```python
import torch

def _softmax(x, axis=-1):
    return torch.softmax(x, dim=axis)

def _gelu(x):
    return torch.nn.functional.gelu(x, approximate='tanh')

def _silu(x):
    return torch.nn.functional.silu(x)

def _sigmoid(x):
    return torch.sigmoid(x)

def _layernorm(x, axis=-1, eps=1e-05):
    m = x.mean(dim=axis, keepdim=True)
    v = x.var(dim=axis, keepdim=True, unbiased=False)
    return (x - m) / torch.sqrt(v + eps)

def _scatter_add(tgt, idx, src, axis=0):
    return tgt.clone().index_add_(axis, idx, src)

def _segment_sum(src, seg, n):
    out = torch.zeros((n,) + src.shape[1:], dtype=src.dtype)
    return out.index_add_(0, seg, src)

def _pad(x, pw):
    flat = tuple((v for pair in reversed(pw) for v in pair))
    return torch.nn.functional.pad(x, flat)
kernel_name = 'gated_mix__sliding_local_dilated__memory_aug_recurrent_mem_tr__prompt'

def setup_inputs():

    _w = lambda a: (lambda t: t.to(torch.bfloat16) if t.is_floating_point() else t)(torch.as_tensor(a))

    def _A_setup():
        B, S, D = (1, 2048, 576)
        return {'x': _w((lambda *s: torch.randn(*s, dtype=torch.bfloat16) * 0.05)(B, S, D)), 'wqkv': _w((lambda *s: torch.randn(*s, dtype=torch.bfloat16) * 0.8)(D, 3 * D)), 'wo': _w((lambda *s: torch.randn(*s, dtype=torch.bfloat16) * 0.05)(D, D))}
    _A_in = _A_setup()

    def _B_setup():
        B, S, Dm = (1, 2048, 576)
        H, Dh = (32, 128)
        M, seg = (8, 32)
        seg = min(seg, S)
        S = S // seg * seg
        return {'x': _w((lambda *s: torch.randn(*s, dtype=torch.bfloat16) * 0.05)(B, S, Dm)), 'mem0': _w((lambda *s: torch.randn(*s, dtype=torch.bfloat16) * 1.6)(B, M, Dm)), 'Wq': _w((lambda *s: torch.randn(*s, dtype=torch.bfloat16) * 0.8)(Dm, H, Dh) * Dm ** (-0.5)), 'Wk': _w((lambda *s: torch.randn(*s, dtype=torch.bfloat16) * 0.8)(Dm, H, Dh) * Dm ** (-0.5)), 'Wv': _w((lambda *s: torch.randn(*s, dtype=torch.bfloat16) * 1.6)(Dm, H, Dh) * Dm ** (-0.5)), 'Wo': _w((lambda *s: torch.randn(*s, dtype=torch.bfloat16) * 1.6)(H, Dh, Dm) * (H * Dh) ** (-0.5)), 'seg_len': seg}
    _B_in = _B_setup()
    return {'A_x': _A_in['x'], 'A_wqkv': _A_in['wqkv'], 'A_wo': _A_in['wo'], 'B_x': _B_in['x'], 'B_mem0': _B_in['mem0'], 'B_Wq': _B_in['Wq'], 'B_Wk': _B_in['Wk'], 'B_Wv': _B_in['Wv'], 'B_Wo': _B_in['Wo'], 'B_seg_len': _B_in['seg_len'], 'gate_w': _w((lambda *s: torch.randn(*s, dtype=torch.bfloat16) * 0.05)(576) * 16.0)}

def reference(A_x, A_wqkv, A_wo, B_x, B_mem0, B_Wq, B_Wk, B_Wv, B_Wo, B_seg_len, gate_w):

    def _A_ref(x, wqkv, wo):
        B, S, D = x.shape
        H = 32
        Dh = D // H
        W, dil = (8, 2)
        qkv = (lambda x, *d: x.permute(*d))((x @ wqkv).reshape(B, S, 3, H, Dh), 2, 0, 3, 1, 4)
        q, k, v = (qkv[0], qkv[1], qkv[2])
        scale = Dh ** (-0.5)
        pos = torch.arange(S)
        off = torch.arange(W) * dil
        idx = pos[:, None] - off[None, :]
        mask = idx >= 0
        idx_c = torch.where(mask, idx, 0).reshape(-1)
        kg = k[:, :, idx_c, :].reshape(B, H, S, W, Dh)
        vg = v[:, :, idx_c, :].reshape(B, H, S, W, Dh)
        logits = torch.einsum('bhsd,bhswd->bhsw', q, kg) * scale
        logits = torch.where(mask[None, None, :, :], logits, -1000000000.0)
        attn = _softmax(logits, axis=-1)
        o = torch.einsum('bhsw,bhswd->bhsd', attn, vg)
        return (lambda x, *d: x.permute(*d))(o, 0, 2, 1, 3).reshape(B, S, D) @ wo

    def _B_ref(x, mem0, Wq, Wk, Wv, Wo, seg_len):
        B, S, Dm = x.shape
        H, Dh = (Wq.shape[1], Wq.shape[2])
        M = mem0.shape[1]
        scale = Dh ** (-0.5)
        n_seg = S // seg_len
        L = M + seg_len
        idx = torch.arange(L)
        mask = (idx[:, None] < M) | (idx[:, None] >= idx[None, :])
        mem = mem0
        outs = []
        for s in range(n_seg):
            xs = x[:, s * seg_len:(s + 1) * seg_len, :].clone()
            h = torch.concatenate([mem, xs], axis=1)
            q = torch.einsum('btd,dhe->bhte', h, Wq)
            k = torch.einsum('btd,dhe->bhte', h, Wk)
            v = torch.einsum('btd,dhe->bhte', h, Wv)
            scores = torch.einsum('bhqe,bhke->bhqk', q, k) * scale
            scores = torch.where(mask[None, None], scores, -1000000000.0)
            p = _softmax(scores, axis=-1)
            o = torch.einsum('bhqk,bhke->bhqe', p, v)
            o = torch.einsum('bhte,hed->btd', o, Wo)
            mem = o[:, :M, :].clone()
            outs.append(o[:, M:, :])
        return torch.concatenate(outs, axis=1)
    x = A_x
    g = _sigmoid((x * gate_w).sum(-1, keepdims=True))
    a = _A_ref(x, A_wqkv, A_wo)
    b = _B_ref(x, B_mem0, B_Wq, B_Wk, B_Wv, B_Wo, B_seg_len)
    return g * a + (1 - g) * b
```

```asm
; @launch grid=(256,1,1) block=(256,1,1) lds=163840
.amdgcn_target "amdgcn-amd-amdhsa--gfx950"
.text
.globl gated_mix__sliding_local_dilated__memory_aug_recurrent_mem_tr__prompt_kernel
.p2align 8
.type gated_mix__sliding_local_dilated__memory_aug_recurrent_mem_tr__prompt_kernel,@function
gated_mix__sliding_local_dilated__memory_aug_recurrent_mem_tr__prompt_kernel:
  s_cmp_ge_u32 s2, 256
  s_cbranch_scc1 L_end
  s_load_dwordx2 s[4:5], s[0:1], 0
  s_load_dwordx2 s[8:9], s[0:1], 104
  s_load_dwordx2 s[12:13], s[0:1], 96
  s_load_dwordx2 s[16:17], s[0:1], 40
  s_load_dwordx2 s[20:21], s[0:1], 48
  s_load_dwordx2 s[24:25], s[0:1], 56
  s_load_dwordx2 s[28:29], s[0:1], 64
  s_load_dwordx2 s[32:33], s[0:1], 32
  s_load_dwordx2 s[36:37], s[0:1], 8
  s_load_dwordx2 s[40:41], s[0:1], 16
  s_load_dwordx2 s[44:45], s[0:1], 80
  s_load_dwordx2 s[48:49], s[0:1], 88
  s_getreg_b32 s54, hwreg(HW_REG_XCC_ID, 0, 3)
  v_lshrrev_b32 v1, 6, v0
  s_nop 0
  v_readfirstlane_b32 s52, v1
  s_mov_b32 s6, 2359296
  s_mov_b32 s7, 0x20000
  s_mov_b32 s10, 268435456
  s_mov_b32 s11, 0x20000
  s_mov_b32 s14, 256
  s_mov_b32 s15, 0x20000
  s_mov_b32 s18, 4718592
  s_mov_b32 s19, 0x20000
  s_mov_b32 s22, 4718592
  s_mov_b32 s23, 0x20000
  s_mov_b32 s26, 4718592
  s_mov_b32 s27, 0x20000
  s_mov_b32 s30, 4718592
  s_mov_b32 s31, 0x20000
  s_mov_b32 s34, 9216
  s_mov_b32 s35, 0x20000
  s_mov_b32 s38, 1990656
  s_mov_b32 s39, 0x20000
  s_mov_b32 s42, 663552
  s_mov_b32 s43, 0x20000
  s_mov_b32 s46, 1152
  s_mov_b32 s47, 0x20000
  s_mov_b32 s50, 2359296
  s_mov_b32 s51, 0x20000
  s_waitcnt lgkmcnt(0)
  s_cmp_eq_u32 s52, 0
  s_cbranch_scc0 L_t1
  s_lshl_b32 s55, s54, 2
  v_mov_b32 v1, s55
  v_mov_b32 v2, 1
  s_mov_b64 exec, 1
  buffer_atomic_add v2, v1, s[12:15], 0 offen sc0
  v_mov_b32 v1, 16320
  s_waitcnt vmcnt(0)
  ds_write_b32 v1, v2
  s_mov_b64 exec, -1
  s_waitcnt lgkmcnt(0)
L_t1:
  s_barrier
  v_mov_b32 v1, 16320
  ds_read_b32 v2, v1
  s_waitcnt lgkmcnt(0)
  v_readfirstlane_b32 s53, v2
  s_barrier
  s_cmp_eq_u32 s54, 0
  s_cbranch_scc1 L_chain
  s_sub_u32 s54, s54, 1
  s_lshl_b32 s54, s54, 5
  s_add_u32 s53, s53, s54
  v_and_b32 v200, 63, v0
  v_lshlrev_b32 v201, 4, v200
  v_lshrrev_b32 v211, 3, v200
  s_lshl_b32 s54, s52, 3
  v_add_u32 v211, s54, v211
  v_bfe_u32 v212, v211, 1, 3
  v_and_b32 v213, 7, v200
  v_xor_b32 v212, v212, v213
  v_mul_u32_u24 v211, 1152, v211
  v_lshl_add_u32 v202, v212, 4, v211
  s_mul_i32 s67, s52, 9216
  v_and_b32 v211, 31, v200
  v_lshrrev_b32 v212, 3, v211
  v_mul_u32_u24 v212, 9216, v212
  v_and_b32 v213, 7, v211
  v_lshl_add_u32 v212, v213, 7, v212
  v_bfe_u32 v213, v211, 1, 3
  v_lshrrev_b32 v214, 5, v200
  v_xor_b32 v213, v213, v214
  v_lshl_add_u32 v203, v213, 4, v212
  v_xor_b32 v204, 32, v203
  v_xor_b32 v205, 64, v203
  v_xor_b32 v206, 0x60, v203
  v_bfe_u32 v211, v200, 2, 2
  v_lshl_add_u32 v212, v214, 3, v211
  v_lshlrev_b32 v212, 8, v212
  v_xor_b32 v211, s52, v211
  v_lshl_add_u32 v212, v211, 6, v212
  v_bfe_u32 v213, v200, 4, 1
  v_and_b32 v211, 3, v200
  v_lshl_add_u32 v210, v213, 5, v212
  v_lshl_add_u32 v210, v211, 3, v210
  v_lshl_add_u32 v209, v213, 4, v212
  v_and_b32 v213, 1, v211
  v_lshl_add_u32 v209, v213, 3, v209
  v_lshrrev_b32 v213, 1, v211
  v_lshl_add_u32 v209, v213, 5, v209
  s_mov_b32 s65, 0
  s_mul_i32 s58, s53, 9363
  s_lshr_b32 s58, s58, 16
  s_mul_i32 s54, s58, 7
  s_sub_u32 s59, s53, s54
  s_mul_i32 s60, s59, 36864
  s_mul_i32 s55, s53, 21846
  s_lshr_b32 s55, s55, 16
  s_mul_i32 s56, s55, 3
  s_sub_u32 s56, s53, s56
  s_lshl_b32 s56, s56, 7
  s_lshl_b32 s55, s55, 2
  s_add_u32 s55, s55, s56
  s_add_u32 s55, s55, 105914368
  s_cmp_lt_u32 s53, 96
  s_cselect_b32 s71, s55, 268435456
  v_mov_b32 v211, 0
  s_mov_b64 exec, 1
  buffer_store_dword v211, v211, s[8:11], s71 offen sc1
  s_mov_b64 exec, -1
  s_add_u32 m0, s67, 0
  s_nop 0
  buffer_load_dwordx4 v202, s[4:7], s60 offen offset:0 lds
  s_add_u32 m0, s67, 896
  s_nop 0
  buffer_load_dwordx4 v202, s[4:7], s60 offen offset:128 lds
  s_add_u32 m0, s67, 1792
  s_nop 0
  buffer_load_dwordx4 v202, s[4:7], s60 offen offset:256 lds
  s_add_u32 m0, s67, 2688
  s_nop 0
  buffer_load_dwordx4 v202, s[4:7], s60 offen offset:384 lds
  s_add_u32 m0, s67, 3584
  s_nop 0
  buffer_load_dwordx4 v202, s[4:7], s60 offen offset:512 lds
  s_add_u32 m0, s67, 4480
  s_nop 0
  buffer_load_dwordx4 v202, s[4:7], s60 offen offset:640 lds
  s_add_u32 m0, s67, 5376
  s_nop 0
  buffer_load_dwordx4 v202, s[4:7], s60 offen offset:768 lds
  s_add_u32 m0, s67, 6272
  s_nop 0
  buffer_load_dwordx4 v202, s[4:7], s60 offen offset:896 lds
  s_add_u32 m0, s67, 7168
  s_nop 0
  buffer_load_dwordx4 v202, s[4:7], s60 offen offset:1024 lds
  v_lshrrev_b32 v211, 4, v200
  v_lshlrev_b32 v212, 2, v211
  v_and_b32 v213, 15, v200
  v_xor_b32 v212, v212, v213
  v_lshlrev_b32 v212, 4, v212
  v_lshl_add_u32 v207, v211, 13, v212
  s_lshl_b32 s62, s58, 8
  s_lshl_b32 s54, s52, 15
  s_add_u32 s62, s62, s54
  v_bfe_u32 v211, v200, 3, 2
  v_lshlrev_b32 v216, 11, v211
  v_bfe_u32 v211, v200, 1, 2
  v_lshl_add_u32 v216, v211, 6, v216
  v_lshrrev_b32 v212, 5, v200
  v_lshl_add_u32 v216, v212, 5, v216
  v_and_b32 v211, 1, v200
  v_lshl_add_u32 v216, v211, 4, v216
  v_bfe_u32 v211, v200, 4, 1
  v_lshlrev_b32 v217, 10, v211
  v_lshl_add_u32 v217, v212, 9, v217
  v_and_b32 v211, 15, v200
  v_lshl_add_u32 v217, v211, 4, v217
  s_lshl_b32 s54, s52, 11
  s_add_u32 s54, s54, 8192
  v_add_u32 v217, s54, v217
  s_lshl_b32 s61, s52, 10
  s_add_u32 s61, s61, 36864
  s_add_u32 m0, s61, 0
  s_add_u32 s54, s62, 0
  buffer_load_dwordx4 v207, s[20:23], s54 offen lds
  s_add_u32 m0, s61, 4096
  s_add_u32 s54, s62, 131072
  buffer_load_dwordx4 v207, s[20:23], s54 offen lds
  s_add_u32 m0, s61, 8192
  s_add_u32 s54, s62, 262144
  buffer_load_dwordx4 v207, s[20:23], s54 offen lds
  s_add_u32 m0, s61, 12288
  s_add_u32 s54, s62, 393216
  buffer_load_dwordx4 v207, s[20:23], s54 offen lds
  s_add_u32 m0, s61, 16384
  s_add_u32 s54, s62, 0
  buffer_load_dwordx4 v207, s[24:27], s54 offen lds
  s_add_u32 m0, s61, 20480
  s_add_u32 s54, s62, 131072
  buffer_load_dwordx4 v207, s[24:27], s54 offen lds
  s_add_u32 m0, s61, 24576
  s_add_u32 s54, s62, 262144
  buffer_load_dwordx4 v207, s[24:27], s54 offen lds
  s_add_u32 m0, s61, 28672
  s_add_u32 s54, s62, 393216
  buffer_load_dwordx4 v207, s[24:27], s54 offen lds
  s_add_u32 m0, s61, 32768
  s_add_u32 s54, s62, 524288
  buffer_load_dwordx4 v207, s[20:23], s54 offen lds
  s_add_u32 m0, s61, 36864
  s_add_u32 s54, s62, 655360
  buffer_load_dwordx4 v207, s[20:23], s54 offen lds
  s_add_u32 m0, s61, 40960
  s_add_u32 s54, s62, 786432
  buffer_load_dwordx4 v207, s[20:23], s54 offen lds
  s_add_u32 m0, s61, 45056
  s_add_u32 s54, s62, 917504
  buffer_load_dwordx4 v207, s[20:23], s54 offen lds
  s_add_u32 m0, s61, 49152
  s_add_u32 s54, s62, 524288
  buffer_load_dwordx4 v207, s[24:27], s54 offen lds
  s_add_u32 m0, s61, 53248
  s_add_u32 s54, s62, 655360
  buffer_load_dwordx4 v207, s[24:27], s54 offen lds
  s_add_u32 m0, s61, 57344
  s_add_u32 s54, s62, 786432
  buffer_load_dwordx4 v207, s[24:27], s54 offen lds
  s_add_u32 m0, s61, 61440
  s_add_u32 s54, s62, 917504
  buffer_load_dwordx4 v207, s[24:27], s54 offen lds
  s_add_u32 m0, s61, 65536
  s_add_u32 s54, s62, 1048576
  buffer_load_dwordx4 v207, s[20:23], s54 offen lds
  s_add_u32 m0, s61, 69632
  s_add_u32 s54, s62, 1179648
  buffer_load_dwordx4 v207, s[20:23], s54 offen lds
  s_add_u32 m0, s61, 73728
  s_add_u32 s54, s62, 1310720
  buffer_load_dwordx4 v207, s[20:23], s54 offen lds
  s_add_u32 m0, s61, 77824
  s_add_u32 s54, s62, 1441792
  buffer_load_dwordx4 v207, s[20:23], s54 offen lds
  s_add_u32 m0, s61, 81920
  s_add_u32 s54, s62, 1048576
  buffer_load_dwordx4 v207, s[24:27], s54 offen lds
  s_add_u32 m0, s61, 86016
  s_add_u32 s54, s62, 1179648
  buffer_load_dwordx4 v207, s[24:27], s54 offen lds
  s_add_u32 m0, s61, 90112
  s_add_u32 s54, s62, 1310720
  buffer_load_dwordx4 v207, s[24:27], s54 offen lds
  s_add_u32 m0, s61, 94208
  s_add_u32 s54, s62, 1441792
  buffer_load_dwordx4 v207, s[24:27], s54 offen lds
  s_waitcnt vmcnt(20) lgkmcnt(0)
  s_barrier
  s_add_u32 m0, s61, 98304
  s_add_u32 s54, s62, 1572864
  buffer_load_dwordx4 v207, s[20:23], s54 offen lds
  s_add_u32 m0, s61, 102400
  s_add_u32 s54, s62, 1703936
  buffer_load_dwordx4 v207, s[20:23], s54 offen lds
  s_add_u32 m0, s61, 106496
  s_add_u32 s54, s62, 1835008
  buffer_load_dwordx4 v207, s[20:23], s54 offen lds
  s_add_u32 m0, s61, 110592
  s_add_u32 s54, s62, 1966080
  buffer_load_dwordx4 v207, s[20:23], s54 offen lds
  v_add_u32 v215, 36864, v209
  ds_read_b64_tr_b16 a[0:1], v215 offset:0
  ds_read_b64_tr_b16 a[2:3], v215 offset:1024
  ds_read_b64_tr_b16 a[4:5], v215 offset:4096
  ds_read_b64_tr_b16 a[6:7], v215 offset:5120
  ds_read_b64_tr_b16 a[8:9], v215 offset:8192
  ds_read_b64_tr_b16 a[10:11], v215 offset:9216
  ds_read_b64_tr_b16 a[12:13], v215 offset:12288
  ds_read_b64_tr_b16 a[14:15], v215 offset:13312
  s_waitcnt vmcnt(20) lgkmcnt(0)
  s_barrier
  s_add_u32 m0, s61, 0
  s_add_u32 s54, s62, 1572864
  buffer_load_dwordx4 v207, s[24:27], s54 offen lds
  s_add_u32 m0, s61, 4096
  s_add_u32 s54, s62, 1703936
  buffer_load_dwordx4 v207, s[24:27], s54 offen lds
  s_add_u32 m0, s61, 8192
  s_add_u32 s54, s62, 1835008
  buffer_load_dwordx4 v207, s[24:27], s54 offen lds
  s_add_u32 m0, s61, 12288
  s_add_u32 s54, s62, 1966080
  buffer_load_dwordx4 v207, s[24:27], s54 offen lds
  v_add_u32 v215, 53248, v210
  ds_read_b64_tr_b16 a[144:145], v215 offset:0
  ds_read_b64_tr_b16 a[146:147], v215 offset:1024
  ds_read_b64_tr_b16 a[148:149], v215 offset:4096
  ds_read_b64_tr_b16 a[150:151], v215 offset:5120
  ds_read_b64_tr_b16 a[152:153], v215 offset:8192
  ds_read_b64_tr_b16 a[154:155], v215 offset:9216
  ds_read_b64_tr_b16 a[156:157], v215 offset:12288
  ds_read_b64_tr_b16 a[158:159], v215 offset:13312
  s_waitcnt vmcnt(20) lgkmcnt(0)
  s_barrier
  s_add_u32 m0, s61, 16384
  s_add_u32 s54, s62, 2097152
  buffer_load_dwordx4 v207, s[20:23], s54 offen lds
  s_add_u32 m0, s61, 20480
  s_add_u32 s54, s62, 2228224
  buffer_load_dwordx4 v207, s[20:23], s54 offen lds
  s_add_u32 m0, s61, 24576
  s_add_u32 s54, s62, 2359296
  buffer_load_dwordx4 v207, s[20:23], s54 offen lds
  s_add_u32 m0, s61, 28672
  s_add_u32 s54, s62, 2490368
  buffer_load_dwordx4 v207, s[20:23], s54 offen lds
  v_add_u32 v215, 69632, v209
  ds_read_b64_tr_b16 a[16:17], v215 offset:0
  ds_read_b64_tr_b16 a[18:19], v215 offset:1024
  ds_read_b64_tr_b16 a[20:21], v215 offset:4096
  ds_read_b64_tr_b16 a[22:23], v215 offset:5120
  ds_read_b64_tr_b16 a[24:25], v215 offset:8192
  ds_read_b64_tr_b16 a[26:27], v215 offset:9216
  ds_read_b64_tr_b16 a[28:29], v215 offset:12288
  ds_read_b64_tr_b16 a[30:31], v215 offset:13312
  s_waitcnt vmcnt(20) lgkmcnt(0)
  s_barrier
  s_add_u32 m0, s61, 32768
  s_add_u32 s54, s62, 2097152
  buffer_load_dwordx4 v207, s[24:27], s54 offen lds
  s_add_u32 m0, s61, 36864
  s_add_u32 s54, s62, 2228224
  buffer_load_dwordx4 v207, s[24:27], s54 offen lds
  s_add_u32 m0, s61, 40960
  s_add_u32 s54, s62, 2359296
  buffer_load_dwordx4 v207, s[24:27], s54 offen lds
  s_add_u32 m0, s61, 45056
  s_add_u32 s54, s62, 2490368
  buffer_load_dwordx4 v207, s[24:27], s54 offen lds
  v_add_u32 v215, 86016, v210
  ds_read_b64_tr_b16 a[160:161], v215 offset:0
  ds_read_b64_tr_b16 a[162:163], v215 offset:1024
  ds_read_b64_tr_b16 a[164:165], v215 offset:4096
  ds_read_b64_tr_b16 a[166:167], v215 offset:5120
  ds_read_b64_tr_b16 a[168:169], v215 offset:8192
  ds_read_b64_tr_b16 a[170:171], v215 offset:9216
  ds_read_b64_tr_b16 a[172:173], v215 offset:12288
  ds_read_b64_tr_b16 a[174:175], v215 offset:13312
  s_waitcnt vmcnt(20) lgkmcnt(0)
  s_barrier
  s_add_u32 m0, s61, 49152
  s_add_u32 s54, s62, 2621440
  buffer_load_dwordx4 v207, s[20:23], s54 offen lds
  s_add_u32 m0, s61, 53248
  s_add_u32 s54, s62, 2752512
  buffer_load_dwordx4 v207, s[20:23], s54 offen lds
  s_add_u32 m0, s61, 57344
  s_add_u32 s54, s62, 2883584
  buffer_load_dwordx4 v207, s[20:23], s54 offen lds
  s_add_u32 m0, s61, 61440
  s_add_u32 s54, s62, 3014656
  buffer_load_dwordx4 v207, s[20:23], s54 offen lds
  v_add_u32 v215, 102400, v209
  ds_read_b64_tr_b16 a[32:33], v215 offset:0
  ds_read_b64_tr_b16 a[34:35], v215 offset:1024
  ds_read_b64_tr_b16 a[36:37], v215 offset:4096
  ds_read_b64_tr_b16 a[38:39], v215 offset:5120
  ds_read_b64_tr_b16 a[40:41], v215 offset:8192
  ds_read_b64_tr_b16 a[42:43], v215 offset:9216
  ds_read_b64_tr_b16 a[44:45], v215 offset:12288
  ds_read_b64_tr_b16 a[46:47], v215 offset:13312
  s_waitcnt vmcnt(20) lgkmcnt(0)
  s_barrier
  s_add_u32 m0, s61, 65536
  s_add_u32 s54, s62, 2621440
  buffer_load_dwordx4 v207, s[24:27], s54 offen lds
  s_add_u32 m0, s61, 69632
  s_add_u32 s54, s62, 2752512
  buffer_load_dwordx4 v207, s[24:27], s54 offen lds
  s_add_u32 m0, s61, 73728
  s_add_u32 s54, s62, 2883584
  buffer_load_dwordx4 v207, s[24:27], s54 offen lds
  s_add_u32 m0, s61, 77824
  s_add_u32 s54, s62, 3014656
  buffer_load_dwordx4 v207, s[24:27], s54 offen lds
  v_add_u32 v215, 118784, v210
  ds_read_b64_tr_b16 a[176:177], v215 offset:0
  ds_read_b64_tr_b16 a[178:179], v215 offset:1024
  ds_read_b64_tr_b16 a[180:181], v215 offset:4096
  ds_read_b64_tr_b16 a[182:183], v215 offset:5120
  ds_read_b64_tr_b16 a[184:185], v215 offset:8192
  ds_read_b64_tr_b16 a[186:187], v215 offset:9216
  ds_read_b64_tr_b16 a[188:189], v215 offset:12288
  ds_read_b64_tr_b16 a[190:191], v215 offset:13312
  s_waitcnt vmcnt(20) lgkmcnt(0)
  s_barrier
  s_add_u32 m0, s61, 81920
  s_add_u32 s54, s62, 3145728
  buffer_load_dwordx4 v207, s[20:23], s54 offen lds
  s_add_u32 m0, s61, 86016
  s_add_u32 s54, s62, 3276800
  buffer_load_dwordx4 v207, s[20:23], s54 offen lds
  s_add_u32 m0, s61, 90112
  s_add_u32 s54, s62, 3407872
  buffer_load_dwordx4 v207, s[20:23], s54 offen lds
  s_add_u32 m0, s61, 94208
  s_add_u32 s54, s62, 3538944
  buffer_load_dwordx4 v207, s[20:23], s54 offen lds
  v_add_u32 v215, 135168, v209
  ds_read_b64_tr_b16 a[48:49], v215 offset:0
  ds_read_b64_tr_b16 a[50:51], v215 offset:1024
  ds_read_b64_tr_b16 a[52:53], v215 offset:4096
  ds_read_b64_tr_b16 a[54:55], v215 offset:5120
  ds_read_b64_tr_b16 a[56:57], v215 offset:8192
  ds_read_b64_tr_b16 a[58:59], v215 offset:9216
  ds_read_b64_tr_b16 a[60:61], v215 offset:12288
  ds_read_b64_tr_b16 a[62:63], v215 offset:13312
  s_waitcnt vmcnt(20) lgkmcnt(0)
  s_barrier
  s_add_u32 m0, s61, 98304
  s_add_u32 s54, s62, 3145728
  buffer_load_dwordx4 v207, s[24:27], s54 offen lds
  s_add_u32 m0, s61, 102400
  s_add_u32 s54, s62, 3276800
  buffer_load_dwordx4 v207, s[24:27], s54 offen lds
  s_add_u32 m0, s61, 106496
  s_add_u32 s54, s62, 3407872
  buffer_load_dwordx4 v207, s[24:27], s54 offen lds
  s_add_u32 m0, s61, 110592
  s_add_u32 s54, s62, 3538944
  buffer_load_dwordx4 v207, s[24:27], s54 offen lds
  v_add_u32 v215, 36864, v210
  ds_read_b64_tr_b16 a[192:193], v215 offset:0
  ds_read_b64_tr_b16 a[194:195], v215 offset:1024
  ds_read_b64_tr_b16 a[196:197], v215 offset:4096
  ds_read_b64_tr_b16 a[198:199], v215 offset:5120
  ds_read_b64_tr_b16 a[200:201], v215 offset:8192
  ds_read_b64_tr_b16 a[202:203], v215 offset:9216
  ds_read_b64_tr_b16 a[204:205], v215 offset:12288
  ds_read_b64_tr_b16 a[206:207], v215 offset:13312
  s_waitcnt vmcnt(20) lgkmcnt(0)
  s_barrier
  s_add_u32 m0, s61, 0
  s_add_u32 s54, s62, 3670016
  buffer_load_dwordx4 v207, s[20:23], s54 offen lds
  s_add_u32 m0, s61, 4096
  s_add_u32 s54, s62, 3801088
  buffer_load_dwordx4 v207, s[20:23], s54 offen lds
  s_add_u32 m0, s61, 8192
  s_add_u32 s54, s62, 3932160
  buffer_load_dwordx4 v207, s[20:23], s54 offen lds
  s_add_u32 m0, s61, 12288
  s_add_u32 s54, s62, 4063232
  buffer_load_dwordx4 v207, s[20:23], s54 offen lds
  v_add_u32 v215, 53248, v209
  ds_read_b64_tr_b16 a[64:65], v215 offset:0
  ds_read_b64_tr_b16 a[66:67], v215 offset:1024
  ds_read_b64_tr_b16 a[68:69], v215 offset:4096
  ds_read_b64_tr_b16 a[70:71], v215 offset:5120
  ds_read_b64_tr_b16 a[72:73], v215 offset:8192
  ds_read_b64_tr_b16 a[74:75], v215 offset:9216
  ds_read_b64_tr_b16 a[76:77], v215 offset:12288
  ds_read_b64_tr_b16 a[78:79], v215 offset:13312
  s_waitcnt vmcnt(20) lgkmcnt(0)
  s_barrier
  s_add_u32 m0, s61, 16384
  s_add_u32 s54, s62, 3670016
  buffer_load_dwordx4 v207, s[24:27], s54 offen lds
  s_add_u32 m0, s61, 20480
  s_add_u32 s54, s62, 3801088
  buffer_load_dwordx4 v207, s[24:27], s54 offen lds
  s_add_u32 m0, s61, 24576
  s_add_u32 s54, s62, 3932160
  buffer_load_dwordx4 v207, s[24:27], s54 offen lds
  s_add_u32 m0, s61, 28672
  s_add_u32 s54, s62, 4063232
  buffer_load_dwordx4 v207, s[24:27], s54 offen lds
  v_add_u32 v215, 69632, v210
  ds_read_b64_tr_b16 a[208:209], v215 offset:0
  ds_read_b64_tr_b16 a[210:211], v215 offset:1024
  ds_read_b64_tr_b16 a[212:213], v215 offset:4096
  ds_read_b64_tr_b16 a[214:215], v215 offset:5120
  ds_read_b64_tr_b16 a[216:217], v215 offset:8192
  ds_read_b64_tr_b16 a[218:219], v215 offset:9216
  ds_read_b64_tr_b16 a[220:221], v215 offset:12288
  ds_read_b64_tr_b16 a[222:223], v215 offset:13312
  s_waitcnt vmcnt(20) lgkmcnt(0)
  s_barrier
  s_add_u32 m0, s61, 32768
  s_add_u32 s54, s62, 4194304
  buffer_load_dwordx4 v207, s[20:23], s54 offen lds
  s_add_u32 m0, s61, 36864
  s_add_u32 s54, s62, 4325376
  buffer_load_dwordx4 v207, s[20:23], s54 offen lds
  s_add_u32 m0, s61, 40960
  s_add_u32 s54, s62, 4456448
  buffer_load_dwordx4 v207, s[20:23], s54 offen lds
  s_add_u32 m0, s61, 45056
  s_add_u32 s54, s62, 4587520
  buffer_load_dwordx4 v207, s[20:23], s54 offen lds
  v_add_u32 v215, 86016, v209
  ds_read_b64_tr_b16 a[80:81], v215 offset:0
  ds_read_b64_tr_b16 a[82:83], v215 offset:1024
  ds_read_b64_tr_b16 a[84:85], v215 offset:4096
  ds_read_b64_tr_b16 a[86:87], v215 offset:5120
  ds_read_b64_tr_b16 a[88:89], v215 offset:8192
  ds_read_b64_tr_b16 a[90:91], v215 offset:9216
  ds_read_b64_tr_b16 a[92:93], v215 offset:12288
  ds_read_b64_tr_b16 a[94:95], v215 offset:13312
  s_waitcnt vmcnt(20) lgkmcnt(0)
  s_barrier
  s_add_u32 m0, s61, 49152
  s_add_u32 s54, s62, 4194304
  buffer_load_dwordx4 v207, s[24:27], s54 offen lds
  s_add_u32 m0, s61, 53248
  s_add_u32 s54, s62, 4325376
  buffer_load_dwordx4 v207, s[24:27], s54 offen lds
  s_add_u32 m0, s61, 57344
  s_add_u32 s54, s62, 4456448
  buffer_load_dwordx4 v207, s[24:27], s54 offen lds
  s_add_u32 m0, s61, 61440
  s_add_u32 s54, s62, 4587520
  buffer_load_dwordx4 v207, s[24:27], s54 offen lds
  v_add_u32 v215, 102400, v210
  ds_read_b64_tr_b16 a[224:225], v215 offset:0
  ds_read_b64_tr_b16 a[226:227], v215 offset:1024
  ds_read_b64_tr_b16 a[228:229], v215 offset:4096
  ds_read_b64_tr_b16 a[230:231], v215 offset:5120
  ds_read_b64_tr_b16 a[232:233], v215 offset:8192
  ds_read_b64_tr_b16 a[234:235], v215 offset:9216
  ds_read_b64_tr_b16 a[236:237], v215 offset:12288
  ds_read_b64_tr_b16 a[238:239], v215 offset:13312
  s_waitcnt vmcnt(20) lgkmcnt(0)
  s_barrier
  v_add_u32 v215, 118784, v209
  ds_read_b64_tr_b16 a[96:97], v215 offset:0
  ds_read_b64_tr_b16 a[98:99], v215 offset:1024
  ds_read_b64_tr_b16 a[100:101], v215 offset:4096
  ds_read_b64_tr_b16 a[102:103], v215 offset:5120
  ds_read_b64_tr_b16 a[104:105], v215 offset:8192
  ds_read_b64_tr_b16 a[106:107], v215 offset:9216
  ds_read_b64_tr_b16 a[108:109], v215 offset:12288
  ds_read_b64_tr_b16 a[110:111], v215 offset:13312
  s_waitcnt vmcnt(16) lgkmcnt(0)
  s_barrier
  v_add_u32 v215, 135168, v210
  ds_read_b64_tr_b16 a[240:241], v215 offset:0
  ds_read_b64_tr_b16 a[242:243], v215 offset:1024
  ds_read_b64_tr_b16 a[244:245], v215 offset:4096
  ds_read_b64_tr_b16 a[246:247], v215 offset:5120
  ds_read_b64_tr_b16 a[248:249], v215 offset:8192
  ds_read_b64_tr_b16 a[250:251], v215 offset:9216
  ds_read_b64_tr_b16 a[252:253], v215 offset:12288
  ds_read_b64_tr_b16 a[254:255], v215 offset:13312
  s_waitcnt vmcnt(12) lgkmcnt(0)
  s_barrier
  v_add_u32 v215, 36864, v209
  ds_read_b64_tr_b16 a[112:113], v215 offset:0
  ds_read_b64_tr_b16 a[114:115], v215 offset:1024
  ds_read_b64_tr_b16 a[116:117], v215 offset:4096
  ds_read_b64_tr_b16 a[118:119], v215 offset:5120
  ds_read_b64_tr_b16 a[120:121], v215 offset:8192
  ds_read_b64_tr_b16 a[122:123], v215 offset:9216
  ds_read_b64_tr_b16 a[124:125], v215 offset:12288
  ds_read_b64_tr_b16 a[126:127], v215 offset:13312
  s_waitcnt vmcnt(8) lgkmcnt(0)
  s_barrier
  v_add_u32 v215, 53248, v210
  ds_read_b64_tr_b16 v[224:225], v215 offset:0
  ds_read_b64_tr_b16 v[226:227], v215 offset:1024
  ds_read_b64_tr_b16 v[228:229], v215 offset:4096
  ds_read_b64_tr_b16 v[230:231], v215 offset:5120
  ds_read_b64_tr_b16 v[232:233], v215 offset:8192
  ds_read_b64_tr_b16 v[234:235], v215 offset:9216
  ds_read_b64_tr_b16 v[236:237], v215 offset:12288
  ds_read_b64_tr_b16 v[238:239], v215 offset:13312
  s_waitcnt vmcnt(4) lgkmcnt(0)
  s_barrier
  v_add_u32 v215, 69632, v209
  ds_read_b64_tr_b16 a[128:129], v215 offset:0
  ds_read_b64_tr_b16 a[130:131], v215 offset:1024
  ds_read_b64_tr_b16 a[132:133], v215 offset:4096
  ds_read_b64_tr_b16 a[134:135], v215 offset:5120
  ds_read_b64_tr_b16 a[136:137], v215 offset:8192
  ds_read_b64_tr_b16 a[138:139], v215 offset:9216
  ds_read_b64_tr_b16 a[140:141], v215 offset:12288
  ds_read_b64_tr_b16 a[142:143], v215 offset:13312
  s_waitcnt vmcnt(0) lgkmcnt(0)
  s_barrier
  v_add_u32 v215, 86016, v210
  ds_read_b64_tr_b16 v[240:241], v215 offset:0
  ds_read_b64_tr_b16 v[242:243], v215 offset:1024
  ds_read_b64_tr_b16 v[244:245], v215 offset:4096
  ds_read_b64_tr_b16 v[246:247], v215 offset:5120
  ds_read_b64_tr_b16 v[248:249], v215 offset:8192
  ds_read_b64_tr_b16 v[250:251], v215 offset:9216
  ds_read_b64_tr_b16 v[252:253], v215 offset:12288
  ds_read_b64_tr_b16 v[254:255], v215 offset:13312
  s_waitcnt lgkmcnt(0)
  s_barrier
  s_mov_b32 s68, 1040356334
  s_lshl_b32 s69, s52, 9
KV_loop:
  s_add_u32 s60, s60, 258048
  s_add_u32 m0, s67, 36864
  s_nop 0
  buffer_load_dwordx4 v202, s[4:7], s60 offen offset:0 lds
  s_add_u32 m0, s67, 37760
  s_nop 0
  buffer_load_dwordx4 v202, s[4:7], s60 offen offset:128 lds
  s_add_u32 m0, s67, 38656
  s_nop 0
  buffer_load_dwordx4 v202, s[4:7], s60 offen offset:256 lds
  s_add_u32 m0, s67, 39552
  s_nop 0
  buffer_load_dwordx4 v202, s[4:7], s60 offen offset:384 lds
  s_add_u32 m0, s67, 40448
  s_nop 0
  buffer_load_dwordx4 v202, s[4:7], s60 offen offset:512 lds
  s_add_u32 m0, s67, 41344
  s_nop 0
  buffer_load_dwordx4 v202, s[4:7], s60 offen offset:640 lds
  s_add_u32 m0, s67, 42240
  s_nop 0
  buffer_load_dwordx4 v202, s[4:7], s60 offen offset:768 lds
  s_add_u32 m0, s67, 43136
  s_nop 0
  buffer_load_dwordx4 v202, s[4:7], s60 offen offset:896 lds
  s_add_u32 m0, s67, 44032
  s_nop 0
  buffer_load_dwordx4 v202, s[4:7], s60 offen offset:1024 lds
  ds_read_b128 v[32:35], v203 offset:0
  ds_read_b128 v[36:39], v204 offset:0
  ds_read_b128 v[40:43], v205 offset:0
  s_waitcnt lgkmcnt(2)
  v_mfma_f32_32x32x16_bf16 v[0:15], a[0:3], v[32:35], 0
  ds_read_b128 v[44:47], v206 offset:0
  v_mfma_f32_32x32x16_bf16 v[16:31], v[32:35], a[144:147], 0
  s_waitcnt lgkmcnt(2)
  v_mfma_f32_32x32x16_bf16 v[0:15], a[4:7], v[36:39], v[0:15]
  ds_read_b128 v[32:35], v203 offset:1024
  v_mfma_f32_32x32x16_bf16 v[16:31], v[36:39], a[148:151], v[16:31]
  s_waitcnt lgkmcnt(2)
  v_mfma_f32_32x32x16_bf16 v[0:15], a[8:11], v[40:43], v[0:15]
  ds_read_b128 v[36:39], v204 offset:1024
  v_mfma_f32_32x32x16_bf16 v[16:31], v[40:43], a[152:155], v[16:31]
  s_waitcnt lgkmcnt(2)
  v_mfma_f32_32x32x16_bf16 v[0:15], a[12:15], v[44:47], v[0:15]
  ds_read_b128 v[40:43], v205 offset:1024
  v_mfma_f32_32x32x16_bf16 v[16:31], v[44:47], a[156:159], v[16:31]
  s_waitcnt lgkmcnt(2)
  v_mfma_f32_32x32x16_bf16 v[0:15], a[16:19], v[32:35], v[0:15]
  ds_read_b128 v[44:47], v206 offset:1024
  v_mfma_f32_32x32x16_bf16 v[16:31], v[32:35], a[160:163], v[16:31]
  s_waitcnt lgkmcnt(2)
  v_mfma_f32_32x32x16_bf16 v[0:15], a[20:23], v[36:39], v[0:15]
  ds_read_b128 v[32:35], v203 offset:2048
  v_mfma_f32_32x32x16_bf16 v[16:31], v[36:39], a[164:167], v[16:31]
  s_waitcnt lgkmcnt(2)
  v_mfma_f32_32x32x16_bf16 v[0:15], a[24:27], v[40:43], v[0:15]
  ds_read_b128 v[36:39], v204 offset:2048
  v_mfma_f32_32x32x16_bf16 v[16:31], v[40:43], a[168:171], v[16:31]
  s_waitcnt lgkmcnt(2)
  v_mfma_f32_32x32x16_bf16 v[0:15], a[28:31], v[44:47], v[0:15]
  ds_read_b128 v[40:43], v205 offset:2048
  v_mfma_f32_32x32x16_bf16 v[16:31], v[44:47], a[172:175], v[16:31]
  s_waitcnt lgkmcnt(2)
  v_mfma_f32_32x32x16_bf16 v[0:15], a[32:35], v[32:35], v[0:15]
  ds_read_b128 v[44:47], v206 offset:2048
  v_mfma_f32_32x32x16_bf16 v[16:31], v[32:35], a[176:179], v[16:31]
  s_waitcnt lgkmcnt(2)
  v_mfma_f32_32x32x16_bf16 v[0:15], a[36:39], v[36:39], v[0:15]
  ds_read_b128 v[32:35], v203 offset:3072
  v_mfma_f32_32x32x16_bf16 v[16:31], v[36:39], a[180:183], v[16:31]
  s_waitcnt lgkmcnt(2)
  v_mfma_f32_32x32x16_bf16 v[0:15], a[40:43], v[40:43], v[0:15]
  ds_read_b128 v[36:39], v204 offset:3072
  v_mfma_f32_32x32x16_bf16 v[16:31], v[40:43], a[184:187], v[16:31]
  s_waitcnt lgkmcnt(2)
  v_mfma_f32_32x32x16_bf16 v[0:15], a[44:47], v[44:47], v[0:15]
  ds_read_b128 v[40:43], v205 offset:3072
  v_mfma_f32_32x32x16_bf16 v[16:31], v[44:47], a[188:191], v[16:31]
  s_waitcnt lgkmcnt(2)
  v_mfma_f32_32x32x16_bf16 v[0:15], a[48:51], v[32:35], v[0:15]
  ds_read_b128 v[44:47], v206 offset:3072
  v_mfma_f32_32x32x16_bf16 v[16:31], v[32:35], a[192:195], v[16:31]
  s_waitcnt lgkmcnt(2)
  v_mfma_f32_32x32x16_bf16 v[0:15], a[52:55], v[36:39], v[0:15]
  ds_read_b128 v[32:35], v203 offset:4096
  v_mfma_f32_32x32x16_bf16 v[16:31], v[36:39], a[196:199], v[16:31]
  s_waitcnt lgkmcnt(2)
  v_mfma_f32_32x32x16_bf16 v[0:15], a[56:59], v[40:43], v[0:15]
  ds_read_b128 v[36:39], v204 offset:4096
  v_mfma_f32_32x32x16_bf16 v[16:31], v[40:43], a[200:203], v[16:31]
  s_waitcnt lgkmcnt(2)
  v_mfma_f32_32x32x16_bf16 v[0:15], a[60:63], v[44:47], v[0:15]
  ds_read_b128 v[40:43], v205 offset:4096
  v_mfma_f32_32x32x16_bf16 v[16:31], v[44:47], a[204:207], v[16:31]
  s_waitcnt lgkmcnt(2)
  v_mfma_f32_32x32x16_bf16 v[0:15], a[64:67], v[32:35], v[0:15]
  ds_read_b128 v[44:47], v206 offset:4096
  v_mfma_f32_32x32x16_bf16 v[16:31], v[32:35], a[208:211], v[16:31]
  s_waitcnt lgkmcnt(2)
  v_mfma_f32_32x32x16_bf16 v[0:15], a[68:71], v[36:39], v[0:15]
  ds_read_b128 v[32:35], v203 offset:5120
  v_mfma_f32_32x32x16_bf16 v[16:31], v[36:39], a[212:215], v[16:31]
  s_waitcnt lgkmcnt(2)
  v_mfma_f32_32x32x16_bf16 v[0:15], a[72:75], v[40:43], v[0:15]
  ds_read_b128 v[36:39], v204 offset:5120
  v_mfma_f32_32x32x16_bf16 v[16:31], v[40:43], a[216:219], v[16:31]
  s_waitcnt lgkmcnt(2)
  v_mfma_f32_32x32x16_bf16 v[0:15], a[76:79], v[44:47], v[0:15]
  ds_read_b128 v[40:43], v205 offset:5120
  v_mfma_f32_32x32x16_bf16 v[16:31], v[44:47], a[220:223], v[16:31]
  s_waitcnt lgkmcnt(2)
  v_mfma_f32_32x32x16_bf16 v[0:15], a[80:83], v[32:35], v[0:15]
  ds_read_b128 v[44:47], v206 offset:5120
  v_mfma_f32_32x32x16_bf16 v[16:31], v[32:35], a[224:227], v[16:31]
  s_waitcnt lgkmcnt(2)
  v_mfma_f32_32x32x16_bf16 v[0:15], a[84:87], v[36:39], v[0:15]
  ds_read_b128 v[32:35], v203 offset:6144
  v_mfma_f32_32x32x16_bf16 v[16:31], v[36:39], a[228:231], v[16:31]
  s_waitcnt lgkmcnt(2)
  v_mfma_f32_32x32x16_bf16 v[0:15], a[88:91], v[40:43], v[0:15]
  ds_read_b128 v[36:39], v204 offset:6144
  v_mfma_f32_32x32x16_bf16 v[16:31], v[40:43], a[232:235], v[16:31]
  s_waitcnt lgkmcnt(2)
  v_mfma_f32_32x32x16_bf16 v[0:15], a[92:95], v[44:47], v[0:15]
  ds_read_b128 v[40:43], v205 offset:6144
  v_mfma_f32_32x32x16_bf16 v[16:31], v[44:47], a[236:239], v[16:31]
  s_waitcnt lgkmcnt(2)
  v_mfma_f32_32x32x16_bf16 v[0:15], a[96:99], v[32:35], v[0:15]
  ds_read_b128 v[44:47], v206 offset:6144
  v_mfma_f32_32x32x16_bf16 v[16:31], v[32:35], a[240:243], v[16:31]
  s_waitcnt lgkmcnt(2)
  v_mfma_f32_32x32x16_bf16 v[0:15], a[100:103], v[36:39], v[0:15]
  ds_read_b128 v[32:35], v203 offset:7168
  v_mfma_f32_32x32x16_bf16 v[16:31], v[36:39], a[244:247], v[16:31]
  s_waitcnt lgkmcnt(2)
  v_mfma_f32_32x32x16_bf16 v[0:15], a[104:107], v[40:43], v[0:15]
  ds_read_b128 v[36:39], v204 offset:7168
  v_mfma_f32_32x32x16_bf16 v[16:31], v[40:43], a[248:251], v[16:31]
  s_waitcnt lgkmcnt(2)
  v_mfma_f32_32x32x16_bf16 v[0:15], a[108:111], v[44:47], v[0:15]
  ds_read_b128 v[40:43], v205 offset:7168
  v_mfma_f32_32x32x16_bf16 v[16:31], v[44:47], a[252:255], v[16:31]
  s_waitcnt lgkmcnt(2)
  v_mfma_f32_32x32x16_bf16 v[0:15], a[112:115], v[32:35], v[0:15]
  ds_read_b128 v[44:47], v206 offset:7168
  v_mfma_f32_32x32x16_bf16 v[16:31], v[32:35], v[224:227], v[16:31]
  s_waitcnt lgkmcnt(2)
  v_mfma_f32_32x32x16_bf16 v[0:15], a[116:119], v[36:39], v[0:15]
  ds_read_b128 v[32:35], v203 offset:8192
  v_mfma_f32_32x32x16_bf16 v[16:31], v[36:39], v[228:231], v[16:31]
  s_waitcnt lgkmcnt(2)
  v_mfma_f32_32x32x16_bf16 v[0:15], a[120:123], v[40:43], v[0:15]
  ds_read_b128 v[36:39], v204 offset:8192
  v_mfma_f32_32x32x16_bf16 v[16:31], v[40:43], v[232:235], v[16:31]
  s_waitcnt lgkmcnt(2)
  v_mfma_f32_32x32x16_bf16 v[0:15], a[124:127], v[44:47], v[0:15]
  ds_read_b128 v[40:43], v205 offset:8192
  v_mfma_f32_32x32x16_bf16 v[16:31], v[44:47], v[236:239], v[16:31]
  s_waitcnt lgkmcnt(2)
  v_mfma_f32_32x32x16_bf16 v[0:15], a[128:131], v[32:35], v[0:15]
  ds_read_b128 v[44:47], v206 offset:8192
  v_mfma_f32_32x32x16_bf16 v[16:31], v[32:35], v[240:243], v[16:31]
  s_waitcnt lgkmcnt(2)
  v_mfma_f32_32x32x16_bf16 v[0:15], a[132:135], v[36:39], v[0:15]
  v_mfma_f32_32x32x16_bf16 v[16:31], v[36:39], v[244:247], v[16:31]
  s_waitcnt lgkmcnt(1)
  v_mfma_f32_32x32x16_bf16 v[0:15], a[136:139], v[40:43], v[0:15]
  v_mfma_f32_32x32x16_bf16 v[16:31], v[40:43], v[248:251], v[16:31]
  s_waitcnt lgkmcnt(0)
  v_mfma_f32_32x32x16_bf16 v[0:15], a[140:143], v[44:47], v[0:15]
  v_mfma_f32_32x32x16_bf16 v[16:31], v[44:47], v[252:255], v[16:31]
  s_lshl_b32 s64, s59, 5
  s_add_u32 s64, s64, s58
  s_lshl_b32 s64, s64, 14
  s_add_u32 s55, s64, s69
  v_mul_f32 v0, s68, v0
  v_mul_f32 v1, s68, v1
  v_mul_f32 v2, s68, v2
  v_mul_f32 v3, s68, v3
  v_mul_f32 v4, s68, v4
  v_mul_f32 v5, s68, v5
  v_mul_f32 v6, s68, v6
  v_mul_f32 v7, s68, v7
  v_mul_f32 v8, s68, v8
  v_mul_f32 v9, s68, v9
  v_mul_f32 v10, s68, v10
  v_mul_f32 v11, s68, v11
  v_mul_f32 v12, s68, v12
  v_mul_f32 v13, s68, v13
  v_mul_f32 v14, s68, v14
  v_mul_f32 v15, s68, v15
  v_cvt_pk_bf16_f32 v48, v0, v4
  v_cvt_pk_bf16_f32 v49, v1, v5
  v_cvt_pk_bf16_f32 v50, v2, v6
  v_cvt_pk_bf16_f32 v51, v3, v7
  buffer_store_dwordx4 v[48:51], v216, s[8:11], s55 offen offset:0 sc1
  v_cvt_pk_bf16_f32 v52, v8, v12
  v_cvt_pk_bf16_f32 v53, v9, v13
  v_cvt_pk_bf16_f32 v54, v10, v14
  v_cvt_pk_bf16_f32 v55, v11, v15
  buffer_store_dwordx4 v[52:55], v216, s[8:11], s55 offen offset:256 sc1
  v_cvt_pk_bf16_f32 v56, v16, v17
  v_cvt_pk_bf16_f32 v57, v20, v21
  v_cvt_pk_bf16_f32 v58, v24, v25
  v_cvt_pk_bf16_f32 v59, v28, v29
  buffer_store_dwordx4 v[56:59], v217, s[8:11], s64 offen offset:0 sc1
  v_cvt_pk_bf16_f32 v60, v18, v19
  v_cvt_pk_bf16_f32 v61, v22, v23
  v_cvt_pk_bf16_f32 v62, v26, v27
  v_cvt_pk_bf16_f32 v63, v30, v31
  buffer_store_dwordx4 v[60:63], v217, s[8:11], s64 offen offset:256 sc1
  s_add_u32 s59, s59, 7
  s_cmp_ge_u32 s59, 64
  s_cbranch_scc1 KV_done
  s_waitcnt vmcnt(4)
  s_barrier
  s_add_u32 s60, s60, 258048
  s_add_u32 m0, s67, 0
  s_nop 0
  buffer_load_dwordx4 v202, s[4:7], s60 offen offset:0 lds
  s_add_u32 m0, s67, 896
  s_nop 0
  buffer_load_dwordx4 v202, s[4:7], s60 offen offset:128 lds
  s_add_u32 m0, s67, 1792
  s_nop 0
  buffer_load_dwordx4 v202, s[4:7], s60 offen offset:256 lds
  s_add_u32 m0, s67, 2688
  s_nop 0
  buffer_load_dwordx4 v202, s[4:7], s60 offen offset:384 lds
  s_add_u32 m0, s67, 3584
  s_nop 0
  buffer_load_dwordx4 v202, s[4:7], s60 offen offset:512 lds
  s_add_u32 m0, s67, 4480
  s_nop 0
  buffer_load_dwordx4 v202, s[4:7], s60 offen offset:640 lds
  s_add_u32 m0, s67, 5376
  s_nop 0
  buffer_load_dwordx4 v202, s[4:7], s60 offen offset:768 lds
  s_add_u32 m0, s67, 6272
  s_nop 0
  buffer_load_dwordx4 v202, s[4:7], s60 offen offset:896 lds
  s_add_u32 m0, s67, 7168
  s_nop 0
  buffer_load_dwordx4 v202, s[4:7], s60 offen offset:1024 lds
  ds_read_b128 v[32:35], v203 offset:36864
  ds_read_b128 v[36:39], v204 offset:36864
  ds_read_b128 v[40:43], v205 offset:36864
  s_waitcnt lgkmcnt(2)
  v_mfma_f32_32x32x16_bf16 v[0:15], a[0:3], v[32:35], 0
  ds_read_b128 v[44:47], v206 offset:36864
  v_mfma_f32_32x32x16_bf16 v[16:31], v[32:35], a[144:147], 0
  s_waitcnt lgkmcnt(2)
  v_mfma_f32_32x32x16_bf16 v[0:15], a[4:7], v[36:39], v[0:15]
  ds_read_b128 v[32:35], v203 offset:37888
  v_mfma_f32_32x32x16_bf16 v[16:31], v[36:39], a[148:151], v[16:31]
  s_waitcnt lgkmcnt(2)
  v_mfma_f32_32x32x16_bf16 v[0:15], a[8:11], v[40:43], v[0:15]
  ds_read_b128 v[36:39], v204 offset:37888
  v_mfma_f32_32x32x16_bf16 v[16:31], v[40:43], a[152:155], v[16:31]
  s_waitcnt lgkmcnt(2)
  v_mfma_f32_32x32x16_bf16 v[0:15], a[12:15], v[44:47], v[0:15]
  ds_read_b128 v[40:43], v205 offset:37888
  v_mfma_f32_32x32x16_bf16 v[16:31], v[44:47], a[156:159], v[16:31]
  s_waitcnt lgkmcnt(2)
  v_mfma_f32_32x32x16_bf16 v[0:15], a[16:19], v[32:35], v[0:15]
  ds_read_b128 v[44:47], v206 offset:37888
  v_mfma_f32_32x32x16_bf16 v[16:31], v[32:35], a[160:163], v[16:31]
  s_waitcnt lgkmcnt(2)
  v_mfma_f32_32x32x16_bf16 v[0:15], a[20:23], v[36:39], v[0:15]
  ds_read_b128 v[32:35], v203 offset:38912
  v_mfma_f32_32x32x16_bf16 v[16:31], v[36:39], a[164:167], v[16:31]
  s_waitcnt lgkmcnt(2)
  v_mfma_f32_32x32x16_bf16 v[0:15], a[24:27], v[40:43], v[0:15]
  ds_read_b128 v[36:39], v204 offset:38912
  v_mfma_f32_32x32x16_bf16 v[16:31], v[40:43], a[168:171], v[16:31]
  s_waitcnt lgkmcnt(2)
  v_mfma_f32_32x32x16_bf16 v[0:15], a[28:31], v[44:47], v[0:15]
  ds_read_b128 v[40:43], v205 offset:38912
  v_mfma_f32_32x32x16_bf16 v[16:31], v[44:47], a[172:175], v[16:31]
  s_waitcnt lgkmcnt(2)
  v_mfma_f32_32x32x16_bf16 v[0:15], a[32:35], v[32:35], v[0:15]
  ds_read_b128 v[44:47], v206 offset:38912
  v_mfma_f32_32x32x16_bf16 v[16:31], v[32:35], a[176:179], v[16:31]
  s_waitcnt lgkmcnt(2)
  v_mfma_f32_32x32x16_bf16 v[0:15], a[36:39], v[36:39], v[0:15]
  ds_read_b128 v[32:35], v203 offset:39936
  v_mfma_f32_32x32x16_bf16 v[16:31], v[36:39], a[180:183], v[16:31]
  s_waitcnt lgkmcnt(2)
  v_mfma_f32_32x32x16_bf16 v[0:15], a[40:43], v[40:43], v[0:15]
  ds_read_b128 v[36:39], v204 offset:39936
  v_mfma_f32_32x32x16_bf16 v[16:31], v[40:43], a[184:187], v[16:31]
  s_waitcnt lgkmcnt(2)
  v_mfma_f32_32x32x16_bf16 v[0:15], a[44:47], v[44:47], v[0:15]
  ds_read_b128 v[40:43], v205 offset:39936
  v_mfma_f32_32x32x16_bf16 v[16:31], v[44:47], a[188:191], v[16:31]
  s_waitcnt lgkmcnt(2)
  v_mfma_f32_32x32x16_bf16 v[0:15], a[48:51], v[32:35], v[0:15]
  ds_read_b128 v[44:47], v206 offset:39936
  v_mfma_f32_32x32x16_bf16 v[16:31], v[32:35], a[192:195], v[16:31]
  s_waitcnt lgkmcnt(2)
  v_mfma_f32_32x32x16_bf16 v[0:15], a[52:55], v[36:39], v[0:15]
  ds_read_b128 v[32:35], v203 offset:40960
  v_mfma_f32_32x32x16_bf16 v[16:31], v[36:39], a[196:199], v[16:31]
  s_waitcnt lgkmcnt(2)
  v_mfma_f32_32x32x16_bf16 v[0:15], a[56:59], v[40:43], v[0:15]
  ds_read_b128 v[36:39], v204 offset:40960
  v_mfma_f32_32x32x16_bf16 v[16:31], v[40:43], a[200:203], v[16:31]
  s_waitcnt lgkmcnt(2)
  v_mfma_f32_32x32x16_bf16 v[0:15], a[60:63], v[44:47], v[0:15]
  ds_read_b128 v[40:43], v205 offset:40960
  v_mfma_f32_32x32x16_bf16 v[16:31], v[44:47], a[204:207], v[16:31]
  s_waitcnt lgkmcnt(2)
  v_mfma_f32_32x32x16_bf16 v[0:15], a[64:67], v[32:35], v[0:15]
  ds_read_b128 v[44:47], v206 offset:40960
  v_mfma_f32_32x32x16_bf16 v[16:31], v[32:35], a[208:211], v[16:31]
  s_waitcnt lgkmcnt(2)
  v_mfma_f32_32x32x16_bf16 v[0:15], a[68:71], v[36:39], v[0:15]
  ds_read_b128 v[32:35], v203 offset:41984
  v_mfma_f32_32x32x16_bf16 v[16:31], v[36:39], a[212:215], v[16:31]
  s_waitcnt lgkmcnt(2)
  v_mfma_f32_32x32x16_bf16 v[0:15], a[72:75], v[40:43], v[0:15]
  ds_read_b128 v[36:39], v204 offset:41984
  v_mfma_f32_32x32x16_bf16 v[16:31], v[40:43], a[216:219], v[16:31]
  s_waitcnt lgkmcnt(2)
  v_mfma_f32_32x32x16_bf16 v[0:15], a[76:79], v[44:47], v[0:15]
  ds_read_b128 v[40:43], v205 offset:41984
  v_mfma_f32_32x32x16_bf16 v[16:31], v[44:47], a[220:223], v[16:31]
  s_waitcnt lgkmcnt(2)
  v_mfma_f32_32x32x16_bf16 v[0:15], a[80:83], v[32:35], v[0:15]
  ds_read_b128 v[44:47], v206 offset:41984
  v_mfma_f32_32x32x16_bf16 v[16:31], v[32:35], a[224:227], v[16:31]
  s_waitcnt lgkmcnt(2)
  v_mfma_f32_32x32x16_bf16 v[0:15], a[84:87], v[36:39], v[0:15]
  ds_read_b128 v[32:35], v203 offset:43008
  v_mfma_f32_32x32x16_bf16 v[16:31], v[36:39], a[228:231], v[16:31]
  s_waitcnt lgkmcnt(2)
  v_mfma_f32_32x32x16_bf16 v[0:15], a[88:91], v[40:43], v[0:15]
  ds_read_b128 v[36:39], v204 offset:43008
  v_mfma_f32_32x32x16_bf16 v[16:31], v[40:43], a[232:235], v[16:31]
  s_waitcnt lgkmcnt(2)
  v_mfma_f32_32x32x16_bf16 v[0:15], a[92:95], v[44:47], v[0:15]
  ds_read_b128 v[40:43], v205 offset:43008
  v_mfma_f32_32x32x16_bf16 v[16:31], v[44:47], a[236:239], v[16:31]
  s_waitcnt lgkmcnt(2)
  v_mfma_f32_32x32x16_bf16 v[0:15], a[96:99], v[32:35], v[0:15]
  ds_read_b128 v[44:47], v206 offset:43008
  v_mfma_f32_32x32x16_bf16 v[16:31], v[32:35], a[240:243], v[16:31]
  s_waitcnt lgkmcnt(2)
  v_mfma_f32_32x32x16_bf16 v[0:15], a[100:103], v[36:39], v[0:15]
  ds_read_b128 v[32:35], v203 offset:44032
  v_mfma_f32_32x32x16_bf16 v[16:31], v[36:39], a[244:247], v[16:31]
  s_waitcnt lgkmcnt(2)
  v_mfma_f32_32x32x16_bf16 v[0:15], a[104:107], v[40:43], v[0:15]
  ds_read_b128 v[36:39], v204 offset:44032
  v_mfma_f32_32x32x16_bf16 v[16:31], v[40:43], a[248:251], v[16:31]
  s_waitcnt lgkmcnt(2)
  v_mfma_f32_32x32x16_bf16 v[0:15], a[108:111], v[44:47], v[0:15]
  ds_read_b128 v[40:43], v205 offset:44032
  v_mfma_f32_32x32x16_bf16 v[16:31], v[44:47], a[252:255], v[16:31]
  s_waitcnt lgkmcnt(2)
  v_mfma_f32_32x32x16_bf16 v[0:15], a[112:115], v[32:35], v[0:15]
  ds_read_b128 v[44:47], v206 offset:44032
  v_mfma_f32_32x32x16_bf16 v[16:31], v[32:35], v[224:227], v[16:31]
  s_waitcnt lgkmcnt(2)
  v_mfma_f32_32x32x16_bf16 v[0:15], a[116:119], v[36:39], v[0:15]
  ds_read_b128 v[32:35], v203 offset:45056
  v_mfma_f32_32x32x16_bf16 v[16:31], v[36:39], v[228:231], v[16:31]
  s_waitcnt lgkmcnt(2)
  v_mfma_f32_32x32x16_bf16 v[0:15], a[120:123], v[40:43], v[0:15]
  ds_read_b128 v[36:39], v204 offset:45056
  v_mfma_f32_32x32x16_bf16 v[16:31], v[40:43], v[232:235], v[16:31]
  s_waitcnt lgkmcnt(2)
  v_mfma_f32_32x32x16_bf16 v[0:15], a[124:127], v[44:47], v[0:15]
  ds_read_b128 v[40:43], v205 offset:45056
  v_mfma_f32_32x32x16_bf16 v[16:31], v[44:47], v[236:239], v[16:31]
  s_waitcnt lgkmcnt(2)
  v_mfma_f32_32x32x16_bf16 v[0:15], a[128:131], v[32:35], v[0:15]
  ds_read_b128 v[44:47], v206 offset:45056
  v_mfma_f32_32x32x16_bf16 v[16:31], v[32:35], v[240:243], v[16:31]
  s_waitcnt lgkmcnt(2)
  v_mfma_f32_32x32x16_bf16 v[0:15], a[132:135], v[36:39], v[0:15]
  v_mfma_f32_32x32x16_bf16 v[16:31], v[36:39], v[244:247], v[16:31]
  s_waitcnt lgkmcnt(1)
  v_mfma_f32_32x32x16_bf16 v[0:15], a[136:139], v[40:43], v[0:15]
  v_mfma_f32_32x32x16_bf16 v[16:31], v[40:43], v[248:251], v[16:31]
  s_waitcnt lgkmcnt(0)
  v_mfma_f32_32x32x16_bf16 v[0:15], a[140:143], v[44:47], v[0:15]
  v_mfma_f32_32x32x16_bf16 v[16:31], v[44:47], v[252:255], v[16:31]
  s_lshl_b32 s64, s59, 5
  s_add_u32 s64, s64, s58
  s_lshl_b32 s64, s64, 14
  s_add_u32 s55, s64, s69
  v_mul_f32 v0, s68, v0
  v_mul_f32 v1, s68, v1
  v_mul_f32 v2, s68, v2
  v_mul_f32 v3, s68, v3
  v_mul_f32 v4, s68, v4
  v_mul_f32 v5, s68, v5
  v_mul_f32 v6, s68, v6
  v_mul_f32 v7, s68, v7
  v_mul_f32 v8, s68, v8
  v_mul_f32 v9, s68, v9
  v_mul_f32 v10, s68, v10
  v_mul_f32 v11, s68, v11
  v_mul_f32 v12, s68, v12
  v_mul_f32 v13, s68, v13
  v_mul_f32 v14, s68, v14
  v_mul_f32 v15, s68, v15
  v_cvt_pk_bf16_f32 v48, v0, v4
  v_cvt_pk_bf16_f32 v49, v1, v5
  v_cvt_pk_bf16_f32 v50, v2, v6
  v_cvt_pk_bf16_f32 v51, v3, v7
  buffer_store_dwordx4 v[48:51], v216, s[8:11], s55 offen offset:0 sc1
  v_cvt_pk_bf16_f32 v52, v8, v12
  v_cvt_pk_bf16_f32 v53, v9, v13
  v_cvt_pk_bf16_f32 v54, v10, v14
  v_cvt_pk_bf16_f32 v55, v11, v15
  buffer_store_dwordx4 v[52:55], v216, s[8:11], s55 offen offset:256 sc1
  v_cvt_pk_bf16_f32 v56, v16, v17
  v_cvt_pk_bf16_f32 v57, v20, v21
  v_cvt_pk_bf16_f32 v58, v24, v25
  v_cvt_pk_bf16_f32 v59, v28, v29
  buffer_store_dwordx4 v[56:59], v217, s[8:11], s64 offen offset:0 sc1
  v_cvt_pk_bf16_f32 v60, v18, v19
  v_cvt_pk_bf16_f32 v61, v22, v23
  v_cvt_pk_bf16_f32 v62, v26, v27
  v_cvt_pk_bf16_f32 v63, v30, v31
  buffer_store_dwordx4 v[60:63], v217, s[8:11], s64 offen offset:256 sc1
  s_add_u32 s59, s59, 7
  s_cmp_ge_u32 s59, 64
  s_cbranch_scc1 KV_done
  s_waitcnt vmcnt(4)
  s_barrier
  s_branch KV_loop
KV_done:
  s_lshl_b32 s56, s58, 2
  s_add_u32 s56, s56, 128
  s_waitcnt vmcnt(0)
  s_barrier
  s_cmp_eq_u32 s52, 0
  s_cbranch_scc0 KV_sig
  v_mov_b32 v211, 1
  v_mov_b32 v212, 0
  s_mov_b64 exec, 1
  buffer_atomic_add v211, v212, s[12:15], s56 offen
  s_mov_b64 exec, -1
KV_sig:
  s_cmp_lt_u32 s53, 96
  s_cbranch_scc0 W_a
  s_mul_i32 s58, s53, 21846
  s_lshr_b32 s58, s58, 16
  s_mul_i32 s54, s58, 3
  s_sub_u32 s59, s53, s54
  s_mul_i32 s60, s59, 36864
  s_add_u32 m0, s67, 0
  s_nop 0
  buffer_load_dwordx4 v202, s[4:7], s60 offen offset:0 lds
  s_add_u32 m0, s67, 896
  s_nop 0
  buffer_load_dwordx4 v202, s[4:7], s60 offen offset:128 lds
  s_add_u32 m0, s67, 1792
  s_nop 0
  buffer_load_dwordx4 v202, s[4:7], s60 offen offset:256 lds
  s_add_u32 m0, s67, 2688
  s_nop 0
  buffer_load_dwordx4 v202, s[4:7], s60 offen offset:384 lds
  s_add_u32 m0, s67, 3584
  s_nop 0
  buffer_load_dwordx4 v202, s[4:7], s60 offen offset:512 lds
  s_add_u32 m0, s67, 4480
  s_nop 0
  buffer_load_dwordx4 v202, s[4:7], s60 offen offset:640 lds
  s_add_u32 m0, s67, 5376
  s_nop 0
  buffer_load_dwordx4 v202, s[4:7], s60 offen offset:768 lds
  s_add_u32 m0, s67, 6272
  s_nop 0
  buffer_load_dwordx4 v202, s[4:7], s60 offen offset:896 lds
  s_add_u32 m0, s67, 7168
  s_nop 0
  buffer_load_dwordx4 v202, s[4:7], s60 offen offset:1024 lds
  v_lshrrev_b32 v211, 4, v200
  v_lshlrev_b32 v212, 2, v211
  v_and_b32 v213, 15, v200
  v_xor_b32 v212, v212, v213
  v_lshlrev_b32 v212, 4, v212
  v_lshl_add_u32 v207, v211, 13, v212
  s_lshl_b32 s62, s58, 8
  s_lshl_b32 s54, s52, 15
  s_add_u32 s62, s62, s54
  s_lshl_b32 s61, s52, 10
  s_add_u32 s61, s61, 36864
  s_add_u32 m0, s61, 0
  s_add_u32 s54, s62, 0
  buffer_load_dwordx4 v207, s[16:19], s54 offen lds
  s_add_u32 m0, s61, 4096
  s_add_u32 s54, s62, 131072
  buffer_load_dwordx4 v207, s[16:19], s54 offen lds
  s_add_u32 m0, s61, 8192
  s_add_u32 s54, s62, 262144
  buffer_load_dwordx4 v207, s[16:19], s54 offen lds
  s_add_u32 m0, s61, 12288
  s_add_u32 s54, s62, 393216
  buffer_load_dwordx4 v207, s[16:19], s54 offen lds
  s_add_u32 m0, s61, 16384
  s_add_u32 s54, s62, 524288
  buffer_load_dwordx4 v207, s[16:19], s54 offen lds
  s_add_u32 m0, s61, 20480
  s_add_u32 s54, s62, 655360
  buffer_load_dwordx4 v207, s[16:19], s54 offen lds
  s_add_u32 m0, s61, 24576
  s_add_u32 s54, s62, 786432
  buffer_load_dwordx4 v207, s[16:19], s54 offen lds
  s_add_u32 m0, s61, 28672
  s_add_u32 s54, s62, 917504
  buffer_load_dwordx4 v207, s[16:19], s54 offen lds
  s_add_u32 m0, s61, 32768
  s_add_u32 s54, s62, 1048576
  buffer_load_dwordx4 v207, s[16:19], s54 offen lds
  s_add_u32 m0, s61, 36864
  s_add_u32 s54, s62, 1179648
  buffer_load_dwordx4 v207, s[16:19], s54 offen lds
  s_add_u32 m0, s61, 40960
  s_add_u32 s54, s62, 1310720
  buffer_load_dwordx4 v207, s[16:19], s54 offen lds
  s_add_u32 m0, s61, 45056
  s_add_u32 s54, s62, 1441792
  buffer_load_dwordx4 v207, s[16:19], s54 offen lds
  s_add_u32 m0, s61, 49152
  s_add_u32 s54, s62, 1572864
  buffer_load_dwordx4 v207, s[16:19], s54 offen lds
  s_add_u32 m0, s61, 53248
  s_add_u32 s54, s62, 1703936
  buffer_load_dwordx4 v207, s[16:19], s54 offen lds
  s_add_u32 m0, s61, 57344
  s_add_u32 s54, s62, 1835008
  buffer_load_dwordx4 v207, s[16:19], s54 offen lds
  s_add_u32 m0, s61, 61440
  s_add_u32 s54, s62, 1966080
  buffer_load_dwordx4 v207, s[16:19], s54 offen lds
  s_add_u32 m0, s61, 65536
  s_add_u32 s54, s62, 2097152
  buffer_load_dwordx4 v207, s[16:19], s54 offen lds
  s_add_u32 m0, s61, 69632
  s_add_u32 s54, s62, 2228224
  buffer_load_dwordx4 v207, s[16:19], s54 offen lds
  s_add_u32 m0, s61, 73728
  s_add_u32 s54, s62, 2359296
  buffer_load_dwordx4 v207, s[16:19], s54 offen lds
  s_add_u32 m0, s61, 77824
  s_add_u32 s54, s62, 2490368
  buffer_load_dwordx4 v207, s[16:19], s54 offen lds
  s_add_u32 m0, s61, 81920
  s_add_u32 s54, s62, 2621440
  buffer_load_dwordx4 v207, s[16:19], s54 offen lds
  s_add_u32 m0, s61, 86016
  s_add_u32 s54, s62, 2752512
  buffer_load_dwordx4 v207, s[16:19], s54 offen lds
  s_add_u32 m0, s61, 90112
  s_add_u32 s54, s62, 2883584
  buffer_load_dwordx4 v207, s[16:19], s54 offen lds
  s_add_u32 m0, s61, 94208
  s_add_u32 s54, s62, 3014656
  buffer_load_dwordx4 v207, s[16:19], s54 offen lds
  s_waitcnt vmcnt(20) lgkmcnt(0)
  s_barrier
  s_add_u32 m0, s61, 98304
  s_add_u32 s54, s62, 3145728
  buffer_load_dwordx4 v207, s[16:19], s54 offen lds
  s_add_u32 m0, s61, 102400
  s_add_u32 s54, s62, 3276800
  buffer_load_dwordx4 v207, s[16:19], s54 offen lds
  s_add_u32 m0, s61, 106496
  s_add_u32 s54, s62, 3407872
  buffer_load_dwordx4 v207, s[16:19], s54 offen lds
  s_add_u32 m0, s61, 110592
  s_add_u32 s54, s62, 3538944
  buffer_load_dwordx4 v207, s[16:19], s54 offen lds
  v_add_u32 v215, 36864, v209
  ds_read_b64_tr_b16 a[0:1], v215 offset:0
  ds_read_b64_tr_b16 a[2:3], v215 offset:1024
  ds_read_b64_tr_b16 a[4:5], v215 offset:4096
  ds_read_b64_tr_b16 a[6:7], v215 offset:5120
  ds_read_b64_tr_b16 a[8:9], v215 offset:8192
  ds_read_b64_tr_b16 a[10:11], v215 offset:9216
  ds_read_b64_tr_b16 a[12:13], v215 offset:12288
  ds_read_b64_tr_b16 a[14:15], v215 offset:13312
  s_waitcnt vmcnt(20) lgkmcnt(0)
  s_barrier
  s_add_u32 m0, s61, 0
  s_add_u32 s54, s62, 3670016
  buffer_load_dwordx4 v207, s[16:19], s54 offen lds
  s_add_u32 m0, s61, 4096
  s_add_u32 s54, s62, 3801088
  buffer_load_dwordx4 v207, s[16:19], s54 offen lds
  s_add_u32 m0, s61, 8192
  s_add_u32 s54, s62, 3932160
  buffer_load_dwordx4 v207, s[16:19], s54 offen lds
  s_add_u32 m0, s61, 12288
  s_add_u32 s54, s62, 4063232
  buffer_load_dwordx4 v207, s[16:19], s54 offen lds
  v_add_u32 v215, 53248, v209
  ds_read_b64_tr_b16 a[16:17], v215 offset:0
  ds_read_b64_tr_b16 a[18:19], v215 offset:1024
  ds_read_b64_tr_b16 a[20:21], v215 offset:4096
  ds_read_b64_tr_b16 a[22:23], v215 offset:5120
  ds_read_b64_tr_b16 a[24:25], v215 offset:8192
  ds_read_b64_tr_b16 a[26:27], v215 offset:9216
  ds_read_b64_tr_b16 a[28:29], v215 offset:12288
  ds_read_b64_tr_b16 a[30:31], v215 offset:13312
  s_waitcnt vmcnt(20) lgkmcnt(0)
  s_barrier
  s_add_u32 m0, s61, 16384
  s_add_u32 s54, s62, 4194304
  buffer_load_dwordx4 v207, s[16:19], s54 offen lds
  s_add_u32 m0, s61, 20480
  s_add_u32 s54, s62, 4325376
  buffer_load_dwordx4 v207, s[16:19], s54 offen lds
  s_add_u32 m0, s61, 24576
  s_add_u32 s54, s62, 4456448
  buffer_load_dwordx4 v207, s[16:19], s54 offen lds
  s_add_u32 m0, s61, 28672
  s_add_u32 s54, s62, 4587520
  buffer_load_dwordx4 v207, s[16:19], s54 offen lds
  v_add_u32 v215, 69632, v209
  ds_read_b64_tr_b16 a[32:33], v215 offset:0
  ds_read_b64_tr_b16 a[34:35], v215 offset:1024
  ds_read_b64_tr_b16 a[36:37], v215 offset:4096
  ds_read_b64_tr_b16 a[38:39], v215 offset:5120
  ds_read_b64_tr_b16 a[40:41], v215 offset:8192
  ds_read_b64_tr_b16 a[42:43], v215 offset:9216
  ds_read_b64_tr_b16 a[44:45], v215 offset:12288
  ds_read_b64_tr_b16 a[46:47], v215 offset:13312
  s_waitcnt vmcnt(20) lgkmcnt(0)
  s_barrier
  v_add_u32 v215, 86016, v209
  ds_read_b64_tr_b16 a[48:49], v215 offset:0
  ds_read_b64_tr_b16 a[50:51], v215 offset:1024
  ds_read_b64_tr_b16 a[52:53], v215 offset:4096
  ds_read_b64_tr_b16 a[54:55], v215 offset:5120
  ds_read_b64_tr_b16 a[56:57], v215 offset:8192
  ds_read_b64_tr_b16 a[58:59], v215 offset:9216
  ds_read_b64_tr_b16 a[60:61], v215 offset:12288
  ds_read_b64_tr_b16 a[62:63], v215 offset:13312
  s_waitcnt vmcnt(16) lgkmcnt(0)
  s_barrier
  v_add_u32 v215, 102400, v209
  ds_read_b64_tr_b16 a[64:65], v215 offset:0
  ds_read_b64_tr_b16 a[66:67], v215 offset:1024
  ds_read_b64_tr_b16 a[68:69], v215 offset:4096
  ds_read_b64_tr_b16 a[70:71], v215 offset:5120
  ds_read_b64_tr_b16 a[72:73], v215 offset:8192
  ds_read_b64_tr_b16 a[74:75], v215 offset:9216
  ds_read_b64_tr_b16 a[76:77], v215 offset:12288
  ds_read_b64_tr_b16 a[78:79], v215 offset:13312
  s_waitcnt vmcnt(12) lgkmcnt(0)
  s_barrier
  v_add_u32 v215, 118784, v209
  ds_read_b64_tr_b16 a[80:81], v215 offset:0
  ds_read_b64_tr_b16 a[82:83], v215 offset:1024
  ds_read_b64_tr_b16 a[84:85], v215 offset:4096
  ds_read_b64_tr_b16 a[86:87], v215 offset:5120
  ds_read_b64_tr_b16 a[88:89], v215 offset:8192
  ds_read_b64_tr_b16 a[90:91], v215 offset:9216
  ds_read_b64_tr_b16 a[92:93], v215 offset:12288
  ds_read_b64_tr_b16 a[94:95], v215 offset:13312
  s_waitcnt vmcnt(8) lgkmcnt(0)
  s_barrier
  v_add_u32 v215, 135168, v209
  ds_read_b64_tr_b16 a[96:97], v215 offset:0
  ds_read_b64_tr_b16 a[98:99], v215 offset:1024
  ds_read_b64_tr_b16 a[100:101], v215 offset:4096
  ds_read_b64_tr_b16 a[102:103], v215 offset:5120
  ds_read_b64_tr_b16 a[104:105], v215 offset:8192
  ds_read_b64_tr_b16 a[106:107], v215 offset:9216
  ds_read_b64_tr_b16 a[108:109], v215 offset:12288
  ds_read_b64_tr_b16 a[110:111], v215 offset:13312
  s_waitcnt vmcnt(4) lgkmcnt(0)
  s_barrier
  v_add_u32 v215, 36864, v209
  ds_read_b64_tr_b16 a[112:113], v215 offset:0
  ds_read_b64_tr_b16 a[114:115], v215 offset:1024
  ds_read_b64_tr_b16 a[116:117], v215 offset:4096
  ds_read_b64_tr_b16 a[118:119], v215 offset:5120
  ds_read_b64_tr_b16 a[120:121], v215 offset:8192
  ds_read_b64_tr_b16 a[122:123], v215 offset:9216
  ds_read_b64_tr_b16 a[124:125], v215 offset:12288
  ds_read_b64_tr_b16 a[126:127], v215 offset:13312
  s_waitcnt vmcnt(0) lgkmcnt(0)
  s_barrier
  v_add_u32 v215, 53248, v209
  ds_read_b64_tr_b16 a[128:129], v215 offset:0
  ds_read_b64_tr_b16 a[130:131], v215 offset:1024
  ds_read_b64_tr_b16 a[132:133], v215 offset:4096
  ds_read_b64_tr_b16 a[134:135], v215 offset:5120
  ds_read_b64_tr_b16 a[136:137], v215 offset:8192
  ds_read_b64_tr_b16 a[138:139], v215 offset:9216
  ds_read_b64_tr_b16 a[140:141], v215 offset:12288
  ds_read_b64_tr_b16 a[142:143], v215 offset:13312
  s_waitcnt lgkmcnt(0)
  s_barrier
  v_and_b32 v211, 31, v200
  v_lshrrev_b32 v212, 5, v200
  v_lshlrev_b32 v213, 2, v212
  v_sub_u32 v211, v211, v213
  v_mov_b32 v214, 0xf149f2ca
  v_cmp_gt_i32 vcc, 0, v211
  s_nop 1
  v_cndmask_b32 v48, 0, v214, vcc
  v_cmp_gt_i32 vcc, 1, v211
  s_nop 1
  v_cndmask_b32 v49, 0, v214, vcc
  v_cmp_gt_i32 vcc, 2, v211
  s_nop 1
  v_cndmask_b32 v50, 0, v214, vcc
  v_cmp_gt_i32 vcc, 3, v211
  s_nop 1
  v_cndmask_b32 v51, 0, v214, vcc
  v_cmp_gt_i32 vcc, 8, v211
  s_nop 1
  v_cndmask_b32 v52, 0, v214, vcc
  v_cmp_gt_i32 vcc, 9, v211
  s_nop 1
  v_cndmask_b32 v53, 0, v214, vcc
  v_cmp_gt_i32 vcc, 10, v211
  s_nop 1
  v_cndmask_b32 v54, 0, v214, vcc
  v_cmp_gt_i32 vcc, 11, v211
  s_nop 1
  v_cndmask_b32 v55, 0, v214, vcc
  v_cmp_gt_i32 vcc, 16, v211
  s_nop 1
  v_cndmask_b32 v56, 0, v214, vcc
  v_cmp_gt_i32 vcc, 17, v211
  s_nop 1
  v_cndmask_b32 v57, 0, v214, vcc
  v_cmp_gt_i32 vcc, 18, v211
  s_nop 1
  v_cndmask_b32 v58, 0, v214, vcc
  v_cmp_gt_i32 vcc, 19, v211
  s_nop 1
  v_cndmask_b32 v59, 0, v214, vcc
  v_cmp_gt_i32 vcc, 24, v211
  s_nop 1
  v_cndmask_b32 v60, 0, v214, vcc
  v_cmp_gt_i32 vcc, 25, v211
  s_nop 1
  v_cndmask_b32 v61, 0, v214, vcc
  v_cmp_gt_i32 vcc, 26, v211
  s_nop 1
  v_cndmask_b32 v62, 0, v214, vcc
  v_cmp_gt_i32 vcc, 27, v211
  s_nop 1
  v_cndmask_b32 v63, 0, v214, vcc
  v_and_b32 v218, 0xff, v216
  v_and_b32 v211, 15, v200
  v_lshl_add_u32 v211, v212, 5, v211
  v_lshlrev_b32 v219, 4, v211
  v_bfe_u32 v211, v200, 4, 1
  v_lshl_add_u32 v219, v211, 2, v219
  s_lshl_b32 s54, s52, 10
  s_add_u32 s54, s54, 8
  v_add_u32 v219, s54, v219
  s_lshl_b32 s54, s52, 11
  s_add_u32 s54, s54, 73728
  v_add_u32 v215, s54, v201
  v_add_u32 v208, 73728, v201
  s_mov_b32 s68, 1040356334
  s_lshl_b32 s69, s58, 7
  s_add_u32 s69, s69, 105906176
  s_lshl_b32 s56, s58, 2
  s_add_u32 s56, s56, 128
  s_mov_b32 s57, 32
  s_cmp_eq_u32 s52, 0
  s_cbranch_scc0 AT_p1_d
  s_mov_b32 exec_hi, 0
  s_mov_b32 exec_lo, 1
AT_p1:
  buffer_load_dword v211, v201, s[12:15], s56 offen sc1
  s_add_u32 s65, s65, 1
  s_waitcnt vmcnt(0)
  v_cmp_gt_u32 vcc, 7, v211
  s_cbranch_vccz AT_p1_x
  s_sleep 8
  s_cmp_lt_u32 s65, 131072
  s_cbranch_scc1 AT_p1
AT_p1_x:
  s_mov_b64 exec, -1
AT_p1_d:
  s_barrier
  s_cmp_eq_u32 s52, 0
  s_cbranch_scc0 AT_arm_d
  s_mov_b32 exec_hi, 0
  s_mov_b32 exec_lo, 1
AT_arm:
  buffer_load_dword v211, v201, s[12:15], s57 offen sc1
  s_add_u32 s65, s65, 1
  s_waitcnt vmcnt(0)
  v_cmp_gt_u32 vcc, 32, v211
  s_cbranch_vccz AT_arm_x
  s_sleep 8
  s_cmp_lt_u32 s65, 131072
  s_cbranch_scc1 AT_arm
AT_arm_x:
  s_mov_b64 exec, -1
AT_arm_d:
  s_barrier
AT_loop:
  s_lshl_b32 s64, s59, 5
  s_add_u32 s64, s64, s58
  s_lshl_b32 s55, s64, 14
  buffer_load_dwordx4 v[128:131], v216, s[8:11], s55 offen offset:0 sc1
  buffer_load_dwordx4 v[132:135], v216, s[8:11], s55 offen offset:256 sc1
  buffer_load_dwordx4 v[136:139], v216, s[8:11], s55 offen offset:512 sc1
  buffer_load_dwordx4 v[140:143], v216, s[8:11], s55 offen offset:768 sc1
  buffer_load_dwordx4 v[144:147], v216, s[8:11], s55 offen offset:1024 sc1
  buffer_load_dwordx4 v[148:151], v216, s[8:11], s55 offen offset:1280 sc1
  buffer_load_dwordx4 v[152:155], v216, s[8:11], s55 offen offset:1536 sc1
  buffer_load_dwordx4 v[156:159], v216, s[8:11], s55 offen offset:1792 sc1
  buffer_load_dwordx4 v[160:163], v217, s[8:11], s55 offen offset:0 sc1
  buffer_load_dwordx4 v[164:167], v217, s[8:11], s55 offen offset:256 sc1
  s_add_u32 s60, s60, 110592
  s_add_u32 m0, s67, 36864
  s_nop 0
  buffer_load_dwordx4 v202, s[4:7], s60 offen offset:0 lds
  s_add_u32 m0, s67, 37760
  s_nop 0
  buffer_load_dwordx4 v202, s[4:7], s60 offen offset:128 lds
  s_add_u32 m0, s67, 38656
  s_nop 0
  buffer_load_dwordx4 v202, s[4:7], s60 offen offset:256 lds
  s_add_u32 m0, s67, 39552
  s_nop 0
  buffer_load_dwordx4 v202, s[4:7], s60 offen offset:384 lds
  s_add_u32 m0, s67, 40448
  s_nop 0
  buffer_load_dwordx4 v202, s[4:7], s60 offen offset:512 lds
  s_add_u32 m0, s67, 41344
  s_nop 0
  buffer_load_dwordx4 v202, s[4:7], s60 offen offset:640 lds
  s_add_u32 m0, s67, 42240
  s_nop 0
  buffer_load_dwordx4 v202, s[4:7], s60 offen offset:768 lds
  s_add_u32 m0, s67, 43136
  s_nop 0
  buffer_load_dwordx4 v202, s[4:7], s60 offen offset:896 lds
  s_add_u32 m0, s67, 44032
  s_nop 0
  buffer_load_dwordx4 v202, s[4:7], s60 offen offset:1024 lds
  ds_read_b128 v[32:35], v203 offset:0
  ds_read_b128 v[36:39], v204 offset:0
  ds_read_b128 v[40:43], v205 offset:0
  s_waitcnt lgkmcnt(2)
  v_mfma_f32_32x32x16_bf16 v[0:15], a[0:3], v[32:35], 0
  ds_read_b128 v[44:47], v206 offset:0
  s_waitcnt lgkmcnt(2)
  v_mfma_f32_32x32x16_bf16 v[0:15], a[4:7], v[36:39], v[0:15]
  ds_read_b128 v[32:35], v203 offset:1024
  s_waitcnt lgkmcnt(2)
  v_mfma_f32_32x32x16_bf16 v[0:15], a[8:11], v[40:43], v[0:15]
  ds_read_b128 v[36:39], v204 offset:1024
  s_waitcnt lgkmcnt(2)
  v_mfma_f32_32x32x16_bf16 v[0:15], a[12:15], v[44:47], v[0:15]
  ds_read_b128 v[40:43], v205 offset:1024
  s_waitcnt lgkmcnt(2)
  v_mfma_f32_32x32x16_bf16 v[0:15], a[16:19], v[32:35], v[0:15]
  ds_read_b128 v[44:47], v206 offset:1024
  s_waitcnt lgkmcnt(2)
  v_mfma_f32_32x32x16_bf16 v[0:15], a[20:23], v[36:39], v[0:15]
  ds_read_b128 v[32:35], v203 offset:2048
  s_waitcnt lgkmcnt(2)
  v_mfma_f32_32x32x16_bf16 v[0:15], a[24:27], v[40:43], v[0:15]
  ds_read_b128 v[36:39], v204 offset:2048
  s_waitcnt lgkmcnt(2)
  v_mfma_f32_32x32x16_bf16 v[0:15], a[28:31], v[44:47], v[0:15]
  ds_read_b128 v[40:43], v205 offset:2048
  s_waitcnt lgkmcnt(2)
  v_mfma_f32_32x32x16_bf16 v[0:15], a[32:35], v[32:35], v[0:15]
  ds_read_b128 v[44:47], v206 offset:2048
  s_waitcnt lgkmcnt(2)
  v_mfma_f32_32x32x16_bf16 v[0:15], a[36:39], v[36:39], v[0:15]
  ds_read_b128 v[32:35], v203 offset:3072
  s_waitcnt lgkmcnt(2)
  v_mfma_f32_32x32x16_bf16 v[0:15], a[40:43], v[40:43], v[0:15]
  ds_read_b128 v[36:39], v204 offset:3072
  s_waitcnt lgkmcnt(2)
  v_mfma_f32_32x32x16_bf16 v[0:15], a[44:47], v[44:47], v[0:15]
  ds_read_b128 v[40:43], v205 offset:3072
  s_waitcnt lgkmcnt(2)
  v_mfma_f32_32x32x16_bf16 v[0:15], a[48:51], v[32:35], v[0:15]
  ds_read_b128 v[44:47], v206 offset:3072
  s_waitcnt lgkmcnt(2)
  v_mfma_f32_32x32x16_bf16 v[0:15], a[52:55], v[36:39], v[0:15]
  ds_read_b128 v[32:35], v203 offset:4096
  s_waitcnt lgkmcnt(2)
  v_mfma_f32_32x32x16_bf16 v[0:15], a[56:59], v[40:43], v[0:15]
  ds_read_b128 v[36:39], v204 offset:4096
  s_waitcnt lgkmcnt(2)
  v_mfma_f32_32x32x16_bf16 v[0:15], a[60:63], v[44:47], v[0:15]
  ds_read_b128 v[40:43], v205 offset:4096
  s_waitcnt lgkmcnt(2)
  v_mfma_f32_32x32x16_bf16 v[0:15], a[64:67], v[32:35], v[0:15]
  ds_read_b128 v[44:47], v206 offset:4096
  s_waitcnt lgkmcnt(2)
  v_mfma_f32_32x32x16_bf16 v[0:15], a[68:71], v[36:39], v[0:15]
  ds_read_b128 v[32:35], v203 offset:5120
  s_waitcnt lgkmcnt(2)
  v_mfma_f32_32x32x16_bf16 v[0:15], a[72:75], v[40:43], v[0:15]
  ds_read_b128 v[36:39], v204 offset:5120
  s_waitcnt lgkmcnt(2)
  v_mfma_f32_32x32x16_bf16 v[0:15], a[76:79], v[44:47], v[0:15]
  ds_read_b128 v[40:43], v205 offset:5120
  s_waitcnt lgkmcnt(2)
  v_mfma_f32_32x32x16_bf16 v[0:15], a[80:83], v[32:35], v[0:15]
  ds_read_b128 v[44:47], v206 offset:5120
  s_waitcnt lgkmcnt(2)
  v_mfma_f32_32x32x16_bf16 v[0:15], a[84:87], v[36:39], v[0:15]
  ds_read_b128 v[32:35], v203 offset:6144
  s_waitcnt lgkmcnt(2)
  v_mfma_f32_32x32x16_bf16 v[0:15], a[88:91], v[40:43], v[0:15]
  ds_read_b128 v[36:39], v204 offset:6144
  s_waitcnt lgkmcnt(2)
  v_mfma_f32_32x32x16_bf16 v[0:15], a[92:95], v[44:47], v[0:15]
  ds_read_b128 v[40:43], v205 offset:6144
  s_waitcnt lgkmcnt(2)
  v_mfma_f32_32x32x16_bf16 v[0:15], a[96:99], v[32:35], v[0:15]
  ds_read_b128 v[44:47], v206 offset:6144
  s_waitcnt lgkmcnt(2)
  v_mfma_f32_32x32x16_bf16 v[0:15], a[100:103], v[36:39], v[0:15]
  ds_read_b128 v[32:35], v203 offset:7168
  s_waitcnt lgkmcnt(2)
  v_mfma_f32_32x32x16_bf16 v[0:15], a[104:107], v[40:43], v[0:15]
  ds_read_b128 v[36:39], v204 offset:7168
  s_waitcnt lgkmcnt(2)
  v_mfma_f32_32x32x16_bf16 v[0:15], a[108:111], v[44:47], v[0:15]
  ds_read_b128 v[40:43], v205 offset:7168
  s_waitcnt lgkmcnt(2)
  v_mfma_f32_32x32x16_bf16 v[0:15], a[112:115], v[32:35], v[0:15]
  ds_read_b128 v[44:47], v206 offset:7168
  s_waitcnt lgkmcnt(2)
  v_mfma_f32_32x32x16_bf16 v[0:15], a[116:119], v[36:39], v[0:15]
  ds_read_b128 v[32:35], v203 offset:8192
  s_waitcnt lgkmcnt(2)
  v_mfma_f32_32x32x16_bf16 v[0:15], a[120:123], v[40:43], v[0:15]
  ds_read_b128 v[36:39], v204 offset:8192
  s_waitcnt lgkmcnt(2)
  v_mfma_f32_32x32x16_bf16 v[0:15], a[124:127], v[44:47], v[0:15]
  ds_read_b128 v[40:43], v205 offset:8192
  s_waitcnt lgkmcnt(2)
  v_mfma_f32_32x32x16_bf16 v[0:15], a[128:131], v[32:35], v[0:15]
  ds_read_b128 v[44:47], v206 offset:8192
  s_waitcnt lgkmcnt(2)
  v_mfma_f32_32x32x16_bf16 v[0:15], a[132:135], v[36:39], v[0:15]
  s_waitcnt lgkmcnt(1)
  v_mfma_f32_32x32x16_bf16 v[0:15], a[136:139], v[40:43], v[0:15]
  s_waitcnt lgkmcnt(0)
  v_mfma_f32_32x32x16_bf16 v[0:15], a[140:143], v[44:47], v[0:15]
  s_nop 11
  v_cvt_pk_bf16_f32 v16, v0, v4
  v_cvt_pk_bf16_f32 v17, v1, v5
  v_cvt_pk_bf16_f32 v18, v2, v6
  v_cvt_pk_bf16_f32 v19, v3, v7
  ds_write_b128 v215, v[16:19] offset:0
  v_cvt_pk_bf16_f32 v20, v8, v12
  v_cvt_pk_bf16_f32 v21, v9, v13
  v_cvt_pk_bf16_f32 v22, v10, v14
  v_cvt_pk_bf16_f32 v23, v11, v15
  ds_write_b128 v215, v[20:23] offset:1024
  s_waitcnt lgkmcnt(0)
  s_barrier
  ds_read_b128 v[96:99], v208 offset:0
  ds_read_b128 v[100:103], v208 offset:1024
  ds_read_b128 v[104:107], v208 offset:2048
  ds_read_b128 v[108:111], v208 offset:3072
  ds_read_b128 v[112:115], v208 offset:4096
  ds_read_b128 v[116:119], v208 offset:5120
  ds_read_b128 v[120:123], v208 offset:6144
  ds_read_b128 v[124:127], v208 offset:7168
  s_waitcnt vmcnt(18) lgkmcnt(7)
  v_mfma_f32_32x32x16_bf16 v[64:79], v[128:131], v[96:99], v[48:63]
  s_waitcnt vmcnt(17) lgkmcnt(6)
  v_mfma_f32_32x32x16_bf16 v[64:79], v[132:135], v[100:103], v[64:79]
  s_waitcnt vmcnt(16) lgkmcnt(5)
  v_mfma_f32_32x32x16_bf16 v[64:79], v[136:139], v[104:107], v[64:79]
  s_waitcnt vmcnt(15) lgkmcnt(4)
  v_mfma_f32_32x32x16_bf16 v[64:79], v[140:143], v[108:111], v[64:79]
  s_waitcnt vmcnt(14) lgkmcnt(3)
  v_mfma_f32_32x32x16_bf16 v[64:79], v[144:147], v[112:115], v[64:79]
  s_waitcnt vmcnt(13) lgkmcnt(2)
  v_mfma_f32_32x32x16_bf16 v[64:79], v[148:151], v[116:119], v[64:79]
  s_waitcnt vmcnt(12) lgkmcnt(1)
  v_mfma_f32_32x32x16_bf16 v[64:79], v[152:155], v[120:123], v[64:79]
  s_waitcnt vmcnt(11) lgkmcnt(0)
  v_mfma_f32_32x32x16_bf16 v[64:79], v[156:159], v[124:127], v[64:79]
  s_add_u32 s70, s59, 2
  s_lshl_b32 s55, s64, 12
  s_add_u32 s55, s55, 34603008
  s_nop 8
  v_max3_f32 v16, v64, v65, v66
  v_max3_f32 v16, v16, v67, v68
  v_max3_f32 v16, v16, v69, v70
  v_max3_f32 v16, v16, v71, v72
  v_max3_f32 v16, v16, v73, v74
  v_max3_f32 v16, v16, v75, v76
  v_max3_f32 v16, v16, v77, v78
  v_max_f32 v16, v16, v79
  s_waitcnt vmcnt(0)
  s_cmp_eq_u32 s52, 0
  s_cbranch_scc0 AT_m0_d
  s_mov_b32 exec_hi, 0
  s_mov_b32 exec_lo, 1
AT_m0:
  buffer_load_dword v211, v201, s[8:11], s69 offen sc1
  s_add_u32 s65, s65, 1
  s_waitcnt vmcnt(0)
  v_cmp_gt_u32 vcc, s70, v211
  s_cbranch_vccz AT_m0_x
  s_sleep 1
  s_cmp_lt_u32 s65, 131072
  s_cbranch_scc1 AT_m0
AT_m0_x:
  s_mov_b64 exec, -1
AT_m0_d:
  s_barrier
  buffer_load_dwordx2 v[128:129], v218, s[8:11], s55 offen offset:0 sc1
  buffer_load_dwordx2 v[130:131], v218, s[8:11], s55 offen offset:1024 sc1
  buffer_load_dwordx2 v[132:133], v218, s[8:11], s55 offen offset:256 sc1
  buffer_load_dwordx2 v[134:135], v218, s[8:11], s55 offen offset:1280 sc1
  buffer_load_dwordx2 v[136:137], v218, s[8:11], s55 offen offset:512 sc1
  buffer_load_dwordx2 v[138:139], v218, s[8:11], s55 offen offset:1536 sc1
  buffer_load_dwordx2 v[140:141], v218, s[8:11], s55 offen offset:768 sc1
  buffer_load_dwordx2 v[142:143], v218, s[8:11], s55 offen offset:1792 sc1
  buffer_load_dwordx2 v[144:145], v218, s[8:11], s55 offen offset:2048 sc1
  buffer_load_dwordx2 v[146:147], v218, s[8:11], s55 offen offset:3072 sc1
  buffer_load_dwordx2 v[148:149], v218, s[8:11], s55 offen offset:2304 sc1
  buffer_load_dwordx2 v[150:151], v218, s[8:11], s55 offen offset:3328 sc1
  buffer_load_dwordx2 v[152:153], v218, s[8:11], s55 offen offset:2560 sc1
  buffer_load_dwordx2 v[154:155], v218, s[8:11], s55 offen offset:3584 sc1
  buffer_load_dwordx2 v[156:157], v218, s[8:11], s55 offen offset:2816 sc1
  buffer_load_dwordx2 v[158:159], v218, s[8:11], s55 offen offset:3840 sc1
  buffer_load_dword v168, v219, s[8:11], s55 offen offset:0 sc1
  buffer_load_dword v169, v219, s[8:11], s55 offen offset:256 sc1
  s_waitcnt vmcnt(16)
  v_mfma_f32_32x32x16_bf16 v[80:95], v[128:131], v[96:99], 0
  s_waitcnt vmcnt(14)
  v_mfma_f32_32x32x16_bf16 v[80:95], v[132:135], v[100:103], v[80:95]
  s_waitcnt vmcnt(12)
  v_mfma_f32_32x32x16_bf16 v[80:95], v[136:139], v[104:107], v[80:95]
  s_waitcnt vmcnt(10)
  v_mfma_f32_32x32x16_bf16 v[80:95], v[140:143], v[108:111], v[80:95]
  s_waitcnt vmcnt(8)
  v_mfma_f32_32x32x16_bf16 v[80:95], v[144:147], v[112:115], v[80:95]
  s_waitcnt vmcnt(6)
  v_mfma_f32_32x32x16_bf16 v[80:95], v[148:151], v[116:119], v[80:95]
  s_waitcnt vmcnt(4)
  v_mfma_f32_32x32x16_bf16 v[80:95], v[152:155], v[120:123], v[80:95]
  s_waitcnt vmcnt(2)
  v_mfma_f32_32x32x16_bf16 v[80:95], v[156:159], v[124:127], v[80:95]
  s_lshl_b32 s64, s64, 13
  s_lshl_b32 s54, s52, 11
  s_add_u32 s64, s64, s54
  s_add_u32 s64, s64, 44040192
  s_nop 7
  v_mul_f32 v80, s68, v80
  v_mul_f32 v81, s68, v81
  v_mul_f32 v82, s68, v82
  v_mul_f32 v83, s68, v83
  v_max3_f32 v16, v16, v80, v81
  v_max3_f32 v16, v16, v82, v83
  v_mov_b32 v17, v16
  s_nop 1
  v_permlane32_swap_b32 v16, v17
  v_max_f32 v16, v16, v17
  v_sub_f32 v64, v64, v16
  v_sub_f32 v65, v65, v16
  v_sub_f32 v66, v66, v16
  v_sub_f32 v67, v67, v16
  v_sub_f32 v68, v68, v16
  v_sub_f32 v69, v69, v16
  v_sub_f32 v70, v70, v16
  v_sub_f32 v71, v71, v16
  v_sub_f32 v72, v72, v16
  v_sub_f32 v73, v73, v16
  v_sub_f32 v74, v74, v16
  v_sub_f32 v75, v75, v16
  v_sub_f32 v76, v76, v16
  v_sub_f32 v77, v77, v16
  v_sub_f32 v78, v78, v16
  v_sub_f32 v79, v79, v16
  v_sub_f32 v80, v80, v16
  v_sub_f32 v81, v81, v16
  v_sub_f32 v82, v82, v16
  v_sub_f32 v83, v83, v16
  v_exp_f32 v64, v64
  v_exp_f32 v65, v65
  v_exp_f32 v66, v66
  v_exp_f32 v67, v67
  v_exp_f32 v68, v68
  v_exp_f32 v69, v69
  v_exp_f32 v70, v70
  v_exp_f32 v71, v71
  v_exp_f32 v72, v72
  v_exp_f32 v73, v73
  v_exp_f32 v74, v74
  v_exp_f32 v75, v75
  v_exp_f32 v76, v76
  v_exp_f32 v77, v77
  v_exp_f32 v78, v78
  v_exp_f32 v79, v79
  v_exp_f32 v80, v80
  v_exp_f32 v81, v81
  v_exp_f32 v82, v82
  v_exp_f32 v83, v83
  v_cvt_pk_bf16_f32 v20, v64, v65
  v_cvt_pk_bf16_f32 v21, v68, v69
  v_cvt_pk_bf16_f32 v22, v72, v73
  v_cvt_pk_bf16_f32 v23, v76, v77
  v_cvt_pk_bf16_f32 v24, v66, v67
  v_cvt_pk_bf16_f32 v25, v70, v71
  v_cvt_pk_bf16_f32 v26, v74, v75
  v_cvt_pk_bf16_f32 v27, v78, v79
  v_cvt_pk_bf16_f32 v28, v80, v81
  v_cvt_pk_bf16_f32 v29, v82, v83
  v_mfma_f32_32x32x16_bf16 v[0:15], v[160:163], v[20:23], 0
  v_add_f32 v16, v64, v65
  v_add_f32 v16, v16, v66
  v_add_f32 v16, v16, v67
  v_add_f32 v16, v16, v68
  v_add_f32 v16, v16, v69
  v_add_f32 v16, v16, v70
  v_add_f32 v16, v16, v71
  v_mfma_f32_32x32x16_bf16 v[0:15], v[164:167], v[24:27], v[0:15]
  v_add_f32 v16, v16, v72
  v_add_f32 v16, v16, v73
  v_add_f32 v16, v16, v74
  v_add_f32 v16, v16, v75
  v_add_f32 v16, v16, v76
  v_add_f32 v16, v16, v77
  s_waitcnt vmcnt(0)
  v_mfma_f32_32x32x8_bf16 v[0:15], v[168:169], v[28:29], v[0:15]
  v_add_f32 v16, v16, v78
  v_add_f32 v16, v16, v79
  v_add_f32 v16, v16, v80
  v_add_f32 v16, v16, v81
  v_add_f32 v16, v16, v82
  v_add_f32 v16, v16, v83
  v_mov_b32 v17, v16
  s_nop 1
  v_permlane32_swap_b32 v16, v17
  v_add_f32 v16, v16, v17
  v_rcp_f32 v16, v16
  s_nop 0
  v_mul_f32 v0, v16, v0
  v_mul_f32 v1, v16, v1
  v_mul_f32 v2, v16, v2
  v_mul_f32 v3, v16, v3
  v_mul_f32 v4, v16, v4
  v_mul_f32 v5, v16, v5
  v_mul_f32 v6, v16, v6
  v_mul_f32 v7, v16, v7
  v_cvt_pk_bf16_f32 v20, v0, v1
  v_cvt_pk_bf16_f32 v21, v2, v3
  v_cvt_pk_bf16_f32 v22, v4, v5
  v_cvt_pk_bf16_f32 v23, v6, v7
  buffer_store_dwordx4 v[20:23], v201, s[8:11], s64 offen offset:0 sc1
  v_mul_f32 v8, v16, v8
  v_mul_f32 v9, v16, v9
  v_mul_f32 v10, v16, v10
  v_mul_f32 v11, v16, v11
  v_mul_f32 v12, v16, v12
  v_mul_f32 v13, v16, v13
  v_mul_f32 v14, v16, v14
  v_mul_f32 v15, v16, v15
  v_cvt_pk_bf16_f32 v24, v8, v9
  v_cvt_pk_bf16_f32 v25, v10, v11
  v_cvt_pk_bf16_f32 v26, v12, v13
  v_cvt_pk_bf16_f32 v27, v14, v15
  buffer_store_dwordx4 v[24:27], v201, s[8:11], s64 offen offset:1024 sc1
  s_add_u32 s59, s59, 3
  v_mov_b32 v212, s59
  s_waitcnt vmcnt(0)
  s_barrier
  s_cmp_eq_u32 s52, 0
  s_cselect_b32 s54, s71, 268435456
  s_mov_b64 exec, 1
  buffer_store_dword v212, v201, s[8:11], s54 offen sc1
  s_mov_b64 exec, -1
  s_cmp_ge_u32 s59, 64
  s_cbranch_scc1 L_exit
  s_lshl_b32 s64, s59, 5
  s_add_u32 s64, s64, s58
  s_lshl_b32 s55, s64, 14
  buffer_load_dwordx4 v[128:131], v216, s[8:11], s55 offen offset:0 sc1
  buffer_load_dwordx4 v[132:135], v216, s[8:11], s55 offen offset:256 sc1
  buffer_load_dwordx4 v[136:139], v216, s[8:11], s55 offen offset:512 sc1
  buffer_load_dwordx4 v[140:143], v216, s[8:11], s55 offen offset:768 sc1
  buffer_load_dwordx4 v[144:147], v216, s[8:11], s55 offen offset:1024 sc1
  buffer_load_dwordx4 v[148:151], v216, s[8:11], s55 offen offset:1280 sc1
  buffer_load_dwordx4 v[152:155], v216, s[8:11], s55 offen offset:1536 sc1
  buffer_load_dwordx4 v[156:159], v216, s[8:11], s55 offen offset:1792 sc1
  buffer_load_dwordx4 v[160:163], v217, s[8:11], s55 offen offset:0 sc1
  buffer_load_dwordx4 v[164:167], v217, s[8:11], s55 offen offset:256 sc1
  s_add_u32 s60, s60, 110592
  s_add_u32 m0, s67, 0
  s_nop 0
  buffer_load_dwordx4 v202, s[4:7], s60 offen offset:0 lds
  s_add_u32 m0, s67, 896
  s_nop 0
  buffer_load_dwordx4 v202, s[4:7], s60 offen offset:128 lds
  s_add_u32 m0, s67, 1792
  s_nop 0
  buffer_load_dwordx4 v202, s[4:7], s60 offen offset:256 lds
  s_add_u32 m0, s67, 2688
  s_nop 0
  buffer_load_dwordx4 v202, s[4:7], s60 offen offset:384 lds
  s_add_u32 m0, s67, 3584
  s_nop 0
  buffer_load_dwordx4 v202, s[4:7], s60 offen offset:512 lds
  s_add_u32 m0, s67, 4480
  s_nop 0
  buffer_load_dwordx4 v202, s[4:7], s60 offen offset:640 lds
  s_add_u32 m0, s67, 5376
  s_nop 0
  buffer_load_dwordx4 v202, s[4:7], s60 offen offset:768 lds
  s_add_u32 m0, s67, 6272
  s_nop 0
  buffer_load_dwordx4 v202, s[4:7], s60 offen offset:896 lds
  s_add_u32 m0, s67, 7168
  s_nop 0
  buffer_load_dwordx4 v202, s[4:7], s60 offen offset:1024 lds
  ds_read_b128 v[32:35], v203 offset:36864
  ds_read_b128 v[36:39], v204 offset:36864
  ds_read_b128 v[40:43], v205 offset:36864
  s_waitcnt lgkmcnt(2)
  v_mfma_f32_32x32x16_bf16 v[0:15], a[0:3], v[32:35], 0
  ds_read_b128 v[44:47], v206 offset:36864
  s_waitcnt lgkmcnt(2)
  v_mfma_f32_32x32x16_bf16 v[0:15], a[4:7], v[36:39], v[0:15]
  ds_read_b128 v[32:35], v203 offset:37888
  s_waitcnt lgkmcnt(2)
  v_mfma_f32_32x32x16_bf16 v[0:15], a[8:11], v[40:43], v[0:15]
  ds_read_b128 v[36:39], v204 offset:37888
  s_waitcnt lgkmcnt(2)
  v_mfma_f32_32x32x16_bf16 v[0:15], a[12:15], v[44:47], v[0:15]
  ds_read_b128 v[40:43], v205 offset:37888
  s_waitcnt lgkmcnt(2)
  v_mfma_f32_32x32x16_bf16 v[0:15], a[16:19], v[32:35], v[0:15]
  ds_read_b128 v[44:47], v206 offset:37888
  s_waitcnt lgkmcnt(2)
  v_mfma_f32_32x32x16_bf16 v[0:15], a[20:23], v[36:39], v[0:15]
  ds_read_b128 v[32:35], v203 offset:38912
  s_waitcnt lgkmcnt(2)
  v_mfma_f32_32x32x16_bf16 v[0:15], a[24:27], v[40:43], v[0:15]
  ds_read_b128 v[36:39], v204 offset:38912
  s_waitcnt lgkmcnt(2)
  v_mfma_f32_32x32x16_bf16 v[0:15], a[28:31], v[44:47], v[0:15]
  ds_read_b128 v[40:43], v205 offset:38912
  s_waitcnt lgkmcnt(2)
  v_mfma_f32_32x32x16_bf16 v[0:15], a[32:35], v[32:35], v[0:15]
  ds_read_b128 v[44:47], v206 offset:38912
  s_waitcnt lgkmcnt(2)
  v_mfma_f32_32x32x16_bf16 v[0:15], a[36:39], v[36:39], v[0:15]
  ds_read_b128 v[32:35], v203 offset:39936
  s_waitcnt lgkmcnt(2)
  v_mfma_f32_32x32x16_bf16 v[0:15], a[40:43], v[40:43], v[0:15]
  ds_read_b128 v[36:39], v204 offset:39936
  s_waitcnt lgkmcnt(2)
  v_mfma_f32_32x32x16_bf16 v[0:15], a[44:47], v[44:47], v[0:15]
  ds_read_b128 v[40:43], v205 offset:39936
  s_waitcnt lgkmcnt(2)
  v_mfma_f32_32x32x16_bf16 v[0:15], a[48:51], v[32:35], v[0:15]
  ds_read_b128 v[44:47], v206 offset:39936
  s_waitcnt lgkmcnt(2)
  v_mfma_f32_32x32x16_bf16 v[0:15], a[52:55], v[36:39], v[0:15]
  ds_read_b128 v[32:35], v203 offset:40960
  s_waitcnt lgkmcnt(2)
  v_mfma_f32_32x32x16_bf16 v[0:15], a[56:59], v[40:43], v[0:15]
  ds_read_b128 v[36:39], v204 offset:40960
  s_waitcnt lgkmcnt(2)
  v_mfma_f32_32x32x16_bf16 v[0:15], a[60:63], v[44:47], v[0:15]
  ds_read_b128 v[40:43], v205 offset:40960
  s_waitcnt lgkmcnt(2)
  v_mfma_f32_32x32x16_bf16 v[0:15], a[64:67], v[32:35], v[0:15]
  ds_read_b128 v[44:47], v206 offset:40960
  s_waitcnt lgkmcnt(2)
  v_mfma_f32_32x32x16_bf16 v[0:15], a[68:71], v[36:39], v[0:15]
  ds_read_b128 v[32:35], v203 offset:41984
  s_waitcnt lgkmcnt(2)
  v_mfma_f32_32x32x16_bf16 v[0:15], a[72:75], v[40:43], v[0:15]
  ds_read_b128 v[36:39], v204 offset:41984
  s_waitcnt lgkmcnt(2)
  v_mfma_f32_32x32x16_bf16 v[0:15], a[76:79], v[44:47], v[0:15]
  ds_read_b128 v[40:43], v205 offset:41984
  s_waitcnt lgkmcnt(2)
  v_mfma_f32_32x32x16_bf16 v[0:15], a[80:83], v[32:35], v[0:15]
  ds_read_b128 v[44:47], v206 offset:41984
  s_waitcnt lgkmcnt(2)
  v_mfma_f32_32x32x16_bf16 v[0:15], a[84:87], v[36:39], v[0:15]
  ds_read_b128 v[32:35], v203 offset:43008
  s_waitcnt lgkmcnt(2)
  v_mfma_f32_32x32x16_bf16 v[0:15], a[88:91], v[40:43], v[0:15]
  ds_read_b128 v[36:39], v204 offset:43008
  s_waitcnt lgkmcnt(2)
  v_mfma_f32_32x32x16_bf16 v[0:15], a[92:95], v[44:47], v[0:15]
  ds_read_b128 v[40:43], v205 offset:43008
  s_waitcnt lgkmcnt(2)
  v_mfma_f32_32x32x16_bf16 v[0:15], a[96:99], v[32:35], v[0:15]
  ds_read_b128 v[44:47], v206 offset:43008
  s_waitcnt lgkmcnt(2)
  v_mfma_f32_32x32x16_bf16 v[0:15], a[100:103], v[36:39], v[0:15]
  ds_read_b128 v[32:35], v203 offset:44032
  s_waitcnt lgkmcnt(2)
  v_mfma_f32_32x32x16_bf16 v[0:15], a[104:107], v[40:43], v[0:15]
  ds_read_b128 v[36:39], v204 offset:44032
  s_waitcnt lgkmcnt(2)
  v_mfma_f32_32x32x16_bf16 v[0:15], a[108:111], v[44:47], v[0:15]
  ds_read_b128 v[40:43], v205 offset:44032
  s_waitcnt lgkmcnt(2)
  v_mfma_f32_32x32x16_bf16 v[0:15], a[112:115], v[32:35], v[0:15]
  ds_read_b128 v[44:47], v206 offset:44032
  s_waitcnt lgkmcnt(2)
  v_mfma_f32_32x32x16_bf16 v[0:15], a[116:119], v[36:39], v[0:15]
  ds_read_b128 v[32:35], v203 offset:45056
  s_waitcnt lgkmcnt(2)
  v_mfma_f32_32x32x16_bf16 v[0:15], a[120:123], v[40:43], v[0:15]
  ds_read_b128 v[36:39], v204 offset:45056
  s_waitcnt lgkmcnt(2)
  v_mfma_f32_32x32x16_bf16 v[0:15], a[124:127], v[44:47], v[0:15]
  ds_read_b128 v[40:43], v205 offset:45056
  s_waitcnt lgkmcnt(2)
  v_mfma_f32_32x32x16_bf16 v[0:15], a[128:131], v[32:35], v[0:15]
  ds_read_b128 v[44:47], v206 offset:45056
  s_waitcnt lgkmcnt(2)
  v_mfma_f32_32x32x16_bf16 v[0:15], a[132:135], v[36:39], v[0:15]
  s_waitcnt lgkmcnt(1)
  v_mfma_f32_32x32x16_bf16 v[0:15], a[136:139], v[40:43], v[0:15]
  s_waitcnt lgkmcnt(0)
  v_mfma_f32_32x32x16_bf16 v[0:15], a[140:143], v[44:47], v[0:15]
  s_nop 11
  v_cvt_pk_bf16_f32 v16, v0, v4
  v_cvt_pk_bf16_f32 v17, v1, v5
  v_cvt_pk_bf16_f32 v18, v2, v6
  v_cvt_pk_bf16_f32 v19, v3, v7
  ds_write_b128 v215, v[16:19] offset:0
  v_cvt_pk_bf16_f32 v20, v8, v12
  v_cvt_pk_bf16_f32 v21, v9, v13
  v_cvt_pk_bf16_f32 v22, v10, v14
  v_cvt_pk_bf16_f32 v23, v11, v15
  ds_write_b128 v215, v[20:23] offset:1024
  s_waitcnt lgkmcnt(0)
  s_barrier
  ds_read_b128 v[96:99], v208 offset:0
  ds_read_b128 v[100:103], v208 offset:1024
  ds_read_b128 v[104:107], v208 offset:2048
  ds_read_b128 v[108:111], v208 offset:3072
  ds_read_b128 v[112:115], v208 offset:4096
  ds_read_b128 v[116:119], v208 offset:5120
  ds_read_b128 v[120:123], v208 offset:6144
  ds_read_b128 v[124:127], v208 offset:7168
  s_waitcnt vmcnt(18) lgkmcnt(7)
  v_mfma_f32_32x32x16_bf16 v[64:79], v[128:131], v[96:99], v[48:63]
  s_waitcnt vmcnt(17) lgkmcnt(6)
  v_mfma_f32_32x32x16_bf16 v[64:79], v[132:135], v[100:103], v[64:79]
  s_waitcnt vmcnt(16) lgkmcnt(5)
  v_mfma_f32_32x32x16_bf16 v[64:79], v[136:139], v[104:107], v[64:79]
  s_waitcnt vmcnt(15) lgkmcnt(4)
  v_mfma_f32_32x32x16_bf16 v[64:79], v[140:143], v[108:111], v[64:79]
  s_waitcnt vmcnt(14) lgkmcnt(3)
  v_mfma_f32_32x32x16_bf16 v[64:79], v[144:147], v[112:115], v[64:79]
  s_waitcnt vmcnt(13) lgkmcnt(2)
  v_mfma_f32_32x32x16_bf16 v[64:79], v[148:151], v[116:119], v[64:79]
  s_waitcnt vmcnt(12) lgkmcnt(1)
  v_mfma_f32_32x32x16_bf16 v[64:79], v[152:155], v[120:123], v[64:79]
  s_waitcnt vmcnt(11) lgkmcnt(0)
  v_mfma_f32_32x32x16_bf16 v[64:79], v[156:159], v[124:127], v[64:79]
  s_add_u32 s70, s59, 2
  s_lshl_b32 s55, s64, 12
  s_add_u32 s55, s55, 34603008
  s_nop 8
  v_max3_f32 v16, v64, v65, v66
  v_max3_f32 v16, v16, v67, v68
  v_max3_f32 v16, v16, v69, v70
  v_max3_f32 v16, v16, v71, v72
  v_max3_f32 v16, v16, v73, v74
  v_max3_f32 v16, v16, v75, v76
  v_max3_f32 v16, v16, v77, v78
  v_max_f32 v16, v16, v79
  s_waitcnt vmcnt(0)
  s_cmp_eq_u32 s52, 0
  s_cbranch_scc0 AT_m1_d
  s_mov_b32 exec_hi, 0
  s_mov_b32 exec_lo, 1
AT_m1:
  buffer_load_dword v211, v201, s[8:11], s69 offen sc1
  s_add_u32 s65, s65, 1
  s_waitcnt vmcnt(0)
  v_cmp_gt_u32 vcc, s70, v211
  s_cbranch_vccz AT_m1_x
  s_sleep 1
  s_cmp_lt_u32 s65, 131072
  s_cbranch_scc1 AT_m1
AT_m1_x:
  s_mov_b64 exec, -1
AT_m1_d:
  s_barrier
  buffer_load_dwordx2 v[128:129], v218, s[8:11], s55 offen offset:0 sc1
  buffer_load_dwordx2 v[130:131], v218, s[8:11], s55 offen offset:1024 sc1
  buffer_load_dwordx2 v[132:133], v218, s[8:11], s55 offen offset:256 sc1
  buffer_load_dwordx2 v[134:135], v218, s[8:11], s55 offen offset:1280 sc1
  buffer_load_dwordx2 v[136:137], v218, s[8:11], s55 offen offset:512 sc1
  buffer_load_dwordx2 v[138:139], v218, s[8:11], s55 offen offset:1536 sc1
  buffer_load_dwordx2 v[140:141], v218, s[8:11], s55 offen offset:768 sc1
  buffer_load_dwordx2 v[142:143], v218, s[8:11], s55 offen offset:1792 sc1
  buffer_load_dwordx2 v[144:145], v218, s[8:11], s55 offen offset:2048 sc1
  buffer_load_dwordx2 v[146:147], v218, s[8:11], s55 offen offset:3072 sc1
  buffer_load_dwordx2 v[148:149], v218, s[8:11], s55 offen offset:2304 sc1
  buffer_load_dwordx2 v[150:151], v218, s[8:11], s55 offen offset:3328 sc1
  buffer_load_dwordx2 v[152:153], v218, s[8:11], s55 offen offset:2560 sc1
  buffer_load_dwordx2 v[154:155], v218, s[8:11], s55 offen offset:3584 sc1
  buffer_load_dwordx2 v[156:157], v218, s[8:11], s55 offen offset:2816 sc1
  buffer_load_dwordx2 v[158:159], v218, s[8:11], s55 offen offset:3840 sc1
  buffer_load_dword v168, v219, s[8:11], s55 offen offset:0 sc1
  buffer_load_dword v169, v219, s[8:11], s55 offen offset:256 sc1
  s_waitcnt vmcnt(16)
  v_mfma_f32_32x32x16_bf16 v[80:95], v[128:131], v[96:99], 0
  s_waitcnt vmcnt(14)
  v_mfma_f32_32x32x16_bf16 v[80:95], v[132:135], v[100:103], v[80:95]
  s_waitcnt vmcnt(12)
  v_mfma_f32_32x32x16_bf16 v[80:95], v[136:139], v[104:107], v[80:95]
  s_waitcnt vmcnt(10)
  v_mfma_f32_32x32x16_bf16 v[80:95], v[140:143], v[108:111], v[80:95]
  s_waitcnt vmcnt(8)
  v_mfma_f32_32x32x16_bf16 v[80:95], v[144:147], v[112:115], v[80:95]
  s_waitcnt vmcnt(6)
  v_mfma_f32_32x32x16_bf16 v[80:95], v[148:151], v[116:119], v[80:95]
  s_waitcnt vmcnt(4)
  v_mfma_f32_32x32x16_bf16 v[80:95], v[152:155], v[120:123], v[80:95]
  s_waitcnt vmcnt(2)
  v_mfma_f32_32x32x16_bf16 v[80:95], v[156:159], v[124:127], v[80:95]
  s_lshl_b32 s64, s64, 13
  s_lshl_b32 s54, s52, 11
  s_add_u32 s64, s64, s54
  s_add_u32 s64, s64, 44040192
  s_nop 7
  v_mul_f32 v80, s68, v80
  v_mul_f32 v81, s68, v81
  v_mul_f32 v82, s68, v82
  v_mul_f32 v83, s68, v83
  v_max3_f32 v16, v16, v80, v81
  v_max3_f32 v16, v16, v82, v83
  v_mov_b32 v17, v16
  s_nop 1
  v_permlane32_swap_b32 v16, v17
  v_max_f32 v16, v16, v17
  v_sub_f32 v64, v64, v16
  v_sub_f32 v65, v65, v16
  v_sub_f32 v66, v66, v16
  v_sub_f32 v67, v67, v16
  v_sub_f32 v68, v68, v16
  v_sub_f32 v69, v69, v16
  v_sub_f32 v70, v70, v16
  v_sub_f32 v71, v71, v16
  v_sub_f32 v72, v72, v16
  v_sub_f32 v73, v73, v16
  v_sub_f32 v74, v74, v16
  v_sub_f32 v75, v75, v16
  v_sub_f32 v76, v76, v16
  v_sub_f32 v77, v77, v16
  v_sub_f32 v78, v78, v16
  v_sub_f32 v79, v79, v16
  v_sub_f32 v80, v80, v16
  v_sub_f32 v81, v81, v16
  v_sub_f32 v82, v82, v16
  v_sub_f32 v83, v83, v16
  v_exp_f32 v64, v64
  v_exp_f32 v65, v65
  v_exp_f32 v66, v66
  v_exp_f32 v67, v67
  v_exp_f32 v68, v68
  v_exp_f32 v69, v69
  v_exp_f32 v70, v70
  v_exp_f32 v71, v71
  v_exp_f32 v72, v72
  v_exp_f32 v73, v73
  v_exp_f32 v74, v74
  v_exp_f32 v75, v75
  v_exp_f32 v76, v76
  v_exp_f32 v77, v77
  v_exp_f32 v78, v78
  v_exp_f32 v79, v79
  v_exp_f32 v80, v80
  v_exp_f32 v81, v81
  v_exp_f32 v82, v82
  v_exp_f32 v83, v83
  v_cvt_pk_bf16_f32 v20, v64, v65
  v_cvt_pk_bf16_f32 v21, v68, v69
  v_cvt_pk_bf16_f32 v22, v72, v73
  v_cvt_pk_bf16_f32 v23, v76, v77
  v_cvt_pk_bf16_f32 v24, v66, v67
  v_cvt_pk_bf16_f32 v25, v70, v71
  v_cvt_pk_bf16_f32 v26, v74, v75
  v_cvt_pk_bf16_f32 v27, v78, v79
  v_cvt_pk_bf16_f32 v28, v80, v81
  v_cvt_pk_bf16_f32 v29, v82, v83
  v_mfma_f32_32x32x16_bf16 v[0:15], v[160:163], v[20:23], 0
  v_add_f32 v16, v64, v65
  v_add_f32 v16, v16, v66
  v_add_f32 v16, v16, v67
  v_add_f32 v16, v16, v68
  v_add_f32 v16, v16, v69
  v_add_f32 v16, v16, v70
  v_add_f32 v16, v16, v71
  v_mfma_f32_32x32x16_bf16 v[0:15], v[164:167], v[24:27], v[0:15]
  v_add_f32 v16, v16, v72
  v_add_f32 v16, v16, v73
  v_add_f32 v16, v16, v74
  v_add_f32 v16, v16, v75
  v_add_f32 v16, v16, v76
  v_add_f32 v16, v16, v77
  s_waitcnt vmcnt(0)
  v_mfma_f32_32x32x8_bf16 v[0:15], v[168:169], v[28:29], v[0:15]
  v_add_f32 v16, v16, v78
  v_add_f32 v16, v16, v79
  v_add_f32 v16, v16, v80
  v_add_f32 v16, v16, v81
  v_add_f32 v16, v16, v82
  v_add_f32 v16, v16, v83
  v_mov_b32 v17, v16
  s_nop 1
  v_permlane32_swap_b32 v16, v17
  v_add_f32 v16, v16, v17
  v_rcp_f32 v16, v16
  s_nop 0
  v_mul_f32 v0, v16, v0
  v_mul_f32 v1, v16, v1
  v_mul_f32 v2, v16, v2
  v_mul_f32 v3, v16, v3
  v_mul_f32 v4, v16, v4
  v_mul_f32 v5, v16, v5
  v_mul_f32 v6, v16, v6
  v_mul_f32 v7, v16, v7
  v_cvt_pk_bf16_f32 v20, v0, v1
  v_cvt_pk_bf16_f32 v21, v2, v3
  v_cvt_pk_bf16_f32 v22, v4, v5
  v_cvt_pk_bf16_f32 v23, v6, v7
  buffer_store_dwordx4 v[20:23], v201, s[8:11], s64 offen offset:0 sc1
  v_mul_f32 v8, v16, v8
  v_mul_f32 v9, v16, v9
  v_mul_f32 v10, v16, v10
  v_mul_f32 v11, v16, v11
  v_mul_f32 v12, v16, v12
  v_mul_f32 v13, v16, v13
  v_mul_f32 v14, v16, v14
  v_mul_f32 v15, v16, v15
  v_cvt_pk_bf16_f32 v24, v8, v9
  v_cvt_pk_bf16_f32 v25, v10, v11
  v_cvt_pk_bf16_f32 v26, v12, v13
  v_cvt_pk_bf16_f32 v27, v14, v15
  buffer_store_dwordx4 v[24:27], v201, s[8:11], s64 offen offset:1024 sc1
  s_add_u32 s59, s59, 3
  v_mov_b32 v212, s59
  s_waitcnt vmcnt(0)
  s_barrier
  s_cmp_eq_u32 s52, 0
  s_cselect_b32 s54, s71, 268435456
  s_mov_b64 exec, 1
  buffer_store_dword v212, v201, s[8:11], s54 offen sc1
  s_mov_b64 exec, -1
  s_cmp_ge_u32 s59, 64
  s_cbranch_scc1 L_exit
  s_branch AT_loop
W_a:
  s_sub_u32 s54, s53, 96
  s_lshr_b32 s68, s54, 4
  s_and_b32 s69, s54, 15
  s_lshl_b32 s60, s69, 2
  s_sub_u32 s60, s60, 1
  s_max_i32 s60, s60, 0
  s_mul_i32 s60, s60, 36864
  s_add_u32 m0, s67, 0
  s_nop 0
  buffer_load_dwordx4 v202, s[4:7], s60 offen offset:0 lds
  s_add_u32 m0, s67, 896
  s_nop 0
  buffer_load_dwordx4 v202, s[4:7], s60 offen offset:128 lds
  s_add_u32 m0, s67, 1792
  s_nop 0
  buffer_load_dwordx4 v202, s[4:7], s60 offen offset:256 lds
  s_add_u32 m0, s67, 2688
  s_nop 0
  buffer_load_dwordx4 v202, s[4:7], s60 offen offset:384 lds
  s_add_u32 m0, s67, 3584
  s_nop 0
  buffer_load_dwordx4 v202, s[4:7], s60 offen offset:512 lds
  s_add_u32 m0, s67, 4480
  s_nop 0
  buffer_load_dwordx4 v202, s[4:7], s60 offen offset:640 lds
  s_add_u32 m0, s67, 5376
  s_nop 0
  buffer_load_dwordx4 v202, s[4:7], s60 offen offset:768 lds
  s_add_u32 m0, s67, 6272
  s_nop 0
  buffer_load_dwordx4 v202, s[4:7], s60 offen offset:896 lds
  s_add_u32 m0, s67, 7168
  s_nop 0
  buffer_load_dwordx4 v202, s[4:7], s60 offen offset:1024 lds
  v_and_b32 v211, 15, v200
  v_mul_u32_u24 v211, 72, v211
  v_lshrrev_b32 v212, 4, v200
  v_mul_u32_u24 v213, 1152, v212
  v_add_u32 v213, v213, v211
  s_lshl_b32 s54, s54, 2
  s_add_u32 s70, s54, s52
  s_mul_i32 s55, s70, 4608
  buffer_load_dwordx4 v[48:51], v213, s[4:7], s55 offen offset:0
  buffer_load_dwordx4 v[52:55], v213, s[4:7], s55 offen offset:16
  buffer_load_dwordx4 v[56:59], v213, s[4:7], s55 offen offset:32
  buffer_load_dwordx4 v[60:63], v213, s[4:7], s55 offen offset:48
  buffer_load_dwordx2 v[64:65], v213, s[4:7], s55 offen offset:64
  buffer_load_dwordx4 v[68:71], v211, s[44:47], 0 offen offset:0
  buffer_load_dwordx4 v[72:75], v211, s[44:47], 0 offen offset:16
  buffer_load_dwordx4 v[76:79], v211, s[44:47], 0 offen offset:32
  buffer_load_dwordx4 v[80:83], v211, s[44:47], 0 offen offset:48
  buffer_load_dwordx2 v[84:85], v211, s[44:47], 0 offen offset:64
  v_mov_b32 v0, 0
  v_mov_b32 v1, 0x3f803f80
  s_waitcnt vmcnt(9)
  v_lshlrev_b32 v2, 16, v48
  s_waitcnt vmcnt(4)
  v_lshlrev_b32 v3, 16, v68
  v_and_b32 v4, 0xffff0000, v48
  v_and_b32 v5, 0xffff0000, v68
  v_mul_f32 v2, v2, v3
  v_mul_f32 v4, v4, v5
  v_cvt_pk_bf16_f32 v2, v2, v4
  v_lshlrev_b32 v3, 16, v2
  v_and_b32 v4, 0xffff0000, v2
  v_add_f32 v0, v0, v3
  v_add_f32 v0, v0, v4
  v_lshlrev_b32 v2, 16, v49
  v_lshlrev_b32 v3, 16, v69
  v_and_b32 v4, 0xffff0000, v49
  v_and_b32 v5, 0xffff0000, v69
  v_mul_f32 v2, v2, v3
  v_mul_f32 v4, v4, v5
  v_cvt_pk_bf16_f32 v2, v2, v4
  v_lshlrev_b32 v3, 16, v2
  v_and_b32 v4, 0xffff0000, v2
  v_add_f32 v0, v0, v3
  v_add_f32 v0, v0, v4
  v_lshlrev_b32 v2, 16, v50
  v_lshlrev_b32 v3, 16, v70
  v_and_b32 v4, 0xffff0000, v50
  v_and_b32 v5, 0xffff0000, v70
  v_mul_f32 v2, v2, v3
  v_mul_f32 v4, v4, v5
  v_cvt_pk_bf16_f32 v2, v2, v4
  v_lshlrev_b32 v3, 16, v2
  v_and_b32 v4, 0xffff0000, v2
  v_add_f32 v0, v0, v3
  v_add_f32 v0, v0, v4
  v_lshlrev_b32 v2, 16, v51
  v_lshlrev_b32 v3, 16, v71
  v_and_b32 v4, 0xffff0000, v51
  v_and_b32 v5, 0xffff0000, v71
  v_mul_f32 v2, v2, v3
  v_mul_f32 v4, v4, v5
  v_cvt_pk_bf16_f32 v2, v2, v4
  v_lshlrev_b32 v3, 16, v2
  v_and_b32 v4, 0xffff0000, v2
  v_add_f32 v0, v0, v3
  v_add_f32 v0, v0, v4
  v_lshlrev_b32 v2, 16, v52
  s_waitcnt vmcnt(3)
  v_lshlrev_b32 v3, 16, v72
  v_and_b32 v4, 0xffff0000, v52
  v_and_b32 v5, 0xffff0000, v72
  v_mul_f32 v2, v2, v3
  v_mul_f32 v4, v4, v5
  v_cvt_pk_bf16_f32 v2, v2, v4
  v_lshlrev_b32 v3, 16, v2
  v_and_b32 v4, 0xffff0000, v2
  v_add_f32 v0, v0, v3
  v_add_f32 v0, v0, v4
  v_lshlrev_b32 v2, 16, v53
  v_lshlrev_b32 v3, 16, v73
  v_and_b32 v4, 0xffff0000, v53
  v_and_b32 v5, 0xffff0000, v73
  v_mul_f32 v2, v2, v3
  v_mul_f32 v4, v4, v5
  v_cvt_pk_bf16_f32 v2, v2, v4
  v_lshlrev_b32 v3, 16, v2
  v_and_b32 v4, 0xffff0000, v2
  v_add_f32 v0, v0, v3
  v_add_f32 v0, v0, v4
  v_lshlrev_b32 v2, 16, v54
  v_lshlrev_b32 v3, 16, v74
  v_and_b32 v4, 0xffff0000, v54
  v_and_b32 v5, 0xffff0000, v74
  v_mul_f32 v2, v2, v3
  v_mul_f32 v4, v4, v5
  v_cvt_pk_bf16_f32 v2, v2, v4
  v_lshlrev_b32 v3, 16, v2
  v_and_b32 v4, 0xffff0000, v2
  v_add_f32 v0, v0, v3
  v_add_f32 v0, v0, v4
  v_lshlrev_b32 v2, 16, v55
  v_lshlrev_b32 v3, 16, v75
  v_and_b32 v4, 0xffff0000, v55
  v_and_b32 v5, 0xffff0000, v75
  v_mul_f32 v2, v2, v3
  v_mul_f32 v4, v4, v5
  v_cvt_pk_bf16_f32 v2, v2, v4
  v_lshlrev_b32 v3, 16, v2
  v_and_b32 v4, 0xffff0000, v2
  v_add_f32 v0, v0, v3
  v_add_f32 v0, v0, v4
  v_lshlrev_b32 v2, 16, v56
  s_waitcnt vmcnt(2)
  v_lshlrev_b32 v3, 16, v76
  v_and_b32 v4, 0xffff0000, v56
  v_and_b32 v5, 0xffff0000, v76
  v_mul_f32 v2, v2, v3
  v_mul_f32 v4, v4, v5
  v_cvt_pk_bf16_f32 v2, v2, v4
  v_lshlrev_b32 v3, 16, v2
  v_and_b32 v4, 0xffff0000, v2
  v_add_f32 v0, v0, v3
  v_add_f32 v0, v0, v4
  v_lshlrev_b32 v2, 16, v57
  v_lshlrev_b32 v3, 16, v77
  v_and_b32 v4, 0xffff0000, v57
  v_and_b32 v5, 0xffff0000, v77
  v_mul_f32 v2, v2, v3
  v_mul_f32 v4, v4, v5
  v_cvt_pk_bf16_f32 v2, v2, v4
  v_lshlrev_b32 v3, 16, v2
  v_and_b32 v4, 0xffff0000, v2
  v_add_f32 v0, v0, v3
  v_add_f32 v0, v0, v4
  v_lshlrev_b32 v2, 16, v58
  v_lshlrev_b32 v3, 16, v78
  v_and_b32 v4, 0xffff0000, v58
  v_and_b32 v5, 0xffff0000, v78
  v_mul_f32 v2, v2, v3
  v_mul_f32 v4, v4, v5
  v_cvt_pk_bf16_f32 v2, v2, v4
  v_lshlrev_b32 v3, 16, v2
  v_and_b32 v4, 0xffff0000, v2
  v_add_f32 v0, v0, v3
  v_add_f32 v0, v0, v4
  v_lshlrev_b32 v2, 16, v59
  v_lshlrev_b32 v3, 16, v79
  v_and_b32 v4, 0xffff0000, v59
  v_and_b32 v5, 0xffff0000, v79
  v_mul_f32 v2, v2, v3
  v_mul_f32 v4, v4, v5
  v_cvt_pk_bf16_f32 v2, v2, v4
  v_lshlrev_b32 v3, 16, v2
  v_and_b32 v4, 0xffff0000, v2
  v_add_f32 v0, v0, v3
  v_add_f32 v0, v0, v4
  v_lshlrev_b32 v2, 16, v60
  s_waitcnt vmcnt(1)
  v_lshlrev_b32 v3, 16, v80
  v_and_b32 v4, 0xffff0000, v60
  v_and_b32 v5, 0xffff0000, v80
  v_mul_f32 v2, v2, v3
  v_mul_f32 v4, v4, v5
  v_cvt_pk_bf16_f32 v2, v2, v4
  v_lshlrev_b32 v3, 16, v2
  v_and_b32 v4, 0xffff0000, v2
  v_add_f32 v0, v0, v3
  v_add_f32 v0, v0, v4
  v_lshlrev_b32 v2, 16, v61
  v_lshlrev_b32 v3, 16, v81
  v_and_b32 v4, 0xffff0000, v61
  v_and_b32 v5, 0xffff0000, v81
  v_mul_f32 v2, v2, v3
  v_mul_f32 v4, v4, v5
  v_cvt_pk_bf16_f32 v2, v2, v4
  v_lshlrev_b32 v3, 16, v2
  v_and_b32 v4, 0xffff0000, v2
  v_add_f32 v0, v0, v3
  v_add_f32 v0, v0, v4
  v_lshlrev_b32 v2, 16, v62
  v_lshlrev_b32 v3, 16, v82
  v_and_b32 v4, 0xffff0000, v62
  v_and_b32 v5, 0xffff0000, v82
  v_mul_f32 v2, v2, v3
  v_mul_f32 v4, v4, v5
  v_cvt_pk_bf16_f32 v2, v2, v4
  v_lshlrev_b32 v3, 16, v2
  v_and_b32 v4, 0xffff0000, v2
  v_add_f32 v0, v0, v3
  v_add_f32 v0, v0, v4
  v_lshlrev_b32 v2, 16, v63
  v_lshlrev_b32 v3, 16, v83
  v_and_b32 v4, 0xffff0000, v63
  v_and_b32 v5, 0xffff0000, v83
  v_mul_f32 v2, v2, v3
  v_mul_f32 v4, v4, v5
  v_cvt_pk_bf16_f32 v2, v2, v4
  v_lshlrev_b32 v3, 16, v2
  v_and_b32 v4, 0xffff0000, v2
  v_add_f32 v0, v0, v3
  v_add_f32 v0, v0, v4
  v_lshlrev_b32 v2, 16, v64
  s_waitcnt vmcnt(0)
  v_lshlrev_b32 v3, 16, v84
  v_and_b32 v4, 0xffff0000, v64
  v_and_b32 v5, 0xffff0000, v84
  v_mul_f32 v2, v2, v3
  v_mul_f32 v4, v4, v5
  v_cvt_pk_bf16_f32 v2, v2, v4
  v_lshlrev_b32 v3, 16, v2
  v_and_b32 v4, 0xffff0000, v2
  v_add_f32 v0, v0, v3
  v_add_f32 v0, v0, v4
  v_lshlrev_b32 v2, 16, v65
  v_lshlrev_b32 v3, 16, v85
  v_and_b32 v4, 0xffff0000, v65
  v_and_b32 v5, 0xffff0000, v85
  v_mul_f32 v2, v2, v3
  v_mul_f32 v4, v4, v5
  v_cvt_pk_bf16_f32 v2, v2, v4
  v_lshlrev_b32 v3, 16, v2
  v_and_b32 v4, 0xffff0000, v2
  v_add_f32 v0, v0, v3
  v_add_f32 v0, v0, v4
  s_nop 1
  v_add_f32_dpp v0, v0, v0 row_ror:1 row_mask:0xf bank_mask:0xf
  s_nop 1
  v_add_f32_dpp v0, v0, v0 row_ror:2 row_mask:0xf bank_mask:0xf
  s_nop 1
  v_add_f32_dpp v0, v0, v0 row_ror:4 row_mask:0xf bank_mask:0xf
  s_nop 1
  v_add_f32_dpp v0, v0, v0 row_ror:8 row_mask:0xf bank_mask:0xf
  v_cvt_pk_bf16_f32 v0, v0, v0
  v_lshlrev_b32 v0, 16, v0
  v_mul_f32 v0, 3216550459, v0
  v_exp_f32 v0, v0
  s_nop 0
  v_add_f32 v0, 1.0, v0
  v_rcp_f32 v0, v0
  s_nop 0
  v_cvt_pk_bf16_f32 v0, v0, v0
  v_lshlrev_b32 v0, 16, v0
  v_lshlrev_b32 v212, 2, v212
  s_lshl_b32 s55, s70, 4
  s_add_u32 s55, s55, 67108864
  s_mov_b32 exec_lo, 0x00010001
  s_mov_b32 exec_hi, 0x00010001
  buffer_store_dword v0, v212, s[8:11], s55 offen sc1
  s_mov_b64 exec, -1
  v_lshrrev_b32 v211, 4, v200
  v_lshlrev_b32 v212, 2, v211
  v_and_b32 v213, 15, v200
  v_xor_b32 v212, v212, v213
  v_mul_u32_u24 v211, 3456, v211
  v_mov_b32 v2, 0x40000000
  v_add_u32 v213, 0, v212
  v_mul_u32_u24 v214, 57, v213
  v_lshrrev_b32 v214, 9, v214
  v_mul_u32_u24 v214, 1008, v214
  v_lshl_add_u32 v214, v213, 4, v214
  v_add_u32 v214, v214, v211
  v_cmp_lt_u32 vcc, 26, v213
  s_nop 1
  v_cndmask_b32 v207, v214, v2, vcc
  v_add_u32 v213, 16, v212
  v_mul_u32_u24 v214, 57, v213
  v_lshrrev_b32 v214, 9, v214
  v_mul_u32_u24 v214, 1008, v214
  v_lshl_add_u32 v214, v213, 4, v214
  v_add_u32 v214, v214, v211
  v_cmp_lt_u32 vcc, 26, v213
  s_nop 1
  v_cndmask_b32 v208, v214, v2, vcc
  s_mul_i32 s62, s68, 144
  s_mul_i32 s54, s52, 13824
  s_add_u32 s62, s62, s54
  s_waitcnt vmcnt(0)
  s_lshl_b32 s61, s52, 10
  s_add_u32 s61, s61, 36864
  s_add_u32 m0, s61, 0
  s_add_u32 s54, s62, 0
  buffer_load_dwordx4 v207, s[36:39], s54 offen lds
  s_add_u32 m0, s61, 4096
  s_add_u32 s54, s62, 55296
  buffer_load_dwordx4 v207, s[36:39], s54 offen lds
  s_add_u32 m0, s61, 8192
  s_add_u32 s54, s62, 110592
  buffer_load_dwordx4 v207, s[36:39], s54 offen lds
  s_add_u32 m0, s61, 12288
  s_add_u32 s54, s62, 165888
  buffer_load_dwordx4 v207, s[36:39], s54 offen lds
  s_add_u32 m0, s61, 16384
  s_add_u32 s54, s62, 0
  buffer_load_dwordx4 v208, s[36:39], s54 offen lds
  s_add_u32 m0, s61, 20480
  s_add_u32 s54, s62, 55296
  buffer_load_dwordx4 v208, s[36:39], s54 offen lds
  s_add_u32 m0, s61, 24576
  s_add_u32 s54, s62, 110592
  buffer_load_dwordx4 v208, s[36:39], s54 offen lds
  s_add_u32 m0, s61, 28672
  s_add_u32 s54, s62, 165888
  buffer_load_dwordx4 v208, s[36:39], s54 offen lds
  s_add_u32 m0, s61, 32768
  s_add_u32 s54, s62, 221184
  buffer_load_dwordx4 v207, s[36:39], s54 offen lds
  s_add_u32 m0, s61, 36864
  s_add_u32 s54, s62, 276480
  buffer_load_dwordx4 v207, s[36:39], s54 offen lds
  s_add_u32 m0, s61, 40960
  s_add_u32 s54, s62, 331776
  buffer_load_dwordx4 v207, s[36:39], s54 offen lds
  s_add_u32 m0, s61, 45056
  s_add_u32 s54, s62, 387072
  buffer_load_dwordx4 v207, s[36:39], s54 offen lds
  s_add_u32 m0, s61, 49152
  s_add_u32 s54, s62, 221184
  buffer_load_dwordx4 v208, s[36:39], s54 offen lds
  s_add_u32 m0, s61, 53248
  s_add_u32 s54, s62, 276480
  buffer_load_dwordx4 v208, s[36:39], s54 offen lds
  s_add_u32 m0, s61, 57344
  s_add_u32 s54, s62, 331776
  buffer_load_dwordx4 v208, s[36:39], s54 offen lds
  s_add_u32 m0, s61, 61440
  s_add_u32 s54, s62, 387072
  buffer_load_dwordx4 v208, s[36:39], s54 offen lds
  s_add_u32 m0, s61, 65536
  s_add_u32 s54, s62, 442368
  buffer_load_dwordx4 v207, s[36:39], s54 offen lds
  s_add_u32 m0, s61, 69632
  s_add_u32 s54, s62, 497664
  buffer_load_dwordx4 v207, s[36:39], s54 offen lds
  s_add_u32 m0, s61, 73728
  s_add_u32 s54, s62, 552960
  buffer_load_dwordx4 v207, s[36:39], s54 offen lds
  s_add_u32 m0, s61, 77824
  s_add_u32 s54, s62, 608256
  buffer_load_dwordx4 v207, s[36:39], s54 offen lds
  s_add_u32 m0, s61, 81920
  s_add_u32 s54, s62, 442368
  buffer_load_dwordx4 v208, s[36:39], s54 offen lds
  s_add_u32 m0, s61, 86016
  s_add_u32 s54, s62, 497664
  buffer_load_dwordx4 v208, s[36:39], s54 offen lds
  s_add_u32 m0, s61, 90112
  s_add_u32 s54, s62, 552960
  buffer_load_dwordx4 v208, s[36:39], s54 offen lds
  s_add_u32 m0, s61, 94208
  s_add_u32 s54, s62, 608256
  buffer_load_dwordx4 v208, s[36:39], s54 offen lds
  s_waitcnt vmcnt(20) lgkmcnt(0)
  s_barrier
  s_add_u32 m0, s61, 98304
  s_add_u32 s54, s62, 663552
  buffer_load_dwordx4 v207, s[36:39], s54 offen lds
  s_add_u32 m0, s61, 102400
  s_add_u32 s54, s62, 718848
  buffer_load_dwordx4 v207, s[36:39], s54 offen lds
  s_add_u32 m0, s61, 106496
  s_add_u32 s54, s62, 774144
  buffer_load_dwordx4 v207, s[36:39], s54 offen lds
  s_add_u32 m0, s61, 110592
  s_add_u32 s54, s62, 829440
  buffer_load_dwordx4 v207, s[36:39], s54 offen lds
  v_add_u32 v215, 36864, v210
  ds_read_b64_tr_b16 a[0:1], v215 offset:0
  ds_read_b64_tr_b16 a[2:3], v215 offset:1024
  ds_read_b64_tr_b16 a[4:5], v215 offset:4096
  ds_read_b64_tr_b16 a[6:7], v215 offset:5120
  ds_read_b64_tr_b16 a[8:9], v215 offset:8192
  ds_read_b64_tr_b16 a[10:11], v215 offset:9216
  ds_read_b64_tr_b16 a[12:13], v215 offset:12288
  ds_read_b64_tr_b16 a[14:15], v215 offset:13312
  s_waitcnt vmcnt(20) lgkmcnt(0)
  s_barrier
  s_add_u32 m0, s61, 0
  s_add_u32 s54, s62, 663552
  buffer_load_dwordx4 v208, s[36:39], s54 offen lds
  s_add_u32 m0, s61, 4096
  s_add_u32 s54, s62, 718848
  buffer_load_dwordx4 v208, s[36:39], s54 offen lds
  s_add_u32 m0, s61, 8192
  s_add_u32 s54, s62, 774144
  buffer_load_dwordx4 v208, s[36:39], s54 offen lds
  s_add_u32 m0, s61, 12288
  s_add_u32 s54, s62, 829440
  buffer_load_dwordx4 v208, s[36:39], s54 offen lds
  v_add_u32 v215, 53248, v210
  ds_read_b64_tr_b16 a[144:145], v215 offset:0
  ds_read_b64_tr_b16 a[146:147], v215 offset:1024
  ds_read_b64_tr_b16 a[148:149], v215 offset:4096
  ds_read_b64_tr_b16 a[150:151], v215 offset:5120
  ds_read_b64_tr_b16 a[152:153], v215 offset:8192
  ds_read_b64_tr_b16 a[154:155], v215 offset:9216
  ds_read_b64_tr_b16 a[156:157], v215 offset:12288
  ds_read_b64_tr_b16 a[158:159], v215 offset:13312
  s_waitcnt vmcnt(20) lgkmcnt(0)
  s_barrier
  s_add_u32 m0, s61, 16384
  s_add_u32 s54, s62, 884736
  buffer_load_dwordx4 v207, s[36:39], s54 offen lds
  s_add_u32 m0, s61, 20480
  s_add_u32 s54, s62, 940032
  buffer_load_dwordx4 v207, s[36:39], s54 offen lds
  s_add_u32 m0, s61, 24576
  s_add_u32 s54, s62, 995328
  buffer_load_dwordx4 v207, s[36:39], s54 offen lds
  s_add_u32 m0, s61, 28672
  s_add_u32 s54, s62, 1050624
  buffer_load_dwordx4 v207, s[36:39], s54 offen lds
  v_add_u32 v215, 69632, v210
  ds_read_b64_tr_b16 a[16:17], v215 offset:0
  ds_read_b64_tr_b16 a[18:19], v215 offset:1024
  ds_read_b64_tr_b16 a[20:21], v215 offset:4096
  ds_read_b64_tr_b16 a[22:23], v215 offset:5120
  ds_read_b64_tr_b16 a[24:25], v215 offset:8192
  ds_read_b64_tr_b16 a[26:27], v215 offset:9216
  ds_read_b64_tr_b16 a[28:29], v215 offset:12288
  ds_read_b64_tr_b16 a[30:31], v215 offset:13312
  s_waitcnt vmcnt(20) lgkmcnt(0)
  s_barrier
  s_add_u32 m0, s61, 32768
  s_add_u32 s54, s62, 884736
  buffer_load_dwordx4 v208, s[36:39], s54 offen lds
  s_add_u32 m0, s61, 36864
  s_add_u32 s54, s62, 940032
  buffer_load_dwordx4 v208, s[36:39], s54 offen lds
  s_add_u32 m0, s61, 40960
  s_add_u32 s54, s62, 995328
  buffer_load_dwordx4 v208, s[36:39], s54 offen lds
  s_add_u32 m0, s61, 45056
  s_add_u32 s54, s62, 1050624
  buffer_load_dwordx4 v208, s[36:39], s54 offen lds
  v_add_u32 v215, 86016, v210
  ds_read_b64_tr_b16 a[160:161], v215 offset:0
  ds_read_b64_tr_b16 a[162:163], v215 offset:1024
  ds_read_b64_tr_b16 a[164:165], v215 offset:4096
  ds_read_b64_tr_b16 a[166:167], v215 offset:5120
  ds_read_b64_tr_b16 a[168:169], v215 offset:8192
  ds_read_b64_tr_b16 a[170:171], v215 offset:9216
  ds_read_b64_tr_b16 a[172:173], v215 offset:12288
  ds_read_b64_tr_b16 a[174:175], v215 offset:13312
  s_waitcnt vmcnt(20) lgkmcnt(0)
  s_barrier
  s_add_u32 m0, s61, 49152
  s_add_u32 s54, s62, 1105920
  buffer_load_dwordx4 v207, s[36:39], s54 offen lds
  s_add_u32 m0, s61, 53248
  s_add_u32 s54, s62, 1161216
  buffer_load_dwordx4 v207, s[36:39], s54 offen lds
  s_add_u32 m0, s61, 57344
  s_add_u32 s54, s62, 1216512
  buffer_load_dwordx4 v207, s[36:39], s54 offen lds
  s_add_u32 m0, s61, 61440
  s_add_u32 s54, s62, 1271808
  buffer_load_dwordx4 v207, s[36:39], s54 offen lds
  v_add_u32 v215, 102400, v210
  ds_read_b64_tr_b16 a[32:33], v215 offset:0
  ds_read_b64_tr_b16 a[34:35], v215 offset:1024
  ds_read_b64_tr_b16 a[36:37], v215 offset:4096
  ds_read_b64_tr_b16 a[38:39], v215 offset:5120
  ds_read_b64_tr_b16 a[40:41], v215 offset:8192
  ds_read_b64_tr_b16 a[42:43], v215 offset:9216
  ds_read_b64_tr_b16 a[44:45], v215 offset:12288
  ds_read_b64_tr_b16 a[46:47], v215 offset:13312
  s_waitcnt vmcnt(20) lgkmcnt(0)
  s_barrier
  s_add_u32 m0, s61, 65536
  s_add_u32 s54, s62, 1105920
  buffer_load_dwordx4 v208, s[36:39], s54 offen lds
  s_add_u32 m0, s61, 69632
  s_add_u32 s54, s62, 1161216
  buffer_load_dwordx4 v208, s[36:39], s54 offen lds
  s_add_u32 m0, s61, 73728
  s_add_u32 s54, s62, 1216512
  buffer_load_dwordx4 v208, s[36:39], s54 offen lds
  s_add_u32 m0, s61, 77824
  s_add_u32 s54, s62, 1271808
  buffer_load_dwordx4 v208, s[36:39], s54 offen lds
  v_add_u32 v215, 118784, v210
  ds_read_b64_tr_b16 a[176:177], v215 offset:0
  ds_read_b64_tr_b16 a[178:179], v215 offset:1024
  ds_read_b64_tr_b16 a[180:181], v215 offset:4096
  ds_read_b64_tr_b16 a[182:183], v215 offset:5120
  ds_read_b64_tr_b16 a[184:185], v215 offset:8192
  ds_read_b64_tr_b16 a[186:187], v215 offset:9216
  ds_read_b64_tr_b16 a[188:189], v215 offset:12288
  ds_read_b64_tr_b16 a[190:191], v215 offset:13312
  s_waitcnt vmcnt(20) lgkmcnt(0)
  s_barrier
  s_add_u32 m0, s61, 81920
  s_add_u32 s54, s62, 1327104
  buffer_load_dwordx4 v207, s[36:39], s54 offen lds
  s_add_u32 m0, s61, 86016
  s_add_u32 s54, s62, 1382400
  buffer_load_dwordx4 v207, s[36:39], s54 offen lds
  s_add_u32 m0, s61, 90112
  s_add_u32 s54, s62, 1437696
  buffer_load_dwordx4 v207, s[36:39], s54 offen lds
  s_add_u32 m0, s61, 94208
  s_add_u32 s54, s62, 1492992
  buffer_load_dwordx4 v207, s[36:39], s54 offen lds
  v_add_u32 v215, 135168, v210
  ds_read_b64_tr_b16 a[48:49], v215 offset:0
  ds_read_b64_tr_b16 a[50:51], v215 offset:1024
  ds_read_b64_tr_b16 a[52:53], v215 offset:4096
  ds_read_b64_tr_b16 a[54:55], v215 offset:5120
  ds_read_b64_tr_b16 a[56:57], v215 offset:8192
  ds_read_b64_tr_b16 a[58:59], v215 offset:9216
  ds_read_b64_tr_b16 a[60:61], v215 offset:12288
  ds_read_b64_tr_b16 a[62:63], v215 offset:13312
  s_waitcnt vmcnt(20) lgkmcnt(0)
  s_barrier
  s_add_u32 m0, s61, 98304
  s_add_u32 s54, s62, 1327104
  buffer_load_dwordx4 v208, s[36:39], s54 offen lds
  s_add_u32 m0, s61, 102400
  s_add_u32 s54, s62, 1382400
  buffer_load_dwordx4 v208, s[36:39], s54 offen lds
  s_add_u32 m0, s61, 106496
  s_add_u32 s54, s62, 1437696
  buffer_load_dwordx4 v208, s[36:39], s54 offen lds
  s_add_u32 m0, s61, 110592
  s_add_u32 s54, s62, 1492992
  buffer_load_dwordx4 v208, s[36:39], s54 offen lds
  v_add_u32 v215, 36864, v210
  ds_read_b64_tr_b16 a[192:193], v215 offset:0
  ds_read_b64_tr_b16 a[194:195], v215 offset:1024
  ds_read_b64_tr_b16 a[196:197], v215 offset:4096
  ds_read_b64_tr_b16 a[198:199], v215 offset:5120
  ds_read_b64_tr_b16 a[200:201], v215 offset:8192
  ds_read_b64_tr_b16 a[202:203], v215 offset:9216
  ds_read_b64_tr_b16 a[204:205], v215 offset:12288
  ds_read_b64_tr_b16 a[206:207], v215 offset:13312
  s_waitcnt vmcnt(20) lgkmcnt(0)
  s_barrier
  s_add_u32 m0, s61, 0
  s_add_u32 s54, s62, 1548288
  buffer_load_dwordx4 v207, s[36:39], s54 offen lds
  s_add_u32 m0, s61, 4096
  s_add_u32 s54, s62, 1603584
  buffer_load_dwordx4 v207, s[36:39], s54 offen lds
  s_add_u32 m0, s61, 8192
  s_add_u32 s54, s62, 1658880
  buffer_load_dwordx4 v207, s[36:39], s54 offen lds
  s_add_u32 m0, s61, 12288
  s_add_u32 s54, s62, 1714176
  buffer_load_dwordx4 v207, s[36:39], s54 offen lds
  v_add_u32 v215, 53248, v210
  ds_read_b64_tr_b16 a[64:65], v215 offset:0
  ds_read_b64_tr_b16 a[66:67], v215 offset:1024
  ds_read_b64_tr_b16 a[68:69], v215 offset:4096
  ds_read_b64_tr_b16 a[70:71], v215 offset:5120
  ds_read_b64_tr_b16 a[72:73], v215 offset:8192
  ds_read_b64_tr_b16 a[74:75], v215 offset:9216
  ds_read_b64_tr_b16 a[76:77], v215 offset:12288
  ds_read_b64_tr_b16 a[78:79], v215 offset:13312
  s_waitcnt vmcnt(20) lgkmcnt(0)
  s_barrier
  s_add_u32 m0, s61, 16384
  s_add_u32 s54, s62, 1548288
  buffer_load_dwordx4 v208, s[36:39], s54 offen lds
  s_add_u32 m0, s61, 20480
  s_add_u32 s54, s62, 1603584
  buffer_load_dwordx4 v208, s[36:39], s54 offen lds
  s_add_u32 m0, s61, 24576
  s_add_u32 s54, s62, 1658880
  buffer_load_dwordx4 v208, s[36:39], s54 offen lds
  s_add_u32 m0, s61, 28672
  s_add_u32 s54, s62, 1714176
  buffer_load_dwordx4 v208, s[36:39], s54 offen lds
  v_add_u32 v215, 69632, v210
  ds_read_b64_tr_b16 a[208:209], v215 offset:0
  ds_read_b64_tr_b16 a[210:211], v215 offset:1024
  ds_read_b64_tr_b16 a[212:213], v215 offset:4096
  ds_read_b64_tr_b16 a[214:215], v215 offset:5120
  ds_read_b64_tr_b16 a[216:217], v215 offset:8192
  ds_read_b64_tr_b16 a[218:219], v215 offset:9216
  ds_read_b64_tr_b16 a[220:221], v215 offset:12288
  ds_read_b64_tr_b16 a[222:223], v215 offset:13312
  s_waitcnt vmcnt(20) lgkmcnt(0)
  s_barrier
  s_add_u32 m0, s61, 32768
  s_add_u32 s54, s62, 1769472
  buffer_load_dwordx4 v207, s[36:39], s54 offen lds
  s_add_u32 m0, s61, 36864
  s_add_u32 s54, s62, 1824768
  buffer_load_dwordx4 v207, s[36:39], s54 offen lds
  s_add_u32 m0, s61, 40960
  s_add_u32 s54, s62, 1880064
  buffer_load_dwordx4 v207, s[36:39], s54 offen lds
  s_add_u32 m0, s61, 45056
  s_add_u32 s54, s62, 1935360
  buffer_load_dwordx4 v207, s[36:39], s54 offen lds
  v_add_u32 v215, 86016, v210
  ds_read_b64_tr_b16 a[80:81], v215 offset:0
  ds_read_b64_tr_b16 a[82:83], v215 offset:1024
  ds_read_b64_tr_b16 a[84:85], v215 offset:4096
  ds_read_b64_tr_b16 a[86:87], v215 offset:5120
  ds_read_b64_tr_b16 a[88:89], v215 offset:8192
  ds_read_b64_tr_b16 a[90:91], v215 offset:9216
  ds_read_b64_tr_b16 a[92:93], v215 offset:12288
  ds_read_b64_tr_b16 a[94:95], v215 offset:13312
  s_waitcnt vmcnt(20) lgkmcnt(0)
  s_barrier
  s_add_u32 m0, s61, 49152
  s_add_u32 s54, s62, 1769472
  buffer_load_dwordx4 v208, s[36:39], s54 offen lds
  s_add_u32 m0, s61, 53248
  s_add_u32 s54, s62, 1824768
  buffer_load_dwordx4 v208, s[36:39], s54 offen lds
  s_add_u32 m0, s61, 57344
  s_add_u32 s54, s62, 1880064
  buffer_load_dwordx4 v208, s[36:39], s54 offen lds
  s_add_u32 m0, s61, 61440
  s_add_u32 s54, s62, 1935360
  buffer_load_dwordx4 v208, s[36:39], s54 offen lds
  v_add_u32 v215, 102400, v210
  ds_read_b64_tr_b16 a[224:225], v215 offset:0
  ds_read_b64_tr_b16 a[226:227], v215 offset:1024
  ds_read_b64_tr_b16 a[228:229], v215 offset:4096
  ds_read_b64_tr_b16 a[230:231], v215 offset:5120
  ds_read_b64_tr_b16 a[232:233], v215 offset:8192
  ds_read_b64_tr_b16 a[234:235], v215 offset:9216
  ds_read_b64_tr_b16 a[236:237], v215 offset:12288
  ds_read_b64_tr_b16 a[238:239], v215 offset:13312
  s_waitcnt vmcnt(20) lgkmcnt(0)
  s_barrier
  v_add_u32 v215, 118784, v210
  ds_read_b64_tr_b16 a[96:97], v215 offset:0
  ds_read_b64_tr_b16 a[98:99], v215 offset:1024
  ds_read_b64_tr_b16 a[100:101], v215 offset:4096
  ds_read_b64_tr_b16 a[102:103], v215 offset:5120
  ds_read_b64_tr_b16 a[104:105], v215 offset:8192
  ds_read_b64_tr_b16 a[106:107], v215 offset:9216
  ds_read_b64_tr_b16 a[108:109], v215 offset:12288
  ds_read_b64_tr_b16 a[110:111], v215 offset:13312
  s_waitcnt vmcnt(16) lgkmcnt(0)
  s_barrier
  v_add_u32 v215, 135168, v210
  ds_read_b64_tr_b16 a[240:241], v215 offset:0
  ds_read_b64_tr_b16 a[242:243], v215 offset:1024
  ds_read_b64_tr_b16 a[244:245], v215 offset:4096
  ds_read_b64_tr_b16 a[246:247], v215 offset:5120
  ds_read_b64_tr_b16 a[248:249], v215 offset:8192
  ds_read_b64_tr_b16 a[250:251], v215 offset:9216
  ds_read_b64_tr_b16 a[252:253], v215 offset:12288
  ds_read_b64_tr_b16 a[254:255], v215 offset:13312
  s_waitcnt vmcnt(12) lgkmcnt(0)
  s_barrier
  v_add_u32 v215, 36864, v210
  ds_read_b64_tr_b16 a[112:113], v215 offset:0
  ds_read_b64_tr_b16 a[114:115], v215 offset:1024
  ds_read_b64_tr_b16 a[116:117], v215 offset:4096
  ds_read_b64_tr_b16 a[118:119], v215 offset:5120
  ds_read_b64_tr_b16 a[120:121], v215 offset:8192
  ds_read_b64_tr_b16 a[122:123], v215 offset:9216
  ds_read_b64_tr_b16 a[124:125], v215 offset:12288
  ds_read_b64_tr_b16 a[126:127], v215 offset:13312
  s_waitcnt vmcnt(8) lgkmcnt(0)
  s_barrier
  v_add_u32 v215, 53248, v210
  ds_read_b64_tr_b16 v[224:225], v215 offset:0
  ds_read_b64_tr_b16 v[226:227], v215 offset:1024
  ds_read_b64_tr_b16 v[228:229], v215 offset:4096
  ds_read_b64_tr_b16 v[230:231], v215 offset:5120
  ds_read_b64_tr_b16 v[232:233], v215 offset:8192
  ds_read_b64_tr_b16 v[234:235], v215 offset:9216
  ds_read_b64_tr_b16 v[236:237], v215 offset:12288
  ds_read_b64_tr_b16 v[238:239], v215 offset:13312
  s_waitcnt vmcnt(4) lgkmcnt(0)
  s_barrier
  v_add_u32 v215, 69632, v210
  ds_read_b64_tr_b16 a[128:129], v215 offset:0
  ds_read_b64_tr_b16 a[130:131], v215 offset:1024
  ds_read_b64_tr_b16 a[132:133], v215 offset:4096
  ds_read_b64_tr_b16 a[134:135], v215 offset:5120
  ds_read_b64_tr_b16 a[136:137], v215 offset:8192
  ds_read_b64_tr_b16 a[138:139], v215 offset:9216
  ds_read_b64_tr_b16 a[140:141], v215 offset:12288
  ds_read_b64_tr_b16 a[142:143], v215 offset:13312
  s_waitcnt vmcnt(0) lgkmcnt(0)
  s_barrier
  v_add_u32 v215, 86016, v210
  ds_read_b64_tr_b16 v[240:241], v215 offset:0
  ds_read_b64_tr_b16 v[242:243], v215 offset:1024
  ds_read_b64_tr_b16 v[244:245], v215 offset:4096
  ds_read_b64_tr_b16 v[246:247], v215 offset:5120
  ds_read_b64_tr_b16 v[248:249], v215 offset:8192
  ds_read_b64_tr_b16 v[250:251], v215 offset:9216
  ds_read_b64_tr_b16 v[252:253], v215 offset:12288
  ds_read_b64_tr_b16 v[254:255], v215 offset:13312
  s_waitcnt lgkmcnt(0)
  s_barrier
  v_and_b32 v211, 31, v200
  v_mul_u32_u24 v218, 516, v211
  v_lshrrev_b32 v212, 5, v200
  v_lshl_add_u32 v218, v212, 3, v218
  s_lshl_b32 s54, s52, 6
  s_add_u32 s54, s54, 73728
  v_add_u32 v218, s54, v218
  s_lshl_b32 s60, s69, 2
  s_mul_i32 s60, s60, 36864
  s_add_u32 m0, s67, 36864
  s_nop 0
  buffer_load_dwordx4 v202, s[4:7], s60 offen offset:0 lds
  s_add_u32 m0, s67, 37760
  s_nop 0
  buffer_load_dwordx4 v202, s[4:7], s60 offen offset:128 lds
  s_add_u32 m0, s67, 38656
  s_nop 0
  buffer_load_dwordx4 v202, s[4:7], s60 offen offset:256 lds
  s_add_u32 m0, s67, 39552
  s_nop 0
  buffer_load_dwordx4 v202, s[4:7], s60 offen offset:384 lds
  s_add_u32 m0, s67, 40448
  s_nop 0
  buffer_load_dwordx4 v202, s[4:7], s60 offen offset:512 lds
  s_add_u32 m0, s67, 41344
  s_nop 0
  buffer_load_dwordx4 v202, s[4:7], s60 offen offset:640 lds
  s_add_u32 m0, s67, 42240
  s_nop 0
  buffer_load_dwordx4 v202, s[4:7], s60 offen offset:768 lds
  s_add_u32 m0, s67, 43136
  s_nop 0
  buffer_load_dwordx4 v202, s[4:7], s60 offen offset:896 lds
  s_add_u32 m0, s67, 44032
  s_nop 0
  buffer_load_dwordx4 v202, s[4:7], s60 offen offset:1024 lds
  s_add_u32 s60, s60, 36864
  ds_read_b128 v[32:35], v203 offset:0
  ds_read_b128 v[36:39], v204 offset:0
  ds_read_b128 v[40:43], v205 offset:0
  s_waitcnt lgkmcnt(2)
  v_mfma_f32_32x32x16_bf16 v[0:15], a[0:3], v[32:35], 0
  ds_read_b128 v[44:47], v206 offset:0
  v_mfma_f32_32x32x16_bf16 v[16:31], a[144:147], v[32:35], 0
  s_waitcnt lgkmcnt(2)
  v_mfma_f32_32x32x16_bf16 v[0:15], a[4:7], v[36:39], v[0:15]
  ds_read_b128 v[32:35], v203 offset:1024
  v_mfma_f32_32x32x16_bf16 v[16:31], a[148:151], v[36:39], v[16:31]
  s_waitcnt lgkmcnt(2)
  v_mfma_f32_32x32x16_bf16 v[0:15], a[8:11], v[40:43], v[0:15]
  ds_read_b128 v[36:39], v204 offset:1024
  v_mfma_f32_32x32x16_bf16 v[16:31], a[152:155], v[40:43], v[16:31]
  s_waitcnt lgkmcnt(2)
  v_mfma_f32_32x32x16_bf16 v[0:15], a[12:15], v[44:47], v[0:15]
  ds_read_b128 v[40:43], v205 offset:1024
  v_mfma_f32_32x32x16_bf16 v[16:31], a[156:159], v[44:47], v[16:31]
  s_waitcnt lgkmcnt(2)
  v_mfma_f32_32x32x16_bf16 v[0:15], a[16:19], v[32:35], v[0:15]
  ds_read_b128 v[44:47], v206 offset:1024
  v_mfma_f32_32x32x16_bf16 v[16:31], a[160:163], v[32:35], v[16:31]
  s_waitcnt lgkmcnt(2)
  v_mfma_f32_32x32x16_bf16 v[0:15], a[20:23], v[36:39], v[0:15]
  ds_read_b128 v[32:35], v203 offset:2048
  v_mfma_f32_32x32x16_bf16 v[16:31], a[164:167], v[36:39], v[16:31]
  s_waitcnt lgkmcnt(2)
  v_mfma_f32_32x32x16_bf16 v[0:15], a[24:27], v[40:43], v[0:15]
  ds_read_b128 v[36:39], v204 offset:2048
  v_mfma_f32_32x32x16_bf16 v[16:31], a[168:171], v[40:43], v[16:31]
  s_waitcnt lgkmcnt(2)
  v_mfma_f32_32x32x16_bf16 v[0:15], a[28:31], v[44:47], v[0:15]
  ds_read_b128 v[40:43], v205 offset:2048
  v_mfma_f32_32x32x16_bf16 v[16:31], a[172:175], v[44:47], v[16:31]
  s_waitcnt lgkmcnt(2)
  v_mfma_f32_32x32x16_bf16 v[0:15], a[32:35], v[32:35], v[0:15]
  ds_read_b128 v[44:47], v206 offset:2048
  v_mfma_f32_32x32x16_bf16 v[16:31], a[176:179], v[32:35], v[16:31]
  s_waitcnt lgkmcnt(2)
  v_mfma_f32_32x32x16_bf16 v[0:15], a[36:39], v[36:39], v[0:15]
  ds_read_b128 v[32:35], v203 offset:3072
  v_mfma_f32_32x32x16_bf16 v[16:31], a[180:183], v[36:39], v[16:31]
  s_waitcnt lgkmcnt(2)
  v_mfma_f32_32x32x16_bf16 v[0:15], a[40:43], v[40:43], v[0:15]
  ds_read_b128 v[36:39], v204 offset:3072
  v_mfma_f32_32x32x16_bf16 v[16:31], a[184:187], v[40:43], v[16:31]
  s_waitcnt lgkmcnt(2)
  v_mfma_f32_32x32x16_bf16 v[0:15], a[44:47], v[44:47], v[0:15]
  ds_read_b128 v[40:43], v205 offset:3072
  v_mfma_f32_32x32x16_bf16 v[16:31], a[188:191], v[44:47], v[16:31]
  s_waitcnt lgkmcnt(2)
  v_mfma_f32_32x32x16_bf16 v[0:15], a[48:51], v[32:35], v[0:15]
  ds_read_b128 v[44:47], v206 offset:3072
  v_mfma_f32_32x32x16_bf16 v[16:31], a[192:195], v[32:35], v[16:31]
  s_waitcnt lgkmcnt(2)
  v_mfma_f32_32x32x16_bf16 v[0:15], a[52:55], v[36:39], v[0:15]
  ds_read_b128 v[32:35], v203 offset:4096
  v_mfma_f32_32x32x16_bf16 v[16:31], a[196:199], v[36:39], v[16:31]
  s_waitcnt lgkmcnt(2)
  v_mfma_f32_32x32x16_bf16 v[0:15], a[56:59], v[40:43], v[0:15]
  ds_read_b128 v[36:39], v204 offset:4096
  v_mfma_f32_32x32x16_bf16 v[16:31], a[200:203], v[40:43], v[16:31]
  s_waitcnt lgkmcnt(2)
  v_mfma_f32_32x32x16_bf16 v[0:15], a[60:63], v[44:47], v[0:15]
  ds_read_b128 v[40:43], v205 offset:4096
  v_mfma_f32_32x32x16_bf16 v[16:31], a[204:207], v[44:47], v[16:31]
  s_waitcnt lgkmcnt(2)
  v_mfma_f32_32x32x16_bf16 v[0:15], a[64:67], v[32:35], v[0:15]
  ds_read_b128 v[44:47], v206 offset:4096
  v_mfma_f32_32x32x16_bf16 v[16:31], a[208:211], v[32:35], v[16:31]
  s_waitcnt lgkmcnt(2)
  v_mfma_f32_32x32x16_bf16 v[0:15], a[68:71], v[36:39], v[0:15]
  ds_read_b128 v[32:35], v203 offset:5120
  v_mfma_f32_32x32x16_bf16 v[16:31], a[212:215], v[36:39], v[16:31]
  s_waitcnt lgkmcnt(2)
  v_mfma_f32_32x32x16_bf16 v[0:15], a[72:75], v[40:43], v[0:15]
  ds_read_b128 v[36:39], v204 offset:5120
  v_mfma_f32_32x32x16_bf16 v[16:31], a[216:219], v[40:43], v[16:31]
  s_waitcnt lgkmcnt(2)
  v_mfma_f32_32x32x16_bf16 v[0:15], a[76:79], v[44:47], v[0:15]
  ds_read_b128 v[40:43], v205 offset:5120
  v_mfma_f32_32x32x16_bf16 v[16:31], a[220:223], v[44:47], v[16:31]
  s_waitcnt lgkmcnt(2)
  v_mfma_f32_32x32x16_bf16 v[0:15], a[80:83], v[32:35], v[0:15]
  ds_read_b128 v[44:47], v206 offset:5120
  v_mfma_f32_32x32x16_bf16 v[16:31], a[224:227], v[32:35], v[16:31]
  s_waitcnt lgkmcnt(2)
  v_mfma_f32_32x32x16_bf16 v[0:15], a[84:87], v[36:39], v[0:15]
  ds_read_b128 v[32:35], v203 offset:6144
  v_mfma_f32_32x32x16_bf16 v[16:31], a[228:231], v[36:39], v[16:31]
  s_waitcnt lgkmcnt(2)
  v_mfma_f32_32x32x16_bf16 v[0:15], a[88:91], v[40:43], v[0:15]
  ds_read_b128 v[36:39], v204 offset:6144
  v_mfma_f32_32x32x16_bf16 v[16:31], a[232:235], v[40:43], v[16:31]
  s_waitcnt lgkmcnt(2)
  v_mfma_f32_32x32x16_bf16 v[0:15], a[92:95], v[44:47], v[0:15]
  ds_read_b128 v[40:43], v205 offset:6144
  v_mfma_f32_32x32x16_bf16 v[16:31], a[236:239], v[44:47], v[16:31]
  s_waitcnt lgkmcnt(2)
  v_mfma_f32_32x32x16_bf16 v[0:15], a[96:99], v[32:35], v[0:15]
  ds_read_b128 v[44:47], v206 offset:6144
  v_mfma_f32_32x32x16_bf16 v[16:31], a[240:243], v[32:35], v[16:31]
  s_waitcnt lgkmcnt(2)
  v_mfma_f32_32x32x16_bf16 v[0:15], a[100:103], v[36:39], v[0:15]
  ds_read_b128 v[32:35], v203 offset:7168
  v_mfma_f32_32x32x16_bf16 v[16:31], a[244:247], v[36:39], v[16:31]
  s_waitcnt lgkmcnt(2)
  v_mfma_f32_32x32x16_bf16 v[0:15], a[104:107], v[40:43], v[0:15]
  ds_read_b128 v[36:39], v204 offset:7168
  v_mfma_f32_32x32x16_bf16 v[16:31], a[248:251], v[40:43], v[16:31]
  s_waitcnt lgkmcnt(2)
  v_mfma_f32_32x32x16_bf16 v[0:15], a[108:111], v[44:47], v[0:15]
  ds_read_b128 v[40:43], v205 offset:7168
  v_mfma_f32_32x32x16_bf16 v[16:31], a[252:255], v[44:47], v[16:31]
  s_waitcnt lgkmcnt(2)
  v_mfma_f32_32x32x16_bf16 v[0:15], a[112:115], v[32:35], v[0:15]
  ds_read_b128 v[44:47], v206 offset:7168
  v_mfma_f32_32x32x16_bf16 v[16:31], v[224:227], v[32:35], v[16:31]
  s_waitcnt lgkmcnt(2)
  v_mfma_f32_32x32x16_bf16 v[0:15], a[116:119], v[36:39], v[0:15]
  ds_read_b128 v[32:35], v203 offset:8192
  v_mfma_f32_32x32x16_bf16 v[16:31], v[228:231], v[36:39], v[16:31]
  s_waitcnt lgkmcnt(2)
  v_mfma_f32_32x32x16_bf16 v[0:15], a[120:123], v[40:43], v[0:15]
  ds_read_b128 v[36:39], v204 offset:8192
  v_mfma_f32_32x32x16_bf16 v[16:31], v[232:235], v[40:43], v[16:31]
  s_waitcnt lgkmcnt(2)
  v_mfma_f32_32x32x16_bf16 v[0:15], a[124:127], v[44:47], v[0:15]
  ds_read_b128 v[40:43], v205 offset:8192
  v_mfma_f32_32x32x16_bf16 v[16:31], v[236:239], v[44:47], v[16:31]
  s_waitcnt lgkmcnt(2)
  v_mfma_f32_32x32x16_bf16 v[0:15], a[128:131], v[32:35], v[0:15]
  ds_read_b128 v[44:47], v206 offset:8192
  v_mfma_f32_32x32x16_bf16 v[16:31], v[240:243], v[32:35], v[16:31]
  s_waitcnt lgkmcnt(2)
  v_mfma_f32_32x32x16_bf16 v[0:15], a[132:135], v[36:39], v[0:15]
  v_mfma_f32_32x32x16_bf16 v[16:31], v[244:247], v[36:39], v[16:31]
  s_waitcnt lgkmcnt(1)
  v_mfma_f32_32x32x16_bf16 v[0:15], a[136:139], v[40:43], v[0:15]
  v_mfma_f32_32x32x16_bf16 v[16:31], v[248:251], v[40:43], v[16:31]
  s_waitcnt lgkmcnt(0)
  v_mfma_f32_32x32x16_bf16 v[0:15], a[140:143], v[44:47], v[0:15]
  v_mfma_f32_32x32x16_bf16 v[16:31], v[252:255], v[44:47], v[16:31]
  s_nop 3
  v_cvt_pk_bf16_f32 v48, v0, v1
  v_cvt_pk_bf16_f32 v49, v2, v3
  ds_write2_b32 v218, v48, v49 offset0:0 offset1:1
  v_cvt_pk_bf16_f32 v48, v4, v5
  v_cvt_pk_bf16_f32 v49, v6, v7
  ds_write2_b32 v218, v48, v49 offset0:4 offset1:5
  v_cvt_pk_bf16_f32 v48, v8, v9
  v_cvt_pk_bf16_f32 v49, v10, v11
  ds_write2_b32 v218, v48, v49 offset0:8 offset1:9
  v_cvt_pk_bf16_f32 v48, v12, v13
  v_cvt_pk_bf16_f32 v49, v14, v15
  ds_write2_b32 v218, v48, v49 offset0:12 offset1:13
  v_cvt_pk_bf16_f32 v48, v16, v17
  v_cvt_pk_bf16_f32 v49, v18, v19
  ds_write2_b32 v218, v48, v49 offset0:64 offset1:65
  v_cvt_pk_bf16_f32 v48, v20, v21
  v_cvt_pk_bf16_f32 v49, v22, v23
  ds_write2_b32 v218, v48, v49 offset0:68 offset1:69
  v_cvt_pk_bf16_f32 v48, v24, v25
  v_cvt_pk_bf16_f32 v49, v26, v27
  ds_write2_b32 v218, v48, v49 offset0:72 offset1:73
  v_cvt_pk_bf16_f32 v48, v28, v29
  v_cvt_pk_bf16_f32 v49, v30, v31
  ds_write2_b32 v218, v48, v49 offset0:76 offset1:77
  v_add_u32 v218, 16512, v218
  s_waitcnt vmcnt(0) lgkmcnt(0)
  s_barrier
  s_add_u32 m0, s67, 0
  s_nop 0
  buffer_load_dwordx4 v202, s[4:7], s60 offen offset:0 lds
  s_add_u32 m0, s67, 896
  s_nop 0
  buffer_load_dwordx4 v202, s[4:7], s60 offen offset:128 lds
  s_add_u32 m0, s67, 1792
  s_nop 0
  buffer_load_dwordx4 v202, s[4:7], s60 offen offset:256 lds
  s_add_u32 m0, s67, 2688
  s_nop 0
  buffer_load_dwordx4 v202, s[4:7], s60 offen offset:384 lds
  s_add_u32 m0, s67, 3584
  s_nop 0
  buffer_load_dwordx4 v202, s[4:7], s60 offen offset:512 lds
  s_add_u32 m0, s67, 4480
  s_nop 0
  buffer_load_dwordx4 v202, s[4:7], s60 offen offset:640 lds
  s_add_u32 m0, s67, 5376
  s_nop 0
  buffer_load_dwordx4 v202, s[4:7], s60 offen offset:768 lds
  s_add_u32 m0, s67, 6272
  s_nop 0
  buffer_load_dwordx4 v202, s[4:7], s60 offen offset:896 lds
  s_add_u32 m0, s67, 7168
  s_nop 0
  buffer_load_dwordx4 v202, s[4:7], s60 offen offset:1024 lds
  s_add_u32 s60, s60, 36864
  ds_read_b128 v[32:35], v203 offset:36864
  ds_read_b128 v[36:39], v204 offset:36864
  ds_read_b128 v[40:43], v205 offset:36864
  s_waitcnt lgkmcnt(2)
  v_mfma_f32_32x32x16_bf16 v[0:15], a[0:3], v[32:35], 0
  ds_read_b128 v[44:47], v206 offset:36864
  v_mfma_f32_32x32x16_bf16 v[16:31], a[144:147], v[32:35], 0
  s_waitcnt lgkmcnt(2)
  v_mfma_f32_32x32x16_bf16 v[0:15], a[4:7], v[36:39], v[0:15]
  ds_read_b128 v[32:35], v203 offset:37888
  v_mfma_f32_32x32x16_bf16 v[16:31], a[148:151], v[36:39], v[16:31]
  s_waitcnt lgkmcnt(2)
  v_mfma_f32_32x32x16_bf16 v[0:15], a[8:11], v[40:43], v[0:15]
  ds_read_b128 v[36:39], v204 offset:37888
  v_mfma_f32_32x32x16_bf16 v[16:31], a[152:155], v[40:43], v[16:31]
  s_waitcnt lgkmcnt(2)
  v_mfma_f32_32x32x16_bf16 v[0:15], a[12:15], v[44:47], v[0:15]
  ds_read_b128 v[40:43], v205 offset:37888
  v_mfma_f32_32x32x16_bf16 v[16:31], a[156:159], v[44:47], v[16:31]
  s_waitcnt lgkmcnt(2)
  v_mfma_f32_32x32x16_bf16 v[0:15], a[16:19], v[32:35], v[0:15]
  ds_read_b128 v[44:47], v206 offset:37888
  v_mfma_f32_32x32x16_bf16 v[16:31], a[160:163], v[32:35], v[16:31]
  s_waitcnt lgkmcnt(2)
  v_mfma_f32_32x32x16_bf16 v[0:15], a[20:23], v[36:39], v[0:15]
  ds_read_b128 v[32:35], v203 offset:38912
  v_mfma_f32_32x32x16_bf16 v[16:31], a[164:167], v[36:39], v[16:31]
  s_waitcnt lgkmcnt(2)
  v_mfma_f32_32x32x16_bf16 v[0:15], a[24:27], v[40:43], v[0:15]
  ds_read_b128 v[36:39], v204 offset:38912
  v_mfma_f32_32x32x16_bf16 v[16:31], a[168:171], v[40:43], v[16:31]
  s_waitcnt lgkmcnt(2)
  v_mfma_f32_32x32x16_bf16 v[0:15], a[28:31], v[44:47], v[0:15]
  ds_read_b128 v[40:43], v205 offset:38912
  v_mfma_f32_32x32x16_bf16 v[16:31], a[172:175], v[44:47], v[16:31]
  s_waitcnt lgkmcnt(2)
  v_mfma_f32_32x32x16_bf16 v[0:15], a[32:35], v[32:35], v[0:15]
  ds_read_b128 v[44:47], v206 offset:38912
  v_mfma_f32_32x32x16_bf16 v[16:31], a[176:179], v[32:35], v[16:31]
  s_waitcnt lgkmcnt(2)
  v_mfma_f32_32x32x16_bf16 v[0:15], a[36:39], v[36:39], v[0:15]
  ds_read_b128 v[32:35], v203 offset:39936
  v_mfma_f32_32x32x16_bf16 v[16:31], a[180:183], v[36:39], v[16:31]
  s_waitcnt lgkmcnt(2)
  v_mfma_f32_32x32x16_bf16 v[0:15], a[40:43], v[40:43], v[0:15]
  ds_read_b128 v[36:39], v204 offset:39936
  v_mfma_f32_32x32x16_bf16 v[16:31], a[184:187], v[40:43], v[16:31]
  s_waitcnt lgkmcnt(2)
  v_mfma_f32_32x32x16_bf16 v[0:15], a[44:47], v[44:47], v[0:15]
  ds_read_b128 v[40:43], v205 offset:39936
  v_mfma_f32_32x32x16_bf16 v[16:31], a[188:191], v[44:47], v[16:31]
  s_waitcnt lgkmcnt(2)
  v_mfma_f32_32x32x16_bf16 v[0:15], a[48:51], v[32:35], v[0:15]
  ds_read_b128 v[44:47], v206 offset:39936
  v_mfma_f32_32x32x16_bf16 v[16:31], a[192:195], v[32:35], v[16:31]
  s_waitcnt lgkmcnt(2)
  v_mfma_f32_32x32x16_bf16 v[0:15], a[52:55], v[36:39], v[0:15]
  ds_read_b128 v[32:35], v203 offset:40960
  v_mfma_f32_32x32x16_bf16 v[16:31], a[196:199], v[36:39], v[16:31]
  s_waitcnt lgkmcnt(2)
  v_mfma_f32_32x32x16_bf16 v[0:15], a[56:59], v[40:43], v[0:15]
  ds_read_b128 v[36:39], v204 offset:40960
  v_mfma_f32_32x32x16_bf16 v[16:31], a[200:203], v[40:43], v[16:31]
  s_waitcnt lgkmcnt(2)
  v_mfma_f32_32x32x16_bf16 v[0:15], a[60:63], v[44:47], v[0:15]
  ds_read_b128 v[40:43], v205 offset:40960
  v_mfma_f32_32x32x16_bf16 v[16:31], a[204:207], v[44:47], v[16:31]
  s_waitcnt lgkmcnt(2)
  v_mfma_f32_32x32x16_bf16 v[0:15], a[64:67], v[32:35], v[0:15]
  ds_read_b128 v[44:47], v206 offset:40960
  v_mfma_f32_32x32x16_bf16 v[16:31], a[208:211], v[32:35], v[16:31]
  s_waitcnt lgkmcnt(2)
  v_mfma_f32_32x32x16_bf16 v[0:15], a[68:71], v[36:39], v[0:15]
  ds_read_b128 v[32:35], v203 offset:41984
  v_mfma_f32_32x32x16_bf16 v[16:31], a[212:215], v[36:39], v[16:31]
  s_waitcnt lgkmcnt(2)
  v_mfma_f32_32x32x16_bf16 v[0:15], a[72:75], v[40:43], v[0:15]
  ds_read_b128 v[36:39], v204 offset:41984
  v_mfma_f32_32x32x16_bf16 v[16:31], a[216:219], v[40:43], v[16:31]
  s_waitcnt lgkmcnt(2)
  v_mfma_f32_32x32x16_bf16 v[0:15], a[76:79], v[44:47], v[0:15]
  ds_read_b128 v[40:43], v205 offset:41984
  v_mfma_f32_32x32x16_bf16 v[16:31], a[220:223], v[44:47], v[16:31]
  s_waitcnt lgkmcnt(2)
  v_mfma_f32_32x32x16_bf16 v[0:15], a[80:83], v[32:35], v[0:15]
  ds_read_b128 v[44:47], v206 offset:41984
  v_mfma_f32_32x32x16_bf16 v[16:31], a[224:227], v[32:35], v[16:31]
  s_waitcnt lgkmcnt(2)
  v_mfma_f32_32x32x16_bf16 v[0:15], a[84:87], v[36:39], v[0:15]
  ds_read_b128 v[32:35], v203 offset:43008
  v_mfma_f32_32x32x16_bf16 v[16:31], a[228:231], v[36:39], v[16:31]
  s_waitcnt lgkmcnt(2)
  v_mfma_f32_32x32x16_bf16 v[0:15], a[88:91], v[40:43], v[0:15]
  ds_read_b128 v[36:39], v204 offset:43008
  v_mfma_f32_32x32x16_bf16 v[16:31], a[232:235], v[40:43], v[16:31]
  s_waitcnt lgkmcnt(2)
  v_mfma_f32_32x32x16_bf16 v[0:15], a[92:95], v[44:47], v[0:15]
  ds_read_b128 v[40:43], v205 offset:43008
  v_mfma_f32_32x32x16_bf16 v[16:31], a[236:239], v[44:47], v[16:31]
  s_waitcnt lgkmcnt(2)
  v_mfma_f32_32x32x16_bf16 v[0:15], a[96:99], v[32:35], v[0:15]
  ds_read_b128 v[44:47], v206 offset:43008
  v_mfma_f32_32x32x16_bf16 v[16:31], a[240:243], v[32:35], v[16:31]
  s_waitcnt lgkmcnt(2)
  v_mfma_f32_32x32x16_bf16 v[0:15], a[100:103], v[36:39], v[0:15]
  ds_read_b128 v[32:35], v203 offset:44032
  v_mfma_f32_32x32x16_bf16 v[16:31], a[244:247], v[36:39], v[16:31]
  s_waitcnt lgkmcnt(2)
  v_mfma_f32_32x32x16_bf16 v[0:15], a[104:107], v[40:43], v[0:15]
  ds_read_b128 v[36:39], v204 offset:44032
  v_mfma_f32_32x32x16_bf16 v[16:31], a[248:251], v[40:43], v[16:31]
  s_waitcnt lgkmcnt(2)
  v_mfma_f32_32x32x16_bf16 v[0:15], a[108:111], v[44:47], v[0:15]
  ds_read_b128 v[40:43], v205 offset:44032
  v_mfma_f32_32x32x16_bf16 v[16:31], a[252:255], v[44:47], v[16:31]
  s_waitcnt lgkmcnt(2)
  v_mfma_f32_32x32x16_bf16 v[0:15], a[112:115], v[32:35], v[0:15]
  ds_read_b128 v[44:47], v206 offset:44032
  v_mfma_f32_32x32x16_bf16 v[16:31], v[224:227], v[32:35], v[16:31]
  s_waitcnt lgkmcnt(2)
  v_mfma_f32_32x32x16_bf16 v[0:15], a[116:119], v[36:39], v[0:15]
  ds_read_b128 v[32:35], v203 offset:45056
  v_mfma_f32_32x32x16_bf16 v[16:31], v[228:231], v[36:39], v[16:31]
  s_waitcnt lgkmcnt(2)
  v_mfma_f32_32x32x16_bf16 v[0:15], a[120:123], v[40:43], v[0:15]
  ds_read_b128 v[36:39], v204 offset:45056
  v_mfma_f32_32x32x16_bf16 v[16:31], v[232:235], v[40:43], v[16:31]
  s_waitcnt lgkmcnt(2)
  v_mfma_f32_32x32x16_bf16 v[0:15], a[124:127], v[44:47], v[0:15]
  ds_read_b128 v[40:43], v205 offset:45056
  v_mfma_f32_32x32x16_bf16 v[16:31], v[236:239], v[44:47], v[16:31]
  s_waitcnt lgkmcnt(2)
  v_mfma_f32_32x32x16_bf16 v[0:15], a[128:131], v[32:35], v[0:15]
  ds_read_b128 v[44:47], v206 offset:45056
  v_mfma_f32_32x32x16_bf16 v[16:31], v[240:243], v[32:35], v[16:31]
  s_waitcnt lgkmcnt(2)
  v_mfma_f32_32x32x16_bf16 v[0:15], a[132:135], v[36:39], v[0:15]
  v_mfma_f32_32x32x16_bf16 v[16:31], v[244:247], v[36:39], v[16:31]
  s_waitcnt lgkmcnt(1)
  v_mfma_f32_32x32x16_bf16 v[0:15], a[136:139], v[40:43], v[0:15]
  v_mfma_f32_32x32x16_bf16 v[16:31], v[248:251], v[40:43], v[16:31]
  s_waitcnt lgkmcnt(0)
  v_mfma_f32_32x32x16_bf16 v[0:15], a[140:143], v[44:47], v[0:15]
  v_mfma_f32_32x32x16_bf16 v[16:31], v[252:255], v[44:47], v[16:31]
  s_nop 3
  v_cvt_pk_bf16_f32 v48, v0, v1
  v_cvt_pk_bf16_f32 v49, v2, v3
  ds_write2_b32 v218, v48, v49 offset0:0 offset1:1
  v_cvt_pk_bf16_f32 v48, v4, v5
  v_cvt_pk_bf16_f32 v49, v6, v7
  ds_write2_b32 v218, v48, v49 offset0:4 offset1:5
  v_cvt_pk_bf16_f32 v48, v8, v9
  v_cvt_pk_bf16_f32 v49, v10, v11
  ds_write2_b32 v218, v48, v49 offset0:8 offset1:9
  v_cvt_pk_bf16_f32 v48, v12, v13
  v_cvt_pk_bf16_f32 v49, v14, v15
  ds_write2_b32 v218, v48, v49 offset0:12 offset1:13
  v_cvt_pk_bf16_f32 v48, v16, v17
  v_cvt_pk_bf16_f32 v49, v18, v19
  ds_write2_b32 v218, v48, v49 offset0:64 offset1:65
  v_cvt_pk_bf16_f32 v48, v20, v21
  v_cvt_pk_bf16_f32 v49, v22, v23
  ds_write2_b32 v218, v48, v49 offset0:68 offset1:69
  v_cvt_pk_bf16_f32 v48, v24, v25
  v_cvt_pk_bf16_f32 v49, v26, v27
  ds_write2_b32 v218, v48, v49 offset0:72 offset1:73
  v_cvt_pk_bf16_f32 v48, v28, v29
  v_cvt_pk_bf16_f32 v49, v30, v31
  ds_write2_b32 v218, v48, v49 offset0:76 offset1:77
  v_add_u32 v218, 16512, v218
  s_waitcnt vmcnt(0) lgkmcnt(0)
  s_barrier
  s_add_u32 m0, s67, 36864
  s_nop 0
  buffer_load_dwordx4 v202, s[4:7], s60 offen offset:0 lds
  s_add_u32 m0, s67, 37760
  s_nop 0
  buffer_load_dwordx4 v202, s[4:7], s60 offen offset:128 lds
  s_add_u32 m0, s67, 38656
  s_nop 0
  buffer_load_dwordx4 v202, s[4:7], s60 offen offset:256 lds
  s_add_u32 m0, s67, 39552
  s_nop 0
  buffer_load_dwordx4 v202, s[4:7], s60 offen offset:384 lds
  s_add_u32 m0, s67, 40448
  s_nop 0
  buffer_load_dwordx4 v202, s[4:7], s60 offen offset:512 lds
  s_add_u32 m0, s67, 41344
  s_nop 0
  buffer_load_dwordx4 v202, s[4:7], s60 offen offset:640 lds
  s_add_u32 m0, s67, 42240
  s_nop 0
  buffer_load_dwordx4 v202, s[4:7], s60 offen offset:768 lds
  s_add_u32 m0, s67, 43136
  s_nop 0
  buffer_load_dwordx4 v202, s[4:7], s60 offen offset:896 lds
  s_add_u32 m0, s67, 44032
  s_nop 0
  buffer_load_dwordx4 v202, s[4:7], s60 offen offset:1024 lds
  s_add_u32 s60, s60, 36864
  ds_read_b128 v[32:35], v203 offset:0
  ds_read_b128 v[36:39], v204 offset:0
  ds_read_b128 v[40:43], v205 offset:0
  s_waitcnt lgkmcnt(2)
  v_mfma_f32_32x32x16_bf16 v[0:15], a[0:3], v[32:35], 0
  ds_read_b128 v[44:47], v206 offset:0
  v_mfma_f32_32x32x16_bf16 v[16:31], a[144:147], v[32:35], 0
  s_waitcnt lgkmcnt(2)
  v_mfma_f32_32x32x16_bf16 v[0:15], a[4:7], v[36:39], v[0:15]
  ds_read_b128 v[32:35], v203 offset:1024
  v_mfma_f32_32x32x16_bf16 v[16:31], a[148:151], v[36:39], v[16:31]
  s_waitcnt lgkmcnt(2)
  v_mfma_f32_32x32x16_bf16 v[0:15], a[8:11], v[40:43], v[0:15]
  ds_read_b128 v[36:39], v204 offset:1024
  v_mfma_f32_32x32x16_bf16 v[16:31], a[152:155], v[40:43], v[16:31]
  s_waitcnt lgkmcnt(2)
  v_mfma_f32_32x32x16_bf16 v[0:15], a[12:15], v[44:47], v[0:15]
  ds_read_b128 v[40:43], v205 offset:1024
  v_mfma_f32_32x32x16_bf16 v[16:31], a[156:159], v[44:47], v[16:31]
  s_waitcnt lgkmcnt(2)
  v_mfma_f32_32x32x16_bf16 v[0:15], a[16:19], v[32:35], v[0:15]
  ds_read_b128 v[44:47], v206 offset:1024
  v_mfma_f32_32x32x16_bf16 v[16:31], a[160:163], v[32:35], v[16:31]
  s_waitcnt lgkmcnt(2)
  v_mfma_f32_32x32x16_bf16 v[0:15], a[20:23], v[36:39], v[0:15]
  ds_read_b128 v[32:35], v203 offset:2048
  v_mfma_f32_32x32x16_bf16 v[16:31], a[164:167], v[36:39], v[16:31]
  s_waitcnt lgkmcnt(2)
  v_mfma_f32_32x32x16_bf16 v[0:15], a[24:27], v[40:43], v[0:15]
  ds_read_b128 v[36:39], v204 offset:2048
  v_mfma_f32_32x32x16_bf16 v[16:31], a[168:171], v[40:43], v[16:31]
  s_waitcnt lgkmcnt(2)
  v_mfma_f32_32x32x16_bf16 v[0:15], a[28:31], v[44:47], v[0:15]
  ds_read_b128 v[40:43], v205 offset:2048
  v_mfma_f32_32x32x16_bf16 v[16:31], a[172:175], v[44:47], v[16:31]
  s_waitcnt lgkmcnt(2)
  v_mfma_f32_32x32x16_bf16 v[0:15], a[32:35], v[32:35], v[0:15]
  ds_read_b128 v[44:47], v206 offset:2048
  v_mfma_f32_32x32x16_bf16 v[16:31], a[176:179], v[32:35], v[16:31]
  s_waitcnt lgkmcnt(2)
  v_mfma_f32_32x32x16_bf16 v[0:15], a[36:39], v[36:39], v[0:15]
  ds_read_b128 v[32:35], v203 offset:3072
  v_mfma_f32_32x32x16_bf16 v[16:31], a[180:183], v[36:39], v[16:31]
  s_waitcnt lgkmcnt(2)
  v_mfma_f32_32x32x16_bf16 v[0:15], a[40:43], v[40:43], v[0:15]
  ds_read_b128 v[36:39], v204 offset:3072
  v_mfma_f32_32x32x16_bf16 v[16:31], a[184:187], v[40:43], v[16:31]
  s_waitcnt lgkmcnt(2)
  v_mfma_f32_32x32x16_bf16 v[0:15], a[44:47], v[44:47], v[0:15]
  ds_read_b128 v[40:43], v205 offset:3072
  v_mfma_f32_32x32x16_bf16 v[16:31], a[188:191], v[44:47], v[16:31]
  s_waitcnt lgkmcnt(2)
  v_mfma_f32_32x32x16_bf16 v[0:15], a[48:51], v[32:35], v[0:15]
  ds_read_b128 v[44:47], v206 offset:3072
  v_mfma_f32_32x32x16_bf16 v[16:31], a[192:195], v[32:35], v[16:31]
  s_waitcnt lgkmcnt(2)
  v_mfma_f32_32x32x16_bf16 v[0:15], a[52:55], v[36:39], v[0:15]
  ds_read_b128 v[32:35], v203 offset:4096
  v_mfma_f32_32x32x16_bf16 v[16:31], a[196:199], v[36:39], v[16:31]
  s_waitcnt lgkmcnt(2)
  v_mfma_f32_32x32x16_bf16 v[0:15], a[56:59], v[40:43], v[0:15]
  ds_read_b128 v[36:39], v204 offset:4096
  v_mfma_f32_32x32x16_bf16 v[16:31], a[200:203], v[40:43], v[16:31]
  s_waitcnt lgkmcnt(2)
  v_mfma_f32_32x32x16_bf16 v[0:15], a[60:63], v[44:47], v[0:15]
  ds_read_b128 v[40:43], v205 offset:4096
  v_mfma_f32_32x32x16_bf16 v[16:31], a[204:207], v[44:47], v[16:31]
  s_waitcnt lgkmcnt(2)
  v_mfma_f32_32x32x16_bf16 v[0:15], a[64:67], v[32:35], v[0:15]
  ds_read_b128 v[44:47], v206 offset:4096
  v_mfma_f32_32x32x16_bf16 v[16:31], a[208:211], v[32:35], v[16:31]
  s_waitcnt lgkmcnt(2)
  v_mfma_f32_32x32x16_bf16 v[0:15], a[68:71], v[36:39], v[0:15]
  ds_read_b128 v[32:35], v203 offset:5120
  v_mfma_f32_32x32x16_bf16 v[16:31], a[212:215], v[36:39], v[16:31]
  s_waitcnt lgkmcnt(2)
  v_mfma_f32_32x32x16_bf16 v[0:15], a[72:75], v[40:43], v[0:15]
  ds_read_b128 v[36:39], v204 offset:5120
  v_mfma_f32_32x32x16_bf16 v[16:31], a[216:219], v[40:43], v[16:31]
  s_waitcnt lgkmcnt(2)
  v_mfma_f32_32x32x16_bf16 v[0:15], a[76:79], v[44:47], v[0:15]
  ds_read_b128 v[40:43], v205 offset:5120
  v_mfma_f32_32x32x16_bf16 v[16:31], a[220:223], v[44:47], v[16:31]
  s_waitcnt lgkmcnt(2)
  v_mfma_f32_32x32x16_bf16 v[0:15], a[80:83], v[32:35], v[0:15]
  ds_read_b128 v[44:47], v206 offset:5120
  v_mfma_f32_32x32x16_bf16 v[16:31], a[224:227], v[32:35], v[16:31]
  s_waitcnt lgkmcnt(2)
  v_mfma_f32_32x32x16_bf16 v[0:15], a[84:87], v[36:39], v[0:15]
  ds_read_b128 v[32:35], v203 offset:6144
  v_mfma_f32_32x32x16_bf16 v[16:31], a[228:231], v[36:39], v[16:31]
  s_waitcnt lgkmcnt(2)
  v_mfma_f32_32x32x16_bf16 v[0:15], a[88:91], v[40:43], v[0:15]
  ds_read_b128 v[36:39], v204 offset:6144
  v_mfma_f32_32x32x16_bf16 v[16:31], a[232:235], v[40:43], v[16:31]
  s_waitcnt lgkmcnt(2)
  v_mfma_f32_32x32x16_bf16 v[0:15], a[92:95], v[44:47], v[0:15]
  ds_read_b128 v[40:43], v205 offset:6144
  v_mfma_f32_32x32x16_bf16 v[16:31], a[236:239], v[44:47], v[16:31]
  s_waitcnt lgkmcnt(2)
  v_mfma_f32_32x32x16_bf16 v[0:15], a[96:99], v[32:35], v[0:15]
  ds_read_b128 v[44:47], v206 offset:6144
  v_mfma_f32_32x32x16_bf16 v[16:31], a[240:243], v[32:35], v[16:31]
  s_waitcnt lgkmcnt(2)
  v_mfma_f32_32x32x16_bf16 v[0:15], a[100:103], v[36:39], v[0:15]
  ds_read_b128 v[32:35], v203 offset:7168
  v_mfma_f32_32x32x16_bf16 v[16:31], a[244:247], v[36:39], v[16:31]
  s_waitcnt lgkmcnt(2)
  v_mfma_f32_32x32x16_bf16 v[0:15], a[104:107], v[40:43], v[0:15]
  ds_read_b128 v[36:39], v204 offset:7168
  v_mfma_f32_32x32x16_bf16 v[16:31], a[248:251], v[40:43], v[16:31]
  s_waitcnt lgkmcnt(2)
  v_mfma_f32_32x32x16_bf16 v[0:15], a[108:111], v[44:47], v[0:15]
  ds_read_b128 v[40:43], v205 offset:7168
  v_mfma_f32_32x32x16_bf16 v[16:31], a[252:255], v[44:47], v[16:31]
  s_waitcnt lgkmcnt(2)
  v_mfma_f32_32x32x16_bf16 v[0:15], a[112:115], v[32:35], v[0:15]
  ds_read_b128 v[44:47], v206 offset:7168
  v_mfma_f32_32x32x16_bf16 v[16:31], v[224:227], v[32:35], v[16:31]
  s_waitcnt lgkmcnt(2)
  v_mfma_f32_32x32x16_bf16 v[0:15], a[116:119], v[36:39], v[0:15]
  ds_read_b128 v[32:35], v203 offset:8192
  v_mfma_f32_32x32x16_bf16 v[16:31], v[228:231], v[36:39], v[16:31]
  s_waitcnt lgkmcnt(2)
  v_mfma_f32_32x32x16_bf16 v[0:15], a[120:123], v[40:43], v[0:15]
  ds_read_b128 v[36:39], v204 offset:8192
  v_mfma_f32_32x32x16_bf16 v[16:31], v[232:235], v[40:43], v[16:31]
  s_waitcnt lgkmcnt(2)
  v_mfma_f32_32x32x16_bf16 v[0:15], a[124:127], v[44:47], v[0:15]
  ds_read_b128 v[40:43], v205 offset:8192
  v_mfma_f32_32x32x16_bf16 v[16:31], v[236:239], v[44:47], v[16:31]
  s_waitcnt lgkmcnt(2)
  v_mfma_f32_32x32x16_bf16 v[0:15], a[128:131], v[32:35], v[0:15]
  ds_read_b128 v[44:47], v206 offset:8192
  v_mfma_f32_32x32x16_bf16 v[16:31], v[240:243], v[32:35], v[16:31]
  s_waitcnt lgkmcnt(2)
  v_mfma_f32_32x32x16_bf16 v[0:15], a[132:135], v[36:39], v[0:15]
  v_mfma_f32_32x32x16_bf16 v[16:31], v[244:247], v[36:39], v[16:31]
  s_waitcnt lgkmcnt(1)
  v_mfma_f32_32x32x16_bf16 v[0:15], a[136:139], v[40:43], v[0:15]
  v_mfma_f32_32x32x16_bf16 v[16:31], v[248:251], v[40:43], v[16:31]
  s_waitcnt lgkmcnt(0)
  v_mfma_f32_32x32x16_bf16 v[0:15], a[140:143], v[44:47], v[0:15]
  v_mfma_f32_32x32x16_bf16 v[16:31], v[252:255], v[44:47], v[16:31]
  s_nop 3
  v_cvt_pk_bf16_f32 v48, v0, v1
  v_cvt_pk_bf16_f32 v49, v2, v3
  ds_write2_b32 v218, v48, v49 offset0:0 offset1:1
  v_cvt_pk_bf16_f32 v48, v4, v5
  v_cvt_pk_bf16_f32 v49, v6, v7
  ds_write2_b32 v218, v48, v49 offset0:4 offset1:5
  v_cvt_pk_bf16_f32 v48, v8, v9
  v_cvt_pk_bf16_f32 v49, v10, v11
  ds_write2_b32 v218, v48, v49 offset0:8 offset1:9
  v_cvt_pk_bf16_f32 v48, v12, v13
  v_cvt_pk_bf16_f32 v49, v14, v15
  ds_write2_b32 v218, v48, v49 offset0:12 offset1:13
  v_cvt_pk_bf16_f32 v48, v16, v17
  v_cvt_pk_bf16_f32 v49, v18, v19
  ds_write2_b32 v218, v48, v49 offset0:64 offset1:65
  v_cvt_pk_bf16_f32 v48, v20, v21
  v_cvt_pk_bf16_f32 v49, v22, v23
  ds_write2_b32 v218, v48, v49 offset0:68 offset1:69
  v_cvt_pk_bf16_f32 v48, v24, v25
  v_cvt_pk_bf16_f32 v49, v26, v27
  ds_write2_b32 v218, v48, v49 offset0:72 offset1:73
  v_cvt_pk_bf16_f32 v48, v28, v29
  v_cvt_pk_bf16_f32 v49, v30, v31
  ds_write2_b32 v218, v48, v49 offset0:76 offset1:77
  v_add_u32 v218, 16512, v218
  s_waitcnt vmcnt(0) lgkmcnt(0)
  s_barrier
  s_add_u32 m0, s67, 0
  s_nop 0
  buffer_load_dwordx4 v202, s[4:7], s60 offen offset:0 lds
  s_add_u32 m0, s67, 896
  s_nop 0
  buffer_load_dwordx4 v202, s[4:7], s60 offen offset:128 lds
  s_add_u32 m0, s67, 1792
  s_nop 0
  buffer_load_dwordx4 v202, s[4:7], s60 offen offset:256 lds
  s_add_u32 m0, s67, 2688
  s_nop 0
  buffer_load_dwordx4 v202, s[4:7], s60 offen offset:384 lds
  s_add_u32 m0, s67, 3584
  s_nop 0
  buffer_load_dwordx4 v202, s[4:7], s60 offen offset:512 lds
  s_add_u32 m0, s67, 4480
  s_nop 0
  buffer_load_dwordx4 v202, s[4:7], s60 offen offset:640 lds
  s_add_u32 m0, s67, 5376
  s_nop 0
  buffer_load_dwordx4 v202, s[4:7], s60 offen offset:768 lds
  s_add_u32 m0, s67, 6272
  s_nop 0
  buffer_load_dwordx4 v202, s[4:7], s60 offen offset:896 lds
  s_add_u32 m0, s67, 7168
  s_nop 0
  buffer_load_dwordx4 v202, s[4:7], s60 offen offset:1024 lds
  s_add_u32 s60, s60, 36864
  ds_read_b128 v[32:35], v203 offset:36864
  ds_read_b128 v[36:39], v204 offset:36864
  ds_read_b128 v[40:43], v205 offset:36864
  s_waitcnt lgkmcnt(2)
  v_mfma_f32_32x32x16_bf16 v[0:15], a[0:3], v[32:35], 0
  ds_read_b128 v[44:47], v206 offset:36864
  v_mfma_f32_32x32x16_bf16 v[16:31], a[144:147], v[32:35], 0
  s_waitcnt lgkmcnt(2)
  v_mfma_f32_32x32x16_bf16 v[0:15], a[4:7], v[36:39], v[0:15]
  ds_read_b128 v[32:35], v203 offset:37888
  v_mfma_f32_32x32x16_bf16 v[16:31], a[148:151], v[36:39], v[16:31]
  s_waitcnt lgkmcnt(2)
  v_mfma_f32_32x32x16_bf16 v[0:15], a[8:11], v[40:43], v[0:15]
  ds_read_b128 v[36:39], v204 offset:37888
  v_mfma_f32_32x32x16_bf16 v[16:31], a[152:155], v[40:43], v[16:31]
  s_waitcnt lgkmcnt(2)
  v_mfma_f32_32x32x16_bf16 v[0:15], a[12:15], v[44:47], v[0:15]
  ds_read_b128 v[40:43], v205 offset:37888
  v_mfma_f32_32x32x16_bf16 v[16:31], a[156:159], v[44:47], v[16:31]
  s_waitcnt lgkmcnt(2)
  v_mfma_f32_32x32x16_bf16 v[0:15], a[16:19], v[32:35], v[0:15]
  ds_read_b128 v[44:47], v206 offset:37888
  v_mfma_f32_32x32x16_bf16 v[16:31], a[160:163], v[32:35], v[16:31]
  s_waitcnt lgkmcnt(2)
  v_mfma_f32_32x32x16_bf16 v[0:15], a[20:23], v[36:39], v[0:15]
  ds_read_b128 v[32:35], v203 offset:38912
  v_mfma_f32_32x32x16_bf16 v[16:31], a[164:167], v[36:39], v[16:31]
  s_waitcnt lgkmcnt(2)
  v_mfma_f32_32x32x16_bf16 v[0:15], a[24:27], v[40:43], v[0:15]
  ds_read_b128 v[36:39], v204 offset:38912
  v_mfma_f32_32x32x16_bf16 v[16:31], a[168:171], v[40:43], v[16:31]
  s_waitcnt lgkmcnt(2)
  v_mfma_f32_32x32x16_bf16 v[0:15], a[28:31], v[44:47], v[0:15]
  ds_read_b128 v[40:43], v205 offset:38912
  v_mfma_f32_32x32x16_bf16 v[16:31], a[172:175], v[44:47], v[16:31]
  s_waitcnt lgkmcnt(2)
  v_mfma_f32_32x32x16_bf16 v[0:15], a[32:35], v[32:35], v[0:15]
  ds_read_b128 v[44:47], v206 offset:38912
  v_mfma_f32_32x32x16_bf16 v[16:31], a[176:179], v[32:35], v[16:31]
  s_waitcnt lgkmcnt(2)
  v_mfma_f32_32x32x16_bf16 v[0:15], a[36:39], v[36:39], v[0:15]
  ds_read_b128 v[32:35], v203 offset:39936
  v_mfma_f32_32x32x16_bf16 v[16:31], a[180:183], v[36:39], v[16:31]
  s_waitcnt lgkmcnt(2)
  v_mfma_f32_32x32x16_bf16 v[0:15], a[40:43], v[40:43], v[0:15]
  ds_read_b128 v[36:39], v204 offset:39936
  v_mfma_f32_32x32x16_bf16 v[16:31], a[184:187], v[40:43], v[16:31]
  s_waitcnt lgkmcnt(2)
  v_mfma_f32_32x32x16_bf16 v[0:15], a[44:47], v[44:47], v[0:15]
  ds_read_b128 v[40:43], v205 offset:39936
  v_mfma_f32_32x32x16_bf16 v[16:31], a[188:191], v[44:47], v[16:31]
  s_waitcnt lgkmcnt(2)
  v_mfma_f32_32x32x16_bf16 v[0:15], a[48:51], v[32:35], v[0:15]
  ds_read_b128 v[44:47], v206 offset:39936
  v_mfma_f32_32x32x16_bf16 v[16:31], a[192:195], v[32:35], v[16:31]
  s_waitcnt lgkmcnt(2)
  v_mfma_f32_32x32x16_bf16 v[0:15], a[52:55], v[36:39], v[0:15]
  ds_read_b128 v[32:35], v203 offset:40960
  v_mfma_f32_32x32x16_bf16 v[16:31], a[196:199], v[36:39], v[16:31]
  s_waitcnt lgkmcnt(2)
  v_mfma_f32_32x32x16_bf16 v[0:15], a[56:59], v[40:43], v[0:15]
  ds_read_b128 v[36:39], v204 offset:40960
  v_mfma_f32_32x32x16_bf16 v[16:31], a[200:203], v[40:43], v[16:31]
  s_waitcnt lgkmcnt(2)
  v_mfma_f32_32x32x16_bf16 v[0:15], a[60:63], v[44:47], v[0:15]
  ds_read_b128 v[40:43], v205 offset:40960
  v_mfma_f32_32x32x16_bf16 v[16:31], a[204:207], v[44:47], v[16:31]
  s_waitcnt lgkmcnt(2)
  v_mfma_f32_32x32x16_bf16 v[0:15], a[64:67], v[32:35], v[0:15]
  ds_read_b128 v[44:47], v206 offset:40960
  v_mfma_f32_32x32x16_bf16 v[16:31], a[208:211], v[32:35], v[16:31]
  s_waitcnt lgkmcnt(2)
  v_mfma_f32_32x32x16_bf16 v[0:15], a[68:71], v[36:39], v[0:15]
  ds_read_b128 v[32:35], v203 offset:41984
  v_mfma_f32_32x32x16_bf16 v[16:31], a[212:215], v[36:39], v[16:31]
  s_waitcnt lgkmcnt(2)
  v_mfma_f32_32x32x16_bf16 v[0:15], a[72:75], v[40:43], v[0:15]
  ds_read_b128 v[36:39], v204 offset:41984
  v_mfma_f32_32x32x16_bf16 v[16:31], a[216:219], v[40:43], v[16:31]
  s_waitcnt lgkmcnt(2)
  v_mfma_f32_32x32x16_bf16 v[0:15], a[76:79], v[44:47], v[0:15]
  ds_read_b128 v[40:43], v205 offset:41984
  v_mfma_f32_32x32x16_bf16 v[16:31], a[220:223], v[44:47], v[16:31]
  s_waitcnt lgkmcnt(2)
  v_mfma_f32_32x32x16_bf16 v[0:15], a[80:83], v[32:35], v[0:15]
  ds_read_b128 v[44:47], v206 offset:41984
  v_mfma_f32_32x32x16_bf16 v[16:31], a[224:227], v[32:35], v[16:31]
  s_waitcnt lgkmcnt(2)
  v_mfma_f32_32x32x16_bf16 v[0:15], a[84:87], v[36:39], v[0:15]
  ds_read_b128 v[32:35], v203 offset:43008
  v_mfma_f32_32x32x16_bf16 v[16:31], a[228:231], v[36:39], v[16:31]
  s_waitcnt lgkmcnt(2)
  v_mfma_f32_32x32x16_bf16 v[0:15], a[88:91], v[40:43], v[0:15]
  ds_read_b128 v[36:39], v204 offset:43008
  v_mfma_f32_32x32x16_bf16 v[16:31], a[232:235], v[40:43], v[16:31]
  s_waitcnt lgkmcnt(2)
  v_mfma_f32_32x32x16_bf16 v[0:15], a[92:95], v[44:47], v[0:15]
  ds_read_b128 v[40:43], v205 offset:43008
  v_mfma_f32_32x32x16_bf16 v[16:31], a[236:239], v[44:47], v[16:31]
  s_waitcnt lgkmcnt(2)
  v_mfma_f32_32x32x16_bf16 v[0:15], a[96:99], v[32:35], v[0:15]
  ds_read_b128 v[44:47], v206 offset:43008
  v_mfma_f32_32x32x16_bf16 v[16:31], a[240:243], v[32:35], v[16:31]
  s_waitcnt lgkmcnt(2)
  v_mfma_f32_32x32x16_bf16 v[0:15], a[100:103], v[36:39], v[0:15]
  ds_read_b128 v[32:35], v203 offset:44032
  v_mfma_f32_32x32x16_bf16 v[16:31], a[244:247], v[36:39], v[16:31]
  s_waitcnt lgkmcnt(2)
  v_mfma_f32_32x32x16_bf16 v[0:15], a[104:107], v[40:43], v[0:15]
  ds_read_b128 v[36:39], v204 offset:44032
  v_mfma_f32_32x32x16_bf16 v[16:31], a[248:251], v[40:43], v[16:31]
  s_waitcnt lgkmcnt(2)
  v_mfma_f32_32x32x16_bf16 v[0:15], a[108:111], v[44:47], v[0:15]
  ds_read_b128 v[40:43], v205 offset:44032
  v_mfma_f32_32x32x16_bf16 v[16:31], a[252:255], v[44:47], v[16:31]
  s_waitcnt lgkmcnt(2)
  v_mfma_f32_32x32x16_bf16 v[0:15], a[112:115], v[32:35], v[0:15]
  ds_read_b128 v[44:47], v206 offset:44032
  v_mfma_f32_32x32x16_bf16 v[16:31], v[224:227], v[32:35], v[16:31]
  s_waitcnt lgkmcnt(2)
  v_mfma_f32_32x32x16_bf16 v[0:15], a[116:119], v[36:39], v[0:15]
  ds_read_b128 v[32:35], v203 offset:45056
  v_mfma_f32_32x32x16_bf16 v[16:31], v[228:231], v[36:39], v[16:31]
  s_waitcnt lgkmcnt(2)
  v_mfma_f32_32x32x16_bf16 v[0:15], a[120:123], v[40:43], v[0:15]
  ds_read_b128 v[36:39], v204 offset:45056
  v_mfma_f32_32x32x16_bf16 v[16:31], v[232:235], v[40:43], v[16:31]
  s_waitcnt lgkmcnt(2)
  v_mfma_f32_32x32x16_bf16 v[0:15], a[124:127], v[44:47], v[0:15]
  ds_read_b128 v[40:43], v205 offset:45056
  v_mfma_f32_32x32x16_bf16 v[16:31], v[236:239], v[44:47], v[16:31]
  s_waitcnt lgkmcnt(2)
  v_mfma_f32_32x32x16_bf16 v[0:15], a[128:131], v[32:35], v[0:15]
  ds_read_b128 v[44:47], v206 offset:45056
  v_mfma_f32_32x32x16_bf16 v[16:31], v[240:243], v[32:35], v[16:31]
  s_waitcnt lgkmcnt(2)
  v_mfma_f32_32x32x16_bf16 v[0:15], a[132:135], v[36:39], v[0:15]
  v_mfma_f32_32x32x16_bf16 v[16:31], v[244:247], v[36:39], v[16:31]
  s_waitcnt lgkmcnt(1)
  v_mfma_f32_32x32x16_bf16 v[0:15], a[136:139], v[40:43], v[0:15]
  v_mfma_f32_32x32x16_bf16 v[16:31], v[248:251], v[40:43], v[16:31]
  s_waitcnt lgkmcnt(0)
  v_mfma_f32_32x32x16_bf16 v[0:15], a[140:143], v[44:47], v[0:15]
  v_mfma_f32_32x32x16_bf16 v[16:31], v[252:255], v[44:47], v[16:31]
  s_nop 3
  v_cvt_pk_bf16_f32 v48, v0, v1
  v_cvt_pk_bf16_f32 v49, v2, v3
  ds_write2_b32 v218, v48, v49 offset0:0 offset1:1
  v_cvt_pk_bf16_f32 v48, v4, v5
  v_cvt_pk_bf16_f32 v49, v6, v7
  ds_write2_b32 v218, v48, v49 offset0:4 offset1:5
  v_cvt_pk_bf16_f32 v48, v8, v9
  v_cvt_pk_bf16_f32 v49, v10, v11
  ds_write2_b32 v218, v48, v49 offset0:8 offset1:9
  v_cvt_pk_bf16_f32 v48, v12, v13
  v_cvt_pk_bf16_f32 v49, v14, v15
  ds_write2_b32 v218, v48, v49 offset0:12 offset1:13
  v_cvt_pk_bf16_f32 v48, v16, v17
  v_cvt_pk_bf16_f32 v49, v18, v19
  ds_write2_b32 v218, v48, v49 offset0:64 offset1:65
  v_cvt_pk_bf16_f32 v48, v20, v21
  v_cvt_pk_bf16_f32 v49, v22, v23
  ds_write2_b32 v218, v48, v49 offset0:68 offset1:69
  v_cvt_pk_bf16_f32 v48, v24, v25
  v_cvt_pk_bf16_f32 v49, v26, v27
  ds_write2_b32 v218, v48, v49 offset0:72 offset1:73
  v_cvt_pk_bf16_f32 v48, v28, v29
  v_cvt_pk_bf16_f32 v49, v30, v31
  ds_write2_b32 v218, v48, v49 offset0:76 offset1:77
  v_add_u32 v218, 16512, v218
  s_waitcnt vmcnt(0) lgkmcnt(0)
  s_barrier
  ds_read_b128 v[32:35], v203 offset:0
  ds_read_b128 v[36:39], v204 offset:0
  ds_read_b128 v[40:43], v205 offset:0
  s_waitcnt lgkmcnt(2)
  v_mfma_f32_32x32x16_bf16 v[0:15], a[0:3], v[32:35], 0
  ds_read_b128 v[44:47], v206 offset:0
  v_mfma_f32_32x32x16_bf16 v[16:31], a[144:147], v[32:35], 0
  s_waitcnt lgkmcnt(2)
  v_mfma_f32_32x32x16_bf16 v[0:15], a[4:7], v[36:39], v[0:15]
  ds_read_b128 v[32:35], v203 offset:1024
  v_mfma_f32_32x32x16_bf16 v[16:31], a[148:151], v[36:39], v[16:31]
  s_waitcnt lgkmcnt(2)
  v_mfma_f32_32x32x16_bf16 v[0:15], a[8:11], v[40:43], v[0:15]
  ds_read_b128 v[36:39], v204 offset:1024
  v_mfma_f32_32x32x16_bf16 v[16:31], a[152:155], v[40:43], v[16:31]
  s_waitcnt lgkmcnt(2)
  v_mfma_f32_32x32x16_bf16 v[0:15], a[12:15], v[44:47], v[0:15]
  ds_read_b128 v[40:43], v205 offset:1024
  v_mfma_f32_32x32x16_bf16 v[16:31], a[156:159], v[44:47], v[16:31]
  s_waitcnt lgkmcnt(2)
  v_mfma_f32_32x32x16_bf16 v[0:15], a[16:19], v[32:35], v[0:15]
  ds_read_b128 v[44:47], v206 offset:1024
  v_mfma_f32_32x32x16_bf16 v[16:31], a[160:163], v[32:35], v[16:31]
  s_waitcnt lgkmcnt(2)
  v_mfma_f32_32x32x16_bf16 v[0:15], a[20:23], v[36:39], v[0:15]
  ds_read_b128 v[32:35], v203 offset:2048
  v_mfma_f32_32x32x16_bf16 v[16:31], a[164:167], v[36:39], v[16:31]
  s_waitcnt lgkmcnt(2)
  v_mfma_f32_32x32x16_bf16 v[0:15], a[24:27], v[40:43], v[0:15]
  ds_read_b128 v[36:39], v204 offset:2048
  v_mfma_f32_32x32x16_bf16 v[16:31], a[168:171], v[40:43], v[16:31]
  s_waitcnt lgkmcnt(2)
  v_mfma_f32_32x32x16_bf16 v[0:15], a[28:31], v[44:47], v[0:15]
  ds_read_b128 v[40:43], v205 offset:2048
  v_mfma_f32_32x32x16_bf16 v[16:31], a[172:175], v[44:47], v[16:31]
  s_waitcnt lgkmcnt(2)
  v_mfma_f32_32x32x16_bf16 v[0:15], a[32:35], v[32:35], v[0:15]
  ds_read_b128 v[44:47], v206 offset:2048
  v_mfma_f32_32x32x16_bf16 v[16:31], a[176:179], v[32:35], v[16:31]
  s_waitcnt lgkmcnt(2)
  v_mfma_f32_32x32x16_bf16 v[0:15], a[36:39], v[36:39], v[0:15]
  ds_read_b128 v[32:35], v203 offset:3072
  v_mfma_f32_32x32x16_bf16 v[16:31], a[180:183], v[36:39], v[16:31]
  s_waitcnt lgkmcnt(2)
  v_mfma_f32_32x32x16_bf16 v[0:15], a[40:43], v[40:43], v[0:15]
  ds_read_b128 v[36:39], v204 offset:3072
  v_mfma_f32_32x32x16_bf16 v[16:31], a[184:187], v[40:43], v[16:31]
  s_waitcnt lgkmcnt(2)
  v_mfma_f32_32x32x16_bf16 v[0:15], a[44:47], v[44:47], v[0:15]
  ds_read_b128 v[40:43], v205 offset:3072
  v_mfma_f32_32x32x16_bf16 v[16:31], a[188:191], v[44:47], v[16:31]
  s_waitcnt lgkmcnt(2)
  v_mfma_f32_32x32x16_bf16 v[0:15], a[48:51], v[32:35], v[0:15]
  ds_read_b128 v[44:47], v206 offset:3072
  v_mfma_f32_32x32x16_bf16 v[16:31], a[192:195], v[32:35], v[16:31]
  s_waitcnt lgkmcnt(2)
  v_mfma_f32_32x32x16_bf16 v[0:15], a[52:55], v[36:39], v[0:15]
  ds_read_b128 v[32:35], v203 offset:4096
  v_mfma_f32_32x32x16_bf16 v[16:31], a[196:199], v[36:39], v[16:31]
  s_waitcnt lgkmcnt(2)
  v_mfma_f32_32x32x16_bf16 v[0:15], a[56:59], v[40:43], v[0:15]
  ds_read_b128 v[36:39], v204 offset:4096
  v_mfma_f32_32x32x16_bf16 v[16:31], a[200:203], v[40:43], v[16:31]
  s_waitcnt lgkmcnt(2)
  v_mfma_f32_32x32x16_bf16 v[0:15], a[60:63], v[44:47], v[0:15]
  ds_read_b128 v[40:43], v205 offset:4096
  v_mfma_f32_32x32x16_bf16 v[16:31], a[204:207], v[44:47], v[16:31]
  s_waitcnt lgkmcnt(2)
  v_mfma_f32_32x32x16_bf16 v[0:15], a[64:67], v[32:35], v[0:15]
  ds_read_b128 v[44:47], v206 offset:4096
  v_mfma_f32_32x32x16_bf16 v[16:31], a[208:211], v[32:35], v[16:31]
  s_waitcnt lgkmcnt(2)
  v_mfma_f32_32x32x16_bf16 v[0:15], a[68:71], v[36:39], v[0:15]
  ds_read_b128 v[32:35], v203 offset:5120
  v_mfma_f32_32x32x16_bf16 v[16:31], a[212:215], v[36:39], v[16:31]
  s_waitcnt lgkmcnt(2)
  v_mfma_f32_32x32x16_bf16 v[0:15], a[72:75], v[40:43], v[0:15]
  ds_read_b128 v[36:39], v204 offset:5120
  v_mfma_f32_32x32x16_bf16 v[16:31], a[216:219], v[40:43], v[16:31]
  s_waitcnt lgkmcnt(2)
  v_mfma_f32_32x32x16_bf16 v[0:15], a[76:79], v[44:47], v[0:15]
  ds_read_b128 v[40:43], v205 offset:5120
  v_mfma_f32_32x32x16_bf16 v[16:31], a[220:223], v[44:47], v[16:31]
  s_waitcnt lgkmcnt(2)
  v_mfma_f32_32x32x16_bf16 v[0:15], a[80:83], v[32:35], v[0:15]
  ds_read_b128 v[44:47], v206 offset:5120
  v_mfma_f32_32x32x16_bf16 v[16:31], a[224:227], v[32:35], v[16:31]
  s_waitcnt lgkmcnt(2)
  v_mfma_f32_32x32x16_bf16 v[0:15], a[84:87], v[36:39], v[0:15]
  ds_read_b128 v[32:35], v203 offset:6144
  v_mfma_f32_32x32x16_bf16 v[16:31], a[228:231], v[36:39], v[16:31]
  s_waitcnt lgkmcnt(2)
  v_mfma_f32_32x32x16_bf16 v[0:15], a[88:91], v[40:43], v[0:15]
  ds_read_b128 v[36:39], v204 offset:6144
  v_mfma_f32_32x32x16_bf16 v[16:31], a[232:235], v[40:43], v[16:31]
  s_waitcnt lgkmcnt(2)
  v_mfma_f32_32x32x16_bf16 v[0:15], a[92:95], v[44:47], v[0:15]
  ds_read_b128 v[40:43], v205 offset:6144
  v_mfma_f32_32x32x16_bf16 v[16:31], a[236:239], v[44:47], v[16:31]
  s_waitcnt lgkmcnt(2)
  v_mfma_f32_32x32x16_bf16 v[0:15], a[96:99], v[32:35], v[0:15]
  ds_read_b128 v[44:47], v206 offset:6144
  v_mfma_f32_32x32x16_bf16 v[16:31], a[240:243], v[32:35], v[16:31]
  s_waitcnt lgkmcnt(2)
  v_mfma_f32_32x32x16_bf16 v[0:15], a[100:103], v[36:39], v[0:15]
  ds_read_b128 v[32:35], v203 offset:7168
  v_mfma_f32_32x32x16_bf16 v[16:31], a[244:247], v[36:39], v[16:31]
  s_waitcnt lgkmcnt(2)
  v_mfma_f32_32x32x16_bf16 v[0:15], a[104:107], v[40:43], v[0:15]
  ds_read_b128 v[36:39], v204 offset:7168
  v_mfma_f32_32x32x16_bf16 v[16:31], a[248:251], v[40:43], v[16:31]
  s_waitcnt lgkmcnt(2)
  v_mfma_f32_32x32x16_bf16 v[0:15], a[108:111], v[44:47], v[0:15]
  ds_read_b128 v[40:43], v205 offset:7168
  v_mfma_f32_32x32x16_bf16 v[16:31], a[252:255], v[44:47], v[16:31]
  s_waitcnt lgkmcnt(2)
  v_mfma_f32_32x32x16_bf16 v[0:15], a[112:115], v[32:35], v[0:15]
  ds_read_b128 v[44:47], v206 offset:7168
  v_mfma_f32_32x32x16_bf16 v[16:31], v[224:227], v[32:35], v[16:31]
  s_waitcnt lgkmcnt(2)
  v_mfma_f32_32x32x16_bf16 v[0:15], a[116:119], v[36:39], v[0:15]
  ds_read_b128 v[32:35], v203 offset:8192
  v_mfma_f32_32x32x16_bf16 v[16:31], v[228:231], v[36:39], v[16:31]
  s_waitcnt lgkmcnt(2)
  v_mfma_f32_32x32x16_bf16 v[0:15], a[120:123], v[40:43], v[0:15]
  ds_read_b128 v[36:39], v204 offset:8192
  v_mfma_f32_32x32x16_bf16 v[16:31], v[232:235], v[40:43], v[16:31]
  s_waitcnt lgkmcnt(2)
  v_mfma_f32_32x32x16_bf16 v[0:15], a[124:127], v[44:47], v[0:15]
  ds_read_b128 v[40:43], v205 offset:8192
  v_mfma_f32_32x32x16_bf16 v[16:31], v[236:239], v[44:47], v[16:31]
  s_waitcnt lgkmcnt(2)
  v_mfma_f32_32x32x16_bf16 v[0:15], a[128:131], v[32:35], v[0:15]
  ds_read_b128 v[44:47], v206 offset:8192
  v_mfma_f32_32x32x16_bf16 v[16:31], v[240:243], v[32:35], v[16:31]
  s_waitcnt lgkmcnt(2)
  v_mfma_f32_32x32x16_bf16 v[0:15], a[132:135], v[36:39], v[0:15]
  v_mfma_f32_32x32x16_bf16 v[16:31], v[244:247], v[36:39], v[16:31]
  s_waitcnt lgkmcnt(1)
  v_mfma_f32_32x32x16_bf16 v[0:15], a[136:139], v[40:43], v[0:15]
  v_mfma_f32_32x32x16_bf16 v[16:31], v[248:251], v[40:43], v[16:31]
  s_waitcnt lgkmcnt(0)
  v_mfma_f32_32x32x16_bf16 v[0:15], a[140:143], v[44:47], v[0:15]
  v_mfma_f32_32x32x16_bf16 v[16:31], v[252:255], v[44:47], v[16:31]
  s_nop 3
  v_cvt_pk_bf16_f32 v48, v0, v1
  v_cvt_pk_bf16_f32 v49, v2, v3
  ds_write2_b32 v218, v48, v49 offset0:0 offset1:1
  v_cvt_pk_bf16_f32 v48, v4, v5
  v_cvt_pk_bf16_f32 v49, v6, v7
  ds_write2_b32 v218, v48, v49 offset0:4 offset1:5
  v_cvt_pk_bf16_f32 v48, v8, v9
  v_cvt_pk_bf16_f32 v49, v10, v11
  ds_write2_b32 v218, v48, v49 offset0:8 offset1:9
  v_cvt_pk_bf16_f32 v48, v12, v13
  v_cvt_pk_bf16_f32 v49, v14, v15
  ds_write2_b32 v218, v48, v49 offset0:12 offset1:13
  v_cvt_pk_bf16_f32 v48, v16, v17
  v_cvt_pk_bf16_f32 v49, v18, v19
  ds_write2_b32 v218, v48, v49 offset0:64 offset1:65
  v_cvt_pk_bf16_f32 v48, v20, v21
  v_cvt_pk_bf16_f32 v49, v22, v23
  ds_write2_b32 v218, v48, v49 offset0:68 offset1:69
  v_cvt_pk_bf16_f32 v48, v24, v25
  v_cvt_pk_bf16_f32 v49, v26, v27
  ds_write2_b32 v218, v48, v49 offset0:72 offset1:73
  v_cvt_pk_bf16_f32 v48, v28, v29
  v_cvt_pk_bf16_f32 v49, v30, v31
  ds_write2_b32 v218, v48, v49 offset0:76 offset1:77
  v_add_u32 v218, 16512, v218
  s_waitcnt vmcnt(0) lgkmcnt(0)
  s_barrier
  v_mul_u32_u24 v219, 516, v200
  s_mul_i32 s54, s52, 36
  s_add_u32 s55, s54, 83016
  v_add_u32 v219, s55, v219
  v_mul_u32_u24 v220, 1152, v200
  s_mul_i32 s55, s68, 144
  s_add_u32 s54, s54, s55
  s_mul_i32 s55, s69, 147456
  s_add_u32 s64, s54, s55
  s_add_u32 s64, s64, 62914560
  s_lshl_b32 s66, s69, 7
  s_mov_b32 s57, 1051597459
  ds_read_b32 v0, v219 offset:7224
  ds_read_b32 v1, v219 offset:7228
  ds_read_b32 v2, v219 offset:7232
  ds_read_b32 v3, v219 offset:7236
  ds_read_b32 v4, v219 offset:7240
  ds_read_b32 v5, v219 offset:7244
  ds_read_b32 v6, v219 offset:7248
  ds_read_b32 v7, v219 offset:7252
  ds_read_b32 v8, v219 offset:7256
  ds_read_b32 v16, v219 offset:7368
  ds_read_b32 v17, v219 offset:7372
  ds_read_b32 v18, v219 offset:7376
  ds_read_b32 v19, v219 offset:7380
  ds_read_b32 v20, v219 offset:7384
  ds_read_b32 v21, v219 offset:7388
  ds_read_b32 v22, v219 offset:7392
  ds_read_b32 v23, v219 offset:7396
  ds_read_b32 v24, v219 offset:7400
  ds_read_b32 v25, v219 offset:6336
  ds_read_b32 v26, v219 offset:6340
  ds_read_b32 v27, v219 offset:6344
  ds_read_b32 v28, v219 offset:6348
  ds_read_b32 v29, v219 offset:6352
  ds_read_b32 v30, v219 offset:6356
  ds_read_b32 v31, v219 offset:6360
  ds_read_b32 v32, v219 offset:6364
  ds_read_b32 v33, v219 offset:6368
  ds_read_b32 v34, v219 offset:5304
  ds_read_b32 v35, v219 offset:5308
  ds_read_b32 v36, v219 offset:5312
  ds_read_b32 v37, v219 offset:5316
  ds_read_b32 v38, v219 offset:5320
  ds_read_b32 v39, v219 offset:5324
  ds_read_b32 v40, v219 offset:5328
  ds_read_b32 v41, v219 offset:5332
  ds_read_b32 v42, v219 offset:5336
  ds_read_b32 v43, v219 offset:4272
  ds_read_b32 v44, v219 offset:4276
  ds_read_b32 v45, v219 offset:4280
  ds_read_b32 v46, v219 offset:4284
  ds_read_b32 v47, v219 offset:4288
  ds_read_b32 v48, v219 offset:4292
  ds_read_b32 v49, v219 offset:4296
  ds_read_b32 v50, v219 offset:4300
  ds_read_b32 v51, v219 offset:4304
  ds_read_b32 v52, v219 offset:3240
  ds_read_b32 v53, v219 offset:3244
  ds_read_b32 v54, v219 offset:3248
  ds_read_b32 v55, v219 offset:3252
  ds_read_b32 v56, v219 offset:3256
  ds_read_b32 v57, v219 offset:3260
  ds_read_b32 v58, v219 offset:3264
  ds_read_b32 v59, v219 offset:3268
  ds_read_b32 v60, v219 offset:3272
  ds_read_b32 v61, v219 offset:2208
  ds_read_b32 v62, v219 offset:2212
  ds_read_b32 v63, v219 offset:2216
  ds_read_b32 v64, v219 offset:2220
  ds_read_b32 v65, v219 offset:2224
  ds_read_b32 v66, v219 offset:2228
  ds_read_b32 v67, v219 offset:2232
  ds_read_b32 v68, v219 offset:2236
  ds_read_b32 v69, v219 offset:2240
  ds_read_b32 v70, v219 offset:1176
  ds_read_b32 v71, v219 offset:1180
  ds_read_b32 v72, v219 offset:1184
  ds_read_b32 v73, v219 offset:1188
  ds_read_b32 v74, v219 offset:1192
  ds_read_b32 v75, v219 offset:1196
  ds_read_b32 v76, v219 offset:1200
  ds_read_b32 v77, v219 offset:1204
  ds_read_b32 v78, v219 offset:1208
  ds_read_b32 v79, v219 offset:144
  ds_read_b32 v80, v219 offset:148
  ds_read_b32 v81, v219 offset:152
  ds_read_b32 v82, v219 offset:156
  ds_read_b32 v83, v219 offset:160
  ds_read_b32 v84, v219 offset:164
  ds_read_b32 v85, v219 offset:168
  ds_read_b32 v86, v219 offset:172
  ds_read_b32 v87, v219 offset:176
  v_mov_b32 v100, 0
  v_mov_b32 v101, 0
  v_mov_b32 v102, 0
  v_mov_b32 v103, 0
  v_mov_b32 v104, 0
  v_mov_b32 v105, 0
  v_mov_b32 v106, 0
  v_mov_b32 v107, 0
  s_waitcnt lgkmcnt(15)
  v_dot2c_f32_bf16 v100, v0, v16
  v_dot2c_f32_bf16 v101, v0, v25
  v_dot2c_f32_bf16 v102, v0, v34
  v_dot2c_f32_bf16 v103, v0, v43
  v_dot2c_f32_bf16 v104, v0, v52
  v_dot2c_f32_bf16 v105, v0, v61
  v_dot2c_f32_bf16 v106, v0, v70
  s_waitcnt lgkmcnt(8)
  v_dot2c_f32_bf16 v107, v0, v79
  v_dot2c_f32_bf16 v100, v1, v17
  v_dot2c_f32_bf16 v101, v1, v26
  v_dot2c_f32_bf16 v102, v1, v35
  v_dot2c_f32_bf16 v103, v1, v44
  v_dot2c_f32_bf16 v104, v1, v53
  v_dot2c_f32_bf16 v105, v1, v62
  v_dot2c_f32_bf16 v106, v1, v71
  s_waitcnt lgkmcnt(7)
  v_dot2c_f32_bf16 v107, v1, v80
  v_dot2c_f32_bf16 v100, v2, v18
  v_dot2c_f32_bf16 v101, v2, v27
  v_dot2c_f32_bf16 v102, v2, v36
  v_dot2c_f32_bf16 v103, v2, v45
  v_dot2c_f32_bf16 v104, v2, v54
  v_dot2c_f32_bf16 v105, v2, v63
  v_dot2c_f32_bf16 v106, v2, v72
  s_waitcnt lgkmcnt(6)
  v_dot2c_f32_bf16 v107, v2, v81
  v_dot2c_f32_bf16 v100, v3, v19
  v_dot2c_f32_bf16 v101, v3, v28
  v_dot2c_f32_bf16 v102, v3, v37
  v_dot2c_f32_bf16 v103, v3, v46
  v_dot2c_f32_bf16 v104, v3, v55
  v_dot2c_f32_bf16 v105, v3, v64
  v_dot2c_f32_bf16 v106, v3, v73
  s_waitcnt lgkmcnt(5)
  v_dot2c_f32_bf16 v107, v3, v82
  v_dot2c_f32_bf16 v100, v4, v20
  v_dot2c_f32_bf16 v101, v4, v29
  v_dot2c_f32_bf16 v102, v4, v38
  v_dot2c_f32_bf16 v103, v4, v47
  v_dot2c_f32_bf16 v104, v4, v56
  v_dot2c_f32_bf16 v105, v4, v65
  v_dot2c_f32_bf16 v106, v4, v74
  s_waitcnt lgkmcnt(4)
  v_dot2c_f32_bf16 v107, v4, v83
  v_dot2c_f32_bf16 v100, v5, v21
  v_dot2c_f32_bf16 v101, v5, v30
  v_dot2c_f32_bf16 v102, v5, v39
  v_dot2c_f32_bf16 v103, v5, v48
  v_dot2c_f32_bf16 v104, v5, v57
  v_dot2c_f32_bf16 v105, v5, v66
  v_dot2c_f32_bf16 v106, v5, v75
  s_waitcnt lgkmcnt(3)
  v_dot2c_f32_bf16 v107, v5, v84
  v_dot2c_f32_bf16 v100, v6, v22
  v_dot2c_f32_bf16 v101, v6, v31
  v_dot2c_f32_bf16 v102, v6, v40
  v_dot2c_f32_bf16 v103, v6, v49
  v_dot2c_f32_bf16 v104, v6, v58
  v_dot2c_f32_bf16 v105, v6, v67
  v_dot2c_f32_bf16 v106, v6, v76
  s_waitcnt lgkmcnt(2)
  v_dot2c_f32_bf16 v107, v6, v85
  v_dot2c_f32_bf16 v100, v7, v23
  v_dot2c_f32_bf16 v101, v7, v32
  v_dot2c_f32_bf16 v102, v7, v41
  v_dot2c_f32_bf16 v103, v7, v50
  v_dot2c_f32_bf16 v104, v7, v59
  v_dot2c_f32_bf16 v105, v7, v68
  v_dot2c_f32_bf16 v106, v7, v77
  s_waitcnt lgkmcnt(1)
  v_dot2c_f32_bf16 v107, v7, v86
  v_dot2c_f32_bf16 v100, v8, v24
  v_dot2c_f32_bf16 v101, v8, v33
  v_dot2c_f32_bf16 v102, v8, v42
  v_dot2c_f32_bf16 v103, v8, v51
  v_dot2c_f32_bf16 v104, v8, v60
  v_dot2c_f32_bf16 v105, v8, v69
  v_dot2c_f32_bf16 v106, v8, v78
  s_waitcnt lgkmcnt(0)
  v_dot2c_f32_bf16 v107, v8, v87
  ds_read_b32 v16, v219 offset:7512
  ds_read_b32 v17, v219 offset:7516
  ds_read_b32 v18, v219 offset:7520
  ds_read_b32 v19, v219 offset:7524
  ds_read_b32 v20, v219 offset:7528
  ds_read_b32 v21, v219 offset:7532
  ds_read_b32 v22, v219 offset:7536
  ds_read_b32 v23, v219 offset:7540
  ds_read_b32 v24, v219 offset:7544
  ds_read_b32 v25, v219 offset:6480
  ds_read_b32 v26, v219 offset:6484
  ds_read_b32 v27, v219 offset:6488
  ds_read_b32 v28, v219 offset:6492
  ds_read_b32 v29, v219 offset:6496
  ds_read_b32 v30, v219 offset:6500
  ds_read_b32 v31, v219 offset:6504
  ds_read_b32 v32, v219 offset:6508
  ds_read_b32 v33, v219 offset:6512
  ds_read_b32 v34, v219 offset:5448
  ds_read_b32 v35, v219 offset:5452
  ds_read_b32 v36, v219 offset:5456
  ds_read_b32 v37, v219 offset:5460
  ds_read_b32 v38, v219 offset:5464
  ds_read_b32 v39, v219 offset:5468
  ds_read_b32 v40, v219 offset:5472
  ds_read_b32 v41, v219 offset:5476
  ds_read_b32 v42, v219 offset:5480
  ds_read_b32 v43, v219 offset:4416
  ds_read_b32 v44, v219 offset:4420
  ds_read_b32 v45, v219 offset:4424
  ds_read_b32 v46, v219 offset:4428
  ds_read_b32 v47, v219 offset:4432
  ds_read_b32 v48, v219 offset:4436
  ds_read_b32 v49, v219 offset:4440
  ds_read_b32 v50, v219 offset:4444
  ds_read_b32 v51, v219 offset:4448
  ds_read_b32 v52, v219 offset:3384
  ds_read_b32 v53, v219 offset:3388
  ds_read_b32 v54, v219 offset:3392
  ds_read_b32 v55, v219 offset:3396
  ds_read_b32 v56, v219 offset:3400
  ds_read_b32 v57, v219 offset:3404
  ds_read_b32 v58, v219 offset:3408
  ds_read_b32 v59, v219 offset:3412
  ds_read_b32 v60, v219 offset:3416
  ds_read_b32 v61, v219 offset:2352
  ds_read_b32 v62, v219 offset:2356
  ds_read_b32 v63, v219 offset:2360
  ds_read_b32 v64, v219 offset:2364
  ds_read_b32 v65, v219 offset:2368
  ds_read_b32 v66, v219 offset:2372
  ds_read_b32 v67, v219 offset:2376
  ds_read_b32 v68, v219 offset:2380
  ds_read_b32 v69, v219 offset:2384
  ds_read_b32 v70, v219 offset:1320
  ds_read_b32 v71, v219 offset:1324
  ds_read_b32 v72, v219 offset:1328
  ds_read_b32 v73, v219 offset:1332
  ds_read_b32 v74, v219 offset:1336
  ds_read_b32 v75, v219 offset:1340
  ds_read_b32 v76, v219 offset:1344
  ds_read_b32 v77, v219 offset:1348
  ds_read_b32 v78, v219 offset:1352
  ds_read_b32 v79, v219 offset:288
  ds_read_b32 v80, v219 offset:292
  ds_read_b32 v81, v219 offset:296
  ds_read_b32 v82, v219 offset:300
  ds_read_b32 v83, v219 offset:304
  ds_read_b32 v84, v219 offset:308
  ds_read_b32 v85, v219 offset:312
  ds_read_b32 v86, v219 offset:316
  ds_read_b32 v87, v219 offset:320
  v_add_u32 v211, s66, v200
  v_mov_b32 v212, 0xf149f2ca
  v_mul_f32 v100, s57, v100
  v_mul_f32 v101, s57, v101
  v_mul_f32 v102, s57, v102
  v_mul_f32 v103, s57, v103
  v_mul_f32 v104, s57, v104
  v_mul_f32 v105, s57, v105
  v_mul_f32 v106, s57, v106
  v_mul_f32 v107, s57, v107
  v_cmp_gt_u32 vcc, 2, v211
  s_nop 1
  v_cndmask_b32 v101, v101, v212, vcc
  v_cmp_gt_u32 vcc, 4, v211
  s_nop 1
  v_cndmask_b32 v102, v102, v212, vcc
  v_cmp_gt_u32 vcc, 6, v211
  s_nop 1
  v_cndmask_b32 v103, v103, v212, vcc
  v_cmp_gt_u32 vcc, 8, v211
  s_nop 1
  v_cndmask_b32 v104, v104, v212, vcc
  v_cmp_gt_u32 vcc, 10, v211
  s_nop 1
  v_cndmask_b32 v105, v105, v212, vcc
  v_cmp_gt_u32 vcc, 12, v211
  s_nop 1
  v_cndmask_b32 v106, v106, v212, vcc
  v_cmp_gt_u32 vcc, 14, v211
  s_nop 1
  v_cndmask_b32 v107, v107, v212, vcc
  v_max3_f32 v213, v100, v101, v102
  v_max3_f32 v213, v213, v103, v104
  v_max3_f32 v213, v213, v105, v106
  v_max_f32 v213, v213, v107
  v_sub_f32 v100, v100, v213
  v_sub_f32 v101, v101, v213
  v_sub_f32 v102, v102, v213
  v_sub_f32 v103, v103, v213
  v_sub_f32 v104, v104, v213
  v_sub_f32 v105, v105, v213
  v_sub_f32 v106, v106, v213
  v_sub_f32 v107, v107, v213
  v_exp_f32 v100, v100
  v_exp_f32 v101, v101
  v_exp_f32 v102, v102
  v_exp_f32 v103, v103
  v_exp_f32 v104, v104
  v_exp_f32 v105, v105
  v_exp_f32 v106, v106
  v_exp_f32 v107, v107
  v_add_f32 v213, v100, v101
  v_add_f32 v213, v213, v102
  v_add_f32 v213, v213, v103
  v_add_f32 v213, v213, v104
  v_add_f32 v213, v213, v105
  v_add_f32 v213, v213, v106
  v_add_f32 v213, v213, v107
  v_rcp_f32 v213, v213
  v_mov_b32 v214, 0
  v_mul_f32 v100, v213, v100
  v_mul_f32 v101, v213, v101
  v_mul_f32 v102, v213, v102
  v_mul_f32 v103, v213, v103
  v_mul_f32 v104, v213, v104
  v_mul_f32 v105, v213, v105
  v_mul_f32 v106, v213, v106
  v_mul_f32 v107, v213, v107
  v_mov_b32 v112, 0
  v_mov_b32 v113, 0
  v_mov_b32 v114, 0
  v_mov_b32 v115, 0
  v_mov_b32 v116, 0
  v_mov_b32 v117, 0
  v_mov_b32 v118, 0
  v_mov_b32 v119, 0
  v_mov_b32 v120, 0
  v_mov_b32 v121, 0
  v_mov_b32 v122, 0
  v_mov_b32 v123, 0
  v_mov_b32 v124, 0
  v_mov_b32 v125, 0
  v_mov_b32 v126, 0
  v_mov_b32 v127, 0
  v_mov_b32 v128, 0
  v_mov_b32 v129, 0
  v_cvt_pk_bf16_f32 v0, v100, v214
  v_cvt_pk_bf16_f32 v1, v214, v100
  s_waitcnt lgkmcnt(15)
  v_dot2c_f32_bf16 v112, v16, v0
  v_dot2c_f32_bf16 v113, v16, v1
  v_dot2c_f32_bf16 v114, v17, v0
  v_dot2c_f32_bf16 v115, v17, v1
  v_dot2c_f32_bf16 v116, v18, v0
  v_dot2c_f32_bf16 v117, v18, v1
  v_dot2c_f32_bf16 v118, v19, v0
  v_dot2c_f32_bf16 v119, v19, v1
  v_dot2c_f32_bf16 v120, v20, v0
  v_dot2c_f32_bf16 v121, v20, v1
  v_dot2c_f32_bf16 v122, v21, v0
  v_dot2c_f32_bf16 v123, v21, v1
  v_dot2c_f32_bf16 v124, v22, v0
  v_dot2c_f32_bf16 v125, v22, v1
  v_dot2c_f32_bf16 v126, v23, v0
  v_dot2c_f32_bf16 v127, v23, v1
  v_dot2c_f32_bf16 v128, v24, v0
  v_dot2c_f32_bf16 v129, v24, v1
  v_cvt_pk_bf16_f32 v2, v101, v214
  v_cvt_pk_bf16_f32 v3, v214, v101
  v_dot2c_f32_bf16 v112, v25, v2
  v_dot2c_f32_bf16 v113, v25, v3
  v_dot2c_f32_bf16 v114, v26, v2
  v_dot2c_f32_bf16 v115, v26, v3
  v_dot2c_f32_bf16 v116, v27, v2
  v_dot2c_f32_bf16 v117, v27, v3
  v_dot2c_f32_bf16 v118, v28, v2
  v_dot2c_f32_bf16 v119, v28, v3
  v_dot2c_f32_bf16 v120, v29, v2
  v_dot2c_f32_bf16 v121, v29, v3
  v_dot2c_f32_bf16 v122, v30, v2
  v_dot2c_f32_bf16 v123, v30, v3
  v_dot2c_f32_bf16 v124, v31, v2
  v_dot2c_f32_bf16 v125, v31, v3
  v_dot2c_f32_bf16 v126, v32, v2
  v_dot2c_f32_bf16 v127, v32, v3
  v_dot2c_f32_bf16 v128, v33, v2
  v_dot2c_f32_bf16 v129, v33, v3
  v_cvt_pk_bf16_f32 v0, v102, v214
  v_cvt_pk_bf16_f32 v1, v214, v102
  v_dot2c_f32_bf16 v112, v34, v0
  v_dot2c_f32_bf16 v113, v34, v1
  v_dot2c_f32_bf16 v114, v35, v0
  v_dot2c_f32_bf16 v115, v35, v1
  v_dot2c_f32_bf16 v116, v36, v0
  v_dot2c_f32_bf16 v117, v36, v1
  v_dot2c_f32_bf16 v118, v37, v0
  v_dot2c_f32_bf16 v119, v37, v1
  v_dot2c_f32_bf16 v120, v38, v0
  v_dot2c_f32_bf16 v121, v38, v1
  v_dot2c_f32_bf16 v122, v39, v0
  v_dot2c_f32_bf16 v123, v39, v1
  v_dot2c_f32_bf16 v124, v40, v0
  v_dot2c_f32_bf16 v125, v40, v1
  v_dot2c_f32_bf16 v126, v41, v0
  v_dot2c_f32_bf16 v127, v41, v1
  v_dot2c_f32_bf16 v128, v42, v0
  v_dot2c_f32_bf16 v129, v42, v1
  v_cvt_pk_bf16_f32 v2, v103, v214
  v_cvt_pk_bf16_f32 v3, v214, v103
  v_dot2c_f32_bf16 v112, v43, v2
  v_dot2c_f32_bf16 v113, v43, v3
  v_dot2c_f32_bf16 v114, v44, v2
  v_dot2c_f32_bf16 v115, v44, v3
  v_dot2c_f32_bf16 v116, v45, v2
  v_dot2c_f32_bf16 v117, v45, v3
  v_dot2c_f32_bf16 v118, v46, v2
  v_dot2c_f32_bf16 v119, v46, v3
  v_dot2c_f32_bf16 v120, v47, v2
  v_dot2c_f32_bf16 v121, v47, v3
  v_dot2c_f32_bf16 v122, v48, v2
  v_dot2c_f32_bf16 v123, v48, v3
  v_dot2c_f32_bf16 v124, v49, v2
  v_dot2c_f32_bf16 v125, v49, v3
  v_dot2c_f32_bf16 v126, v50, v2
  v_dot2c_f32_bf16 v127, v50, v3
  v_dot2c_f32_bf16 v128, v51, v2
  v_dot2c_f32_bf16 v129, v51, v3
  v_cvt_pk_bf16_f32 v0, v104, v214
  v_cvt_pk_bf16_f32 v1, v214, v104
  v_dot2c_f32_bf16 v112, v52, v0
  v_dot2c_f32_bf16 v113, v52, v1
  v_dot2c_f32_bf16 v114, v53, v0
  v_dot2c_f32_bf16 v115, v53, v1
  v_dot2c_f32_bf16 v116, v54, v0
  v_dot2c_f32_bf16 v117, v54, v1
  v_dot2c_f32_bf16 v118, v55, v0
  v_dot2c_f32_bf16 v119, v55, v1
  v_dot2c_f32_bf16 v120, v56, v0
  v_dot2c_f32_bf16 v121, v56, v1
  v_dot2c_f32_bf16 v122, v57, v0
  v_dot2c_f32_bf16 v123, v57, v1
  v_dot2c_f32_bf16 v124, v58, v0
  v_dot2c_f32_bf16 v125, v58, v1
  v_dot2c_f32_bf16 v126, v59, v0
  v_dot2c_f32_bf16 v127, v59, v1
  v_dot2c_f32_bf16 v128, v60, v0
  v_dot2c_f32_bf16 v129, v60, v1
  v_cvt_pk_bf16_f32 v2, v105, v214
  v_cvt_pk_bf16_f32 v3, v214, v105
  v_dot2c_f32_bf16 v112, v61, v2
  v_dot2c_f32_bf16 v113, v61, v3
  v_dot2c_f32_bf16 v114, v62, v2
  v_dot2c_f32_bf16 v115, v62, v3
  v_dot2c_f32_bf16 v116, v63, v2
  v_dot2c_f32_bf16 v117, v63, v3
  v_dot2c_f32_bf16 v118, v64, v2
  v_dot2c_f32_bf16 v119, v64, v3
  v_dot2c_f32_bf16 v120, v65, v2
  v_dot2c_f32_bf16 v121, v65, v3
  v_dot2c_f32_bf16 v122, v66, v2
  v_dot2c_f32_bf16 v123, v66, v3
  v_dot2c_f32_bf16 v124, v67, v2
  v_dot2c_f32_bf16 v125, v67, v3
  v_dot2c_f32_bf16 v126, v68, v2
  v_dot2c_f32_bf16 v127, v68, v3
  v_dot2c_f32_bf16 v128, v69, v2
  v_dot2c_f32_bf16 v129, v69, v3
  v_cvt_pk_bf16_f32 v0, v106, v214
  v_cvt_pk_bf16_f32 v1, v214, v106
  v_dot2c_f32_bf16 v112, v70, v0
  v_dot2c_f32_bf16 v113, v70, v1
  v_dot2c_f32_bf16 v114, v71, v0
  v_dot2c_f32_bf16 v115, v71, v1
  v_dot2c_f32_bf16 v116, v72, v0
  v_dot2c_f32_bf16 v117, v72, v1
  s_waitcnt lgkmcnt(14)
  v_dot2c_f32_bf16 v118, v73, v0
  v_dot2c_f32_bf16 v119, v73, v1
  s_waitcnt lgkmcnt(13)
  v_dot2c_f32_bf16 v120, v74, v0
  v_dot2c_f32_bf16 v121, v74, v1
  s_waitcnt lgkmcnt(12)
  v_dot2c_f32_bf16 v122, v75, v0
  v_dot2c_f32_bf16 v123, v75, v1
  s_waitcnt lgkmcnt(11)
  v_dot2c_f32_bf16 v124, v76, v0
  v_dot2c_f32_bf16 v125, v76, v1
  s_waitcnt lgkmcnt(10)
  v_dot2c_f32_bf16 v126, v77, v0
  v_dot2c_f32_bf16 v127, v77, v1
  s_waitcnt lgkmcnt(9)
  v_dot2c_f32_bf16 v128, v78, v0
  v_dot2c_f32_bf16 v129, v78, v1
  v_cvt_pk_bf16_f32 v2, v107, v214
  v_cvt_pk_bf16_f32 v3, v214, v107
  s_waitcnt lgkmcnt(8)
  v_dot2c_f32_bf16 v112, v79, v2
  v_dot2c_f32_bf16 v113, v79, v3
  s_waitcnt lgkmcnt(7)
  v_dot2c_f32_bf16 v114, v80, v2
  v_dot2c_f32_bf16 v115, v80, v3
  s_waitcnt lgkmcnt(6)
  v_dot2c_f32_bf16 v116, v81, v2
  v_dot2c_f32_bf16 v117, v81, v3
  s_waitcnt lgkmcnt(5)
  v_dot2c_f32_bf16 v118, v82, v2
  v_dot2c_f32_bf16 v119, v82, v3
  s_waitcnt lgkmcnt(4)
  v_dot2c_f32_bf16 v120, v83, v2
  v_dot2c_f32_bf16 v121, v83, v3
  s_waitcnt lgkmcnt(3)
  v_dot2c_f32_bf16 v122, v84, v2
  v_dot2c_f32_bf16 v123, v84, v3
  s_waitcnt lgkmcnt(2)
  v_dot2c_f32_bf16 v124, v85, v2
  v_dot2c_f32_bf16 v125, v85, v3
  s_waitcnt lgkmcnt(1)
  v_dot2c_f32_bf16 v126, v86, v2
  v_dot2c_f32_bf16 v127, v86, v3
  s_waitcnt lgkmcnt(0)
  v_dot2c_f32_bf16 v128, v87, v2
  v_dot2c_f32_bf16 v129, v87, v3
  v_cvt_pk_bf16_f32 v132, v112, v113
  v_cvt_pk_bf16_f32 v133, v114, v115
  v_cvt_pk_bf16_f32 v134, v116, v117
  v_cvt_pk_bf16_f32 v135, v118, v119
  v_cvt_pk_bf16_f32 v136, v120, v121
  v_cvt_pk_bf16_f32 v137, v122, v123
  v_cvt_pk_bf16_f32 v138, v124, v125
  v_cvt_pk_bf16_f32 v139, v126, v127
  v_cvt_pk_bf16_f32 v140, v128, v129
  buffer_store_dwordx4 v[132:135], v220, s[8:11], s64 offen sc1
  buffer_store_dwordx4 v[136:139], v220, s[8:11], s64 offen offset:16 sc1
  buffer_store_dword v140, v220, s[8:11], s64 offen offset:32 sc1
  v_add_u32 v219, 33024, v219
  s_add_u32 s66, s66, 64
  s_add_u32 s64, s64, 73728
  ds_read_b32 v0, v219 offset:7224
  ds_read_b32 v1, v219 offset:7228
  ds_read_b32 v2, v219 offset:7232
  ds_read_b32 v3, v219 offset:7236
  ds_read_b32 v4, v219 offset:7240
  ds_read_b32 v5, v219 offset:7244
  ds_read_b32 v6, v219 offset:7248
  ds_read_b32 v7, v219 offset:7252
  ds_read_b32 v8, v219 offset:7256
  ds_read_b32 v16, v219 offset:7368
  ds_read_b32 v17, v219 offset:7372
  ds_read_b32 v18, v219 offset:7376
  ds_read_b32 v19, v219 offset:7380
  ds_read_b32 v20, v219 offset:7384
  ds_read_b32 v21, v219 offset:7388
  ds_read_b32 v22, v219 offset:7392
  ds_read_b32 v23, v219 offset:7396
  ds_read_b32 v24, v219 offset:7400
  ds_read_b32 v25, v219 offset:6336
  ds_read_b32 v26, v219 offset:6340
  ds_read_b32 v27, v219 offset:6344
  ds_read_b32 v28, v219 offset:6348
  ds_read_b32 v29, v219 offset:6352
  ds_read_b32 v30, v219 offset:6356
  ds_read_b32 v31, v219 offset:6360
  ds_read_b32 v32, v219 offset:6364
  ds_read_b32 v33, v219 offset:6368
  ds_read_b32 v34, v219 offset:5304
  ds_read_b32 v35, v219 offset:5308
  ds_read_b32 v36, v219 offset:5312
  ds_read_b32 v37, v219 offset:5316
  ds_read_b32 v38, v219 offset:5320
  ds_read_b32 v39, v219 offset:5324
  ds_read_b32 v40, v219 offset:5328
  ds_read_b32 v41, v219 offset:5332
  ds_read_b32 v42, v219 offset:5336
  ds_read_b32 v43, v219 offset:4272
  ds_read_b32 v44, v219 offset:4276
  ds_read_b32 v45, v219 offset:4280
  ds_read_b32 v46, v219 offset:4284
  ds_read_b32 v47, v219 offset:4288
  ds_read_b32 v48, v219 offset:4292
  ds_read_b32 v49, v219 offset:4296
  ds_read_b32 v50, v219 offset:4300
  ds_read_b32 v51, v219 offset:4304
  ds_read_b32 v52, v219 offset:3240
  ds_read_b32 v53, v219 offset:3244
  ds_read_b32 v54, v219 offset:3248
  ds_read_b32 v55, v219 offset:3252
  ds_read_b32 v56, v219 offset:3256
  ds_read_b32 v57, v219 offset:3260
  ds_read_b32 v58, v219 offset:3264
  ds_read_b32 v59, v219 offset:3268
  ds_read_b32 v60, v219 offset:3272
  ds_read_b32 v61, v219 offset:2208
  ds_read_b32 v62, v219 offset:2212
  ds_read_b32 v63, v219 offset:2216
  ds_read_b32 v64, v219 offset:2220
  ds_read_b32 v65, v219 offset:2224
  ds_read_b32 v66, v219 offset:2228
  ds_read_b32 v67, v219 offset:2232
  ds_read_b32 v68, v219 offset:2236
  ds_read_b32 v69, v219 offset:2240
  ds_read_b32 v70, v219 offset:1176
  ds_read_b32 v71, v219 offset:1180
  ds_read_b32 v72, v219 offset:1184
  ds_read_b32 v73, v219 offset:1188
  ds_read_b32 v74, v219 offset:1192
  ds_read_b32 v75, v219 offset:1196
  ds_read_b32 v76, v219 offset:1200
  ds_read_b32 v77, v219 offset:1204
  ds_read_b32 v78, v219 offset:1208
  ds_read_b32 v79, v219 offset:144
  ds_read_b32 v80, v219 offset:148
  ds_read_b32 v81, v219 offset:152
  ds_read_b32 v82, v219 offset:156
  ds_read_b32 v83, v219 offset:160
  ds_read_b32 v84, v219 offset:164
  ds_read_b32 v85, v219 offset:168
  ds_read_b32 v86, v219 offset:172
  ds_read_b32 v87, v219 offset:176
  v_mov_b32 v100, 0
  v_mov_b32 v101, 0
  v_mov_b32 v102, 0
  v_mov_b32 v103, 0
  v_mov_b32 v104, 0
  v_mov_b32 v105, 0
  v_mov_b32 v106, 0
  v_mov_b32 v107, 0
  s_waitcnt lgkmcnt(15)
  v_dot2c_f32_bf16 v100, v0, v16
  v_dot2c_f32_bf16 v101, v0, v25
  v_dot2c_f32_bf16 v102, v0, v34
  v_dot2c_f32_bf16 v103, v0, v43
  v_dot2c_f32_bf16 v104, v0, v52
  v_dot2c_f32_bf16 v105, v0, v61
  v_dot2c_f32_bf16 v106, v0, v70
  s_waitcnt lgkmcnt(8)
  v_dot2c_f32_bf16 v107, v0, v79
  v_dot2c_f32_bf16 v100, v1, v17
  v_dot2c_f32_bf16 v101, v1, v26
  v_dot2c_f32_bf16 v102, v1, v35
  v_dot2c_f32_bf16 v103, v1, v44
  v_dot2c_f32_bf16 v104, v1, v53
  v_dot2c_f32_bf16 v105, v1, v62
  v_dot2c_f32_bf16 v106, v1, v71
  s_waitcnt lgkmcnt(7)
  v_dot2c_f32_bf16 v107, v1, v80
  v_dot2c_f32_bf16 v100, v2, v18
  v_dot2c_f32_bf16 v101, v2, v27
  v_dot2c_f32_bf16 v102, v2, v36
  v_dot2c_f32_bf16 v103, v2, v45
  v_dot2c_f32_bf16 v104, v2, v54
  v_dot2c_f32_bf16 v105, v2, v63
  v_dot2c_f32_bf16 v106, v2, v72
  s_waitcnt lgkmcnt(6)
  v_dot2c_f32_bf16 v107, v2, v81
  v_dot2c_f32_bf16 v100, v3, v19
  v_dot2c_f32_bf16 v101, v3, v28
  v_dot2c_f32_bf16 v102, v3, v37
  v_dot2c_f32_bf16 v103, v3, v46
  v_dot2c_f32_bf16 v104, v3, v55
  v_dot2c_f32_bf16 v105, v3, v64
  v_dot2c_f32_bf16 v106, v3, v73
  s_waitcnt lgkmcnt(5)
  v_dot2c_f32_bf16 v107, v3, v82
  v_dot2c_f32_bf16 v100, v4, v20
  v_dot2c_f32_bf16 v101, v4, v29
  v_dot2c_f32_bf16 v102, v4, v38
  v_dot2c_f32_bf16 v103, v4, v47
  v_dot2c_f32_bf16 v104, v4, v56
  v_dot2c_f32_bf16 v105, v4, v65
  v_dot2c_f32_bf16 v106, v4, v74
  s_waitcnt lgkmcnt(4)
  v_dot2c_f32_bf16 v107, v4, v83
  v_dot2c_f32_bf16 v100, v5, v21
  v_dot2c_f32_bf16 v101, v5, v30
  v_dot2c_f32_bf16 v102, v5, v39
  v_dot2c_f32_bf16 v103, v5, v48
  v_dot2c_f32_bf16 v104, v5, v57
  v_dot2c_f32_bf16 v105, v5, v66
  v_dot2c_f32_bf16 v106, v5, v75
  s_waitcnt lgkmcnt(3)
  v_dot2c_f32_bf16 v107, v5, v84
  v_dot2c_f32_bf16 v100, v6, v22
  v_dot2c_f32_bf16 v101, v6, v31
  v_dot2c_f32_bf16 v102, v6, v40
  v_dot2c_f32_bf16 v103, v6, v49
  v_dot2c_f32_bf16 v104, v6, v58
  v_dot2c_f32_bf16 v105, v6, v67
  v_dot2c_f32_bf16 v106, v6, v76
  s_waitcnt lgkmcnt(2)
  v_dot2c_f32_bf16 v107, v6, v85
  v_dot2c_f32_bf16 v100, v7, v23
  v_dot2c_f32_bf16 v101, v7, v32
  v_dot2c_f32_bf16 v102, v7, v41
  v_dot2c_f32_bf16 v103, v7, v50
  v_dot2c_f32_bf16 v104, v7, v59
  v_dot2c_f32_bf16 v105, v7, v68
  v_dot2c_f32_bf16 v106, v7, v77
  s_waitcnt lgkmcnt(1)
  v_dot2c_f32_bf16 v107, v7, v86
  v_dot2c_f32_bf16 v100, v8, v24
  v_dot2c_f32_bf16 v101, v8, v33
  v_dot2c_f32_bf16 v102, v8, v42
  v_dot2c_f32_bf16 v103, v8, v51
  v_dot2c_f32_bf16 v104, v8, v60
  v_dot2c_f32_bf16 v105, v8, v69
  v_dot2c_f32_bf16 v106, v8, v78
  s_waitcnt lgkmcnt(0)
  v_dot2c_f32_bf16 v107, v8, v87
  ds_read_b32 v16, v219 offset:7512
  ds_read_b32 v17, v219 offset:7516
  ds_read_b32 v18, v219 offset:7520
  ds_read_b32 v19, v219 offset:7524
  ds_read_b32 v20, v219 offset:7528
  ds_read_b32 v21, v219 offset:7532
  ds_read_b32 v22, v219 offset:7536
  ds_read_b32 v23, v219 offset:7540
  ds_read_b32 v24, v219 offset:7544
  ds_read_b32 v25, v219 offset:6480
  ds_read_b32 v26, v219 offset:6484
  ds_read_b32 v27, v219 offset:6488
  ds_read_b32 v28, v219 offset:6492
  ds_read_b32 v29, v219 offset:6496
  ds_read_b32 v30, v219 offset:6500
  ds_read_b32 v31, v219 offset:6504
  ds_read_b32 v32, v219 offset:6508
  ds_read_b32 v33, v219 offset:6512
  ds_read_b32 v34, v219 offset:5448
  ds_read_b32 v35, v219 offset:5452
  ds_read_b32 v36, v219 offset:5456
  ds_read_b32 v37, v219 offset:5460
  ds_read_b32 v38, v219 offset:5464
  ds_read_b32 v39, v219 offset:5468
  ds_read_b32 v40, v219 offset:5472
  ds_read_b32 v41, v219 offset:5476
  ds_read_b32 v42, v219 offset:5480
  ds_read_b32 v43, v219 offset:4416
  ds_read_b32 v44, v219 offset:4420
  ds_read_b32 v45, v219 offset:4424
  ds_read_b32 v46, v219 offset:4428
  ds_read_b32 v47, v219 offset:4432
  ds_read_b32 v48, v219 offset:4436
  ds_read_b32 v49, v219 offset:4440
  ds_read_b32 v50, v219 offset:4444
  ds_read_b32 v51, v219 offset:4448
  ds_read_b32 v52, v219 offset:3384
  ds_read_b32 v53, v219 offset:3388
  ds_read_b32 v54, v219 offset:3392
  ds_read_b32 v55, v219 offset:3396
  ds_read_b32 v56, v219 offset:3400
  ds_read_b32 v57, v219 offset:3404
  ds_read_b32 v58, v219 offset:3408
  ds_read_b32 v59, v219 offset:3412
  ds_read_b32 v60, v219 offset:3416
  ds_read_b32 v61, v219 offset:2352
  ds_read_b32 v62, v219 offset:2356
  ds_read_b32 v63, v219 offset:2360
  ds_read_b32 v64, v219 offset:2364
  ds_read_b32 v65, v219 offset:2368
  ds_read_b32 v66, v219 offset:2372
  ds_read_b32 v67, v219 offset:2376
  ds_read_b32 v68, v219 offset:2380
  ds_read_b32 v69, v219 offset:2384
  ds_read_b32 v70, v219 offset:1320
  ds_read_b32 v71, v219 offset:1324
  ds_read_b32 v72, v219 offset:1328
  ds_read_b32 v73, v219 offset:1332
  ds_read_b32 v74, v219 offset:1336
  ds_read_b32 v75, v219 offset:1340
  ds_read_b32 v76, v219 offset:1344
  ds_read_b32 v77, v219 offset:1348
  ds_read_b32 v78, v219 offset:1352
  ds_read_b32 v79, v219 offset:288
  ds_read_b32 v80, v219 offset:292
  ds_read_b32 v81, v219 offset:296
  ds_read_b32 v82, v219 offset:300
  ds_read_b32 v83, v219 offset:304
  ds_read_b32 v84, v219 offset:308
  ds_read_b32 v85, v219 offset:312
  ds_read_b32 v86, v219 offset:316
  ds_read_b32 v87, v219 offset:320
  v_add_u32 v211, s66, v200
  v_mov_b32 v212, 0xf149f2ca
  v_mul_f32 v100, s57, v100
  v_mul_f32 v101, s57, v101
  v_mul_f32 v102, s57, v102
  v_mul_f32 v103, s57, v103
  v_mul_f32 v104, s57, v104
  v_mul_f32 v105, s57, v105
  v_mul_f32 v106, s57, v106
  v_mul_f32 v107, s57, v107
  v_cmp_gt_u32 vcc, 2, v211
  s_nop 1
  v_cndmask_b32 v101, v101, v212, vcc
  v_cmp_gt_u32 vcc, 4, v211
  s_nop 1
  v_cndmask_b32 v102, v102, v212, vcc
  v_cmp_gt_u32 vcc, 6, v211
  s_nop 1
  v_cndmask_b32 v103, v103, v212, vcc
  v_cmp_gt_u32 vcc, 8, v211
  s_nop 1
  v_cndmask_b32 v104, v104, v212, vcc
  v_cmp_gt_u32 vcc, 10, v211
  s_nop 1
  v_cndmask_b32 v105, v105, v212, vcc
  v_cmp_gt_u32 vcc, 12, v211
  s_nop 1
  v_cndmask_b32 v106, v106, v212, vcc
  v_cmp_gt_u32 vcc, 14, v211
  s_nop 1
  v_cndmask_b32 v107, v107, v212, vcc
  v_max3_f32 v213, v100, v101, v102
  v_max3_f32 v213, v213, v103, v104
  v_max3_f32 v213, v213, v105, v106
  v_max_f32 v213, v213, v107
  v_sub_f32 v100, v100, v213
  v_sub_f32 v101, v101, v213
  v_sub_f32 v102, v102, v213
  v_sub_f32 v103, v103, v213
  v_sub_f32 v104, v104, v213
  v_sub_f32 v105, v105, v213
  v_sub_f32 v106, v106, v213
  v_sub_f32 v107, v107, v213
  v_exp_f32 v100, v100
  v_exp_f32 v101, v101
  v_exp_f32 v102, v102
  v_exp_f32 v103, v103
  v_exp_f32 v104, v104
  v_exp_f32 v105, v105
  v_exp_f32 v106, v106
  v_exp_f32 v107, v107
  v_add_f32 v213, v100, v101
  v_add_f32 v213, v213, v102
  v_add_f32 v213, v213, v103
  v_add_f32 v213, v213, v104
  v_add_f32 v213, v213, v105
  v_add_f32 v213, v213, v106
  v_add_f32 v213, v213, v107
  v_rcp_f32 v213, v213
  v_mov_b32 v214, 0
  v_mul_f32 v100, v213, v100
  v_mul_f32 v101, v213, v101
  v_mul_f32 v102, v213, v102
  v_mul_f32 v103, v213, v103
  v_mul_f32 v104, v213, v104
  v_mul_f32 v105, v213, v105
  v_mul_f32 v106, v213, v106
  v_mul_f32 v107, v213, v107
  v_mov_b32 v112, 0
  v_mov_b32 v113, 0
  v_mov_b32 v114, 0
  v_mov_b32 v115, 0
  v_mov_b32 v116, 0
  v_mov_b32 v117, 0
  v_mov_b32 v118, 0
  v_mov_b32 v119, 0
  v_mov_b32 v120, 0
  v_mov_b32 v121, 0
  v_mov_b32 v122, 0
  v_mov_b32 v123, 0
  v_mov_b32 v124, 0
  v_mov_b32 v125, 0
  v_mov_b32 v126, 0
  v_mov_b32 v127, 0
  v_mov_b32 v128, 0
  v_mov_b32 v129, 0
  v_cvt_pk_bf16_f32 v0, v100, v214
  v_cvt_pk_bf16_f32 v1, v214, v100
  s_waitcnt lgkmcnt(15)
  v_dot2c_f32_bf16 v112, v16, v0
  v_dot2c_f32_bf16 v113, v16, v1
  v_dot2c_f32_bf16 v114, v17, v0
  v_dot2c_f32_bf16 v115, v17, v1
  v_dot2c_f32_bf16 v116, v18, v0
  v_dot2c_f32_bf16 v117, v18, v1
  v_dot2c_f32_bf16 v118, v19, v0
  v_dot2c_f32_bf16 v119, v19, v1
  v_dot2c_f32_bf16 v120, v20, v0
  v_dot2c_f32_bf16 v121, v20, v1
  v_dot2c_f32_bf16 v122, v21, v0
  v_dot2c_f32_bf16 v123, v21, v1
  v_dot2c_f32_bf16 v124, v22, v0
  v_dot2c_f32_bf16 v125, v22, v1
  v_dot2c_f32_bf16 v126, v23, v0
  v_dot2c_f32_bf16 v127, v23, v1
  v_dot2c_f32_bf16 v128, v24, v0
  v_dot2c_f32_bf16 v129, v24, v1
  v_cvt_pk_bf16_f32 v2, v101, v214
  v_cvt_pk_bf16_f32 v3, v214, v101
  v_dot2c_f32_bf16 v112, v25, v2
  v_dot2c_f32_bf16 v113, v25, v3
  v_dot2c_f32_bf16 v114, v26, v2
  v_dot2c_f32_bf16 v115, v26, v3
  v_dot2c_f32_bf16 v116, v27, v2
  v_dot2c_f32_bf16 v117, v27, v3
  v_dot2c_f32_bf16 v118, v28, v2
  v_dot2c_f32_bf16 v119, v28, v3
  v_dot2c_f32_bf16 v120, v29, v2
  v_dot2c_f32_bf16 v121, v29, v3
  v_dot2c_f32_bf16 v122, v30, v2
  v_dot2c_f32_bf16 v123, v30, v3
  v_dot2c_f32_bf16 v124, v31, v2
  v_dot2c_f32_bf16 v125, v31, v3
  v_dot2c_f32_bf16 v126, v32, v2
  v_dot2c_f32_bf16 v127, v32, v3
  v_dot2c_f32_bf16 v128, v33, v2
  v_dot2c_f32_bf16 v129, v33, v3
  v_cvt_pk_bf16_f32 v0, v102, v214
  v_cvt_pk_bf16_f32 v1, v214, v102
  v_dot2c_f32_bf16 v112, v34, v0
  v_dot2c_f32_bf16 v113, v34, v1
  v_dot2c_f32_bf16 v114, v35, v0
  v_dot2c_f32_bf16 v115, v35, v1
  v_dot2c_f32_bf16 v116, v36, v0
  v_dot2c_f32_bf16 v117, v36, v1
  v_dot2c_f32_bf16 v118, v37, v0
  v_dot2c_f32_bf16 v119, v37, v1
  v_dot2c_f32_bf16 v120, v38, v0
  v_dot2c_f32_bf16 v121, v38, v1
  v_dot2c_f32_bf16 v122, v39, v0
  v_dot2c_f32_bf16 v123, v39, v1
  v_dot2c_f32_bf16 v124, v40, v0
  v_dot2c_f32_bf16 v125, v40, v1
  v_dot2c_f32_bf16 v126, v41, v0
  v_dot2c_f32_bf16 v127, v41, v1
  v_dot2c_f32_bf16 v128, v42, v0
  v_dot2c_f32_bf16 v129, v42, v1
  v_cvt_pk_bf16_f32 v2, v103, v214
  v_cvt_pk_bf16_f32 v3, v214, v103
  v_dot2c_f32_bf16 v112, v43, v2
  v_dot2c_f32_bf16 v113, v43, v3
  v_dot2c_f32_bf16 v114, v44, v2
  v_dot2c_f32_bf16 v115, v44, v3
  v_dot2c_f32_bf16 v116, v45, v2
  v_dot2c_f32_bf16 v117, v45, v3
  v_dot2c_f32_bf16 v118, v46, v2
  v_dot2c_f32_bf16 v119, v46, v3
  v_dot2c_f32_bf16 v120, v47, v2
  v_dot2c_f32_bf16 v121, v47, v3
  v_dot2c_f32_bf16 v122, v48, v2
  v_dot2c_f32_bf16 v123, v48, v3
  v_dot2c_f32_bf16 v124, v49, v2
  v_dot2c_f32_bf16 v125, v49, v3
  v_dot2c_f32_bf16 v126, v50, v2
  v_dot2c_f32_bf16 v127, v50, v3
  v_dot2c_f32_bf16 v128, v51, v2
  v_dot2c_f32_bf16 v129, v51, v3
  v_cvt_pk_bf16_f32 v0, v104, v214
  v_cvt_pk_bf16_f32 v1, v214, v104
  v_dot2c_f32_bf16 v112, v52, v0
  v_dot2c_f32_bf16 v113, v52, v1
  v_dot2c_f32_bf16 v114, v53, v0
  v_dot2c_f32_bf16 v115, v53, v1
  v_dot2c_f32_bf16 v116, v54, v0
  v_dot2c_f32_bf16 v117, v54, v1
  v_dot2c_f32_bf16 v118, v55, v0
  v_dot2c_f32_bf16 v119, v55, v1
  v_dot2c_f32_bf16 v120, v56, v0
  v_dot2c_f32_bf16 v121, v56, v1
  v_dot2c_f32_bf16 v122, v57, v0
  v_dot2c_f32_bf16 v123, v57, v1
  v_dot2c_f32_bf16 v124, v58, v0
  v_dot2c_f32_bf16 v125, v58, v1
  v_dot2c_f32_bf16 v126, v59, v0
  v_dot2c_f32_bf16 v127, v59, v1
  v_dot2c_f32_bf16 v128, v60, v0
  v_dot2c_f32_bf16 v129, v60, v1
  v_cvt_pk_bf16_f32 v2, v105, v214
  v_cvt_pk_bf16_f32 v3, v214, v105
  v_dot2c_f32_bf16 v112, v61, v2
  v_dot2c_f32_bf16 v113, v61, v3
  v_dot2c_f32_bf16 v114, v62, v2
  v_dot2c_f32_bf16 v115, v62, v3
  v_dot2c_f32_bf16 v116, v63, v2
  v_dot2c_f32_bf16 v117, v63, v3
  v_dot2c_f32_bf16 v118, v64, v2
  v_dot2c_f32_bf16 v119, v64, v3
  v_dot2c_f32_bf16 v120, v65, v2
  v_dot2c_f32_bf16 v121, v65, v3
  v_dot2c_f32_bf16 v122, v66, v2
  v_dot2c_f32_bf16 v123, v66, v3
  v_dot2c_f32_bf16 v124, v67, v2
  v_dot2c_f32_bf16 v125, v67, v3
  v_dot2c_f32_bf16 v126, v68, v2
  v_dot2c_f32_bf16 v127, v68, v3
  v_dot2c_f32_bf16 v128, v69, v2
  v_dot2c_f32_bf16 v129, v69, v3
  v_cvt_pk_bf16_f32 v0, v106, v214
  v_cvt_pk_bf16_f32 v1, v214, v106
  v_dot2c_f32_bf16 v112, v70, v0
  v_dot2c_f32_bf16 v113, v70, v1
  v_dot2c_f32_bf16 v114, v71, v0
  v_dot2c_f32_bf16 v115, v71, v1
  v_dot2c_f32_bf16 v116, v72, v0
  v_dot2c_f32_bf16 v117, v72, v1
  s_waitcnt lgkmcnt(14)
  v_dot2c_f32_bf16 v118, v73, v0
  v_dot2c_f32_bf16 v119, v73, v1
  s_waitcnt lgkmcnt(13)
  v_dot2c_f32_bf16 v120, v74, v0
  v_dot2c_f32_bf16 v121, v74, v1
  s_waitcnt lgkmcnt(12)
  v_dot2c_f32_bf16 v122, v75, v0
  v_dot2c_f32_bf16 v123, v75, v1
  s_waitcnt lgkmcnt(11)
  v_dot2c_f32_bf16 v124, v76, v0
  v_dot2c_f32_bf16 v125, v76, v1
  s_waitcnt lgkmcnt(10)
  v_dot2c_f32_bf16 v126, v77, v0
  v_dot2c_f32_bf16 v127, v77, v1
  s_waitcnt lgkmcnt(9)
  v_dot2c_f32_bf16 v128, v78, v0
  v_dot2c_f32_bf16 v129, v78, v1
  v_cvt_pk_bf16_f32 v2, v107, v214
  v_cvt_pk_bf16_f32 v3, v214, v107
  s_waitcnt lgkmcnt(8)
  v_dot2c_f32_bf16 v112, v79, v2
  v_dot2c_f32_bf16 v113, v79, v3
  s_waitcnt lgkmcnt(7)
  v_dot2c_f32_bf16 v114, v80, v2
  v_dot2c_f32_bf16 v115, v80, v3
  s_waitcnt lgkmcnt(6)
  v_dot2c_f32_bf16 v116, v81, v2
  v_dot2c_f32_bf16 v117, v81, v3
  s_waitcnt lgkmcnt(5)
  v_dot2c_f32_bf16 v118, v82, v2
  v_dot2c_f32_bf16 v119, v82, v3
  s_waitcnt lgkmcnt(4)
  v_dot2c_f32_bf16 v120, v83, v2
  v_dot2c_f32_bf16 v121, v83, v3
  s_waitcnt lgkmcnt(3)
  v_dot2c_f32_bf16 v122, v84, v2
  v_dot2c_f32_bf16 v123, v84, v3
  s_waitcnt lgkmcnt(2)
  v_dot2c_f32_bf16 v124, v85, v2
  v_dot2c_f32_bf16 v125, v85, v3
  s_waitcnt lgkmcnt(1)
  v_dot2c_f32_bf16 v126, v86, v2
  v_dot2c_f32_bf16 v127, v86, v3
  s_waitcnt lgkmcnt(0)
  v_dot2c_f32_bf16 v128, v87, v2
  v_dot2c_f32_bf16 v129, v87, v3
  v_cvt_pk_bf16_f32 v132, v112, v113
  v_cvt_pk_bf16_f32 v133, v114, v115
  v_cvt_pk_bf16_f32 v134, v116, v117
  v_cvt_pk_bf16_f32 v135, v118, v119
  v_cvt_pk_bf16_f32 v136, v120, v121
  v_cvt_pk_bf16_f32 v137, v122, v123
  v_cvt_pk_bf16_f32 v138, v124, v125
  v_cvt_pk_bf16_f32 v139, v126, v127
  v_cvt_pk_bf16_f32 v140, v128, v129
  buffer_store_dwordx4 v[132:135], v220, s[8:11], s64 offen sc1
  buffer_store_dwordx4 v[136:139], v220, s[8:11], s64 offen offset:16 sc1
  buffer_store_dword v140, v220, s[8:11], s64 offen offset:32 sc1
  s_mov_b32 s56, 36
  s_waitcnt vmcnt(0)
  s_barrier
  s_cmp_eq_u32 s52, 0
  s_cbranch_scc0 A_sig
  v_mov_b32 v211, 1
  v_mov_b32 v212, 0
  s_mov_b64 exec, 1
  buffer_atomic_add v211, v212, s[12:15], s56 offen
  s_mov_b64 exec, -1
A_sig:
  s_cmp_lt_u32 s53, 204
  s_cbranch_scc0 L_exit
  s_sub_u32 s54, s53, 96
  s_mul_i32 s55, s54, 3641
  s_lshr_b32 s55, s55, 16
  s_mul_i32 s56, s55, 18
  s_sub_u32 s70, s54, s56
  s_and_b32 s69, s55, 1
  s_lshr_b32 s68, s55, 1
  v_lshrrev_b32 v211, 2, v200
  v_mul_u32_u24 v211, 1152, v211
  v_and_b32 v212, 3, v200
  v_lshl_add_u32 v207, v212, 4, v211
  s_lshl_b32 s54, s70, 6
  s_mul_i32 s55, s52, 1179648
  s_add_u32 s62, s54, s55
  s_mul_i32 s55, s52, 184320
  s_add_u32 s63, s54, s55
  s_mul_i32 s61, s52, 40960
  v_bfe_u32 v211, v200, 2, 2
  v_lshlrev_b32 v212, 4, v212
  v_add_u32 v212, s61, v212
  v_lshl_add_u32 v212, v211, 6, v212
  v_lshrrev_b32 v213, 4, v200
  v_lshl_add_u32 v210, v213, 9, v212
  v_lshrrev_b32 v214, 5, v200
  v_lshl_add_u32 v209, v214, 10, v212
  v_and_b32 v214, 1, v213
  v_lshl_add_u32 v209, v214, 8, v209
  s_add_u32 m0, s61, 0
  s_add_u32 s54, s62, 0
  buffer_load_dwordx4 v207, s[28:31], s54 offen lds
  s_add_u32 m0, s61, 1024
  s_add_u32 s54, s62, 18432
  buffer_load_dwordx4 v207, s[28:31], s54 offen lds
  s_add_u32 m0, s61, 2048
  s_add_u32 s54, s62, 36864
  buffer_load_dwordx4 v207, s[28:31], s54 offen lds
  s_add_u32 m0, s61, 3072
  s_add_u32 s54, s62, 55296
  buffer_load_dwordx4 v207, s[28:31], s54 offen lds
  s_add_u32 m0, s61, 4096
  s_add_u32 s54, s62, 73728
  buffer_load_dwordx4 v207, s[28:31], s54 offen lds
  s_add_u32 m0, s61, 5120
  s_add_u32 s54, s62, 92160
  buffer_load_dwordx4 v207, s[28:31], s54 offen lds
  s_add_u32 m0, s61, 6144
  s_add_u32 s54, s62, 110592
  buffer_load_dwordx4 v207, s[28:31], s54 offen lds
  s_add_u32 m0, s61, 7168
  s_add_u32 s54, s62, 129024
  buffer_load_dwordx4 v207, s[28:31], s54 offen lds
  s_add_u32 m0, s61, 8192
  s_add_u32 s54, s62, 147456
  buffer_load_dwordx4 v207, s[28:31], s54 offen lds
  s_add_u32 m0, s61, 9216
  s_add_u32 s54, s62, 165888
  buffer_load_dwordx4 v207, s[28:31], s54 offen lds
  s_add_u32 m0, s61, 10240
  s_add_u32 s54, s62, 184320
  buffer_load_dwordx4 v207, s[28:31], s54 offen lds
  s_add_u32 m0, s61, 11264
  s_add_u32 s54, s62, 202752
  buffer_load_dwordx4 v207, s[28:31], s54 offen lds
  s_add_u32 m0, s61, 12288
  s_add_u32 s54, s62, 221184
  buffer_load_dwordx4 v207, s[28:31], s54 offen lds
  s_add_u32 m0, s61, 13312
  s_add_u32 s54, s62, 239616
  buffer_load_dwordx4 v207, s[28:31], s54 offen lds
  s_add_u32 m0, s61, 14336
  s_add_u32 s54, s62, 258048
  buffer_load_dwordx4 v207, s[28:31], s54 offen lds
  s_add_u32 m0, s61, 15360
  s_add_u32 s54, s62, 276480
  buffer_load_dwordx4 v207, s[28:31], s54 offen lds
  s_add_u32 m0, s61, 16384
  s_add_u32 s54, s62, 294912
  buffer_load_dwordx4 v207, s[28:31], s54 offen lds
  s_add_u32 m0, s61, 17408
  s_add_u32 s54, s62, 313344
  buffer_load_dwordx4 v207, s[28:31], s54 offen lds
  s_add_u32 m0, s61, 18432
  s_add_u32 s54, s62, 331776
  buffer_load_dwordx4 v207, s[28:31], s54 offen lds
  s_add_u32 m0, s61, 19456
  s_add_u32 s54, s62, 350208
  buffer_load_dwordx4 v207, s[28:31], s54 offen lds
  s_add_u32 m0, s61, 20480
  s_add_u32 s54, s62, 368640
  buffer_load_dwordx4 v207, s[28:31], s54 offen lds
  s_add_u32 m0, s61, 21504
  s_add_u32 s54, s62, 387072
  buffer_load_dwordx4 v207, s[28:31], s54 offen lds
  s_add_u32 m0, s61, 22528
  s_add_u32 s54, s62, 405504
  buffer_load_dwordx4 v207, s[28:31], s54 offen lds
  s_add_u32 m0, s61, 23552
  s_add_u32 s54, s62, 423936
  buffer_load_dwordx4 v207, s[28:31], s54 offen lds
  s_add_u32 m0, s61, 24576
  s_add_u32 s54, s62, 442368
  buffer_load_dwordx4 v207, s[28:31], s54 offen lds
  s_add_u32 m0, s61, 25600
  s_add_u32 s54, s62, 460800
  buffer_load_dwordx4 v207, s[28:31], s54 offen lds
  s_add_u32 m0, s61, 26624
  s_add_u32 s54, s62, 479232
  buffer_load_dwordx4 v207, s[28:31], s54 offen lds
  s_add_u32 m0, s61, 27648
  s_add_u32 s54, s62, 497664
  buffer_load_dwordx4 v207, s[28:31], s54 offen lds
  s_add_u32 m0, s61, 28672
  s_add_u32 s54, s62, 516096
  buffer_load_dwordx4 v207, s[28:31], s54 offen lds
  s_add_u32 m0, s61, 29696
  s_add_u32 s54, s62, 534528
  buffer_load_dwordx4 v207, s[28:31], s54 offen lds
  s_add_u32 m0, s61, 30720
  s_add_u32 s54, s62, 552960
  buffer_load_dwordx4 v207, s[28:31], s54 offen lds
  s_add_u32 m0, s61, 31744
  s_add_u32 s54, s62, 571392
  buffer_load_dwordx4 v207, s[28:31], s54 offen lds
  s_add_u32 m0, s61, 32768
  s_add_u32 s54, s62, 589824
  buffer_load_dwordx4 v207, s[28:31], s54 offen lds
  s_add_u32 m0, s61, 33792
  s_add_u32 s54, s62, 608256
  buffer_load_dwordx4 v207, s[28:31], s54 offen lds
  s_add_u32 m0, s61, 34816
  s_add_u32 s54, s62, 626688
  buffer_load_dwordx4 v207, s[28:31], s54 offen lds
  s_add_u32 m0, s61, 35840
  s_add_u32 s54, s62, 645120
  buffer_load_dwordx4 v207, s[28:31], s54 offen lds
  s_add_u32 m0, s61, 36864
  s_add_u32 s54, s62, 663552
  buffer_load_dwordx4 v207, s[28:31], s54 offen lds
  s_add_u32 m0, s61, 37888
  s_add_u32 s54, s62, 681984
  buffer_load_dwordx4 v207, s[28:31], s54 offen lds
  s_waitcnt vmcnt(36) lgkmcnt(0)
  s_add_u32 m0, s61, 38912
  s_add_u32 s54, s62, 700416
  buffer_load_dwordx4 v207, s[28:31], s54 offen lds
  s_add_u32 m0, s61, 39936
  s_add_u32 s54, s62, 718848
  buffer_load_dwordx4 v207, s[28:31], s54 offen lds
  ds_read_b64_tr_b16 a[0:1], v209 offset:0
  ds_read_b64_tr_b16 a[2:3], v209 offset:512
  ds_read_b64_tr_b16 a[4:5], v209 offset:8
  ds_read_b64_tr_b16 a[6:7], v209 offset:520
  s_waitcnt vmcnt(36) lgkmcnt(0)
  s_add_u32 m0, s61, 0
  s_add_u32 s54, s62, 737280
  buffer_load_dwordx4 v207, s[28:31], s54 offen lds
  s_add_u32 m0, s61, 1024
  s_add_u32 s54, s62, 755712
  buffer_load_dwordx4 v207, s[28:31], s54 offen lds
  ds_read_b64_tr_b16 a[8:9], v209 offset:2048
  ds_read_b64_tr_b16 a[10:11], v209 offset:2560
  ds_read_b64_tr_b16 a[12:13], v209 offset:2056
  ds_read_b64_tr_b16 a[14:15], v209 offset:2568
  s_waitcnt vmcnt(36) lgkmcnt(0)
  s_add_u32 m0, s61, 2048
  s_add_u32 s54, s62, 774144
  buffer_load_dwordx4 v207, s[28:31], s54 offen lds
  s_add_u32 m0, s61, 3072
  s_add_u32 s54, s62, 792576
  buffer_load_dwordx4 v207, s[28:31], s54 offen lds
  ds_read_b64_tr_b16 a[16:17], v209 offset:4096
  ds_read_b64_tr_b16 a[18:19], v209 offset:4608
  ds_read_b64_tr_b16 a[20:21], v209 offset:4104
  ds_read_b64_tr_b16 a[22:23], v209 offset:4616
  s_waitcnt vmcnt(36) lgkmcnt(0)
  s_add_u32 m0, s61, 4096
  s_add_u32 s54, s62, 811008
  buffer_load_dwordx4 v207, s[28:31], s54 offen lds
  s_add_u32 m0, s61, 5120
  s_add_u32 s54, s62, 829440
  buffer_load_dwordx4 v207, s[28:31], s54 offen lds
  ds_read_b64_tr_b16 a[24:25], v209 offset:6144
  ds_read_b64_tr_b16 a[26:27], v209 offset:6656
  ds_read_b64_tr_b16 a[28:29], v209 offset:6152
  ds_read_b64_tr_b16 a[30:31], v209 offset:6664
  s_waitcnt vmcnt(36) lgkmcnt(0)
  s_add_u32 m0, s61, 6144
  s_add_u32 s54, s62, 847872
  buffer_load_dwordx4 v207, s[28:31], s54 offen lds
  s_add_u32 m0, s61, 7168
  s_add_u32 s54, s62, 866304
  buffer_load_dwordx4 v207, s[28:31], s54 offen lds
  ds_read_b64_tr_b16 a[32:33], v209 offset:8192
  ds_read_b64_tr_b16 a[34:35], v209 offset:8704
  ds_read_b64_tr_b16 a[36:37], v209 offset:8200
  ds_read_b64_tr_b16 a[38:39], v209 offset:8712
  s_waitcnt vmcnt(36) lgkmcnt(0)
  s_add_u32 m0, s61, 8192
  s_add_u32 s54, s62, 884736
  buffer_load_dwordx4 v207, s[28:31], s54 offen lds
  s_add_u32 m0, s61, 9216
  s_add_u32 s54, s62, 903168
  buffer_load_dwordx4 v207, s[28:31], s54 offen lds
  ds_read_b64_tr_b16 a[40:41], v209 offset:10240
  ds_read_b64_tr_b16 a[42:43], v209 offset:10752
  ds_read_b64_tr_b16 a[44:45], v209 offset:10248
  ds_read_b64_tr_b16 a[46:47], v209 offset:10760
  s_waitcnt vmcnt(36) lgkmcnt(0)
  s_add_u32 m0, s61, 10240
  s_add_u32 s54, s62, 921600
  buffer_load_dwordx4 v207, s[28:31], s54 offen lds
  s_add_u32 m0, s61, 11264
  s_add_u32 s54, s62, 940032
  buffer_load_dwordx4 v207, s[28:31], s54 offen lds
  ds_read_b64_tr_b16 a[48:49], v209 offset:12288
  ds_read_b64_tr_b16 a[50:51], v209 offset:12800
  ds_read_b64_tr_b16 a[52:53], v209 offset:12296
  ds_read_b64_tr_b16 a[54:55], v209 offset:12808
  s_waitcnt vmcnt(36) lgkmcnt(0)
  s_add_u32 m0, s61, 12288
  s_add_u32 s54, s62, 958464
  buffer_load_dwordx4 v207, s[28:31], s54 offen lds
  s_add_u32 m0, s61, 13312
  s_add_u32 s54, s62, 976896
  buffer_load_dwordx4 v207, s[28:31], s54 offen lds
  ds_read_b64_tr_b16 a[56:57], v209 offset:14336
  ds_read_b64_tr_b16 a[58:59], v209 offset:14848
  ds_read_b64_tr_b16 a[60:61], v209 offset:14344
  ds_read_b64_tr_b16 a[62:63], v209 offset:14856
  s_waitcnt vmcnt(36) lgkmcnt(0)
  s_add_u32 m0, s61, 14336
  s_add_u32 s54, s62, 995328
  buffer_load_dwordx4 v207, s[28:31], s54 offen lds
  s_add_u32 m0, s61, 15360
  s_add_u32 s54, s62, 1013760
  buffer_load_dwordx4 v207, s[28:31], s54 offen lds
  ds_read_b64_tr_b16 a[64:65], v209 offset:16384
  ds_read_b64_tr_b16 a[66:67], v209 offset:16896
  ds_read_b64_tr_b16 a[68:69], v209 offset:16392
  ds_read_b64_tr_b16 a[70:71], v209 offset:16904
  s_waitcnt vmcnt(36) lgkmcnt(0)
  s_add_u32 m0, s61, 16384
  s_add_u32 s54, s62, 1032192
  buffer_load_dwordx4 v207, s[28:31], s54 offen lds
  s_add_u32 m0, s61, 17408
  s_add_u32 s54, s62, 1050624
  buffer_load_dwordx4 v207, s[28:31], s54 offen lds
  ds_read_b64_tr_b16 a[72:73], v209 offset:18432
  ds_read_b64_tr_b16 a[74:75], v209 offset:18944
  ds_read_b64_tr_b16 a[76:77], v209 offset:18440
  ds_read_b64_tr_b16 a[78:79], v209 offset:18952
  s_waitcnt vmcnt(36) lgkmcnt(0)
  s_add_u32 m0, s61, 18432
  s_add_u32 s54, s62, 1069056
  buffer_load_dwordx4 v207, s[28:31], s54 offen lds
  s_add_u32 m0, s61, 19456
  s_add_u32 s54, s62, 1087488
  buffer_load_dwordx4 v207, s[28:31], s54 offen lds
  ds_read_b64_tr_b16 a[80:81], v209 offset:20480
  ds_read_b64_tr_b16 a[82:83], v209 offset:20992
  ds_read_b64_tr_b16 a[84:85], v209 offset:20488
  ds_read_b64_tr_b16 a[86:87], v209 offset:21000
  s_waitcnt vmcnt(36) lgkmcnt(0)
  s_add_u32 m0, s61, 20480
  s_add_u32 s54, s62, 1105920
  buffer_load_dwordx4 v207, s[28:31], s54 offen lds
  s_add_u32 m0, s61, 21504
  s_add_u32 s54, s62, 1124352
  buffer_load_dwordx4 v207, s[28:31], s54 offen lds
  ds_read_b64_tr_b16 a[88:89], v209 offset:22528
  ds_read_b64_tr_b16 a[90:91], v209 offset:23040
  ds_read_b64_tr_b16 a[92:93], v209 offset:22536
  ds_read_b64_tr_b16 a[94:95], v209 offset:23048
  s_waitcnt vmcnt(36) lgkmcnt(0)
  s_add_u32 m0, s61, 22528
  s_add_u32 s54, s62, 1142784
  buffer_load_dwordx4 v207, s[28:31], s54 offen lds
  s_add_u32 m0, s61, 23552
  s_add_u32 s54, s62, 1161216
  buffer_load_dwordx4 v207, s[28:31], s54 offen lds
  ds_read_b64_tr_b16 a[96:97], v209 offset:24576
  ds_read_b64_tr_b16 a[98:99], v209 offset:25088
  ds_read_b64_tr_b16 a[100:101], v209 offset:24584
  ds_read_b64_tr_b16 a[102:103], v209 offset:25096
  s_waitcnt vmcnt(36) lgkmcnt(0)
  s_add_u32 m0, s61, 24576
  s_add_u32 s54, s63, 0
  buffer_load_dwordx4 v207, s[40:43], s54 offen lds
  s_add_u32 m0, s61, 25600
  s_add_u32 s54, s63, 18432
  buffer_load_dwordx4 v207, s[40:43], s54 offen lds
  ds_read_b64_tr_b16 a[104:105], v209 offset:26624
  ds_read_b64_tr_b16 a[106:107], v209 offset:27136
  ds_read_b64_tr_b16 a[108:109], v209 offset:26632
  ds_read_b64_tr_b16 a[110:111], v209 offset:27144
  s_waitcnt vmcnt(36) lgkmcnt(0)
  s_add_u32 m0, s61, 26624
  s_add_u32 s54, s63, 36864
  buffer_load_dwordx4 v207, s[40:43], s54 offen lds
  s_add_u32 m0, s61, 27648
  s_add_u32 s54, s63, 55296
  buffer_load_dwordx4 v207, s[40:43], s54 offen lds
  ds_read_b64_tr_b16 a[112:113], v209 offset:28672
  ds_read_b64_tr_b16 a[114:115], v209 offset:29184
  ds_read_b64_tr_b16 a[116:117], v209 offset:28680
  ds_read_b64_tr_b16 a[118:119], v209 offset:29192
  s_waitcnt vmcnt(36) lgkmcnt(0)
  s_add_u32 m0, s61, 28672
  s_add_u32 s54, s63, 73728
  buffer_load_dwordx4 v207, s[40:43], s54 offen lds
  s_add_u32 m0, s61, 29696
  s_add_u32 s54, s63, 92160
  buffer_load_dwordx4 v207, s[40:43], s54 offen lds
  ds_read_b64_tr_b16 a[120:121], v209 offset:30720
  ds_read_b64_tr_b16 a[122:123], v209 offset:31232
  ds_read_b64_tr_b16 a[124:125], v209 offset:30728
  ds_read_b64_tr_b16 a[126:127], v209 offset:31240
  s_waitcnt vmcnt(36) lgkmcnt(0)
  s_add_u32 m0, s61, 30720
  s_add_u32 s54, s63, 110592
  buffer_load_dwordx4 v207, s[40:43], s54 offen lds
  s_add_u32 m0, s61, 31744
  s_add_u32 s54, s63, 129024
  buffer_load_dwordx4 v207, s[40:43], s54 offen lds
  ds_read_b64_tr_b16 a[128:129], v209 offset:32768
  ds_read_b64_tr_b16 a[130:131], v209 offset:33280
  ds_read_b64_tr_b16 a[132:133], v209 offset:32776
  ds_read_b64_tr_b16 a[134:135], v209 offset:33288
  s_waitcnt vmcnt(36) lgkmcnt(0)
  s_add_u32 m0, s61, 32768
  s_add_u32 s54, s63, 147456
  buffer_load_dwordx4 v207, s[40:43], s54 offen lds
  s_add_u32 m0, s61, 33792
  s_add_u32 s54, s63, 165888
  buffer_load_dwordx4 v207, s[40:43], s54 offen lds
  ds_read_b64_tr_b16 a[136:137], v209 offset:34816
  ds_read_b64_tr_b16 a[138:139], v209 offset:35328
  ds_read_b64_tr_b16 a[140:141], v209 offset:34824
  ds_read_b64_tr_b16 a[142:143], v209 offset:35336
  s_waitcnt vmcnt(36) lgkmcnt(0)
  ds_read_b64_tr_b16 a[144:145], v209 offset:36864
  ds_read_b64_tr_b16 a[146:147], v209 offset:37376
  ds_read_b64_tr_b16 a[148:149], v209 offset:36872
  ds_read_b64_tr_b16 a[150:151], v209 offset:37384
  s_waitcnt vmcnt(34) lgkmcnt(0)
  ds_read_b64_tr_b16 a[152:153], v209 offset:38912
  ds_read_b64_tr_b16 a[154:155], v209 offset:39424
  ds_read_b64_tr_b16 a[156:157], v209 offset:38920
  ds_read_b64_tr_b16 a[158:159], v209 offset:39432
  s_waitcnt vmcnt(32) lgkmcnt(0)
  ds_read_b64_tr_b16 a[160:161], v209 offset:0
  ds_read_b64_tr_b16 a[162:163], v209 offset:512
  ds_read_b64_tr_b16 a[164:165], v209 offset:8
  ds_read_b64_tr_b16 a[166:167], v209 offset:520
  s_waitcnt vmcnt(30) lgkmcnt(0)
  ds_read_b64_tr_b16 a[168:169], v209 offset:2048
  ds_read_b64_tr_b16 a[170:171], v209 offset:2560
  ds_read_b64_tr_b16 a[172:173], v209 offset:2056
  ds_read_b64_tr_b16 a[174:175], v209 offset:2568
  s_waitcnt vmcnt(28) lgkmcnt(0)
  ds_read_b64_tr_b16 a[176:177], v209 offset:4096
  ds_read_b64_tr_b16 a[178:179], v209 offset:4608
  ds_read_b64_tr_b16 a[180:181], v209 offset:4104
  ds_read_b64_tr_b16 a[182:183], v209 offset:4616
  s_waitcnt vmcnt(26) lgkmcnt(0)
  ds_read_b64_tr_b16 a[184:185], v209 offset:6144
  ds_read_b64_tr_b16 a[186:187], v209 offset:6656
  ds_read_b64_tr_b16 a[188:189], v209 offset:6152
  ds_read_b64_tr_b16 a[190:191], v209 offset:6664
  s_waitcnt vmcnt(24) lgkmcnt(0)
  ds_read_b64_tr_b16 a[192:193], v209 offset:8192
  ds_read_b64_tr_b16 a[194:195], v209 offset:8704
  ds_read_b64_tr_b16 a[196:197], v209 offset:8200
  ds_read_b64_tr_b16 a[198:199], v209 offset:8712
  s_waitcnt vmcnt(22) lgkmcnt(0)
  ds_read_b64_tr_b16 a[200:201], v209 offset:10240
  ds_read_b64_tr_b16 a[202:203], v209 offset:10752
  ds_read_b64_tr_b16 a[204:205], v209 offset:10248
  ds_read_b64_tr_b16 a[206:207], v209 offset:10760
  s_waitcnt vmcnt(20) lgkmcnt(0)
  ds_read_b64_tr_b16 a[208:209], v209 offset:12288
  ds_read_b64_tr_b16 a[210:211], v209 offset:12800
  ds_read_b64_tr_b16 a[212:213], v209 offset:12296
  ds_read_b64_tr_b16 a[214:215], v209 offset:12808
  s_waitcnt vmcnt(18) lgkmcnt(0)
  ds_read_b64_tr_b16 a[216:217], v209 offset:14336
  ds_read_b64_tr_b16 a[218:219], v209 offset:14848
  ds_read_b64_tr_b16 a[220:221], v209 offset:14344
  ds_read_b64_tr_b16 a[222:223], v209 offset:14856
  s_waitcnt vmcnt(16) lgkmcnt(0)
  ds_read_b64_tr_b16 a[224:225], v209 offset:16384
  ds_read_b64_tr_b16 a[226:227], v209 offset:16896
  ds_read_b64_tr_b16 a[228:229], v209 offset:16392
  ds_read_b64_tr_b16 a[230:231], v209 offset:16904
  s_waitcnt vmcnt(14) lgkmcnt(0)
  ds_read_b64_tr_b16 a[232:233], v209 offset:18432
  ds_read_b64_tr_b16 a[234:235], v209 offset:18944
  ds_read_b64_tr_b16 a[236:237], v209 offset:18440
  ds_read_b64_tr_b16 a[238:239], v209 offset:18952
  s_waitcnt vmcnt(12) lgkmcnt(0)
  ds_read_b64_tr_b16 a[240:241], v209 offset:20480
  ds_read_b64_tr_b16 a[242:243], v209 offset:20992
  ds_read_b64_tr_b16 a[244:245], v209 offset:20488
  ds_read_b64_tr_b16 a[246:247], v209 offset:21000
  s_waitcnt vmcnt(10) lgkmcnt(0)
  ds_read_b64_tr_b16 a[248:249], v209 offset:22528
  ds_read_b64_tr_b16 a[250:251], v209 offset:23040
  ds_read_b64_tr_b16 a[252:253], v209 offset:22536
  ds_read_b64_tr_b16 a[254:255], v209 offset:23048
  s_waitcnt vmcnt(8) lgkmcnt(0)
  ds_read_b64_tr_b16 v[216:217], v210 offset:24576
  ds_read_b64_tr_b16 v[218:219], v210 offset:24832
  ds_read_b64_tr_b16 v[220:221], v210 offset:24584
  ds_read_b64_tr_b16 v[222:223], v210 offset:24840
  s_waitcnt vmcnt(6) lgkmcnt(0)
  ds_read_b64_tr_b16 v[224:225], v210 offset:26624
  ds_read_b64_tr_b16 v[226:227], v210 offset:26880
  ds_read_b64_tr_b16 v[228:229], v210 offset:26632
  ds_read_b64_tr_b16 v[230:231], v210 offset:26888
  s_waitcnt vmcnt(4) lgkmcnt(0)
  ds_read_b64_tr_b16 v[232:233], v210 offset:28672
  ds_read_b64_tr_b16 v[234:235], v210 offset:28928
  ds_read_b64_tr_b16 v[236:237], v210 offset:28680
  ds_read_b64_tr_b16 v[238:239], v210 offset:28936
  s_waitcnt vmcnt(2) lgkmcnt(0)
  ds_read_b64_tr_b16 v[240:241], v210 offset:30720
  ds_read_b64_tr_b16 v[242:243], v210 offset:30976
  ds_read_b64_tr_b16 v[244:245], v210 offset:30728
  ds_read_b64_tr_b16 v[246:247], v210 offset:30984
  s_waitcnt vmcnt(0) lgkmcnt(0)
  ds_read_b64_tr_b16 v[248:249], v210 offset:32768
  ds_read_b64_tr_b16 v[250:251], v210 offset:33024
  ds_read_b64_tr_b16 v[252:253], v210 offset:32776
  ds_read_b64_tr_b16 v[254:255], v210 offset:33032
  v_and_b32 v211, 15, v200
  s_lshl_b32 s54, s69, 4
  v_add_u32 v211, s54, v211
  v_lshl_add_u32 v212, v214, 5, v211
  v_lshlrev_b32 v164, 4, v212
  v_lshrrev_b32 v212, 5, v200
  v_lshl_add_u32 v164, v212, 10, v164
  v_mul_u32_u24 v167, 1152, v211
  v_lshl_add_u32 v167, v213, 4, v167
  v_lshlrev_b32 v166, 2, v211
  v_lshlrev_b32 v208, 2, v200
  s_lshl_b32 s54, s52, 11
  v_add_u32 v168, s54, v201
  s_mov_b32 s59, s68
  s_lshl_b32 s66, s68, 7
  s_add_u32 s66, s66, 105914368
  s_mov_b32 s56, 128
  s_mov_b32 s57, 36
  s_waitcnt lgkmcnt(0)
  s_cmp_eq_u32 s52, 0
  s_cbranch_scc0 O_p1_d
  s_mov_b32 exec_hi, 0
  s_mov_b32 exec_lo, -1
O_p1:
  buffer_load_dword v211, v208, s[12:15], s56 offen sc1
  s_add_u32 s65, s65, 1
  s_waitcnt vmcnt(0)
  v_cmp_gt_u32 vcc, 7, v211
  s_cbranch_vccz O_p1_x
  s_sleep 16
  s_cmp_lt_u32 s65, 131072
  s_cbranch_scc1 O_p1
O_p1_x:
  s_mov_b64 exec, -1
O_p1_d:
  s_barrier
  s_cmp_eq_u32 s52, 0
  s_cbranch_scc0 O_a_d
  s_mov_b32 exec_hi, 0
  s_mov_b32 exec_lo, 1
O_a:
  buffer_load_dword v211, v208, s[12:15], s57 offen sc1
  s_add_u32 s65, s65, 1
  s_waitcnt vmcnt(0)
  v_cmp_gt_u32 vcc, 0x80, v211
  s_cbranch_vccz O_a_x
  s_sleep 16
  s_cmp_lt_u32 s65, 131072
  s_cbranch_scc1 O_a
O_a_x:
  s_mov_b64 exec, -1
O_a_d:
  s_barrier
O_loop:
  s_mul_i32 s64, s59, 36864
  s_mul_i32 s54, s52, 320
  s_add_u32 s55, s64, s54
  s_add_u32 s55, s55, 62914560
  s_cmp_eq_u32 s52, 3
  s_cselect_b32 s56, 268435456, s55
  buffer_load_dwordx4 v[128:131], v167, s[8:11], s55 offen offset:0 sc1
  buffer_load_dwordx4 v[132:135], v167, s[8:11], s55 offen offset:64 sc1
  buffer_load_dwordx4 v[136:139], v167, s[8:11], s55 offen offset:128 sc1
  buffer_load_dwordx4 v[140:143], v167, s[8:11], s56 offen offset:192 sc1
  buffer_load_dwordx4 v[144:147], v167, s[8:11], s56 offen offset:256 sc1
  s_lshl_b32 s55, s59, 7
  s_add_u32 s55, s55, 67108864
  buffer_load_dword v165, v166, s[8:11], s55 offen sc1
  s_waitcnt vmcnt(5)
  v_mfma_f32_16x16x32_bf16 v[156:159], v[216:219], v[128:131], 0
  v_mfma_f32_16x16x32_bf16 v[160:163], v[220:223], v[128:131], 0
  s_waitcnt vmcnt(4)
  v_mfma_f32_16x16x32_bf16 v[156:159], v[224:227], v[132:135], v[156:159]
  v_mfma_f32_16x16x32_bf16 v[160:163], v[228:231], v[132:135], v[160:163]
  s_waitcnt vmcnt(3)
  v_mfma_f32_16x16x32_bf16 v[156:159], v[232:235], v[136:139], v[156:159]
  v_mfma_f32_16x16x32_bf16 v[160:163], v[236:239], v[136:139], v[160:163]
  s_waitcnt vmcnt(2)
  v_mfma_f32_16x16x32_bf16 v[156:159], v[240:243], v[140:143], v[156:159]
  v_mfma_f32_16x16x32_bf16 v[160:163], v[244:247], v[140:143], v[160:163]
  s_waitcnt vmcnt(1)
  v_mfma_f32_16x16x32_bf16 v[156:159], v[248:251], v[144:147], v[156:159]
  v_mfma_f32_16x16x32_bf16 v[160:163], v[252:255], v[144:147], v[160:163]
  s_waitcnt vmcnt(0)
  s_nop 2
  v_mul_f32 v156, v165, v156
  v_mul_f32 v157, v165, v157
  v_mul_f32 v158, v165, v158
  v_mul_f32 v159, v165, v159
  v_mul_f32 v160, v165, v160
  v_mul_f32 v161, v165, v161
  v_mul_f32 v162, v165, v162
  v_mul_f32 v163, v165, v163
  v_sub_f32 v165, 1.0, v165
  v_cvt_pk_bf16_f32 v165, v165, v165
  v_lshlrev_b32 v165, 16, v165
  s_add_u32 s71, s59, 3
  s_lshl_b32 s55, s59, 18
  s_lshl_b32 s54, s52, 16
  s_add_u32 s55, s55, s54
  s_add_u32 s62, s55, 44040192
  s_cmp_eq_u32 s52, 0
  s_cbranch_scc0 O_b_d
  s_mov_b32 exec_hi, 0
  s_mov_b32 exec_lo, -1
O_b:
  buffer_load_dword v211, v208, s[8:11], s66 offen sc1
  s_add_u32 s65, s65, 1
  s_waitcnt vmcnt(0)
  v_cmp_gt_u32 vcc, s71, v211
  s_cbranch_vccz O_b_x
  s_sleep 1
  s_cmp_lt_u32 s65, 131072
  s_cbranch_scc1 O_b
O_b_x:
  s_mov_b64 exec, -1
O_b_d:
  s_barrier
  buffer_load_dwordx4 v[0:3], v164, s[8:11], s62 offen offset:0 sc1
  buffer_load_dwordx4 v[4:7], v164, s[8:11], s62 offen offset:2048 sc1
  s_add_u32 s62, s62, 4096
  buffer_load_dwordx4 v[8:11], v164, s[8:11], s62 offen offset:0 sc1
  buffer_load_dwordx4 v[12:15], v164, s[8:11], s62 offen offset:2048 sc1
  s_add_u32 s62, s62, 4096
  buffer_load_dwordx4 v[16:19], v164, s[8:11], s62 offen offset:0 sc1
  buffer_load_dwordx4 v[20:23], v164, s[8:11], s62 offen offset:2048 sc1
  s_add_u32 s62, s62, 4096
  buffer_load_dwordx4 v[24:27], v164, s[8:11], s62 offen offset:0 sc1
  buffer_load_dwordx4 v[28:31], v164, s[8:11], s62 offen offset:2048 sc1
  s_add_u32 s62, s62, 4096
  buffer_load_dwordx4 v[32:35], v164, s[8:11], s62 offen offset:0 sc1
  buffer_load_dwordx4 v[36:39], v164, s[8:11], s62 offen offset:2048 sc1
  s_add_u32 s62, s62, 4096
  buffer_load_dwordx4 v[40:43], v164, s[8:11], s62 offen offset:0 sc1
  buffer_load_dwordx4 v[44:47], v164, s[8:11], s62 offen offset:2048 sc1
  s_add_u32 s62, s62, 4096
  buffer_load_dwordx4 v[48:51], v164, s[8:11], s62 offen offset:0 sc1
  buffer_load_dwordx4 v[52:55], v164, s[8:11], s62 offen offset:2048 sc1
  s_add_u32 s62, s62, 4096
  buffer_load_dwordx4 v[56:59], v164, s[8:11], s62 offen offset:0 sc1
  buffer_load_dwordx4 v[60:63], v164, s[8:11], s62 offen offset:2048 sc1
  s_add_u32 s62, s62, 4096
  buffer_load_dwordx4 v[64:67], v164, s[8:11], s62 offen offset:0 sc1
  buffer_load_dwordx4 v[68:71], v164, s[8:11], s62 offen offset:2048 sc1
  s_add_u32 s62, s62, 4096
  buffer_load_dwordx4 v[72:75], v164, s[8:11], s62 offen offset:0 sc1
  buffer_load_dwordx4 v[76:79], v164, s[8:11], s62 offen offset:2048 sc1
  s_add_u32 s62, s62, 4096
  buffer_load_dwordx4 v[80:83], v164, s[8:11], s62 offen offset:0 sc1
  buffer_load_dwordx4 v[84:87], v164, s[8:11], s62 offen offset:2048 sc1
  s_add_u32 s62, s62, 4096
  buffer_load_dwordx4 v[88:91], v164, s[8:11], s62 offen offset:0 sc1
  buffer_load_dwordx4 v[92:95], v164, s[8:11], s62 offen offset:2048 sc1
  s_add_u32 s62, s62, 4096
  buffer_load_dwordx4 v[96:99], v164, s[8:11], s62 offen offset:0 sc1
  buffer_load_dwordx4 v[100:103], v164, s[8:11], s62 offen offset:2048 sc1
  s_add_u32 s62, s62, 4096
  buffer_load_dwordx4 v[104:107], v164, s[8:11], s62 offen offset:0 sc1
  buffer_load_dwordx4 v[108:111], v164, s[8:11], s62 offen offset:2048 sc1
  s_add_u32 s62, s62, 4096
  buffer_load_dwordx4 v[112:115], v164, s[8:11], s62 offen offset:0 sc1
  buffer_load_dwordx4 v[116:119], v164, s[8:11], s62 offen offset:2048 sc1
  s_add_u32 s62, s62, 4096
  buffer_load_dwordx4 v[120:123], v164, s[8:11], s62 offen offset:0 sc1
  buffer_load_dwordx4 v[124:127], v164, s[8:11], s62 offen offset:2048 sc1
  s_add_u32 s62, s62, 4096
  s_waitcnt vmcnt(31)
  v_mfma_f32_16x16x32_bf16 v[148:151], a[0:3], v[0:3], 0
  v_mfma_f32_16x16x32_bf16 v[152:155], a[4:7], v[0:3], 0
  s_waitcnt vmcnt(30)
  v_mfma_f32_16x16x32_bf16 v[148:151], a[8:11], v[4:7], v[148:151]
  v_mfma_f32_16x16x32_bf16 v[152:155], a[12:15], v[4:7], v[152:155]
  s_waitcnt vmcnt(29)
  v_mfma_f32_16x16x32_bf16 v[148:151], a[16:19], v[8:11], v[148:151]
  v_mfma_f32_16x16x32_bf16 v[152:155], a[20:23], v[8:11], v[152:155]
  s_waitcnt vmcnt(28)
  v_mfma_f32_16x16x32_bf16 v[148:151], a[24:27], v[12:15], v[148:151]
  v_mfma_f32_16x16x32_bf16 v[152:155], a[28:31], v[12:15], v[152:155]
  s_waitcnt vmcnt(27)
  v_mfma_f32_16x16x32_bf16 v[148:151], a[32:35], v[16:19], v[148:151]
  v_mfma_f32_16x16x32_bf16 v[152:155], a[36:39], v[16:19], v[152:155]
  s_waitcnt vmcnt(26)
  v_mfma_f32_16x16x32_bf16 v[148:151], a[40:43], v[20:23], v[148:151]
  v_mfma_f32_16x16x32_bf16 v[152:155], a[44:47], v[20:23], v[152:155]
  s_waitcnt vmcnt(25)
  v_mfma_f32_16x16x32_bf16 v[148:151], a[48:51], v[24:27], v[148:151]
  v_mfma_f32_16x16x32_bf16 v[152:155], a[52:55], v[24:27], v[152:155]
  s_waitcnt vmcnt(24)
  v_mfma_f32_16x16x32_bf16 v[148:151], a[56:59], v[28:31], v[148:151]
  v_mfma_f32_16x16x32_bf16 v[152:155], a[60:63], v[28:31], v[152:155]
  s_waitcnt vmcnt(23)
  v_mfma_f32_16x16x32_bf16 v[148:151], a[64:67], v[32:35], v[148:151]
  v_mfma_f32_16x16x32_bf16 v[152:155], a[68:71], v[32:35], v[152:155]
  s_waitcnt vmcnt(22)
  v_mfma_f32_16x16x32_bf16 v[148:151], a[72:75], v[36:39], v[148:151]
  v_mfma_f32_16x16x32_bf16 v[152:155], a[76:79], v[36:39], v[152:155]
  s_waitcnt vmcnt(21)
  v_mfma_f32_16x16x32_bf16 v[148:151], a[80:83], v[40:43], v[148:151]
  v_mfma_f32_16x16x32_bf16 v[152:155], a[84:87], v[40:43], v[152:155]
  s_waitcnt vmcnt(20)
  v_mfma_f32_16x16x32_bf16 v[148:151], a[88:91], v[44:47], v[148:151]
  v_mfma_f32_16x16x32_bf16 v[152:155], a[92:95], v[44:47], v[152:155]
  s_waitcnt vmcnt(19)
  v_mfma_f32_16x16x32_bf16 v[148:151], a[96:99], v[48:51], v[148:151]
  v_mfma_f32_16x16x32_bf16 v[152:155], a[100:103], v[48:51], v[152:155]
  s_waitcnt vmcnt(18)
  v_mfma_f32_16x16x32_bf16 v[148:151], a[104:107], v[52:55], v[148:151]
  v_mfma_f32_16x16x32_bf16 v[152:155], a[108:111], v[52:55], v[152:155]
  s_waitcnt vmcnt(17)
  v_mfma_f32_16x16x32_bf16 v[148:151], a[112:115], v[56:59], v[148:151]
  v_mfma_f32_16x16x32_bf16 v[152:155], a[116:119], v[56:59], v[152:155]
  s_waitcnt vmcnt(16)
  v_mfma_f32_16x16x32_bf16 v[148:151], a[120:123], v[60:63], v[148:151]
  v_mfma_f32_16x16x32_bf16 v[152:155], a[124:127], v[60:63], v[152:155]
  s_waitcnt vmcnt(15)
  v_mfma_f32_16x16x32_bf16 v[148:151], a[128:131], v[64:67], v[148:151]
  v_mfma_f32_16x16x32_bf16 v[152:155], a[132:135], v[64:67], v[152:155]
  s_waitcnt vmcnt(14)
  v_mfma_f32_16x16x32_bf16 v[148:151], a[136:139], v[68:71], v[148:151]
  v_mfma_f32_16x16x32_bf16 v[152:155], a[140:143], v[68:71], v[152:155]
  s_waitcnt vmcnt(13)
  v_mfma_f32_16x16x32_bf16 v[148:151], a[144:147], v[72:75], v[148:151]
  v_mfma_f32_16x16x32_bf16 v[152:155], a[148:151], v[72:75], v[152:155]
  s_waitcnt vmcnt(12)
  v_mfma_f32_16x16x32_bf16 v[148:151], a[152:155], v[76:79], v[148:151]
  v_mfma_f32_16x16x32_bf16 v[152:155], a[156:159], v[76:79], v[152:155]
  s_waitcnt vmcnt(11)
  v_mfma_f32_16x16x32_bf16 v[148:151], a[160:163], v[80:83], v[148:151]
  v_mfma_f32_16x16x32_bf16 v[152:155], a[164:167], v[80:83], v[152:155]
  s_waitcnt vmcnt(10)
  v_mfma_f32_16x16x32_bf16 v[148:151], a[168:171], v[84:87], v[148:151]
  v_mfma_f32_16x16x32_bf16 v[152:155], a[172:175], v[84:87], v[152:155]
  s_waitcnt vmcnt(9)
  v_mfma_f32_16x16x32_bf16 v[148:151], a[176:179], v[88:91], v[148:151]
  v_mfma_f32_16x16x32_bf16 v[152:155], a[180:183], v[88:91], v[152:155]
  s_waitcnt vmcnt(8)
  v_mfma_f32_16x16x32_bf16 v[148:151], a[184:187], v[92:95], v[148:151]
  v_mfma_f32_16x16x32_bf16 v[152:155], a[188:191], v[92:95], v[152:155]
  s_waitcnt vmcnt(7)
  v_mfma_f32_16x16x32_bf16 v[148:151], a[192:195], v[96:99], v[148:151]
  v_mfma_f32_16x16x32_bf16 v[152:155], a[196:199], v[96:99], v[152:155]
  s_waitcnt vmcnt(6)
  v_mfma_f32_16x16x32_bf16 v[148:151], a[200:203], v[100:103], v[148:151]
  v_mfma_f32_16x16x32_bf16 v[152:155], a[204:207], v[100:103], v[152:155]
  s_waitcnt vmcnt(5)
  v_mfma_f32_16x16x32_bf16 v[148:151], a[208:211], v[104:107], v[148:151]
  v_mfma_f32_16x16x32_bf16 v[152:155], a[212:215], v[104:107], v[152:155]
  s_waitcnt vmcnt(4)
  v_mfma_f32_16x16x32_bf16 v[148:151], a[216:219], v[108:111], v[148:151]
  v_mfma_f32_16x16x32_bf16 v[152:155], a[220:223], v[108:111], v[152:155]
  s_waitcnt vmcnt(3)
  v_mfma_f32_16x16x32_bf16 v[148:151], a[224:227], v[112:115], v[148:151]
  v_mfma_f32_16x16x32_bf16 v[152:155], a[228:231], v[112:115], v[152:155]
  s_waitcnt vmcnt(2)
  v_mfma_f32_16x16x32_bf16 v[148:151], a[232:235], v[116:119], v[148:151]
  v_mfma_f32_16x16x32_bf16 v[152:155], a[236:239], v[116:119], v[152:155]
  s_waitcnt vmcnt(1)
  v_mfma_f32_16x16x32_bf16 v[148:151], a[240:243], v[120:123], v[148:151]
  v_mfma_f32_16x16x32_bf16 v[152:155], a[244:247], v[120:123], v[152:155]
  s_waitcnt vmcnt(0)
  v_mfma_f32_16x16x32_bf16 v[148:151], a[248:251], v[124:127], v[148:151]
  v_mfma_f32_16x16x32_bf16 v[152:155], a[252:255], v[124:127], v[152:155]
  s_nop 3
  v_fmac_f32 v156, v165, v148
  v_fmac_f32 v157, v165, v149
  v_fmac_f32 v158, v165, v150
  v_fmac_f32 v159, v165, v151
  v_fmac_f32 v160, v165, v152
  v_fmac_f32 v161, v165, v153
  v_fmac_f32 v162, v165, v154
  v_fmac_f32 v163, v165, v155
  ds_write_b128 v168, v[156:159]
  ds_write_b128 v168, v[160:163] offset:1024
  s_lshl_b32 s54, s70, 6
  s_add_u32 s64, s64, s54
  s_mov_b32 s59, s71
  s_waitcnt lgkmcnt(0)
  s_barrier
  s_cmp_eq_u32 s52, 0
  s_cbranch_scc0 O_next
  ds_read_b128 v[0:3], v201 offset:2048
  ds_read_b128 v[4:7], v201 offset:3072
  ds_read_b128 v[8:11], v201 offset:4096
  ds_read_b128 v[12:15], v201 offset:5120
  ds_read_b128 v[16:19], v201 offset:6144
  ds_read_b128 v[20:23], v201 offset:7168
  s_waitcnt lgkmcnt(5)
  v_add_f32 v156, v156, v0
  v_add_f32 v157, v157, v1
  v_add_f32 v158, v158, v2
  v_add_f32 v159, v159, v3
  s_waitcnt lgkmcnt(4)
  v_add_f32 v160, v160, v4
  v_add_f32 v161, v161, v5
  v_add_f32 v162, v162, v6
  v_add_f32 v163, v163, v7
  s_waitcnt lgkmcnt(3)
  v_add_f32 v156, v156, v8
  v_add_f32 v157, v157, v9
  v_add_f32 v158, v158, v10
  v_add_f32 v159, v159, v11
  s_waitcnt lgkmcnt(2)
  v_add_f32 v160, v160, v12
  v_add_f32 v161, v161, v13
  v_add_f32 v162, v162, v14
  v_add_f32 v163, v163, v15
  s_waitcnt lgkmcnt(1)
  v_add_f32 v156, v156, v16
  v_add_f32 v157, v157, v17
  v_add_f32 v158, v158, v18
  v_add_f32 v159, v159, v19
  s_waitcnt lgkmcnt(0)
  v_add_f32 v160, v160, v20
  v_add_f32 v161, v161, v21
  v_add_f32 v162, v162, v22
  v_add_f32 v163, v163, v23
  v_cvt_pk_bf16_f32 v148, v156, v157
  v_cvt_pk_bf16_f32 v149, v158, v159
  v_cvt_pk_bf16_f32 v150, v160, v161
  v_cvt_pk_bf16_f32 v151, v162, v163
  buffer_store_dwordx4 v[148:151], v167, s[48:51], s64 offen
  s_nop 1
O_next:
  s_cmp_lt_u32 s59, 64
  s_cbranch_scc1 O_loop
  s_branch L_exit
L_chain:
  v_and_b32 v0, 63, v0
  v_and_b32 v1, 15, v0
  v_lshrrev_b32 v2, 4, v0
  v_lshlrev_b32 v76, 4, v0
  v_add_u32 v75, 0x10000, v76
  v_lshrrev_b32 v3, 2, v1
  v_and_b32 v4, 1, v1
  v_lshl_add_u32 v3, v3, 1, v4
  v_bfe_u32 v4, v1, 1, 1
  v_mul_u32_u24 v74, 0xaaaa, v4
  v_add_u32 v74, 0x4444, v74
  v_mul_u32_u24 v5, 576, v3
  v_add_u32 v5, 9216, v5
  v_lshl_add_u32 v78, v2, 4, v5
  v_lshl_add_u32 v77, v2, 5, v5
  v_lshl_add_u32 v77, v4, 4, v77
  v_mul_u32_u24 v15, 1152, v3
  v_lshl_add_u32 v15, v2, 5, v15
  v_lshl_add_u32 v15, v4, 4, v15
  s_lshl_b32 s54, s52, 8
  buffer_load_dwordx4 v[20:23], v15, s[32:35], s54 offen
  buffer_load_dwordx4 v[24:27], v15, s[32:35], s54 offen offset:128
  buffer_load_dwordx4 v[28:31], v15, s[32:35], 0 offen offset:1024
  v_mul_u32_u24 v79, 1152, v2
  v_lshl_add_u32 v79, v1, 2, v79
  s_lshl_b32 s54, s52, 6
  s_add_u32 s54, s54, 9216
  v_add_u32 v79, s54, v79
  v_lshrrev_b32 v5, 3, v0
  v_mul_u32_u24 v68, 2176, v5
  v_and_b32 v5, 7, v0
  v_lshl_add_u32 v68, v5, 3, v68
  v_and_b32 v5, 1, v2
  v_lshlrev_b32 v5, 4, v5
  v_lshl_add_u32 v5, v1, 2, v5
  v_mov_b32 v6, 0x40000000
  v_cmp_lt_u32 vcc, 3, v1
  s_nop 1
  v_cndmask_b32 v5, v5, v6, vcc
  v_lshrrev_b32 v6, 1, v2
  v_lshl_add_u32 v69, v6, 10, v5
  v_lshl_add_u32 v70, v6, 8, v5
  v_mov_b32 v71, -1
  ds_write_b128 v76, v[68:71] offset:13824
  v_and_b32 v5, 3, v1
  v_lshrrev_b32 v6, 2, v1
  v_lshl_add_u32 v5, v5, 2, v6
  v_and_b32 v6, 1, v5
  v_lshlrev_b32 v6, 4, v6
  v_mov_b32 v7, 0x3f80
  v_lshlrev_b32 v6, v6, v7
  v_lshrrev_b32 v5, 1, v5
  v_cmp_eq_u32 vcc, 0, v5
  s_nop 1
  v_cndmask_b32 v32, 0, v6, vcc
  v_cmp_eq_u32 vcc, 1, v5
  s_nop 1
  v_cndmask_b32 v33, 0, v6, vcc
  v_cmp_eq_u32 vcc, 2, v5
  s_nop 1
  v_cndmask_b32 v34, 0, v6, vcc
  v_cmp_eq_u32 vcc, 3, v5
  s_nop 1
  v_cndmask_b32 v35, 0, v6, vcc
  ds_write_b128 v76, v[32:35] offset:14848
  v_and_b32 v3, 1, v2
  s_lshl_b32 s54, s52, 1
  v_add_u32 v3, s54, v3
  v_lshlrev_b32 v3, 1, v3
  v_xor_b32 v3, v3, v1
  v_lshlrev_b32 v3, 4, v3
  v_lshl_add_u32 v8, v2, 13, v3
  s_and_b32 s54, s52, 1
  s_lshr_b32 s55, s52, 1
  v_lshrrev_b32 v3, 3, v0
  v_and_b32 v4, 1, v3
  v_lshlrev_b32 v4, 4, v4
  v_and_b32 v5, 6, v3
  v_add_u32 v4, v4, v5
  s_lshl_b32 s56, s55, 3
  s_add_u32 s56, s56, s54
  v_add_u32 v4, s56, v4
  v_mul_u32_u24 v4, 1152, v4
  v_and_b32 v5, 2, v3
  v_lshlrev_b32 v5, 1, v5
  v_and_b32 v6, 7, v0
  v_xor_b32 v6, v6, v5
  v_lshl_add_u32 v9, v6, 4, v4
  v_and_b32 v4, 1, v2
  v_lshlrev_b32 v4, 4, v4
  v_and_b32 v5, 2, v2
  v_add_u32 v4, v4, v5
  s_lshl_b32 s56, s55, 2
  s_add_u32 s56, s56, s54
  v_add_u32 v4, s56, v4
  v_mul_u32_u24 v4, 1152, v4
  v_lshlrev_b32 v6, 1, v2
  v_xor_b32 v6, v6, v1
  v_lshl_add_u32 v10, v6, 4, v4
  v_bfe_u32 v17, v1, 2, 1
  v_bfe_u32 v18, v1, 3, 1
  v_and_b32 v19, 1, v2
  v_lshrrev_b32 v72, 1, v2
  v_and_b32 v73, 3, v1
  v_lshl_add_u32 v3, v19, 1, v17
  v_lshl_add_u32 v6, v18, 2, v3
  v_lshl_add_u32 v4, v72, 4, v17
  v_lshl_add_u32 v4, v19, 2, v4
  v_lshl_add_u32 v4, v18, 3, v4
  v_lshlrev_b32 v4, 8, v4
  s_lshl_b32 s54, s52, 6
  v_lshl_add_u32 v5, v73, 3, s54
  v_lshlrev_b32 v7, 5, v6
  v_xor_b32 v5, v5, v7
  v_add_u32 v11, v4, v5
  v_xor_b32 v12, 32, v11
  v_lshl_add_u32 v4, v72, 2, v3
  v_lshlrev_b32 v4, 7, v4
  v_lshl_add_u32 v4, v73, 3, v4
  s_and_b32 s54, s52, 1
  v_xor_b32 v7, s54, v19
  v_lshl_add_u32 v7, v7, 1, v18
  v_lshl_add_u32 v13, v7, 5, v4
  v_lshlrev_b32 v4, 11, v72
  v_lshl_add_u32 v4, v73, 3, v4
  v_lshl_add_u32 v5, v3, 8, v4
  v_lshl_add_u32 v7, v18, 2, s52
  v_xor_b32 v7, v7, v3
  v_lshl_add_u32 v14, v7, 5, v5
  s_lshl_b32 s54, s53, 14
  s_lshl_b32 s55, s52, 11
  s_add_u32 s58, s54, s55
  s_add_u32 s59, s58, 8192
  s_lshl_b32 s55, s52, 12
  s_add_u32 s70, s54, s55
  s_add_u32 s70, s70, 524288
  s_lshl_b32 s54, s53, 12
  s_lshl_b32 s55, s52, 10
  s_add_u32 s54, s54, s55
  s_add_u32 s68, s54, 34471936
  s_lshl_b32 s54, s53, 7
  s_add_u32 s71, s54, 105906176
  s_lshl_b32 s54, s53, 6
  s_mul_i32 s55, s52, 17408
  s_add_u32 s55, s54, s55
  s_add_u32 s73, s55, 100663296
  s_add_u32 s74, s55, 100732928
  s_add_u32 s75, s55, 100802560
  s_add_u32 s76, s55, 100872192
  s_and_b32 s56, s52, 1
  s_mul_i32 s55, s56, 17408
  s_add_u32 s55, s54, s55
  s_add_u32 s77, s55, 100941824
  s_mul_i32 s54, s52, 69632
  s_mul_i32 s55, s53, 2176
  s_add_u32 s54, s54, s55
  s_add_u32 s60, s54, 100663296
  s_and_b32 s56, s53, 15
  s_mul_i32 s55, s56, 2176
  s_add_u32 s61, s55, 100941824
  s_lshl_b32 s54, s52, 11
  s_add_u32 s64, s54, 102760448
  s_mov_b32 s65, 102768640
  s_lshl_b32 s55, s53, 5
  s_add_u32 s54, s54, s55
  s_add_u32 s62, s54, 102776832
  s_lshr_b32 s54, s56, 3
  s_lshl_b32 s54, s54, 9
  s_and_b32 s55, s56, 7
  s_lshl_b32 s55, s55, 5
  s_add_u32 s54, s54, s55
  s_add_u32 s63, s54, 102785024
  s_mov_b32 s66, 0
  s_mov_b32 s67, 0
  s_mov_b32 s72, 0
  s_mov_b32 s69, 1040356334
  s_lshl_b32 s78, s53, 8
  s_lshl_b32 s54, s52, 15
  s_add_u32 s78, s78, s54
  s_mul_i32 s79, s53, 147456
  s_lshl_b32 s57, s52, 10
  s_add_u32 s57, s57, 16384
  s_add_u32 m0, s57, 0
  s_add_u32 s54, s78, 524288
  buffer_load_dwordx4 v8, s[16:19], s54 offen lds
  s_add_u32 m0, s57, 4096
  s_add_u32 s54, s78, 655360
  buffer_load_dwordx4 v8, s[16:19], s54 offen lds
  s_add_u32 m0, s57, 8192
  s_add_u32 s54, s78, 786432
  buffer_load_dwordx4 v8, s[16:19], s54 offen lds
  s_add_u32 m0, s57, 12288
  s_add_u32 s54, s78, 917504
  buffer_load_dwordx4 v8, s[16:19], s54 offen lds
  s_add_u32 m0, s57, 16384
  s_add_u32 s54, s78, 1048576
  buffer_load_dwordx4 v8, s[16:19], s54 offen lds
  s_add_u32 m0, s57, 20480
  s_add_u32 s54, s78, 1179648
  buffer_load_dwordx4 v8, s[16:19], s54 offen lds
  s_add_u32 m0, s57, 24576
  s_add_u32 s54, s78, 1310720
  buffer_load_dwordx4 v8, s[16:19], s54 offen lds
  s_add_u32 m0, s57, 28672
  s_add_u32 s54, s78, 1441792
  buffer_load_dwordx4 v8, s[16:19], s54 offen lds
  s_add_u32 m0, s57, 32768
  s_add_u32 s54, s78, 1572864
  buffer_load_dwordx4 v8, s[16:19], s54 offen lds
  s_add_u32 m0, s57, 36864
  s_add_u32 s54, s78, 1703936
  buffer_load_dwordx4 v8, s[16:19], s54 offen lds
  s_add_u32 m0, s57, 40960
  s_add_u32 s54, s78, 1835008
  buffer_load_dwordx4 v8, s[16:19], s54 offen lds
  s_add_u32 m0, s57, 45056
  s_add_u32 s54, s78, 1966080
  buffer_load_dwordx4 v8, s[16:19], s54 offen lds
  s_add_u32 m0, s57, 49152
  s_add_u32 s54, s78, 2097152
  buffer_load_dwordx4 v8, s[16:19], s54 offen lds
  s_add_u32 m0, s57, 53248
  s_add_u32 s54, s78, 2228224
  buffer_load_dwordx4 v8, s[16:19], s54 offen lds
  s_add_u32 m0, s57, 57344
  s_add_u32 s54, s78, 2359296
  buffer_load_dwordx4 v8, s[16:19], s54 offen lds
  s_add_u32 m0, s57, 61440
  s_add_u32 s54, s78, 2490368
  buffer_load_dwordx4 v8, s[16:19], s54 offen lds
  s_add_u32 m0, s57, 65536
  s_add_u32 s54, s78, 2621440
  buffer_load_dwordx4 v8, s[16:19], s54 offen lds
  s_add_u32 m0, s57, 69632
  s_add_u32 s54, s78, 2752512
  buffer_load_dwordx4 v8, s[16:19], s54 offen lds
  s_add_u32 m0, s57, 73728
  s_add_u32 s54, s78, 2883584
  buffer_load_dwordx4 v8, s[16:19], s54 offen lds
  s_add_u32 m0, s57, 77824
  s_add_u32 s54, s78, 3014656
  buffer_load_dwordx4 v8, s[16:19], s54 offen lds
  s_add_u32 m0, s57, 81920
  s_add_u32 s54, s78, 3145728
  buffer_load_dwordx4 v8, s[16:19], s54 offen lds
  s_add_u32 m0, s57, 86016
  s_add_u32 s54, s78, 3276800
  buffer_load_dwordx4 v8, s[16:19], s54 offen lds
  s_add_u32 m0, s57, 90112
  s_add_u32 s54, s78, 3407872
  buffer_load_dwordx4 v8, s[16:19], s54 offen lds
  s_add_u32 m0, s57, 94208
  s_add_u32 s54, s78, 3538944
  buffer_load_dwordx4 v8, s[16:19], s54 offen lds
  s_add_u32 m0, s57, 98304
  s_add_u32 s54, s78, 3670016
  buffer_load_dwordx4 v8, s[16:19], s54 offen lds
  s_add_u32 m0, s57, 102400
  s_add_u32 s54, s78, 3801088
  buffer_load_dwordx4 v8, s[16:19], s54 offen lds
  s_add_u32 m0, s57, 106496
  s_add_u32 s54, s78, 3932160
  buffer_load_dwordx4 v8, s[16:19], s54 offen lds
  s_add_u32 m0, s57, 110592
  s_add_u32 s54, s78, 4063232
  buffer_load_dwordx4 v8, s[16:19], s54 offen lds
  s_add_u32 m0, s57, 114688
  s_add_u32 s54, s78, 4194304
  buffer_load_dwordx4 v8, s[16:19], s54 offen lds
  s_add_u32 m0, s57, 118784
  s_add_u32 s54, s78, 4325376
  buffer_load_dwordx4 v8, s[16:19], s54 offen lds
  s_add_u32 m0, s57, 122880
  s_add_u32 s54, s78, 4456448
  buffer_load_dwordx4 v8, s[16:19], s54 offen lds
  s_add_u32 m0, s57, 126976
  s_add_u32 s54, s78, 4587520
  buffer_load_dwordx4 v8, s[16:19], s54 offen lds
  s_waitcnt vmcnt(28) lgkmcnt(0)
  s_barrier
  s_add_u32 m0, s57, 131072
  s_add_u32 s54, s78, 524288
  buffer_load_dwordx4 v8, s[20:23], s54 offen lds
  s_add_u32 m0, s57, 135168
  s_add_u32 s54, s78, 655360
  buffer_load_dwordx4 v8, s[20:23], s54 offen lds
  s_add_u32 m0, s57, 139264
  s_add_u32 s54, s78, 786432
  buffer_load_dwordx4 v8, s[20:23], s54 offen lds
  s_add_u32 m0, s57, 143360
  s_add_u32 s54, s78, 917504
  buffer_load_dwordx4 v8, s[20:23], s54 offen lds
  v_add_u32 v15, 16384, v11
  v_add_u32 v16, 16384, v12
  ds_read_b64_tr_b16 v[80:81], v15 offset:0
  ds_read_b64_tr_b16 v[82:83], v15 offset:512
  ds_read_b64_tr_b16 v[84:85], v15 offset:8192
  ds_read_b64_tr_b16 v[86:87], v15 offset:8704
  ds_read_b64_tr_b16 v[88:89], v16 offset:0
  ds_read_b64_tr_b16 v[90:91], v16 offset:512
  ds_read_b64_tr_b16 v[92:93], v16 offset:8192
  ds_read_b64_tr_b16 v[94:95], v16 offset:8704
  s_waitcnt vmcnt(28) lgkmcnt(0)
  s_barrier
  s_add_u32 m0, s57, 0
  s_add_u32 s54, s78, 1572864
  buffer_load_dwordx4 v8, s[20:23], s54 offen lds
  s_add_u32 m0, s57, 4096
  s_add_u32 s54, s78, 1703936
  buffer_load_dwordx4 v8, s[20:23], s54 offen lds
  s_add_u32 m0, s57, 8192
  s_add_u32 s54, s78, 1835008
  buffer_load_dwordx4 v8, s[20:23], s54 offen lds
  s_add_u32 m0, s57, 12288
  s_add_u32 s54, s78, 1966080
  buffer_load_dwordx4 v8, s[20:23], s54 offen lds
  v_add_u32 v15, 32768, v11
  v_add_u32 v16, 32768, v12
  ds_read_b64_tr_b16 v[96:97], v15 offset:0
  ds_read_b64_tr_b16 v[98:99], v15 offset:512
  ds_read_b64_tr_b16 v[100:101], v15 offset:8192
  ds_read_b64_tr_b16 v[102:103], v15 offset:8704
  ds_read_b64_tr_b16 v[104:105], v16 offset:0
  ds_read_b64_tr_b16 v[106:107], v16 offset:512
  ds_read_b64_tr_b16 v[108:109], v16 offset:8192
  ds_read_b64_tr_b16 v[110:111], v16 offset:8704
  s_waitcnt vmcnt(28) lgkmcnt(0)
  s_barrier
  s_add_u32 m0, s57, 16384
  s_add_u32 s54, s78, 2621440
  buffer_load_dwordx4 v8, s[20:23], s54 offen lds
  s_add_u32 m0, s57, 20480
  s_add_u32 s54, s78, 2752512
  buffer_load_dwordx4 v8, s[20:23], s54 offen lds
  s_add_u32 m0, s57, 24576
  s_add_u32 s54, s78, 2883584
  buffer_load_dwordx4 v8, s[20:23], s54 offen lds
  s_add_u32 m0, s57, 28672
  s_add_u32 s54, s78, 3014656
  buffer_load_dwordx4 v8, s[20:23], s54 offen lds
  v_add_u32 v15, 49152, v11
  v_add_u32 v16, 49152, v12
  ds_read_b64_tr_b16 v[112:113], v15 offset:0
  ds_read_b64_tr_b16 v[114:115], v15 offset:512
  ds_read_b64_tr_b16 v[116:117], v15 offset:8192
  ds_read_b64_tr_b16 v[118:119], v15 offset:8704
  ds_read_b64_tr_b16 v[120:121], v16 offset:0
  ds_read_b64_tr_b16 v[122:123], v16 offset:512
  ds_read_b64_tr_b16 v[124:125], v16 offset:8192
  ds_read_b64_tr_b16 v[126:127], v16 offset:8704
  s_waitcnt vmcnt(28) lgkmcnt(0)
  s_barrier
  s_add_u32 m0, s57, 32768
  s_add_u32 s54, s78, 3145728
  buffer_load_dwordx4 v8, s[20:23], s54 offen lds
  s_add_u32 m0, s57, 36864
  s_add_u32 s54, s78, 3276800
  buffer_load_dwordx4 v8, s[20:23], s54 offen lds
  s_add_u32 m0, s57, 40960
  s_add_u32 s54, s78, 3407872
  buffer_load_dwordx4 v8, s[20:23], s54 offen lds
  s_add_u32 m0, s57, 45056
  s_add_u32 s54, s78, 3538944
  buffer_load_dwordx4 v8, s[20:23], s54 offen lds
  v_add_u32 v15, 65536, v11
  v_add_u32 v16, 65536, v12
  ds_read_b64_tr_b16 v[128:129], v15 offset:0
  ds_read_b64_tr_b16 v[130:131], v15 offset:512
  ds_read_b64_tr_b16 v[132:133], v15 offset:8192
  ds_read_b64_tr_b16 v[134:135], v15 offset:8704
  ds_read_b64_tr_b16 v[136:137], v16 offset:0
  ds_read_b64_tr_b16 v[138:139], v16 offset:512
  ds_read_b64_tr_b16 v[140:141], v16 offset:8192
  ds_read_b64_tr_b16 v[142:143], v16 offset:8704
  s_waitcnt vmcnt(28) lgkmcnt(0)
  s_barrier
  s_add_u32 m0, s57, 49152
  s_add_u32 s54, s78, 3670016
  buffer_load_dwordx4 v8, s[20:23], s54 offen lds
  s_add_u32 m0, s57, 53248
  s_add_u32 s54, s78, 3801088
  buffer_load_dwordx4 v8, s[20:23], s54 offen lds
  s_add_u32 m0, s57, 57344
  s_add_u32 s54, s78, 3932160
  buffer_load_dwordx4 v8, s[20:23], s54 offen lds
  s_add_u32 m0, s57, 61440
  s_add_u32 s54, s78, 4063232
  buffer_load_dwordx4 v8, s[20:23], s54 offen lds
  v_add_u32 v15, 81920, v11
  v_add_u32 v16, 81920, v12
  ds_read_b64_tr_b16 v[144:145], v15 offset:0
  ds_read_b64_tr_b16 v[146:147], v15 offset:512
  ds_read_b64_tr_b16 v[148:149], v15 offset:8192
  ds_read_b64_tr_b16 v[150:151], v15 offset:8704
  ds_read_b64_tr_b16 v[152:153], v16 offset:0
  ds_read_b64_tr_b16 v[154:155], v16 offset:512
  ds_read_b64_tr_b16 v[156:157], v16 offset:8192
  ds_read_b64_tr_b16 v[158:159], v16 offset:8704
  s_waitcnt vmcnt(28) lgkmcnt(0)
  s_barrier
  s_add_u32 m0, s57, 65536
  s_add_u32 s54, s78, 0
  buffer_load_dwordx4 v8, s[24:27], s54 offen lds
  s_add_u32 m0, s57, 69632
  s_add_u32 s54, s78, 131072
  buffer_load_dwordx4 v8, s[24:27], s54 offen lds
  s_add_u32 m0, s57, 73728
  s_add_u32 s54, s78, 262144
  buffer_load_dwordx4 v8, s[24:27], s54 offen lds
  s_add_u32 m0, s57, 77824
  s_add_u32 s54, s78, 393216
  buffer_load_dwordx4 v8, s[24:27], s54 offen lds
  v_add_u32 v15, 98304, v11
  v_add_u32 v16, 98304, v12
  ds_read_b64_tr_b16 v[160:161], v15 offset:0
  ds_read_b64_tr_b16 v[162:163], v15 offset:512
  ds_read_b64_tr_b16 v[164:165], v15 offset:8192
  ds_read_b64_tr_b16 v[166:167], v15 offset:8704
  ds_read_b64_tr_b16 v[168:169], v16 offset:0
  ds_read_b64_tr_b16 v[170:171], v16 offset:512
  ds_read_b64_tr_b16 v[172:173], v16 offset:8192
  ds_read_b64_tr_b16 v[174:175], v16 offset:8704
  s_waitcnt vmcnt(28) lgkmcnt(0)
  s_barrier
  s_add_u32 m0, s57, 81920
  s_add_u32 s54, s78, 524288
  buffer_load_dwordx4 v8, s[24:27], s54 offen lds
  s_add_u32 m0, s57, 86016
  s_add_u32 s54, s78, 655360
  buffer_load_dwordx4 v8, s[24:27], s54 offen lds
  s_add_u32 m0, s57, 90112
  s_add_u32 s54, s78, 786432
  buffer_load_dwordx4 v8, s[24:27], s54 offen lds
  s_add_u32 m0, s57, 94208
  s_add_u32 s54, s78, 917504
  buffer_load_dwordx4 v8, s[24:27], s54 offen lds
  v_add_u32 v15, 114688, v11
  v_add_u32 v16, 114688, v12
  ds_read_b64_tr_b16 v[176:177], v15 offset:0
  ds_read_b64_tr_b16 v[178:179], v15 offset:512
  ds_read_b64_tr_b16 v[180:181], v15 offset:8192
  ds_read_b64_tr_b16 v[182:183], v15 offset:8704
  ds_read_b64_tr_b16 v[184:185], v16 offset:0
  ds_read_b64_tr_b16 v[186:187], v16 offset:512
  ds_read_b64_tr_b16 v[188:189], v16 offset:8192
  ds_read_b64_tr_b16 v[190:191], v16 offset:8704
  s_waitcnt vmcnt(28) lgkmcnt(0)
  s_barrier
  s_add_u32 m0, s57, 98304
  s_add_u32 s54, s78, 1048576
  buffer_load_dwordx4 v8, s[24:27], s54 offen lds
  s_add_u32 m0, s57, 102400
  s_add_u32 s54, s78, 1179648
  buffer_load_dwordx4 v8, s[24:27], s54 offen lds
  s_add_u32 m0, s57, 106496
  s_add_u32 s54, s78, 1310720
  buffer_load_dwordx4 v8, s[24:27], s54 offen lds
  s_add_u32 m0, s57, 110592
  s_add_u32 s54, s78, 1441792
  buffer_load_dwordx4 v8, s[24:27], s54 offen lds
  v_add_u32 v15, 131072, v11
  v_add_u32 v16, 131072, v12
  ds_read_b64_tr_b16 v[192:193], v15 offset:0
  ds_read_b64_tr_b16 v[194:195], v15 offset:512
  ds_read_b64_tr_b16 v[196:197], v15 offset:8192
  ds_read_b64_tr_b16 v[198:199], v15 offset:8704
  ds_read_b64_tr_b16 v[200:201], v16 offset:0
  ds_read_b64_tr_b16 v[202:203], v16 offset:512
  ds_read_b64_tr_b16 v[204:205], v16 offset:8192
  ds_read_b64_tr_b16 v[206:207], v16 offset:8704
  s_waitcnt vmcnt(28) lgkmcnt(0)
  s_barrier
  s_add_u32 m0, s57, 114688
  s_add_u32 s54, s78, 1572864
  buffer_load_dwordx4 v8, s[24:27], s54 offen lds
  s_add_u32 m0, s57, 118784
  s_add_u32 s54, s78, 1703936
  buffer_load_dwordx4 v8, s[24:27], s54 offen lds
  s_add_u32 m0, s57, 122880
  s_add_u32 s54, s78, 1835008
  buffer_load_dwordx4 v8, s[24:27], s54 offen lds
  s_add_u32 m0, s57, 126976
  s_add_u32 s54, s78, 1966080
  buffer_load_dwordx4 v8, s[24:27], s54 offen lds
  v_add_u32 v15, 147456, v11
  v_add_u32 v16, 147456, v12
  ds_read_b64_tr_b16 v[208:209], v15 offset:0
  ds_read_b64_tr_b16 v[210:211], v15 offset:512
  ds_read_b64_tr_b16 v[212:213], v15 offset:8192
  ds_read_b64_tr_b16 v[214:215], v15 offset:8704
  ds_read_b64_tr_b16 v[216:217], v16 offset:0
  ds_read_b64_tr_b16 v[218:219], v16 offset:512
  ds_read_b64_tr_b16 v[220:221], v16 offset:8192
  ds_read_b64_tr_b16 v[222:223], v16 offset:8704
  s_waitcnt vmcnt(28) lgkmcnt(0)
  s_barrier
  s_add_u32 m0, s57, 131072
  s_add_u32 s54, s78, 2097152
  buffer_load_dwordx4 v8, s[24:27], s54 offen lds
  s_add_u32 m0, s57, 135168
  s_add_u32 s54, s78, 2228224
  buffer_load_dwordx4 v8, s[24:27], s54 offen lds
  s_add_u32 m0, s57, 139264
  s_add_u32 s54, s78, 2359296
  buffer_load_dwordx4 v8, s[24:27], s54 offen lds
  s_add_u32 m0, s57, 143360
  s_add_u32 s54, s78, 2490368
  buffer_load_dwordx4 v8, s[24:27], s54 offen lds
  v_add_u32 v15, 16384, v11
  v_add_u32 v16, 16384, v12
  ds_read_b64_tr_b16 v[224:225], v15 offset:0
  ds_read_b64_tr_b16 v[226:227], v15 offset:512
  ds_read_b64_tr_b16 v[228:229], v15 offset:8192
  ds_read_b64_tr_b16 v[230:231], v15 offset:8704
  ds_read_b64_tr_b16 v[232:233], v16 offset:0
  ds_read_b64_tr_b16 v[234:235], v16 offset:512
  ds_read_b64_tr_b16 v[236:237], v16 offset:8192
  ds_read_b64_tr_b16 v[238:239], v16 offset:8704
  s_waitcnt vmcnt(28) lgkmcnt(0)
  s_barrier
  s_add_u32 m0, s57, 0
  s_add_u32 s54, s78, 2621440
  buffer_load_dwordx4 v8, s[24:27], s54 offen lds
  s_add_u32 m0, s57, 4096
  s_add_u32 s54, s78, 2752512
  buffer_load_dwordx4 v8, s[24:27], s54 offen lds
  s_add_u32 m0, s57, 8192
  s_add_u32 s54, s78, 2883584
  buffer_load_dwordx4 v8, s[24:27], s54 offen lds
  s_add_u32 m0, s57, 12288
  s_add_u32 s54, s78, 3014656
  buffer_load_dwordx4 v8, s[24:27], s54 offen lds
  v_add_u32 v15, 32768, v11
  v_add_u32 v16, 32768, v12
  ds_read_b64_tr_b16 v[240:241], v15 offset:0
  ds_read_b64_tr_b16 v[242:243], v15 offset:512
  ds_read_b64_tr_b16 v[244:245], v15 offset:8192
  ds_read_b64_tr_b16 v[246:247], v15 offset:8704
  ds_read_b64_tr_b16 v[248:249], v16 offset:0
  ds_read_b64_tr_b16 v[250:251], v16 offset:512
  ds_read_b64_tr_b16 v[252:253], v16 offset:8192
  ds_read_b64_tr_b16 v[254:255], v16 offset:8704
  s_waitcnt vmcnt(28) lgkmcnt(0)
  s_barrier
  s_add_u32 m0, s57, 16384
  s_add_u32 s54, s78, 3145728
  buffer_load_dwordx4 v8, s[24:27], s54 offen lds
  s_add_u32 m0, s57, 20480
  s_add_u32 s54, s78, 3276800
  buffer_load_dwordx4 v8, s[24:27], s54 offen lds
  s_add_u32 m0, s57, 24576
  s_add_u32 s54, s78, 3407872
  buffer_load_dwordx4 v8, s[24:27], s54 offen lds
  s_add_u32 m0, s57, 28672
  s_add_u32 s54, s78, 3538944
  buffer_load_dwordx4 v8, s[24:27], s54 offen lds
  v_add_u32 v15, 49152, v11
  v_add_u32 v16, 49152, v12
  ds_read_b64_tr_b16 a[0:1], v15 offset:0
  ds_read_b64_tr_b16 a[2:3], v15 offset:512
  ds_read_b64_tr_b16 a[4:5], v15 offset:8192
  ds_read_b64_tr_b16 a[6:7], v15 offset:8704
  ds_read_b64_tr_b16 a[8:9], v16 offset:0
  ds_read_b64_tr_b16 a[10:11], v16 offset:512
  ds_read_b64_tr_b16 a[12:13], v16 offset:8192
  ds_read_b64_tr_b16 a[14:15], v16 offset:8704
  s_waitcnt vmcnt(28) lgkmcnt(0)
  s_barrier
  s_add_u32 m0, s57, 32768
  s_add_u32 s54, s78, 3670016
  buffer_load_dwordx4 v8, s[24:27], s54 offen lds
  s_add_u32 m0, s57, 36864
  s_add_u32 s54, s78, 3801088
  buffer_load_dwordx4 v8, s[24:27], s54 offen lds
  s_add_u32 m0, s57, 40960
  s_add_u32 s54, s78, 3932160
  buffer_load_dwordx4 v8, s[24:27], s54 offen lds
  s_add_u32 m0, s57, 45056
  s_add_u32 s54, s78, 4063232
  buffer_load_dwordx4 v8, s[24:27], s54 offen lds
  v_add_u32 v15, 65536, v11
  v_add_u32 v16, 65536, v12
  ds_read_b64_tr_b16 a[16:17], v15 offset:0
  ds_read_b64_tr_b16 a[18:19], v15 offset:512
  ds_read_b64_tr_b16 a[20:21], v15 offset:8192
  ds_read_b64_tr_b16 a[22:23], v15 offset:8704
  ds_read_b64_tr_b16 a[24:25], v16 offset:0
  ds_read_b64_tr_b16 a[26:27], v16 offset:512
  ds_read_b64_tr_b16 a[28:29], v16 offset:8192
  ds_read_b64_tr_b16 a[30:31], v16 offset:8704
  s_waitcnt vmcnt(28) lgkmcnt(0)
  s_barrier
  s_add_u32 m0, s57, 49152
  s_add_u32 s54, s78, 4194304
  buffer_load_dwordx4 v8, s[24:27], s54 offen lds
  s_add_u32 m0, s57, 53248
  s_add_u32 s54, s78, 4325376
  buffer_load_dwordx4 v8, s[24:27], s54 offen lds
  s_add_u32 m0, s57, 57344
  s_add_u32 s54, s78, 4456448
  buffer_load_dwordx4 v8, s[24:27], s54 offen lds
  s_add_u32 m0, s57, 61440
  s_add_u32 s54, s78, 4587520
  buffer_load_dwordx4 v8, s[24:27], s54 offen lds
  v_add_u32 v15, 81920, v11
  v_add_u32 v16, 81920, v12
  ds_read_b64_tr_b16 a[32:33], v15 offset:0
  ds_read_b64_tr_b16 a[34:35], v15 offset:512
  ds_read_b64_tr_b16 a[36:37], v15 offset:8192
  ds_read_b64_tr_b16 a[38:39], v15 offset:8704
  ds_read_b64_tr_b16 a[40:41], v16 offset:0
  ds_read_b64_tr_b16 a[42:43], v16 offset:512
  ds_read_b64_tr_b16 a[44:45], v16 offset:8192
  ds_read_b64_tr_b16 a[46:47], v16 offset:8704
  s_waitcnt vmcnt(28) lgkmcnt(0)
  s_barrier
  s_add_u32 m0, s57, 65536
  s_add_u32 s54, s79, 0
  buffer_load_dwordx4 v10, s[28:31], s54 offen lds
  s_add_u32 m0, s57, 69632
  s_add_u32 s54, s79, 9216
  buffer_load_dwordx4 v10, s[28:31], s54 offen lds
  s_add_u32 m0, s57, 73728
  s_add_u32 s54, s79, 36864
  buffer_load_dwordx4 v10, s[28:31], s54 offen lds
  s_add_u32 m0, s57, 77824
  s_add_u32 s54, s79, 46080
  buffer_load_dwordx4 v10, s[28:31], s54 offen lds
  v_add_u32 v15, 98304, v11
  v_add_u32 v16, 98304, v12
  ds_read_b64_tr_b16 a[48:49], v15 offset:0
  ds_read_b64_tr_b16 a[50:51], v15 offset:512
  ds_read_b64_tr_b16 a[52:53], v15 offset:8192
  ds_read_b64_tr_b16 a[54:55], v15 offset:8704
  ds_read_b64_tr_b16 a[56:57], v16 offset:0
  ds_read_b64_tr_b16 a[58:59], v16 offset:512
  ds_read_b64_tr_b16 a[60:61], v16 offset:8192
  ds_read_b64_tr_b16 a[62:63], v16 offset:8704
  s_waitcnt vmcnt(28) lgkmcnt(0)
  s_barrier
  s_add_u32 m0, s57, 81920
  s_add_u32 s54, s79, 73728
  buffer_load_dwordx4 v10, s[28:31], s54 offen lds
  s_add_u32 m0, s57, 86016
  s_add_u32 s54, s79, 82944
  buffer_load_dwordx4 v10, s[28:31], s54 offen lds
  s_add_u32 m0, s57, 90112
  s_add_u32 s54, s79, 110592
  buffer_load_dwordx4 v10, s[28:31], s54 offen lds
  s_add_u32 m0, s57, 94208
  s_add_u32 s54, s79, 119808
  buffer_load_dwordx4 v10, s[28:31], s54 offen lds
  v_add_u32 v15, 114688, v11
  v_add_u32 v16, 114688, v12
  ds_read_b64_tr_b16 a[64:65], v15 offset:0
  ds_read_b64_tr_b16 a[66:67], v15 offset:512
  ds_read_b64_tr_b16 a[68:69], v15 offset:8192
  ds_read_b64_tr_b16 a[70:71], v15 offset:8704
  ds_read_b64_tr_b16 a[72:73], v16 offset:0
  ds_read_b64_tr_b16 a[74:75], v16 offset:512
  ds_read_b64_tr_b16 a[76:77], v16 offset:8192
  ds_read_b64_tr_b16 a[78:79], v16 offset:8704
  s_waitcnt vmcnt(28) lgkmcnt(0)
  s_barrier
  s_add_u32 m0, s57, 98304
  s_add_u32 s54, s79, 256
  buffer_load_dwordx4 v10, s[28:31], s54 offen lds
  s_add_u32 m0, s57, 102400
  s_add_u32 s54, s79, 9472
  buffer_load_dwordx4 v10, s[28:31], s54 offen lds
  s_add_u32 m0, s57, 106496
  s_add_u32 s54, s79, 37120
  buffer_load_dwordx4 v10, s[28:31], s54 offen lds
  s_add_u32 m0, s57, 110592
  s_add_u32 s54, s79, 46336
  buffer_load_dwordx4 v10, s[28:31], s54 offen lds
  v_add_u32 v15, 131072, v11
  v_add_u32 v16, 131072, v12
  ds_read_b64_tr_b16 a[80:81], v15 offset:0
  ds_read_b64_tr_b16 a[82:83], v15 offset:512
  ds_read_b64_tr_b16 a[84:85], v15 offset:8192
  ds_read_b64_tr_b16 a[86:87], v15 offset:8704
  ds_read_b64_tr_b16 a[88:89], v16 offset:0
  ds_read_b64_tr_b16 a[90:91], v16 offset:512
  ds_read_b64_tr_b16 a[92:93], v16 offset:8192
  ds_read_b64_tr_b16 a[94:95], v16 offset:8704
  s_waitcnt vmcnt(28) lgkmcnt(0)
  s_barrier
  s_add_u32 m0, s57, 114688
  s_add_u32 s54, s79, 512
  buffer_load_dwordx4 v10, s[28:31], s54 offen lds
  s_add_u32 m0, s57, 118784
  s_add_u32 s54, s79, 9728
  buffer_load_dwordx4 v10, s[28:31], s54 offen lds
  s_add_u32 m0, s57, 122880
  s_add_u32 s54, s79, 37376
  buffer_load_dwordx4 v10, s[28:31], s54 offen lds
  s_add_u32 m0, s57, 126976
  s_add_u32 s54, s79, 46592
  buffer_load_dwordx4 v10, s[28:31], s54 offen lds
  v_add_u32 v15, 147456, v11
  v_add_u32 v16, 147456, v12
  ds_read_b64_tr_b16 a[96:97], v15 offset:0
  ds_read_b64_tr_b16 a[98:99], v15 offset:512
  ds_read_b64_tr_b16 a[100:101], v15 offset:8192
  ds_read_b64_tr_b16 a[102:103], v15 offset:8704
  ds_read_b64_tr_b16 a[104:105], v16 offset:0
  ds_read_b64_tr_b16 a[106:107], v16 offset:512
  ds_read_b64_tr_b16 a[108:109], v16 offset:8192
  ds_read_b64_tr_b16 a[110:111], v16 offset:8704
  s_waitcnt vmcnt(28) lgkmcnt(0)
  s_barrier
  s_add_u32 m0, s57, 131072
  s_add_u32 s54, s79, 768
  buffer_load_dwordx4 v10, s[28:31], s54 offen lds
  s_add_u32 m0, s57, 135168
  s_add_u32 s54, s79, 9984
  buffer_load_dwordx4 v10, s[28:31], s54 offen lds
  s_add_u32 m0, s57, 139264
  s_add_u32 s54, s79, 37632
  buffer_load_dwordx4 v10, s[28:31], s54 offen lds
  s_add_u32 m0, s57, 143360
  s_add_u32 s54, s79, 46848
  buffer_load_dwordx4 v10, s[28:31], s54 offen lds
  v_add_u32 v15, 16384, v11
  v_add_u32 v16, 16384, v12
  ds_read_b64_tr_b16 a[112:113], v15 offset:0
  ds_read_b64_tr_b16 a[114:115], v15 offset:512
  ds_read_b64_tr_b16 a[116:117], v15 offset:8192
  ds_read_b64_tr_b16 a[118:119], v15 offset:8704
  ds_read_b64_tr_b16 a[120:121], v16 offset:0
  ds_read_b64_tr_b16 a[122:123], v16 offset:512
  ds_read_b64_tr_b16 a[124:125], v16 offset:8192
  ds_read_b64_tr_b16 a[126:127], v16 offset:8704
  s_waitcnt vmcnt(28) lgkmcnt(0)
  s_barrier
  s_add_u32 m0, s57, 0
  s_add_u32 s54, s78, 0
  buffer_load_dwordx4 v8, s[16:19], s54 offen lds
  s_add_u32 m0, s57, 4096
  s_add_u32 s54, s78, 131072
  buffer_load_dwordx4 v8, s[16:19], s54 offen lds
  s_add_u32 m0, s57, 8192
  s_add_u32 s54, s78, 262144
  buffer_load_dwordx4 v8, s[16:19], s54 offen lds
  s_add_u32 m0, s57, 12288
  s_add_u32 s54, s78, 393216
  buffer_load_dwordx4 v8, s[16:19], s54 offen lds
  v_add_u32 v15, 32768, v11
  v_add_u32 v16, 32768, v12
  ds_read_b64_tr_b16 a[128:129], v15 offset:0
  ds_read_b64_tr_b16 a[130:131], v15 offset:512
  ds_read_b64_tr_b16 a[132:133], v15 offset:8192
  ds_read_b64_tr_b16 a[134:135], v15 offset:8704
  ds_read_b64_tr_b16 a[136:137], v16 offset:0
  ds_read_b64_tr_b16 a[138:139], v16 offset:512
  ds_read_b64_tr_b16 a[140:141], v16 offset:8192
  ds_read_b64_tr_b16 a[142:143], v16 offset:8704
  s_waitcnt vmcnt(28) lgkmcnt(0)
  s_barrier
  s_add_u32 m0, s57, 16384
  s_add_u32 s54, s78, 0
  buffer_load_dwordx4 v8, s[20:23], s54 offen lds
  s_add_u32 m0, s57, 20480
  s_add_u32 s54, s78, 131072
  buffer_load_dwordx4 v8, s[20:23], s54 offen lds
  s_add_u32 m0, s57, 24576
  s_add_u32 s54, s78, 262144
  buffer_load_dwordx4 v8, s[20:23], s54 offen lds
  s_add_u32 m0, s57, 28672
  s_add_u32 s54, s78, 393216
  buffer_load_dwordx4 v8, s[20:23], s54 offen lds
  v_add_u32 v15, 49152, v11
  v_add_u32 v16, 49152, v12
  ds_read_b64_tr_b16 a[144:145], v15 offset:0
  ds_read_b64_tr_b16 a[146:147], v15 offset:512
  ds_read_b64_tr_b16 a[148:149], v15 offset:8192
  ds_read_b64_tr_b16 a[150:151], v15 offset:8704
  ds_read_b64_tr_b16 a[152:153], v16 offset:0
  ds_read_b64_tr_b16 a[154:155], v16 offset:512
  ds_read_b64_tr_b16 a[156:157], v16 offset:8192
  ds_read_b64_tr_b16 a[158:159], v16 offset:8704
  s_waitcnt vmcnt(28) lgkmcnt(0)
  s_barrier
  s_add_u32 m0, s57, 32768
  s_add_u32 s54, s78, 1048576
  buffer_load_dwordx4 v8, s[20:23], s54 offen lds
  s_add_u32 m0, s57, 36864
  s_add_u32 s54, s78, 1179648
  buffer_load_dwordx4 v8, s[20:23], s54 offen lds
  s_add_u32 m0, s57, 40960
  s_add_u32 s54, s78, 1310720
  buffer_load_dwordx4 v8, s[20:23], s54 offen lds
  s_add_u32 m0, s57, 45056
  s_add_u32 s54, s78, 1441792
  buffer_load_dwordx4 v8, s[20:23], s54 offen lds
  v_add_u32 v15, 65536, v11
  v_add_u32 v16, 65536, v12
  ds_read_b64_tr_b16 a[160:161], v15 offset:0
  ds_read_b64_tr_b16 a[162:163], v15 offset:512
  ds_read_b64_tr_b16 a[164:165], v15 offset:8192
  ds_read_b64_tr_b16 a[166:167], v15 offset:8704
  ds_read_b64_tr_b16 a[168:169], v16 offset:0
  ds_read_b64_tr_b16 a[170:171], v16 offset:512
  ds_read_b64_tr_b16 a[172:173], v16 offset:8192
  ds_read_b64_tr_b16 a[174:175], v16 offset:8704
  s_waitcnt vmcnt(28) lgkmcnt(0)
  s_barrier
  s_add_u32 m0, s57, 49152
  s_add_u32 s54, s78, 4194304
  buffer_load_dwordx4 v8, s[20:23], s54 offen lds
  s_add_u32 m0, s57, 53248
  s_add_u32 s54, s78, 4325376
  buffer_load_dwordx4 v8, s[20:23], s54 offen lds
  s_add_u32 m0, s57, 57344
  s_add_u32 s54, s78, 4456448
  buffer_load_dwordx4 v8, s[20:23], s54 offen lds
  s_add_u32 m0, s57, 61440
  s_add_u32 s54, s78, 4587520
  buffer_load_dwordx4 v8, s[20:23], s54 offen lds
  v_add_u32 v15, 81920, v14
  ds_read_b64_tr_b16 a[176:177], v15 offset:0
  ds_read_b64_tr_b16 a[178:179], v15 offset:1024
  ds_read_b64_tr_b16 a[180:181], v15 offset:4096
  ds_read_b64_tr_b16 a[182:183], v15 offset:5120
  ds_read_b64_tr_b16 a[184:185], v15 offset:8192
  ds_read_b64_tr_b16 a[186:187], v15 offset:9216
  ds_read_b64_tr_b16 a[188:189], v15 offset:12288
  ds_read_b64_tr_b16 a[190:191], v15 offset:13312
  s_waitcnt vmcnt(28) lgkmcnt(0)
  s_barrier
  s_add_u32 m0, s57, 65536
  s_add_u32 s54, s78, 2097152
  buffer_load_dwordx4 v8, s[20:23], s54 offen lds
  s_add_u32 m0, s57, 69632
  s_add_u32 s54, s78, 2228224
  buffer_load_dwordx4 v8, s[20:23], s54 offen lds
  s_add_u32 m0, s57, 73728
  s_add_u32 s54, s78, 2359296
  buffer_load_dwordx4 v8, s[20:23], s54 offen lds
  s_add_u32 m0, s57, 77824
  s_add_u32 s54, s78, 2490368
  buffer_load_dwordx4 v8, s[20:23], s54 offen lds
  v_add_u32 v15, 98304, v14
  ds_read_b64_tr_b16 a[192:193], v15 offset:0
  ds_read_b64_tr_b16 a[194:195], v15 offset:1024
  ds_read_b64_tr_b16 a[196:197], v15 offset:4096
  ds_read_b64_tr_b16 a[198:199], v15 offset:5120
  ds_read_b64_tr_b16 a[200:201], v15 offset:8192
  ds_read_b64_tr_b16 a[202:203], v15 offset:9216
  ds_read_b64_tr_b16 a[204:205], v15 offset:12288
  ds_read_b64_tr_b16 a[206:207], v15 offset:13312
  s_waitcnt vmcnt(28) lgkmcnt(0)
  s_barrier
  s_add_u32 m0, s57, 81920
  s_add_u32 s54, s79, 73984
  buffer_load_dwordx4 v10, s[28:31], s54 offen lds
  s_add_u32 m0, s57, 86016
  s_add_u32 s54, s79, 83200
  buffer_load_dwordx4 v10, s[28:31], s54 offen lds
  s_add_u32 m0, s57, 90112
  s_add_u32 s54, s79, 110848
  buffer_load_dwordx4 v10, s[28:31], s54 offen lds
  s_add_u32 m0, s57, 94208
  s_add_u32 s54, s79, 120064
  buffer_load_dwordx4 v10, s[28:31], s54 offen lds
  v_add_u32 v15, 114688, v14
  ds_read_b64_tr_b16 a[208:209], v15 offset:0
  ds_read_b64_tr_b16 a[210:211], v15 offset:1024
  ds_read_b64_tr_b16 a[212:213], v15 offset:4096
  ds_read_b64_tr_b16 a[214:215], v15 offset:5120
  ds_read_b64_tr_b16 a[216:217], v15 offset:8192
  ds_read_b64_tr_b16 a[218:219], v15 offset:9216
  ds_read_b64_tr_b16 a[220:221], v15 offset:12288
  ds_read_b64_tr_b16 a[222:223], v15 offset:13312
  s_waitcnt vmcnt(28) lgkmcnt(0)
  s_barrier
  s_add_u32 m0, s57, 98304
  s_add_u32 s54, s79, 74240
  buffer_load_dwordx4 v10, s[28:31], s54 offen lds
  s_add_u32 m0, s57, 102400
  s_add_u32 s54, s79, 83456
  buffer_load_dwordx4 v10, s[28:31], s54 offen lds
  s_add_u32 m0, s57, 106496
  s_add_u32 s54, s79, 111104
  buffer_load_dwordx4 v10, s[28:31], s54 offen lds
  s_add_u32 m0, s57, 110592
  s_add_u32 s54, s79, 120320
  buffer_load_dwordx4 v10, s[28:31], s54 offen lds
  v_add_u32 v15, 131072, v14
  ds_read_b64_tr_b16 a[224:225], v15 offset:0
  ds_read_b64_tr_b16 a[226:227], v15 offset:1024
  ds_read_b64_tr_b16 a[228:229], v15 offset:4096
  ds_read_b64_tr_b16 a[230:231], v15 offset:5120
  ds_read_b64_tr_b16 a[232:233], v15 offset:8192
  ds_read_b64_tr_b16 a[234:235], v15 offset:9216
  ds_read_b64_tr_b16 a[236:237], v15 offset:12288
  ds_read_b64_tr_b16 a[238:239], v15 offset:13312
  s_waitcnt vmcnt(28) lgkmcnt(0)
  s_barrier
  s_add_u32 m0, s57, 114688
  s_add_u32 s54, s79, 74496
  buffer_load_dwordx4 v10, s[28:31], s54 offen lds
  s_add_u32 m0, s57, 118784
  s_add_u32 s54, s79, 83712
  buffer_load_dwordx4 v10, s[28:31], s54 offen lds
  s_add_u32 m0, s57, 122880
  s_add_u32 s54, s79, 111360
  buffer_load_dwordx4 v10, s[28:31], s54 offen lds
  s_add_u32 m0, s57, 126976
  s_add_u32 s54, s79, 120576
  buffer_load_dwordx4 v10, s[28:31], s54 offen lds
  v_add_u32 v15, 147456, v14
  ds_read_b64_tr_b16 a[240:241], v15 offset:0
  ds_read_b64_tr_b16 a[242:243], v15 offset:1024
  ds_read_b64_tr_b16 a[244:245], v15 offset:4096
  ds_read_b64_tr_b16 a[246:247], v15 offset:5120
  ds_read_b64_tr_b16 a[248:249], v15 offset:8192
  ds_read_b64_tr_b16 a[250:251], v15 offset:9216
  ds_read_b64_tr_b16 a[252:253], v15 offset:12288
  ds_read_b64_tr_b16 a[254:255], v15 offset:13312
  s_waitcnt vmcnt(28) lgkmcnt(0)
  s_barrier
  s_add_u32 m0, s57, 131072
  s_add_u32 s54, s79, 1024
  buffer_load_dwordx4 v9, s[28:31], s54 offen lds
  s_add_u32 m0, s57, 135168
  s_add_u32 s54, s79, 37888
  buffer_load_dwordx4 v9, s[28:31], s54 offen lds
  s_add_u32 m0, s57, 139264
  s_add_u32 s54, s79, 74752
  buffer_load_dwordx4 v9, s[28:31], s54 offen lds
  s_add_u32 m0, s57, 143360
  s_add_u32 s54, s79, 111616
  buffer_load_dwordx4 v9, s[28:31], s54 offen lds
  buffer_store_dwordx4 v[20:23], v76, s[8:11], s64 offen
  buffer_store_dwordx4 v[24:27], v76, s[8:11], s64 offen offset:1024
  buffer_store_dwordx4 v[28:31], v76, s[8:11], s65 offen
  v_mov_b32 v32, -1
  v_mov_b32 v33, -1
  buffer_store_dwordx2 v[32:33], v68, s[8:11], s73 offen
  buffer_store_dwordx2 v[32:33], v68, s[8:11], s74 offen
  buffer_store_dwordx2 v[32:33], v68, s[8:11], s75 offen
  buffer_store_dwordx2 v[32:33], v68, s[8:11], s76 offen
  buffer_store_dwordx2 v[32:33], v68, s[8:11], s77 offen
  buffer_store_dword v32, v69, s[8:11], s62 offen
  buffer_store_dword v32, v70, s[8:11], s63 offen
  v_mov_b32 v34, 0
  s_mov_b64 exec, 1
  buffer_store_dword v34, v34, s[8:11], s71 offen sc1
  s_mov_b64 exec, -1
  v_add_u32 v15, 16384, v11
  v_add_u32 v16, 16384, v12
  ds_read_b64_tr_b16 v[52:53], v15 offset:0
  ds_read_b64_tr_b16 v[54:55], v15 offset:512
  ds_read_b64_tr_b16 v[56:57], v15 offset:8192
  ds_read_b64_tr_b16 v[58:59], v15 offset:8704
  ds_read_b64_tr_b16 v[60:61], v16 offset:0
  ds_read_b64_tr_b16 v[62:63], v16 offset:512
  ds_read_b64_tr_b16 v[64:65], v16 offset:8192
  ds_read_b64_tr_b16 v[66:67], v16 offset:8704
  s_waitcnt vmcnt(39) lgkmcnt(0)
  s_barrier
  s_lshl_b32 s54, s52, 12
  s_add_u32 s54, s54, 16384
  v_add_u32 v7, s54, v76
  ds_write_b128 v7, v[52:55] offset:0
  ds_write_b128 v7, v[56:59] offset:1024
  ds_write_b128 v7, v[60:63] offset:2048
  ds_write_b128 v7, v[64:67] offset:3072
  v_add_u32 v15, 32768, v11
  v_add_u32 v16, 32768, v12
  ds_read_b64_tr_b16 v[36:37], v15 offset:0
  ds_read_b64_tr_b16 v[38:39], v15 offset:512
  ds_read_b64_tr_b16 v[40:41], v15 offset:8192
  ds_read_b64_tr_b16 v[42:43], v15 offset:8704
  ds_read_b64_tr_b16 v[44:45], v16 offset:0
  ds_read_b64_tr_b16 v[46:47], v16 offset:512
  ds_read_b64_tr_b16 v[48:49], v16 offset:8192
  ds_read_b64_tr_b16 v[50:51], v16 offset:8704
  s_waitcnt vmcnt(35) lgkmcnt(0)
  s_barrier
  s_lshl_b32 s54, s52, 12
  s_add_u32 s54, s54, 32768
  v_add_u32 v7, s54, v76
  ds_write_b128 v7, v[36:39] offset:0
  ds_write_b128 v7, v[40:43] offset:1024
  ds_write_b128 v7, v[44:47] offset:2048
  ds_write_b128 v7, v[48:51] offset:3072
  v_add_u32 v15, 49152, v11
  v_add_u32 v16, 49152, v12
  ds_read_b64_tr_b16 v[52:53], v15 offset:0
  ds_read_b64_tr_b16 v[54:55], v15 offset:512
  ds_read_b64_tr_b16 v[56:57], v15 offset:8192
  ds_read_b64_tr_b16 v[58:59], v15 offset:8704
  ds_read_b64_tr_b16 v[60:61], v16 offset:0
  ds_read_b64_tr_b16 v[62:63], v16 offset:512
  ds_read_b64_tr_b16 v[64:65], v16 offset:8192
  ds_read_b64_tr_b16 v[66:67], v16 offset:8704
  s_waitcnt vmcnt(31) lgkmcnt(0)
  s_barrier
  s_lshl_b32 s54, s52, 12
  s_add_u32 s54, s54, 49152
  v_add_u32 v7, s54, v76
  ds_write_b128 v7, v[52:55] offset:0
  ds_write_b128 v7, v[56:59] offset:1024
  ds_write_b128 v7, v[60:63] offset:2048
  ds_write_b128 v7, v[64:67] offset:3072
  v_add_u32 v15, 65536, v11
  v_add_u32 v16, 65536, v12
  ds_read_b64_tr_b16 v[36:37], v15 offset:0
  ds_read_b64_tr_b16 v[38:39], v15 offset:512
  ds_read_b64_tr_b16 v[40:41], v15 offset:8192
  ds_read_b64_tr_b16 v[42:43], v15 offset:8704
  ds_read_b64_tr_b16 v[44:45], v16 offset:0
  ds_read_b64_tr_b16 v[46:47], v16 offset:512
  ds_read_b64_tr_b16 v[48:49], v16 offset:8192
  ds_read_b64_tr_b16 v[50:51], v16 offset:8704
  s_waitcnt vmcnt(27) lgkmcnt(0)
  s_barrier
  s_lshl_b32 s54, s52, 12
  s_add_u32 s54, s54, 65536
  v_add_u32 v7, s54, v76
  ds_write_b128 v7, v[36:39] offset:0
  ds_write_b128 v7, v[40:43] offset:1024
  ds_write_b128 v7, v[44:47] offset:2048
  ds_write_b128 v7, v[48:51] offset:3072
  v_add_u32 v15, 81920, v11
  v_add_u32 v16, 81920, v12
  ds_read_b64_tr_b16 v[52:53], v15 offset:0
  ds_read_b64_tr_b16 v[54:55], v15 offset:512
  ds_read_b64_tr_b16 v[56:57], v15 offset:8192
  ds_read_b64_tr_b16 v[58:59], v15 offset:8704
  ds_read_b64_tr_b16 v[60:61], v16 offset:0
  ds_read_b64_tr_b16 v[62:63], v16 offset:512
  ds_read_b64_tr_b16 v[64:65], v16 offset:8192
  ds_read_b64_tr_b16 v[66:67], v16 offset:8704
  s_waitcnt vmcnt(23) lgkmcnt(0)
  s_barrier
  s_lshl_b32 s54, s52, 12
  s_add_u32 s54, s54, 81920
  v_add_u32 v7, s54, v76
  ds_write_b128 v7, v[52:55] offset:0
  ds_write_b128 v7, v[56:59] offset:1024
  ds_write_b128 v7, v[60:63] offset:2048
  ds_write_b128 v7, v[64:67] offset:3072
  v_add_u32 v15, 98304, v14
  ds_read_b64_tr_b16 v[36:37], v15 offset:0
  ds_read_b64_tr_b16 v[38:39], v15 offset:1024
  ds_read_b64_tr_b16 v[40:41], v15 offset:4096
  ds_read_b64_tr_b16 v[42:43], v15 offset:5120
  ds_read_b64_tr_b16 v[44:45], v15 offset:8192
  ds_read_b64_tr_b16 v[46:47], v15 offset:9216
  ds_read_b64_tr_b16 v[48:49], v15 offset:12288
  ds_read_b64_tr_b16 v[50:51], v15 offset:13312
  s_waitcnt vmcnt(19) lgkmcnt(0)
  s_barrier
  s_lshl_b32 s54, s52, 12
  s_add_u32 s54, s54, 98304
  v_add_u32 v7, s54, v76
  ds_write_b128 v7, v[36:39] offset:0
  ds_write_b128 v7, v[40:43] offset:1024
  ds_write_b128 v7, v[44:47] offset:2048
  ds_write_b128 v7, v[48:51] offset:3072
  v_add_u32 v15, 114688, v14
  ds_read_b64_tr_b16 v[52:53], v15 offset:0
  ds_read_b64_tr_b16 v[54:55], v15 offset:1024
  ds_read_b64_tr_b16 v[56:57], v15 offset:4096
  ds_read_b64_tr_b16 v[58:59], v15 offset:5120
  ds_read_b64_tr_b16 v[60:61], v15 offset:8192
  ds_read_b64_tr_b16 v[62:63], v15 offset:9216
  ds_read_b64_tr_b16 v[64:65], v15 offset:12288
  ds_read_b64_tr_b16 v[66:67], v15 offset:13312
  s_waitcnt vmcnt(15) lgkmcnt(0)
  s_barrier
  s_lshl_b32 s54, s52, 12
  s_add_u32 s54, s54, 114688
  v_add_u32 v7, s54, v76
  ds_write_b128 v7, v[52:55] offset:0
  ds_write_b128 v7, v[56:59] offset:1024
  ds_write_b128 v7, v[60:63] offset:2048
  ds_write_b128 v7, v[64:67] offset:3072
  v_add_u32 v15, 131072, v14
  ds_read_b64_tr_b16 v[36:37], v15 offset:0
  ds_read_b64_tr_b16 v[38:39], v15 offset:1024
  ds_read_b64_tr_b16 v[40:41], v15 offset:4096
  ds_read_b64_tr_b16 v[42:43], v15 offset:5120
  ds_read_b64_tr_b16 v[44:45], v15 offset:8192
  ds_read_b64_tr_b16 v[46:47], v15 offset:9216
  ds_read_b64_tr_b16 v[48:49], v15 offset:12288
  ds_read_b64_tr_b16 v[50:51], v15 offset:13312
  s_waitcnt vmcnt(11) lgkmcnt(0)
  s_barrier
  s_lshl_b32 s54, s52, 12
  s_add_u32 s54, s54, 131072
  v_add_u32 v7, s54, v76
  ds_write_b128 v7, v[36:39] offset:0
  ds_write_b128 v7, v[40:43] offset:1024
  ds_write_b128 v7, v[44:47] offset:2048
  ds_write_b128 v7, v[48:51] offset:3072
  v_add_u32 v15, 147456, v13
  s_waitcnt lgkmcnt(0)
  ds_read_b64_tr_b16 v[36:37], v15 offset:0
  ds_read_b64_tr_b16 v[38:39], v15 offset:1024
  ds_read_b64_tr_b16 v[40:41], v15 offset:2048
  ds_read_b64_tr_b16 v[42:43], v15 offset:3072
  ds_read_b64_tr_b16 v[44:45], v15 offset:4096
  ds_read_b64_tr_b16 v[46:47], v15 offset:5120
  ds_read_b64_tr_b16 v[48:49], v15 offset:6144
  ds_read_b64_tr_b16 v[50:51], v15 offset:7168
  ds_read_b64_tr_b16 v[52:53], v15 offset:8192
  ds_read_b64_tr_b16 v[54:55], v15 offset:9216
  ds_read_b64_tr_b16 v[56:57], v15 offset:10240
  ds_read_b64_tr_b16 v[58:59], v15 offset:11264
  ds_read_b64_tr_b16 v[60:61], v15 offset:12288
  ds_read_b64_tr_b16 v[62:63], v15 offset:13312
  ds_read_b64_tr_b16 v[64:65], v15 offset:14336
  ds_read_b64_tr_b16 v[66:67], v15 offset:15360
  s_waitcnt vmcnt(0) lgkmcnt(0)
  s_barrier
  s_and_b32 s54, s52, 1
  s_lshl_b32 s54, s54, 13
  s_add_u32 s54, s54, 147456
  v_add_u32 v7, s54, v76
  ds_write_b128 v7, v[36:39] offset:0
  ds_write_b128 v7, v[40:43] offset:1024
  ds_write_b128 v7, v[44:47] offset:2048
  ds_write_b128 v7, v[48:51] offset:3072
  ds_write_b128 v7, v[52:55] offset:4096
  ds_write_b128 v7, v[56:59] offset:5120
  ds_write_b128 v7, v[60:63] offset:6144
  ds_write_b128 v7, v[64:67] offset:7168
  s_waitcnt lgkmcnt(0)
  s_cmp_eq_u32 s52, 0
  s_cbranch_scc0 L_tb2
  v_mov_b32 v1, 32
  v_mov_b32 v2, 1
  s_mov_b64 exec, 1
  buffer_atomic_add v2, v1, s[12:15], 0 offen
  s_mov_b64 exec, 3
  s_lshl_b32 s55, s53, 2
  s_add_u32 s55, s55, 128
  v_mov_b32 v3, 32
  v_writelane_b32 v1, s55, 1
  v_writelane_b32 v3, 7, 1
L_tb1:
  buffer_load_dword v2, v1, s[12:15], 0 offen sc1
  s_add_u32 s67, s67, 1
  s_waitcnt vmcnt(0)
  v_cmp_lt_u32 vcc, v2, v3
  s_cmp_lt_u32 s67, 131072
  s_cselect_b64 vcc, vcc, 0
  s_cbranch_vccnz L_tb1
  s_mov_b64 exec, -1
L_tb2:
  s_barrier
  s_cmp_eq_u32 s52, 1
  s_cbranch_scc1 L_w1
  s_cmp_eq_u32 s52, 2
  s_cbranch_scc1 L_w2
  s_cmp_eq_u32 s52, 3
  s_cbranch_scc1 L_w3
  v_mov_b64 v[20:21], 0
  v_mov_b64 v[22:23], 0
  v_mov_b64 v[24:25], 0
  v_mov_b64 v[26:27], 0
  v_mov_b64 v[28:29], 0
  v_mov_b64 v[30:31], 0
  v_mov_b64 v[32:33], 0
  v_mov_b64 v[34:35], 0
  s_mov_b32 m0, 15872
  s_branch Cf0_h2
.p2align 6
Cf0_top:
  s_waitcnt lgkmcnt(0)
  s_barrier
  ds_read_b128 v[0:3], v76 offset:0
  ds_read_b128 v[4:7], v76 offset:1024
  s_waitcnt lgkmcnt(1)
  v_smfmac_f32_16x16x64_bf16 v[20:23], v[0:3], v[60:67], v74
  ds_read_b128 v[60:63], v76 offset:34816
  v_smfmac_f32_16x16x64_bf16 v[24:27], v[0:3], v[44:51], v74
  ds_read_b128 v[64:67], v76 offset:35840
  s_waitcnt lgkmcnt(2)
  v_smfmac_f32_16x16x64_bf16 v[20:23], v[4:7], v[80:87], v74
  buffer_load_dwordx4 v[44:47], v76, s[8:11], s58 offen offset:0 sc1
  ds_read_b128 v[8:11], v76 offset:2048
  v_smfmac_f32_16x16x64_bf16 v[28:31], v[0:3], v[36:43], v74
  ds_read_b128 v[36:39], v76 offset:49152
  v_smfmac_f32_16x16x64_bf16 v[24:27], v[4:7], v[88:95], v74
  buffer_load_dwordx4 v[48:51], v76, s[8:11], s58 offen offset:1024 sc1
  ds_read_b128 v[40:43], v76 offset:50176
  v_smfmac_f32_16x16x64_bf16 v[28:31], v[4:7], v[208:215], v74
  s_waitcnt vmcnt(4)
  ds_read_b128 v[12:15], v76 offset:3072
  v_smfmac_f32_16x16x64_bf16 v[32:35], v[4:7], v[216:223], v74
  buffer_load_dwordx4 v[52:55], v76, s[8:11], s59 offen offset:0 sc1
  s_waitcnt lgkmcnt(4)
  v_smfmac_f32_16x16x64_bf16 v[32:35], v[0:3], v[60:67], v74
  ds_read_b128 v[60:63], v76 offset:51200
  s_waitcnt lgkmcnt(4)
  v_smfmac_f32_16x16x64_bf16 v[20:23], v[8:11], v[96:103], v74
  buffer_load_dwordx4 v[56:59], v76, s[8:11], s59 offen offset:1024 sc1
  ds_read_b128 v[64:67], v76 offset:52224
  v_smfmac_f32_16x16x64_bf16 v[24:27], v[8:11], v[104:111], v74
  buffer_store_dwordx4 v[16:19], v76, s[8:11], s68 offen sc1
  ds_read_b128 v[0:3], v76 offset:8192
  s_waitcnt lgkmcnt(4)
  v_smfmac_f32_16x16x64_bf16 v[28:31], v[8:11], v[36:43], v74
  ds_read_b128 v[36:39], v75 offset:0
  s_waitcnt lgkmcnt(4)
  v_smfmac_f32_16x16x64_bf16 v[20:23], v[12:15], v[112:119], v74
  ds_read_b128 v[40:43], v75 offset:1024
  v_smfmac_f32_16x16x64_bf16 v[24:27], v[12:15], v[120:127], v74
  buffer_load_dword v73, s[8:11], s70 offen lds
  s_waitcnt lgkmcnt(3)
  v_smfmac_f32_16x16x64_bf16 v[32:35], v[8:11], v[60:67], v74
  ds_read_b128 v[60:63], v75 offset:2048
  v_smfmac_f32_16x16x64_bf16 v[28:31], v[12:15], v[224:231], v74
  ds_read_b128 v[64:67], v75 offset:3072
  v_smfmac_f32_16x16x64_bf16 v[32:35], v[12:15], v[232:239], v74
  s_barrier
  s_waitcnt lgkmcnt(4)
  v_smfmac_f32_16x16x64_bf16 v[20:23], v[0:3], v[192:199], v74
  ds_read_b128 v[4:7], v76 offset:4096
  s_waitcnt lgkmcnt(3)
  v_smfmac_f32_16x16x64_bf16 v[28:31], v[0:3], v[36:43], v74
  ds_read_b128 v[16:19], v76 offset:5120
  v_smfmac_f32_16x16x64_bf16 v[24:27], v[0:3], v[200:207], v74
  ds_read_b128 v[36:39], v75 offset:16384
  s_waitcnt lgkmcnt(3)
  v_mov_b32 v68, 0x3f803f80
  v_smfmac_f32_16x16x64_bf16 v[32:35], v[0:3], v[60:67], v74
  ds_read_b128 v[40:43], v75 offset:17408
  s_waitcnt lgkmcnt(3)
  v_smfmac_f32_16x16x64_bf16 v[20:23], v[4:7], v[128:135], v74
  ds_read_b128 v[12:15], v76 offset:6144
  v_mov_b32 v69, 0x3f803f80
  v_smfmac_f32_16x16x64_bf16 v[24:27], v[4:7], v[136:143], v74
  ds_read_b128 v[8:11], v76 offset:7168
  s_waitcnt lgkmcnt(4)
  v_smfmac_f32_16x16x64_bf16 v[20:23], v[16:19], v[144:151], v74
  ds_read_b128 v[60:63], v75 offset:18432
  v_mov_b64 v[70:71], v[68:69]
  v_smfmac_f32_16x16x64_bf16 v[24:27], v[16:19], v[152:159], v74
  ds_read_b128 v[64:67], v75 offset:19456
  s_waitcnt lgkmcnt(4)
  v_smfmac_f32_16x16x64_bf16 v[28:31], v[4:7], v[36:43], v74
  s_waitcnt lgkmcnt(3)
  v_mov_b64 v[36:37], 0
  v_smfmac_f32_16x16x64_bf16 v[20:23], v[12:15], v[160:167], v74
  s_waitcnt lgkmcnt(2)
  v_mov_b64 v[38:39], 0
  v_smfmac_f32_16x16x64_bf16 v[20:23], v[8:11], v[176:183], v74
  v_mov_b64 v[40:41], 0
  v_smfmac_f32_16x16x64_bf16 v[24:27], v[12:15], v[168:175], v74
  v_mov_b64 v[42:43], 0
  v_smfmac_f32_16x16x64_bf16 v[24:27], v[8:11], v[184:191], v74
  s_waitcnt lgkmcnt(0)
  v_add_f32 v20, v20, v22
  v_smfmac_f32_16x16x64_bf16 v[32:35], v[4:7], v[60:67], v74
  v_add_f32 v21, v21, v23
  v_smfmac_f32_16x16x64_bf16 v[28:31], v[16:19], v[240:247], v74
  v_add_f32 v24, v24, v26
  v_cvt_pk_bf16_f32 v22, v20, v24
  v_smfmac_f32_16x16x64_bf16 v[28:31], v[12:15], a[0:7], v74
  ds_write_b32 v79, v22 offset:0
  v_add_f32 v25, v25, v27
  v_cvt_pk_bf16_f32 v23, v21, v25
  v_smfmac_f32_16x16x64_bf16 v[28:31], v[8:11], a[16:23], v74
  ds_write_b32 v79, v23 offset:576
  v_cmp_u_f32 vcc, v20, v21
  v_smfmac_f32_16x16x64_bf16 v[32:35], v[16:19], v[248:255], v74
  v_smfmac_f32_16x16x64_bf16 v[32:35], v[12:15], a[8:15], v74
  v_add_f32 v28, v28, v30
  v_add_f32 v29, v29, v31
  v_smfmac_f32_16x16x64_bf16 v[32:35], v[8:11], a[24:31], v74
  s_cbranch_vccnz Cf0_rec
Cf0_recok:
  v_smfmac_f32_16x16x64_bf16 v[36:39], v[16:19], a[112:119], v74
  s_waitcnt lgkmcnt(0)
  s_barrier
  ds_read_b128 v[60:63], v77
  v_smfmac_f32_16x16x64_bf16 v[40:43], v[16:19], a[120:127], v74
  ds_read_b128 v[64:67], v77 offset:128
  v_add_f32 v32, v32, v34
  v_cvt_pk_bf16_f32 v30, v28, v32
  v_smfmac_f32_16x16x64_bf16 v[36:39], v[0:3], a[160:167], v74
  ds_write_b32 v79, v30 offset:256
  v_add_f32 v33, v33, v35
  v_cvt_pk_bf16_f32 v31, v29, v33
  v_smfmac_f32_16x16x64_bf16 v[40:43], v[0:3], a[168:175], v74
  ds_write_b32 v79, v31 offset:832
  v_xor_b32 v75, 0x8000, v75
  v_smfmac_f32_16x16x64_bf16 v[36:39], v[4:7], a[96:103], v74
  ds_read_b128 v[0:3], v76 offset:0
  v_mov_b32 v29, 0
  v_smfmac_f32_16x16x64_bf16 v[40:43], v[4:7], a[104:111], v74
  s_waitcnt vmcnt(4) lgkmcnt(3)
  v_mov_b32 v30, 0
  v_mfma_f32_16x16x32_bf16 v[44:47], v[44:47], v[60:63], 0
  ds_read_b128 v[4:7], v76 offset:1024
  s_waitcnt lgkmcnt(2)
  v_mfma_f32_16x16x32_bf16 v[44:47], v[48:51], v[64:67], v[44:47]
  s_barrier
  v_smfmac_f32_16x16x64_bf16 v[36:39], v[8:11], a[144:151], v74
  ds_read_b128 v[20:23], v77 offset:256
  ds_read_b128 v[24:27], v77 offset:384
  v_smfmac_f32_16x16x64_bf16 v[40:43], v[8:11], a[152:159], v74
  ds_read_b128 v[8:11], v76 offset:2048
  v_add_f32_dpp v72, v46, v44 quad_perm:[2,3,0,1] row_mask:0xf bank_mask:0xf
  v_add_f32_dpp v73, v47, v45 quad_perm:[2,3,0,1] row_mask:0xf bank_mask:0xf
  v_smfmac_f32_16x16x64_bf16 v[36:39], v[12:15], a[128:135], v74
  ds_read_b128 v[44:47], v75 offset:0
  v_exp_f32_dpp v72, v72 quad_perm:[0,1,0,1] row_mask:0xf bank_mask:0xf
  v_smfmac_f32_16x16x64_bf16 v[40:43], v[12:15], a[136:143], v74
  ds_read_b128 v[12:15], v76 offset:3072
  s_waitcnt lgkmcnt(6)
  v_exp_f32_dpp v73, v73 quad_perm:[0,1,0,1] row_mask:0xf bank_mask:0xf
  v_smfmac_f32_16x16x64_bf16 v[36:39], v[0:3], a[32:39], v74
  s_waitcnt lgkmcnt(3)
  v_cvt_pk_bf16_f32 v72, v72, v73
  v_mfma_f32_16x16x32_bf16 v[20:23], v[20:23], v[60:63], 0
  ds_write_b32 v78, v72 offset:512
  v_mfma_f32_16x16x32_bf16 v[20:23], v[24:27], v[64:67], v[20:23]
  ds_read_b128 v[48:51], v75 offset:1024
  v_smfmac_f32_16x16x64_bf16 v[40:43], v[0:3], a[40:47], v74
  ds_read_b128 v[60:63], v75 offset:2048
  v_smfmac_f32_16x16x64_bf16 v[36:39], v[4:7], a[48:55], v74
  s_waitcnt lgkmcnt(5)
  v_add_f32_dpp v24, v22, v20 quad_perm:[2,3,0,1] row_mask:0xf bank_mask:0xf
  v_add_f32_dpp v25, v23, v21 quad_perm:[2,3,0,1] row_mask:0xf bank_mask:0xf
  v_smfmac_f32_16x16x64_bf16 v[36:39], v[8:11], a[64:71], v74
  s_waitcnt lgkmcnt(2)
  s_barrier
  ds_read_b128 v[32:35], v78 offset:512
  v_smfmac_f32_16x16x64_bf16 v[36:39], v[12:15], a[80:87], v74
  ds_read_b128 v[64:67], v75 offset:3072
  v_mul_f32 v24, s69, v24
  v_smfmac_f32_16x16x64_bf16 v[40:43], v[4:7], a[56:63], v74
  v_mul_f32 v25, s69, v25
  v_smfmac_f32_16x16x64_bf16 v[40:43], v[8:11], a[72:79], v74
  v_exp_f32_dpp v24, v24 quad_perm:[0,1,0,1] row_mask:0xf bank_mask:0xf
  v_smfmac_f32_16x16x64_bf16 v[40:43], v[12:15], a[88:95], v74
  s_waitcnt vmcnt(2) lgkmcnt(1)
  v_exp_f32_dpp v25, v25 quad_perm:[0,1,0,1] row_mask:0xf bank_mask:0xf
  v_mfma_f32_16x16x32_bf16 v[8:11], v[32:35], v[68:71], 0
  v_add_f32 v36, v36, v38
  v_add_f32 v37, v37, v39
  v_mfma_f32_16x16x32_bf16 v[0:3], v[32:35], v[52:55], 0
  v_add_f32 v40, v40, v42
  v_add_f32 v41, v41, v43
  v_mfma_f32_16x16x32_bf16 v[4:7], v[32:35], v[56:59], 0
  v_cvt_pk_bf16_f32 v28, v24, v25
  v_cvt_pk_bf16_f32 v72, v36, v37
  v_cvt_pk_bf16_f32 v73, v40, v41
  v_mfma_f32_16x16x16_bf16 v[8:11], v[28:29], v[68:69], v[8:11]
  v_cvt_pk_bf16_f32 v31, v24, v25
  v_mfma_f32_16x16x16_bf16 v[0:3], v[28:29], v[72:73], v[0:3]
  ds_read_b128 v[68:71], v76 offset:13824
  v_mfma_f32_16x16x16_bf16 v[4:7], v[30:31], v[72:73], v[4:7]
  v_rcp_f32 v10, v8
  v_rcp_f32 v11, v9
  v_mul_f32 v0, v10, v0
  v_mul_f32 v1, v11, v1
  s_nop 0
  v_mul_f32 v4, v10, v4
  v_mul_f32 v5, v11, v5
  v_cvt_pk_bf16_f32 v2, v0, v4
  ds_write_b32 v79, v2 offset:0
  v_cvt_pk_bf16_f32 v3, v1, v5
  ds_write_b32 v79, v3 offset:576
  v_mov_b64 v[16:17], 0
  v_mov_b64 v[18:19], 0
  v_mov_b64 v[20:21], 0
  v_mov_b64 v[22:23], 0
  v_mov_b64 v[24:25], 0
  v_mov_b64 v[26:27], 0
  v_mov_b64 v[28:29], 0
  v_mov_b64 v[30:31], 0
  v_mov_b64 v[32:33], 0
  v_mov_b64 v[34:35], 0
  s_waitcnt lgkmcnt(0)
  s_barrier
  ds_read_b128 v[0:3], v78 offset:0
  ds_read_b128 v[4:7], v78 offset:64
  ds_read_b128 v[8:11], v78 offset:128
  ds_read_b128 v[12:15], v78 offset:192
  s_cmp_eq_u32 s66, 63
  s_cbranch_scc1 Cf0_last
  s_waitcnt lgkmcnt(3)
  v_smfmac_f32_16x16x64_bf16 v[16:19], v[0:3], a[176:183], v74
  s_waitcnt lgkmcnt(2)
  v_smfmac_f32_16x16x64_bf16 v[16:19], v[4:7], a[184:191], v74
  s_waitcnt lgkmcnt(1)
  v_smfmac_f32_16x16x64_bf16 v[16:19], v[8:11], a[192:199], v74
  ds_read_b128 v[52:55], v75 offset:16384
  s_waitcnt lgkmcnt(1)
  v_smfmac_f32_16x16x64_bf16 v[16:19], v[12:15], a[200:207], v74
  ds_read_b128 v[56:59], v75 offset:17408
  v_smfmac_f32_16x16x64_bf16 v[20:23], v[0:3], a[208:215], v74
  ds_read_b128 v[36:39], v75 offset:18432
  v_smfmac_f32_16x16x64_bf16 v[20:23], v[4:7], a[216:223], v74
  ds_read_b128 v[40:43], v75 offset:19456
  v_cvt_pk_bf16_f32 v16, v16, v17
  v_cvt_pk_bf16_f32 v17, v18, v19
  v_bfi_b32 v16, 1, s72, v16
  v_smfmac_f32_16x16x64_bf16 v[20:23], v[8:11], v[44:51], v74
  ds_read_b128 v[44:47], v75 offset:32768
  buffer_store_dwordx2 v[16:17], v68, s[8:11], s73 offen
  v_smfmac_f32_16x16x64_bf16 v[20:23], v[12:15], v[60:67], v74
  ds_read_b128 v[48:51], v75 offset:33792
  v_smfmac_f32_16x16x64_bf16 v[24:27], v[0:3], a[224:231], v74
  ds_read_b128 v[60:63], v75 offset:34816
  v_smfmac_f32_16x16x64_bf16 v[24:27], v[4:7], a[232:239], v74
  ds_read_b128 v[64:67], v75 offset:35840
  s_waitcnt lgkmcnt(6)
  v_cvt_pk_bf16_f32 v20, v20, v21
  v_cvt_pk_bf16_f32 v21, v22, v23
  v_bfi_b32 v20, 1, s72, v20
  v_smfmac_f32_16x16x64_bf16 v[24:27], v[8:11], v[52:59], v74
  buffer_store_dwordx2 v[20:21], v68, s[8:11], s74 offen
  s_waitcnt lgkmcnt(4)
  v_mov_b64 v[18:19], v[72:73]
  v_smfmac_f32_16x16x64_bf16 v[24:27], v[12:15], v[36:43], v74
  v_mov_b64 v[20:21], 0
  v_smfmac_f32_16x16x64_bf16 v[28:31], v[0:3], a[240:247], v74
  v_mov_b64 v[22:23], 0
  v_smfmac_f32_16x16x64_bf16 v[28:31], v[4:7], a[248:255], v74
  s_waitcnt lgkmcnt(2)
  v_cvt_pk_bf16_f32 v24, v24, v25
  v_cvt_pk_bf16_f32 v25, v26, v27
  v_bfi_b32 v24, 1, s72, v24
  v_smfmac_f32_16x16x64_bf16 v[28:31], v[8:11], v[44:51], v74
  buffer_store_dwordx2 v[24:25], v68, s[8:11], s75 offen
  s_waitcnt lgkmcnt(0)
  v_smfmac_f32_16x16x64_bf16 v[28:31], v[12:15], v[60:67], v74
  ds_read_b64 v[16:17], v77 offset:256
  v_xor_b32 v75, 0x8000, v75
  ds_read_b128 v[52:55], v76 offset:14848
  s_nop 3
  v_cvt_pk_bf16_f32 v28, v28, v29
  v_cvt_pk_bf16_f32 v29, v30, v31
  v_bfi_b32 v28, 1, s72, v28
  buffer_store_dwordx2 v[28:29], v68, s[8:11], s76 offen
  v_mov_b64 v[24:25], 0
  v_mov_b64 v[26:27], 0
  v_mov_b64 v[28:29], 0
  v_mov_b64 v[30:31], 0
  s_add_u32 s58, s58, 524288
  s_add_u32 s59, s59, 524288
  s_add_u32 s70, s70, 524288
  s_add_u32 s68, s68, 131072
  s_add_u32 s66, s66, 1
  s_xor_b32 s64, s64, 16384
  s_xor_b32 s65, s65, 16384
  s_nop 15
  s_nop 7
  buffer_load_dwordx4 v[0:3], v76, s[8:11], s60 offen offset:0 sc1
  buffer_load_dwordx4 v[4:7], v76, s[8:11], s60 offen offset:1024 sc1
  buffer_load_dwordx4 v[8:11], v76, s[8:11], s61 offen offset:0 sc1
  buffer_load_dwordx4 v[12:15], v76, s[8:11], s61 offen offset:1024 sc1
  s_nop 15
  s_nop 11
  buffer_load_dwordx4 v[44:47], v76, s[8:11], s60 offen offset:0 sc1
  buffer_load_dwordx4 v[48:51], v76, s[8:11], s60 offen offset:1024 sc1
  buffer_load_dwordx4 v[60:63], v76, s[8:11], s61 offen offset:0 sc1
  buffer_load_dwordx4 v[64:67], v76, s[8:11], s61 offen offset:1024 sc1
  s_waitcnt vmcnt(7) lgkmcnt(0)
  v_mfma_f32_16x16x32_bf16 v[56:59], v[52:55], v[0:3], 0
  v_bitop3_b32 v72, v0, v2, s72 bitop3:0x7e
  s_waitcnt vmcnt(6)
  v_mfma_f32_16x16x32_bf16 v[56:59], v[52:55], v[4:7], v[56:59]
  v_bitop3_b32 v73, v4, v6, s72 bitop3:0x7e
  v_or_b32 v72, v72, v73
  s_waitcnt vmcnt(5)
  v_mfma_f32_16x16x32_bf16 v[36:39], v[52:55], v[8:11], 0
  v_bitop3_b32 v73, v8, v10, s72 bitop3:0x7e
  v_or_b32 v72, v72, v73
  s_waitcnt vmcnt(4)
  v_mfma_f32_16x16x32_bf16 v[36:39], v[52:55], v[12:15], v[36:39]
  v_bitop3_b32 v73, v12, v14, s72 bitop3:0x7e
  v_bitop3_b32 v72, v72, v73, 1 bitop3:0xa8
  v_cmp_ne_u32 vcc, 0, v72
  s_cbranch_vccnz Cf0_h1r
Cf0_h1p:
  v_add_f32_dpp v56, v56, v56 row_ror:4 row_mask:0xf bank_mask:0xf
  v_add_f32_dpp v57, v57, v57 row_ror:4 row_mask:0xf bank_mask:0xf
  s_nop 0
  v_add_f32_dpp v56, v56, v56 row_ror:8 row_mask:0xf bank_mask:0xf
  v_add_f32_dpp v57, v57, v57 row_ror:8 row_mask:0xf bank_mask:0xf
  v_cvt_pk_bf16_f32 v56, v56, v57
  buffer_store_dword v56, v69, s[8:11], s62 offen
  v_add_f32_dpp v36, v36, v36 row_ror:4 row_mask:0xf bank_mask:0xf
  v_add_f32_dpp v37, v37, v37 row_ror:4 row_mask:0xf bank_mask:0xf
  s_nop 0
  v_add_f32_dpp v36, v36, v36 row_ror:8 row_mask:0xf bank_mask:0xf
  v_add_f32_dpp v37, v37, v37 row_ror:8 row_mask:0xf bank_mask:0xf
  v_cvt_pk_bf16_f32 v36, v36, v37
  buffer_store_dword v36, v70, s[8:11], s63 offen
Cf0_h1ok:
  s_xor_b32 s62, s62, 16384
  s_xor_b32 s63, s63, 16384
  s_xor_b32 s72, s72, 1
  s_nop 15
  s_nop 7
Cf0_h2:
  v_lshlrev_b32 v73, 2, v76
  buffer_load_dwordx4 v[52:55], v76, s[8:11], s64 offen offset:0 sc1
  buffer_load_dwordx4 v[56:59], v76, s[8:11], s64 offen offset:1024 sc1
  buffer_load_dwordx4 v[12:15], v76, s[8:11], s65 offen offset:0 sc1
  s_nop 15
  s_nop 1
  buffer_load_dwordx4 v[52:55], v76, s[8:11], s64 offen offset:0 sc1
  buffer_load_dwordx4 v[56:59], v76, s[8:11], s64 offen offset:1024 sc1
  buffer_load_dwordx4 v[12:15], v76, s[8:11], s65 offen offset:0 sc1
  s_nop 15
  s_nop 1
  buffer_load_dwordx4 v[52:55], v76, s[8:11], s64 offen offset:0 sc1
  buffer_load_dwordx4 v[56:59], v76, s[8:11], s64 offen offset:1024 sc1
  buffer_load_dwordx4 v[12:15], v76, s[8:11], s65 offen offset:0 sc1
  s_waitcnt vmcnt(11)
  ds_read_b128 v[60:63], v76 offset:16384
  ds_read_b128 v[64:67], v76 offset:17408
  ds_read_b128 v[44:47], v76 offset:18432
  ds_read_b128 v[48:51], v76 offset:19456
  ds_read_b128 v[36:39], v76 offset:32768
  ds_read_b128 v[40:43], v76 offset:33792
  s_waitcnt vmcnt(6)
  v_max3_u32 v72, v52, v53, v54
  v_max3_u32 v72, v72, v55, v56
  v_max3_u32 v72, v72, v57, v58
  v_max3_u32 v72, v72, v59, v12
  v_max3_u32 v72, v72, v13, v14
  v_max_u32 v72, v72, v15
  ds_write_b128 v76, v[52:55] offset:0
  ds_write_b128 v76, v[56:59] offset:1024
  ds_write_b128 v76, v[12:15] offset:8192
  v_cmp_eq_u32 vcc, -1, v72
  s_cbranch_vccnz Cf0_h2r
Cf0_h2w:
  buffer_store_dword v71, v69, s[8:11], s62 offen
  buffer_store_dword v71, v70, s[8:11], s63 offen
  s_branch Cf0_top
Cf0_rec:
  s_nop 7
  s_waitcnt vmcnt(0) lgkmcnt(0)
  v_max3_u32 v72, v0, v1, v2
  v_max3_u32 v72, v72, v3, v4
  v_max3_u32 v72, v72, v5, v6
  v_max3_u32 v72, v72, v7, v8
  v_max3_u32 v72, v72, v9, v10
  v_max3_u32 v72, v72, v11, v12
  v_max3_u32 v72, v72, v13, v14
  v_max3_u32 v72, v72, v15, v16
  v_max3_u32 v72, v72, v17, v18
  v_max_u32 v72, v72, v19
  v_cmp_eq_u32 vcc, -1, v72
  s_cbranch_vccz Cf0_recok
  s_barrier
  v_mov_b64 v[20:21], 0
  v_mov_b64 v[22:23], 0
  v_mov_b64 v[24:25], 0
  v_mov_b64 v[26:27], 0
  v_mov_b64 v[28:29], 0
  v_mov_b64 v[30:31], 0
  v_mov_b64 v[32:33], 0
  v_mov_b64 v[34:35], 0
  s_waitcnt lgkmcnt(0)
  s_barrier
  ds_read_b128 v[0:3], v76 offset:0
  ds_read_b128 v[60:63], v76 offset:16384
  ds_read_b128 v[64:67], v76 offset:17408
  s_waitcnt lgkmcnt(0)
  v_smfmac_f32_16x16x64_bf16 v[20:23], v[0:3], v[60:67], v74
  ds_read_b128 v[60:63], v76 offset:18432
  ds_read_b128 v[64:67], v76 offset:19456
  s_waitcnt lgkmcnt(0)
  v_smfmac_f32_16x16x64_bf16 v[24:27], v[0:3], v[60:67], v74
  ds_read_b128 v[60:63], v76 offset:32768
  ds_read_b128 v[64:67], v76 offset:33792
  s_waitcnt lgkmcnt(0)
  v_smfmac_f32_16x16x64_bf16 v[28:31], v[0:3], v[60:67], v74
  ds_read_b128 v[60:63], v76 offset:34816
  ds_read_b128 v[64:67], v76 offset:35840
  s_waitcnt lgkmcnt(0)
  v_smfmac_f32_16x16x64_bf16 v[32:35], v[0:3], v[60:67], v74
  ds_read_b128 v[4:7], v76 offset:1024
  s_waitcnt lgkmcnt(0)
  v_smfmac_f32_16x16x64_bf16 v[20:23], v[4:7], v[80:87], v74
  v_smfmac_f32_16x16x64_bf16 v[24:27], v[4:7], v[88:95], v74
  v_smfmac_f32_16x16x64_bf16 v[28:31], v[4:7], v[208:215], v74
  v_smfmac_f32_16x16x64_bf16 v[32:35], v[4:7], v[216:223], v74
  ds_read_b128 v[8:11], v76 offset:2048
  s_waitcnt lgkmcnt(0)
  v_smfmac_f32_16x16x64_bf16 v[20:23], v[8:11], v[96:103], v74
  v_smfmac_f32_16x16x64_bf16 v[24:27], v[8:11], v[104:111], v74
  ds_read_b128 v[60:63], v76 offset:49152
  ds_read_b128 v[64:67], v76 offset:50176
  s_waitcnt lgkmcnt(0)
  v_smfmac_f32_16x16x64_bf16 v[28:31], v[8:11], v[60:67], v74
  ds_read_b128 v[60:63], v76 offset:51200
  ds_read_b128 v[64:67], v76 offset:52224
  s_waitcnt lgkmcnt(0)
  v_smfmac_f32_16x16x64_bf16 v[32:35], v[8:11], v[60:67], v74
  ds_read_b128 v[12:15], v76 offset:3072
  s_waitcnt lgkmcnt(0)
  v_smfmac_f32_16x16x64_bf16 v[20:23], v[12:15], v[112:119], v74
  v_smfmac_f32_16x16x64_bf16 v[24:27], v[12:15], v[120:127], v74
  v_smfmac_f32_16x16x64_bf16 v[28:31], v[12:15], v[224:231], v74
  v_smfmac_f32_16x16x64_bf16 v[32:35], v[12:15], v[232:239], v74
  ds_read_b128 v[4:7], v76 offset:4096
  s_waitcnt lgkmcnt(0)
  v_smfmac_f32_16x16x64_bf16 v[20:23], v[4:7], v[128:135], v74
  v_smfmac_f32_16x16x64_bf16 v[24:27], v[4:7], v[136:143], v74
  ds_read_b128 v[60:63], v75 offset:16384
  ds_read_b128 v[64:67], v75 offset:17408
  s_waitcnt lgkmcnt(0)
  v_smfmac_f32_16x16x64_bf16 v[28:31], v[4:7], v[60:67], v74
  ds_read_b128 v[60:63], v75 offset:18432
  ds_read_b128 v[64:67], v75 offset:19456
  s_waitcnt lgkmcnt(0)
  v_smfmac_f32_16x16x64_bf16 v[32:35], v[4:7], v[60:67], v74
  ds_read_b128 v[16:19], v76 offset:5120
  s_waitcnt lgkmcnt(0)
  v_smfmac_f32_16x16x64_bf16 v[20:23], v[16:19], v[144:151], v74
  v_smfmac_f32_16x16x64_bf16 v[24:27], v[16:19], v[152:159], v74
  v_smfmac_f32_16x16x64_bf16 v[28:31], v[16:19], v[240:247], v74
  v_smfmac_f32_16x16x64_bf16 v[32:35], v[16:19], v[248:255], v74
  ds_read_b128 v[12:15], v76 offset:6144
  s_waitcnt lgkmcnt(0)
  v_smfmac_f32_16x16x64_bf16 v[20:23], v[12:15], v[160:167], v74
  v_smfmac_f32_16x16x64_bf16 v[24:27], v[12:15], v[168:175], v74
  v_smfmac_f32_16x16x64_bf16 v[28:31], v[12:15], a[0:7], v74
  v_smfmac_f32_16x16x64_bf16 v[32:35], v[12:15], a[8:15], v74
  ds_read_b128 v[8:11], v76 offset:7168
  s_waitcnt lgkmcnt(0)
  v_smfmac_f32_16x16x64_bf16 v[20:23], v[8:11], v[176:183], v74
  v_smfmac_f32_16x16x64_bf16 v[24:27], v[8:11], v[184:191], v74
  v_smfmac_f32_16x16x64_bf16 v[28:31], v[8:11], a[16:23], v74
  v_smfmac_f32_16x16x64_bf16 v[32:35], v[8:11], a[24:31], v74
  ds_read_b128 v[0:3], v76 offset:8192
  s_waitcnt lgkmcnt(0)
  v_smfmac_f32_16x16x64_bf16 v[20:23], v[0:3], v[192:199], v74
  v_smfmac_f32_16x16x64_bf16 v[24:27], v[0:3], v[200:207], v74
  ds_read_b128 v[60:63], v75 offset:0
  ds_read_b128 v[64:67], v75 offset:1024
  s_waitcnt lgkmcnt(0)
  v_smfmac_f32_16x16x64_bf16 v[28:31], v[0:3], v[60:67], v74
  ds_read_b128 v[60:63], v75 offset:2048
  ds_read_b128 v[64:67], v75 offset:3072
  s_waitcnt lgkmcnt(0)
  v_smfmac_f32_16x16x64_bf16 v[32:35], v[0:3], v[60:67], v74
  v_add_f32 v20, v20, v22
  v_add_f32 v21, v21, v23
  v_add_f32 v24, v24, v26
  v_cvt_pk_bf16_f32 v22, v20, v24
  ds_write_b32 v79, v22 offset:0
  v_add_f32 v25, v25, v27
  v_cvt_pk_bf16_f32 v23, v21, v25
  ds_write_b32 v79, v23 offset:576
  v_add_f32 v28, v28, v30
  v_add_f32 v29, v29, v31
  s_waitcnt lgkmcnt(0)
  s_nop 1
  s_branch Cf0_recok
Cf0_h1r:
  s_mov_b64 exec, vcc
  buffer_load_dwordx4 v[0:3], v76, s[8:11], s60 offen offset:0 sc1
  buffer_load_dwordx4 v[4:7], v76, s[8:11], s60 offen offset:1024 sc1
  buffer_load_dwordx4 v[8:11], v76, s[8:11], s61 offen offset:0 sc1
  buffer_load_dwordx4 v[12:15], v76, s[8:11], s61 offen offset:1024 sc1
  s_mov_b64 exec, -1
  s_add_u32 s67, s67, 1
  s_waitcnt vmcnt(7)
  v_mfma_f32_16x16x32_bf16 v[56:59], v[52:55], v[44:47], 0
  v_bitop3_b32 v72, v44, v46, s72 bitop3:0x7e
  s_waitcnt vmcnt(6)
  v_mfma_f32_16x16x32_bf16 v[56:59], v[52:55], v[48:51], v[56:59]
  v_bitop3_b32 v73, v48, v50, s72 bitop3:0x7e
  v_or_b32 v72, v72, v73
  s_waitcnt vmcnt(5)
  v_mfma_f32_16x16x32_bf16 v[36:39], v[52:55], v[60:63], 0
  v_bitop3_b32 v73, v60, v62, s72 bitop3:0x7e
  v_or_b32 v72, v72, v73
  s_waitcnt vmcnt(4)
  v_mfma_f32_16x16x32_bf16 v[36:39], v[52:55], v[64:67], v[36:39]
  v_bitop3_b32 v73, v64, v66, s72 bitop3:0x7e
  v_bitop3_b32 v72, v72, v73, 1 bitop3:0xa8
  v_cmp_ne_u32 vcc, 0, v72
  s_cbranch_vccz Cf0_h1p
  s_mov_b64 exec, vcc
  buffer_load_dwordx4 v[44:47], v76, s[8:11], s60 offen offset:0 sc1
  buffer_load_dwordx4 v[48:51], v76, s[8:11], s60 offen offset:1024 sc1
  buffer_load_dwordx4 v[60:63], v76, s[8:11], s61 offen offset:0 sc1
  buffer_load_dwordx4 v[64:67], v76, s[8:11], s61 offen offset:1024 sc1
  s_mov_b64 exec, -1
  s_add_u32 s67, s67, 1
  s_waitcnt vmcnt(7)
  v_mfma_f32_16x16x32_bf16 v[56:59], v[52:55], v[0:3], 0
  v_bitop3_b32 v72, v0, v2, s72 bitop3:0x7e
  s_waitcnt vmcnt(6)
  v_mfma_f32_16x16x32_bf16 v[56:59], v[52:55], v[4:7], v[56:59]
  v_bitop3_b32 v73, v4, v6, s72 bitop3:0x7e
  v_or_b32 v72, v72, v73
  s_waitcnt vmcnt(5)
  v_mfma_f32_16x16x32_bf16 v[36:39], v[52:55], v[8:11], 0
  v_bitop3_b32 v73, v8, v10, s72 bitop3:0x7e
  v_or_b32 v72, v72, v73
  s_waitcnt vmcnt(4)
  v_mfma_f32_16x16x32_bf16 v[36:39], v[52:55], v[12:15], v[36:39]
  v_bitop3_b32 v73, v12, v14, s72 bitop3:0x7e
  v_bitop3_b32 v72, v72, v73, 1 bitop3:0xa8
  v_cmp_ne_u32 vcc, 0, v72
  s_cbranch_vccz Cf0_h1p
  s_cmp_lt_u32 s67, 131072
  s_cbranch_scc1 Cf0_h1r
  s_branch Cf0_h1p
Cf0_h2r:
Cf0_h2s:
  s_mov_b64 exec, vcc
  buffer_load_dwordx4 v[52:55], v76, s[8:11], s64 offen offset:0 sc1
  buffer_load_dwordx4 v[56:59], v76, s[8:11], s64 offen offset:1024 sc1
  buffer_load_dwordx4 v[12:15], v76, s[8:11], s65 offen offset:0 sc1
  s_mov_b64 exec, -1
  s_add_u32 s67, s67, 1
  s_waitcnt vmcnt(6)
  v_max3_u32 v72, v52, v53, v54
  v_max3_u32 v72, v72, v55, v56
  v_max3_u32 v72, v72, v57, v58
  v_max3_u32 v72, v72, v59, v12
  v_max3_u32 v72, v72, v13, v14
  v_max_u32 v72, v72, v15
  v_cmp_eq_u32 vcc, -1, v72
  s_cbranch_vccz Cf0_h2ok
  s_mov_b64 exec, vcc
  buffer_load_dwordx4 v[52:55], v76, s[8:11], s64 offen offset:0 sc1
  buffer_load_dwordx4 v[56:59], v76, s[8:11], s64 offen offset:1024 sc1
  buffer_load_dwordx4 v[12:15], v76, s[8:11], s65 offen offset:0 sc1
  s_mov_b64 exec, -1
  s_add_u32 s67, s67, 1
  s_waitcnt vmcnt(6)
  v_max3_u32 v72, v52, v53, v54
  v_max3_u32 v72, v72, v55, v56
  v_max3_u32 v72, v72, v57, v58
  v_max3_u32 v72, v72, v59, v12
  v_max3_u32 v72, v72, v13, v14
  v_max_u32 v72, v72, v15
  v_cmp_eq_u32 vcc, -1, v72
  s_cbranch_vccz Cf0_h2ok
  s_mov_b64 exec, vcc
  buffer_load_dwordx4 v[52:55], v76, s[8:11], s64 offen offset:0 sc1
  buffer_load_dwordx4 v[56:59], v76, s[8:11], s64 offen offset:1024 sc1
  buffer_load_dwordx4 v[12:15], v76, s[8:11], s65 offen offset:0 sc1
  s_mov_b64 exec, -1
  s_add_u32 s67, s67, 1
  s_waitcnt vmcnt(6)
  v_max3_u32 v72, v52, v53, v54
  v_max3_u32 v72, v72, v55, v56
  v_max3_u32 v72, v72, v57, v58
  v_max3_u32 v72, v72, v59, v12
  v_max3_u32 v72, v72, v13, v14
  v_max_u32 v72, v72, v15
  v_cmp_eq_u32 vcc, -1, v72
  s_cbranch_vccz Cf0_h2ok
  s_mov_b64 exec, vcc
  buffer_load_dwordx4 v[52:55], v76, s[8:11], s64 offen offset:0 sc1
  buffer_load_dwordx4 v[56:59], v76, s[8:11], s64 offen offset:1024 sc1
  buffer_load_dwordx4 v[12:15], v76, s[8:11], s65 offen offset:0 sc1
  s_mov_b64 exec, -1
  s_add_u32 s67, s67, 1
  s_waitcnt vmcnt(6)
  v_max3_u32 v72, v52, v53, v54
  v_max3_u32 v72, v72, v55, v56
  v_max3_u32 v72, v72, v57, v58
  v_max3_u32 v72, v72, v59, v12
  v_max3_u32 v72, v72, v13, v14
  v_max_u32 v72, v72, v15
  v_cmp_eq_u32 vcc, -1, v72
  s_cbranch_vccz Cf0_h2ok
  s_cmp_lt_u32 s67, 131072
  s_cbranch_scc1 Cf0_h2s
Cf0_h2ok:
  ds_write_b128 v76, v[52:55] offset:0
  ds_write_b128 v76, v[56:59] offset:1024
  ds_write_b128 v76, v[12:15] offset:8192
  s_branch Cf0_h2w
Cf0_last:
  s_waitcnt vmcnt(0) lgkmcnt(0)
  ds_read_b64 v[16:17], v77 offset:256
  v_mov_b64 v[18:19], v[72:73]
  s_add_u32 s68, s68, 131072
  s_waitcnt lgkmcnt(0)
  buffer_store_dwordx4 v[16:19], v76, s[8:11], s68 offen sc1
  s_waitcnt vmcnt(0)
  s_barrier
  s_branch L_cexit
L_w1:
  v_mov_b64 v[20:21], 0
  v_mov_b64 v[22:23], 0
  v_mov_b64 v[24:25], 0
  v_mov_b64 v[26:27], 0
  v_mov_b64 v[28:29], 0
  v_mov_b64 v[30:31], 0
  v_mov_b64 v[32:33], 0
  v_mov_b64 v[34:35], 0
  s_mov_b32 m0, 15872
  s_branch Cf1_h2
.p2align 6
Cf1_top:
  s_waitcnt lgkmcnt(0)
  s_barrier
  ds_read_b128 v[0:3], v76 offset:0
  ds_read_b128 v[4:7], v76 offset:1024
  s_waitcnt lgkmcnt(1)
  v_smfmac_f32_16x16x64_bf16 v[20:23], v[0:3], v[60:67], v74
  ds_read_b128 v[60:63], v76 offset:38912
  v_smfmac_f32_16x16x64_bf16 v[24:27], v[0:3], v[44:51], v74
  ds_read_b128 v[64:67], v76 offset:39936
  s_waitcnt lgkmcnt(2)
  v_smfmac_f32_16x16x64_bf16 v[20:23], v[4:7], v[80:87], v74
  buffer_load_dwordx4 v[44:47], v76, s[8:11], s58 offen offset:0 sc1
  ds_read_b128 v[8:11], v76 offset:2048
  v_smfmac_f32_16x16x64_bf16 v[28:31], v[0:3], v[36:43], v74
  ds_read_b128 v[36:39], v76 offset:53248
  v_smfmac_f32_16x16x64_bf16 v[24:27], v[4:7], v[88:95], v74
  buffer_load_dwordx4 v[48:51], v76, s[8:11], s58 offen offset:1024 sc1
  ds_read_b128 v[40:43], v76 offset:54272
  v_smfmac_f32_16x16x64_bf16 v[28:31], v[4:7], v[208:215], v74
  ds_read_b128 v[12:15], v76 offset:3072
  v_smfmac_f32_16x16x64_bf16 v[32:35], v[4:7], v[216:223], v74
  buffer_load_dwordx4 v[52:55], v76, s[8:11], s59 offen offset:0 sc1
  s_waitcnt lgkmcnt(4)
  v_smfmac_f32_16x16x64_bf16 v[32:35], v[0:3], v[60:67], v74
  ds_read_b128 v[60:63], v76 offset:55296
  s_waitcnt lgkmcnt(4)
  v_smfmac_f32_16x16x64_bf16 v[20:23], v[8:11], v[96:103], v74
  buffer_load_dwordx4 v[56:59], v76, s[8:11], s59 offen offset:1024 sc1
  ds_read_b128 v[64:67], v76 offset:56320
  v_smfmac_f32_16x16x64_bf16 v[24:27], v[8:11], v[104:111], v74
  ds_read_b128 v[0:3], v76 offset:8192
  s_waitcnt lgkmcnt(4)
  v_smfmac_f32_16x16x64_bf16 v[28:31], v[8:11], v[36:43], v74
  ds_read_b128 v[36:39], v75 offset:4096
  s_waitcnt lgkmcnt(4)
  v_smfmac_f32_16x16x64_bf16 v[20:23], v[12:15], v[112:119], v74
  buffer_store_dwordx4 v[16:19], v76, s[8:11], s68 offen sc1
  ds_read_b128 v[40:43], v75 offset:5120
  v_smfmac_f32_16x16x64_bf16 v[24:27], v[12:15], v[120:127], v74
  buffer_load_dword v73, s[8:11], s70 offen lds
  s_waitcnt lgkmcnt(3)
  v_smfmac_f32_16x16x64_bf16 v[32:35], v[8:11], v[60:67], v74
  ds_read_b128 v[60:63], v75 offset:6144
  v_smfmac_f32_16x16x64_bf16 v[28:31], v[12:15], v[224:231], v74
  ds_read_b128 v[64:67], v75 offset:7168
  v_smfmac_f32_16x16x64_bf16 v[32:35], v[12:15], v[232:239], v74
  s_barrier
  s_waitcnt lgkmcnt(4)
  v_smfmac_f32_16x16x64_bf16 v[20:23], v[0:3], v[192:199], v74
  ds_read_b128 v[4:7], v76 offset:4096
  s_waitcnt lgkmcnt(3)
  v_smfmac_f32_16x16x64_bf16 v[28:31], v[0:3], v[36:43], v74
  ds_read_b128 v[16:19], v76 offset:5120
  v_smfmac_f32_16x16x64_bf16 v[24:27], v[0:3], v[200:207], v74
  ds_read_b128 v[36:39], v75 offset:20480
  s_waitcnt lgkmcnt(3)
  v_mov_b32 v68, 0x3f803f80
  v_smfmac_f32_16x16x64_bf16 v[32:35], v[0:3], v[60:67], v74
  ds_read_b128 v[40:43], v75 offset:21504
  s_waitcnt lgkmcnt(3)
  v_smfmac_f32_16x16x64_bf16 v[20:23], v[4:7], v[128:135], v74
  ds_read_b128 v[12:15], v76 offset:6144
  v_mov_b32 v69, 0x3f803f80
  v_smfmac_f32_16x16x64_bf16 v[24:27], v[4:7], v[136:143], v74
  ds_read_b128 v[8:11], v76 offset:7168
  s_waitcnt lgkmcnt(4)
  v_smfmac_f32_16x16x64_bf16 v[20:23], v[16:19], v[144:151], v74
  ds_read_b128 v[60:63], v75 offset:22528
  v_mov_b64 v[70:71], v[68:69]
  v_smfmac_f32_16x16x64_bf16 v[24:27], v[16:19], v[152:159], v74
  ds_read_b128 v[64:67], v75 offset:23552
  s_waitcnt lgkmcnt(4)
  v_smfmac_f32_16x16x64_bf16 v[28:31], v[4:7], v[36:43], v74
  s_waitcnt lgkmcnt(3)
  v_mov_b64 v[36:37], 0
  v_smfmac_f32_16x16x64_bf16 v[20:23], v[12:15], v[160:167], v74
  s_waitcnt lgkmcnt(2)
  v_mov_b64 v[38:39], 0
  v_smfmac_f32_16x16x64_bf16 v[20:23], v[8:11], v[176:183], v74
  v_mov_b64 v[40:41], 0
  v_smfmac_f32_16x16x64_bf16 v[24:27], v[12:15], v[168:175], v74
  v_mov_b64 v[42:43], 0
  v_smfmac_f32_16x16x64_bf16 v[24:27], v[8:11], v[184:191], v74
  s_waitcnt lgkmcnt(0)
  v_add_f32 v20, v20, v22
  v_smfmac_f32_16x16x64_bf16 v[32:35], v[4:7], v[60:67], v74
  v_add_f32 v21, v21, v23
  v_smfmac_f32_16x16x64_bf16 v[28:31], v[16:19], v[240:247], v74
  v_add_f32 v24, v24, v26
  v_cvt_pk_bf16_f32 v22, v20, v24
  v_smfmac_f32_16x16x64_bf16 v[28:31], v[12:15], a[0:7], v74
  ds_write_b32 v79, v22 offset:0
  v_add_f32 v25, v25, v27
  v_cvt_pk_bf16_f32 v23, v21, v25
  v_smfmac_f32_16x16x64_bf16 v[28:31], v[8:11], a[16:23], v74
  ds_write_b32 v79, v23 offset:576
  v_cmp_u_f32 vcc, v20, v21
  v_smfmac_f32_16x16x64_bf16 v[32:35], v[16:19], v[248:255], v74
  s_mov_b64 exec, 1
  buffer_store_dword v72, v76, s[8:11], s71 offen sc1
  s_mov_b64 exec, -1
  v_smfmac_f32_16x16x64_bf16 v[32:35], v[12:15], a[8:15], v74
  v_add_f32 v28, v28, v30
  v_add_f32 v29, v29, v31
  v_smfmac_f32_16x16x64_bf16 v[32:35], v[8:11], a[24:31], v74
  s_cbranch_vccnz Cf1_rec
Cf1_recok:
  v_smfmac_f32_16x16x64_bf16 v[36:39], v[16:19], a[112:119], v74
  s_waitcnt lgkmcnt(0)
  s_barrier
  ds_read_b128 v[60:63], v77
  v_smfmac_f32_16x16x64_bf16 v[40:43], v[16:19], a[120:127], v74
  ds_read_b128 v[64:67], v77 offset:128
  v_add_f32 v32, v32, v34
  v_cvt_pk_bf16_f32 v30, v28, v32
  v_smfmac_f32_16x16x64_bf16 v[36:39], v[0:3], a[160:167], v74
  ds_write_b32 v79, v30 offset:256
  v_add_f32 v33, v33, v35
  v_cvt_pk_bf16_f32 v31, v29, v33
  v_smfmac_f32_16x16x64_bf16 v[40:43], v[0:3], a[168:175], v74
  ds_write_b32 v79, v31 offset:832
  v_xor_b32 v75, 0x8000, v75
  v_smfmac_f32_16x16x64_bf16 v[36:39], v[4:7], a[96:103], v74
  ds_read_b128 v[0:3], v76 offset:0
  v_mov_b32 v29, 0
  v_smfmac_f32_16x16x64_bf16 v[40:43], v[4:7], a[104:111], v74
  s_waitcnt vmcnt(5) lgkmcnt(3)
  v_mov_b32 v30, 0
  v_mfma_f32_16x16x32_bf16 v[44:47], v[44:47], v[60:63], 0
  ds_read_b128 v[4:7], v76 offset:1024
  s_waitcnt lgkmcnt(2)
  v_mfma_f32_16x16x32_bf16 v[44:47], v[48:51], v[64:67], v[44:47]
  s_barrier
  v_smfmac_f32_16x16x64_bf16 v[36:39], v[8:11], a[144:151], v74
  ds_read_b128 v[20:23], v77 offset:256
  ds_read_b128 v[24:27], v77 offset:384
  v_smfmac_f32_16x16x64_bf16 v[40:43], v[8:11], a[152:159], v74
  ds_read_b128 v[8:11], v76 offset:2048
  v_add_f32_dpp v72, v46, v44 quad_perm:[2,3,0,1] row_mask:0xf bank_mask:0xf
  v_add_f32_dpp v73, v47, v45 quad_perm:[2,3,0,1] row_mask:0xf bank_mask:0xf
  v_smfmac_f32_16x16x64_bf16 v[36:39], v[12:15], a[128:135], v74
  ds_read_b128 v[44:47], v75 offset:4096
  v_exp_f32_dpp v72, v72 quad_perm:[0,1,0,1] row_mask:0xf bank_mask:0xf
  v_smfmac_f32_16x16x64_bf16 v[40:43], v[12:15], a[136:143], v74
  ds_read_b128 v[12:15], v76 offset:3072
  s_waitcnt lgkmcnt(6)
  v_exp_f32_dpp v73, v73 quad_perm:[0,1,0,1] row_mask:0xf bank_mask:0xf
  v_smfmac_f32_16x16x64_bf16 v[36:39], v[0:3], a[32:39], v74
  s_waitcnt lgkmcnt(3)
  v_cvt_pk_bf16_f32 v72, v72, v73
  v_mfma_f32_16x16x32_bf16 v[20:23], v[20:23], v[60:63], 0
  ds_write_b32 v78, v72 offset:516
  v_mfma_f32_16x16x32_bf16 v[20:23], v[24:27], v[64:67], v[20:23]
  ds_read_b128 v[48:51], v75 offset:5120
  v_smfmac_f32_16x16x64_bf16 v[40:43], v[0:3], a[40:47], v74
  ds_read_b128 v[60:63], v75 offset:6144
  v_smfmac_f32_16x16x64_bf16 v[36:39], v[4:7], a[48:55], v74
  s_waitcnt lgkmcnt(5)
  v_add_f32_dpp v24, v22, v20 quad_perm:[2,3,0,1] row_mask:0xf bank_mask:0xf
  v_add_f32_dpp v25, v23, v21 quad_perm:[2,3,0,1] row_mask:0xf bank_mask:0xf
  v_smfmac_f32_16x16x64_bf16 v[36:39], v[8:11], a[64:71], v74
  s_waitcnt lgkmcnt(2)
  s_barrier
  ds_read_b128 v[32:35], v78 offset:512
  v_smfmac_f32_16x16x64_bf16 v[36:39], v[12:15], a[80:87], v74
  ds_read_b128 v[64:67], v75 offset:7168
  v_mul_f32 v24, s69, v24
  v_smfmac_f32_16x16x64_bf16 v[40:43], v[4:7], a[56:63], v74
  v_mul_f32 v25, s69, v25
  v_smfmac_f32_16x16x64_bf16 v[40:43], v[8:11], a[72:79], v74
  v_exp_f32_dpp v24, v24 quad_perm:[0,1,0,1] row_mask:0xf bank_mask:0xf
  v_smfmac_f32_16x16x64_bf16 v[40:43], v[12:15], a[88:95], v74
  s_waitcnt vmcnt(3) lgkmcnt(1)
  v_exp_f32_dpp v25, v25 quad_perm:[0,1,0,1] row_mask:0xf bank_mask:0xf
  v_mfma_f32_16x16x32_bf16 v[8:11], v[32:35], v[68:71], 0
  v_add_f32 v36, v36, v38
  v_add_f32 v37, v37, v39
  v_mfma_f32_16x16x32_bf16 v[0:3], v[32:35], v[52:55], 0
  v_add_f32 v40, v40, v42
  v_add_f32 v41, v41, v43
  v_mfma_f32_16x16x32_bf16 v[4:7], v[32:35], v[56:59], 0
  v_cvt_pk_bf16_f32 v28, v24, v25
  v_cvt_pk_bf16_f32 v72, v36, v37
  v_cvt_pk_bf16_f32 v73, v40, v41
  v_mfma_f32_16x16x16_bf16 v[8:11], v[28:29], v[68:69], v[8:11]
  v_cvt_pk_bf16_f32 v31, v24, v25
  v_mfma_f32_16x16x16_bf16 v[0:3], v[28:29], v[72:73], v[0:3]
  ds_read_b128 v[68:71], v76 offset:13824
  v_mfma_f32_16x16x16_bf16 v[4:7], v[30:31], v[72:73], v[4:7]
  v_rcp_f32 v10, v8
  v_rcp_f32 v11, v9
  v_mul_f32 v0, v10, v0
  v_mul_f32 v1, v11, v1
  s_nop 0
  v_mul_f32 v4, v10, v4
  v_mul_f32 v5, v11, v5
  v_cvt_pk_bf16_f32 v2, v0, v4
  ds_write_b32 v79, v2 offset:0
  v_cvt_pk_bf16_f32 v3, v1, v5
  ds_write_b32 v79, v3 offset:576
  v_mov_b64 v[16:17], 0
  v_mov_b64 v[18:19], 0
  v_mov_b64 v[20:21], 0
  v_mov_b64 v[22:23], 0
  v_mov_b64 v[24:25], 0
  v_mov_b64 v[26:27], 0
  v_mov_b64 v[28:29], 0
  v_mov_b64 v[30:31], 0
  v_mov_b64 v[32:33], 0
  v_mov_b64 v[34:35], 0
  s_waitcnt lgkmcnt(0)
  s_barrier
  ds_read_b128 v[0:3], v78 offset:0
  ds_read_b128 v[4:7], v78 offset:64
  ds_read_b128 v[8:11], v78 offset:128
  ds_read_b128 v[12:15], v78 offset:192
  s_cmp_eq_u32 s66, 63
  s_cbranch_scc1 Cf1_last
  s_waitcnt lgkmcnt(3)
  v_smfmac_f32_16x16x64_bf16 v[16:19], v[0:3], a[176:183], v74
  s_waitcnt lgkmcnt(2)
  v_smfmac_f32_16x16x64_bf16 v[16:19], v[4:7], a[184:191], v74
  s_waitcnt lgkmcnt(1)
  v_smfmac_f32_16x16x64_bf16 v[16:19], v[8:11], a[192:199], v74
  ds_read_b128 v[52:55], v75 offset:20480
  s_waitcnt lgkmcnt(1)
  v_smfmac_f32_16x16x64_bf16 v[16:19], v[12:15], a[200:207], v74
  ds_read_b128 v[56:59], v75 offset:21504
  v_smfmac_f32_16x16x64_bf16 v[20:23], v[0:3], a[208:215], v74
  ds_read_b128 v[36:39], v75 offset:22528
  v_smfmac_f32_16x16x64_bf16 v[20:23], v[4:7], a[216:223], v74
  ds_read_b128 v[40:43], v75 offset:23552
  v_cvt_pk_bf16_f32 v16, v16, v17
  v_cvt_pk_bf16_f32 v17, v18, v19
  v_bfi_b32 v16, 1, s72, v16
  v_smfmac_f32_16x16x64_bf16 v[20:23], v[8:11], v[44:51], v74
  ds_read_b128 v[44:47], v75 offset:36864
  buffer_store_dwordx2 v[16:17], v68, s[8:11], s73 offen
  v_smfmac_f32_16x16x64_bf16 v[20:23], v[12:15], v[60:67], v74
  ds_read_b128 v[48:51], v75 offset:37888
  v_smfmac_f32_16x16x64_bf16 v[24:27], v[0:3], a[224:231], v74
  ds_read_b128 v[60:63], v75 offset:38912
  v_smfmac_f32_16x16x64_bf16 v[24:27], v[4:7], a[232:239], v74
  ds_read_b128 v[64:67], v75 offset:39936
  s_waitcnt lgkmcnt(6)
  v_cvt_pk_bf16_f32 v20, v20, v21
  v_cvt_pk_bf16_f32 v21, v22, v23
  v_bfi_b32 v20, 1, s72, v20
  v_smfmac_f32_16x16x64_bf16 v[24:27], v[8:11], v[52:59], v74
  buffer_store_dwordx2 v[20:21], v68, s[8:11], s74 offen
  s_waitcnt lgkmcnt(4)
  v_mov_b64 v[18:19], v[72:73]
  v_smfmac_f32_16x16x64_bf16 v[24:27], v[12:15], v[36:43], v74
  v_mov_b64 v[20:21], 0
  v_smfmac_f32_16x16x64_bf16 v[28:31], v[0:3], a[240:247], v74
  v_mov_b64 v[22:23], 0
  v_smfmac_f32_16x16x64_bf16 v[28:31], v[4:7], a[248:255], v74
  s_waitcnt lgkmcnt(2)
  v_cvt_pk_bf16_f32 v24, v24, v25
  v_cvt_pk_bf16_f32 v25, v26, v27
  v_bfi_b32 v24, 1, s72, v24
  v_smfmac_f32_16x16x64_bf16 v[28:31], v[8:11], v[44:51], v74
  buffer_store_dwordx2 v[24:25], v68, s[8:11], s75 offen
  s_waitcnt lgkmcnt(0)
  v_smfmac_f32_16x16x64_bf16 v[28:31], v[12:15], v[60:67], v74
  ds_read_b64 v[16:17], v77 offset:264
  v_xor_b32 v75, 0x8000, v75
  ds_read_b128 v[0:3], v76 offset:14848
  s_nop 3
  v_cvt_pk_bf16_f32 v28, v28, v29
  v_cvt_pk_bf16_f32 v29, v30, v31
  v_bfi_b32 v28, 1, s72, v28
  buffer_store_dwordx2 v[28:29], v68, s[8:11], s76 offen
  v_mov_b64 v[24:25], 0
  v_mov_b64 v[26:27], 0
  v_mov_b64 v[28:29], 0
  v_mov_b64 v[30:31], 0
  s_add_u32 s58, s58, 524288
  s_add_u32 s59, s59, 524288
  s_add_u32 s70, s70, 524288
  s_add_u32 s68, s68, 131072
  s_add_u32 s66, s66, 1
  s_xor_b32 s64, s64, 16384
  s_xor_b32 s65, s65, 16384
  s_nop 15
  s_nop 15
  s_nop 7
  buffer_load_dwordx4 v[52:55], v76, s[8:11], s60 offen offset:0 sc1
  buffer_load_dwordx4 v[56:59], v76, s[8:11], s60 offen offset:1024 sc1
  s_nop 15
  s_nop 11
  buffer_load_dwordx4 v[36:39], v76, s[8:11], s60 offen offset:0 sc1
  buffer_load_dwordx4 v[40:43], v76, s[8:11], s60 offen offset:1024 sc1
  s_waitcnt vmcnt(3) lgkmcnt(0)
  v_mfma_f32_16x16x32_bf16 v[4:7], v[0:3], v[52:55], 0
  v_bitop3_b32 v72, v52, v54, s72 bitop3:0x7e
  s_waitcnt vmcnt(2)
  v_mfma_f32_16x16x32_bf16 v[4:7], v[0:3], v[56:59], v[4:7]
  v_bitop3_b32 v73, v56, v58, s72 bitop3:0x7e
  v_bitop3_b32 v72, v72, v73, 1 bitop3:0xa8
  v_cmp_ne_u32 vcc, 0, v72
  s_cbranch_vccnz Cf1_h1r
Cf1_h1p:
  s_nop 2
  v_add_f32_dpp v4, v4, v4 row_ror:4 row_mask:0xf bank_mask:0xf
  v_add_f32_dpp v5, v5, v5 row_ror:4 row_mask:0xf bank_mask:0xf
  s_nop 0
  v_add_f32_dpp v4, v4, v4 row_ror:8 row_mask:0xf bank_mask:0xf
  v_add_f32_dpp v5, v5, v5 row_ror:8 row_mask:0xf bank_mask:0xf
  v_cvt_pk_bf16_f32 v4, v4, v5
  buffer_store_dword v4, v69, s[8:11], s62 offen
Cf1_h1ok:
  s_xor_b32 s62, s62, 16384
  s_xor_b32 s72, s72, 1
  s_nop 15
  s_nop 7
Cf1_h2:
  v_lshlrev_b32 v73, 2, v76
  buffer_load_dwordx4 v[52:55], v76, s[8:11], s64 offen offset:0 sc1
  buffer_load_dwordx4 v[56:59], v76, s[8:11], s64 offen offset:1024 sc1
  s_nop 15
  s_nop 1
  buffer_load_dwordx4 v[52:55], v76, s[8:11], s64 offen offset:0 sc1
  buffer_load_dwordx4 v[56:59], v76, s[8:11], s64 offen offset:1024 sc1
  s_nop 15
  s_nop 1
  buffer_load_dwordx4 v[52:55], v76, s[8:11], s64 offen offset:0 sc1
  buffer_load_dwordx4 v[56:59], v76, s[8:11], s64 offen offset:1024 sc1
  s_waitcnt vmcnt(7)
  ds_read_b128 v[60:63], v76 offset:20480
  ds_read_b128 v[64:67], v76 offset:21504
  ds_read_b128 v[44:47], v76 offset:22528
  ds_read_b128 v[48:51], v76 offset:23552
  ds_read_b128 v[36:39], v76 offset:36864
  ds_read_b128 v[40:43], v76 offset:37888
  s_waitcnt vmcnt(4)
  v_max3_u32 v72, v52, v53, v54
  v_max3_u32 v72, v72, v55, v56
  v_max3_u32 v72, v72, v57, v58
  v_max_u32 v72, v72, v59
  ds_write_b128 v76, v[52:55] offset:2048
  ds_write_b128 v76, v[56:59] offset:3072
  v_cmp_eq_u32 vcc, -1, v72
  s_cbranch_vccnz Cf1_h2r
Cf1_h2w:
  buffer_store_dword v71, v69, s[8:11], s62 offen
  v_mov_b32 v72, s66
  s_branch Cf1_top
Cf1_rec:
  s_nop 7
  s_waitcnt vmcnt(0) lgkmcnt(0)
  v_max3_u32 v72, v0, v1, v2
  v_max3_u32 v72, v72, v3, v4
  v_max3_u32 v72, v72, v5, v6
  v_max3_u32 v72, v72, v7, v8
  v_max3_u32 v72, v72, v9, v10
  v_max3_u32 v72, v72, v11, v12
  v_max3_u32 v72, v72, v13, v14
  v_max3_u32 v72, v72, v15, v16
  v_max3_u32 v72, v72, v17, v18
  v_max_u32 v72, v72, v19
  v_cmp_eq_u32 vcc, -1, v72
  s_cbranch_vccz Cf1_recok
  s_barrier
  v_mov_b64 v[20:21], 0
  v_mov_b64 v[22:23], 0
  v_mov_b64 v[24:25], 0
  v_mov_b64 v[26:27], 0
  v_mov_b64 v[28:29], 0
  v_mov_b64 v[30:31], 0
  v_mov_b64 v[32:33], 0
  v_mov_b64 v[34:35], 0
  s_waitcnt lgkmcnt(0)
  s_barrier
  ds_read_b128 v[0:3], v76 offset:0
  ds_read_b128 v[60:63], v76 offset:20480
  ds_read_b128 v[64:67], v76 offset:21504
  s_waitcnt lgkmcnt(0)
  v_smfmac_f32_16x16x64_bf16 v[20:23], v[0:3], v[60:67], v74
  ds_read_b128 v[60:63], v76 offset:22528
  ds_read_b128 v[64:67], v76 offset:23552
  s_waitcnt lgkmcnt(0)
  v_smfmac_f32_16x16x64_bf16 v[24:27], v[0:3], v[60:67], v74
  ds_read_b128 v[60:63], v76 offset:36864
  ds_read_b128 v[64:67], v76 offset:37888
  s_waitcnt lgkmcnt(0)
  v_smfmac_f32_16x16x64_bf16 v[28:31], v[0:3], v[60:67], v74
  ds_read_b128 v[60:63], v76 offset:38912
  ds_read_b128 v[64:67], v76 offset:39936
  s_waitcnt lgkmcnt(0)
  v_smfmac_f32_16x16x64_bf16 v[32:35], v[0:3], v[60:67], v74
  ds_read_b128 v[4:7], v76 offset:1024
  s_waitcnt lgkmcnt(0)
  v_smfmac_f32_16x16x64_bf16 v[20:23], v[4:7], v[80:87], v74
  v_smfmac_f32_16x16x64_bf16 v[24:27], v[4:7], v[88:95], v74
  v_smfmac_f32_16x16x64_bf16 v[28:31], v[4:7], v[208:215], v74
  v_smfmac_f32_16x16x64_bf16 v[32:35], v[4:7], v[216:223], v74
  ds_read_b128 v[8:11], v76 offset:2048
  s_waitcnt lgkmcnt(0)
  v_smfmac_f32_16x16x64_bf16 v[20:23], v[8:11], v[96:103], v74
  v_smfmac_f32_16x16x64_bf16 v[24:27], v[8:11], v[104:111], v74
  ds_read_b128 v[60:63], v76 offset:53248
  ds_read_b128 v[64:67], v76 offset:54272
  s_waitcnt lgkmcnt(0)
  v_smfmac_f32_16x16x64_bf16 v[28:31], v[8:11], v[60:67], v74
  ds_read_b128 v[60:63], v76 offset:55296
  ds_read_b128 v[64:67], v76 offset:56320
  s_waitcnt lgkmcnt(0)
  v_smfmac_f32_16x16x64_bf16 v[32:35], v[8:11], v[60:67], v74
  ds_read_b128 v[12:15], v76 offset:3072
  s_waitcnt lgkmcnt(0)
  v_smfmac_f32_16x16x64_bf16 v[20:23], v[12:15], v[112:119], v74
  v_smfmac_f32_16x16x64_bf16 v[24:27], v[12:15], v[120:127], v74
  v_smfmac_f32_16x16x64_bf16 v[28:31], v[12:15], v[224:231], v74
  v_smfmac_f32_16x16x64_bf16 v[32:35], v[12:15], v[232:239], v74
  ds_read_b128 v[4:7], v76 offset:4096
  s_waitcnt lgkmcnt(0)
  v_smfmac_f32_16x16x64_bf16 v[20:23], v[4:7], v[128:135], v74
  v_smfmac_f32_16x16x64_bf16 v[24:27], v[4:7], v[136:143], v74
  ds_read_b128 v[60:63], v75 offset:20480
  ds_read_b128 v[64:67], v75 offset:21504
  s_waitcnt lgkmcnt(0)
  v_smfmac_f32_16x16x64_bf16 v[28:31], v[4:7], v[60:67], v74
  ds_read_b128 v[60:63], v75 offset:22528
  ds_read_b128 v[64:67], v75 offset:23552
  s_waitcnt lgkmcnt(0)
  v_smfmac_f32_16x16x64_bf16 v[32:35], v[4:7], v[60:67], v74
  ds_read_b128 v[16:19], v76 offset:5120
  s_waitcnt lgkmcnt(0)
  v_smfmac_f32_16x16x64_bf16 v[20:23], v[16:19], v[144:151], v74
  v_smfmac_f32_16x16x64_bf16 v[24:27], v[16:19], v[152:159], v74
  v_smfmac_f32_16x16x64_bf16 v[28:31], v[16:19], v[240:247], v74
  v_smfmac_f32_16x16x64_bf16 v[32:35], v[16:19], v[248:255], v74
  ds_read_b128 v[12:15], v76 offset:6144
  s_waitcnt lgkmcnt(0)
  v_smfmac_f32_16x16x64_bf16 v[20:23], v[12:15], v[160:167], v74
  v_smfmac_f32_16x16x64_bf16 v[24:27], v[12:15], v[168:175], v74
  v_smfmac_f32_16x16x64_bf16 v[28:31], v[12:15], a[0:7], v74
  v_smfmac_f32_16x16x64_bf16 v[32:35], v[12:15], a[8:15], v74
  ds_read_b128 v[8:11], v76 offset:7168
  s_waitcnt lgkmcnt(0)
  v_smfmac_f32_16x16x64_bf16 v[20:23], v[8:11], v[176:183], v74
  v_smfmac_f32_16x16x64_bf16 v[24:27], v[8:11], v[184:191], v74
  v_smfmac_f32_16x16x64_bf16 v[28:31], v[8:11], a[16:23], v74
  v_smfmac_f32_16x16x64_bf16 v[32:35], v[8:11], a[24:31], v74
  ds_read_b128 v[0:3], v76 offset:8192
  s_waitcnt lgkmcnt(0)
  v_smfmac_f32_16x16x64_bf16 v[20:23], v[0:3], v[192:199], v74
  v_smfmac_f32_16x16x64_bf16 v[24:27], v[0:3], v[200:207], v74
  ds_read_b128 v[60:63], v75 offset:4096
  ds_read_b128 v[64:67], v75 offset:5120
  s_waitcnt lgkmcnt(0)
  v_smfmac_f32_16x16x64_bf16 v[28:31], v[0:3], v[60:67], v74
  ds_read_b128 v[60:63], v75 offset:6144
  ds_read_b128 v[64:67], v75 offset:7168
  s_waitcnt lgkmcnt(0)
  v_smfmac_f32_16x16x64_bf16 v[32:35], v[0:3], v[60:67], v74
  v_add_f32 v20, v20, v22
  v_add_f32 v21, v21, v23
  v_add_f32 v24, v24, v26
  v_cvt_pk_bf16_f32 v22, v20, v24
  ds_write_b32 v79, v22 offset:0
  v_add_f32 v25, v25, v27
  v_cvt_pk_bf16_f32 v23, v21, v25
  ds_write_b32 v79, v23 offset:576
  v_add_f32 v28, v28, v30
  v_add_f32 v29, v29, v31
  s_waitcnt lgkmcnt(0)
  s_nop 1
  s_branch Cf1_recok
Cf1_h1r:
  s_mov_b64 exec, vcc
  buffer_load_dwordx4 v[52:55], v76, s[8:11], s60 offen offset:0 sc1
  buffer_load_dwordx4 v[56:59], v76, s[8:11], s60 offen offset:1024 sc1
  s_mov_b64 exec, -1
  s_add_u32 s67, s67, 1
  s_waitcnt vmcnt(3)
  v_mfma_f32_16x16x32_bf16 v[4:7], v[0:3], v[36:39], 0
  v_bitop3_b32 v72, v36, v38, s72 bitop3:0x7e
  s_waitcnt vmcnt(2)
  v_mfma_f32_16x16x32_bf16 v[4:7], v[0:3], v[40:43], v[4:7]
  v_bitop3_b32 v73, v40, v42, s72 bitop3:0x7e
  v_bitop3_b32 v72, v72, v73, 1 bitop3:0xa8
  v_cmp_ne_u32 vcc, 0, v72
  s_cbranch_vccz Cf1_h1p
  s_mov_b64 exec, vcc
  buffer_load_dwordx4 v[36:39], v76, s[8:11], s60 offen offset:0 sc1
  buffer_load_dwordx4 v[40:43], v76, s[8:11], s60 offen offset:1024 sc1
  s_mov_b64 exec, -1
  s_add_u32 s67, s67, 1
  s_waitcnt vmcnt(3)
  v_mfma_f32_16x16x32_bf16 v[4:7], v[0:3], v[52:55], 0
  v_bitop3_b32 v72, v52, v54, s72 bitop3:0x7e
  s_waitcnt vmcnt(2)
  v_mfma_f32_16x16x32_bf16 v[4:7], v[0:3], v[56:59], v[4:7]
  v_bitop3_b32 v73, v56, v58, s72 bitop3:0x7e
  v_bitop3_b32 v72, v72, v73, 1 bitop3:0xa8
  v_cmp_ne_u32 vcc, 0, v72
  s_cbranch_vccz Cf1_h1p
  s_cmp_lt_u32 s67, 131072
  s_cbranch_scc1 Cf1_h1r
  s_branch Cf1_h1p
Cf1_h2r:
Cf1_h2s:
  s_mov_b64 exec, vcc
  buffer_load_dwordx4 v[52:55], v76, s[8:11], s64 offen offset:0 sc1
  buffer_load_dwordx4 v[56:59], v76, s[8:11], s64 offen offset:1024 sc1
  s_mov_b64 exec, -1
  s_add_u32 s67, s67, 1
  s_waitcnt vmcnt(4)
  v_max3_u32 v72, v52, v53, v54
  v_max3_u32 v72, v72, v55, v56
  v_max3_u32 v72, v72, v57, v58
  v_max_u32 v72, v72, v59
  v_cmp_eq_u32 vcc, -1, v72
  s_cbranch_vccz Cf1_h2ok
  s_mov_b64 exec, vcc
  buffer_load_dwordx4 v[52:55], v76, s[8:11], s64 offen offset:0 sc1
  buffer_load_dwordx4 v[56:59], v76, s[8:11], s64 offen offset:1024 sc1
  s_mov_b64 exec, -1
  s_add_u32 s67, s67, 1
  s_waitcnt vmcnt(4)
  v_max3_u32 v72, v52, v53, v54
  v_max3_u32 v72, v72, v55, v56
  v_max3_u32 v72, v72, v57, v58
  v_max_u32 v72, v72, v59
  v_cmp_eq_u32 vcc, -1, v72
  s_cbranch_vccz Cf1_h2ok
  s_mov_b64 exec, vcc
  buffer_load_dwordx4 v[52:55], v76, s[8:11], s64 offen offset:0 sc1
  buffer_load_dwordx4 v[56:59], v76, s[8:11], s64 offen offset:1024 sc1
  s_mov_b64 exec, -1
  s_add_u32 s67, s67, 1
  s_waitcnt vmcnt(4)
  v_max3_u32 v72, v52, v53, v54
  v_max3_u32 v72, v72, v55, v56
  v_max3_u32 v72, v72, v57, v58
  v_max_u32 v72, v72, v59
  v_cmp_eq_u32 vcc, -1, v72
  s_cbranch_vccz Cf1_h2ok
  s_mov_b64 exec, vcc
  buffer_load_dwordx4 v[52:55], v76, s[8:11], s64 offen offset:0 sc1
  buffer_load_dwordx4 v[56:59], v76, s[8:11], s64 offen offset:1024 sc1
  s_mov_b64 exec, -1
  s_add_u32 s67, s67, 1
  s_waitcnt vmcnt(4)
  v_max3_u32 v72, v52, v53, v54
  v_max3_u32 v72, v72, v55, v56
  v_max3_u32 v72, v72, v57, v58
  v_max_u32 v72, v72, v59
  v_cmp_eq_u32 vcc, -1, v72
  s_cbranch_vccz Cf1_h2ok
  s_cmp_lt_u32 s67, 131072
  s_cbranch_scc1 Cf1_h2s
Cf1_h2ok:
  ds_write_b128 v76, v[52:55] offset:2048
  ds_write_b128 v76, v[56:59] offset:3072
  s_branch Cf1_h2w
Cf1_last:
  s_waitcnt vmcnt(0) lgkmcnt(0)
  ds_read_b64 v[16:17], v77 offset:264
  v_mov_b64 v[18:19], v[72:73]
  s_add_u32 s68, s68, 131072
  s_waitcnt lgkmcnt(0)
  buffer_store_dwordx4 v[16:19], v76, s[8:11], s68 offen sc1
  s_waitcnt vmcnt(0)
  s_barrier
  v_mov_b32 v72, 65
  s_mov_b64 exec, 1
  buffer_store_dword v72, v76, s[8:11], s71 offen sc1
  s_mov_b64 exec, -1
  s_branch L_cexit
L_w2:
  v_mov_b64 v[20:21], 0
  v_mov_b64 v[22:23], 0
  v_mov_b64 v[24:25], 0
  v_mov_b64 v[26:27], 0
  v_mov_b64 v[28:29], 0
  v_mov_b64 v[30:31], 0
  v_mov_b64 v[32:33], 0
  v_mov_b64 v[34:35], 0
  s_mov_b32 m0, 15872
  s_branch Cf2_h2
.p2align 6
Cf2_top:
  s_waitcnt lgkmcnt(0)
  s_barrier
  ds_read_b128 v[0:3], v76 offset:0
  ds_read_b128 v[4:7], v76 offset:1024
  buffer_load_dwordx4 v76, s[8:11], s64 offen offset:0 sc1 lds
  buffer_load_dwordx4 v76, s[8:11], s64 offen offset:1024 sc1 lds
  s_waitcnt lgkmcnt(1)
  v_smfmac_f32_16x16x64_bf16 v[20:23], v[0:3], v[60:67], v74
  ds_read_b128 v[60:63], v76 offset:43008
  v_smfmac_f32_16x16x64_bf16 v[24:27], v[0:3], v[44:51], v74
  s_mov_b32 m0, 15872
  ds_read_b128 v[64:67], v76 offset:44032
  s_waitcnt lgkmcnt(2)
  v_smfmac_f32_16x16x64_bf16 v[20:23], v[4:7], v[80:87], v74
  buffer_load_dwordx4 v[44:47], v76, s[8:11], s58 offen offset:0 sc1
  ds_read_b128 v[8:11], v76 offset:2048
  v_smfmac_f32_16x16x64_bf16 v[28:31], v[0:3], v[36:43], v74
  ds_read_b128 v[36:39], v76 offset:57344
  v_smfmac_f32_16x16x64_bf16 v[24:27], v[4:7], v[88:95], v74
  buffer_load_dwordx4 v[48:51], v76, s[8:11], s58 offen offset:1024 sc1
  ds_read_b128 v[40:43], v76 offset:58368
  v_smfmac_f32_16x16x64_bf16 v[28:31], v[4:7], v[208:215], v74
  ds_read_b128 v[12:15], v76 offset:3072
  v_smfmac_f32_16x16x64_bf16 v[32:35], v[4:7], v[216:223], v74
  buffer_load_dwordx4 v[52:55], v76, s[8:11], s59 offen offset:0 sc1
  s_waitcnt lgkmcnt(4)
  v_smfmac_f32_16x16x64_bf16 v[32:35], v[0:3], v[60:67], v74
  ds_read_b128 v[60:63], v76 offset:59392
  s_waitcnt lgkmcnt(4)
  v_smfmac_f32_16x16x64_bf16 v[20:23], v[8:11], v[96:103], v74
  buffer_load_dwordx4 v[56:59], v76, s[8:11], s59 offen offset:1024 sc1
  ds_read_b128 v[64:67], v76 offset:60416
  v_smfmac_f32_16x16x64_bf16 v[24:27], v[8:11], v[104:111], v74
  ds_read_b128 v[0:3], v76 offset:8192
  s_waitcnt lgkmcnt(4)
  v_smfmac_f32_16x16x64_bf16 v[28:31], v[8:11], v[36:43], v74
  ds_read_b128 v[36:39], v75 offset:8192
  s_waitcnt lgkmcnt(4)
  v_smfmac_f32_16x16x64_bf16 v[20:23], v[12:15], v[112:119], v74
  ds_read_b128 v[40:43], v75 offset:9216
  v_smfmac_f32_16x16x64_bf16 v[24:27], v[12:15], v[120:127], v74
  s_waitcnt lgkmcnt(3)
  v_smfmac_f32_16x16x64_bf16 v[32:35], v[8:11], v[60:67], v74
  buffer_store_dwordx4 v[16:19], v76, s[8:11], s68 offen sc1
  ds_read_b128 v[60:63], v75 offset:10240
  v_smfmac_f32_16x16x64_bf16 v[28:31], v[12:15], v[224:231], v74
  buffer_load_dword v73, s[8:11], s70 offen lds
  s_waitcnt vmcnt(6)
  ds_read_b128 v[64:67], v75 offset:11264
  v_smfmac_f32_16x16x64_bf16 v[32:35], v[12:15], v[232:239], v74
  s_barrier
  s_waitcnt lgkmcnt(4)
  v_smfmac_f32_16x16x64_bf16 v[20:23], v[0:3], v[192:199], v74
  ds_read_b128 v[4:7], v76 offset:4096
  s_waitcnt lgkmcnt(3)
  v_smfmac_f32_16x16x64_bf16 v[28:31], v[0:3], v[36:43], v74
  ds_read_b128 v[16:19], v76 offset:5120
  v_smfmac_f32_16x16x64_bf16 v[24:27], v[0:3], v[200:207], v74
  ds_read_b128 v[36:39], v75 offset:24576
  s_waitcnt lgkmcnt(3)
  v_mov_b32 v68, 0x3f803f80
  v_smfmac_f32_16x16x64_bf16 v[32:35], v[0:3], v[60:67], v74
  ds_read_b128 v[40:43], v75 offset:25600
  s_waitcnt lgkmcnt(3)
  v_smfmac_f32_16x16x64_bf16 v[20:23], v[4:7], v[128:135], v74
  ds_read_b128 v[12:15], v76 offset:6144
  v_mov_b32 v69, 0x3f803f80
  v_smfmac_f32_16x16x64_bf16 v[24:27], v[4:7], v[136:143], v74
  ds_read_b128 v[8:11], v76 offset:7168
  s_waitcnt lgkmcnt(4)
  v_smfmac_f32_16x16x64_bf16 v[20:23], v[16:19], v[144:151], v74
  ds_read_b128 v[60:63], v75 offset:26624
  v_mov_b64 v[70:71], v[68:69]
  v_smfmac_f32_16x16x64_bf16 v[24:27], v[16:19], v[152:159], v74
  ds_read_b128 v[64:67], v75 offset:27648
  s_waitcnt lgkmcnt(4)
  v_smfmac_f32_16x16x64_bf16 v[28:31], v[4:7], v[36:43], v74
  s_waitcnt lgkmcnt(3)
  v_mov_b64 v[36:37], 0
  v_smfmac_f32_16x16x64_bf16 v[20:23], v[12:15], v[160:167], v74
  s_waitcnt lgkmcnt(2)
  v_mov_b64 v[38:39], 0
  v_smfmac_f32_16x16x64_bf16 v[20:23], v[8:11], v[176:183], v74
  v_mov_b64 v[40:41], 0
  v_smfmac_f32_16x16x64_bf16 v[24:27], v[12:15], v[168:175], v74
  v_mov_b64 v[42:43], 0
  v_smfmac_f32_16x16x64_bf16 v[24:27], v[8:11], v[184:191], v74
  s_waitcnt lgkmcnt(0)
  v_add_f32 v20, v20, v22
  v_smfmac_f32_16x16x64_bf16 v[32:35], v[4:7], v[60:67], v74
  v_add_f32 v21, v21, v23
  v_smfmac_f32_16x16x64_bf16 v[28:31], v[16:19], v[240:247], v74
  v_add_f32 v24, v24, v26
  v_cvt_pk_bf16_f32 v22, v20, v24
  v_smfmac_f32_16x16x64_bf16 v[28:31], v[12:15], a[0:7], v74
  ds_write_b32 v79, v22 offset:0
  v_add_f32 v25, v25, v27
  v_cvt_pk_bf16_f32 v23, v21, v25
  v_smfmac_f32_16x16x64_bf16 v[28:31], v[8:11], a[16:23], v74
  ds_write_b32 v79, v23 offset:576
  v_cmp_u_f32 vcc, v20, v21
  v_smfmac_f32_16x16x64_bf16 v[32:35], v[16:19], v[248:255], v74
  v_smfmac_f32_16x16x64_bf16 v[32:35], v[12:15], a[8:15], v74
  v_add_f32 v28, v28, v30
  v_add_f32 v29, v29, v31
  v_smfmac_f32_16x16x64_bf16 v[32:35], v[8:11], a[24:31], v74
  s_cbranch_vccnz Cf2_rec
Cf2_recok:
  v_smfmac_f32_16x16x64_bf16 v[36:39], v[16:19], a[112:119], v74
  s_waitcnt lgkmcnt(0)
  s_barrier
  ds_read_b128 v[60:63], v77
  v_smfmac_f32_16x16x64_bf16 v[40:43], v[16:19], a[120:127], v74
  ds_read_b128 v[64:67], v77 offset:128
  v_add_f32 v32, v32, v34
  v_cvt_pk_bf16_f32 v30, v28, v32
  v_smfmac_f32_16x16x64_bf16 v[36:39], v[0:3], a[160:167], v74
  ds_write_b32 v79, v30 offset:256
  v_add_f32 v33, v33, v35
  v_cvt_pk_bf16_f32 v31, v29, v33
  v_smfmac_f32_16x16x64_bf16 v[40:43], v[0:3], a[168:175], v74
  ds_write_b32 v79, v31 offset:832
  v_xor_b32 v75, 0x8000, v75
  v_smfmac_f32_16x16x64_bf16 v[36:39], v[4:7], a[96:103], v74
  ds_read_b128 v[0:3], v76 offset:0
  v_mov_b32 v29, 0
  v_smfmac_f32_16x16x64_bf16 v[40:43], v[4:7], a[104:111], v74
  s_waitcnt vmcnt(4) lgkmcnt(3)
  v_mov_b32 v30, 0
  v_mfma_f32_16x16x32_bf16 v[44:47], v[44:47], v[60:63], 0
  ds_read_b128 v[4:7], v76 offset:1024
  s_waitcnt lgkmcnt(2)
  v_mfma_f32_16x16x32_bf16 v[44:47], v[48:51], v[64:67], v[44:47]
  s_barrier
  v_smfmac_f32_16x16x64_bf16 v[36:39], v[8:11], a[144:151], v74
  ds_read_b128 v[20:23], v77 offset:256
  ds_read_b128 v[24:27], v77 offset:384
  v_smfmac_f32_16x16x64_bf16 v[40:43], v[8:11], a[152:159], v74
  ds_read_b128 v[8:11], v76 offset:2048
  v_add_f32_dpp v72, v46, v44 quad_perm:[2,3,0,1] row_mask:0xf bank_mask:0xf
  v_add_f32_dpp v73, v47, v45 quad_perm:[2,3,0,1] row_mask:0xf bank_mask:0xf
  v_smfmac_f32_16x16x64_bf16 v[36:39], v[12:15], a[128:135], v74
  ds_read_b128 v[44:47], v75 offset:49152
  v_exp_f32_dpp v72, v72 quad_perm:[0,1,0,1] row_mask:0xf bank_mask:0xf
  v_smfmac_f32_16x16x64_bf16 v[40:43], v[12:15], a[136:143], v74
  ds_read_b128 v[12:15], v76 offset:3072
  s_waitcnt lgkmcnt(6)
  v_exp_f32_dpp v73, v73 quad_perm:[0,1,0,1] row_mask:0xf bank_mask:0xf
  v_smfmac_f32_16x16x64_bf16 v[36:39], v[0:3], a[32:39], v74
  s_waitcnt lgkmcnt(3)
  v_cvt_pk_bf16_f32 v72, v72, v73
  v_mfma_f32_16x16x32_bf16 v[20:23], v[20:23], v[60:63], 0
  ds_write_b32 v78, v72 offset:520
  v_mfma_f32_16x16x32_bf16 v[20:23], v[24:27], v[64:67], v[20:23]
  ds_read_b128 v[48:51], v75 offset:50176
  v_smfmac_f32_16x16x64_bf16 v[40:43], v[0:3], a[40:47], v74
  ds_read_b128 v[60:63], v75 offset:51200
  v_smfmac_f32_16x16x64_bf16 v[36:39], v[4:7], a[48:55], v74
  s_waitcnt lgkmcnt(5)
  v_add_f32_dpp v24, v22, v20 quad_perm:[2,3,0,1] row_mask:0xf bank_mask:0xf
  v_add_f32_dpp v25, v23, v21 quad_perm:[2,3,0,1] row_mask:0xf bank_mask:0xf
  v_smfmac_f32_16x16x64_bf16 v[36:39], v[8:11], a[64:71], v74
  s_waitcnt lgkmcnt(2)
  s_barrier
  ds_read_b128 v[32:35], v78 offset:512
  v_smfmac_f32_16x16x64_bf16 v[36:39], v[12:15], a[80:87], v74
  ds_read_b128 v[64:67], v75 offset:52224
  v_mul_f32 v24, s69, v24
  v_smfmac_f32_16x16x64_bf16 v[40:43], v[4:7], a[56:63], v74
  v_mul_f32 v25, s69, v25
  v_smfmac_f32_16x16x64_bf16 v[40:43], v[8:11], a[72:79], v74
  v_exp_f32_dpp v24, v24 quad_perm:[0,1,0,1] row_mask:0xf bank_mask:0xf
  v_smfmac_f32_16x16x64_bf16 v[40:43], v[12:15], a[88:95], v74
  s_waitcnt vmcnt(2) lgkmcnt(1)
  v_exp_f32_dpp v25, v25 quad_perm:[0,1,0,1] row_mask:0xf bank_mask:0xf
  v_mfma_f32_16x16x32_bf16 v[8:11], v[32:35], v[68:71], 0
  v_add_f32 v36, v36, v38
  v_add_f32 v37, v37, v39
  v_mfma_f32_16x16x32_bf16 v[0:3], v[32:35], v[52:55], 0
  v_add_f32 v40, v40, v42
  v_add_f32 v41, v41, v43
  v_mfma_f32_16x16x32_bf16 v[4:7], v[32:35], v[56:59], 0
  v_cvt_pk_bf16_f32 v28, v24, v25
  v_cvt_pk_bf16_f32 v72, v36, v37
  v_cvt_pk_bf16_f32 v73, v40, v41
  v_mfma_f32_16x16x16_bf16 v[8:11], v[28:29], v[68:69], v[8:11]
  v_cvt_pk_bf16_f32 v31, v24, v25
  v_mfma_f32_16x16x16_bf16 v[0:3], v[28:29], v[72:73], v[0:3]
  ds_read_b128 v[68:71], v76 offset:13824
  v_mfma_f32_16x16x16_bf16 v[4:7], v[30:31], v[72:73], v[4:7]
  v_rcp_f32 v10, v8
  v_rcp_f32 v11, v9
  v_mul_f32 v0, v10, v0
  v_mul_f32 v1, v11, v1
  s_nop 0
  v_mul_f32 v4, v10, v4
  v_mul_f32 v5, v11, v5
  v_cvt_pk_bf16_f32 v2, v0, v4
  ds_write_b32 v79, v2 offset:0
  v_cvt_pk_bf16_f32 v3, v1, v5
  ds_write_b32 v79, v3 offset:576
  v_mov_b64 v[16:17], 0
  v_mov_b64 v[18:19], 0
  v_mov_b64 v[20:21], 0
  v_mov_b64 v[22:23], 0
  v_mov_b64 v[24:25], 0
  v_mov_b64 v[26:27], 0
  v_mov_b64 v[28:29], 0
  v_mov_b64 v[30:31], 0
  v_mov_b64 v[32:33], 0
  v_mov_b64 v[34:35], 0
  s_waitcnt lgkmcnt(0)
  s_barrier
  ds_read_b128 v[0:3], v78 offset:0
  ds_read_b128 v[4:7], v78 offset:64
  ds_read_b128 v[8:11], v78 offset:128
  ds_read_b128 v[12:15], v78 offset:192
  s_cmp_eq_u32 s66, 63
  s_cbranch_scc1 Cf2_last
  s_waitcnt lgkmcnt(3)
  v_smfmac_f32_16x16x64_bf16 v[16:19], v[0:3], a[176:183], v74
  ds_read_b128 v[52:55], v75 offset:53248
  ds_read_b128 v[56:59], v75 offset:54272
  s_waitcnt lgkmcnt(4)
  v_smfmac_f32_16x16x64_bf16 v[16:19], v[4:7], a[184:191], v74
  ds_read_b128 v[36:39], v75 offset:55296
  s_waitcnt lgkmcnt(4)
  v_smfmac_f32_16x16x64_bf16 v[16:19], v[8:11], a[192:199], v74
  ds_read_b128 v[40:43], v75 offset:56320
  s_waitcnt lgkmcnt(4)
  v_smfmac_f32_16x16x64_bf16 v[16:19], v[12:15], a[200:207], v74
  v_smfmac_f32_16x16x64_bf16 v[32:35], v[0:3], v[44:51], v74
  ds_read_b128 v[44:47], v75 offset:8192
  ds_read_b128 v[48:51], v75 offset:9216
  v_smfmac_f32_16x16x64_bf16 v[32:35], v[4:7], v[60:67], v74
  ds_read_b128 v[60:63], v75 offset:10240
  s_waitcnt lgkmcnt(5)
  v_cvt_pk_bf16_f32 v16, v16, v17
  v_cvt_pk_bf16_f32 v17, v18, v19
  v_bfi_b32 v16, 1, s72, v16
  v_smfmac_f32_16x16x64_bf16 v[32:35], v[8:11], v[52:59], v74
  ds_read_b128 v[64:67], v75 offset:11264
  buffer_store_dwordx2 v[16:17], v68, s[8:11], s73 offen
  s_waitcnt lgkmcnt(4)
  v_smfmac_f32_16x16x64_bf16 v[32:35], v[12:15], v[36:43], v74
  ds_read_b128 v[52:55], v75 offset:24576
  v_smfmac_f32_16x16x64_bf16 v[20:23], v[0:3], a[208:215], v74
  ds_read_b128 v[56:59], v75 offset:25600
  v_smfmac_f32_16x16x64_bf16 v[20:23], v[4:7], a[216:223], v74
  ds_read_b128 v[36:39], v75 offset:26624
  s_waitcnt lgkmcnt(5)
  v_cvt_pk_bf16_f32 v32, v32, v33
  v_cvt_pk_bf16_f32 v33, v34, v35
  v_bfi_b32 v32, 1, s72, v32
  v_smfmac_f32_16x16x64_bf16 v[20:23], v[8:11], v[44:51], v74
  ds_read_b128 v[40:43], v75 offset:27648
  buffer_store_dwordx2 v[32:33], v68, s[8:11], s77 offen
  s_waitcnt lgkmcnt(4)
  v_mov_b64 v[18:19], v[72:73]
  v_smfmac_f32_16x16x64_bf16 v[20:23], v[12:15], v[60:67], v74
  ds_read_b128 v[44:47], v75 offset:40960
  v_mov_b64 v[32:33], 0
  v_smfmac_f32_16x16x64_bf16 v[24:27], v[0:3], a[224:231], v74
  ds_read_b128 v[48:51], v75 offset:41984
  v_mov_b64 v[34:35], 0
  v_smfmac_f32_16x16x64_bf16 v[24:27], v[4:7], a[232:239], v74
  ds_read_b128 v[60:63], v75 offset:43008
  s_waitcnt lgkmcnt(5)
  v_cvt_pk_bf16_f32 v20, v20, v21
  v_cvt_pk_bf16_f32 v21, v22, v23
  v_bfi_b32 v20, 1, s72, v20
  v_smfmac_f32_16x16x64_bf16 v[24:27], v[8:11], v[52:59], v74
  ds_read_b128 v[64:67], v75 offset:44032
  buffer_store_dwordx2 v[20:21], v68, s[8:11], s74 offen
  s_waitcnt lgkmcnt(4)
  v_smfmac_f32_16x16x64_bf16 v[24:27], v[12:15], v[36:43], v74
  ds_read_b64 v[16:17], v77 offset:384
  v_xor_b32 v75, 0x8000, v75
  v_smfmac_f32_16x16x64_bf16 v[28:31], v[0:3], a[240:247], v74
  v_smfmac_f32_16x16x64_bf16 v[28:31], v[4:7], a[248:255], v74
  s_waitcnt lgkmcnt(3)
  v_cvt_pk_bf16_f32 v24, v24, v25
  v_cvt_pk_bf16_f32 v25, v26, v27
  v_bfi_b32 v24, 1, s72, v24
  v_smfmac_f32_16x16x64_bf16 v[28:31], v[8:11], v[44:51], v74
  buffer_store_dwordx2 v[24:25], v68, s[8:11], s75 offen
  s_waitcnt lgkmcnt(1)
  v_smfmac_f32_16x16x64_bf16 v[28:31], v[12:15], v[60:67], v74
  ds_read_b128 v[0:3], v76 offset:14848
  s_nop 6
  v_cvt_pk_bf16_f32 v28, v28, v29
  v_cvt_pk_bf16_f32 v29, v30, v31
  v_bfi_b32 v28, 1, s72, v28
  buffer_store_dwordx2 v[28:29], v68, s[8:11], s76 offen
  v_mov_b64 v[20:21], 0
  v_mov_b64 v[22:23], 0
  v_mov_b64 v[24:25], 0
  v_mov_b64 v[26:27], 0
  v_mov_b64 v[28:29], 0
  v_mov_b64 v[30:31], 0
  s_add_u32 s58, s58, 524288
  s_add_u32 s59, s59, 524288
  s_add_u32 s70, s70, 524288
  s_add_u32 s68, s68, 131072
  s_add_u32 s66, s66, 1
  s_xor_b32 s64, s64, 16384
  s_xor_b32 s65, s65, 16384
  s_nop 15
  s_nop 15
  s_nop 7
  buffer_load_dwordx4 v[52:55], v76, s[8:11], s60 offen offset:0 sc1
  buffer_load_dwordx4 v[56:59], v76, s[8:11], s60 offen offset:1024 sc1
  s_nop 15
  s_nop 11
  buffer_load_dwordx4 v[36:39], v76, s[8:11], s60 offen offset:0 sc1
  buffer_load_dwordx4 v[40:43], v76, s[8:11], s60 offen offset:1024 sc1
  s_waitcnt vmcnt(3) lgkmcnt(0)
  v_mfma_f32_16x16x32_bf16 v[4:7], v[0:3], v[52:55], 0
  v_bitop3_b32 v72, v52, v54, s72 bitop3:0x7e
  s_waitcnt vmcnt(2)
  v_mfma_f32_16x16x32_bf16 v[4:7], v[0:3], v[56:59], v[4:7]
  v_bitop3_b32 v73, v56, v58, s72 bitop3:0x7e
  v_bitop3_b32 v72, v72, v73, 1 bitop3:0xa8
  v_cmp_ne_u32 vcc, 0, v72
  s_cbranch_vccnz Cf2_h1r
Cf2_h1p:
  s_nop 2
  v_add_f32_dpp v4, v4, v4 row_ror:4 row_mask:0xf bank_mask:0xf
  v_add_f32_dpp v5, v5, v5 row_ror:4 row_mask:0xf bank_mask:0xf
  s_nop 0
  v_add_f32_dpp v4, v4, v4 row_ror:8 row_mask:0xf bank_mask:0xf
  v_add_f32_dpp v5, v5, v5 row_ror:8 row_mask:0xf bank_mask:0xf
  v_cvt_pk_bf16_f32 v4, v4, v5
  buffer_store_dword v4, v69, s[8:11], s62 offen
Cf2_h1ok:
  s_xor_b32 s62, s62, 16384
  s_xor_b32 s72, s72, 1
Cf2_h2:
  v_lshlrev_b32 v73, 2, v76
  s_mov_b32 m0, 4096
  buffer_store_dword v71, v69, s[8:11], s62 offen
  s_waitcnt vmcnt(2)
  ds_read_b128 v[60:63], v76 offset:24576
  ds_read_b128 v[64:67], v76 offset:25600
  ds_read_b128 v[44:47], v76 offset:26624
  ds_read_b128 v[48:51], v76 offset:27648
  ds_read_b128 v[36:39], v76 offset:40960
  ds_read_b128 v[40:43], v76 offset:41984
  s_branch Cf2_top
Cf2_rec:
  s_nop 7
  s_waitcnt vmcnt(0) lgkmcnt(0)
  v_max3_u32 v72, v0, v1, v2
  v_max3_u32 v72, v72, v3, v4
  v_max3_u32 v72, v72, v5, v6
  v_max3_u32 v72, v72, v7, v8
  v_max3_u32 v72, v72, v9, v10
  v_max3_u32 v72, v72, v11, v12
  v_max3_u32 v72, v72, v13, v14
  v_max3_u32 v72, v72, v15, v16
  v_max3_u32 v72, v72, v17, v18
  v_max_u32 v72, v72, v19
  v_cmp_eq_u32 vcc, -1, v72
  s_cbranch_vccz Cf2_recok
  s_barrier
Cf2_recp:
  buffer_load_dwordx4 v[60:63], v76, s[8:11], s64 offen offset:0 sc1
  buffer_load_dwordx4 v[64:67], v76, s[8:11], s64 offen offset:1024 sc1
  s_add_u32 s67, s67, 1
  s_cmp_lt_u32 s67, 131072
  s_cselect_b32 s54, -2, -1
  s_waitcnt vmcnt(1)
  v_max3_u32 v72, v60, v61, v62
  s_waitcnt vmcnt(0)
  v_max3_u32 v72, v72, v63, v64
  v_max3_u32 v72, v72, v65, v66
  v_max_u32 v72, v72, v67
  v_cmp_lt_u32 vcc, s54, v72
  s_cbranch_vccnz Cf2_recp
  ds_write_b128 v76, v[60:63] offset:4096
  ds_write_b128 v76, v[64:67] offset:5120
  v_mov_b64 v[20:21], 0
  v_mov_b64 v[22:23], 0
  v_mov_b64 v[24:25], 0
  v_mov_b64 v[26:27], 0
  v_mov_b64 v[28:29], 0
  v_mov_b64 v[30:31], 0
  v_mov_b64 v[32:33], 0
  v_mov_b64 v[34:35], 0
  s_waitcnt lgkmcnt(0)
  s_barrier
  ds_read_b128 v[0:3], v76 offset:0
  ds_read_b128 v[60:63], v76 offset:24576
  ds_read_b128 v[64:67], v76 offset:25600
  s_waitcnt lgkmcnt(0)
  v_smfmac_f32_16x16x64_bf16 v[20:23], v[0:3], v[60:67], v74
  ds_read_b128 v[60:63], v76 offset:26624
  ds_read_b128 v[64:67], v76 offset:27648
  s_waitcnt lgkmcnt(0)
  v_smfmac_f32_16x16x64_bf16 v[24:27], v[0:3], v[60:67], v74
  ds_read_b128 v[60:63], v76 offset:40960
  ds_read_b128 v[64:67], v76 offset:41984
  s_waitcnt lgkmcnt(0)
  v_smfmac_f32_16x16x64_bf16 v[28:31], v[0:3], v[60:67], v74
  ds_read_b128 v[60:63], v76 offset:43008
  ds_read_b128 v[64:67], v76 offset:44032
  s_waitcnt lgkmcnt(0)
  v_smfmac_f32_16x16x64_bf16 v[32:35], v[0:3], v[60:67], v74
  ds_read_b128 v[4:7], v76 offset:1024
  s_waitcnt lgkmcnt(0)
  v_smfmac_f32_16x16x64_bf16 v[20:23], v[4:7], v[80:87], v74
  v_smfmac_f32_16x16x64_bf16 v[24:27], v[4:7], v[88:95], v74
  v_smfmac_f32_16x16x64_bf16 v[28:31], v[4:7], v[208:215], v74
  v_smfmac_f32_16x16x64_bf16 v[32:35], v[4:7], v[216:223], v74
  ds_read_b128 v[8:11], v76 offset:2048
  s_waitcnt lgkmcnt(0)
  v_smfmac_f32_16x16x64_bf16 v[20:23], v[8:11], v[96:103], v74
  v_smfmac_f32_16x16x64_bf16 v[24:27], v[8:11], v[104:111], v74
  ds_read_b128 v[60:63], v76 offset:57344
  ds_read_b128 v[64:67], v76 offset:58368
  s_waitcnt lgkmcnt(0)
  v_smfmac_f32_16x16x64_bf16 v[28:31], v[8:11], v[60:67], v74
  ds_read_b128 v[60:63], v76 offset:59392
  ds_read_b128 v[64:67], v76 offset:60416
  s_waitcnt lgkmcnt(0)
  v_smfmac_f32_16x16x64_bf16 v[32:35], v[8:11], v[60:67], v74
  ds_read_b128 v[12:15], v76 offset:3072
  s_waitcnt lgkmcnt(0)
  v_smfmac_f32_16x16x64_bf16 v[20:23], v[12:15], v[112:119], v74
  v_smfmac_f32_16x16x64_bf16 v[24:27], v[12:15], v[120:127], v74
  v_smfmac_f32_16x16x64_bf16 v[28:31], v[12:15], v[224:231], v74
  v_smfmac_f32_16x16x64_bf16 v[32:35], v[12:15], v[232:239], v74
  ds_read_b128 v[4:7], v76 offset:4096
  s_waitcnt lgkmcnt(0)
  v_smfmac_f32_16x16x64_bf16 v[20:23], v[4:7], v[128:135], v74
  v_smfmac_f32_16x16x64_bf16 v[24:27], v[4:7], v[136:143], v74
  ds_read_b128 v[60:63], v75 offset:24576
  ds_read_b128 v[64:67], v75 offset:25600
  s_waitcnt lgkmcnt(0)
  v_smfmac_f32_16x16x64_bf16 v[28:31], v[4:7], v[60:67], v74
  ds_read_b128 v[60:63], v75 offset:26624
  ds_read_b128 v[64:67], v75 offset:27648
  s_waitcnt lgkmcnt(0)
  v_smfmac_f32_16x16x64_bf16 v[32:35], v[4:7], v[60:67], v74
  ds_read_b128 v[16:19], v76 offset:5120
  s_waitcnt lgkmcnt(0)
  v_smfmac_f32_16x16x64_bf16 v[20:23], v[16:19], v[144:151], v74
  v_smfmac_f32_16x16x64_bf16 v[24:27], v[16:19], v[152:159], v74
  v_smfmac_f32_16x16x64_bf16 v[28:31], v[16:19], v[240:247], v74
  v_smfmac_f32_16x16x64_bf16 v[32:35], v[16:19], v[248:255], v74
  ds_read_b128 v[12:15], v76 offset:6144
  s_waitcnt lgkmcnt(0)
  v_smfmac_f32_16x16x64_bf16 v[20:23], v[12:15], v[160:167], v74
  v_smfmac_f32_16x16x64_bf16 v[24:27], v[12:15], v[168:175], v74
  v_smfmac_f32_16x16x64_bf16 v[28:31], v[12:15], a[0:7], v74
  v_smfmac_f32_16x16x64_bf16 v[32:35], v[12:15], a[8:15], v74
  ds_read_b128 v[8:11], v76 offset:7168
  s_waitcnt lgkmcnt(0)
  v_smfmac_f32_16x16x64_bf16 v[20:23], v[8:11], v[176:183], v74
  v_smfmac_f32_16x16x64_bf16 v[24:27], v[8:11], v[184:191], v74
  v_smfmac_f32_16x16x64_bf16 v[28:31], v[8:11], a[16:23], v74
  v_smfmac_f32_16x16x64_bf16 v[32:35], v[8:11], a[24:31], v74
  ds_read_b128 v[0:3], v76 offset:8192
  s_waitcnt lgkmcnt(0)
  v_smfmac_f32_16x16x64_bf16 v[20:23], v[0:3], v[192:199], v74
  v_smfmac_f32_16x16x64_bf16 v[24:27], v[0:3], v[200:207], v74
  ds_read_b128 v[60:63], v75 offset:8192
  ds_read_b128 v[64:67], v75 offset:9216
  s_waitcnt lgkmcnt(0)
  v_smfmac_f32_16x16x64_bf16 v[28:31], v[0:3], v[60:67], v74
  ds_read_b128 v[60:63], v75 offset:10240
  ds_read_b128 v[64:67], v75 offset:11264
  s_waitcnt lgkmcnt(0)
  v_smfmac_f32_16x16x64_bf16 v[32:35], v[0:3], v[60:67], v74
  v_add_f32 v20, v20, v22
  v_add_f32 v21, v21, v23
  v_add_f32 v24, v24, v26
  v_cvt_pk_bf16_f32 v22, v20, v24
  ds_write_b32 v79, v22 offset:0
  v_add_f32 v25, v25, v27
  v_cvt_pk_bf16_f32 v23, v21, v25
  ds_write_b32 v79, v23 offset:576
  v_add_f32 v28, v28, v30
  v_add_f32 v29, v29, v31
  s_waitcnt lgkmcnt(0)
  s_nop 1
  s_branch Cf2_recok
Cf2_h1r:
  s_mov_b64 exec, vcc
  buffer_load_dwordx4 v[52:55], v76, s[8:11], s60 offen offset:0 sc1
  buffer_load_dwordx4 v[56:59], v76, s[8:11], s60 offen offset:1024 sc1
  s_mov_b64 exec, -1
  s_add_u32 s67, s67, 1
  s_waitcnt vmcnt(3)
  v_mfma_f32_16x16x32_bf16 v[4:7], v[0:3], v[36:39], 0
  v_bitop3_b32 v72, v36, v38, s72 bitop3:0x7e
  s_waitcnt vmcnt(2)
  v_mfma_f32_16x16x32_bf16 v[4:7], v[0:3], v[40:43], v[4:7]
  v_bitop3_b32 v73, v40, v42, s72 bitop3:0x7e
  v_bitop3_b32 v72, v72, v73, 1 bitop3:0xa8
  v_cmp_ne_u32 vcc, 0, v72
  s_cbranch_vccz Cf2_h1p
  s_mov_b64 exec, vcc
  buffer_load_dwordx4 v[36:39], v76, s[8:11], s60 offen offset:0 sc1
  buffer_load_dwordx4 v[40:43], v76, s[8:11], s60 offen offset:1024 sc1
  s_mov_b64 exec, -1
  s_add_u32 s67, s67, 1
  s_waitcnt vmcnt(3)
  v_mfma_f32_16x16x32_bf16 v[4:7], v[0:3], v[52:55], 0
  v_bitop3_b32 v72, v52, v54, s72 bitop3:0x7e
  s_waitcnt vmcnt(2)
  v_mfma_f32_16x16x32_bf16 v[4:7], v[0:3], v[56:59], v[4:7]
  v_bitop3_b32 v73, v56, v58, s72 bitop3:0x7e
  v_bitop3_b32 v72, v72, v73, 1 bitop3:0xa8
  v_cmp_ne_u32 vcc, 0, v72
  s_cbranch_vccz Cf2_h1p
  s_cmp_lt_u32 s67, 131072
  s_cbranch_scc1 Cf2_h1r
  s_branch Cf2_h1p
Cf2_last:
  s_waitcnt vmcnt(0) lgkmcnt(0)
  ds_read_b64 v[16:17], v77 offset:384
  v_mov_b64 v[18:19], v[72:73]
  s_add_u32 s68, s68, 131072
  s_waitcnt lgkmcnt(0)
  buffer_store_dwordx4 v[16:19], v76, s[8:11], s68 offen sc1
  s_waitcnt vmcnt(0)
  s_barrier
  s_branch L_cexit
L_w3:
  v_mov_b64 v[20:21], 0
  v_mov_b64 v[22:23], 0
  v_mov_b64 v[24:25], 0
  v_mov_b64 v[26:27], 0
  v_mov_b64 v[28:29], 0
  v_mov_b64 v[30:31], 0
  v_mov_b64 v[32:33], 0
  v_mov_b64 v[34:35], 0
  s_mov_b32 m0, 15872
  s_branch Cf3_h2
.p2align 6
Cf3_top:
  s_waitcnt lgkmcnt(0)
  s_barrier
  ds_read_b128 v[0:3], v76 offset:0
  ds_read_b128 v[4:7], v76 offset:1024
  buffer_load_dwordx4 v76, s[8:11], s64 offen offset:0 sc1 lds
  buffer_load_dwordx4 v76, s[8:11], s64 offen offset:1024 sc1 lds
  s_waitcnt lgkmcnt(1)
  v_smfmac_f32_16x16x64_bf16 v[20:23], v[0:3], v[60:67], v74
  ds_read_b128 v[60:63], v76 offset:47104
  v_smfmac_f32_16x16x64_bf16 v[24:27], v[0:3], v[44:51], v74
  s_mov_b32 m0, 15872
  ds_read_b128 v[64:67], v76 offset:48128
  s_waitcnt lgkmcnt(2)
  v_smfmac_f32_16x16x64_bf16 v[20:23], v[4:7], v[80:87], v74
  buffer_load_dwordx4 v[44:47], v76, s[8:11], s58 offen offset:0 sc1
  ds_read_b128 v[8:11], v76 offset:2048
  v_smfmac_f32_16x16x64_bf16 v[28:31], v[0:3], v[36:43], v74
  ds_read_b128 v[36:39], v76 offset:61440
  v_smfmac_f32_16x16x64_bf16 v[24:27], v[4:7], v[88:95], v74
  buffer_load_dwordx4 v[48:51], v76, s[8:11], s58 offen offset:1024 sc1
  ds_read_b128 v[40:43], v76 offset:62464
  v_smfmac_f32_16x16x64_bf16 v[28:31], v[4:7], v[208:215], v74
  ds_read_b128 v[12:15], v76 offset:3072
  v_smfmac_f32_16x16x64_bf16 v[32:35], v[4:7], v[216:223], v74
  buffer_load_dwordx4 v[52:55], v76, s[8:11], s59 offen offset:0 sc1
  s_waitcnt lgkmcnt(4)
  v_smfmac_f32_16x16x64_bf16 v[32:35], v[0:3], v[60:67], v74
  ds_read_b128 v[60:63], v76 offset:63488
  s_waitcnt lgkmcnt(4)
  v_smfmac_f32_16x16x64_bf16 v[20:23], v[8:11], v[96:103], v74
  buffer_load_dwordx4 v[56:59], v76, s[8:11], s59 offen offset:1024 sc1
  ds_read_b128 v[64:67], v76 offset:64512
  v_smfmac_f32_16x16x64_bf16 v[24:27], v[8:11], v[104:111], v74
  ds_read_b128 v[0:3], v76 offset:8192
  s_waitcnt lgkmcnt(4)
  v_smfmac_f32_16x16x64_bf16 v[28:31], v[8:11], v[36:43], v74
  ds_read_b128 v[36:39], v75 offset:12288
  s_waitcnt lgkmcnt(4)
  v_smfmac_f32_16x16x64_bf16 v[20:23], v[12:15], v[112:119], v74
  ds_read_b128 v[40:43], v75 offset:13312
  v_smfmac_f32_16x16x64_bf16 v[24:27], v[12:15], v[120:127], v74
  buffer_load_dword v73, s[8:11], s70 offen lds
  s_waitcnt lgkmcnt(3)
  v_smfmac_f32_16x16x64_bf16 v[32:35], v[8:11], v[60:67], v74
  ds_read_b128 v[60:63], v75 offset:14336
  v_smfmac_f32_16x16x64_bf16 v[28:31], v[12:15], v[224:231], v74
  s_waitcnt vmcnt(5)
  ds_read_b128 v[64:67], v75 offset:15360
  v_smfmac_f32_16x16x64_bf16 v[32:35], v[12:15], v[232:239], v74
  buffer_store_dwordx4 v[16:19], v76, s[8:11], s68 offen sc1
  s_barrier
  s_waitcnt lgkmcnt(4)
  v_smfmac_f32_16x16x64_bf16 v[20:23], v[0:3], v[192:199], v74
  ds_read_b128 v[4:7], v76 offset:4096
  s_waitcnt lgkmcnt(3)
  v_smfmac_f32_16x16x64_bf16 v[28:31], v[0:3], v[36:43], v74
  ds_read_b128 v[16:19], v76 offset:5120
  v_smfmac_f32_16x16x64_bf16 v[24:27], v[0:3], v[200:207], v74
  ds_read_b128 v[36:39], v75 offset:28672
  s_waitcnt lgkmcnt(3)
  v_mov_b32 v68, 0x3f803f80
  v_smfmac_f32_16x16x64_bf16 v[32:35], v[0:3], v[60:67], v74
  ds_read_b128 v[40:43], v75 offset:29696
  s_waitcnt lgkmcnt(3)
  v_smfmac_f32_16x16x64_bf16 v[20:23], v[4:7], v[128:135], v74
  ds_read_b128 v[12:15], v76 offset:6144
  v_mov_b32 v69, 0x3f803f80
  v_smfmac_f32_16x16x64_bf16 v[24:27], v[4:7], v[136:143], v74
  ds_read_b128 v[8:11], v76 offset:7168
  s_waitcnt lgkmcnt(4)
  v_smfmac_f32_16x16x64_bf16 v[20:23], v[16:19], v[144:151], v74
  ds_read_b128 v[60:63], v75 offset:30720
  v_mov_b64 v[70:71], v[68:69]
  v_smfmac_f32_16x16x64_bf16 v[24:27], v[16:19], v[152:159], v74
  ds_read_b128 v[64:67], v75 offset:31744
  s_waitcnt lgkmcnt(4)
  v_smfmac_f32_16x16x64_bf16 v[28:31], v[4:7], v[36:43], v74
  s_waitcnt lgkmcnt(3)
  v_mov_b64 v[36:37], 0
  v_smfmac_f32_16x16x64_bf16 v[20:23], v[12:15], v[160:167], v74
  s_waitcnt lgkmcnt(2)
  v_mov_b64 v[38:39], 0
  v_smfmac_f32_16x16x64_bf16 v[20:23], v[8:11], v[176:183], v74
  v_mov_b64 v[40:41], 0
  v_smfmac_f32_16x16x64_bf16 v[24:27], v[12:15], v[168:175], v74
  v_mov_b64 v[42:43], 0
  v_smfmac_f32_16x16x64_bf16 v[24:27], v[8:11], v[184:191], v74
  s_waitcnt lgkmcnt(0)
  v_add_f32 v20, v20, v22
  v_smfmac_f32_16x16x64_bf16 v[32:35], v[4:7], v[60:67], v74
  v_add_f32 v21, v21, v23
  v_smfmac_f32_16x16x64_bf16 v[28:31], v[16:19], v[240:247], v74
  v_add_f32 v24, v24, v26
  v_cvt_pk_bf16_f32 v22, v20, v24
  v_smfmac_f32_16x16x64_bf16 v[28:31], v[12:15], a[0:7], v74
  ds_write_b32 v79, v22 offset:0
  v_add_f32 v25, v25, v27
  v_cvt_pk_bf16_f32 v23, v21, v25
  v_smfmac_f32_16x16x64_bf16 v[28:31], v[8:11], a[16:23], v74
  ds_write_b32 v79, v23 offset:576
  v_cmp_u_f32 vcc, v20, v21
  v_smfmac_f32_16x16x64_bf16 v[32:35], v[16:19], v[248:255], v74
  v_smfmac_f32_16x16x64_bf16 v[32:35], v[12:15], a[8:15], v74
  v_add_f32 v28, v28, v30
  v_add_f32 v29, v29, v31
  v_smfmac_f32_16x16x64_bf16 v[32:35], v[8:11], a[24:31], v74
  s_cbranch_vccnz Cf3_rec
Cf3_recok:
  v_smfmac_f32_16x16x64_bf16 v[36:39], v[16:19], a[112:119], v74
  s_waitcnt lgkmcnt(0)
  s_barrier
  ds_read_b128 v[60:63], v77
  v_smfmac_f32_16x16x64_bf16 v[40:43], v[16:19], a[120:127], v74
  ds_read_b128 v[64:67], v77 offset:128
  v_add_f32 v32, v32, v34
  v_cvt_pk_bf16_f32 v30, v28, v32
  v_smfmac_f32_16x16x64_bf16 v[36:39], v[0:3], a[160:167], v74
  ds_write_b32 v79, v30 offset:256
  v_add_f32 v33, v33, v35
  v_cvt_pk_bf16_f32 v31, v29, v33
  v_smfmac_f32_16x16x64_bf16 v[40:43], v[0:3], a[168:175], v74
  ds_write_b32 v79, v31 offset:832
  v_xor_b32 v75, 0x8000, v75
  v_smfmac_f32_16x16x64_bf16 v[36:39], v[4:7], a[96:103], v74
  ds_read_b128 v[0:3], v76 offset:0
  v_mov_b32 v29, 0
  v_smfmac_f32_16x16x64_bf16 v[40:43], v[4:7], a[104:111], v74
  s_waitcnt vmcnt(4) lgkmcnt(3)
  v_mov_b32 v30, 0
  v_mfma_f32_16x16x32_bf16 v[44:47], v[44:47], v[60:63], 0
  ds_read_b128 v[4:7], v76 offset:1024
  s_waitcnt lgkmcnt(2)
  v_mfma_f32_16x16x32_bf16 v[44:47], v[48:51], v[64:67], v[44:47]
  s_barrier
  v_smfmac_f32_16x16x64_bf16 v[36:39], v[8:11], a[144:151], v74
  ds_read_b128 v[20:23], v77 offset:256
  ds_read_b128 v[24:27], v77 offset:384
  v_smfmac_f32_16x16x64_bf16 v[40:43], v[8:11], a[152:159], v74
  ds_read_b128 v[8:11], v76 offset:2048
  v_add_f32_dpp v72, v46, v44 quad_perm:[2,3,0,1] row_mask:0xf bank_mask:0xf
  v_add_f32_dpp v73, v47, v45 quad_perm:[2,3,0,1] row_mask:0xf bank_mask:0xf
  v_smfmac_f32_16x16x64_bf16 v[36:39], v[12:15], a[128:135], v74
  ds_read_b128 v[44:47], v75 offset:57344
  v_exp_f32_dpp v72, v72 quad_perm:[0,1,0,1] row_mask:0xf bank_mask:0xf
  v_smfmac_f32_16x16x64_bf16 v[40:43], v[12:15], a[136:143], v74
  ds_read_b128 v[12:15], v76 offset:3072
  s_waitcnt lgkmcnt(6)
  v_exp_f32_dpp v73, v73 quad_perm:[0,1,0,1] row_mask:0xf bank_mask:0xf
  v_smfmac_f32_16x16x64_bf16 v[36:39], v[0:3], a[32:39], v74
  s_waitcnt lgkmcnt(3)
  v_cvt_pk_bf16_f32 v72, v72, v73
  v_mfma_f32_16x16x32_bf16 v[20:23], v[20:23], v[60:63], 0
  ds_write_b32 v78, v72 offset:524
  v_mfma_f32_16x16x32_bf16 v[20:23], v[24:27], v[64:67], v[20:23]
  ds_read_b128 v[48:51], v75 offset:58368
  v_smfmac_f32_16x16x64_bf16 v[40:43], v[0:3], a[40:47], v74
  ds_read_b128 v[60:63], v75 offset:59392
  v_smfmac_f32_16x16x64_bf16 v[36:39], v[4:7], a[48:55], v74
  s_waitcnt lgkmcnt(5)
  v_add_f32_dpp v24, v22, v20 quad_perm:[2,3,0,1] row_mask:0xf bank_mask:0xf
  v_add_f32_dpp v25, v23, v21 quad_perm:[2,3,0,1] row_mask:0xf bank_mask:0xf
  v_smfmac_f32_16x16x64_bf16 v[36:39], v[8:11], a[64:71], v74
  s_waitcnt lgkmcnt(2)
  s_barrier
  ds_read_b128 v[32:35], v78 offset:512
  v_smfmac_f32_16x16x64_bf16 v[36:39], v[12:15], a[80:87], v74
  ds_read_b128 v[64:67], v75 offset:60416
  v_mul_f32 v24, s69, v24
  v_smfmac_f32_16x16x64_bf16 v[40:43], v[4:7], a[56:63], v74
  v_mul_f32 v25, s69, v25
  v_smfmac_f32_16x16x64_bf16 v[40:43], v[8:11], a[72:79], v74
  v_exp_f32_dpp v24, v24 quad_perm:[0,1,0,1] row_mask:0xf bank_mask:0xf
  v_smfmac_f32_16x16x64_bf16 v[40:43], v[12:15], a[88:95], v74
  s_waitcnt vmcnt(2) lgkmcnt(1)
  v_exp_f32_dpp v25, v25 quad_perm:[0,1,0,1] row_mask:0xf bank_mask:0xf
  v_mfma_f32_16x16x32_bf16 v[8:11], v[32:35], v[68:71], 0
  v_add_f32 v36, v36, v38
  v_add_f32 v37, v37, v39
  v_mfma_f32_16x16x32_bf16 v[0:3], v[32:35], v[52:55], 0
  v_add_f32 v40, v40, v42
  v_add_f32 v41, v41, v43
  v_mfma_f32_16x16x32_bf16 v[4:7], v[32:35], v[56:59], 0
  v_cvt_pk_bf16_f32 v28, v24, v25
  v_cvt_pk_bf16_f32 v72, v36, v37
  v_cvt_pk_bf16_f32 v73, v40, v41
  v_mfma_f32_16x16x16_bf16 v[8:11], v[28:29], v[68:69], v[8:11]
  v_cvt_pk_bf16_f32 v31, v24, v25
  v_mfma_f32_16x16x16_bf16 v[0:3], v[28:29], v[72:73], v[0:3]
  ds_read_b128 v[68:71], v76 offset:13824
  v_mfma_f32_16x16x16_bf16 v[4:7], v[30:31], v[72:73], v[4:7]
  v_rcp_f32 v10, v8
  v_rcp_f32 v11, v9
  v_mul_f32 v0, v10, v0
  v_mul_f32 v1, v11, v1
  s_nop 0
  v_mul_f32 v4, v10, v4
  v_mul_f32 v5, v11, v5
  v_cvt_pk_bf16_f32 v2, v0, v4
  ds_write_b32 v79, v2 offset:0
  v_cvt_pk_bf16_f32 v3, v1, v5
  ds_write_b32 v79, v3 offset:576
  v_mov_b64 v[16:17], 0
  v_mov_b64 v[18:19], 0
  v_mov_b64 v[20:21], 0
  v_mov_b64 v[22:23], 0
  v_mov_b64 v[24:25], 0
  v_mov_b64 v[26:27], 0
  v_mov_b64 v[28:29], 0
  v_mov_b64 v[30:31], 0
  v_mov_b64 v[32:33], 0
  v_mov_b64 v[34:35], 0
  s_waitcnt lgkmcnt(0)
  s_barrier
  ds_read_b128 v[0:3], v78 offset:0
  ds_read_b128 v[4:7], v78 offset:64
  ds_read_b128 v[8:11], v78 offset:128
  ds_read_b128 v[12:15], v78 offset:192
  s_cmp_eq_u32 s66, 63
  s_cbranch_scc1 Cf3_last
  s_waitcnt lgkmcnt(3)
  v_smfmac_f32_16x16x64_bf16 v[16:19], v[0:3], a[176:183], v74
  ds_read_b128 v[52:55], v75 offset:61440
  ds_read_b128 v[56:59], v75 offset:62464
  s_waitcnt lgkmcnt(4)
  v_smfmac_f32_16x16x64_bf16 v[16:19], v[4:7], a[184:191], v74
  ds_read_b128 v[36:39], v75 offset:63488
  s_waitcnt lgkmcnt(4)
  v_smfmac_f32_16x16x64_bf16 v[16:19], v[8:11], a[192:199], v74
  ds_read_b128 v[40:43], v75 offset:64512
  s_waitcnt lgkmcnt(4)
  v_smfmac_f32_16x16x64_bf16 v[16:19], v[12:15], a[200:207], v74
  v_smfmac_f32_16x16x64_bf16 v[32:35], v[0:3], v[44:51], v74
  ds_read_b128 v[44:47], v75 offset:12288
  ds_read_b128 v[48:51], v75 offset:13312
  v_smfmac_f32_16x16x64_bf16 v[32:35], v[4:7], v[60:67], v74
  ds_read_b128 v[60:63], v75 offset:14336
  s_waitcnt lgkmcnt(5)
  v_cvt_pk_bf16_f32 v16, v16, v17
  v_cvt_pk_bf16_f32 v17, v18, v19
  v_bfi_b32 v16, 1, s72, v16
  v_smfmac_f32_16x16x64_bf16 v[32:35], v[8:11], v[52:59], v74
  ds_read_b128 v[64:67], v75 offset:15360
  buffer_store_dwordx2 v[16:17], v68, s[8:11], s73 offen
  s_waitcnt lgkmcnt(4)
  v_smfmac_f32_16x16x64_bf16 v[32:35], v[12:15], v[36:43], v74
  ds_read_b128 v[52:55], v75 offset:28672
  v_smfmac_f32_16x16x64_bf16 v[20:23], v[0:3], a[208:215], v74
  ds_read_b128 v[56:59], v75 offset:29696
  v_smfmac_f32_16x16x64_bf16 v[20:23], v[4:7], a[216:223], v74
  ds_read_b128 v[36:39], v75 offset:30720
  s_waitcnt lgkmcnt(5)
  v_cvt_pk_bf16_f32 v32, v32, v33
  v_cvt_pk_bf16_f32 v33, v34, v35
  v_bfi_b32 v32, 1, s72, v32
  v_smfmac_f32_16x16x64_bf16 v[20:23], v[8:11], v[44:51], v74
  ds_read_b128 v[40:43], v75 offset:31744
  buffer_store_dwordx2 v[32:33], v68, s[8:11], s77 offen
  s_waitcnt lgkmcnt(4)
  v_mov_b64 v[18:19], v[72:73]
  v_smfmac_f32_16x16x64_bf16 v[20:23], v[12:15], v[60:67], v74
  ds_read_b128 v[44:47], v75 offset:45056
  v_mov_b64 v[32:33], 0
  v_smfmac_f32_16x16x64_bf16 v[24:27], v[0:3], a[224:231], v74
  ds_read_b128 v[48:51], v75 offset:46080
  v_mov_b64 v[34:35], 0
  v_smfmac_f32_16x16x64_bf16 v[24:27], v[4:7], a[232:239], v74
  ds_read_b128 v[60:63], v75 offset:47104
  s_waitcnt lgkmcnt(5)
  v_cvt_pk_bf16_f32 v20, v20, v21
  v_cvt_pk_bf16_f32 v21, v22, v23
  v_bfi_b32 v20, 1, s72, v20
  v_smfmac_f32_16x16x64_bf16 v[24:27], v[8:11], v[52:59], v74
  ds_read_b128 v[64:67], v75 offset:48128
  buffer_store_dwordx2 v[20:21], v68, s[8:11], s74 offen
  s_waitcnt lgkmcnt(4)
  v_smfmac_f32_16x16x64_bf16 v[24:27], v[12:15], v[36:43], v74
  ds_read_b64 v[16:17], v77 offset:392
  v_xor_b32 v75, 0x8000, v75
  v_smfmac_f32_16x16x64_bf16 v[28:31], v[0:3], a[240:247], v74
  v_smfmac_f32_16x16x64_bf16 v[28:31], v[4:7], a[248:255], v74
  s_waitcnt lgkmcnt(3)
  v_cvt_pk_bf16_f32 v24, v24, v25
  v_cvt_pk_bf16_f32 v25, v26, v27
  v_bfi_b32 v24, 1, s72, v24
  v_smfmac_f32_16x16x64_bf16 v[28:31], v[8:11], v[44:51], v74
  buffer_store_dwordx2 v[24:25], v68, s[8:11], s75 offen
  s_waitcnt lgkmcnt(1)
  v_smfmac_f32_16x16x64_bf16 v[28:31], v[12:15], v[60:67], v74
  ds_read_b128 v[0:3], v76 offset:14848
  s_nop 6
  v_cvt_pk_bf16_f32 v28, v28, v29
  v_cvt_pk_bf16_f32 v29, v30, v31
  v_bfi_b32 v28, 1, s72, v28
  buffer_store_dwordx2 v[28:29], v68, s[8:11], s76 offen
  v_mov_b64 v[20:21], 0
  v_mov_b64 v[22:23], 0
  v_mov_b64 v[24:25], 0
  v_mov_b64 v[26:27], 0
  v_mov_b64 v[28:29], 0
  v_mov_b64 v[30:31], 0
  s_add_u32 s58, s58, 524288
  s_add_u32 s59, s59, 524288
  s_add_u32 s70, s70, 524288
  s_add_u32 s68, s68, 131072
  s_add_u32 s66, s66, 1
  s_xor_b32 s64, s64, 16384
  s_xor_b32 s65, s65, 16384
  s_nop 15
  s_nop 15
  s_nop 15
  s_nop 7
  buffer_load_dwordx4 v[52:55], v76, s[8:11], s60 offen offset:0 sc1
  buffer_load_dwordx4 v[56:59], v76, s[8:11], s60 offen offset:1024 sc1
  s_nop 15
  s_nop 11
  buffer_load_dwordx4 v[36:39], v76, s[8:11], s60 offen offset:0 sc1
  buffer_load_dwordx4 v[40:43], v76, s[8:11], s60 offen offset:1024 sc1
  s_waitcnt vmcnt(3) lgkmcnt(0)
  v_mfma_f32_16x16x32_bf16 v[4:7], v[0:3], v[52:55], 0
  v_bitop3_b32 v72, v52, v54, s72 bitop3:0x7e
  s_waitcnt vmcnt(2)
  v_mfma_f32_16x16x32_bf16 v[4:7], v[0:3], v[56:59], v[4:7]
  v_bitop3_b32 v73, v56, v58, s72 bitop3:0x7e
  v_bitop3_b32 v72, v72, v73, 1 bitop3:0xa8
  v_cmp_ne_u32 vcc, 0, v72
  s_cbranch_vccnz Cf3_h1r
Cf3_h1p:
  s_nop 2
  v_add_f32_dpp v4, v4, v4 row_ror:4 row_mask:0xf bank_mask:0xf
  v_add_f32_dpp v5, v5, v5 row_ror:4 row_mask:0xf bank_mask:0xf
  s_nop 0
  v_add_f32_dpp v4, v4, v4 row_ror:8 row_mask:0xf bank_mask:0xf
  v_add_f32_dpp v5, v5, v5 row_ror:8 row_mask:0xf bank_mask:0xf
  v_cvt_pk_bf16_f32 v4, v4, v5
  buffer_store_dword v4, v69, s[8:11], s62 offen
Cf3_h1ok:
  s_xor_b32 s62, s62, 16384
  s_xor_b32 s72, s72, 1
Cf3_h2:
  v_lshlrev_b32 v73, 2, v76
  s_mov_b32 m0, 6144
  buffer_store_dword v71, v69, s[8:11], s62 offen
  s_waitcnt vmcnt(2)
  ds_read_b128 v[60:63], v76 offset:28672
  ds_read_b128 v[64:67], v76 offset:29696
  ds_read_b128 v[44:47], v76 offset:30720
  ds_read_b128 v[48:51], v76 offset:31744
  ds_read_b128 v[36:39], v76 offset:45056
  ds_read_b128 v[40:43], v76 offset:46080
  s_branch Cf3_top
Cf3_rec:
  s_nop 7
  s_waitcnt vmcnt(0) lgkmcnt(0)
  v_max3_u32 v72, v0, v1, v2
  v_max3_u32 v72, v72, v3, v4
  v_max3_u32 v72, v72, v5, v6
  v_max3_u32 v72, v72, v7, v8
  v_max3_u32 v72, v72, v9, v10
  v_max3_u32 v72, v72, v11, v12
  v_max3_u32 v72, v72, v13, v14
  v_max3_u32 v72, v72, v15, v16
  v_max3_u32 v72, v72, v17, v18
  v_max_u32 v72, v72, v19
  v_cmp_eq_u32 vcc, -1, v72
  s_cbranch_vccz Cf3_recok
  s_barrier
Cf3_recp:
  buffer_load_dwordx4 v[60:63], v76, s[8:11], s64 offen offset:0 sc1
  buffer_load_dwordx4 v[64:67], v76, s[8:11], s64 offen offset:1024 sc1
  s_add_u32 s67, s67, 1
  s_cmp_lt_u32 s67, 131072
  s_cselect_b32 s54, -2, -1
  s_waitcnt vmcnt(1)
  v_max3_u32 v72, v60, v61, v62
  s_waitcnt vmcnt(0)
  v_max3_u32 v72, v72, v63, v64
  v_max3_u32 v72, v72, v65, v66
  v_max_u32 v72, v72, v67
  v_cmp_lt_u32 vcc, s54, v72
  s_cbranch_vccnz Cf3_recp
  ds_write_b128 v76, v[60:63] offset:6144
  ds_write_b128 v76, v[64:67] offset:7168
  v_mov_b64 v[20:21], 0
  v_mov_b64 v[22:23], 0
  v_mov_b64 v[24:25], 0
  v_mov_b64 v[26:27], 0
  v_mov_b64 v[28:29], 0
  v_mov_b64 v[30:31], 0
  v_mov_b64 v[32:33], 0
  v_mov_b64 v[34:35], 0
  s_waitcnt lgkmcnt(0)
  s_barrier
  ds_read_b128 v[0:3], v76 offset:0
  ds_read_b128 v[60:63], v76 offset:28672
  ds_read_b128 v[64:67], v76 offset:29696
  s_waitcnt lgkmcnt(0)
  v_smfmac_f32_16x16x64_bf16 v[20:23], v[0:3], v[60:67], v74
  ds_read_b128 v[60:63], v76 offset:30720
  ds_read_b128 v[64:67], v76 offset:31744
  s_waitcnt lgkmcnt(0)
  v_smfmac_f32_16x16x64_bf16 v[24:27], v[0:3], v[60:67], v74
  ds_read_b128 v[60:63], v76 offset:45056
  ds_read_b128 v[64:67], v76 offset:46080
  s_waitcnt lgkmcnt(0)
  v_smfmac_f32_16x16x64_bf16 v[28:31], v[0:3], v[60:67], v74
  ds_read_b128 v[60:63], v76 offset:47104
  ds_read_b128 v[64:67], v76 offset:48128
  s_waitcnt lgkmcnt(0)
  v_smfmac_f32_16x16x64_bf16 v[32:35], v[0:3], v[60:67], v74
  ds_read_b128 v[4:7], v76 offset:1024
  s_waitcnt lgkmcnt(0)
  v_smfmac_f32_16x16x64_bf16 v[20:23], v[4:7], v[80:87], v74
  v_smfmac_f32_16x16x64_bf16 v[24:27], v[4:7], v[88:95], v74
  v_smfmac_f32_16x16x64_bf16 v[28:31], v[4:7], v[208:215], v74
  v_smfmac_f32_16x16x64_bf16 v[32:35], v[4:7], v[216:223], v74
  ds_read_b128 v[8:11], v76 offset:2048
  s_waitcnt lgkmcnt(0)
  v_smfmac_f32_16x16x64_bf16 v[20:23], v[8:11], v[96:103], v74
  v_smfmac_f32_16x16x64_bf16 v[24:27], v[8:11], v[104:111], v74
  ds_read_b128 v[60:63], v76 offset:61440
  ds_read_b128 v[64:67], v76 offset:62464
  s_waitcnt lgkmcnt(0)
  v_smfmac_f32_16x16x64_bf16 v[28:31], v[8:11], v[60:67], v74
  ds_read_b128 v[60:63], v76 offset:63488
  ds_read_b128 v[64:67], v76 offset:64512
  s_waitcnt lgkmcnt(0)
  v_smfmac_f32_16x16x64_bf16 v[32:35], v[8:11], v[60:67], v74
  ds_read_b128 v[12:15], v76 offset:3072
  s_waitcnt lgkmcnt(0)
  v_smfmac_f32_16x16x64_bf16 v[20:23], v[12:15], v[112:119], v74
  v_smfmac_f32_16x16x64_bf16 v[24:27], v[12:15], v[120:127], v74
  v_smfmac_f32_16x16x64_bf16 v[28:31], v[12:15], v[224:231], v74
  v_smfmac_f32_16x16x64_bf16 v[32:35], v[12:15], v[232:239], v74
  ds_read_b128 v[4:7], v76 offset:4096
  s_waitcnt lgkmcnt(0)
  v_smfmac_f32_16x16x64_bf16 v[20:23], v[4:7], v[128:135], v74
  v_smfmac_f32_16x16x64_bf16 v[24:27], v[4:7], v[136:143], v74
  ds_read_b128 v[60:63], v75 offset:28672
  ds_read_b128 v[64:67], v75 offset:29696
  s_waitcnt lgkmcnt(0)
  v_smfmac_f32_16x16x64_bf16 v[28:31], v[4:7], v[60:67], v74
  ds_read_b128 v[60:63], v75 offset:30720
  ds_read_b128 v[64:67], v75 offset:31744
  s_waitcnt lgkmcnt(0)
  v_smfmac_f32_16x16x64_bf16 v[32:35], v[4:7], v[60:67], v74
  ds_read_b128 v[16:19], v76 offset:5120
  s_waitcnt lgkmcnt(0)
  v_smfmac_f32_16x16x64_bf16 v[20:23], v[16:19], v[144:151], v74
  v_smfmac_f32_16x16x64_bf16 v[24:27], v[16:19], v[152:159], v74
  v_smfmac_f32_16x16x64_bf16 v[28:31], v[16:19], v[240:247], v74
  v_smfmac_f32_16x16x64_bf16 v[32:35], v[16:19], v[248:255], v74
  ds_read_b128 v[12:15], v76 offset:6144
  s_waitcnt lgkmcnt(0)
  v_smfmac_f32_16x16x64_bf16 v[20:23], v[12:15], v[160:167], v74
  v_smfmac_f32_16x16x64_bf16 v[24:27], v[12:15], v[168:175], v74
  v_smfmac_f32_16x16x64_bf16 v[28:31], v[12:15], a[0:7], v74
  v_smfmac_f32_16x16x64_bf16 v[32:35], v[12:15], a[8:15], v74
  ds_read_b128 v[8:11], v76 offset:7168
  s_waitcnt lgkmcnt(0)
  v_smfmac_f32_16x16x64_bf16 v[20:23], v[8:11], v[176:183], v74
  v_smfmac_f32_16x16x64_bf16 v[24:27], v[8:11], v[184:191], v74
  v_smfmac_f32_16x16x64_bf16 v[28:31], v[8:11], a[16:23], v74
  v_smfmac_f32_16x16x64_bf16 v[32:35], v[8:11], a[24:31], v74
  ds_read_b128 v[0:3], v76 offset:8192
  s_waitcnt lgkmcnt(0)
  v_smfmac_f32_16x16x64_bf16 v[20:23], v[0:3], v[192:199], v74
  v_smfmac_f32_16x16x64_bf16 v[24:27], v[0:3], v[200:207], v74
  ds_read_b128 v[60:63], v75 offset:12288
  ds_read_b128 v[64:67], v75 offset:13312
  s_waitcnt lgkmcnt(0)
  v_smfmac_f32_16x16x64_bf16 v[28:31], v[0:3], v[60:67], v74
  ds_read_b128 v[60:63], v75 offset:14336
  ds_read_b128 v[64:67], v75 offset:15360
  s_waitcnt lgkmcnt(0)
  v_smfmac_f32_16x16x64_bf16 v[32:35], v[0:3], v[60:67], v74
  v_add_f32 v20, v20, v22
  v_add_f32 v21, v21, v23
  v_add_f32 v24, v24, v26
  v_cvt_pk_bf16_f32 v22, v20, v24
  ds_write_b32 v79, v22 offset:0
  v_add_f32 v25, v25, v27
  v_cvt_pk_bf16_f32 v23, v21, v25
  ds_write_b32 v79, v23 offset:576
  v_add_f32 v28, v28, v30
  v_add_f32 v29, v29, v31
  s_waitcnt lgkmcnt(0)
  s_nop 1
  s_branch Cf3_recok
Cf3_h1r:
  s_mov_b64 exec, vcc
  buffer_load_dwordx4 v[52:55], v76, s[8:11], s60 offen offset:0 sc1
  buffer_load_dwordx4 v[56:59], v76, s[8:11], s60 offen offset:1024 sc1
  s_mov_b64 exec, -1
  s_add_u32 s67, s67, 1
  s_waitcnt vmcnt(3)
  v_mfma_f32_16x16x32_bf16 v[4:7], v[0:3], v[36:39], 0
  v_bitop3_b32 v72, v36, v38, s72 bitop3:0x7e
  s_waitcnt vmcnt(2)
  v_mfma_f32_16x16x32_bf16 v[4:7], v[0:3], v[40:43], v[4:7]
  v_bitop3_b32 v73, v40, v42, s72 bitop3:0x7e
  v_bitop3_b32 v72, v72, v73, 1 bitop3:0xa8
  v_cmp_ne_u32 vcc, 0, v72
  s_cbranch_vccz Cf3_h1p
  s_mov_b64 exec, vcc
  buffer_load_dwordx4 v[36:39], v76, s[8:11], s60 offen offset:0 sc1
  buffer_load_dwordx4 v[40:43], v76, s[8:11], s60 offen offset:1024 sc1
  s_mov_b64 exec, -1
  s_add_u32 s67, s67, 1
  s_waitcnt vmcnt(3)
  v_mfma_f32_16x16x32_bf16 v[4:7], v[0:3], v[52:55], 0
  v_bitop3_b32 v72, v52, v54, s72 bitop3:0x7e
  s_waitcnt vmcnt(2)
  v_mfma_f32_16x16x32_bf16 v[4:7], v[0:3], v[56:59], v[4:7]
  v_bitop3_b32 v73, v56, v58, s72 bitop3:0x7e
  v_bitop3_b32 v72, v72, v73, 1 bitop3:0xa8
  v_cmp_ne_u32 vcc, 0, v72
  s_cbranch_vccz Cf3_h1p
  s_cmp_lt_u32 s67, 131072
  s_cbranch_scc1 Cf3_h1r
  s_branch Cf3_h1p
Cf3_last:
  s_waitcnt vmcnt(0) lgkmcnt(0)
  ds_read_b64 v[16:17], v77 offset:392
  v_mov_b64 v[18:19], v[72:73]
  s_add_u32 s68, s68, 131072
  s_waitcnt lgkmcnt(0)
  buffer_store_dwordx4 v[16:19], v76, s[8:11], s68 offen sc1
  s_waitcnt vmcnt(0)
  s_barrier
  s_branch L_cexit
L_cexit:
L_exit:
L_end:
s_endpgm
.section .rodata,"a"
.p2align 6
.amdhsa_kernel gated_mix__sliding_local_dilated__memory_aug_recurrent_mem_tr__prompt_kernel
  .amdhsa_next_free_vgpr 512
  .amdhsa_next_free_sgpr 102
  .amdhsa_accum_offset 256
  .amdhsa_group_segment_fixed_size 0
  .amdhsa_kernarg_size 112
  .amdhsa_user_sgpr_count 2
  .amdhsa_user_sgpr_kernarg_segment_ptr 1
  .amdhsa_system_sgpr_workgroup_id_x 1
.end_amdhsa_kernel
```

```asm
; @launch grid=(256,1,1) block=(256,1,1) lds=163840
.amdgcn_target "amdgcn-amd-amdhsa--gfx950"
.text
.globl gated_mix__sliding_local_dilated__memory_aug_recurrent_mem_tr__prompt_kernel
.p2align 8
.type gated_mix__sliding_local_dilated__memory_aug_recurrent_mem_tr__prompt_kernel,@function
gated_mix__sliding_local_dilated__memory_aug_recurrent_mem_tr__prompt_kernel:
  s_cmp_ge_u32 s2, 256
  s_cbranch_scc1 L_end
  s_load_dwordx2 s[4:5], s[0:1], 0
  s_load_dwordx2 s[8:9], s[0:1], 104
  s_load_dwordx2 s[12:13], s[0:1], 96
  s_load_dwordx2 s[16:17], s[0:1], 40
  s_load_dwordx2 s[20:21], s[0:1], 48
  s_load_dwordx2 s[24:25], s[0:1], 56
  s_load_dwordx2 s[28:29], s[0:1], 64
  s_load_dwordx2 s[32:33], s[0:1], 32
  s_load_dwordx2 s[36:37], s[0:1], 8
  s_load_dwordx2 s[40:41], s[0:1], 16
  s_load_dwordx2 s[44:45], s[0:1], 80
  s_load_dwordx2 s[48:49], s[0:1], 88
  s_getreg_b32 s54, hwreg(HW_REG_XCC_ID, 0, 3)
  v_lshrrev_b32 v1, 6, v0
  s_nop 0
  v_readfirstlane_b32 s52, v1
  s_mov_b32 s6, 2359296
  s_mov_b32 s7, 0x20000
  s_mov_b32 s10, 268435456
  s_mov_b32 s11, 0x20000
  s_mov_b32 s14, 256
  s_mov_b32 s15, 0x20000
  s_mov_b32 s18, 4718592
  s_mov_b32 s19, 0x20000
  s_mov_b32 s22, 4718592
  s_mov_b32 s23, 0x20000
  s_mov_b32 s26, 4718592
  s_mov_b32 s27, 0x20000
  s_mov_b32 s30, 4718592
  s_mov_b32 s31, 0x20000
  s_mov_b32 s34, 9216
  s_mov_b32 s35, 0x20000
  s_mov_b32 s38, 1990656
  s_mov_b32 s39, 0x20000
  s_mov_b32 s42, 663552
  s_mov_b32 s43, 0x20000
  s_mov_b32 s46, 1152
  s_mov_b32 s47, 0x20000
  s_mov_b32 s50, 2359296
  s_mov_b32 s51, 0x20000
  s_waitcnt lgkmcnt(0)
  s_lshl_b32 s55, s54, 2
  s_cmp_eq_u32 s52, 0
  s_cselect_b32 s55, s55, 0x1000
  v_mov_b32 v1, s55
  v_mov_b32 v2, 1
  s_mov_b64 exec, 1
  buffer_atomic_add v2, v1, s[12:15], 0 offen sc0
  s_mov_b64 exec, -1
  s_sub_u32 s55, s54, 1
  s_lshl_b32 s55, s55, 5
  s_lshr_b32 s56, s2, 3
  s_add_u32 s55, s55, s56
  s_mul_i32 s55, s55, 21120
  s_cmp_eq_u32 s54, 0
  s_cselect_b32 s55, 0x10000000, s55
  v_lshlrev_b32 v3, 7, v0
  v_mov_b32 v4, 0x40000000
  v_cmp_lt_u32 vcc, 164, v0
  s_nop 1
  v_cndmask_b32 v3, v3, v4, vcc
  buffer_load_dword v192, v3, s[20:23], s55 offen
  buffer_load_dword v193, v3, s[24:27], s55 offen
  buffer_load_dword v194, v3, s[16:19], s55 offen
  buffer_load_dword v195, v3, s[28:31], s55 offen
  s_cmp_eq_u32 s52, 0
  s_cbranch_scc0 L_t1
  v_mov_b32 v1, 16320
  s_mov_b64 exec, 1
  s_waitcnt vmcnt(4)
  ds_write_b32 v1, v2
  s_mov_b64 exec, -1
  s_waitcnt lgkmcnt(0)
L_t1:
  s_barrier
  v_mov_b32 v1, 16320
  ds_read_b32 v5, v1
  s_waitcnt lgkmcnt(0)
  v_readfirstlane_b32 s53, v5
  s_barrier
  s_cmp_lt_u32 s53, 32
  s_cbranch_scc1 L_role
  s_mov_b32 s57, 0
L_sur:
  s_load_dwordx8 s[60:67], s[12:13], 0 glc
  s_add_u32 s57, s57, 1
  s_waitcnt lgkmcnt(0)
  s_mov_b32 s55, s60
  s_add_u32 s55, s55, s61
  s_add_u32 s55, s55, s62
  s_add_u32 s55, s55, s63
  s_add_u32 s55, s55, s64
  s_add_u32 s55, s55, s65
  s_add_u32 s55, s55, s66
  s_add_u32 s55, s55, s67
  s_cmp_ge_u32 s57, 131072
  s_cbranch_scc1 L_end
  s_cmp_lt_u32 s55, 256
  s_cbranch_scc1 L_sur
  s_sub_u32 s53, s53, 32
  s_sub_u32 s55, s60, 32
  s_max_i32 s55, s55, 0
  s_cmp_gt_u32 s54, 0
  s_cselect_b32 s55, s55, 0
  s_add_u32 s53, s53, s55
  s_sub_u32 s55, s61, 32
  s_max_i32 s55, s55, 0
  s_cmp_gt_u32 s54, 1
  s_cselect_b32 s55, s55, 0
  s_add_u32 s53, s53, s55
  s_sub_u32 s55, s62, 32
  s_max_i32 s55, s55, 0
  s_cmp_gt_u32 s54, 2
  s_cselect_b32 s55, s55, 0
  s_add_u32 s53, s53, s55
  s_sub_u32 s55, s63, 32
  s_max_i32 s55, s55, 0
  s_cmp_gt_u32 s54, 3
  s_cselect_b32 s55, s55, 0
  s_add_u32 s53, s53, s55
  s_sub_u32 s55, s64, 32
  s_max_i32 s55, s55, 0
  s_cmp_gt_u32 s54, 4
  s_cselect_b32 s55, s55, 0
  s_add_u32 s53, s53, s55
  s_sub_u32 s55, s65, 32
  s_max_i32 s55, s55, 0
  s_cmp_gt_u32 s54, 5
  s_cselect_b32 s55, s55, 0
  s_add_u32 s53, s53, s55
  s_sub_u32 s55, s66, 32
  s_max_i32 s55, s55, 0
  s_cmp_gt_u32 s54, 6
  s_cselect_b32 s55, s55, 0
  s_add_u32 s53, s53, s55
  s_min_u32 s55, s60, 32
  s_mov_b32 s54, 0
  s_add_u32 s53, s53, s55
  s_cmp_lt_u32 s53, 32
  s_cbranch_scc1 L_role
  s_sub_u32 s53, s53, 32
  s_min_u32 s55, s61, 32
  s_mov_b32 s54, 1
  s_add_u32 s53, s53, s55
  s_cmp_lt_u32 s53, 32
  s_cbranch_scc1 L_role
  s_sub_u32 s53, s53, 32
  s_min_u32 s55, s62, 32
  s_mov_b32 s54, 2
  s_add_u32 s53, s53, s55
  s_cmp_lt_u32 s53, 32
  s_cbranch_scc1 L_role
  s_sub_u32 s53, s53, 32
  s_min_u32 s55, s63, 32
  s_mov_b32 s54, 3
  s_add_u32 s53, s53, s55
  s_cmp_lt_u32 s53, 32
  s_cbranch_scc1 L_role
  s_sub_u32 s53, s53, 32
  s_min_u32 s55, s64, 32
  s_mov_b32 s54, 4
  s_add_u32 s53, s53, s55
  s_cmp_lt_u32 s53, 32
  s_cbranch_scc1 L_role
  s_sub_u32 s53, s53, 32
  s_min_u32 s55, s65, 32
  s_mov_b32 s54, 5
  s_add_u32 s53, s53, s55
  s_cmp_lt_u32 s53, 32
  s_cbranch_scc1 L_role
  s_sub_u32 s53, s53, 32
  s_min_u32 s55, s66, 32
  s_mov_b32 s54, 6
  s_add_u32 s53, s53, s55
  s_cmp_lt_u32 s53, 32
  s_cbranch_scc1 L_role
  s_sub_u32 s53, s53, 32
  s_min_u32 s55, s67, 32
  s_mov_b32 s54, 7
  s_add_u32 s53, s53, s55
  s_cmp_lt_u32 s53, 32
  s_cbranch_scc1 L_role
  s_sub_u32 s53, s53, 32
  s_branch L_end
L_role:
  s_cmp_eq_u32 s54, 0
  s_cbranch_scc1 L_chain
  s_sub_u32 s54, s54, 1
  s_lshl_b32 s54, s54, 5
  s_add_u32 s53, s53, s54
  v_and_b32 v200, 63, v0
  v_lshlrev_b32 v201, 4, v200
  v_lshrrev_b32 v211, 3, v200
  s_lshl_b32 s54, s52, 3
  v_add_u32 v211, s54, v211
  v_bfe_u32 v212, v211, 1, 3
  v_and_b32 v213, 7, v200
  v_xor_b32 v212, v212, v213
  v_mul_u32_u24 v211, 1152, v211
  v_lshl_add_u32 v202, v212, 4, v211
  s_mul_i32 s67, s52, 9216
  v_and_b32 v211, 31, v200
  v_lshrrev_b32 v212, 3, v211
  v_mul_u32_u24 v212, 9216, v212
  v_and_b32 v213, 7, v211
  v_lshl_add_u32 v212, v213, 7, v212
  v_bfe_u32 v213, v211, 1, 3
  v_lshrrev_b32 v214, 5, v200
  v_xor_b32 v213, v213, v214
  v_lshl_add_u32 v203, v213, 4, v212
  v_xor_b32 v204, 32, v203
  v_xor_b32 v205, 64, v203
  v_xor_b32 v206, 0x60, v203
  v_bfe_u32 v211, v200, 2, 2
  v_lshl_add_u32 v212, v214, 3, v211
  v_lshlrev_b32 v212, 8, v212
  v_xor_b32 v211, s52, v211
  v_lshl_add_u32 v212, v211, 6, v212
  v_bfe_u32 v213, v200, 4, 1
  v_and_b32 v211, 3, v200
  v_lshl_add_u32 v210, v213, 5, v212
  v_lshl_add_u32 v210, v211, 3, v210
  v_lshl_add_u32 v209, v213, 4, v212
  v_and_b32 v213, 1, v211
  v_lshl_add_u32 v209, v213, 3, v209
  v_lshrrev_b32 v213, 1, v211
  v_lshl_add_u32 v209, v213, 5, v209
  s_mov_b32 s65, 0
  s_mul_i32 s58, s53, 9363
  s_lshr_b32 s58, s58, 16
  s_mul_i32 s54, s58, 7
  s_sub_u32 s59, s53, s54
  s_mul_i32 s60, s59, 36864
  s_mul_i32 s55, s53, 21846
  s_lshr_b32 s55, s55, 16
  s_mul_i32 s56, s55, 3
  s_sub_u32 s56, s53, s56
  s_lshl_b32 s56, s56, 7
  s_lshl_b32 s55, s55, 2
  s_add_u32 s55, s55, s56
  s_add_u32 s55, s55, 105914368
  s_cmp_lt_u32 s53, 96
  s_cselect_b32 s71, s55, 268435456
  v_mov_b32 v211, 0
  s_mov_b64 exec, 1
  buffer_store_dword v211, v211, s[8:11], s71 offen sc1
  s_mov_b64 exec, -1
  s_add_u32 m0, s67, 0
  s_nop 0
  buffer_load_dwordx4 v202, s[4:7], s60 offen offset:0 lds
  s_add_u32 m0, s67, 896
  s_nop 0
  buffer_load_dwordx4 v202, s[4:7], s60 offen offset:128 lds
  s_add_u32 m0, s67, 1792
  s_nop 0
  buffer_load_dwordx4 v202, s[4:7], s60 offen offset:256 lds
  s_add_u32 m0, s67, 2688
  s_nop 0
  buffer_load_dwordx4 v202, s[4:7], s60 offen offset:384 lds
  s_add_u32 m0, s67, 3584
  s_nop 0
  buffer_load_dwordx4 v202, s[4:7], s60 offen offset:512 lds
  s_add_u32 m0, s67, 4480
  s_nop 0
  buffer_load_dwordx4 v202, s[4:7], s60 offen offset:640 lds
  s_add_u32 m0, s67, 5376
  s_nop 0
  buffer_load_dwordx4 v202, s[4:7], s60 offen offset:768 lds
  s_add_u32 m0, s67, 6272
  s_nop 0
  buffer_load_dwordx4 v202, s[4:7], s60 offen offset:896 lds
  s_add_u32 m0, s67, 7168
  s_nop 0
  buffer_load_dwordx4 v202, s[4:7], s60 offen offset:1024 lds
  v_lshrrev_b32 v211, 4, v200
  v_lshlrev_b32 v212, 2, v211
  v_and_b32 v213, 15, v200
  v_xor_b32 v212, v212, v213
  v_lshlrev_b32 v212, 4, v212
  v_lshl_add_u32 v207, v211, 13, v212
  s_lshl_b32 s62, s58, 8
  s_lshl_b32 s54, s52, 15
  s_add_u32 s62, s62, s54
  v_bfe_u32 v211, v200, 3, 2
  v_lshlrev_b32 v216, 11, v211
  v_bfe_u32 v211, v200, 1, 2
  v_lshl_add_u32 v216, v211, 6, v216
  v_lshrrev_b32 v212, 5, v200
  v_lshl_add_u32 v216, v212, 5, v216
  v_and_b32 v211, 1, v200
  v_lshl_add_u32 v216, v211, 4, v216
  v_bfe_u32 v211, v200, 4, 1
  v_lshlrev_b32 v217, 10, v211
  v_lshl_add_u32 v217, v212, 9, v217
  v_and_b32 v211, 15, v200
  v_lshl_add_u32 v217, v211, 4, v217
  s_lshl_b32 s54, s52, 11
  s_add_u32 s54, s54, 8192
  v_add_u32 v217, s54, v217
  s_lshl_b32 s61, s52, 10
  s_add_u32 s61, s61, 36864
  s_add_u32 m0, s61, 0
  s_add_u32 s54, s62, 0
  buffer_load_dwordx4 v207, s[20:23], s54 offen lds
  s_add_u32 m0, s61, 4096
  s_add_u32 s54, s62, 131072
  buffer_load_dwordx4 v207, s[20:23], s54 offen lds
  s_add_u32 m0, s61, 8192
  s_add_u32 s54, s62, 262144
  buffer_load_dwordx4 v207, s[20:23], s54 offen lds
  s_add_u32 m0, s61, 12288
  s_add_u32 s54, s62, 393216
  buffer_load_dwordx4 v207, s[20:23], s54 offen lds
  s_add_u32 m0, s61, 16384
  s_add_u32 s54, s62, 0
  buffer_load_dwordx4 v207, s[24:27], s54 offen lds
  s_add_u32 m0, s61, 20480
  s_add_u32 s54, s62, 131072
  buffer_load_dwordx4 v207, s[24:27], s54 offen lds
  s_add_u32 m0, s61, 24576
  s_add_u32 s54, s62, 262144
  buffer_load_dwordx4 v207, s[24:27], s54 offen lds
  s_add_u32 m0, s61, 28672
  s_add_u32 s54, s62, 393216
  buffer_load_dwordx4 v207, s[24:27], s54 offen lds
  s_add_u32 m0, s61, 32768
  s_add_u32 s54, s62, 524288
  buffer_load_dwordx4 v207, s[20:23], s54 offen lds
  s_add_u32 m0, s61, 36864
  s_add_u32 s54, s62, 655360
  buffer_load_dwordx4 v207, s[20:23], s54 offen lds
  s_add_u32 m0, s61, 40960
  s_add_u32 s54, s62, 786432
  buffer_load_dwordx4 v207, s[20:23], s54 offen lds
  s_add_u32 m0, s61, 45056
  s_add_u32 s54, s62, 917504
  buffer_load_dwordx4 v207, s[20:23], s54 offen lds
  s_add_u32 m0, s61, 49152
  s_add_u32 s54, s62, 524288
  buffer_load_dwordx4 v207, s[24:27], s54 offen lds
  s_add_u32 m0, s61, 53248
  s_add_u32 s54, s62, 655360
  buffer_load_dwordx4 v207, s[24:27], s54 offen lds
  s_add_u32 m0, s61, 57344
  s_add_u32 s54, s62, 786432
  buffer_load_dwordx4 v207, s[24:27], s54 offen lds
  s_add_u32 m0, s61, 61440
  s_add_u32 s54, s62, 917504
  buffer_load_dwordx4 v207, s[24:27], s54 offen lds
  s_add_u32 m0, s61, 65536
  s_add_u32 s54, s62, 1048576
  buffer_load_dwordx4 v207, s[20:23], s54 offen lds
  s_add_u32 m0, s61, 69632
  s_add_u32 s54, s62, 1179648
  buffer_load_dwordx4 v207, s[20:23], s54 offen lds
  s_add_u32 m0, s61, 73728
  s_add_u32 s54, s62, 1310720
  buffer_load_dwordx4 v207, s[20:23], s54 offen lds
  s_add_u32 m0, s61, 77824
  s_add_u32 s54, s62, 1441792
  buffer_load_dwordx4 v207, s[20:23], s54 offen lds
  s_add_u32 m0, s61, 81920
  s_add_u32 s54, s62, 1048576
  buffer_load_dwordx4 v207, s[24:27], s54 offen lds
  s_add_u32 m0, s61, 86016
  s_add_u32 s54, s62, 1179648
  buffer_load_dwordx4 v207, s[24:27], s54 offen lds
  s_add_u32 m0, s61, 90112
  s_add_u32 s54, s62, 1310720
  buffer_load_dwordx4 v207, s[24:27], s54 offen lds
  s_add_u32 m0, s61, 94208
  s_add_u32 s54, s62, 1441792
  buffer_load_dwordx4 v207, s[24:27], s54 offen lds
  s_waitcnt vmcnt(20) lgkmcnt(0)
  s_barrier
  s_add_u32 m0, s61, 98304
  s_add_u32 s54, s62, 1572864
  buffer_load_dwordx4 v207, s[20:23], s54 offen lds
  s_add_u32 m0, s61, 102400
  s_add_u32 s54, s62, 1703936
  buffer_load_dwordx4 v207, s[20:23], s54 offen lds
  s_add_u32 m0, s61, 106496
  s_add_u32 s54, s62, 1835008
  buffer_load_dwordx4 v207, s[20:23], s54 offen lds
  s_add_u32 m0, s61, 110592
  s_add_u32 s54, s62, 1966080
  buffer_load_dwordx4 v207, s[20:23], s54 offen lds
  v_add_u32 v215, 36864, v209
  ds_read_b64_tr_b16 a[0:1], v215 offset:0
  ds_read_b64_tr_b16 a[2:3], v215 offset:1024
  ds_read_b64_tr_b16 a[4:5], v215 offset:4096
  ds_read_b64_tr_b16 a[6:7], v215 offset:5120
  ds_read_b64_tr_b16 a[8:9], v215 offset:8192
  ds_read_b64_tr_b16 a[10:11], v215 offset:9216
  ds_read_b64_tr_b16 a[12:13], v215 offset:12288
  ds_read_b64_tr_b16 a[14:15], v215 offset:13312
  s_waitcnt vmcnt(20) lgkmcnt(0)
  s_barrier
  s_add_u32 m0, s61, 0
  s_add_u32 s54, s62, 1572864
  buffer_load_dwordx4 v207, s[24:27], s54 offen lds
  s_add_u32 m0, s61, 4096
  s_add_u32 s54, s62, 1703936
  buffer_load_dwordx4 v207, s[24:27], s54 offen lds
  s_add_u32 m0, s61, 8192
  s_add_u32 s54, s62, 1835008
  buffer_load_dwordx4 v207, s[24:27], s54 offen lds
  s_add_u32 m0, s61, 12288
  s_add_u32 s54, s62, 1966080
  buffer_load_dwordx4 v207, s[24:27], s54 offen lds
  v_add_u32 v215, 53248, v210
  ds_read_b64_tr_b16 a[144:145], v215 offset:0
  ds_read_b64_tr_b16 a[146:147], v215 offset:1024
  ds_read_b64_tr_b16 a[148:149], v215 offset:4096
  ds_read_b64_tr_b16 a[150:151], v215 offset:5120
  ds_read_b64_tr_b16 a[152:153], v215 offset:8192
  ds_read_b64_tr_b16 a[154:155], v215 offset:9216
  ds_read_b64_tr_b16 a[156:157], v215 offset:12288
  ds_read_b64_tr_b16 a[158:159], v215 offset:13312
  s_waitcnt vmcnt(20) lgkmcnt(0)
  s_barrier
  s_add_u32 m0, s61, 16384
  s_add_u32 s54, s62, 2097152
  buffer_load_dwordx4 v207, s[20:23], s54 offen lds
  s_add_u32 m0, s61, 20480
  s_add_u32 s54, s62, 2228224
  buffer_load_dwordx4 v207, s[20:23], s54 offen lds
  s_add_u32 m0, s61, 24576
  s_add_u32 s54, s62, 2359296
  buffer_load_dwordx4 v207, s[20:23], s54 offen lds
  s_add_u32 m0, s61, 28672
  s_add_u32 s54, s62, 2490368
  buffer_load_dwordx4 v207, s[20:23], s54 offen lds
  v_add_u32 v215, 69632, v209
  ds_read_b64_tr_b16 a[16:17], v215 offset:0
  ds_read_b64_tr_b16 a[18:19], v215 offset:1024
  ds_read_b64_tr_b16 a[20:21], v215 offset:4096
  ds_read_b64_tr_b16 a[22:23], v215 offset:5120
  ds_read_b64_tr_b16 a[24:25], v215 offset:8192
  ds_read_b64_tr_b16 a[26:27], v215 offset:9216
  ds_read_b64_tr_b16 a[28:29], v215 offset:12288
  ds_read_b64_tr_b16 a[30:31], v215 offset:13312
  s_waitcnt vmcnt(20) lgkmcnt(0)
  s_barrier
  s_add_u32 m0, s61, 32768
  s_add_u32 s54, s62, 2097152
  buffer_load_dwordx4 v207, s[24:27], s54 offen lds
  s_add_u32 m0, s61, 36864
  s_add_u32 s54, s62, 2228224
  buffer_load_dwordx4 v207, s[24:27], s54 offen lds
  s_add_u32 m0, s61, 40960
  s_add_u32 s54, s62, 2359296
  buffer_load_dwordx4 v207, s[24:27], s54 offen lds
  s_add_u32 m0, s61, 45056
  s_add_u32 s54, s62, 2490368
  buffer_load_dwordx4 v207, s[24:27], s54 offen lds
  v_add_u32 v215, 86016, v210
  ds_read_b64_tr_b16 a[160:161], v215 offset:0
  ds_read_b64_tr_b16 a[162:163], v215 offset:1024
  ds_read_b64_tr_b16 a[164:165], v215 offset:4096
  ds_read_b64_tr_b16 a[166:167], v215 offset:5120
  ds_read_b64_tr_b16 a[168:169], v215 offset:8192
  ds_read_b64_tr_b16 a[170:171], v215 offset:9216
  ds_read_b64_tr_b16 a[172:173], v215 offset:12288
  ds_read_b64_tr_b16 a[174:175], v215 offset:13312
  s_waitcnt vmcnt(20) lgkmcnt(0)
  s_barrier
  s_add_u32 m0, s61, 49152
  s_add_u32 s54, s62, 2621440
  buffer_load_dwordx4 v207, s[20:23], s54 offen lds
  s_add_u32 m0, s61, 53248
  s_add_u32 s54, s62, 2752512
  buffer_load_dwordx4 v207, s[20:23], s54 offen lds
  s_add_u32 m0, s61, 57344
  s_add_u32 s54, s62, 2883584
  buffer_load_dwordx4 v207, s[20:23], s54 offen lds
  s_add_u32 m0, s61, 61440
  s_add_u32 s54, s62, 3014656
  buffer_load_dwordx4 v207, s[20:23], s54 offen lds
  v_add_u32 v215, 102400, v209
  ds_read_b64_tr_b16 a[32:33], v215 offset:0
  ds_read_b64_tr_b16 a[34:35], v215 offset:1024
  ds_read_b64_tr_b16 a[36:37], v215 offset:4096
  ds_read_b64_tr_b16 a[38:39], v215 offset:5120
  ds_read_b64_tr_b16 a[40:41], v215 offset:8192
  ds_read_b64_tr_b16 a[42:43], v215 offset:9216
  ds_read_b64_tr_b16 a[44:45], v215 offset:12288
  ds_read_b64_tr_b16 a[46:47], v215 offset:13312
  s_waitcnt vmcnt(20) lgkmcnt(0)
  s_barrier
  s_add_u32 m0, s61, 65536
  s_add_u32 s54, s62, 2621440
  buffer_load_dwordx4 v207, s[24:27], s54 offen lds
  s_add_u32 m0, s61, 69632
  s_add_u32 s54, s62, 2752512
  buffer_load_dwordx4 v207, s[24:27], s54 offen lds
  s_add_u32 m0, s61, 73728
  s_add_u32 s54, s62, 2883584
  buffer_load_dwordx4 v207, s[24:27], s54 offen lds
  s_add_u32 m0, s61, 77824
  s_add_u32 s54, s62, 3014656
  buffer_load_dwordx4 v207, s[24:27], s54 offen lds
  v_add_u32 v215, 118784, v210
  ds_read_b64_tr_b16 a[176:177], v215 offset:0
  ds_read_b64_tr_b16 a[178:179], v215 offset:1024
  ds_read_b64_tr_b16 a[180:181], v215 offset:4096
  ds_read_b64_tr_b16 a[182:183], v215 offset:5120
  ds_read_b64_tr_b16 a[184:185], v215 offset:8192
  ds_read_b64_tr_b16 a[186:187], v215 offset:9216
  ds_read_b64_tr_b16 a[188:189], v215 offset:12288
  ds_read_b64_tr_b16 a[190:191], v215 offset:13312
  s_waitcnt vmcnt(20) lgkmcnt(0)
  s_barrier
  s_add_u32 m0, s61, 81920
  s_add_u32 s54, s62, 3145728
  buffer_load_dwordx4 v207, s[20:23], s54 offen lds
  s_add_u32 m0, s61, 86016
  s_add_u32 s54, s62, 3276800
  buffer_load_dwordx4 v207, s[20:23], s54 offen lds
  s_add_u32 m0, s61, 90112
  s_add_u32 s54, s62, 3407872
  buffer_load_dwordx4 v207, s[20:23], s54 offen lds
  s_add_u32 m0, s61, 94208
  s_add_u32 s54, s62, 3538944
  buffer_load_dwordx4 v207, s[20:23], s54 offen lds
  v_add_u32 v215, 135168, v209
  ds_read_b64_tr_b16 a[48:49], v215 offset:0
  ds_read_b64_tr_b16 a[50:51], v215 offset:1024
  ds_read_b64_tr_b16 a[52:53], v215 offset:4096
  ds_read_b64_tr_b16 a[54:55], v215 offset:5120
  ds_read_b64_tr_b16 a[56:57], v215 offset:8192
  ds_read_b64_tr_b16 a[58:59], v215 offset:9216
  ds_read_b64_tr_b16 a[60:61], v215 offset:12288
  ds_read_b64_tr_b16 a[62:63], v215 offset:13312
  s_waitcnt vmcnt(20) lgkmcnt(0)
  s_barrier
  s_add_u32 m0, s61, 98304
  s_add_u32 s54, s62, 3145728
  buffer_load_dwordx4 v207, s[24:27], s54 offen lds
  s_add_u32 m0, s61, 102400
  s_add_u32 s54, s62, 3276800
  buffer_load_dwordx4 v207, s[24:27], s54 offen lds
  s_add_u32 m0, s61, 106496
  s_add_u32 s54, s62, 3407872
  buffer_load_dwordx4 v207, s[24:27], s54 offen lds
  s_add_u32 m0, s61, 110592
  s_add_u32 s54, s62, 3538944
  buffer_load_dwordx4 v207, s[24:27], s54 offen lds
  v_add_u32 v215, 36864, v210
  ds_read_b64_tr_b16 a[192:193], v215 offset:0
  ds_read_b64_tr_b16 a[194:195], v215 offset:1024
  ds_read_b64_tr_b16 a[196:197], v215 offset:4096
  ds_read_b64_tr_b16 a[198:199], v215 offset:5120
  ds_read_b64_tr_b16 a[200:201], v215 offset:8192
  ds_read_b64_tr_b16 a[202:203], v215 offset:9216
  ds_read_b64_tr_b16 a[204:205], v215 offset:12288
  ds_read_b64_tr_b16 a[206:207], v215 offset:13312
  s_waitcnt vmcnt(20) lgkmcnt(0)
  s_barrier
  s_add_u32 m0, s61, 0
  s_add_u32 s54, s62, 3670016
  buffer_load_dwordx4 v207, s[20:23], s54 offen lds
  s_add_u32 m0, s61, 4096
  s_add_u32 s54, s62, 3801088
  buffer_load_dwordx4 v207, s[20:23], s54 offen lds
  s_add_u32 m0, s61, 8192
  s_add_u32 s54, s62, 3932160
  buffer_load_dwordx4 v207, s[20:23], s54 offen lds
  s_add_u32 m0, s61, 12288
  s_add_u32 s54, s62, 4063232
  buffer_load_dwordx4 v207, s[20:23], s54 offen lds
  v_add_u32 v215, 53248, v209
  ds_read_b64_tr_b16 a[64:65], v215 offset:0
  ds_read_b64_tr_b16 a[66:67], v215 offset:1024
  ds_read_b64_tr_b16 a[68:69], v215 offset:4096
  ds_read_b64_tr_b16 a[70:71], v215 offset:5120
  ds_read_b64_tr_b16 a[72:73], v215 offset:8192
  ds_read_b64_tr_b16 a[74:75], v215 offset:9216
  ds_read_b64_tr_b16 a[76:77], v215 offset:12288
  ds_read_b64_tr_b16 a[78:79], v215 offset:13312
  s_waitcnt vmcnt(20) lgkmcnt(0)
  s_barrier
  s_add_u32 m0, s61, 16384
  s_add_u32 s54, s62, 3670016
  buffer_load_dwordx4 v207, s[24:27], s54 offen lds
  s_add_u32 m0, s61, 20480
  s_add_u32 s54, s62, 3801088
  buffer_load_dwordx4 v207, s[24:27], s54 offen lds
  s_add_u32 m0, s61, 24576
  s_add_u32 s54, s62, 3932160
  buffer_load_dwordx4 v207, s[24:27], s54 offen lds
  s_add_u32 m0, s61, 28672
  s_add_u32 s54, s62, 4063232
  buffer_load_dwordx4 v207, s[24:27], s54 offen lds
  v_add_u32 v215, 69632, v210
  ds_read_b64_tr_b16 a[208:209], v215 offset:0
  ds_read_b64_tr_b16 a[210:211], v215 offset:1024
  ds_read_b64_tr_b16 a[212:213], v215 offset:4096
  ds_read_b64_tr_b16 a[214:215], v215 offset:5120
  ds_read_b64_tr_b16 a[216:217], v215 offset:8192
  ds_read_b64_tr_b16 a[218:219], v215 offset:9216
  ds_read_b64_tr_b16 a[220:221], v215 offset:12288
  ds_read_b64_tr_b16 a[222:223], v215 offset:13312
  s_waitcnt vmcnt(20) lgkmcnt(0)
  s_barrier
  s_add_u32 m0, s61, 32768
  s_add_u32 s54, s62, 4194304
  buffer_load_dwordx4 v207, s[20:23], s54 offen lds
  s_add_u32 m0, s61, 36864
  s_add_u32 s54, s62, 4325376
  buffer_load_dwordx4 v207, s[20:23], s54 offen lds
  s_add_u32 m0, s61, 40960
  s_add_u32 s54, s62, 4456448
  buffer_load_dwordx4 v207, s[20:23], s54 offen lds
  s_add_u32 m0, s61, 45056
  s_add_u32 s54, s62, 4587520
  buffer_load_dwordx4 v207, s[20:23], s54 offen lds
  v_add_u32 v215, 86016, v209
  ds_read_b64_tr_b16 a[80:81], v215 offset:0
  ds_read_b64_tr_b16 a[82:83], v215 offset:1024
  ds_read_b64_tr_b16 a[84:85], v215 offset:4096
  ds_read_b64_tr_b16 a[86:87], v215 offset:5120
  ds_read_b64_tr_b16 a[88:89], v215 offset:8192
  ds_read_b64_tr_b16 a[90:91], v215 offset:9216
  ds_read_b64_tr_b16 a[92:93], v215 offset:12288
  ds_read_b64_tr_b16 a[94:95], v215 offset:13312
  s_waitcnt vmcnt(20) lgkmcnt(0)
  s_barrier
  s_add_u32 m0, s61, 49152
  s_add_u32 s54, s62, 4194304
  buffer_load_dwordx4 v207, s[24:27], s54 offen lds
  s_add_u32 m0, s61, 53248
  s_add_u32 s54, s62, 4325376
  buffer_load_dwordx4 v207, s[24:27], s54 offen lds
  s_add_u32 m0, s61, 57344
  s_add_u32 s54, s62, 4456448
  buffer_load_dwordx4 v207, s[24:27], s54 offen lds
  s_add_u32 m0, s61, 61440
  s_add_u32 s54, s62, 4587520
  buffer_load_dwordx4 v207, s[24:27], s54 offen lds
  v_add_u32 v215, 102400, v210
  ds_read_b64_tr_b16 a[224:225], v215 offset:0
  ds_read_b64_tr_b16 a[226:227], v215 offset:1024
  ds_read_b64_tr_b16 a[228:229], v215 offset:4096
  ds_read_b64_tr_b16 a[230:231], v215 offset:5120
  ds_read_b64_tr_b16 a[232:233], v215 offset:8192
  ds_read_b64_tr_b16 a[234:235], v215 offset:9216
  ds_read_b64_tr_b16 a[236:237], v215 offset:12288
  ds_read_b64_tr_b16 a[238:239], v215 offset:13312
  s_waitcnt vmcnt(20) lgkmcnt(0)
  s_barrier
  v_add_u32 v215, 118784, v209
  ds_read_b64_tr_b16 a[96:97], v215 offset:0
  ds_read_b64_tr_b16 a[98:99], v215 offset:1024
  ds_read_b64_tr_b16 a[100:101], v215 offset:4096
  ds_read_b64_tr_b16 a[102:103], v215 offset:5120
  ds_read_b64_tr_b16 a[104:105], v215 offset:8192
  ds_read_b64_tr_b16 a[106:107], v215 offset:9216
  ds_read_b64_tr_b16 a[108:109], v215 offset:12288
  ds_read_b64_tr_b16 a[110:111], v215 offset:13312
  s_waitcnt vmcnt(16) lgkmcnt(0)
  s_barrier
  v_add_u32 v215, 135168, v210
  ds_read_b64_tr_b16 a[240:241], v215 offset:0
  ds_read_b64_tr_b16 a[242:243], v215 offset:1024
  ds_read_b64_tr_b16 a[244:245], v215 offset:4096
  ds_read_b64_tr_b16 a[246:247], v215 offset:5120
  ds_read_b64_tr_b16 a[248:249], v215 offset:8192
  ds_read_b64_tr_b16 a[250:251], v215 offset:9216
  ds_read_b64_tr_b16 a[252:253], v215 offset:12288
  ds_read_b64_tr_b16 a[254:255], v215 offset:13312
  s_waitcnt vmcnt(12) lgkmcnt(0)
  s_barrier
  v_add_u32 v215, 36864, v209
  ds_read_b64_tr_b16 a[112:113], v215 offset:0
  ds_read_b64_tr_b16 a[114:115], v215 offset:1024
  ds_read_b64_tr_b16 a[116:117], v215 offset:4096
  ds_read_b64_tr_b16 a[118:119], v215 offset:5120
  ds_read_b64_tr_b16 a[120:121], v215 offset:8192
  ds_read_b64_tr_b16 a[122:123], v215 offset:9216
  ds_read_b64_tr_b16 a[124:125], v215 offset:12288
  ds_read_b64_tr_b16 a[126:127], v215 offset:13312
  s_waitcnt vmcnt(8) lgkmcnt(0)
  s_barrier
  v_add_u32 v215, 53248, v210
  ds_read_b64_tr_b16 v[224:225], v215 offset:0
  ds_read_b64_tr_b16 v[226:227], v215 offset:1024
  ds_read_b64_tr_b16 v[228:229], v215 offset:4096
  ds_read_b64_tr_b16 v[230:231], v215 offset:5120
  ds_read_b64_tr_b16 v[232:233], v215 offset:8192
  ds_read_b64_tr_b16 v[234:235], v215 offset:9216
  ds_read_b64_tr_b16 v[236:237], v215 offset:12288
  ds_read_b64_tr_b16 v[238:239], v215 offset:13312
  s_waitcnt vmcnt(4) lgkmcnt(0)
  s_barrier
  v_add_u32 v215, 69632, v209
  ds_read_b64_tr_b16 a[128:129], v215 offset:0
  ds_read_b64_tr_b16 a[130:131], v215 offset:1024
  ds_read_b64_tr_b16 a[132:133], v215 offset:4096
  ds_read_b64_tr_b16 a[134:135], v215 offset:5120
  ds_read_b64_tr_b16 a[136:137], v215 offset:8192
  ds_read_b64_tr_b16 a[138:139], v215 offset:9216
  ds_read_b64_tr_b16 a[140:141], v215 offset:12288
  ds_read_b64_tr_b16 a[142:143], v215 offset:13312
  s_waitcnt vmcnt(0) lgkmcnt(0)
  s_barrier
  v_add_u32 v215, 86016, v210
  ds_read_b64_tr_b16 v[240:241], v215 offset:0
  ds_read_b64_tr_b16 v[242:243], v215 offset:1024
  ds_read_b64_tr_b16 v[244:245], v215 offset:4096
  ds_read_b64_tr_b16 v[246:247], v215 offset:5120
  ds_read_b64_tr_b16 v[248:249], v215 offset:8192
  ds_read_b64_tr_b16 v[250:251], v215 offset:9216
  ds_read_b64_tr_b16 v[252:253], v215 offset:12288
  ds_read_b64_tr_b16 v[254:255], v215 offset:13312
  s_waitcnt lgkmcnt(0)
  s_barrier
  s_mov_b32 s68, 1040356334
  s_lshl_b32 s69, s52, 9
  s_lshl_b32 s70, s58, 2
  s_add_u32 s70, s70, 128
KV_loop:
  s_add_u32 s60, s60, 258048
  s_add_u32 m0, s67, 36864
  s_nop 0
  buffer_load_dwordx4 v202, s[4:7], s60 offen offset:0 lds
  s_add_u32 m0, s67, 37760
  s_nop 0
  buffer_load_dwordx4 v202, s[4:7], s60 offen offset:128 lds
  s_add_u32 m0, s67, 38656
  s_nop 0
  buffer_load_dwordx4 v202, s[4:7], s60 offen offset:256 lds
  s_add_u32 m0, s67, 39552
  s_nop 0
  buffer_load_dwordx4 v202, s[4:7], s60 offen offset:384 lds
  s_add_u32 m0, s67, 40448
  s_nop 0
  buffer_load_dwordx4 v202, s[4:7], s60 offen offset:512 lds
  s_add_u32 m0, s67, 41344
  s_nop 0
  buffer_load_dwordx4 v202, s[4:7], s60 offen offset:640 lds
  s_add_u32 m0, s67, 42240
  s_nop 0
  buffer_load_dwordx4 v202, s[4:7], s60 offen offset:768 lds
  s_add_u32 m0, s67, 43136
  s_nop 0
  buffer_load_dwordx4 v202, s[4:7], s60 offen offset:896 lds
  s_add_u32 m0, s67, 44032
  s_nop 0
  buffer_load_dwordx4 v202, s[4:7], s60 offen offset:1024 lds
  ds_read_b128 v[32:35], v203 offset:0
  ds_read_b128 v[36:39], v204 offset:0
  ds_read_b128 v[40:43], v205 offset:0
  s_waitcnt lgkmcnt(2)
  v_mfma_f32_32x32x16_bf16 v[0:15], a[0:3], v[32:35], 0
  ds_read_b128 v[44:47], v206 offset:0
  v_mfma_f32_32x32x16_bf16 v[16:31], v[32:35], a[144:147], 0
  s_waitcnt lgkmcnt(2)
  v_mfma_f32_32x32x16_bf16 v[0:15], a[4:7], v[36:39], v[0:15]
  ds_read_b128 v[32:35], v203 offset:1024
  v_mfma_f32_32x32x16_bf16 v[16:31], v[36:39], a[148:151], v[16:31]
  s_waitcnt lgkmcnt(2)
  v_mfma_f32_32x32x16_bf16 v[0:15], a[8:11], v[40:43], v[0:15]
  ds_read_b128 v[36:39], v204 offset:1024
  v_mfma_f32_32x32x16_bf16 v[16:31], v[40:43], a[152:155], v[16:31]
  s_waitcnt lgkmcnt(2)
  v_mfma_f32_32x32x16_bf16 v[0:15], a[12:15], v[44:47], v[0:15]
  ds_read_b128 v[40:43], v205 offset:1024
  v_mfma_f32_32x32x16_bf16 v[16:31], v[44:47], a[156:159], v[16:31]
  s_waitcnt lgkmcnt(2)
  v_mfma_f32_32x32x16_bf16 v[0:15], a[16:19], v[32:35], v[0:15]
  ds_read_b128 v[44:47], v206 offset:1024
  v_mfma_f32_32x32x16_bf16 v[16:31], v[32:35], a[160:163], v[16:31]
  s_waitcnt lgkmcnt(2)
  v_mfma_f32_32x32x16_bf16 v[0:15], a[20:23], v[36:39], v[0:15]
  ds_read_b128 v[32:35], v203 offset:2048
  v_mfma_f32_32x32x16_bf16 v[16:31], v[36:39], a[164:167], v[16:31]
  s_waitcnt lgkmcnt(2)
  v_mfma_f32_32x32x16_bf16 v[0:15], a[24:27], v[40:43], v[0:15]
  ds_read_b128 v[36:39], v204 offset:2048
  v_mfma_f32_32x32x16_bf16 v[16:31], v[40:43], a[168:171], v[16:31]
  s_waitcnt lgkmcnt(2)
  v_mfma_f32_32x32x16_bf16 v[0:15], a[28:31], v[44:47], v[0:15]
  ds_read_b128 v[40:43], v205 offset:2048
  v_mfma_f32_32x32x16_bf16 v[16:31], v[44:47], a[172:175], v[16:31]
  s_waitcnt lgkmcnt(2)
  v_mfma_f32_32x32x16_bf16 v[0:15], a[32:35], v[32:35], v[0:15]
  ds_read_b128 v[44:47], v206 offset:2048
  v_mfma_f32_32x32x16_bf16 v[16:31], v[32:35], a[176:179], v[16:31]
  s_waitcnt lgkmcnt(2)
  v_mfma_f32_32x32x16_bf16 v[0:15], a[36:39], v[36:39], v[0:15]
  ds_read_b128 v[32:35], v203 offset:3072
  v_mfma_f32_32x32x16_bf16 v[16:31], v[36:39], a[180:183], v[16:31]
  s_waitcnt lgkmcnt(2)
  v_mfma_f32_32x32x16_bf16 v[0:15], a[40:43], v[40:43], v[0:15]
  ds_read_b128 v[36:39], v204 offset:3072
  v_mfma_f32_32x32x16_bf16 v[16:31], v[40:43], a[184:187], v[16:31]
  s_waitcnt lgkmcnt(2)
  v_mfma_f32_32x32x16_bf16 v[0:15], a[44:47], v[44:47], v[0:15]
  ds_read_b128 v[40:43], v205 offset:3072
  v_mfma_f32_32x32x16_bf16 v[16:31], v[44:47], a[188:191], v[16:31]
  s_waitcnt lgkmcnt(2)
  v_mfma_f32_32x32x16_bf16 v[0:15], a[48:51], v[32:35], v[0:15]
  ds_read_b128 v[44:47], v206 offset:3072
  v_mfma_f32_32x32x16_bf16 v[16:31], v[32:35], a[192:195], v[16:31]
  s_waitcnt lgkmcnt(2)
  v_mfma_f32_32x32x16_bf16 v[0:15], a[52:55], v[36:39], v[0:15]
  ds_read_b128 v[32:35], v203 offset:4096
  v_mfma_f32_32x32x16_bf16 v[16:31], v[36:39], a[196:199], v[16:31]
  s_waitcnt lgkmcnt(2)
  v_mfma_f32_32x32x16_bf16 v[0:15], a[56:59], v[40:43], v[0:15]
  ds_read_b128 v[36:39], v204 offset:4096
  v_mfma_f32_32x32x16_bf16 v[16:31], v[40:43], a[200:203], v[16:31]
  s_waitcnt lgkmcnt(2)
  v_mfma_f32_32x32x16_bf16 v[0:15], a[60:63], v[44:47], v[0:15]
  ds_read_b128 v[40:43], v205 offset:4096
  v_mfma_f32_32x32x16_bf16 v[16:31], v[44:47], a[204:207], v[16:31]
  s_waitcnt lgkmcnt(2)
  v_mfma_f32_32x32x16_bf16 v[0:15], a[64:67], v[32:35], v[0:15]
  ds_read_b128 v[44:47], v206 offset:4096
  v_mfma_f32_32x32x16_bf16 v[16:31], v[32:35], a[208:211], v[16:31]
  s_waitcnt lgkmcnt(2)
  v_mfma_f32_32x32x16_bf16 v[0:15], a[68:71], v[36:39], v[0:15]
  ds_read_b128 v[32:35], v203 offset:5120
  v_mfma_f32_32x32x16_bf16 v[16:31], v[36:39], a[212:215], v[16:31]
  s_waitcnt lgkmcnt(2)
  v_mfma_f32_32x32x16_bf16 v[0:15], a[72:75], v[40:43], v[0:15]
  ds_read_b128 v[36:39], v204 offset:5120
  v_mfma_f32_32x32x16_bf16 v[16:31], v[40:43], a[216:219], v[16:31]
  s_waitcnt lgkmcnt(2)
  v_mfma_f32_32x32x16_bf16 v[0:15], a[76:79], v[44:47], v[0:15]
  ds_read_b128 v[40:43], v205 offset:5120
  v_mfma_f32_32x32x16_bf16 v[16:31], v[44:47], a[220:223], v[16:31]
  s_waitcnt lgkmcnt(2)
  v_mfma_f32_32x32x16_bf16 v[0:15], a[80:83], v[32:35], v[0:15]
  ds_read_b128 v[44:47], v206 offset:5120
  v_mfma_f32_32x32x16_bf16 v[16:31], v[32:35], a[224:227], v[16:31]
  s_waitcnt lgkmcnt(2)
  v_mfma_f32_32x32x16_bf16 v[0:15], a[84:87], v[36:39], v[0:15]
  ds_read_b128 v[32:35], v203 offset:6144
  v_mfma_f32_32x32x16_bf16 v[16:31], v[36:39], a[228:231], v[16:31]
  s_waitcnt lgkmcnt(2)
  v_mfma_f32_32x32x16_bf16 v[0:15], a[88:91], v[40:43], v[0:15]
  ds_read_b128 v[36:39], v204 offset:6144
  v_mfma_f32_32x32x16_bf16 v[16:31], v[40:43], a[232:235], v[16:31]
  s_waitcnt lgkmcnt(2)
  v_mfma_f32_32x32x16_bf16 v[0:15], a[92:95], v[44:47], v[0:15]
  ds_read_b128 v[40:43], v205 offset:6144
  v_mfma_f32_32x32x16_bf16 v[16:31], v[44:47], a[236:239], v[16:31]
  s_waitcnt lgkmcnt(2)
  v_mfma_f32_32x32x16_bf16 v[0:15], a[96:99], v[32:35], v[0:15]
  ds_read_b128 v[44:47], v206 offset:6144
  v_mfma_f32_32x32x16_bf16 v[16:31], v[32:35], a[240:243], v[16:31]
  s_waitcnt lgkmcnt(2)
  v_mfma_f32_32x32x16_bf16 v[0:15], a[100:103], v[36:39], v[0:15]
  ds_read_b128 v[32:35], v203 offset:7168
  v_mfma_f32_32x32x16_bf16 v[16:31], v[36:39], a[244:247], v[16:31]
  s_waitcnt lgkmcnt(2)
  v_mfma_f32_32x32x16_bf16 v[0:15], a[104:107], v[40:43], v[0:15]
  ds_read_b128 v[36:39], v204 offset:7168
  v_mfma_f32_32x32x16_bf16 v[16:31], v[40:43], a[248:251], v[16:31]
  s_waitcnt lgkmcnt(2)
  v_mfma_f32_32x32x16_bf16 v[0:15], a[108:111], v[44:47], v[0:15]
  ds_read_b128 v[40:43], v205 offset:7168
  v_mfma_f32_32x32x16_bf16 v[16:31], v[44:47], a[252:255], v[16:31]
  s_waitcnt lgkmcnt(2)
  v_mfma_f32_32x32x16_bf16 v[0:15], a[112:115], v[32:35], v[0:15]
  ds_read_b128 v[44:47], v206 offset:7168
  v_mfma_f32_32x32x16_bf16 v[16:31], v[32:35], v[224:227], v[16:31]
  s_waitcnt lgkmcnt(2)
  v_mfma_f32_32x32x16_bf16 v[0:15], a[116:119], v[36:39], v[0:15]
  ds_read_b128 v[32:35], v203 offset:8192
  v_mfma_f32_32x32x16_bf16 v[16:31], v[36:39], v[228:231], v[16:31]
  s_waitcnt lgkmcnt(2)
  v_mfma_f32_32x32x16_bf16 v[0:15], a[120:123], v[40:43], v[0:15]
  ds_read_b128 v[36:39], v204 offset:8192
  v_mfma_f32_32x32x16_bf16 v[16:31], v[40:43], v[232:235], v[16:31]
  s_waitcnt lgkmcnt(2)
  v_mfma_f32_32x32x16_bf16 v[0:15], a[124:127], v[44:47], v[0:15]
  ds_read_b128 v[40:43], v205 offset:8192
  v_mfma_f32_32x32x16_bf16 v[16:31], v[44:47], v[236:239], v[16:31]
  s_waitcnt lgkmcnt(2)
  v_mfma_f32_32x32x16_bf16 v[0:15], a[128:131], v[32:35], v[0:15]
  ds_read_b128 v[44:47], v206 offset:8192
  v_mfma_f32_32x32x16_bf16 v[16:31], v[32:35], v[240:243], v[16:31]
  s_waitcnt lgkmcnt(2)
  v_mfma_f32_32x32x16_bf16 v[0:15], a[132:135], v[36:39], v[0:15]
  v_mfma_f32_32x32x16_bf16 v[16:31], v[36:39], v[244:247], v[16:31]
  s_waitcnt lgkmcnt(1)
  v_mfma_f32_32x32x16_bf16 v[0:15], a[136:139], v[40:43], v[0:15]
  v_mfma_f32_32x32x16_bf16 v[16:31], v[40:43], v[248:251], v[16:31]
  s_waitcnt lgkmcnt(0)
  v_mfma_f32_32x32x16_bf16 v[0:15], a[140:143], v[44:47], v[0:15]
  v_mfma_f32_32x32x16_bf16 v[16:31], v[44:47], v[252:255], v[16:31]
  s_lshl_b32 s64, s59, 5
  s_add_u32 s64, s64, s58
  s_lshl_b32 s64, s64, 14
  s_add_u32 s55, s64, s69
  v_mul_f32 v0, s68, v0
  v_mul_f32 v1, s68, v1
  v_mul_f32 v2, s68, v2
  v_mul_f32 v3, s68, v3
  v_mul_f32 v4, s68, v4
  v_mul_f32 v5, s68, v5
  v_mul_f32 v6, s68, v6
  v_mul_f32 v7, s68, v7
  v_mul_f32 v8, s68, v8
  v_mul_f32 v9, s68, v9
  v_mul_f32 v10, s68, v10
  v_mul_f32 v11, s68, v11
  v_mul_f32 v12, s68, v12
  v_mul_f32 v13, s68, v13
  v_mul_f32 v14, s68, v14
  v_mul_f32 v15, s68, v15
  v_cvt_pk_bf16_f32 v48, v0, v4
  v_cvt_pk_bf16_f32 v49, v1, v5
  v_cvt_pk_bf16_f32 v50, v2, v6
  v_cvt_pk_bf16_f32 v51, v3, v7
  buffer_store_dwordx4 v[48:51], v216, s[8:11], s55 offen offset:0 sc1
  v_cvt_pk_bf16_f32 v52, v8, v12
  v_cvt_pk_bf16_f32 v53, v9, v13
  v_cvt_pk_bf16_f32 v54, v10, v14
  v_cvt_pk_bf16_f32 v55, v11, v15
  buffer_store_dwordx4 v[52:55], v216, s[8:11], s55 offen offset:256 sc1
  v_cvt_pk_bf16_f32 v56, v16, v17
  v_cvt_pk_bf16_f32 v57, v20, v21
  v_cvt_pk_bf16_f32 v58, v24, v25
  v_cvt_pk_bf16_f32 v59, v28, v29
  buffer_store_dwordx4 v[56:59], v217, s[8:11], s64 offen offset:0 sc1
  v_cvt_pk_bf16_f32 v60, v18, v19
  v_cvt_pk_bf16_f32 v61, v22, v23
  v_cvt_pk_bf16_f32 v62, v26, v27
  v_cvt_pk_bf16_f32 v63, v30, v31
  buffer_store_dwordx4 v[60:63], v217, s[8:11], s64 offen offset:256 sc1
  s_add_u32 s59, s59, 7
  s_cmp_ge_u32 s59, 64
  s_cbranch_scc1 KV_done
  s_waitcnt vmcnt(4)
  s_barrier
  s_add_u32 s60, s60, 258048
  s_add_u32 m0, s67, 0
  s_nop 0
  buffer_load_dwordx4 v202, s[4:7], s60 offen offset:0 lds
  s_add_u32 m0, s67, 896
  s_nop 0
  buffer_load_dwordx4 v202, s[4:7], s60 offen offset:128 lds
  s_add_u32 m0, s67, 1792
  s_nop 0
  buffer_load_dwordx4 v202, s[4:7], s60 offen offset:256 lds
  s_add_u32 m0, s67, 2688
  s_nop 0
  buffer_load_dwordx4 v202, s[4:7], s60 offen offset:384 lds
  s_add_u32 m0, s67, 3584
  s_nop 0
  buffer_load_dwordx4 v202, s[4:7], s60 offen offset:512 lds
  s_add_u32 m0, s67, 4480
  s_nop 0
  buffer_load_dwordx4 v202, s[4:7], s60 offen offset:640 lds
  s_add_u32 m0, s67, 5376
  s_nop 0
  buffer_load_dwordx4 v202, s[4:7], s60 offen offset:768 lds
  s_add_u32 m0, s67, 6272
  s_nop 0
  buffer_load_dwordx4 v202, s[4:7], s60 offen offset:896 lds
  s_add_u32 m0, s67, 7168
  s_nop 0
  buffer_load_dwordx4 v202, s[4:7], s60 offen offset:1024 lds
  ds_read_b128 v[32:35], v203 offset:36864
  ds_read_b128 v[36:39], v204 offset:36864
  ds_read_b128 v[40:43], v205 offset:36864
  s_waitcnt lgkmcnt(2)
  v_mfma_f32_32x32x16_bf16 v[0:15], a[0:3], v[32:35], 0
  ds_read_b128 v[44:47], v206 offset:36864
  v_mfma_f32_32x32x16_bf16 v[16:31], v[32:35], a[144:147], 0
  s_waitcnt lgkmcnt(2)
  v_mfma_f32_32x32x16_bf16 v[0:15], a[4:7], v[36:39], v[0:15]
  ds_read_b128 v[32:35], v203 offset:37888
  v_mfma_f32_32x32x16_bf16 v[16:31], v[36:39], a[148:151], v[16:31]
  s_waitcnt lgkmcnt(2)
  v_mfma_f32_32x32x16_bf16 v[0:15], a[8:11], v[40:43], v[0:15]
  ds_read_b128 v[36:39], v204 offset:37888
  v_mfma_f32_32x32x16_bf16 v[16:31], v[40:43], a[152:155], v[16:31]
  s_waitcnt lgkmcnt(2)
  v_mfma_f32_32x32x16_bf16 v[0:15], a[12:15], v[44:47], v[0:15]
  ds_read_b128 v[40:43], v205 offset:37888
  v_mfma_f32_32x32x16_bf16 v[16:31], v[44:47], a[156:159], v[16:31]
  s_waitcnt lgkmcnt(2)
  v_mfma_f32_32x32x16_bf16 v[0:15], a[16:19], v[32:35], v[0:15]
  ds_read_b128 v[44:47], v206 offset:37888
  v_mfma_f32_32x32x16_bf16 v[16:31], v[32:35], a[160:163], v[16:31]
  s_waitcnt lgkmcnt(2)
  v_mfma_f32_32x32x16_bf16 v[0:15], a[20:23], v[36:39], v[0:15]
  ds_read_b128 v[32:35], v203 offset:38912
  v_mfma_f32_32x32x16_bf16 v[16:31], v[36:39], a[164:167], v[16:31]
  s_waitcnt lgkmcnt(2)
  v_mfma_f32_32x32x16_bf16 v[0:15], a[24:27], v[40:43], v[0:15]
  ds_read_b128 v[36:39], v204 offset:38912
  v_mfma_f32_32x32x16_bf16 v[16:31], v[40:43], a[168:171], v[16:31]
  s_waitcnt lgkmcnt(2)
  v_mfma_f32_32x32x16_bf16 v[0:15], a[28:31], v[44:47], v[0:15]
  ds_read_b128 v[40:43], v205 offset:38912
  v_mfma_f32_32x32x16_bf16 v[16:31], v[44:47], a[172:175], v[16:31]
  s_waitcnt lgkmcnt(2)
  v_mfma_f32_32x32x16_bf16 v[0:15], a[32:35], v[32:35], v[0:15]
  ds_read_b128 v[44:47], v206 offset:38912
  v_mfma_f32_32x32x16_bf16 v[16:31], v[32:35], a[176:179], v[16:31]
  s_waitcnt lgkmcnt(2)
  v_mfma_f32_32x32x16_bf16 v[0:15], a[36:39], v[36:39], v[0:15]
  ds_read_b128 v[32:35], v203 offset:39936
  v_mfma_f32_32x32x16_bf16 v[16:31], v[36:39], a[180:183], v[16:31]
  s_waitcnt lgkmcnt(2)
  v_mfma_f32_32x32x16_bf16 v[0:15], a[40:43], v[40:43], v[0:15]
  ds_read_b128 v[36:39], v204 offset:39936
  v_mfma_f32_32x32x16_bf16 v[16:31], v[40:43], a[184:187], v[16:31]
  s_waitcnt lgkmcnt(2)
  v_mfma_f32_32x32x16_bf16 v[0:15], a[44:47], v[44:47], v[0:15]
  ds_read_b128 v[40:43], v205 offset:39936
  v_mfma_f32_32x32x16_bf16 v[16:31], v[44:47], a[188:191], v[16:31]
  s_waitcnt lgkmcnt(2)
  v_mfma_f32_32x32x16_bf16 v[0:15], a[48:51], v[32:35], v[0:15]
  ds_read_b128 v[44:47], v206 offset:39936
  v_mfma_f32_32x32x16_bf16 v[16:31], v[32:35], a[192:195], v[16:31]
  s_waitcnt lgkmcnt(2)
  v_mfma_f32_32x32x16_bf16 v[0:15], a[52:55], v[36:39], v[0:15]
  ds_read_b128 v[32:35], v203 offset:40960
  v_mfma_f32_32x32x16_bf16 v[16:31], v[36:39], a[196:199], v[16:31]
  s_waitcnt lgkmcnt(2)
  v_mfma_f32_32x32x16_bf16 v[0:15], a[56:59], v[40:43], v[0:15]
  ds_read_b128 v[36:39], v204 offset:40960
  v_mfma_f32_32x32x16_bf16 v[16:31], v[40:43], a[200:203], v[16:31]
  s_waitcnt lgkmcnt(2)
  v_mfma_f32_32x32x16_bf16 v[0:15], a[60:63], v[44:47], v[0:15]
  ds_read_b128 v[40:43], v205 offset:40960
  v_mfma_f32_32x32x16_bf16 v[16:31], v[44:47], a[204:207], v[16:31]
  s_waitcnt lgkmcnt(2)
  v_mfma_f32_32x32x16_bf16 v[0:15], a[64:67], v[32:35], v[0:15]
  ds_read_b128 v[44:47], v206 offset:40960
  v_mfma_f32_32x32x16_bf16 v[16:31], v[32:35], a[208:211], v[16:31]
  s_waitcnt lgkmcnt(2)
  v_mfma_f32_32x32x16_bf16 v[0:15], a[68:71], v[36:39], v[0:15]
  ds_read_b128 v[32:35], v203 offset:41984
  v_mfma_f32_32x32x16_bf16 v[16:31], v[36:39], a[212:215], v[16:31]
  s_waitcnt lgkmcnt(2)
  v_mfma_f32_32x32x16_bf16 v[0:15], a[72:75], v[40:43], v[0:15]
  ds_read_b128 v[36:39], v204 offset:41984
  v_mfma_f32_32x32x16_bf16 v[16:31], v[40:43], a[216:219], v[16:31]
  s_waitcnt lgkmcnt(2)
  v_mfma_f32_32x32x16_bf16 v[0:15], a[76:79], v[44:47], v[0:15]
  ds_read_b128 v[40:43], v205 offset:41984
  v_mfma_f32_32x32x16_bf16 v[16:31], v[44:47], a[220:223], v[16:31]
  s_waitcnt lgkmcnt(2)
  v_mfma_f32_32x32x16_bf16 v[0:15], a[80:83], v[32:35], v[0:15]
  ds_read_b128 v[44:47], v206 offset:41984
  v_mfma_f32_32x32x16_bf16 v[16:31], v[32:35], a[224:227], v[16:31]
  s_waitcnt lgkmcnt(2)
  v_mfma_f32_32x32x16_bf16 v[0:15], a[84:87], v[36:39], v[0:15]
  ds_read_b128 v[32:35], v203 offset:43008
  v_mfma_f32_32x32x16_bf16 v[16:31], v[36:39], a[228:231], v[16:31]
  s_waitcnt lgkmcnt(2)
  v_mfma_f32_32x32x16_bf16 v[0:15], a[88:91], v[40:43], v[0:15]
  ds_read_b128 v[36:39], v204 offset:43008
  v_mfma_f32_32x32x16_bf16 v[16:31], v[40:43], a[232:235], v[16:31]
  s_waitcnt lgkmcnt(2)
  v_mfma_f32_32x32x16_bf16 v[0:15], a[92:95], v[44:47], v[0:15]
  ds_read_b128 v[40:43], v205 offset:43008
  v_mfma_f32_32x32x16_bf16 v[16:31], v[44:47], a[236:239], v[16:31]
  s_waitcnt lgkmcnt(2)
  v_mfma_f32_32x32x16_bf16 v[0:15], a[96:99], v[32:35], v[0:15]
  ds_read_b128 v[44:47], v206 offset:43008
  v_mfma_f32_32x32x16_bf16 v[16:31], v[32:35], a[240:243], v[16:31]
  s_waitcnt lgkmcnt(2)
  v_mfma_f32_32x32x16_bf16 v[0:15], a[100:103], v[36:39], v[0:15]
  ds_read_b128 v[32:35], v203 offset:44032
  v_mfma_f32_32x32x16_bf16 v[16:31], v[36:39], a[244:247], v[16:31]
  s_waitcnt lgkmcnt(2)
  v_mfma_f32_32x32x16_bf16 v[0:15], a[104:107], v[40:43], v[0:15]
  ds_read_b128 v[36:39], v204 offset:44032
  v_mfma_f32_32x32x16_bf16 v[16:31], v[40:43], a[248:251], v[16:31]
  s_waitcnt lgkmcnt(2)
  v_mfma_f32_32x32x16_bf16 v[0:15], a[108:111], v[44:47], v[0:15]
  ds_read_b128 v[40:43], v205 offset:44032
  v_mfma_f32_32x32x16_bf16 v[16:31], v[44:47], a[252:255], v[16:31]
  s_waitcnt lgkmcnt(2)
  v_mfma_f32_32x32x16_bf16 v[0:15], a[112:115], v[32:35], v[0:15]
  ds_read_b128 v[44:47], v206 offset:44032
  v_mfma_f32_32x32x16_bf16 v[16:31], v[32:35], v[224:227], v[16:31]
  s_waitcnt lgkmcnt(2)
  v_mfma_f32_32x32x16_bf16 v[0:15], a[116:119], v[36:39], v[0:15]
  ds_read_b128 v[32:35], v203 offset:45056
  v_mfma_f32_32x32x16_bf16 v[16:31], v[36:39], v[228:231], v[16:31]
  s_waitcnt lgkmcnt(2)
  v_mfma_f32_32x32x16_bf16 v[0:15], a[120:123], v[40:43], v[0:15]
  ds_read_b128 v[36:39], v204 offset:45056
  v_mfma_f32_32x32x16_bf16 v[16:31], v[40:43], v[232:235], v[16:31]
  s_waitcnt lgkmcnt(2)
  v_mfma_f32_32x32x16_bf16 v[0:15], a[124:127], v[44:47], v[0:15]
  ds_read_b128 v[40:43], v205 offset:45056
  v_mfma_f32_32x32x16_bf16 v[16:31], v[44:47], v[236:239], v[16:31]
  s_waitcnt lgkmcnt(2)
  v_mfma_f32_32x32x16_bf16 v[0:15], a[128:131], v[32:35], v[0:15]
  ds_read_b128 v[44:47], v206 offset:45056
  v_mfma_f32_32x32x16_bf16 v[16:31], v[32:35], v[240:243], v[16:31]
  s_waitcnt lgkmcnt(2)
  v_mfma_f32_32x32x16_bf16 v[0:15], a[132:135], v[36:39], v[0:15]
  v_mfma_f32_32x32x16_bf16 v[16:31], v[36:39], v[244:247], v[16:31]
  s_waitcnt lgkmcnt(1)
  v_mfma_f32_32x32x16_bf16 v[0:15], a[136:139], v[40:43], v[0:15]
  v_mfma_f32_32x32x16_bf16 v[16:31], v[40:43], v[248:251], v[16:31]
  s_waitcnt lgkmcnt(0)
  v_mfma_f32_32x32x16_bf16 v[0:15], a[140:143], v[44:47], v[0:15]
  v_mfma_f32_32x32x16_bf16 v[16:31], v[44:47], v[252:255], v[16:31]
  s_lshl_b32 s64, s59, 5
  s_add_u32 s64, s64, s58
  s_lshl_b32 s64, s64, 14
  s_add_u32 s55, s64, s69
  v_mul_f32 v0, s68, v0
  v_mul_f32 v1, s68, v1
  v_mul_f32 v2, s68, v2
  v_mul_f32 v3, s68, v3
  v_mul_f32 v4, s68, v4
  v_mul_f32 v5, s68, v5
  v_mul_f32 v6, s68, v6
  v_mul_f32 v7, s68, v7
  v_mul_f32 v8, s68, v8
  v_mul_f32 v9, s68, v9
  v_mul_f32 v10, s68, v10
  v_mul_f32 v11, s68, v11
  v_mul_f32 v12, s68, v12
  v_mul_f32 v13, s68, v13
  v_mul_f32 v14, s68, v14
  v_mul_f32 v15, s68, v15
  v_cvt_pk_bf16_f32 v48, v0, v4
  v_cvt_pk_bf16_f32 v49, v1, v5
  v_cvt_pk_bf16_f32 v50, v2, v6
  v_cvt_pk_bf16_f32 v51, v3, v7
  buffer_store_dwordx4 v[48:51], v216, s[8:11], s55 offen offset:0 sc1
  v_cvt_pk_bf16_f32 v52, v8, v12
  v_cvt_pk_bf16_f32 v53, v9, v13
  v_cvt_pk_bf16_f32 v54, v10, v14
  v_cvt_pk_bf16_f32 v55, v11, v15
  buffer_store_dwordx4 v[52:55], v216, s[8:11], s55 offen offset:256 sc1
  v_cvt_pk_bf16_f32 v56, v16, v17
  v_cvt_pk_bf16_f32 v57, v20, v21
  v_cvt_pk_bf16_f32 v58, v24, v25
  v_cvt_pk_bf16_f32 v59, v28, v29
  buffer_store_dwordx4 v[56:59], v217, s[8:11], s64 offen offset:0 sc1
  v_cvt_pk_bf16_f32 v60, v18, v19
  v_cvt_pk_bf16_f32 v61, v22, v23
  v_cvt_pk_bf16_f32 v62, v26, v27
  v_cvt_pk_bf16_f32 v63, v30, v31
  buffer_store_dwordx4 v[60:63], v217, s[8:11], s64 offen offset:256 sc1
  s_add_u32 s59, s59, 7
  s_cmp_ge_u32 s59, 64
  s_cbranch_scc1 KV_done
  s_sub_u32 s54, s59, 14
  s_cmp_lt_u32 s54, 7
  s_cbranch_scc1 KV_early
  s_waitcnt vmcnt(4)
  s_barrier
KV_cont:
  s_branch KV_loop
KV_early:
  s_waitcnt vmcnt(0)
  s_barrier
  s_cmp_eq_u32 s52, 0
  s_cbranch_scc0 KV_sig0
  v_mov_b32 v211, 1
  v_mov_b32 v212, 0
  s_mov_b64 exec, 1
  buffer_atomic_add v211, v212, s[12:15], s70 offen
  s_mov_b64 exec, -1
KV_sig0:
  s_branch KV_cont
KV_done:
  s_waitcnt vmcnt(0)
  s_barrier
  s_cmp_eq_u32 s52, 0
  s_cbranch_scc0 KV_sig
  v_mov_b32 v211, 256
  v_mov_b32 v212, 0
  s_mov_b64 exec, 1
  buffer_atomic_add v211, v212, s[12:15], s70 offen
  s_mov_b64 exec, -1
KV_sig:
  s_cmp_lt_u32 s53, 96
  s_cbranch_scc0 W_a
  s_mul_i32 s58, s53, 21846
  s_lshr_b32 s58, s58, 16
  s_mul_i32 s54, s58, 3
  s_sub_u32 s59, s53, s54
  s_mul_i32 s60, s59, 36864
  s_add_u32 m0, s67, 0
  s_nop 0
  buffer_load_dwordx4 v202, s[4:7], s60 offen offset:0 lds
  s_add_u32 m0, s67, 896
  s_nop 0
  buffer_load_dwordx4 v202, s[4:7], s60 offen offset:128 lds
  s_add_u32 m0, s67, 1792
  s_nop 0
  buffer_load_dwordx4 v202, s[4:7], s60 offen offset:256 lds
  s_add_u32 m0, s67, 2688
  s_nop 0
  buffer_load_dwordx4 v202, s[4:7], s60 offen offset:384 lds
  s_add_u32 m0, s67, 3584
  s_nop 0
  buffer_load_dwordx4 v202, s[4:7], s60 offen offset:512 lds
  s_add_u32 m0, s67, 4480
  s_nop 0
  buffer_load_dwordx4 v202, s[4:7], s60 offen offset:640 lds
  s_add_u32 m0, s67, 5376
  s_nop 0
  buffer_load_dwordx4 v202, s[4:7], s60 offen offset:768 lds
  s_add_u32 m0, s67, 6272
  s_nop 0
  buffer_load_dwordx4 v202, s[4:7], s60 offen offset:896 lds
  s_add_u32 m0, s67, 7168
  s_nop 0
  buffer_load_dwordx4 v202, s[4:7], s60 offen offset:1024 lds
  v_lshrrev_b32 v211, 4, v200
  v_lshlrev_b32 v212, 2, v211
  v_and_b32 v213, 15, v200
  v_xor_b32 v212, v212, v213
  v_lshlrev_b32 v212, 4, v212
  v_lshl_add_u32 v207, v211, 13, v212
  s_lshl_b32 s62, s58, 8
  s_lshl_b32 s54, s52, 15
  s_add_u32 s62, s62, s54
  s_lshl_b32 s61, s52, 10
  s_add_u32 s61, s61, 36864
  s_add_u32 m0, s61, 0
  s_add_u32 s54, s62, 0
  buffer_load_dwordx4 v207, s[16:19], s54 offen lds
  s_add_u32 m0, s61, 4096
  s_add_u32 s54, s62, 131072
  buffer_load_dwordx4 v207, s[16:19], s54 offen lds
  s_add_u32 m0, s61, 8192
  s_add_u32 s54, s62, 262144
  buffer_load_dwordx4 v207, s[16:19], s54 offen lds
  s_add_u32 m0, s61, 12288
  s_add_u32 s54, s62, 393216
  buffer_load_dwordx4 v207, s[16:19], s54 offen lds
  s_add_u32 m0, s61, 16384
  s_add_u32 s54, s62, 524288
  buffer_load_dwordx4 v207, s[16:19], s54 offen lds
  s_add_u32 m0, s61, 20480
  s_add_u32 s54, s62, 655360
  buffer_load_dwordx4 v207, s[16:19], s54 offen lds
  s_add_u32 m0, s61, 24576
  s_add_u32 s54, s62, 786432
  buffer_load_dwordx4 v207, s[16:19], s54 offen lds
  s_add_u32 m0, s61, 28672
  s_add_u32 s54, s62, 917504
  buffer_load_dwordx4 v207, s[16:19], s54 offen lds
  s_add_u32 m0, s61, 32768
  s_add_u32 s54, s62, 1048576
  buffer_load_dwordx4 v207, s[16:19], s54 offen lds
  s_add_u32 m0, s61, 36864
  s_add_u32 s54, s62, 1179648
  buffer_load_dwordx4 v207, s[16:19], s54 offen lds
  s_add_u32 m0, s61, 40960
  s_add_u32 s54, s62, 1310720
  buffer_load_dwordx4 v207, s[16:19], s54 offen lds
  s_add_u32 m0, s61, 45056
  s_add_u32 s54, s62, 1441792
  buffer_load_dwordx4 v207, s[16:19], s54 offen lds
  s_add_u32 m0, s61, 49152
  s_add_u32 s54, s62, 1572864
  buffer_load_dwordx4 v207, s[16:19], s54 offen lds
  s_add_u32 m0, s61, 53248
  s_add_u32 s54, s62, 1703936
  buffer_load_dwordx4 v207, s[16:19], s54 offen lds
  s_add_u32 m0, s61, 57344
  s_add_u32 s54, s62, 1835008
  buffer_load_dwordx4 v207, s[16:19], s54 offen lds
  s_add_u32 m0, s61, 61440
  s_add_u32 s54, s62, 1966080
  buffer_load_dwordx4 v207, s[16:19], s54 offen lds
  s_add_u32 m0, s61, 65536
  s_add_u32 s54, s62, 2097152
  buffer_load_dwordx4 v207, s[16:19], s54 offen lds
  s_add_u32 m0, s61, 69632
  s_add_u32 s54, s62, 2228224
  buffer_load_dwordx4 v207, s[16:19], s54 offen lds
  s_add_u32 m0, s61, 73728
  s_add_u32 s54, s62, 2359296
  buffer_load_dwordx4 v207, s[16:19], s54 offen lds
  s_add_u32 m0, s61, 77824
  s_add_u32 s54, s62, 2490368
  buffer_load_dwordx4 v207, s[16:19], s54 offen lds
  s_add_u32 m0, s61, 81920
  s_add_u32 s54, s62, 2621440
  buffer_load_dwordx4 v207, s[16:19], s54 offen lds
  s_add_u32 m0, s61, 86016
  s_add_u32 s54, s62, 2752512
  buffer_load_dwordx4 v207, s[16:19], s54 offen lds
  s_add_u32 m0, s61, 90112
  s_add_u32 s54, s62, 2883584
  buffer_load_dwordx4 v207, s[16:19], s54 offen lds
  s_add_u32 m0, s61, 94208
  s_add_u32 s54, s62, 3014656
  buffer_load_dwordx4 v207, s[16:19], s54 offen lds
  s_waitcnt vmcnt(20) lgkmcnt(0)
  s_barrier
  s_add_u32 m0, s61, 98304
  s_add_u32 s54, s62, 3145728
  buffer_load_dwordx4 v207, s[16:19], s54 offen lds
  s_add_u32 m0, s61, 102400
  s_add_u32 s54, s62, 3276800
  buffer_load_dwordx4 v207, s[16:19], s54 offen lds
  s_add_u32 m0, s61, 106496
  s_add_u32 s54, s62, 3407872
  buffer_load_dwordx4 v207, s[16:19], s54 offen lds
  s_add_u32 m0, s61, 110592
  s_add_u32 s54, s62, 3538944
  buffer_load_dwordx4 v207, s[16:19], s54 offen lds
  v_add_u32 v215, 36864, v209
  ds_read_b64_tr_b16 a[0:1], v215 offset:0
  ds_read_b64_tr_b16 a[2:3], v215 offset:1024
  ds_read_b64_tr_b16 a[4:5], v215 offset:4096
  ds_read_b64_tr_b16 a[6:7], v215 offset:5120
  ds_read_b64_tr_b16 a[8:9], v215 offset:8192
  ds_read_b64_tr_b16 a[10:11], v215 offset:9216
  ds_read_b64_tr_b16 a[12:13], v215 offset:12288
  ds_read_b64_tr_b16 a[14:15], v215 offset:13312
  s_waitcnt vmcnt(20) lgkmcnt(0)
  s_barrier
  s_add_u32 m0, s61, 0
  s_add_u32 s54, s62, 3670016
  buffer_load_dwordx4 v207, s[16:19], s54 offen lds
  s_add_u32 m0, s61, 4096
  s_add_u32 s54, s62, 3801088
  buffer_load_dwordx4 v207, s[16:19], s54 offen lds
  s_add_u32 m0, s61, 8192
  s_add_u32 s54, s62, 3932160
  buffer_load_dwordx4 v207, s[16:19], s54 offen lds
  s_add_u32 m0, s61, 12288
  s_add_u32 s54, s62, 4063232
  buffer_load_dwordx4 v207, s[16:19], s54 offen lds
  v_add_u32 v215, 53248, v209
  ds_read_b64_tr_b16 a[16:17], v215 offset:0
  ds_read_b64_tr_b16 a[18:19], v215 offset:1024
  ds_read_b64_tr_b16 a[20:21], v215 offset:4096
  ds_read_b64_tr_b16 a[22:23], v215 offset:5120
  ds_read_b64_tr_b16 a[24:25], v215 offset:8192
  ds_read_b64_tr_b16 a[26:27], v215 offset:9216
  ds_read_b64_tr_b16 a[28:29], v215 offset:12288
  ds_read_b64_tr_b16 a[30:31], v215 offset:13312
  s_waitcnt vmcnt(20) lgkmcnt(0)
  s_barrier
  s_add_u32 m0, s61, 16384
  s_add_u32 s54, s62, 4194304
  buffer_load_dwordx4 v207, s[16:19], s54 offen lds
  s_add_u32 m0, s61, 20480
  s_add_u32 s54, s62, 4325376
  buffer_load_dwordx4 v207, s[16:19], s54 offen lds
  s_add_u32 m0, s61, 24576
  s_add_u32 s54, s62, 4456448
  buffer_load_dwordx4 v207, s[16:19], s54 offen lds
  s_add_u32 m0, s61, 28672
  s_add_u32 s54, s62, 4587520
  buffer_load_dwordx4 v207, s[16:19], s54 offen lds
  v_add_u32 v215, 69632, v209
  ds_read_b64_tr_b16 a[32:33], v215 offset:0
  ds_read_b64_tr_b16 a[34:35], v215 offset:1024
  ds_read_b64_tr_b16 a[36:37], v215 offset:4096
  ds_read_b64_tr_b16 a[38:39], v215 offset:5120
  ds_read_b64_tr_b16 a[40:41], v215 offset:8192
  ds_read_b64_tr_b16 a[42:43], v215 offset:9216
  ds_read_b64_tr_b16 a[44:45], v215 offset:12288
  ds_read_b64_tr_b16 a[46:47], v215 offset:13312
  s_waitcnt vmcnt(20) lgkmcnt(0)
  s_barrier
  v_add_u32 v215, 86016, v209
  ds_read_b64_tr_b16 a[48:49], v215 offset:0
  ds_read_b64_tr_b16 a[50:51], v215 offset:1024
  ds_read_b64_tr_b16 a[52:53], v215 offset:4096
  ds_read_b64_tr_b16 a[54:55], v215 offset:5120
  ds_read_b64_tr_b16 a[56:57], v215 offset:8192
  ds_read_b64_tr_b16 a[58:59], v215 offset:9216
  ds_read_b64_tr_b16 a[60:61], v215 offset:12288
  ds_read_b64_tr_b16 a[62:63], v215 offset:13312
  s_waitcnt vmcnt(16) lgkmcnt(0)
  s_barrier
  v_add_u32 v215, 102400, v209
  ds_read_b64_tr_b16 a[64:65], v215 offset:0
  ds_read_b64_tr_b16 a[66:67], v215 offset:1024
  ds_read_b64_tr_b16 a[68:69], v215 offset:4096
  ds_read_b64_tr_b16 a[70:71], v215 offset:5120
  ds_read_b64_tr_b16 a[72:73], v215 offset:8192
  ds_read_b64_tr_b16 a[74:75], v215 offset:9216
  ds_read_b64_tr_b16 a[76:77], v215 offset:12288
  ds_read_b64_tr_b16 a[78:79], v215 offset:13312
  s_waitcnt vmcnt(12) lgkmcnt(0)
  s_barrier
  v_add_u32 v215, 118784, v209
  ds_read_b64_tr_b16 a[80:81], v215 offset:0
  ds_read_b64_tr_b16 a[82:83], v215 offset:1024
  ds_read_b64_tr_b16 a[84:85], v215 offset:4096
  ds_read_b64_tr_b16 a[86:87], v215 offset:5120
  ds_read_b64_tr_b16 a[88:89], v215 offset:8192
  ds_read_b64_tr_b16 a[90:91], v215 offset:9216
  ds_read_b64_tr_b16 a[92:93], v215 offset:12288
  ds_read_b64_tr_b16 a[94:95], v215 offset:13312
  s_waitcnt vmcnt(8) lgkmcnt(0)
  s_barrier
  v_add_u32 v215, 135168, v209
  ds_read_b64_tr_b16 a[96:97], v215 offset:0
  ds_read_b64_tr_b16 a[98:99], v215 offset:1024
  ds_read_b64_tr_b16 a[100:101], v215 offset:4096
  ds_read_b64_tr_b16 a[102:103], v215 offset:5120
  ds_read_b64_tr_b16 a[104:105], v215 offset:8192
  ds_read_b64_tr_b16 a[106:107], v215 offset:9216
  ds_read_b64_tr_b16 a[108:109], v215 offset:12288
  ds_read_b64_tr_b16 a[110:111], v215 offset:13312
  s_waitcnt vmcnt(4) lgkmcnt(0)
  s_barrier
  v_add_u32 v215, 36864, v209
  ds_read_b64_tr_b16 a[112:113], v215 offset:0
  ds_read_b64_tr_b16 a[114:115], v215 offset:1024
  ds_read_b64_tr_b16 a[116:117], v215 offset:4096
  ds_read_b64_tr_b16 a[118:119], v215 offset:5120
  ds_read_b64_tr_b16 a[120:121], v215 offset:8192
  ds_read_b64_tr_b16 a[122:123], v215 offset:9216
  ds_read_b64_tr_b16 a[124:125], v215 offset:12288
  ds_read_b64_tr_b16 a[126:127], v215 offset:13312
  s_waitcnt vmcnt(0) lgkmcnt(0)
  s_barrier
  v_add_u32 v215, 53248, v209
  ds_read_b64_tr_b16 a[128:129], v215 offset:0
  ds_read_b64_tr_b16 a[130:131], v215 offset:1024
  ds_read_b64_tr_b16 a[132:133], v215 offset:4096
  ds_read_b64_tr_b16 a[134:135], v215 offset:5120
  ds_read_b64_tr_b16 a[136:137], v215 offset:8192
  ds_read_b64_tr_b16 a[138:139], v215 offset:9216
  ds_read_b64_tr_b16 a[140:141], v215 offset:12288
  ds_read_b64_tr_b16 a[142:143], v215 offset:13312
  s_waitcnt lgkmcnt(0)
  s_barrier
  v_and_b32 v211, 31, v200
  v_lshrrev_b32 v212, 5, v200
  v_lshlrev_b32 v213, 2, v212
  v_sub_u32 v211, v211, v213
  v_mov_b32 v214, 0xf149f2ca
  v_cmp_gt_i32 vcc, 0, v211
  s_nop 1
  v_cndmask_b32 v48, 0, v214, vcc
  v_cmp_gt_i32 vcc, 1, v211
  s_nop 1
  v_cndmask_b32 v49, 0, v214, vcc
  v_cmp_gt_i32 vcc, 2, v211
  s_nop 1
  v_cndmask_b32 v50, 0, v214, vcc
  v_cmp_gt_i32 vcc, 3, v211
  s_nop 1
  v_cndmask_b32 v51, 0, v214, vcc
  v_cmp_gt_i32 vcc, 8, v211
  s_nop 1
  v_cndmask_b32 v52, 0, v214, vcc
  v_cmp_gt_i32 vcc, 9, v211
  s_nop 1
  v_cndmask_b32 v53, 0, v214, vcc
  v_cmp_gt_i32 vcc, 10, v211
  s_nop 1
  v_cndmask_b32 v54, 0, v214, vcc
  v_cmp_gt_i32 vcc, 11, v211
  s_nop 1
  v_cndmask_b32 v55, 0, v214, vcc
  v_cmp_gt_i32 vcc, 16, v211
  s_nop 1
  v_cndmask_b32 v56, 0, v214, vcc
  v_cmp_gt_i32 vcc, 17, v211
  s_nop 1
  v_cndmask_b32 v57, 0, v214, vcc
  v_cmp_gt_i32 vcc, 18, v211
  s_nop 1
  v_cndmask_b32 v58, 0, v214, vcc
  v_cmp_gt_i32 vcc, 19, v211
  s_nop 1
  v_cndmask_b32 v59, 0, v214, vcc
  v_cmp_gt_i32 vcc, 24, v211
  s_nop 1
  v_cndmask_b32 v60, 0, v214, vcc
  v_cmp_gt_i32 vcc, 25, v211
  s_nop 1
  v_cndmask_b32 v61, 0, v214, vcc
  v_cmp_gt_i32 vcc, 26, v211
  s_nop 1
  v_cndmask_b32 v62, 0, v214, vcc
  v_cmp_gt_i32 vcc, 27, v211
  s_nop 1
  v_cndmask_b32 v63, 0, v214, vcc
  v_and_b32 v218, 0xff, v216
  v_and_b32 v211, 15, v200
  v_lshl_add_u32 v211, v212, 5, v211
  v_lshlrev_b32 v219, 4, v211
  v_bfe_u32 v211, v200, 4, 1
  v_lshl_add_u32 v219, v211, 2, v219
  s_lshl_b32 s54, s52, 10
  s_add_u32 s54, s54, 8
  v_add_u32 v219, s54, v219
  s_lshl_b32 s54, s52, 11
  s_add_u32 s54, s54, 73728
  v_add_u32 v215, s54, v201
  v_add_u32 v208, 73728, v201
  s_mov_b32 s68, 1040356334
  s_lshl_b32 s69, s58, 7
  s_add_u32 s69, s69, 105906176
  s_lshl_b32 s56, s58, 2
  s_add_u32 s56, s56, 128
  s_mov_b32 s57, 32
  s_cmp_eq_u32 s52, 0
  s_cbranch_scc0 AT_p1_d
  s_mov_b32 exec_hi, 0
  s_mov_b32 exec_lo, 1
AT_p1:
  buffer_load_dword v211, v201, s[12:15], s56 offen sc1
  s_add_u32 s65, s65, 1
  s_waitcnt vmcnt(0)
  v_cmp_gt_u32 vcc, 0x700, v211
  s_cbranch_vccz AT_p1_x
  s_sleep 8
  s_cmp_lt_u32 s65, 131072
  s_cbranch_scc1 AT_p1
AT_p1_x:
  s_mov_b64 exec, -1
AT_p1_d:
  s_barrier
  s_cmp_eq_u32 s52, 0
  s_cbranch_scc0 AT_arm_d
  s_mov_b32 exec_hi, 0
  s_mov_b32 exec_lo, 1
AT_arm:
  buffer_load_dword v211, v201, s[12:15], s57 offen sc1
  s_add_u32 s65, s65, 1
  s_waitcnt vmcnt(0)
  v_cmp_gt_u32 vcc, 32, v211
  s_cbranch_vccz AT_arm_x
  s_sleep 8
  s_cmp_lt_u32 s65, 131072
  s_cbranch_scc1 AT_arm
AT_arm_x:
  s_mov_b64 exec, -1
AT_arm_d:
  s_barrier
AT_loop:
  s_lshl_b32 s64, s59, 5
  s_add_u32 s64, s64, s58
  s_lshl_b32 s55, s64, 14
  buffer_load_dwordx4 v[128:131], v216, s[8:11], s55 offen offset:0 sc1
  buffer_load_dwordx4 v[132:135], v216, s[8:11], s55 offen offset:256 sc1
  buffer_load_dwordx4 v[136:139], v216, s[8:11], s55 offen offset:512 sc1
  buffer_load_dwordx4 v[140:143], v216, s[8:11], s55 offen offset:768 sc1
  buffer_load_dwordx4 v[144:147], v216, s[8:11], s55 offen offset:1024 sc1
  buffer_load_dwordx4 v[148:151], v216, s[8:11], s55 offen offset:1280 sc1
  buffer_load_dwordx4 v[152:155], v216, s[8:11], s55 offen offset:1536 sc1
  buffer_load_dwordx4 v[156:159], v216, s[8:11], s55 offen offset:1792 sc1
  buffer_load_dwordx4 v[160:163], v217, s[8:11], s55 offen offset:0 sc1
  buffer_load_dwordx4 v[164:167], v217, s[8:11], s55 offen offset:256 sc1
  s_add_u32 s60, s60, 110592
  s_add_u32 m0, s67, 36864
  s_nop 0
  buffer_load_dwordx4 v202, s[4:7], s60 offen offset:0 lds
  s_add_u32 m0, s67, 37760
  s_nop 0
  buffer_load_dwordx4 v202, s[4:7], s60 offen offset:128 lds
  s_add_u32 m0, s67, 38656
  s_nop 0
  buffer_load_dwordx4 v202, s[4:7], s60 offen offset:256 lds
  s_add_u32 m0, s67, 39552
  s_nop 0
  buffer_load_dwordx4 v202, s[4:7], s60 offen offset:384 lds
  s_add_u32 m0, s67, 40448
  s_nop 0
  buffer_load_dwordx4 v202, s[4:7], s60 offen offset:512 lds
  s_add_u32 m0, s67, 41344
  s_nop 0
  buffer_load_dwordx4 v202, s[4:7], s60 offen offset:640 lds
  s_add_u32 m0, s67, 42240
  s_nop 0
  buffer_load_dwordx4 v202, s[4:7], s60 offen offset:768 lds
  s_add_u32 m0, s67, 43136
  s_nop 0
  buffer_load_dwordx4 v202, s[4:7], s60 offen offset:896 lds
  s_add_u32 m0, s67, 44032
  s_nop 0
  buffer_load_dwordx4 v202, s[4:7], s60 offen offset:1024 lds
  ds_read_b128 v[32:35], v203 offset:0
  ds_read_b128 v[36:39], v204 offset:0
  ds_read_b128 v[40:43], v205 offset:0
  s_waitcnt lgkmcnt(2)
  v_mfma_f32_32x32x16_bf16 v[0:15], a[0:3], v[32:35], 0
  ds_read_b128 v[44:47], v206 offset:0
  s_waitcnt lgkmcnt(2)
  v_mfma_f32_32x32x16_bf16 v[0:15], a[4:7], v[36:39], v[0:15]
  ds_read_b128 v[32:35], v203 offset:1024
  s_waitcnt lgkmcnt(2)
  v_mfma_f32_32x32x16_bf16 v[0:15], a[8:11], v[40:43], v[0:15]
  ds_read_b128 v[36:39], v204 offset:1024
  s_waitcnt lgkmcnt(2)
  v_mfma_f32_32x32x16_bf16 v[0:15], a[12:15], v[44:47], v[0:15]
  ds_read_b128 v[40:43], v205 offset:1024
  s_waitcnt lgkmcnt(2)
  v_mfma_f32_32x32x16_bf16 v[0:15], a[16:19], v[32:35], v[0:15]
  ds_read_b128 v[44:47], v206 offset:1024
  s_waitcnt lgkmcnt(2)
  v_mfma_f32_32x32x16_bf16 v[0:15], a[20:23], v[36:39], v[0:15]
  ds_read_b128 v[32:35], v203 offset:2048
  s_waitcnt lgkmcnt(2)
  v_mfma_f32_32x32x16_bf16 v[0:15], a[24:27], v[40:43], v[0:15]
  ds_read_b128 v[36:39], v204 offset:2048
  s_waitcnt lgkmcnt(2)
  v_mfma_f32_32x32x16_bf16 v[0:15], a[28:31], v[44:47], v[0:15]
  ds_read_b128 v[40:43], v205 offset:2048
  s_waitcnt lgkmcnt(2)
  v_mfma_f32_32x32x16_bf16 v[0:15], a[32:35], v[32:35], v[0:15]
  ds_read_b128 v[44:47], v206 offset:2048
  s_waitcnt lgkmcnt(2)
  v_mfma_f32_32x32x16_bf16 v[0:15], a[36:39], v[36:39], v[0:15]
  ds_read_b128 v[32:35], v203 offset:3072
  s_waitcnt lgkmcnt(2)
  v_mfma_f32_32x32x16_bf16 v[0:15], a[40:43], v[40:43], v[0:15]
  ds_read_b128 v[36:39], v204 offset:3072
  s_waitcnt lgkmcnt(2)
  v_mfma_f32_32x32x16_bf16 v[0:15], a[44:47], v[44:47], v[0:15]
  ds_read_b128 v[40:43], v205 offset:3072
  s_waitcnt lgkmcnt(2)
  v_mfma_f32_32x32x16_bf16 v[0:15], a[48:51], v[32:35], v[0:15]
  ds_read_b128 v[44:47], v206 offset:3072
  s_waitcnt lgkmcnt(2)
  v_mfma_f32_32x32x16_bf16 v[0:15], a[52:55], v[36:39], v[0:15]
  ds_read_b128 v[32:35], v203 offset:4096
  s_waitcnt lgkmcnt(2)
  v_mfma_f32_32x32x16_bf16 v[0:15], a[56:59], v[40:43], v[0:15]
  ds_read_b128 v[36:39], v204 offset:4096
  s_waitcnt lgkmcnt(2)
  v_mfma_f32_32x32x16_bf16 v[0:15], a[60:63], v[44:47], v[0:15]
  ds_read_b128 v[40:43], v205 offset:4096
  s_waitcnt lgkmcnt(2)
  v_mfma_f32_32x32x16_bf16 v[0:15], a[64:67], v[32:35], v[0:15]
  ds_read_b128 v[44:47], v206 offset:4096
  s_waitcnt lgkmcnt(2)
  v_mfma_f32_32x32x16_bf16 v[0:15], a[68:71], v[36:39], v[0:15]
  ds_read_b128 v[32:35], v203 offset:5120
  s_waitcnt lgkmcnt(2)
  v_mfma_f32_32x32x16_bf16 v[0:15], a[72:75], v[40:43], v[0:15]
  ds_read_b128 v[36:39], v204 offset:5120
  s_waitcnt lgkmcnt(2)
  v_mfma_f32_32x32x16_bf16 v[0:15], a[76:79], v[44:47], v[0:15]
  ds_read_b128 v[40:43], v205 offset:5120
  s_waitcnt lgkmcnt(2)
  v_mfma_f32_32x32x16_bf16 v[0:15], a[80:83], v[32:35], v[0:15]
  ds_read_b128 v[44:47], v206 offset:5120
  s_waitcnt lgkmcnt(2)
  v_mfma_f32_32x32x16_bf16 v[0:15], a[84:87], v[36:39], v[0:15]
  ds_read_b128 v[32:35], v203 offset:6144
  s_waitcnt lgkmcnt(2)
  v_mfma_f32_32x32x16_bf16 v[0:15], a[88:91], v[40:43], v[0:15]
  ds_read_b128 v[36:39], v204 offset:6144
  s_waitcnt lgkmcnt(2)
  v_mfma_f32_32x32x16_bf16 v[0:15], a[92:95], v[44:47], v[0:15]
  ds_read_b128 v[40:43], v205 offset:6144
  s_waitcnt lgkmcnt(2)
  v_mfma_f32_32x32x16_bf16 v[0:15], a[96:99], v[32:35], v[0:15]
  ds_read_b128 v[44:47], v206 offset:6144
  s_waitcnt lgkmcnt(2)
  v_mfma_f32_32x32x16_bf16 v[0:15], a[100:103], v[36:39], v[0:15]
  ds_read_b128 v[32:35], v203 offset:7168
  s_waitcnt lgkmcnt(2)
  v_mfma_f32_32x32x16_bf16 v[0:15], a[104:107], v[40:43], v[0:15]
  ds_read_b128 v[36:39], v204 offset:7168
  s_waitcnt lgkmcnt(2)
  v_mfma_f32_32x32x16_bf16 v[0:15], a[108:111], v[44:47], v[0:15]
  ds_read_b128 v[40:43], v205 offset:7168
  s_waitcnt lgkmcnt(2)
  v_mfma_f32_32x32x16_bf16 v[0:15], a[112:115], v[32:35], v[0:15]
  ds_read_b128 v[44:47], v206 offset:7168
  s_waitcnt lgkmcnt(2)
  v_mfma_f32_32x32x16_bf16 v[0:15], a[116:119], v[36:39], v[0:15]
  ds_read_b128 v[32:35], v203 offset:8192
  s_waitcnt lgkmcnt(2)
  v_mfma_f32_32x32x16_bf16 v[0:15], a[120:123], v[40:43], v[0:15]
  ds_read_b128 v[36:39], v204 offset:8192
  s_waitcnt lgkmcnt(2)
  v_mfma_f32_32x32x16_bf16 v[0:15], a[124:127], v[44:47], v[0:15]
  ds_read_b128 v[40:43], v205 offset:8192
  s_waitcnt lgkmcnt(2)
  v_mfma_f32_32x32x16_bf16 v[0:15], a[128:131], v[32:35], v[0:15]
  ds_read_b128 v[44:47], v206 offset:8192
  s_waitcnt lgkmcnt(2)
  v_mfma_f32_32x32x16_bf16 v[0:15], a[132:135], v[36:39], v[0:15]
  s_waitcnt lgkmcnt(1)
  v_mfma_f32_32x32x16_bf16 v[0:15], a[136:139], v[40:43], v[0:15]
  s_waitcnt lgkmcnt(0)
  v_mfma_f32_32x32x16_bf16 v[0:15], a[140:143], v[44:47], v[0:15]
  s_nop 11
  v_cvt_pk_bf16_f32 v16, v0, v4
  v_cvt_pk_bf16_f32 v17, v1, v5
  v_cvt_pk_bf16_f32 v18, v2, v6
  v_cvt_pk_bf16_f32 v19, v3, v7
  ds_write_b128 v215, v[16:19] offset:0
  v_cvt_pk_bf16_f32 v20, v8, v12
  v_cvt_pk_bf16_f32 v21, v9, v13
  v_cvt_pk_bf16_f32 v22, v10, v14
  v_cvt_pk_bf16_f32 v23, v11, v15
  ds_write_b128 v215, v[20:23] offset:1024
  s_waitcnt lgkmcnt(0)
  s_barrier
  ds_read_b128 v[96:99], v208 offset:0
  ds_read_b128 v[100:103], v208 offset:1024
  ds_read_b128 v[104:107], v208 offset:2048
  ds_read_b128 v[108:111], v208 offset:3072
  ds_read_b128 v[112:115], v208 offset:4096
  ds_read_b128 v[116:119], v208 offset:5120
  ds_read_b128 v[120:123], v208 offset:6144
  ds_read_b128 v[124:127], v208 offset:7168
  s_waitcnt vmcnt(18) lgkmcnt(7)
  v_mfma_f32_32x32x16_bf16 v[64:79], v[128:131], v[96:99], v[48:63]
  s_waitcnt vmcnt(17) lgkmcnt(6)
  v_mfma_f32_32x32x16_bf16 v[64:79], v[132:135], v[100:103], v[64:79]
  s_waitcnt vmcnt(16) lgkmcnt(5)
  v_mfma_f32_32x32x16_bf16 v[64:79], v[136:139], v[104:107], v[64:79]
  s_waitcnt vmcnt(15) lgkmcnt(4)
  v_mfma_f32_32x32x16_bf16 v[64:79], v[140:143], v[108:111], v[64:79]
  s_waitcnt vmcnt(14) lgkmcnt(3)
  v_mfma_f32_32x32x16_bf16 v[64:79], v[144:147], v[112:115], v[64:79]
  s_waitcnt vmcnt(13) lgkmcnt(2)
  v_mfma_f32_32x32x16_bf16 v[64:79], v[148:151], v[116:119], v[64:79]
  s_waitcnt vmcnt(12) lgkmcnt(1)
  v_mfma_f32_32x32x16_bf16 v[64:79], v[152:155], v[120:123], v[64:79]
  s_waitcnt vmcnt(11) lgkmcnt(0)
  v_mfma_f32_32x32x16_bf16 v[64:79], v[156:159], v[124:127], v[64:79]
  s_add_u32 s70, s59, 2
  s_lshl_b32 s55, s64, 12
  s_add_u32 s55, s55, 34603008
  s_nop 8
  v_max3_f32 v16, v64, v65, v66
  v_max3_f32 v16, v16, v67, v68
  v_max3_f32 v16, v16, v69, v70
  v_max3_f32 v16, v16, v71, v72
  v_max3_f32 v16, v16, v73, v74
  v_max3_f32 v16, v16, v75, v76
  v_max3_f32 v16, v16, v77, v78
  v_max_f32 v16, v16, v79
  s_waitcnt vmcnt(0)
  s_cmp_eq_u32 s52, 0
  s_cbranch_scc0 AT_m0_d
  s_mov_b32 exec_hi, 0
  s_mov_b32 exec_lo, 1
AT_m0:
  buffer_load_dword v211, v201, s[8:11], s69 offen sc1
  s_add_u32 s65, s65, 1
  s_waitcnt vmcnt(0)
  v_cmp_gt_u32 vcc, s70, v211
  s_cbranch_vccz AT_m0_x
  s_sleep 1
  s_cmp_lt_u32 s65, 131072
  s_cbranch_scc1 AT_m0
AT_m0_x:
  s_mov_b64 exec, -1
AT_m0_d:
  s_barrier
  buffer_load_dwordx2 v[128:129], v218, s[8:11], s55 offen offset:0 sc1
  buffer_load_dwordx2 v[130:131], v218, s[8:11], s55 offen offset:1024 sc1
  buffer_load_dwordx2 v[132:133], v218, s[8:11], s55 offen offset:256 sc1
  buffer_load_dwordx2 v[134:135], v218, s[8:11], s55 offen offset:1280 sc1
  buffer_load_dwordx2 v[136:137], v218, s[8:11], s55 offen offset:512 sc1
  buffer_load_dwordx2 v[138:139], v218, s[8:11], s55 offen offset:1536 sc1
  buffer_load_dwordx2 v[140:141], v218, s[8:11], s55 offen offset:768 sc1
  buffer_load_dwordx2 v[142:143], v218, s[8:11], s55 offen offset:1792 sc1
  buffer_load_dwordx2 v[144:145], v218, s[8:11], s55 offen offset:2048 sc1
  buffer_load_dwordx2 v[146:147], v218, s[8:11], s55 offen offset:3072 sc1
  buffer_load_dwordx2 v[148:149], v218, s[8:11], s55 offen offset:2304 sc1
  buffer_load_dwordx2 v[150:151], v218, s[8:11], s55 offen offset:3328 sc1
  buffer_load_dwordx2 v[152:153], v218, s[8:11], s55 offen offset:2560 sc1
  buffer_load_dwordx2 v[154:155], v218, s[8:11], s55 offen offset:3584 sc1
  buffer_load_dwordx2 v[156:157], v218, s[8:11], s55 offen offset:2816 sc1
  buffer_load_dwordx2 v[158:159], v218, s[8:11], s55 offen offset:3840 sc1
  buffer_load_dword v168, v219, s[8:11], s55 offen offset:0 sc1
  buffer_load_dword v169, v219, s[8:11], s55 offen offset:256 sc1
  s_waitcnt vmcnt(16)
  v_mfma_f32_32x32x16_bf16 v[80:95], v[128:131], v[96:99], 0
  s_waitcnt vmcnt(14)
  v_mfma_f32_32x32x16_bf16 v[80:95], v[132:135], v[100:103], v[80:95]
  s_waitcnt vmcnt(12)
  v_mfma_f32_32x32x16_bf16 v[80:95], v[136:139], v[104:107], v[80:95]
  s_waitcnt vmcnt(10)
  v_mfma_f32_32x32x16_bf16 v[80:95], v[140:143], v[108:111], v[80:95]
  s_waitcnt vmcnt(8)
  v_mfma_f32_32x32x16_bf16 v[80:95], v[144:147], v[112:115], v[80:95]
  s_waitcnt vmcnt(6)
  v_mfma_f32_32x32x16_bf16 v[80:95], v[148:151], v[116:119], v[80:95]
  s_waitcnt vmcnt(4)
  v_mfma_f32_32x32x16_bf16 v[80:95], v[152:155], v[120:123], v[80:95]
  s_waitcnt vmcnt(2)
  v_mfma_f32_32x32x16_bf16 v[80:95], v[156:159], v[124:127], v[80:95]
  s_lshl_b32 s64, s64, 13
  s_lshl_b32 s54, s52, 11
  s_add_u32 s64, s64, s54
  s_add_u32 s64, s64, 44040192
  s_nop 7
  v_mul_f32 v80, s68, v80
  v_mul_f32 v81, s68, v81
  v_mul_f32 v82, s68, v82
  v_mul_f32 v83, s68, v83
  v_max3_f32 v16, v16, v80, v81
  v_max3_f32 v16, v16, v82, v83
  v_mov_b32 v17, v16
  s_nop 1
  v_permlane32_swap_b32 v16, v17
  v_max_f32 v16, v16, v17
  v_sub_f32 v64, v64, v16
  v_sub_f32 v65, v65, v16
  v_sub_f32 v66, v66, v16
  v_sub_f32 v67, v67, v16
  v_sub_f32 v68, v68, v16
  v_sub_f32 v69, v69, v16
  v_sub_f32 v70, v70, v16
  v_sub_f32 v71, v71, v16
  v_sub_f32 v72, v72, v16
  v_sub_f32 v73, v73, v16
  v_sub_f32 v74, v74, v16
  v_sub_f32 v75, v75, v16
  v_sub_f32 v76, v76, v16
  v_sub_f32 v77, v77, v16
  v_sub_f32 v78, v78, v16
  v_sub_f32 v79, v79, v16
  v_sub_f32 v80, v80, v16
  v_sub_f32 v81, v81, v16
  v_sub_f32 v82, v82, v16
  v_sub_f32 v83, v83, v16
  v_exp_f32 v64, v64
  v_exp_f32 v65, v65
  v_exp_f32 v66, v66
  v_exp_f32 v67, v67
  v_exp_f32 v68, v68
  v_exp_f32 v69, v69
  v_exp_f32 v70, v70
  v_exp_f32 v71, v71
  v_exp_f32 v72, v72
  v_exp_f32 v73, v73
  v_exp_f32 v74, v74
  v_exp_f32 v75, v75
  v_exp_f32 v76, v76
  v_exp_f32 v77, v77
  v_exp_f32 v78, v78
  v_exp_f32 v79, v79
  v_exp_f32 v80, v80
  v_exp_f32 v81, v81
  v_exp_f32 v82, v82
  v_exp_f32 v83, v83
  v_cvt_pk_bf16_f32 v20, v64, v65
  v_cvt_pk_bf16_f32 v21, v68, v69
  v_cvt_pk_bf16_f32 v22, v72, v73
  v_cvt_pk_bf16_f32 v23, v76, v77
  v_cvt_pk_bf16_f32 v24, v66, v67
  v_cvt_pk_bf16_f32 v25, v70, v71
  v_cvt_pk_bf16_f32 v26, v74, v75
  v_cvt_pk_bf16_f32 v27, v78, v79
  v_cvt_pk_bf16_f32 v28, v80, v81
  v_cvt_pk_bf16_f32 v29, v82, v83
  v_mfma_f32_32x32x16_bf16 v[0:15], v[160:163], v[20:23], 0
  v_add_f32 v16, v64, v65
  v_add_f32 v16, v16, v66
  v_add_f32 v16, v16, v67
  v_add_f32 v16, v16, v68
  v_add_f32 v16, v16, v69
  v_add_f32 v16, v16, v70
  v_add_f32 v16, v16, v71
  v_mfma_f32_32x32x16_bf16 v[0:15], v[164:167], v[24:27], v[0:15]
  v_add_f32 v16, v16, v72
  v_add_f32 v16, v16, v73
  v_add_f32 v16, v16, v74
  v_add_f32 v16, v16, v75
  v_add_f32 v16, v16, v76
  v_add_f32 v16, v16, v77
  s_waitcnt vmcnt(0)
  v_mfma_f32_32x32x8_bf16 v[0:15], v[168:169], v[28:29], v[0:15]
  v_add_f32 v16, v16, v78
  v_add_f32 v16, v16, v79
  v_add_f32 v16, v16, v80
  v_add_f32 v16, v16, v81
  v_add_f32 v16, v16, v82
  v_add_f32 v16, v16, v83
  v_mov_b32 v17, v16
  s_nop 1
  v_permlane32_swap_b32 v16, v17
  v_add_f32 v16, v16, v17
  v_rcp_f32 v16, v16
  s_nop 0
  v_mul_f32 v0, v16, v0
  v_mul_f32 v1, v16, v1
  v_mul_f32 v2, v16, v2
  v_mul_f32 v3, v16, v3
  v_mul_f32 v4, v16, v4
  v_mul_f32 v5, v16, v5
  v_mul_f32 v6, v16, v6
  v_mul_f32 v7, v16, v7
  v_cvt_pk_bf16_f32 v20, v0, v1
  v_cvt_pk_bf16_f32 v21, v2, v3
  v_cvt_pk_bf16_f32 v22, v4, v5
  v_cvt_pk_bf16_f32 v23, v6, v7
  buffer_store_dwordx4 v[20:23], v201, s[8:11], s64 offen offset:0 sc1
  v_mul_f32 v8, v16, v8
  v_mul_f32 v9, v16, v9
  v_mul_f32 v10, v16, v10
  v_mul_f32 v11, v16, v11
  v_mul_f32 v12, v16, v12
  v_mul_f32 v13, v16, v13
  v_mul_f32 v14, v16, v14
  v_mul_f32 v15, v16, v15
  v_cvt_pk_bf16_f32 v24, v8, v9
  v_cvt_pk_bf16_f32 v25, v10, v11
  v_cvt_pk_bf16_f32 v26, v12, v13
  v_cvt_pk_bf16_f32 v27, v14, v15
  buffer_store_dwordx4 v[24:27], v201, s[8:11], s64 offen offset:1024 sc1
  s_add_u32 s59, s59, 3
  v_mov_b32 v212, s59
  s_waitcnt vmcnt(0)
  s_barrier
  s_cmp_eq_u32 s52, 0
  s_cselect_b32 s54, s71, 268435456
  s_mov_b64 exec, 1
  buffer_store_dword v212, v201, s[8:11], s54 offen sc1
  s_mov_b64 exec, -1
  s_cmp_ge_u32 s59, 64
  s_cbranch_scc1 L_exit
  s_lshl_b32 s64, s59, 5
  s_add_u32 s64, s64, s58
  s_lshl_b32 s55, s64, 14
  buffer_load_dwordx4 v[128:131], v216, s[8:11], s55 offen offset:0 sc1
  buffer_load_dwordx4 v[132:135], v216, s[8:11], s55 offen offset:256 sc1
  buffer_load_dwordx4 v[136:139], v216, s[8:11], s55 offen offset:512 sc1
  buffer_load_dwordx4 v[140:143], v216, s[8:11], s55 offen offset:768 sc1
  buffer_load_dwordx4 v[144:147], v216, s[8:11], s55 offen offset:1024 sc1
  buffer_load_dwordx4 v[148:151], v216, s[8:11], s55 offen offset:1280 sc1
  buffer_load_dwordx4 v[152:155], v216, s[8:11], s55 offen offset:1536 sc1
  buffer_load_dwordx4 v[156:159], v216, s[8:11], s55 offen offset:1792 sc1
  buffer_load_dwordx4 v[160:163], v217, s[8:11], s55 offen offset:0 sc1
  buffer_load_dwordx4 v[164:167], v217, s[8:11], s55 offen offset:256 sc1
  s_add_u32 s60, s60, 110592
  s_add_u32 m0, s67, 0
  s_nop 0
  buffer_load_dwordx4 v202, s[4:7], s60 offen offset:0 lds
  s_add_u32 m0, s67, 896
  s_nop 0
  buffer_load_dwordx4 v202, s[4:7], s60 offen offset:128 lds
  s_add_u32 m0, s67, 1792
  s_nop 0
  buffer_load_dwordx4 v202, s[4:7], s60 offen offset:256 lds
  s_add_u32 m0, s67, 2688
  s_nop 0
  buffer_load_dwordx4 v202, s[4:7], s60 offen offset:384 lds
  s_add_u32 m0, s67, 3584
  s_nop 0
  buffer_load_dwordx4 v202, s[4:7], s60 offen offset:512 lds
  s_add_u32 m0, s67, 4480
  s_nop 0
  buffer_load_dwordx4 v202, s[4:7], s60 offen offset:640 lds
  s_add_u32 m0, s67, 5376
  s_nop 0
  buffer_load_dwordx4 v202, s[4:7], s60 offen offset:768 lds
  s_add_u32 m0, s67, 6272
  s_nop 0
  buffer_load_dwordx4 v202, s[4:7], s60 offen offset:896 lds
  s_add_u32 m0, s67, 7168
  s_nop 0
  buffer_load_dwordx4 v202, s[4:7], s60 offen offset:1024 lds
  ds_read_b128 v[32:35], v203 offset:36864
  ds_read_b128 v[36:39], v204 offset:36864
  ds_read_b128 v[40:43], v205 offset:36864
  s_waitcnt lgkmcnt(2)
  v_mfma_f32_32x32x16_bf16 v[0:15], a[0:3], v[32:35], 0
  ds_read_b128 v[44:47], v206 offset:36864
  s_waitcnt lgkmcnt(2)
  v_mfma_f32_32x32x16_bf16 v[0:15], a[4:7], v[36:39], v[0:15]
  ds_read_b128 v[32:35], v203 offset:37888
  s_waitcnt lgkmcnt(2)
  v_mfma_f32_32x32x16_bf16 v[0:15], a[8:11], v[40:43], v[0:15]
  ds_read_b128 v[36:39], v204 offset:37888
  s_waitcnt lgkmcnt(2)
  v_mfma_f32_32x32x16_bf16 v[0:15], a[12:15], v[44:47], v[0:15]
  ds_read_b128 v[40:43], v205 offset:37888
  s_waitcnt lgkmcnt(2)
  v_mfma_f32_32x32x16_bf16 v[0:15], a[16:19], v[32:35], v[0:15]
  ds_read_b128 v[44:47], v206 offset:37888
  s_waitcnt lgkmcnt(2)
  v_mfma_f32_32x32x16_bf16 v[0:15], a[20:23], v[36:39], v[0:15]
  ds_read_b128 v[32:35], v203 offset:38912
  s_waitcnt lgkmcnt(2)
  v_mfma_f32_32x32x16_bf16 v[0:15], a[24:27], v[40:43], v[0:15]
  ds_read_b128 v[36:39], v204 offset:38912
  s_waitcnt lgkmcnt(2)
  v_mfma_f32_32x32x16_bf16 v[0:15], a[28:31], v[44:47], v[0:15]
  ds_read_b128 v[40:43], v205 offset:38912
  s_waitcnt lgkmcnt(2)
  v_mfma_f32_32x32x16_bf16 v[0:15], a[32:35], v[32:35], v[0:15]
  ds_read_b128 v[44:47], v206 offset:38912
  s_waitcnt lgkmcnt(2)
  v_mfma_f32_32x32x16_bf16 v[0:15], a[36:39], v[36:39], v[0:15]
  ds_read_b128 v[32:35], v203 offset:39936
  s_waitcnt lgkmcnt(2)
  v_mfma_f32_32x32x16_bf16 v[0:15], a[40:43], v[40:43], v[0:15]
  ds_read_b128 v[36:39], v204 offset:39936
  s_waitcnt lgkmcnt(2)
  v_mfma_f32_32x32x16_bf16 v[0:15], a[44:47], v[44:47], v[0:15]
  ds_read_b128 v[40:43], v205 offset:39936
  s_waitcnt lgkmcnt(2)
  v_mfma_f32_32x32x16_bf16 v[0:15], a[48:51], v[32:35], v[0:15]
  ds_read_b128 v[44:47], v206 offset:39936
  s_waitcnt lgkmcnt(2)
  v_mfma_f32_32x32x16_bf16 v[0:15], a[52:55], v[36:39], v[0:15]
  ds_read_b128 v[32:35], v203 offset:40960
  s_waitcnt lgkmcnt(2)
  v_mfma_f32_32x32x16_bf16 v[0:15], a[56:59], v[40:43], v[0:15]
  ds_read_b128 v[36:39], v204 offset:40960
  s_waitcnt lgkmcnt(2)
  v_mfma_f32_32x32x16_bf16 v[0:15], a[60:63], v[44:47], v[0:15]
  ds_read_b128 v[40:43], v205 offset:40960
  s_waitcnt lgkmcnt(2)
  v_mfma_f32_32x32x16_bf16 v[0:15], a[64:67], v[32:35], v[0:15]
  ds_read_b128 v[44:47], v206 offset:40960
  s_waitcnt lgkmcnt(2)
  v_mfma_f32_32x32x16_bf16 v[0:15], a[68:71], v[36:39], v[0:15]
  ds_read_b128 v[32:35], v203 offset:41984
  s_waitcnt lgkmcnt(2)
  v_mfma_f32_32x32x16_bf16 v[0:15], a[72:75], v[40:43], v[0:15]
  ds_read_b128 v[36:39], v204 offset:41984
  s_waitcnt lgkmcnt(2)
  v_mfma_f32_32x32x16_bf16 v[0:15], a[76:79], v[44:47], v[0:15]
  ds_read_b128 v[40:43], v205 offset:41984
  s_waitcnt lgkmcnt(2)
  v_mfma_f32_32x32x16_bf16 v[0:15], a[80:83], v[32:35], v[0:15]
  ds_read_b128 v[44:47], v206 offset:41984
  s_waitcnt lgkmcnt(2)
  v_mfma_f32_32x32x16_bf16 v[0:15], a[84:87], v[36:39], v[0:15]
  ds_read_b128 v[32:35], v203 offset:43008
  s_waitcnt lgkmcnt(2)
  v_mfma_f32_32x32x16_bf16 v[0:15], a[88:91], v[40:43], v[0:15]
  ds_read_b128 v[36:39], v204 offset:43008
  s_waitcnt lgkmcnt(2)
  v_mfma_f32_32x32x16_bf16 v[0:15], a[92:95], v[44:47], v[0:15]
  ds_read_b128 v[40:43], v205 offset:43008
  s_waitcnt lgkmcnt(2)
  v_mfma_f32_32x32x16_bf16 v[0:15], a[96:99], v[32:35], v[0:15]
  ds_read_b128 v[44:47], v206 offset:43008
  s_waitcnt lgkmcnt(2)
  v_mfma_f32_32x32x16_bf16 v[0:15], a[100:103], v[36:39], v[0:15]
  ds_read_b128 v[32:35], v203 offset:44032
  s_waitcnt lgkmcnt(2)
  v_mfma_f32_32x32x16_bf16 v[0:15], a[104:107], v[40:43], v[0:15]
  ds_read_b128 v[36:39], v204 offset:44032
  s_waitcnt lgkmcnt(2)
  v_mfma_f32_32x32x16_bf16 v[0:15], a[108:111], v[44:47], v[0:15]
  ds_read_b128 v[40:43], v205 offset:44032
  s_waitcnt lgkmcnt(2)
  v_mfma_f32_32x32x16_bf16 v[0:15], a[112:115], v[32:35], v[0:15]
  ds_read_b128 v[44:47], v206 offset:44032
  s_waitcnt lgkmcnt(2)
  v_mfma_f32_32x32x16_bf16 v[0:15], a[116:119], v[36:39], v[0:15]
  ds_read_b128 v[32:35], v203 offset:45056
  s_waitcnt lgkmcnt(2)
  v_mfma_f32_32x32x16_bf16 v[0:15], a[120:123], v[40:43], v[0:15]
  ds_read_b128 v[36:39], v204 offset:45056
  s_waitcnt lgkmcnt(2)
  v_mfma_f32_32x32x16_bf16 v[0:15], a[124:127], v[44:47], v[0:15]
  ds_read_b128 v[40:43], v205 offset:45056
  s_waitcnt lgkmcnt(2)
  v_mfma_f32_32x32x16_bf16 v[0:15], a[128:131], v[32:35], v[0:15]
  ds_read_b128 v[44:47], v206 offset:45056
  s_waitcnt lgkmcnt(2)
  v_mfma_f32_32x32x16_bf16 v[0:15], a[132:135], v[36:39], v[0:15]
  s_waitcnt lgkmcnt(1)
  v_mfma_f32_32x32x16_bf16 v[0:15], a[136:139], v[40:43], v[0:15]
  s_waitcnt lgkmcnt(0)
  v_mfma_f32_32x32x16_bf16 v[0:15], a[140:143], v[44:47], v[0:15]
  s_nop 11
  v_cvt_pk_bf16_f32 v16, v0, v4
  v_cvt_pk_bf16_f32 v17, v1, v5
  v_cvt_pk_bf16_f32 v18, v2, v6
  v_cvt_pk_bf16_f32 v19, v3, v7
  ds_write_b128 v215, v[16:19] offset:0
  v_cvt_pk_bf16_f32 v20, v8, v12
  v_cvt_pk_bf16_f32 v21, v9, v13
  v_cvt_pk_bf16_f32 v22, v10, v14
  v_cvt_pk_bf16_f32 v23, v11, v15
  ds_write_b128 v215, v[20:23] offset:1024
  s_waitcnt lgkmcnt(0)
  s_barrier
  ds_read_b128 v[96:99], v208 offset:0
  ds_read_b128 v[100:103], v208 offset:1024
  ds_read_b128 v[104:107], v208 offset:2048
  ds_read_b128 v[108:111], v208 offset:3072
  ds_read_b128 v[112:115], v208 offset:4096
  ds_read_b128 v[116:119], v208 offset:5120
  ds_read_b128 v[120:123], v208 offset:6144
  ds_read_b128 v[124:127], v208 offset:7168
  s_waitcnt vmcnt(18) lgkmcnt(7)
  v_mfma_f32_32x32x16_bf16 v[64:79], v[128:131], v[96:99], v[48:63]
  s_waitcnt vmcnt(17) lgkmcnt(6)
  v_mfma_f32_32x32x16_bf16 v[64:79], v[132:135], v[100:103], v[64:79]
  s_waitcnt vmcnt(16) lgkmcnt(5)
  v_mfma_f32_32x32x16_bf16 v[64:79], v[136:139], v[104:107], v[64:79]
  s_waitcnt vmcnt(15) lgkmcnt(4)
  v_mfma_f32_32x32x16_bf16 v[64:79], v[140:143], v[108:111], v[64:79]
  s_waitcnt vmcnt(14) lgkmcnt(3)
  v_mfma_f32_32x32x16_bf16 v[64:79], v[144:147], v[112:115], v[64:79]
  s_waitcnt vmcnt(13) lgkmcnt(2)
  v_mfma_f32_32x32x16_bf16 v[64:79], v[148:151], v[116:119], v[64:79]
  s_waitcnt vmcnt(12) lgkmcnt(1)
  v_mfma_f32_32x32x16_bf16 v[64:79], v[152:155], v[120:123], v[64:79]
  s_waitcnt vmcnt(11) lgkmcnt(0)
  v_mfma_f32_32x32x16_bf16 v[64:79], v[156:159], v[124:127], v[64:79]
  s_add_u32 s70, s59, 2
  s_lshl_b32 s55, s64, 12
  s_add_u32 s55, s55, 34603008
  s_nop 8
  v_max3_f32 v16, v64, v65, v66
  v_max3_f32 v16, v16, v67, v68
  v_max3_f32 v16, v16, v69, v70
  v_max3_f32 v16, v16, v71, v72
  v_max3_f32 v16, v16, v73, v74
  v_max3_f32 v16, v16, v75, v76
  v_max3_f32 v16, v16, v77, v78
  v_max_f32 v16, v16, v79
  s_waitcnt vmcnt(0)
  s_cmp_eq_u32 s52, 0
  s_cbranch_scc0 AT_m1_d
  s_mov_b32 exec_hi, 0
  s_mov_b32 exec_lo, 1
AT_m1:
  buffer_load_dword v211, v201, s[8:11], s69 offen sc1
  s_add_u32 s65, s65, 1
  s_waitcnt vmcnt(0)
  v_cmp_gt_u32 vcc, s70, v211
  s_cbranch_vccz AT_m1_x
  s_sleep 1
  s_cmp_lt_u32 s65, 131072
  s_cbranch_scc1 AT_m1
AT_m1_x:
  s_mov_b64 exec, -1
AT_m1_d:
  s_barrier
  buffer_load_dwordx2 v[128:129], v218, s[8:11], s55 offen offset:0 sc1
  buffer_load_dwordx2 v[130:131], v218, s[8:11], s55 offen offset:1024 sc1
  buffer_load_dwordx2 v[132:133], v218, s[8:11], s55 offen offset:256 sc1
  buffer_load_dwordx2 v[134:135], v218, s[8:11], s55 offen offset:1280 sc1
  buffer_load_dwordx2 v[136:137], v218, s[8:11], s55 offen offset:512 sc1
  buffer_load_dwordx2 v[138:139], v218, s[8:11], s55 offen offset:1536 sc1
  buffer_load_dwordx2 v[140:141], v218, s[8:11], s55 offen offset:768 sc1
  buffer_load_dwordx2 v[142:143], v218, s[8:11], s55 offen offset:1792 sc1
  buffer_load_dwordx2 v[144:145], v218, s[8:11], s55 offen offset:2048 sc1
  buffer_load_dwordx2 v[146:147], v218, s[8:11], s55 offen offset:3072 sc1
  buffer_load_dwordx2 v[148:149], v218, s[8:11], s55 offen offset:2304 sc1
  buffer_load_dwordx2 v[150:151], v218, s[8:11], s55 offen offset:3328 sc1
  buffer_load_dwordx2 v[152:153], v218, s[8:11], s55 offen offset:2560 sc1
  buffer_load_dwordx2 v[154:155], v218, s[8:11], s55 offen offset:3584 sc1
  buffer_load_dwordx2 v[156:157], v218, s[8:11], s55 offen offset:2816 sc1
  buffer_load_dwordx2 v[158:159], v218, s[8:11], s55 offen offset:3840 sc1
  buffer_load_dword v168, v219, s[8:11], s55 offen offset:0 sc1
  buffer_load_dword v169, v219, s[8:11], s55 offen offset:256 sc1
  s_waitcnt vmcnt(16)
  v_mfma_f32_32x32x16_bf16 v[80:95], v[128:131], v[96:99], 0
  s_waitcnt vmcnt(14)
  v_mfma_f32_32x32x16_bf16 v[80:95], v[132:135], v[100:103], v[80:95]
  s_waitcnt vmcnt(12)
  v_mfma_f32_32x32x16_bf16 v[80:95], v[136:139], v[104:107], v[80:95]
  s_waitcnt vmcnt(10)
  v_mfma_f32_32x32x16_bf16 v[80:95], v[140:143], v[108:111], v[80:95]
  s_waitcnt vmcnt(8)
  v_mfma_f32_32x32x16_bf16 v[80:95], v[144:147], v[112:115], v[80:95]
  s_waitcnt vmcnt(6)
  v_mfma_f32_32x32x16_bf16 v[80:95], v[148:151], v[116:119], v[80:95]
  s_waitcnt vmcnt(4)
  v_mfma_f32_32x32x16_bf16 v[80:95], v[152:155], v[120:123], v[80:95]
  s_waitcnt vmcnt(2)
  v_mfma_f32_32x32x16_bf16 v[80:95], v[156:159], v[124:127], v[80:95]
  s_lshl_b32 s64, s64, 13
  s_lshl_b32 s54, s52, 11
  s_add_u32 s64, s64, s54
  s_add_u32 s64, s64, 44040192
  s_nop 7
  v_mul_f32 v80, s68, v80
  v_mul_f32 v81, s68, v81
  v_mul_f32 v82, s68, v82
  v_mul_f32 v83, s68, v83
  v_max3_f32 v16, v16, v80, v81
  v_max3_f32 v16, v16, v82, v83
  v_mov_b32 v17, v16
  s_nop 1
  v_permlane32_swap_b32 v16, v17
  v_max_f32 v16, v16, v17
  v_sub_f32 v64, v64, v16
  v_sub_f32 v65, v65, v16
  v_sub_f32 v66, v66, v16
  v_sub_f32 v67, v67, v16
  v_sub_f32 v68, v68, v16
  v_sub_f32 v69, v69, v16
  v_sub_f32 v70, v70, v16
  v_sub_f32 v71, v71, v16
  v_sub_f32 v72, v72, v16
  v_sub_f32 v73, v73, v16
  v_sub_f32 v74, v74, v16
  v_sub_f32 v75, v75, v16
  v_sub_f32 v76, v76, v16
  v_sub_f32 v77, v77, v16
  v_sub_f32 v78, v78, v16
  v_sub_f32 v79, v79, v16
  v_sub_f32 v80, v80, v16
  v_sub_f32 v81, v81, v16
  v_sub_f32 v82, v82, v16
  v_sub_f32 v83, v83, v16
  v_exp_f32 v64, v64
  v_exp_f32 v65, v65
  v_exp_f32 v66, v66
  v_exp_f32 v67, v67
  v_exp_f32 v68, v68
  v_exp_f32 v69, v69
  v_exp_f32 v70, v70
  v_exp_f32 v71, v71
  v_exp_f32 v72, v72
  v_exp_f32 v73, v73
  v_exp_f32 v74, v74
  v_exp_f32 v75, v75
  v_exp_f32 v76, v76
  v_exp_f32 v77, v77
  v_exp_f32 v78, v78
  v_exp_f32 v79, v79
  v_exp_f32 v80, v80
  v_exp_f32 v81, v81
  v_exp_f32 v82, v82
  v_exp_f32 v83, v83
  v_cvt_pk_bf16_f32 v20, v64, v65
  v_cvt_pk_bf16_f32 v21, v68, v69
  v_cvt_pk_bf16_f32 v22, v72, v73
  v_cvt_pk_bf16_f32 v23, v76, v77
  v_cvt_pk_bf16_f32 v24, v66, v67
  v_cvt_pk_bf16_f32 v25, v70, v71
  v_cvt_pk_bf16_f32 v26, v74, v75
  v_cvt_pk_bf16_f32 v27, v78, v79
  v_cvt_pk_bf16_f32 v28, v80, v81
  v_cvt_pk_bf16_f32 v29, v82, v83
  v_mfma_f32_32x32x16_bf16 v[0:15], v[160:163], v[20:23], 0
  v_add_f32 v16, v64, v65
  v_add_f32 v16, v16, v66
  v_add_f32 v16, v16, v67
  v_add_f32 v16, v16, v68
  v_add_f32 v16, v16, v69
  v_add_f32 v16, v16, v70
  v_add_f32 v16, v16, v71
  v_mfma_f32_32x32x16_bf16 v[0:15], v[164:167], v[24:27], v[0:15]
  v_add_f32 v16, v16, v72
  v_add_f32 v16, v16, v73
  v_add_f32 v16, v16, v74
  v_add_f32 v16, v16, v75
  v_add_f32 v16, v16, v76
  v_add_f32 v16, v16, v77
  s_waitcnt vmcnt(0)
  v_mfma_f32_32x32x8_bf16 v[0:15], v[168:169], v[28:29], v[0:15]
  v_add_f32 v16, v16, v78
  v_add_f32 v16, v16, v79
  v_add_f32 v16, v16, v80
  v_add_f32 v16, v16, v81
  v_add_f32 v16, v16, v82
  v_add_f32 v16, v16, v83
  v_mov_b32 v17, v16
  s_nop 1
  v_permlane32_swap_b32 v16, v17
  v_add_f32 v16, v16, v17
  v_rcp_f32 v16, v16
  s_nop 0
  v_mul_f32 v0, v16, v0
  v_mul_f32 v1, v16, v1
  v_mul_f32 v2, v16, v2
  v_mul_f32 v3, v16, v3
  v_mul_f32 v4, v16, v4
  v_mul_f32 v5, v16, v5
  v_mul_f32 v6, v16, v6
  v_mul_f32 v7, v16, v7
  v_cvt_pk_bf16_f32 v20, v0, v1
  v_cvt_pk_bf16_f32 v21, v2, v3
  v_cvt_pk_bf16_f32 v22, v4, v5
  v_cvt_pk_bf16_f32 v23, v6, v7
  buffer_store_dwordx4 v[20:23], v201, s[8:11], s64 offen offset:0 sc1
  v_mul_f32 v8, v16, v8
  v_mul_f32 v9, v16, v9
  v_mul_f32 v10, v16, v10
  v_mul_f32 v11, v16, v11
  v_mul_f32 v12, v16, v12
  v_mul_f32 v13, v16, v13
  v_mul_f32 v14, v16, v14
  v_mul_f32 v15, v16, v15
  v_cvt_pk_bf16_f32 v24, v8, v9
  v_cvt_pk_bf16_f32 v25, v10, v11
  v_cvt_pk_bf16_f32 v26, v12, v13
  v_cvt_pk_bf16_f32 v27, v14, v15
  buffer_store_dwordx4 v[24:27], v201, s[8:11], s64 offen offset:1024 sc1
  s_add_u32 s59, s59, 3
  v_mov_b32 v212, s59
  s_waitcnt vmcnt(0)
  s_barrier
  s_cmp_eq_u32 s52, 0
  s_cselect_b32 s54, s71, 268435456
  s_mov_b64 exec, 1
  buffer_store_dword v212, v201, s[8:11], s54 offen sc1
  s_mov_b64 exec, -1
  s_cmp_ge_u32 s59, 64
  s_cbranch_scc1 L_exit
  s_branch AT_loop
W_a:
  s_sub_u32 s54, s53, 96
  s_lshr_b32 s68, s54, 4
  s_and_b32 s69, s54, 15
  s_lshl_b32 s60, s69, 2
  s_sub_u32 s60, s60, 1
  s_max_i32 s60, s60, 0
  s_mul_i32 s60, s60, 36864
  s_add_u32 m0, s67, 0
  s_nop 0
  buffer_load_dwordx4 v202, s[4:7], s60 offen offset:0 lds
  s_add_u32 m0, s67, 896
  s_nop 0
  buffer_load_dwordx4 v202, s[4:7], s60 offen offset:128 lds
  s_add_u32 m0, s67, 1792
  s_nop 0
  buffer_load_dwordx4 v202, s[4:7], s60 offen offset:256 lds
  s_add_u32 m0, s67, 2688
  s_nop 0
  buffer_load_dwordx4 v202, s[4:7], s60 offen offset:384 lds
  s_add_u32 m0, s67, 3584
  s_nop 0
  buffer_load_dwordx4 v202, s[4:7], s60 offen offset:512 lds
  s_add_u32 m0, s67, 4480
  s_nop 0
  buffer_load_dwordx4 v202, s[4:7], s60 offen offset:640 lds
  s_add_u32 m0, s67, 5376
  s_nop 0
  buffer_load_dwordx4 v202, s[4:7], s60 offen offset:768 lds
  s_add_u32 m0, s67, 6272
  s_nop 0
  buffer_load_dwordx4 v202, s[4:7], s60 offen offset:896 lds
  s_add_u32 m0, s67, 7168
  s_nop 0
  buffer_load_dwordx4 v202, s[4:7], s60 offen offset:1024 lds
  v_and_b32 v211, 15, v200
  v_mul_u32_u24 v211, 72, v211
  v_lshrrev_b32 v212, 4, v200
  v_mul_u32_u24 v213, 1152, v212
  v_add_u32 v213, v213, v211
  s_lshl_b32 s54, s54, 2
  s_add_u32 s70, s54, s52
  s_mul_i32 s55, s70, 4608
  buffer_load_dwordx4 v[48:51], v213, s[4:7], s55 offen offset:0
  buffer_load_dwordx4 v[52:55], v213, s[4:7], s55 offen offset:16
  buffer_load_dwordx4 v[56:59], v213, s[4:7], s55 offen offset:32
  buffer_load_dwordx4 v[60:63], v213, s[4:7], s55 offen offset:48
  buffer_load_dwordx2 v[64:65], v213, s[4:7], s55 offen offset:64
  buffer_load_dwordx4 v[68:71], v211, s[44:47], 0 offen offset:0
  buffer_load_dwordx4 v[72:75], v211, s[44:47], 0 offen offset:16
  buffer_load_dwordx4 v[76:79], v211, s[44:47], 0 offen offset:32
  buffer_load_dwordx4 v[80:83], v211, s[44:47], 0 offen offset:48
  buffer_load_dwordx2 v[84:85], v211, s[44:47], 0 offen offset:64
  v_mov_b32 v0, 0
  v_mov_b32 v1, 0x3f803f80
  s_waitcnt vmcnt(9)
  v_lshlrev_b32 v2, 16, v48
  s_waitcnt vmcnt(4)
  v_lshlrev_b32 v3, 16, v68
  v_and_b32 v4, 0xffff0000, v48
  v_and_b32 v5, 0xffff0000, v68
  v_mul_f32 v2, v2, v3
  v_mul_f32 v4, v4, v5
  v_cvt_pk_bf16_f32 v2, v2, v4
  v_lshlrev_b32 v3, 16, v2
  v_and_b32 v4, 0xffff0000, v2
  v_add_f32 v0, v0, v3
  v_add_f32 v0, v0, v4
  v_lshlrev_b32 v2, 16, v49
  v_lshlrev_b32 v3, 16, v69
  v_and_b32 v4, 0xffff0000, v49
  v_and_b32 v5, 0xffff0000, v69
  v_mul_f32 v2, v2, v3
  v_mul_f32 v4, v4, v5
  v_cvt_pk_bf16_f32 v2, v2, v4
  v_lshlrev_b32 v3, 16, v2
  v_and_b32 v4, 0xffff0000, v2
  v_add_f32 v0, v0, v3
  v_add_f32 v0, v0, v4
  v_lshlrev_b32 v2, 16, v50
  v_lshlrev_b32 v3, 16, v70
  v_and_b32 v4, 0xffff0000, v50
  v_and_b32 v5, 0xffff0000, v70
  v_mul_f32 v2, v2, v3
  v_mul_f32 v4, v4, v5
  v_cvt_pk_bf16_f32 v2, v2, v4
  v_lshlrev_b32 v3, 16, v2
  v_and_b32 v4, 0xffff0000, v2
  v_add_f32 v0, v0, v3
  v_add_f32 v0, v0, v4
  v_lshlrev_b32 v2, 16, v51
  v_lshlrev_b32 v3, 16, v71
  v_and_b32 v4, 0xffff0000, v51
  v_and_b32 v5, 0xffff0000, v71
  v_mul_f32 v2, v2, v3
  v_mul_f32 v4, v4, v5
  v_cvt_pk_bf16_f32 v2, v2, v4
  v_lshlrev_b32 v3, 16, v2
  v_and_b32 v4, 0xffff0000, v2
  v_add_f32 v0, v0, v3
  v_add_f32 v0, v0, v4
  v_lshlrev_b32 v2, 16, v52
  s_waitcnt vmcnt(3)
  v_lshlrev_b32 v3, 16, v72
  v_and_b32 v4, 0xffff0000, v52
  v_and_b32 v5, 0xffff0000, v72
  v_mul_f32 v2, v2, v3
  v_mul_f32 v4, v4, v5
  v_cvt_pk_bf16_f32 v2, v2, v4
  v_lshlrev_b32 v3, 16, v2
  v_and_b32 v4, 0xffff0000, v2
  v_add_f32 v0, v0, v3
  v_add_f32 v0, v0, v4
  v_lshlrev_b32 v2, 16, v53
  v_lshlrev_b32 v3, 16, v73
  v_and_b32 v4, 0xffff0000, v53
  v_and_b32 v5, 0xffff0000, v73
  v_mul_f32 v2, v2, v3
  v_mul_f32 v4, v4, v5
  v_cvt_pk_bf16_f32 v2, v2, v4
  v_lshlrev_b32 v3, 16, v2
  v_and_b32 v4, 0xffff0000, v2
  v_add_f32 v0, v0, v3
  v_add_f32 v0, v0, v4
  v_lshlrev_b32 v2, 16, v54
  v_lshlrev_b32 v3, 16, v74
  v_and_b32 v4, 0xffff0000, v54
  v_and_b32 v5, 0xffff0000, v74
  v_mul_f32 v2, v2, v3
  v_mul_f32 v4, v4, v5
  v_cvt_pk_bf16_f32 v2, v2, v4
  v_lshlrev_b32 v3, 16, v2
  v_and_b32 v4, 0xffff0000, v2
  v_add_f32 v0, v0, v3
  v_add_f32 v0, v0, v4
  v_lshlrev_b32 v2, 16, v55
  v_lshlrev_b32 v3, 16, v75
  v_and_b32 v4, 0xffff0000, v55
  v_and_b32 v5, 0xffff0000, v75
  v_mul_f32 v2, v2, v3
  v_mul_f32 v4, v4, v5
  v_cvt_pk_bf16_f32 v2, v2, v4
  v_lshlrev_b32 v3, 16, v2
  v_and_b32 v4, 0xffff0000, v2
  v_add_f32 v0, v0, v3
  v_add_f32 v0, v0, v4
  v_lshlrev_b32 v2, 16, v56
  s_waitcnt vmcnt(2)
  v_lshlrev_b32 v3, 16, v76
  v_and_b32 v4, 0xffff0000, v56
  v_and_b32 v5, 0xffff0000, v76
  v_mul_f32 v2, v2, v3
  v_mul_f32 v4, v4, v5
  v_cvt_pk_bf16_f32 v2, v2, v4
  v_lshlrev_b32 v3, 16, v2
  v_and_b32 v4, 0xffff0000, v2
  v_add_f32 v0, v0, v3
  v_add_f32 v0, v0, v4
  v_lshlrev_b32 v2, 16, v57
  v_lshlrev_b32 v3, 16, v77
  v_and_b32 v4, 0xffff0000, v57
  v_and_b32 v5, 0xffff0000, v77
  v_mul_f32 v2, v2, v3
  v_mul_f32 v4, v4, v5
  v_cvt_pk_bf16_f32 v2, v2, v4
  v_lshlrev_b32 v3, 16, v2
  v_and_b32 v4, 0xffff0000, v2
  v_add_f32 v0, v0, v3
  v_add_f32 v0, v0, v4
  v_lshlrev_b32 v2, 16, v58
  v_lshlrev_b32 v3, 16, v78
  v_and_b32 v4, 0xffff0000, v58
  v_and_b32 v5, 0xffff0000, v78
  v_mul_f32 v2, v2, v3
  v_mul_f32 v4, v4, v5
  v_cvt_pk_bf16_f32 v2, v2, v4
  v_lshlrev_b32 v3, 16, v2
  v_and_b32 v4, 0xffff0000, v2
  v_add_f32 v0, v0, v3
  v_add_f32 v0, v0, v4
  v_lshlrev_b32 v2, 16, v59
  v_lshlrev_b32 v3, 16, v79
  v_and_b32 v4, 0xffff0000, v59
  v_and_b32 v5, 0xffff0000, v79
  v_mul_f32 v2, v2, v3
  v_mul_f32 v4, v4, v5
  v_cvt_pk_bf16_f32 v2, v2, v4
  v_lshlrev_b32 v3, 16, v2
  v_and_b32 v4, 0xffff0000, v2
  v_add_f32 v0, v0, v3
  v_add_f32 v0, v0, v4
  v_lshlrev_b32 v2, 16, v60
  s_waitcnt vmcnt(1)
  v_lshlrev_b32 v3, 16, v80
  v_and_b32 v4, 0xffff0000, v60
  v_and_b32 v5, 0xffff0000, v80
  v_mul_f32 v2, v2, v3
  v_mul_f32 v4, v4, v5
  v_cvt_pk_bf16_f32 v2, v2, v4
  v_lshlrev_b32 v3, 16, v2
  v_and_b32 v4, 0xffff0000, v2
  v_add_f32 v0, v0, v3
  v_add_f32 v0, v0, v4
  v_lshlrev_b32 v2, 16, v61
  v_lshlrev_b32 v3, 16, v81
  v_and_b32 v4, 0xffff0000, v61
  v_and_b32 v5, 0xffff0000, v81
  v_mul_f32 v2, v2, v3
  v_mul_f32 v4, v4, v5
  v_cvt_pk_bf16_f32 v2, v2, v4
  v_lshlrev_b32 v3, 16, v2
  v_and_b32 v4, 0xffff0000, v2
  v_add_f32 v0, v0, v3
  v_add_f32 v0, v0, v4
  v_lshlrev_b32 v2, 16, v62
  v_lshlrev_b32 v3, 16, v82
  v_and_b32 v4, 0xffff0000, v62
  v_and_b32 v5, 0xffff0000, v82
  v_mul_f32 v2, v2, v3
  v_mul_f32 v4, v4, v5
  v_cvt_pk_bf16_f32 v2, v2, v4
  v_lshlrev_b32 v3, 16, v2
  v_and_b32 v4, 0xffff0000, v2
  v_add_f32 v0, v0, v3
  v_add_f32 v0, v0, v4
  v_lshlrev_b32 v2, 16, v63
  v_lshlrev_b32 v3, 16, v83
  v_and_b32 v4, 0xffff0000, v63
  v_and_b32 v5, 0xffff0000, v83
  v_mul_f32 v2, v2, v3
  v_mul_f32 v4, v4, v5
  v_cvt_pk_bf16_f32 v2, v2, v4
  v_lshlrev_b32 v3, 16, v2
  v_and_b32 v4, 0xffff0000, v2
  v_add_f32 v0, v0, v3
  v_add_f32 v0, v0, v4
  v_lshlrev_b32 v2, 16, v64
  s_waitcnt vmcnt(0)
  v_lshlrev_b32 v3, 16, v84
  v_and_b32 v4, 0xffff0000, v64
  v_and_b32 v5, 0xffff0000, v84
  v_mul_f32 v2, v2, v3
  v_mul_f32 v4, v4, v5
  v_cvt_pk_bf16_f32 v2, v2, v4
  v_lshlrev_b32 v3, 16, v2
  v_and_b32 v4, 0xffff0000, v2
  v_add_f32 v0, v0, v3
  v_add_f32 v0, v0, v4
  v_lshlrev_b32 v2, 16, v65
  v_lshlrev_b32 v3, 16, v85
  v_and_b32 v4, 0xffff0000, v65
  v_and_b32 v5, 0xffff0000, v85
  v_mul_f32 v2, v2, v3
  v_mul_f32 v4, v4, v5
  v_cvt_pk_bf16_f32 v2, v2, v4
  v_lshlrev_b32 v3, 16, v2
  v_and_b32 v4, 0xffff0000, v2
  v_add_f32 v0, v0, v3
  v_add_f32 v0, v0, v4
  s_nop 1
  v_add_f32_dpp v0, v0, v0 row_ror:1 row_mask:0xf bank_mask:0xf
  s_nop 1
  v_add_f32_dpp v0, v0, v0 row_ror:2 row_mask:0xf bank_mask:0xf
  s_nop 1
  v_add_f32_dpp v0, v0, v0 row_ror:4 row_mask:0xf bank_mask:0xf
  s_nop 1
  v_add_f32_dpp v0, v0, v0 row_ror:8 row_mask:0xf bank_mask:0xf
  v_cvt_pk_bf16_f32 v0, v0, v0
  v_lshlrev_b32 v0, 16, v0
  v_mul_f32 v0, 3216550459, v0
  v_exp_f32 v0, v0
  s_nop 0
  v_add_f32 v0, 1.0, v0
  v_rcp_f32 v0, v0
  s_nop 0
  v_cvt_pk_bf16_f32 v0, v0, v0
  v_lshlrev_b32 v0, 16, v0
  v_lshlrev_b32 v212, 2, v212
  s_lshl_b32 s55, s70, 4
  s_add_u32 s55, s55, 67108864
  s_mov_b32 exec_lo, 0x00010001
  s_mov_b32 exec_hi, 0x00010001
  buffer_store_dword v0, v212, s[8:11], s55 offen sc1
  s_mov_b64 exec, -1
  v_lshrrev_b32 v211, 4, v200
  v_lshlrev_b32 v212, 2, v211
  v_and_b32 v213, 15, v200
  v_xor_b32 v212, v212, v213
  v_mul_u32_u24 v211, 3456, v211
  v_mov_b32 v2, 0x40000000
  v_add_u32 v213, 0, v212
  v_mul_u32_u24 v214, 57, v213
  v_lshrrev_b32 v214, 9, v214
  v_mul_u32_u24 v214, 1008, v214
  v_lshl_add_u32 v214, v213, 4, v214
  v_add_u32 v214, v214, v211
  v_cmp_lt_u32 vcc, 26, v213
  s_nop 1
  v_cndmask_b32 v207, v214, v2, vcc
  v_add_u32 v213, 16, v212
  v_mul_u32_u24 v214, 57, v213
  v_lshrrev_b32 v214, 9, v214
  v_mul_u32_u24 v214, 1008, v214
  v_lshl_add_u32 v214, v213, 4, v214
  v_add_u32 v214, v214, v211
  v_cmp_lt_u32 vcc, 26, v213
  s_nop 1
  v_cndmask_b32 v208, v214, v2, vcc
  s_mul_i32 s62, s68, 144
  s_mul_i32 s54, s52, 13824
  s_add_u32 s62, s62, s54
  s_waitcnt vmcnt(0)
  s_lshl_b32 s61, s52, 10
  s_add_u32 s61, s61, 36864
  s_add_u32 m0, s61, 0
  s_add_u32 s54, s62, 0
  buffer_load_dwordx4 v207, s[36:39], s54 offen lds
  s_add_u32 m0, s61, 4096
  s_add_u32 s54, s62, 55296
  buffer_load_dwordx4 v207, s[36:39], s54 offen lds
  s_add_u32 m0, s61, 8192
  s_add_u32 s54, s62, 110592
  buffer_load_dwordx4 v207, s[36:39], s54 offen lds
  s_add_u32 m0, s61, 12288
  s_add_u32 s54, s62, 165888
  buffer_load_dwordx4 v207, s[36:39], s54 offen lds
  s_add_u32 m0, s61, 16384
  s_add_u32 s54, s62, 0
  buffer_load_dwordx4 v208, s[36:39], s54 offen lds
  s_add_u32 m0, s61, 20480
  s_add_u32 s54, s62, 55296
  buffer_load_dwordx4 v208, s[36:39], s54 offen lds
  s_add_u32 m0, s61, 24576
  s_add_u32 s54, s62, 110592
  buffer_load_dwordx4 v208, s[36:39], s54 offen lds
  s_add_u32 m0, s61, 28672
  s_add_u32 s54, s62, 165888
  buffer_load_dwordx4 v208, s[36:39], s54 offen lds
  s_add_u32 m0, s61, 32768
  s_add_u32 s54, s62, 221184
  buffer_load_dwordx4 v207, s[36:39], s54 offen lds
  s_add_u32 m0, s61, 36864
  s_add_u32 s54, s62, 276480
  buffer_load_dwordx4 v207, s[36:39], s54 offen lds
  s_add_u32 m0, s61, 40960
  s_add_u32 s54, s62, 331776
  buffer_load_dwordx4 v207, s[36:39], s54 offen lds
  s_add_u32 m0, s61, 45056
  s_add_u32 s54, s62, 387072
  buffer_load_dwordx4 v207, s[36:39], s54 offen lds
  s_add_u32 m0, s61, 49152
  s_add_u32 s54, s62, 221184
  buffer_load_dwordx4 v208, s[36:39], s54 offen lds
  s_add_u32 m0, s61, 53248
  s_add_u32 s54, s62, 276480
  buffer_load_dwordx4 v208, s[36:39], s54 offen lds
  s_add_u32 m0, s61, 57344
  s_add_u32 s54, s62, 331776
  buffer_load_dwordx4 v208, s[36:39], s54 offen lds
  s_add_u32 m0, s61, 61440
  s_add_u32 s54, s62, 387072
  buffer_load_dwordx4 v208, s[36:39], s54 offen lds
  s_add_u32 m0, s61, 65536
  s_add_u32 s54, s62, 442368
  buffer_load_dwordx4 v207, s[36:39], s54 offen lds
  s_add_u32 m0, s61, 69632
  s_add_u32 s54, s62, 497664
  buffer_load_dwordx4 v207, s[36:39], s54 offen lds
  s_add_u32 m0, s61, 73728
  s_add_u32 s54, s62, 552960
  buffer_load_dwordx4 v207, s[36:39], s54 offen lds
  s_add_u32 m0, s61, 77824
  s_add_u32 s54, s62, 608256
  buffer_load_dwordx4 v207, s[36:39], s54 offen lds
  s_add_u32 m0, s61, 81920
  s_add_u32 s54, s62, 442368
  buffer_load_dwordx4 v208, s[36:39], s54 offen lds
  s_add_u32 m0, s61, 86016
  s_add_u32 s54, s62, 497664
  buffer_load_dwordx4 v208, s[36:39], s54 offen lds
  s_add_u32 m0, s61, 90112
  s_add_u32 s54, s62, 552960
  buffer_load_dwordx4 v208, s[36:39], s54 offen lds
  s_add_u32 m0, s61, 94208
  s_add_u32 s54, s62, 608256
  buffer_load_dwordx4 v208, s[36:39], s54 offen lds
  s_waitcnt vmcnt(20) lgkmcnt(0)
  s_barrier
  s_add_u32 m0, s61, 98304
  s_add_u32 s54, s62, 663552
  buffer_load_dwordx4 v207, s[36:39], s54 offen lds
  s_add_u32 m0, s61, 102400
  s_add_u32 s54, s62, 718848
  buffer_load_dwordx4 v207, s[36:39], s54 offen lds
  s_add_u32 m0, s61, 106496
  s_add_u32 s54, s62, 774144
  buffer_load_dwordx4 v207, s[36:39], s54 offen lds
  s_add_u32 m0, s61, 110592
  s_add_u32 s54, s62, 829440
  buffer_load_dwordx4 v207, s[36:39], s54 offen lds
  v_add_u32 v215, 36864, v210
  ds_read_b64_tr_b16 a[0:1], v215 offset:0
  ds_read_b64_tr_b16 a[2:3], v215 offset:1024
  ds_read_b64_tr_b16 a[4:5], v215 offset:4096
  ds_read_b64_tr_b16 a[6:7], v215 offset:5120
  ds_read_b64_tr_b16 a[8:9], v215 offset:8192
  ds_read_b64_tr_b16 a[10:11], v215 offset:9216
  ds_read_b64_tr_b16 a[12:13], v215 offset:12288
  ds_read_b64_tr_b16 a[14:15], v215 offset:13312
  s_waitcnt vmcnt(20) lgkmcnt(0)
  s_barrier
  s_add_u32 m0, s61, 0
  s_add_u32 s54, s62, 663552
  buffer_load_dwordx4 v208, s[36:39], s54 offen lds
  s_add_u32 m0, s61, 4096
  s_add_u32 s54, s62, 718848
  buffer_load_dwordx4 v208, s[36:39], s54 offen lds
  s_add_u32 m0, s61, 8192
  s_add_u32 s54, s62, 774144
  buffer_load_dwordx4 v208, s[36:39], s54 offen lds
  s_add_u32 m0, s61, 12288
  s_add_u32 s54, s62, 829440
  buffer_load_dwordx4 v208, s[36:39], s54 offen lds
  v_add_u32 v215, 53248, v210
  ds_read_b64_tr_b16 a[144:145], v215 offset:0
  ds_read_b64_tr_b16 a[146:147], v215 offset:1024
  ds_read_b64_tr_b16 a[148:149], v215 offset:4096
  ds_read_b64_tr_b16 a[150:151], v215 offset:5120
  ds_read_b64_tr_b16 a[152:153], v215 offset:8192
  ds_read_b64_tr_b16 a[154:155], v215 offset:9216
  ds_read_b64_tr_b16 a[156:157], v215 offset:12288
  ds_read_b64_tr_b16 a[158:159], v215 offset:13312
  s_waitcnt vmcnt(20) lgkmcnt(0)
  s_barrier
  s_add_u32 m0, s61, 16384
  s_add_u32 s54, s62, 884736
  buffer_load_dwordx4 v207, s[36:39], s54 offen lds
  s_add_u32 m0, s61, 20480
  s_add_u32 s54, s62, 940032
  buffer_load_dwordx4 v207, s[36:39], s54 offen lds
  s_add_u32 m0, s61, 24576
  s_add_u32 s54, s62, 995328
  buffer_load_dwordx4 v207, s[36:39], s54 offen lds
  s_add_u32 m0, s61, 28672
  s_add_u32 s54, s62, 1050624
  buffer_load_dwordx4 v207, s[36:39], s54 offen lds
  v_add_u32 v215, 69632, v210
  ds_read_b64_tr_b16 a[16:17], v215 offset:0
  ds_read_b64_tr_b16 a[18:19], v215 offset:1024
  ds_read_b64_tr_b16 a[20:21], v215 offset:4096
  ds_read_b64_tr_b16 a[22:23], v215 offset:5120
  ds_read_b64_tr_b16 a[24:25], v215 offset:8192
  ds_read_b64_tr_b16 a[26:27], v215 offset:9216
  ds_read_b64_tr_b16 a[28:29], v215 offset:12288
  ds_read_b64_tr_b16 a[30:31], v215 offset:13312
  s_waitcnt vmcnt(20) lgkmcnt(0)
  s_barrier
  s_add_u32 m0, s61, 32768
  s_add_u32 s54, s62, 884736
  buffer_load_dwordx4 v208, s[36:39], s54 offen lds
  s_add_u32 m0, s61, 36864
  s_add_u32 s54, s62, 940032
  buffer_load_dwordx4 v208, s[36:39], s54 offen lds
  s_add_u32 m0, s61, 40960
  s_add_u32 s54, s62, 995328
  buffer_load_dwordx4 v208, s[36:39], s54 offen lds
  s_add_u32 m0, s61, 45056
  s_add_u32 s54, s62, 1050624
  buffer_load_dwordx4 v208, s[36:39], s54 offen lds
  v_add_u32 v215, 86016, v210
  ds_read_b64_tr_b16 a[160:161], v215 offset:0
  ds_read_b64_tr_b16 a[162:163], v215 offset:1024
  ds_read_b64_tr_b16 a[164:165], v215 offset:4096
  ds_read_b64_tr_b16 a[166:167], v215 offset:5120
  ds_read_b64_tr_b16 a[168:169], v215 offset:8192
  ds_read_b64_tr_b16 a[170:171], v215 offset:9216
  ds_read_b64_tr_b16 a[172:173], v215 offset:12288
  ds_read_b64_tr_b16 a[174:175], v215 offset:13312
  s_waitcnt vmcnt(20) lgkmcnt(0)
  s_barrier
  s_add_u32 m0, s61, 49152
  s_add_u32 s54, s62, 1105920
  buffer_load_dwordx4 v207, s[36:39], s54 offen lds
  s_add_u32 m0, s61, 53248
  s_add_u32 s54, s62, 1161216
  buffer_load_dwordx4 v207, s[36:39], s54 offen lds
  s_add_u32 m0, s61, 57344
  s_add_u32 s54, s62, 1216512
  buffer_load_dwordx4 v207, s[36:39], s54 offen lds
  s_add_u32 m0, s61, 61440
  s_add_u32 s54, s62, 1271808
  buffer_load_dwordx4 v207, s[36:39], s54 offen lds
  v_add_u32 v215, 102400, v210
  ds_read_b64_tr_b16 a[32:33], v215 offset:0
  ds_read_b64_tr_b16 a[34:35], v215 offset:1024
  ds_read_b64_tr_b16 a[36:37], v215 offset:4096
  ds_read_b64_tr_b16 a[38:39], v215 offset:5120
  ds_read_b64_tr_b16 a[40:41], v215 offset:8192
  ds_read_b64_tr_b16 a[42:43], v215 offset:9216
  ds_read_b64_tr_b16 a[44:45], v215 offset:12288
  ds_read_b64_tr_b16 a[46:47], v215 offset:13312
  s_waitcnt vmcnt(20) lgkmcnt(0)
  s_barrier
  s_add_u32 m0, s61, 65536
  s_add_u32 s54, s62, 1105920
  buffer_load_dwordx4 v208, s[36:39], s54 offen lds
  s_add_u32 m0, s61, 69632
  s_add_u32 s54, s62, 1161216
  buffer_load_dwordx4 v208, s[36:39], s54 offen lds
  s_add_u32 m0, s61, 73728
  s_add_u32 s54, s62, 1216512
  buffer_load_dwordx4 v208, s[36:39], s54 offen lds
  s_add_u32 m0, s61, 77824
  s_add_u32 s54, s62, 1271808
  buffer_load_dwordx4 v208, s[36:39], s54 offen lds
  v_add_u32 v215, 118784, v210
  ds_read_b64_tr_b16 a[176:177], v215 offset:0
  ds_read_b64_tr_b16 a[178:179], v215 offset:1024
  ds_read_b64_tr_b16 a[180:181], v215 offset:4096
  ds_read_b64_tr_b16 a[182:183], v215 offset:5120
  ds_read_b64_tr_b16 a[184:185], v215 offset:8192
  ds_read_b64_tr_b16 a[186:187], v215 offset:9216
  ds_read_b64_tr_b16 a[188:189], v215 offset:12288
  ds_read_b64_tr_b16 a[190:191], v215 offset:13312
  s_waitcnt vmcnt(20) lgkmcnt(0)
  s_barrier
  s_add_u32 m0, s61, 81920
  s_add_u32 s54, s62, 1327104
  buffer_load_dwordx4 v207, s[36:39], s54 offen lds
  s_add_u32 m0, s61, 86016
  s_add_u32 s54, s62, 1382400
  buffer_load_dwordx4 v207, s[36:39], s54 offen lds
  s_add_u32 m0, s61, 90112
  s_add_u32 s54, s62, 1437696
  buffer_load_dwordx4 v207, s[36:39], s54 offen lds
  s_add_u32 m0, s61, 94208
  s_add_u32 s54, s62, 1492992
  buffer_load_dwordx4 v207, s[36:39], s54 offen lds
  v_add_u32 v215, 135168, v210
  ds_read_b64_tr_b16 a[48:49], v215 offset:0
  ds_read_b64_tr_b16 a[50:51], v215 offset:1024
  ds_read_b64_tr_b16 a[52:53], v215 offset:4096
  ds_read_b64_tr_b16 a[54:55], v215 offset:5120
  ds_read_b64_tr_b16 a[56:57], v215 offset:8192
  ds_read_b64_tr_b16 a[58:59], v215 offset:9216
  ds_read_b64_tr_b16 a[60:61], v215 offset:12288
  ds_read_b64_tr_b16 a[62:63], v215 offset:13312
  s_waitcnt vmcnt(20) lgkmcnt(0)
  s_barrier
  s_add_u32 m0, s61, 98304
  s_add_u32 s54, s62, 1327104
  buffer_load_dwordx4 v208, s[36:39], s54 offen lds
  s_add_u32 m0, s61, 102400
  s_add_u32 s54, s62, 1382400
  buffer_load_dwordx4 v208, s[36:39], s54 offen lds
  s_add_u32 m0, s61, 106496
  s_add_u32 s54, s62, 1437696
  buffer_load_dwordx4 v208, s[36:39], s54 offen lds
  s_add_u32 m0, s61, 110592
  s_add_u32 s54, s62, 1492992
  buffer_load_dwordx4 v208, s[36:39], s54 offen lds
  v_add_u32 v215, 36864, v210
  ds_read_b64_tr_b16 a[192:193], v215 offset:0
  ds_read_b64_tr_b16 a[194:195], v215 offset:1024
  ds_read_b64_tr_b16 a[196:197], v215 offset:4096
  ds_read_b64_tr_b16 a[198:199], v215 offset:5120
  ds_read_b64_tr_b16 a[200:201], v215 offset:8192
  ds_read_b64_tr_b16 a[202:203], v215 offset:9216
  ds_read_b64_tr_b16 a[204:205], v215 offset:12288
  ds_read_b64_tr_b16 a[206:207], v215 offset:13312
  s_waitcnt vmcnt(20) lgkmcnt(0)
  s_barrier
  s_add_u32 m0, s61, 0
  s_add_u32 s54, s62, 1548288
  buffer_load_dwordx4 v207, s[36:39], s54 offen lds
  s_add_u32 m0, s61, 4096
  s_add_u32 s54, s62, 1603584
  buffer_load_dwordx4 v207, s[36:39], s54 offen lds
  s_add_u32 m0, s61, 8192
  s_add_u32 s54, s62, 1658880
  buffer_load_dwordx4 v207, s[36:39], s54 offen lds
  s_add_u32 m0, s61, 12288
  s_add_u32 s54, s62, 1714176
  buffer_load_dwordx4 v207, s[36:39], s54 offen lds
  v_add_u32 v215, 53248, v210
  ds_read_b64_tr_b16 a[64:65], v215 offset:0
  ds_read_b64_tr_b16 a[66:67], v215 offset:1024
  ds_read_b64_tr_b16 a[68:69], v215 offset:4096
  ds_read_b64_tr_b16 a[70:71], v215 offset:5120
  ds_read_b64_tr_b16 a[72:73], v215 offset:8192
  ds_read_b64_tr_b16 a[74:75], v215 offset:9216
  ds_read_b64_tr_b16 a[76:77], v215 offset:12288
  ds_read_b64_tr_b16 a[78:79], v215 offset:13312
  s_waitcnt vmcnt(20) lgkmcnt(0)
  s_barrier
  s_add_u32 m0, s61, 16384
  s_add_u32 s54, s62, 1548288
  buffer_load_dwordx4 v208, s[36:39], s54 offen lds
  s_add_u32 m0, s61, 20480
  s_add_u32 s54, s62, 1603584
  buffer_load_dwordx4 v208, s[36:39], s54 offen lds
  s_add_u32 m0, s61, 24576
  s_add_u32 s54, s62, 1658880
  buffer_load_dwordx4 v208, s[36:39], s54 offen lds
  s_add_u32 m0, s61, 28672
  s_add_u32 s54, s62, 1714176
  buffer_load_dwordx4 v208, s[36:39], s54 offen lds
  v_add_u32 v215, 69632, v210
  ds_read_b64_tr_b16 a[208:209], v215 offset:0
  ds_read_b64_tr_b16 a[210:211], v215 offset:1024
  ds_read_b64_tr_b16 a[212:213], v215 offset:4096
  ds_read_b64_tr_b16 a[214:215], v215 offset:5120
  ds_read_b64_tr_b16 a[216:217], v215 offset:8192
  ds_read_b64_tr_b16 a[218:219], v215 offset:9216
  ds_read_b64_tr_b16 a[220:221], v215 offset:12288
  ds_read_b64_tr_b16 a[222:223], v215 offset:13312
  s_waitcnt vmcnt(20) lgkmcnt(0)
  s_barrier
  s_add_u32 m0, s61, 32768
  s_add_u32 s54, s62, 1769472
  buffer_load_dwordx4 v207, s[36:39], s54 offen lds
  s_add_u32 m0, s61, 36864
  s_add_u32 s54, s62, 1824768
  buffer_load_dwordx4 v207, s[36:39], s54 offen lds
  s_add_u32 m0, s61, 40960
  s_add_u32 s54, s62, 1880064
  buffer_load_dwordx4 v207, s[36:39], s54 offen lds
  s_add_u32 m0, s61, 45056
  s_add_u32 s54, s62, 1935360
  buffer_load_dwordx4 v207, s[36:39], s54 offen lds
  v_add_u32 v215, 86016, v210
  ds_read_b64_tr_b16 a[80:81], v215 offset:0
  ds_read_b64_tr_b16 a[82:83], v215 offset:1024
  ds_read_b64_tr_b16 a[84:85], v215 offset:4096
  ds_read_b64_tr_b16 a[86:87], v215 offset:5120
  ds_read_b64_tr_b16 a[88:89], v215 offset:8192
  ds_read_b64_tr_b16 a[90:91], v215 offset:9216
  ds_read_b64_tr_b16 a[92:93], v215 offset:12288
  ds_read_b64_tr_b16 a[94:95], v215 offset:13312
  s_waitcnt vmcnt(20) lgkmcnt(0)
  s_barrier
  s_add_u32 m0, s61, 49152
  s_add_u32 s54, s62, 1769472
  buffer_load_dwordx4 v208, s[36:39], s54 offen lds
  s_add_u32 m0, s61, 53248
  s_add_u32 s54, s62, 1824768
  buffer_load_dwordx4 v208, s[36:39], s54 offen lds
  s_add_u32 m0, s61, 57344
  s_add_u32 s54, s62, 1880064
  buffer_load_dwordx4 v208, s[36:39], s54 offen lds
  s_add_u32 m0, s61, 61440
  s_add_u32 s54, s62, 1935360
  buffer_load_dwordx4 v208, s[36:39], s54 offen lds
  v_add_u32 v215, 102400, v210
  ds_read_b64_tr_b16 a[224:225], v215 offset:0
  ds_read_b64_tr_b16 a[226:227], v215 offset:1024
  ds_read_b64_tr_b16 a[228:229], v215 offset:4096
  ds_read_b64_tr_b16 a[230:231], v215 offset:5120
  ds_read_b64_tr_b16 a[232:233], v215 offset:8192
  ds_read_b64_tr_b16 a[234:235], v215 offset:9216
  ds_read_b64_tr_b16 a[236:237], v215 offset:12288
  ds_read_b64_tr_b16 a[238:239], v215 offset:13312
  s_waitcnt vmcnt(20) lgkmcnt(0)
  s_barrier
  v_add_u32 v215, 118784, v210
  ds_read_b64_tr_b16 a[96:97], v215 offset:0
  ds_read_b64_tr_b16 a[98:99], v215 offset:1024
  ds_read_b64_tr_b16 a[100:101], v215 offset:4096
  ds_read_b64_tr_b16 a[102:103], v215 offset:5120
  ds_read_b64_tr_b16 a[104:105], v215 offset:8192
  ds_read_b64_tr_b16 a[106:107], v215 offset:9216
  ds_read_b64_tr_b16 a[108:109], v215 offset:12288
  ds_read_b64_tr_b16 a[110:111], v215 offset:13312
  s_waitcnt vmcnt(16) lgkmcnt(0)
  s_barrier
  v_add_u32 v215, 135168, v210
  ds_read_b64_tr_b16 a[240:241], v215 offset:0
  ds_read_b64_tr_b16 a[242:243], v215 offset:1024
  ds_read_b64_tr_b16 a[244:245], v215 offset:4096
  ds_read_b64_tr_b16 a[246:247], v215 offset:5120
  ds_read_b64_tr_b16 a[248:249], v215 offset:8192
  ds_read_b64_tr_b16 a[250:251], v215 offset:9216
  ds_read_b64_tr_b16 a[252:253], v215 offset:12288
  ds_read_b64_tr_b16 a[254:255], v215 offset:13312
  s_waitcnt vmcnt(12) lgkmcnt(0)
  s_barrier
  v_add_u32 v215, 36864, v210
  ds_read_b64_tr_b16 a[112:113], v215 offset:0
  ds_read_b64_tr_b16 a[114:115], v215 offset:1024
  ds_read_b64_tr_b16 a[116:117], v215 offset:4096
  ds_read_b64_tr_b16 a[118:119], v215 offset:5120
  ds_read_b64_tr_b16 a[120:121], v215 offset:8192
  ds_read_b64_tr_b16 a[122:123], v215 offset:9216
  ds_read_b64_tr_b16 a[124:125], v215 offset:12288
  ds_read_b64_tr_b16 a[126:127], v215 offset:13312
  s_waitcnt vmcnt(8) lgkmcnt(0)
  s_barrier
  v_add_u32 v215, 53248, v210
  ds_read_b64_tr_b16 v[224:225], v215 offset:0
  ds_read_b64_tr_b16 v[226:227], v215 offset:1024
  ds_read_b64_tr_b16 v[228:229], v215 offset:4096
  ds_read_b64_tr_b16 v[230:231], v215 offset:5120
  ds_read_b64_tr_b16 v[232:233], v215 offset:8192
  ds_read_b64_tr_b16 v[234:235], v215 offset:9216
  ds_read_b64_tr_b16 v[236:237], v215 offset:12288
  ds_read_b64_tr_b16 v[238:239], v215 offset:13312
  s_waitcnt vmcnt(4) lgkmcnt(0)
  s_barrier
  v_add_u32 v215, 69632, v210
  ds_read_b64_tr_b16 a[128:129], v215 offset:0
  ds_read_b64_tr_b16 a[130:131], v215 offset:1024
  ds_read_b64_tr_b16 a[132:133], v215 offset:4096
  ds_read_b64_tr_b16 a[134:135], v215 offset:5120
  ds_read_b64_tr_b16 a[136:137], v215 offset:8192
  ds_read_b64_tr_b16 a[138:139], v215 offset:9216
  ds_read_b64_tr_b16 a[140:141], v215 offset:12288
  ds_read_b64_tr_b16 a[142:143], v215 offset:13312
  s_waitcnt vmcnt(0) lgkmcnt(0)
  s_barrier
  v_add_u32 v215, 86016, v210
  ds_read_b64_tr_b16 v[240:241], v215 offset:0
  ds_read_b64_tr_b16 v[242:243], v215 offset:1024
  ds_read_b64_tr_b16 v[244:245], v215 offset:4096
  ds_read_b64_tr_b16 v[246:247], v215 offset:5120
  ds_read_b64_tr_b16 v[248:249], v215 offset:8192
  ds_read_b64_tr_b16 v[250:251], v215 offset:9216
  ds_read_b64_tr_b16 v[252:253], v215 offset:12288
  ds_read_b64_tr_b16 v[254:255], v215 offset:13312
  s_waitcnt lgkmcnt(0)
  s_barrier
  v_and_b32 v211, 31, v200
  v_mul_u32_u24 v218, 516, v211
  v_lshrrev_b32 v212, 5, v200
  v_lshl_add_u32 v218, v212, 3, v218
  s_lshl_b32 s54, s52, 6
  s_add_u32 s54, s54, 73728
  v_add_u32 v218, s54, v218
  s_lshl_b32 s60, s69, 2
  s_mul_i32 s60, s60, 36864
  s_add_u32 m0, s67, 36864
  s_nop 0
  buffer_load_dwordx4 v202, s[4:7], s60 offen offset:0 lds
  s_add_u32 m0, s67, 37760
  s_nop 0
  buffer_load_dwordx4 v202, s[4:7], s60 offen offset:128 lds
  s_add_u32 m0, s67, 38656
  s_nop 0
  buffer_load_dwordx4 v202, s[4:7], s60 offen offset:256 lds
  s_add_u32 m0, s67, 39552
  s_nop 0
  buffer_load_dwordx4 v202, s[4:7], s60 offen offset:384 lds
  s_add_u32 m0, s67, 40448
  s_nop 0
  buffer_load_dwordx4 v202, s[4:7], s60 offen offset:512 lds
  s_add_u32 m0, s67, 41344
  s_nop 0
  buffer_load_dwordx4 v202, s[4:7], s60 offen offset:640 lds
  s_add_u32 m0, s67, 42240
  s_nop 0
  buffer_load_dwordx4 v202, s[4:7], s60 offen offset:768 lds
  s_add_u32 m0, s67, 43136
  s_nop 0
  buffer_load_dwordx4 v202, s[4:7], s60 offen offset:896 lds
  s_add_u32 m0, s67, 44032
  s_nop 0
  buffer_load_dwordx4 v202, s[4:7], s60 offen offset:1024 lds
  s_add_u32 s60, s60, 36864
  ds_read_b128 v[32:35], v203 offset:0
  ds_read_b128 v[36:39], v204 offset:0
  ds_read_b128 v[40:43], v205 offset:0
  s_waitcnt lgkmcnt(2)
  v_mfma_f32_32x32x16_bf16 v[0:15], a[0:3], v[32:35], 0
  ds_read_b128 v[44:47], v206 offset:0
  v_mfma_f32_32x32x16_bf16 v[16:31], a[144:147], v[32:35], 0
  s_waitcnt lgkmcnt(2)
  v_mfma_f32_32x32x16_bf16 v[0:15], a[4:7], v[36:39], v[0:15]
  ds_read_b128 v[32:35], v203 offset:1024
  v_mfma_f32_32x32x16_bf16 v[16:31], a[148:151], v[36:39], v[16:31]
  s_waitcnt lgkmcnt(2)
  v_mfma_f32_32x32x16_bf16 v[0:15], a[8:11], v[40:43], v[0:15]
  ds_read_b128 v[36:39], v204 offset:1024
  v_mfma_f32_32x32x16_bf16 v[16:31], a[152:155], v[40:43], v[16:31]
  s_waitcnt lgkmcnt(2)
  v_mfma_f32_32x32x16_bf16 v[0:15], a[12:15], v[44:47], v[0:15]
  ds_read_b128 v[40:43], v205 offset:1024
  v_mfma_f32_32x32x16_bf16 v[16:31], a[156:159], v[44:47], v[16:31]
  s_waitcnt lgkmcnt(2)
  v_mfma_f32_32x32x16_bf16 v[0:15], a[16:19], v[32:35], v[0:15]
  ds_read_b128 v[44:47], v206 offset:1024
  v_mfma_f32_32x32x16_bf16 v[16:31], a[160:163], v[32:35], v[16:31]
  s_waitcnt lgkmcnt(2)
  v_mfma_f32_32x32x16_bf16 v[0:15], a[20:23], v[36:39], v[0:15]
  ds_read_b128 v[32:35], v203 offset:2048
  v_mfma_f32_32x32x16_bf16 v[16:31], a[164:167], v[36:39], v[16:31]
  s_waitcnt lgkmcnt(2)
  v_mfma_f32_32x32x16_bf16 v[0:15], a[24:27], v[40:43], v[0:15]
  ds_read_b128 v[36:39], v204 offset:2048
  v_mfma_f32_32x32x16_bf16 v[16:31], a[168:171], v[40:43], v[16:31]
  s_waitcnt lgkmcnt(2)
  v_mfma_f32_32x32x16_bf16 v[0:15], a[28:31], v[44:47], v[0:15]
  ds_read_b128 v[40:43], v205 offset:2048
  v_mfma_f32_32x32x16_bf16 v[16:31], a[172:175], v[44:47], v[16:31]
  s_waitcnt lgkmcnt(2)
  v_mfma_f32_32x32x16_bf16 v[0:15], a[32:35], v[32:35], v[0:15]
  ds_read_b128 v[44:47], v206 offset:2048
  v_mfma_f32_32x32x16_bf16 v[16:31], a[176:179], v[32:35], v[16:31]
  s_waitcnt lgkmcnt(2)
  v_mfma_f32_32x32x16_bf16 v[0:15], a[36:39], v[36:39], v[0:15]
  ds_read_b128 v[32:35], v203 offset:3072
  v_mfma_f32_32x32x16_bf16 v[16:31], a[180:183], v[36:39], v[16:31]
  s_waitcnt lgkmcnt(2)
  v_mfma_f32_32x32x16_bf16 v[0:15], a[40:43], v[40:43], v[0:15]
  ds_read_b128 v[36:39], v204 offset:3072
  v_mfma_f32_32x32x16_bf16 v[16:31], a[184:187], v[40:43], v[16:31]
  s_waitcnt lgkmcnt(2)
  v_mfma_f32_32x32x16_bf16 v[0:15], a[44:47], v[44:47], v[0:15]
  ds_read_b128 v[40:43], v205 offset:3072
  v_mfma_f32_32x32x16_bf16 v[16:31], a[188:191], v[44:47], v[16:31]
  s_waitcnt lgkmcnt(2)
  v_mfma_f32_32x32x16_bf16 v[0:15], a[48:51], v[32:35], v[0:15]
  ds_read_b128 v[44:47], v206 offset:3072
  v_mfma_f32_32x32x16_bf16 v[16:31], a[192:195], v[32:35], v[16:31]
  s_waitcnt lgkmcnt(2)
  v_mfma_f32_32x32x16_bf16 v[0:15], a[52:55], v[36:39], v[0:15]
  ds_read_b128 v[32:35], v203 offset:4096
  v_mfma_f32_32x32x16_bf16 v[16:31], a[196:199], v[36:39], v[16:31]
  s_waitcnt lgkmcnt(2)
  v_mfma_f32_32x32x16_bf16 v[0:15], a[56:59], v[40:43], v[0:15]
  ds_read_b128 v[36:39], v204 offset:4096
  v_mfma_f32_32x32x16_bf16 v[16:31], a[200:203], v[40:43], v[16:31]
  s_waitcnt lgkmcnt(2)
  v_mfma_f32_32x32x16_bf16 v[0:15], a[60:63], v[44:47], v[0:15]
  ds_read_b128 v[40:43], v205 offset:4096
  v_mfma_f32_32x32x16_bf16 v[16:31], a[204:207], v[44:47], v[16:31]
  s_waitcnt lgkmcnt(2)
  v_mfma_f32_32x32x16_bf16 v[0:15], a[64:67], v[32:35], v[0:15]
  ds_read_b128 v[44:47], v206 offset:4096
  v_mfma_f32_32x32x16_bf16 v[16:31], a[208:211], v[32:35], v[16:31]
  s_waitcnt lgkmcnt(2)
  v_mfma_f32_32x32x16_bf16 v[0:15], a[68:71], v[36:39], v[0:15]
  ds_read_b128 v[32:35], v203 offset:5120
  v_mfma_f32_32x32x16_bf16 v[16:31], a[212:215], v[36:39], v[16:31]
  s_waitcnt lgkmcnt(2)
  v_mfma_f32_32x32x16_bf16 v[0:15], a[72:75], v[40:43], v[0:15]
  ds_read_b128 v[36:39], v204 offset:5120
  v_mfma_f32_32x32x16_bf16 v[16:31], a[216:219], v[40:43], v[16:31]
  s_waitcnt lgkmcnt(2)
  v_mfma_f32_32x32x16_bf16 v[0:15], a[76:79], v[44:47], v[0:15]
  ds_read_b128 v[40:43], v205 offset:5120
  v_mfma_f32_32x32x16_bf16 v[16:31], a[220:223], v[44:47], v[16:31]
  s_waitcnt lgkmcnt(2)
  v_mfma_f32_32x32x16_bf16 v[0:15], a[80:83], v[32:35], v[0:15]
  ds_read_b128 v[44:47], v206 offset:5120
  v_mfma_f32_32x32x16_bf16 v[16:31], a[224:227], v[32:35], v[16:31]
  s_waitcnt lgkmcnt(2)
  v_mfma_f32_32x32x16_bf16 v[0:15], a[84:87], v[36:39], v[0:15]
  ds_read_b128 v[32:35], v203 offset:6144
  v_mfma_f32_32x32x16_bf16 v[16:31], a[228:231], v[36:39], v[16:31]
  s_waitcnt lgkmcnt(2)
  v_mfma_f32_32x32x16_bf16 v[0:15], a[88:91], v[40:43], v[0:15]
  ds_read_b128 v[36:39], v204 offset:6144
  v_mfma_f32_32x32x16_bf16 v[16:31], a[232:235], v[40:43], v[16:31]
  s_waitcnt lgkmcnt(2)
  v_mfma_f32_32x32x16_bf16 v[0:15], a[92:95], v[44:47], v[0:15]
  ds_read_b128 v[40:43], v205 offset:6144
  v_mfma_f32_32x32x16_bf16 v[16:31], a[236:239], v[44:47], v[16:31]
  s_waitcnt lgkmcnt(2)
  v_mfma_f32_32x32x16_bf16 v[0:15], a[96:99], v[32:35], v[0:15]
  ds_read_b128 v[44:47], v206 offset:6144
  v_mfma_f32_32x32x16_bf16 v[16:31], a[240:243], v[32:35], v[16:31]
  s_waitcnt lgkmcnt(2)
  v_mfma_f32_32x32x16_bf16 v[0:15], a[100:103], v[36:39], v[0:15]
  ds_read_b128 v[32:35], v203 offset:7168
  v_mfma_f32_32x32x16_bf16 v[16:31], a[244:247], v[36:39], v[16:31]
  s_waitcnt lgkmcnt(2)
  v_mfma_f32_32x32x16_bf16 v[0:15], a[104:107], v[40:43], v[0:15]
  ds_read_b128 v[36:39], v204 offset:7168
  v_mfma_f32_32x32x16_bf16 v[16:31], a[248:251], v[40:43], v[16:31]
  s_waitcnt lgkmcnt(2)
  v_mfma_f32_32x32x16_bf16 v[0:15], a[108:111], v[44:47], v[0:15]
  ds_read_b128 v[40:43], v205 offset:7168
  v_mfma_f32_32x32x16_bf16 v[16:31], a[252:255], v[44:47], v[16:31]
  s_waitcnt lgkmcnt(2)
  v_mfma_f32_32x32x16_bf16 v[0:15], a[112:115], v[32:35], v[0:15]
  ds_read_b128 v[44:47], v206 offset:7168
  v_mfma_f32_32x32x16_bf16 v[16:31], v[224:227], v[32:35], v[16:31]
  s_waitcnt lgkmcnt(2)
  v_mfma_f32_32x32x16_bf16 v[0:15], a[116:119], v[36:39], v[0:15]
  ds_read_b128 v[32:35], v203 offset:8192
  v_mfma_f32_32x32x16_bf16 v[16:31], v[228:231], v[36:39], v[16:31]
  s_waitcnt lgkmcnt(2)
  v_mfma_f32_32x32x16_bf16 v[0:15], a[120:123], v[40:43], v[0:15]
  ds_read_b128 v[36:39], v204 offset:8192
  v_mfma_f32_32x32x16_bf16 v[16:31], v[232:235], v[40:43], v[16:31]
  s_waitcnt lgkmcnt(2)
  v_mfma_f32_32x32x16_bf16 v[0:15], a[124:127], v[44:47], v[0:15]
  ds_read_b128 v[40:43], v205 offset:8192
  v_mfma_f32_32x32x16_bf16 v[16:31], v[236:239], v[44:47], v[16:31]
  s_waitcnt lgkmcnt(2)
  v_mfma_f32_32x32x16_bf16 v[0:15], a[128:131], v[32:35], v[0:15]
  ds_read_b128 v[44:47], v206 offset:8192
  v_mfma_f32_32x32x16_bf16 v[16:31], v[240:243], v[32:35], v[16:31]
  s_waitcnt lgkmcnt(2)
  v_mfma_f32_32x32x16_bf16 v[0:15], a[132:135], v[36:39], v[0:15]
  v_mfma_f32_32x32x16_bf16 v[16:31], v[244:247], v[36:39], v[16:31]
  s_waitcnt lgkmcnt(1)
  v_mfma_f32_32x32x16_bf16 v[0:15], a[136:139], v[40:43], v[0:15]
  v_mfma_f32_32x32x16_bf16 v[16:31], v[248:251], v[40:43], v[16:31]
  s_waitcnt lgkmcnt(0)
  v_mfma_f32_32x32x16_bf16 v[0:15], a[140:143], v[44:47], v[0:15]
  v_mfma_f32_32x32x16_bf16 v[16:31], v[252:255], v[44:47], v[16:31]
  s_nop 3
  v_cvt_pk_bf16_f32 v48, v0, v1
  v_cvt_pk_bf16_f32 v49, v2, v3
  ds_write2_b32 v218, v48, v49 offset0:0 offset1:1
  v_cvt_pk_bf16_f32 v48, v4, v5
  v_cvt_pk_bf16_f32 v49, v6, v7
  ds_write2_b32 v218, v48, v49 offset0:4 offset1:5
  v_cvt_pk_bf16_f32 v48, v8, v9
  v_cvt_pk_bf16_f32 v49, v10, v11
  ds_write2_b32 v218, v48, v49 offset0:8 offset1:9
  v_cvt_pk_bf16_f32 v48, v12, v13
  v_cvt_pk_bf16_f32 v49, v14, v15
  ds_write2_b32 v218, v48, v49 offset0:12 offset1:13
  v_cvt_pk_bf16_f32 v48, v16, v17
  v_cvt_pk_bf16_f32 v49, v18, v19
  ds_write2_b32 v218, v48, v49 offset0:64 offset1:65
  v_cvt_pk_bf16_f32 v48, v20, v21
  v_cvt_pk_bf16_f32 v49, v22, v23
  ds_write2_b32 v218, v48, v49 offset0:68 offset1:69
  v_cvt_pk_bf16_f32 v48, v24, v25
  v_cvt_pk_bf16_f32 v49, v26, v27
  ds_write2_b32 v218, v48, v49 offset0:72 offset1:73
  v_cvt_pk_bf16_f32 v48, v28, v29
  v_cvt_pk_bf16_f32 v49, v30, v31
  ds_write2_b32 v218, v48, v49 offset0:76 offset1:77
  v_add_u32 v218, 16512, v218
  s_waitcnt vmcnt(0) lgkmcnt(0)
  s_barrier
  s_add_u32 m0, s67, 0
  s_nop 0
  buffer_load_dwordx4 v202, s[4:7], s60 offen offset:0 lds
  s_add_u32 m0, s67, 896
  s_nop 0
  buffer_load_dwordx4 v202, s[4:7], s60 offen offset:128 lds
  s_add_u32 m0, s67, 1792
  s_nop 0
  buffer_load_dwordx4 v202, s[4:7], s60 offen offset:256 lds
  s_add_u32 m0, s67, 2688
  s_nop 0
  buffer_load_dwordx4 v202, s[4:7], s60 offen offset:384 lds
  s_add_u32 m0, s67, 3584
  s_nop 0
  buffer_load_dwordx4 v202, s[4:7], s60 offen offset:512 lds
  s_add_u32 m0, s67, 4480
  s_nop 0
  buffer_load_dwordx4 v202, s[4:7], s60 offen offset:640 lds
  s_add_u32 m0, s67, 5376
  s_nop 0
  buffer_load_dwordx4 v202, s[4:7], s60 offen offset:768 lds
  s_add_u32 m0, s67, 6272
  s_nop 0
  buffer_load_dwordx4 v202, s[4:7], s60 offen offset:896 lds
  s_add_u32 m0, s67, 7168
  s_nop 0
  buffer_load_dwordx4 v202, s[4:7], s60 offen offset:1024 lds
  s_add_u32 s60, s60, 36864
  ds_read_b128 v[32:35], v203 offset:36864
  ds_read_b128 v[36:39], v204 offset:36864
  ds_read_b128 v[40:43], v205 offset:36864
  s_waitcnt lgkmcnt(2)
  v_mfma_f32_32x32x16_bf16 v[0:15], a[0:3], v[32:35], 0
  ds_read_b128 v[44:47], v206 offset:36864
  v_mfma_f32_32x32x16_bf16 v[16:31], a[144:147], v[32:35], 0
  s_waitcnt lgkmcnt(2)
  v_mfma_f32_32x32x16_bf16 v[0:15], a[4:7], v[36:39], v[0:15]
  ds_read_b128 v[32:35], v203 offset:37888
  v_mfma_f32_32x32x16_bf16 v[16:31], a[148:151], v[36:39], v[16:31]
  s_waitcnt lgkmcnt(2)
  v_mfma_f32_32x32x16_bf16 v[0:15], a[8:11], v[40:43], v[0:15]
  ds_read_b128 v[36:39], v204 offset:37888
  v_mfma_f32_32x32x16_bf16 v[16:31], a[152:155], v[40:43], v[16:31]
  s_waitcnt lgkmcnt(2)
  v_mfma_f32_32x32x16_bf16 v[0:15], a[12:15], v[44:47], v[0:15]
  ds_read_b128 v[40:43], v205 offset:37888
  v_mfma_f32_32x32x16_bf16 v[16:31], a[156:159], v[44:47], v[16:31]
  s_waitcnt lgkmcnt(2)
  v_mfma_f32_32x32x16_bf16 v[0:15], a[16:19], v[32:35], v[0:15]
  ds_read_b128 v[44:47], v206 offset:37888
  v_mfma_f32_32x32x16_bf16 v[16:31], a[160:163], v[32:35], v[16:31]
  s_waitcnt lgkmcnt(2)
  v_mfma_f32_32x32x16_bf16 v[0:15], a[20:23], v[36:39], v[0:15]
  ds_read_b128 v[32:35], v203 offset:38912
  v_mfma_f32_32x32x16_bf16 v[16:31], a[164:167], v[36:39], v[16:31]
  s_waitcnt lgkmcnt(2)
  v_mfma_f32_32x32x16_bf16 v[0:15], a[24:27], v[40:43], v[0:15]
  ds_read_b128 v[36:39], v204 offset:38912
  v_mfma_f32_32x32x16_bf16 v[16:31], a[168:171], v[40:43], v[16:31]
  s_waitcnt lgkmcnt(2)
  v_mfma_f32_32x32x16_bf16 v[0:15], a[28:31], v[44:47], v[0:15]
  ds_read_b128 v[40:43], v205 offset:38912
  v_mfma_f32_32x32x16_bf16 v[16:31], a[172:175], v[44:47], v[16:31]
  s_waitcnt lgkmcnt(2)
  v_mfma_f32_32x32x16_bf16 v[0:15], a[32:35], v[32:35], v[0:15]
  ds_read_b128 v[44:47], v206 offset:38912
  v_mfma_f32_32x32x16_bf16 v[16:31], a[176:179], v[32:35], v[16:31]
  s_waitcnt lgkmcnt(2)
  v_mfma_f32_32x32x16_bf16 v[0:15], a[36:39], v[36:39], v[0:15]
  ds_read_b128 v[32:35], v203 offset:39936
  v_mfma_f32_32x32x16_bf16 v[16:31], a[180:183], v[36:39], v[16:31]
  s_waitcnt lgkmcnt(2)
  v_mfma_f32_32x32x16_bf16 v[0:15], a[40:43], v[40:43], v[0:15]
  ds_read_b128 v[36:39], v204 offset:39936
  v_mfma_f32_32x32x16_bf16 v[16:31], a[184:187], v[40:43], v[16:31]
  s_waitcnt lgkmcnt(2)
  v_mfma_f32_32x32x16_bf16 v[0:15], a[44:47], v[44:47], v[0:15]
  ds_read_b128 v[40:43], v205 offset:39936
  v_mfma_f32_32x32x16_bf16 v[16:31], a[188:191], v[44:47], v[16:31]
  s_waitcnt lgkmcnt(2)
  v_mfma_f32_32x32x16_bf16 v[0:15], a[48:51], v[32:35], v[0:15]
  ds_read_b128 v[44:47], v206 offset:39936
  v_mfma_f32_32x32x16_bf16 v[16:31], a[192:195], v[32:35], v[16:31]
  s_waitcnt lgkmcnt(2)
  v_mfma_f32_32x32x16_bf16 v[0:15], a[52:55], v[36:39], v[0:15]
  ds_read_b128 v[32:35], v203 offset:40960
  v_mfma_f32_32x32x16_bf16 v[16:31], a[196:199], v[36:39], v[16:31]
  s_waitcnt lgkmcnt(2)
  v_mfma_f32_32x32x16_bf16 v[0:15], a[56:59], v[40:43], v[0:15]
  ds_read_b128 v[36:39], v204 offset:40960
  v_mfma_f32_32x32x16_bf16 v[16:31], a[200:203], v[40:43], v[16:31]
  s_waitcnt lgkmcnt(2)
  v_mfma_f32_32x32x16_bf16 v[0:15], a[60:63], v[44:47], v[0:15]
  ds_read_b128 v[40:43], v205 offset:40960
  v_mfma_f32_32x32x16_bf16 v[16:31], a[204:207], v[44:47], v[16:31]
  s_waitcnt lgkmcnt(2)
  v_mfma_f32_32x32x16_bf16 v[0:15], a[64:67], v[32:35], v[0:15]
  ds_read_b128 v[44:47], v206 offset:40960
  v_mfma_f32_32x32x16_bf16 v[16:31], a[208:211], v[32:35], v[16:31]
  s_waitcnt lgkmcnt(2)
  v_mfma_f32_32x32x16_bf16 v[0:15], a[68:71], v[36:39], v[0:15]
  ds_read_b128 v[32:35], v203 offset:41984
  v_mfma_f32_32x32x16_bf16 v[16:31], a[212:215], v[36:39], v[16:31]
  s_waitcnt lgkmcnt(2)
  v_mfma_f32_32x32x16_bf16 v[0:15], a[72:75], v[40:43], v[0:15]
  ds_read_b128 v[36:39], v204 offset:41984
  v_mfma_f32_32x32x16_bf16 v[16:31], a[216:219], v[40:43], v[16:31]
  s_waitcnt lgkmcnt(2)
  v_mfma_f32_32x32x16_bf16 v[0:15], a[76:79], v[44:47], v[0:15]
  ds_read_b128 v[40:43], v205 offset:41984
  v_mfma_f32_32x32x16_bf16 v[16:31], a[220:223], v[44:47], v[16:31]
  s_waitcnt lgkmcnt(2)
  v_mfma_f32_32x32x16_bf16 v[0:15], a[80:83], v[32:35], v[0:15]
  ds_read_b128 v[44:47], v206 offset:41984
  v_mfma_f32_32x32x16_bf16 v[16:31], a[224:227], v[32:35], v[16:31]
  s_waitcnt lgkmcnt(2)
  v_mfma_f32_32x32x16_bf16 v[0:15], a[84:87], v[36:39], v[0:15]
  ds_read_b128 v[32:35], v203 offset:43008
  v_mfma_f32_32x32x16_bf16 v[16:31], a[228:231], v[36:39], v[16:31]
  s_waitcnt lgkmcnt(2)
  v_mfma_f32_32x32x16_bf16 v[0:15], a[88:91], v[40:43], v[0:15]
  ds_read_b128 v[36:39], v204 offset:43008
  v_mfma_f32_32x32x16_bf16 v[16:31], a[232:235], v[40:43], v[16:31]
  s_waitcnt lgkmcnt(2)
  v_mfma_f32_32x32x16_bf16 v[0:15], a[92:95], v[44:47], v[0:15]
  ds_read_b128 v[40:43], v205 offset:43008
  v_mfma_f32_32x32x16_bf16 v[16:31], a[236:239], v[44:47], v[16:31]
  s_waitcnt lgkmcnt(2)
  v_mfma_f32_32x32x16_bf16 v[0:15], a[96:99], v[32:35], v[0:15]
  ds_read_b128 v[44:47], v206 offset:43008
  v_mfma_f32_32x32x16_bf16 v[16:31], a[240:243], v[32:35], v[16:31]
  s_waitcnt lgkmcnt(2)
  v_mfma_f32_32x32x16_bf16 v[0:15], a[100:103], v[36:39], v[0:15]
  ds_read_b128 v[32:35], v203 offset:44032
  v_mfma_f32_32x32x16_bf16 v[16:31], a[244:247], v[36:39], v[16:31]
  s_waitcnt lgkmcnt(2)
  v_mfma_f32_32x32x16_bf16 v[0:15], a[104:107], v[40:43], v[0:15]
  ds_read_b128 v[36:39], v204 offset:44032
  v_mfma_f32_32x32x16_bf16 v[16:31], a[248:251], v[40:43], v[16:31]
  s_waitcnt lgkmcnt(2)
  v_mfma_f32_32x32x16_bf16 v[0:15], a[108:111], v[44:47], v[0:15]
  ds_read_b128 v[40:43], v205 offset:44032
  v_mfma_f32_32x32x16_bf16 v[16:31], a[252:255], v[44:47], v[16:31]
  s_waitcnt lgkmcnt(2)
  v_mfma_f32_32x32x16_bf16 v[0:15], a[112:115], v[32:35], v[0:15]
  ds_read_b128 v[44:47], v206 offset:44032
  v_mfma_f32_32x32x16_bf16 v[16:31], v[224:227], v[32:35], v[16:31]
  s_waitcnt lgkmcnt(2)
  v_mfma_f32_32x32x16_bf16 v[0:15], a[116:119], v[36:39], v[0:15]
  ds_read_b128 v[32:35], v203 offset:45056
  v_mfma_f32_32x32x16_bf16 v[16:31], v[228:231], v[36:39], v[16:31]
  s_waitcnt lgkmcnt(2)
  v_mfma_f32_32x32x16_bf16 v[0:15], a[120:123], v[40:43], v[0:15]
  ds_read_b128 v[36:39], v204 offset:45056
  v_mfma_f32_32x32x16_bf16 v[16:31], v[232:235], v[40:43], v[16:31]
  s_waitcnt lgkmcnt(2)
  v_mfma_f32_32x32x16_bf16 v[0:15], a[124:127], v[44:47], v[0:15]
  ds_read_b128 v[40:43], v205 offset:45056
  v_mfma_f32_32x32x16_bf16 v[16:31], v[236:239], v[44:47], v[16:31]
  s_waitcnt lgkmcnt(2)
  v_mfma_f32_32x32x16_bf16 v[0:15], a[128:131], v[32:35], v[0:15]
  ds_read_b128 v[44:47], v206 offset:45056
  v_mfma_f32_32x32x16_bf16 v[16:31], v[240:243], v[32:35], v[16:31]
  s_waitcnt lgkmcnt(2)
  v_mfma_f32_32x32x16_bf16 v[0:15], a[132:135], v[36:39], v[0:15]
  v_mfma_f32_32x32x16_bf16 v[16:31], v[244:247], v[36:39], v[16:31]
  s_waitcnt lgkmcnt(1)
  v_mfma_f32_32x32x16_bf16 v[0:15], a[136:139], v[40:43], v[0:15]
  v_mfma_f32_32x32x16_bf16 v[16:31], v[248:251], v[40:43], v[16:31]
  s_waitcnt lgkmcnt(0)
  v_mfma_f32_32x32x16_bf16 v[0:15], a[140:143], v[44:47], v[0:15]
  v_mfma_f32_32x32x16_bf16 v[16:31], v[252:255], v[44:47], v[16:31]
  s_nop 3
  v_cvt_pk_bf16_f32 v48, v0, v1
  v_cvt_pk_bf16_f32 v49, v2, v3
  ds_write2_b32 v218, v48, v49 offset0:0 offset1:1
  v_cvt_pk_bf16_f32 v48, v4, v5
  v_cvt_pk_bf16_f32 v49, v6, v7
  ds_write2_b32 v218, v48, v49 offset0:4 offset1:5
  v_cvt_pk_bf16_f32 v48, v8, v9
  v_cvt_pk_bf16_f32 v49, v10, v11
  ds_write2_b32 v218, v48, v49 offset0:8 offset1:9
  v_cvt_pk_bf16_f32 v48, v12, v13
  v_cvt_pk_bf16_f32 v49, v14, v15
  ds_write2_b32 v218, v48, v49 offset0:12 offset1:13
  v_cvt_pk_bf16_f32 v48, v16, v17
  v_cvt_pk_bf16_f32 v49, v18, v19
  ds_write2_b32 v218, v48, v49 offset0:64 offset1:65
  v_cvt_pk_bf16_f32 v48, v20, v21
  v_cvt_pk_bf16_f32 v49, v22, v23
  ds_write2_b32 v218, v48, v49 offset0:68 offset1:69
  v_cvt_pk_bf16_f32 v48, v24, v25
  v_cvt_pk_bf16_f32 v49, v26, v27
  ds_write2_b32 v218, v48, v49 offset0:72 offset1:73
  v_cvt_pk_bf16_f32 v48, v28, v29
  v_cvt_pk_bf16_f32 v49, v30, v31
  ds_write2_b32 v218, v48, v49 offset0:76 offset1:77
  v_add_u32 v218, 16512, v218
  s_waitcnt vmcnt(0) lgkmcnt(0)
  s_barrier
  s_add_u32 m0, s67, 36864
  s_nop 0
  buffer_load_dwordx4 v202, s[4:7], s60 offen offset:0 lds
  s_add_u32 m0, s67, 37760
  s_nop 0
  buffer_load_dwordx4 v202, s[4:7], s60 offen offset:128 lds
  s_add_u32 m0, s67, 38656
  s_nop 0
  buffer_load_dwordx4 v202, s[4:7], s60 offen offset:256 lds
  s_add_u32 m0, s67, 39552
  s_nop 0
  buffer_load_dwordx4 v202, s[4:7], s60 offen offset:384 lds
  s_add_u32 m0, s67, 40448
  s_nop 0
  buffer_load_dwordx4 v202, s[4:7], s60 offen offset:512 lds
  s_add_u32 m0, s67, 41344
  s_nop 0
  buffer_load_dwordx4 v202, s[4:7], s60 offen offset:640 lds
  s_add_u32 m0, s67, 42240
  s_nop 0
  buffer_load_dwordx4 v202, s[4:7], s60 offen offset:768 lds
  s_add_u32 m0, s67, 43136
  s_nop 0
  buffer_load_dwordx4 v202, s[4:7], s60 offen offset:896 lds
  s_add_u32 m0, s67, 44032
  s_nop 0
  buffer_load_dwordx4 v202, s[4:7], s60 offen offset:1024 lds
  s_add_u32 s60, s60, 36864
  ds_read_b128 v[32:35], v203 offset:0
  ds_read_b128 v[36:39], v204 offset:0
  ds_read_b128 v[40:43], v205 offset:0
  s_waitcnt lgkmcnt(2)
  v_mfma_f32_32x32x16_bf16 v[0:15], a[0:3], v[32:35], 0
  ds_read_b128 v[44:47], v206 offset:0
  v_mfma_f32_32x32x16_bf16 v[16:31], a[144:147], v[32:35], 0
  s_waitcnt lgkmcnt(2)
  v_mfma_f32_32x32x16_bf16 v[0:15], a[4:7], v[36:39], v[0:15]
  ds_read_b128 v[32:35], v203 offset:1024
  v_mfma_f32_32x32x16_bf16 v[16:31], a[148:151], v[36:39], v[16:31]
  s_waitcnt lgkmcnt(2)
  v_mfma_f32_32x32x16_bf16 v[0:15], a[8:11], v[40:43], v[0:15]
  ds_read_b128 v[36:39], v204 offset:1024
  v_mfma_f32_32x32x16_bf16 v[16:31], a[152:155], v[40:43], v[16:31]
  s_waitcnt lgkmcnt(2)
  v_mfma_f32_32x32x16_bf16 v[0:15], a[12:15], v[44:47], v[0:15]
  ds_read_b128 v[40:43], v205 offset:1024
  v_mfma_f32_32x32x16_bf16 v[16:31], a[156:159], v[44:47], v[16:31]
  s_waitcnt lgkmcnt(2)
  v_mfma_f32_32x32x16_bf16 v[0:15], a[16:19], v[32:35], v[0:15]
  ds_read_b128 v[44:47], v206 offset:1024
  v_mfma_f32_32x32x16_bf16 v[16:31], a[160:163], v[32:35], v[16:31]
  s_waitcnt lgkmcnt(2)
  v_mfma_f32_32x32x16_bf16 v[0:15], a[20:23], v[36:39], v[0:15]
  ds_read_b128 v[32:35], v203 offset:2048
  v_mfma_f32_32x32x16_bf16 v[16:31], a[164:167], v[36:39], v[16:31]
  s_waitcnt lgkmcnt(2)
  v_mfma_f32_32x32x16_bf16 v[0:15], a[24:27], v[40:43], v[0:15]
  ds_read_b128 v[36:39], v204 offset:2048
  v_mfma_f32_32x32x16_bf16 v[16:31], a[168:171], v[40:43], v[16:31]
  s_waitcnt lgkmcnt(2)
  v_mfma_f32_32x32x16_bf16 v[0:15], a[28:31], v[44:47], v[0:15]
  ds_read_b128 v[40:43], v205 offset:2048
  v_mfma_f32_32x32x16_bf16 v[16:31], a[172:175], v[44:47], v[16:31]
  s_waitcnt lgkmcnt(2)
  v_mfma_f32_32x32x16_bf16 v[0:15], a[32:35], v[32:35], v[0:15]
  ds_read_b128 v[44:47], v206 offset:2048
  v_mfma_f32_32x32x16_bf16 v[16:31], a[176:179], v[32:35], v[16:31]
  s_waitcnt lgkmcnt(2)
  v_mfma_f32_32x32x16_bf16 v[0:15], a[36:39], v[36:39], v[0:15]
  ds_read_b128 v[32:35], v203 offset:3072
  v_mfma_f32_32x32x16_bf16 v[16:31], a[180:183], v[36:39], v[16:31]
  s_waitcnt lgkmcnt(2)
  v_mfma_f32_32x32x16_bf16 v[0:15], a[40:43], v[40:43], v[0:15]
  ds_read_b128 v[36:39], v204 offset:3072
  v_mfma_f32_32x32x16_bf16 v[16:31], a[184:187], v[40:43], v[16:31]
  s_waitcnt lgkmcnt(2)
  v_mfma_f32_32x32x16_bf16 v[0:15], a[44:47], v[44:47], v[0:15]
  ds_read_b128 v[40:43], v205 offset:3072
  v_mfma_f32_32x32x16_bf16 v[16:31], a[188:191], v[44:47], v[16:31]
  s_waitcnt lgkmcnt(2)
  v_mfma_f32_32x32x16_bf16 v[0:15], a[48:51], v[32:35], v[0:15]
  ds_read_b128 v[44:47], v206 offset:3072
  v_mfma_f32_32x32x16_bf16 v[16:31], a[192:195], v[32:35], v[16:31]
  s_waitcnt lgkmcnt(2)
  v_mfma_f32_32x32x16_bf16 v[0:15], a[52:55], v[36:39], v[0:15]
  ds_read_b128 v[32:35], v203 offset:4096
  v_mfma_f32_32x32x16_bf16 v[16:31], a[196:199], v[36:39], v[16:31]
  s_waitcnt lgkmcnt(2)
  v_mfma_f32_32x32x16_bf16 v[0:15], a[56:59], v[40:43], v[0:15]
  ds_read_b128 v[36:39], v204 offset:4096
  v_mfma_f32_32x32x16_bf16 v[16:31], a[200:203], v[40:43], v[16:31]
  s_waitcnt lgkmcnt(2)
  v_mfma_f32_32x32x16_bf16 v[0:15], a[60:63], v[44:47], v[0:15]
  ds_read_b128 v[40:43], v205 offset:4096
  v_mfma_f32_32x32x16_bf16 v[16:31], a[204:207], v[44:47], v[16:31]
  s_waitcnt lgkmcnt(2)
  v_mfma_f32_32x32x16_bf16 v[0:15], a[64:67], v[32:35], v[0:15]
  ds_read_b128 v[44:47], v206 offset:4096
  v_mfma_f32_32x32x16_bf16 v[16:31], a[208:211], v[32:35], v[16:31]
  s_waitcnt lgkmcnt(2)
  v_mfma_f32_32x32x16_bf16 v[0:15], a[68:71], v[36:39], v[0:15]
  ds_read_b128 v[32:35], v203 offset:5120
  v_mfma_f32_32x32x16_bf16 v[16:31], a[212:215], v[36:39], v[16:31]
  s_waitcnt lgkmcnt(2)
  v_mfma_f32_32x32x16_bf16 v[0:15], a[72:75], v[40:43], v[0:15]
  ds_read_b128 v[36:39], v204 offset:5120
  v_mfma_f32_32x32x16_bf16 v[16:31], a[216:219], v[40:43], v[16:31]
  s_waitcnt lgkmcnt(2)
  v_mfma_f32_32x32x16_bf16 v[0:15], a[76:79], v[44:47], v[0:15]
  ds_read_b128 v[40:43], v205 offset:5120
  v_mfma_f32_32x32x16_bf16 v[16:31], a[220:223], v[44:47], v[16:31]
  s_waitcnt lgkmcnt(2)
  v_mfma_f32_32x32x16_bf16 v[0:15], a[80:83], v[32:35], v[0:15]
  ds_read_b128 v[44:47], v206 offset:5120
  v_mfma_f32_32x32x16_bf16 v[16:31], a[224:227], v[32:35], v[16:31]
  s_waitcnt lgkmcnt(2)
  v_mfma_f32_32x32x16_bf16 v[0:15], a[84:87], v[36:39], v[0:15]
  ds_read_b128 v[32:35], v203 offset:6144
  v_mfma_f32_32x32x16_bf16 v[16:31], a[228:231], v[36:39], v[16:31]
  s_waitcnt lgkmcnt(2)
  v_mfma_f32_32x32x16_bf16 v[0:15], a[88:91], v[40:43], v[0:15]
  ds_read_b128 v[36:39], v204 offset:6144
  v_mfma_f32_32x32x16_bf16 v[16:31], a[232:235], v[40:43], v[16:31]
  s_waitcnt lgkmcnt(2)
  v_mfma_f32_32x32x16_bf16 v[0:15], a[92:95], v[44:47], v[0:15]
  ds_read_b128 v[40:43], v205 offset:6144
  v_mfma_f32_32x32x16_bf16 v[16:31], a[236:239], v[44:47], v[16:31]
  s_waitcnt lgkmcnt(2)
  v_mfma_f32_32x32x16_bf16 v[0:15], a[96:99], v[32:35], v[0:15]
  ds_read_b128 v[44:47], v206 offset:6144
  v_mfma_f32_32x32x16_bf16 v[16:31], a[240:243], v[32:35], v[16:31]
  s_waitcnt lgkmcnt(2)
  v_mfma_f32_32x32x16_bf16 v[0:15], a[100:103], v[36:39], v[0:15]
  ds_read_b128 v[32:35], v203 offset:7168
  v_mfma_f32_32x32x16_bf16 v[16:31], a[244:247], v[36:39], v[16:31]
  s_waitcnt lgkmcnt(2)
  v_mfma_f32_32x32x16_bf16 v[0:15], a[104:107], v[40:43], v[0:15]
  ds_read_b128 v[36:39], v204 offset:7168
  v_mfma_f32_32x32x16_bf16 v[16:31], a[248:251], v[40:43], v[16:31]
  s_waitcnt lgkmcnt(2)
  v_mfma_f32_32x32x16_bf16 v[0:15], a[108:111], v[44:47], v[0:15]
  ds_read_b128 v[40:43], v205 offset:7168
  v_mfma_f32_32x32x16_bf16 v[16:31], a[252:255], v[44:47], v[16:31]
  s_waitcnt lgkmcnt(2)
  v_mfma_f32_32x32x16_bf16 v[0:15], a[112:115], v[32:35], v[0:15]
  ds_read_b128 v[44:47], v206 offset:7168
  v_mfma_f32_32x32x16_bf16 v[16:31], v[224:227], v[32:35], v[16:31]
  s_waitcnt lgkmcnt(2)
  v_mfma_f32_32x32x16_bf16 v[0:15], a[116:119], v[36:39], v[0:15]
  ds_read_b128 v[32:35], v203 offset:8192
  v_mfma_f32_32x32x16_bf16 v[16:31], v[228:231], v[36:39], v[16:31]
  s_waitcnt lgkmcnt(2)
  v_mfma_f32_32x32x16_bf16 v[0:15], a[120:123], v[40:43], v[0:15]
  ds_read_b128 v[36:39], v204 offset:8192
  v_mfma_f32_32x32x16_bf16 v[16:31], v[232:235], v[40:43], v[16:31]
  s_waitcnt lgkmcnt(2)
  v_mfma_f32_32x32x16_bf16 v[0:15], a[124:127], v[44:47], v[0:15]
  ds_read_b128 v[40:43], v205 offset:8192
  v_mfma_f32_32x32x16_bf16 v[16:31], v[236:239], v[44:47], v[16:31]
  s_waitcnt lgkmcnt(2)
  v_mfma_f32_32x32x16_bf16 v[0:15], a[128:131], v[32:35], v[0:15]
  ds_read_b128 v[44:47], v206 offset:8192
  v_mfma_f32_32x32x16_bf16 v[16:31], v[240:243], v[32:35], v[16:31]
  s_waitcnt lgkmcnt(2)
  v_mfma_f32_32x32x16_bf16 v[0:15], a[132:135], v[36:39], v[0:15]
  v_mfma_f32_32x32x16_bf16 v[16:31], v[244:247], v[36:39], v[16:31]
  s_waitcnt lgkmcnt(1)
  v_mfma_f32_32x32x16_bf16 v[0:15], a[136:139], v[40:43], v[0:15]
  v_mfma_f32_32x32x16_bf16 v[16:31], v[248:251], v[40:43], v[16:31]
  s_waitcnt lgkmcnt(0)
  v_mfma_f32_32x32x16_bf16 v[0:15], a[140:143], v[44:47], v[0:15]
  v_mfma_f32_32x32x16_bf16 v[16:31], v[252:255], v[44:47], v[16:31]
  s_nop 3
  v_cvt_pk_bf16_f32 v48, v0, v1
  v_cvt_pk_bf16_f32 v49, v2, v3
  ds_write2_b32 v218, v48, v49 offset0:0 offset1:1
  v_cvt_pk_bf16_f32 v48, v4, v5
  v_cvt_pk_bf16_f32 v49, v6, v7
  ds_write2_b32 v218, v48, v49 offset0:4 offset1:5
  v_cvt_pk_bf16_f32 v48, v8, v9
  v_cvt_pk_bf16_f32 v49, v10, v11
  ds_write2_b32 v218, v48, v49 offset0:8 offset1:9
  v_cvt_pk_bf16_f32 v48, v12, v13
  v_cvt_pk_bf16_f32 v49, v14, v15
  ds_write2_b32 v218, v48, v49 offset0:12 offset1:13
  v_cvt_pk_bf16_f32 v48, v16, v17
  v_cvt_pk_bf16_f32 v49, v18, v19
  ds_write2_b32 v218, v48, v49 offset0:64 offset1:65
  v_cvt_pk_bf16_f32 v48, v20, v21
  v_cvt_pk_bf16_f32 v49, v22, v23
  ds_write2_b32 v218, v48, v49 offset0:68 offset1:69
  v_cvt_pk_bf16_f32 v48, v24, v25
  v_cvt_pk_bf16_f32 v49, v26, v27
  ds_write2_b32 v218, v48, v49 offset0:72 offset1:73
  v_cvt_pk_bf16_f32 v48, v28, v29
  v_cvt_pk_bf16_f32 v49, v30, v31
  ds_write2_b32 v218, v48, v49 offset0:76 offset1:77
  v_add_u32 v218, 16512, v218
  s_waitcnt vmcnt(0) lgkmcnt(0)
  s_barrier
  s_add_u32 m0, s67, 0
  s_nop 0
  buffer_load_dwordx4 v202, s[4:7], s60 offen offset:0 lds
  s_add_u32 m0, s67, 896
  s_nop 0
  buffer_load_dwordx4 v202, s[4:7], s60 offen offset:128 lds
  s_add_u32 m0, s67, 1792
  s_nop 0
  buffer_load_dwordx4 v202, s[4:7], s60 offen offset:256 lds
  s_add_u32 m0, s67, 2688
  s_nop 0
  buffer_load_dwordx4 v202, s[4:7], s60 offen offset:384 lds
  s_add_u32 m0, s67, 3584
  s_nop 0
  buffer_load_dwordx4 v202, s[4:7], s60 offen offset:512 lds
  s_add_u32 m0, s67, 4480
  s_nop 0
  buffer_load_dwordx4 v202, s[4:7], s60 offen offset:640 lds
  s_add_u32 m0, s67, 5376
  s_nop 0
  buffer_load_dwordx4 v202, s[4:7], s60 offen offset:768 lds
  s_add_u32 m0, s67, 6272
  s_nop 0
  buffer_load_dwordx4 v202, s[4:7], s60 offen offset:896 lds
  s_add_u32 m0, s67, 7168
  s_nop 0
  buffer_load_dwordx4 v202, s[4:7], s60 offen offset:1024 lds
  s_add_u32 s60, s60, 36864
  ds_read_b128 v[32:35], v203 offset:36864
  ds_read_b128 v[36:39], v204 offset:36864
  ds_read_b128 v[40:43], v205 offset:36864
  s_waitcnt lgkmcnt(2)
  v_mfma_f32_32x32x16_bf16 v[0:15], a[0:3], v[32:35], 0
  ds_read_b128 v[44:47], v206 offset:36864
  v_mfma_f32_32x32x16_bf16 v[16:31], a[144:147], v[32:35], 0
  s_waitcnt lgkmcnt(2)
  v_mfma_f32_32x32x16_bf16 v[0:15], a[4:7], v[36:39], v[0:15]
  ds_read_b128 v[32:35], v203 offset:37888
  v_mfma_f32_32x32x16_bf16 v[16:31], a[148:151], v[36:39], v[16:31]
  s_waitcnt lgkmcnt(2)
  v_mfma_f32_32x32x16_bf16 v[0:15], a[8:11], v[40:43], v[0:15]
  ds_read_b128 v[36:39], v204 offset:37888
  v_mfma_f32_32x32x16_bf16 v[16:31], a[152:155], v[40:43], v[16:31]
  s_waitcnt lgkmcnt(2)
  v_mfma_f32_32x32x16_bf16 v[0:15], a[12:15], v[44:47], v[0:15]
  ds_read_b128 v[40:43], v205 offset:37888
  v_mfma_f32_32x32x16_bf16 v[16:31], a[156:159], v[44:47], v[16:31]
  s_waitcnt lgkmcnt(2)
  v_mfma_f32_32x32x16_bf16 v[0:15], a[16:19], v[32:35], v[0:15]
  ds_read_b128 v[44:47], v206 offset:37888
  v_mfma_f32_32x32x16_bf16 v[16:31], a[160:163], v[32:35], v[16:31]
  s_waitcnt lgkmcnt(2)
  v_mfma_f32_32x32x16_bf16 v[0:15], a[20:23], v[36:39], v[0:15]
  ds_read_b128 v[32:35], v203 offset:38912
  v_mfma_f32_32x32x16_bf16 v[16:31], a[164:167], v[36:39], v[16:31]
  s_waitcnt lgkmcnt(2)
  v_mfma_f32_32x32x16_bf16 v[0:15], a[24:27], v[40:43], v[0:15]
  ds_read_b128 v[36:39], v204 offset:38912
  v_mfma_f32_32x32x16_bf16 v[16:31], a[168:171], v[40:43], v[16:31]
  s_waitcnt lgkmcnt(2)
  v_mfma_f32_32x32x16_bf16 v[0:15], a[28:31], v[44:47], v[0:15]
  ds_read_b128 v[40:43], v205 offset:38912
  v_mfma_f32_32x32x16_bf16 v[16:31], a[172:175], v[44:47], v[16:31]
  s_waitcnt lgkmcnt(2)
  v_mfma_f32_32x32x16_bf16 v[0:15], a[32:35], v[32:35], v[0:15]
  ds_read_b128 v[44:47], v206 offset:38912
  v_mfma_f32_32x32x16_bf16 v[16:31], a[176:179], v[32:35], v[16:31]
  s_waitcnt lgkmcnt(2)
  v_mfma_f32_32x32x16_bf16 v[0:15], a[36:39], v[36:39], v[0:15]
  ds_read_b128 v[32:35], v203 offset:39936
  v_mfma_f32_32x32x16_bf16 v[16:31], a[180:183], v[36:39], v[16:31]
  s_waitcnt lgkmcnt(2)
  v_mfma_f32_32x32x16_bf16 v[0:15], a[40:43], v[40:43], v[0:15]
  ds_read_b128 v[36:39], v204 offset:39936
  v_mfma_f32_32x32x16_bf16 v[16:31], a[184:187], v[40:43], v[16:31]
  s_waitcnt lgkmcnt(2)
  v_mfma_f32_32x32x16_bf16 v[0:15], a[44:47], v[44:47], v[0:15]
  ds_read_b128 v[40:43], v205 offset:39936
  v_mfma_f32_32x32x16_bf16 v[16:31], a[188:191], v[44:47], v[16:31]
  s_waitcnt lgkmcnt(2)
  v_mfma_f32_32x32x16_bf16 v[0:15], a[48:51], v[32:35], v[0:15]
  ds_read_b128 v[44:47], v206 offset:39936
  v_mfma_f32_32x32x16_bf16 v[16:31], a[192:195], v[32:35], v[16:31]
  s_waitcnt lgkmcnt(2)
  v_mfma_f32_32x32x16_bf16 v[0:15], a[52:55], v[36:39], v[0:15]
  ds_read_b128 v[32:35], v203 offset:40960
  v_mfma_f32_32x32x16_bf16 v[16:31], a[196:199], v[36:39], v[16:31]
  s_waitcnt lgkmcnt(2)
  v_mfma_f32_32x32x16_bf16 v[0:15], a[56:59], v[40:43], v[0:15]
  ds_read_b128 v[36:39], v204 offset:40960
  v_mfma_f32_32x32x16_bf16 v[16:31], a[200:203], v[40:43], v[16:31]
  s_waitcnt lgkmcnt(2)
  v_mfma_f32_32x32x16_bf16 v[0:15], a[60:63], v[44:47], v[0:15]
  ds_read_b128 v[40:43], v205 offset:40960
  v_mfma_f32_32x32x16_bf16 v[16:31], a[204:207], v[44:47], v[16:31]
  s_waitcnt lgkmcnt(2)
  v_mfma_f32_32x32x16_bf16 v[0:15], a[64:67], v[32:35], v[0:15]
  ds_read_b128 v[44:47], v206 offset:40960
  v_mfma_f32_32x32x16_bf16 v[16:31], a[208:211], v[32:35], v[16:31]
  s_waitcnt lgkmcnt(2)
  v_mfma_f32_32x32x16_bf16 v[0:15], a[68:71], v[36:39], v[0:15]
  ds_read_b128 v[32:35], v203 offset:41984
  v_mfma_f32_32x32x16_bf16 v[16:31], a[212:215], v[36:39], v[16:31]
  s_waitcnt lgkmcnt(2)
  v_mfma_f32_32x32x16_bf16 v[0:15], a[72:75], v[40:43], v[0:15]
  ds_read_b128 v[36:39], v204 offset:41984
  v_mfma_f32_32x32x16_bf16 v[16:31], a[216:219], v[40:43], v[16:31]
  s_waitcnt lgkmcnt(2)
  v_mfma_f32_32x32x16_bf16 v[0:15], a[76:79], v[44:47], v[0:15]
  ds_read_b128 v[40:43], v205 offset:41984
  v_mfma_f32_32x32x16_bf16 v[16:31], a[220:223], v[44:47], v[16:31]
  s_waitcnt lgkmcnt(2)
  v_mfma_f32_32x32x16_bf16 v[0:15], a[80:83], v[32:35], v[0:15]
  ds_read_b128 v[44:47], v206 offset:41984
  v_mfma_f32_32x32x16_bf16 v[16:31], a[224:227], v[32:35], v[16:31]
  s_waitcnt lgkmcnt(2)
  v_mfma_f32_32x32x16_bf16 v[0:15], a[84:87], v[36:39], v[0:15]
  ds_read_b128 v[32:35], v203 offset:43008
  v_mfma_f32_32x32x16_bf16 v[16:31], a[228:231], v[36:39], v[16:31]
  s_waitcnt lgkmcnt(2)
  v_mfma_f32_32x32x16_bf16 v[0:15], a[88:91], v[40:43], v[0:15]
  ds_read_b128 v[36:39], v204 offset:43008
  v_mfma_f32_32x32x16_bf16 v[16:31], a[232:235], v[40:43], v[16:31]
  s_waitcnt lgkmcnt(2)
  v_mfma_f32_32x32x16_bf16 v[0:15], a[92:95], v[44:47], v[0:15]
  ds_read_b128 v[40:43], v205 offset:43008
  v_mfma_f32_32x32x16_bf16 v[16:31], a[236:239], v[44:47], v[16:31]
  s_waitcnt lgkmcnt(2)
  v_mfma_f32_32x32x16_bf16 v[0:15], a[96:99], v[32:35], v[0:15]
  ds_read_b128 v[44:47], v206 offset:43008
  v_mfma_f32_32x32x16_bf16 v[16:31], a[240:243], v[32:35], v[16:31]
  s_waitcnt lgkmcnt(2)
  v_mfma_f32_32x32x16_bf16 v[0:15], a[100:103], v[36:39], v[0:15]
  ds_read_b128 v[32:35], v203 offset:44032
  v_mfma_f32_32x32x16_bf16 v[16:31], a[244:247], v[36:39], v[16:31]
  s_waitcnt lgkmcnt(2)
  v_mfma_f32_32x32x16_bf16 v[0:15], a[104:107], v[40:43], v[0:15]
  ds_read_b128 v[36:39], v204 offset:44032
  v_mfma_f32_32x32x16_bf16 v[16:31], a[248:251], v[40:43], v[16:31]
  s_waitcnt lgkmcnt(2)
  v_mfma_f32_32x32x16_bf16 v[0:15], a[108:111], v[44:47], v[0:15]
  ds_read_b128 v[40:43], v205 offset:44032
  v_mfma_f32_32x32x16_bf16 v[16:31], a[252:255], v[44:47], v[16:31]
  s_waitcnt lgkmcnt(2)
  v_mfma_f32_32x32x16_bf16 v[0:15], a[112:115], v[32:35], v[0:15]
  ds_read_b128 v[44:47], v206 offset:44032
  v_mfma_f32_32x32x16_bf16 v[16:31], v[224:227], v[32:35], v[16:31]
  s_waitcnt lgkmcnt(2)
  v_mfma_f32_32x32x16_bf16 v[0:15], a[116:119], v[36:39], v[0:15]
  ds_read_b128 v[32:35], v203 offset:45056
  v_mfma_f32_32x32x16_bf16 v[16:31], v[228:231], v[36:39], v[16:31]
  s_waitcnt lgkmcnt(2)
  v_mfma_f32_32x32x16_bf16 v[0:15], a[120:123], v[40:43], v[0:15]
  ds_read_b128 v[36:39], v204 offset:45056
  v_mfma_f32_32x32x16_bf16 v[16:31], v[232:235], v[40:43], v[16:31]
  s_waitcnt lgkmcnt(2)
  v_mfma_f32_32x32x16_bf16 v[0:15], a[124:127], v[44:47], v[0:15]
  ds_read_b128 v[40:43], v205 offset:45056
  v_mfma_f32_32x32x16_bf16 v[16:31], v[236:239], v[44:47], v[16:31]
  s_waitcnt lgkmcnt(2)
  v_mfma_f32_32x32x16_bf16 v[0:15], a[128:131], v[32:35], v[0:15]
  ds_read_b128 v[44:47], v206 offset:45056
  v_mfma_f32_32x32x16_bf16 v[16:31], v[240:243], v[32:35], v[16:31]
  s_waitcnt lgkmcnt(2)
  v_mfma_f32_32x32x16_bf16 v[0:15], a[132:135], v[36:39], v[0:15]
  v_mfma_f32_32x32x16_bf16 v[16:31], v[244:247], v[36:39], v[16:31]
  s_waitcnt lgkmcnt(1)
  v_mfma_f32_32x32x16_bf16 v[0:15], a[136:139], v[40:43], v[0:15]
  v_mfma_f32_32x32x16_bf16 v[16:31], v[248:251], v[40:43], v[16:31]
  s_waitcnt lgkmcnt(0)
  v_mfma_f32_32x32x16_bf16 v[0:15], a[140:143], v[44:47], v[0:15]
  v_mfma_f32_32x32x16_bf16 v[16:31], v[252:255], v[44:47], v[16:31]
  s_nop 3
  v_cvt_pk_bf16_f32 v48, v0, v1
  v_cvt_pk_bf16_f32 v49, v2, v3
  ds_write2_b32 v218, v48, v49 offset0:0 offset1:1
  v_cvt_pk_bf16_f32 v48, v4, v5
  v_cvt_pk_bf16_f32 v49, v6, v7
  ds_write2_b32 v218, v48, v49 offset0:4 offset1:5
  v_cvt_pk_bf16_f32 v48, v8, v9
  v_cvt_pk_bf16_f32 v49, v10, v11
  ds_write2_b32 v218, v48, v49 offset0:8 offset1:9
  v_cvt_pk_bf16_f32 v48, v12, v13
  v_cvt_pk_bf16_f32 v49, v14, v15
  ds_write2_b32 v218, v48, v49 offset0:12 offset1:13
  v_cvt_pk_bf16_f32 v48, v16, v17
  v_cvt_pk_bf16_f32 v49, v18, v19
  ds_write2_b32 v218, v48, v49 offset0:64 offset1:65
  v_cvt_pk_bf16_f32 v48, v20, v21
  v_cvt_pk_bf16_f32 v49, v22, v23
  ds_write2_b32 v218, v48, v49 offset0:68 offset1:69
  v_cvt_pk_bf16_f32 v48, v24, v25
  v_cvt_pk_bf16_f32 v49, v26, v27
  ds_write2_b32 v218, v48, v49 offset0:72 offset1:73
  v_cvt_pk_bf16_f32 v48, v28, v29
  v_cvt_pk_bf16_f32 v49, v30, v31
  ds_write2_b32 v218, v48, v49 offset0:76 offset1:77
  v_add_u32 v218, 16512, v218
  s_waitcnt vmcnt(0) lgkmcnt(0)
  s_barrier
  ds_read_b128 v[32:35], v203 offset:0
  ds_read_b128 v[36:39], v204 offset:0
  ds_read_b128 v[40:43], v205 offset:0
  s_waitcnt lgkmcnt(2)
  v_mfma_f32_32x32x16_bf16 v[0:15], a[0:3], v[32:35], 0
  ds_read_b128 v[44:47], v206 offset:0
  v_mfma_f32_32x32x16_bf16 v[16:31], a[144:147], v[32:35], 0
  s_waitcnt lgkmcnt(2)
  v_mfma_f32_32x32x16_bf16 v[0:15], a[4:7], v[36:39], v[0:15]
  ds_read_b128 v[32:35], v203 offset:1024
  v_mfma_f32_32x32x16_bf16 v[16:31], a[148:151], v[36:39], v[16:31]
  s_waitcnt lgkmcnt(2)
  v_mfma_f32_32x32x16_bf16 v[0:15], a[8:11], v[40:43], v[0:15]
  ds_read_b128 v[36:39], v204 offset:1024
  v_mfma_f32_32x32x16_bf16 v[16:31], a[152:155], v[40:43], v[16:31]
  s_waitcnt lgkmcnt(2)
  v_mfma_f32_32x32x16_bf16 v[0:15], a[12:15], v[44:47], v[0:15]
  ds_read_b128 v[40:43], v205 offset:1024
  v_mfma_f32_32x32x16_bf16 v[16:31], a[156:159], v[44:47], v[16:31]
  s_waitcnt lgkmcnt(2)
  v_mfma_f32_32x32x16_bf16 v[0:15], a[16:19], v[32:35], v[0:15]
  ds_read_b128 v[44:47], v206 offset:1024
  v_mfma_f32_32x32x16_bf16 v[16:31], a[160:163], v[32:35], v[16:31]
  s_waitcnt lgkmcnt(2)
  v_mfma_f32_32x32x16_bf16 v[0:15], a[20:23], v[36:39], v[0:15]
  ds_read_b128 v[32:35], v203 offset:2048
  v_mfma_f32_32x32x16_bf16 v[16:31], a[164:167], v[36:39], v[16:31]
  s_waitcnt lgkmcnt(2)
  v_mfma_f32_32x32x16_bf16 v[0:15], a[24:27], v[40:43], v[0:15]
  ds_read_b128 v[36:39], v204 offset:2048
  v_mfma_f32_32x32x16_bf16 v[16:31], a[168:171], v[40:43], v[16:31]
  s_waitcnt lgkmcnt(2)
  v_mfma_f32_32x32x16_bf16 v[0:15], a[28:31], v[44:47], v[0:15]
  ds_read_b128 v[40:43], v205 offset:2048
  v_mfma_f32_32x32x16_bf16 v[16:31], a[172:175], v[44:47], v[16:31]
  s_waitcnt lgkmcnt(2)
  v_mfma_f32_32x32x16_bf16 v[0:15], a[32:35], v[32:35], v[0:15]
  ds_read_b128 v[44:47], v206 offset:2048
  v_mfma_f32_32x32x16_bf16 v[16:31], a[176:179], v[32:35], v[16:31]
  s_waitcnt lgkmcnt(2)
  v_mfma_f32_32x32x16_bf16 v[0:15], a[36:39], v[36:39], v[0:15]
  ds_read_b128 v[32:35], v203 offset:3072
  v_mfma_f32_32x32x16_bf16 v[16:31], a[180:183], v[36:39], v[16:31]
  s_waitcnt lgkmcnt(2)
  v_mfma_f32_32x32x16_bf16 v[0:15], a[40:43], v[40:43], v[0:15]
  ds_read_b128 v[36:39], v204 offset:3072
  v_mfma_f32_32x32x16_bf16 v[16:31], a[184:187], v[40:43], v[16:31]
  s_waitcnt lgkmcnt(2)
  v_mfma_f32_32x32x16_bf16 v[0:15], a[44:47], v[44:47], v[0:15]
  ds_read_b128 v[40:43], v205 offset:3072
  v_mfma_f32_32x32x16_bf16 v[16:31], a[188:191], v[44:47], v[16:31]
  s_waitcnt lgkmcnt(2)
  v_mfma_f32_32x32x16_bf16 v[0:15], a[48:51], v[32:35], v[0:15]
  ds_read_b128 v[44:47], v206 offset:3072
  v_mfma_f32_32x32x16_bf16 v[16:31], a[192:195], v[32:35], v[16:31]
  s_waitcnt lgkmcnt(2)
  v_mfma_f32_32x32x16_bf16 v[0:15], a[52:55], v[36:39], v[0:15]
  ds_read_b128 v[32:35], v203 offset:4096
  v_mfma_f32_32x32x16_bf16 v[16:31], a[196:199], v[36:39], v[16:31]
  s_waitcnt lgkmcnt(2)
  v_mfma_f32_32x32x16_bf16 v[0:15], a[56:59], v[40:43], v[0:15]
  ds_read_b128 v[36:39], v204 offset:4096
  v_mfma_f32_32x32x16_bf16 v[16:31], a[200:203], v[40:43], v[16:31]
  s_waitcnt lgkmcnt(2)
  v_mfma_f32_32x32x16_bf16 v[0:15], a[60:63], v[44:47], v[0:15]
  ds_read_b128 v[40:43], v205 offset:4096
  v_mfma_f32_32x32x16_bf16 v[16:31], a[204:207], v[44:47], v[16:31]
  s_waitcnt lgkmcnt(2)
  v_mfma_f32_32x32x16_bf16 v[0:15], a[64:67], v[32:35], v[0:15]
  ds_read_b128 v[44:47], v206 offset:4096
  v_mfma_f32_32x32x16_bf16 v[16:31], a[208:211], v[32:35], v[16:31]
  s_waitcnt lgkmcnt(2)
  v_mfma_f32_32x32x16_bf16 v[0:15], a[68:71], v[36:39], v[0:15]
  ds_read_b128 v[32:35], v203 offset:5120
  v_mfma_f32_32x32x16_bf16 v[16:31], a[212:215], v[36:39], v[16:31]
  s_waitcnt lgkmcnt(2)
  v_mfma_f32_32x32x16_bf16 v[0:15], a[72:75], v[40:43], v[0:15]
  ds_read_b128 v[36:39], v204 offset:5120
  v_mfma_f32_32x32x16_bf16 v[16:31], a[216:219], v[40:43], v[16:31]
  s_waitcnt lgkmcnt(2)
  v_mfma_f32_32x32x16_bf16 v[0:15], a[76:79], v[44:47], v[0:15]
  ds_read_b128 v[40:43], v205 offset:5120
  v_mfma_f32_32x32x16_bf16 v[16:31], a[220:223], v[44:47], v[16:31]
  s_waitcnt lgkmcnt(2)
  v_mfma_f32_32x32x16_bf16 v[0:15], a[80:83], v[32:35], v[0:15]
  ds_read_b128 v[44:47], v206 offset:5120
  v_mfma_f32_32x32x16_bf16 v[16:31], a[224:227], v[32:35], v[16:31]
  s_waitcnt lgkmcnt(2)
  v_mfma_f32_32x32x16_bf16 v[0:15], a[84:87], v[36:39], v[0:15]
  ds_read_b128 v[32:35], v203 offset:6144
  v_mfma_f32_32x32x16_bf16 v[16:31], a[228:231], v[36:39], v[16:31]
  s_waitcnt lgkmcnt(2)
  v_mfma_f32_32x32x16_bf16 v[0:15], a[88:91], v[40:43], v[0:15]
  ds_read_b128 v[36:39], v204 offset:6144
  v_mfma_f32_32x32x16_bf16 v[16:31], a[232:235], v[40:43], v[16:31]
  s_waitcnt lgkmcnt(2)
  v_mfma_f32_32x32x16_bf16 v[0:15], a[92:95], v[44:47], v[0:15]
  ds_read_b128 v[40:43], v205 offset:6144
  v_mfma_f32_32x32x16_bf16 v[16:31], a[236:239], v[44:47], v[16:31]
  s_waitcnt lgkmcnt(2)
  v_mfma_f32_32x32x16_bf16 v[0:15], a[96:99], v[32:35], v[0:15]
  ds_read_b128 v[44:47], v206 offset:6144
  v_mfma_f32_32x32x16_bf16 v[16:31], a[240:243], v[32:35], v[16:31]
  s_waitcnt lgkmcnt(2)
  v_mfma_f32_32x32x16_bf16 v[0:15], a[100:103], v[36:39], v[0:15]
  ds_read_b128 v[32:35], v203 offset:7168
  v_mfma_f32_32x32x16_bf16 v[16:31], a[244:247], v[36:39], v[16:31]
  s_waitcnt lgkmcnt(2)
  v_mfma_f32_32x32x16_bf16 v[0:15], a[104:107], v[40:43], v[0:15]
  ds_read_b128 v[36:39], v204 offset:7168
  v_mfma_f32_32x32x16_bf16 v[16:31], a[248:251], v[40:43], v[16:31]
  s_waitcnt lgkmcnt(2)
  v_mfma_f32_32x32x16_bf16 v[0:15], a[108:111], v[44:47], v[0:15]
  ds_read_b128 v[40:43], v205 offset:7168
  v_mfma_f32_32x32x16_bf16 v[16:31], a[252:255], v[44:47], v[16:31]
  s_waitcnt lgkmcnt(2)
  v_mfma_f32_32x32x16_bf16 v[0:15], a[112:115], v[32:35], v[0:15]
  ds_read_b128 v[44:47], v206 offset:7168
  v_mfma_f32_32x32x16_bf16 v[16:31], v[224:227], v[32:35], v[16:31]
  s_waitcnt lgkmcnt(2)
  v_mfma_f32_32x32x16_bf16 v[0:15], a[116:119], v[36:39], v[0:15]
  ds_read_b128 v[32:35], v203 offset:8192
  v_mfma_f32_32x32x16_bf16 v[16:31], v[228:231], v[36:39], v[16:31]
  s_waitcnt lgkmcnt(2)
  v_mfma_f32_32x32x16_bf16 v[0:15], a[120:123], v[40:43], v[0:15]
  ds_read_b128 v[36:39], v204 offset:8192
  v_mfma_f32_32x32x16_bf16 v[16:31], v[232:235], v[40:43], v[16:31]
  s_waitcnt lgkmcnt(2)
  v_mfma_f32_32x32x16_bf16 v[0:15], a[124:127], v[44:47], v[0:15]
  ds_read_b128 v[40:43], v205 offset:8192
  v_mfma_f32_32x32x16_bf16 v[16:31], v[236:239], v[44:47], v[16:31]
  s_waitcnt lgkmcnt(2)
  v_mfma_f32_32x32x16_bf16 v[0:15], a[128:131], v[32:35], v[0:15]
  ds_read_b128 v[44:47], v206 offset:8192
  v_mfma_f32_32x32x16_bf16 v[16:31], v[240:243], v[32:35], v[16:31]
  s_waitcnt lgkmcnt(2)
  v_mfma_f32_32x32x16_bf16 v[0:15], a[132:135], v[36:39], v[0:15]
  v_mfma_f32_32x32x16_bf16 v[16:31], v[244:247], v[36:39], v[16:31]
  s_waitcnt lgkmcnt(1)
  v_mfma_f32_32x32x16_bf16 v[0:15], a[136:139], v[40:43], v[0:15]
  v_mfma_f32_32x32x16_bf16 v[16:31], v[248:251], v[40:43], v[16:31]
  s_waitcnt lgkmcnt(0)
  v_mfma_f32_32x32x16_bf16 v[0:15], a[140:143], v[44:47], v[0:15]
  v_mfma_f32_32x32x16_bf16 v[16:31], v[252:255], v[44:47], v[16:31]
  s_nop 3
  v_cvt_pk_bf16_f32 v48, v0, v1
  v_cvt_pk_bf16_f32 v49, v2, v3
  ds_write2_b32 v218, v48, v49 offset0:0 offset1:1
  v_cvt_pk_bf16_f32 v48, v4, v5
  v_cvt_pk_bf16_f32 v49, v6, v7
  ds_write2_b32 v218, v48, v49 offset0:4 offset1:5
  v_cvt_pk_bf16_f32 v48, v8, v9
  v_cvt_pk_bf16_f32 v49, v10, v11
  ds_write2_b32 v218, v48, v49 offset0:8 offset1:9
  v_cvt_pk_bf16_f32 v48, v12, v13
  v_cvt_pk_bf16_f32 v49, v14, v15
  ds_write2_b32 v218, v48, v49 offset0:12 offset1:13
  v_cvt_pk_bf16_f32 v48, v16, v17
  v_cvt_pk_bf16_f32 v49, v18, v19
  ds_write2_b32 v218, v48, v49 offset0:64 offset1:65
  v_cvt_pk_bf16_f32 v48, v20, v21
  v_cvt_pk_bf16_f32 v49, v22, v23
  ds_write2_b32 v218, v48, v49 offset0:68 offset1:69
  v_cvt_pk_bf16_f32 v48, v24, v25
  v_cvt_pk_bf16_f32 v49, v26, v27
  ds_write2_b32 v218, v48, v49 offset0:72 offset1:73
  v_cvt_pk_bf16_f32 v48, v28, v29
  v_cvt_pk_bf16_f32 v49, v30, v31
  ds_write2_b32 v218, v48, v49 offset0:76 offset1:77
  v_add_u32 v218, 16512, v218
  s_waitcnt vmcnt(0) lgkmcnt(0)
  s_barrier
  v_mul_u32_u24 v219, 516, v200
  s_mul_i32 s54, s52, 36
  s_add_u32 s55, s54, 83016
  v_add_u32 v219, s55, v219
  v_mul_u32_u24 v220, 1152, v200
  s_mul_i32 s55, s68, 144
  s_add_u32 s54, s54, s55
  s_mul_i32 s55, s69, 147456
  s_add_u32 s64, s54, s55
  s_add_u32 s64, s64, 62914560
  s_lshl_b32 s66, s69, 7
  s_mov_b32 s57, 1051597459
  ds_read_b32 v0, v219 offset:7224
  ds_read_b32 v1, v219 offset:7228
  ds_read_b32 v2, v219 offset:7232
  ds_read_b32 v3, v219 offset:7236
  ds_read_b32 v4, v219 offset:7240
  ds_read_b32 v5, v219 offset:7244
  ds_read_b32 v6, v219 offset:7248
  ds_read_b32 v7, v219 offset:7252
  ds_read_b32 v8, v219 offset:7256
  ds_read_b32 v16, v219 offset:7368
  ds_read_b32 v17, v219 offset:7372
  ds_read_b32 v18, v219 offset:7376
  ds_read_b32 v19, v219 offset:7380
  ds_read_b32 v20, v219 offset:7384
  ds_read_b32 v21, v219 offset:7388
  ds_read_b32 v22, v219 offset:7392
  ds_read_b32 v23, v219 offset:7396
  ds_read_b32 v24, v219 offset:7400
  ds_read_b32 v25, v219 offset:6336
  ds_read_b32 v26, v219 offset:6340
  ds_read_b32 v27, v219 offset:6344
  ds_read_b32 v28, v219 offset:6348
  ds_read_b32 v29, v219 offset:6352
  ds_read_b32 v30, v219 offset:6356
  ds_read_b32 v31, v219 offset:6360
  ds_read_b32 v32, v219 offset:6364
  ds_read_b32 v33, v219 offset:6368
  ds_read_b32 v34, v219 offset:5304
  ds_read_b32 v35, v219 offset:5308
  ds_read_b32 v36, v219 offset:5312
  ds_read_b32 v37, v219 offset:5316
  ds_read_b32 v38, v219 offset:5320
  ds_read_b32 v39, v219 offset:5324
  ds_read_b32 v40, v219 offset:5328
  ds_read_b32 v41, v219 offset:5332
  ds_read_b32 v42, v219 offset:5336
  ds_read_b32 v43, v219 offset:4272
  ds_read_b32 v44, v219 offset:4276
  ds_read_b32 v45, v219 offset:4280
  ds_read_b32 v46, v219 offset:4284
  ds_read_b32 v47, v219 offset:4288
  ds_read_b32 v48, v219 offset:4292
  ds_read_b32 v49, v219 offset:4296
  ds_read_b32 v50, v219 offset:4300
  ds_read_b32 v51, v219 offset:4304
  ds_read_b32 v52, v219 offset:3240
  ds_read_b32 v53, v219 offset:3244
  ds_read_b32 v54, v219 offset:3248
  ds_read_b32 v55, v219 offset:3252
  ds_read_b32 v56, v219 offset:3256
  ds_read_b32 v57, v219 offset:3260
  ds_read_b32 v58, v219 offset:3264
  ds_read_b32 v59, v219 offset:3268
  ds_read_b32 v60, v219 offset:3272
  ds_read_b32 v61, v219 offset:2208
  ds_read_b32 v62, v219 offset:2212
  ds_read_b32 v63, v219 offset:2216
  ds_read_b32 v64, v219 offset:2220
  ds_read_b32 v65, v219 offset:2224
  ds_read_b32 v66, v219 offset:2228
  ds_read_b32 v67, v219 offset:2232
  ds_read_b32 v68, v219 offset:2236
  ds_read_b32 v69, v219 offset:2240
  ds_read_b32 v70, v219 offset:1176
  ds_read_b32 v71, v219 offset:1180
  ds_read_b32 v72, v219 offset:1184
  ds_read_b32 v73, v219 offset:1188
  ds_read_b32 v74, v219 offset:1192
  ds_read_b32 v75, v219 offset:1196
  ds_read_b32 v76, v219 offset:1200
  ds_read_b32 v77, v219 offset:1204
  ds_read_b32 v78, v219 offset:1208
  ds_read_b32 v79, v219 offset:144
  ds_read_b32 v80, v219 offset:148
  ds_read_b32 v81, v219 offset:152
  ds_read_b32 v82, v219 offset:156
  ds_read_b32 v83, v219 offset:160
  ds_read_b32 v84, v219 offset:164
  ds_read_b32 v85, v219 offset:168
  ds_read_b32 v86, v219 offset:172
  ds_read_b32 v87, v219 offset:176
  v_mov_b32 v100, 0
  v_mov_b32 v101, 0
  v_mov_b32 v102, 0
  v_mov_b32 v103, 0
  v_mov_b32 v104, 0
  v_mov_b32 v105, 0
  v_mov_b32 v106, 0
  v_mov_b32 v107, 0
  s_waitcnt lgkmcnt(15)
  v_dot2c_f32_bf16 v100, v0, v16
  v_dot2c_f32_bf16 v101, v0, v25
  v_dot2c_f32_bf16 v102, v0, v34
  v_dot2c_f32_bf16 v103, v0, v43
  v_dot2c_f32_bf16 v104, v0, v52
  v_dot2c_f32_bf16 v105, v0, v61
  v_dot2c_f32_bf16 v106, v0, v70
  s_waitcnt lgkmcnt(8)
  v_dot2c_f32_bf16 v107, v0, v79
  v_dot2c_f32_bf16 v100, v1, v17
  v_dot2c_f32_bf16 v101, v1, v26
  v_dot2c_f32_bf16 v102, v1, v35
  v_dot2c_f32_bf16 v103, v1, v44
  v_dot2c_f32_bf16 v104, v1, v53
  v_dot2c_f32_bf16 v105, v1, v62
  v_dot2c_f32_bf16 v106, v1, v71
  s_waitcnt lgkmcnt(7)
  v_dot2c_f32_bf16 v107, v1, v80
  v_dot2c_f32_bf16 v100, v2, v18
  v_dot2c_f32_bf16 v101, v2, v27
  v_dot2c_f32_bf16 v102, v2, v36
  v_dot2c_f32_bf16 v103, v2, v45
  v_dot2c_f32_bf16 v104, v2, v54
  v_dot2c_f32_bf16 v105, v2, v63
  v_dot2c_f32_bf16 v106, v2, v72
  s_waitcnt lgkmcnt(6)
  v_dot2c_f32_bf16 v107, v2, v81
  v_dot2c_f32_bf16 v100, v3, v19
  v_dot2c_f32_bf16 v101, v3, v28
  v_dot2c_f32_bf16 v102, v3, v37
  v_dot2c_f32_bf16 v103, v3, v46
  v_dot2c_f32_bf16 v104, v3, v55
  v_dot2c_f32_bf16 v105, v3, v64
  v_dot2c_f32_bf16 v106, v3, v73
  s_waitcnt lgkmcnt(5)
  v_dot2c_f32_bf16 v107, v3, v82
  v_dot2c_f32_bf16 v100, v4, v20
  v_dot2c_f32_bf16 v101, v4, v29
  v_dot2c_f32_bf16 v102, v4, v38
  v_dot2c_f32_bf16 v103, v4, v47
  v_dot2c_f32_bf16 v104, v4, v56
  v_dot2c_f32_bf16 v105, v4, v65
  v_dot2c_f32_bf16 v106, v4, v74
  s_waitcnt lgkmcnt(4)
  v_dot2c_f32_bf16 v107, v4, v83
  v_dot2c_f32_bf16 v100, v5, v21
  v_dot2c_f32_bf16 v101, v5, v30
  v_dot2c_f32_bf16 v102, v5, v39
  v_dot2c_f32_bf16 v103, v5, v48
  v_dot2c_f32_bf16 v104, v5, v57
  v_dot2c_f32_bf16 v105, v5, v66
  v_dot2c_f32_bf16 v106, v5, v75
  s_waitcnt lgkmcnt(3)
  v_dot2c_f32_bf16 v107, v5, v84
  v_dot2c_f32_bf16 v100, v6, v22
  v_dot2c_f32_bf16 v101, v6, v31
  v_dot2c_f32_bf16 v102, v6, v40
  v_dot2c_f32_bf16 v103, v6, v49
  v_dot2c_f32_bf16 v104, v6, v58
  v_dot2c_f32_bf16 v105, v6, v67
  v_dot2c_f32_bf16 v106, v6, v76
  s_waitcnt lgkmcnt(2)
  v_dot2c_f32_bf16 v107, v6, v85
  v_dot2c_f32_bf16 v100, v7, v23
  v_dot2c_f32_bf16 v101, v7, v32
  v_dot2c_f32_bf16 v102, v7, v41
  v_dot2c_f32_bf16 v103, v7, v50
  v_dot2c_f32_bf16 v104, v7, v59
  v_dot2c_f32_bf16 v105, v7, v68
  v_dot2c_f32_bf16 v106, v7, v77
  s_waitcnt lgkmcnt(1)
  v_dot2c_f32_bf16 v107, v7, v86
  v_dot2c_f32_bf16 v100, v8, v24
  v_dot2c_f32_bf16 v101, v8, v33
  v_dot2c_f32_bf16 v102, v8, v42
  v_dot2c_f32_bf16 v103, v8, v51
  v_dot2c_f32_bf16 v104, v8, v60
  v_dot2c_f32_bf16 v105, v8, v69
  v_dot2c_f32_bf16 v106, v8, v78
  s_waitcnt lgkmcnt(0)
  v_dot2c_f32_bf16 v107, v8, v87
  ds_read_b32 v16, v219 offset:7512
  ds_read_b32 v17, v219 offset:7516
  ds_read_b32 v18, v219 offset:7520
  ds_read_b32 v19, v219 offset:7524
  ds_read_b32 v20, v219 offset:7528
  ds_read_b32 v21, v219 offset:7532
  ds_read_b32 v22, v219 offset:7536
  ds_read_b32 v23, v219 offset:7540
  ds_read_b32 v24, v219 offset:7544
  ds_read_b32 v25, v219 offset:6480
  ds_read_b32 v26, v219 offset:6484
  ds_read_b32 v27, v219 offset:6488
  ds_read_b32 v28, v219 offset:6492
  ds_read_b32 v29, v219 offset:6496
  ds_read_b32 v30, v219 offset:6500
  ds_read_b32 v31, v219 offset:6504
  ds_read_b32 v32, v219 offset:6508
  ds_read_b32 v33, v219 offset:6512
  ds_read_b32 v34, v219 offset:5448
  ds_read_b32 v35, v219 offset:5452
  ds_read_b32 v36, v219 offset:5456
  ds_read_b32 v37, v219 offset:5460
  ds_read_b32 v38, v219 offset:5464
  ds_read_b32 v39, v219 offset:5468
  ds_read_b32 v40, v219 offset:5472
  ds_read_b32 v41, v219 offset:5476
  ds_read_b32 v42, v219 offset:5480
  ds_read_b32 v43, v219 offset:4416
  ds_read_b32 v44, v219 offset:4420
  ds_read_b32 v45, v219 offset:4424
  ds_read_b32 v46, v219 offset:4428
  ds_read_b32 v47, v219 offset:4432
  ds_read_b32 v48, v219 offset:4436
  ds_read_b32 v49, v219 offset:4440
  ds_read_b32 v50, v219 offset:4444
  ds_read_b32 v51, v219 offset:4448
  ds_read_b32 v52, v219 offset:3384
  ds_read_b32 v53, v219 offset:3388
  ds_read_b32 v54, v219 offset:3392
  ds_read_b32 v55, v219 offset:3396
  ds_read_b32 v56, v219 offset:3400
  ds_read_b32 v57, v219 offset:3404
  ds_read_b32 v58, v219 offset:3408
  ds_read_b32 v59, v219 offset:3412
  ds_read_b32 v60, v219 offset:3416
  ds_read_b32 v61, v219 offset:2352
  ds_read_b32 v62, v219 offset:2356
  ds_read_b32 v63, v219 offset:2360
  ds_read_b32 v64, v219 offset:2364
  ds_read_b32 v65, v219 offset:2368
  ds_read_b32 v66, v219 offset:2372
  ds_read_b32 v67, v219 offset:2376
  ds_read_b32 v68, v219 offset:2380
  ds_read_b32 v69, v219 offset:2384
  ds_read_b32 v70, v219 offset:1320
  ds_read_b32 v71, v219 offset:1324
  ds_read_b32 v72, v219 offset:1328
  ds_read_b32 v73, v219 offset:1332
  ds_read_b32 v74, v219 offset:1336
  ds_read_b32 v75, v219 offset:1340
  ds_read_b32 v76, v219 offset:1344
  ds_read_b32 v77, v219 offset:1348
  ds_read_b32 v78, v219 offset:1352
  ds_read_b32 v79, v219 offset:288
  ds_read_b32 v80, v219 offset:292
  ds_read_b32 v81, v219 offset:296
  ds_read_b32 v82, v219 offset:300
  ds_read_b32 v83, v219 offset:304
  ds_read_b32 v84, v219 offset:308
  ds_read_b32 v85, v219 offset:312
  ds_read_b32 v86, v219 offset:316
  ds_read_b32 v87, v219 offset:320
  v_add_u32 v211, s66, v200
  v_mov_b32 v212, 0xf149f2ca
  v_mul_f32 v100, s57, v100
  v_mul_f32 v101, s57, v101
  v_mul_f32 v102, s57, v102
  v_mul_f32 v103, s57, v103
  v_mul_f32 v104, s57, v104
  v_mul_f32 v105, s57, v105
  v_mul_f32 v106, s57, v106
  v_mul_f32 v107, s57, v107
  v_cmp_gt_u32 vcc, 2, v211
  s_nop 1
  v_cndmask_b32 v101, v101, v212, vcc
  v_cmp_gt_u32 vcc, 4, v211
  s_nop 1
  v_cndmask_b32 v102, v102, v212, vcc
  v_cmp_gt_u32 vcc, 6, v211
  s_nop 1
  v_cndmask_b32 v103, v103, v212, vcc
  v_cmp_gt_u32 vcc, 8, v211
  s_nop 1
  v_cndmask_b32 v104, v104, v212, vcc
  v_cmp_gt_u32 vcc, 10, v211
  s_nop 1
  v_cndmask_b32 v105, v105, v212, vcc
  v_cmp_gt_u32 vcc, 12, v211
  s_nop 1
  v_cndmask_b32 v106, v106, v212, vcc
  v_cmp_gt_u32 vcc, 14, v211
  s_nop 1
  v_cndmask_b32 v107, v107, v212, vcc
  v_max3_f32 v213, v100, v101, v102
  v_max3_f32 v213, v213, v103, v104
  v_max3_f32 v213, v213, v105, v106
  v_max_f32 v213, v213, v107
  v_sub_f32 v100, v100, v213
  v_sub_f32 v101, v101, v213
  v_sub_f32 v102, v102, v213
  v_sub_f32 v103, v103, v213
  v_sub_f32 v104, v104, v213
  v_sub_f32 v105, v105, v213
  v_sub_f32 v106, v106, v213
  v_sub_f32 v107, v107, v213
  v_exp_f32 v100, v100
  v_exp_f32 v101, v101
  v_exp_f32 v102, v102
  v_exp_f32 v103, v103
  v_exp_f32 v104, v104
  v_exp_f32 v105, v105
  v_exp_f32 v106, v106
  v_exp_f32 v107, v107
  v_add_f32 v213, v100, v101
  v_add_f32 v213, v213, v102
  v_add_f32 v213, v213, v103
  v_add_f32 v213, v213, v104
  v_add_f32 v213, v213, v105
  v_add_f32 v213, v213, v106
  v_add_f32 v213, v213, v107
  v_rcp_f32 v213, v213
  v_mov_b32 v214, 0
  v_mul_f32 v100, v213, v100
  v_mul_f32 v101, v213, v101
  v_mul_f32 v102, v213, v102
  v_mul_f32 v103, v213, v103
  v_mul_f32 v104, v213, v104
  v_mul_f32 v105, v213, v105
  v_mul_f32 v106, v213, v106
  v_mul_f32 v107, v213, v107
  v_mov_b32 v112, 0
  v_mov_b32 v113, 0
  v_mov_b32 v114, 0
  v_mov_b32 v115, 0
  v_mov_b32 v116, 0
  v_mov_b32 v117, 0
  v_mov_b32 v118, 0
  v_mov_b32 v119, 0
  v_mov_b32 v120, 0
  v_mov_b32 v121, 0
  v_mov_b32 v122, 0
  v_mov_b32 v123, 0
  v_mov_b32 v124, 0
  v_mov_b32 v125, 0
  v_mov_b32 v126, 0
  v_mov_b32 v127, 0
  v_mov_b32 v128, 0
  v_mov_b32 v129, 0
  v_cvt_pk_bf16_f32 v0, v100, v214
  v_cvt_pk_bf16_f32 v1, v214, v100
  s_waitcnt lgkmcnt(15)
  v_dot2c_f32_bf16 v112, v16, v0
  v_dot2c_f32_bf16 v113, v16, v1
  v_dot2c_f32_bf16 v114, v17, v0
  v_dot2c_f32_bf16 v115, v17, v1
  v_dot2c_f32_bf16 v116, v18, v0
  v_dot2c_f32_bf16 v117, v18, v1
  v_dot2c_f32_bf16 v118, v19, v0
  v_dot2c_f32_bf16 v119, v19, v1
  v_dot2c_f32_bf16 v120, v20, v0
  v_dot2c_f32_bf16 v121, v20, v1
  v_dot2c_f32_bf16 v122, v21, v0
  v_dot2c_f32_bf16 v123, v21, v1
  v_dot2c_f32_bf16 v124, v22, v0
  v_dot2c_f32_bf16 v125, v22, v1
  v_dot2c_f32_bf16 v126, v23, v0
  v_dot2c_f32_bf16 v127, v23, v1
  v_dot2c_f32_bf16 v128, v24, v0
  v_dot2c_f32_bf16 v129, v24, v1
  v_cvt_pk_bf16_f32 v2, v101, v214
  v_cvt_pk_bf16_f32 v3, v214, v101
  v_dot2c_f32_bf16 v112, v25, v2
  v_dot2c_f32_bf16 v113, v25, v3
  v_dot2c_f32_bf16 v114, v26, v2
  v_dot2c_f32_bf16 v115, v26, v3
  v_dot2c_f32_bf16 v116, v27, v2
  v_dot2c_f32_bf16 v117, v27, v3
  v_dot2c_f32_bf16 v118, v28, v2
  v_dot2c_f32_bf16 v119, v28, v3
  v_dot2c_f32_bf16 v120, v29, v2
  v_dot2c_f32_bf16 v121, v29, v3
  v_dot2c_f32_bf16 v122, v30, v2
  v_dot2c_f32_bf16 v123, v30, v3
  v_dot2c_f32_bf16 v124, v31, v2
  v_dot2c_f32_bf16 v125, v31, v3
  v_dot2c_f32_bf16 v126, v32, v2
  v_dot2c_f32_bf16 v127, v32, v3
  v_dot2c_f32_bf16 v128, v33, v2
  v_dot2c_f32_bf16 v129, v33, v3
  v_cvt_pk_bf16_f32 v0, v102, v214
  v_cvt_pk_bf16_f32 v1, v214, v102
  v_dot2c_f32_bf16 v112, v34, v0
  v_dot2c_f32_bf16 v113, v34, v1
  v_dot2c_f32_bf16 v114, v35, v0
  v_dot2c_f32_bf16 v115, v35, v1
  v_dot2c_f32_bf16 v116, v36, v0
  v_dot2c_f32_bf16 v117, v36, v1
  v_dot2c_f32_bf16 v118, v37, v0
  v_dot2c_f32_bf16 v119, v37, v1
  v_dot2c_f32_bf16 v120, v38, v0
  v_dot2c_f32_bf16 v121, v38, v1
  v_dot2c_f32_bf16 v122, v39, v0
  v_dot2c_f32_bf16 v123, v39, v1
  v_dot2c_f32_bf16 v124, v40, v0
  v_dot2c_f32_bf16 v125, v40, v1
  v_dot2c_f32_bf16 v126, v41, v0
  v_dot2c_f32_bf16 v127, v41, v1
  v_dot2c_f32_bf16 v128, v42, v0
  v_dot2c_f32_bf16 v129, v42, v1
  v_cvt_pk_bf16_f32 v2, v103, v214
  v_cvt_pk_bf16_f32 v3, v214, v103
  v_dot2c_f32_bf16 v112, v43, v2
  v_dot2c_f32_bf16 v113, v43, v3
  v_dot2c_f32_bf16 v114, v44, v2
  v_dot2c_f32_bf16 v115, v44, v3
  v_dot2c_f32_bf16 v116, v45, v2
  v_dot2c_f32_bf16 v117, v45, v3
  v_dot2c_f32_bf16 v118, v46, v2
  v_dot2c_f32_bf16 v119, v46, v3
  v_dot2c_f32_bf16 v120, v47, v2
  v_dot2c_f32_bf16 v121, v47, v3
  v_dot2c_f32_bf16 v122, v48, v2
  v_dot2c_f32_bf16 v123, v48, v3
  v_dot2c_f32_bf16 v124, v49, v2
  v_dot2c_f32_bf16 v125, v49, v3
  v_dot2c_f32_bf16 v126, v50, v2
  v_dot2c_f32_bf16 v127, v50, v3
  v_dot2c_f32_bf16 v128, v51, v2
  v_dot2c_f32_bf16 v129, v51, v3
  v_cvt_pk_bf16_f32 v0, v104, v214
  v_cvt_pk_bf16_f32 v1, v214, v104
  v_dot2c_f32_bf16 v112, v52, v0
  v_dot2c_f32_bf16 v113, v52, v1
  v_dot2c_f32_bf16 v114, v53, v0
  v_dot2c_f32_bf16 v115, v53, v1
  v_dot2c_f32_bf16 v116, v54, v0
  v_dot2c_f32_bf16 v117, v54, v1
  v_dot2c_f32_bf16 v118, v55, v0
  v_dot2c_f32_bf16 v119, v55, v1
  v_dot2c_f32_bf16 v120, v56, v0
  v_dot2c_f32_bf16 v121, v56, v1
  v_dot2c_f32_bf16 v122, v57, v0
  v_dot2c_f32_bf16 v123, v57, v1
  v_dot2c_f32_bf16 v124, v58, v0
  v_dot2c_f32_bf16 v125, v58, v1
  v_dot2c_f32_bf16 v126, v59, v0
  v_dot2c_f32_bf16 v127, v59, v1
  v_dot2c_f32_bf16 v128, v60, v0
  v_dot2c_f32_bf16 v129, v60, v1
  v_cvt_pk_bf16_f32 v2, v105, v214
  v_cvt_pk_bf16_f32 v3, v214, v105
  v_dot2c_f32_bf16 v112, v61, v2
  v_dot2c_f32_bf16 v113, v61, v3
  v_dot2c_f32_bf16 v114, v62, v2
  v_dot2c_f32_bf16 v115, v62, v3
  v_dot2c_f32_bf16 v116, v63, v2
  v_dot2c_f32_bf16 v117, v63, v3
  v_dot2c_f32_bf16 v118, v64, v2
  v_dot2c_f32_bf16 v119, v64, v3
  v_dot2c_f32_bf16 v120, v65, v2
  v_dot2c_f32_bf16 v121, v65, v3
  v_dot2c_f32_bf16 v122, v66, v2
  v_dot2c_f32_bf16 v123, v66, v3
  v_dot2c_f32_bf16 v124, v67, v2
  v_dot2c_f32_bf16 v125, v67, v3
  v_dot2c_f32_bf16 v126, v68, v2
  v_dot2c_f32_bf16 v127, v68, v3
  v_dot2c_f32_bf16 v128, v69, v2
  v_dot2c_f32_bf16 v129, v69, v3
  v_cvt_pk_bf16_f32 v0, v106, v214
  v_cvt_pk_bf16_f32 v1, v214, v106
  v_dot2c_f32_bf16 v112, v70, v0
  v_dot2c_f32_bf16 v113, v70, v1
  v_dot2c_f32_bf16 v114, v71, v0
  v_dot2c_f32_bf16 v115, v71, v1
  v_dot2c_f32_bf16 v116, v72, v0
  v_dot2c_f32_bf16 v117, v72, v1
  s_waitcnt lgkmcnt(14)
  v_dot2c_f32_bf16 v118, v73, v0
  v_dot2c_f32_bf16 v119, v73, v1
  s_waitcnt lgkmcnt(13)
  v_dot2c_f32_bf16 v120, v74, v0
  v_dot2c_f32_bf16 v121, v74, v1
  s_waitcnt lgkmcnt(12)
  v_dot2c_f32_bf16 v122, v75, v0
  v_dot2c_f32_bf16 v123, v75, v1
  s_waitcnt lgkmcnt(11)
  v_dot2c_f32_bf16 v124, v76, v0
  v_dot2c_f32_bf16 v125, v76, v1
  s_waitcnt lgkmcnt(10)
  v_dot2c_f32_bf16 v126, v77, v0
  v_dot2c_f32_bf16 v127, v77, v1
  s_waitcnt lgkmcnt(9)
  v_dot2c_f32_bf16 v128, v78, v0
  v_dot2c_f32_bf16 v129, v78, v1
  v_cvt_pk_bf16_f32 v2, v107, v214
  v_cvt_pk_bf16_f32 v3, v214, v107
  s_waitcnt lgkmcnt(8)
  v_dot2c_f32_bf16 v112, v79, v2
  v_dot2c_f32_bf16 v113, v79, v3
  s_waitcnt lgkmcnt(7)
  v_dot2c_f32_bf16 v114, v80, v2
  v_dot2c_f32_bf16 v115, v80, v3
  s_waitcnt lgkmcnt(6)
  v_dot2c_f32_bf16 v116, v81, v2
  v_dot2c_f32_bf16 v117, v81, v3
  s_waitcnt lgkmcnt(5)
  v_dot2c_f32_bf16 v118, v82, v2
  v_dot2c_f32_bf16 v119, v82, v3
  s_waitcnt lgkmcnt(4)
  v_dot2c_f32_bf16 v120, v83, v2
  v_dot2c_f32_bf16 v121, v83, v3
  s_waitcnt lgkmcnt(3)
  v_dot2c_f32_bf16 v122, v84, v2
  v_dot2c_f32_bf16 v123, v84, v3
  s_waitcnt lgkmcnt(2)
  v_dot2c_f32_bf16 v124, v85, v2
  v_dot2c_f32_bf16 v125, v85, v3
  s_waitcnt lgkmcnt(1)
  v_dot2c_f32_bf16 v126, v86, v2
  v_dot2c_f32_bf16 v127, v86, v3
  s_waitcnt lgkmcnt(0)
  v_dot2c_f32_bf16 v128, v87, v2
  v_dot2c_f32_bf16 v129, v87, v3
  v_cvt_pk_bf16_f32 v132, v112, v113
  v_cvt_pk_bf16_f32 v133, v114, v115
  v_cvt_pk_bf16_f32 v134, v116, v117
  v_cvt_pk_bf16_f32 v135, v118, v119
  v_cvt_pk_bf16_f32 v136, v120, v121
  v_cvt_pk_bf16_f32 v137, v122, v123
  v_cvt_pk_bf16_f32 v138, v124, v125
  v_cvt_pk_bf16_f32 v139, v126, v127
  v_cvt_pk_bf16_f32 v140, v128, v129
  buffer_store_dwordx4 v[132:135], v220, s[8:11], s64 offen sc1
  buffer_store_dwordx4 v[136:139], v220, s[8:11], s64 offen offset:16 sc1
  buffer_store_dword v140, v220, s[8:11], s64 offen offset:32 sc1
  v_add_u32 v219, 33024, v219
  s_add_u32 s66, s66, 64
  s_add_u32 s64, s64, 73728
  ds_read_b32 v0, v219 offset:7224
  ds_read_b32 v1, v219 offset:7228
  ds_read_b32 v2, v219 offset:7232
  ds_read_b32 v3, v219 offset:7236
  ds_read_b32 v4, v219 offset:7240
  ds_read_b32 v5, v219 offset:7244
  ds_read_b32 v6, v219 offset:7248
  ds_read_b32 v7, v219 offset:7252
  ds_read_b32 v8, v219 offset:7256
  ds_read_b32 v16, v219 offset:7368
  ds_read_b32 v17, v219 offset:7372
  ds_read_b32 v18, v219 offset:7376
  ds_read_b32 v19, v219 offset:7380
  ds_read_b32 v20, v219 offset:7384
  ds_read_b32 v21, v219 offset:7388
  ds_read_b32 v22, v219 offset:7392
  ds_read_b32 v23, v219 offset:7396
  ds_read_b32 v24, v219 offset:7400
  ds_read_b32 v25, v219 offset:6336
  ds_read_b32 v26, v219 offset:6340
  ds_read_b32 v27, v219 offset:6344
  ds_read_b32 v28, v219 offset:6348
  ds_read_b32 v29, v219 offset:6352
  ds_read_b32 v30, v219 offset:6356
  ds_read_b32 v31, v219 offset:6360
  ds_read_b32 v32, v219 offset:6364
  ds_read_b32 v33, v219 offset:6368
  ds_read_b32 v34, v219 offset:5304
  ds_read_b32 v35, v219 offset:5308
  ds_read_b32 v36, v219 offset:5312
  ds_read_b32 v37, v219 offset:5316
  ds_read_b32 v38, v219 offset:5320
  ds_read_b32 v39, v219 offset:5324
  ds_read_b32 v40, v219 offset:5328
  ds_read_b32 v41, v219 offset:5332
  ds_read_b32 v42, v219 offset:5336
  ds_read_b32 v43, v219 offset:4272
  ds_read_b32 v44, v219 offset:4276
  ds_read_b32 v45, v219 offset:4280
  ds_read_b32 v46, v219 offset:4284
  ds_read_b32 v47, v219 offset:4288
  ds_read_b32 v48, v219 offset:4292
  ds_read_b32 v49, v219 offset:4296
  ds_read_b32 v50, v219 offset:4300
  ds_read_b32 v51, v219 offset:4304
  ds_read_b32 v52, v219 offset:3240
  ds_read_b32 v53, v219 offset:3244
  ds_read_b32 v54, v219 offset:3248
  ds_read_b32 v55, v219 offset:3252
  ds_read_b32 v56, v219 offset:3256
  ds_read_b32 v57, v219 offset:3260
  ds_read_b32 v58, v219 offset:3264
  ds_read_b32 v59, v219 offset:3268
  ds_read_b32 v60, v219 offset:3272
  ds_read_b32 v61, v219 offset:2208
  ds_read_b32 v62, v219 offset:2212
  ds_read_b32 v63, v219 offset:2216
  ds_read_b32 v64, v219 offset:2220
  ds_read_b32 v65, v219 offset:2224
  ds_read_b32 v66, v219 offset:2228
  ds_read_b32 v67, v219 offset:2232
  ds_read_b32 v68, v219 offset:2236
  ds_read_b32 v69, v219 offset:2240
  ds_read_b32 v70, v219 offset:1176
  ds_read_b32 v71, v219 offset:1180
  ds_read_b32 v72, v219 offset:1184
  ds_read_b32 v73, v219 offset:1188
  ds_read_b32 v74, v219 offset:1192
  ds_read_b32 v75, v219 offset:1196
  ds_read_b32 v76, v219 offset:1200
  ds_read_b32 v77, v219 offset:1204
  ds_read_b32 v78, v219 offset:1208
  ds_read_b32 v79, v219 offset:144
  ds_read_b32 v80, v219 offset:148
  ds_read_b32 v81, v219 offset:152
  ds_read_b32 v82, v219 offset:156
  ds_read_b32 v83, v219 offset:160
  ds_read_b32 v84, v219 offset:164
  ds_read_b32 v85, v219 offset:168
  ds_read_b32 v86, v219 offset:172
  ds_read_b32 v87, v219 offset:176
  v_mov_b32 v100, 0
  v_mov_b32 v101, 0
  v_mov_b32 v102, 0
  v_mov_b32 v103, 0
  v_mov_b32 v104, 0
  v_mov_b32 v105, 0
  v_mov_b32 v106, 0
  v_mov_b32 v107, 0
  s_waitcnt lgkmcnt(15)
  v_dot2c_f32_bf16 v100, v0, v16
  v_dot2c_f32_bf16 v101, v0, v25
  v_dot2c_f32_bf16 v102, v0, v34
  v_dot2c_f32_bf16 v103, v0, v43
  v_dot2c_f32_bf16 v104, v0, v52
  v_dot2c_f32_bf16 v105, v0, v61
  v_dot2c_f32_bf16 v106, v0, v70
  s_waitcnt lgkmcnt(8)
  v_dot2c_f32_bf16 v107, v0, v79
  v_dot2c_f32_bf16 v100, v1, v17
  v_dot2c_f32_bf16 v101, v1, v26
  v_dot2c_f32_bf16 v102, v1, v35
  v_dot2c_f32_bf16 v103, v1, v44
  v_dot2c_f32_bf16 v104, v1, v53
  v_dot2c_f32_bf16 v105, v1, v62
  v_dot2c_f32_bf16 v106, v1, v71
  s_waitcnt lgkmcnt(7)
  v_dot2c_f32_bf16 v107, v1, v80
  v_dot2c_f32_bf16 v100, v2, v18
  v_dot2c_f32_bf16 v101, v2, v27
  v_dot2c_f32_bf16 v102, v2, v36
  v_dot2c_f32_bf16 v103, v2, v45
  v_dot2c_f32_bf16 v104, v2, v54
  v_dot2c_f32_bf16 v105, v2, v63
  v_dot2c_f32_bf16 v106, v2, v72
  s_waitcnt lgkmcnt(6)
  v_dot2c_f32_bf16 v107, v2, v81
  v_dot2c_f32_bf16 v100, v3, v19
  v_dot2c_f32_bf16 v101, v3, v28
  v_dot2c_f32_bf16 v102, v3, v37
  v_dot2c_f32_bf16 v103, v3, v46
  v_dot2c_f32_bf16 v104, v3, v55
  v_dot2c_f32_bf16 v105, v3, v64
  v_dot2c_f32_bf16 v106, v3, v73
  s_waitcnt lgkmcnt(5)
  v_dot2c_f32_bf16 v107, v3, v82
  v_dot2c_f32_bf16 v100, v4, v20
  v_dot2c_f32_bf16 v101, v4, v29
  v_dot2c_f32_bf16 v102, v4, v38
  v_dot2c_f32_bf16 v103, v4, v47
  v_dot2c_f32_bf16 v104, v4, v56
  v_dot2c_f32_bf16 v105, v4, v65
  v_dot2c_f32_bf16 v106, v4, v74
  s_waitcnt lgkmcnt(4)
  v_dot2c_f32_bf16 v107, v4, v83
  v_dot2c_f32_bf16 v100, v5, v21
  v_dot2c_f32_bf16 v101, v5, v30
  v_dot2c_f32_bf16 v102, v5, v39
  v_dot2c_f32_bf16 v103, v5, v48
  v_dot2c_f32_bf16 v104, v5, v57
  v_dot2c_f32_bf16 v105, v5, v66
  v_dot2c_f32_bf16 v106, v5, v75
  s_waitcnt lgkmcnt(3)
  v_dot2c_f32_bf16 v107, v5, v84
  v_dot2c_f32_bf16 v100, v6, v22
  v_dot2c_f32_bf16 v101, v6, v31
  v_dot2c_f32_bf16 v102, v6, v40
  v_dot2c_f32_bf16 v103, v6, v49
  v_dot2c_f32_bf16 v104, v6, v58
  v_dot2c_f32_bf16 v105, v6, v67
  v_dot2c_f32_bf16 v106, v6, v76
  s_waitcnt lgkmcnt(2)
  v_dot2c_f32_bf16 v107, v6, v85
  v_dot2c_f32_bf16 v100, v7, v23
  v_dot2c_f32_bf16 v101, v7, v32
  v_dot2c_f32_bf16 v102, v7, v41
  v_dot2c_f32_bf16 v103, v7, v50
  v_dot2c_f32_bf16 v104, v7, v59
  v_dot2c_f32_bf16 v105, v7, v68
  v_dot2c_f32_bf16 v106, v7, v77
  s_waitcnt lgkmcnt(1)
  v_dot2c_f32_bf16 v107, v7, v86
  v_dot2c_f32_bf16 v100, v8, v24
  v_dot2c_f32_bf16 v101, v8, v33
  v_dot2c_f32_bf16 v102, v8, v42
  v_dot2c_f32_bf16 v103, v8, v51
  v_dot2c_f32_bf16 v104, v8, v60
  v_dot2c_f32_bf16 v105, v8, v69
  v_dot2c_f32_bf16 v106, v8, v78
  s_waitcnt lgkmcnt(0)
  v_dot2c_f32_bf16 v107, v8, v87
  ds_read_b32 v16, v219 offset:7512
  ds_read_b32 v17, v219 offset:7516
  ds_read_b32 v18, v219 offset:7520
  ds_read_b32 v19, v219 offset:7524
  ds_read_b32 v20, v219 offset:7528
  ds_read_b32 v21, v219 offset:7532
  ds_read_b32 v22, v219 offset:7536
  ds_read_b32 v23, v219 offset:7540
  ds_read_b32 v24, v219 offset:7544
  ds_read_b32 v25, v219 offset:6480
  ds_read_b32 v26, v219 offset:6484
  ds_read_b32 v27, v219 offset:6488
  ds_read_b32 v28, v219 offset:6492
  ds_read_b32 v29, v219 offset:6496
  ds_read_b32 v30, v219 offset:6500
  ds_read_b32 v31, v219 offset:6504
  ds_read_b32 v32, v219 offset:6508
  ds_read_b32 v33, v219 offset:6512
  ds_read_b32 v34, v219 offset:5448
  ds_read_b32 v35, v219 offset:5452
  ds_read_b32 v36, v219 offset:5456
  ds_read_b32 v37, v219 offset:5460
  ds_read_b32 v38, v219 offset:5464
  ds_read_b32 v39, v219 offset:5468
  ds_read_b32 v40, v219 offset:5472
  ds_read_b32 v41, v219 offset:5476
  ds_read_b32 v42, v219 offset:5480
  ds_read_b32 v43, v219 offset:4416
  ds_read_b32 v44, v219 offset:4420
  ds_read_b32 v45, v219 offset:4424
  ds_read_b32 v46, v219 offset:4428
  ds_read_b32 v47, v219 offset:4432
  ds_read_b32 v48, v219 offset:4436
  ds_read_b32 v49, v219 offset:4440
  ds_read_b32 v50, v219 offset:4444
  ds_read_b32 v51, v219 offset:4448
  ds_read_b32 v52, v219 offset:3384
  ds_read_b32 v53, v219 offset:3388
  ds_read_b32 v54, v219 offset:3392
  ds_read_b32 v55, v219 offset:3396
  ds_read_b32 v56, v219 offset:3400
  ds_read_b32 v57, v219 offset:3404
  ds_read_b32 v58, v219 offset:3408
  ds_read_b32 v59, v219 offset:3412
  ds_read_b32 v60, v219 offset:3416
  ds_read_b32 v61, v219 offset:2352
  ds_read_b32 v62, v219 offset:2356
  ds_read_b32 v63, v219 offset:2360
  ds_read_b32 v64, v219 offset:2364
  ds_read_b32 v65, v219 offset:2368
  ds_read_b32 v66, v219 offset:2372
  ds_read_b32 v67, v219 offset:2376
  ds_read_b32 v68, v219 offset:2380
  ds_read_b32 v69, v219 offset:2384
  ds_read_b32 v70, v219 offset:1320
  ds_read_b32 v71, v219 offset:1324
  ds_read_b32 v72, v219 offset:1328
  ds_read_b32 v73, v219 offset:1332
  ds_read_b32 v74, v219 offset:1336
  ds_read_b32 v75, v219 offset:1340
  ds_read_b32 v76, v219 offset:1344
  ds_read_b32 v77, v219 offset:1348
  ds_read_b32 v78, v219 offset:1352
  ds_read_b32 v79, v219 offset:288
  ds_read_b32 v80, v219 offset:292
  ds_read_b32 v81, v219 offset:296
  ds_read_b32 v82, v219 offset:300
  ds_read_b32 v83, v219 offset:304
  ds_read_b32 v84, v219 offset:308
  ds_read_b32 v85, v219 offset:312
  ds_read_b32 v86, v219 offset:316
  ds_read_b32 v87, v219 offset:320
  v_add_u32 v211, s66, v200
  v_mov_b32 v212, 0xf149f2ca
  v_mul_f32 v100, s57, v100
  v_mul_f32 v101, s57, v101
  v_mul_f32 v102, s57, v102
  v_mul_f32 v103, s57, v103
  v_mul_f32 v104, s57, v104
  v_mul_f32 v105, s57, v105
  v_mul_f32 v106, s57, v106
  v_mul_f32 v107, s57, v107
  v_cmp_gt_u32 vcc, 2, v211
  s_nop 1
  v_cndmask_b32 v101, v101, v212, vcc
  v_cmp_gt_u32 vcc, 4, v211
  s_nop 1
  v_cndmask_b32 v102, v102, v212, vcc
  v_cmp_gt_u32 vcc, 6, v211
  s_nop 1
  v_cndmask_b32 v103, v103, v212, vcc
  v_cmp_gt_u32 vcc, 8, v211
  s_nop 1
  v_cndmask_b32 v104, v104, v212, vcc
  v_cmp_gt_u32 vcc, 10, v211
  s_nop 1
  v_cndmask_b32 v105, v105, v212, vcc
  v_cmp_gt_u32 vcc, 12, v211
  s_nop 1
  v_cndmask_b32 v106, v106, v212, vcc
  v_cmp_gt_u32 vcc, 14, v211
  s_nop 1
  v_cndmask_b32 v107, v107, v212, vcc
  v_max3_f32 v213, v100, v101, v102
  v_max3_f32 v213, v213, v103, v104
  v_max3_f32 v213, v213, v105, v106
  v_max_f32 v213, v213, v107
  v_sub_f32 v100, v100, v213
  v_sub_f32 v101, v101, v213
  v_sub_f32 v102, v102, v213
  v_sub_f32 v103, v103, v213
  v_sub_f32 v104, v104, v213
  v_sub_f32 v105, v105, v213
  v_sub_f32 v106, v106, v213
  v_sub_f32 v107, v107, v213
  v_exp_f32 v100, v100
  v_exp_f32 v101, v101
  v_exp_f32 v102, v102
  v_exp_f32 v103, v103
  v_exp_f32 v104, v104
  v_exp_f32 v105, v105
  v_exp_f32 v106, v106
  v_exp_f32 v107, v107
  v_add_f32 v213, v100, v101
  v_add_f32 v213, v213, v102
  v_add_f32 v213, v213, v103
  v_add_f32 v213, v213, v104
  v_add_f32 v213, v213, v105
  v_add_f32 v213, v213, v106
  v_add_f32 v213, v213, v107
  v_rcp_f32 v213, v213
  v_mov_b32 v214, 0
  v_mul_f32 v100, v213, v100
  v_mul_f32 v101, v213, v101
  v_mul_f32 v102, v213, v102
  v_mul_f32 v103, v213, v103
  v_mul_f32 v104, v213, v104
  v_mul_f32 v105, v213, v105
  v_mul_f32 v106, v213, v106
  v_mul_f32 v107, v213, v107
  v_mov_b32 v112, 0
  v_mov_b32 v113, 0
  v_mov_b32 v114, 0
  v_mov_b32 v115, 0
  v_mov_b32 v116, 0
  v_mov_b32 v117, 0
  v_mov_b32 v118, 0
  v_mov_b32 v119, 0
  v_mov_b32 v120, 0
  v_mov_b32 v121, 0
  v_mov_b32 v122, 0
  v_mov_b32 v123, 0
  v_mov_b32 v124, 0
  v_mov_b32 v125, 0
  v_mov_b32 v126, 0
  v_mov_b32 v127, 0
  v_mov_b32 v128, 0
  v_mov_b32 v129, 0
  v_cvt_pk_bf16_f32 v0, v100, v214
  v_cvt_pk_bf16_f32 v1, v214, v100
  s_waitcnt lgkmcnt(15)
  v_dot2c_f32_bf16 v112, v16, v0
  v_dot2c_f32_bf16 v113, v16, v1
  v_dot2c_f32_bf16 v114, v17, v0
  v_dot2c_f32_bf16 v115, v17, v1
  v_dot2c_f32_bf16 v116, v18, v0
  v_dot2c_f32_bf16 v117, v18, v1
  v_dot2c_f32_bf16 v118, v19, v0
  v_dot2c_f32_bf16 v119, v19, v1
  v_dot2c_f32_bf16 v120, v20, v0
  v_dot2c_f32_bf16 v121, v20, v1
  v_dot2c_f32_bf16 v122, v21, v0
  v_dot2c_f32_bf16 v123, v21, v1
  v_dot2c_f32_bf16 v124, v22, v0
  v_dot2c_f32_bf16 v125, v22, v1
  v_dot2c_f32_bf16 v126, v23, v0
  v_dot2c_f32_bf16 v127, v23, v1
  v_dot2c_f32_bf16 v128, v24, v0
  v_dot2c_f32_bf16 v129, v24, v1
  v_cvt_pk_bf16_f32 v2, v101, v214
  v_cvt_pk_bf16_f32 v3, v214, v101
  v_dot2c_f32_bf16 v112, v25, v2
  v_dot2c_f32_bf16 v113, v25, v3
  v_dot2c_f32_bf16 v114, v26, v2
  v_dot2c_f32_bf16 v115, v26, v3
  v_dot2c_f32_bf16 v116, v27, v2
  v_dot2c_f32_bf16 v117, v27, v3
  v_dot2c_f32_bf16 v118, v28, v2
  v_dot2c_f32_bf16 v119, v28, v3
  v_dot2c_f32_bf16 v120, v29, v2
  v_dot2c_f32_bf16 v121, v29, v3
  v_dot2c_f32_bf16 v122, v30, v2
  v_dot2c_f32_bf16 v123, v30, v3
  v_dot2c_f32_bf16 v124, v31, v2
  v_dot2c_f32_bf16 v125, v31, v3
  v_dot2c_f32_bf16 v126, v32, v2
  v_dot2c_f32_bf16 v127, v32, v3
  v_dot2c_f32_bf16 v128, v33, v2
  v_dot2c_f32_bf16 v129, v33, v3
  v_cvt_pk_bf16_f32 v0, v102, v214
  v_cvt_pk_bf16_f32 v1, v214, v102
  v_dot2c_f32_bf16 v112, v34, v0
  v_dot2c_f32_bf16 v113, v34, v1
  v_dot2c_f32_bf16 v114, v35, v0
  v_dot2c_f32_bf16 v115, v35, v1
  v_dot2c_f32_bf16 v116, v36, v0
  v_dot2c_f32_bf16 v117, v36, v1
  v_dot2c_f32_bf16 v118, v37, v0
  v_dot2c_f32_bf16 v119, v37, v1
  v_dot2c_f32_bf16 v120, v38, v0
  v_dot2c_f32_bf16 v121, v38, v1
  v_dot2c_f32_bf16 v122, v39, v0
  v_dot2c_f32_bf16 v123, v39, v1
  v_dot2c_f32_bf16 v124, v40, v0
  v_dot2c_f32_bf16 v125, v40, v1
  v_dot2c_f32_bf16 v126, v41, v0
  v_dot2c_f32_bf16 v127, v41, v1
  v_dot2c_f32_bf16 v128, v42, v0
  v_dot2c_f32_bf16 v129, v42, v1
  v_cvt_pk_bf16_f32 v2, v103, v214
  v_cvt_pk_bf16_f32 v3, v214, v103
  v_dot2c_f32_bf16 v112, v43, v2
  v_dot2c_f32_bf16 v113, v43, v3
  v_dot2c_f32_bf16 v114, v44, v2
  v_dot2c_f32_bf16 v115, v44, v3
  v_dot2c_f32_bf16 v116, v45, v2
  v_dot2c_f32_bf16 v117, v45, v3
  v_dot2c_f32_bf16 v118, v46, v2
  v_dot2c_f32_bf16 v119, v46, v3
  v_dot2c_f32_bf16 v120, v47, v2
  v_dot2c_f32_bf16 v121, v47, v3
  v_dot2c_f32_bf16 v122, v48, v2
  v_dot2c_f32_bf16 v123, v48, v3
  v_dot2c_f32_bf16 v124, v49, v2
  v_dot2c_f32_bf16 v125, v49, v3
  v_dot2c_f32_bf16 v126, v50, v2
  v_dot2c_f32_bf16 v127, v50, v3
  v_dot2c_f32_bf16 v128, v51, v2
  v_dot2c_f32_bf16 v129, v51, v3
  v_cvt_pk_bf16_f32 v0, v104, v214
  v_cvt_pk_bf16_f32 v1, v214, v104
  v_dot2c_f32_bf16 v112, v52, v0
  v_dot2c_f32_bf16 v113, v52, v1
  v_dot2c_f32_bf16 v114, v53, v0
  v_dot2c_f32_bf16 v115, v53, v1
  v_dot2c_f32_bf16 v116, v54, v0
  v_dot2c_f32_bf16 v117, v54, v1
  v_dot2c_f32_bf16 v118, v55, v0
  v_dot2c_f32_bf16 v119, v55, v1
  v_dot2c_f32_bf16 v120, v56, v0
  v_dot2c_f32_bf16 v121, v56, v1
  v_dot2c_f32_bf16 v122, v57, v0
  v_dot2c_f32_bf16 v123, v57, v1
  v_dot2c_f32_bf16 v124, v58, v0
  v_dot2c_f32_bf16 v125, v58, v1
  v_dot2c_f32_bf16 v126, v59, v0
  v_dot2c_f32_bf16 v127, v59, v1
  v_dot2c_f32_bf16 v128, v60, v0
  v_dot2c_f32_bf16 v129, v60, v1
  v_cvt_pk_bf16_f32 v2, v105, v214
  v_cvt_pk_bf16_f32 v3, v214, v105
  v_dot2c_f32_bf16 v112, v61, v2
  v_dot2c_f32_bf16 v113, v61, v3
  v_dot2c_f32_bf16 v114, v62, v2
  v_dot2c_f32_bf16 v115, v62, v3
  v_dot2c_f32_bf16 v116, v63, v2
  v_dot2c_f32_bf16 v117, v63, v3
  v_dot2c_f32_bf16 v118, v64, v2
  v_dot2c_f32_bf16 v119, v64, v3
  v_dot2c_f32_bf16 v120, v65, v2
  v_dot2c_f32_bf16 v121, v65, v3
  v_dot2c_f32_bf16 v122, v66, v2
  v_dot2c_f32_bf16 v123, v66, v3
  v_dot2c_f32_bf16 v124, v67, v2
  v_dot2c_f32_bf16 v125, v67, v3
  v_dot2c_f32_bf16 v126, v68, v2
  v_dot2c_f32_bf16 v127, v68, v3
  v_dot2c_f32_bf16 v128, v69, v2
  v_dot2c_f32_bf16 v129, v69, v3
  v_cvt_pk_bf16_f32 v0, v106, v214
  v_cvt_pk_bf16_f32 v1, v214, v106
  v_dot2c_f32_bf16 v112, v70, v0
  v_dot2c_f32_bf16 v113, v70, v1
  v_dot2c_f32_bf16 v114, v71, v0
  v_dot2c_f32_bf16 v115, v71, v1
  v_dot2c_f32_bf16 v116, v72, v0
  v_dot2c_f32_bf16 v117, v72, v1
  s_waitcnt lgkmcnt(14)
  v_dot2c_f32_bf16 v118, v73, v0
  v_dot2c_f32_bf16 v119, v73, v1
  s_waitcnt lgkmcnt(13)
  v_dot2c_f32_bf16 v120, v74, v0
  v_dot2c_f32_bf16 v121, v74, v1
  s_waitcnt lgkmcnt(12)
  v_dot2c_f32_bf16 v122, v75, v0
  v_dot2c_f32_bf16 v123, v75, v1
  s_waitcnt lgkmcnt(11)
  v_dot2c_f32_bf16 v124, v76, v0
  v_dot2c_f32_bf16 v125, v76, v1
  s_waitcnt lgkmcnt(10)
  v_dot2c_f32_bf16 v126, v77, v0
  v_dot2c_f32_bf16 v127, v77, v1
  s_waitcnt lgkmcnt(9)
  v_dot2c_f32_bf16 v128, v78, v0
  v_dot2c_f32_bf16 v129, v78, v1
  v_cvt_pk_bf16_f32 v2, v107, v214
  v_cvt_pk_bf16_f32 v3, v214, v107
  s_waitcnt lgkmcnt(8)
  v_dot2c_f32_bf16 v112, v79, v2
  v_dot2c_f32_bf16 v113, v79, v3
  s_waitcnt lgkmcnt(7)
  v_dot2c_f32_bf16 v114, v80, v2
  v_dot2c_f32_bf16 v115, v80, v3
  s_waitcnt lgkmcnt(6)
  v_dot2c_f32_bf16 v116, v81, v2
  v_dot2c_f32_bf16 v117, v81, v3
  s_waitcnt lgkmcnt(5)
  v_dot2c_f32_bf16 v118, v82, v2
  v_dot2c_f32_bf16 v119, v82, v3
  s_waitcnt lgkmcnt(4)
  v_dot2c_f32_bf16 v120, v83, v2
  v_dot2c_f32_bf16 v121, v83, v3
  s_waitcnt lgkmcnt(3)
  v_dot2c_f32_bf16 v122, v84, v2
  v_dot2c_f32_bf16 v123, v84, v3
  s_waitcnt lgkmcnt(2)
  v_dot2c_f32_bf16 v124, v85, v2
  v_dot2c_f32_bf16 v125, v85, v3
  s_waitcnt lgkmcnt(1)
  v_dot2c_f32_bf16 v126, v86, v2
  v_dot2c_f32_bf16 v127, v86, v3
  s_waitcnt lgkmcnt(0)
  v_dot2c_f32_bf16 v128, v87, v2
  v_dot2c_f32_bf16 v129, v87, v3
  v_cvt_pk_bf16_f32 v132, v112, v113
  v_cvt_pk_bf16_f32 v133, v114, v115
  v_cvt_pk_bf16_f32 v134, v116, v117
  v_cvt_pk_bf16_f32 v135, v118, v119
  v_cvt_pk_bf16_f32 v136, v120, v121
  v_cvt_pk_bf16_f32 v137, v122, v123
  v_cvt_pk_bf16_f32 v138, v124, v125
  v_cvt_pk_bf16_f32 v139, v126, v127
  v_cvt_pk_bf16_f32 v140, v128, v129
  buffer_store_dwordx4 v[132:135], v220, s[8:11], s64 offen sc1
  buffer_store_dwordx4 v[136:139], v220, s[8:11], s64 offen offset:16 sc1
  buffer_store_dword v140, v220, s[8:11], s64 offen offset:32 sc1
  s_mov_b32 s56, 36
  s_waitcnt vmcnt(0)
  s_barrier
  s_cmp_eq_u32 s52, 0
  s_cbranch_scc0 A_sig
  v_mov_b32 v211, 1
  v_mov_b32 v212, 0
  s_mov_b64 exec, 1
  buffer_atomic_add v211, v212, s[12:15], s56 offen
  s_mov_b64 exec, -1
A_sig:
  s_cmp_lt_u32 s53, 204
  s_cbranch_scc0 L_exit
  s_sub_u32 s54, s53, 96
  s_mul_i32 s55, s54, 3641
  s_lshr_b32 s55, s55, 16
  s_mul_i32 s56, s55, 18
  s_sub_u32 s70, s54, s56
  s_and_b32 s69, s55, 1
  s_lshr_b32 s68, s55, 1
  v_lshrrev_b32 v211, 2, v200
  v_mul_u32_u24 v211, 1152, v211
  v_and_b32 v212, 3, v200
  v_lshl_add_u32 v207, v212, 4, v211
  s_lshl_b32 s54, s70, 6
  s_mul_i32 s55, s52, 1179648
  s_add_u32 s62, s54, s55
  s_mul_i32 s55, s52, 184320
  s_add_u32 s63, s54, s55
  s_mul_i32 s61, s52, 40960
  v_bfe_u32 v211, v200, 2, 2
  v_lshlrev_b32 v212, 4, v212
  v_add_u32 v212, s61, v212
  v_lshl_add_u32 v212, v211, 6, v212
  v_lshrrev_b32 v213, 4, v200
  v_lshl_add_u32 v210, v213, 9, v212
  v_lshrrev_b32 v214, 5, v200
  v_lshl_add_u32 v209, v214, 10, v212
  v_and_b32 v214, 1, v213
  v_lshl_add_u32 v209, v214, 8, v209
  s_add_u32 m0, s61, 0
  s_add_u32 s54, s62, 0
  buffer_load_dwordx4 v207, s[28:31], s54 offen lds
  s_add_u32 m0, s61, 1024
  s_add_u32 s54, s62, 18432
  buffer_load_dwordx4 v207, s[28:31], s54 offen lds
  s_add_u32 m0, s61, 2048
  s_add_u32 s54, s62, 36864
  buffer_load_dwordx4 v207, s[28:31], s54 offen lds
  s_add_u32 m0, s61, 3072
  s_add_u32 s54, s62, 55296
  buffer_load_dwordx4 v207, s[28:31], s54 offen lds
  s_add_u32 m0, s61, 4096
  s_add_u32 s54, s62, 73728
  buffer_load_dwordx4 v207, s[28:31], s54 offen lds
  s_add_u32 m0, s61, 5120
  s_add_u32 s54, s62, 92160
  buffer_load_dwordx4 v207, s[28:31], s54 offen lds
  s_add_u32 m0, s61, 6144
  s_add_u32 s54, s62, 110592
  buffer_load_dwordx4 v207, s[28:31], s54 offen lds
  s_add_u32 m0, s61, 7168
  s_add_u32 s54, s62, 129024
  buffer_load_dwordx4 v207, s[28:31], s54 offen lds
  s_add_u32 m0, s61, 8192
  s_add_u32 s54, s62, 147456
  buffer_load_dwordx4 v207, s[28:31], s54 offen lds
  s_add_u32 m0, s61, 9216
  s_add_u32 s54, s62, 165888
  buffer_load_dwordx4 v207, s[28:31], s54 offen lds
  s_add_u32 m0, s61, 10240
  s_add_u32 s54, s62, 184320
  buffer_load_dwordx4 v207, s[28:31], s54 offen lds
  s_add_u32 m0, s61, 11264
  s_add_u32 s54, s62, 202752
  buffer_load_dwordx4 v207, s[28:31], s54 offen lds
  s_add_u32 m0, s61, 12288
  s_add_u32 s54, s62, 221184
  buffer_load_dwordx4 v207, s[28:31], s54 offen lds
  s_add_u32 m0, s61, 13312
  s_add_u32 s54, s62, 239616
  buffer_load_dwordx4 v207, s[28:31], s54 offen lds
  s_add_u32 m0, s61, 14336
  s_add_u32 s54, s62, 258048
  buffer_load_dwordx4 v207, s[28:31], s54 offen lds
  s_add_u32 m0, s61, 15360
  s_add_u32 s54, s62, 276480
  buffer_load_dwordx4 v207, s[28:31], s54 offen lds
  s_add_u32 m0, s61, 16384
  s_add_u32 s54, s62, 294912
  buffer_load_dwordx4 v207, s[28:31], s54 offen lds
  s_add_u32 m0, s61, 17408
  s_add_u32 s54, s62, 313344
  buffer_load_dwordx4 v207, s[28:31], s54 offen lds
  s_add_u32 m0, s61, 18432
  s_add_u32 s54, s62, 331776
  buffer_load_dwordx4 v207, s[28:31], s54 offen lds
  s_add_u32 m0, s61, 19456
  s_add_u32 s54, s62, 350208
  buffer_load_dwordx4 v207, s[28:31], s54 offen lds
  s_add_u32 m0, s61, 20480
  s_add_u32 s54, s62, 368640
  buffer_load_dwordx4 v207, s[28:31], s54 offen lds
  s_add_u32 m0, s61, 21504
  s_add_u32 s54, s62, 387072
  buffer_load_dwordx4 v207, s[28:31], s54 offen lds
  s_add_u32 m0, s61, 22528
  s_add_u32 s54, s62, 405504
  buffer_load_dwordx4 v207, s[28:31], s54 offen lds
  s_add_u32 m0, s61, 23552
  s_add_u32 s54, s62, 423936
  buffer_load_dwordx4 v207, s[28:31], s54 offen lds
  s_add_u32 m0, s61, 24576
  s_add_u32 s54, s62, 442368
  buffer_load_dwordx4 v207, s[28:31], s54 offen lds
  s_add_u32 m0, s61, 25600
  s_add_u32 s54, s62, 460800
  buffer_load_dwordx4 v207, s[28:31], s54 offen lds
  s_add_u32 m0, s61, 26624
  s_add_u32 s54, s62, 479232
  buffer_load_dwordx4 v207, s[28:31], s54 offen lds
  s_add_u32 m0, s61, 27648
  s_add_u32 s54, s62, 497664
  buffer_load_dwordx4 v207, s[28:31], s54 offen lds
  s_add_u32 m0, s61, 28672
  s_add_u32 s54, s62, 516096
  buffer_load_dwordx4 v207, s[28:31], s54 offen lds
  s_add_u32 m0, s61, 29696
  s_add_u32 s54, s62, 534528
  buffer_load_dwordx4 v207, s[28:31], s54 offen lds
  s_add_u32 m0, s61, 30720
  s_add_u32 s54, s62, 552960
  buffer_load_dwordx4 v207, s[28:31], s54 offen lds
  s_add_u32 m0, s61, 31744
  s_add_u32 s54, s62, 571392
  buffer_load_dwordx4 v207, s[28:31], s54 offen lds
  s_add_u32 m0, s61, 32768
  s_add_u32 s54, s62, 589824
  buffer_load_dwordx4 v207, s[28:31], s54 offen lds
  s_add_u32 m0, s61, 33792
  s_add_u32 s54, s62, 608256
  buffer_load_dwordx4 v207, s[28:31], s54 offen lds
  s_add_u32 m0, s61, 34816
  s_add_u32 s54, s62, 626688
  buffer_load_dwordx4 v207, s[28:31], s54 offen lds
  s_add_u32 m0, s61, 35840
  s_add_u32 s54, s62, 645120
  buffer_load_dwordx4 v207, s[28:31], s54 offen lds
  s_add_u32 m0, s61, 36864
  s_add_u32 s54, s62, 663552
  buffer_load_dwordx4 v207, s[28:31], s54 offen lds
  s_add_u32 m0, s61, 37888
  s_add_u32 s54, s62, 681984
  buffer_load_dwordx4 v207, s[28:31], s54 offen lds
  s_waitcnt vmcnt(36) lgkmcnt(0)
  s_add_u32 m0, s61, 38912
  s_add_u32 s54, s62, 700416
  buffer_load_dwordx4 v207, s[28:31], s54 offen lds
  s_add_u32 m0, s61, 39936
  s_add_u32 s54, s62, 718848
  buffer_load_dwordx4 v207, s[28:31], s54 offen lds
  ds_read_b64_tr_b16 a[0:1], v209 offset:0
  ds_read_b64_tr_b16 a[2:3], v209 offset:512
  ds_read_b64_tr_b16 a[4:5], v209 offset:8
  ds_read_b64_tr_b16 a[6:7], v209 offset:520
  s_waitcnt vmcnt(36) lgkmcnt(0)
  s_add_u32 m0, s61, 0
  s_add_u32 s54, s62, 737280
  buffer_load_dwordx4 v207, s[28:31], s54 offen lds
  s_add_u32 m0, s61, 1024
  s_add_u32 s54, s62, 755712
  buffer_load_dwordx4 v207, s[28:31], s54 offen lds
  ds_read_b64_tr_b16 a[8:9], v209 offset:2048
  ds_read_b64_tr_b16 a[10:11], v209 offset:2560
  ds_read_b64_tr_b16 a[12:13], v209 offset:2056
  ds_read_b64_tr_b16 a[14:15], v209 offset:2568
  s_waitcnt vmcnt(36) lgkmcnt(0)
  s_add_u32 m0, s61, 2048
  s_add_u32 s54, s62, 774144
  buffer_load_dwordx4 v207, s[28:31], s54 offen lds
  s_add_u32 m0, s61, 3072
  s_add_u32 s54, s62, 792576
  buffer_load_dwordx4 v207, s[28:31], s54 offen lds
  ds_read_b64_tr_b16 a[16:17], v209 offset:4096
  ds_read_b64_tr_b16 a[18:19], v209 offset:4608
  ds_read_b64_tr_b16 a[20:21], v209 offset:4104
  ds_read_b64_tr_b16 a[22:23], v209 offset:4616
  s_waitcnt vmcnt(36) lgkmcnt(0)
  s_add_u32 m0, s61, 4096
  s_add_u32 s54, s62, 811008
  buffer_load_dwordx4 v207, s[28:31], s54 offen lds
  s_add_u32 m0, s61, 5120
  s_add_u32 s54, s62, 829440
  buffer_load_dwordx4 v207, s[28:31], s54 offen lds
  ds_read_b64_tr_b16 a[24:25], v209 offset:6144
  ds_read_b64_tr_b16 a[26:27], v209 offset:6656
  ds_read_b64_tr_b16 a[28:29], v209 offset:6152
  ds_read_b64_tr_b16 a[30:31], v209 offset:6664
  s_waitcnt vmcnt(36) lgkmcnt(0)
  s_add_u32 m0, s61, 6144
  s_add_u32 s54, s62, 847872
  buffer_load_dwordx4 v207, s[28:31], s54 offen lds
  s_add_u32 m0, s61, 7168
  s_add_u32 s54, s62, 866304
  buffer_load_dwordx4 v207, s[28:31], s54 offen lds
  ds_read_b64_tr_b16 a[32:33], v209 offset:8192
  ds_read_b64_tr_b16 a[34:35], v209 offset:8704
  ds_read_b64_tr_b16 a[36:37], v209 offset:8200
  ds_read_b64_tr_b16 a[38:39], v209 offset:8712
  s_waitcnt vmcnt(36) lgkmcnt(0)
  s_add_u32 m0, s61, 8192
  s_add_u32 s54, s62, 884736
  buffer_load_dwordx4 v207, s[28:31], s54 offen lds
  s_add_u32 m0, s61, 9216
  s_add_u32 s54, s62, 903168
  buffer_load_dwordx4 v207, s[28:31], s54 offen lds
  ds_read_b64_tr_b16 a[40:41], v209 offset:10240
  ds_read_b64_tr_b16 a[42:43], v209 offset:10752
  ds_read_b64_tr_b16 a[44:45], v209 offset:10248
  ds_read_b64_tr_b16 a[46:47], v209 offset:10760
  s_waitcnt vmcnt(36) lgkmcnt(0)
  s_add_u32 m0, s61, 10240
  s_add_u32 s54, s62, 921600
  buffer_load_dwordx4 v207, s[28:31], s54 offen lds
  s_add_u32 m0, s61, 11264
  s_add_u32 s54, s62, 940032
  buffer_load_dwordx4 v207, s[28:31], s54 offen lds
  ds_read_b64_tr_b16 a[48:49], v209 offset:12288
  ds_read_b64_tr_b16 a[50:51], v209 offset:12800
  ds_read_b64_tr_b16 a[52:53], v209 offset:12296
  ds_read_b64_tr_b16 a[54:55], v209 offset:12808
  s_waitcnt vmcnt(36) lgkmcnt(0)
  s_add_u32 m0, s61, 12288
  s_add_u32 s54, s62, 958464
  buffer_load_dwordx4 v207, s[28:31], s54 offen lds
  s_add_u32 m0, s61, 13312
  s_add_u32 s54, s62, 976896
  buffer_load_dwordx4 v207, s[28:31], s54 offen lds
  ds_read_b64_tr_b16 a[56:57], v209 offset:14336
  ds_read_b64_tr_b16 a[58:59], v209 offset:14848
  ds_read_b64_tr_b16 a[60:61], v209 offset:14344
  ds_read_b64_tr_b16 a[62:63], v209 offset:14856
  s_waitcnt vmcnt(36) lgkmcnt(0)
  s_add_u32 m0, s61, 14336
  s_add_u32 s54, s62, 995328
  buffer_load_dwordx4 v207, s[28:31], s54 offen lds
  s_add_u32 m0, s61, 15360
  s_add_u32 s54, s62, 1013760
  buffer_load_dwordx4 v207, s[28:31], s54 offen lds
  ds_read_b64_tr_b16 a[64:65], v209 offset:16384
  ds_read_b64_tr_b16 a[66:67], v209 offset:16896
  ds_read_b64_tr_b16 a[68:69], v209 offset:16392
  ds_read_b64_tr_b16 a[70:71], v209 offset:16904
  s_waitcnt vmcnt(36) lgkmcnt(0)
  s_add_u32 m0, s61, 16384
  s_add_u32 s54, s62, 1032192
  buffer_load_dwordx4 v207, s[28:31], s54 offen lds
  s_add_u32 m0, s61, 17408
  s_add_u32 s54, s62, 1050624
  buffer_load_dwordx4 v207, s[28:31], s54 offen lds
  ds_read_b64_tr_b16 a[72:73], v209 offset:18432
  ds_read_b64_tr_b16 a[74:75], v209 offset:18944
  ds_read_b64_tr_b16 a[76:77], v209 offset:18440
  ds_read_b64_tr_b16 a[78:79], v209 offset:18952
  s_waitcnt vmcnt(36) lgkmcnt(0)
  s_add_u32 m0, s61, 18432
  s_add_u32 s54, s62, 1069056
  buffer_load_dwordx4 v207, s[28:31], s54 offen lds
  s_add_u32 m0, s61, 19456
  s_add_u32 s54, s62, 1087488
  buffer_load_dwordx4 v207, s[28:31], s54 offen lds
  ds_read_b64_tr_b16 a[80:81], v209 offset:20480
  ds_read_b64_tr_b16 a[82:83], v209 offset:20992
  ds_read_b64_tr_b16 a[84:85], v209 offset:20488
  ds_read_b64_tr_b16 a[86:87], v209 offset:21000
  s_waitcnt vmcnt(36) lgkmcnt(0)
  s_add_u32 m0, s61, 20480
  s_add_u32 s54, s62, 1105920
  buffer_load_dwordx4 v207, s[28:31], s54 offen lds
  s_add_u32 m0, s61, 21504
  s_add_u32 s54, s62, 1124352
  buffer_load_dwordx4 v207, s[28:31], s54 offen lds
  ds_read_b64_tr_b16 a[88:89], v209 offset:22528
  ds_read_b64_tr_b16 a[90:91], v209 offset:23040
  ds_read_b64_tr_b16 a[92:93], v209 offset:22536
  ds_read_b64_tr_b16 a[94:95], v209 offset:23048
  s_waitcnt vmcnt(36) lgkmcnt(0)
  s_add_u32 m0, s61, 22528
  s_add_u32 s54, s62, 1142784
  buffer_load_dwordx4 v207, s[28:31], s54 offen lds
  s_add_u32 m0, s61, 23552
  s_add_u32 s54, s62, 1161216
  buffer_load_dwordx4 v207, s[28:31], s54 offen lds
  ds_read_b64_tr_b16 a[96:97], v209 offset:24576
  ds_read_b64_tr_b16 a[98:99], v209 offset:25088
  ds_read_b64_tr_b16 a[100:101], v209 offset:24584
  ds_read_b64_tr_b16 a[102:103], v209 offset:25096
  s_waitcnt vmcnt(36) lgkmcnt(0)
  s_add_u32 m0, s61, 24576
  s_add_u32 s54, s63, 0
  buffer_load_dwordx4 v207, s[40:43], s54 offen lds
  s_add_u32 m0, s61, 25600
  s_add_u32 s54, s63, 18432
  buffer_load_dwordx4 v207, s[40:43], s54 offen lds
  ds_read_b64_tr_b16 a[104:105], v209 offset:26624
  ds_read_b64_tr_b16 a[106:107], v209 offset:27136
  ds_read_b64_tr_b16 a[108:109], v209 offset:26632
  ds_read_b64_tr_b16 a[110:111], v209 offset:27144
  s_waitcnt vmcnt(36) lgkmcnt(0)
  s_add_u32 m0, s61, 26624
  s_add_u32 s54, s63, 36864
  buffer_load_dwordx4 v207, s[40:43], s54 offen lds
  s_add_u32 m0, s61, 27648
  s_add_u32 s54, s63, 55296
  buffer_load_dwordx4 v207, s[40:43], s54 offen lds
  ds_read_b64_tr_b16 a[112:113], v209 offset:28672
  ds_read_b64_tr_b16 a[114:115], v209 offset:29184
  ds_read_b64_tr_b16 a[116:117], v209 offset:28680
  ds_read_b64_tr_b16 a[118:119], v209 offset:29192
  s_waitcnt vmcnt(36) lgkmcnt(0)
  s_add_u32 m0, s61, 28672
  s_add_u32 s54, s63, 73728
  buffer_load_dwordx4 v207, s[40:43], s54 offen lds
  s_add_u32 m0, s61, 29696
  s_add_u32 s54, s63, 92160
  buffer_load_dwordx4 v207, s[40:43], s54 offen lds
  ds_read_b64_tr_b16 a[120:121], v209 offset:30720
  ds_read_b64_tr_b16 a[122:123], v209 offset:31232
  ds_read_b64_tr_b16 a[124:125], v209 offset:30728
  ds_read_b64_tr_b16 a[126:127], v209 offset:31240
  s_waitcnt vmcnt(36) lgkmcnt(0)
  s_add_u32 m0, s61, 30720
  s_add_u32 s54, s63, 110592
  buffer_load_dwordx4 v207, s[40:43], s54 offen lds
  s_add_u32 m0, s61, 31744
  s_add_u32 s54, s63, 129024
  buffer_load_dwordx4 v207, s[40:43], s54 offen lds
  ds_read_b64_tr_b16 a[128:129], v209 offset:32768
  ds_read_b64_tr_b16 a[130:131], v209 offset:33280
  ds_read_b64_tr_b16 a[132:133], v209 offset:32776
  ds_read_b64_tr_b16 a[134:135], v209 offset:33288
  s_waitcnt vmcnt(36) lgkmcnt(0)
  s_add_u32 m0, s61, 32768
  s_add_u32 s54, s63, 147456
  buffer_load_dwordx4 v207, s[40:43], s54 offen lds
  s_add_u32 m0, s61, 33792
  s_add_u32 s54, s63, 165888
  buffer_load_dwordx4 v207, s[40:43], s54 offen lds
  ds_read_b64_tr_b16 a[136:137], v209 offset:34816
  ds_read_b64_tr_b16 a[138:139], v209 offset:35328
  ds_read_b64_tr_b16 a[140:141], v209 offset:34824
  ds_read_b64_tr_b16 a[142:143], v209 offset:35336
  s_waitcnt vmcnt(36) lgkmcnt(0)
  ds_read_b64_tr_b16 a[144:145], v209 offset:36864
  ds_read_b64_tr_b16 a[146:147], v209 offset:37376
  ds_read_b64_tr_b16 a[148:149], v209 offset:36872
  ds_read_b64_tr_b16 a[150:151], v209 offset:37384
  s_waitcnt vmcnt(34) lgkmcnt(0)
  ds_read_b64_tr_b16 a[152:153], v209 offset:38912
  ds_read_b64_tr_b16 a[154:155], v209 offset:39424
  ds_read_b64_tr_b16 a[156:157], v209 offset:38920
  ds_read_b64_tr_b16 a[158:159], v209 offset:39432
  s_waitcnt vmcnt(32) lgkmcnt(0)
  ds_read_b64_tr_b16 a[160:161], v209 offset:0
  ds_read_b64_tr_b16 a[162:163], v209 offset:512
  ds_read_b64_tr_b16 a[164:165], v209 offset:8
  ds_read_b64_tr_b16 a[166:167], v209 offset:520
  s_waitcnt vmcnt(30) lgkmcnt(0)
  ds_read_b64_tr_b16 a[168:169], v209 offset:2048
  ds_read_b64_tr_b16 a[170:171], v209 offset:2560
  ds_read_b64_tr_b16 a[172:173], v209 offset:2056
  ds_read_b64_tr_b16 a[174:175], v209 offset:2568
  s_waitcnt vmcnt(28) lgkmcnt(0)
  ds_read_b64_tr_b16 a[176:177], v209 offset:4096
  ds_read_b64_tr_b16 a[178:179], v209 offset:4608
  ds_read_b64_tr_b16 a[180:181], v209 offset:4104
  ds_read_b64_tr_b16 a[182:183], v209 offset:4616
  s_waitcnt vmcnt(26) lgkmcnt(0)
  ds_read_b64_tr_b16 a[184:185], v209 offset:6144
  ds_read_b64_tr_b16 a[186:187], v209 offset:6656
  ds_read_b64_tr_b16 a[188:189], v209 offset:6152
  ds_read_b64_tr_b16 a[190:191], v209 offset:6664
  s_waitcnt vmcnt(24) lgkmcnt(0)
  ds_read_b64_tr_b16 a[192:193], v209 offset:8192
  ds_read_b64_tr_b16 a[194:195], v209 offset:8704
  ds_read_b64_tr_b16 a[196:197], v209 offset:8200
  ds_read_b64_tr_b16 a[198:199], v209 offset:8712
  s_waitcnt vmcnt(22) lgkmcnt(0)
  ds_read_b64_tr_b16 a[200:201], v209 offset:10240
  ds_read_b64_tr_b16 a[202:203], v209 offset:10752
  ds_read_b64_tr_b16 a[204:205], v209 offset:10248
  ds_read_b64_tr_b16 a[206:207], v209 offset:10760
  s_waitcnt vmcnt(20) lgkmcnt(0)
  ds_read_b64_tr_b16 a[208:209], v209 offset:12288
  ds_read_b64_tr_b16 a[210:211], v209 offset:12800
  ds_read_b64_tr_b16 a[212:213], v209 offset:12296
  ds_read_b64_tr_b16 a[214:215], v209 offset:12808
  s_waitcnt vmcnt(18) lgkmcnt(0)
  ds_read_b64_tr_b16 a[216:217], v209 offset:14336
  ds_read_b64_tr_b16 a[218:219], v209 offset:14848
  ds_read_b64_tr_b16 a[220:221], v209 offset:14344
  ds_read_b64_tr_b16 a[222:223], v209 offset:14856
  s_waitcnt vmcnt(16) lgkmcnt(0)
  ds_read_b64_tr_b16 a[224:225], v209 offset:16384
  ds_read_b64_tr_b16 a[226:227], v209 offset:16896
  ds_read_b64_tr_b16 a[228:229], v209 offset:16392
  ds_read_b64_tr_b16 a[230:231], v209 offset:16904
  s_waitcnt vmcnt(14) lgkmcnt(0)
  ds_read_b64_tr_b16 a[232:233], v209 offset:18432
  ds_read_b64_tr_b16 a[234:235], v209 offset:18944
  ds_read_b64_tr_b16 a[236:237], v209 offset:18440
  ds_read_b64_tr_b16 a[238:239], v209 offset:18952
  s_waitcnt vmcnt(12) lgkmcnt(0)
  ds_read_b64_tr_b16 a[240:241], v209 offset:20480
  ds_read_b64_tr_b16 a[242:243], v209 offset:20992
  ds_read_b64_tr_b16 a[244:245], v209 offset:20488
  ds_read_b64_tr_b16 a[246:247], v209 offset:21000
  s_waitcnt vmcnt(10) lgkmcnt(0)
  ds_read_b64_tr_b16 a[248:249], v209 offset:22528
  ds_read_b64_tr_b16 a[250:251], v209 offset:23040
  ds_read_b64_tr_b16 a[252:253], v209 offset:22536
  ds_read_b64_tr_b16 a[254:255], v209 offset:23048
  s_waitcnt vmcnt(8) lgkmcnt(0)
  ds_read_b64_tr_b16 v[216:217], v210 offset:24576
  ds_read_b64_tr_b16 v[218:219], v210 offset:24832
  ds_read_b64_tr_b16 v[220:221], v210 offset:24584
  ds_read_b64_tr_b16 v[222:223], v210 offset:24840
  s_waitcnt vmcnt(6) lgkmcnt(0)
  ds_read_b64_tr_b16 v[224:225], v210 offset:26624
  ds_read_b64_tr_b16 v[226:227], v210 offset:26880
  ds_read_b64_tr_b16 v[228:229], v210 offset:26632
  ds_read_b64_tr_b16 v[230:231], v210 offset:26888
  s_waitcnt vmcnt(4) lgkmcnt(0)
  ds_read_b64_tr_b16 v[232:233], v210 offset:28672
  ds_read_b64_tr_b16 v[234:235], v210 offset:28928
  ds_read_b64_tr_b16 v[236:237], v210 offset:28680
  ds_read_b64_tr_b16 v[238:239], v210 offset:28936
  s_waitcnt vmcnt(2) lgkmcnt(0)
  ds_read_b64_tr_b16 v[240:241], v210 offset:30720
  ds_read_b64_tr_b16 v[242:243], v210 offset:30976
  ds_read_b64_tr_b16 v[244:245], v210 offset:30728
  ds_read_b64_tr_b16 v[246:247], v210 offset:30984
  s_waitcnt vmcnt(0) lgkmcnt(0)
  ds_read_b64_tr_b16 v[248:249], v210 offset:32768
  ds_read_b64_tr_b16 v[250:251], v210 offset:33024
  ds_read_b64_tr_b16 v[252:253], v210 offset:32776
  ds_read_b64_tr_b16 v[254:255], v210 offset:33032
  v_and_b32 v211, 15, v200
  s_lshl_b32 s54, s69, 4
  v_add_u32 v211, s54, v211
  v_lshl_add_u32 v212, v214, 5, v211
  v_lshlrev_b32 v164, 4, v212
  v_lshrrev_b32 v212, 5, v200
  v_lshl_add_u32 v164, v212, 10, v164
  v_mul_u32_u24 v167, 1152, v211
  v_lshl_add_u32 v167, v213, 4, v167
  v_lshlrev_b32 v166, 2, v211
  v_lshlrev_b32 v208, 2, v200
  s_lshl_b32 s54, s52, 11
  v_add_u32 v168, s54, v201
  s_mov_b32 s59, s68
  s_lshl_b32 s66, s68, 7
  s_add_u32 s66, s66, 105914368
  s_mov_b32 s56, 128
  s_mov_b32 s57, 36
  s_waitcnt lgkmcnt(0)
  s_cmp_eq_u32 s52, 0
  s_cbranch_scc0 O_p1_d
  s_mov_b32 exec_hi, 0
  s_mov_b32 exec_lo, -1
O_p1:
  buffer_load_dword v211, v208, s[12:15], s56 offen sc1
  s_add_u32 s65, s65, 1
  s_waitcnt vmcnt(0)
  v_cmp_gt_u32 vcc, 0x700, v211
  s_cbranch_vccz O_p1_x
  s_sleep 16
  s_cmp_lt_u32 s65, 131072
  s_cbranch_scc1 O_p1
O_p1_x:
  s_mov_b64 exec, -1
O_p1_d:
  s_barrier
  s_cmp_eq_u32 s52, 0
  s_cbranch_scc0 O_a_d
  s_mov_b32 exec_hi, 0
  s_mov_b32 exec_lo, 1
O_a:
  buffer_load_dword v211, v208, s[12:15], s57 offen sc1
  s_add_u32 s65, s65, 1
  s_waitcnt vmcnt(0)
  v_cmp_gt_u32 vcc, 0x80, v211
  s_cbranch_vccz O_a_x
  s_sleep 16
  s_cmp_lt_u32 s65, 131072
  s_cbranch_scc1 O_a
O_a_x:
  s_mov_b64 exec, -1
O_a_d:
  s_barrier
O_loop:
  s_mul_i32 s64, s59, 36864
  s_mul_i32 s54, s52, 320
  s_add_u32 s55, s64, s54
  s_add_u32 s55, s55, 62914560
  s_cmp_eq_u32 s52, 3
  s_cselect_b32 s56, 268435456, s55
  buffer_load_dwordx4 v[128:131], v167, s[8:11], s55 offen offset:0 sc1
  buffer_load_dwordx4 v[132:135], v167, s[8:11], s55 offen offset:64 sc1
  buffer_load_dwordx4 v[136:139], v167, s[8:11], s55 offen offset:128 sc1
  buffer_load_dwordx4 v[140:143], v167, s[8:11], s56 offen offset:192 sc1
  buffer_load_dwordx4 v[144:147], v167, s[8:11], s56 offen offset:256 sc1
  s_lshl_b32 s55, s59, 7
  s_add_u32 s55, s55, 67108864
  buffer_load_dword v165, v166, s[8:11], s55 offen sc1
  s_waitcnt vmcnt(5)
  v_mfma_f32_16x16x32_bf16 v[156:159], v[216:219], v[128:131], 0
  v_mfma_f32_16x16x32_bf16 v[160:163], v[220:223], v[128:131], 0
  s_waitcnt vmcnt(4)
  v_mfma_f32_16x16x32_bf16 v[156:159], v[224:227], v[132:135], v[156:159]
  v_mfma_f32_16x16x32_bf16 v[160:163], v[228:231], v[132:135], v[160:163]
  s_waitcnt vmcnt(3)
  v_mfma_f32_16x16x32_bf16 v[156:159], v[232:235], v[136:139], v[156:159]
  v_mfma_f32_16x16x32_bf16 v[160:163], v[236:239], v[136:139], v[160:163]
  s_waitcnt vmcnt(2)
  v_mfma_f32_16x16x32_bf16 v[156:159], v[240:243], v[140:143], v[156:159]
  v_mfma_f32_16x16x32_bf16 v[160:163], v[244:247], v[140:143], v[160:163]
  s_waitcnt vmcnt(1)
  v_mfma_f32_16x16x32_bf16 v[156:159], v[248:251], v[144:147], v[156:159]
  v_mfma_f32_16x16x32_bf16 v[160:163], v[252:255], v[144:147], v[160:163]
  s_waitcnt vmcnt(0)
  s_nop 2
  v_mul_f32 v156, v165, v156
  v_mul_f32 v157, v165, v157
  v_mul_f32 v158, v165, v158
  v_mul_f32 v159, v165, v159
  v_mul_f32 v160, v165, v160
  v_mul_f32 v161, v165, v161
  v_mul_f32 v162, v165, v162
  v_mul_f32 v163, v165, v163
  v_sub_f32 v165, 1.0, v165
  v_cvt_pk_bf16_f32 v165, v165, v165
  v_lshlrev_b32 v165, 16, v165
  s_add_u32 s71, s59, 3
  s_lshl_b32 s55, s59, 18
  s_lshl_b32 s54, s52, 16
  s_add_u32 s55, s55, s54
  s_add_u32 s62, s55, 44040192
  s_cmp_eq_u32 s52, 0
  s_cbranch_scc0 O_b_d
  s_mov_b32 exec_hi, 0
  s_mov_b32 exec_lo, -1
O_b:
  buffer_load_dword v211, v208, s[8:11], s66 offen sc1
  s_add_u32 s65, s65, 1
  s_waitcnt vmcnt(0)
  v_cmp_gt_u32 vcc, s71, v211
  s_cbranch_vccz O_b_x
  s_sleep 1
  s_cmp_lt_u32 s65, 131072
  s_cbranch_scc1 O_b
O_b_x:
  s_mov_b64 exec, -1
O_b_d:
  s_barrier
  buffer_load_dwordx4 v[0:3], v164, s[8:11], s62 offen offset:0 sc1
  buffer_load_dwordx4 v[4:7], v164, s[8:11], s62 offen offset:2048 sc1
  s_add_u32 s62, s62, 4096
  buffer_load_dwordx4 v[8:11], v164, s[8:11], s62 offen offset:0 sc1
  buffer_load_dwordx4 v[12:15], v164, s[8:11], s62 offen offset:2048 sc1
  s_add_u32 s62, s62, 4096
  buffer_load_dwordx4 v[16:19], v164, s[8:11], s62 offen offset:0 sc1
  buffer_load_dwordx4 v[20:23], v164, s[8:11], s62 offen offset:2048 sc1
  s_add_u32 s62, s62, 4096
  buffer_load_dwordx4 v[24:27], v164, s[8:11], s62 offen offset:0 sc1
  buffer_load_dwordx4 v[28:31], v164, s[8:11], s62 offen offset:2048 sc1
  s_add_u32 s62, s62, 4096
  buffer_load_dwordx4 v[32:35], v164, s[8:11], s62 offen offset:0 sc1
  buffer_load_dwordx4 v[36:39], v164, s[8:11], s62 offen offset:2048 sc1
  s_add_u32 s62, s62, 4096
  buffer_load_dwordx4 v[40:43], v164, s[8:11], s62 offen offset:0 sc1
  buffer_load_dwordx4 v[44:47], v164, s[8:11], s62 offen offset:2048 sc1
  s_add_u32 s62, s62, 4096
  buffer_load_dwordx4 v[48:51], v164, s[8:11], s62 offen offset:0 sc1
  buffer_load_dwordx4 v[52:55], v164, s[8:11], s62 offen offset:2048 sc1
  s_add_u32 s62, s62, 4096
  buffer_load_dwordx4 v[56:59], v164, s[8:11], s62 offen offset:0 sc1
  buffer_load_dwordx4 v[60:63], v164, s[8:11], s62 offen offset:2048 sc1
  s_add_u32 s62, s62, 4096
  buffer_load_dwordx4 v[64:67], v164, s[8:11], s62 offen offset:0 sc1
  buffer_load_dwordx4 v[68:71], v164, s[8:11], s62 offen offset:2048 sc1
  s_add_u32 s62, s62, 4096
  buffer_load_dwordx4 v[72:75], v164, s[8:11], s62 offen offset:0 sc1
  buffer_load_dwordx4 v[76:79], v164, s[8:11], s62 offen offset:2048 sc1
  s_add_u32 s62, s62, 4096
  buffer_load_dwordx4 v[80:83], v164, s[8:11], s62 offen offset:0 sc1
  buffer_load_dwordx4 v[84:87], v164, s[8:11], s62 offen offset:2048 sc1
  s_add_u32 s62, s62, 4096
  buffer_load_dwordx4 v[88:91], v164, s[8:11], s62 offen offset:0 sc1
  buffer_load_dwordx4 v[92:95], v164, s[8:11], s62 offen offset:2048 sc1
  s_add_u32 s62, s62, 4096
  buffer_load_dwordx4 v[96:99], v164, s[8:11], s62 offen offset:0 sc1
  buffer_load_dwordx4 v[100:103], v164, s[8:11], s62 offen offset:2048 sc1
  s_add_u32 s62, s62, 4096
  buffer_load_dwordx4 v[104:107], v164, s[8:11], s62 offen offset:0 sc1
  buffer_load_dwordx4 v[108:111], v164, s[8:11], s62 offen offset:2048 sc1
  s_add_u32 s62, s62, 4096
  buffer_load_dwordx4 v[112:115], v164, s[8:11], s62 offen offset:0 sc1
  buffer_load_dwordx4 v[116:119], v164, s[8:11], s62 offen offset:2048 sc1
  s_add_u32 s62, s62, 4096
  buffer_load_dwordx4 v[120:123], v164, s[8:11], s62 offen offset:0 sc1
  buffer_load_dwordx4 v[124:127], v164, s[8:11], s62 offen offset:2048 sc1
  s_add_u32 s62, s62, 4096
  s_waitcnt vmcnt(31)
  v_mfma_f32_16x16x32_bf16 v[148:151], a[0:3], v[0:3], 0
  v_mfma_f32_16x16x32_bf16 v[152:155], a[4:7], v[0:3], 0
  s_waitcnt vmcnt(30)
  v_mfma_f32_16x16x32_bf16 v[148:151], a[8:11], v[4:7], v[148:151]
  v_mfma_f32_16x16x32_bf16 v[152:155], a[12:15], v[4:7], v[152:155]
  s_waitcnt vmcnt(29)
  v_mfma_f32_16x16x32_bf16 v[148:151], a[16:19], v[8:11], v[148:151]
  v_mfma_f32_16x16x32_bf16 v[152:155], a[20:23], v[8:11], v[152:155]
  s_waitcnt vmcnt(28)
  v_mfma_f32_16x16x32_bf16 v[148:151], a[24:27], v[12:15], v[148:151]
  v_mfma_f32_16x16x32_bf16 v[152:155], a[28:31], v[12:15], v[152:155]
  s_waitcnt vmcnt(27)
  v_mfma_f32_16x16x32_bf16 v[148:151], a[32:35], v[16:19], v[148:151]
  v_mfma_f32_16x16x32_bf16 v[152:155], a[36:39], v[16:19], v[152:155]
  s_waitcnt vmcnt(26)
  v_mfma_f32_16x16x32_bf16 v[148:151], a[40:43], v[20:23], v[148:151]
  v_mfma_f32_16x16x32_bf16 v[152:155], a[44:47], v[20:23], v[152:155]
  s_waitcnt vmcnt(25)
  v_mfma_f32_16x16x32_bf16 v[148:151], a[48:51], v[24:27], v[148:151]
  v_mfma_f32_16x16x32_bf16 v[152:155], a[52:55], v[24:27], v[152:155]
  s_waitcnt vmcnt(24)
  v_mfma_f32_16x16x32_bf16 v[148:151], a[56:59], v[28:31], v[148:151]
  v_mfma_f32_16x16x32_bf16 v[152:155], a[60:63], v[28:31], v[152:155]
  s_waitcnt vmcnt(23)
  v_mfma_f32_16x16x32_bf16 v[148:151], a[64:67], v[32:35], v[148:151]
  v_mfma_f32_16x16x32_bf16 v[152:155], a[68:71], v[32:35], v[152:155]
  s_waitcnt vmcnt(22)
  v_mfma_f32_16x16x32_bf16 v[148:151], a[72:75], v[36:39], v[148:151]
  v_mfma_f32_16x16x32_bf16 v[152:155], a[76:79], v[36:39], v[152:155]
  s_waitcnt vmcnt(21)
  v_mfma_f32_16x16x32_bf16 v[148:151], a[80:83], v[40:43], v[148:151]
  v_mfma_f32_16x16x32_bf16 v[152:155], a[84:87], v[40:43], v[152:155]
  s_waitcnt vmcnt(20)
  v_mfma_f32_16x16x32_bf16 v[148:151], a[88:91], v[44:47], v[148:151]
  v_mfma_f32_16x16x32_bf16 v[152:155], a[92:95], v[44:47], v[152:155]
  s_waitcnt vmcnt(19)
  v_mfma_f32_16x16x32_bf16 v[148:151], a[96:99], v[48:51], v[148:151]
  v_mfma_f32_16x16x32_bf16 v[152:155], a[100:103], v[48:51], v[152:155]
  s_waitcnt vmcnt(18)
  v_mfma_f32_16x16x32_bf16 v[148:151], a[104:107], v[52:55], v[148:151]
  v_mfma_f32_16x16x32_bf16 v[152:155], a[108:111], v[52:55], v[152:155]
  s_waitcnt vmcnt(17)
  v_mfma_f32_16x16x32_bf16 v[148:151], a[112:115], v[56:59], v[148:151]
  v_mfma_f32_16x16x32_bf16 v[152:155], a[116:119], v[56:59], v[152:155]
  s_waitcnt vmcnt(16)
  v_mfma_f32_16x16x32_bf16 v[148:151], a[120:123], v[60:63], v[148:151]
  v_mfma_f32_16x16x32_bf16 v[152:155], a[124:127], v[60:63], v[152:155]
  s_waitcnt vmcnt(15)
  v_mfma_f32_16x16x32_bf16 v[148:151], a[128:131], v[64:67], v[148:151]
  v_mfma_f32_16x16x32_bf16 v[152:155], a[132:135], v[64:67], v[152:155]
  s_waitcnt vmcnt(14)
  v_mfma_f32_16x16x32_bf16 v[148:151], a[136:139], v[68:71], v[148:151]
  v_mfma_f32_16x16x32_bf16 v[152:155], a[140:143], v[68:71], v[152:155]
  s_waitcnt vmcnt(13)
  v_mfma_f32_16x16x32_bf16 v[148:151], a[144:147], v[72:75], v[148:151]
  v_mfma_f32_16x16x32_bf16 v[152:155], a[148:151], v[72:75], v[152:155]
  s_waitcnt vmcnt(12)
  v_mfma_f32_16x16x32_bf16 v[148:151], a[152:155], v[76:79], v[148:151]
  v_mfma_f32_16x16x32_bf16 v[152:155], a[156:159], v[76:79], v[152:155]
  s_waitcnt vmcnt(11)
  v_mfma_f32_16x16x32_bf16 v[148:151], a[160:163], v[80:83], v[148:151]
  v_mfma_f32_16x16x32_bf16 v[152:155], a[164:167], v[80:83], v[152:155]
  s_waitcnt vmcnt(10)
  v_mfma_f32_16x16x32_bf16 v[148:151], a[168:171], v[84:87], v[148:151]
  v_mfma_f32_16x16x32_bf16 v[152:155], a[172:175], v[84:87], v[152:155]
  s_waitcnt vmcnt(9)
  v_mfma_f32_16x16x32_bf16 v[148:151], a[176:179], v[88:91], v[148:151]
  v_mfma_f32_16x16x32_bf16 v[152:155], a[180:183], v[88:91], v[152:155]
  s_waitcnt vmcnt(8)
  v_mfma_f32_16x16x32_bf16 v[148:151], a[184:187], v[92:95], v[148:151]
  v_mfma_f32_16x16x32_bf16 v[152:155], a[188:191], v[92:95], v[152:155]
  s_waitcnt vmcnt(7)
  v_mfma_f32_16x16x32_bf16 v[148:151], a[192:195], v[96:99], v[148:151]
  v_mfma_f32_16x16x32_bf16 v[152:155], a[196:199], v[96:99], v[152:155]
  s_waitcnt vmcnt(6)
  v_mfma_f32_16x16x32_bf16 v[148:151], a[200:203], v[100:103], v[148:151]
  v_mfma_f32_16x16x32_bf16 v[152:155], a[204:207], v[100:103], v[152:155]
  s_waitcnt vmcnt(5)
  v_mfma_f32_16x16x32_bf16 v[148:151], a[208:211], v[104:107], v[148:151]
  v_mfma_f32_16x16x32_bf16 v[152:155], a[212:215], v[104:107], v[152:155]
  s_waitcnt vmcnt(4)
  v_mfma_f32_16x16x32_bf16 v[148:151], a[216:219], v[108:111], v[148:151]
  v_mfma_f32_16x16x32_bf16 v[152:155], a[220:223], v[108:111], v[152:155]
  s_waitcnt vmcnt(3)
  v_mfma_f32_16x16x32_bf16 v[148:151], a[224:227], v[112:115], v[148:151]
  v_mfma_f32_16x16x32_bf16 v[152:155], a[228:231], v[112:115], v[152:155]
  s_waitcnt vmcnt(2)
  v_mfma_f32_16x16x32_bf16 v[148:151], a[232:235], v[116:119], v[148:151]
  v_mfma_f32_16x16x32_bf16 v[152:155], a[236:239], v[116:119], v[152:155]
  s_waitcnt vmcnt(1)
  v_mfma_f32_16x16x32_bf16 v[148:151], a[240:243], v[120:123], v[148:151]
  v_mfma_f32_16x16x32_bf16 v[152:155], a[244:247], v[120:123], v[152:155]
  s_waitcnt vmcnt(0)
  v_mfma_f32_16x16x32_bf16 v[148:151], a[248:251], v[124:127], v[148:151]
  v_mfma_f32_16x16x32_bf16 v[152:155], a[252:255], v[124:127], v[152:155]
  s_nop 3
  v_fmac_f32 v156, v165, v148
  v_fmac_f32 v157, v165, v149
  v_fmac_f32 v158, v165, v150
  v_fmac_f32 v159, v165, v151
  v_fmac_f32 v160, v165, v152
  v_fmac_f32 v161, v165, v153
  v_fmac_f32 v162, v165, v154
  v_fmac_f32 v163, v165, v155
  ds_write_b128 v168, v[156:159]
  ds_write_b128 v168, v[160:163] offset:1024
  s_lshl_b32 s54, s70, 6
  s_add_u32 s64, s64, s54
  s_mov_b32 s59, s71
  s_waitcnt lgkmcnt(0)
  s_barrier
  s_cmp_eq_u32 s52, 0
  s_cbranch_scc0 O_next
  ds_read_b128 v[0:3], v201 offset:2048
  ds_read_b128 v[4:7], v201 offset:3072
  ds_read_b128 v[8:11], v201 offset:4096
  ds_read_b128 v[12:15], v201 offset:5120
  ds_read_b128 v[16:19], v201 offset:6144
  ds_read_b128 v[20:23], v201 offset:7168
  s_waitcnt lgkmcnt(5)
  v_add_f32 v156, v156, v0
  v_add_f32 v157, v157, v1
  v_add_f32 v158, v158, v2
  v_add_f32 v159, v159, v3
  s_waitcnt lgkmcnt(4)
  v_add_f32 v160, v160, v4
  v_add_f32 v161, v161, v5
  v_add_f32 v162, v162, v6
  v_add_f32 v163, v163, v7
  s_waitcnt lgkmcnt(3)
  v_add_f32 v156, v156, v8
  v_add_f32 v157, v157, v9
  v_add_f32 v158, v158, v10
  v_add_f32 v159, v159, v11
  s_waitcnt lgkmcnt(2)
  v_add_f32 v160, v160, v12
  v_add_f32 v161, v161, v13
  v_add_f32 v162, v162, v14
  v_add_f32 v163, v163, v15
  s_waitcnt lgkmcnt(1)
  v_add_f32 v156, v156, v16
  v_add_f32 v157, v157, v17
  v_add_f32 v158, v158, v18
  v_add_f32 v159, v159, v19
  s_waitcnt lgkmcnt(0)
  v_add_f32 v160, v160, v20
  v_add_f32 v161, v161, v21
  v_add_f32 v162, v162, v22
  v_add_f32 v163, v163, v23
  v_cvt_pk_bf16_f32 v148, v156, v157
  v_cvt_pk_bf16_f32 v149, v158, v159
  v_cvt_pk_bf16_f32 v150, v160, v161
  v_cvt_pk_bf16_f32 v151, v162, v163
  buffer_store_dwordx4 v[148:151], v167, s[48:51], s64 offen
  s_nop 1
O_next:
  s_cmp_lt_u32 s59, 64
  s_cbranch_scc1 O_loop
  s_branch L_exit
L_chain:
  s_waitcnt vmcnt(0)
  v_and_b32 v0, 63, v0
  v_and_b32 v1, 15, v0
  v_lshrrev_b32 v2, 4, v0
  v_lshlrev_b32 v76, 4, v0
  v_add_u32 v75, 0x10000, v76
  v_lshrrev_b32 v3, 2, v1
  v_and_b32 v4, 1, v1
  v_lshl_add_u32 v3, v3, 1, v4
  v_bfe_u32 v4, v1, 1, 1
  v_mul_u32_u24 v74, 0xaaaa, v4
  v_add_u32 v74, 0x4444, v74
  v_mul_u32_u24 v5, 576, v3
  v_add_u32 v5, 0, v5
  v_lshl_add_u32 v78, v2, 4, v5
  v_lshl_add_u32 v77, v2, 5, v5
  v_lshl_add_u32 v77, v4, 4, v77
  v_mul_u32_u24 v15, 1152, v3
  v_lshl_add_u32 v15, v2, 5, v15
  v_lshl_add_u32 v15, v4, 4, v15
  s_lshl_b32 s54, s52, 8
  buffer_load_dwordx4 v[20:23], v15, s[32:35], s54 offen
  buffer_load_dwordx4 v[24:27], v15, s[32:35], s54 offen offset:128
  buffer_load_dwordx4 v[28:31], v15, s[32:35], 0 offen offset:1024
  v_mul_u32_u24 v79, 1152, v2
  v_lshl_add_u32 v79, v1, 2, v79
  s_lshl_b32 s54, s52, 6
  s_add_u32 s54, s54, 0
  v_add_u32 v79, s54, v79
  v_lshrrev_b32 v5, 3, v0
  v_mul_u32_u24 v68, 2176, v5
  v_and_b32 v5, 7, v0
  v_lshl_add_u32 v68, v5, 3, v68
  v_and_b32 v5, 1, v2
  v_lshlrev_b32 v5, 4, v5
  v_lshl_add_u32 v5, v1, 2, v5
  v_mov_b32 v6, 0x40000000
  v_cmp_lt_u32 vcc, 3, v1
  s_nop 1
  v_cndmask_b32 v5, v5, v6, vcc
  v_lshrrev_b32 v6, 1, v2
  v_lshl_add_u32 v69, v6, 10, v5
  v_lshl_add_u32 v70, v6, 8, v5
  v_mov_b32 v71, -1
  ds_write_b128 v76, v[68:71] offset:13824
  v_and_b32 v5, 3, v1
  v_lshrrev_b32 v6, 2, v1
  v_lshl_add_u32 v5, v5, 2, v6
  v_and_b32 v6, 1, v5
  v_lshlrev_b32 v6, 4, v6
  v_mov_b32 v7, 0x3f80
  v_lshlrev_b32 v6, v6, v7
  v_lshrrev_b32 v5, 1, v5
  v_cmp_eq_u32 vcc, 0, v5
  s_nop 1
  v_cndmask_b32 v32, 0, v6, vcc
  v_cmp_eq_u32 vcc, 1, v5
  s_nop 1
  v_cndmask_b32 v33, 0, v6, vcc
  v_cmp_eq_u32 vcc, 2, v5
  s_nop 1
  v_cndmask_b32 v34, 0, v6, vcc
  v_cmp_eq_u32 vcc, 3, v5
  s_nop 1
  v_cndmask_b32 v35, 0, v6, vcc
  ds_write_b128 v76, v[32:35] offset:14848
  v_and_b32 v3, 1, v2
  s_lshl_b32 s54, s52, 1
  v_add_u32 v3, s54, v3
  v_lshlrev_b32 v3, 1, v3
  v_xor_b32 v3, v3, v1
  v_lshlrev_b32 v3, 4, v3
  v_lshl_add_u32 v8, v2, 13, v3
  s_and_b32 s54, s52, 1
  s_lshr_b32 s55, s52, 1
  v_lshrrev_b32 v3, 3, v0
  v_and_b32 v4, 1, v3
  v_lshlrev_b32 v4, 4, v4
  v_and_b32 v5, 6, v3
  v_add_u32 v4, v4, v5
  s_lshl_b32 s56, s55, 3
  s_add_u32 s56, s56, s54
  v_add_u32 v4, s56, v4
  v_mul_u32_u24 v4, 1152, v4
  v_and_b32 v5, 2, v3
  v_lshlrev_b32 v5, 1, v5
  v_and_b32 v6, 7, v0
  v_xor_b32 v6, v6, v5
  v_lshl_add_u32 v9, v6, 4, v4
  v_and_b32 v4, 1, v2
  v_lshlrev_b32 v4, 4, v4
  v_and_b32 v5, 2, v2
  v_add_u32 v4, v4, v5
  s_lshl_b32 s56, s55, 2
  s_add_u32 s56, s56, s54
  v_add_u32 v4, s56, v4
  v_mul_u32_u24 v4, 1152, v4
  v_lshlrev_b32 v6, 1, v2
  v_xor_b32 v6, v6, v1
  v_lshl_add_u32 v10, v6, 4, v4
  v_bfe_u32 v17, v1, 2, 1
  v_bfe_u32 v18, v1, 3, 1
  v_and_b32 v19, 1, v2
  v_lshrrev_b32 v72, 1, v2
  v_and_b32 v73, 3, v1
  v_lshl_add_u32 v3, v19, 1, v17
  v_lshl_add_u32 v6, v18, 2, v3
  v_lshl_add_u32 v4, v72, 4, v17
  v_lshl_add_u32 v4, v19, 2, v4
  v_lshl_add_u32 v4, v18, 3, v4
  v_lshlrev_b32 v4, 8, v4
  s_lshl_b32 s54, s52, 6
  v_lshl_add_u32 v5, v73, 3, s54
  v_lshlrev_b32 v7, 5, v6
  v_xor_b32 v5, v5, v7
  v_add_u32 v11, v4, v5
  v_xor_b32 v12, 32, v11
  v_lshl_add_u32 v4, v72, 2, v3
  v_lshlrev_b32 v4, 7, v4
  v_lshl_add_u32 v4, v73, 3, v4
  s_and_b32 s54, s52, 1
  v_xor_b32 v7, s54, v19
  v_lshl_add_u32 v7, v7, 1, v18
  v_lshl_add_u32 v13, v7, 5, v4
  v_lshlrev_b32 v4, 11, v72
  v_lshl_add_u32 v4, v73, 3, v4
  v_lshl_add_u32 v5, v3, 8, v4
  v_lshl_add_u32 v7, v18, 2, s52
  v_xor_b32 v7, v7, v3
  v_lshl_add_u32 v14, v7, 5, v5
  s_lshl_b32 s54, s53, 14
  s_lshl_b32 s55, s52, 11
  s_add_u32 s58, s54, s55
  s_add_u32 s59, s58, 8192
  s_lshl_b32 s55, s52, 12
  s_add_u32 s70, s54, s55
  s_add_u32 s70, s70, 524288
  s_lshl_b32 s54, s53, 12
  s_lshl_b32 s55, s52, 10
  s_add_u32 s54, s54, s55
  s_add_u32 s68, s54, 34471936
  s_lshl_b32 s54, s53, 7
  s_add_u32 s71, s54, 105906176
  s_lshl_b32 s54, s53, 6
  s_mul_i32 s55, s52, 17408
  s_add_u32 s55, s54, s55
  s_add_u32 s73, s55, 100663296
  s_add_u32 s74, s55, 100732928
  s_add_u32 s75, s55, 100802560
  s_add_u32 s76, s55, 100872192
  s_and_b32 s56, s52, 1
  s_mul_i32 s55, s56, 17408
  s_add_u32 s55, s54, s55
  s_add_u32 s77, s55, 100941824
  s_mul_i32 s54, s52, 69632
  s_mul_i32 s55, s53, 2176
  s_add_u32 s54, s54, s55
  s_add_u32 s60, s54, 100663296
  s_and_b32 s56, s53, 15
  s_mul_i32 s55, s56, 2176
  s_add_u32 s61, s55, 100941824
  s_lshl_b32 s54, s52, 11
  s_add_u32 s64, s54, 102760448
  s_mov_b32 s65, 102768640
  s_lshl_b32 s55, s53, 5
  s_add_u32 s54, s54, s55
  s_add_u32 s62, s54, 102776832
  s_lshr_b32 s54, s56, 3
  s_lshl_b32 s54, s54, 9
  s_and_b32 s55, s56, 7
  s_lshl_b32 s55, s55, 5
  s_add_u32 s54, s54, s55
  s_add_u32 s63, s54, 102785024
  s_mov_b32 s66, 0
  s_mov_b32 s67, 0
  s_mov_b32 s72, 0
  s_mov_b32 s69, 1040356334
  s_lshl_b32 s78, s53, 8
  s_lshl_b32 s54, s52, 15
  s_add_u32 s78, s78, s54
  s_mul_i32 s79, s53, 147456
  s_lshl_b32 s57, s52, 10
  s_add_u32 s57, s57, 16384
  s_add_u32 m0, s57, 0
  s_add_u32 s54, s78, 524288
  buffer_load_dwordx4 v8, s[16:19], s54 offen lds
  s_add_u32 m0, s57, 4096
  s_add_u32 s54, s78, 655360
  buffer_load_dwordx4 v8, s[16:19], s54 offen lds
  s_add_u32 m0, s57, 8192
  s_add_u32 s54, s78, 786432
  buffer_load_dwordx4 v8, s[16:19], s54 offen lds
  s_add_u32 m0, s57, 12288
  s_add_u32 s54, s78, 917504
  buffer_load_dwordx4 v8, s[16:19], s54 offen lds
  s_add_u32 m0, s57, 16384
  s_add_u32 s54, s78, 1048576
  buffer_load_dwordx4 v8, s[16:19], s54 offen lds
  s_add_u32 m0, s57, 20480
  s_add_u32 s54, s78, 1179648
  buffer_load_dwordx4 v8, s[16:19], s54 offen lds
  s_add_u32 m0, s57, 24576
  s_add_u32 s54, s78, 1310720
  buffer_load_dwordx4 v8, s[16:19], s54 offen lds
  s_add_u32 m0, s57, 28672
  s_add_u32 s54, s78, 1441792
  buffer_load_dwordx4 v8, s[16:19], s54 offen lds
  s_add_u32 m0, s57, 32768
  s_add_u32 s54, s78, 1572864
  buffer_load_dwordx4 v8, s[16:19], s54 offen lds
  s_add_u32 m0, s57, 36864
  s_add_u32 s54, s78, 1703936
  buffer_load_dwordx4 v8, s[16:19], s54 offen lds
  s_add_u32 m0, s57, 40960
  s_add_u32 s54, s78, 1835008
  buffer_load_dwordx4 v8, s[16:19], s54 offen lds
  s_add_u32 m0, s57, 45056
  s_add_u32 s54, s78, 1966080
  buffer_load_dwordx4 v8, s[16:19], s54 offen lds
  s_add_u32 m0, s57, 49152
  s_add_u32 s54, s78, 2097152
  buffer_load_dwordx4 v8, s[16:19], s54 offen lds
  s_add_u32 m0, s57, 53248
  s_add_u32 s54, s78, 2228224
  buffer_load_dwordx4 v8, s[16:19], s54 offen lds
  s_add_u32 m0, s57, 57344
  s_add_u32 s54, s78, 2359296
  buffer_load_dwordx4 v8, s[16:19], s54 offen lds
  s_add_u32 m0, s57, 61440
  s_add_u32 s54, s78, 2490368
  buffer_load_dwordx4 v8, s[16:19], s54 offen lds
  s_add_u32 m0, s57, 65536
  s_add_u32 s54, s78, 2621440
  buffer_load_dwordx4 v8, s[16:19], s54 offen lds
  s_add_u32 m0, s57, 69632
  s_add_u32 s54, s78, 2752512
  buffer_load_dwordx4 v8, s[16:19], s54 offen lds
  s_add_u32 m0, s57, 73728
  s_add_u32 s54, s78, 2883584
  buffer_load_dwordx4 v8, s[16:19], s54 offen lds
  s_add_u32 m0, s57, 77824
  s_add_u32 s54, s78, 3014656
  buffer_load_dwordx4 v8, s[16:19], s54 offen lds
  s_add_u32 m0, s57, 81920
  s_add_u32 s54, s78, 3145728
  buffer_load_dwordx4 v8, s[16:19], s54 offen lds
  s_add_u32 m0, s57, 86016
  s_add_u32 s54, s78, 3276800
  buffer_load_dwordx4 v8, s[16:19], s54 offen lds
  s_add_u32 m0, s57, 90112
  s_add_u32 s54, s78, 3407872
  buffer_load_dwordx4 v8, s[16:19], s54 offen lds
  s_add_u32 m0, s57, 94208
  s_add_u32 s54, s78, 3538944
  buffer_load_dwordx4 v8, s[16:19], s54 offen lds
  s_add_u32 m0, s57, 98304
  s_add_u32 s54, s78, 3670016
  buffer_load_dwordx4 v8, s[16:19], s54 offen lds
  s_add_u32 m0, s57, 102400
  s_add_u32 s54, s78, 3801088
  buffer_load_dwordx4 v8, s[16:19], s54 offen lds
  s_add_u32 m0, s57, 106496
  s_add_u32 s54, s78, 3932160
  buffer_load_dwordx4 v8, s[16:19], s54 offen lds
  s_add_u32 m0, s57, 110592
  s_add_u32 s54, s78, 4063232
  buffer_load_dwordx4 v8, s[16:19], s54 offen lds
  s_add_u32 m0, s57, 114688
  s_add_u32 s54, s78, 4194304
  buffer_load_dwordx4 v8, s[16:19], s54 offen lds
  s_add_u32 m0, s57, 118784
  s_add_u32 s54, s78, 4325376
  buffer_load_dwordx4 v8, s[16:19], s54 offen lds
  s_add_u32 m0, s57, 122880
  s_add_u32 s54, s78, 4456448
  buffer_load_dwordx4 v8, s[16:19], s54 offen lds
  s_add_u32 m0, s57, 126976
  s_add_u32 s54, s78, 4587520
  buffer_load_dwordx4 v8, s[16:19], s54 offen lds
  s_waitcnt vmcnt(28) lgkmcnt(0)
  s_barrier
  s_add_u32 m0, s57, 131072
  s_add_u32 s54, s78, 524288
  buffer_load_dwordx4 v8, s[20:23], s54 offen lds
  s_add_u32 m0, s57, 135168
  s_add_u32 s54, s78, 655360
  buffer_load_dwordx4 v8, s[20:23], s54 offen lds
  s_add_u32 m0, s57, 139264
  s_add_u32 s54, s78, 786432
  buffer_load_dwordx4 v8, s[20:23], s54 offen lds
  s_add_u32 m0, s57, 143360
  s_add_u32 s54, s78, 917504
  buffer_load_dwordx4 v8, s[20:23], s54 offen lds
  v_add_u32 v15, 16384, v11
  v_add_u32 v16, 16384, v12
  ds_read_b64_tr_b16 v[80:81], v15 offset:0
  ds_read_b64_tr_b16 v[82:83], v15 offset:512
  ds_read_b64_tr_b16 v[84:85], v15 offset:8192
  ds_read_b64_tr_b16 v[86:87], v15 offset:8704
  ds_read_b64_tr_b16 v[88:89], v16 offset:0
  ds_read_b64_tr_b16 v[90:91], v16 offset:512
  ds_read_b64_tr_b16 v[92:93], v16 offset:8192
  ds_read_b64_tr_b16 v[94:95], v16 offset:8704
  s_waitcnt vmcnt(28) lgkmcnt(0)
  s_barrier
  s_add_u32 m0, s57, 0
  s_add_u32 s54, s78, 1572864
  buffer_load_dwordx4 v8, s[20:23], s54 offen lds
  s_add_u32 m0, s57, 4096
  s_add_u32 s54, s78, 1703936
  buffer_load_dwordx4 v8, s[20:23], s54 offen lds
  s_add_u32 m0, s57, 8192
  s_add_u32 s54, s78, 1835008
  buffer_load_dwordx4 v8, s[20:23], s54 offen lds
  s_add_u32 m0, s57, 12288
  s_add_u32 s54, s78, 1966080
  buffer_load_dwordx4 v8, s[20:23], s54 offen lds
  v_add_u32 v15, 32768, v11
  v_add_u32 v16, 32768, v12
  ds_read_b64_tr_b16 v[96:97], v15 offset:0
  ds_read_b64_tr_b16 v[98:99], v15 offset:512
  ds_read_b64_tr_b16 v[100:101], v15 offset:8192
  ds_read_b64_tr_b16 v[102:103], v15 offset:8704
  ds_read_b64_tr_b16 v[104:105], v16 offset:0
  ds_read_b64_tr_b16 v[106:107], v16 offset:512
  ds_read_b64_tr_b16 v[108:109], v16 offset:8192
  ds_read_b64_tr_b16 v[110:111], v16 offset:8704
  s_waitcnt vmcnt(28) lgkmcnt(0)
  s_barrier
  s_add_u32 m0, s57, 16384
  s_add_u32 s54, s78, 2621440
  buffer_load_dwordx4 v8, s[20:23], s54 offen lds
  s_add_u32 m0, s57, 20480
  s_add_u32 s54, s78, 2752512
  buffer_load_dwordx4 v8, s[20:23], s54 offen lds
  s_add_u32 m0, s57, 24576
  s_add_u32 s54, s78, 2883584
  buffer_load_dwordx4 v8, s[20:23], s54 offen lds
  s_add_u32 m0, s57, 28672
  s_add_u32 s54, s78, 3014656
  buffer_load_dwordx4 v8, s[20:23], s54 offen lds
  v_add_u32 v15, 49152, v11
  v_add_u32 v16, 49152, v12
  ds_read_b64_tr_b16 v[112:113], v15 offset:0
  ds_read_b64_tr_b16 v[114:115], v15 offset:512
  ds_read_b64_tr_b16 v[116:117], v15 offset:8192
  ds_read_b64_tr_b16 v[118:119], v15 offset:8704
  ds_read_b64_tr_b16 v[120:121], v16 offset:0
  ds_read_b64_tr_b16 v[122:123], v16 offset:512
  ds_read_b64_tr_b16 v[124:125], v16 offset:8192
  ds_read_b64_tr_b16 v[126:127], v16 offset:8704
  s_waitcnt vmcnt(28) lgkmcnt(0)
  s_barrier
  s_add_u32 m0, s57, 32768
  s_add_u32 s54, s78, 3145728
  buffer_load_dwordx4 v8, s[20:23], s54 offen lds
  s_add_u32 m0, s57, 36864
  s_add_u32 s54, s78, 3276800
  buffer_load_dwordx4 v8, s[20:23], s54 offen lds
  s_add_u32 m0, s57, 40960
  s_add_u32 s54, s78, 3407872
  buffer_load_dwordx4 v8, s[20:23], s54 offen lds
  s_add_u32 m0, s57, 45056
  s_add_u32 s54, s78, 3538944
  buffer_load_dwordx4 v8, s[20:23], s54 offen lds
  v_add_u32 v15, 65536, v11
  v_add_u32 v16, 65536, v12
  ds_read_b64_tr_b16 v[128:129], v15 offset:0
  ds_read_b64_tr_b16 v[130:131], v15 offset:512
  ds_read_b64_tr_b16 v[132:133], v15 offset:8192
  ds_read_b64_tr_b16 v[134:135], v15 offset:8704
  ds_read_b64_tr_b16 v[136:137], v16 offset:0
  ds_read_b64_tr_b16 v[138:139], v16 offset:512
  ds_read_b64_tr_b16 v[140:141], v16 offset:8192
  ds_read_b64_tr_b16 v[142:143], v16 offset:8704
  s_waitcnt vmcnt(28) lgkmcnt(0)
  s_barrier
  s_add_u32 m0, s57, 49152
  s_add_u32 s54, s78, 3670016
  buffer_load_dwordx4 v8, s[20:23], s54 offen lds
  s_add_u32 m0, s57, 53248
  s_add_u32 s54, s78, 3801088
  buffer_load_dwordx4 v8, s[20:23], s54 offen lds
  s_add_u32 m0, s57, 57344
  s_add_u32 s54, s78, 3932160
  buffer_load_dwordx4 v8, s[20:23], s54 offen lds
  s_add_u32 m0, s57, 61440
  s_add_u32 s54, s78, 4063232
  buffer_load_dwordx4 v8, s[20:23], s54 offen lds
  v_add_u32 v15, 81920, v11
  v_add_u32 v16, 81920, v12
  ds_read_b64_tr_b16 v[144:145], v15 offset:0
  ds_read_b64_tr_b16 v[146:147], v15 offset:512
  ds_read_b64_tr_b16 v[148:149], v15 offset:8192
  ds_read_b64_tr_b16 v[150:151], v15 offset:8704
  ds_read_b64_tr_b16 v[152:153], v16 offset:0
  ds_read_b64_tr_b16 v[154:155], v16 offset:512
  ds_read_b64_tr_b16 v[156:157], v16 offset:8192
  ds_read_b64_tr_b16 v[158:159], v16 offset:8704
  s_waitcnt vmcnt(28) lgkmcnt(0)
  s_barrier
  s_add_u32 m0, s57, 65536
  s_add_u32 s54, s78, 0
  buffer_load_dwordx4 v8, s[24:27], s54 offen lds
  s_add_u32 m0, s57, 69632
  s_add_u32 s54, s78, 131072
  buffer_load_dwordx4 v8, s[24:27], s54 offen lds
  s_add_u32 m0, s57, 73728
  s_add_u32 s54, s78, 262144
  buffer_load_dwordx4 v8, s[24:27], s54 offen lds
  s_add_u32 m0, s57, 77824
  s_add_u32 s54, s78, 393216
  buffer_load_dwordx4 v8, s[24:27], s54 offen lds
  v_add_u32 v15, 98304, v11
  v_add_u32 v16, 98304, v12
  ds_read_b64_tr_b16 v[160:161], v15 offset:0
  ds_read_b64_tr_b16 v[162:163], v15 offset:512
  ds_read_b64_tr_b16 v[164:165], v15 offset:8192
  ds_read_b64_tr_b16 v[166:167], v15 offset:8704
  ds_read_b64_tr_b16 v[168:169], v16 offset:0
  ds_read_b64_tr_b16 v[170:171], v16 offset:512
  ds_read_b64_tr_b16 v[172:173], v16 offset:8192
  ds_read_b64_tr_b16 v[174:175], v16 offset:8704
  s_waitcnt vmcnt(28) lgkmcnt(0)
  s_barrier
  s_add_u32 m0, s57, 81920
  s_add_u32 s54, s78, 524288
  buffer_load_dwordx4 v8, s[24:27], s54 offen lds
  s_add_u32 m0, s57, 86016
  s_add_u32 s54, s78, 655360
  buffer_load_dwordx4 v8, s[24:27], s54 offen lds
  s_add_u32 m0, s57, 90112
  s_add_u32 s54, s78, 786432
  buffer_load_dwordx4 v8, s[24:27], s54 offen lds
  s_add_u32 m0, s57, 94208
  s_add_u32 s54, s78, 917504
  buffer_load_dwordx4 v8, s[24:27], s54 offen lds
  v_add_u32 v15, 114688, v11
  v_add_u32 v16, 114688, v12
  ds_read_b64_tr_b16 v[176:177], v15 offset:0
  ds_read_b64_tr_b16 v[178:179], v15 offset:512
  ds_read_b64_tr_b16 v[180:181], v15 offset:8192
  ds_read_b64_tr_b16 v[182:183], v15 offset:8704
  ds_read_b64_tr_b16 v[184:185], v16 offset:0
  ds_read_b64_tr_b16 v[186:187], v16 offset:512
  ds_read_b64_tr_b16 v[188:189], v16 offset:8192
  ds_read_b64_tr_b16 v[190:191], v16 offset:8704
  s_waitcnt vmcnt(28) lgkmcnt(0)
  s_barrier
  s_add_u32 m0, s57, 98304
  s_add_u32 s54, s78, 1048576
  buffer_load_dwordx4 v8, s[24:27], s54 offen lds
  s_add_u32 m0, s57, 102400
  s_add_u32 s54, s78, 1179648
  buffer_load_dwordx4 v8, s[24:27], s54 offen lds
  s_add_u32 m0, s57, 106496
  s_add_u32 s54, s78, 1310720
  buffer_load_dwordx4 v8, s[24:27], s54 offen lds
  s_add_u32 m0, s57, 110592
  s_add_u32 s54, s78, 1441792
  buffer_load_dwordx4 v8, s[24:27], s54 offen lds
  v_add_u32 v15, 131072, v11
  v_add_u32 v16, 131072, v12
  ds_read_b64_tr_b16 v[192:193], v15 offset:0
  ds_read_b64_tr_b16 v[194:195], v15 offset:512
  ds_read_b64_tr_b16 v[196:197], v15 offset:8192
  ds_read_b64_tr_b16 v[198:199], v15 offset:8704
  ds_read_b64_tr_b16 v[200:201], v16 offset:0
  ds_read_b64_tr_b16 v[202:203], v16 offset:512
  ds_read_b64_tr_b16 v[204:205], v16 offset:8192
  ds_read_b64_tr_b16 v[206:207], v16 offset:8704
  s_waitcnt vmcnt(28) lgkmcnt(0)
  s_barrier
  s_add_u32 m0, s57, 114688
  s_add_u32 s54, s78, 1572864
  buffer_load_dwordx4 v8, s[24:27], s54 offen lds
  s_add_u32 m0, s57, 118784
  s_add_u32 s54, s78, 1703936
  buffer_load_dwordx4 v8, s[24:27], s54 offen lds
  s_add_u32 m0, s57, 122880
  s_add_u32 s54, s78, 1835008
  buffer_load_dwordx4 v8, s[24:27], s54 offen lds
  s_add_u32 m0, s57, 126976
  s_add_u32 s54, s78, 1966080
  buffer_load_dwordx4 v8, s[24:27], s54 offen lds
  v_add_u32 v15, 147456, v11
  v_add_u32 v16, 147456, v12
  ds_read_b64_tr_b16 v[208:209], v15 offset:0
  ds_read_b64_tr_b16 v[210:211], v15 offset:512
  ds_read_b64_tr_b16 v[212:213], v15 offset:8192
  ds_read_b64_tr_b16 v[214:215], v15 offset:8704
  ds_read_b64_tr_b16 v[216:217], v16 offset:0
  ds_read_b64_tr_b16 v[218:219], v16 offset:512
  ds_read_b64_tr_b16 v[220:221], v16 offset:8192
  ds_read_b64_tr_b16 v[222:223], v16 offset:8704
  s_waitcnt vmcnt(28) lgkmcnt(0)
  s_barrier
  s_add_u32 m0, s57, 131072
  s_add_u32 s54, s78, 2097152
  buffer_load_dwordx4 v8, s[24:27], s54 offen lds
  s_add_u32 m0, s57, 135168
  s_add_u32 s54, s78, 2228224
  buffer_load_dwordx4 v8, s[24:27], s54 offen lds
  s_add_u32 m0, s57, 139264
  s_add_u32 s54, s78, 2359296
  buffer_load_dwordx4 v8, s[24:27], s54 offen lds
  s_add_u32 m0, s57, 143360
  s_add_u32 s54, s78, 2490368
  buffer_load_dwordx4 v8, s[24:27], s54 offen lds
  v_add_u32 v15, 16384, v11
  v_add_u32 v16, 16384, v12
  ds_read_b64_tr_b16 v[224:225], v15 offset:0
  ds_read_b64_tr_b16 v[226:227], v15 offset:512
  ds_read_b64_tr_b16 v[228:229], v15 offset:8192
  ds_read_b64_tr_b16 v[230:231], v15 offset:8704
  ds_read_b64_tr_b16 v[232:233], v16 offset:0
  ds_read_b64_tr_b16 v[234:235], v16 offset:512
  ds_read_b64_tr_b16 v[236:237], v16 offset:8192
  ds_read_b64_tr_b16 v[238:239], v16 offset:8704
  s_waitcnt vmcnt(28) lgkmcnt(0)
  s_barrier
  s_add_u32 m0, s57, 0
  s_add_u32 s54, s78, 2621440
  buffer_load_dwordx4 v8, s[24:27], s54 offen lds
  s_add_u32 m0, s57, 4096
  s_add_u32 s54, s78, 2752512
  buffer_load_dwordx4 v8, s[24:27], s54 offen lds
  s_add_u32 m0, s57, 8192
  s_add_u32 s54, s78, 2883584
  buffer_load_dwordx4 v8, s[24:27], s54 offen lds
  s_add_u32 m0, s57, 12288
  s_add_u32 s54, s78, 3014656
  buffer_load_dwordx4 v8, s[24:27], s54 offen lds
  v_add_u32 v15, 32768, v11
  v_add_u32 v16, 32768, v12
  ds_read_b64_tr_b16 v[240:241], v15 offset:0
  ds_read_b64_tr_b16 v[242:243], v15 offset:512
  ds_read_b64_tr_b16 v[244:245], v15 offset:8192
  ds_read_b64_tr_b16 v[246:247], v15 offset:8704
  ds_read_b64_tr_b16 v[248:249], v16 offset:0
  ds_read_b64_tr_b16 v[250:251], v16 offset:512
  ds_read_b64_tr_b16 v[252:253], v16 offset:8192
  ds_read_b64_tr_b16 v[254:255], v16 offset:8704
  s_waitcnt vmcnt(28) lgkmcnt(0)
  s_barrier
  s_add_u32 m0, s57, 16384
  s_add_u32 s54, s78, 3145728
  buffer_load_dwordx4 v8, s[24:27], s54 offen lds
  s_add_u32 m0, s57, 20480
  s_add_u32 s54, s78, 3276800
  buffer_load_dwordx4 v8, s[24:27], s54 offen lds
  s_add_u32 m0, s57, 24576
  s_add_u32 s54, s78, 3407872
  buffer_load_dwordx4 v8, s[24:27], s54 offen lds
  s_add_u32 m0, s57, 28672
  s_add_u32 s54, s78, 3538944
  buffer_load_dwordx4 v8, s[24:27], s54 offen lds
  v_add_u32 v15, 49152, v11
  v_add_u32 v16, 49152, v12
  ds_read_b64_tr_b16 a[0:1], v15 offset:0
  ds_read_b64_tr_b16 a[2:3], v15 offset:512
  ds_read_b64_tr_b16 a[4:5], v15 offset:8192
  ds_read_b64_tr_b16 a[6:7], v15 offset:8704
  ds_read_b64_tr_b16 a[8:9], v16 offset:0
  ds_read_b64_tr_b16 a[10:11], v16 offset:512
  ds_read_b64_tr_b16 a[12:13], v16 offset:8192
  ds_read_b64_tr_b16 a[14:15], v16 offset:8704
  s_waitcnt vmcnt(28) lgkmcnt(0)
  s_barrier
  s_add_u32 m0, s57, 32768
  s_add_u32 s54, s78, 3670016
  buffer_load_dwordx4 v8, s[24:27], s54 offen lds
  s_add_u32 m0, s57, 36864
  s_add_u32 s54, s78, 3801088
  buffer_load_dwordx4 v8, s[24:27], s54 offen lds
  s_add_u32 m0, s57, 40960
  s_add_u32 s54, s78, 3932160
  buffer_load_dwordx4 v8, s[24:27], s54 offen lds
  s_add_u32 m0, s57, 45056
  s_add_u32 s54, s78, 4063232
  buffer_load_dwordx4 v8, s[24:27], s54 offen lds
  v_add_u32 v15, 65536, v11
  v_add_u32 v16, 65536, v12
  ds_read_b64_tr_b16 a[16:17], v15 offset:0
  ds_read_b64_tr_b16 a[18:19], v15 offset:512
  ds_read_b64_tr_b16 a[20:21], v15 offset:8192
  ds_read_b64_tr_b16 a[22:23], v15 offset:8704
  ds_read_b64_tr_b16 a[24:25], v16 offset:0
  ds_read_b64_tr_b16 a[26:27], v16 offset:512
  ds_read_b64_tr_b16 a[28:29], v16 offset:8192
  ds_read_b64_tr_b16 a[30:31], v16 offset:8704
  s_waitcnt vmcnt(28) lgkmcnt(0)
  s_barrier
  s_add_u32 m0, s57, 49152
  s_add_u32 s54, s78, 4194304
  buffer_load_dwordx4 v8, s[24:27], s54 offen lds
  s_add_u32 m0, s57, 53248
  s_add_u32 s54, s78, 4325376
  buffer_load_dwordx4 v8, s[24:27], s54 offen lds
  s_add_u32 m0, s57, 57344
  s_add_u32 s54, s78, 4456448
  buffer_load_dwordx4 v8, s[24:27], s54 offen lds
  s_add_u32 m0, s57, 61440
  s_add_u32 s54, s78, 4587520
  buffer_load_dwordx4 v8, s[24:27], s54 offen lds
  v_add_u32 v15, 81920, v11
  v_add_u32 v16, 81920, v12
  ds_read_b64_tr_b16 a[32:33], v15 offset:0
  ds_read_b64_tr_b16 a[34:35], v15 offset:512
  ds_read_b64_tr_b16 a[36:37], v15 offset:8192
  ds_read_b64_tr_b16 a[38:39], v15 offset:8704
  ds_read_b64_tr_b16 a[40:41], v16 offset:0
  ds_read_b64_tr_b16 a[42:43], v16 offset:512
  ds_read_b64_tr_b16 a[44:45], v16 offset:8192
  ds_read_b64_tr_b16 a[46:47], v16 offset:8704
  s_waitcnt vmcnt(28) lgkmcnt(0)
  s_barrier
  s_add_u32 m0, s57, 65536
  s_add_u32 s54, s79, 0
  buffer_load_dwordx4 v10, s[28:31], s54 offen lds
  s_add_u32 m0, s57, 69632
  s_add_u32 s54, s79, 9216
  buffer_load_dwordx4 v10, s[28:31], s54 offen lds
  s_add_u32 m0, s57, 73728
  s_add_u32 s54, s79, 36864
  buffer_load_dwordx4 v10, s[28:31], s54 offen lds
  s_add_u32 m0, s57, 77824
  s_add_u32 s54, s79, 46080
  buffer_load_dwordx4 v10, s[28:31], s54 offen lds
  v_add_u32 v15, 98304, v11
  v_add_u32 v16, 98304, v12
  ds_read_b64_tr_b16 a[48:49], v15 offset:0
  ds_read_b64_tr_b16 a[50:51], v15 offset:512
  ds_read_b64_tr_b16 a[52:53], v15 offset:8192
  ds_read_b64_tr_b16 a[54:55], v15 offset:8704
  ds_read_b64_tr_b16 a[56:57], v16 offset:0
  ds_read_b64_tr_b16 a[58:59], v16 offset:512
  ds_read_b64_tr_b16 a[60:61], v16 offset:8192
  ds_read_b64_tr_b16 a[62:63], v16 offset:8704
  s_waitcnt vmcnt(28) lgkmcnt(0)
  s_barrier
  s_add_u32 m0, s57, 81920
  s_add_u32 s54, s79, 73728
  buffer_load_dwordx4 v10, s[28:31], s54 offen lds
  s_add_u32 m0, s57, 86016
  s_add_u32 s54, s79, 82944
  buffer_load_dwordx4 v10, s[28:31], s54 offen lds
  s_add_u32 m0, s57, 90112
  s_add_u32 s54, s79, 110592
  buffer_load_dwordx4 v10, s[28:31], s54 offen lds
  s_add_u32 m0, s57, 94208
  s_add_u32 s54, s79, 119808
  buffer_load_dwordx4 v10, s[28:31], s54 offen lds
  v_add_u32 v15, 114688, v11
  v_add_u32 v16, 114688, v12
  ds_read_b64_tr_b16 a[64:65], v15 offset:0
  ds_read_b64_tr_b16 a[66:67], v15 offset:512
  ds_read_b64_tr_b16 a[68:69], v15 offset:8192
  ds_read_b64_tr_b16 a[70:71], v15 offset:8704
  ds_read_b64_tr_b16 a[72:73], v16 offset:0
  ds_read_b64_tr_b16 a[74:75], v16 offset:512
  ds_read_b64_tr_b16 a[76:77], v16 offset:8192
  ds_read_b64_tr_b16 a[78:79], v16 offset:8704
  s_waitcnt vmcnt(28) lgkmcnt(0)
  s_barrier
  s_add_u32 m0, s57, 98304
  s_add_u32 s54, s79, 256
  buffer_load_dwordx4 v10, s[28:31], s54 offen lds
  s_add_u32 m0, s57, 102400
  s_add_u32 s54, s79, 9472
  buffer_load_dwordx4 v10, s[28:31], s54 offen lds
  s_add_u32 m0, s57, 106496
  s_add_u32 s54, s79, 37120
  buffer_load_dwordx4 v10, s[28:31], s54 offen lds
  s_add_u32 m0, s57, 110592
  s_add_u32 s54, s79, 46336
  buffer_load_dwordx4 v10, s[28:31], s54 offen lds
  v_add_u32 v15, 131072, v11
  v_add_u32 v16, 131072, v12
  ds_read_b64_tr_b16 a[80:81], v15 offset:0
  ds_read_b64_tr_b16 a[82:83], v15 offset:512
  ds_read_b64_tr_b16 a[84:85], v15 offset:8192
  ds_read_b64_tr_b16 a[86:87], v15 offset:8704
  ds_read_b64_tr_b16 a[88:89], v16 offset:0
  ds_read_b64_tr_b16 a[90:91], v16 offset:512
  ds_read_b64_tr_b16 a[92:93], v16 offset:8192
  ds_read_b64_tr_b16 a[94:95], v16 offset:8704
  s_waitcnt vmcnt(28) lgkmcnt(0)
  s_barrier
  s_add_u32 m0, s57, 114688
  s_add_u32 s54, s79, 512
  buffer_load_dwordx4 v10, s[28:31], s54 offen lds
  s_add_u32 m0, s57, 118784
  s_add_u32 s54, s79, 9728
  buffer_load_dwordx4 v10, s[28:31], s54 offen lds
  s_add_u32 m0, s57, 122880
  s_add_u32 s54, s79, 37376
  buffer_load_dwordx4 v10, s[28:31], s54 offen lds
  s_add_u32 m0, s57, 126976
  s_add_u32 s54, s79, 46592
  buffer_load_dwordx4 v10, s[28:31], s54 offen lds
  v_add_u32 v15, 147456, v11
  v_add_u32 v16, 147456, v12
  ds_read_b64_tr_b16 a[96:97], v15 offset:0
  ds_read_b64_tr_b16 a[98:99], v15 offset:512
  ds_read_b64_tr_b16 a[100:101], v15 offset:8192
  ds_read_b64_tr_b16 a[102:103], v15 offset:8704
  ds_read_b64_tr_b16 a[104:105], v16 offset:0
  ds_read_b64_tr_b16 a[106:107], v16 offset:512
  ds_read_b64_tr_b16 a[108:109], v16 offset:8192
  ds_read_b64_tr_b16 a[110:111], v16 offset:8704
  s_waitcnt vmcnt(28) lgkmcnt(0)
  s_barrier
  s_add_u32 m0, s57, 131072
  s_add_u32 s54, s79, 768
  buffer_load_dwordx4 v10, s[28:31], s54 offen lds
  s_add_u32 m0, s57, 135168
  s_add_u32 s54, s79, 9984
  buffer_load_dwordx4 v10, s[28:31], s54 offen lds
  s_add_u32 m0, s57, 139264
  s_add_u32 s54, s79, 37632
  buffer_load_dwordx4 v10, s[28:31], s54 offen lds
  s_add_u32 m0, s57, 143360
  s_add_u32 s54, s79, 46848
  buffer_load_dwordx4 v10, s[28:31], s54 offen lds
  v_add_u32 v15, 16384, v11
  v_add_u32 v16, 16384, v12
  ds_read_b64_tr_b16 a[112:113], v15 offset:0
  ds_read_b64_tr_b16 a[114:115], v15 offset:512
  ds_read_b64_tr_b16 a[116:117], v15 offset:8192
  ds_read_b64_tr_b16 a[118:119], v15 offset:8704
  ds_read_b64_tr_b16 a[120:121], v16 offset:0
  ds_read_b64_tr_b16 a[122:123], v16 offset:512
  ds_read_b64_tr_b16 a[124:125], v16 offset:8192
  ds_read_b64_tr_b16 a[126:127], v16 offset:8704
  s_waitcnt vmcnt(28) lgkmcnt(0)
  s_barrier
  s_add_u32 m0, s57, 0
  s_add_u32 s54, s78, 0
  buffer_load_dwordx4 v8, s[16:19], s54 offen lds
  s_add_u32 m0, s57, 4096
  s_add_u32 s54, s78, 131072
  buffer_load_dwordx4 v8, s[16:19], s54 offen lds
  s_add_u32 m0, s57, 8192
  s_add_u32 s54, s78, 262144
  buffer_load_dwordx4 v8, s[16:19], s54 offen lds
  s_add_u32 m0, s57, 12288
  s_add_u32 s54, s78, 393216
  buffer_load_dwordx4 v8, s[16:19], s54 offen lds
  v_add_u32 v15, 32768, v11
  v_add_u32 v16, 32768, v12
  ds_read_b64_tr_b16 a[128:129], v15 offset:0
  ds_read_b64_tr_b16 a[130:131], v15 offset:512
  ds_read_b64_tr_b16 a[132:133], v15 offset:8192
  ds_read_b64_tr_b16 a[134:135], v15 offset:8704
  ds_read_b64_tr_b16 a[136:137], v16 offset:0
  ds_read_b64_tr_b16 a[138:139], v16 offset:512
  ds_read_b64_tr_b16 a[140:141], v16 offset:8192
  ds_read_b64_tr_b16 a[142:143], v16 offset:8704
  s_waitcnt vmcnt(28) lgkmcnt(0)
  s_barrier
  s_add_u32 m0, s57, 16384
  s_add_u32 s54, s78, 0
  buffer_load_dwordx4 v8, s[20:23], s54 offen lds
  s_add_u32 m0, s57, 20480
  s_add_u32 s54, s78, 131072
  buffer_load_dwordx4 v8, s[20:23], s54 offen lds
  s_add_u32 m0, s57, 24576
  s_add_u32 s54, s78, 262144
  buffer_load_dwordx4 v8, s[20:23], s54 offen lds
  s_add_u32 m0, s57, 28672
  s_add_u32 s54, s78, 393216
  buffer_load_dwordx4 v8, s[20:23], s54 offen lds
  v_add_u32 v15, 49152, v11
  v_add_u32 v16, 49152, v12
  ds_read_b64_tr_b16 a[144:145], v15 offset:0
  ds_read_b64_tr_b16 a[146:147], v15 offset:512
  ds_read_b64_tr_b16 a[148:149], v15 offset:8192
  ds_read_b64_tr_b16 a[150:151], v15 offset:8704
  ds_read_b64_tr_b16 a[152:153], v16 offset:0
  ds_read_b64_tr_b16 a[154:155], v16 offset:512
  ds_read_b64_tr_b16 a[156:157], v16 offset:8192
  ds_read_b64_tr_b16 a[158:159], v16 offset:8704
  s_waitcnt vmcnt(28) lgkmcnt(0)
  s_barrier
  s_add_u32 m0, s57, 32768
  s_add_u32 s54, s78, 1048576
  buffer_load_dwordx4 v8, s[20:23], s54 offen lds
  s_add_u32 m0, s57, 36864
  s_add_u32 s54, s78, 1179648
  buffer_load_dwordx4 v8, s[20:23], s54 offen lds
  s_add_u32 m0, s57, 40960
  s_add_u32 s54, s78, 1310720
  buffer_load_dwordx4 v8, s[20:23], s54 offen lds
  s_add_u32 m0, s57, 45056
  s_add_u32 s54, s78, 1441792
  buffer_load_dwordx4 v8, s[20:23], s54 offen lds
  v_add_u32 v15, 65536, v11
  v_add_u32 v16, 65536, v12
  ds_read_b64_tr_b16 a[160:161], v15 offset:0
  ds_read_b64_tr_b16 a[162:163], v15 offset:512
  ds_read_b64_tr_b16 a[164:165], v15 offset:8192
  ds_read_b64_tr_b16 a[166:167], v15 offset:8704
  ds_read_b64_tr_b16 a[168:169], v16 offset:0
  ds_read_b64_tr_b16 a[170:171], v16 offset:512
  ds_read_b64_tr_b16 a[172:173], v16 offset:8192
  ds_read_b64_tr_b16 a[174:175], v16 offset:8704
  s_waitcnt vmcnt(28) lgkmcnt(0)
  s_barrier
  s_add_u32 m0, s57, 49152
  s_add_u32 s54, s78, 4194304
  buffer_load_dwordx4 v8, s[20:23], s54 offen lds
  s_add_u32 m0, s57, 53248
  s_add_u32 s54, s78, 4325376
  buffer_load_dwordx4 v8, s[20:23], s54 offen lds
  s_add_u32 m0, s57, 57344
  s_add_u32 s54, s78, 4456448
  buffer_load_dwordx4 v8, s[20:23], s54 offen lds
  s_add_u32 m0, s57, 61440
  s_add_u32 s54, s78, 4587520
  buffer_load_dwordx4 v8, s[20:23], s54 offen lds
  v_add_u32 v15, 81920, v14
  ds_read_b64_tr_b16 a[176:177], v15 offset:0
  ds_read_b64_tr_b16 a[178:179], v15 offset:1024
  ds_read_b64_tr_b16 a[180:181], v15 offset:4096
  ds_read_b64_tr_b16 a[182:183], v15 offset:5120
  ds_read_b64_tr_b16 a[184:185], v15 offset:8192
  ds_read_b64_tr_b16 a[186:187], v15 offset:9216
  ds_read_b64_tr_b16 a[188:189], v15 offset:12288
  ds_read_b64_tr_b16 a[190:191], v15 offset:13312
  s_waitcnt vmcnt(28) lgkmcnt(0)
  s_barrier
  s_add_u32 m0, s57, 65536
  s_add_u32 s54, s78, 2097152
  buffer_load_dwordx4 v8, s[20:23], s54 offen lds
  s_add_u32 m0, s57, 69632
  s_add_u32 s54, s78, 2228224
  buffer_load_dwordx4 v8, s[20:23], s54 offen lds
  s_add_u32 m0, s57, 73728
  s_add_u32 s54, s78, 2359296
  buffer_load_dwordx4 v8, s[20:23], s54 offen lds
  s_add_u32 m0, s57, 77824
  s_add_u32 s54, s78, 2490368
  buffer_load_dwordx4 v8, s[20:23], s54 offen lds
  v_add_u32 v15, 98304, v14
  ds_read_b64_tr_b16 a[192:193], v15 offset:0
  ds_read_b64_tr_b16 a[194:195], v15 offset:1024
  ds_read_b64_tr_b16 a[196:197], v15 offset:4096
  ds_read_b64_tr_b16 a[198:199], v15 offset:5120
  ds_read_b64_tr_b16 a[200:201], v15 offset:8192
  ds_read_b64_tr_b16 a[202:203], v15 offset:9216
  ds_read_b64_tr_b16 a[204:205], v15 offset:12288
  ds_read_b64_tr_b16 a[206:207], v15 offset:13312
  s_waitcnt vmcnt(28) lgkmcnt(0)
  s_barrier
  s_add_u32 m0, s57, 81920
  s_add_u32 s54, s79, 73984
  buffer_load_dwordx4 v10, s[28:31], s54 offen lds
  s_add_u32 m0, s57, 86016
  s_add_u32 s54, s79, 83200
  buffer_load_dwordx4 v10, s[28:31], s54 offen lds
  s_add_u32 m0, s57, 90112
  s_add_u32 s54, s79, 110848
  buffer_load_dwordx4 v10, s[28:31], s54 offen lds
  s_add_u32 m0, s57, 94208
  s_add_u32 s54, s79, 120064
  buffer_load_dwordx4 v10, s[28:31], s54 offen lds
  v_add_u32 v15, 114688, v14
  ds_read_b64_tr_b16 a[208:209], v15 offset:0
  ds_read_b64_tr_b16 a[210:211], v15 offset:1024
  ds_read_b64_tr_b16 a[212:213], v15 offset:4096
  ds_read_b64_tr_b16 a[214:215], v15 offset:5120
  ds_read_b64_tr_b16 a[216:217], v15 offset:8192
  ds_read_b64_tr_b16 a[218:219], v15 offset:9216
  ds_read_b64_tr_b16 a[220:221], v15 offset:12288
  ds_read_b64_tr_b16 a[222:223], v15 offset:13312
  s_waitcnt vmcnt(28) lgkmcnt(0)
  s_barrier
  s_add_u32 m0, s57, 98304
  s_add_u32 s54, s79, 74240
  buffer_load_dwordx4 v10, s[28:31], s54 offen lds
  s_add_u32 m0, s57, 102400
  s_add_u32 s54, s79, 83456
  buffer_load_dwordx4 v10, s[28:31], s54 offen lds
  s_add_u32 m0, s57, 106496
  s_add_u32 s54, s79, 111104
  buffer_load_dwordx4 v10, s[28:31], s54 offen lds
  s_add_u32 m0, s57, 110592
  s_add_u32 s54, s79, 120320
  buffer_load_dwordx4 v10, s[28:31], s54 offen lds
  v_add_u32 v15, 131072, v14
  ds_read_b64_tr_b16 a[224:225], v15 offset:0
  ds_read_b64_tr_b16 a[226:227], v15 offset:1024
  ds_read_b64_tr_b16 a[228:229], v15 offset:4096
  ds_read_b64_tr_b16 a[230:231], v15 offset:5120
  ds_read_b64_tr_b16 a[232:233], v15 offset:8192
  ds_read_b64_tr_b16 a[234:235], v15 offset:9216
  ds_read_b64_tr_b16 a[236:237], v15 offset:12288
  ds_read_b64_tr_b16 a[238:239], v15 offset:13312
  s_waitcnt vmcnt(28) lgkmcnt(0)
  s_barrier
  s_add_u32 m0, s57, 114688
  s_add_u32 s54, s79, 74496
  buffer_load_dwordx4 v10, s[28:31], s54 offen lds
  s_add_u32 m0, s57, 118784
  s_add_u32 s54, s79, 83712
  buffer_load_dwordx4 v10, s[28:31], s54 offen lds
  s_add_u32 m0, s57, 122880
  s_add_u32 s54, s79, 111360
  buffer_load_dwordx4 v10, s[28:31], s54 offen lds
  s_add_u32 m0, s57, 126976
  s_add_u32 s54, s79, 120576
  buffer_load_dwordx4 v10, s[28:31], s54 offen lds
  v_add_u32 v15, 147456, v14
  ds_read_b64_tr_b16 a[240:241], v15 offset:0
  ds_read_b64_tr_b16 a[242:243], v15 offset:1024
  ds_read_b64_tr_b16 a[244:245], v15 offset:4096
  ds_read_b64_tr_b16 a[246:247], v15 offset:5120
  ds_read_b64_tr_b16 a[248:249], v15 offset:8192
  ds_read_b64_tr_b16 a[250:251], v15 offset:9216
  ds_read_b64_tr_b16 a[252:253], v15 offset:12288
  ds_read_b64_tr_b16 a[254:255], v15 offset:13312
  s_waitcnt vmcnt(28) lgkmcnt(0)
  s_barrier
  s_add_u32 m0, s57, 131072
  s_add_u32 s54, s79, 1024
  buffer_load_dwordx4 v9, s[28:31], s54 offen lds
  s_add_u32 m0, s57, 135168
  s_add_u32 s54, s79, 37888
  buffer_load_dwordx4 v9, s[28:31], s54 offen lds
  s_add_u32 m0, s57, 139264
  s_add_u32 s54, s79, 74752
  buffer_load_dwordx4 v9, s[28:31], s54 offen lds
  s_add_u32 m0, s57, 143360
  s_add_u32 s54, s79, 111616
  buffer_load_dwordx4 v9, s[28:31], s54 offen lds
C_mode:
  s_load_dwordx8 s[80:87], s[12:13], 0 glc
  s_add_u32 s67, s67, 1
  s_waitcnt lgkmcnt(0)
  s_mov_b32 s3, 0
  s_cmp_ge_u32 s80, 32
  s_cbranch_scc1 C_modeok
  s_mov_b32 s3, 1
  s_add_u32 s80, s80, s81
  s_add_u32 s80, s80, s82
  s_add_u32 s80, s80, s83
  s_add_u32 s80, s80, s84
  s_add_u32 s80, s80, s85
  s_add_u32 s80, s80, s86
  s_add_u32 s80, s80, s87
  s_cmp_ge_u32 s67, 131072
  s_cbranch_scc1 C_modeok
  s_cmp_lt_u32 s80, 256
  s_cbranch_scc1 C_mode
C_modeok:
  v_mov_b32 v32, -1
  v_mov_b32 v33, -1
  v_mov_b32 v34, 0
  s_cmp_eq_u32 s3, 0
  s_cbranch_scc0 C_arm1
  buffer_store_dwordx4 v[20:23], v76, s[8:11], s64 offen
  buffer_store_dwordx4 v[24:27], v76, s[8:11], s64 offen offset:1024
  buffer_store_dwordx4 v[28:31], v76, s[8:11], s65 offen
  buffer_store_dwordx2 v[32:33], v68, s[8:11], s73 offen
  buffer_store_dwordx2 v[32:33], v68, s[8:11], s74 offen
  buffer_store_dwordx2 v[32:33], v68, s[8:11], s75 offen
  buffer_store_dwordx2 v[32:33], v68, s[8:11], s76 offen
  buffer_store_dwordx2 v[32:33], v68, s[8:11], s77 offen
  buffer_store_dword v32, v69, s[8:11], s62 offen
  buffer_store_dword v32, v70, s[8:11], s63 offen
  s_branch C_arm2
C_arm1:
  buffer_store_dwordx4 v[20:23], v76, s[8:11], s64 offen sc1
  buffer_store_dwordx4 v[24:27], v76, s[8:11], s64 offen offset:1024 sc1
  buffer_store_dwordx4 v[28:31], v76, s[8:11], s65 offen sc1
  buffer_store_dwordx2 v[32:33], v68, s[8:11], s73 offen sc1
  buffer_store_dwordx2 v[32:33], v68, s[8:11], s74 offen sc1
  buffer_store_dwordx2 v[32:33], v68, s[8:11], s75 offen sc1
  buffer_store_dwordx2 v[32:33], v68, s[8:11], s76 offen sc1
  buffer_store_dwordx2 v[32:33], v68, s[8:11], s77 offen sc1
  buffer_store_dword v32, v69, s[8:11], s62 offen sc1
  buffer_store_dword v32, v70, s[8:11], s63 offen sc1
C_arm2:
  s_mov_b64 exec, 1
  buffer_store_dword v34, v34, s[8:11], s71 offen sc1
  s_mov_b64 exec, -1
  v_add_u32 v15, 16384, v11
  v_add_u32 v16, 16384, v12
  ds_read_b64_tr_b16 v[52:53], v15 offset:0
  ds_read_b64_tr_b16 v[54:55], v15 offset:512
  ds_read_b64_tr_b16 v[56:57], v15 offset:8192
  ds_read_b64_tr_b16 v[58:59], v15 offset:8704
  ds_read_b64_tr_b16 v[60:61], v16 offset:0
  ds_read_b64_tr_b16 v[62:63], v16 offset:512
  ds_read_b64_tr_b16 v[64:65], v16 offset:8192
  ds_read_b64_tr_b16 v[66:67], v16 offset:8704
  s_waitcnt vmcnt(39) lgkmcnt(0)
  s_barrier
  s_lshl_b32 s54, s52, 12
  s_add_u32 s54, s54, 16384
  v_add_u32 v7, s54, v76
  ds_write_b128 v7, v[52:55] offset:0
  ds_write_b128 v7, v[56:59] offset:1024
  ds_write_b128 v7, v[60:63] offset:2048
  ds_write_b128 v7, v[64:67] offset:3072
  v_add_u32 v15, 32768, v11
  v_add_u32 v16, 32768, v12
  ds_read_b64_tr_b16 v[36:37], v15 offset:0
  ds_read_b64_tr_b16 v[38:39], v15 offset:512
  ds_read_b64_tr_b16 v[40:41], v15 offset:8192
  ds_read_b64_tr_b16 v[42:43], v15 offset:8704
  ds_read_b64_tr_b16 v[44:45], v16 offset:0
  ds_read_b64_tr_b16 v[46:47], v16 offset:512
  ds_read_b64_tr_b16 v[48:49], v16 offset:8192
  ds_read_b64_tr_b16 v[50:51], v16 offset:8704
  s_waitcnt vmcnt(35) lgkmcnt(0)
  s_barrier
  s_lshl_b32 s54, s52, 12
  s_add_u32 s54, s54, 32768
  v_add_u32 v7, s54, v76
  ds_write_b128 v7, v[36:39] offset:0
  ds_write_b128 v7, v[40:43] offset:1024
  ds_write_b128 v7, v[44:47] offset:2048
  ds_write_b128 v7, v[48:51] offset:3072
  v_add_u32 v15, 49152, v11
  v_add_u32 v16, 49152, v12
  ds_read_b64_tr_b16 v[52:53], v15 offset:0
  ds_read_b64_tr_b16 v[54:55], v15 offset:512
  ds_read_b64_tr_b16 v[56:57], v15 offset:8192
  ds_read_b64_tr_b16 v[58:59], v15 offset:8704
  ds_read_b64_tr_b16 v[60:61], v16 offset:0
  ds_read_b64_tr_b16 v[62:63], v16 offset:512
  ds_read_b64_tr_b16 v[64:65], v16 offset:8192
  ds_read_b64_tr_b16 v[66:67], v16 offset:8704
  s_waitcnt vmcnt(31) lgkmcnt(0)
  s_barrier
  s_lshl_b32 s54, s52, 12
  s_add_u32 s54, s54, 49152
  v_add_u32 v7, s54, v76
  ds_write_b128 v7, v[52:55] offset:0
  ds_write_b128 v7, v[56:59] offset:1024
  ds_write_b128 v7, v[60:63] offset:2048
  ds_write_b128 v7, v[64:67] offset:3072
  v_add_u32 v15, 65536, v11
  v_add_u32 v16, 65536, v12
  ds_read_b64_tr_b16 v[36:37], v15 offset:0
  ds_read_b64_tr_b16 v[38:39], v15 offset:512
  ds_read_b64_tr_b16 v[40:41], v15 offset:8192
  ds_read_b64_tr_b16 v[42:43], v15 offset:8704
  ds_read_b64_tr_b16 v[44:45], v16 offset:0
  ds_read_b64_tr_b16 v[46:47], v16 offset:512
  ds_read_b64_tr_b16 v[48:49], v16 offset:8192
  ds_read_b64_tr_b16 v[50:51], v16 offset:8704
  s_waitcnt vmcnt(27) lgkmcnt(0)
  s_barrier
  s_lshl_b32 s54, s52, 12
  s_add_u32 s54, s54, 65536
  v_add_u32 v7, s54, v76
  ds_write_b128 v7, v[36:39] offset:0
  ds_write_b128 v7, v[40:43] offset:1024
  ds_write_b128 v7, v[44:47] offset:2048
  ds_write_b128 v7, v[48:51] offset:3072
  v_add_u32 v15, 81920, v11
  v_add_u32 v16, 81920, v12
  ds_read_b64_tr_b16 v[52:53], v15 offset:0
  ds_read_b64_tr_b16 v[54:55], v15 offset:512
  ds_read_b64_tr_b16 v[56:57], v15 offset:8192
  ds_read_b64_tr_b16 v[58:59], v15 offset:8704
  ds_read_b64_tr_b16 v[60:61], v16 offset:0
  ds_read_b64_tr_b16 v[62:63], v16 offset:512
  ds_read_b64_tr_b16 v[64:65], v16 offset:8192
  ds_read_b64_tr_b16 v[66:67], v16 offset:8704
  s_waitcnt vmcnt(23) lgkmcnt(0)
  s_barrier
  s_lshl_b32 s54, s52, 12
  s_add_u32 s54, s54, 81920
  v_add_u32 v7, s54, v76
  ds_write_b128 v7, v[52:55] offset:0
  ds_write_b128 v7, v[56:59] offset:1024
  ds_write_b128 v7, v[60:63] offset:2048
  ds_write_b128 v7, v[64:67] offset:3072
  v_add_u32 v15, 98304, v14
  ds_read_b64_tr_b16 v[36:37], v15 offset:0
  ds_read_b64_tr_b16 v[38:39], v15 offset:1024
  ds_read_b64_tr_b16 v[40:41], v15 offset:4096
  ds_read_b64_tr_b16 v[42:43], v15 offset:5120
  ds_read_b64_tr_b16 v[44:45], v15 offset:8192
  ds_read_b64_tr_b16 v[46:47], v15 offset:9216
  ds_read_b64_tr_b16 v[48:49], v15 offset:12288
  ds_read_b64_tr_b16 v[50:51], v15 offset:13312
  s_waitcnt vmcnt(19) lgkmcnt(0)
  s_barrier
  s_lshl_b32 s54, s52, 12
  s_add_u32 s54, s54, 98304
  v_add_u32 v7, s54, v76
  ds_write_b128 v7, v[36:39] offset:0
  ds_write_b128 v7, v[40:43] offset:1024
  ds_write_b128 v7, v[44:47] offset:2048
  ds_write_b128 v7, v[48:51] offset:3072
  v_add_u32 v15, 114688, v14
  ds_read_b64_tr_b16 v[52:53], v15 offset:0
  ds_read_b64_tr_b16 v[54:55], v15 offset:1024
  ds_read_b64_tr_b16 v[56:57], v15 offset:4096
  ds_read_b64_tr_b16 v[58:59], v15 offset:5120
  ds_read_b64_tr_b16 v[60:61], v15 offset:8192
  ds_read_b64_tr_b16 v[62:63], v15 offset:9216
  ds_read_b64_tr_b16 v[64:65], v15 offset:12288
  ds_read_b64_tr_b16 v[66:67], v15 offset:13312
  s_waitcnt vmcnt(15) lgkmcnt(0)
  s_barrier
  s_lshl_b32 s54, s52, 12
  s_add_u32 s54, s54, 114688
  v_add_u32 v7, s54, v76
  ds_write_b128 v7, v[52:55] offset:0
  ds_write_b128 v7, v[56:59] offset:1024
  ds_write_b128 v7, v[60:63] offset:2048
  ds_write_b128 v7, v[64:67] offset:3072
  v_add_u32 v15, 131072, v14
  ds_read_b64_tr_b16 v[36:37], v15 offset:0
  ds_read_b64_tr_b16 v[38:39], v15 offset:1024
  ds_read_b64_tr_b16 v[40:41], v15 offset:4096
  ds_read_b64_tr_b16 v[42:43], v15 offset:5120
  ds_read_b64_tr_b16 v[44:45], v15 offset:8192
  ds_read_b64_tr_b16 v[46:47], v15 offset:9216
  ds_read_b64_tr_b16 v[48:49], v15 offset:12288
  ds_read_b64_tr_b16 v[50:51], v15 offset:13312
  s_waitcnt vmcnt(11) lgkmcnt(0)
  s_barrier
  s_lshl_b32 s54, s52, 12
  s_add_u32 s54, s54, 131072
  v_add_u32 v7, s54, v76
  ds_write_b128 v7, v[36:39] offset:0
  ds_write_b128 v7, v[40:43] offset:1024
  ds_write_b128 v7, v[44:47] offset:2048
  ds_write_b128 v7, v[48:51] offset:3072
  v_add_u32 v15, 147456, v13
  s_waitcnt lgkmcnt(0)
  ds_read_b64_tr_b16 v[36:37], v15 offset:0
  ds_read_b64_tr_b16 v[38:39], v15 offset:1024
  ds_read_b64_tr_b16 v[40:41], v15 offset:2048
  ds_read_b64_tr_b16 v[42:43], v15 offset:3072
  ds_read_b64_tr_b16 v[44:45], v15 offset:4096
  ds_read_b64_tr_b16 v[46:47], v15 offset:5120
  ds_read_b64_tr_b16 v[48:49], v15 offset:6144
  ds_read_b64_tr_b16 v[50:51], v15 offset:7168
  ds_read_b64_tr_b16 v[52:53], v15 offset:8192
  ds_read_b64_tr_b16 v[54:55], v15 offset:9216
  ds_read_b64_tr_b16 v[56:57], v15 offset:10240
  ds_read_b64_tr_b16 v[58:59], v15 offset:11264
  ds_read_b64_tr_b16 v[60:61], v15 offset:12288
  ds_read_b64_tr_b16 v[62:63], v15 offset:13312
  ds_read_b64_tr_b16 v[64:65], v15 offset:14336
  ds_read_b64_tr_b16 v[66:67], v15 offset:15360
  s_waitcnt vmcnt(0) lgkmcnt(0)
  s_barrier
  s_and_b32 s54, s52, 1
  s_lshl_b32 s54, s54, 13
  s_add_u32 s54, s54, 147456
  v_add_u32 v7, s54, v76
  ds_write_b128 v7, v[36:39] offset:0
  ds_write_b128 v7, v[40:43] offset:1024
  ds_write_b128 v7, v[44:47] offset:2048
  ds_write_b128 v7, v[48:51] offset:3072
  ds_write_b128 v7, v[52:55] offset:4096
  ds_write_b128 v7, v[56:59] offset:5120
  ds_write_b128 v7, v[60:63] offset:6144
  ds_write_b128 v7, v[64:67] offset:7168
  s_waitcnt lgkmcnt(0)
  s_cmp_eq_u32 s52, 0
  s_cbranch_scc0 L_tb2
  v_mov_b32 v1, 32
  v_mov_b32 v2, 1
  s_mov_b64 exec, 1
  buffer_atomic_add v2, v1, s[12:15], 0 offen
  s_mov_b64 exec, 3
  s_lshl_b32 s55, s53, 2
  s_add_u32 s55, s55, 128
  v_mov_b32 v3, 32
  v_writelane_b32 v1, s55, 1
  v_writelane_b32 v3, 7, 1
L_tb1:
  buffer_load_dword v2, v1, s[12:15], 0 offen sc1
  s_add_u32 s67, s67, 1
  s_waitcnt vmcnt(0)
  v_and_b32 v2, 0xff, v2
  v_cmp_lt_u32 vcc, v2, v3
  s_cmp_lt_u32 s67, 131072
  s_cselect_b64 vcc, vcc, 0
  s_cbranch_vccnz L_tb1
  s_mov_b64 exec, -1
L_tb2:
  s_barrier
  s_lshl_b32 s54, s3, 2
  s_add_u32 s54, s54, s52
  s_cmp_eq_u32 s54, 1
  s_cbranch_scc1 L_w1
  s_cmp_eq_u32 s54, 2
  s_cbranch_scc1 L_w2
  s_cmp_eq_u32 s54, 3
  s_cbranch_scc1 L_w3
  s_cmp_eq_u32 s54, 4
  s_cbranch_scc1 L_w4
  s_cmp_eq_u32 s54, 5
  s_cbranch_scc1 L_w5
  s_cmp_eq_u32 s54, 6
  s_cbranch_scc1 L_w6
  s_cmp_eq_u32 s54, 7
  s_cbranch_scc1 L_w7
  v_mov_b64 v[20:21], 0
  v_mov_b64 v[22:23], 0
  v_mov_b64 v[24:25], 0
  v_mov_b64 v[26:27], 0
  v_mov_b64 v[28:29], 0
  v_mov_b64 v[30:31], 0
  v_mov_b64 v[32:33], 0
  v_mov_b64 v[34:35], 0
  s_mov_b32 m0, 15872
  s_branch Cf0_h2
.p2align 6
Cf0_top:
  s_waitcnt lgkmcnt(0)
  s_barrier
  ds_read_b128 v[0:3], v76 offset:4608
  ds_read_b128 v[4:7], v76 offset:5632
  s_waitcnt lgkmcnt(1)
  v_smfmac_f32_16x16x64_bf16 v[20:23], v[0:3], v[60:67], v74
  ds_read_b128 v[60:63], v76 offset:34816
  v_smfmac_f32_16x16x64_bf16 v[24:27], v[0:3], v[44:51], v74
  ds_read_b128 v[64:67], v76 offset:35840
  s_waitcnt lgkmcnt(2)
  v_smfmac_f32_16x16x64_bf16 v[20:23], v[4:7], v[80:87], v74
  buffer_load_dwordx4 v[44:47], v76, s[8:11], s58 offen offset:0 sc1
  ds_read_b128 v[8:11], v76 offset:6656
  v_smfmac_f32_16x16x64_bf16 v[28:31], v[0:3], v[36:43], v74
  ds_read_b128 v[36:39], v76 offset:49152
  v_smfmac_f32_16x16x64_bf16 v[24:27], v[4:7], v[88:95], v74
  buffer_load_dwordx4 v[48:51], v76, s[8:11], s58 offen offset:1024 sc1
  ds_read_b128 v[40:43], v76 offset:50176
  v_smfmac_f32_16x16x64_bf16 v[28:31], v[4:7], v[208:215], v74
  s_waitcnt vmcnt(4)
  ds_read_b128 v[12:15], v76 offset:7680
  v_smfmac_f32_16x16x64_bf16 v[32:35], v[4:7], v[216:223], v74
  buffer_load_dwordx4 v[52:55], v76, s[8:11], s59 offen offset:0 sc1
  s_waitcnt lgkmcnt(4)
  v_smfmac_f32_16x16x64_bf16 v[32:35], v[0:3], v[60:67], v74
  ds_read_b128 v[60:63], v76 offset:51200
  s_waitcnt lgkmcnt(4)
  v_smfmac_f32_16x16x64_bf16 v[20:23], v[8:11], v[96:103], v74
  buffer_load_dwordx4 v[56:59], v76, s[8:11], s59 offen offset:1024 sc1
  ds_read_b128 v[64:67], v76 offset:52224
  v_smfmac_f32_16x16x64_bf16 v[24:27], v[8:11], v[104:111], v74
  buffer_store_dwordx4 v[16:19], v76, s[8:11], s68 offen sc1
  ds_read_b128 v[0:3], v76 offset:12800
  s_waitcnt lgkmcnt(4)
  v_smfmac_f32_16x16x64_bf16 v[28:31], v[8:11], v[36:43], v74
  ds_read_b128 v[36:39], v75 offset:0
  s_waitcnt lgkmcnt(4)
  v_smfmac_f32_16x16x64_bf16 v[20:23], v[12:15], v[112:119], v74
  ds_read_b128 v[40:43], v75 offset:1024
  v_smfmac_f32_16x16x64_bf16 v[24:27], v[12:15], v[120:127], v74
  buffer_load_dword v73, s[8:11], s70 offen lds
  s_waitcnt lgkmcnt(3)
  v_smfmac_f32_16x16x64_bf16 v[32:35], v[8:11], v[60:67], v74
  ds_read_b128 v[60:63], v75 offset:2048
  v_smfmac_f32_16x16x64_bf16 v[28:31], v[12:15], v[224:231], v74
  ds_read_b128 v[64:67], v75 offset:3072
  v_smfmac_f32_16x16x64_bf16 v[32:35], v[12:15], v[232:239], v74
  s_barrier
  s_waitcnt lgkmcnt(4)
  v_smfmac_f32_16x16x64_bf16 v[20:23], v[0:3], v[192:199], v74
  ds_read_b128 v[4:7], v76 offset:8704
  s_waitcnt lgkmcnt(3)
  v_smfmac_f32_16x16x64_bf16 v[28:31], v[0:3], v[36:43], v74
  ds_read_b128 v[16:19], v76 offset:9728
  v_smfmac_f32_16x16x64_bf16 v[24:27], v[0:3], v[200:207], v74
  ds_read_b128 v[36:39], v75 offset:16384
  s_waitcnt lgkmcnt(3)
  v_mov_b32 v68, 0x3f803f80
  v_smfmac_f32_16x16x64_bf16 v[32:35], v[0:3], v[60:67], v74
  ds_read_b128 v[40:43], v75 offset:17408
  s_waitcnt lgkmcnt(3)
  v_smfmac_f32_16x16x64_bf16 v[20:23], v[4:7], v[128:135], v74
  ds_read_b128 v[12:15], v76 offset:10752
  v_mov_b32 v69, 0x3f803f80
  v_smfmac_f32_16x16x64_bf16 v[24:27], v[4:7], v[136:143], v74
  ds_read_b128 v[8:11], v76 offset:11776
  s_waitcnt lgkmcnt(4)
  v_smfmac_f32_16x16x64_bf16 v[20:23], v[16:19], v[144:151], v74
  ds_read_b128 v[60:63], v75 offset:18432
  v_mov_b64 v[70:71], v[68:69]
  v_smfmac_f32_16x16x64_bf16 v[24:27], v[16:19], v[152:159], v74
  ds_read_b128 v[64:67], v75 offset:19456
  s_waitcnt lgkmcnt(4)
  v_smfmac_f32_16x16x64_bf16 v[28:31], v[4:7], v[36:43], v74
  s_waitcnt lgkmcnt(3)
  v_mov_b64 v[36:37], 0
  v_smfmac_f32_16x16x64_bf16 v[20:23], v[12:15], v[160:167], v74
  s_waitcnt lgkmcnt(2)
  v_mov_b64 v[38:39], 0
  v_smfmac_f32_16x16x64_bf16 v[20:23], v[8:11], v[176:183], v74
  v_mov_b64 v[40:41], 0
  v_smfmac_f32_16x16x64_bf16 v[24:27], v[12:15], v[168:175], v74
  v_mov_b64 v[42:43], 0
  v_smfmac_f32_16x16x64_bf16 v[24:27], v[8:11], v[184:191], v74
  s_waitcnt lgkmcnt(0)
  v_add_f32 v20, v20, v22
  v_smfmac_f32_16x16x64_bf16 v[32:35], v[4:7], v[60:67], v74
  v_add_f32 v21, v21, v23
  v_smfmac_f32_16x16x64_bf16 v[28:31], v[16:19], v[240:247], v74
  v_add_f32 v24, v24, v26
  v_cvt_pk_bf16_f32 v22, v20, v24
  v_smfmac_f32_16x16x64_bf16 v[28:31], v[12:15], a[0:7], v74
  ds_write_b32 v79, v22 offset:0
  v_add_f32 v25, v25, v27
  v_cvt_pk_bf16_f32 v23, v21, v25
  v_smfmac_f32_16x16x64_bf16 v[28:31], v[8:11], a[16:23], v74
  ds_write_b32 v79, v23 offset:576
  v_cmp_u_f32 vcc, v20, v21
  v_smfmac_f32_16x16x64_bf16 v[32:35], v[16:19], v[248:255], v74
  v_smfmac_f32_16x16x64_bf16 v[32:35], v[12:15], a[8:15], v74
  v_add_f32 v28, v28, v30
  v_add_f32 v29, v29, v31
  v_smfmac_f32_16x16x64_bf16 v[32:35], v[8:11], a[24:31], v74
  s_cbranch_vccnz Cf0_rec
Cf0_recok:
  v_smfmac_f32_16x16x64_bf16 v[36:39], v[16:19], a[112:119], v74
  s_waitcnt lgkmcnt(0)
  s_barrier
  ds_read_b128 v[60:63], v77
  v_smfmac_f32_16x16x64_bf16 v[40:43], v[16:19], a[120:127], v74
  ds_read_b128 v[64:67], v77 offset:128
  v_add_f32 v32, v32, v34
  v_cvt_pk_bf16_f32 v30, v28, v32
  v_smfmac_f32_16x16x64_bf16 v[36:39], v[0:3], a[160:167], v74
  ds_write_b32 v79, v30 offset:256
  v_add_f32 v33, v33, v35
  v_cvt_pk_bf16_f32 v31, v29, v33
  v_smfmac_f32_16x16x64_bf16 v[40:43], v[0:3], a[168:175], v74
  ds_write_b32 v79, v31 offset:832
  v_xor_b32 v75, 0x8000, v75
  v_smfmac_f32_16x16x64_bf16 v[36:39], v[4:7], a[96:103], v74
  ds_read_b128 v[0:3], v76 offset:4608
  v_mov_b32 v29, 0
  v_smfmac_f32_16x16x64_bf16 v[40:43], v[4:7], a[104:111], v74
  s_waitcnt vmcnt(4) lgkmcnt(3)
  v_mov_b32 v30, 0
  v_mfma_f32_16x16x32_bf16 v[44:47], v[44:47], v[60:63], 0
  ds_read_b128 v[4:7], v76 offset:5632
  s_waitcnt lgkmcnt(2)
  v_mfma_f32_16x16x32_bf16 v[44:47], v[48:51], v[64:67], v[44:47]
  s_barrier
  v_smfmac_f32_16x16x64_bf16 v[36:39], v[8:11], a[144:151], v74
  ds_read_b128 v[20:23], v77 offset:256
  ds_read_b128 v[24:27], v77 offset:384
  v_smfmac_f32_16x16x64_bf16 v[40:43], v[8:11], a[152:159], v74
  ds_read_b128 v[8:11], v76 offset:6656
  v_add_f32_dpp v72, v46, v44 quad_perm:[2,3,0,1] row_mask:0xf bank_mask:0xf
  v_add_f32_dpp v73, v47, v45 quad_perm:[2,3,0,1] row_mask:0xf bank_mask:0xf
  v_smfmac_f32_16x16x64_bf16 v[36:39], v[12:15], a[128:135], v74
  ds_read_b128 v[44:47], v75 offset:0
  v_exp_f32_dpp v72, v72 quad_perm:[0,1,0,1] row_mask:0xf bank_mask:0xf
  v_smfmac_f32_16x16x64_bf16 v[40:43], v[12:15], a[136:143], v74
  ds_read_b128 v[12:15], v76 offset:7680
  s_waitcnt lgkmcnt(6)
  v_exp_f32_dpp v73, v73 quad_perm:[0,1,0,1] row_mask:0xf bank_mask:0xf
  v_smfmac_f32_16x16x64_bf16 v[36:39], v[0:3], a[32:39], v74
  s_waitcnt lgkmcnt(3)
  v_cvt_pk_bf16_f32 v72, v72, v73
  v_mfma_f32_16x16x32_bf16 v[20:23], v[20:23], v[60:63], 0
  ds_write_b32 v78, v72 offset:512
  v_mfma_f32_16x16x32_bf16 v[20:23], v[24:27], v[64:67], v[20:23]
  ds_read_b128 v[48:51], v75 offset:1024
  v_smfmac_f32_16x16x64_bf16 v[40:43], v[0:3], a[40:47], v74
  ds_read_b128 v[60:63], v75 offset:2048
  v_smfmac_f32_16x16x64_bf16 v[36:39], v[4:7], a[48:55], v74
  s_waitcnt lgkmcnt(5)
  v_add_f32_dpp v24, v22, v20 quad_perm:[2,3,0,1] row_mask:0xf bank_mask:0xf
  v_add_f32_dpp v25, v23, v21 quad_perm:[2,3,0,1] row_mask:0xf bank_mask:0xf
  v_smfmac_f32_16x16x64_bf16 v[36:39], v[8:11], a[64:71], v74
  s_waitcnt lgkmcnt(2)
  s_barrier
  ds_read_b128 v[32:35], v78 offset:512
  v_smfmac_f32_16x16x64_bf16 v[36:39], v[12:15], a[80:87], v74
  ds_read_b128 v[64:67], v75 offset:3072
  v_mul_f32 v24, s69, v24
  v_smfmac_f32_16x16x64_bf16 v[40:43], v[4:7], a[56:63], v74
  v_mul_f32 v25, s69, v25
  v_smfmac_f32_16x16x64_bf16 v[40:43], v[8:11], a[72:79], v74
  v_exp_f32_dpp v24, v24 quad_perm:[0,1,0,1] row_mask:0xf bank_mask:0xf
  v_smfmac_f32_16x16x64_bf16 v[40:43], v[12:15], a[88:95], v74
  s_waitcnt vmcnt(2) lgkmcnt(1)
  v_exp_f32_dpp v25, v25 quad_perm:[0,1,0,1] row_mask:0xf bank_mask:0xf
  v_mfma_f32_16x16x32_bf16 v[8:11], v[32:35], v[68:71], 0
  v_add_f32 v36, v36, v38
  v_add_f32 v37, v37, v39
  v_mfma_f32_16x16x32_bf16 v[0:3], v[32:35], v[52:55], 0
  v_add_f32 v40, v40, v42
  v_add_f32 v41, v41, v43
  v_mfma_f32_16x16x32_bf16 v[4:7], v[32:35], v[56:59], 0
  v_cvt_pk_bf16_f32 v28, v24, v25
  v_cvt_pk_bf16_f32 v72, v36, v37
  v_cvt_pk_bf16_f32 v73, v40, v41
  v_mfma_f32_16x16x16_bf16 v[8:11], v[28:29], v[68:69], v[8:11]
  v_cvt_pk_bf16_f32 v31, v24, v25
  v_mfma_f32_16x16x16_bf16 v[0:3], v[28:29], v[72:73], v[0:3]
  ds_read_b128 v[68:71], v76 offset:13824
  v_mfma_f32_16x16x16_bf16 v[4:7], v[30:31], v[72:73], v[4:7]
  v_rcp_f32 v10, v8
  v_rcp_f32 v11, v9
  v_mul_f32 v0, v10, v0
  v_mul_f32 v1, v11, v1
  s_nop 0
  v_mul_f32 v4, v10, v4
  v_mul_f32 v5, v11, v5
  v_cvt_pk_bf16_f32 v2, v0, v4
  ds_write_b32 v79, v2 offset:8704
  v_cvt_pk_bf16_f32 v3, v1, v5
  ds_write_b32 v79, v3 offset:9280
  v_subrev_u32 v8, 813694976, v8
  v_subrev_u32 v9, 813694976, v9
  v_max_u32 v8, v8, v9
  v_cmp_le_u32 vcc, 503316480, v8
  v_mov_b64 v[16:17], 0
  v_mov_b64 v[18:19], 0
  v_mov_b64 v[20:21], 0
  v_mov_b64 v[22:23], 0
  s_cbranch_vccnz Cf0_mx
Cf0_mxok:
  s_cmp_eq_u32 s66, 63
  s_waitcnt lgkmcnt(0)
  s_barrier
  ds_read_b128 v[0:3], v78 offset:8704
  ds_read_b128 v[4:7], v78 offset:8768
  ds_read_b128 v[8:11], v78 offset:8832
  ds_read_b128 v[12:15], v78 offset:8896
  v_mov_b64 v[24:25], 0
  v_mov_b64 v[26:27], 0
  v_mov_b64 v[28:29], 0
  v_mov_b64 v[30:31], 0
  v_mov_b64 v[32:33], 0
  v_mov_b64 v[34:35], 0
  s_waitcnt lgkmcnt(3)
  v_smfmac_f32_16x16x64_bf16 v[16:19], v[0:3], a[176:183], v74
  s_cbranch_scc1 Cf0_last
  s_waitcnt lgkmcnt(2)
  v_smfmac_f32_16x16x64_bf16 v[16:19], v[4:7], a[184:191], v74
  s_waitcnt lgkmcnt(1)
  v_smfmac_f32_16x16x64_bf16 v[16:19], v[8:11], a[192:199], v74
  ds_read_b128 v[52:55], v75 offset:16384
  s_waitcnt lgkmcnt(1)
  v_smfmac_f32_16x16x64_bf16 v[16:19], v[12:15], a[200:207], v74
  ds_read_b128 v[56:59], v75 offset:17408
  v_smfmac_f32_16x16x64_bf16 v[20:23], v[0:3], a[208:215], v74
  ds_read_b128 v[36:39], v75 offset:18432
  v_smfmac_f32_16x16x64_bf16 v[20:23], v[4:7], a[216:223], v74
  ds_read_b128 v[40:43], v75 offset:19456
  v_cvt_pk_bf16_f32 v16, v16, v17
  v_cvt_pk_bf16_f32 v17, v18, v19
  v_bfi_b32 v16, 1, s72, v16
  v_smfmac_f32_16x16x64_bf16 v[20:23], v[8:11], v[44:51], v74
  ds_read_b128 v[44:47], v75 offset:32768
  buffer_store_dwordx2 v[16:17], v68, s[8:11], s73 offen
  v_smfmac_f32_16x16x64_bf16 v[20:23], v[12:15], v[60:67], v74
  ds_read_b128 v[48:51], v75 offset:33792
  v_smfmac_f32_16x16x64_bf16 v[24:27], v[0:3], a[224:231], v74
  ds_read_b128 v[60:63], v75 offset:34816
  v_smfmac_f32_16x16x64_bf16 v[24:27], v[4:7], a[232:239], v74
  ds_read_b128 v[64:67], v75 offset:35840
  s_waitcnt lgkmcnt(6)
  v_cvt_pk_bf16_f32 v20, v20, v21
  v_cvt_pk_bf16_f32 v21, v22, v23
  v_bfi_b32 v20, 1, s72, v20
  v_smfmac_f32_16x16x64_bf16 v[24:27], v[8:11], v[52:59], v74
  buffer_store_dwordx2 v[20:21], v68, s[8:11], s74 offen
  s_waitcnt lgkmcnt(4)
  v_mov_b64 v[18:19], v[72:73]
  v_smfmac_f32_16x16x64_bf16 v[24:27], v[12:15], v[36:43], v74
  v_mov_b64 v[20:21], 0
  v_smfmac_f32_16x16x64_bf16 v[28:31], v[0:3], a[240:247], v74
  v_mov_b64 v[22:23], 0
  v_smfmac_f32_16x16x64_bf16 v[28:31], v[4:7], a[248:255], v74
  s_waitcnt lgkmcnt(2)
  v_cvt_pk_bf16_f32 v24, v24, v25
  v_cvt_pk_bf16_f32 v25, v26, v27
  v_bfi_b32 v24, 1, s72, v24
  v_smfmac_f32_16x16x64_bf16 v[28:31], v[8:11], v[44:51], v74
  buffer_store_dwordx2 v[24:25], v68, s[8:11], s75 offen
  s_waitcnt lgkmcnt(0)
  v_smfmac_f32_16x16x64_bf16 v[28:31], v[12:15], v[60:67], v74
  ds_read_b64 v[16:17], v77 offset:256
  v_xor_b32 v75, 0x8000, v75
  ds_read_b128 v[52:55], v76 offset:14848
  s_nop 3
  v_cvt_pk_bf16_f32 v28, v28, v29
  v_cvt_pk_bf16_f32 v29, v30, v31
  v_bfi_b32 v28, 1, s72, v28
  buffer_store_dwordx2 v[28:29], v68, s[8:11], s76 offen
  v_mov_b64 v[24:25], 0
  v_mov_b64 v[26:27], 0
  v_mov_b64 v[28:29], 0
  v_mov_b64 v[30:31], 0
  s_add_u32 s58, s58, 524288
  s_add_u32 s59, s59, 524288
  s_add_u32 s70, s70, 524288
  s_add_u32 s68, s68, 131072
  s_add_u32 s66, s66, 1
  s_xor_b32 s64, s64, 16384
  s_xor_b32 s65, s65, 16384
  s_nop 15
  s_nop 7
  buffer_load_dwordx4 v[0:3], v76, s[8:11], s60 offen offset:0 sc1
  buffer_load_dwordx4 v[4:7], v76, s[8:11], s60 offen offset:1024 sc1
  buffer_load_dwordx4 v[8:11], v76, s[8:11], s61 offen offset:0 sc1
  buffer_load_dwordx4 v[12:15], v76, s[8:11], s61 offen offset:1024 sc1
  s_nop 15
  s_nop 11
  buffer_load_dwordx4 v[44:47], v76, s[8:11], s60 offen offset:0 sc1
  buffer_load_dwordx4 v[48:51], v76, s[8:11], s60 offen offset:1024 sc1
  buffer_load_dwordx4 v[60:63], v76, s[8:11], s61 offen offset:0 sc1
  buffer_load_dwordx4 v[64:67], v76, s[8:11], s61 offen offset:1024 sc1
  s_waitcnt vmcnt(7) lgkmcnt(0)
  v_mfma_f32_16x16x32_bf16 v[56:59], v[52:55], v[0:3], 0
  v_bitop3_b32 v72, v0, v2, s72 bitop3:0x7e
  s_waitcnt vmcnt(6)
  v_mfma_f32_16x16x32_bf16 v[56:59], v[52:55], v[4:7], v[56:59]
  v_bitop3_b32 v73, v4, v6, s72 bitop3:0x7e
  v_or_b32 v72, v72, v73
  s_waitcnt vmcnt(5)
  v_mfma_f32_16x16x32_bf16 v[36:39], v[52:55], v[8:11], 0
  v_bitop3_b32 v73, v8, v10, s72 bitop3:0x7e
  v_or_b32 v72, v72, v73
  s_waitcnt vmcnt(4)
  v_mfma_f32_16x16x32_bf16 v[36:39], v[52:55], v[12:15], v[36:39]
  v_bitop3_b32 v73, v12, v14, s72 bitop3:0x7e
  v_bitop3_b32 v72, v72, v73, 1 bitop3:0xa8
  v_cmp_ne_u32 vcc, 0, v72
  s_cbranch_vccnz Cf0_h1r
Cf0_h1p:
  v_add_f32_dpp v56, v56, v56 row_ror:4 row_mask:0xf bank_mask:0xf
  v_add_f32_dpp v57, v57, v57 row_ror:4 row_mask:0xf bank_mask:0xf
  s_nop 0
  v_add_f32_dpp v56, v56, v56 row_ror:8 row_mask:0xf bank_mask:0xf
  v_add_f32_dpp v57, v57, v57 row_ror:8 row_mask:0xf bank_mask:0xf
  v_cvt_pk_bf16_f32 v56, v56, v57
  buffer_store_dword v56, v69, s[8:11], s62 offen
  v_add_f32_dpp v36, v36, v36 row_ror:4 row_mask:0xf bank_mask:0xf
  v_add_f32_dpp v37, v37, v37 row_ror:4 row_mask:0xf bank_mask:0xf
  s_nop 0
  v_add_f32_dpp v36, v36, v36 row_ror:8 row_mask:0xf bank_mask:0xf
  v_add_f32_dpp v37, v37, v37 row_ror:8 row_mask:0xf bank_mask:0xf
  v_cvt_pk_bf16_f32 v36, v36, v37
  buffer_store_dword v36, v70, s[8:11], s63 offen
Cf0_h1ok:
  s_xor_b32 s62, s62, 16384
  s_xor_b32 s63, s63, 16384
  s_xor_b32 s72, s72, 1
  s_nop 15
  s_nop 7
Cf0_h2:
  v_lshlrev_b32 v73, 2, v76
  buffer_load_dwordx4 v[52:55], v76, s[8:11], s64 offen offset:0 sc1
  buffer_load_dwordx4 v[56:59], v76, s[8:11], s64 offen offset:1024 sc1
  buffer_load_dwordx4 v[12:15], v76, s[8:11], s65 offen offset:0 sc1
  s_nop 15
  s_nop 1
  buffer_load_dwordx4 v[52:55], v76, s[8:11], s64 offen offset:0 sc1
  buffer_load_dwordx4 v[56:59], v76, s[8:11], s64 offen offset:1024 sc1
  buffer_load_dwordx4 v[12:15], v76, s[8:11], s65 offen offset:0 sc1
  s_nop 15
  s_nop 1
  buffer_load_dwordx4 v[52:55], v76, s[8:11], s64 offen offset:0 sc1
  buffer_load_dwordx4 v[56:59], v76, s[8:11], s64 offen offset:1024 sc1
  buffer_load_dwordx4 v[12:15], v76, s[8:11], s65 offen offset:0 sc1
  s_waitcnt vmcnt(11)
  ds_read_b128 v[60:63], v76 offset:16384
  ds_read_b128 v[64:67], v76 offset:17408
  ds_read_b128 v[44:47], v76 offset:18432
  ds_read_b128 v[48:51], v76 offset:19456
  ds_read_b128 v[36:39], v76 offset:32768
  ds_read_b128 v[40:43], v76 offset:33792
  s_waitcnt vmcnt(6)
  v_max3_u32 v72, v52, v53, v54
  v_max3_u32 v72, v72, v55, v56
  v_max3_u32 v72, v72, v57, v58
  v_max3_u32 v72, v72, v59, v12
  v_max3_u32 v72, v72, v13, v14
  v_max_u32 v72, v72, v15
  ds_write_b128 v76, v[52:55] offset:4608
  ds_write_b128 v76, v[56:59] offset:5632
  ds_write_b128 v76, v[12:15] offset:12800
  v_cmp_eq_u32 vcc, -1, v72
  s_cbranch_vccnz Cf0_h2r
Cf0_h2w:
  buffer_store_dword v71, v69, s[8:11], s62 offen
  buffer_store_dword v71, v70, s[8:11], s63 offen
  s_branch Cf0_top
Cf0_rec:
  s_nop 7
  s_waitcnt vmcnt(0) lgkmcnt(0)
  v_max3_u32 v72, v0, v1, v2
  v_max3_u32 v72, v72, v3, v4
  v_max3_u32 v72, v72, v5, v6
  v_max3_u32 v72, v72, v7, v8
  v_max3_u32 v72, v72, v9, v10
  v_max3_u32 v72, v72, v11, v12
  v_max3_u32 v72, v72, v13, v14
  v_max3_u32 v72, v72, v15, v16
  v_max3_u32 v72, v72, v17, v18
  v_max_u32 v72, v72, v19
  v_cmp_eq_u32 vcc, -1, v72
  s_cbranch_vccz Cf0_recok
  s_barrier
  v_mov_b64 v[20:21], 0
  v_mov_b64 v[22:23], 0
  v_mov_b64 v[24:25], 0
  v_mov_b64 v[26:27], 0
  v_mov_b64 v[28:29], 0
  v_mov_b64 v[30:31], 0
  v_mov_b64 v[32:33], 0
  v_mov_b64 v[34:35], 0
  s_waitcnt lgkmcnt(0)
  s_barrier
  ds_read_b128 v[0:3], v76 offset:4608
  ds_read_b128 v[60:63], v76 offset:16384
  ds_read_b128 v[64:67], v76 offset:17408
  s_waitcnt lgkmcnt(0)
  v_smfmac_f32_16x16x64_bf16 v[20:23], v[0:3], v[60:67], v74
  ds_read_b128 v[60:63], v76 offset:18432
  ds_read_b128 v[64:67], v76 offset:19456
  s_waitcnt lgkmcnt(0)
  v_smfmac_f32_16x16x64_bf16 v[24:27], v[0:3], v[60:67], v74
  ds_read_b128 v[60:63], v76 offset:32768
  ds_read_b128 v[64:67], v76 offset:33792
  s_waitcnt lgkmcnt(0)
  v_smfmac_f32_16x16x64_bf16 v[28:31], v[0:3], v[60:67], v74
  ds_read_b128 v[60:63], v76 offset:34816
  ds_read_b128 v[64:67], v76 offset:35840
  s_waitcnt lgkmcnt(0)
  v_smfmac_f32_16x16x64_bf16 v[32:35], v[0:3], v[60:67], v74
  ds_read_b128 v[4:7], v76 offset:5632
  s_waitcnt lgkmcnt(0)
  v_smfmac_f32_16x16x64_bf16 v[20:23], v[4:7], v[80:87], v74
  v_smfmac_f32_16x16x64_bf16 v[24:27], v[4:7], v[88:95], v74
  v_smfmac_f32_16x16x64_bf16 v[28:31], v[4:7], v[208:215], v74
  v_smfmac_f32_16x16x64_bf16 v[32:35], v[4:7], v[216:223], v74
  ds_read_b128 v[8:11], v76 offset:6656
  s_waitcnt lgkmcnt(0)
  v_smfmac_f32_16x16x64_bf16 v[20:23], v[8:11], v[96:103], v74
  v_smfmac_f32_16x16x64_bf16 v[24:27], v[8:11], v[104:111], v74
  ds_read_b128 v[60:63], v76 offset:49152
  ds_read_b128 v[64:67], v76 offset:50176
  s_waitcnt lgkmcnt(0)
  v_smfmac_f32_16x16x64_bf16 v[28:31], v[8:11], v[60:67], v74
  ds_read_b128 v[60:63], v76 offset:51200
  ds_read_b128 v[64:67], v76 offset:52224
  s_waitcnt lgkmcnt(0)
  v_smfmac_f32_16x16x64_bf16 v[32:35], v[8:11], v[60:67], v74
  ds_read_b128 v[12:15], v76 offset:7680
  s_waitcnt lgkmcnt(0)
  v_smfmac_f32_16x16x64_bf16 v[20:23], v[12:15], v[112:119], v74
  v_smfmac_f32_16x16x64_bf16 v[24:27], v[12:15], v[120:127], v74
  v_smfmac_f32_16x16x64_bf16 v[28:31], v[12:15], v[224:231], v74
  v_smfmac_f32_16x16x64_bf16 v[32:35], v[12:15], v[232:239], v74
  ds_read_b128 v[4:7], v76 offset:8704
  s_waitcnt lgkmcnt(0)
  v_smfmac_f32_16x16x64_bf16 v[20:23], v[4:7], v[128:135], v74
  v_smfmac_f32_16x16x64_bf16 v[24:27], v[4:7], v[136:143], v74
  ds_read_b128 v[60:63], v75 offset:16384
  ds_read_b128 v[64:67], v75 offset:17408
  s_waitcnt lgkmcnt(0)
  v_smfmac_f32_16x16x64_bf16 v[28:31], v[4:7], v[60:67], v74
  ds_read_b128 v[60:63], v75 offset:18432
  ds_read_b128 v[64:67], v75 offset:19456
  s_waitcnt lgkmcnt(0)
  v_smfmac_f32_16x16x64_bf16 v[32:35], v[4:7], v[60:67], v74
  ds_read_b128 v[16:19], v76 offset:9728
  s_waitcnt lgkmcnt(0)
  v_smfmac_f32_16x16x64_bf16 v[20:23], v[16:19], v[144:151], v74
  v_smfmac_f32_16x16x64_bf16 v[24:27], v[16:19], v[152:159], v74
  v_smfmac_f32_16x16x64_bf16 v[28:31], v[16:19], v[240:247], v74
  v_smfmac_f32_16x16x64_bf16 v[32:35], v[16:19], v[248:255], v74
  ds_read_b128 v[12:15], v76 offset:10752
  s_waitcnt lgkmcnt(0)
  v_smfmac_f32_16x16x64_bf16 v[20:23], v[12:15], v[160:167], v74
  v_smfmac_f32_16x16x64_bf16 v[24:27], v[12:15], v[168:175], v74
  v_smfmac_f32_16x16x64_bf16 v[28:31], v[12:15], a[0:7], v74
  v_smfmac_f32_16x16x64_bf16 v[32:35], v[12:15], a[8:15], v74
  ds_read_b128 v[8:11], v76 offset:11776
  s_waitcnt lgkmcnt(0)
  v_smfmac_f32_16x16x64_bf16 v[20:23], v[8:11], v[176:183], v74
  v_smfmac_f32_16x16x64_bf16 v[24:27], v[8:11], v[184:191], v74
  v_smfmac_f32_16x16x64_bf16 v[28:31], v[8:11], a[16:23], v74
  v_smfmac_f32_16x16x64_bf16 v[32:35], v[8:11], a[24:31], v74
  ds_read_b128 v[0:3], v76 offset:12800
  s_waitcnt lgkmcnt(0)
  v_smfmac_f32_16x16x64_bf16 v[20:23], v[0:3], v[192:199], v74
  v_smfmac_f32_16x16x64_bf16 v[24:27], v[0:3], v[200:207], v74
  ds_read_b128 v[60:63], v75 offset:0
  ds_read_b128 v[64:67], v75 offset:1024
  s_waitcnt lgkmcnt(0)
  v_smfmac_f32_16x16x64_bf16 v[28:31], v[0:3], v[60:67], v74
  ds_read_b128 v[60:63], v75 offset:2048
  ds_read_b128 v[64:67], v75 offset:3072
  s_waitcnt lgkmcnt(0)
  v_smfmac_f32_16x16x64_bf16 v[32:35], v[0:3], v[60:67], v74
  v_add_f32 v20, v20, v22
  v_add_f32 v21, v21, v23
  v_add_f32 v24, v24, v26
  v_cvt_pk_bf16_f32 v22, v20, v24
  ds_write_b32 v79, v22 offset:0
  v_add_f32 v25, v25, v27
  v_cvt_pk_bf16_f32 v23, v21, v25
  ds_write_b32 v79, v23 offset:576
  v_add_f32 v28, v28, v30
  v_add_f32 v29, v29, v31
  s_waitcnt lgkmcnt(0)
  s_nop 1
  s_branch Cf0_recok
Cf0_mx:
  s_waitcnt lgkmcnt(0)
  s_barrier
  buffer_load_dwordx4 v[0:3], v76, s[8:11], s58 offen offset:0 sc1
  ds_read_b128 v[20:23], v77 offset:0
  ds_read_b128 v[28:31], v77 offset:256
  buffer_load_dwordx4 v[4:7], v76, s[8:11], s58 offen offset:1024 sc1
  ds_read_b128 v[24:27], v77 offset:128
  ds_read_b128 v[32:35], v77 offset:384
  s_waitcnt vmcnt(1) lgkmcnt(3)
  v_mfma_f32_16x16x32_bf16 v[8:11], v[0:3], v[20:23], 0
  s_waitcnt vmcnt(0) lgkmcnt(1)
  v_mfma_f32_16x16x32_bf16 v[8:11], v[4:7], v[24:27], v[8:11]
  v_mfma_f32_16x16x32_bf16 v[12:15], v[28:31], v[20:23], 0
  s_waitcnt lgkmcnt(0)
  v_mfma_f32_16x16x32_bf16 v[12:15], v[32:35], v[24:27], v[12:15]
  v_add_f32_dpp v8, v10, v8 quad_perm:[2,3,0,1] row_mask:0xf bank_mask:0xf
  v_add_f32_dpp v9, v11, v9 quad_perm:[2,3,0,1] row_mask:0xf bank_mask:0xf
  s_nop 0
  v_mov_b32_dpp v8, v8 quad_perm:[0,1,0,1] row_mask:0xf bank_mask:0xf
  v_mov_b32_dpp v9, v9 quad_perm:[0,1,0,1] row_mask:0xf bank_mask:0xf
  s_nop 1
  v_add_f32_dpp v12, v14, v12 quad_perm:[2,3,0,1] row_mask:0xf bank_mask:0xf
  v_add_f32_dpp v13, v15, v13 quad_perm:[2,3,0,1] row_mask:0xf bank_mask:0xf
  s_nop 0
  v_mov_b32_dpp v12, v12 quad_perm:[0,1,0,1] row_mask:0xf bank_mask:0xf
  v_mov_b32_dpp v13, v13 quad_perm:[0,1,0,1] row_mask:0xf bank_mask:0xf
  v_mul_f32 v12, s69, v12
  ds_write_b32 v78, v8 offset:8704
  v_mul_f32 v13, s69, v13
  ds_write_b32 v78, v9 offset:8768
  s_waitcnt lgkmcnt(0)
  s_barrier
  ds_read_b128 v[36:39], v78 offset:8704
  ds_read_b128 v[40:43], v78 offset:8768
  s_waitcnt lgkmcnt(0)
  s_barrier
  v_max_f32 v16, v36, v37
  v_max3_f32 v16, v16, v38, v39
  v_max3_f32 v16, v16, v40, v41
  v_max3_f32 v16, v16, v42, v43
  v_max3_f32 v16, v16, v12, v13
  v_mov_b32 v17, v16
  s_nop 1
  v_permlane16_swap_b32 v16, v17
  v_max_f32 v16, v16, v17
  v_mov_b32 v17, v16
  s_nop 1
  v_permlane32_swap_b32 v16, v17
  v_max_f32 v16, v16, v17
  v_sub_f32 v36, v36, v16
  v_sub_f32 v37, v37, v16
  v_sub_f32 v38, v38, v16
  v_sub_f32 v39, v39, v16
  v_sub_f32 v40, v40, v16
  v_sub_f32 v41, v41, v16
  v_sub_f32 v42, v42, v16
  v_sub_f32 v43, v43, v16
  v_sub_f32 v12, v12, v16
  v_sub_f32 v13, v13, v16
  v_exp_f32 v36, v36
  v_exp_f32 v37, v37
  v_exp_f32 v38, v38
  v_exp_f32 v39, v39
  v_exp_f32 v40, v40
  v_exp_f32 v41, v41
  v_exp_f32 v42, v42
  v_exp_f32 v43, v43
  v_exp_f32 v12, v12
  v_exp_f32 v13, v13
  v_cvt_pk_bf16_f32 v32, v36, v40
  v_cvt_pk_bf16_f32 v33, v37, v41
  v_cvt_pk_bf16_f32 v34, v38, v42
  v_cvt_pk_bf16_f32 v35, v39, v43
  v_cvt_pk_bf16_f32 v28, v12, v13
  v_cvt_pk_bf16_f32 v31, v12, v13
  v_mov_b32 v29, 0
  v_mov_b32 v30, 0
  v_mov_b32 v68, 0x3f803f80
  v_mov_b32 v69, 0x3f803f80
  v_mov_b32 v70, 0x3f803f80
  v_mov_b32 v71, 0x3f803f80
  s_nop 1
  v_mfma_f32_16x16x32_bf16 v[8:11], v[32:35], v[68:71], 0
  v_mfma_f32_16x16x32_bf16 v[0:3], v[32:35], v[52:55], 0
  v_mfma_f32_16x16x32_bf16 v[4:7], v[32:35], v[56:59], 0
  v_mfma_f32_16x16x16_bf16 v[8:11], v[28:29], v[68:69], v[8:11]
  v_mfma_f32_16x16x16_bf16 v[0:3], v[28:29], v[72:73], v[0:3]
  v_mfma_f32_16x16x16_bf16 v[4:7], v[30:31], v[72:73], v[4:7]
  ds_read_b128 v[68:71], v76 offset:13824
  v_rcp_f32 v10, v8
  v_rcp_f32 v11, v9
  v_mul_f32 v0, v10, v0
  v_mul_f32 v1, v11, v1
  s_nop 0
  v_mul_f32 v4, v10, v4
  v_mul_f32 v5, v11, v5
  v_cvt_pk_bf16_f32 v2, v0, v4
  ds_write_b32 v79, v2 offset:8704
  v_cvt_pk_bf16_f32 v3, v1, v5
  ds_write_b32 v79, v3 offset:9280
  v_mov_b64 v[16:17], 0
  v_mov_b64 v[18:19], 0
  v_mov_b64 v[20:21], 0
  v_mov_b64 v[22:23], 0
  s_branch Cf0_mxok
Cf0_h1r:
  s_mov_b64 exec, vcc
  buffer_load_dwordx4 v[0:3], v76, s[8:11], s60 offen offset:0 sc1
  buffer_load_dwordx4 v[4:7], v76, s[8:11], s60 offen offset:1024 sc1
  buffer_load_dwordx4 v[8:11], v76, s[8:11], s61 offen offset:0 sc1
  buffer_load_dwordx4 v[12:15], v76, s[8:11], s61 offen offset:1024 sc1
  s_mov_b64 exec, -1
  s_add_u32 s67, s67, 1
  s_waitcnt vmcnt(7)
  v_mfma_f32_16x16x32_bf16 v[56:59], v[52:55], v[44:47], 0
  v_bitop3_b32 v72, v44, v46, s72 bitop3:0x7e
  s_waitcnt vmcnt(6)
  v_mfma_f32_16x16x32_bf16 v[56:59], v[52:55], v[48:51], v[56:59]
  v_bitop3_b32 v73, v48, v50, s72 bitop3:0x7e
  v_or_b32 v72, v72, v73
  s_waitcnt vmcnt(5)
  v_mfma_f32_16x16x32_bf16 v[36:39], v[52:55], v[60:63], 0
  v_bitop3_b32 v73, v60, v62, s72 bitop3:0x7e
  v_or_b32 v72, v72, v73
  s_waitcnt vmcnt(4)
  v_mfma_f32_16x16x32_bf16 v[36:39], v[52:55], v[64:67], v[36:39]
  v_bitop3_b32 v73, v64, v66, s72 bitop3:0x7e
  v_bitop3_b32 v72, v72, v73, 1 bitop3:0xa8
  v_cmp_ne_u32 vcc, 0, v72
  s_cbranch_vccz Cf0_h1p
  s_mov_b64 exec, vcc
  buffer_load_dwordx4 v[44:47], v76, s[8:11], s60 offen offset:0 sc1
  buffer_load_dwordx4 v[48:51], v76, s[8:11], s60 offen offset:1024 sc1
  buffer_load_dwordx4 v[60:63], v76, s[8:11], s61 offen offset:0 sc1
  buffer_load_dwordx4 v[64:67], v76, s[8:11], s61 offen offset:1024 sc1
  s_mov_b64 exec, -1
  s_add_u32 s67, s67, 1
  s_waitcnt vmcnt(7)
  v_mfma_f32_16x16x32_bf16 v[56:59], v[52:55], v[0:3], 0
  v_bitop3_b32 v72, v0, v2, s72 bitop3:0x7e
  s_waitcnt vmcnt(6)
  v_mfma_f32_16x16x32_bf16 v[56:59], v[52:55], v[4:7], v[56:59]
  v_bitop3_b32 v73, v4, v6, s72 bitop3:0x7e
  v_or_b32 v72, v72, v73
  s_waitcnt vmcnt(5)
  v_mfma_f32_16x16x32_bf16 v[36:39], v[52:55], v[8:11], 0
  v_bitop3_b32 v73, v8, v10, s72 bitop3:0x7e
  v_or_b32 v72, v72, v73
  s_waitcnt vmcnt(4)
  v_mfma_f32_16x16x32_bf16 v[36:39], v[52:55], v[12:15], v[36:39]
  v_bitop3_b32 v73, v12, v14, s72 bitop3:0x7e
  v_bitop3_b32 v72, v72, v73, 1 bitop3:0xa8
  v_cmp_ne_u32 vcc, 0, v72
  s_cbranch_vccz Cf0_h1p
  s_cmp_lt_u32 s67, 131072
  s_cbranch_scc1 Cf0_h1r
  s_branch Cf0_h1p
Cf0_h2r:
Cf0_h2s:
  s_mov_b64 exec, vcc
  buffer_load_dwordx4 v[52:55], v76, s[8:11], s64 offen offset:0 sc1
  buffer_load_dwordx4 v[56:59], v76, s[8:11], s64 offen offset:1024 sc1
  buffer_load_dwordx4 v[12:15], v76, s[8:11], s65 offen offset:0 sc1
  s_mov_b64 exec, -1
  s_add_u32 s67, s67, 1
  s_waitcnt vmcnt(6)
  v_max3_u32 v72, v52, v53, v54
  v_max3_u32 v72, v72, v55, v56
  v_max3_u32 v72, v72, v57, v58
  v_max3_u32 v72, v72, v59, v12
  v_max3_u32 v72, v72, v13, v14
  v_max_u32 v72, v72, v15
  v_cmp_eq_u32 vcc, -1, v72
  s_cbranch_vccz Cf0_h2ok
  s_mov_b64 exec, vcc
  buffer_load_dwordx4 v[52:55], v76, s[8:11], s64 offen offset:0 sc1
  buffer_load_dwordx4 v[56:59], v76, s[8:11], s64 offen offset:1024 sc1
  buffer_load_dwordx4 v[12:15], v76, s[8:11], s65 offen offset:0 sc1
  s_mov_b64 exec, -1
  s_add_u32 s67, s67, 1
  s_waitcnt vmcnt(6)
  v_max3_u32 v72, v52, v53, v54
  v_max3_u32 v72, v72, v55, v56
  v_max3_u32 v72, v72, v57, v58
  v_max3_u32 v72, v72, v59, v12
  v_max3_u32 v72, v72, v13, v14
  v_max_u32 v72, v72, v15
  v_cmp_eq_u32 vcc, -1, v72
  s_cbranch_vccz Cf0_h2ok
  s_mov_b64 exec, vcc
  buffer_load_dwordx4 v[52:55], v76, s[8:11], s64 offen offset:0 sc1
  buffer_load_dwordx4 v[56:59], v76, s[8:11], s64 offen offset:1024 sc1
  buffer_load_dwordx4 v[12:15], v76, s[8:11], s65 offen offset:0 sc1
  s_mov_b64 exec, -1
  s_add_u32 s67, s67, 1
  s_waitcnt vmcnt(6)
  v_max3_u32 v72, v52, v53, v54
  v_max3_u32 v72, v72, v55, v56
  v_max3_u32 v72, v72, v57, v58
  v_max3_u32 v72, v72, v59, v12
  v_max3_u32 v72, v72, v13, v14
  v_max_u32 v72, v72, v15
  v_cmp_eq_u32 vcc, -1, v72
  s_cbranch_vccz Cf0_h2ok
  s_mov_b64 exec, vcc
  buffer_load_dwordx4 v[52:55], v76, s[8:11], s64 offen offset:0 sc1
  buffer_load_dwordx4 v[56:59], v76, s[8:11], s64 offen offset:1024 sc1
  buffer_load_dwordx4 v[12:15], v76, s[8:11], s65 offen offset:0 sc1
  s_mov_b64 exec, -1
  s_add_u32 s67, s67, 1
  s_waitcnt vmcnt(6)
  v_max3_u32 v72, v52, v53, v54
  v_max3_u32 v72, v72, v55, v56
  v_max3_u32 v72, v72, v57, v58
  v_max3_u32 v72, v72, v59, v12
  v_max3_u32 v72, v72, v13, v14
  v_max_u32 v72, v72, v15
  v_cmp_eq_u32 vcc, -1, v72
  s_cbranch_vccz Cf0_h2ok
  s_cmp_lt_u32 s67, 131072
  s_cbranch_scc1 Cf0_h2s
Cf0_h2ok:
  ds_write_b128 v76, v[52:55] offset:4608
  ds_write_b128 v76, v[56:59] offset:5632
  ds_write_b128 v76, v[12:15] offset:12800
  s_branch Cf0_h2w
Cf0_last:
  s_nop 7
  s_waitcnt vmcnt(0) lgkmcnt(0)
  ds_read_b64 v[16:17], v77 offset:256
  v_mov_b64 v[18:19], v[72:73]
  s_add_u32 s68, s68, 131072
  s_waitcnt lgkmcnt(0)
  buffer_store_dwordx4 v[16:19], v76, s[8:11], s68 offen sc1
  s_waitcnt vmcnt(0)
  s_barrier
  s_branch L_cexit
L_w1:
  v_mov_b64 v[20:21], 0
  v_mov_b64 v[22:23], 0
  v_mov_b64 v[24:25], 0
  v_mov_b64 v[26:27], 0
  v_mov_b64 v[28:29], 0
  v_mov_b64 v[30:31], 0
  v_mov_b64 v[32:33], 0
  v_mov_b64 v[34:35], 0
  s_mov_b32 m0, 15872
  s_branch Cf1_h2
.p2align 6
Cf1_top:
  s_waitcnt lgkmcnt(0)
  s_barrier
  ds_read_b128 v[0:3], v76 offset:4608
  ds_read_b128 v[4:7], v76 offset:5632
  s_waitcnt lgkmcnt(1)
  v_smfmac_f32_16x16x64_bf16 v[20:23], v[0:3], v[60:67], v74
  ds_read_b128 v[60:63], v76 offset:38912
  v_smfmac_f32_16x16x64_bf16 v[24:27], v[0:3], v[44:51], v74
  ds_read_b128 v[64:67], v76 offset:39936
  s_waitcnt lgkmcnt(2)
  v_smfmac_f32_16x16x64_bf16 v[20:23], v[4:7], v[80:87], v74
  buffer_load_dwordx4 v[44:47], v76, s[8:11], s58 offen offset:0 sc1
  ds_read_b128 v[8:11], v76 offset:6656
  v_smfmac_f32_16x16x64_bf16 v[28:31], v[0:3], v[36:43], v74
  ds_read_b128 v[36:39], v76 offset:53248
  v_smfmac_f32_16x16x64_bf16 v[24:27], v[4:7], v[88:95], v74
  buffer_load_dwordx4 v[48:51], v76, s[8:11], s58 offen offset:1024 sc1
  ds_read_b128 v[40:43], v76 offset:54272
  v_smfmac_f32_16x16x64_bf16 v[28:31], v[4:7], v[208:215], v74
  ds_read_b128 v[12:15], v76 offset:7680
  v_smfmac_f32_16x16x64_bf16 v[32:35], v[4:7], v[216:223], v74
  buffer_load_dwordx4 v[52:55], v76, s[8:11], s59 offen offset:0 sc1
  s_waitcnt lgkmcnt(4)
  v_smfmac_f32_16x16x64_bf16 v[32:35], v[0:3], v[60:67], v74
  ds_read_b128 v[60:63], v76 offset:55296
  s_waitcnt lgkmcnt(4)
  v_smfmac_f32_16x16x64_bf16 v[20:23], v[8:11], v[96:103], v74
  buffer_load_dwordx4 v[56:59], v76, s[8:11], s59 offen offset:1024 sc1
  ds_read_b128 v[64:67], v76 offset:56320
  v_smfmac_f32_16x16x64_bf16 v[24:27], v[8:11], v[104:111], v74
  ds_read_b128 v[0:3], v76 offset:12800
  s_waitcnt lgkmcnt(4)
  v_smfmac_f32_16x16x64_bf16 v[28:31], v[8:11], v[36:43], v74
  ds_read_b128 v[36:39], v75 offset:4096
  s_waitcnt lgkmcnt(4)
  v_smfmac_f32_16x16x64_bf16 v[20:23], v[12:15], v[112:119], v74
  buffer_store_dwordx4 v[16:19], v76, s[8:11], s68 offen sc1
  ds_read_b128 v[40:43], v75 offset:5120
  v_smfmac_f32_16x16x64_bf16 v[24:27], v[12:15], v[120:127], v74
  buffer_load_dword v73, s[8:11], s70 offen lds
  s_waitcnt lgkmcnt(3)
  v_smfmac_f32_16x16x64_bf16 v[32:35], v[8:11], v[60:67], v74
  ds_read_b128 v[60:63], v75 offset:6144
  v_smfmac_f32_16x16x64_bf16 v[28:31], v[12:15], v[224:231], v74
  ds_read_b128 v[64:67], v75 offset:7168
  v_smfmac_f32_16x16x64_bf16 v[32:35], v[12:15], v[232:239], v74
  s_barrier
  s_waitcnt lgkmcnt(4)
  v_smfmac_f32_16x16x64_bf16 v[20:23], v[0:3], v[192:199], v74
  ds_read_b128 v[4:7], v76 offset:8704
  s_waitcnt lgkmcnt(3)
  v_smfmac_f32_16x16x64_bf16 v[28:31], v[0:3], v[36:43], v74
  ds_read_b128 v[16:19], v76 offset:9728
  v_smfmac_f32_16x16x64_bf16 v[24:27], v[0:3], v[200:207], v74
  ds_read_b128 v[36:39], v75 offset:20480
  s_waitcnt lgkmcnt(3)
  v_mov_b32 v68, 0x3f803f80
  v_smfmac_f32_16x16x64_bf16 v[32:35], v[0:3], v[60:67], v74
  ds_read_b128 v[40:43], v75 offset:21504
  s_waitcnt lgkmcnt(3)
  v_smfmac_f32_16x16x64_bf16 v[20:23], v[4:7], v[128:135], v74
  ds_read_b128 v[12:15], v76 offset:10752
  v_mov_b32 v69, 0x3f803f80
  v_smfmac_f32_16x16x64_bf16 v[24:27], v[4:7], v[136:143], v74
  ds_read_b128 v[8:11], v76 offset:11776
  s_waitcnt lgkmcnt(4)
  v_smfmac_f32_16x16x64_bf16 v[20:23], v[16:19], v[144:151], v74
  ds_read_b128 v[60:63], v75 offset:22528
  v_mov_b64 v[70:71], v[68:69]
  v_smfmac_f32_16x16x64_bf16 v[24:27], v[16:19], v[152:159], v74
  ds_read_b128 v[64:67], v75 offset:23552
  s_waitcnt lgkmcnt(4)
  v_smfmac_f32_16x16x64_bf16 v[28:31], v[4:7], v[36:43], v74
  s_waitcnt lgkmcnt(3)
  v_mov_b64 v[36:37], 0
  v_smfmac_f32_16x16x64_bf16 v[20:23], v[12:15], v[160:167], v74
  s_waitcnt lgkmcnt(2)
  v_mov_b64 v[38:39], 0
  v_smfmac_f32_16x16x64_bf16 v[20:23], v[8:11], v[176:183], v74
  v_mov_b64 v[40:41], 0
  v_smfmac_f32_16x16x64_bf16 v[24:27], v[12:15], v[168:175], v74
  v_mov_b64 v[42:43], 0
  v_smfmac_f32_16x16x64_bf16 v[24:27], v[8:11], v[184:191], v74
  s_waitcnt lgkmcnt(0)
  v_add_f32 v20, v20, v22
  v_smfmac_f32_16x16x64_bf16 v[32:35], v[4:7], v[60:67], v74
  v_add_f32 v21, v21, v23
  v_smfmac_f32_16x16x64_bf16 v[28:31], v[16:19], v[240:247], v74
  v_add_f32 v24, v24, v26
  v_cvt_pk_bf16_f32 v22, v20, v24
  v_smfmac_f32_16x16x64_bf16 v[28:31], v[12:15], a[0:7], v74
  ds_write_b32 v79, v22 offset:0
  v_add_f32 v25, v25, v27
  v_cvt_pk_bf16_f32 v23, v21, v25
  v_smfmac_f32_16x16x64_bf16 v[28:31], v[8:11], a[16:23], v74
  ds_write_b32 v79, v23 offset:576
  v_cmp_u_f32 vcc, v20, v21
  v_smfmac_f32_16x16x64_bf16 v[32:35], v[16:19], v[248:255], v74
  s_mov_b64 exec, 1
  buffer_store_dword v72, v76, s[8:11], s71 offen sc1
  s_mov_b64 exec, -1
  v_smfmac_f32_16x16x64_bf16 v[32:35], v[12:15], a[8:15], v74
  v_add_f32 v28, v28, v30
  v_add_f32 v29, v29, v31
  v_smfmac_f32_16x16x64_bf16 v[32:35], v[8:11], a[24:31], v74
  s_cbranch_vccnz Cf1_rec
Cf1_recok:
  v_smfmac_f32_16x16x64_bf16 v[36:39], v[16:19], a[112:119], v74
  s_waitcnt lgkmcnt(0)
  s_barrier
  ds_read_b128 v[60:63], v77
  v_smfmac_f32_16x16x64_bf16 v[40:43], v[16:19], a[120:127], v74
  ds_read_b128 v[64:67], v77 offset:128
  v_add_f32 v32, v32, v34
  v_cvt_pk_bf16_f32 v30, v28, v32
  v_smfmac_f32_16x16x64_bf16 v[36:39], v[0:3], a[160:167], v74
  ds_write_b32 v79, v30 offset:256
  v_add_f32 v33, v33, v35
  v_cvt_pk_bf16_f32 v31, v29, v33
  v_smfmac_f32_16x16x64_bf16 v[40:43], v[0:3], a[168:175], v74
  ds_write_b32 v79, v31 offset:832
  v_xor_b32 v75, 0x8000, v75
  v_smfmac_f32_16x16x64_bf16 v[36:39], v[4:7], a[96:103], v74
  ds_read_b128 v[0:3], v76 offset:4608
  v_mov_b32 v29, 0
  v_smfmac_f32_16x16x64_bf16 v[40:43], v[4:7], a[104:111], v74
  s_waitcnt vmcnt(5) lgkmcnt(3)
  v_mov_b32 v30, 0
  v_mfma_f32_16x16x32_bf16 v[44:47], v[44:47], v[60:63], 0
  ds_read_b128 v[4:7], v76 offset:5632
  s_waitcnt lgkmcnt(2)
  v_mfma_f32_16x16x32_bf16 v[44:47], v[48:51], v[64:67], v[44:47]
  s_barrier
  v_smfmac_f32_16x16x64_bf16 v[36:39], v[8:11], a[144:151], v74
  ds_read_b128 v[20:23], v77 offset:256
  ds_read_b128 v[24:27], v77 offset:384
  v_smfmac_f32_16x16x64_bf16 v[40:43], v[8:11], a[152:159], v74
  ds_read_b128 v[8:11], v76 offset:6656
  v_add_f32_dpp v72, v46, v44 quad_perm:[2,3,0,1] row_mask:0xf bank_mask:0xf
  v_add_f32_dpp v73, v47, v45 quad_perm:[2,3,0,1] row_mask:0xf bank_mask:0xf
  v_smfmac_f32_16x16x64_bf16 v[36:39], v[12:15], a[128:135], v74
  ds_read_b128 v[44:47], v75 offset:4096
  v_exp_f32_dpp v72, v72 quad_perm:[0,1,0,1] row_mask:0xf bank_mask:0xf
  v_smfmac_f32_16x16x64_bf16 v[40:43], v[12:15], a[136:143], v74
  ds_read_b128 v[12:15], v76 offset:7680
  s_waitcnt lgkmcnt(6)
  v_exp_f32_dpp v73, v73 quad_perm:[0,1,0,1] row_mask:0xf bank_mask:0xf
  v_smfmac_f32_16x16x64_bf16 v[36:39], v[0:3], a[32:39], v74
  s_waitcnt lgkmcnt(3)
  v_cvt_pk_bf16_f32 v72, v72, v73
  v_mfma_f32_16x16x32_bf16 v[20:23], v[20:23], v[60:63], 0
  ds_write_b32 v78, v72 offset:516
  v_mfma_f32_16x16x32_bf16 v[20:23], v[24:27], v[64:67], v[20:23]
  ds_read_b128 v[48:51], v75 offset:5120
  v_smfmac_f32_16x16x64_bf16 v[40:43], v[0:3], a[40:47], v74
  ds_read_b128 v[60:63], v75 offset:6144
  v_smfmac_f32_16x16x64_bf16 v[36:39], v[4:7], a[48:55], v74
  s_waitcnt lgkmcnt(5)
  v_add_f32_dpp v24, v22, v20 quad_perm:[2,3,0,1] row_mask:0xf bank_mask:0xf
  v_add_f32_dpp v25, v23, v21 quad_perm:[2,3,0,1] row_mask:0xf bank_mask:0xf
  v_smfmac_f32_16x16x64_bf16 v[36:39], v[8:11], a[64:71], v74
  s_waitcnt lgkmcnt(2)
  s_barrier
  ds_read_b128 v[32:35], v78 offset:512
  v_smfmac_f32_16x16x64_bf16 v[36:39], v[12:15], a[80:87], v74
  ds_read_b128 v[64:67], v75 offset:7168
  v_mul_f32 v24, s69, v24
  v_smfmac_f32_16x16x64_bf16 v[40:43], v[4:7], a[56:63], v74
  v_mul_f32 v25, s69, v25
  v_smfmac_f32_16x16x64_bf16 v[40:43], v[8:11], a[72:79], v74
  v_exp_f32_dpp v24, v24 quad_perm:[0,1,0,1] row_mask:0xf bank_mask:0xf
  v_smfmac_f32_16x16x64_bf16 v[40:43], v[12:15], a[88:95], v74
  s_waitcnt vmcnt(3) lgkmcnt(1)
  v_exp_f32_dpp v25, v25 quad_perm:[0,1,0,1] row_mask:0xf bank_mask:0xf
  v_mfma_f32_16x16x32_bf16 v[8:11], v[32:35], v[68:71], 0
  v_add_f32 v36, v36, v38
  v_add_f32 v37, v37, v39
  v_mfma_f32_16x16x32_bf16 v[0:3], v[32:35], v[52:55], 0
  v_add_f32 v40, v40, v42
  v_add_f32 v41, v41, v43
  v_mfma_f32_16x16x32_bf16 v[4:7], v[32:35], v[56:59], 0
  v_cvt_pk_bf16_f32 v28, v24, v25
  v_cvt_pk_bf16_f32 v72, v36, v37
  v_cvt_pk_bf16_f32 v73, v40, v41
  v_mfma_f32_16x16x16_bf16 v[8:11], v[28:29], v[68:69], v[8:11]
  v_cvt_pk_bf16_f32 v31, v24, v25
  v_mfma_f32_16x16x16_bf16 v[0:3], v[28:29], v[72:73], v[0:3]
  ds_read_b128 v[68:71], v76 offset:13824
  v_mfma_f32_16x16x16_bf16 v[4:7], v[30:31], v[72:73], v[4:7]
  v_rcp_f32 v10, v8
  v_rcp_f32 v11, v9
  v_mul_f32 v0, v10, v0
  v_mul_f32 v1, v11, v1
  s_nop 0
  v_mul_f32 v4, v10, v4
  v_mul_f32 v5, v11, v5
  v_cvt_pk_bf16_f32 v2, v0, v4
  ds_write_b32 v79, v2 offset:8704
  v_cvt_pk_bf16_f32 v3, v1, v5
  ds_write_b32 v79, v3 offset:9280
  v_subrev_u32 v8, 813694976, v8
  v_subrev_u32 v9, 813694976, v9
  v_max_u32 v8, v8, v9
  v_cmp_le_u32 vcc, 503316480, v8
  v_mov_b64 v[16:17], 0
  v_mov_b64 v[18:19], 0
  v_mov_b64 v[20:21], 0
  v_mov_b64 v[22:23], 0
  s_cbranch_vccnz Cf1_mx
Cf1_mxok:
  s_cmp_eq_u32 s66, 63
  s_waitcnt lgkmcnt(0)
  s_barrier
  ds_read_b128 v[0:3], v78 offset:8704
  ds_read_b128 v[4:7], v78 offset:8768
  ds_read_b128 v[8:11], v78 offset:8832
  ds_read_b128 v[12:15], v78 offset:8896
  v_mov_b64 v[24:25], 0
  v_mov_b64 v[26:27], 0
  v_mov_b64 v[28:29], 0
  v_mov_b64 v[30:31], 0
  v_mov_b64 v[32:33], 0
  v_mov_b64 v[34:35], 0
  s_waitcnt lgkmcnt(3)
  v_smfmac_f32_16x16x64_bf16 v[16:19], v[0:3], a[176:183], v74
  s_cbranch_scc1 Cf1_last
  s_waitcnt lgkmcnt(2)
  v_smfmac_f32_16x16x64_bf16 v[16:19], v[4:7], a[184:191], v74
  s_waitcnt lgkmcnt(1)
  v_smfmac_f32_16x16x64_bf16 v[16:19], v[8:11], a[192:199], v74
  ds_read_b128 v[52:55], v75 offset:20480
  s_waitcnt lgkmcnt(1)
  v_smfmac_f32_16x16x64_bf16 v[16:19], v[12:15], a[200:207], v74
  ds_read_b128 v[56:59], v75 offset:21504
  v_smfmac_f32_16x16x64_bf16 v[20:23], v[0:3], a[208:215], v74
  ds_read_b128 v[36:39], v75 offset:22528
  v_smfmac_f32_16x16x64_bf16 v[20:23], v[4:7], a[216:223], v74
  ds_read_b128 v[40:43], v75 offset:23552
  v_cvt_pk_bf16_f32 v16, v16, v17
  v_cvt_pk_bf16_f32 v17, v18, v19
  v_bfi_b32 v16, 1, s72, v16
  v_smfmac_f32_16x16x64_bf16 v[20:23], v[8:11], v[44:51], v74
  ds_read_b128 v[44:47], v75 offset:36864
  buffer_store_dwordx2 v[16:17], v68, s[8:11], s73 offen
  v_smfmac_f32_16x16x64_bf16 v[20:23], v[12:15], v[60:67], v74
  ds_read_b128 v[48:51], v75 offset:37888
  v_smfmac_f32_16x16x64_bf16 v[24:27], v[0:3], a[224:231], v74
  ds_read_b128 v[60:63], v75 offset:38912
  v_smfmac_f32_16x16x64_bf16 v[24:27], v[4:7], a[232:239], v74
  ds_read_b128 v[64:67], v75 offset:39936
  s_waitcnt lgkmcnt(6)
  v_cvt_pk_bf16_f32 v20, v20, v21
  v_cvt_pk_bf16_f32 v21, v22, v23
  v_bfi_b32 v20, 1, s72, v20
  v_smfmac_f32_16x16x64_bf16 v[24:27], v[8:11], v[52:59], v74
  buffer_store_dwordx2 v[20:21], v68, s[8:11], s74 offen
  s_waitcnt lgkmcnt(4)
  v_mov_b64 v[18:19], v[72:73]
  v_smfmac_f32_16x16x64_bf16 v[24:27], v[12:15], v[36:43], v74
  v_mov_b64 v[20:21], 0
  v_smfmac_f32_16x16x64_bf16 v[28:31], v[0:3], a[240:247], v74
  v_mov_b64 v[22:23], 0
  v_smfmac_f32_16x16x64_bf16 v[28:31], v[4:7], a[248:255], v74
  s_waitcnt lgkmcnt(2)
  v_cvt_pk_bf16_f32 v24, v24, v25
  v_cvt_pk_bf16_f32 v25, v26, v27
  v_bfi_b32 v24, 1, s72, v24
  v_smfmac_f32_16x16x64_bf16 v[28:31], v[8:11], v[44:51], v74
  buffer_store_dwordx2 v[24:25], v68, s[8:11], s75 offen
  s_waitcnt lgkmcnt(0)
  v_smfmac_f32_16x16x64_bf16 v[28:31], v[12:15], v[60:67], v74
  ds_read_b64 v[16:17], v77 offset:264
  v_xor_b32 v75, 0x8000, v75
  ds_read_b128 v[0:3], v76 offset:14848
  s_nop 3
  v_cvt_pk_bf16_f32 v28, v28, v29
  v_cvt_pk_bf16_f32 v29, v30, v31
  v_bfi_b32 v28, 1, s72, v28
  buffer_store_dwordx2 v[28:29], v68, s[8:11], s76 offen
  v_mov_b64 v[24:25], 0
  v_mov_b64 v[26:27], 0
  v_mov_b64 v[28:29], 0
  v_mov_b64 v[30:31], 0
  s_add_u32 s58, s58, 524288
  s_add_u32 s59, s59, 524288
  s_add_u32 s70, s70, 524288
  s_add_u32 s68, s68, 131072
  s_add_u32 s66, s66, 1
  s_xor_b32 s64, s64, 16384
  s_xor_b32 s65, s65, 16384
  s_nop 15
  s_nop 15
  s_nop 7
  buffer_load_dwordx4 v[52:55], v76, s[8:11], s60 offen offset:0 sc1
  buffer_load_dwordx4 v[56:59], v76, s[8:11], s60 offen offset:1024 sc1
  s_nop 15
  s_nop 11
  buffer_load_dwordx4 v[36:39], v76, s[8:11], s60 offen offset:0 sc1
  buffer_load_dwordx4 v[40:43], v76, s[8:11], s60 offen offset:1024 sc1
  s_waitcnt vmcnt(3) lgkmcnt(0)
  v_mfma_f32_16x16x32_bf16 v[4:7], v[0:3], v[52:55], 0
  v_bitop3_b32 v72, v52, v54, s72 bitop3:0x7e
  s_waitcnt vmcnt(2)
  v_mfma_f32_16x16x32_bf16 v[4:7], v[0:3], v[56:59], v[4:7]
  v_bitop3_b32 v73, v56, v58, s72 bitop3:0x7e
  v_bitop3_b32 v72, v72, v73, 1 bitop3:0xa8
  v_cmp_ne_u32 vcc, 0, v72
  s_cbranch_vccnz Cf1_h1r
Cf1_h1p:
  s_nop 2
  v_add_f32_dpp v4, v4, v4 row_ror:4 row_mask:0xf bank_mask:0xf
  v_add_f32_dpp v5, v5, v5 row_ror:4 row_mask:0xf bank_mask:0xf
  s_nop 0
  v_add_f32_dpp v4, v4, v4 row_ror:8 row_mask:0xf bank_mask:0xf
  v_add_f32_dpp v5, v5, v5 row_ror:8 row_mask:0xf bank_mask:0xf
  v_cvt_pk_bf16_f32 v4, v4, v5
  buffer_store_dword v4, v69, s[8:11], s62 offen
Cf1_h1ok:
  s_xor_b32 s62, s62, 16384
  s_xor_b32 s72, s72, 1
  s_nop 15
  s_nop 7
Cf1_h2:
  v_lshlrev_b32 v73, 2, v76
  buffer_load_dwordx4 v[52:55], v76, s[8:11], s64 offen offset:0 sc1
  buffer_load_dwordx4 v[56:59], v76, s[8:11], s64 offen offset:1024 sc1
  s_nop 15
  s_nop 1
  buffer_load_dwordx4 v[52:55], v76, s[8:11], s64 offen offset:0 sc1
  buffer_load_dwordx4 v[56:59], v76, s[8:11], s64 offen offset:1024 sc1
  s_nop 15
  s_nop 1
  buffer_load_dwordx4 v[52:55], v76, s[8:11], s64 offen offset:0 sc1
  buffer_load_dwordx4 v[56:59], v76, s[8:11], s64 offen offset:1024 sc1
  s_waitcnt vmcnt(7)
  ds_read_b128 v[60:63], v76 offset:20480
  ds_read_b128 v[64:67], v76 offset:21504
  ds_read_b128 v[44:47], v76 offset:22528
  ds_read_b128 v[48:51], v76 offset:23552
  ds_read_b128 v[36:39], v76 offset:36864
  ds_read_b128 v[40:43], v76 offset:37888
  s_waitcnt vmcnt(4)
  v_max3_u32 v72, v52, v53, v54
  v_max3_u32 v72, v72, v55, v56
  v_max3_u32 v72, v72, v57, v58
  v_max_u32 v72, v72, v59
  ds_write_b128 v76, v[52:55] offset:6656
  ds_write_b128 v76, v[56:59] offset:7680
  v_cmp_eq_u32 vcc, -1, v72
  s_cbranch_vccnz Cf1_h2r
Cf1_h2w:
  buffer_store_dword v71, v69, s[8:11], s62 offen
  v_mov_b32 v72, s66
  s_branch Cf1_top
Cf1_rec:
  s_nop 7
  s_waitcnt vmcnt(0) lgkmcnt(0)
  v_max3_u32 v72, v0, v1, v2
  v_max3_u32 v72, v72, v3, v4
  v_max3_u32 v72, v72, v5, v6
  v_max3_u32 v72, v72, v7, v8
  v_max3_u32 v72, v72, v9, v10
  v_max3_u32 v72, v72, v11, v12
  v_max3_u32 v72, v72, v13, v14
  v_max3_u32 v72, v72, v15, v16
  v_max3_u32 v72, v72, v17, v18
  v_max_u32 v72, v72, v19
  v_cmp_eq_u32 vcc, -1, v72
  s_cbranch_vccz Cf1_recok
  s_barrier
  v_mov_b64 v[20:21], 0
  v_mov_b64 v[22:23], 0
  v_mov_b64 v[24:25], 0
  v_mov_b64 v[26:27], 0
  v_mov_b64 v[28:29], 0
  v_mov_b64 v[30:31], 0
  v_mov_b64 v[32:33], 0
  v_mov_b64 v[34:35], 0
  s_waitcnt lgkmcnt(0)
  s_barrier
  ds_read_b128 v[0:3], v76 offset:4608
  ds_read_b128 v[60:63], v76 offset:20480
  ds_read_b128 v[64:67], v76 offset:21504
  s_waitcnt lgkmcnt(0)
  v_smfmac_f32_16x16x64_bf16 v[20:23], v[0:3], v[60:67], v74
  ds_read_b128 v[60:63], v76 offset:22528
  ds_read_b128 v[64:67], v76 offset:23552
  s_waitcnt lgkmcnt(0)
  v_smfmac_f32_16x16x64_bf16 v[24:27], v[0:3], v[60:67], v74
  ds_read_b128 v[60:63], v76 offset:36864
  ds_read_b128 v[64:67], v76 offset:37888
  s_waitcnt lgkmcnt(0)
  v_smfmac_f32_16x16x64_bf16 v[28:31], v[0:3], v[60:67], v74
  ds_read_b128 v[60:63], v76 offset:38912
  ds_read_b128 v[64:67], v76 offset:39936
  s_waitcnt lgkmcnt(0)
  v_smfmac_f32_16x16x64_bf16 v[32:35], v[0:3], v[60:67], v74
  ds_read_b128 v[4:7], v76 offset:5632
  s_waitcnt lgkmcnt(0)
  v_smfmac_f32_16x16x64_bf16 v[20:23], v[4:7], v[80:87], v74
  v_smfmac_f32_16x16x64_bf16 v[24:27], v[4:7], v[88:95], v74
  v_smfmac_f32_16x16x64_bf16 v[28:31], v[4:7], v[208:215], v74
  v_smfmac_f32_16x16x64_bf16 v[32:35], v[4:7], v[216:223], v74
  ds_read_b128 v[8:11], v76 offset:6656
  s_waitcnt lgkmcnt(0)
  v_smfmac_f32_16x16x64_bf16 v[20:23], v[8:11], v[96:103], v74
  v_smfmac_f32_16x16x64_bf16 v[24:27], v[8:11], v[104:111], v74
  ds_read_b128 v[60:63], v76 offset:53248
  ds_read_b128 v[64:67], v76 offset:54272
  s_waitcnt lgkmcnt(0)
  v_smfmac_f32_16x16x64_bf16 v[28:31], v[8:11], v[60:67], v74
  ds_read_b128 v[60:63], v76 offset:55296
  ds_read_b128 v[64:67], v76 offset:56320
  s_waitcnt lgkmcnt(0)
  v_smfmac_f32_16x16x64_bf16 v[32:35], v[8:11], v[60:67], v74
  ds_read_b128 v[12:15], v76 offset:7680
  s_waitcnt lgkmcnt(0)
  v_smfmac_f32_16x16x64_bf16 v[20:23], v[12:15], v[112:119], v74
  v_smfmac_f32_16x16x64_bf16 v[24:27], v[12:15], v[120:127], v74
  v_smfmac_f32_16x16x64_bf16 v[28:31], v[12:15], v[224:231], v74
  v_smfmac_f32_16x16x64_bf16 v[32:35], v[12:15], v[232:239], v74
  ds_read_b128 v[4:7], v76 offset:8704
  s_waitcnt lgkmcnt(0)
  v_smfmac_f32_16x16x64_bf16 v[20:23], v[4:7], v[128:135], v74
  v_smfmac_f32_16x16x64_bf16 v[24:27], v[4:7], v[136:143], v74
  ds_read_b128 v[60:63], v75 offset:20480
  ds_read_b128 v[64:67], v75 offset:21504
  s_waitcnt lgkmcnt(0)
  v_smfmac_f32_16x16x64_bf16 v[28:31], v[4:7], v[60:67], v74
  ds_read_b128 v[60:63], v75 offset:22528
  ds_read_b128 v[64:67], v75 offset:23552
  s_waitcnt lgkmcnt(0)
  v_smfmac_f32_16x16x64_bf16 v[32:35], v[4:7], v[60:67], v74
  ds_read_b128 v[16:19], v76 offset:9728
  s_waitcnt lgkmcnt(0)
  v_smfmac_f32_16x16x64_bf16 v[20:23], v[16:19], v[144:151], v74
  v_smfmac_f32_16x16x64_bf16 v[24:27], v[16:19], v[152:159], v74
  v_smfmac_f32_16x16x64_bf16 v[28:31], v[16:19], v[240:247], v74
  v_smfmac_f32_16x16x64_bf16 v[32:35], v[16:19], v[248:255], v74
  ds_read_b128 v[12:15], v76 offset:10752
  s_waitcnt lgkmcnt(0)
  v_smfmac_f32_16x16x64_bf16 v[20:23], v[12:15], v[160:167], v74
  v_smfmac_f32_16x16x64_bf16 v[24:27], v[12:15], v[168:175], v74
  v_smfmac_f32_16x16x64_bf16 v[28:31], v[12:15], a[0:7], v74
  v_smfmac_f32_16x16x64_bf16 v[32:35], v[12:15], a[8:15], v74
  ds_read_b128 v[8:11], v76 offset:11776
  s_waitcnt lgkmcnt(0)
  v_smfmac_f32_16x16x64_bf16 v[20:23], v[8:11], v[176:183], v74
  v_smfmac_f32_16x16x64_bf16 v[24:27], v[8:11], v[184:191], v74
  v_smfmac_f32_16x16x64_bf16 v[28:31], v[8:11], a[16:23], v74
  v_smfmac_f32_16x16x64_bf16 v[32:35], v[8:11], a[24:31], v74
  ds_read_b128 v[0:3], v76 offset:12800
  s_waitcnt lgkmcnt(0)
  v_smfmac_f32_16x16x64_bf16 v[20:23], v[0:3], v[192:199], v74
  v_smfmac_f32_16x16x64_bf16 v[24:27], v[0:3], v[200:207], v74
  ds_read_b128 v[60:63], v75 offset:4096
  ds_read_b128 v[64:67], v75 offset:5120
  s_waitcnt lgkmcnt(0)
  v_smfmac_f32_16x16x64_bf16 v[28:31], v[0:3], v[60:67], v74
  ds_read_b128 v[60:63], v75 offset:6144
  ds_read_b128 v[64:67], v75 offset:7168
  s_waitcnt lgkmcnt(0)
  v_smfmac_f32_16x16x64_bf16 v[32:35], v[0:3], v[60:67], v74
  v_add_f32 v20, v20, v22
  v_add_f32 v21, v21, v23
  v_add_f32 v24, v24, v26
  v_cvt_pk_bf16_f32 v22, v20, v24
  ds_write_b32 v79, v22 offset:0
  v_add_f32 v25, v25, v27
  v_cvt_pk_bf16_f32 v23, v21, v25
  ds_write_b32 v79, v23 offset:576
  v_add_f32 v28, v28, v30
  v_add_f32 v29, v29, v31
  s_waitcnt lgkmcnt(0)
  s_nop 1
  s_branch Cf1_recok
Cf1_mx:
  s_waitcnt lgkmcnt(0)
  s_barrier
  buffer_load_dwordx4 v[0:3], v76, s[8:11], s58 offen offset:0 sc1
  ds_read_b128 v[20:23], v77 offset:0
  ds_read_b128 v[28:31], v77 offset:256
  buffer_load_dwordx4 v[4:7], v76, s[8:11], s58 offen offset:1024 sc1
  ds_read_b128 v[24:27], v77 offset:128
  ds_read_b128 v[32:35], v77 offset:384
  s_waitcnt vmcnt(1) lgkmcnt(3)
  v_mfma_f32_16x16x32_bf16 v[8:11], v[0:3], v[20:23], 0
  s_waitcnt vmcnt(0) lgkmcnt(1)
  v_mfma_f32_16x16x32_bf16 v[8:11], v[4:7], v[24:27], v[8:11]
  v_mfma_f32_16x16x32_bf16 v[12:15], v[28:31], v[20:23], 0
  s_waitcnt lgkmcnt(0)
  v_mfma_f32_16x16x32_bf16 v[12:15], v[32:35], v[24:27], v[12:15]
  v_add_f32_dpp v8, v10, v8 quad_perm:[2,3,0,1] row_mask:0xf bank_mask:0xf
  v_add_f32_dpp v9, v11, v9 quad_perm:[2,3,0,1] row_mask:0xf bank_mask:0xf
  s_nop 0
  v_mov_b32_dpp v8, v8 quad_perm:[0,1,0,1] row_mask:0xf bank_mask:0xf
  v_mov_b32_dpp v9, v9 quad_perm:[0,1,0,1] row_mask:0xf bank_mask:0xf
  s_nop 1
  v_add_f32_dpp v12, v14, v12 quad_perm:[2,3,0,1] row_mask:0xf bank_mask:0xf
  v_add_f32_dpp v13, v15, v13 quad_perm:[2,3,0,1] row_mask:0xf bank_mask:0xf
  s_nop 0
  v_mov_b32_dpp v12, v12 quad_perm:[0,1,0,1] row_mask:0xf bank_mask:0xf
  v_mov_b32_dpp v13, v13 quad_perm:[0,1,0,1] row_mask:0xf bank_mask:0xf
  v_mul_f32 v12, s69, v12
  ds_write_b32 v78, v8 offset:8708
  v_mul_f32 v13, s69, v13
  ds_write_b32 v78, v9 offset:8772
  s_waitcnt lgkmcnt(0)
  s_barrier
  ds_read_b128 v[36:39], v78 offset:8704
  ds_read_b128 v[40:43], v78 offset:8768
  s_waitcnt lgkmcnt(0)
  s_barrier
  v_max_f32 v16, v36, v37
  v_max3_f32 v16, v16, v38, v39
  v_max3_f32 v16, v16, v40, v41
  v_max3_f32 v16, v16, v42, v43
  v_max3_f32 v16, v16, v12, v13
  v_mov_b32 v17, v16
  s_nop 1
  v_permlane16_swap_b32 v16, v17
  v_max_f32 v16, v16, v17
  v_mov_b32 v17, v16
  s_nop 1
  v_permlane32_swap_b32 v16, v17
  v_max_f32 v16, v16, v17
  v_sub_f32 v36, v36, v16
  v_sub_f32 v37, v37, v16
  v_sub_f32 v38, v38, v16
  v_sub_f32 v39, v39, v16
  v_sub_f32 v40, v40, v16
  v_sub_f32 v41, v41, v16
  v_sub_f32 v42, v42, v16
  v_sub_f32 v43, v43, v16
  v_sub_f32 v12, v12, v16
  v_sub_f32 v13, v13, v16
  v_exp_f32 v36, v36
  v_exp_f32 v37, v37
  v_exp_f32 v38, v38
  v_exp_f32 v39, v39
  v_exp_f32 v40, v40
  v_exp_f32 v41, v41
  v_exp_f32 v42, v42
  v_exp_f32 v43, v43
  v_exp_f32 v12, v12
  v_exp_f32 v13, v13
  v_cvt_pk_bf16_f32 v32, v36, v40
  v_cvt_pk_bf16_f32 v33, v37, v41
  v_cvt_pk_bf16_f32 v34, v38, v42
  v_cvt_pk_bf16_f32 v35, v39, v43
  v_cvt_pk_bf16_f32 v28, v12, v13
  v_cvt_pk_bf16_f32 v31, v12, v13
  v_mov_b32 v29, 0
  v_mov_b32 v30, 0
  v_mov_b32 v68, 0x3f803f80
  v_mov_b32 v69, 0x3f803f80
  v_mov_b32 v70, 0x3f803f80
  v_mov_b32 v71, 0x3f803f80
  s_nop 1
  v_mfma_f32_16x16x32_bf16 v[8:11], v[32:35], v[68:71], 0
  v_mfma_f32_16x16x32_bf16 v[0:3], v[32:35], v[52:55], 0
  v_mfma_f32_16x16x32_bf16 v[4:7], v[32:35], v[56:59], 0
  v_mfma_f32_16x16x16_bf16 v[8:11], v[28:29], v[68:69], v[8:11]
  v_mfma_f32_16x16x16_bf16 v[0:3], v[28:29], v[72:73], v[0:3]
  v_mfma_f32_16x16x16_bf16 v[4:7], v[30:31], v[72:73], v[4:7]
  ds_read_b128 v[68:71], v76 offset:13824
  v_rcp_f32 v10, v8
  v_rcp_f32 v11, v9
  v_mul_f32 v0, v10, v0
  v_mul_f32 v1, v11, v1
  s_nop 0
  v_mul_f32 v4, v10, v4
  v_mul_f32 v5, v11, v5
  v_cvt_pk_bf16_f32 v2, v0, v4
  ds_write_b32 v79, v2 offset:8704
  v_cvt_pk_bf16_f32 v3, v1, v5
  ds_write_b32 v79, v3 offset:9280
  v_mov_b64 v[16:17], 0
  v_mov_b64 v[18:19], 0
  v_mov_b64 v[20:21], 0
  v_mov_b64 v[22:23], 0
  s_branch Cf1_mxok
Cf1_h1r:
  s_mov_b64 exec, vcc
  buffer_load_dwordx4 v[52:55], v76, s[8:11], s60 offen offset:0 sc1
  buffer_load_dwordx4 v[56:59], v76, s[8:11], s60 offen offset:1024 sc1
  s_mov_b64 exec, -1
  s_add_u32 s67, s67, 1
  s_waitcnt vmcnt(3)
  v_mfma_f32_16x16x32_bf16 v[4:7], v[0:3], v[36:39], 0
  v_bitop3_b32 v72, v36, v38, s72 bitop3:0x7e
  s_waitcnt vmcnt(2)
  v_mfma_f32_16x16x32_bf16 v[4:7], v[0:3], v[40:43], v[4:7]
  v_bitop3_b32 v73, v40, v42, s72 bitop3:0x7e
  v_bitop3_b32 v72, v72, v73, 1 bitop3:0xa8
  v_cmp_ne_u32 vcc, 0, v72
  s_cbranch_vccz Cf1_h1p
  s_mov_b64 exec, vcc
  buffer_load_dwordx4 v[36:39], v76, s[8:11], s60 offen offset:0 sc1
  buffer_load_dwordx4 v[40:43], v76, s[8:11], s60 offen offset:1024 sc1
  s_mov_b64 exec, -1
  s_add_u32 s67, s67, 1
  s_waitcnt vmcnt(3)
  v_mfma_f32_16x16x32_bf16 v[4:7], v[0:3], v[52:55], 0
  v_bitop3_b32 v72, v52, v54, s72 bitop3:0x7e
  s_waitcnt vmcnt(2)
  v_mfma_f32_16x16x32_bf16 v[4:7], v[0:3], v[56:59], v[4:7]
  v_bitop3_b32 v73, v56, v58, s72 bitop3:0x7e
  v_bitop3_b32 v72, v72, v73, 1 bitop3:0xa8
  v_cmp_ne_u32 vcc, 0, v72
  s_cbranch_vccz Cf1_h1p
  s_cmp_lt_u32 s67, 131072
  s_cbranch_scc1 Cf1_h1r
  s_branch Cf1_h1p
Cf1_h2r:
Cf1_h2s:
  s_mov_b64 exec, vcc
  buffer_load_dwordx4 v[52:55], v76, s[8:11], s64 offen offset:0 sc1
  buffer_load_dwordx4 v[56:59], v76, s[8:11], s64 offen offset:1024 sc1
  s_mov_b64 exec, -1
  s_add_u32 s67, s67, 1
  s_waitcnt vmcnt(4)
  v_max3_u32 v72, v52, v53, v54
  v_max3_u32 v72, v72, v55, v56
  v_max3_u32 v72, v72, v57, v58
  v_max_u32 v72, v72, v59
  v_cmp_eq_u32 vcc, -1, v72
  s_cbranch_vccz Cf1_h2ok
  s_mov_b64 exec, vcc
  buffer_load_dwordx4 v[52:55], v76, s[8:11], s64 offen offset:0 sc1
  buffer_load_dwordx4 v[56:59], v76, s[8:11], s64 offen offset:1024 sc1
  s_mov_b64 exec, -1
  s_add_u32 s67, s67, 1
  s_waitcnt vmcnt(4)
  v_max3_u32 v72, v52, v53, v54
  v_max3_u32 v72, v72, v55, v56
  v_max3_u32 v72, v72, v57, v58
  v_max_u32 v72, v72, v59
  v_cmp_eq_u32 vcc, -1, v72
  s_cbranch_vccz Cf1_h2ok
  s_mov_b64 exec, vcc
  buffer_load_dwordx4 v[52:55], v76, s[8:11], s64 offen offset:0 sc1
  buffer_load_dwordx4 v[56:59], v76, s[8:11], s64 offen offset:1024 sc1
  s_mov_b64 exec, -1
  s_add_u32 s67, s67, 1
  s_waitcnt vmcnt(4)
  v_max3_u32 v72, v52, v53, v54
  v_max3_u32 v72, v72, v55, v56
  v_max3_u32 v72, v72, v57, v58
  v_max_u32 v72, v72, v59
  v_cmp_eq_u32 vcc, -1, v72
  s_cbranch_vccz Cf1_h2ok
  s_mov_b64 exec, vcc
  buffer_load_dwordx4 v[52:55], v76, s[8:11], s64 offen offset:0 sc1
  buffer_load_dwordx4 v[56:59], v76, s[8:11], s64 offen offset:1024 sc1
  s_mov_b64 exec, -1
  s_add_u32 s67, s67, 1
  s_waitcnt vmcnt(4)
  v_max3_u32 v72, v52, v53, v54
  v_max3_u32 v72, v72, v55, v56
  v_max3_u32 v72, v72, v57, v58
  v_max_u32 v72, v72, v59
  v_cmp_eq_u32 vcc, -1, v72
  s_cbranch_vccz Cf1_h2ok
  s_cmp_lt_u32 s67, 131072
  s_cbranch_scc1 Cf1_h2s
Cf1_h2ok:
  ds_write_b128 v76, v[52:55] offset:6656
  ds_write_b128 v76, v[56:59] offset:7680
  s_branch Cf1_h2w
Cf1_last:
  s_nop 7
  s_waitcnt vmcnt(0) lgkmcnt(0)
  ds_read_b64 v[16:17], v77 offset:264
  v_mov_b64 v[18:19], v[72:73]
  s_add_u32 s68, s68, 131072
  s_waitcnt lgkmcnt(0)
  buffer_store_dwordx4 v[16:19], v76, s[8:11], s68 offen sc1
  s_waitcnt vmcnt(0)
  s_barrier
  v_mov_b32 v72, 65
  s_mov_b64 exec, 1
  buffer_store_dword v72, v76, s[8:11], s71 offen sc1
  s_mov_b64 exec, -1
  s_branch L_cexit
L_w2:
  v_mov_b64 v[20:21], 0
  v_mov_b64 v[22:23], 0
  v_mov_b64 v[24:25], 0
  v_mov_b64 v[26:27], 0
  v_mov_b64 v[28:29], 0
  v_mov_b64 v[30:31], 0
  v_mov_b64 v[32:33], 0
  v_mov_b64 v[34:35], 0
  s_mov_b32 m0, 15872
  s_branch Cf2_h2
.p2align 6
Cf2_top:
  s_waitcnt lgkmcnt(0)
  s_barrier
  ds_read_b128 v[0:3], v76 offset:4608
  ds_read_b128 v[4:7], v76 offset:5632
  buffer_load_dwordx4 v76, s[8:11], s64 offen offset:0 sc1 lds
  buffer_load_dwordx4 v76, s[8:11], s64 offen offset:1024 sc1 lds
  s_waitcnt lgkmcnt(1)
  v_smfmac_f32_16x16x64_bf16 v[20:23], v[0:3], v[60:67], v74
  ds_read_b128 v[60:63], v76 offset:43008
  v_smfmac_f32_16x16x64_bf16 v[24:27], v[0:3], v[44:51], v74
  s_mov_b32 m0, 15872
  ds_read_b128 v[64:67], v76 offset:44032
  s_waitcnt lgkmcnt(2)
  v_smfmac_f32_16x16x64_bf16 v[20:23], v[4:7], v[80:87], v74
  buffer_load_dwordx4 v[44:47], v76, s[8:11], s58 offen offset:0 sc1
  ds_read_b128 v[8:11], v76 offset:6656
  v_smfmac_f32_16x16x64_bf16 v[28:31], v[0:3], v[36:43], v74
  ds_read_b128 v[36:39], v76 offset:57344
  v_smfmac_f32_16x16x64_bf16 v[24:27], v[4:7], v[88:95], v74
  buffer_load_dwordx4 v[48:51], v76, s[8:11], s58 offen offset:1024 sc1
  ds_read_b128 v[40:43], v76 offset:58368
  v_smfmac_f32_16x16x64_bf16 v[28:31], v[4:7], v[208:215], v74
  ds_read_b128 v[12:15], v76 offset:7680
  v_smfmac_f32_16x16x64_bf16 v[32:35], v[4:7], v[216:223], v74
  buffer_load_dwordx4 v[52:55], v76, s[8:11], s59 offen offset:0 sc1
  s_waitcnt lgkmcnt(4)
  v_smfmac_f32_16x16x64_bf16 v[32:35], v[0:3], v[60:67], v74
  ds_read_b128 v[60:63], v76 offset:59392
  s_waitcnt lgkmcnt(4)
  v_smfmac_f32_16x16x64_bf16 v[20:23], v[8:11], v[96:103], v74
  buffer_load_dwordx4 v[56:59], v76, s[8:11], s59 offen offset:1024 sc1
  ds_read_b128 v[64:67], v76 offset:60416
  v_smfmac_f32_16x16x64_bf16 v[24:27], v[8:11], v[104:111], v74
  ds_read_b128 v[0:3], v76 offset:12800
  s_waitcnt lgkmcnt(4)
  v_smfmac_f32_16x16x64_bf16 v[28:31], v[8:11], v[36:43], v74
  ds_read_b128 v[36:39], v75 offset:8192
  s_waitcnt lgkmcnt(4)
  v_smfmac_f32_16x16x64_bf16 v[20:23], v[12:15], v[112:119], v74
  ds_read_b128 v[40:43], v75 offset:9216
  v_smfmac_f32_16x16x64_bf16 v[24:27], v[12:15], v[120:127], v74
  s_waitcnt lgkmcnt(3)
  v_smfmac_f32_16x16x64_bf16 v[32:35], v[8:11], v[60:67], v74
  buffer_store_dwordx4 v[16:19], v76, s[8:11], s68 offen sc1
  ds_read_b128 v[60:63], v75 offset:10240
  v_smfmac_f32_16x16x64_bf16 v[28:31], v[12:15], v[224:231], v74
  buffer_load_dword v73, s[8:11], s70 offen lds
  s_waitcnt vmcnt(6)
  ds_read_b128 v[64:67], v75 offset:11264
  v_smfmac_f32_16x16x64_bf16 v[32:35], v[12:15], v[232:239], v74
  s_barrier
  s_waitcnt lgkmcnt(4)
  v_smfmac_f32_16x16x64_bf16 v[20:23], v[0:3], v[192:199], v74
  ds_read_b128 v[4:7], v76 offset:8704
  s_waitcnt lgkmcnt(3)
  v_smfmac_f32_16x16x64_bf16 v[28:31], v[0:3], v[36:43], v74
  ds_read_b128 v[16:19], v76 offset:9728
  v_smfmac_f32_16x16x64_bf16 v[24:27], v[0:3], v[200:207], v74
  ds_read_b128 v[36:39], v75 offset:24576
  s_waitcnt lgkmcnt(3)
  v_mov_b32 v68, 0x3f803f80
  v_smfmac_f32_16x16x64_bf16 v[32:35], v[0:3], v[60:67], v74
  ds_read_b128 v[40:43], v75 offset:25600
  s_waitcnt lgkmcnt(3)
  v_smfmac_f32_16x16x64_bf16 v[20:23], v[4:7], v[128:135], v74
  ds_read_b128 v[12:15], v76 offset:10752
  v_mov_b32 v69, 0x3f803f80
  v_smfmac_f32_16x16x64_bf16 v[24:27], v[4:7], v[136:143], v74
  ds_read_b128 v[8:11], v76 offset:11776
  s_waitcnt lgkmcnt(4)
  v_smfmac_f32_16x16x64_bf16 v[20:23], v[16:19], v[144:151], v74
  ds_read_b128 v[60:63], v75 offset:26624
  v_mov_b64 v[70:71], v[68:69]
  v_smfmac_f32_16x16x64_bf16 v[24:27], v[16:19], v[152:159], v74
  ds_read_b128 v[64:67], v75 offset:27648
  s_waitcnt lgkmcnt(4)
  v_smfmac_f32_16x16x64_bf16 v[28:31], v[4:7], v[36:43], v74
  s_waitcnt lgkmcnt(3)
  v_mov_b64 v[36:37], 0
  v_smfmac_f32_16x16x64_bf16 v[20:23], v[12:15], v[160:167], v74
  s_waitcnt lgkmcnt(2)
  v_mov_b64 v[38:39], 0
  v_smfmac_f32_16x16x64_bf16 v[20:23], v[8:11], v[176:183], v74
  v_mov_b64 v[40:41], 0
  v_smfmac_f32_16x16x64_bf16 v[24:27], v[12:15], v[168:175], v74
  v_mov_b64 v[42:43], 0
  v_smfmac_f32_16x16x64_bf16 v[24:27], v[8:11], v[184:191], v74
  s_waitcnt lgkmcnt(0)
  v_add_f32 v20, v20, v22
  v_smfmac_f32_16x16x64_bf16 v[32:35], v[4:7], v[60:67], v74
  v_add_f32 v21, v21, v23
  v_smfmac_f32_16x16x64_bf16 v[28:31], v[16:19], v[240:247], v74
  v_add_f32 v24, v24, v26
  v_cvt_pk_bf16_f32 v22, v20, v24
  v_smfmac_f32_16x16x64_bf16 v[28:31], v[12:15], a[0:7], v74
  ds_write_b32 v79, v22 offset:0
  v_add_f32 v25, v25, v27
  v_cvt_pk_bf16_f32 v23, v21, v25
  v_smfmac_f32_16x16x64_bf16 v[28:31], v[8:11], a[16:23], v74
  ds_write_b32 v79, v23 offset:576
  v_cmp_u_f32 vcc, v20, v21
  v_smfmac_f32_16x16x64_bf16 v[32:35], v[16:19], v[248:255], v74
  v_smfmac_f32_16x16x64_bf16 v[32:35], v[12:15], a[8:15], v74
  v_add_f32 v28, v28, v30
  v_add_f32 v29, v29, v31
  v_smfmac_f32_16x16x64_bf16 v[32:35], v[8:11], a[24:31], v74
  s_cbranch_vccnz Cf2_rec
Cf2_recok:
  v_smfmac_f32_16x16x64_bf16 v[36:39], v[16:19], a[112:119], v74
  s_waitcnt lgkmcnt(0)
  s_barrier
  ds_read_b128 v[60:63], v77
  v_smfmac_f32_16x16x64_bf16 v[40:43], v[16:19], a[120:127], v74
  ds_read_b128 v[64:67], v77 offset:128
  v_add_f32 v32, v32, v34
  v_cvt_pk_bf16_f32 v30, v28, v32
  v_smfmac_f32_16x16x64_bf16 v[36:39], v[0:3], a[160:167], v74
  ds_write_b32 v79, v30 offset:256
  v_add_f32 v33, v33, v35
  v_cvt_pk_bf16_f32 v31, v29, v33
  v_smfmac_f32_16x16x64_bf16 v[40:43], v[0:3], a[168:175], v74
  ds_write_b32 v79, v31 offset:832
  v_xor_b32 v75, 0x8000, v75
  v_smfmac_f32_16x16x64_bf16 v[36:39], v[4:7], a[96:103], v74
  ds_read_b128 v[0:3], v76 offset:4608
  v_mov_b32 v29, 0
  v_smfmac_f32_16x16x64_bf16 v[40:43], v[4:7], a[104:111], v74
  s_waitcnt vmcnt(4) lgkmcnt(3)
  v_mov_b32 v30, 0
  v_mfma_f32_16x16x32_bf16 v[44:47], v[44:47], v[60:63], 0
  ds_read_b128 v[4:7], v76 offset:5632
  s_waitcnt lgkmcnt(2)
  v_mfma_f32_16x16x32_bf16 v[44:47], v[48:51], v[64:67], v[44:47]
  s_barrier
  v_smfmac_f32_16x16x64_bf16 v[36:39], v[8:11], a[144:151], v74
  ds_read_b128 v[20:23], v77 offset:256
  ds_read_b128 v[24:27], v77 offset:384
  v_smfmac_f32_16x16x64_bf16 v[40:43], v[8:11], a[152:159], v74
  ds_read_b128 v[8:11], v76 offset:6656
  v_add_f32_dpp v72, v46, v44 quad_perm:[2,3,0,1] row_mask:0xf bank_mask:0xf
  v_add_f32_dpp v73, v47, v45 quad_perm:[2,3,0,1] row_mask:0xf bank_mask:0xf
  v_smfmac_f32_16x16x64_bf16 v[36:39], v[12:15], a[128:135], v74
  ds_read_b128 v[44:47], v75 offset:49152
  v_exp_f32_dpp v72, v72 quad_perm:[0,1,0,1] row_mask:0xf bank_mask:0xf
  v_smfmac_f32_16x16x64_bf16 v[40:43], v[12:15], a[136:143], v74
  ds_read_b128 v[12:15], v76 offset:7680
  s_waitcnt lgkmcnt(6)
  v_exp_f32_dpp v73, v73 quad_perm:[0,1,0,1] row_mask:0xf bank_mask:0xf
  v_smfmac_f32_16x16x64_bf16 v[36:39], v[0:3], a[32:39], v74
  s_waitcnt lgkmcnt(3)
  v_cvt_pk_bf16_f32 v72, v72, v73
  v_mfma_f32_16x16x32_bf16 v[20:23], v[20:23], v[60:63], 0
  ds_write_b32 v78, v72 offset:520
  v_mfma_f32_16x16x32_bf16 v[20:23], v[24:27], v[64:67], v[20:23]
  ds_read_b128 v[48:51], v75 offset:50176
  v_smfmac_f32_16x16x64_bf16 v[40:43], v[0:3], a[40:47], v74
  ds_read_b128 v[60:63], v75 offset:51200
  v_smfmac_f32_16x16x64_bf16 v[36:39], v[4:7], a[48:55], v74
  s_waitcnt lgkmcnt(5)
  v_add_f32_dpp v24, v22, v20 quad_perm:[2,3,0,1] row_mask:0xf bank_mask:0xf
  v_add_f32_dpp v25, v23, v21 quad_perm:[2,3,0,1] row_mask:0xf bank_mask:0xf
  v_smfmac_f32_16x16x64_bf16 v[36:39], v[8:11], a[64:71], v74
  s_waitcnt lgkmcnt(2)
  s_barrier
  ds_read_b128 v[32:35], v78 offset:512
  v_smfmac_f32_16x16x64_bf16 v[36:39], v[12:15], a[80:87], v74
  ds_read_b128 v[64:67], v75 offset:52224
  v_mul_f32 v24, s69, v24
  v_smfmac_f32_16x16x64_bf16 v[40:43], v[4:7], a[56:63], v74
  v_mul_f32 v25, s69, v25
  v_smfmac_f32_16x16x64_bf16 v[40:43], v[8:11], a[72:79], v74
  v_exp_f32_dpp v24, v24 quad_perm:[0,1,0,1] row_mask:0xf bank_mask:0xf
  v_smfmac_f32_16x16x64_bf16 v[40:43], v[12:15], a[88:95], v74
  s_waitcnt vmcnt(2) lgkmcnt(1)
  v_exp_f32_dpp v25, v25 quad_perm:[0,1,0,1] row_mask:0xf bank_mask:0xf
  v_mfma_f32_16x16x32_bf16 v[8:11], v[32:35], v[68:71], 0
  v_add_f32 v36, v36, v38
  v_add_f32 v37, v37, v39
  v_mfma_f32_16x16x32_bf16 v[0:3], v[32:35], v[52:55], 0
  v_add_f32 v40, v40, v42
  v_add_f32 v41, v41, v43
  v_mfma_f32_16x16x32_bf16 v[4:7], v[32:35], v[56:59], 0
  v_cvt_pk_bf16_f32 v28, v24, v25
  v_cvt_pk_bf16_f32 v72, v36, v37
  v_cvt_pk_bf16_f32 v73, v40, v41
  v_mfma_f32_16x16x16_bf16 v[8:11], v[28:29], v[68:69], v[8:11]
  v_cvt_pk_bf16_f32 v31, v24, v25
  v_mfma_f32_16x16x16_bf16 v[0:3], v[28:29], v[72:73], v[0:3]
  ds_read_b128 v[68:71], v76 offset:13824
  v_mfma_f32_16x16x16_bf16 v[4:7], v[30:31], v[72:73], v[4:7]
  v_rcp_f32 v10, v8
  v_rcp_f32 v11, v9
  v_mul_f32 v0, v10, v0
  v_mul_f32 v1, v11, v1
  s_nop 0
  v_mul_f32 v4, v10, v4
  v_mul_f32 v5, v11, v5
  v_cvt_pk_bf16_f32 v2, v0, v4
  ds_write_b32 v79, v2 offset:8704
  v_cvt_pk_bf16_f32 v3, v1, v5
  ds_write_b32 v79, v3 offset:9280
  v_subrev_u32 v8, 813694976, v8
  v_subrev_u32 v9, 813694976, v9
  v_max_u32 v8, v8, v9
  v_cmp_le_u32 vcc, 503316480, v8
  v_mov_b64 v[16:17], 0
  v_mov_b64 v[18:19], 0
  v_mov_b64 v[20:21], 0
  v_mov_b64 v[22:23], 0
  s_cbranch_vccnz Cf2_mx
Cf2_mxok:
  s_cmp_eq_u32 s66, 63
  s_waitcnt lgkmcnt(0)
  s_barrier
  ds_read_b128 v[0:3], v78 offset:8704
  ds_read_b128 v[4:7], v78 offset:8768
  ds_read_b128 v[8:11], v78 offset:8832
  ds_read_b128 v[12:15], v78 offset:8896
  v_mov_b64 v[24:25], 0
  v_mov_b64 v[26:27], 0
  v_mov_b64 v[28:29], 0
  v_mov_b64 v[30:31], 0
  v_mov_b64 v[32:33], 0
  v_mov_b64 v[34:35], 0
  s_waitcnt lgkmcnt(3)
  v_smfmac_f32_16x16x64_bf16 v[16:19], v[0:3], a[176:183], v74
  ds_read_b128 v[52:55], v75 offset:53248
  ds_read_b128 v[56:59], v75 offset:54272
  s_waitcnt lgkmcnt(4)
  v_smfmac_f32_16x16x64_bf16 v[16:19], v[4:7], a[184:191], v74
  ds_read_b128 v[36:39], v75 offset:55296
  s_waitcnt lgkmcnt(4)
  v_smfmac_f32_16x16x64_bf16 v[16:19], v[8:11], a[192:199], v74
  ds_read_b128 v[40:43], v75 offset:56320
  s_waitcnt lgkmcnt(4)
  v_smfmac_f32_16x16x64_bf16 v[16:19], v[12:15], a[200:207], v74
  s_cbranch_scc1 Cf2_last
  v_smfmac_f32_16x16x64_bf16 v[32:35], v[0:3], v[44:51], v74
  ds_read_b128 v[44:47], v75 offset:8192
  ds_read_b128 v[48:51], v75 offset:9216
  v_smfmac_f32_16x16x64_bf16 v[32:35], v[4:7], v[60:67], v74
  ds_read_b128 v[60:63], v75 offset:10240
  s_waitcnt lgkmcnt(5)
  v_cvt_pk_bf16_f32 v16, v16, v17
  v_cvt_pk_bf16_f32 v17, v18, v19
  v_bfi_b32 v16, 1, s72, v16
  v_smfmac_f32_16x16x64_bf16 v[32:35], v[8:11], v[52:59], v74
  ds_read_b128 v[64:67], v75 offset:11264
  buffer_store_dwordx2 v[16:17], v68, s[8:11], s73 offen
  s_waitcnt lgkmcnt(4)
  v_smfmac_f32_16x16x64_bf16 v[32:35], v[12:15], v[36:43], v74
  ds_read_b128 v[52:55], v75 offset:24576
  v_smfmac_f32_16x16x64_bf16 v[20:23], v[0:3], a[208:215], v74
  ds_read_b128 v[56:59], v75 offset:25600
  v_smfmac_f32_16x16x64_bf16 v[20:23], v[4:7], a[216:223], v74
  ds_read_b128 v[36:39], v75 offset:26624
  s_waitcnt lgkmcnt(5)
  v_cvt_pk_bf16_f32 v32, v32, v33
  v_cvt_pk_bf16_f32 v33, v34, v35
  v_bfi_b32 v32, 1, s72, v32
  v_smfmac_f32_16x16x64_bf16 v[20:23], v[8:11], v[44:51], v74
  ds_read_b128 v[40:43], v75 offset:27648
  buffer_store_dwordx2 v[32:33], v68, s[8:11], s77 offen
  s_waitcnt lgkmcnt(4)
  v_mov_b64 v[18:19], v[72:73]
  v_smfmac_f32_16x16x64_bf16 v[20:23], v[12:15], v[60:67], v74
  ds_read_b128 v[44:47], v75 offset:40960
  v_mov_b64 v[32:33], 0
  v_smfmac_f32_16x16x64_bf16 v[24:27], v[0:3], a[224:231], v74
  ds_read_b128 v[48:51], v75 offset:41984
  v_mov_b64 v[34:35], 0
  v_smfmac_f32_16x16x64_bf16 v[24:27], v[4:7], a[232:239], v74
  ds_read_b128 v[60:63], v75 offset:43008
  s_waitcnt lgkmcnt(5)
  v_cvt_pk_bf16_f32 v20, v20, v21
  v_cvt_pk_bf16_f32 v21, v22, v23
  v_bfi_b32 v20, 1, s72, v20
  v_smfmac_f32_16x16x64_bf16 v[24:27], v[8:11], v[52:59], v74
  ds_read_b128 v[64:67], v75 offset:44032
  buffer_store_dwordx2 v[20:21], v68, s[8:11], s74 offen
  s_waitcnt lgkmcnt(4)
  v_smfmac_f32_16x16x64_bf16 v[24:27], v[12:15], v[36:43], v74
  ds_read_b64 v[16:17], v77 offset:384
  v_xor_b32 v75, 0x8000, v75
  v_smfmac_f32_16x16x64_bf16 v[28:31], v[0:3], a[240:247], v74
  v_smfmac_f32_16x16x64_bf16 v[28:31], v[4:7], a[248:255], v74
  s_waitcnt lgkmcnt(3)
  v_cvt_pk_bf16_f32 v24, v24, v25
  v_cvt_pk_bf16_f32 v25, v26, v27
  v_bfi_b32 v24, 1, s72, v24
  v_smfmac_f32_16x16x64_bf16 v[28:31], v[8:11], v[44:51], v74
  buffer_store_dwordx2 v[24:25], v68, s[8:11], s75 offen
  s_waitcnt lgkmcnt(1)
  v_smfmac_f32_16x16x64_bf16 v[28:31], v[12:15], v[60:67], v74
  ds_read_b128 v[0:3], v76 offset:14848
  s_nop 6
  v_cvt_pk_bf16_f32 v28, v28, v29
  v_cvt_pk_bf16_f32 v29, v30, v31
  v_bfi_b32 v28, 1, s72, v28
  buffer_store_dwordx2 v[28:29], v68, s[8:11], s76 offen
  v_mov_b64 v[20:21], 0
  v_mov_b64 v[22:23], 0
  v_mov_b64 v[24:25], 0
  v_mov_b64 v[26:27], 0
  v_mov_b64 v[28:29], 0
  v_mov_b64 v[30:31], 0
  s_add_u32 s58, s58, 524288
  s_add_u32 s59, s59, 524288
  s_add_u32 s70, s70, 524288
  s_add_u32 s68, s68, 131072
  s_add_u32 s66, s66, 1
  s_xor_b32 s64, s64, 16384
  s_xor_b32 s65, s65, 16384
  s_nop 15
  s_nop 15
  s_nop 7
  buffer_load_dwordx4 v[52:55], v76, s[8:11], s60 offen offset:0 sc1
  buffer_load_dwordx4 v[56:59], v76, s[8:11], s60 offen offset:1024 sc1
  s_nop 15
  s_nop 11
  buffer_load_dwordx4 v[36:39], v76, s[8:11], s60 offen offset:0 sc1
  buffer_load_dwordx4 v[40:43], v76, s[8:11], s60 offen offset:1024 sc1
  s_waitcnt vmcnt(3) lgkmcnt(0)
  v_mfma_f32_16x16x32_bf16 v[4:7], v[0:3], v[52:55], 0
  v_bitop3_b32 v72, v52, v54, s72 bitop3:0x7e
  s_waitcnt vmcnt(2)
  v_mfma_f32_16x16x32_bf16 v[4:7], v[0:3], v[56:59], v[4:7]
  v_bitop3_b32 v73, v56, v58, s72 bitop3:0x7e
  v_bitop3_b32 v72, v72, v73, 1 bitop3:0xa8
  v_cmp_ne_u32 vcc, 0, v72
  s_cbranch_vccnz Cf2_h1r
Cf2_h1p:
  s_nop 2
  v_add_f32_dpp v4, v4, v4 row_ror:4 row_mask:0xf bank_mask:0xf
  v_add_f32_dpp v5, v5, v5 row_ror:4 row_mask:0xf bank_mask:0xf
  s_nop 0
  v_add_f32_dpp v4, v4, v4 row_ror:8 row_mask:0xf bank_mask:0xf
  v_add_f32_dpp v5, v5, v5 row_ror:8 row_mask:0xf bank_mask:0xf
  v_cvt_pk_bf16_f32 v4, v4, v5
  buffer_store_dword v4, v69, s[8:11], s62 offen
Cf2_h1ok:
  s_xor_b32 s62, s62, 16384
  s_xor_b32 s72, s72, 1
Cf2_h2:
  v_lshlrev_b32 v73, 2, v76
  s_mov_b32 m0, 8704
  buffer_store_dword v71, v69, s[8:11], s62 offen
  s_waitcnt vmcnt(2)
  ds_read_b128 v[60:63], v76 offset:24576
  ds_read_b128 v[64:67], v76 offset:25600
  ds_read_b128 v[44:47], v76 offset:26624
  ds_read_b128 v[48:51], v76 offset:27648
  ds_read_b128 v[36:39], v76 offset:40960
  ds_read_b128 v[40:43], v76 offset:41984
  s_branch Cf2_top
Cf2_rec:
  s_nop 7
  s_waitcnt vmcnt(0) lgkmcnt(0)
  v_max3_u32 v72, v0, v1, v2
  v_max3_u32 v72, v72, v3, v4
  v_max3_u32 v72, v72, v5, v6
  v_max3_u32 v72, v72, v7, v8
  v_max3_u32 v72, v72, v9, v10
  v_max3_u32 v72, v72, v11, v12
  v_max3_u32 v72, v72, v13, v14
  v_max3_u32 v72, v72, v15, v16
  v_max3_u32 v72, v72, v17, v18
  v_max_u32 v72, v72, v19
  v_cmp_eq_u32 vcc, -1, v72
  s_cbranch_vccz Cf2_recok
  s_barrier
Cf2_recp:
  buffer_load_dwordx4 v[60:63], v76, s[8:11], s64 offen offset:0 sc1
  buffer_load_dwordx4 v[64:67], v76, s[8:11], s64 offen offset:1024 sc1
  s_add_u32 s67, s67, 1
  s_cmp_lt_u32 s67, 131072
  s_cselect_b32 s54, -2, -1
  s_waitcnt vmcnt(1)
  v_max3_u32 v72, v60, v61, v62
  s_waitcnt vmcnt(0)
  v_max3_u32 v72, v72, v63, v64
  v_max3_u32 v72, v72, v65, v66
  v_max_u32 v72, v72, v67
  v_cmp_lt_u32 vcc, s54, v72
  s_cbranch_vccnz Cf2_recp
  ds_write_b128 v76, v[60:63] offset:8704
  ds_write_b128 v76, v[64:67] offset:9728
  v_mov_b64 v[20:21], 0
  v_mov_b64 v[22:23], 0
  v_mov_b64 v[24:25], 0
  v_mov_b64 v[26:27], 0
  v_mov_b64 v[28:29], 0
  v_mov_b64 v[30:31], 0
  v_mov_b64 v[32:33], 0
  v_mov_b64 v[34:35], 0
  s_waitcnt lgkmcnt(0)
  s_barrier
  ds_read_b128 v[0:3], v76 offset:4608
  ds_read_b128 v[60:63], v76 offset:24576
  ds_read_b128 v[64:67], v76 offset:25600
  s_waitcnt lgkmcnt(0)
  v_smfmac_f32_16x16x64_bf16 v[20:23], v[0:3], v[60:67], v74
  ds_read_b128 v[60:63], v76 offset:26624
  ds_read_b128 v[64:67], v76 offset:27648
  s_waitcnt lgkmcnt(0)
  v_smfmac_f32_16x16x64_bf16 v[24:27], v[0:3], v[60:67], v74
  ds_read_b128 v[60:63], v76 offset:40960
  ds_read_b128 v[64:67], v76 offset:41984
  s_waitcnt lgkmcnt(0)
  v_smfmac_f32_16x16x64_bf16 v[28:31], v[0:3], v[60:67], v74
  ds_read_b128 v[60:63], v76 offset:43008
  ds_read_b128 v[64:67], v76 offset:44032
  s_waitcnt lgkmcnt(0)
  v_smfmac_f32_16x16x64_bf16 v[32:35], v[0:3], v[60:67], v74
  ds_read_b128 v[4:7], v76 offset:5632
  s_waitcnt lgkmcnt(0)
  v_smfmac_f32_16x16x64_bf16 v[20:23], v[4:7], v[80:87], v74
  v_smfmac_f32_16x16x64_bf16 v[24:27], v[4:7], v[88:95], v74
  v_smfmac_f32_16x16x64_bf16 v[28:31], v[4:7], v[208:215], v74
  v_smfmac_f32_16x16x64_bf16 v[32:35], v[4:7], v[216:223], v74
  ds_read_b128 v[8:11], v76 offset:6656
  s_waitcnt lgkmcnt(0)
  v_smfmac_f32_16x16x64_bf16 v[20:23], v[8:11], v[96:103], v74
  v_smfmac_f32_16x16x64_bf16 v[24:27], v[8:11], v[104:111], v74
  ds_read_b128 v[60:63], v76 offset:57344
  ds_read_b128 v[64:67], v76 offset:58368
  s_waitcnt lgkmcnt(0)
  v_smfmac_f32_16x16x64_bf16 v[28:31], v[8:11], v[60:67], v74
  ds_read_b128 v[60:63], v76 offset:59392
  ds_read_b128 v[64:67], v76 offset:60416
  s_waitcnt lgkmcnt(0)
  v_smfmac_f32_16x16x64_bf16 v[32:35], v[8:11], v[60:67], v74
  ds_read_b128 v[12:15], v76 offset:7680
  s_waitcnt lgkmcnt(0)
  v_smfmac_f32_16x16x64_bf16 v[20:23], v[12:15], v[112:119], v74
  v_smfmac_f32_16x16x64_bf16 v[24:27], v[12:15], v[120:127], v74
  v_smfmac_f32_16x16x64_bf16 v[28:31], v[12:15], v[224:231], v74
  v_smfmac_f32_16x16x64_bf16 v[32:35], v[12:15], v[232:239], v74
  ds_read_b128 v[4:7], v76 offset:8704
  s_waitcnt lgkmcnt(0)
  v_smfmac_f32_16x16x64_bf16 v[20:23], v[4:7], v[128:135], v74
  v_smfmac_f32_16x16x64_bf16 v[24:27], v[4:7], v[136:143], v74
  ds_read_b128 v[60:63], v75 offset:24576
  ds_read_b128 v[64:67], v75 offset:25600
  s_waitcnt lgkmcnt(0)
  v_smfmac_f32_16x16x64_bf16 v[28:31], v[4:7], v[60:67], v74
  ds_read_b128 v[60:63], v75 offset:26624
  ds_read_b128 v[64:67], v75 offset:27648
  s_waitcnt lgkmcnt(0)
  v_smfmac_f32_16x16x64_bf16 v[32:35], v[4:7], v[60:67], v74
  ds_read_b128 v[16:19], v76 offset:9728
  s_waitcnt lgkmcnt(0)
  v_smfmac_f32_16x16x64_bf16 v[20:23], v[16:19], v[144:151], v74
  v_smfmac_f32_16x16x64_bf16 v[24:27], v[16:19], v[152:159], v74
  v_smfmac_f32_16x16x64_bf16 v[28:31], v[16:19], v[240:247], v74
  v_smfmac_f32_16x16x64_bf16 v[32:35], v[16:19], v[248:255], v74
  ds_read_b128 v[12:15], v76 offset:10752
  s_waitcnt lgkmcnt(0)
  v_smfmac_f32_16x16x64_bf16 v[20:23], v[12:15], v[160:167], v74
  v_smfmac_f32_16x16x64_bf16 v[24:27], v[12:15], v[168:175], v74
  v_smfmac_f32_16x16x64_bf16 v[28:31], v[12:15], a[0:7], v74
  v_smfmac_f32_16x16x64_bf16 v[32:35], v[12:15], a[8:15], v74
  ds_read_b128 v[8:11], v76 offset:11776
  s_waitcnt lgkmcnt(0)
  v_smfmac_f32_16x16x64_bf16 v[20:23], v[8:11], v[176:183], v74
  v_smfmac_f32_16x16x64_bf16 v[24:27], v[8:11], v[184:191], v74
  v_smfmac_f32_16x16x64_bf16 v[28:31], v[8:11], a[16:23], v74
  v_smfmac_f32_16x16x64_bf16 v[32:35], v[8:11], a[24:31], v74
  ds_read_b128 v[0:3], v76 offset:12800
  s_waitcnt lgkmcnt(0)
  v_smfmac_f32_16x16x64_bf16 v[20:23], v[0:3], v[192:199], v74
  v_smfmac_f32_16x16x64_bf16 v[24:27], v[0:3], v[200:207], v74
  ds_read_b128 v[60:63], v75 offset:8192
  ds_read_b128 v[64:67], v75 offset:9216
  s_waitcnt lgkmcnt(0)
  v_smfmac_f32_16x16x64_bf16 v[28:31], v[0:3], v[60:67], v74
  ds_read_b128 v[60:63], v75 offset:10240
  ds_read_b128 v[64:67], v75 offset:11264
  s_waitcnt lgkmcnt(0)
  v_smfmac_f32_16x16x64_bf16 v[32:35], v[0:3], v[60:67], v74
  v_add_f32 v20, v20, v22
  v_add_f32 v21, v21, v23
  v_add_f32 v24, v24, v26
  v_cvt_pk_bf16_f32 v22, v20, v24
  ds_write_b32 v79, v22 offset:0
  v_add_f32 v25, v25, v27
  v_cvt_pk_bf16_f32 v23, v21, v25
  ds_write_b32 v79, v23 offset:576
  v_add_f32 v28, v28, v30
  v_add_f32 v29, v29, v31
  s_waitcnt lgkmcnt(0)
  s_nop 1
  s_branch Cf2_recok
Cf2_mx:
  s_waitcnt lgkmcnt(0)
  s_barrier
  buffer_load_dwordx4 v[0:3], v76, s[8:11], s58 offen offset:0 sc1
  ds_read_b128 v[20:23], v77 offset:0
  ds_read_b128 v[28:31], v77 offset:256
  buffer_load_dwordx4 v[4:7], v76, s[8:11], s58 offen offset:1024 sc1
  ds_read_b128 v[24:27], v77 offset:128
  ds_read_b128 v[32:35], v77 offset:384
  s_waitcnt vmcnt(1) lgkmcnt(3)
  v_mfma_f32_16x16x32_bf16 v[8:11], v[0:3], v[20:23], 0
  s_waitcnt vmcnt(0) lgkmcnt(1)
  v_mfma_f32_16x16x32_bf16 v[8:11], v[4:7], v[24:27], v[8:11]
  v_mfma_f32_16x16x32_bf16 v[12:15], v[28:31], v[20:23], 0
  s_waitcnt lgkmcnt(0)
  v_mfma_f32_16x16x32_bf16 v[12:15], v[32:35], v[24:27], v[12:15]
  v_add_f32_dpp v8, v10, v8 quad_perm:[2,3,0,1] row_mask:0xf bank_mask:0xf
  v_add_f32_dpp v9, v11, v9 quad_perm:[2,3,0,1] row_mask:0xf bank_mask:0xf
  s_nop 0
  v_mov_b32_dpp v8, v8 quad_perm:[0,1,0,1] row_mask:0xf bank_mask:0xf
  v_mov_b32_dpp v9, v9 quad_perm:[0,1,0,1] row_mask:0xf bank_mask:0xf
  s_nop 1
  v_add_f32_dpp v12, v14, v12 quad_perm:[2,3,0,1] row_mask:0xf bank_mask:0xf
  v_add_f32_dpp v13, v15, v13 quad_perm:[2,3,0,1] row_mask:0xf bank_mask:0xf
  s_nop 0
  v_mov_b32_dpp v12, v12 quad_perm:[0,1,0,1] row_mask:0xf bank_mask:0xf
  v_mov_b32_dpp v13, v13 quad_perm:[0,1,0,1] row_mask:0xf bank_mask:0xf
  v_mul_f32 v12, s69, v12
  ds_write_b32 v78, v8 offset:8712
  v_mul_f32 v13, s69, v13
  ds_write_b32 v78, v9 offset:8776
  s_waitcnt lgkmcnt(0)
  s_barrier
  ds_read_b128 v[36:39], v78 offset:8704
  ds_read_b128 v[40:43], v78 offset:8768
  s_waitcnt lgkmcnt(0)
  s_barrier
  v_max_f32 v16, v36, v37
  v_max3_f32 v16, v16, v38, v39
  v_max3_f32 v16, v16, v40, v41
  v_max3_f32 v16, v16, v42, v43
  v_max3_f32 v16, v16, v12, v13
  v_mov_b32 v17, v16
  s_nop 1
  v_permlane16_swap_b32 v16, v17
  v_max_f32 v16, v16, v17
  v_mov_b32 v17, v16
  s_nop 1
  v_permlane32_swap_b32 v16, v17
  v_max_f32 v16, v16, v17
  v_sub_f32 v36, v36, v16
  v_sub_f32 v37, v37, v16
  v_sub_f32 v38, v38, v16
  v_sub_f32 v39, v39, v16
  v_sub_f32 v40, v40, v16
  v_sub_f32 v41, v41, v16
  v_sub_f32 v42, v42, v16
  v_sub_f32 v43, v43, v16
  v_sub_f32 v12, v12, v16
  v_sub_f32 v13, v13, v16
  v_exp_f32 v36, v36
  v_exp_f32 v37, v37
  v_exp_f32 v38, v38
  v_exp_f32 v39, v39
  v_exp_f32 v40, v40
  v_exp_f32 v41, v41
  v_exp_f32 v42, v42
  v_exp_f32 v43, v43
  v_exp_f32 v12, v12
  v_exp_f32 v13, v13
  v_cvt_pk_bf16_f32 v32, v36, v40
  v_cvt_pk_bf16_f32 v33, v37, v41
  v_cvt_pk_bf16_f32 v34, v38, v42
  v_cvt_pk_bf16_f32 v35, v39, v43
  v_cvt_pk_bf16_f32 v28, v12, v13
  v_cvt_pk_bf16_f32 v31, v12, v13
  v_mov_b32 v29, 0
  v_mov_b32 v30, 0
  v_mov_b32 v68, 0x3f803f80
  v_mov_b32 v69, 0x3f803f80
  v_mov_b32 v70, 0x3f803f80
  v_mov_b32 v71, 0x3f803f80
  s_nop 1
  v_mfma_f32_16x16x32_bf16 v[8:11], v[32:35], v[68:71], 0
  v_mfma_f32_16x16x32_bf16 v[0:3], v[32:35], v[52:55], 0
  v_mfma_f32_16x16x32_bf16 v[4:7], v[32:35], v[56:59], 0
  v_mfma_f32_16x16x16_bf16 v[8:11], v[28:29], v[68:69], v[8:11]
  v_mfma_f32_16x16x16_bf16 v[0:3], v[28:29], v[72:73], v[0:3]
  v_mfma_f32_16x16x16_bf16 v[4:7], v[30:31], v[72:73], v[4:7]
  ds_read_b128 v[68:71], v76 offset:13824
  v_rcp_f32 v10, v8
  v_rcp_f32 v11, v9
  v_mul_f32 v0, v10, v0
  v_mul_f32 v1, v11, v1
  s_nop 0
  v_mul_f32 v4, v10, v4
  v_mul_f32 v5, v11, v5
  v_cvt_pk_bf16_f32 v2, v0, v4
  ds_write_b32 v79, v2 offset:8704
  v_cvt_pk_bf16_f32 v3, v1, v5
  ds_write_b32 v79, v3 offset:9280
  v_mov_b64 v[16:17], 0
  v_mov_b64 v[18:19], 0
  v_mov_b64 v[20:21], 0
  v_mov_b64 v[22:23], 0
  s_branch Cf2_mxok
Cf2_h1r:
  s_mov_b64 exec, vcc
  buffer_load_dwordx4 v[52:55], v76, s[8:11], s60 offen offset:0 sc1
  buffer_load_dwordx4 v[56:59], v76, s[8:11], s60 offen offset:1024 sc1
  s_mov_b64 exec, -1
  s_add_u32 s67, s67, 1
  s_waitcnt vmcnt(3)
  v_mfma_f32_16x16x32_bf16 v[4:7], v[0:3], v[36:39], 0
  v_bitop3_b32 v72, v36, v38, s72 bitop3:0x7e
  s_waitcnt vmcnt(2)
  v_mfma_f32_16x16x32_bf16 v[4:7], v[0:3], v[40:43], v[4:7]
  v_bitop3_b32 v73, v40, v42, s72 bitop3:0x7e
  v_bitop3_b32 v72, v72, v73, 1 bitop3:0xa8
  v_cmp_ne_u32 vcc, 0, v72
  s_cbranch_vccz Cf2_h1p
  s_mov_b64 exec, vcc
  buffer_load_dwordx4 v[36:39], v76, s[8:11], s60 offen offset:0 sc1
  buffer_load_dwordx4 v[40:43], v76, s[8:11], s60 offen offset:1024 sc1
  s_mov_b64 exec, -1
  s_add_u32 s67, s67, 1
  s_waitcnt vmcnt(3)
  v_mfma_f32_16x16x32_bf16 v[4:7], v[0:3], v[52:55], 0
  v_bitop3_b32 v72, v52, v54, s72 bitop3:0x7e
  s_waitcnt vmcnt(2)
  v_mfma_f32_16x16x32_bf16 v[4:7], v[0:3], v[56:59], v[4:7]
  v_bitop3_b32 v73, v56, v58, s72 bitop3:0x7e
  v_bitop3_b32 v72, v72, v73, 1 bitop3:0xa8
  v_cmp_ne_u32 vcc, 0, v72
  s_cbranch_vccz Cf2_h1p
  s_cmp_lt_u32 s67, 131072
  s_cbranch_scc1 Cf2_h1r
  s_branch Cf2_h1p
Cf2_last:
  s_nop 7
  s_waitcnt vmcnt(0) lgkmcnt(0)
  ds_read_b64 v[16:17], v77 offset:384
  v_mov_b64 v[18:19], v[72:73]
  s_add_u32 s68, s68, 131072
  s_waitcnt lgkmcnt(0)
  buffer_store_dwordx4 v[16:19], v76, s[8:11], s68 offen sc1
  s_waitcnt vmcnt(0)
  s_barrier
  s_branch L_cexit
L_w3:
  v_mov_b64 v[20:21], 0
  v_mov_b64 v[22:23], 0
  v_mov_b64 v[24:25], 0
  v_mov_b64 v[26:27], 0
  v_mov_b64 v[28:29], 0
  v_mov_b64 v[30:31], 0
  v_mov_b64 v[32:33], 0
  v_mov_b64 v[34:35], 0
  s_mov_b32 m0, 15872
  s_branch Cf3_h2
.p2align 6
Cf3_top:
  s_waitcnt lgkmcnt(0)
  s_barrier
  ds_read_b128 v[0:3], v76 offset:4608
  ds_read_b128 v[4:7], v76 offset:5632
  buffer_load_dwordx4 v76, s[8:11], s64 offen offset:0 sc1 lds
  buffer_load_dwordx4 v76, s[8:11], s64 offen offset:1024 sc1 lds
  s_waitcnt lgkmcnt(1)
  v_smfmac_f32_16x16x64_bf16 v[20:23], v[0:3], v[60:67], v74
  ds_read_b128 v[60:63], v76 offset:47104
  v_smfmac_f32_16x16x64_bf16 v[24:27], v[0:3], v[44:51], v74
  s_mov_b32 m0, 15872
  ds_read_b128 v[64:67], v76 offset:48128
  s_waitcnt lgkmcnt(2)
  v_smfmac_f32_16x16x64_bf16 v[20:23], v[4:7], v[80:87], v74
  buffer_load_dwordx4 v[44:47], v76, s[8:11], s58 offen offset:0 sc1
  ds_read_b128 v[8:11], v76 offset:6656
  v_smfmac_f32_16x16x64_bf16 v[28:31], v[0:3], v[36:43], v74
  ds_read_b128 v[36:39], v76 offset:61440
  v_smfmac_f32_16x16x64_bf16 v[24:27], v[4:7], v[88:95], v74
  buffer_load_dwordx4 v[48:51], v76, s[8:11], s58 offen offset:1024 sc1
  ds_read_b128 v[40:43], v76 offset:62464
  v_smfmac_f32_16x16x64_bf16 v[28:31], v[4:7], v[208:215], v74
  ds_read_b128 v[12:15], v76 offset:7680
  v_smfmac_f32_16x16x64_bf16 v[32:35], v[4:7], v[216:223], v74
  buffer_load_dwordx4 v[52:55], v76, s[8:11], s59 offen offset:0 sc1
  s_waitcnt lgkmcnt(4)
  v_smfmac_f32_16x16x64_bf16 v[32:35], v[0:3], v[60:67], v74
  ds_read_b128 v[60:63], v76 offset:63488
  s_waitcnt lgkmcnt(4)
  v_smfmac_f32_16x16x64_bf16 v[20:23], v[8:11], v[96:103], v74
  buffer_load_dwordx4 v[56:59], v76, s[8:11], s59 offen offset:1024 sc1
  ds_read_b128 v[64:67], v76 offset:64512
  v_smfmac_f32_16x16x64_bf16 v[24:27], v[8:11], v[104:111], v74
  ds_read_b128 v[0:3], v76 offset:12800
  s_waitcnt lgkmcnt(4)
  v_smfmac_f32_16x16x64_bf16 v[28:31], v[8:11], v[36:43], v74
  ds_read_b128 v[36:39], v75 offset:12288
  s_waitcnt lgkmcnt(4)
  v_smfmac_f32_16x16x64_bf16 v[20:23], v[12:15], v[112:119], v74
  ds_read_b128 v[40:43], v75 offset:13312
  v_smfmac_f32_16x16x64_bf16 v[24:27], v[12:15], v[120:127], v74
  buffer_load_dword v73, s[8:11], s70 offen lds
  s_waitcnt lgkmcnt(3)
  v_smfmac_f32_16x16x64_bf16 v[32:35], v[8:11], v[60:67], v74
  ds_read_b128 v[60:63], v75 offset:14336
  v_smfmac_f32_16x16x64_bf16 v[28:31], v[12:15], v[224:231], v74
  s_waitcnt vmcnt(5)
  ds_read_b128 v[64:67], v75 offset:15360
  v_smfmac_f32_16x16x64_bf16 v[32:35], v[12:15], v[232:239], v74
  buffer_store_dwordx4 v[16:19], v76, s[8:11], s68 offen sc1
  s_barrier
  s_waitcnt lgkmcnt(4)
  v_smfmac_f32_16x16x64_bf16 v[20:23], v[0:3], v[192:199], v74
  ds_read_b128 v[4:7], v76 offset:8704
  s_waitcnt lgkmcnt(3)
  v_smfmac_f32_16x16x64_bf16 v[28:31], v[0:3], v[36:43], v74
  ds_read_b128 v[16:19], v76 offset:9728
  v_smfmac_f32_16x16x64_bf16 v[24:27], v[0:3], v[200:207], v74
  ds_read_b128 v[36:39], v75 offset:28672
  s_waitcnt lgkmcnt(3)
  v_mov_b32 v68, 0x3f803f80
  v_smfmac_f32_16x16x64_bf16 v[32:35], v[0:3], v[60:67], v74
  ds_read_b128 v[40:43], v75 offset:29696
  s_waitcnt lgkmcnt(3)
  v_smfmac_f32_16x16x64_bf16 v[20:23], v[4:7], v[128:135], v74
  ds_read_b128 v[12:15], v76 offset:10752
  v_mov_b32 v69, 0x3f803f80
  v_smfmac_f32_16x16x64_bf16 v[24:27], v[4:7], v[136:143], v74
  ds_read_b128 v[8:11], v76 offset:11776
  s_waitcnt lgkmcnt(4)
  v_smfmac_f32_16x16x64_bf16 v[20:23], v[16:19], v[144:151], v74
  ds_read_b128 v[60:63], v75 offset:30720
  v_mov_b64 v[70:71], v[68:69]
  v_smfmac_f32_16x16x64_bf16 v[24:27], v[16:19], v[152:159], v74
  ds_read_b128 v[64:67], v75 offset:31744
  s_waitcnt lgkmcnt(4)
  v_smfmac_f32_16x16x64_bf16 v[28:31], v[4:7], v[36:43], v74
  s_waitcnt lgkmcnt(3)
  v_mov_b64 v[36:37], 0
  v_smfmac_f32_16x16x64_bf16 v[20:23], v[12:15], v[160:167], v74
  s_waitcnt lgkmcnt(2)
  v_mov_b64 v[38:39], 0
  v_smfmac_f32_16x16x64_bf16 v[20:23], v[8:11], v[176:183], v74
  v_mov_b64 v[40:41], 0
  v_smfmac_f32_16x16x64_bf16 v[24:27], v[12:15], v[168:175], v74
  v_mov_b64 v[42:43], 0
  v_smfmac_f32_16x16x64_bf16 v[24:27], v[8:11], v[184:191], v74
  s_waitcnt lgkmcnt(0)
  v_add_f32 v20, v20, v22
  v_smfmac_f32_16x16x64_bf16 v[32:35], v[4:7], v[60:67], v74
  v_add_f32 v21, v21, v23
  v_smfmac_f32_16x16x64_bf16 v[28:31], v[16:19], v[240:247], v74
  v_add_f32 v24, v24, v26
  v_cvt_pk_bf16_f32 v22, v20, v24
  v_smfmac_f32_16x16x64_bf16 v[28:31], v[12:15], a[0:7], v74
  ds_write_b32 v79, v22 offset:0
  v_add_f32 v25, v25, v27
  v_cvt_pk_bf16_f32 v23, v21, v25
  v_smfmac_f32_16x16x64_bf16 v[28:31], v[8:11], a[16:23], v74
  ds_write_b32 v79, v23 offset:576
  v_cmp_u_f32 vcc, v20, v21
  v_smfmac_f32_16x16x64_bf16 v[32:35], v[16:19], v[248:255], v74
  v_smfmac_f32_16x16x64_bf16 v[32:35], v[12:15], a[8:15], v74
  v_add_f32 v28, v28, v30
  v_add_f32 v29, v29, v31
  v_smfmac_f32_16x16x64_bf16 v[32:35], v[8:11], a[24:31], v74
  s_cbranch_vccnz Cf3_rec
Cf3_recok:
  v_smfmac_f32_16x16x64_bf16 v[36:39], v[16:19], a[112:119], v74
  s_waitcnt lgkmcnt(0)
  s_barrier
  ds_read_b128 v[60:63], v77
  v_smfmac_f32_16x16x64_bf16 v[40:43], v[16:19], a[120:127], v74
  ds_read_b128 v[64:67], v77 offset:128
  v_add_f32 v32, v32, v34
  v_cvt_pk_bf16_f32 v30, v28, v32
  v_smfmac_f32_16x16x64_bf16 v[36:39], v[0:3], a[160:167], v74
  ds_write_b32 v79, v30 offset:256
  v_add_f32 v33, v33, v35
  v_cvt_pk_bf16_f32 v31, v29, v33
  v_smfmac_f32_16x16x64_bf16 v[40:43], v[0:3], a[168:175], v74
  ds_write_b32 v79, v31 offset:832
  v_xor_b32 v75, 0x8000, v75
  v_smfmac_f32_16x16x64_bf16 v[36:39], v[4:7], a[96:103], v74
  ds_read_b128 v[0:3], v76 offset:4608
  v_mov_b32 v29, 0
  v_smfmac_f32_16x16x64_bf16 v[40:43], v[4:7], a[104:111], v74
  s_waitcnt vmcnt(4) lgkmcnt(3)
  v_mov_b32 v30, 0
  v_mfma_f32_16x16x32_bf16 v[44:47], v[44:47], v[60:63], 0
  ds_read_b128 v[4:7], v76 offset:5632
  s_waitcnt lgkmcnt(2)
  v_mfma_f32_16x16x32_bf16 v[44:47], v[48:51], v[64:67], v[44:47]
  s_barrier
  v_smfmac_f32_16x16x64_bf16 v[36:39], v[8:11], a[144:151], v74
  ds_read_b128 v[20:23], v77 offset:256
  ds_read_b128 v[24:27], v77 offset:384
  v_smfmac_f32_16x16x64_bf16 v[40:43], v[8:11], a[152:159], v74
  ds_read_b128 v[8:11], v76 offset:6656
  v_add_f32_dpp v72, v46, v44 quad_perm:[2,3,0,1] row_mask:0xf bank_mask:0xf
  v_add_f32_dpp v73, v47, v45 quad_perm:[2,3,0,1] row_mask:0xf bank_mask:0xf
  v_smfmac_f32_16x16x64_bf16 v[36:39], v[12:15], a[128:135], v74
  ds_read_b128 v[44:47], v75 offset:57344
  v_exp_f32_dpp v72, v72 quad_perm:[0,1,0,1] row_mask:0xf bank_mask:0xf
  v_smfmac_f32_16x16x64_bf16 v[40:43], v[12:15], a[136:143], v74
  ds_read_b128 v[12:15], v76 offset:7680
  s_waitcnt lgkmcnt(6)
  v_exp_f32_dpp v73, v73 quad_perm:[0,1,0,1] row_mask:0xf bank_mask:0xf
  v_smfmac_f32_16x16x64_bf16 v[36:39], v[0:3], a[32:39], v74
  s_waitcnt lgkmcnt(3)
  v_cvt_pk_bf16_f32 v72, v72, v73
  v_mfma_f32_16x16x32_bf16 v[20:23], v[20:23], v[60:63], 0
  ds_write_b32 v78, v72 offset:524
  v_mfma_f32_16x16x32_bf16 v[20:23], v[24:27], v[64:67], v[20:23]
  ds_read_b128 v[48:51], v75 offset:58368
  v_smfmac_f32_16x16x64_bf16 v[40:43], v[0:3], a[40:47], v74
  ds_read_b128 v[60:63], v75 offset:59392
  v_smfmac_f32_16x16x64_bf16 v[36:39], v[4:7], a[48:55], v74
  s_waitcnt lgkmcnt(5)
  v_add_f32_dpp v24, v22, v20 quad_perm:[2,3,0,1] row_mask:0xf bank_mask:0xf
  v_add_f32_dpp v25, v23, v21 quad_perm:[2,3,0,1] row_mask:0xf bank_mask:0xf
  v_smfmac_f32_16x16x64_bf16 v[36:39], v[8:11], a[64:71], v74
  s_waitcnt lgkmcnt(2)
  s_barrier
  ds_read_b128 v[32:35], v78 offset:512
  v_smfmac_f32_16x16x64_bf16 v[36:39], v[12:15], a[80:87], v74
  ds_read_b128 v[64:67], v75 offset:60416
  v_mul_f32 v24, s69, v24
  v_smfmac_f32_16x16x64_bf16 v[40:43], v[4:7], a[56:63], v74
  v_mul_f32 v25, s69, v25
  v_smfmac_f32_16x16x64_bf16 v[40:43], v[8:11], a[72:79], v74
  v_exp_f32_dpp v24, v24 quad_perm:[0,1,0,1] row_mask:0xf bank_mask:0xf
  v_smfmac_f32_16x16x64_bf16 v[40:43], v[12:15], a[88:95], v74
  s_waitcnt vmcnt(2) lgkmcnt(1)
  v_exp_f32_dpp v25, v25 quad_perm:[0,1,0,1] row_mask:0xf bank_mask:0xf
  v_mfma_f32_16x16x32_bf16 v[8:11], v[32:35], v[68:71], 0
  v_add_f32 v36, v36, v38
  v_add_f32 v37, v37, v39
  v_mfma_f32_16x16x32_bf16 v[0:3], v[32:35], v[52:55], 0
  v_add_f32 v40, v40, v42
  v_add_f32 v41, v41, v43
  v_mfma_f32_16x16x32_bf16 v[4:7], v[32:35], v[56:59], 0
  v_cvt_pk_bf16_f32 v28, v24, v25
  v_cvt_pk_bf16_f32 v72, v36, v37
  v_cvt_pk_bf16_f32 v73, v40, v41
  v_mfma_f32_16x16x16_bf16 v[8:11], v[28:29], v[68:69], v[8:11]
  v_cvt_pk_bf16_f32 v31, v24, v25
  v_mfma_f32_16x16x16_bf16 v[0:3], v[28:29], v[72:73], v[0:3]
  ds_read_b128 v[68:71], v76 offset:13824
  v_mfma_f32_16x16x16_bf16 v[4:7], v[30:31], v[72:73], v[4:7]
  v_rcp_f32 v10, v8
  v_rcp_f32 v11, v9
  v_mul_f32 v0, v10, v0
  v_mul_f32 v1, v11, v1
  s_nop 0
  v_mul_f32 v4, v10, v4
  v_mul_f32 v5, v11, v5
  v_cvt_pk_bf16_f32 v2, v0, v4
  ds_write_b32 v79, v2 offset:8704
  v_cvt_pk_bf16_f32 v3, v1, v5
  ds_write_b32 v79, v3 offset:9280
  v_subrev_u32 v8, 813694976, v8
  v_subrev_u32 v9, 813694976, v9
  v_max_u32 v8, v8, v9
  v_cmp_le_u32 vcc, 503316480, v8
  v_mov_b64 v[16:17], 0
  v_mov_b64 v[18:19], 0
  v_mov_b64 v[20:21], 0
  v_mov_b64 v[22:23], 0
  s_cbranch_vccnz Cf3_mx
Cf3_mxok:
  s_cmp_eq_u32 s66, 63
  s_waitcnt lgkmcnt(0)
  s_barrier
  ds_read_b128 v[0:3], v78 offset:8704
  ds_read_b128 v[4:7], v78 offset:8768
  ds_read_b128 v[8:11], v78 offset:8832
  ds_read_b128 v[12:15], v78 offset:8896
  v_mov_b64 v[24:25], 0
  v_mov_b64 v[26:27], 0
  v_mov_b64 v[28:29], 0
  v_mov_b64 v[30:31], 0
  v_mov_b64 v[32:33], 0
  v_mov_b64 v[34:35], 0
  s_waitcnt lgkmcnt(3)
  v_smfmac_f32_16x16x64_bf16 v[16:19], v[0:3], a[176:183], v74
  ds_read_b128 v[52:55], v75 offset:61440
  ds_read_b128 v[56:59], v75 offset:62464
  s_waitcnt lgkmcnt(4)
  v_smfmac_f32_16x16x64_bf16 v[16:19], v[4:7], a[184:191], v74
  ds_read_b128 v[36:39], v75 offset:63488
  s_waitcnt lgkmcnt(4)
  v_smfmac_f32_16x16x64_bf16 v[16:19], v[8:11], a[192:199], v74
  ds_read_b128 v[40:43], v75 offset:64512
  s_waitcnt lgkmcnt(4)
  v_smfmac_f32_16x16x64_bf16 v[16:19], v[12:15], a[200:207], v74
  s_cbranch_scc1 Cf3_last
  v_smfmac_f32_16x16x64_bf16 v[32:35], v[0:3], v[44:51], v74
  ds_read_b128 v[44:47], v75 offset:12288
  ds_read_b128 v[48:51], v75 offset:13312
  v_smfmac_f32_16x16x64_bf16 v[32:35], v[4:7], v[60:67], v74
  ds_read_b128 v[60:63], v75 offset:14336
  s_waitcnt lgkmcnt(5)
  v_cvt_pk_bf16_f32 v16, v16, v17
  v_cvt_pk_bf16_f32 v17, v18, v19
  v_bfi_b32 v16, 1, s72, v16
  v_smfmac_f32_16x16x64_bf16 v[32:35], v[8:11], v[52:59], v74
  ds_read_b128 v[64:67], v75 offset:15360
  buffer_store_dwordx2 v[16:17], v68, s[8:11], s73 offen
  s_waitcnt lgkmcnt(4)
  v_smfmac_f32_16x16x64_bf16 v[32:35], v[12:15], v[36:43], v74
  ds_read_b128 v[52:55], v75 offset:28672
  v_smfmac_f32_16x16x64_bf16 v[20:23], v[0:3], a[208:215], v74
  ds_read_b128 v[56:59], v75 offset:29696
  v_smfmac_f32_16x16x64_bf16 v[20:23], v[4:7], a[216:223], v74
  ds_read_b128 v[36:39], v75 offset:30720
  s_waitcnt lgkmcnt(5)
  v_cvt_pk_bf16_f32 v32, v32, v33
  v_cvt_pk_bf16_f32 v33, v34, v35
  v_bfi_b32 v32, 1, s72, v32
  v_smfmac_f32_16x16x64_bf16 v[20:23], v[8:11], v[44:51], v74
  ds_read_b128 v[40:43], v75 offset:31744
  buffer_store_dwordx2 v[32:33], v68, s[8:11], s77 offen
  s_waitcnt lgkmcnt(4)
  v_mov_b64 v[18:19], v[72:73]
  v_smfmac_f32_16x16x64_bf16 v[20:23], v[12:15], v[60:67], v74
  ds_read_b128 v[44:47], v75 offset:45056
  v_mov_b64 v[32:33], 0
  v_smfmac_f32_16x16x64_bf16 v[24:27], v[0:3], a[224:231], v74
  ds_read_b128 v[48:51], v75 offset:46080
  v_mov_b64 v[34:35], 0
  v_smfmac_f32_16x16x64_bf16 v[24:27], v[4:7], a[232:239], v74
  ds_read_b128 v[60:63], v75 offset:47104
  s_waitcnt lgkmcnt(5)
  v_cvt_pk_bf16_f32 v20, v20, v21
  v_cvt_pk_bf16_f32 v21, v22, v23
  v_bfi_b32 v20, 1, s72, v20
  v_smfmac_f32_16x16x64_bf16 v[24:27], v[8:11], v[52:59], v74
  ds_read_b128 v[64:67], v75 offset:48128
  buffer_store_dwordx2 v[20:21], v68, s[8:11], s74 offen
  s_waitcnt lgkmcnt(4)
  v_smfmac_f32_16x16x64_bf16 v[24:27], v[12:15], v[36:43], v74
  ds_read_b64 v[16:17], v77 offset:392
  v_xor_b32 v75, 0x8000, v75
  v_smfmac_f32_16x16x64_bf16 v[28:31], v[0:3], a[240:247], v74
  v_smfmac_f32_16x16x64_bf16 v[28:31], v[4:7], a[248:255], v74
  s_waitcnt lgkmcnt(3)
  v_cvt_pk_bf16_f32 v24, v24, v25
  v_cvt_pk_bf16_f32 v25, v26, v27
  v_bfi_b32 v24, 1, s72, v24
  v_smfmac_f32_16x16x64_bf16 v[28:31], v[8:11], v[44:51], v74
  buffer_store_dwordx2 v[24:25], v68, s[8:11], s75 offen
  s_waitcnt lgkmcnt(1)
  v_smfmac_f32_16x16x64_bf16 v[28:31], v[12:15], v[60:67], v74
  ds_read_b128 v[0:3], v76 offset:14848
  s_nop 6
  v_cvt_pk_bf16_f32 v28, v28, v29
  v_cvt_pk_bf16_f32 v29, v30, v31
  v_bfi_b32 v28, 1, s72, v28
  buffer_store_dwordx2 v[28:29], v68, s[8:11], s76 offen
  v_mov_b64 v[20:21], 0
  v_mov_b64 v[22:23], 0
  v_mov_b64 v[24:25], 0
  v_mov_b64 v[26:27], 0
  v_mov_b64 v[28:29], 0
  v_mov_b64 v[30:31], 0
  s_add_u32 s58, s58, 524288
  s_add_u32 s59, s59, 524288
  s_add_u32 s70, s70, 524288
  s_add_u32 s68, s68, 131072
  s_add_u32 s66, s66, 1
  s_xor_b32 s64, s64, 16384
  s_xor_b32 s65, s65, 16384
  s_nop 15
  s_nop 15
  s_nop 15
  s_nop 7
  buffer_load_dwordx4 v[52:55], v76, s[8:11], s60 offen offset:0 sc1
  buffer_load_dwordx4 v[56:59], v76, s[8:11], s60 offen offset:1024 sc1
  s_nop 15
  s_nop 11
  buffer_load_dwordx4 v[36:39], v76, s[8:11], s60 offen offset:0 sc1
  buffer_load_dwordx4 v[40:43], v76, s[8:11], s60 offen offset:1024 sc1
  s_waitcnt lgkmcnt(0)
  s_cmp_eq_u32 s66, 12
  s_cbranch_scc1 Cf3_kv
Cf3_kvb:
  s_waitcnt vmcnt(3)
  v_mfma_f32_16x16x32_bf16 v[4:7], v[0:3], v[52:55], 0
  v_bitop3_b32 v72, v52, v54, s72 bitop3:0x7e
  s_waitcnt vmcnt(2)
  v_mfma_f32_16x16x32_bf16 v[4:7], v[0:3], v[56:59], v[4:7]
  v_bitop3_b32 v73, v56, v58, s72 bitop3:0x7e
  v_bitop3_b32 v72, v72, v73, 1 bitop3:0xa8
  v_cmp_ne_u32 vcc, 0, v72
  s_cbranch_vccnz Cf3_h1r
Cf3_h1p:
  s_nop 2
  v_add_f32_dpp v4, v4, v4 row_ror:4 row_mask:0xf bank_mask:0xf
  v_add_f32_dpp v5, v5, v5 row_ror:4 row_mask:0xf bank_mask:0xf
  s_nop 0
  v_add_f32_dpp v4, v4, v4 row_ror:8 row_mask:0xf bank_mask:0xf
  v_add_f32_dpp v5, v5, v5 row_ror:8 row_mask:0xf bank_mask:0xf
  v_cvt_pk_bf16_f32 v4, v4, v5
  buffer_store_dword v4, v69, s[8:11], s62 offen
Cf3_h1ok:
  s_xor_b32 s62, s62, 16384
  s_xor_b32 s72, s72, 1
Cf3_h2:
  v_lshlrev_b32 v73, 2, v76
  s_mov_b32 m0, 10752
  buffer_store_dword v71, v69, s[8:11], s62 offen
  s_waitcnt vmcnt(2)
  ds_read_b128 v[60:63], v76 offset:28672
  ds_read_b128 v[64:67], v76 offset:29696
  ds_read_b128 v[44:47], v76 offset:30720
  ds_read_b128 v[48:51], v76 offset:31744
  ds_read_b128 v[36:39], v76 offset:45056
  ds_read_b128 v[40:43], v76 offset:46080
  s_cmp_eq_u32 s66, 12
  s_cbranch_scc1 Cf3_kv2
  s_branch Cf3_top
Cf3_rec:
  s_nop 7
  s_waitcnt vmcnt(0) lgkmcnt(0)
  v_max3_u32 v72, v0, v1, v2
  v_max3_u32 v72, v72, v3, v4
  v_max3_u32 v72, v72, v5, v6
  v_max3_u32 v72, v72, v7, v8
  v_max3_u32 v72, v72, v9, v10
  v_max3_u32 v72, v72, v11, v12
  v_max3_u32 v72, v72, v13, v14
  v_max3_u32 v72, v72, v15, v16
  v_max3_u32 v72, v72, v17, v18
  v_max_u32 v72, v72, v19
  v_cmp_eq_u32 vcc, -1, v72
  s_cbranch_vccz Cf3_recok
  s_barrier
Cf3_recp:
  buffer_load_dwordx4 v[60:63], v76, s[8:11], s64 offen offset:0 sc1
  buffer_load_dwordx4 v[64:67], v76, s[8:11], s64 offen offset:1024 sc1
  s_add_u32 s67, s67, 1
  s_cmp_lt_u32 s67, 131072
  s_cselect_b32 s54, -2, -1
  s_waitcnt vmcnt(1)
  v_max3_u32 v72, v60, v61, v62
  s_waitcnt vmcnt(0)
  v_max3_u32 v72, v72, v63, v64
  v_max3_u32 v72, v72, v65, v66
  v_max_u32 v72, v72, v67
  v_cmp_lt_u32 vcc, s54, v72
  s_cbranch_vccnz Cf3_recp
  ds_write_b128 v76, v[60:63] offset:10752
  ds_write_b128 v76, v[64:67] offset:11776
  v_mov_b64 v[20:21], 0
  v_mov_b64 v[22:23], 0
  v_mov_b64 v[24:25], 0
  v_mov_b64 v[26:27], 0
  v_mov_b64 v[28:29], 0
  v_mov_b64 v[30:31], 0
  v_mov_b64 v[32:33], 0
  v_mov_b64 v[34:35], 0
  s_waitcnt lgkmcnt(0)
  s_barrier
  ds_read_b128 v[0:3], v76 offset:4608
  ds_read_b128 v[60:63], v76 offset:28672
  ds_read_b128 v[64:67], v76 offset:29696
  s_waitcnt lgkmcnt(0)
  v_smfmac_f32_16x16x64_bf16 v[20:23], v[0:3], v[60:67], v74
  ds_read_b128 v[60:63], v76 offset:30720
  ds_read_b128 v[64:67], v76 offset:31744
  s_waitcnt lgkmcnt(0)
  v_smfmac_f32_16x16x64_bf16 v[24:27], v[0:3], v[60:67], v74
  ds_read_b128 v[60:63], v76 offset:45056
  ds_read_b128 v[64:67], v76 offset:46080
  s_waitcnt lgkmcnt(0)
  v_smfmac_f32_16x16x64_bf16 v[28:31], v[0:3], v[60:67], v74
  ds_read_b128 v[60:63], v76 offset:47104
  ds_read_b128 v[64:67], v76 offset:48128
  s_waitcnt lgkmcnt(0)
  v_smfmac_f32_16x16x64_bf16 v[32:35], v[0:3], v[60:67], v74
  ds_read_b128 v[4:7], v76 offset:5632
  s_waitcnt lgkmcnt(0)
  v_smfmac_f32_16x16x64_bf16 v[20:23], v[4:7], v[80:87], v74
  v_smfmac_f32_16x16x64_bf16 v[24:27], v[4:7], v[88:95], v74
  v_smfmac_f32_16x16x64_bf16 v[28:31], v[4:7], v[208:215], v74
  v_smfmac_f32_16x16x64_bf16 v[32:35], v[4:7], v[216:223], v74
  ds_read_b128 v[8:11], v76 offset:6656
  s_waitcnt lgkmcnt(0)
  v_smfmac_f32_16x16x64_bf16 v[20:23], v[8:11], v[96:103], v74
  v_smfmac_f32_16x16x64_bf16 v[24:27], v[8:11], v[104:111], v74
  ds_read_b128 v[60:63], v76 offset:61440
  ds_read_b128 v[64:67], v76 offset:62464
  s_waitcnt lgkmcnt(0)
  v_smfmac_f32_16x16x64_bf16 v[28:31], v[8:11], v[60:67], v74
  ds_read_b128 v[60:63], v76 offset:63488
  ds_read_b128 v[64:67], v76 offset:64512
  s_waitcnt lgkmcnt(0)
  v_smfmac_f32_16x16x64_bf16 v[32:35], v[8:11], v[60:67], v74
  ds_read_b128 v[12:15], v76 offset:7680
  s_waitcnt lgkmcnt(0)
  v_smfmac_f32_16x16x64_bf16 v[20:23], v[12:15], v[112:119], v74
  v_smfmac_f32_16x16x64_bf16 v[24:27], v[12:15], v[120:127], v74
  v_smfmac_f32_16x16x64_bf16 v[28:31], v[12:15], v[224:231], v74
  v_smfmac_f32_16x16x64_bf16 v[32:35], v[12:15], v[232:239], v74
  ds_read_b128 v[4:7], v76 offset:8704
  s_waitcnt lgkmcnt(0)
  v_smfmac_f32_16x16x64_bf16 v[20:23], v[4:7], v[128:135], v74
  v_smfmac_f32_16x16x64_bf16 v[24:27], v[4:7], v[136:143], v74
  ds_read_b128 v[60:63], v75 offset:28672
  ds_read_b128 v[64:67], v75 offset:29696
  s_waitcnt lgkmcnt(0)
  v_smfmac_f32_16x16x64_bf16 v[28:31], v[4:7], v[60:67], v74
  ds_read_b128 v[60:63], v75 offset:30720
  ds_read_b128 v[64:67], v75 offset:31744
  s_waitcnt lgkmcnt(0)
  v_smfmac_f32_16x16x64_bf16 v[32:35], v[4:7], v[60:67], v74
  ds_read_b128 v[16:19], v76 offset:9728
  s_waitcnt lgkmcnt(0)
  v_smfmac_f32_16x16x64_bf16 v[20:23], v[16:19], v[144:151], v74
  v_smfmac_f32_16x16x64_bf16 v[24:27], v[16:19], v[152:159], v74
  v_smfmac_f32_16x16x64_bf16 v[28:31], v[16:19], v[240:247], v74
  v_smfmac_f32_16x16x64_bf16 v[32:35], v[16:19], v[248:255], v74
  ds_read_b128 v[12:15], v76 offset:10752
  s_waitcnt lgkmcnt(0)
  v_smfmac_f32_16x16x64_bf16 v[20:23], v[12:15], v[160:167], v74
  v_smfmac_f32_16x16x64_bf16 v[24:27], v[12:15], v[168:175], v74
  v_smfmac_f32_16x16x64_bf16 v[28:31], v[12:15], a[0:7], v74
  v_smfmac_f32_16x16x64_bf16 v[32:35], v[12:15], a[8:15], v74
  ds_read_b128 v[8:11], v76 offset:11776
  s_waitcnt lgkmcnt(0)
  v_smfmac_f32_16x16x64_bf16 v[20:23], v[8:11], v[176:183], v74
  v_smfmac_f32_16x16x64_bf16 v[24:27], v[8:11], v[184:191], v74
  v_smfmac_f32_16x16x64_bf16 v[28:31], v[8:11], a[16:23], v74
  v_smfmac_f32_16x16x64_bf16 v[32:35], v[8:11], a[24:31], v74
  ds_read_b128 v[0:3], v76 offset:12800
  s_waitcnt lgkmcnt(0)
  v_smfmac_f32_16x16x64_bf16 v[20:23], v[0:3], v[192:199], v74
  v_smfmac_f32_16x16x64_bf16 v[24:27], v[0:3], v[200:207], v74
  ds_read_b128 v[60:63], v75 offset:12288
  ds_read_b128 v[64:67], v75 offset:13312
  s_waitcnt lgkmcnt(0)
  v_smfmac_f32_16x16x64_bf16 v[28:31], v[0:3], v[60:67], v74
  ds_read_b128 v[60:63], v75 offset:14336
  ds_read_b128 v[64:67], v75 offset:15360
  s_waitcnt lgkmcnt(0)
  v_smfmac_f32_16x16x64_bf16 v[32:35], v[0:3], v[60:67], v74
  v_add_f32 v20, v20, v22
  v_add_f32 v21, v21, v23
  v_add_f32 v24, v24, v26
  v_cvt_pk_bf16_f32 v22, v20, v24
  ds_write_b32 v79, v22 offset:0
  v_add_f32 v25, v25, v27
  v_cvt_pk_bf16_f32 v23, v21, v25
  ds_write_b32 v79, v23 offset:576
  v_add_f32 v28, v28, v30
  v_add_f32 v29, v29, v31
  s_waitcnt lgkmcnt(0)
  s_nop 1
  s_branch Cf3_recok
Cf3_mx:
  s_waitcnt lgkmcnt(0)
  s_barrier
  buffer_load_dwordx4 v[0:3], v76, s[8:11], s58 offen offset:0 sc1
  ds_read_b128 v[20:23], v77 offset:0
  ds_read_b128 v[28:31], v77 offset:256
  buffer_load_dwordx4 v[4:7], v76, s[8:11], s58 offen offset:1024 sc1
  ds_read_b128 v[24:27], v77 offset:128
  ds_read_b128 v[32:35], v77 offset:384
  s_waitcnt vmcnt(1) lgkmcnt(3)
  v_mfma_f32_16x16x32_bf16 v[8:11], v[0:3], v[20:23], 0
  s_waitcnt vmcnt(0) lgkmcnt(1)
  v_mfma_f32_16x16x32_bf16 v[8:11], v[4:7], v[24:27], v[8:11]
  v_mfma_f32_16x16x32_bf16 v[12:15], v[28:31], v[20:23], 0
  s_waitcnt lgkmcnt(0)
  v_mfma_f32_16x16x32_bf16 v[12:15], v[32:35], v[24:27], v[12:15]
  v_add_f32_dpp v8, v10, v8 quad_perm:[2,3,0,1] row_mask:0xf bank_mask:0xf
  v_add_f32_dpp v9, v11, v9 quad_perm:[2,3,0,1] row_mask:0xf bank_mask:0xf
  s_nop 0
  v_mov_b32_dpp v8, v8 quad_perm:[0,1,0,1] row_mask:0xf bank_mask:0xf
  v_mov_b32_dpp v9, v9 quad_perm:[0,1,0,1] row_mask:0xf bank_mask:0xf
  s_nop 1
  v_add_f32_dpp v12, v14, v12 quad_perm:[2,3,0,1] row_mask:0xf bank_mask:0xf
  v_add_f32_dpp v13, v15, v13 quad_perm:[2,3,0,1] row_mask:0xf bank_mask:0xf
  s_nop 0
  v_mov_b32_dpp v12, v12 quad_perm:[0,1,0,1] row_mask:0xf bank_mask:0xf
  v_mov_b32_dpp v13, v13 quad_perm:[0,1,0,1] row_mask:0xf bank_mask:0xf
  v_mul_f32 v12, s69, v12
  ds_write_b32 v78, v8 offset:8716
  v_mul_f32 v13, s69, v13
  ds_write_b32 v78, v9 offset:8780
  s_waitcnt lgkmcnt(0)
  s_barrier
  ds_read_b128 v[36:39], v78 offset:8704
  ds_read_b128 v[40:43], v78 offset:8768
  s_waitcnt lgkmcnt(0)
  s_barrier
  v_max_f32 v16, v36, v37
  v_max3_f32 v16, v16, v38, v39
  v_max3_f32 v16, v16, v40, v41
  v_max3_f32 v16, v16, v42, v43
  v_max3_f32 v16, v16, v12, v13
  v_mov_b32 v17, v16
  s_nop 1
  v_permlane16_swap_b32 v16, v17
  v_max_f32 v16, v16, v17
  v_mov_b32 v17, v16
  s_nop 1
  v_permlane32_swap_b32 v16, v17
  v_max_f32 v16, v16, v17
  v_sub_f32 v36, v36, v16
  v_sub_f32 v37, v37, v16
  v_sub_f32 v38, v38, v16
  v_sub_f32 v39, v39, v16
  v_sub_f32 v40, v40, v16
  v_sub_f32 v41, v41, v16
  v_sub_f32 v42, v42, v16
  v_sub_f32 v43, v43, v16
  v_sub_f32 v12, v12, v16
  v_sub_f32 v13, v13, v16
  v_exp_f32 v36, v36
  v_exp_f32 v37, v37
  v_exp_f32 v38, v38
  v_exp_f32 v39, v39
  v_exp_f32 v40, v40
  v_exp_f32 v41, v41
  v_exp_f32 v42, v42
  v_exp_f32 v43, v43
  v_exp_f32 v12, v12
  v_exp_f32 v13, v13
  v_cvt_pk_bf16_f32 v32, v36, v40
  v_cvt_pk_bf16_f32 v33, v37, v41
  v_cvt_pk_bf16_f32 v34, v38, v42
  v_cvt_pk_bf16_f32 v35, v39, v43
  v_cvt_pk_bf16_f32 v28, v12, v13
  v_cvt_pk_bf16_f32 v31, v12, v13
  v_mov_b32 v29, 0
  v_mov_b32 v30, 0
  v_mov_b32 v68, 0x3f803f80
  v_mov_b32 v69, 0x3f803f80
  v_mov_b32 v70, 0x3f803f80
  v_mov_b32 v71, 0x3f803f80
  s_nop 1
  v_mfma_f32_16x16x32_bf16 v[8:11], v[32:35], v[68:71], 0
  v_mfma_f32_16x16x32_bf16 v[0:3], v[32:35], v[52:55], 0
  v_mfma_f32_16x16x32_bf16 v[4:7], v[32:35], v[56:59], 0
  v_mfma_f32_16x16x16_bf16 v[8:11], v[28:29], v[68:69], v[8:11]
  v_mfma_f32_16x16x16_bf16 v[0:3], v[28:29], v[72:73], v[0:3]
  v_mfma_f32_16x16x16_bf16 v[4:7], v[30:31], v[72:73], v[4:7]
  ds_read_b128 v[68:71], v76 offset:13824
  v_rcp_f32 v10, v8
  v_rcp_f32 v11, v9
  v_mul_f32 v0, v10, v0
  v_mul_f32 v1, v11, v1
  s_nop 0
  v_mul_f32 v4, v10, v4
  v_mul_f32 v5, v11, v5
  v_cvt_pk_bf16_f32 v2, v0, v4
  ds_write_b32 v79, v2 offset:8704
  v_cvt_pk_bf16_f32 v3, v1, v5
  ds_write_b32 v79, v3 offset:9280
  v_mov_b64 v[16:17], 0
  v_mov_b64 v[18:19], 0
  v_mov_b64 v[20:21], 0
  v_mov_b64 v[22:23], 0
  s_branch Cf3_mxok
Cf3_kv:
  s_lshl_b32 s56, s53, 2
  s_add_u32 s56, s56, 128
  s_load_dword s57, s[12:13], s56 glc
  s_branch Cf3_kvb
Cf3_kv2:
  s_waitcnt lgkmcnt(0)
  s_cmp_ge_u32 s57, 0x700
  s_cbranch_scc1 Cf3_top
  s_load_dword s57, s[12:13], s56 glc
  s_add_u32 s67, s67, 1
  s_cmp_lt_u32 s67, 131072
  s_cbranch_scc1 Cf3_kv2
  s_branch Cf3_top
Cf3_h1r:
  s_mov_b64 exec, vcc
  buffer_load_dwordx4 v[52:55], v76, s[8:11], s60 offen offset:0 sc1
  buffer_load_dwordx4 v[56:59], v76, s[8:11], s60 offen offset:1024 sc1
  s_mov_b64 exec, -1
  s_add_u32 s67, s67, 1
  s_waitcnt vmcnt(3)
  v_mfma_f32_16x16x32_bf16 v[4:7], v[0:3], v[36:39], 0
  v_bitop3_b32 v72, v36, v38, s72 bitop3:0x7e
  s_waitcnt vmcnt(2)
  v_mfma_f32_16x16x32_bf16 v[4:7], v[0:3], v[40:43], v[4:7]
  v_bitop3_b32 v73, v40, v42, s72 bitop3:0x7e
  v_bitop3_b32 v72, v72, v73, 1 bitop3:0xa8
  v_cmp_ne_u32 vcc, 0, v72
  s_cbranch_vccz Cf3_h1p
  s_mov_b64 exec, vcc
  buffer_load_dwordx4 v[36:39], v76, s[8:11], s60 offen offset:0 sc1
  buffer_load_dwordx4 v[40:43], v76, s[8:11], s60 offen offset:1024 sc1
  s_mov_b64 exec, -1
  s_add_u32 s67, s67, 1
  s_waitcnt vmcnt(3)
  v_mfma_f32_16x16x32_bf16 v[4:7], v[0:3], v[52:55], 0
  v_bitop3_b32 v72, v52, v54, s72 bitop3:0x7e
  s_waitcnt vmcnt(2)
  v_mfma_f32_16x16x32_bf16 v[4:7], v[0:3], v[56:59], v[4:7]
  v_bitop3_b32 v73, v56, v58, s72 bitop3:0x7e
  v_bitop3_b32 v72, v72, v73, 1 bitop3:0xa8
  v_cmp_ne_u32 vcc, 0, v72
  s_cbranch_vccz Cf3_h1p
  s_cmp_lt_u32 s67, 131072
  s_cbranch_scc1 Cf3_h1r
  s_branch Cf3_h1p
Cf3_last:
  s_nop 7
  s_waitcnt vmcnt(0) lgkmcnt(0)
  ds_read_b64 v[16:17], v77 offset:392
  v_mov_b64 v[18:19], v[72:73]
  s_add_u32 s68, s68, 131072
  s_waitcnt lgkmcnt(0)
  buffer_store_dwordx4 v[16:19], v76, s[8:11], s68 offen sc1
  s_waitcnt vmcnt(0)
  s_barrier
  s_branch L_cexit
L_w4:
  v_mov_b64 v[20:21], 0
  v_mov_b64 v[22:23], 0
  v_mov_b64 v[24:25], 0
  v_mov_b64 v[26:27], 0
  v_mov_b64 v[28:29], 0
  v_mov_b64 v[30:31], 0
  v_mov_b64 v[32:33], 0
  v_mov_b64 v[34:35], 0
  s_mov_b32 m0, 15872
  s_branch Cs0_h2
.p2align 6
Cs0_top:
  s_waitcnt lgkmcnt(0)
  s_barrier
  ds_read_b128 v[0:3], v76 offset:4608
  ds_read_b128 v[4:7], v76 offset:5632
  s_waitcnt lgkmcnt(1)
  v_smfmac_f32_16x16x64_bf16 v[20:23], v[0:3], v[60:67], v74
  ds_read_b128 v[60:63], v76 offset:34816
  v_smfmac_f32_16x16x64_bf16 v[24:27], v[0:3], v[44:51], v74
  ds_read_b128 v[64:67], v76 offset:35840
  s_waitcnt lgkmcnt(2)
  v_smfmac_f32_16x16x64_bf16 v[20:23], v[4:7], v[80:87], v74
  buffer_load_dwordx4 v[44:47], v76, s[8:11], s58 offen offset:0 sc1
  ds_read_b128 v[8:11], v76 offset:6656
  v_smfmac_f32_16x16x64_bf16 v[28:31], v[0:3], v[36:43], v74
  ds_read_b128 v[36:39], v76 offset:49152
  v_smfmac_f32_16x16x64_bf16 v[24:27], v[4:7], v[88:95], v74
  buffer_load_dwordx4 v[48:51], v76, s[8:11], s58 offen offset:1024 sc1
  ds_read_b128 v[40:43], v76 offset:50176
  v_smfmac_f32_16x16x64_bf16 v[28:31], v[4:7], v[208:215], v74
  s_waitcnt vmcnt(4)
  ds_read_b128 v[12:15], v76 offset:7680
  v_smfmac_f32_16x16x64_bf16 v[32:35], v[4:7], v[216:223], v74
  buffer_load_dwordx4 v[52:55], v76, s[8:11], s59 offen offset:0 sc1
  s_waitcnt lgkmcnt(4)
  v_smfmac_f32_16x16x64_bf16 v[32:35], v[0:3], v[60:67], v74
  ds_read_b128 v[60:63], v76 offset:51200
  s_waitcnt lgkmcnt(4)
  v_smfmac_f32_16x16x64_bf16 v[20:23], v[8:11], v[96:103], v74
  buffer_load_dwordx4 v[56:59], v76, s[8:11], s59 offen offset:1024 sc1
  ds_read_b128 v[64:67], v76 offset:52224
  v_smfmac_f32_16x16x64_bf16 v[24:27], v[8:11], v[104:111], v74
  buffer_store_dwordx4 v[16:19], v76, s[8:11], s68 offen sc1
  ds_read_b128 v[0:3], v76 offset:12800
  s_waitcnt lgkmcnt(4)
  v_smfmac_f32_16x16x64_bf16 v[28:31], v[8:11], v[36:43], v74
  ds_read_b128 v[36:39], v75 offset:0
  s_waitcnt lgkmcnt(4)
  v_smfmac_f32_16x16x64_bf16 v[20:23], v[12:15], v[112:119], v74
  ds_read_b128 v[40:43], v75 offset:1024
  v_smfmac_f32_16x16x64_bf16 v[24:27], v[12:15], v[120:127], v74
  buffer_load_dword v73, s[8:11], s70 offen lds
  s_waitcnt lgkmcnt(3)
  v_smfmac_f32_16x16x64_bf16 v[32:35], v[8:11], v[60:67], v74
  ds_read_b128 v[60:63], v75 offset:2048
  v_smfmac_f32_16x16x64_bf16 v[28:31], v[12:15], v[224:231], v74
  ds_read_b128 v[64:67], v75 offset:3072
  v_smfmac_f32_16x16x64_bf16 v[32:35], v[12:15], v[232:239], v74
  s_barrier
  s_waitcnt lgkmcnt(4)
  v_smfmac_f32_16x16x64_bf16 v[20:23], v[0:3], v[192:199], v74
  ds_read_b128 v[4:7], v76 offset:8704
  s_waitcnt lgkmcnt(3)
  v_smfmac_f32_16x16x64_bf16 v[28:31], v[0:3], v[36:43], v74
  ds_read_b128 v[16:19], v76 offset:9728
  v_smfmac_f32_16x16x64_bf16 v[24:27], v[0:3], v[200:207], v74
  ds_read_b128 v[36:39], v75 offset:16384
  s_waitcnt lgkmcnt(3)
  v_mov_b32 v68, 0x3f803f80
  v_smfmac_f32_16x16x64_bf16 v[32:35], v[0:3], v[60:67], v74
  ds_read_b128 v[40:43], v75 offset:17408
  s_waitcnt lgkmcnt(3)
  v_smfmac_f32_16x16x64_bf16 v[20:23], v[4:7], v[128:135], v74
  ds_read_b128 v[12:15], v76 offset:10752
  v_mov_b32 v69, 0x3f803f80
  v_smfmac_f32_16x16x64_bf16 v[24:27], v[4:7], v[136:143], v74
  ds_read_b128 v[8:11], v76 offset:11776
  s_waitcnt lgkmcnt(4)
  v_smfmac_f32_16x16x64_bf16 v[20:23], v[16:19], v[144:151], v74
  ds_read_b128 v[60:63], v75 offset:18432
  v_mov_b64 v[70:71], v[68:69]
  v_smfmac_f32_16x16x64_bf16 v[24:27], v[16:19], v[152:159], v74
  ds_read_b128 v[64:67], v75 offset:19456
  s_waitcnt lgkmcnt(4)
  v_smfmac_f32_16x16x64_bf16 v[28:31], v[4:7], v[36:43], v74
  s_waitcnt lgkmcnt(3)
  v_mov_b64 v[36:37], 0
  v_smfmac_f32_16x16x64_bf16 v[20:23], v[12:15], v[160:167], v74
  s_waitcnt lgkmcnt(2)
  v_mov_b64 v[38:39], 0
  v_smfmac_f32_16x16x64_bf16 v[20:23], v[8:11], v[176:183], v74
  v_mov_b64 v[40:41], 0
  v_smfmac_f32_16x16x64_bf16 v[24:27], v[12:15], v[168:175], v74
  v_mov_b64 v[42:43], 0
  v_smfmac_f32_16x16x64_bf16 v[24:27], v[8:11], v[184:191], v74
  s_waitcnt lgkmcnt(0)
  v_add_f32 v20, v20, v22
  v_smfmac_f32_16x16x64_bf16 v[32:35], v[4:7], v[60:67], v74
  v_add_f32 v21, v21, v23
  v_smfmac_f32_16x16x64_bf16 v[28:31], v[16:19], v[240:247], v74
  v_add_f32 v24, v24, v26
  v_cvt_pk_bf16_f32 v22, v20, v24
  v_smfmac_f32_16x16x64_bf16 v[28:31], v[12:15], a[0:7], v74
  ds_write_b32 v79, v22 offset:0
  v_add_f32 v25, v25, v27
  v_cvt_pk_bf16_f32 v23, v21, v25
  v_smfmac_f32_16x16x64_bf16 v[28:31], v[8:11], a[16:23], v74
  ds_write_b32 v79, v23 offset:576
  v_cmp_u_f32 vcc, v20, v21
  v_smfmac_f32_16x16x64_bf16 v[32:35], v[16:19], v[248:255], v74
  v_smfmac_f32_16x16x64_bf16 v[32:35], v[12:15], a[8:15], v74
  v_add_f32 v28, v28, v30
  v_add_f32 v29, v29, v31
  v_smfmac_f32_16x16x64_bf16 v[32:35], v[8:11], a[24:31], v74
  s_cbranch_vccnz Cs0_rec
Cs0_recok:
  v_smfmac_f32_16x16x64_bf16 v[36:39], v[16:19], a[112:119], v74
  s_waitcnt lgkmcnt(0)
  s_barrier
  ds_read_b128 v[60:63], v77
  v_smfmac_f32_16x16x64_bf16 v[40:43], v[16:19], a[120:127], v74
  ds_read_b128 v[64:67], v77 offset:128
  v_add_f32 v32, v32, v34
  v_cvt_pk_bf16_f32 v30, v28, v32
  v_smfmac_f32_16x16x64_bf16 v[36:39], v[0:3], a[160:167], v74
  ds_write_b32 v79, v30 offset:256
  v_add_f32 v33, v33, v35
  v_cvt_pk_bf16_f32 v31, v29, v33
  v_smfmac_f32_16x16x64_bf16 v[40:43], v[0:3], a[168:175], v74
  ds_write_b32 v79, v31 offset:832
  v_xor_b32 v75, 0x8000, v75
  v_smfmac_f32_16x16x64_bf16 v[36:39], v[4:7], a[96:103], v74
  ds_read_b128 v[0:3], v76 offset:4608
  v_mov_b32 v29, 0
  v_smfmac_f32_16x16x64_bf16 v[40:43], v[4:7], a[104:111], v74
  s_waitcnt vmcnt(4) lgkmcnt(3)
  v_mov_b32 v30, 0
  v_mfma_f32_16x16x32_bf16 v[44:47], v[44:47], v[60:63], 0
  ds_read_b128 v[4:7], v76 offset:5632
  s_waitcnt lgkmcnt(2)
  v_mfma_f32_16x16x32_bf16 v[44:47], v[48:51], v[64:67], v[44:47]
  s_barrier
  v_smfmac_f32_16x16x64_bf16 v[36:39], v[8:11], a[144:151], v74
  ds_read_b128 v[20:23], v77 offset:256
  ds_read_b128 v[24:27], v77 offset:384
  v_smfmac_f32_16x16x64_bf16 v[40:43], v[8:11], a[152:159], v74
  ds_read_b128 v[8:11], v76 offset:6656
  v_add_f32_dpp v72, v46, v44 quad_perm:[2,3,0,1] row_mask:0xf bank_mask:0xf
  v_add_f32_dpp v73, v47, v45 quad_perm:[2,3,0,1] row_mask:0xf bank_mask:0xf
  v_smfmac_f32_16x16x64_bf16 v[36:39], v[12:15], a[128:135], v74
  ds_read_b128 v[44:47], v75 offset:0
  v_exp_f32_dpp v72, v72 quad_perm:[0,1,0,1] row_mask:0xf bank_mask:0xf
  v_smfmac_f32_16x16x64_bf16 v[40:43], v[12:15], a[136:143], v74
  ds_read_b128 v[12:15], v76 offset:7680
  s_waitcnt lgkmcnt(6)
  v_exp_f32_dpp v73, v73 quad_perm:[0,1,0,1] row_mask:0xf bank_mask:0xf
  v_smfmac_f32_16x16x64_bf16 v[36:39], v[0:3], a[32:39], v74
  s_waitcnt lgkmcnt(3)
  v_cvt_pk_bf16_f32 v72, v72, v73
  v_mfma_f32_16x16x32_bf16 v[20:23], v[20:23], v[60:63], 0
  ds_write_b32 v78, v72 offset:512
  v_mfma_f32_16x16x32_bf16 v[20:23], v[24:27], v[64:67], v[20:23]
  ds_read_b128 v[48:51], v75 offset:1024
  v_smfmac_f32_16x16x64_bf16 v[40:43], v[0:3], a[40:47], v74
  ds_read_b128 v[60:63], v75 offset:2048
  v_smfmac_f32_16x16x64_bf16 v[36:39], v[4:7], a[48:55], v74
  s_waitcnt lgkmcnt(5)
  v_add_f32_dpp v24, v22, v20 quad_perm:[2,3,0,1] row_mask:0xf bank_mask:0xf
  v_add_f32_dpp v25, v23, v21 quad_perm:[2,3,0,1] row_mask:0xf bank_mask:0xf
  v_smfmac_f32_16x16x64_bf16 v[36:39], v[8:11], a[64:71], v74
  s_waitcnt lgkmcnt(2)
  s_barrier
  ds_read_b128 v[32:35], v78 offset:512
  v_smfmac_f32_16x16x64_bf16 v[36:39], v[12:15], a[80:87], v74
  ds_read_b128 v[64:67], v75 offset:3072
  v_mul_f32 v24, s69, v24
  v_smfmac_f32_16x16x64_bf16 v[40:43], v[4:7], a[56:63], v74
  v_mul_f32 v25, s69, v25
  v_smfmac_f32_16x16x64_bf16 v[40:43], v[8:11], a[72:79], v74
  v_exp_f32_dpp v24, v24 quad_perm:[0,1,0,1] row_mask:0xf bank_mask:0xf
  v_smfmac_f32_16x16x64_bf16 v[40:43], v[12:15], a[88:95], v74
  s_waitcnt vmcnt(2) lgkmcnt(1)
  v_exp_f32_dpp v25, v25 quad_perm:[0,1,0,1] row_mask:0xf bank_mask:0xf
  v_mfma_f32_16x16x32_bf16 v[8:11], v[32:35], v[68:71], 0
  v_add_f32 v36, v36, v38
  v_add_f32 v37, v37, v39
  v_mfma_f32_16x16x32_bf16 v[0:3], v[32:35], v[52:55], 0
  v_add_f32 v40, v40, v42
  v_add_f32 v41, v41, v43
  v_mfma_f32_16x16x32_bf16 v[4:7], v[32:35], v[56:59], 0
  v_cvt_pk_bf16_f32 v28, v24, v25
  v_cvt_pk_bf16_f32 v72, v36, v37
  v_cvt_pk_bf16_f32 v73, v40, v41
  v_mfma_f32_16x16x16_bf16 v[8:11], v[28:29], v[68:69], v[8:11]
  v_cvt_pk_bf16_f32 v31, v24, v25
  v_mfma_f32_16x16x16_bf16 v[0:3], v[28:29], v[72:73], v[0:3]
  ds_read_b128 v[68:71], v76 offset:13824
  v_mfma_f32_16x16x16_bf16 v[4:7], v[30:31], v[72:73], v[4:7]
  v_rcp_f32 v10, v8
  v_rcp_f32 v11, v9
  v_mul_f32 v0, v10, v0
  v_mul_f32 v1, v11, v1
  s_nop 0
  v_mul_f32 v4, v10, v4
  v_mul_f32 v5, v11, v5
  v_cvt_pk_bf16_f32 v2, v0, v4
  ds_write_b32 v79, v2 offset:8704
  v_cvt_pk_bf16_f32 v3, v1, v5
  ds_write_b32 v79, v3 offset:9280
  v_subrev_u32 v8, 813694976, v8
  v_subrev_u32 v9, 813694976, v9
  v_max_u32 v8, v8, v9
  v_cmp_le_u32 vcc, 503316480, v8
  v_mov_b64 v[16:17], 0
  v_mov_b64 v[18:19], 0
  v_mov_b64 v[20:21], 0
  v_mov_b64 v[22:23], 0
  s_cbranch_vccnz Cs0_mx
Cs0_mxok:
  s_cmp_eq_u32 s66, 63
  s_waitcnt lgkmcnt(0)
  s_barrier
  ds_read_b128 v[0:3], v78 offset:8704
  ds_read_b128 v[4:7], v78 offset:8768
  ds_read_b128 v[8:11], v78 offset:8832
  ds_read_b128 v[12:15], v78 offset:8896
  v_mov_b64 v[24:25], 0
  v_mov_b64 v[26:27], 0
  v_mov_b64 v[28:29], 0
  v_mov_b64 v[30:31], 0
  v_mov_b64 v[32:33], 0
  v_mov_b64 v[34:35], 0
  s_waitcnt lgkmcnt(3)
  v_smfmac_f32_16x16x64_bf16 v[16:19], v[0:3], a[176:183], v74
  s_cbranch_scc1 Cs0_last
  s_waitcnt lgkmcnt(2)
  v_smfmac_f32_16x16x64_bf16 v[16:19], v[4:7], a[184:191], v74
  s_waitcnt lgkmcnt(1)
  v_smfmac_f32_16x16x64_bf16 v[16:19], v[8:11], a[192:199], v74
  ds_read_b128 v[52:55], v75 offset:16384
  s_waitcnt lgkmcnt(1)
  v_smfmac_f32_16x16x64_bf16 v[16:19], v[12:15], a[200:207], v74
  ds_read_b128 v[56:59], v75 offset:17408
  v_smfmac_f32_16x16x64_bf16 v[20:23], v[0:3], a[208:215], v74
  ds_read_b128 v[36:39], v75 offset:18432
  v_smfmac_f32_16x16x64_bf16 v[20:23], v[4:7], a[216:223], v74
  ds_read_b128 v[40:43], v75 offset:19456
  v_cvt_pk_bf16_f32 v16, v16, v17
  v_cvt_pk_bf16_f32 v17, v18, v19
  v_bfi_b32 v16, 1, s72, v16
  v_smfmac_f32_16x16x64_bf16 v[20:23], v[8:11], v[44:51], v74
  ds_read_b128 v[44:47], v75 offset:32768
  buffer_store_dwordx2 v[16:17], v68, s[8:11], s73 offen sc1
  v_smfmac_f32_16x16x64_bf16 v[20:23], v[12:15], v[60:67], v74
  ds_read_b128 v[48:51], v75 offset:33792
  v_smfmac_f32_16x16x64_bf16 v[24:27], v[0:3], a[224:231], v74
  ds_read_b128 v[60:63], v75 offset:34816
  v_smfmac_f32_16x16x64_bf16 v[24:27], v[4:7], a[232:239], v74
  ds_read_b128 v[64:67], v75 offset:35840
  s_waitcnt lgkmcnt(6)
  v_cvt_pk_bf16_f32 v20, v20, v21
  v_cvt_pk_bf16_f32 v21, v22, v23
  v_bfi_b32 v20, 1, s72, v20
  v_smfmac_f32_16x16x64_bf16 v[24:27], v[8:11], v[52:59], v74
  buffer_store_dwordx2 v[20:21], v68, s[8:11], s74 offen sc1
  s_waitcnt lgkmcnt(4)
  v_mov_b64 v[18:19], v[72:73]
  v_smfmac_f32_16x16x64_bf16 v[24:27], v[12:15], v[36:43], v74
  v_mov_b64 v[20:21], 0
  v_smfmac_f32_16x16x64_bf16 v[28:31], v[0:3], a[240:247], v74
  v_mov_b64 v[22:23], 0
  v_smfmac_f32_16x16x64_bf16 v[28:31], v[4:7], a[248:255], v74
  s_waitcnt lgkmcnt(2)
  v_cvt_pk_bf16_f32 v24, v24, v25
  v_cvt_pk_bf16_f32 v25, v26, v27
  v_bfi_b32 v24, 1, s72, v24
  v_smfmac_f32_16x16x64_bf16 v[28:31], v[8:11], v[44:51], v74
  buffer_store_dwordx2 v[24:25], v68, s[8:11], s75 offen sc1
  s_waitcnt lgkmcnt(0)
  v_smfmac_f32_16x16x64_bf16 v[28:31], v[12:15], v[60:67], v74
  ds_read_b64 v[16:17], v77 offset:256
  v_xor_b32 v75, 0x8000, v75
  ds_read_b128 v[52:55], v76 offset:14848
  s_nop 3
  v_cvt_pk_bf16_f32 v28, v28, v29
  v_cvt_pk_bf16_f32 v29, v30, v31
  v_bfi_b32 v28, 1, s72, v28
  buffer_store_dwordx2 v[28:29], v68, s[8:11], s76 offen sc1
  v_mov_b64 v[24:25], 0
  v_mov_b64 v[26:27], 0
  v_mov_b64 v[28:29], 0
  v_mov_b64 v[30:31], 0
  s_add_u32 s58, s58, 524288
  s_add_u32 s59, s59, 524288
  s_add_u32 s70, s70, 524288
  s_add_u32 s68, s68, 131072
  s_add_u32 s66, s66, 1
  s_xor_b32 s64, s64, 16384
  s_xor_b32 s65, s65, 16384
  s_nop 15
  s_nop 7
  buffer_load_dwordx4 v[0:3], v76, s[8:11], s60 offen offset:0 sc1
  buffer_load_dwordx4 v[4:7], v76, s[8:11], s60 offen offset:1024 sc1
  buffer_load_dwordx4 v[8:11], v76, s[8:11], s61 offen offset:0 sc1
  buffer_load_dwordx4 v[12:15], v76, s[8:11], s61 offen offset:1024 sc1
  s_nop 15
  s_nop 11
  buffer_load_dwordx4 v[44:47], v76, s[8:11], s60 offen offset:0 sc1
  buffer_load_dwordx4 v[48:51], v76, s[8:11], s60 offen offset:1024 sc1
  buffer_load_dwordx4 v[60:63], v76, s[8:11], s61 offen offset:0 sc1
  buffer_load_dwordx4 v[64:67], v76, s[8:11], s61 offen offset:1024 sc1
  s_waitcnt vmcnt(7) lgkmcnt(0)
  v_mfma_f32_16x16x32_bf16 v[56:59], v[52:55], v[0:3], 0
  v_bitop3_b32 v72, v0, v2, s72 bitop3:0x7e
  s_waitcnt vmcnt(6)
  v_mfma_f32_16x16x32_bf16 v[56:59], v[52:55], v[4:7], v[56:59]
  v_bitop3_b32 v73, v4, v6, s72 bitop3:0x7e
  v_or_b32 v72, v72, v73
  s_waitcnt vmcnt(5)
  v_mfma_f32_16x16x32_bf16 v[36:39], v[52:55], v[8:11], 0
  v_bitop3_b32 v73, v8, v10, s72 bitop3:0x7e
  v_or_b32 v72, v72, v73
  s_waitcnt vmcnt(4)
  v_mfma_f32_16x16x32_bf16 v[36:39], v[52:55], v[12:15], v[36:39]
  v_bitop3_b32 v73, v12, v14, s72 bitop3:0x7e
  v_bitop3_b32 v72, v72, v73, 1 bitop3:0xa8
  v_cmp_ne_u32 vcc, 0, v72
  s_cbranch_vccnz Cs0_h1r
Cs0_h1p:
  v_add_f32_dpp v56, v56, v56 row_ror:4 row_mask:0xf bank_mask:0xf
  v_add_f32_dpp v57, v57, v57 row_ror:4 row_mask:0xf bank_mask:0xf
  s_nop 0
  v_add_f32_dpp v56, v56, v56 row_ror:8 row_mask:0xf bank_mask:0xf
  v_add_f32_dpp v57, v57, v57 row_ror:8 row_mask:0xf bank_mask:0xf
  v_cvt_pk_bf16_f32 v56, v56, v57
  buffer_store_dword v56, v69, s[8:11], s62 offen sc1
  v_add_f32_dpp v36, v36, v36 row_ror:4 row_mask:0xf bank_mask:0xf
  v_add_f32_dpp v37, v37, v37 row_ror:4 row_mask:0xf bank_mask:0xf
  s_nop 0
  v_add_f32_dpp v36, v36, v36 row_ror:8 row_mask:0xf bank_mask:0xf
  v_add_f32_dpp v37, v37, v37 row_ror:8 row_mask:0xf bank_mask:0xf
  v_cvt_pk_bf16_f32 v36, v36, v37
  buffer_store_dword v36, v70, s[8:11], s63 offen sc1
Cs0_h1ok:
  s_xor_b32 s62, s62, 16384
  s_xor_b32 s63, s63, 16384
  s_xor_b32 s72, s72, 1
  s_nop 15
  s_nop 7
Cs0_h2:
  v_lshlrev_b32 v73, 2, v76
  buffer_load_dwordx4 v[52:55], v76, s[8:11], s64 offen offset:0 sc1
  buffer_load_dwordx4 v[56:59], v76, s[8:11], s64 offen offset:1024 sc1
  buffer_load_dwordx4 v[12:15], v76, s[8:11], s65 offen offset:0 sc1
  s_nop 15
  s_nop 1
  buffer_load_dwordx4 v[52:55], v76, s[8:11], s64 offen offset:0 sc1
  buffer_load_dwordx4 v[56:59], v76, s[8:11], s64 offen offset:1024 sc1
  buffer_load_dwordx4 v[12:15], v76, s[8:11], s65 offen offset:0 sc1
  s_nop 15
  s_nop 1
  buffer_load_dwordx4 v[52:55], v76, s[8:11], s64 offen offset:0 sc1
  buffer_load_dwordx4 v[56:59], v76, s[8:11], s64 offen offset:1024 sc1
  buffer_load_dwordx4 v[12:15], v76, s[8:11], s65 offen offset:0 sc1
  s_waitcnt vmcnt(11)
  ds_read_b128 v[60:63], v76 offset:16384
  ds_read_b128 v[64:67], v76 offset:17408
  ds_read_b128 v[44:47], v76 offset:18432
  ds_read_b128 v[48:51], v76 offset:19456
  ds_read_b128 v[36:39], v76 offset:32768
  ds_read_b128 v[40:43], v76 offset:33792
  s_waitcnt vmcnt(6)
  v_max3_u32 v72, v52, v53, v54
  v_max3_u32 v72, v72, v55, v56
  v_max3_u32 v72, v72, v57, v58
  v_max3_u32 v72, v72, v59, v12
  v_max3_u32 v72, v72, v13, v14
  v_max_u32 v72, v72, v15
  ds_write_b128 v76, v[52:55] offset:4608
  ds_write_b128 v76, v[56:59] offset:5632
  ds_write_b128 v76, v[12:15] offset:12800
  v_cmp_eq_u32 vcc, -1, v72
  s_cbranch_vccnz Cs0_h2r
Cs0_h2w:
  buffer_store_dword v71, v69, s[8:11], s62 offen sc1
  buffer_store_dword v71, v70, s[8:11], s63 offen sc1
  s_branch Cs0_top
Cs0_rec:
  s_nop 7
  s_waitcnt vmcnt(0) lgkmcnt(0)
  v_max3_u32 v72, v0, v1, v2
  v_max3_u32 v72, v72, v3, v4
  v_max3_u32 v72, v72, v5, v6
  v_max3_u32 v72, v72, v7, v8
  v_max3_u32 v72, v72, v9, v10
  v_max3_u32 v72, v72, v11, v12
  v_max3_u32 v72, v72, v13, v14
  v_max3_u32 v72, v72, v15, v16
  v_max3_u32 v72, v72, v17, v18
  v_max_u32 v72, v72, v19
  v_cmp_eq_u32 vcc, -1, v72
  s_cbranch_vccz Cs0_recok
  s_barrier
  v_mov_b64 v[20:21], 0
  v_mov_b64 v[22:23], 0
  v_mov_b64 v[24:25], 0
  v_mov_b64 v[26:27], 0
  v_mov_b64 v[28:29], 0
  v_mov_b64 v[30:31], 0
  v_mov_b64 v[32:33], 0
  v_mov_b64 v[34:35], 0
  s_waitcnt lgkmcnt(0)
  s_barrier
  ds_read_b128 v[0:3], v76 offset:4608
  ds_read_b128 v[60:63], v76 offset:16384
  ds_read_b128 v[64:67], v76 offset:17408
  s_waitcnt lgkmcnt(0)
  v_smfmac_f32_16x16x64_bf16 v[20:23], v[0:3], v[60:67], v74
  ds_read_b128 v[60:63], v76 offset:18432
  ds_read_b128 v[64:67], v76 offset:19456
  s_waitcnt lgkmcnt(0)
  v_smfmac_f32_16x16x64_bf16 v[24:27], v[0:3], v[60:67], v74
  ds_read_b128 v[60:63], v76 offset:32768
  ds_read_b128 v[64:67], v76 offset:33792
  s_waitcnt lgkmcnt(0)
  v_smfmac_f32_16x16x64_bf16 v[28:31], v[0:3], v[60:67], v74
  ds_read_b128 v[60:63], v76 offset:34816
  ds_read_b128 v[64:67], v76 offset:35840
  s_waitcnt lgkmcnt(0)
  v_smfmac_f32_16x16x64_bf16 v[32:35], v[0:3], v[60:67], v74
  ds_read_b128 v[4:7], v76 offset:5632
  s_waitcnt lgkmcnt(0)
  v_smfmac_f32_16x16x64_bf16 v[20:23], v[4:7], v[80:87], v74
  v_smfmac_f32_16x16x64_bf16 v[24:27], v[4:7], v[88:95], v74
  v_smfmac_f32_16x16x64_bf16 v[28:31], v[4:7], v[208:215], v74
  v_smfmac_f32_16x16x64_bf16 v[32:35], v[4:7], v[216:223], v74
  ds_read_b128 v[8:11], v76 offset:6656
  s_waitcnt lgkmcnt(0)
  v_smfmac_f32_16x16x64_bf16 v[20:23], v[8:11], v[96:103], v74
  v_smfmac_f32_16x16x64_bf16 v[24:27], v[8:11], v[104:111], v74
  ds_read_b128 v[60:63], v76 offset:49152
  ds_read_b128 v[64:67], v76 offset:50176
  s_waitcnt lgkmcnt(0)
  v_smfmac_f32_16x16x64_bf16 v[28:31], v[8:11], v[60:67], v74
  ds_read_b128 v[60:63], v76 offset:51200
  ds_read_b128 v[64:67], v76 offset:52224
  s_waitcnt lgkmcnt(0)
  v_smfmac_f32_16x16x64_bf16 v[32:35], v[8:11], v[60:67], v74
  ds_read_b128 v[12:15], v76 offset:7680
  s_waitcnt lgkmcnt(0)
  v_smfmac_f32_16x16x64_bf16 v[20:23], v[12:15], v[112:119], v74
  v_smfmac_f32_16x16x64_bf16 v[24:27], v[12:15], v[120:127], v74
  v_smfmac_f32_16x16x64_bf16 v[28:31], v[12:15], v[224:231], v74
  v_smfmac_f32_16x16x64_bf16 v[32:35], v[12:15], v[232:239], v74
  ds_read_b128 v[4:7], v76 offset:8704
  s_waitcnt lgkmcnt(0)
  v_smfmac_f32_16x16x64_bf16 v[20:23], v[4:7], v[128:135], v74
  v_smfmac_f32_16x16x64_bf16 v[24:27], v[4:7], v[136:143], v74
  ds_read_b128 v[60:63], v75 offset:16384
  ds_read_b128 v[64:67], v75 offset:17408
  s_waitcnt lgkmcnt(0)
  v_smfmac_f32_16x16x64_bf16 v[28:31], v[4:7], v[60:67], v74
  ds_read_b128 v[60:63], v75 offset:18432
  ds_read_b128 v[64:67], v75 offset:19456
  s_waitcnt lgkmcnt(0)
  v_smfmac_f32_16x16x64_bf16 v[32:35], v[4:7], v[60:67], v74
  ds_read_b128 v[16:19], v76 offset:9728
  s_waitcnt lgkmcnt(0)
  v_smfmac_f32_16x16x64_bf16 v[20:23], v[16:19], v[144:151], v74
  v_smfmac_f32_16x16x64_bf16 v[24:27], v[16:19], v[152:159], v74
  v_smfmac_f32_16x16x64_bf16 v[28:31], v[16:19], v[240:247], v74
  v_smfmac_f32_16x16x64_bf16 v[32:35], v[16:19], v[248:255], v74
  ds_read_b128 v[12:15], v76 offset:10752
  s_waitcnt lgkmcnt(0)
  v_smfmac_f32_16x16x64_bf16 v[20:23], v[12:15], v[160:167], v74
  v_smfmac_f32_16x16x64_bf16 v[24:27], v[12:15], v[168:175], v74
  v_smfmac_f32_16x16x64_bf16 v[28:31], v[12:15], a[0:7], v74
  v_smfmac_f32_16x16x64_bf16 v[32:35], v[12:15], a[8:15], v74
  ds_read_b128 v[8:11], v76 offset:11776
  s_waitcnt lgkmcnt(0)
  v_smfmac_f32_16x16x64_bf16 v[20:23], v[8:11], v[176:183], v74
  v_smfmac_f32_16x16x64_bf16 v[24:27], v[8:11], v[184:191], v74
  v_smfmac_f32_16x16x64_bf16 v[28:31], v[8:11], a[16:23], v74
  v_smfmac_f32_16x16x64_bf16 v[32:35], v[8:11], a[24:31], v74
  ds_read_b128 v[0:3], v76 offset:12800
  s_waitcnt lgkmcnt(0)
  v_smfmac_f32_16x16x64_bf16 v[20:23], v[0:3], v[192:199], v74
  v_smfmac_f32_16x16x64_bf16 v[24:27], v[0:3], v[200:207], v74
  ds_read_b128 v[60:63], v75 offset:0
  ds_read_b128 v[64:67], v75 offset:1024
  s_waitcnt lgkmcnt(0)
  v_smfmac_f32_16x16x64_bf16 v[28:31], v[0:3], v[60:67], v74
  ds_read_b128 v[60:63], v75 offset:2048
  ds_read_b128 v[64:67], v75 offset:3072
  s_waitcnt lgkmcnt(0)
  v_smfmac_f32_16x16x64_bf16 v[32:35], v[0:3], v[60:67], v74
  v_add_f32 v20, v20, v22
  v_add_f32 v21, v21, v23
  v_add_f32 v24, v24, v26
  v_cvt_pk_bf16_f32 v22, v20, v24
  ds_write_b32 v79, v22 offset:0
  v_add_f32 v25, v25, v27
  v_cvt_pk_bf16_f32 v23, v21, v25
  ds_write_b32 v79, v23 offset:576
  v_add_f32 v28, v28, v30
  v_add_f32 v29, v29, v31
  s_waitcnt lgkmcnt(0)
  s_nop 1
  s_branch Cs0_recok
Cs0_mx:
  s_waitcnt lgkmcnt(0)
  s_barrier
  buffer_load_dwordx4 v[0:3], v76, s[8:11], s58 offen offset:0 sc1
  ds_read_b128 v[20:23], v77 offset:0
  ds_read_b128 v[28:31], v77 offset:256
  buffer_load_dwordx4 v[4:7], v76, s[8:11], s58 offen offset:1024 sc1
  ds_read_b128 v[24:27], v77 offset:128
  ds_read_b128 v[32:35], v77 offset:384
  s_waitcnt vmcnt(1) lgkmcnt(3)
  v_mfma_f32_16x16x32_bf16 v[8:11], v[0:3], v[20:23], 0
  s_waitcnt vmcnt(0) lgkmcnt(1)
  v_mfma_f32_16x16x32_bf16 v[8:11], v[4:7], v[24:27], v[8:11]
  v_mfma_f32_16x16x32_bf16 v[12:15], v[28:31], v[20:23], 0
  s_waitcnt lgkmcnt(0)
  v_mfma_f32_16x16x32_bf16 v[12:15], v[32:35], v[24:27], v[12:15]
  v_add_f32_dpp v8, v10, v8 quad_perm:[2,3,0,1] row_mask:0xf bank_mask:0xf
  v_add_f32_dpp v9, v11, v9 quad_perm:[2,3,0,1] row_mask:0xf bank_mask:0xf
  s_nop 0
  v_mov_b32_dpp v8, v8 quad_perm:[0,1,0,1] row_mask:0xf bank_mask:0xf
  v_mov_b32_dpp v9, v9 quad_perm:[0,1,0,1] row_mask:0xf bank_mask:0xf
  s_nop 1
  v_add_f32_dpp v12, v14, v12 quad_perm:[2,3,0,1] row_mask:0xf bank_mask:0xf
  v_add_f32_dpp v13, v15, v13 quad_perm:[2,3,0,1] row_mask:0xf bank_mask:0xf
  s_nop 0
  v_mov_b32_dpp v12, v12 quad_perm:[0,1,0,1] row_mask:0xf bank_mask:0xf
  v_mov_b32_dpp v13, v13 quad_perm:[0,1,0,1] row_mask:0xf bank_mask:0xf
  v_mul_f32 v12, s69, v12
  ds_write_b32 v78, v8 offset:8704
  v_mul_f32 v13, s69, v13
  ds_write_b32 v78, v9 offset:8768
  s_waitcnt lgkmcnt(0)
  s_barrier
  ds_read_b128 v[36:39], v78 offset:8704
  ds_read_b128 v[40:43], v78 offset:8768
  s_waitcnt lgkmcnt(0)
  s_barrier
  v_max_f32 v16, v36, v37
  v_max3_f32 v16, v16, v38, v39
  v_max3_f32 v16, v16, v40, v41
  v_max3_f32 v16, v16, v42, v43
  v_max3_f32 v16, v16, v12, v13
  v_mov_b32 v17, v16
  s_nop 1
  v_permlane16_swap_b32 v16, v17
  v_max_f32 v16, v16, v17
  v_mov_b32 v17, v16
  s_nop 1
  v_permlane32_swap_b32 v16, v17
  v_max_f32 v16, v16, v17
  v_sub_f32 v36, v36, v16
  v_sub_f32 v37, v37, v16
  v_sub_f32 v38, v38, v16
  v_sub_f32 v39, v39, v16
  v_sub_f32 v40, v40, v16
  v_sub_f32 v41, v41, v16
  v_sub_f32 v42, v42, v16
  v_sub_f32 v43, v43, v16
  v_sub_f32 v12, v12, v16
  v_sub_f32 v13, v13, v16
  v_exp_f32 v36, v36
  v_exp_f32 v37, v37
  v_exp_f32 v38, v38
  v_exp_f32 v39, v39
  v_exp_f32 v40, v40
  v_exp_f32 v41, v41
  v_exp_f32 v42, v42
  v_exp_f32 v43, v43
  v_exp_f32 v12, v12
  v_exp_f32 v13, v13
  v_cvt_pk_bf16_f32 v32, v36, v40
  v_cvt_pk_bf16_f32 v33, v37, v41
  v_cvt_pk_bf16_f32 v34, v38, v42
  v_cvt_pk_bf16_f32 v35, v39, v43
  v_cvt_pk_bf16_f32 v28, v12, v13
  v_cvt_pk_bf16_f32 v31, v12, v13
  v_mov_b32 v29, 0
  v_mov_b32 v30, 0
  v_mov_b32 v68, 0x3f803f80
  v_mov_b32 v69, 0x3f803f80
  v_mov_b32 v70, 0x3f803f80
  v_mov_b32 v71, 0x3f803f80
  s_nop 1
  v_mfma_f32_16x16x32_bf16 v[8:11], v[32:35], v[68:71], 0
  v_mfma_f32_16x16x32_bf16 v[0:3], v[32:35], v[52:55], 0
  v_mfma_f32_16x16x32_bf16 v[4:7], v[32:35], v[56:59], 0
  v_mfma_f32_16x16x16_bf16 v[8:11], v[28:29], v[68:69], v[8:11]
  v_mfma_f32_16x16x16_bf16 v[0:3], v[28:29], v[72:73], v[0:3]
  v_mfma_f32_16x16x16_bf16 v[4:7], v[30:31], v[72:73], v[4:7]
  ds_read_b128 v[68:71], v76 offset:13824
  v_rcp_f32 v10, v8
  v_rcp_f32 v11, v9
  v_mul_f32 v0, v10, v0
  v_mul_f32 v1, v11, v1
  s_nop 0
  v_mul_f32 v4, v10, v4
  v_mul_f32 v5, v11, v5
  v_cvt_pk_bf16_f32 v2, v0, v4
  ds_write_b32 v79, v2 offset:8704
  v_cvt_pk_bf16_f32 v3, v1, v5
  ds_write_b32 v79, v3 offset:9280
  v_mov_b64 v[16:17], 0
  v_mov_b64 v[18:19], 0
  v_mov_b64 v[20:21], 0
  v_mov_b64 v[22:23], 0
  s_branch Cs0_mxok
Cs0_h1r:
  s_mov_b64 exec, vcc
  buffer_load_dwordx4 v[0:3], v76, s[8:11], s60 offen offset:0 sc1
  buffer_load_dwordx4 v[4:7], v76, s[8:11], s60 offen offset:1024 sc1
  buffer_load_dwordx4 v[8:11], v76, s[8:11], s61 offen offset:0 sc1
  buffer_load_dwordx4 v[12:15], v76, s[8:11], s61 offen offset:1024 sc1
  s_mov_b64 exec, -1
  s_add_u32 s67, s67, 1
  s_waitcnt vmcnt(7)
  v_mfma_f32_16x16x32_bf16 v[56:59], v[52:55], v[44:47], 0
  v_bitop3_b32 v72, v44, v46, s72 bitop3:0x7e
  s_waitcnt vmcnt(6)
  v_mfma_f32_16x16x32_bf16 v[56:59], v[52:55], v[48:51], v[56:59]
  v_bitop3_b32 v73, v48, v50, s72 bitop3:0x7e
  v_or_b32 v72, v72, v73
  s_waitcnt vmcnt(5)
  v_mfma_f32_16x16x32_bf16 v[36:39], v[52:55], v[60:63], 0
  v_bitop3_b32 v73, v60, v62, s72 bitop3:0x7e
  v_or_b32 v72, v72, v73
  s_waitcnt vmcnt(4)
  v_mfma_f32_16x16x32_bf16 v[36:39], v[52:55], v[64:67], v[36:39]
  v_bitop3_b32 v73, v64, v66, s72 bitop3:0x7e
  v_bitop3_b32 v72, v72, v73, 1 bitop3:0xa8
  v_cmp_ne_u32 vcc, 0, v72
  s_cbranch_vccz Cs0_h1p
  s_mov_b64 exec, vcc
  buffer_load_dwordx4 v[44:47], v76, s[8:11], s60 offen offset:0 sc1
  buffer_load_dwordx4 v[48:51], v76, s[8:11], s60 offen offset:1024 sc1
  buffer_load_dwordx4 v[60:63], v76, s[8:11], s61 offen offset:0 sc1
  buffer_load_dwordx4 v[64:67], v76, s[8:11], s61 offen offset:1024 sc1
  s_mov_b64 exec, -1
  s_add_u32 s67, s67, 1
  s_waitcnt vmcnt(7)
  v_mfma_f32_16x16x32_bf16 v[56:59], v[52:55], v[0:3], 0
  v_bitop3_b32 v72, v0, v2, s72 bitop3:0x7e
  s_waitcnt vmcnt(6)
  v_mfma_f32_16x16x32_bf16 v[56:59], v[52:55], v[4:7], v[56:59]
  v_bitop3_b32 v73, v4, v6, s72 bitop3:0x7e
  v_or_b32 v72, v72, v73
  s_waitcnt vmcnt(5)
  v_mfma_f32_16x16x32_bf16 v[36:39], v[52:55], v[8:11], 0
  v_bitop3_b32 v73, v8, v10, s72 bitop3:0x7e
  v_or_b32 v72, v72, v73
  s_waitcnt vmcnt(4)
  v_mfma_f32_16x16x32_bf16 v[36:39], v[52:55], v[12:15], v[36:39]
  v_bitop3_b32 v73, v12, v14, s72 bitop3:0x7e
  v_bitop3_b32 v72, v72, v73, 1 bitop3:0xa8
  v_cmp_ne_u32 vcc, 0, v72
  s_cbranch_vccz Cs0_h1p
  s_cmp_lt_u32 s67, 131072
  s_cbranch_scc1 Cs0_h1r
  s_branch Cs0_h1p
Cs0_h2r:
Cs0_h2s:
  s_mov_b64 exec, vcc
  buffer_load_dwordx4 v[52:55], v76, s[8:11], s64 offen offset:0 sc1
  buffer_load_dwordx4 v[56:59], v76, s[8:11], s64 offen offset:1024 sc1
  buffer_load_dwordx4 v[12:15], v76, s[8:11], s65 offen offset:0 sc1
  s_mov_b64 exec, -1
  s_add_u32 s67, s67, 1
  s_waitcnt vmcnt(6)
  v_max3_u32 v72, v52, v53, v54
  v_max3_u32 v72, v72, v55, v56
  v_max3_u32 v72, v72, v57, v58
  v_max3_u32 v72, v72, v59, v12
  v_max3_u32 v72, v72, v13, v14
  v_max_u32 v72, v72, v15
  v_cmp_eq_u32 vcc, -1, v72
  s_cbranch_vccz Cs0_h2ok
  s_mov_b64 exec, vcc
  buffer_load_dwordx4 v[52:55], v76, s[8:11], s64 offen offset:0 sc1
  buffer_load_dwordx4 v[56:59], v76, s[8:11], s64 offen offset:1024 sc1
  buffer_load_dwordx4 v[12:15], v76, s[8:11], s65 offen offset:0 sc1
  s_mov_b64 exec, -1
  s_add_u32 s67, s67, 1
  s_waitcnt vmcnt(6)
  v_max3_u32 v72, v52, v53, v54
  v_max3_u32 v72, v72, v55, v56
  v_max3_u32 v72, v72, v57, v58
  v_max3_u32 v72, v72, v59, v12
  v_max3_u32 v72, v72, v13, v14
  v_max_u32 v72, v72, v15
  v_cmp_eq_u32 vcc, -1, v72
  s_cbranch_vccz Cs0_h2ok
  s_mov_b64 exec, vcc
  buffer_load_dwordx4 v[52:55], v76, s[8:11], s64 offen offset:0 sc1
  buffer_load_dwordx4 v[56:59], v76, s[8:11], s64 offen offset:1024 sc1
  buffer_load_dwordx4 v[12:15], v76, s[8:11], s65 offen offset:0 sc1
  s_mov_b64 exec, -1
  s_add_u32 s67, s67, 1
  s_waitcnt vmcnt(6)
  v_max3_u32 v72, v52, v53, v54
  v_max3_u32 v72, v72, v55, v56
  v_max3_u32 v72, v72, v57, v58
  v_max3_u32 v72, v72, v59, v12
  v_max3_u32 v72, v72, v13, v14
  v_max_u32 v72, v72, v15
  v_cmp_eq_u32 vcc, -1, v72
  s_cbranch_vccz Cs0_h2ok
  s_mov_b64 exec, vcc
  buffer_load_dwordx4 v[52:55], v76, s[8:11], s64 offen offset:0 sc1
  buffer_load_dwordx4 v[56:59], v76, s[8:11], s64 offen offset:1024 sc1
  buffer_load_dwordx4 v[12:15], v76, s[8:11], s65 offen offset:0 sc1
  s_mov_b64 exec, -1
  s_add_u32 s67, s67, 1
  s_waitcnt vmcnt(6)
  v_max3_u32 v72, v52, v53, v54
  v_max3_u32 v72, v72, v55, v56
  v_max3_u32 v72, v72, v57, v58
  v_max3_u32 v72, v72, v59, v12
  v_max3_u32 v72, v72, v13, v14
  v_max_u32 v72, v72, v15
  v_cmp_eq_u32 vcc, -1, v72
  s_cbranch_vccz Cs0_h2ok
  s_cmp_lt_u32 s67, 131072
  s_cbranch_scc1 Cs0_h2s
Cs0_h2ok:
  ds_write_b128 v76, v[52:55] offset:4608
  ds_write_b128 v76, v[56:59] offset:5632
  ds_write_b128 v76, v[12:15] offset:12800
  s_branch Cs0_h2w
Cs0_last:
  s_nop 7
  s_waitcnt vmcnt(0) lgkmcnt(0)
  ds_read_b64 v[16:17], v77 offset:256
  v_mov_b64 v[18:19], v[72:73]
  s_add_u32 s68, s68, 131072
  s_waitcnt lgkmcnt(0)
  buffer_store_dwordx4 v[16:19], v76, s[8:11], s68 offen sc1
  s_waitcnt vmcnt(0)
  s_barrier
  s_branch L_cexit
L_w5:
  v_mov_b64 v[20:21], 0
  v_mov_b64 v[22:23], 0
  v_mov_b64 v[24:25], 0
  v_mov_b64 v[26:27], 0
  v_mov_b64 v[28:29], 0
  v_mov_b64 v[30:31], 0
  v_mov_b64 v[32:33], 0
  v_mov_b64 v[34:35], 0
  s_mov_b32 m0, 15872
  s_branch Cs1_h2
.p2align 6
Cs1_top:
  s_waitcnt lgkmcnt(0)
  s_barrier
  ds_read_b128 v[0:3], v76 offset:4608
  ds_read_b128 v[4:7], v76 offset:5632
  s_waitcnt lgkmcnt(1)
  v_smfmac_f32_16x16x64_bf16 v[20:23], v[0:3], v[60:67], v74
  ds_read_b128 v[60:63], v76 offset:38912
  v_smfmac_f32_16x16x64_bf16 v[24:27], v[0:3], v[44:51], v74
  ds_read_b128 v[64:67], v76 offset:39936
  s_waitcnt lgkmcnt(2)
  v_smfmac_f32_16x16x64_bf16 v[20:23], v[4:7], v[80:87], v74
  buffer_load_dwordx4 v[44:47], v76, s[8:11], s58 offen offset:0 sc1
  ds_read_b128 v[8:11], v76 offset:6656
  v_smfmac_f32_16x16x64_bf16 v[28:31], v[0:3], v[36:43], v74
  ds_read_b128 v[36:39], v76 offset:53248
  v_smfmac_f32_16x16x64_bf16 v[24:27], v[4:7], v[88:95], v74
  buffer_load_dwordx4 v[48:51], v76, s[8:11], s58 offen offset:1024 sc1
  ds_read_b128 v[40:43], v76 offset:54272
  v_smfmac_f32_16x16x64_bf16 v[28:31], v[4:7], v[208:215], v74
  ds_read_b128 v[12:15], v76 offset:7680
  v_smfmac_f32_16x16x64_bf16 v[32:35], v[4:7], v[216:223], v74
  buffer_load_dwordx4 v[52:55], v76, s[8:11], s59 offen offset:0 sc1
  s_waitcnt lgkmcnt(4)
  v_smfmac_f32_16x16x64_bf16 v[32:35], v[0:3], v[60:67], v74
  ds_read_b128 v[60:63], v76 offset:55296
  s_waitcnt lgkmcnt(4)
  v_smfmac_f32_16x16x64_bf16 v[20:23], v[8:11], v[96:103], v74
  buffer_load_dwordx4 v[56:59], v76, s[8:11], s59 offen offset:1024 sc1
  ds_read_b128 v[64:67], v76 offset:56320
  v_smfmac_f32_16x16x64_bf16 v[24:27], v[8:11], v[104:111], v74
  ds_read_b128 v[0:3], v76 offset:12800
  s_waitcnt lgkmcnt(4)
  v_smfmac_f32_16x16x64_bf16 v[28:31], v[8:11], v[36:43], v74
  ds_read_b128 v[36:39], v75 offset:4096
  s_waitcnt lgkmcnt(4)
  v_smfmac_f32_16x16x64_bf16 v[20:23], v[12:15], v[112:119], v74
  buffer_store_dwordx4 v[16:19], v76, s[8:11], s68 offen sc1
  ds_read_b128 v[40:43], v75 offset:5120
  v_smfmac_f32_16x16x64_bf16 v[24:27], v[12:15], v[120:127], v74
  buffer_load_dword v73, s[8:11], s70 offen lds
  s_waitcnt lgkmcnt(3)
  v_smfmac_f32_16x16x64_bf16 v[32:35], v[8:11], v[60:67], v74
  ds_read_b128 v[60:63], v75 offset:6144
  v_smfmac_f32_16x16x64_bf16 v[28:31], v[12:15], v[224:231], v74
  ds_read_b128 v[64:67], v75 offset:7168
  v_smfmac_f32_16x16x64_bf16 v[32:35], v[12:15], v[232:239], v74
  s_barrier
  s_waitcnt lgkmcnt(4)
  v_smfmac_f32_16x16x64_bf16 v[20:23], v[0:3], v[192:199], v74
  ds_read_b128 v[4:7], v76 offset:8704
  s_waitcnt lgkmcnt(3)
  v_smfmac_f32_16x16x64_bf16 v[28:31], v[0:3], v[36:43], v74
  ds_read_b128 v[16:19], v76 offset:9728
  v_smfmac_f32_16x16x64_bf16 v[24:27], v[0:3], v[200:207], v74
  ds_read_b128 v[36:39], v75 offset:20480
  s_waitcnt lgkmcnt(3)
  v_mov_b32 v68, 0x3f803f80
  v_smfmac_f32_16x16x64_bf16 v[32:35], v[0:3], v[60:67], v74
  ds_read_b128 v[40:43], v75 offset:21504
  s_waitcnt lgkmcnt(3)
  v_smfmac_f32_16x16x64_bf16 v[20:23], v[4:7], v[128:135], v74
  ds_read_b128 v[12:15], v76 offset:10752
  v_mov_b32 v69, 0x3f803f80
  v_smfmac_f32_16x16x64_bf16 v[24:27], v[4:7], v[136:143], v74
  ds_read_b128 v[8:11], v76 offset:11776
  s_waitcnt lgkmcnt(4)
  v_smfmac_f32_16x16x64_bf16 v[20:23], v[16:19], v[144:151], v74
  ds_read_b128 v[60:63], v75 offset:22528
  v_mov_b64 v[70:71], v[68:69]
  v_smfmac_f32_16x16x64_bf16 v[24:27], v[16:19], v[152:159], v74
  ds_read_b128 v[64:67], v75 offset:23552
  s_waitcnt lgkmcnt(4)
  v_smfmac_f32_16x16x64_bf16 v[28:31], v[4:7], v[36:43], v74
  s_waitcnt lgkmcnt(3)
  v_mov_b64 v[36:37], 0
  v_smfmac_f32_16x16x64_bf16 v[20:23], v[12:15], v[160:167], v74
  s_waitcnt lgkmcnt(2)
  v_mov_b64 v[38:39], 0
  v_smfmac_f32_16x16x64_bf16 v[20:23], v[8:11], v[176:183], v74
  v_mov_b64 v[40:41], 0
  v_smfmac_f32_16x16x64_bf16 v[24:27], v[12:15], v[168:175], v74
  v_mov_b64 v[42:43], 0
  v_smfmac_f32_16x16x64_bf16 v[24:27], v[8:11], v[184:191], v74
  s_waitcnt lgkmcnt(0)
  v_add_f32 v20, v20, v22
  v_smfmac_f32_16x16x64_bf16 v[32:35], v[4:7], v[60:67], v74
  v_add_f32 v21, v21, v23
  v_smfmac_f32_16x16x64_bf16 v[28:31], v[16:19], v[240:247], v74
  v_add_f32 v24, v24, v26
  v_cvt_pk_bf16_f32 v22, v20, v24
  v_smfmac_f32_16x16x64_bf16 v[28:31], v[12:15], a[0:7], v74
  ds_write_b32 v79, v22 offset:0
  v_add_f32 v25, v25, v27
  v_cvt_pk_bf16_f32 v23, v21, v25
  v_smfmac_f32_16x16x64_bf16 v[28:31], v[8:11], a[16:23], v74
  ds_write_b32 v79, v23 offset:576
  v_cmp_u_f32 vcc, v20, v21
  v_smfmac_f32_16x16x64_bf16 v[32:35], v[16:19], v[248:255], v74
  s_mov_b64 exec, 1
  buffer_store_dword v72, v76, s[8:11], s71 offen sc1
  s_mov_b64 exec, -1
  v_smfmac_f32_16x16x64_bf16 v[32:35], v[12:15], a[8:15], v74
  v_add_f32 v28, v28, v30
  v_add_f32 v29, v29, v31
  v_smfmac_f32_16x16x64_bf16 v[32:35], v[8:11], a[24:31], v74
  s_cbranch_vccnz Cs1_rec
Cs1_recok:
  v_smfmac_f32_16x16x64_bf16 v[36:39], v[16:19], a[112:119], v74
  s_waitcnt lgkmcnt(0)
  s_barrier
  ds_read_b128 v[60:63], v77
  v_smfmac_f32_16x16x64_bf16 v[40:43], v[16:19], a[120:127], v74
  ds_read_b128 v[64:67], v77 offset:128
  v_add_f32 v32, v32, v34
  v_cvt_pk_bf16_f32 v30, v28, v32
  v_smfmac_f32_16x16x64_bf16 v[36:39], v[0:3], a[160:167], v74
  ds_write_b32 v79, v30 offset:256
  v_add_f32 v33, v33, v35
  v_cvt_pk_bf16_f32 v31, v29, v33
  v_smfmac_f32_16x16x64_bf16 v[40:43], v[0:3], a[168:175], v74
  ds_write_b32 v79, v31 offset:832
  v_xor_b32 v75, 0x8000, v75
  v_smfmac_f32_16x16x64_bf16 v[36:39], v[4:7], a[96:103], v74
  ds_read_b128 v[0:3], v76 offset:4608
  v_mov_b32 v29, 0
  v_smfmac_f32_16x16x64_bf16 v[40:43], v[4:7], a[104:111], v74
  s_waitcnt vmcnt(5) lgkmcnt(3)
  v_mov_b32 v30, 0
  v_mfma_f32_16x16x32_bf16 v[44:47], v[44:47], v[60:63], 0
  ds_read_b128 v[4:7], v76 offset:5632
  s_waitcnt lgkmcnt(2)
  v_mfma_f32_16x16x32_bf16 v[44:47], v[48:51], v[64:67], v[44:47]
  s_barrier
  v_smfmac_f32_16x16x64_bf16 v[36:39], v[8:11], a[144:151], v74
  ds_read_b128 v[20:23], v77 offset:256
  ds_read_b128 v[24:27], v77 offset:384
  v_smfmac_f32_16x16x64_bf16 v[40:43], v[8:11], a[152:159], v74
  ds_read_b128 v[8:11], v76 offset:6656
  v_add_f32_dpp v72, v46, v44 quad_perm:[2,3,0,1] row_mask:0xf bank_mask:0xf
  v_add_f32_dpp v73, v47, v45 quad_perm:[2,3,0,1] row_mask:0xf bank_mask:0xf
  v_smfmac_f32_16x16x64_bf16 v[36:39], v[12:15], a[128:135], v74
  ds_read_b128 v[44:47], v75 offset:4096
  v_exp_f32_dpp v72, v72 quad_perm:[0,1,0,1] row_mask:0xf bank_mask:0xf
  v_smfmac_f32_16x16x64_bf16 v[40:43], v[12:15], a[136:143], v74
  ds_read_b128 v[12:15], v76 offset:7680
  s_waitcnt lgkmcnt(6)
  v_exp_f32_dpp v73, v73 quad_perm:[0,1,0,1] row_mask:0xf bank_mask:0xf
  v_smfmac_f32_16x16x64_bf16 v[36:39], v[0:3], a[32:39], v74
  s_waitcnt lgkmcnt(3)
  v_cvt_pk_bf16_f32 v72, v72, v73
  v_mfma_f32_16x16x32_bf16 v[20:23], v[20:23], v[60:63], 0
  ds_write_b32 v78, v72 offset:516
  v_mfma_f32_16x16x32_bf16 v[20:23], v[24:27], v[64:67], v[20:23]
  ds_read_b128 v[48:51], v75 offset:5120
  v_smfmac_f32_16x16x64_bf16 v[40:43], v[0:3], a[40:47], v74
  ds_read_b128 v[60:63], v75 offset:6144
  v_smfmac_f32_16x16x64_bf16 v[36:39], v[4:7], a[48:55], v74
  s_waitcnt lgkmcnt(5)
  v_add_f32_dpp v24, v22, v20 quad_perm:[2,3,0,1] row_mask:0xf bank_mask:0xf
  v_add_f32_dpp v25, v23, v21 quad_perm:[2,3,0,1] row_mask:0xf bank_mask:0xf
  v_smfmac_f32_16x16x64_bf16 v[36:39], v[8:11], a[64:71], v74
  s_waitcnt lgkmcnt(2)
  s_barrier
  ds_read_b128 v[32:35], v78 offset:512
  v_smfmac_f32_16x16x64_bf16 v[36:39], v[12:15], a[80:87], v74
  ds_read_b128 v[64:67], v75 offset:7168
  v_mul_f32 v24, s69, v24
  v_smfmac_f32_16x16x64_bf16 v[40:43], v[4:7], a[56:63], v74
  v_mul_f32 v25, s69, v25
  v_smfmac_f32_16x16x64_bf16 v[40:43], v[8:11], a[72:79], v74
  v_exp_f32_dpp v24, v24 quad_perm:[0,1,0,1] row_mask:0xf bank_mask:0xf
  v_smfmac_f32_16x16x64_bf16 v[40:43], v[12:15], a[88:95], v74
  s_waitcnt vmcnt(3) lgkmcnt(1)
  v_exp_f32_dpp v25, v25 quad_perm:[0,1,0,1] row_mask:0xf bank_mask:0xf
  v_mfma_f32_16x16x32_bf16 v[8:11], v[32:35], v[68:71], 0
  v_add_f32 v36, v36, v38
  v_add_f32 v37, v37, v39
  v_mfma_f32_16x16x32_bf16 v[0:3], v[32:35], v[52:55], 0
  v_add_f32 v40, v40, v42
  v_add_f32 v41, v41, v43
  v_mfma_f32_16x16x32_bf16 v[4:7], v[32:35], v[56:59], 0
  v_cvt_pk_bf16_f32 v28, v24, v25
  v_cvt_pk_bf16_f32 v72, v36, v37
  v_cvt_pk_bf16_f32 v73, v40, v41
  v_mfma_f32_16x16x16_bf16 v[8:11], v[28:29], v[68:69], v[8:11]
  v_cvt_pk_bf16_f32 v31, v24, v25
  v_mfma_f32_16x16x16_bf16 v[0:3], v[28:29], v[72:73], v[0:3]
  ds_read_b128 v[68:71], v76 offset:13824
  v_mfma_f32_16x16x16_bf16 v[4:7], v[30:31], v[72:73], v[4:7]
  v_rcp_f32 v10, v8
  v_rcp_f32 v11, v9
  v_mul_f32 v0, v10, v0
  v_mul_f32 v1, v11, v1
  s_nop 0
  v_mul_f32 v4, v10, v4
  v_mul_f32 v5, v11, v5
  v_cvt_pk_bf16_f32 v2, v0, v4
  ds_write_b32 v79, v2 offset:8704
  v_cvt_pk_bf16_f32 v3, v1, v5
  ds_write_b32 v79, v3 offset:9280
  v_subrev_u32 v8, 813694976, v8
  v_subrev_u32 v9, 813694976, v9
  v_max_u32 v8, v8, v9
  v_cmp_le_u32 vcc, 503316480, v8
  v_mov_b64 v[16:17], 0
  v_mov_b64 v[18:19], 0
  v_mov_b64 v[20:21], 0
  v_mov_b64 v[22:23], 0
  s_cbranch_vccnz Cs1_mx
Cs1_mxok:
  s_cmp_eq_u32 s66, 63
  s_waitcnt lgkmcnt(0)
  s_barrier
  ds_read_b128 v[0:3], v78 offset:8704
  ds_read_b128 v[4:7], v78 offset:8768
  ds_read_b128 v[8:11], v78 offset:8832
  ds_read_b128 v[12:15], v78 offset:8896
  v_mov_b64 v[24:25], 0
  v_mov_b64 v[26:27], 0
  v_mov_b64 v[28:29], 0
  v_mov_b64 v[30:31], 0
  v_mov_b64 v[32:33], 0
  v_mov_b64 v[34:35], 0
  s_waitcnt lgkmcnt(3)
  v_smfmac_f32_16x16x64_bf16 v[16:19], v[0:3], a[176:183], v74
  s_cbranch_scc1 Cs1_last
  s_waitcnt lgkmcnt(2)
  v_smfmac_f32_16x16x64_bf16 v[16:19], v[4:7], a[184:191], v74
  s_waitcnt lgkmcnt(1)
  v_smfmac_f32_16x16x64_bf16 v[16:19], v[8:11], a[192:199], v74
  ds_read_b128 v[52:55], v75 offset:20480
  s_waitcnt lgkmcnt(1)
  v_smfmac_f32_16x16x64_bf16 v[16:19], v[12:15], a[200:207], v74
  ds_read_b128 v[56:59], v75 offset:21504
  v_smfmac_f32_16x16x64_bf16 v[20:23], v[0:3], a[208:215], v74
  ds_read_b128 v[36:39], v75 offset:22528
  v_smfmac_f32_16x16x64_bf16 v[20:23], v[4:7], a[216:223], v74
  ds_read_b128 v[40:43], v75 offset:23552
  v_cvt_pk_bf16_f32 v16, v16, v17
  v_cvt_pk_bf16_f32 v17, v18, v19
  v_bfi_b32 v16, 1, s72, v16
  v_smfmac_f32_16x16x64_bf16 v[20:23], v[8:11], v[44:51], v74
  ds_read_b128 v[44:47], v75 offset:36864
  buffer_store_dwordx2 v[16:17], v68, s[8:11], s73 offen sc1
  v_smfmac_f32_16x16x64_bf16 v[20:23], v[12:15], v[60:67], v74
  ds_read_b128 v[48:51], v75 offset:37888
  v_smfmac_f32_16x16x64_bf16 v[24:27], v[0:3], a[224:231], v74
  ds_read_b128 v[60:63], v75 offset:38912
  v_smfmac_f32_16x16x64_bf16 v[24:27], v[4:7], a[232:239], v74
  ds_read_b128 v[64:67], v75 offset:39936
  s_waitcnt lgkmcnt(6)
  v_cvt_pk_bf16_f32 v20, v20, v21
  v_cvt_pk_bf16_f32 v21, v22, v23
  v_bfi_b32 v20, 1, s72, v20
  v_smfmac_f32_16x16x64_bf16 v[24:27], v[8:11], v[52:59], v74
  buffer_store_dwordx2 v[20:21], v68, s[8:11], s74 offen sc1
  s_waitcnt lgkmcnt(4)
  v_mov_b64 v[18:19], v[72:73]
  v_smfmac_f32_16x16x64_bf16 v[24:27], v[12:15], v[36:43], v74
  v_mov_b64 v[20:21], 0
  v_smfmac_f32_16x16x64_bf16 v[28:31], v[0:3], a[240:247], v74
  v_mov_b64 v[22:23], 0
  v_smfmac_f32_16x16x64_bf16 v[28:31], v[4:7], a[248:255], v74
  s_waitcnt lgkmcnt(2)
  v_cvt_pk_bf16_f32 v24, v24, v25
  v_cvt_pk_bf16_f32 v25, v26, v27
  v_bfi_b32 v24, 1, s72, v24
  v_smfmac_f32_16x16x64_bf16 v[28:31], v[8:11], v[44:51], v74
  buffer_store_dwordx2 v[24:25], v68, s[8:11], s75 offen sc1
  s_waitcnt lgkmcnt(0)
  v_smfmac_f32_16x16x64_bf16 v[28:31], v[12:15], v[60:67], v74
  ds_read_b64 v[16:17], v77 offset:264
  v_xor_b32 v75, 0x8000, v75
  ds_read_b128 v[0:3], v76 offset:14848
  s_nop 3
  v_cvt_pk_bf16_f32 v28, v28, v29
  v_cvt_pk_bf16_f32 v29, v30, v31
  v_bfi_b32 v28, 1, s72, v28
  buffer_store_dwordx2 v[28:29], v68, s[8:11], s76 offen sc1
  v_mov_b64 v[24:25], 0
  v_mov_b64 v[26:27], 0
  v_mov_b64 v[28:29], 0
  v_mov_b64 v[30:31], 0
  s_add_u32 s58, s58, 524288
  s_add_u32 s59, s59, 524288
  s_add_u32 s70, s70, 524288
  s_add_u32 s68, s68, 131072
  s_add_u32 s66, s66, 1
  s_xor_b32 s64, s64, 16384
  s_xor_b32 s65, s65, 16384
  s_nop 15
  s_nop 15
  s_nop 7
  buffer_load_dwordx4 v[52:55], v76, s[8:11], s60 offen offset:0 sc1
  buffer_load_dwordx4 v[56:59], v76, s[8:11], s60 offen offset:1024 sc1
  s_nop 15
  s_nop 11
  buffer_load_dwordx4 v[36:39], v76, s[8:11], s60 offen offset:0 sc1
  buffer_load_dwordx4 v[40:43], v76, s[8:11], s60 offen offset:1024 sc1
  s_waitcnt vmcnt(3) lgkmcnt(0)
  v_mfma_f32_16x16x32_bf16 v[4:7], v[0:3], v[52:55], 0
  v_bitop3_b32 v72, v52, v54, s72 bitop3:0x7e
  s_waitcnt vmcnt(2)
  v_mfma_f32_16x16x32_bf16 v[4:7], v[0:3], v[56:59], v[4:7]
  v_bitop3_b32 v73, v56, v58, s72 bitop3:0x7e
  v_bitop3_b32 v72, v72, v73, 1 bitop3:0xa8
  v_cmp_ne_u32 vcc, 0, v72
  s_cbranch_vccnz Cs1_h1r
Cs1_h1p:
  s_nop 2
  v_add_f32_dpp v4, v4, v4 row_ror:4 row_mask:0xf bank_mask:0xf
  v_add_f32_dpp v5, v5, v5 row_ror:4 row_mask:0xf bank_mask:0xf
  s_nop 0
  v_add_f32_dpp v4, v4, v4 row_ror:8 row_mask:0xf bank_mask:0xf
  v_add_f32_dpp v5, v5, v5 row_ror:8 row_mask:0xf bank_mask:0xf
  v_cvt_pk_bf16_f32 v4, v4, v5
  buffer_store_dword v4, v69, s[8:11], s62 offen sc1
Cs1_h1ok:
  s_xor_b32 s62, s62, 16384
  s_xor_b32 s72, s72, 1
  s_nop 15
  s_nop 7
Cs1_h2:
  v_lshlrev_b32 v73, 2, v76
  buffer_load_dwordx4 v[52:55], v76, s[8:11], s64 offen offset:0 sc1
  buffer_load_dwordx4 v[56:59], v76, s[8:11], s64 offen offset:1024 sc1
  s_nop 15
  s_nop 1
  buffer_load_dwordx4 v[52:55], v76, s[8:11], s64 offen offset:0 sc1
  buffer_load_dwordx4 v[56:59], v76, s[8:11], s64 offen offset:1024 sc1
  s_nop 15
  s_nop 1
  buffer_load_dwordx4 v[52:55], v76, s[8:11], s64 offen offset:0 sc1
  buffer_load_dwordx4 v[56:59], v76, s[8:11], s64 offen offset:1024 sc1
  s_waitcnt vmcnt(7)
  ds_read_b128 v[60:63], v76 offset:20480
  ds_read_b128 v[64:67], v76 offset:21504
  ds_read_b128 v[44:47], v76 offset:22528
  ds_read_b128 v[48:51], v76 offset:23552
  ds_read_b128 v[36:39], v76 offset:36864
  ds_read_b128 v[40:43], v76 offset:37888
  s_waitcnt vmcnt(4)
  v_max3_u32 v72, v52, v53, v54
  v_max3_u32 v72, v72, v55, v56
  v_max3_u32 v72, v72, v57, v58
  v_max_u32 v72, v72, v59
  ds_write_b128 v76, v[52:55] offset:6656
  ds_write_b128 v76, v[56:59] offset:7680
  v_cmp_eq_u32 vcc, -1, v72
  s_cbranch_vccnz Cs1_h2r
Cs1_h2w:
  buffer_store_dword v71, v69, s[8:11], s62 offen sc1
  v_mov_b32 v72, s66
  s_branch Cs1_top
Cs1_rec:
  s_nop 7
  s_waitcnt vmcnt(0) lgkmcnt(0)
  v_max3_u32 v72, v0, v1, v2
  v_max3_u32 v72, v72, v3, v4
  v_max3_u32 v72, v72, v5, v6
  v_max3_u32 v72, v72, v7, v8
  v_max3_u32 v72, v72, v9, v10
  v_max3_u32 v72, v72, v11, v12
  v_max3_u32 v72, v72, v13, v14
  v_max3_u32 v72, v72, v15, v16
  v_max3_u32 v72, v72, v17, v18
  v_max_u32 v72, v72, v19
  v_cmp_eq_u32 vcc, -1, v72
  s_cbranch_vccz Cs1_recok
  s_barrier
  v_mov_b64 v[20:21], 0
  v_mov_b64 v[22:23], 0
  v_mov_b64 v[24:25], 0
  v_mov_b64 v[26:27], 0
  v_mov_b64 v[28:29], 0
  v_mov_b64 v[30:31], 0
  v_mov_b64 v[32:33], 0
  v_mov_b64 v[34:35], 0
  s_waitcnt lgkmcnt(0)
  s_barrier
  ds_read_b128 v[0:3], v76 offset:4608
  ds_read_b128 v[60:63], v76 offset:20480
  ds_read_b128 v[64:67], v76 offset:21504
  s_waitcnt lgkmcnt(0)
  v_smfmac_f32_16x16x64_bf16 v[20:23], v[0:3], v[60:67], v74
  ds_read_b128 v[60:63], v76 offset:22528
  ds_read_b128 v[64:67], v76 offset:23552
  s_waitcnt lgkmcnt(0)
  v_smfmac_f32_16x16x64_bf16 v[24:27], v[0:3], v[60:67], v74
  ds_read_b128 v[60:63], v76 offset:36864
  ds_read_b128 v[64:67], v76 offset:37888
  s_waitcnt lgkmcnt(0)
  v_smfmac_f32_16x16x64_bf16 v[28:31], v[0:3], v[60:67], v74
  ds_read_b128 v[60:63], v76 offset:38912
  ds_read_b128 v[64:67], v76 offset:39936
  s_waitcnt lgkmcnt(0)
  v_smfmac_f32_16x16x64_bf16 v[32:35], v[0:3], v[60:67], v74
  ds_read_b128 v[4:7], v76 offset:5632
  s_waitcnt lgkmcnt(0)
  v_smfmac_f32_16x16x64_bf16 v[20:23], v[4:7], v[80:87], v74
  v_smfmac_f32_16x16x64_bf16 v[24:27], v[4:7], v[88:95], v74
  v_smfmac_f32_16x16x64_bf16 v[28:31], v[4:7], v[208:215], v74
  v_smfmac_f32_16x16x64_bf16 v[32:35], v[4:7], v[216:223], v74
  ds_read_b128 v[8:11], v76 offset:6656
  s_waitcnt lgkmcnt(0)
  v_smfmac_f32_16x16x64_bf16 v[20:23], v[8:11], v[96:103], v74
  v_smfmac_f32_16x16x64_bf16 v[24:27], v[8:11], v[104:111], v74
  ds_read_b128 v[60:63], v76 offset:53248
  ds_read_b128 v[64:67], v76 offset:54272
  s_waitcnt lgkmcnt(0)
  v_smfmac_f32_16x16x64_bf16 v[28:31], v[8:11], v[60:67], v74
  ds_read_b128 v[60:63], v76 offset:55296
  ds_read_b128 v[64:67], v76 offset:56320
  s_waitcnt lgkmcnt(0)
  v_smfmac_f32_16x16x64_bf16 v[32:35], v[8:11], v[60:67], v74
  ds_read_b128 v[12:15], v76 offset:7680
  s_waitcnt lgkmcnt(0)
  v_smfmac_f32_16x16x64_bf16 v[20:23], v[12:15], v[112:119], v74
  v_smfmac_f32_16x16x64_bf16 v[24:27], v[12:15], v[120:127], v74
  v_smfmac_f32_16x16x64_bf16 v[28:31], v[12:15], v[224:231], v74
  v_smfmac_f32_16x16x64_bf16 v[32:35], v[12:15], v[232:239], v74
  ds_read_b128 v[4:7], v76 offset:8704
  s_waitcnt lgkmcnt(0)
  v_smfmac_f32_16x16x64_bf16 v[20:23], v[4:7], v[128:135], v74
  v_smfmac_f32_16x16x64_bf16 v[24:27], v[4:7], v[136:143], v74
  ds_read_b128 v[60:63], v75 offset:20480
  ds_read_b128 v[64:67], v75 offset:21504
  s_waitcnt lgkmcnt(0)
  v_smfmac_f32_16x16x64_bf16 v[28:31], v[4:7], v[60:67], v74
  ds_read_b128 v[60:63], v75 offset:22528
  ds_read_b128 v[64:67], v75 offset:23552
  s_waitcnt lgkmcnt(0)
  v_smfmac_f32_16x16x64_bf16 v[32:35], v[4:7], v[60:67], v74
  ds_read_b128 v[16:19], v76 offset:9728
  s_waitcnt lgkmcnt(0)
  v_smfmac_f32_16x16x64_bf16 v[20:23], v[16:19], v[144:151], v74
  v_smfmac_f32_16x16x64_bf16 v[24:27], v[16:19], v[152:159], v74
  v_smfmac_f32_16x16x64_bf16 v[28:31], v[16:19], v[240:247], v74
  v_smfmac_f32_16x16x64_bf16 v[32:35], v[16:19], v[248:255], v74
  ds_read_b128 v[12:15], v76 offset:10752
  s_waitcnt lgkmcnt(0)
  v_smfmac_f32_16x16x64_bf16 v[20:23], v[12:15], v[160:167], v74
  v_smfmac_f32_16x16x64_bf16 v[24:27], v[12:15], v[168:175], v74
  v_smfmac_f32_16x16x64_bf16 v[28:31], v[12:15], a[0:7], v74
  v_smfmac_f32_16x16x64_bf16 v[32:35], v[12:15], a[8:15], v74
  ds_read_b128 v[8:11], v76 offset:11776
  s_waitcnt lgkmcnt(0)
  v_smfmac_f32_16x16x64_bf16 v[20:23], v[8:11], v[176:183], v74
  v_smfmac_f32_16x16x64_bf16 v[24:27], v[8:11], v[184:191], v74
  v_smfmac_f32_16x16x64_bf16 v[28:31], v[8:11], a[16:23], v74
  v_smfmac_f32_16x16x64_bf16 v[32:35], v[8:11], a[24:31], v74
  ds_read_b128 v[0:3], v76 offset:12800
  s_waitcnt lgkmcnt(0)
  v_smfmac_f32_16x16x64_bf16 v[20:23], v[0:3], v[192:199], v74
  v_smfmac_f32_16x16x64_bf16 v[24:27], v[0:3], v[200:207], v74
  ds_read_b128 v[60:63], v75 offset:4096
  ds_read_b128 v[64:67], v75 offset:5120
  s_waitcnt lgkmcnt(0)
  v_smfmac_f32_16x16x64_bf16 v[28:31], v[0:3], v[60:67], v74
  ds_read_b128 v[60:63], v75 offset:6144
  ds_read_b128 v[64:67], v75 offset:7168
  s_waitcnt lgkmcnt(0)
  v_smfmac_f32_16x16x64_bf16 v[32:35], v[0:3], v[60:67], v74
  v_add_f32 v20, v20, v22
  v_add_f32 v21, v21, v23
  v_add_f32 v24, v24, v26
  v_cvt_pk_bf16_f32 v22, v20, v24
  ds_write_b32 v79, v22 offset:0
  v_add_f32 v25, v25, v27
  v_cvt_pk_bf16_f32 v23, v21, v25
  ds_write_b32 v79, v23 offset:576
  v_add_f32 v28, v28, v30
  v_add_f32 v29, v29, v31
  s_waitcnt lgkmcnt(0)
  s_nop 1
  s_branch Cs1_recok
Cs1_mx:
  s_waitcnt lgkmcnt(0)
  s_barrier
  buffer_load_dwordx4 v[0:3], v76, s[8:11], s58 offen offset:0 sc1
  ds_read_b128 v[20:23], v77 offset:0
  ds_read_b128 v[28:31], v77 offset:256
  buffer_load_dwordx4 v[4:7], v76, s[8:11], s58 offen offset:1024 sc1
  ds_read_b128 v[24:27], v77 offset:128
  ds_read_b128 v[32:35], v77 offset:384
  s_waitcnt vmcnt(1) lgkmcnt(3)
  v_mfma_f32_16x16x32_bf16 v[8:11], v[0:3], v[20:23], 0
  s_waitcnt vmcnt(0) lgkmcnt(1)
  v_mfma_f32_16x16x32_bf16 v[8:11], v[4:7], v[24:27], v[8:11]
  v_mfma_f32_16x16x32_bf16 v[12:15], v[28:31], v[20:23], 0
  s_waitcnt lgkmcnt(0)
  v_mfma_f32_16x16x32_bf16 v[12:15], v[32:35], v[24:27], v[12:15]
  v_add_f32_dpp v8, v10, v8 quad_perm:[2,3,0,1] row_mask:0xf bank_mask:0xf
  v_add_f32_dpp v9, v11, v9 quad_perm:[2,3,0,1] row_mask:0xf bank_mask:0xf
  s_nop 0
  v_mov_b32_dpp v8, v8 quad_perm:[0,1,0,1] row_mask:0xf bank_mask:0xf
  v_mov_b32_dpp v9, v9 quad_perm:[0,1,0,1] row_mask:0xf bank_mask:0xf
  s_nop 1
  v_add_f32_dpp v12, v14, v12 quad_perm:[2,3,0,1] row_mask:0xf bank_mask:0xf
  v_add_f32_dpp v13, v15, v13 quad_perm:[2,3,0,1] row_mask:0xf bank_mask:0xf
  s_nop 0
  v_mov_b32_dpp v12, v12 quad_perm:[0,1,0,1] row_mask:0xf bank_mask:0xf
  v_mov_b32_dpp v13, v13 quad_perm:[0,1,0,1] row_mask:0xf bank_mask:0xf
  v_mul_f32 v12, s69, v12
  ds_write_b32 v78, v8 offset:8708
  v_mul_f32 v13, s69, v13
  ds_write_b32 v78, v9 offset:8772
  s_waitcnt lgkmcnt(0)
  s_barrier
  ds_read_b128 v[36:39], v78 offset:8704
  ds_read_b128 v[40:43], v78 offset:8768
  s_waitcnt lgkmcnt(0)
  s_barrier
  v_max_f32 v16, v36, v37
  v_max3_f32 v16, v16, v38, v39
  v_max3_f32 v16, v16, v40, v41
  v_max3_f32 v16, v16, v42, v43
  v_max3_f32 v16, v16, v12, v13
  v_mov_b32 v17, v16
  s_nop 1
  v_permlane16_swap_b32 v16, v17
  v_max_f32 v16, v16, v17
  v_mov_b32 v17, v16
  s_nop 1
  v_permlane32_swap_b32 v16, v17
  v_max_f32 v16, v16, v17
  v_sub_f32 v36, v36, v16
  v_sub_f32 v37, v37, v16
  v_sub_f32 v38, v38, v16
  v_sub_f32 v39, v39, v16
  v_sub_f32 v40, v40, v16
  v_sub_f32 v41, v41, v16
  v_sub_f32 v42, v42, v16
  v_sub_f32 v43, v43, v16
  v_sub_f32 v12, v12, v16
  v_sub_f32 v13, v13, v16
  v_exp_f32 v36, v36
  v_exp_f32 v37, v37
  v_exp_f32 v38, v38
  v_exp_f32 v39, v39
  v_exp_f32 v40, v40
  v_exp_f32 v41, v41
  v_exp_f32 v42, v42
  v_exp_f32 v43, v43
  v_exp_f32 v12, v12
  v_exp_f32 v13, v13
  v_cvt_pk_bf16_f32 v32, v36, v40
  v_cvt_pk_bf16_f32 v33, v37, v41
  v_cvt_pk_bf16_f32 v34, v38, v42
  v_cvt_pk_bf16_f32 v35, v39, v43
  v_cvt_pk_bf16_f32 v28, v12, v13
  v_cvt_pk_bf16_f32 v31, v12, v13
  v_mov_b32 v29, 0
  v_mov_b32 v30, 0
  v_mov_b32 v68, 0x3f803f80
  v_mov_b32 v69, 0x3f803f80
  v_mov_b32 v70, 0x3f803f80
  v_mov_b32 v71, 0x3f803f80
  s_nop 1
  v_mfma_f32_16x16x32_bf16 v[8:11], v[32:35], v[68:71], 0
  v_mfma_f32_16x16x32_bf16 v[0:3], v[32:35], v[52:55], 0
  v_mfma_f32_16x16x32_bf16 v[4:7], v[32:35], v[56:59], 0
  v_mfma_f32_16x16x16_bf16 v[8:11], v[28:29], v[68:69], v[8:11]
  v_mfma_f32_16x16x16_bf16 v[0:3], v[28:29], v[72:73], v[0:3]
  v_mfma_f32_16x16x16_bf16 v[4:7], v[30:31], v[72:73], v[4:7]
  ds_read_b128 v[68:71], v76 offset:13824
  v_rcp_f32 v10, v8
  v_rcp_f32 v11, v9
  v_mul_f32 v0, v10, v0
  v_mul_f32 v1, v11, v1
  s_nop 0
  v_mul_f32 v4, v10, v4
  v_mul_f32 v5, v11, v5
  v_cvt_pk_bf16_f32 v2, v0, v4
  ds_write_b32 v79, v2 offset:8704
  v_cvt_pk_bf16_f32 v3, v1, v5
  ds_write_b32 v79, v3 offset:9280
  v_mov_b64 v[16:17], 0
  v_mov_b64 v[18:19], 0
  v_mov_b64 v[20:21], 0
  v_mov_b64 v[22:23], 0
  s_branch Cs1_mxok
Cs1_h1r:
  s_mov_b64 exec, vcc
  buffer_load_dwordx4 v[52:55], v76, s[8:11], s60 offen offset:0 sc1
  buffer_load_dwordx4 v[56:59], v76, s[8:11], s60 offen offset:1024 sc1
  s_mov_b64 exec, -1
  s_add_u32 s67, s67, 1
  s_waitcnt vmcnt(3)
  v_mfma_f32_16x16x32_bf16 v[4:7], v[0:3], v[36:39], 0
  v_bitop3_b32 v72, v36, v38, s72 bitop3:0x7e
  s_waitcnt vmcnt(2)
  v_mfma_f32_16x16x32_bf16 v[4:7], v[0:3], v[40:43], v[4:7]
  v_bitop3_b32 v73, v40, v42, s72 bitop3:0x7e
  v_bitop3_b32 v72, v72, v73, 1 bitop3:0xa8
  v_cmp_ne_u32 vcc, 0, v72
  s_cbranch_vccz Cs1_h1p
  s_mov_b64 exec, vcc
  buffer_load_dwordx4 v[36:39], v76, s[8:11], s60 offen offset:0 sc1
  buffer_load_dwordx4 v[40:43], v76, s[8:11], s60 offen offset:1024 sc1
  s_mov_b64 exec, -1
  s_add_u32 s67, s67, 1
  s_waitcnt vmcnt(3)
  v_mfma_f32_16x16x32_bf16 v[4:7], v[0:3], v[52:55], 0
  v_bitop3_b32 v72, v52, v54, s72 bitop3:0x7e
  s_waitcnt vmcnt(2)
  v_mfma_f32_16x16x32_bf16 v[4:7], v[0:3], v[56:59], v[4:7]
  v_bitop3_b32 v73, v56, v58, s72 bitop3:0x7e
  v_bitop3_b32 v72, v72, v73, 1 bitop3:0xa8
  v_cmp_ne_u32 vcc, 0, v72
  s_cbranch_vccz Cs1_h1p
  s_cmp_lt_u32 s67, 131072
  s_cbranch_scc1 Cs1_h1r
  s_branch Cs1_h1p
Cs1_h2r:
Cs1_h2s:
  s_mov_b64 exec, vcc
  buffer_load_dwordx4 v[52:55], v76, s[8:11], s64 offen offset:0 sc1
  buffer_load_dwordx4 v[56:59], v76, s[8:11], s64 offen offset:1024 sc1
  s_mov_b64 exec, -1
  s_add_u32 s67, s67, 1
  s_waitcnt vmcnt(4)
  v_max3_u32 v72, v52, v53, v54
  v_max3_u32 v72, v72, v55, v56
  v_max3_u32 v72, v72, v57, v58
  v_max_u32 v72, v72, v59
  v_cmp_eq_u32 vcc, -1, v72
  s_cbranch_vccz Cs1_h2ok
  s_mov_b64 exec, vcc
  buffer_load_dwordx4 v[52:55], v76, s[8:11], s64 offen offset:0 sc1
  buffer_load_dwordx4 v[56:59], v76, s[8:11], s64 offen offset:1024 sc1
  s_mov_b64 exec, -1
  s_add_u32 s67, s67, 1
  s_waitcnt vmcnt(4)
  v_max3_u32 v72, v52, v53, v54
  v_max3_u32 v72, v72, v55, v56
  v_max3_u32 v72, v72, v57, v58
  v_max_u32 v72, v72, v59
  v_cmp_eq_u32 vcc, -1, v72
  s_cbranch_vccz Cs1_h2ok
  s_mov_b64 exec, vcc
  buffer_load_dwordx4 v[52:55], v76, s[8:11], s64 offen offset:0 sc1
  buffer_load_dwordx4 v[56:59], v76, s[8:11], s64 offen offset:1024 sc1
  s_mov_b64 exec, -1
  s_add_u32 s67, s67, 1
  s_waitcnt vmcnt(4)
  v_max3_u32 v72, v52, v53, v54
  v_max3_u32 v72, v72, v55, v56
  v_max3_u32 v72, v72, v57, v58
  v_max_u32 v72, v72, v59
  v_cmp_eq_u32 vcc, -1, v72
  s_cbranch_vccz Cs1_h2ok
  s_mov_b64 exec, vcc
  buffer_load_dwordx4 v[52:55], v76, s[8:11], s64 offen offset:0 sc1
  buffer_load_dwordx4 v[56:59], v76, s[8:11], s64 offen offset:1024 sc1
  s_mov_b64 exec, -1
  s_add_u32 s67, s67, 1
  s_waitcnt vmcnt(4)
  v_max3_u32 v72, v52, v53, v54
  v_max3_u32 v72, v72, v55, v56
  v_max3_u32 v72, v72, v57, v58
  v_max_u32 v72, v72, v59
  v_cmp_eq_u32 vcc, -1, v72
  s_cbranch_vccz Cs1_h2ok
  s_cmp_lt_u32 s67, 131072
  s_cbranch_scc1 Cs1_h2s
Cs1_h2ok:
  ds_write_b128 v76, v[52:55] offset:6656
  ds_write_b128 v76, v[56:59] offset:7680
  s_branch Cs1_h2w
Cs1_last:
  s_nop 7
  s_waitcnt vmcnt(0) lgkmcnt(0)
  ds_read_b64 v[16:17], v77 offset:264
  v_mov_b64 v[18:19], v[72:73]
  s_add_u32 s68, s68, 131072
  s_waitcnt lgkmcnt(0)
  buffer_store_dwordx4 v[16:19], v76, s[8:11], s68 offen sc1
  s_waitcnt vmcnt(0)
  s_barrier
  v_mov_b32 v72, 65
  s_mov_b64 exec, 1
  buffer_store_dword v72, v76, s[8:11], s71 offen sc1
  s_mov_b64 exec, -1
  s_branch L_cexit
L_w6:
  v_mov_b64 v[20:21], 0
  v_mov_b64 v[22:23], 0
  v_mov_b64 v[24:25], 0
  v_mov_b64 v[26:27], 0
  v_mov_b64 v[28:29], 0
  v_mov_b64 v[30:31], 0
  v_mov_b64 v[32:33], 0
  v_mov_b64 v[34:35], 0
  s_mov_b32 m0, 15872
  s_branch Cs2_h2
.p2align 6
Cs2_top:
  s_waitcnt lgkmcnt(0)
  s_barrier
  ds_read_b128 v[0:3], v76 offset:4608
  ds_read_b128 v[4:7], v76 offset:5632
  buffer_load_dwordx4 v76, s[8:11], s64 offen offset:0 sc1 lds
  buffer_load_dwordx4 v76, s[8:11], s64 offen offset:1024 sc1 lds
  s_waitcnt lgkmcnt(1)
  v_smfmac_f32_16x16x64_bf16 v[20:23], v[0:3], v[60:67], v74
  ds_read_b128 v[60:63], v76 offset:43008
  v_smfmac_f32_16x16x64_bf16 v[24:27], v[0:3], v[44:51], v74
  s_mov_b32 m0, 15872
  ds_read_b128 v[64:67], v76 offset:44032
  s_waitcnt lgkmcnt(2)
  v_smfmac_f32_16x16x64_bf16 v[20:23], v[4:7], v[80:87], v74
  buffer_load_dwordx4 v[44:47], v76, s[8:11], s58 offen offset:0 sc1
  ds_read_b128 v[8:11], v76 offset:6656
  v_smfmac_f32_16x16x64_bf16 v[28:31], v[0:3], v[36:43], v74
  ds_read_b128 v[36:39], v76 offset:57344
  v_smfmac_f32_16x16x64_bf16 v[24:27], v[4:7], v[88:95], v74
  buffer_load_dwordx4 v[48:51], v76, s[8:11], s58 offen offset:1024 sc1
  ds_read_b128 v[40:43], v76 offset:58368
  v_smfmac_f32_16x16x64_bf16 v[28:31], v[4:7], v[208:215], v74
  ds_read_b128 v[12:15], v76 offset:7680
  v_smfmac_f32_16x16x64_bf16 v[32:35], v[4:7], v[216:223], v74
  buffer_load_dwordx4 v[52:55], v76, s[8:11], s59 offen offset:0 sc1
  s_waitcnt lgkmcnt(4)
  v_smfmac_f32_16x16x64_bf16 v[32:35], v[0:3], v[60:67], v74
  ds_read_b128 v[60:63], v76 offset:59392
  s_waitcnt lgkmcnt(4)
  v_smfmac_f32_16x16x64_bf16 v[20:23], v[8:11], v[96:103], v74
  buffer_load_dwordx4 v[56:59], v76, s[8:11], s59 offen offset:1024 sc1
  ds_read_b128 v[64:67], v76 offset:60416
  v_smfmac_f32_16x16x64_bf16 v[24:27], v[8:11], v[104:111], v74
  ds_read_b128 v[0:3], v76 offset:12800
  s_waitcnt lgkmcnt(4)
  v_smfmac_f32_16x16x64_bf16 v[28:31], v[8:11], v[36:43], v74
  ds_read_b128 v[36:39], v75 offset:8192
  s_waitcnt lgkmcnt(4)
  v_smfmac_f32_16x16x64_bf16 v[20:23], v[12:15], v[112:119], v74
  ds_read_b128 v[40:43], v75 offset:9216
  v_smfmac_f32_16x16x64_bf16 v[24:27], v[12:15], v[120:127], v74
  s_waitcnt lgkmcnt(3)
  v_smfmac_f32_16x16x64_bf16 v[32:35], v[8:11], v[60:67], v74
  buffer_store_dwordx4 v[16:19], v76, s[8:11], s68 offen sc1
  ds_read_b128 v[60:63], v75 offset:10240
  v_smfmac_f32_16x16x64_bf16 v[28:31], v[12:15], v[224:231], v74
  buffer_load_dword v73, s[8:11], s70 offen lds
  s_waitcnt vmcnt(6)
  ds_read_b128 v[64:67], v75 offset:11264
  v_smfmac_f32_16x16x64_bf16 v[32:35], v[12:15], v[232:239], v74
  s_barrier
  s_waitcnt lgkmcnt(4)
  v_smfmac_f32_16x16x64_bf16 v[20:23], v[0:3], v[192:199], v74
  ds_read_b128 v[4:7], v76 offset:8704
  s_waitcnt lgkmcnt(3)
  v_smfmac_f32_16x16x64_bf16 v[28:31], v[0:3], v[36:43], v74
  ds_read_b128 v[16:19], v76 offset:9728
  v_smfmac_f32_16x16x64_bf16 v[24:27], v[0:3], v[200:207], v74
  ds_read_b128 v[36:39], v75 offset:24576
  s_waitcnt lgkmcnt(3)
  v_mov_b32 v68, 0x3f803f80
  v_smfmac_f32_16x16x64_bf16 v[32:35], v[0:3], v[60:67], v74
  ds_read_b128 v[40:43], v75 offset:25600
  s_waitcnt lgkmcnt(3)
  v_smfmac_f32_16x16x64_bf16 v[20:23], v[4:7], v[128:135], v74
  ds_read_b128 v[12:15], v76 offset:10752
  v_mov_b32 v69, 0x3f803f80
  v_smfmac_f32_16x16x64_bf16 v[24:27], v[4:7], v[136:143], v74
  ds_read_b128 v[8:11], v76 offset:11776
  s_waitcnt lgkmcnt(4)
  v_smfmac_f32_16x16x64_bf16 v[20:23], v[16:19], v[144:151], v74
  ds_read_b128 v[60:63], v75 offset:26624
  v_mov_b64 v[70:71], v[68:69]
  v_smfmac_f32_16x16x64_bf16 v[24:27], v[16:19], v[152:159], v74
  ds_read_b128 v[64:67], v75 offset:27648
  s_waitcnt lgkmcnt(4)
  v_smfmac_f32_16x16x64_bf16 v[28:31], v[4:7], v[36:43], v74
  s_waitcnt lgkmcnt(3)
  v_mov_b64 v[36:37], 0
  v_smfmac_f32_16x16x64_bf16 v[20:23], v[12:15], v[160:167], v74
  s_waitcnt lgkmcnt(2)
  v_mov_b64 v[38:39], 0
  v_smfmac_f32_16x16x64_bf16 v[20:23], v[8:11], v[176:183], v74
  v_mov_b64 v[40:41], 0
  v_smfmac_f32_16x16x64_bf16 v[24:27], v[12:15], v[168:175], v74
  v_mov_b64 v[42:43], 0
  v_smfmac_f32_16x16x64_bf16 v[24:27], v[8:11], v[184:191], v74
  s_waitcnt lgkmcnt(0)
  v_add_f32 v20, v20, v22
  v_smfmac_f32_16x16x64_bf16 v[32:35], v[4:7], v[60:67], v74
  v_add_f32 v21, v21, v23
  v_smfmac_f32_16x16x64_bf16 v[28:31], v[16:19], v[240:247], v74
  v_add_f32 v24, v24, v26
  v_cvt_pk_bf16_f32 v22, v20, v24
  v_smfmac_f32_16x16x64_bf16 v[28:31], v[12:15], a[0:7], v74
  ds_write_b32 v79, v22 offset:0
  v_add_f32 v25, v25, v27
  v_cvt_pk_bf16_f32 v23, v21, v25
  v_smfmac_f32_16x16x64_bf16 v[28:31], v[8:11], a[16:23], v74
  ds_write_b32 v79, v23 offset:576
  v_cmp_u_f32 vcc, v20, v21
  v_smfmac_f32_16x16x64_bf16 v[32:35], v[16:19], v[248:255], v74
  v_smfmac_f32_16x16x64_bf16 v[32:35], v[12:15], a[8:15], v74
  v_add_f32 v28, v28, v30
  v_add_f32 v29, v29, v31
  v_smfmac_f32_16x16x64_bf16 v[32:35], v[8:11], a[24:31], v74
  s_cbranch_vccnz Cs2_rec
Cs2_recok:
  v_smfmac_f32_16x16x64_bf16 v[36:39], v[16:19], a[112:119], v74
  s_waitcnt lgkmcnt(0)
  s_barrier
  ds_read_b128 v[60:63], v77
  v_smfmac_f32_16x16x64_bf16 v[40:43], v[16:19], a[120:127], v74
  ds_read_b128 v[64:67], v77 offset:128
  v_add_f32 v32, v32, v34
  v_cvt_pk_bf16_f32 v30, v28, v32
  v_smfmac_f32_16x16x64_bf16 v[36:39], v[0:3], a[160:167], v74
  ds_write_b32 v79, v30 offset:256
  v_add_f32 v33, v33, v35
  v_cvt_pk_bf16_f32 v31, v29, v33
  v_smfmac_f32_16x16x64_bf16 v[40:43], v[0:3], a[168:175], v74
  ds_write_b32 v79, v31 offset:832
  v_xor_b32 v75, 0x8000, v75
  v_smfmac_f32_16x16x64_bf16 v[36:39], v[4:7], a[96:103], v74
  ds_read_b128 v[0:3], v76 offset:4608
  v_mov_b32 v29, 0
  v_smfmac_f32_16x16x64_bf16 v[40:43], v[4:7], a[104:111], v74
  s_waitcnt vmcnt(4) lgkmcnt(3)
  v_mov_b32 v30, 0
  v_mfma_f32_16x16x32_bf16 v[44:47], v[44:47], v[60:63], 0
  ds_read_b128 v[4:7], v76 offset:5632
  s_waitcnt lgkmcnt(2)
  v_mfma_f32_16x16x32_bf16 v[44:47], v[48:51], v[64:67], v[44:47]
  s_barrier
  v_smfmac_f32_16x16x64_bf16 v[36:39], v[8:11], a[144:151], v74
  ds_read_b128 v[20:23], v77 offset:256
  ds_read_b128 v[24:27], v77 offset:384
  v_smfmac_f32_16x16x64_bf16 v[40:43], v[8:11], a[152:159], v74
  ds_read_b128 v[8:11], v76 offset:6656
  v_add_f32_dpp v72, v46, v44 quad_perm:[2,3,0,1] row_mask:0xf bank_mask:0xf
  v_add_f32_dpp v73, v47, v45 quad_perm:[2,3,0,1] row_mask:0xf bank_mask:0xf
  v_smfmac_f32_16x16x64_bf16 v[36:39], v[12:15], a[128:135], v74
  ds_read_b128 v[44:47], v75 offset:49152
  v_exp_f32_dpp v72, v72 quad_perm:[0,1,0,1] row_mask:0xf bank_mask:0xf
  v_smfmac_f32_16x16x64_bf16 v[40:43], v[12:15], a[136:143], v74
  ds_read_b128 v[12:15], v76 offset:7680
  s_waitcnt lgkmcnt(6)
  v_exp_f32_dpp v73, v73 quad_perm:[0,1,0,1] row_mask:0xf bank_mask:0xf
  v_smfmac_f32_16x16x64_bf16 v[36:39], v[0:3], a[32:39], v74
  s_waitcnt lgkmcnt(3)
  v_cvt_pk_bf16_f32 v72, v72, v73
  v_mfma_f32_16x16x32_bf16 v[20:23], v[20:23], v[60:63], 0
  ds_write_b32 v78, v72 offset:520
  v_mfma_f32_16x16x32_bf16 v[20:23], v[24:27], v[64:67], v[20:23]
  ds_read_b128 v[48:51], v75 offset:50176
  v_smfmac_f32_16x16x64_bf16 v[40:43], v[0:3], a[40:47], v74
  ds_read_b128 v[60:63], v75 offset:51200
  v_smfmac_f32_16x16x64_bf16 v[36:39], v[4:7], a[48:55], v74
  s_waitcnt lgkmcnt(5)
  v_add_f32_dpp v24, v22, v20 quad_perm:[2,3,0,1] row_mask:0xf bank_mask:0xf
  v_add_f32_dpp v25, v23, v21 quad_perm:[2,3,0,1] row_mask:0xf bank_mask:0xf
  v_smfmac_f32_16x16x64_bf16 v[36:39], v[8:11], a[64:71], v74
  s_waitcnt lgkmcnt(2)
  s_barrier
  ds_read_b128 v[32:35], v78 offset:512
  v_smfmac_f32_16x16x64_bf16 v[36:39], v[12:15], a[80:87], v74
  ds_read_b128 v[64:67], v75 offset:52224
  v_mul_f32 v24, s69, v24
  v_smfmac_f32_16x16x64_bf16 v[40:43], v[4:7], a[56:63], v74
  v_mul_f32 v25, s69, v25
  v_smfmac_f32_16x16x64_bf16 v[40:43], v[8:11], a[72:79], v74
  v_exp_f32_dpp v24, v24 quad_perm:[0,1,0,1] row_mask:0xf bank_mask:0xf
  v_smfmac_f32_16x16x64_bf16 v[40:43], v[12:15], a[88:95], v74
  s_waitcnt vmcnt(2) lgkmcnt(1)
  v_exp_f32_dpp v25, v25 quad_perm:[0,1,0,1] row_mask:0xf bank_mask:0xf
  v_mfma_f32_16x16x32_bf16 v[8:11], v[32:35], v[68:71], 0
  v_add_f32 v36, v36, v38
  v_add_f32 v37, v37, v39
  v_mfma_f32_16x16x32_bf16 v[0:3], v[32:35], v[52:55], 0
  v_add_f32 v40, v40, v42
  v_add_f32 v41, v41, v43
  v_mfma_f32_16x16x32_bf16 v[4:7], v[32:35], v[56:59], 0
  v_cvt_pk_bf16_f32 v28, v24, v25
  v_cvt_pk_bf16_f32 v72, v36, v37
  v_cvt_pk_bf16_f32 v73, v40, v41
  v_mfma_f32_16x16x16_bf16 v[8:11], v[28:29], v[68:69], v[8:11]
  v_cvt_pk_bf16_f32 v31, v24, v25
  v_mfma_f32_16x16x16_bf16 v[0:3], v[28:29], v[72:73], v[0:3]
  ds_read_b128 v[68:71], v76 offset:13824
  v_mfma_f32_16x16x16_bf16 v[4:7], v[30:31], v[72:73], v[4:7]
  v_rcp_f32 v10, v8
  v_rcp_f32 v11, v9
  v_mul_f32 v0, v10, v0
  v_mul_f32 v1, v11, v1
  s_nop 0
  v_mul_f32 v4, v10, v4
  v_mul_f32 v5, v11, v5
  v_cvt_pk_bf16_f32 v2, v0, v4
  ds_write_b32 v79, v2 offset:8704
  v_cvt_pk_bf16_f32 v3, v1, v5
  ds_write_b32 v79, v3 offset:9280
  v_subrev_u32 v8, 813694976, v8
  v_subrev_u32 v9, 813694976, v9
  v_max_u32 v8, v8, v9
  v_cmp_le_u32 vcc, 503316480, v8
  v_mov_b64 v[16:17], 0
  v_mov_b64 v[18:19], 0
  v_mov_b64 v[20:21], 0
  v_mov_b64 v[22:23], 0
  s_cbranch_vccnz Cs2_mx
Cs2_mxok:
  s_cmp_eq_u32 s66, 63
  s_waitcnt lgkmcnt(0)
  s_barrier
  ds_read_b128 v[0:3], v78 offset:8704
  ds_read_b128 v[4:7], v78 offset:8768
  ds_read_b128 v[8:11], v78 offset:8832
  ds_read_b128 v[12:15], v78 offset:8896
  v_mov_b64 v[24:25], 0
  v_mov_b64 v[26:27], 0
  v_mov_b64 v[28:29], 0
  v_mov_b64 v[30:31], 0
  v_mov_b64 v[32:33], 0
  v_mov_b64 v[34:35], 0
  s_waitcnt lgkmcnt(3)
  v_smfmac_f32_16x16x64_bf16 v[16:19], v[0:3], a[176:183], v74
  ds_read_b128 v[52:55], v75 offset:53248
  ds_read_b128 v[56:59], v75 offset:54272
  s_waitcnt lgkmcnt(4)
  v_smfmac_f32_16x16x64_bf16 v[16:19], v[4:7], a[184:191], v74
  ds_read_b128 v[36:39], v75 offset:55296
  s_waitcnt lgkmcnt(4)
  v_smfmac_f32_16x16x64_bf16 v[16:19], v[8:11], a[192:199], v74
  ds_read_b128 v[40:43], v75 offset:56320
  s_waitcnt lgkmcnt(4)
  v_smfmac_f32_16x16x64_bf16 v[16:19], v[12:15], a[200:207], v74
  s_cbranch_scc1 Cs2_last
  v_smfmac_f32_16x16x64_bf16 v[32:35], v[0:3], v[44:51], v74
  ds_read_b128 v[44:47], v75 offset:8192
  ds_read_b128 v[48:51], v75 offset:9216
  v_smfmac_f32_16x16x64_bf16 v[32:35], v[4:7], v[60:67], v74
  ds_read_b128 v[60:63], v75 offset:10240
  s_waitcnt lgkmcnt(5)
  v_cvt_pk_bf16_f32 v16, v16, v17
  v_cvt_pk_bf16_f32 v17, v18, v19
  v_bfi_b32 v16, 1, s72, v16
  v_smfmac_f32_16x16x64_bf16 v[32:35], v[8:11], v[52:59], v74
  ds_read_b128 v[64:67], v75 offset:11264
  buffer_store_dwordx2 v[16:17], v68, s[8:11], s73 offen sc1
  s_waitcnt lgkmcnt(4)
  v_smfmac_f32_16x16x64_bf16 v[32:35], v[12:15], v[36:43], v74
  ds_read_b128 v[52:55], v75 offset:24576
  v_smfmac_f32_16x16x64_bf16 v[20:23], v[0:3], a[208:215], v74
  ds_read_b128 v[56:59], v75 offset:25600
  v_smfmac_f32_16x16x64_bf16 v[20:23], v[4:7], a[216:223], v74
  ds_read_b128 v[36:39], v75 offset:26624
  s_waitcnt lgkmcnt(5)
  v_cvt_pk_bf16_f32 v32, v32, v33
  v_cvt_pk_bf16_f32 v33, v34, v35
  v_bfi_b32 v32, 1, s72, v32
  v_smfmac_f32_16x16x64_bf16 v[20:23], v[8:11], v[44:51], v74
  ds_read_b128 v[40:43], v75 offset:27648
  buffer_store_dwordx2 v[32:33], v68, s[8:11], s77 offen sc1
  s_waitcnt lgkmcnt(4)
  v_mov_b64 v[18:19], v[72:73]
  v_smfmac_f32_16x16x64_bf16 v[20:23], v[12:15], v[60:67], v74
  ds_read_b128 v[44:47], v75 offset:40960
  v_mov_b64 v[32:33], 0
  v_smfmac_f32_16x16x64_bf16 v[24:27], v[0:3], a[224:231], v74
  ds_read_b128 v[48:51], v75 offset:41984
  v_mov_b64 v[34:35], 0
  v_smfmac_f32_16x16x64_bf16 v[24:27], v[4:7], a[232:239], v74
  ds_read_b128 v[60:63], v75 offset:43008
  s_waitcnt lgkmcnt(5)
  v_cvt_pk_bf16_f32 v20, v20, v21
  v_cvt_pk_bf16_f32 v21, v22, v23
  v_bfi_b32 v20, 1, s72, v20
  v_smfmac_f32_16x16x64_bf16 v[24:27], v[8:11], v[52:59], v74
  ds_read_b128 v[64:67], v75 offset:44032
  buffer_store_dwordx2 v[20:21], v68, s[8:11], s74 offen sc1
  s_waitcnt lgkmcnt(4)
  v_smfmac_f32_16x16x64_bf16 v[24:27], v[12:15], v[36:43], v74
  ds_read_b64 v[16:17], v77 offset:384
  v_xor_b32 v75, 0x8000, v75
  v_smfmac_f32_16x16x64_bf16 v[28:31], v[0:3], a[240:247], v74
  v_smfmac_f32_16x16x64_bf16 v[28:31], v[4:7], a[248:255], v74
  s_waitcnt lgkmcnt(3)
  v_cvt_pk_bf16_f32 v24, v24, v25
  v_cvt_pk_bf16_f32 v25, v26, v27
  v_bfi_b32 v24, 1, s72, v24
  v_smfmac_f32_16x16x64_bf16 v[28:31], v[8:11], v[44:51], v74
  buffer_store_dwordx2 v[24:25], v68, s[8:11], s75 offen sc1
  s_waitcnt lgkmcnt(1)
  v_smfmac_f32_16x16x64_bf16 v[28:31], v[12:15], v[60:67], v74
  ds_read_b128 v[0:3], v76 offset:14848
  s_nop 6
  v_cvt_pk_bf16_f32 v28, v28, v29
  v_cvt_pk_bf16_f32 v29, v30, v31
  v_bfi_b32 v28, 1, s72, v28
  buffer_store_dwordx2 v[28:29], v68, s[8:11], s76 offen sc1
  v_mov_b64 v[20:21], 0
  v_mov_b64 v[22:23], 0
  v_mov_b64 v[24:25], 0
  v_mov_b64 v[26:27], 0
  v_mov_b64 v[28:29], 0
  v_mov_b64 v[30:31], 0
  s_add_u32 s58, s58, 524288
  s_add_u32 s59, s59, 524288
  s_add_u32 s70, s70, 524288
  s_add_u32 s68, s68, 131072
  s_add_u32 s66, s66, 1
  s_xor_b32 s64, s64, 16384
  s_xor_b32 s65, s65, 16384
  s_nop 15
  s_nop 15
  s_nop 7
  buffer_load_dwordx4 v[52:55], v76, s[8:11], s60 offen offset:0 sc1
  buffer_load_dwordx4 v[56:59], v76, s[8:11], s60 offen offset:1024 sc1
  s_nop 15
  s_nop 11
  buffer_load_dwordx4 v[36:39], v76, s[8:11], s60 offen offset:0 sc1
  buffer_load_dwordx4 v[40:43], v76, s[8:11], s60 offen offset:1024 sc1
  s_waitcnt vmcnt(3) lgkmcnt(0)
  v_mfma_f32_16x16x32_bf16 v[4:7], v[0:3], v[52:55], 0
  v_bitop3_b32 v72, v52, v54, s72 bitop3:0x7e
  s_waitcnt vmcnt(2)
  v_mfma_f32_16x16x32_bf16 v[4:7], v[0:3], v[56:59], v[4:7]
  v_bitop3_b32 v73, v56, v58, s72 bitop3:0x7e
  v_bitop3_b32 v72, v72, v73, 1 bitop3:0xa8
  v_cmp_ne_u32 vcc, 0, v72
  s_cbranch_vccnz Cs2_h1r
Cs2_h1p:
  s_nop 2
  v_add_f32_dpp v4, v4, v4 row_ror:4 row_mask:0xf bank_mask:0xf
  v_add_f32_dpp v5, v5, v5 row_ror:4 row_mask:0xf bank_mask:0xf
  s_nop 0
  v_add_f32_dpp v4, v4, v4 row_ror:8 row_mask:0xf bank_mask:0xf
  v_add_f32_dpp v5, v5, v5 row_ror:8 row_mask:0xf bank_mask:0xf
  v_cvt_pk_bf16_f32 v4, v4, v5
  buffer_store_dword v4, v69, s[8:11], s62 offen sc1
Cs2_h1ok:
  s_xor_b32 s62, s62, 16384
  s_xor_b32 s72, s72, 1
Cs2_h2:
  v_lshlrev_b32 v73, 2, v76
  s_mov_b32 m0, 8704
  buffer_store_dword v71, v69, s[8:11], s62 offen sc1
  s_waitcnt vmcnt(2)
  ds_read_b128 v[60:63], v76 offset:24576
  ds_read_b128 v[64:67], v76 offset:25600
  ds_read_b128 v[44:47], v76 offset:26624
  ds_read_b128 v[48:51], v76 offset:27648
  ds_read_b128 v[36:39], v76 offset:40960
  ds_read_b128 v[40:43], v76 offset:41984
  s_branch Cs2_top
Cs2_rec:
  s_nop 7
  s_waitcnt vmcnt(0) lgkmcnt(0)
  v_max3_u32 v72, v0, v1, v2
  v_max3_u32 v72, v72, v3, v4
  v_max3_u32 v72, v72, v5, v6
  v_max3_u32 v72, v72, v7, v8
  v_max3_u32 v72, v72, v9, v10
  v_max3_u32 v72, v72, v11, v12
  v_max3_u32 v72, v72, v13, v14
  v_max3_u32 v72, v72, v15, v16
  v_max3_u32 v72, v72, v17, v18
  v_max_u32 v72, v72, v19
  v_cmp_eq_u32 vcc, -1, v72
  s_cbranch_vccz Cs2_recok
  s_barrier
Cs2_recp:
  buffer_load_dwordx4 v[60:63], v76, s[8:11], s64 offen offset:0 sc1
  buffer_load_dwordx4 v[64:67], v76, s[8:11], s64 offen offset:1024 sc1
  s_add_u32 s67, s67, 1
  s_cmp_lt_u32 s67, 131072
  s_cselect_b32 s54, -2, -1
  s_waitcnt vmcnt(1)
  v_max3_u32 v72, v60, v61, v62
  s_waitcnt vmcnt(0)
  v_max3_u32 v72, v72, v63, v64
  v_max3_u32 v72, v72, v65, v66
  v_max_u32 v72, v72, v67
  v_cmp_lt_u32 vcc, s54, v72
  s_cbranch_vccnz Cs2_recp
  ds_write_b128 v76, v[60:63] offset:8704
  ds_write_b128 v76, v[64:67] offset:9728
  v_mov_b64 v[20:21], 0
  v_mov_b64 v[22:23], 0
  v_mov_b64 v[24:25], 0
  v_mov_b64 v[26:27], 0
  v_mov_b64 v[28:29], 0
  v_mov_b64 v[30:31], 0
  v_mov_b64 v[32:33], 0
  v_mov_b64 v[34:35], 0
  s_waitcnt lgkmcnt(0)
  s_barrier
  ds_read_b128 v[0:3], v76 offset:4608
  ds_read_b128 v[60:63], v76 offset:24576
  ds_read_b128 v[64:67], v76 offset:25600
  s_waitcnt lgkmcnt(0)
  v_smfmac_f32_16x16x64_bf16 v[20:23], v[0:3], v[60:67], v74
  ds_read_b128 v[60:63], v76 offset:26624
  ds_read_b128 v[64:67], v76 offset:27648
  s_waitcnt lgkmcnt(0)
  v_smfmac_f32_16x16x64_bf16 v[24:27], v[0:3], v[60:67], v74
  ds_read_b128 v[60:63], v76 offset:40960
  ds_read_b128 v[64:67], v76 offset:41984
  s_waitcnt lgkmcnt(0)
  v_smfmac_f32_16x16x64_bf16 v[28:31], v[0:3], v[60:67], v74
  ds_read_b128 v[60:63], v76 offset:43008
  ds_read_b128 v[64:67], v76 offset:44032
  s_waitcnt lgkmcnt(0)
  v_smfmac_f32_16x16x64_bf16 v[32:35], v[0:3], v[60:67], v74
  ds_read_b128 v[4:7], v76 offset:5632
  s_waitcnt lgkmcnt(0)
  v_smfmac_f32_16x16x64_bf16 v[20:23], v[4:7], v[80:87], v74
  v_smfmac_f32_16x16x64_bf16 v[24:27], v[4:7], v[88:95], v74
  v_smfmac_f32_16x16x64_bf16 v[28:31], v[4:7], v[208:215], v74
  v_smfmac_f32_16x16x64_bf16 v[32:35], v[4:7], v[216:223], v74
  ds_read_b128 v[8:11], v76 offset:6656
  s_waitcnt lgkmcnt(0)
  v_smfmac_f32_16x16x64_bf16 v[20:23], v[8:11], v[96:103], v74
  v_smfmac_f32_16x16x64_bf16 v[24:27], v[8:11], v[104:111], v74
  ds_read_b128 v[60:63], v76 offset:57344
  ds_read_b128 v[64:67], v76 offset:58368
  s_waitcnt lgkmcnt(0)
  v_smfmac_f32_16x16x64_bf16 v[28:31], v[8:11], v[60:67], v74
  ds_read_b128 v[60:63], v76 offset:59392
  ds_read_b128 v[64:67], v76 offset:60416
  s_waitcnt lgkmcnt(0)
  v_smfmac_f32_16x16x64_bf16 v[32:35], v[8:11], v[60:67], v74
  ds_read_b128 v[12:15], v76 offset:7680
  s_waitcnt lgkmcnt(0)
  v_smfmac_f32_16x16x64_bf16 v[20:23], v[12:15], v[112:119], v74
  v_smfmac_f32_16x16x64_bf16 v[24:27], v[12:15], v[120:127], v74
  v_smfmac_f32_16x16x64_bf16 v[28:31], v[12:15], v[224:231], v74
  v_smfmac_f32_16x16x64_bf16 v[32:35], v[12:15], v[232:239], v74
  ds_read_b128 v[4:7], v76 offset:8704
  s_waitcnt lgkmcnt(0)
  v_smfmac_f32_16x16x64_bf16 v[20:23], v[4:7], v[128:135], v74
  v_smfmac_f32_16x16x64_bf16 v[24:27], v[4:7], v[136:143], v74
  ds_read_b128 v[60:63], v75 offset:24576
  ds_read_b128 v[64:67], v75 offset:25600
  s_waitcnt lgkmcnt(0)
  v_smfmac_f32_16x16x64_bf16 v[28:31], v[4:7], v[60:67], v74
  ds_read_b128 v[60:63], v75 offset:26624
  ds_read_b128 v[64:67], v75 offset:27648
  s_waitcnt lgkmcnt(0)
  v_smfmac_f32_16x16x64_bf16 v[32:35], v[4:7], v[60:67], v74
  ds_read_b128 v[16:19], v76 offset:9728
  s_waitcnt lgkmcnt(0)
  v_smfmac_f32_16x16x64_bf16 v[20:23], v[16:19], v[144:151], v74
  v_smfmac_f32_16x16x64_bf16 v[24:27], v[16:19], v[152:159], v74
  v_smfmac_f32_16x16x64_bf16 v[28:31], v[16:19], v[240:247], v74
  v_smfmac_f32_16x16x64_bf16 v[32:35], v[16:19], v[248:255], v74
  ds_read_b128 v[12:15], v76 offset:10752
  s_waitcnt lgkmcnt(0)
  v_smfmac_f32_16x16x64_bf16 v[20:23], v[12:15], v[160:167], v74
  v_smfmac_f32_16x16x64_bf16 v[24:27], v[12:15], v[168:175], v74
  v_smfmac_f32_16x16x64_bf16 v[28:31], v[12:15], a[0:7], v74
  v_smfmac_f32_16x16x64_bf16 v[32:35], v[12:15], a[8:15], v74
  ds_read_b128 v[8:11], v76 offset:11776
  s_waitcnt lgkmcnt(0)
  v_smfmac_f32_16x16x64_bf16 v[20:23], v[8:11], v[176:183], v74
  v_smfmac_f32_16x16x64_bf16 v[24:27], v[8:11], v[184:191], v74
  v_smfmac_f32_16x16x64_bf16 v[28:31], v[8:11], a[16:23], v74
  v_smfmac_f32_16x16x64_bf16 v[32:35], v[8:11], a[24:31], v74
  ds_read_b128 v[0:3], v76 offset:12800
  s_waitcnt lgkmcnt(0)
  v_smfmac_f32_16x16x64_bf16 v[20:23], v[0:3], v[192:199], v74
  v_smfmac_f32_16x16x64_bf16 v[24:27], v[0:3], v[200:207], v74
  ds_read_b128 v[60:63], v75 offset:8192
  ds_read_b128 v[64:67], v75 offset:9216
  s_waitcnt lgkmcnt(0)
  v_smfmac_f32_16x16x64_bf16 v[28:31], v[0:3], v[60:67], v74
  ds_read_b128 v[60:63], v75 offset:10240
  ds_read_b128 v[64:67], v75 offset:11264
  s_waitcnt lgkmcnt(0)
  v_smfmac_f32_16x16x64_bf16 v[32:35], v[0:3], v[60:67], v74
  v_add_f32 v20, v20, v22
  v_add_f32 v21, v21, v23
  v_add_f32 v24, v24, v26
  v_cvt_pk_bf16_f32 v22, v20, v24
  ds_write_b32 v79, v22 offset:0
  v_add_f32 v25, v25, v27
  v_cvt_pk_bf16_f32 v23, v21, v25
  ds_write_b32 v79, v23 offset:576
  v_add_f32 v28, v28, v30
  v_add_f32 v29, v29, v31
  s_waitcnt lgkmcnt(0)
  s_nop 1
  s_branch Cs2_recok
Cs2_mx:
  s_waitcnt lgkmcnt(0)
  s_barrier
  buffer_load_dwordx4 v[0:3], v76, s[8:11], s58 offen offset:0 sc1
  ds_read_b128 v[20:23], v77 offset:0
  ds_read_b128 v[28:31], v77 offset:256
  buffer_load_dwordx4 v[4:7], v76, s[8:11], s58 offen offset:1024 sc1
  ds_read_b128 v[24:27], v77 offset:128
  ds_read_b128 v[32:35], v77 offset:384
  s_waitcnt vmcnt(1) lgkmcnt(3)
  v_mfma_f32_16x16x32_bf16 v[8:11], v[0:3], v[20:23], 0
  s_waitcnt vmcnt(0) lgkmcnt(1)
  v_mfma_f32_16x16x32_bf16 v[8:11], v[4:7], v[24:27], v[8:11]
  v_mfma_f32_16x16x32_bf16 v[12:15], v[28:31], v[20:23], 0
  s_waitcnt lgkmcnt(0)
  v_mfma_f32_16x16x32_bf16 v[12:15], v[32:35], v[24:27], v[12:15]
  v_add_f32_dpp v8, v10, v8 quad_perm:[2,3,0,1] row_mask:0xf bank_mask:0xf
  v_add_f32_dpp v9, v11, v9 quad_perm:[2,3,0,1] row_mask:0xf bank_mask:0xf
  s_nop 0
  v_mov_b32_dpp v8, v8 quad_perm:[0,1,0,1] row_mask:0xf bank_mask:0xf
  v_mov_b32_dpp v9, v9 quad_perm:[0,1,0,1] row_mask:0xf bank_mask:0xf
  s_nop 1
  v_add_f32_dpp v12, v14, v12 quad_perm:[2,3,0,1] row_mask:0xf bank_mask:0xf
  v_add_f32_dpp v13, v15, v13 quad_perm:[2,3,0,1] row_mask:0xf bank_mask:0xf
  s_nop 0
  v_mov_b32_dpp v12, v12 quad_perm:[0,1,0,1] row_mask:0xf bank_mask:0xf
  v_mov_b32_dpp v13, v13 quad_perm:[0,1,0,1] row_mask:0xf bank_mask:0xf
  v_mul_f32 v12, s69, v12
  ds_write_b32 v78, v8 offset:8712
  v_mul_f32 v13, s69, v13
  ds_write_b32 v78, v9 offset:8776
  s_waitcnt lgkmcnt(0)
  s_barrier
  ds_read_b128 v[36:39], v78 offset:8704
  ds_read_b128 v[40:43], v78 offset:8768
  s_waitcnt lgkmcnt(0)
  s_barrier
  v_max_f32 v16, v36, v37
  v_max3_f32 v16, v16, v38, v39
  v_max3_f32 v16, v16, v40, v41
  v_max3_f32 v16, v16, v42, v43
  v_max3_f32 v16, v16, v12, v13
  v_mov_b32 v17, v16
  s_nop 1
  v_permlane16_swap_b32 v16, v17
  v_max_f32 v16, v16, v17
  v_mov_b32 v17, v16
  s_nop 1
  v_permlane32_swap_b32 v16, v17
  v_max_f32 v16, v16, v17
  v_sub_f32 v36, v36, v16
  v_sub_f32 v37, v37, v16
  v_sub_f32 v38, v38, v16
  v_sub_f32 v39, v39, v16
  v_sub_f32 v40, v40, v16
  v_sub_f32 v41, v41, v16
  v_sub_f32 v42, v42, v16
  v_sub_f32 v43, v43, v16
  v_sub_f32 v12, v12, v16
  v_sub_f32 v13, v13, v16
  v_exp_f32 v36, v36
  v_exp_f32 v37, v37
  v_exp_f32 v38, v38
  v_exp_f32 v39, v39
  v_exp_f32 v40, v40
  v_exp_f32 v41, v41
  v_exp_f32 v42, v42
  v_exp_f32 v43, v43
  v_exp_f32 v12, v12
  v_exp_f32 v13, v13
  v_cvt_pk_bf16_f32 v32, v36, v40
  v_cvt_pk_bf16_f32 v33, v37, v41
  v_cvt_pk_bf16_f32 v34, v38, v42
  v_cvt_pk_bf16_f32 v35, v39, v43
  v_cvt_pk_bf16_f32 v28, v12, v13
  v_cvt_pk_bf16_f32 v31, v12, v13
  v_mov_b32 v29, 0
  v_mov_b32 v30, 0
  v_mov_b32 v68, 0x3f803f80
  v_mov_b32 v69, 0x3f803f80
  v_mov_b32 v70, 0x3f803f80
  v_mov_b32 v71, 0x3f803f80
  s_nop 1
  v_mfma_f32_16x16x32_bf16 v[8:11], v[32:35], v[68:71], 0
  v_mfma_f32_16x16x32_bf16 v[0:3], v[32:35], v[52:55], 0
  v_mfma_f32_16x16x32_bf16 v[4:7], v[32:35], v[56:59], 0
  v_mfma_f32_16x16x16_bf16 v[8:11], v[28:29], v[68:69], v[8:11]
  v_mfma_f32_16x16x16_bf16 v[0:3], v[28:29], v[72:73], v[0:3]
  v_mfma_f32_16x16x16_bf16 v[4:7], v[30:31], v[72:73], v[4:7]
  ds_read_b128 v[68:71], v76 offset:13824
  v_rcp_f32 v10, v8
  v_rcp_f32 v11, v9
  v_mul_f32 v0, v10, v0
  v_mul_f32 v1, v11, v1
  s_nop 0
  v_mul_f32 v4, v10, v4
  v_mul_f32 v5, v11, v5
  v_cvt_pk_bf16_f32 v2, v0, v4
  ds_write_b32 v79, v2 offset:8704
  v_cvt_pk_bf16_f32 v3, v1, v5
  ds_write_b32 v79, v3 offset:9280
  v_mov_b64 v[16:17], 0
  v_mov_b64 v[18:19], 0
  v_mov_b64 v[20:21], 0
  v_mov_b64 v[22:23], 0
  s_branch Cs2_mxok
Cs2_h1r:
  s_mov_b64 exec, vcc
  buffer_load_dwordx4 v[52:55], v76, s[8:11], s60 offen offset:0 sc1
  buffer_load_dwordx4 v[56:59], v76, s[8:11], s60 offen offset:1024 sc1
  s_mov_b64 exec, -1
  s_add_u32 s67, s67, 1
  s_waitcnt vmcnt(3)
  v_mfma_f32_16x16x32_bf16 v[4:7], v[0:3], v[36:39], 0
  v_bitop3_b32 v72, v36, v38, s72 bitop3:0x7e
  s_waitcnt vmcnt(2)
  v_mfma_f32_16x16x32_bf16 v[4:7], v[0:3], v[40:43], v[4:7]
  v_bitop3_b32 v73, v40, v42, s72 bitop3:0x7e
  v_bitop3_b32 v72, v72, v73, 1 bitop3:0xa8
  v_cmp_ne_u32 vcc, 0, v72
  s_cbranch_vccz Cs2_h1p
  s_mov_b64 exec, vcc
  buffer_load_dwordx4 v[36:39], v76, s[8:11], s60 offen offset:0 sc1
  buffer_load_dwordx4 v[40:43], v76, s[8:11], s60 offen offset:1024 sc1
  s_mov_b64 exec, -1
  s_add_u32 s67, s67, 1
  s_waitcnt vmcnt(3)
  v_mfma_f32_16x16x32_bf16 v[4:7], v[0:3], v[52:55], 0
  v_bitop3_b32 v72, v52, v54, s72 bitop3:0x7e
  s_waitcnt vmcnt(2)
  v_mfma_f32_16x16x32_bf16 v[4:7], v[0:3], v[56:59], v[4:7]
  v_bitop3_b32 v73, v56, v58, s72 bitop3:0x7e
  v_bitop3_b32 v72, v72, v73, 1 bitop3:0xa8
  v_cmp_ne_u32 vcc, 0, v72
  s_cbranch_vccz Cs2_h1p
  s_cmp_lt_u32 s67, 131072
  s_cbranch_scc1 Cs2_h1r
  s_branch Cs2_h1p
Cs2_last:
  s_nop 7
  s_waitcnt vmcnt(0) lgkmcnt(0)
  ds_read_b64 v[16:17], v77 offset:384
  v_mov_b64 v[18:19], v[72:73]
  s_add_u32 s68, s68, 131072
  s_waitcnt lgkmcnt(0)
  buffer_store_dwordx4 v[16:19], v76, s[8:11], s68 offen sc1
  s_waitcnt vmcnt(0)
  s_barrier
  s_branch L_cexit
L_w7:
  v_mov_b64 v[20:21], 0
  v_mov_b64 v[22:23], 0
  v_mov_b64 v[24:25], 0
  v_mov_b64 v[26:27], 0
  v_mov_b64 v[28:29], 0
  v_mov_b64 v[30:31], 0
  v_mov_b64 v[32:33], 0
  v_mov_b64 v[34:35], 0
  s_mov_b32 m0, 15872
  s_branch Cs3_h2
.p2align 6
Cs3_top:
  s_waitcnt lgkmcnt(0)
  s_barrier
  ds_read_b128 v[0:3], v76 offset:4608
  ds_read_b128 v[4:7], v76 offset:5632
  buffer_load_dwordx4 v76, s[8:11], s64 offen offset:0 sc1 lds
  buffer_load_dwordx4 v76, s[8:11], s64 offen offset:1024 sc1 lds
  s_waitcnt lgkmcnt(1)
  v_smfmac_f32_16x16x64_bf16 v[20:23], v[0:3], v[60:67], v74
  ds_read_b128 v[60:63], v76 offset:47104
  v_smfmac_f32_16x16x64_bf16 v[24:27], v[0:3], v[44:51], v74
  s_mov_b32 m0, 15872
  ds_read_b128 v[64:67], v76 offset:48128
  s_waitcnt lgkmcnt(2)
  v_smfmac_f32_16x16x64_bf16 v[20:23], v[4:7], v[80:87], v74
  buffer_load_dwordx4 v[44:47], v76, s[8:11], s58 offen offset:0 sc1
  ds_read_b128 v[8:11], v76 offset:6656
  v_smfmac_f32_16x16x64_bf16 v[28:31], v[0:3], v[36:43], v74
  ds_read_b128 v[36:39], v76 offset:61440
  v_smfmac_f32_16x16x64_bf16 v[24:27], v[4:7], v[88:95], v74
  buffer_load_dwordx4 v[48:51], v76, s[8:11], s58 offen offset:1024 sc1
  ds_read_b128 v[40:43], v76 offset:62464
  v_smfmac_f32_16x16x64_bf16 v[28:31], v[4:7], v[208:215], v74
  ds_read_b128 v[12:15], v76 offset:7680
  v_smfmac_f32_16x16x64_bf16 v[32:35], v[4:7], v[216:223], v74
  buffer_load_dwordx4 v[52:55], v76, s[8:11], s59 offen offset:0 sc1
  s_waitcnt lgkmcnt(4)
  v_smfmac_f32_16x16x64_bf16 v[32:35], v[0:3], v[60:67], v74
  ds_read_b128 v[60:63], v76 offset:63488
  s_waitcnt lgkmcnt(4)
  v_smfmac_f32_16x16x64_bf16 v[20:23], v[8:11], v[96:103], v74
  buffer_load_dwordx4 v[56:59], v76, s[8:11], s59 offen offset:1024 sc1
  ds_read_b128 v[64:67], v76 offset:64512
  v_smfmac_f32_16x16x64_bf16 v[24:27], v[8:11], v[104:111], v74
  ds_read_b128 v[0:3], v76 offset:12800
  s_waitcnt lgkmcnt(4)
  v_smfmac_f32_16x16x64_bf16 v[28:31], v[8:11], v[36:43], v74
  ds_read_b128 v[36:39], v75 offset:12288
  s_waitcnt lgkmcnt(4)
  v_smfmac_f32_16x16x64_bf16 v[20:23], v[12:15], v[112:119], v74
  ds_read_b128 v[40:43], v75 offset:13312
  v_smfmac_f32_16x16x64_bf16 v[24:27], v[12:15], v[120:127], v74
  buffer_load_dword v73, s[8:11], s70 offen lds
  s_waitcnt lgkmcnt(3)
  v_smfmac_f32_16x16x64_bf16 v[32:35], v[8:11], v[60:67], v74
  ds_read_b128 v[60:63], v75 offset:14336
  v_smfmac_f32_16x16x64_bf16 v[28:31], v[12:15], v[224:231], v74
  s_waitcnt vmcnt(5)
  ds_read_b128 v[64:67], v75 offset:15360
  v_smfmac_f32_16x16x64_bf16 v[32:35], v[12:15], v[232:239], v74
  buffer_store_dwordx4 v[16:19], v76, s[8:11], s68 offen sc1
  s_barrier
  s_waitcnt lgkmcnt(4)
  v_smfmac_f32_16x16x64_bf16 v[20:23], v[0:3], v[192:199], v74
  ds_read_b128 v[4:7], v76 offset:8704
  s_waitcnt lgkmcnt(3)
  v_smfmac_f32_16x16x64_bf16 v[28:31], v[0:3], v[36:43], v74
  ds_read_b128 v[16:19], v76 offset:9728
  v_smfmac_f32_16x16x64_bf16 v[24:27], v[0:3], v[200:207], v74
  ds_read_b128 v[36:39], v75 offset:28672
  s_waitcnt lgkmcnt(3)
  v_mov_b32 v68, 0x3f803f80
  v_smfmac_f32_16x16x64_bf16 v[32:35], v[0:3], v[60:67], v74
  ds_read_b128 v[40:43], v75 offset:29696
  s_waitcnt lgkmcnt(3)
  v_smfmac_f32_16x16x64_bf16 v[20:23], v[4:7], v[128:135], v74
  ds_read_b128 v[12:15], v76 offset:10752
  v_mov_b32 v69, 0x3f803f80
  v_smfmac_f32_16x16x64_bf16 v[24:27], v[4:7], v[136:143], v74
  ds_read_b128 v[8:11], v76 offset:11776
  s_waitcnt lgkmcnt(4)
  v_smfmac_f32_16x16x64_bf16 v[20:23], v[16:19], v[144:151], v74
  ds_read_b128 v[60:63], v75 offset:30720
  v_mov_b64 v[70:71], v[68:69]
  v_smfmac_f32_16x16x64_bf16 v[24:27], v[16:19], v[152:159], v74
  ds_read_b128 v[64:67], v75 offset:31744
  s_waitcnt lgkmcnt(4)
  v_smfmac_f32_16x16x64_bf16 v[28:31], v[4:7], v[36:43], v74
  s_waitcnt lgkmcnt(3)
  v_mov_b64 v[36:37], 0
  v_smfmac_f32_16x16x64_bf16 v[20:23], v[12:15], v[160:167], v74
  s_waitcnt lgkmcnt(2)
  v_mov_b64 v[38:39], 0
  v_smfmac_f32_16x16x64_bf16 v[20:23], v[8:11], v[176:183], v74
  v_mov_b64 v[40:41], 0
  v_smfmac_f32_16x16x64_bf16 v[24:27], v[12:15], v[168:175], v74
  v_mov_b64 v[42:43], 0
  v_smfmac_f32_16x16x64_bf16 v[24:27], v[8:11], v[184:191], v74
  s_waitcnt lgkmcnt(0)
  v_add_f32 v20, v20, v22
  v_smfmac_f32_16x16x64_bf16 v[32:35], v[4:7], v[60:67], v74
  v_add_f32 v21, v21, v23
  v_smfmac_f32_16x16x64_bf16 v[28:31], v[16:19], v[240:247], v74
  v_add_f32 v24, v24, v26
  v_cvt_pk_bf16_f32 v22, v20, v24
  v_smfmac_f32_16x16x64_bf16 v[28:31], v[12:15], a[0:7], v74
  ds_write_b32 v79, v22 offset:0
  v_add_f32 v25, v25, v27
  v_cvt_pk_bf16_f32 v23, v21, v25
  v_smfmac_f32_16x16x64_bf16 v[28:31], v[8:11], a[16:23], v74
  ds_write_b32 v79, v23 offset:576
  v_cmp_u_f32 vcc, v20, v21
  v_smfmac_f32_16x16x64_bf16 v[32:35], v[16:19], v[248:255], v74
  v_smfmac_f32_16x16x64_bf16 v[32:35], v[12:15], a[8:15], v74
  v_add_f32 v28, v28, v30
  v_add_f32 v29, v29, v31
  v_smfmac_f32_16x16x64_bf16 v[32:35], v[8:11], a[24:31], v74
  s_cbranch_vccnz Cs3_rec
Cs3_recok:
  v_smfmac_f32_16x16x64_bf16 v[36:39], v[16:19], a[112:119], v74
  s_waitcnt lgkmcnt(0)
  s_barrier
  ds_read_b128 v[60:63], v77
  v_smfmac_f32_16x16x64_bf16 v[40:43], v[16:19], a[120:127], v74
  ds_read_b128 v[64:67], v77 offset:128
  v_add_f32 v32, v32, v34
  v_cvt_pk_bf16_f32 v30, v28, v32
  v_smfmac_f32_16x16x64_bf16 v[36:39], v[0:3], a[160:167], v74
  ds_write_b32 v79, v30 offset:256
  v_add_f32 v33, v33, v35
  v_cvt_pk_bf16_f32 v31, v29, v33
  v_smfmac_f32_16x16x64_bf16 v[40:43], v[0:3], a[168:175], v74
  ds_write_b32 v79, v31 offset:832
  v_xor_b32 v75, 0x8000, v75
  v_smfmac_f32_16x16x64_bf16 v[36:39], v[4:7], a[96:103], v74
  ds_read_b128 v[0:3], v76 offset:4608
  v_mov_b32 v29, 0
  v_smfmac_f32_16x16x64_bf16 v[40:43], v[4:7], a[104:111], v74
  s_waitcnt vmcnt(4) lgkmcnt(3)
  v_mov_b32 v30, 0
  v_mfma_f32_16x16x32_bf16 v[44:47], v[44:47], v[60:63], 0
  ds_read_b128 v[4:7], v76 offset:5632
  s_waitcnt lgkmcnt(2)
  v_mfma_f32_16x16x32_bf16 v[44:47], v[48:51], v[64:67], v[44:47]
  s_barrier
  v_smfmac_f32_16x16x64_bf16 v[36:39], v[8:11], a[144:151], v74
  ds_read_b128 v[20:23], v77 offset:256
  ds_read_b128 v[24:27], v77 offset:384
  v_smfmac_f32_16x16x64_bf16 v[40:43], v[8:11], a[152:159], v74
  ds_read_b128 v[8:11], v76 offset:6656
  v_add_f32_dpp v72, v46, v44 quad_perm:[2,3,0,1] row_mask:0xf bank_mask:0xf
  v_add_f32_dpp v73, v47, v45 quad_perm:[2,3,0,1] row_mask:0xf bank_mask:0xf
  v_smfmac_f32_16x16x64_bf16 v[36:39], v[12:15], a[128:135], v74
  ds_read_b128 v[44:47], v75 offset:57344
  v_exp_f32_dpp v72, v72 quad_perm:[0,1,0,1] row_mask:0xf bank_mask:0xf
  v_smfmac_f32_16x16x64_bf16 v[40:43], v[12:15], a[136:143], v74
  ds_read_b128 v[12:15], v76 offset:7680
  s_waitcnt lgkmcnt(6)
  v_exp_f32_dpp v73, v73 quad_perm:[0,1,0,1] row_mask:0xf bank_mask:0xf
  v_smfmac_f32_16x16x64_bf16 v[36:39], v[0:3], a[32:39], v74
  s_waitcnt lgkmcnt(3)
  v_cvt_pk_bf16_f32 v72, v72, v73
  v_mfma_f32_16x16x32_bf16 v[20:23], v[20:23], v[60:63], 0
  ds_write_b32 v78, v72 offset:524
  v_mfma_f32_16x16x32_bf16 v[20:23], v[24:27], v[64:67], v[20:23]
  ds_read_b128 v[48:51], v75 offset:58368
  v_smfmac_f32_16x16x64_bf16 v[40:43], v[0:3], a[40:47], v74
  ds_read_b128 v[60:63], v75 offset:59392
  v_smfmac_f32_16x16x64_bf16 v[36:39], v[4:7], a[48:55], v74
  s_waitcnt lgkmcnt(5)
  v_add_f32_dpp v24, v22, v20 quad_perm:[2,3,0,1] row_mask:0xf bank_mask:0xf
  v_add_f32_dpp v25, v23, v21 quad_perm:[2,3,0,1] row_mask:0xf bank_mask:0xf
  v_smfmac_f32_16x16x64_bf16 v[36:39], v[8:11], a[64:71], v74
  s_waitcnt lgkmcnt(2)
  s_barrier
  ds_read_b128 v[32:35], v78 offset:512
  v_smfmac_f32_16x16x64_bf16 v[36:39], v[12:15], a[80:87], v74
  ds_read_b128 v[64:67], v75 offset:60416
  v_mul_f32 v24, s69, v24
  v_smfmac_f32_16x16x64_bf16 v[40:43], v[4:7], a[56:63], v74
  v_mul_f32 v25, s69, v25
  v_smfmac_f32_16x16x64_bf16 v[40:43], v[8:11], a[72:79], v74
  v_exp_f32_dpp v24, v24 quad_perm:[0,1,0,1] row_mask:0xf bank_mask:0xf
  v_smfmac_f32_16x16x64_bf16 v[40:43], v[12:15], a[88:95], v74
  s_waitcnt vmcnt(2) lgkmcnt(1)
  v_exp_f32_dpp v25, v25 quad_perm:[0,1,0,1] row_mask:0xf bank_mask:0xf
  v_mfma_f32_16x16x32_bf16 v[8:11], v[32:35], v[68:71], 0
  v_add_f32 v36, v36, v38
  v_add_f32 v37, v37, v39
  v_mfma_f32_16x16x32_bf16 v[0:3], v[32:35], v[52:55], 0
  v_add_f32 v40, v40, v42
  v_add_f32 v41, v41, v43
  v_mfma_f32_16x16x32_bf16 v[4:7], v[32:35], v[56:59], 0
  v_cvt_pk_bf16_f32 v28, v24, v25
  v_cvt_pk_bf16_f32 v72, v36, v37
  v_cvt_pk_bf16_f32 v73, v40, v41
  v_mfma_f32_16x16x16_bf16 v[8:11], v[28:29], v[68:69], v[8:11]
  v_cvt_pk_bf16_f32 v31, v24, v25
  v_mfma_f32_16x16x16_bf16 v[0:3], v[28:29], v[72:73], v[0:3]
  ds_read_b128 v[68:71], v76 offset:13824
  v_mfma_f32_16x16x16_bf16 v[4:7], v[30:31], v[72:73], v[4:7]
  v_rcp_f32 v10, v8
  v_rcp_f32 v11, v9
  v_mul_f32 v0, v10, v0
  v_mul_f32 v1, v11, v1
  s_nop 0
  v_mul_f32 v4, v10, v4
  v_mul_f32 v5, v11, v5
  v_cvt_pk_bf16_f32 v2, v0, v4
  ds_write_b32 v79, v2 offset:8704
  v_cvt_pk_bf16_f32 v3, v1, v5
  ds_write_b32 v79, v3 offset:9280
  v_subrev_u32 v8, 813694976, v8
  v_subrev_u32 v9, 813694976, v9
  v_max_u32 v8, v8, v9
  v_cmp_le_u32 vcc, 503316480, v8
  v_mov_b64 v[16:17], 0
  v_mov_b64 v[18:19], 0
  v_mov_b64 v[20:21], 0
  v_mov_b64 v[22:23], 0
  s_cbranch_vccnz Cs3_mx
Cs3_mxok:
  s_cmp_eq_u32 s66, 63
  s_waitcnt lgkmcnt(0)
  s_barrier
  ds_read_b128 v[0:3], v78 offset:8704
  ds_read_b128 v[4:7], v78 offset:8768
  ds_read_b128 v[8:11], v78 offset:8832
  ds_read_b128 v[12:15], v78 offset:8896
  v_mov_b64 v[24:25], 0
  v_mov_b64 v[26:27], 0
  v_mov_b64 v[28:29], 0
  v_mov_b64 v[30:31], 0
  v_mov_b64 v[32:33], 0
  v_mov_b64 v[34:35], 0
  s_waitcnt lgkmcnt(3)
  v_smfmac_f32_16x16x64_bf16 v[16:19], v[0:3], a[176:183], v74
  ds_read_b128 v[52:55], v75 offset:61440
  ds_read_b128 v[56:59], v75 offset:62464
  s_waitcnt lgkmcnt(4)
  v_smfmac_f32_16x16x64_bf16 v[16:19], v[4:7], a[184:191], v74
  ds_read_b128 v[36:39], v75 offset:63488
  s_waitcnt lgkmcnt(4)
  v_smfmac_f32_16x16x64_bf16 v[16:19], v[8:11], a[192:199], v74
  ds_read_b128 v[40:43], v75 offset:64512
  s_waitcnt lgkmcnt(4)
  v_smfmac_f32_16x16x64_bf16 v[16:19], v[12:15], a[200:207], v74
  s_cbranch_scc1 Cs3_last
  v_smfmac_f32_16x16x64_bf16 v[32:35], v[0:3], v[44:51], v74
  ds_read_b128 v[44:47], v75 offset:12288
  ds_read_b128 v[48:51], v75 offset:13312
  v_smfmac_f32_16x16x64_bf16 v[32:35], v[4:7], v[60:67], v74
  ds_read_b128 v[60:63], v75 offset:14336
  s_waitcnt lgkmcnt(5)
  v_cvt_pk_bf16_f32 v16, v16, v17
  v_cvt_pk_bf16_f32 v17, v18, v19
  v_bfi_b32 v16, 1, s72, v16
  v_smfmac_f32_16x16x64_bf16 v[32:35], v[8:11], v[52:59], v74
  ds_read_b128 v[64:67], v75 offset:15360
  buffer_store_dwordx2 v[16:17], v68, s[8:11], s73 offen sc1
  s_waitcnt lgkmcnt(4)
  v_smfmac_f32_16x16x64_bf16 v[32:35], v[12:15], v[36:43], v74
  ds_read_b128 v[52:55], v75 offset:28672
  v_smfmac_f32_16x16x64_bf16 v[20:23], v[0:3], a[208:215], v74
  ds_read_b128 v[56:59], v75 offset:29696
  v_smfmac_f32_16x16x64_bf16 v[20:23], v[4:7], a[216:223], v74
  ds_read_b128 v[36:39], v75 offset:30720
  s_waitcnt lgkmcnt(5)
  v_cvt_pk_bf16_f32 v32, v32, v33
  v_cvt_pk_bf16_f32 v33, v34, v35
  v_bfi_b32 v32, 1, s72, v32
  v_smfmac_f32_16x16x64_bf16 v[20:23], v[8:11], v[44:51], v74
  ds_read_b128 v[40:43], v75 offset:31744
  buffer_store_dwordx2 v[32:33], v68, s[8:11], s77 offen sc1
  s_waitcnt lgkmcnt(4)
  v_mov_b64 v[18:19], v[72:73]
  v_smfmac_f32_16x16x64_bf16 v[20:23], v[12:15], v[60:67], v74
  ds_read_b128 v[44:47], v75 offset:45056
  v_mov_b64 v[32:33], 0
  v_smfmac_f32_16x16x64_bf16 v[24:27], v[0:3], a[224:231], v74
  ds_read_b128 v[48:51], v75 offset:46080
  v_mov_b64 v[34:35], 0
  v_smfmac_f32_16x16x64_bf16 v[24:27], v[4:7], a[232:239], v74
  ds_read_b128 v[60:63], v75 offset:47104
  s_waitcnt lgkmcnt(5)
  v_cvt_pk_bf16_f32 v20, v20, v21
  v_cvt_pk_bf16_f32 v21, v22, v23
  v_bfi_b32 v20, 1, s72, v20
  v_smfmac_f32_16x16x64_bf16 v[24:27], v[8:11], v[52:59], v74
  ds_read_b128 v[64:67], v75 offset:48128
  buffer_store_dwordx2 v[20:21], v68, s[8:11], s74 offen sc1
  s_waitcnt lgkmcnt(4)
  v_smfmac_f32_16x16x64_bf16 v[24:27], v[12:15], v[36:43], v74
  ds_read_b64 v[16:17], v77 offset:392
  v_xor_b32 v75, 0x8000, v75
  v_smfmac_f32_16x16x64_bf16 v[28:31], v[0:3], a[240:247], v74
  v_smfmac_f32_16x16x64_bf16 v[28:31], v[4:7], a[248:255], v74
  s_waitcnt lgkmcnt(3)
  v_cvt_pk_bf16_f32 v24, v24, v25
  v_cvt_pk_bf16_f32 v25, v26, v27
  v_bfi_b32 v24, 1, s72, v24
  v_smfmac_f32_16x16x64_bf16 v[28:31], v[8:11], v[44:51], v74
  buffer_store_dwordx2 v[24:25], v68, s[8:11], s75 offen sc1
  s_waitcnt lgkmcnt(1)
  v_smfmac_f32_16x16x64_bf16 v[28:31], v[12:15], v[60:67], v74
  ds_read_b128 v[0:3], v76 offset:14848
  s_nop 6
  v_cvt_pk_bf16_f32 v28, v28, v29
  v_cvt_pk_bf16_f32 v29, v30, v31
  v_bfi_b32 v28, 1, s72, v28
  buffer_store_dwordx2 v[28:29], v68, s[8:11], s76 offen sc1
  v_mov_b64 v[20:21], 0
  v_mov_b64 v[22:23], 0
  v_mov_b64 v[24:25], 0
  v_mov_b64 v[26:27], 0
  v_mov_b64 v[28:29], 0
  v_mov_b64 v[30:31], 0
  s_add_u32 s58, s58, 524288
  s_add_u32 s59, s59, 524288
  s_add_u32 s70, s70, 524288
  s_add_u32 s68, s68, 131072
  s_add_u32 s66, s66, 1
  s_xor_b32 s64, s64, 16384
  s_xor_b32 s65, s65, 16384
  s_nop 15
  s_nop 15
  s_nop 15
  s_nop 7
  buffer_load_dwordx4 v[52:55], v76, s[8:11], s60 offen offset:0 sc1
  buffer_load_dwordx4 v[56:59], v76, s[8:11], s60 offen offset:1024 sc1
  s_nop 15
  s_nop 11
  buffer_load_dwordx4 v[36:39], v76, s[8:11], s60 offen offset:0 sc1
  buffer_load_dwordx4 v[40:43], v76, s[8:11], s60 offen offset:1024 sc1
  s_waitcnt lgkmcnt(0)
  s_cmp_eq_u32 s66, 12
  s_cbranch_scc1 Cs3_kv
Cs3_kvb:
  s_waitcnt vmcnt(3)
  v_mfma_f32_16x16x32_bf16 v[4:7], v[0:3], v[52:55], 0
  v_bitop3_b32 v72, v52, v54, s72 bitop3:0x7e
  s_waitcnt vmcnt(2)
  v_mfma_f32_16x16x32_bf16 v[4:7], v[0:3], v[56:59], v[4:7]
  v_bitop3_b32 v73, v56, v58, s72 bitop3:0x7e
  v_bitop3_b32 v72, v72, v73, 1 bitop3:0xa8
  v_cmp_ne_u32 vcc, 0, v72
  s_cbranch_vccnz Cs3_h1r
Cs3_h1p:
  s_nop 2
  v_add_f32_dpp v4, v4, v4 row_ror:4 row_mask:0xf bank_mask:0xf
  v_add_f32_dpp v5, v5, v5 row_ror:4 row_mask:0xf bank_mask:0xf
  s_nop 0
  v_add_f32_dpp v4, v4, v4 row_ror:8 row_mask:0xf bank_mask:0xf
  v_add_f32_dpp v5, v5, v5 row_ror:8 row_mask:0xf bank_mask:0xf
  v_cvt_pk_bf16_f32 v4, v4, v5
  buffer_store_dword v4, v69, s[8:11], s62 offen sc1
Cs3_h1ok:
  s_xor_b32 s62, s62, 16384
  s_xor_b32 s72, s72, 1
Cs3_h2:
  v_lshlrev_b32 v73, 2, v76
  s_mov_b32 m0, 10752
  buffer_store_dword v71, v69, s[8:11], s62 offen sc1
  s_waitcnt vmcnt(2)
  ds_read_b128 v[60:63], v76 offset:28672
  ds_read_b128 v[64:67], v76 offset:29696
  ds_read_b128 v[44:47], v76 offset:30720
  ds_read_b128 v[48:51], v76 offset:31744
  ds_read_b128 v[36:39], v76 offset:45056
  ds_read_b128 v[40:43], v76 offset:46080
  s_cmp_eq_u32 s66, 12
  s_cbranch_scc1 Cs3_kv2
  s_branch Cs3_top
Cs3_rec:
  s_nop 7
  s_waitcnt vmcnt(0) lgkmcnt(0)
  v_max3_u32 v72, v0, v1, v2
  v_max3_u32 v72, v72, v3, v4
  v_max3_u32 v72, v72, v5, v6
  v_max3_u32 v72, v72, v7, v8
  v_max3_u32 v72, v72, v9, v10
  v_max3_u32 v72, v72, v11, v12
  v_max3_u32 v72, v72, v13, v14
  v_max3_u32 v72, v72, v15, v16
  v_max3_u32 v72, v72, v17, v18
  v_max_u32 v72, v72, v19
  v_cmp_eq_u32 vcc, -1, v72
  s_cbranch_vccz Cs3_recok
  s_barrier
Cs3_recp:
  buffer_load_dwordx4 v[60:63], v76, s[8:11], s64 offen offset:0 sc1
  buffer_load_dwordx4 v[64:67], v76, s[8:11], s64 offen offset:1024 sc1
  s_add_u32 s67, s67, 1
  s_cmp_lt_u32 s67, 131072
  s_cselect_b32 s54, -2, -1
  s_waitcnt vmcnt(1)
  v_max3_u32 v72, v60, v61, v62
  s_waitcnt vmcnt(0)
  v_max3_u32 v72, v72, v63, v64
  v_max3_u32 v72, v72, v65, v66
  v_max_u32 v72, v72, v67
  v_cmp_lt_u32 vcc, s54, v72
  s_cbranch_vccnz Cs3_recp
  ds_write_b128 v76, v[60:63] offset:10752
  ds_write_b128 v76, v[64:67] offset:11776
  v_mov_b64 v[20:21], 0
  v_mov_b64 v[22:23], 0
  v_mov_b64 v[24:25], 0
  v_mov_b64 v[26:27], 0
  v_mov_b64 v[28:29], 0
  v_mov_b64 v[30:31], 0
  v_mov_b64 v[32:33], 0
  v_mov_b64 v[34:35], 0
  s_waitcnt lgkmcnt(0)
  s_barrier
  ds_read_b128 v[0:3], v76 offset:4608
  ds_read_b128 v[60:63], v76 offset:28672
  ds_read_b128 v[64:67], v76 offset:29696
  s_waitcnt lgkmcnt(0)
  v_smfmac_f32_16x16x64_bf16 v[20:23], v[0:3], v[60:67], v74
  ds_read_b128 v[60:63], v76 offset:30720
  ds_read_b128 v[64:67], v76 offset:31744
  s_waitcnt lgkmcnt(0)
  v_smfmac_f32_16x16x64_bf16 v[24:27], v[0:3], v[60:67], v74
  ds_read_b128 v[60:63], v76 offset:45056
  ds_read_b128 v[64:67], v76 offset:46080
  s_waitcnt lgkmcnt(0)
  v_smfmac_f32_16x16x64_bf16 v[28:31], v[0:3], v[60:67], v74
  ds_read_b128 v[60:63], v76 offset:47104
  ds_read_b128 v[64:67], v76 offset:48128
  s_waitcnt lgkmcnt(0)
  v_smfmac_f32_16x16x64_bf16 v[32:35], v[0:3], v[60:67], v74
  ds_read_b128 v[4:7], v76 offset:5632
  s_waitcnt lgkmcnt(0)
  v_smfmac_f32_16x16x64_bf16 v[20:23], v[4:7], v[80:87], v74
  v_smfmac_f32_16x16x64_bf16 v[24:27], v[4:7], v[88:95], v74
  v_smfmac_f32_16x16x64_bf16 v[28:31], v[4:7], v[208:215], v74
  v_smfmac_f32_16x16x64_bf16 v[32:35], v[4:7], v[216:223], v74
  ds_read_b128 v[8:11], v76 offset:6656
  s_waitcnt lgkmcnt(0)
  v_smfmac_f32_16x16x64_bf16 v[20:23], v[8:11], v[96:103], v74
  v_smfmac_f32_16x16x64_bf16 v[24:27], v[8:11], v[104:111], v74
  ds_read_b128 v[60:63], v76 offset:61440
  ds_read_b128 v[64:67], v76 offset:62464
  s_waitcnt lgkmcnt(0)
  v_smfmac_f32_16x16x64_bf16 v[28:31], v[8:11], v[60:67], v74
  ds_read_b128 v[60:63], v76 offset:63488
  ds_read_b128 v[64:67], v76 offset:64512
  s_waitcnt lgkmcnt(0)
  v_smfmac_f32_16x16x64_bf16 v[32:35], v[8:11], v[60:67], v74
  ds_read_b128 v[12:15], v76 offset:7680
  s_waitcnt lgkmcnt(0)
  v_smfmac_f32_16x16x64_bf16 v[20:23], v[12:15], v[112:119], v74
  v_smfmac_f32_16x16x64_bf16 v[24:27], v[12:15], v[120:127], v74
  v_smfmac_f32_16x16x64_bf16 v[28:31], v[12:15], v[224:231], v74
  v_smfmac_f32_16x16x64_bf16 v[32:35], v[12:15], v[232:239], v74
  ds_read_b128 v[4:7], v76 offset:8704
  s_waitcnt lgkmcnt(0)
  v_smfmac_f32_16x16x64_bf16 v[20:23], v[4:7], v[128:135], v74
  v_smfmac_f32_16x16x64_bf16 v[24:27], v[4:7], v[136:143], v74
  ds_read_b128 v[60:63], v75 offset:28672
  ds_read_b128 v[64:67], v75 offset:29696
  s_waitcnt lgkmcnt(0)
  v_smfmac_f32_16x16x64_bf16 v[28:31], v[4:7], v[60:67], v74
  ds_read_b128 v[60:63], v75 offset:30720
  ds_read_b128 v[64:67], v75 offset:31744
  s_waitcnt lgkmcnt(0)
  v_smfmac_f32_16x16x64_bf16 v[32:35], v[4:7], v[60:67], v74
  ds_read_b128 v[16:19], v76 offset:9728
  s_waitcnt lgkmcnt(0)
  v_smfmac_f32_16x16x64_bf16 v[20:23], v[16:19], v[144:151], v74
  v_smfmac_f32_16x16x64_bf16 v[24:27], v[16:19], v[152:159], v74
  v_smfmac_f32_16x16x64_bf16 v[28:31], v[16:19], v[240:247], v74
  v_smfmac_f32_16x16x64_bf16 v[32:35], v[16:19], v[248:255], v74
  ds_read_b128 v[12:15], v76 offset:10752
  s_waitcnt lgkmcnt(0)
  v_smfmac_f32_16x16x64_bf16 v[20:23], v[12:15], v[160:167], v74
  v_smfmac_f32_16x16x64_bf16 v[24:27], v[12:15], v[168:175], v74
  v_smfmac_f32_16x16x64_bf16 v[28:31], v[12:15], a[0:7], v74
  v_smfmac_f32_16x16x64_bf16 v[32:35], v[12:15], a[8:15], v74
  ds_read_b128 v[8:11], v76 offset:11776
  s_waitcnt lgkmcnt(0)
  v_smfmac_f32_16x16x64_bf16 v[20:23], v[8:11], v[176:183], v74
  v_smfmac_f32_16x16x64_bf16 v[24:27], v[8:11], v[184:191], v74
  v_smfmac_f32_16x16x64_bf16 v[28:31], v[8:11], a[16:23], v74
  v_smfmac_f32_16x16x64_bf16 v[32:35], v[8:11], a[24:31], v74
  ds_read_b128 v[0:3], v76 offset:12800
  s_waitcnt lgkmcnt(0)
  v_smfmac_f32_16x16x64_bf16 v[20:23], v[0:3], v[192:199], v74
  v_smfmac_f32_16x16x64_bf16 v[24:27], v[0:3], v[200:207], v74
  ds_read_b128 v[60:63], v75 offset:12288
  ds_read_b128 v[64:67], v75 offset:13312
  s_waitcnt lgkmcnt(0)
  v_smfmac_f32_16x16x64_bf16 v[28:31], v[0:3], v[60:67], v74
  ds_read_b128 v[60:63], v75 offset:14336
  ds_read_b128 v[64:67], v75 offset:15360
  s_waitcnt lgkmcnt(0)
  v_smfmac_f32_16x16x64_bf16 v[32:35], v[0:3], v[60:67], v74
  v_add_f32 v20, v20, v22
  v_add_f32 v21, v21, v23
  v_add_f32 v24, v24, v26
  v_cvt_pk_bf16_f32 v22, v20, v24
  ds_write_b32 v79, v22 offset:0
  v_add_f32 v25, v25, v27
  v_cvt_pk_bf16_f32 v23, v21, v25
  ds_write_b32 v79, v23 offset:576
  v_add_f32 v28, v28, v30
  v_add_f32 v29, v29, v31
  s_waitcnt lgkmcnt(0)
  s_nop 1
  s_branch Cs3_recok
Cs3_mx:
  s_waitcnt lgkmcnt(0)
  s_barrier
  buffer_load_dwordx4 v[0:3], v76, s[8:11], s58 offen offset:0 sc1
  ds_read_b128 v[20:23], v77 offset:0
  ds_read_b128 v[28:31], v77 offset:256
  buffer_load_dwordx4 v[4:7], v76, s[8:11], s58 offen offset:1024 sc1
  ds_read_b128 v[24:27], v77 offset:128
  ds_read_b128 v[32:35], v77 offset:384
  s_waitcnt vmcnt(1) lgkmcnt(3)
  v_mfma_f32_16x16x32_bf16 v[8:11], v[0:3], v[20:23], 0
  s_waitcnt vmcnt(0) lgkmcnt(1)
  v_mfma_f32_16x16x32_bf16 v[8:11], v[4:7], v[24:27], v[8:11]
  v_mfma_f32_16x16x32_bf16 v[12:15], v[28:31], v[20:23], 0
  s_waitcnt lgkmcnt(0)
  v_mfma_f32_16x16x32_bf16 v[12:15], v[32:35], v[24:27], v[12:15]
  v_add_f32_dpp v8, v10, v8 quad_perm:[2,3,0,1] row_mask:0xf bank_mask:0xf
  v_add_f32_dpp v9, v11, v9 quad_perm:[2,3,0,1] row_mask:0xf bank_mask:0xf
  s_nop 0
  v_mov_b32_dpp v8, v8 quad_perm:[0,1,0,1] row_mask:0xf bank_mask:0xf
  v_mov_b32_dpp v9, v9 quad_perm:[0,1,0,1] row_mask:0xf bank_mask:0xf
  s_nop 1
  v_add_f32_dpp v12, v14, v12 quad_perm:[2,3,0,1] row_mask:0xf bank_mask:0xf
  v_add_f32_dpp v13, v15, v13 quad_perm:[2,3,0,1] row_mask:0xf bank_mask:0xf
  s_nop 0
  v_mov_b32_dpp v12, v12 quad_perm:[0,1,0,1] row_mask:0xf bank_mask:0xf
  v_mov_b32_dpp v13, v13 quad_perm:[0,1,0,1] row_mask:0xf bank_mask:0xf
  v_mul_f32 v12, s69, v12
  ds_write_b32 v78, v8 offset:8716
  v_mul_f32 v13, s69, v13
  ds_write_b32 v78, v9 offset:8780
  s_waitcnt lgkmcnt(0)
  s_barrier
  ds_read_b128 v[36:39], v78 offset:8704
  ds_read_b128 v[40:43], v78 offset:8768
  s_waitcnt lgkmcnt(0)
  s_barrier
  v_max_f32 v16, v36, v37
  v_max3_f32 v16, v16, v38, v39
  v_max3_f32 v16, v16, v40, v41
  v_max3_f32 v16, v16, v42, v43
  v_max3_f32 v16, v16, v12, v13
  v_mov_b32 v17, v16
  s_nop 1
  v_permlane16_swap_b32 v16, v17
  v_max_f32 v16, v16, v17
  v_mov_b32 v17, v16
  s_nop 1
  v_permlane32_swap_b32 v16, v17
  v_max_f32 v16, v16, v17
  v_sub_f32 v36, v36, v16
  v_sub_f32 v37, v37, v16
  v_sub_f32 v38, v38, v16
  v_sub_f32 v39, v39, v16
  v_sub_f32 v40, v40, v16
  v_sub_f32 v41, v41, v16
  v_sub_f32 v42, v42, v16
  v_sub_f32 v43, v43, v16
  v_sub_f32 v12, v12, v16
  v_sub_f32 v13, v13, v16
  v_exp_f32 v36, v36
  v_exp_f32 v37, v37
  v_exp_f32 v38, v38
  v_exp_f32 v39, v39
  v_exp_f32 v40, v40
  v_exp_f32 v41, v41
  v_exp_f32 v42, v42
  v_exp_f32 v43, v43
  v_exp_f32 v12, v12
  v_exp_f32 v13, v13
  v_cvt_pk_bf16_f32 v32, v36, v40
  v_cvt_pk_bf16_f32 v33, v37, v41
  v_cvt_pk_bf16_f32 v34, v38, v42
  v_cvt_pk_bf16_f32 v35, v39, v43
  v_cvt_pk_bf16_f32 v28, v12, v13
  v_cvt_pk_bf16_f32 v31, v12, v13
  v_mov_b32 v29, 0
  v_mov_b32 v30, 0
  v_mov_b32 v68, 0x3f803f80
  v_mov_b32 v69, 0x3f803f80
  v_mov_b32 v70, 0x3f803f80
  v_mov_b32 v71, 0x3f803f80
  s_nop 1
  v_mfma_f32_16x16x32_bf16 v[8:11], v[32:35], v[68:71], 0
  v_mfma_f32_16x16x32_bf16 v[0:3], v[32:35], v[52:55], 0
  v_mfma_f32_16x16x32_bf16 v[4:7], v[32:35], v[56:59], 0
  v_mfma_f32_16x16x16_bf16 v[8:11], v[28:29], v[68:69], v[8:11]
  v_mfma_f32_16x16x16_bf16 v[0:3], v[28:29], v[72:73], v[0:3]
  v_mfma_f32_16x16x16_bf16 v[4:7], v[30:31], v[72:73], v[4:7]
  ds_read_b128 v[68:71], v76 offset:13824
  v_rcp_f32 v10, v8
  v_rcp_f32 v11, v9
  v_mul_f32 v0, v10, v0
  v_mul_f32 v1, v11, v1
  s_nop 0
  v_mul_f32 v4, v10, v4
  v_mul_f32 v5, v11, v5
  v_cvt_pk_bf16_f32 v2, v0, v4
  ds_write_b32 v79, v2 offset:8704
  v_cvt_pk_bf16_f32 v3, v1, v5
  ds_write_b32 v79, v3 offset:9280
  v_mov_b64 v[16:17], 0
  v_mov_b64 v[18:19], 0
  v_mov_b64 v[20:21], 0
  v_mov_b64 v[22:23], 0
  s_branch Cs3_mxok
Cs3_kv:
  s_lshl_b32 s56, s53, 2
  s_add_u32 s56, s56, 128
  s_load_dword s57, s[12:13], s56 glc
  s_branch Cs3_kvb
Cs3_kv2:
  s_waitcnt lgkmcnt(0)
  s_cmp_ge_u32 s57, 0x700
  s_cbranch_scc1 Cs3_top
  s_load_dword s57, s[12:13], s56 glc
  s_add_u32 s67, s67, 1
  s_cmp_lt_u32 s67, 131072
  s_cbranch_scc1 Cs3_kv2
  s_branch Cs3_top
Cs3_h1r:
  s_mov_b64 exec, vcc
  buffer_load_dwordx4 v[52:55], v76, s[8:11], s60 offen offset:0 sc1
  buffer_load_dwordx4 v[56:59], v76, s[8:11], s60 offen offset:1024 sc1
  s_mov_b64 exec, -1
  s_add_u32 s67, s67, 1
  s_waitcnt vmcnt(3)
  v_mfma_f32_16x16x32_bf16 v[4:7], v[0:3], v[36:39], 0
  v_bitop3_b32 v72, v36, v38, s72 bitop3:0x7e
  s_waitcnt vmcnt(2)
  v_mfma_f32_16x16x32_bf16 v[4:7], v[0:3], v[40:43], v[4:7]
  v_bitop3_b32 v73, v40, v42, s72 bitop3:0x7e
  v_bitop3_b32 v72, v72, v73, 1 bitop3:0xa8
  v_cmp_ne_u32 vcc, 0, v72
  s_cbranch_vccz Cs3_h1p
  s_mov_b64 exec, vcc
  buffer_load_dwordx4 v[36:39], v76, s[8:11], s60 offen offset:0 sc1
  buffer_load_dwordx4 v[40:43], v76, s[8:11], s60 offen offset:1024 sc1
  s_mov_b64 exec, -1
  s_add_u32 s67, s67, 1
  s_waitcnt vmcnt(3)
  v_mfma_f32_16x16x32_bf16 v[4:7], v[0:3], v[52:55], 0
  v_bitop3_b32 v72, v52, v54, s72 bitop3:0x7e
  s_waitcnt vmcnt(2)
  v_mfma_f32_16x16x32_bf16 v[4:7], v[0:3], v[56:59], v[4:7]
  v_bitop3_b32 v73, v56, v58, s72 bitop3:0x7e
  v_bitop3_b32 v72, v72, v73, 1 bitop3:0xa8
  v_cmp_ne_u32 vcc, 0, v72
  s_cbranch_vccz Cs3_h1p
  s_cmp_lt_u32 s67, 131072
  s_cbranch_scc1 Cs3_h1r
  s_branch Cs3_h1p
Cs3_last:
  s_nop 7
  s_waitcnt vmcnt(0) lgkmcnt(0)
  ds_read_b64 v[16:17], v77 offset:392
  v_mov_b64 v[18:19], v[72:73]
  s_add_u32 s68, s68, 131072
  s_waitcnt lgkmcnt(0)
  buffer_store_dwordx4 v[16:19], v76, s[8:11], s68 offen sc1
  s_waitcnt vmcnt(0)
  s_barrier
  s_branch L_cexit
L_cexit:
L_exit:
L_end:
s_endpgm
.section .rodata,"a"
.p2align 6
.amdhsa_kernel gated_mix__sliding_local_dilated__memory_aug_recurrent_mem_tr__prompt_kernel
  .amdhsa_next_free_vgpr 512
  .amdhsa_next_free_sgpr 102
  .amdhsa_accum_offset 256
  .amdhsa_group_segment_fixed_size 0
  .amdhsa_kernarg_size 112
  .amdhsa_user_sgpr_count 2
  .amdhsa_user_sgpr_kernarg_segment_ptr 1
  .amdhsa_system_sgpr_workgroup_id_x 1
.end_amdhsa_kernel
```

```asm
; @launch grid=(256,1,1) block=(256,1,1) lds=163840
.amdgcn_target "amdgcn-amd-amdhsa--gfx950"
.text
.globl gated_mix__sliding_local_dilated__memory_aug_recurrent_mem_tr__prompt_kernel
.p2align 8
.type gated_mix__sliding_local_dilated__memory_aug_recurrent_mem_tr__prompt_kernel,@function
gated_mix__sliding_local_dilated__memory_aug_recurrent_mem_tr__prompt_kernel:
  s_cmp_ge_u32 s2, 256
  s_cbranch_scc1 L_end
  s_load_dwordx2 s[4:5], s[0:1], 0
  s_load_dwordx2 s[8:9], s[0:1], 104
  s_load_dwordx2 s[12:13], s[0:1], 96
  s_load_dwordx2 s[16:17], s[0:1], 40
  s_load_dwordx2 s[20:21], s[0:1], 48
  s_load_dwordx2 s[24:25], s[0:1], 56
  s_load_dwordx2 s[28:29], s[0:1], 64
  s_load_dwordx2 s[32:33], s[0:1], 32
  s_load_dwordx2 s[36:37], s[0:1], 8
  s_load_dwordx2 s[40:41], s[0:1], 16
  s_load_dwordx2 s[44:45], s[0:1], 80
  s_load_dwordx2 s[48:49], s[0:1], 88
  s_getreg_b32 s54, hwreg(HW_REG_XCC_ID, 0, 3)
  v_lshrrev_b32 v1, 6, v0
  s_nop 0
  v_readfirstlane_b32 s52, v1
  s_mov_b32 s6, 2359296
  s_mov_b32 s7, 0x20000
  s_mov_b32 s10, 268435456
  s_mov_b32 s11, 0x20000
  s_mov_b32 s14, 256
  s_mov_b32 s15, 0x20000
  s_mov_b32 s18, 4718592
  s_mov_b32 s19, 0x20000
  s_mov_b32 s22, 4718592
  s_mov_b32 s23, 0x20000
  s_mov_b32 s26, 4718592
  s_mov_b32 s27, 0x20000
  s_mov_b32 s30, 4718592
  s_mov_b32 s31, 0x20000
  s_mov_b32 s34, 9216
  s_mov_b32 s35, 0x20000
  s_mov_b32 s38, 1990656
  s_mov_b32 s39, 0x20000
  s_mov_b32 s42, 663552
  s_mov_b32 s43, 0x20000
  s_mov_b32 s46, 1152
  s_mov_b32 s47, 0x20000
  s_mov_b32 s50, 2359296
  s_mov_b32 s51, 0x20000
  s_waitcnt lgkmcnt(0)
  s_lshr_b32 s0, s2, 3
  s_mov_b32 s2, s54
  s_mov_b32 s1, 0
  s_lshl_b32 s55, s2, 2
  s_cmp_eq_u32 s52, 0
  s_cselect_b32 s55, s55, 0x1000
  s_lshl_b32 s56, 1, s0
  v_mov_b32 v1, 0
  v_mov_b32 v35, s56
  s_mov_b64 exec, 1
  buffer_atomic_or v35, v1, s[12:15], s55 offen sc0
  s_mov_b64 exec, -1
L_role:
  s_mov_b32 s53, s0
  s_cmp_eq_u32 s2, 0
  s_cbranch_scc0 L_worker
  v_and_b32 v0, 63, v0
  v_and_b32 v1, 15, v0
  v_lshrrev_b32 v2, 4, v0
  v_and_b32 v3, 1, v2
  s_lshl_b32 s54, s52, 1
  v_add_u32 v3, s54, v3
  v_lshlrev_b32 v3, 1, v3
  v_xor_b32 v3, v3, v1
  v_lshlrev_b32 v3, 4, v3
  v_lshl_add_u32 v8, v2, 13, v3
  s_lshl_b32 s78, s53, 8
  s_lshl_b32 s54, s52, 15
  s_add_u32 s78, s78, s54
  s_mul_i32 s79, s53, 147456
  s_lshl_b32 s57, s52, 10
  s_add_u32 s57, s57, 16384
  s_add_u32 m0, s57, 0
  s_add_u32 s54, s78, 524288
  buffer_load_dwordx4 v8, s[16:19], s54 offen  lds
  s_add_u32 m0, s57, 4096
  s_add_u32 s54, s78, 655360
  buffer_load_dwordx4 v8, s[16:19], s54 offen  lds
  s_add_u32 m0, s57, 8192
  s_add_u32 s54, s78, 786432
  buffer_load_dwordx4 v8, s[16:19], s54 offen  lds
  s_add_u32 m0, s57, 12288
  s_add_u32 s54, s78, 917504
  buffer_load_dwordx4 v8, s[16:19], s54 offen  lds
  s_add_u32 m0, s57, 16384
  s_add_u32 s54, s78, 1048576
  buffer_load_dwordx4 v8, s[16:19], s54 offen  lds
  s_add_u32 m0, s57, 20480
  s_add_u32 s54, s78, 1179648
  buffer_load_dwordx4 v8, s[16:19], s54 offen  lds
  s_add_u32 m0, s57, 24576
  s_add_u32 s54, s78, 1310720
  buffer_load_dwordx4 v8, s[16:19], s54 offen  lds
  s_add_u32 m0, s57, 28672
  s_add_u32 s54, s78, 1441792
  buffer_load_dwordx4 v8, s[16:19], s54 offen  lds
  s_add_u32 m0, s57, 32768
  s_add_u32 s54, s78, 1572864
  buffer_load_dwordx4 v8, s[16:19], s54 offen  lds
  s_add_u32 m0, s57, 36864
  s_add_u32 s54, s78, 1703936
  buffer_load_dwordx4 v8, s[16:19], s54 offen  lds
  s_add_u32 m0, s57, 40960
  s_add_u32 s54, s78, 1835008
  buffer_load_dwordx4 v8, s[16:19], s54 offen  lds
  s_add_u32 m0, s57, 45056
  s_add_u32 s54, s78, 1966080
  buffer_load_dwordx4 v8, s[16:19], s54 offen  lds
  s_add_u32 m0, s57, 49152
  s_add_u32 s54, s78, 2097152
  buffer_load_dwordx4 v8, s[16:19], s54 offen  lds
  s_add_u32 m0, s57, 53248
  s_add_u32 s54, s78, 2228224
  buffer_load_dwordx4 v8, s[16:19], s54 offen  lds
  s_add_u32 m0, s57, 57344
  s_add_u32 s54, s78, 2359296
  buffer_load_dwordx4 v8, s[16:19], s54 offen  lds
  s_add_u32 m0, s57, 61440
  s_add_u32 s54, s78, 2490368
  buffer_load_dwordx4 v8, s[16:19], s54 offen  lds
  s_add_u32 m0, s57, 65536
  s_add_u32 s54, s78, 2621440
  buffer_load_dwordx4 v8, s[16:19], s54 offen  lds
  s_add_u32 m0, s57, 69632
  s_add_u32 s54, s78, 2752512
  buffer_load_dwordx4 v8, s[16:19], s54 offen  lds
  s_add_u32 m0, s57, 73728
  s_add_u32 s54, s78, 2883584
  buffer_load_dwordx4 v8, s[16:19], s54 offen  lds
  s_add_u32 m0, s57, 77824
  s_add_u32 s54, s78, 3014656
  buffer_load_dwordx4 v8, s[16:19], s54 offen  lds
  v_lshlrev_b32 v76, 4, v0
  v_add_u32 v75, 0x10000, v76
  v_lshrrev_b32 v3, 2, v1
  v_and_b32 v4, 1, v1
  v_lshl_add_u32 v3, v3, 1, v4
  v_bfe_u32 v4, v1, 1, 1
  v_mul_u32_u24 v74, 0xaaaa, v4
  v_add_u32 v74, 0x4444, v74
  v_mul_u32_u24 v5, 576, v3
  v_add_u32 v5, 0, v5
  v_lshl_add_u32 v78, v2, 4, v5
  v_lshl_add_u32 v77, v2, 5, v5
  v_lshl_add_u32 v77, v4, 4, v77
  v_mul_u32_u24 v15, 1152, v3
  v_lshl_add_u32 v15, v2, 5, v15
  v_lshl_add_u32 v15, v4, 4, v15
  s_lshl_b32 s54, s52, 8
  buffer_load_dwordx4 v[20:23], v15, s[32:35], s54 offen
  buffer_load_dwordx4 v[24:27], v15, s[32:35], s54 offen offset:128
  buffer_load_dwordx4 v[28:31], v15, s[32:35], 0 offen offset:1024
  v_mul_u32_u24 v79, 1152, v2
  v_lshl_add_u32 v79, v1, 2, v79
  s_lshl_b32 s54, s52, 6
  s_add_u32 s54, s54, 0
  v_add_u32 v79, s54, v79
  v_lshrrev_b32 v5, 3, v0
  v_mul_u32_u24 v68, 2176, v5
  v_and_b32 v5, 7, v0
  v_lshl_add_u32 v68, v5, 3, v68
  v_and_b32 v5, 1, v2
  v_lshlrev_b32 v5, 4, v5
  v_lshl_add_u32 v5, v1, 2, v5
  v_mov_b32 v6, 0x40000000
  v_cmp_lt_u32 vcc, 3, v1
  s_nop 1
  v_cndmask_b32 v5, v5, v6, vcc
  v_lshrrev_b32 v6, 1, v2
  v_lshl_add_u32 v69, v6, 10, v5
  v_lshl_add_u32 v70, v6, 8, v5
  v_mov_b32 v71, -1
  ds_write_b128 v76, v[68:71] offset:13824
  v_and_b32 v5, 3, v1
  v_lshrrev_b32 v6, 2, v1
  v_lshl_add_u32 v5, v5, 2, v6
  v_and_b32 v6, 1, v5
  v_lshlrev_b32 v6, 4, v6
  v_mov_b32 v7, 0x3f80
  v_lshlrev_b32 v6, v6, v7
  v_lshrrev_b32 v5, 1, v5
  v_cmp_eq_u32 vcc, 0, v5
  s_nop 1
  v_cndmask_b32 v40, 0, v6, vcc
  v_cmp_eq_u32 vcc, 1, v5
  s_nop 1
  v_cndmask_b32 v41, 0, v6, vcc
  v_cmp_eq_u32 vcc, 2, v5
  s_nop 1
  v_cndmask_b32 v42, 0, v6, vcc
  v_cmp_eq_u32 vcc, 3, v5
  s_nop 1
  v_cndmask_b32 v43, 0, v6, vcc
  ds_write_b128 v76, v[40:43] offset:14848
  s_and_b32 s54, s52, 1
  s_lshr_b32 s55, s52, 1
  v_lshrrev_b32 v3, 3, v0
  v_and_b32 v4, 1, v3
  v_lshlrev_b32 v4, 4, v4
  v_and_b32 v5, 6, v3
  v_add_u32 v4, v4, v5
  s_lshl_b32 s56, s55, 3
  s_add_u32 s56, s56, s54
  v_add_u32 v4, s56, v4
  v_mul_u32_u24 v4, 1152, v4
  v_and_b32 v5, 2, v3
  v_lshlrev_b32 v5, 1, v5
  v_and_b32 v6, 7, v0
  v_xor_b32 v6, v6, v5
  v_lshl_add_u32 v9, v6, 4, v4
  v_and_b32 v4, 1, v2
  v_lshlrev_b32 v4, 4, v4
  v_and_b32 v5, 2, v2
  v_add_u32 v4, v4, v5
  s_lshl_b32 s56, s55, 2
  s_add_u32 s56, s56, s54
  v_add_u32 v4, s56, v4
  v_mul_u32_u24 v4, 1152, v4
  v_lshlrev_b32 v6, 1, v2
  v_xor_b32 v6, v6, v1
  v_lshl_add_u32 v10, v6, 4, v4
  v_bfe_u32 v17, v1, 2, 1
  v_bfe_u32 v18, v1, 3, 1
  v_and_b32 v19, 1, v2
  v_lshrrev_b32 v72, 1, v2
  v_and_b32 v73, 3, v1
  v_lshl_add_u32 v3, v19, 1, v17
  v_lshl_add_u32 v6, v18, 2, v3
  v_lshl_add_u32 v4, v72, 4, v17
  v_lshl_add_u32 v4, v19, 2, v4
  v_lshl_add_u32 v4, v18, 3, v4
  v_lshlrev_b32 v4, 8, v4
  s_lshl_b32 s54, s52, 6
  v_lshl_add_u32 v5, v73, 3, s54
  v_lshlrev_b32 v7, 5, v6
  v_xor_b32 v5, v5, v7
  v_add_u32 v11, v4, v5
  v_xor_b32 v12, 32, v11
  v_lshl_add_u32 v4, v72, 2, v3
  v_lshlrev_b32 v4, 7, v4
  v_lshl_add_u32 v4, v73, 3, v4
  s_and_b32 s54, s52, 1
  v_xor_b32 v7, s54, v19
  v_lshl_add_u32 v7, v7, 1, v18
  v_lshl_add_u32 v13, v7, 5, v4
  v_lshlrev_b32 v4, 11, v72
  v_lshl_add_u32 v4, v73, 3, v4
  v_lshl_add_u32 v5, v3, 8, v4
  v_lshl_add_u32 v7, v18, 2, s52
  v_xor_b32 v7, v7, v3
  v_lshl_add_u32 v14, v7, 5, v5
  s_lshl_b32 s54, s53, 14
  s_lshl_b32 s55, s52, 11
  s_add_u32 s54, s54, 1048576
  s_add_u32 s58, s54, s55
  s_add_u32 s59, s58, 8192
  s_lshl_b32 s55, s52, 12
  s_add_u32 s70, s54, s55
  s_add_u32 s70, s70, 655360
  s_lshl_b32 s54, s53, 12
  s_lshl_b32 s55, s52, 10
  s_add_u32 s54, s54, s55
  s_add_u32 s68, s54, 917504
  s_lshl_b32 s54, s53, 7
  s_add_u32 s71, s54, 352256
  s_lshl_b32 s54, s53, 6
  s_mul_i32 s55, s52, 17408
  s_add_u32 s55, s54, s55
  s_add_u32 s73, s55, 0
  s_add_u32 s74, s55, 69632
  s_add_u32 s75, s55, 139264
  s_add_u32 s76, s55, 208896
  s_and_b32 s56, s52, 1
  s_mul_i32 s55, s56, 17408
  s_add_u32 s55, s54, s55
  s_add_u32 s77, s55, 278528
  s_mul_i32 s54, s52, 69632
  s_mul_i32 s55, s53, 2176
  s_add_u32 s54, s54, s55
  s_add_u32 s60, s54, 0
  s_and_b32 s56, s53, 15
  s_mul_i32 s55, s56, 2176
  s_add_u32 s61, s55, 278528
  s_lshl_b32 s54, s52, 11
  s_add_u32 s64, s54, 360448
  s_mov_b32 s65, 368640
  s_lshl_b32 s55, s53, 5
  s_add_u32 s54, s54, s55
  s_add_u32 s62, s54, 376832
  s_lshr_b32 s54, s56, 3
  s_lshl_b32 s54, s54, 9
  s_and_b32 s55, s56, 7
  s_lshl_b32 s55, s55, 5
  s_add_u32 s54, s54, s55
  s_add_u32 s63, s54, 385024
  s_mov_b32 s66, 0
  s_mov_b32 s67, 0
  s_mov_b32 s72, 0
  s_mov_b32 s69, 1040356334
  s_waitcnt vmcnt(19) lgkmcnt(0)
  s_barrier
  s_add_u32 m0, s57, 81920
  s_add_u32 s54, s78, 3145728
  buffer_load_dwordx4 v8, s[16:19], s54 offen  lds
  s_add_u32 m0, s57, 86016
  s_add_u32 s54, s78, 3276800
  buffer_load_dwordx4 v8, s[16:19], s54 offen  lds
  s_add_u32 m0, s57, 90112
  s_add_u32 s54, s78, 3407872
  buffer_load_dwordx4 v8, s[16:19], s54 offen  lds
  s_add_u32 m0, s57, 94208
  s_add_u32 s54, s78, 3538944
  buffer_load_dwordx4 v8, s[16:19], s54 offen  lds
  v_add_u32 v15, 16384, v11
  v_add_u32 v16, 16384, v12
  ds_read_b64_tr_b16 v[80:81], v15 offset:0
  ds_read_b64_tr_b16 v[82:83], v15 offset:512
  ds_read_b64_tr_b16 v[84:85], v15 offset:8192
  ds_read_b64_tr_b16 v[86:87], v15 offset:8704
  ds_read_b64_tr_b16 v[88:89], v16 offset:0
  ds_read_b64_tr_b16 v[90:91], v16 offset:512
  ds_read_b64_tr_b16 v[92:93], v16 offset:8192
  ds_read_b64_tr_b16 v[94:95], v16 offset:8704
  s_waitcnt vmcnt(19) lgkmcnt(0)
  s_barrier
  s_add_u32 m0, s57, 98304
  s_add_u32 s54, s78, 3670016
  buffer_load_dwordx4 v8, s[16:19], s54 offen  lds
  s_add_u32 m0, s57, 102400
  s_add_u32 s54, s78, 3801088
  buffer_load_dwordx4 v8, s[16:19], s54 offen  lds
  s_add_u32 m0, s57, 106496
  s_add_u32 s54, s78, 3932160
  buffer_load_dwordx4 v8, s[16:19], s54 offen  lds
  s_add_u32 m0, s57, 110592
  s_add_u32 s54, s78, 4063232
  buffer_load_dwordx4 v8, s[16:19], s54 offen  lds
  v_add_u32 v15, 32768, v11
  v_add_u32 v16, 32768, v12
  ds_read_b64_tr_b16 v[96:97], v15 offset:0
  ds_read_b64_tr_b16 v[98:99], v15 offset:512
  ds_read_b64_tr_b16 v[100:101], v15 offset:8192
  ds_read_b64_tr_b16 v[102:103], v15 offset:8704
  ds_read_b64_tr_b16 v[104:105], v16 offset:0
  ds_read_b64_tr_b16 v[106:107], v16 offset:512
  ds_read_b64_tr_b16 v[108:109], v16 offset:8192
  ds_read_b64_tr_b16 v[110:111], v16 offset:8704
  s_waitcnt vmcnt(19) lgkmcnt(0)
  s_barrier
  s_add_u32 m0, s57, 114688
  s_add_u32 s54, s78, 4194304
  buffer_load_dwordx4 v8, s[16:19], s54 offen  lds
  s_add_u32 m0, s57, 118784
  s_add_u32 s54, s78, 4325376
  buffer_load_dwordx4 v8, s[16:19], s54 offen  lds
  s_add_u32 m0, s57, 122880
  s_add_u32 s54, s78, 4456448
  buffer_load_dwordx4 v8, s[16:19], s54 offen  lds
  s_add_u32 m0, s57, 126976
  s_add_u32 s54, s78, 4587520
  buffer_load_dwordx4 v8, s[16:19], s54 offen  lds
  v_add_u32 v15, 49152, v11
  v_add_u32 v16, 49152, v12
  ds_read_b64_tr_b16 v[112:113], v15 offset:0
  ds_read_b64_tr_b16 v[114:115], v15 offset:512
  ds_read_b64_tr_b16 v[116:117], v15 offset:8192
  ds_read_b64_tr_b16 v[118:119], v15 offset:8704
  ds_read_b64_tr_b16 v[120:121], v16 offset:0
  ds_read_b64_tr_b16 v[122:123], v16 offset:512
  ds_read_b64_tr_b16 v[124:125], v16 offset:8192
  ds_read_b64_tr_b16 v[126:127], v16 offset:8704
  s_waitcnt vmcnt(19) lgkmcnt(0)
  s_barrier
  s_add_u32 m0, s57, 131072
  s_add_u32 s54, s78, 524288
  buffer_load_dwordx4 v8, s[20:23], s54 offen  lds
  s_add_u32 m0, s57, 135168
  s_add_u32 s54, s78, 655360
  buffer_load_dwordx4 v8, s[20:23], s54 offen  lds
  s_add_u32 m0, s57, 139264
  s_add_u32 s54, s78, 786432
  buffer_load_dwordx4 v8, s[20:23], s54 offen  lds
  s_add_u32 m0, s57, 143360
  s_add_u32 s54, s78, 917504
  buffer_load_dwordx4 v8, s[20:23], s54 offen  lds
  v_add_u32 v15, 65536, v11
  v_add_u32 v16, 65536, v12
  ds_read_b64_tr_b16 v[128:129], v15 offset:0
  ds_read_b64_tr_b16 v[130:131], v15 offset:512
  ds_read_b64_tr_b16 v[132:133], v15 offset:8192
  ds_read_b64_tr_b16 v[134:135], v15 offset:8704
  ds_read_b64_tr_b16 v[136:137], v16 offset:0
  ds_read_b64_tr_b16 v[138:139], v16 offset:512
  ds_read_b64_tr_b16 v[140:141], v16 offset:8192
  ds_read_b64_tr_b16 v[142:143], v16 offset:8704
  s_waitcnt vmcnt(19) lgkmcnt(0)
  s_barrier
  s_add_u32 m0, s57, 0
  s_add_u32 s54, s78, 1572864
  buffer_load_dwordx4 v8, s[20:23], s54 offen  lds
  s_add_u32 m0, s57, 4096
  s_add_u32 s54, s78, 1703936
  buffer_load_dwordx4 v8, s[20:23], s54 offen  lds
  s_add_u32 m0, s57, 8192
  s_add_u32 s54, s78, 1835008
  buffer_load_dwordx4 v8, s[20:23], s54 offen  lds
  s_add_u32 m0, s57, 12288
  s_add_u32 s54, s78, 1966080
  buffer_load_dwordx4 v8, s[20:23], s54 offen  lds
  v_add_u32 v15, 81920, v11
  v_add_u32 v16, 81920, v12
  ds_read_b64_tr_b16 v[144:145], v15 offset:0
  ds_read_b64_tr_b16 v[146:147], v15 offset:512
  ds_read_b64_tr_b16 v[148:149], v15 offset:8192
  ds_read_b64_tr_b16 v[150:151], v15 offset:8704
  ds_read_b64_tr_b16 v[152:153], v16 offset:0
  ds_read_b64_tr_b16 v[154:155], v16 offset:512
  ds_read_b64_tr_b16 v[156:157], v16 offset:8192
  ds_read_b64_tr_b16 v[158:159], v16 offset:8704
  s_waitcnt vmcnt(16) lgkmcnt(0)
  s_barrier
  s_add_u32 m0, s57, 16384
  s_add_u32 s54, s78, 2621440
  buffer_load_dwordx4 v8, s[20:23], s54 offen  lds
  s_add_u32 m0, s57, 20480
  s_add_u32 s54, s78, 2752512
  buffer_load_dwordx4 v8, s[20:23], s54 offen  lds
  s_add_u32 m0, s57, 24576
  s_add_u32 s54, s78, 2883584
  buffer_load_dwordx4 v8, s[20:23], s54 offen  lds
  s_add_u32 m0, s57, 28672
  s_add_u32 s54, s78, 3014656
  buffer_load_dwordx4 v8, s[20:23], s54 offen  lds
  v_add_u32 v15, 98304, v11
  v_add_u32 v16, 98304, v12
  ds_read_b64_tr_b16 v[160:161], v15 offset:0
  ds_read_b64_tr_b16 v[162:163], v15 offset:512
  ds_read_b64_tr_b16 v[164:165], v15 offset:8192
  ds_read_b64_tr_b16 v[166:167], v15 offset:8704
  ds_read_b64_tr_b16 v[168:169], v16 offset:0
  ds_read_b64_tr_b16 v[170:171], v16 offset:512
  ds_read_b64_tr_b16 v[172:173], v16 offset:8192
  ds_read_b64_tr_b16 v[174:175], v16 offset:8704
  s_waitcnt vmcnt(16) lgkmcnt(0)
  s_barrier
  s_add_u32 m0, s57, 32768
  s_add_u32 s54, s78, 3145728
  buffer_load_dwordx4 v8, s[20:23], s54 offen  lds
  s_add_u32 m0, s57, 36864
  s_add_u32 s54, s78, 3276800
  buffer_load_dwordx4 v8, s[20:23], s54 offen  lds
  s_add_u32 m0, s57, 40960
  s_add_u32 s54, s78, 3407872
  buffer_load_dwordx4 v8, s[20:23], s54 offen  lds
  s_add_u32 m0, s57, 45056
  s_add_u32 s54, s78, 3538944
  buffer_load_dwordx4 v8, s[20:23], s54 offen  lds
  s_cmp_eq_u32 s1, 1
  s_cbranch_scc1 C_ver_ok
  v_mov_b32 v33, 16320
  s_cmp_eq_u32 s52, 0
  s_cbranch_scc0 C_ver_b
  s_waitcnt vmcnt(51)
  s_mov_b64 exec, 1
  ds_write_b32 v33, v35
  s_mov_b64 exec, -1
  s_waitcnt lgkmcnt(0)
C_ver_b:
  s_barrier
  ds_read_b32 v32, v33
  s_waitcnt lgkmcnt(0)
  v_readfirstlane_b32 s54, v32
  s_nop 0
  s_bitcmp1_b32 s54, s0
  s_cbranch_scc1 L_conf
C_ver_ok:
  v_add_u32 v15, 114688, v11
  v_add_u32 v16, 114688, v12
  ds_read_b64_tr_b16 v[176:177], v15 offset:0
  ds_read_b64_tr_b16 v[178:179], v15 offset:512
  ds_read_b64_tr_b16 v[180:181], v15 offset:8192
  ds_read_b64_tr_b16 v[182:183], v15 offset:8704
  ds_read_b64_tr_b16 v[184:185], v16 offset:0
  ds_read_b64_tr_b16 v[186:187], v16 offset:512
  ds_read_b64_tr_b16 v[188:189], v16 offset:8192
  ds_read_b64_tr_b16 v[190:191], v16 offset:8704
  s_waitcnt vmcnt(16) lgkmcnt(0)
  s_barrier
  s_add_u32 m0, s57, 49152
  s_add_u32 s54, s78, 3670016
  buffer_load_dwordx4 v8, s[20:23], s54 offen  lds
  s_add_u32 m0, s57, 53248
  s_add_u32 s54, s78, 3801088
  buffer_load_dwordx4 v8, s[20:23], s54 offen  lds
  s_add_u32 m0, s57, 57344
  s_add_u32 s54, s78, 3932160
  buffer_load_dwordx4 v8, s[20:23], s54 offen  lds
  s_add_u32 m0, s57, 61440
  s_add_u32 s54, s78, 4063232
  buffer_load_dwordx4 v8, s[20:23], s54 offen  lds
  v_add_u32 v15, 131072, v11
  v_add_u32 v16, 131072, v12
  ds_read_b64_tr_b16 v[192:193], v15 offset:0
  ds_read_b64_tr_b16 v[194:195], v15 offset:512
  ds_read_b64_tr_b16 v[196:197], v15 offset:8192
  ds_read_b64_tr_b16 v[198:199], v15 offset:8704
  ds_read_b64_tr_b16 v[200:201], v16 offset:0
  ds_read_b64_tr_b16 v[202:203], v16 offset:512
  ds_read_b64_tr_b16 v[204:205], v16 offset:8192
  ds_read_b64_tr_b16 v[206:207], v16 offset:8704
  s_waitcnt vmcnt(16) lgkmcnt(0)
  s_barrier
  s_add_u32 m0, s57, 65536
  s_add_u32 s54, s78, 0
  buffer_load_dwordx4 v8, s[24:27], s54 offen  lds
  s_add_u32 m0, s57, 69632
  s_add_u32 s54, s78, 131072
  buffer_load_dwordx4 v8, s[24:27], s54 offen  lds
  s_add_u32 m0, s57, 73728
  s_add_u32 s54, s78, 262144
  buffer_load_dwordx4 v8, s[24:27], s54 offen  lds
  s_add_u32 m0, s57, 77824
  s_add_u32 s54, s78, 393216
  buffer_load_dwordx4 v8, s[24:27], s54 offen  lds
  v_mov_b32 v4, -1
  v_mov_b32 v5, -1
  v_mov_b64 v[6:7], v[4:5]
  v_mov_b32 v3, 0
  s_lshl_b32 s56, s53, 14
  s_xor_b32 s54, s64, s56
  s_xor_b32 s55, s65, s56
  s_cmp_lt_u32 s53, 2
  s_cselect_b32 s54, s54, 268435456
  s_cselect_b32 s55, s55, 268435456
  s_lshr_b32 s56, s53, 4
  s_or_b32 s56, s56, s52
  s_cmp_eq_u32 s56, 0
  s_cselect_b32 s56, s61, 268435456
  buffer_store_dwordx4 v[4:7], v76, s[8:11], s60 offen offset:0 sc1
  buffer_store_dwordx4 v[4:7], v76, s[8:11], s60 offen offset:1024 sc1
  buffer_store_dwordx4 v[4:7], v76, s[8:11], s56 offen offset:0 sc1
  buffer_store_dwordx4 v[4:7], v76, s[8:11], s56 offen offset:1024 sc1
  buffer_store_dwordx4 v[4:7], v76, s[8:11], s54 offen offset:0 sc1
  buffer_store_dwordx4 v[4:7], v76, s[8:11], s54 offen offset:1024 sc1
  buffer_store_dwordx4 v[4:7], v76, s[8:11], s55 offen offset:0 sc1
  s_mov_b64 exec, 1
  buffer_store_dword v3, v3, s[8:11], s71 offen sc1
  s_mov_b64 exec, -1
  v_min_u32 v20, -2, v20
  v_min_u32 v21, -2, v21
  v_min_u32 v22, -2, v22
  v_min_u32 v23, -2, v23
  v_min_u32 v24, -2, v24
  v_min_u32 v25, -2, v25
  v_min_u32 v26, -2, v26
  v_min_u32 v27, -2, v27
  v_min_u32 v28, -2, v28
  v_min_u32 v29, -2, v29
  v_min_u32 v30, -2, v30
  v_min_u32 v31, -2, v31
  s_lshl_b32 s54, s52, 11
  v_add_u32 v3, s54, v76
  ds_write_b128 v3, v[20:23] offset:4608
  ds_write_b128 v3, v[24:27] offset:5632
  ds_write_b128 v76, v[28:31] offset:12800
  v_add_u32 v15, 147456, v11
  v_add_u32 v16, 147456, v12
  ds_read_b64_tr_b16 v[208:209], v15 offset:0
  ds_read_b64_tr_b16 v[210:211], v15 offset:512
  ds_read_b64_tr_b16 v[212:213], v15 offset:8192
  ds_read_b64_tr_b16 v[214:215], v15 offset:8704
  ds_read_b64_tr_b16 v[216:217], v16 offset:0
  ds_read_b64_tr_b16 v[218:219], v16 offset:512
  ds_read_b64_tr_b16 v[220:221], v16 offset:8192
  ds_read_b64_tr_b16 v[222:223], v16 offset:8704
  s_waitcnt vmcnt(24) lgkmcnt(0)
  s_barrier
  s_add_u32 m0, s57, 81920
  s_add_u32 s54, s78, 524288
  buffer_load_dwordx4 v8, s[24:27], s54 offen  lds
  s_add_u32 m0, s57, 86016
  s_add_u32 s54, s78, 655360
  buffer_load_dwordx4 v8, s[24:27], s54 offen  lds
  s_add_u32 m0, s57, 90112
  s_add_u32 s54, s78, 786432
  buffer_load_dwordx4 v8, s[24:27], s54 offen  lds
  s_add_u32 m0, s57, 94208
  s_add_u32 s54, s78, 917504
  buffer_load_dwordx4 v8, s[24:27], s54 offen  lds
  v_add_u32 v15, 16384, v11
  v_add_u32 v16, 16384, v12
  ds_read_b64_tr_b16 v[224:225], v15 offset:0
  ds_read_b64_tr_b16 v[226:227], v15 offset:512
  ds_read_b64_tr_b16 v[228:229], v15 offset:8192
  ds_read_b64_tr_b16 v[230:231], v15 offset:8704
  ds_read_b64_tr_b16 v[232:233], v16 offset:0
  ds_read_b64_tr_b16 v[234:235], v16 offset:512
  ds_read_b64_tr_b16 v[236:237], v16 offset:8192
  ds_read_b64_tr_b16 v[238:239], v16 offset:8704
  s_waitcnt vmcnt(24) lgkmcnt(0)
  s_barrier
  s_add_u32 m0, s57, 98304
  s_add_u32 s54, s78, 1048576
  buffer_load_dwordx4 v8, s[24:27], s54 offen  lds
  s_add_u32 m0, s57, 102400
  s_add_u32 s54, s78, 1179648
  buffer_load_dwordx4 v8, s[24:27], s54 offen  lds
  s_add_u32 m0, s57, 106496
  s_add_u32 s54, s78, 1310720
  buffer_load_dwordx4 v8, s[24:27], s54 offen  lds
  s_add_u32 m0, s57, 110592
  s_add_u32 s54, s78, 1441792
  buffer_load_dwordx4 v8, s[24:27], s54 offen  lds
  v_add_u32 v15, 32768, v11
  v_add_u32 v16, 32768, v12
  ds_read_b64_tr_b16 v[240:241], v15 offset:0
  ds_read_b64_tr_b16 v[242:243], v15 offset:512
  ds_read_b64_tr_b16 v[244:245], v15 offset:8192
  ds_read_b64_tr_b16 v[246:247], v15 offset:8704
  ds_read_b64_tr_b16 v[248:249], v16 offset:0
  ds_read_b64_tr_b16 v[250:251], v16 offset:512
  ds_read_b64_tr_b16 v[252:253], v16 offset:8192
  ds_read_b64_tr_b16 v[254:255], v16 offset:8704
  s_waitcnt vmcnt(24) lgkmcnt(0)
  s_barrier
  s_add_u32 m0, s57, 114688
  s_add_u32 s54, s78, 1572864
  buffer_load_dwordx4 v8, s[24:27], s54 offen  lds
  s_add_u32 m0, s57, 118784
  s_add_u32 s54, s78, 1703936
  buffer_load_dwordx4 v8, s[24:27], s54 offen  lds
  s_add_u32 m0, s57, 122880
  s_add_u32 s54, s78, 1835008
  buffer_load_dwordx4 v8, s[24:27], s54 offen  lds
  s_add_u32 m0, s57, 126976
  s_add_u32 s54, s78, 1966080
  buffer_load_dwordx4 v8, s[24:27], s54 offen  lds
  v_add_u32 v15, 49152, v11
  v_add_u32 v16, 49152, v12
  ds_read_b64_tr_b16 a[0:1], v15 offset:0
  ds_read_b64_tr_b16 a[2:3], v15 offset:512
  ds_read_b64_tr_b16 a[4:5], v15 offset:8192
  ds_read_b64_tr_b16 a[6:7], v15 offset:8704
  ds_read_b64_tr_b16 a[8:9], v16 offset:0
  ds_read_b64_tr_b16 a[10:11], v16 offset:512
  ds_read_b64_tr_b16 a[12:13], v16 offset:8192
  ds_read_b64_tr_b16 a[14:15], v16 offset:8704
  s_waitcnt vmcnt(24) lgkmcnt(0)
  s_barrier
  s_add_u32 m0, s57, 131072
  s_add_u32 s54, s78, 2097152
  buffer_load_dwordx4 v8, s[24:27], s54 offen  lds
  s_add_u32 m0, s57, 135168
  s_add_u32 s54, s78, 2228224
  buffer_load_dwordx4 v8, s[24:27], s54 offen  lds
  s_add_u32 m0, s57, 139264
  s_add_u32 s54, s78, 2359296
  buffer_load_dwordx4 v8, s[24:27], s54 offen  lds
  s_add_u32 m0, s57, 143360
  s_add_u32 s54, s78, 2490368
  buffer_load_dwordx4 v8, s[24:27], s54 offen  lds
  v_add_u32 v15, 65536, v11
  v_add_u32 v16, 65536, v12
  ds_read_b64_tr_b16 a[16:17], v15 offset:0
  ds_read_b64_tr_b16 a[18:19], v15 offset:512
  ds_read_b64_tr_b16 a[20:21], v15 offset:8192
  ds_read_b64_tr_b16 a[22:23], v15 offset:8704
  ds_read_b64_tr_b16 a[24:25], v16 offset:0
  ds_read_b64_tr_b16 a[26:27], v16 offset:512
  ds_read_b64_tr_b16 a[28:29], v16 offset:8192
  ds_read_b64_tr_b16 a[30:31], v16 offset:8704
  s_waitcnt vmcnt(24) lgkmcnt(0)
  s_barrier
  s_add_u32 m0, s57, 0
  s_add_u32 s54, s78, 2621440
  buffer_load_dwordx4 v8, s[24:27], s54 offen  lds
  s_add_u32 m0, s57, 4096
  s_add_u32 s54, s78, 2752512
  buffer_load_dwordx4 v8, s[24:27], s54 offen  lds
  s_add_u32 m0, s57, 8192
  s_add_u32 s54, s78, 2883584
  buffer_load_dwordx4 v8, s[24:27], s54 offen  lds
  s_add_u32 m0, s57, 12288
  s_add_u32 s54, s78, 3014656
  buffer_load_dwordx4 v8, s[24:27], s54 offen  lds
  v_add_u32 v15, 81920, v11
  v_add_u32 v16, 81920, v12
  ds_read_b64_tr_b16 a[32:33], v15 offset:0
  ds_read_b64_tr_b16 a[34:35], v15 offset:512
  ds_read_b64_tr_b16 a[36:37], v15 offset:8192
  ds_read_b64_tr_b16 a[38:39], v15 offset:8704
  ds_read_b64_tr_b16 a[40:41], v16 offset:0
  ds_read_b64_tr_b16 a[42:43], v16 offset:512
  ds_read_b64_tr_b16 a[44:45], v16 offset:8192
  ds_read_b64_tr_b16 a[46:47], v16 offset:8704
  s_waitcnt vmcnt(16) lgkmcnt(0)
  s_barrier
  s_add_u32 m0, s57, 16384
  s_add_u32 s54, s78, 3145728
  buffer_load_dwordx4 v8, s[24:27], s54 offen  lds
  s_add_u32 m0, s57, 20480
  s_add_u32 s54, s78, 3276800
  buffer_load_dwordx4 v8, s[24:27], s54 offen  lds
  s_add_u32 m0, s57, 24576
  s_add_u32 s54, s78, 3407872
  buffer_load_dwordx4 v8, s[24:27], s54 offen  lds
  s_add_u32 m0, s57, 28672
  s_add_u32 s54, s78, 3538944
  buffer_load_dwordx4 v8, s[24:27], s54 offen  lds
  v_add_u32 v15, 98304, v11
  v_add_u32 v16, 98304, v12
  ds_read_b64_tr_b16 a[48:49], v15 offset:0
  ds_read_b64_tr_b16 a[50:51], v15 offset:512
  ds_read_b64_tr_b16 a[52:53], v15 offset:8192
  ds_read_b64_tr_b16 a[54:55], v15 offset:8704
  ds_read_b64_tr_b16 a[56:57], v16 offset:0
  ds_read_b64_tr_b16 a[58:59], v16 offset:512
  ds_read_b64_tr_b16 a[60:61], v16 offset:8192
  ds_read_b64_tr_b16 a[62:63], v16 offset:8704
  s_waitcnt vmcnt(16) lgkmcnt(0)
  s_barrier
  s_add_u32 m0, s57, 32768
  s_add_u32 s54, s78, 3670016
  buffer_load_dwordx4 v8, s[24:27], s54 offen  lds
  s_add_u32 m0, s57, 36864
  s_add_u32 s54, s78, 3801088
  buffer_load_dwordx4 v8, s[24:27], s54 offen  lds
  s_add_u32 m0, s57, 40960
  s_add_u32 s54, s78, 3932160
  buffer_load_dwordx4 v8, s[24:27], s54 offen  lds
  s_add_u32 m0, s57, 45056
  s_add_u32 s54, s78, 4063232
  buffer_load_dwordx4 v8, s[24:27], s54 offen  lds
  v_add_u32 v15, 114688, v11
  v_add_u32 v16, 114688, v12
  ds_read_b64_tr_b16 a[64:65], v15 offset:0
  ds_read_b64_tr_b16 a[66:67], v15 offset:512
  ds_read_b64_tr_b16 a[68:69], v15 offset:8192
  ds_read_b64_tr_b16 a[70:71], v15 offset:8704
  ds_read_b64_tr_b16 a[72:73], v16 offset:0
  ds_read_b64_tr_b16 a[74:75], v16 offset:512
  ds_read_b64_tr_b16 a[76:77], v16 offset:8192
  ds_read_b64_tr_b16 a[78:79], v16 offset:8704
  s_waitcnt vmcnt(16) lgkmcnt(0)
  s_barrier
  s_add_u32 m0, s57, 49152
  s_add_u32 s54, s78, 4194304
  buffer_load_dwordx4 v8, s[24:27], s54 offen  lds
  s_add_u32 m0, s57, 53248
  s_add_u32 s54, s78, 4325376
  buffer_load_dwordx4 v8, s[24:27], s54 offen  lds
  s_add_u32 m0, s57, 57344
  s_add_u32 s54, s78, 4456448
  buffer_load_dwordx4 v8, s[24:27], s54 offen  lds
  s_add_u32 m0, s57, 61440
  s_add_u32 s54, s78, 4587520
  buffer_load_dwordx4 v8, s[24:27], s54 offen  lds
  v_add_u32 v15, 131072, v11
  v_add_u32 v16, 131072, v12
  ds_read_b64_tr_b16 a[80:81], v15 offset:0
  ds_read_b64_tr_b16 a[82:83], v15 offset:512
  ds_read_b64_tr_b16 a[84:85], v15 offset:8192
  ds_read_b64_tr_b16 a[86:87], v15 offset:8704
  ds_read_b64_tr_b16 a[88:89], v16 offset:0
  ds_read_b64_tr_b16 a[90:91], v16 offset:512
  ds_read_b64_tr_b16 a[92:93], v16 offset:8192
  ds_read_b64_tr_b16 a[94:95], v16 offset:8704
  s_waitcnt vmcnt(16) lgkmcnt(0)
  s_barrier
  s_add_u32 m0, s57, 65536
  s_add_u32 s54, s79, 0
  buffer_load_dwordx4 v10, s[28:31], s54 offen  lds
  s_add_u32 m0, s57, 69632
  s_add_u32 s54, s79, 9216
  buffer_load_dwordx4 v10, s[28:31], s54 offen  lds
  s_add_u32 m0, s57, 73728
  s_add_u32 s54, s79, 36864
  buffer_load_dwordx4 v10, s[28:31], s54 offen  lds
  s_add_u32 m0, s57, 77824
  s_add_u32 s54, s79, 46080
  buffer_load_dwordx4 v10, s[28:31], s54 offen  lds
  s_cmp_eq_u32 s52, 0
  s_cselect_b32 s54, 32, 0x1000
  v_mov_b32 v32, 1
  v_mov_b32 v7, 0
  s_mov_b64 exec, 1
  buffer_atomic_add v32, v7, s[12:15], s54 offen
  s_mov_b64 exec, -1
  v_add_u32 v15, 147456, v11
  v_add_u32 v16, 147456, v12
  ds_read_b64_tr_b16 a[96:97], v15 offset:0
  ds_read_b64_tr_b16 a[98:99], v15 offset:512
  ds_read_b64_tr_b16 a[100:101], v15 offset:8192
  ds_read_b64_tr_b16 a[102:103], v15 offset:8704
  ds_read_b64_tr_b16 a[104:105], v16 offset:0
  ds_read_b64_tr_b16 a[106:107], v16 offset:512
  ds_read_b64_tr_b16 a[108:109], v16 offset:8192
  ds_read_b64_tr_b16 a[110:111], v16 offset:8704
  s_waitcnt vmcnt(17) lgkmcnt(0)
  s_barrier
  s_add_u32 m0, s57, 81920
  s_add_u32 s54, s79, 73728
  buffer_load_dwordx4 v10, s[28:31], s54 offen  lds
  s_add_u32 m0, s57, 86016
  s_add_u32 s54, s79, 82944
  buffer_load_dwordx4 v10, s[28:31], s54 offen  lds
  s_add_u32 m0, s57, 90112
  s_add_u32 s54, s79, 110592
  buffer_load_dwordx4 v10, s[28:31], s54 offen  lds
  s_add_u32 m0, s57, 94208
  s_add_u32 s54, s79, 119808
  buffer_load_dwordx4 v10, s[28:31], s54 offen  lds
  v_add_u32 v15, 16384, v11
  v_add_u32 v16, 16384, v12
  ds_read_b64_tr_b16 a[112:113], v15 offset:0
  ds_read_b64_tr_b16 a[114:115], v15 offset:512
  ds_read_b64_tr_b16 a[116:117], v15 offset:8192
  ds_read_b64_tr_b16 a[118:119], v15 offset:8704
  ds_read_b64_tr_b16 a[120:121], v16 offset:0
  ds_read_b64_tr_b16 a[122:123], v16 offset:512
  ds_read_b64_tr_b16 a[124:125], v16 offset:8192
  ds_read_b64_tr_b16 a[126:127], v16 offset:8704
  s_waitcnt vmcnt(17) lgkmcnt(0)
  s_barrier
  s_add_u32 m0, s57, 98304
  s_add_u32 s54, s79, 256
  buffer_load_dwordx4 v10, s[28:31], s54 offen  lds
  s_add_u32 m0, s57, 102400
  s_add_u32 s54, s79, 9472
  buffer_load_dwordx4 v10, s[28:31], s54 offen  lds
  s_add_u32 m0, s57, 106496
  s_add_u32 s54, s79, 37120
  buffer_load_dwordx4 v10, s[28:31], s54 offen  lds
  s_add_u32 m0, s57, 110592
  s_add_u32 s54, s79, 46336
  buffer_load_dwordx4 v10, s[28:31], s54 offen  lds
  v_add_u32 v15, 32768, v11
  v_add_u32 v16, 32768, v12
  ds_read_b64_tr_b16 a[128:129], v15 offset:0
  ds_read_b64_tr_b16 a[130:131], v15 offset:512
  ds_read_b64_tr_b16 a[132:133], v15 offset:8192
  ds_read_b64_tr_b16 a[134:135], v15 offset:8704
  ds_read_b64_tr_b16 a[136:137], v16 offset:0
  ds_read_b64_tr_b16 a[138:139], v16 offset:512
  ds_read_b64_tr_b16 a[140:141], v16 offset:8192
  ds_read_b64_tr_b16 a[142:143], v16 offset:8704
  s_waitcnt vmcnt(17) lgkmcnt(0)
  s_barrier
  s_add_u32 m0, s57, 114688
  s_add_u32 s54, s79, 512
  buffer_load_dwordx4 v10, s[28:31], s54 offen  lds
  s_add_u32 m0, s57, 118784
  s_add_u32 s54, s79, 9728
  buffer_load_dwordx4 v10, s[28:31], s54 offen  lds
  s_add_u32 m0, s57, 122880
  s_add_u32 s54, s79, 37376
  buffer_load_dwordx4 v10, s[28:31], s54 offen  lds
  s_add_u32 m0, s57, 126976
  s_add_u32 s54, s79, 46592
  buffer_load_dwordx4 v10, s[28:31], s54 offen  lds
  v_add_u32 v15, 49152, v11
  v_add_u32 v16, 49152, v12
  ds_read_b64_tr_b16 a[144:145], v15 offset:0
  ds_read_b64_tr_b16 a[146:147], v15 offset:512
  ds_read_b64_tr_b16 a[148:149], v15 offset:8192
  ds_read_b64_tr_b16 a[150:151], v15 offset:8704
  ds_read_b64_tr_b16 a[152:153], v16 offset:0
  ds_read_b64_tr_b16 a[154:155], v16 offset:512
  ds_read_b64_tr_b16 a[156:157], v16 offset:8192
  ds_read_b64_tr_b16 a[158:159], v16 offset:8704
  s_waitcnt vmcnt(17) lgkmcnt(0)
  s_barrier
  s_add_u32 m0, s57, 131072
  s_add_u32 s54, s79, 768
  buffer_load_dwordx4 v10, s[28:31], s54 offen  lds
  s_add_u32 m0, s57, 135168
  s_add_u32 s54, s79, 9984
  buffer_load_dwordx4 v10, s[28:31], s54 offen  lds
  s_add_u32 m0, s57, 139264
  s_add_u32 s54, s79, 37632
  buffer_load_dwordx4 v10, s[28:31], s54 offen  lds
  s_add_u32 m0, s57, 143360
  s_add_u32 s54, s79, 46848
  buffer_load_dwordx4 v10, s[28:31], s54 offen  lds
  v_add_u32 v15, 65536, v11
  v_add_u32 v16, 65536, v12
  ds_read_b64_tr_b16 a[160:161], v15 offset:0
  ds_read_b64_tr_b16 a[162:163], v15 offset:512
  ds_read_b64_tr_b16 a[164:165], v15 offset:8192
  ds_read_b64_tr_b16 a[166:167], v15 offset:8704
  ds_read_b64_tr_b16 a[168:169], v16 offset:0
  ds_read_b64_tr_b16 a[170:171], v16 offset:512
  ds_read_b64_tr_b16 a[172:173], v16 offset:8192
  ds_read_b64_tr_b16 a[174:175], v16 offset:8704
  s_waitcnt vmcnt(17) lgkmcnt(0)
  s_barrier
  s_add_u32 m0, s57, 0
  s_add_u32 s54, s78, 0
  buffer_load_dwordx4 v8, s[16:19], s54 offen  lds
  s_add_u32 m0, s57, 4096
  s_add_u32 s54, s78, 131072
  buffer_load_dwordx4 v8, s[16:19], s54 offen  lds
  s_add_u32 m0, s57, 8192
  s_add_u32 s54, s78, 262144
  buffer_load_dwordx4 v8, s[16:19], s54 offen  lds
  s_add_u32 m0, s57, 12288
  s_add_u32 s54, s78, 393216
  buffer_load_dwordx4 v8, s[16:19], s54 offen  lds
  v_add_u32 v15, 81920, v14
  ds_read_b64_tr_b16 a[176:177], v15 offset:0
  ds_read_b64_tr_b16 a[178:179], v15 offset:1024
  ds_read_b64_tr_b16 a[180:181], v15 offset:4096
  ds_read_b64_tr_b16 a[182:183], v15 offset:5120
  ds_read_b64_tr_b16 a[184:185], v15 offset:8192
  ds_read_b64_tr_b16 a[186:187], v15 offset:9216
  ds_read_b64_tr_b16 a[188:189], v15 offset:12288
  ds_read_b64_tr_b16 a[190:191], v15 offset:13312
  s_waitcnt vmcnt(16) lgkmcnt(0)
  s_barrier
  s_add_u32 m0, s57, 16384
  s_add_u32 s54, s78, 0
  buffer_load_dwordx4 v8, s[20:23], s54 offen  lds
  s_add_u32 m0, s57, 20480
  s_add_u32 s54, s78, 131072
  buffer_load_dwordx4 v8, s[20:23], s54 offen  lds
  s_add_u32 m0, s57, 24576
  s_add_u32 s54, s78, 262144
  buffer_load_dwordx4 v8, s[20:23], s54 offen  lds
  s_add_u32 m0, s57, 28672
  s_add_u32 s54, s78, 393216
  buffer_load_dwordx4 v8, s[20:23], s54 offen  lds
  v_add_u32 v15, 98304, v14
  ds_read_b64_tr_b16 a[192:193], v15 offset:0
  ds_read_b64_tr_b16 a[194:195], v15 offset:1024
  ds_read_b64_tr_b16 a[196:197], v15 offset:4096
  ds_read_b64_tr_b16 a[198:199], v15 offset:5120
  ds_read_b64_tr_b16 a[200:201], v15 offset:8192
  ds_read_b64_tr_b16 a[202:203], v15 offset:9216
  ds_read_b64_tr_b16 a[204:205], v15 offset:12288
  ds_read_b64_tr_b16 a[206:207], v15 offset:13312
  s_waitcnt vmcnt(16) lgkmcnt(0)
  s_barrier
  s_add_u32 m0, s57, 32768
  s_add_u32 s54, s78, 1048576
  buffer_load_dwordx4 v8, s[20:23], s54 offen  lds
  s_add_u32 m0, s57, 36864
  s_add_u32 s54, s78, 1179648
  buffer_load_dwordx4 v8, s[20:23], s54 offen  lds
  s_add_u32 m0, s57, 40960
  s_add_u32 s54, s78, 1310720
  buffer_load_dwordx4 v8, s[20:23], s54 offen  lds
  s_add_u32 m0, s57, 45056
  s_add_u32 s54, s78, 1441792
  buffer_load_dwordx4 v8, s[20:23], s54 offen  lds
  v_add_u32 v15, 114688, v14
  ds_read_b64_tr_b16 a[208:209], v15 offset:0
  ds_read_b64_tr_b16 a[210:211], v15 offset:1024
  ds_read_b64_tr_b16 a[212:213], v15 offset:4096
  ds_read_b64_tr_b16 a[214:215], v15 offset:5120
  ds_read_b64_tr_b16 a[216:217], v15 offset:8192
  ds_read_b64_tr_b16 a[218:219], v15 offset:9216
  ds_read_b64_tr_b16 a[220:221], v15 offset:12288
  ds_read_b64_tr_b16 a[222:223], v15 offset:13312
  s_waitcnt vmcnt(16) lgkmcnt(0)
  s_barrier
  s_add_u32 m0, s57, 49152
  s_add_u32 s54, s78, 4194304
  buffer_load_dwordx4 v8, s[20:23], s54 offen  lds
  s_add_u32 m0, s57, 53248
  s_add_u32 s54, s78, 4325376
  buffer_load_dwordx4 v8, s[20:23], s54 offen  lds
  s_add_u32 m0, s57, 57344
  s_add_u32 s54, s78, 4456448
  buffer_load_dwordx4 v8, s[20:23], s54 offen  lds
  s_add_u32 m0, s57, 61440
  s_add_u32 s54, s78, 4587520
  buffer_load_dwordx4 v8, s[20:23], s54 offen  lds
  v_add_u32 v15, 131072, v14
  ds_read_b64_tr_b16 a[224:225], v15 offset:0
  ds_read_b64_tr_b16 a[226:227], v15 offset:1024
  ds_read_b64_tr_b16 a[228:229], v15 offset:4096
  ds_read_b64_tr_b16 a[230:231], v15 offset:5120
  ds_read_b64_tr_b16 a[232:233], v15 offset:8192
  ds_read_b64_tr_b16 a[234:235], v15 offset:9216
  ds_read_b64_tr_b16 a[236:237], v15 offset:12288
  ds_read_b64_tr_b16 a[238:239], v15 offset:13312
  s_waitcnt vmcnt(16) lgkmcnt(0)
  s_barrier
  s_add_u32 m0, s57, 65536
  s_add_u32 s54, s78, 2097152
  buffer_load_dwordx4 v8, s[20:23], s54 offen  lds
  s_add_u32 m0, s57, 69632
  s_add_u32 s54, s78, 2228224
  buffer_load_dwordx4 v8, s[20:23], s54 offen  lds
  s_add_u32 m0, s57, 73728
  s_add_u32 s54, s78, 2359296
  buffer_load_dwordx4 v8, s[20:23], s54 offen  lds
  s_add_u32 m0, s57, 77824
  s_add_u32 s54, s78, 2490368
  buffer_load_dwordx4 v8, s[20:23], s54 offen  lds
  v_add_u32 v15, 147456, v14
  ds_read_b64_tr_b16 a[240:241], v15 offset:0
  ds_read_b64_tr_b16 a[242:243], v15 offset:1024
  ds_read_b64_tr_b16 a[244:245], v15 offset:4096
  ds_read_b64_tr_b16 a[246:247], v15 offset:5120
  ds_read_b64_tr_b16 a[248:249], v15 offset:8192
  ds_read_b64_tr_b16 a[250:251], v15 offset:9216
  ds_read_b64_tr_b16 a[252:253], v15 offset:12288
  ds_read_b64_tr_b16 a[254:255], v15 offset:13312
  s_waitcnt vmcnt(16) lgkmcnt(0)
  s_barrier
  s_add_u32 m0, s57, 81920
  s_add_u32 s54, s79, 1024
  buffer_load_dwordx4 v9, s[28:31], s54 offen  lds
  s_add_u32 m0, s57, 86016
  s_add_u32 s54, s79, 37888
  buffer_load_dwordx4 v9, s[28:31], s54 offen  lds
  s_add_u32 m0, s57, 90112
  s_add_u32 s54, s79, 74752
  buffer_load_dwordx4 v9, s[28:31], s54 offen  lds
  s_add_u32 m0, s57, 94208
  s_add_u32 s54, s79, 111616
  buffer_load_dwordx4 v9, s[28:31], s54 offen  lds
  v_add_u32 v15, 16384, v11
  v_add_u32 v16, 16384, v12
  ds_read_b64_tr_b16 v[52:53], v15 offset:0
  ds_read_b64_tr_b16 v[54:55], v15 offset:512
  ds_read_b64_tr_b16 v[56:57], v15 offset:8192
  ds_read_b64_tr_b16 v[58:59], v15 offset:8704
  ds_read_b64_tr_b16 v[60:61], v16 offset:0
  ds_read_b64_tr_b16 v[62:63], v16 offset:512
  ds_read_b64_tr_b16 v[64:65], v16 offset:8192
  ds_read_b64_tr_b16 v[66:67], v16 offset:8704
  s_waitcnt vmcnt(16) lgkmcnt(0)
  s_barrier
  s_lshl_b32 s54, s52, 12
  s_add_u32 s54, s54, 16384
  v_add_u32 v7, s54, v76
  ds_write_b128 v7, v[52:55] offset:0
  ds_write_b128 v7, v[56:59] offset:1024
  ds_write_b128 v7, v[60:63] offset:2048
  ds_write_b128 v7, v[64:67] offset:3072
  s_add_u32 m0, s57, 98304
  s_add_u32 s54, s79, 73984
  buffer_load_dwordx4 v10, s[28:31], s54 offen  lds
  s_add_u32 m0, s57, 102400
  s_add_u32 s54, s79, 83200
  buffer_load_dwordx4 v10, s[28:31], s54 offen  lds
  s_add_u32 m0, s57, 106496
  s_add_u32 s54, s79, 110848
  buffer_load_dwordx4 v10, s[28:31], s54 offen  lds
  s_add_u32 m0, s57, 110592
  s_add_u32 s54, s79, 120064
  buffer_load_dwordx4 v10, s[28:31], s54 offen  lds
  v_add_u32 v15, 32768, v11
  v_add_u32 v16, 32768, v12
  ds_read_b64_tr_b16 v[36:37], v15 offset:0
  ds_read_b64_tr_b16 v[38:39], v15 offset:512
  ds_read_b64_tr_b16 v[40:41], v15 offset:8192
  ds_read_b64_tr_b16 v[42:43], v15 offset:8704
  ds_read_b64_tr_b16 v[44:45], v16 offset:0
  ds_read_b64_tr_b16 v[46:47], v16 offset:512
  ds_read_b64_tr_b16 v[48:49], v16 offset:8192
  ds_read_b64_tr_b16 v[50:51], v16 offset:8704
  s_waitcnt vmcnt(16) lgkmcnt(0)
  s_barrier
  s_lshl_b32 s54, s52, 12
  s_add_u32 s54, s54, 32768
  v_add_u32 v7, s54, v76
  ds_write_b128 v7, v[36:39] offset:0
  ds_write_b128 v7, v[40:43] offset:1024
  ds_write_b128 v7, v[44:47] offset:2048
  ds_write_b128 v7, v[48:51] offset:3072
  s_add_u32 m0, s57, 114688
  s_add_u32 s54, s79, 74240
  buffer_load_dwordx4 v10, s[28:31], s54 offen  lds
  s_add_u32 m0, s57, 118784
  s_add_u32 s54, s79, 83456
  buffer_load_dwordx4 v10, s[28:31], s54 offen  lds
  s_add_u32 m0, s57, 122880
  s_add_u32 s54, s79, 111104
  buffer_load_dwordx4 v10, s[28:31], s54 offen  lds
  s_add_u32 m0, s57, 126976
  s_add_u32 s54, s79, 120320
  buffer_load_dwordx4 v10, s[28:31], s54 offen  lds
  v_add_u32 v15, 49152, v11
  v_add_u32 v16, 49152, v12
  ds_read_b64_tr_b16 v[52:53], v15 offset:0
  ds_read_b64_tr_b16 v[54:55], v15 offset:512
  ds_read_b64_tr_b16 v[56:57], v15 offset:8192
  ds_read_b64_tr_b16 v[58:59], v15 offset:8704
  ds_read_b64_tr_b16 v[60:61], v16 offset:0
  ds_read_b64_tr_b16 v[62:63], v16 offset:512
  ds_read_b64_tr_b16 v[64:65], v16 offset:8192
  ds_read_b64_tr_b16 v[66:67], v16 offset:8704
  s_waitcnt vmcnt(16) lgkmcnt(0)
  s_barrier
  s_lshl_b32 s54, s52, 12
  s_add_u32 s54, s54, 49152
  v_add_u32 v7, s54, v76
  ds_write_b128 v7, v[52:55] offset:0
  ds_write_b128 v7, v[56:59] offset:1024
  ds_write_b128 v7, v[60:63] offset:2048
  ds_write_b128 v7, v[64:67] offset:3072
  s_add_u32 m0, s57, 131072
  s_add_u32 s54, s79, 74496
  buffer_load_dwordx4 v10, s[28:31], s54 offen  lds
  s_add_u32 m0, s57, 135168
  s_add_u32 s54, s79, 83712
  buffer_load_dwordx4 v10, s[28:31], s54 offen  lds
  s_add_u32 m0, s57, 139264
  s_add_u32 s54, s79, 111360
  buffer_load_dwordx4 v10, s[28:31], s54 offen  lds
  s_add_u32 m0, s57, 143360
  s_add_u32 s54, s79, 120576
  buffer_load_dwordx4 v10, s[28:31], s54 offen  lds
  v_lshlrev_b32 v7, 3, v76
  s_lshl_b32 s54, s52, 13
  s_add_u32 s54, s54, 360448
  s_bitcmp1_b32 s52, 0
  s_cselect_b64 exec, 0xff, -1
  buffer_load_dword v35, v7, s[8:11], s54 offen sc1
  s_mov_b64 exec, -1
  v_add_u32 v15, 65536, v11
  v_add_u32 v16, 65536, v12
  ds_read_b64_tr_b16 v[36:37], v15 offset:0
  ds_read_b64_tr_b16 v[38:39], v15 offset:512
  ds_read_b64_tr_b16 v[40:41], v15 offset:8192
  ds_read_b64_tr_b16 v[42:43], v15 offset:8704
  ds_read_b64_tr_b16 v[44:45], v16 offset:0
  ds_read_b64_tr_b16 v[46:47], v16 offset:512
  ds_read_b64_tr_b16 v[48:49], v16 offset:8192
  ds_read_b64_tr_b16 v[50:51], v16 offset:8704
  s_waitcnt vmcnt(17) lgkmcnt(0)
  s_barrier
  s_lshl_b32 s54, s52, 12
  s_add_u32 s54, s54, 65536
  v_add_u32 v7, s54, v76
  ds_write_b128 v7, v[36:39] offset:0
  ds_write_b128 v7, v[40:43] offset:1024
  ds_write_b128 v7, v[44:47] offset:2048
  ds_write_b128 v7, v[48:51] offset:3072
  s_lshl_b32 s54, s53, 2
  s_add_u32 s54, s54, 128
  v_lshrrev_b32 v20, 2, v76
  v_writelane_b32 v20, s54, 16
  buffer_load_dword v21, v20, s[12:15], 0 offen sc1
  v_add_u32 v15, 81920, v11
  v_add_u32 v16, 81920, v12
  ds_read_b64_tr_b16 v[52:53], v15 offset:0
  ds_read_b64_tr_b16 v[54:55], v15 offset:512
  ds_read_b64_tr_b16 v[56:57], v15 offset:8192
  ds_read_b64_tr_b16 v[58:59], v15 offset:8704
  ds_read_b64_tr_b16 v[60:61], v16 offset:0
  ds_read_b64_tr_b16 v[62:63], v16 offset:512
  ds_read_b64_tr_b16 v[64:65], v16 offset:8192
  ds_read_b64_tr_b16 v[66:67], v16 offset:8704
  s_waitcnt vmcnt(14) lgkmcnt(0)
  s_barrier
  s_lshl_b32 s54, s52, 12
  s_add_u32 s54, s54, 81920
  v_add_u32 v7, s54, v76
  ds_write_b128 v7, v[52:55] offset:0
  ds_write_b128 v7, v[56:59] offset:1024
  ds_write_b128 v7, v[60:63] offset:2048
  ds_write_b128 v7, v[64:67] offset:3072
  v_add_u32 v15, 98304, v13
  s_waitcnt lgkmcnt(0)
  ds_read_b64_tr_b16 v[36:37], v15 offset:0
  ds_read_b64_tr_b16 v[38:39], v15 offset:1024
  ds_read_b64_tr_b16 v[40:41], v15 offset:2048
  ds_read_b64_tr_b16 v[42:43], v15 offset:3072
  ds_read_b64_tr_b16 v[44:45], v15 offset:4096
  ds_read_b64_tr_b16 v[46:47], v15 offset:5120
  ds_read_b64_tr_b16 v[48:49], v15 offset:6144
  ds_read_b64_tr_b16 v[50:51], v15 offset:7168
  ds_read_b64_tr_b16 v[52:53], v15 offset:8192
  ds_read_b64_tr_b16 v[54:55], v15 offset:9216
  ds_read_b64_tr_b16 v[56:57], v15 offset:10240
  ds_read_b64_tr_b16 v[58:59], v15 offset:11264
  ds_read_b64_tr_b16 v[60:61], v15 offset:12288
  ds_read_b64_tr_b16 v[62:63], v15 offset:13312
  ds_read_b64_tr_b16 v[64:65], v15 offset:14336
  ds_read_b64_tr_b16 v[66:67], v15 offset:15360
  s_waitcnt vmcnt(10) lgkmcnt(0)
  s_barrier
  s_and_b32 s54, s52, 1
  s_lshl_b32 s54, s54, 13
  s_add_u32 s54, s54, 98304
  v_add_u32 v7, s54, v76
  ds_write_b128 v7, v[36:39] offset:0
  ds_write_b128 v7, v[40:43] offset:1024
  ds_write_b128 v7, v[44:47] offset:2048
  ds_write_b128 v7, v[48:51] offset:3072
  ds_write_b128 v7, v[52:55] offset:4096
  ds_write_b128 v7, v[56:59] offset:5120
  ds_write_b128 v7, v[60:63] offset:6144
  ds_write_b128 v7, v[64:67] offset:7168
  v_add_u32 v15, 114688, v14
  ds_read_b64_tr_b16 v[52:53], v15 offset:0
  ds_read_b64_tr_b16 v[54:55], v15 offset:1024
  ds_read_b64_tr_b16 v[56:57], v15 offset:4096
  ds_read_b64_tr_b16 v[58:59], v15 offset:5120
  ds_read_b64_tr_b16 v[60:61], v15 offset:8192
  ds_read_b64_tr_b16 v[62:63], v15 offset:9216
  ds_read_b64_tr_b16 v[64:65], v15 offset:12288
  ds_read_b64_tr_b16 v[66:67], v15 offset:13312
  s_waitcnt vmcnt(6) lgkmcnt(0)
  s_barrier
  s_lshl_b32 s54, s52, 12
  s_add_u32 s54, s54, 114688
  v_add_u32 v7, s54, v76
  ds_write_b128 v7, v[52:55] offset:0
  ds_write_b128 v7, v[56:59] offset:1024
  ds_write_b128 v7, v[60:63] offset:2048
  ds_write_b128 v7, v[64:67] offset:3072
  v_add_u32 v15, 131072, v14
  ds_read_b64_tr_b16 v[36:37], v15 offset:0
  ds_read_b64_tr_b16 v[38:39], v15 offset:1024
  ds_read_b64_tr_b16 v[40:41], v15 offset:4096
  ds_read_b64_tr_b16 v[42:43], v15 offset:5120
  ds_read_b64_tr_b16 v[44:45], v15 offset:8192
  ds_read_b64_tr_b16 v[46:47], v15 offset:9216
  ds_read_b64_tr_b16 v[48:49], v15 offset:12288
  ds_read_b64_tr_b16 v[50:51], v15 offset:13312
  s_waitcnt vmcnt(2) lgkmcnt(0)
  s_barrier
  s_lshl_b32 s54, s52, 12
  s_add_u32 s54, s54, 131072
  v_add_u32 v7, s54, v76
  ds_write_b128 v7, v[36:39] offset:0
  ds_write_b128 v7, v[40:43] offset:1024
  ds_write_b128 v7, v[44:47] offset:2048
  ds_write_b128 v7, v[48:51] offset:3072
  v_add_u32 v15, 147456, v14
  ds_read_b64_tr_b16 v[52:53], v15 offset:0
  ds_read_b64_tr_b16 v[54:55], v15 offset:1024
  ds_read_b64_tr_b16 v[56:57], v15 offset:4096
  ds_read_b64_tr_b16 v[58:59], v15 offset:5120
  ds_read_b64_tr_b16 v[60:61], v15 offset:8192
  ds_read_b64_tr_b16 v[62:63], v15 offset:9216
  ds_read_b64_tr_b16 v[64:65], v15 offset:12288
  ds_read_b64_tr_b16 v[66:67], v15 offset:13312
  s_waitcnt vmcnt(0) lgkmcnt(0)
  s_barrier
  s_lshl_b32 s54, s52, 12
  s_add_u32 s54, s54, 147456
  v_add_u32 v7, s54, v76
  ds_write_b128 v7, v[52:55] offset:0
  ds_write_b128 v7, v[56:59] offset:1024
  ds_write_b128 v7, v[60:63] offset:2048
  ds_write_b128 v7, v[64:67] offset:3072
  s_waitcnt lgkmcnt(0)
  s_branch C_rd1
C_rd0:
  s_sleep 2
  buffer_load_dword v21, v20, s[12:15], 0 offen sc1
  s_waitcnt vmcnt(0)
C_rd1:
  s_mov_b32 s3, 1
  s_add_u32 s67, s67, 1
  s_cmp_ge_u32 s67, 131072
  s_cbranch_scc1 C_rd2
  v_readlane_b32 s54, v21, 8
  v_readlane_b32 s55, v21, 16
  v_readlane_b32 s56, v21, 0
  s_cmp_lt_u32 s54, 32
  s_cbranch_scc1 C_rd0
  s_and_b32 s55, s55, 0xff
  s_cmp_lt_u32 s55, 7
  s_cbranch_scc1 C_rd0
  s_cmp_eq_u32 s56, -1
  s_cselect_b32 s3, 0, 1
C_rd2:
  s_lshl_b32 s54, s3, 2
  s_add_u32 s54, s54, s52
  s_cmp_eq_u32 s54, 1
  s_cbranch_scc1 L_w1
  s_cmp_eq_u32 s54, 2
  s_cbranch_scc1 L_w2
  s_cmp_eq_u32 s54, 3
  s_cbranch_scc1 L_w3
  s_cmp_eq_u32 s54, 4
  s_cbranch_scc1 L_w4
  s_cmp_eq_u32 s54, 5
  s_cbranch_scc1 L_w5
  s_cmp_eq_u32 s54, 6
  s_cbranch_scc1 L_w6
  s_cmp_eq_u32 s54, 7
  s_cbranch_scc1 L_w7
L_w0:
  v_mov_b64 v[20:21], 0
  v_mov_b64 v[22:23], 0
  v_mov_b64 v[24:25], 0
  v_mov_b64 v[26:27], 0
  v_mov_b64 v[28:29], 0
  v_mov_b64 v[30:31], 0
  v_mov_b64 v[32:33], 0
  v_mov_b64 v[34:35], 0
  s_mov_b32 m0, 15872
  v_lshlrev_b32 v73, 2, v76
  v_mov_b32 v72, 0
  ds_read_b128 v[60:63], v76 offset:16384
  ds_read_b128 v[64:67], v76 offset:17408
  ds_read_b128 v[44:47], v76 offset:18432
  ds_read_b128 v[48:51], v76 offset:19456
  ds_read_b128 v[36:39], v76 offset:32768
  ds_read_b128 v[40:43], v76 offset:33792
  ds_read_b128 v[0:3], v76 offset:4608
  ds_read_b128 v[4:7], v76 offset:5632
  s_branch Cf0_top2
.p2align 6
Cf0_top:
  s_waitcnt lgkmcnt(0)
  s_barrier
  ds_read_b128 v[0:3], v76 offset:4608
  ds_read_b128 v[4:7], v76 offset:5632
Cf0_top2:
  s_waitcnt lgkmcnt(1)
  v_smfmac_f32_16x16x64_bf16 v[20:23], v[0:3], v[60:67], v74
  ds_read_b128 v[60:63], v76 offset:34816
  v_smfmac_f32_16x16x64_bf16 v[24:27], v[0:3], v[44:51], v74
  ds_read_b128 v[64:67], v76 offset:35840
  s_waitcnt lgkmcnt(2)
  v_smfmac_f32_16x16x64_bf16 v[20:23], v[4:7], v[80:87], v74
  buffer_load_dwordx4 v[44:47], v76, s[8:11], s58 offen offset:0 sc1
  ds_read_b128 v[8:11], v76 offset:6656
  v_smfmac_f32_16x16x64_bf16 v[28:31], v[0:3], v[36:43], v74
  ds_read_b128 v[36:39], v76 offset:49152
  v_smfmac_f32_16x16x64_bf16 v[24:27], v[4:7], v[88:95], v74
  buffer_load_dwordx4 v[48:51], v76, s[8:11], s58 offen offset:1024 sc1
  ds_read_b128 v[40:43], v76 offset:50176
  v_smfmac_f32_16x16x64_bf16 v[28:31], v[4:7], v[208:215], v74
  s_waitcnt vmcnt(4)
  ds_read_b128 v[12:15], v76 offset:7680
  v_smfmac_f32_16x16x64_bf16 v[32:35], v[4:7], v[216:223], v74
  buffer_load_dwordx4 v[52:55], v76, s[8:11], s59 offen offset:0 sc1
  s_waitcnt lgkmcnt(4)
  v_smfmac_f32_16x16x64_bf16 v[32:35], v[0:3], v[60:67], v74
  ds_read_b128 v[60:63], v76 offset:51200
  s_waitcnt lgkmcnt(4)
  v_smfmac_f32_16x16x64_bf16 v[20:23], v[8:11], v[96:103], v74
  buffer_load_dwordx4 v[56:59], v76, s[8:11], s59 offen offset:1024 sc1
  ds_read_b128 v[64:67], v76 offset:52224
  v_smfmac_f32_16x16x64_bf16 v[24:27], v[8:11], v[104:111], v74
  buffer_store_dwordx4 v[16:19], v76, s[8:11], s68 offen sc1
  ds_read_b128 v[0:3], v76 offset:12800
  s_waitcnt lgkmcnt(4)
  v_smfmac_f32_16x16x64_bf16 v[28:31], v[8:11], v[36:43], v74
  ds_read_b128 v[36:39], v75 offset:0
  s_waitcnt lgkmcnt(4)
  v_smfmac_f32_16x16x64_bf16 v[20:23], v[12:15], v[112:119], v74
  ds_read_b128 v[40:43], v75 offset:1024
  v_smfmac_f32_16x16x64_bf16 v[24:27], v[12:15], v[120:127], v74
  buffer_load_dword v73, s[8:11], s70 offen lds
  s_waitcnt lgkmcnt(3)
  v_smfmac_f32_16x16x64_bf16 v[32:35], v[8:11], v[60:67], v74
  ds_read_b128 v[60:63], v75 offset:2048
  v_smfmac_f32_16x16x64_bf16 v[28:31], v[12:15], v[224:231], v74
  ds_read_b128 v[64:67], v75 offset:3072
  v_smfmac_f32_16x16x64_bf16 v[32:35], v[12:15], v[232:239], v74
  s_barrier
  s_waitcnt lgkmcnt(4)
  v_smfmac_f32_16x16x64_bf16 v[20:23], v[0:3], v[192:199], v74
  ds_read_b128 v[4:7], v76 offset:8704
  s_waitcnt lgkmcnt(3)
  v_smfmac_f32_16x16x64_bf16 v[28:31], v[0:3], v[36:43], v74
  ds_read_b128 v[16:19], v76 offset:9728
  v_smfmac_f32_16x16x64_bf16 v[24:27], v[0:3], v[200:207], v74
  ds_read_b128 v[36:39], v75 offset:16384
  s_waitcnt lgkmcnt(3)
  v_mov_b32 v68, 0x3f803f80
  v_smfmac_f32_16x16x64_bf16 v[32:35], v[0:3], v[60:67], v74
  ds_read_b128 v[40:43], v75 offset:17408
  s_waitcnt lgkmcnt(3)
  v_smfmac_f32_16x16x64_bf16 v[20:23], v[4:7], v[128:135], v74
  ds_read_b128 v[12:15], v76 offset:10752
  v_mov_b32 v69, 0x3f803f80
  v_smfmac_f32_16x16x64_bf16 v[24:27], v[4:7], v[136:143], v74
  ds_read_b128 v[8:11], v76 offset:11776
  s_waitcnt lgkmcnt(4)
  v_smfmac_f32_16x16x64_bf16 v[20:23], v[16:19], v[144:151], v74
  ds_read_b128 v[60:63], v75 offset:18432
  v_mov_b64 v[70:71], v[68:69]
  v_smfmac_f32_16x16x64_bf16 v[24:27], v[16:19], v[152:159], v74
  ds_read_b128 v[64:67], v75 offset:19456
  s_waitcnt lgkmcnt(4)
  v_smfmac_f32_16x16x64_bf16 v[28:31], v[4:7], v[36:43], v74
  s_waitcnt lgkmcnt(3)
  v_mov_b64 v[36:37], 0
  v_smfmac_f32_16x16x64_bf16 v[20:23], v[12:15], v[160:167], v74
  s_waitcnt lgkmcnt(2)
  v_mov_b64 v[38:39], 0
  v_smfmac_f32_16x16x64_bf16 v[20:23], v[8:11], v[176:183], v74
  v_mov_b64 v[40:41], 0
  v_smfmac_f32_16x16x64_bf16 v[24:27], v[12:15], v[168:175], v74
  v_mov_b64 v[42:43], 0
  v_smfmac_f32_16x16x64_bf16 v[24:27], v[8:11], v[184:191], v74
  s_waitcnt lgkmcnt(0)
  v_add_f32 v20, v20, v22
  v_smfmac_f32_16x16x64_bf16 v[32:35], v[4:7], v[60:67], v74
  v_add_f32 v21, v21, v23
  v_smfmac_f32_16x16x64_bf16 v[28:31], v[16:19], v[240:247], v74
  v_add_f32 v24, v24, v26
  v_cvt_pk_bf16_f32 v22, v20, v24
  v_smfmac_f32_16x16x64_bf16 v[28:31], v[12:15], a[0:7], v74
  ds_write_b32 v79, v22 offset:0
  v_add_f32 v25, v25, v27
  v_cvt_pk_bf16_f32 v23, v21, v25
  v_smfmac_f32_16x16x64_bf16 v[28:31], v[8:11], a[16:23], v74
  ds_write_b32 v79, v23 offset:576
  v_cmp_u_f32 vcc, v20, v21
  v_smfmac_f32_16x16x64_bf16 v[32:35], v[16:19], v[248:255], v74
  v_smfmac_f32_16x16x64_bf16 v[32:35], v[12:15], a[8:15], v74
  v_add_f32 v28, v28, v30
  v_add_f32 v29, v29, v31
  v_smfmac_f32_16x16x64_bf16 v[32:35], v[8:11], a[24:31], v74
  s_cbranch_vccnz Cf0_rec
Cf0_recok:
  v_smfmac_f32_16x16x64_bf16 v[36:39], v[16:19], a[112:119], v74
  s_waitcnt lgkmcnt(0)
  s_barrier
  ds_read_b128 v[60:63], v77
  v_smfmac_f32_16x16x64_bf16 v[40:43], v[16:19], a[120:127], v74
  ds_read_b128 v[64:67], v77 offset:128
  v_add_f32 v32, v32, v34
  v_cvt_pk_bf16_f32 v30, v28, v32
  v_smfmac_f32_16x16x64_bf16 v[36:39], v[0:3], a[160:167], v74
  ds_write_b32 v79, v30 offset:256
  v_add_f32 v33, v33, v35
  v_cvt_pk_bf16_f32 v31, v29, v33
  v_smfmac_f32_16x16x64_bf16 v[40:43], v[0:3], a[168:175], v74
  ds_write_b32 v79, v31 offset:832
  v_xor_b32 v75, 0x8000, v75
  v_smfmac_f32_16x16x64_bf16 v[36:39], v[4:7], a[96:103], v74
  ds_read_b128 v[0:3], v76 offset:4608
  v_mov_b32 v29, 0
  v_smfmac_f32_16x16x64_bf16 v[40:43], v[4:7], a[104:111], v74
  s_waitcnt vmcnt(4) lgkmcnt(3)
  v_mov_b32 v30, 0
  v_mfma_f32_16x16x32_bf16 v[44:47], v[44:47], v[60:63], 0
  ds_read_b128 v[4:7], v76 offset:5632
  s_waitcnt lgkmcnt(2)
  v_mfma_f32_16x16x32_bf16 v[44:47], v[48:51], v[64:67], v[44:47]
  s_barrier
  v_smfmac_f32_16x16x64_bf16 v[36:39], v[8:11], a[144:151], v74
  ds_read_b128 v[20:23], v77 offset:256
  ds_read_b128 v[24:27], v77 offset:384
  v_smfmac_f32_16x16x64_bf16 v[40:43], v[8:11], a[152:159], v74
  ds_read_b128 v[8:11], v76 offset:6656
  v_add_f32_dpp v72, v46, v44 quad_perm:[2,3,0,1] row_mask:0xf bank_mask:0xf
  v_add_f32_dpp v73, v47, v45 quad_perm:[2,3,0,1] row_mask:0xf bank_mask:0xf
  v_smfmac_f32_16x16x64_bf16 v[36:39], v[12:15], a[128:135], v74
  ds_read_b128 v[44:47], v75 offset:16384
  v_exp_f32_dpp v72, v72 quad_perm:[0,1,0,1] row_mask:0xf bank_mask:0xf
  v_smfmac_f32_16x16x64_bf16 v[40:43], v[12:15], a[136:143], v74
  ds_read_b128 v[12:15], v76 offset:7680
  s_waitcnt lgkmcnt(6)
  v_exp_f32_dpp v73, v73 quad_perm:[0,1,0,1] row_mask:0xf bank_mask:0xf
  v_smfmac_f32_16x16x64_bf16 v[36:39], v[0:3], a[32:39], v74
  s_waitcnt lgkmcnt(3)
  v_cvt_pk_bf16_f32 v72, v72, v73
  v_mfma_f32_16x16x32_bf16 v[20:23], v[20:23], v[60:63], 0
  ds_write_b32 v78, v72 offset:512
  v_mfma_f32_16x16x32_bf16 v[20:23], v[24:27], v[64:67], v[20:23]
  ds_read_b128 v[48:51], v75 offset:17408
  v_smfmac_f32_16x16x64_bf16 v[40:43], v[0:3], a[40:47], v74
  ds_read_b128 v[60:63], v75 offset:18432
  v_smfmac_f32_16x16x64_bf16 v[36:39], v[4:7], a[48:55], v74
  s_waitcnt lgkmcnt(5)
  v_add_f32_dpp v24, v22, v20 quad_perm:[2,3,0,1] row_mask:0xf bank_mask:0xf
  v_add_f32_dpp v25, v23, v21 quad_perm:[2,3,0,1] row_mask:0xf bank_mask:0xf
  v_smfmac_f32_16x16x64_bf16 v[36:39], v[8:11], a[64:71], v74
  s_waitcnt lgkmcnt(2)
  s_barrier
  ds_read_b128 v[32:35], v78 offset:512
  v_smfmac_f32_16x16x64_bf16 v[36:39], v[12:15], a[80:87], v74
  ds_read_b128 v[64:67], v75 offset:19456
  v_mul_f32 v24, s69, v24
  v_smfmac_f32_16x16x64_bf16 v[40:43], v[4:7], a[56:63], v74
  v_mul_f32 v25, s69, v25
  v_smfmac_f32_16x16x64_bf16 v[40:43], v[8:11], a[72:79], v74
  v_exp_f32_dpp v24, v24 quad_perm:[0,1,0,1] row_mask:0xf bank_mask:0xf
  v_smfmac_f32_16x16x64_bf16 v[40:43], v[12:15], a[88:95], v74
  s_waitcnt vmcnt(2) lgkmcnt(1)
  v_exp_f32_dpp v25, v25 quad_perm:[0,1,0,1] row_mask:0xf bank_mask:0xf
  v_mfma_f32_16x16x32_bf16 v[8:11], v[32:35], v[68:71], 0
  v_add_f32 v36, v36, v38
  v_add_f32 v37, v37, v39
  v_mfma_f32_16x16x32_bf16 v[0:3], v[32:35], v[52:55], 0
  v_add_f32 v40, v40, v42
  v_add_f32 v41, v41, v43
  v_mfma_f32_16x16x32_bf16 v[4:7], v[32:35], v[56:59], 0
  v_cvt_pk_bf16_f32 v28, v24, v25
  v_cvt_pk_bf16_f32 v72, v36, v37
  v_cvt_pk_bf16_f32 v73, v40, v41
  v_mfma_f32_16x16x16_bf16 v[8:11], v[28:29], v[68:69], v[8:11]
  v_cvt_pk_bf16_f32 v31, v24, v25
  v_mfma_f32_16x16x16_bf16 v[0:3], v[28:29], v[72:73], v[0:3]
  ds_read_b128 v[68:71], v76 offset:13824
  v_mfma_f32_16x16x16_bf16 v[4:7], v[30:31], v[72:73], v[4:7]
  v_rcp_f32 v10, v8
  v_rcp_f32 v11, v9
  v_mul_f32 v0, v10, v0
  v_mul_f32 v1, v11, v1
  s_nop 0
  v_mul_f32 v4, v10, v4
  v_mul_f32 v5, v11, v5
  v_cvt_pk_bf16_f32 v2, v0, v4
  ds_write_b32 v79, v2 offset:8704
  v_cvt_pk_bf16_f32 v3, v1, v5
  ds_write_b32 v79, v3 offset:9280
  v_subrev_u32 v8, 813694976, v8
  v_subrev_u32 v9, 813694976, v9
  v_max_u32 v8, v8, v9
  v_cmp_le_u32 vcc, 503316480, v8
  v_mov_b64 v[16:17], 0
  v_mov_b64 v[18:19], 0
  v_mov_b64 v[20:21], 0
  v_mov_b64 v[22:23], 0
  s_cbranch_vccnz Cf0_mx
Cf0_mxok:
  s_cmp_eq_u32 s66, 63
  s_waitcnt lgkmcnt(0)
  s_barrier
  ds_read_b128 v[0:3], v78 offset:8704
  ds_read_b128 v[4:7], v78 offset:8768
  ds_read_b128 v[8:11], v78 offset:8832
  ds_read_b128 v[12:15], v78 offset:8896
  v_mov_b64 v[24:25], 0
  v_mov_b64 v[26:27], 0
  v_mov_b64 v[28:29], 0
  v_mov_b64 v[30:31], 0
  v_mov_b64 v[32:33], 0
  v_mov_b64 v[34:35], 0
  s_waitcnt lgkmcnt(3)
  v_smfmac_f32_16x16x64_bf16 v[16:19], v[0:3], a[176:183], v74
  s_cbranch_scc1 Cf0_last
  s_waitcnt lgkmcnt(2)
  v_smfmac_f32_16x16x64_bf16 v[16:19], v[4:7], a[184:191], v74
  s_waitcnt lgkmcnt(1)
  v_smfmac_f32_16x16x64_bf16 v[16:19], v[8:11], a[192:199], v74
  ds_read_b128 v[52:55], v75 offset:32768
  s_waitcnt lgkmcnt(1)
  v_smfmac_f32_16x16x64_bf16 v[16:19], v[12:15], a[200:207], v74
  ds_read_b128 v[56:59], v75 offset:33792
  v_smfmac_f32_16x16x64_bf16 v[20:23], v[0:3], a[208:215], v74
  ds_read_b128 v[36:39], v75 offset:34816
  v_smfmac_f32_16x16x64_bf16 v[20:23], v[4:7], a[216:223], v74
  ds_read_b128 v[40:43], v75 offset:35840
  v_cvt_pk_bf16_f32 v16, v16, v17
  v_cvt_pk_bf16_f32 v17, v18, v19
  v_bfi_b32 v16, 1, s72, v16
  v_smfmac_f32_16x16x64_bf16 v[20:23], v[8:11], v[44:51], v74
  ds_read_b128 v[44:47], v75 offset:49152
  buffer_store_dwordx2 v[16:17], v68, s[8:11], s73 offen
  v_smfmac_f32_16x16x64_bf16 v[20:23], v[12:15], v[60:67], v74
  ds_read_b128 v[48:51], v75 offset:50176
  v_smfmac_f32_16x16x64_bf16 v[24:27], v[0:3], a[224:231], v74
  ds_read_b128 v[60:63], v75 offset:51200
  v_smfmac_f32_16x16x64_bf16 v[24:27], v[4:7], a[232:239], v74
  ds_read_b128 v[64:67], v75 offset:52224
  s_waitcnt lgkmcnt(6)
  v_cvt_pk_bf16_f32 v20, v20, v21
  v_cvt_pk_bf16_f32 v21, v22, v23
  v_bfi_b32 v20, 1, s72, v20
  v_smfmac_f32_16x16x64_bf16 v[24:27], v[8:11], v[52:59], v74
  buffer_store_dwordx2 v[20:21], v68, s[8:11], s74 offen
  s_waitcnt lgkmcnt(4)
  v_mov_b64 v[18:19], v[72:73]
  v_smfmac_f32_16x16x64_bf16 v[24:27], v[12:15], v[36:43], v74
  v_mov_b64 v[20:21], 0
  v_smfmac_f32_16x16x64_bf16 v[28:31], v[0:3], a[240:247], v74
  v_mov_b64 v[22:23], 0
  v_smfmac_f32_16x16x64_bf16 v[28:31], v[4:7], a[248:255], v74
  s_waitcnt lgkmcnt(2)
  v_cvt_pk_bf16_f32 v24, v24, v25
  v_cvt_pk_bf16_f32 v25, v26, v27
  v_bfi_b32 v24, 1, s72, v24
  v_smfmac_f32_16x16x64_bf16 v[28:31], v[8:11], v[44:51], v74
  buffer_store_dwordx2 v[24:25], v68, s[8:11], s75 offen
  s_waitcnt lgkmcnt(0)
  v_smfmac_f32_16x16x64_bf16 v[28:31], v[12:15], v[60:67], v74
  ds_read_b64 v[16:17], v77 offset:256
  v_xor_b32 v75, 0x8000, v75
  ds_read_b128 v[52:55], v76 offset:14848
  s_nop 3
  v_cvt_pk_bf16_f32 v28, v28, v29
  v_cvt_pk_bf16_f32 v29, v30, v31
  v_bfi_b32 v28, 1, s72, v28
  buffer_store_dwordx2 v[28:29], v68, s[8:11], s76 offen
  v_mov_b64 v[24:25], 0
  v_mov_b64 v[26:27], 0
  v_mov_b64 v[28:29], 0
  v_mov_b64 v[30:31], 0
  s_add_u32 s58, s58, 655360
  s_add_u32 s59, s59, 655360
  s_add_u32 s70, s70, 655360
  s_add_u32 s68, s68, 655360
  s_add_u32 s66, s66, 1
  s_xor_b32 s64, s64, 16384
  s_xor_b32 s65, s65, 16384
  s_nop 15
  s_nop 7
  buffer_load_dwordx4 v[0:3], v76, s[8:11], s60 offen offset:0 sc1
  buffer_load_dwordx4 v[4:7], v76, s[8:11], s60 offen offset:1024 sc1
  buffer_load_dwordx4 v[8:11], v76, s[8:11], s61 offen offset:0 sc1
  buffer_load_dwordx4 v[12:15], v76, s[8:11], s61 offen offset:1024 sc1
  s_nop 15
  s_nop 11
  buffer_load_dwordx4 v[44:47], v76, s[8:11], s60 offen offset:0 sc1
  buffer_load_dwordx4 v[48:51], v76, s[8:11], s60 offen offset:1024 sc1
  buffer_load_dwordx4 v[60:63], v76, s[8:11], s61 offen offset:0 sc1
  buffer_load_dwordx4 v[64:67], v76, s[8:11], s61 offen offset:1024 sc1
  s_waitcnt vmcnt(7) lgkmcnt(0)
  v_mfma_f32_16x16x32_bf16 v[56:59], v[52:55], v[0:3], 0
  v_bitop3_b32 v72, v0, v2, s72 bitop3:0x7e
  s_waitcnt vmcnt(6)
  v_mfma_f32_16x16x32_bf16 v[56:59], v[52:55], v[4:7], v[56:59]
  v_bitop3_b32 v73, v4, v6, s72 bitop3:0x7e
  v_or_b32 v72, v72, v73
  s_waitcnt vmcnt(5)
  v_mfma_f32_16x16x32_bf16 v[36:39], v[52:55], v[8:11], 0
  v_bitop3_b32 v73, v8, v10, s72 bitop3:0x7e
  v_or_b32 v72, v72, v73
  s_waitcnt vmcnt(4)
  v_mfma_f32_16x16x32_bf16 v[36:39], v[52:55], v[12:15], v[36:39]
  v_bitop3_b32 v73, v12, v14, s72 bitop3:0x7e
  v_bitop3_b32 v72, v72, v73, 1 bitop3:0xa8
  v_cmp_ne_u32 vcc, 0, v72
  s_cbranch_vccnz Cf0_h1r
Cf0_h1p:
  v_add_f32_dpp v56, v56, v56 row_ror:4 row_mask:0xf bank_mask:0xf
  v_add_f32_dpp v57, v57, v57 row_ror:4 row_mask:0xf bank_mask:0xf
  s_nop 0
  v_add_f32_dpp v56, v56, v56 row_ror:8 row_mask:0xf bank_mask:0xf
  v_add_f32_dpp v57, v57, v57 row_ror:8 row_mask:0xf bank_mask:0xf
  v_cvt_pk_bf16_f32 v56, v56, v57
  buffer_store_dword v56, v69, s[8:11], s62 offen
  v_add_f32_dpp v36, v36, v36 row_ror:4 row_mask:0xf bank_mask:0xf
  v_add_f32_dpp v37, v37, v37 row_ror:4 row_mask:0xf bank_mask:0xf
  s_nop 0
  v_add_f32_dpp v36, v36, v36 row_ror:8 row_mask:0xf bank_mask:0xf
  v_add_f32_dpp v37, v37, v37 row_ror:8 row_mask:0xf bank_mask:0xf
  v_cvt_pk_bf16_f32 v36, v36, v37
  buffer_store_dword v36, v70, s[8:11], s63 offen
Cf0_h1ok:
  s_xor_b32 s62, s62, 16384
  s_xor_b32 s63, s63, 16384
  s_xor_b32 s72, s72, 1
  s_nop 15
  s_nop 7
Cf0_h2:
  v_lshlrev_b32 v73, 2, v76
  buffer_load_dwordx4 v[52:55], v76, s[8:11], s64 offen offset:0 sc1
  buffer_load_dwordx4 v[56:59], v76, s[8:11], s64 offen offset:1024 sc1
  buffer_load_dwordx4 v[12:15], v76, s[8:11], s65 offen offset:0 sc1
  s_nop 15
  s_nop 1
  buffer_load_dwordx4 v[52:55], v76, s[8:11], s64 offen offset:0 sc1
  buffer_load_dwordx4 v[56:59], v76, s[8:11], s64 offen offset:1024 sc1
  buffer_load_dwordx4 v[12:15], v76, s[8:11], s65 offen offset:0 sc1
  s_nop 15
  s_nop 1
  buffer_load_dwordx4 v[52:55], v76, s[8:11], s64 offen offset:0 sc1
  buffer_load_dwordx4 v[56:59], v76, s[8:11], s64 offen offset:1024 sc1
  buffer_load_dwordx4 v[12:15], v76, s[8:11], s65 offen offset:0 sc1
  s_waitcnt vmcnt(11)
  ds_read_b128 v[60:63], v76 offset:16384
  ds_read_b128 v[64:67], v76 offset:17408
  ds_read_b128 v[44:47], v76 offset:18432
  ds_read_b128 v[48:51], v76 offset:19456
  ds_read_b128 v[36:39], v76 offset:32768
  ds_read_b128 v[40:43], v76 offset:33792
  s_waitcnt vmcnt(6)
  v_max3_u32 v72, v52, v53, v54
  v_max3_u32 v72, v72, v55, v56
  v_max3_u32 v72, v72, v57, v58
  v_max3_u32 v72, v72, v59, v12
  v_max3_u32 v72, v72, v13, v14
  v_max_u32 v72, v72, v15
  ds_write_b128 v76, v[52:55] offset:4608
  ds_write_b128 v76, v[56:59] offset:5632
  ds_write_b128 v76, v[12:15] offset:12800
  v_cmp_eq_u32 vcc, -1, v72
  s_cbranch_vccnz Cf0_h2r
Cf0_h2w:
  buffer_store_dword v71, v69, s[8:11], s62 offen
  buffer_store_dword v71, v70, s[8:11], s63 offen
  s_branch Cf0_top
Cf0_rec:
  s_nop 7
  s_waitcnt vmcnt(0) lgkmcnt(0)
  v_max3_u32 v72, v0, v1, v2
  v_max3_u32 v72, v72, v3, v4
  v_max3_u32 v72, v72, v5, v6
  v_max3_u32 v72, v72, v7, v8
  v_max3_u32 v72, v72, v9, v10
  v_max3_u32 v72, v72, v11, v12
  v_max3_u32 v72, v72, v13, v14
  v_max3_u32 v72, v72, v15, v16
  v_max3_u32 v72, v72, v17, v18
  v_max_u32 v72, v72, v19
  v_cmp_eq_u32 vcc, -1, v72
  s_cbranch_vccz Cf0_recok
  s_barrier
  v_mov_b64 v[20:21], 0
  v_mov_b64 v[22:23], 0
  v_mov_b64 v[24:25], 0
  v_mov_b64 v[26:27], 0
  v_mov_b64 v[28:29], 0
  v_mov_b64 v[30:31], 0
  v_mov_b64 v[32:33], 0
  v_mov_b64 v[34:35], 0
  s_waitcnt lgkmcnt(0)
  s_barrier
  ds_read_b128 v[0:3], v76 offset:4608
  ds_read_b128 v[60:63], v76 offset:16384
  ds_read_b128 v[64:67], v76 offset:17408
  s_waitcnt lgkmcnt(0)
  v_smfmac_f32_16x16x64_bf16 v[20:23], v[0:3], v[60:67], v74
  ds_read_b128 v[60:63], v76 offset:18432
  ds_read_b128 v[64:67], v76 offset:19456
  s_waitcnt lgkmcnt(0)
  v_smfmac_f32_16x16x64_bf16 v[24:27], v[0:3], v[60:67], v74
  ds_read_b128 v[60:63], v76 offset:32768
  ds_read_b128 v[64:67], v76 offset:33792
  s_waitcnt lgkmcnt(0)
  v_smfmac_f32_16x16x64_bf16 v[28:31], v[0:3], v[60:67], v74
  ds_read_b128 v[60:63], v76 offset:34816
  ds_read_b128 v[64:67], v76 offset:35840
  s_waitcnt lgkmcnt(0)
  v_smfmac_f32_16x16x64_bf16 v[32:35], v[0:3], v[60:67], v74
  ds_read_b128 v[4:7], v76 offset:5632
  s_waitcnt lgkmcnt(0)
  v_smfmac_f32_16x16x64_bf16 v[20:23], v[4:7], v[80:87], v74
  v_smfmac_f32_16x16x64_bf16 v[24:27], v[4:7], v[88:95], v74
  v_smfmac_f32_16x16x64_bf16 v[28:31], v[4:7], v[208:215], v74
  v_smfmac_f32_16x16x64_bf16 v[32:35], v[4:7], v[216:223], v74
  ds_read_b128 v[8:11], v76 offset:6656
  s_waitcnt lgkmcnt(0)
  v_smfmac_f32_16x16x64_bf16 v[20:23], v[8:11], v[96:103], v74
  v_smfmac_f32_16x16x64_bf16 v[24:27], v[8:11], v[104:111], v74
  ds_read_b128 v[60:63], v76 offset:49152
  ds_read_b128 v[64:67], v76 offset:50176
  s_waitcnt lgkmcnt(0)
  v_smfmac_f32_16x16x64_bf16 v[28:31], v[8:11], v[60:67], v74
  ds_read_b128 v[60:63], v76 offset:51200
  ds_read_b128 v[64:67], v76 offset:52224
  s_waitcnt lgkmcnt(0)
  v_smfmac_f32_16x16x64_bf16 v[32:35], v[8:11], v[60:67], v74
  ds_read_b128 v[12:15], v76 offset:7680
  s_waitcnt lgkmcnt(0)
  v_smfmac_f32_16x16x64_bf16 v[20:23], v[12:15], v[112:119], v74
  v_smfmac_f32_16x16x64_bf16 v[24:27], v[12:15], v[120:127], v74
  v_smfmac_f32_16x16x64_bf16 v[28:31], v[12:15], v[224:231], v74
  v_smfmac_f32_16x16x64_bf16 v[32:35], v[12:15], v[232:239], v74
  ds_read_b128 v[4:7], v76 offset:8704
  s_waitcnt lgkmcnt(0)
  v_smfmac_f32_16x16x64_bf16 v[20:23], v[4:7], v[128:135], v74
  v_smfmac_f32_16x16x64_bf16 v[24:27], v[4:7], v[136:143], v74
  ds_read_b128 v[60:63], v75 offset:16384
  ds_read_b128 v[64:67], v75 offset:17408
  s_waitcnt lgkmcnt(0)
  v_smfmac_f32_16x16x64_bf16 v[28:31], v[4:7], v[60:67], v74
  ds_read_b128 v[60:63], v75 offset:18432
  ds_read_b128 v[64:67], v75 offset:19456
  s_waitcnt lgkmcnt(0)
  v_smfmac_f32_16x16x64_bf16 v[32:35], v[4:7], v[60:67], v74
  ds_read_b128 v[16:19], v76 offset:9728
  s_waitcnt lgkmcnt(0)
  v_smfmac_f32_16x16x64_bf16 v[20:23], v[16:19], v[144:151], v74
  v_smfmac_f32_16x16x64_bf16 v[24:27], v[16:19], v[152:159], v74
  v_smfmac_f32_16x16x64_bf16 v[28:31], v[16:19], v[240:247], v74
  v_smfmac_f32_16x16x64_bf16 v[32:35], v[16:19], v[248:255], v74
  ds_read_b128 v[12:15], v76 offset:10752
  s_waitcnt lgkmcnt(0)
  v_smfmac_f32_16x16x64_bf16 v[20:23], v[12:15], v[160:167], v74
  v_smfmac_f32_16x16x64_bf16 v[24:27], v[12:15], v[168:175], v74
  v_smfmac_f32_16x16x64_bf16 v[28:31], v[12:15], a[0:7], v74
  v_smfmac_f32_16x16x64_bf16 v[32:35], v[12:15], a[8:15], v74
  ds_read_b128 v[8:11], v76 offset:11776
  s_waitcnt lgkmcnt(0)
  v_smfmac_f32_16x16x64_bf16 v[20:23], v[8:11], v[176:183], v74
  v_smfmac_f32_16x16x64_bf16 v[24:27], v[8:11], v[184:191], v74
  v_smfmac_f32_16x16x64_bf16 v[28:31], v[8:11], a[16:23], v74
  v_smfmac_f32_16x16x64_bf16 v[32:35], v[8:11], a[24:31], v74
  ds_read_b128 v[0:3], v76 offset:12800
  s_waitcnt lgkmcnt(0)
  v_smfmac_f32_16x16x64_bf16 v[20:23], v[0:3], v[192:199], v74
  v_smfmac_f32_16x16x64_bf16 v[24:27], v[0:3], v[200:207], v74
  ds_read_b128 v[60:63], v75 offset:0
  ds_read_b128 v[64:67], v75 offset:1024
  s_waitcnt lgkmcnt(0)
  v_smfmac_f32_16x16x64_bf16 v[28:31], v[0:3], v[60:67], v74
  ds_read_b128 v[60:63], v75 offset:2048
  ds_read_b128 v[64:67], v75 offset:3072
  s_waitcnt lgkmcnt(0)
  v_smfmac_f32_16x16x64_bf16 v[32:35], v[0:3], v[60:67], v74
  v_add_f32 v20, v20, v22
  v_add_f32 v21, v21, v23
  v_add_f32 v24, v24, v26
  v_cvt_pk_bf16_f32 v22, v20, v24
  ds_write_b32 v79, v22 offset:0
  v_add_f32 v25, v25, v27
  v_cvt_pk_bf16_f32 v23, v21, v25
  ds_write_b32 v79, v23 offset:576
  v_add_f32 v28, v28, v30
  v_add_f32 v29, v29, v31
  s_waitcnt lgkmcnt(0)
  s_nop 1
  s_branch Cf0_recok
Cf0_mx:
  s_waitcnt lgkmcnt(0)
  s_barrier
  buffer_load_dwordx4 v[0:3], v76, s[8:11], s58 offen offset:0 sc1
  ds_read_b128 v[20:23], v77 offset:0
  ds_read_b128 v[28:31], v77 offset:256
  buffer_load_dwordx4 v[4:7], v76, s[8:11], s58 offen offset:1024 sc1
  ds_read_b128 v[24:27], v77 offset:128
  ds_read_b128 v[32:35], v77 offset:384
  s_waitcnt vmcnt(1) lgkmcnt(3)
  v_mfma_f32_16x16x32_bf16 v[8:11], v[0:3], v[20:23], 0
  s_waitcnt vmcnt(0) lgkmcnt(1)
  v_mfma_f32_16x16x32_bf16 v[8:11], v[4:7], v[24:27], v[8:11]
  v_mfma_f32_16x16x32_bf16 v[12:15], v[28:31], v[20:23], 0
  s_waitcnt lgkmcnt(0)
  v_mfma_f32_16x16x32_bf16 v[12:15], v[32:35], v[24:27], v[12:15]
  v_add_f32_dpp v8, v10, v8 quad_perm:[2,3,0,1] row_mask:0xf bank_mask:0xf
  v_add_f32_dpp v9, v11, v9 quad_perm:[2,3,0,1] row_mask:0xf bank_mask:0xf
  s_nop 0
  v_mov_b32_dpp v8, v8 quad_perm:[0,1,0,1] row_mask:0xf bank_mask:0xf
  v_mov_b32_dpp v9, v9 quad_perm:[0,1,0,1] row_mask:0xf bank_mask:0xf
  s_nop 1
  v_add_f32_dpp v12, v14, v12 quad_perm:[2,3,0,1] row_mask:0xf bank_mask:0xf
  v_add_f32_dpp v13, v15, v13 quad_perm:[2,3,0,1] row_mask:0xf bank_mask:0xf
  s_nop 0
  v_mov_b32_dpp v12, v12 quad_perm:[0,1,0,1] row_mask:0xf bank_mask:0xf
  v_mov_b32_dpp v13, v13 quad_perm:[0,1,0,1] row_mask:0xf bank_mask:0xf
  v_mul_f32 v12, s69, v12
  ds_write_b32 v78, v8 offset:8704
  v_mul_f32 v13, s69, v13
  ds_write_b32 v78, v9 offset:8768
  s_waitcnt lgkmcnt(0)
  s_barrier
  ds_read_b128 v[36:39], v78 offset:8704
  ds_read_b128 v[40:43], v78 offset:8768
  s_waitcnt lgkmcnt(0)
  s_barrier
  v_max_f32 v16, v36, v37
  v_max3_f32 v16, v16, v38, v39
  v_max3_f32 v16, v16, v40, v41
  v_max3_f32 v16, v16, v42, v43
  v_max3_f32 v16, v16, v12, v13
  v_mov_b32 v17, v16
  s_nop 1
  v_permlane16_swap_b32 v16, v17
  v_max_f32 v16, v16, v17
  v_mov_b32 v17, v16
  s_nop 1
  v_permlane32_swap_b32 v16, v17
  v_max_f32 v16, v16, v17
  v_sub_f32 v36, v36, v16
  v_sub_f32 v37, v37, v16
  v_sub_f32 v38, v38, v16
  v_sub_f32 v39, v39, v16
  v_sub_f32 v40, v40, v16
  v_sub_f32 v41, v41, v16
  v_sub_f32 v42, v42, v16
  v_sub_f32 v43, v43, v16
  v_sub_f32 v12, v12, v16
  v_sub_f32 v13, v13, v16
  v_exp_f32 v36, v36
  v_exp_f32 v37, v37
  v_exp_f32 v38, v38
  v_exp_f32 v39, v39
  v_exp_f32 v40, v40
  v_exp_f32 v41, v41
  v_exp_f32 v42, v42
  v_exp_f32 v43, v43
  v_exp_f32 v12, v12
  v_exp_f32 v13, v13
  v_cvt_pk_bf16_f32 v32, v36, v40
  v_cvt_pk_bf16_f32 v33, v37, v41
  v_cvt_pk_bf16_f32 v34, v38, v42
  v_cvt_pk_bf16_f32 v35, v39, v43
  v_cvt_pk_bf16_f32 v28, v12, v13
  v_cvt_pk_bf16_f32 v31, v12, v13
  v_mov_b32 v29, 0
  v_mov_b32 v30, 0
  v_mov_b32 v68, 0x3f803f80
  v_mov_b32 v69, 0x3f803f80
  v_mov_b32 v70, 0x3f803f80
  v_mov_b32 v71, 0x3f803f80
  s_nop 1
  v_mfma_f32_16x16x32_bf16 v[8:11], v[32:35], v[68:71], 0
  v_mfma_f32_16x16x32_bf16 v[0:3], v[32:35], v[52:55], 0
  v_mfma_f32_16x16x32_bf16 v[4:7], v[32:35], v[56:59], 0
  v_mfma_f32_16x16x16_bf16 v[8:11], v[28:29], v[68:69], v[8:11]
  v_mfma_f32_16x16x16_bf16 v[0:3], v[28:29], v[72:73], v[0:3]
  v_mfma_f32_16x16x16_bf16 v[4:7], v[30:31], v[72:73], v[4:7]
  ds_read_b128 v[68:71], v76 offset:13824
  v_rcp_f32 v10, v8
  v_rcp_f32 v11, v9
  v_mul_f32 v0, v10, v0
  v_mul_f32 v1, v11, v1
  s_nop 0
  v_mul_f32 v4, v10, v4
  v_mul_f32 v5, v11, v5
  v_cvt_pk_bf16_f32 v2, v0, v4
  ds_write_b32 v79, v2 offset:8704
  v_cvt_pk_bf16_f32 v3, v1, v5
  ds_write_b32 v79, v3 offset:9280
  v_mov_b64 v[16:17], 0
  v_mov_b64 v[18:19], 0
  v_mov_b64 v[20:21], 0
  v_mov_b64 v[22:23], 0
  s_branch Cf0_mxok
Cf0_h1r:
  s_mov_b64 exec, vcc
  buffer_load_dwordx4 v[0:3], v76, s[8:11], s60 offen offset:0 sc1
  buffer_load_dwordx4 v[4:7], v76, s[8:11], s60 offen offset:1024 sc1
  buffer_load_dwordx4 v[8:11], v76, s[8:11], s61 offen offset:0 sc1
  buffer_load_dwordx4 v[12:15], v76, s[8:11], s61 offen offset:1024 sc1
  s_mov_b64 exec, -1
  s_add_u32 s67, s67, 1
  s_waitcnt vmcnt(7)
  v_mfma_f32_16x16x32_bf16 v[56:59], v[52:55], v[44:47], 0
  v_bitop3_b32 v72, v44, v46, s72 bitop3:0x7e
  s_waitcnt vmcnt(6)
  v_mfma_f32_16x16x32_bf16 v[56:59], v[52:55], v[48:51], v[56:59]
  v_bitop3_b32 v73, v48, v50, s72 bitop3:0x7e
  v_or_b32 v72, v72, v73
  s_waitcnt vmcnt(5)
  v_mfma_f32_16x16x32_bf16 v[36:39], v[52:55], v[60:63], 0
  v_bitop3_b32 v73, v60, v62, s72 bitop3:0x7e
  v_or_b32 v72, v72, v73
  s_waitcnt vmcnt(4)
  v_mfma_f32_16x16x32_bf16 v[36:39], v[52:55], v[64:67], v[36:39]
  v_bitop3_b32 v73, v64, v66, s72 bitop3:0x7e
  v_bitop3_b32 v72, v72, v73, 1 bitop3:0xa8
  v_cmp_ne_u32 vcc, 0, v72
  s_cbranch_vccz Cf0_h1p
  s_mov_b64 exec, vcc
  buffer_load_dwordx4 v[44:47], v76, s[8:11], s60 offen offset:0 sc1
  buffer_load_dwordx4 v[48:51], v76, s[8:11], s60 offen offset:1024 sc1
  buffer_load_dwordx4 v[60:63], v76, s[8:11], s61 offen offset:0 sc1
  buffer_load_dwordx4 v[64:67], v76, s[8:11], s61 offen offset:1024 sc1
  s_mov_b64 exec, -1
  s_add_u32 s67, s67, 1
  s_waitcnt vmcnt(7)
  v_mfma_f32_16x16x32_bf16 v[56:59], v[52:55], v[0:3], 0
  v_bitop3_b32 v72, v0, v2, s72 bitop3:0x7e
  s_waitcnt vmcnt(6)
  v_mfma_f32_16x16x32_bf16 v[56:59], v[52:55], v[4:7], v[56:59]
  v_bitop3_b32 v73, v4, v6, s72 bitop3:0x7e
  v_or_b32 v72, v72, v73
  s_waitcnt vmcnt(5)
  v_mfma_f32_16x16x32_bf16 v[36:39], v[52:55], v[8:11], 0
  v_bitop3_b32 v73, v8, v10, s72 bitop3:0x7e
  v_or_b32 v72, v72, v73
  s_waitcnt vmcnt(4)
  v_mfma_f32_16x16x32_bf16 v[36:39], v[52:55], v[12:15], v[36:39]
  v_bitop3_b32 v73, v12, v14, s72 bitop3:0x7e
  v_bitop3_b32 v72, v72, v73, 1 bitop3:0xa8
  v_cmp_ne_u32 vcc, 0, v72
  s_cbranch_vccz Cf0_h1p
  s_cmp_lt_u32 s67, 131072
  s_cbranch_scc1 Cf0_h1r
  s_branch Cf0_h1p
Cf0_h2r:
Cf0_h2s:
  s_mov_b64 exec, vcc
  buffer_load_dwordx4 v[52:55], v76, s[8:11], s64 offen offset:0 sc1
  buffer_load_dwordx4 v[56:59], v76, s[8:11], s64 offen offset:1024 sc1
  buffer_load_dwordx4 v[12:15], v76, s[8:11], s65 offen offset:0 sc1
  s_mov_b64 exec, -1
  s_add_u32 s67, s67, 1
  s_waitcnt vmcnt(6)
  v_max3_u32 v72, v52, v53, v54
  v_max3_u32 v72, v72, v55, v56
  v_max3_u32 v72, v72, v57, v58
  v_max3_u32 v72, v72, v59, v12
  v_max3_u32 v72, v72, v13, v14
  v_max_u32 v72, v72, v15
  v_cmp_eq_u32 vcc, -1, v72
  s_cbranch_vccz Cf0_h2ok
  s_mov_b64 exec, vcc
  buffer_load_dwordx4 v[52:55], v76, s[8:11], s64 offen offset:0 sc1
  buffer_load_dwordx4 v[56:59], v76, s[8:11], s64 offen offset:1024 sc1
  buffer_load_dwordx4 v[12:15], v76, s[8:11], s65 offen offset:0 sc1
  s_mov_b64 exec, -1
  s_add_u32 s67, s67, 1
  s_waitcnt vmcnt(6)
  v_max3_u32 v72, v52, v53, v54
  v_max3_u32 v72, v72, v55, v56
  v_max3_u32 v72, v72, v57, v58
  v_max3_u32 v72, v72, v59, v12
  v_max3_u32 v72, v72, v13, v14
  v_max_u32 v72, v72, v15
  v_cmp_eq_u32 vcc, -1, v72
  s_cbranch_vccz Cf0_h2ok
  s_mov_b64 exec, vcc
  buffer_load_dwordx4 v[52:55], v76, s[8:11], s64 offen offset:0 sc1
  buffer_load_dwordx4 v[56:59], v76, s[8:11], s64 offen offset:1024 sc1
  buffer_load_dwordx4 v[12:15], v76, s[8:11], s65 offen offset:0 sc1
  s_mov_b64 exec, -1
  s_add_u32 s67, s67, 1
  s_waitcnt vmcnt(6)
  v_max3_u32 v72, v52, v53, v54
  v_max3_u32 v72, v72, v55, v56
  v_max3_u32 v72, v72, v57, v58
  v_max3_u32 v72, v72, v59, v12
  v_max3_u32 v72, v72, v13, v14
  v_max_u32 v72, v72, v15
  v_cmp_eq_u32 vcc, -1, v72
  s_cbranch_vccz Cf0_h2ok
  s_mov_b64 exec, vcc
  buffer_load_dwordx4 v[52:55], v76, s[8:11], s64 offen offset:0 sc1
  buffer_load_dwordx4 v[56:59], v76, s[8:11], s64 offen offset:1024 sc1
  buffer_load_dwordx4 v[12:15], v76, s[8:11], s65 offen offset:0 sc1
  s_mov_b64 exec, -1
  s_add_u32 s67, s67, 1
  s_waitcnt vmcnt(6)
  v_max3_u32 v72, v52, v53, v54
  v_max3_u32 v72, v72, v55, v56
  v_max3_u32 v72, v72, v57, v58
  v_max3_u32 v72, v72, v59, v12
  v_max3_u32 v72, v72, v13, v14
  v_max_u32 v72, v72, v15
  v_cmp_eq_u32 vcc, -1, v72
  s_cbranch_vccz Cf0_h2ok
  s_cmp_lt_u32 s67, 131072
  s_cbranch_scc1 Cf0_h2s
Cf0_h2ok:
  ds_write_b128 v76, v[52:55] offset:4608
  ds_write_b128 v76, v[56:59] offset:5632
  ds_write_b128 v76, v[12:15] offset:12800
  s_branch Cf0_h2w
Cf0_last:
  s_nop 7
  s_waitcnt vmcnt(0) lgkmcnt(0)
  ds_read_b64 v[16:17], v77 offset:256
  v_mov_b64 v[18:19], v[72:73]
  s_add_u32 s68, s68, 655360
  s_waitcnt lgkmcnt(0)
  buffer_store_dwordx4 v[16:19], v76, s[8:11], s68 offen sc1
  s_waitcnt vmcnt(0)
  s_barrier
  s_branch L_cexit
L_w1:
  v_mov_b64 v[20:21], 0
  v_mov_b64 v[22:23], 0
  v_mov_b64 v[24:25], 0
  v_mov_b64 v[26:27], 0
  v_mov_b64 v[28:29], 0
  v_mov_b64 v[30:31], 0
  v_mov_b64 v[32:33], 0
  v_mov_b64 v[34:35], 0
  s_mov_b32 m0, 15872
  v_lshlrev_b32 v73, 2, v76
  v_mov_b32 v72, 0
  ds_read_b128 v[60:63], v76 offset:20480
  ds_read_b128 v[64:67], v76 offset:21504
  ds_read_b128 v[44:47], v76 offset:22528
  ds_read_b128 v[48:51], v76 offset:23552
  ds_read_b128 v[36:39], v76 offset:36864
  ds_read_b128 v[40:43], v76 offset:37888
  ds_read_b128 v[0:3], v76 offset:4608
  ds_read_b128 v[4:7], v76 offset:5632
  s_branch Cf1_top2
.p2align 6
Cf1_top:
  s_waitcnt lgkmcnt(0)
  s_barrier
  ds_read_b128 v[0:3], v76 offset:4608
  ds_read_b128 v[4:7], v76 offset:5632
Cf1_top2:
  s_waitcnt lgkmcnt(1)
  v_smfmac_f32_16x16x64_bf16 v[20:23], v[0:3], v[60:67], v74
  ds_read_b128 v[60:63], v76 offset:38912
  v_smfmac_f32_16x16x64_bf16 v[24:27], v[0:3], v[44:51], v74
  ds_read_b128 v[64:67], v76 offset:39936
  s_waitcnt lgkmcnt(2)
  v_smfmac_f32_16x16x64_bf16 v[20:23], v[4:7], v[80:87], v74
  buffer_load_dwordx4 v[44:47], v76, s[8:11], s58 offen offset:0 sc1
  ds_read_b128 v[8:11], v76 offset:6656
  v_smfmac_f32_16x16x64_bf16 v[28:31], v[0:3], v[36:43], v74
  ds_read_b128 v[36:39], v76 offset:53248
  v_smfmac_f32_16x16x64_bf16 v[24:27], v[4:7], v[88:95], v74
  buffer_load_dwordx4 v[48:51], v76, s[8:11], s58 offen offset:1024 sc1
  ds_read_b128 v[40:43], v76 offset:54272
  v_smfmac_f32_16x16x64_bf16 v[28:31], v[4:7], v[208:215], v74
  ds_read_b128 v[12:15], v76 offset:7680
  v_smfmac_f32_16x16x64_bf16 v[32:35], v[4:7], v[216:223], v74
  buffer_load_dwordx4 v[52:55], v76, s[8:11], s59 offen offset:0 sc1
  s_waitcnt lgkmcnt(4)
  v_smfmac_f32_16x16x64_bf16 v[32:35], v[0:3], v[60:67], v74
  ds_read_b128 v[60:63], v76 offset:55296
  s_waitcnt lgkmcnt(4)
  v_smfmac_f32_16x16x64_bf16 v[20:23], v[8:11], v[96:103], v74
  buffer_load_dwordx4 v[56:59], v76, s[8:11], s59 offen offset:1024 sc1
  ds_read_b128 v[64:67], v76 offset:56320
  v_smfmac_f32_16x16x64_bf16 v[24:27], v[8:11], v[104:111], v74
  ds_read_b128 v[0:3], v76 offset:12800
  s_waitcnt lgkmcnt(4)
  v_smfmac_f32_16x16x64_bf16 v[28:31], v[8:11], v[36:43], v74
  ds_read_b128 v[36:39], v75 offset:4096
  s_waitcnt lgkmcnt(4)
  v_smfmac_f32_16x16x64_bf16 v[20:23], v[12:15], v[112:119], v74
  buffer_store_dwordx4 v[16:19], v76, s[8:11], s68 offen sc1
  ds_read_b128 v[40:43], v75 offset:5120
  v_smfmac_f32_16x16x64_bf16 v[24:27], v[12:15], v[120:127], v74
  buffer_load_dword v73, s[8:11], s70 offen lds
  s_waitcnt lgkmcnt(3)
  v_smfmac_f32_16x16x64_bf16 v[32:35], v[8:11], v[60:67], v74
  ds_read_b128 v[60:63], v75 offset:6144
  v_smfmac_f32_16x16x64_bf16 v[28:31], v[12:15], v[224:231], v74
  ds_read_b128 v[64:67], v75 offset:7168
  v_smfmac_f32_16x16x64_bf16 v[32:35], v[12:15], v[232:239], v74
  s_barrier
  s_waitcnt lgkmcnt(4)
  v_smfmac_f32_16x16x64_bf16 v[20:23], v[0:3], v[192:199], v74
  ds_read_b128 v[4:7], v76 offset:8704
  s_waitcnt lgkmcnt(3)
  v_smfmac_f32_16x16x64_bf16 v[28:31], v[0:3], v[36:43], v74
  ds_read_b128 v[16:19], v76 offset:9728
  v_smfmac_f32_16x16x64_bf16 v[24:27], v[0:3], v[200:207], v74
  ds_read_b128 v[36:39], v75 offset:20480
  s_waitcnt lgkmcnt(3)
  v_mov_b32 v68, 0x3f803f80
  v_smfmac_f32_16x16x64_bf16 v[32:35], v[0:3], v[60:67], v74
  ds_read_b128 v[40:43], v75 offset:21504
  s_waitcnt lgkmcnt(3)
  v_smfmac_f32_16x16x64_bf16 v[20:23], v[4:7], v[128:135], v74
  ds_read_b128 v[12:15], v76 offset:10752
  v_mov_b32 v69, 0x3f803f80
  v_smfmac_f32_16x16x64_bf16 v[24:27], v[4:7], v[136:143], v74
  ds_read_b128 v[8:11], v76 offset:11776
  s_waitcnt lgkmcnt(4)
  v_smfmac_f32_16x16x64_bf16 v[20:23], v[16:19], v[144:151], v74
  ds_read_b128 v[60:63], v75 offset:22528
  v_mov_b64 v[70:71], v[68:69]
  v_smfmac_f32_16x16x64_bf16 v[24:27], v[16:19], v[152:159], v74
  ds_read_b128 v[64:67], v75 offset:23552
  s_waitcnt lgkmcnt(4)
  v_smfmac_f32_16x16x64_bf16 v[28:31], v[4:7], v[36:43], v74
  s_waitcnt lgkmcnt(3)
  v_mov_b64 v[36:37], 0
  v_smfmac_f32_16x16x64_bf16 v[20:23], v[12:15], v[160:167], v74
  s_waitcnt lgkmcnt(2)
  v_mov_b64 v[38:39], 0
  v_smfmac_f32_16x16x64_bf16 v[20:23], v[8:11], v[176:183], v74
  v_mov_b64 v[40:41], 0
  v_smfmac_f32_16x16x64_bf16 v[24:27], v[12:15], v[168:175], v74
  v_mov_b64 v[42:43], 0
  v_smfmac_f32_16x16x64_bf16 v[24:27], v[8:11], v[184:191], v74
  s_waitcnt lgkmcnt(0)
  v_add_f32 v20, v20, v22
  v_smfmac_f32_16x16x64_bf16 v[32:35], v[4:7], v[60:67], v74
  v_add_f32 v21, v21, v23
  v_smfmac_f32_16x16x64_bf16 v[28:31], v[16:19], v[240:247], v74
  v_add_f32 v24, v24, v26
  v_cvt_pk_bf16_f32 v22, v20, v24
  v_smfmac_f32_16x16x64_bf16 v[28:31], v[12:15], a[0:7], v74
  ds_write_b32 v79, v22 offset:0
  v_add_f32 v25, v25, v27
  v_cvt_pk_bf16_f32 v23, v21, v25
  v_smfmac_f32_16x16x64_bf16 v[28:31], v[8:11], a[16:23], v74
  ds_write_b32 v79, v23 offset:576
  v_cmp_u_f32 vcc, v20, v21
  v_smfmac_f32_16x16x64_bf16 v[32:35], v[16:19], v[248:255], v74
  s_mov_b64 exec, 1
  buffer_store_dword v72, v76, s[8:11], s71 offen sc1
  s_mov_b64 exec, -1
  v_smfmac_f32_16x16x64_bf16 v[32:35], v[12:15], a[8:15], v74
  v_add_f32 v28, v28, v30
  v_add_f32 v29, v29, v31
  v_smfmac_f32_16x16x64_bf16 v[32:35], v[8:11], a[24:31], v74
  s_cbranch_vccnz Cf1_rec
Cf1_recok:
  v_smfmac_f32_16x16x64_bf16 v[36:39], v[16:19], a[112:119], v74
  s_waitcnt lgkmcnt(0)
  s_barrier
  ds_read_b128 v[60:63], v77
  v_smfmac_f32_16x16x64_bf16 v[40:43], v[16:19], a[120:127], v74
  ds_read_b128 v[64:67], v77 offset:128
  v_add_f32 v32, v32, v34
  v_cvt_pk_bf16_f32 v30, v28, v32
  v_smfmac_f32_16x16x64_bf16 v[36:39], v[0:3], a[160:167], v74
  ds_write_b32 v79, v30 offset:256
  v_add_f32 v33, v33, v35
  v_cvt_pk_bf16_f32 v31, v29, v33
  v_smfmac_f32_16x16x64_bf16 v[40:43], v[0:3], a[168:175], v74
  ds_write_b32 v79, v31 offset:832
  v_xor_b32 v75, 0x8000, v75
  v_smfmac_f32_16x16x64_bf16 v[36:39], v[4:7], a[96:103], v74
  ds_read_b128 v[0:3], v76 offset:4608
  v_mov_b32 v29, 0
  v_smfmac_f32_16x16x64_bf16 v[40:43], v[4:7], a[104:111], v74
  s_waitcnt vmcnt(5) lgkmcnt(3)
  v_mov_b32 v30, 0
  v_mfma_f32_16x16x32_bf16 v[44:47], v[44:47], v[60:63], 0
  ds_read_b128 v[4:7], v76 offset:5632
  s_waitcnt lgkmcnt(2)
  v_mfma_f32_16x16x32_bf16 v[44:47], v[48:51], v[64:67], v[44:47]
  s_barrier
  v_smfmac_f32_16x16x64_bf16 v[36:39], v[8:11], a[144:151], v74
  ds_read_b128 v[20:23], v77 offset:256
  ds_read_b128 v[24:27], v77 offset:384
  v_smfmac_f32_16x16x64_bf16 v[40:43], v[8:11], a[152:159], v74
  ds_read_b128 v[8:11], v76 offset:6656
  v_add_f32_dpp v72, v46, v44 quad_perm:[2,3,0,1] row_mask:0xf bank_mask:0xf
  v_add_f32_dpp v73, v47, v45 quad_perm:[2,3,0,1] row_mask:0xf bank_mask:0xf
  v_smfmac_f32_16x16x64_bf16 v[36:39], v[12:15], a[128:135], v74
  ds_read_b128 v[44:47], v75 offset:20480
  v_exp_f32_dpp v72, v72 quad_perm:[0,1,0,1] row_mask:0xf bank_mask:0xf
  v_smfmac_f32_16x16x64_bf16 v[40:43], v[12:15], a[136:143], v74
  ds_read_b128 v[12:15], v76 offset:7680
  s_waitcnt lgkmcnt(6)
  v_exp_f32_dpp v73, v73 quad_perm:[0,1,0,1] row_mask:0xf bank_mask:0xf
  v_smfmac_f32_16x16x64_bf16 v[36:39], v[0:3], a[32:39], v74
  s_waitcnt lgkmcnt(3)
  v_cvt_pk_bf16_f32 v72, v72, v73
  v_mfma_f32_16x16x32_bf16 v[20:23], v[20:23], v[60:63], 0
  ds_write_b32 v78, v72 offset:516
  v_mfma_f32_16x16x32_bf16 v[20:23], v[24:27], v[64:67], v[20:23]
  ds_read_b128 v[48:51], v75 offset:21504
  v_smfmac_f32_16x16x64_bf16 v[40:43], v[0:3], a[40:47], v74
  ds_read_b128 v[60:63], v75 offset:22528
  v_smfmac_f32_16x16x64_bf16 v[36:39], v[4:7], a[48:55], v74
  s_waitcnt lgkmcnt(5)
  v_add_f32_dpp v24, v22, v20 quad_perm:[2,3,0,1] row_mask:0xf bank_mask:0xf
  v_add_f32_dpp v25, v23, v21 quad_perm:[2,3,0,1] row_mask:0xf bank_mask:0xf
  v_smfmac_f32_16x16x64_bf16 v[36:39], v[8:11], a[64:71], v74
  s_waitcnt lgkmcnt(2)
  s_barrier
  ds_read_b128 v[32:35], v78 offset:512
  v_smfmac_f32_16x16x64_bf16 v[36:39], v[12:15], a[80:87], v74
  ds_read_b128 v[64:67], v75 offset:23552
  v_mul_f32 v24, s69, v24
  v_smfmac_f32_16x16x64_bf16 v[40:43], v[4:7], a[56:63], v74
  v_mul_f32 v25, s69, v25
  v_smfmac_f32_16x16x64_bf16 v[40:43], v[8:11], a[72:79], v74
  v_exp_f32_dpp v24, v24 quad_perm:[0,1,0,1] row_mask:0xf bank_mask:0xf
  v_smfmac_f32_16x16x64_bf16 v[40:43], v[12:15], a[88:95], v74
  s_waitcnt vmcnt(3) lgkmcnt(1)
  v_exp_f32_dpp v25, v25 quad_perm:[0,1,0,1] row_mask:0xf bank_mask:0xf
  v_mfma_f32_16x16x32_bf16 v[8:11], v[32:35], v[68:71], 0
  v_add_f32 v36, v36, v38
  v_add_f32 v37, v37, v39
  v_mfma_f32_16x16x32_bf16 v[0:3], v[32:35], v[52:55], 0
  v_add_f32 v40, v40, v42
  v_add_f32 v41, v41, v43
  v_mfma_f32_16x16x32_bf16 v[4:7], v[32:35], v[56:59], 0
  v_cvt_pk_bf16_f32 v28, v24, v25
  v_cvt_pk_bf16_f32 v72, v36, v37
  v_cvt_pk_bf16_f32 v73, v40, v41
  v_mfma_f32_16x16x16_bf16 v[8:11], v[28:29], v[68:69], v[8:11]
  v_cvt_pk_bf16_f32 v31, v24, v25
  v_mfma_f32_16x16x16_bf16 v[0:3], v[28:29], v[72:73], v[0:3]
  ds_read_b128 v[68:71], v76 offset:13824
  v_mfma_f32_16x16x16_bf16 v[4:7], v[30:31], v[72:73], v[4:7]
  v_rcp_f32 v10, v8
  v_rcp_f32 v11, v9
  v_mul_f32 v0, v10, v0
  v_mul_f32 v1, v11, v1
  s_nop 0
  v_mul_f32 v4, v10, v4
  v_mul_f32 v5, v11, v5
  v_cvt_pk_bf16_f32 v2, v0, v4
  ds_write_b32 v79, v2 offset:8704
  v_cvt_pk_bf16_f32 v3, v1, v5
  ds_write_b32 v79, v3 offset:9280
  v_subrev_u32 v8, 813694976, v8
  v_subrev_u32 v9, 813694976, v9
  v_max_u32 v8, v8, v9
  v_cmp_le_u32 vcc, 503316480, v8
  v_mov_b64 v[16:17], 0
  v_mov_b64 v[18:19], 0
  v_mov_b64 v[20:21], 0
  v_mov_b64 v[22:23], 0
  s_cbranch_vccnz Cf1_mx
Cf1_mxok:
  s_cmp_eq_u32 s66, 63
  s_waitcnt lgkmcnt(0)
  s_barrier
  ds_read_b128 v[0:3], v78 offset:8704
  ds_read_b128 v[4:7], v78 offset:8768
  ds_read_b128 v[8:11], v78 offset:8832
  ds_read_b128 v[12:15], v78 offset:8896
  v_mov_b64 v[24:25], 0
  v_mov_b64 v[26:27], 0
  v_mov_b64 v[28:29], 0
  v_mov_b64 v[30:31], 0
  v_mov_b64 v[32:33], 0
  v_mov_b64 v[34:35], 0
  s_waitcnt lgkmcnt(3)
  v_smfmac_f32_16x16x64_bf16 v[16:19], v[0:3], a[176:183], v74
  s_cbranch_scc1 Cf1_last
  s_waitcnt lgkmcnt(2)
  v_smfmac_f32_16x16x64_bf16 v[16:19], v[4:7], a[184:191], v74
  s_waitcnt lgkmcnt(1)
  v_smfmac_f32_16x16x64_bf16 v[16:19], v[8:11], a[192:199], v74
  ds_read_b128 v[52:55], v75 offset:36864
  s_waitcnt lgkmcnt(1)
  v_smfmac_f32_16x16x64_bf16 v[16:19], v[12:15], a[200:207], v74
  ds_read_b128 v[56:59], v75 offset:37888
  v_smfmac_f32_16x16x64_bf16 v[20:23], v[0:3], a[208:215], v74
  ds_read_b128 v[36:39], v75 offset:38912
  v_smfmac_f32_16x16x64_bf16 v[20:23], v[4:7], a[216:223], v74
  ds_read_b128 v[40:43], v75 offset:39936
  v_cvt_pk_bf16_f32 v16, v16, v17
  v_cvt_pk_bf16_f32 v17, v18, v19
  v_bfi_b32 v16, 1, s72, v16
  v_smfmac_f32_16x16x64_bf16 v[20:23], v[8:11], v[44:51], v74
  ds_read_b128 v[44:47], v75 offset:53248
  buffer_store_dwordx2 v[16:17], v68, s[8:11], s73 offen
  v_smfmac_f32_16x16x64_bf16 v[20:23], v[12:15], v[60:67], v74
  ds_read_b128 v[48:51], v75 offset:54272
  v_smfmac_f32_16x16x64_bf16 v[24:27], v[0:3], a[224:231], v74
  ds_read_b128 v[60:63], v75 offset:55296
  v_smfmac_f32_16x16x64_bf16 v[24:27], v[4:7], a[232:239], v74
  ds_read_b128 v[64:67], v75 offset:56320
  s_waitcnt lgkmcnt(6)
  v_cvt_pk_bf16_f32 v20, v20, v21
  v_cvt_pk_bf16_f32 v21, v22, v23
  v_bfi_b32 v20, 1, s72, v20
  v_smfmac_f32_16x16x64_bf16 v[24:27], v[8:11], v[52:59], v74
  buffer_store_dwordx2 v[20:21], v68, s[8:11], s74 offen
  s_waitcnt lgkmcnt(4)
  v_mov_b64 v[18:19], v[72:73]
  v_smfmac_f32_16x16x64_bf16 v[24:27], v[12:15], v[36:43], v74
  v_mov_b64 v[20:21], 0
  v_smfmac_f32_16x16x64_bf16 v[28:31], v[0:3], a[240:247], v74
  v_mov_b64 v[22:23], 0
  v_smfmac_f32_16x16x64_bf16 v[28:31], v[4:7], a[248:255], v74
  s_waitcnt lgkmcnt(2)
  v_cvt_pk_bf16_f32 v24, v24, v25
  v_cvt_pk_bf16_f32 v25, v26, v27
  v_bfi_b32 v24, 1, s72, v24
  v_smfmac_f32_16x16x64_bf16 v[28:31], v[8:11], v[44:51], v74
  buffer_store_dwordx2 v[24:25], v68, s[8:11], s75 offen
  s_waitcnt lgkmcnt(0)
  v_smfmac_f32_16x16x64_bf16 v[28:31], v[12:15], v[60:67], v74
  ds_read_b64 v[16:17], v77 offset:264
  v_xor_b32 v75, 0x8000, v75
  ds_read_b128 v[0:3], v76 offset:14848
  s_nop 3
  v_cvt_pk_bf16_f32 v28, v28, v29
  v_cvt_pk_bf16_f32 v29, v30, v31
  v_bfi_b32 v28, 1, s72, v28
  buffer_store_dwordx2 v[28:29], v68, s[8:11], s76 offen
  v_mov_b64 v[24:25], 0
  v_mov_b64 v[26:27], 0
  v_mov_b64 v[28:29], 0
  v_mov_b64 v[30:31], 0
  s_add_u32 s58, s58, 655360
  s_add_u32 s59, s59, 655360
  s_add_u32 s70, s70, 655360
  s_add_u32 s68, s68, 655360
  s_add_u32 s66, s66, 1
  s_xor_b32 s64, s64, 16384
  s_xor_b32 s65, s65, 16384
  s_nop 15
  s_nop 15
  s_nop 7
  buffer_load_dwordx4 v[52:55], v76, s[8:11], s60 offen offset:0 sc1
  buffer_load_dwordx4 v[56:59], v76, s[8:11], s60 offen offset:1024 sc1
  s_nop 15
  s_nop 11
  buffer_load_dwordx4 v[36:39], v76, s[8:11], s60 offen offset:0 sc1
  buffer_load_dwordx4 v[40:43], v76, s[8:11], s60 offen offset:1024 sc1
  s_waitcnt vmcnt(3) lgkmcnt(0)
  v_mfma_f32_16x16x32_bf16 v[4:7], v[0:3], v[52:55], 0
  v_bitop3_b32 v72, v52, v54, s72 bitop3:0x7e
  s_waitcnt vmcnt(2)
  v_mfma_f32_16x16x32_bf16 v[4:7], v[0:3], v[56:59], v[4:7]
  v_bitop3_b32 v73, v56, v58, s72 bitop3:0x7e
  v_bitop3_b32 v72, v72, v73, 1 bitop3:0xa8
  v_cmp_ne_u32 vcc, 0, v72
  s_cbranch_vccnz Cf1_h1r
Cf1_h1p:
  s_nop 2
  v_add_f32_dpp v4, v4, v4 row_ror:4 row_mask:0xf bank_mask:0xf
  v_add_f32_dpp v5, v5, v5 row_ror:4 row_mask:0xf bank_mask:0xf
  s_nop 0
  v_add_f32_dpp v4, v4, v4 row_ror:8 row_mask:0xf bank_mask:0xf
  v_add_f32_dpp v5, v5, v5 row_ror:8 row_mask:0xf bank_mask:0xf
  v_cvt_pk_bf16_f32 v4, v4, v5
  buffer_store_dword v4, v69, s[8:11], s62 offen
Cf1_h1ok:
  s_xor_b32 s62, s62, 16384
  s_xor_b32 s72, s72, 1
  s_nop 15
  s_nop 7
Cf1_h2:
  v_lshlrev_b32 v73, 2, v76
  buffer_load_dwordx4 v[52:55], v76, s[8:11], s64 offen offset:0 sc1
  buffer_load_dwordx4 v[56:59], v76, s[8:11], s64 offen offset:1024 sc1
  s_nop 15
  s_nop 1
  buffer_load_dwordx4 v[52:55], v76, s[8:11], s64 offen offset:0 sc1
  buffer_load_dwordx4 v[56:59], v76, s[8:11], s64 offen offset:1024 sc1
  s_nop 15
  s_nop 1
  buffer_load_dwordx4 v[52:55], v76, s[8:11], s64 offen offset:0 sc1
  buffer_load_dwordx4 v[56:59], v76, s[8:11], s64 offen offset:1024 sc1
  s_waitcnt vmcnt(7)
  ds_read_b128 v[60:63], v76 offset:20480
  ds_read_b128 v[64:67], v76 offset:21504
  ds_read_b128 v[44:47], v76 offset:22528
  ds_read_b128 v[48:51], v76 offset:23552
  ds_read_b128 v[36:39], v76 offset:36864
  ds_read_b128 v[40:43], v76 offset:37888
  s_waitcnt vmcnt(4)
  v_max3_u32 v72, v52, v53, v54
  v_max3_u32 v72, v72, v55, v56
  v_max3_u32 v72, v72, v57, v58
  v_max_u32 v72, v72, v59
  ds_write_b128 v76, v[52:55] offset:6656
  ds_write_b128 v76, v[56:59] offset:7680
  v_cmp_eq_u32 vcc, -1, v72
  s_cbranch_vccnz Cf1_h2r
Cf1_h2w:
  buffer_store_dword v71, v69, s[8:11], s62 offen
  v_mov_b32 v72, s66
  s_branch Cf1_top
Cf1_rec:
  s_nop 7
  s_waitcnt vmcnt(0) lgkmcnt(0)
  v_max3_u32 v72, v0, v1, v2
  v_max3_u32 v72, v72, v3, v4
  v_max3_u32 v72, v72, v5, v6
  v_max3_u32 v72, v72, v7, v8
  v_max3_u32 v72, v72, v9, v10
  v_max3_u32 v72, v72, v11, v12
  v_max3_u32 v72, v72, v13, v14
  v_max3_u32 v72, v72, v15, v16
  v_max3_u32 v72, v72, v17, v18
  v_max_u32 v72, v72, v19
  v_cmp_eq_u32 vcc, -1, v72
  s_cbranch_vccz Cf1_recok
  s_barrier
  v_mov_b64 v[20:21], 0
  v_mov_b64 v[22:23], 0
  v_mov_b64 v[24:25], 0
  v_mov_b64 v[26:27], 0
  v_mov_b64 v[28:29], 0
  v_mov_b64 v[30:31], 0
  v_mov_b64 v[32:33], 0
  v_mov_b64 v[34:35], 0
  s_waitcnt lgkmcnt(0)
  s_barrier
  ds_read_b128 v[0:3], v76 offset:4608
  ds_read_b128 v[60:63], v76 offset:20480
  ds_read_b128 v[64:67], v76 offset:21504
  s_waitcnt lgkmcnt(0)
  v_smfmac_f32_16x16x64_bf16 v[20:23], v[0:3], v[60:67], v74
  ds_read_b128 v[60:63], v76 offset:22528
  ds_read_b128 v[64:67], v76 offset:23552
  s_waitcnt lgkmcnt(0)
  v_smfmac_f32_16x16x64_bf16 v[24:27], v[0:3], v[60:67], v74
  ds_read_b128 v[60:63], v76 offset:36864
  ds_read_b128 v[64:67], v76 offset:37888
  s_waitcnt lgkmcnt(0)
  v_smfmac_f32_16x16x64_bf16 v[28:31], v[0:3], v[60:67], v74
  ds_read_b128 v[60:63], v76 offset:38912
  ds_read_b128 v[64:67], v76 offset:39936
  s_waitcnt lgkmcnt(0)
  v_smfmac_f32_16x16x64_bf16 v[32:35], v[0:3], v[60:67], v74
  ds_read_b128 v[4:7], v76 offset:5632
  s_waitcnt lgkmcnt(0)
  v_smfmac_f32_16x16x64_bf16 v[20:23], v[4:7], v[80:87], v74
  v_smfmac_f32_16x16x64_bf16 v[24:27], v[4:7], v[88:95], v74
  v_smfmac_f32_16x16x64_bf16 v[28:31], v[4:7], v[208:215], v74
  v_smfmac_f32_16x16x64_bf16 v[32:35], v[4:7], v[216:223], v74
  ds_read_b128 v[8:11], v76 offset:6656
  s_waitcnt lgkmcnt(0)
  v_smfmac_f32_16x16x64_bf16 v[20:23], v[8:11], v[96:103], v74
  v_smfmac_f32_16x16x64_bf16 v[24:27], v[8:11], v[104:111], v74
  ds_read_b128 v[60:63], v76 offset:53248
  ds_read_b128 v[64:67], v76 offset:54272
  s_waitcnt lgkmcnt(0)
  v_smfmac_f32_16x16x64_bf16 v[28:31], v[8:11], v[60:67], v74
  ds_read_b128 v[60:63], v76 offset:55296
  ds_read_b128 v[64:67], v76 offset:56320
  s_waitcnt lgkmcnt(0)
  v_smfmac_f32_16x16x64_bf16 v[32:35], v[8:11], v[60:67], v74
  ds_read_b128 v[12:15], v76 offset:7680
  s_waitcnt lgkmcnt(0)
  v_smfmac_f32_16x16x64_bf16 v[20:23], v[12:15], v[112:119], v74
  v_smfmac_f32_16x16x64_bf16 v[24:27], v[12:15], v[120:127], v74
  v_smfmac_f32_16x16x64_bf16 v[28:31], v[12:15], v[224:231], v74
  v_smfmac_f32_16x16x64_bf16 v[32:35], v[12:15], v[232:239], v74
  ds_read_b128 v[4:7], v76 offset:8704
  s_waitcnt lgkmcnt(0)
  v_smfmac_f32_16x16x64_bf16 v[20:23], v[4:7], v[128:135], v74
  v_smfmac_f32_16x16x64_bf16 v[24:27], v[4:7], v[136:143], v74
  ds_read_b128 v[60:63], v75 offset:20480
  ds_read_b128 v[64:67], v75 offset:21504
  s_waitcnt lgkmcnt(0)
  v_smfmac_f32_16x16x64_bf16 v[28:31], v[4:7], v[60:67], v74
  ds_read_b128 v[60:63], v75 offset:22528
  ds_read_b128 v[64:67], v75 offset:23552
  s_waitcnt lgkmcnt(0)
  v_smfmac_f32_16x16x64_bf16 v[32:35], v[4:7], v[60:67], v74
  ds_read_b128 v[16:19], v76 offset:9728
  s_waitcnt lgkmcnt(0)
  v_smfmac_f32_16x16x64_bf16 v[20:23], v[16:19], v[144:151], v74
  v_smfmac_f32_16x16x64_bf16 v[24:27], v[16:19], v[152:159], v74
  v_smfmac_f32_16x16x64_bf16 v[28:31], v[16:19], v[240:247], v74
  v_smfmac_f32_16x16x64_bf16 v[32:35], v[16:19], v[248:255], v74
  ds_read_b128 v[12:15], v76 offset:10752
  s_waitcnt lgkmcnt(0)
  v_smfmac_f32_16x16x64_bf16 v[20:23], v[12:15], v[160:167], v74
  v_smfmac_f32_16x16x64_bf16 v[24:27], v[12:15], v[168:175], v74
  v_smfmac_f32_16x16x64_bf16 v[28:31], v[12:15], a[0:7], v74
  v_smfmac_f32_16x16x64_bf16 v[32:35], v[12:15], a[8:15], v74
  ds_read_b128 v[8:11], v76 offset:11776
  s_waitcnt lgkmcnt(0)
  v_smfmac_f32_16x16x64_bf16 v[20:23], v[8:11], v[176:183], v74
  v_smfmac_f32_16x16x64_bf16 v[24:27], v[8:11], v[184:191], v74
  v_smfmac_f32_16x16x64_bf16 v[28:31], v[8:11], a[16:23], v74
  v_smfmac_f32_16x16x64_bf16 v[32:35], v[8:11], a[24:31], v74
  ds_read_b128 v[0:3], v76 offset:12800
  s_waitcnt lgkmcnt(0)
  v_smfmac_f32_16x16x64_bf16 v[20:23], v[0:3], v[192:199], v74
  v_smfmac_f32_16x16x64_bf16 v[24:27], v[0:3], v[200:207], v74
  ds_read_b128 v[60:63], v75 offset:4096
  ds_read_b128 v[64:67], v75 offset:5120
  s_waitcnt lgkmcnt(0)
  v_smfmac_f32_16x16x64_bf16 v[28:31], v[0:3], v[60:67], v74
  ds_read_b128 v[60:63], v75 offset:6144
  ds_read_b128 v[64:67], v75 offset:7168
  s_waitcnt lgkmcnt(0)
  v_smfmac_f32_16x16x64_bf16 v[32:35], v[0:3], v[60:67], v74
  v_add_f32 v20, v20, v22
  v_add_f32 v21, v21, v23
  v_add_f32 v24, v24, v26
  v_cvt_pk_bf16_f32 v22, v20, v24
  ds_write_b32 v79, v22 offset:0
  v_add_f32 v25, v25, v27
  v_cvt_pk_bf16_f32 v23, v21, v25
  ds_write_b32 v79, v23 offset:576
  v_add_f32 v28, v28, v30
  v_add_f32 v29, v29, v31
  s_waitcnt lgkmcnt(0)
  s_nop 1
  s_branch Cf1_recok
Cf1_mx:
  s_waitcnt lgkmcnt(0)
  s_barrier
  buffer_load_dwordx4 v[0:3], v76, s[8:11], s58 offen offset:0 sc1
  ds_read_b128 v[20:23], v77 offset:0
  ds_read_b128 v[28:31], v77 offset:256
  buffer_load_dwordx4 v[4:7], v76, s[8:11], s58 offen offset:1024 sc1
  ds_read_b128 v[24:27], v77 offset:128
  ds_read_b128 v[32:35], v77 offset:384
  s_waitcnt vmcnt(1) lgkmcnt(3)
  v_mfma_f32_16x16x32_bf16 v[8:11], v[0:3], v[20:23], 0
  s_waitcnt vmcnt(0) lgkmcnt(1)
  v_mfma_f32_16x16x32_bf16 v[8:11], v[4:7], v[24:27], v[8:11]
  v_mfma_f32_16x16x32_bf16 v[12:15], v[28:31], v[20:23], 0
  s_waitcnt lgkmcnt(0)
  v_mfma_f32_16x16x32_bf16 v[12:15], v[32:35], v[24:27], v[12:15]
  v_add_f32_dpp v8, v10, v8 quad_perm:[2,3,0,1] row_mask:0xf bank_mask:0xf
  v_add_f32_dpp v9, v11, v9 quad_perm:[2,3,0,1] row_mask:0xf bank_mask:0xf
  s_nop 0
  v_mov_b32_dpp v8, v8 quad_perm:[0,1,0,1] row_mask:0xf bank_mask:0xf
  v_mov_b32_dpp v9, v9 quad_perm:[0,1,0,1] row_mask:0xf bank_mask:0xf
  s_nop 1
  v_add_f32_dpp v12, v14, v12 quad_perm:[2,3,0,1] row_mask:0xf bank_mask:0xf
  v_add_f32_dpp v13, v15, v13 quad_perm:[2,3,0,1] row_mask:0xf bank_mask:0xf
  s_nop 0
  v_mov_b32_dpp v12, v12 quad_perm:[0,1,0,1] row_mask:0xf bank_mask:0xf
  v_mov_b32_dpp v13, v13 quad_perm:[0,1,0,1] row_mask:0xf bank_mask:0xf
  v_mul_f32 v12, s69, v12
  ds_write_b32 v78, v8 offset:8708
  v_mul_f32 v13, s69, v13
  ds_write_b32 v78, v9 offset:8772
  s_waitcnt lgkmcnt(0)
  s_barrier
  ds_read_b128 v[36:39], v78 offset:8704
  ds_read_b128 v[40:43], v78 offset:8768
  s_waitcnt lgkmcnt(0)
  s_barrier
  v_max_f32 v16, v36, v37
  v_max3_f32 v16, v16, v38, v39
  v_max3_f32 v16, v16, v40, v41
  v_max3_f32 v16, v16, v42, v43
  v_max3_f32 v16, v16, v12, v13
  v_mov_b32 v17, v16
  s_nop 1
  v_permlane16_swap_b32 v16, v17
  v_max_f32 v16, v16, v17
  v_mov_b32 v17, v16
  s_nop 1
  v_permlane32_swap_b32 v16, v17
  v_max_f32 v16, v16, v17
  v_sub_f32 v36, v36, v16
  v_sub_f32 v37, v37, v16
  v_sub_f32 v38, v38, v16
  v_sub_f32 v39, v39, v16
  v_sub_f32 v40, v40, v16
  v_sub_f32 v41, v41, v16
  v_sub_f32 v42, v42, v16
  v_sub_f32 v43, v43, v16
  v_sub_f32 v12, v12, v16
  v_sub_f32 v13, v13, v16
  v_exp_f32 v36, v36
  v_exp_f32 v37, v37
  v_exp_f32 v38, v38
  v_exp_f32 v39, v39
  v_exp_f32 v40, v40
  v_exp_f32 v41, v41
  v_exp_f32 v42, v42
  v_exp_f32 v43, v43
  v_exp_f32 v12, v12
  v_exp_f32 v13, v13
  v_cvt_pk_bf16_f32 v32, v36, v40
  v_cvt_pk_bf16_f32 v33, v37, v41
  v_cvt_pk_bf16_f32 v34, v38, v42
  v_cvt_pk_bf16_f32 v35, v39, v43
  v_cvt_pk_bf16_f32 v28, v12, v13
  v_cvt_pk_bf16_f32 v31, v12, v13
  v_mov_b32 v29, 0
  v_mov_b32 v30, 0
  v_mov_b32 v68, 0x3f803f80
  v_mov_b32 v69, 0x3f803f80
  v_mov_b32 v70, 0x3f803f80
  v_mov_b32 v71, 0x3f803f80
  s_nop 1
  v_mfma_f32_16x16x32_bf16 v[8:11], v[32:35], v[68:71], 0
  v_mfma_f32_16x16x32_bf16 v[0:3], v[32:35], v[52:55], 0
  v_mfma_f32_16x16x32_bf16 v[4:7], v[32:35], v[56:59], 0
  v_mfma_f32_16x16x16_bf16 v[8:11], v[28:29], v[68:69], v[8:11]
  v_mfma_f32_16x16x16_bf16 v[0:3], v[28:29], v[72:73], v[0:3]
  v_mfma_f32_16x16x16_bf16 v[4:7], v[30:31], v[72:73], v[4:7]
  ds_read_b128 v[68:71], v76 offset:13824
  v_rcp_f32 v10, v8
  v_rcp_f32 v11, v9
  v_mul_f32 v0, v10, v0
  v_mul_f32 v1, v11, v1
  s_nop 0
  v_mul_f32 v4, v10, v4
  v_mul_f32 v5, v11, v5
  v_cvt_pk_bf16_f32 v2, v0, v4
  ds_write_b32 v79, v2 offset:8704
  v_cvt_pk_bf16_f32 v3, v1, v5
  ds_write_b32 v79, v3 offset:9280
  v_mov_b64 v[16:17], 0
  v_mov_b64 v[18:19], 0
  v_mov_b64 v[20:21], 0
  v_mov_b64 v[22:23], 0
  s_branch Cf1_mxok
Cf1_h1r:
  s_mov_b64 exec, vcc
  buffer_load_dwordx4 v[52:55], v76, s[8:11], s60 offen offset:0 sc1
  buffer_load_dwordx4 v[56:59], v76, s[8:11], s60 offen offset:1024 sc1
  s_mov_b64 exec, -1
  s_add_u32 s67, s67, 1
  s_waitcnt vmcnt(3)
  v_mfma_f32_16x16x32_bf16 v[4:7], v[0:3], v[36:39], 0
  v_bitop3_b32 v72, v36, v38, s72 bitop3:0x7e
  s_waitcnt vmcnt(2)
  v_mfma_f32_16x16x32_bf16 v[4:7], v[0:3], v[40:43], v[4:7]
  v_bitop3_b32 v73, v40, v42, s72 bitop3:0x7e
  v_bitop3_b32 v72, v72, v73, 1 bitop3:0xa8
  v_cmp_ne_u32 vcc, 0, v72
  s_cbranch_vccz Cf1_h1p
  s_mov_b64 exec, vcc
  buffer_load_dwordx4 v[36:39], v76, s[8:11], s60 offen offset:0 sc1
  buffer_load_dwordx4 v[40:43], v76, s[8:11], s60 offen offset:1024 sc1
  s_mov_b64 exec, -1
  s_add_u32 s67, s67, 1
  s_waitcnt vmcnt(3)
  v_mfma_f32_16x16x32_bf16 v[4:7], v[0:3], v[52:55], 0
  v_bitop3_b32 v72, v52, v54, s72 bitop3:0x7e
  s_waitcnt vmcnt(2)
  v_mfma_f32_16x16x32_bf16 v[4:7], v[0:3], v[56:59], v[4:7]
  v_bitop3_b32 v73, v56, v58, s72 bitop3:0x7e
  v_bitop3_b32 v72, v72, v73, 1 bitop3:0xa8
  v_cmp_ne_u32 vcc, 0, v72
  s_cbranch_vccz Cf1_h1p
  s_cmp_lt_u32 s67, 131072
  s_cbranch_scc1 Cf1_h1r
  s_branch Cf1_h1p
Cf1_h2r:
Cf1_h2s:
  s_mov_b64 exec, vcc
  buffer_load_dwordx4 v[52:55], v76, s[8:11], s64 offen offset:0 sc1
  buffer_load_dwordx4 v[56:59], v76, s[8:11], s64 offen offset:1024 sc1
  s_mov_b64 exec, -1
  s_add_u32 s67, s67, 1
  s_waitcnt vmcnt(4)
  v_max3_u32 v72, v52, v53, v54
  v_max3_u32 v72, v72, v55, v56
  v_max3_u32 v72, v72, v57, v58
  v_max_u32 v72, v72, v59
  v_cmp_eq_u32 vcc, -1, v72
  s_cbranch_vccz Cf1_h2ok
  s_mov_b64 exec, vcc
  buffer_load_dwordx4 v[52:55], v76, s[8:11], s64 offen offset:0 sc1
  buffer_load_dwordx4 v[56:59], v76, s[8:11], s64 offen offset:1024 sc1
  s_mov_b64 exec, -1
  s_add_u32 s67, s67, 1
  s_waitcnt vmcnt(4)
  v_max3_u32 v72, v52, v53, v54
  v_max3_u32 v72, v72, v55, v56
  v_max3_u32 v72, v72, v57, v58
  v_max_u32 v72, v72, v59
  v_cmp_eq_u32 vcc, -1, v72
  s_cbranch_vccz Cf1_h2ok
  s_mov_b64 exec, vcc
  buffer_load_dwordx4 v[52:55], v76, s[8:11], s64 offen offset:0 sc1
  buffer_load_dwordx4 v[56:59], v76, s[8:11], s64 offen offset:1024 sc1
  s_mov_b64 exec, -1
  s_add_u32 s67, s67, 1
  s_waitcnt vmcnt(4)
  v_max3_u32 v72, v52, v53, v54
  v_max3_u32 v72, v72, v55, v56
  v_max3_u32 v72, v72, v57, v58
  v_max_u32 v72, v72, v59
  v_cmp_eq_u32 vcc, -1, v72
  s_cbranch_vccz Cf1_h2ok
  s_mov_b64 exec, vcc
  buffer_load_dwordx4 v[52:55], v76, s[8:11], s64 offen offset:0 sc1
  buffer_load_dwordx4 v[56:59], v76, s[8:11], s64 offen offset:1024 sc1
  s_mov_b64 exec, -1
  s_add_u32 s67, s67, 1
  s_waitcnt vmcnt(4)
  v_max3_u32 v72, v52, v53, v54
  v_max3_u32 v72, v72, v55, v56
  v_max3_u32 v72, v72, v57, v58
  v_max_u32 v72, v72, v59
  v_cmp_eq_u32 vcc, -1, v72
  s_cbranch_vccz Cf1_h2ok
  s_cmp_lt_u32 s67, 131072
  s_cbranch_scc1 Cf1_h2s
Cf1_h2ok:
  ds_write_b128 v76, v[52:55] offset:6656
  ds_write_b128 v76, v[56:59] offset:7680
  s_branch Cf1_h2w
Cf1_last:
  s_nop 7
  s_waitcnt vmcnt(0) lgkmcnt(0)
  ds_read_b64 v[16:17], v77 offset:264
  v_mov_b64 v[18:19], v[72:73]
  s_add_u32 s68, s68, 655360
  s_waitcnt lgkmcnt(0)
  buffer_store_dwordx4 v[16:19], v76, s[8:11], s68 offen sc1
  s_waitcnt vmcnt(0)
  s_barrier
  v_mov_b32 v72, 65
  s_mov_b64 exec, 1
  buffer_store_dword v72, v76, s[8:11], s71 offen sc1
  s_mov_b64 exec, -1
  s_branch L_cexit
L_w2:
  v_mov_b64 v[20:21], 0
  v_mov_b64 v[22:23], 0
  v_mov_b64 v[24:25], 0
  v_mov_b64 v[26:27], 0
  v_mov_b64 v[28:29], 0
  v_mov_b64 v[30:31], 0
  v_mov_b64 v[32:33], 0
  v_mov_b64 v[34:35], 0
  s_mov_b32 m0, 15872
  v_lshlrev_b32 v73, 2, v76
  v_mov_b32 v72, 0
  ds_read_b128 v[60:63], v76 offset:24576
  ds_read_b128 v[64:67], v76 offset:25600
  ds_read_b128 v[44:47], v76 offset:26624
  ds_read_b128 v[48:51], v76 offset:27648
  ds_read_b128 v[36:39], v76 offset:40960
  ds_read_b128 v[40:43], v76 offset:41984
  ds_read_b128 v[0:3], v76 offset:4608
  ds_read_b128 v[4:7], v76 offset:5632
  s_branch Cf2_top2
.p2align 6
Cf2_top:
  s_waitcnt lgkmcnt(0)
  s_barrier
  ds_read_b128 v[0:3], v76 offset:4608
  ds_read_b128 v[4:7], v76 offset:5632
  buffer_load_dwordx4 v76, s[8:11], s64 offen offset:0 sc1 lds
  buffer_load_dwordx4 v76, s[8:11], s64 offen offset:1024 sc1 lds
Cf2_top2:
  s_waitcnt lgkmcnt(1)
  v_smfmac_f32_16x16x64_bf16 v[20:23], v[0:3], v[60:67], v74
  ds_read_b128 v[60:63], v76 offset:43008
  v_smfmac_f32_16x16x64_bf16 v[24:27], v[0:3], v[44:51], v74
  s_mov_b32 m0, 15872
  ds_read_b128 v[64:67], v76 offset:44032
  s_waitcnt lgkmcnt(2)
  v_smfmac_f32_16x16x64_bf16 v[20:23], v[4:7], v[80:87], v74
  buffer_load_dwordx4 v[44:47], v76, s[8:11], s58 offen offset:0 sc1
  ds_read_b128 v[8:11], v76 offset:6656
  v_smfmac_f32_16x16x64_bf16 v[28:31], v[0:3], v[36:43], v74
  ds_read_b128 v[36:39], v76 offset:57344
  v_smfmac_f32_16x16x64_bf16 v[24:27], v[4:7], v[88:95], v74
  buffer_load_dwordx4 v[48:51], v76, s[8:11], s58 offen offset:1024 sc1
  ds_read_b128 v[40:43], v76 offset:58368
  v_smfmac_f32_16x16x64_bf16 v[28:31], v[4:7], v[208:215], v74
  ds_read_b128 v[12:15], v76 offset:7680
  v_smfmac_f32_16x16x64_bf16 v[32:35], v[4:7], v[216:223], v74
  buffer_load_dwordx4 v[52:55], v76, s[8:11], s59 offen offset:0 sc1
  s_waitcnt lgkmcnt(4)
  v_smfmac_f32_16x16x64_bf16 v[32:35], v[0:3], v[60:67], v74
  ds_read_b128 v[60:63], v76 offset:59392
  s_waitcnt lgkmcnt(4)
  v_smfmac_f32_16x16x64_bf16 v[20:23], v[8:11], v[96:103], v74
  buffer_load_dwordx4 v[56:59], v76, s[8:11], s59 offen offset:1024 sc1
  ds_read_b128 v[64:67], v76 offset:60416
  v_smfmac_f32_16x16x64_bf16 v[24:27], v[8:11], v[104:111], v74
  ds_read_b128 v[0:3], v76 offset:12800
  s_waitcnt lgkmcnt(4)
  v_smfmac_f32_16x16x64_bf16 v[28:31], v[8:11], v[36:43], v74
  ds_read_b128 v[36:39], v75 offset:8192
  s_waitcnt lgkmcnt(4)
  v_smfmac_f32_16x16x64_bf16 v[20:23], v[12:15], v[112:119], v74
  ds_read_b128 v[40:43], v75 offset:9216
  v_smfmac_f32_16x16x64_bf16 v[24:27], v[12:15], v[120:127], v74
  s_waitcnt lgkmcnt(3)
  v_smfmac_f32_16x16x64_bf16 v[32:35], v[8:11], v[60:67], v74
  buffer_store_dwordx4 v[16:19], v76, s[8:11], s68 offen sc1
  ds_read_b128 v[60:63], v75 offset:10240
  v_smfmac_f32_16x16x64_bf16 v[28:31], v[12:15], v[224:231], v74
  buffer_load_dword v73, s[8:11], s70 offen lds
  s_waitcnt vmcnt(6)
  ds_read_b128 v[64:67], v75 offset:11264
  v_smfmac_f32_16x16x64_bf16 v[32:35], v[12:15], v[232:239], v74
  s_barrier
  s_waitcnt lgkmcnt(4)
  v_smfmac_f32_16x16x64_bf16 v[20:23], v[0:3], v[192:199], v74
  ds_read_b128 v[4:7], v76 offset:8704
  s_waitcnt lgkmcnt(3)
  v_smfmac_f32_16x16x64_bf16 v[28:31], v[0:3], v[36:43], v74
  ds_read_b128 v[16:19], v76 offset:9728
  v_smfmac_f32_16x16x64_bf16 v[24:27], v[0:3], v[200:207], v74
  ds_read_b128 v[36:39], v75 offset:24576
  s_waitcnt lgkmcnt(3)
  v_mov_b32 v68, 0x3f803f80
  v_smfmac_f32_16x16x64_bf16 v[32:35], v[0:3], v[60:67], v74
  ds_read_b128 v[40:43], v75 offset:25600
  s_waitcnt lgkmcnt(3)
  v_smfmac_f32_16x16x64_bf16 v[20:23], v[4:7], v[128:135], v74
  ds_read_b128 v[12:15], v76 offset:10752
  v_mov_b32 v69, 0x3f803f80
  v_smfmac_f32_16x16x64_bf16 v[24:27], v[4:7], v[136:143], v74
  ds_read_b128 v[8:11], v76 offset:11776
  s_waitcnt lgkmcnt(4)
  v_smfmac_f32_16x16x64_bf16 v[20:23], v[16:19], v[144:151], v74
  ds_read_b128 v[60:63], v75 offset:26624
  v_mov_b64 v[70:71], v[68:69]
  v_smfmac_f32_16x16x64_bf16 v[24:27], v[16:19], v[152:159], v74
  ds_read_b128 v[64:67], v75 offset:27648
  s_waitcnt lgkmcnt(4)
  v_smfmac_f32_16x16x64_bf16 v[28:31], v[4:7], v[36:43], v74
  s_waitcnt lgkmcnt(3)
  v_mov_b64 v[36:37], 0
  v_smfmac_f32_16x16x64_bf16 v[20:23], v[12:15], v[160:167], v74
  s_waitcnt lgkmcnt(2)
  v_mov_b64 v[38:39], 0
  v_smfmac_f32_16x16x64_bf16 v[20:23], v[8:11], v[176:183], v74
  v_mov_b64 v[40:41], 0
  v_smfmac_f32_16x16x64_bf16 v[24:27], v[12:15], v[168:175], v74
  v_mov_b64 v[42:43], 0
  v_smfmac_f32_16x16x64_bf16 v[24:27], v[8:11], v[184:191], v74
  s_waitcnt lgkmcnt(0)
  v_add_f32 v20, v20, v22
  v_smfmac_f32_16x16x64_bf16 v[32:35], v[4:7], v[60:67], v74
  v_add_f32 v21, v21, v23
  v_smfmac_f32_16x16x64_bf16 v[28:31], v[16:19], v[240:247], v74
  v_add_f32 v24, v24, v26
  v_cvt_pk_bf16_f32 v22, v20, v24
  v_smfmac_f32_16x16x64_bf16 v[28:31], v[12:15], a[0:7], v74
  ds_write_b32 v79, v22 offset:0
  v_add_f32 v25, v25, v27
  v_cvt_pk_bf16_f32 v23, v21, v25
  v_smfmac_f32_16x16x64_bf16 v[28:31], v[8:11], a[16:23], v74
  ds_write_b32 v79, v23 offset:576
  v_cmp_u_f32 vcc, v20, v21
  v_smfmac_f32_16x16x64_bf16 v[32:35], v[16:19], v[248:255], v74
  v_smfmac_f32_16x16x64_bf16 v[32:35], v[12:15], a[8:15], v74
  v_add_f32 v28, v28, v30
  v_add_f32 v29, v29, v31
  v_smfmac_f32_16x16x64_bf16 v[32:35], v[8:11], a[24:31], v74
  s_cbranch_vccnz Cf2_rec
Cf2_recok:
  v_smfmac_f32_16x16x64_bf16 v[36:39], v[16:19], a[112:119], v74
  s_waitcnt lgkmcnt(0)
  s_barrier
  ds_read_b128 v[60:63], v77
  v_smfmac_f32_16x16x64_bf16 v[40:43], v[16:19], a[120:127], v74
  ds_read_b128 v[64:67], v77 offset:128
  v_add_f32 v32, v32, v34
  v_cvt_pk_bf16_f32 v30, v28, v32
  v_smfmac_f32_16x16x64_bf16 v[36:39], v[0:3], a[160:167], v74
  ds_write_b32 v79, v30 offset:256
  v_add_f32 v33, v33, v35
  v_cvt_pk_bf16_f32 v31, v29, v33
  v_smfmac_f32_16x16x64_bf16 v[40:43], v[0:3], a[168:175], v74
  ds_write_b32 v79, v31 offset:832
  v_xor_b32 v75, 0x8000, v75
  v_smfmac_f32_16x16x64_bf16 v[36:39], v[4:7], a[96:103], v74
  ds_read_b128 v[0:3], v76 offset:4608
  v_mov_b32 v29, 0
  v_smfmac_f32_16x16x64_bf16 v[40:43], v[4:7], a[104:111], v74
  s_waitcnt vmcnt(4) lgkmcnt(3)
  v_mov_b32 v30, 0
  v_mfma_f32_16x16x32_bf16 v[44:47], v[44:47], v[60:63], 0
  ds_read_b128 v[4:7], v76 offset:5632
  s_waitcnt lgkmcnt(2)
  v_mfma_f32_16x16x32_bf16 v[44:47], v[48:51], v[64:67], v[44:47]
  s_barrier
  v_smfmac_f32_16x16x64_bf16 v[36:39], v[8:11], a[144:151], v74
  ds_read_b128 v[20:23], v77 offset:256
  ds_read_b128 v[24:27], v77 offset:384
  v_smfmac_f32_16x16x64_bf16 v[40:43], v[8:11], a[152:159], v74
  ds_read_b128 v[8:11], v76 offset:6656
  v_add_f32_dpp v72, v46, v44 quad_perm:[2,3,0,1] row_mask:0xf bank_mask:0xf
  v_add_f32_dpp v73, v47, v45 quad_perm:[2,3,0,1] row_mask:0xf bank_mask:0xf
  v_smfmac_f32_16x16x64_bf16 v[36:39], v[12:15], a[128:135], v74
  ds_read_b128 v[44:47], v75 offset:0
  v_exp_f32_dpp v72, v72 quad_perm:[0,1,0,1] row_mask:0xf bank_mask:0xf
  v_smfmac_f32_16x16x64_bf16 v[40:43], v[12:15], a[136:143], v74
  ds_read_b128 v[12:15], v76 offset:7680
  s_waitcnt lgkmcnt(6)
  v_exp_f32_dpp v73, v73 quad_perm:[0,1,0,1] row_mask:0xf bank_mask:0xf
  v_smfmac_f32_16x16x64_bf16 v[36:39], v[0:3], a[32:39], v74
  s_waitcnt lgkmcnt(3)
  v_cvt_pk_bf16_f32 v72, v72, v73
  v_mfma_f32_16x16x32_bf16 v[20:23], v[20:23], v[60:63], 0
  ds_write_b32 v78, v72 offset:520
  v_mfma_f32_16x16x32_bf16 v[20:23], v[24:27], v[64:67], v[20:23]
  ds_read_b128 v[48:51], v75 offset:1024
  v_smfmac_f32_16x16x64_bf16 v[40:43], v[0:3], a[40:47], v74
  ds_read_b128 v[60:63], v75 offset:2048
  v_smfmac_f32_16x16x64_bf16 v[36:39], v[4:7], a[48:55], v74
  s_waitcnt lgkmcnt(5)
  v_add_f32_dpp v24, v22, v20 quad_perm:[2,3,0,1] row_mask:0xf bank_mask:0xf
  v_add_f32_dpp v25, v23, v21 quad_perm:[2,3,0,1] row_mask:0xf bank_mask:0xf
  v_smfmac_f32_16x16x64_bf16 v[36:39], v[8:11], a[64:71], v74
  s_waitcnt lgkmcnt(2)
  s_barrier
  ds_read_b128 v[32:35], v78 offset:512
  v_smfmac_f32_16x16x64_bf16 v[36:39], v[12:15], a[80:87], v74
  ds_read_b128 v[64:67], v75 offset:3072
  v_mul_f32 v24, s69, v24
  v_smfmac_f32_16x16x64_bf16 v[40:43], v[4:7], a[56:63], v74
  v_mul_f32 v25, s69, v25
  v_smfmac_f32_16x16x64_bf16 v[40:43], v[8:11], a[72:79], v74
  v_exp_f32_dpp v24, v24 quad_perm:[0,1,0,1] row_mask:0xf bank_mask:0xf
  v_smfmac_f32_16x16x64_bf16 v[40:43], v[12:15], a[88:95], v74
  s_waitcnt vmcnt(2) lgkmcnt(1)
  v_exp_f32_dpp v25, v25 quad_perm:[0,1,0,1] row_mask:0xf bank_mask:0xf
  v_mfma_f32_16x16x32_bf16 v[8:11], v[32:35], v[68:71], 0
  v_add_f32 v36, v36, v38
  v_add_f32 v37, v37, v39
  v_mfma_f32_16x16x32_bf16 v[0:3], v[32:35], v[52:55], 0
  v_add_f32 v40, v40, v42
  v_add_f32 v41, v41, v43
  v_mfma_f32_16x16x32_bf16 v[4:7], v[32:35], v[56:59], 0
  v_cvt_pk_bf16_f32 v28, v24, v25
  v_cvt_pk_bf16_f32 v72, v36, v37
  v_cvt_pk_bf16_f32 v73, v40, v41
  v_mfma_f32_16x16x16_bf16 v[8:11], v[28:29], v[68:69], v[8:11]
  v_cvt_pk_bf16_f32 v31, v24, v25
  v_mfma_f32_16x16x16_bf16 v[0:3], v[28:29], v[72:73], v[0:3]
  ds_read_b128 v[68:71], v76 offset:13824
  v_mfma_f32_16x16x16_bf16 v[4:7], v[30:31], v[72:73], v[4:7]
  v_rcp_f32 v10, v8
  v_rcp_f32 v11, v9
  v_mul_f32 v0, v10, v0
  v_mul_f32 v1, v11, v1
  s_nop 0
  v_mul_f32 v4, v10, v4
  v_mul_f32 v5, v11, v5
  v_cvt_pk_bf16_f32 v2, v0, v4
  ds_write_b32 v79, v2 offset:8704
  v_cvt_pk_bf16_f32 v3, v1, v5
  ds_write_b32 v79, v3 offset:9280
  v_subrev_u32 v8, 813694976, v8
  v_subrev_u32 v9, 813694976, v9
  v_max_u32 v8, v8, v9
  v_cmp_le_u32 vcc, 503316480, v8
  v_mov_b64 v[16:17], 0
  v_mov_b64 v[18:19], 0
  v_mov_b64 v[20:21], 0
  v_mov_b64 v[22:23], 0
  s_cbranch_vccnz Cf2_mx
Cf2_mxok:
  s_cmp_eq_u32 s66, 63
  s_waitcnt lgkmcnt(0)
  s_barrier
  ds_read_b128 v[0:3], v78 offset:8704
  ds_read_b128 v[4:7], v78 offset:8768
  ds_read_b128 v[8:11], v78 offset:8832
  ds_read_b128 v[12:15], v78 offset:8896
  v_mov_b64 v[24:25], 0
  v_mov_b64 v[26:27], 0
  v_mov_b64 v[28:29], 0
  v_mov_b64 v[30:31], 0
  v_mov_b64 v[32:33], 0
  v_mov_b64 v[34:35], 0
  s_waitcnt lgkmcnt(3)
  v_smfmac_f32_16x16x64_bf16 v[16:19], v[0:3], a[176:183], v74
  ds_read_b128 v[52:55], v75 offset:4096
  ds_read_b128 v[56:59], v75 offset:5120
  s_waitcnt lgkmcnt(4)
  v_smfmac_f32_16x16x64_bf16 v[16:19], v[4:7], a[184:191], v74
  ds_read_b128 v[36:39], v75 offset:6144
  s_waitcnt lgkmcnt(4)
  v_smfmac_f32_16x16x64_bf16 v[16:19], v[8:11], a[192:199], v74
  ds_read_b128 v[40:43], v75 offset:7168
  s_waitcnt lgkmcnt(4)
  v_smfmac_f32_16x16x64_bf16 v[16:19], v[12:15], a[200:207], v74
  s_cbranch_scc1 Cf2_last
  v_smfmac_f32_16x16x64_bf16 v[32:35], v[0:3], v[44:51], v74
  ds_read_b128 v[44:47], v75 offset:24576
  ds_read_b128 v[48:51], v75 offset:25600
  v_smfmac_f32_16x16x64_bf16 v[32:35], v[4:7], v[60:67], v74
  ds_read_b128 v[60:63], v75 offset:26624
  s_waitcnt lgkmcnt(5)
  v_cvt_pk_bf16_f32 v16, v16, v17
  v_cvt_pk_bf16_f32 v17, v18, v19
  v_bfi_b32 v16, 1, s72, v16
  v_smfmac_f32_16x16x64_bf16 v[32:35], v[8:11], v[52:59], v74
  ds_read_b128 v[64:67], v75 offset:27648
  buffer_store_dwordx2 v[16:17], v68, s[8:11], s73 offen
  s_waitcnt lgkmcnt(4)
  v_smfmac_f32_16x16x64_bf16 v[32:35], v[12:15], v[36:43], v74
  ds_read_b128 v[52:55], v75 offset:40960
  v_smfmac_f32_16x16x64_bf16 v[20:23], v[0:3], a[208:215], v74
  ds_read_b128 v[56:59], v75 offset:41984
  v_smfmac_f32_16x16x64_bf16 v[20:23], v[4:7], a[216:223], v74
  ds_read_b128 v[36:39], v75 offset:43008
  s_waitcnt lgkmcnt(5)
  v_cvt_pk_bf16_f32 v32, v32, v33
  v_cvt_pk_bf16_f32 v33, v34, v35
  v_bfi_b32 v32, 1, s72, v32
  v_smfmac_f32_16x16x64_bf16 v[20:23], v[8:11], v[44:51], v74
  ds_read_b128 v[40:43], v75 offset:44032
  buffer_store_dwordx2 v[32:33], v68, s[8:11], s77 offen
  s_waitcnt lgkmcnt(4)
  v_mov_b64 v[18:19], v[72:73]
  v_smfmac_f32_16x16x64_bf16 v[20:23], v[12:15], v[60:67], v74
  ds_read_b128 v[44:47], v75 offset:57344
  v_mov_b64 v[32:33], 0
  v_smfmac_f32_16x16x64_bf16 v[24:27], v[0:3], a[224:231], v74
  ds_read_b128 v[48:51], v75 offset:58368
  v_mov_b64 v[34:35], 0
  v_smfmac_f32_16x16x64_bf16 v[24:27], v[4:7], a[232:239], v74
  ds_read_b128 v[60:63], v75 offset:59392
  s_waitcnt lgkmcnt(5)
  v_cvt_pk_bf16_f32 v20, v20, v21
  v_cvt_pk_bf16_f32 v21, v22, v23
  v_bfi_b32 v20, 1, s72, v20
  v_smfmac_f32_16x16x64_bf16 v[24:27], v[8:11], v[52:59], v74
  ds_read_b128 v[64:67], v75 offset:60416
  buffer_store_dwordx2 v[20:21], v68, s[8:11], s74 offen
  s_waitcnt lgkmcnt(4)
  v_smfmac_f32_16x16x64_bf16 v[24:27], v[12:15], v[36:43], v74
  ds_read_b64 v[16:17], v77 offset:384
  v_xor_b32 v75, 0x8000, v75
  v_smfmac_f32_16x16x64_bf16 v[28:31], v[0:3], a[240:247], v74
  v_smfmac_f32_16x16x64_bf16 v[28:31], v[4:7], a[248:255], v74
  s_waitcnt lgkmcnt(3)
  v_cvt_pk_bf16_f32 v24, v24, v25
  v_cvt_pk_bf16_f32 v25, v26, v27
  v_bfi_b32 v24, 1, s72, v24
  v_smfmac_f32_16x16x64_bf16 v[28:31], v[8:11], v[44:51], v74
  buffer_store_dwordx2 v[24:25], v68, s[8:11], s75 offen
  s_waitcnt lgkmcnt(1)
  v_smfmac_f32_16x16x64_bf16 v[28:31], v[12:15], v[60:67], v74
  ds_read_b128 v[0:3], v76 offset:14848
  s_nop 6
  v_cvt_pk_bf16_f32 v28, v28, v29
  v_cvt_pk_bf16_f32 v29, v30, v31
  v_bfi_b32 v28, 1, s72, v28
  buffer_store_dwordx2 v[28:29], v68, s[8:11], s76 offen
  v_mov_b64 v[20:21], 0
  v_mov_b64 v[22:23], 0
  v_mov_b64 v[24:25], 0
  v_mov_b64 v[26:27], 0
  v_mov_b64 v[28:29], 0
  v_mov_b64 v[30:31], 0
  s_add_u32 s58, s58, 655360
  s_add_u32 s59, s59, 655360
  s_add_u32 s70, s70, 655360
  s_add_u32 s68, s68, 655360
  s_add_u32 s66, s66, 1
  s_xor_b32 s64, s64, 16384
  s_xor_b32 s65, s65, 16384
  s_nop 15
  s_nop 15
  s_nop 7
  buffer_load_dwordx4 v[52:55], v76, s[8:11], s60 offen offset:0 sc1
  buffer_load_dwordx4 v[56:59], v76, s[8:11], s60 offen offset:1024 sc1
  s_nop 15
  s_nop 11
  buffer_load_dwordx4 v[36:39], v76, s[8:11], s60 offen offset:0 sc1
  buffer_load_dwordx4 v[40:43], v76, s[8:11], s60 offen offset:1024 sc1
  s_waitcnt vmcnt(3) lgkmcnt(0)
  v_mfma_f32_16x16x32_bf16 v[4:7], v[0:3], v[52:55], 0
  v_bitop3_b32 v72, v52, v54, s72 bitop3:0x7e
  s_waitcnt vmcnt(2)
  v_mfma_f32_16x16x32_bf16 v[4:7], v[0:3], v[56:59], v[4:7]
  v_bitop3_b32 v73, v56, v58, s72 bitop3:0x7e
  v_bitop3_b32 v72, v72, v73, 1 bitop3:0xa8
  v_cmp_ne_u32 vcc, 0, v72
  s_cbranch_vccnz Cf2_h1r
Cf2_h1p:
  s_nop 2
  v_add_f32_dpp v4, v4, v4 row_ror:4 row_mask:0xf bank_mask:0xf
  v_add_f32_dpp v5, v5, v5 row_ror:4 row_mask:0xf bank_mask:0xf
  s_nop 0
  v_add_f32_dpp v4, v4, v4 row_ror:8 row_mask:0xf bank_mask:0xf
  v_add_f32_dpp v5, v5, v5 row_ror:8 row_mask:0xf bank_mask:0xf
  v_cvt_pk_bf16_f32 v4, v4, v5
  buffer_store_dword v4, v69, s[8:11], s62 offen
Cf2_h1ok:
  s_xor_b32 s62, s62, 16384
  s_xor_b32 s72, s72, 1
Cf2_h2:
  v_lshlrev_b32 v73, 2, v76
  s_mov_b32 m0, 8704
  buffer_store_dword v71, v69, s[8:11], s62 offen
  s_waitcnt vmcnt(2)
  ds_read_b128 v[60:63], v76 offset:24576
  ds_read_b128 v[64:67], v76 offset:25600
  ds_read_b128 v[44:47], v76 offset:26624
  ds_read_b128 v[48:51], v76 offset:27648
  ds_read_b128 v[36:39], v76 offset:40960
  ds_read_b128 v[40:43], v76 offset:41984
  s_branch Cf2_top
Cf2_rec:
  s_nop 7
  s_waitcnt vmcnt(0) lgkmcnt(0)
  v_max3_u32 v72, v0, v1, v2
  v_max3_u32 v72, v72, v3, v4
  v_max3_u32 v72, v72, v5, v6
  v_max3_u32 v72, v72, v7, v8
  v_max3_u32 v72, v72, v9, v10
  v_max3_u32 v72, v72, v11, v12
  v_max3_u32 v72, v72, v13, v14
  v_max3_u32 v72, v72, v15, v16
  v_max3_u32 v72, v72, v17, v18
  v_max_u32 v72, v72, v19
  v_cmp_eq_u32 vcc, -1, v72
  s_cbranch_vccz Cf2_recok
  s_barrier
Cf2_recp:
  buffer_load_dwordx4 v[60:63], v76, s[8:11], s64 offen offset:0 sc1
  buffer_load_dwordx4 v[64:67], v76, s[8:11], s64 offen offset:1024 sc1
  s_add_u32 s67, s67, 1
  s_cmp_lt_u32 s67, 131072
  s_cselect_b32 s54, -2, -1
  s_waitcnt vmcnt(1)
  v_max3_u32 v72, v60, v61, v62
  s_waitcnt vmcnt(0)
  v_max3_u32 v72, v72, v63, v64
  v_max3_u32 v72, v72, v65, v66
  v_max_u32 v72, v72, v67
  v_cmp_lt_u32 vcc, s54, v72
  s_cbranch_vccnz Cf2_recp
  ds_write_b128 v76, v[60:63] offset:8704
  ds_write_b128 v76, v[64:67] offset:9728
  v_mov_b64 v[20:21], 0
  v_mov_b64 v[22:23], 0
  v_mov_b64 v[24:25], 0
  v_mov_b64 v[26:27], 0
  v_mov_b64 v[28:29], 0
  v_mov_b64 v[30:31], 0
  v_mov_b64 v[32:33], 0
  v_mov_b64 v[34:35], 0
  s_waitcnt lgkmcnt(0)
  s_barrier
  ds_read_b128 v[0:3], v76 offset:4608
  ds_read_b128 v[60:63], v76 offset:24576
  ds_read_b128 v[64:67], v76 offset:25600
  s_waitcnt lgkmcnt(0)
  v_smfmac_f32_16x16x64_bf16 v[20:23], v[0:3], v[60:67], v74
  ds_read_b128 v[60:63], v76 offset:26624
  ds_read_b128 v[64:67], v76 offset:27648
  s_waitcnt lgkmcnt(0)
  v_smfmac_f32_16x16x64_bf16 v[24:27], v[0:3], v[60:67], v74
  ds_read_b128 v[60:63], v76 offset:40960
  ds_read_b128 v[64:67], v76 offset:41984
  s_waitcnt lgkmcnt(0)
  v_smfmac_f32_16x16x64_bf16 v[28:31], v[0:3], v[60:67], v74
  ds_read_b128 v[60:63], v76 offset:43008
  ds_read_b128 v[64:67], v76 offset:44032
  s_waitcnt lgkmcnt(0)
  v_smfmac_f32_16x16x64_bf16 v[32:35], v[0:3], v[60:67], v74
  ds_read_b128 v[4:7], v76 offset:5632
  s_waitcnt lgkmcnt(0)
  v_smfmac_f32_16x16x64_bf16 v[20:23], v[4:7], v[80:87], v74
  v_smfmac_f32_16x16x64_bf16 v[24:27], v[4:7], v[88:95], v74
  v_smfmac_f32_16x16x64_bf16 v[28:31], v[4:7], v[208:215], v74
  v_smfmac_f32_16x16x64_bf16 v[32:35], v[4:7], v[216:223], v74
  ds_read_b128 v[8:11], v76 offset:6656
  s_waitcnt lgkmcnt(0)
  v_smfmac_f32_16x16x64_bf16 v[20:23], v[8:11], v[96:103], v74
  v_smfmac_f32_16x16x64_bf16 v[24:27], v[8:11], v[104:111], v74
  ds_read_b128 v[60:63], v76 offset:57344
  ds_read_b128 v[64:67], v76 offset:58368
  s_waitcnt lgkmcnt(0)
  v_smfmac_f32_16x16x64_bf16 v[28:31], v[8:11], v[60:67], v74
  ds_read_b128 v[60:63], v76 offset:59392
  ds_read_b128 v[64:67], v76 offset:60416
  s_waitcnt lgkmcnt(0)
  v_smfmac_f32_16x16x64_bf16 v[32:35], v[8:11], v[60:67], v74
  ds_read_b128 v[12:15], v76 offset:7680
  s_waitcnt lgkmcnt(0)
  v_smfmac_f32_16x16x64_bf16 v[20:23], v[12:15], v[112:119], v74
  v_smfmac_f32_16x16x64_bf16 v[24:27], v[12:15], v[120:127], v74
  v_smfmac_f32_16x16x64_bf16 v[28:31], v[12:15], v[224:231], v74
  v_smfmac_f32_16x16x64_bf16 v[32:35], v[12:15], v[232:239], v74
  ds_read_b128 v[4:7], v76 offset:8704
  s_waitcnt lgkmcnt(0)
  v_smfmac_f32_16x16x64_bf16 v[20:23], v[4:7], v[128:135], v74
  v_smfmac_f32_16x16x64_bf16 v[24:27], v[4:7], v[136:143], v74
  ds_read_b128 v[60:63], v75 offset:24576
  ds_read_b128 v[64:67], v75 offset:25600
  s_waitcnt lgkmcnt(0)
  v_smfmac_f32_16x16x64_bf16 v[28:31], v[4:7], v[60:67], v74
  ds_read_b128 v[60:63], v75 offset:26624
  ds_read_b128 v[64:67], v75 offset:27648
  s_waitcnt lgkmcnt(0)
  v_smfmac_f32_16x16x64_bf16 v[32:35], v[4:7], v[60:67], v74
  ds_read_b128 v[16:19], v76 offset:9728
  s_waitcnt lgkmcnt(0)
  v_smfmac_f32_16x16x64_bf16 v[20:23], v[16:19], v[144:151], v74
  v_smfmac_f32_16x16x64_bf16 v[24:27], v[16:19], v[152:159], v74
  v_smfmac_f32_16x16x64_bf16 v[28:31], v[16:19], v[240:247], v74
  v_smfmac_f32_16x16x64_bf16 v[32:35], v[16:19], v[248:255], v74
  ds_read_b128 v[12:15], v76 offset:10752
  s_waitcnt lgkmcnt(0)
  v_smfmac_f32_16x16x64_bf16 v[20:23], v[12:15], v[160:167], v74
  v_smfmac_f32_16x16x64_bf16 v[24:27], v[12:15], v[168:175], v74
  v_smfmac_f32_16x16x64_bf16 v[28:31], v[12:15], a[0:7], v74
  v_smfmac_f32_16x16x64_bf16 v[32:35], v[12:15], a[8:15], v74
  ds_read_b128 v[8:11], v76 offset:11776
  s_waitcnt lgkmcnt(0)
  v_smfmac_f32_16x16x64_bf16 v[20:23], v[8:11], v[176:183], v74
  v_smfmac_f32_16x16x64_bf16 v[24:27], v[8:11], v[184:191], v74
  v_smfmac_f32_16x16x64_bf16 v[28:31], v[8:11], a[16:23], v74
  v_smfmac_f32_16x16x64_bf16 v[32:35], v[8:11], a[24:31], v74
  ds_read_b128 v[0:3], v76 offset:12800
  s_waitcnt lgkmcnt(0)
  v_smfmac_f32_16x16x64_bf16 v[20:23], v[0:3], v[192:199], v74
  v_smfmac_f32_16x16x64_bf16 v[24:27], v[0:3], v[200:207], v74
  ds_read_b128 v[60:63], v75 offset:8192
  ds_read_b128 v[64:67], v75 offset:9216
  s_waitcnt lgkmcnt(0)
  v_smfmac_f32_16x16x64_bf16 v[28:31], v[0:3], v[60:67], v74
  ds_read_b128 v[60:63], v75 offset:10240
  ds_read_b128 v[64:67], v75 offset:11264
  s_waitcnt lgkmcnt(0)
  v_smfmac_f32_16x16x64_bf16 v[32:35], v[0:3], v[60:67], v74
  v_add_f32 v20, v20, v22
  v_add_f32 v21, v21, v23
  v_add_f32 v24, v24, v26
  v_cvt_pk_bf16_f32 v22, v20, v24
  ds_write_b32 v79, v22 offset:0
  v_add_f32 v25, v25, v27
  v_cvt_pk_bf16_f32 v23, v21, v25
  ds_write_b32 v79, v23 offset:576
  v_add_f32 v28, v28, v30
  v_add_f32 v29, v29, v31
  s_waitcnt lgkmcnt(0)
  s_nop 1
  s_branch Cf2_recok
Cf2_mx:
  s_waitcnt lgkmcnt(0)
  s_barrier
  buffer_load_dwordx4 v[0:3], v76, s[8:11], s58 offen offset:0 sc1
  ds_read_b128 v[20:23], v77 offset:0
  ds_read_b128 v[28:31], v77 offset:256
  buffer_load_dwordx4 v[4:7], v76, s[8:11], s58 offen offset:1024 sc1
  ds_read_b128 v[24:27], v77 offset:128
  ds_read_b128 v[32:35], v77 offset:384
  s_waitcnt vmcnt(1) lgkmcnt(3)
  v_mfma_f32_16x16x32_bf16 v[8:11], v[0:3], v[20:23], 0
  s_waitcnt vmcnt(0) lgkmcnt(1)
  v_mfma_f32_16x16x32_bf16 v[8:11], v[4:7], v[24:27], v[8:11]
  v_mfma_f32_16x16x32_bf16 v[12:15], v[28:31], v[20:23], 0
  s_waitcnt lgkmcnt(0)
  v_mfma_f32_16x16x32_bf16 v[12:15], v[32:35], v[24:27], v[12:15]
  v_add_f32_dpp v8, v10, v8 quad_perm:[2,3,0,1] row_mask:0xf bank_mask:0xf
  v_add_f32_dpp v9, v11, v9 quad_perm:[2,3,0,1] row_mask:0xf bank_mask:0xf
  s_nop 0
  v_mov_b32_dpp v8, v8 quad_perm:[0,1,0,1] row_mask:0xf bank_mask:0xf
  v_mov_b32_dpp v9, v9 quad_perm:[0,1,0,1] row_mask:0xf bank_mask:0xf
  s_nop 1
  v_add_f32_dpp v12, v14, v12 quad_perm:[2,3,0,1] row_mask:0xf bank_mask:0xf
  v_add_f32_dpp v13, v15, v13 quad_perm:[2,3,0,1] row_mask:0xf bank_mask:0xf
  s_nop 0
  v_mov_b32_dpp v12, v12 quad_perm:[0,1,0,1] row_mask:0xf bank_mask:0xf
  v_mov_b32_dpp v13, v13 quad_perm:[0,1,0,1] row_mask:0xf bank_mask:0xf
  v_mul_f32 v12, s69, v12
  ds_write_b32 v78, v8 offset:8712
  v_mul_f32 v13, s69, v13
  ds_write_b32 v78, v9 offset:8776
  s_waitcnt lgkmcnt(0)
  s_barrier
  ds_read_b128 v[36:39], v78 offset:8704
  ds_read_b128 v[40:43], v78 offset:8768
  s_waitcnt lgkmcnt(0)
  s_barrier
  v_max_f32 v16, v36, v37
  v_max3_f32 v16, v16, v38, v39
  v_max3_f32 v16, v16, v40, v41
  v_max3_f32 v16, v16, v42, v43
  v_max3_f32 v16, v16, v12, v13
  v_mov_b32 v17, v16
  s_nop 1
  v_permlane16_swap_b32 v16, v17
  v_max_f32 v16, v16, v17
  v_mov_b32 v17, v16
  s_nop 1
  v_permlane32_swap_b32 v16, v17
  v_max_f32 v16, v16, v17
  v_sub_f32 v36, v36, v16
  v_sub_f32 v37, v37, v16
  v_sub_f32 v38, v38, v16
  v_sub_f32 v39, v39, v16
  v_sub_f32 v40, v40, v16
  v_sub_f32 v41, v41, v16
  v_sub_f32 v42, v42, v16
  v_sub_f32 v43, v43, v16
  v_sub_f32 v12, v12, v16
  v_sub_f32 v13, v13, v16
  v_exp_f32 v36, v36
  v_exp_f32 v37, v37
  v_exp_f32 v38, v38
  v_exp_f32 v39, v39
  v_exp_f32 v40, v40
  v_exp_f32 v41, v41
  v_exp_f32 v42, v42
  v_exp_f32 v43, v43
  v_exp_f32 v12, v12
  v_exp_f32 v13, v13
  v_cvt_pk_bf16_f32 v32, v36, v40
  v_cvt_pk_bf16_f32 v33, v37, v41
  v_cvt_pk_bf16_f32 v34, v38, v42
  v_cvt_pk_bf16_f32 v35, v39, v43
  v_cvt_pk_bf16_f32 v28, v12, v13
  v_cvt_pk_bf16_f32 v31, v12, v13
  v_mov_b32 v29, 0
  v_mov_b32 v30, 0
  v_mov_b32 v68, 0x3f803f80
  v_mov_b32 v69, 0x3f803f80
  v_mov_b32 v70, 0x3f803f80
  v_mov_b32 v71, 0x3f803f80
  s_nop 1
  v_mfma_f32_16x16x32_bf16 v[8:11], v[32:35], v[68:71], 0
  v_mfma_f32_16x16x32_bf16 v[0:3], v[32:35], v[52:55], 0
  v_mfma_f32_16x16x32_bf16 v[4:7], v[32:35], v[56:59], 0
  v_mfma_f32_16x16x16_bf16 v[8:11], v[28:29], v[68:69], v[8:11]
  v_mfma_f32_16x16x16_bf16 v[0:3], v[28:29], v[72:73], v[0:3]
  v_mfma_f32_16x16x16_bf16 v[4:7], v[30:31], v[72:73], v[4:7]
  ds_read_b128 v[68:71], v76 offset:13824
  v_rcp_f32 v10, v8
  v_rcp_f32 v11, v9
  v_mul_f32 v0, v10, v0
  v_mul_f32 v1, v11, v1
  s_nop 0
  v_mul_f32 v4, v10, v4
  v_mul_f32 v5, v11, v5
  v_cvt_pk_bf16_f32 v2, v0, v4
  ds_write_b32 v79, v2 offset:8704
  v_cvt_pk_bf16_f32 v3, v1, v5
  ds_write_b32 v79, v3 offset:9280
  v_mov_b64 v[16:17], 0
  v_mov_b64 v[18:19], 0
  v_mov_b64 v[20:21], 0
  v_mov_b64 v[22:23], 0
  s_branch Cf2_mxok
Cf2_h1r:
  s_mov_b64 exec, vcc
  buffer_load_dwordx4 v[52:55], v76, s[8:11], s60 offen offset:0 sc1
  buffer_load_dwordx4 v[56:59], v76, s[8:11], s60 offen offset:1024 sc1
  s_mov_b64 exec, -1
  s_add_u32 s67, s67, 1
  s_waitcnt vmcnt(3)
  v_mfma_f32_16x16x32_bf16 v[4:7], v[0:3], v[36:39], 0
  v_bitop3_b32 v72, v36, v38, s72 bitop3:0x7e
  s_waitcnt vmcnt(2)
  v_mfma_f32_16x16x32_bf16 v[4:7], v[0:3], v[40:43], v[4:7]
  v_bitop3_b32 v73, v40, v42, s72 bitop3:0x7e
  v_bitop3_b32 v72, v72, v73, 1 bitop3:0xa8
  v_cmp_ne_u32 vcc, 0, v72
  s_cbranch_vccz Cf2_h1p
  s_mov_b64 exec, vcc
  buffer_load_dwordx4 v[36:39], v76, s[8:11], s60 offen offset:0 sc1
  buffer_load_dwordx4 v[40:43], v76, s[8:11], s60 offen offset:1024 sc1
  s_mov_b64 exec, -1
  s_add_u32 s67, s67, 1
  s_waitcnt vmcnt(3)
  v_mfma_f32_16x16x32_bf16 v[4:7], v[0:3], v[52:55], 0
  v_bitop3_b32 v72, v52, v54, s72 bitop3:0x7e
  s_waitcnt vmcnt(2)
  v_mfma_f32_16x16x32_bf16 v[4:7], v[0:3], v[56:59], v[4:7]
  v_bitop3_b32 v73, v56, v58, s72 bitop3:0x7e
  v_bitop3_b32 v72, v72, v73, 1 bitop3:0xa8
  v_cmp_ne_u32 vcc, 0, v72
  s_cbranch_vccz Cf2_h1p
  s_cmp_lt_u32 s67, 131072
  s_cbranch_scc1 Cf2_h1r
  s_branch Cf2_h1p
Cf2_last:
  s_nop 7
  s_waitcnt vmcnt(0) lgkmcnt(0)
  ds_read_b64 v[16:17], v77 offset:384
  v_mov_b64 v[18:19], v[72:73]
  s_add_u32 s68, s68, 655360
  s_waitcnt lgkmcnt(0)
  buffer_store_dwordx4 v[16:19], v76, s[8:11], s68 offen sc1
  s_waitcnt vmcnt(0)
  s_barrier
  s_branch L_cexit
L_w3:
  v_mov_b64 v[20:21], 0
  v_mov_b64 v[22:23], 0
  v_mov_b64 v[24:25], 0
  v_mov_b64 v[26:27], 0
  v_mov_b64 v[28:29], 0
  v_mov_b64 v[30:31], 0
  v_mov_b64 v[32:33], 0
  v_mov_b64 v[34:35], 0
  s_mov_b32 m0, 15872
  v_lshlrev_b32 v73, 2, v76
  v_mov_b32 v72, 0
  ds_read_b128 v[60:63], v76 offset:28672
  ds_read_b128 v[64:67], v76 offset:29696
  ds_read_b128 v[44:47], v76 offset:30720
  ds_read_b128 v[48:51], v76 offset:31744
  ds_read_b128 v[36:39], v76 offset:45056
  ds_read_b128 v[40:43], v76 offset:46080
  ds_read_b128 v[0:3], v76 offset:4608
  ds_read_b128 v[4:7], v76 offset:5632
  s_branch Cf3_top2
.p2align 6
Cf3_top:
  s_waitcnt lgkmcnt(0)
  s_barrier
  ds_read_b128 v[0:3], v76 offset:4608
  ds_read_b128 v[4:7], v76 offset:5632
  buffer_load_dwordx4 v76, s[8:11], s64 offen offset:0 sc1 lds
  buffer_load_dwordx4 v76, s[8:11], s64 offen offset:1024 sc1 lds
Cf3_top2:
  s_waitcnt lgkmcnt(1)
  v_smfmac_f32_16x16x64_bf16 v[20:23], v[0:3], v[60:67], v74
  ds_read_b128 v[60:63], v76 offset:47104
  v_smfmac_f32_16x16x64_bf16 v[24:27], v[0:3], v[44:51], v74
  s_mov_b32 m0, 15872
  ds_read_b128 v[64:67], v76 offset:48128
  s_waitcnt lgkmcnt(2)
  v_smfmac_f32_16x16x64_bf16 v[20:23], v[4:7], v[80:87], v74
  buffer_load_dwordx4 v[44:47], v76, s[8:11], s58 offen offset:0 sc1
  ds_read_b128 v[8:11], v76 offset:6656
  v_smfmac_f32_16x16x64_bf16 v[28:31], v[0:3], v[36:43], v74
  ds_read_b128 v[36:39], v76 offset:61440
  v_smfmac_f32_16x16x64_bf16 v[24:27], v[4:7], v[88:95], v74
  buffer_load_dwordx4 v[48:51], v76, s[8:11], s58 offen offset:1024 sc1
  ds_read_b128 v[40:43], v76 offset:62464
  v_smfmac_f32_16x16x64_bf16 v[28:31], v[4:7], v[208:215], v74
  ds_read_b128 v[12:15], v76 offset:7680
  v_smfmac_f32_16x16x64_bf16 v[32:35], v[4:7], v[216:223], v74
  buffer_load_dwordx4 v[52:55], v76, s[8:11], s59 offen offset:0 sc1
  s_waitcnt lgkmcnt(4)
  v_smfmac_f32_16x16x64_bf16 v[32:35], v[0:3], v[60:67], v74
  ds_read_b128 v[60:63], v76 offset:63488
  s_waitcnt lgkmcnt(4)
  v_smfmac_f32_16x16x64_bf16 v[20:23], v[8:11], v[96:103], v74
  buffer_load_dwordx4 v[56:59], v76, s[8:11], s59 offen offset:1024 sc1
  ds_read_b128 v[64:67], v76 offset:64512
  v_smfmac_f32_16x16x64_bf16 v[24:27], v[8:11], v[104:111], v74
  ds_read_b128 v[0:3], v76 offset:12800
  s_waitcnt lgkmcnt(4)
  v_smfmac_f32_16x16x64_bf16 v[28:31], v[8:11], v[36:43], v74
  ds_read_b128 v[36:39], v75 offset:12288
  s_waitcnt lgkmcnt(4)
  v_smfmac_f32_16x16x64_bf16 v[20:23], v[12:15], v[112:119], v74
  ds_read_b128 v[40:43], v75 offset:13312
  v_smfmac_f32_16x16x64_bf16 v[24:27], v[12:15], v[120:127], v74
  buffer_load_dword v73, s[8:11], s70 offen lds
  s_waitcnt lgkmcnt(3)
  v_smfmac_f32_16x16x64_bf16 v[32:35], v[8:11], v[60:67], v74
  ds_read_b128 v[60:63], v75 offset:14336
  v_smfmac_f32_16x16x64_bf16 v[28:31], v[12:15], v[224:231], v74
  s_waitcnt vmcnt(5)
  ds_read_b128 v[64:67], v75 offset:15360
  v_smfmac_f32_16x16x64_bf16 v[32:35], v[12:15], v[232:239], v74
  buffer_store_dwordx4 v[16:19], v76, s[8:11], s68 offen sc1
  s_barrier
  s_waitcnt lgkmcnt(4)
  v_smfmac_f32_16x16x64_bf16 v[20:23], v[0:3], v[192:199], v74
  ds_read_b128 v[4:7], v76 offset:8704
  s_waitcnt lgkmcnt(3)
  v_smfmac_f32_16x16x64_bf16 v[28:31], v[0:3], v[36:43], v74
  ds_read_b128 v[16:19], v76 offset:9728
  v_smfmac_f32_16x16x64_bf16 v[24:27], v[0:3], v[200:207], v74
  ds_read_b128 v[36:39], v75 offset:28672
  s_waitcnt lgkmcnt(3)
  v_mov_b32 v68, 0x3f803f80
  v_smfmac_f32_16x16x64_bf16 v[32:35], v[0:3], v[60:67], v74
  ds_read_b128 v[40:43], v75 offset:29696
  s_waitcnt lgkmcnt(3)
  v_smfmac_f32_16x16x64_bf16 v[20:23], v[4:7], v[128:135], v74
  ds_read_b128 v[12:15], v76 offset:10752
  v_mov_b32 v69, 0x3f803f80
  v_smfmac_f32_16x16x64_bf16 v[24:27], v[4:7], v[136:143], v74
  ds_read_b128 v[8:11], v76 offset:11776
  s_waitcnt lgkmcnt(4)
  v_smfmac_f32_16x16x64_bf16 v[20:23], v[16:19], v[144:151], v74
  ds_read_b128 v[60:63], v75 offset:30720
  v_mov_b64 v[70:71], v[68:69]
  v_smfmac_f32_16x16x64_bf16 v[24:27], v[16:19], v[152:159], v74
  ds_read_b128 v[64:67], v75 offset:31744
  s_waitcnt lgkmcnt(4)
  v_smfmac_f32_16x16x64_bf16 v[28:31], v[4:7], v[36:43], v74
  s_waitcnt lgkmcnt(3)
  v_mov_b64 v[36:37], 0
  v_smfmac_f32_16x16x64_bf16 v[20:23], v[12:15], v[160:167], v74
  s_waitcnt lgkmcnt(2)
  v_mov_b64 v[38:39], 0
  v_smfmac_f32_16x16x64_bf16 v[20:23], v[8:11], v[176:183], v74
  v_mov_b64 v[40:41], 0
  v_smfmac_f32_16x16x64_bf16 v[24:27], v[12:15], v[168:175], v74
  v_mov_b64 v[42:43], 0
  v_smfmac_f32_16x16x64_bf16 v[24:27], v[8:11], v[184:191], v74
  s_waitcnt lgkmcnt(0)
  v_add_f32 v20, v20, v22
  v_smfmac_f32_16x16x64_bf16 v[32:35], v[4:7], v[60:67], v74
  v_add_f32 v21, v21, v23
  v_smfmac_f32_16x16x64_bf16 v[28:31], v[16:19], v[240:247], v74
  v_add_f32 v24, v24, v26
  v_cvt_pk_bf16_f32 v22, v20, v24
  v_smfmac_f32_16x16x64_bf16 v[28:31], v[12:15], a[0:7], v74
  ds_write_b32 v79, v22 offset:0
  v_add_f32 v25, v25, v27
  v_cvt_pk_bf16_f32 v23, v21, v25
  v_smfmac_f32_16x16x64_bf16 v[28:31], v[8:11], a[16:23], v74
  ds_write_b32 v79, v23 offset:576
  v_cmp_u_f32 vcc, v20, v21
  v_smfmac_f32_16x16x64_bf16 v[32:35], v[16:19], v[248:255], v74
  v_smfmac_f32_16x16x64_bf16 v[32:35], v[12:15], a[8:15], v74
  v_add_f32 v28, v28, v30
  v_add_f32 v29, v29, v31
  v_smfmac_f32_16x16x64_bf16 v[32:35], v[8:11], a[24:31], v74
  s_cbranch_vccnz Cf3_rec
Cf3_recok:
  v_smfmac_f32_16x16x64_bf16 v[36:39], v[16:19], a[112:119], v74
  s_waitcnt lgkmcnt(0)
  s_barrier
  ds_read_b128 v[60:63], v77
  v_smfmac_f32_16x16x64_bf16 v[40:43], v[16:19], a[120:127], v74
  ds_read_b128 v[64:67], v77 offset:128
  v_add_f32 v32, v32, v34
  v_cvt_pk_bf16_f32 v30, v28, v32
  v_smfmac_f32_16x16x64_bf16 v[36:39], v[0:3], a[160:167], v74
  ds_write_b32 v79, v30 offset:256
  v_add_f32 v33, v33, v35
  v_cvt_pk_bf16_f32 v31, v29, v33
  v_smfmac_f32_16x16x64_bf16 v[40:43], v[0:3], a[168:175], v74
  ds_write_b32 v79, v31 offset:832
  v_xor_b32 v75, 0x8000, v75
  v_smfmac_f32_16x16x64_bf16 v[36:39], v[4:7], a[96:103], v74
  ds_read_b128 v[0:3], v76 offset:4608
  v_mov_b32 v29, 0
  v_smfmac_f32_16x16x64_bf16 v[40:43], v[4:7], a[104:111], v74
  s_waitcnt vmcnt(4) lgkmcnt(3)
  v_mov_b32 v30, 0
  v_mfma_f32_16x16x32_bf16 v[44:47], v[44:47], v[60:63], 0
  ds_read_b128 v[4:7], v76 offset:5632
  s_waitcnt lgkmcnt(2)
  v_mfma_f32_16x16x32_bf16 v[44:47], v[48:51], v[64:67], v[44:47]
  s_barrier
  v_smfmac_f32_16x16x64_bf16 v[36:39], v[8:11], a[144:151], v74
  ds_read_b128 v[20:23], v77 offset:256
  ds_read_b128 v[24:27], v77 offset:384
  v_smfmac_f32_16x16x64_bf16 v[40:43], v[8:11], a[152:159], v74
  ds_read_b128 v[8:11], v76 offset:6656
  v_add_f32_dpp v72, v46, v44 quad_perm:[2,3,0,1] row_mask:0xf bank_mask:0xf
  v_add_f32_dpp v73, v47, v45 quad_perm:[2,3,0,1] row_mask:0xf bank_mask:0xf
  v_smfmac_f32_16x16x64_bf16 v[36:39], v[12:15], a[128:135], v74
  ds_read_b128 v[44:47], v75 offset:8192
  v_exp_f32_dpp v72, v72 quad_perm:[0,1,0,1] row_mask:0xf bank_mask:0xf
  v_smfmac_f32_16x16x64_bf16 v[40:43], v[12:15], a[136:143], v74
  ds_read_b128 v[12:15], v76 offset:7680
  s_waitcnt lgkmcnt(6)
  v_exp_f32_dpp v73, v73 quad_perm:[0,1,0,1] row_mask:0xf bank_mask:0xf
  v_smfmac_f32_16x16x64_bf16 v[36:39], v[0:3], a[32:39], v74
  s_waitcnt lgkmcnt(3)
  v_cvt_pk_bf16_f32 v72, v72, v73
  v_mfma_f32_16x16x32_bf16 v[20:23], v[20:23], v[60:63], 0
  ds_write_b32 v78, v72 offset:524
  v_mfma_f32_16x16x32_bf16 v[20:23], v[24:27], v[64:67], v[20:23]
  ds_read_b128 v[48:51], v75 offset:9216
  v_smfmac_f32_16x16x64_bf16 v[40:43], v[0:3], a[40:47], v74
  ds_read_b128 v[60:63], v75 offset:10240
  v_smfmac_f32_16x16x64_bf16 v[36:39], v[4:7], a[48:55], v74
  s_waitcnt lgkmcnt(5)
  v_add_f32_dpp v24, v22, v20 quad_perm:[2,3,0,1] row_mask:0xf bank_mask:0xf
  v_add_f32_dpp v25, v23, v21 quad_perm:[2,3,0,1] row_mask:0xf bank_mask:0xf
  v_smfmac_f32_16x16x64_bf16 v[36:39], v[8:11], a[64:71], v74
  s_waitcnt lgkmcnt(2)
  s_barrier
  ds_read_b128 v[32:35], v78 offset:512
  v_smfmac_f32_16x16x64_bf16 v[36:39], v[12:15], a[80:87], v74
  ds_read_b128 v[64:67], v75 offset:11264
  v_mul_f32 v24, s69, v24
  v_smfmac_f32_16x16x64_bf16 v[40:43], v[4:7], a[56:63], v74
  v_mul_f32 v25, s69, v25
  v_smfmac_f32_16x16x64_bf16 v[40:43], v[8:11], a[72:79], v74
  v_exp_f32_dpp v24, v24 quad_perm:[0,1,0,1] row_mask:0xf bank_mask:0xf
  v_smfmac_f32_16x16x64_bf16 v[40:43], v[12:15], a[88:95], v74
  s_waitcnt vmcnt(2) lgkmcnt(1)
  v_exp_f32_dpp v25, v25 quad_perm:[0,1,0,1] row_mask:0xf bank_mask:0xf
  v_mfma_f32_16x16x32_bf16 v[8:11], v[32:35], v[68:71], 0
  v_add_f32 v36, v36, v38
  v_add_f32 v37, v37, v39
  v_mfma_f32_16x16x32_bf16 v[0:3], v[32:35], v[52:55], 0
  v_add_f32 v40, v40, v42
  v_add_f32 v41, v41, v43
  v_mfma_f32_16x16x32_bf16 v[4:7], v[32:35], v[56:59], 0
  v_cvt_pk_bf16_f32 v28, v24, v25
  v_cvt_pk_bf16_f32 v72, v36, v37
  v_cvt_pk_bf16_f32 v73, v40, v41
  v_mfma_f32_16x16x16_bf16 v[8:11], v[28:29], v[68:69], v[8:11]
  v_cvt_pk_bf16_f32 v31, v24, v25
  v_mfma_f32_16x16x16_bf16 v[0:3], v[28:29], v[72:73], v[0:3]
  ds_read_b128 v[68:71], v76 offset:13824
  v_mfma_f32_16x16x16_bf16 v[4:7], v[30:31], v[72:73], v[4:7]
  v_rcp_f32 v10, v8
  v_rcp_f32 v11, v9
  v_mul_f32 v0, v10, v0
  v_mul_f32 v1, v11, v1
  s_nop 0
  v_mul_f32 v4, v10, v4
  v_mul_f32 v5, v11, v5
  v_cvt_pk_bf16_f32 v2, v0, v4
  ds_write_b32 v79, v2 offset:8704
  v_cvt_pk_bf16_f32 v3, v1, v5
  ds_write_b32 v79, v3 offset:9280
  v_subrev_u32 v8, 813694976, v8
  v_subrev_u32 v9, 813694976, v9
  v_max_u32 v8, v8, v9
  v_cmp_le_u32 vcc, 503316480, v8
  v_mov_b64 v[16:17], 0
  v_mov_b64 v[18:19], 0
  v_mov_b64 v[20:21], 0
  v_mov_b64 v[22:23], 0
  s_cbranch_vccnz Cf3_mx
Cf3_mxok:
  s_cmp_eq_u32 s66, 63
  s_waitcnt lgkmcnt(0)
  s_barrier
  ds_read_b128 v[0:3], v78 offset:8704
  ds_read_b128 v[4:7], v78 offset:8768
  ds_read_b128 v[8:11], v78 offset:8832
  ds_read_b128 v[12:15], v78 offset:8896
  v_mov_b64 v[24:25], 0
  v_mov_b64 v[26:27], 0
  v_mov_b64 v[28:29], 0
  v_mov_b64 v[30:31], 0
  v_mov_b64 v[32:33], 0
  v_mov_b64 v[34:35], 0
  s_waitcnt lgkmcnt(3)
  v_smfmac_f32_16x16x64_bf16 v[16:19], v[0:3], a[176:183], v74
  ds_read_b128 v[52:55], v75 offset:12288
  ds_read_b128 v[56:59], v75 offset:13312
  s_waitcnt lgkmcnt(4)
  v_smfmac_f32_16x16x64_bf16 v[16:19], v[4:7], a[184:191], v74
  ds_read_b128 v[36:39], v75 offset:14336
  s_waitcnt lgkmcnt(4)
  v_smfmac_f32_16x16x64_bf16 v[16:19], v[8:11], a[192:199], v74
  ds_read_b128 v[40:43], v75 offset:15360
  s_waitcnt lgkmcnt(4)
  v_smfmac_f32_16x16x64_bf16 v[16:19], v[12:15], a[200:207], v74
  s_cbranch_scc1 Cf3_last
  v_smfmac_f32_16x16x64_bf16 v[32:35], v[0:3], v[44:51], v74
  ds_read_b128 v[44:47], v75 offset:28672
  ds_read_b128 v[48:51], v75 offset:29696
  v_smfmac_f32_16x16x64_bf16 v[32:35], v[4:7], v[60:67], v74
  ds_read_b128 v[60:63], v75 offset:30720
  s_waitcnt lgkmcnt(5)
  v_cvt_pk_bf16_f32 v16, v16, v17
  v_cvt_pk_bf16_f32 v17, v18, v19
  v_bfi_b32 v16, 1, s72, v16
  v_smfmac_f32_16x16x64_bf16 v[32:35], v[8:11], v[52:59], v74
  ds_read_b128 v[64:67], v75 offset:31744
  buffer_store_dwordx2 v[16:17], v68, s[8:11], s73 offen
  s_waitcnt lgkmcnt(4)
  v_smfmac_f32_16x16x64_bf16 v[32:35], v[12:15], v[36:43], v74
  ds_read_b128 v[52:55], v75 offset:45056
  v_smfmac_f32_16x16x64_bf16 v[20:23], v[0:3], a[208:215], v74
  ds_read_b128 v[56:59], v75 offset:46080
  v_smfmac_f32_16x16x64_bf16 v[20:23], v[4:7], a[216:223], v74
  ds_read_b128 v[36:39], v75 offset:47104
  s_waitcnt lgkmcnt(5)
  v_cvt_pk_bf16_f32 v32, v32, v33
  v_cvt_pk_bf16_f32 v33, v34, v35
  v_bfi_b32 v32, 1, s72, v32
  v_smfmac_f32_16x16x64_bf16 v[20:23], v[8:11], v[44:51], v74
  ds_read_b128 v[40:43], v75 offset:48128
  buffer_store_dwordx2 v[32:33], v68, s[8:11], s77 offen
  s_waitcnt lgkmcnt(4)
  v_mov_b64 v[18:19], v[72:73]
  v_smfmac_f32_16x16x64_bf16 v[20:23], v[12:15], v[60:67], v74
  ds_read_b128 v[44:47], v75 offset:61440
  v_mov_b64 v[32:33], 0
  v_smfmac_f32_16x16x64_bf16 v[24:27], v[0:3], a[224:231], v74
  ds_read_b128 v[48:51], v75 offset:62464
  v_mov_b64 v[34:35], 0
  v_smfmac_f32_16x16x64_bf16 v[24:27], v[4:7], a[232:239], v74
  ds_read_b128 v[60:63], v75 offset:63488
  s_waitcnt lgkmcnt(5)
  v_cvt_pk_bf16_f32 v20, v20, v21
  v_cvt_pk_bf16_f32 v21, v22, v23
  v_bfi_b32 v20, 1, s72, v20
  v_smfmac_f32_16x16x64_bf16 v[24:27], v[8:11], v[52:59], v74
  ds_read_b128 v[64:67], v75 offset:64512
  buffer_store_dwordx2 v[20:21], v68, s[8:11], s74 offen
  s_waitcnt lgkmcnt(4)
  v_smfmac_f32_16x16x64_bf16 v[24:27], v[12:15], v[36:43], v74
  ds_read_b64 v[16:17], v77 offset:392
  v_xor_b32 v75, 0x8000, v75
  v_smfmac_f32_16x16x64_bf16 v[28:31], v[0:3], a[240:247], v74
  v_smfmac_f32_16x16x64_bf16 v[28:31], v[4:7], a[248:255], v74
  s_waitcnt lgkmcnt(3)
  v_cvt_pk_bf16_f32 v24, v24, v25
  v_cvt_pk_bf16_f32 v25, v26, v27
  v_bfi_b32 v24, 1, s72, v24
  v_smfmac_f32_16x16x64_bf16 v[28:31], v[8:11], v[44:51], v74
  buffer_store_dwordx2 v[24:25], v68, s[8:11], s75 offen
  s_waitcnt lgkmcnt(1)
  v_smfmac_f32_16x16x64_bf16 v[28:31], v[12:15], v[60:67], v74
  ds_read_b128 v[0:3], v76 offset:14848
  s_nop 6
  v_cvt_pk_bf16_f32 v28, v28, v29
  v_cvt_pk_bf16_f32 v29, v30, v31
  v_bfi_b32 v28, 1, s72, v28
  buffer_store_dwordx2 v[28:29], v68, s[8:11], s76 offen
  v_mov_b64 v[20:21], 0
  v_mov_b64 v[22:23], 0
  v_mov_b64 v[24:25], 0
  v_mov_b64 v[26:27], 0
  v_mov_b64 v[28:29], 0
  v_mov_b64 v[30:31], 0
  s_add_u32 s58, s58, 655360
  s_add_u32 s59, s59, 655360
  s_add_u32 s70, s70, 655360
  s_add_u32 s68, s68, 655360
  s_add_u32 s66, s66, 1
  s_xor_b32 s64, s64, 16384
  s_xor_b32 s65, s65, 16384
  s_nop 15
  s_nop 15
  s_nop 15
  s_nop 7
  buffer_load_dwordx4 v[52:55], v76, s[8:11], s60 offen offset:0 sc1
  buffer_load_dwordx4 v[56:59], v76, s[8:11], s60 offen offset:1024 sc1
  s_nop 15
  s_nop 11
  buffer_load_dwordx4 v[36:39], v76, s[8:11], s60 offen offset:0 sc1
  buffer_load_dwordx4 v[40:43], v76, s[8:11], s60 offen offset:1024 sc1
  s_waitcnt lgkmcnt(0)
  s_cmp_eq_u32 s66, 12
  s_cbranch_scc1 Cf3_kv
Cf3_kvb:
  s_waitcnt vmcnt(3)
  v_mfma_f32_16x16x32_bf16 v[4:7], v[0:3], v[52:55], 0
  v_bitop3_b32 v72, v52, v54, s72 bitop3:0x7e
  s_waitcnt vmcnt(2)
  v_mfma_f32_16x16x32_bf16 v[4:7], v[0:3], v[56:59], v[4:7]
  v_bitop3_b32 v73, v56, v58, s72 bitop3:0x7e
  v_bitop3_b32 v72, v72, v73, 1 bitop3:0xa8
  v_cmp_ne_u32 vcc, 0, v72
  s_cbranch_vccnz Cf3_h1r
Cf3_h1p:
  s_nop 2
  v_add_f32_dpp v4, v4, v4 row_ror:4 row_mask:0xf bank_mask:0xf
  v_add_f32_dpp v5, v5, v5 row_ror:4 row_mask:0xf bank_mask:0xf
  s_nop 0
  v_add_f32_dpp v4, v4, v4 row_ror:8 row_mask:0xf bank_mask:0xf
  v_add_f32_dpp v5, v5, v5 row_ror:8 row_mask:0xf bank_mask:0xf
  v_cvt_pk_bf16_f32 v4, v4, v5
  buffer_store_dword v4, v69, s[8:11], s62 offen
Cf3_h1ok:
  s_xor_b32 s62, s62, 16384
  s_xor_b32 s72, s72, 1
Cf3_h2:
  v_lshlrev_b32 v73, 2, v76
  s_mov_b32 m0, 10752
  buffer_store_dword v71, v69, s[8:11], s62 offen
  s_waitcnt vmcnt(2)
  ds_read_b128 v[60:63], v76 offset:28672
  ds_read_b128 v[64:67], v76 offset:29696
  ds_read_b128 v[44:47], v76 offset:30720
  ds_read_b128 v[48:51], v76 offset:31744
  ds_read_b128 v[36:39], v76 offset:45056
  ds_read_b128 v[40:43], v76 offset:46080
  s_cmp_eq_u32 s66, 12
  s_cbranch_scc1 Cf3_kv2
  s_branch Cf3_top
Cf3_rec:
  s_nop 7
  s_waitcnt vmcnt(0) lgkmcnt(0)
  v_max3_u32 v72, v0, v1, v2
  v_max3_u32 v72, v72, v3, v4
  v_max3_u32 v72, v72, v5, v6
  v_max3_u32 v72, v72, v7, v8
  v_max3_u32 v72, v72, v9, v10
  v_max3_u32 v72, v72, v11, v12
  v_max3_u32 v72, v72, v13, v14
  v_max3_u32 v72, v72, v15, v16
  v_max3_u32 v72, v72, v17, v18
  v_max_u32 v72, v72, v19
  v_cmp_eq_u32 vcc, -1, v72
  s_cbranch_vccz Cf3_recok
  s_barrier
Cf3_recp:
  buffer_load_dwordx4 v[60:63], v76, s[8:11], s64 offen offset:0 sc1
  buffer_load_dwordx4 v[64:67], v76, s[8:11], s64 offen offset:1024 sc1
  s_add_u32 s67, s67, 1
  s_cmp_lt_u32 s67, 131072
  s_cselect_b32 s54, -2, -1
  s_waitcnt vmcnt(1)
  v_max3_u32 v72, v60, v61, v62
  s_waitcnt vmcnt(0)
  v_max3_u32 v72, v72, v63, v64
  v_max3_u32 v72, v72, v65, v66
  v_max_u32 v72, v72, v67
  v_cmp_lt_u32 vcc, s54, v72
  s_cbranch_vccnz Cf3_recp
  ds_write_b128 v76, v[60:63] offset:10752
  ds_write_b128 v76, v[64:67] offset:11776
  v_mov_b64 v[20:21], 0
  v_mov_b64 v[22:23], 0
  v_mov_b64 v[24:25], 0
  v_mov_b64 v[26:27], 0
  v_mov_b64 v[28:29], 0
  v_mov_b64 v[30:31], 0
  v_mov_b64 v[32:33], 0
  v_mov_b64 v[34:35], 0
  s_waitcnt lgkmcnt(0)
  s_barrier
  ds_read_b128 v[0:3], v76 offset:4608
  ds_read_b128 v[60:63], v76 offset:28672
  ds_read_b128 v[64:67], v76 offset:29696
  s_waitcnt lgkmcnt(0)
  v_smfmac_f32_16x16x64_bf16 v[20:23], v[0:3], v[60:67], v74
  ds_read_b128 v[60:63], v76 offset:30720
  ds_read_b128 v[64:67], v76 offset:31744
  s_waitcnt lgkmcnt(0)
  v_smfmac_f32_16x16x64_bf16 v[24:27], v[0:3], v[60:67], v74
  ds_read_b128 v[60:63], v76 offset:45056
  ds_read_b128 v[64:67], v76 offset:46080
  s_waitcnt lgkmcnt(0)
  v_smfmac_f32_16x16x64_bf16 v[28:31], v[0:3], v[60:67], v74
  ds_read_b128 v[60:63], v76 offset:47104
  ds_read_b128 v[64:67], v76 offset:48128
  s_waitcnt lgkmcnt(0)
  v_smfmac_f32_16x16x64_bf16 v[32:35], v[0:3], v[60:67], v74
  ds_read_b128 v[4:7], v76 offset:5632
  s_waitcnt lgkmcnt(0)
  v_smfmac_f32_16x16x64_bf16 v[20:23], v[4:7], v[80:87], v74
  v_smfmac_f32_16x16x64_bf16 v[24:27], v[4:7], v[88:95], v74
  v_smfmac_f32_16x16x64_bf16 v[28:31], v[4:7], v[208:215], v74
  v_smfmac_f32_16x16x64_bf16 v[32:35], v[4:7], v[216:223], v74
  ds_read_b128 v[8:11], v76 offset:6656
  s_waitcnt lgkmcnt(0)
  v_smfmac_f32_16x16x64_bf16 v[20:23], v[8:11], v[96:103], v74
  v_smfmac_f32_16x16x64_bf16 v[24:27], v[8:11], v[104:111], v74
  ds_read_b128 v[60:63], v76 offset:61440
  ds_read_b128 v[64:67], v76 offset:62464
  s_waitcnt lgkmcnt(0)
  v_smfmac_f32_16x16x64_bf16 v[28:31], v[8:11], v[60:67], v74
  ds_read_b128 v[60:63], v76 offset:63488
  ds_read_b128 v[64:67], v76 offset:64512
  s_waitcnt lgkmcnt(0)
  v_smfmac_f32_16x16x64_bf16 v[32:35], v[8:11], v[60:67], v74
  ds_read_b128 v[12:15], v76 offset:7680
  s_waitcnt lgkmcnt(0)
  v_smfmac_f32_16x16x64_bf16 v[20:23], v[12:15], v[112:119], v74
  v_smfmac_f32_16x16x64_bf16 v[24:27], v[12:15], v[120:127], v74
  v_smfmac_f32_16x16x64_bf16 v[28:31], v[12:15], v[224:231], v74
  v_smfmac_f32_16x16x64_bf16 v[32:35], v[12:15], v[232:239], v74
  ds_read_b128 v[4:7], v76 offset:8704
  s_waitcnt lgkmcnt(0)
  v_smfmac_f32_16x16x64_bf16 v[20:23], v[4:7], v[128:135], v74
  v_smfmac_f32_16x16x64_bf16 v[24:27], v[4:7], v[136:143], v74
  ds_read_b128 v[60:63], v75 offset:28672
  ds_read_b128 v[64:67], v75 offset:29696
  s_waitcnt lgkmcnt(0)
  v_smfmac_f32_16x16x64_bf16 v[28:31], v[4:7], v[60:67], v74
  ds_read_b128 v[60:63], v75 offset:30720
  ds_read_b128 v[64:67], v75 offset:31744
  s_waitcnt lgkmcnt(0)
  v_smfmac_f32_16x16x64_bf16 v[32:35], v[4:7], v[60:67], v74
  ds_read_b128 v[16:19], v76 offset:9728
  s_waitcnt lgkmcnt(0)
  v_smfmac_f32_16x16x64_bf16 v[20:23], v[16:19], v[144:151], v74
  v_smfmac_f32_16x16x64_bf16 v[24:27], v[16:19], v[152:159], v74
  v_smfmac_f32_16x16x64_bf16 v[28:31], v[16:19], v[240:247], v74
  v_smfmac_f32_16x16x64_bf16 v[32:35], v[16:19], v[248:255], v74
  ds_read_b128 v[12:15], v76 offset:10752
  s_waitcnt lgkmcnt(0)
  v_smfmac_f32_16x16x64_bf16 v[20:23], v[12:15], v[160:167], v74
  v_smfmac_f32_16x16x64_bf16 v[24:27], v[12:15], v[168:175], v74
  v_smfmac_f32_16x16x64_bf16 v[28:31], v[12:15], a[0:7], v74
  v_smfmac_f32_16x16x64_bf16 v[32:35], v[12:15], a[8:15], v74
  ds_read_b128 v[8:11], v76 offset:11776
  s_waitcnt lgkmcnt(0)
  v_smfmac_f32_16x16x64_bf16 v[20:23], v[8:11], v[176:183], v74
  v_smfmac_f32_16x16x64_bf16 v[24:27], v[8:11], v[184:191], v74
  v_smfmac_f32_16x16x64_bf16 v[28:31], v[8:11], a[16:23], v74
  v_smfmac_f32_16x16x64_bf16 v[32:35], v[8:11], a[24:31], v74
  ds_read_b128 v[0:3], v76 offset:12800
  s_waitcnt lgkmcnt(0)
  v_smfmac_f32_16x16x64_bf16 v[20:23], v[0:3], v[192:199], v74
  v_smfmac_f32_16x16x64_bf16 v[24:27], v[0:3], v[200:207], v74
  ds_read_b128 v[60:63], v75 offset:12288
  ds_read_b128 v[64:67], v75 offset:13312
  s_waitcnt lgkmcnt(0)
  v_smfmac_f32_16x16x64_bf16 v[28:31], v[0:3], v[60:67], v74
  ds_read_b128 v[60:63], v75 offset:14336
  ds_read_b128 v[64:67], v75 offset:15360
  s_waitcnt lgkmcnt(0)
  v_smfmac_f32_16x16x64_bf16 v[32:35], v[0:3], v[60:67], v74
  v_add_f32 v20, v20, v22
  v_add_f32 v21, v21, v23
  v_add_f32 v24, v24, v26
  v_cvt_pk_bf16_f32 v22, v20, v24
  ds_write_b32 v79, v22 offset:0
  v_add_f32 v25, v25, v27
  v_cvt_pk_bf16_f32 v23, v21, v25
  ds_write_b32 v79, v23 offset:576
  v_add_f32 v28, v28, v30
  v_add_f32 v29, v29, v31
  s_waitcnt lgkmcnt(0)
  s_nop 1
  s_branch Cf3_recok
Cf3_mx:
  s_waitcnt lgkmcnt(0)
  s_barrier
  buffer_load_dwordx4 v[0:3], v76, s[8:11], s58 offen offset:0 sc1
  ds_read_b128 v[20:23], v77 offset:0
  ds_read_b128 v[28:31], v77 offset:256
  buffer_load_dwordx4 v[4:7], v76, s[8:11], s58 offen offset:1024 sc1
  ds_read_b128 v[24:27], v77 offset:128
  ds_read_b128 v[32:35], v77 offset:384
  s_waitcnt vmcnt(1) lgkmcnt(3)
  v_mfma_f32_16x16x32_bf16 v[8:11], v[0:3], v[20:23], 0
  s_waitcnt vmcnt(0) lgkmcnt(1)
  v_mfma_f32_16x16x32_bf16 v[8:11], v[4:7], v[24:27], v[8:11]
  v_mfma_f32_16x16x32_bf16 v[12:15], v[28:31], v[20:23], 0
  s_waitcnt lgkmcnt(0)
  v_mfma_f32_16x16x32_bf16 v[12:15], v[32:35], v[24:27], v[12:15]
  v_add_f32_dpp v8, v10, v8 quad_perm:[2,3,0,1] row_mask:0xf bank_mask:0xf
  v_add_f32_dpp v9, v11, v9 quad_perm:[2,3,0,1] row_mask:0xf bank_mask:0xf
  s_nop 0
  v_mov_b32_dpp v8, v8 quad_perm:[0,1,0,1] row_mask:0xf bank_mask:0xf
  v_mov_b32_dpp v9, v9 quad_perm:[0,1,0,1] row_mask:0xf bank_mask:0xf
  s_nop 1
  v_add_f32_dpp v12, v14, v12 quad_perm:[2,3,0,1] row_mask:0xf bank_mask:0xf
  v_add_f32_dpp v13, v15, v13 quad_perm:[2,3,0,1] row_mask:0xf bank_mask:0xf
  s_nop 0
  v_mov_b32_dpp v12, v12 quad_perm:[0,1,0,1] row_mask:0xf bank_mask:0xf
  v_mov_b32_dpp v13, v13 quad_perm:[0,1,0,1] row_mask:0xf bank_mask:0xf
  v_mul_f32 v12, s69, v12
  ds_write_b32 v78, v8 offset:8716
  v_mul_f32 v13, s69, v13
  ds_write_b32 v78, v9 offset:8780
  s_waitcnt lgkmcnt(0)
  s_barrier
  ds_read_b128 v[36:39], v78 offset:8704
  ds_read_b128 v[40:43], v78 offset:8768
  s_waitcnt lgkmcnt(0)
  s_barrier
  v_max_f32 v16, v36, v37
  v_max3_f32 v16, v16, v38, v39
  v_max3_f32 v16, v16, v40, v41
  v_max3_f32 v16, v16, v42, v43
  v_max3_f32 v16, v16, v12, v13
  v_mov_b32 v17, v16
  s_nop 1
  v_permlane16_swap_b32 v16, v17
  v_max_f32 v16, v16, v17
  v_mov_b32 v17, v16
  s_nop 1
  v_permlane32_swap_b32 v16, v17
  v_max_f32 v16, v16, v17
  v_sub_f32 v36, v36, v16
  v_sub_f32 v37, v37, v16
  v_sub_f32 v38, v38, v16
  v_sub_f32 v39, v39, v16
  v_sub_f32 v40, v40, v16
  v_sub_f32 v41, v41, v16
  v_sub_f32 v42, v42, v16
  v_sub_f32 v43, v43, v16
  v_sub_f32 v12, v12, v16
  v_sub_f32 v13, v13, v16
  v_exp_f32 v36, v36
  v_exp_f32 v37, v37
  v_exp_f32 v38, v38
  v_exp_f32 v39, v39
  v_exp_f32 v40, v40
  v_exp_f32 v41, v41
  v_exp_f32 v42, v42
  v_exp_f32 v43, v43
  v_exp_f32 v12, v12
  v_exp_f32 v13, v13
  v_cvt_pk_bf16_f32 v32, v36, v40
  v_cvt_pk_bf16_f32 v33, v37, v41
  v_cvt_pk_bf16_f32 v34, v38, v42
  v_cvt_pk_bf16_f32 v35, v39, v43
  v_cvt_pk_bf16_f32 v28, v12, v13
  v_cvt_pk_bf16_f32 v31, v12, v13
  v_mov_b32 v29, 0
  v_mov_b32 v30, 0
  v_mov_b32 v68, 0x3f803f80
  v_mov_b32 v69, 0x3f803f80
  v_mov_b32 v70, 0x3f803f80
  v_mov_b32 v71, 0x3f803f80
  s_nop 1
  v_mfma_f32_16x16x32_bf16 v[8:11], v[32:35], v[68:71], 0
  v_mfma_f32_16x16x32_bf16 v[0:3], v[32:35], v[52:55], 0
  v_mfma_f32_16x16x32_bf16 v[4:7], v[32:35], v[56:59], 0
  v_mfma_f32_16x16x16_bf16 v[8:11], v[28:29], v[68:69], v[8:11]
  v_mfma_f32_16x16x16_bf16 v[0:3], v[28:29], v[72:73], v[0:3]
  v_mfma_f32_16x16x16_bf16 v[4:7], v[30:31], v[72:73], v[4:7]
  ds_read_b128 v[68:71], v76 offset:13824
  v_rcp_f32 v10, v8
  v_rcp_f32 v11, v9
  v_mul_f32 v0, v10, v0
  v_mul_f32 v1, v11, v1
  s_nop 0
  v_mul_f32 v4, v10, v4
  v_mul_f32 v5, v11, v5
  v_cvt_pk_bf16_f32 v2, v0, v4
  ds_write_b32 v79, v2 offset:8704
  v_cvt_pk_bf16_f32 v3, v1, v5
  ds_write_b32 v79, v3 offset:9280
  v_mov_b64 v[16:17], 0
  v_mov_b64 v[18:19], 0
  v_mov_b64 v[20:21], 0
  v_mov_b64 v[22:23], 0
  s_branch Cf3_mxok
Cf3_kv:
  s_lshl_b32 s56, s53, 2
  s_add_u32 s56, s56, 128
  s_load_dword s57, s[12:13], s56 glc
  s_branch Cf3_kvb
Cf3_kv2:
  s_waitcnt lgkmcnt(0)
  s_cmp_ge_u32 s57, 0x700
  s_cbranch_scc1 Cf3_top
  s_load_dword s57, s[12:13], s56 glc
  s_add_u32 s67, s67, 1
  s_cmp_lt_u32 s67, 131072
  s_cbranch_scc1 Cf3_kv2
  s_branch Cf3_top
Cf3_h1r:
  s_mov_b64 exec, vcc
  buffer_load_dwordx4 v[52:55], v76, s[8:11], s60 offen offset:0 sc1
  buffer_load_dwordx4 v[56:59], v76, s[8:11], s60 offen offset:1024 sc1
  s_mov_b64 exec, -1
  s_add_u32 s67, s67, 1
  s_waitcnt vmcnt(3)
  v_mfma_f32_16x16x32_bf16 v[4:7], v[0:3], v[36:39], 0
  v_bitop3_b32 v72, v36, v38, s72 bitop3:0x7e
  s_waitcnt vmcnt(2)
  v_mfma_f32_16x16x32_bf16 v[4:7], v[0:3], v[40:43], v[4:7]
  v_bitop3_b32 v73, v40, v42, s72 bitop3:0x7e
  v_bitop3_b32 v72, v72, v73, 1 bitop3:0xa8
  v_cmp_ne_u32 vcc, 0, v72
  s_cbranch_vccz Cf3_h1p
  s_mov_b64 exec, vcc
  buffer_load_dwordx4 v[36:39], v76, s[8:11], s60 offen offset:0 sc1
  buffer_load_dwordx4 v[40:43], v76, s[8:11], s60 offen offset:1024 sc1
  s_mov_b64 exec, -1
  s_add_u32 s67, s67, 1
  s_waitcnt vmcnt(3)
  v_mfma_f32_16x16x32_bf16 v[4:7], v[0:3], v[52:55], 0
  v_bitop3_b32 v72, v52, v54, s72 bitop3:0x7e
  s_waitcnt vmcnt(2)
  v_mfma_f32_16x16x32_bf16 v[4:7], v[0:3], v[56:59], v[4:7]
  v_bitop3_b32 v73, v56, v58, s72 bitop3:0x7e
  v_bitop3_b32 v72, v72, v73, 1 bitop3:0xa8
  v_cmp_ne_u32 vcc, 0, v72
  s_cbranch_vccz Cf3_h1p
  s_cmp_lt_u32 s67, 131072
  s_cbranch_scc1 Cf3_h1r
  s_branch Cf3_h1p
Cf3_last:
  s_nop 7
  s_waitcnt vmcnt(0) lgkmcnt(0)
  ds_read_b64 v[16:17], v77 offset:392
  v_mov_b64 v[18:19], v[72:73]
  s_add_u32 s68, s68, 655360
  s_waitcnt lgkmcnt(0)
  buffer_store_dwordx4 v[16:19], v76, s[8:11], s68 offen sc1
  s_waitcnt vmcnt(0)
  s_barrier
  s_branch L_cexit
L_w4:
  v_mov_b64 v[20:21], 0
  v_mov_b64 v[22:23], 0
  v_mov_b64 v[24:25], 0
  v_mov_b64 v[26:27], 0
  v_mov_b64 v[28:29], 0
  v_mov_b64 v[30:31], 0
  v_mov_b64 v[32:33], 0
  v_mov_b64 v[34:35], 0
  s_mov_b32 m0, 15872
  v_lshlrev_b32 v73, 2, v76
  v_mov_b32 v72, 0
  ds_read_b128 v[60:63], v76 offset:16384
  ds_read_b128 v[64:67], v76 offset:17408
  ds_read_b128 v[44:47], v76 offset:18432
  ds_read_b128 v[48:51], v76 offset:19456
  ds_read_b128 v[36:39], v76 offset:32768
  ds_read_b128 v[40:43], v76 offset:33792
  ds_read_b128 v[0:3], v76 offset:4608
  ds_read_b128 v[4:7], v76 offset:5632
  s_branch Cs0_top2
.p2align 6
Cs0_top:
  s_waitcnt lgkmcnt(0)
  s_barrier
  ds_read_b128 v[0:3], v76 offset:4608
  ds_read_b128 v[4:7], v76 offset:5632
Cs0_top2:
  s_waitcnt lgkmcnt(1)
  v_smfmac_f32_16x16x64_bf16 v[20:23], v[0:3], v[60:67], v74
  ds_read_b128 v[60:63], v76 offset:34816
  v_smfmac_f32_16x16x64_bf16 v[24:27], v[0:3], v[44:51], v74
  ds_read_b128 v[64:67], v76 offset:35840
  s_waitcnt lgkmcnt(2)
  v_smfmac_f32_16x16x64_bf16 v[20:23], v[4:7], v[80:87], v74
  buffer_load_dwordx4 v[44:47], v76, s[8:11], s58 offen offset:0 sc1
  ds_read_b128 v[8:11], v76 offset:6656
  v_smfmac_f32_16x16x64_bf16 v[28:31], v[0:3], v[36:43], v74
  ds_read_b128 v[36:39], v76 offset:49152
  v_smfmac_f32_16x16x64_bf16 v[24:27], v[4:7], v[88:95], v74
  buffer_load_dwordx4 v[48:51], v76, s[8:11], s58 offen offset:1024 sc1
  ds_read_b128 v[40:43], v76 offset:50176
  v_smfmac_f32_16x16x64_bf16 v[28:31], v[4:7], v[208:215], v74
  s_waitcnt vmcnt(4)
  ds_read_b128 v[12:15], v76 offset:7680
  v_smfmac_f32_16x16x64_bf16 v[32:35], v[4:7], v[216:223], v74
  buffer_load_dwordx4 v[52:55], v76, s[8:11], s59 offen offset:0 sc1
  s_waitcnt lgkmcnt(4)
  v_smfmac_f32_16x16x64_bf16 v[32:35], v[0:3], v[60:67], v74
  ds_read_b128 v[60:63], v76 offset:51200
  s_waitcnt lgkmcnt(4)
  v_smfmac_f32_16x16x64_bf16 v[20:23], v[8:11], v[96:103], v74
  buffer_load_dwordx4 v[56:59], v76, s[8:11], s59 offen offset:1024 sc1
  ds_read_b128 v[64:67], v76 offset:52224
  v_smfmac_f32_16x16x64_bf16 v[24:27], v[8:11], v[104:111], v74
  buffer_store_dwordx4 v[16:19], v76, s[8:11], s68 offen sc1
  ds_read_b128 v[0:3], v76 offset:12800
  s_waitcnt lgkmcnt(4)
  v_smfmac_f32_16x16x64_bf16 v[28:31], v[8:11], v[36:43], v74
  ds_read_b128 v[36:39], v75 offset:0
  s_waitcnt lgkmcnt(4)
  v_smfmac_f32_16x16x64_bf16 v[20:23], v[12:15], v[112:119], v74
  ds_read_b128 v[40:43], v75 offset:1024
  v_smfmac_f32_16x16x64_bf16 v[24:27], v[12:15], v[120:127], v74
  buffer_load_dword v73, s[8:11], s70 offen lds
  s_waitcnt lgkmcnt(3)
  v_smfmac_f32_16x16x64_bf16 v[32:35], v[8:11], v[60:67], v74
  ds_read_b128 v[60:63], v75 offset:2048
  v_smfmac_f32_16x16x64_bf16 v[28:31], v[12:15], v[224:231], v74
  ds_read_b128 v[64:67], v75 offset:3072
  v_smfmac_f32_16x16x64_bf16 v[32:35], v[12:15], v[232:239], v74
  s_barrier
  s_waitcnt lgkmcnt(4)
  v_smfmac_f32_16x16x64_bf16 v[20:23], v[0:3], v[192:199], v74
  ds_read_b128 v[4:7], v76 offset:8704
  s_waitcnt lgkmcnt(3)
  v_smfmac_f32_16x16x64_bf16 v[28:31], v[0:3], v[36:43], v74
  ds_read_b128 v[16:19], v76 offset:9728
  v_smfmac_f32_16x16x64_bf16 v[24:27], v[0:3], v[200:207], v74
  ds_read_b128 v[36:39], v75 offset:16384
  s_waitcnt lgkmcnt(3)
  v_mov_b32 v68, 0x3f803f80
  v_smfmac_f32_16x16x64_bf16 v[32:35], v[0:3], v[60:67], v74
  ds_read_b128 v[40:43], v75 offset:17408
  s_waitcnt lgkmcnt(3)
  v_smfmac_f32_16x16x64_bf16 v[20:23], v[4:7], v[128:135], v74
  ds_read_b128 v[12:15], v76 offset:10752
  v_mov_b32 v69, 0x3f803f80
  v_smfmac_f32_16x16x64_bf16 v[24:27], v[4:7], v[136:143], v74
  ds_read_b128 v[8:11], v76 offset:11776
  s_waitcnt lgkmcnt(4)
  v_smfmac_f32_16x16x64_bf16 v[20:23], v[16:19], v[144:151], v74
  ds_read_b128 v[60:63], v75 offset:18432
  v_mov_b64 v[70:71], v[68:69]
  v_smfmac_f32_16x16x64_bf16 v[24:27], v[16:19], v[152:159], v74
  ds_read_b128 v[64:67], v75 offset:19456
  s_waitcnt lgkmcnt(4)
  v_smfmac_f32_16x16x64_bf16 v[28:31], v[4:7], v[36:43], v74
  s_waitcnt lgkmcnt(3)
  v_mov_b64 v[36:37], 0
  v_smfmac_f32_16x16x64_bf16 v[20:23], v[12:15], v[160:167], v74
  s_waitcnt lgkmcnt(2)
  v_mov_b64 v[38:39], 0
  v_smfmac_f32_16x16x64_bf16 v[20:23], v[8:11], v[176:183], v74
  v_mov_b64 v[40:41], 0
  v_smfmac_f32_16x16x64_bf16 v[24:27], v[12:15], v[168:175], v74
  v_mov_b64 v[42:43], 0
  v_smfmac_f32_16x16x64_bf16 v[24:27], v[8:11], v[184:191], v74
  s_waitcnt lgkmcnt(0)
  v_add_f32 v20, v20, v22
  v_smfmac_f32_16x16x64_bf16 v[32:35], v[4:7], v[60:67], v74
  v_add_f32 v21, v21, v23
  v_smfmac_f32_16x16x64_bf16 v[28:31], v[16:19], v[240:247], v74
  v_add_f32 v24, v24, v26
  v_cvt_pk_bf16_f32 v22, v20, v24
  v_smfmac_f32_16x16x64_bf16 v[28:31], v[12:15], a[0:7], v74
  ds_write_b32 v79, v22 offset:0
  v_add_f32 v25, v25, v27
  v_cvt_pk_bf16_f32 v23, v21, v25
  v_smfmac_f32_16x16x64_bf16 v[28:31], v[8:11], a[16:23], v74
  ds_write_b32 v79, v23 offset:576
  v_cmp_u_f32 vcc, v20, v21
  v_smfmac_f32_16x16x64_bf16 v[32:35], v[16:19], v[248:255], v74
  v_smfmac_f32_16x16x64_bf16 v[32:35], v[12:15], a[8:15], v74
  v_add_f32 v28, v28, v30
  v_add_f32 v29, v29, v31
  v_smfmac_f32_16x16x64_bf16 v[32:35], v[8:11], a[24:31], v74
  s_cbranch_vccnz Cs0_rec
Cs0_recok:
  v_smfmac_f32_16x16x64_bf16 v[36:39], v[16:19], a[112:119], v74
  s_waitcnt lgkmcnt(0)
  s_barrier
  ds_read_b128 v[60:63], v77
  v_smfmac_f32_16x16x64_bf16 v[40:43], v[16:19], a[120:127], v74
  ds_read_b128 v[64:67], v77 offset:128
  v_add_f32 v32, v32, v34
  v_cvt_pk_bf16_f32 v30, v28, v32
  v_smfmac_f32_16x16x64_bf16 v[36:39], v[0:3], a[160:167], v74
  ds_write_b32 v79, v30 offset:256
  v_add_f32 v33, v33, v35
  v_cvt_pk_bf16_f32 v31, v29, v33
  v_smfmac_f32_16x16x64_bf16 v[40:43], v[0:3], a[168:175], v74
  ds_write_b32 v79, v31 offset:832
  v_xor_b32 v75, 0x8000, v75
  v_smfmac_f32_16x16x64_bf16 v[36:39], v[4:7], a[96:103], v74
  ds_read_b128 v[0:3], v76 offset:4608
  v_mov_b32 v29, 0
  v_smfmac_f32_16x16x64_bf16 v[40:43], v[4:7], a[104:111], v74
  s_waitcnt vmcnt(4) lgkmcnt(3)
  v_mov_b32 v30, 0
  v_mfma_f32_16x16x32_bf16 v[44:47], v[44:47], v[60:63], 0
  ds_read_b128 v[4:7], v76 offset:5632
  s_waitcnt lgkmcnt(2)
  v_mfma_f32_16x16x32_bf16 v[44:47], v[48:51], v[64:67], v[44:47]
  s_barrier
  v_smfmac_f32_16x16x64_bf16 v[36:39], v[8:11], a[144:151], v74
  ds_read_b128 v[20:23], v77 offset:256
  ds_read_b128 v[24:27], v77 offset:384
  v_smfmac_f32_16x16x64_bf16 v[40:43], v[8:11], a[152:159], v74
  ds_read_b128 v[8:11], v76 offset:6656
  v_add_f32_dpp v72, v46, v44 quad_perm:[2,3,0,1] row_mask:0xf bank_mask:0xf
  v_add_f32_dpp v73, v47, v45 quad_perm:[2,3,0,1] row_mask:0xf bank_mask:0xf
  v_smfmac_f32_16x16x64_bf16 v[36:39], v[12:15], a[128:135], v74
  ds_read_b128 v[44:47], v75 offset:16384
  v_exp_f32_dpp v72, v72 quad_perm:[0,1,0,1] row_mask:0xf bank_mask:0xf
  v_smfmac_f32_16x16x64_bf16 v[40:43], v[12:15], a[136:143], v74
  ds_read_b128 v[12:15], v76 offset:7680
  s_waitcnt lgkmcnt(6)
  v_exp_f32_dpp v73, v73 quad_perm:[0,1,0,1] row_mask:0xf bank_mask:0xf
  v_smfmac_f32_16x16x64_bf16 v[36:39], v[0:3], a[32:39], v74
  s_waitcnt lgkmcnt(3)
  v_cvt_pk_bf16_f32 v72, v72, v73
  v_mfma_f32_16x16x32_bf16 v[20:23], v[20:23], v[60:63], 0
  ds_write_b32 v78, v72 offset:512
  v_mfma_f32_16x16x32_bf16 v[20:23], v[24:27], v[64:67], v[20:23]
  ds_read_b128 v[48:51], v75 offset:17408
  v_smfmac_f32_16x16x64_bf16 v[40:43], v[0:3], a[40:47], v74
  ds_read_b128 v[60:63], v75 offset:18432
  v_smfmac_f32_16x16x64_bf16 v[36:39], v[4:7], a[48:55], v74
  s_waitcnt lgkmcnt(5)
  v_add_f32_dpp v24, v22, v20 quad_perm:[2,3,0,1] row_mask:0xf bank_mask:0xf
  v_add_f32_dpp v25, v23, v21 quad_perm:[2,3,0,1] row_mask:0xf bank_mask:0xf
  v_smfmac_f32_16x16x64_bf16 v[36:39], v[8:11], a[64:71], v74
  s_waitcnt lgkmcnt(2)
  s_barrier
  ds_read_b128 v[32:35], v78 offset:512
  v_smfmac_f32_16x16x64_bf16 v[36:39], v[12:15], a[80:87], v74
  ds_read_b128 v[64:67], v75 offset:19456
  v_mul_f32 v24, s69, v24
  v_smfmac_f32_16x16x64_bf16 v[40:43], v[4:7], a[56:63], v74
  v_mul_f32 v25, s69, v25
  v_smfmac_f32_16x16x64_bf16 v[40:43], v[8:11], a[72:79], v74
  v_exp_f32_dpp v24, v24 quad_perm:[0,1,0,1] row_mask:0xf bank_mask:0xf
  v_smfmac_f32_16x16x64_bf16 v[40:43], v[12:15], a[88:95], v74
  s_waitcnt vmcnt(2) lgkmcnt(1)
  v_exp_f32_dpp v25, v25 quad_perm:[0,1,0,1] row_mask:0xf bank_mask:0xf
  v_mfma_f32_16x16x32_bf16 v[8:11], v[32:35], v[68:71], 0
  v_add_f32 v36, v36, v38
  v_add_f32 v37, v37, v39
  v_mfma_f32_16x16x32_bf16 v[0:3], v[32:35], v[52:55], 0
  v_add_f32 v40, v40, v42
  v_add_f32 v41, v41, v43
  v_mfma_f32_16x16x32_bf16 v[4:7], v[32:35], v[56:59], 0
  v_cvt_pk_bf16_f32 v28, v24, v25
  v_cvt_pk_bf16_f32 v72, v36, v37
  v_cvt_pk_bf16_f32 v73, v40, v41
  v_mfma_f32_16x16x16_bf16 v[8:11], v[28:29], v[68:69], v[8:11]
  v_cvt_pk_bf16_f32 v31, v24, v25
  v_mfma_f32_16x16x16_bf16 v[0:3], v[28:29], v[72:73], v[0:3]
  ds_read_b128 v[68:71], v76 offset:13824
  v_mfma_f32_16x16x16_bf16 v[4:7], v[30:31], v[72:73], v[4:7]
  v_rcp_f32 v10, v8
  v_rcp_f32 v11, v9
  v_mul_f32 v0, v10, v0
  v_mul_f32 v1, v11, v1
  s_nop 0
  v_mul_f32 v4, v10, v4
  v_mul_f32 v5, v11, v5
  v_cvt_pk_bf16_f32 v2, v0, v4
  ds_write_b32 v79, v2 offset:8704
  v_cvt_pk_bf16_f32 v3, v1, v5
  ds_write_b32 v79, v3 offset:9280
  v_subrev_u32 v8, 813694976, v8
  v_subrev_u32 v9, 813694976, v9
  v_max_u32 v8, v8, v9
  v_cmp_le_u32 vcc, 503316480, v8
  v_mov_b64 v[16:17], 0
  v_mov_b64 v[18:19], 0
  v_mov_b64 v[20:21], 0
  v_mov_b64 v[22:23], 0
  s_cbranch_vccnz Cs0_mx
Cs0_mxok:
  s_cmp_eq_u32 s66, 63
  s_waitcnt lgkmcnt(0)
  s_barrier
  ds_read_b128 v[0:3], v78 offset:8704
  ds_read_b128 v[4:7], v78 offset:8768
  ds_read_b128 v[8:11], v78 offset:8832
  ds_read_b128 v[12:15], v78 offset:8896
  v_mov_b64 v[24:25], 0
  v_mov_b64 v[26:27], 0
  v_mov_b64 v[28:29], 0
  v_mov_b64 v[30:31], 0
  v_mov_b64 v[32:33], 0
  v_mov_b64 v[34:35], 0
  s_waitcnt lgkmcnt(3)
  v_smfmac_f32_16x16x64_bf16 v[16:19], v[0:3], a[176:183], v74
  s_cbranch_scc1 Cs0_last
  s_waitcnt lgkmcnt(2)
  v_smfmac_f32_16x16x64_bf16 v[16:19], v[4:7], a[184:191], v74
  s_waitcnt lgkmcnt(1)
  v_smfmac_f32_16x16x64_bf16 v[16:19], v[8:11], a[192:199], v74
  ds_read_b128 v[52:55], v75 offset:32768
  s_waitcnt lgkmcnt(1)
  v_smfmac_f32_16x16x64_bf16 v[16:19], v[12:15], a[200:207], v74
  ds_read_b128 v[56:59], v75 offset:33792
  v_smfmac_f32_16x16x64_bf16 v[20:23], v[0:3], a[208:215], v74
  ds_read_b128 v[36:39], v75 offset:34816
  v_smfmac_f32_16x16x64_bf16 v[20:23], v[4:7], a[216:223], v74
  ds_read_b128 v[40:43], v75 offset:35840
  v_cvt_pk_bf16_f32 v16, v16, v17
  v_cvt_pk_bf16_f32 v17, v18, v19
  v_bfi_b32 v16, 1, s72, v16
  v_smfmac_f32_16x16x64_bf16 v[20:23], v[8:11], v[44:51], v74
  ds_read_b128 v[44:47], v75 offset:49152
  buffer_store_dwordx2 v[16:17], v68, s[8:11], s73 offen sc1
  v_smfmac_f32_16x16x64_bf16 v[20:23], v[12:15], v[60:67], v74
  ds_read_b128 v[48:51], v75 offset:50176
  v_smfmac_f32_16x16x64_bf16 v[24:27], v[0:3], a[224:231], v74
  ds_read_b128 v[60:63], v75 offset:51200
  v_smfmac_f32_16x16x64_bf16 v[24:27], v[4:7], a[232:239], v74
  ds_read_b128 v[64:67], v75 offset:52224
  s_waitcnt lgkmcnt(6)
  v_cvt_pk_bf16_f32 v20, v20, v21
  v_cvt_pk_bf16_f32 v21, v22, v23
  v_bfi_b32 v20, 1, s72, v20
  v_smfmac_f32_16x16x64_bf16 v[24:27], v[8:11], v[52:59], v74
  buffer_store_dwordx2 v[20:21], v68, s[8:11], s74 offen sc1
  s_waitcnt lgkmcnt(4)
  v_mov_b64 v[18:19], v[72:73]
  v_smfmac_f32_16x16x64_bf16 v[24:27], v[12:15], v[36:43], v74
  v_mov_b64 v[20:21], 0
  v_smfmac_f32_16x16x64_bf16 v[28:31], v[0:3], a[240:247], v74
  v_mov_b64 v[22:23], 0
  v_smfmac_f32_16x16x64_bf16 v[28:31], v[4:7], a[248:255], v74
  s_waitcnt lgkmcnt(2)
  v_cvt_pk_bf16_f32 v24, v24, v25
  v_cvt_pk_bf16_f32 v25, v26, v27
  v_bfi_b32 v24, 1, s72, v24
  v_smfmac_f32_16x16x64_bf16 v[28:31], v[8:11], v[44:51], v74
  buffer_store_dwordx2 v[24:25], v68, s[8:11], s75 offen sc1
  s_waitcnt lgkmcnt(0)
  v_smfmac_f32_16x16x64_bf16 v[28:31], v[12:15], v[60:67], v74
  ds_read_b64 v[16:17], v77 offset:256
  v_xor_b32 v75, 0x8000, v75
  ds_read_b128 v[52:55], v76 offset:14848
  s_nop 3
  v_cvt_pk_bf16_f32 v28, v28, v29
  v_cvt_pk_bf16_f32 v29, v30, v31
  v_bfi_b32 v28, 1, s72, v28
  buffer_store_dwordx2 v[28:29], v68, s[8:11], s76 offen sc1
  v_mov_b64 v[24:25], 0
  v_mov_b64 v[26:27], 0
  v_mov_b64 v[28:29], 0
  v_mov_b64 v[30:31], 0
  s_add_u32 s58, s58, 655360
  s_add_u32 s59, s59, 655360
  s_add_u32 s70, s70, 655360
  s_add_u32 s68, s68, 655360
  s_add_u32 s66, s66, 1
  s_xor_b32 s64, s64, 16384
  s_xor_b32 s65, s65, 16384
  s_nop 15
  s_nop 7
  buffer_load_dwordx4 v[0:3], v76, s[8:11], s60 offen offset:0 sc1
  buffer_load_dwordx4 v[4:7], v76, s[8:11], s60 offen offset:1024 sc1
  buffer_load_dwordx4 v[8:11], v76, s[8:11], s61 offen offset:0 sc1
  buffer_load_dwordx4 v[12:15], v76, s[8:11], s61 offen offset:1024 sc1
  s_nop 15
  s_nop 11
  buffer_load_dwordx4 v[44:47], v76, s[8:11], s60 offen offset:0 sc1
  buffer_load_dwordx4 v[48:51], v76, s[8:11], s60 offen offset:1024 sc1
  buffer_load_dwordx4 v[60:63], v76, s[8:11], s61 offen offset:0 sc1
  buffer_load_dwordx4 v[64:67], v76, s[8:11], s61 offen offset:1024 sc1
  s_waitcnt vmcnt(7) lgkmcnt(0)
  v_mfma_f32_16x16x32_bf16 v[56:59], v[52:55], v[0:3], 0
  v_bitop3_b32 v72, v0, v2, s72 bitop3:0x7e
  s_waitcnt vmcnt(6)
  v_mfma_f32_16x16x32_bf16 v[56:59], v[52:55], v[4:7], v[56:59]
  v_bitop3_b32 v73, v4, v6, s72 bitop3:0x7e
  v_or_b32 v72, v72, v73
  s_waitcnt vmcnt(5)
  v_mfma_f32_16x16x32_bf16 v[36:39], v[52:55], v[8:11], 0
  v_bitop3_b32 v73, v8, v10, s72 bitop3:0x7e
  v_or_b32 v72, v72, v73
  s_waitcnt vmcnt(4)
  v_mfma_f32_16x16x32_bf16 v[36:39], v[52:55], v[12:15], v[36:39]
  v_bitop3_b32 v73, v12, v14, s72 bitop3:0x7e
  v_bitop3_b32 v72, v72, v73, 1 bitop3:0xa8
  v_cmp_ne_u32 vcc, 0, v72
  s_cbranch_vccnz Cs0_h1r
Cs0_h1p:
  v_add_f32_dpp v56, v56, v56 row_ror:4 row_mask:0xf bank_mask:0xf
  v_add_f32_dpp v57, v57, v57 row_ror:4 row_mask:0xf bank_mask:0xf
  s_nop 0
  v_add_f32_dpp v56, v56, v56 row_ror:8 row_mask:0xf bank_mask:0xf
  v_add_f32_dpp v57, v57, v57 row_ror:8 row_mask:0xf bank_mask:0xf
  v_cvt_pk_bf16_f32 v56, v56, v57
  buffer_store_dword v56, v69, s[8:11], s62 offen sc1
  v_add_f32_dpp v36, v36, v36 row_ror:4 row_mask:0xf bank_mask:0xf
  v_add_f32_dpp v37, v37, v37 row_ror:4 row_mask:0xf bank_mask:0xf
  s_nop 0
  v_add_f32_dpp v36, v36, v36 row_ror:8 row_mask:0xf bank_mask:0xf
  v_add_f32_dpp v37, v37, v37 row_ror:8 row_mask:0xf bank_mask:0xf
  v_cvt_pk_bf16_f32 v36, v36, v37
  buffer_store_dword v36, v70, s[8:11], s63 offen sc1
Cs0_h1ok:
  s_xor_b32 s62, s62, 16384
  s_xor_b32 s63, s63, 16384
  s_xor_b32 s72, s72, 1
  s_nop 15
  s_nop 7
Cs0_h2:
  v_lshlrev_b32 v73, 2, v76
  buffer_load_dwordx4 v[52:55], v76, s[8:11], s64 offen offset:0 sc1
  buffer_load_dwordx4 v[56:59], v76, s[8:11], s64 offen offset:1024 sc1
  buffer_load_dwordx4 v[12:15], v76, s[8:11], s65 offen offset:0 sc1
  s_nop 15
  s_nop 1
  buffer_load_dwordx4 v[52:55], v76, s[8:11], s64 offen offset:0 sc1
  buffer_load_dwordx4 v[56:59], v76, s[8:11], s64 offen offset:1024 sc1
  buffer_load_dwordx4 v[12:15], v76, s[8:11], s65 offen offset:0 sc1
  s_nop 15
  s_nop 1
  buffer_load_dwordx4 v[52:55], v76, s[8:11], s64 offen offset:0 sc1
  buffer_load_dwordx4 v[56:59], v76, s[8:11], s64 offen offset:1024 sc1
  buffer_load_dwordx4 v[12:15], v76, s[8:11], s65 offen offset:0 sc1
  s_waitcnt vmcnt(11)
  ds_read_b128 v[60:63], v76 offset:16384
  ds_read_b128 v[64:67], v76 offset:17408
  ds_read_b128 v[44:47], v76 offset:18432
  ds_read_b128 v[48:51], v76 offset:19456
  ds_read_b128 v[36:39], v76 offset:32768
  ds_read_b128 v[40:43], v76 offset:33792
  s_waitcnt vmcnt(6)
  v_max3_u32 v72, v52, v53, v54
  v_max3_u32 v72, v72, v55, v56
  v_max3_u32 v72, v72, v57, v58
  v_max3_u32 v72, v72, v59, v12
  v_max3_u32 v72, v72, v13, v14
  v_max_u32 v72, v72, v15
  ds_write_b128 v76, v[52:55] offset:4608
  ds_write_b128 v76, v[56:59] offset:5632
  ds_write_b128 v76, v[12:15] offset:12800
  v_cmp_eq_u32 vcc, -1, v72
  s_cbranch_vccnz Cs0_h2r
Cs0_h2w:
  buffer_store_dword v71, v69, s[8:11], s62 offen sc1
  buffer_store_dword v71, v70, s[8:11], s63 offen sc1
  s_branch Cs0_top
Cs0_rec:
  s_nop 7
  s_waitcnt vmcnt(0) lgkmcnt(0)
  v_max3_u32 v72, v0, v1, v2
  v_max3_u32 v72, v72, v3, v4
  v_max3_u32 v72, v72, v5, v6
  v_max3_u32 v72, v72, v7, v8
  v_max3_u32 v72, v72, v9, v10
  v_max3_u32 v72, v72, v11, v12
  v_max3_u32 v72, v72, v13, v14
  v_max3_u32 v72, v72, v15, v16
  v_max3_u32 v72, v72, v17, v18
  v_max_u32 v72, v72, v19
  v_cmp_eq_u32 vcc, -1, v72
  s_cbranch_vccz Cs0_recok
  s_barrier
  v_mov_b64 v[20:21], 0
  v_mov_b64 v[22:23], 0
  v_mov_b64 v[24:25], 0
  v_mov_b64 v[26:27], 0
  v_mov_b64 v[28:29], 0
  v_mov_b64 v[30:31], 0
  v_mov_b64 v[32:33], 0
  v_mov_b64 v[34:35], 0
  s_waitcnt lgkmcnt(0)
  s_barrier
  ds_read_b128 v[0:3], v76 offset:4608
  ds_read_b128 v[60:63], v76 offset:16384
  ds_read_b128 v[64:67], v76 offset:17408
  s_waitcnt lgkmcnt(0)
  v_smfmac_f32_16x16x64_bf16 v[20:23], v[0:3], v[60:67], v74
  ds_read_b128 v[60:63], v76 offset:18432
  ds_read_b128 v[64:67], v76 offset:19456
  s_waitcnt lgkmcnt(0)
  v_smfmac_f32_16x16x64_bf16 v[24:27], v[0:3], v[60:67], v74
  ds_read_b128 v[60:63], v76 offset:32768
  ds_read_b128 v[64:67], v76 offset:33792
  s_waitcnt lgkmcnt(0)
  v_smfmac_f32_16x16x64_bf16 v[28:31], v[0:3], v[60:67], v74
  ds_read_b128 v[60:63], v76 offset:34816
  ds_read_b128 v[64:67], v76 offset:35840
  s_waitcnt lgkmcnt(0)
  v_smfmac_f32_16x16x64_bf16 v[32:35], v[0:3], v[60:67], v74
  ds_read_b128 v[4:7], v76 offset:5632
  s_waitcnt lgkmcnt(0)
  v_smfmac_f32_16x16x64_bf16 v[20:23], v[4:7], v[80:87], v74
  v_smfmac_f32_16x16x64_bf16 v[24:27], v[4:7], v[88:95], v74
  v_smfmac_f32_16x16x64_bf16 v[28:31], v[4:7], v[208:215], v74
  v_smfmac_f32_16x16x64_bf16 v[32:35], v[4:7], v[216:223], v74
  ds_read_b128 v[8:11], v76 offset:6656
  s_waitcnt lgkmcnt(0)
  v_smfmac_f32_16x16x64_bf16 v[20:23], v[8:11], v[96:103], v74
  v_smfmac_f32_16x16x64_bf16 v[24:27], v[8:11], v[104:111], v74
  ds_read_b128 v[60:63], v76 offset:49152
  ds_read_b128 v[64:67], v76 offset:50176
  s_waitcnt lgkmcnt(0)
  v_smfmac_f32_16x16x64_bf16 v[28:31], v[8:11], v[60:67], v74
  ds_read_b128 v[60:63], v76 offset:51200
  ds_read_b128 v[64:67], v76 offset:52224
  s_waitcnt lgkmcnt(0)
  v_smfmac_f32_16x16x64_bf16 v[32:35], v[8:11], v[60:67], v74
  ds_read_b128 v[12:15], v76 offset:7680
  s_waitcnt lgkmcnt(0)
  v_smfmac_f32_16x16x64_bf16 v[20:23], v[12:15], v[112:119], v74
  v_smfmac_f32_16x16x64_bf16 v[24:27], v[12:15], v[120:127], v74
  v_smfmac_f32_16x16x64_bf16 v[28:31], v[12:15], v[224:231], v74
  v_smfmac_f32_16x16x64_bf16 v[32:35], v[12:15], v[232:239], v74
  ds_read_b128 v[4:7], v76 offset:8704
  s_waitcnt lgkmcnt(0)
  v_smfmac_f32_16x16x64_bf16 v[20:23], v[4:7], v[128:135], v74
  v_smfmac_f32_16x16x64_bf16 v[24:27], v[4:7], v[136:143], v74
  ds_read_b128 v[60:63], v75 offset:16384
  ds_read_b128 v[64:67], v75 offset:17408
  s_waitcnt lgkmcnt(0)
  v_smfmac_f32_16x16x64_bf16 v[28:31], v[4:7], v[60:67], v74
  ds_read_b128 v[60:63], v75 offset:18432
  ds_read_b128 v[64:67], v75 offset:19456
  s_waitcnt lgkmcnt(0)
  v_smfmac_f32_16x16x64_bf16 v[32:35], v[4:7], v[60:67], v74
  ds_read_b128 v[16:19], v76 offset:9728
  s_waitcnt lgkmcnt(0)
  v_smfmac_f32_16x16x64_bf16 v[20:23], v[16:19], v[144:151], v74
  v_smfmac_f32_16x16x64_bf16 v[24:27], v[16:19], v[152:159], v74
  v_smfmac_f32_16x16x64_bf16 v[28:31], v[16:19], v[240:247], v74
  v_smfmac_f32_16x16x64_bf16 v[32:35], v[16:19], v[248:255], v74
  ds_read_b128 v[12:15], v76 offset:10752
  s_waitcnt lgkmcnt(0)
  v_smfmac_f32_16x16x64_bf16 v[20:23], v[12:15], v[160:167], v74
  v_smfmac_f32_16x16x64_bf16 v[24:27], v[12:15], v[168:175], v74
  v_smfmac_f32_16x16x64_bf16 v[28:31], v[12:15], a[0:7], v74
  v_smfmac_f32_16x16x64_bf16 v[32:35], v[12:15], a[8:15], v74
  ds_read_b128 v[8:11], v76 offset:11776
  s_waitcnt lgkmcnt(0)
  v_smfmac_f32_16x16x64_bf16 v[20:23], v[8:11], v[176:183], v74
  v_smfmac_f32_16x16x64_bf16 v[24:27], v[8:11], v[184:191], v74
  v_smfmac_f32_16x16x64_bf16 v[28:31], v[8:11], a[16:23], v74
  v_smfmac_f32_16x16x64_bf16 v[32:35], v[8:11], a[24:31], v74
  ds_read_b128 v[0:3], v76 offset:12800
  s_waitcnt lgkmcnt(0)
  v_smfmac_f32_16x16x64_bf16 v[20:23], v[0:3], v[192:199], v74
  v_smfmac_f32_16x16x64_bf16 v[24:27], v[0:3], v[200:207], v74
  ds_read_b128 v[60:63], v75 offset:0
  ds_read_b128 v[64:67], v75 offset:1024
  s_waitcnt lgkmcnt(0)
  v_smfmac_f32_16x16x64_bf16 v[28:31], v[0:3], v[60:67], v74
  ds_read_b128 v[60:63], v75 offset:2048
  ds_read_b128 v[64:67], v75 offset:3072
  s_waitcnt lgkmcnt(0)
  v_smfmac_f32_16x16x64_bf16 v[32:35], v[0:3], v[60:67], v74
  v_add_f32 v20, v20, v22
  v_add_f32 v21, v21, v23
  v_add_f32 v24, v24, v26
  v_cvt_pk_bf16_f32 v22, v20, v24
  ds_write_b32 v79, v22 offset:0
  v_add_f32 v25, v25, v27
  v_cvt_pk_bf16_f32 v23, v21, v25
  ds_write_b32 v79, v23 offset:576
  v_add_f32 v28, v28, v30
  v_add_f32 v29, v29, v31
  s_waitcnt lgkmcnt(0)
  s_nop 1
  s_branch Cs0_recok
Cs0_mx:
  s_waitcnt lgkmcnt(0)
  s_barrier
  buffer_load_dwordx4 v[0:3], v76, s[8:11], s58 offen offset:0 sc1
  ds_read_b128 v[20:23], v77 offset:0
  ds_read_b128 v[28:31], v77 offset:256
  buffer_load_dwordx4 v[4:7], v76, s[8:11], s58 offen offset:1024 sc1
  ds_read_b128 v[24:27], v77 offset:128
  ds_read_b128 v[32:35], v77 offset:384
  s_waitcnt vmcnt(1) lgkmcnt(3)
  v_mfma_f32_16x16x32_bf16 v[8:11], v[0:3], v[20:23], 0
  s_waitcnt vmcnt(0) lgkmcnt(1)
  v_mfma_f32_16x16x32_bf16 v[8:11], v[4:7], v[24:27], v[8:11]
  v_mfma_f32_16x16x32_bf16 v[12:15], v[28:31], v[20:23], 0
  s_waitcnt lgkmcnt(0)
  v_mfma_f32_16x16x32_bf16 v[12:15], v[32:35], v[24:27], v[12:15]
  v_add_f32_dpp v8, v10, v8 quad_perm:[2,3,0,1] row_mask:0xf bank_mask:0xf
  v_add_f32_dpp v9, v11, v9 quad_perm:[2,3,0,1] row_mask:0xf bank_mask:0xf
  s_nop 0
  v_mov_b32_dpp v8, v8 quad_perm:[0,1,0,1] row_mask:0xf bank_mask:0xf
  v_mov_b32_dpp v9, v9 quad_perm:[0,1,0,1] row_mask:0xf bank_mask:0xf
  s_nop 1
  v_add_f32_dpp v12, v14, v12 quad_perm:[2,3,0,1] row_mask:0xf bank_mask:0xf
  v_add_f32_dpp v13, v15, v13 quad_perm:[2,3,0,1] row_mask:0xf bank_mask:0xf
  s_nop 0
  v_mov_b32_dpp v12, v12 quad_perm:[0,1,0,1] row_mask:0xf bank_mask:0xf
  v_mov_b32_dpp v13, v13 quad_perm:[0,1,0,1] row_mask:0xf bank_mask:0xf
  v_mul_f32 v12, s69, v12
  ds_write_b32 v78, v8 offset:8704
  v_mul_f32 v13, s69, v13
  ds_write_b32 v78, v9 offset:8768
  s_waitcnt lgkmcnt(0)
  s_barrier
  ds_read_b128 v[36:39], v78 offset:8704
  ds_read_b128 v[40:43], v78 offset:8768
  s_waitcnt lgkmcnt(0)
  s_barrier
  v_max_f32 v16, v36, v37
  v_max3_f32 v16, v16, v38, v39
  v_max3_f32 v16, v16, v40, v41
  v_max3_f32 v16, v16, v42, v43
  v_max3_f32 v16, v16, v12, v13
  v_mov_b32 v17, v16
  s_nop 1
  v_permlane16_swap_b32 v16, v17
  v_max_f32 v16, v16, v17
  v_mov_b32 v17, v16
  s_nop 1
  v_permlane32_swap_b32 v16, v17
  v_max_f32 v16, v16, v17
  v_sub_f32 v36, v36, v16
  v_sub_f32 v37, v37, v16
  v_sub_f32 v38, v38, v16
  v_sub_f32 v39, v39, v16
  v_sub_f32 v40, v40, v16
  v_sub_f32 v41, v41, v16
  v_sub_f32 v42, v42, v16
  v_sub_f32 v43, v43, v16
  v_sub_f32 v12, v12, v16
  v_sub_f32 v13, v13, v16
  v_exp_f32 v36, v36
  v_exp_f32 v37, v37
  v_exp_f32 v38, v38
  v_exp_f32 v39, v39
  v_exp_f32 v40, v40
  v_exp_f32 v41, v41
  v_exp_f32 v42, v42
  v_exp_f32 v43, v43
  v_exp_f32 v12, v12
  v_exp_f32 v13, v13
  v_cvt_pk_bf16_f32 v32, v36, v40
  v_cvt_pk_bf16_f32 v33, v37, v41
  v_cvt_pk_bf16_f32 v34, v38, v42
  v_cvt_pk_bf16_f32 v35, v39, v43
  v_cvt_pk_bf16_f32 v28, v12, v13
  v_cvt_pk_bf16_f32 v31, v12, v13
  v_mov_b32 v29, 0
  v_mov_b32 v30, 0
  v_mov_b32 v68, 0x3f803f80
  v_mov_b32 v69, 0x3f803f80
  v_mov_b32 v70, 0x3f803f80
  v_mov_b32 v71, 0x3f803f80
  s_nop 1
  v_mfma_f32_16x16x32_bf16 v[8:11], v[32:35], v[68:71], 0
  v_mfma_f32_16x16x32_bf16 v[0:3], v[32:35], v[52:55], 0
  v_mfma_f32_16x16x32_bf16 v[4:7], v[32:35], v[56:59], 0
  v_mfma_f32_16x16x16_bf16 v[8:11], v[28:29], v[68:69], v[8:11]
  v_mfma_f32_16x16x16_bf16 v[0:3], v[28:29], v[72:73], v[0:3]
  v_mfma_f32_16x16x16_bf16 v[4:7], v[30:31], v[72:73], v[4:7]
  ds_read_b128 v[68:71], v76 offset:13824
  v_rcp_f32 v10, v8
  v_rcp_f32 v11, v9
  v_mul_f32 v0, v10, v0
  v_mul_f32 v1, v11, v1
  s_nop 0
  v_mul_f32 v4, v10, v4
  v_mul_f32 v5, v11, v5
  v_cvt_pk_bf16_f32 v2, v0, v4
  ds_write_b32 v79, v2 offset:8704
  v_cvt_pk_bf16_f32 v3, v1, v5
  ds_write_b32 v79, v3 offset:9280
  v_mov_b64 v[16:17], 0
  v_mov_b64 v[18:19], 0
  v_mov_b64 v[20:21], 0
  v_mov_b64 v[22:23], 0
  s_branch Cs0_mxok
Cs0_h1r:
  s_mov_b64 exec, vcc
  buffer_load_dwordx4 v[0:3], v76, s[8:11], s60 offen offset:0 sc1
  buffer_load_dwordx4 v[4:7], v76, s[8:11], s60 offen offset:1024 sc1
  buffer_load_dwordx4 v[8:11], v76, s[8:11], s61 offen offset:0 sc1
  buffer_load_dwordx4 v[12:15], v76, s[8:11], s61 offen offset:1024 sc1
  s_mov_b64 exec, -1
  s_add_u32 s67, s67, 1
  s_waitcnt vmcnt(7)
  v_mfma_f32_16x16x32_bf16 v[56:59], v[52:55], v[44:47], 0
  v_bitop3_b32 v72, v44, v46, s72 bitop3:0x7e
  s_waitcnt vmcnt(6)
  v_mfma_f32_16x16x32_bf16 v[56:59], v[52:55], v[48:51], v[56:59]
  v_bitop3_b32 v73, v48, v50, s72 bitop3:0x7e
  v_or_b32 v72, v72, v73
  s_waitcnt vmcnt(5)
  v_mfma_f32_16x16x32_bf16 v[36:39], v[52:55], v[60:63], 0
  v_bitop3_b32 v73, v60, v62, s72 bitop3:0x7e
  v_or_b32 v72, v72, v73
  s_waitcnt vmcnt(4)
  v_mfma_f32_16x16x32_bf16 v[36:39], v[52:55], v[64:67], v[36:39]
  v_bitop3_b32 v73, v64, v66, s72 bitop3:0x7e
  v_bitop3_b32 v72, v72, v73, 1 bitop3:0xa8
  v_cmp_ne_u32 vcc, 0, v72
  s_cbranch_vccz Cs0_h1p
  s_mov_b64 exec, vcc
  buffer_load_dwordx4 v[44:47], v76, s[8:11], s60 offen offset:0 sc1
  buffer_load_dwordx4 v[48:51], v76, s[8:11], s60 offen offset:1024 sc1
  buffer_load_dwordx4 v[60:63], v76, s[8:11], s61 offen offset:0 sc1
  buffer_load_dwordx4 v[64:67], v76, s[8:11], s61 offen offset:1024 sc1
  s_mov_b64 exec, -1
  s_add_u32 s67, s67, 1
  s_waitcnt vmcnt(7)
  v_mfma_f32_16x16x32_bf16 v[56:59], v[52:55], v[0:3], 0
  v_bitop3_b32 v72, v0, v2, s72 bitop3:0x7e
  s_waitcnt vmcnt(6)
  v_mfma_f32_16x16x32_bf16 v[56:59], v[52:55], v[4:7], v[56:59]
  v_bitop3_b32 v73, v4, v6, s72 bitop3:0x7e
  v_or_b32 v72, v72, v73
  s_waitcnt vmcnt(5)
  v_mfma_f32_16x16x32_bf16 v[36:39], v[52:55], v[8:11], 0
  v_bitop3_b32 v73, v8, v10, s72 bitop3:0x7e
  v_or_b32 v72, v72, v73
  s_waitcnt vmcnt(4)
  v_mfma_f32_16x16x32_bf16 v[36:39], v[52:55], v[12:15], v[36:39]
  v_bitop3_b32 v73, v12, v14, s72 bitop3:0x7e
  v_bitop3_b32 v72, v72, v73, 1 bitop3:0xa8
  v_cmp_ne_u32 vcc, 0, v72
  s_cbranch_vccz Cs0_h1p
  s_cmp_lt_u32 s67, 131072
  s_cbranch_scc1 Cs0_h1r
  s_branch Cs0_h1p
Cs0_h2r:
Cs0_h2s:
  s_mov_b64 exec, vcc
  buffer_load_dwordx4 v[52:55], v76, s[8:11], s64 offen offset:0 sc1
  buffer_load_dwordx4 v[56:59], v76, s[8:11], s64 offen offset:1024 sc1
  buffer_load_dwordx4 v[12:15], v76, s[8:11], s65 offen offset:0 sc1
  s_mov_b64 exec, -1
  s_add_u32 s67, s67, 1
  s_waitcnt vmcnt(6)
  v_max3_u32 v72, v52, v53, v54
  v_max3_u32 v72, v72, v55, v56
  v_max3_u32 v72, v72, v57, v58
  v_max3_u32 v72, v72, v59, v12
  v_max3_u32 v72, v72, v13, v14
  v_max_u32 v72, v72, v15
  v_cmp_eq_u32 vcc, -1, v72
  s_cbranch_vccz Cs0_h2ok
  s_mov_b64 exec, vcc
  buffer_load_dwordx4 v[52:55], v76, s[8:11], s64 offen offset:0 sc1
  buffer_load_dwordx4 v[56:59], v76, s[8:11], s64 offen offset:1024 sc1
  buffer_load_dwordx4 v[12:15], v76, s[8:11], s65 offen offset:0 sc1
  s_mov_b64 exec, -1
  s_add_u32 s67, s67, 1
  s_waitcnt vmcnt(6)
  v_max3_u32 v72, v52, v53, v54
  v_max3_u32 v72, v72, v55, v56
  v_max3_u32 v72, v72, v57, v58
  v_max3_u32 v72, v72, v59, v12
  v_max3_u32 v72, v72, v13, v14
  v_max_u32 v72, v72, v15
  v_cmp_eq_u32 vcc, -1, v72
  s_cbranch_vccz Cs0_h2ok
  s_mov_b64 exec, vcc
  buffer_load_dwordx4 v[52:55], v76, s[8:11], s64 offen offset:0 sc1
  buffer_load_dwordx4 v[56:59], v76, s[8:11], s64 offen offset:1024 sc1
  buffer_load_dwordx4 v[12:15], v76, s[8:11], s65 offen offset:0 sc1
  s_mov_b64 exec, -1
  s_add_u32 s67, s67, 1
  s_waitcnt vmcnt(6)
  v_max3_u32 v72, v52, v53, v54
  v_max3_u32 v72, v72, v55, v56
  v_max3_u32 v72, v72, v57, v58
  v_max3_u32 v72, v72, v59, v12
  v_max3_u32 v72, v72, v13, v14
  v_max_u32 v72, v72, v15
  v_cmp_eq_u32 vcc, -1, v72
  s_cbranch_vccz Cs0_h2ok
  s_mov_b64 exec, vcc
  buffer_load_dwordx4 v[52:55], v76, s[8:11], s64 offen offset:0 sc1
  buffer_load_dwordx4 v[56:59], v76, s[8:11], s64 offen offset:1024 sc1
  buffer_load_dwordx4 v[12:15], v76, s[8:11], s65 offen offset:0 sc1
  s_mov_b64 exec, -1
  s_add_u32 s67, s67, 1
  s_waitcnt vmcnt(6)
  v_max3_u32 v72, v52, v53, v54
  v_max3_u32 v72, v72, v55, v56
  v_max3_u32 v72, v72, v57, v58
  v_max3_u32 v72, v72, v59, v12
  v_max3_u32 v72, v72, v13, v14
  v_max_u32 v72, v72, v15
  v_cmp_eq_u32 vcc, -1, v72
  s_cbranch_vccz Cs0_h2ok
  s_cmp_lt_u32 s67, 131072
  s_cbranch_scc1 Cs0_h2s
Cs0_h2ok:
  ds_write_b128 v76, v[52:55] offset:4608
  ds_write_b128 v76, v[56:59] offset:5632
  ds_write_b128 v76, v[12:15] offset:12800
  s_branch Cs0_h2w
Cs0_last:
  s_nop 7
  s_waitcnt vmcnt(0) lgkmcnt(0)
  ds_read_b64 v[16:17], v77 offset:256
  v_mov_b64 v[18:19], v[72:73]
  s_add_u32 s68, s68, 655360
  s_waitcnt lgkmcnt(0)
  buffer_store_dwordx4 v[16:19], v76, s[8:11], s68 offen sc1
  s_waitcnt vmcnt(0)
  s_barrier
  s_branch L_cexit
L_w5:
  v_mov_b64 v[20:21], 0
  v_mov_b64 v[22:23], 0
  v_mov_b64 v[24:25], 0
  v_mov_b64 v[26:27], 0
  v_mov_b64 v[28:29], 0
  v_mov_b64 v[30:31], 0
  v_mov_b64 v[32:33], 0
  v_mov_b64 v[34:35], 0
  s_mov_b32 m0, 15872
  v_lshlrev_b32 v73, 2, v76
  v_mov_b32 v72, 0
  ds_read_b128 v[60:63], v76 offset:20480
  ds_read_b128 v[64:67], v76 offset:21504
  ds_read_b128 v[44:47], v76 offset:22528
  ds_read_b128 v[48:51], v76 offset:23552
  ds_read_b128 v[36:39], v76 offset:36864
  ds_read_b128 v[40:43], v76 offset:37888
  ds_read_b128 v[0:3], v76 offset:4608
  ds_read_b128 v[4:7], v76 offset:5632
  s_branch Cs1_top2
.p2align 6
Cs1_top:
  s_waitcnt lgkmcnt(0)
  s_barrier
  ds_read_b128 v[0:3], v76 offset:4608
  ds_read_b128 v[4:7], v76 offset:5632
Cs1_top2:
  s_waitcnt lgkmcnt(1)
  v_smfmac_f32_16x16x64_bf16 v[20:23], v[0:3], v[60:67], v74
  ds_read_b128 v[60:63], v76 offset:38912
  v_smfmac_f32_16x16x64_bf16 v[24:27], v[0:3], v[44:51], v74
  ds_read_b128 v[64:67], v76 offset:39936
  s_waitcnt lgkmcnt(2)
  v_smfmac_f32_16x16x64_bf16 v[20:23], v[4:7], v[80:87], v74
  buffer_load_dwordx4 v[44:47], v76, s[8:11], s58 offen offset:0 sc1
  ds_read_b128 v[8:11], v76 offset:6656
  v_smfmac_f32_16x16x64_bf16 v[28:31], v[0:3], v[36:43], v74
  ds_read_b128 v[36:39], v76 offset:53248
  v_smfmac_f32_16x16x64_bf16 v[24:27], v[4:7], v[88:95], v74
  buffer_load_dwordx4 v[48:51], v76, s[8:11], s58 offen offset:1024 sc1
  ds_read_b128 v[40:43], v76 offset:54272
  v_smfmac_f32_16x16x64_bf16 v[28:31], v[4:7], v[208:215], v74
  ds_read_b128 v[12:15], v76 offset:7680
  v_smfmac_f32_16x16x64_bf16 v[32:35], v[4:7], v[216:223], v74
  buffer_load_dwordx4 v[52:55], v76, s[8:11], s59 offen offset:0 sc1
  s_waitcnt lgkmcnt(4)
  v_smfmac_f32_16x16x64_bf16 v[32:35], v[0:3], v[60:67], v74
  ds_read_b128 v[60:63], v76 offset:55296
  s_waitcnt lgkmcnt(4)
  v_smfmac_f32_16x16x64_bf16 v[20:23], v[8:11], v[96:103], v74
  buffer_load_dwordx4 v[56:59], v76, s[8:11], s59 offen offset:1024 sc1
  ds_read_b128 v[64:67], v76 offset:56320
  v_smfmac_f32_16x16x64_bf16 v[24:27], v[8:11], v[104:111], v74
  ds_read_b128 v[0:3], v76 offset:12800
  s_waitcnt lgkmcnt(4)
  v_smfmac_f32_16x16x64_bf16 v[28:31], v[8:11], v[36:43], v74
  ds_read_b128 v[36:39], v75 offset:4096
  s_waitcnt lgkmcnt(4)
  v_smfmac_f32_16x16x64_bf16 v[20:23], v[12:15], v[112:119], v74
  buffer_store_dwordx4 v[16:19], v76, s[8:11], s68 offen sc1
  ds_read_b128 v[40:43], v75 offset:5120
  v_smfmac_f32_16x16x64_bf16 v[24:27], v[12:15], v[120:127], v74
  buffer_load_dword v73, s[8:11], s70 offen lds
  s_waitcnt lgkmcnt(3)
  v_smfmac_f32_16x16x64_bf16 v[32:35], v[8:11], v[60:67], v74
  ds_read_b128 v[60:63], v75 offset:6144
  v_smfmac_f32_16x16x64_bf16 v[28:31], v[12:15], v[224:231], v74
  ds_read_b128 v[64:67], v75 offset:7168
  v_smfmac_f32_16x16x64_bf16 v[32:35], v[12:15], v[232:239], v74
  s_barrier
  s_waitcnt lgkmcnt(4)
  v_smfmac_f32_16x16x64_bf16 v[20:23], v[0:3], v[192:199], v74
  ds_read_b128 v[4:7], v76 offset:8704
  s_waitcnt lgkmcnt(3)
  v_smfmac_f32_16x16x64_bf16 v[28:31], v[0:3], v[36:43], v74
  ds_read_b128 v[16:19], v76 offset:9728
  v_smfmac_f32_16x16x64_bf16 v[24:27], v[0:3], v[200:207], v74
  ds_read_b128 v[36:39], v75 offset:20480
  s_waitcnt lgkmcnt(3)
  v_mov_b32 v68, 0x3f803f80
  v_smfmac_f32_16x16x64_bf16 v[32:35], v[0:3], v[60:67], v74
  ds_read_b128 v[40:43], v75 offset:21504
  s_waitcnt lgkmcnt(3)
  v_smfmac_f32_16x16x64_bf16 v[20:23], v[4:7], v[128:135], v74
  ds_read_b128 v[12:15], v76 offset:10752
  v_mov_b32 v69, 0x3f803f80
  v_smfmac_f32_16x16x64_bf16 v[24:27], v[4:7], v[136:143], v74
  ds_read_b128 v[8:11], v76 offset:11776
  s_waitcnt lgkmcnt(4)
  v_smfmac_f32_16x16x64_bf16 v[20:23], v[16:19], v[144:151], v74
  ds_read_b128 v[60:63], v75 offset:22528
  v_mov_b64 v[70:71], v[68:69]
  v_smfmac_f32_16x16x64_bf16 v[24:27], v[16:19], v[152:159], v74
  ds_read_b128 v[64:67], v75 offset:23552
  s_waitcnt lgkmcnt(4)
  v_smfmac_f32_16x16x64_bf16 v[28:31], v[4:7], v[36:43], v74
  s_waitcnt lgkmcnt(3)
  v_mov_b64 v[36:37], 0
  v_smfmac_f32_16x16x64_bf16 v[20:23], v[12:15], v[160:167], v74
  s_waitcnt lgkmcnt(2)
  v_mov_b64 v[38:39], 0
  v_smfmac_f32_16x16x64_bf16 v[20:23], v[8:11], v[176:183], v74
  v_mov_b64 v[40:41], 0
  v_smfmac_f32_16x16x64_bf16 v[24:27], v[12:15], v[168:175], v74
  v_mov_b64 v[42:43], 0
  v_smfmac_f32_16x16x64_bf16 v[24:27], v[8:11], v[184:191], v74
  s_waitcnt lgkmcnt(0)
  v_add_f32 v20, v20, v22
  v_smfmac_f32_16x16x64_bf16 v[32:35], v[4:7], v[60:67], v74
  v_add_f32 v21, v21, v23
  v_smfmac_f32_16x16x64_bf16 v[28:31], v[16:19], v[240:247], v74
  v_add_f32 v24, v24, v26
  v_cvt_pk_bf16_f32 v22, v20, v24
  v_smfmac_f32_16x16x64_bf16 v[28:31], v[12:15], a[0:7], v74
  ds_write_b32 v79, v22 offset:0
  v_add_f32 v25, v25, v27
  v_cvt_pk_bf16_f32 v23, v21, v25
  v_smfmac_f32_16x16x64_bf16 v[28:31], v[8:11], a[16:23], v74
  ds_write_b32 v79, v23 offset:576
  v_cmp_u_f32 vcc, v20, v21
  v_smfmac_f32_16x16x64_bf16 v[32:35], v[16:19], v[248:255], v74
  s_mov_b64 exec, 1
  buffer_store_dword v72, v76, s[8:11], s71 offen sc1
  s_mov_b64 exec, -1
  v_smfmac_f32_16x16x64_bf16 v[32:35], v[12:15], a[8:15], v74
  v_add_f32 v28, v28, v30
  v_add_f32 v29, v29, v31
  v_smfmac_f32_16x16x64_bf16 v[32:35], v[8:11], a[24:31], v74
  s_cbranch_vccnz Cs1_rec
Cs1_recok:
  v_smfmac_f32_16x16x64_bf16 v[36:39], v[16:19], a[112:119], v74
  s_waitcnt lgkmcnt(0)
  s_barrier
  ds_read_b128 v[60:63], v77
  v_smfmac_f32_16x16x64_bf16 v[40:43], v[16:19], a[120:127], v74
  ds_read_b128 v[64:67], v77 offset:128
  v_add_f32 v32, v32, v34
  v_cvt_pk_bf16_f32 v30, v28, v32
  v_smfmac_f32_16x16x64_bf16 v[36:39], v[0:3], a[160:167], v74
  ds_write_b32 v79, v30 offset:256
  v_add_f32 v33, v33, v35
  v_cvt_pk_bf16_f32 v31, v29, v33
  v_smfmac_f32_16x16x64_bf16 v[40:43], v[0:3], a[168:175], v74
  ds_write_b32 v79, v31 offset:832
  v_xor_b32 v75, 0x8000, v75
  v_smfmac_f32_16x16x64_bf16 v[36:39], v[4:7], a[96:103], v74
  ds_read_b128 v[0:3], v76 offset:4608
  v_mov_b32 v29, 0
  v_smfmac_f32_16x16x64_bf16 v[40:43], v[4:7], a[104:111], v74
  s_waitcnt vmcnt(5) lgkmcnt(3)
  v_mov_b32 v30, 0
  v_mfma_f32_16x16x32_bf16 v[44:47], v[44:47], v[60:63], 0
  ds_read_b128 v[4:7], v76 offset:5632
  s_waitcnt lgkmcnt(2)
  v_mfma_f32_16x16x32_bf16 v[44:47], v[48:51], v[64:67], v[44:47]
  s_barrier
  v_smfmac_f32_16x16x64_bf16 v[36:39], v[8:11], a[144:151], v74
  ds_read_b128 v[20:23], v77 offset:256
  ds_read_b128 v[24:27], v77 offset:384
  v_smfmac_f32_16x16x64_bf16 v[40:43], v[8:11], a[152:159], v74
  ds_read_b128 v[8:11], v76 offset:6656
  v_add_f32_dpp v72, v46, v44 quad_perm:[2,3,0,1] row_mask:0xf bank_mask:0xf
  v_add_f32_dpp v73, v47, v45 quad_perm:[2,3,0,1] row_mask:0xf bank_mask:0xf
  v_smfmac_f32_16x16x64_bf16 v[36:39], v[12:15], a[128:135], v74
  ds_read_b128 v[44:47], v75 offset:20480
  v_exp_f32_dpp v72, v72 quad_perm:[0,1,0,1] row_mask:0xf bank_mask:0xf
  v_smfmac_f32_16x16x64_bf16 v[40:43], v[12:15], a[136:143], v74
  ds_read_b128 v[12:15], v76 offset:7680
  s_waitcnt lgkmcnt(6)
  v_exp_f32_dpp v73, v73 quad_perm:[0,1,0,1] row_mask:0xf bank_mask:0xf
  v_smfmac_f32_16x16x64_bf16 v[36:39], v[0:3], a[32:39], v74
  s_waitcnt lgkmcnt(3)
  v_cvt_pk_bf16_f32 v72, v72, v73
  v_mfma_f32_16x16x32_bf16 v[20:23], v[20:23], v[60:63], 0
  ds_write_b32 v78, v72 offset:516
  v_mfma_f32_16x16x32_bf16 v[20:23], v[24:27], v[64:67], v[20:23]
  ds_read_b128 v[48:51], v75 offset:21504
  v_smfmac_f32_16x16x64_bf16 v[40:43], v[0:3], a[40:47], v74
  ds_read_b128 v[60:63], v75 offset:22528
  v_smfmac_f32_16x16x64_bf16 v[36:39], v[4:7], a[48:55], v74
  s_waitcnt lgkmcnt(5)
  v_add_f32_dpp v24, v22, v20 quad_perm:[2,3,0,1] row_mask:0xf bank_mask:0xf
  v_add_f32_dpp v25, v23, v21 quad_perm:[2,3,0,1] row_mask:0xf bank_mask:0xf
  v_smfmac_f32_16x16x64_bf16 v[36:39], v[8:11], a[64:71], v74
  s_waitcnt lgkmcnt(2)
  s_barrier
  ds_read_b128 v[32:35], v78 offset:512
  v_smfmac_f32_16x16x64_bf16 v[36:39], v[12:15], a[80:87], v74
  ds_read_b128 v[64:67], v75 offset:23552
  v_mul_f32 v24, s69, v24
  v_smfmac_f32_16x16x64_bf16 v[40:43], v[4:7], a[56:63], v74
  v_mul_f32 v25, s69, v25
  v_smfmac_f32_16x16x64_bf16 v[40:43], v[8:11], a[72:79], v74
  v_exp_f32_dpp v24, v24 quad_perm:[0,1,0,1] row_mask:0xf bank_mask:0xf
  v_smfmac_f32_16x16x64_bf16 v[40:43], v[12:15], a[88:95], v74
  s_waitcnt vmcnt(3) lgkmcnt(1)
  v_exp_f32_dpp v25, v25 quad_perm:[0,1,0,1] row_mask:0xf bank_mask:0xf
  v_mfma_f32_16x16x32_bf16 v[8:11], v[32:35], v[68:71], 0
  v_add_f32 v36, v36, v38
  v_add_f32 v37, v37, v39
  v_mfma_f32_16x16x32_bf16 v[0:3], v[32:35], v[52:55], 0
  v_add_f32 v40, v40, v42
  v_add_f32 v41, v41, v43
  v_mfma_f32_16x16x32_bf16 v[4:7], v[32:35], v[56:59], 0
  v_cvt_pk_bf16_f32 v28, v24, v25
  v_cvt_pk_bf16_f32 v72, v36, v37
  v_cvt_pk_bf16_f32 v73, v40, v41
  v_mfma_f32_16x16x16_bf16 v[8:11], v[28:29], v[68:69], v[8:11]
  v_cvt_pk_bf16_f32 v31, v24, v25
  v_mfma_f32_16x16x16_bf16 v[0:3], v[28:29], v[72:73], v[0:3]
  ds_read_b128 v[68:71], v76 offset:13824
  v_mfma_f32_16x16x16_bf16 v[4:7], v[30:31], v[72:73], v[4:7]
  v_rcp_f32 v10, v8
  v_rcp_f32 v11, v9
  v_mul_f32 v0, v10, v0
  v_mul_f32 v1, v11, v1
  s_nop 0
  v_mul_f32 v4, v10, v4
  v_mul_f32 v5, v11, v5
  v_cvt_pk_bf16_f32 v2, v0, v4
  ds_write_b32 v79, v2 offset:8704
  v_cvt_pk_bf16_f32 v3, v1, v5
  ds_write_b32 v79, v3 offset:9280
  v_subrev_u32 v8, 813694976, v8
  v_subrev_u32 v9, 813694976, v9
  v_max_u32 v8, v8, v9
  v_cmp_le_u32 vcc, 503316480, v8
  v_mov_b64 v[16:17], 0
  v_mov_b64 v[18:19], 0
  v_mov_b64 v[20:21], 0
  v_mov_b64 v[22:23], 0
  s_cbranch_vccnz Cs1_mx
Cs1_mxok:
  s_cmp_eq_u32 s66, 63
  s_waitcnt lgkmcnt(0)
  s_barrier
  ds_read_b128 v[0:3], v78 offset:8704
  ds_read_b128 v[4:7], v78 offset:8768
  ds_read_b128 v[8:11], v78 offset:8832
  ds_read_b128 v[12:15], v78 offset:8896
  v_mov_b64 v[24:25], 0
  v_mov_b64 v[26:27], 0
  v_mov_b64 v[28:29], 0
  v_mov_b64 v[30:31], 0
  v_mov_b64 v[32:33], 0
  v_mov_b64 v[34:35], 0
  s_waitcnt lgkmcnt(3)
  v_smfmac_f32_16x16x64_bf16 v[16:19], v[0:3], a[176:183], v74
  s_cbranch_scc1 Cs1_last
  s_waitcnt lgkmcnt(2)
  v_smfmac_f32_16x16x64_bf16 v[16:19], v[4:7], a[184:191], v74
  s_waitcnt lgkmcnt(1)
  v_smfmac_f32_16x16x64_bf16 v[16:19], v[8:11], a[192:199], v74
  ds_read_b128 v[52:55], v75 offset:36864
  s_waitcnt lgkmcnt(1)
  v_smfmac_f32_16x16x64_bf16 v[16:19], v[12:15], a[200:207], v74
  ds_read_b128 v[56:59], v75 offset:37888
  v_smfmac_f32_16x16x64_bf16 v[20:23], v[0:3], a[208:215], v74
  ds_read_b128 v[36:39], v75 offset:38912
  v_smfmac_f32_16x16x64_bf16 v[20:23], v[4:7], a[216:223], v74
  ds_read_b128 v[40:43], v75 offset:39936
  v_cvt_pk_bf16_f32 v16, v16, v17
  v_cvt_pk_bf16_f32 v17, v18, v19
  v_bfi_b32 v16, 1, s72, v16
  v_smfmac_f32_16x16x64_bf16 v[20:23], v[8:11], v[44:51], v74
  ds_read_b128 v[44:47], v75 offset:53248
  buffer_store_dwordx2 v[16:17], v68, s[8:11], s73 offen sc1
  v_smfmac_f32_16x16x64_bf16 v[20:23], v[12:15], v[60:67], v74
  ds_read_b128 v[48:51], v75 offset:54272
  v_smfmac_f32_16x16x64_bf16 v[24:27], v[0:3], a[224:231], v74
  ds_read_b128 v[60:63], v75 offset:55296
  v_smfmac_f32_16x16x64_bf16 v[24:27], v[4:7], a[232:239], v74
  ds_read_b128 v[64:67], v75 offset:56320
  s_waitcnt lgkmcnt(6)
  v_cvt_pk_bf16_f32 v20, v20, v21
  v_cvt_pk_bf16_f32 v21, v22, v23
  v_bfi_b32 v20, 1, s72, v20
  v_smfmac_f32_16x16x64_bf16 v[24:27], v[8:11], v[52:59], v74
  buffer_store_dwordx2 v[20:21], v68, s[8:11], s74 offen sc1
  s_waitcnt lgkmcnt(4)
  v_mov_b64 v[18:19], v[72:73]
  v_smfmac_f32_16x16x64_bf16 v[24:27], v[12:15], v[36:43], v74
  v_mov_b64 v[20:21], 0
  v_smfmac_f32_16x16x64_bf16 v[28:31], v[0:3], a[240:247], v74
  v_mov_b64 v[22:23], 0
  v_smfmac_f32_16x16x64_bf16 v[28:31], v[4:7], a[248:255], v74
  s_waitcnt lgkmcnt(2)
  v_cvt_pk_bf16_f32 v24, v24, v25
  v_cvt_pk_bf16_f32 v25, v26, v27
  v_bfi_b32 v24, 1, s72, v24
  v_smfmac_f32_16x16x64_bf16 v[28:31], v[8:11], v[44:51], v74
  buffer_store_dwordx2 v[24:25], v68, s[8:11], s75 offen sc1
  s_waitcnt lgkmcnt(0)
  v_smfmac_f32_16x16x64_bf16 v[28:31], v[12:15], v[60:67], v74
  ds_read_b64 v[16:17], v77 offset:264
  v_xor_b32 v75, 0x8000, v75
  ds_read_b128 v[0:3], v76 offset:14848
  s_nop 3
  v_cvt_pk_bf16_f32 v28, v28, v29
  v_cvt_pk_bf16_f32 v29, v30, v31
  v_bfi_b32 v28, 1, s72, v28
  buffer_store_dwordx2 v[28:29], v68, s[8:11], s76 offen sc1
  v_mov_b64 v[24:25], 0
  v_mov_b64 v[26:27], 0
  v_mov_b64 v[28:29], 0
  v_mov_b64 v[30:31], 0
  s_add_u32 s58, s58, 655360
  s_add_u32 s59, s59, 655360
  s_add_u32 s70, s70, 655360
  s_add_u32 s68, s68, 655360
  s_add_u32 s66, s66, 1
  s_xor_b32 s64, s64, 16384
  s_xor_b32 s65, s65, 16384
  s_nop 15
  s_nop 15
  s_nop 7
  buffer_load_dwordx4 v[52:55], v76, s[8:11], s60 offen offset:0 sc1
  buffer_load_dwordx4 v[56:59], v76, s[8:11], s60 offen offset:1024 sc1
  s_nop 15
  s_nop 11
  buffer_load_dwordx4 v[36:39], v76, s[8:11], s60 offen offset:0 sc1
  buffer_load_dwordx4 v[40:43], v76, s[8:11], s60 offen offset:1024 sc1
  s_waitcnt vmcnt(3) lgkmcnt(0)
  v_mfma_f32_16x16x32_bf16 v[4:7], v[0:3], v[52:55], 0
  v_bitop3_b32 v72, v52, v54, s72 bitop3:0x7e
  s_waitcnt vmcnt(2)
  v_mfma_f32_16x16x32_bf16 v[4:7], v[0:3], v[56:59], v[4:7]
  v_bitop3_b32 v73, v56, v58, s72 bitop3:0x7e
  v_bitop3_b32 v72, v72, v73, 1 bitop3:0xa8
  v_cmp_ne_u32 vcc, 0, v72
  s_cbranch_vccnz Cs1_h1r
Cs1_h1p:
  s_nop 2
  v_add_f32_dpp v4, v4, v4 row_ror:4 row_mask:0xf bank_mask:0xf
  v_add_f32_dpp v5, v5, v5 row_ror:4 row_mask:0xf bank_mask:0xf
  s_nop 0
  v_add_f32_dpp v4, v4, v4 row_ror:8 row_mask:0xf bank_mask:0xf
  v_add_f32_dpp v5, v5, v5 row_ror:8 row_mask:0xf bank_mask:0xf
  v_cvt_pk_bf16_f32 v4, v4, v5
  buffer_store_dword v4, v69, s[8:11], s62 offen sc1
Cs1_h1ok:
  s_xor_b32 s62, s62, 16384
  s_xor_b32 s72, s72, 1
  s_nop 15
  s_nop 7
Cs1_h2:
  v_lshlrev_b32 v73, 2, v76
  buffer_load_dwordx4 v[52:55], v76, s[8:11], s64 offen offset:0 sc1
  buffer_load_dwordx4 v[56:59], v76, s[8:11], s64 offen offset:1024 sc1
  s_nop 15
  s_nop 1
  buffer_load_dwordx4 v[52:55], v76, s[8:11], s64 offen offset:0 sc1
  buffer_load_dwordx4 v[56:59], v76, s[8:11], s64 offen offset:1024 sc1
  s_nop 15
  s_nop 1
  buffer_load_dwordx4 v[52:55], v76, s[8:11], s64 offen offset:0 sc1
  buffer_load_dwordx4 v[56:59], v76, s[8:11], s64 offen offset:1024 sc1
  s_waitcnt vmcnt(7)
  ds_read_b128 v[60:63], v76 offset:20480
  ds_read_b128 v[64:67], v76 offset:21504
  ds_read_b128 v[44:47], v76 offset:22528
  ds_read_b128 v[48:51], v76 offset:23552
  ds_read_b128 v[36:39], v76 offset:36864
  ds_read_b128 v[40:43], v76 offset:37888
  s_waitcnt vmcnt(4)
  v_max3_u32 v72, v52, v53, v54
  v_max3_u32 v72, v72, v55, v56
  v_max3_u32 v72, v72, v57, v58
  v_max_u32 v72, v72, v59
  ds_write_b128 v76, v[52:55] offset:6656
  ds_write_b128 v76, v[56:59] offset:7680
  v_cmp_eq_u32 vcc, -1, v72
  s_cbranch_vccnz Cs1_h2r
Cs1_h2w:
  buffer_store_dword v71, v69, s[8:11], s62 offen sc1
  v_mov_b32 v72, s66
  s_branch Cs1_top
Cs1_rec:
  s_nop 7
  s_waitcnt vmcnt(0) lgkmcnt(0)
  v_max3_u32 v72, v0, v1, v2
  v_max3_u32 v72, v72, v3, v4
  v_max3_u32 v72, v72, v5, v6
  v_max3_u32 v72, v72, v7, v8
  v_max3_u32 v72, v72, v9, v10
  v_max3_u32 v72, v72, v11, v12
  v_max3_u32 v72, v72, v13, v14
  v_max3_u32 v72, v72, v15, v16
  v_max3_u32 v72, v72, v17, v18
  v_max_u32 v72, v72, v19
  v_cmp_eq_u32 vcc, -1, v72
  s_cbranch_vccz Cs1_recok
  s_barrier
  v_mov_b64 v[20:21], 0
  v_mov_b64 v[22:23], 0
  v_mov_b64 v[24:25], 0
  v_mov_b64 v[26:27], 0
  v_mov_b64 v[28:29], 0
  v_mov_b64 v[30:31], 0
  v_mov_b64 v[32:33], 0
  v_mov_b64 v[34:35], 0
  s_waitcnt lgkmcnt(0)
  s_barrier
  ds_read_b128 v[0:3], v76 offset:4608
  ds_read_b128 v[60:63], v76 offset:20480
  ds_read_b128 v[64:67], v76 offset:21504
  s_waitcnt lgkmcnt(0)
  v_smfmac_f32_16x16x64_bf16 v[20:23], v[0:3], v[60:67], v74
  ds_read_b128 v[60:63], v76 offset:22528
  ds_read_b128 v[64:67], v76 offset:23552
  s_waitcnt lgkmcnt(0)
  v_smfmac_f32_16x16x64_bf16 v[24:27], v[0:3], v[60:67], v74
  ds_read_b128 v[60:63], v76 offset:36864
  ds_read_b128 v[64:67], v76 offset:37888
  s_waitcnt lgkmcnt(0)
  v_smfmac_f32_16x16x64_bf16 v[28:31], v[0:3], v[60:67], v74
  ds_read_b128 v[60:63], v76 offset:38912
  ds_read_b128 v[64:67], v76 offset:39936
  s_waitcnt lgkmcnt(0)
  v_smfmac_f32_16x16x64_bf16 v[32:35], v[0:3], v[60:67], v74
  ds_read_b128 v[4:7], v76 offset:5632
  s_waitcnt lgkmcnt(0)
  v_smfmac_f32_16x16x64_bf16 v[20:23], v[4:7], v[80:87], v74
  v_smfmac_f32_16x16x64_bf16 v[24:27], v[4:7], v[88:95], v74
  v_smfmac_f32_16x16x64_bf16 v[28:31], v[4:7], v[208:215], v74
  v_smfmac_f32_16x16x64_bf16 v[32:35], v[4:7], v[216:223], v74
  ds_read_b128 v[8:11], v76 offset:6656
  s_waitcnt lgkmcnt(0)
  v_smfmac_f32_16x16x64_bf16 v[20:23], v[8:11], v[96:103], v74
  v_smfmac_f32_16x16x64_bf16 v[24:27], v[8:11], v[104:111], v74
  ds_read_b128 v[60:63], v76 offset:53248
  ds_read_b128 v[64:67], v76 offset:54272
  s_waitcnt lgkmcnt(0)
  v_smfmac_f32_16x16x64_bf16 v[28:31], v[8:11], v[60:67], v74
  ds_read_b128 v[60:63], v76 offset:55296
  ds_read_b128 v[64:67], v76 offset:56320
  s_waitcnt lgkmcnt(0)
  v_smfmac_f32_16x16x64_bf16 v[32:35], v[8:11], v[60:67], v74
  ds_read_b128 v[12:15], v76 offset:7680
  s_waitcnt lgkmcnt(0)
  v_smfmac_f32_16x16x64_bf16 v[20:23], v[12:15], v[112:119], v74
  v_smfmac_f32_16x16x64_bf16 v[24:27], v[12:15], v[120:127], v74
  v_smfmac_f32_16x16x64_bf16 v[28:31], v[12:15], v[224:231], v74
  v_smfmac_f32_16x16x64_bf16 v[32:35], v[12:15], v[232:239], v74
  ds_read_b128 v[4:7], v76 offset:8704
  s_waitcnt lgkmcnt(0)
  v_smfmac_f32_16x16x64_bf16 v[20:23], v[4:7], v[128:135], v74
  v_smfmac_f32_16x16x64_bf16 v[24:27], v[4:7], v[136:143], v74
  ds_read_b128 v[60:63], v75 offset:20480
  ds_read_b128 v[64:67], v75 offset:21504
  s_waitcnt lgkmcnt(0)
  v_smfmac_f32_16x16x64_bf16 v[28:31], v[4:7], v[60:67], v74
  ds_read_b128 v[60:63], v75 offset:22528
  ds_read_b128 v[64:67], v75 offset:23552
  s_waitcnt lgkmcnt(0)
  v_smfmac_f32_16x16x64_bf16 v[32:35], v[4:7], v[60:67], v74
  ds_read_b128 v[16:19], v76 offset:9728
  s_waitcnt lgkmcnt(0)
  v_smfmac_f32_16x16x64_bf16 v[20:23], v[16:19], v[144:151], v74
  v_smfmac_f32_16x16x64_bf16 v[24:27], v[16:19], v[152:159], v74
  v_smfmac_f32_16x16x64_bf16 v[28:31], v[16:19], v[240:247], v74
  v_smfmac_f32_16x16x64_bf16 v[32:35], v[16:19], v[248:255], v74
  ds_read_b128 v[12:15], v76 offset:10752
  s_waitcnt lgkmcnt(0)
  v_smfmac_f32_16x16x64_bf16 v[20:23], v[12:15], v[160:167], v74
  v_smfmac_f32_16x16x64_bf16 v[24:27], v[12:15], v[168:175], v74
  v_smfmac_f32_16x16x64_bf16 v[28:31], v[12:15], a[0:7], v74
  v_smfmac_f32_16x16x64_bf16 v[32:35], v[12:15], a[8:15], v74
  ds_read_b128 v[8:11], v76 offset:11776
  s_waitcnt lgkmcnt(0)
  v_smfmac_f32_16x16x64_bf16 v[20:23], v[8:11], v[176:183], v74
  v_smfmac_f32_16x16x64_bf16 v[24:27], v[8:11], v[184:191], v74
  v_smfmac_f32_16x16x64_bf16 v[28:31], v[8:11], a[16:23], v74
  v_smfmac_f32_16x16x64_bf16 v[32:35], v[8:11], a[24:31], v74
  ds_read_b128 v[0:3], v76 offset:12800
  s_waitcnt lgkmcnt(0)
  v_smfmac_f32_16x16x64_bf16 v[20:23], v[0:3], v[192:199], v74
  v_smfmac_f32_16x16x64_bf16 v[24:27], v[0:3], v[200:207], v74
  ds_read_b128 v[60:63], v75 offset:4096
  ds_read_b128 v[64:67], v75 offset:5120
  s_waitcnt lgkmcnt(0)
  v_smfmac_f32_16x16x64_bf16 v[28:31], v[0:3], v[60:67], v74
  ds_read_b128 v[60:63], v75 offset:6144
  ds_read_b128 v[64:67], v75 offset:7168
  s_waitcnt lgkmcnt(0)
  v_smfmac_f32_16x16x64_bf16 v[32:35], v[0:3], v[60:67], v74
  v_add_f32 v20, v20, v22
  v_add_f32 v21, v21, v23
  v_add_f32 v24, v24, v26
  v_cvt_pk_bf16_f32 v22, v20, v24
  ds_write_b32 v79, v22 offset:0
  v_add_f32 v25, v25, v27
  v_cvt_pk_bf16_f32 v23, v21, v25
  ds_write_b32 v79, v23 offset:576
  v_add_f32 v28, v28, v30
  v_add_f32 v29, v29, v31
  s_waitcnt lgkmcnt(0)
  s_nop 1
  s_branch Cs1_recok
Cs1_mx:
  s_waitcnt lgkmcnt(0)
  s_barrier
  buffer_load_dwordx4 v[0:3], v76, s[8:11], s58 offen offset:0 sc1
  ds_read_b128 v[20:23], v77 offset:0
  ds_read_b128 v[28:31], v77 offset:256
  buffer_load_dwordx4 v[4:7], v76, s[8:11], s58 offen offset:1024 sc1
  ds_read_b128 v[24:27], v77 offset:128
  ds_read_b128 v[32:35], v77 offset:384
  s_waitcnt vmcnt(1) lgkmcnt(3)
  v_mfma_f32_16x16x32_bf16 v[8:11], v[0:3], v[20:23], 0
  s_waitcnt vmcnt(0) lgkmcnt(1)
  v_mfma_f32_16x16x32_bf16 v[8:11], v[4:7], v[24:27], v[8:11]
  v_mfma_f32_16x16x32_bf16 v[12:15], v[28:31], v[20:23], 0
  s_waitcnt lgkmcnt(0)
  v_mfma_f32_16x16x32_bf16 v[12:15], v[32:35], v[24:27], v[12:15]
  v_add_f32_dpp v8, v10, v8 quad_perm:[2,3,0,1] row_mask:0xf bank_mask:0xf
  v_add_f32_dpp v9, v11, v9 quad_perm:[2,3,0,1] row_mask:0xf bank_mask:0xf
  s_nop 0
  v_mov_b32_dpp v8, v8 quad_perm:[0,1,0,1] row_mask:0xf bank_mask:0xf
  v_mov_b32_dpp v9, v9 quad_perm:[0,1,0,1] row_mask:0xf bank_mask:0xf
  s_nop 1
  v_add_f32_dpp v12, v14, v12 quad_perm:[2,3,0,1] row_mask:0xf bank_mask:0xf
  v_add_f32_dpp v13, v15, v13 quad_perm:[2,3,0,1] row_mask:0xf bank_mask:0xf
  s_nop 0
  v_mov_b32_dpp v12, v12 quad_perm:[0,1,0,1] row_mask:0xf bank_mask:0xf
  v_mov_b32_dpp v13, v13 quad_perm:[0,1,0,1] row_mask:0xf bank_mask:0xf
  v_mul_f32 v12, s69, v12
  ds_write_b32 v78, v8 offset:8708
  v_mul_f32 v13, s69, v13
  ds_write_b32 v78, v9 offset:8772
  s_waitcnt lgkmcnt(0)
  s_barrier
  ds_read_b128 v[36:39], v78 offset:8704
  ds_read_b128 v[40:43], v78 offset:8768
  s_waitcnt lgkmcnt(0)
  s_barrier
  v_max_f32 v16, v36, v37
  v_max3_f32 v16, v16, v38, v39
  v_max3_f32 v16, v16, v40, v41
  v_max3_f32 v16, v16, v42, v43
  v_max3_f32 v16, v16, v12, v13
  v_mov_b32 v17, v16
  s_nop 1
  v_permlane16_swap_b32 v16, v17
  v_max_f32 v16, v16, v17
  v_mov_b32 v17, v16
  s_nop 1
  v_permlane32_swap_b32 v16, v17
  v_max_f32 v16, v16, v17
  v_sub_f32 v36, v36, v16
  v_sub_f32 v37, v37, v16
  v_sub_f32 v38, v38, v16
  v_sub_f32 v39, v39, v16
  v_sub_f32 v40, v40, v16
  v_sub_f32 v41, v41, v16
  v_sub_f32 v42, v42, v16
  v_sub_f32 v43, v43, v16
  v_sub_f32 v12, v12, v16
  v_sub_f32 v13, v13, v16
  v_exp_f32 v36, v36
  v_exp_f32 v37, v37
  v_exp_f32 v38, v38
  v_exp_f32 v39, v39
  v_exp_f32 v40, v40
  v_exp_f32 v41, v41
  v_exp_f32 v42, v42
  v_exp_f32 v43, v43
  v_exp_f32 v12, v12
  v_exp_f32 v13, v13
  v_cvt_pk_bf16_f32 v32, v36, v40
  v_cvt_pk_bf16_f32 v33, v37, v41
  v_cvt_pk_bf16_f32 v34, v38, v42
  v_cvt_pk_bf16_f32 v35, v39, v43
  v_cvt_pk_bf16_f32 v28, v12, v13
  v_cvt_pk_bf16_f32 v31, v12, v13
  v_mov_b32 v29, 0
  v_mov_b32 v30, 0
  v_mov_b32 v68, 0x3f803f80
  v_mov_b32 v69, 0x3f803f80
  v_mov_b32 v70, 0x3f803f80
  v_mov_b32 v71, 0x3f803f80
  s_nop 1
  v_mfma_f32_16x16x32_bf16 v[8:11], v[32:35], v[68:71], 0
  v_mfma_f32_16x16x32_bf16 v[0:3], v[32:35], v[52:55], 0
  v_mfma_f32_16x16x32_bf16 v[4:7], v[32:35], v[56:59], 0
  v_mfma_f32_16x16x16_bf16 v[8:11], v[28:29], v[68:69], v[8:11]
  v_mfma_f32_16x16x16_bf16 v[0:3], v[28:29], v[72:73], v[0:3]
  v_mfma_f32_16x16x16_bf16 v[4:7], v[30:31], v[72:73], v[4:7]
  ds_read_b128 v[68:71], v76 offset:13824
  v_rcp_f32 v10, v8
  v_rcp_f32 v11, v9
  v_mul_f32 v0, v10, v0
  v_mul_f32 v1, v11, v1
  s_nop 0
  v_mul_f32 v4, v10, v4
  v_mul_f32 v5, v11, v5
  v_cvt_pk_bf16_f32 v2, v0, v4
  ds_write_b32 v79, v2 offset:8704
  v_cvt_pk_bf16_f32 v3, v1, v5
  ds_write_b32 v79, v3 offset:9280
  v_mov_b64 v[16:17], 0
  v_mov_b64 v[18:19], 0
  v_mov_b64 v[20:21], 0
  v_mov_b64 v[22:23], 0
  s_branch Cs1_mxok
Cs1_h1r:
  s_mov_b64 exec, vcc
  buffer_load_dwordx4 v[52:55], v76, s[8:11], s60 offen offset:0 sc1
  buffer_load_dwordx4 v[56:59], v76, s[8:11], s60 offen offset:1024 sc1
  s_mov_b64 exec, -1
  s_add_u32 s67, s67, 1
  s_waitcnt vmcnt(3)
  v_mfma_f32_16x16x32_bf16 v[4:7], v[0:3], v[36:39], 0
  v_bitop3_b32 v72, v36, v38, s72 bitop3:0x7e
  s_waitcnt vmcnt(2)
  v_mfma_f32_16x16x32_bf16 v[4:7], v[0:3], v[40:43], v[4:7]
  v_bitop3_b32 v73, v40, v42, s72 bitop3:0x7e
  v_bitop3_b32 v72, v72, v73, 1 bitop3:0xa8
  v_cmp_ne_u32 vcc, 0, v72
  s_cbranch_vccz Cs1_h1p
  s_mov_b64 exec, vcc
  buffer_load_dwordx4 v[36:39], v76, s[8:11], s60 offen offset:0 sc1
  buffer_load_dwordx4 v[40:43], v76, s[8:11], s60 offen offset:1024 sc1
  s_mov_b64 exec, -1
  s_add_u32 s67, s67, 1
  s_waitcnt vmcnt(3)
  v_mfma_f32_16x16x32_bf16 v[4:7], v[0:3], v[52:55], 0
  v_bitop3_b32 v72, v52, v54, s72 bitop3:0x7e
  s_waitcnt vmcnt(2)
  v_mfma_f32_16x16x32_bf16 v[4:7], v[0:3], v[56:59], v[4:7]
  v_bitop3_b32 v73, v56, v58, s72 bitop3:0x7e
  v_bitop3_b32 v72, v72, v73, 1 bitop3:0xa8
  v_cmp_ne_u32 vcc, 0, v72
  s_cbranch_vccz Cs1_h1p
  s_cmp_lt_u32 s67, 131072
  s_cbranch_scc1 Cs1_h1r
  s_branch Cs1_h1p
Cs1_h2r:
Cs1_h2s:
  s_mov_b64 exec, vcc
  buffer_load_dwordx4 v[52:55], v76, s[8:11], s64 offen offset:0 sc1
  buffer_load_dwordx4 v[56:59], v76, s[8:11], s64 offen offset:1024 sc1
  s_mov_b64 exec, -1
  s_add_u32 s67, s67, 1
  s_waitcnt vmcnt(4)
  v_max3_u32 v72, v52, v53, v54
  v_max3_u32 v72, v72, v55, v56
  v_max3_u32 v72, v72, v57, v58
  v_max_u32 v72, v72, v59
  v_cmp_eq_u32 vcc, -1, v72
  s_cbranch_vccz Cs1_h2ok
  s_mov_b64 exec, vcc
  buffer_load_dwordx4 v[52:55], v76, s[8:11], s64 offen offset:0 sc1
  buffer_load_dwordx4 v[56:59], v76, s[8:11], s64 offen offset:1024 sc1
  s_mov_b64 exec, -1
  s_add_u32 s67, s67, 1
  s_waitcnt vmcnt(4)
  v_max3_u32 v72, v52, v53, v54
  v_max3_u32 v72, v72, v55, v56
  v_max3_u32 v72, v72, v57, v58
  v_max_u32 v72, v72, v59
  v_cmp_eq_u32 vcc, -1, v72
  s_cbranch_vccz Cs1_h2ok
  s_mov_b64 exec, vcc
  buffer_load_dwordx4 v[52:55], v76, s[8:11], s64 offen offset:0 sc1
  buffer_load_dwordx4 v[56:59], v76, s[8:11], s64 offen offset:1024 sc1
  s_mov_b64 exec, -1
  s_add_u32 s67, s67, 1
  s_waitcnt vmcnt(4)
  v_max3_u32 v72, v52, v53, v54
  v_max3_u32 v72, v72, v55, v56
  v_max3_u32 v72, v72, v57, v58
  v_max_u32 v72, v72, v59
  v_cmp_eq_u32 vcc, -1, v72
  s_cbranch_vccz Cs1_h2ok
  s_mov_b64 exec, vcc
  buffer_load_dwordx4 v[52:55], v76, s[8:11], s64 offen offset:0 sc1
  buffer_load_dwordx4 v[56:59], v76, s[8:11], s64 offen offset:1024 sc1
  s_mov_b64 exec, -1
  s_add_u32 s67, s67, 1
  s_waitcnt vmcnt(4)
  v_max3_u32 v72, v52, v53, v54
  v_max3_u32 v72, v72, v55, v56
  v_max3_u32 v72, v72, v57, v58
  v_max_u32 v72, v72, v59
  v_cmp_eq_u32 vcc, -1, v72
  s_cbranch_vccz Cs1_h2ok
  s_cmp_lt_u32 s67, 131072
  s_cbranch_scc1 Cs1_h2s
Cs1_h2ok:
  ds_write_b128 v76, v[52:55] offset:6656
  ds_write_b128 v76, v[56:59] offset:7680
  s_branch Cs1_h2w
Cs1_last:
  s_nop 7
  s_waitcnt vmcnt(0) lgkmcnt(0)
  ds_read_b64 v[16:17], v77 offset:264
  v_mov_b64 v[18:19], v[72:73]
  s_add_u32 s68, s68, 655360
  s_waitcnt lgkmcnt(0)
  buffer_store_dwordx4 v[16:19], v76, s[8:11], s68 offen sc1
  s_waitcnt vmcnt(0)
  s_barrier
  v_mov_b32 v72, 65
  s_mov_b64 exec, 1
  buffer_store_dword v72, v76, s[8:11], s71 offen sc1
  s_mov_b64 exec, -1
  s_branch L_cexit
L_w6:
  v_mov_b64 v[20:21], 0
  v_mov_b64 v[22:23], 0
  v_mov_b64 v[24:25], 0
  v_mov_b64 v[26:27], 0
  v_mov_b64 v[28:29], 0
  v_mov_b64 v[30:31], 0
  v_mov_b64 v[32:33], 0
  v_mov_b64 v[34:35], 0
  s_mov_b32 m0, 15872
  v_lshlrev_b32 v73, 2, v76
  v_mov_b32 v72, 0
  ds_read_b128 v[60:63], v76 offset:24576
  ds_read_b128 v[64:67], v76 offset:25600
  ds_read_b128 v[44:47], v76 offset:26624
  ds_read_b128 v[48:51], v76 offset:27648
  ds_read_b128 v[36:39], v76 offset:40960
  ds_read_b128 v[40:43], v76 offset:41984
  ds_read_b128 v[0:3], v76 offset:4608
  ds_read_b128 v[4:7], v76 offset:5632
  s_branch Cs2_top2
.p2align 6
Cs2_top:
  s_waitcnt lgkmcnt(0)
  s_barrier
  ds_read_b128 v[0:3], v76 offset:4608
  ds_read_b128 v[4:7], v76 offset:5632
  buffer_load_dwordx4 v76, s[8:11], s64 offen offset:0 sc1 lds
  buffer_load_dwordx4 v76, s[8:11], s64 offen offset:1024 sc1 lds
Cs2_top2:
  s_waitcnt lgkmcnt(1)
  v_smfmac_f32_16x16x64_bf16 v[20:23], v[0:3], v[60:67], v74
  ds_read_b128 v[60:63], v76 offset:43008
  v_smfmac_f32_16x16x64_bf16 v[24:27], v[0:3], v[44:51], v74
  s_mov_b32 m0, 15872
  ds_read_b128 v[64:67], v76 offset:44032
  s_waitcnt lgkmcnt(2)
  v_smfmac_f32_16x16x64_bf16 v[20:23], v[4:7], v[80:87], v74
  buffer_load_dwordx4 v[44:47], v76, s[8:11], s58 offen offset:0 sc1
  ds_read_b128 v[8:11], v76 offset:6656
  v_smfmac_f32_16x16x64_bf16 v[28:31], v[0:3], v[36:43], v74
  ds_read_b128 v[36:39], v76 offset:57344
  v_smfmac_f32_16x16x64_bf16 v[24:27], v[4:7], v[88:95], v74
  buffer_load_dwordx4 v[48:51], v76, s[8:11], s58 offen offset:1024 sc1
  ds_read_b128 v[40:43], v76 offset:58368
  v_smfmac_f32_16x16x64_bf16 v[28:31], v[4:7], v[208:215], v74
  ds_read_b128 v[12:15], v76 offset:7680
  v_smfmac_f32_16x16x64_bf16 v[32:35], v[4:7], v[216:223], v74
  buffer_load_dwordx4 v[52:55], v76, s[8:11], s59 offen offset:0 sc1
  s_waitcnt lgkmcnt(4)
  v_smfmac_f32_16x16x64_bf16 v[32:35], v[0:3], v[60:67], v74
  ds_read_b128 v[60:63], v76 offset:59392
  s_waitcnt lgkmcnt(4)
  v_smfmac_f32_16x16x64_bf16 v[20:23], v[8:11], v[96:103], v74
  buffer_load_dwordx4 v[56:59], v76, s[8:11], s59 offen offset:1024 sc1
  ds_read_b128 v[64:67], v76 offset:60416
  v_smfmac_f32_16x16x64_bf16 v[24:27], v[8:11], v[104:111], v74
  ds_read_b128 v[0:3], v76 offset:12800
  s_waitcnt lgkmcnt(4)
  v_smfmac_f32_16x16x64_bf16 v[28:31], v[8:11], v[36:43], v74
  ds_read_b128 v[36:39], v75 offset:8192
  s_waitcnt lgkmcnt(4)
  v_smfmac_f32_16x16x64_bf16 v[20:23], v[12:15], v[112:119], v74
  ds_read_b128 v[40:43], v75 offset:9216
  v_smfmac_f32_16x16x64_bf16 v[24:27], v[12:15], v[120:127], v74
  s_waitcnt lgkmcnt(3)
  v_smfmac_f32_16x16x64_bf16 v[32:35], v[8:11], v[60:67], v74
  buffer_store_dwordx4 v[16:19], v76, s[8:11], s68 offen sc1
  ds_read_b128 v[60:63], v75 offset:10240
  v_smfmac_f32_16x16x64_bf16 v[28:31], v[12:15], v[224:231], v74
  buffer_load_dword v73, s[8:11], s70 offen lds
  s_waitcnt vmcnt(6)
  ds_read_b128 v[64:67], v75 offset:11264
  v_smfmac_f32_16x16x64_bf16 v[32:35], v[12:15], v[232:239], v74
  s_barrier
  s_waitcnt lgkmcnt(4)
  v_smfmac_f32_16x16x64_bf16 v[20:23], v[0:3], v[192:199], v74
  ds_read_b128 v[4:7], v76 offset:8704
  s_waitcnt lgkmcnt(3)
  v_smfmac_f32_16x16x64_bf16 v[28:31], v[0:3], v[36:43], v74
  ds_read_b128 v[16:19], v76 offset:9728
  v_smfmac_f32_16x16x64_bf16 v[24:27], v[0:3], v[200:207], v74
  ds_read_b128 v[36:39], v75 offset:24576
  s_waitcnt lgkmcnt(3)
  v_mov_b32 v68, 0x3f803f80
  v_smfmac_f32_16x16x64_bf16 v[32:35], v[0:3], v[60:67], v74
  ds_read_b128 v[40:43], v75 offset:25600
  s_waitcnt lgkmcnt(3)
  v_smfmac_f32_16x16x64_bf16 v[20:23], v[4:7], v[128:135], v74
  ds_read_b128 v[12:15], v76 offset:10752
  v_mov_b32 v69, 0x3f803f80
  v_smfmac_f32_16x16x64_bf16 v[24:27], v[4:7], v[136:143], v74
  ds_read_b128 v[8:11], v76 offset:11776
  s_waitcnt lgkmcnt(4)
  v_smfmac_f32_16x16x64_bf16 v[20:23], v[16:19], v[144:151], v74
  ds_read_b128 v[60:63], v75 offset:26624
  v_mov_b64 v[70:71], v[68:69]
  v_smfmac_f32_16x16x64_bf16 v[24:27], v[16:19], v[152:159], v74
  ds_read_b128 v[64:67], v75 offset:27648
  s_waitcnt lgkmcnt(4)
  v_smfmac_f32_16x16x64_bf16 v[28:31], v[4:7], v[36:43], v74
  s_waitcnt lgkmcnt(3)
  v_mov_b64 v[36:37], 0
  v_smfmac_f32_16x16x64_bf16 v[20:23], v[12:15], v[160:167], v74
  s_waitcnt lgkmcnt(2)
  v_mov_b64 v[38:39], 0
  v_smfmac_f32_16x16x64_bf16 v[20:23], v[8:11], v[176:183], v74
  v_mov_b64 v[40:41], 0
  v_smfmac_f32_16x16x64_bf16 v[24:27], v[12:15], v[168:175], v74
  v_mov_b64 v[42:43], 0
  v_smfmac_f32_16x16x64_bf16 v[24:27], v[8:11], v[184:191], v74
  s_waitcnt lgkmcnt(0)
  v_add_f32 v20, v20, v22
  v_smfmac_f32_16x16x64_bf16 v[32:35], v[4:7], v[60:67], v74
  v_add_f32 v21, v21, v23
  v_smfmac_f32_16x16x64_bf16 v[28:31], v[16:19], v[240:247], v74
  v_add_f32 v24, v24, v26
  v_cvt_pk_bf16_f32 v22, v20, v24
  v_smfmac_f32_16x16x64_bf16 v[28:31], v[12:15], a[0:7], v74
  ds_write_b32 v79, v22 offset:0
  v_add_f32 v25, v25, v27
  v_cvt_pk_bf16_f32 v23, v21, v25
  v_smfmac_f32_16x16x64_bf16 v[28:31], v[8:11], a[16:23], v74
  ds_write_b32 v79, v23 offset:576
  v_cmp_u_f32 vcc, v20, v21
  v_smfmac_f32_16x16x64_bf16 v[32:35], v[16:19], v[248:255], v74
  v_smfmac_f32_16x16x64_bf16 v[32:35], v[12:15], a[8:15], v74
  v_add_f32 v28, v28, v30
  v_add_f32 v29, v29, v31
  v_smfmac_f32_16x16x64_bf16 v[32:35], v[8:11], a[24:31], v74
  s_cbranch_vccnz Cs2_rec
Cs2_recok:
  v_smfmac_f32_16x16x64_bf16 v[36:39], v[16:19], a[112:119], v74
  s_waitcnt lgkmcnt(0)
  s_barrier
  ds_read_b128 v[60:63], v77
  v_smfmac_f32_16x16x64_bf16 v[40:43], v[16:19], a[120:127], v74
  ds_read_b128 v[64:67], v77 offset:128
  v_add_f32 v32, v32, v34
  v_cvt_pk_bf16_f32 v30, v28, v32
  v_smfmac_f32_16x16x64_bf16 v[36:39], v[0:3], a[160:167], v74
  ds_write_b32 v79, v30 offset:256
  v_add_f32 v33, v33, v35
  v_cvt_pk_bf16_f32 v31, v29, v33
  v_smfmac_f32_16x16x64_bf16 v[40:43], v[0:3], a[168:175], v74
  ds_write_b32 v79, v31 offset:832
  v_xor_b32 v75, 0x8000, v75
  v_smfmac_f32_16x16x64_bf16 v[36:39], v[4:7], a[96:103], v74
  ds_read_b128 v[0:3], v76 offset:4608
  v_mov_b32 v29, 0
  v_smfmac_f32_16x16x64_bf16 v[40:43], v[4:7], a[104:111], v74
  s_waitcnt vmcnt(4) lgkmcnt(3)
  v_mov_b32 v30, 0
  v_mfma_f32_16x16x32_bf16 v[44:47], v[44:47], v[60:63], 0
  ds_read_b128 v[4:7], v76 offset:5632
  s_waitcnt lgkmcnt(2)
  v_mfma_f32_16x16x32_bf16 v[44:47], v[48:51], v[64:67], v[44:47]
  s_barrier
  v_smfmac_f32_16x16x64_bf16 v[36:39], v[8:11], a[144:151], v74
  ds_read_b128 v[20:23], v77 offset:256
  ds_read_b128 v[24:27], v77 offset:384
  v_smfmac_f32_16x16x64_bf16 v[40:43], v[8:11], a[152:159], v74
  ds_read_b128 v[8:11], v76 offset:6656
  v_add_f32_dpp v72, v46, v44 quad_perm:[2,3,0,1] row_mask:0xf bank_mask:0xf
  v_add_f32_dpp v73, v47, v45 quad_perm:[2,3,0,1] row_mask:0xf bank_mask:0xf
  v_smfmac_f32_16x16x64_bf16 v[36:39], v[12:15], a[128:135], v74
  ds_read_b128 v[44:47], v75 offset:0
  v_exp_f32_dpp v72, v72 quad_perm:[0,1,0,1] row_mask:0xf bank_mask:0xf
  v_smfmac_f32_16x16x64_bf16 v[40:43], v[12:15], a[136:143], v74
  ds_read_b128 v[12:15], v76 offset:7680
  s_waitcnt lgkmcnt(6)
  v_exp_f32_dpp v73, v73 quad_perm:[0,1,0,1] row_mask:0xf bank_mask:0xf
  v_smfmac_f32_16x16x64_bf16 v[36:39], v[0:3], a[32:39], v74
  s_waitcnt lgkmcnt(3)
  v_cvt_pk_bf16_f32 v72, v72, v73
  v_mfma_f32_16x16x32_bf16 v[20:23], v[20:23], v[60:63], 0
  ds_write_b32 v78, v72 offset:520
  v_mfma_f32_16x16x32_bf16 v[20:23], v[24:27], v[64:67], v[20:23]
  ds_read_b128 v[48:51], v75 offset:1024
  v_smfmac_f32_16x16x64_bf16 v[40:43], v[0:3], a[40:47], v74
  ds_read_b128 v[60:63], v75 offset:2048
  v_smfmac_f32_16x16x64_bf16 v[36:39], v[4:7], a[48:55], v74
  s_waitcnt lgkmcnt(5)
  v_add_f32_dpp v24, v22, v20 quad_perm:[2,3,0,1] row_mask:0xf bank_mask:0xf
  v_add_f32_dpp v25, v23, v21 quad_perm:[2,3,0,1] row_mask:0xf bank_mask:0xf
  v_smfmac_f32_16x16x64_bf16 v[36:39], v[8:11], a[64:71], v74
  s_waitcnt lgkmcnt(2)
  s_barrier
  ds_read_b128 v[32:35], v78 offset:512
  v_smfmac_f32_16x16x64_bf16 v[36:39], v[12:15], a[80:87], v74
  ds_read_b128 v[64:67], v75 offset:3072
  v_mul_f32 v24, s69, v24
  v_smfmac_f32_16x16x64_bf16 v[40:43], v[4:7], a[56:63], v74
  v_mul_f32 v25, s69, v25
  v_smfmac_f32_16x16x64_bf16 v[40:43], v[8:11], a[72:79], v74
  v_exp_f32_dpp v24, v24 quad_perm:[0,1,0,1] row_mask:0xf bank_mask:0xf
  v_smfmac_f32_16x16x64_bf16 v[40:43], v[12:15], a[88:95], v74
  s_waitcnt vmcnt(2) lgkmcnt(1)
  v_exp_f32_dpp v25, v25 quad_perm:[0,1,0,1] row_mask:0xf bank_mask:0xf
  v_mfma_f32_16x16x32_bf16 v[8:11], v[32:35], v[68:71], 0
  v_add_f32 v36, v36, v38
  v_add_f32 v37, v37, v39
  v_mfma_f32_16x16x32_bf16 v[0:3], v[32:35], v[52:55], 0
  v_add_f32 v40, v40, v42
  v_add_f32 v41, v41, v43
  v_mfma_f32_16x16x32_bf16 v[4:7], v[32:35], v[56:59], 0
  v_cvt_pk_bf16_f32 v28, v24, v25
  v_cvt_pk_bf16_f32 v72, v36, v37
  v_cvt_pk_bf16_f32 v73, v40, v41
  v_mfma_f32_16x16x16_bf16 v[8:11], v[28:29], v[68:69], v[8:11]
  v_cvt_pk_bf16_f32 v31, v24, v25
  v_mfma_f32_16x16x16_bf16 v[0:3], v[28:29], v[72:73], v[0:3]
  ds_read_b128 v[68:71], v76 offset:13824
  v_mfma_f32_16x16x16_bf16 v[4:7], v[30:31], v[72:73], v[4:7]
  v_rcp_f32 v10, v8
  v_rcp_f32 v11, v9
  v_mul_f32 v0, v10, v0
  v_mul_f32 v1, v11, v1
  s_nop 0
  v_mul_f32 v4, v10, v4
  v_mul_f32 v5, v11, v5
  v_cvt_pk_bf16_f32 v2, v0, v4
  ds_write_b32 v79, v2 offset:8704
  v_cvt_pk_bf16_f32 v3, v1, v5
  ds_write_b32 v79, v3 offset:9280
  v_subrev_u32 v8, 813694976, v8
  v_subrev_u32 v9, 813694976, v9
  v_max_u32 v8, v8, v9
  v_cmp_le_u32 vcc, 503316480, v8
  v_mov_b64 v[16:17], 0
  v_mov_b64 v[18:19], 0
  v_mov_b64 v[20:21], 0
  v_mov_b64 v[22:23], 0
  s_cbranch_vccnz Cs2_mx
Cs2_mxok:
  s_cmp_eq_u32 s66, 63
  s_waitcnt lgkmcnt(0)
  s_barrier
  ds_read_b128 v[0:3], v78 offset:8704
  ds_read_b128 v[4:7], v78 offset:8768
  ds_read_b128 v[8:11], v78 offset:8832
  ds_read_b128 v[12:15], v78 offset:8896
  v_mov_b64 v[24:25], 0
  v_mov_b64 v[26:27], 0
  v_mov_b64 v[28:29], 0
  v_mov_b64 v[30:31], 0
  v_mov_b64 v[32:33], 0
  v_mov_b64 v[34:35], 0
  s_waitcnt lgkmcnt(3)
  v_smfmac_f32_16x16x64_bf16 v[16:19], v[0:3], a[176:183], v74
  ds_read_b128 v[52:55], v75 offset:4096
  ds_read_b128 v[56:59], v75 offset:5120
  s_waitcnt lgkmcnt(4)
  v_smfmac_f32_16x16x64_bf16 v[16:19], v[4:7], a[184:191], v74
  ds_read_b128 v[36:39], v75 offset:6144
  s_waitcnt lgkmcnt(4)
  v_smfmac_f32_16x16x64_bf16 v[16:19], v[8:11], a[192:199], v74
  ds_read_b128 v[40:43], v75 offset:7168
  s_waitcnt lgkmcnt(4)
  v_smfmac_f32_16x16x64_bf16 v[16:19], v[12:15], a[200:207], v74
  s_cbranch_scc1 Cs2_last
  v_smfmac_f32_16x16x64_bf16 v[32:35], v[0:3], v[44:51], v74
  ds_read_b128 v[44:47], v75 offset:24576
  ds_read_b128 v[48:51], v75 offset:25600
  v_smfmac_f32_16x16x64_bf16 v[32:35], v[4:7], v[60:67], v74
  ds_read_b128 v[60:63], v75 offset:26624
  s_waitcnt lgkmcnt(5)
  v_cvt_pk_bf16_f32 v16, v16, v17
  v_cvt_pk_bf16_f32 v17, v18, v19
  v_bfi_b32 v16, 1, s72, v16
  v_smfmac_f32_16x16x64_bf16 v[32:35], v[8:11], v[52:59], v74
  ds_read_b128 v[64:67], v75 offset:27648
  buffer_store_dwordx2 v[16:17], v68, s[8:11], s73 offen sc1
  s_waitcnt lgkmcnt(4)
  v_smfmac_f32_16x16x64_bf16 v[32:35], v[12:15], v[36:43], v74
  ds_read_b128 v[52:55], v75 offset:40960
  v_smfmac_f32_16x16x64_bf16 v[20:23], v[0:3], a[208:215], v74
  ds_read_b128 v[56:59], v75 offset:41984
  v_smfmac_f32_16x16x64_bf16 v[20:23], v[4:7], a[216:223], v74
  ds_read_b128 v[36:39], v75 offset:43008
  s_waitcnt lgkmcnt(5)
  v_cvt_pk_bf16_f32 v32, v32, v33
  v_cvt_pk_bf16_f32 v33, v34, v35
  v_bfi_b32 v32, 1, s72, v32
  v_smfmac_f32_16x16x64_bf16 v[20:23], v[8:11], v[44:51], v74
  ds_read_b128 v[40:43], v75 offset:44032
  buffer_store_dwordx2 v[32:33], v68, s[8:11], s77 offen sc1
  s_waitcnt lgkmcnt(4)
  v_mov_b64 v[18:19], v[72:73]
  v_smfmac_f32_16x16x64_bf16 v[20:23], v[12:15], v[60:67], v74
  ds_read_b128 v[44:47], v75 offset:57344
  v_mov_b64 v[32:33], 0
  v_smfmac_f32_16x16x64_bf16 v[24:27], v[0:3], a[224:231], v74
  ds_read_b128 v[48:51], v75 offset:58368
  v_mov_b64 v[34:35], 0
  v_smfmac_f32_16x16x64_bf16 v[24:27], v[4:7], a[232:239], v74
  ds_read_b128 v[60:63], v75 offset:59392
  s_waitcnt lgkmcnt(5)
  v_cvt_pk_bf16_f32 v20, v20, v21
  v_cvt_pk_bf16_f32 v21, v22, v23
  v_bfi_b32 v20, 1, s72, v20
  v_smfmac_f32_16x16x64_bf16 v[24:27], v[8:11], v[52:59], v74
  ds_read_b128 v[64:67], v75 offset:60416
  buffer_store_dwordx2 v[20:21], v68, s[8:11], s74 offen sc1
  s_waitcnt lgkmcnt(4)
  v_smfmac_f32_16x16x64_bf16 v[24:27], v[12:15], v[36:43], v74
  ds_read_b64 v[16:17], v77 offset:384
  v_xor_b32 v75, 0x8000, v75
  v_smfmac_f32_16x16x64_bf16 v[28:31], v[0:3], a[240:247], v74
  v_smfmac_f32_16x16x64_bf16 v[28:31], v[4:7], a[248:255], v74
  s_waitcnt lgkmcnt(3)
  v_cvt_pk_bf16_f32 v24, v24, v25
  v_cvt_pk_bf16_f32 v25, v26, v27
  v_bfi_b32 v24, 1, s72, v24
  v_smfmac_f32_16x16x64_bf16 v[28:31], v[8:11], v[44:51], v74
  buffer_store_dwordx2 v[24:25], v68, s[8:11], s75 offen sc1
  s_waitcnt lgkmcnt(1)
  v_smfmac_f32_16x16x64_bf16 v[28:31], v[12:15], v[60:67], v74
  ds_read_b128 v[0:3], v76 offset:14848
  s_nop 6
  v_cvt_pk_bf16_f32 v28, v28, v29
  v_cvt_pk_bf16_f32 v29, v30, v31
  v_bfi_b32 v28, 1, s72, v28
  buffer_store_dwordx2 v[28:29], v68, s[8:11], s76 offen sc1
  v_mov_b64 v[20:21], 0
  v_mov_b64 v[22:23], 0
  v_mov_b64 v[24:25], 0
  v_mov_b64 v[26:27], 0
  v_mov_b64 v[28:29], 0
  v_mov_b64 v[30:31], 0
  s_add_u32 s58, s58, 655360
  s_add_u32 s59, s59, 655360
  s_add_u32 s70, s70, 655360
  s_add_u32 s68, s68, 655360
  s_add_u32 s66, s66, 1
  s_xor_b32 s64, s64, 16384
  s_xor_b32 s65, s65, 16384
  s_nop 15
  s_nop 15
  s_nop 7
  buffer_load_dwordx4 v[52:55], v76, s[8:11], s60 offen offset:0 sc1
  buffer_load_dwordx4 v[56:59], v76, s[8:11], s60 offen offset:1024 sc1
  s_nop 15
  s_nop 11
  buffer_load_dwordx4 v[36:39], v76, s[8:11], s60 offen offset:0 sc1
  buffer_load_dwordx4 v[40:43], v76, s[8:11], s60 offen offset:1024 sc1
  s_waitcnt vmcnt(3) lgkmcnt(0)
  v_mfma_f32_16x16x32_bf16 v[4:7], v[0:3], v[52:55], 0
  v_bitop3_b32 v72, v52, v54, s72 bitop3:0x7e
  s_waitcnt vmcnt(2)
  v_mfma_f32_16x16x32_bf16 v[4:7], v[0:3], v[56:59], v[4:7]
  v_bitop3_b32 v73, v56, v58, s72 bitop3:0x7e
  v_bitop3_b32 v72, v72, v73, 1 bitop3:0xa8
  v_cmp_ne_u32 vcc, 0, v72
  s_cbranch_vccnz Cs2_h1r
Cs2_h1p:
  s_nop 2
  v_add_f32_dpp v4, v4, v4 row_ror:4 row_mask:0xf bank_mask:0xf
  v_add_f32_dpp v5, v5, v5 row_ror:4 row_mask:0xf bank_mask:0xf
  s_nop 0
  v_add_f32_dpp v4, v4, v4 row_ror:8 row_mask:0xf bank_mask:0xf
  v_add_f32_dpp v5, v5, v5 row_ror:8 row_mask:0xf bank_mask:0xf
  v_cvt_pk_bf16_f32 v4, v4, v5
  buffer_store_dword v4, v69, s[8:11], s62 offen sc1
Cs2_h1ok:
  s_xor_b32 s62, s62, 16384
  s_xor_b32 s72, s72, 1
Cs2_h2:
  v_lshlrev_b32 v73, 2, v76
  s_mov_b32 m0, 8704
  buffer_store_dword v71, v69, s[8:11], s62 offen sc1
  s_waitcnt vmcnt(2)
  ds_read_b128 v[60:63], v76 offset:24576
  ds_read_b128 v[64:67], v76 offset:25600
  ds_read_b128 v[44:47], v76 offset:26624
  ds_read_b128 v[48:51], v76 offset:27648
  ds_read_b128 v[36:39], v76 offset:40960
  ds_read_b128 v[40:43], v76 offset:41984
  s_branch Cs2_top
Cs2_rec:
  s_nop 7
  s_waitcnt vmcnt(0) lgkmcnt(0)
  v_max3_u32 v72, v0, v1, v2
  v_max3_u32 v72, v72, v3, v4
  v_max3_u32 v72, v72, v5, v6
  v_max3_u32 v72, v72, v7, v8
  v_max3_u32 v72, v72, v9, v10
  v_max3_u32 v72, v72, v11, v12
  v_max3_u32 v72, v72, v13, v14
  v_max3_u32 v72, v72, v15, v16
  v_max3_u32 v72, v72, v17, v18
  v_max_u32 v72, v72, v19
  v_cmp_eq_u32 vcc, -1, v72
  s_cbranch_vccz Cs2_recok
  s_barrier
Cs2_recp:
  buffer_load_dwordx4 v[60:63], v76, s[8:11], s64 offen offset:0 sc1
  buffer_load_dwordx4 v[64:67], v76, s[8:11], s64 offen offset:1024 sc1
  s_add_u32 s67, s67, 1
  s_cmp_lt_u32 s67, 131072
  s_cselect_b32 s54, -2, -1
  s_waitcnt vmcnt(1)
  v_max3_u32 v72, v60, v61, v62
  s_waitcnt vmcnt(0)
  v_max3_u32 v72, v72, v63, v64
  v_max3_u32 v72, v72, v65, v66
  v_max_u32 v72, v72, v67
  v_cmp_lt_u32 vcc, s54, v72
  s_cbranch_vccnz Cs2_recp
  ds_write_b128 v76, v[60:63] offset:8704
  ds_write_b128 v76, v[64:67] offset:9728
  v_mov_b64 v[20:21], 0
  v_mov_b64 v[22:23], 0
  v_mov_b64 v[24:25], 0
  v_mov_b64 v[26:27], 0
  v_mov_b64 v[28:29], 0
  v_mov_b64 v[30:31], 0
  v_mov_b64 v[32:33], 0
  v_mov_b64 v[34:35], 0
  s_waitcnt lgkmcnt(0)
  s_barrier
  ds_read_b128 v[0:3], v76 offset:4608
  ds_read_b128 v[60:63], v76 offset:24576
  ds_read_b128 v[64:67], v76 offset:25600
  s_waitcnt lgkmcnt(0)
  v_smfmac_f32_16x16x64_bf16 v[20:23], v[0:3], v[60:67], v74
  ds_read_b128 v[60:63], v76 offset:26624
  ds_read_b128 v[64:67], v76 offset:27648
  s_waitcnt lgkmcnt(0)
  v_smfmac_f32_16x16x64_bf16 v[24:27], v[0:3], v[60:67], v74
  ds_read_b128 v[60:63], v76 offset:40960
  ds_read_b128 v[64:67], v76 offset:41984
  s_waitcnt lgkmcnt(0)
  v_smfmac_f32_16x16x64_bf16 v[28:31], v[0:3], v[60:67], v74
  ds_read_b128 v[60:63], v76 offset:43008
  ds_read_b128 v[64:67], v76 offset:44032
  s_waitcnt lgkmcnt(0)
  v_smfmac_f32_16x16x64_bf16 v[32:35], v[0:3], v[60:67], v74
  ds_read_b128 v[4:7], v76 offset:5632
  s_waitcnt lgkmcnt(0)
  v_smfmac_f32_16x16x64_bf16 v[20:23], v[4:7], v[80:87], v74
  v_smfmac_f32_16x16x64_bf16 v[24:27], v[4:7], v[88:95], v74
  v_smfmac_f32_16x16x64_bf16 v[28:31], v[4:7], v[208:215], v74
  v_smfmac_f32_16x16x64_bf16 v[32:35], v[4:7], v[216:223], v74
  ds_read_b128 v[8:11], v76 offset:6656
  s_waitcnt lgkmcnt(0)
  v_smfmac_f32_16x16x64_bf16 v[20:23], v[8:11], v[96:103], v74
  v_smfmac_f32_16x16x64_bf16 v[24:27], v[8:11], v[104:111], v74
  ds_read_b128 v[60:63], v76 offset:57344
  ds_read_b128 v[64:67], v76 offset:58368
  s_waitcnt lgkmcnt(0)
  v_smfmac_f32_16x16x64_bf16 v[28:31], v[8:11], v[60:67], v74
  ds_read_b128 v[60:63], v76 offset:59392
  ds_read_b128 v[64:67], v76 offset:60416
  s_waitcnt lgkmcnt(0)
  v_smfmac_f32_16x16x64_bf16 v[32:35], v[8:11], v[60:67], v74
  ds_read_b128 v[12:15], v76 offset:7680
  s_waitcnt lgkmcnt(0)
  v_smfmac_f32_16x16x64_bf16 v[20:23], v[12:15], v[112:119], v74
  v_smfmac_f32_16x16x64_bf16 v[24:27], v[12:15], v[120:127], v74
  v_smfmac_f32_16x16x64_bf16 v[28:31], v[12:15], v[224:231], v74
  v_smfmac_f32_16x16x64_bf16 v[32:35], v[12:15], v[232:239], v74
  ds_read_b128 v[4:7], v76 offset:8704
  s_waitcnt lgkmcnt(0)
  v_smfmac_f32_16x16x64_bf16 v[20:23], v[4:7], v[128:135], v74
  v_smfmac_f32_16x16x64_bf16 v[24:27], v[4:7], v[136:143], v74
  ds_read_b128 v[60:63], v75 offset:24576
  ds_read_b128 v[64:67], v75 offset:25600
  s_waitcnt lgkmcnt(0)
  v_smfmac_f32_16x16x64_bf16 v[28:31], v[4:7], v[60:67], v74
  ds_read_b128 v[60:63], v75 offset:26624
  ds_read_b128 v[64:67], v75 offset:27648
  s_waitcnt lgkmcnt(0)
  v_smfmac_f32_16x16x64_bf16 v[32:35], v[4:7], v[60:67], v74
  ds_read_b128 v[16:19], v76 offset:9728
  s_waitcnt lgkmcnt(0)
  v_smfmac_f32_16x16x64_bf16 v[20:23], v[16:19], v[144:151], v74
  v_smfmac_f32_16x16x64_bf16 v[24:27], v[16:19], v[152:159], v74
  v_smfmac_f32_16x16x64_bf16 v[28:31], v[16:19], v[240:247], v74
  v_smfmac_f32_16x16x64_bf16 v[32:35], v[16:19], v[248:255], v74
  ds_read_b128 v[12:15], v76 offset:10752
  s_waitcnt lgkmcnt(0)
  v_smfmac_f32_16x16x64_bf16 v[20:23], v[12:15], v[160:167], v74
  v_smfmac_f32_16x16x64_bf16 v[24:27], v[12:15], v[168:175], v74
  v_smfmac_f32_16x16x64_bf16 v[28:31], v[12:15], a[0:7], v74
  v_smfmac_f32_16x16x64_bf16 v[32:35], v[12:15], a[8:15], v74
  ds_read_b128 v[8:11], v76 offset:11776
  s_waitcnt lgkmcnt(0)
  v_smfmac_f32_16x16x64_bf16 v[20:23], v[8:11], v[176:183], v74
  v_smfmac_f32_16x16x64_bf16 v[24:27], v[8:11], v[184:191], v74
  v_smfmac_f32_16x16x64_bf16 v[28:31], v[8:11], a[16:23], v74
  v_smfmac_f32_16x16x64_bf16 v[32:35], v[8:11], a[24:31], v74
  ds_read_b128 v[0:3], v76 offset:12800
  s_waitcnt lgkmcnt(0)
  v_smfmac_f32_16x16x64_bf16 v[20:23], v[0:3], v[192:199], v74
  v_smfmac_f32_16x16x64_bf16 v[24:27], v[0:3], v[200:207], v74
  ds_read_b128 v[60:63], v75 offset:8192
  ds_read_b128 v[64:67], v75 offset:9216
  s_waitcnt lgkmcnt(0)
  v_smfmac_f32_16x16x64_bf16 v[28:31], v[0:3], v[60:67], v74
  ds_read_b128 v[60:63], v75 offset:10240
  ds_read_b128 v[64:67], v75 offset:11264
  s_waitcnt lgkmcnt(0)
  v_smfmac_f32_16x16x64_bf16 v[32:35], v[0:3], v[60:67], v74
  v_add_f32 v20, v20, v22
  v_add_f32 v21, v21, v23
  v_add_f32 v24, v24, v26
  v_cvt_pk_bf16_f32 v22, v20, v24
  ds_write_b32 v79, v22 offset:0
  v_add_f32 v25, v25, v27
  v_cvt_pk_bf16_f32 v23, v21, v25
  ds_write_b32 v79, v23 offset:576
  v_add_f32 v28, v28, v30
  v_add_f32 v29, v29, v31
  s_waitcnt lgkmcnt(0)
  s_nop 1
  s_branch Cs2_recok
Cs2_mx:
  s_waitcnt lgkmcnt(0)
  s_barrier
  buffer_load_dwordx4 v[0:3], v76, s[8:11], s58 offen offset:0 sc1
  ds_read_b128 v[20:23], v77 offset:0
  ds_read_b128 v[28:31], v77 offset:256
  buffer_load_dwordx4 v[4:7], v76, s[8:11], s58 offen offset:1024 sc1
  ds_read_b128 v[24:27], v77 offset:128
  ds_read_b128 v[32:35], v77 offset:384
  s_waitcnt vmcnt(1) lgkmcnt(3)
  v_mfma_f32_16x16x32_bf16 v[8:11], v[0:3], v[20:23], 0
  s_waitcnt vmcnt(0) lgkmcnt(1)
  v_mfma_f32_16x16x32_bf16 v[8:11], v[4:7], v[24:27], v[8:11]
  v_mfma_f32_16x16x32_bf16 v[12:15], v[28:31], v[20:23], 0
  s_waitcnt lgkmcnt(0)
  v_mfma_f32_16x16x32_bf16 v[12:15], v[32:35], v[24:27], v[12:15]
  v_add_f32_dpp v8, v10, v8 quad_perm:[2,3,0,1] row_mask:0xf bank_mask:0xf
  v_add_f32_dpp v9, v11, v9 quad_perm:[2,3,0,1] row_mask:0xf bank_mask:0xf
  s_nop 0
  v_mov_b32_dpp v8, v8 quad_perm:[0,1,0,1] row_mask:0xf bank_mask:0xf
  v_mov_b32_dpp v9, v9 quad_perm:[0,1,0,1] row_mask:0xf bank_mask:0xf
  s_nop 1
  v_add_f32_dpp v12, v14, v12 quad_perm:[2,3,0,1] row_mask:0xf bank_mask:0xf
  v_add_f32_dpp v13, v15, v13 quad_perm:[2,3,0,1] row_mask:0xf bank_mask:0xf
  s_nop 0
  v_mov_b32_dpp v12, v12 quad_perm:[0,1,0,1] row_mask:0xf bank_mask:0xf
  v_mov_b32_dpp v13, v13 quad_perm:[0,1,0,1] row_mask:0xf bank_mask:0xf
  v_mul_f32 v12, s69, v12
  ds_write_b32 v78, v8 offset:8712
  v_mul_f32 v13, s69, v13
  ds_write_b32 v78, v9 offset:8776
  s_waitcnt lgkmcnt(0)
  s_barrier
  ds_read_b128 v[36:39], v78 offset:8704
  ds_read_b128 v[40:43], v78 offset:8768
  s_waitcnt lgkmcnt(0)
  s_barrier
  v_max_f32 v16, v36, v37
  v_max3_f32 v16, v16, v38, v39
  v_max3_f32 v16, v16, v40, v41
  v_max3_f32 v16, v16, v42, v43
  v_max3_f32 v16, v16, v12, v13
  v_mov_b32 v17, v16
  s_nop 1
  v_permlane16_swap_b32 v16, v17
  v_max_f32 v16, v16, v17
  v_mov_b32 v17, v16
  s_nop 1
  v_permlane32_swap_b32 v16, v17
  v_max_f32 v16, v16, v17
  v_sub_f32 v36, v36, v16
  v_sub_f32 v37, v37, v16
  v_sub_f32 v38, v38, v16
  v_sub_f32 v39, v39, v16
  v_sub_f32 v40, v40, v16
  v_sub_f32 v41, v41, v16
  v_sub_f32 v42, v42, v16
  v_sub_f32 v43, v43, v16
  v_sub_f32 v12, v12, v16
  v_sub_f32 v13, v13, v16
  v_exp_f32 v36, v36
  v_exp_f32 v37, v37
  v_exp_f32 v38, v38
  v_exp_f32 v39, v39
  v_exp_f32 v40, v40
  v_exp_f32 v41, v41
  v_exp_f32 v42, v42
  v_exp_f32 v43, v43
  v_exp_f32 v12, v12
  v_exp_f32 v13, v13
  v_cvt_pk_bf16_f32 v32, v36, v40
  v_cvt_pk_bf16_f32 v33, v37, v41
  v_cvt_pk_bf16_f32 v34, v38, v42
  v_cvt_pk_bf16_f32 v35, v39, v43
  v_cvt_pk_bf16_f32 v28, v12, v13
  v_cvt_pk_bf16_f32 v31, v12, v13
  v_mov_b32 v29, 0
  v_mov_b32 v30, 0
  v_mov_b32 v68, 0x3f803f80
  v_mov_b32 v69, 0x3f803f80
  v_mov_b32 v70, 0x3f803f80
  v_mov_b32 v71, 0x3f803f80
  s_nop 1
  v_mfma_f32_16x16x32_bf16 v[8:11], v[32:35], v[68:71], 0
  v_mfma_f32_16x16x32_bf16 v[0:3], v[32:35], v[52:55], 0
  v_mfma_f32_16x16x32_bf16 v[4:7], v[32:35], v[56:59], 0
  v_mfma_f32_16x16x16_bf16 v[8:11], v[28:29], v[68:69], v[8:11]
  v_mfma_f32_16x16x16_bf16 v[0:3], v[28:29], v[72:73], v[0:3]
  v_mfma_f32_16x16x16_bf16 v[4:7], v[30:31], v[72:73], v[4:7]
  ds_read_b128 v[68:71], v76 offset:13824
  v_rcp_f32 v10, v8
  v_rcp_f32 v11, v9
  v_mul_f32 v0, v10, v0
  v_mul_f32 v1, v11, v1
  s_nop 0
  v_mul_f32 v4, v10, v4
  v_mul_f32 v5, v11, v5
  v_cvt_pk_bf16_f32 v2, v0, v4
  ds_write_b32 v79, v2 offset:8704
  v_cvt_pk_bf16_f32 v3, v1, v5
  ds_write_b32 v79, v3 offset:9280
  v_mov_b64 v[16:17], 0
  v_mov_b64 v[18:19], 0
  v_mov_b64 v[20:21], 0
  v_mov_b64 v[22:23], 0
  s_branch Cs2_mxok
Cs2_h1r:
  s_mov_b64 exec, vcc
  buffer_load_dwordx4 v[52:55], v76, s[8:11], s60 offen offset:0 sc1
  buffer_load_dwordx4 v[56:59], v76, s[8:11], s60 offen offset:1024 sc1
  s_mov_b64 exec, -1
  s_add_u32 s67, s67, 1
  s_waitcnt vmcnt(3)
  v_mfma_f32_16x16x32_bf16 v[4:7], v[0:3], v[36:39], 0
  v_bitop3_b32 v72, v36, v38, s72 bitop3:0x7e
  s_waitcnt vmcnt(2)
  v_mfma_f32_16x16x32_bf16 v[4:7], v[0:3], v[40:43], v[4:7]
  v_bitop3_b32 v73, v40, v42, s72 bitop3:0x7e
  v_bitop3_b32 v72, v72, v73, 1 bitop3:0xa8
  v_cmp_ne_u32 vcc, 0, v72
  s_cbranch_vccz Cs2_h1p
  s_mov_b64 exec, vcc
  buffer_load_dwordx4 v[36:39], v76, s[8:11], s60 offen offset:0 sc1
  buffer_load_dwordx4 v[40:43], v76, s[8:11], s60 offen offset:1024 sc1
  s_mov_b64 exec, -1
  s_add_u32 s67, s67, 1
  s_waitcnt vmcnt(3)
  v_mfma_f32_16x16x32_bf16 v[4:7], v[0:3], v[52:55], 0
  v_bitop3_b32 v72, v52, v54, s72 bitop3:0x7e
  s_waitcnt vmcnt(2)
  v_mfma_f32_16x16x32_bf16 v[4:7], v[0:3], v[56:59], v[4:7]
  v_bitop3_b32 v73, v56, v58, s72 bitop3:0x7e
  v_bitop3_b32 v72, v72, v73, 1 bitop3:0xa8
  v_cmp_ne_u32 vcc, 0, v72
  s_cbranch_vccz Cs2_h1p
  s_cmp_lt_u32 s67, 131072
  s_cbranch_scc1 Cs2_h1r
  s_branch Cs2_h1p
Cs2_last:
  s_nop 7
  s_waitcnt vmcnt(0) lgkmcnt(0)
  ds_read_b64 v[16:17], v77 offset:384
  v_mov_b64 v[18:19], v[72:73]
  s_add_u32 s68, s68, 655360
  s_waitcnt lgkmcnt(0)
  buffer_store_dwordx4 v[16:19], v76, s[8:11], s68 offen sc1
  s_waitcnt vmcnt(0)
  s_barrier
  s_branch L_cexit
L_w7:
  v_mov_b64 v[20:21], 0
  v_mov_b64 v[22:23], 0
  v_mov_b64 v[24:25], 0
  v_mov_b64 v[26:27], 0
  v_mov_b64 v[28:29], 0
  v_mov_b64 v[30:31], 0
  v_mov_b64 v[32:33], 0
  v_mov_b64 v[34:35], 0
  s_mov_b32 m0, 15872
  v_lshlrev_b32 v73, 2, v76
  v_mov_b32 v72, 0
  ds_read_b128 v[60:63], v76 offset:28672
  ds_read_b128 v[64:67], v76 offset:29696
  ds_read_b128 v[44:47], v76 offset:30720
  ds_read_b128 v[48:51], v76 offset:31744
  ds_read_b128 v[36:39], v76 offset:45056
  ds_read_b128 v[40:43], v76 offset:46080
  ds_read_b128 v[0:3], v76 offset:4608
  ds_read_b128 v[4:7], v76 offset:5632
  s_branch Cs3_top2
.p2align 6
Cs3_top:
  s_waitcnt lgkmcnt(0)
  s_barrier
  ds_read_b128 v[0:3], v76 offset:4608
  ds_read_b128 v[4:7], v76 offset:5632
  buffer_load_dwordx4 v76, s[8:11], s64 offen offset:0 sc1 lds
  buffer_load_dwordx4 v76, s[8:11], s64 offen offset:1024 sc1 lds
Cs3_top2:
  s_waitcnt lgkmcnt(1)
  v_smfmac_f32_16x16x64_bf16 v[20:23], v[0:3], v[60:67], v74
  ds_read_b128 v[60:63], v76 offset:47104
  v_smfmac_f32_16x16x64_bf16 v[24:27], v[0:3], v[44:51], v74
  s_mov_b32 m0, 15872
  ds_read_b128 v[64:67], v76 offset:48128
  s_waitcnt lgkmcnt(2)
  v_smfmac_f32_16x16x64_bf16 v[20:23], v[4:7], v[80:87], v74
  buffer_load_dwordx4 v[44:47], v76, s[8:11], s58 offen offset:0 sc1
  ds_read_b128 v[8:11], v76 offset:6656
  v_smfmac_f32_16x16x64_bf16 v[28:31], v[0:3], v[36:43], v74
  ds_read_b128 v[36:39], v76 offset:61440
  v_smfmac_f32_16x16x64_bf16 v[24:27], v[4:7], v[88:95], v74
  buffer_load_dwordx4 v[48:51], v76, s[8:11], s58 offen offset:1024 sc1
  ds_read_b128 v[40:43], v76 offset:62464
  v_smfmac_f32_16x16x64_bf16 v[28:31], v[4:7], v[208:215], v74
  ds_read_b128 v[12:15], v76 offset:7680
  v_smfmac_f32_16x16x64_bf16 v[32:35], v[4:7], v[216:223], v74
  buffer_load_dwordx4 v[52:55], v76, s[8:11], s59 offen offset:0 sc1
  s_waitcnt lgkmcnt(4)
  v_smfmac_f32_16x16x64_bf16 v[32:35], v[0:3], v[60:67], v74
  ds_read_b128 v[60:63], v76 offset:63488
  s_waitcnt lgkmcnt(4)
  v_smfmac_f32_16x16x64_bf16 v[20:23], v[8:11], v[96:103], v74
  buffer_load_dwordx4 v[56:59], v76, s[8:11], s59 offen offset:1024 sc1
  ds_read_b128 v[64:67], v76 offset:64512
  v_smfmac_f32_16x16x64_bf16 v[24:27], v[8:11], v[104:111], v74
  ds_read_b128 v[0:3], v76 offset:12800
  s_waitcnt lgkmcnt(4)
  v_smfmac_f32_16x16x64_bf16 v[28:31], v[8:11], v[36:43], v74
  ds_read_b128 v[36:39], v75 offset:12288
  s_waitcnt lgkmcnt(4)
  v_smfmac_f32_16x16x64_bf16 v[20:23], v[12:15], v[112:119], v74
  ds_read_b128 v[40:43], v75 offset:13312
  v_smfmac_f32_16x16x64_bf16 v[24:27], v[12:15], v[120:127], v74
  buffer_load_dword v73, s[8:11], s70 offen lds
  s_waitcnt lgkmcnt(3)
  v_smfmac_f32_16x16x64_bf16 v[32:35], v[8:11], v[60:67], v74
  ds_read_b128 v[60:63], v75 offset:14336
  v_smfmac_f32_16x16x64_bf16 v[28:31], v[12:15], v[224:231], v74
  s_waitcnt vmcnt(5)
  ds_read_b128 v[64:67], v75 offset:15360
  v_smfmac_f32_16x16x64_bf16 v[32:35], v[12:15], v[232:239], v74
  buffer_store_dwordx4 v[16:19], v76, s[8:11], s68 offen sc1
  s_barrier
  s_waitcnt lgkmcnt(4)
  v_smfmac_f32_16x16x64_bf16 v[20:23], v[0:3], v[192:199], v74
  ds_read_b128 v[4:7], v76 offset:8704
  s_waitcnt lgkmcnt(3)
  v_smfmac_f32_16x16x64_bf16 v[28:31], v[0:3], v[36:43], v74
  ds_read_b128 v[16:19], v76 offset:9728
  v_smfmac_f32_16x16x64_bf16 v[24:27], v[0:3], v[200:207], v74
  ds_read_b128 v[36:39], v75 offset:28672
  s_waitcnt lgkmcnt(3)
  v_mov_b32 v68, 0x3f803f80
  v_smfmac_f32_16x16x64_bf16 v[32:35], v[0:3], v[60:67], v74
  ds_read_b128 v[40:43], v75 offset:29696
  s_waitcnt lgkmcnt(3)
  v_smfmac_f32_16x16x64_bf16 v[20:23], v[4:7], v[128:135], v74
  ds_read_b128 v[12:15], v76 offset:10752
  v_mov_b32 v69, 0x3f803f80
  v_smfmac_f32_16x16x64_bf16 v[24:27], v[4:7], v[136:143], v74
  ds_read_b128 v[8:11], v76 offset:11776
  s_waitcnt lgkmcnt(4)
  v_smfmac_f32_16x16x64_bf16 v[20:23], v[16:19], v[144:151], v74
  ds_read_b128 v[60:63], v75 offset:30720
  v_mov_b64 v[70:71], v[68:69]
  v_smfmac_f32_16x16x64_bf16 v[24:27], v[16:19], v[152:159], v74
  ds_read_b128 v[64:67], v75 offset:31744
  s_waitcnt lgkmcnt(4)
  v_smfmac_f32_16x16x64_bf16 v[28:31], v[4:7], v[36:43], v74
  s_waitcnt lgkmcnt(3)
  v_mov_b64 v[36:37], 0
  v_smfmac_f32_16x16x64_bf16 v[20:23], v[12:15], v[160:167], v74
  s_waitcnt lgkmcnt(2)
  v_mov_b64 v[38:39], 0
  v_smfmac_f32_16x16x64_bf16 v[20:23], v[8:11], v[176:183], v74
  v_mov_b64 v[40:41], 0
  v_smfmac_f32_16x16x64_bf16 v[24:27], v[12:15], v[168:175], v74
  v_mov_b64 v[42:43], 0
  v_smfmac_f32_16x16x64_bf16 v[24:27], v[8:11], v[184:191], v74
  s_waitcnt lgkmcnt(0)
  v_add_f32 v20, v20, v22
  v_smfmac_f32_16x16x64_bf16 v[32:35], v[4:7], v[60:67], v74
  v_add_f32 v21, v21, v23
  v_smfmac_f32_16x16x64_bf16 v[28:31], v[16:19], v[240:247], v74
  v_add_f32 v24, v24, v26
  v_cvt_pk_bf16_f32 v22, v20, v24
  v_smfmac_f32_16x16x64_bf16 v[28:31], v[12:15], a[0:7], v74
  ds_write_b32 v79, v22 offset:0
  v_add_f32 v25, v25, v27
  v_cvt_pk_bf16_f32 v23, v21, v25
  v_smfmac_f32_16x16x64_bf16 v[28:31], v[8:11], a[16:23], v74
  ds_write_b32 v79, v23 offset:576
  v_cmp_u_f32 vcc, v20, v21
  v_smfmac_f32_16x16x64_bf16 v[32:35], v[16:19], v[248:255], v74
  v_smfmac_f32_16x16x64_bf16 v[32:35], v[12:15], a[8:15], v74
  v_add_f32 v28, v28, v30
  v_add_f32 v29, v29, v31
  v_smfmac_f32_16x16x64_bf16 v[32:35], v[8:11], a[24:31], v74
  s_cbranch_vccnz Cs3_rec
Cs3_recok:
  v_smfmac_f32_16x16x64_bf16 v[36:39], v[16:19], a[112:119], v74
  s_waitcnt lgkmcnt(0)
  s_barrier
  ds_read_b128 v[60:63], v77
  v_smfmac_f32_16x16x64_bf16 v[40:43], v[16:19], a[120:127], v74
  ds_read_b128 v[64:67], v77 offset:128
  v_add_f32 v32, v32, v34
  v_cvt_pk_bf16_f32 v30, v28, v32
  v_smfmac_f32_16x16x64_bf16 v[36:39], v[0:3], a[160:167], v74
  ds_write_b32 v79, v30 offset:256
  v_add_f32 v33, v33, v35
  v_cvt_pk_bf16_f32 v31, v29, v33
  v_smfmac_f32_16x16x64_bf16 v[40:43], v[0:3], a[168:175], v74
  ds_write_b32 v79, v31 offset:832
  v_xor_b32 v75, 0x8000, v75
  v_smfmac_f32_16x16x64_bf16 v[36:39], v[4:7], a[96:103], v74
  ds_read_b128 v[0:3], v76 offset:4608
  v_mov_b32 v29, 0
  v_smfmac_f32_16x16x64_bf16 v[40:43], v[4:7], a[104:111], v74
  s_waitcnt vmcnt(4) lgkmcnt(3)
  v_mov_b32 v30, 0
  v_mfma_f32_16x16x32_bf16 v[44:47], v[44:47], v[60:63], 0
  ds_read_b128 v[4:7], v76 offset:5632
  s_waitcnt lgkmcnt(2)
  v_mfma_f32_16x16x32_bf16 v[44:47], v[48:51], v[64:67], v[44:47]
  s_barrier
  v_smfmac_f32_16x16x64_bf16 v[36:39], v[8:11], a[144:151], v74
  ds_read_b128 v[20:23], v77 offset:256
  ds_read_b128 v[24:27], v77 offset:384
  v_smfmac_f32_16x16x64_bf16 v[40:43], v[8:11], a[152:159], v74
  ds_read_b128 v[8:11], v76 offset:6656
  v_add_f32_dpp v72, v46, v44 quad_perm:[2,3,0,1] row_mask:0xf bank_mask:0xf
  v_add_f32_dpp v73, v47, v45 quad_perm:[2,3,0,1] row_mask:0xf bank_mask:0xf
  v_smfmac_f32_16x16x64_bf16 v[36:39], v[12:15], a[128:135], v74
  ds_read_b128 v[44:47], v75 offset:8192
  v_exp_f32_dpp v72, v72 quad_perm:[0,1,0,1] row_mask:0xf bank_mask:0xf
  v_smfmac_f32_16x16x64_bf16 v[40:43], v[12:15], a[136:143], v74
  ds_read_b128 v[12:15], v76 offset:7680
  s_waitcnt lgkmcnt(6)
  v_exp_f32_dpp v73, v73 quad_perm:[0,1,0,1] row_mask:0xf bank_mask:0xf
  v_smfmac_f32_16x16x64_bf16 v[36:39], v[0:3], a[32:39], v74
  s_waitcnt lgkmcnt(3)
  v_cvt_pk_bf16_f32 v72, v72, v73
  v_mfma_f32_16x16x32_bf16 v[20:23], v[20:23], v[60:63], 0
  ds_write_b32 v78, v72 offset:524
  v_mfma_f32_16x16x32_bf16 v[20:23], v[24:27], v[64:67], v[20:23]
  ds_read_b128 v[48:51], v75 offset:9216
  v_smfmac_f32_16x16x64_bf16 v[40:43], v[0:3], a[40:47], v74
  ds_read_b128 v[60:63], v75 offset:10240
  v_smfmac_f32_16x16x64_bf16 v[36:39], v[4:7], a[48:55], v74
  s_waitcnt lgkmcnt(5)
  v_add_f32_dpp v24, v22, v20 quad_perm:[2,3,0,1] row_mask:0xf bank_mask:0xf
  v_add_f32_dpp v25, v23, v21 quad_perm:[2,3,0,1] row_mask:0xf bank_mask:0xf
  v_smfmac_f32_16x16x64_bf16 v[36:39], v[8:11], a[64:71], v74
  s_waitcnt lgkmcnt(2)
  s_barrier
  ds_read_b128 v[32:35], v78 offset:512
  v_smfmac_f32_16x16x64_bf16 v[36:39], v[12:15], a[80:87], v74
  ds_read_b128 v[64:67], v75 offset:11264
  v_mul_f32 v24, s69, v24
  v_smfmac_f32_16x16x64_bf16 v[40:43], v[4:7], a[56:63], v74
  v_mul_f32 v25, s69, v25
  v_smfmac_f32_16x16x64_bf16 v[40:43], v[8:11], a[72:79], v74
  v_exp_f32_dpp v24, v24 quad_perm:[0,1,0,1] row_mask:0xf bank_mask:0xf
  v_smfmac_f32_16x16x64_bf16 v[40:43], v[12:15], a[88:95], v74
  s_waitcnt vmcnt(2) lgkmcnt(1)
  v_exp_f32_dpp v25, v25 quad_perm:[0,1,0,1] row_mask:0xf bank_mask:0xf
  v_mfma_f32_16x16x32_bf16 v[8:11], v[32:35], v[68:71], 0
  v_add_f32 v36, v36, v38
  v_add_f32 v37, v37, v39
  v_mfma_f32_16x16x32_bf16 v[0:3], v[32:35], v[52:55], 0
  v_add_f32 v40, v40, v42
  v_add_f32 v41, v41, v43
  v_mfma_f32_16x16x32_bf16 v[4:7], v[32:35], v[56:59], 0
  v_cvt_pk_bf16_f32 v28, v24, v25
  v_cvt_pk_bf16_f32 v72, v36, v37
  v_cvt_pk_bf16_f32 v73, v40, v41
  v_mfma_f32_16x16x16_bf16 v[8:11], v[28:29], v[68:69], v[8:11]
  v_cvt_pk_bf16_f32 v31, v24, v25
  v_mfma_f32_16x16x16_bf16 v[0:3], v[28:29], v[72:73], v[0:3]
  ds_read_b128 v[68:71], v76 offset:13824
  v_mfma_f32_16x16x16_bf16 v[4:7], v[30:31], v[72:73], v[4:7]
  v_rcp_f32 v10, v8
  v_rcp_f32 v11, v9
  v_mul_f32 v0, v10, v0
  v_mul_f32 v1, v11, v1
  s_nop 0
  v_mul_f32 v4, v10, v4
  v_mul_f32 v5, v11, v5
  v_cvt_pk_bf16_f32 v2, v0, v4
  ds_write_b32 v79, v2 offset:8704
  v_cvt_pk_bf16_f32 v3, v1, v5
  ds_write_b32 v79, v3 offset:9280
  v_subrev_u32 v8, 813694976, v8
  v_subrev_u32 v9, 813694976, v9
  v_max_u32 v8, v8, v9
  v_cmp_le_u32 vcc, 503316480, v8
  v_mov_b64 v[16:17], 0
  v_mov_b64 v[18:19], 0
  v_mov_b64 v[20:21], 0
  v_mov_b64 v[22:23], 0
  s_cbranch_vccnz Cs3_mx
Cs3_mxok:
  s_cmp_eq_u32 s66, 63
  s_waitcnt lgkmcnt(0)
  s_barrier
  ds_read_b128 v[0:3], v78 offset:8704
  ds_read_b128 v[4:7], v78 offset:8768
  ds_read_b128 v[8:11], v78 offset:8832
  ds_read_b128 v[12:15], v78 offset:8896
  v_mov_b64 v[24:25], 0
  v_mov_b64 v[26:27], 0
  v_mov_b64 v[28:29], 0
  v_mov_b64 v[30:31], 0
  v_mov_b64 v[32:33], 0
  v_mov_b64 v[34:35], 0
  s_waitcnt lgkmcnt(3)
  v_smfmac_f32_16x16x64_bf16 v[16:19], v[0:3], a[176:183], v74
  ds_read_b128 v[52:55], v75 offset:12288
  ds_read_b128 v[56:59], v75 offset:13312
  s_waitcnt lgkmcnt(4)
  v_smfmac_f32_16x16x64_bf16 v[16:19], v[4:7], a[184:191], v74
  ds_read_b128 v[36:39], v75 offset:14336
  s_waitcnt lgkmcnt(4)
  v_smfmac_f32_16x16x64_bf16 v[16:19], v[8:11], a[192:199], v74
  ds_read_b128 v[40:43], v75 offset:15360
  s_waitcnt lgkmcnt(4)
  v_smfmac_f32_16x16x64_bf16 v[16:19], v[12:15], a[200:207], v74
  s_cbranch_scc1 Cs3_last
  v_smfmac_f32_16x16x64_bf16 v[32:35], v[0:3], v[44:51], v74
  ds_read_b128 v[44:47], v75 offset:28672
  ds_read_b128 v[48:51], v75 offset:29696
  v_smfmac_f32_16x16x64_bf16 v[32:35], v[4:7], v[60:67], v74
  ds_read_b128 v[60:63], v75 offset:30720
  s_waitcnt lgkmcnt(5)
  v_cvt_pk_bf16_f32 v16, v16, v17
  v_cvt_pk_bf16_f32 v17, v18, v19
  v_bfi_b32 v16, 1, s72, v16
  v_smfmac_f32_16x16x64_bf16 v[32:35], v[8:11], v[52:59], v74
  ds_read_b128 v[64:67], v75 offset:31744
  buffer_store_dwordx2 v[16:17], v68, s[8:11], s73 offen sc1
  s_waitcnt lgkmcnt(4)
  v_smfmac_f32_16x16x64_bf16 v[32:35], v[12:15], v[36:43], v74
  ds_read_b128 v[52:55], v75 offset:45056
  v_smfmac_f32_16x16x64_bf16 v[20:23], v[0:3], a[208:215], v74
  ds_read_b128 v[56:59], v75 offset:46080
  v_smfmac_f32_16x16x64_bf16 v[20:23], v[4:7], a[216:223], v74
  ds_read_b128 v[36:39], v75 offset:47104
  s_waitcnt lgkmcnt(5)
  v_cvt_pk_bf16_f32 v32, v32, v33
  v_cvt_pk_bf16_f32 v33, v34, v35
  v_bfi_b32 v32, 1, s72, v32
  v_smfmac_f32_16x16x64_bf16 v[20:23], v[8:11], v[44:51], v74
  ds_read_b128 v[40:43], v75 offset:48128
  buffer_store_dwordx2 v[32:33], v68, s[8:11], s77 offen sc1
  s_waitcnt lgkmcnt(4)
  v_mov_b64 v[18:19], v[72:73]
  v_smfmac_f32_16x16x64_bf16 v[20:23], v[12:15], v[60:67], v74
  ds_read_b128 v[44:47], v75 offset:61440
  v_mov_b64 v[32:33], 0
  v_smfmac_f32_16x16x64_bf16 v[24:27], v[0:3], a[224:231], v74
  ds_read_b128 v[48:51], v75 offset:62464
  v_mov_b64 v[34:35], 0
  v_smfmac_f32_16x16x64_bf16 v[24:27], v[4:7], a[232:239], v74
  ds_read_b128 v[60:63], v75 offset:63488
  s_waitcnt lgkmcnt(5)
  v_cvt_pk_bf16_f32 v20, v20, v21
  v_cvt_pk_bf16_f32 v21, v22, v23
  v_bfi_b32 v20, 1, s72, v20
  v_smfmac_f32_16x16x64_bf16 v[24:27], v[8:11], v[52:59], v74
  ds_read_b128 v[64:67], v75 offset:64512
  buffer_store_dwordx2 v[20:21], v68, s[8:11], s74 offen sc1
  s_waitcnt lgkmcnt(4)
  v_smfmac_f32_16x16x64_bf16 v[24:27], v[12:15], v[36:43], v74
  ds_read_b64 v[16:17], v77 offset:392
  v_xor_b32 v75, 0x8000, v75
  v_smfmac_f32_16x16x64_bf16 v[28:31], v[0:3], a[240:247], v74
  v_smfmac_f32_16x16x64_bf16 v[28:31], v[4:7], a[248:255], v74
  s_waitcnt lgkmcnt(3)
  v_cvt_pk_bf16_f32 v24, v24, v25
  v_cvt_pk_bf16_f32 v25, v26, v27
  v_bfi_b32 v24, 1, s72, v24
  v_smfmac_f32_16x16x64_bf16 v[28:31], v[8:11], v[44:51], v74
  buffer_store_dwordx2 v[24:25], v68, s[8:11], s75 offen sc1
  s_waitcnt lgkmcnt(1)
  v_smfmac_f32_16x16x64_bf16 v[28:31], v[12:15], v[60:67], v74
  ds_read_b128 v[0:3], v76 offset:14848
  s_nop 6
  v_cvt_pk_bf16_f32 v28, v28, v29
  v_cvt_pk_bf16_f32 v29, v30, v31
  v_bfi_b32 v28, 1, s72, v28
  buffer_store_dwordx2 v[28:29], v68, s[8:11], s76 offen sc1
  v_mov_b64 v[20:21], 0
  v_mov_b64 v[22:23], 0
  v_mov_b64 v[24:25], 0
  v_mov_b64 v[26:27], 0
  v_mov_b64 v[28:29], 0
  v_mov_b64 v[30:31], 0
  s_add_u32 s58, s58, 655360
  s_add_u32 s59, s59, 655360
  s_add_u32 s70, s70, 655360
  s_add_u32 s68, s68, 655360
  s_add_u32 s66, s66, 1
  s_xor_b32 s64, s64, 16384
  s_xor_b32 s65, s65, 16384
  s_nop 15
  s_nop 15
  s_nop 15
  s_nop 7
  buffer_load_dwordx4 v[52:55], v76, s[8:11], s60 offen offset:0 sc1
  buffer_load_dwordx4 v[56:59], v76, s[8:11], s60 offen offset:1024 sc1
  s_nop 15
  s_nop 11
  buffer_load_dwordx4 v[36:39], v76, s[8:11], s60 offen offset:0 sc1
  buffer_load_dwordx4 v[40:43], v76, s[8:11], s60 offen offset:1024 sc1
  s_waitcnt lgkmcnt(0)
  s_cmp_eq_u32 s66, 12
  s_cbranch_scc1 Cs3_kv
Cs3_kvb:
  s_waitcnt vmcnt(3)
  v_mfma_f32_16x16x32_bf16 v[4:7], v[0:3], v[52:55], 0
  v_bitop3_b32 v72, v52, v54, s72 bitop3:0x7e
  s_waitcnt vmcnt(2)
  v_mfma_f32_16x16x32_bf16 v[4:7], v[0:3], v[56:59], v[4:7]
  v_bitop3_b32 v73, v56, v58, s72 bitop3:0x7e
  v_bitop3_b32 v72, v72, v73, 1 bitop3:0xa8
  v_cmp_ne_u32 vcc, 0, v72
  s_cbranch_vccnz Cs3_h1r
Cs3_h1p:
  s_nop 2
  v_add_f32_dpp v4, v4, v4 row_ror:4 row_mask:0xf bank_mask:0xf
  v_add_f32_dpp v5, v5, v5 row_ror:4 row_mask:0xf bank_mask:0xf
  s_nop 0
  v_add_f32_dpp v4, v4, v4 row_ror:8 row_mask:0xf bank_mask:0xf
  v_add_f32_dpp v5, v5, v5 row_ror:8 row_mask:0xf bank_mask:0xf
  v_cvt_pk_bf16_f32 v4, v4, v5
  buffer_store_dword v4, v69, s[8:11], s62 offen sc1
Cs3_h1ok:
  s_xor_b32 s62, s62, 16384
  s_xor_b32 s72, s72, 1
Cs3_h2:
  v_lshlrev_b32 v73, 2, v76
  s_mov_b32 m0, 10752
  buffer_store_dword v71, v69, s[8:11], s62 offen sc1
  s_waitcnt vmcnt(2)
  ds_read_b128 v[60:63], v76 offset:28672
  ds_read_b128 v[64:67], v76 offset:29696
  ds_read_b128 v[44:47], v76 offset:30720
  ds_read_b128 v[48:51], v76 offset:31744
  ds_read_b128 v[36:39], v76 offset:45056
  ds_read_b128 v[40:43], v76 offset:46080
  s_cmp_eq_u32 s66, 12
  s_cbranch_scc1 Cs3_kv2
  s_branch Cs3_top
Cs3_rec:
  s_nop 7
  s_waitcnt vmcnt(0) lgkmcnt(0)
  v_max3_u32 v72, v0, v1, v2
  v_max3_u32 v72, v72, v3, v4
  v_max3_u32 v72, v72, v5, v6
  v_max3_u32 v72, v72, v7, v8
  v_max3_u32 v72, v72, v9, v10
  v_max3_u32 v72, v72, v11, v12
  v_max3_u32 v72, v72, v13, v14
  v_max3_u32 v72, v72, v15, v16
  v_max3_u32 v72, v72, v17, v18
  v_max_u32 v72, v72, v19
  v_cmp_eq_u32 vcc, -1, v72
  s_cbranch_vccz Cs3_recok
  s_barrier
Cs3_recp:
  buffer_load_dwordx4 v[60:63], v76, s[8:11], s64 offen offset:0 sc1
  buffer_load_dwordx4 v[64:67], v76, s[8:11], s64 offen offset:1024 sc1
  s_add_u32 s67, s67, 1
  s_cmp_lt_u32 s67, 131072
  s_cselect_b32 s54, -2, -1
  s_waitcnt vmcnt(1)
  v_max3_u32 v72, v60, v61, v62
  s_waitcnt vmcnt(0)
  v_max3_u32 v72, v72, v63, v64
  v_max3_u32 v72, v72, v65, v66
  v_max_u32 v72, v72, v67
  v_cmp_lt_u32 vcc, s54, v72
  s_cbranch_vccnz Cs3_recp
  ds_write_b128 v76, v[60:63] offset:10752
  ds_write_b128 v76, v[64:67] offset:11776
  v_mov_b64 v[20:21], 0
  v_mov_b64 v[22:23], 0
  v_mov_b64 v[24:25], 0
  v_mov_b64 v[26:27], 0
  v_mov_b64 v[28:29], 0
  v_mov_b64 v[30:31], 0
  v_mov_b64 v[32:33], 0
  v_mov_b64 v[34:35], 0
  s_waitcnt lgkmcnt(0)
  s_barrier
  ds_read_b128 v[0:3], v76 offset:4608
  ds_read_b128 v[60:63], v76 offset:28672
  ds_read_b128 v[64:67], v76 offset:29696
  s_waitcnt lgkmcnt(0)
  v_smfmac_f32_16x16x64_bf16 v[20:23], v[0:3], v[60:67], v74
  ds_read_b128 v[60:63], v76 offset:30720
  ds_read_b128 v[64:67], v76 offset:31744
  s_waitcnt lgkmcnt(0)
  v_smfmac_f32_16x16x64_bf16 v[24:27], v[0:3], v[60:67], v74
  ds_read_b128 v[60:63], v76 offset:45056
  ds_read_b128 v[64:67], v76 offset:46080
  s_waitcnt lgkmcnt(0)
  v_smfmac_f32_16x16x64_bf16 v[28:31], v[0:3], v[60:67], v74
  ds_read_b128 v[60:63], v76 offset:47104
  ds_read_b128 v[64:67], v76 offset:48128
  s_waitcnt lgkmcnt(0)
  v_smfmac_f32_16x16x64_bf16 v[32:35], v[0:3], v[60:67], v74
  ds_read_b128 v[4:7], v76 offset:5632
  s_waitcnt lgkmcnt(0)
  v_smfmac_f32_16x16x64_bf16 v[20:23], v[4:7], v[80:87], v74
  v_smfmac_f32_16x16x64_bf16 v[24:27], v[4:7], v[88:95], v74
  v_smfmac_f32_16x16x64_bf16 v[28:31], v[4:7], v[208:215], v74
  v_smfmac_f32_16x16x64_bf16 v[32:35], v[4:7], v[216:223], v74
  ds_read_b128 v[8:11], v76 offset:6656
  s_waitcnt lgkmcnt(0)
  v_smfmac_f32_16x16x64_bf16 v[20:23], v[8:11], v[96:103], v74
  v_smfmac_f32_16x16x64_bf16 v[24:27], v[8:11], v[104:111], v74
  ds_read_b128 v[60:63], v76 offset:61440
  ds_read_b128 v[64:67], v76 offset:62464
  s_waitcnt lgkmcnt(0)
  v_smfmac_f32_16x16x64_bf16 v[28:31], v[8:11], v[60:67], v74
  ds_read_b128 v[60:63], v76 offset:63488
  ds_read_b128 v[64:67], v76 offset:64512
  s_waitcnt lgkmcnt(0)
  v_smfmac_f32_16x16x64_bf16 v[32:35], v[8:11], v[60:67], v74
  ds_read_b128 v[12:15], v76 offset:7680
  s_waitcnt lgkmcnt(0)
  v_smfmac_f32_16x16x64_bf16 v[20:23], v[12:15], v[112:119], v74
  v_smfmac_f32_16x16x64_bf16 v[24:27], v[12:15], v[120:127], v74
  v_smfmac_f32_16x16x64_bf16 v[28:31], v[12:15], v[224:231], v74
  v_smfmac_f32_16x16x64_bf16 v[32:35], v[12:15], v[232:239], v74
  ds_read_b128 v[4:7], v76 offset:8704
  s_waitcnt lgkmcnt(0)
  v_smfmac_f32_16x16x64_bf16 v[20:23], v[4:7], v[128:135], v74
  v_smfmac_f32_16x16x64_bf16 v[24:27], v[4:7], v[136:143], v74
  ds_read_b128 v[60:63], v75 offset:28672
  ds_read_b128 v[64:67], v75 offset:29696
  s_waitcnt lgkmcnt(0)
  v_smfmac_f32_16x16x64_bf16 v[28:31], v[4:7], v[60:67], v74
  ds_read_b128 v[60:63], v75 offset:30720
  ds_read_b128 v[64:67], v75 offset:31744
  s_waitcnt lgkmcnt(0)
  v_smfmac_f32_16x16x64_bf16 v[32:35], v[4:7], v[60:67], v74
  ds_read_b128 v[16:19], v76 offset:9728
  s_waitcnt lgkmcnt(0)
  v_smfmac_f32_16x16x64_bf16 v[20:23], v[16:19], v[144:151], v74
  v_smfmac_f32_16x16x64_bf16 v[24:27], v[16:19], v[152:159], v74
  v_smfmac_f32_16x16x64_bf16 v[28:31], v[16:19], v[240:247], v74
  v_smfmac_f32_16x16x64_bf16 v[32:35], v[16:19], v[248:255], v74
  ds_read_b128 v[12:15], v76 offset:10752
  s_waitcnt lgkmcnt(0)
  v_smfmac_f32_16x16x64_bf16 v[20:23], v[12:15], v[160:167], v74
  v_smfmac_f32_16x16x64_bf16 v[24:27], v[12:15], v[168:175], v74
  v_smfmac_f32_16x16x64_bf16 v[28:31], v[12:15], a[0:7], v74
  v_smfmac_f32_16x16x64_bf16 v[32:35], v[12:15], a[8:15], v74
  ds_read_b128 v[8:11], v76 offset:11776
  s_waitcnt lgkmcnt(0)
  v_smfmac_f32_16x16x64_bf16 v[20:23], v[8:11], v[176:183], v74
  v_smfmac_f32_16x16x64_bf16 v[24:27], v[8:11], v[184:191], v74
  v_smfmac_f32_16x16x64_bf16 v[28:31], v[8:11], a[16:23], v74
  v_smfmac_f32_16x16x64_bf16 v[32:35], v[8:11], a[24:31], v74
  ds_read_b128 v[0:3], v76 offset:12800
  s_waitcnt lgkmcnt(0)
  v_smfmac_f32_16x16x64_bf16 v[20:23], v[0:3], v[192:199], v74
  v_smfmac_f32_16x16x64_bf16 v[24:27], v[0:3], v[200:207], v74
  ds_read_b128 v[60:63], v75 offset:12288
  ds_read_b128 v[64:67], v75 offset:13312
  s_waitcnt lgkmcnt(0)
  v_smfmac_f32_16x16x64_bf16 v[28:31], v[0:3], v[60:67], v74
  ds_read_b128 v[60:63], v75 offset:14336
  ds_read_b128 v[64:67], v75 offset:15360
  s_waitcnt lgkmcnt(0)
  v_smfmac_f32_16x16x64_bf16 v[32:35], v[0:3], v[60:67], v74
  v_add_f32 v20, v20, v22
  v_add_f32 v21, v21, v23
  v_add_f32 v24, v24, v26
  v_cvt_pk_bf16_f32 v22, v20, v24
  ds_write_b32 v79, v22 offset:0
  v_add_f32 v25, v25, v27
  v_cvt_pk_bf16_f32 v23, v21, v25
  ds_write_b32 v79, v23 offset:576
  v_add_f32 v28, v28, v30
  v_add_f32 v29, v29, v31
  s_waitcnt lgkmcnt(0)
  s_nop 1
  s_branch Cs3_recok
Cs3_mx:
  s_waitcnt lgkmcnt(0)
  s_barrier
  buffer_load_dwordx4 v[0:3], v76, s[8:11], s58 offen offset:0 sc1
  ds_read_b128 v[20:23], v77 offset:0
  ds_read_b128 v[28:31], v77 offset:256
  buffer_load_dwordx4 v[4:7], v76, s[8:11], s58 offen offset:1024 sc1
  ds_read_b128 v[24:27], v77 offset:128
  ds_read_b128 v[32:35], v77 offset:384
  s_waitcnt vmcnt(1) lgkmcnt(3)
  v_mfma_f32_16x16x32_bf16 v[8:11], v[0:3], v[20:23], 0
  s_waitcnt vmcnt(0) lgkmcnt(1)
  v_mfma_f32_16x16x32_bf16 v[8:11], v[4:7], v[24:27], v[8:11]
  v_mfma_f32_16x16x32_bf16 v[12:15], v[28:31], v[20:23], 0
  s_waitcnt lgkmcnt(0)
  v_mfma_f32_16x16x32_bf16 v[12:15], v[32:35], v[24:27], v[12:15]
  v_add_f32_dpp v8, v10, v8 quad_perm:[2,3,0,1] row_mask:0xf bank_mask:0xf
  v_add_f32_dpp v9, v11, v9 quad_perm:[2,3,0,1] row_mask:0xf bank_mask:0xf
  s_nop 0
  v_mov_b32_dpp v8, v8 quad_perm:[0,1,0,1] row_mask:0xf bank_mask:0xf
  v_mov_b32_dpp v9, v9 quad_perm:[0,1,0,1] row_mask:0xf bank_mask:0xf
  s_nop 1
  v_add_f32_dpp v12, v14, v12 quad_perm:[2,3,0,1] row_mask:0xf bank_mask:0xf
  v_add_f32_dpp v13, v15, v13 quad_perm:[2,3,0,1] row_mask:0xf bank_mask:0xf
  s_nop 0
  v_mov_b32_dpp v12, v12 quad_perm:[0,1,0,1] row_mask:0xf bank_mask:0xf
  v_mov_b32_dpp v13, v13 quad_perm:[0,1,0,1] row_mask:0xf bank_mask:0xf
  v_mul_f32 v12, s69, v12
  ds_write_b32 v78, v8 offset:8716
  v_mul_f32 v13, s69, v13
  ds_write_b32 v78, v9 offset:8780
  s_waitcnt lgkmcnt(0)
  s_barrier
  ds_read_b128 v[36:39], v78 offset:8704
  ds_read_b128 v[40:43], v78 offset:8768
  s_waitcnt lgkmcnt(0)
  s_barrier
  v_max_f32 v16, v36, v37
  v_max3_f32 v16, v16, v38, v39
  v_max3_f32 v16, v16, v40, v41
  v_max3_f32 v16, v16, v42, v43
  v_max3_f32 v16, v16, v12, v13
  v_mov_b32 v17, v16
  s_nop 1
  v_permlane16_swap_b32 v16, v17
  v_max_f32 v16, v16, v17
  v_mov_b32 v17, v16
  s_nop 1
  v_permlane32_swap_b32 v16, v17
  v_max_f32 v16, v16, v17
  v_sub_f32 v36, v36, v16
  v_sub_f32 v37, v37, v16
  v_sub_f32 v38, v38, v16
  v_sub_f32 v39, v39, v16
  v_sub_f32 v40, v40, v16
  v_sub_f32 v41, v41, v16
  v_sub_f32 v42, v42, v16
  v_sub_f32 v43, v43, v16
  v_sub_f32 v12, v12, v16
  v_sub_f32 v13, v13, v16
  v_exp_f32 v36, v36
  v_exp_f32 v37, v37
  v_exp_f32 v38, v38
  v_exp_f32 v39, v39
  v_exp_f32 v40, v40
  v_exp_f32 v41, v41
  v_exp_f32 v42, v42
  v_exp_f32 v43, v43
  v_exp_f32 v12, v12
  v_exp_f32 v13, v13
  v_cvt_pk_bf16_f32 v32, v36, v40
  v_cvt_pk_bf16_f32 v33, v37, v41
  v_cvt_pk_bf16_f32 v34, v38, v42
  v_cvt_pk_bf16_f32 v35, v39, v43
  v_cvt_pk_bf16_f32 v28, v12, v13
  v_cvt_pk_bf16_f32 v31, v12, v13
  v_mov_b32 v29, 0
  v_mov_b32 v30, 0
  v_mov_b32 v68, 0x3f803f80
  v_mov_b32 v69, 0x3f803f80
  v_mov_b32 v70, 0x3f803f80
  v_mov_b32 v71, 0x3f803f80
  s_nop 1
  v_mfma_f32_16x16x32_bf16 v[8:11], v[32:35], v[68:71], 0
  v_mfma_f32_16x16x32_bf16 v[0:3], v[32:35], v[52:55], 0
  v_mfma_f32_16x16x32_bf16 v[4:7], v[32:35], v[56:59], 0
  v_mfma_f32_16x16x16_bf16 v[8:11], v[28:29], v[68:69], v[8:11]
  v_mfma_f32_16x16x16_bf16 v[0:3], v[28:29], v[72:73], v[0:3]
  v_mfma_f32_16x16x16_bf16 v[4:7], v[30:31], v[72:73], v[4:7]
  ds_read_b128 v[68:71], v76 offset:13824
  v_rcp_f32 v10, v8
  v_rcp_f32 v11, v9
  v_mul_f32 v0, v10, v0
  v_mul_f32 v1, v11, v1
  s_nop 0
  v_mul_f32 v4, v10, v4
  v_mul_f32 v5, v11, v5
  v_cvt_pk_bf16_f32 v2, v0, v4
  ds_write_b32 v79, v2 offset:8704
  v_cvt_pk_bf16_f32 v3, v1, v5
  ds_write_b32 v79, v3 offset:9280
  v_mov_b64 v[16:17], 0
  v_mov_b64 v[18:19], 0
  v_mov_b64 v[20:21], 0
  v_mov_b64 v[22:23], 0
  s_branch Cs3_mxok
Cs3_kv:
  s_lshl_b32 s56, s53, 2
  s_add_u32 s56, s56, 128
  s_load_dword s57, s[12:13], s56 glc
  s_branch Cs3_kvb
Cs3_kv2:
  s_waitcnt lgkmcnt(0)
  s_cmp_ge_u32 s57, 0x700
  s_cbranch_scc1 Cs3_top
  s_load_dword s57, s[12:13], s56 glc
  s_add_u32 s67, s67, 1
  s_cmp_lt_u32 s67, 131072
  s_cbranch_scc1 Cs3_kv2
  s_branch Cs3_top
Cs3_h1r:
  s_mov_b64 exec, vcc
  buffer_load_dwordx4 v[52:55], v76, s[8:11], s60 offen offset:0 sc1
  buffer_load_dwordx4 v[56:59], v76, s[8:11], s60 offen offset:1024 sc1
  s_mov_b64 exec, -1
  s_add_u32 s67, s67, 1
  s_waitcnt vmcnt(3)
  v_mfma_f32_16x16x32_bf16 v[4:7], v[0:3], v[36:39], 0
  v_bitop3_b32 v72, v36, v38, s72 bitop3:0x7e
  s_waitcnt vmcnt(2)
  v_mfma_f32_16x16x32_bf16 v[4:7], v[0:3], v[40:43], v[4:7]
  v_bitop3_b32 v73, v40, v42, s72 bitop3:0x7e
  v_bitop3_b32 v72, v72, v73, 1 bitop3:0xa8
  v_cmp_ne_u32 vcc, 0, v72
  s_cbranch_vccz Cs3_h1p
  s_mov_b64 exec, vcc
  buffer_load_dwordx4 v[36:39], v76, s[8:11], s60 offen offset:0 sc1
  buffer_load_dwordx4 v[40:43], v76, s[8:11], s60 offen offset:1024 sc1
  s_mov_b64 exec, -1
  s_add_u32 s67, s67, 1
  s_waitcnt vmcnt(3)
  v_mfma_f32_16x16x32_bf16 v[4:7], v[0:3], v[52:55], 0
  v_bitop3_b32 v72, v52, v54, s72 bitop3:0x7e
  s_waitcnt vmcnt(2)
  v_mfma_f32_16x16x32_bf16 v[4:7], v[0:3], v[56:59], v[4:7]
  v_bitop3_b32 v73, v56, v58, s72 bitop3:0x7e
  v_bitop3_b32 v72, v72, v73, 1 bitop3:0xa8
  v_cmp_ne_u32 vcc, 0, v72
  s_cbranch_vccz Cs3_h1p
  s_cmp_lt_u32 s67, 131072
  s_cbranch_scc1 Cs3_h1r
  s_branch Cs3_h1p
Cs3_last:
  s_nop 7
  s_waitcnt vmcnt(0) lgkmcnt(0)
  ds_read_b64 v[16:17], v77 offset:392
  v_mov_b64 v[18:19], v[72:73]
  s_add_u32 s68, s68, 655360
  s_waitcnt lgkmcnt(0)
  buffer_store_dwordx4 v[16:19], v76, s[8:11], s68 offen sc1
  s_waitcnt vmcnt(0)
  s_barrier
  s_branch L_cexit
L_conf:
  s_waitcnt vmcnt(0) lgkmcnt(0)
  s_barrier
  s_cmp_eq_u32 s52, 0
  s_cbranch_scc0 L_cf2
  s_mov_b64 exec, 1
  s_lshl_b32 s57, s2, 2
  v_mov_b32 v1, 0
L_cf0:
  s_cmp_eq_u32 s54, -1
  s_cbranch_scc1 L_cf1
  s_mov_b32 s55, s54
  s_lshr_b64 s[54:55], s[54:55], s0
  s_ff0_i32_b32 s56, s54
  s_add_u32 s0, s0, s56
  s_and_b32 s0, s0, 31
  s_lshl_b32 s56, 1, s0
  v_mov_b32 v35, s56
  buffer_atomic_or v35, v1, s[12:15], s57 offen sc0
  s_waitcnt vmcnt(0)
  v_readfirstlane_b32 s54, v35
  s_nop 0
  s_bitcmp1_b32 s54, s0
  s_cbranch_scc1 L_cf0
  v_mov_b32 v35, s0
  s_branch L_cf3
L_cf1:
  v_mov_b32 v35, 1
  buffer_atomic_add v35, v1, s[12:15], 0 offen offset:40 sc0
  s_waitcnt vmcnt(0)
  v_add_u32 v35, 32, v35
L_cf3:
  ds_write_b32 v33, v35
  s_mov_b64 exec, -1
  s_waitcnt lgkmcnt(0)
L_cf2:
  s_barrier
  ds_read_b32 v32, v33
  s_waitcnt lgkmcnt(0)
  v_readfirstlane_b32 s0, v32
  s_mov_b32 s1, 1
  s_cmp_lt_u32 s0, 32
  s_cbranch_scc1 L_role
  s_sub_u32 s53, s0, 32
  s_mov_b32 s57, 0
L_sur:
  s_load_dwordx16 s[60:75], s[12:13], 0 glc
  s_add_u32 s57, s57, 1
  s_waitcnt lgkmcnt(0)
  s_mov_b32 s55, s70
  s_bcnt1_i32_b32 s56, s60
  s_add_u32 s55, s55, s56
  s_bcnt1_i32_b32 s56, s61
  s_add_u32 s55, s55, s56
  s_bcnt1_i32_b32 s56, s62
  s_add_u32 s55, s55, s56
  s_bcnt1_i32_b32 s56, s63
  s_add_u32 s55, s55, s56
  s_bcnt1_i32_b32 s56, s64
  s_add_u32 s55, s55, s56
  s_bcnt1_i32_b32 s56, s65
  s_add_u32 s55, s55, s56
  s_bcnt1_i32_b32 s56, s66
  s_add_u32 s55, s55, s56
  s_bcnt1_i32_b32 s56, s67
  s_add_u32 s55, s55, s56
  s_cmp_ge_u32 s57, 131072
  s_cbranch_scc1 L_end
  s_cmp_lt_u32 s55, 256
  s_cbranch_scc1 L_sur
  s_mov_b32 s2, 0
  s_mov_b32 s54, s60
  s_bcnt0_i32_b32 s56, s54
  s_cmp_lt_u32 s53, s56
  s_cbranch_scc1 L_sur2
  s_sub_u32 s53, s53, s56
  s_mov_b32 s2, 1
  s_mov_b32 s54, s61
  s_bcnt0_i32_b32 s56, s54
  s_cmp_lt_u32 s53, s56
  s_cbranch_scc1 L_sur2
  s_sub_u32 s53, s53, s56
  s_mov_b32 s2, 2
  s_mov_b32 s54, s62
  s_bcnt0_i32_b32 s56, s54
  s_cmp_lt_u32 s53, s56
  s_cbranch_scc1 L_sur2
  s_sub_u32 s53, s53, s56
  s_mov_b32 s2, 3
  s_mov_b32 s54, s63
  s_bcnt0_i32_b32 s56, s54
  s_cmp_lt_u32 s53, s56
  s_cbranch_scc1 L_sur2
  s_sub_u32 s53, s53, s56
  s_mov_b32 s2, 4
  s_mov_b32 s54, s64
  s_bcnt0_i32_b32 s56, s54
  s_cmp_lt_u32 s53, s56
  s_cbranch_scc1 L_sur2
  s_sub_u32 s53, s53, s56
  s_mov_b32 s2, 5
  s_mov_b32 s54, s65
  s_bcnt0_i32_b32 s56, s54
  s_cmp_lt_u32 s53, s56
  s_cbranch_scc1 L_sur2
  s_sub_u32 s53, s53, s56
  s_mov_b32 s2, 6
  s_mov_b32 s54, s66
  s_bcnt0_i32_b32 s56, s54
  s_cmp_lt_u32 s53, s56
  s_cbranch_scc1 L_sur2
  s_sub_u32 s53, s53, s56
  s_mov_b32 s2, 7
  s_mov_b32 s54, s67
  s_bcnt0_i32_b32 s56, s54
  s_cmp_lt_u32 s53, s56
  s_cbranch_scc1 L_sur2
  s_sub_u32 s53, s53, s56
  s_branch L_end
L_sur2:
  s_ff0_i32_b32 s0, s54
  s_bitset1_b32 s54, s0
  s_sub_u32 s53, s53, 1
  s_cbranch_scc0 L_sur2
  s_branch L_role
L_worker:
  s_sub_u32 s54, s2, 1
  s_lshl_b32 s54, s54, 5
  s_add_u32 s53, s53, s54
  v_and_b32 v200, 63, v0
  v_lshlrev_b32 v201, 4, v200
  v_lshrrev_b32 v211, 3, v200
  s_lshl_b32 s54, s52, 3
  v_add_u32 v211, s54, v211
  v_bfe_u32 v212, v211, 1, 3
  v_and_b32 v213, 7, v200
  v_xor_b32 v212, v212, v213
  v_mul_u32_u24 v211, 1152, v211
  v_lshl_add_u32 v202, v212, 4, v211
  s_mul_i32 s67, s52, 9216
  v_and_b32 v211, 31, v200
  v_lshrrev_b32 v212, 3, v211
  v_mul_u32_u24 v212, 9216, v212
  v_and_b32 v213, 7, v211
  v_lshl_add_u32 v212, v213, 7, v212
  v_bfe_u32 v213, v211, 1, 3
  v_lshrrev_b32 v214, 5, v200
  v_xor_b32 v213, v213, v214
  v_lshl_add_u32 v203, v213, 4, v212
  v_xor_b32 v204, 32, v203
  v_xor_b32 v205, 64, v203
  v_xor_b32 v206, 0x60, v203
  v_bfe_u32 v211, v200, 2, 2
  v_lshl_add_u32 v212, v214, 3, v211
  v_lshlrev_b32 v212, 8, v212
  v_xor_b32 v211, s52, v211
  v_lshl_add_u32 v212, v211, 6, v212
  v_bfe_u32 v213, v200, 4, 1
  v_and_b32 v211, 3, v200
  v_lshl_add_u32 v210, v213, 5, v212
  v_lshl_add_u32 v210, v211, 3, v210
  v_lshl_add_u32 v209, v213, 4, v212
  v_and_b32 v213, 1, v211
  v_lshl_add_u32 v209, v213, 3, v209
  v_lshrrev_b32 v213, 1, v211
  v_lshl_add_u32 v209, v213, 5, v209
  s_mov_b32 s65, 0
  s_mul_i32 s58, s53, 9363
  s_lshr_b32 s58, s58, 16
  s_mul_i32 s54, s58, 7
  s_sub_u32 s59, s53, s54
  s_mul_i32 s60, s59, 36864
  s_add_u32 m0, s67, 0
  s_nop 0
  buffer_load_dwordx4 v202, s[4:7], s60 offen offset:0 lds
  s_add_u32 m0, s67, 896
  s_nop 0
  buffer_load_dwordx4 v202, s[4:7], s60 offen offset:128 lds
  s_add_u32 m0, s67, 1792
  s_nop 0
  buffer_load_dwordx4 v202, s[4:7], s60 offen offset:256 lds
  s_add_u32 m0, s67, 2688
  s_nop 0
  buffer_load_dwordx4 v202, s[4:7], s60 offen offset:384 lds
  s_add_u32 m0, s67, 3584
  s_nop 0
  buffer_load_dwordx4 v202, s[4:7], s60 offen offset:512 lds
  s_add_u32 m0, s67, 4480
  s_nop 0
  buffer_load_dwordx4 v202, s[4:7], s60 offen offset:640 lds
  s_add_u32 m0, s67, 5376
  s_nop 0
  buffer_load_dwordx4 v202, s[4:7], s60 offen offset:768 lds
  s_add_u32 m0, s67, 6272
  s_nop 0
  buffer_load_dwordx4 v202, s[4:7], s60 offen offset:896 lds
  s_add_u32 m0, s67, 7168
  s_nop 0
  buffer_load_dwordx4 v202, s[4:7], s60 offen offset:1024 lds
  v_lshrrev_b32 v211, 4, v200
  v_lshlrev_b32 v212, 2, v211
  v_and_b32 v213, 15, v200
  v_xor_b32 v212, v212, v213
  v_lshlrev_b32 v212, 4, v212
  v_lshl_add_u32 v207, v211, 13, v212
  s_lshl_b32 s62, s58, 8
  s_lshl_b32 s54, s52, 15
  s_add_u32 s62, s62, s54
  s_lshl_b32 s61, s52, 10
  s_add_u32 s61, s61, 36864
  s_add_u32 m0, s61, 0
  s_add_u32 s54, s62, 0
  buffer_load_dwordx4 v207, s[20:23], s54 offen lds
  s_add_u32 m0, s61, 4096
  s_add_u32 s54, s62, 131072
  buffer_load_dwordx4 v207, s[20:23], s54 offen lds
  s_add_u32 m0, s61, 8192
  s_add_u32 s54, s62, 262144
  buffer_load_dwordx4 v207, s[20:23], s54 offen lds
  s_add_u32 m0, s61, 12288
  s_add_u32 s54, s62, 393216
  buffer_load_dwordx4 v207, s[20:23], s54 offen lds
  s_add_u32 m0, s61, 16384
  s_add_u32 s54, s62, 0
  buffer_load_dwordx4 v207, s[24:27], s54 offen lds
  s_add_u32 m0, s61, 20480
  s_add_u32 s54, s62, 131072
  buffer_load_dwordx4 v207, s[24:27], s54 offen lds
  s_add_u32 m0, s61, 24576
  s_add_u32 s54, s62, 262144
  buffer_load_dwordx4 v207, s[24:27], s54 offen lds
  s_add_u32 m0, s61, 28672
  s_add_u32 s54, s62, 393216
  buffer_load_dwordx4 v207, s[24:27], s54 offen lds
  s_add_u32 m0, s61, 32768
  s_add_u32 s54, s62, 524288
  buffer_load_dwordx4 v207, s[20:23], s54 offen lds
  s_add_u32 m0, s61, 36864
  s_add_u32 s54, s62, 655360
  buffer_load_dwordx4 v207, s[20:23], s54 offen lds
  s_add_u32 m0, s61, 40960
  s_add_u32 s54, s62, 786432
  buffer_load_dwordx4 v207, s[20:23], s54 offen lds
  s_add_u32 m0, s61, 45056
  s_add_u32 s54, s62, 917504
  buffer_load_dwordx4 v207, s[20:23], s54 offen lds
  s_add_u32 m0, s61, 49152
  s_add_u32 s54, s62, 524288
  buffer_load_dwordx4 v207, s[24:27], s54 offen lds
  s_add_u32 m0, s61, 53248
  s_add_u32 s54, s62, 655360
  buffer_load_dwordx4 v207, s[24:27], s54 offen lds
  s_add_u32 m0, s61, 57344
  s_add_u32 s54, s62, 786432
  buffer_load_dwordx4 v207, s[24:27], s54 offen lds
  s_add_u32 m0, s61, 61440
  s_add_u32 s54, s62, 917504
  buffer_load_dwordx4 v207, s[24:27], s54 offen lds
  s_add_u32 m0, s61, 65536
  s_add_u32 s54, s62, 1048576
  buffer_load_dwordx4 v207, s[20:23], s54 offen lds
  s_add_u32 m0, s61, 69632
  s_add_u32 s54, s62, 1179648
  buffer_load_dwordx4 v207, s[20:23], s54 offen lds
  s_add_u32 m0, s61, 73728
  s_add_u32 s54, s62, 1310720
  buffer_load_dwordx4 v207, s[20:23], s54 offen lds
  s_add_u32 m0, s61, 77824
  s_add_u32 s54, s62, 1441792
  buffer_load_dwordx4 v207, s[20:23], s54 offen lds
  s_add_u32 m0, s61, 81920
  s_add_u32 s54, s62, 1048576
  buffer_load_dwordx4 v207, s[24:27], s54 offen lds
  s_add_u32 m0, s61, 86016
  s_add_u32 s54, s62, 1179648
  buffer_load_dwordx4 v207, s[24:27], s54 offen lds
  s_add_u32 m0, s61, 90112
  s_add_u32 s54, s62, 1310720
  buffer_load_dwordx4 v207, s[24:27], s54 offen lds
  s_add_u32 m0, s61, 94208
  s_add_u32 s54, s62, 1441792
  buffer_load_dwordx4 v207, s[24:27], s54 offen lds
  v_bfe_u32 v211, v200, 3, 2
  v_lshlrev_b32 v216, 11, v211
  v_bfe_u32 v211, v200, 1, 2
  v_lshl_add_u32 v216, v211, 6, v216
  v_lshrrev_b32 v212, 5, v200
  v_lshl_add_u32 v216, v212, 5, v216
  v_and_b32 v211, 1, v200
  v_lshl_add_u32 v216, v211, 4, v216
  v_bfe_u32 v211, v200, 4, 1
  v_lshlrev_b32 v217, 10, v211
  v_lshl_add_u32 v217, v212, 9, v217
  v_and_b32 v211, 15, v200
  v_lshl_add_u32 v217, v211, 4, v217
  s_lshl_b32 s54, s52, 11
  s_add_u32 s54, s54, 8192
  v_add_u32 v217, s54, v217
  s_cmp_eq_u32 s1, 1
  s_cbranch_scc1 W_ver_ok
  v_mov_b32 v33, 163832
  s_cmp_eq_u32 s52, 0
  s_cbranch_scc0 W_ver_b
  s_waitcnt vmcnt(33)
  s_mov_b64 exec, 1
  ds_write_b32 v33, v35
  s_mov_b64 exec, -1
  s_waitcnt lgkmcnt(0)
W_ver_b:
  s_barrier
  ds_read_b32 v32, v33
  s_waitcnt lgkmcnt(0)
  v_readfirstlane_b32 s54, v32
  s_nop 0
  s_bitcmp1_b32 s54, s0
  s_cbranch_scc1 L_conf
W_ver_ok:
  s_waitcnt vmcnt(20) lgkmcnt(0)
  s_barrier
  s_add_u32 m0, s61, 98304
  s_add_u32 s54, s62, 1572864
  buffer_load_dwordx4 v207, s[20:23], s54 offen lds
  s_add_u32 m0, s61, 102400
  s_add_u32 s54, s62, 1703936
  buffer_load_dwordx4 v207, s[20:23], s54 offen lds
  s_add_u32 m0, s61, 106496
  s_add_u32 s54, s62, 1835008
  buffer_load_dwordx4 v207, s[20:23], s54 offen lds
  s_add_u32 m0, s61, 110592
  s_add_u32 s54, s62, 1966080
  buffer_load_dwordx4 v207, s[20:23], s54 offen lds
  v_add_u32 v215, 36864, v209
  ds_read_b64_tr_b16 a[0:1], v215 offset:0
  ds_read_b64_tr_b16 a[2:3], v215 offset:1024
  ds_read_b64_tr_b16 a[4:5], v215 offset:4096
  ds_read_b64_tr_b16 a[6:7], v215 offset:5120
  ds_read_b64_tr_b16 a[8:9], v215 offset:8192
  ds_read_b64_tr_b16 a[10:11], v215 offset:9216
  ds_read_b64_tr_b16 a[12:13], v215 offset:12288
  ds_read_b64_tr_b16 a[14:15], v215 offset:13312
  s_waitcnt vmcnt(20) lgkmcnt(0)
  s_barrier
  s_add_u32 m0, s61, 0
  s_add_u32 s54, s62, 1572864
  buffer_load_dwordx4 v207, s[24:27], s54 offen lds
  s_add_u32 m0, s61, 4096
  s_add_u32 s54, s62, 1703936
  buffer_load_dwordx4 v207, s[24:27], s54 offen lds
  s_add_u32 m0, s61, 8192
  s_add_u32 s54, s62, 1835008
  buffer_load_dwordx4 v207, s[24:27], s54 offen lds
  s_add_u32 m0, s61, 12288
  s_add_u32 s54, s62, 1966080
  buffer_load_dwordx4 v207, s[24:27], s54 offen lds
  v_add_u32 v215, 53248, v210
  ds_read_b64_tr_b16 a[144:145], v215 offset:0
  ds_read_b64_tr_b16 a[146:147], v215 offset:1024
  ds_read_b64_tr_b16 a[148:149], v215 offset:4096
  ds_read_b64_tr_b16 a[150:151], v215 offset:5120
  ds_read_b64_tr_b16 a[152:153], v215 offset:8192
  ds_read_b64_tr_b16 a[154:155], v215 offset:9216
  ds_read_b64_tr_b16 a[156:157], v215 offset:12288
  ds_read_b64_tr_b16 a[158:159], v215 offset:13312
  s_waitcnt vmcnt(20) lgkmcnt(0)
  s_barrier
  s_add_u32 m0, s61, 16384
  s_add_u32 s54, s62, 2097152
  buffer_load_dwordx4 v207, s[20:23], s54 offen lds
  s_add_u32 m0, s61, 20480
  s_add_u32 s54, s62, 2228224
  buffer_load_dwordx4 v207, s[20:23], s54 offen lds
  s_add_u32 m0, s61, 24576
  s_add_u32 s54, s62, 2359296
  buffer_load_dwordx4 v207, s[20:23], s54 offen lds
  s_add_u32 m0, s61, 28672
  s_add_u32 s54, s62, 2490368
  buffer_load_dwordx4 v207, s[20:23], s54 offen lds
  v_add_u32 v215, 69632, v209
  ds_read_b64_tr_b16 a[16:17], v215 offset:0
  ds_read_b64_tr_b16 a[18:19], v215 offset:1024
  ds_read_b64_tr_b16 a[20:21], v215 offset:4096
  ds_read_b64_tr_b16 a[22:23], v215 offset:5120
  ds_read_b64_tr_b16 a[24:25], v215 offset:8192
  ds_read_b64_tr_b16 a[26:27], v215 offset:9216
  ds_read_b64_tr_b16 a[28:29], v215 offset:12288
  ds_read_b64_tr_b16 a[30:31], v215 offset:13312
  s_waitcnt vmcnt(20) lgkmcnt(0)
  s_barrier
  s_add_u32 m0, s61, 32768
  s_add_u32 s54, s62, 2097152
  buffer_load_dwordx4 v207, s[24:27], s54 offen lds
  s_add_u32 m0, s61, 36864
  s_add_u32 s54, s62, 2228224
  buffer_load_dwordx4 v207, s[24:27], s54 offen lds
  s_add_u32 m0, s61, 40960
  s_add_u32 s54, s62, 2359296
  buffer_load_dwordx4 v207, s[24:27], s54 offen lds
  s_add_u32 m0, s61, 45056
  s_add_u32 s54, s62, 2490368
  buffer_load_dwordx4 v207, s[24:27], s54 offen lds
  v_add_u32 v215, 86016, v210
  ds_read_b64_tr_b16 a[160:161], v215 offset:0
  ds_read_b64_tr_b16 a[162:163], v215 offset:1024
  ds_read_b64_tr_b16 a[164:165], v215 offset:4096
  ds_read_b64_tr_b16 a[166:167], v215 offset:5120
  ds_read_b64_tr_b16 a[168:169], v215 offset:8192
  ds_read_b64_tr_b16 a[170:171], v215 offset:9216
  ds_read_b64_tr_b16 a[172:173], v215 offset:12288
  ds_read_b64_tr_b16 a[174:175], v215 offset:13312
  s_waitcnt vmcnt(20) lgkmcnt(0)
  s_barrier
  s_add_u32 m0, s61, 49152
  s_add_u32 s54, s62, 2621440
  buffer_load_dwordx4 v207, s[20:23], s54 offen lds
  s_add_u32 m0, s61, 53248
  s_add_u32 s54, s62, 2752512
  buffer_load_dwordx4 v207, s[20:23], s54 offen lds
  s_add_u32 m0, s61, 57344
  s_add_u32 s54, s62, 2883584
  buffer_load_dwordx4 v207, s[20:23], s54 offen lds
  s_add_u32 m0, s61, 61440
  s_add_u32 s54, s62, 3014656
  buffer_load_dwordx4 v207, s[20:23], s54 offen lds
  v_add_u32 v215, 102400, v209
  ds_read_b64_tr_b16 a[32:33], v215 offset:0
  ds_read_b64_tr_b16 a[34:35], v215 offset:1024
  ds_read_b64_tr_b16 a[36:37], v215 offset:4096
  ds_read_b64_tr_b16 a[38:39], v215 offset:5120
  ds_read_b64_tr_b16 a[40:41], v215 offset:8192
  ds_read_b64_tr_b16 a[42:43], v215 offset:9216
  ds_read_b64_tr_b16 a[44:45], v215 offset:12288
  ds_read_b64_tr_b16 a[46:47], v215 offset:13312
  s_waitcnt vmcnt(20) lgkmcnt(0)
  s_barrier
  s_add_u32 m0, s61, 65536
  s_add_u32 s54, s62, 2621440
  buffer_load_dwordx4 v207, s[24:27], s54 offen lds
  s_add_u32 m0, s61, 69632
  s_add_u32 s54, s62, 2752512
  buffer_load_dwordx4 v207, s[24:27], s54 offen lds
  s_add_u32 m0, s61, 73728
  s_add_u32 s54, s62, 2883584
  buffer_load_dwordx4 v207, s[24:27], s54 offen lds
  s_add_u32 m0, s61, 77824
  s_add_u32 s54, s62, 3014656
  buffer_load_dwordx4 v207, s[24:27], s54 offen lds
  v_add_u32 v215, 118784, v210
  ds_read_b64_tr_b16 a[176:177], v215 offset:0
  ds_read_b64_tr_b16 a[178:179], v215 offset:1024
  ds_read_b64_tr_b16 a[180:181], v215 offset:4096
  ds_read_b64_tr_b16 a[182:183], v215 offset:5120
  ds_read_b64_tr_b16 a[184:185], v215 offset:8192
  ds_read_b64_tr_b16 a[186:187], v215 offset:9216
  ds_read_b64_tr_b16 a[188:189], v215 offset:12288
  ds_read_b64_tr_b16 a[190:191], v215 offset:13312
  s_waitcnt vmcnt(20) lgkmcnt(0)
  s_barrier
  s_add_u32 m0, s61, 81920
  s_add_u32 s54, s62, 3145728
  buffer_load_dwordx4 v207, s[20:23], s54 offen lds
  s_add_u32 m0, s61, 86016
  s_add_u32 s54, s62, 3276800
  buffer_load_dwordx4 v207, s[20:23], s54 offen lds
  s_add_u32 m0, s61, 90112
  s_add_u32 s54, s62, 3407872
  buffer_load_dwordx4 v207, s[20:23], s54 offen lds
  s_add_u32 m0, s61, 94208
  s_add_u32 s54, s62, 3538944
  buffer_load_dwordx4 v207, s[20:23], s54 offen lds
  v_add_u32 v215, 135168, v209
  ds_read_b64_tr_b16 a[48:49], v215 offset:0
  ds_read_b64_tr_b16 a[50:51], v215 offset:1024
  ds_read_b64_tr_b16 a[52:53], v215 offset:4096
  ds_read_b64_tr_b16 a[54:55], v215 offset:5120
  ds_read_b64_tr_b16 a[56:57], v215 offset:8192
  ds_read_b64_tr_b16 a[58:59], v215 offset:9216
  ds_read_b64_tr_b16 a[60:61], v215 offset:12288
  ds_read_b64_tr_b16 a[62:63], v215 offset:13312
  s_waitcnt vmcnt(20) lgkmcnt(0)
  s_barrier
  s_add_u32 m0, s61, 98304
  s_add_u32 s54, s62, 3145728
  buffer_load_dwordx4 v207, s[24:27], s54 offen lds
  s_add_u32 m0, s61, 102400
  s_add_u32 s54, s62, 3276800
  buffer_load_dwordx4 v207, s[24:27], s54 offen lds
  s_add_u32 m0, s61, 106496
  s_add_u32 s54, s62, 3407872
  buffer_load_dwordx4 v207, s[24:27], s54 offen lds
  s_add_u32 m0, s61, 110592
  s_add_u32 s54, s62, 3538944
  buffer_load_dwordx4 v207, s[24:27], s54 offen lds
  v_add_u32 v215, 36864, v210
  ds_read_b64_tr_b16 a[192:193], v215 offset:0
  ds_read_b64_tr_b16 a[194:195], v215 offset:1024
  ds_read_b64_tr_b16 a[196:197], v215 offset:4096
  ds_read_b64_tr_b16 a[198:199], v215 offset:5120
  ds_read_b64_tr_b16 a[200:201], v215 offset:8192
  ds_read_b64_tr_b16 a[202:203], v215 offset:9216
  ds_read_b64_tr_b16 a[204:205], v215 offset:12288
  ds_read_b64_tr_b16 a[206:207], v215 offset:13312
  s_waitcnt vmcnt(20) lgkmcnt(0)
  s_barrier
  s_add_u32 m0, s61, 0
  s_add_u32 s54, s62, 3670016
  buffer_load_dwordx4 v207, s[20:23], s54 offen lds
  s_add_u32 m0, s61, 4096
  s_add_u32 s54, s62, 3801088
  buffer_load_dwordx4 v207, s[20:23], s54 offen lds
  s_add_u32 m0, s61, 8192
  s_add_u32 s54, s62, 3932160
  buffer_load_dwordx4 v207, s[20:23], s54 offen lds
  s_add_u32 m0, s61, 12288
  s_add_u32 s54, s62, 4063232
  buffer_load_dwordx4 v207, s[20:23], s54 offen lds
  v_add_u32 v215, 53248, v209
  ds_read_b64_tr_b16 a[64:65], v215 offset:0
  ds_read_b64_tr_b16 a[66:67], v215 offset:1024
  ds_read_b64_tr_b16 a[68:69], v215 offset:4096
  ds_read_b64_tr_b16 a[70:71], v215 offset:5120
  ds_read_b64_tr_b16 a[72:73], v215 offset:8192
  ds_read_b64_tr_b16 a[74:75], v215 offset:9216
  ds_read_b64_tr_b16 a[76:77], v215 offset:12288
  ds_read_b64_tr_b16 a[78:79], v215 offset:13312
  s_waitcnt vmcnt(20) lgkmcnt(0)
  s_barrier
  s_add_u32 m0, s61, 16384
  s_add_u32 s54, s62, 3670016
  buffer_load_dwordx4 v207, s[24:27], s54 offen lds
  s_add_u32 m0, s61, 20480
  s_add_u32 s54, s62, 3801088
  buffer_load_dwordx4 v207, s[24:27], s54 offen lds
  s_add_u32 m0, s61, 24576
  s_add_u32 s54, s62, 3932160
  buffer_load_dwordx4 v207, s[24:27], s54 offen lds
  s_add_u32 m0, s61, 28672
  s_add_u32 s54, s62, 4063232
  buffer_load_dwordx4 v207, s[24:27], s54 offen lds
  v_add_u32 v215, 69632, v210
  ds_read_b64_tr_b16 a[208:209], v215 offset:0
  ds_read_b64_tr_b16 a[210:211], v215 offset:1024
  ds_read_b64_tr_b16 a[212:213], v215 offset:4096
  ds_read_b64_tr_b16 a[214:215], v215 offset:5120
  ds_read_b64_tr_b16 a[216:217], v215 offset:8192
  ds_read_b64_tr_b16 a[218:219], v215 offset:9216
  ds_read_b64_tr_b16 a[220:221], v215 offset:12288
  ds_read_b64_tr_b16 a[222:223], v215 offset:13312
  s_waitcnt vmcnt(20) lgkmcnt(0)
  s_barrier
  s_add_u32 m0, s61, 32768
  s_add_u32 s54, s62, 4194304
  buffer_load_dwordx4 v207, s[20:23], s54 offen lds
  s_add_u32 m0, s61, 36864
  s_add_u32 s54, s62, 4325376
  buffer_load_dwordx4 v207, s[20:23], s54 offen lds
  s_add_u32 m0, s61, 40960
  s_add_u32 s54, s62, 4456448
  buffer_load_dwordx4 v207, s[20:23], s54 offen lds
  s_add_u32 m0, s61, 45056
  s_add_u32 s54, s62, 4587520
  buffer_load_dwordx4 v207, s[20:23], s54 offen lds
  v_add_u32 v215, 86016, v209
  ds_read_b64_tr_b16 a[80:81], v215 offset:0
  ds_read_b64_tr_b16 a[82:83], v215 offset:1024
  ds_read_b64_tr_b16 a[84:85], v215 offset:4096
  ds_read_b64_tr_b16 a[86:87], v215 offset:5120
  ds_read_b64_tr_b16 a[88:89], v215 offset:8192
  ds_read_b64_tr_b16 a[90:91], v215 offset:9216
  ds_read_b64_tr_b16 a[92:93], v215 offset:12288
  ds_read_b64_tr_b16 a[94:95], v215 offset:13312
  s_waitcnt vmcnt(20) lgkmcnt(0)
  s_barrier
  s_add_u32 m0, s61, 49152
  s_add_u32 s54, s62, 4194304
  buffer_load_dwordx4 v207, s[24:27], s54 offen lds
  s_add_u32 m0, s61, 53248
  s_add_u32 s54, s62, 4325376
  buffer_load_dwordx4 v207, s[24:27], s54 offen lds
  s_add_u32 m0, s61, 57344
  s_add_u32 s54, s62, 4456448
  buffer_load_dwordx4 v207, s[24:27], s54 offen lds
  s_add_u32 m0, s61, 61440
  s_add_u32 s54, s62, 4587520
  buffer_load_dwordx4 v207, s[24:27], s54 offen lds
  s_mul_i32 s54, s53, 21120
  s_lshl_b32 s55, s52, 13
  s_add_u32 s54, s54, s55
  s_cmp_eq_u32 s52, 3
  s_cselect_b32 s54, 0x10000000, s54
  v_lshlrev_b32 v211, 3, v201
  buffer_load_dword v196, v211, s[28:31], s54 offen
  v_add_u32 v215, 102400, v210
  ds_read_b64_tr_b16 a[224:225], v215 offset:0
  ds_read_b64_tr_b16 a[226:227], v215 offset:1024
  ds_read_b64_tr_b16 a[228:229], v215 offset:4096
  ds_read_b64_tr_b16 a[230:231], v215 offset:5120
  ds_read_b64_tr_b16 a[232:233], v215 offset:8192
  ds_read_b64_tr_b16 a[234:235], v215 offset:9216
  ds_read_b64_tr_b16 a[236:237], v215 offset:12288
  ds_read_b64_tr_b16 a[238:239], v215 offset:13312
  s_waitcnt vmcnt(21) lgkmcnt(0)
  s_barrier
  s_lshl_b32 s54, s53, 13
  s_lshr_b32 s55, s53, 6
  s_or_b32 s55, s55, s52
  s_cmp_eq_u32 s55, 0
  s_cselect_b32 s54, s54, 0x10000000
  v_lshlrev_b32 v211, 3, v201
  buffer_load_dword v196, v211, s[16:19], s54 offen
  v_add_u32 v215, 118784, v209
  ds_read_b64_tr_b16 a[96:97], v215 offset:0
  ds_read_b64_tr_b16 a[98:99], v215 offset:1024
  ds_read_b64_tr_b16 a[100:101], v215 offset:4096
  ds_read_b64_tr_b16 a[102:103], v215 offset:5120
  ds_read_b64_tr_b16 a[104:105], v215 offset:8192
  ds_read_b64_tr_b16 a[106:107], v215 offset:9216
  ds_read_b64_tr_b16 a[108:109], v215 offset:12288
  ds_read_b64_tr_b16 a[110:111], v215 offset:13312
  s_waitcnt vmcnt(18) lgkmcnt(0)
  s_barrier
  v_add_u32 v215, 135168, v210
  ds_read_b64_tr_b16 a[240:241], v215 offset:0
  ds_read_b64_tr_b16 a[242:243], v215 offset:1024
  ds_read_b64_tr_b16 a[244:245], v215 offset:4096
  ds_read_b64_tr_b16 a[246:247], v215 offset:5120
  ds_read_b64_tr_b16 a[248:249], v215 offset:8192
  ds_read_b64_tr_b16 a[250:251], v215 offset:9216
  ds_read_b64_tr_b16 a[252:253], v215 offset:12288
  ds_read_b64_tr_b16 a[254:255], v215 offset:13312
  s_waitcnt vmcnt(14) lgkmcnt(0)
  s_barrier
  v_add_u32 v215, 36864, v209
  ds_read_b64_tr_b16 a[112:113], v215 offset:0
  ds_read_b64_tr_b16 a[114:115], v215 offset:1024
  ds_read_b64_tr_b16 a[116:117], v215 offset:4096
  ds_read_b64_tr_b16 a[118:119], v215 offset:5120
  ds_read_b64_tr_b16 a[120:121], v215 offset:8192
  ds_read_b64_tr_b16 a[122:123], v215 offset:9216
  ds_read_b64_tr_b16 a[124:125], v215 offset:12288
  ds_read_b64_tr_b16 a[126:127], v215 offset:13312
  s_waitcnt vmcnt(10) lgkmcnt(0)
  s_barrier
  v_add_u32 v215, 53248, v210
  ds_read_b64_tr_b16 v[224:225], v215 offset:0
  ds_read_b64_tr_b16 v[226:227], v215 offset:1024
  ds_read_b64_tr_b16 v[228:229], v215 offset:4096
  ds_read_b64_tr_b16 v[230:231], v215 offset:5120
  ds_read_b64_tr_b16 v[232:233], v215 offset:8192
  ds_read_b64_tr_b16 v[234:235], v215 offset:9216
  ds_read_b64_tr_b16 v[236:237], v215 offset:12288
  ds_read_b64_tr_b16 v[238:239], v215 offset:13312
  s_waitcnt vmcnt(6) lgkmcnt(0)
  s_barrier
  v_add_u32 v215, 69632, v209
  ds_read_b64_tr_b16 a[128:129], v215 offset:0
  ds_read_b64_tr_b16 a[130:131], v215 offset:1024
  ds_read_b64_tr_b16 a[132:133], v215 offset:4096
  ds_read_b64_tr_b16 a[134:135], v215 offset:5120
  ds_read_b64_tr_b16 a[136:137], v215 offset:8192
  ds_read_b64_tr_b16 a[138:139], v215 offset:9216
  ds_read_b64_tr_b16 a[140:141], v215 offset:12288
  ds_read_b64_tr_b16 a[142:143], v215 offset:13312
  s_waitcnt vmcnt(2) lgkmcnt(0)
  s_barrier
  v_add_u32 v215, 86016, v210
  ds_read_b64_tr_b16 v[240:241], v215 offset:0
  ds_read_b64_tr_b16 v[242:243], v215 offset:1024
  ds_read_b64_tr_b16 v[244:245], v215 offset:4096
  ds_read_b64_tr_b16 v[246:247], v215 offset:5120
  ds_read_b64_tr_b16 v[248:249], v215 offset:8192
  ds_read_b64_tr_b16 v[250:251], v215 offset:9216
  ds_read_b64_tr_b16 v[252:253], v215 offset:12288
  ds_read_b64_tr_b16 v[254:255], v215 offset:13312
  s_waitcnt lgkmcnt(0)
  s_barrier
  s_mul_i32 s55, s53, 21846
  s_lshr_b32 s55, s55, 16
  s_mul_i32 s56, s55, 3
  s_sub_u32 s56, s53, s56
  s_lshl_b32 s56, s56, 7
  s_lshl_b32 s55, s55, 2
  s_add_u32 s55, s55, s56
  s_add_u32 s55, s55, 356352
  s_cmp_lt_u32 s53, 96
  s_cselect_b32 s71, s55, 268435456
  v_mov_b32 v211, 0
  s_mov_b64 exec, 1
  buffer_store_dword v211, v211, s[8:11], s71 offen sc1
  s_mov_b64 exec, -1
  s_mov_b32 s68, 1040356334
  s_lshl_b32 s69, s52, 9
  s_lshl_b32 s70, s58, 2
  s_add_u32 s70, s70, 128
KV_loop:
  s_add_u32 s60, s60, 258048
  s_add_u32 m0, s67, 36864
  s_nop 0
  buffer_load_dwordx4 v202, s[4:7], s60 offen offset:0 lds
  s_add_u32 m0, s67, 37760
  s_nop 0
  buffer_load_dwordx4 v202, s[4:7], s60 offen offset:128 lds
  s_add_u32 m0, s67, 38656
  s_nop 0
  buffer_load_dwordx4 v202, s[4:7], s60 offen offset:256 lds
  s_add_u32 m0, s67, 39552
  s_nop 0
  buffer_load_dwordx4 v202, s[4:7], s60 offen offset:384 lds
  s_add_u32 m0, s67, 40448
  s_nop 0
  buffer_load_dwordx4 v202, s[4:7], s60 offen offset:512 lds
  s_add_u32 m0, s67, 41344
  s_nop 0
  buffer_load_dwordx4 v202, s[4:7], s60 offen offset:640 lds
  s_add_u32 m0, s67, 42240
  s_nop 0
  buffer_load_dwordx4 v202, s[4:7], s60 offen offset:768 lds
  s_add_u32 m0, s67, 43136
  s_nop 0
  buffer_load_dwordx4 v202, s[4:7], s60 offen offset:896 lds
  s_add_u32 m0, s67, 44032
  s_nop 0
  buffer_load_dwordx4 v202, s[4:7], s60 offen offset:1024 lds
  ds_read_b128 v[32:35], v203 offset:0
  ds_read_b128 v[36:39], v204 offset:0
  ds_read_b128 v[40:43], v205 offset:0
  s_waitcnt lgkmcnt(2)
  v_mfma_f32_32x32x16_bf16 v[0:15], a[0:3], v[32:35], 0
  ds_read_b128 v[44:47], v206 offset:0
  v_mfma_f32_32x32x16_bf16 v[16:31], v[32:35], a[144:147], 0
  s_waitcnt lgkmcnt(2)
  v_mfma_f32_32x32x16_bf16 v[0:15], a[4:7], v[36:39], v[0:15]
  ds_read_b128 v[32:35], v203 offset:1024
  v_mfma_f32_32x32x16_bf16 v[16:31], v[36:39], a[148:151], v[16:31]
  s_waitcnt lgkmcnt(2)
  v_mfma_f32_32x32x16_bf16 v[0:15], a[8:11], v[40:43], v[0:15]
  ds_read_b128 v[36:39], v204 offset:1024
  v_mfma_f32_32x32x16_bf16 v[16:31], v[40:43], a[152:155], v[16:31]
  s_waitcnt lgkmcnt(2)
  v_mfma_f32_32x32x16_bf16 v[0:15], a[12:15], v[44:47], v[0:15]
  ds_read_b128 v[40:43], v205 offset:1024
  v_mfma_f32_32x32x16_bf16 v[16:31], v[44:47], a[156:159], v[16:31]
  s_waitcnt lgkmcnt(2)
  v_mfma_f32_32x32x16_bf16 v[0:15], a[16:19], v[32:35], v[0:15]
  ds_read_b128 v[44:47], v206 offset:1024
  v_mfma_f32_32x32x16_bf16 v[16:31], v[32:35], a[160:163], v[16:31]
  s_waitcnt lgkmcnt(2)
  v_mfma_f32_32x32x16_bf16 v[0:15], a[20:23], v[36:39], v[0:15]
  ds_read_b128 v[32:35], v203 offset:2048
  v_mfma_f32_32x32x16_bf16 v[16:31], v[36:39], a[164:167], v[16:31]
  s_waitcnt lgkmcnt(2)
  v_mfma_f32_32x32x16_bf16 v[0:15], a[24:27], v[40:43], v[0:15]
  ds_read_b128 v[36:39], v204 offset:2048
  v_mfma_f32_32x32x16_bf16 v[16:31], v[40:43], a[168:171], v[16:31]
  s_waitcnt lgkmcnt(2)
  v_mfma_f32_32x32x16_bf16 v[0:15], a[28:31], v[44:47], v[0:15]
  ds_read_b128 v[40:43], v205 offset:2048
  v_mfma_f32_32x32x16_bf16 v[16:31], v[44:47], a[172:175], v[16:31]
  s_waitcnt lgkmcnt(2)
  v_mfma_f32_32x32x16_bf16 v[0:15], a[32:35], v[32:35], v[0:15]
  ds_read_b128 v[44:47], v206 offset:2048
  v_mfma_f32_32x32x16_bf16 v[16:31], v[32:35], a[176:179], v[16:31]
  s_waitcnt lgkmcnt(2)
  v_mfma_f32_32x32x16_bf16 v[0:15], a[36:39], v[36:39], v[0:15]
  ds_read_b128 v[32:35], v203 offset:3072
  v_mfma_f32_32x32x16_bf16 v[16:31], v[36:39], a[180:183], v[16:31]
  s_waitcnt lgkmcnt(2)
  v_mfma_f32_32x32x16_bf16 v[0:15], a[40:43], v[40:43], v[0:15]
  ds_read_b128 v[36:39], v204 offset:3072
  v_mfma_f32_32x32x16_bf16 v[16:31], v[40:43], a[184:187], v[16:31]
  s_waitcnt lgkmcnt(2)
  v_mfma_f32_32x32x16_bf16 v[0:15], a[44:47], v[44:47], v[0:15]
  ds_read_b128 v[40:43], v205 offset:3072
  v_mfma_f32_32x32x16_bf16 v[16:31], v[44:47], a[188:191], v[16:31]
  s_waitcnt lgkmcnt(2)
  v_mfma_f32_32x32x16_bf16 v[0:15], a[48:51], v[32:35], v[0:15]
  ds_read_b128 v[44:47], v206 offset:3072
  v_mfma_f32_32x32x16_bf16 v[16:31], v[32:35], a[192:195], v[16:31]
  s_waitcnt lgkmcnt(2)
  v_mfma_f32_32x32x16_bf16 v[0:15], a[52:55], v[36:39], v[0:15]
  ds_read_b128 v[32:35], v203 offset:4096
  v_mfma_f32_32x32x16_bf16 v[16:31], v[36:39], a[196:199], v[16:31]
  s_waitcnt lgkmcnt(2)
  v_mfma_f32_32x32x16_bf16 v[0:15], a[56:59], v[40:43], v[0:15]
  ds_read_b128 v[36:39], v204 offset:4096
  v_mfma_f32_32x32x16_bf16 v[16:31], v[40:43], a[200:203], v[16:31]
  s_waitcnt lgkmcnt(2)
  v_mfma_f32_32x32x16_bf16 v[0:15], a[60:63], v[44:47], v[0:15]
  ds_read_b128 v[40:43], v205 offset:4096
  v_mfma_f32_32x32x16_bf16 v[16:31], v[44:47], a[204:207], v[16:31]
  s_waitcnt lgkmcnt(2)
  v_mfma_f32_32x32x16_bf16 v[0:15], a[64:67], v[32:35], v[0:15]
  ds_read_b128 v[44:47], v206 offset:4096
  v_mfma_f32_32x32x16_bf16 v[16:31], v[32:35], a[208:211], v[16:31]
  s_waitcnt lgkmcnt(2)
  v_mfma_f32_32x32x16_bf16 v[0:15], a[68:71], v[36:39], v[0:15]
  ds_read_b128 v[32:35], v203 offset:5120
  v_mfma_f32_32x32x16_bf16 v[16:31], v[36:39], a[212:215], v[16:31]
  s_waitcnt lgkmcnt(2)
  v_mfma_f32_32x32x16_bf16 v[0:15], a[72:75], v[40:43], v[0:15]
  ds_read_b128 v[36:39], v204 offset:5120
  v_mfma_f32_32x32x16_bf16 v[16:31], v[40:43], a[216:219], v[16:31]
  s_waitcnt lgkmcnt(2)
  v_mfma_f32_32x32x16_bf16 v[0:15], a[76:79], v[44:47], v[0:15]
  ds_read_b128 v[40:43], v205 offset:5120
  v_mfma_f32_32x32x16_bf16 v[16:31], v[44:47], a[220:223], v[16:31]
  s_waitcnt lgkmcnt(2)
  v_mfma_f32_32x32x16_bf16 v[0:15], a[80:83], v[32:35], v[0:15]
  ds_read_b128 v[44:47], v206 offset:5120
  v_mfma_f32_32x32x16_bf16 v[16:31], v[32:35], a[224:227], v[16:31]
  s_waitcnt lgkmcnt(2)
  v_mfma_f32_32x32x16_bf16 v[0:15], a[84:87], v[36:39], v[0:15]
  ds_read_b128 v[32:35], v203 offset:6144
  v_mfma_f32_32x32x16_bf16 v[16:31], v[36:39], a[228:231], v[16:31]
  s_waitcnt lgkmcnt(2)
  v_mfma_f32_32x32x16_bf16 v[0:15], a[88:91], v[40:43], v[0:15]
  ds_read_b128 v[36:39], v204 offset:6144
  v_mfma_f32_32x32x16_bf16 v[16:31], v[40:43], a[232:235], v[16:31]
  s_waitcnt lgkmcnt(2)
  v_mfma_f32_32x32x16_bf16 v[0:15], a[92:95], v[44:47], v[0:15]
  ds_read_b128 v[40:43], v205 offset:6144
  v_mfma_f32_32x32x16_bf16 v[16:31], v[44:47], a[236:239], v[16:31]
  s_waitcnt lgkmcnt(2)
  v_mfma_f32_32x32x16_bf16 v[0:15], a[96:99], v[32:35], v[0:15]
  ds_read_b128 v[44:47], v206 offset:6144
  v_mfma_f32_32x32x16_bf16 v[16:31], v[32:35], a[240:243], v[16:31]
  s_waitcnt lgkmcnt(2)
  v_mfma_f32_32x32x16_bf16 v[0:15], a[100:103], v[36:39], v[0:15]
  ds_read_b128 v[32:35], v203 offset:7168
  v_mfma_f32_32x32x16_bf16 v[16:31], v[36:39], a[244:247], v[16:31]
  s_waitcnt lgkmcnt(2)
  v_mfma_f32_32x32x16_bf16 v[0:15], a[104:107], v[40:43], v[0:15]
  ds_read_b128 v[36:39], v204 offset:7168
  v_mfma_f32_32x32x16_bf16 v[16:31], v[40:43], a[248:251], v[16:31]
  s_waitcnt lgkmcnt(2)
  v_mfma_f32_32x32x16_bf16 v[0:15], a[108:111], v[44:47], v[0:15]
  ds_read_b128 v[40:43], v205 offset:7168
  v_mfma_f32_32x32x16_bf16 v[16:31], v[44:47], a[252:255], v[16:31]
  s_waitcnt lgkmcnt(2)
  v_mfma_f32_32x32x16_bf16 v[0:15], a[112:115], v[32:35], v[0:15]
  ds_read_b128 v[44:47], v206 offset:7168
  v_mfma_f32_32x32x16_bf16 v[16:31], v[32:35], v[224:227], v[16:31]
  s_waitcnt lgkmcnt(2)
  v_mfma_f32_32x32x16_bf16 v[0:15], a[116:119], v[36:39], v[0:15]
  ds_read_b128 v[32:35], v203 offset:8192
  v_mfma_f32_32x32x16_bf16 v[16:31], v[36:39], v[228:231], v[16:31]
  s_waitcnt lgkmcnt(2)
  v_mfma_f32_32x32x16_bf16 v[0:15], a[120:123], v[40:43], v[0:15]
  ds_read_b128 v[36:39], v204 offset:8192
  v_mfma_f32_32x32x16_bf16 v[16:31], v[40:43], v[232:235], v[16:31]
  s_waitcnt lgkmcnt(2)
  v_mfma_f32_32x32x16_bf16 v[0:15], a[124:127], v[44:47], v[0:15]
  ds_read_b128 v[40:43], v205 offset:8192
  v_mfma_f32_32x32x16_bf16 v[16:31], v[44:47], v[236:239], v[16:31]
  s_waitcnt lgkmcnt(2)
  v_mfma_f32_32x32x16_bf16 v[0:15], a[128:131], v[32:35], v[0:15]
  ds_read_b128 v[44:47], v206 offset:8192
  v_mfma_f32_32x32x16_bf16 v[16:31], v[32:35], v[240:243], v[16:31]
  s_waitcnt lgkmcnt(2)
  v_mfma_f32_32x32x16_bf16 v[0:15], a[132:135], v[36:39], v[0:15]
  v_mfma_f32_32x32x16_bf16 v[16:31], v[36:39], v[244:247], v[16:31]
  s_waitcnt lgkmcnt(1)
  v_mfma_f32_32x32x16_bf16 v[0:15], a[136:139], v[40:43], v[0:15]
  v_mfma_f32_32x32x16_bf16 v[16:31], v[40:43], v[248:251], v[16:31]
  s_waitcnt lgkmcnt(0)
  v_mfma_f32_32x32x16_bf16 v[0:15], a[140:143], v[44:47], v[0:15]
  v_mfma_f32_32x32x16_bf16 v[16:31], v[44:47], v[252:255], v[16:31]
  s_mul_i32 s64, s59, 655360
  s_lshl_b32 s55, s58, 14
  s_add_u32 s64, s64, s55
  s_add_u32 s64, s64, 1048576
  s_add_u32 s55, s64, s69
  v_mul_f32 v0, s68, v0
  v_mul_f32 v1, s68, v1
  v_mul_f32 v2, s68, v2
  v_mul_f32 v3, s68, v3
  v_mul_f32 v4, s68, v4
  v_mul_f32 v5, s68, v5
  v_mul_f32 v6, s68, v6
  v_mul_f32 v7, s68, v7
  v_mul_f32 v8, s68, v8
  v_mul_f32 v9, s68, v9
  v_mul_f32 v10, s68, v10
  v_mul_f32 v11, s68, v11
  v_mul_f32 v12, s68, v12
  v_mul_f32 v13, s68, v13
  v_mul_f32 v14, s68, v14
  v_mul_f32 v15, s68, v15
  v_cvt_pk_bf16_f32 v48, v0, v4
  v_cvt_pk_bf16_f32 v49, v1, v5
  v_cvt_pk_bf16_f32 v50, v2, v6
  v_cvt_pk_bf16_f32 v51, v3, v7
  buffer_store_dwordx4 v[48:51], v216, s[8:11], s55 offen offset:0 sc1
  v_cvt_pk_bf16_f32 v52, v8, v12
  v_cvt_pk_bf16_f32 v53, v9, v13
  v_cvt_pk_bf16_f32 v54, v10, v14
  v_cvt_pk_bf16_f32 v55, v11, v15
  buffer_store_dwordx4 v[52:55], v216, s[8:11], s55 offen offset:256 sc1
  v_cvt_pk_bf16_f32 v56, v16, v17
  v_cvt_pk_bf16_f32 v57, v20, v21
  v_cvt_pk_bf16_f32 v58, v24, v25
  v_cvt_pk_bf16_f32 v59, v28, v29
  buffer_store_dwordx4 v[56:59], v217, s[8:11], s64 offen offset:0 sc1
  v_cvt_pk_bf16_f32 v60, v18, v19
  v_cvt_pk_bf16_f32 v61, v22, v23
  v_cvt_pk_bf16_f32 v62, v26, v27
  v_cvt_pk_bf16_f32 v63, v30, v31
  buffer_store_dwordx4 v[60:63], v217, s[8:11], s64 offen offset:256 sc1
  s_add_u32 s59, s59, 7
  s_cmp_ge_u32 s59, 64
  s_cbranch_scc1 KV_done
  s_waitcnt vmcnt(4)
  s_barrier
  s_add_u32 s60, s60, 258048
  s_add_u32 m0, s67, 0
  s_nop 0
  buffer_load_dwordx4 v202, s[4:7], s60 offen offset:0 lds
  s_add_u32 m0, s67, 896
  s_nop 0
  buffer_load_dwordx4 v202, s[4:7], s60 offen offset:128 lds
  s_add_u32 m0, s67, 1792
  s_nop 0
  buffer_load_dwordx4 v202, s[4:7], s60 offen offset:256 lds
  s_add_u32 m0, s67, 2688
  s_nop 0
  buffer_load_dwordx4 v202, s[4:7], s60 offen offset:384 lds
  s_add_u32 m0, s67, 3584
  s_nop 0
  buffer_load_dwordx4 v202, s[4:7], s60 offen offset:512 lds
  s_add_u32 m0, s67, 4480
  s_nop 0
  buffer_load_dwordx4 v202, s[4:7], s60 offen offset:640 lds
  s_add_u32 m0, s67, 5376
  s_nop 0
  buffer_load_dwordx4 v202, s[4:7], s60 offen offset:768 lds
  s_add_u32 m0, s67, 6272
  s_nop 0
  buffer_load_dwordx4 v202, s[4:7], s60 offen offset:896 lds
  s_add_u32 m0, s67, 7168
  s_nop 0
  buffer_load_dwordx4 v202, s[4:7], s60 offen offset:1024 lds
  ds_read_b128 v[32:35], v203 offset:36864
  ds_read_b128 v[36:39], v204 offset:36864
  ds_read_b128 v[40:43], v205 offset:36864
  s_waitcnt lgkmcnt(2)
  v_mfma_f32_32x32x16_bf16 v[0:15], a[0:3], v[32:35], 0
  ds_read_b128 v[44:47], v206 offset:36864
  v_mfma_f32_32x32x16_bf16 v[16:31], v[32:35], a[144:147], 0
  s_waitcnt lgkmcnt(2)
  v_mfma_f32_32x32x16_bf16 v[0:15], a[4:7], v[36:39], v[0:15]
  ds_read_b128 v[32:35], v203 offset:37888
  v_mfma_f32_32x32x16_bf16 v[16:31], v[36:39], a[148:151], v[16:31]
  s_waitcnt lgkmcnt(2)
  v_mfma_f32_32x32x16_bf16 v[0:15], a[8:11], v[40:43], v[0:15]
  ds_read_b128 v[36:39], v204 offset:37888
  v_mfma_f32_32x32x16_bf16 v[16:31], v[40:43], a[152:155], v[16:31]
  s_waitcnt lgkmcnt(2)
  v_mfma_f32_32x32x16_bf16 v[0:15], a[12:15], v[44:47], v[0:15]
  ds_read_b128 v[40:43], v205 offset:37888
  v_mfma_f32_32x32x16_bf16 v[16:31], v[44:47], a[156:159], v[16:31]
  s_waitcnt lgkmcnt(2)
  v_mfma_f32_32x32x16_bf16 v[0:15], a[16:19], v[32:35], v[0:15]
  ds_read_b128 v[44:47], v206 offset:37888
  v_mfma_f32_32x32x16_bf16 v[16:31], v[32:35], a[160:163], v[16:31]
  s_waitcnt lgkmcnt(2)
  v_mfma_f32_32x32x16_bf16 v[0:15], a[20:23], v[36:39], v[0:15]
  ds_read_b128 v[32:35], v203 offset:38912
  v_mfma_f32_32x32x16_bf16 v[16:31], v[36:39], a[164:167], v[16:31]
  s_waitcnt lgkmcnt(2)
  v_mfma_f32_32x32x16_bf16 v[0:15], a[24:27], v[40:43], v[0:15]
  ds_read_b128 v[36:39], v204 offset:38912
  v_mfma_f32_32x32x16_bf16 v[16:31], v[40:43], a[168:171], v[16:31]
  s_waitcnt lgkmcnt(2)
  v_mfma_f32_32x32x16_bf16 v[0:15], a[28:31], v[44:47], v[0:15]
  ds_read_b128 v[40:43], v205 offset:38912
  v_mfma_f32_32x32x16_bf16 v[16:31], v[44:47], a[172:175], v[16:31]
  s_waitcnt lgkmcnt(2)
  v_mfma_f32_32x32x16_bf16 v[0:15], a[32:35], v[32:35], v[0:15]
  ds_read_b128 v[44:47], v206 offset:38912
  v_mfma_f32_32x32x16_bf16 v[16:31], v[32:35], a[176:179], v[16:31]
  s_waitcnt lgkmcnt(2)
  v_mfma_f32_32x32x16_bf16 v[0:15], a[36:39], v[36:39], v[0:15]
  ds_read_b128 v[32:35], v203 offset:39936
  v_mfma_f32_32x32x16_bf16 v[16:31], v[36:39], a[180:183], v[16:31]
  s_waitcnt lgkmcnt(2)
  v_mfma_f32_32x32x16_bf16 v[0:15], a[40:43], v[40:43], v[0:15]
  ds_read_b128 v[36:39], v204 offset:39936
  v_mfma_f32_32x32x16_bf16 v[16:31], v[40:43], a[184:187], v[16:31]
  s_waitcnt lgkmcnt(2)
  v_mfma_f32_32x32x16_bf16 v[0:15], a[44:47], v[44:47], v[0:15]
  ds_read_b128 v[40:43], v205 offset:39936
  v_mfma_f32_32x32x16_bf16 v[16:31], v[44:47], a[188:191], v[16:31]
  s_waitcnt lgkmcnt(2)
  v_mfma_f32_32x32x16_bf16 v[0:15], a[48:51], v[32:35], v[0:15]
  ds_read_b128 v[44:47], v206 offset:39936
  v_mfma_f32_32x32x16_bf16 v[16:31], v[32:35], a[192:195], v[16:31]
  s_waitcnt lgkmcnt(2)
  v_mfma_f32_32x32x16_bf16 v[0:15], a[52:55], v[36:39], v[0:15]
  ds_read_b128 v[32:35], v203 offset:40960
  v_mfma_f32_32x32x16_bf16 v[16:31], v[36:39], a[196:199], v[16:31]
  s_waitcnt lgkmcnt(2)
  v_mfma_f32_32x32x16_bf16 v[0:15], a[56:59], v[40:43], v[0:15]
  ds_read_b128 v[36:39], v204 offset:40960
  v_mfma_f32_32x32x16_bf16 v[16:31], v[40:43], a[200:203], v[16:31]
  s_waitcnt lgkmcnt(2)
  v_mfma_f32_32x32x16_bf16 v[0:15], a[60:63], v[44:47], v[0:15]
  ds_read_b128 v[40:43], v205 offset:40960
  v_mfma_f32_32x32x16_bf16 v[16:31], v[44:47], a[204:207], v[16:31]
  s_waitcnt lgkmcnt(2)
  v_mfma_f32_32x32x16_bf16 v[0:15], a[64:67], v[32:35], v[0:15]
  ds_read_b128 v[44:47], v206 offset:40960
  v_mfma_f32_32x32x16_bf16 v[16:31], v[32:35], a[208:211], v[16:31]
  s_waitcnt lgkmcnt(2)
  v_mfma_f32_32x32x16_bf16 v[0:15], a[68:71], v[36:39], v[0:15]
  ds_read_b128 v[32:35], v203 offset:41984
  v_mfma_f32_32x32x16_bf16 v[16:31], v[36:39], a[212:215], v[16:31]
  s_waitcnt lgkmcnt(2)
  v_mfma_f32_32x32x16_bf16 v[0:15], a[72:75], v[40:43], v[0:15]
  ds_read_b128 v[36:39], v204 offset:41984
  v_mfma_f32_32x32x16_bf16 v[16:31], v[40:43], a[216:219], v[16:31]
  s_waitcnt lgkmcnt(2)
  v_mfma_f32_32x32x16_bf16 v[0:15], a[76:79], v[44:47], v[0:15]
  ds_read_b128 v[40:43], v205 offset:41984
  v_mfma_f32_32x32x16_bf16 v[16:31], v[44:47], a[220:223], v[16:31]
  s_waitcnt lgkmcnt(2)
  v_mfma_f32_32x32x16_bf16 v[0:15], a[80:83], v[32:35], v[0:15]
  ds_read_b128 v[44:47], v206 offset:41984
  v_mfma_f32_32x32x16_bf16 v[16:31], v[32:35], a[224:227], v[16:31]
  s_waitcnt lgkmcnt(2)
  v_mfma_f32_32x32x16_bf16 v[0:15], a[84:87], v[36:39], v[0:15]
  ds_read_b128 v[32:35], v203 offset:43008
  v_mfma_f32_32x32x16_bf16 v[16:31], v[36:39], a[228:231], v[16:31]
  s_waitcnt lgkmcnt(2)
  v_mfma_f32_32x32x16_bf16 v[0:15], a[88:91], v[40:43], v[0:15]
  ds_read_b128 v[36:39], v204 offset:43008
  v_mfma_f32_32x32x16_bf16 v[16:31], v[40:43], a[232:235], v[16:31]
  s_waitcnt lgkmcnt(2)
  v_mfma_f32_32x32x16_bf16 v[0:15], a[92:95], v[44:47], v[0:15]
  ds_read_b128 v[40:43], v205 offset:43008
  v_mfma_f32_32x32x16_bf16 v[16:31], v[44:47], a[236:239], v[16:31]
  s_waitcnt lgkmcnt(2)
  v_mfma_f32_32x32x16_bf16 v[0:15], a[96:99], v[32:35], v[0:15]
  ds_read_b128 v[44:47], v206 offset:43008
  v_mfma_f32_32x32x16_bf16 v[16:31], v[32:35], a[240:243], v[16:31]
  s_waitcnt lgkmcnt(2)
  v_mfma_f32_32x32x16_bf16 v[0:15], a[100:103], v[36:39], v[0:15]
  ds_read_b128 v[32:35], v203 offset:44032
  v_mfma_f32_32x32x16_bf16 v[16:31], v[36:39], a[244:247], v[16:31]
  s_waitcnt lgkmcnt(2)
  v_mfma_f32_32x32x16_bf16 v[0:15], a[104:107], v[40:43], v[0:15]
  ds_read_b128 v[36:39], v204 offset:44032
  v_mfma_f32_32x32x16_bf16 v[16:31], v[40:43], a[248:251], v[16:31]
  s_waitcnt lgkmcnt(2)
  v_mfma_f32_32x32x16_bf16 v[0:15], a[108:111], v[44:47], v[0:15]
  ds_read_b128 v[40:43], v205 offset:44032
  v_mfma_f32_32x32x16_bf16 v[16:31], v[44:47], a[252:255], v[16:31]
  s_waitcnt lgkmcnt(2)
  v_mfma_f32_32x32x16_bf16 v[0:15], a[112:115], v[32:35], v[0:15]
  ds_read_b128 v[44:47], v206 offset:44032
  v_mfma_f32_32x32x16_bf16 v[16:31], v[32:35], v[224:227], v[16:31]
  s_waitcnt lgkmcnt(2)
  v_mfma_f32_32x32x16_bf16 v[0:15], a[116:119], v[36:39], v[0:15]
  ds_read_b128 v[32:35], v203 offset:45056
  v_mfma_f32_32x32x16_bf16 v[16:31], v[36:39], v[228:231], v[16:31]
  s_waitcnt lgkmcnt(2)
  v_mfma_f32_32x32x16_bf16 v[0:15], a[120:123], v[40:43], v[0:15]
  ds_read_b128 v[36:39], v204 offset:45056
  v_mfma_f32_32x32x16_bf16 v[16:31], v[40:43], v[232:235], v[16:31]
  s_waitcnt lgkmcnt(2)
  v_mfma_f32_32x32x16_bf16 v[0:15], a[124:127], v[44:47], v[0:15]
  ds_read_b128 v[40:43], v205 offset:45056
  v_mfma_f32_32x32x16_bf16 v[16:31], v[44:47], v[236:239], v[16:31]
  s_waitcnt lgkmcnt(2)
  v_mfma_f32_32x32x16_bf16 v[0:15], a[128:131], v[32:35], v[0:15]
  ds_read_b128 v[44:47], v206 offset:45056
  v_mfma_f32_32x32x16_bf16 v[16:31], v[32:35], v[240:243], v[16:31]
  s_waitcnt lgkmcnt(2)
  v_mfma_f32_32x32x16_bf16 v[0:15], a[132:135], v[36:39], v[0:15]
  v_mfma_f32_32x32x16_bf16 v[16:31], v[36:39], v[244:247], v[16:31]
  s_waitcnt lgkmcnt(1)
  v_mfma_f32_32x32x16_bf16 v[0:15], a[136:139], v[40:43], v[0:15]
  v_mfma_f32_32x32x16_bf16 v[16:31], v[40:43], v[248:251], v[16:31]
  s_waitcnt lgkmcnt(0)
  v_mfma_f32_32x32x16_bf16 v[0:15], a[140:143], v[44:47], v[0:15]
  v_mfma_f32_32x32x16_bf16 v[16:31], v[44:47], v[252:255], v[16:31]
  s_mul_i32 s64, s59, 655360
  s_lshl_b32 s55, s58, 14
  s_add_u32 s64, s64, s55
  s_add_u32 s64, s64, 1048576
  s_add_u32 s55, s64, s69
  v_mul_f32 v0, s68, v0
  v_mul_f32 v1, s68, v1
  v_mul_f32 v2, s68, v2
  v_mul_f32 v3, s68, v3
  v_mul_f32 v4, s68, v4
  v_mul_f32 v5, s68, v5
  v_mul_f32 v6, s68, v6
  v_mul_f32 v7, s68, v7
  v_mul_f32 v8, s68, v8
  v_mul_f32 v9, s68, v9
  v_mul_f32 v10, s68, v10
  v_mul_f32 v11, s68, v11
  v_mul_f32 v12, s68, v12
  v_mul_f32 v13, s68, v13
  v_mul_f32 v14, s68, v14
  v_mul_f32 v15, s68, v15
  v_cvt_pk_bf16_f32 v48, v0, v4
  v_cvt_pk_bf16_f32 v49, v1, v5
  v_cvt_pk_bf16_f32 v50, v2, v6
  v_cvt_pk_bf16_f32 v51, v3, v7
  buffer_store_dwordx4 v[48:51], v216, s[8:11], s55 offen offset:0 sc1
  v_cvt_pk_bf16_f32 v52, v8, v12
  v_cvt_pk_bf16_f32 v53, v9, v13
  v_cvt_pk_bf16_f32 v54, v10, v14
  v_cvt_pk_bf16_f32 v55, v11, v15
  buffer_store_dwordx4 v[52:55], v216, s[8:11], s55 offen offset:256 sc1
  v_cvt_pk_bf16_f32 v56, v16, v17
  v_cvt_pk_bf16_f32 v57, v20, v21
  v_cvt_pk_bf16_f32 v58, v24, v25
  v_cvt_pk_bf16_f32 v59, v28, v29
  buffer_store_dwordx4 v[56:59], v217, s[8:11], s64 offen offset:0 sc1
  v_cvt_pk_bf16_f32 v60, v18, v19
  v_cvt_pk_bf16_f32 v61, v22, v23
  v_cvt_pk_bf16_f32 v62, v26, v27
  v_cvt_pk_bf16_f32 v63, v30, v31
  buffer_store_dwordx4 v[60:63], v217, s[8:11], s64 offen offset:256 sc1
  s_add_u32 s59, s59, 7
  s_cmp_ge_u32 s59, 64
  s_cbranch_scc1 KV_done
  s_sub_u32 s54, s59, 14
  s_cmp_lt_u32 s54, 7
  s_cbranch_scc1 KV_early
  s_waitcnt vmcnt(4)
  s_barrier
KV_cont:
  s_branch KV_loop
KV_early:
  s_waitcnt vmcnt(0)
  s_barrier
  s_cmp_eq_u32 s52, 0
  s_cbranch_scc0 KV_sig0
  v_mov_b32 v211, 1
  v_mov_b32 v212, 0
  s_mov_b64 exec, 1
  buffer_atomic_add v211, v212, s[12:15], s70 offen
  s_mov_b64 exec, -1
KV_sig0:
  s_branch KV_cont
KV_done:
  s_waitcnt vmcnt(0)
  s_barrier
  s_cmp_eq_u32 s52, 0
  s_cbranch_scc0 KV_sig
  v_mov_b32 v211, 256
  v_mov_b32 v212, 0
  s_mov_b64 exec, 1
  buffer_atomic_add v211, v212, s[12:15], s70 offen
  s_mov_b64 exec, -1
KV_sig:
  s_cmp_lt_u32 s53, 96
  s_cbranch_scc0 W_a
  s_mul_i32 s58, s53, 21846
  s_lshr_b32 s58, s58, 16
  s_mul_i32 s54, s58, 3
  s_sub_u32 s59, s53, s54
  s_mul_i32 s60, s59, 36864
  s_add_u32 m0, s67, 0
  s_nop 0
  buffer_load_dwordx4 v202, s[4:7], s60 offen offset:0 lds
  s_add_u32 m0, s67, 896
  s_nop 0
  buffer_load_dwordx4 v202, s[4:7], s60 offen offset:128 lds
  s_add_u32 m0, s67, 1792
  s_nop 0
  buffer_load_dwordx4 v202, s[4:7], s60 offen offset:256 lds
  s_add_u32 m0, s67, 2688
  s_nop 0
  buffer_load_dwordx4 v202, s[4:7], s60 offen offset:384 lds
  s_add_u32 m0, s67, 3584
  s_nop 0
  buffer_load_dwordx4 v202, s[4:7], s60 offen offset:512 lds
  s_add_u32 m0, s67, 4480
  s_nop 0
  buffer_load_dwordx4 v202, s[4:7], s60 offen offset:640 lds
  s_add_u32 m0, s67, 5376
  s_nop 0
  buffer_load_dwordx4 v202, s[4:7], s60 offen offset:768 lds
  s_add_u32 m0, s67, 6272
  s_nop 0
  buffer_load_dwordx4 v202, s[4:7], s60 offen offset:896 lds
  s_add_u32 m0, s67, 7168
  s_nop 0
  buffer_load_dwordx4 v202, s[4:7], s60 offen offset:1024 lds
  v_lshrrev_b32 v211, 4, v200
  v_lshlrev_b32 v212, 2, v211
  v_and_b32 v213, 15, v200
  v_xor_b32 v212, v212, v213
  v_lshlrev_b32 v212, 4, v212
  v_lshl_add_u32 v207, v211, 13, v212
  s_lshl_b32 s62, s58, 8
  s_lshl_b32 s54, s52, 15
  s_add_u32 s62, s62, s54
  s_lshl_b32 s61, s52, 10
  s_add_u32 s61, s61, 36864
  s_add_u32 m0, s61, 0
  s_add_u32 s54, s62, 0
  buffer_load_dwordx4 v207, s[16:19], s54 offen lds
  s_add_u32 m0, s61, 4096
  s_add_u32 s54, s62, 131072
  buffer_load_dwordx4 v207, s[16:19], s54 offen lds
  s_add_u32 m0, s61, 8192
  s_add_u32 s54, s62, 262144
  buffer_load_dwordx4 v207, s[16:19], s54 offen lds
  s_add_u32 m0, s61, 12288
  s_add_u32 s54, s62, 393216
  buffer_load_dwordx4 v207, s[16:19], s54 offen lds
  s_add_u32 m0, s61, 16384
  s_add_u32 s54, s62, 524288
  buffer_load_dwordx4 v207, s[16:19], s54 offen lds
  s_add_u32 m0, s61, 20480
  s_add_u32 s54, s62, 655360
  buffer_load_dwordx4 v207, s[16:19], s54 offen lds
  s_add_u32 m0, s61, 24576
  s_add_u32 s54, s62, 786432
  buffer_load_dwordx4 v207, s[16:19], s54 offen lds
  s_add_u32 m0, s61, 28672
  s_add_u32 s54, s62, 917504
  buffer_load_dwordx4 v207, s[16:19], s54 offen lds
  s_add_u32 m0, s61, 32768
  s_add_u32 s54, s62, 1048576
  buffer_load_dwordx4 v207, s[16:19], s54 offen lds
  s_add_u32 m0, s61, 36864
  s_add_u32 s54, s62, 1179648
  buffer_load_dwordx4 v207, s[16:19], s54 offen lds
  s_add_u32 m0, s61, 40960
  s_add_u32 s54, s62, 1310720
  buffer_load_dwordx4 v207, s[16:19], s54 offen lds
  s_add_u32 m0, s61, 45056
  s_add_u32 s54, s62, 1441792
  buffer_load_dwordx4 v207, s[16:19], s54 offen lds
  s_add_u32 m0, s61, 49152
  s_add_u32 s54, s62, 1572864
  buffer_load_dwordx4 v207, s[16:19], s54 offen lds
  s_add_u32 m0, s61, 53248
  s_add_u32 s54, s62, 1703936
  buffer_load_dwordx4 v207, s[16:19], s54 offen lds
  s_add_u32 m0, s61, 57344
  s_add_u32 s54, s62, 1835008
  buffer_load_dwordx4 v207, s[16:19], s54 offen lds
  s_add_u32 m0, s61, 61440
  s_add_u32 s54, s62, 1966080
  buffer_load_dwordx4 v207, s[16:19], s54 offen lds
  s_add_u32 m0, s61, 65536
  s_add_u32 s54, s62, 2097152
  buffer_load_dwordx4 v207, s[16:19], s54 offen lds
  s_add_u32 m0, s61, 69632
  s_add_u32 s54, s62, 2228224
  buffer_load_dwordx4 v207, s[16:19], s54 offen lds
  s_add_u32 m0, s61, 73728
  s_add_u32 s54, s62, 2359296
  buffer_load_dwordx4 v207, s[16:19], s54 offen lds
  s_add_u32 m0, s61, 77824
  s_add_u32 s54, s62, 2490368
  buffer_load_dwordx4 v207, s[16:19], s54 offen lds
  s_add_u32 m0, s61, 81920
  s_add_u32 s54, s62, 2621440
  buffer_load_dwordx4 v207, s[16:19], s54 offen lds
  s_add_u32 m0, s61, 86016
  s_add_u32 s54, s62, 2752512
  buffer_load_dwordx4 v207, s[16:19], s54 offen lds
  s_add_u32 m0, s61, 90112
  s_add_u32 s54, s62, 2883584
  buffer_load_dwordx4 v207, s[16:19], s54 offen lds
  s_add_u32 m0, s61, 94208
  s_add_u32 s54, s62, 3014656
  buffer_load_dwordx4 v207, s[16:19], s54 offen lds
  s_waitcnt vmcnt(20) lgkmcnt(0)
  s_barrier
  s_add_u32 m0, s61, 98304
  s_add_u32 s54, s62, 3145728
  buffer_load_dwordx4 v207, s[16:19], s54 offen lds
  s_add_u32 m0, s61, 102400
  s_add_u32 s54, s62, 3276800
  buffer_load_dwordx4 v207, s[16:19], s54 offen lds
  s_add_u32 m0, s61, 106496
  s_add_u32 s54, s62, 3407872
  buffer_load_dwordx4 v207, s[16:19], s54 offen lds
  s_add_u32 m0, s61, 110592
  s_add_u32 s54, s62, 3538944
  buffer_load_dwordx4 v207, s[16:19], s54 offen lds
  v_add_u32 v215, 36864, v209
  ds_read_b64_tr_b16 a[0:1], v215 offset:0
  ds_read_b64_tr_b16 a[2:3], v215 offset:1024
  ds_read_b64_tr_b16 a[4:5], v215 offset:4096
  ds_read_b64_tr_b16 a[6:7], v215 offset:5120
  ds_read_b64_tr_b16 a[8:9], v215 offset:8192
  ds_read_b64_tr_b16 a[10:11], v215 offset:9216
  ds_read_b64_tr_b16 a[12:13], v215 offset:12288
  ds_read_b64_tr_b16 a[14:15], v215 offset:13312
  s_waitcnt vmcnt(20) lgkmcnt(0)
  s_barrier
  s_add_u32 m0, s61, 0
  s_add_u32 s54, s62, 3670016
  buffer_load_dwordx4 v207, s[16:19], s54 offen lds
  s_add_u32 m0, s61, 4096
  s_add_u32 s54, s62, 3801088
  buffer_load_dwordx4 v207, s[16:19], s54 offen lds
  s_add_u32 m0, s61, 8192
  s_add_u32 s54, s62, 3932160
  buffer_load_dwordx4 v207, s[16:19], s54 offen lds
  s_add_u32 m0, s61, 12288
  s_add_u32 s54, s62, 4063232
  buffer_load_dwordx4 v207, s[16:19], s54 offen lds
  v_add_u32 v215, 53248, v209
  ds_read_b64_tr_b16 a[16:17], v215 offset:0
  ds_read_b64_tr_b16 a[18:19], v215 offset:1024
  ds_read_b64_tr_b16 a[20:21], v215 offset:4096
  ds_read_b64_tr_b16 a[22:23], v215 offset:5120
  ds_read_b64_tr_b16 a[24:25], v215 offset:8192
  ds_read_b64_tr_b16 a[26:27], v215 offset:9216
  ds_read_b64_tr_b16 a[28:29], v215 offset:12288
  ds_read_b64_tr_b16 a[30:31], v215 offset:13312
  s_waitcnt vmcnt(20) lgkmcnt(0)
  s_barrier
  s_add_u32 m0, s61, 16384
  s_add_u32 s54, s62, 4194304
  buffer_load_dwordx4 v207, s[16:19], s54 offen lds
  s_add_u32 m0, s61, 20480
  s_add_u32 s54, s62, 4325376
  buffer_load_dwordx4 v207, s[16:19], s54 offen lds
  s_add_u32 m0, s61, 24576
  s_add_u32 s54, s62, 4456448
  buffer_load_dwordx4 v207, s[16:19], s54 offen lds
  s_add_u32 m0, s61, 28672
  s_add_u32 s54, s62, 4587520
  buffer_load_dwordx4 v207, s[16:19], s54 offen lds
  v_add_u32 v215, 69632, v209
  ds_read_b64_tr_b16 a[32:33], v215 offset:0
  ds_read_b64_tr_b16 a[34:35], v215 offset:1024
  ds_read_b64_tr_b16 a[36:37], v215 offset:4096
  ds_read_b64_tr_b16 a[38:39], v215 offset:5120
  ds_read_b64_tr_b16 a[40:41], v215 offset:8192
  ds_read_b64_tr_b16 a[42:43], v215 offset:9216
  ds_read_b64_tr_b16 a[44:45], v215 offset:12288
  ds_read_b64_tr_b16 a[46:47], v215 offset:13312
  s_waitcnt vmcnt(20) lgkmcnt(0)
  s_barrier
  v_add_u32 v215, 86016, v209
  ds_read_b64_tr_b16 a[48:49], v215 offset:0
  ds_read_b64_tr_b16 a[50:51], v215 offset:1024
  ds_read_b64_tr_b16 a[52:53], v215 offset:4096
  ds_read_b64_tr_b16 a[54:55], v215 offset:5120
  ds_read_b64_tr_b16 a[56:57], v215 offset:8192
  ds_read_b64_tr_b16 a[58:59], v215 offset:9216
  ds_read_b64_tr_b16 a[60:61], v215 offset:12288
  ds_read_b64_tr_b16 a[62:63], v215 offset:13312
  s_waitcnt vmcnt(16) lgkmcnt(0)
  s_barrier
  v_add_u32 v215, 102400, v209
  ds_read_b64_tr_b16 a[64:65], v215 offset:0
  ds_read_b64_tr_b16 a[66:67], v215 offset:1024
  ds_read_b64_tr_b16 a[68:69], v215 offset:4096
  ds_read_b64_tr_b16 a[70:71], v215 offset:5120
  ds_read_b64_tr_b16 a[72:73], v215 offset:8192
  ds_read_b64_tr_b16 a[74:75], v215 offset:9216
  ds_read_b64_tr_b16 a[76:77], v215 offset:12288
  ds_read_b64_tr_b16 a[78:79], v215 offset:13312
  s_waitcnt vmcnt(12) lgkmcnt(0)
  s_barrier
  v_add_u32 v215, 118784, v209
  ds_read_b64_tr_b16 a[80:81], v215 offset:0
  ds_read_b64_tr_b16 a[82:83], v215 offset:1024
  ds_read_b64_tr_b16 a[84:85], v215 offset:4096
  ds_read_b64_tr_b16 a[86:87], v215 offset:5120
  ds_read_b64_tr_b16 a[88:89], v215 offset:8192
  ds_read_b64_tr_b16 a[90:91], v215 offset:9216
  ds_read_b64_tr_b16 a[92:93], v215 offset:12288
  ds_read_b64_tr_b16 a[94:95], v215 offset:13312
  s_waitcnt vmcnt(8) lgkmcnt(0)
  s_barrier
  v_add_u32 v215, 135168, v209
  ds_read_b64_tr_b16 a[96:97], v215 offset:0
  ds_read_b64_tr_b16 a[98:99], v215 offset:1024
  ds_read_b64_tr_b16 a[100:101], v215 offset:4096
  ds_read_b64_tr_b16 a[102:103], v215 offset:5120
  ds_read_b64_tr_b16 a[104:105], v215 offset:8192
  ds_read_b64_tr_b16 a[106:107], v215 offset:9216
  ds_read_b64_tr_b16 a[108:109], v215 offset:12288
  ds_read_b64_tr_b16 a[110:111], v215 offset:13312
  s_waitcnt vmcnt(4) lgkmcnt(0)
  s_barrier
  v_add_u32 v215, 36864, v209
  ds_read_b64_tr_b16 a[112:113], v215 offset:0
  ds_read_b64_tr_b16 a[114:115], v215 offset:1024
  ds_read_b64_tr_b16 a[116:117], v215 offset:4096
  ds_read_b64_tr_b16 a[118:119], v215 offset:5120
  ds_read_b64_tr_b16 a[120:121], v215 offset:8192
  ds_read_b64_tr_b16 a[122:123], v215 offset:9216
  ds_read_b64_tr_b16 a[124:125], v215 offset:12288
  ds_read_b64_tr_b16 a[126:127], v215 offset:13312
  s_waitcnt vmcnt(0) lgkmcnt(0)
  s_barrier
  v_add_u32 v215, 53248, v209
  ds_read_b64_tr_b16 a[128:129], v215 offset:0
  ds_read_b64_tr_b16 a[130:131], v215 offset:1024
  ds_read_b64_tr_b16 a[132:133], v215 offset:4096
  ds_read_b64_tr_b16 a[134:135], v215 offset:5120
  ds_read_b64_tr_b16 a[136:137], v215 offset:8192
  ds_read_b64_tr_b16 a[138:139], v215 offset:9216
  ds_read_b64_tr_b16 a[140:141], v215 offset:12288
  ds_read_b64_tr_b16 a[142:143], v215 offset:13312
  s_waitcnt lgkmcnt(0)
  s_barrier
  v_and_b32 v211, 31, v200
  v_lshrrev_b32 v212, 5, v200
  v_lshlrev_b32 v213, 2, v212
  v_sub_u32 v211, v211, v213
  v_mov_b32 v214, 0xf149f2ca
  v_cmp_gt_i32 vcc, 0, v211
  s_nop 1
  v_cndmask_b32 v48, 0, v214, vcc
  v_cmp_gt_i32 vcc, 1, v211
  s_nop 1
  v_cndmask_b32 v49, 0, v214, vcc
  v_cmp_gt_i32 vcc, 2, v211
  s_nop 1
  v_cndmask_b32 v50, 0, v214, vcc
  v_cmp_gt_i32 vcc, 3, v211
  s_nop 1
  v_cndmask_b32 v51, 0, v214, vcc
  v_cmp_gt_i32 vcc, 8, v211
  s_nop 1
  v_cndmask_b32 v52, 0, v214, vcc
  v_cmp_gt_i32 vcc, 9, v211
  s_nop 1
  v_cndmask_b32 v53, 0, v214, vcc
  v_cmp_gt_i32 vcc, 10, v211
  s_nop 1
  v_cndmask_b32 v54, 0, v214, vcc
  v_cmp_gt_i32 vcc, 11, v211
  s_nop 1
  v_cndmask_b32 v55, 0, v214, vcc
  v_cmp_gt_i32 vcc, 16, v211
  s_nop 1
  v_cndmask_b32 v56, 0, v214, vcc
  v_cmp_gt_i32 vcc, 17, v211
  s_nop 1
  v_cndmask_b32 v57, 0, v214, vcc
  v_cmp_gt_i32 vcc, 18, v211
  s_nop 1
  v_cndmask_b32 v58, 0, v214, vcc
  v_cmp_gt_i32 vcc, 19, v211
  s_nop 1
  v_cndmask_b32 v59, 0, v214, vcc
  v_cmp_gt_i32 vcc, 24, v211
  s_nop 1
  v_cndmask_b32 v60, 0, v214, vcc
  v_cmp_gt_i32 vcc, 25, v211
  s_nop 1
  v_cndmask_b32 v61, 0, v214, vcc
  v_cmp_gt_i32 vcc, 26, v211
  s_nop 1
  v_cndmask_b32 v62, 0, v214, vcc
  v_cmp_gt_i32 vcc, 27, v211
  s_nop 1
  v_cndmask_b32 v63, 0, v214, vcc
  v_and_b32 v218, 0xff, v216
  v_and_b32 v211, 15, v200
  v_lshl_add_u32 v211, v212, 5, v211
  v_lshlrev_b32 v219, 4, v211
  v_bfe_u32 v211, v200, 4, 1
  v_lshl_add_u32 v219, v211, 2, v219
  s_lshl_b32 s54, s52, 10
  s_add_u32 s54, s54, 8
  v_add_u32 v219, s54, v219
  s_lshl_b32 s54, s52, 11
  s_add_u32 s54, s54, 73728
  v_add_u32 v215, s54, v201
  v_add_u32 v208, 73728, v201
  s_mov_b32 s68, 1040356334
  s_lshl_b32 s69, s58, 7
  s_add_u32 s69, s69, 352256
  s_lshl_b32 s56, s58, 2
  s_add_u32 s56, s56, 128
  s_mov_b32 s57, 32
  s_cmp_eq_u32 s52, 0
  s_cbranch_scc0 AT_p1_d
  s_mov_b32 exec_hi, 0
  s_mov_b32 exec_lo, 1
AT_p1:
  buffer_load_dword v211, v201, s[12:15], s56 offen sc1
  s_add_u32 s65, s65, 1
  s_waitcnt vmcnt(0)
  v_cmp_gt_u32 vcc, 0x700, v211
  s_cbranch_vccz AT_p1_x
  s_sleep 8
  s_cmp_lt_u32 s65, 131072
  s_cbranch_scc1 AT_p1
AT_p1_x:
  s_mov_b64 exec, -1
AT_p1_d:
  s_barrier
  s_cmp_eq_u32 s52, 0
  s_cbranch_scc0 AT_arm_d
  s_mov_b32 exec_hi, 0
  s_mov_b32 exec_lo, 1
AT_arm:
  buffer_load_dword v211, v201, s[12:15], s57 offen sc1
  s_add_u32 s65, s65, 1
  s_waitcnt vmcnt(0)
  v_cmp_gt_u32 vcc, 32, v211
  s_cbranch_vccz AT_arm_x
  s_sleep 8
  s_cmp_lt_u32 s65, 131072
  s_cbranch_scc1 AT_arm
AT_arm_x:
  s_mov_b64 exec, -1
AT_arm_d:
  s_barrier
AT_loop:
  s_lshl_b32 s64, s59, 5
  s_add_u32 s64, s64, s58
  s_mul_i32 s66, s59, 655360
  s_lshl_b32 s55, s58, 14
  s_add_u32 s55, s55, s66
  s_add_u32 s55, s55, 1048576
  buffer_load_dwordx4 v[128:131], v216, s[8:11], s55 offen offset:0 sc1
  buffer_load_dwordx4 v[132:135], v216, s[8:11], s55 offen offset:256 sc1
  buffer_load_dwordx4 v[136:139], v216, s[8:11], s55 offen offset:512 sc1
  buffer_load_dwordx4 v[140:143], v216, s[8:11], s55 offen offset:768 sc1
  buffer_load_dwordx4 v[144:147], v216, s[8:11], s55 offen offset:1024 sc1
  buffer_load_dwordx4 v[148:151], v216, s[8:11], s55 offen offset:1280 sc1
  buffer_load_dwordx4 v[152:155], v216, s[8:11], s55 offen offset:1536 sc1
  buffer_load_dwordx4 v[156:159], v216, s[8:11], s55 offen offset:1792 sc1
  buffer_load_dwordx4 v[160:163], v217, s[8:11], s55 offen offset:0 sc1
  buffer_load_dwordx4 v[164:167], v217, s[8:11], s55 offen offset:256 sc1
  s_add_u32 s60, s60, 110592
  s_add_u32 m0, s67, 36864
  s_nop 0
  buffer_load_dwordx4 v202, s[4:7], s60 offen offset:0 lds
  s_add_u32 m0, s67, 37760
  s_nop 0
  buffer_load_dwordx4 v202, s[4:7], s60 offen offset:128 lds
  s_add_u32 m0, s67, 38656
  s_nop 0
  buffer_load_dwordx4 v202, s[4:7], s60 offen offset:256 lds
  s_add_u32 m0, s67, 39552
  s_nop 0
  buffer_load_dwordx4 v202, s[4:7], s60 offen offset:384 lds
  s_add_u32 m0, s67, 40448
  s_nop 0
  buffer_load_dwordx4 v202, s[4:7], s60 offen offset:512 lds
  s_add_u32 m0, s67, 41344
  s_nop 0
  buffer_load_dwordx4 v202, s[4:7], s60 offen offset:640 lds
  s_add_u32 m0, s67, 42240
  s_nop 0
  buffer_load_dwordx4 v202, s[4:7], s60 offen offset:768 lds
  s_add_u32 m0, s67, 43136
  s_nop 0
  buffer_load_dwordx4 v202, s[4:7], s60 offen offset:896 lds
  s_add_u32 m0, s67, 44032
  s_nop 0
  buffer_load_dwordx4 v202, s[4:7], s60 offen offset:1024 lds
  ds_read_b128 v[32:35], v203 offset:0
  ds_read_b128 v[36:39], v204 offset:0
  ds_read_b128 v[40:43], v205 offset:0
  s_waitcnt lgkmcnt(2)
  v_mfma_f32_32x32x16_bf16 v[0:15], a[0:3], v[32:35], 0
  ds_read_b128 v[44:47], v206 offset:0
  s_waitcnt lgkmcnt(2)
  v_mfma_f32_32x32x16_bf16 v[0:15], a[4:7], v[36:39], v[0:15]
  ds_read_b128 v[32:35], v203 offset:1024
  s_waitcnt lgkmcnt(2)
  v_mfma_f32_32x32x16_bf16 v[0:15], a[8:11], v[40:43], v[0:15]
  ds_read_b128 v[36:39], v204 offset:1024
  s_waitcnt lgkmcnt(2)
  v_mfma_f32_32x32x16_bf16 v[0:15], a[12:15], v[44:47], v[0:15]
  ds_read_b128 v[40:43], v205 offset:1024
  s_waitcnt lgkmcnt(2)
  v_mfma_f32_32x32x16_bf16 v[0:15], a[16:19], v[32:35], v[0:15]
  ds_read_b128 v[44:47], v206 offset:1024
  s_waitcnt lgkmcnt(2)
  v_mfma_f32_32x32x16_bf16 v[0:15], a[20:23], v[36:39], v[0:15]
  ds_read_b128 v[32:35], v203 offset:2048
  s_waitcnt lgkmcnt(2)
  v_mfma_f32_32x32x16_bf16 v[0:15], a[24:27], v[40:43], v[0:15]
  ds_read_b128 v[36:39], v204 offset:2048
  s_waitcnt lgkmcnt(2)
  v_mfma_f32_32x32x16_bf16 v[0:15], a[28:31], v[44:47], v[0:15]
  ds_read_b128 v[40:43], v205 offset:2048
  s_waitcnt lgkmcnt(2)
  v_mfma_f32_32x32x16_bf16 v[0:15], a[32:35], v[32:35], v[0:15]
  ds_read_b128 v[44:47], v206 offset:2048
  s_waitcnt lgkmcnt(2)
  v_mfma_f32_32x32x16_bf16 v[0:15], a[36:39], v[36:39], v[0:15]
  ds_read_b128 v[32:35], v203 offset:3072
  s_waitcnt lgkmcnt(2)
  v_mfma_f32_32x32x16_bf16 v[0:15], a[40:43], v[40:43], v[0:15]
  ds_read_b128 v[36:39], v204 offset:3072
  s_waitcnt lgkmcnt(2)
  v_mfma_f32_32x32x16_bf16 v[0:15], a[44:47], v[44:47], v[0:15]
  ds_read_b128 v[40:43], v205 offset:3072
  s_waitcnt lgkmcnt(2)
  v_mfma_f32_32x32x16_bf16 v[0:15], a[48:51], v[32:35], v[0:15]
  ds_read_b128 v[44:47], v206 offset:3072
  s_waitcnt lgkmcnt(2)
  v_mfma_f32_32x32x16_bf16 v[0:15], a[52:55], v[36:39], v[0:15]
  ds_read_b128 v[32:35], v203 offset:4096
  s_waitcnt lgkmcnt(2)
  v_mfma_f32_32x32x16_bf16 v[0:15], a[56:59], v[40:43], v[0:15]
  ds_read_b128 v[36:39], v204 offset:4096
  s_waitcnt lgkmcnt(2)
  v_mfma_f32_32x32x16_bf16 v[0:15], a[60:63], v[44:47], v[0:15]
  ds_read_b128 v[40:43], v205 offset:4096
  s_waitcnt lgkmcnt(2)
  v_mfma_f32_32x32x16_bf16 v[0:15], a[64:67], v[32:35], v[0:15]
  ds_read_b128 v[44:47], v206 offset:4096
  s_waitcnt lgkmcnt(2)
  v_mfma_f32_32x32x16_bf16 v[0:15], a[68:71], v[36:39], v[0:15]
  ds_read_b128 v[32:35], v203 offset:5120
  s_waitcnt lgkmcnt(2)
  v_mfma_f32_32x32x16_bf16 v[0:15], a[72:75], v[40:43], v[0:15]
  ds_read_b128 v[36:39], v204 offset:5120
  s_waitcnt lgkmcnt(2)
  v_mfma_f32_32x32x16_bf16 v[0:15], a[76:79], v[44:47], v[0:15]
  ds_read_b128 v[40:43], v205 offset:5120
  s_waitcnt lgkmcnt(2)
  v_mfma_f32_32x32x16_bf16 v[0:15], a[80:83], v[32:35], v[0:15]
  ds_read_b128 v[44:47], v206 offset:5120
  s_waitcnt lgkmcnt(2)
  v_mfma_f32_32x32x16_bf16 v[0:15], a[84:87], v[36:39], v[0:15]
  ds_read_b128 v[32:35], v203 offset:6144
  s_waitcnt lgkmcnt(2)
  v_mfma_f32_32x32x16_bf16 v[0:15], a[88:91], v[40:43], v[0:15]
  ds_read_b128 v[36:39], v204 offset:6144
  s_waitcnt lgkmcnt(2)
  v_mfma_f32_32x32x16_bf16 v[0:15], a[92:95], v[44:47], v[0:15]
  ds_read_b128 v[40:43], v205 offset:6144
  s_waitcnt lgkmcnt(2)
  v_mfma_f32_32x32x16_bf16 v[0:15], a[96:99], v[32:35], v[0:15]
  ds_read_b128 v[44:47], v206 offset:6144
  s_waitcnt lgkmcnt(2)
  v_mfma_f32_32x32x16_bf16 v[0:15], a[100:103], v[36:39], v[0:15]
  ds_read_b128 v[32:35], v203 offset:7168
  s_waitcnt lgkmcnt(2)
  v_mfma_f32_32x32x16_bf16 v[0:15], a[104:107], v[40:43], v[0:15]
  ds_read_b128 v[36:39], v204 offset:7168
  s_waitcnt lgkmcnt(2)
  v_mfma_f32_32x32x16_bf16 v[0:15], a[108:111], v[44:47], v[0:15]
  ds_read_b128 v[40:43], v205 offset:7168
  s_waitcnt lgkmcnt(2)
  v_mfma_f32_32x32x16_bf16 v[0:15], a[112:115], v[32:35], v[0:15]
  ds_read_b128 v[44:47], v206 offset:7168
  s_waitcnt lgkmcnt(2)
  v_mfma_f32_32x32x16_bf16 v[0:15], a[116:119], v[36:39], v[0:15]
  ds_read_b128 v[32:35], v203 offset:8192
  s_waitcnt lgkmcnt(2)
  v_mfma_f32_32x32x16_bf16 v[0:15], a[120:123], v[40:43], v[0:15]
  ds_read_b128 v[36:39], v204 offset:8192
  s_waitcnt lgkmcnt(2)
  v_mfma_f32_32x32x16_bf16 v[0:15], a[124:127], v[44:47], v[0:15]
  ds_read_b128 v[40:43], v205 offset:8192
  s_waitcnt lgkmcnt(2)
  v_mfma_f32_32x32x16_bf16 v[0:15], a[128:131], v[32:35], v[0:15]
  ds_read_b128 v[44:47], v206 offset:8192
  s_waitcnt lgkmcnt(2)
  v_mfma_f32_32x32x16_bf16 v[0:15], a[132:135], v[36:39], v[0:15]
  s_waitcnt lgkmcnt(1)
  v_mfma_f32_32x32x16_bf16 v[0:15], a[136:139], v[40:43], v[0:15]
  s_waitcnt lgkmcnt(0)
  v_mfma_f32_32x32x16_bf16 v[0:15], a[140:143], v[44:47], v[0:15]
  s_nop 11
  v_cvt_pk_bf16_f32 v16, v0, v4
  v_cvt_pk_bf16_f32 v17, v1, v5
  v_cvt_pk_bf16_f32 v18, v2, v6
  v_cvt_pk_bf16_f32 v19, v3, v7
  ds_write_b128 v215, v[16:19] offset:0
  v_cvt_pk_bf16_f32 v20, v8, v12
  v_cvt_pk_bf16_f32 v21, v9, v13
  v_cvt_pk_bf16_f32 v22, v10, v14
  v_cvt_pk_bf16_f32 v23, v11, v15
  ds_write_b128 v215, v[20:23] offset:1024
  s_waitcnt lgkmcnt(0)
  s_barrier
  ds_read_b128 v[96:99], v208 offset:0
  ds_read_b128 v[100:103], v208 offset:1024
  ds_read_b128 v[104:107], v208 offset:2048
  ds_read_b128 v[108:111], v208 offset:3072
  ds_read_b128 v[112:115], v208 offset:4096
  ds_read_b128 v[116:119], v208 offset:5120
  ds_read_b128 v[120:123], v208 offset:6144
  ds_read_b128 v[124:127], v208 offset:7168
  s_waitcnt vmcnt(18) lgkmcnt(7)
  v_mfma_f32_32x32x16_bf16 v[64:79], v[128:131], v[96:99], v[48:63]
  s_waitcnt vmcnt(17) lgkmcnt(6)
  v_mfma_f32_32x32x16_bf16 v[64:79], v[132:135], v[100:103], v[64:79]
  s_waitcnt vmcnt(16) lgkmcnt(5)
  v_mfma_f32_32x32x16_bf16 v[64:79], v[136:139], v[104:107], v[64:79]
  s_waitcnt vmcnt(15) lgkmcnt(4)
  v_mfma_f32_32x32x16_bf16 v[64:79], v[140:143], v[108:111], v[64:79]
  s_waitcnt vmcnt(14) lgkmcnt(3)
  v_mfma_f32_32x32x16_bf16 v[64:79], v[144:147], v[112:115], v[64:79]
  s_waitcnt vmcnt(13) lgkmcnt(2)
  v_mfma_f32_32x32x16_bf16 v[64:79], v[148:151], v[116:119], v[64:79]
  s_waitcnt vmcnt(12) lgkmcnt(1)
  v_mfma_f32_32x32x16_bf16 v[64:79], v[152:155], v[120:123], v[64:79]
  s_waitcnt vmcnt(11) lgkmcnt(0)
  v_mfma_f32_32x32x16_bf16 v[64:79], v[156:159], v[124:127], v[64:79]
  s_add_u32 s70, s59, 2
  s_lshl_b32 s55, s58, 12
  s_add_u32 s55, s55, s66
  s_add_u32 s55, s55, 1572864
  s_nop 7
  v_max3_f32 v16, v64, v65, v66
  v_max3_f32 v16, v16, v67, v68
  v_max3_f32 v16, v16, v69, v70
  v_max3_f32 v16, v16, v71, v72
  v_max3_f32 v16, v16, v73, v74
  v_max3_f32 v16, v16, v75, v76
  v_max3_f32 v16, v16, v77, v78
  v_max_f32 v16, v16, v79
  s_waitcnt vmcnt(0)
  s_cmp_eq_u32 s52, 0
  s_cbranch_scc0 AT_m0_d
  s_mov_b32 exec_hi, 0
  s_mov_b32 exec_lo, 1
AT_m0:
  buffer_load_dword v211, v201, s[8:11], s69 offen sc1
  s_add_u32 s65, s65, 1
  s_waitcnt vmcnt(0)
  v_cmp_gt_u32 vcc, s70, v211
  s_cbranch_vccz AT_m0_x
  s_sleep 1
  s_cmp_lt_u32 s65, 131072
  s_cbranch_scc1 AT_m0
AT_m0_x:
  s_mov_b64 exec, -1
AT_m0_d:
  s_barrier
  buffer_load_dwordx2 v[128:129], v218, s[8:11], s55 offen offset:0 sc1
  buffer_load_dwordx2 v[130:131], v218, s[8:11], s55 offen offset:1024 sc1
  buffer_load_dwordx2 v[132:133], v218, s[8:11], s55 offen offset:256 sc1
  buffer_load_dwordx2 v[134:135], v218, s[8:11], s55 offen offset:1280 sc1
  buffer_load_dwordx2 v[136:137], v218, s[8:11], s55 offen offset:512 sc1
  buffer_load_dwordx2 v[138:139], v218, s[8:11], s55 offen offset:1536 sc1
  buffer_load_dwordx2 v[140:141], v218, s[8:11], s55 offen offset:768 sc1
  buffer_load_dwordx2 v[142:143], v218, s[8:11], s55 offen offset:1792 sc1
  buffer_load_dwordx2 v[144:145], v218, s[8:11], s55 offen offset:2048 sc1
  buffer_load_dwordx2 v[146:147], v218, s[8:11], s55 offen offset:3072 sc1
  buffer_load_dwordx2 v[148:149], v218, s[8:11], s55 offen offset:2304 sc1
  buffer_load_dwordx2 v[150:151], v218, s[8:11], s55 offen offset:3328 sc1
  buffer_load_dwordx2 v[152:153], v218, s[8:11], s55 offen offset:2560 sc1
  buffer_load_dwordx2 v[154:155], v218, s[8:11], s55 offen offset:3584 sc1
  buffer_load_dwordx2 v[156:157], v218, s[8:11], s55 offen offset:2816 sc1
  buffer_load_dwordx2 v[158:159], v218, s[8:11], s55 offen offset:3840 sc1
  buffer_load_dword v168, v219, s[8:11], s55 offen offset:0 sc1
  buffer_load_dword v169, v219, s[8:11], s55 offen offset:256 sc1
  s_waitcnt vmcnt(16)
  v_mfma_f32_32x32x16_bf16 v[80:95], v[128:131], v[96:99], 0
  s_waitcnt vmcnt(14)
  v_mfma_f32_32x32x16_bf16 v[80:95], v[132:135], v[100:103], v[80:95]
  s_waitcnt vmcnt(12)
  v_mfma_f32_32x32x16_bf16 v[80:95], v[136:139], v[104:107], v[80:95]
  s_waitcnt vmcnt(10)
  v_mfma_f32_32x32x16_bf16 v[80:95], v[140:143], v[108:111], v[80:95]
  s_waitcnt vmcnt(8)
  v_mfma_f32_32x32x16_bf16 v[80:95], v[144:147], v[112:115], v[80:95]
  s_waitcnt vmcnt(6)
  v_mfma_f32_32x32x16_bf16 v[80:95], v[148:151], v[116:119], v[80:95]
  s_waitcnt vmcnt(4)
  v_mfma_f32_32x32x16_bf16 v[80:95], v[152:155], v[120:123], v[80:95]
  s_waitcnt vmcnt(2)
  v_mfma_f32_32x32x16_bf16 v[80:95], v[156:159], v[124:127], v[80:95]
  s_lshl_b32 s64, s64, 13
  s_lshl_b32 s54, s52, 11
  s_add_u32 s64, s64, s54
  s_add_u32 s64, s64, 46137344
  s_nop 7
  v_mul_f32 v80, s68, v80
  v_mul_f32 v81, s68, v81
  v_mul_f32 v82, s68, v82
  v_mul_f32 v83, s68, v83
  v_max3_f32 v16, v16, v80, v81
  v_max3_f32 v16, v16, v82, v83
  v_mov_b32 v17, v16
  s_nop 1
  v_permlane32_swap_b32 v16, v17
  v_max_f32 v16, v16, v17
  v_sub_f32 v64, v64, v16
  v_sub_f32 v65, v65, v16
  v_sub_f32 v66, v66, v16
  v_sub_f32 v67, v67, v16
  v_sub_f32 v68, v68, v16
  v_sub_f32 v69, v69, v16
  v_sub_f32 v70, v70, v16
  v_sub_f32 v71, v71, v16
  v_sub_f32 v72, v72, v16
  v_sub_f32 v73, v73, v16
  v_sub_f32 v74, v74, v16
  v_sub_f32 v75, v75, v16
  v_sub_f32 v76, v76, v16
  v_sub_f32 v77, v77, v16
  v_sub_f32 v78, v78, v16
  v_sub_f32 v79, v79, v16
  v_sub_f32 v80, v80, v16
  v_sub_f32 v81, v81, v16
  v_sub_f32 v82, v82, v16
  v_sub_f32 v83, v83, v16
  v_exp_f32 v64, v64
  v_exp_f32 v65, v65
  v_exp_f32 v66, v66
  v_exp_f32 v67, v67
  v_exp_f32 v68, v68
  v_exp_f32 v69, v69
  v_exp_f32 v70, v70
  v_exp_f32 v71, v71
  v_exp_f32 v72, v72
  v_exp_f32 v73, v73
  v_exp_f32 v74, v74
  v_exp_f32 v75, v75
  v_exp_f32 v76, v76
  v_exp_f32 v77, v77
  v_exp_f32 v78, v78
  v_exp_f32 v79, v79
  v_exp_f32 v80, v80
  v_exp_f32 v81, v81
  v_exp_f32 v82, v82
  v_exp_f32 v83, v83
  v_cvt_pk_bf16_f32 v20, v64, v65
  v_cvt_pk_bf16_f32 v21, v68, v69
  v_cvt_pk_bf16_f32 v22, v72, v73
  v_cvt_pk_bf16_f32 v23, v76, v77
  v_cvt_pk_bf16_f32 v24, v66, v67
  v_cvt_pk_bf16_f32 v25, v70, v71
  v_cvt_pk_bf16_f32 v26, v74, v75
  v_cvt_pk_bf16_f32 v27, v78, v79
  v_cvt_pk_bf16_f32 v28, v80, v81
  v_cvt_pk_bf16_f32 v29, v82, v83
  v_mfma_f32_32x32x16_bf16 v[0:15], v[160:163], v[20:23], 0
  v_add_f32 v16, v64, v65
  v_add_f32 v16, v16, v66
  v_add_f32 v16, v16, v67
  v_add_f32 v16, v16, v68
  v_add_f32 v16, v16, v69
  v_add_f32 v16, v16, v70
  v_add_f32 v16, v16, v71
  v_mfma_f32_32x32x16_bf16 v[0:15], v[164:167], v[24:27], v[0:15]
  v_add_f32 v16, v16, v72
  v_add_f32 v16, v16, v73
  v_add_f32 v16, v16, v74
  v_add_f32 v16, v16, v75
  v_add_f32 v16, v16, v76
  v_add_f32 v16, v16, v77
  s_waitcnt vmcnt(0)
  v_mfma_f32_32x32x8_bf16 v[0:15], v[168:169], v[28:29], v[0:15]
  v_add_f32 v16, v16, v78
  v_add_f32 v16, v16, v79
  v_add_f32 v16, v16, v80
  v_add_f32 v16, v16, v81
  v_add_f32 v16, v16, v82
  v_add_f32 v16, v16, v83
  v_mov_b32 v17, v16
  s_nop 1
  v_permlane32_swap_b32 v16, v17
  v_add_f32 v16, v16, v17
  v_rcp_f32 v16, v16
  s_nop 0
  v_mul_f32 v0, v16, v0
  v_mul_f32 v1, v16, v1
  v_mul_f32 v2, v16, v2
  v_mul_f32 v3, v16, v3
  v_mul_f32 v4, v16, v4
  v_mul_f32 v5, v16, v5
  v_mul_f32 v6, v16, v6
  v_mul_f32 v7, v16, v7
  v_cvt_pk_bf16_f32 v20, v0, v1
  v_cvt_pk_bf16_f32 v21, v2, v3
  v_cvt_pk_bf16_f32 v22, v4, v5
  v_cvt_pk_bf16_f32 v23, v6, v7
  buffer_store_dwordx4 v[20:23], v201, s[8:11], s64 offen offset:0 sc1
  v_mul_f32 v8, v16, v8
  v_mul_f32 v9, v16, v9
  v_mul_f32 v10, v16, v10
  v_mul_f32 v11, v16, v11
  v_mul_f32 v12, v16, v12
  v_mul_f32 v13, v16, v13
  v_mul_f32 v14, v16, v14
  v_mul_f32 v15, v16, v15
  v_cvt_pk_bf16_f32 v24, v8, v9
  v_cvt_pk_bf16_f32 v25, v10, v11
  v_cvt_pk_bf16_f32 v26, v12, v13
  v_cvt_pk_bf16_f32 v27, v14, v15
  buffer_store_dwordx4 v[24:27], v201, s[8:11], s64 offen offset:1024 sc1
  s_add_u32 s59, s59, 3
  v_mov_b32 v212, s59
  s_waitcnt vmcnt(0)
  s_barrier
  s_cmp_eq_u32 s52, 0
  s_cselect_b32 s54, s71, 268435456
  s_mov_b64 exec, 1
  buffer_store_dword v212, v201, s[8:11], s54 offen sc1
  s_mov_b64 exec, -1
  s_cmp_ge_u32 s59, 64
  s_cbranch_scc1 L_exit
  s_lshl_b32 s64, s59, 5
  s_add_u32 s64, s64, s58
  s_mul_i32 s66, s59, 655360
  s_lshl_b32 s55, s58, 14
  s_add_u32 s55, s55, s66
  s_add_u32 s55, s55, 1048576
  buffer_load_dwordx4 v[128:131], v216, s[8:11], s55 offen offset:0 sc1
  buffer_load_dwordx4 v[132:135], v216, s[8:11], s55 offen offset:256 sc1
  buffer_load_dwordx4 v[136:139], v216, s[8:11], s55 offen offset:512 sc1
  buffer_load_dwordx4 v[140:143], v216, s[8:11], s55 offen offset:768 sc1
  buffer_load_dwordx4 v[144:147], v216, s[8:11], s55 offen offset:1024 sc1
  buffer_load_dwordx4 v[148:151], v216, s[8:11], s55 offen offset:1280 sc1
  buffer_load_dwordx4 v[152:155], v216, s[8:11], s55 offen offset:1536 sc1
  buffer_load_dwordx4 v[156:159], v216, s[8:11], s55 offen offset:1792 sc1
  buffer_load_dwordx4 v[160:163], v217, s[8:11], s55 offen offset:0 sc1
  buffer_load_dwordx4 v[164:167], v217, s[8:11], s55 offen offset:256 sc1
  s_add_u32 s60, s60, 110592
  s_add_u32 m0, s67, 0
  s_nop 0
  buffer_load_dwordx4 v202, s[4:7], s60 offen offset:0 lds
  s_add_u32 m0, s67, 896
  s_nop 0
  buffer_load_dwordx4 v202, s[4:7], s60 offen offset:128 lds
  s_add_u32 m0, s67, 1792
  s_nop 0
  buffer_load_dwordx4 v202, s[4:7], s60 offen offset:256 lds
  s_add_u32 m0, s67, 2688
  s_nop 0
  buffer_load_dwordx4 v202, s[4:7], s60 offen offset:384 lds
  s_add_u32 m0, s67, 3584
  s_nop 0
  buffer_load_dwordx4 v202, s[4:7], s60 offen offset:512 lds
  s_add_u32 m0, s67, 4480
  s_nop 0
  buffer_load_dwordx4 v202, s[4:7], s60 offen offset:640 lds
  s_add_u32 m0, s67, 5376
  s_nop 0
  buffer_load_dwordx4 v202, s[4:7], s60 offen offset:768 lds
  s_add_u32 m0, s67, 6272
  s_nop 0
  buffer_load_dwordx4 v202, s[4:7], s60 offen offset:896 lds
  s_add_u32 m0, s67, 7168
  s_nop 0
  buffer_load_dwordx4 v202, s[4:7], s60 offen offset:1024 lds
  ds_read_b128 v[32:35], v203 offset:36864
  ds_read_b128 v[36:39], v204 offset:36864
  ds_read_b128 v[40:43], v205 offset:36864
  s_waitcnt lgkmcnt(2)
  v_mfma_f32_32x32x16_bf16 v[0:15], a[0:3], v[32:35], 0
  ds_read_b128 v[44:47], v206 offset:36864
  s_waitcnt lgkmcnt(2)
  v_mfma_f32_32x32x16_bf16 v[0:15], a[4:7], v[36:39], v[0:15]
  ds_read_b128 v[32:35], v203 offset:37888
  s_waitcnt lgkmcnt(2)
  v_mfma_f32_32x32x16_bf16 v[0:15], a[8:11], v[40:43], v[0:15]
  ds_read_b128 v[36:39], v204 offset:37888
  s_waitcnt lgkmcnt(2)
  v_mfma_f32_32x32x16_bf16 v[0:15], a[12:15], v[44:47], v[0:15]
  ds_read_b128 v[40:43], v205 offset:37888
  s_waitcnt lgkmcnt(2)
  v_mfma_f32_32x32x16_bf16 v[0:15], a[16:19], v[32:35], v[0:15]
  ds_read_b128 v[44:47], v206 offset:37888
  s_waitcnt lgkmcnt(2)
  v_mfma_f32_32x32x16_bf16 v[0:15], a[20:23], v[36:39], v[0:15]
  ds_read_b128 v[32:35], v203 offset:38912
  s_waitcnt lgkmcnt(2)
  v_mfma_f32_32x32x16_bf16 v[0:15], a[24:27], v[40:43], v[0:15]
  ds_read_b128 v[36:39], v204 offset:38912
  s_waitcnt lgkmcnt(2)
  v_mfma_f32_32x32x16_bf16 v[0:15], a[28:31], v[44:47], v[0:15]
  ds_read_b128 v[40:43], v205 offset:38912
  s_waitcnt lgkmcnt(2)
  v_mfma_f32_32x32x16_bf16 v[0:15], a[32:35], v[32:35], v[0:15]
  ds_read_b128 v[44:47], v206 offset:38912
  s_waitcnt lgkmcnt(2)
  v_mfma_f32_32x32x16_bf16 v[0:15], a[36:39], v[36:39], v[0:15]
  ds_read_b128 v[32:35], v203 offset:39936
  s_waitcnt lgkmcnt(2)
  v_mfma_f32_32x32x16_bf16 v[0:15], a[40:43], v[40:43], v[0:15]
  ds_read_b128 v[36:39], v204 offset:39936
  s_waitcnt lgkmcnt(2)
  v_mfma_f32_32x32x16_bf16 v[0:15], a[44:47], v[44:47], v[0:15]
  ds_read_b128 v[40:43], v205 offset:39936
  s_waitcnt lgkmcnt(2)
  v_mfma_f32_32x32x16_bf16 v[0:15], a[48:51], v[32:35], v[0:15]
  ds_read_b128 v[44:47], v206 offset:39936
  s_waitcnt lgkmcnt(2)
  v_mfma_f32_32x32x16_bf16 v[0:15], a[52:55], v[36:39], v[0:15]
  ds_read_b128 v[32:35], v203 offset:40960
  s_waitcnt lgkmcnt(2)
  v_mfma_f32_32x32x16_bf16 v[0:15], a[56:59], v[40:43], v[0:15]
  ds_read_b128 v[36:39], v204 offset:40960
  s_waitcnt lgkmcnt(2)
  v_mfma_f32_32x32x16_bf16 v[0:15], a[60:63], v[44:47], v[0:15]
  ds_read_b128 v[40:43], v205 offset:40960
  s_waitcnt lgkmcnt(2)
  v_mfma_f32_32x32x16_bf16 v[0:15], a[64:67], v[32:35], v[0:15]
  ds_read_b128 v[44:47], v206 offset:40960
  s_waitcnt lgkmcnt(2)
  v_mfma_f32_32x32x16_bf16 v[0:15], a[68:71], v[36:39], v[0:15]
  ds_read_b128 v[32:35], v203 offset:41984
  s_waitcnt lgkmcnt(2)
  v_mfma_f32_32x32x16_bf16 v[0:15], a[72:75], v[40:43], v[0:15]
  ds_read_b128 v[36:39], v204 offset:41984
  s_waitcnt lgkmcnt(2)
  v_mfma_f32_32x32x16_bf16 v[0:15], a[76:79], v[44:47], v[0:15]
  ds_read_b128 v[40:43], v205 offset:41984
  s_waitcnt lgkmcnt(2)
  v_mfma_f32_32x32x16_bf16 v[0:15], a[80:83], v[32:35], v[0:15]
  ds_read_b128 v[44:47], v206 offset:41984
  s_waitcnt lgkmcnt(2)
  v_mfma_f32_32x32x16_bf16 v[0:15], a[84:87], v[36:39], v[0:15]
  ds_read_b128 v[32:35], v203 offset:43008
  s_waitcnt lgkmcnt(2)
  v_mfma_f32_32x32x16_bf16 v[0:15], a[88:91], v[40:43], v[0:15]
  ds_read_b128 v[36:39], v204 offset:43008
  s_waitcnt lgkmcnt(2)
  v_mfma_f32_32x32x16_bf16 v[0:15], a[92:95], v[44:47], v[0:15]
  ds_read_b128 v[40:43], v205 offset:43008
  s_waitcnt lgkmcnt(2)
  v_mfma_f32_32x32x16_bf16 v[0:15], a[96:99], v[32:35], v[0:15]
  ds_read_b128 v[44:47], v206 offset:43008
  s_waitcnt lgkmcnt(2)
  v_mfma_f32_32x32x16_bf16 v[0:15], a[100:103], v[36:39], v[0:15]
  ds_read_b128 v[32:35], v203 offset:44032
  s_waitcnt lgkmcnt(2)
  v_mfma_f32_32x32x16_bf16 v[0:15], a[104:107], v[40:43], v[0:15]
  ds_read_b128 v[36:39], v204 offset:44032
  s_waitcnt lgkmcnt(2)
  v_mfma_f32_32x32x16_bf16 v[0:15], a[108:111], v[44:47], v[0:15]
  ds_read_b128 v[40:43], v205 offset:44032
  s_waitcnt lgkmcnt(2)
  v_mfma_f32_32x32x16_bf16 v[0:15], a[112:115], v[32:35], v[0:15]
  ds_read_b128 v[44:47], v206 offset:44032
  s_waitcnt lgkmcnt(2)
  v_mfma_f32_32x32x16_bf16 v[0:15], a[116:119], v[36:39], v[0:15]
  ds_read_b128 v[32:35], v203 offset:45056
  s_waitcnt lgkmcnt(2)
  v_mfma_f32_32x32x16_bf16 v[0:15], a[120:123], v[40:43], v[0:15]
  ds_read_b128 v[36:39], v204 offset:45056
  s_waitcnt lgkmcnt(2)
  v_mfma_f32_32x32x16_bf16 v[0:15], a[124:127], v[44:47], v[0:15]
  ds_read_b128 v[40:43], v205 offset:45056
  s_waitcnt lgkmcnt(2)
  v_mfma_f32_32x32x16_bf16 v[0:15], a[128:131], v[32:35], v[0:15]
  ds_read_b128 v[44:47], v206 offset:45056
  s_waitcnt lgkmcnt(2)
  v_mfma_f32_32x32x16_bf16 v[0:15], a[132:135], v[36:39], v[0:15]
  s_waitcnt lgkmcnt(1)
  v_mfma_f32_32x32x16_bf16 v[0:15], a[136:139], v[40:43], v[0:15]
  s_waitcnt lgkmcnt(0)
  v_mfma_f32_32x32x16_bf16 v[0:15], a[140:143], v[44:47], v[0:15]
  s_nop 11
  v_cvt_pk_bf16_f32 v16, v0, v4
  v_cvt_pk_bf16_f32 v17, v1, v5
  v_cvt_pk_bf16_f32 v18, v2, v6
  v_cvt_pk_bf16_f32 v19, v3, v7
  ds_write_b128 v215, v[16:19] offset:0
  v_cvt_pk_bf16_f32 v20, v8, v12
  v_cvt_pk_bf16_f32 v21, v9, v13
  v_cvt_pk_bf16_f32 v22, v10, v14
  v_cvt_pk_bf16_f32 v23, v11, v15
  ds_write_b128 v215, v[20:23] offset:1024
  s_waitcnt lgkmcnt(0)
  s_barrier
  ds_read_b128 v[96:99], v208 offset:0
  ds_read_b128 v[100:103], v208 offset:1024
  ds_read_b128 v[104:107], v208 offset:2048
  ds_read_b128 v[108:111], v208 offset:3072
  ds_read_b128 v[112:115], v208 offset:4096
  ds_read_b128 v[116:119], v208 offset:5120
  ds_read_b128 v[120:123], v208 offset:6144
  ds_read_b128 v[124:127], v208 offset:7168
  s_waitcnt vmcnt(18) lgkmcnt(7)
  v_mfma_f32_32x32x16_bf16 v[64:79], v[128:131], v[96:99], v[48:63]
  s_waitcnt vmcnt(17) lgkmcnt(6)
  v_mfma_f32_32x32x16_bf16 v[64:79], v[132:135], v[100:103], v[64:79]
  s_waitcnt vmcnt(16) lgkmcnt(5)
  v_mfma_f32_32x32x16_bf16 v[64:79], v[136:139], v[104:107], v[64:79]
  s_waitcnt vmcnt(15) lgkmcnt(4)
  v_mfma_f32_32x32x16_bf16 v[64:79], v[140:143], v[108:111], v[64:79]
  s_waitcnt vmcnt(14) lgkmcnt(3)
  v_mfma_f32_32x32x16_bf16 v[64:79], v[144:147], v[112:115], v[64:79]
  s_waitcnt vmcnt(13) lgkmcnt(2)
  v_mfma_f32_32x32x16_bf16 v[64:79], v[148:151], v[116:119], v[64:79]
  s_waitcnt vmcnt(12) lgkmcnt(1)
  v_mfma_f32_32x32x16_bf16 v[64:79], v[152:155], v[120:123], v[64:79]
  s_waitcnt vmcnt(11) lgkmcnt(0)
  v_mfma_f32_32x32x16_bf16 v[64:79], v[156:159], v[124:127], v[64:79]
  s_add_u32 s70, s59, 2
  s_lshl_b32 s55, s58, 12
  s_add_u32 s55, s55, s66
  s_add_u32 s55, s55, 1572864
  s_nop 7
  v_max3_f32 v16, v64, v65, v66
  v_max3_f32 v16, v16, v67, v68
  v_max3_f32 v16, v16, v69, v70
  v_max3_f32 v16, v16, v71, v72
  v_max3_f32 v16, v16, v73, v74
  v_max3_f32 v16, v16, v75, v76
  v_max3_f32 v16, v16, v77, v78
  v_max_f32 v16, v16, v79
  s_waitcnt vmcnt(0)
  s_cmp_eq_u32 s52, 0
  s_cbranch_scc0 AT_m1_d
  s_mov_b32 exec_hi, 0
  s_mov_b32 exec_lo, 1
AT_m1:
  buffer_load_dword v211, v201, s[8:11], s69 offen sc1
  s_add_u32 s65, s65, 1
  s_waitcnt vmcnt(0)
  v_cmp_gt_u32 vcc, s70, v211
  s_cbranch_vccz AT_m1_x
  s_sleep 1
  s_cmp_lt_u32 s65, 131072
  s_cbranch_scc1 AT_m1
AT_m1_x:
  s_mov_b64 exec, -1
AT_m1_d:
  s_barrier
  buffer_load_dwordx2 v[128:129], v218, s[8:11], s55 offen offset:0 sc1
  buffer_load_dwordx2 v[130:131], v218, s[8:11], s55 offen offset:1024 sc1
  buffer_load_dwordx2 v[132:133], v218, s[8:11], s55 offen offset:256 sc1
  buffer_load_dwordx2 v[134:135], v218, s[8:11], s55 offen offset:1280 sc1
  buffer_load_dwordx2 v[136:137], v218, s[8:11], s55 offen offset:512 sc1
  buffer_load_dwordx2 v[138:139], v218, s[8:11], s55 offen offset:1536 sc1
  buffer_load_dwordx2 v[140:141], v218, s[8:11], s55 offen offset:768 sc1
  buffer_load_dwordx2 v[142:143], v218, s[8:11], s55 offen offset:1792 sc1
  buffer_load_dwordx2 v[144:145], v218, s[8:11], s55 offen offset:2048 sc1
  buffer_load_dwordx2 v[146:147], v218, s[8:11], s55 offen offset:3072 sc1
  buffer_load_dwordx2 v[148:149], v218, s[8:11], s55 offen offset:2304 sc1
  buffer_load_dwordx2 v[150:151], v218, s[8:11], s55 offen offset:3328 sc1
  buffer_load_dwordx2 v[152:153], v218, s[8:11], s55 offen offset:2560 sc1
  buffer_load_dwordx2 v[154:155], v218, s[8:11], s55 offen offset:3584 sc1
  buffer_load_dwordx2 v[156:157], v218, s[8:11], s55 offen offset:2816 sc1
  buffer_load_dwordx2 v[158:159], v218, s[8:11], s55 offen offset:3840 sc1
  buffer_load_dword v168, v219, s[8:11], s55 offen offset:0 sc1
  buffer_load_dword v169, v219, s[8:11], s55 offen offset:256 sc1
  s_waitcnt vmcnt(16)
  v_mfma_f32_32x32x16_bf16 v[80:95], v[128:131], v[96:99], 0
  s_waitcnt vmcnt(14)
  v_mfma_f32_32x32x16_bf16 v[80:95], v[132:135], v[100:103], v[80:95]
  s_waitcnt vmcnt(12)
  v_mfma_f32_32x32x16_bf16 v[80:95], v[136:139], v[104:107], v[80:95]
  s_waitcnt vmcnt(10)
  v_mfma_f32_32x32x16_bf16 v[80:95], v[140:143], v[108:111], v[80:95]
  s_waitcnt vmcnt(8)
  v_mfma_f32_32x32x16_bf16 v[80:95], v[144:147], v[112:115], v[80:95]
  s_waitcnt vmcnt(6)
  v_mfma_f32_32x32x16_bf16 v[80:95], v[148:151], v[116:119], v[80:95]
  s_waitcnt vmcnt(4)
  v_mfma_f32_32x32x16_bf16 v[80:95], v[152:155], v[120:123], v[80:95]
  s_waitcnt vmcnt(2)
  v_mfma_f32_32x32x16_bf16 v[80:95], v[156:159], v[124:127], v[80:95]
  s_lshl_b32 s64, s64, 13
  s_lshl_b32 s54, s52, 11
  s_add_u32 s64, s64, s54
  s_add_u32 s64, s64, 46137344
  s_nop 7
  v_mul_f32 v80, s68, v80
  v_mul_f32 v81, s68, v81
  v_mul_f32 v82, s68, v82
  v_mul_f32 v83, s68, v83
  v_max3_f32 v16, v16, v80, v81
  v_max3_f32 v16, v16, v82, v83
  v_mov_b32 v17, v16
  s_nop 1
  v_permlane32_swap_b32 v16, v17
  v_max_f32 v16, v16, v17
  v_sub_f32 v64, v64, v16
  v_sub_f32 v65, v65, v16
  v_sub_f32 v66, v66, v16
  v_sub_f32 v67, v67, v16
  v_sub_f32 v68, v68, v16
  v_sub_f32 v69, v69, v16
  v_sub_f32 v70, v70, v16
  v_sub_f32 v71, v71, v16
  v_sub_f32 v72, v72, v16
  v_sub_f32 v73, v73, v16
  v_sub_f32 v74, v74, v16
  v_sub_f32 v75, v75, v16
  v_sub_f32 v76, v76, v16
  v_sub_f32 v77, v77, v16
  v_sub_f32 v78, v78, v16
  v_sub_f32 v79, v79, v16
  v_sub_f32 v80, v80, v16
  v_sub_f32 v81, v81, v16
  v_sub_f32 v82, v82, v16
  v_sub_f32 v83, v83, v16
  v_exp_f32 v64, v64
  v_exp_f32 v65, v65
  v_exp_f32 v66, v66
  v_exp_f32 v67, v67
  v_exp_f32 v68, v68
  v_exp_f32 v69, v69
  v_exp_f32 v70, v70
  v_exp_f32 v71, v71
  v_exp_f32 v72, v72
  v_exp_f32 v73, v73
  v_exp_f32 v74, v74
  v_exp_f32 v75, v75
  v_exp_f32 v76, v76
  v_exp_f32 v77, v77
  v_exp_f32 v78, v78
  v_exp_f32 v79, v79
  v_exp_f32 v80, v80
  v_exp_f32 v81, v81
  v_exp_f32 v82, v82
  v_exp_f32 v83, v83
  v_cvt_pk_bf16_f32 v20, v64, v65
  v_cvt_pk_bf16_f32 v21, v68, v69
  v_cvt_pk_bf16_f32 v22, v72, v73
  v_cvt_pk_bf16_f32 v23, v76, v77
  v_cvt_pk_bf16_f32 v24, v66, v67
  v_cvt_pk_bf16_f32 v25, v70, v71
  v_cvt_pk_bf16_f32 v26, v74, v75
  v_cvt_pk_bf16_f32 v27, v78, v79
  v_cvt_pk_bf16_f32 v28, v80, v81
  v_cvt_pk_bf16_f32 v29, v82, v83
  v_mfma_f32_32x32x16_bf16 v[0:15], v[160:163], v[20:23], 0
  v_add_f32 v16, v64, v65
  v_add_f32 v16, v16, v66
  v_add_f32 v16, v16, v67
  v_add_f32 v16, v16, v68
  v_add_f32 v16, v16, v69
  v_add_f32 v16, v16, v70
  v_add_f32 v16, v16, v71
  v_mfma_f32_32x32x16_bf16 v[0:15], v[164:167], v[24:27], v[0:15]
  v_add_f32 v16, v16, v72
  v_add_f32 v16, v16, v73
  v_add_f32 v16, v16, v74
  v_add_f32 v16, v16, v75
  v_add_f32 v16, v16, v76
  v_add_f32 v16, v16, v77
  s_waitcnt vmcnt(0)
  v_mfma_f32_32x32x8_bf16 v[0:15], v[168:169], v[28:29], v[0:15]
  v_add_f32 v16, v16, v78
  v_add_f32 v16, v16, v79
  v_add_f32 v16, v16, v80
  v_add_f32 v16, v16, v81
  v_add_f32 v16, v16, v82
  v_add_f32 v16, v16, v83
  v_mov_b32 v17, v16
  s_nop 1
  v_permlane32_swap_b32 v16, v17
  v_add_f32 v16, v16, v17
  v_rcp_f32 v16, v16
  s_nop 0
  v_mul_f32 v0, v16, v0
  v_mul_f32 v1, v16, v1
  v_mul_f32 v2, v16, v2
  v_mul_f32 v3, v16, v3
  v_mul_f32 v4, v16, v4
  v_mul_f32 v5, v16, v5
  v_mul_f32 v6, v16, v6
  v_mul_f32 v7, v16, v7
  v_cvt_pk_bf16_f32 v20, v0, v1
  v_cvt_pk_bf16_f32 v21, v2, v3
  v_cvt_pk_bf16_f32 v22, v4, v5
  v_cvt_pk_bf16_f32 v23, v6, v7
  buffer_store_dwordx4 v[20:23], v201, s[8:11], s64 offen offset:0 sc1
  v_mul_f32 v8, v16, v8
  v_mul_f32 v9, v16, v9
  v_mul_f32 v10, v16, v10
  v_mul_f32 v11, v16, v11
  v_mul_f32 v12, v16, v12
  v_mul_f32 v13, v16, v13
  v_mul_f32 v14, v16, v14
  v_mul_f32 v15, v16, v15
  v_cvt_pk_bf16_f32 v24, v8, v9
  v_cvt_pk_bf16_f32 v25, v10, v11
  v_cvt_pk_bf16_f32 v26, v12, v13
  v_cvt_pk_bf16_f32 v27, v14, v15
  buffer_store_dwordx4 v[24:27], v201, s[8:11], s64 offen offset:1024 sc1
  s_add_u32 s59, s59, 3
  v_mov_b32 v212, s59
  s_waitcnt vmcnt(0)
  s_barrier
  s_cmp_eq_u32 s52, 0
  s_cselect_b32 s54, s71, 268435456
  s_mov_b64 exec, 1
  buffer_store_dword v212, v201, s[8:11], s54 offen sc1
  s_mov_b64 exec, -1
  s_cmp_ge_u32 s59, 64
  s_cbranch_scc1 L_exit
  s_branch AT_loop
W_a:
  s_sub_u32 s54, s53, 96
  s_lshr_b32 s68, s54, 4
  s_and_b32 s69, s54, 15
  s_lshl_b32 s60, s69, 2
  s_sub_u32 s60, s60, 1
  s_max_i32 s60, s60, 0
  s_mul_i32 s60, s60, 36864
  s_add_u32 m0, s67, 0
  s_nop 0
  buffer_load_dwordx4 v202, s[4:7], s60 offen offset:0 lds
  s_add_u32 m0, s67, 896
  s_nop 0
  buffer_load_dwordx4 v202, s[4:7], s60 offen offset:128 lds
  s_add_u32 m0, s67, 1792
  s_nop 0
  buffer_load_dwordx4 v202, s[4:7], s60 offen offset:256 lds
  s_add_u32 m0, s67, 2688
  s_nop 0
  buffer_load_dwordx4 v202, s[4:7], s60 offen offset:384 lds
  s_add_u32 m0, s67, 3584
  s_nop 0
  buffer_load_dwordx4 v202, s[4:7], s60 offen offset:512 lds
  s_add_u32 m0, s67, 4480
  s_nop 0
  buffer_load_dwordx4 v202, s[4:7], s60 offen offset:640 lds
  s_add_u32 m0, s67, 5376
  s_nop 0
  buffer_load_dwordx4 v202, s[4:7], s60 offen offset:768 lds
  s_add_u32 m0, s67, 6272
  s_nop 0
  buffer_load_dwordx4 v202, s[4:7], s60 offen offset:896 lds
  s_add_u32 m0, s67, 7168
  s_nop 0
  buffer_load_dwordx4 v202, s[4:7], s60 offen offset:1024 lds
  v_and_b32 v211, 15, v200
  v_mul_u32_u24 v211, 72, v211
  v_lshrrev_b32 v212, 4, v200
  v_mul_u32_u24 v213, 1152, v212
  v_add_u32 v213, v213, v211
  s_lshl_b32 s54, s54, 2
  s_add_u32 s70, s54, s52
  s_mul_i32 s55, s70, 4608
  buffer_load_dwordx4 v[48:51], v213, s[4:7], s55 offen offset:0
  buffer_load_dwordx4 v[52:55], v213, s[4:7], s55 offen offset:16
  buffer_load_dwordx4 v[56:59], v213, s[4:7], s55 offen offset:32
  buffer_load_dwordx4 v[60:63], v213, s[4:7], s55 offen offset:48
  buffer_load_dwordx2 v[64:65], v213, s[4:7], s55 offen offset:64
  buffer_load_dwordx4 v[68:71], v211, s[44:47], 0 offen offset:0
  buffer_load_dwordx4 v[72:75], v211, s[44:47], 0 offen offset:16
  buffer_load_dwordx4 v[76:79], v211, s[44:47], 0 offen offset:32
  buffer_load_dwordx4 v[80:83], v211, s[44:47], 0 offen offset:48
  buffer_load_dwordx2 v[84:85], v211, s[44:47], 0 offen offset:64
  v_mov_b32 v0, 0
  v_mov_b32 v1, 0x3f803f80
  s_waitcnt vmcnt(9)
  v_lshlrev_b32 v2, 16, v48
  s_waitcnt vmcnt(4)
  v_lshlrev_b32 v3, 16, v68
  v_and_b32 v4, 0xffff0000, v48
  v_and_b32 v5, 0xffff0000, v68
  v_mul_f32 v2, v2, v3
  v_mul_f32 v4, v4, v5
  v_cvt_pk_bf16_f32 v2, v2, v4
  v_lshlrev_b32 v3, 16, v2
  v_and_b32 v4, 0xffff0000, v2
  v_add_f32 v0, v0, v3
  v_add_f32 v0, v0, v4
  v_lshlrev_b32 v2, 16, v49
  v_lshlrev_b32 v3, 16, v69
  v_and_b32 v4, 0xffff0000, v49
  v_and_b32 v5, 0xffff0000, v69
  v_mul_f32 v2, v2, v3
  v_mul_f32 v4, v4, v5
  v_cvt_pk_bf16_f32 v2, v2, v4
  v_lshlrev_b32 v3, 16, v2
  v_and_b32 v4, 0xffff0000, v2
  v_add_f32 v0, v0, v3
  v_add_f32 v0, v0, v4
  v_lshlrev_b32 v2, 16, v50
  v_lshlrev_b32 v3, 16, v70
  v_and_b32 v4, 0xffff0000, v50
  v_and_b32 v5, 0xffff0000, v70
  v_mul_f32 v2, v2, v3
  v_mul_f32 v4, v4, v5
  v_cvt_pk_bf16_f32 v2, v2, v4
  v_lshlrev_b32 v3, 16, v2
  v_and_b32 v4, 0xffff0000, v2
  v_add_f32 v0, v0, v3
  v_add_f32 v0, v0, v4
  v_lshlrev_b32 v2, 16, v51
  v_lshlrev_b32 v3, 16, v71
  v_and_b32 v4, 0xffff0000, v51
  v_and_b32 v5, 0xffff0000, v71
  v_mul_f32 v2, v2, v3
  v_mul_f32 v4, v4, v5
  v_cvt_pk_bf16_f32 v2, v2, v4
  v_lshlrev_b32 v3, 16, v2
  v_and_b32 v4, 0xffff0000, v2
  v_add_f32 v0, v0, v3
  v_add_f32 v0, v0, v4
  v_lshlrev_b32 v2, 16, v52
  s_waitcnt vmcnt(3)
  v_lshlrev_b32 v3, 16, v72
  v_and_b32 v4, 0xffff0000, v52
  v_and_b32 v5, 0xffff0000, v72
  v_mul_f32 v2, v2, v3
  v_mul_f32 v4, v4, v5
  v_cvt_pk_bf16_f32 v2, v2, v4
  v_lshlrev_b32 v3, 16, v2
  v_and_b32 v4, 0xffff0000, v2
  v_add_f32 v0, v0, v3
  v_add_f32 v0, v0, v4
  v_lshlrev_b32 v2, 16, v53
  v_lshlrev_b32 v3, 16, v73
  v_and_b32 v4, 0xffff0000, v53
  v_and_b32 v5, 0xffff0000, v73
  v_mul_f32 v2, v2, v3
  v_mul_f32 v4, v4, v5
  v_cvt_pk_bf16_f32 v2, v2, v4
  v_lshlrev_b32 v3, 16, v2
  v_and_b32 v4, 0xffff0000, v2
  v_add_f32 v0, v0, v3
  v_add_f32 v0, v0, v4
  v_lshlrev_b32 v2, 16, v54
  v_lshlrev_b32 v3, 16, v74
  v_and_b32 v4, 0xffff0000, v54
  v_and_b32 v5, 0xffff0000, v74
  v_mul_f32 v2, v2, v3
  v_mul_f32 v4, v4, v5
  v_cvt_pk_bf16_f32 v2, v2, v4
  v_lshlrev_b32 v3, 16, v2
  v_and_b32 v4, 0xffff0000, v2
  v_add_f32 v0, v0, v3
  v_add_f32 v0, v0, v4
  v_lshlrev_b32 v2, 16, v55
  v_lshlrev_b32 v3, 16, v75
  v_and_b32 v4, 0xffff0000, v55
  v_and_b32 v5, 0xffff0000, v75
  v_mul_f32 v2, v2, v3
  v_mul_f32 v4, v4, v5
  v_cvt_pk_bf16_f32 v2, v2, v4
  v_lshlrev_b32 v3, 16, v2
  v_and_b32 v4, 0xffff0000, v2
  v_add_f32 v0, v0, v3
  v_add_f32 v0, v0, v4
  v_lshlrev_b32 v2, 16, v56
  s_waitcnt vmcnt(2)
  v_lshlrev_b32 v3, 16, v76
  v_and_b32 v4, 0xffff0000, v56
  v_and_b32 v5, 0xffff0000, v76
  v_mul_f32 v2, v2, v3
  v_mul_f32 v4, v4, v5
  v_cvt_pk_bf16_f32 v2, v2, v4
  v_lshlrev_b32 v3, 16, v2
  v_and_b32 v4, 0xffff0000, v2
  v_add_f32 v0, v0, v3
  v_add_f32 v0, v0, v4
  v_lshlrev_b32 v2, 16, v57
  v_lshlrev_b32 v3, 16, v77
  v_and_b32 v4, 0xffff0000, v57
  v_and_b32 v5, 0xffff0000, v77
  v_mul_f32 v2, v2, v3
  v_mul_f32 v4, v4, v5
  v_cvt_pk_bf16_f32 v2, v2, v4
  v_lshlrev_b32 v3, 16, v2
  v_and_b32 v4, 0xffff0000, v2
  v_add_f32 v0, v0, v3
  v_add_f32 v0, v0, v4
  v_lshlrev_b32 v2, 16, v58
  v_lshlrev_b32 v3, 16, v78
  v_and_b32 v4, 0xffff0000, v58
  v_and_b32 v5, 0xffff0000, v78
  v_mul_f32 v2, v2, v3
  v_mul_f32 v4, v4, v5
  v_cvt_pk_bf16_f32 v2, v2, v4
  v_lshlrev_b32 v3, 16, v2
  v_and_b32 v4, 0xffff0000, v2
  v_add_f32 v0, v0, v3
  v_add_f32 v0, v0, v4
  v_lshlrev_b32 v2, 16, v59
  v_lshlrev_b32 v3, 16, v79
  v_and_b32 v4, 0xffff0000, v59
  v_and_b32 v5, 0xffff0000, v79
  v_mul_f32 v2, v2, v3
  v_mul_f32 v4, v4, v5
  v_cvt_pk_bf16_f32 v2, v2, v4
  v_lshlrev_b32 v3, 16, v2
  v_and_b32 v4, 0xffff0000, v2
  v_add_f32 v0, v0, v3
  v_add_f32 v0, v0, v4
  v_lshlrev_b32 v2, 16, v60
  s_waitcnt vmcnt(1)
  v_lshlrev_b32 v3, 16, v80
  v_and_b32 v4, 0xffff0000, v60
  v_and_b32 v5, 0xffff0000, v80
  v_mul_f32 v2, v2, v3
  v_mul_f32 v4, v4, v5
  v_cvt_pk_bf16_f32 v2, v2, v4
  v_lshlrev_b32 v3, 16, v2
  v_and_b32 v4, 0xffff0000, v2
  v_add_f32 v0, v0, v3
  v_add_f32 v0, v0, v4
  v_lshlrev_b32 v2, 16, v61
  v_lshlrev_b32 v3, 16, v81
  v_and_b32 v4, 0xffff0000, v61
  v_and_b32 v5, 0xffff0000, v81
  v_mul_f32 v2, v2, v3
  v_mul_f32 v4, v4, v5
  v_cvt_pk_bf16_f32 v2, v2, v4
  v_lshlrev_b32 v3, 16, v2
  v_and_b32 v4, 0xffff0000, v2
  v_add_f32 v0, v0, v3
  v_add_f32 v0, v0, v4
  v_lshlrev_b32 v2, 16, v62
  v_lshlrev_b32 v3, 16, v82
  v_and_b32 v4, 0xffff0000, v62
  v_and_b32 v5, 0xffff0000, v82
  v_mul_f32 v2, v2, v3
  v_mul_f32 v4, v4, v5
  v_cvt_pk_bf16_f32 v2, v2, v4
  v_lshlrev_b32 v3, 16, v2
  v_and_b32 v4, 0xffff0000, v2
  v_add_f32 v0, v0, v3
  v_add_f32 v0, v0, v4
  v_lshlrev_b32 v2, 16, v63
  v_lshlrev_b32 v3, 16, v83
  v_and_b32 v4, 0xffff0000, v63
  v_and_b32 v5, 0xffff0000, v83
  v_mul_f32 v2, v2, v3
  v_mul_f32 v4, v4, v5
  v_cvt_pk_bf16_f32 v2, v2, v4
  v_lshlrev_b32 v3, 16, v2
  v_and_b32 v4, 0xffff0000, v2
  v_add_f32 v0, v0, v3
  v_add_f32 v0, v0, v4
  v_lshlrev_b32 v2, 16, v64
  s_waitcnt vmcnt(0)
  v_lshlrev_b32 v3, 16, v84
  v_and_b32 v4, 0xffff0000, v64
  v_and_b32 v5, 0xffff0000, v84
  v_mul_f32 v2, v2, v3
  v_mul_f32 v4, v4, v5
  v_cvt_pk_bf16_f32 v2, v2, v4
  v_lshlrev_b32 v3, 16, v2
  v_and_b32 v4, 0xffff0000, v2
  v_add_f32 v0, v0, v3
  v_add_f32 v0, v0, v4
  v_lshlrev_b32 v2, 16, v65
  v_lshlrev_b32 v3, 16, v85
  v_and_b32 v4, 0xffff0000, v65
  v_and_b32 v5, 0xffff0000, v85
  v_mul_f32 v2, v2, v3
  v_mul_f32 v4, v4, v5
  v_cvt_pk_bf16_f32 v2, v2, v4
  v_lshlrev_b32 v3, 16, v2
  v_and_b32 v4, 0xffff0000, v2
  v_add_f32 v0, v0, v3
  v_add_f32 v0, v0, v4
  s_nop 1
  v_add_f32_dpp v0, v0, v0 row_ror:1 row_mask:0xf bank_mask:0xf
  s_nop 1
  v_add_f32_dpp v0, v0, v0 row_ror:2 row_mask:0xf bank_mask:0xf
  s_nop 1
  v_add_f32_dpp v0, v0, v0 row_ror:4 row_mask:0xf bank_mask:0xf
  s_nop 1
  v_add_f32_dpp v0, v0, v0 row_ror:8 row_mask:0xf bank_mask:0xf
  v_cvt_pk_bf16_f32 v0, v0, v0
  v_lshlrev_b32 v0, 16, v0
  v_mul_f32 v0, 3216550459, v0
  v_exp_f32 v0, v0
  s_nop 0
  v_add_f32 v0, 1.0, v0
  v_rcp_f32 v0, v0
  s_nop 0
  v_cvt_pk_bf16_f32 v0, v0, v0
  v_lshlrev_b32 v0, 16, v0
  v_lshlrev_b32 v212, 2, v212
  s_lshl_b32 s55, s70, 4
  s_add_u32 s55, s55, 66060288
  s_mov_b32 exec_lo, 0x00010001
  s_mov_b32 exec_hi, 0x00010001
  buffer_store_dword v0, v212, s[8:11], s55 offen sc1
  s_mov_b64 exec, -1
  v_lshrrev_b32 v211, 4, v200
  v_lshlrev_b32 v212, 2, v211
  v_and_b32 v213, 15, v200
  v_xor_b32 v212, v212, v213
  v_mul_u32_u24 v211, 3456, v211
  v_mov_b32 v2, 0x40000000
  v_add_u32 v213, 0, v212
  v_mul_u32_u24 v214, 57, v213
  v_lshrrev_b32 v214, 9, v214
  v_mul_u32_u24 v214, 1008, v214
  v_lshl_add_u32 v214, v213, 4, v214
  v_add_u32 v214, v214, v211
  v_cmp_lt_u32 vcc, 26, v213
  s_nop 1
  v_cndmask_b32 v207, v214, v2, vcc
  v_add_u32 v213, 16, v212
  v_mul_u32_u24 v214, 57, v213
  v_lshrrev_b32 v214, 9, v214
  v_mul_u32_u24 v214, 1008, v214
  v_lshl_add_u32 v214, v213, 4, v214
  v_add_u32 v214, v214, v211
  v_cmp_lt_u32 vcc, 26, v213
  s_nop 1
  v_cndmask_b32 v208, v214, v2, vcc
  s_mul_i32 s62, s68, 144
  s_mul_i32 s54, s52, 13824
  s_add_u32 s62, s62, s54
  s_waitcnt vmcnt(0)
  s_lshl_b32 s61, s52, 10
  s_add_u32 s61, s61, 36864
  s_add_u32 m0, s61, 0
  s_add_u32 s54, s62, 0
  buffer_load_dwordx4 v207, s[36:39], s54 offen lds
  s_add_u32 m0, s61, 4096
  s_add_u32 s54, s62, 55296
  buffer_load_dwordx4 v207, s[36:39], s54 offen lds
  s_add_u32 m0, s61, 8192
  s_add_u32 s54, s62, 110592
  buffer_load_dwordx4 v207, s[36:39], s54 offen lds
  s_add_u32 m0, s61, 12288
  s_add_u32 s54, s62, 165888
  buffer_load_dwordx4 v207, s[36:39], s54 offen lds
  s_add_u32 m0, s61, 16384
  s_add_u32 s54, s62, 0
  buffer_load_dwordx4 v208, s[36:39], s54 offen lds
  s_add_u32 m0, s61, 20480
  s_add_u32 s54, s62, 55296
  buffer_load_dwordx4 v208, s[36:39], s54 offen lds
  s_add_u32 m0, s61, 24576
  s_add_u32 s54, s62, 110592
  buffer_load_dwordx4 v208, s[36:39], s54 offen lds
  s_add_u32 m0, s61, 28672
  s_add_u32 s54, s62, 165888
  buffer_load_dwordx4 v208, s[36:39], s54 offen lds
  s_add_u32 m0, s61, 32768
  s_add_u32 s54, s62, 221184
  buffer_load_dwordx4 v207, s[36:39], s54 offen lds
  s_add_u32 m0, s61, 36864
  s_add_u32 s54, s62, 276480
  buffer_load_dwordx4 v207, s[36:39], s54 offen lds
  s_add_u32 m0, s61, 40960
  s_add_u32 s54, s62, 331776
  buffer_load_dwordx4 v207, s[36:39], s54 offen lds
  s_add_u32 m0, s61, 45056
  s_add_u32 s54, s62, 387072
  buffer_load_dwordx4 v207, s[36:39], s54 offen lds
  s_add_u32 m0, s61, 49152
  s_add_u32 s54, s62, 221184
  buffer_load_dwordx4 v208, s[36:39], s54 offen lds
  s_add_u32 m0, s61, 53248
  s_add_u32 s54, s62, 276480
  buffer_load_dwordx4 v208, s[36:39], s54 offen lds
  s_add_u32 m0, s61, 57344
  s_add_u32 s54, s62, 331776
  buffer_load_dwordx4 v208, s[36:39], s54 offen lds
  s_add_u32 m0, s61, 61440
  s_add_u32 s54, s62, 387072
  buffer_load_dwordx4 v208, s[36:39], s54 offen lds
  s_add_u32 m0, s61, 65536
  s_add_u32 s54, s62, 442368
  buffer_load_dwordx4 v207, s[36:39], s54 offen lds
  s_add_u32 m0, s61, 69632
  s_add_u32 s54, s62, 497664
  buffer_load_dwordx4 v207, s[36:39], s54 offen lds
  s_add_u32 m0, s61, 73728
  s_add_u32 s54, s62, 552960
  buffer_load_dwordx4 v207, s[36:39], s54 offen lds
  s_add_u32 m0, s61, 77824
  s_add_u32 s54, s62, 608256
  buffer_load_dwordx4 v207, s[36:39], s54 offen lds
  s_add_u32 m0, s61, 81920
  s_add_u32 s54, s62, 442368
  buffer_load_dwordx4 v208, s[36:39], s54 offen lds
  s_add_u32 m0, s61, 86016
  s_add_u32 s54, s62, 497664
  buffer_load_dwordx4 v208, s[36:39], s54 offen lds
  s_add_u32 m0, s61, 90112
  s_add_u32 s54, s62, 552960
  buffer_load_dwordx4 v208, s[36:39], s54 offen lds
  s_add_u32 m0, s61, 94208
  s_add_u32 s54, s62, 608256
  buffer_load_dwordx4 v208, s[36:39], s54 offen lds
  s_waitcnt vmcnt(20) lgkmcnt(0)
  s_barrier
  s_add_u32 m0, s61, 98304
  s_add_u32 s54, s62, 663552
  buffer_load_dwordx4 v207, s[36:39], s54 offen lds
  s_add_u32 m0, s61, 102400
  s_add_u32 s54, s62, 718848
  buffer_load_dwordx4 v207, s[36:39], s54 offen lds
  s_add_u32 m0, s61, 106496
  s_add_u32 s54, s62, 774144
  buffer_load_dwordx4 v207, s[36:39], s54 offen lds
  s_add_u32 m0, s61, 110592
  s_add_u32 s54, s62, 829440
  buffer_load_dwordx4 v207, s[36:39], s54 offen lds
  v_add_u32 v215, 36864, v210
  ds_read_b64_tr_b16 a[0:1], v215 offset:0
  ds_read_b64_tr_b16 a[2:3], v215 offset:1024
  ds_read_b64_tr_b16 a[4:5], v215 offset:4096
  ds_read_b64_tr_b16 a[6:7], v215 offset:5120
  ds_read_b64_tr_b16 a[8:9], v215 offset:8192
  ds_read_b64_tr_b16 a[10:11], v215 offset:9216
  ds_read_b64_tr_b16 a[12:13], v215 offset:12288
  ds_read_b64_tr_b16 a[14:15], v215 offset:13312
  s_waitcnt vmcnt(20) lgkmcnt(0)
  s_barrier
  s_add_u32 m0, s61, 0
  s_add_u32 s54, s62, 663552
  buffer_load_dwordx4 v208, s[36:39], s54 offen lds
  s_add_u32 m0, s61, 4096
  s_add_u32 s54, s62, 718848
  buffer_load_dwordx4 v208, s[36:39], s54 offen lds
  s_add_u32 m0, s61, 8192
  s_add_u32 s54, s62, 774144
  buffer_load_dwordx4 v208, s[36:39], s54 offen lds
  s_add_u32 m0, s61, 12288
  s_add_u32 s54, s62, 829440
  buffer_load_dwordx4 v208, s[36:39], s54 offen lds
  v_add_u32 v215, 53248, v210
  ds_read_b64_tr_b16 a[144:145], v215 offset:0
  ds_read_b64_tr_b16 a[146:147], v215 offset:1024
  ds_read_b64_tr_b16 a[148:149], v215 offset:4096
  ds_read_b64_tr_b16 a[150:151], v215 offset:5120
  ds_read_b64_tr_b16 a[152:153], v215 offset:8192
  ds_read_b64_tr_b16 a[154:155], v215 offset:9216
  ds_read_b64_tr_b16 a[156:157], v215 offset:12288
  ds_read_b64_tr_b16 a[158:159], v215 offset:13312
  s_waitcnt vmcnt(20) lgkmcnt(0)
  s_barrier
  s_add_u32 m0, s61, 16384
  s_add_u32 s54, s62, 884736
  buffer_load_dwordx4 v207, s[36:39], s54 offen lds
  s_add_u32 m0, s61, 20480
  s_add_u32 s54, s62, 940032
  buffer_load_dwordx4 v207, s[36:39], s54 offen lds
  s_add_u32 m0, s61, 24576
  s_add_u32 s54, s62, 995328
  buffer_load_dwordx4 v207, s[36:39], s54 offen lds
  s_add_u32 m0, s61, 28672
  s_add_u32 s54, s62, 1050624
  buffer_load_dwordx4 v207, s[36:39], s54 offen lds
  v_add_u32 v215, 69632, v210
  ds_read_b64_tr_b16 a[16:17], v215 offset:0
  ds_read_b64_tr_b16 a[18:19], v215 offset:1024
  ds_read_b64_tr_b16 a[20:21], v215 offset:4096
  ds_read_b64_tr_b16 a[22:23], v215 offset:5120
  ds_read_b64_tr_b16 a[24:25], v215 offset:8192
  ds_read_b64_tr_b16 a[26:27], v215 offset:9216
  ds_read_b64_tr_b16 a[28:29], v215 offset:12288
  ds_read_b64_tr_b16 a[30:31], v215 offset:13312
  s_waitcnt vmcnt(20) lgkmcnt(0)
  s_barrier
  s_add_u32 m0, s61, 32768
  s_add_u32 s54, s62, 884736
  buffer_load_dwordx4 v208, s[36:39], s54 offen lds
  s_add_u32 m0, s61, 36864
  s_add_u32 s54, s62, 940032
  buffer_load_dwordx4 v208, s[36:39], s54 offen lds
  s_add_u32 m0, s61, 40960
  s_add_u32 s54, s62, 995328
  buffer_load_dwordx4 v208, s[36:39], s54 offen lds
  s_add_u32 m0, s61, 45056
  s_add_u32 s54, s62, 1050624
  buffer_load_dwordx4 v208, s[36:39], s54 offen lds
  v_add_u32 v215, 86016, v210
  ds_read_b64_tr_b16 a[160:161], v215 offset:0
  ds_read_b64_tr_b16 a[162:163], v215 offset:1024
  ds_read_b64_tr_b16 a[164:165], v215 offset:4096
  ds_read_b64_tr_b16 a[166:167], v215 offset:5120
  ds_read_b64_tr_b16 a[168:169], v215 offset:8192
  ds_read_b64_tr_b16 a[170:171], v215 offset:9216
  ds_read_b64_tr_b16 a[172:173], v215 offset:12288
  ds_read_b64_tr_b16 a[174:175], v215 offset:13312
  s_waitcnt vmcnt(20) lgkmcnt(0)
  s_barrier
  s_add_u32 m0, s61, 49152
  s_add_u32 s54, s62, 1105920
  buffer_load_dwordx4 v207, s[36:39], s54 offen lds
  s_add_u32 m0, s61, 53248
  s_add_u32 s54, s62, 1161216
  buffer_load_dwordx4 v207, s[36:39], s54 offen lds
  s_add_u32 m0, s61, 57344
  s_add_u32 s54, s62, 1216512
  buffer_load_dwordx4 v207, s[36:39], s54 offen lds
  s_add_u32 m0, s61, 61440
  s_add_u32 s54, s62, 1271808
  buffer_load_dwordx4 v207, s[36:39], s54 offen lds
  v_add_u32 v215, 102400, v210
  ds_read_b64_tr_b16 a[32:33], v215 offset:0
  ds_read_b64_tr_b16 a[34:35], v215 offset:1024
  ds_read_b64_tr_b16 a[36:37], v215 offset:4096
  ds_read_b64_tr_b16 a[38:39], v215 offset:5120
  ds_read_b64_tr_b16 a[40:41], v215 offset:8192
  ds_read_b64_tr_b16 a[42:43], v215 offset:9216
  ds_read_b64_tr_b16 a[44:45], v215 offset:12288
  ds_read_b64_tr_b16 a[46:47], v215 offset:13312
  s_waitcnt vmcnt(20) lgkmcnt(0)
  s_barrier
  s_add_u32 m0, s61, 65536
  s_add_u32 s54, s62, 1105920
  buffer_load_dwordx4 v208, s[36:39], s54 offen lds
  s_add_u32 m0, s61, 69632
  s_add_u32 s54, s62, 1161216
  buffer_load_dwordx4 v208, s[36:39], s54 offen lds
  s_add_u32 m0, s61, 73728
  s_add_u32 s54, s62, 1216512
  buffer_load_dwordx4 v208, s[36:39], s54 offen lds
  s_add_u32 m0, s61, 77824
  s_add_u32 s54, s62, 1271808
  buffer_load_dwordx4 v208, s[36:39], s54 offen lds
  v_add_u32 v215, 118784, v210
  ds_read_b64_tr_b16 a[176:177], v215 offset:0
  ds_read_b64_tr_b16 a[178:179], v215 offset:1024
  ds_read_b64_tr_b16 a[180:181], v215 offset:4096
  ds_read_b64_tr_b16 a[182:183], v215 offset:5120
  ds_read_b64_tr_b16 a[184:185], v215 offset:8192
  ds_read_b64_tr_b16 a[186:187], v215 offset:9216
  ds_read_b64_tr_b16 a[188:189], v215 offset:12288
  ds_read_b64_tr_b16 a[190:191], v215 offset:13312
  s_waitcnt vmcnt(20) lgkmcnt(0)
  s_barrier
  s_add_u32 m0, s61, 81920
  s_add_u32 s54, s62, 1327104
  buffer_load_dwordx4 v207, s[36:39], s54 offen lds
  s_add_u32 m0, s61, 86016
  s_add_u32 s54, s62, 1382400
  buffer_load_dwordx4 v207, s[36:39], s54 offen lds
  s_add_u32 m0, s61, 90112
  s_add_u32 s54, s62, 1437696
  buffer_load_dwordx4 v207, s[36:39], s54 offen lds
  s_add_u32 m0, s61, 94208
  s_add_u32 s54, s62, 1492992
  buffer_load_dwordx4 v207, s[36:39], s54 offen lds
  v_add_u32 v215, 135168, v210
  ds_read_b64_tr_b16 a[48:49], v215 offset:0
  ds_read_b64_tr_b16 a[50:51], v215 offset:1024
  ds_read_b64_tr_b16 a[52:53], v215 offset:4096
  ds_read_b64_tr_b16 a[54:55], v215 offset:5120
  ds_read_b64_tr_b16 a[56:57], v215 offset:8192
  ds_read_b64_tr_b16 a[58:59], v215 offset:9216
  ds_read_b64_tr_b16 a[60:61], v215 offset:12288
  ds_read_b64_tr_b16 a[62:63], v215 offset:13312
  s_waitcnt vmcnt(20) lgkmcnt(0)
  s_barrier
  s_add_u32 m0, s61, 98304
  s_add_u32 s54, s62, 1327104
  buffer_load_dwordx4 v208, s[36:39], s54 offen lds
  s_add_u32 m0, s61, 102400
  s_add_u32 s54, s62, 1382400
  buffer_load_dwordx4 v208, s[36:39], s54 offen lds
  s_add_u32 m0, s61, 106496
  s_add_u32 s54, s62, 1437696
  buffer_load_dwordx4 v208, s[36:39], s54 offen lds
  s_add_u32 m0, s61, 110592
  s_add_u32 s54, s62, 1492992
  buffer_load_dwordx4 v208, s[36:39], s54 offen lds
  v_add_u32 v215, 36864, v210
  ds_read_b64_tr_b16 a[192:193], v215 offset:0
  ds_read_b64_tr_b16 a[194:195], v215 offset:1024
  ds_read_b64_tr_b16 a[196:197], v215 offset:4096
  ds_read_b64_tr_b16 a[198:199], v215 offset:5120
  ds_read_b64_tr_b16 a[200:201], v215 offset:8192
  ds_read_b64_tr_b16 a[202:203], v215 offset:9216
  ds_read_b64_tr_b16 a[204:205], v215 offset:12288
  ds_read_b64_tr_b16 a[206:207], v215 offset:13312
  s_waitcnt vmcnt(20) lgkmcnt(0)
  s_barrier
  s_add_u32 m0, s61, 0
  s_add_u32 s54, s62, 1548288
  buffer_load_dwordx4 v207, s[36:39], s54 offen lds
  s_add_u32 m0, s61, 4096
  s_add_u32 s54, s62, 1603584
  buffer_load_dwordx4 v207, s[36:39], s54 offen lds
  s_add_u32 m0, s61, 8192
  s_add_u32 s54, s62, 1658880
  buffer_load_dwordx4 v207, s[36:39], s54 offen lds
  s_add_u32 m0, s61, 12288
  s_add_u32 s54, s62, 1714176
  buffer_load_dwordx4 v207, s[36:39], s54 offen lds
  v_add_u32 v215, 53248, v210
  ds_read_b64_tr_b16 a[64:65], v215 offset:0
  ds_read_b64_tr_b16 a[66:67], v215 offset:1024
  ds_read_b64_tr_b16 a[68:69], v215 offset:4096
  ds_read_b64_tr_b16 a[70:71], v215 offset:5120
  ds_read_b64_tr_b16 a[72:73], v215 offset:8192
  ds_read_b64_tr_b16 a[74:75], v215 offset:9216
  ds_read_b64_tr_b16 a[76:77], v215 offset:12288
  ds_read_b64_tr_b16 a[78:79], v215 offset:13312
  s_waitcnt vmcnt(20) lgkmcnt(0)
  s_barrier
  s_add_u32 m0, s61, 16384
  s_add_u32 s54, s62, 1548288
  buffer_load_dwordx4 v208, s[36:39], s54 offen lds
  s_add_u32 m0, s61, 20480
  s_add_u32 s54, s62, 1603584
  buffer_load_dwordx4 v208, s[36:39], s54 offen lds
  s_add_u32 m0, s61, 24576
  s_add_u32 s54, s62, 1658880
  buffer_load_dwordx4 v208, s[36:39], s54 offen lds
  s_add_u32 m0, s61, 28672
  s_add_u32 s54, s62, 1714176
  buffer_load_dwordx4 v208, s[36:39], s54 offen lds
  v_add_u32 v215, 69632, v210
  ds_read_b64_tr_b16 a[208:209], v215 offset:0
  ds_read_b64_tr_b16 a[210:211], v215 offset:1024
  ds_read_b64_tr_b16 a[212:213], v215 offset:4096
  ds_read_b64_tr_b16 a[214:215], v215 offset:5120
  ds_read_b64_tr_b16 a[216:217], v215 offset:8192
  ds_read_b64_tr_b16 a[218:219], v215 offset:9216
  ds_read_b64_tr_b16 a[220:221], v215 offset:12288
  ds_read_b64_tr_b16 a[222:223], v215 offset:13312
  s_waitcnt vmcnt(20) lgkmcnt(0)
  s_barrier
  s_add_u32 m0, s61, 32768
  s_add_u32 s54, s62, 1769472
  buffer_load_dwordx4 v207, s[36:39], s54 offen lds
  s_add_u32 m0, s61, 36864
  s_add_u32 s54, s62, 1824768
  buffer_load_dwordx4 v207, s[36:39], s54 offen lds
  s_add_u32 m0, s61, 40960
  s_add_u32 s54, s62, 1880064
  buffer_load_dwordx4 v207, s[36:39], s54 offen lds
  s_add_u32 m0, s61, 45056
  s_add_u32 s54, s62, 1935360
  buffer_load_dwordx4 v207, s[36:39], s54 offen lds
  v_add_u32 v215, 86016, v210
  ds_read_b64_tr_b16 a[80:81], v215 offset:0
  ds_read_b64_tr_b16 a[82:83], v215 offset:1024
  ds_read_b64_tr_b16 a[84:85], v215 offset:4096
  ds_read_b64_tr_b16 a[86:87], v215 offset:5120
  ds_read_b64_tr_b16 a[88:89], v215 offset:8192
  ds_read_b64_tr_b16 a[90:91], v215 offset:9216
  ds_read_b64_tr_b16 a[92:93], v215 offset:12288
  ds_read_b64_tr_b16 a[94:95], v215 offset:13312
  s_waitcnt vmcnt(20) lgkmcnt(0)
  s_barrier
  s_add_u32 m0, s61, 49152
  s_add_u32 s54, s62, 1769472
  buffer_load_dwordx4 v208, s[36:39], s54 offen lds
  s_add_u32 m0, s61, 53248
  s_add_u32 s54, s62, 1824768
  buffer_load_dwordx4 v208, s[36:39], s54 offen lds
  s_add_u32 m0, s61, 57344
  s_add_u32 s54, s62, 1880064
  buffer_load_dwordx4 v208, s[36:39], s54 offen lds
  s_add_u32 m0, s61, 61440
  s_add_u32 s54, s62, 1935360
  buffer_load_dwordx4 v208, s[36:39], s54 offen lds
  v_add_u32 v215, 102400, v210
  ds_read_b64_tr_b16 a[224:225], v215 offset:0
  ds_read_b64_tr_b16 a[226:227], v215 offset:1024
  ds_read_b64_tr_b16 a[228:229], v215 offset:4096
  ds_read_b64_tr_b16 a[230:231], v215 offset:5120
  ds_read_b64_tr_b16 a[232:233], v215 offset:8192
  ds_read_b64_tr_b16 a[234:235], v215 offset:9216
  ds_read_b64_tr_b16 a[236:237], v215 offset:12288
  ds_read_b64_tr_b16 a[238:239], v215 offset:13312
  s_waitcnt vmcnt(20) lgkmcnt(0)
  s_barrier
  v_add_u32 v215, 118784, v210
  ds_read_b64_tr_b16 a[96:97], v215 offset:0
  ds_read_b64_tr_b16 a[98:99], v215 offset:1024
  ds_read_b64_tr_b16 a[100:101], v215 offset:4096
  ds_read_b64_tr_b16 a[102:103], v215 offset:5120
  ds_read_b64_tr_b16 a[104:105], v215 offset:8192
  ds_read_b64_tr_b16 a[106:107], v215 offset:9216
  ds_read_b64_tr_b16 a[108:109], v215 offset:12288
  ds_read_b64_tr_b16 a[110:111], v215 offset:13312
  s_waitcnt vmcnt(16) lgkmcnt(0)
  s_barrier
  v_add_u32 v215, 135168, v210
  ds_read_b64_tr_b16 a[240:241], v215 offset:0
  ds_read_b64_tr_b16 a[242:243], v215 offset:1024
  ds_read_b64_tr_b16 a[244:245], v215 offset:4096
  ds_read_b64_tr_b16 a[246:247], v215 offset:5120
  ds_read_b64_tr_b16 a[248:249], v215 offset:8192
  ds_read_b64_tr_b16 a[250:251], v215 offset:9216
  ds_read_b64_tr_b16 a[252:253], v215 offset:12288
  ds_read_b64_tr_b16 a[254:255], v215 offset:13312
  s_waitcnt vmcnt(12) lgkmcnt(0)
  s_barrier
  v_add_u32 v215, 36864, v210
  ds_read_b64_tr_b16 a[112:113], v215 offset:0
  ds_read_b64_tr_b16 a[114:115], v215 offset:1024
  ds_read_b64_tr_b16 a[116:117], v215 offset:4096
  ds_read_b64_tr_b16 a[118:119], v215 offset:5120
  ds_read_b64_tr_b16 a[120:121], v215 offset:8192
  ds_read_b64_tr_b16 a[122:123], v215 offset:9216
  ds_read_b64_tr_b16 a[124:125], v215 offset:12288
  ds_read_b64_tr_b16 a[126:127], v215 offset:13312
  s_waitcnt vmcnt(8) lgkmcnt(0)
  s_barrier
  v_add_u32 v215, 53248, v210
  ds_read_b64_tr_b16 v[224:225], v215 offset:0
  ds_read_b64_tr_b16 v[226:227], v215 offset:1024
  ds_read_b64_tr_b16 v[228:229], v215 offset:4096
  ds_read_b64_tr_b16 v[230:231], v215 offset:5120
  ds_read_b64_tr_b16 v[232:233], v215 offset:8192
  ds_read_b64_tr_b16 v[234:235], v215 offset:9216
  ds_read_b64_tr_b16 v[236:237], v215 offset:12288
  ds_read_b64_tr_b16 v[238:239], v215 offset:13312
  s_waitcnt vmcnt(4) lgkmcnt(0)
  s_barrier
  v_add_u32 v215, 69632, v210
  ds_read_b64_tr_b16 a[128:129], v215 offset:0
  ds_read_b64_tr_b16 a[130:131], v215 offset:1024
  ds_read_b64_tr_b16 a[132:133], v215 offset:4096
  ds_read_b64_tr_b16 a[134:135], v215 offset:5120
  ds_read_b64_tr_b16 a[136:137], v215 offset:8192
  ds_read_b64_tr_b16 a[138:139], v215 offset:9216
  ds_read_b64_tr_b16 a[140:141], v215 offset:12288
  ds_read_b64_tr_b16 a[142:143], v215 offset:13312
  s_waitcnt vmcnt(0) lgkmcnt(0)
  s_barrier
  v_add_u32 v215, 86016, v210
  ds_read_b64_tr_b16 v[240:241], v215 offset:0
  ds_read_b64_tr_b16 v[242:243], v215 offset:1024
  ds_read_b64_tr_b16 v[244:245], v215 offset:4096
  ds_read_b64_tr_b16 v[246:247], v215 offset:5120
  ds_read_b64_tr_b16 v[248:249], v215 offset:8192
  ds_read_b64_tr_b16 v[250:251], v215 offset:9216
  ds_read_b64_tr_b16 v[252:253], v215 offset:12288
  ds_read_b64_tr_b16 v[254:255], v215 offset:13312
  s_waitcnt lgkmcnt(0)
  s_barrier
  v_and_b32 v211, 31, v200
  v_mul_u32_u24 v218, 516, v211
  v_lshrrev_b32 v212, 5, v200
  v_lshl_add_u32 v218, v212, 3, v218
  s_lshl_b32 s54, s52, 6
  s_add_u32 s54, s54, 73728
  v_add_u32 v218, s54, v218
  s_lshl_b32 s60, s69, 2
  s_mul_i32 s60, s60, 36864
  s_add_u32 m0, s67, 36864
  s_nop 0
  buffer_load_dwordx4 v202, s[4:7], s60 offen offset:0 lds
  s_add_u32 m0, s67, 37760
  s_nop 0
  buffer_load_dwordx4 v202, s[4:7], s60 offen offset:128 lds
  s_add_u32 m0, s67, 38656
  s_nop 0
  buffer_load_dwordx4 v202, s[4:7], s60 offen offset:256 lds
  s_add_u32 m0, s67, 39552
  s_nop 0
  buffer_load_dwordx4 v202, s[4:7], s60 offen offset:384 lds
  s_add_u32 m0, s67, 40448
  s_nop 0
  buffer_load_dwordx4 v202, s[4:7], s60 offen offset:512 lds
  s_add_u32 m0, s67, 41344
  s_nop 0
  buffer_load_dwordx4 v202, s[4:7], s60 offen offset:640 lds
  s_add_u32 m0, s67, 42240
  s_nop 0
  buffer_load_dwordx4 v202, s[4:7], s60 offen offset:768 lds
  s_add_u32 m0, s67, 43136
  s_nop 0
  buffer_load_dwordx4 v202, s[4:7], s60 offen offset:896 lds
  s_add_u32 m0, s67, 44032
  s_nop 0
  buffer_load_dwordx4 v202, s[4:7], s60 offen offset:1024 lds
  s_add_u32 s60, s60, 36864
  ds_read_b128 v[32:35], v203 offset:0
  ds_read_b128 v[36:39], v204 offset:0
  ds_read_b128 v[40:43], v205 offset:0
  s_waitcnt lgkmcnt(2)
  v_mfma_f32_32x32x16_bf16 v[0:15], a[0:3], v[32:35], 0
  ds_read_b128 v[44:47], v206 offset:0
  v_mfma_f32_32x32x16_bf16 v[16:31], a[144:147], v[32:35], 0
  s_waitcnt lgkmcnt(2)
  v_mfma_f32_32x32x16_bf16 v[0:15], a[4:7], v[36:39], v[0:15]
  ds_read_b128 v[32:35], v203 offset:1024
  v_mfma_f32_32x32x16_bf16 v[16:31], a[148:151], v[36:39], v[16:31]
  s_waitcnt lgkmcnt(2)
  v_mfma_f32_32x32x16_bf16 v[0:15], a[8:11], v[40:43], v[0:15]
  ds_read_b128 v[36:39], v204 offset:1024
  v_mfma_f32_32x32x16_bf16 v[16:31], a[152:155], v[40:43], v[16:31]
  s_waitcnt lgkmcnt(2)
  v_mfma_f32_32x32x16_bf16 v[0:15], a[12:15], v[44:47], v[0:15]
  ds_read_b128 v[40:43], v205 offset:1024
  v_mfma_f32_32x32x16_bf16 v[16:31], a[156:159], v[44:47], v[16:31]
  s_waitcnt lgkmcnt(2)
  v_mfma_f32_32x32x16_bf16 v[0:15], a[16:19], v[32:35], v[0:15]
  ds_read_b128 v[44:47], v206 offset:1024
  v_mfma_f32_32x32x16_bf16 v[16:31], a[160:163], v[32:35], v[16:31]
  s_waitcnt lgkmcnt(2)
  v_mfma_f32_32x32x16_bf16 v[0:15], a[20:23], v[36:39], v[0:15]
  ds_read_b128 v[32:35], v203 offset:2048
  v_mfma_f32_32x32x16_bf16 v[16:31], a[164:167], v[36:39], v[16:31]
  s_waitcnt lgkmcnt(2)
  v_mfma_f32_32x32x16_bf16 v[0:15], a[24:27], v[40:43], v[0:15]
  ds_read_b128 v[36:39], v204 offset:2048
  v_mfma_f32_32x32x16_bf16 v[16:31], a[168:171], v[40:43], v[16:31]
  s_waitcnt lgkmcnt(2)
  v_mfma_f32_32x32x16_bf16 v[0:15], a[28:31], v[44:47], v[0:15]
  ds_read_b128 v[40:43], v205 offset:2048
  v_mfma_f32_32x32x16_bf16 v[16:31], a[172:175], v[44:47], v[16:31]
  s_waitcnt lgkmcnt(2)
  v_mfma_f32_32x32x16_bf16 v[0:15], a[32:35], v[32:35], v[0:15]
  ds_read_b128 v[44:47], v206 offset:2048
  v_mfma_f32_32x32x16_bf16 v[16:31], a[176:179], v[32:35], v[16:31]
  s_waitcnt lgkmcnt(2)
  v_mfma_f32_32x32x16_bf16 v[0:15], a[36:39], v[36:39], v[0:15]
  ds_read_b128 v[32:35], v203 offset:3072
  v_mfma_f32_32x32x16_bf16 v[16:31], a[180:183], v[36:39], v[16:31]
  s_waitcnt lgkmcnt(2)
  v_mfma_f32_32x32x16_bf16 v[0:15], a[40:43], v[40:43], v[0:15]
  ds_read_b128 v[36:39], v204 offset:3072
  v_mfma_f32_32x32x16_bf16 v[16:31], a[184:187], v[40:43], v[16:31]
  s_waitcnt lgkmcnt(2)
  v_mfma_f32_32x32x16_bf16 v[0:15], a[44:47], v[44:47], v[0:15]
  ds_read_b128 v[40:43], v205 offset:3072
  v_mfma_f32_32x32x16_bf16 v[16:31], a[188:191], v[44:47], v[16:31]
  s_waitcnt lgkmcnt(2)
  v_mfma_f32_32x32x16_bf16 v[0:15], a[48:51], v[32:35], v[0:15]
  ds_read_b128 v[44:47], v206 offset:3072
  v_mfma_f32_32x32x16_bf16 v[16:31], a[192:195], v[32:35], v[16:31]
  s_waitcnt lgkmcnt(2)
  v_mfma_f32_32x32x16_bf16 v[0:15], a[52:55], v[36:39], v[0:15]
  ds_read_b128 v[32:35], v203 offset:4096
  v_mfma_f32_32x32x16_bf16 v[16:31], a[196:199], v[36:39], v[16:31]
  s_waitcnt lgkmcnt(2)
  v_mfma_f32_32x32x16_bf16 v[0:15], a[56:59], v[40:43], v[0:15]
  ds_read_b128 v[36:39], v204 offset:4096
  v_mfma_f32_32x32x16_bf16 v[16:31], a[200:203], v[40:43], v[16:31]
  s_waitcnt lgkmcnt(2)
  v_mfma_f32_32x32x16_bf16 v[0:15], a[60:63], v[44:47], v[0:15]
  ds_read_b128 v[40:43], v205 offset:4096
  v_mfma_f32_32x32x16_bf16 v[16:31], a[204:207], v[44:47], v[16:31]
  s_waitcnt lgkmcnt(2)
  v_mfma_f32_32x32x16_bf16 v[0:15], a[64:67], v[32:35], v[0:15]
  ds_read_b128 v[44:47], v206 offset:4096
  v_mfma_f32_32x32x16_bf16 v[16:31], a[208:211], v[32:35], v[16:31]
  s_waitcnt lgkmcnt(2)
  v_mfma_f32_32x32x16_bf16 v[0:15], a[68:71], v[36:39], v[0:15]
  ds_read_b128 v[32:35], v203 offset:5120
  v_mfma_f32_32x32x16_bf16 v[16:31], a[212:215], v[36:39], v[16:31]
  s_waitcnt lgkmcnt(2)
  v_mfma_f32_32x32x16_bf16 v[0:15], a[72:75], v[40:43], v[0:15]
  ds_read_b128 v[36:39], v204 offset:5120
  v_mfma_f32_32x32x16_bf16 v[16:31], a[216:219], v[40:43], v[16:31]
  s_waitcnt lgkmcnt(2)
  v_mfma_f32_32x32x16_bf16 v[0:15], a[76:79], v[44:47], v[0:15]
  ds_read_b128 v[40:43], v205 offset:5120
  v_mfma_f32_32x32x16_bf16 v[16:31], a[220:223], v[44:47], v[16:31]
  s_waitcnt lgkmcnt(2)
  v_mfma_f32_32x32x16_bf16 v[0:15], a[80:83], v[32:35], v[0:15]
  ds_read_b128 v[44:47], v206 offset:5120
  v_mfma_f32_32x32x16_bf16 v[16:31], a[224:227], v[32:35], v[16:31]
  s_waitcnt lgkmcnt(2)
  v_mfma_f32_32x32x16_bf16 v[0:15], a[84:87], v[36:39], v[0:15]
  ds_read_b128 v[32:35], v203 offset:6144
  v_mfma_f32_32x32x16_bf16 v[16:31], a[228:231], v[36:39], v[16:31]
  s_waitcnt lgkmcnt(2)
  v_mfma_f32_32x32x16_bf16 v[0:15], a[88:91], v[40:43], v[0:15]
  ds_read_b128 v[36:39], v204 offset:6144
  v_mfma_f32_32x32x16_bf16 v[16:31], a[232:235], v[40:43], v[16:31]
  s_waitcnt lgkmcnt(2)
  v_mfma_f32_32x32x16_bf16 v[0:15], a[92:95], v[44:47], v[0:15]
  ds_read_b128 v[40:43], v205 offset:6144
  v_mfma_f32_32x32x16_bf16 v[16:31], a[236:239], v[44:47], v[16:31]
  s_waitcnt lgkmcnt(2)
  v_mfma_f32_32x32x16_bf16 v[0:15], a[96:99], v[32:35], v[0:15]
  ds_read_b128 v[44:47], v206 offset:6144
  v_mfma_f32_32x32x16_bf16 v[16:31], a[240:243], v[32:35], v[16:31]
  s_waitcnt lgkmcnt(2)
  v_mfma_f32_32x32x16_bf16 v[0:15], a[100:103], v[36:39], v[0:15]
  ds_read_b128 v[32:35], v203 offset:7168
  v_mfma_f32_32x32x16_bf16 v[16:31], a[244:247], v[36:39], v[16:31]
  s_waitcnt lgkmcnt(2)
  v_mfma_f32_32x32x16_bf16 v[0:15], a[104:107], v[40:43], v[0:15]
  ds_read_b128 v[36:39], v204 offset:7168
  v_mfma_f32_32x32x16_bf16 v[16:31], a[248:251], v[40:43], v[16:31]
  s_waitcnt lgkmcnt(2)
  v_mfma_f32_32x32x16_bf16 v[0:15], a[108:111], v[44:47], v[0:15]
  ds_read_b128 v[40:43], v205 offset:7168
  v_mfma_f32_32x32x16_bf16 v[16:31], a[252:255], v[44:47], v[16:31]
  s_waitcnt lgkmcnt(2)
  v_mfma_f32_32x32x16_bf16 v[0:15], a[112:115], v[32:35], v[0:15]
  ds_read_b128 v[44:47], v206 offset:7168
  v_mfma_f32_32x32x16_bf16 v[16:31], v[224:227], v[32:35], v[16:31]
  s_waitcnt lgkmcnt(2)
  v_mfma_f32_32x32x16_bf16 v[0:15], a[116:119], v[36:39], v[0:15]
  ds_read_b128 v[32:35], v203 offset:8192
  v_mfma_f32_32x32x16_bf16 v[16:31], v[228:231], v[36:39], v[16:31]
  s_waitcnt lgkmcnt(2)
  v_mfma_f32_32x32x16_bf16 v[0:15], a[120:123], v[40:43], v[0:15]
  ds_read_b128 v[36:39], v204 offset:8192
  v_mfma_f32_32x32x16_bf16 v[16:31], v[232:235], v[40:43], v[16:31]
  s_waitcnt lgkmcnt(2)
  v_mfma_f32_32x32x16_bf16 v[0:15], a[124:127], v[44:47], v[0:15]
  ds_read_b128 v[40:43], v205 offset:8192
  v_mfma_f32_32x32x16_bf16 v[16:31], v[236:239], v[44:47], v[16:31]
  s_waitcnt lgkmcnt(2)
  v_mfma_f32_32x32x16_bf16 v[0:15], a[128:131], v[32:35], v[0:15]
  ds_read_b128 v[44:47], v206 offset:8192
  v_mfma_f32_32x32x16_bf16 v[16:31], v[240:243], v[32:35], v[16:31]
  s_waitcnt lgkmcnt(2)
  v_mfma_f32_32x32x16_bf16 v[0:15], a[132:135], v[36:39], v[0:15]
  v_mfma_f32_32x32x16_bf16 v[16:31], v[244:247], v[36:39], v[16:31]
  s_waitcnt lgkmcnt(1)
  v_mfma_f32_32x32x16_bf16 v[0:15], a[136:139], v[40:43], v[0:15]
  v_mfma_f32_32x32x16_bf16 v[16:31], v[248:251], v[40:43], v[16:31]
  s_waitcnt lgkmcnt(0)
  v_mfma_f32_32x32x16_bf16 v[0:15], a[140:143], v[44:47], v[0:15]
  v_mfma_f32_32x32x16_bf16 v[16:31], v[252:255], v[44:47], v[16:31]
  s_nop 3
  v_cvt_pk_bf16_f32 v48, v0, v1
  v_cvt_pk_bf16_f32 v49, v2, v3
  ds_write2_b32 v218, v48, v49 offset0:0 offset1:1
  v_cvt_pk_bf16_f32 v48, v4, v5
  v_cvt_pk_bf16_f32 v49, v6, v7
  ds_write2_b32 v218, v48, v49 offset0:4 offset1:5
  v_cvt_pk_bf16_f32 v48, v8, v9
  v_cvt_pk_bf16_f32 v49, v10, v11
  ds_write2_b32 v218, v48, v49 offset0:8 offset1:9
  v_cvt_pk_bf16_f32 v48, v12, v13
  v_cvt_pk_bf16_f32 v49, v14, v15
  ds_write2_b32 v218, v48, v49 offset0:12 offset1:13
  v_cvt_pk_bf16_f32 v48, v16, v17
  v_cvt_pk_bf16_f32 v49, v18, v19
  ds_write2_b32 v218, v48, v49 offset0:64 offset1:65
  v_cvt_pk_bf16_f32 v48, v20, v21
  v_cvt_pk_bf16_f32 v49, v22, v23
  ds_write2_b32 v218, v48, v49 offset0:68 offset1:69
  v_cvt_pk_bf16_f32 v48, v24, v25
  v_cvt_pk_bf16_f32 v49, v26, v27
  ds_write2_b32 v218, v48, v49 offset0:72 offset1:73
  v_cvt_pk_bf16_f32 v48, v28, v29
  v_cvt_pk_bf16_f32 v49, v30, v31
  ds_write2_b32 v218, v48, v49 offset0:76 offset1:77
  v_add_u32 v218, 16512, v218
  s_waitcnt vmcnt(0) lgkmcnt(0)
  s_barrier
  s_add_u32 m0, s67, 0
  s_nop 0
  buffer_load_dwordx4 v202, s[4:7], s60 offen offset:0 lds
  s_add_u32 m0, s67, 896
  s_nop 0
  buffer_load_dwordx4 v202, s[4:7], s60 offen offset:128 lds
  s_add_u32 m0, s67, 1792
  s_nop 0
  buffer_load_dwordx4 v202, s[4:7], s60 offen offset:256 lds
  s_add_u32 m0, s67, 2688
  s_nop 0
  buffer_load_dwordx4 v202, s[4:7], s60 offen offset:384 lds
  s_add_u32 m0, s67, 3584
  s_nop 0
  buffer_load_dwordx4 v202, s[4:7], s60 offen offset:512 lds
  s_add_u32 m0, s67, 4480
  s_nop 0
  buffer_load_dwordx4 v202, s[4:7], s60 offen offset:640 lds
  s_add_u32 m0, s67, 5376
  s_nop 0
  buffer_load_dwordx4 v202, s[4:7], s60 offen offset:768 lds
  s_add_u32 m0, s67, 6272
  s_nop 0
  buffer_load_dwordx4 v202, s[4:7], s60 offen offset:896 lds
  s_add_u32 m0, s67, 7168
  s_nop 0
  buffer_load_dwordx4 v202, s[4:7], s60 offen offset:1024 lds
  s_add_u32 s60, s60, 36864
  ds_read_b128 v[32:35], v203 offset:36864
  ds_read_b128 v[36:39], v204 offset:36864
  ds_read_b128 v[40:43], v205 offset:36864
  s_waitcnt lgkmcnt(2)
  v_mfma_f32_32x32x16_bf16 v[0:15], a[0:3], v[32:35], 0
  ds_read_b128 v[44:47], v206 offset:36864
  v_mfma_f32_32x32x16_bf16 v[16:31], a[144:147], v[32:35], 0
  s_waitcnt lgkmcnt(2)
  v_mfma_f32_32x32x16_bf16 v[0:15], a[4:7], v[36:39], v[0:15]
  ds_read_b128 v[32:35], v203 offset:37888
  v_mfma_f32_32x32x16_bf16 v[16:31], a[148:151], v[36:39], v[16:31]
  s_waitcnt lgkmcnt(2)
  v_mfma_f32_32x32x16_bf16 v[0:15], a[8:11], v[40:43], v[0:15]
  ds_read_b128 v[36:39], v204 offset:37888
  v_mfma_f32_32x32x16_bf16 v[16:31], a[152:155], v[40:43], v[16:31]
  s_waitcnt lgkmcnt(2)
  v_mfma_f32_32x32x16_bf16 v[0:15], a[12:15], v[44:47], v[0:15]
  ds_read_b128 v[40:43], v205 offset:37888
  v_mfma_f32_32x32x16_bf16 v[16:31], a[156:159], v[44:47], v[16:31]
  s_waitcnt lgkmcnt(2)
  v_mfma_f32_32x32x16_bf16 v[0:15], a[16:19], v[32:35], v[0:15]
  ds_read_b128 v[44:47], v206 offset:37888
  v_mfma_f32_32x32x16_bf16 v[16:31], a[160:163], v[32:35], v[16:31]
  s_waitcnt lgkmcnt(2)
  v_mfma_f32_32x32x16_bf16 v[0:15], a[20:23], v[36:39], v[0:15]
  ds_read_b128 v[32:35], v203 offset:38912
  v_mfma_f32_32x32x16_bf16 v[16:31], a[164:167], v[36:39], v[16:31]
  s_waitcnt lgkmcnt(2)
  v_mfma_f32_32x32x16_bf16 v[0:15], a[24:27], v[40:43], v[0:15]
  ds_read_b128 v[36:39], v204 offset:38912
  v_mfma_f32_32x32x16_bf16 v[16:31], a[168:171], v[40:43], v[16:31]
  s_waitcnt lgkmcnt(2)
  v_mfma_f32_32x32x16_bf16 v[0:15], a[28:31], v[44:47], v[0:15]
  ds_read_b128 v[40:43], v205 offset:38912
  v_mfma_f32_32x32x16_bf16 v[16:31], a[172:175], v[44:47], v[16:31]
  s_waitcnt lgkmcnt(2)
  v_mfma_f32_32x32x16_bf16 v[0:15], a[32:35], v[32:35], v[0:15]
  ds_read_b128 v[44:47], v206 offset:38912
  v_mfma_f32_32x32x16_bf16 v[16:31], a[176:179], v[32:35], v[16:31]
  s_waitcnt lgkmcnt(2)
  v_mfma_f32_32x32x16_bf16 v[0:15], a[36:39], v[36:39], v[0:15]
  ds_read_b128 v[32:35], v203 offset:39936
  v_mfma_f32_32x32x16_bf16 v[16:31], a[180:183], v[36:39], v[16:31]
  s_waitcnt lgkmcnt(2)
  v_mfma_f32_32x32x16_bf16 v[0:15], a[40:43], v[40:43], v[0:15]
  ds_read_b128 v[36:39], v204 offset:39936
  v_mfma_f32_32x32x16_bf16 v[16:31], a[184:187], v[40:43], v[16:31]
  s_waitcnt lgkmcnt(2)
  v_mfma_f32_32x32x16_bf16 v[0:15], a[44:47], v[44:47], v[0:15]
  ds_read_b128 v[40:43], v205 offset:39936
  v_mfma_f32_32x32x16_bf16 v[16:31], a[188:191], v[44:47], v[16:31]
  s_waitcnt lgkmcnt(2)
  v_mfma_f32_32x32x16_bf16 v[0:15], a[48:51], v[32:35], v[0:15]
  ds_read_b128 v[44:47], v206 offset:39936
  v_mfma_f32_32x32x16_bf16 v[16:31], a[192:195], v[32:35], v[16:31]
  s_waitcnt lgkmcnt(2)
  v_mfma_f32_32x32x16_bf16 v[0:15], a[52:55], v[36:39], v[0:15]
  ds_read_b128 v[32:35], v203 offset:40960
  v_mfma_f32_32x32x16_bf16 v[16:31], a[196:199], v[36:39], v[16:31]
  s_waitcnt lgkmcnt(2)
  v_mfma_f32_32x32x16_bf16 v[0:15], a[56:59], v[40:43], v[0:15]
  ds_read_b128 v[36:39], v204 offset:40960
  v_mfma_f32_32x32x16_bf16 v[16:31], a[200:203], v[40:43], v[16:31]
  s_waitcnt lgkmcnt(2)
  v_mfma_f32_32x32x16_bf16 v[0:15], a[60:63], v[44:47], v[0:15]
  ds_read_b128 v[40:43], v205 offset:40960
  v_mfma_f32_32x32x16_bf16 v[16:31], a[204:207], v[44:47], v[16:31]
  s_waitcnt lgkmcnt(2)
  v_mfma_f32_32x32x16_bf16 v[0:15], a[64:67], v[32:35], v[0:15]
  ds_read_b128 v[44:47], v206 offset:40960
  v_mfma_f32_32x32x16_bf16 v[16:31], a[208:211], v[32:35], v[16:31]
  s_waitcnt lgkmcnt(2)
  v_mfma_f32_32x32x16_bf16 v[0:15], a[68:71], v[36:39], v[0:15]
  ds_read_b128 v[32:35], v203 offset:41984
  v_mfma_f32_32x32x16_bf16 v[16:31], a[212:215], v[36:39], v[16:31]
  s_waitcnt lgkmcnt(2)
  v_mfma_f32_32x32x16_bf16 v[0:15], a[72:75], v[40:43], v[0:15]
  ds_read_b128 v[36:39], v204 offset:41984
  v_mfma_f32_32x32x16_bf16 v[16:31], a[216:219], v[40:43], v[16:31]
  s_waitcnt lgkmcnt(2)
  v_mfma_f32_32x32x16_bf16 v[0:15], a[76:79], v[44:47], v[0:15]
  ds_read_b128 v[40:43], v205 offset:41984
  v_mfma_f32_32x32x16_bf16 v[16:31], a[220:223], v[44:47], v[16:31]
  s_waitcnt lgkmcnt(2)
  v_mfma_f32_32x32x16_bf16 v[0:15], a[80:83], v[32:35], v[0:15]
  ds_read_b128 v[44:47], v206 offset:41984
  v_mfma_f32_32x32x16_bf16 v[16:31], a[224:227], v[32:35], v[16:31]
  s_waitcnt lgkmcnt(2)
  v_mfma_f32_32x32x16_bf16 v[0:15], a[84:87], v[36:39], v[0:15]
  ds_read_b128 v[32:35], v203 offset:43008
  v_mfma_f32_32x32x16_bf16 v[16:31], a[228:231], v[36:39], v[16:31]
  s_waitcnt lgkmcnt(2)
  v_mfma_f32_32x32x16_bf16 v[0:15], a[88:91], v[40:43], v[0:15]
  ds_read_b128 v[36:39], v204 offset:43008
  v_mfma_f32_32x32x16_bf16 v[16:31], a[232:235], v[40:43], v[16:31]
  s_waitcnt lgkmcnt(2)
  v_mfma_f32_32x32x16_bf16 v[0:15], a[92:95], v[44:47], v[0:15]
  ds_read_b128 v[40:43], v205 offset:43008
  v_mfma_f32_32x32x16_bf16 v[16:31], a[236:239], v[44:47], v[16:31]
  s_waitcnt lgkmcnt(2)
  v_mfma_f32_32x32x16_bf16 v[0:15], a[96:99], v[32:35], v[0:15]
  ds_read_b128 v[44:47], v206 offset:43008
  v_mfma_f32_32x32x16_bf16 v[16:31], a[240:243], v[32:35], v[16:31]
  s_waitcnt lgkmcnt(2)
  v_mfma_f32_32x32x16_bf16 v[0:15], a[100:103], v[36:39], v[0:15]
  ds_read_b128 v[32:35], v203 offset:44032
  v_mfma_f32_32x32x16_bf16 v[16:31], a[244:247], v[36:39], v[16:31]
  s_waitcnt lgkmcnt(2)
  v_mfma_f32_32x32x16_bf16 v[0:15], a[104:107], v[40:43], v[0:15]
  ds_read_b128 v[36:39], v204 offset:44032
  v_mfma_f32_32x32x16_bf16 v[16:31], a[248:251], v[40:43], v[16:31]
  s_waitcnt lgkmcnt(2)
  v_mfma_f32_32x32x16_bf16 v[0:15], a[108:111], v[44:47], v[0:15]
  ds_read_b128 v[40:43], v205 offset:44032
  v_mfma_f32_32x32x16_bf16 v[16:31], a[252:255], v[44:47], v[16:31]
  s_waitcnt lgkmcnt(2)
  v_mfma_f32_32x32x16_bf16 v[0:15], a[112:115], v[32:35], v[0:15]
  ds_read_b128 v[44:47], v206 offset:44032
  v_mfma_f32_32x32x16_bf16 v[16:31], v[224:227], v[32:35], v[16:31]
  s_waitcnt lgkmcnt(2)
  v_mfma_f32_32x32x16_bf16 v[0:15], a[116:119], v[36:39], v[0:15]
  ds_read_b128 v[32:35], v203 offset:45056
  v_mfma_f32_32x32x16_bf16 v[16:31], v[228:231], v[36:39], v[16:31]
  s_waitcnt lgkmcnt(2)
  v_mfma_f32_32x32x16_bf16 v[0:15], a[120:123], v[40:43], v[0:15]
  ds_read_b128 v[36:39], v204 offset:45056
  v_mfma_f32_32x32x16_bf16 v[16:31], v[232:235], v[40:43], v[16:31]
  s_waitcnt lgkmcnt(2)
  v_mfma_f32_32x32x16_bf16 v[0:15], a[124:127], v[44:47], v[0:15]
  ds_read_b128 v[40:43], v205 offset:45056
  v_mfma_f32_32x32x16_bf16 v[16:31], v[236:239], v[44:47], v[16:31]
  s_waitcnt lgkmcnt(2)
  v_mfma_f32_32x32x16_bf16 v[0:15], a[128:131], v[32:35], v[0:15]
  ds_read_b128 v[44:47], v206 offset:45056
  v_mfma_f32_32x32x16_bf16 v[16:31], v[240:243], v[32:35], v[16:31]
  s_waitcnt lgkmcnt(2)
  v_mfma_f32_32x32x16_bf16 v[0:15], a[132:135], v[36:39], v[0:15]
  v_mfma_f32_32x32x16_bf16 v[16:31], v[244:247], v[36:39], v[16:31]
  s_waitcnt lgkmcnt(1)
  v_mfma_f32_32x32x16_bf16 v[0:15], a[136:139], v[40:43], v[0:15]
  v_mfma_f32_32x32x16_bf16 v[16:31], v[248:251], v[40:43], v[16:31]
  s_waitcnt lgkmcnt(0)
  v_mfma_f32_32x32x16_bf16 v[0:15], a[140:143], v[44:47], v[0:15]
  v_mfma_f32_32x32x16_bf16 v[16:31], v[252:255], v[44:47], v[16:31]
  s_nop 3
  v_cvt_pk_bf16_f32 v48, v0, v1
  v_cvt_pk_bf16_f32 v49, v2, v3
  ds_write2_b32 v218, v48, v49 offset0:0 offset1:1
  v_cvt_pk_bf16_f32 v48, v4, v5
  v_cvt_pk_bf16_f32 v49, v6, v7
  ds_write2_b32 v218, v48, v49 offset0:4 offset1:5
  v_cvt_pk_bf16_f32 v48, v8, v9
  v_cvt_pk_bf16_f32 v49, v10, v11
  ds_write2_b32 v218, v48, v49 offset0:8 offset1:9
  v_cvt_pk_bf16_f32 v48, v12, v13
  v_cvt_pk_bf16_f32 v49, v14, v15
  ds_write2_b32 v218, v48, v49 offset0:12 offset1:13
  v_cvt_pk_bf16_f32 v48, v16, v17
  v_cvt_pk_bf16_f32 v49, v18, v19
  ds_write2_b32 v218, v48, v49 offset0:64 offset1:65
  v_cvt_pk_bf16_f32 v48, v20, v21
  v_cvt_pk_bf16_f32 v49, v22, v23
  ds_write2_b32 v218, v48, v49 offset0:68 offset1:69
  v_cvt_pk_bf16_f32 v48, v24, v25
  v_cvt_pk_bf16_f32 v49, v26, v27
  ds_write2_b32 v218, v48, v49 offset0:72 offset1:73
  v_cvt_pk_bf16_f32 v48, v28, v29
  v_cvt_pk_bf16_f32 v49, v30, v31
  ds_write2_b32 v218, v48, v49 offset0:76 offset1:77
  v_add_u32 v218, 16512, v218
  s_waitcnt vmcnt(0) lgkmcnt(0)
  s_barrier
  s_add_u32 m0, s67, 36864
  s_nop 0
  buffer_load_dwordx4 v202, s[4:7], s60 offen offset:0 lds
  s_add_u32 m0, s67, 37760
  s_nop 0
  buffer_load_dwordx4 v202, s[4:7], s60 offen offset:128 lds
  s_add_u32 m0, s67, 38656
  s_nop 0
  buffer_load_dwordx4 v202, s[4:7], s60 offen offset:256 lds
  s_add_u32 m0, s67, 39552
  s_nop 0
  buffer_load_dwordx4 v202, s[4:7], s60 offen offset:384 lds
  s_add_u32 m0, s67, 40448
  s_nop 0
  buffer_load_dwordx4 v202, s[4:7], s60 offen offset:512 lds
  s_add_u32 m0, s67, 41344
  s_nop 0
  buffer_load_dwordx4 v202, s[4:7], s60 offen offset:640 lds
  s_add_u32 m0, s67, 42240
  s_nop 0
  buffer_load_dwordx4 v202, s[4:7], s60 offen offset:768 lds
  s_add_u32 m0, s67, 43136
  s_nop 0
  buffer_load_dwordx4 v202, s[4:7], s60 offen offset:896 lds
  s_add_u32 m0, s67, 44032
  s_nop 0
  buffer_load_dwordx4 v202, s[4:7], s60 offen offset:1024 lds
  s_add_u32 s60, s60, 36864
  ds_read_b128 v[32:35], v203 offset:0
  ds_read_b128 v[36:39], v204 offset:0
  ds_read_b128 v[40:43], v205 offset:0
  s_waitcnt lgkmcnt(2)
  v_mfma_f32_32x32x16_bf16 v[0:15], a[0:3], v[32:35], 0
  ds_read_b128 v[44:47], v206 offset:0
  v_mfma_f32_32x32x16_bf16 v[16:31], a[144:147], v[32:35], 0
  s_waitcnt lgkmcnt(2)
  v_mfma_f32_32x32x16_bf16 v[0:15], a[4:7], v[36:39], v[0:15]
  ds_read_b128 v[32:35], v203 offset:1024
  v_mfma_f32_32x32x16_bf16 v[16:31], a[148:151], v[36:39], v[16:31]
  s_waitcnt lgkmcnt(2)
  v_mfma_f32_32x32x16_bf16 v[0:15], a[8:11], v[40:43], v[0:15]
  ds_read_b128 v[36:39], v204 offset:1024
  v_mfma_f32_32x32x16_bf16 v[16:31], a[152:155], v[40:43], v[16:31]
  s_waitcnt lgkmcnt(2)
  v_mfma_f32_32x32x16_bf16 v[0:15], a[12:15], v[44:47], v[0:15]
  ds_read_b128 v[40:43], v205 offset:1024
  v_mfma_f32_32x32x16_bf16 v[16:31], a[156:159], v[44:47], v[16:31]
  s_waitcnt lgkmcnt(2)
  v_mfma_f32_32x32x16_bf16 v[0:15], a[16:19], v[32:35], v[0:15]
  ds_read_b128 v[44:47], v206 offset:1024
  v_mfma_f32_32x32x16_bf16 v[16:31], a[160:163], v[32:35], v[16:31]
  s_waitcnt lgkmcnt(2)
  v_mfma_f32_32x32x16_bf16 v[0:15], a[20:23], v[36:39], v[0:15]
  ds_read_b128 v[32:35], v203 offset:2048
  v_mfma_f32_32x32x16_bf16 v[16:31], a[164:167], v[36:39], v[16:31]
  s_waitcnt lgkmcnt(2)
  v_mfma_f32_32x32x16_bf16 v[0:15], a[24:27], v[40:43], v[0:15]
  ds_read_b128 v[36:39], v204 offset:2048
  v_mfma_f32_32x32x16_bf16 v[16:31], a[168:171], v[40:43], v[16:31]
  s_waitcnt lgkmcnt(2)
  v_mfma_f32_32x32x16_bf16 v[0:15], a[28:31], v[44:47], v[0:15]
  ds_read_b128 v[40:43], v205 offset:2048
  v_mfma_f32_32x32x16_bf16 v[16:31], a[172:175], v[44:47], v[16:31]
  s_waitcnt lgkmcnt(2)
  v_mfma_f32_32x32x16_bf16 v[0:15], a[32:35], v[32:35], v[0:15]
  ds_read_b128 v[44:47], v206 offset:2048
  v_mfma_f32_32x32x16_bf16 v[16:31], a[176:179], v[32:35], v[16:31]
  s_waitcnt lgkmcnt(2)
  v_mfma_f32_32x32x16_bf16 v[0:15], a[36:39], v[36:39], v[0:15]
  ds_read_b128 v[32:35], v203 offset:3072
  v_mfma_f32_32x32x16_bf16 v[16:31], a[180:183], v[36:39], v[16:31]
  s_waitcnt lgkmcnt(2)
  v_mfma_f32_32x32x16_bf16 v[0:15], a[40:43], v[40:43], v[0:15]
  ds_read_b128 v[36:39], v204 offset:3072
  v_mfma_f32_32x32x16_bf16 v[16:31], a[184:187], v[40:43], v[16:31]
  s_waitcnt lgkmcnt(2)
  v_mfma_f32_32x32x16_bf16 v[0:15], a[44:47], v[44:47], v[0:15]
  ds_read_b128 v[40:43], v205 offset:3072
  v_mfma_f32_32x32x16_bf16 v[16:31], a[188:191], v[44:47], v[16:31]
  s_waitcnt lgkmcnt(2)
  v_mfma_f32_32x32x16_bf16 v[0:15], a[48:51], v[32:35], v[0:15]
  ds_read_b128 v[44:47], v206 offset:3072
  v_mfma_f32_32x32x16_bf16 v[16:31], a[192:195], v[32:35], v[16:31]
  s_waitcnt lgkmcnt(2)
  v_mfma_f32_32x32x16_bf16 v[0:15], a[52:55], v[36:39], v[0:15]
  ds_read_b128 v[32:35], v203 offset:4096
  v_mfma_f32_32x32x16_bf16 v[16:31], a[196:199], v[36:39], v[16:31]
  s_waitcnt lgkmcnt(2)
  v_mfma_f32_32x32x16_bf16 v[0:15], a[56:59], v[40:43], v[0:15]
  ds_read_b128 v[36:39], v204 offset:4096
  v_mfma_f32_32x32x16_bf16 v[16:31], a[200:203], v[40:43], v[16:31]
  s_waitcnt lgkmcnt(2)
  v_mfma_f32_32x32x16_bf16 v[0:15], a[60:63], v[44:47], v[0:15]
  ds_read_b128 v[40:43], v205 offset:4096
  v_mfma_f32_32x32x16_bf16 v[16:31], a[204:207], v[44:47], v[16:31]
  s_waitcnt lgkmcnt(2)
  v_mfma_f32_32x32x16_bf16 v[0:15], a[64:67], v[32:35], v[0:15]
  ds_read_b128 v[44:47], v206 offset:4096
  v_mfma_f32_32x32x16_bf16 v[16:31], a[208:211], v[32:35], v[16:31]
  s_waitcnt lgkmcnt(2)
  v_mfma_f32_32x32x16_bf16 v[0:15], a[68:71], v[36:39], v[0:15]
  ds_read_b128 v[32:35], v203 offset:5120
  v_mfma_f32_32x32x16_bf16 v[16:31], a[212:215], v[36:39], v[16:31]
  s_waitcnt lgkmcnt(2)
  v_mfma_f32_32x32x16_bf16 v[0:15], a[72:75], v[40:43], v[0:15]
  ds_read_b128 v[36:39], v204 offset:5120
  v_mfma_f32_32x32x16_bf16 v[16:31], a[216:219], v[40:43], v[16:31]
  s_waitcnt lgkmcnt(2)
  v_mfma_f32_32x32x16_bf16 v[0:15], a[76:79], v[44:47], v[0:15]
  ds_read_b128 v[40:43], v205 offset:5120
  v_mfma_f32_32x32x16_bf16 v[16:31], a[220:223], v[44:47], v[16:31]
  s_waitcnt lgkmcnt(2)
  v_mfma_f32_32x32x16_bf16 v[0:15], a[80:83], v[32:35], v[0:15]
  ds_read_b128 v[44:47], v206 offset:5120
  v_mfma_f32_32x32x16_bf16 v[16:31], a[224:227], v[32:35], v[16:31]
  s_waitcnt lgkmcnt(2)
  v_mfma_f32_32x32x16_bf16 v[0:15], a[84:87], v[36:39], v[0:15]
  ds_read_b128 v[32:35], v203 offset:6144
  v_mfma_f32_32x32x16_bf16 v[16:31], a[228:231], v[36:39], v[16:31]
  s_waitcnt lgkmcnt(2)
  v_mfma_f32_32x32x16_bf16 v[0:15], a[88:91], v[40:43], v[0:15]
  ds_read_b128 v[36:39], v204 offset:6144
  v_mfma_f32_32x32x16_bf16 v[16:31], a[232:235], v[40:43], v[16:31]
  s_waitcnt lgkmcnt(2)
  v_mfma_f32_32x32x16_bf16 v[0:15], a[92:95], v[44:47], v[0:15]
  ds_read_b128 v[40:43], v205 offset:6144
  v_mfma_f32_32x32x16_bf16 v[16:31], a[236:239], v[44:47], v[16:31]
  s_waitcnt lgkmcnt(2)
  v_mfma_f32_32x32x16_bf16 v[0:15], a[96:99], v[32:35], v[0:15]
  ds_read_b128 v[44:47], v206 offset:6144
  v_mfma_f32_32x32x16_bf16 v[16:31], a[240:243], v[32:35], v[16:31]
  s_waitcnt lgkmcnt(2)
  v_mfma_f32_32x32x16_bf16 v[0:15], a[100:103], v[36:39], v[0:15]
  ds_read_b128 v[32:35], v203 offset:7168
  v_mfma_f32_32x32x16_bf16 v[16:31], a[244:247], v[36:39], v[16:31]
  s_waitcnt lgkmcnt(2)
  v_mfma_f32_32x32x16_bf16 v[0:15], a[104:107], v[40:43], v[0:15]
  ds_read_b128 v[36:39], v204 offset:7168
  v_mfma_f32_32x32x16_bf16 v[16:31], a[248:251], v[40:43], v[16:31]
  s_waitcnt lgkmcnt(2)
  v_mfma_f32_32x32x16_bf16 v[0:15], a[108:111], v[44:47], v[0:15]
  ds_read_b128 v[40:43], v205 offset:7168
  v_mfma_f32_32x32x16_bf16 v[16:31], a[252:255], v[44:47], v[16:31]
  s_waitcnt lgkmcnt(2)
  v_mfma_f32_32x32x16_bf16 v[0:15], a[112:115], v[32:35], v[0:15]
  ds_read_b128 v[44:47], v206 offset:7168
  v_mfma_f32_32x32x16_bf16 v[16:31], v[224:227], v[32:35], v[16:31]
  s_waitcnt lgkmcnt(2)
  v_mfma_f32_32x32x16_bf16 v[0:15], a[116:119], v[36:39], v[0:15]
  ds_read_b128 v[32:35], v203 offset:8192
  v_mfma_f32_32x32x16_bf16 v[16:31], v[228:231], v[36:39], v[16:31]
  s_waitcnt lgkmcnt(2)
  v_mfma_f32_32x32x16_bf16 v[0:15], a[120:123], v[40:43], v[0:15]
  ds_read_b128 v[36:39], v204 offset:8192
  v_mfma_f32_32x32x16_bf16 v[16:31], v[232:235], v[40:43], v[16:31]
  s_waitcnt lgkmcnt(2)
  v_mfma_f32_32x32x16_bf16 v[0:15], a[124:127], v[44:47], v[0:15]
  ds_read_b128 v[40:43], v205 offset:8192
  v_mfma_f32_32x32x16_bf16 v[16:31], v[236:239], v[44:47], v[16:31]
  s_waitcnt lgkmcnt(2)
  v_mfma_f32_32x32x16_bf16 v[0:15], a[128:131], v[32:35], v[0:15]
  ds_read_b128 v[44:47], v206 offset:8192
  v_mfma_f32_32x32x16_bf16 v[16:31], v[240:243], v[32:35], v[16:31]
  s_waitcnt lgkmcnt(2)
  v_mfma_f32_32x32x16_bf16 v[0:15], a[132:135], v[36:39], v[0:15]
  v_mfma_f32_32x32x16_bf16 v[16:31], v[244:247], v[36:39], v[16:31]
  s_waitcnt lgkmcnt(1)
  v_mfma_f32_32x32x16_bf16 v[0:15], a[136:139], v[40:43], v[0:15]
  v_mfma_f32_32x32x16_bf16 v[16:31], v[248:251], v[40:43], v[16:31]
  s_waitcnt lgkmcnt(0)
  v_mfma_f32_32x32x16_bf16 v[0:15], a[140:143], v[44:47], v[0:15]
  v_mfma_f32_32x32x16_bf16 v[16:31], v[252:255], v[44:47], v[16:31]
  s_nop 3
  v_cvt_pk_bf16_f32 v48, v0, v1
  v_cvt_pk_bf16_f32 v49, v2, v3
  ds_write2_b32 v218, v48, v49 offset0:0 offset1:1
  v_cvt_pk_bf16_f32 v48, v4, v5
  v_cvt_pk_bf16_f32 v49, v6, v7
  ds_write2_b32 v218, v48, v49 offset0:4 offset1:5
  v_cvt_pk_bf16_f32 v48, v8, v9
  v_cvt_pk_bf16_f32 v49, v10, v11
  ds_write2_b32 v218, v48, v49 offset0:8 offset1:9
  v_cvt_pk_bf16_f32 v48, v12, v13
  v_cvt_pk_bf16_f32 v49, v14, v15
  ds_write2_b32 v218, v48, v49 offset0:12 offset1:13
  v_cvt_pk_bf16_f32 v48, v16, v17
  v_cvt_pk_bf16_f32 v49, v18, v19
  ds_write2_b32 v218, v48, v49 offset0:64 offset1:65
  v_cvt_pk_bf16_f32 v48, v20, v21
  v_cvt_pk_bf16_f32 v49, v22, v23
  ds_write2_b32 v218, v48, v49 offset0:68 offset1:69
  v_cvt_pk_bf16_f32 v48, v24, v25
  v_cvt_pk_bf16_f32 v49, v26, v27
  ds_write2_b32 v218, v48, v49 offset0:72 offset1:73
  v_cvt_pk_bf16_f32 v48, v28, v29
  v_cvt_pk_bf16_f32 v49, v30, v31
  ds_write2_b32 v218, v48, v49 offset0:76 offset1:77
  v_add_u32 v218, 16512, v218
  s_waitcnt vmcnt(0) lgkmcnt(0)
  s_barrier
  s_add_u32 m0, s67, 0
  s_nop 0
  buffer_load_dwordx4 v202, s[4:7], s60 offen offset:0 lds
  s_add_u32 m0, s67, 896
  s_nop 0
  buffer_load_dwordx4 v202, s[4:7], s60 offen offset:128 lds
  s_add_u32 m0, s67, 1792
  s_nop 0
  buffer_load_dwordx4 v202, s[4:7], s60 offen offset:256 lds
  s_add_u32 m0, s67, 2688
  s_nop 0
  buffer_load_dwordx4 v202, s[4:7], s60 offen offset:384 lds
  s_add_u32 m0, s67, 3584
  s_nop 0
  buffer_load_dwordx4 v202, s[4:7], s60 offen offset:512 lds
  s_add_u32 m0, s67, 4480
  s_nop 0
  buffer_load_dwordx4 v202, s[4:7], s60 offen offset:640 lds
  s_add_u32 m0, s67, 5376
  s_nop 0
  buffer_load_dwordx4 v202, s[4:7], s60 offen offset:768 lds
  s_add_u32 m0, s67, 6272
  s_nop 0
  buffer_load_dwordx4 v202, s[4:7], s60 offen offset:896 lds
  s_add_u32 m0, s67, 7168
  s_nop 0
  buffer_load_dwordx4 v202, s[4:7], s60 offen offset:1024 lds
  s_add_u32 s60, s60, 36864
  ds_read_b128 v[32:35], v203 offset:36864
  ds_read_b128 v[36:39], v204 offset:36864
  ds_read_b128 v[40:43], v205 offset:36864
  s_waitcnt lgkmcnt(2)
  v_mfma_f32_32x32x16_bf16 v[0:15], a[0:3], v[32:35], 0
  ds_read_b128 v[44:47], v206 offset:36864
  v_mfma_f32_32x32x16_bf16 v[16:31], a[144:147], v[32:35], 0
  s_waitcnt lgkmcnt(2)
  v_mfma_f32_32x32x16_bf16 v[0:15], a[4:7], v[36:39], v[0:15]
  ds_read_b128 v[32:35], v203 offset:37888
  v_mfma_f32_32x32x16_bf16 v[16:31], a[148:151], v[36:39], v[16:31]
  s_waitcnt lgkmcnt(2)
  v_mfma_f32_32x32x16_bf16 v[0:15], a[8:11], v[40:43], v[0:15]
  ds_read_b128 v[36:39], v204 offset:37888
  v_mfma_f32_32x32x16_bf16 v[16:31], a[152:155], v[40:43], v[16:31]
  s_waitcnt lgkmcnt(2)
  v_mfma_f32_32x32x16_bf16 v[0:15], a[12:15], v[44:47], v[0:15]
  ds_read_b128 v[40:43], v205 offset:37888
  v_mfma_f32_32x32x16_bf16 v[16:31], a[156:159], v[44:47], v[16:31]
  s_waitcnt lgkmcnt(2)
  v_mfma_f32_32x32x16_bf16 v[0:15], a[16:19], v[32:35], v[0:15]
  ds_read_b128 v[44:47], v206 offset:37888
  v_mfma_f32_32x32x16_bf16 v[16:31], a[160:163], v[32:35], v[16:31]
  s_waitcnt lgkmcnt(2)
  v_mfma_f32_32x32x16_bf16 v[0:15], a[20:23], v[36:39], v[0:15]
  ds_read_b128 v[32:35], v203 offset:38912
  v_mfma_f32_32x32x16_bf16 v[16:31], a[164:167], v[36:39], v[16:31]
  s_waitcnt lgkmcnt(2)
  v_mfma_f32_32x32x16_bf16 v[0:15], a[24:27], v[40:43], v[0:15]
  ds_read_b128 v[36:39], v204 offset:38912
  v_mfma_f32_32x32x16_bf16 v[16:31], a[168:171], v[40:43], v[16:31]
  s_waitcnt lgkmcnt(2)
  v_mfma_f32_32x32x16_bf16 v[0:15], a[28:31], v[44:47], v[0:15]
  ds_read_b128 v[40:43], v205 offset:38912
  v_mfma_f32_32x32x16_bf16 v[16:31], a[172:175], v[44:47], v[16:31]
  s_waitcnt lgkmcnt(2)
  v_mfma_f32_32x32x16_bf16 v[0:15], a[32:35], v[32:35], v[0:15]
  ds_read_b128 v[44:47], v206 offset:38912
  v_mfma_f32_32x32x16_bf16 v[16:31], a[176:179], v[32:35], v[16:31]
  s_waitcnt lgkmcnt(2)
  v_mfma_f32_32x32x16_bf16 v[0:15], a[36:39], v[36:39], v[0:15]
  ds_read_b128 v[32:35], v203 offset:39936
  v_mfma_f32_32x32x16_bf16 v[16:31], a[180:183], v[36:39], v[16:31]
  s_waitcnt lgkmcnt(2)
  v_mfma_f32_32x32x16_bf16 v[0:15], a[40:43], v[40:43], v[0:15]
  ds_read_b128 v[36:39], v204 offset:39936
  v_mfma_f32_32x32x16_bf16 v[16:31], a[184:187], v[40:43], v[16:31]
  s_waitcnt lgkmcnt(2)
  v_mfma_f32_32x32x16_bf16 v[0:15], a[44:47], v[44:47], v[0:15]
  ds_read_b128 v[40:43], v205 offset:39936
  v_mfma_f32_32x32x16_bf16 v[16:31], a[188:191], v[44:47], v[16:31]
  s_waitcnt lgkmcnt(2)
  v_mfma_f32_32x32x16_bf16 v[0:15], a[48:51], v[32:35], v[0:15]
  ds_read_b128 v[44:47], v206 offset:39936
  v_mfma_f32_32x32x16_bf16 v[16:31], a[192:195], v[32:35], v[16:31]
  s_waitcnt lgkmcnt(2)
  v_mfma_f32_32x32x16_bf16 v[0:15], a[52:55], v[36:39], v[0:15]
  ds_read_b128 v[32:35], v203 offset:40960
  v_mfma_f32_32x32x16_bf16 v[16:31], a[196:199], v[36:39], v[16:31]
  s_waitcnt lgkmcnt(2)
  v_mfma_f32_32x32x16_bf16 v[0:15], a[56:59], v[40:43], v[0:15]
  ds_read_b128 v[36:39], v204 offset:40960
  v_mfma_f32_32x32x16_bf16 v[16:31], a[200:203], v[40:43], v[16:31]
  s_waitcnt lgkmcnt(2)
  v_mfma_f32_32x32x16_bf16 v[0:15], a[60:63], v[44:47], v[0:15]
  ds_read_b128 v[40:43], v205 offset:40960
  v_mfma_f32_32x32x16_bf16 v[16:31], a[204:207], v[44:47], v[16:31]
  s_waitcnt lgkmcnt(2)
  v_mfma_f32_32x32x16_bf16 v[0:15], a[64:67], v[32:35], v[0:15]
  ds_read_b128 v[44:47], v206 offset:40960
  v_mfma_f32_32x32x16_bf16 v[16:31], a[208:211], v[32:35], v[16:31]
  s_waitcnt lgkmcnt(2)
  v_mfma_f32_32x32x16_bf16 v[0:15], a[68:71], v[36:39], v[0:15]
  ds_read_b128 v[32:35], v203 offset:41984
  v_mfma_f32_32x32x16_bf16 v[16:31], a[212:215], v[36:39], v[16:31]
  s_waitcnt lgkmcnt(2)
  v_mfma_f32_32x32x16_bf16 v[0:15], a[72:75], v[40:43], v[0:15]
  ds_read_b128 v[36:39], v204 offset:41984
  v_mfma_f32_32x32x16_bf16 v[16:31], a[216:219], v[40:43], v[16:31]
  s_waitcnt lgkmcnt(2)
  v_mfma_f32_32x32x16_bf16 v[0:15], a[76:79], v[44:47], v[0:15]
  ds_read_b128 v[40:43], v205 offset:41984
  v_mfma_f32_32x32x16_bf16 v[16:31], a[220:223], v[44:47], v[16:31]
  s_waitcnt lgkmcnt(2)
  v_mfma_f32_32x32x16_bf16 v[0:15], a[80:83], v[32:35], v[0:15]
  ds_read_b128 v[44:47], v206 offset:41984
  v_mfma_f32_32x32x16_bf16 v[16:31], a[224:227], v[32:35], v[16:31]
  s_waitcnt lgkmcnt(2)
  v_mfma_f32_32x32x16_bf16 v[0:15], a[84:87], v[36:39], v[0:15]
  ds_read_b128 v[32:35], v203 offset:43008
  v_mfma_f32_32x32x16_bf16 v[16:31], a[228:231], v[36:39], v[16:31]
  s_waitcnt lgkmcnt(2)
  v_mfma_f32_32x32x16_bf16 v[0:15], a[88:91], v[40:43], v[0:15]
  ds_read_b128 v[36:39], v204 offset:43008
  v_mfma_f32_32x32x16_bf16 v[16:31], a[232:235], v[40:43], v[16:31]
  s_waitcnt lgkmcnt(2)
  v_mfma_f32_32x32x16_bf16 v[0:15], a[92:95], v[44:47], v[0:15]
  ds_read_b128 v[40:43], v205 offset:43008
  v_mfma_f32_32x32x16_bf16 v[16:31], a[236:239], v[44:47], v[16:31]
  s_waitcnt lgkmcnt(2)
  v_mfma_f32_32x32x16_bf16 v[0:15], a[96:99], v[32:35], v[0:15]
  ds_read_b128 v[44:47], v206 offset:43008
  v_mfma_f32_32x32x16_bf16 v[16:31], a[240:243], v[32:35], v[16:31]
  s_waitcnt lgkmcnt(2)
  v_mfma_f32_32x32x16_bf16 v[0:15], a[100:103], v[36:39], v[0:15]
  ds_read_b128 v[32:35], v203 offset:44032
  v_mfma_f32_32x32x16_bf16 v[16:31], a[244:247], v[36:39], v[16:31]
  s_waitcnt lgkmcnt(2)
  v_mfma_f32_32x32x16_bf16 v[0:15], a[104:107], v[40:43], v[0:15]
  ds_read_b128 v[36:39], v204 offset:44032
  v_mfma_f32_32x32x16_bf16 v[16:31], a[248:251], v[40:43], v[16:31]
  s_waitcnt lgkmcnt(2)
  v_mfma_f32_32x32x16_bf16 v[0:15], a[108:111], v[44:47], v[0:15]
  ds_read_b128 v[40:43], v205 offset:44032
  v_mfma_f32_32x32x16_bf16 v[16:31], a[252:255], v[44:47], v[16:31]
  s_waitcnt lgkmcnt(2)
  v_mfma_f32_32x32x16_bf16 v[0:15], a[112:115], v[32:35], v[0:15]
  ds_read_b128 v[44:47], v206 offset:44032
  v_mfma_f32_32x32x16_bf16 v[16:31], v[224:227], v[32:35], v[16:31]
  s_waitcnt lgkmcnt(2)
  v_mfma_f32_32x32x16_bf16 v[0:15], a[116:119], v[36:39], v[0:15]
  ds_read_b128 v[32:35], v203 offset:45056
  v_mfma_f32_32x32x16_bf16 v[16:31], v[228:231], v[36:39], v[16:31]
  s_waitcnt lgkmcnt(2)
  v_mfma_f32_32x32x16_bf16 v[0:15], a[120:123], v[40:43], v[0:15]
  ds_read_b128 v[36:39], v204 offset:45056
  v_mfma_f32_32x32x16_bf16 v[16:31], v[232:235], v[40:43], v[16:31]
  s_waitcnt lgkmcnt(2)
  v_mfma_f32_32x32x16_bf16 v[0:15], a[124:127], v[44:47], v[0:15]
  ds_read_b128 v[40:43], v205 offset:45056
  v_mfma_f32_32x32x16_bf16 v[16:31], v[236:239], v[44:47], v[16:31]
  s_waitcnt lgkmcnt(2)
  v_mfma_f32_32x32x16_bf16 v[0:15], a[128:131], v[32:35], v[0:15]
  ds_read_b128 v[44:47], v206 offset:45056
  v_mfma_f32_32x32x16_bf16 v[16:31], v[240:243], v[32:35], v[16:31]
  s_waitcnt lgkmcnt(2)
  v_mfma_f32_32x32x16_bf16 v[0:15], a[132:135], v[36:39], v[0:15]
  v_mfma_f32_32x32x16_bf16 v[16:31], v[244:247], v[36:39], v[16:31]
  s_waitcnt lgkmcnt(1)
  v_mfma_f32_32x32x16_bf16 v[0:15], a[136:139], v[40:43], v[0:15]
  v_mfma_f32_32x32x16_bf16 v[16:31], v[248:251], v[40:43], v[16:31]
  s_waitcnt lgkmcnt(0)
  v_mfma_f32_32x32x16_bf16 v[0:15], a[140:143], v[44:47], v[0:15]
  v_mfma_f32_32x32x16_bf16 v[16:31], v[252:255], v[44:47], v[16:31]
  s_nop 3
  v_cvt_pk_bf16_f32 v48, v0, v1
  v_cvt_pk_bf16_f32 v49, v2, v3
  ds_write2_b32 v218, v48, v49 offset0:0 offset1:1
  v_cvt_pk_bf16_f32 v48, v4, v5
  v_cvt_pk_bf16_f32 v49, v6, v7
  ds_write2_b32 v218, v48, v49 offset0:4 offset1:5
  v_cvt_pk_bf16_f32 v48, v8, v9
  v_cvt_pk_bf16_f32 v49, v10, v11
  ds_write2_b32 v218, v48, v49 offset0:8 offset1:9
  v_cvt_pk_bf16_f32 v48, v12, v13
  v_cvt_pk_bf16_f32 v49, v14, v15
  ds_write2_b32 v218, v48, v49 offset0:12 offset1:13
  v_cvt_pk_bf16_f32 v48, v16, v17
  v_cvt_pk_bf16_f32 v49, v18, v19
  ds_write2_b32 v218, v48, v49 offset0:64 offset1:65
  v_cvt_pk_bf16_f32 v48, v20, v21
  v_cvt_pk_bf16_f32 v49, v22, v23
  ds_write2_b32 v218, v48, v49 offset0:68 offset1:69
  v_cvt_pk_bf16_f32 v48, v24, v25
  v_cvt_pk_bf16_f32 v49, v26, v27
  ds_write2_b32 v218, v48, v49 offset0:72 offset1:73
  v_cvt_pk_bf16_f32 v48, v28, v29
  v_cvt_pk_bf16_f32 v49, v30, v31
  ds_write2_b32 v218, v48, v49 offset0:76 offset1:77
  v_add_u32 v218, 16512, v218
  s_waitcnt vmcnt(0) lgkmcnt(0)
  s_barrier
  ds_read_b128 v[32:35], v203 offset:0
  ds_read_b128 v[36:39], v204 offset:0
  ds_read_b128 v[40:43], v205 offset:0
  s_waitcnt lgkmcnt(2)
  v_mfma_f32_32x32x16_bf16 v[0:15], a[0:3], v[32:35], 0
  ds_read_b128 v[44:47], v206 offset:0
  v_mfma_f32_32x32x16_bf16 v[16:31], a[144:147], v[32:35], 0
  s_waitcnt lgkmcnt(2)
  v_mfma_f32_32x32x16_bf16 v[0:15], a[4:7], v[36:39], v[0:15]
  ds_read_b128 v[32:35], v203 offset:1024
  v_mfma_f32_32x32x16_bf16 v[16:31], a[148:151], v[36:39], v[16:31]
  s_waitcnt lgkmcnt(2)
  v_mfma_f32_32x32x16_bf16 v[0:15], a[8:11], v[40:43], v[0:15]
  ds_read_b128 v[36:39], v204 offset:1024
  v_mfma_f32_32x32x16_bf16 v[16:31], a[152:155], v[40:43], v[16:31]
  s_waitcnt lgkmcnt(2)
  v_mfma_f32_32x32x16_bf16 v[0:15], a[12:15], v[44:47], v[0:15]
  ds_read_b128 v[40:43], v205 offset:1024
  v_mfma_f32_32x32x16_bf16 v[16:31], a[156:159], v[44:47], v[16:31]
  s_waitcnt lgkmcnt(2)
  v_mfma_f32_32x32x16_bf16 v[0:15], a[16:19], v[32:35], v[0:15]
  ds_read_b128 v[44:47], v206 offset:1024
  v_mfma_f32_32x32x16_bf16 v[16:31], a[160:163], v[32:35], v[16:31]
  s_waitcnt lgkmcnt(2)
  v_mfma_f32_32x32x16_bf16 v[0:15], a[20:23], v[36:39], v[0:15]
  ds_read_b128 v[32:35], v203 offset:2048
  v_mfma_f32_32x32x16_bf16 v[16:31], a[164:167], v[36:39], v[16:31]
  s_waitcnt lgkmcnt(2)
  v_mfma_f32_32x32x16_bf16 v[0:15], a[24:27], v[40:43], v[0:15]
  ds_read_b128 v[36:39], v204 offset:2048
  v_mfma_f32_32x32x16_bf16 v[16:31], a[168:171], v[40:43], v[16:31]
  s_waitcnt lgkmcnt(2)
  v_mfma_f32_32x32x16_bf16 v[0:15], a[28:31], v[44:47], v[0:15]
  ds_read_b128 v[40:43], v205 offset:2048
  v_mfma_f32_32x32x16_bf16 v[16:31], a[172:175], v[44:47], v[16:31]
  s_waitcnt lgkmcnt(2)
  v_mfma_f32_32x32x16_bf16 v[0:15], a[32:35], v[32:35], v[0:15]
  ds_read_b128 v[44:47], v206 offset:2048
  v_mfma_f32_32x32x16_bf16 v[16:31], a[176:179], v[32:35], v[16:31]
  s_waitcnt lgkmcnt(2)
  v_mfma_f32_32x32x16_bf16 v[0:15], a[36:39], v[36:39], v[0:15]
  ds_read_b128 v[32:35], v203 offset:3072
  v_mfma_f32_32x32x16_bf16 v[16:31], a[180:183], v[36:39], v[16:31]
  s_waitcnt lgkmcnt(2)
  v_mfma_f32_32x32x16_bf16 v[0:15], a[40:43], v[40:43], v[0:15]
  ds_read_b128 v[36:39], v204 offset:3072
  v_mfma_f32_32x32x16_bf16 v[16:31], a[184:187], v[40:43], v[16:31]
  s_waitcnt lgkmcnt(2)
  v_mfma_f32_32x32x16_bf16 v[0:15], a[44:47], v[44:47], v[0:15]
  ds_read_b128 v[40:43], v205 offset:3072
  v_mfma_f32_32x32x16_bf16 v[16:31], a[188:191], v[44:47], v[16:31]
  s_waitcnt lgkmcnt(2)
  v_mfma_f32_32x32x16_bf16 v[0:15], a[48:51], v[32:35], v[0:15]
  ds_read_b128 v[44:47], v206 offset:3072
  v_mfma_f32_32x32x16_bf16 v[16:31], a[192:195], v[32:35], v[16:31]
  s_waitcnt lgkmcnt(2)
  v_mfma_f32_32x32x16_bf16 v[0:15], a[52:55], v[36:39], v[0:15]
  ds_read_b128 v[32:35], v203 offset:4096
  v_mfma_f32_32x32x16_bf16 v[16:31], a[196:199], v[36:39], v[16:31]
  s_waitcnt lgkmcnt(2)
  v_mfma_f32_32x32x16_bf16 v[0:15], a[56:59], v[40:43], v[0:15]
  ds_read_b128 v[36:39], v204 offset:4096
  v_mfma_f32_32x32x16_bf16 v[16:31], a[200:203], v[40:43], v[16:31]
  s_waitcnt lgkmcnt(2)
  v_mfma_f32_32x32x16_bf16 v[0:15], a[60:63], v[44:47], v[0:15]
  ds_read_b128 v[40:43], v205 offset:4096
  v_mfma_f32_32x32x16_bf16 v[16:31], a[204:207], v[44:47], v[16:31]
  s_waitcnt lgkmcnt(2)
  v_mfma_f32_32x32x16_bf16 v[0:15], a[64:67], v[32:35], v[0:15]
  ds_read_b128 v[44:47], v206 offset:4096
  v_mfma_f32_32x32x16_bf16 v[16:31], a[208:211], v[32:35], v[16:31]
  s_waitcnt lgkmcnt(2)
  v_mfma_f32_32x32x16_bf16 v[0:15], a[68:71], v[36:39], v[0:15]
  ds_read_b128 v[32:35], v203 offset:5120
  v_mfma_f32_32x32x16_bf16 v[16:31], a[212:215], v[36:39], v[16:31]
  s_waitcnt lgkmcnt(2)
  v_mfma_f32_32x32x16_bf16 v[0:15], a[72:75], v[40:43], v[0:15]
  ds_read_b128 v[36:39], v204 offset:5120
  v_mfma_f32_32x32x16_bf16 v[16:31], a[216:219], v[40:43], v[16:31]
  s_waitcnt lgkmcnt(2)
  v_mfma_f32_32x32x16_bf16 v[0:15], a[76:79], v[44:47], v[0:15]
  ds_read_b128 v[40:43], v205 offset:5120
  v_mfma_f32_32x32x16_bf16 v[16:31], a[220:223], v[44:47], v[16:31]
  s_waitcnt lgkmcnt(2)
  v_mfma_f32_32x32x16_bf16 v[0:15], a[80:83], v[32:35], v[0:15]
  ds_read_b128 v[44:47], v206 offset:5120
  v_mfma_f32_32x32x16_bf16 v[16:31], a[224:227], v[32:35], v[16:31]
  s_waitcnt lgkmcnt(2)
  v_mfma_f32_32x32x16_bf16 v[0:15], a[84:87], v[36:39], v[0:15]
  ds_read_b128 v[32:35], v203 offset:6144
  v_mfma_f32_32x32x16_bf16 v[16:31], a[228:231], v[36:39], v[16:31]
  s_waitcnt lgkmcnt(2)
  v_mfma_f32_32x32x16_bf16 v[0:15], a[88:91], v[40:43], v[0:15]
  ds_read_b128 v[36:39], v204 offset:6144
  v_mfma_f32_32x32x16_bf16 v[16:31], a[232:235], v[40:43], v[16:31]
  s_waitcnt lgkmcnt(2)
  v_mfma_f32_32x32x16_bf16 v[0:15], a[92:95], v[44:47], v[0:15]
  ds_read_b128 v[40:43], v205 offset:6144
  v_mfma_f32_32x32x16_bf16 v[16:31], a[236:239], v[44:47], v[16:31]
  s_waitcnt lgkmcnt(2)
  v_mfma_f32_32x32x16_bf16 v[0:15], a[96:99], v[32:35], v[0:15]
  ds_read_b128 v[44:47], v206 offset:6144
  v_mfma_f32_32x32x16_bf16 v[16:31], a[240:243], v[32:35], v[16:31]
  s_waitcnt lgkmcnt(2)
  v_mfma_f32_32x32x16_bf16 v[0:15], a[100:103], v[36:39], v[0:15]
  ds_read_b128 v[32:35], v203 offset:7168
  v_mfma_f32_32x32x16_bf16 v[16:31], a[244:247], v[36:39], v[16:31]
  s_waitcnt lgkmcnt(2)
  v_mfma_f32_32x32x16_bf16 v[0:15], a[104:107], v[40:43], v[0:15]
  ds_read_b128 v[36:39], v204 offset:7168
  v_mfma_f32_32x32x16_bf16 v[16:31], a[248:251], v[40:43], v[16:31]
  s_waitcnt lgkmcnt(2)
  v_mfma_f32_32x32x16_bf16 v[0:15], a[108:111], v[44:47], v[0:15]
  ds_read_b128 v[40:43], v205 offset:7168
  v_mfma_f32_32x32x16_bf16 v[16:31], a[252:255], v[44:47], v[16:31]
  s_waitcnt lgkmcnt(2)
  v_mfma_f32_32x32x16_bf16 v[0:15], a[112:115], v[32:35], v[0:15]
  ds_read_b128 v[44:47], v206 offset:7168
  v_mfma_f32_32x32x16_bf16 v[16:31], v[224:227], v[32:35], v[16:31]
  s_waitcnt lgkmcnt(2)
  v_mfma_f32_32x32x16_bf16 v[0:15], a[116:119], v[36:39], v[0:15]
  ds_read_b128 v[32:35], v203 offset:8192
  v_mfma_f32_32x32x16_bf16 v[16:31], v[228:231], v[36:39], v[16:31]
  s_waitcnt lgkmcnt(2)
  v_mfma_f32_32x32x16_bf16 v[0:15], a[120:123], v[40:43], v[0:15]
  ds_read_b128 v[36:39], v204 offset:8192
  v_mfma_f32_32x32x16_bf16 v[16:31], v[232:235], v[40:43], v[16:31]
  s_waitcnt lgkmcnt(2)
  v_mfma_f32_32x32x16_bf16 v[0:15], a[124:127], v[44:47], v[0:15]
  ds_read_b128 v[40:43], v205 offset:8192
  v_mfma_f32_32x32x16_bf16 v[16:31], v[236:239], v[44:47], v[16:31]
  s_waitcnt lgkmcnt(2)
  v_mfma_f32_32x32x16_bf16 v[0:15], a[128:131], v[32:35], v[0:15]
  ds_read_b128 v[44:47], v206 offset:8192
  v_mfma_f32_32x32x16_bf16 v[16:31], v[240:243], v[32:35], v[16:31]
  s_waitcnt lgkmcnt(2)
  v_mfma_f32_32x32x16_bf16 v[0:15], a[132:135], v[36:39], v[0:15]
  v_mfma_f32_32x32x16_bf16 v[16:31], v[244:247], v[36:39], v[16:31]
  s_waitcnt lgkmcnt(1)
  v_mfma_f32_32x32x16_bf16 v[0:15], a[136:139], v[40:43], v[0:15]
  v_mfma_f32_32x32x16_bf16 v[16:31], v[248:251], v[40:43], v[16:31]
  s_waitcnt lgkmcnt(0)
  v_mfma_f32_32x32x16_bf16 v[0:15], a[140:143], v[44:47], v[0:15]
  v_mfma_f32_32x32x16_bf16 v[16:31], v[252:255], v[44:47], v[16:31]
  s_nop 3
  v_cvt_pk_bf16_f32 v48, v0, v1
  v_cvt_pk_bf16_f32 v49, v2, v3
  ds_write2_b32 v218, v48, v49 offset0:0 offset1:1
  v_cvt_pk_bf16_f32 v48, v4, v5
  v_cvt_pk_bf16_f32 v49, v6, v7
  ds_write2_b32 v218, v48, v49 offset0:4 offset1:5
  v_cvt_pk_bf16_f32 v48, v8, v9
  v_cvt_pk_bf16_f32 v49, v10, v11
  ds_write2_b32 v218, v48, v49 offset0:8 offset1:9
  v_cvt_pk_bf16_f32 v48, v12, v13
  v_cvt_pk_bf16_f32 v49, v14, v15
  ds_write2_b32 v218, v48, v49 offset0:12 offset1:13
  v_cvt_pk_bf16_f32 v48, v16, v17
  v_cvt_pk_bf16_f32 v49, v18, v19
  ds_write2_b32 v218, v48, v49 offset0:64 offset1:65
  v_cvt_pk_bf16_f32 v48, v20, v21
  v_cvt_pk_bf16_f32 v49, v22, v23
  ds_write2_b32 v218, v48, v49 offset0:68 offset1:69
  v_cvt_pk_bf16_f32 v48, v24, v25
  v_cvt_pk_bf16_f32 v49, v26, v27
  ds_write2_b32 v218, v48, v49 offset0:72 offset1:73
  v_cvt_pk_bf16_f32 v48, v28, v29
  v_cvt_pk_bf16_f32 v49, v30, v31
  ds_write2_b32 v218, v48, v49 offset0:76 offset1:77
  v_add_u32 v218, 16512, v218
  s_waitcnt vmcnt(0) lgkmcnt(0)
  s_barrier
  v_mul_u32_u24 v219, 516, v200
  s_mul_i32 s54, s52, 36
  s_add_u32 s55, s54, 83016
  v_add_u32 v219, s55, v219
  v_mul_u32_u24 v220, 1152, v200
  s_mul_i32 s55, s68, 144
  s_add_u32 s54, s54, s55
  s_mul_i32 s55, s69, 147456
  s_add_u32 s64, s54, s55
  s_add_u32 s64, s64, 62914560
  s_lshl_b32 s66, s69, 7
  s_mov_b32 s57, 1051597459
  ds_read_b32 v0, v219 offset:7224
  ds_read_b32 v1, v219 offset:7228
  ds_read_b32 v2, v219 offset:7232
  ds_read_b32 v3, v219 offset:7236
  ds_read_b32 v4, v219 offset:7240
  ds_read_b32 v5, v219 offset:7244
  ds_read_b32 v6, v219 offset:7248
  ds_read_b32 v7, v219 offset:7252
  ds_read_b32 v8, v219 offset:7256
  ds_read_b32 v16, v219 offset:7368
  ds_read_b32 v17, v219 offset:7372
  ds_read_b32 v18, v219 offset:7376
  ds_read_b32 v19, v219 offset:7380
  ds_read_b32 v20, v219 offset:7384
  ds_read_b32 v21, v219 offset:7388
  ds_read_b32 v22, v219 offset:7392
  ds_read_b32 v23, v219 offset:7396
  ds_read_b32 v24, v219 offset:7400
  ds_read_b32 v25, v219 offset:6336
  ds_read_b32 v26, v219 offset:6340
  ds_read_b32 v27, v219 offset:6344
  ds_read_b32 v28, v219 offset:6348
  ds_read_b32 v29, v219 offset:6352
  ds_read_b32 v30, v219 offset:6356
  ds_read_b32 v31, v219 offset:6360
  ds_read_b32 v32, v219 offset:6364
  ds_read_b32 v33, v219 offset:6368
  ds_read_b32 v34, v219 offset:5304
  ds_read_b32 v35, v219 offset:5308
  ds_read_b32 v36, v219 offset:5312
  ds_read_b32 v37, v219 offset:5316
  ds_read_b32 v38, v219 offset:5320
  ds_read_b32 v39, v219 offset:5324
  ds_read_b32 v40, v219 offset:5328
  ds_read_b32 v41, v219 offset:5332
  ds_read_b32 v42, v219 offset:5336
  ds_read_b32 v43, v219 offset:4272
  ds_read_b32 v44, v219 offset:4276
  ds_read_b32 v45, v219 offset:4280
  ds_read_b32 v46, v219 offset:4284
  ds_read_b32 v47, v219 offset:4288
  ds_read_b32 v48, v219 offset:4292
  ds_read_b32 v49, v219 offset:4296
  ds_read_b32 v50, v219 offset:4300
  ds_read_b32 v51, v219 offset:4304
  ds_read_b32 v52, v219 offset:3240
  ds_read_b32 v53, v219 offset:3244
  ds_read_b32 v54, v219 offset:3248
  ds_read_b32 v55, v219 offset:3252
  ds_read_b32 v56, v219 offset:3256
  ds_read_b32 v57, v219 offset:3260
  ds_read_b32 v58, v219 offset:3264
  ds_read_b32 v59, v219 offset:3268
  ds_read_b32 v60, v219 offset:3272
  ds_read_b32 v61, v219 offset:2208
  ds_read_b32 v62, v219 offset:2212
  ds_read_b32 v63, v219 offset:2216
  ds_read_b32 v64, v219 offset:2220
  ds_read_b32 v65, v219 offset:2224
  ds_read_b32 v66, v219 offset:2228
  ds_read_b32 v67, v219 offset:2232
  ds_read_b32 v68, v219 offset:2236
  ds_read_b32 v69, v219 offset:2240
  ds_read_b32 v70, v219 offset:1176
  ds_read_b32 v71, v219 offset:1180
  ds_read_b32 v72, v219 offset:1184
  ds_read_b32 v73, v219 offset:1188
  ds_read_b32 v74, v219 offset:1192
  ds_read_b32 v75, v219 offset:1196
  ds_read_b32 v76, v219 offset:1200
  ds_read_b32 v77, v219 offset:1204
  ds_read_b32 v78, v219 offset:1208
  ds_read_b32 v79, v219 offset:144
  ds_read_b32 v80, v219 offset:148
  ds_read_b32 v81, v219 offset:152
  ds_read_b32 v82, v219 offset:156
  ds_read_b32 v83, v219 offset:160
  ds_read_b32 v84, v219 offset:164
  ds_read_b32 v85, v219 offset:168
  ds_read_b32 v86, v219 offset:172
  ds_read_b32 v87, v219 offset:176
  v_mov_b32 v100, 0
  v_mov_b32 v101, 0
  v_mov_b32 v102, 0
  v_mov_b32 v103, 0
  v_mov_b32 v104, 0
  v_mov_b32 v105, 0
  v_mov_b32 v106, 0
  v_mov_b32 v107, 0
  s_waitcnt lgkmcnt(15)
  v_dot2c_f32_bf16 v100, v0, v16
  v_dot2c_f32_bf16 v101, v0, v25
  v_dot2c_f32_bf16 v102, v0, v34
  v_dot2c_f32_bf16 v103, v0, v43
  v_dot2c_f32_bf16 v104, v0, v52
  v_dot2c_f32_bf16 v105, v0, v61
  v_dot2c_f32_bf16 v106, v0, v70
  s_waitcnt lgkmcnt(8)
  v_dot2c_f32_bf16 v107, v0, v79
  v_dot2c_f32_bf16 v100, v1, v17
  v_dot2c_f32_bf16 v101, v1, v26
  v_dot2c_f32_bf16 v102, v1, v35
  v_dot2c_f32_bf16 v103, v1, v44
  v_dot2c_f32_bf16 v104, v1, v53
  v_dot2c_f32_bf16 v105, v1, v62
  v_dot2c_f32_bf16 v106, v1, v71
  s_waitcnt lgkmcnt(7)
  v_dot2c_f32_bf16 v107, v1, v80
  v_dot2c_f32_bf16 v100, v2, v18
  v_dot2c_f32_bf16 v101, v2, v27
  v_dot2c_f32_bf16 v102, v2, v36
  v_dot2c_f32_bf16 v103, v2, v45
  v_dot2c_f32_bf16 v104, v2, v54
  v_dot2c_f32_bf16 v105, v2, v63
  v_dot2c_f32_bf16 v106, v2, v72
  s_waitcnt lgkmcnt(6)
  v_dot2c_f32_bf16 v107, v2, v81
  v_dot2c_f32_bf16 v100, v3, v19
  v_dot2c_f32_bf16 v101, v3, v28
  v_dot2c_f32_bf16 v102, v3, v37
  v_dot2c_f32_bf16 v103, v3, v46
  v_dot2c_f32_bf16 v104, v3, v55
  v_dot2c_f32_bf16 v105, v3, v64
  v_dot2c_f32_bf16 v106, v3, v73
  s_waitcnt lgkmcnt(5)
  v_dot2c_f32_bf16 v107, v3, v82
  v_dot2c_f32_bf16 v100, v4, v20
  v_dot2c_f32_bf16 v101, v4, v29
  v_dot2c_f32_bf16 v102, v4, v38
  v_dot2c_f32_bf16 v103, v4, v47
  v_dot2c_f32_bf16 v104, v4, v56
  v_dot2c_f32_bf16 v105, v4, v65
  v_dot2c_f32_bf16 v106, v4, v74
  s_waitcnt lgkmcnt(4)
  v_dot2c_f32_bf16 v107, v4, v83
  v_dot2c_f32_bf16 v100, v5, v21
  v_dot2c_f32_bf16 v101, v5, v30
  v_dot2c_f32_bf16 v102, v5, v39
  v_dot2c_f32_bf16 v103, v5, v48
  v_dot2c_f32_bf16 v104, v5, v57
  v_dot2c_f32_bf16 v105, v5, v66
  v_dot2c_f32_bf16 v106, v5, v75
  s_waitcnt lgkmcnt(3)
  v_dot2c_f32_bf16 v107, v5, v84
  v_dot2c_f32_bf16 v100, v6, v22
  v_dot2c_f32_bf16 v101, v6, v31
  v_dot2c_f32_bf16 v102, v6, v40
  v_dot2c_f32_bf16 v103, v6, v49
  v_dot2c_f32_bf16 v104, v6, v58
  v_dot2c_f32_bf16 v105, v6, v67
  v_dot2c_f32_bf16 v106, v6, v76
  s_waitcnt lgkmcnt(2)
  v_dot2c_f32_bf16 v107, v6, v85
  v_dot2c_f32_bf16 v100, v7, v23
  v_dot2c_f32_bf16 v101, v7, v32
  v_dot2c_f32_bf16 v102, v7, v41
  v_dot2c_f32_bf16 v103, v7, v50
  v_dot2c_f32_bf16 v104, v7, v59
  v_dot2c_f32_bf16 v105, v7, v68
  v_dot2c_f32_bf16 v106, v7, v77
  s_waitcnt lgkmcnt(1)
  v_dot2c_f32_bf16 v107, v7, v86
  v_dot2c_f32_bf16 v100, v8, v24
  v_dot2c_f32_bf16 v101, v8, v33
  v_dot2c_f32_bf16 v102, v8, v42
  v_dot2c_f32_bf16 v103, v8, v51
  v_dot2c_f32_bf16 v104, v8, v60
  v_dot2c_f32_bf16 v105, v8, v69
  v_dot2c_f32_bf16 v106, v8, v78
  s_waitcnt lgkmcnt(0)
  v_dot2c_f32_bf16 v107, v8, v87
  ds_read_b32 v16, v219 offset:7512
  ds_read_b32 v17, v219 offset:7516
  ds_read_b32 v18, v219 offset:7520
  ds_read_b32 v19, v219 offset:7524
  ds_read_b32 v20, v219 offset:7528
  ds_read_b32 v21, v219 offset:7532
  ds_read_b32 v22, v219 offset:7536
  ds_read_b32 v23, v219 offset:7540
  ds_read_b32 v24, v219 offset:7544
  ds_read_b32 v25, v219 offset:6480
  ds_read_b32 v26, v219 offset:6484
  ds_read_b32 v27, v219 offset:6488
  ds_read_b32 v28, v219 offset:6492
  ds_read_b32 v29, v219 offset:6496
  ds_read_b32 v30, v219 offset:6500
  ds_read_b32 v31, v219 offset:6504
  ds_read_b32 v32, v219 offset:6508
  ds_read_b32 v33, v219 offset:6512
  ds_read_b32 v34, v219 offset:5448
  ds_read_b32 v35, v219 offset:5452
  ds_read_b32 v36, v219 offset:5456
  ds_read_b32 v37, v219 offset:5460
  ds_read_b32 v38, v219 offset:5464
  ds_read_b32 v39, v219 offset:5468
  ds_read_b32 v40, v219 offset:5472
  ds_read_b32 v41, v219 offset:5476
  ds_read_b32 v42, v219 offset:5480
  ds_read_b32 v43, v219 offset:4416
  ds_read_b32 v44, v219 offset:4420
  ds_read_b32 v45, v219 offset:4424
  ds_read_b32 v46, v219 offset:4428
  ds_read_b32 v47, v219 offset:4432
  ds_read_b32 v48, v219 offset:4436
  ds_read_b32 v49, v219 offset:4440
  ds_read_b32 v50, v219 offset:4444
  ds_read_b32 v51, v219 offset:4448
  ds_read_b32 v52, v219 offset:3384
  ds_read_b32 v53, v219 offset:3388
  ds_read_b32 v54, v219 offset:3392
  ds_read_b32 v55, v219 offset:3396
  ds_read_b32 v56, v219 offset:3400
  ds_read_b32 v57, v219 offset:3404
  ds_read_b32 v58, v219 offset:3408
  ds_read_b32 v59, v219 offset:3412
  ds_read_b32 v60, v219 offset:3416
  ds_read_b32 v61, v219 offset:2352
  ds_read_b32 v62, v219 offset:2356
  ds_read_b32 v63, v219 offset:2360
  ds_read_b32 v64, v219 offset:2364
  ds_read_b32 v65, v219 offset:2368
  ds_read_b32 v66, v219 offset:2372
  ds_read_b32 v67, v219 offset:2376
  ds_read_b32 v68, v219 offset:2380
  ds_read_b32 v69, v219 offset:2384
  ds_read_b32 v70, v219 offset:1320
  ds_read_b32 v71, v219 offset:1324
  ds_read_b32 v72, v219 offset:1328
  ds_read_b32 v73, v219 offset:1332
  ds_read_b32 v74, v219 offset:1336
  ds_read_b32 v75, v219 offset:1340
  ds_read_b32 v76, v219 offset:1344
  ds_read_b32 v77, v219 offset:1348
  ds_read_b32 v78, v219 offset:1352
  ds_read_b32 v79, v219 offset:288
  ds_read_b32 v80, v219 offset:292
  ds_read_b32 v81, v219 offset:296
  ds_read_b32 v82, v219 offset:300
  ds_read_b32 v83, v219 offset:304
  ds_read_b32 v84, v219 offset:308
  ds_read_b32 v85, v219 offset:312
  ds_read_b32 v86, v219 offset:316
  ds_read_b32 v87, v219 offset:320
  v_add_u32 v211, s66, v200
  v_mov_b32 v212, 0xf149f2ca
  v_mul_f32 v100, s57, v100
  v_mul_f32 v101, s57, v101
  v_mul_f32 v102, s57, v102
  v_mul_f32 v103, s57, v103
  v_mul_f32 v104, s57, v104
  v_mul_f32 v105, s57, v105
  v_mul_f32 v106, s57, v106
  v_mul_f32 v107, s57, v107
  v_cmp_gt_u32 vcc, 2, v211
  s_nop 1
  v_cndmask_b32 v101, v101, v212, vcc
  v_cmp_gt_u32 vcc, 4, v211
  s_nop 1
  v_cndmask_b32 v102, v102, v212, vcc
  v_cmp_gt_u32 vcc, 6, v211
  s_nop 1
  v_cndmask_b32 v103, v103, v212, vcc
  v_cmp_gt_u32 vcc, 8, v211
  s_nop 1
  v_cndmask_b32 v104, v104, v212, vcc
  v_cmp_gt_u32 vcc, 10, v211
  s_nop 1
  v_cndmask_b32 v105, v105, v212, vcc
  v_cmp_gt_u32 vcc, 12, v211
  s_nop 1
  v_cndmask_b32 v106, v106, v212, vcc
  v_cmp_gt_u32 vcc, 14, v211
  s_nop 1
  v_cndmask_b32 v107, v107, v212, vcc
  v_max3_f32 v213, v100, v101, v102
  v_max3_f32 v213, v213, v103, v104
  v_max3_f32 v213, v213, v105, v106
  v_max_f32 v213, v213, v107
  v_sub_f32 v100, v100, v213
  v_sub_f32 v101, v101, v213
  v_sub_f32 v102, v102, v213
  v_sub_f32 v103, v103, v213
  v_sub_f32 v104, v104, v213
  v_sub_f32 v105, v105, v213
  v_sub_f32 v106, v106, v213
  v_sub_f32 v107, v107, v213
  v_exp_f32 v100, v100
  v_exp_f32 v101, v101
  v_exp_f32 v102, v102
  v_exp_f32 v103, v103
  v_exp_f32 v104, v104
  v_exp_f32 v105, v105
  v_exp_f32 v106, v106
  v_exp_f32 v107, v107
  v_add_f32 v213, v100, v101
  v_add_f32 v213, v213, v102
  v_add_f32 v213, v213, v103
  v_add_f32 v213, v213, v104
  v_add_f32 v213, v213, v105
  v_add_f32 v213, v213, v106
  v_add_f32 v213, v213, v107
  v_rcp_f32 v213, v213
  v_mov_b32 v214, 0
  v_mul_f32 v100, v213, v100
  v_mul_f32 v101, v213, v101
  v_mul_f32 v102, v213, v102
  v_mul_f32 v103, v213, v103
  v_mul_f32 v104, v213, v104
  v_mul_f32 v105, v213, v105
  v_mul_f32 v106, v213, v106
  v_mul_f32 v107, v213, v107
  v_mov_b32 v112, 0
  v_mov_b32 v113, 0
  v_mov_b32 v114, 0
  v_mov_b32 v115, 0
  v_mov_b32 v116, 0
  v_mov_b32 v117, 0
  v_mov_b32 v118, 0
  v_mov_b32 v119, 0
  v_mov_b32 v120, 0
  v_mov_b32 v121, 0
  v_mov_b32 v122, 0
  v_mov_b32 v123, 0
  v_mov_b32 v124, 0
  v_mov_b32 v125, 0
  v_mov_b32 v126, 0
  v_mov_b32 v127, 0
  v_mov_b32 v128, 0
  v_mov_b32 v129, 0
  v_cvt_pk_bf16_f32 v0, v100, v214
  v_cvt_pk_bf16_f32 v1, v214, v100
  s_waitcnt lgkmcnt(15)
  v_dot2c_f32_bf16 v112, v16, v0
  v_dot2c_f32_bf16 v113, v16, v1
  v_dot2c_f32_bf16 v114, v17, v0
  v_dot2c_f32_bf16 v115, v17, v1
  v_dot2c_f32_bf16 v116, v18, v0
  v_dot2c_f32_bf16 v117, v18, v1
  v_dot2c_f32_bf16 v118, v19, v0
  v_dot2c_f32_bf16 v119, v19, v1
  v_dot2c_f32_bf16 v120, v20, v0
  v_dot2c_f32_bf16 v121, v20, v1
  v_dot2c_f32_bf16 v122, v21, v0
  v_dot2c_f32_bf16 v123, v21, v1
  v_dot2c_f32_bf16 v124, v22, v0
  v_dot2c_f32_bf16 v125, v22, v1
  v_dot2c_f32_bf16 v126, v23, v0
  v_dot2c_f32_bf16 v127, v23, v1
  v_dot2c_f32_bf16 v128, v24, v0
  v_dot2c_f32_bf16 v129, v24, v1
  v_cvt_pk_bf16_f32 v2, v101, v214
  v_cvt_pk_bf16_f32 v3, v214, v101
  v_dot2c_f32_bf16 v112, v25, v2
  v_dot2c_f32_bf16 v113, v25, v3
  v_dot2c_f32_bf16 v114, v26, v2
  v_dot2c_f32_bf16 v115, v26, v3
  v_dot2c_f32_bf16 v116, v27, v2
  v_dot2c_f32_bf16 v117, v27, v3
  v_dot2c_f32_bf16 v118, v28, v2
  v_dot2c_f32_bf16 v119, v28, v3
  v_dot2c_f32_bf16 v120, v29, v2
  v_dot2c_f32_bf16 v121, v29, v3
  v_dot2c_f32_bf16 v122, v30, v2
  v_dot2c_f32_bf16 v123, v30, v3
  v_dot2c_f32_bf16 v124, v31, v2
  v_dot2c_f32_bf16 v125, v31, v3
  v_dot2c_f32_bf16 v126, v32, v2
  v_dot2c_f32_bf16 v127, v32, v3
  v_dot2c_f32_bf16 v128, v33, v2
  v_dot2c_f32_bf16 v129, v33, v3
  v_cvt_pk_bf16_f32 v0, v102, v214
  v_cvt_pk_bf16_f32 v1, v214, v102
  v_dot2c_f32_bf16 v112, v34, v0
  v_dot2c_f32_bf16 v113, v34, v1
  v_dot2c_f32_bf16 v114, v35, v0
  v_dot2c_f32_bf16 v115, v35, v1
  v_dot2c_f32_bf16 v116, v36, v0
  v_dot2c_f32_bf16 v117, v36, v1
  v_dot2c_f32_bf16 v118, v37, v0
  v_dot2c_f32_bf16 v119, v37, v1
  v_dot2c_f32_bf16 v120, v38, v0
  v_dot2c_f32_bf16 v121, v38, v1
  v_dot2c_f32_bf16 v122, v39, v0
  v_dot2c_f32_bf16 v123, v39, v1
  v_dot2c_f32_bf16 v124, v40, v0
  v_dot2c_f32_bf16 v125, v40, v1
  v_dot2c_f32_bf16 v126, v41, v0
  v_dot2c_f32_bf16 v127, v41, v1
  v_dot2c_f32_bf16 v128, v42, v0
  v_dot2c_f32_bf16 v129, v42, v1
  v_cvt_pk_bf16_f32 v2, v103, v214
  v_cvt_pk_bf16_f32 v3, v214, v103
  v_dot2c_f32_bf16 v112, v43, v2
  v_dot2c_f32_bf16 v113, v43, v3
  v_dot2c_f32_bf16 v114, v44, v2
  v_dot2c_f32_bf16 v115, v44, v3
  v_dot2c_f32_bf16 v116, v45, v2
  v_dot2c_f32_bf16 v117, v45, v3
  v_dot2c_f32_bf16 v118, v46, v2
  v_dot2c_f32_bf16 v119, v46, v3
  v_dot2c_f32_bf16 v120, v47, v2
  v_dot2c_f32_bf16 v121, v47, v3
  v_dot2c_f32_bf16 v122, v48, v2
  v_dot2c_f32_bf16 v123, v48, v3
  v_dot2c_f32_bf16 v124, v49, v2
  v_dot2c_f32_bf16 v125, v49, v3
  v_dot2c_f32_bf16 v126, v50, v2
  v_dot2c_f32_bf16 v127, v50, v3
  v_dot2c_f32_bf16 v128, v51, v2
  v_dot2c_f32_bf16 v129, v51, v3
  v_cvt_pk_bf16_f32 v0, v104, v214
  v_cvt_pk_bf16_f32 v1, v214, v104
  v_dot2c_f32_bf16 v112, v52, v0
  v_dot2c_f32_bf16 v113, v52, v1
  v_dot2c_f32_bf16 v114, v53, v0
  v_dot2c_f32_bf16 v115, v53, v1
  v_dot2c_f32_bf16 v116, v54, v0
  v_dot2c_f32_bf16 v117, v54, v1
  v_dot2c_f32_bf16 v118, v55, v0
  v_dot2c_f32_bf16 v119, v55, v1
  v_dot2c_f32_bf16 v120, v56, v0
  v_dot2c_f32_bf16 v121, v56, v1
  v_dot2c_f32_bf16 v122, v57, v0
  v_dot2c_f32_bf16 v123, v57, v1
  v_dot2c_f32_bf16 v124, v58, v0
  v_dot2c_f32_bf16 v125, v58, v1
  v_dot2c_f32_bf16 v126, v59, v0
  v_dot2c_f32_bf16 v127, v59, v1
  v_dot2c_f32_bf16 v128, v60, v0
  v_dot2c_f32_bf16 v129, v60, v1
  v_cvt_pk_bf16_f32 v2, v105, v214
  v_cvt_pk_bf16_f32 v3, v214, v105
  v_dot2c_f32_bf16 v112, v61, v2
  v_dot2c_f32_bf16 v113, v61, v3
  v_dot2c_f32_bf16 v114, v62, v2
  v_dot2c_f32_bf16 v115, v62, v3
  v_dot2c_f32_bf16 v116, v63, v2
  v_dot2c_f32_bf16 v117, v63, v3
  v_dot2c_f32_bf16 v118, v64, v2
  v_dot2c_f32_bf16 v119, v64, v3
  v_dot2c_f32_bf16 v120, v65, v2
  v_dot2c_f32_bf16 v121, v65, v3
  v_dot2c_f32_bf16 v122, v66, v2
  v_dot2c_f32_bf16 v123, v66, v3
  v_dot2c_f32_bf16 v124, v67, v2
  v_dot2c_f32_bf16 v125, v67, v3
  v_dot2c_f32_bf16 v126, v68, v2
  v_dot2c_f32_bf16 v127, v68, v3
  v_dot2c_f32_bf16 v128, v69, v2
  v_dot2c_f32_bf16 v129, v69, v3
  v_cvt_pk_bf16_f32 v0, v106, v214
  v_cvt_pk_bf16_f32 v1, v214, v106
  v_dot2c_f32_bf16 v112, v70, v0
  v_dot2c_f32_bf16 v113, v70, v1
  v_dot2c_f32_bf16 v114, v71, v0
  v_dot2c_f32_bf16 v115, v71, v1
  v_dot2c_f32_bf16 v116, v72, v0
  v_dot2c_f32_bf16 v117, v72, v1
  s_waitcnt lgkmcnt(14)
  v_dot2c_f32_bf16 v118, v73, v0
  v_dot2c_f32_bf16 v119, v73, v1
  s_waitcnt lgkmcnt(13)
  v_dot2c_f32_bf16 v120, v74, v0
  v_dot2c_f32_bf16 v121, v74, v1
  s_waitcnt lgkmcnt(12)
  v_dot2c_f32_bf16 v122, v75, v0
  v_dot2c_f32_bf16 v123, v75, v1
  s_waitcnt lgkmcnt(11)
  v_dot2c_f32_bf16 v124, v76, v0
  v_dot2c_f32_bf16 v125, v76, v1
  s_waitcnt lgkmcnt(10)
  v_dot2c_f32_bf16 v126, v77, v0
  v_dot2c_f32_bf16 v127, v77, v1
  s_waitcnt lgkmcnt(9)
  v_dot2c_f32_bf16 v128, v78, v0
  v_dot2c_f32_bf16 v129, v78, v1
  v_cvt_pk_bf16_f32 v2, v107, v214
  v_cvt_pk_bf16_f32 v3, v214, v107
  s_waitcnt lgkmcnt(8)
  v_dot2c_f32_bf16 v112, v79, v2
  v_dot2c_f32_bf16 v113, v79, v3
  s_waitcnt lgkmcnt(7)
  v_dot2c_f32_bf16 v114, v80, v2
  v_dot2c_f32_bf16 v115, v80, v3
  s_waitcnt lgkmcnt(6)
  v_dot2c_f32_bf16 v116, v81, v2
  v_dot2c_f32_bf16 v117, v81, v3
  s_waitcnt lgkmcnt(5)
  v_dot2c_f32_bf16 v118, v82, v2
  v_dot2c_f32_bf16 v119, v82, v3
  s_waitcnt lgkmcnt(4)
  v_dot2c_f32_bf16 v120, v83, v2
  v_dot2c_f32_bf16 v121, v83, v3
  s_waitcnt lgkmcnt(3)
  v_dot2c_f32_bf16 v122, v84, v2
  v_dot2c_f32_bf16 v123, v84, v3
  s_waitcnt lgkmcnt(2)
  v_dot2c_f32_bf16 v124, v85, v2
  v_dot2c_f32_bf16 v125, v85, v3
  s_waitcnt lgkmcnt(1)
  v_dot2c_f32_bf16 v126, v86, v2
  v_dot2c_f32_bf16 v127, v86, v3
  s_waitcnt lgkmcnt(0)
  v_dot2c_f32_bf16 v128, v87, v2
  v_dot2c_f32_bf16 v129, v87, v3
  v_cvt_pk_bf16_f32 v132, v112, v113
  v_cvt_pk_bf16_f32 v133, v114, v115
  v_cvt_pk_bf16_f32 v134, v116, v117
  v_cvt_pk_bf16_f32 v135, v118, v119
  v_cvt_pk_bf16_f32 v136, v120, v121
  v_cvt_pk_bf16_f32 v137, v122, v123
  v_cvt_pk_bf16_f32 v138, v124, v125
  v_cvt_pk_bf16_f32 v139, v126, v127
  v_cvt_pk_bf16_f32 v140, v128, v129
  buffer_store_dwordx4 v[132:135], v220, s[8:11], s64 offen sc1
  buffer_store_dwordx4 v[136:139], v220, s[8:11], s64 offen offset:16 sc1
  buffer_store_dword v140, v220, s[8:11], s64 offen offset:32 sc1
  v_add_u32 v219, 33024, v219
  s_add_u32 s66, s66, 64
  s_add_u32 s64, s64, 73728
  ds_read_b32 v0, v219 offset:7224
  ds_read_b32 v1, v219 offset:7228
  ds_read_b32 v2, v219 offset:7232
  ds_read_b32 v3, v219 offset:7236
  ds_read_b32 v4, v219 offset:7240
  ds_read_b32 v5, v219 offset:7244
  ds_read_b32 v6, v219 offset:7248
  ds_read_b32 v7, v219 offset:7252
  ds_read_b32 v8, v219 offset:7256
  ds_read_b32 v16, v219 offset:7368
  ds_read_b32 v17, v219 offset:7372
  ds_read_b32 v18, v219 offset:7376
  ds_read_b32 v19, v219 offset:7380
  ds_read_b32 v20, v219 offset:7384
  ds_read_b32 v21, v219 offset:7388
  ds_read_b32 v22, v219 offset:7392
  ds_read_b32 v23, v219 offset:7396
  ds_read_b32 v24, v219 offset:7400
  ds_read_b32 v25, v219 offset:6336
  ds_read_b32 v26, v219 offset:6340
  ds_read_b32 v27, v219 offset:6344
  ds_read_b32 v28, v219 offset:6348
  ds_read_b32 v29, v219 offset:6352
  ds_read_b32 v30, v219 offset:6356
  ds_read_b32 v31, v219 offset:6360
  ds_read_b32 v32, v219 offset:6364
  ds_read_b32 v33, v219 offset:6368
  ds_read_b32 v34, v219 offset:5304
  ds_read_b32 v35, v219 offset:5308
  ds_read_b32 v36, v219 offset:5312
  ds_read_b32 v37, v219 offset:5316
  ds_read_b32 v38, v219 offset:5320
  ds_read_b32 v39, v219 offset:5324
  ds_read_b32 v40, v219 offset:5328
  ds_read_b32 v41, v219 offset:5332
  ds_read_b32 v42, v219 offset:5336
  ds_read_b32 v43, v219 offset:4272
  ds_read_b32 v44, v219 offset:4276
  ds_read_b32 v45, v219 offset:4280
  ds_read_b32 v46, v219 offset:4284
  ds_read_b32 v47, v219 offset:4288
  ds_read_b32 v48, v219 offset:4292
  ds_read_b32 v49, v219 offset:4296
  ds_read_b32 v50, v219 offset:4300
  ds_read_b32 v51, v219 offset:4304
  ds_read_b32 v52, v219 offset:3240
  ds_read_b32 v53, v219 offset:3244
  ds_read_b32 v54, v219 offset:3248
  ds_read_b32 v55, v219 offset:3252
  ds_read_b32 v56, v219 offset:3256
  ds_read_b32 v57, v219 offset:3260
  ds_read_b32 v58, v219 offset:3264
  ds_read_b32 v59, v219 offset:3268
  ds_read_b32 v60, v219 offset:3272
  ds_read_b32 v61, v219 offset:2208
  ds_read_b32 v62, v219 offset:2212
  ds_read_b32 v63, v219 offset:2216
  ds_read_b32 v64, v219 offset:2220
  ds_read_b32 v65, v219 offset:2224
  ds_read_b32 v66, v219 offset:2228
  ds_read_b32 v67, v219 offset:2232
  ds_read_b32 v68, v219 offset:2236
  ds_read_b32 v69, v219 offset:2240
  ds_read_b32 v70, v219 offset:1176
  ds_read_b32 v71, v219 offset:1180
  ds_read_b32 v72, v219 offset:1184
  ds_read_b32 v73, v219 offset:1188
  ds_read_b32 v74, v219 offset:1192
  ds_read_b32 v75, v219 offset:1196
  ds_read_b32 v76, v219 offset:1200
  ds_read_b32 v77, v219 offset:1204
  ds_read_b32 v78, v219 offset:1208
  ds_read_b32 v79, v219 offset:144
  ds_read_b32 v80, v219 offset:148
  ds_read_b32 v81, v219 offset:152
  ds_read_b32 v82, v219 offset:156
  ds_read_b32 v83, v219 offset:160
  ds_read_b32 v84, v219 offset:164
  ds_read_b32 v85, v219 offset:168
  ds_read_b32 v86, v219 offset:172
  ds_read_b32 v87, v219 offset:176
  v_mov_b32 v100, 0
  v_mov_b32 v101, 0
  v_mov_b32 v102, 0
  v_mov_b32 v103, 0
  v_mov_b32 v104, 0
  v_mov_b32 v105, 0
  v_mov_b32 v106, 0
  v_mov_b32 v107, 0
  s_waitcnt lgkmcnt(15)
  v_dot2c_f32_bf16 v100, v0, v16
  v_dot2c_f32_bf16 v101, v0, v25
  v_dot2c_f32_bf16 v102, v0, v34
  v_dot2c_f32_bf16 v103, v0, v43
  v_dot2c_f32_bf16 v104, v0, v52
  v_dot2c_f32_bf16 v105, v0, v61
  v_dot2c_f32_bf16 v106, v0, v70
  s_waitcnt lgkmcnt(8)
  v_dot2c_f32_bf16 v107, v0, v79
  v_dot2c_f32_bf16 v100, v1, v17
  v_dot2c_f32_bf16 v101, v1, v26
  v_dot2c_f32_bf16 v102, v1, v35
  v_dot2c_f32_bf16 v103, v1, v44
  v_dot2c_f32_bf16 v104, v1, v53
  v_dot2c_f32_bf16 v105, v1, v62
  v_dot2c_f32_bf16 v106, v1, v71
  s_waitcnt lgkmcnt(7)
  v_dot2c_f32_bf16 v107, v1, v80
  v_dot2c_f32_bf16 v100, v2, v18
  v_dot2c_f32_bf16 v101, v2, v27
  v_dot2c_f32_bf16 v102, v2, v36
  v_dot2c_f32_bf16 v103, v2, v45
  v_dot2c_f32_bf16 v104, v2, v54
  v_dot2c_f32_bf16 v105, v2, v63
  v_dot2c_f32_bf16 v106, v2, v72
  s_waitcnt lgkmcnt(6)
  v_dot2c_f32_bf16 v107, v2, v81
  v_dot2c_f32_bf16 v100, v3, v19
  v_dot2c_f32_bf16 v101, v3, v28
  v_dot2c_f32_bf16 v102, v3, v37
  v_dot2c_f32_bf16 v103, v3, v46
  v_dot2c_f32_bf16 v104, v3, v55
  v_dot2c_f32_bf16 v105, v3, v64
  v_dot2c_f32_bf16 v106, v3, v73
  s_waitcnt lgkmcnt(5)
  v_dot2c_f32_bf16 v107, v3, v82
  v_dot2c_f32_bf16 v100, v4, v20
  v_dot2c_f32_bf16 v101, v4, v29
  v_dot2c_f32_bf16 v102, v4, v38
  v_dot2c_f32_bf16 v103, v4, v47
  v_dot2c_f32_bf16 v104, v4, v56
  v_dot2c_f32_bf16 v105, v4, v65
  v_dot2c_f32_bf16 v106, v4, v74
  s_waitcnt lgkmcnt(4)
  v_dot2c_f32_bf16 v107, v4, v83
  v_dot2c_f32_bf16 v100, v5, v21
  v_dot2c_f32_bf16 v101, v5, v30
  v_dot2c_f32_bf16 v102, v5, v39
  v_dot2c_f32_bf16 v103, v5, v48
  v_dot2c_f32_bf16 v104, v5, v57
  v_dot2c_f32_bf16 v105, v5, v66
  v_dot2c_f32_bf16 v106, v5, v75
  s_waitcnt lgkmcnt(3)
  v_dot2c_f32_bf16 v107, v5, v84
  v_dot2c_f32_bf16 v100, v6, v22
  v_dot2c_f32_bf16 v101, v6, v31
  v_dot2c_f32_bf16 v102, v6, v40
  v_dot2c_f32_bf16 v103, v6, v49
  v_dot2c_f32_bf16 v104, v6, v58
  v_dot2c_f32_bf16 v105, v6, v67
  v_dot2c_f32_bf16 v106, v6, v76
  s_waitcnt lgkmcnt(2)
  v_dot2c_f32_bf16 v107, v6, v85
  v_dot2c_f32_bf16 v100, v7, v23
  v_dot2c_f32_bf16 v101, v7, v32
  v_dot2c_f32_bf16 v102, v7, v41
  v_dot2c_f32_bf16 v103, v7, v50
  v_dot2c_f32_bf16 v104, v7, v59
  v_dot2c_f32_bf16 v105, v7, v68
  v_dot2c_f32_bf16 v106, v7, v77
  s_waitcnt lgkmcnt(1)
  v_dot2c_f32_bf16 v107, v7, v86
  v_dot2c_f32_bf16 v100, v8, v24
  v_dot2c_f32_bf16 v101, v8, v33
  v_dot2c_f32_bf16 v102, v8, v42
  v_dot2c_f32_bf16 v103, v8, v51
  v_dot2c_f32_bf16 v104, v8, v60
  v_dot2c_f32_bf16 v105, v8, v69
  v_dot2c_f32_bf16 v106, v8, v78
  s_waitcnt lgkmcnt(0)
  v_dot2c_f32_bf16 v107, v8, v87
  ds_read_b32 v16, v219 offset:7512
  ds_read_b32 v17, v219 offset:7516
  ds_read_b32 v18, v219 offset:7520
  ds_read_b32 v19, v219 offset:7524
  ds_read_b32 v20, v219 offset:7528
  ds_read_b32 v21, v219 offset:7532
  ds_read_b32 v22, v219 offset:7536
  ds_read_b32 v23, v219 offset:7540
  ds_read_b32 v24, v219 offset:7544
  ds_read_b32 v25, v219 offset:6480
  ds_read_b32 v26, v219 offset:6484
  ds_read_b32 v27, v219 offset:6488
  ds_read_b32 v28, v219 offset:6492
  ds_read_b32 v29, v219 offset:6496
  ds_read_b32 v30, v219 offset:6500
  ds_read_b32 v31, v219 offset:6504
  ds_read_b32 v32, v219 offset:6508
  ds_read_b32 v33, v219 offset:6512
  ds_read_b32 v34, v219 offset:5448
  ds_read_b32 v35, v219 offset:5452
  ds_read_b32 v36, v219 offset:5456
  ds_read_b32 v37, v219 offset:5460
  ds_read_b32 v38, v219 offset:5464
  ds_read_b32 v39, v219 offset:5468
  ds_read_b32 v40, v219 offset:5472
  ds_read_b32 v41, v219 offset:5476
  ds_read_b32 v42, v219 offset:5480
  ds_read_b32 v43, v219 offset:4416
  ds_read_b32 v44, v219 offset:4420
  ds_read_b32 v45, v219 offset:4424
  ds_read_b32 v46, v219 offset:4428
  ds_read_b32 v47, v219 offset:4432
  ds_read_b32 v48, v219 offset:4436
  ds_read_b32 v49, v219 offset:4440
  ds_read_b32 v50, v219 offset:4444
  ds_read_b32 v51, v219 offset:4448
  ds_read_b32 v52, v219 offset:3384
  ds_read_b32 v53, v219 offset:3388
  ds_read_b32 v54, v219 offset:3392
  ds_read_b32 v55, v219 offset:3396
  ds_read_b32 v56, v219 offset:3400
  ds_read_b32 v57, v219 offset:3404
  ds_read_b32 v58, v219 offset:3408
  ds_read_b32 v59, v219 offset:3412
  ds_read_b32 v60, v219 offset:3416
  ds_read_b32 v61, v219 offset:2352
  ds_read_b32 v62, v219 offset:2356
  ds_read_b32 v63, v219 offset:2360
  ds_read_b32 v64, v219 offset:2364
  ds_read_b32 v65, v219 offset:2368
  ds_read_b32 v66, v219 offset:2372
  ds_read_b32 v67, v219 offset:2376
  ds_read_b32 v68, v219 offset:2380
  ds_read_b32 v69, v219 offset:2384
  ds_read_b32 v70, v219 offset:1320
  ds_read_b32 v71, v219 offset:1324
  ds_read_b32 v72, v219 offset:1328
  ds_read_b32 v73, v219 offset:1332
  ds_read_b32 v74, v219 offset:1336
  ds_read_b32 v75, v219 offset:1340
  ds_read_b32 v76, v219 offset:1344
  ds_read_b32 v77, v219 offset:1348
  ds_read_b32 v78, v219 offset:1352
  ds_read_b32 v79, v219 offset:288
  ds_read_b32 v80, v219 offset:292
  ds_read_b32 v81, v219 offset:296
  ds_read_b32 v82, v219 offset:300
  ds_read_b32 v83, v219 offset:304
  ds_read_b32 v84, v219 offset:308
  ds_read_b32 v85, v219 offset:312
  ds_read_b32 v86, v219 offset:316
  ds_read_b32 v87, v219 offset:320
  v_add_u32 v211, s66, v200
  v_mov_b32 v212, 0xf149f2ca
  v_mul_f32 v100, s57, v100
  v_mul_f32 v101, s57, v101
  v_mul_f32 v102, s57, v102
  v_mul_f32 v103, s57, v103
  v_mul_f32 v104, s57, v104
  v_mul_f32 v105, s57, v105
  v_mul_f32 v106, s57, v106
  v_mul_f32 v107, s57, v107
  v_cmp_gt_u32 vcc, 2, v211
  s_nop 1
  v_cndmask_b32 v101, v101, v212, vcc
  v_cmp_gt_u32 vcc, 4, v211
  s_nop 1
  v_cndmask_b32 v102, v102, v212, vcc
  v_cmp_gt_u32 vcc, 6, v211
  s_nop 1
  v_cndmask_b32 v103, v103, v212, vcc
  v_cmp_gt_u32 vcc, 8, v211
  s_nop 1
  v_cndmask_b32 v104, v104, v212, vcc
  v_cmp_gt_u32 vcc, 10, v211
  s_nop 1
  v_cndmask_b32 v105, v105, v212, vcc
  v_cmp_gt_u32 vcc, 12, v211
  s_nop 1
  v_cndmask_b32 v106, v106, v212, vcc
  v_cmp_gt_u32 vcc, 14, v211
  s_nop 1
  v_cndmask_b32 v107, v107, v212, vcc
  v_max3_f32 v213, v100, v101, v102
  v_max3_f32 v213, v213, v103, v104
  v_max3_f32 v213, v213, v105, v106
  v_max_f32 v213, v213, v107
  v_sub_f32 v100, v100, v213
  v_sub_f32 v101, v101, v213
  v_sub_f32 v102, v102, v213
  v_sub_f32 v103, v103, v213
  v_sub_f32 v104, v104, v213
  v_sub_f32 v105, v105, v213
  v_sub_f32 v106, v106, v213
  v_sub_f32 v107, v107, v213
  v_exp_f32 v100, v100
  v_exp_f32 v101, v101
  v_exp_f32 v102, v102
  v_exp_f32 v103, v103
  v_exp_f32 v104, v104
  v_exp_f32 v105, v105
  v_exp_f32 v106, v106
  v_exp_f32 v107, v107
  v_add_f32 v213, v100, v101
  v_add_f32 v213, v213, v102
  v_add_f32 v213, v213, v103
  v_add_f32 v213, v213, v104
  v_add_f32 v213, v213, v105
  v_add_f32 v213, v213, v106
  v_add_f32 v213, v213, v107
  v_rcp_f32 v213, v213
  v_mov_b32 v214, 0
  v_mul_f32 v100, v213, v100
  v_mul_f32 v101, v213, v101
  v_mul_f32 v102, v213, v102
  v_mul_f32 v103, v213, v103
  v_mul_f32 v104, v213, v104
  v_mul_f32 v105, v213, v105
  v_mul_f32 v106, v213, v106
  v_mul_f32 v107, v213, v107
  v_mov_b32 v112, 0
  v_mov_b32 v113, 0
  v_mov_b32 v114, 0
  v_mov_b32 v115, 0
  v_mov_b32 v116, 0
  v_mov_b32 v117, 0
  v_mov_b32 v118, 0
  v_mov_b32 v119, 0
  v_mov_b32 v120, 0
  v_mov_b32 v121, 0
  v_mov_b32 v122, 0
  v_mov_b32 v123, 0
  v_mov_b32 v124, 0
  v_mov_b32 v125, 0
  v_mov_b32 v126, 0
  v_mov_b32 v127, 0
  v_mov_b32 v128, 0
  v_mov_b32 v129, 0
  v_cvt_pk_bf16_f32 v0, v100, v214
  v_cvt_pk_bf16_f32 v1, v214, v100
  s_waitcnt lgkmcnt(15)
  v_dot2c_f32_bf16 v112, v16, v0
  v_dot2c_f32_bf16 v113, v16, v1
  v_dot2c_f32_bf16 v114, v17, v0
  v_dot2c_f32_bf16 v115, v17, v1
  v_dot2c_f32_bf16 v116, v18, v0
  v_dot2c_f32_bf16 v117, v18, v1
  v_dot2c_f32_bf16 v118, v19, v0
  v_dot2c_f32_bf16 v119, v19, v1
  v_dot2c_f32_bf16 v120, v20, v0
  v_dot2c_f32_bf16 v121, v20, v1
  v_dot2c_f32_bf16 v122, v21, v0
  v_dot2c_f32_bf16 v123, v21, v1
  v_dot2c_f32_bf16 v124, v22, v0
  v_dot2c_f32_bf16 v125, v22, v1
  v_dot2c_f32_bf16 v126, v23, v0
  v_dot2c_f32_bf16 v127, v23, v1
  v_dot2c_f32_bf16 v128, v24, v0
  v_dot2c_f32_bf16 v129, v24, v1
  v_cvt_pk_bf16_f32 v2, v101, v214
  v_cvt_pk_bf16_f32 v3, v214, v101
  v_dot2c_f32_bf16 v112, v25, v2
  v_dot2c_f32_bf16 v113, v25, v3
  v_dot2c_f32_bf16 v114, v26, v2
  v_dot2c_f32_bf16 v115, v26, v3
  v_dot2c_f32_bf16 v116, v27, v2
  v_dot2c_f32_bf16 v117, v27, v3
  v_dot2c_f32_bf16 v118, v28, v2
  v_dot2c_f32_bf16 v119, v28, v3
  v_dot2c_f32_bf16 v120, v29, v2
  v_dot2c_f32_bf16 v121, v29, v3
  v_dot2c_f32_bf16 v122, v30, v2
  v_dot2c_f32_bf16 v123, v30, v3
  v_dot2c_f32_bf16 v124, v31, v2
  v_dot2c_f32_bf16 v125, v31, v3
  v_dot2c_f32_bf16 v126, v32, v2
  v_dot2c_f32_bf16 v127, v32, v3
  v_dot2c_f32_bf16 v128, v33, v2
  v_dot2c_f32_bf16 v129, v33, v3
  v_cvt_pk_bf16_f32 v0, v102, v214
  v_cvt_pk_bf16_f32 v1, v214, v102
  v_dot2c_f32_bf16 v112, v34, v0
  v_dot2c_f32_bf16 v113, v34, v1
  v_dot2c_f32_bf16 v114, v35, v0
  v_dot2c_f32_bf16 v115, v35, v1
  v_dot2c_f32_bf16 v116, v36, v0
  v_dot2c_f32_bf16 v117, v36, v1
  v_dot2c_f32_bf16 v118, v37, v0
  v_dot2c_f32_bf16 v119, v37, v1
  v_dot2c_f32_bf16 v120, v38, v0
  v_dot2c_f32_bf16 v121, v38, v1
  v_dot2c_f32_bf16 v122, v39, v0
  v_dot2c_f32_bf16 v123, v39, v1
  v_dot2c_f32_bf16 v124, v40, v0
  v_dot2c_f32_bf16 v125, v40, v1
  v_dot2c_f32_bf16 v126, v41, v0
  v_dot2c_f32_bf16 v127, v41, v1
  v_dot2c_f32_bf16 v128, v42, v0
  v_dot2c_f32_bf16 v129, v42, v1
  v_cvt_pk_bf16_f32 v2, v103, v214
  v_cvt_pk_bf16_f32 v3, v214, v103
  v_dot2c_f32_bf16 v112, v43, v2
  v_dot2c_f32_bf16 v113, v43, v3
  v_dot2c_f32_bf16 v114, v44, v2
  v_dot2c_f32_bf16 v115, v44, v3
  v_dot2c_f32_bf16 v116, v45, v2
  v_dot2c_f32_bf16 v117, v45, v3
  v_dot2c_f32_bf16 v118, v46, v2
  v_dot2c_f32_bf16 v119, v46, v3
  v_dot2c_f32_bf16 v120, v47, v2
  v_dot2c_f32_bf16 v121, v47, v3
  v_dot2c_f32_bf16 v122, v48, v2
  v_dot2c_f32_bf16 v123, v48, v3
  v_dot2c_f32_bf16 v124, v49, v2
  v_dot2c_f32_bf16 v125, v49, v3
  v_dot2c_f32_bf16 v126, v50, v2
  v_dot2c_f32_bf16 v127, v50, v3
  v_dot2c_f32_bf16 v128, v51, v2
  v_dot2c_f32_bf16 v129, v51, v3
  v_cvt_pk_bf16_f32 v0, v104, v214
  v_cvt_pk_bf16_f32 v1, v214, v104
  v_dot2c_f32_bf16 v112, v52, v0
  v_dot2c_f32_bf16 v113, v52, v1
  v_dot2c_f32_bf16 v114, v53, v0
  v_dot2c_f32_bf16 v115, v53, v1
  v_dot2c_f32_bf16 v116, v54, v0
  v_dot2c_f32_bf16 v117, v54, v1
  v_dot2c_f32_bf16 v118, v55, v0
  v_dot2c_f32_bf16 v119, v55, v1
  v_dot2c_f32_bf16 v120, v56, v0
  v_dot2c_f32_bf16 v121, v56, v1
  v_dot2c_f32_bf16 v122, v57, v0
  v_dot2c_f32_bf16 v123, v57, v1
  v_dot2c_f32_bf16 v124, v58, v0
  v_dot2c_f32_bf16 v125, v58, v1
  v_dot2c_f32_bf16 v126, v59, v0
  v_dot2c_f32_bf16 v127, v59, v1
  v_dot2c_f32_bf16 v128, v60, v0
  v_dot2c_f32_bf16 v129, v60, v1
  v_cvt_pk_bf16_f32 v2, v105, v214
  v_cvt_pk_bf16_f32 v3, v214, v105
  v_dot2c_f32_bf16 v112, v61, v2
  v_dot2c_f32_bf16 v113, v61, v3
  v_dot2c_f32_bf16 v114, v62, v2
  v_dot2c_f32_bf16 v115, v62, v3
  v_dot2c_f32_bf16 v116, v63, v2
  v_dot2c_f32_bf16 v117, v63, v3
  v_dot2c_f32_bf16 v118, v64, v2
  v_dot2c_f32_bf16 v119, v64, v3
  v_dot2c_f32_bf16 v120, v65, v2
  v_dot2c_f32_bf16 v121, v65, v3
  v_dot2c_f32_bf16 v122, v66, v2
  v_dot2c_f32_bf16 v123, v66, v3
  v_dot2c_f32_bf16 v124, v67, v2
  v_dot2c_f32_bf16 v125, v67, v3
  v_dot2c_f32_bf16 v126, v68, v2
  v_dot2c_f32_bf16 v127, v68, v3
  v_dot2c_f32_bf16 v128, v69, v2
  v_dot2c_f32_bf16 v129, v69, v3
  v_cvt_pk_bf16_f32 v0, v106, v214
  v_cvt_pk_bf16_f32 v1, v214, v106
  v_dot2c_f32_bf16 v112, v70, v0
  v_dot2c_f32_bf16 v113, v70, v1
  v_dot2c_f32_bf16 v114, v71, v0
  v_dot2c_f32_bf16 v115, v71, v1
  v_dot2c_f32_bf16 v116, v72, v0
  v_dot2c_f32_bf16 v117, v72, v1
  s_waitcnt lgkmcnt(14)
  v_dot2c_f32_bf16 v118, v73, v0
  v_dot2c_f32_bf16 v119, v73, v1
  s_waitcnt lgkmcnt(13)
  v_dot2c_f32_bf16 v120, v74, v0
  v_dot2c_f32_bf16 v121, v74, v1
  s_waitcnt lgkmcnt(12)
  v_dot2c_f32_bf16 v122, v75, v0
  v_dot2c_f32_bf16 v123, v75, v1
  s_waitcnt lgkmcnt(11)
  v_dot2c_f32_bf16 v124, v76, v0
  v_dot2c_f32_bf16 v125, v76, v1
  s_waitcnt lgkmcnt(10)
  v_dot2c_f32_bf16 v126, v77, v0
  v_dot2c_f32_bf16 v127, v77, v1
  s_waitcnt lgkmcnt(9)
  v_dot2c_f32_bf16 v128, v78, v0
  v_dot2c_f32_bf16 v129, v78, v1
  v_cvt_pk_bf16_f32 v2, v107, v214
  v_cvt_pk_bf16_f32 v3, v214, v107
  s_waitcnt lgkmcnt(8)
  v_dot2c_f32_bf16 v112, v79, v2
  v_dot2c_f32_bf16 v113, v79, v3
  s_waitcnt lgkmcnt(7)
  v_dot2c_f32_bf16 v114, v80, v2
  v_dot2c_f32_bf16 v115, v80, v3
  s_waitcnt lgkmcnt(6)
  v_dot2c_f32_bf16 v116, v81, v2
  v_dot2c_f32_bf16 v117, v81, v3
  s_waitcnt lgkmcnt(5)
  v_dot2c_f32_bf16 v118, v82, v2
  v_dot2c_f32_bf16 v119, v82, v3
  s_waitcnt lgkmcnt(4)
  v_dot2c_f32_bf16 v120, v83, v2
  v_dot2c_f32_bf16 v121, v83, v3
  s_waitcnt lgkmcnt(3)
  v_dot2c_f32_bf16 v122, v84, v2
  v_dot2c_f32_bf16 v123, v84, v3
  s_waitcnt lgkmcnt(2)
  v_dot2c_f32_bf16 v124, v85, v2
  v_dot2c_f32_bf16 v125, v85, v3
  s_waitcnt lgkmcnt(1)
  v_dot2c_f32_bf16 v126, v86, v2
  v_dot2c_f32_bf16 v127, v86, v3
  s_waitcnt lgkmcnt(0)
  v_dot2c_f32_bf16 v128, v87, v2
  v_dot2c_f32_bf16 v129, v87, v3
  v_cvt_pk_bf16_f32 v132, v112, v113
  v_cvt_pk_bf16_f32 v133, v114, v115
  v_cvt_pk_bf16_f32 v134, v116, v117
  v_cvt_pk_bf16_f32 v135, v118, v119
  v_cvt_pk_bf16_f32 v136, v120, v121
  v_cvt_pk_bf16_f32 v137, v122, v123
  v_cvt_pk_bf16_f32 v138, v124, v125
  v_cvt_pk_bf16_f32 v139, v126, v127
  v_cvt_pk_bf16_f32 v140, v128, v129
  buffer_store_dwordx4 v[132:135], v220, s[8:11], s64 offen sc1
  buffer_store_dwordx4 v[136:139], v220, s[8:11], s64 offen offset:16 sc1
  buffer_store_dword v140, v220, s[8:11], s64 offen offset:32 sc1
  s_mov_b32 s56, 36
  s_waitcnt vmcnt(0)
  s_barrier
  s_cmp_eq_u32 s52, 0
  s_cbranch_scc0 A_sig
  v_mov_b32 v211, 1
  v_mov_b32 v212, 0
  s_mov_b64 exec, 1
  buffer_atomic_add v211, v212, s[12:15], s56 offen
  s_mov_b64 exec, -1
A_sig:
  s_cmp_lt_u32 s53, 204
  s_cbranch_scc0 L_exit
  s_sub_u32 s54, s53, 96
  s_mul_i32 s55, s54, 3641
  s_lshr_b32 s55, s55, 16
  s_mul_i32 s56, s55, 18
  s_sub_u32 s70, s54, s56
  s_and_b32 s69, s55, 1
  s_lshr_b32 s68, s55, 1
  v_lshrrev_b32 v211, 2, v200
  v_mul_u32_u24 v211, 1152, v211
  v_and_b32 v212, 3, v200
  v_lshl_add_u32 v207, v212, 4, v211
  s_lshl_b32 s54, s70, 6
  s_mul_i32 s55, s52, 1179648
  s_add_u32 s62, s54, s55
  s_mul_i32 s55, s52, 184320
  s_add_u32 s63, s54, s55
  s_mul_i32 s61, s52, 40960
  v_bfe_u32 v211, v200, 2, 2
  v_lshlrev_b32 v212, 4, v212
  v_add_u32 v212, s61, v212
  v_lshl_add_u32 v212, v211, 6, v212
  v_lshrrev_b32 v213, 4, v200
  v_lshl_add_u32 v210, v213, 9, v212
  v_lshrrev_b32 v214, 5, v200
  v_lshl_add_u32 v209, v214, 10, v212
  v_and_b32 v214, 1, v213
  v_lshl_add_u32 v209, v214, 8, v209
  s_add_u32 m0, s61, 0
  s_add_u32 s54, s62, 0
  buffer_load_dwordx4 v207, s[28:31], s54 offen lds
  s_add_u32 m0, s61, 1024
  s_add_u32 s54, s62, 18432
  buffer_load_dwordx4 v207, s[28:31], s54 offen lds
  s_add_u32 m0, s61, 2048
  s_add_u32 s54, s62, 36864
  buffer_load_dwordx4 v207, s[28:31], s54 offen lds
  s_add_u32 m0, s61, 3072
  s_add_u32 s54, s62, 55296
  buffer_load_dwordx4 v207, s[28:31], s54 offen lds
  s_add_u32 m0, s61, 4096
  s_add_u32 s54, s62, 73728
  buffer_load_dwordx4 v207, s[28:31], s54 offen lds
  s_add_u32 m0, s61, 5120
  s_add_u32 s54, s62, 92160
  buffer_load_dwordx4 v207, s[28:31], s54 offen lds
  s_add_u32 m0, s61, 6144
  s_add_u32 s54, s62, 110592
  buffer_load_dwordx4 v207, s[28:31], s54 offen lds
  s_add_u32 m0, s61, 7168
  s_add_u32 s54, s62, 129024
  buffer_load_dwordx4 v207, s[28:31], s54 offen lds
  s_add_u32 m0, s61, 8192
  s_add_u32 s54, s62, 147456
  buffer_load_dwordx4 v207, s[28:31], s54 offen lds
  s_add_u32 m0, s61, 9216
  s_add_u32 s54, s62, 165888
  buffer_load_dwordx4 v207, s[28:31], s54 offen lds
  s_add_u32 m0, s61, 10240
  s_add_u32 s54, s62, 184320
  buffer_load_dwordx4 v207, s[28:31], s54 offen lds
  s_add_u32 m0, s61, 11264
  s_add_u32 s54, s62, 202752
  buffer_load_dwordx4 v207, s[28:31], s54 offen lds
  s_add_u32 m0, s61, 12288
  s_add_u32 s54, s62, 221184
  buffer_load_dwordx4 v207, s[28:31], s54 offen lds
  s_add_u32 m0, s61, 13312
  s_add_u32 s54, s62, 239616
  buffer_load_dwordx4 v207, s[28:31], s54 offen lds
  s_add_u32 m0, s61, 14336
  s_add_u32 s54, s62, 258048
  buffer_load_dwordx4 v207, s[28:31], s54 offen lds
  s_add_u32 m0, s61, 15360
  s_add_u32 s54, s62, 276480
  buffer_load_dwordx4 v207, s[28:31], s54 offen lds
  s_add_u32 m0, s61, 16384
  s_add_u32 s54, s62, 294912
  buffer_load_dwordx4 v207, s[28:31], s54 offen lds
  s_add_u32 m0, s61, 17408
  s_add_u32 s54, s62, 313344
  buffer_load_dwordx4 v207, s[28:31], s54 offen lds
  s_add_u32 m0, s61, 18432
  s_add_u32 s54, s62, 331776
  buffer_load_dwordx4 v207, s[28:31], s54 offen lds
  s_add_u32 m0, s61, 19456
  s_add_u32 s54, s62, 350208
  buffer_load_dwordx4 v207, s[28:31], s54 offen lds
  s_add_u32 m0, s61, 20480
  s_add_u32 s54, s62, 368640
  buffer_load_dwordx4 v207, s[28:31], s54 offen lds
  s_add_u32 m0, s61, 21504
  s_add_u32 s54, s62, 387072
  buffer_load_dwordx4 v207, s[28:31], s54 offen lds
  s_add_u32 m0, s61, 22528
  s_add_u32 s54, s62, 405504
  buffer_load_dwordx4 v207, s[28:31], s54 offen lds
  s_add_u32 m0, s61, 23552
  s_add_u32 s54, s62, 423936
  buffer_load_dwordx4 v207, s[28:31], s54 offen lds
  s_add_u32 m0, s61, 24576
  s_add_u32 s54, s62, 442368
  buffer_load_dwordx4 v207, s[28:31], s54 offen lds
  s_add_u32 m0, s61, 25600
  s_add_u32 s54, s62, 460800
  buffer_load_dwordx4 v207, s[28:31], s54 offen lds
  s_add_u32 m0, s61, 26624
  s_add_u32 s54, s62, 479232
  buffer_load_dwordx4 v207, s[28:31], s54 offen lds
  s_add_u32 m0, s61, 27648
  s_add_u32 s54, s62, 497664
  buffer_load_dwordx4 v207, s[28:31], s54 offen lds
  s_add_u32 m0, s61, 28672
  s_add_u32 s54, s62, 516096
  buffer_load_dwordx4 v207, s[28:31], s54 offen lds
  s_add_u32 m0, s61, 29696
  s_add_u32 s54, s62, 534528
  buffer_load_dwordx4 v207, s[28:31], s54 offen lds
  s_add_u32 m0, s61, 30720
  s_add_u32 s54, s62, 552960
  buffer_load_dwordx4 v207, s[28:31], s54 offen lds
  s_add_u32 m0, s61, 31744
  s_add_u32 s54, s62, 571392
  buffer_load_dwordx4 v207, s[28:31], s54 offen lds
  s_add_u32 m0, s61, 32768
  s_add_u32 s54, s62, 589824
  buffer_load_dwordx4 v207, s[28:31], s54 offen lds
  s_add_u32 m0, s61, 33792
  s_add_u32 s54, s62, 608256
  buffer_load_dwordx4 v207, s[28:31], s54 offen lds
  s_add_u32 m0, s61, 34816
  s_add_u32 s54, s62, 626688
  buffer_load_dwordx4 v207, s[28:31], s54 offen lds
  s_add_u32 m0, s61, 35840
  s_add_u32 s54, s62, 645120
  buffer_load_dwordx4 v207, s[28:31], s54 offen lds
  s_add_u32 m0, s61, 36864
  s_add_u32 s54, s62, 663552
  buffer_load_dwordx4 v207, s[28:31], s54 offen lds
  s_add_u32 m0, s61, 37888
  s_add_u32 s54, s62, 681984
  buffer_load_dwordx4 v207, s[28:31], s54 offen lds
  s_waitcnt vmcnt(36) lgkmcnt(0)
  s_add_u32 m0, s61, 38912
  s_add_u32 s54, s62, 700416
  buffer_load_dwordx4 v207, s[28:31], s54 offen lds
  s_add_u32 m0, s61, 39936
  s_add_u32 s54, s62, 718848
  buffer_load_dwordx4 v207, s[28:31], s54 offen lds
  ds_read_b64_tr_b16 a[0:1], v209 offset:0
  ds_read_b64_tr_b16 a[2:3], v209 offset:512
  ds_read_b64_tr_b16 a[4:5], v209 offset:8
  ds_read_b64_tr_b16 a[6:7], v209 offset:520
  s_waitcnt vmcnt(36) lgkmcnt(0)
  s_add_u32 m0, s61, 0
  s_add_u32 s54, s62, 737280
  buffer_load_dwordx4 v207, s[28:31], s54 offen lds
  s_add_u32 m0, s61, 1024
  s_add_u32 s54, s62, 755712
  buffer_load_dwordx4 v207, s[28:31], s54 offen lds
  ds_read_b64_tr_b16 a[8:9], v209 offset:2048
  ds_read_b64_tr_b16 a[10:11], v209 offset:2560
  ds_read_b64_tr_b16 a[12:13], v209 offset:2056
  ds_read_b64_tr_b16 a[14:15], v209 offset:2568
  s_waitcnt vmcnt(36) lgkmcnt(0)
  s_add_u32 m0, s61, 2048
  s_add_u32 s54, s62, 774144
  buffer_load_dwordx4 v207, s[28:31], s54 offen lds
  s_add_u32 m0, s61, 3072
  s_add_u32 s54, s62, 792576
  buffer_load_dwordx4 v207, s[28:31], s54 offen lds
  ds_read_b64_tr_b16 a[16:17], v209 offset:4096
  ds_read_b64_tr_b16 a[18:19], v209 offset:4608
  ds_read_b64_tr_b16 a[20:21], v209 offset:4104
  ds_read_b64_tr_b16 a[22:23], v209 offset:4616
  s_waitcnt vmcnt(36) lgkmcnt(0)
  s_add_u32 m0, s61, 4096
  s_add_u32 s54, s62, 811008
  buffer_load_dwordx4 v207, s[28:31], s54 offen lds
  s_add_u32 m0, s61, 5120
  s_add_u32 s54, s62, 829440
  buffer_load_dwordx4 v207, s[28:31], s54 offen lds
  ds_read_b64_tr_b16 a[24:25], v209 offset:6144
  ds_read_b64_tr_b16 a[26:27], v209 offset:6656
  ds_read_b64_tr_b16 a[28:29], v209 offset:6152
  ds_read_b64_tr_b16 a[30:31], v209 offset:6664
  s_waitcnt vmcnt(36) lgkmcnt(0)
  s_add_u32 m0, s61, 6144
  s_add_u32 s54, s62, 847872
  buffer_load_dwordx4 v207, s[28:31], s54 offen lds
  s_add_u32 m0, s61, 7168
  s_add_u32 s54, s62, 866304
  buffer_load_dwordx4 v207, s[28:31], s54 offen lds
  ds_read_b64_tr_b16 a[32:33], v209 offset:8192
  ds_read_b64_tr_b16 a[34:35], v209 offset:8704
  ds_read_b64_tr_b16 a[36:37], v209 offset:8200
  ds_read_b64_tr_b16 a[38:39], v209 offset:8712
  s_waitcnt vmcnt(36) lgkmcnt(0)
  s_add_u32 m0, s61, 8192
  s_add_u32 s54, s62, 884736
  buffer_load_dwordx4 v207, s[28:31], s54 offen lds
  s_add_u32 m0, s61, 9216
  s_add_u32 s54, s62, 903168
  buffer_load_dwordx4 v207, s[28:31], s54 offen lds
  ds_read_b64_tr_b16 a[40:41], v209 offset:10240
  ds_read_b64_tr_b16 a[42:43], v209 offset:10752
  ds_read_b64_tr_b16 a[44:45], v209 offset:10248
  ds_read_b64_tr_b16 a[46:47], v209 offset:10760
  s_waitcnt vmcnt(36) lgkmcnt(0)
  s_add_u32 m0, s61, 10240
  s_add_u32 s54, s62, 921600
  buffer_load_dwordx4 v207, s[28:31], s54 offen lds
  s_add_u32 m0, s61, 11264
  s_add_u32 s54, s62, 940032
  buffer_load_dwordx4 v207, s[28:31], s54 offen lds
  ds_read_b64_tr_b16 a[48:49], v209 offset:12288
  ds_read_b64_tr_b16 a[50:51], v209 offset:12800
  ds_read_b64_tr_b16 a[52:53], v209 offset:12296
  ds_read_b64_tr_b16 a[54:55], v209 offset:12808
  s_waitcnt vmcnt(36) lgkmcnt(0)
  s_add_u32 m0, s61, 12288
  s_add_u32 s54, s62, 958464
  buffer_load_dwordx4 v207, s[28:31], s54 offen lds
  s_add_u32 m0, s61, 13312
  s_add_u32 s54, s62, 976896
  buffer_load_dwordx4 v207, s[28:31], s54 offen lds
  ds_read_b64_tr_b16 a[56:57], v209 offset:14336
  ds_read_b64_tr_b16 a[58:59], v209 offset:14848
  ds_read_b64_tr_b16 a[60:61], v209 offset:14344
  ds_read_b64_tr_b16 a[62:63], v209 offset:14856
  s_waitcnt vmcnt(36) lgkmcnt(0)
  s_add_u32 m0, s61, 14336
  s_add_u32 s54, s62, 995328
  buffer_load_dwordx4 v207, s[28:31], s54 offen lds
  s_add_u32 m0, s61, 15360
  s_add_u32 s54, s62, 1013760
  buffer_load_dwordx4 v207, s[28:31], s54 offen lds
  ds_read_b64_tr_b16 a[64:65], v209 offset:16384
  ds_read_b64_tr_b16 a[66:67], v209 offset:16896
  ds_read_b64_tr_b16 a[68:69], v209 offset:16392
  ds_read_b64_tr_b16 a[70:71], v209 offset:16904
  s_waitcnt vmcnt(36) lgkmcnt(0)
  s_add_u32 m0, s61, 16384
  s_add_u32 s54, s62, 1032192
  buffer_load_dwordx4 v207, s[28:31], s54 offen lds
  s_add_u32 m0, s61, 17408
  s_add_u32 s54, s62, 1050624
  buffer_load_dwordx4 v207, s[28:31], s54 offen lds
  ds_read_b64_tr_b16 a[72:73], v209 offset:18432
  ds_read_b64_tr_b16 a[74:75], v209 offset:18944
  ds_read_b64_tr_b16 a[76:77], v209 offset:18440
  ds_read_b64_tr_b16 a[78:79], v209 offset:18952
  s_waitcnt vmcnt(36) lgkmcnt(0)
  s_add_u32 m0, s61, 18432
  s_add_u32 s54, s62, 1069056
  buffer_load_dwordx4 v207, s[28:31], s54 offen lds
  s_add_u32 m0, s61, 19456
  s_add_u32 s54, s62, 1087488
  buffer_load_dwordx4 v207, s[28:31], s54 offen lds
  ds_read_b64_tr_b16 a[80:81], v209 offset:20480
  ds_read_b64_tr_b16 a[82:83], v209 offset:20992
  ds_read_b64_tr_b16 a[84:85], v209 offset:20488
  ds_read_b64_tr_b16 a[86:87], v209 offset:21000
  s_waitcnt vmcnt(36) lgkmcnt(0)
  s_add_u32 m0, s61, 20480
  s_add_u32 s54, s62, 1105920
  buffer_load_dwordx4 v207, s[28:31], s54 offen lds
  s_add_u32 m0, s61, 21504
  s_add_u32 s54, s62, 1124352
  buffer_load_dwordx4 v207, s[28:31], s54 offen lds
  ds_read_b64_tr_b16 a[88:89], v209 offset:22528
  ds_read_b64_tr_b16 a[90:91], v209 offset:23040
  ds_read_b64_tr_b16 a[92:93], v209 offset:22536
  ds_read_b64_tr_b16 a[94:95], v209 offset:23048
  s_waitcnt vmcnt(36) lgkmcnt(0)
  s_add_u32 m0, s61, 22528
  s_add_u32 s54, s62, 1142784
  buffer_load_dwordx4 v207, s[28:31], s54 offen lds
  s_add_u32 m0, s61, 23552
  s_add_u32 s54, s62, 1161216
  buffer_load_dwordx4 v207, s[28:31], s54 offen lds
  ds_read_b64_tr_b16 a[96:97], v209 offset:24576
  ds_read_b64_tr_b16 a[98:99], v209 offset:25088
  ds_read_b64_tr_b16 a[100:101], v209 offset:24584
  ds_read_b64_tr_b16 a[102:103], v209 offset:25096
  s_waitcnt vmcnt(36) lgkmcnt(0)
  s_add_u32 m0, s61, 24576
  s_add_u32 s54, s63, 0
  buffer_load_dwordx4 v207, s[40:43], s54 offen lds
  s_add_u32 m0, s61, 25600
  s_add_u32 s54, s63, 18432
  buffer_load_dwordx4 v207, s[40:43], s54 offen lds
  ds_read_b64_tr_b16 a[104:105], v209 offset:26624
  ds_read_b64_tr_b16 a[106:107], v209 offset:27136
  ds_read_b64_tr_b16 a[108:109], v209 offset:26632
  ds_read_b64_tr_b16 a[110:111], v209 offset:27144
  s_waitcnt vmcnt(36) lgkmcnt(0)
  s_add_u32 m0, s61, 26624
  s_add_u32 s54, s63, 36864
  buffer_load_dwordx4 v207, s[40:43], s54 offen lds
  s_add_u32 m0, s61, 27648
  s_add_u32 s54, s63, 55296
  buffer_load_dwordx4 v207, s[40:43], s54 offen lds
  ds_read_b64_tr_b16 a[112:113], v209 offset:28672
  ds_read_b64_tr_b16 a[114:115], v209 offset:29184
  ds_read_b64_tr_b16 a[116:117], v209 offset:28680
  ds_read_b64_tr_b16 a[118:119], v209 offset:29192
  s_waitcnt vmcnt(36) lgkmcnt(0)
  s_add_u32 m0, s61, 28672
  s_add_u32 s54, s63, 73728
  buffer_load_dwordx4 v207, s[40:43], s54 offen lds
  s_add_u32 m0, s61, 29696
  s_add_u32 s54, s63, 92160
  buffer_load_dwordx4 v207, s[40:43], s54 offen lds
  ds_read_b64_tr_b16 a[120:121], v209 offset:30720
  ds_read_b64_tr_b16 a[122:123], v209 offset:31232
  ds_read_b64_tr_b16 a[124:125], v209 offset:30728
  ds_read_b64_tr_b16 a[126:127], v209 offset:31240
  s_waitcnt vmcnt(36) lgkmcnt(0)
  s_add_u32 m0, s61, 30720
  s_add_u32 s54, s63, 110592
  buffer_load_dwordx4 v207, s[40:43], s54 offen lds
  s_add_u32 m0, s61, 31744
  s_add_u32 s54, s63, 129024
  buffer_load_dwordx4 v207, s[40:43], s54 offen lds
  ds_read_b64_tr_b16 a[128:129], v209 offset:32768
  ds_read_b64_tr_b16 a[130:131], v209 offset:33280
  ds_read_b64_tr_b16 a[132:133], v209 offset:32776
  ds_read_b64_tr_b16 a[134:135], v209 offset:33288
  s_waitcnt vmcnt(36) lgkmcnt(0)
  s_add_u32 m0, s61, 32768
  s_add_u32 s54, s63, 147456
  buffer_load_dwordx4 v207, s[40:43], s54 offen lds
  s_add_u32 m0, s61, 33792
  s_add_u32 s54, s63, 165888
  buffer_load_dwordx4 v207, s[40:43], s54 offen lds
  ds_read_b64_tr_b16 a[136:137], v209 offset:34816
  ds_read_b64_tr_b16 a[138:139], v209 offset:35328
  ds_read_b64_tr_b16 a[140:141], v209 offset:34824
  ds_read_b64_tr_b16 a[142:143], v209 offset:35336
  s_waitcnt vmcnt(36) lgkmcnt(0)
  ds_read_b64_tr_b16 a[144:145], v209 offset:36864
  ds_read_b64_tr_b16 a[146:147], v209 offset:37376
  ds_read_b64_tr_b16 a[148:149], v209 offset:36872
  ds_read_b64_tr_b16 a[150:151], v209 offset:37384
  s_waitcnt vmcnt(34) lgkmcnt(0)
  ds_read_b64_tr_b16 a[152:153], v209 offset:38912
  ds_read_b64_tr_b16 a[154:155], v209 offset:39424
  ds_read_b64_tr_b16 a[156:157], v209 offset:38920
  ds_read_b64_tr_b16 a[158:159], v209 offset:39432
  s_waitcnt vmcnt(32) lgkmcnt(0)
  ds_read_b64_tr_b16 a[160:161], v209 offset:0
  ds_read_b64_tr_b16 a[162:163], v209 offset:512
  ds_read_b64_tr_b16 a[164:165], v209 offset:8
  ds_read_b64_tr_b16 a[166:167], v209 offset:520
  s_waitcnt vmcnt(30) lgkmcnt(0)
  ds_read_b64_tr_b16 a[168:169], v209 offset:2048
  ds_read_b64_tr_b16 a[170:171], v209 offset:2560
  ds_read_b64_tr_b16 a[172:173], v209 offset:2056
  ds_read_b64_tr_b16 a[174:175], v209 offset:2568
  s_waitcnt vmcnt(28) lgkmcnt(0)
  ds_read_b64_tr_b16 a[176:177], v209 offset:4096
  ds_read_b64_tr_b16 a[178:179], v209 offset:4608
  ds_read_b64_tr_b16 a[180:181], v209 offset:4104
  ds_read_b64_tr_b16 a[182:183], v209 offset:4616
  s_waitcnt vmcnt(26) lgkmcnt(0)
  ds_read_b64_tr_b16 a[184:185], v209 offset:6144
  ds_read_b64_tr_b16 a[186:187], v209 offset:6656
  ds_read_b64_tr_b16 a[188:189], v209 offset:6152
  ds_read_b64_tr_b16 a[190:191], v209 offset:6664
  s_waitcnt vmcnt(24) lgkmcnt(0)
  ds_read_b64_tr_b16 a[192:193], v209 offset:8192
  ds_read_b64_tr_b16 a[194:195], v209 offset:8704
  ds_read_b64_tr_b16 a[196:197], v209 offset:8200
  ds_read_b64_tr_b16 a[198:199], v209 offset:8712
  s_waitcnt vmcnt(22) lgkmcnt(0)
  ds_read_b64_tr_b16 a[200:201], v209 offset:10240
  ds_read_b64_tr_b16 a[202:203], v209 offset:10752
  ds_read_b64_tr_b16 a[204:205], v209 offset:10248
  ds_read_b64_tr_b16 a[206:207], v209 offset:10760
  s_waitcnt vmcnt(20) lgkmcnt(0)
  ds_read_b64_tr_b16 a[208:209], v209 offset:12288
  ds_read_b64_tr_b16 a[210:211], v209 offset:12800
  ds_read_b64_tr_b16 a[212:213], v209 offset:12296
  ds_read_b64_tr_b16 a[214:215], v209 offset:12808
  s_waitcnt vmcnt(18) lgkmcnt(0)
  ds_read_b64_tr_b16 a[216:217], v209 offset:14336
  ds_read_b64_tr_b16 a[218:219], v209 offset:14848
  ds_read_b64_tr_b16 a[220:221], v209 offset:14344
  ds_read_b64_tr_b16 a[222:223], v209 offset:14856
  s_waitcnt vmcnt(16) lgkmcnt(0)
  ds_read_b64_tr_b16 a[224:225], v209 offset:16384
  ds_read_b64_tr_b16 a[226:227], v209 offset:16896
  ds_read_b64_tr_b16 a[228:229], v209 offset:16392
  ds_read_b64_tr_b16 a[230:231], v209 offset:16904
  s_waitcnt vmcnt(14) lgkmcnt(0)
  ds_read_b64_tr_b16 a[232:233], v209 offset:18432
  ds_read_b64_tr_b16 a[234:235], v209 offset:18944
  ds_read_b64_tr_b16 a[236:237], v209 offset:18440
  ds_read_b64_tr_b16 a[238:239], v209 offset:18952
  s_waitcnt vmcnt(12) lgkmcnt(0)
  ds_read_b64_tr_b16 a[240:241], v209 offset:20480
  ds_read_b64_tr_b16 a[242:243], v209 offset:20992
  ds_read_b64_tr_b16 a[244:245], v209 offset:20488
  ds_read_b64_tr_b16 a[246:247], v209 offset:21000
  s_waitcnt vmcnt(10) lgkmcnt(0)
  ds_read_b64_tr_b16 a[248:249], v209 offset:22528
  ds_read_b64_tr_b16 a[250:251], v209 offset:23040
  ds_read_b64_tr_b16 a[252:253], v209 offset:22536
  ds_read_b64_tr_b16 a[254:255], v209 offset:23048
  s_waitcnt vmcnt(8) lgkmcnt(0)
  ds_read_b64_tr_b16 v[216:217], v210 offset:24576
  ds_read_b64_tr_b16 v[218:219], v210 offset:24832
  ds_read_b64_tr_b16 v[220:221], v210 offset:24584
  ds_read_b64_tr_b16 v[222:223], v210 offset:24840
  s_waitcnt vmcnt(6) lgkmcnt(0)
  ds_read_b64_tr_b16 v[224:225], v210 offset:26624
  ds_read_b64_tr_b16 v[226:227], v210 offset:26880
  ds_read_b64_tr_b16 v[228:229], v210 offset:26632
  ds_read_b64_tr_b16 v[230:231], v210 offset:26888
  s_waitcnt vmcnt(4) lgkmcnt(0)
  ds_read_b64_tr_b16 v[232:233], v210 offset:28672
  ds_read_b64_tr_b16 v[234:235], v210 offset:28928
  ds_read_b64_tr_b16 v[236:237], v210 offset:28680
  ds_read_b64_tr_b16 v[238:239], v210 offset:28936
  s_waitcnt vmcnt(2) lgkmcnt(0)
  ds_read_b64_tr_b16 v[240:241], v210 offset:30720
  ds_read_b64_tr_b16 v[242:243], v210 offset:30976
  ds_read_b64_tr_b16 v[244:245], v210 offset:30728
  ds_read_b64_tr_b16 v[246:247], v210 offset:30984
  s_waitcnt vmcnt(0) lgkmcnt(0)
  ds_read_b64_tr_b16 v[248:249], v210 offset:32768
  ds_read_b64_tr_b16 v[250:251], v210 offset:33024
  ds_read_b64_tr_b16 v[252:253], v210 offset:32776
  ds_read_b64_tr_b16 v[254:255], v210 offset:33032
  v_and_b32 v211, 15, v200
  s_lshl_b32 s54, s69, 4
  v_add_u32 v211, s54, v211
  v_lshl_add_u32 v212, v214, 5, v211
  v_lshlrev_b32 v164, 4, v212
  v_lshrrev_b32 v212, 5, v200
  v_lshl_add_u32 v164, v212, 10, v164
  v_mul_u32_u24 v167, 1152, v211
  v_lshl_add_u32 v167, v213, 4, v167
  v_lshlrev_b32 v166, 2, v211
  v_lshlrev_b32 v208, 2, v200
  s_lshl_b32 s54, s52, 11
  v_add_u32 v168, s54, v201
  s_mov_b32 s59, s68
  s_lshl_b32 s66, s68, 7
  s_add_u32 s66, s66, 356352
  s_mov_b32 s56, 128
  s_mov_b32 s57, 36
  s_waitcnt lgkmcnt(0)
  s_cmp_eq_u32 s52, 0
  s_cbranch_scc0 O_p1_d
  s_mov_b32 exec_hi, 0
  s_mov_b32 exec_lo, -1
O_p1:
  buffer_load_dword v211, v208, s[12:15], s56 offen sc1
  s_add_u32 s65, s65, 1
  s_waitcnt vmcnt(0)
  v_cmp_gt_u32 vcc, 0x700, v211
  s_cbranch_vccz O_p1_x
  s_sleep 16
  s_cmp_lt_u32 s65, 131072
  s_cbranch_scc1 O_p1
O_p1_x:
  s_mov_b64 exec, -1
O_p1_d:
  s_barrier
  s_cmp_eq_u32 s52, 0
  s_cbranch_scc0 O_a_d
  s_mov_b32 exec_hi, 0
  s_mov_b32 exec_lo, 1
O_a:
  buffer_load_dword v211, v208, s[12:15], s57 offen sc1
  s_add_u32 s65, s65, 1
  s_waitcnt vmcnt(0)
  v_cmp_gt_u32 vcc, 0x80, v211
  s_cbranch_vccz O_a_x
  s_sleep 16
  s_cmp_lt_u32 s65, 131072
  s_cbranch_scc1 O_a
O_a_x:
  s_mov_b64 exec, -1
O_a_d:
  s_barrier
O_loop:
  s_mul_i32 s64, s59, 36864
  s_mul_i32 s54, s52, 320
  s_add_u32 s55, s64, s54
  s_add_u32 s55, s55, 62914560
  s_cmp_eq_u32 s52, 3
  s_cselect_b32 s56, 268435456, s55
  buffer_load_dwordx4 v[128:131], v167, s[8:11], s55 offen offset:0 sc1
  buffer_load_dwordx4 v[132:135], v167, s[8:11], s55 offen offset:64 sc1
  buffer_load_dwordx4 v[136:139], v167, s[8:11], s55 offen offset:128 sc1
  buffer_load_dwordx4 v[140:143], v167, s[8:11], s56 offen offset:192 sc1
  buffer_load_dwordx4 v[144:147], v167, s[8:11], s56 offen offset:256 sc1
  s_lshl_b32 s55, s59, 7
  s_add_u32 s55, s55, 66060288
  buffer_load_dword v165, v166, s[8:11], s55 offen sc1
  s_waitcnt vmcnt(5)
  v_mfma_f32_16x16x32_bf16 v[156:159], v[216:219], v[128:131], 0
  v_mfma_f32_16x16x32_bf16 v[160:163], v[220:223], v[128:131], 0
  s_waitcnt vmcnt(4)
  v_mfma_f32_16x16x32_bf16 v[156:159], v[224:227], v[132:135], v[156:159]
  v_mfma_f32_16x16x32_bf16 v[160:163], v[228:231], v[132:135], v[160:163]
  s_waitcnt vmcnt(3)
  v_mfma_f32_16x16x32_bf16 v[156:159], v[232:235], v[136:139], v[156:159]
  v_mfma_f32_16x16x32_bf16 v[160:163], v[236:239], v[136:139], v[160:163]
  s_waitcnt vmcnt(2)
  v_mfma_f32_16x16x32_bf16 v[156:159], v[240:243], v[140:143], v[156:159]
  v_mfma_f32_16x16x32_bf16 v[160:163], v[244:247], v[140:143], v[160:163]
  s_waitcnt vmcnt(1)
  v_mfma_f32_16x16x32_bf16 v[156:159], v[248:251], v[144:147], v[156:159]
  v_mfma_f32_16x16x32_bf16 v[160:163], v[252:255], v[144:147], v[160:163]
  s_waitcnt vmcnt(0)
  s_nop 2
  v_mul_f32 v156, v165, v156
  v_mul_f32 v157, v165, v157
  v_mul_f32 v158, v165, v158
  v_mul_f32 v159, v165, v159
  v_mul_f32 v160, v165, v160
  v_mul_f32 v161, v165, v161
  v_mul_f32 v162, v165, v162
  v_mul_f32 v163, v165, v163
  v_sub_f32 v165, 1.0, v165
  v_cvt_pk_bf16_f32 v165, v165, v165
  v_lshlrev_b32 v165, 16, v165
  s_add_u32 s71, s59, 3
  s_lshl_b32 s55, s59, 18
  s_lshl_b32 s54, s52, 16
  s_add_u32 s55, s55, s54
  s_add_u32 s62, s55, 46137344
  s_cmp_eq_u32 s52, 0
  s_cbranch_scc0 O_b_d
  s_mov_b32 exec_hi, 0
  s_mov_b32 exec_lo, -1
O_b:
  buffer_load_dword v211, v208, s[8:11], s66 offen sc1
  s_add_u32 s65, s65, 1
  s_waitcnt vmcnt(0)
  v_cmp_gt_u32 vcc, s71, v211
  s_cbranch_vccz O_b_x
  s_sleep 1
  s_cmp_lt_u32 s65, 131072
  s_cbranch_scc1 O_b
O_b_x:
  s_mov_b64 exec, -1
O_b_d:
  s_barrier
  buffer_load_dwordx4 v[0:3], v164, s[8:11], s62 offen offset:0 sc1
  buffer_load_dwordx4 v[4:7], v164, s[8:11], s62 offen offset:2048 sc1
  s_add_u32 s62, s62, 4096
  buffer_load_dwordx4 v[8:11], v164, s[8:11], s62 offen offset:0 sc1
  buffer_load_dwordx4 v[12:15], v164, s[8:11], s62 offen offset:2048 sc1
  s_add_u32 s62, s62, 4096
  buffer_load_dwordx4 v[16:19], v164, s[8:11], s62 offen offset:0 sc1
  buffer_load_dwordx4 v[20:23], v164, s[8:11], s62 offen offset:2048 sc1
  s_add_u32 s62, s62, 4096
  buffer_load_dwordx4 v[24:27], v164, s[8:11], s62 offen offset:0 sc1
  buffer_load_dwordx4 v[28:31], v164, s[8:11], s62 offen offset:2048 sc1
  s_add_u32 s62, s62, 4096
  buffer_load_dwordx4 v[32:35], v164, s[8:11], s62 offen offset:0 sc1
  buffer_load_dwordx4 v[36:39], v164, s[8:11], s62 offen offset:2048 sc1
  s_add_u32 s62, s62, 4096
  buffer_load_dwordx4 v[40:43], v164, s[8:11], s62 offen offset:0 sc1
  buffer_load_dwordx4 v[44:47], v164, s[8:11], s62 offen offset:2048 sc1
  s_add_u32 s62, s62, 4096
  buffer_load_dwordx4 v[48:51], v164, s[8:11], s62 offen offset:0 sc1
  buffer_load_dwordx4 v[52:55], v164, s[8:11], s62 offen offset:2048 sc1
  s_add_u32 s62, s62, 4096
  buffer_load_dwordx4 v[56:59], v164, s[8:11], s62 offen offset:0 sc1
  buffer_load_dwordx4 v[60:63], v164, s[8:11], s62 offen offset:2048 sc1
  s_add_u32 s62, s62, 4096
  buffer_load_dwordx4 v[64:67], v164, s[8:11], s62 offen offset:0 sc1
  buffer_load_dwordx4 v[68:71], v164, s[8:11], s62 offen offset:2048 sc1
  s_add_u32 s62, s62, 4096
  buffer_load_dwordx4 v[72:75], v164, s[8:11], s62 offen offset:0 sc1
  buffer_load_dwordx4 v[76:79], v164, s[8:11], s62 offen offset:2048 sc1
  s_add_u32 s62, s62, 4096
  buffer_load_dwordx4 v[80:83], v164, s[8:11], s62 offen offset:0 sc1
  buffer_load_dwordx4 v[84:87], v164, s[8:11], s62 offen offset:2048 sc1
  s_add_u32 s62, s62, 4096
  buffer_load_dwordx4 v[88:91], v164, s[8:11], s62 offen offset:0 sc1
  buffer_load_dwordx4 v[92:95], v164, s[8:11], s62 offen offset:2048 sc1
  s_add_u32 s62, s62, 4096
  buffer_load_dwordx4 v[96:99], v164, s[8:11], s62 offen offset:0 sc1
  buffer_load_dwordx4 v[100:103], v164, s[8:11], s62 offen offset:2048 sc1
  s_add_u32 s62, s62, 4096
  buffer_load_dwordx4 v[104:107], v164, s[8:11], s62 offen offset:0 sc1
  buffer_load_dwordx4 v[108:111], v164, s[8:11], s62 offen offset:2048 sc1
  s_add_u32 s62, s62, 4096
  buffer_load_dwordx4 v[112:115], v164, s[8:11], s62 offen offset:0 sc1
  buffer_load_dwordx4 v[116:119], v164, s[8:11], s62 offen offset:2048 sc1
  s_add_u32 s62, s62, 4096
  buffer_load_dwordx4 v[120:123], v164, s[8:11], s62 offen offset:0 sc1
  buffer_load_dwordx4 v[124:127], v164, s[8:11], s62 offen offset:2048 sc1
  s_add_u32 s62, s62, 4096
  s_waitcnt vmcnt(31)
  v_mfma_f32_16x16x32_bf16 v[148:151], a[0:3], v[0:3], 0
  v_mfma_f32_16x16x32_bf16 v[152:155], a[4:7], v[0:3], 0
  s_waitcnt vmcnt(30)
  v_mfma_f32_16x16x32_bf16 v[148:151], a[8:11], v[4:7], v[148:151]
  v_mfma_f32_16x16x32_bf16 v[152:155], a[12:15], v[4:7], v[152:155]
  s_waitcnt vmcnt(29)
  v_mfma_f32_16x16x32_bf16 v[148:151], a[16:19], v[8:11], v[148:151]
  v_mfma_f32_16x16x32_bf16 v[152:155], a[20:23], v[8:11], v[152:155]
  s_waitcnt vmcnt(28)
  v_mfma_f32_16x16x32_bf16 v[148:151], a[24:27], v[12:15], v[148:151]
  v_mfma_f32_16x16x32_bf16 v[152:155], a[28:31], v[12:15], v[152:155]
  s_waitcnt vmcnt(27)
  v_mfma_f32_16x16x32_bf16 v[148:151], a[32:35], v[16:19], v[148:151]
  v_mfma_f32_16x16x32_bf16 v[152:155], a[36:39], v[16:19], v[152:155]
  s_waitcnt vmcnt(26)
  v_mfma_f32_16x16x32_bf16 v[148:151], a[40:43], v[20:23], v[148:151]
  v_mfma_f32_16x16x32_bf16 v[152:155], a[44:47], v[20:23], v[152:155]
  s_waitcnt vmcnt(25)
  v_mfma_f32_16x16x32_bf16 v[148:151], a[48:51], v[24:27], v[148:151]
  v_mfma_f32_16x16x32_bf16 v[152:155], a[52:55], v[24:27], v[152:155]
  s_waitcnt vmcnt(24)
  v_mfma_f32_16x16x32_bf16 v[148:151], a[56:59], v[28:31], v[148:151]
  v_mfma_f32_16x16x32_bf16 v[152:155], a[60:63], v[28:31], v[152:155]
  s_waitcnt vmcnt(23)
  v_mfma_f32_16x16x32_bf16 v[148:151], a[64:67], v[32:35], v[148:151]
  v_mfma_f32_16x16x32_bf16 v[152:155], a[68:71], v[32:35], v[152:155]
  s_waitcnt vmcnt(22)
  v_mfma_f32_16x16x32_bf16 v[148:151], a[72:75], v[36:39], v[148:151]
  v_mfma_f32_16x16x32_bf16 v[152:155], a[76:79], v[36:39], v[152:155]
  s_waitcnt vmcnt(21)
  v_mfma_f32_16x16x32_bf16 v[148:151], a[80:83], v[40:43], v[148:151]
  v_mfma_f32_16x16x32_bf16 v[152:155], a[84:87], v[40:43], v[152:155]
  s_waitcnt vmcnt(20)
  v_mfma_f32_16x16x32_bf16 v[148:151], a[88:91], v[44:47], v[148:151]
  v_mfma_f32_16x16x32_bf16 v[152:155], a[92:95], v[44:47], v[152:155]
  s_waitcnt vmcnt(19)
  v_mfma_f32_16x16x32_bf16 v[148:151], a[96:99], v[48:51], v[148:151]
  v_mfma_f32_16x16x32_bf16 v[152:155], a[100:103], v[48:51], v[152:155]
  s_waitcnt vmcnt(18)
  v_mfma_f32_16x16x32_bf16 v[148:151], a[104:107], v[52:55], v[148:151]
  v_mfma_f32_16x16x32_bf16 v[152:155], a[108:111], v[52:55], v[152:155]
  s_waitcnt vmcnt(17)
  v_mfma_f32_16x16x32_bf16 v[148:151], a[112:115], v[56:59], v[148:151]
  v_mfma_f32_16x16x32_bf16 v[152:155], a[116:119], v[56:59], v[152:155]
  s_waitcnt vmcnt(16)
  v_mfma_f32_16x16x32_bf16 v[148:151], a[120:123], v[60:63], v[148:151]
  v_mfma_f32_16x16x32_bf16 v[152:155], a[124:127], v[60:63], v[152:155]
  s_waitcnt vmcnt(15)
  v_mfma_f32_16x16x32_bf16 v[148:151], a[128:131], v[64:67], v[148:151]
  v_mfma_f32_16x16x32_bf16 v[152:155], a[132:135], v[64:67], v[152:155]
  s_waitcnt vmcnt(14)
  v_mfma_f32_16x16x32_bf16 v[148:151], a[136:139], v[68:71], v[148:151]
  v_mfma_f32_16x16x32_bf16 v[152:155], a[140:143], v[68:71], v[152:155]
  s_waitcnt vmcnt(13)
  v_mfma_f32_16x16x32_bf16 v[148:151], a[144:147], v[72:75], v[148:151]
  v_mfma_f32_16x16x32_bf16 v[152:155], a[148:151], v[72:75], v[152:155]
  s_waitcnt vmcnt(12)
  v_mfma_f32_16x16x32_bf16 v[148:151], a[152:155], v[76:79], v[148:151]
  v_mfma_f32_16x16x32_bf16 v[152:155], a[156:159], v[76:79], v[152:155]
  s_waitcnt vmcnt(11)
  v_mfma_f32_16x16x32_bf16 v[148:151], a[160:163], v[80:83], v[148:151]
  v_mfma_f32_16x16x32_bf16 v[152:155], a[164:167], v[80:83], v[152:155]
  s_waitcnt vmcnt(10)
  v_mfma_f32_16x16x32_bf16 v[148:151], a[168:171], v[84:87], v[148:151]
  v_mfma_f32_16x16x32_bf16 v[152:155], a[172:175], v[84:87], v[152:155]
  s_waitcnt vmcnt(9)
  v_mfma_f32_16x16x32_bf16 v[148:151], a[176:179], v[88:91], v[148:151]
  v_mfma_f32_16x16x32_bf16 v[152:155], a[180:183], v[88:91], v[152:155]
  s_waitcnt vmcnt(8)
  v_mfma_f32_16x16x32_bf16 v[148:151], a[184:187], v[92:95], v[148:151]
  v_mfma_f32_16x16x32_bf16 v[152:155], a[188:191], v[92:95], v[152:155]
  s_waitcnt vmcnt(7)
  v_mfma_f32_16x16x32_bf16 v[148:151], a[192:195], v[96:99], v[148:151]
  v_mfma_f32_16x16x32_bf16 v[152:155], a[196:199], v[96:99], v[152:155]
  s_waitcnt vmcnt(6)
  v_mfma_f32_16x16x32_bf16 v[148:151], a[200:203], v[100:103], v[148:151]
  v_mfma_f32_16x16x32_bf16 v[152:155], a[204:207], v[100:103], v[152:155]
  s_waitcnt vmcnt(5)
  v_mfma_f32_16x16x32_bf16 v[148:151], a[208:211], v[104:107], v[148:151]
  v_mfma_f32_16x16x32_bf16 v[152:155], a[212:215], v[104:107], v[152:155]
  s_waitcnt vmcnt(4)
  v_mfma_f32_16x16x32_bf16 v[148:151], a[216:219], v[108:111], v[148:151]
  v_mfma_f32_16x16x32_bf16 v[152:155], a[220:223], v[108:111], v[152:155]
  s_waitcnt vmcnt(3)
  v_mfma_f32_16x16x32_bf16 v[148:151], a[224:227], v[112:115], v[148:151]
  v_mfma_f32_16x16x32_bf16 v[152:155], a[228:231], v[112:115], v[152:155]
  s_waitcnt vmcnt(2)
  v_mfma_f32_16x16x32_bf16 v[148:151], a[232:235], v[116:119], v[148:151]
  v_mfma_f32_16x16x32_bf16 v[152:155], a[236:239], v[116:119], v[152:155]
  s_waitcnt vmcnt(1)
  v_mfma_f32_16x16x32_bf16 v[148:151], a[240:243], v[120:123], v[148:151]
  v_mfma_f32_16x16x32_bf16 v[152:155], a[244:247], v[120:123], v[152:155]
  s_waitcnt vmcnt(0)
  v_mfma_f32_16x16x32_bf16 v[148:151], a[248:251], v[124:127], v[148:151]
  v_mfma_f32_16x16x32_bf16 v[152:155], a[252:255], v[124:127], v[152:155]
  s_nop 3
  v_fmac_f32 v156, v165, v148
  v_fmac_f32 v157, v165, v149
  v_fmac_f32 v158, v165, v150
  v_fmac_f32 v159, v165, v151
  v_fmac_f32 v160, v165, v152
  v_fmac_f32 v161, v165, v153
  v_fmac_f32 v162, v165, v154
  v_fmac_f32 v163, v165, v155
  ds_write_b128 v168, v[156:159]
  ds_write_b128 v168, v[160:163] offset:1024
  s_lshl_b32 s54, s70, 6
  s_add_u32 s64, s64, s54
  s_mov_b32 s59, s71
  s_waitcnt lgkmcnt(0)
  s_barrier
  s_cmp_eq_u32 s52, 0
  s_cbranch_scc0 O_next
  ds_read_b128 v[0:3], v201 offset:2048
  ds_read_b128 v[4:7], v201 offset:3072
  ds_read_b128 v[8:11], v201 offset:4096
  ds_read_b128 v[12:15], v201 offset:5120
  ds_read_b128 v[16:19], v201 offset:6144
  ds_read_b128 v[20:23], v201 offset:7168
  s_waitcnt lgkmcnt(5)
  v_add_f32 v156, v156, v0
  v_add_f32 v157, v157, v1
  v_add_f32 v158, v158, v2
  v_add_f32 v159, v159, v3
  s_waitcnt lgkmcnt(4)
  v_add_f32 v160, v160, v4
  v_add_f32 v161, v161, v5
  v_add_f32 v162, v162, v6
  v_add_f32 v163, v163, v7
  s_waitcnt lgkmcnt(3)
  v_add_f32 v156, v156, v8
  v_add_f32 v157, v157, v9
  v_add_f32 v158, v158, v10
  v_add_f32 v159, v159, v11
  s_waitcnt lgkmcnt(2)
  v_add_f32 v160, v160, v12
  v_add_f32 v161, v161, v13
  v_add_f32 v162, v162, v14
  v_add_f32 v163, v163, v15
  s_waitcnt lgkmcnt(1)
  v_add_f32 v156, v156, v16
  v_add_f32 v157, v157, v17
  v_add_f32 v158, v158, v18
  v_add_f32 v159, v159, v19
  s_waitcnt lgkmcnt(0)
  v_add_f32 v160, v160, v20
  v_add_f32 v161, v161, v21
  v_add_f32 v162, v162, v22
  v_add_f32 v163, v163, v23
  v_cvt_pk_bf16_f32 v148, v156, v157
  v_cvt_pk_bf16_f32 v149, v158, v159
  v_cvt_pk_bf16_f32 v150, v160, v161
  v_cvt_pk_bf16_f32 v151, v162, v163
  buffer_store_dwordx4 v[148:151], v167, s[48:51], s64 offen
  s_nop 1
O_next:
  s_cmp_lt_u32 s59, 64
  s_cbranch_scc1 O_loop
  s_branch L_exit
L_cexit:
L_exit:
L_end:
s_endpgm
.section .rodata,"a"
.p2align 6
.amdhsa_kernel gated_mix__sliding_local_dilated__memory_aug_recurrent_mem_tr__prompt_kernel
  .amdhsa_next_free_vgpr 512
  .amdhsa_next_free_sgpr 102
  .amdhsa_accum_offset 256
  .amdhsa_group_segment_fixed_size 0
  .amdhsa_kernarg_size 112
  .amdhsa_user_sgpr_count 2
  .amdhsa_user_sgpr_kernarg_segment_ptr 1
  .amdhsa_system_sgpr_workgroup_id_x 1
.end_amdhsa_kernel
```

```asm
; @launch grid=(256,1,1) block=(256,1,1) lds=163840
.amdgcn_target "amdgcn-amd-amdhsa--gfx950"
.text
.globl gated_mix__sliding_local_dilated__memory_aug_recurrent_mem_tr__prompt_kernel
.p2align 8
.type gated_mix__sliding_local_dilated__memory_aug_recurrent_mem_tr__prompt_kernel,@function
gated_mix__sliding_local_dilated__memory_aug_recurrent_mem_tr__prompt_kernel:
  s_cmp_ge_u32 s2, 256
  s_cbranch_scc1 L_end
  s_load_dwordx2 s[4:5], s[0:1], 0
  s_load_dwordx2 s[8:9], s[0:1], 104
  s_load_dwordx2 s[12:13], s[0:1], 96
  s_load_dwordx2 s[16:17], s[0:1], 40
  s_load_dwordx2 s[20:21], s[0:1], 48
  s_load_dwordx2 s[24:25], s[0:1], 56
  s_load_dwordx2 s[28:29], s[0:1], 64
  s_load_dwordx2 s[32:33], s[0:1], 32
  s_load_dwordx2 s[36:37], s[0:1], 8
  s_load_dwordx2 s[40:41], s[0:1], 16
  s_load_dwordx2 s[44:45], s[0:1], 80
  s_load_dwordx2 s[48:49], s[0:1], 88
  s_getreg_b32 s54, hwreg(HW_REG_XCC_ID, 0, 3)
  v_lshrrev_b32 v1, 6, v0
  s_nop 0
  v_readfirstlane_b32 s52, v1
  s_mov_b32 s6, 2359296
  s_mov_b32 s7, 0x20000
  s_mov_b32 s10, 268435456
  s_mov_b32 s11, 0x20000
  s_mov_b32 s14, 256
  s_mov_b32 s15, 0x20000
  s_mov_b32 s18, 4718592
  s_mov_b32 s19, 0x20000
  s_mov_b32 s22, 4718592
  s_mov_b32 s23, 0x20000
  s_mov_b32 s26, 4718592
  s_mov_b32 s27, 0x20000
  s_mov_b32 s30, 4718592
  s_mov_b32 s31, 0x20000
  s_mov_b32 s34, 9216
  s_mov_b32 s35, 0x20000
  s_mov_b32 s38, 1990656
  s_mov_b32 s39, 0x20000
  s_mov_b32 s42, 663552
  s_mov_b32 s43, 0x20000
  s_mov_b32 s46, 1152
  s_mov_b32 s47, 0x20000
  s_mov_b32 s50, 2359296
  s_mov_b32 s51, 0x20000
  s_waitcnt lgkmcnt(0)
  s_lshr_b32 s0, s2, 3
  s_mov_b32 s2, s54
  s_mov_b32 s1, 0
  s_lshl_b32 s55, s2, 2
  s_cmp_eq_u32 s52, 0
  s_cselect_b32 s55, s55, 0x1000
  s_lshl_b32 s56, 1, s0
  v_mov_b32 v1, 0
  v_mov_b32 v35, s56
  s_mov_b64 exec, 1
  buffer_atomic_or v35, v1, s[12:15], s55 offen sc0
  s_mov_b64 exec, -1
L_role:
  s_mov_b32 s53, s0
  s_cmp_eq_u32 s2, 0
  s_cbranch_scc0 L_worker
  v_and_b32 v0, 63, v0
  v_and_b32 v1, 15, v0
  v_lshrrev_b32 v2, 4, v0
  v_and_b32 v3, 1, v2
  s_lshl_b32 s54, s52, 1
  v_add_u32 v3, s54, v3
  v_lshlrev_b32 v3, 1, v3
  v_xor_b32 v3, v3, v1
  v_lshlrev_b32 v3, 4, v3
  v_lshl_add_u32 v8, v2, 13, v3
  s_lshl_b32 s78, s53, 8
  s_lshl_b32 s54, s52, 15
  s_add_u32 s78, s78, s54
  s_mul_i32 s79, s53, 147456
  s_lshl_b32 s57, s52, 10
  s_add_u32 s57, s57, 16384
  s_getpc_b64 s[80:81]
L_pc_1:
  s_and_b32 s55, s0, 1
  s_lshl_b32 s55, s55, 2
  s_add_u32 s55, s55, s52
  s_lshl_b32 s55, s55, 10
  v_and_b32 v199, 63, v0
  v_lshl_add_u32 v199, v199, 4, s55
  v_min_u32 v199, (L_w0 - L_pc_1), v199
  global_load_dword v196, v199, s[80:81]
  s_add_u32 m0, s57, 0
  s_add_u32 s54, s78, 524288
  buffer_load_dwordx4 v8, s[16:19], s54 offen  lds
  s_add_u32 m0, s57, 4096
  s_add_u32 s54, s78, 655360
  buffer_load_dwordx4 v8, s[16:19], s54 offen  lds
  s_add_u32 m0, s57, 8192
  s_add_u32 s54, s78, 786432
  buffer_load_dwordx4 v8, s[16:19], s54 offen  lds
  s_add_u32 m0, s57, 12288
  s_add_u32 s54, s78, 917504
  buffer_load_dwordx4 v8, s[16:19], s54 offen  lds
  s_add_u32 m0, s57, 16384
  s_add_u32 s54, s78, 1048576
  buffer_load_dwordx4 v8, s[16:19], s54 offen  lds
  s_add_u32 m0, s57, 20480
  s_add_u32 s54, s78, 1179648
  buffer_load_dwordx4 v8, s[16:19], s54 offen  lds
  s_add_u32 m0, s57, 24576
  s_add_u32 s54, s78, 1310720
  buffer_load_dwordx4 v8, s[16:19], s54 offen  lds
  s_add_u32 m0, s57, 28672
  s_add_u32 s54, s78, 1441792
  buffer_load_dwordx4 v8, s[16:19], s54 offen  lds
  s_add_u32 m0, s57, 32768
  s_add_u32 s54, s78, 1572864
  buffer_load_dwordx4 v8, s[16:19], s54 offen  lds
  s_add_u32 m0, s57, 36864
  s_add_u32 s54, s78, 1703936
  buffer_load_dwordx4 v8, s[16:19], s54 offen  lds
  s_add_u32 m0, s57, 40960
  s_add_u32 s54, s78, 1835008
  buffer_load_dwordx4 v8, s[16:19], s54 offen  lds
  s_add_u32 m0, s57, 45056
  s_add_u32 s54, s78, 1966080
  buffer_load_dwordx4 v8, s[16:19], s54 offen  lds
  s_add_u32 m0, s57, 49152
  s_add_u32 s54, s78, 2097152
  buffer_load_dwordx4 v8, s[16:19], s54 offen  lds
  s_add_u32 m0, s57, 53248
  s_add_u32 s54, s78, 2228224
  buffer_load_dwordx4 v8, s[16:19], s54 offen  lds
  s_add_u32 m0, s57, 57344
  s_add_u32 s54, s78, 2359296
  buffer_load_dwordx4 v8, s[16:19], s54 offen  lds
  s_add_u32 m0, s57, 61440
  s_add_u32 s54, s78, 2490368
  buffer_load_dwordx4 v8, s[16:19], s54 offen  lds
  s_add_u32 m0, s57, 65536
  s_add_u32 s54, s78, 2621440
  buffer_load_dwordx4 v8, s[16:19], s54 offen  lds
  s_add_u32 m0, s57, 69632
  s_add_u32 s54, s78, 2752512
  buffer_load_dwordx4 v8, s[16:19], s54 offen  lds
  s_add_u32 m0, s57, 73728
  s_add_u32 s54, s78, 2883584
  buffer_load_dwordx4 v8, s[16:19], s54 offen  lds
  s_add_u32 m0, s57, 77824
  s_add_u32 s54, s78, 3014656
  buffer_load_dwordx4 v8, s[16:19], s54 offen  lds
  v_lshlrev_b32 v76, 4, v0
  v_add_u32 v75, 0x10000, v76
  v_lshrrev_b32 v3, 2, v1
  v_and_b32 v4, 1, v1
  v_lshl_add_u32 v3, v3, 1, v4
  v_bfe_u32 v4, v1, 1, 1
  v_mul_u32_u24 v74, 0xaaaa, v4
  v_add_u32 v74, 0x4444, v74
  v_mul_u32_u24 v5, 576, v3
  v_add_u32 v5, 0, v5
  v_lshl_add_u32 v78, v2, 4, v5
  v_lshl_add_u32 v77, v2, 5, v5
  v_lshl_add_u32 v77, v4, 4, v77
  v_mul_u32_u24 v15, 1152, v3
  v_lshl_add_u32 v15, v2, 5, v15
  v_lshl_add_u32 v15, v4, 4, v15
  s_lshl_b32 s54, s52, 8
  buffer_load_dwordx4 v[20:23], v15, s[32:35], s54 offen
  buffer_load_dwordx4 v[24:27], v15, s[32:35], s54 offen offset:128
  buffer_load_dwordx4 v[28:31], v15, s[32:35], 0 offen offset:1024
  v_mul_u32_u24 v79, 1152, v2
  v_lshl_add_u32 v79, v1, 2, v79
  s_lshl_b32 s54, s52, 6
  s_add_u32 s54, s54, 0
  v_add_u32 v79, s54, v79
  v_lshrrev_b32 v5, 3, v0
  v_mul_u32_u24 v68, 2176, v5
  v_and_b32 v5, 7, v0
  v_lshl_add_u32 v68, v5, 3, v68
  v_and_b32 v5, 1, v2
  v_lshlrev_b32 v5, 4, v5
  v_lshl_add_u32 v5, v1, 2, v5
  v_mov_b32 v6, 0x40000000
  v_cmp_lt_u32 vcc, 3, v1
  s_nop 1
  v_cndmask_b32 v5, v5, v6, vcc
  v_lshrrev_b32 v6, 1, v2
  v_lshl_add_u32 v69, v6, 10, v5
  v_lshl_add_u32 v70, v6, 8, v5
  v_mov_b32 v71, -1
  ds_write_b128 v76, v[68:71] offset:13824
  v_and_b32 v5, 3, v1
  v_lshrrev_b32 v6, 2, v1
  v_lshl_add_u32 v5, v5, 2, v6
  v_and_b32 v6, 1, v5
  v_lshlrev_b32 v6, 4, v6
  v_mov_b32 v7, 0x3f80
  v_lshlrev_b32 v6, v6, v7
  v_lshrrev_b32 v5, 1, v5
  v_cmp_eq_u32 vcc, 0, v5
  s_nop 1
  v_cndmask_b32 v40, 0, v6, vcc
  v_cmp_eq_u32 vcc, 1, v5
  s_nop 1
  v_cndmask_b32 v41, 0, v6, vcc
  v_cmp_eq_u32 vcc, 2, v5
  s_nop 1
  v_cndmask_b32 v42, 0, v6, vcc
  v_cmp_eq_u32 vcc, 3, v5
  s_nop 1
  v_cndmask_b32 v43, 0, v6, vcc
  ds_write_b128 v76, v[40:43] offset:14848
  s_and_b32 s54, s52, 1
  s_lshr_b32 s55, s52, 1
  v_lshrrev_b32 v3, 3, v0
  v_and_b32 v4, 1, v3
  v_lshlrev_b32 v4, 4, v4
  v_and_b32 v5, 6, v3
  v_add_u32 v4, v4, v5
  s_lshl_b32 s56, s55, 3
  s_add_u32 s56, s56, s54
  v_add_u32 v4, s56, v4
  v_mul_u32_u24 v4, 1152, v4
  v_and_b32 v5, 2, v3
  v_lshlrev_b32 v5, 1, v5
  v_and_b32 v6, 7, v0
  v_xor_b32 v6, v6, v5
  v_lshl_add_u32 v9, v6, 4, v4
  v_and_b32 v4, 1, v2
  v_lshlrev_b32 v4, 4, v4
  v_and_b32 v5, 2, v2
  v_add_u32 v4, v4, v5
  s_lshl_b32 s56, s55, 2
  s_add_u32 s56, s56, s54
  v_add_u32 v4, s56, v4
  v_mul_u32_u24 v4, 1152, v4
  v_lshlrev_b32 v6, 1, v2
  v_xor_b32 v6, v6, v1
  v_lshl_add_u32 v10, v6, 4, v4
  v_bfe_u32 v17, v1, 2, 1
  v_bfe_u32 v18, v1, 3, 1
  v_and_b32 v19, 1, v2
  v_lshrrev_b32 v72, 1, v2
  v_and_b32 v73, 3, v1
  v_lshl_add_u32 v3, v19, 1, v17
  v_lshl_add_u32 v6, v18, 2, v3
  v_lshl_add_u32 v4, v72, 4, v17
  v_lshl_add_u32 v4, v19, 2, v4
  v_lshl_add_u32 v4, v18, 3, v4
  v_lshlrev_b32 v4, 8, v4
  s_lshl_b32 s54, s52, 6
  v_lshl_add_u32 v5, v73, 3, s54
  v_lshlrev_b32 v7, 5, v6
  v_xor_b32 v5, v5, v7
  v_add_u32 v11, v4, v5
  v_xor_b32 v12, 32, v11
  v_lshl_add_u32 v4, v72, 2, v3
  v_lshlrev_b32 v4, 7, v4
  v_lshl_add_u32 v4, v73, 3, v4
  s_and_b32 s54, s52, 1
  v_xor_b32 v7, s54, v19
  v_lshl_add_u32 v7, v7, 1, v18
  v_lshl_add_u32 v13, v7, 5, v4
  v_lshlrev_b32 v4, 11, v72
  v_lshl_add_u32 v4, v73, 3, v4
  v_lshl_add_u32 v5, v3, 8, v4
  v_lshl_add_u32 v7, v18, 2, s52
  v_xor_b32 v7, v7, v3
  v_lshl_add_u32 v14, v7, 5, v5
  s_lshl_b32 s54, s53, 14
  s_lshl_b32 s55, s52, 11
  s_add_u32 s54, s54, 1048576
  s_add_u32 s58, s54, s55
  s_add_u32 s59, s58, 8192
  s_lshl_b32 s55, s52, 12
  s_add_u32 s70, s54, s55
  s_add_u32 s70, s70, 655360
  s_lshl_b32 s54, s53, 12
  s_lshl_b32 s55, s52, 10
  s_add_u32 s54, s54, s55
  s_add_u32 s68, s54, 917504
  s_lshl_b32 s54, s53, 7
  s_add_u32 s71, s54, 352256
  s_lshl_b32 s54, s53, 6
  s_mul_i32 s55, s52, 17408
  s_add_u32 s55, s54, s55
  s_add_u32 s73, s55, 0
  s_add_u32 s74, s55, 69632
  s_add_u32 s75, s55, 139264
  s_add_u32 s76, s55, 208896
  s_and_b32 s56, s52, 1
  s_mul_i32 s55, s56, 17408
  s_add_u32 s55, s54, s55
  s_add_u32 s77, s55, 278528
  s_mul_i32 s54, s52, 69632
  s_mul_i32 s55, s53, 2176
  s_add_u32 s54, s54, s55
  s_add_u32 s60, s54, 0
  s_and_b32 s56, s53, 15
  s_mul_i32 s55, s56, 2176
  s_add_u32 s61, s55, 278528
  s_lshl_b32 s54, s52, 11
  s_add_u32 s64, s54, 360448
  s_mov_b32 s65, 368640
  s_lshl_b32 s55, s53, 5
  s_add_u32 s54, s54, s55
  s_add_u32 s62, s54, 376832
  s_lshr_b32 s54, s56, 3
  s_lshl_b32 s54, s54, 9
  s_and_b32 s55, s56, 7
  s_lshl_b32 s55, s55, 5
  s_add_u32 s54, s54, s55
  s_add_u32 s63, s54, 385024
  s_mov_b32 s66, 0
  s_mov_b32 s67, 0
  s_mov_b32 s72, 0
  s_mov_b32 s69, 1040356334
  s_waitcnt vmcnt(19) lgkmcnt(0)
  s_barrier
  s_add_u32 m0, s57, 81920
  s_add_u32 s54, s78, 3145728
  buffer_load_dwordx4 v8, s[16:19], s54 offen  lds
  s_add_u32 m0, s57, 86016
  s_add_u32 s54, s78, 3276800
  buffer_load_dwordx4 v8, s[16:19], s54 offen  lds
  s_add_u32 m0, s57, 90112
  s_add_u32 s54, s78, 3407872
  buffer_load_dwordx4 v8, s[16:19], s54 offen  lds
  s_add_u32 m0, s57, 94208
  s_add_u32 s54, s78, 3538944
  buffer_load_dwordx4 v8, s[16:19], s54 offen  lds
  v_add_u32 v15, 16384, v11
  v_add_u32 v16, 16384, v12
  ds_read_b64_tr_b16 v[80:81], v15 offset:0
  ds_read_b64_tr_b16 v[82:83], v15 offset:512
  ds_read_b64_tr_b16 v[84:85], v15 offset:8192
  ds_read_b64_tr_b16 v[86:87], v15 offset:8704
  ds_read_b64_tr_b16 v[88:89], v16 offset:0
  ds_read_b64_tr_b16 v[90:91], v16 offset:512
  ds_read_b64_tr_b16 v[92:93], v16 offset:8192
  ds_read_b64_tr_b16 v[94:95], v16 offset:8704
  s_waitcnt vmcnt(19) lgkmcnt(0)
  s_barrier
  s_add_u32 m0, s57, 98304
  s_add_u32 s54, s78, 3670016
  buffer_load_dwordx4 v8, s[16:19], s54 offen  lds
  s_add_u32 m0, s57, 102400
  s_add_u32 s54, s78, 3801088
  buffer_load_dwordx4 v8, s[16:19], s54 offen  lds
  s_add_u32 m0, s57, 106496
  s_add_u32 s54, s78, 3932160
  buffer_load_dwordx4 v8, s[16:19], s54 offen  lds
  s_add_u32 m0, s57, 110592
  s_add_u32 s54, s78, 4063232
  buffer_load_dwordx4 v8, s[16:19], s54 offen  lds
  v_add_u32 v15, 32768, v11
  v_add_u32 v16, 32768, v12
  ds_read_b64_tr_b16 v[96:97], v15 offset:0
  ds_read_b64_tr_b16 v[98:99], v15 offset:512
  ds_read_b64_tr_b16 v[100:101], v15 offset:8192
  ds_read_b64_tr_b16 v[102:103], v15 offset:8704
  ds_read_b64_tr_b16 v[104:105], v16 offset:0
  ds_read_b64_tr_b16 v[106:107], v16 offset:512
  ds_read_b64_tr_b16 v[108:109], v16 offset:8192
  ds_read_b64_tr_b16 v[110:111], v16 offset:8704
  s_waitcnt vmcnt(19) lgkmcnt(0)
  s_barrier
  s_add_u32 m0, s57, 114688
  s_add_u32 s54, s78, 4194304
  buffer_load_dwordx4 v8, s[16:19], s54 offen  lds
  s_add_u32 m0, s57, 118784
  s_add_u32 s54, s78, 4325376
  buffer_load_dwordx4 v8, s[16:19], s54 offen  lds
  s_add_u32 m0, s57, 122880
  s_add_u32 s54, s78, 4456448
  buffer_load_dwordx4 v8, s[16:19], s54 offen  lds
  s_add_u32 m0, s57, 126976
  s_add_u32 s54, s78, 4587520
  buffer_load_dwordx4 v8, s[16:19], s54 offen  lds
  v_add_u32 v15, 49152, v11
  v_add_u32 v16, 49152, v12
  ds_read_b64_tr_b16 v[112:113], v15 offset:0
  ds_read_b64_tr_b16 v[114:115], v15 offset:512
  ds_read_b64_tr_b16 v[116:117], v15 offset:8192
  ds_read_b64_tr_b16 v[118:119], v15 offset:8704
  ds_read_b64_tr_b16 v[120:121], v16 offset:0
  ds_read_b64_tr_b16 v[122:123], v16 offset:512
  ds_read_b64_tr_b16 v[124:125], v16 offset:8192
  ds_read_b64_tr_b16 v[126:127], v16 offset:8704
  s_waitcnt vmcnt(19) lgkmcnt(0)
  s_barrier
  s_add_u32 m0, s57, 131072
  s_add_u32 s54, s78, 524288
  buffer_load_dwordx4 v8, s[20:23], s54 offen  lds
  s_add_u32 m0, s57, 135168
  s_add_u32 s54, s78, 655360
  buffer_load_dwordx4 v8, s[20:23], s54 offen  lds
  s_add_u32 m0, s57, 139264
  s_add_u32 s54, s78, 786432
  buffer_load_dwordx4 v8, s[20:23], s54 offen  lds
  s_add_u32 m0, s57, 143360
  s_add_u32 s54, s78, 917504
  buffer_load_dwordx4 v8, s[20:23], s54 offen  lds
  v_add_u32 v15, 65536, v11
  v_add_u32 v16, 65536, v12
  ds_read_b64_tr_b16 v[128:129], v15 offset:0
  ds_read_b64_tr_b16 v[130:131], v15 offset:512
  ds_read_b64_tr_b16 v[132:133], v15 offset:8192
  ds_read_b64_tr_b16 v[134:135], v15 offset:8704
  ds_read_b64_tr_b16 v[136:137], v16 offset:0
  ds_read_b64_tr_b16 v[138:139], v16 offset:512
  ds_read_b64_tr_b16 v[140:141], v16 offset:8192
  ds_read_b64_tr_b16 v[142:143], v16 offset:8704
  s_waitcnt vmcnt(19) lgkmcnt(0)
  s_barrier
  s_add_u32 m0, s57, 0
  s_add_u32 s54, s78, 1572864
  buffer_load_dwordx4 v8, s[20:23], s54 offen  lds
  s_add_u32 m0, s57, 4096
  s_add_u32 s54, s78, 1703936
  buffer_load_dwordx4 v8, s[20:23], s54 offen  lds
  s_add_u32 m0, s57, 8192
  s_add_u32 s54, s78, 1835008
  buffer_load_dwordx4 v8, s[20:23], s54 offen  lds
  s_add_u32 m0, s57, 12288
  s_add_u32 s54, s78, 1966080
  buffer_load_dwordx4 v8, s[20:23], s54 offen  lds
  v_add_u32 v15, 81920, v11
  v_add_u32 v16, 81920, v12
  ds_read_b64_tr_b16 v[144:145], v15 offset:0
  ds_read_b64_tr_b16 v[146:147], v15 offset:512
  ds_read_b64_tr_b16 v[148:149], v15 offset:8192
  ds_read_b64_tr_b16 v[150:151], v15 offset:8704
  ds_read_b64_tr_b16 v[152:153], v16 offset:0
  ds_read_b64_tr_b16 v[154:155], v16 offset:512
  ds_read_b64_tr_b16 v[156:157], v16 offset:8192
  ds_read_b64_tr_b16 v[158:159], v16 offset:8704
  s_waitcnt vmcnt(16) lgkmcnt(0)
  s_barrier
  s_add_u32 m0, s57, 16384
  s_add_u32 s54, s78, 3145728
  buffer_load_dwordx4 v8, s[20:23], s54 offen  lds
  s_add_u32 m0, s57, 20480
  s_add_u32 s54, s78, 3276800
  buffer_load_dwordx4 v8, s[20:23], s54 offen  lds
  s_add_u32 m0, s57, 24576
  s_add_u32 s54, s78, 3407872
  buffer_load_dwordx4 v8, s[20:23], s54 offen  lds
  s_add_u32 m0, s57, 28672
  s_add_u32 s54, s78, 3538944
  buffer_load_dwordx4 v8, s[20:23], s54 offen  lds
  v_add_u32 v15, 98304, v11
  v_add_u32 v16, 98304, v12
  ds_read_b64_tr_b16 v[160:161], v15 offset:0
  ds_read_b64_tr_b16 v[162:163], v15 offset:512
  ds_read_b64_tr_b16 v[164:165], v15 offset:8192
  ds_read_b64_tr_b16 v[166:167], v15 offset:8704
  ds_read_b64_tr_b16 v[168:169], v16 offset:0
  ds_read_b64_tr_b16 v[170:171], v16 offset:512
  ds_read_b64_tr_b16 v[172:173], v16 offset:8192
  ds_read_b64_tr_b16 v[174:175], v16 offset:8704
  s_waitcnt vmcnt(16) lgkmcnt(0)
  s_barrier
  s_add_u32 m0, s57, 32768
  s_add_u32 s54, s78, 3670016
  buffer_load_dwordx4 v8, s[20:23], s54 offen  lds
  s_add_u32 m0, s57, 36864
  s_add_u32 s54, s78, 3801088
  buffer_load_dwordx4 v8, s[20:23], s54 offen  lds
  s_add_u32 m0, s57, 40960
  s_add_u32 s54, s78, 3932160
  buffer_load_dwordx4 v8, s[20:23], s54 offen  lds
  s_add_u32 m0, s57, 45056
  s_add_u32 s54, s78, 4063232
  buffer_load_dwordx4 v8, s[20:23], s54 offen  lds
  s_cmp_eq_u32 s1, 1
  s_cbranch_scc1 C_ver_ok
  v_mov_b32 v33, 16320
  s_cmp_eq_u32 s52, 0
  s_cbranch_scc0 C_ver_b
  s_waitcnt vmcnt(52)
  s_mov_b64 exec, 1
  ds_write_b32 v33, v35
  s_mov_b64 exec, -1
  s_waitcnt lgkmcnt(0)
C_ver_b:
  s_barrier
  ds_read_b32 v32, v33
  s_waitcnt lgkmcnt(0)
  v_readfirstlane_b32 s54, v32
  s_nop 0
  s_bitcmp1_b32 s54, s0
  s_cbranch_scc1 L_conf
C_ver_ok:
  v_add_u32 v15, 114688, v11
  v_add_u32 v16, 114688, v12
  ds_read_b64_tr_b16 v[176:177], v15 offset:0
  ds_read_b64_tr_b16 v[178:179], v15 offset:512
  ds_read_b64_tr_b16 v[180:181], v15 offset:8192
  ds_read_b64_tr_b16 v[182:183], v15 offset:8704
  ds_read_b64_tr_b16 v[184:185], v16 offset:0
  ds_read_b64_tr_b16 v[186:187], v16 offset:512
  ds_read_b64_tr_b16 v[188:189], v16 offset:8192
  ds_read_b64_tr_b16 v[190:191], v16 offset:8704
  s_waitcnt vmcnt(16) lgkmcnt(0)
  s_barrier
  s_add_u32 m0, s57, 49152
  s_add_u32 s54, s78, 4194304
  buffer_load_dwordx4 v8, s[20:23], s54 offen  lds
  s_add_u32 m0, s57, 53248
  s_add_u32 s54, s78, 4325376
  buffer_load_dwordx4 v8, s[20:23], s54 offen  lds
  s_add_u32 m0, s57, 57344
  s_add_u32 s54, s78, 4456448
  buffer_load_dwordx4 v8, s[20:23], s54 offen  lds
  s_add_u32 m0, s57, 61440
  s_add_u32 s54, s78, 4587520
  buffer_load_dwordx4 v8, s[20:23], s54 offen  lds
  v_add_u32 v15, 131072, v11
  v_add_u32 v16, 131072, v12
  ds_read_b64_tr_b16 v[192:193], v15 offset:0
  ds_read_b64_tr_b16 v[194:195], v15 offset:512
  ds_read_b64_tr_b16 v[196:197], v15 offset:8192
  ds_read_b64_tr_b16 v[198:199], v15 offset:8704
  ds_read_b64_tr_b16 v[200:201], v16 offset:0
  ds_read_b64_tr_b16 v[202:203], v16 offset:512
  ds_read_b64_tr_b16 v[204:205], v16 offset:8192
  ds_read_b64_tr_b16 v[206:207], v16 offset:8704
  s_waitcnt vmcnt(16) lgkmcnt(0)
  s_barrier
  s_add_u32 m0, s57, 65536
  s_add_u32 s54, s78, 0
  buffer_load_dwordx4 v8, s[24:27], s54 offen  lds
  s_add_u32 m0, s57, 69632
  s_add_u32 s54, s78, 131072
  buffer_load_dwordx4 v8, s[24:27], s54 offen  lds
  s_add_u32 m0, s57, 73728
  s_add_u32 s54, s78, 262144
  buffer_load_dwordx4 v8, s[24:27], s54 offen  lds
  s_add_u32 m0, s57, 77824
  s_add_u32 s54, s78, 393216
  buffer_load_dwordx4 v8, s[24:27], s54 offen  lds
  s_getpc_b64 s[80:81]
  v_lshlrev_b32 v7, 2, v76
  global_load_dword v35, v7, s[80:81] offset:1024
  v_mov_b32 v4, -1
  v_mov_b32 v5, -1
  v_mov_b64 v[6:7], v[4:5]
  v_mov_b32 v3, 0
  s_lshl_b32 s56, s53, 14
  s_xor_b32 s54, s64, s56
  s_xor_b32 s55, s65, s56
  s_cmp_lt_u32 s53, 2
  s_cselect_b32 s54, s54, 268435456
  s_cselect_b32 s55, s55, 268435456
  s_lshr_b32 s56, s53, 4
  s_or_b32 s56, s56, s52
  s_cmp_eq_u32 s56, 0
  s_cselect_b32 s56, s61, 268435456
  buffer_store_dwordx4 v[4:7], v76, s[8:11], s60 offen offset:0 sc1
  buffer_store_dwordx4 v[4:7], v76, s[8:11], s60 offen offset:1024 sc1
  buffer_store_dwordx4 v[4:7], v76, s[8:11], s56 offen offset:0 sc1
  buffer_store_dwordx4 v[4:7], v76, s[8:11], s56 offen offset:1024 sc1
  buffer_store_dwordx4 v[4:7], v76, s[8:11], s54 offen offset:0 sc1
  buffer_store_dwordx4 v[4:7], v76, s[8:11], s54 offen offset:1024 sc1
  buffer_store_dwordx4 v[4:7], v76, s[8:11], s55 offen offset:0 sc1
  s_mov_b64 exec, 1
  buffer_store_dword v3, v3, s[8:11], s71 offen sc1
  s_mov_b64 exec, -1
  v_min_u32 v20, -2, v20
  v_min_u32 v21, -2, v21
  v_min_u32 v22, -2, v22
  v_min_u32 v23, -2, v23
  v_min_u32 v24, -2, v24
  v_min_u32 v25, -2, v25
  v_min_u32 v26, -2, v26
  v_min_u32 v27, -2, v27
  v_min_u32 v28, -2, v28
  v_min_u32 v29, -2, v29
  v_min_u32 v30, -2, v30
  v_min_u32 v31, -2, v31
  s_lshl_b32 s54, s52, 11
  v_add_u32 v3, s54, v76
  ds_write_b128 v3, v[20:23] offset:4608
  ds_write_b128 v3, v[24:27] offset:5632
  ds_write_b128 v76, v[28:31] offset:12800
  v_add_u32 v15, 147456, v11
  v_add_u32 v16, 147456, v12
  ds_read_b64_tr_b16 v[208:209], v15 offset:0
  ds_read_b64_tr_b16 v[210:211], v15 offset:512
  ds_read_b64_tr_b16 v[212:213], v15 offset:8192
  ds_read_b64_tr_b16 v[214:215], v15 offset:8704
  ds_read_b64_tr_b16 v[216:217], v16 offset:0
  ds_read_b64_tr_b16 v[218:219], v16 offset:512
  ds_read_b64_tr_b16 v[220:221], v16 offset:8192
  ds_read_b64_tr_b16 v[222:223], v16 offset:8704
  s_waitcnt vmcnt(25) lgkmcnt(0)
  s_barrier
  s_add_u32 m0, s57, 81920
  s_add_u32 s54, s78, 524288
  buffer_load_dwordx4 v8, s[24:27], s54 offen  lds
  s_add_u32 m0, s57, 86016
  s_add_u32 s54, s78, 655360
  buffer_load_dwordx4 v8, s[24:27], s54 offen  lds
  s_add_u32 m0, s57, 90112
  s_add_u32 s54, s78, 786432
  buffer_load_dwordx4 v8, s[24:27], s54 offen  lds
  s_add_u32 m0, s57, 94208
  s_add_u32 s54, s78, 917504
  buffer_load_dwordx4 v8, s[24:27], s54 offen  lds
  v_add_u32 v15, 16384, v11
  v_add_u32 v16, 16384, v12
  ds_read_b64_tr_b16 v[224:225], v15 offset:0
  ds_read_b64_tr_b16 v[226:227], v15 offset:512
  ds_read_b64_tr_b16 v[228:229], v15 offset:8192
  ds_read_b64_tr_b16 v[230:231], v15 offset:8704
  ds_read_b64_tr_b16 v[232:233], v16 offset:0
  ds_read_b64_tr_b16 v[234:235], v16 offset:512
  ds_read_b64_tr_b16 v[236:237], v16 offset:8192
  ds_read_b64_tr_b16 v[238:239], v16 offset:8704
  s_waitcnt vmcnt(25) lgkmcnt(0)
  s_barrier
  s_add_u32 m0, s57, 98304
  s_add_u32 s54, s78, 1048576
  buffer_load_dwordx4 v8, s[24:27], s54 offen  lds
  s_add_u32 m0, s57, 102400
  s_add_u32 s54, s78, 1179648
  buffer_load_dwordx4 v8, s[24:27], s54 offen  lds
  s_add_u32 m0, s57, 106496
  s_add_u32 s54, s78, 1310720
  buffer_load_dwordx4 v8, s[24:27], s54 offen  lds
  s_add_u32 m0, s57, 110592
  s_add_u32 s54, s78, 1441792
  buffer_load_dwordx4 v8, s[24:27], s54 offen  lds
  v_add_u32 v15, 32768, v11
  v_add_u32 v16, 32768, v12
  ds_read_b64_tr_b16 v[240:241], v15 offset:0
  ds_read_b64_tr_b16 v[242:243], v15 offset:512
  ds_read_b64_tr_b16 v[244:245], v15 offset:8192
  ds_read_b64_tr_b16 v[246:247], v15 offset:8704
  ds_read_b64_tr_b16 v[248:249], v16 offset:0
  ds_read_b64_tr_b16 v[250:251], v16 offset:512
  ds_read_b64_tr_b16 v[252:253], v16 offset:8192
  ds_read_b64_tr_b16 v[254:255], v16 offset:8704
  s_waitcnt vmcnt(25) lgkmcnt(0)
  s_barrier
  s_add_u32 m0, s57, 114688
  s_add_u32 s54, s78, 1572864
  buffer_load_dwordx4 v8, s[24:27], s54 offen  lds
  s_add_u32 m0, s57, 118784
  s_add_u32 s54, s78, 1703936
  buffer_load_dwordx4 v8, s[24:27], s54 offen  lds
  s_add_u32 m0, s57, 122880
  s_add_u32 s54, s78, 1835008
  buffer_load_dwordx4 v8, s[24:27], s54 offen  lds
  s_add_u32 m0, s57, 126976
  s_add_u32 s54, s78, 1966080
  buffer_load_dwordx4 v8, s[24:27], s54 offen  lds
  v_add_u32 v15, 49152, v11
  v_add_u32 v16, 49152, v12
  ds_read_b64_tr_b16 a[0:1], v15 offset:0
  ds_read_b64_tr_b16 a[2:3], v15 offset:512
  ds_read_b64_tr_b16 a[4:5], v15 offset:8192
  ds_read_b64_tr_b16 a[6:7], v15 offset:8704
  ds_read_b64_tr_b16 a[8:9], v16 offset:0
  ds_read_b64_tr_b16 a[10:11], v16 offset:512
  ds_read_b64_tr_b16 a[12:13], v16 offset:8192
  ds_read_b64_tr_b16 a[14:15], v16 offset:8704
  s_waitcnt vmcnt(25) lgkmcnt(0)
  s_barrier
  s_add_u32 m0, s57, 131072
  s_add_u32 s54, s78, 2097152
  buffer_load_dwordx4 v8, s[24:27], s54 offen  lds
  s_add_u32 m0, s57, 135168
  s_add_u32 s54, s78, 2228224
  buffer_load_dwordx4 v8, s[24:27], s54 offen  lds
  s_add_u32 m0, s57, 139264
  s_add_u32 s54, s78, 2359296
  buffer_load_dwordx4 v8, s[24:27], s54 offen  lds
  s_add_u32 m0, s57, 143360
  s_add_u32 s54, s78, 2490368
  buffer_load_dwordx4 v8, s[24:27], s54 offen  lds
  v_add_u32 v15, 65536, v11
  v_add_u32 v16, 65536, v12
  ds_read_b64_tr_b16 a[16:17], v15 offset:0
  ds_read_b64_tr_b16 a[18:19], v15 offset:512
  ds_read_b64_tr_b16 a[20:21], v15 offset:8192
  ds_read_b64_tr_b16 a[22:23], v15 offset:8704
  ds_read_b64_tr_b16 a[24:25], v16 offset:0
  ds_read_b64_tr_b16 a[26:27], v16 offset:512
  ds_read_b64_tr_b16 a[28:29], v16 offset:8192
  ds_read_b64_tr_b16 a[30:31], v16 offset:8704
  s_waitcnt vmcnt(25) lgkmcnt(0)
  s_barrier
  s_add_u32 m0, s57, 0
  s_add_u32 s54, s78, 2621440
  buffer_load_dwordx4 v8, s[24:27], s54 offen  lds
  s_add_u32 m0, s57, 4096
  s_add_u32 s54, s78, 2752512
  buffer_load_dwordx4 v8, s[24:27], s54 offen  lds
  s_add_u32 m0, s57, 8192
  s_add_u32 s54, s78, 2883584
  buffer_load_dwordx4 v8, s[24:27], s54 offen  lds
  s_add_u32 m0, s57, 12288
  s_add_u32 s54, s78, 3014656
  buffer_load_dwordx4 v8, s[24:27], s54 offen  lds
  v_add_u32 v15, 81920, v11
  v_add_u32 v16, 81920, v12
  ds_read_b64_tr_b16 a[32:33], v15 offset:0
  ds_read_b64_tr_b16 a[34:35], v15 offset:512
  ds_read_b64_tr_b16 a[36:37], v15 offset:8192
  ds_read_b64_tr_b16 a[38:39], v15 offset:8704
  ds_read_b64_tr_b16 a[40:41], v16 offset:0
  ds_read_b64_tr_b16 a[42:43], v16 offset:512
  ds_read_b64_tr_b16 a[44:45], v16 offset:8192
  ds_read_b64_tr_b16 a[46:47], v16 offset:8704
  s_waitcnt vmcnt(16) lgkmcnt(0)
  s_barrier
  s_add_u32 m0, s57, 16384
  s_add_u32 s54, s78, 3145728
  buffer_load_dwordx4 v8, s[24:27], s54 offen  lds
  s_add_u32 m0, s57, 20480
  s_add_u32 s54, s78, 3276800
  buffer_load_dwordx4 v8, s[24:27], s54 offen  lds
  s_add_u32 m0, s57, 24576
  s_add_u32 s54, s78, 3407872
  buffer_load_dwordx4 v8, s[24:27], s54 offen  lds
  s_add_u32 m0, s57, 28672
  s_add_u32 s54, s78, 3538944
  buffer_load_dwordx4 v8, s[24:27], s54 offen  lds
  s_getpc_b64 s[80:81]
  v_lshlrev_b32 v7, 2, v76
  global_load_dword v35, v7, s[80:81] offset:1024
  v_add_u32 v15, 98304, v11
  v_add_u32 v16, 98304, v12
  ds_read_b64_tr_b16 a[48:49], v15 offset:0
  ds_read_b64_tr_b16 a[50:51], v15 offset:512
  ds_read_b64_tr_b16 a[52:53], v15 offset:8192
  ds_read_b64_tr_b16 a[54:55], v15 offset:8704
  ds_read_b64_tr_b16 a[56:57], v16 offset:0
  ds_read_b64_tr_b16 a[58:59], v16 offset:512
  ds_read_b64_tr_b16 a[60:61], v16 offset:8192
  ds_read_b64_tr_b16 a[62:63], v16 offset:8704
  s_waitcnt vmcnt(17) lgkmcnt(0)
  s_barrier
  s_add_u32 m0, s57, 32768
  s_add_u32 s54, s78, 3670016
  buffer_load_dwordx4 v8, s[24:27], s54 offen  lds
  s_add_u32 m0, s57, 36864
  s_add_u32 s54, s78, 3801088
  buffer_load_dwordx4 v8, s[24:27], s54 offen  lds
  s_add_u32 m0, s57, 40960
  s_add_u32 s54, s78, 3932160
  buffer_load_dwordx4 v8, s[24:27], s54 offen  lds
  s_add_u32 m0, s57, 45056
  s_add_u32 s54, s78, 4063232
  buffer_load_dwordx4 v8, s[24:27], s54 offen  lds
  v_add_u32 v15, 114688, v11
  v_add_u32 v16, 114688, v12
  ds_read_b64_tr_b16 a[64:65], v15 offset:0
  ds_read_b64_tr_b16 a[66:67], v15 offset:512
  ds_read_b64_tr_b16 a[68:69], v15 offset:8192
  ds_read_b64_tr_b16 a[70:71], v15 offset:8704
  ds_read_b64_tr_b16 a[72:73], v16 offset:0
  ds_read_b64_tr_b16 a[74:75], v16 offset:512
  ds_read_b64_tr_b16 a[76:77], v16 offset:8192
  ds_read_b64_tr_b16 a[78:79], v16 offset:8704
  s_waitcnt vmcnt(17) lgkmcnt(0)
  s_barrier
  s_add_u32 m0, s57, 49152
  s_add_u32 s54, s78, 4194304
  buffer_load_dwordx4 v8, s[24:27], s54 offen  lds
  s_add_u32 m0, s57, 53248
  s_add_u32 s54, s78, 4325376
  buffer_load_dwordx4 v8, s[24:27], s54 offen  lds
  s_add_u32 m0, s57, 57344
  s_add_u32 s54, s78, 4456448
  buffer_load_dwordx4 v8, s[24:27], s54 offen  lds
  s_add_u32 m0, s57, 61440
  s_add_u32 s54, s78, 4587520
  buffer_load_dwordx4 v8, s[24:27], s54 offen  lds
  v_add_u32 v15, 131072, v11
  v_add_u32 v16, 131072, v12
  ds_read_b64_tr_b16 a[80:81], v15 offset:0
  ds_read_b64_tr_b16 a[82:83], v15 offset:512
  ds_read_b64_tr_b16 a[84:85], v15 offset:8192
  ds_read_b64_tr_b16 a[86:87], v15 offset:8704
  ds_read_b64_tr_b16 a[88:89], v16 offset:0
  ds_read_b64_tr_b16 a[90:91], v16 offset:512
  ds_read_b64_tr_b16 a[92:93], v16 offset:8192
  ds_read_b64_tr_b16 a[94:95], v16 offset:8704
  s_waitcnt vmcnt(17) lgkmcnt(0)
  s_barrier
  s_add_u32 m0, s57, 65536
  s_add_u32 s54, s79, 73728
  buffer_load_dwordx4 v10, s[28:31], s54 offen  lds
  s_add_u32 m0, s57, 69632
  s_add_u32 s54, s79, 82944
  buffer_load_dwordx4 v10, s[28:31], s54 offen  lds
  s_add_u32 m0, s57, 73728
  s_add_u32 s54, s79, 110592
  buffer_load_dwordx4 v10, s[28:31], s54 offen  lds
  s_add_u32 m0, s57, 77824
  s_add_u32 s54, s79, 119808
  buffer_load_dwordx4 v10, s[28:31], s54 offen  lds
  s_cmp_eq_u32 s52, 0
  s_cselect_b32 s54, 32, 0x1000
  v_mov_b32 v32, 1
  v_mov_b32 v7, 0
  s_mov_b64 exec, 1
  buffer_atomic_add v32, v7, s[12:15], s54 offen
  s_mov_b64 exec, -1
  v_add_u32 v15, 147456, v11
  v_add_u32 v16, 147456, v12
  ds_read_b64_tr_b16 a[96:97], v15 offset:0
  ds_read_b64_tr_b16 a[98:99], v15 offset:512
  ds_read_b64_tr_b16 a[100:101], v15 offset:8192
  ds_read_b64_tr_b16 a[102:103], v15 offset:8704
  ds_read_b64_tr_b16 a[104:105], v16 offset:0
  ds_read_b64_tr_b16 a[106:107], v16 offset:512
  ds_read_b64_tr_b16 a[108:109], v16 offset:8192
  ds_read_b64_tr_b16 a[110:111], v16 offset:8704
  s_waitcnt vmcnt(18) lgkmcnt(0)
  s_barrier
  s_add_u32 m0, s57, 81920
  s_add_u32 s54, s79, 256
  buffer_load_dwordx4 v10, s[28:31], s54 offen  lds
  s_add_u32 m0, s57, 86016
  s_add_u32 s54, s79, 9472
  buffer_load_dwordx4 v10, s[28:31], s54 offen  lds
  s_add_u32 m0, s57, 90112
  s_add_u32 s54, s79, 37120
  buffer_load_dwordx4 v10, s[28:31], s54 offen  lds
  s_add_u32 m0, s57, 94208
  s_add_u32 s54, s79, 46336
  buffer_load_dwordx4 v10, s[28:31], s54 offen  lds
  v_add_u32 v15, 16384, v11
  v_add_u32 v16, 16384, v12
  ds_read_b64_tr_b16 a[112:113], v15 offset:0
  ds_read_b64_tr_b16 a[114:115], v15 offset:512
  ds_read_b64_tr_b16 a[116:117], v15 offset:8192
  ds_read_b64_tr_b16 a[118:119], v15 offset:8704
  ds_read_b64_tr_b16 a[120:121], v16 offset:0
  ds_read_b64_tr_b16 a[122:123], v16 offset:512
  ds_read_b64_tr_b16 a[124:125], v16 offset:8192
  ds_read_b64_tr_b16 a[126:127], v16 offset:8704
  s_waitcnt vmcnt(18) lgkmcnt(0)
  s_barrier
  s_add_u32 m0, s57, 98304
  s_add_u32 s54, s79, 512
  buffer_load_dwordx4 v10, s[28:31], s54 offen  lds
  s_add_u32 m0, s57, 102400
  s_add_u32 s54, s79, 9728
  buffer_load_dwordx4 v10, s[28:31], s54 offen  lds
  s_add_u32 m0, s57, 106496
  s_add_u32 s54, s79, 37376
  buffer_load_dwordx4 v10, s[28:31], s54 offen  lds
  s_add_u32 m0, s57, 110592
  s_add_u32 s54, s79, 46592
  buffer_load_dwordx4 v10, s[28:31], s54 offen  lds
  v_add_u32 v15, 32768, v11
  v_add_u32 v16, 32768, v12
  ds_read_b64_tr_b16 a[128:129], v15 offset:0
  ds_read_b64_tr_b16 a[130:131], v15 offset:512
  ds_read_b64_tr_b16 a[132:133], v15 offset:8192
  ds_read_b64_tr_b16 a[134:135], v15 offset:8704
  ds_read_b64_tr_b16 a[136:137], v16 offset:0
  ds_read_b64_tr_b16 a[138:139], v16 offset:512
  ds_read_b64_tr_b16 a[140:141], v16 offset:8192
  ds_read_b64_tr_b16 a[142:143], v16 offset:8704
  s_waitcnt vmcnt(17) lgkmcnt(0)
  s_barrier
  s_add_u32 m0, s57, 114688
  s_add_u32 s54, s79, 768
  buffer_load_dwordx4 v10, s[28:31], s54 offen  lds
  s_add_u32 m0, s57, 118784
  s_add_u32 s54, s79, 9984
  buffer_load_dwordx4 v10, s[28:31], s54 offen  lds
  s_add_u32 m0, s57, 122880
  s_add_u32 s54, s79, 37632
  buffer_load_dwordx4 v10, s[28:31], s54 offen  lds
  s_add_u32 m0, s57, 126976
  s_add_u32 s54, s79, 46848
  buffer_load_dwordx4 v10, s[28:31], s54 offen  lds
  s_getpc_b64 s[80:81]
  v_lshlrev_b32 v7, 2, v76
  global_load_dword v35, v7, s[80:81] offset:1024
  v_add_u32 v15, 49152, v11
  v_add_u32 v16, 49152, v12
  ds_read_b64_tr_b16 a[144:145], v15 offset:0
  ds_read_b64_tr_b16 a[146:147], v15 offset:512
  ds_read_b64_tr_b16 a[148:149], v15 offset:8192
  ds_read_b64_tr_b16 a[150:151], v15 offset:8704
  ds_read_b64_tr_b16 a[152:153], v16 offset:0
  ds_read_b64_tr_b16 a[154:155], v16 offset:512
  ds_read_b64_tr_b16 a[156:157], v16 offset:8192
  ds_read_b64_tr_b16 a[158:159], v16 offset:8704
  s_waitcnt vmcnt(18) lgkmcnt(0)
  s_barrier
  s_add_u32 m0, s57, 131072
  s_add_u32 s54, s79, 74496
  buffer_load_dwordx4 v10, s[28:31], s54 offen  lds
  s_add_u32 m0, s57, 135168
  s_add_u32 s54, s79, 83712
  buffer_load_dwordx4 v10, s[28:31], s54 offen  lds
  s_add_u32 m0, s57, 139264
  s_add_u32 s54, s79, 111360
  buffer_load_dwordx4 v10, s[28:31], s54 offen  lds
  s_add_u32 m0, s57, 143360
  s_add_u32 s54, s79, 120576
  buffer_load_dwordx4 v10, s[28:31], s54 offen  lds
  v_add_u32 v15, 65536, v11
  v_add_u32 v16, 65536, v12
  ds_read_b64_tr_b16 a[160:161], v15 offset:0
  ds_read_b64_tr_b16 a[162:163], v15 offset:512
  ds_read_b64_tr_b16 a[164:165], v15 offset:8192
  ds_read_b64_tr_b16 a[166:167], v15 offset:8704
  ds_read_b64_tr_b16 a[168:169], v16 offset:0
  ds_read_b64_tr_b16 a[170:171], v16 offset:512
  ds_read_b64_tr_b16 a[172:173], v16 offset:8192
  ds_read_b64_tr_b16 a[174:175], v16 offset:8704
  s_waitcnt vmcnt(18) lgkmcnt(0)
  s_barrier
  s_add_u32 m0, s57, 0
  s_add_u32 s54, s78, 0
  buffer_load_dwordx4 v8, s[16:19], s54 offen  lds
  s_add_u32 m0, s57, 4096
  s_add_u32 s54, s78, 131072
  buffer_load_dwordx4 v8, s[16:19], s54 offen  lds
  s_add_u32 m0, s57, 8192
  s_add_u32 s54, s78, 262144
  buffer_load_dwordx4 v8, s[16:19], s54 offen  lds
  s_add_u32 m0, s57, 12288
  s_add_u32 s54, s78, 393216
  buffer_load_dwordx4 v8, s[16:19], s54 offen  lds
  v_add_u32 v15, 81920, v14
  ds_read_b64_tr_b16 a[176:177], v15 offset:0
  ds_read_b64_tr_b16 a[178:179], v15 offset:1024
  ds_read_b64_tr_b16 a[180:181], v15 offset:4096
  ds_read_b64_tr_b16 a[182:183], v15 offset:5120
  ds_read_b64_tr_b16 a[184:185], v15 offset:8192
  ds_read_b64_tr_b16 a[186:187], v15 offset:9216
  ds_read_b64_tr_b16 a[188:189], v15 offset:12288
  ds_read_b64_tr_b16 a[190:191], v15 offset:13312
  s_waitcnt vmcnt(17) lgkmcnt(0)
  s_barrier
  s_add_u32 m0, s57, 16384
  s_add_u32 s54, s78, 0
  buffer_load_dwordx4 v8, s[20:23], s54 offen  lds
  s_add_u32 m0, s57, 20480
  s_add_u32 s54, s78, 131072
  buffer_load_dwordx4 v8, s[20:23], s54 offen  lds
  s_add_u32 m0, s57, 24576
  s_add_u32 s54, s78, 262144
  buffer_load_dwordx4 v8, s[20:23], s54 offen  lds
  s_add_u32 m0, s57, 28672
  s_add_u32 s54, s78, 393216
  buffer_load_dwordx4 v8, s[20:23], s54 offen  lds
  v_add_u32 v15, 98304, v14
  ds_read_b64_tr_b16 a[192:193], v15 offset:0
  ds_read_b64_tr_b16 a[194:195], v15 offset:1024
  ds_read_b64_tr_b16 a[196:197], v15 offset:4096
  ds_read_b64_tr_b16 a[198:199], v15 offset:5120
  ds_read_b64_tr_b16 a[200:201], v15 offset:8192
  ds_read_b64_tr_b16 a[202:203], v15 offset:9216
  ds_read_b64_tr_b16 a[204:205], v15 offset:12288
  ds_read_b64_tr_b16 a[206:207], v15 offset:13312
  s_waitcnt vmcnt(17) lgkmcnt(0)
  s_barrier
  s_add_u32 m0, s57, 32768
  s_add_u32 s54, s78, 1048576
  buffer_load_dwordx4 v8, s[20:23], s54 offen  lds
  s_add_u32 m0, s57, 36864
  s_add_u32 s54, s78, 1179648
  buffer_load_dwordx4 v8, s[20:23], s54 offen  lds
  s_add_u32 m0, s57, 40960
  s_add_u32 s54, s78, 1310720
  buffer_load_dwordx4 v8, s[20:23], s54 offen  lds
  s_add_u32 m0, s57, 45056
  s_add_u32 s54, s78, 1441792
  buffer_load_dwordx4 v8, s[20:23], s54 offen  lds
  v_add_u32 v15, 114688, v14
  ds_read_b64_tr_b16 a[208:209], v15 offset:0
  ds_read_b64_tr_b16 a[210:211], v15 offset:1024
  ds_read_b64_tr_b16 a[212:213], v15 offset:4096
  ds_read_b64_tr_b16 a[214:215], v15 offset:5120
  ds_read_b64_tr_b16 a[216:217], v15 offset:8192
  ds_read_b64_tr_b16 a[218:219], v15 offset:9216
  ds_read_b64_tr_b16 a[220:221], v15 offset:12288
  ds_read_b64_tr_b16 a[222:223], v15 offset:13312
  s_waitcnt vmcnt(17) lgkmcnt(0)
  s_barrier
  s_add_u32 m0, s57, 49152
  s_add_u32 s54, s78, 2097152
  buffer_load_dwordx4 v8, s[20:23], s54 offen  lds
  s_add_u32 m0, s57, 53248
  s_add_u32 s54, s78, 2228224
  buffer_load_dwordx4 v8, s[20:23], s54 offen  lds
  s_add_u32 m0, s57, 57344
  s_add_u32 s54, s78, 2359296
  buffer_load_dwordx4 v8, s[20:23], s54 offen  lds
  s_add_u32 m0, s57, 61440
  s_add_u32 s54, s78, 2490368
  buffer_load_dwordx4 v8, s[20:23], s54 offen  lds
  v_add_u32 v15, 131072, v14
  ds_read_b64_tr_b16 a[224:225], v15 offset:0
  ds_read_b64_tr_b16 a[226:227], v15 offset:1024
  ds_read_b64_tr_b16 a[228:229], v15 offset:4096
  ds_read_b64_tr_b16 a[230:231], v15 offset:5120
  ds_read_b64_tr_b16 a[232:233], v15 offset:8192
  ds_read_b64_tr_b16 a[234:235], v15 offset:9216
  ds_read_b64_tr_b16 a[236:237], v15 offset:12288
  ds_read_b64_tr_b16 a[238:239], v15 offset:13312
  s_waitcnt vmcnt(16) lgkmcnt(0)
  s_barrier
  s_add_u32 m0, s57, 65536
  s_add_u32 s54, s78, 2621440
  buffer_load_dwordx4 v8, s[20:23], s54 offen  lds
  s_add_u32 m0, s57, 69632
  s_add_u32 s54, s78, 2752512
  buffer_load_dwordx4 v8, s[20:23], s54 offen  lds
  s_add_u32 m0, s57, 73728
  s_add_u32 s54, s78, 2883584
  buffer_load_dwordx4 v8, s[20:23], s54 offen  lds
  s_add_u32 m0, s57, 77824
  s_add_u32 s54, s78, 3014656
  buffer_load_dwordx4 v8, s[20:23], s54 offen  lds
  v_add_u32 v15, 147456, v14
  ds_read_b64_tr_b16 a[240:241], v15 offset:0
  ds_read_b64_tr_b16 a[242:243], v15 offset:1024
  ds_read_b64_tr_b16 a[244:245], v15 offset:4096
  ds_read_b64_tr_b16 a[246:247], v15 offset:5120
  ds_read_b64_tr_b16 a[248:249], v15 offset:8192
  ds_read_b64_tr_b16 a[250:251], v15 offset:9216
  ds_read_b64_tr_b16 a[252:253], v15 offset:12288
  ds_read_b64_tr_b16 a[254:255], v15 offset:13312
  s_waitcnt vmcnt(16) lgkmcnt(0)
  s_barrier
  s_add_u32 m0, s57, 81920
  s_add_u32 s54, s79, 1024
  buffer_load_dwordx4 v9, s[28:31], s54 offen  lds
  s_add_u32 m0, s57, 86016
  s_add_u32 s54, s79, 37888
  buffer_load_dwordx4 v9, s[28:31], s54 offen  lds
  s_add_u32 m0, s57, 90112
  s_add_u32 s54, s79, 74752
  buffer_load_dwordx4 v9, s[28:31], s54 offen  lds
  s_add_u32 m0, s57, 94208
  s_add_u32 s54, s79, 111616
  buffer_load_dwordx4 v9, s[28:31], s54 offen  lds
  v_add_u32 v15, 16384, v11
  v_add_u32 v16, 16384, v12
  ds_read_b64_tr_b16 v[52:53], v15 offset:0
  ds_read_b64_tr_b16 v[54:55], v15 offset:512
  ds_read_b64_tr_b16 v[56:57], v15 offset:8192
  ds_read_b64_tr_b16 v[58:59], v15 offset:8704
  ds_read_b64_tr_b16 v[60:61], v16 offset:0
  ds_read_b64_tr_b16 v[62:63], v16 offset:512
  ds_read_b64_tr_b16 v[64:65], v16 offset:8192
  ds_read_b64_tr_b16 v[66:67], v16 offset:8704
  s_waitcnt vmcnt(16) lgkmcnt(0)
  s_barrier
  s_lshl_b32 s54, s52, 12
  s_add_u32 s54, s54, 16384
  v_add_u32 v7, s54, v76
  ds_write_b128 v7, v[52:55] offset:0
  ds_write_b128 v7, v[56:59] offset:1024
  ds_write_b128 v7, v[60:63] offset:2048
  ds_write_b128 v7, v[64:67] offset:3072
  s_add_u32 m0, s57, 98304
  s_add_u32 s54, s79, 0
  buffer_load_dwordx4 v10, s[28:31], s54 offen  lds
  s_add_u32 m0, s57, 102400
  s_add_u32 s54, s79, 9216
  buffer_load_dwordx4 v10, s[28:31], s54 offen  lds
  s_add_u32 m0, s57, 106496
  s_add_u32 s54, s79, 36864
  buffer_load_dwordx4 v10, s[28:31], s54 offen  lds
  s_add_u32 m0, s57, 110592
  s_add_u32 s54, s79, 46080
  buffer_load_dwordx4 v10, s[28:31], s54 offen  lds
  v_add_u32 v15, 32768, v11
  v_add_u32 v16, 32768, v12
  ds_read_b64_tr_b16 v[36:37], v15 offset:0
  ds_read_b64_tr_b16 v[38:39], v15 offset:512
  ds_read_b64_tr_b16 v[40:41], v15 offset:8192
  ds_read_b64_tr_b16 v[42:43], v15 offset:8704
  ds_read_b64_tr_b16 v[44:45], v16 offset:0
  ds_read_b64_tr_b16 v[46:47], v16 offset:512
  ds_read_b64_tr_b16 v[48:49], v16 offset:8192
  ds_read_b64_tr_b16 v[50:51], v16 offset:8704
  s_waitcnt vmcnt(16) lgkmcnt(0)
  s_barrier
  s_lshl_b32 s54, s52, 12
  s_add_u32 s54, s54, 32768
  v_add_u32 v7, s54, v76
  ds_write_b128 v7, v[36:39] offset:0
  ds_write_b128 v7, v[40:43] offset:1024
  ds_write_b128 v7, v[44:47] offset:2048
  ds_write_b128 v7, v[48:51] offset:3072
  s_add_u32 m0, s57, 114688
  s_add_u32 s54, s79, 73984
  buffer_load_dwordx4 v10, s[28:31], s54 offen  lds
  s_add_u32 m0, s57, 118784
  s_add_u32 s54, s79, 83200
  buffer_load_dwordx4 v10, s[28:31], s54 offen  lds
  s_add_u32 m0, s57, 122880
  s_add_u32 s54, s79, 110848
  buffer_load_dwordx4 v10, s[28:31], s54 offen  lds
  s_add_u32 m0, s57, 126976
  s_add_u32 s54, s79, 120064
  buffer_load_dwordx4 v10, s[28:31], s54 offen  lds
  v_add_u32 v15, 49152, v11
  v_add_u32 v16, 49152, v12
  ds_read_b64_tr_b16 v[52:53], v15 offset:0
  ds_read_b64_tr_b16 v[54:55], v15 offset:512
  ds_read_b64_tr_b16 v[56:57], v15 offset:8192
  ds_read_b64_tr_b16 v[58:59], v15 offset:8704
  ds_read_b64_tr_b16 v[60:61], v16 offset:0
  ds_read_b64_tr_b16 v[62:63], v16 offset:512
  ds_read_b64_tr_b16 v[64:65], v16 offset:8192
  ds_read_b64_tr_b16 v[66:67], v16 offset:8704
  s_waitcnt vmcnt(16) lgkmcnt(0)
  s_barrier
  s_lshl_b32 s54, s52, 12
  s_add_u32 s54, s54, 49152
  v_add_u32 v7, s54, v76
  ds_write_b128 v7, v[52:55] offset:0
  ds_write_b128 v7, v[56:59] offset:1024
  ds_write_b128 v7, v[60:63] offset:2048
  ds_write_b128 v7, v[64:67] offset:3072
  s_add_u32 m0, s57, 131072
  s_add_u32 s54, s79, 74240
  buffer_load_dwordx4 v10, s[28:31], s54 offen  lds
  s_add_u32 m0, s57, 135168
  s_add_u32 s54, s79, 83456
  buffer_load_dwordx4 v10, s[28:31], s54 offen  lds
  s_add_u32 m0, s57, 139264
  s_add_u32 s54, s79, 111104
  buffer_load_dwordx4 v10, s[28:31], s54 offen  lds
  s_add_u32 m0, s57, 143360
  s_add_u32 s54, s79, 120320
  buffer_load_dwordx4 v10, s[28:31], s54 offen  lds
  v_lshlrev_b32 v7, 3, v76
  s_lshl_b32 s54, s52, 13
  s_add_u32 s54, s54, 360448
  s_bitcmp1_b32 s52, 0
  s_cselect_b64 exec, 0xff, -1
  buffer_load_dword v35, v7, s[8:11], s54 offen sc1
  s_mov_b64 exec, -1
  s_getpc_b64 s[80:81]
C_pc:
  s_mov_b32 s55, (L_w0 - C_pc)
  s_cmp_eq_u32 s52, 1
  s_cselect_b32 s55, (L_w1 - C_pc), s55
  s_cmp_eq_u32 s52, 2
  s_cselect_b32 s55, (L_w2 - C_pc), s55
  s_cmp_eq_u32 s52, 3
  s_cselect_b32 s55, (L_w3 - C_pc), s55
  v_lshl_add_u32 v7, v76, 3, s55
  global_load_dword v35, v7, s[80:81]
  v_add_u32 v15, 65536, v11
  v_add_u32 v16, 65536, v12
  ds_read_b64_tr_b16 v[36:37], v15 offset:0
  ds_read_b64_tr_b16 v[38:39], v15 offset:512
  ds_read_b64_tr_b16 v[40:41], v15 offset:8192
  ds_read_b64_tr_b16 v[42:43], v15 offset:8704
  ds_read_b64_tr_b16 v[44:45], v16 offset:0
  ds_read_b64_tr_b16 v[46:47], v16 offset:512
  ds_read_b64_tr_b16 v[48:49], v16 offset:8192
  ds_read_b64_tr_b16 v[50:51], v16 offset:8704
  s_waitcnt vmcnt(18) lgkmcnt(0)
  s_barrier
  s_lshl_b32 s54, s52, 12
  s_add_u32 s54, s54, 65536
  v_add_u32 v7, s54, v76
  ds_write_b128 v7, v[36:39] offset:0
  ds_write_b128 v7, v[40:43] offset:1024
  ds_write_b128 v7, v[44:47] offset:2048
  ds_write_b128 v7, v[48:51] offset:3072
  s_lshl_b32 s54, s53, 2
  s_add_u32 s54, s54, 128
  v_lshrrev_b32 v20, 2, v76
  v_writelane_b32 v20, s54, 16
  buffer_load_dword v21, v20, s[12:15], 0 offen sc1
  v_add_u32 v15, 81920, v11
  v_add_u32 v16, 81920, v12
  ds_read_b64_tr_b16 v[52:53], v15 offset:0
  ds_read_b64_tr_b16 v[54:55], v15 offset:512
  ds_read_b64_tr_b16 v[56:57], v15 offset:8192
  ds_read_b64_tr_b16 v[58:59], v15 offset:8704
  ds_read_b64_tr_b16 v[60:61], v16 offset:0
  ds_read_b64_tr_b16 v[62:63], v16 offset:512
  ds_read_b64_tr_b16 v[64:65], v16 offset:8192
  ds_read_b64_tr_b16 v[66:67], v16 offset:8704
  s_waitcnt vmcnt(15) lgkmcnt(0)
  s_barrier
  s_lshl_b32 s54, s52, 12
  s_add_u32 s54, s54, 81920
  v_add_u32 v7, s54, v76
  ds_write_b128 v7, v[52:55] offset:0
  ds_write_b128 v7, v[56:59] offset:1024
  ds_write_b128 v7, v[60:63] offset:2048
  ds_write_b128 v7, v[64:67] offset:3072
  v_add_u32 v15, 98304, v13
  s_waitcnt lgkmcnt(0)
  ds_read_b64_tr_b16 v[36:37], v15 offset:0
  ds_read_b64_tr_b16 v[38:39], v15 offset:1024
  ds_read_b64_tr_b16 v[40:41], v15 offset:2048
  ds_read_b64_tr_b16 v[42:43], v15 offset:3072
  ds_read_b64_tr_b16 v[44:45], v15 offset:4096
  ds_read_b64_tr_b16 v[46:47], v15 offset:5120
  ds_read_b64_tr_b16 v[48:49], v15 offset:6144
  ds_read_b64_tr_b16 v[50:51], v15 offset:7168
  ds_read_b64_tr_b16 v[52:53], v15 offset:8192
  ds_read_b64_tr_b16 v[54:55], v15 offset:9216
  ds_read_b64_tr_b16 v[56:57], v15 offset:10240
  ds_read_b64_tr_b16 v[58:59], v15 offset:11264
  ds_read_b64_tr_b16 v[60:61], v15 offset:12288
  ds_read_b64_tr_b16 v[62:63], v15 offset:13312
  ds_read_b64_tr_b16 v[64:65], v15 offset:14336
  ds_read_b64_tr_b16 v[66:67], v15 offset:15360
  s_waitcnt vmcnt(11) lgkmcnt(0)
  s_barrier
  s_and_b32 s54, s52, 1
  s_lshl_b32 s54, s54, 13
  s_add_u32 s54, s54, 98304
  v_add_u32 v7, s54, v76
  ds_write_b128 v7, v[36:39] offset:0
  ds_write_b128 v7, v[40:43] offset:1024
  ds_write_b128 v7, v[44:47] offset:2048
  ds_write_b128 v7, v[48:51] offset:3072
  ds_write_b128 v7, v[52:55] offset:4096
  ds_write_b128 v7, v[56:59] offset:5120
  ds_write_b128 v7, v[60:63] offset:6144
  ds_write_b128 v7, v[64:67] offset:7168
  v_add_u32 v15, 114688, v14
  ds_read_b64_tr_b16 v[52:53], v15 offset:0
  ds_read_b64_tr_b16 v[54:55], v15 offset:1024
  ds_read_b64_tr_b16 v[56:57], v15 offset:4096
  ds_read_b64_tr_b16 v[58:59], v15 offset:5120
  ds_read_b64_tr_b16 v[60:61], v15 offset:8192
  ds_read_b64_tr_b16 v[62:63], v15 offset:9216
  ds_read_b64_tr_b16 v[64:65], v15 offset:12288
  ds_read_b64_tr_b16 v[66:67], v15 offset:13312
  s_waitcnt vmcnt(7) lgkmcnt(0)
  s_barrier
  s_lshl_b32 s54, s52, 12
  s_add_u32 s54, s54, 114688
  v_add_u32 v7, s54, v76
  ds_write_b128 v7, v[52:55] offset:0
  ds_write_b128 v7, v[56:59] offset:1024
  ds_write_b128 v7, v[60:63] offset:2048
  ds_write_b128 v7, v[64:67] offset:3072
  v_add_u32 v15, 131072, v14
  ds_read_b64_tr_b16 v[36:37], v15 offset:0
  ds_read_b64_tr_b16 v[38:39], v15 offset:1024
  ds_read_b64_tr_b16 v[40:41], v15 offset:4096
  ds_read_b64_tr_b16 v[42:43], v15 offset:5120
  ds_read_b64_tr_b16 v[44:45], v15 offset:8192
  ds_read_b64_tr_b16 v[46:47], v15 offset:9216
  ds_read_b64_tr_b16 v[48:49], v15 offset:12288
  ds_read_b64_tr_b16 v[50:51], v15 offset:13312
  s_waitcnt vmcnt(3) lgkmcnt(0)
  s_barrier
  s_lshl_b32 s54, s52, 12
  s_add_u32 s54, s54, 131072
  v_add_u32 v7, s54, v76
  ds_write_b128 v7, v[36:39] offset:0
  ds_write_b128 v7, v[40:43] offset:1024
  ds_write_b128 v7, v[44:47] offset:2048
  ds_write_b128 v7, v[48:51] offset:3072
  v_add_u32 v15, 147456, v14
  ds_read_b64_tr_b16 v[52:53], v15 offset:0
  ds_read_b64_tr_b16 v[54:55], v15 offset:1024
  ds_read_b64_tr_b16 v[56:57], v15 offset:4096
  ds_read_b64_tr_b16 v[58:59], v15 offset:5120
  ds_read_b64_tr_b16 v[60:61], v15 offset:8192
  ds_read_b64_tr_b16 v[62:63], v15 offset:9216
  ds_read_b64_tr_b16 v[64:65], v15 offset:12288
  ds_read_b64_tr_b16 v[66:67], v15 offset:13312
  s_waitcnt vmcnt(0) lgkmcnt(0)
  s_barrier
  s_lshl_b32 s54, s52, 12
  s_add_u32 s54, s54, 147456
  v_add_u32 v7, s54, v76
  ds_write_b128 v7, v[52:55] offset:0
  ds_write_b128 v7, v[56:59] offset:1024
  ds_write_b128 v7, v[60:63] offset:2048
  ds_write_b128 v7, v[64:67] offset:3072
  s_waitcnt lgkmcnt(0)
  s_branch C_rd1
C_rd0:
  s_sleep 2
  buffer_load_dword v21, v20, s[12:15], 0 offen sc1
  s_waitcnt vmcnt(0)
C_rd1:
  s_mov_b32 s3, 1
  s_add_u32 s67, s67, 1
  s_cmp_ge_u32 s67, 131072
  s_cbranch_scc1 C_rd2
  v_readlane_b32 s54, v21, 8
  v_readlane_b32 s55, v21, 16
  v_readlane_b32 s56, v21, 0
  s_cmp_lt_u32 s54, 32
  s_cbranch_scc1 C_rd0
  s_and_b32 s55, s55, 0xff
  s_cmp_lt_u32 s55, 7
  s_cbranch_scc1 C_rd0
  s_cmp_eq_u32 s56, -1
  s_cselect_b32 s3, 0, 1
C_rd2:
  s_lshl_b32 s54, s3, 2
  s_add_u32 s54, s54, s52
  s_cmp_eq_u32 s54, 1
  s_cbranch_scc1 L_w1
  s_cmp_eq_u32 s54, 2
  s_cbranch_scc1 L_w2
  s_cmp_eq_u32 s54, 3
  s_cbranch_scc1 L_w3
  s_cmp_eq_u32 s54, 4
  s_cbranch_scc1 L_w4
  s_cmp_eq_u32 s54, 5
  s_cbranch_scc1 L_w5
  s_cmp_eq_u32 s54, 6
  s_cbranch_scc1 L_w6
  s_cmp_eq_u32 s54, 7
  s_cbranch_scc1 L_w7
L_w0:
  v_mov_b64 v[20:21], 0
  v_mov_b64 v[22:23], 0
  v_mov_b64 v[24:25], 0
  v_mov_b64 v[26:27], 0
  v_mov_b64 v[28:29], 0
  v_mov_b64 v[30:31], 0
  v_mov_b64 v[32:33], 0
  v_mov_b64 v[34:35], 0
  s_mov_b32 s78, 0x3f803f80
  s_mov_b32 s79, s78
  s_mov_b32 s65, 360448
  s_mov_b32 m0, 15872
  v_lshlrev_b32 v73, 2, v76
  v_mov_b32 v72, 0
  ds_read_b128 v[60:63], v76 offset:16384
  ds_read_b128 v[64:67], v76 offset:17408
  ds_read_b128 v[44:47], v76 offset:18432
  ds_read_b128 v[48:51], v76 offset:19456
  ds_read_b128 v[36:39], v76 offset:32768
  ds_read_b128 v[40:43], v76 offset:33792
  ds_read_b128 v[0:3], v76 offset:4608
  ds_read_b128 v[4:7], v76 offset:5632
  s_branch Cf0_top2
.p2align 6
Cf0_h2:
  v_lshlrev_b32 v73, 2, v76
  s_nop 15
  s_nop 11
  buffer_load_dwordx4 v[52:55], v76, s[8:11], s65 offen offset:0 sc1
  buffer_load_dwordx4 v[56:59], v76, s[8:11], s65 offen offset:1024 sc1
  s_nop 15
  s_nop 1
  buffer_load_dwordx4 v[52:55], v76, s[8:11], s65 offen offset:0 sc1
  buffer_load_dwordx4 v[56:59], v76, s[8:11], s65 offen offset:1024 sc1
  s_nop 15
  s_nop 1
  buffer_load_dwordx4 v[52:55], v76, s[8:11], s65 offen offset:0 sc1
  buffer_load_dwordx4 v[56:59], v76, s[8:11], s65 offen offset:1024 sc1
  s_waitcnt vmcnt(8)
  ds_read_b128 v[60:63], v76 offset:16384
  ds_read_b128 v[64:67], v76 offset:17408
  ds_read_b128 v[44:47], v76 offset:18432
  ds_read_b128 v[48:51], v76 offset:19456
  ds_read_b128 v[36:39], v76 offset:32768
  ds_read_b128 v[40:43], v76 offset:33792
  s_waitcnt vmcnt(4)
  v_max3_u32 v72, v52, v53, v54
  v_max3_u32 v72, v72, v55, v56
  v_max3_u32 v72, v72, v57, v58
  v_max_u32 v72, v72, v59
  ds_write_b128 v76, v[52:55] offset:4608
  ds_write_b128 v76, v[56:59] offset:5632
  v_cmp_eq_u32 vcc, -1, v72
  s_cbranch_vccnz Cf0_h2r
Cf0_h2w:
  s_waitcnt lgkmcnt(0)
  s_barrier
  ds_read_b128 v[0:3], v76 offset:4608
  ds_read_b128 v[4:7], v76 offset:5632
Cf0_top2:
  ds_read_b128 v[8:11], v76 offset:6656
  s_waitcnt lgkmcnt(2)
  v_smfmac_f32_16x16x64_bf16 v[20:23], v[0:3], v[60:67], v74
  ds_read_b128 v[60:63], v76 offset:34816
  v_smfmac_f32_16x16x64_bf16 v[24:27], v[0:3], v[44:51], v74
  ds_read_b128 v[64:67], v76 offset:35840
  s_waitcnt lgkmcnt(3)
  v_smfmac_f32_16x16x64_bf16 v[20:23], v[4:7], v[80:87], v74
  buffer_load_dwordx4 v[44:47], v76, s[8:11], s58 offen offset:0 sc1
  v_smfmac_f32_16x16x64_bf16 v[28:31], v[0:3], v[36:43], v74
  ds_read_b128 v[36:39], v76 offset:49152
  v_smfmac_f32_16x16x64_bf16 v[24:27], v[4:7], v[88:95], v74
  buffer_load_dwordx4 v[48:51], v76, s[8:11], s58 offen offset:1024 sc1
  ds_read_b128 v[40:43], v76 offset:50176
  v_smfmac_f32_16x16x64_bf16 v[28:31], v[4:7], v[208:215], v74
  ds_read_b128 v[12:15], v76 offset:7680
  s_waitcnt lgkmcnt(5)
  v_smfmac_f32_16x16x64_bf16 v[32:35], v[4:7], v[216:223], v74
  buffer_load_dwordx4 v[52:55], v76, s[8:11], s59 offen offset:0 sc1
  s_waitcnt lgkmcnt(3)
  v_smfmac_f32_16x16x64_bf16 v[32:35], v[0:3], v[60:67], v74
  buffer_load_dwordx4 v[56:59], v76, s[8:11], s59 offen offset:1024 sc1
  v_smfmac_f32_16x16x64_bf16 v[20:23], v[8:11], v[96:103], v74
  buffer_store_dwordx4 v[16:19], v76, s[8:11], s68 offen sc1
  ds_read_b128 v[60:63], v76 offset:51200
  v_smfmac_f32_16x16x64_bf16 v[24:27], v[8:11], v[104:111], v74
  ds_read_b128 v[64:67], v76 offset:52224
  s_waitcnt lgkmcnt(3)
  v_smfmac_f32_16x16x64_bf16 v[28:31], v[8:11], v[36:43], v74
  ds_read_b128 v[36:39], v75 offset:0
  s_waitcnt lgkmcnt(3)
  v_smfmac_f32_16x16x64_bf16 v[20:23], v[12:15], v[112:119], v74
  ds_read_b128 v[40:43], v75 offset:1024
  v_smfmac_f32_16x16x64_bf16 v[24:27], v[12:15], v[120:127], v74
  s_barrier
  ds_read_b128 v[0:3], v76 offset:8704
  v_smfmac_f32_16x16x64_bf16 v[28:31], v[12:15], v[224:231], v74
  ds_read_b128 v[4:7], v76 offset:9728
  v_smfmac_f32_16x16x64_bf16 v[32:35], v[12:15], v[232:239], v74
  buffer_load_dword v73, s[8:11], s70 offen lds
  s_waitcnt lgkmcnt(4)
  v_smfmac_f32_16x16x64_bf16 v[32:35], v[8:11], v[60:67], v74
  ds_read_b128 v[60:63], v75 offset:2048
  s_waitcnt lgkmcnt(2)
  v_smfmac_f32_16x16x64_bf16 v[20:23], v[0:3], v[128:135], v74
  ds_read_b128 v[16:19], v76 offset:10752
  v_smfmac_f32_16x16x64_bf16 v[24:27], v[0:3], v[136:143], v74
  ds_read_b128 v[64:67], v75 offset:3072
  v_smfmac_f32_16x16x64_bf16 v[28:31], v[0:3], v[36:43], v74
  ds_read_b128 v[36:39], v75 offset:16384
  s_waitcnt lgkmcnt(4)
  v_smfmac_f32_16x16x64_bf16 v[20:23], v[4:7], v[144:151], v74
  ds_read_b128 v[12:15], v76 offset:11776
  v_smfmac_f32_16x16x64_bf16 v[24:27], v[4:7], v[152:159], v74
  ds_read_b128 v[40:43], v75 offset:17408
  s_waitcnt lgkmcnt(4)
  v_smfmac_f32_16x16x64_bf16 v[20:23], v[16:19], v[160:167], v74
  ds_read_b128 v[8:11], v76 offset:12800
  s_waitcnt lgkmcnt(4)
  v_smfmac_f32_16x16x64_bf16 v[32:35], v[0:3], v[60:67], v74
  ds_read_b128 v[60:63], v75 offset:18432
  v_mov_b64 v[68:69], s[78:79]
  v_smfmac_f32_16x16x64_bf16 v[24:27], v[16:19], v[168:175], v74
  ds_read_b128 v[64:67], v75 offset:19456
  s_waitcnt lgkmcnt(4)
  v_mov_b64 v[70:71], s[78:79]
  v_smfmac_f32_16x16x64_bf16 v[20:23], v[12:15], v[176:183], v74
  s_waitcnt lgkmcnt(3)
  v_smfmac_f32_16x16x64_bf16 v[28:31], v[4:7], v[36:43], v74
  s_waitcnt lgkmcnt(2)
  v_mov_b64 v[36:37], 0
  v_smfmac_f32_16x16x64_bf16 v[20:23], v[8:11], v[192:199], v74
  v_mov_b64 v[38:39], 0
  v_smfmac_f32_16x16x64_bf16 v[24:27], v[12:15], v[184:191], v74
  v_mov_b64 v[40:41], 0
  v_smfmac_f32_16x16x64_bf16 v[24:27], v[8:11], v[200:207], v74
  s_waitcnt lgkmcnt(0)
  v_add_f32 v20, v20, v22
  v_smfmac_f32_16x16x64_bf16 v[32:35], v[4:7], v[60:67], v74
  v_add_f32 v21, v21, v23
  v_smfmac_f32_16x16x64_bf16 v[28:31], v[16:19], v[240:247], v74
  v_add_f32 v24, v24, v26
  v_cvt_pk_bf16_f32 v22, v20, v24
  v_smfmac_f32_16x16x64_bf16 v[28:31], v[12:15], a[0:7], v74
  ds_write_b32 v79, v22 offset:0
  v_add_f32 v25, v25, v27
  v_cvt_pk_bf16_f32 v23, v21, v25
  v_smfmac_f32_16x16x64_bf16 v[28:31], v[8:11], a[16:23], v74
  ds_write_b32 v79, v23 offset:576
  v_cmp_u_f32 vcc, v20, v21
  v_smfmac_f32_16x16x64_bf16 v[32:35], v[16:19], v[248:255], v74
  v_mov_b64 v[42:43], 0
  v_smfmac_f32_16x16x64_bf16 v[32:35], v[12:15], a[8:15], v74
  v_add_f32 v28, v28, v30
  v_add_f32 v29, v29, v31
  v_smfmac_f32_16x16x64_bf16 v[32:35], v[8:11], a[24:31], v74
  s_cbranch_vccnz Cf0_rec
Cf0_recok:
  v_smfmac_f32_16x16x64_bf16 v[36:39], v[16:19], a[128:135], v74
  s_waitcnt lgkmcnt(0)
  s_barrier
  ds_read_b128 v[60:63], v77
  v_smfmac_f32_16x16x64_bf16 v[40:43], v[16:19], a[136:143], v74
  ds_read_b128 v[64:67], v77 offset:128
  v_add_f32 v32, v32, v34
  v_cvt_pk_bf16_f32 v30, v28, v32
  v_smfmac_f32_16x16x64_bf16 v[36:39], v[0:3], a[96:103], v74
  ds_write_b32 v79, v30 offset:256
  v_add_f32 v33, v33, v35
  v_cvt_pk_bf16_f32 v31, v29, v33
  v_smfmac_f32_16x16x64_bf16 v[40:43], v[0:3], a[104:111], v74
  ds_write_b32 v79, v31 offset:832
  v_xor_b32 v75, 0x8000, v75
  v_smfmac_f32_16x16x64_bf16 v[36:39], v[4:7], a[112:119], v74
  ds_read_b128 v[0:3], v76 offset:4608
  v_mov_b32 v29, 0
  v_smfmac_f32_16x16x64_bf16 v[40:43], v[4:7], a[120:127], v74
  s_waitcnt vmcnt(4) lgkmcnt(3)
  v_mov_b32 v30, 0
  v_mfma_f32_16x16x32_bf16 v[44:47], v[44:47], v[60:63], 0
  ds_read_b128 v[4:7], v76 offset:5632
  s_waitcnt lgkmcnt(2)
  v_mfma_f32_16x16x32_bf16 v[44:47], v[48:51], v[64:67], v[44:47]
  s_barrier
  v_smfmac_f32_16x16x64_bf16 v[36:39], v[8:11], a[160:167], v74
  ds_read_b128 v[20:23], v77 offset:256
  ds_read_b128 v[24:27], v77 offset:384
  v_smfmac_f32_16x16x64_bf16 v[40:43], v[8:11], a[168:175], v74
  ds_read_b128 v[8:11], v76 offset:6656
  v_add_f32_dpp v72, v46, v44 quad_perm:[2,3,0,1] row_mask:0xf bank_mask:0xf
  v_add_f32_dpp v73, v47, v45 quad_perm:[2,3,0,1] row_mask:0xf bank_mask:0xf
  v_smfmac_f32_16x16x64_bf16 v[36:39], v[12:15], a[144:151], v74
  s_waitcnt lgkmcnt(4)
  v_exp_f32_dpp v72, v72 quad_perm:[0,1,0,1] row_mask:0xf bank_mask:0xf
  v_smfmac_f32_16x16x64_bf16 v[40:43], v[12:15], a[152:159], v74
  ds_read_b128 v[12:15], v76 offset:7680
  v_exp_f32_dpp v73, v73 quad_perm:[0,1,0,1] row_mask:0xf bank_mask:0xf
  v_smfmac_f32_16x16x64_bf16 v[36:39], v[0:3], a[32:39], v74
  s_waitcnt lgkmcnt(2)
  v_cvt_pk_bf16_f32 v72, v72, v73
  v_mfma_f32_16x16x32_bf16 v[20:23], v[20:23], v[60:63], 0
  ds_write_b32 v78, v72 offset:512
  v_mov_b64 v[16:17], 0
  v_mfma_f32_16x16x32_bf16 v[20:23], v[24:27], v[64:67], v[20:23]
  ds_read_b128 v[44:47], v75 offset:16384
  v_mov_b64 v[18:19], 0
  v_smfmac_f32_16x16x64_bf16 v[40:43], v[0:3], a[40:47], v74
  ds_read_b128 v[48:51], v75 offset:17408
  s_waitcnt lgkmcnt(4)
  v_smfmac_f32_16x16x64_bf16 v[36:39], v[4:7], a[48:55], v74
  v_add_f32_dpp v24, v22, v20 quad_perm:[2,3,0,1] row_mask:0xf bank_mask:0xf
  v_add_f32_dpp v25, v23, v21 quad_perm:[2,3,0,1] row_mask:0xf bank_mask:0xf
  v_smfmac_f32_16x16x64_bf16 v[36:39], v[8:11], a[64:71], v74
  s_waitcnt lgkmcnt(2)
  s_barrier
  ds_read_b128 v[32:35], v78 offset:512
  v_smfmac_f32_16x16x64_bf16 v[36:39], v[12:15], a[80:87], v74
  ds_read_b128 v[60:63], v75 offset:18432
  v_mul_f32 v24, s69, v24
  v_smfmac_f32_16x16x64_bf16 v[40:43], v[4:7], a[56:63], v74
  ds_read_b128 v[64:67], v75 offset:19456
  v_mul_f32 v25, s69, v25
  v_smfmac_f32_16x16x64_bf16 v[40:43], v[8:11], a[72:79], v74
  v_exp_f32_dpp v24, v24 quad_perm:[0,1,0,1] row_mask:0xf bank_mask:0xf
  v_smfmac_f32_16x16x64_bf16 v[40:43], v[12:15], a[88:95], v74
  s_waitcnt vmcnt(2) lgkmcnt(2)
  v_exp_f32_dpp v25, v25 quad_perm:[0,1,0,1] row_mask:0xf bank_mask:0xf
  v_mfma_f32_16x16x32_bf16 v[8:11], v[32:35], v[68:71], 0
  v_add_f32 v36, v36, v38
  v_add_f32 v37, v37, v39
  v_mfma_f32_16x16x32_bf16 v[0:3], v[32:35], v[52:55], 0
  v_add_f32 v40, v40, v42
  v_add_f32 v41, v41, v43
  v_mfma_f32_16x16x32_bf16 v[4:7], v[32:35], v[56:59], 0
  v_cvt_pk_bf16_f32 v28, v24, v25
  v_cvt_pk_bf16_f32 v72, v36, v37
  v_cvt_pk_bf16_f32 v73, v40, v41
  v_mfma_f32_16x16x16_bf16 v[8:11], v[28:29], v[68:69], v[8:11]
  v_cvt_pk_bf16_f32 v31, v24, v25
  v_mov_b64 v[20:21], 0
  v_mfma_f32_16x16x16_bf16 v[0:3], v[28:29], v[72:73], v[0:3]
  ds_read_b128 v[68:71], v76 offset:13824
  v_mov_b64 v[22:23], 0
  v_mfma_f32_16x16x16_bf16 v[4:7], v[30:31], v[72:73], v[4:7]
  v_rcp_f32 v10, v8
  v_rcp_f32 v11, v9
  v_mul_f32 v0, v10, v0
  v_mul_f32 v1, v11, v1
  s_nop 0
  v_mul_f32 v4, v10, v4
  v_mul_f32 v5, v11, v5
  v_cvt_pk_bf16_f32 v2, v0, v4
  ds_write_b32 v79, v2 offset:8704
  v_cvt_pk_bf16_f32 v3, v1, v5
  ds_write_b32 v79, v3 offset:9280
  v_max3_f32 v8, v8, v9, v10
  v_max_f32 v8, v8, v11
  v_cmp_le_f32 vcc, 1317011456, v8
  v_mov_b64 v[24:25], 0
  v_mov_b64 v[26:27], 0
  s_cbranch_vccnz Cf0_mx
Cf0_mxok:
  s_waitcnt lgkmcnt(0)
  s_barrier
  ds_read_b128 v[0:3], v78 offset:8704
  ds_read_b128 v[4:7], v78 offset:8768
  ds_read_b128 v[8:11], v78 offset:8832
  ds_read_b128 v[12:15], v78 offset:8896
  s_cmp_eq_u32 s66, 63
  s_cbranch_scc1 Cf0_last
  s_waitcnt lgkmcnt(3)
  v_smfmac_f32_16x16x64_bf16 v[16:19], v[0:3], v[44:51], v74
  ds_read_b128 v[52:55], v75 offset:32768
  s_waitcnt lgkmcnt(3)
  v_smfmac_f32_16x16x64_bf16 v[16:19], v[4:7], v[60:67], v74
  ds_read_b128 v[56:59], v75 offset:33792
  s_waitcnt lgkmcnt(3)
  v_smfmac_f32_16x16x64_bf16 v[16:19], v[8:11], a[176:183], v74
  ds_read_b128 v[36:39], v75 offset:34816
  s_waitcnt lgkmcnt(3)
  v_smfmac_f32_16x16x64_bf16 v[16:19], v[12:15], a[184:191], v74
  ds_read_b128 v[40:43], v75 offset:35840
  ds_read_b128 v[44:47], v75 offset:49152
  v_smfmac_f32_16x16x64_bf16 v[20:23], v[0:3], a[192:199], v74
  ds_read_b128 v[48:51], v75 offset:50176
  ds_read_b128 v[60:63], v75 offset:51200
  v_smfmac_f32_16x16x64_bf16 v[20:23], v[4:7], a[200:207], v74
  ds_read_b128 v[64:67], v75 offset:52224
  s_waitcnt lgkmcnt(6)
  v_cvt_pk_bf16_f32 v16, v16, v17
  v_cvt_pk_bf16_f32 v17, v18, v19
  v_bfi_b32 v16, 1, s72, v16
  v_smfmac_f32_16x16x64_bf16 v[20:23], v[8:11], v[52:59], v74
  buffer_store_dwordx2 v[16:17], v68, s[8:11], s73 offen
  s_waitcnt lgkmcnt(4)
  v_smfmac_f32_16x16x64_bf16 v[20:23], v[12:15], v[36:43], v74
  v_mov_b64 v[32:33], 0
  v_smfmac_f32_16x16x64_bf16 v[24:27], v[0:3], a[208:215], v74
  v_mov_b64 v[34:35], 0
  v_smfmac_f32_16x16x64_bf16 v[24:27], v[4:7], a[216:223], v74
  s_waitcnt lgkmcnt(2)
  v_cvt_pk_bf16_f32 v20, v20, v21
  v_cvt_pk_bf16_f32 v21, v22, v23
  v_bfi_b32 v20, 1, s72, v20
  v_smfmac_f32_16x16x64_bf16 v[24:27], v[8:11], v[44:51], v74
  buffer_store_dwordx2 v[20:21], v68, s[8:11], s74 offen
  s_waitcnt lgkmcnt(0)
  v_smfmac_f32_16x16x64_bf16 v[24:27], v[12:15], v[60:67], v74
  v_smfmac_f32_16x16x64_bf16 v[32:35], v[0:3], a[224:231], v74
  v_smfmac_f32_16x16x64_bf16 v[32:35], v[4:7], a[232:239], v74
  v_cvt_pk_bf16_f32 v24, v24, v25
  v_cvt_pk_bf16_f32 v25, v26, v27
  v_bfi_b32 v24, 1, s72, v24
  v_smfmac_f32_16x16x64_bf16 v[32:35], v[8:11], a[240:247], v74
  s_nop 1
  buffer_store_dwordx2 v[24:25], v68, s[8:11], s75 offen
  v_smfmac_f32_16x16x64_bf16 v[32:35], v[12:15], a[248:255], v74
  ds_read_b128 v[0:3], v76 offset:14848
  ds_read_b64 v[16:17], v77 offset:256
  v_mov_b64 v[18:19], v[72:73]
  v_xor_b32 v75, 0x8000, v75
  s_nop 3
  v_cvt_pk_bf16_f32 v32, v32, v33
  v_cvt_pk_bf16_f32 v33, v34, v35
  v_bfi_b32 v32, 1, s72, v32
  buffer_store_dwordx2 v[32:33], v68, s[8:11], s76 offen
  v_mov_b64 v[20:21], 0
  v_mov_b64 v[22:23], 0
  v_mov_b64 v[24:25], 0
  v_mov_b64 v[26:27], 0
  v_mov_b64 v[28:29], 0
  v_mov_b64 v[30:31], 0
  v_mov_b64 v[32:33], 0
  v_mov_b64 v[34:35], 0
  s_add_u32 s58, s58, 655360
  s_add_u32 s59, s59, 655360
  s_add_u32 s70, s70, 655360
  s_add_u32 s68, s68, 655360
  s_add_u32 s66, s66, 1
  s_xor_b32 s64, s64, 16384
  s_xor_b32 s65, s65, 16384
  s_nop 15
  s_nop 3
  buffer_load_dwordx4 v[52:55], v76, s[8:11], s60 offen offset:0 sc1
  buffer_load_dwordx4 v[56:59], v76, s[8:11], s60 offen offset:1024 sc1
  s_nop 15
  s_nop 11
  buffer_load_dwordx4 v[36:39], v76, s[8:11], s60 offen offset:0 sc1
  buffer_load_dwordx4 v[40:43], v76, s[8:11], s60 offen offset:1024 sc1
  s_waitcnt lgkmcnt(0)
  s_waitcnt vmcnt(3)
  v_mfma_f32_16x16x32_bf16 v[4:7], v[0:3], v[52:55], 0
  v_bitop3_b32 v72, v52, v54, s72 bitop3:0x7e
  s_waitcnt vmcnt(2)
  v_mfma_f32_16x16x32_bf16 v[4:7], v[0:3], v[56:59], v[4:7]
  v_bitop3_b32 v73, v56, v58, s72 bitop3:0x7e
  v_bitop3_b32 v72, v72, v73, 1 bitop3:0xa8
  v_cmp_ne_u32 vcc, 0, v72
  s_nop 0
  s_cmp_eq_u64 vcc, 0
  s_cselect_b32 s54, s62, 268435456
  s_nop 0
  v_add_f32_dpp v4, v4, v4 row_ror:4 row_mask:0xf bank_mask:0xf
  v_add_f32_dpp v5, v5, v5 row_ror:4 row_mask:0xf bank_mask:0xf
  s_nop 0
  v_add_f32_dpp v4, v4, v4 row_ror:8 row_mask:0xf bank_mask:0xf
  v_add_f32_dpp v5, v5, v5 row_ror:8 row_mask:0xf bank_mask:0xf
  v_cvt_pk_bf16_f32 v4, v4, v5
  buffer_store_dword v4, v69, s[8:11], s54 offen
  s_cbranch_vccnz Cf0_h1r
  s_xor_b32 s62, s62, 16384
  buffer_store_dword v71, v69, s[8:11], s62 offen
  s_xor_b32 s72, s72, 1
  s_branch Cf0_h2
Cf0_h1r:
  s_mov_b64 exec, vcc
  buffer_load_dwordx4 v[52:55], v76, s[8:11], s60 offen offset:0 sc1
  buffer_load_dwordx4 v[56:59], v76, s[8:11], s60 offen offset:1024 sc1
  s_mov_b64 exec, -1
  s_add_u32 s67, s67, 1
  s_waitcnt vmcnt(4)
  v_mfma_f32_16x16x32_bf16 v[4:7], v[0:3], v[36:39], 0
  v_bitop3_b32 v72, v36, v38, s72 bitop3:0x7e
  s_waitcnt vmcnt(3)
  v_mfma_f32_16x16x32_bf16 v[4:7], v[0:3], v[40:43], v[4:7]
  v_bitop3_b32 v73, v40, v42, s72 bitop3:0x7e
  v_bitop3_b32 v72, v72, v73, 1 bitop3:0xa8
  v_cmp_ne_u32 vcc, 0, v72
  s_cbranch_vccz Cf0_h1p
  s_mov_b64 exec, vcc
  buffer_load_dwordx4 v[36:39], v76, s[8:11], s60 offen offset:0 sc1
  buffer_load_dwordx4 v[40:43], v76, s[8:11], s60 offen offset:1024 sc1
  s_mov_b64 exec, -1
  s_add_u32 s67, s67, 1
  s_waitcnt vmcnt(3)
  v_mfma_f32_16x16x32_bf16 v[4:7], v[0:3], v[52:55], 0
  v_bitop3_b32 v72, v52, v54, s72 bitop3:0x7e
  s_waitcnt vmcnt(2)
  v_mfma_f32_16x16x32_bf16 v[4:7], v[0:3], v[56:59], v[4:7]
  v_bitop3_b32 v73, v56, v58, s72 bitop3:0x7e
  v_bitop3_b32 v72, v72, v73, 1 bitop3:0xa8
  v_cmp_ne_u32 vcc, 0, v72
  s_cbranch_vccz Cf0_h1p
Cf0_h1s:
  s_mov_b64 exec, vcc
  buffer_load_dwordx4 v[52:55], v76, s[8:11], s60 offen offset:0 sc1
  buffer_load_dwordx4 v[56:59], v76, s[8:11], s60 offen offset:1024 sc1
  s_mov_b64 exec, -1
  s_add_u32 s67, s67, 1
  s_waitcnt vmcnt(3)
  v_mfma_f32_16x16x32_bf16 v[4:7], v[0:3], v[36:39], 0
  v_bitop3_b32 v72, v36, v38, s72 bitop3:0x7e
  s_waitcnt vmcnt(2)
  v_mfma_f32_16x16x32_bf16 v[4:7], v[0:3], v[40:43], v[4:7]
  v_bitop3_b32 v73, v40, v42, s72 bitop3:0x7e
  v_bitop3_b32 v72, v72, v73, 1 bitop3:0xa8
  v_cmp_ne_u32 vcc, 0, v72
  s_cbranch_vccz Cf0_h1p
  s_mov_b64 exec, vcc
  buffer_load_dwordx4 v[36:39], v76, s[8:11], s60 offen offset:0 sc1
  buffer_load_dwordx4 v[40:43], v76, s[8:11], s60 offen offset:1024 sc1
  s_mov_b64 exec, -1
  s_add_u32 s67, s67, 1
  s_waitcnt vmcnt(3)
  v_mfma_f32_16x16x32_bf16 v[4:7], v[0:3], v[52:55], 0
  v_bitop3_b32 v72, v52, v54, s72 bitop3:0x7e
  s_waitcnt vmcnt(2)
  v_mfma_f32_16x16x32_bf16 v[4:7], v[0:3], v[56:59], v[4:7]
  v_bitop3_b32 v73, v56, v58, s72 bitop3:0x7e
  v_bitop3_b32 v72, v72, v73, 1 bitop3:0xa8
  v_cmp_ne_u32 vcc, 0, v72
  s_cbranch_vccz Cf0_h1p
  s_cmp_lt_u32 s67, 131072
  s_cbranch_scc1 Cf0_h1s
Cf0_h1p:
  s_nop 2
  v_add_f32_dpp v4, v4, v4 row_ror:4 row_mask:0xf bank_mask:0xf
  v_add_f32_dpp v5, v5, v5 row_ror:4 row_mask:0xf bank_mask:0xf
  s_nop 0
  v_add_f32_dpp v4, v4, v4 row_ror:8 row_mask:0xf bank_mask:0xf
  v_add_f32_dpp v5, v5, v5 row_ror:8 row_mask:0xf bank_mask:0xf
  v_cvt_pk_bf16_f32 v4, v4, v5
  buffer_store_dword v4, v69, s[8:11], s62 offen
  s_xor_b32 s62, s62, 16384
  buffer_store_dword v71, v69, s[8:11], s62 offen
  s_xor_b32 s72, s72, 1
  s_branch Cf0_h2
Cf0_h2r:
  s_mov_b64 exec, vcc
  buffer_load_dwordx4 v[52:55], v76, s[8:11], s65 offen offset:0 sc1
  buffer_load_dwordx4 v[56:59], v76, s[8:11], s65 offen offset:1024 sc1
  s_mov_b64 exec, -1
  s_add_u32 s67, s67, 1
  s_waitcnt vmcnt(4)
  v_max3_u32 v72, v52, v53, v54
  v_max3_u32 v72, v72, v55, v56
  v_max3_u32 v72, v72, v57, v58
  v_max_u32 v72, v72, v59
  ds_write_b128 v76, v[52:55] offset:4608
  ds_write_b128 v76, v[56:59] offset:5632
  v_cmp_eq_u32 vcc, -1, v72
  s_cbranch_vccz Cf0_h2w
  s_mov_b64 exec, vcc
  buffer_load_dwordx4 v[52:55], v76, s[8:11], s65 offen offset:0 sc1
  buffer_load_dwordx4 v[56:59], v76, s[8:11], s65 offen offset:1024 sc1
  s_mov_b64 exec, -1
  s_add_u32 s67, s67, 1
  s_waitcnt vmcnt(4)
  v_max3_u32 v72, v52, v53, v54
  v_max3_u32 v72, v72, v55, v56
  v_max3_u32 v72, v72, v57, v58
  v_max_u32 v72, v72, v59
  ds_write_b128 v76, v[52:55] offset:4608
  ds_write_b128 v76, v[56:59] offset:5632
  v_cmp_eq_u32 vcc, -1, v72
  s_cbranch_vccz Cf0_h2w
  s_mov_b64 exec, vcc
  buffer_load_dwordx4 v[52:55], v76, s[8:11], s65 offen offset:0 sc1
  buffer_load_dwordx4 v[56:59], v76, s[8:11], s65 offen offset:1024 sc1
  s_mov_b64 exec, -1
  s_add_u32 s67, s67, 1
  s_waitcnt vmcnt(4)
  v_max3_u32 v72, v52, v53, v54
  v_max3_u32 v72, v72, v55, v56
  v_max3_u32 v72, v72, v57, v58
  v_max_u32 v72, v72, v59
  ds_write_b128 v76, v[52:55] offset:4608
  ds_write_b128 v76, v[56:59] offset:5632
  v_cmp_eq_u32 vcc, -1, v72
  s_cbranch_vccz Cf0_h2w
  s_mov_b64 exec, vcc
  buffer_load_dwordx4 v[52:55], v76, s[8:11], s65 offen offset:0 sc1
  buffer_load_dwordx4 v[56:59], v76, s[8:11], s65 offen offset:1024 sc1
  s_mov_b64 exec, -1
  s_add_u32 s67, s67, 1
  s_waitcnt vmcnt(4)
  v_max3_u32 v72, v52, v53, v54
  v_max3_u32 v72, v72, v55, v56
  v_max3_u32 v72, v72, v57, v58
  v_max_u32 v72, v72, v59
  ds_write_b128 v76, v[52:55] offset:4608
  ds_write_b128 v76, v[56:59] offset:5632
  v_cmp_eq_u32 vcc, -1, v72
  s_cbranch_vccz Cf0_h2w
  s_cmp_lt_u32 s67, 131072
  s_cbranch_scc1 Cf0_h2r
Cf0_h2ok:
  ds_write_b128 v76, v[52:55] offset:4608
  ds_write_b128 v76, v[56:59] offset:5632
  s_branch Cf0_h2w
Cf0_rec:
  s_nop 7
  s_waitcnt vmcnt(0) lgkmcnt(0)
  v_max3_u32 v72, v0, v1, v2
  v_max3_u32 v72, v72, v3, v4
  v_max3_u32 v72, v72, v5, v6
  v_max3_u32 v72, v72, v7, v8
  v_max3_u32 v72, v72, v9, v10
  v_max3_u32 v72, v72, v11, v12
  v_max3_u32 v72, v72, v13, v14
  v_max3_u32 v72, v72, v15, v16
  v_max3_u32 v72, v72, v17, v18
  v_max_u32 v72, v72, v19
  v_cmp_eq_u32 vcc, -1, v72
  s_cbranch_vccz Cf0_recok
  s_barrier
  v_mov_b64 v[20:21], 0
  v_mov_b64 v[22:23], 0
  v_mov_b64 v[24:25], 0
  v_mov_b64 v[26:27], 0
  v_mov_b64 v[28:29], 0
  v_mov_b64 v[30:31], 0
  v_mov_b64 v[32:33], 0
  v_mov_b64 v[34:35], 0
  s_waitcnt lgkmcnt(0)
  s_barrier
  ds_read_b128 v[0:3], v76 offset:4608
  ds_read_b128 v[60:63], v76 offset:16384
  ds_read_b128 v[64:67], v76 offset:17408
  s_waitcnt lgkmcnt(0)
  v_smfmac_f32_16x16x64_bf16 v[20:23], v[0:3], v[60:67], v74
  ds_read_b128 v[60:63], v76 offset:18432
  ds_read_b128 v[64:67], v76 offset:19456
  s_waitcnt lgkmcnt(0)
  v_smfmac_f32_16x16x64_bf16 v[24:27], v[0:3], v[60:67], v74
  ds_read_b128 v[60:63], v76 offset:32768
  ds_read_b128 v[64:67], v76 offset:33792
  s_waitcnt lgkmcnt(0)
  v_smfmac_f32_16x16x64_bf16 v[28:31], v[0:3], v[60:67], v74
  ds_read_b128 v[60:63], v76 offset:34816
  ds_read_b128 v[64:67], v76 offset:35840
  s_waitcnt lgkmcnt(0)
  v_smfmac_f32_16x16x64_bf16 v[32:35], v[0:3], v[60:67], v74
  ds_read_b128 v[4:7], v76 offset:5632
  s_waitcnt lgkmcnt(0)
  v_smfmac_f32_16x16x64_bf16 v[20:23], v[4:7], v[80:87], v74
  v_smfmac_f32_16x16x64_bf16 v[24:27], v[4:7], v[88:95], v74
  v_smfmac_f32_16x16x64_bf16 v[28:31], v[4:7], v[208:215], v74
  v_smfmac_f32_16x16x64_bf16 v[32:35], v[4:7], v[216:223], v74
  ds_read_b128 v[8:11], v76 offset:6656
  s_waitcnt lgkmcnt(0)
  v_smfmac_f32_16x16x64_bf16 v[20:23], v[8:11], v[96:103], v74
  v_smfmac_f32_16x16x64_bf16 v[24:27], v[8:11], v[104:111], v74
  ds_read_b128 v[60:63], v76 offset:49152
  ds_read_b128 v[64:67], v76 offset:50176
  s_waitcnt lgkmcnt(0)
  v_smfmac_f32_16x16x64_bf16 v[28:31], v[8:11], v[60:67], v74
  ds_read_b128 v[60:63], v76 offset:51200
  ds_read_b128 v[64:67], v76 offset:52224
  s_waitcnt lgkmcnt(0)
  v_smfmac_f32_16x16x64_bf16 v[32:35], v[8:11], v[60:67], v74
  ds_read_b128 v[12:15], v76 offset:7680
  s_waitcnt lgkmcnt(0)
  v_smfmac_f32_16x16x64_bf16 v[20:23], v[12:15], v[112:119], v74
  v_smfmac_f32_16x16x64_bf16 v[24:27], v[12:15], v[120:127], v74
  v_smfmac_f32_16x16x64_bf16 v[28:31], v[12:15], v[224:231], v74
  v_smfmac_f32_16x16x64_bf16 v[32:35], v[12:15], v[232:239], v74
  ds_read_b128 v[0:3], v76 offset:8704
  s_waitcnt lgkmcnt(0)
  v_smfmac_f32_16x16x64_bf16 v[20:23], v[0:3], v[128:135], v74
  v_smfmac_f32_16x16x64_bf16 v[24:27], v[0:3], v[136:143], v74
  ds_read_b128 v[60:63], v75 offset:0
  ds_read_b128 v[64:67], v75 offset:1024
  s_waitcnt lgkmcnt(0)
  v_smfmac_f32_16x16x64_bf16 v[28:31], v[0:3], v[60:67], v74
  ds_read_b128 v[60:63], v75 offset:2048
  ds_read_b128 v[64:67], v75 offset:3072
  s_waitcnt lgkmcnt(0)
  v_smfmac_f32_16x16x64_bf16 v[32:35], v[0:3], v[60:67], v74
  ds_read_b128 v[4:7], v76 offset:9728
  s_waitcnt lgkmcnt(0)
  v_smfmac_f32_16x16x64_bf16 v[20:23], v[4:7], v[144:151], v74
  v_smfmac_f32_16x16x64_bf16 v[24:27], v[4:7], v[152:159], v74
  ds_read_b128 v[60:63], v75 offset:16384
  ds_read_b128 v[64:67], v75 offset:17408
  s_waitcnt lgkmcnt(0)
  v_smfmac_f32_16x16x64_bf16 v[28:31], v[4:7], v[60:67], v74
  ds_read_b128 v[60:63], v75 offset:18432
  ds_read_b128 v[64:67], v75 offset:19456
  s_waitcnt lgkmcnt(0)
  v_smfmac_f32_16x16x64_bf16 v[32:35], v[4:7], v[60:67], v74
  ds_read_b128 v[16:19], v76 offset:10752
  s_waitcnt lgkmcnt(0)
  v_smfmac_f32_16x16x64_bf16 v[20:23], v[16:19], v[160:167], v74
  v_smfmac_f32_16x16x64_bf16 v[24:27], v[16:19], v[168:175], v74
  v_smfmac_f32_16x16x64_bf16 v[28:31], v[16:19], v[240:247], v74
  v_smfmac_f32_16x16x64_bf16 v[32:35], v[16:19], v[248:255], v74
  ds_read_b128 v[12:15], v76 offset:11776
  s_waitcnt lgkmcnt(0)
  v_smfmac_f32_16x16x64_bf16 v[20:23], v[12:15], v[176:183], v74
  v_smfmac_f32_16x16x64_bf16 v[24:27], v[12:15], v[184:191], v74
  v_smfmac_f32_16x16x64_bf16 v[28:31], v[12:15], a[0:7], v74
  v_smfmac_f32_16x16x64_bf16 v[32:35], v[12:15], a[8:15], v74
  ds_read_b128 v[8:11], v76 offset:12800
  s_waitcnt lgkmcnt(0)
  v_smfmac_f32_16x16x64_bf16 v[20:23], v[8:11], v[192:199], v74
  v_smfmac_f32_16x16x64_bf16 v[24:27], v[8:11], v[200:207], v74
  v_smfmac_f32_16x16x64_bf16 v[28:31], v[8:11], a[16:23], v74
  v_smfmac_f32_16x16x64_bf16 v[32:35], v[8:11], a[24:31], v74
  v_add_f32 v20, v20, v22
  v_add_f32 v21, v21, v23
  v_add_f32 v24, v24, v26
  v_cvt_pk_bf16_f32 v22, v20, v24
  s_nop 0
  ds_write_b32 v79, v22 offset:0
  v_add_f32 v25, v25, v27
  v_cvt_pk_bf16_f32 v23, v21, v25
  ds_write_b32 v79, v23 offset:576
  v_add_f32 v28, v28, v30
  v_add_f32 v29, v29, v31
  s_waitcnt lgkmcnt(0)
  s_nop 1
  s_branch Cf0_recok
Cf0_mx:
  s_waitcnt lgkmcnt(0)
  s_barrier
  buffer_load_dwordx4 v[0:3], v76, s[8:11], s58 offen offset:0 sc1
  ds_read_b128 v[20:23], v77 offset:0
  ds_read_b128 v[28:31], v77 offset:256
  buffer_load_dwordx4 v[4:7], v76, s[8:11], s58 offen offset:1024 sc1
  ds_read_b128 v[24:27], v77 offset:128
  ds_read_b128 v[32:35], v77 offset:384
  s_waitcnt vmcnt(1) lgkmcnt(3)
  v_mfma_f32_16x16x32_bf16 v[8:11], v[0:3], v[20:23], 0
  s_waitcnt vmcnt(0) lgkmcnt(1)
  v_mfma_f32_16x16x32_bf16 v[8:11], v[4:7], v[24:27], v[8:11]
  v_mfma_f32_16x16x32_bf16 v[12:15], v[28:31], v[20:23], 0
  s_waitcnt lgkmcnt(0)
  v_mfma_f32_16x16x32_bf16 v[12:15], v[32:35], v[24:27], v[12:15]
  v_add_f32_dpp v8, v10, v8 quad_perm:[2,3,0,1] row_mask:0xf bank_mask:0xf
  v_add_f32_dpp v9, v11, v9 quad_perm:[2,3,0,1] row_mask:0xf bank_mask:0xf
  s_nop 0
  v_mov_b32_dpp v8, v8 quad_perm:[0,1,0,1] row_mask:0xf bank_mask:0xf
  v_mov_b32_dpp v9, v9 quad_perm:[0,1,0,1] row_mask:0xf bank_mask:0xf
  s_nop 1
  v_add_f32_dpp v12, v14, v12 quad_perm:[2,3,0,1] row_mask:0xf bank_mask:0xf
  v_add_f32_dpp v13, v15, v13 quad_perm:[2,3,0,1] row_mask:0xf bank_mask:0xf
  s_nop 0
  v_mov_b32_dpp v12, v12 quad_perm:[0,1,0,1] row_mask:0xf bank_mask:0xf
  v_mov_b32_dpp v13, v13 quad_perm:[0,1,0,1] row_mask:0xf bank_mask:0xf
  v_mul_f32 v12, s69, v12
  ds_write_b32 v78, v8 offset:8704
  v_mul_f32 v13, s69, v13
  ds_write_b32 v78, v9 offset:8768
  s_waitcnt lgkmcnt(0)
  s_barrier
  ds_read_b128 v[36:39], v78 offset:8704
  ds_read_b128 v[40:43], v78 offset:8768
  s_waitcnt lgkmcnt(0)
  s_barrier
  v_max_f32 v16, v36, v37
  v_max3_f32 v16, v16, v38, v39
  v_max3_f32 v16, v16, v40, v41
  v_max3_f32 v16, v16, v42, v43
  v_max3_f32 v16, v16, v12, v13
  v_mov_b32 v17, v16
  s_nop 1
  v_permlane16_swap_b32 v16, v17
  v_max_f32 v16, v16, v17
  v_mov_b32 v17, v16
  s_nop 1
  v_permlane32_swap_b32 v16, v17
  v_max_f32 v16, v16, v17
  v_sub_f32 v36, v36, v16
  v_sub_f32 v37, v37, v16
  v_sub_f32 v38, v38, v16
  v_sub_f32 v39, v39, v16
  v_sub_f32 v40, v40, v16
  v_sub_f32 v41, v41, v16
  v_sub_f32 v42, v42, v16
  v_sub_f32 v43, v43, v16
  v_sub_f32 v12, v12, v16
  v_sub_f32 v13, v13, v16
  v_exp_f32 v36, v36
  v_exp_f32 v37, v37
  v_exp_f32 v38, v38
  v_exp_f32 v39, v39
  v_exp_f32 v40, v40
  v_exp_f32 v41, v41
  v_exp_f32 v42, v42
  v_exp_f32 v43, v43
  v_exp_f32 v12, v12
  v_exp_f32 v13, v13
  v_cvt_pk_bf16_f32 v32, v36, v40
  v_cvt_pk_bf16_f32 v33, v37, v41
  v_cvt_pk_bf16_f32 v34, v38, v42
  v_cvt_pk_bf16_f32 v35, v39, v43
  v_cvt_pk_bf16_f32 v28, v12, v13
  v_cvt_pk_bf16_f32 v31, v12, v13
  v_mov_b32 v29, 0
  v_mov_b32 v30, 0
  v_mov_b32 v68, 0x3f803f80
  v_mov_b32 v69, 0x3f803f80
  v_mov_b32 v70, 0x3f803f80
  v_mov_b32 v71, 0x3f803f80
  s_nop 1
  v_mfma_f32_16x16x32_bf16 v[8:11], v[32:35], v[68:71], 0
  v_mfma_f32_16x16x32_bf16 v[0:3], v[32:35], v[52:55], 0
  v_mfma_f32_16x16x32_bf16 v[4:7], v[32:35], v[56:59], 0
  v_mfma_f32_16x16x16_bf16 v[8:11], v[28:29], v[68:69], v[8:11]
  v_mfma_f32_16x16x16_bf16 v[0:3], v[28:29], v[72:73], v[0:3]
  v_mfma_f32_16x16x16_bf16 v[4:7], v[30:31], v[72:73], v[4:7]
  ds_read_b128 v[68:71], v76 offset:13824
  v_rcp_f32 v10, v8
  v_rcp_f32 v11, v9
  v_mul_f32 v0, v10, v0
  v_mul_f32 v1, v11, v1
  s_nop 0
  v_mul_f32 v4, v10, v4
  v_mul_f32 v5, v11, v5
  v_cvt_pk_bf16_f32 v2, v0, v4
  ds_write_b32 v79, v2 offset:8704
  v_cvt_pk_bf16_f32 v3, v1, v5
  ds_write_b32 v79, v3 offset:9280
  v_mov_b64 v[16:17], 0
  v_mov_b64 v[18:19], 0
  v_mov_b64 v[20:21], 0
  v_mov_b64 v[22:23], 0
  v_mov_b64 v[24:25], 0
  v_mov_b64 v[26:27], 0
  s_branch Cf0_mxok
Cf0_last:
  s_waitcnt vmcnt(0) lgkmcnt(0)
  ds_read_b64 v[16:17], v77 offset:256
  v_mov_b64 v[18:19], v[72:73]
  s_add_u32 s68, s68, 655360
  s_waitcnt lgkmcnt(0)
  buffer_store_dwordx4 v[16:19], v76, s[8:11], s68 offen sc1
  s_waitcnt vmcnt(0)
  s_barrier
  s_branch L_cexit
L_w1:
  v_mov_b64 v[20:21], 0
  v_mov_b64 v[22:23], 0
  v_mov_b64 v[24:25], 0
  v_mov_b64 v[26:27], 0
  v_mov_b64 v[28:29], 0
  v_mov_b64 v[30:31], 0
  v_mov_b64 v[32:33], 0
  v_mov_b64 v[34:35], 0
  s_mov_b32 s78, 0x3f803f80
  s_mov_b32 s79, s78
  s_mov_b32 s65, 360448
  s_mov_b32 m0, 15872
  v_lshlrev_b32 v73, 2, v76
  v_mov_b32 v72, 0
  ds_read_b128 v[60:63], v76 offset:20480
  ds_read_b128 v[64:67], v76 offset:21504
  ds_read_b128 v[44:47], v76 offset:22528
  ds_read_b128 v[48:51], v76 offset:23552
  ds_read_b128 v[36:39], v76 offset:36864
  ds_read_b128 v[40:43], v76 offset:37888
  ds_read_b128 v[0:3], v76 offset:4608
  ds_read_b128 v[4:7], v76 offset:5632
  s_branch Cf1_top2
.p2align 6
Cf1_h2:
  v_lshlrev_b32 v73, 2, v76
  s_nop 15
  s_nop 3
  buffer_load_dwordx4 v[52:55], v76, s[8:11], s65 offen offset:2048 sc1
  s_nop 15
  s_nop 1
  buffer_load_dwordx4 v[52:55], v76, s[8:11], s65 offen offset:2048 sc1
  s_nop 15
  s_nop 1
  buffer_load_dwordx4 v[52:55], v76, s[8:11], s65 offen offset:2048 sc1
  s_waitcnt vmcnt(5)
  ds_read_b128 v[60:63], v76 offset:20480
  ds_read_b128 v[64:67], v76 offset:21504
  ds_read_b128 v[44:47], v76 offset:22528
  ds_read_b128 v[48:51], v76 offset:23552
  ds_read_b128 v[36:39], v76 offset:36864
  ds_read_b128 v[40:43], v76 offset:37888
  s_waitcnt vmcnt(2)
  v_max3_u32 v72, v52, v53, v54
  v_max_u32 v72, v72, v55
  ds_write_b128 v76, v[52:55] offset:6656
  v_cmp_eq_u32 vcc, -1, v72
  s_cbranch_vccnz Cf1_h2r
Cf1_h2w:
  s_waitcnt lgkmcnt(0)
  s_barrier
  ds_read_b128 v[0:3], v76 offset:4608
  ds_read_b128 v[4:7], v76 offset:5632
Cf1_top2:
  ds_read_b128 v[8:11], v76 offset:6656
  s_waitcnt lgkmcnt(2)
  v_smfmac_f32_16x16x64_bf16 v[20:23], v[0:3], v[60:67], v74
  ds_read_b128 v[60:63], v76 offset:38912
  v_smfmac_f32_16x16x64_bf16 v[24:27], v[0:3], v[44:51], v74
  ds_read_b128 v[64:67], v76 offset:39936
  s_waitcnt lgkmcnt(3)
  v_smfmac_f32_16x16x64_bf16 v[20:23], v[4:7], v[80:87], v74
  buffer_load_dwordx4 v[44:47], v76, s[8:11], s58 offen offset:0 sc1
  v_smfmac_f32_16x16x64_bf16 v[28:31], v[0:3], v[36:43], v74
  ds_read_b128 v[36:39], v76 offset:53248
  v_smfmac_f32_16x16x64_bf16 v[24:27], v[4:7], v[88:95], v74
  buffer_load_dwordx4 v[48:51], v76, s[8:11], s58 offen offset:1024 sc1
  ds_read_b128 v[40:43], v76 offset:54272
  v_smfmac_f32_16x16x64_bf16 v[28:31], v[4:7], v[208:215], v74
  ds_read_b128 v[12:15], v76 offset:7680
  s_waitcnt lgkmcnt(5)
  v_smfmac_f32_16x16x64_bf16 v[32:35], v[4:7], v[216:223], v74
  buffer_load_dwordx4 v[52:55], v76, s[8:11], s59 offen offset:0 sc1
  s_waitcnt lgkmcnt(3)
  v_smfmac_f32_16x16x64_bf16 v[32:35], v[0:3], v[60:67], v74
  buffer_load_dwordx4 v[56:59], v76, s[8:11], s59 offen offset:1024 sc1
  v_smfmac_f32_16x16x64_bf16 v[20:23], v[8:11], v[96:103], v74
  ds_read_b128 v[60:63], v76 offset:55296
  v_smfmac_f32_16x16x64_bf16 v[24:27], v[8:11], v[104:111], v74
  ds_read_b128 v[64:67], v76 offset:56320
  s_waitcnt lgkmcnt(3)
  v_smfmac_f32_16x16x64_bf16 v[28:31], v[8:11], v[36:43], v74
  buffer_store_dwordx4 v[16:19], v76, s[8:11], s68 offen sc1
  ds_read_b128 v[36:39], v75 offset:4096
  s_waitcnt lgkmcnt(3)
  v_smfmac_f32_16x16x64_bf16 v[20:23], v[12:15], v[112:119], v74
  ds_read_b128 v[40:43], v75 offset:5120
  v_smfmac_f32_16x16x64_bf16 v[24:27], v[12:15], v[120:127], v74
  s_barrier
  ds_read_b128 v[0:3], v76 offset:8704
  v_smfmac_f32_16x16x64_bf16 v[28:31], v[12:15], v[224:231], v74
  ds_read_b128 v[4:7], v76 offset:9728
  v_smfmac_f32_16x16x64_bf16 v[32:35], v[12:15], v[232:239], v74
  buffer_load_dword v73, s[8:11], s70 offen lds
  s_waitcnt lgkmcnt(4)
  v_smfmac_f32_16x16x64_bf16 v[32:35], v[8:11], v[60:67], v74
  ds_read_b128 v[60:63], v75 offset:6144
  s_waitcnt lgkmcnt(2)
  v_smfmac_f32_16x16x64_bf16 v[20:23], v[0:3], v[128:135], v74
  ds_read_b128 v[16:19], v76 offset:10752
  v_smfmac_f32_16x16x64_bf16 v[24:27], v[0:3], v[136:143], v74
  ds_read_b128 v[64:67], v75 offset:7168
  v_smfmac_f32_16x16x64_bf16 v[28:31], v[0:3], v[36:43], v74
  ds_read_b128 v[36:39], v75 offset:20480
  s_waitcnt lgkmcnt(4)
  v_smfmac_f32_16x16x64_bf16 v[20:23], v[4:7], v[144:151], v74
  ds_read_b128 v[12:15], v76 offset:11776
  v_smfmac_f32_16x16x64_bf16 v[24:27], v[4:7], v[152:159], v74
  ds_read_b128 v[40:43], v75 offset:21504
  s_waitcnt lgkmcnt(4)
  v_smfmac_f32_16x16x64_bf16 v[20:23], v[16:19], v[160:167], v74
  ds_read_b128 v[8:11], v76 offset:12800
  s_waitcnt lgkmcnt(4)
  v_smfmac_f32_16x16x64_bf16 v[32:35], v[0:3], v[60:67], v74
  ds_read_b128 v[60:63], v75 offset:22528
  v_mov_b64 v[68:69], s[78:79]
  v_smfmac_f32_16x16x64_bf16 v[24:27], v[16:19], v[168:175], v74
  ds_read_b128 v[64:67], v75 offset:23552
  s_waitcnt lgkmcnt(4)
  v_mov_b64 v[70:71], s[78:79]
  v_smfmac_f32_16x16x64_bf16 v[20:23], v[12:15], v[176:183], v74
  s_waitcnt lgkmcnt(3)
  v_smfmac_f32_16x16x64_bf16 v[28:31], v[4:7], v[36:43], v74
  s_waitcnt lgkmcnt(2)
  v_mov_b64 v[36:37], 0
  v_smfmac_f32_16x16x64_bf16 v[20:23], v[8:11], v[192:199], v74
  v_mov_b64 v[38:39], 0
  v_smfmac_f32_16x16x64_bf16 v[24:27], v[12:15], v[184:191], v74
  v_mov_b64 v[40:41], 0
  v_smfmac_f32_16x16x64_bf16 v[24:27], v[8:11], v[200:207], v74
  s_waitcnt lgkmcnt(0)
  v_add_f32 v20, v20, v22
  v_smfmac_f32_16x16x64_bf16 v[32:35], v[4:7], v[60:67], v74
  v_add_f32 v21, v21, v23
  v_smfmac_f32_16x16x64_bf16 v[28:31], v[16:19], v[240:247], v74
  v_add_f32 v24, v24, v26
  v_cvt_pk_bf16_f32 v22, v20, v24
  v_smfmac_f32_16x16x64_bf16 v[28:31], v[12:15], a[0:7], v74
  ds_write_b32 v79, v22 offset:0
  v_add_f32 v25, v25, v27
  v_cvt_pk_bf16_f32 v23, v21, v25
  v_smfmac_f32_16x16x64_bf16 v[28:31], v[8:11], a[16:23], v74
  ds_write_b32 v79, v23 offset:576
  v_cmp_u_f32 vcc, v20, v21
  v_smfmac_f32_16x16x64_bf16 v[32:35], v[16:19], v[248:255], v74
  v_mov_b64 v[42:43], 0
  v_smfmac_f32_16x16x64_bf16 v[32:35], v[12:15], a[8:15], v74
  v_add_f32 v28, v28, v30
  v_add_f32 v29, v29, v31
  v_smfmac_f32_16x16x64_bf16 v[32:35], v[8:11], a[24:31], v74
  s_cbranch_vccnz Cf1_rec
Cf1_recok:
  v_smfmac_f32_16x16x64_bf16 v[36:39], v[16:19], a[128:135], v74
  s_waitcnt lgkmcnt(0)
  s_barrier
  ds_read_b128 v[60:63], v77
  v_smfmac_f32_16x16x64_bf16 v[40:43], v[16:19], a[136:143], v74
  ds_read_b128 v[64:67], v77 offset:128
  v_add_f32 v32, v32, v34
  v_cvt_pk_bf16_f32 v30, v28, v32
  v_smfmac_f32_16x16x64_bf16 v[36:39], v[0:3], a[96:103], v74
  ds_write_b32 v79, v30 offset:256
  v_add_f32 v33, v33, v35
  v_cvt_pk_bf16_f32 v31, v29, v33
  v_smfmac_f32_16x16x64_bf16 v[40:43], v[0:3], a[104:111], v74
  ds_write_b32 v79, v31 offset:832
  v_xor_b32 v75, 0x8000, v75
  v_smfmac_f32_16x16x64_bf16 v[36:39], v[4:7], a[112:119], v74
  ds_read_b128 v[0:3], v76 offset:4608
  v_mov_b32 v29, 0
  v_smfmac_f32_16x16x64_bf16 v[40:43], v[4:7], a[120:127], v74
  s_waitcnt vmcnt(4) lgkmcnt(3)
  v_mov_b32 v30, 0
  v_mfma_f32_16x16x32_bf16 v[44:47], v[44:47], v[60:63], 0
  ds_read_b128 v[4:7], v76 offset:5632
  s_waitcnt lgkmcnt(2)
  v_mfma_f32_16x16x32_bf16 v[44:47], v[48:51], v[64:67], v[44:47]
  s_barrier
  v_smfmac_f32_16x16x64_bf16 v[36:39], v[8:11], a[160:167], v74
  ds_read_b128 v[20:23], v77 offset:256
  ds_read_b128 v[24:27], v77 offset:384
  v_smfmac_f32_16x16x64_bf16 v[40:43], v[8:11], a[168:175], v74
  ds_read_b128 v[8:11], v76 offset:6656
  v_add_f32_dpp v72, v46, v44 quad_perm:[2,3,0,1] row_mask:0xf bank_mask:0xf
  v_add_f32_dpp v73, v47, v45 quad_perm:[2,3,0,1] row_mask:0xf bank_mask:0xf
  v_smfmac_f32_16x16x64_bf16 v[36:39], v[12:15], a[144:151], v74
  s_waitcnt lgkmcnt(4)
  v_exp_f32_dpp v72, v72 quad_perm:[0,1,0,1] row_mask:0xf bank_mask:0xf
  v_smfmac_f32_16x16x64_bf16 v[40:43], v[12:15], a[152:159], v74
  ds_read_b128 v[12:15], v76 offset:7680
  v_exp_f32_dpp v73, v73 quad_perm:[0,1,0,1] row_mask:0xf bank_mask:0xf
  v_smfmac_f32_16x16x64_bf16 v[36:39], v[0:3], a[32:39], v74
  s_waitcnt lgkmcnt(2)
  v_cvt_pk_bf16_f32 v72, v72, v73
  v_mfma_f32_16x16x32_bf16 v[20:23], v[20:23], v[60:63], 0
  ds_write_b32 v78, v72 offset:516
  v_mov_b64 v[16:17], 0
  v_mfma_f32_16x16x32_bf16 v[20:23], v[24:27], v[64:67], v[20:23]
  ds_read_b128 v[44:47], v75 offset:20480
  v_mov_b64 v[18:19], 0
  v_smfmac_f32_16x16x64_bf16 v[40:43], v[0:3], a[40:47], v74
  ds_read_b128 v[48:51], v75 offset:21504
  s_waitcnt lgkmcnt(4)
  v_smfmac_f32_16x16x64_bf16 v[36:39], v[4:7], a[48:55], v74
  v_add_f32_dpp v24, v22, v20 quad_perm:[2,3,0,1] row_mask:0xf bank_mask:0xf
  v_add_f32_dpp v25, v23, v21 quad_perm:[2,3,0,1] row_mask:0xf bank_mask:0xf
  v_smfmac_f32_16x16x64_bf16 v[36:39], v[8:11], a[64:71], v74
  s_waitcnt lgkmcnt(2)
  s_barrier
  ds_read_b128 v[32:35], v78 offset:512
  v_smfmac_f32_16x16x64_bf16 v[36:39], v[12:15], a[80:87], v74
  ds_read_b128 v[60:63], v75 offset:22528
  v_mul_f32 v24, s69, v24
  v_smfmac_f32_16x16x64_bf16 v[40:43], v[4:7], a[56:63], v74
  ds_read_b128 v[64:67], v75 offset:23552
  v_mul_f32 v25, s69, v25
  v_smfmac_f32_16x16x64_bf16 v[40:43], v[8:11], a[72:79], v74
  v_exp_f32_dpp v24, v24 quad_perm:[0,1,0,1] row_mask:0xf bank_mask:0xf
  v_smfmac_f32_16x16x64_bf16 v[40:43], v[12:15], a[88:95], v74
  s_waitcnt vmcnt(2) lgkmcnt(2)
  v_exp_f32_dpp v25, v25 quad_perm:[0,1,0,1] row_mask:0xf bank_mask:0xf
  v_mfma_f32_16x16x32_bf16 v[8:11], v[32:35], v[68:71], 0
  v_add_f32 v36, v36, v38
  v_add_f32 v37, v37, v39
  v_mfma_f32_16x16x32_bf16 v[0:3], v[32:35], v[52:55], 0
  v_add_f32 v40, v40, v42
  v_add_f32 v41, v41, v43
  v_mfma_f32_16x16x32_bf16 v[4:7], v[32:35], v[56:59], 0
  v_cvt_pk_bf16_f32 v28, v24, v25
  v_cvt_pk_bf16_f32 v72, v36, v37
  v_cvt_pk_bf16_f32 v73, v40, v41
  v_mfma_f32_16x16x16_bf16 v[8:11], v[28:29], v[68:69], v[8:11]
  v_cvt_pk_bf16_f32 v31, v24, v25
  v_mov_b64 v[20:21], 0
  v_mfma_f32_16x16x16_bf16 v[0:3], v[28:29], v[72:73], v[0:3]
  ds_read_b128 v[68:71], v76 offset:13824
  v_mov_b64 v[22:23], 0
  v_mfma_f32_16x16x16_bf16 v[4:7], v[30:31], v[72:73], v[4:7]
  v_rcp_f32 v10, v8
  v_rcp_f32 v11, v9
  v_mul_f32 v0, v10, v0
  v_mul_f32 v1, v11, v1
  s_nop 0
  v_mul_f32 v4, v10, v4
  v_mul_f32 v5, v11, v5
  v_cvt_pk_bf16_f32 v2, v0, v4
  ds_write_b32 v79, v2 offset:8704
  v_cvt_pk_bf16_f32 v3, v1, v5
  ds_write_b32 v79, v3 offset:9280
  v_max3_f32 v8, v8, v9, v10
  v_max_f32 v8, v8, v11
  v_cmp_le_f32 vcc, 1317011456, v8
  v_mov_b64 v[24:25], 0
  v_mov_b64 v[26:27], 0
  s_cbranch_vccnz Cf1_mx
Cf1_mxok:
  s_waitcnt lgkmcnt(0)
  s_barrier
  ds_read_b128 v[0:3], v78 offset:8704
  ds_read_b128 v[4:7], v78 offset:8768
  ds_read_b128 v[8:11], v78 offset:8832
  ds_read_b128 v[12:15], v78 offset:8896
  s_cmp_eq_u32 s66, 63
  s_cbranch_scc1 Cf1_last
  s_waitcnt lgkmcnt(3)
  v_smfmac_f32_16x16x64_bf16 v[16:19], v[0:3], v[44:51], v74
  ds_read_b128 v[52:55], v75 offset:36864
  s_waitcnt lgkmcnt(3)
  v_smfmac_f32_16x16x64_bf16 v[16:19], v[4:7], v[60:67], v74
  ds_read_b128 v[56:59], v75 offset:37888
  s_waitcnt lgkmcnt(3)
  v_smfmac_f32_16x16x64_bf16 v[16:19], v[8:11], a[176:183], v74
  ds_read_b128 v[36:39], v75 offset:38912
  s_waitcnt lgkmcnt(3)
  v_smfmac_f32_16x16x64_bf16 v[16:19], v[12:15], a[184:191], v74
  ds_read_b128 v[40:43], v75 offset:39936
  ds_read_b128 v[44:47], v75 offset:53248
  v_smfmac_f32_16x16x64_bf16 v[20:23], v[0:3], a[192:199], v74
  ds_read_b128 v[48:51], v75 offset:54272
  ds_read_b128 v[60:63], v75 offset:55296
  v_smfmac_f32_16x16x64_bf16 v[20:23], v[4:7], a[200:207], v74
  ds_read_b128 v[64:67], v75 offset:56320
  s_waitcnt lgkmcnt(6)
  v_cvt_pk_bf16_f32 v16, v16, v17
  v_cvt_pk_bf16_f32 v17, v18, v19
  v_bfi_b32 v16, 1, s72, v16
  v_smfmac_f32_16x16x64_bf16 v[20:23], v[8:11], v[52:59], v74
  buffer_store_dwordx2 v[16:17], v68, s[8:11], s73 offen
  s_waitcnt lgkmcnt(4)
  v_smfmac_f32_16x16x64_bf16 v[20:23], v[12:15], v[36:43], v74
  v_mov_b64 v[32:33], 0
  v_smfmac_f32_16x16x64_bf16 v[24:27], v[0:3], a[208:215], v74
  v_mov_b64 v[34:35], 0
  v_smfmac_f32_16x16x64_bf16 v[24:27], v[4:7], a[216:223], v74
  s_waitcnt lgkmcnt(2)
  v_cvt_pk_bf16_f32 v20, v20, v21
  v_cvt_pk_bf16_f32 v21, v22, v23
  v_bfi_b32 v20, 1, s72, v20
  v_smfmac_f32_16x16x64_bf16 v[24:27], v[8:11], v[44:51], v74
  buffer_store_dwordx2 v[20:21], v68, s[8:11], s74 offen
  s_waitcnt lgkmcnt(0)
  v_smfmac_f32_16x16x64_bf16 v[24:27], v[12:15], v[60:67], v74
  v_smfmac_f32_16x16x64_bf16 v[32:35], v[0:3], a[224:231], v74
  v_smfmac_f32_16x16x64_bf16 v[32:35], v[4:7], a[232:239], v74
  v_cvt_pk_bf16_f32 v24, v24, v25
  v_cvt_pk_bf16_f32 v25, v26, v27
  v_bfi_b32 v24, 1, s72, v24
  v_smfmac_f32_16x16x64_bf16 v[32:35], v[8:11], a[240:247], v74
  s_nop 1
  buffer_store_dwordx2 v[24:25], v68, s[8:11], s75 offen
  v_smfmac_f32_16x16x64_bf16 v[32:35], v[12:15], a[248:255], v74
  ds_read_b128 v[0:3], v76 offset:14848
  ds_read_b64 v[16:17], v77 offset:264
  v_mov_b64 v[18:19], v[72:73]
  v_xor_b32 v75, 0x8000, v75
  s_nop 3
  v_cvt_pk_bf16_f32 v32, v32, v33
  v_cvt_pk_bf16_f32 v33, v34, v35
  v_bfi_b32 v32, 1, s72, v32
  buffer_store_dwordx2 v[32:33], v68, s[8:11], s76 offen
  v_mov_b64 v[20:21], 0
  v_mov_b64 v[22:23], 0
  v_mov_b64 v[24:25], 0
  v_mov_b64 v[26:27], 0
  v_mov_b64 v[28:29], 0
  v_mov_b64 v[30:31], 0
  v_mov_b64 v[32:33], 0
  v_mov_b64 v[34:35], 0
  s_add_u32 s58, s58, 655360
  s_add_u32 s59, s59, 655360
  s_add_u32 s70, s70, 655360
  s_add_u32 s68, s68, 655360
  s_add_u32 s66, s66, 1
  s_xor_b32 s64, s64, 16384
  s_xor_b32 s65, s65, 16384
  s_nop 15
  s_nop 15
  s_nop 7
  buffer_load_dwordx4 v[52:55], v76, s[8:11], s60 offen offset:0 sc1
  buffer_load_dwordx4 v[56:59], v76, s[8:11], s60 offen offset:1024 sc1
  s_nop 15
  s_nop 11
  buffer_load_dwordx4 v[36:39], v76, s[8:11], s60 offen offset:0 sc1
  buffer_load_dwordx4 v[40:43], v76, s[8:11], s60 offen offset:1024 sc1
  s_waitcnt lgkmcnt(0)
  s_waitcnt vmcnt(3)
  v_mfma_f32_16x16x32_bf16 v[4:7], v[0:3], v[52:55], 0
  v_bitop3_b32 v72, v52, v54, s72 bitop3:0x7e
  s_waitcnt vmcnt(2)
  v_mfma_f32_16x16x32_bf16 v[4:7], v[0:3], v[56:59], v[4:7]
  v_bitop3_b32 v73, v56, v58, s72 bitop3:0x7e
  v_bitop3_b32 v72, v72, v73, 1 bitop3:0xa8
  v_cmp_ne_u32 vcc, 0, v72
  s_nop 0
  s_cmp_eq_u64 vcc, 0
  s_cselect_b32 s54, s62, 268435456
  s_nop 0
  v_add_f32_dpp v4, v4, v4 row_ror:4 row_mask:0xf bank_mask:0xf
  v_add_f32_dpp v5, v5, v5 row_ror:4 row_mask:0xf bank_mask:0xf
  s_nop 0
  v_add_f32_dpp v4, v4, v4 row_ror:8 row_mask:0xf bank_mask:0xf
  v_add_f32_dpp v5, v5, v5 row_ror:8 row_mask:0xf bank_mask:0xf
  v_cvt_pk_bf16_f32 v4, v4, v5
  buffer_store_dword v4, v69, s[8:11], s54 offen
  s_cbranch_vccnz Cf1_h1r
  s_xor_b32 s62, s62, 16384
  buffer_store_dword v71, v69, s[8:11], s62 offen
  s_xor_b32 s72, s72, 1
  s_branch Cf1_h2
Cf1_h1r:
  s_mov_b64 exec, vcc
  buffer_load_dwordx4 v[52:55], v76, s[8:11], s60 offen offset:0 sc1
  buffer_load_dwordx4 v[56:59], v76, s[8:11], s60 offen offset:1024 sc1
  s_mov_b64 exec, -1
  s_add_u32 s67, s67, 1
  s_waitcnt vmcnt(4)
  v_mfma_f32_16x16x32_bf16 v[4:7], v[0:3], v[36:39], 0
  v_bitop3_b32 v72, v36, v38, s72 bitop3:0x7e
  s_waitcnt vmcnt(3)
  v_mfma_f32_16x16x32_bf16 v[4:7], v[0:3], v[40:43], v[4:7]
  v_bitop3_b32 v73, v40, v42, s72 bitop3:0x7e
  v_bitop3_b32 v72, v72, v73, 1 bitop3:0xa8
  v_cmp_ne_u32 vcc, 0, v72
  s_cbranch_vccz Cf1_h1p
  s_mov_b64 exec, vcc
  buffer_load_dwordx4 v[36:39], v76, s[8:11], s60 offen offset:0 sc1
  buffer_load_dwordx4 v[40:43], v76, s[8:11], s60 offen offset:1024 sc1
  s_mov_b64 exec, -1
  s_add_u32 s67, s67, 1
  s_waitcnt vmcnt(3)
  v_mfma_f32_16x16x32_bf16 v[4:7], v[0:3], v[52:55], 0
  v_bitop3_b32 v72, v52, v54, s72 bitop3:0x7e
  s_waitcnt vmcnt(2)
  v_mfma_f32_16x16x32_bf16 v[4:7], v[0:3], v[56:59], v[4:7]
  v_bitop3_b32 v73, v56, v58, s72 bitop3:0x7e
  v_bitop3_b32 v72, v72, v73, 1 bitop3:0xa8
  v_cmp_ne_u32 vcc, 0, v72
  s_cbranch_vccz Cf1_h1p
Cf1_h1s:
  s_mov_b64 exec, vcc
  buffer_load_dwordx4 v[52:55], v76, s[8:11], s60 offen offset:0 sc1
  buffer_load_dwordx4 v[56:59], v76, s[8:11], s60 offen offset:1024 sc1
  s_mov_b64 exec, -1
  s_add_u32 s67, s67, 1
  s_waitcnt vmcnt(3)
  v_mfma_f32_16x16x32_bf16 v[4:7], v[0:3], v[36:39], 0
  v_bitop3_b32 v72, v36, v38, s72 bitop3:0x7e
  s_waitcnt vmcnt(2)
  v_mfma_f32_16x16x32_bf16 v[4:7], v[0:3], v[40:43], v[4:7]
  v_bitop3_b32 v73, v40, v42, s72 bitop3:0x7e
  v_bitop3_b32 v72, v72, v73, 1 bitop3:0xa8
  v_cmp_ne_u32 vcc, 0, v72
  s_cbranch_vccz Cf1_h1p
  s_mov_b64 exec, vcc
  buffer_load_dwordx4 v[36:39], v76, s[8:11], s60 offen offset:0 sc1
  buffer_load_dwordx4 v[40:43], v76, s[8:11], s60 offen offset:1024 sc1
  s_mov_b64 exec, -1
  s_add_u32 s67, s67, 1
  s_waitcnt vmcnt(3)
  v_mfma_f32_16x16x32_bf16 v[4:7], v[0:3], v[52:55], 0
  v_bitop3_b32 v72, v52, v54, s72 bitop3:0x7e
  s_waitcnt vmcnt(2)
  v_mfma_f32_16x16x32_bf16 v[4:7], v[0:3], v[56:59], v[4:7]
  v_bitop3_b32 v73, v56, v58, s72 bitop3:0x7e
  v_bitop3_b32 v72, v72, v73, 1 bitop3:0xa8
  v_cmp_ne_u32 vcc, 0, v72
  s_cbranch_vccz Cf1_h1p
  s_cmp_lt_u32 s67, 131072
  s_cbranch_scc1 Cf1_h1s
Cf1_h1p:
  s_nop 2
  v_add_f32_dpp v4, v4, v4 row_ror:4 row_mask:0xf bank_mask:0xf
  v_add_f32_dpp v5, v5, v5 row_ror:4 row_mask:0xf bank_mask:0xf
  s_nop 0
  v_add_f32_dpp v4, v4, v4 row_ror:8 row_mask:0xf bank_mask:0xf
  v_add_f32_dpp v5, v5, v5 row_ror:8 row_mask:0xf bank_mask:0xf
  v_cvt_pk_bf16_f32 v4, v4, v5
  buffer_store_dword v4, v69, s[8:11], s62 offen
  s_xor_b32 s62, s62, 16384
  buffer_store_dword v71, v69, s[8:11], s62 offen
  s_xor_b32 s72, s72, 1
  s_branch Cf1_h2
Cf1_h2r:
  s_mov_b64 exec, vcc
  buffer_load_dwordx4 v[52:55], v76, s[8:11], s65 offen offset:2048 sc1
  s_mov_b64 exec, -1
  s_add_u32 s67, s67, 1
  s_waitcnt vmcnt(2)
  v_max3_u32 v72, v52, v53, v54
  v_max_u32 v72, v72, v55
  ds_write_b128 v76, v[52:55] offset:6656
  v_cmp_eq_u32 vcc, -1, v72
  s_cbranch_vccz Cf1_h2w
  s_mov_b64 exec, vcc
  buffer_load_dwordx4 v[52:55], v76, s[8:11], s65 offen offset:2048 sc1
  s_mov_b64 exec, -1
  s_add_u32 s67, s67, 1
  s_waitcnt vmcnt(2)
  v_max3_u32 v72, v52, v53, v54
  v_max_u32 v72, v72, v55
  ds_write_b128 v76, v[52:55] offset:6656
  v_cmp_eq_u32 vcc, -1, v72
  s_cbranch_vccz Cf1_h2w
  s_mov_b64 exec, vcc
  buffer_load_dwordx4 v[52:55], v76, s[8:11], s65 offen offset:2048 sc1
  s_mov_b64 exec, -1
  s_add_u32 s67, s67, 1
  s_waitcnt vmcnt(2)
  v_max3_u32 v72, v52, v53, v54
  v_max_u32 v72, v72, v55
  ds_write_b128 v76, v[52:55] offset:6656
  v_cmp_eq_u32 vcc, -1, v72
  s_cbranch_vccz Cf1_h2w
  s_mov_b64 exec, vcc
  buffer_load_dwordx4 v[52:55], v76, s[8:11], s65 offen offset:2048 sc1
  s_mov_b64 exec, -1
  s_add_u32 s67, s67, 1
  s_waitcnt vmcnt(2)
  v_max3_u32 v72, v52, v53, v54
  v_max_u32 v72, v72, v55
  ds_write_b128 v76, v[52:55] offset:6656
  v_cmp_eq_u32 vcc, -1, v72
  s_cbranch_vccz Cf1_h2w
  s_cmp_lt_u32 s67, 131072
  s_cbranch_scc1 Cf1_h2r
Cf1_h2ok:
  ds_write_b128 v76, v[52:55] offset:6656
  s_branch Cf1_h2w
Cf1_rec:
  s_nop 7
  s_waitcnt vmcnt(0) lgkmcnt(0)
  v_max3_u32 v72, v0, v1, v2
  v_max3_u32 v72, v72, v3, v4
  v_max3_u32 v72, v72, v5, v6
  v_max3_u32 v72, v72, v7, v8
  v_max3_u32 v72, v72, v9, v10
  v_max3_u32 v72, v72, v11, v12
  v_max3_u32 v72, v72, v13, v14
  v_max3_u32 v72, v72, v15, v16
  v_max3_u32 v72, v72, v17, v18
  v_max_u32 v72, v72, v19
  v_cmp_eq_u32 vcc, -1, v72
  s_cbranch_vccz Cf1_recok
  s_barrier
  v_mov_b64 v[20:21], 0
  v_mov_b64 v[22:23], 0
  v_mov_b64 v[24:25], 0
  v_mov_b64 v[26:27], 0
  v_mov_b64 v[28:29], 0
  v_mov_b64 v[30:31], 0
  v_mov_b64 v[32:33], 0
  v_mov_b64 v[34:35], 0
  s_waitcnt lgkmcnt(0)
  s_barrier
  ds_read_b128 v[0:3], v76 offset:4608
  ds_read_b128 v[60:63], v76 offset:20480
  ds_read_b128 v[64:67], v76 offset:21504
  s_waitcnt lgkmcnt(0)
  v_smfmac_f32_16x16x64_bf16 v[20:23], v[0:3], v[60:67], v74
  ds_read_b128 v[60:63], v76 offset:22528
  ds_read_b128 v[64:67], v76 offset:23552
  s_waitcnt lgkmcnt(0)
  v_smfmac_f32_16x16x64_bf16 v[24:27], v[0:3], v[60:67], v74
  ds_read_b128 v[60:63], v76 offset:36864
  ds_read_b128 v[64:67], v76 offset:37888
  s_waitcnt lgkmcnt(0)
  v_smfmac_f32_16x16x64_bf16 v[28:31], v[0:3], v[60:67], v74
  ds_read_b128 v[60:63], v76 offset:38912
  ds_read_b128 v[64:67], v76 offset:39936
  s_waitcnt lgkmcnt(0)
  v_smfmac_f32_16x16x64_bf16 v[32:35], v[0:3], v[60:67], v74
  ds_read_b128 v[4:7], v76 offset:5632
  s_waitcnt lgkmcnt(0)
  v_smfmac_f32_16x16x64_bf16 v[20:23], v[4:7], v[80:87], v74
  v_smfmac_f32_16x16x64_bf16 v[24:27], v[4:7], v[88:95], v74
  v_smfmac_f32_16x16x64_bf16 v[28:31], v[4:7], v[208:215], v74
  v_smfmac_f32_16x16x64_bf16 v[32:35], v[4:7], v[216:223], v74
  ds_read_b128 v[8:11], v76 offset:6656
  s_waitcnt lgkmcnt(0)
  v_smfmac_f32_16x16x64_bf16 v[20:23], v[8:11], v[96:103], v74
  v_smfmac_f32_16x16x64_bf16 v[24:27], v[8:11], v[104:111], v74
  ds_read_b128 v[60:63], v76 offset:53248
  ds_read_b128 v[64:67], v76 offset:54272
  s_waitcnt lgkmcnt(0)
  v_smfmac_f32_16x16x64_bf16 v[28:31], v[8:11], v[60:67], v74
  ds_read_b128 v[60:63], v76 offset:55296
  ds_read_b128 v[64:67], v76 offset:56320
  s_waitcnt lgkmcnt(0)
  v_smfmac_f32_16x16x64_bf16 v[32:35], v[8:11], v[60:67], v74
  ds_read_b128 v[12:15], v76 offset:7680
  s_waitcnt lgkmcnt(0)
  v_smfmac_f32_16x16x64_bf16 v[20:23], v[12:15], v[112:119], v74
  v_smfmac_f32_16x16x64_bf16 v[24:27], v[12:15], v[120:127], v74
  v_smfmac_f32_16x16x64_bf16 v[28:31], v[12:15], v[224:231], v74
  v_smfmac_f32_16x16x64_bf16 v[32:35], v[12:15], v[232:239], v74
  ds_read_b128 v[0:3], v76 offset:8704
  s_waitcnt lgkmcnt(0)
  v_smfmac_f32_16x16x64_bf16 v[20:23], v[0:3], v[128:135], v74
  v_smfmac_f32_16x16x64_bf16 v[24:27], v[0:3], v[136:143], v74
  ds_read_b128 v[60:63], v75 offset:4096
  ds_read_b128 v[64:67], v75 offset:5120
  s_waitcnt lgkmcnt(0)
  v_smfmac_f32_16x16x64_bf16 v[28:31], v[0:3], v[60:67], v74
  ds_read_b128 v[60:63], v75 offset:6144
  ds_read_b128 v[64:67], v75 offset:7168
  s_waitcnt lgkmcnt(0)
  v_smfmac_f32_16x16x64_bf16 v[32:35], v[0:3], v[60:67], v74
  ds_read_b128 v[4:7], v76 offset:9728
  s_waitcnt lgkmcnt(0)
  v_smfmac_f32_16x16x64_bf16 v[20:23], v[4:7], v[144:151], v74
  v_smfmac_f32_16x16x64_bf16 v[24:27], v[4:7], v[152:159], v74
  ds_read_b128 v[60:63], v75 offset:20480
  ds_read_b128 v[64:67], v75 offset:21504
  s_waitcnt lgkmcnt(0)
  v_smfmac_f32_16x16x64_bf16 v[28:31], v[4:7], v[60:67], v74
  ds_read_b128 v[60:63], v75 offset:22528
  ds_read_b128 v[64:67], v75 offset:23552
  s_waitcnt lgkmcnt(0)
  v_smfmac_f32_16x16x64_bf16 v[32:35], v[4:7], v[60:67], v74
  ds_read_b128 v[16:19], v76 offset:10752
  s_waitcnt lgkmcnt(0)
  v_smfmac_f32_16x16x64_bf16 v[20:23], v[16:19], v[160:167], v74
  v_smfmac_f32_16x16x64_bf16 v[24:27], v[16:19], v[168:175], v74
  v_smfmac_f32_16x16x64_bf16 v[28:31], v[16:19], v[240:247], v74
  v_smfmac_f32_16x16x64_bf16 v[32:35], v[16:19], v[248:255], v74
  ds_read_b128 v[12:15], v76 offset:11776
  s_waitcnt lgkmcnt(0)
  v_smfmac_f32_16x16x64_bf16 v[20:23], v[12:15], v[176:183], v74
  v_smfmac_f32_16x16x64_bf16 v[24:27], v[12:15], v[184:191], v74
  v_smfmac_f32_16x16x64_bf16 v[28:31], v[12:15], a[0:7], v74
  v_smfmac_f32_16x16x64_bf16 v[32:35], v[12:15], a[8:15], v74
  ds_read_b128 v[8:11], v76 offset:12800
  s_waitcnt lgkmcnt(0)
  v_smfmac_f32_16x16x64_bf16 v[20:23], v[8:11], v[192:199], v74
  v_smfmac_f32_16x16x64_bf16 v[24:27], v[8:11], v[200:207], v74
  v_smfmac_f32_16x16x64_bf16 v[28:31], v[8:11], a[16:23], v74
  v_smfmac_f32_16x16x64_bf16 v[32:35], v[8:11], a[24:31], v74
  v_add_f32 v20, v20, v22
  v_add_f32 v21, v21, v23
  v_add_f32 v24, v24, v26
  v_cvt_pk_bf16_f32 v22, v20, v24
  s_nop 0
  ds_write_b32 v79, v22 offset:0
  v_add_f32 v25, v25, v27
  v_cvt_pk_bf16_f32 v23, v21, v25
  ds_write_b32 v79, v23 offset:576
  v_add_f32 v28, v28, v30
  v_add_f32 v29, v29, v31
  s_waitcnt lgkmcnt(0)
  s_nop 1
  s_branch Cf1_recok
Cf1_mx:
  s_waitcnt lgkmcnt(0)
  s_barrier
  buffer_load_dwordx4 v[0:3], v76, s[8:11], s58 offen offset:0 sc1
  ds_read_b128 v[20:23], v77 offset:0
  ds_read_b128 v[28:31], v77 offset:256
  buffer_load_dwordx4 v[4:7], v76, s[8:11], s58 offen offset:1024 sc1
  ds_read_b128 v[24:27], v77 offset:128
  ds_read_b128 v[32:35], v77 offset:384
  s_waitcnt vmcnt(1) lgkmcnt(3)
  v_mfma_f32_16x16x32_bf16 v[8:11], v[0:3], v[20:23], 0
  s_waitcnt vmcnt(0) lgkmcnt(1)
  v_mfma_f32_16x16x32_bf16 v[8:11], v[4:7], v[24:27], v[8:11]
  v_mfma_f32_16x16x32_bf16 v[12:15], v[28:31], v[20:23], 0
  s_waitcnt lgkmcnt(0)
  v_mfma_f32_16x16x32_bf16 v[12:15], v[32:35], v[24:27], v[12:15]
  v_add_f32_dpp v8, v10, v8 quad_perm:[2,3,0,1] row_mask:0xf bank_mask:0xf
  v_add_f32_dpp v9, v11, v9 quad_perm:[2,3,0,1] row_mask:0xf bank_mask:0xf
  s_nop 0
  v_mov_b32_dpp v8, v8 quad_perm:[0,1,0,1] row_mask:0xf bank_mask:0xf
  v_mov_b32_dpp v9, v9 quad_perm:[0,1,0,1] row_mask:0xf bank_mask:0xf
  s_nop 1
  v_add_f32_dpp v12, v14, v12 quad_perm:[2,3,0,1] row_mask:0xf bank_mask:0xf
  v_add_f32_dpp v13, v15, v13 quad_perm:[2,3,0,1] row_mask:0xf bank_mask:0xf
  s_nop 0
  v_mov_b32_dpp v12, v12 quad_perm:[0,1,0,1] row_mask:0xf bank_mask:0xf
  v_mov_b32_dpp v13, v13 quad_perm:[0,1,0,1] row_mask:0xf bank_mask:0xf
  v_mul_f32 v12, s69, v12
  ds_write_b32 v78, v8 offset:8708
  v_mul_f32 v13, s69, v13
  ds_write_b32 v78, v9 offset:8772
  s_waitcnt lgkmcnt(0)
  s_barrier
  ds_read_b128 v[36:39], v78 offset:8704
  ds_read_b128 v[40:43], v78 offset:8768
  s_waitcnt lgkmcnt(0)
  s_barrier
  v_max_f32 v16, v36, v37
  v_max3_f32 v16, v16, v38, v39
  v_max3_f32 v16, v16, v40, v41
  v_max3_f32 v16, v16, v42, v43
  v_max3_f32 v16, v16, v12, v13
  v_mov_b32 v17, v16
  s_nop 1
  v_permlane16_swap_b32 v16, v17
  v_max_f32 v16, v16, v17
  v_mov_b32 v17, v16
  s_nop 1
  v_permlane32_swap_b32 v16, v17
  v_max_f32 v16, v16, v17
  v_sub_f32 v36, v36, v16
  v_sub_f32 v37, v37, v16
  v_sub_f32 v38, v38, v16
  v_sub_f32 v39, v39, v16
  v_sub_f32 v40, v40, v16
  v_sub_f32 v41, v41, v16
  v_sub_f32 v42, v42, v16
  v_sub_f32 v43, v43, v16
  v_sub_f32 v12, v12, v16
  v_sub_f32 v13, v13, v16
  v_exp_f32 v36, v36
  v_exp_f32 v37, v37
  v_exp_f32 v38, v38
  v_exp_f32 v39, v39
  v_exp_f32 v40, v40
  v_exp_f32 v41, v41
  v_exp_f32 v42, v42
  v_exp_f32 v43, v43
  v_exp_f32 v12, v12
  v_exp_f32 v13, v13
  v_cvt_pk_bf16_f32 v32, v36, v40
  v_cvt_pk_bf16_f32 v33, v37, v41
  v_cvt_pk_bf16_f32 v34, v38, v42
  v_cvt_pk_bf16_f32 v35, v39, v43
  v_cvt_pk_bf16_f32 v28, v12, v13
  v_cvt_pk_bf16_f32 v31, v12, v13
  v_mov_b32 v29, 0
  v_mov_b32 v30, 0
  v_mov_b32 v68, 0x3f803f80
  v_mov_b32 v69, 0x3f803f80
  v_mov_b32 v70, 0x3f803f80
  v_mov_b32 v71, 0x3f803f80
  s_nop 1
  v_mfma_f32_16x16x32_bf16 v[8:11], v[32:35], v[68:71], 0
  v_mfma_f32_16x16x32_bf16 v[0:3], v[32:35], v[52:55], 0
  v_mfma_f32_16x16x32_bf16 v[4:7], v[32:35], v[56:59], 0
  v_mfma_f32_16x16x16_bf16 v[8:11], v[28:29], v[68:69], v[8:11]
  v_mfma_f32_16x16x16_bf16 v[0:3], v[28:29], v[72:73], v[0:3]
  v_mfma_f32_16x16x16_bf16 v[4:7], v[30:31], v[72:73], v[4:7]
  ds_read_b128 v[68:71], v76 offset:13824
  v_rcp_f32 v10, v8
  v_rcp_f32 v11, v9
  v_mul_f32 v0, v10, v0
  v_mul_f32 v1, v11, v1
  s_nop 0
  v_mul_f32 v4, v10, v4
  v_mul_f32 v5, v11, v5
  v_cvt_pk_bf16_f32 v2, v0, v4
  ds_write_b32 v79, v2 offset:8704
  v_cvt_pk_bf16_f32 v3, v1, v5
  ds_write_b32 v79, v3 offset:9280
  v_mov_b64 v[16:17], 0
  v_mov_b64 v[18:19], 0
  v_mov_b64 v[20:21], 0
  v_mov_b64 v[22:23], 0
  v_mov_b64 v[24:25], 0
  v_mov_b64 v[26:27], 0
  s_branch Cf1_mxok
Cf1_last:
  s_waitcnt vmcnt(0) lgkmcnt(0)
  ds_read_b64 v[16:17], v77 offset:264
  v_mov_b64 v[18:19], v[72:73]
  s_add_u32 s68, s68, 655360
  s_waitcnt lgkmcnt(0)
  buffer_store_dwordx4 v[16:19], v76, s[8:11], s68 offen sc1
  s_waitcnt vmcnt(0)
  s_barrier
  s_branch L_cexit
L_w2:
  v_mov_b64 v[20:21], 0
  v_mov_b64 v[22:23], 0
  v_mov_b64 v[24:25], 0
  v_mov_b64 v[26:27], 0
  v_mov_b64 v[28:29], 0
  v_mov_b64 v[30:31], 0
  v_mov_b64 v[32:33], 0
  v_mov_b64 v[34:35], 0
  s_mov_b32 s78, 0x3f803f80
  s_mov_b32 s79, s78
  s_mov_b32 s65, 360448
  s_mov_b32 m0, 15872
  v_lshlrev_b32 v73, 2, v76
  v_mov_b32 v72, 0
  ds_read_b128 v[60:63], v76 offset:24576
  ds_read_b128 v[64:67], v76 offset:25600
  ds_read_b128 v[44:47], v76 offset:26624
  ds_read_b128 v[48:51], v76 offset:27648
  ds_read_b128 v[36:39], v76 offset:40960
  ds_read_b128 v[40:43], v76 offset:41984
  ds_read_b128 v[0:3], v76 offset:4608
  ds_read_b128 v[4:7], v76 offset:5632
  s_branch Cf2_top2
.p2align 6
Cf2_h2:
  v_lshlrev_b32 v73, 2, v76
  s_mov_b32 m0, 8704
  s_nop 3
  buffer_load_dwordx4 v[52:55], v76, s[8:11], s65 offen offset:3072 sc1
  s_nop 15
  s_nop 1
  buffer_load_dwordx4 v[52:55], v76, s[8:11], s65 offen offset:3072 sc1
  s_nop 15
  s_nop 1
  buffer_load_dwordx4 v[52:55], v76, s[8:11], s65 offen offset:3072 sc1
  s_waitcnt vmcnt(5)
  ds_read_b128 v[60:63], v76 offset:24576
  ds_read_b128 v[64:67], v76 offset:25600
  ds_read_b128 v[44:47], v76 offset:26624
  ds_read_b128 v[48:51], v76 offset:27648
  ds_read_b128 v[36:39], v76 offset:40960
  ds_read_b128 v[40:43], v76 offset:41984
  s_waitcnt vmcnt(2)
  v_max3_u32 v72, v52, v53, v54
  v_max_u32 v72, v72, v55
  ds_write_b128 v76, v[52:55] offset:7680
  v_cmp_eq_u32 vcc, -1, v72
  s_cbranch_vccnz Cf2_h2r
Cf2_h2w:
  s_waitcnt lgkmcnt(0)
  s_barrier
  ds_read_b128 v[0:3], v76 offset:4608
  ds_read_b128 v[4:7], v76 offset:5632
  buffer_load_dwordx4 v76, s[8:11], s64 offen offset:0 sc1 lds
  buffer_load_dwordx4 v76, s[8:11], s64 offen offset:1024 sc1 lds
Cf2_top2:
  ds_read_b128 v[8:11], v76 offset:6656
  s_mov_b32 m0, 15872
  s_waitcnt lgkmcnt(2)
  v_smfmac_f32_16x16x64_bf16 v[20:23], v[0:3], v[60:67], v74
  ds_read_b128 v[60:63], v76 offset:43008
  v_smfmac_f32_16x16x64_bf16 v[24:27], v[0:3], v[44:51], v74
  ds_read_b128 v[64:67], v76 offset:44032
  s_waitcnt lgkmcnt(3)
  v_smfmac_f32_16x16x64_bf16 v[20:23], v[4:7], v[80:87], v74
  buffer_load_dwordx4 v[44:47], v76, s[8:11], s58 offen offset:0 sc1
  v_smfmac_f32_16x16x64_bf16 v[28:31], v[0:3], v[36:43], v74
  ds_read_b128 v[36:39], v76 offset:57344
  v_smfmac_f32_16x16x64_bf16 v[24:27], v[4:7], v[88:95], v74
  buffer_load_dwordx4 v[48:51], v76, s[8:11], s58 offen offset:1024 sc1
  ds_read_b128 v[40:43], v76 offset:58368
  v_smfmac_f32_16x16x64_bf16 v[28:31], v[4:7], v[208:215], v74
  ds_read_b128 v[12:15], v76 offset:7680
  s_waitcnt lgkmcnt(5)
  v_smfmac_f32_16x16x64_bf16 v[32:35], v[4:7], v[216:223], v74
  buffer_load_dwordx4 v[52:55], v76, s[8:11], s59 offen offset:0 sc1
  s_waitcnt lgkmcnt(3)
  v_smfmac_f32_16x16x64_bf16 v[32:35], v[0:3], v[60:67], v74
  buffer_load_dwordx4 v[56:59], v76, s[8:11], s59 offen offset:1024 sc1
  v_smfmac_f32_16x16x64_bf16 v[20:23], v[8:11], v[96:103], v74
  ds_read_b128 v[60:63], v76 offset:59392
  v_smfmac_f32_16x16x64_bf16 v[24:27], v[8:11], v[104:111], v74
  ds_read_b128 v[64:67], v76 offset:60416
  s_waitcnt lgkmcnt(3)
  v_smfmac_f32_16x16x64_bf16 v[28:31], v[8:11], v[36:43], v74
  buffer_load_dword v73, s[8:11], s70 offen lds
  ds_read_b128 v[36:39], v75 offset:8192
  s_waitcnt lgkmcnt(3)
  v_smfmac_f32_16x16x64_bf16 v[20:23], v[12:15], v[112:119], v74
  s_waitcnt vmcnt(5)
  ds_read_b128 v[40:43], v75 offset:9216
  v_smfmac_f32_16x16x64_bf16 v[24:27], v[12:15], v[120:127], v74
  s_barrier
  ds_read_b128 v[0:3], v76 offset:8704
  v_smfmac_f32_16x16x64_bf16 v[28:31], v[12:15], v[224:231], v74
  buffer_store_dwordx4 v[16:19], v76, s[8:11], s68 offen sc1
  ds_read_b128 v[4:7], v76 offset:9728
  v_smfmac_f32_16x16x64_bf16 v[32:35], v[12:15], v[232:239], v74
  s_waitcnt lgkmcnt(4)
  v_smfmac_f32_16x16x64_bf16 v[32:35], v[8:11], v[60:67], v74
  ds_read_b128 v[60:63], v75 offset:10240
  s_waitcnt lgkmcnt(2)
  v_smfmac_f32_16x16x64_bf16 v[20:23], v[0:3], v[128:135], v74
  ds_read_b128 v[16:19], v76 offset:10752
  v_smfmac_f32_16x16x64_bf16 v[24:27], v[0:3], v[136:143], v74
  ds_read_b128 v[64:67], v75 offset:11264
  v_smfmac_f32_16x16x64_bf16 v[28:31], v[0:3], v[36:43], v74
  ds_read_b128 v[36:39], v75 offset:24576
  s_waitcnt lgkmcnt(4)
  v_smfmac_f32_16x16x64_bf16 v[20:23], v[4:7], v[144:151], v74
  ds_read_b128 v[12:15], v76 offset:11776
  v_smfmac_f32_16x16x64_bf16 v[24:27], v[4:7], v[152:159], v74
  ds_read_b128 v[40:43], v75 offset:25600
  s_waitcnt lgkmcnt(4)
  v_smfmac_f32_16x16x64_bf16 v[20:23], v[16:19], v[160:167], v74
  ds_read_b128 v[8:11], v76 offset:12800
  s_waitcnt lgkmcnt(4)
  v_smfmac_f32_16x16x64_bf16 v[32:35], v[0:3], v[60:67], v74
  ds_read_b128 v[60:63], v75 offset:26624
  v_mov_b64 v[68:69], s[78:79]
  v_smfmac_f32_16x16x64_bf16 v[24:27], v[16:19], v[168:175], v74
  ds_read_b128 v[64:67], v75 offset:27648
  s_waitcnt lgkmcnt(4)
  v_mov_b64 v[70:71], s[78:79]
  v_smfmac_f32_16x16x64_bf16 v[20:23], v[12:15], v[176:183], v74
  s_waitcnt lgkmcnt(3)
  v_smfmac_f32_16x16x64_bf16 v[28:31], v[4:7], v[36:43], v74
  s_waitcnt lgkmcnt(2)
  v_mov_b64 v[36:37], 0
  v_smfmac_f32_16x16x64_bf16 v[20:23], v[8:11], v[192:199], v74
  v_mov_b64 v[38:39], 0
  v_smfmac_f32_16x16x64_bf16 v[24:27], v[12:15], v[184:191], v74
  v_mov_b64 v[40:41], 0
  v_smfmac_f32_16x16x64_bf16 v[24:27], v[8:11], v[200:207], v74
  s_waitcnt lgkmcnt(0)
  v_add_f32 v20, v20, v22
  v_smfmac_f32_16x16x64_bf16 v[32:35], v[4:7], v[60:67], v74
  v_add_f32 v21, v21, v23
  v_smfmac_f32_16x16x64_bf16 v[28:31], v[16:19], v[240:247], v74
  v_add_f32 v24, v24, v26
  v_cvt_pk_bf16_f32 v22, v20, v24
  v_smfmac_f32_16x16x64_bf16 v[28:31], v[12:15], a[0:7], v74
  ds_write_b32 v79, v22 offset:0
  v_add_f32 v25, v25, v27
  v_cvt_pk_bf16_f32 v23, v21, v25
  v_smfmac_f32_16x16x64_bf16 v[28:31], v[8:11], a[16:23], v74
  ds_write_b32 v79, v23 offset:576
  v_cmp_u_f32 vcc, v20, v21
  v_smfmac_f32_16x16x64_bf16 v[32:35], v[16:19], v[248:255], v74
  v_mov_b64 v[42:43], 0
  v_smfmac_f32_16x16x64_bf16 v[32:35], v[12:15], a[8:15], v74
  v_add_f32 v28, v28, v30
  v_add_f32 v29, v29, v31
  v_smfmac_f32_16x16x64_bf16 v[32:35], v[8:11], a[24:31], v74
  s_cbranch_vccnz Cf2_rec
Cf2_recok:
  v_smfmac_f32_16x16x64_bf16 v[36:39], v[16:19], a[128:135], v74
  s_waitcnt lgkmcnt(0)
  s_barrier
  ds_read_b128 v[60:63], v77
  v_smfmac_f32_16x16x64_bf16 v[40:43], v[16:19], a[136:143], v74
  ds_read_b128 v[64:67], v77 offset:128
  v_add_f32 v32, v32, v34
  v_cvt_pk_bf16_f32 v30, v28, v32
  v_smfmac_f32_16x16x64_bf16 v[36:39], v[0:3], a[96:103], v74
  ds_write_b32 v79, v30 offset:256
  v_add_f32 v33, v33, v35
  v_cvt_pk_bf16_f32 v31, v29, v33
  v_smfmac_f32_16x16x64_bf16 v[40:43], v[0:3], a[104:111], v74
  ds_write_b32 v79, v31 offset:832
  v_xor_b32 v75, 0x8000, v75
  v_smfmac_f32_16x16x64_bf16 v[36:39], v[4:7], a[112:119], v74
  ds_read_b128 v[0:3], v76 offset:4608
  v_mov_b32 v29, 0
  v_smfmac_f32_16x16x64_bf16 v[40:43], v[4:7], a[120:127], v74
  s_waitcnt vmcnt(4) lgkmcnt(3)
  v_mov_b32 v30, 0
  v_mfma_f32_16x16x32_bf16 v[44:47], v[44:47], v[60:63], 0
  ds_read_b128 v[4:7], v76 offset:5632
  s_waitcnt lgkmcnt(2)
  v_mfma_f32_16x16x32_bf16 v[44:47], v[48:51], v[64:67], v[44:47]
  s_barrier
  v_smfmac_f32_16x16x64_bf16 v[36:39], v[8:11], a[160:167], v74
  ds_read_b128 v[20:23], v77 offset:256
  ds_read_b128 v[24:27], v77 offset:384
  v_smfmac_f32_16x16x64_bf16 v[40:43], v[8:11], a[168:175], v74
  ds_read_b128 v[8:11], v76 offset:6656
  v_add_f32_dpp v72, v46, v44 quad_perm:[2,3,0,1] row_mask:0xf bank_mask:0xf
  v_add_f32_dpp v73, v47, v45 quad_perm:[2,3,0,1] row_mask:0xf bank_mask:0xf
  v_smfmac_f32_16x16x64_bf16 v[36:39], v[12:15], a[144:151], v74
  s_waitcnt lgkmcnt(4)
  v_exp_f32_dpp v72, v72 quad_perm:[0,1,0,1] row_mask:0xf bank_mask:0xf
  v_smfmac_f32_16x16x64_bf16 v[40:43], v[12:15], a[152:159], v74
  ds_read_b128 v[12:15], v76 offset:7680
  v_exp_f32_dpp v73, v73 quad_perm:[0,1,0,1] row_mask:0xf bank_mask:0xf
  v_smfmac_f32_16x16x64_bf16 v[36:39], v[0:3], a[32:39], v74
  s_waitcnt lgkmcnt(2)
  v_cvt_pk_bf16_f32 v72, v72, v73
  v_mfma_f32_16x16x32_bf16 v[20:23], v[20:23], v[60:63], 0
  ds_write_b32 v78, v72 offset:520
  v_mov_b64 v[16:17], 0
  v_mfma_f32_16x16x32_bf16 v[20:23], v[24:27], v[64:67], v[20:23]
  ds_read_b128 v[44:47], v75 offset:24576
  v_mov_b64 v[18:19], 0
  v_smfmac_f32_16x16x64_bf16 v[40:43], v[0:3], a[40:47], v74
  ds_read_b128 v[48:51], v75 offset:25600
  s_waitcnt lgkmcnt(4)
  v_smfmac_f32_16x16x64_bf16 v[36:39], v[4:7], a[48:55], v74
  v_add_f32_dpp v24, v22, v20 quad_perm:[2,3,0,1] row_mask:0xf bank_mask:0xf
  v_add_f32_dpp v25, v23, v21 quad_perm:[2,3,0,1] row_mask:0xf bank_mask:0xf
  v_smfmac_f32_16x16x64_bf16 v[36:39], v[8:11], a[64:71], v74
  s_waitcnt lgkmcnt(2)
  s_barrier
  ds_read_b128 v[32:35], v78 offset:512
  v_smfmac_f32_16x16x64_bf16 v[36:39], v[12:15], a[80:87], v74
  ds_read_b128 v[60:63], v75 offset:26624
  v_mul_f32 v24, s69, v24
  v_smfmac_f32_16x16x64_bf16 v[40:43], v[4:7], a[56:63], v74
  ds_read_b128 v[64:67], v75 offset:27648
  v_mul_f32 v25, s69, v25
  v_smfmac_f32_16x16x64_bf16 v[40:43], v[8:11], a[72:79], v74
  v_exp_f32_dpp v24, v24 quad_perm:[0,1,0,1] row_mask:0xf bank_mask:0xf
  v_smfmac_f32_16x16x64_bf16 v[40:43], v[12:15], a[88:95], v74
  s_waitcnt vmcnt(2) lgkmcnt(2)
  v_exp_f32_dpp v25, v25 quad_perm:[0,1,0,1] row_mask:0xf bank_mask:0xf
  v_mfma_f32_16x16x32_bf16 v[8:11], v[32:35], v[68:71], 0
  v_add_f32 v36, v36, v38
  v_add_f32 v37, v37, v39
  v_mfma_f32_16x16x32_bf16 v[0:3], v[32:35], v[52:55], 0
  v_add_f32 v40, v40, v42
  v_add_f32 v41, v41, v43
  v_mfma_f32_16x16x32_bf16 v[4:7], v[32:35], v[56:59], 0
  v_cvt_pk_bf16_f32 v28, v24, v25
  v_cvt_pk_bf16_f32 v72, v36, v37
  v_cvt_pk_bf16_f32 v73, v40, v41
  v_mfma_f32_16x16x16_bf16 v[8:11], v[28:29], v[68:69], v[8:11]
  v_cvt_pk_bf16_f32 v31, v24, v25
  v_mov_b64 v[20:21], 0
  v_mfma_f32_16x16x16_bf16 v[0:3], v[28:29], v[72:73], v[0:3]
  ds_read_b128 v[68:71], v76 offset:13824
  v_mov_b64 v[22:23], 0
  v_mfma_f32_16x16x16_bf16 v[4:7], v[30:31], v[72:73], v[4:7]
  v_rcp_f32 v10, v8
  v_rcp_f32 v11, v9
  v_mul_f32 v0, v10, v0
  v_mul_f32 v1, v11, v1
  s_nop 0
  v_mul_f32 v4, v10, v4
  v_mul_f32 v5, v11, v5
  v_cvt_pk_bf16_f32 v2, v0, v4
  ds_write_b32 v79, v2 offset:8704
  v_cvt_pk_bf16_f32 v3, v1, v5
  ds_write_b32 v79, v3 offset:9280
  v_max3_f32 v8, v8, v9, v10
  v_max_f32 v8, v8, v11
  v_cmp_le_f32 vcc, 1317011456, v8
  v_mov_b64 v[24:25], 0
  v_mov_b64 v[26:27], 0
  s_cbranch_vccnz Cf2_mx
Cf2_mxok:
  s_waitcnt lgkmcnt(0)
  s_barrier
  ds_read_b128 v[0:3], v78 offset:8704
  ds_read_b128 v[4:7], v78 offset:8768
  ds_read_b128 v[8:11], v78 offset:8832
  ds_read_b128 v[12:15], v78 offset:8896
  s_cmp_eq_u32 s66, 63
  s_cbranch_scc1 Cf2_last
  s_waitcnt lgkmcnt(3)
  v_smfmac_f32_16x16x64_bf16 v[16:19], v[0:3], v[44:51], v74
  ds_read_b128 v[52:55], v75 offset:40960
  s_waitcnt lgkmcnt(3)
  v_smfmac_f32_16x16x64_bf16 v[16:19], v[4:7], v[60:67], v74
  ds_read_b128 v[56:59], v75 offset:41984
  s_waitcnt lgkmcnt(3)
  v_smfmac_f32_16x16x64_bf16 v[16:19], v[8:11], a[176:183], v74
  ds_read_b128 v[36:39], v75 offset:43008
  s_waitcnt lgkmcnt(3)
  v_smfmac_f32_16x16x64_bf16 v[16:19], v[12:15], a[184:191], v74
  ds_read_b128 v[40:43], v75 offset:44032
  ds_read_b128 v[44:47], v75 offset:57344
  v_smfmac_f32_16x16x64_bf16 v[20:23], v[0:3], a[192:199], v74
  ds_read_b128 v[48:51], v75 offset:58368
  ds_read_b128 v[60:63], v75 offset:59392
  v_smfmac_f32_16x16x64_bf16 v[20:23], v[4:7], a[200:207], v74
  ds_read_b128 v[64:67], v75 offset:60416
  s_waitcnt lgkmcnt(6)
  v_cvt_pk_bf16_f32 v16, v16, v17
  v_cvt_pk_bf16_f32 v17, v18, v19
  v_bfi_b32 v16, 1, s72, v16
  v_smfmac_f32_16x16x64_bf16 v[20:23], v[8:11], v[52:59], v74
  buffer_store_dwordx2 v[16:17], v68, s[8:11], s73 offen
  s_waitcnt lgkmcnt(4)
  v_smfmac_f32_16x16x64_bf16 v[20:23], v[12:15], v[36:43], v74
  ds_read_b128 v[52:55], v75 offset:0
  v_mov_b64 v[32:33], 0
  v_smfmac_f32_16x16x64_bf16 v[24:27], v[0:3], a[208:215], v74
  ds_read_b128 v[56:59], v75 offset:1024
  v_mov_b64 v[34:35], 0
  v_smfmac_f32_16x16x64_bf16 v[24:27], v[4:7], a[216:223], v74
  ds_read_b128 v[36:39], v75 offset:2048
  s_waitcnt lgkmcnt(5)
  v_cvt_pk_bf16_f32 v20, v20, v21
  v_cvt_pk_bf16_f32 v21, v22, v23
  v_bfi_b32 v20, 1, s72, v20
  v_smfmac_f32_16x16x64_bf16 v[24:27], v[8:11], v[44:51], v74
  buffer_store_dwordx2 v[20:21], v68, s[8:11], s74 offen
  s_waitcnt lgkmcnt(3)
  v_smfmac_f32_16x16x64_bf16 v[24:27], v[12:15], v[60:67], v74
  ds_read_b128 v[40:43], v75 offset:3072
  v_mov_b64 v[28:29], 0
  v_smfmac_f32_16x16x64_bf16 v[32:35], v[0:3], a[224:231], v74
  ds_read_b128 v[44:47], v75 offset:4096
  ds_read_b128 v[48:51], v75 offset:5120
  v_smfmac_f32_16x16x64_bf16 v[32:35], v[4:7], a[232:239], v74
  ds_read_b128 v[60:63], v75 offset:6144
  v_cvt_pk_bf16_f32 v24, v24, v25
  v_cvt_pk_bf16_f32 v25, v26, v27
  v_bfi_b32 v24, 1, s72, v24
  v_smfmac_f32_16x16x64_bf16 v[32:35], v[8:11], a[240:247], v74
  buffer_store_dwordx2 v[24:25], v68, s[8:11], s75 offen
  v_mov_b64 v[30:31], 0
  v_smfmac_f32_16x16x64_bf16 v[32:35], v[12:15], a[248:255], v74
  ds_read_b128 v[64:67], v75 offset:7168
  s_waitcnt lgkmcnt(6)
  v_smfmac_f32_16x16x64_bf16 v[28:31], v[0:3], v[52:59], v74
  s_waitcnt lgkmcnt(4)
  v_smfmac_f32_16x16x64_bf16 v[28:31], v[4:7], v[36:43], v74
  s_waitcnt lgkmcnt(2)
  v_cvt_pk_bf16_f32 v32, v32, v33
  v_cvt_pk_bf16_f32 v33, v34, v35
  v_bfi_b32 v32, 1, s72, v32
  v_smfmac_f32_16x16x64_bf16 v[28:31], v[8:11], v[44:51], v74
  buffer_store_dwordx2 v[32:33], v68, s[8:11], s76 offen
  s_waitcnt lgkmcnt(0)
  v_smfmac_f32_16x16x64_bf16 v[28:31], v[12:15], v[60:67], v74
  ds_read_b128 v[0:3], v76 offset:14848
  ds_read_b64 v[16:17], v77 offset:384
  v_mov_b64 v[18:19], v[72:73]
  v_xor_b32 v75, 0x8000, v75
  s_nop 3
  v_cvt_pk_bf16_f32 v28, v28, v29
  v_cvt_pk_bf16_f32 v29, v30, v31
  v_bfi_b32 v28, 1, s72, v28
  buffer_store_dwordx2 v[28:29], v68, s[8:11], s77 offen
  v_mov_b64 v[20:21], 0
  v_mov_b64 v[22:23], 0
  v_mov_b64 v[24:25], 0
  v_mov_b64 v[26:27], 0
  v_mov_b64 v[28:29], 0
  v_mov_b64 v[30:31], 0
  v_mov_b64 v[32:33], 0
  v_mov_b64 v[34:35], 0
  s_add_u32 s58, s58, 655360
  s_add_u32 s59, s59, 655360
  s_add_u32 s70, s70, 655360
  s_add_u32 s68, s68, 655360
  s_add_u32 s66, s66, 1
  s_xor_b32 s64, s64, 16384
  s_xor_b32 s65, s65, 16384
  s_nop 15
  s_nop 15
  s_nop 7
  buffer_load_dwordx4 v[52:55], v76, s[8:11], s60 offen offset:0 sc1
  buffer_load_dwordx4 v[56:59], v76, s[8:11], s60 offen offset:1024 sc1
  s_nop 15
  s_nop 11
  buffer_load_dwordx4 v[36:39], v76, s[8:11], s60 offen offset:0 sc1
  buffer_load_dwordx4 v[40:43], v76, s[8:11], s60 offen offset:1024 sc1
  s_waitcnt lgkmcnt(0)
  s_waitcnt vmcnt(3)
  v_mfma_f32_16x16x32_bf16 v[4:7], v[0:3], v[52:55], 0
  v_bitop3_b32 v72, v52, v54, s72 bitop3:0x7e
  s_waitcnt vmcnt(2)
  v_mfma_f32_16x16x32_bf16 v[4:7], v[0:3], v[56:59], v[4:7]
  v_bitop3_b32 v73, v56, v58, s72 bitop3:0x7e
  v_bitop3_b32 v72, v72, v73, 1 bitop3:0xa8
  v_cmp_ne_u32 vcc, 0, v72
  s_nop 0
  s_cmp_eq_u64 vcc, 0
  s_cselect_b32 s54, s62, 268435456
  s_nop 0
  v_add_f32_dpp v4, v4, v4 row_ror:4 row_mask:0xf bank_mask:0xf
  v_add_f32_dpp v5, v5, v5 row_ror:4 row_mask:0xf bank_mask:0xf
  s_nop 0
  v_add_f32_dpp v4, v4, v4 row_ror:8 row_mask:0xf bank_mask:0xf
  v_add_f32_dpp v5, v5, v5 row_ror:8 row_mask:0xf bank_mask:0xf
  v_cvt_pk_bf16_f32 v4, v4, v5
  buffer_store_dword v4, v69, s[8:11], s54 offen
  s_cbranch_vccnz Cf2_h1r
  s_xor_b32 s62, s62, 16384
  buffer_store_dword v71, v69, s[8:11], s62 offen
  s_xor_b32 s72, s72, 1
  s_branch Cf2_h2
Cf2_h1r:
  s_mov_b64 exec, vcc
  buffer_load_dwordx4 v[52:55], v76, s[8:11], s60 offen offset:0 sc1
  buffer_load_dwordx4 v[56:59], v76, s[8:11], s60 offen offset:1024 sc1
  s_mov_b64 exec, -1
  s_add_u32 s67, s67, 1
  s_waitcnt vmcnt(4)
  v_mfma_f32_16x16x32_bf16 v[4:7], v[0:3], v[36:39], 0
  v_bitop3_b32 v72, v36, v38, s72 bitop3:0x7e
  s_waitcnt vmcnt(3)
  v_mfma_f32_16x16x32_bf16 v[4:7], v[0:3], v[40:43], v[4:7]
  v_bitop3_b32 v73, v40, v42, s72 bitop3:0x7e
  v_bitop3_b32 v72, v72, v73, 1 bitop3:0xa8
  v_cmp_ne_u32 vcc, 0, v72
  s_cbranch_vccz Cf2_h1p
  s_mov_b64 exec, vcc
  buffer_load_dwordx4 v[36:39], v76, s[8:11], s60 offen offset:0 sc1
  buffer_load_dwordx4 v[40:43], v76, s[8:11], s60 offen offset:1024 sc1
  s_mov_b64 exec, -1
  s_add_u32 s67, s67, 1
  s_waitcnt vmcnt(3)
  v_mfma_f32_16x16x32_bf16 v[4:7], v[0:3], v[52:55], 0
  v_bitop3_b32 v72, v52, v54, s72 bitop3:0x7e
  s_waitcnt vmcnt(2)
  v_mfma_f32_16x16x32_bf16 v[4:7], v[0:3], v[56:59], v[4:7]
  v_bitop3_b32 v73, v56, v58, s72 bitop3:0x7e
  v_bitop3_b32 v72, v72, v73, 1 bitop3:0xa8
  v_cmp_ne_u32 vcc, 0, v72
  s_cbranch_vccz Cf2_h1p
Cf2_h1s:
  s_mov_b64 exec, vcc
  buffer_load_dwordx4 v[52:55], v76, s[8:11], s60 offen offset:0 sc1
  buffer_load_dwordx4 v[56:59], v76, s[8:11], s60 offen offset:1024 sc1
  s_mov_b64 exec, -1
  s_add_u32 s67, s67, 1
  s_waitcnt vmcnt(3)
  v_mfma_f32_16x16x32_bf16 v[4:7], v[0:3], v[36:39], 0
  v_bitop3_b32 v72, v36, v38, s72 bitop3:0x7e
  s_waitcnt vmcnt(2)
  v_mfma_f32_16x16x32_bf16 v[4:7], v[0:3], v[40:43], v[4:7]
  v_bitop3_b32 v73, v40, v42, s72 bitop3:0x7e
  v_bitop3_b32 v72, v72, v73, 1 bitop3:0xa8
  v_cmp_ne_u32 vcc, 0, v72
  s_cbranch_vccz Cf2_h1p
  s_mov_b64 exec, vcc
  buffer_load_dwordx4 v[36:39], v76, s[8:11], s60 offen offset:0 sc1
  buffer_load_dwordx4 v[40:43], v76, s[8:11], s60 offen offset:1024 sc1
  s_mov_b64 exec, -1
  s_add_u32 s67, s67, 1
  s_waitcnt vmcnt(3)
  v_mfma_f32_16x16x32_bf16 v[4:7], v[0:3], v[52:55], 0
  v_bitop3_b32 v72, v52, v54, s72 bitop3:0x7e
  s_waitcnt vmcnt(2)
  v_mfma_f32_16x16x32_bf16 v[4:7], v[0:3], v[56:59], v[4:7]
  v_bitop3_b32 v73, v56, v58, s72 bitop3:0x7e
  v_bitop3_b32 v72, v72, v73, 1 bitop3:0xa8
  v_cmp_ne_u32 vcc, 0, v72
  s_cbranch_vccz Cf2_h1p
  s_cmp_lt_u32 s67, 131072
  s_cbranch_scc1 Cf2_h1s
Cf2_h1p:
  s_nop 2
  v_add_f32_dpp v4, v4, v4 row_ror:4 row_mask:0xf bank_mask:0xf
  v_add_f32_dpp v5, v5, v5 row_ror:4 row_mask:0xf bank_mask:0xf
  s_nop 0
  v_add_f32_dpp v4, v4, v4 row_ror:8 row_mask:0xf bank_mask:0xf
  v_add_f32_dpp v5, v5, v5 row_ror:8 row_mask:0xf bank_mask:0xf
  v_cvt_pk_bf16_f32 v4, v4, v5
  buffer_store_dword v4, v69, s[8:11], s62 offen
  s_xor_b32 s62, s62, 16384
  buffer_store_dword v71, v69, s[8:11], s62 offen
  s_xor_b32 s72, s72, 1
  s_branch Cf2_h2
Cf2_h2r:
  s_mov_b64 exec, vcc
  buffer_load_dwordx4 v[52:55], v76, s[8:11], s65 offen offset:3072 sc1
  s_mov_b64 exec, -1
  s_add_u32 s67, s67, 1
  s_waitcnt vmcnt(2)
  v_max3_u32 v72, v52, v53, v54
  v_max_u32 v72, v72, v55
  ds_write_b128 v76, v[52:55] offset:7680
  v_cmp_eq_u32 vcc, -1, v72
  s_cbranch_vccz Cf2_h2w
  s_mov_b64 exec, vcc
  buffer_load_dwordx4 v[52:55], v76, s[8:11], s65 offen offset:3072 sc1
  s_mov_b64 exec, -1
  s_add_u32 s67, s67, 1
  s_waitcnt vmcnt(2)
  v_max3_u32 v72, v52, v53, v54
  v_max_u32 v72, v72, v55
  ds_write_b128 v76, v[52:55] offset:7680
  v_cmp_eq_u32 vcc, -1, v72
  s_cbranch_vccz Cf2_h2w
  s_mov_b64 exec, vcc
  buffer_load_dwordx4 v[52:55], v76, s[8:11], s65 offen offset:3072 sc1
  s_mov_b64 exec, -1
  s_add_u32 s67, s67, 1
  s_waitcnt vmcnt(2)
  v_max3_u32 v72, v52, v53, v54
  v_max_u32 v72, v72, v55
  ds_write_b128 v76, v[52:55] offset:7680
  v_cmp_eq_u32 vcc, -1, v72
  s_cbranch_vccz Cf2_h2w
  s_mov_b64 exec, vcc
  buffer_load_dwordx4 v[52:55], v76, s[8:11], s65 offen offset:3072 sc1
  s_mov_b64 exec, -1
  s_add_u32 s67, s67, 1
  s_waitcnt vmcnt(2)
  v_max3_u32 v72, v52, v53, v54
  v_max_u32 v72, v72, v55
  ds_write_b128 v76, v[52:55] offset:7680
  v_cmp_eq_u32 vcc, -1, v72
  s_cbranch_vccz Cf2_h2w
  s_cmp_lt_u32 s67, 131072
  s_cbranch_scc1 Cf2_h2r
Cf2_h2ok:
  ds_write_b128 v76, v[52:55] offset:7680
  s_branch Cf2_h2w
Cf2_rec:
  s_nop 7
  s_waitcnt vmcnt(0) lgkmcnt(0)
  v_max3_u32 v72, v0, v1, v2
  v_max3_u32 v72, v72, v3, v4
  v_max3_u32 v72, v72, v5, v6
  v_max3_u32 v72, v72, v7, v8
  v_max3_u32 v72, v72, v9, v10
  v_max3_u32 v72, v72, v11, v12
  v_max3_u32 v72, v72, v13, v14
  v_max3_u32 v72, v72, v15, v16
  v_max3_u32 v72, v72, v17, v18
  v_max_u32 v72, v72, v19
  v_cmp_eq_u32 vcc, -1, v72
  s_cbranch_vccz Cf2_recok
  s_barrier
Cf2_recp:
  buffer_load_dwordx4 v[0:3], v76, s[8:11], s64 offen offset:0 sc1
  buffer_load_dwordx4 v[4:7], v76, s[8:11], s64 offen offset:1024 sc1
  s_add_u32 s67, s67, 1
  s_cmp_lt_u32 s67, 131072
  s_cselect_b32 s54, -2, -1
  s_waitcnt vmcnt(1)
  v_max3_u32 v72, v0, v1, v2
  s_waitcnt vmcnt(0)
  v_max3_u32 v72, v72, v3, v4
  v_max3_u32 v72, v72, v5, v6
  v_max_u32 v72, v72, v7
  v_cmp_lt_u32 vcc, s54, v72
  s_cbranch_vccnz Cf2_recp
  ds_write_b128 v76, v[0:3] offset:8704
  ds_write_b128 v76, v[4:7] offset:9728
  v_mov_b64 v[20:21], 0
  v_mov_b64 v[22:23], 0
  v_mov_b64 v[24:25], 0
  v_mov_b64 v[26:27], 0
  v_mov_b64 v[28:29], 0
  v_mov_b64 v[30:31], 0
  v_mov_b64 v[32:33], 0
  v_mov_b64 v[34:35], 0
  s_waitcnt lgkmcnt(0)
  s_barrier
  ds_read_b128 v[0:3], v76 offset:4608
  ds_read_b128 v[60:63], v76 offset:24576
  ds_read_b128 v[64:67], v76 offset:25600
  s_waitcnt lgkmcnt(0)
  v_smfmac_f32_16x16x64_bf16 v[20:23], v[0:3], v[60:67], v74
  ds_read_b128 v[60:63], v76 offset:26624
  ds_read_b128 v[64:67], v76 offset:27648
  s_waitcnt lgkmcnt(0)
  v_smfmac_f32_16x16x64_bf16 v[24:27], v[0:3], v[60:67], v74
  ds_read_b128 v[60:63], v76 offset:40960
  ds_read_b128 v[64:67], v76 offset:41984
  s_waitcnt lgkmcnt(0)
  v_smfmac_f32_16x16x64_bf16 v[28:31], v[0:3], v[60:67], v74
  ds_read_b128 v[60:63], v76 offset:43008
  ds_read_b128 v[64:67], v76 offset:44032
  s_waitcnt lgkmcnt(0)
  v_smfmac_f32_16x16x64_bf16 v[32:35], v[0:3], v[60:67], v74
  ds_read_b128 v[4:7], v76 offset:5632
  s_waitcnt lgkmcnt(0)
  v_smfmac_f32_16x16x64_bf16 v[20:23], v[4:7], v[80:87], v74
  v_smfmac_f32_16x16x64_bf16 v[24:27], v[4:7], v[88:95], v74
  v_smfmac_f32_16x16x64_bf16 v[28:31], v[4:7], v[208:215], v74
  v_smfmac_f32_16x16x64_bf16 v[32:35], v[4:7], v[216:223], v74
  ds_read_b128 v[8:11], v76 offset:6656
  s_waitcnt lgkmcnt(0)
  v_smfmac_f32_16x16x64_bf16 v[20:23], v[8:11], v[96:103], v74
  v_smfmac_f32_16x16x64_bf16 v[24:27], v[8:11], v[104:111], v74
  ds_read_b128 v[60:63], v76 offset:57344
  ds_read_b128 v[64:67], v76 offset:58368
  s_waitcnt lgkmcnt(0)
  v_smfmac_f32_16x16x64_bf16 v[28:31], v[8:11], v[60:67], v74
  ds_read_b128 v[60:63], v76 offset:59392
  ds_read_b128 v[64:67], v76 offset:60416
  s_waitcnt lgkmcnt(0)
  v_smfmac_f32_16x16x64_bf16 v[32:35], v[8:11], v[60:67], v74
  ds_read_b128 v[12:15], v76 offset:7680
  s_waitcnt lgkmcnt(0)
  v_smfmac_f32_16x16x64_bf16 v[20:23], v[12:15], v[112:119], v74
  v_smfmac_f32_16x16x64_bf16 v[24:27], v[12:15], v[120:127], v74
  v_smfmac_f32_16x16x64_bf16 v[28:31], v[12:15], v[224:231], v74
  v_smfmac_f32_16x16x64_bf16 v[32:35], v[12:15], v[232:239], v74
  ds_read_b128 v[0:3], v76 offset:8704
  s_waitcnt lgkmcnt(0)
  v_smfmac_f32_16x16x64_bf16 v[20:23], v[0:3], v[128:135], v74
  v_smfmac_f32_16x16x64_bf16 v[24:27], v[0:3], v[136:143], v74
  ds_read_b128 v[60:63], v75 offset:8192
  ds_read_b128 v[64:67], v75 offset:9216
  s_waitcnt lgkmcnt(0)
  v_smfmac_f32_16x16x64_bf16 v[28:31], v[0:3], v[60:67], v74
  ds_read_b128 v[60:63], v75 offset:10240
  ds_read_b128 v[64:67], v75 offset:11264
  s_waitcnt lgkmcnt(0)
  v_smfmac_f32_16x16x64_bf16 v[32:35], v[0:3], v[60:67], v74
  ds_read_b128 v[4:7], v76 offset:9728
  s_waitcnt lgkmcnt(0)
  v_smfmac_f32_16x16x64_bf16 v[20:23], v[4:7], v[144:151], v74
  v_smfmac_f32_16x16x64_bf16 v[24:27], v[4:7], v[152:159], v74
  ds_read_b128 v[60:63], v75 offset:24576
  ds_read_b128 v[64:67], v75 offset:25600
  s_waitcnt lgkmcnt(0)
  v_smfmac_f32_16x16x64_bf16 v[28:31], v[4:7], v[60:67], v74
  ds_read_b128 v[60:63], v75 offset:26624
  ds_read_b128 v[64:67], v75 offset:27648
  s_waitcnt lgkmcnt(0)
  v_smfmac_f32_16x16x64_bf16 v[32:35], v[4:7], v[60:67], v74
  ds_read_b128 v[16:19], v76 offset:10752
  s_waitcnt lgkmcnt(0)
  v_smfmac_f32_16x16x64_bf16 v[20:23], v[16:19], v[160:167], v74
  v_smfmac_f32_16x16x64_bf16 v[24:27], v[16:19], v[168:175], v74
  v_smfmac_f32_16x16x64_bf16 v[28:31], v[16:19], v[240:247], v74
  v_smfmac_f32_16x16x64_bf16 v[32:35], v[16:19], v[248:255], v74
  ds_read_b128 v[12:15], v76 offset:11776
  s_waitcnt lgkmcnt(0)
  v_smfmac_f32_16x16x64_bf16 v[20:23], v[12:15], v[176:183], v74
  v_smfmac_f32_16x16x64_bf16 v[24:27], v[12:15], v[184:191], v74
  v_smfmac_f32_16x16x64_bf16 v[28:31], v[12:15], a[0:7], v74
  v_smfmac_f32_16x16x64_bf16 v[32:35], v[12:15], a[8:15], v74
  ds_read_b128 v[8:11], v76 offset:12800
  s_waitcnt lgkmcnt(0)
  v_smfmac_f32_16x16x64_bf16 v[20:23], v[8:11], v[192:199], v74
  v_smfmac_f32_16x16x64_bf16 v[24:27], v[8:11], v[200:207], v74
  v_smfmac_f32_16x16x64_bf16 v[28:31], v[8:11], a[16:23], v74
  v_smfmac_f32_16x16x64_bf16 v[32:35], v[8:11], a[24:31], v74
  v_add_f32 v20, v20, v22
  v_add_f32 v21, v21, v23
  v_add_f32 v24, v24, v26
  v_cvt_pk_bf16_f32 v22, v20, v24
  s_nop 0
  ds_write_b32 v79, v22 offset:0
  v_add_f32 v25, v25, v27
  v_cvt_pk_bf16_f32 v23, v21, v25
  ds_write_b32 v79, v23 offset:576
  v_add_f32 v28, v28, v30
  v_add_f32 v29, v29, v31
  s_waitcnt lgkmcnt(0)
  s_nop 1
  s_branch Cf2_recok
Cf2_mx:
  s_waitcnt lgkmcnt(0)
  s_barrier
  buffer_load_dwordx4 v[0:3], v76, s[8:11], s58 offen offset:0 sc1
  ds_read_b128 v[20:23], v77 offset:0
  ds_read_b128 v[28:31], v77 offset:256
  buffer_load_dwordx4 v[4:7], v76, s[8:11], s58 offen offset:1024 sc1
  ds_read_b128 v[24:27], v77 offset:128
  ds_read_b128 v[32:35], v77 offset:384
  s_waitcnt vmcnt(1) lgkmcnt(3)
  v_mfma_f32_16x16x32_bf16 v[8:11], v[0:3], v[20:23], 0
  s_waitcnt vmcnt(0) lgkmcnt(1)
  v_mfma_f32_16x16x32_bf16 v[8:11], v[4:7], v[24:27], v[8:11]
  v_mfma_f32_16x16x32_bf16 v[12:15], v[28:31], v[20:23], 0
  s_waitcnt lgkmcnt(0)
  v_mfma_f32_16x16x32_bf16 v[12:15], v[32:35], v[24:27], v[12:15]
  v_add_f32_dpp v8, v10, v8 quad_perm:[2,3,0,1] row_mask:0xf bank_mask:0xf
  v_add_f32_dpp v9, v11, v9 quad_perm:[2,3,0,1] row_mask:0xf bank_mask:0xf
  s_nop 0
  v_mov_b32_dpp v8, v8 quad_perm:[0,1,0,1] row_mask:0xf bank_mask:0xf
  v_mov_b32_dpp v9, v9 quad_perm:[0,1,0,1] row_mask:0xf bank_mask:0xf
  s_nop 1
  v_add_f32_dpp v12, v14, v12 quad_perm:[2,3,0,1] row_mask:0xf bank_mask:0xf
  v_add_f32_dpp v13, v15, v13 quad_perm:[2,3,0,1] row_mask:0xf bank_mask:0xf
  s_nop 0
  v_mov_b32_dpp v12, v12 quad_perm:[0,1,0,1] row_mask:0xf bank_mask:0xf
  v_mov_b32_dpp v13, v13 quad_perm:[0,1,0,1] row_mask:0xf bank_mask:0xf
  v_mul_f32 v12, s69, v12
  ds_write_b32 v78, v8 offset:8712
  v_mul_f32 v13, s69, v13
  ds_write_b32 v78, v9 offset:8776
  s_waitcnt lgkmcnt(0)
  s_barrier
  ds_read_b128 v[36:39], v78 offset:8704
  ds_read_b128 v[40:43], v78 offset:8768
  s_waitcnt lgkmcnt(0)
  s_barrier
  v_max_f32 v16, v36, v37
  v_max3_f32 v16, v16, v38, v39
  v_max3_f32 v16, v16, v40, v41
  v_max3_f32 v16, v16, v42, v43
  v_max3_f32 v16, v16, v12, v13
  v_mov_b32 v17, v16
  s_nop 1
  v_permlane16_swap_b32 v16, v17
  v_max_f32 v16, v16, v17
  v_mov_b32 v17, v16
  s_nop 1
  v_permlane32_swap_b32 v16, v17
  v_max_f32 v16, v16, v17
  v_sub_f32 v36, v36, v16
  v_sub_f32 v37, v37, v16
  v_sub_f32 v38, v38, v16
  v_sub_f32 v39, v39, v16
  v_sub_f32 v40, v40, v16
  v_sub_f32 v41, v41, v16
  v_sub_f32 v42, v42, v16
  v_sub_f32 v43, v43, v16
  v_sub_f32 v12, v12, v16
  v_sub_f32 v13, v13, v16
  v_exp_f32 v36, v36
  v_exp_f32 v37, v37
  v_exp_f32 v38, v38
  v_exp_f32 v39, v39
  v_exp_f32 v40, v40
  v_exp_f32 v41, v41
  v_exp_f32 v42, v42
  v_exp_f32 v43, v43
  v_exp_f32 v12, v12
  v_exp_f32 v13, v13
  v_cvt_pk_bf16_f32 v32, v36, v40
  v_cvt_pk_bf16_f32 v33, v37, v41
  v_cvt_pk_bf16_f32 v34, v38, v42
  v_cvt_pk_bf16_f32 v35, v39, v43
  v_cvt_pk_bf16_f32 v28, v12, v13
  v_cvt_pk_bf16_f32 v31, v12, v13
  v_mov_b32 v29, 0
  v_mov_b32 v30, 0
  v_mov_b32 v68, 0x3f803f80
  v_mov_b32 v69, 0x3f803f80
  v_mov_b32 v70, 0x3f803f80
  v_mov_b32 v71, 0x3f803f80
  s_nop 1
  v_mfma_f32_16x16x32_bf16 v[8:11], v[32:35], v[68:71], 0
  v_mfma_f32_16x16x32_bf16 v[0:3], v[32:35], v[52:55], 0
  v_mfma_f32_16x16x32_bf16 v[4:7], v[32:35], v[56:59], 0
  v_mfma_f32_16x16x16_bf16 v[8:11], v[28:29], v[68:69], v[8:11]
  v_mfma_f32_16x16x16_bf16 v[0:3], v[28:29], v[72:73], v[0:3]
  v_mfma_f32_16x16x16_bf16 v[4:7], v[30:31], v[72:73], v[4:7]
  ds_read_b128 v[68:71], v76 offset:13824
  v_rcp_f32 v10, v8
  v_rcp_f32 v11, v9
  v_mul_f32 v0, v10, v0
  v_mul_f32 v1, v11, v1
  s_nop 0
  v_mul_f32 v4, v10, v4
  v_mul_f32 v5, v11, v5
  v_cvt_pk_bf16_f32 v2, v0, v4
  ds_write_b32 v79, v2 offset:8704
  v_cvt_pk_bf16_f32 v3, v1, v5
  ds_write_b32 v79, v3 offset:9280
  v_mov_b64 v[16:17], 0
  v_mov_b64 v[18:19], 0
  v_mov_b64 v[20:21], 0
  v_mov_b64 v[22:23], 0
  v_mov_b64 v[24:25], 0
  v_mov_b64 v[26:27], 0
  s_branch Cf2_mxok
Cf2_last:
  s_waitcnt vmcnt(0) lgkmcnt(0)
  ds_read_b64 v[16:17], v77 offset:384
  v_mov_b64 v[18:19], v[72:73]
  s_add_u32 s68, s68, 655360
  s_waitcnt lgkmcnt(0)
  buffer_store_dwordx4 v[16:19], v76, s[8:11], s68 offen sc1
  s_waitcnt vmcnt(0)
  s_barrier
  s_branch L_cexit
L_w3:
  v_mov_b64 v[20:21], 0
  v_mov_b64 v[22:23], 0
  v_mov_b64 v[24:25], 0
  v_mov_b64 v[26:27], 0
  v_mov_b64 v[28:29], 0
  v_mov_b64 v[30:31], 0
  v_mov_b64 v[32:33], 0
  v_mov_b64 v[34:35], 0
  s_mov_b32 s78, 0x3f803f80
  s_mov_b32 s79, s78
  s_mov_b32 s65, 360448
  s_mov_b32 m0, 15872
  v_lshlrev_b32 v73, 2, v76
  v_mov_b32 v72, 0
  ds_read_b128 v[60:63], v76 offset:28672
  ds_read_b128 v[64:67], v76 offset:29696
  ds_read_b128 v[44:47], v76 offset:30720
  ds_read_b128 v[48:51], v76 offset:31744
  ds_read_b128 v[36:39], v76 offset:45056
  ds_read_b128 v[40:43], v76 offset:46080
  ds_read_b128 v[0:3], v76 offset:4608
  ds_read_b128 v[4:7], v76 offset:5632
  s_branch Cf3_top2
.p2align 6
Cf3_h2:
  v_lshlrev_b32 v73, 2, v76
  s_mov_b32 m0, 10752
  s_waitcnt vmcnt(4)
  ds_read_b128 v[60:63], v76 offset:28672
  ds_read_b128 v[64:67], v76 offset:29696
  ds_read_b128 v[44:47], v76 offset:30720
  ds_read_b128 v[48:51], v76 offset:31744
  ds_read_b128 v[36:39], v76 offset:45056
  ds_read_b128 v[40:43], v76 offset:46080
  v_mov_b32 v72, s66
  s_cmp_eq_u32 s66, 12
  s_cbranch_scc1 Cf3_kv2
Cf3_h2w:
  s_waitcnt lgkmcnt(0)
  s_barrier
  ds_read_b128 v[0:3], v76 offset:4608
  ds_read_b128 v[4:7], v76 offset:5632
  buffer_load_dwordx4 v76, s[8:11], s64 offen offset:0 sc1 lds
  buffer_load_dwordx4 v76, s[8:11], s64 offen offset:1024 sc1 lds
  buffer_load_dwordx4 v76, s[8:11], s64 offen offset:2048 sc1 lds
Cf3_top2:
  ds_read_b128 v[8:11], v76 offset:6656
  s_mov_b32 m0, 15872
  s_waitcnt lgkmcnt(2)
  v_smfmac_f32_16x16x64_bf16 v[20:23], v[0:3], v[60:67], v74
  ds_read_b128 v[60:63], v76 offset:47104
  v_smfmac_f32_16x16x64_bf16 v[24:27], v[0:3], v[44:51], v74
  ds_read_b128 v[64:67], v76 offset:48128
  s_waitcnt lgkmcnt(3)
  v_smfmac_f32_16x16x64_bf16 v[20:23], v[4:7], v[80:87], v74
  buffer_load_dwordx4 v[44:47], v76, s[8:11], s58 offen offset:0 sc1
  v_smfmac_f32_16x16x64_bf16 v[28:31], v[0:3], v[36:43], v74
  ds_read_b128 v[36:39], v76 offset:61440
  v_smfmac_f32_16x16x64_bf16 v[24:27], v[4:7], v[88:95], v74
  buffer_load_dwordx4 v[48:51], v76, s[8:11], s58 offen offset:1024 sc1
  ds_read_b128 v[40:43], v76 offset:62464
  v_smfmac_f32_16x16x64_bf16 v[28:31], v[4:7], v[208:215], v74
  ds_read_b128 v[12:15], v76 offset:7680
  s_waitcnt lgkmcnt(5)
  v_smfmac_f32_16x16x64_bf16 v[32:35], v[4:7], v[216:223], v74
  buffer_load_dwordx4 v[52:55], v76, s[8:11], s59 offen offset:0 sc1
  s_waitcnt lgkmcnt(3)
  v_smfmac_f32_16x16x64_bf16 v[32:35], v[0:3], v[60:67], v74
  buffer_load_dwordx4 v[56:59], v76, s[8:11], s59 offen offset:1024 sc1
  v_smfmac_f32_16x16x64_bf16 v[20:23], v[8:11], v[96:103], v74
  ds_read_b128 v[60:63], v76 offset:63488
  v_smfmac_f32_16x16x64_bf16 v[24:27], v[8:11], v[104:111], v74
  ds_read_b128 v[64:67], v76 offset:64512
  s_waitcnt lgkmcnt(3)
  v_smfmac_f32_16x16x64_bf16 v[28:31], v[8:11], v[36:43], v74
  buffer_load_dword v73, s[8:11], s70 offen lds
  ds_read_b128 v[36:39], v75 offset:12288
  s_waitcnt lgkmcnt(3)
  v_smfmac_f32_16x16x64_bf16 v[20:23], v[12:15], v[112:119], v74
  s_waitcnt vmcnt(5)
  ds_read_b128 v[40:43], v75 offset:13312
  v_smfmac_f32_16x16x64_bf16 v[24:27], v[12:15], v[120:127], v74
  s_barrier
  ds_read_b128 v[0:3], v76 offset:8704
  v_smfmac_f32_16x16x64_bf16 v[28:31], v[12:15], v[224:231], v74
  ds_read_b128 v[4:7], v76 offset:9728
  v_smfmac_f32_16x16x64_bf16 v[32:35], v[12:15], v[232:239], v74
  s_waitcnt lgkmcnt(4)
  v_smfmac_f32_16x16x64_bf16 v[32:35], v[8:11], v[60:67], v74
  buffer_store_dwordx4 v[16:19], v76, s[8:11], s68 offen sc1
  ds_read_b128 v[60:63], v75 offset:14336
  s_waitcnt lgkmcnt(2)
  v_smfmac_f32_16x16x64_bf16 v[20:23], v[0:3], v[128:135], v74
  ds_read_b128 v[16:19], v76 offset:10752
  v_smfmac_f32_16x16x64_bf16 v[24:27], v[0:3], v[136:143], v74
  ds_read_b128 v[64:67], v75 offset:15360
  v_smfmac_f32_16x16x64_bf16 v[28:31], v[0:3], v[36:43], v74
  ds_read_b128 v[36:39], v75 offset:28672
  s_waitcnt lgkmcnt(4)
  v_smfmac_f32_16x16x64_bf16 v[20:23], v[4:7], v[144:151], v74
  ds_read_b128 v[12:15], v76 offset:11776
  v_smfmac_f32_16x16x64_bf16 v[24:27], v[4:7], v[152:159], v74
  ds_read_b128 v[40:43], v75 offset:29696
  s_waitcnt lgkmcnt(4)
  v_smfmac_f32_16x16x64_bf16 v[20:23], v[16:19], v[160:167], v74
  ds_read_b128 v[8:11], v76 offset:12800
  s_waitcnt lgkmcnt(4)
  v_smfmac_f32_16x16x64_bf16 v[32:35], v[0:3], v[60:67], v74
  ds_read_b128 v[60:63], v75 offset:30720
  v_mov_b64 v[68:69], s[78:79]
  v_smfmac_f32_16x16x64_bf16 v[24:27], v[16:19], v[168:175], v74
  ds_read_b128 v[64:67], v75 offset:31744
  s_waitcnt lgkmcnt(4)
  v_mov_b64 v[70:71], s[78:79]
  v_smfmac_f32_16x16x64_bf16 v[20:23], v[12:15], v[176:183], v74
  s_mov_b64 exec, 1
  buffer_store_dword v72, v76, s[8:11], s71 offen sc1
  s_mov_b64 exec, -1
  s_waitcnt lgkmcnt(3)
  v_smfmac_f32_16x16x64_bf16 v[28:31], v[4:7], v[36:43], v74
  s_waitcnt lgkmcnt(2)
  v_mov_b64 v[36:37], 0
  v_smfmac_f32_16x16x64_bf16 v[20:23], v[8:11], v[192:199], v74
  v_mov_b64 v[38:39], 0
  v_smfmac_f32_16x16x64_bf16 v[24:27], v[12:15], v[184:191], v74
  v_mov_b64 v[40:41], 0
  v_smfmac_f32_16x16x64_bf16 v[24:27], v[8:11], v[200:207], v74
  s_waitcnt lgkmcnt(0)
  v_add_f32 v20, v20, v22
  v_smfmac_f32_16x16x64_bf16 v[32:35], v[4:7], v[60:67], v74
  v_add_f32 v21, v21, v23
  v_smfmac_f32_16x16x64_bf16 v[28:31], v[16:19], v[240:247], v74
  v_add_f32 v24, v24, v26
  v_cvt_pk_bf16_f32 v22, v20, v24
  v_smfmac_f32_16x16x64_bf16 v[28:31], v[12:15], a[0:7], v74
  ds_write_b32 v79, v22 offset:0
  v_add_f32 v25, v25, v27
  v_cvt_pk_bf16_f32 v23, v21, v25
  v_smfmac_f32_16x16x64_bf16 v[28:31], v[8:11], a[16:23], v74
  ds_write_b32 v79, v23 offset:576
  v_cmp_u_f32 vcc, v20, v21
  v_smfmac_f32_16x16x64_bf16 v[32:35], v[16:19], v[248:255], v74
  v_mov_b64 v[42:43], 0
  v_smfmac_f32_16x16x64_bf16 v[32:35], v[12:15], a[8:15], v74
  v_add_f32 v28, v28, v30
  v_add_f32 v29, v29, v31
  v_smfmac_f32_16x16x64_bf16 v[32:35], v[8:11], a[24:31], v74
  s_cbranch_vccnz Cf3_rec
Cf3_recok:
  v_smfmac_f32_16x16x64_bf16 v[36:39], v[16:19], a[128:135], v74
  s_waitcnt lgkmcnt(0)
  s_barrier
  ds_read_b128 v[60:63], v77
  v_smfmac_f32_16x16x64_bf16 v[40:43], v[16:19], a[136:143], v74
  ds_read_b128 v[64:67], v77 offset:128
  v_add_f32 v32, v32, v34
  v_cvt_pk_bf16_f32 v30, v28, v32
  v_smfmac_f32_16x16x64_bf16 v[36:39], v[0:3], a[96:103], v74
  ds_write_b32 v79, v30 offset:256
  v_add_f32 v33, v33, v35
  v_cvt_pk_bf16_f32 v31, v29, v33
  v_smfmac_f32_16x16x64_bf16 v[40:43], v[0:3], a[104:111], v74
  ds_write_b32 v79, v31 offset:832
  v_xor_b32 v75, 0x8000, v75
  v_smfmac_f32_16x16x64_bf16 v[36:39], v[4:7], a[112:119], v74
  ds_read_b128 v[0:3], v76 offset:4608
  v_mov_b32 v29, 0
  v_smfmac_f32_16x16x64_bf16 v[40:43], v[4:7], a[120:127], v74
  s_waitcnt vmcnt(5) lgkmcnt(3)
  v_mov_b32 v30, 0
  v_mfma_f32_16x16x32_bf16 v[44:47], v[44:47], v[60:63], 0
  ds_read_b128 v[4:7], v76 offset:5632
  s_waitcnt lgkmcnt(2)
  v_mfma_f32_16x16x32_bf16 v[44:47], v[48:51], v[64:67], v[44:47]
  s_barrier
  v_smfmac_f32_16x16x64_bf16 v[36:39], v[8:11], a[160:167], v74
  ds_read_b128 v[20:23], v77 offset:256
  ds_read_b128 v[24:27], v77 offset:384
  v_smfmac_f32_16x16x64_bf16 v[40:43], v[8:11], a[168:175], v74
  ds_read_b128 v[8:11], v76 offset:6656
  v_add_f32_dpp v72, v46, v44 quad_perm:[2,3,0,1] row_mask:0xf bank_mask:0xf
  v_add_f32_dpp v73, v47, v45 quad_perm:[2,3,0,1] row_mask:0xf bank_mask:0xf
  v_smfmac_f32_16x16x64_bf16 v[36:39], v[12:15], a[144:151], v74
  s_waitcnt lgkmcnt(4)
  v_exp_f32_dpp v72, v72 quad_perm:[0,1,0,1] row_mask:0xf bank_mask:0xf
  v_smfmac_f32_16x16x64_bf16 v[40:43], v[12:15], a[152:159], v74
  ds_read_b128 v[12:15], v76 offset:7680
  v_exp_f32_dpp v73, v73 quad_perm:[0,1,0,1] row_mask:0xf bank_mask:0xf
  v_smfmac_f32_16x16x64_bf16 v[36:39], v[0:3], a[32:39], v74
  s_waitcnt lgkmcnt(2)
  v_cvt_pk_bf16_f32 v72, v72, v73
  v_mfma_f32_16x16x32_bf16 v[20:23], v[20:23], v[60:63], 0
  ds_write_b32 v78, v72 offset:524
  v_mov_b64 v[16:17], 0
  v_mfma_f32_16x16x32_bf16 v[20:23], v[24:27], v[64:67], v[20:23]
  ds_read_b128 v[44:47], v75 offset:28672
  v_mov_b64 v[18:19], 0
  v_smfmac_f32_16x16x64_bf16 v[40:43], v[0:3], a[40:47], v74
  ds_read_b128 v[48:51], v75 offset:29696
  s_waitcnt lgkmcnt(4)
  v_smfmac_f32_16x16x64_bf16 v[36:39], v[4:7], a[48:55], v74
  v_add_f32_dpp v24, v22, v20 quad_perm:[2,3,0,1] row_mask:0xf bank_mask:0xf
  v_add_f32_dpp v25, v23, v21 quad_perm:[2,3,0,1] row_mask:0xf bank_mask:0xf
  v_smfmac_f32_16x16x64_bf16 v[36:39], v[8:11], a[64:71], v74
  s_waitcnt lgkmcnt(2)
  s_barrier
  ds_read_b128 v[32:35], v78 offset:512
  v_smfmac_f32_16x16x64_bf16 v[36:39], v[12:15], a[80:87], v74
  ds_read_b128 v[60:63], v75 offset:30720
  v_mul_f32 v24, s69, v24
  v_smfmac_f32_16x16x64_bf16 v[40:43], v[4:7], a[56:63], v74
  ds_read_b128 v[64:67], v75 offset:31744
  v_mul_f32 v25, s69, v25
  v_smfmac_f32_16x16x64_bf16 v[40:43], v[8:11], a[72:79], v74
  v_exp_f32_dpp v24, v24 quad_perm:[0,1,0,1] row_mask:0xf bank_mask:0xf
  v_smfmac_f32_16x16x64_bf16 v[40:43], v[12:15], a[88:95], v74
  s_waitcnt vmcnt(3) lgkmcnt(2)
  v_exp_f32_dpp v25, v25 quad_perm:[0,1,0,1] row_mask:0xf bank_mask:0xf
  v_mfma_f32_16x16x32_bf16 v[8:11], v[32:35], v[68:71], 0
  v_add_f32 v36, v36, v38
  v_add_f32 v37, v37, v39
  v_mfma_f32_16x16x32_bf16 v[0:3], v[32:35], v[52:55], 0
  v_add_f32 v40, v40, v42
  v_add_f32 v41, v41, v43
  v_mfma_f32_16x16x32_bf16 v[4:7], v[32:35], v[56:59], 0
  v_cvt_pk_bf16_f32 v28, v24, v25
  v_cvt_pk_bf16_f32 v72, v36, v37
  v_cvt_pk_bf16_f32 v73, v40, v41
  v_mfma_f32_16x16x16_bf16 v[8:11], v[28:29], v[68:69], v[8:11]
  v_cvt_pk_bf16_f32 v31, v24, v25
  v_mov_b64 v[20:21], 0
  v_mfma_f32_16x16x16_bf16 v[0:3], v[28:29], v[72:73], v[0:3]
  ds_read_b128 v[68:71], v76 offset:13824
  v_mov_b64 v[22:23], 0
  v_mfma_f32_16x16x16_bf16 v[4:7], v[30:31], v[72:73], v[4:7]
  v_rcp_f32 v10, v8
  v_rcp_f32 v11, v9
  v_mul_f32 v0, v10, v0
  v_mul_f32 v1, v11, v1
  s_nop 0
  v_mul_f32 v4, v10, v4
  v_mul_f32 v5, v11, v5
  v_cvt_pk_bf16_f32 v2, v0, v4
  ds_write_b32 v79, v2 offset:8704
  v_cvt_pk_bf16_f32 v3, v1, v5
  ds_write_b32 v79, v3 offset:9280
  v_max3_f32 v8, v8, v9, v10
  v_max_f32 v8, v8, v11
  v_cmp_le_f32 vcc, 1317011456, v8
  v_mov_b64 v[24:25], 0
  v_mov_b64 v[26:27], 0
  s_cbranch_vccnz Cf3_mx
Cf3_mxok:
  s_waitcnt lgkmcnt(0)
  s_barrier
  ds_read_b128 v[0:3], v78 offset:8704
  ds_read_b128 v[4:7], v78 offset:8768
  ds_read_b128 v[8:11], v78 offset:8832
  ds_read_b128 v[12:15], v78 offset:8896
  s_cmp_eq_u32 s66, 63
  s_cbranch_scc1 Cf3_last
  s_waitcnt lgkmcnt(3)
  v_smfmac_f32_16x16x64_bf16 v[16:19], v[0:3], v[44:51], v74
  ds_read_b128 v[52:55], v75 offset:45056
  s_waitcnt lgkmcnt(3)
  v_smfmac_f32_16x16x64_bf16 v[16:19], v[4:7], v[60:67], v74
  ds_read_b128 v[56:59], v75 offset:46080
  s_waitcnt lgkmcnt(3)
  v_smfmac_f32_16x16x64_bf16 v[16:19], v[8:11], a[176:183], v74
  ds_read_b128 v[36:39], v75 offset:47104
  s_waitcnt lgkmcnt(3)
  v_smfmac_f32_16x16x64_bf16 v[16:19], v[12:15], a[184:191], v74
  ds_read_b128 v[40:43], v75 offset:48128
  ds_read_b128 v[44:47], v75 offset:61440
  v_smfmac_f32_16x16x64_bf16 v[20:23], v[0:3], a[192:199], v74
  ds_read_b128 v[48:51], v75 offset:62464
  ds_read_b128 v[60:63], v75 offset:63488
  v_smfmac_f32_16x16x64_bf16 v[20:23], v[4:7], a[200:207], v74
  ds_read_b128 v[64:67], v75 offset:64512
  s_waitcnt lgkmcnt(6)
  v_cvt_pk_bf16_f32 v16, v16, v17
  v_cvt_pk_bf16_f32 v17, v18, v19
  v_bfi_b32 v16, 1, s72, v16
  v_smfmac_f32_16x16x64_bf16 v[20:23], v[8:11], v[52:59], v74
  buffer_store_dwordx2 v[16:17], v68, s[8:11], s73 offen
  s_waitcnt lgkmcnt(4)
  v_smfmac_f32_16x16x64_bf16 v[20:23], v[12:15], v[36:43], v74
  ds_read_b128 v[52:55], v75 offset:8192
  v_mov_b64 v[32:33], 0
  v_smfmac_f32_16x16x64_bf16 v[24:27], v[0:3], a[208:215], v74
  ds_read_b128 v[56:59], v75 offset:9216
  v_mov_b64 v[34:35], 0
  v_smfmac_f32_16x16x64_bf16 v[24:27], v[4:7], a[216:223], v74
  ds_read_b128 v[36:39], v75 offset:10240
  s_waitcnt lgkmcnt(5)
  v_cvt_pk_bf16_f32 v20, v20, v21
  v_cvt_pk_bf16_f32 v21, v22, v23
  v_bfi_b32 v20, 1, s72, v20
  v_smfmac_f32_16x16x64_bf16 v[24:27], v[8:11], v[44:51], v74
  buffer_store_dwordx2 v[20:21], v68, s[8:11], s74 offen
  s_waitcnt lgkmcnt(3)
  v_smfmac_f32_16x16x64_bf16 v[24:27], v[12:15], v[60:67], v74
  ds_read_b128 v[40:43], v75 offset:11264
  v_mov_b64 v[28:29], 0
  v_smfmac_f32_16x16x64_bf16 v[32:35], v[0:3], a[224:231], v74
  ds_read_b128 v[44:47], v75 offset:12288
  ds_read_b128 v[48:51], v75 offset:13312
  v_smfmac_f32_16x16x64_bf16 v[32:35], v[4:7], a[232:239], v74
  ds_read_b128 v[60:63], v75 offset:14336
  v_cvt_pk_bf16_f32 v24, v24, v25
  v_cvt_pk_bf16_f32 v25, v26, v27
  v_bfi_b32 v24, 1, s72, v24
  v_smfmac_f32_16x16x64_bf16 v[32:35], v[8:11], a[240:247], v74
  buffer_store_dwordx2 v[24:25], v68, s[8:11], s75 offen
  v_mov_b64 v[30:31], 0
  v_smfmac_f32_16x16x64_bf16 v[32:35], v[12:15], a[248:255], v74
  ds_read_b128 v[64:67], v75 offset:15360
  s_waitcnt lgkmcnt(6)
  v_smfmac_f32_16x16x64_bf16 v[28:31], v[0:3], v[52:59], v74
  s_waitcnt lgkmcnt(4)
  v_smfmac_f32_16x16x64_bf16 v[28:31], v[4:7], v[36:43], v74
  s_waitcnt lgkmcnt(2)
  v_cvt_pk_bf16_f32 v32, v32, v33
  v_cvt_pk_bf16_f32 v33, v34, v35
  v_bfi_b32 v32, 1, s72, v32
  v_smfmac_f32_16x16x64_bf16 v[28:31], v[8:11], v[44:51], v74
  buffer_store_dwordx2 v[32:33], v68, s[8:11], s76 offen
  s_waitcnt lgkmcnt(0)
  v_smfmac_f32_16x16x64_bf16 v[28:31], v[12:15], v[60:67], v74
  ds_read_b128 v[52:55], v76 offset:14848
  ds_read_b64 v[16:17], v77 offset:392
  v_mov_b64 v[18:19], v[72:73]
  v_xor_b32 v75, 0x8000, v75
  s_nop 3
  v_cvt_pk_bf16_f32 v28, v28, v29
  v_cvt_pk_bf16_f32 v29, v30, v31
  v_bfi_b32 v28, 1, s72, v28
  buffer_store_dwordx2 v[28:29], v68, s[8:11], s77 offen
  v_mov_b64 v[20:21], 0
  v_mov_b64 v[22:23], 0
  v_mov_b64 v[24:25], 0
  v_mov_b64 v[26:27], 0
  v_mov_b64 v[28:29], 0
  v_mov_b64 v[30:31], 0
  v_mov_b64 v[32:33], 0
  v_mov_b64 v[34:35], 0
  s_add_u32 s58, s58, 655360
  s_add_u32 s59, s59, 655360
  s_add_u32 s70, s70, 655360
  s_add_u32 s68, s68, 655360
  s_add_u32 s66, s66, 1
  s_xor_b32 s64, s64, 16384
  s_xor_b32 s65, s65, 16384
  s_nop 15
  s_nop 15
  s_nop 15
  s_nop 9
  buffer_load_dwordx4 v[0:3], v76, s[8:11], s60 offen offset:0 sc1
  buffer_load_dwordx4 v[4:7], v76, s[8:11], s60 offen offset:1024 sc1
  buffer_load_dwordx4 v[8:11], v76, s[8:11], s61 offen offset:0 sc1
  buffer_load_dwordx4 v[12:15], v76, s[8:11], s61 offen offset:1024 sc1
  s_nop 15
  s_nop 11
  buffer_load_dwordx4 v[44:47], v76, s[8:11], s60 offen offset:0 sc1
  buffer_load_dwordx4 v[48:51], v76, s[8:11], s60 offen offset:1024 sc1
  buffer_load_dwordx4 v[60:63], v76, s[8:11], s61 offen offset:0 sc1
  buffer_load_dwordx4 v[64:67], v76, s[8:11], s61 offen offset:1024 sc1
  s_waitcnt lgkmcnt(0)
  s_cmp_eq_u32 s66, 12
  s_cbranch_scc1 Cf3_kv
Cf3_kvb:
  s_waitcnt vmcnt(7)
  v_mfma_f32_16x16x32_bf16 v[56:59], v[52:55], v[0:3], 0
  v_bitop3_b32 v72, v0, v2, s72 bitop3:0x7e
  s_waitcnt vmcnt(6)
  v_mfma_f32_16x16x32_bf16 v[56:59], v[52:55], v[4:7], v[56:59]
  v_bitop3_b32 v73, v4, v6, s72 bitop3:0x7e
  v_or_b32 v72, v72, v73
  s_waitcnt vmcnt(5)
  v_mfma_f32_16x16x32_bf16 v[36:39], v[52:55], v[8:11], 0
  v_bitop3_b32 v73, v8, v10, s72 bitop3:0x7e
  v_or_b32 v72, v72, v73
  s_waitcnt vmcnt(4)
  v_mfma_f32_16x16x32_bf16 v[36:39], v[52:55], v[12:15], v[36:39]
  v_bitop3_b32 v73, v12, v14, s72 bitop3:0x7e
  v_bitop3_b32 v72, v72, v73, 1 bitop3:0xa8
  v_cmp_ne_u32 vcc, 0, v72
  s_nop 0
  s_cmp_eq_u64 vcc, 0
  s_cselect_b32 s54, s62, 268435456
  s_cselect_b32 s55, s63, 268435456
  v_add_f32_dpp v56, v56, v56 row_ror:4 row_mask:0xf bank_mask:0xf
  v_add_f32_dpp v57, v57, v57 row_ror:4 row_mask:0xf bank_mask:0xf
  v_add_f32_dpp v36, v36, v36 row_ror:4 row_mask:0xf bank_mask:0xf
  v_add_f32_dpp v37, v37, v37 row_ror:4 row_mask:0xf bank_mask:0xf
  v_add_f32_dpp v56, v56, v56 row_ror:8 row_mask:0xf bank_mask:0xf
  v_add_f32_dpp v57, v57, v57 row_ror:8 row_mask:0xf bank_mask:0xf
  v_add_f32_dpp v36, v36, v36 row_ror:8 row_mask:0xf bank_mask:0xf
  v_add_f32_dpp v37, v37, v37 row_ror:8 row_mask:0xf bank_mask:0xf
  v_cvt_pk_bf16_f32 v56, v56, v57
  buffer_store_dword v56, v69, s[8:11], s54 offen
  v_cvt_pk_bf16_f32 v36, v36, v37
  buffer_store_dword v36, v70, s[8:11], s55 offen
  s_cbranch_vccnz Cf3_h1r
  s_xor_b32 s62, s62, 16384
  buffer_store_dword v71, v69, s[8:11], s62 offen
  s_xor_b32 s63, s63, 16384
  buffer_store_dword v71, v70, s[8:11], s63 offen
  s_xor_b32 s72, s72, 1
  s_branch Cf3_h2
Cf3_h1r:
  s_mov_b64 exec, vcc
  buffer_load_dwordx4 v[0:3], v76, s[8:11], s60 offen offset:0 sc1
  buffer_load_dwordx4 v[4:7], v76, s[8:11], s60 offen offset:1024 sc1
  buffer_load_dwordx4 v[8:11], v76, s[8:11], s61 offen offset:0 sc1
  buffer_load_dwordx4 v[12:15], v76, s[8:11], s61 offen offset:1024 sc1
  s_mov_b64 exec, -1
  s_add_u32 s67, s67, 1
  s_waitcnt vmcnt(9)
  v_mfma_f32_16x16x32_bf16 v[56:59], v[52:55], v[44:47], 0
  v_bitop3_b32 v72, v44, v46, s72 bitop3:0x7e
  s_waitcnt vmcnt(8)
  v_mfma_f32_16x16x32_bf16 v[56:59], v[52:55], v[48:51], v[56:59]
  v_bitop3_b32 v73, v48, v50, s72 bitop3:0x7e
  v_or_b32 v72, v72, v73
  s_waitcnt vmcnt(7)
  v_mfma_f32_16x16x32_bf16 v[36:39], v[52:55], v[60:63], 0
  v_bitop3_b32 v73, v60, v62, s72 bitop3:0x7e
  v_or_b32 v72, v72, v73
  s_waitcnt vmcnt(6)
  v_mfma_f32_16x16x32_bf16 v[36:39], v[52:55], v[64:67], v[36:39]
  v_bitop3_b32 v73, v64, v66, s72 bitop3:0x7e
  v_bitop3_b32 v72, v72, v73, 1 bitop3:0xa8
  v_cmp_ne_u32 vcc, 0, v72
  s_cbranch_vccz Cf3_h1p
  s_mov_b64 exec, vcc
  buffer_load_dwordx4 v[44:47], v76, s[8:11], s60 offen offset:0 sc1
  buffer_load_dwordx4 v[48:51], v76, s[8:11], s60 offen offset:1024 sc1
  buffer_load_dwordx4 v[60:63], v76, s[8:11], s61 offen offset:0 sc1
  buffer_load_dwordx4 v[64:67], v76, s[8:11], s61 offen offset:1024 sc1
  s_mov_b64 exec, -1
  s_add_u32 s67, s67, 1
  s_waitcnt vmcnt(7)
  v_mfma_f32_16x16x32_bf16 v[56:59], v[52:55], v[0:3], 0
  v_bitop3_b32 v72, v0, v2, s72 bitop3:0x7e
  s_waitcnt vmcnt(6)
  v_mfma_f32_16x16x32_bf16 v[56:59], v[52:55], v[4:7], v[56:59]
  v_bitop3_b32 v73, v4, v6, s72 bitop3:0x7e
  v_or_b32 v72, v72, v73
  s_waitcnt vmcnt(5)
  v_mfma_f32_16x16x32_bf16 v[36:39], v[52:55], v[8:11], 0
  v_bitop3_b32 v73, v8, v10, s72 bitop3:0x7e
  v_or_b32 v72, v72, v73
  s_waitcnt vmcnt(4)
  v_mfma_f32_16x16x32_bf16 v[36:39], v[52:55], v[12:15], v[36:39]
  v_bitop3_b32 v73, v12, v14, s72 bitop3:0x7e
  v_bitop3_b32 v72, v72, v73, 1 bitop3:0xa8
  v_cmp_ne_u32 vcc, 0, v72
  s_cbranch_vccz Cf3_h1p
Cf3_h1s:
  s_mov_b64 exec, vcc
  buffer_load_dwordx4 v[0:3], v76, s[8:11], s60 offen offset:0 sc1
  buffer_load_dwordx4 v[4:7], v76, s[8:11], s60 offen offset:1024 sc1
  buffer_load_dwordx4 v[8:11], v76, s[8:11], s61 offen offset:0 sc1
  buffer_load_dwordx4 v[12:15], v76, s[8:11], s61 offen offset:1024 sc1
  s_mov_b64 exec, -1
  s_add_u32 s67, s67, 1
  s_waitcnt vmcnt(7)
  v_mfma_f32_16x16x32_bf16 v[56:59], v[52:55], v[44:47], 0
  v_bitop3_b32 v72, v44, v46, s72 bitop3:0x7e
  s_waitcnt vmcnt(6)
  v_mfma_f32_16x16x32_bf16 v[56:59], v[52:55], v[48:51], v[56:59]
  v_bitop3_b32 v73, v48, v50, s72 bitop3:0x7e
  v_or_b32 v72, v72, v73
  s_waitcnt vmcnt(5)
  v_mfma_f32_16x16x32_bf16 v[36:39], v[52:55], v[60:63], 0
  v_bitop3_b32 v73, v60, v62, s72 bitop3:0x7e
  v_or_b32 v72, v72, v73
  s_waitcnt vmcnt(4)
  v_mfma_f32_16x16x32_bf16 v[36:39], v[52:55], v[64:67], v[36:39]
  v_bitop3_b32 v73, v64, v66, s72 bitop3:0x7e
  v_bitop3_b32 v72, v72, v73, 1 bitop3:0xa8
  v_cmp_ne_u32 vcc, 0, v72
  s_cbranch_vccz Cf3_h1p
  s_mov_b64 exec, vcc
  buffer_load_dwordx4 v[44:47], v76, s[8:11], s60 offen offset:0 sc1
  buffer_load_dwordx4 v[48:51], v76, s[8:11], s60 offen offset:1024 sc1
  buffer_load_dwordx4 v[60:63], v76, s[8:11], s61 offen offset:0 sc1
  buffer_load_dwordx4 v[64:67], v76, s[8:11], s61 offen offset:1024 sc1
  s_mov_b64 exec, -1
  s_add_u32 s67, s67, 1
  s_waitcnt vmcnt(7)
  v_mfma_f32_16x16x32_bf16 v[56:59], v[52:55], v[0:3], 0
  v_bitop3_b32 v72, v0, v2, s72 bitop3:0x7e
  s_waitcnt vmcnt(6)
  v_mfma_f32_16x16x32_bf16 v[56:59], v[52:55], v[4:7], v[56:59]
  v_bitop3_b32 v73, v4, v6, s72 bitop3:0x7e
  v_or_b32 v72, v72, v73
  s_waitcnt vmcnt(5)
  v_mfma_f32_16x16x32_bf16 v[36:39], v[52:55], v[8:11], 0
  v_bitop3_b32 v73, v8, v10, s72 bitop3:0x7e
  v_or_b32 v72, v72, v73
  s_waitcnt vmcnt(4)
  v_mfma_f32_16x16x32_bf16 v[36:39], v[52:55], v[12:15], v[36:39]
  v_bitop3_b32 v73, v12, v14, s72 bitop3:0x7e
  v_bitop3_b32 v72, v72, v73, 1 bitop3:0xa8
  v_cmp_ne_u32 vcc, 0, v72
  s_cbranch_vccz Cf3_h1p
  s_cmp_lt_u32 s67, 131072
  s_cbranch_scc1 Cf3_h1s
Cf3_h1p:
  s_nop 2
  v_add_f32_dpp v56, v56, v56 row_ror:4 row_mask:0xf bank_mask:0xf
  v_add_f32_dpp v57, v57, v57 row_ror:4 row_mask:0xf bank_mask:0xf
  v_add_f32_dpp v36, v36, v36 row_ror:4 row_mask:0xf bank_mask:0xf
  v_add_f32_dpp v37, v37, v37 row_ror:4 row_mask:0xf bank_mask:0xf
  v_add_f32_dpp v56, v56, v56 row_ror:8 row_mask:0xf bank_mask:0xf
  v_add_f32_dpp v57, v57, v57 row_ror:8 row_mask:0xf bank_mask:0xf
  v_add_f32_dpp v36, v36, v36 row_ror:8 row_mask:0xf bank_mask:0xf
  v_add_f32_dpp v37, v37, v37 row_ror:8 row_mask:0xf bank_mask:0xf
  v_cvt_pk_bf16_f32 v56, v56, v57
  buffer_store_dword v56, v69, s[8:11], s62 offen
  v_cvt_pk_bf16_f32 v36, v36, v37
  buffer_store_dword v36, v70, s[8:11], s63 offen
  s_xor_b32 s62, s62, 16384
  buffer_store_dword v71, v69, s[8:11], s62 offen
  s_xor_b32 s63, s63, 16384
  buffer_store_dword v71, v70, s[8:11], s63 offen
  s_xor_b32 s72, s72, 1
  s_branch Cf3_h2
Cf3_rec:
  s_nop 7
  s_waitcnt vmcnt(0) lgkmcnt(0)
  v_max3_u32 v72, v0, v1, v2
  v_max3_u32 v72, v72, v3, v4
  v_max3_u32 v72, v72, v5, v6
  v_max3_u32 v72, v72, v7, v8
  v_max3_u32 v72, v72, v9, v10
  v_max3_u32 v72, v72, v11, v12
  v_max3_u32 v72, v72, v13, v14
  v_max3_u32 v72, v72, v15, v16
  v_max3_u32 v72, v72, v17, v18
  v_max_u32 v72, v72, v19
  v_cmp_eq_u32 vcc, -1, v72
  s_cbranch_vccz Cf3_recok
  s_barrier
Cf3_recp:
  buffer_load_dwordx4 v[0:3], v76, s[8:11], s64 offen offset:0 sc1
  buffer_load_dwordx4 v[4:7], v76, s[8:11], s64 offen offset:1024 sc1
  buffer_load_dwordx4 v[8:11], v76, s[8:11], s64 offen offset:2048 sc1
  s_add_u32 s67, s67, 1
  s_cmp_lt_u32 s67, 131072
  s_cselect_b32 s54, -2, -1
  s_waitcnt vmcnt(2)
  v_max3_u32 v72, v0, v1, v2
  s_waitcnt vmcnt(1)
  v_max3_u32 v72, v72, v3, v4
  v_max3_u32 v72, v72, v5, v6
  s_waitcnt vmcnt(0)
  v_max3_u32 v72, v72, v7, v8
  v_max3_u32 v72, v72, v9, v10
  v_max_u32 v72, v72, v11
  v_cmp_lt_u32 vcc, s54, v72
  s_cbranch_vccnz Cf3_recp
  ds_write_b128 v76, v[0:3] offset:10752
  ds_write_b128 v76, v[4:7] offset:11776
  ds_write_b128 v76, v[8:11] offset:12800
  v_mov_b64 v[20:21], 0
  v_mov_b64 v[22:23], 0
  v_mov_b64 v[24:25], 0
  v_mov_b64 v[26:27], 0
  v_mov_b64 v[28:29], 0
  v_mov_b64 v[30:31], 0
  v_mov_b64 v[32:33], 0
  v_mov_b64 v[34:35], 0
  s_waitcnt lgkmcnt(0)
  s_barrier
  ds_read_b128 v[0:3], v76 offset:4608
  ds_read_b128 v[60:63], v76 offset:28672
  ds_read_b128 v[64:67], v76 offset:29696
  s_waitcnt lgkmcnt(0)
  v_smfmac_f32_16x16x64_bf16 v[20:23], v[0:3], v[60:67], v74
  ds_read_b128 v[60:63], v76 offset:30720
  ds_read_b128 v[64:67], v76 offset:31744
  s_waitcnt lgkmcnt(0)
  v_smfmac_f32_16x16x64_bf16 v[24:27], v[0:3], v[60:67], v74
  ds_read_b128 v[60:63], v76 offset:45056
  ds_read_b128 v[64:67], v76 offset:46080
  s_waitcnt lgkmcnt(0)
  v_smfmac_f32_16x16x64_bf16 v[28:31], v[0:3], v[60:67], v74
  ds_read_b128 v[60:63], v76 offset:47104
  ds_read_b128 v[64:67], v76 offset:48128
  s_waitcnt lgkmcnt(0)
  v_smfmac_f32_16x16x64_bf16 v[32:35], v[0:3], v[60:67], v74
  ds_read_b128 v[4:7], v76 offset:5632
  s_waitcnt lgkmcnt(0)
  v_smfmac_f32_16x16x64_bf16 v[20:23], v[4:7], v[80:87], v74
  v_smfmac_f32_16x16x64_bf16 v[24:27], v[4:7], v[88:95], v74
  v_smfmac_f32_16x16x64_bf16 v[28:31], v[4:7], v[208:215], v74
  v_smfmac_f32_16x16x64_bf16 v[32:35], v[4:7], v[216:223], v74
  ds_read_b128 v[8:11], v76 offset:6656
  s_waitcnt lgkmcnt(0)
  v_smfmac_f32_16x16x64_bf16 v[20:23], v[8:11], v[96:103], v74
  v_smfmac_f32_16x16x64_bf16 v[24:27], v[8:11], v[104:111], v74
  ds_read_b128 v[60:63], v76 offset:61440
  ds_read_b128 v[64:67], v76 offset:62464
  s_waitcnt lgkmcnt(0)
  v_smfmac_f32_16x16x64_bf16 v[28:31], v[8:11], v[60:67], v74
  ds_read_b128 v[60:63], v76 offset:63488
  ds_read_b128 v[64:67], v76 offset:64512
  s_waitcnt lgkmcnt(0)
  v_smfmac_f32_16x16x64_bf16 v[32:35], v[8:11], v[60:67], v74
  ds_read_b128 v[12:15], v76 offset:7680
  s_waitcnt lgkmcnt(0)
  v_smfmac_f32_16x16x64_bf16 v[20:23], v[12:15], v[112:119], v74
  v_smfmac_f32_16x16x64_bf16 v[24:27], v[12:15], v[120:127], v74
  v_smfmac_f32_16x16x64_bf16 v[28:31], v[12:15], v[224:231], v74
  v_smfmac_f32_16x16x64_bf16 v[32:35], v[12:15], v[232:239], v74
  ds_read_b128 v[0:3], v76 offset:8704
  s_waitcnt lgkmcnt(0)
  v_smfmac_f32_16x16x64_bf16 v[20:23], v[0:3], v[128:135], v74
  v_smfmac_f32_16x16x64_bf16 v[24:27], v[0:3], v[136:143], v74
  ds_read_b128 v[60:63], v75 offset:12288
  ds_read_b128 v[64:67], v75 offset:13312
  s_waitcnt lgkmcnt(0)
  v_smfmac_f32_16x16x64_bf16 v[28:31], v[0:3], v[60:67], v74
  ds_read_b128 v[60:63], v75 offset:14336
  ds_read_b128 v[64:67], v75 offset:15360
  s_waitcnt lgkmcnt(0)
  v_smfmac_f32_16x16x64_bf16 v[32:35], v[0:3], v[60:67], v74
  ds_read_b128 v[4:7], v76 offset:9728
  s_waitcnt lgkmcnt(0)
  v_smfmac_f32_16x16x64_bf16 v[20:23], v[4:7], v[144:151], v74
  v_smfmac_f32_16x16x64_bf16 v[24:27], v[4:7], v[152:159], v74
  ds_read_b128 v[60:63], v75 offset:28672
  ds_read_b128 v[64:67], v75 offset:29696
  s_waitcnt lgkmcnt(0)
  v_smfmac_f32_16x16x64_bf16 v[28:31], v[4:7], v[60:67], v74
  ds_read_b128 v[60:63], v75 offset:30720
  ds_read_b128 v[64:67], v75 offset:31744
  s_waitcnt lgkmcnt(0)
  v_smfmac_f32_16x16x64_bf16 v[32:35], v[4:7], v[60:67], v74
  ds_read_b128 v[16:19], v76 offset:10752
  s_waitcnt lgkmcnt(0)
  v_smfmac_f32_16x16x64_bf16 v[20:23], v[16:19], v[160:167], v74
  v_smfmac_f32_16x16x64_bf16 v[24:27], v[16:19], v[168:175], v74
  v_smfmac_f32_16x16x64_bf16 v[28:31], v[16:19], v[240:247], v74
  v_smfmac_f32_16x16x64_bf16 v[32:35], v[16:19], v[248:255], v74
  ds_read_b128 v[12:15], v76 offset:11776
  s_waitcnt lgkmcnt(0)
  v_smfmac_f32_16x16x64_bf16 v[20:23], v[12:15], v[176:183], v74
  v_smfmac_f32_16x16x64_bf16 v[24:27], v[12:15], v[184:191], v74
  v_smfmac_f32_16x16x64_bf16 v[28:31], v[12:15], a[0:7], v74
  v_smfmac_f32_16x16x64_bf16 v[32:35], v[12:15], a[8:15], v74
  ds_read_b128 v[8:11], v76 offset:12800
  s_waitcnt lgkmcnt(0)
  v_smfmac_f32_16x16x64_bf16 v[20:23], v[8:11], v[192:199], v74
  v_smfmac_f32_16x16x64_bf16 v[24:27], v[8:11], v[200:207], v74
  v_smfmac_f32_16x16x64_bf16 v[28:31], v[8:11], a[16:23], v74
  v_smfmac_f32_16x16x64_bf16 v[32:35], v[8:11], a[24:31], v74
  v_add_f32 v20, v20, v22
  v_add_f32 v21, v21, v23
  v_add_f32 v24, v24, v26
  v_cvt_pk_bf16_f32 v22, v20, v24
  s_nop 0
  ds_write_b32 v79, v22 offset:0
  v_add_f32 v25, v25, v27
  v_cvt_pk_bf16_f32 v23, v21, v25
  ds_write_b32 v79, v23 offset:576
  v_add_f32 v28, v28, v30
  v_add_f32 v29, v29, v31
  s_waitcnt lgkmcnt(0)
  s_nop 1
  s_branch Cf3_recok
Cf3_mx:
  s_waitcnt lgkmcnt(0)
  s_barrier
  buffer_load_dwordx4 v[0:3], v76, s[8:11], s58 offen offset:0 sc1
  ds_read_b128 v[20:23], v77 offset:0
  ds_read_b128 v[28:31], v77 offset:256
  buffer_load_dwordx4 v[4:7], v76, s[8:11], s58 offen offset:1024 sc1
  ds_read_b128 v[24:27], v77 offset:128
  ds_read_b128 v[32:35], v77 offset:384
  s_waitcnt vmcnt(1) lgkmcnt(3)
  v_mfma_f32_16x16x32_bf16 v[8:11], v[0:3], v[20:23], 0
  s_waitcnt vmcnt(0) lgkmcnt(1)
  v_mfma_f32_16x16x32_bf16 v[8:11], v[4:7], v[24:27], v[8:11]
  v_mfma_f32_16x16x32_bf16 v[12:15], v[28:31], v[20:23], 0
  s_waitcnt lgkmcnt(0)
  v_mfma_f32_16x16x32_bf16 v[12:15], v[32:35], v[24:27], v[12:15]
  v_add_f32_dpp v8, v10, v8 quad_perm:[2,3,0,1] row_mask:0xf bank_mask:0xf
  v_add_f32_dpp v9, v11, v9 quad_perm:[2,3,0,1] row_mask:0xf bank_mask:0xf
  s_nop 0
  v_mov_b32_dpp v8, v8 quad_perm:[0,1,0,1] row_mask:0xf bank_mask:0xf
  v_mov_b32_dpp v9, v9 quad_perm:[0,1,0,1] row_mask:0xf bank_mask:0xf
  s_nop 1
  v_add_f32_dpp v12, v14, v12 quad_perm:[2,3,0,1] row_mask:0xf bank_mask:0xf
  v_add_f32_dpp v13, v15, v13 quad_perm:[2,3,0,1] row_mask:0xf bank_mask:0xf
  s_nop 0
  v_mov_b32_dpp v12, v12 quad_perm:[0,1,0,1] row_mask:0xf bank_mask:0xf
  v_mov_b32_dpp v13, v13 quad_perm:[0,1,0,1] row_mask:0xf bank_mask:0xf
  v_mul_f32 v12, s69, v12
  ds_write_b32 v78, v8 offset:8716
  v_mul_f32 v13, s69, v13
  ds_write_b32 v78, v9 offset:8780
  s_waitcnt lgkmcnt(0)
  s_barrier
  ds_read_b128 v[36:39], v78 offset:8704
  ds_read_b128 v[40:43], v78 offset:8768
  s_waitcnt lgkmcnt(0)
  s_barrier
  v_max_f32 v16, v36, v37
  v_max3_f32 v16, v16, v38, v39
  v_max3_f32 v16, v16, v40, v41
  v_max3_f32 v16, v16, v42, v43
  v_max3_f32 v16, v16, v12, v13
  v_mov_b32 v17, v16
  s_nop 1
  v_permlane16_swap_b32 v16, v17
  v_max_f32 v16, v16, v17
  v_mov_b32 v17, v16
  s_nop 1
  v_permlane32_swap_b32 v16, v17
  v_max_f32 v16, v16, v17
  v_sub_f32 v36, v36, v16
  v_sub_f32 v37, v37, v16
  v_sub_f32 v38, v38, v16
  v_sub_f32 v39, v39, v16
  v_sub_f32 v40, v40, v16
  v_sub_f32 v41, v41, v16
  v_sub_f32 v42, v42, v16
  v_sub_f32 v43, v43, v16
  v_sub_f32 v12, v12, v16
  v_sub_f32 v13, v13, v16
  v_exp_f32 v36, v36
  v_exp_f32 v37, v37
  v_exp_f32 v38, v38
  v_exp_f32 v39, v39
  v_exp_f32 v40, v40
  v_exp_f32 v41, v41
  v_exp_f32 v42, v42
  v_exp_f32 v43, v43
  v_exp_f32 v12, v12
  v_exp_f32 v13, v13
  v_cvt_pk_bf16_f32 v32, v36, v40
  v_cvt_pk_bf16_f32 v33, v37, v41
  v_cvt_pk_bf16_f32 v34, v38, v42
  v_cvt_pk_bf16_f32 v35, v39, v43
  v_cvt_pk_bf16_f32 v28, v12, v13
  v_cvt_pk_bf16_f32 v31, v12, v13
  v_mov_b32 v29, 0
  v_mov_b32 v30, 0
  v_mov_b32 v68, 0x3f803f80
  v_mov_b32 v69, 0x3f803f80
  v_mov_b32 v70, 0x3f803f80
  v_mov_b32 v71, 0x3f803f80
  s_nop 1
  v_mfma_f32_16x16x32_bf16 v[8:11], v[32:35], v[68:71], 0
  v_mfma_f32_16x16x32_bf16 v[0:3], v[32:35], v[52:55], 0
  v_mfma_f32_16x16x32_bf16 v[4:7], v[32:35], v[56:59], 0
  v_mfma_f32_16x16x16_bf16 v[8:11], v[28:29], v[68:69], v[8:11]
  v_mfma_f32_16x16x16_bf16 v[0:3], v[28:29], v[72:73], v[0:3]
  v_mfma_f32_16x16x16_bf16 v[4:7], v[30:31], v[72:73], v[4:7]
  ds_read_b128 v[68:71], v76 offset:13824
  v_rcp_f32 v10, v8
  v_rcp_f32 v11, v9
  v_mul_f32 v0, v10, v0
  v_mul_f32 v1, v11, v1
  s_nop 0
  v_mul_f32 v4, v10, v4
  v_mul_f32 v5, v11, v5
  v_cvt_pk_bf16_f32 v2, v0, v4
  ds_write_b32 v79, v2 offset:8704
  v_cvt_pk_bf16_f32 v3, v1, v5
  ds_write_b32 v79, v3 offset:9280
  v_mov_b64 v[16:17], 0
  v_mov_b64 v[18:19], 0
  v_mov_b64 v[20:21], 0
  v_mov_b64 v[22:23], 0
  v_mov_b64 v[24:25], 0
  v_mov_b64 v[26:27], 0
  s_branch Cf3_mxok
Cf3_kv:
  s_lshl_b32 s56, s53, 2
  s_add_u32 s56, s56, 128
  s_load_dword s57, s[12:13], s56 glc
  s_branch Cf3_kvb
Cf3_kv2:
  s_waitcnt lgkmcnt(0)
  s_cmp_ge_u32 s57, 0x700
  s_cbranch_scc1 Cf3_h2w
  s_load_dword s57, s[12:13], s56 glc
  s_add_u32 s67, s67, 1
  s_cmp_lt_u32 s67, 131072
  s_cbranch_scc1 Cf3_kv2
  s_branch Cf3_h2w
Cf3_last:
  s_waitcnt vmcnt(0) lgkmcnt(0)
  ds_read_b64 v[16:17], v77 offset:392
  v_mov_b64 v[18:19], v[72:73]
  s_add_u32 s68, s68, 655360
  s_waitcnt lgkmcnt(0)
  buffer_store_dwordx4 v[16:19], v76, s[8:11], s68 offen sc1
  s_waitcnt vmcnt(0)
  s_barrier
  v_mov_b32 v72, 65
  s_mov_b64 exec, 1
  buffer_store_dword v72, v76, s[8:11], s71 offen sc1
  s_mov_b64 exec, -1
  s_branch L_cexit
L_w4:
  v_mov_b64 v[20:21], 0
  v_mov_b64 v[22:23], 0
  v_mov_b64 v[24:25], 0
  v_mov_b64 v[26:27], 0
  v_mov_b64 v[28:29], 0
  v_mov_b64 v[30:31], 0
  v_mov_b64 v[32:33], 0
  v_mov_b64 v[34:35], 0
  s_mov_b32 s78, 0x3f803f80
  s_mov_b32 s79, s78
  s_mov_b32 s65, 360448
  s_mov_b32 m0, 15872
  v_lshlrev_b32 v73, 2, v76
  v_mov_b32 v72, 0
  ds_read_b128 v[60:63], v76 offset:16384
  ds_read_b128 v[64:67], v76 offset:17408
  ds_read_b128 v[44:47], v76 offset:18432
  ds_read_b128 v[48:51], v76 offset:19456
  ds_read_b128 v[36:39], v76 offset:32768
  ds_read_b128 v[40:43], v76 offset:33792
  ds_read_b128 v[0:3], v76 offset:4608
  ds_read_b128 v[4:7], v76 offset:5632
  s_branch Cs0_top2
.p2align 6
Cs0_h2:
  v_lshlrev_b32 v73, 2, v76
  s_nop 15
  s_nop 11
  buffer_load_dwordx4 v[52:55], v76, s[8:11], s65 offen offset:0 sc1
  buffer_load_dwordx4 v[56:59], v76, s[8:11], s65 offen offset:1024 sc1
  s_nop 15
  s_nop 1
  buffer_load_dwordx4 v[52:55], v76, s[8:11], s65 offen offset:0 sc1
  buffer_load_dwordx4 v[56:59], v76, s[8:11], s65 offen offset:1024 sc1
  s_nop 15
  s_nop 1
  buffer_load_dwordx4 v[52:55], v76, s[8:11], s65 offen offset:0 sc1
  buffer_load_dwordx4 v[56:59], v76, s[8:11], s65 offen offset:1024 sc1
  s_waitcnt vmcnt(8)
  ds_read_b128 v[60:63], v76 offset:16384
  ds_read_b128 v[64:67], v76 offset:17408
  ds_read_b128 v[44:47], v76 offset:18432
  ds_read_b128 v[48:51], v76 offset:19456
  ds_read_b128 v[36:39], v76 offset:32768
  ds_read_b128 v[40:43], v76 offset:33792
  s_waitcnt vmcnt(4)
  v_max3_u32 v72, v52, v53, v54
  v_max3_u32 v72, v72, v55, v56
  v_max3_u32 v72, v72, v57, v58
  v_max_u32 v72, v72, v59
  ds_write_b128 v76, v[52:55] offset:4608
  ds_write_b128 v76, v[56:59] offset:5632
  v_cmp_eq_u32 vcc, -1, v72
  s_cbranch_vccnz Cs0_h2r
Cs0_h2w:
  s_waitcnt lgkmcnt(0)
  s_barrier
  ds_read_b128 v[0:3], v76 offset:4608
  ds_read_b128 v[4:7], v76 offset:5632
Cs0_top2:
  ds_read_b128 v[8:11], v76 offset:6656
  s_waitcnt lgkmcnt(2)
  v_smfmac_f32_16x16x64_bf16 v[20:23], v[0:3], v[60:67], v74
  ds_read_b128 v[60:63], v76 offset:34816
  v_smfmac_f32_16x16x64_bf16 v[24:27], v[0:3], v[44:51], v74
  ds_read_b128 v[64:67], v76 offset:35840
  s_waitcnt lgkmcnt(3)
  v_smfmac_f32_16x16x64_bf16 v[20:23], v[4:7], v[80:87], v74
  buffer_load_dwordx4 v[44:47], v76, s[8:11], s58 offen offset:0 sc1
  v_smfmac_f32_16x16x64_bf16 v[28:31], v[0:3], v[36:43], v74
  ds_read_b128 v[36:39], v76 offset:49152
  v_smfmac_f32_16x16x64_bf16 v[24:27], v[4:7], v[88:95], v74
  buffer_load_dwordx4 v[48:51], v76, s[8:11], s58 offen offset:1024 sc1
  ds_read_b128 v[40:43], v76 offset:50176
  v_smfmac_f32_16x16x64_bf16 v[28:31], v[4:7], v[208:215], v74
  ds_read_b128 v[12:15], v76 offset:7680
  s_waitcnt lgkmcnt(5)
  v_smfmac_f32_16x16x64_bf16 v[32:35], v[4:7], v[216:223], v74
  buffer_load_dwordx4 v[52:55], v76, s[8:11], s59 offen offset:0 sc1
  s_waitcnt lgkmcnt(3)
  v_smfmac_f32_16x16x64_bf16 v[32:35], v[0:3], v[60:67], v74
  buffer_load_dwordx4 v[56:59], v76, s[8:11], s59 offen offset:1024 sc1
  v_smfmac_f32_16x16x64_bf16 v[20:23], v[8:11], v[96:103], v74
  buffer_store_dwordx4 v[16:19], v76, s[8:11], s68 offen sc1
  ds_read_b128 v[60:63], v76 offset:51200
  v_smfmac_f32_16x16x64_bf16 v[24:27], v[8:11], v[104:111], v74
  ds_read_b128 v[64:67], v76 offset:52224
  s_waitcnt lgkmcnt(3)
  v_smfmac_f32_16x16x64_bf16 v[28:31], v[8:11], v[36:43], v74
  ds_read_b128 v[36:39], v75 offset:0
  s_waitcnt lgkmcnt(3)
  v_smfmac_f32_16x16x64_bf16 v[20:23], v[12:15], v[112:119], v74
  ds_read_b128 v[40:43], v75 offset:1024
  v_smfmac_f32_16x16x64_bf16 v[24:27], v[12:15], v[120:127], v74
  s_barrier
  ds_read_b128 v[0:3], v76 offset:8704
  v_smfmac_f32_16x16x64_bf16 v[28:31], v[12:15], v[224:231], v74
  ds_read_b128 v[4:7], v76 offset:9728
  v_smfmac_f32_16x16x64_bf16 v[32:35], v[12:15], v[232:239], v74
  buffer_load_dword v73, s[8:11], s70 offen lds
  s_waitcnt lgkmcnt(4)
  v_smfmac_f32_16x16x64_bf16 v[32:35], v[8:11], v[60:67], v74
  ds_read_b128 v[60:63], v75 offset:2048
  s_waitcnt lgkmcnt(2)
  v_smfmac_f32_16x16x64_bf16 v[20:23], v[0:3], v[128:135], v74
  ds_read_b128 v[16:19], v76 offset:10752
  v_smfmac_f32_16x16x64_bf16 v[24:27], v[0:3], v[136:143], v74
  ds_read_b128 v[64:67], v75 offset:3072
  v_smfmac_f32_16x16x64_bf16 v[28:31], v[0:3], v[36:43], v74
  ds_read_b128 v[36:39], v75 offset:16384
  s_waitcnt lgkmcnt(4)
  v_smfmac_f32_16x16x64_bf16 v[20:23], v[4:7], v[144:151], v74
  ds_read_b128 v[12:15], v76 offset:11776
  v_smfmac_f32_16x16x64_bf16 v[24:27], v[4:7], v[152:159], v74
  ds_read_b128 v[40:43], v75 offset:17408
  s_waitcnt lgkmcnt(4)
  v_smfmac_f32_16x16x64_bf16 v[20:23], v[16:19], v[160:167], v74
  ds_read_b128 v[8:11], v76 offset:12800
  s_waitcnt lgkmcnt(4)
  v_smfmac_f32_16x16x64_bf16 v[32:35], v[0:3], v[60:67], v74
  ds_read_b128 v[60:63], v75 offset:18432
  v_mov_b64 v[68:69], s[78:79]
  v_smfmac_f32_16x16x64_bf16 v[24:27], v[16:19], v[168:175], v74
  ds_read_b128 v[64:67], v75 offset:19456
  s_waitcnt lgkmcnt(4)
  v_mov_b64 v[70:71], s[78:79]
  v_smfmac_f32_16x16x64_bf16 v[20:23], v[12:15], v[176:183], v74
  s_waitcnt lgkmcnt(3)
  v_smfmac_f32_16x16x64_bf16 v[28:31], v[4:7], v[36:43], v74
  s_waitcnt lgkmcnt(2)
  v_mov_b64 v[36:37], 0
  v_smfmac_f32_16x16x64_bf16 v[20:23], v[8:11], v[192:199], v74
  v_mov_b64 v[38:39], 0
  v_smfmac_f32_16x16x64_bf16 v[24:27], v[12:15], v[184:191], v74
  v_mov_b64 v[40:41], 0
  v_smfmac_f32_16x16x64_bf16 v[24:27], v[8:11], v[200:207], v74
  s_waitcnt lgkmcnt(0)
  v_add_f32 v20, v20, v22
  v_smfmac_f32_16x16x64_bf16 v[32:35], v[4:7], v[60:67], v74
  v_add_f32 v21, v21, v23
  v_smfmac_f32_16x16x64_bf16 v[28:31], v[16:19], v[240:247], v74
  v_add_f32 v24, v24, v26
  v_cvt_pk_bf16_f32 v22, v20, v24
  v_smfmac_f32_16x16x64_bf16 v[28:31], v[12:15], a[0:7], v74
  ds_write_b32 v79, v22 offset:0
  v_add_f32 v25, v25, v27
  v_cvt_pk_bf16_f32 v23, v21, v25
  v_smfmac_f32_16x16x64_bf16 v[28:31], v[8:11], a[16:23], v74
  ds_write_b32 v79, v23 offset:576
  v_cmp_u_f32 vcc, v20, v21
  v_smfmac_f32_16x16x64_bf16 v[32:35], v[16:19], v[248:255], v74
  v_mov_b64 v[42:43], 0
  v_smfmac_f32_16x16x64_bf16 v[32:35], v[12:15], a[8:15], v74
  v_add_f32 v28, v28, v30
  v_add_f32 v29, v29, v31
  v_smfmac_f32_16x16x64_bf16 v[32:35], v[8:11], a[24:31], v74
  s_cbranch_vccnz Cs0_rec
Cs0_recok:
  v_smfmac_f32_16x16x64_bf16 v[36:39], v[16:19], a[128:135], v74
  s_waitcnt lgkmcnt(0)
  s_barrier
  ds_read_b128 v[60:63], v77
  v_smfmac_f32_16x16x64_bf16 v[40:43], v[16:19], a[136:143], v74
  ds_read_b128 v[64:67], v77 offset:128
  v_add_f32 v32, v32, v34
  v_cvt_pk_bf16_f32 v30, v28, v32
  v_smfmac_f32_16x16x64_bf16 v[36:39], v[0:3], a[96:103], v74
  ds_write_b32 v79, v30 offset:256
  v_add_f32 v33, v33, v35
  v_cvt_pk_bf16_f32 v31, v29, v33
  v_smfmac_f32_16x16x64_bf16 v[40:43], v[0:3], a[104:111], v74
  ds_write_b32 v79, v31 offset:832
  v_xor_b32 v75, 0x8000, v75
  v_smfmac_f32_16x16x64_bf16 v[36:39], v[4:7], a[112:119], v74
  ds_read_b128 v[0:3], v76 offset:4608
  v_mov_b32 v29, 0
  v_smfmac_f32_16x16x64_bf16 v[40:43], v[4:7], a[120:127], v74
  s_waitcnt vmcnt(4) lgkmcnt(3)
  v_mov_b32 v30, 0
  v_mfma_f32_16x16x32_bf16 v[44:47], v[44:47], v[60:63], 0
  ds_read_b128 v[4:7], v76 offset:5632
  s_waitcnt lgkmcnt(2)
  v_mfma_f32_16x16x32_bf16 v[44:47], v[48:51], v[64:67], v[44:47]
  s_barrier
  v_smfmac_f32_16x16x64_bf16 v[36:39], v[8:11], a[160:167], v74
  ds_read_b128 v[20:23], v77 offset:256
  ds_read_b128 v[24:27], v77 offset:384
  v_smfmac_f32_16x16x64_bf16 v[40:43], v[8:11], a[168:175], v74
  ds_read_b128 v[8:11], v76 offset:6656
  v_add_f32_dpp v72, v46, v44 quad_perm:[2,3,0,1] row_mask:0xf bank_mask:0xf
  v_add_f32_dpp v73, v47, v45 quad_perm:[2,3,0,1] row_mask:0xf bank_mask:0xf
  v_smfmac_f32_16x16x64_bf16 v[36:39], v[12:15], a[144:151], v74
  s_waitcnt lgkmcnt(4)
  v_exp_f32_dpp v72, v72 quad_perm:[0,1,0,1] row_mask:0xf bank_mask:0xf
  v_smfmac_f32_16x16x64_bf16 v[40:43], v[12:15], a[152:159], v74
  ds_read_b128 v[12:15], v76 offset:7680
  v_exp_f32_dpp v73, v73 quad_perm:[0,1,0,1] row_mask:0xf bank_mask:0xf
  v_smfmac_f32_16x16x64_bf16 v[36:39], v[0:3], a[32:39], v74
  s_waitcnt lgkmcnt(2)
  v_cvt_pk_bf16_f32 v72, v72, v73
  v_mfma_f32_16x16x32_bf16 v[20:23], v[20:23], v[60:63], 0
  ds_write_b32 v78, v72 offset:512
  v_mov_b64 v[16:17], 0
  v_mfma_f32_16x16x32_bf16 v[20:23], v[24:27], v[64:67], v[20:23]
  ds_read_b128 v[44:47], v75 offset:16384
  v_mov_b64 v[18:19], 0
  v_smfmac_f32_16x16x64_bf16 v[40:43], v[0:3], a[40:47], v74
  ds_read_b128 v[48:51], v75 offset:17408
  s_waitcnt lgkmcnt(4)
  v_smfmac_f32_16x16x64_bf16 v[36:39], v[4:7], a[48:55], v74
  v_add_f32_dpp v24, v22, v20 quad_perm:[2,3,0,1] row_mask:0xf bank_mask:0xf
  v_add_f32_dpp v25, v23, v21 quad_perm:[2,3,0,1] row_mask:0xf bank_mask:0xf
  v_smfmac_f32_16x16x64_bf16 v[36:39], v[8:11], a[64:71], v74
  s_waitcnt lgkmcnt(2)
  s_barrier
  ds_read_b128 v[32:35], v78 offset:512
  v_smfmac_f32_16x16x64_bf16 v[36:39], v[12:15], a[80:87], v74
  ds_read_b128 v[60:63], v75 offset:18432
  v_mul_f32 v24, s69, v24
  v_smfmac_f32_16x16x64_bf16 v[40:43], v[4:7], a[56:63], v74
  ds_read_b128 v[64:67], v75 offset:19456
  v_mul_f32 v25, s69, v25
  v_smfmac_f32_16x16x64_bf16 v[40:43], v[8:11], a[72:79], v74
  v_exp_f32_dpp v24, v24 quad_perm:[0,1,0,1] row_mask:0xf bank_mask:0xf
  v_smfmac_f32_16x16x64_bf16 v[40:43], v[12:15], a[88:95], v74
  s_waitcnt vmcnt(2) lgkmcnt(2)
  v_exp_f32_dpp v25, v25 quad_perm:[0,1,0,1] row_mask:0xf bank_mask:0xf
  v_mfma_f32_16x16x32_bf16 v[8:11], v[32:35], v[68:71], 0
  v_add_f32 v36, v36, v38
  v_add_f32 v37, v37, v39
  v_mfma_f32_16x16x32_bf16 v[0:3], v[32:35], v[52:55], 0
  v_add_f32 v40, v40, v42
  v_add_f32 v41, v41, v43
  v_mfma_f32_16x16x32_bf16 v[4:7], v[32:35], v[56:59], 0
  v_cvt_pk_bf16_f32 v28, v24, v25
  v_cvt_pk_bf16_f32 v72, v36, v37
  v_cvt_pk_bf16_f32 v73, v40, v41
  v_mfma_f32_16x16x16_bf16 v[8:11], v[28:29], v[68:69], v[8:11]
  v_cvt_pk_bf16_f32 v31, v24, v25
  v_mov_b64 v[20:21], 0
  v_mfma_f32_16x16x16_bf16 v[0:3], v[28:29], v[72:73], v[0:3]
  ds_read_b128 v[68:71], v76 offset:13824
  v_mov_b64 v[22:23], 0
  v_mfma_f32_16x16x16_bf16 v[4:7], v[30:31], v[72:73], v[4:7]
  v_rcp_f32 v10, v8
  v_rcp_f32 v11, v9
  v_mul_f32 v0, v10, v0
  v_mul_f32 v1, v11, v1
  s_nop 0
  v_mul_f32 v4, v10, v4
  v_mul_f32 v5, v11, v5
  v_cvt_pk_bf16_f32 v2, v0, v4
  ds_write_b32 v79, v2 offset:8704
  v_cvt_pk_bf16_f32 v3, v1, v5
  ds_write_b32 v79, v3 offset:9280
  v_max3_f32 v8, v8, v9, v10
  v_max_f32 v8, v8, v11
  v_cmp_le_f32 vcc, 1317011456, v8
  v_mov_b64 v[24:25], 0
  v_mov_b64 v[26:27], 0
  s_cbranch_vccnz Cs0_mx
Cs0_mxok:
  s_waitcnt lgkmcnt(0)
  s_barrier
  ds_read_b128 v[0:3], v78 offset:8704
  ds_read_b128 v[4:7], v78 offset:8768
  ds_read_b128 v[8:11], v78 offset:8832
  ds_read_b128 v[12:15], v78 offset:8896
  s_cmp_eq_u32 s66, 63
  s_cbranch_scc1 Cs0_last
  s_waitcnt lgkmcnt(3)
  v_smfmac_f32_16x16x64_bf16 v[16:19], v[0:3], v[44:51], v74
  ds_read_b128 v[52:55], v75 offset:32768
  s_waitcnt lgkmcnt(3)
  v_smfmac_f32_16x16x64_bf16 v[16:19], v[4:7], v[60:67], v74
  ds_read_b128 v[56:59], v75 offset:33792
  s_waitcnt lgkmcnt(3)
  v_smfmac_f32_16x16x64_bf16 v[16:19], v[8:11], a[176:183], v74
  ds_read_b128 v[36:39], v75 offset:34816
  s_waitcnt lgkmcnt(3)
  v_smfmac_f32_16x16x64_bf16 v[16:19], v[12:15], a[184:191], v74
  ds_read_b128 v[40:43], v75 offset:35840
  ds_read_b128 v[44:47], v75 offset:49152
  v_smfmac_f32_16x16x64_bf16 v[20:23], v[0:3], a[192:199], v74
  ds_read_b128 v[48:51], v75 offset:50176
  ds_read_b128 v[60:63], v75 offset:51200
  v_smfmac_f32_16x16x64_bf16 v[20:23], v[4:7], a[200:207], v74
  ds_read_b128 v[64:67], v75 offset:52224
  s_waitcnt lgkmcnt(6)
  v_cvt_pk_bf16_f32 v16, v16, v17
  v_cvt_pk_bf16_f32 v17, v18, v19
  v_bfi_b32 v16, 1, s72, v16
  v_smfmac_f32_16x16x64_bf16 v[20:23], v[8:11], v[52:59], v74
  buffer_store_dwordx2 v[16:17], v68, s[8:11], s73 offen sc1
  s_waitcnt lgkmcnt(4)
  v_smfmac_f32_16x16x64_bf16 v[20:23], v[12:15], v[36:43], v74
  v_mov_b64 v[32:33], 0
  v_smfmac_f32_16x16x64_bf16 v[24:27], v[0:3], a[208:215], v74
  v_mov_b64 v[34:35], 0
  v_smfmac_f32_16x16x64_bf16 v[24:27], v[4:7], a[216:223], v74
  s_waitcnt lgkmcnt(2)
  v_cvt_pk_bf16_f32 v20, v20, v21
  v_cvt_pk_bf16_f32 v21, v22, v23
  v_bfi_b32 v20, 1, s72, v20
  v_smfmac_f32_16x16x64_bf16 v[24:27], v[8:11], v[44:51], v74
  buffer_store_dwordx2 v[20:21], v68, s[8:11], s74 offen sc1
  s_waitcnt lgkmcnt(0)
  v_smfmac_f32_16x16x64_bf16 v[24:27], v[12:15], v[60:67], v74
  v_smfmac_f32_16x16x64_bf16 v[32:35], v[0:3], a[224:231], v74
  v_smfmac_f32_16x16x64_bf16 v[32:35], v[4:7], a[232:239], v74
  v_cvt_pk_bf16_f32 v24, v24, v25
  v_cvt_pk_bf16_f32 v25, v26, v27
  v_bfi_b32 v24, 1, s72, v24
  v_smfmac_f32_16x16x64_bf16 v[32:35], v[8:11], a[240:247], v74
  s_nop 1
  buffer_store_dwordx2 v[24:25], v68, s[8:11], s75 offen sc1
  v_smfmac_f32_16x16x64_bf16 v[32:35], v[12:15], a[248:255], v74
  ds_read_b128 v[0:3], v76 offset:14848
  ds_read_b64 v[16:17], v77 offset:256
  v_mov_b64 v[18:19], v[72:73]
  v_xor_b32 v75, 0x8000, v75
  s_nop 3
  v_cvt_pk_bf16_f32 v32, v32, v33
  v_cvt_pk_bf16_f32 v33, v34, v35
  v_bfi_b32 v32, 1, s72, v32
  buffer_store_dwordx2 v[32:33], v68, s[8:11], s76 offen sc1
  v_mov_b64 v[20:21], 0
  v_mov_b64 v[22:23], 0
  v_mov_b64 v[24:25], 0
  v_mov_b64 v[26:27], 0
  v_mov_b64 v[28:29], 0
  v_mov_b64 v[30:31], 0
  v_mov_b64 v[32:33], 0
  v_mov_b64 v[34:35], 0
  s_add_u32 s58, s58, 655360
  s_add_u32 s59, s59, 655360
  s_add_u32 s70, s70, 655360
  s_add_u32 s68, s68, 655360
  s_add_u32 s66, s66, 1
  s_xor_b32 s64, s64, 16384
  s_xor_b32 s65, s65, 16384
  s_nop 15
  s_nop 3
  buffer_load_dwordx4 v[52:55], v76, s[8:11], s60 offen offset:0 sc1
  buffer_load_dwordx4 v[56:59], v76, s[8:11], s60 offen offset:1024 sc1
  s_nop 15
  s_nop 11
  buffer_load_dwordx4 v[36:39], v76, s[8:11], s60 offen offset:0 sc1
  buffer_load_dwordx4 v[40:43], v76, s[8:11], s60 offen offset:1024 sc1
  s_waitcnt lgkmcnt(0)
  s_waitcnt vmcnt(3)
  v_mfma_f32_16x16x32_bf16 v[4:7], v[0:3], v[52:55], 0
  v_bitop3_b32 v72, v52, v54, s72 bitop3:0x7e
  s_waitcnt vmcnt(2)
  v_mfma_f32_16x16x32_bf16 v[4:7], v[0:3], v[56:59], v[4:7]
  v_bitop3_b32 v73, v56, v58, s72 bitop3:0x7e
  v_bitop3_b32 v72, v72, v73, 1 bitop3:0xa8
  v_cmp_ne_u32 vcc, 0, v72
  s_nop 0
  s_cmp_eq_u64 vcc, 0
  s_cselect_b32 s54, s62, 268435456
  s_nop 0
  v_add_f32_dpp v4, v4, v4 row_ror:4 row_mask:0xf bank_mask:0xf
  v_add_f32_dpp v5, v5, v5 row_ror:4 row_mask:0xf bank_mask:0xf
  s_nop 0
  v_add_f32_dpp v4, v4, v4 row_ror:8 row_mask:0xf bank_mask:0xf
  v_add_f32_dpp v5, v5, v5 row_ror:8 row_mask:0xf bank_mask:0xf
  v_cvt_pk_bf16_f32 v4, v4, v5
  buffer_store_dword v4, v69, s[8:11], s54 offen sc1
  s_cbranch_vccnz Cs0_h1r
  s_xor_b32 s62, s62, 16384
  buffer_store_dword v71, v69, s[8:11], s62 offen sc1
  s_xor_b32 s72, s72, 1
  s_branch Cs0_h2
Cs0_h1r:
  s_mov_b64 exec, vcc
  buffer_load_dwordx4 v[52:55], v76, s[8:11], s60 offen offset:0 sc1
  buffer_load_dwordx4 v[56:59], v76, s[8:11], s60 offen offset:1024 sc1
  s_mov_b64 exec, -1
  s_add_u32 s67, s67, 1
  s_waitcnt vmcnt(4)
  v_mfma_f32_16x16x32_bf16 v[4:7], v[0:3], v[36:39], 0
  v_bitop3_b32 v72, v36, v38, s72 bitop3:0x7e
  s_waitcnt vmcnt(3)
  v_mfma_f32_16x16x32_bf16 v[4:7], v[0:3], v[40:43], v[4:7]
  v_bitop3_b32 v73, v40, v42, s72 bitop3:0x7e
  v_bitop3_b32 v72, v72, v73, 1 bitop3:0xa8
  v_cmp_ne_u32 vcc, 0, v72
  s_cbranch_vccz Cs0_h1p
  s_mov_b64 exec, vcc
  buffer_load_dwordx4 v[36:39], v76, s[8:11], s60 offen offset:0 sc1
  buffer_load_dwordx4 v[40:43], v76, s[8:11], s60 offen offset:1024 sc1
  s_mov_b64 exec, -1
  s_add_u32 s67, s67, 1
  s_waitcnt vmcnt(3)
  v_mfma_f32_16x16x32_bf16 v[4:7], v[0:3], v[52:55], 0
  v_bitop3_b32 v72, v52, v54, s72 bitop3:0x7e
  s_waitcnt vmcnt(2)
  v_mfma_f32_16x16x32_bf16 v[4:7], v[0:3], v[56:59], v[4:7]
  v_bitop3_b32 v73, v56, v58, s72 bitop3:0x7e
  v_bitop3_b32 v72, v72, v73, 1 bitop3:0xa8
  v_cmp_ne_u32 vcc, 0, v72
  s_cbranch_vccz Cs0_h1p
Cs0_h1s:
  s_mov_b64 exec, vcc
  buffer_load_dwordx4 v[52:55], v76, s[8:11], s60 offen offset:0 sc1
  buffer_load_dwordx4 v[56:59], v76, s[8:11], s60 offen offset:1024 sc1
  s_mov_b64 exec, -1
  s_add_u32 s67, s67, 1
  s_waitcnt vmcnt(3)
  v_mfma_f32_16x16x32_bf16 v[4:7], v[0:3], v[36:39], 0
  v_bitop3_b32 v72, v36, v38, s72 bitop3:0x7e
  s_waitcnt vmcnt(2)
  v_mfma_f32_16x16x32_bf16 v[4:7], v[0:3], v[40:43], v[4:7]
  v_bitop3_b32 v73, v40, v42, s72 bitop3:0x7e
  v_bitop3_b32 v72, v72, v73, 1 bitop3:0xa8
  v_cmp_ne_u32 vcc, 0, v72
  s_cbranch_vccz Cs0_h1p
  s_mov_b64 exec, vcc
  buffer_load_dwordx4 v[36:39], v76, s[8:11], s60 offen offset:0 sc1
  buffer_load_dwordx4 v[40:43], v76, s[8:11], s60 offen offset:1024 sc1
  s_mov_b64 exec, -1
  s_add_u32 s67, s67, 1
  s_waitcnt vmcnt(3)
  v_mfma_f32_16x16x32_bf16 v[4:7], v[0:3], v[52:55], 0
  v_bitop3_b32 v72, v52, v54, s72 bitop3:0x7e
  s_waitcnt vmcnt(2)
  v_mfma_f32_16x16x32_bf16 v[4:7], v[0:3], v[56:59], v[4:7]
  v_bitop3_b32 v73, v56, v58, s72 bitop3:0x7e
  v_bitop3_b32 v72, v72, v73, 1 bitop3:0xa8
  v_cmp_ne_u32 vcc, 0, v72
  s_cbranch_vccz Cs0_h1p
  s_cmp_lt_u32 s67, 131072
  s_cbranch_scc1 Cs0_h1s
Cs0_h1p:
  s_nop 2
  v_add_f32_dpp v4, v4, v4 row_ror:4 row_mask:0xf bank_mask:0xf
  v_add_f32_dpp v5, v5, v5 row_ror:4 row_mask:0xf bank_mask:0xf
  s_nop 0
  v_add_f32_dpp v4, v4, v4 row_ror:8 row_mask:0xf bank_mask:0xf
  v_add_f32_dpp v5, v5, v5 row_ror:8 row_mask:0xf bank_mask:0xf
  v_cvt_pk_bf16_f32 v4, v4, v5
  buffer_store_dword v4, v69, s[8:11], s62 offen sc1
  s_xor_b32 s62, s62, 16384
  buffer_store_dword v71, v69, s[8:11], s62 offen sc1
  s_xor_b32 s72, s72, 1
  s_branch Cs0_h2
Cs0_h2r:
  s_mov_b64 exec, vcc
  buffer_load_dwordx4 v[52:55], v76, s[8:11], s65 offen offset:0 sc1
  buffer_load_dwordx4 v[56:59], v76, s[8:11], s65 offen offset:1024 sc1
  s_mov_b64 exec, -1
  s_add_u32 s67, s67, 1
  s_waitcnt vmcnt(4)
  v_max3_u32 v72, v52, v53, v54
  v_max3_u32 v72, v72, v55, v56
  v_max3_u32 v72, v72, v57, v58
  v_max_u32 v72, v72, v59
  ds_write_b128 v76, v[52:55] offset:4608
  ds_write_b128 v76, v[56:59] offset:5632
  v_cmp_eq_u32 vcc, -1, v72
  s_cbranch_vccz Cs0_h2w
  s_mov_b64 exec, vcc
  buffer_load_dwordx4 v[52:55], v76, s[8:11], s65 offen offset:0 sc1
  buffer_load_dwordx4 v[56:59], v76, s[8:11], s65 offen offset:1024 sc1
  s_mov_b64 exec, -1
  s_add_u32 s67, s67, 1
  s_waitcnt vmcnt(4)
  v_max3_u32 v72, v52, v53, v54
  v_max3_u32 v72, v72, v55, v56
  v_max3_u32 v72, v72, v57, v58
  v_max_u32 v72, v72, v59
  ds_write_b128 v76, v[52:55] offset:4608
  ds_write_b128 v76, v[56:59] offset:5632
  v_cmp_eq_u32 vcc, -1, v72
  s_cbranch_vccz Cs0_h2w
  s_mov_b64 exec, vcc
  buffer_load_dwordx4 v[52:55], v76, s[8:11], s65 offen offset:0 sc1
  buffer_load_dwordx4 v[56:59], v76, s[8:11], s65 offen offset:1024 sc1
  s_mov_b64 exec, -1
  s_add_u32 s67, s67, 1
  s_waitcnt vmcnt(4)
  v_max3_u32 v72, v52, v53, v54
  v_max3_u32 v72, v72, v55, v56
  v_max3_u32 v72, v72, v57, v58
  v_max_u32 v72, v72, v59
  ds_write_b128 v76, v[52:55] offset:4608
  ds_write_b128 v76, v[56:59] offset:5632
  v_cmp_eq_u32 vcc, -1, v72
  s_cbranch_vccz Cs0_h2w
  s_mov_b64 exec, vcc
  buffer_load_dwordx4 v[52:55], v76, s[8:11], s65 offen offset:0 sc1
  buffer_load_dwordx4 v[56:59], v76, s[8:11], s65 offen offset:1024 sc1
  s_mov_b64 exec, -1
  s_add_u32 s67, s67, 1
  s_waitcnt vmcnt(4)
  v_max3_u32 v72, v52, v53, v54
  v_max3_u32 v72, v72, v55, v56
  v_max3_u32 v72, v72, v57, v58
  v_max_u32 v72, v72, v59
  ds_write_b128 v76, v[52:55] offset:4608
  ds_write_b128 v76, v[56:59] offset:5632
  v_cmp_eq_u32 vcc, -1, v72
  s_cbranch_vccz Cs0_h2w
  s_cmp_lt_u32 s67, 131072
  s_cbranch_scc1 Cs0_h2r
Cs0_h2ok:
  ds_write_b128 v76, v[52:55] offset:4608
  ds_write_b128 v76, v[56:59] offset:5632
  s_branch Cs0_h2w
Cs0_rec:
  s_nop 7
  s_waitcnt vmcnt(0) lgkmcnt(0)
  v_max3_u32 v72, v0, v1, v2
  v_max3_u32 v72, v72, v3, v4
  v_max3_u32 v72, v72, v5, v6
  v_max3_u32 v72, v72, v7, v8
  v_max3_u32 v72, v72, v9, v10
  v_max3_u32 v72, v72, v11, v12
  v_max3_u32 v72, v72, v13, v14
  v_max3_u32 v72, v72, v15, v16
  v_max3_u32 v72, v72, v17, v18
  v_max_u32 v72, v72, v19
  v_cmp_eq_u32 vcc, -1, v72
  s_cbranch_vccz Cs0_recok
  s_barrier
  v_mov_b64 v[20:21], 0
  v_mov_b64 v[22:23], 0
  v_mov_b64 v[24:25], 0
  v_mov_b64 v[26:27], 0
  v_mov_b64 v[28:29], 0
  v_mov_b64 v[30:31], 0
  v_mov_b64 v[32:33], 0
  v_mov_b64 v[34:35], 0
  s_waitcnt lgkmcnt(0)
  s_barrier
  ds_read_b128 v[0:3], v76 offset:4608
  ds_read_b128 v[60:63], v76 offset:16384
  ds_read_b128 v[64:67], v76 offset:17408
  s_waitcnt lgkmcnt(0)
  v_smfmac_f32_16x16x64_bf16 v[20:23], v[0:3], v[60:67], v74
  ds_read_b128 v[60:63], v76 offset:18432
  ds_read_b128 v[64:67], v76 offset:19456
  s_waitcnt lgkmcnt(0)
  v_smfmac_f32_16x16x64_bf16 v[24:27], v[0:3], v[60:67], v74
  ds_read_b128 v[60:63], v76 offset:32768
  ds_read_b128 v[64:67], v76 offset:33792
  s_waitcnt lgkmcnt(0)
  v_smfmac_f32_16x16x64_bf16 v[28:31], v[0:3], v[60:67], v74
  ds_read_b128 v[60:63], v76 offset:34816
  ds_read_b128 v[64:67], v76 offset:35840
  s_waitcnt lgkmcnt(0)
  v_smfmac_f32_16x16x64_bf16 v[32:35], v[0:3], v[60:67], v74
  ds_read_b128 v[4:7], v76 offset:5632
  s_waitcnt lgkmcnt(0)
  v_smfmac_f32_16x16x64_bf16 v[20:23], v[4:7], v[80:87], v74
  v_smfmac_f32_16x16x64_bf16 v[24:27], v[4:7], v[88:95], v74
  v_smfmac_f32_16x16x64_bf16 v[28:31], v[4:7], v[208:215], v74
  v_smfmac_f32_16x16x64_bf16 v[32:35], v[4:7], v[216:223], v74
  ds_read_b128 v[8:11], v76 offset:6656
  s_waitcnt lgkmcnt(0)
  v_smfmac_f32_16x16x64_bf16 v[20:23], v[8:11], v[96:103], v74
  v_smfmac_f32_16x16x64_bf16 v[24:27], v[8:11], v[104:111], v74
  ds_read_b128 v[60:63], v76 offset:49152
  ds_read_b128 v[64:67], v76 offset:50176
  s_waitcnt lgkmcnt(0)
  v_smfmac_f32_16x16x64_bf16 v[28:31], v[8:11], v[60:67], v74
  ds_read_b128 v[60:63], v76 offset:51200
  ds_read_b128 v[64:67], v76 offset:52224
  s_waitcnt lgkmcnt(0)
  v_smfmac_f32_16x16x64_bf16 v[32:35], v[8:11], v[60:67], v74
  ds_read_b128 v[12:15], v76 offset:7680
  s_waitcnt lgkmcnt(0)
  v_smfmac_f32_16x16x64_bf16 v[20:23], v[12:15], v[112:119], v74
  v_smfmac_f32_16x16x64_bf16 v[24:27], v[12:15], v[120:127], v74
  v_smfmac_f32_16x16x64_bf16 v[28:31], v[12:15], v[224:231], v74
  v_smfmac_f32_16x16x64_bf16 v[32:35], v[12:15], v[232:239], v74
  ds_read_b128 v[0:3], v76 offset:8704
  s_waitcnt lgkmcnt(0)
  v_smfmac_f32_16x16x64_bf16 v[20:23], v[0:3], v[128:135], v74
  v_smfmac_f32_16x16x64_bf16 v[24:27], v[0:3], v[136:143], v74
  ds_read_b128 v[60:63], v75 offset:0
  ds_read_b128 v[64:67], v75 offset:1024
  s_waitcnt lgkmcnt(0)
  v_smfmac_f32_16x16x64_bf16 v[28:31], v[0:3], v[60:67], v74
  ds_read_b128 v[60:63], v75 offset:2048
  ds_read_b128 v[64:67], v75 offset:3072
  s_waitcnt lgkmcnt(0)
  v_smfmac_f32_16x16x64_bf16 v[32:35], v[0:3], v[60:67], v74
  ds_read_b128 v[4:7], v76 offset:9728
  s_waitcnt lgkmcnt(0)
  v_smfmac_f32_16x16x64_bf16 v[20:23], v[4:7], v[144:151], v74
  v_smfmac_f32_16x16x64_bf16 v[24:27], v[4:7], v[152:159], v74
  ds_read_b128 v[60:63], v75 offset:16384
  ds_read_b128 v[64:67], v75 offset:17408
  s_waitcnt lgkmcnt(0)
  v_smfmac_f32_16x16x64_bf16 v[28:31], v[4:7], v[60:67], v74
  ds_read_b128 v[60:63], v75 offset:18432
  ds_read_b128 v[64:67], v75 offset:19456
  s_waitcnt lgkmcnt(0)
  v_smfmac_f32_16x16x64_bf16 v[32:35], v[4:7], v[60:67], v74
  ds_read_b128 v[16:19], v76 offset:10752
  s_waitcnt lgkmcnt(0)
  v_smfmac_f32_16x16x64_bf16 v[20:23], v[16:19], v[160:167], v74
  v_smfmac_f32_16x16x64_bf16 v[24:27], v[16:19], v[168:175], v74
  v_smfmac_f32_16x16x64_bf16 v[28:31], v[16:19], v[240:247], v74
  v_smfmac_f32_16x16x64_bf16 v[32:35], v[16:19], v[248:255], v74
  ds_read_b128 v[12:15], v76 offset:11776
  s_waitcnt lgkmcnt(0)
  v_smfmac_f32_16x16x64_bf16 v[20:23], v[12:15], v[176:183], v74
  v_smfmac_f32_16x16x64_bf16 v[24:27], v[12:15], v[184:191], v74
  v_smfmac_f32_16x16x64_bf16 v[28:31], v[12:15], a[0:7], v74
  v_smfmac_f32_16x16x64_bf16 v[32:35], v[12:15], a[8:15], v74
  ds_read_b128 v[8:11], v76 offset:12800
  s_waitcnt lgkmcnt(0)
  v_smfmac_f32_16x16x64_bf16 v[20:23], v[8:11], v[192:199], v74
  v_smfmac_f32_16x16x64_bf16 v[24:27], v[8:11], v[200:207], v74
  v_smfmac_f32_16x16x64_bf16 v[28:31], v[8:11], a[16:23], v74
  v_smfmac_f32_16x16x64_bf16 v[32:35], v[8:11], a[24:31], v74
  v_add_f32 v20, v20, v22
  v_add_f32 v21, v21, v23
  v_add_f32 v24, v24, v26
  v_cvt_pk_bf16_f32 v22, v20, v24
  s_nop 0
  ds_write_b32 v79, v22 offset:0
  v_add_f32 v25, v25, v27
  v_cvt_pk_bf16_f32 v23, v21, v25
  ds_write_b32 v79, v23 offset:576
  v_add_f32 v28, v28, v30
  v_add_f32 v29, v29, v31
  s_waitcnt lgkmcnt(0)
  s_nop 1
  s_branch Cs0_recok
Cs0_mx:
  s_waitcnt lgkmcnt(0)
  s_barrier
  buffer_load_dwordx4 v[0:3], v76, s[8:11], s58 offen offset:0 sc1
  ds_read_b128 v[20:23], v77 offset:0
  ds_read_b128 v[28:31], v77 offset:256
  buffer_load_dwordx4 v[4:7], v76, s[8:11], s58 offen offset:1024 sc1
  ds_read_b128 v[24:27], v77 offset:128
  ds_read_b128 v[32:35], v77 offset:384
  s_waitcnt vmcnt(1) lgkmcnt(3)
  v_mfma_f32_16x16x32_bf16 v[8:11], v[0:3], v[20:23], 0
  s_waitcnt vmcnt(0) lgkmcnt(1)
  v_mfma_f32_16x16x32_bf16 v[8:11], v[4:7], v[24:27], v[8:11]
  v_mfma_f32_16x16x32_bf16 v[12:15], v[28:31], v[20:23], 0
  s_waitcnt lgkmcnt(0)
  v_mfma_f32_16x16x32_bf16 v[12:15], v[32:35], v[24:27], v[12:15]
  v_add_f32_dpp v8, v10, v8 quad_perm:[2,3,0,1] row_mask:0xf bank_mask:0xf
  v_add_f32_dpp v9, v11, v9 quad_perm:[2,3,0,1] row_mask:0xf bank_mask:0xf
  s_nop 0
  v_mov_b32_dpp v8, v8 quad_perm:[0,1,0,1] row_mask:0xf bank_mask:0xf
  v_mov_b32_dpp v9, v9 quad_perm:[0,1,0,1] row_mask:0xf bank_mask:0xf
  s_nop 1
  v_add_f32_dpp v12, v14, v12 quad_perm:[2,3,0,1] row_mask:0xf bank_mask:0xf
  v_add_f32_dpp v13, v15, v13 quad_perm:[2,3,0,1] row_mask:0xf bank_mask:0xf
  s_nop 0
  v_mov_b32_dpp v12, v12 quad_perm:[0,1,0,1] row_mask:0xf bank_mask:0xf
  v_mov_b32_dpp v13, v13 quad_perm:[0,1,0,1] row_mask:0xf bank_mask:0xf
  v_mul_f32 v12, s69, v12
  ds_write_b32 v78, v8 offset:8704
  v_mul_f32 v13, s69, v13
  ds_write_b32 v78, v9 offset:8768
  s_waitcnt lgkmcnt(0)
  s_barrier
  ds_read_b128 v[36:39], v78 offset:8704
  ds_read_b128 v[40:43], v78 offset:8768
  s_waitcnt lgkmcnt(0)
  s_barrier
  v_max_f32 v16, v36, v37
  v_max3_f32 v16, v16, v38, v39
  v_max3_f32 v16, v16, v40, v41
  v_max3_f32 v16, v16, v42, v43
  v_max3_f32 v16, v16, v12, v13
  v_mov_b32 v17, v16
  s_nop 1
  v_permlane16_swap_b32 v16, v17
  v_max_f32 v16, v16, v17
  v_mov_b32 v17, v16
  s_nop 1
  v_permlane32_swap_b32 v16, v17
  v_max_f32 v16, v16, v17
  v_sub_f32 v36, v36, v16
  v_sub_f32 v37, v37, v16
  v_sub_f32 v38, v38, v16
  v_sub_f32 v39, v39, v16
  v_sub_f32 v40, v40, v16
  v_sub_f32 v41, v41, v16
  v_sub_f32 v42, v42, v16
  v_sub_f32 v43, v43, v16
  v_sub_f32 v12, v12, v16
  v_sub_f32 v13, v13, v16
  v_exp_f32 v36, v36
  v_exp_f32 v37, v37
  v_exp_f32 v38, v38
  v_exp_f32 v39, v39
  v_exp_f32 v40, v40
  v_exp_f32 v41, v41
  v_exp_f32 v42, v42
  v_exp_f32 v43, v43
  v_exp_f32 v12, v12
  v_exp_f32 v13, v13
  v_cvt_pk_bf16_f32 v32, v36, v40
  v_cvt_pk_bf16_f32 v33, v37, v41
  v_cvt_pk_bf16_f32 v34, v38, v42
  v_cvt_pk_bf16_f32 v35, v39, v43
  v_cvt_pk_bf16_f32 v28, v12, v13
  v_cvt_pk_bf16_f32 v31, v12, v13
  v_mov_b32 v29, 0
  v_mov_b32 v30, 0
  v_mov_b32 v68, 0x3f803f80
  v_mov_b32 v69, 0x3f803f80
  v_mov_b32 v70, 0x3f803f80
  v_mov_b32 v71, 0x3f803f80
  s_nop 1
  v_mfma_f32_16x16x32_bf16 v[8:11], v[32:35], v[68:71], 0
  v_mfma_f32_16x16x32_bf16 v[0:3], v[32:35], v[52:55], 0
  v_mfma_f32_16x16x32_bf16 v[4:7], v[32:35], v[56:59], 0
  v_mfma_f32_16x16x16_bf16 v[8:11], v[28:29], v[68:69], v[8:11]
  v_mfma_f32_16x16x16_bf16 v[0:3], v[28:29], v[72:73], v[0:3]
  v_mfma_f32_16x16x16_bf16 v[4:7], v[30:31], v[72:73], v[4:7]
  ds_read_b128 v[68:71], v76 offset:13824
  v_rcp_f32 v10, v8
  v_rcp_f32 v11, v9
  v_mul_f32 v0, v10, v0
  v_mul_f32 v1, v11, v1
  s_nop 0
  v_mul_f32 v4, v10, v4
  v_mul_f32 v5, v11, v5
  v_cvt_pk_bf16_f32 v2, v0, v4
  ds_write_b32 v79, v2 offset:8704
  v_cvt_pk_bf16_f32 v3, v1, v5
  ds_write_b32 v79, v3 offset:9280
  v_mov_b64 v[16:17], 0
  v_mov_b64 v[18:19], 0
  v_mov_b64 v[20:21], 0
  v_mov_b64 v[22:23], 0
  v_mov_b64 v[24:25], 0
  v_mov_b64 v[26:27], 0
  s_branch Cs0_mxok
Cs0_last:
  s_waitcnt vmcnt(0) lgkmcnt(0)
  ds_read_b64 v[16:17], v77 offset:256
  v_mov_b64 v[18:19], v[72:73]
  s_add_u32 s68, s68, 655360
  s_waitcnt lgkmcnt(0)
  buffer_store_dwordx4 v[16:19], v76, s[8:11], s68 offen sc1
  s_waitcnt vmcnt(0)
  s_barrier
  s_branch L_cexit
L_w5:
  v_mov_b64 v[20:21], 0
  v_mov_b64 v[22:23], 0
  v_mov_b64 v[24:25], 0
  v_mov_b64 v[26:27], 0
  v_mov_b64 v[28:29], 0
  v_mov_b64 v[30:31], 0
  v_mov_b64 v[32:33], 0
  v_mov_b64 v[34:35], 0
  s_mov_b32 s78, 0x3f803f80
  s_mov_b32 s79, s78
  s_mov_b32 s65, 360448
  s_mov_b32 m0, 15872
  v_lshlrev_b32 v73, 2, v76
  v_mov_b32 v72, 0
  ds_read_b128 v[60:63], v76 offset:20480
  ds_read_b128 v[64:67], v76 offset:21504
  ds_read_b128 v[44:47], v76 offset:22528
  ds_read_b128 v[48:51], v76 offset:23552
  ds_read_b128 v[36:39], v76 offset:36864
  ds_read_b128 v[40:43], v76 offset:37888
  ds_read_b128 v[0:3], v76 offset:4608
  ds_read_b128 v[4:7], v76 offset:5632
  s_branch Cs1_top2
.p2align 6
Cs1_h2:
  v_lshlrev_b32 v73, 2, v76
  s_nop 15
  s_nop 3
  buffer_load_dwordx4 v[52:55], v76, s[8:11], s65 offen offset:2048 sc1
  s_nop 15
  s_nop 1
  buffer_load_dwordx4 v[52:55], v76, s[8:11], s65 offen offset:2048 sc1
  s_nop 15
  s_nop 1
  buffer_load_dwordx4 v[52:55], v76, s[8:11], s65 offen offset:2048 sc1
  s_waitcnt vmcnt(5)
  ds_read_b128 v[60:63], v76 offset:20480
  ds_read_b128 v[64:67], v76 offset:21504
  ds_read_b128 v[44:47], v76 offset:22528
  ds_read_b128 v[48:51], v76 offset:23552
  ds_read_b128 v[36:39], v76 offset:36864
  ds_read_b128 v[40:43], v76 offset:37888
  s_waitcnt vmcnt(2)
  v_max3_u32 v72, v52, v53, v54
  v_max_u32 v72, v72, v55
  ds_write_b128 v76, v[52:55] offset:6656
  v_cmp_eq_u32 vcc, -1, v72
  s_cbranch_vccnz Cs1_h2r
Cs1_h2w:
  s_waitcnt lgkmcnt(0)
  s_barrier
  ds_read_b128 v[0:3], v76 offset:4608
  ds_read_b128 v[4:7], v76 offset:5632
Cs1_top2:
  ds_read_b128 v[8:11], v76 offset:6656
  s_waitcnt lgkmcnt(2)
  v_smfmac_f32_16x16x64_bf16 v[20:23], v[0:3], v[60:67], v74
  ds_read_b128 v[60:63], v76 offset:38912
  v_smfmac_f32_16x16x64_bf16 v[24:27], v[0:3], v[44:51], v74
  ds_read_b128 v[64:67], v76 offset:39936
  s_waitcnt lgkmcnt(3)
  v_smfmac_f32_16x16x64_bf16 v[20:23], v[4:7], v[80:87], v74
  buffer_load_dwordx4 v[44:47], v76, s[8:11], s58 offen offset:0 sc1
  v_smfmac_f32_16x16x64_bf16 v[28:31], v[0:3], v[36:43], v74
  ds_read_b128 v[36:39], v76 offset:53248
  v_smfmac_f32_16x16x64_bf16 v[24:27], v[4:7], v[88:95], v74
  buffer_load_dwordx4 v[48:51], v76, s[8:11], s58 offen offset:1024 sc1
  ds_read_b128 v[40:43], v76 offset:54272
  v_smfmac_f32_16x16x64_bf16 v[28:31], v[4:7], v[208:215], v74
  ds_read_b128 v[12:15], v76 offset:7680
  s_waitcnt lgkmcnt(5)
  v_smfmac_f32_16x16x64_bf16 v[32:35], v[4:7], v[216:223], v74
  buffer_load_dwordx4 v[52:55], v76, s[8:11], s59 offen offset:0 sc1
  s_waitcnt lgkmcnt(3)
  v_smfmac_f32_16x16x64_bf16 v[32:35], v[0:3], v[60:67], v74
  buffer_load_dwordx4 v[56:59], v76, s[8:11], s59 offen offset:1024 sc1
  v_smfmac_f32_16x16x64_bf16 v[20:23], v[8:11], v[96:103], v74
  ds_read_b128 v[60:63], v76 offset:55296
  v_smfmac_f32_16x16x64_bf16 v[24:27], v[8:11], v[104:111], v74
  ds_read_b128 v[64:67], v76 offset:56320
  s_waitcnt lgkmcnt(3)
  v_smfmac_f32_16x16x64_bf16 v[28:31], v[8:11], v[36:43], v74
  buffer_store_dwordx4 v[16:19], v76, s[8:11], s68 offen sc1
  ds_read_b128 v[36:39], v75 offset:4096
  s_waitcnt lgkmcnt(3)
  v_smfmac_f32_16x16x64_bf16 v[20:23], v[12:15], v[112:119], v74
  ds_read_b128 v[40:43], v75 offset:5120
  v_smfmac_f32_16x16x64_bf16 v[24:27], v[12:15], v[120:127], v74
  s_barrier
  ds_read_b128 v[0:3], v76 offset:8704
  v_smfmac_f32_16x16x64_bf16 v[28:31], v[12:15], v[224:231], v74
  ds_read_b128 v[4:7], v76 offset:9728
  v_smfmac_f32_16x16x64_bf16 v[32:35], v[12:15], v[232:239], v74
  buffer_load_dword v73, s[8:11], s70 offen lds
  s_waitcnt lgkmcnt(4)
  v_smfmac_f32_16x16x64_bf16 v[32:35], v[8:11], v[60:67], v74
  ds_read_b128 v[60:63], v75 offset:6144
  s_waitcnt lgkmcnt(2)
  v_smfmac_f32_16x16x64_bf16 v[20:23], v[0:3], v[128:135], v74
  ds_read_b128 v[16:19], v76 offset:10752
  v_smfmac_f32_16x16x64_bf16 v[24:27], v[0:3], v[136:143], v74
  ds_read_b128 v[64:67], v75 offset:7168
  v_smfmac_f32_16x16x64_bf16 v[28:31], v[0:3], v[36:43], v74
  ds_read_b128 v[36:39], v75 offset:20480
  s_waitcnt lgkmcnt(4)
  v_smfmac_f32_16x16x64_bf16 v[20:23], v[4:7], v[144:151], v74
  ds_read_b128 v[12:15], v76 offset:11776
  v_smfmac_f32_16x16x64_bf16 v[24:27], v[4:7], v[152:159], v74
  ds_read_b128 v[40:43], v75 offset:21504
  s_waitcnt lgkmcnt(4)
  v_smfmac_f32_16x16x64_bf16 v[20:23], v[16:19], v[160:167], v74
  ds_read_b128 v[8:11], v76 offset:12800
  s_waitcnt lgkmcnt(4)
  v_smfmac_f32_16x16x64_bf16 v[32:35], v[0:3], v[60:67], v74
  ds_read_b128 v[60:63], v75 offset:22528
  v_mov_b64 v[68:69], s[78:79]
  v_smfmac_f32_16x16x64_bf16 v[24:27], v[16:19], v[168:175], v74
  ds_read_b128 v[64:67], v75 offset:23552
  s_waitcnt lgkmcnt(4)
  v_mov_b64 v[70:71], s[78:79]
  v_smfmac_f32_16x16x64_bf16 v[20:23], v[12:15], v[176:183], v74
  s_waitcnt lgkmcnt(3)
  v_smfmac_f32_16x16x64_bf16 v[28:31], v[4:7], v[36:43], v74
  s_waitcnt lgkmcnt(2)
  v_mov_b64 v[36:37], 0
  v_smfmac_f32_16x16x64_bf16 v[20:23], v[8:11], v[192:199], v74
  v_mov_b64 v[38:39], 0
  v_smfmac_f32_16x16x64_bf16 v[24:27], v[12:15], v[184:191], v74
  v_mov_b64 v[40:41], 0
  v_smfmac_f32_16x16x64_bf16 v[24:27], v[8:11], v[200:207], v74
  s_waitcnt lgkmcnt(0)
  v_add_f32 v20, v20, v22
  v_smfmac_f32_16x16x64_bf16 v[32:35], v[4:7], v[60:67], v74
  v_add_f32 v21, v21, v23
  v_smfmac_f32_16x16x64_bf16 v[28:31], v[16:19], v[240:247], v74
  v_add_f32 v24, v24, v26
  v_cvt_pk_bf16_f32 v22, v20, v24
  v_smfmac_f32_16x16x64_bf16 v[28:31], v[12:15], a[0:7], v74
  ds_write_b32 v79, v22 offset:0
  v_add_f32 v25, v25, v27
  v_cvt_pk_bf16_f32 v23, v21, v25
  v_smfmac_f32_16x16x64_bf16 v[28:31], v[8:11], a[16:23], v74
  ds_write_b32 v79, v23 offset:576
  v_cmp_u_f32 vcc, v20, v21
  v_smfmac_f32_16x16x64_bf16 v[32:35], v[16:19], v[248:255], v74
  v_mov_b64 v[42:43], 0
  v_smfmac_f32_16x16x64_bf16 v[32:35], v[12:15], a[8:15], v74
  v_add_f32 v28, v28, v30
  v_add_f32 v29, v29, v31
  v_smfmac_f32_16x16x64_bf16 v[32:35], v[8:11], a[24:31], v74
  s_cbranch_vccnz Cs1_rec
Cs1_recok:
  v_smfmac_f32_16x16x64_bf16 v[36:39], v[16:19], a[128:135], v74
  s_waitcnt lgkmcnt(0)
  s_barrier
  ds_read_b128 v[60:63], v77
  v_smfmac_f32_16x16x64_bf16 v[40:43], v[16:19], a[136:143], v74
  ds_read_b128 v[64:67], v77 offset:128
  v_add_f32 v32, v32, v34
  v_cvt_pk_bf16_f32 v30, v28, v32
  v_smfmac_f32_16x16x64_bf16 v[36:39], v[0:3], a[96:103], v74
  ds_write_b32 v79, v30 offset:256
  v_add_f32 v33, v33, v35
  v_cvt_pk_bf16_f32 v31, v29, v33
  v_smfmac_f32_16x16x64_bf16 v[40:43], v[0:3], a[104:111], v74
  ds_write_b32 v79, v31 offset:832
  v_xor_b32 v75, 0x8000, v75
  v_smfmac_f32_16x16x64_bf16 v[36:39], v[4:7], a[112:119], v74
  ds_read_b128 v[0:3], v76 offset:4608
  v_mov_b32 v29, 0
  v_smfmac_f32_16x16x64_bf16 v[40:43], v[4:7], a[120:127], v74
  s_waitcnt vmcnt(4) lgkmcnt(3)
  v_mov_b32 v30, 0
  v_mfma_f32_16x16x32_bf16 v[44:47], v[44:47], v[60:63], 0
  ds_read_b128 v[4:7], v76 offset:5632
  s_waitcnt lgkmcnt(2)
  v_mfma_f32_16x16x32_bf16 v[44:47], v[48:51], v[64:67], v[44:47]
  s_barrier
  v_smfmac_f32_16x16x64_bf16 v[36:39], v[8:11], a[160:167], v74
  ds_read_b128 v[20:23], v77 offset:256
  ds_read_b128 v[24:27], v77 offset:384
  v_smfmac_f32_16x16x64_bf16 v[40:43], v[8:11], a[168:175], v74
  ds_read_b128 v[8:11], v76 offset:6656
  v_add_f32_dpp v72, v46, v44 quad_perm:[2,3,0,1] row_mask:0xf bank_mask:0xf
  v_add_f32_dpp v73, v47, v45 quad_perm:[2,3,0,1] row_mask:0xf bank_mask:0xf
  v_smfmac_f32_16x16x64_bf16 v[36:39], v[12:15], a[144:151], v74
  s_waitcnt lgkmcnt(4)
  v_exp_f32_dpp v72, v72 quad_perm:[0,1,0,1] row_mask:0xf bank_mask:0xf
  v_smfmac_f32_16x16x64_bf16 v[40:43], v[12:15], a[152:159], v74
  ds_read_b128 v[12:15], v76 offset:7680
  v_exp_f32_dpp v73, v73 quad_perm:[0,1,0,1] row_mask:0xf bank_mask:0xf
  v_smfmac_f32_16x16x64_bf16 v[36:39], v[0:3], a[32:39], v74
  s_waitcnt lgkmcnt(2)
  v_cvt_pk_bf16_f32 v72, v72, v73
  v_mfma_f32_16x16x32_bf16 v[20:23], v[20:23], v[60:63], 0
  ds_write_b32 v78, v72 offset:516
  v_mov_b64 v[16:17], 0
  v_mfma_f32_16x16x32_bf16 v[20:23], v[24:27], v[64:67], v[20:23]
  ds_read_b128 v[44:47], v75 offset:20480
  v_mov_b64 v[18:19], 0
  v_smfmac_f32_16x16x64_bf16 v[40:43], v[0:3], a[40:47], v74
  ds_read_b128 v[48:51], v75 offset:21504
  s_waitcnt lgkmcnt(4)
  v_smfmac_f32_16x16x64_bf16 v[36:39], v[4:7], a[48:55], v74
  v_add_f32_dpp v24, v22, v20 quad_perm:[2,3,0,1] row_mask:0xf bank_mask:0xf
  v_add_f32_dpp v25, v23, v21 quad_perm:[2,3,0,1] row_mask:0xf bank_mask:0xf
  v_smfmac_f32_16x16x64_bf16 v[36:39], v[8:11], a[64:71], v74
  s_waitcnt lgkmcnt(2)
  s_barrier
  ds_read_b128 v[32:35], v78 offset:512
  v_smfmac_f32_16x16x64_bf16 v[36:39], v[12:15], a[80:87], v74
  ds_read_b128 v[60:63], v75 offset:22528
  v_mul_f32 v24, s69, v24
  v_smfmac_f32_16x16x64_bf16 v[40:43], v[4:7], a[56:63], v74
  ds_read_b128 v[64:67], v75 offset:23552
  v_mul_f32 v25, s69, v25
  v_smfmac_f32_16x16x64_bf16 v[40:43], v[8:11], a[72:79], v74
  v_exp_f32_dpp v24, v24 quad_perm:[0,1,0,1] row_mask:0xf bank_mask:0xf
  v_smfmac_f32_16x16x64_bf16 v[40:43], v[12:15], a[88:95], v74
  s_waitcnt vmcnt(2) lgkmcnt(2)
  v_exp_f32_dpp v25, v25 quad_perm:[0,1,0,1] row_mask:0xf bank_mask:0xf
  v_mfma_f32_16x16x32_bf16 v[8:11], v[32:35], v[68:71], 0
  v_add_f32 v36, v36, v38
  v_add_f32 v37, v37, v39
  v_mfma_f32_16x16x32_bf16 v[0:3], v[32:35], v[52:55], 0
  v_add_f32 v40, v40, v42
  v_add_f32 v41, v41, v43
  v_mfma_f32_16x16x32_bf16 v[4:7], v[32:35], v[56:59], 0
  v_cvt_pk_bf16_f32 v28, v24, v25
  v_cvt_pk_bf16_f32 v72, v36, v37
  v_cvt_pk_bf16_f32 v73, v40, v41
  v_mfma_f32_16x16x16_bf16 v[8:11], v[28:29], v[68:69], v[8:11]
  v_cvt_pk_bf16_f32 v31, v24, v25
  v_mov_b64 v[20:21], 0
  v_mfma_f32_16x16x16_bf16 v[0:3], v[28:29], v[72:73], v[0:3]
  ds_read_b128 v[68:71], v76 offset:13824
  v_mov_b64 v[22:23], 0
  v_mfma_f32_16x16x16_bf16 v[4:7], v[30:31], v[72:73], v[4:7]
  v_rcp_f32 v10, v8
  v_rcp_f32 v11, v9
  v_mul_f32 v0, v10, v0
  v_mul_f32 v1, v11, v1
  s_nop 0
  v_mul_f32 v4, v10, v4
  v_mul_f32 v5, v11, v5
  v_cvt_pk_bf16_f32 v2, v0, v4
  ds_write_b32 v79, v2 offset:8704
  v_cvt_pk_bf16_f32 v3, v1, v5
  ds_write_b32 v79, v3 offset:9280
  v_max3_f32 v8, v8, v9, v10
  v_max_f32 v8, v8, v11
  v_cmp_le_f32 vcc, 1317011456, v8
  v_mov_b64 v[24:25], 0
  v_mov_b64 v[26:27], 0
  s_cbranch_vccnz Cs1_mx
Cs1_mxok:
  s_waitcnt lgkmcnt(0)
  s_barrier
  ds_read_b128 v[0:3], v78 offset:8704
  ds_read_b128 v[4:7], v78 offset:8768
  ds_read_b128 v[8:11], v78 offset:8832
  ds_read_b128 v[12:15], v78 offset:8896
  s_cmp_eq_u32 s66, 63
  s_cbranch_scc1 Cs1_last
  s_waitcnt lgkmcnt(3)
  v_smfmac_f32_16x16x64_bf16 v[16:19], v[0:3], v[44:51], v74
  ds_read_b128 v[52:55], v75 offset:36864
  s_waitcnt lgkmcnt(3)
  v_smfmac_f32_16x16x64_bf16 v[16:19], v[4:7], v[60:67], v74
  ds_read_b128 v[56:59], v75 offset:37888
  s_waitcnt lgkmcnt(3)
  v_smfmac_f32_16x16x64_bf16 v[16:19], v[8:11], a[176:183], v74
  ds_read_b128 v[36:39], v75 offset:38912
  s_waitcnt lgkmcnt(3)
  v_smfmac_f32_16x16x64_bf16 v[16:19], v[12:15], a[184:191], v74
  ds_read_b128 v[40:43], v75 offset:39936
  ds_read_b128 v[44:47], v75 offset:53248
  v_smfmac_f32_16x16x64_bf16 v[20:23], v[0:3], a[192:199], v74
  ds_read_b128 v[48:51], v75 offset:54272
  ds_read_b128 v[60:63], v75 offset:55296
  v_smfmac_f32_16x16x64_bf16 v[20:23], v[4:7], a[200:207], v74
  ds_read_b128 v[64:67], v75 offset:56320
  s_waitcnt lgkmcnt(6)
  v_cvt_pk_bf16_f32 v16, v16, v17
  v_cvt_pk_bf16_f32 v17, v18, v19
  v_bfi_b32 v16, 1, s72, v16
  v_smfmac_f32_16x16x64_bf16 v[20:23], v[8:11], v[52:59], v74
  buffer_store_dwordx2 v[16:17], v68, s[8:11], s73 offen sc1
  s_waitcnt lgkmcnt(4)
  v_smfmac_f32_16x16x64_bf16 v[20:23], v[12:15], v[36:43], v74
  v_mov_b64 v[32:33], 0
  v_smfmac_f32_16x16x64_bf16 v[24:27], v[0:3], a[208:215], v74
  v_mov_b64 v[34:35], 0
  v_smfmac_f32_16x16x64_bf16 v[24:27], v[4:7], a[216:223], v74
  s_waitcnt lgkmcnt(2)
  v_cvt_pk_bf16_f32 v20, v20, v21
  v_cvt_pk_bf16_f32 v21, v22, v23
  v_bfi_b32 v20, 1, s72, v20
  v_smfmac_f32_16x16x64_bf16 v[24:27], v[8:11], v[44:51], v74
  buffer_store_dwordx2 v[20:21], v68, s[8:11], s74 offen sc1
  s_waitcnt lgkmcnt(0)
  v_smfmac_f32_16x16x64_bf16 v[24:27], v[12:15], v[60:67], v74
  v_smfmac_f32_16x16x64_bf16 v[32:35], v[0:3], a[224:231], v74
  v_smfmac_f32_16x16x64_bf16 v[32:35], v[4:7], a[232:239], v74
  v_cvt_pk_bf16_f32 v24, v24, v25
  v_cvt_pk_bf16_f32 v25, v26, v27
  v_bfi_b32 v24, 1, s72, v24
  v_smfmac_f32_16x16x64_bf16 v[32:35], v[8:11], a[240:247], v74
  s_nop 1
  buffer_store_dwordx2 v[24:25], v68, s[8:11], s75 offen sc1
  v_smfmac_f32_16x16x64_bf16 v[32:35], v[12:15], a[248:255], v74
  ds_read_b128 v[0:3], v76 offset:14848
  ds_read_b64 v[16:17], v77 offset:264
  v_mov_b64 v[18:19], v[72:73]
  v_xor_b32 v75, 0x8000, v75
  s_nop 3
  v_cvt_pk_bf16_f32 v32, v32, v33
  v_cvt_pk_bf16_f32 v33, v34, v35
  v_bfi_b32 v32, 1, s72, v32
  buffer_store_dwordx2 v[32:33], v68, s[8:11], s76 offen sc1
  v_mov_b64 v[20:21], 0
  v_mov_b64 v[22:23], 0
  v_mov_b64 v[24:25], 0
  v_mov_b64 v[26:27], 0
  v_mov_b64 v[28:29], 0
  v_mov_b64 v[30:31], 0
  v_mov_b64 v[32:33], 0
  v_mov_b64 v[34:35], 0
  s_add_u32 s58, s58, 655360
  s_add_u32 s59, s59, 655360
  s_add_u32 s70, s70, 655360
  s_add_u32 s68, s68, 655360
  s_add_u32 s66, s66, 1
  s_xor_b32 s64, s64, 16384
  s_xor_b32 s65, s65, 16384
  s_nop 15
  s_nop 15
  s_nop 7
  buffer_load_dwordx4 v[52:55], v76, s[8:11], s60 offen offset:0 sc1
  buffer_load_dwordx4 v[56:59], v76, s[8:11], s60 offen offset:1024 sc1
  s_nop 15
  s_nop 11
  buffer_load_dwordx4 v[36:39], v76, s[8:11], s60 offen offset:0 sc1
  buffer_load_dwordx4 v[40:43], v76, s[8:11], s60 offen offset:1024 sc1
  s_waitcnt lgkmcnt(0)
  s_waitcnt vmcnt(3)
  v_mfma_f32_16x16x32_bf16 v[4:7], v[0:3], v[52:55], 0
  v_bitop3_b32 v72, v52, v54, s72 bitop3:0x7e
  s_waitcnt vmcnt(2)
  v_mfma_f32_16x16x32_bf16 v[4:7], v[0:3], v[56:59], v[4:7]
  v_bitop3_b32 v73, v56, v58, s72 bitop3:0x7e
  v_bitop3_b32 v72, v72, v73, 1 bitop3:0xa8
  v_cmp_ne_u32 vcc, 0, v72
  s_nop 0
  s_cmp_eq_u64 vcc, 0
  s_cselect_b32 s54, s62, 268435456
  s_nop 0
  v_add_f32_dpp v4, v4, v4 row_ror:4 row_mask:0xf bank_mask:0xf
  v_add_f32_dpp v5, v5, v5 row_ror:4 row_mask:0xf bank_mask:0xf
  s_nop 0
  v_add_f32_dpp v4, v4, v4 row_ror:8 row_mask:0xf bank_mask:0xf
  v_add_f32_dpp v5, v5, v5 row_ror:8 row_mask:0xf bank_mask:0xf
  v_cvt_pk_bf16_f32 v4, v4, v5
  buffer_store_dword v4, v69, s[8:11], s54 offen sc1
  s_cbranch_vccnz Cs1_h1r
  s_xor_b32 s62, s62, 16384
  buffer_store_dword v71, v69, s[8:11], s62 offen sc1
  s_xor_b32 s72, s72, 1
  s_branch Cs1_h2
Cs1_h1r:
  s_mov_b64 exec, vcc
  buffer_load_dwordx4 v[52:55], v76, s[8:11], s60 offen offset:0 sc1
  buffer_load_dwordx4 v[56:59], v76, s[8:11], s60 offen offset:1024 sc1
  s_mov_b64 exec, -1
  s_add_u32 s67, s67, 1
  s_waitcnt vmcnt(4)
  v_mfma_f32_16x16x32_bf16 v[4:7], v[0:3], v[36:39], 0
  v_bitop3_b32 v72, v36, v38, s72 bitop3:0x7e
  s_waitcnt vmcnt(3)
  v_mfma_f32_16x16x32_bf16 v[4:7], v[0:3], v[40:43], v[4:7]
  v_bitop3_b32 v73, v40, v42, s72 bitop3:0x7e
  v_bitop3_b32 v72, v72, v73, 1 bitop3:0xa8
  v_cmp_ne_u32 vcc, 0, v72
  s_cbranch_vccz Cs1_h1p
  s_mov_b64 exec, vcc
  buffer_load_dwordx4 v[36:39], v76, s[8:11], s60 offen offset:0 sc1
  buffer_load_dwordx4 v[40:43], v76, s[8:11], s60 offen offset:1024 sc1
  s_mov_b64 exec, -1
  s_add_u32 s67, s67, 1
  s_waitcnt vmcnt(3)
  v_mfma_f32_16x16x32_bf16 v[4:7], v[0:3], v[52:55], 0
  v_bitop3_b32 v72, v52, v54, s72 bitop3:0x7e
  s_waitcnt vmcnt(2)
  v_mfma_f32_16x16x32_bf16 v[4:7], v[0:3], v[56:59], v[4:7]
  v_bitop3_b32 v73, v56, v58, s72 bitop3:0x7e
  v_bitop3_b32 v72, v72, v73, 1 bitop3:0xa8
  v_cmp_ne_u32 vcc, 0, v72
  s_cbranch_vccz Cs1_h1p
Cs1_h1s:
  s_mov_b64 exec, vcc
  buffer_load_dwordx4 v[52:55], v76, s[8:11], s60 offen offset:0 sc1
  buffer_load_dwordx4 v[56:59], v76, s[8:11], s60 offen offset:1024 sc1
  s_mov_b64 exec, -1
  s_add_u32 s67, s67, 1
  s_waitcnt vmcnt(3)
  v_mfma_f32_16x16x32_bf16 v[4:7], v[0:3], v[36:39], 0
  v_bitop3_b32 v72, v36, v38, s72 bitop3:0x7e
  s_waitcnt vmcnt(2)
  v_mfma_f32_16x16x32_bf16 v[4:7], v[0:3], v[40:43], v[4:7]
  v_bitop3_b32 v73, v40, v42, s72 bitop3:0x7e
  v_bitop3_b32 v72, v72, v73, 1 bitop3:0xa8
  v_cmp_ne_u32 vcc, 0, v72
  s_cbranch_vccz Cs1_h1p
  s_mov_b64 exec, vcc
  buffer_load_dwordx4 v[36:39], v76, s[8:11], s60 offen offset:0 sc1
  buffer_load_dwordx4 v[40:43], v76, s[8:11], s60 offen offset:1024 sc1
  s_mov_b64 exec, -1
  s_add_u32 s67, s67, 1
  s_waitcnt vmcnt(3)
  v_mfma_f32_16x16x32_bf16 v[4:7], v[0:3], v[52:55], 0
  v_bitop3_b32 v72, v52, v54, s72 bitop3:0x7e
  s_waitcnt vmcnt(2)
  v_mfma_f32_16x16x32_bf16 v[4:7], v[0:3], v[56:59], v[4:7]
  v_bitop3_b32 v73, v56, v58, s72 bitop3:0x7e
  v_bitop3_b32 v72, v72, v73, 1 bitop3:0xa8
  v_cmp_ne_u32 vcc, 0, v72
  s_cbranch_vccz Cs1_h1p
  s_cmp_lt_u32 s67, 131072
  s_cbranch_scc1 Cs1_h1s
Cs1_h1p:
  s_nop 2
  v_add_f32_dpp v4, v4, v4 row_ror:4 row_mask:0xf bank_mask:0xf
  v_add_f32_dpp v5, v5, v5 row_ror:4 row_mask:0xf bank_mask:0xf
  s_nop 0
  v_add_f32_dpp v4, v4, v4 row_ror:8 row_mask:0xf bank_mask:0xf
  v_add_f32_dpp v5, v5, v5 row_ror:8 row_mask:0xf bank_mask:0xf
  v_cvt_pk_bf16_f32 v4, v4, v5
  buffer_store_dword v4, v69, s[8:11], s62 offen sc1
  s_xor_b32 s62, s62, 16384
  buffer_store_dword v71, v69, s[8:11], s62 offen sc1
  s_xor_b32 s72, s72, 1
  s_branch Cs1_h2
Cs1_h2r:
  s_mov_b64 exec, vcc
  buffer_load_dwordx4 v[52:55], v76, s[8:11], s65 offen offset:2048 sc1
  s_mov_b64 exec, -1
  s_add_u32 s67, s67, 1
  s_waitcnt vmcnt(2)
  v_max3_u32 v72, v52, v53, v54
  v_max_u32 v72, v72, v55
  ds_write_b128 v76, v[52:55] offset:6656
  v_cmp_eq_u32 vcc, -1, v72
  s_cbranch_vccz Cs1_h2w
  s_mov_b64 exec, vcc
  buffer_load_dwordx4 v[52:55], v76, s[8:11], s65 offen offset:2048 sc1
  s_mov_b64 exec, -1
  s_add_u32 s67, s67, 1
  s_waitcnt vmcnt(2)
  v_max3_u32 v72, v52, v53, v54
  v_max_u32 v72, v72, v55
  ds_write_b128 v76, v[52:55] offset:6656
  v_cmp_eq_u32 vcc, -1, v72
  s_cbranch_vccz Cs1_h2w
  s_mov_b64 exec, vcc
  buffer_load_dwordx4 v[52:55], v76, s[8:11], s65 offen offset:2048 sc1
  s_mov_b64 exec, -1
  s_add_u32 s67, s67, 1
  s_waitcnt vmcnt(2)
  v_max3_u32 v72, v52, v53, v54
  v_max_u32 v72, v72, v55
  ds_write_b128 v76, v[52:55] offset:6656
  v_cmp_eq_u32 vcc, -1, v72
  s_cbranch_vccz Cs1_h2w
  s_mov_b64 exec, vcc
  buffer_load_dwordx4 v[52:55], v76, s[8:11], s65 offen offset:2048 sc1
  s_mov_b64 exec, -1
  s_add_u32 s67, s67, 1
  s_waitcnt vmcnt(2)
  v_max3_u32 v72, v52, v53, v54
  v_max_u32 v72, v72, v55
  ds_write_b128 v76, v[52:55] offset:6656
  v_cmp_eq_u32 vcc, -1, v72
  s_cbranch_vccz Cs1_h2w
  s_cmp_lt_u32 s67, 131072
  s_cbranch_scc1 Cs1_h2r
Cs1_h2ok:
  ds_write_b128 v76, v[52:55] offset:6656
  s_branch Cs1_h2w
Cs1_rec:
  s_nop 7
  s_waitcnt vmcnt(0) lgkmcnt(0)
  v_max3_u32 v72, v0, v1, v2
  v_max3_u32 v72, v72, v3, v4
  v_max3_u32 v72, v72, v5, v6
  v_max3_u32 v72, v72, v7, v8
  v_max3_u32 v72, v72, v9, v10
  v_max3_u32 v72, v72, v11, v12
  v_max3_u32 v72, v72, v13, v14
  v_max3_u32 v72, v72, v15, v16
  v_max3_u32 v72, v72, v17, v18
  v_max_u32 v72, v72, v19
  v_cmp_eq_u32 vcc, -1, v72
  s_cbranch_vccz Cs1_recok
  s_barrier
  v_mov_b64 v[20:21], 0
  v_mov_b64 v[22:23], 0
  v_mov_b64 v[24:25], 0
  v_mov_b64 v[26:27], 0
  v_mov_b64 v[28:29], 0
  v_mov_b64 v[30:31], 0
  v_mov_b64 v[32:33], 0
  v_mov_b64 v[34:35], 0
  s_waitcnt lgkmcnt(0)
  s_barrier
  ds_read_b128 v[0:3], v76 offset:4608
  ds_read_b128 v[60:63], v76 offset:20480
  ds_read_b128 v[64:67], v76 offset:21504
  s_waitcnt lgkmcnt(0)
  v_smfmac_f32_16x16x64_bf16 v[20:23], v[0:3], v[60:67], v74
  ds_read_b128 v[60:63], v76 offset:22528
  ds_read_b128 v[64:67], v76 offset:23552
  s_waitcnt lgkmcnt(0)
  v_smfmac_f32_16x16x64_bf16 v[24:27], v[0:3], v[60:67], v74
  ds_read_b128 v[60:63], v76 offset:36864
  ds_read_b128 v[64:67], v76 offset:37888
  s_waitcnt lgkmcnt(0)
  v_smfmac_f32_16x16x64_bf16 v[28:31], v[0:3], v[60:67], v74
  ds_read_b128 v[60:63], v76 offset:38912
  ds_read_b128 v[64:67], v76 offset:39936
  s_waitcnt lgkmcnt(0)
  v_smfmac_f32_16x16x64_bf16 v[32:35], v[0:3], v[60:67], v74
  ds_read_b128 v[4:7], v76 offset:5632
  s_waitcnt lgkmcnt(0)
  v_smfmac_f32_16x16x64_bf16 v[20:23], v[4:7], v[80:87], v74
  v_smfmac_f32_16x16x64_bf16 v[24:27], v[4:7], v[88:95], v74
  v_smfmac_f32_16x16x64_bf16 v[28:31], v[4:7], v[208:215], v74
  v_smfmac_f32_16x16x64_bf16 v[32:35], v[4:7], v[216:223], v74
  ds_read_b128 v[8:11], v76 offset:6656
  s_waitcnt lgkmcnt(0)
  v_smfmac_f32_16x16x64_bf16 v[20:23], v[8:11], v[96:103], v74
  v_smfmac_f32_16x16x64_bf16 v[24:27], v[8:11], v[104:111], v74
  ds_read_b128 v[60:63], v76 offset:53248
  ds_read_b128 v[64:67], v76 offset:54272
  s_waitcnt lgkmcnt(0)
  v_smfmac_f32_16x16x64_bf16 v[28:31], v[8:11], v[60:67], v74
  ds_read_b128 v[60:63], v76 offset:55296
  ds_read_b128 v[64:67], v76 offset:56320
  s_waitcnt lgkmcnt(0)
  v_smfmac_f32_16x16x64_bf16 v[32:35], v[8:11], v[60:67], v74
  ds_read_b128 v[12:15], v76 offset:7680
  s_waitcnt lgkmcnt(0)
  v_smfmac_f32_16x16x64_bf16 v[20:23], v[12:15], v[112:119], v74
  v_smfmac_f32_16x16x64_bf16 v[24:27], v[12:15], v[120:127], v74
  v_smfmac_f32_16x16x64_bf16 v[28:31], v[12:15], v[224:231], v74
  v_smfmac_f32_16x16x64_bf16 v[32:35], v[12:15], v[232:239], v74
  ds_read_b128 v[0:3], v76 offset:8704
  s_waitcnt lgkmcnt(0)
  v_smfmac_f32_16x16x64_bf16 v[20:23], v[0:3], v[128:135], v74
  v_smfmac_f32_16x16x64_bf16 v[24:27], v[0:3], v[136:143], v74
  ds_read_b128 v[60:63], v75 offset:4096
  ds_read_b128 v[64:67], v75 offset:5120
  s_waitcnt lgkmcnt(0)
  v_smfmac_f32_16x16x64_bf16 v[28:31], v[0:3], v[60:67], v74
  ds_read_b128 v[60:63], v75 offset:6144
  ds_read_b128 v[64:67], v75 offset:7168
  s_waitcnt lgkmcnt(0)
  v_smfmac_f32_16x16x64_bf16 v[32:35], v[0:3], v[60:67], v74
  ds_read_b128 v[4:7], v76 offset:9728
  s_waitcnt lgkmcnt(0)
  v_smfmac_f32_16x16x64_bf16 v[20:23], v[4:7], v[144:151], v74
  v_smfmac_f32_16x16x64_bf16 v[24:27], v[4:7], v[152:159], v74
  ds_read_b128 v[60:63], v75 offset:20480
  ds_read_b128 v[64:67], v75 offset:21504
  s_waitcnt lgkmcnt(0)
  v_smfmac_f32_16x16x64_bf16 v[28:31], v[4:7], v[60:67], v74
  ds_read_b128 v[60:63], v75 offset:22528
  ds_read_b128 v[64:67], v75 offset:23552
  s_waitcnt lgkmcnt(0)
  v_smfmac_f32_16x16x64_bf16 v[32:35], v[4:7], v[60:67], v74
  ds_read_b128 v[16:19], v76 offset:10752
  s_waitcnt lgkmcnt(0)
  v_smfmac_f32_16x16x64_bf16 v[20:23], v[16:19], v[160:167], v74
  v_smfmac_f32_16x16x64_bf16 v[24:27], v[16:19], v[168:175], v74
  v_smfmac_f32_16x16x64_bf16 v[28:31], v[16:19], v[240:247], v74
  v_smfmac_f32_16x16x64_bf16 v[32:35], v[16:19], v[248:255], v74
  ds_read_b128 v[12:15], v76 offset:11776
  s_waitcnt lgkmcnt(0)
  v_smfmac_f32_16x16x64_bf16 v[20:23], v[12:15], v[176:183], v74
  v_smfmac_f32_16x16x64_bf16 v[24:27], v[12:15], v[184:191], v74
  v_smfmac_f32_16x16x64_bf16 v[28:31], v[12:15], a[0:7], v74
  v_smfmac_f32_16x16x64_bf16 v[32:35], v[12:15], a[8:15], v74
  ds_read_b128 v[8:11], v76 offset:12800
  s_waitcnt lgkmcnt(0)
  v_smfmac_f32_16x16x64_bf16 v[20:23], v[8:11], v[192:199], v74
  v_smfmac_f32_16x16x64_bf16 v[24:27], v[8:11], v[200:207], v74
  v_smfmac_f32_16x16x64_bf16 v[28:31], v[8:11], a[16:23], v74
  v_smfmac_f32_16x16x64_bf16 v[32:35], v[8:11], a[24:31], v74
  v_add_f32 v20, v20, v22
  v_add_f32 v21, v21, v23
  v_add_f32 v24, v24, v26
  v_cvt_pk_bf16_f32 v22, v20, v24
  s_nop 0
  ds_write_b32 v79, v22 offset:0
  v_add_f32 v25, v25, v27
  v_cvt_pk_bf16_f32 v23, v21, v25
  ds_write_b32 v79, v23 offset:576
  v_add_f32 v28, v28, v30
  v_add_f32 v29, v29, v31
  s_waitcnt lgkmcnt(0)
  s_nop 1
  s_branch Cs1_recok
Cs1_mx:
  s_waitcnt lgkmcnt(0)
  s_barrier
  buffer_load_dwordx4 v[0:3], v76, s[8:11], s58 offen offset:0 sc1
  ds_read_b128 v[20:23], v77 offset:0
  ds_read_b128 v[28:31], v77 offset:256
  buffer_load_dwordx4 v[4:7], v76, s[8:11], s58 offen offset:1024 sc1
  ds_read_b128 v[24:27], v77 offset:128
  ds_read_b128 v[32:35], v77 offset:384
  s_waitcnt vmcnt(1) lgkmcnt(3)
  v_mfma_f32_16x16x32_bf16 v[8:11], v[0:3], v[20:23], 0
  s_waitcnt vmcnt(0) lgkmcnt(1)
  v_mfma_f32_16x16x32_bf16 v[8:11], v[4:7], v[24:27], v[8:11]
  v_mfma_f32_16x16x32_bf16 v[12:15], v[28:31], v[20:23], 0
  s_waitcnt lgkmcnt(0)
  v_mfma_f32_16x16x32_bf16 v[12:15], v[32:35], v[24:27], v[12:15]
  v_add_f32_dpp v8, v10, v8 quad_perm:[2,3,0,1] row_mask:0xf bank_mask:0xf
  v_add_f32_dpp v9, v11, v9 quad_perm:[2,3,0,1] row_mask:0xf bank_mask:0xf
  s_nop 0
  v_mov_b32_dpp v8, v8 quad_perm:[0,1,0,1] row_mask:0xf bank_mask:0xf
  v_mov_b32_dpp v9, v9 quad_perm:[0,1,0,1] row_mask:0xf bank_mask:0xf
  s_nop 1
  v_add_f32_dpp v12, v14, v12 quad_perm:[2,3,0,1] row_mask:0xf bank_mask:0xf
  v_add_f32_dpp v13, v15, v13 quad_perm:[2,3,0,1] row_mask:0xf bank_mask:0xf
  s_nop 0
  v_mov_b32_dpp v12, v12 quad_perm:[0,1,0,1] row_mask:0xf bank_mask:0xf
  v_mov_b32_dpp v13, v13 quad_perm:[0,1,0,1] row_mask:0xf bank_mask:0xf
  v_mul_f32 v12, s69, v12
  ds_write_b32 v78, v8 offset:8708
  v_mul_f32 v13, s69, v13
  ds_write_b32 v78, v9 offset:8772
  s_waitcnt lgkmcnt(0)
  s_barrier
  ds_read_b128 v[36:39], v78 offset:8704
  ds_read_b128 v[40:43], v78 offset:8768
  s_waitcnt lgkmcnt(0)
  s_barrier
  v_max_f32 v16, v36, v37
  v_max3_f32 v16, v16, v38, v39
  v_max3_f32 v16, v16, v40, v41
  v_max3_f32 v16, v16, v42, v43
  v_max3_f32 v16, v16, v12, v13
  v_mov_b32 v17, v16
  s_nop 1
  v_permlane16_swap_b32 v16, v17
  v_max_f32 v16, v16, v17
  v_mov_b32 v17, v16
  s_nop 1
  v_permlane32_swap_b32 v16, v17
  v_max_f32 v16, v16, v17
  v_sub_f32 v36, v36, v16
  v_sub_f32 v37, v37, v16
  v_sub_f32 v38, v38, v16
  v_sub_f32 v39, v39, v16
  v_sub_f32 v40, v40, v16
  v_sub_f32 v41, v41, v16
  v_sub_f32 v42, v42, v16
  v_sub_f32 v43, v43, v16
  v_sub_f32 v12, v12, v16
  v_sub_f32 v13, v13, v16
  v_exp_f32 v36, v36
  v_exp_f32 v37, v37
  v_exp_f32 v38, v38
  v_exp_f32 v39, v39
  v_exp_f32 v40, v40
  v_exp_f32 v41, v41
  v_exp_f32 v42, v42
  v_exp_f32 v43, v43
  v_exp_f32 v12, v12
  v_exp_f32 v13, v13
  v_cvt_pk_bf16_f32 v32, v36, v40
  v_cvt_pk_bf16_f32 v33, v37, v41
  v_cvt_pk_bf16_f32 v34, v38, v42
  v_cvt_pk_bf16_f32 v35, v39, v43
  v_cvt_pk_bf16_f32 v28, v12, v13
  v_cvt_pk_bf16_f32 v31, v12, v13
  v_mov_b32 v29, 0
  v_mov_b32 v30, 0
  v_mov_b32 v68, 0x3f803f80
  v_mov_b32 v69, 0x3f803f80
  v_mov_b32 v70, 0x3f803f80
  v_mov_b32 v71, 0x3f803f80
  s_nop 1
  v_mfma_f32_16x16x32_bf16 v[8:11], v[32:35], v[68:71], 0
  v_mfma_f32_16x16x32_bf16 v[0:3], v[32:35], v[52:55], 0
  v_mfma_f32_16x16x32_bf16 v[4:7], v[32:35], v[56:59], 0
  v_mfma_f32_16x16x16_bf16 v[8:11], v[28:29], v[68:69], v[8:11]
  v_mfma_f32_16x16x16_bf16 v[0:3], v[28:29], v[72:73], v[0:3]
  v_mfma_f32_16x16x16_bf16 v[4:7], v[30:31], v[72:73], v[4:7]
  ds_read_b128 v[68:71], v76 offset:13824
  v_rcp_f32 v10, v8
  v_rcp_f32 v11, v9
  v_mul_f32 v0, v10, v0
  v_mul_f32 v1, v11, v1
  s_nop 0
  v_mul_f32 v4, v10, v4
  v_mul_f32 v5, v11, v5
  v_cvt_pk_bf16_f32 v2, v0, v4
  ds_write_b32 v79, v2 offset:8704
  v_cvt_pk_bf16_f32 v3, v1, v5
  ds_write_b32 v79, v3 offset:9280
  v_mov_b64 v[16:17], 0
  v_mov_b64 v[18:19], 0
  v_mov_b64 v[20:21], 0
  v_mov_b64 v[22:23], 0
  v_mov_b64 v[24:25], 0
  v_mov_b64 v[26:27], 0
  s_branch Cs1_mxok
Cs1_last:
  s_waitcnt vmcnt(0) lgkmcnt(0)
  ds_read_b64 v[16:17], v77 offset:264
  v_mov_b64 v[18:19], v[72:73]
  s_add_u32 s68, s68, 655360
  s_waitcnt lgkmcnt(0)
  buffer_store_dwordx4 v[16:19], v76, s[8:11], s68 offen sc1
  s_waitcnt vmcnt(0)
  s_barrier
  s_branch L_cexit
L_w6:
  v_mov_b64 v[20:21], 0
  v_mov_b64 v[22:23], 0
  v_mov_b64 v[24:25], 0
  v_mov_b64 v[26:27], 0
  v_mov_b64 v[28:29], 0
  v_mov_b64 v[30:31], 0
  v_mov_b64 v[32:33], 0
  v_mov_b64 v[34:35], 0
  s_mov_b32 s78, 0x3f803f80
  s_mov_b32 s79, s78
  s_mov_b32 s65, 360448
  s_mov_b32 m0, 15872
  v_lshlrev_b32 v73, 2, v76
  v_mov_b32 v72, 0
  ds_read_b128 v[60:63], v76 offset:24576
  ds_read_b128 v[64:67], v76 offset:25600
  ds_read_b128 v[44:47], v76 offset:26624
  ds_read_b128 v[48:51], v76 offset:27648
  ds_read_b128 v[36:39], v76 offset:40960
  ds_read_b128 v[40:43], v76 offset:41984
  ds_read_b128 v[0:3], v76 offset:4608
  ds_read_b128 v[4:7], v76 offset:5632
  s_branch Cs2_top2
.p2align 6
Cs2_h2:
  v_lshlrev_b32 v73, 2, v76
  s_mov_b32 m0, 8704
  s_nop 3
  buffer_load_dwordx4 v[52:55], v76, s[8:11], s65 offen offset:3072 sc1
  s_nop 15
  s_nop 1
  buffer_load_dwordx4 v[52:55], v76, s[8:11], s65 offen offset:3072 sc1
  s_nop 15
  s_nop 1
  buffer_load_dwordx4 v[52:55], v76, s[8:11], s65 offen offset:3072 sc1
  s_waitcnt vmcnt(5)
  ds_read_b128 v[60:63], v76 offset:24576
  ds_read_b128 v[64:67], v76 offset:25600
  ds_read_b128 v[44:47], v76 offset:26624
  ds_read_b128 v[48:51], v76 offset:27648
  ds_read_b128 v[36:39], v76 offset:40960
  ds_read_b128 v[40:43], v76 offset:41984
  s_waitcnt vmcnt(2)
  v_max3_u32 v72, v52, v53, v54
  v_max_u32 v72, v72, v55
  ds_write_b128 v76, v[52:55] offset:7680
  v_cmp_eq_u32 vcc, -1, v72
  s_cbranch_vccnz Cs2_h2r
Cs2_h2w:
  s_waitcnt lgkmcnt(0)
  s_barrier
  ds_read_b128 v[0:3], v76 offset:4608
  ds_read_b128 v[4:7], v76 offset:5632
  buffer_load_dwordx4 v76, s[8:11], s64 offen offset:0 sc1 lds
  buffer_load_dwordx4 v76, s[8:11], s64 offen offset:1024 sc1 lds
Cs2_top2:
  ds_read_b128 v[8:11], v76 offset:6656
  s_mov_b32 m0, 15872
  s_waitcnt lgkmcnt(2)
  v_smfmac_f32_16x16x64_bf16 v[20:23], v[0:3], v[60:67], v74
  ds_read_b128 v[60:63], v76 offset:43008
  v_smfmac_f32_16x16x64_bf16 v[24:27], v[0:3], v[44:51], v74
  ds_read_b128 v[64:67], v76 offset:44032
  s_waitcnt lgkmcnt(3)
  v_smfmac_f32_16x16x64_bf16 v[20:23], v[4:7], v[80:87], v74
  buffer_load_dwordx4 v[44:47], v76, s[8:11], s58 offen offset:0 sc1
  v_smfmac_f32_16x16x64_bf16 v[28:31], v[0:3], v[36:43], v74
  ds_read_b128 v[36:39], v76 offset:57344
  v_smfmac_f32_16x16x64_bf16 v[24:27], v[4:7], v[88:95], v74
  buffer_load_dwordx4 v[48:51], v76, s[8:11], s58 offen offset:1024 sc1
  ds_read_b128 v[40:43], v76 offset:58368
  v_smfmac_f32_16x16x64_bf16 v[28:31], v[4:7], v[208:215], v74
  ds_read_b128 v[12:15], v76 offset:7680
  s_waitcnt lgkmcnt(5)
  v_smfmac_f32_16x16x64_bf16 v[32:35], v[4:7], v[216:223], v74
  buffer_load_dwordx4 v[52:55], v76, s[8:11], s59 offen offset:0 sc1
  s_waitcnt lgkmcnt(3)
  v_smfmac_f32_16x16x64_bf16 v[32:35], v[0:3], v[60:67], v74
  buffer_load_dwordx4 v[56:59], v76, s[8:11], s59 offen offset:1024 sc1
  v_smfmac_f32_16x16x64_bf16 v[20:23], v[8:11], v[96:103], v74
  ds_read_b128 v[60:63], v76 offset:59392
  v_smfmac_f32_16x16x64_bf16 v[24:27], v[8:11], v[104:111], v74
  ds_read_b128 v[64:67], v76 offset:60416
  s_waitcnt lgkmcnt(3)
  v_smfmac_f32_16x16x64_bf16 v[28:31], v[8:11], v[36:43], v74
  buffer_load_dword v73, s[8:11], s70 offen lds
  ds_read_b128 v[36:39], v75 offset:8192
  s_waitcnt lgkmcnt(3)
  v_smfmac_f32_16x16x64_bf16 v[20:23], v[12:15], v[112:119], v74
  s_waitcnt vmcnt(5)
  ds_read_b128 v[40:43], v75 offset:9216
  v_smfmac_f32_16x16x64_bf16 v[24:27], v[12:15], v[120:127], v74
  s_barrier
  ds_read_b128 v[0:3], v76 offset:8704
  v_smfmac_f32_16x16x64_bf16 v[28:31], v[12:15], v[224:231], v74
  buffer_store_dwordx4 v[16:19], v76, s[8:11], s68 offen sc1
  ds_read_b128 v[4:7], v76 offset:9728
  v_smfmac_f32_16x16x64_bf16 v[32:35], v[12:15], v[232:239], v74
  s_waitcnt lgkmcnt(4)
  v_smfmac_f32_16x16x64_bf16 v[32:35], v[8:11], v[60:67], v74
  ds_read_b128 v[60:63], v75 offset:10240
  s_waitcnt lgkmcnt(2)
  v_smfmac_f32_16x16x64_bf16 v[20:23], v[0:3], v[128:135], v74
  ds_read_b128 v[16:19], v76 offset:10752
  v_smfmac_f32_16x16x64_bf16 v[24:27], v[0:3], v[136:143], v74
  ds_read_b128 v[64:67], v75 offset:11264
  v_smfmac_f32_16x16x64_bf16 v[28:31], v[0:3], v[36:43], v74
  ds_read_b128 v[36:39], v75 offset:24576
  s_waitcnt lgkmcnt(4)
  v_smfmac_f32_16x16x64_bf16 v[20:23], v[4:7], v[144:151], v74
  ds_read_b128 v[12:15], v76 offset:11776
  v_smfmac_f32_16x16x64_bf16 v[24:27], v[4:7], v[152:159], v74
  ds_read_b128 v[40:43], v75 offset:25600
  s_waitcnt lgkmcnt(4)
  v_smfmac_f32_16x16x64_bf16 v[20:23], v[16:19], v[160:167], v74
  ds_read_b128 v[8:11], v76 offset:12800
  s_waitcnt lgkmcnt(4)
  v_smfmac_f32_16x16x64_bf16 v[32:35], v[0:3], v[60:67], v74
  ds_read_b128 v[60:63], v75 offset:26624
  v_mov_b64 v[68:69], s[78:79]
  v_smfmac_f32_16x16x64_bf16 v[24:27], v[16:19], v[168:175], v74
  ds_read_b128 v[64:67], v75 offset:27648
  s_waitcnt lgkmcnt(4)
  v_mov_b64 v[70:71], s[78:79]
  v_smfmac_f32_16x16x64_bf16 v[20:23], v[12:15], v[176:183], v74
  s_waitcnt lgkmcnt(3)
  v_smfmac_f32_16x16x64_bf16 v[28:31], v[4:7], v[36:43], v74
  s_waitcnt lgkmcnt(2)
  v_mov_b64 v[36:37], 0
  v_smfmac_f32_16x16x64_bf16 v[20:23], v[8:11], v[192:199], v74
  v_mov_b64 v[38:39], 0
  v_smfmac_f32_16x16x64_bf16 v[24:27], v[12:15], v[184:191], v74
  v_mov_b64 v[40:41], 0
  v_smfmac_f32_16x16x64_bf16 v[24:27], v[8:11], v[200:207], v74
  s_waitcnt lgkmcnt(0)
  v_add_f32 v20, v20, v22
  v_smfmac_f32_16x16x64_bf16 v[32:35], v[4:7], v[60:67], v74
  v_add_f32 v21, v21, v23
  v_smfmac_f32_16x16x64_bf16 v[28:31], v[16:19], v[240:247], v74
  v_add_f32 v24, v24, v26
  v_cvt_pk_bf16_f32 v22, v20, v24
  v_smfmac_f32_16x16x64_bf16 v[28:31], v[12:15], a[0:7], v74
  ds_write_b32 v79, v22 offset:0
  v_add_f32 v25, v25, v27
  v_cvt_pk_bf16_f32 v23, v21, v25
  v_smfmac_f32_16x16x64_bf16 v[28:31], v[8:11], a[16:23], v74
  ds_write_b32 v79, v23 offset:576
  v_cmp_u_f32 vcc, v20, v21
  v_smfmac_f32_16x16x64_bf16 v[32:35], v[16:19], v[248:255], v74
  v_mov_b64 v[42:43], 0
  v_smfmac_f32_16x16x64_bf16 v[32:35], v[12:15], a[8:15], v74
  v_add_f32 v28, v28, v30
  v_add_f32 v29, v29, v31
  v_smfmac_f32_16x16x64_bf16 v[32:35], v[8:11], a[24:31], v74
  s_cbranch_vccnz Cs2_rec
Cs2_recok:
  v_smfmac_f32_16x16x64_bf16 v[36:39], v[16:19], a[128:135], v74
  s_waitcnt lgkmcnt(0)
  s_barrier
  ds_read_b128 v[60:63], v77
  v_smfmac_f32_16x16x64_bf16 v[40:43], v[16:19], a[136:143], v74
  ds_read_b128 v[64:67], v77 offset:128
  v_add_f32 v32, v32, v34
  v_cvt_pk_bf16_f32 v30, v28, v32
  v_smfmac_f32_16x16x64_bf16 v[36:39], v[0:3], a[96:103], v74
  ds_write_b32 v79, v30 offset:256
  v_add_f32 v33, v33, v35
  v_cvt_pk_bf16_f32 v31, v29, v33
  v_smfmac_f32_16x16x64_bf16 v[40:43], v[0:3], a[104:111], v74
  ds_write_b32 v79, v31 offset:832
  v_xor_b32 v75, 0x8000, v75
  v_smfmac_f32_16x16x64_bf16 v[36:39], v[4:7], a[112:119], v74
  ds_read_b128 v[0:3], v76 offset:4608
  v_mov_b32 v29, 0
  v_smfmac_f32_16x16x64_bf16 v[40:43], v[4:7], a[120:127], v74
  s_waitcnt vmcnt(4) lgkmcnt(3)
  v_mov_b32 v30, 0
  v_mfma_f32_16x16x32_bf16 v[44:47], v[44:47], v[60:63], 0
  ds_read_b128 v[4:7], v76 offset:5632
  s_waitcnt lgkmcnt(2)
  v_mfma_f32_16x16x32_bf16 v[44:47], v[48:51], v[64:67], v[44:47]
  s_barrier
  v_smfmac_f32_16x16x64_bf16 v[36:39], v[8:11], a[160:167], v74
  ds_read_b128 v[20:23], v77 offset:256
  ds_read_b128 v[24:27], v77 offset:384
  v_smfmac_f32_16x16x64_bf16 v[40:43], v[8:11], a[168:175], v74
  ds_read_b128 v[8:11], v76 offset:6656
  v_add_f32_dpp v72, v46, v44 quad_perm:[2,3,0,1] row_mask:0xf bank_mask:0xf
  v_add_f32_dpp v73, v47, v45 quad_perm:[2,3,0,1] row_mask:0xf bank_mask:0xf
  v_smfmac_f32_16x16x64_bf16 v[36:39], v[12:15], a[144:151], v74
  s_waitcnt lgkmcnt(4)
  v_exp_f32_dpp v72, v72 quad_perm:[0,1,0,1] row_mask:0xf bank_mask:0xf
  v_smfmac_f32_16x16x64_bf16 v[40:43], v[12:15], a[152:159], v74
  ds_read_b128 v[12:15], v76 offset:7680
  v_exp_f32_dpp v73, v73 quad_perm:[0,1,0,1] row_mask:0xf bank_mask:0xf
  v_smfmac_f32_16x16x64_bf16 v[36:39], v[0:3], a[32:39], v74
  s_waitcnt lgkmcnt(2)
  v_cvt_pk_bf16_f32 v72, v72, v73
  v_mfma_f32_16x16x32_bf16 v[20:23], v[20:23], v[60:63], 0
  ds_write_b32 v78, v72 offset:520
  v_mov_b64 v[16:17], 0
  v_mfma_f32_16x16x32_bf16 v[20:23], v[24:27], v[64:67], v[20:23]
  ds_read_b128 v[44:47], v75 offset:24576
  v_mov_b64 v[18:19], 0
  v_smfmac_f32_16x16x64_bf16 v[40:43], v[0:3], a[40:47], v74
  ds_read_b128 v[48:51], v75 offset:25600
  s_waitcnt lgkmcnt(4)
  v_smfmac_f32_16x16x64_bf16 v[36:39], v[4:7], a[48:55], v74
  v_add_f32_dpp v24, v22, v20 quad_perm:[2,3,0,1] row_mask:0xf bank_mask:0xf
  v_add_f32_dpp v25, v23, v21 quad_perm:[2,3,0,1] row_mask:0xf bank_mask:0xf
  v_smfmac_f32_16x16x64_bf16 v[36:39], v[8:11], a[64:71], v74
  s_waitcnt lgkmcnt(2)
  s_barrier
  ds_read_b128 v[32:35], v78 offset:512
  v_smfmac_f32_16x16x64_bf16 v[36:39], v[12:15], a[80:87], v74
  ds_read_b128 v[60:63], v75 offset:26624
  v_mul_f32 v24, s69, v24
  v_smfmac_f32_16x16x64_bf16 v[40:43], v[4:7], a[56:63], v74
  ds_read_b128 v[64:67], v75 offset:27648
  v_mul_f32 v25, s69, v25
  v_smfmac_f32_16x16x64_bf16 v[40:43], v[8:11], a[72:79], v74
  v_exp_f32_dpp v24, v24 quad_perm:[0,1,0,1] row_mask:0xf bank_mask:0xf
  v_smfmac_f32_16x16x64_bf16 v[40:43], v[12:15], a[88:95], v74
  s_waitcnt vmcnt(2) lgkmcnt(2)
  v_exp_f32_dpp v25, v25 quad_perm:[0,1,0,1] row_mask:0xf bank_mask:0xf
  v_mfma_f32_16x16x32_bf16 v[8:11], v[32:35], v[68:71], 0
  v_add_f32 v36, v36, v38
  v_add_f32 v37, v37, v39
  v_mfma_f32_16x16x32_bf16 v[0:3], v[32:35], v[52:55], 0
  v_add_f32 v40, v40, v42
  v_add_f32 v41, v41, v43
  v_mfma_f32_16x16x32_bf16 v[4:7], v[32:35], v[56:59], 0
  v_cvt_pk_bf16_f32 v28, v24, v25
  v_cvt_pk_bf16_f32 v72, v36, v37
  v_cvt_pk_bf16_f32 v73, v40, v41
  v_mfma_f32_16x16x16_bf16 v[8:11], v[28:29], v[68:69], v[8:11]
  v_cvt_pk_bf16_f32 v31, v24, v25
  v_mov_b64 v[20:21], 0
  v_mfma_f32_16x16x16_bf16 v[0:3], v[28:29], v[72:73], v[0:3]
  ds_read_b128 v[68:71], v76 offset:13824
  v_mov_b64 v[22:23], 0
  v_mfma_f32_16x16x16_bf16 v[4:7], v[30:31], v[72:73], v[4:7]
  v_rcp_f32 v10, v8
  v_rcp_f32 v11, v9
  v_mul_f32 v0, v10, v0
  v_mul_f32 v1, v11, v1
  s_nop 0
  v_mul_f32 v4, v10, v4
  v_mul_f32 v5, v11, v5
  v_cvt_pk_bf16_f32 v2, v0, v4
  ds_write_b32 v79, v2 offset:8704
  v_cvt_pk_bf16_f32 v3, v1, v5
  ds_write_b32 v79, v3 offset:9280
  v_max3_f32 v8, v8, v9, v10
  v_max_f32 v8, v8, v11
  v_cmp_le_f32 vcc, 1317011456, v8
  v_mov_b64 v[24:25], 0
  v_mov_b64 v[26:27], 0
  s_cbranch_vccnz Cs2_mx
Cs2_mxok:
  s_waitcnt lgkmcnt(0)
  s_barrier
  ds_read_b128 v[0:3], v78 offset:8704
  ds_read_b128 v[4:7], v78 offset:8768
  ds_read_b128 v[8:11], v78 offset:8832
  ds_read_b128 v[12:15], v78 offset:8896
  s_cmp_eq_u32 s66, 63
  s_cbranch_scc1 Cs2_last
  s_waitcnt lgkmcnt(3)
  v_smfmac_f32_16x16x64_bf16 v[16:19], v[0:3], v[44:51], v74
  ds_read_b128 v[52:55], v75 offset:40960
  s_waitcnt lgkmcnt(3)
  v_smfmac_f32_16x16x64_bf16 v[16:19], v[4:7], v[60:67], v74
  ds_read_b128 v[56:59], v75 offset:41984
  s_waitcnt lgkmcnt(3)
  v_smfmac_f32_16x16x64_bf16 v[16:19], v[8:11], a[176:183], v74
  ds_read_b128 v[36:39], v75 offset:43008
  s_waitcnt lgkmcnt(3)
  v_smfmac_f32_16x16x64_bf16 v[16:19], v[12:15], a[184:191], v74
  ds_read_b128 v[40:43], v75 offset:44032
  ds_read_b128 v[44:47], v75 offset:57344
  v_smfmac_f32_16x16x64_bf16 v[20:23], v[0:3], a[192:199], v74
  ds_read_b128 v[48:51], v75 offset:58368
  ds_read_b128 v[60:63], v75 offset:59392
  v_smfmac_f32_16x16x64_bf16 v[20:23], v[4:7], a[200:207], v74
  ds_read_b128 v[64:67], v75 offset:60416
  s_waitcnt lgkmcnt(6)
  v_cvt_pk_bf16_f32 v16, v16, v17
  v_cvt_pk_bf16_f32 v17, v18, v19
  v_bfi_b32 v16, 1, s72, v16
  v_smfmac_f32_16x16x64_bf16 v[20:23], v[8:11], v[52:59], v74
  buffer_store_dwordx2 v[16:17], v68, s[8:11], s73 offen sc1
  s_waitcnt lgkmcnt(4)
  v_smfmac_f32_16x16x64_bf16 v[20:23], v[12:15], v[36:43], v74
  ds_read_b128 v[52:55], v75 offset:0
  v_mov_b64 v[32:33], 0
  v_smfmac_f32_16x16x64_bf16 v[24:27], v[0:3], a[208:215], v74
  ds_read_b128 v[56:59], v75 offset:1024
  v_mov_b64 v[34:35], 0
  v_smfmac_f32_16x16x64_bf16 v[24:27], v[4:7], a[216:223], v74
  ds_read_b128 v[36:39], v75 offset:2048
  s_waitcnt lgkmcnt(5)
  v_cvt_pk_bf16_f32 v20, v20, v21
  v_cvt_pk_bf16_f32 v21, v22, v23
  v_bfi_b32 v20, 1, s72, v20
  v_smfmac_f32_16x16x64_bf16 v[24:27], v[8:11], v[44:51], v74
  buffer_store_dwordx2 v[20:21], v68, s[8:11], s74 offen sc1
  s_waitcnt lgkmcnt(3)
  v_smfmac_f32_16x16x64_bf16 v[24:27], v[12:15], v[60:67], v74
  ds_read_b128 v[40:43], v75 offset:3072
  v_mov_b64 v[28:29], 0
  v_smfmac_f32_16x16x64_bf16 v[32:35], v[0:3], a[224:231], v74
  ds_read_b128 v[44:47], v75 offset:4096
  ds_read_b128 v[48:51], v75 offset:5120
  v_smfmac_f32_16x16x64_bf16 v[32:35], v[4:7], a[232:239], v74
  ds_read_b128 v[60:63], v75 offset:6144
  v_cvt_pk_bf16_f32 v24, v24, v25
  v_cvt_pk_bf16_f32 v25, v26, v27
  v_bfi_b32 v24, 1, s72, v24
  v_smfmac_f32_16x16x64_bf16 v[32:35], v[8:11], a[240:247], v74
  buffer_store_dwordx2 v[24:25], v68, s[8:11], s75 offen sc1
  v_mov_b64 v[30:31], 0
  v_smfmac_f32_16x16x64_bf16 v[32:35], v[12:15], a[248:255], v74
  ds_read_b128 v[64:67], v75 offset:7168
  s_waitcnt lgkmcnt(6)
  v_smfmac_f32_16x16x64_bf16 v[28:31], v[0:3], v[52:59], v74
  s_waitcnt lgkmcnt(4)
  v_smfmac_f32_16x16x64_bf16 v[28:31], v[4:7], v[36:43], v74
  s_waitcnt lgkmcnt(2)
  v_cvt_pk_bf16_f32 v32, v32, v33
  v_cvt_pk_bf16_f32 v33, v34, v35
  v_bfi_b32 v32, 1, s72, v32
  v_smfmac_f32_16x16x64_bf16 v[28:31], v[8:11], v[44:51], v74
  buffer_store_dwordx2 v[32:33], v68, s[8:11], s76 offen sc1
  s_waitcnt lgkmcnt(0)
  v_smfmac_f32_16x16x64_bf16 v[28:31], v[12:15], v[60:67], v74
  ds_read_b128 v[0:3], v76 offset:14848
  ds_read_b64 v[16:17], v77 offset:384
  v_mov_b64 v[18:19], v[72:73]
  v_xor_b32 v75, 0x8000, v75
  s_nop 3
  v_cvt_pk_bf16_f32 v28, v28, v29
  v_cvt_pk_bf16_f32 v29, v30, v31
  v_bfi_b32 v28, 1, s72, v28
  buffer_store_dwordx2 v[28:29], v68, s[8:11], s77 offen sc1
  v_mov_b64 v[20:21], 0
  v_mov_b64 v[22:23], 0
  v_mov_b64 v[24:25], 0
  v_mov_b64 v[26:27], 0
  v_mov_b64 v[28:29], 0
  v_mov_b64 v[30:31], 0
  v_mov_b64 v[32:33], 0
  v_mov_b64 v[34:35], 0
  s_add_u32 s58, s58, 655360
  s_add_u32 s59, s59, 655360
  s_add_u32 s70, s70, 655360
  s_add_u32 s68, s68, 655360
  s_add_u32 s66, s66, 1
  s_xor_b32 s64, s64, 16384
  s_xor_b32 s65, s65, 16384
  s_nop 15
  s_nop 15
  s_nop 7
  buffer_load_dwordx4 v[52:55], v76, s[8:11], s60 offen offset:0 sc1
  buffer_load_dwordx4 v[56:59], v76, s[8:11], s60 offen offset:1024 sc1
  s_nop 15
  s_nop 11
  buffer_load_dwordx4 v[36:39], v76, s[8:11], s60 offen offset:0 sc1
  buffer_load_dwordx4 v[40:43], v76, s[8:11], s60 offen offset:1024 sc1
  s_waitcnt lgkmcnt(0)
  s_waitcnt vmcnt(3)
  v_mfma_f32_16x16x32_bf16 v[4:7], v[0:3], v[52:55], 0
  v_bitop3_b32 v72, v52, v54, s72 bitop3:0x7e
  s_waitcnt vmcnt(2)
  v_mfma_f32_16x16x32_bf16 v[4:7], v[0:3], v[56:59], v[4:7]
  v_bitop3_b32 v73, v56, v58, s72 bitop3:0x7e
  v_bitop3_b32 v72, v72, v73, 1 bitop3:0xa8
  v_cmp_ne_u32 vcc, 0, v72
  s_nop 0
  s_cmp_eq_u64 vcc, 0
  s_cselect_b32 s54, s62, 268435456
  s_nop 0
  v_add_f32_dpp v4, v4, v4 row_ror:4 row_mask:0xf bank_mask:0xf
  v_add_f32_dpp v5, v5, v5 row_ror:4 row_mask:0xf bank_mask:0xf
  s_nop 0
  v_add_f32_dpp v4, v4, v4 row_ror:8 row_mask:0xf bank_mask:0xf
  v_add_f32_dpp v5, v5, v5 row_ror:8 row_mask:0xf bank_mask:0xf
  v_cvt_pk_bf16_f32 v4, v4, v5
  buffer_store_dword v4, v69, s[8:11], s54 offen sc1
  s_cbranch_vccnz Cs2_h1r
  s_xor_b32 s62, s62, 16384
  buffer_store_dword v71, v69, s[8:11], s62 offen sc1
  s_xor_b32 s72, s72, 1
  s_branch Cs2_h2
Cs2_h1r:
  s_mov_b64 exec, vcc
  buffer_load_dwordx4 v[52:55], v76, s[8:11], s60 offen offset:0 sc1
  buffer_load_dwordx4 v[56:59], v76, s[8:11], s60 offen offset:1024 sc1
  s_mov_b64 exec, -1
  s_add_u32 s67, s67, 1
  s_waitcnt vmcnt(4)
  v_mfma_f32_16x16x32_bf16 v[4:7], v[0:3], v[36:39], 0
  v_bitop3_b32 v72, v36, v38, s72 bitop3:0x7e
  s_waitcnt vmcnt(3)
  v_mfma_f32_16x16x32_bf16 v[4:7], v[0:3], v[40:43], v[4:7]
  v_bitop3_b32 v73, v40, v42, s72 bitop3:0x7e
  v_bitop3_b32 v72, v72, v73, 1 bitop3:0xa8
  v_cmp_ne_u32 vcc, 0, v72
  s_cbranch_vccz Cs2_h1p
  s_mov_b64 exec, vcc
  buffer_load_dwordx4 v[36:39], v76, s[8:11], s60 offen offset:0 sc1
  buffer_load_dwordx4 v[40:43], v76, s[8:11], s60 offen offset:1024 sc1
  s_mov_b64 exec, -1
  s_add_u32 s67, s67, 1
  s_waitcnt vmcnt(3)
  v_mfma_f32_16x16x32_bf16 v[4:7], v[0:3], v[52:55], 0
  v_bitop3_b32 v72, v52, v54, s72 bitop3:0x7e
  s_waitcnt vmcnt(2)
  v_mfma_f32_16x16x32_bf16 v[4:7], v[0:3], v[56:59], v[4:7]
  v_bitop3_b32 v73, v56, v58, s72 bitop3:0x7e
  v_bitop3_b32 v72, v72, v73, 1 bitop3:0xa8
  v_cmp_ne_u32 vcc, 0, v72
  s_cbranch_vccz Cs2_h1p
Cs2_h1s:
  s_mov_b64 exec, vcc
  buffer_load_dwordx4 v[52:55], v76, s[8:11], s60 offen offset:0 sc1
  buffer_load_dwordx4 v[56:59], v76, s[8:11], s60 offen offset:1024 sc1
  s_mov_b64 exec, -1
  s_add_u32 s67, s67, 1
  s_waitcnt vmcnt(3)
  v_mfma_f32_16x16x32_bf16 v[4:7], v[0:3], v[36:39], 0
  v_bitop3_b32 v72, v36, v38, s72 bitop3:0x7e
  s_waitcnt vmcnt(2)
  v_mfma_f32_16x16x32_bf16 v[4:7], v[0:3], v[40:43], v[4:7]
  v_bitop3_b32 v73, v40, v42, s72 bitop3:0x7e
  v_bitop3_b32 v72, v72, v73, 1 bitop3:0xa8
  v_cmp_ne_u32 vcc, 0, v72
  s_cbranch_vccz Cs2_h1p
  s_mov_b64 exec, vcc
  buffer_load_dwordx4 v[36:39], v76, s[8:11], s60 offen offset:0 sc1
  buffer_load_dwordx4 v[40:43], v76, s[8:11], s60 offen offset:1024 sc1
  s_mov_b64 exec, -1
  s_add_u32 s67, s67, 1
  s_waitcnt vmcnt(3)
  v_mfma_f32_16x16x32_bf16 v[4:7], v[0:3], v[52:55], 0
  v_bitop3_b32 v72, v52, v54, s72 bitop3:0x7e
  s_waitcnt vmcnt(2)
  v_mfma_f32_16x16x32_bf16 v[4:7], v[0:3], v[56:59], v[4:7]
  v_bitop3_b32 v73, v56, v58, s72 bitop3:0x7e
  v_bitop3_b32 v72, v72, v73, 1 bitop3:0xa8
  v_cmp_ne_u32 vcc, 0, v72
  s_cbranch_vccz Cs2_h1p
  s_cmp_lt_u32 s67, 131072
  s_cbranch_scc1 Cs2_h1s
Cs2_h1p:
  s_nop 2
  v_add_f32_dpp v4, v4, v4 row_ror:4 row_mask:0xf bank_mask:0xf
  v_add_f32_dpp v5, v5, v5 row_ror:4 row_mask:0xf bank_mask:0xf
  s_nop 0
  v_add_f32_dpp v4, v4, v4 row_ror:8 row_mask:0xf bank_mask:0xf
  v_add_f32_dpp v5, v5, v5 row_ror:8 row_mask:0xf bank_mask:0xf
  v_cvt_pk_bf16_f32 v4, v4, v5
  buffer_store_dword v4, v69, s[8:11], s62 offen sc1
  s_xor_b32 s62, s62, 16384
  buffer_store_dword v71, v69, s[8:11], s62 offen sc1
  s_xor_b32 s72, s72, 1
  s_branch Cs2_h2
Cs2_h2r:
  s_mov_b64 exec, vcc
  buffer_load_dwordx4 v[52:55], v76, s[8:11], s65 offen offset:3072 sc1
  s_mov_b64 exec, -1
  s_add_u32 s67, s67, 1
  s_waitcnt vmcnt(2)
  v_max3_u32 v72, v52, v53, v54
  v_max_u32 v72, v72, v55
  ds_write_b128 v76, v[52:55] offset:7680
  v_cmp_eq_u32 vcc, -1, v72
  s_cbranch_vccz Cs2_h2w
  s_mov_b64 exec, vcc
  buffer_load_dwordx4 v[52:55], v76, s[8:11], s65 offen offset:3072 sc1
  s_mov_b64 exec, -1
  s_add_u32 s67, s67, 1
  s_waitcnt vmcnt(2)
  v_max3_u32 v72, v52, v53, v54
  v_max_u32 v72, v72, v55
  ds_write_b128 v76, v[52:55] offset:7680
  v_cmp_eq_u32 vcc, -1, v72
  s_cbranch_vccz Cs2_h2w
  s_mov_b64 exec, vcc
  buffer_load_dwordx4 v[52:55], v76, s[8:11], s65 offen offset:3072 sc1
  s_mov_b64 exec, -1
  s_add_u32 s67, s67, 1
  s_waitcnt vmcnt(2)
  v_max3_u32 v72, v52, v53, v54
  v_max_u32 v72, v72, v55
  ds_write_b128 v76, v[52:55] offset:7680
  v_cmp_eq_u32 vcc, -1, v72
  s_cbranch_vccz Cs2_h2w
  s_mov_b64 exec, vcc
  buffer_load_dwordx4 v[52:55], v76, s[8:11], s65 offen offset:3072 sc1
  s_mov_b64 exec, -1
  s_add_u32 s67, s67, 1
  s_waitcnt vmcnt(2)
  v_max3_u32 v72, v52, v53, v54
  v_max_u32 v72, v72, v55
  ds_write_b128 v76, v[52:55] offset:7680
  v_cmp_eq_u32 vcc, -1, v72
  s_cbranch_vccz Cs2_h2w
  s_cmp_lt_u32 s67, 131072
  s_cbranch_scc1 Cs2_h2r
Cs2_h2ok:
  ds_write_b128 v76, v[52:55] offset:7680
  s_branch Cs2_h2w
Cs2_rec:
  s_nop 7
  s_waitcnt vmcnt(0) lgkmcnt(0)
  v_max3_u32 v72, v0, v1, v2
  v_max3_u32 v72, v72, v3, v4
  v_max3_u32 v72, v72, v5, v6
  v_max3_u32 v72, v72, v7, v8
  v_max3_u32 v72, v72, v9, v10
  v_max3_u32 v72, v72, v11, v12
  v_max3_u32 v72, v72, v13, v14
  v_max3_u32 v72, v72, v15, v16
  v_max3_u32 v72, v72, v17, v18
  v_max_u32 v72, v72, v19
  v_cmp_eq_u32 vcc, -1, v72
  s_cbranch_vccz Cs2_recok
  s_barrier
Cs2_recp:
  buffer_load_dwordx4 v[0:3], v76, s[8:11], s64 offen offset:0 sc1
  buffer_load_dwordx4 v[4:7], v76, s[8:11], s64 offen offset:1024 sc1
  s_add_u32 s67, s67, 1
  s_cmp_lt_u32 s67, 131072
  s_cselect_b32 s54, -2, -1
  s_waitcnt vmcnt(1)
  v_max3_u32 v72, v0, v1, v2
  s_waitcnt vmcnt(0)
  v_max3_u32 v72, v72, v3, v4
  v_max3_u32 v72, v72, v5, v6
  v_max_u32 v72, v72, v7
  v_cmp_lt_u32 vcc, s54, v72
  s_cbranch_vccnz Cs2_recp
  ds_write_b128 v76, v[0:3] offset:8704
  ds_write_b128 v76, v[4:7] offset:9728
  v_mov_b64 v[20:21], 0
  v_mov_b64 v[22:23], 0
  v_mov_b64 v[24:25], 0
  v_mov_b64 v[26:27], 0
  v_mov_b64 v[28:29], 0
  v_mov_b64 v[30:31], 0
  v_mov_b64 v[32:33], 0
  v_mov_b64 v[34:35], 0
  s_waitcnt lgkmcnt(0)
  s_barrier
  ds_read_b128 v[0:3], v76 offset:4608
  ds_read_b128 v[60:63], v76 offset:24576
  ds_read_b128 v[64:67], v76 offset:25600
  s_waitcnt lgkmcnt(0)
  v_smfmac_f32_16x16x64_bf16 v[20:23], v[0:3], v[60:67], v74
  ds_read_b128 v[60:63], v76 offset:26624
  ds_read_b128 v[64:67], v76 offset:27648
  s_waitcnt lgkmcnt(0)
  v_smfmac_f32_16x16x64_bf16 v[24:27], v[0:3], v[60:67], v74
  ds_read_b128 v[60:63], v76 offset:40960
  ds_read_b128 v[64:67], v76 offset:41984
  s_waitcnt lgkmcnt(0)
  v_smfmac_f32_16x16x64_bf16 v[28:31], v[0:3], v[60:67], v74
  ds_read_b128 v[60:63], v76 offset:43008
  ds_read_b128 v[64:67], v76 offset:44032
  s_waitcnt lgkmcnt(0)
  v_smfmac_f32_16x16x64_bf16 v[32:35], v[0:3], v[60:67], v74
  ds_read_b128 v[4:7], v76 offset:5632
  s_waitcnt lgkmcnt(0)
  v_smfmac_f32_16x16x64_bf16 v[20:23], v[4:7], v[80:87], v74
  v_smfmac_f32_16x16x64_bf16 v[24:27], v[4:7], v[88:95], v74
  v_smfmac_f32_16x16x64_bf16 v[28:31], v[4:7], v[208:215], v74
  v_smfmac_f32_16x16x64_bf16 v[32:35], v[4:7], v[216:223], v74
  ds_read_b128 v[8:11], v76 offset:6656
  s_waitcnt lgkmcnt(0)
  v_smfmac_f32_16x16x64_bf16 v[20:23], v[8:11], v[96:103], v74
  v_smfmac_f32_16x16x64_bf16 v[24:27], v[8:11], v[104:111], v74
  ds_read_b128 v[60:63], v76 offset:57344
  ds_read_b128 v[64:67], v76 offset:58368
  s_waitcnt lgkmcnt(0)
  v_smfmac_f32_16x16x64_bf16 v[28:31], v[8:11], v[60:67], v74
  ds_read_b128 v[60:63], v76 offset:59392
  ds_read_b128 v[64:67], v76 offset:60416
  s_waitcnt lgkmcnt(0)
  v_smfmac_f32_16x16x64_bf16 v[32:35], v[8:11], v[60:67], v74
  ds_read_b128 v[12:15], v76 offset:7680
  s_waitcnt lgkmcnt(0)
  v_smfmac_f32_16x16x64_bf16 v[20:23], v[12:15], v[112:119], v74
  v_smfmac_f32_16x16x64_bf16 v[24:27], v[12:15], v[120:127], v74
  v_smfmac_f32_16x16x64_bf16 v[28:31], v[12:15], v[224:231], v74
  v_smfmac_f32_16x16x64_bf16 v[32:35], v[12:15], v[232:239], v74
  ds_read_b128 v[0:3], v76 offset:8704
  s_waitcnt lgkmcnt(0)
  v_smfmac_f32_16x16x64_bf16 v[20:23], v[0:3], v[128:135], v74
  v_smfmac_f32_16x16x64_bf16 v[24:27], v[0:3], v[136:143], v74
  ds_read_b128 v[60:63], v75 offset:8192
  ds_read_b128 v[64:67], v75 offset:9216
  s_waitcnt lgkmcnt(0)
  v_smfmac_f32_16x16x64_bf16 v[28:31], v[0:3], v[60:67], v74
  ds_read_b128 v[60:63], v75 offset:10240
  ds_read_b128 v[64:67], v75 offset:11264
  s_waitcnt lgkmcnt(0)
  v_smfmac_f32_16x16x64_bf16 v[32:35], v[0:3], v[60:67], v74
  ds_read_b128 v[4:7], v76 offset:9728
  s_waitcnt lgkmcnt(0)
  v_smfmac_f32_16x16x64_bf16 v[20:23], v[4:7], v[144:151], v74
  v_smfmac_f32_16x16x64_bf16 v[24:27], v[4:7], v[152:159], v74
  ds_read_b128 v[60:63], v75 offset:24576
  ds_read_b128 v[64:67], v75 offset:25600
  s_waitcnt lgkmcnt(0)
  v_smfmac_f32_16x16x64_bf16 v[28:31], v[4:7], v[60:67], v74
  ds_read_b128 v[60:63], v75 offset:26624
  ds_read_b128 v[64:67], v75 offset:27648
  s_waitcnt lgkmcnt(0)
  v_smfmac_f32_16x16x64_bf16 v[32:35], v[4:7], v[60:67], v74
  ds_read_b128 v[16:19], v76 offset:10752
  s_waitcnt lgkmcnt(0)
  v_smfmac_f32_16x16x64_bf16 v[20:23], v[16:19], v[160:167], v74
  v_smfmac_f32_16x16x64_bf16 v[24:27], v[16:19], v[168:175], v74
  v_smfmac_f32_16x16x64_bf16 v[28:31], v[16:19], v[240:247], v74
  v_smfmac_f32_16x16x64_bf16 v[32:35], v[16:19], v[248:255], v74
  ds_read_b128 v[12:15], v76 offset:11776
  s_waitcnt lgkmcnt(0)
  v_smfmac_f32_16x16x64_bf16 v[20:23], v[12:15], v[176:183], v74
  v_smfmac_f32_16x16x64_bf16 v[24:27], v[12:15], v[184:191], v74
  v_smfmac_f32_16x16x64_bf16 v[28:31], v[12:15], a[0:7], v74
  v_smfmac_f32_16x16x64_bf16 v[32:35], v[12:15], a[8:15], v74
  ds_read_b128 v[8:11], v76 offset:12800
  s_waitcnt lgkmcnt(0)
  v_smfmac_f32_16x16x64_bf16 v[20:23], v[8:11], v[192:199], v74
  v_smfmac_f32_16x16x64_bf16 v[24:27], v[8:11], v[200:207], v74
  v_smfmac_f32_16x16x64_bf16 v[28:31], v[8:11], a[16:23], v74
  v_smfmac_f32_16x16x64_bf16 v[32:35], v[8:11], a[24:31], v74
  v_add_f32 v20, v20, v22
  v_add_f32 v21, v21, v23
  v_add_f32 v24, v24, v26
  v_cvt_pk_bf16_f32 v22, v20, v24
  s_nop 0
  ds_write_b32 v79, v22 offset:0
  v_add_f32 v25, v25, v27
  v_cvt_pk_bf16_f32 v23, v21, v25
  ds_write_b32 v79, v23 offset:576
  v_add_f32 v28, v28, v30
  v_add_f32 v29, v29, v31
  s_waitcnt lgkmcnt(0)
  s_nop 1
  s_branch Cs2_recok
Cs2_mx:
  s_waitcnt lgkmcnt(0)
  s_barrier
  buffer_load_dwordx4 v[0:3], v76, s[8:11], s58 offen offset:0 sc1
  ds_read_b128 v[20:23], v77 offset:0
  ds_read_b128 v[28:31], v77 offset:256
  buffer_load_dwordx4 v[4:7], v76, s[8:11], s58 offen offset:1024 sc1
  ds_read_b128 v[24:27], v77 offset:128
  ds_read_b128 v[32:35], v77 offset:384
  s_waitcnt vmcnt(1) lgkmcnt(3)
  v_mfma_f32_16x16x32_bf16 v[8:11], v[0:3], v[20:23], 0
  s_waitcnt vmcnt(0) lgkmcnt(1)
  v_mfma_f32_16x16x32_bf16 v[8:11], v[4:7], v[24:27], v[8:11]
  v_mfma_f32_16x16x32_bf16 v[12:15], v[28:31], v[20:23], 0
  s_waitcnt lgkmcnt(0)
  v_mfma_f32_16x16x32_bf16 v[12:15], v[32:35], v[24:27], v[12:15]
  v_add_f32_dpp v8, v10, v8 quad_perm:[2,3,0,1] row_mask:0xf bank_mask:0xf
  v_add_f32_dpp v9, v11, v9 quad_perm:[2,3,0,1] row_mask:0xf bank_mask:0xf
  s_nop 0
  v_mov_b32_dpp v8, v8 quad_perm:[0,1,0,1] row_mask:0xf bank_mask:0xf
  v_mov_b32_dpp v9, v9 quad_perm:[0,1,0,1] row_mask:0xf bank_mask:0xf
  s_nop 1
  v_add_f32_dpp v12, v14, v12 quad_perm:[2,3,0,1] row_mask:0xf bank_mask:0xf
  v_add_f32_dpp v13, v15, v13 quad_perm:[2,3,0,1] row_mask:0xf bank_mask:0xf
  s_nop 0
  v_mov_b32_dpp v12, v12 quad_perm:[0,1,0,1] row_mask:0xf bank_mask:0xf
  v_mov_b32_dpp v13, v13 quad_perm:[0,1,0,1] row_mask:0xf bank_mask:0xf
  v_mul_f32 v12, s69, v12
  ds_write_b32 v78, v8 offset:8712
  v_mul_f32 v13, s69, v13
  ds_write_b32 v78, v9 offset:8776
  s_waitcnt lgkmcnt(0)
  s_barrier
  ds_read_b128 v[36:39], v78 offset:8704
  ds_read_b128 v[40:43], v78 offset:8768
  s_waitcnt lgkmcnt(0)
  s_barrier
  v_max_f32 v16, v36, v37
  v_max3_f32 v16, v16, v38, v39
  v_max3_f32 v16, v16, v40, v41
  v_max3_f32 v16, v16, v42, v43
  v_max3_f32 v16, v16, v12, v13
  v_mov_b32 v17, v16
  s_nop 1
  v_permlane16_swap_b32 v16, v17
  v_max_f32 v16, v16, v17
  v_mov_b32 v17, v16
  s_nop 1
  v_permlane32_swap_b32 v16, v17
  v_max_f32 v16, v16, v17
  v_sub_f32 v36, v36, v16
  v_sub_f32 v37, v37, v16
  v_sub_f32 v38, v38, v16
  v_sub_f32 v39, v39, v16
  v_sub_f32 v40, v40, v16
  v_sub_f32 v41, v41, v16
  v_sub_f32 v42, v42, v16
  v_sub_f32 v43, v43, v16
  v_sub_f32 v12, v12, v16
  v_sub_f32 v13, v13, v16
  v_exp_f32 v36, v36
  v_exp_f32 v37, v37
  v_exp_f32 v38, v38
  v_exp_f32 v39, v39
  v_exp_f32 v40, v40
  v_exp_f32 v41, v41
  v_exp_f32 v42, v42
  v_exp_f32 v43, v43
  v_exp_f32 v12, v12
  v_exp_f32 v13, v13
  v_cvt_pk_bf16_f32 v32, v36, v40
  v_cvt_pk_bf16_f32 v33, v37, v41
  v_cvt_pk_bf16_f32 v34, v38, v42
  v_cvt_pk_bf16_f32 v35, v39, v43
  v_cvt_pk_bf16_f32 v28, v12, v13
  v_cvt_pk_bf16_f32 v31, v12, v13
  v_mov_b32 v29, 0
  v_mov_b32 v30, 0
  v_mov_b32 v68, 0x3f803f80
  v_mov_b32 v69, 0x3f803f80
  v_mov_b32 v70, 0x3f803f80
  v_mov_b32 v71, 0x3f803f80
  s_nop 1
  v_mfma_f32_16x16x32_bf16 v[8:11], v[32:35], v[68:71], 0
  v_mfma_f32_16x16x32_bf16 v[0:3], v[32:35], v[52:55], 0
  v_mfma_f32_16x16x32_bf16 v[4:7], v[32:35], v[56:59], 0
  v_mfma_f32_16x16x16_bf16 v[8:11], v[28:29], v[68:69], v[8:11]
  v_mfma_f32_16x16x16_bf16 v[0:3], v[28:29], v[72:73], v[0:3]
  v_mfma_f32_16x16x16_bf16 v[4:7], v[30:31], v[72:73], v[4:7]
  ds_read_b128 v[68:71], v76 offset:13824
  v_rcp_f32 v10, v8
  v_rcp_f32 v11, v9
  v_mul_f32 v0, v10, v0
  v_mul_f32 v1, v11, v1
  s_nop 0
  v_mul_f32 v4, v10, v4
  v_mul_f32 v5, v11, v5
  v_cvt_pk_bf16_f32 v2, v0, v4
  ds_write_b32 v79, v2 offset:8704
  v_cvt_pk_bf16_f32 v3, v1, v5
  ds_write_b32 v79, v3 offset:9280
  v_mov_b64 v[16:17], 0
  v_mov_b64 v[18:19], 0
  v_mov_b64 v[20:21], 0
  v_mov_b64 v[22:23], 0
  v_mov_b64 v[24:25], 0
  v_mov_b64 v[26:27], 0
  s_branch Cs2_mxok
Cs2_last:
  s_waitcnt vmcnt(0) lgkmcnt(0)
  ds_read_b64 v[16:17], v77 offset:384
  v_mov_b64 v[18:19], v[72:73]
  s_add_u32 s68, s68, 655360
  s_waitcnt lgkmcnt(0)
  buffer_store_dwordx4 v[16:19], v76, s[8:11], s68 offen sc1
  s_waitcnt vmcnt(0)
  s_barrier
  s_branch L_cexit
L_w7:
  v_mov_b64 v[20:21], 0
  v_mov_b64 v[22:23], 0
  v_mov_b64 v[24:25], 0
  v_mov_b64 v[26:27], 0
  v_mov_b64 v[28:29], 0
  v_mov_b64 v[30:31], 0
  v_mov_b64 v[32:33], 0
  v_mov_b64 v[34:35], 0
  s_mov_b32 s78, 0x3f803f80
  s_mov_b32 s79, s78
  s_mov_b32 s65, 360448
  s_mov_b32 m0, 15872
  v_lshlrev_b32 v73, 2, v76
  v_mov_b32 v72, 0
  ds_read_b128 v[60:63], v76 offset:28672
  ds_read_b128 v[64:67], v76 offset:29696
  ds_read_b128 v[44:47], v76 offset:30720
  ds_read_b128 v[48:51], v76 offset:31744
  ds_read_b128 v[36:39], v76 offset:45056
  ds_read_b128 v[40:43], v76 offset:46080
  ds_read_b128 v[0:3], v76 offset:4608
  ds_read_b128 v[4:7], v76 offset:5632
  s_branch Cs3_top2
.p2align 6
Cs3_h2:
  v_lshlrev_b32 v73, 2, v76
  s_mov_b32 m0, 10752
  s_waitcnt vmcnt(4)
  ds_read_b128 v[60:63], v76 offset:28672
  ds_read_b128 v[64:67], v76 offset:29696
  ds_read_b128 v[44:47], v76 offset:30720
  ds_read_b128 v[48:51], v76 offset:31744
  ds_read_b128 v[36:39], v76 offset:45056
  ds_read_b128 v[40:43], v76 offset:46080
  v_mov_b32 v72, s66
  s_cmp_eq_u32 s66, 12
  s_cbranch_scc1 Cs3_kv2
Cs3_h2w:
  s_waitcnt lgkmcnt(0)
  s_barrier
  ds_read_b128 v[0:3], v76 offset:4608
  ds_read_b128 v[4:7], v76 offset:5632
  buffer_load_dwordx4 v76, s[8:11], s64 offen offset:0 sc1 lds
  buffer_load_dwordx4 v76, s[8:11], s64 offen offset:1024 sc1 lds
  buffer_load_dwordx4 v76, s[8:11], s64 offen offset:2048 sc1 lds
Cs3_top2:
  ds_read_b128 v[8:11], v76 offset:6656
  s_mov_b32 m0, 15872
  s_waitcnt lgkmcnt(2)
  v_smfmac_f32_16x16x64_bf16 v[20:23], v[0:3], v[60:67], v74
  ds_read_b128 v[60:63], v76 offset:47104
  v_smfmac_f32_16x16x64_bf16 v[24:27], v[0:3], v[44:51], v74
  ds_read_b128 v[64:67], v76 offset:48128
  s_waitcnt lgkmcnt(3)
  v_smfmac_f32_16x16x64_bf16 v[20:23], v[4:7], v[80:87], v74
  buffer_load_dwordx4 v[44:47], v76, s[8:11], s58 offen offset:0 sc1
  v_smfmac_f32_16x16x64_bf16 v[28:31], v[0:3], v[36:43], v74
  ds_read_b128 v[36:39], v76 offset:61440
  v_smfmac_f32_16x16x64_bf16 v[24:27], v[4:7], v[88:95], v74
  buffer_load_dwordx4 v[48:51], v76, s[8:11], s58 offen offset:1024 sc1
  ds_read_b128 v[40:43], v76 offset:62464
  v_smfmac_f32_16x16x64_bf16 v[28:31], v[4:7], v[208:215], v74
  ds_read_b128 v[12:15], v76 offset:7680
  s_waitcnt lgkmcnt(5)
  v_smfmac_f32_16x16x64_bf16 v[32:35], v[4:7], v[216:223], v74
  buffer_load_dwordx4 v[52:55], v76, s[8:11], s59 offen offset:0 sc1
  s_waitcnt lgkmcnt(3)
  v_smfmac_f32_16x16x64_bf16 v[32:35], v[0:3], v[60:67], v74
  buffer_load_dwordx4 v[56:59], v76, s[8:11], s59 offen offset:1024 sc1
  v_smfmac_f32_16x16x64_bf16 v[20:23], v[8:11], v[96:103], v74
  ds_read_b128 v[60:63], v76 offset:63488
  v_smfmac_f32_16x16x64_bf16 v[24:27], v[8:11], v[104:111], v74
  ds_read_b128 v[64:67], v76 offset:64512
  s_waitcnt lgkmcnt(3)
  v_smfmac_f32_16x16x64_bf16 v[28:31], v[8:11], v[36:43], v74
  buffer_load_dword v73, s[8:11], s70 offen lds
  ds_read_b128 v[36:39], v75 offset:12288
  s_waitcnt lgkmcnt(3)
  v_smfmac_f32_16x16x64_bf16 v[20:23], v[12:15], v[112:119], v74
  s_waitcnt vmcnt(5)
  ds_read_b128 v[40:43], v75 offset:13312
  v_smfmac_f32_16x16x64_bf16 v[24:27], v[12:15], v[120:127], v74
  s_barrier
  ds_read_b128 v[0:3], v76 offset:8704
  v_smfmac_f32_16x16x64_bf16 v[28:31], v[12:15], v[224:231], v74
  ds_read_b128 v[4:7], v76 offset:9728
  v_smfmac_f32_16x16x64_bf16 v[32:35], v[12:15], v[232:239], v74
  s_waitcnt lgkmcnt(4)
  v_smfmac_f32_16x16x64_bf16 v[32:35], v[8:11], v[60:67], v74
  buffer_store_dwordx4 v[16:19], v76, s[8:11], s68 offen sc1
  ds_read_b128 v[60:63], v75 offset:14336
  s_waitcnt lgkmcnt(2)
  v_smfmac_f32_16x16x64_bf16 v[20:23], v[0:3], v[128:135], v74
  ds_read_b128 v[16:19], v76 offset:10752
  v_smfmac_f32_16x16x64_bf16 v[24:27], v[0:3], v[136:143], v74
  ds_read_b128 v[64:67], v75 offset:15360
  v_smfmac_f32_16x16x64_bf16 v[28:31], v[0:3], v[36:43], v74
  ds_read_b128 v[36:39], v75 offset:28672
  s_waitcnt lgkmcnt(4)
  v_smfmac_f32_16x16x64_bf16 v[20:23], v[4:7], v[144:151], v74
  ds_read_b128 v[12:15], v76 offset:11776
  v_smfmac_f32_16x16x64_bf16 v[24:27], v[4:7], v[152:159], v74
  ds_read_b128 v[40:43], v75 offset:29696
  s_waitcnt lgkmcnt(4)
  v_smfmac_f32_16x16x64_bf16 v[20:23], v[16:19], v[160:167], v74
  ds_read_b128 v[8:11], v76 offset:12800
  s_waitcnt lgkmcnt(4)
  v_smfmac_f32_16x16x64_bf16 v[32:35], v[0:3], v[60:67], v74
  ds_read_b128 v[60:63], v75 offset:30720
  v_mov_b64 v[68:69], s[78:79]
  v_smfmac_f32_16x16x64_bf16 v[24:27], v[16:19], v[168:175], v74
  ds_read_b128 v[64:67], v75 offset:31744
  s_waitcnt lgkmcnt(4)
  v_mov_b64 v[70:71], s[78:79]
  v_smfmac_f32_16x16x64_bf16 v[20:23], v[12:15], v[176:183], v74
  s_mov_b64 exec, 1
  buffer_store_dword v72, v76, s[8:11], s71 offen sc1
  s_mov_b64 exec, -1
  s_waitcnt lgkmcnt(3)
  v_smfmac_f32_16x16x64_bf16 v[28:31], v[4:7], v[36:43], v74
  s_waitcnt lgkmcnt(2)
  v_mov_b64 v[36:37], 0
  v_smfmac_f32_16x16x64_bf16 v[20:23], v[8:11], v[192:199], v74
  v_mov_b64 v[38:39], 0
  v_smfmac_f32_16x16x64_bf16 v[24:27], v[12:15], v[184:191], v74
  v_mov_b64 v[40:41], 0
  v_smfmac_f32_16x16x64_bf16 v[24:27], v[8:11], v[200:207], v74
  s_waitcnt lgkmcnt(0)
  v_add_f32 v20, v20, v22
  v_smfmac_f32_16x16x64_bf16 v[32:35], v[4:7], v[60:67], v74
  v_add_f32 v21, v21, v23
  v_smfmac_f32_16x16x64_bf16 v[28:31], v[16:19], v[240:247], v74
  v_add_f32 v24, v24, v26
  v_cvt_pk_bf16_f32 v22, v20, v24
  v_smfmac_f32_16x16x64_bf16 v[28:31], v[12:15], a[0:7], v74
  ds_write_b32 v79, v22 offset:0
  v_add_f32 v25, v25, v27
  v_cvt_pk_bf16_f32 v23, v21, v25
  v_smfmac_f32_16x16x64_bf16 v[28:31], v[8:11], a[16:23], v74
  ds_write_b32 v79, v23 offset:576
  v_cmp_u_f32 vcc, v20, v21
  v_smfmac_f32_16x16x64_bf16 v[32:35], v[16:19], v[248:255], v74
  v_mov_b64 v[42:43], 0
  v_smfmac_f32_16x16x64_bf16 v[32:35], v[12:15], a[8:15], v74
  v_add_f32 v28, v28, v30
  v_add_f32 v29, v29, v31
  v_smfmac_f32_16x16x64_bf16 v[32:35], v[8:11], a[24:31], v74
  s_cbranch_vccnz Cs3_rec
Cs3_recok:
  v_smfmac_f32_16x16x64_bf16 v[36:39], v[16:19], a[128:135], v74
  s_waitcnt lgkmcnt(0)
  s_barrier
  ds_read_b128 v[60:63], v77
  v_smfmac_f32_16x16x64_bf16 v[40:43], v[16:19], a[136:143], v74
  ds_read_b128 v[64:67], v77 offset:128
  v_add_f32 v32, v32, v34
  v_cvt_pk_bf16_f32 v30, v28, v32
  v_smfmac_f32_16x16x64_bf16 v[36:39], v[0:3], a[96:103], v74
  ds_write_b32 v79, v30 offset:256
  v_add_f32 v33, v33, v35
  v_cvt_pk_bf16_f32 v31, v29, v33
  v_smfmac_f32_16x16x64_bf16 v[40:43], v[0:3], a[104:111], v74
  ds_write_b32 v79, v31 offset:832
  v_xor_b32 v75, 0x8000, v75
  v_smfmac_f32_16x16x64_bf16 v[36:39], v[4:7], a[112:119], v74
  ds_read_b128 v[0:3], v76 offset:4608
  v_mov_b32 v29, 0
  v_smfmac_f32_16x16x64_bf16 v[40:43], v[4:7], a[120:127], v74
  s_waitcnt vmcnt(5) lgkmcnt(3)
  v_mov_b32 v30, 0
  v_mfma_f32_16x16x32_bf16 v[44:47], v[44:47], v[60:63], 0
  ds_read_b128 v[4:7], v76 offset:5632
  s_waitcnt lgkmcnt(2)
  v_mfma_f32_16x16x32_bf16 v[44:47], v[48:51], v[64:67], v[44:47]
  s_barrier
  v_smfmac_f32_16x16x64_bf16 v[36:39], v[8:11], a[160:167], v74
  ds_read_b128 v[20:23], v77 offset:256
  ds_read_b128 v[24:27], v77 offset:384
  v_smfmac_f32_16x16x64_bf16 v[40:43], v[8:11], a[168:175], v74
  ds_read_b128 v[8:11], v76 offset:6656
  v_add_f32_dpp v72, v46, v44 quad_perm:[2,3,0,1] row_mask:0xf bank_mask:0xf
  v_add_f32_dpp v73, v47, v45 quad_perm:[2,3,0,1] row_mask:0xf bank_mask:0xf
  v_smfmac_f32_16x16x64_bf16 v[36:39], v[12:15], a[144:151], v74
  s_waitcnt lgkmcnt(4)
  v_exp_f32_dpp v72, v72 quad_perm:[0,1,0,1] row_mask:0xf bank_mask:0xf
  v_smfmac_f32_16x16x64_bf16 v[40:43], v[12:15], a[152:159], v74
  ds_read_b128 v[12:15], v76 offset:7680
  v_exp_f32_dpp v73, v73 quad_perm:[0,1,0,1] row_mask:0xf bank_mask:0xf
  v_smfmac_f32_16x16x64_bf16 v[36:39], v[0:3], a[32:39], v74
  s_waitcnt lgkmcnt(2)
  v_cvt_pk_bf16_f32 v72, v72, v73
  v_mfma_f32_16x16x32_bf16 v[20:23], v[20:23], v[60:63], 0
  ds_write_b32 v78, v72 offset:524
  v_mov_b64 v[16:17], 0
  v_mfma_f32_16x16x32_bf16 v[20:23], v[24:27], v[64:67], v[20:23]
  ds_read_b128 v[44:47], v75 offset:28672
  v_mov_b64 v[18:19], 0
  v_smfmac_f32_16x16x64_bf16 v[40:43], v[0:3], a[40:47], v74
  ds_read_b128 v[48:51], v75 offset:29696
  s_waitcnt lgkmcnt(4)
  v_smfmac_f32_16x16x64_bf16 v[36:39], v[4:7], a[48:55], v74
  v_add_f32_dpp v24, v22, v20 quad_perm:[2,3,0,1] row_mask:0xf bank_mask:0xf
  v_add_f32_dpp v25, v23, v21 quad_perm:[2,3,0,1] row_mask:0xf bank_mask:0xf
  v_smfmac_f32_16x16x64_bf16 v[36:39], v[8:11], a[64:71], v74
  s_waitcnt lgkmcnt(2)
  s_barrier
  ds_read_b128 v[32:35], v78 offset:512
  v_smfmac_f32_16x16x64_bf16 v[36:39], v[12:15], a[80:87], v74
  ds_read_b128 v[60:63], v75 offset:30720
  v_mul_f32 v24, s69, v24
  v_smfmac_f32_16x16x64_bf16 v[40:43], v[4:7], a[56:63], v74
  ds_read_b128 v[64:67], v75 offset:31744
  v_mul_f32 v25, s69, v25
  v_smfmac_f32_16x16x64_bf16 v[40:43], v[8:11], a[72:79], v74
  v_exp_f32_dpp v24, v24 quad_perm:[0,1,0,1] row_mask:0xf bank_mask:0xf
  v_smfmac_f32_16x16x64_bf16 v[40:43], v[12:15], a[88:95], v74
  s_waitcnt vmcnt(3) lgkmcnt(2)
  v_exp_f32_dpp v25, v25 quad_perm:[0,1,0,1] row_mask:0xf bank_mask:0xf
  v_mfma_f32_16x16x32_bf16 v[8:11], v[32:35], v[68:71], 0
  v_add_f32 v36, v36, v38
  v_add_f32 v37, v37, v39
  v_mfma_f32_16x16x32_bf16 v[0:3], v[32:35], v[52:55], 0
  v_add_f32 v40, v40, v42
  v_add_f32 v41, v41, v43
  v_mfma_f32_16x16x32_bf16 v[4:7], v[32:35], v[56:59], 0
  v_cvt_pk_bf16_f32 v28, v24, v25
  v_cvt_pk_bf16_f32 v72, v36, v37
  v_cvt_pk_bf16_f32 v73, v40, v41
  v_mfma_f32_16x16x16_bf16 v[8:11], v[28:29], v[68:69], v[8:11]
  v_cvt_pk_bf16_f32 v31, v24, v25
  v_mov_b64 v[20:21], 0
  v_mfma_f32_16x16x16_bf16 v[0:3], v[28:29], v[72:73], v[0:3]
  ds_read_b128 v[68:71], v76 offset:13824
  v_mov_b64 v[22:23], 0
  v_mfma_f32_16x16x16_bf16 v[4:7], v[30:31], v[72:73], v[4:7]
  v_rcp_f32 v10, v8
  v_rcp_f32 v11, v9
  v_mul_f32 v0, v10, v0
  v_mul_f32 v1, v11, v1
  s_nop 0
  v_mul_f32 v4, v10, v4
  v_mul_f32 v5, v11, v5
  v_cvt_pk_bf16_f32 v2, v0, v4
  ds_write_b32 v79, v2 offset:8704
  v_cvt_pk_bf16_f32 v3, v1, v5
  ds_write_b32 v79, v3 offset:9280
  v_max3_f32 v8, v8, v9, v10
  v_max_f32 v8, v8, v11
  v_cmp_le_f32 vcc, 1317011456, v8
  v_mov_b64 v[24:25], 0
  v_mov_b64 v[26:27], 0
  s_cbranch_vccnz Cs3_mx
Cs3_mxok:
  s_waitcnt lgkmcnt(0)
  s_barrier
  ds_read_b128 v[0:3], v78 offset:8704
  ds_read_b128 v[4:7], v78 offset:8768
  ds_read_b128 v[8:11], v78 offset:8832
  ds_read_b128 v[12:15], v78 offset:8896
  s_cmp_eq_u32 s66, 63
  s_cbranch_scc1 Cs3_last
  s_waitcnt lgkmcnt(3)
  v_smfmac_f32_16x16x64_bf16 v[16:19], v[0:3], v[44:51], v74
  ds_read_b128 v[52:55], v75 offset:45056
  s_waitcnt lgkmcnt(3)
  v_smfmac_f32_16x16x64_bf16 v[16:19], v[4:7], v[60:67], v74
  ds_read_b128 v[56:59], v75 offset:46080
  s_waitcnt lgkmcnt(3)
  v_smfmac_f32_16x16x64_bf16 v[16:19], v[8:11], a[176:183], v74
  ds_read_b128 v[36:39], v75 offset:47104
  s_waitcnt lgkmcnt(3)
  v_smfmac_f32_16x16x64_bf16 v[16:19], v[12:15], a[184:191], v74
  ds_read_b128 v[40:43], v75 offset:48128
  ds_read_b128 v[44:47], v75 offset:61440
  v_smfmac_f32_16x16x64_bf16 v[20:23], v[0:3], a[192:199], v74
  ds_read_b128 v[48:51], v75 offset:62464
  ds_read_b128 v[60:63], v75 offset:63488
  v_smfmac_f32_16x16x64_bf16 v[20:23], v[4:7], a[200:207], v74
  ds_read_b128 v[64:67], v75 offset:64512
  s_waitcnt lgkmcnt(6)
  v_cvt_pk_bf16_f32 v16, v16, v17
  v_cvt_pk_bf16_f32 v17, v18, v19
  v_bfi_b32 v16, 1, s72, v16
  v_smfmac_f32_16x16x64_bf16 v[20:23], v[8:11], v[52:59], v74
  buffer_store_dwordx2 v[16:17], v68, s[8:11], s73 offen sc1
  s_waitcnt lgkmcnt(4)
  v_smfmac_f32_16x16x64_bf16 v[20:23], v[12:15], v[36:43], v74
  ds_read_b128 v[52:55], v75 offset:8192
  v_mov_b64 v[32:33], 0
  v_smfmac_f32_16x16x64_bf16 v[24:27], v[0:3], a[208:215], v74
  ds_read_b128 v[56:59], v75 offset:9216
  v_mov_b64 v[34:35], 0
  v_smfmac_f32_16x16x64_bf16 v[24:27], v[4:7], a[216:223], v74
  ds_read_b128 v[36:39], v75 offset:10240
  s_waitcnt lgkmcnt(5)
  v_cvt_pk_bf16_f32 v20, v20, v21
  v_cvt_pk_bf16_f32 v21, v22, v23
  v_bfi_b32 v20, 1, s72, v20
  v_smfmac_f32_16x16x64_bf16 v[24:27], v[8:11], v[44:51], v74
  buffer_store_dwordx2 v[20:21], v68, s[8:11], s74 offen sc1
  s_waitcnt lgkmcnt(3)
  v_smfmac_f32_16x16x64_bf16 v[24:27], v[12:15], v[60:67], v74
  ds_read_b128 v[40:43], v75 offset:11264
  v_mov_b64 v[28:29], 0
  v_smfmac_f32_16x16x64_bf16 v[32:35], v[0:3], a[224:231], v74
  ds_read_b128 v[44:47], v75 offset:12288
  ds_read_b128 v[48:51], v75 offset:13312
  v_smfmac_f32_16x16x64_bf16 v[32:35], v[4:7], a[232:239], v74
  ds_read_b128 v[60:63], v75 offset:14336
  v_cvt_pk_bf16_f32 v24, v24, v25
  v_cvt_pk_bf16_f32 v25, v26, v27
  v_bfi_b32 v24, 1, s72, v24
  v_smfmac_f32_16x16x64_bf16 v[32:35], v[8:11], a[240:247], v74
  buffer_store_dwordx2 v[24:25], v68, s[8:11], s75 offen sc1
  v_mov_b64 v[30:31], 0
  v_smfmac_f32_16x16x64_bf16 v[32:35], v[12:15], a[248:255], v74
  ds_read_b128 v[64:67], v75 offset:15360
  s_waitcnt lgkmcnt(6)
  v_smfmac_f32_16x16x64_bf16 v[28:31], v[0:3], v[52:59], v74
  s_waitcnt lgkmcnt(4)
  v_smfmac_f32_16x16x64_bf16 v[28:31], v[4:7], v[36:43], v74
  s_waitcnt lgkmcnt(2)
  v_cvt_pk_bf16_f32 v32, v32, v33
  v_cvt_pk_bf16_f32 v33, v34, v35
  v_bfi_b32 v32, 1, s72, v32
  v_smfmac_f32_16x16x64_bf16 v[28:31], v[8:11], v[44:51], v74
  buffer_store_dwordx2 v[32:33], v68, s[8:11], s76 offen sc1
  s_waitcnt lgkmcnt(0)
  v_smfmac_f32_16x16x64_bf16 v[28:31], v[12:15], v[60:67], v74
  ds_read_b128 v[52:55], v76 offset:14848
  ds_read_b64 v[16:17], v77 offset:392
  v_mov_b64 v[18:19], v[72:73]
  v_xor_b32 v75, 0x8000, v75
  s_nop 3
  v_cvt_pk_bf16_f32 v28, v28, v29
  v_cvt_pk_bf16_f32 v29, v30, v31
  v_bfi_b32 v28, 1, s72, v28
  buffer_store_dwordx2 v[28:29], v68, s[8:11], s77 offen sc1
  v_mov_b64 v[20:21], 0
  v_mov_b64 v[22:23], 0
  v_mov_b64 v[24:25], 0
  v_mov_b64 v[26:27], 0
  v_mov_b64 v[28:29], 0
  v_mov_b64 v[30:31], 0
  v_mov_b64 v[32:33], 0
  v_mov_b64 v[34:35], 0
  s_add_u32 s58, s58, 655360
  s_add_u32 s59, s59, 655360
  s_add_u32 s70, s70, 655360
  s_add_u32 s68, s68, 655360
  s_add_u32 s66, s66, 1
  s_xor_b32 s64, s64, 16384
  s_xor_b32 s65, s65, 16384
  s_nop 15
  s_nop 15
  s_nop 15
  s_nop 9
  buffer_load_dwordx4 v[0:3], v76, s[8:11], s60 offen offset:0 sc1
  buffer_load_dwordx4 v[4:7], v76, s[8:11], s60 offen offset:1024 sc1
  buffer_load_dwordx4 v[8:11], v76, s[8:11], s61 offen offset:0 sc1
  buffer_load_dwordx4 v[12:15], v76, s[8:11], s61 offen offset:1024 sc1
  s_nop 15
  s_nop 11
  buffer_load_dwordx4 v[44:47], v76, s[8:11], s60 offen offset:0 sc1
  buffer_load_dwordx4 v[48:51], v76, s[8:11], s60 offen offset:1024 sc1
  buffer_load_dwordx4 v[60:63], v76, s[8:11], s61 offen offset:0 sc1
  buffer_load_dwordx4 v[64:67], v76, s[8:11], s61 offen offset:1024 sc1
  s_waitcnt lgkmcnt(0)
  s_cmp_eq_u32 s66, 12
  s_cbranch_scc1 Cs3_kv
Cs3_kvb:
  s_waitcnt vmcnt(7)
  v_mfma_f32_16x16x32_bf16 v[56:59], v[52:55], v[0:3], 0
  v_bitop3_b32 v72, v0, v2, s72 bitop3:0x7e
  s_waitcnt vmcnt(6)
  v_mfma_f32_16x16x32_bf16 v[56:59], v[52:55], v[4:7], v[56:59]
  v_bitop3_b32 v73, v4, v6, s72 bitop3:0x7e
  v_or_b32 v72, v72, v73
  s_waitcnt vmcnt(5)
  v_mfma_f32_16x16x32_bf16 v[36:39], v[52:55], v[8:11], 0
  v_bitop3_b32 v73, v8, v10, s72 bitop3:0x7e
  v_or_b32 v72, v72, v73
  s_waitcnt vmcnt(4)
  v_mfma_f32_16x16x32_bf16 v[36:39], v[52:55], v[12:15], v[36:39]
  v_bitop3_b32 v73, v12, v14, s72 bitop3:0x7e
  v_bitop3_b32 v72, v72, v73, 1 bitop3:0xa8
  v_cmp_ne_u32 vcc, 0, v72
  s_nop 0
  s_cmp_eq_u64 vcc, 0
  s_cselect_b32 s54, s62, 268435456
  s_cselect_b32 s55, s63, 268435456
  v_add_f32_dpp v56, v56, v56 row_ror:4 row_mask:0xf bank_mask:0xf
  v_add_f32_dpp v57, v57, v57 row_ror:4 row_mask:0xf bank_mask:0xf
  v_add_f32_dpp v36, v36, v36 row_ror:4 row_mask:0xf bank_mask:0xf
  v_add_f32_dpp v37, v37, v37 row_ror:4 row_mask:0xf bank_mask:0xf
  v_add_f32_dpp v56, v56, v56 row_ror:8 row_mask:0xf bank_mask:0xf
  v_add_f32_dpp v57, v57, v57 row_ror:8 row_mask:0xf bank_mask:0xf
  v_add_f32_dpp v36, v36, v36 row_ror:8 row_mask:0xf bank_mask:0xf
  v_add_f32_dpp v37, v37, v37 row_ror:8 row_mask:0xf bank_mask:0xf
  v_cvt_pk_bf16_f32 v56, v56, v57
  buffer_store_dword v56, v69, s[8:11], s54 offen sc1
  v_cvt_pk_bf16_f32 v36, v36, v37
  buffer_store_dword v36, v70, s[8:11], s55 offen sc1
  s_cbranch_vccnz Cs3_h1r
  s_xor_b32 s62, s62, 16384
  buffer_store_dword v71, v69, s[8:11], s62 offen sc1
  s_xor_b32 s63, s63, 16384
  buffer_store_dword v71, v70, s[8:11], s63 offen sc1
  s_xor_b32 s72, s72, 1
  s_branch Cs3_h2
Cs3_h1r:
  s_mov_b64 exec, vcc
  buffer_load_dwordx4 v[0:3], v76, s[8:11], s60 offen offset:0 sc1
  buffer_load_dwordx4 v[4:7], v76, s[8:11], s60 offen offset:1024 sc1
  buffer_load_dwordx4 v[8:11], v76, s[8:11], s61 offen offset:0 sc1
  buffer_load_dwordx4 v[12:15], v76, s[8:11], s61 offen offset:1024 sc1
  s_mov_b64 exec, -1
  s_add_u32 s67, s67, 1
  s_waitcnt vmcnt(9)
  v_mfma_f32_16x16x32_bf16 v[56:59], v[52:55], v[44:47], 0
  v_bitop3_b32 v72, v44, v46, s72 bitop3:0x7e
  s_waitcnt vmcnt(8)
  v_mfma_f32_16x16x32_bf16 v[56:59], v[52:55], v[48:51], v[56:59]
  v_bitop3_b32 v73, v48, v50, s72 bitop3:0x7e
  v_or_b32 v72, v72, v73
  s_waitcnt vmcnt(7)
  v_mfma_f32_16x16x32_bf16 v[36:39], v[52:55], v[60:63], 0
  v_bitop3_b32 v73, v60, v62, s72 bitop3:0x7e
  v_or_b32 v72, v72, v73
  s_waitcnt vmcnt(6)
  v_mfma_f32_16x16x32_bf16 v[36:39], v[52:55], v[64:67], v[36:39]
  v_bitop3_b32 v73, v64, v66, s72 bitop3:0x7e
  v_bitop3_b32 v72, v72, v73, 1 bitop3:0xa8
  v_cmp_ne_u32 vcc, 0, v72
  s_cbranch_vccz Cs3_h1p
  s_mov_b64 exec, vcc
  buffer_load_dwordx4 v[44:47], v76, s[8:11], s60 offen offset:0 sc1
  buffer_load_dwordx4 v[48:51], v76, s[8:11], s60 offen offset:1024 sc1
  buffer_load_dwordx4 v[60:63], v76, s[8:11], s61 offen offset:0 sc1
  buffer_load_dwordx4 v[64:67], v76, s[8:11], s61 offen offset:1024 sc1
  s_mov_b64 exec, -1
  s_add_u32 s67, s67, 1
  s_waitcnt vmcnt(7)
  v_mfma_f32_16x16x32_bf16 v[56:59], v[52:55], v[0:3], 0
  v_bitop3_b32 v72, v0, v2, s72 bitop3:0x7e
  s_waitcnt vmcnt(6)
  v_mfma_f32_16x16x32_bf16 v[56:59], v[52:55], v[4:7], v[56:59]
  v_bitop3_b32 v73, v4, v6, s72 bitop3:0x7e
  v_or_b32 v72, v72, v73
  s_waitcnt vmcnt(5)
  v_mfma_f32_16x16x32_bf16 v[36:39], v[52:55], v[8:11], 0
  v_bitop3_b32 v73, v8, v10, s72 bitop3:0x7e
  v_or_b32 v72, v72, v73
  s_waitcnt vmcnt(4)
  v_mfma_f32_16x16x32_bf16 v[36:39], v[52:55], v[12:15], v[36:39]
  v_bitop3_b32 v73, v12, v14, s72 bitop3:0x7e
  v_bitop3_b32 v72, v72, v73, 1 bitop3:0xa8
  v_cmp_ne_u32 vcc, 0, v72
  s_cbranch_vccz Cs3_h1p
Cs3_h1s:
  s_mov_b64 exec, vcc
  buffer_load_dwordx4 v[0:3], v76, s[8:11], s60 offen offset:0 sc1
  buffer_load_dwordx4 v[4:7], v76, s[8:11], s60 offen offset:1024 sc1
  buffer_load_dwordx4 v[8:11], v76, s[8:11], s61 offen offset:0 sc1
  buffer_load_dwordx4 v[12:15], v76, s[8:11], s61 offen offset:1024 sc1
  s_mov_b64 exec, -1
  s_add_u32 s67, s67, 1
  s_waitcnt vmcnt(7)
  v_mfma_f32_16x16x32_bf16 v[56:59], v[52:55], v[44:47], 0
  v_bitop3_b32 v72, v44, v46, s72 bitop3:0x7e
  s_waitcnt vmcnt(6)
  v_mfma_f32_16x16x32_bf16 v[56:59], v[52:55], v[48:51], v[56:59]
  v_bitop3_b32 v73, v48, v50, s72 bitop3:0x7e
  v_or_b32 v72, v72, v73
  s_waitcnt vmcnt(5)
  v_mfma_f32_16x16x32_bf16 v[36:39], v[52:55], v[60:63], 0
  v_bitop3_b32 v73, v60, v62, s72 bitop3:0x7e
  v_or_b32 v72, v72, v73
  s_waitcnt vmcnt(4)
  v_mfma_f32_16x16x32_bf16 v[36:39], v[52:55], v[64:67], v[36:39]
  v_bitop3_b32 v73, v64, v66, s72 bitop3:0x7e
  v_bitop3_b32 v72, v72, v73, 1 bitop3:0xa8
  v_cmp_ne_u32 vcc, 0, v72
  s_cbranch_vccz Cs3_h1p
  s_mov_b64 exec, vcc
  buffer_load_dwordx4 v[44:47], v76, s[8:11], s60 offen offset:0 sc1
  buffer_load_dwordx4 v[48:51], v76, s[8:11], s60 offen offset:1024 sc1
  buffer_load_dwordx4 v[60:63], v76, s[8:11], s61 offen offset:0 sc1
  buffer_load_dwordx4 v[64:67], v76, s[8:11], s61 offen offset:1024 sc1
  s_mov_b64 exec, -1
  s_add_u32 s67, s67, 1
  s_waitcnt vmcnt(7)
  v_mfma_f32_16x16x32_bf16 v[56:59], v[52:55], v[0:3], 0
  v_bitop3_b32 v72, v0, v2, s72 bitop3:0x7e
  s_waitcnt vmcnt(6)
  v_mfma_f32_16x16x32_bf16 v[56:59], v[52:55], v[4:7], v[56:59]
  v_bitop3_b32 v73, v4, v6, s72 bitop3:0x7e
  v_or_b32 v72, v72, v73
  s_waitcnt vmcnt(5)
  v_mfma_f32_16x16x32_bf16 v[36:39], v[52:55], v[8:11], 0
  v_bitop3_b32 v73, v8, v10, s72 bitop3:0x7e
  v_or_b32 v72, v72, v73
  s_waitcnt vmcnt(4)
  v_mfma_f32_16x16x32_bf16 v[36:39], v[52:55], v[12:15], v[36:39]
  v_bitop3_b32 v73, v12, v14, s72 bitop3:0x7e
  v_bitop3_b32 v72, v72, v73, 1 bitop3:0xa8
  v_cmp_ne_u32 vcc, 0, v72
  s_cbranch_vccz Cs3_h1p
  s_cmp_lt_u32 s67, 131072
  s_cbranch_scc1 Cs3_h1s
Cs3_h1p:
  s_nop 2
  v_add_f32_dpp v56, v56, v56 row_ror:4 row_mask:0xf bank_mask:0xf
  v_add_f32_dpp v57, v57, v57 row_ror:4 row_mask:0xf bank_mask:0xf
  v_add_f32_dpp v36, v36, v36 row_ror:4 row_mask:0xf bank_mask:0xf
  v_add_f32_dpp v37, v37, v37 row_ror:4 row_mask:0xf bank_mask:0xf
  v_add_f32_dpp v56, v56, v56 row_ror:8 row_mask:0xf bank_mask:0xf
  v_add_f32_dpp v57, v57, v57 row_ror:8 row_mask:0xf bank_mask:0xf
  v_add_f32_dpp v36, v36, v36 row_ror:8 row_mask:0xf bank_mask:0xf
  v_add_f32_dpp v37, v37, v37 row_ror:8 row_mask:0xf bank_mask:0xf
  v_cvt_pk_bf16_f32 v56, v56, v57
  buffer_store_dword v56, v69, s[8:11], s62 offen sc1
  v_cvt_pk_bf16_f32 v36, v36, v37
  buffer_store_dword v36, v70, s[8:11], s63 offen sc1
  s_xor_b32 s62, s62, 16384
  buffer_store_dword v71, v69, s[8:11], s62 offen sc1
  s_xor_b32 s63, s63, 16384
  buffer_store_dword v71, v70, s[8:11], s63 offen sc1
  s_xor_b32 s72, s72, 1
  s_branch Cs3_h2
Cs3_rec:
  s_nop 7
  s_waitcnt vmcnt(0) lgkmcnt(0)
  v_max3_u32 v72, v0, v1, v2
  v_max3_u32 v72, v72, v3, v4
  v_max3_u32 v72, v72, v5, v6
  v_max3_u32 v72, v72, v7, v8
  v_max3_u32 v72, v72, v9, v10
  v_max3_u32 v72, v72, v11, v12
  v_max3_u32 v72, v72, v13, v14
  v_max3_u32 v72, v72, v15, v16
  v_max3_u32 v72, v72, v17, v18
  v_max_u32 v72, v72, v19
  v_cmp_eq_u32 vcc, -1, v72
  s_cbranch_vccz Cs3_recok
  s_barrier
Cs3_recp:
  buffer_load_dwordx4 v[0:3], v76, s[8:11], s64 offen offset:0 sc1
  buffer_load_dwordx4 v[4:7], v76, s[8:11], s64 offen offset:1024 sc1
  buffer_load_dwordx4 v[8:11], v76, s[8:11], s64 offen offset:2048 sc1
  s_add_u32 s67, s67, 1
  s_cmp_lt_u32 s67, 131072
  s_cselect_b32 s54, -2, -1
  s_waitcnt vmcnt(2)
  v_max3_u32 v72, v0, v1, v2
  s_waitcnt vmcnt(1)
  v_max3_u32 v72, v72, v3, v4
  v_max3_u32 v72, v72, v5, v6
  s_waitcnt vmcnt(0)
  v_max3_u32 v72, v72, v7, v8
  v_max3_u32 v72, v72, v9, v10
  v_max_u32 v72, v72, v11
  v_cmp_lt_u32 vcc, s54, v72
  s_cbranch_vccnz Cs3_recp
  ds_write_b128 v76, v[0:3] offset:10752
  ds_write_b128 v76, v[4:7] offset:11776
  ds_write_b128 v76, v[8:11] offset:12800
  v_mov_b64 v[20:21], 0
  v_mov_b64 v[22:23], 0
  v_mov_b64 v[24:25], 0
  v_mov_b64 v[26:27], 0
  v_mov_b64 v[28:29], 0
  v_mov_b64 v[30:31], 0
  v_mov_b64 v[32:33], 0
  v_mov_b64 v[34:35], 0
  s_waitcnt lgkmcnt(0)
  s_barrier
  ds_read_b128 v[0:3], v76 offset:4608
  ds_read_b128 v[60:63], v76 offset:28672
  ds_read_b128 v[64:67], v76 offset:29696
  s_waitcnt lgkmcnt(0)
  v_smfmac_f32_16x16x64_bf16 v[20:23], v[0:3], v[60:67], v74
  ds_read_b128 v[60:63], v76 offset:30720
  ds_read_b128 v[64:67], v76 offset:31744
  s_waitcnt lgkmcnt(0)
  v_smfmac_f32_16x16x64_bf16 v[24:27], v[0:3], v[60:67], v74
  ds_read_b128 v[60:63], v76 offset:45056
  ds_read_b128 v[64:67], v76 offset:46080
  s_waitcnt lgkmcnt(0)
  v_smfmac_f32_16x16x64_bf16 v[28:31], v[0:3], v[60:67], v74
  ds_read_b128 v[60:63], v76 offset:47104
  ds_read_b128 v[64:67], v76 offset:48128
  s_waitcnt lgkmcnt(0)
  v_smfmac_f32_16x16x64_bf16 v[32:35], v[0:3], v[60:67], v74
  ds_read_b128 v[4:7], v76 offset:5632
  s_waitcnt lgkmcnt(0)
  v_smfmac_f32_16x16x64_bf16 v[20:23], v[4:7], v[80:87], v74
  v_smfmac_f32_16x16x64_bf16 v[24:27], v[4:7], v[88:95], v74
  v_smfmac_f32_16x16x64_bf16 v[28:31], v[4:7], v[208:215], v74
  v_smfmac_f32_16x16x64_bf16 v[32:35], v[4:7], v[216:223], v74
  ds_read_b128 v[8:11], v76 offset:6656
  s_waitcnt lgkmcnt(0)
  v_smfmac_f32_16x16x64_bf16 v[20:23], v[8:11], v[96:103], v74
  v_smfmac_f32_16x16x64_bf16 v[24:27], v[8:11], v[104:111], v74
  ds_read_b128 v[60:63], v76 offset:61440
  ds_read_b128 v[64:67], v76 offset:62464
  s_waitcnt lgkmcnt(0)
  v_smfmac_f32_16x16x64_bf16 v[28:31], v[8:11], v[60:67], v74
  ds_read_b128 v[60:63], v76 offset:63488
  ds_read_b128 v[64:67], v76 offset:64512
  s_waitcnt lgkmcnt(0)
  v_smfmac_f32_16x16x64_bf16 v[32:35], v[8:11], v[60:67], v74
  ds_read_b128 v[12:15], v76 offset:7680
  s_waitcnt lgkmcnt(0)
  v_smfmac_f32_16x16x64_bf16 v[20:23], v[12:15], v[112:119], v74
  v_smfmac_f32_16x16x64_bf16 v[24:27], v[12:15], v[120:127], v74
  v_smfmac_f32_16x16x64_bf16 v[28:31], v[12:15], v[224:231], v74
  v_smfmac_f32_16x16x64_bf16 v[32:35], v[12:15], v[232:239], v74
  ds_read_b128 v[0:3], v76 offset:8704
  s_waitcnt lgkmcnt(0)
  v_smfmac_f32_16x16x64_bf16 v[20:23], v[0:3], v[128:135], v74
  v_smfmac_f32_16x16x64_bf16 v[24:27], v[0:3], v[136:143], v74
  ds_read_b128 v[60:63], v75 offset:12288
  ds_read_b128 v[64:67], v75 offset:13312
  s_waitcnt lgkmcnt(0)
  v_smfmac_f32_16x16x64_bf16 v[28:31], v[0:3], v[60:67], v74
  ds_read_b128 v[60:63], v75 offset:14336
  ds_read_b128 v[64:67], v75 offset:15360
  s_waitcnt lgkmcnt(0)
  v_smfmac_f32_16x16x64_bf16 v[32:35], v[0:3], v[60:67], v74
  ds_read_b128 v[4:7], v76 offset:9728
  s_waitcnt lgkmcnt(0)
  v_smfmac_f32_16x16x64_bf16 v[20:23], v[4:7], v[144:151], v74
  v_smfmac_f32_16x16x64_bf16 v[24:27], v[4:7], v[152:159], v74
  ds_read_b128 v[60:63], v75 offset:28672
  ds_read_b128 v[64:67], v75 offset:29696
  s_waitcnt lgkmcnt(0)
  v_smfmac_f32_16x16x64_bf16 v[28:31], v[4:7], v[60:67], v74
  ds_read_b128 v[60:63], v75 offset:30720
  ds_read_b128 v[64:67], v75 offset:31744
  s_waitcnt lgkmcnt(0)
  v_smfmac_f32_16x16x64_bf16 v[32:35], v[4:7], v[60:67], v74
  ds_read_b128 v[16:19], v76 offset:10752
  s_waitcnt lgkmcnt(0)
  v_smfmac_f32_16x16x64_bf16 v[20:23], v[16:19], v[160:167], v74
  v_smfmac_f32_16x16x64_bf16 v[24:27], v[16:19], v[168:175], v74
  v_smfmac_f32_16x16x64_bf16 v[28:31], v[16:19], v[240:247], v74
  v_smfmac_f32_16x16x64_bf16 v[32:35], v[16:19], v[248:255], v74
  ds_read_b128 v[12:15], v76 offset:11776
  s_waitcnt lgkmcnt(0)
  v_smfmac_f32_16x16x64_bf16 v[20:23], v[12:15], v[176:183], v74
  v_smfmac_f32_16x16x64_bf16 v[24:27], v[12:15], v[184:191], v74
  v_smfmac_f32_16x16x64_bf16 v[28:31], v[12:15], a[0:7], v74
  v_smfmac_f32_16x16x64_bf16 v[32:35], v[12:15], a[8:15], v74
  ds_read_b128 v[8:11], v76 offset:12800
  s_waitcnt lgkmcnt(0)
  v_smfmac_f32_16x16x64_bf16 v[20:23], v[8:11], v[192:199], v74
  v_smfmac_f32_16x16x64_bf16 v[24:27], v[8:11], v[200:207], v74
  v_smfmac_f32_16x16x64_bf16 v[28:31], v[8:11], a[16:23], v74
  v_smfmac_f32_16x16x64_bf16 v[32:35], v[8:11], a[24:31], v74
  v_add_f32 v20, v20, v22
  v_add_f32 v21, v21, v23
  v_add_f32 v24, v24, v26
  v_cvt_pk_bf16_f32 v22, v20, v24
  s_nop 0
  ds_write_b32 v79, v22 offset:0
  v_add_f32 v25, v25, v27
  v_cvt_pk_bf16_f32 v23, v21, v25
  ds_write_b32 v79, v23 offset:576
  v_add_f32 v28, v28, v30
  v_add_f32 v29, v29, v31
  s_waitcnt lgkmcnt(0)
  s_nop 1
  s_branch Cs3_recok
Cs3_mx:
  s_waitcnt lgkmcnt(0)
  s_barrier
  buffer_load_dwordx4 v[0:3], v76, s[8:11], s58 offen offset:0 sc1
  ds_read_b128 v[20:23], v77 offset:0
  ds_read_b128 v[28:31], v77 offset:256
  buffer_load_dwordx4 v[4:7], v76, s[8:11], s58 offen offset:1024 sc1
  ds_read_b128 v[24:27], v77 offset:128
  ds_read_b128 v[32:35], v77 offset:384
  s_waitcnt vmcnt(1) lgkmcnt(3)
  v_mfma_f32_16x16x32_bf16 v[8:11], v[0:3], v[20:23], 0
  s_waitcnt vmcnt(0) lgkmcnt(1)
  v_mfma_f32_16x16x32_bf16 v[8:11], v[4:7], v[24:27], v[8:11]
  v_mfma_f32_16x16x32_bf16 v[12:15], v[28:31], v[20:23], 0
  s_waitcnt lgkmcnt(0)
  v_mfma_f32_16x16x32_bf16 v[12:15], v[32:35], v[24:27], v[12:15]
  v_add_f32_dpp v8, v10, v8 quad_perm:[2,3,0,1] row_mask:0xf bank_mask:0xf
  v_add_f32_dpp v9, v11, v9 quad_perm:[2,3,0,1] row_mask:0xf bank_mask:0xf
  s_nop 0
  v_mov_b32_dpp v8, v8 quad_perm:[0,1,0,1] row_mask:0xf bank_mask:0xf
  v_mov_b32_dpp v9, v9 quad_perm:[0,1,0,1] row_mask:0xf bank_mask:0xf
  s_nop 1
  v_add_f32_dpp v12, v14, v12 quad_perm:[2,3,0,1] row_mask:0xf bank_mask:0xf
  v_add_f32_dpp v13, v15, v13 quad_perm:[2,3,0,1] row_mask:0xf bank_mask:0xf
  s_nop 0
  v_mov_b32_dpp v12, v12 quad_perm:[0,1,0,1] row_mask:0xf bank_mask:0xf
  v_mov_b32_dpp v13, v13 quad_perm:[0,1,0,1] row_mask:0xf bank_mask:0xf
  v_mul_f32 v12, s69, v12
  ds_write_b32 v78, v8 offset:8716
  v_mul_f32 v13, s69, v13
  ds_write_b32 v78, v9 offset:8780
  s_waitcnt lgkmcnt(0)
  s_barrier
  ds_read_b128 v[36:39], v78 offset:8704
  ds_read_b128 v[40:43], v78 offset:8768
  s_waitcnt lgkmcnt(0)
  s_barrier
  v_max_f32 v16, v36, v37
  v_max3_f32 v16, v16, v38, v39
  v_max3_f32 v16, v16, v40, v41
  v_max3_f32 v16, v16, v42, v43
  v_max3_f32 v16, v16, v12, v13
  v_mov_b32 v17, v16
  s_nop 1
  v_permlane16_swap_b32 v16, v17
  v_max_f32 v16, v16, v17
  v_mov_b32 v17, v16
  s_nop 1
  v_permlane32_swap_b32 v16, v17
  v_max_f32 v16, v16, v17
  v_sub_f32 v36, v36, v16
  v_sub_f32 v37, v37, v16
  v_sub_f32 v38, v38, v16
  v_sub_f32 v39, v39, v16
  v_sub_f32 v40, v40, v16
  v_sub_f32 v41, v41, v16
  v_sub_f32 v42, v42, v16
  v_sub_f32 v43, v43, v16
  v_sub_f32 v12, v12, v16
  v_sub_f32 v13, v13, v16
  v_exp_f32 v36, v36
  v_exp_f32 v37, v37
  v_exp_f32 v38, v38
  v_exp_f32 v39, v39
  v_exp_f32 v40, v40
  v_exp_f32 v41, v41
  v_exp_f32 v42, v42
  v_exp_f32 v43, v43
  v_exp_f32 v12, v12
  v_exp_f32 v13, v13
  v_cvt_pk_bf16_f32 v32, v36, v40
  v_cvt_pk_bf16_f32 v33, v37, v41
  v_cvt_pk_bf16_f32 v34, v38, v42
  v_cvt_pk_bf16_f32 v35, v39, v43
  v_cvt_pk_bf16_f32 v28, v12, v13
  v_cvt_pk_bf16_f32 v31, v12, v13
  v_mov_b32 v29, 0
  v_mov_b32 v30, 0
  v_mov_b32 v68, 0x3f803f80
  v_mov_b32 v69, 0x3f803f80
  v_mov_b32 v70, 0x3f803f80
  v_mov_b32 v71, 0x3f803f80
  s_nop 1
  v_mfma_f32_16x16x32_bf16 v[8:11], v[32:35], v[68:71], 0
  v_mfma_f32_16x16x32_bf16 v[0:3], v[32:35], v[52:55], 0
  v_mfma_f32_16x16x32_bf16 v[4:7], v[32:35], v[56:59], 0
  v_mfma_f32_16x16x16_bf16 v[8:11], v[28:29], v[68:69], v[8:11]
  v_mfma_f32_16x16x16_bf16 v[0:3], v[28:29], v[72:73], v[0:3]
  v_mfma_f32_16x16x16_bf16 v[4:7], v[30:31], v[72:73], v[4:7]
  ds_read_b128 v[68:71], v76 offset:13824
  v_rcp_f32 v10, v8
  v_rcp_f32 v11, v9
  v_mul_f32 v0, v10, v0
  v_mul_f32 v1, v11, v1
  s_nop 0
  v_mul_f32 v4, v10, v4
  v_mul_f32 v5, v11, v5
  v_cvt_pk_bf16_f32 v2, v0, v4
  ds_write_b32 v79, v2 offset:8704
  v_cvt_pk_bf16_f32 v3, v1, v5
  ds_write_b32 v79, v3 offset:9280
  v_mov_b64 v[16:17], 0
  v_mov_b64 v[18:19], 0
  v_mov_b64 v[20:21], 0
  v_mov_b64 v[22:23], 0
  v_mov_b64 v[24:25], 0
  v_mov_b64 v[26:27], 0
  s_branch Cs3_mxok
Cs3_kv:
  s_lshl_b32 s56, s53, 2
  s_add_u32 s56, s56, 128
  s_load_dword s57, s[12:13], s56 glc
  s_branch Cs3_kvb
Cs3_kv2:
  s_waitcnt lgkmcnt(0)
  s_cmp_ge_u32 s57, 0x700
  s_cbranch_scc1 Cs3_h2w
  s_load_dword s57, s[12:13], s56 glc
  s_add_u32 s67, s67, 1
  s_cmp_lt_u32 s67, 131072
  s_cbranch_scc1 Cs3_kv2
  s_branch Cs3_h2w
Cs3_last:
  s_waitcnt vmcnt(0) lgkmcnt(0)
  ds_read_b64 v[16:17], v77 offset:392
  v_mov_b64 v[18:19], v[72:73]
  s_add_u32 s68, s68, 655360
  s_waitcnt lgkmcnt(0)
  buffer_store_dwordx4 v[16:19], v76, s[8:11], s68 offen sc1
  s_waitcnt vmcnt(0)
  s_barrier
  v_mov_b32 v72, 65
  s_mov_b64 exec, 1
  buffer_store_dword v72, v76, s[8:11], s71 offen sc1
  s_mov_b64 exec, -1
  s_branch L_cexit
L_conf:
  s_waitcnt vmcnt(0) lgkmcnt(0)
  s_barrier
  s_cmp_eq_u32 s52, 0
  s_cbranch_scc0 L_cf2
  s_mov_b64 exec, 1
  s_lshl_b32 s57, s2, 2
  v_mov_b32 v1, 0
L_cf0:
  s_cmp_eq_u32 s54, -1
  s_cbranch_scc1 L_cf1
  s_mov_b32 s55, s54
  s_lshr_b64 s[54:55], s[54:55], s0
  s_ff0_i32_b32 s56, s54
  s_add_u32 s0, s0, s56
  s_and_b32 s0, s0, 31
  s_lshl_b32 s56, 1, s0
  v_mov_b32 v35, s56
  buffer_atomic_or v35, v1, s[12:15], s57 offen sc0
  s_waitcnt vmcnt(0)
  v_readfirstlane_b32 s54, v35
  s_nop 0
  s_bitcmp1_b32 s54, s0
  s_cbranch_scc1 L_cf0
  v_mov_b32 v35, s0
  s_branch L_cf3
L_cf1:
  v_mov_b32 v35, 1
  buffer_atomic_add v35, v1, s[12:15], 0 offen offset:40 sc0
  s_waitcnt vmcnt(0)
  v_add_u32 v35, 32, v35
L_cf3:
  ds_write_b32 v33, v35
  s_mov_b64 exec, -1
  s_waitcnt lgkmcnt(0)
L_cf2:
  s_barrier
  ds_read_b32 v32, v33
  s_waitcnt lgkmcnt(0)
  v_readfirstlane_b32 s0, v32
  s_mov_b32 s1, 1
  s_cmp_lt_u32 s0, 32
  s_cbranch_scc1 L_role
  s_sub_u32 s53, s0, 32
  s_mov_b32 s57, 0
L_sur:
  s_load_dwordx16 s[60:75], s[12:13], 0 glc
  s_add_u32 s57, s57, 1
  s_waitcnt lgkmcnt(0)
  s_mov_b32 s55, s70
  s_bcnt1_i32_b32 s56, s60
  s_add_u32 s55, s55, s56
  s_bcnt1_i32_b32 s56, s61
  s_add_u32 s55, s55, s56
  s_bcnt1_i32_b32 s56, s62
  s_add_u32 s55, s55, s56
  s_bcnt1_i32_b32 s56, s63
  s_add_u32 s55, s55, s56
  s_bcnt1_i32_b32 s56, s64
  s_add_u32 s55, s55, s56
  s_bcnt1_i32_b32 s56, s65
  s_add_u32 s55, s55, s56
  s_bcnt1_i32_b32 s56, s66
  s_add_u32 s55, s55, s56
  s_bcnt1_i32_b32 s56, s67
  s_add_u32 s55, s55, s56
  s_cmp_ge_u32 s57, 131072
  s_cbranch_scc1 L_end
  s_cmp_lt_u32 s55, 256
  s_cbranch_scc1 L_sur
  s_mov_b32 s2, 0
  s_mov_b32 s54, s60
  s_bcnt0_i32_b32 s56, s54
  s_cmp_lt_u32 s53, s56
  s_cbranch_scc1 L_sur2
  s_sub_u32 s53, s53, s56
  s_mov_b32 s2, 1
  s_mov_b32 s54, s61
  s_bcnt0_i32_b32 s56, s54
  s_cmp_lt_u32 s53, s56
  s_cbranch_scc1 L_sur2
  s_sub_u32 s53, s53, s56
  s_mov_b32 s2, 2
  s_mov_b32 s54, s62
  s_bcnt0_i32_b32 s56, s54
  s_cmp_lt_u32 s53, s56
  s_cbranch_scc1 L_sur2
  s_sub_u32 s53, s53, s56
  s_mov_b32 s2, 3
  s_mov_b32 s54, s63
  s_bcnt0_i32_b32 s56, s54
  s_cmp_lt_u32 s53, s56
  s_cbranch_scc1 L_sur2
  s_sub_u32 s53, s53, s56
  s_mov_b32 s2, 4
  s_mov_b32 s54, s64
  s_bcnt0_i32_b32 s56, s54
  s_cmp_lt_u32 s53, s56
  s_cbranch_scc1 L_sur2
  s_sub_u32 s53, s53, s56
  s_mov_b32 s2, 5
  s_mov_b32 s54, s65
  s_bcnt0_i32_b32 s56, s54
  s_cmp_lt_u32 s53, s56
  s_cbranch_scc1 L_sur2
  s_sub_u32 s53, s53, s56
  s_mov_b32 s2, 6
  s_mov_b32 s54, s66
  s_bcnt0_i32_b32 s56, s54
  s_cmp_lt_u32 s53, s56
  s_cbranch_scc1 L_sur2
  s_sub_u32 s53, s53, s56
  s_mov_b32 s2, 7
  s_mov_b32 s54, s67
  s_bcnt0_i32_b32 s56, s54
  s_cmp_lt_u32 s53, s56
  s_cbranch_scc1 L_sur2
  s_sub_u32 s53, s53, s56
  s_branch L_end
L_sur2:
  s_ff0_i32_b32 s0, s54
  s_bitset1_b32 s54, s0
  s_sub_u32 s53, s53, 1
  s_cbranch_scc0 L_sur2
  s_branch L_role
L_worker:
  s_sub_u32 s54, s2, 1
  s_lshl_b32 s54, s54, 5
  s_add_u32 s53, s53, s54
  s_getpc_b64 s[80:81]
L_pc_2:
  s_and_b32 s55, s0, 1
  s_lshl_b32 s55, s55, 2
  s_add_u32 s55, s55, s52
  s_lshl_b32 s55, s55, 13
  v_and_b32 v199, 63, v0
  v_lshl_add_u32 v199, v199, 7, s55
  v_min_u32 v199, (L_end - L_pc_2), v199
  global_load_dword v196, v199, s[80:81]
  v_and_b32 v200, 63, v0
  v_lshlrev_b32 v201, 4, v200
  v_lshrrev_b32 v211, 3, v200
  s_lshl_b32 s54, s52, 3
  v_add_u32 v211, s54, v211
  v_bfe_u32 v212, v211, 1, 3
  v_and_b32 v213, 7, v200
  v_xor_b32 v212, v212, v213
  v_mul_u32_u24 v211, 1152, v211
  v_lshl_add_u32 v202, v212, 4, v211
  s_mul_i32 s67, s52, 9216
  v_and_b32 v211, 31, v200
  v_lshrrev_b32 v212, 3, v211
  v_mul_u32_u24 v212, 9216, v212
  v_and_b32 v213, 7, v211
  v_lshl_add_u32 v212, v213, 7, v212
  v_bfe_u32 v213, v211, 1, 3
  v_lshrrev_b32 v214, 5, v200
  v_xor_b32 v213, v213, v214
  v_lshl_add_u32 v203, v213, 4, v212
  v_xor_b32 v204, 32, v203
  v_xor_b32 v205, 64, v203
  v_xor_b32 v206, 0x60, v203
  v_bfe_u32 v211, v200, 2, 2
  v_lshl_add_u32 v212, v214, 3, v211
  v_lshlrev_b32 v212, 8, v212
  v_xor_b32 v211, s52, v211
  v_lshl_add_u32 v212, v211, 6, v212
  v_bfe_u32 v213, v200, 4, 1
  v_and_b32 v211, 3, v200
  v_lshl_add_u32 v210, v213, 5, v212
  v_lshl_add_u32 v210, v211, 3, v210
  v_lshl_add_u32 v209, v213, 4, v212
  v_and_b32 v213, 1, v211
  v_lshl_add_u32 v209, v213, 3, v209
  v_lshrrev_b32 v213, 1, v211
  v_lshl_add_u32 v209, v213, 5, v209
  s_mov_b32 s65, 0
  s_mul_i32 s58, s53, 9363
  s_lshr_b32 s58, s58, 16
  s_mul_i32 s54, s58, 7
  s_sub_u32 s59, s53, s54
  s_mul_i32 s60, s59, 36864
  s_add_u32 m0, s67, 0
  s_nop 0
  buffer_load_dwordx4 v202, s[4:7], s60 offen offset:0 lds
  s_add_u32 m0, s67, 896
  s_nop 0
  buffer_load_dwordx4 v202, s[4:7], s60 offen offset:128 lds
  s_add_u32 m0, s67, 1792
  s_nop 0
  buffer_load_dwordx4 v202, s[4:7], s60 offen offset:256 lds
  s_add_u32 m0, s67, 2688
  s_nop 0
  buffer_load_dwordx4 v202, s[4:7], s60 offen offset:384 lds
  s_add_u32 m0, s67, 3584
  s_nop 0
  buffer_load_dwordx4 v202, s[4:7], s60 offen offset:512 lds
  s_add_u32 m0, s67, 4480
  s_nop 0
  buffer_load_dwordx4 v202, s[4:7], s60 offen offset:640 lds
  s_add_u32 m0, s67, 5376
  s_nop 0
  buffer_load_dwordx4 v202, s[4:7], s60 offen offset:768 lds
  s_add_u32 m0, s67, 6272
  s_nop 0
  buffer_load_dwordx4 v202, s[4:7], s60 offen offset:896 lds
  s_add_u32 m0, s67, 7168
  s_nop 0
  buffer_load_dwordx4 v202, s[4:7], s60 offen offset:1024 lds
  v_lshrrev_b32 v211, 4, v200
  v_lshlrev_b32 v212, 2, v211
  v_and_b32 v213, 15, v200
  v_xor_b32 v212, v212, v213
  v_lshlrev_b32 v212, 4, v212
  v_lshl_add_u32 v207, v211, 13, v212
  s_lshl_b32 s62, s58, 8
  s_lshl_b32 s54, s52, 15
  s_add_u32 s62, s62, s54
  s_lshl_b32 s61, s52, 10
  s_add_u32 s61, s61, 36864
  s_add_u32 m0, s61, 0
  s_add_u32 s54, s62, 0
  buffer_load_dwordx4 v207, s[20:23], s54 offen lds
  s_add_u32 m0, s61, 4096
  s_add_u32 s54, s62, 131072
  buffer_load_dwordx4 v207, s[20:23], s54 offen lds
  s_add_u32 m0, s61, 8192
  s_add_u32 s54, s62, 262144
  buffer_load_dwordx4 v207, s[20:23], s54 offen lds
  s_add_u32 m0, s61, 12288
  s_add_u32 s54, s62, 393216
  buffer_load_dwordx4 v207, s[20:23], s54 offen lds
  s_add_u32 m0, s61, 16384
  s_add_u32 s54, s62, 0
  buffer_load_dwordx4 v207, s[24:27], s54 offen lds
  s_add_u32 m0, s61, 20480
  s_add_u32 s54, s62, 131072
  buffer_load_dwordx4 v207, s[24:27], s54 offen lds
  s_add_u32 m0, s61, 24576
  s_add_u32 s54, s62, 262144
  buffer_load_dwordx4 v207, s[24:27], s54 offen lds
  s_add_u32 m0, s61, 28672
  s_add_u32 s54, s62, 393216
  buffer_load_dwordx4 v207, s[24:27], s54 offen lds
  s_add_u32 m0, s61, 32768
  s_add_u32 s54, s62, 524288
  buffer_load_dwordx4 v207, s[20:23], s54 offen lds
  s_add_u32 m0, s61, 36864
  s_add_u32 s54, s62, 655360
  buffer_load_dwordx4 v207, s[20:23], s54 offen lds
  s_add_u32 m0, s61, 40960
  s_add_u32 s54, s62, 786432
  buffer_load_dwordx4 v207, s[20:23], s54 offen lds
  s_add_u32 m0, s61, 45056
  s_add_u32 s54, s62, 917504
  buffer_load_dwordx4 v207, s[20:23], s54 offen lds
  s_add_u32 m0, s61, 49152
  s_add_u32 s54, s62, 524288
  buffer_load_dwordx4 v207, s[24:27], s54 offen lds
  s_add_u32 m0, s61, 53248
  s_add_u32 s54, s62, 655360
  buffer_load_dwordx4 v207, s[24:27], s54 offen lds
  s_add_u32 m0, s61, 57344
  s_add_u32 s54, s62, 786432
  buffer_load_dwordx4 v207, s[24:27], s54 offen lds
  s_add_u32 m0, s61, 61440
  s_add_u32 s54, s62, 917504
  buffer_load_dwordx4 v207, s[24:27], s54 offen lds
  s_add_u32 m0, s61, 65536
  s_add_u32 s54, s62, 1048576
  buffer_load_dwordx4 v207, s[20:23], s54 offen lds
  s_add_u32 m0, s61, 69632
  s_add_u32 s54, s62, 1179648
  buffer_load_dwordx4 v207, s[20:23], s54 offen lds
  s_add_u32 m0, s61, 73728
  s_add_u32 s54, s62, 1310720
  buffer_load_dwordx4 v207, s[20:23], s54 offen lds
  s_add_u32 m0, s61, 77824
  s_add_u32 s54, s62, 1441792
  buffer_load_dwordx4 v207, s[20:23], s54 offen lds
  s_add_u32 m0, s61, 81920
  s_add_u32 s54, s62, 1048576
  buffer_load_dwordx4 v207, s[24:27], s54 offen lds
  s_add_u32 m0, s61, 86016
  s_add_u32 s54, s62, 1179648
  buffer_load_dwordx4 v207, s[24:27], s54 offen lds
  s_add_u32 m0, s61, 90112
  s_add_u32 s54, s62, 1310720
  buffer_load_dwordx4 v207, s[24:27], s54 offen lds
  s_add_u32 m0, s61, 94208
  s_add_u32 s54, s62, 1441792
  buffer_load_dwordx4 v207, s[24:27], s54 offen lds
  v_bfe_u32 v211, v200, 3, 2
  v_lshlrev_b32 v216, 11, v211
  v_bfe_u32 v211, v200, 1, 2
  v_lshl_add_u32 v216, v211, 6, v216
  v_lshrrev_b32 v212, 5, v200
  v_lshl_add_u32 v216, v212, 5, v216
  v_and_b32 v211, 1, v200
  v_lshl_add_u32 v216, v211, 4, v216
  v_bfe_u32 v211, v200, 4, 1
  v_lshlrev_b32 v217, 10, v211
  v_lshl_add_u32 v217, v212, 9, v217
  v_and_b32 v211, 15, v200
  v_lshl_add_u32 v217, v211, 4, v217
  s_lshl_b32 s54, s52, 11
  s_add_u32 s54, s54, 8192
  v_add_u32 v217, s54, v217
  s_cmp_eq_u32 s1, 1
  s_cbranch_scc1 W_ver_ok
  v_mov_b32 v33, 163832
  s_cmp_eq_u32 s52, 0
  s_cbranch_scc0 W_ver_b
  s_waitcnt vmcnt(34)
  s_mov_b64 exec, 1
  ds_write_b32 v33, v35
  s_mov_b64 exec, -1
  s_waitcnt lgkmcnt(0)
W_ver_b:
  s_barrier
  ds_read_b32 v32, v33
  s_waitcnt lgkmcnt(0)
  v_readfirstlane_b32 s54, v32
  s_nop 0
  s_bitcmp1_b32 s54, s0
  s_cbranch_scc1 L_conf
W_ver_ok:
  s_waitcnt vmcnt(20) lgkmcnt(0)
  s_barrier
  s_add_u32 m0, s61, 98304
  s_add_u32 s54, s62, 1572864
  buffer_load_dwordx4 v207, s[20:23], s54 offen lds
  s_add_u32 m0, s61, 102400
  s_add_u32 s54, s62, 1703936
  buffer_load_dwordx4 v207, s[20:23], s54 offen lds
  s_add_u32 m0, s61, 106496
  s_add_u32 s54, s62, 1835008
  buffer_load_dwordx4 v207, s[20:23], s54 offen lds
  s_add_u32 m0, s61, 110592
  s_add_u32 s54, s62, 1966080
  buffer_load_dwordx4 v207, s[20:23], s54 offen lds
  v_add_u32 v215, 36864, v209
  ds_read_b64_tr_b16 a[0:1], v215 offset:0
  ds_read_b64_tr_b16 a[2:3], v215 offset:1024
  ds_read_b64_tr_b16 a[4:5], v215 offset:4096
  ds_read_b64_tr_b16 a[6:7], v215 offset:5120
  ds_read_b64_tr_b16 a[8:9], v215 offset:8192
  ds_read_b64_tr_b16 a[10:11], v215 offset:9216
  ds_read_b64_tr_b16 a[12:13], v215 offset:12288
  ds_read_b64_tr_b16 a[14:15], v215 offset:13312
  s_waitcnt vmcnt(20) lgkmcnt(0)
  s_barrier
  s_add_u32 m0, s61, 0
  s_add_u32 s54, s62, 1572864
  buffer_load_dwordx4 v207, s[24:27], s54 offen lds
  s_add_u32 m0, s61, 4096
  s_add_u32 s54, s62, 1703936
  buffer_load_dwordx4 v207, s[24:27], s54 offen lds
  s_add_u32 m0, s61, 8192
  s_add_u32 s54, s62, 1835008
  buffer_load_dwordx4 v207, s[24:27], s54 offen lds
  s_add_u32 m0, s61, 12288
  s_add_u32 s54, s62, 1966080
  buffer_load_dwordx4 v207, s[24:27], s54 offen lds
  v_add_u32 v215, 53248, v210
  ds_read_b64_tr_b16 a[144:145], v215 offset:0
  ds_read_b64_tr_b16 a[146:147], v215 offset:1024
  ds_read_b64_tr_b16 a[148:149], v215 offset:4096
  ds_read_b64_tr_b16 a[150:151], v215 offset:5120
  ds_read_b64_tr_b16 a[152:153], v215 offset:8192
  ds_read_b64_tr_b16 a[154:155], v215 offset:9216
  ds_read_b64_tr_b16 a[156:157], v215 offset:12288
  ds_read_b64_tr_b16 a[158:159], v215 offset:13312
  s_waitcnt vmcnt(20) lgkmcnt(0)
  s_barrier
  s_add_u32 m0, s61, 16384
  s_add_u32 s54, s62, 2097152
  buffer_load_dwordx4 v207, s[20:23], s54 offen lds
  s_add_u32 m0, s61, 20480
  s_add_u32 s54, s62, 2228224
  buffer_load_dwordx4 v207, s[20:23], s54 offen lds
  s_add_u32 m0, s61, 24576
  s_add_u32 s54, s62, 2359296
  buffer_load_dwordx4 v207, s[20:23], s54 offen lds
  s_add_u32 m0, s61, 28672
  s_add_u32 s54, s62, 2490368
  buffer_load_dwordx4 v207, s[20:23], s54 offen lds
  v_add_u32 v215, 69632, v209
  ds_read_b64_tr_b16 a[16:17], v215 offset:0
  ds_read_b64_tr_b16 a[18:19], v215 offset:1024
  ds_read_b64_tr_b16 a[20:21], v215 offset:4096
  ds_read_b64_tr_b16 a[22:23], v215 offset:5120
  ds_read_b64_tr_b16 a[24:25], v215 offset:8192
  ds_read_b64_tr_b16 a[26:27], v215 offset:9216
  ds_read_b64_tr_b16 a[28:29], v215 offset:12288
  ds_read_b64_tr_b16 a[30:31], v215 offset:13312
  s_waitcnt vmcnt(20) lgkmcnt(0)
  s_barrier
  s_add_u32 m0, s61, 32768
  s_add_u32 s54, s62, 2097152
  buffer_load_dwordx4 v207, s[24:27], s54 offen lds
  s_add_u32 m0, s61, 36864
  s_add_u32 s54, s62, 2228224
  buffer_load_dwordx4 v207, s[24:27], s54 offen lds
  s_add_u32 m0, s61, 40960
  s_add_u32 s54, s62, 2359296
  buffer_load_dwordx4 v207, s[24:27], s54 offen lds
  s_add_u32 m0, s61, 45056
  s_add_u32 s54, s62, 2490368
  buffer_load_dwordx4 v207, s[24:27], s54 offen lds
  v_add_u32 v215, 86016, v210
  ds_read_b64_tr_b16 a[160:161], v215 offset:0
  ds_read_b64_tr_b16 a[162:163], v215 offset:1024
  ds_read_b64_tr_b16 a[164:165], v215 offset:4096
  ds_read_b64_tr_b16 a[166:167], v215 offset:5120
  ds_read_b64_tr_b16 a[168:169], v215 offset:8192
  ds_read_b64_tr_b16 a[170:171], v215 offset:9216
  ds_read_b64_tr_b16 a[172:173], v215 offset:12288
  ds_read_b64_tr_b16 a[174:175], v215 offset:13312
  s_waitcnt vmcnt(20) lgkmcnt(0)
  s_barrier
  s_add_u32 m0, s61, 49152
  s_add_u32 s54, s62, 2621440
  buffer_load_dwordx4 v207, s[20:23], s54 offen lds
  s_add_u32 m0, s61, 53248
  s_add_u32 s54, s62, 2752512
  buffer_load_dwordx4 v207, s[20:23], s54 offen lds
  s_add_u32 m0, s61, 57344
  s_add_u32 s54, s62, 2883584
  buffer_load_dwordx4 v207, s[20:23], s54 offen lds
  s_add_u32 m0, s61, 61440
  s_add_u32 s54, s62, 3014656
  buffer_load_dwordx4 v207, s[20:23], s54 offen lds
  v_add_u32 v215, 102400, v209
  ds_read_b64_tr_b16 a[32:33], v215 offset:0
  ds_read_b64_tr_b16 a[34:35], v215 offset:1024
  ds_read_b64_tr_b16 a[36:37], v215 offset:4096
  ds_read_b64_tr_b16 a[38:39], v215 offset:5120
  ds_read_b64_tr_b16 a[40:41], v215 offset:8192
  ds_read_b64_tr_b16 a[42:43], v215 offset:9216
  ds_read_b64_tr_b16 a[44:45], v215 offset:12288
  ds_read_b64_tr_b16 a[46:47], v215 offset:13312
  s_waitcnt vmcnt(20) lgkmcnt(0)
  s_barrier
  s_add_u32 m0, s61, 65536
  s_add_u32 s54, s62, 2621440
  buffer_load_dwordx4 v207, s[24:27], s54 offen lds
  s_add_u32 m0, s61, 69632
  s_add_u32 s54, s62, 2752512
  buffer_load_dwordx4 v207, s[24:27], s54 offen lds
  s_add_u32 m0, s61, 73728
  s_add_u32 s54, s62, 2883584
  buffer_load_dwordx4 v207, s[24:27], s54 offen lds
  s_add_u32 m0, s61, 77824
  s_add_u32 s54, s62, 3014656
  buffer_load_dwordx4 v207, s[24:27], s54 offen lds
  v_add_u32 v215, 118784, v210
  ds_read_b64_tr_b16 a[176:177], v215 offset:0
  ds_read_b64_tr_b16 a[178:179], v215 offset:1024
  ds_read_b64_tr_b16 a[180:181], v215 offset:4096
  ds_read_b64_tr_b16 a[182:183], v215 offset:5120
  ds_read_b64_tr_b16 a[184:185], v215 offset:8192
  ds_read_b64_tr_b16 a[186:187], v215 offset:9216
  ds_read_b64_tr_b16 a[188:189], v215 offset:12288
  ds_read_b64_tr_b16 a[190:191], v215 offset:13312
  s_waitcnt vmcnt(20) lgkmcnt(0)
  s_barrier
  s_add_u32 m0, s61, 81920
  s_add_u32 s54, s62, 3145728
  buffer_load_dwordx4 v207, s[20:23], s54 offen lds
  s_add_u32 m0, s61, 86016
  s_add_u32 s54, s62, 3276800
  buffer_load_dwordx4 v207, s[20:23], s54 offen lds
  s_add_u32 m0, s61, 90112
  s_add_u32 s54, s62, 3407872
  buffer_load_dwordx4 v207, s[20:23], s54 offen lds
  s_add_u32 m0, s61, 94208
  s_add_u32 s54, s62, 3538944
  buffer_load_dwordx4 v207, s[20:23], s54 offen lds
  v_add_u32 v215, 135168, v209
  ds_read_b64_tr_b16 a[48:49], v215 offset:0
  ds_read_b64_tr_b16 a[50:51], v215 offset:1024
  ds_read_b64_tr_b16 a[52:53], v215 offset:4096
  ds_read_b64_tr_b16 a[54:55], v215 offset:5120
  ds_read_b64_tr_b16 a[56:57], v215 offset:8192
  ds_read_b64_tr_b16 a[58:59], v215 offset:9216
  ds_read_b64_tr_b16 a[60:61], v215 offset:12288
  ds_read_b64_tr_b16 a[62:63], v215 offset:13312
  s_waitcnt vmcnt(20) lgkmcnt(0)
  s_barrier
  s_add_u32 m0, s61, 98304
  s_add_u32 s54, s62, 3145728
  buffer_load_dwordx4 v207, s[24:27], s54 offen lds
  s_add_u32 m0, s61, 102400
  s_add_u32 s54, s62, 3276800
  buffer_load_dwordx4 v207, s[24:27], s54 offen lds
  s_add_u32 m0, s61, 106496
  s_add_u32 s54, s62, 3407872
  buffer_load_dwordx4 v207, s[24:27], s54 offen lds
  s_add_u32 m0, s61, 110592
  s_add_u32 s54, s62, 3538944
  buffer_load_dwordx4 v207, s[24:27], s54 offen lds
  v_add_u32 v215, 36864, v210
  ds_read_b64_tr_b16 a[192:193], v215 offset:0
  ds_read_b64_tr_b16 a[194:195], v215 offset:1024
  ds_read_b64_tr_b16 a[196:197], v215 offset:4096
  ds_read_b64_tr_b16 a[198:199], v215 offset:5120
  ds_read_b64_tr_b16 a[200:201], v215 offset:8192
  ds_read_b64_tr_b16 a[202:203], v215 offset:9216
  ds_read_b64_tr_b16 a[204:205], v215 offset:12288
  ds_read_b64_tr_b16 a[206:207], v215 offset:13312
  s_waitcnt vmcnt(20) lgkmcnt(0)
  s_barrier
  s_add_u32 m0, s61, 0
  s_add_u32 s54, s62, 3670016
  buffer_load_dwordx4 v207, s[20:23], s54 offen lds
  s_add_u32 m0, s61, 4096
  s_add_u32 s54, s62, 3801088
  buffer_load_dwordx4 v207, s[20:23], s54 offen lds
  s_add_u32 m0, s61, 8192
  s_add_u32 s54, s62, 3932160
  buffer_load_dwordx4 v207, s[20:23], s54 offen lds
  s_add_u32 m0, s61, 12288
  s_add_u32 s54, s62, 4063232
  buffer_load_dwordx4 v207, s[20:23], s54 offen lds
  v_add_u32 v215, 53248, v209
  ds_read_b64_tr_b16 a[64:65], v215 offset:0
  ds_read_b64_tr_b16 a[66:67], v215 offset:1024
  ds_read_b64_tr_b16 a[68:69], v215 offset:4096
  ds_read_b64_tr_b16 a[70:71], v215 offset:5120
  ds_read_b64_tr_b16 a[72:73], v215 offset:8192
  ds_read_b64_tr_b16 a[74:75], v215 offset:9216
  ds_read_b64_tr_b16 a[76:77], v215 offset:12288
  ds_read_b64_tr_b16 a[78:79], v215 offset:13312
  s_waitcnt vmcnt(20) lgkmcnt(0)
  s_barrier
  s_add_u32 m0, s61, 16384
  s_add_u32 s54, s62, 3670016
  buffer_load_dwordx4 v207, s[24:27], s54 offen lds
  s_add_u32 m0, s61, 20480
  s_add_u32 s54, s62, 3801088
  buffer_load_dwordx4 v207, s[24:27], s54 offen lds
  s_add_u32 m0, s61, 24576
  s_add_u32 s54, s62, 3932160
  buffer_load_dwordx4 v207, s[24:27], s54 offen lds
  s_add_u32 m0, s61, 28672
  s_add_u32 s54, s62, 4063232
  buffer_load_dwordx4 v207, s[24:27], s54 offen lds
  v_add_u32 v215, 69632, v210
  ds_read_b64_tr_b16 a[208:209], v215 offset:0
  ds_read_b64_tr_b16 a[210:211], v215 offset:1024
  ds_read_b64_tr_b16 a[212:213], v215 offset:4096
  ds_read_b64_tr_b16 a[214:215], v215 offset:5120
  ds_read_b64_tr_b16 a[216:217], v215 offset:8192
  ds_read_b64_tr_b16 a[218:219], v215 offset:9216
  ds_read_b64_tr_b16 a[220:221], v215 offset:12288
  ds_read_b64_tr_b16 a[222:223], v215 offset:13312
  s_waitcnt vmcnt(20) lgkmcnt(0)
  s_barrier
  s_add_u32 m0, s61, 32768
  s_add_u32 s54, s62, 4194304
  buffer_load_dwordx4 v207, s[20:23], s54 offen lds
  s_add_u32 m0, s61, 36864
  s_add_u32 s54, s62, 4325376
  buffer_load_dwordx4 v207, s[20:23], s54 offen lds
  s_add_u32 m0, s61, 40960
  s_add_u32 s54, s62, 4456448
  buffer_load_dwordx4 v207, s[20:23], s54 offen lds
  s_add_u32 m0, s61, 45056
  s_add_u32 s54, s62, 4587520
  buffer_load_dwordx4 v207, s[20:23], s54 offen lds
  v_add_u32 v215, 86016, v209
  ds_read_b64_tr_b16 a[80:81], v215 offset:0
  ds_read_b64_tr_b16 a[82:83], v215 offset:1024
  ds_read_b64_tr_b16 a[84:85], v215 offset:4096
  ds_read_b64_tr_b16 a[86:87], v215 offset:5120
  ds_read_b64_tr_b16 a[88:89], v215 offset:8192
  ds_read_b64_tr_b16 a[90:91], v215 offset:9216
  ds_read_b64_tr_b16 a[92:93], v215 offset:12288
  ds_read_b64_tr_b16 a[94:95], v215 offset:13312
  s_waitcnt vmcnt(20) lgkmcnt(0)
  s_barrier
  s_add_u32 m0, s61, 49152
  s_add_u32 s54, s62, 4194304
  buffer_load_dwordx4 v207, s[24:27], s54 offen lds
  s_add_u32 m0, s61, 53248
  s_add_u32 s54, s62, 4325376
  buffer_load_dwordx4 v207, s[24:27], s54 offen lds
  s_add_u32 m0, s61, 57344
  s_add_u32 s54, s62, 4456448
  buffer_load_dwordx4 v207, s[24:27], s54 offen lds
  s_add_u32 m0, s61, 61440
  s_add_u32 s54, s62, 4587520
  buffer_load_dwordx4 v207, s[24:27], s54 offen lds
  s_mul_i32 s54, s53, 21120
  s_lshl_b32 s55, s52, 13
  s_add_u32 s54, s54, s55
  s_cmp_eq_u32 s52, 3
  s_cselect_b32 s54, 0x10000000, s54
  v_lshlrev_b32 v211, 3, v201
  buffer_load_dword v196, v211, s[28:31], s54 offen
  v_add_u32 v215, 102400, v210
  ds_read_b64_tr_b16 a[224:225], v215 offset:0
  ds_read_b64_tr_b16 a[226:227], v215 offset:1024
  ds_read_b64_tr_b16 a[228:229], v215 offset:4096
  ds_read_b64_tr_b16 a[230:231], v215 offset:5120
  ds_read_b64_tr_b16 a[232:233], v215 offset:8192
  ds_read_b64_tr_b16 a[234:235], v215 offset:9216
  ds_read_b64_tr_b16 a[236:237], v215 offset:12288
  ds_read_b64_tr_b16 a[238:239], v215 offset:13312
  s_waitcnt vmcnt(21) lgkmcnt(0)
  s_barrier
  s_lshl_b32 s54, s53, 13
  s_lshr_b32 s55, s53, 6
  s_or_b32 s55, s55, s52
  s_cmp_eq_u32 s55, 0
  s_cselect_b32 s54, s54, 0x10000000
  v_lshlrev_b32 v211, 3, v201
  buffer_load_dword v196, v211, s[16:19], s54 offen
  v_add_u32 v215, 118784, v209
  ds_read_b64_tr_b16 a[96:97], v215 offset:0
  ds_read_b64_tr_b16 a[98:99], v215 offset:1024
  ds_read_b64_tr_b16 a[100:101], v215 offset:4096
  ds_read_b64_tr_b16 a[102:103], v215 offset:5120
  ds_read_b64_tr_b16 a[104:105], v215 offset:8192
  ds_read_b64_tr_b16 a[106:107], v215 offset:9216
  ds_read_b64_tr_b16 a[108:109], v215 offset:12288
  ds_read_b64_tr_b16 a[110:111], v215 offset:13312
  s_waitcnt vmcnt(18) lgkmcnt(0)
  s_barrier
  v_add_u32 v215, 135168, v210
  ds_read_b64_tr_b16 a[240:241], v215 offset:0
  ds_read_b64_tr_b16 a[242:243], v215 offset:1024
  ds_read_b64_tr_b16 a[244:245], v215 offset:4096
  ds_read_b64_tr_b16 a[246:247], v215 offset:5120
  ds_read_b64_tr_b16 a[248:249], v215 offset:8192
  ds_read_b64_tr_b16 a[250:251], v215 offset:9216
  ds_read_b64_tr_b16 a[252:253], v215 offset:12288
  ds_read_b64_tr_b16 a[254:255], v215 offset:13312
  s_waitcnt vmcnt(14) lgkmcnt(0)
  s_barrier
  v_add_u32 v215, 36864, v209
  ds_read_b64_tr_b16 a[112:113], v215 offset:0
  ds_read_b64_tr_b16 a[114:115], v215 offset:1024
  ds_read_b64_tr_b16 a[116:117], v215 offset:4096
  ds_read_b64_tr_b16 a[118:119], v215 offset:5120
  ds_read_b64_tr_b16 a[120:121], v215 offset:8192
  ds_read_b64_tr_b16 a[122:123], v215 offset:9216
  ds_read_b64_tr_b16 a[124:125], v215 offset:12288
  ds_read_b64_tr_b16 a[126:127], v215 offset:13312
  s_waitcnt vmcnt(10) lgkmcnt(0)
  s_barrier
  v_add_u32 v215, 53248, v210
  ds_read_b64_tr_b16 v[224:225], v215 offset:0
  ds_read_b64_tr_b16 v[226:227], v215 offset:1024
  ds_read_b64_tr_b16 v[228:229], v215 offset:4096
  ds_read_b64_tr_b16 v[230:231], v215 offset:5120
  ds_read_b64_tr_b16 v[232:233], v215 offset:8192
  ds_read_b64_tr_b16 v[234:235], v215 offset:9216
  ds_read_b64_tr_b16 v[236:237], v215 offset:12288
  ds_read_b64_tr_b16 v[238:239], v215 offset:13312
  s_waitcnt vmcnt(6) lgkmcnt(0)
  s_barrier
  v_add_u32 v215, 69632, v209
  ds_read_b64_tr_b16 a[128:129], v215 offset:0
  ds_read_b64_tr_b16 a[130:131], v215 offset:1024
  ds_read_b64_tr_b16 a[132:133], v215 offset:4096
  ds_read_b64_tr_b16 a[134:135], v215 offset:5120
  ds_read_b64_tr_b16 a[136:137], v215 offset:8192
  ds_read_b64_tr_b16 a[138:139], v215 offset:9216
  ds_read_b64_tr_b16 a[140:141], v215 offset:12288
  ds_read_b64_tr_b16 a[142:143], v215 offset:13312
  s_waitcnt vmcnt(2) lgkmcnt(0)
  s_barrier
  v_add_u32 v215, 86016, v210
  ds_read_b64_tr_b16 v[240:241], v215 offset:0
  ds_read_b64_tr_b16 v[242:243], v215 offset:1024
  ds_read_b64_tr_b16 v[244:245], v215 offset:4096
  ds_read_b64_tr_b16 v[246:247], v215 offset:5120
  ds_read_b64_tr_b16 v[248:249], v215 offset:8192
  ds_read_b64_tr_b16 v[250:251], v215 offset:9216
  ds_read_b64_tr_b16 v[252:253], v215 offset:12288
  ds_read_b64_tr_b16 v[254:255], v215 offset:13312
  s_waitcnt lgkmcnt(0)
  s_barrier
  s_mul_i32 s55, s53, 21846
  s_lshr_b32 s55, s55, 16
  s_mul_i32 s56, s55, 3
  s_sub_u32 s56, s53, s56
  s_lshl_b32 s56, s56, 7
  s_lshl_b32 s55, s55, 2
  s_add_u32 s55, s55, s56
  s_add_u32 s55, s55, 356352
  s_cmp_lt_u32 s53, 96
  s_cselect_b32 s71, s55, 268435456
  v_mov_b32 v211, 0
  s_mov_b64 exec, 1
  buffer_store_dword v211, v211, s[8:11], s71 offen sc1
  s_mov_b64 exec, -1
  s_mov_b32 s68, 1040356334
  s_lshl_b32 s69, s52, 9
  s_lshl_b32 s70, s58, 2
  s_add_u32 s70, s70, 128
KV_loop:
  s_add_u32 s60, s60, 258048
  s_add_u32 m0, s67, 36864
  s_nop 0
  buffer_load_dwordx4 v202, s[4:7], s60 offen offset:0 lds
  s_add_u32 m0, s67, 37760
  s_nop 0
  buffer_load_dwordx4 v202, s[4:7], s60 offen offset:128 lds
  s_add_u32 m0, s67, 38656
  s_nop 0
  buffer_load_dwordx4 v202, s[4:7], s60 offen offset:256 lds
  s_add_u32 m0, s67, 39552
  s_nop 0
  buffer_load_dwordx4 v202, s[4:7], s60 offen offset:384 lds
  s_add_u32 m0, s67, 40448
  s_nop 0
  buffer_load_dwordx4 v202, s[4:7], s60 offen offset:512 lds
  s_add_u32 m0, s67, 41344
  s_nop 0
  buffer_load_dwordx4 v202, s[4:7], s60 offen offset:640 lds
  s_add_u32 m0, s67, 42240
  s_nop 0
  buffer_load_dwordx4 v202, s[4:7], s60 offen offset:768 lds
  s_add_u32 m0, s67, 43136
  s_nop 0
  buffer_load_dwordx4 v202, s[4:7], s60 offen offset:896 lds
  s_add_u32 m0, s67, 44032
  s_nop 0
  buffer_load_dwordx4 v202, s[4:7], s60 offen offset:1024 lds
  ds_read_b128 v[32:35], v203 offset:0
  ds_read_b128 v[36:39], v204 offset:0
  ds_read_b128 v[40:43], v205 offset:0
  s_waitcnt lgkmcnt(2)
  v_mfma_f32_32x32x16_bf16 v[0:15], a[0:3], v[32:35], 0
  ds_read_b128 v[44:47], v206 offset:0
  v_mfma_f32_32x32x16_bf16 v[16:31], v[32:35], a[144:147], 0
  s_waitcnt lgkmcnt(2)
  v_mfma_f32_32x32x16_bf16 v[0:15], a[4:7], v[36:39], v[0:15]
  ds_read_b128 v[32:35], v203 offset:1024
  v_mfma_f32_32x32x16_bf16 v[16:31], v[36:39], a[148:151], v[16:31]
  s_waitcnt lgkmcnt(2)
  v_mfma_f32_32x32x16_bf16 v[0:15], a[8:11], v[40:43], v[0:15]
  ds_read_b128 v[36:39], v204 offset:1024
  v_mfma_f32_32x32x16_bf16 v[16:31], v[40:43], a[152:155], v[16:31]
  s_waitcnt lgkmcnt(2)
  v_mfma_f32_32x32x16_bf16 v[0:15], a[12:15], v[44:47], v[0:15]
  ds_read_b128 v[40:43], v205 offset:1024
  v_mfma_f32_32x32x16_bf16 v[16:31], v[44:47], a[156:159], v[16:31]
  s_waitcnt lgkmcnt(2)
  v_mfma_f32_32x32x16_bf16 v[0:15], a[16:19], v[32:35], v[0:15]
  ds_read_b128 v[44:47], v206 offset:1024
  v_mfma_f32_32x32x16_bf16 v[16:31], v[32:35], a[160:163], v[16:31]
  s_waitcnt lgkmcnt(2)
  v_mfma_f32_32x32x16_bf16 v[0:15], a[20:23], v[36:39], v[0:15]
  ds_read_b128 v[32:35], v203 offset:2048
  v_mfma_f32_32x32x16_bf16 v[16:31], v[36:39], a[164:167], v[16:31]
  s_waitcnt lgkmcnt(2)
  v_mfma_f32_32x32x16_bf16 v[0:15], a[24:27], v[40:43], v[0:15]
  ds_read_b128 v[36:39], v204 offset:2048
  v_mfma_f32_32x32x16_bf16 v[16:31], v[40:43], a[168:171], v[16:31]
  s_waitcnt lgkmcnt(2)
  v_mfma_f32_32x32x16_bf16 v[0:15], a[28:31], v[44:47], v[0:15]
  ds_read_b128 v[40:43], v205 offset:2048
  v_mfma_f32_32x32x16_bf16 v[16:31], v[44:47], a[172:175], v[16:31]
  s_waitcnt lgkmcnt(2)
  v_mfma_f32_32x32x16_bf16 v[0:15], a[32:35], v[32:35], v[0:15]
  ds_read_b128 v[44:47], v206 offset:2048
  v_mfma_f32_32x32x16_bf16 v[16:31], v[32:35], a[176:179], v[16:31]
  s_waitcnt lgkmcnt(2)
  v_mfma_f32_32x32x16_bf16 v[0:15], a[36:39], v[36:39], v[0:15]
  ds_read_b128 v[32:35], v203 offset:3072
  v_mfma_f32_32x32x16_bf16 v[16:31], v[36:39], a[180:183], v[16:31]
  s_waitcnt lgkmcnt(2)
  v_mfma_f32_32x32x16_bf16 v[0:15], a[40:43], v[40:43], v[0:15]
  ds_read_b128 v[36:39], v204 offset:3072
  v_mfma_f32_32x32x16_bf16 v[16:31], v[40:43], a[184:187], v[16:31]
  s_waitcnt lgkmcnt(2)
  v_mfma_f32_32x32x16_bf16 v[0:15], a[44:47], v[44:47], v[0:15]
  ds_read_b128 v[40:43], v205 offset:3072
  v_mfma_f32_32x32x16_bf16 v[16:31], v[44:47], a[188:191], v[16:31]
  s_waitcnt lgkmcnt(2)
  v_mfma_f32_32x32x16_bf16 v[0:15], a[48:51], v[32:35], v[0:15]
  ds_read_b128 v[44:47], v206 offset:3072
  v_mfma_f32_32x32x16_bf16 v[16:31], v[32:35], a[192:195], v[16:31]
  s_waitcnt lgkmcnt(2)
  v_mfma_f32_32x32x16_bf16 v[0:15], a[52:55], v[36:39], v[0:15]
  ds_read_b128 v[32:35], v203 offset:4096
  v_mfma_f32_32x32x16_bf16 v[16:31], v[36:39], a[196:199], v[16:31]
  s_waitcnt lgkmcnt(2)
  v_mfma_f32_32x32x16_bf16 v[0:15], a[56:59], v[40:43], v[0:15]
  ds_read_b128 v[36:39], v204 offset:4096
  v_mfma_f32_32x32x16_bf16 v[16:31], v[40:43], a[200:203], v[16:31]
  s_waitcnt lgkmcnt(2)
  v_mfma_f32_32x32x16_bf16 v[0:15], a[60:63], v[44:47], v[0:15]
  ds_read_b128 v[40:43], v205 offset:4096
  v_mfma_f32_32x32x16_bf16 v[16:31], v[44:47], a[204:207], v[16:31]
  s_waitcnt lgkmcnt(2)
  v_mfma_f32_32x32x16_bf16 v[0:15], a[64:67], v[32:35], v[0:15]
  ds_read_b128 v[44:47], v206 offset:4096
  v_mfma_f32_32x32x16_bf16 v[16:31], v[32:35], a[208:211], v[16:31]
  s_waitcnt lgkmcnt(2)
  v_mfma_f32_32x32x16_bf16 v[0:15], a[68:71], v[36:39], v[0:15]
  ds_read_b128 v[32:35], v203 offset:5120
  v_mfma_f32_32x32x16_bf16 v[16:31], v[36:39], a[212:215], v[16:31]
  s_waitcnt lgkmcnt(2)
  v_mfma_f32_32x32x16_bf16 v[0:15], a[72:75], v[40:43], v[0:15]
  ds_read_b128 v[36:39], v204 offset:5120
  v_mfma_f32_32x32x16_bf16 v[16:31], v[40:43], a[216:219], v[16:31]
  s_waitcnt lgkmcnt(2)
  v_mfma_f32_32x32x16_bf16 v[0:15], a[76:79], v[44:47], v[0:15]
  ds_read_b128 v[40:43], v205 offset:5120
  v_mfma_f32_32x32x16_bf16 v[16:31], v[44:47], a[220:223], v[16:31]
  s_waitcnt lgkmcnt(2)
  v_mfma_f32_32x32x16_bf16 v[0:15], a[80:83], v[32:35], v[0:15]
  ds_read_b128 v[44:47], v206 offset:5120
  v_mfma_f32_32x32x16_bf16 v[16:31], v[32:35], a[224:227], v[16:31]
  s_waitcnt lgkmcnt(2)
  v_mfma_f32_32x32x16_bf16 v[0:15], a[84:87], v[36:39], v[0:15]
  ds_read_b128 v[32:35], v203 offset:6144
  v_mfma_f32_32x32x16_bf16 v[16:31], v[36:39], a[228:231], v[16:31]
  s_waitcnt lgkmcnt(2)
  v_mfma_f32_32x32x16_bf16 v[0:15], a[88:91], v[40:43], v[0:15]
  ds_read_b128 v[36:39], v204 offset:6144
  v_mfma_f32_32x32x16_bf16 v[16:31], v[40:43], a[232:235], v[16:31]
  s_waitcnt lgkmcnt(2)
  v_mfma_f32_32x32x16_bf16 v[0:15], a[92:95], v[44:47], v[0:15]
  ds_read_b128 v[40:43], v205 offset:6144
  v_mfma_f32_32x32x16_bf16 v[16:31], v[44:47], a[236:239], v[16:31]
  s_waitcnt lgkmcnt(2)
  v_mfma_f32_32x32x16_bf16 v[0:15], a[96:99], v[32:35], v[0:15]
  ds_read_b128 v[44:47], v206 offset:6144
  v_mfma_f32_32x32x16_bf16 v[16:31], v[32:35], a[240:243], v[16:31]
  s_waitcnt lgkmcnt(2)
  v_mfma_f32_32x32x16_bf16 v[0:15], a[100:103], v[36:39], v[0:15]
  ds_read_b128 v[32:35], v203 offset:7168
  v_mfma_f32_32x32x16_bf16 v[16:31], v[36:39], a[244:247], v[16:31]
  s_waitcnt lgkmcnt(2)
  v_mfma_f32_32x32x16_bf16 v[0:15], a[104:107], v[40:43], v[0:15]
  ds_read_b128 v[36:39], v204 offset:7168
  v_mfma_f32_32x32x16_bf16 v[16:31], v[40:43], a[248:251], v[16:31]
  s_waitcnt lgkmcnt(2)
  v_mfma_f32_32x32x16_bf16 v[0:15], a[108:111], v[44:47], v[0:15]
  ds_read_b128 v[40:43], v205 offset:7168
  v_mfma_f32_32x32x16_bf16 v[16:31], v[44:47], a[252:255], v[16:31]
  s_waitcnt lgkmcnt(2)
  v_mfma_f32_32x32x16_bf16 v[0:15], a[112:115], v[32:35], v[0:15]
  ds_read_b128 v[44:47], v206 offset:7168
  v_mfma_f32_32x32x16_bf16 v[16:31], v[32:35], v[224:227], v[16:31]
  s_waitcnt lgkmcnt(2)
  v_mfma_f32_32x32x16_bf16 v[0:15], a[116:119], v[36:39], v[0:15]
  ds_read_b128 v[32:35], v203 offset:8192
  v_mfma_f32_32x32x16_bf16 v[16:31], v[36:39], v[228:231], v[16:31]
  s_waitcnt lgkmcnt(2)
  v_mfma_f32_32x32x16_bf16 v[0:15], a[120:123], v[40:43], v[0:15]
  ds_read_b128 v[36:39], v204 offset:8192
  v_mfma_f32_32x32x16_bf16 v[16:31], v[40:43], v[232:235], v[16:31]
  s_waitcnt lgkmcnt(2)
  v_mfma_f32_32x32x16_bf16 v[0:15], a[124:127], v[44:47], v[0:15]
  ds_read_b128 v[40:43], v205 offset:8192
  v_mfma_f32_32x32x16_bf16 v[16:31], v[44:47], v[236:239], v[16:31]
  s_waitcnt lgkmcnt(2)
  v_mfma_f32_32x32x16_bf16 v[0:15], a[128:131], v[32:35], v[0:15]
  ds_read_b128 v[44:47], v206 offset:8192
  v_mfma_f32_32x32x16_bf16 v[16:31], v[32:35], v[240:243], v[16:31]
  s_waitcnt lgkmcnt(2)
  v_mfma_f32_32x32x16_bf16 v[0:15], a[132:135], v[36:39], v[0:15]
  v_mfma_f32_32x32x16_bf16 v[16:31], v[36:39], v[244:247], v[16:31]
  s_waitcnt lgkmcnt(1)
  v_mfma_f32_32x32x16_bf16 v[0:15], a[136:139], v[40:43], v[0:15]
  v_mfma_f32_32x32x16_bf16 v[16:31], v[40:43], v[248:251], v[16:31]
  s_waitcnt lgkmcnt(0)
  v_mfma_f32_32x32x16_bf16 v[0:15], a[140:143], v[44:47], v[0:15]
  v_mfma_f32_32x32x16_bf16 v[16:31], v[44:47], v[252:255], v[16:31]
  s_mul_i32 s64, s59, 655360
  s_lshl_b32 s55, s58, 14
  s_add_u32 s64, s64, s55
  s_add_u32 s64, s64, 1048576
  s_add_u32 s55, s64, s69
  v_mul_f32 v0, s68, v0
  v_mul_f32 v1, s68, v1
  v_mul_f32 v2, s68, v2
  v_mul_f32 v3, s68, v3
  v_mul_f32 v4, s68, v4
  v_mul_f32 v5, s68, v5
  v_mul_f32 v6, s68, v6
  v_mul_f32 v7, s68, v7
  v_mul_f32 v8, s68, v8
  v_mul_f32 v9, s68, v9
  v_mul_f32 v10, s68, v10
  v_mul_f32 v11, s68, v11
  v_mul_f32 v12, s68, v12
  v_mul_f32 v13, s68, v13
  v_mul_f32 v14, s68, v14
  v_mul_f32 v15, s68, v15
  v_cvt_pk_bf16_f32 v48, v0, v4
  v_cvt_pk_bf16_f32 v49, v1, v5
  v_cvt_pk_bf16_f32 v50, v2, v6
  v_cvt_pk_bf16_f32 v51, v3, v7
  buffer_store_dwordx4 v[48:51], v216, s[8:11], s55 offen offset:0 sc1
  v_cvt_pk_bf16_f32 v52, v8, v12
  v_cvt_pk_bf16_f32 v53, v9, v13
  v_cvt_pk_bf16_f32 v54, v10, v14
  v_cvt_pk_bf16_f32 v55, v11, v15
  buffer_store_dwordx4 v[52:55], v216, s[8:11], s55 offen offset:256 sc1
  v_cvt_pk_bf16_f32 v56, v16, v17
  v_cvt_pk_bf16_f32 v57, v20, v21
  v_cvt_pk_bf16_f32 v58, v24, v25
  v_cvt_pk_bf16_f32 v59, v28, v29
  buffer_store_dwordx4 v[56:59], v217, s[8:11], s64 offen offset:0 sc1
  v_cvt_pk_bf16_f32 v60, v18, v19
  v_cvt_pk_bf16_f32 v61, v22, v23
  v_cvt_pk_bf16_f32 v62, v26, v27
  v_cvt_pk_bf16_f32 v63, v30, v31
  buffer_store_dwordx4 v[60:63], v217, s[8:11], s64 offen offset:256 sc1
  s_add_u32 s59, s59, 7
  s_cmp_ge_u32 s59, 64
  s_cbranch_scc1 KV_done
  s_waitcnt vmcnt(4)
  s_barrier
  s_add_u32 s60, s60, 258048
  s_add_u32 m0, s67, 0
  s_nop 0
  buffer_load_dwordx4 v202, s[4:7], s60 offen offset:0 lds
  s_add_u32 m0, s67, 896
  s_nop 0
  buffer_load_dwordx4 v202, s[4:7], s60 offen offset:128 lds
  s_add_u32 m0, s67, 1792
  s_nop 0
  buffer_load_dwordx4 v202, s[4:7], s60 offen offset:256 lds
  s_add_u32 m0, s67, 2688
  s_nop 0
  buffer_load_dwordx4 v202, s[4:7], s60 offen offset:384 lds
  s_add_u32 m0, s67, 3584
  s_nop 0
  buffer_load_dwordx4 v202, s[4:7], s60 offen offset:512 lds
  s_add_u32 m0, s67, 4480
  s_nop 0
  buffer_load_dwordx4 v202, s[4:7], s60 offen offset:640 lds
  s_add_u32 m0, s67, 5376
  s_nop 0
  buffer_load_dwordx4 v202, s[4:7], s60 offen offset:768 lds
  s_add_u32 m0, s67, 6272
  s_nop 0
  buffer_load_dwordx4 v202, s[4:7], s60 offen offset:896 lds
  s_add_u32 m0, s67, 7168
  s_nop 0
  buffer_load_dwordx4 v202, s[4:7], s60 offen offset:1024 lds
  ds_read_b128 v[32:35], v203 offset:36864
  ds_read_b128 v[36:39], v204 offset:36864
  ds_read_b128 v[40:43], v205 offset:36864
  s_waitcnt lgkmcnt(2)
  v_mfma_f32_32x32x16_bf16 v[0:15], a[0:3], v[32:35], 0
  ds_read_b128 v[44:47], v206 offset:36864
  v_mfma_f32_32x32x16_bf16 v[16:31], v[32:35], a[144:147], 0
  s_waitcnt lgkmcnt(2)
  v_mfma_f32_32x32x16_bf16 v[0:15], a[4:7], v[36:39], v[0:15]
  ds_read_b128 v[32:35], v203 offset:37888
  v_mfma_f32_32x32x16_bf16 v[16:31], v[36:39], a[148:151], v[16:31]
  s_waitcnt lgkmcnt(2)
  v_mfma_f32_32x32x16_bf16 v[0:15], a[8:11], v[40:43], v[0:15]
  ds_read_b128 v[36:39], v204 offset:37888
  v_mfma_f32_32x32x16_bf16 v[16:31], v[40:43], a[152:155], v[16:31]
  s_waitcnt lgkmcnt(2)
  v_mfma_f32_32x32x16_bf16 v[0:15], a[12:15], v[44:47], v[0:15]
  ds_read_b128 v[40:43], v205 offset:37888
  v_mfma_f32_32x32x16_bf16 v[16:31], v[44:47], a[156:159], v[16:31]
  s_waitcnt lgkmcnt(2)
  v_mfma_f32_32x32x16_bf16 v[0:15], a[16:19], v[32:35], v[0:15]
  ds_read_b128 v[44:47], v206 offset:37888
  v_mfma_f32_32x32x16_bf16 v[16:31], v[32:35], a[160:163], v[16:31]
  s_waitcnt lgkmcnt(2)
  v_mfma_f32_32x32x16_bf16 v[0:15], a[20:23], v[36:39], v[0:15]
  ds_read_b128 v[32:35], v203 offset:38912
  v_mfma_f32_32x32x16_bf16 v[16:31], v[36:39], a[164:167], v[16:31]
  s_waitcnt lgkmcnt(2)
  v_mfma_f32_32x32x16_bf16 v[0:15], a[24:27], v[40:43], v[0:15]
  ds_read_b128 v[36:39], v204 offset:38912
  v_mfma_f32_32x32x16_bf16 v[16:31], v[40:43], a[168:171], v[16:31]
  s_waitcnt lgkmcnt(2)
  v_mfma_f32_32x32x16_bf16 v[0:15], a[28:31], v[44:47], v[0:15]
  ds_read_b128 v[40:43], v205 offset:38912
  v_mfma_f32_32x32x16_bf16 v[16:31], v[44:47], a[172:175], v[16:31]
  s_waitcnt lgkmcnt(2)
  v_mfma_f32_32x32x16_bf16 v[0:15], a[32:35], v[32:35], v[0:15]
  ds_read_b128 v[44:47], v206 offset:38912
  v_mfma_f32_32x32x16_bf16 v[16:31], v[32:35], a[176:179], v[16:31]
  s_waitcnt lgkmcnt(2)
  v_mfma_f32_32x32x16_bf16 v[0:15], a[36:39], v[36:39], v[0:15]
  ds_read_b128 v[32:35], v203 offset:39936
  v_mfma_f32_32x32x16_bf16 v[16:31], v[36:39], a[180:183], v[16:31]
  s_waitcnt lgkmcnt(2)
  v_mfma_f32_32x32x16_bf16 v[0:15], a[40:43], v[40:43], v[0:15]
  ds_read_b128 v[36:39], v204 offset:39936
  v_mfma_f32_32x32x16_bf16 v[16:31], v[40:43], a[184:187], v[16:31]
  s_waitcnt lgkmcnt(2)
  v_mfma_f32_32x32x16_bf16 v[0:15], a[44:47], v[44:47], v[0:15]
  ds_read_b128 v[40:43], v205 offset:39936
  v_mfma_f32_32x32x16_bf16 v[16:31], v[44:47], a[188:191], v[16:31]
  s_waitcnt lgkmcnt(2)
  v_mfma_f32_32x32x16_bf16 v[0:15], a[48:51], v[32:35], v[0:15]
  ds_read_b128 v[44:47], v206 offset:39936
  v_mfma_f32_32x32x16_bf16 v[16:31], v[32:35], a[192:195], v[16:31]
  s_waitcnt lgkmcnt(2)
  v_mfma_f32_32x32x16_bf16 v[0:15], a[52:55], v[36:39], v[0:15]
  ds_read_b128 v[32:35], v203 offset:40960
  v_mfma_f32_32x32x16_bf16 v[16:31], v[36:39], a[196:199], v[16:31]
  s_waitcnt lgkmcnt(2)
  v_mfma_f32_32x32x16_bf16 v[0:15], a[56:59], v[40:43], v[0:15]
  ds_read_b128 v[36:39], v204 offset:40960
  v_mfma_f32_32x32x16_bf16 v[16:31], v[40:43], a[200:203], v[16:31]
  s_waitcnt lgkmcnt(2)
  v_mfma_f32_32x32x16_bf16 v[0:15], a[60:63], v[44:47], v[0:15]
  ds_read_b128 v[40:43], v205 offset:40960
  v_mfma_f32_32x32x16_bf16 v[16:31], v[44:47], a[204:207], v[16:31]
  s_waitcnt lgkmcnt(2)
  v_mfma_f32_32x32x16_bf16 v[0:15], a[64:67], v[32:35], v[0:15]
  ds_read_b128 v[44:47], v206 offset:40960
  v_mfma_f32_32x32x16_bf16 v[16:31], v[32:35], a[208:211], v[16:31]
  s_waitcnt lgkmcnt(2)
  v_mfma_f32_32x32x16_bf16 v[0:15], a[68:71], v[36:39], v[0:15]
  ds_read_b128 v[32:35], v203 offset:41984
  v_mfma_f32_32x32x16_bf16 v[16:31], v[36:39], a[212:215], v[16:31]
  s_waitcnt lgkmcnt(2)
  v_mfma_f32_32x32x16_bf16 v[0:15], a[72:75], v[40:43], v[0:15]
  ds_read_b128 v[36:39], v204 offset:41984
  v_mfma_f32_32x32x16_bf16 v[16:31], v[40:43], a[216:219], v[16:31]
  s_waitcnt lgkmcnt(2)
  v_mfma_f32_32x32x16_bf16 v[0:15], a[76:79], v[44:47], v[0:15]
  ds_read_b128 v[40:43], v205 offset:41984
  v_mfma_f32_32x32x16_bf16 v[16:31], v[44:47], a[220:223], v[16:31]
  s_waitcnt lgkmcnt(2)
  v_mfma_f32_32x32x16_bf16 v[0:15], a[80:83], v[32:35], v[0:15]
  ds_read_b128 v[44:47], v206 offset:41984
  v_mfma_f32_32x32x16_bf16 v[16:31], v[32:35], a[224:227], v[16:31]
  s_waitcnt lgkmcnt(2)
  v_mfma_f32_32x32x16_bf16 v[0:15], a[84:87], v[36:39], v[0:15]
  ds_read_b128 v[32:35], v203 offset:43008
  v_mfma_f32_32x32x16_bf16 v[16:31], v[36:39], a[228:231], v[16:31]
  s_waitcnt lgkmcnt(2)
  v_mfma_f32_32x32x16_bf16 v[0:15], a[88:91], v[40:43], v[0:15]
  ds_read_b128 v[36:39], v204 offset:43008
  v_mfma_f32_32x32x16_bf16 v[16:31], v[40:43], a[232:235], v[16:31]
  s_waitcnt lgkmcnt(2)
  v_mfma_f32_32x32x16_bf16 v[0:15], a[92:95], v[44:47], v[0:15]
  ds_read_b128 v[40:43], v205 offset:43008
  v_mfma_f32_32x32x16_bf16 v[16:31], v[44:47], a[236:239], v[16:31]
  s_waitcnt lgkmcnt(2)
  v_mfma_f32_32x32x16_bf16 v[0:15], a[96:99], v[32:35], v[0:15]
  ds_read_b128 v[44:47], v206 offset:43008
  v_mfma_f32_32x32x16_bf16 v[16:31], v[32:35], a[240:243], v[16:31]
  s_waitcnt lgkmcnt(2)
  v_mfma_f32_32x32x16_bf16 v[0:15], a[100:103], v[36:39], v[0:15]
  ds_read_b128 v[32:35], v203 offset:44032
  v_mfma_f32_32x32x16_bf16 v[16:31], v[36:39], a[244:247], v[16:31]
  s_waitcnt lgkmcnt(2)
  v_mfma_f32_32x32x16_bf16 v[0:15], a[104:107], v[40:43], v[0:15]
  ds_read_b128 v[36:39], v204 offset:44032
  v_mfma_f32_32x32x16_bf16 v[16:31], v[40:43], a[248:251], v[16:31]
  s_waitcnt lgkmcnt(2)
  v_mfma_f32_32x32x16_bf16 v[0:15], a[108:111], v[44:47], v[0:15]
  ds_read_b128 v[40:43], v205 offset:44032
  v_mfma_f32_32x32x16_bf16 v[16:31], v[44:47], a[252:255], v[16:31]
  s_waitcnt lgkmcnt(2)
  v_mfma_f32_32x32x16_bf16 v[0:15], a[112:115], v[32:35], v[0:15]
  ds_read_b128 v[44:47], v206 offset:44032
  v_mfma_f32_32x32x16_bf16 v[16:31], v[32:35], v[224:227], v[16:31]
  s_waitcnt lgkmcnt(2)
  v_mfma_f32_32x32x16_bf16 v[0:15], a[116:119], v[36:39], v[0:15]
  ds_read_b128 v[32:35], v203 offset:45056
  v_mfma_f32_32x32x16_bf16 v[16:31], v[36:39], v[228:231], v[16:31]
  s_waitcnt lgkmcnt(2)
  v_mfma_f32_32x32x16_bf16 v[0:15], a[120:123], v[40:43], v[0:15]
  ds_read_b128 v[36:39], v204 offset:45056
  v_mfma_f32_32x32x16_bf16 v[16:31], v[40:43], v[232:235], v[16:31]
  s_waitcnt lgkmcnt(2)
  v_mfma_f32_32x32x16_bf16 v[0:15], a[124:127], v[44:47], v[0:15]
  ds_read_b128 v[40:43], v205 offset:45056
  v_mfma_f32_32x32x16_bf16 v[16:31], v[44:47], v[236:239], v[16:31]
  s_waitcnt lgkmcnt(2)
  v_mfma_f32_32x32x16_bf16 v[0:15], a[128:131], v[32:35], v[0:15]
  ds_read_b128 v[44:47], v206 offset:45056
  v_mfma_f32_32x32x16_bf16 v[16:31], v[32:35], v[240:243], v[16:31]
  s_waitcnt lgkmcnt(2)
  v_mfma_f32_32x32x16_bf16 v[0:15], a[132:135], v[36:39], v[0:15]
  v_mfma_f32_32x32x16_bf16 v[16:31], v[36:39], v[244:247], v[16:31]
  s_waitcnt lgkmcnt(1)
  v_mfma_f32_32x32x16_bf16 v[0:15], a[136:139], v[40:43], v[0:15]
  v_mfma_f32_32x32x16_bf16 v[16:31], v[40:43], v[248:251], v[16:31]
  s_waitcnt lgkmcnt(0)
  v_mfma_f32_32x32x16_bf16 v[0:15], a[140:143], v[44:47], v[0:15]
  v_mfma_f32_32x32x16_bf16 v[16:31], v[44:47], v[252:255], v[16:31]
  s_mul_i32 s64, s59, 655360
  s_lshl_b32 s55, s58, 14
  s_add_u32 s64, s64, s55
  s_add_u32 s64, s64, 1048576
  s_add_u32 s55, s64, s69
  v_mul_f32 v0, s68, v0
  v_mul_f32 v1, s68, v1
  v_mul_f32 v2, s68, v2
  v_mul_f32 v3, s68, v3
  v_mul_f32 v4, s68, v4
  v_mul_f32 v5, s68, v5
  v_mul_f32 v6, s68, v6
  v_mul_f32 v7, s68, v7
  v_mul_f32 v8, s68, v8
  v_mul_f32 v9, s68, v9
  v_mul_f32 v10, s68, v10
  v_mul_f32 v11, s68, v11
  v_mul_f32 v12, s68, v12
  v_mul_f32 v13, s68, v13
  v_mul_f32 v14, s68, v14
  v_mul_f32 v15, s68, v15
  v_cvt_pk_bf16_f32 v48, v0, v4
  v_cvt_pk_bf16_f32 v49, v1, v5
  v_cvt_pk_bf16_f32 v50, v2, v6
  v_cvt_pk_bf16_f32 v51, v3, v7
  buffer_store_dwordx4 v[48:51], v216, s[8:11], s55 offen offset:0 sc1
  v_cvt_pk_bf16_f32 v52, v8, v12
  v_cvt_pk_bf16_f32 v53, v9, v13
  v_cvt_pk_bf16_f32 v54, v10, v14
  v_cvt_pk_bf16_f32 v55, v11, v15
  buffer_store_dwordx4 v[52:55], v216, s[8:11], s55 offen offset:256 sc1
  v_cvt_pk_bf16_f32 v56, v16, v17
  v_cvt_pk_bf16_f32 v57, v20, v21
  v_cvt_pk_bf16_f32 v58, v24, v25
  v_cvt_pk_bf16_f32 v59, v28, v29
  buffer_store_dwordx4 v[56:59], v217, s[8:11], s64 offen offset:0 sc1
  v_cvt_pk_bf16_f32 v60, v18, v19
  v_cvt_pk_bf16_f32 v61, v22, v23
  v_cvt_pk_bf16_f32 v62, v26, v27
  v_cvt_pk_bf16_f32 v63, v30, v31
  buffer_store_dwordx4 v[60:63], v217, s[8:11], s64 offen offset:256 sc1
  s_add_u32 s59, s59, 7
  s_cmp_ge_u32 s59, 64
  s_cbranch_scc1 KV_done
  s_sub_u32 s54, s59, 14
  s_cmp_lt_u32 s54, 7
  s_cbranch_scc1 KV_early
  s_waitcnt vmcnt(4)
  s_barrier
KV_cont:
  s_branch KV_loop
KV_early:
  s_waitcnt vmcnt(0)
  s_barrier
  s_cmp_eq_u32 s52, 0
  s_cbranch_scc0 KV_sig0
  v_mov_b32 v211, 1
  v_mov_b32 v212, 0
  s_mov_b64 exec, 1
  buffer_atomic_add v211, v212, s[12:15], s70 offen
  s_mov_b64 exec, -1
KV_sig0:
  s_branch KV_cont
KV_done:
  s_waitcnt vmcnt(0)
  s_barrier
  s_cmp_eq_u32 s52, 0
  s_cbranch_scc0 KV_sig
  v_mov_b32 v211, 256
  v_mov_b32 v212, 0
  s_mov_b64 exec, 1
  buffer_atomic_add v211, v212, s[12:15], s70 offen
  s_mov_b64 exec, -1
KV_sig:
  s_cmp_lt_u32 s53, 96
  s_cbranch_scc0 W_a
  s_mul_i32 s58, s53, 21846
  s_lshr_b32 s58, s58, 16
  s_mul_i32 s54, s58, 3
  s_sub_u32 s59, s53, s54
  s_mul_i32 s60, s59, 36864
  s_add_u32 m0, s67, 0
  s_nop 0
  buffer_load_dwordx4 v202, s[4:7], s60 offen offset:0 lds
  s_add_u32 m0, s67, 896
  s_nop 0
  buffer_load_dwordx4 v202, s[4:7], s60 offen offset:128 lds
  s_add_u32 m0, s67, 1792
  s_nop 0
  buffer_load_dwordx4 v202, s[4:7], s60 offen offset:256 lds
  s_add_u32 m0, s67, 2688
  s_nop 0
  buffer_load_dwordx4 v202, s[4:7], s60 offen offset:384 lds
  s_add_u32 m0, s67, 3584
  s_nop 0
  buffer_load_dwordx4 v202, s[4:7], s60 offen offset:512 lds
  s_add_u32 m0, s67, 4480
  s_nop 0
  buffer_load_dwordx4 v202, s[4:7], s60 offen offset:640 lds
  s_add_u32 m0, s67, 5376
  s_nop 0
  buffer_load_dwordx4 v202, s[4:7], s60 offen offset:768 lds
  s_add_u32 m0, s67, 6272
  s_nop 0
  buffer_load_dwordx4 v202, s[4:7], s60 offen offset:896 lds
  s_add_u32 m0, s67, 7168
  s_nop 0
  buffer_load_dwordx4 v202, s[4:7], s60 offen offset:1024 lds
  v_lshrrev_b32 v211, 4, v200
  v_lshlrev_b32 v212, 2, v211
  v_and_b32 v213, 15, v200
  v_xor_b32 v212, v212, v213
  v_lshlrev_b32 v212, 4, v212
  v_lshl_add_u32 v207, v211, 13, v212
  s_lshl_b32 s62, s58, 8
  s_lshl_b32 s54, s52, 15
  s_add_u32 s62, s62, s54
  s_lshl_b32 s61, s52, 10
  s_add_u32 s61, s61, 36864
  s_add_u32 m0, s61, 0
  s_add_u32 s54, s62, 0
  buffer_load_dwordx4 v207, s[16:19], s54 offen lds
  s_add_u32 m0, s61, 4096
  s_add_u32 s54, s62, 131072
  buffer_load_dwordx4 v207, s[16:19], s54 offen lds
  s_add_u32 m0, s61, 8192
  s_add_u32 s54, s62, 262144
  buffer_load_dwordx4 v207, s[16:19], s54 offen lds
  s_add_u32 m0, s61, 12288
  s_add_u32 s54, s62, 393216
  buffer_load_dwordx4 v207, s[16:19], s54 offen lds
  s_add_u32 m0, s61, 16384
  s_add_u32 s54, s62, 524288
  buffer_load_dwordx4 v207, s[16:19], s54 offen lds
  s_add_u32 m0, s61, 20480
  s_add_u32 s54, s62, 655360
  buffer_load_dwordx4 v207, s[16:19], s54 offen lds
  s_add_u32 m0, s61, 24576
  s_add_u32 s54, s62, 786432
  buffer_load_dwordx4 v207, s[16:19], s54 offen lds
  s_add_u32 m0, s61, 28672
  s_add_u32 s54, s62, 917504
  buffer_load_dwordx4 v207, s[16:19], s54 offen lds
  s_add_u32 m0, s61, 32768
  s_add_u32 s54, s62, 1048576
  buffer_load_dwordx4 v207, s[16:19], s54 offen lds
  s_add_u32 m0, s61, 36864
  s_add_u32 s54, s62, 1179648
  buffer_load_dwordx4 v207, s[16:19], s54 offen lds
  s_add_u32 m0, s61, 40960
  s_add_u32 s54, s62, 1310720
  buffer_load_dwordx4 v207, s[16:19], s54 offen lds
  s_add_u32 m0, s61, 45056
  s_add_u32 s54, s62, 1441792
  buffer_load_dwordx4 v207, s[16:19], s54 offen lds
  s_add_u32 m0, s61, 49152
  s_add_u32 s54, s62, 1572864
  buffer_load_dwordx4 v207, s[16:19], s54 offen lds
  s_add_u32 m0, s61, 53248
  s_add_u32 s54, s62, 1703936
  buffer_load_dwordx4 v207, s[16:19], s54 offen lds
  s_add_u32 m0, s61, 57344
  s_add_u32 s54, s62, 1835008
  buffer_load_dwordx4 v207, s[16:19], s54 offen lds
  s_add_u32 m0, s61, 61440
  s_add_u32 s54, s62, 1966080
  buffer_load_dwordx4 v207, s[16:19], s54 offen lds
  s_add_u32 m0, s61, 65536
  s_add_u32 s54, s62, 2097152
  buffer_load_dwordx4 v207, s[16:19], s54 offen lds
  s_add_u32 m0, s61, 69632
  s_add_u32 s54, s62, 2228224
  buffer_load_dwordx4 v207, s[16:19], s54 offen lds
  s_add_u32 m0, s61, 73728
  s_add_u32 s54, s62, 2359296
  buffer_load_dwordx4 v207, s[16:19], s54 offen lds
  s_add_u32 m0, s61, 77824
  s_add_u32 s54, s62, 2490368
  buffer_load_dwordx4 v207, s[16:19], s54 offen lds
  s_add_u32 m0, s61, 81920
  s_add_u32 s54, s62, 2621440
  buffer_load_dwordx4 v207, s[16:19], s54 offen lds
  s_add_u32 m0, s61, 86016
  s_add_u32 s54, s62, 2752512
  buffer_load_dwordx4 v207, s[16:19], s54 offen lds
  s_add_u32 m0, s61, 90112
  s_add_u32 s54, s62, 2883584
  buffer_load_dwordx4 v207, s[16:19], s54 offen lds
  s_add_u32 m0, s61, 94208
  s_add_u32 s54, s62, 3014656
  buffer_load_dwordx4 v207, s[16:19], s54 offen lds
  s_waitcnt vmcnt(20) lgkmcnt(0)
  s_barrier
  s_add_u32 m0, s61, 98304
  s_add_u32 s54, s62, 3145728
  buffer_load_dwordx4 v207, s[16:19], s54 offen lds
  s_add_u32 m0, s61, 102400
  s_add_u32 s54, s62, 3276800
  buffer_load_dwordx4 v207, s[16:19], s54 offen lds
  s_add_u32 m0, s61, 106496
  s_add_u32 s54, s62, 3407872
  buffer_load_dwordx4 v207, s[16:19], s54 offen lds
  s_add_u32 m0, s61, 110592
  s_add_u32 s54, s62, 3538944
  buffer_load_dwordx4 v207, s[16:19], s54 offen lds
  v_add_u32 v215, 36864, v209
  ds_read_b64_tr_b16 a[0:1], v215 offset:0
  ds_read_b64_tr_b16 a[2:3], v215 offset:1024
  ds_read_b64_tr_b16 a[4:5], v215 offset:4096
  ds_read_b64_tr_b16 a[6:7], v215 offset:5120
  ds_read_b64_tr_b16 a[8:9], v215 offset:8192
  ds_read_b64_tr_b16 a[10:11], v215 offset:9216
  ds_read_b64_tr_b16 a[12:13], v215 offset:12288
  ds_read_b64_tr_b16 a[14:15], v215 offset:13312
  s_waitcnt vmcnt(20) lgkmcnt(0)
  s_barrier
  s_add_u32 m0, s61, 0
  s_add_u32 s54, s62, 3670016
  buffer_load_dwordx4 v207, s[16:19], s54 offen lds
  s_add_u32 m0, s61, 4096
  s_add_u32 s54, s62, 3801088
  buffer_load_dwordx4 v207, s[16:19], s54 offen lds
  s_add_u32 m0, s61, 8192
  s_add_u32 s54, s62, 3932160
  buffer_load_dwordx4 v207, s[16:19], s54 offen lds
  s_add_u32 m0, s61, 12288
  s_add_u32 s54, s62, 4063232
  buffer_load_dwordx4 v207, s[16:19], s54 offen lds
  v_add_u32 v215, 53248, v209
  ds_read_b64_tr_b16 a[16:17], v215 offset:0
  ds_read_b64_tr_b16 a[18:19], v215 offset:1024
  ds_read_b64_tr_b16 a[20:21], v215 offset:4096
  ds_read_b64_tr_b16 a[22:23], v215 offset:5120
  ds_read_b64_tr_b16 a[24:25], v215 offset:8192
  ds_read_b64_tr_b16 a[26:27], v215 offset:9216
  ds_read_b64_tr_b16 a[28:29], v215 offset:12288
  ds_read_b64_tr_b16 a[30:31], v215 offset:13312
  s_waitcnt vmcnt(20) lgkmcnt(0)
  s_barrier
  s_add_u32 m0, s61, 16384
  s_add_u32 s54, s62, 4194304
  buffer_load_dwordx4 v207, s[16:19], s54 offen lds
  s_add_u32 m0, s61, 20480
  s_add_u32 s54, s62, 4325376
  buffer_load_dwordx4 v207, s[16:19], s54 offen lds
  s_add_u32 m0, s61, 24576
  s_add_u32 s54, s62, 4456448
  buffer_load_dwordx4 v207, s[16:19], s54 offen lds
  s_add_u32 m0, s61, 28672
  s_add_u32 s54, s62, 4587520
  buffer_load_dwordx4 v207, s[16:19], s54 offen lds
  v_add_u32 v215, 69632, v209
  ds_read_b64_tr_b16 a[32:33], v215 offset:0
  ds_read_b64_tr_b16 a[34:35], v215 offset:1024
  ds_read_b64_tr_b16 a[36:37], v215 offset:4096
  ds_read_b64_tr_b16 a[38:39], v215 offset:5120
  ds_read_b64_tr_b16 a[40:41], v215 offset:8192
  ds_read_b64_tr_b16 a[42:43], v215 offset:9216
  ds_read_b64_tr_b16 a[44:45], v215 offset:12288
  ds_read_b64_tr_b16 a[46:47], v215 offset:13312
  s_waitcnt vmcnt(20) lgkmcnt(0)
  s_barrier
  v_add_u32 v215, 86016, v209
  ds_read_b64_tr_b16 a[48:49], v215 offset:0
  ds_read_b64_tr_b16 a[50:51], v215 offset:1024
  ds_read_b64_tr_b16 a[52:53], v215 offset:4096
  ds_read_b64_tr_b16 a[54:55], v215 offset:5120
  ds_read_b64_tr_b16 a[56:57], v215 offset:8192
  ds_read_b64_tr_b16 a[58:59], v215 offset:9216
  ds_read_b64_tr_b16 a[60:61], v215 offset:12288
  ds_read_b64_tr_b16 a[62:63], v215 offset:13312
  s_waitcnt vmcnt(16) lgkmcnt(0)
  s_barrier
  v_add_u32 v215, 102400, v209
  ds_read_b64_tr_b16 a[64:65], v215 offset:0
  ds_read_b64_tr_b16 a[66:67], v215 offset:1024
  ds_read_b64_tr_b16 a[68:69], v215 offset:4096
  ds_read_b64_tr_b16 a[70:71], v215 offset:5120
  ds_read_b64_tr_b16 a[72:73], v215 offset:8192
  ds_read_b64_tr_b16 a[74:75], v215 offset:9216
  ds_read_b64_tr_b16 a[76:77], v215 offset:12288
  ds_read_b64_tr_b16 a[78:79], v215 offset:13312
  s_waitcnt vmcnt(12) lgkmcnt(0)
  s_barrier
  v_add_u32 v215, 118784, v209
  ds_read_b64_tr_b16 a[80:81], v215 offset:0
  ds_read_b64_tr_b16 a[82:83], v215 offset:1024
  ds_read_b64_tr_b16 a[84:85], v215 offset:4096
  ds_read_b64_tr_b16 a[86:87], v215 offset:5120
  ds_read_b64_tr_b16 a[88:89], v215 offset:8192
  ds_read_b64_tr_b16 a[90:91], v215 offset:9216
  ds_read_b64_tr_b16 a[92:93], v215 offset:12288
  ds_read_b64_tr_b16 a[94:95], v215 offset:13312
  s_waitcnt vmcnt(8) lgkmcnt(0)
  s_barrier
  v_add_u32 v215, 135168, v209
  ds_read_b64_tr_b16 a[96:97], v215 offset:0
  ds_read_b64_tr_b16 a[98:99], v215 offset:1024
  ds_read_b64_tr_b16 a[100:101], v215 offset:4096
  ds_read_b64_tr_b16 a[102:103], v215 offset:5120
  ds_read_b64_tr_b16 a[104:105], v215 offset:8192
  ds_read_b64_tr_b16 a[106:107], v215 offset:9216
  ds_read_b64_tr_b16 a[108:109], v215 offset:12288
  ds_read_b64_tr_b16 a[110:111], v215 offset:13312
  s_waitcnt vmcnt(4) lgkmcnt(0)
  s_barrier
  v_add_u32 v215, 36864, v209
  ds_read_b64_tr_b16 a[112:113], v215 offset:0
  ds_read_b64_tr_b16 a[114:115], v215 offset:1024
  ds_read_b64_tr_b16 a[116:117], v215 offset:4096
  ds_read_b64_tr_b16 a[118:119], v215 offset:5120
  ds_read_b64_tr_b16 a[120:121], v215 offset:8192
  ds_read_b64_tr_b16 a[122:123], v215 offset:9216
  ds_read_b64_tr_b16 a[124:125], v215 offset:12288
  ds_read_b64_tr_b16 a[126:127], v215 offset:13312
  s_waitcnt vmcnt(0) lgkmcnt(0)
  s_barrier
  v_add_u32 v215, 53248, v209
  ds_read_b64_tr_b16 a[128:129], v215 offset:0
  ds_read_b64_tr_b16 a[130:131], v215 offset:1024
  ds_read_b64_tr_b16 a[132:133], v215 offset:4096
  ds_read_b64_tr_b16 a[134:135], v215 offset:5120
  ds_read_b64_tr_b16 a[136:137], v215 offset:8192
  ds_read_b64_tr_b16 a[138:139], v215 offset:9216
  ds_read_b64_tr_b16 a[140:141], v215 offset:12288
  ds_read_b64_tr_b16 a[142:143], v215 offset:13312
  s_waitcnt lgkmcnt(0)
  s_barrier
  v_and_b32 v211, 31, v200
  v_lshrrev_b32 v212, 5, v200
  v_lshlrev_b32 v213, 2, v212
  v_sub_u32 v211, v211, v213
  v_mov_b32 v214, 0xf149f2ca
  v_cmp_gt_i32 vcc, 0, v211
  s_nop 1
  v_cndmask_b32 v48, 0, v214, vcc
  v_cmp_gt_i32 vcc, 1, v211
  s_nop 1
  v_cndmask_b32 v49, 0, v214, vcc
  v_cmp_gt_i32 vcc, 2, v211
  s_nop 1
  v_cndmask_b32 v50, 0, v214, vcc
  v_cmp_gt_i32 vcc, 3, v211
  s_nop 1
  v_cndmask_b32 v51, 0, v214, vcc
  v_cmp_gt_i32 vcc, 8, v211
  s_nop 1
  v_cndmask_b32 v52, 0, v214, vcc
  v_cmp_gt_i32 vcc, 9, v211
  s_nop 1
  v_cndmask_b32 v53, 0, v214, vcc
  v_cmp_gt_i32 vcc, 10, v211
  s_nop 1
  v_cndmask_b32 v54, 0, v214, vcc
  v_cmp_gt_i32 vcc, 11, v211
  s_nop 1
  v_cndmask_b32 v55, 0, v214, vcc
  v_cmp_gt_i32 vcc, 16, v211
  s_nop 1
  v_cndmask_b32 v56, 0, v214, vcc
  v_cmp_gt_i32 vcc, 17, v211
  s_nop 1
  v_cndmask_b32 v57, 0, v214, vcc
  v_cmp_gt_i32 vcc, 18, v211
  s_nop 1
  v_cndmask_b32 v58, 0, v214, vcc
  v_cmp_gt_i32 vcc, 19, v211
  s_nop 1
  v_cndmask_b32 v59, 0, v214, vcc
  v_cmp_gt_i32 vcc, 24, v211
  s_nop 1
  v_cndmask_b32 v60, 0, v214, vcc
  v_cmp_gt_i32 vcc, 25, v211
  s_nop 1
  v_cndmask_b32 v61, 0, v214, vcc
  v_cmp_gt_i32 vcc, 26, v211
  s_nop 1
  v_cndmask_b32 v62, 0, v214, vcc
  v_cmp_gt_i32 vcc, 27, v211
  s_nop 1
  v_cndmask_b32 v63, 0, v214, vcc
  v_and_b32 v218, 0xff, v216
  v_and_b32 v211, 15, v200
  v_lshl_add_u32 v211, v212, 5, v211
  v_lshlrev_b32 v219, 4, v211
  v_bfe_u32 v211, v200, 4, 1
  v_lshl_add_u32 v219, v211, 2, v219
  s_lshl_b32 s54, s52, 10
  s_add_u32 s54, s54, 8
  v_add_u32 v219, s54, v219
  s_lshl_b32 s54, s52, 11
  s_add_u32 s54, s54, 73728
  v_add_u32 v215, s54, v201
  v_add_u32 v208, 73728, v201
  s_mov_b32 s68, 1040356334
  s_lshl_b32 s69, s58, 7
  s_add_u32 s69, s69, 352256
  s_lshl_b32 s56, s58, 2
  s_add_u32 s56, s56, 128
  s_mov_b32 s57, 32
  s_cmp_eq_u32 s52, 0
  s_cbranch_scc0 AT_p1_d
  s_mov_b32 exec_hi, 0
  s_mov_b32 exec_lo, 1
AT_p1:
  buffer_load_dword v211, v201, s[12:15], s56 offen sc1
  s_add_u32 s65, s65, 1
  s_waitcnt vmcnt(0)
  v_cmp_gt_u32 vcc, 0x700, v211
  s_cbranch_vccz AT_p1_x
  s_sleep 8
  s_cmp_lt_u32 s65, 131072
  s_cbranch_scc1 AT_p1
AT_p1_x:
  s_mov_b64 exec, -1
AT_p1_d:
  s_barrier
  s_cmp_eq_u32 s52, 0
  s_cbranch_scc0 AT_arm_d
  s_mov_b32 exec_hi, 0
  s_mov_b32 exec_lo, 1
AT_arm:
  buffer_load_dword v211, v201, s[12:15], s57 offen sc1
  s_add_u32 s65, s65, 1
  s_waitcnt vmcnt(0)
  v_cmp_gt_u32 vcc, 32, v211
  s_cbranch_vccz AT_arm_x
  s_sleep 8
  s_cmp_lt_u32 s65, 131072
  s_cbranch_scc1 AT_arm
AT_arm_x:
  s_mov_b64 exec, -1
AT_arm_d:
  s_barrier
AT_loop:
  s_lshl_b32 s64, s59, 5
  s_add_u32 s64, s64, s58
  s_mul_i32 s66, s59, 655360
  s_lshl_b32 s55, s58, 14
  s_add_u32 s55, s55, s66
  s_add_u32 s55, s55, 1048576
  buffer_load_dwordx4 v[128:131], v216, s[8:11], s55 offen offset:0 sc1
  buffer_load_dwordx4 v[132:135], v216, s[8:11], s55 offen offset:256 sc1
  buffer_load_dwordx4 v[136:139], v216, s[8:11], s55 offen offset:512 sc1
  buffer_load_dwordx4 v[140:143], v216, s[8:11], s55 offen offset:768 sc1
  buffer_load_dwordx4 v[144:147], v216, s[8:11], s55 offen offset:1024 sc1
  buffer_load_dwordx4 v[148:151], v216, s[8:11], s55 offen offset:1280 sc1
  buffer_load_dwordx4 v[152:155], v216, s[8:11], s55 offen offset:1536 sc1
  buffer_load_dwordx4 v[156:159], v216, s[8:11], s55 offen offset:1792 sc1
  buffer_load_dwordx4 v[160:163], v217, s[8:11], s55 offen offset:0 sc1
  buffer_load_dwordx4 v[164:167], v217, s[8:11], s55 offen offset:256 sc1
  s_add_u32 s60, s60, 110592
  s_add_u32 m0, s67, 36864
  s_nop 0
  buffer_load_dwordx4 v202, s[4:7], s60 offen offset:0 lds
  s_add_u32 m0, s67, 37760
  s_nop 0
  buffer_load_dwordx4 v202, s[4:7], s60 offen offset:128 lds
  s_add_u32 m0, s67, 38656
  s_nop 0
  buffer_load_dwordx4 v202, s[4:7], s60 offen offset:256 lds
  s_add_u32 m0, s67, 39552
  s_nop 0
  buffer_load_dwordx4 v202, s[4:7], s60 offen offset:384 lds
  s_add_u32 m0, s67, 40448
  s_nop 0
  buffer_load_dwordx4 v202, s[4:7], s60 offen offset:512 lds
  s_add_u32 m0, s67, 41344
  s_nop 0
  buffer_load_dwordx4 v202, s[4:7], s60 offen offset:640 lds
  s_add_u32 m0, s67, 42240
  s_nop 0
  buffer_load_dwordx4 v202, s[4:7], s60 offen offset:768 lds
  s_add_u32 m0, s67, 43136
  s_nop 0
  buffer_load_dwordx4 v202, s[4:7], s60 offen offset:896 lds
  s_add_u32 m0, s67, 44032
  s_nop 0
  buffer_load_dwordx4 v202, s[4:7], s60 offen offset:1024 lds
  ds_read_b128 v[32:35], v203 offset:0
  ds_read_b128 v[36:39], v204 offset:0
  ds_read_b128 v[40:43], v205 offset:0
  s_waitcnt lgkmcnt(2)
  v_mfma_f32_32x32x16_bf16 v[0:15], a[0:3], v[32:35], 0
  ds_read_b128 v[44:47], v206 offset:0
  s_waitcnt lgkmcnt(2)
  v_mfma_f32_32x32x16_bf16 v[0:15], a[4:7], v[36:39], v[0:15]
  ds_read_b128 v[32:35], v203 offset:1024
  s_waitcnt lgkmcnt(2)
  v_mfma_f32_32x32x16_bf16 v[0:15], a[8:11], v[40:43], v[0:15]
  ds_read_b128 v[36:39], v204 offset:1024
  s_waitcnt lgkmcnt(2)
  v_mfma_f32_32x32x16_bf16 v[0:15], a[12:15], v[44:47], v[0:15]
  ds_read_b128 v[40:43], v205 offset:1024
  s_waitcnt lgkmcnt(2)
  v_mfma_f32_32x32x16_bf16 v[0:15], a[16:19], v[32:35], v[0:15]
  ds_read_b128 v[44:47], v206 offset:1024
  s_waitcnt lgkmcnt(2)
  v_mfma_f32_32x32x16_bf16 v[0:15], a[20:23], v[36:39], v[0:15]
  ds_read_b128 v[32:35], v203 offset:2048
  s_waitcnt lgkmcnt(2)
  v_mfma_f32_32x32x16_bf16 v[0:15], a[24:27], v[40:43], v[0:15]
  ds_read_b128 v[36:39], v204 offset:2048
  s_waitcnt lgkmcnt(2)
  v_mfma_f32_32x32x16_bf16 v[0:15], a[28:31], v[44:47], v[0:15]
  ds_read_b128 v[40:43], v205 offset:2048
  s_waitcnt lgkmcnt(2)
  v_mfma_f32_32x32x16_bf16 v[0:15], a[32:35], v[32:35], v[0:15]
  ds_read_b128 v[44:47], v206 offset:2048
  s_waitcnt lgkmcnt(2)
  v_mfma_f32_32x32x16_bf16 v[0:15], a[36:39], v[36:39], v[0:15]
  ds_read_b128 v[32:35], v203 offset:3072
  s_waitcnt lgkmcnt(2)
  v_mfma_f32_32x32x16_bf16 v[0:15], a[40:43], v[40:43], v[0:15]
  ds_read_b128 v[36:39], v204 offset:3072
  s_waitcnt lgkmcnt(2)
  v_mfma_f32_32x32x16_bf16 v[0:15], a[44:47], v[44:47], v[0:15]
  ds_read_b128 v[40:43], v205 offset:3072
  s_waitcnt lgkmcnt(2)
  v_mfma_f32_32x32x16_bf16 v[0:15], a[48:51], v[32:35], v[0:15]
  ds_read_b128 v[44:47], v206 offset:3072
  s_waitcnt lgkmcnt(2)
  v_mfma_f32_32x32x16_bf16 v[0:15], a[52:55], v[36:39], v[0:15]
  ds_read_b128 v[32:35], v203 offset:4096
  s_waitcnt lgkmcnt(2)
  v_mfma_f32_32x32x16_bf16 v[0:15], a[56:59], v[40:43], v[0:15]
  ds_read_b128 v[36:39], v204 offset:4096
  s_waitcnt lgkmcnt(2)
  v_mfma_f32_32x32x16_bf16 v[0:15], a[60:63], v[44:47], v[0:15]
  ds_read_b128 v[40:43], v205 offset:4096
  s_waitcnt lgkmcnt(2)
  v_mfma_f32_32x32x16_bf16 v[0:15], a[64:67], v[32:35], v[0:15]
  ds_read_b128 v[44:47], v206 offset:4096
  s_waitcnt lgkmcnt(2)
  v_mfma_f32_32x32x16_bf16 v[0:15], a[68:71], v[36:39], v[0:15]
  ds_read_b128 v[32:35], v203 offset:5120
  s_waitcnt lgkmcnt(2)
  v_mfma_f32_32x32x16_bf16 v[0:15], a[72:75], v[40:43], v[0:15]
  ds_read_b128 v[36:39], v204 offset:5120
  s_waitcnt lgkmcnt(2)
  v_mfma_f32_32x32x16_bf16 v[0:15], a[76:79], v[44:47], v[0:15]
  ds_read_b128 v[40:43], v205 offset:5120
  s_waitcnt lgkmcnt(2)
  v_mfma_f32_32x32x16_bf16 v[0:15], a[80:83], v[32:35], v[0:15]
  ds_read_b128 v[44:47], v206 offset:5120
  s_waitcnt lgkmcnt(2)
  v_mfma_f32_32x32x16_bf16 v[0:15], a[84:87], v[36:39], v[0:15]
  ds_read_b128 v[32:35], v203 offset:6144
  s_waitcnt lgkmcnt(2)
  v_mfma_f32_32x32x16_bf16 v[0:15], a[88:91], v[40:43], v[0:15]
  ds_read_b128 v[36:39], v204 offset:6144
  s_waitcnt lgkmcnt(2)
  v_mfma_f32_32x32x16_bf16 v[0:15], a[92:95], v[44:47], v[0:15]
  ds_read_b128 v[40:43], v205 offset:6144
  s_waitcnt lgkmcnt(2)
  v_mfma_f32_32x32x16_bf16 v[0:15], a[96:99], v[32:35], v[0:15]
  ds_read_b128 v[44:47], v206 offset:6144
  s_waitcnt lgkmcnt(2)
  v_mfma_f32_32x32x16_bf16 v[0:15], a[100:103], v[36:39], v[0:15]
  ds_read_b128 v[32:35], v203 offset:7168
  s_waitcnt lgkmcnt(2)
  v_mfma_f32_32x32x16_bf16 v[0:15], a[104:107], v[40:43], v[0:15]
  ds_read_b128 v[36:39], v204 offset:7168
  s_waitcnt lgkmcnt(2)
  v_mfma_f32_32x32x16_bf16 v[0:15], a[108:111], v[44:47], v[0:15]
  ds_read_b128 v[40:43], v205 offset:7168
  s_waitcnt lgkmcnt(2)
  v_mfma_f32_32x32x16_bf16 v[0:15], a[112:115], v[32:35], v[0:15]
  ds_read_b128 v[44:47], v206 offset:7168
  s_waitcnt lgkmcnt(2)
  v_mfma_f32_32x32x16_bf16 v[0:15], a[116:119], v[36:39], v[0:15]
  ds_read_b128 v[32:35], v203 offset:8192
  s_waitcnt lgkmcnt(2)
  v_mfma_f32_32x32x16_bf16 v[0:15], a[120:123], v[40:43], v[0:15]
  ds_read_b128 v[36:39], v204 offset:8192
  s_waitcnt lgkmcnt(2)
  v_mfma_f32_32x32x16_bf16 v[0:15], a[124:127], v[44:47], v[0:15]
  ds_read_b128 v[40:43], v205 offset:8192
  s_waitcnt lgkmcnt(2)
  v_mfma_f32_32x32x16_bf16 v[0:15], a[128:131], v[32:35], v[0:15]
  ds_read_b128 v[44:47], v206 offset:8192
  s_waitcnt lgkmcnt(2)
  v_mfma_f32_32x32x16_bf16 v[0:15], a[132:135], v[36:39], v[0:15]
  s_waitcnt lgkmcnt(1)
  v_mfma_f32_32x32x16_bf16 v[0:15], a[136:139], v[40:43], v[0:15]
  s_waitcnt lgkmcnt(0)
  v_mfma_f32_32x32x16_bf16 v[0:15], a[140:143], v[44:47], v[0:15]
  s_nop 11
  v_cvt_pk_bf16_f32 v16, v0, v4
  v_cvt_pk_bf16_f32 v17, v1, v5
  v_cvt_pk_bf16_f32 v18, v2, v6
  v_cvt_pk_bf16_f32 v19, v3, v7
  ds_write_b128 v215, v[16:19] offset:0
  v_cvt_pk_bf16_f32 v20, v8, v12
  v_cvt_pk_bf16_f32 v21, v9, v13
  v_cvt_pk_bf16_f32 v22, v10, v14
  v_cvt_pk_bf16_f32 v23, v11, v15
  ds_write_b128 v215, v[20:23] offset:1024
  s_waitcnt lgkmcnt(0)
  s_barrier
  ds_read_b128 v[96:99], v208 offset:0
  ds_read_b128 v[100:103], v208 offset:1024
  ds_read_b128 v[104:107], v208 offset:2048
  ds_read_b128 v[108:111], v208 offset:3072
  ds_read_b128 v[112:115], v208 offset:4096
  ds_read_b128 v[116:119], v208 offset:5120
  ds_read_b128 v[120:123], v208 offset:6144
  ds_read_b128 v[124:127], v208 offset:7168
  s_waitcnt vmcnt(18) lgkmcnt(7)
  v_mfma_f32_32x32x16_bf16 v[64:79], v[128:131], v[96:99], v[48:63]
  s_waitcnt vmcnt(17) lgkmcnt(6)
  v_mfma_f32_32x32x16_bf16 v[64:79], v[132:135], v[100:103], v[64:79]
  s_waitcnt vmcnt(16) lgkmcnt(5)
  v_mfma_f32_32x32x16_bf16 v[64:79], v[136:139], v[104:107], v[64:79]
  s_waitcnt vmcnt(15) lgkmcnt(4)
  v_mfma_f32_32x32x16_bf16 v[64:79], v[140:143], v[108:111], v[64:79]
  s_waitcnt vmcnt(14) lgkmcnt(3)
  v_mfma_f32_32x32x16_bf16 v[64:79], v[144:147], v[112:115], v[64:79]
  s_waitcnt vmcnt(13) lgkmcnt(2)
  v_mfma_f32_32x32x16_bf16 v[64:79], v[148:151], v[116:119], v[64:79]
  s_waitcnt vmcnt(12) lgkmcnt(1)
  v_mfma_f32_32x32x16_bf16 v[64:79], v[152:155], v[120:123], v[64:79]
  s_waitcnt vmcnt(11) lgkmcnt(0)
  v_mfma_f32_32x32x16_bf16 v[64:79], v[156:159], v[124:127], v[64:79]
  s_add_u32 s70, s59, 2
  s_lshl_b32 s55, s58, 12
  s_add_u32 s55, s55, s66
  s_add_u32 s55, s55, 1572864
  s_nop 7
  v_max3_f32 v16, v64, v65, v66
  v_max3_f32 v16, v16, v67, v68
  v_max3_f32 v16, v16, v69, v70
  v_max3_f32 v16, v16, v71, v72
  v_max3_f32 v16, v16, v73, v74
  v_max3_f32 v16, v16, v75, v76
  v_max3_f32 v16, v16, v77, v78
  v_max_f32 v16, v16, v79
  s_waitcnt vmcnt(0)
  s_cmp_eq_u32 s52, 0
  s_cbranch_scc0 AT_m0_d
  s_mov_b32 exec_hi, 0
  s_mov_b32 exec_lo, 1
AT_m0:
  buffer_load_dword v211, v201, s[8:11], s69 offen sc1
  s_add_u32 s65, s65, 1
  s_waitcnt vmcnt(0)
  v_cmp_gt_u32 vcc, s70, v211
  s_cbranch_vccz AT_m0_x
  s_sleep 1
  s_cmp_lt_u32 s65, 131072
  s_cbranch_scc1 AT_m0
AT_m0_x:
  s_mov_b64 exec, -1
AT_m0_d:
  s_barrier
  buffer_load_dwordx2 v[128:129], v218, s[8:11], s55 offen offset:0 sc1
  buffer_load_dwordx2 v[130:131], v218, s[8:11], s55 offen offset:1024 sc1
  buffer_load_dwordx2 v[132:133], v218, s[8:11], s55 offen offset:256 sc1
  buffer_load_dwordx2 v[134:135], v218, s[8:11], s55 offen offset:1280 sc1
  buffer_load_dwordx2 v[136:137], v218, s[8:11], s55 offen offset:512 sc1
  buffer_load_dwordx2 v[138:139], v218, s[8:11], s55 offen offset:1536 sc1
  buffer_load_dwordx2 v[140:141], v218, s[8:11], s55 offen offset:768 sc1
  buffer_load_dwordx2 v[142:143], v218, s[8:11], s55 offen offset:1792 sc1
  buffer_load_dwordx2 v[144:145], v218, s[8:11], s55 offen offset:2048 sc1
  buffer_load_dwordx2 v[146:147], v218, s[8:11], s55 offen offset:3072 sc1
  buffer_load_dwordx2 v[148:149], v218, s[8:11], s55 offen offset:2304 sc1
  buffer_load_dwordx2 v[150:151], v218, s[8:11], s55 offen offset:3328 sc1
  buffer_load_dwordx2 v[152:153], v218, s[8:11], s55 offen offset:2560 sc1
  buffer_load_dwordx2 v[154:155], v218, s[8:11], s55 offen offset:3584 sc1
  buffer_load_dwordx2 v[156:157], v218, s[8:11], s55 offen offset:2816 sc1
  buffer_load_dwordx2 v[158:159], v218, s[8:11], s55 offen offset:3840 sc1
  buffer_load_dword v168, v219, s[8:11], s55 offen offset:0 sc1
  buffer_load_dword v169, v219, s[8:11], s55 offen offset:256 sc1
  s_waitcnt vmcnt(16)
  v_mfma_f32_32x32x16_bf16 v[80:95], v[128:131], v[96:99], 0
  s_waitcnt vmcnt(14)
  v_mfma_f32_32x32x16_bf16 v[80:95], v[132:135], v[100:103], v[80:95]
  s_waitcnt vmcnt(12)
  v_mfma_f32_32x32x16_bf16 v[80:95], v[136:139], v[104:107], v[80:95]
  s_waitcnt vmcnt(10)
  v_mfma_f32_32x32x16_bf16 v[80:95], v[140:143], v[108:111], v[80:95]
  s_waitcnt vmcnt(8)
  v_mfma_f32_32x32x16_bf16 v[80:95], v[144:147], v[112:115], v[80:95]
  s_waitcnt vmcnt(6)
  v_mfma_f32_32x32x16_bf16 v[80:95], v[148:151], v[116:119], v[80:95]
  s_waitcnt vmcnt(4)
  v_mfma_f32_32x32x16_bf16 v[80:95], v[152:155], v[120:123], v[80:95]
  s_waitcnt vmcnt(2)
  v_mfma_f32_32x32x16_bf16 v[80:95], v[156:159], v[124:127], v[80:95]
  s_lshl_b32 s64, s64, 13
  s_lshl_b32 s54, s52, 11
  s_add_u32 s64, s64, s54
  s_add_u32 s64, s64, 46137344
  s_nop 7
  v_mul_f32 v80, s68, v80
  v_mul_f32 v81, s68, v81
  v_mul_f32 v82, s68, v82
  v_mul_f32 v83, s68, v83
  v_max3_f32 v16, v16, v80, v81
  v_max3_f32 v16, v16, v82, v83
  v_mov_b32 v17, v16
  s_nop 1
  v_permlane32_swap_b32 v16, v17
  v_max_f32 v16, v16, v17
  v_sub_f32 v64, v64, v16
  v_sub_f32 v65, v65, v16
  v_sub_f32 v66, v66, v16
  v_sub_f32 v67, v67, v16
  v_sub_f32 v68, v68, v16
  v_sub_f32 v69, v69, v16
  v_sub_f32 v70, v70, v16
  v_sub_f32 v71, v71, v16
  v_sub_f32 v72, v72, v16
  v_sub_f32 v73, v73, v16
  v_sub_f32 v74, v74, v16
  v_sub_f32 v75, v75, v16
  v_sub_f32 v76, v76, v16
  v_sub_f32 v77, v77, v16
  v_sub_f32 v78, v78, v16
  v_sub_f32 v79, v79, v16
  v_sub_f32 v80, v80, v16
  v_sub_f32 v81, v81, v16
  v_sub_f32 v82, v82, v16
  v_sub_f32 v83, v83, v16
  v_exp_f32 v64, v64
  v_exp_f32 v65, v65
  v_exp_f32 v66, v66
  v_exp_f32 v67, v67
  v_exp_f32 v68, v68
  v_exp_f32 v69, v69
  v_exp_f32 v70, v70
  v_exp_f32 v71, v71
  v_exp_f32 v72, v72
  v_exp_f32 v73, v73
  v_exp_f32 v74, v74
  v_exp_f32 v75, v75
  v_exp_f32 v76, v76
  v_exp_f32 v77, v77
  v_exp_f32 v78, v78
  v_exp_f32 v79, v79
  v_exp_f32 v80, v80
  v_exp_f32 v81, v81
  v_exp_f32 v82, v82
  v_exp_f32 v83, v83
  v_cvt_pk_bf16_f32 v20, v64, v65
  v_cvt_pk_bf16_f32 v21, v68, v69
  v_cvt_pk_bf16_f32 v22, v72, v73
  v_cvt_pk_bf16_f32 v23, v76, v77
  v_cvt_pk_bf16_f32 v24, v66, v67
  v_cvt_pk_bf16_f32 v25, v70, v71
  v_cvt_pk_bf16_f32 v26, v74, v75
  v_cvt_pk_bf16_f32 v27, v78, v79
  v_cvt_pk_bf16_f32 v28, v80, v81
  v_cvt_pk_bf16_f32 v29, v82, v83
  v_mfma_f32_32x32x16_bf16 v[0:15], v[160:163], v[20:23], 0
  v_add_f32 v16, v64, v65
  v_add_f32 v16, v16, v66
  v_add_f32 v16, v16, v67
  v_add_f32 v16, v16, v68
  v_add_f32 v16, v16, v69
  v_add_f32 v16, v16, v70
  v_add_f32 v16, v16, v71
  v_mfma_f32_32x32x16_bf16 v[0:15], v[164:167], v[24:27], v[0:15]
  v_add_f32 v16, v16, v72
  v_add_f32 v16, v16, v73
  v_add_f32 v16, v16, v74
  v_add_f32 v16, v16, v75
  v_add_f32 v16, v16, v76
  v_add_f32 v16, v16, v77
  s_waitcnt vmcnt(0)
  v_mfma_f32_32x32x8_bf16 v[0:15], v[168:169], v[28:29], v[0:15]
  v_add_f32 v16, v16, v78
  v_add_f32 v16, v16, v79
  v_add_f32 v16, v16, v80
  v_add_f32 v16, v16, v81
  v_add_f32 v16, v16, v82
  v_add_f32 v16, v16, v83
  v_mov_b32 v17, v16
  s_nop 1
  v_permlane32_swap_b32 v16, v17
  v_add_f32 v16, v16, v17
  v_rcp_f32 v16, v16
  s_nop 0
  v_mul_f32 v0, v16, v0
  v_mul_f32 v1, v16, v1
  v_mul_f32 v2, v16, v2
  v_mul_f32 v3, v16, v3
  v_mul_f32 v4, v16, v4
  v_mul_f32 v5, v16, v5
  v_mul_f32 v6, v16, v6
  v_mul_f32 v7, v16, v7
  v_cvt_pk_bf16_f32 v20, v0, v1
  v_cvt_pk_bf16_f32 v21, v2, v3
  v_cvt_pk_bf16_f32 v22, v4, v5
  v_cvt_pk_bf16_f32 v23, v6, v7
  buffer_store_dwordx4 v[20:23], v201, s[8:11], s64 offen offset:0 sc1
  v_mul_f32 v8, v16, v8
  v_mul_f32 v9, v16, v9
  v_mul_f32 v10, v16, v10
  v_mul_f32 v11, v16, v11
  v_mul_f32 v12, v16, v12
  v_mul_f32 v13, v16, v13
  v_mul_f32 v14, v16, v14
  v_mul_f32 v15, v16, v15
  v_cvt_pk_bf16_f32 v24, v8, v9
  v_cvt_pk_bf16_f32 v25, v10, v11
  v_cvt_pk_bf16_f32 v26, v12, v13
  v_cvt_pk_bf16_f32 v27, v14, v15
  buffer_store_dwordx4 v[24:27], v201, s[8:11], s64 offen offset:1024 sc1
  s_add_u32 s59, s59, 3
  v_mov_b32 v212, s59
  s_waitcnt vmcnt(0)
  s_barrier
  s_cmp_eq_u32 s52, 0
  s_cselect_b32 s54, s71, 268435456
  s_mov_b64 exec, 1
  buffer_store_dword v212, v201, s[8:11], s54 offen sc1
  s_mov_b64 exec, -1
  s_cmp_ge_u32 s59, 64
  s_cbranch_scc1 L_exit
  s_lshl_b32 s64, s59, 5
  s_add_u32 s64, s64, s58
  s_mul_i32 s66, s59, 655360
  s_lshl_b32 s55, s58, 14
  s_add_u32 s55, s55, s66
  s_add_u32 s55, s55, 1048576
  buffer_load_dwordx4 v[128:131], v216, s[8:11], s55 offen offset:0 sc1
  buffer_load_dwordx4 v[132:135], v216, s[8:11], s55 offen offset:256 sc1
  buffer_load_dwordx4 v[136:139], v216, s[8:11], s55 offen offset:512 sc1
  buffer_load_dwordx4 v[140:143], v216, s[8:11], s55 offen offset:768 sc1
  buffer_load_dwordx4 v[144:147], v216, s[8:11], s55 offen offset:1024 sc1
  buffer_load_dwordx4 v[148:151], v216, s[8:11], s55 offen offset:1280 sc1
  buffer_load_dwordx4 v[152:155], v216, s[8:11], s55 offen offset:1536 sc1
  buffer_load_dwordx4 v[156:159], v216, s[8:11], s55 offen offset:1792 sc1
  buffer_load_dwordx4 v[160:163], v217, s[8:11], s55 offen offset:0 sc1
  buffer_load_dwordx4 v[164:167], v217, s[8:11], s55 offen offset:256 sc1
  s_add_u32 s60, s60, 110592
  s_add_u32 m0, s67, 0
  s_nop 0
  buffer_load_dwordx4 v202, s[4:7], s60 offen offset:0 lds
  s_add_u32 m0, s67, 896
  s_nop 0
  buffer_load_dwordx4 v202, s[4:7], s60 offen offset:128 lds
  s_add_u32 m0, s67, 1792
  s_nop 0
  buffer_load_dwordx4 v202, s[4:7], s60 offen offset:256 lds
  s_add_u32 m0, s67, 2688
  s_nop 0
  buffer_load_dwordx4 v202, s[4:7], s60 offen offset:384 lds
  s_add_u32 m0, s67, 3584
  s_nop 0
  buffer_load_dwordx4 v202, s[4:7], s60 offen offset:512 lds
  s_add_u32 m0, s67, 4480
  s_nop 0
  buffer_load_dwordx4 v202, s[4:7], s60 offen offset:640 lds
  s_add_u32 m0, s67, 5376
  s_nop 0
  buffer_load_dwordx4 v202, s[4:7], s60 offen offset:768 lds
  s_add_u32 m0, s67, 6272
  s_nop 0
  buffer_load_dwordx4 v202, s[4:7], s60 offen offset:896 lds
  s_add_u32 m0, s67, 7168
  s_nop 0
  buffer_load_dwordx4 v202, s[4:7], s60 offen offset:1024 lds
  ds_read_b128 v[32:35], v203 offset:36864
  ds_read_b128 v[36:39], v204 offset:36864
  ds_read_b128 v[40:43], v205 offset:36864
  s_waitcnt lgkmcnt(2)
  v_mfma_f32_32x32x16_bf16 v[0:15], a[0:3], v[32:35], 0
  ds_read_b128 v[44:47], v206 offset:36864
  s_waitcnt lgkmcnt(2)
  v_mfma_f32_32x32x16_bf16 v[0:15], a[4:7], v[36:39], v[0:15]
  ds_read_b128 v[32:35], v203 offset:37888
  s_waitcnt lgkmcnt(2)
  v_mfma_f32_32x32x16_bf16 v[0:15], a[8:11], v[40:43], v[0:15]
  ds_read_b128 v[36:39], v204 offset:37888
  s_waitcnt lgkmcnt(2)
  v_mfma_f32_32x32x16_bf16 v[0:15], a[12:15], v[44:47], v[0:15]
  ds_read_b128 v[40:43], v205 offset:37888
  s_waitcnt lgkmcnt(2)
  v_mfma_f32_32x32x16_bf16 v[0:15], a[16:19], v[32:35], v[0:15]
  ds_read_b128 v[44:47], v206 offset:37888
  s_waitcnt lgkmcnt(2)
  v_mfma_f32_32x32x16_bf16 v[0:15], a[20:23], v[36:39], v[0:15]
  ds_read_b128 v[32:35], v203 offset:38912
  s_waitcnt lgkmcnt(2)
  v_mfma_f32_32x32x16_bf16 v[0:15], a[24:27], v[40:43], v[0:15]
  ds_read_b128 v[36:39], v204 offset:38912
  s_waitcnt lgkmcnt(2)
  v_mfma_f32_32x32x16_bf16 v[0:15], a[28:31], v[44:47], v[0:15]
  ds_read_b128 v[40:43], v205 offset:38912
  s_waitcnt lgkmcnt(2)
  v_mfma_f32_32x32x16_bf16 v[0:15], a[32:35], v[32:35], v[0:15]
  ds_read_b128 v[44:47], v206 offset:38912
  s_waitcnt lgkmcnt(2)
  v_mfma_f32_32x32x16_bf16 v[0:15], a[36:39], v[36:39], v[0:15]
  ds_read_b128 v[32:35], v203 offset:39936
  s_waitcnt lgkmcnt(2)
  v_mfma_f32_32x32x16_bf16 v[0:15], a[40:43], v[40:43], v[0:15]
  ds_read_b128 v[36:39], v204 offset:39936
  s_waitcnt lgkmcnt(2)
  v_mfma_f32_32x32x16_bf16 v[0:15], a[44:47], v[44:47], v[0:15]
  ds_read_b128 v[40:43], v205 offset:39936
  s_waitcnt lgkmcnt(2)
  v_mfma_f32_32x32x16_bf16 v[0:15], a[48:51], v[32:35], v[0:15]
  ds_read_b128 v[44:47], v206 offset:39936
  s_waitcnt lgkmcnt(2)
  v_mfma_f32_32x32x16_bf16 v[0:15], a[52:55], v[36:39], v[0:15]
  ds_read_b128 v[32:35], v203 offset:40960
  s_waitcnt lgkmcnt(2)
  v_mfma_f32_32x32x16_bf16 v[0:15], a[56:59], v[40:43], v[0:15]
  ds_read_b128 v[36:39], v204 offset:40960
  s_waitcnt lgkmcnt(2)
  v_mfma_f32_32x32x16_bf16 v[0:15], a[60:63], v[44:47], v[0:15]
  ds_read_b128 v[40:43], v205 offset:40960
  s_waitcnt lgkmcnt(2)
  v_mfma_f32_32x32x16_bf16 v[0:15], a[64:67], v[32:35], v[0:15]
  ds_read_b128 v[44:47], v206 offset:40960
  s_waitcnt lgkmcnt(2)
  v_mfma_f32_32x32x16_bf16 v[0:15], a[68:71], v[36:39], v[0:15]
  ds_read_b128 v[32:35], v203 offset:41984
  s_waitcnt lgkmcnt(2)
  v_mfma_f32_32x32x16_bf16 v[0:15], a[72:75], v[40:43], v[0:15]
  ds_read_b128 v[36:39], v204 offset:41984
  s_waitcnt lgkmcnt(2)
  v_mfma_f32_32x32x16_bf16 v[0:15], a[76:79], v[44:47], v[0:15]
  ds_read_b128 v[40:43], v205 offset:41984
  s_waitcnt lgkmcnt(2)
  v_mfma_f32_32x32x16_bf16 v[0:15], a[80:83], v[32:35], v[0:15]
  ds_read_b128 v[44:47], v206 offset:41984
  s_waitcnt lgkmcnt(2)
  v_mfma_f32_32x32x16_bf16 v[0:15], a[84:87], v[36:39], v[0:15]
  ds_read_b128 v[32:35], v203 offset:43008
  s_waitcnt lgkmcnt(2)
  v_mfma_f32_32x32x16_bf16 v[0:15], a[88:91], v[40:43], v[0:15]
  ds_read_b128 v[36:39], v204 offset:43008
  s_waitcnt lgkmcnt(2)
  v_mfma_f32_32x32x16_bf16 v[0:15], a[92:95], v[44:47], v[0:15]
  ds_read_b128 v[40:43], v205 offset:43008
  s_waitcnt lgkmcnt(2)
  v_mfma_f32_32x32x16_bf16 v[0:15], a[96:99], v[32:35], v[0:15]
  ds_read_b128 v[44:47], v206 offset:43008
  s_waitcnt lgkmcnt(2)
  v_mfma_f32_32x32x16_bf16 v[0:15], a[100:103], v[36:39], v[0:15]
  ds_read_b128 v[32:35], v203 offset:44032
  s_waitcnt lgkmcnt(2)
  v_mfma_f32_32x32x16_bf16 v[0:15], a[104:107], v[40:43], v[0:15]
  ds_read_b128 v[36:39], v204 offset:44032
  s_waitcnt lgkmcnt(2)
  v_mfma_f32_32x32x16_bf16 v[0:15], a[108:111], v[44:47], v[0:15]
  ds_read_b128 v[40:43], v205 offset:44032
  s_waitcnt lgkmcnt(2)
  v_mfma_f32_32x32x16_bf16 v[0:15], a[112:115], v[32:35], v[0:15]
  ds_read_b128 v[44:47], v206 offset:44032
  s_waitcnt lgkmcnt(2)
  v_mfma_f32_32x32x16_bf16 v[0:15], a[116:119], v[36:39], v[0:15]
  ds_read_b128 v[32:35], v203 offset:45056
  s_waitcnt lgkmcnt(2)
  v_mfma_f32_32x32x16_bf16 v[0:15], a[120:123], v[40:43], v[0:15]
  ds_read_b128 v[36:39], v204 offset:45056
  s_waitcnt lgkmcnt(2)
  v_mfma_f32_32x32x16_bf16 v[0:15], a[124:127], v[44:47], v[0:15]
  ds_read_b128 v[40:43], v205 offset:45056
  s_waitcnt lgkmcnt(2)
  v_mfma_f32_32x32x16_bf16 v[0:15], a[128:131], v[32:35], v[0:15]
  ds_read_b128 v[44:47], v206 offset:45056
  s_waitcnt lgkmcnt(2)
  v_mfma_f32_32x32x16_bf16 v[0:15], a[132:135], v[36:39], v[0:15]
  s_waitcnt lgkmcnt(1)
  v_mfma_f32_32x32x16_bf16 v[0:15], a[136:139], v[40:43], v[0:15]
  s_waitcnt lgkmcnt(0)
  v_mfma_f32_32x32x16_bf16 v[0:15], a[140:143], v[44:47], v[0:15]
  s_nop 11
  v_cvt_pk_bf16_f32 v16, v0, v4
  v_cvt_pk_bf16_f32 v17, v1, v5
  v_cvt_pk_bf16_f32 v18, v2, v6
  v_cvt_pk_bf16_f32 v19, v3, v7
  ds_write_b128 v215, v[16:19] offset:0
  v_cvt_pk_bf16_f32 v20, v8, v12
  v_cvt_pk_bf16_f32 v21, v9, v13
  v_cvt_pk_bf16_f32 v22, v10, v14
  v_cvt_pk_bf16_f32 v23, v11, v15
  ds_write_b128 v215, v[20:23] offset:1024
  s_waitcnt lgkmcnt(0)
  s_barrier
  ds_read_b128 v[96:99], v208 offset:0
  ds_read_b128 v[100:103], v208 offset:1024
  ds_read_b128 v[104:107], v208 offset:2048
  ds_read_b128 v[108:111], v208 offset:3072
  ds_read_b128 v[112:115], v208 offset:4096
  ds_read_b128 v[116:119], v208 offset:5120
  ds_read_b128 v[120:123], v208 offset:6144
  ds_read_b128 v[124:127], v208 offset:7168
  s_waitcnt vmcnt(18) lgkmcnt(7)
  v_mfma_f32_32x32x16_bf16 v[64:79], v[128:131], v[96:99], v[48:63]
  s_waitcnt vmcnt(17) lgkmcnt(6)
  v_mfma_f32_32x32x16_bf16 v[64:79], v[132:135], v[100:103], v[64:79]
  s_waitcnt vmcnt(16) lgkmcnt(5)
  v_mfma_f32_32x32x16_bf16 v[64:79], v[136:139], v[104:107], v[64:79]
  s_waitcnt vmcnt(15) lgkmcnt(4)
  v_mfma_f32_32x32x16_bf16 v[64:79], v[140:143], v[108:111], v[64:79]
  s_waitcnt vmcnt(14) lgkmcnt(3)
  v_mfma_f32_32x32x16_bf16 v[64:79], v[144:147], v[112:115], v[64:79]
  s_waitcnt vmcnt(13) lgkmcnt(2)
  v_mfma_f32_32x32x16_bf16 v[64:79], v[148:151], v[116:119], v[64:79]
  s_waitcnt vmcnt(12) lgkmcnt(1)
  v_mfma_f32_32x32x16_bf16 v[64:79], v[152:155], v[120:123], v[64:79]
  s_waitcnt vmcnt(11) lgkmcnt(0)
  v_mfma_f32_32x32x16_bf16 v[64:79], v[156:159], v[124:127], v[64:79]
  s_add_u32 s70, s59, 2
  s_lshl_b32 s55, s58, 12
  s_add_u32 s55, s55, s66
  s_add_u32 s55, s55, 1572864
  s_nop 7
  v_max3_f32 v16, v64, v65, v66
  v_max3_f32 v16, v16, v67, v68
  v_max3_f32 v16, v16, v69, v70
  v_max3_f32 v16, v16, v71, v72
  v_max3_f32 v16, v16, v73, v74
  v_max3_f32 v16, v16, v75, v76
  v_max3_f32 v16, v16, v77, v78
  v_max_f32 v16, v16, v79
  s_waitcnt vmcnt(0)
  s_cmp_eq_u32 s52, 0
  s_cbranch_scc0 AT_m1_d
  s_mov_b32 exec_hi, 0
  s_mov_b32 exec_lo, 1
AT_m1:
  buffer_load_dword v211, v201, s[8:11], s69 offen sc1
  s_add_u32 s65, s65, 1
  s_waitcnt vmcnt(0)
  v_cmp_gt_u32 vcc, s70, v211
  s_cbranch_vccz AT_m1_x
  s_sleep 1
  s_cmp_lt_u32 s65, 131072
  s_cbranch_scc1 AT_m1
AT_m1_x:
  s_mov_b64 exec, -1
AT_m1_d:
  s_barrier
  buffer_load_dwordx2 v[128:129], v218, s[8:11], s55 offen offset:0 sc1
  buffer_load_dwordx2 v[130:131], v218, s[8:11], s55 offen offset:1024 sc1
  buffer_load_dwordx2 v[132:133], v218, s[8:11], s55 offen offset:256 sc1
  buffer_load_dwordx2 v[134:135], v218, s[8:11], s55 offen offset:1280 sc1
  buffer_load_dwordx2 v[136:137], v218, s[8:11], s55 offen offset:512 sc1
  buffer_load_dwordx2 v[138:139], v218, s[8:11], s55 offen offset:1536 sc1
  buffer_load_dwordx2 v[140:141], v218, s[8:11], s55 offen offset:768 sc1
  buffer_load_dwordx2 v[142:143], v218, s[8:11], s55 offen offset:1792 sc1
  buffer_load_dwordx2 v[144:145], v218, s[8:11], s55 offen offset:2048 sc1
  buffer_load_dwordx2 v[146:147], v218, s[8:11], s55 offen offset:3072 sc1
  buffer_load_dwordx2 v[148:149], v218, s[8:11], s55 offen offset:2304 sc1
  buffer_load_dwordx2 v[150:151], v218, s[8:11], s55 offen offset:3328 sc1
  buffer_load_dwordx2 v[152:153], v218, s[8:11], s55 offen offset:2560 sc1
  buffer_load_dwordx2 v[154:155], v218, s[8:11], s55 offen offset:3584 sc1
  buffer_load_dwordx2 v[156:157], v218, s[8:11], s55 offen offset:2816 sc1
  buffer_load_dwordx2 v[158:159], v218, s[8:11], s55 offen offset:3840 sc1
  buffer_load_dword v168, v219, s[8:11], s55 offen offset:0 sc1
  buffer_load_dword v169, v219, s[8:11], s55 offen offset:256 sc1
  s_waitcnt vmcnt(16)
  v_mfma_f32_32x32x16_bf16 v[80:95], v[128:131], v[96:99], 0
  s_waitcnt vmcnt(14)
  v_mfma_f32_32x32x16_bf16 v[80:95], v[132:135], v[100:103], v[80:95]
  s_waitcnt vmcnt(12)
  v_mfma_f32_32x32x16_bf16 v[80:95], v[136:139], v[104:107], v[80:95]
  s_waitcnt vmcnt(10)
  v_mfma_f32_32x32x16_bf16 v[80:95], v[140:143], v[108:111], v[80:95]
  s_waitcnt vmcnt(8)
  v_mfma_f32_32x32x16_bf16 v[80:95], v[144:147], v[112:115], v[80:95]
  s_waitcnt vmcnt(6)
  v_mfma_f32_32x32x16_bf16 v[80:95], v[148:151], v[116:119], v[80:95]
  s_waitcnt vmcnt(4)
  v_mfma_f32_32x32x16_bf16 v[80:95], v[152:155], v[120:123], v[80:95]
  s_waitcnt vmcnt(2)
  v_mfma_f32_32x32x16_bf16 v[80:95], v[156:159], v[124:127], v[80:95]
  s_lshl_b32 s64, s64, 13
  s_lshl_b32 s54, s52, 11
  s_add_u32 s64, s64, s54
  s_add_u32 s64, s64, 46137344
  s_nop 7
  v_mul_f32 v80, s68, v80
  v_mul_f32 v81, s68, v81
  v_mul_f32 v82, s68, v82
  v_mul_f32 v83, s68, v83
  v_max3_f32 v16, v16, v80, v81
  v_max3_f32 v16, v16, v82, v83
  v_mov_b32 v17, v16
  s_nop 1
  v_permlane32_swap_b32 v16, v17
  v_max_f32 v16, v16, v17
  v_sub_f32 v64, v64, v16
  v_sub_f32 v65, v65, v16
  v_sub_f32 v66, v66, v16
  v_sub_f32 v67, v67, v16
  v_sub_f32 v68, v68, v16
  v_sub_f32 v69, v69, v16
  v_sub_f32 v70, v70, v16
  v_sub_f32 v71, v71, v16
  v_sub_f32 v72, v72, v16
  v_sub_f32 v73, v73, v16
  v_sub_f32 v74, v74, v16
  v_sub_f32 v75, v75, v16
  v_sub_f32 v76, v76, v16
  v_sub_f32 v77, v77, v16
  v_sub_f32 v78, v78, v16
  v_sub_f32 v79, v79, v16
  v_sub_f32 v80, v80, v16
  v_sub_f32 v81, v81, v16
  v_sub_f32 v82, v82, v16
  v_sub_f32 v83, v83, v16
  v_exp_f32 v64, v64
  v_exp_f32 v65, v65
  v_exp_f32 v66, v66
  v_exp_f32 v67, v67
  v_exp_f32 v68, v68
  v_exp_f32 v69, v69
  v_exp_f32 v70, v70
  v_exp_f32 v71, v71
  v_exp_f32 v72, v72
  v_exp_f32 v73, v73
  v_exp_f32 v74, v74
  v_exp_f32 v75, v75
  v_exp_f32 v76, v76
  v_exp_f32 v77, v77
  v_exp_f32 v78, v78
  v_exp_f32 v79, v79
  v_exp_f32 v80, v80
  v_exp_f32 v81, v81
  v_exp_f32 v82, v82
  v_exp_f32 v83, v83
  v_cvt_pk_bf16_f32 v20, v64, v65
  v_cvt_pk_bf16_f32 v21, v68, v69
  v_cvt_pk_bf16_f32 v22, v72, v73
  v_cvt_pk_bf16_f32 v23, v76, v77
  v_cvt_pk_bf16_f32 v24, v66, v67
  v_cvt_pk_bf16_f32 v25, v70, v71
  v_cvt_pk_bf16_f32 v26, v74, v75
  v_cvt_pk_bf16_f32 v27, v78, v79
  v_cvt_pk_bf16_f32 v28, v80, v81
  v_cvt_pk_bf16_f32 v29, v82, v83
  v_mfma_f32_32x32x16_bf16 v[0:15], v[160:163], v[20:23], 0
  v_add_f32 v16, v64, v65
  v_add_f32 v16, v16, v66
  v_add_f32 v16, v16, v67
  v_add_f32 v16, v16, v68
  v_add_f32 v16, v16, v69
  v_add_f32 v16, v16, v70
  v_add_f32 v16, v16, v71
  v_mfma_f32_32x32x16_bf16 v[0:15], v[164:167], v[24:27], v[0:15]
  v_add_f32 v16, v16, v72
  v_add_f32 v16, v16, v73
  v_add_f32 v16, v16, v74
  v_add_f32 v16, v16, v75
  v_add_f32 v16, v16, v76
  v_add_f32 v16, v16, v77
  s_waitcnt vmcnt(0)
  v_mfma_f32_32x32x8_bf16 v[0:15], v[168:169], v[28:29], v[0:15]
  v_add_f32 v16, v16, v78
  v_add_f32 v16, v16, v79
  v_add_f32 v16, v16, v80
  v_add_f32 v16, v16, v81
  v_add_f32 v16, v16, v82
  v_add_f32 v16, v16, v83
  v_mov_b32 v17, v16
  s_nop 1
  v_permlane32_swap_b32 v16, v17
  v_add_f32 v16, v16, v17
  v_rcp_f32 v16, v16
  s_nop 0
  v_mul_f32 v0, v16, v0
  v_mul_f32 v1, v16, v1
  v_mul_f32 v2, v16, v2
  v_mul_f32 v3, v16, v3
  v_mul_f32 v4, v16, v4
  v_mul_f32 v5, v16, v5
  v_mul_f32 v6, v16, v6
  v_mul_f32 v7, v16, v7
  v_cvt_pk_bf16_f32 v20, v0, v1
  v_cvt_pk_bf16_f32 v21, v2, v3
  v_cvt_pk_bf16_f32 v22, v4, v5
  v_cvt_pk_bf16_f32 v23, v6, v7
  buffer_store_dwordx4 v[20:23], v201, s[8:11], s64 offen offset:0 sc1
  v_mul_f32 v8, v16, v8
  v_mul_f32 v9, v16, v9
  v_mul_f32 v10, v16, v10
  v_mul_f32 v11, v16, v11
  v_mul_f32 v12, v16, v12
  v_mul_f32 v13, v16, v13
  v_mul_f32 v14, v16, v14
  v_mul_f32 v15, v16, v15
  v_cvt_pk_bf16_f32 v24, v8, v9
  v_cvt_pk_bf16_f32 v25, v10, v11
  v_cvt_pk_bf16_f32 v26, v12, v13
  v_cvt_pk_bf16_f32 v27, v14, v15
  buffer_store_dwordx4 v[24:27], v201, s[8:11], s64 offen offset:1024 sc1
  s_add_u32 s59, s59, 3
  v_mov_b32 v212, s59
  s_waitcnt vmcnt(0)
  s_barrier
  s_cmp_eq_u32 s52, 0
  s_cselect_b32 s54, s71, 268435456
  s_mov_b64 exec, 1
  buffer_store_dword v212, v201, s[8:11], s54 offen sc1
  s_mov_b64 exec, -1
  s_cmp_ge_u32 s59, 64
  s_cbranch_scc1 L_exit
  s_branch AT_loop
W_a:
  s_sub_u32 s54, s53, 96
  s_lshr_b32 s68, s54, 4
  s_and_b32 s69, s54, 15
  s_lshl_b32 s60, s69, 2
  s_sub_u32 s60, s60, 1
  s_max_i32 s60, s60, 0
  s_mul_i32 s60, s60, 36864
  s_add_u32 m0, s67, 0
  s_nop 0
  buffer_load_dwordx4 v202, s[4:7], s60 offen offset:0 lds
  s_add_u32 m0, s67, 896
  s_nop 0
  buffer_load_dwordx4 v202, s[4:7], s60 offen offset:128 lds
  s_add_u32 m0, s67, 1792
  s_nop 0
  buffer_load_dwordx4 v202, s[4:7], s60 offen offset:256 lds
  s_add_u32 m0, s67, 2688
  s_nop 0
  buffer_load_dwordx4 v202, s[4:7], s60 offen offset:384 lds
  s_add_u32 m0, s67, 3584
  s_nop 0
  buffer_load_dwordx4 v202, s[4:7], s60 offen offset:512 lds
  s_add_u32 m0, s67, 4480
  s_nop 0
  buffer_load_dwordx4 v202, s[4:7], s60 offen offset:640 lds
  s_add_u32 m0, s67, 5376
  s_nop 0
  buffer_load_dwordx4 v202, s[4:7], s60 offen offset:768 lds
  s_add_u32 m0, s67, 6272
  s_nop 0
  buffer_load_dwordx4 v202, s[4:7], s60 offen offset:896 lds
  s_add_u32 m0, s67, 7168
  s_nop 0
  buffer_load_dwordx4 v202, s[4:7], s60 offen offset:1024 lds
  v_and_b32 v211, 15, v200
  v_mul_u32_u24 v211, 72, v211
  v_lshrrev_b32 v212, 4, v200
  v_mul_u32_u24 v213, 1152, v212
  v_add_u32 v213, v213, v211
  s_lshl_b32 s54, s54, 2
  s_add_u32 s70, s54, s52
  s_mul_i32 s55, s70, 4608
  buffer_load_dwordx4 v[48:51], v213, s[4:7], s55 offen offset:0
  buffer_load_dwordx4 v[52:55], v213, s[4:7], s55 offen offset:16
  buffer_load_dwordx4 v[56:59], v213, s[4:7], s55 offen offset:32
  buffer_load_dwordx4 v[60:63], v213, s[4:7], s55 offen offset:48
  buffer_load_dwordx2 v[64:65], v213, s[4:7], s55 offen offset:64
  buffer_load_dwordx4 v[68:71], v211, s[44:47], 0 offen offset:0
  buffer_load_dwordx4 v[72:75], v211, s[44:47], 0 offen offset:16
  buffer_load_dwordx4 v[76:79], v211, s[44:47], 0 offen offset:32
  buffer_load_dwordx4 v[80:83], v211, s[44:47], 0 offen offset:48
  buffer_load_dwordx2 v[84:85], v211, s[44:47], 0 offen offset:64
  v_mov_b32 v0, 0
  v_mov_b32 v1, 0x3f803f80
  s_waitcnt vmcnt(9)
  v_lshlrev_b32 v2, 16, v48
  s_waitcnt vmcnt(4)
  v_lshlrev_b32 v3, 16, v68
  v_and_b32 v4, 0xffff0000, v48
  v_and_b32 v5, 0xffff0000, v68
  v_mul_f32 v2, v2, v3
  v_mul_f32 v4, v4, v5
  v_cvt_pk_bf16_f32 v2, v2, v4
  v_lshlrev_b32 v3, 16, v2
  v_and_b32 v4, 0xffff0000, v2
  v_add_f32 v0, v0, v3
  v_add_f32 v0, v0, v4
  v_lshlrev_b32 v2, 16, v49
  v_lshlrev_b32 v3, 16, v69
  v_and_b32 v4, 0xffff0000, v49
  v_and_b32 v5, 0xffff0000, v69
  v_mul_f32 v2, v2, v3
  v_mul_f32 v4, v4, v5
  v_cvt_pk_bf16_f32 v2, v2, v4
  v_lshlrev_b32 v3, 16, v2
  v_and_b32 v4, 0xffff0000, v2
  v_add_f32 v0, v0, v3
  v_add_f32 v0, v0, v4
  v_lshlrev_b32 v2, 16, v50
  v_lshlrev_b32 v3, 16, v70
  v_and_b32 v4, 0xffff0000, v50
  v_and_b32 v5, 0xffff0000, v70
  v_mul_f32 v2, v2, v3
  v_mul_f32 v4, v4, v5
  v_cvt_pk_bf16_f32 v2, v2, v4
  v_lshlrev_b32 v3, 16, v2
  v_and_b32 v4, 0xffff0000, v2
  v_add_f32 v0, v0, v3
  v_add_f32 v0, v0, v4
  v_lshlrev_b32 v2, 16, v51
  v_lshlrev_b32 v3, 16, v71
  v_and_b32 v4, 0xffff0000, v51
  v_and_b32 v5, 0xffff0000, v71
  v_mul_f32 v2, v2, v3
  v_mul_f32 v4, v4, v5
  v_cvt_pk_bf16_f32 v2, v2, v4
  v_lshlrev_b32 v3, 16, v2
  v_and_b32 v4, 0xffff0000, v2
  v_add_f32 v0, v0, v3
  v_add_f32 v0, v0, v4
  v_lshlrev_b32 v2, 16, v52
  s_waitcnt vmcnt(3)
  v_lshlrev_b32 v3, 16, v72
  v_and_b32 v4, 0xffff0000, v52
  v_and_b32 v5, 0xffff0000, v72
  v_mul_f32 v2, v2, v3
  v_mul_f32 v4, v4, v5
  v_cvt_pk_bf16_f32 v2, v2, v4
  v_lshlrev_b32 v3, 16, v2
  v_and_b32 v4, 0xffff0000, v2
  v_add_f32 v0, v0, v3
  v_add_f32 v0, v0, v4
  v_lshlrev_b32 v2, 16, v53
  v_lshlrev_b32 v3, 16, v73
  v_and_b32 v4, 0xffff0000, v53
  v_and_b32 v5, 0xffff0000, v73
  v_mul_f32 v2, v2, v3
  v_mul_f32 v4, v4, v5
  v_cvt_pk_bf16_f32 v2, v2, v4
  v_lshlrev_b32 v3, 16, v2
  v_and_b32 v4, 0xffff0000, v2
  v_add_f32 v0, v0, v3
  v_add_f32 v0, v0, v4
  v_lshlrev_b32 v2, 16, v54
  v_lshlrev_b32 v3, 16, v74
  v_and_b32 v4, 0xffff0000, v54
  v_and_b32 v5, 0xffff0000, v74
  v_mul_f32 v2, v2, v3
  v_mul_f32 v4, v4, v5
  v_cvt_pk_bf16_f32 v2, v2, v4
  v_lshlrev_b32 v3, 16, v2
  v_and_b32 v4, 0xffff0000, v2
  v_add_f32 v0, v0, v3
  v_add_f32 v0, v0, v4
  v_lshlrev_b32 v2, 16, v55
  v_lshlrev_b32 v3, 16, v75
  v_and_b32 v4, 0xffff0000, v55
  v_and_b32 v5, 0xffff0000, v75
  v_mul_f32 v2, v2, v3
  v_mul_f32 v4, v4, v5
  v_cvt_pk_bf16_f32 v2, v2, v4
  v_lshlrev_b32 v3, 16, v2
  v_and_b32 v4, 0xffff0000, v2
  v_add_f32 v0, v0, v3
  v_add_f32 v0, v0, v4
  v_lshlrev_b32 v2, 16, v56
  s_waitcnt vmcnt(2)
  v_lshlrev_b32 v3, 16, v76
  v_and_b32 v4, 0xffff0000, v56
  v_and_b32 v5, 0xffff0000, v76
  v_mul_f32 v2, v2, v3
  v_mul_f32 v4, v4, v5
  v_cvt_pk_bf16_f32 v2, v2, v4
  v_lshlrev_b32 v3, 16, v2
  v_and_b32 v4, 0xffff0000, v2
  v_add_f32 v0, v0, v3
  v_add_f32 v0, v0, v4
  v_lshlrev_b32 v2, 16, v57
  v_lshlrev_b32 v3, 16, v77
  v_and_b32 v4, 0xffff0000, v57
  v_and_b32 v5, 0xffff0000, v77
  v_mul_f32 v2, v2, v3
  v_mul_f32 v4, v4, v5
  v_cvt_pk_bf16_f32 v2, v2, v4
  v_lshlrev_b32 v3, 16, v2
  v_and_b32 v4, 0xffff0000, v2
  v_add_f32 v0, v0, v3
  v_add_f32 v0, v0, v4
  v_lshlrev_b32 v2, 16, v58
  v_lshlrev_b32 v3, 16, v78
  v_and_b32 v4, 0xffff0000, v58
  v_and_b32 v5, 0xffff0000, v78
  v_mul_f32 v2, v2, v3
  v_mul_f32 v4, v4, v5
  v_cvt_pk_bf16_f32 v2, v2, v4
  v_lshlrev_b32 v3, 16, v2
  v_and_b32 v4, 0xffff0000, v2
  v_add_f32 v0, v0, v3
  v_add_f32 v0, v0, v4
  v_lshlrev_b32 v2, 16, v59
  v_lshlrev_b32 v3, 16, v79
  v_and_b32 v4, 0xffff0000, v59
  v_and_b32 v5, 0xffff0000, v79
  v_mul_f32 v2, v2, v3
  v_mul_f32 v4, v4, v5
  v_cvt_pk_bf16_f32 v2, v2, v4
  v_lshlrev_b32 v3, 16, v2
  v_and_b32 v4, 0xffff0000, v2
  v_add_f32 v0, v0, v3
  v_add_f32 v0, v0, v4
  v_lshlrev_b32 v2, 16, v60
  s_waitcnt vmcnt(1)
  v_lshlrev_b32 v3, 16, v80
  v_and_b32 v4, 0xffff0000, v60
  v_and_b32 v5, 0xffff0000, v80
  v_mul_f32 v2, v2, v3
  v_mul_f32 v4, v4, v5
  v_cvt_pk_bf16_f32 v2, v2, v4
  v_lshlrev_b32 v3, 16, v2
  v_and_b32 v4, 0xffff0000, v2
  v_add_f32 v0, v0, v3
  v_add_f32 v0, v0, v4
  v_lshlrev_b32 v2, 16, v61
  v_lshlrev_b32 v3, 16, v81
  v_and_b32 v4, 0xffff0000, v61
  v_and_b32 v5, 0xffff0000, v81
  v_mul_f32 v2, v2, v3
  v_mul_f32 v4, v4, v5
  v_cvt_pk_bf16_f32 v2, v2, v4
  v_lshlrev_b32 v3, 16, v2
  v_and_b32 v4, 0xffff0000, v2
  v_add_f32 v0, v0, v3
  v_add_f32 v0, v0, v4
  v_lshlrev_b32 v2, 16, v62
  v_lshlrev_b32 v3, 16, v82
  v_and_b32 v4, 0xffff0000, v62
  v_and_b32 v5, 0xffff0000, v82
  v_mul_f32 v2, v2, v3
  v_mul_f32 v4, v4, v5
  v_cvt_pk_bf16_f32 v2, v2, v4
  v_lshlrev_b32 v3, 16, v2
  v_and_b32 v4, 0xffff0000, v2
  v_add_f32 v0, v0, v3
  v_add_f32 v0, v0, v4
  v_lshlrev_b32 v2, 16, v63
  v_lshlrev_b32 v3, 16, v83
  v_and_b32 v4, 0xffff0000, v63
  v_and_b32 v5, 0xffff0000, v83
  v_mul_f32 v2, v2, v3
  v_mul_f32 v4, v4, v5
  v_cvt_pk_bf16_f32 v2, v2, v4
  v_lshlrev_b32 v3, 16, v2
  v_and_b32 v4, 0xffff0000, v2
  v_add_f32 v0, v0, v3
  v_add_f32 v0, v0, v4
  v_lshlrev_b32 v2, 16, v64
  s_waitcnt vmcnt(0)
  v_lshlrev_b32 v3, 16, v84
  v_and_b32 v4, 0xffff0000, v64
  v_and_b32 v5, 0xffff0000, v84
  v_mul_f32 v2, v2, v3
  v_mul_f32 v4, v4, v5
  v_cvt_pk_bf16_f32 v2, v2, v4
  v_lshlrev_b32 v3, 16, v2
  v_and_b32 v4, 0xffff0000, v2
  v_add_f32 v0, v0, v3
  v_add_f32 v0, v0, v4
  v_lshlrev_b32 v2, 16, v65
  v_lshlrev_b32 v3, 16, v85
  v_and_b32 v4, 0xffff0000, v65
  v_and_b32 v5, 0xffff0000, v85
  v_mul_f32 v2, v2, v3
  v_mul_f32 v4, v4, v5
  v_cvt_pk_bf16_f32 v2, v2, v4
  v_lshlrev_b32 v3, 16, v2
  v_and_b32 v4, 0xffff0000, v2
  v_add_f32 v0, v0, v3
  v_add_f32 v0, v0, v4
  s_nop 1
  v_add_f32_dpp v0, v0, v0 row_ror:1 row_mask:0xf bank_mask:0xf
  s_nop 1
  v_add_f32_dpp v0, v0, v0 row_ror:2 row_mask:0xf bank_mask:0xf
  s_nop 1
  v_add_f32_dpp v0, v0, v0 row_ror:4 row_mask:0xf bank_mask:0xf
  s_nop 1
  v_add_f32_dpp v0, v0, v0 row_ror:8 row_mask:0xf bank_mask:0xf
  v_cvt_pk_bf16_f32 v0, v0, v0
  v_lshlrev_b32 v0, 16, v0
  v_mul_f32 v0, 3216550459, v0
  v_exp_f32 v0, v0
  s_nop 0
  v_add_f32 v0, 1.0, v0
  v_rcp_f32 v0, v0
  s_nop 0
  v_cvt_pk_bf16_f32 v0, v0, v0
  v_lshlrev_b32 v0, 16, v0
  v_lshlrev_b32 v212, 2, v212
  s_lshl_b32 s55, s70, 4
  s_add_u32 s55, s55, 66060288
  s_mov_b32 exec_lo, 0x00010001
  s_mov_b32 exec_hi, 0x00010001
  buffer_store_dword v0, v212, s[8:11], s55 offen sc1
  s_mov_b64 exec, -1
  v_lshrrev_b32 v211, 4, v200
  v_lshlrev_b32 v212, 2, v211
  v_and_b32 v213, 15, v200
  v_xor_b32 v212, v212, v213
  v_mul_u32_u24 v211, 3456, v211
  v_mov_b32 v2, 0x40000000
  v_add_u32 v213, 0, v212
  v_mul_u32_u24 v214, 57, v213
  v_lshrrev_b32 v214, 9, v214
  v_mul_u32_u24 v214, 1008, v214
  v_lshl_add_u32 v214, v213, 4, v214
  v_add_u32 v214, v214, v211
  v_cmp_lt_u32 vcc, 26, v213
  s_nop 1
  v_cndmask_b32 v207, v214, v2, vcc
  v_add_u32 v213, 16, v212
  v_mul_u32_u24 v214, 57, v213
  v_lshrrev_b32 v214, 9, v214
  v_mul_u32_u24 v214, 1008, v214
  v_lshl_add_u32 v214, v213, 4, v214
  v_add_u32 v214, v214, v211
  v_cmp_lt_u32 vcc, 26, v213
  s_nop 1
  v_cndmask_b32 v208, v214, v2, vcc
  s_mul_i32 s62, s68, 144
  s_mul_i32 s54, s52, 13824
  s_add_u32 s62, s62, s54
  s_waitcnt vmcnt(0)
  s_lshl_b32 s61, s52, 10
  s_add_u32 s61, s61, 36864
  s_add_u32 m0, s61, 0
  s_add_u32 s54, s62, 0
  buffer_load_dwordx4 v207, s[36:39], s54 offen lds
  s_add_u32 m0, s61, 4096
  s_add_u32 s54, s62, 55296
  buffer_load_dwordx4 v207, s[36:39], s54 offen lds
  s_add_u32 m0, s61, 8192
  s_add_u32 s54, s62, 110592
  buffer_load_dwordx4 v207, s[36:39], s54 offen lds
  s_add_u32 m0, s61, 12288
  s_add_u32 s54, s62, 165888
  buffer_load_dwordx4 v207, s[36:39], s54 offen lds
  s_add_u32 m0, s61, 16384
  s_add_u32 s54, s62, 0
  buffer_load_dwordx4 v208, s[36:39], s54 offen lds
  s_add_u32 m0, s61, 20480
  s_add_u32 s54, s62, 55296
  buffer_load_dwordx4 v208, s[36:39], s54 offen lds
  s_add_u32 m0, s61, 24576
  s_add_u32 s54, s62, 110592
  buffer_load_dwordx4 v208, s[36:39], s54 offen lds
  s_add_u32 m0, s61, 28672
  s_add_u32 s54, s62, 165888
  buffer_load_dwordx4 v208, s[36:39], s54 offen lds
  s_add_u32 m0, s61, 32768
  s_add_u32 s54, s62, 221184
  buffer_load_dwordx4 v207, s[36:39], s54 offen lds
  s_add_u32 m0, s61, 36864
  s_add_u32 s54, s62, 276480
  buffer_load_dwordx4 v207, s[36:39], s54 offen lds
  s_add_u32 m0, s61, 40960
  s_add_u32 s54, s62, 331776
  buffer_load_dwordx4 v207, s[36:39], s54 offen lds
  s_add_u32 m0, s61, 45056
  s_add_u32 s54, s62, 387072
  buffer_load_dwordx4 v207, s[36:39], s54 offen lds
  s_add_u32 m0, s61, 49152
  s_add_u32 s54, s62, 221184
  buffer_load_dwordx4 v208, s[36:39], s54 offen lds
  s_add_u32 m0, s61, 53248
  s_add_u32 s54, s62, 276480
  buffer_load_dwordx4 v208, s[36:39], s54 offen lds
  s_add_u32 m0, s61, 57344
  s_add_u32 s54, s62, 331776
  buffer_load_dwordx4 v208, s[36:39], s54 offen lds
  s_add_u32 m0, s61, 61440
  s_add_u32 s54, s62, 387072
  buffer_load_dwordx4 v208, s[36:39], s54 offen lds
  s_add_u32 m0, s61, 65536
  s_add_u32 s54, s62, 442368
  buffer_load_dwordx4 v207, s[36:39], s54 offen lds
  s_add_u32 m0, s61, 69632
  s_add_u32 s54, s62, 497664
  buffer_load_dwordx4 v207, s[36:39], s54 offen lds
  s_add_u32 m0, s61, 73728
  s_add_u32 s54, s62, 552960
  buffer_load_dwordx4 v207, s[36:39], s54 offen lds
  s_add_u32 m0, s61, 77824
  s_add_u32 s54, s62, 608256
  buffer_load_dwordx4 v207, s[36:39], s54 offen lds
  s_add_u32 m0, s61, 81920
  s_add_u32 s54, s62, 442368
  buffer_load_dwordx4 v208, s[36:39], s54 offen lds
  s_add_u32 m0, s61, 86016
  s_add_u32 s54, s62, 497664
  buffer_load_dwordx4 v208, s[36:39], s54 offen lds
  s_add_u32 m0, s61, 90112
  s_add_u32 s54, s62, 552960
  buffer_load_dwordx4 v208, s[36:39], s54 offen lds
  s_add_u32 m0, s61, 94208
  s_add_u32 s54, s62, 608256
  buffer_load_dwordx4 v208, s[36:39], s54 offen lds
  s_waitcnt vmcnt(20) lgkmcnt(0)
  s_barrier
  s_add_u32 m0, s61, 98304
  s_add_u32 s54, s62, 663552
  buffer_load_dwordx4 v207, s[36:39], s54 offen lds
  s_add_u32 m0, s61, 102400
  s_add_u32 s54, s62, 718848
  buffer_load_dwordx4 v207, s[36:39], s54 offen lds
  s_add_u32 m0, s61, 106496
  s_add_u32 s54, s62, 774144
  buffer_load_dwordx4 v207, s[36:39], s54 offen lds
  s_add_u32 m0, s61, 110592
  s_add_u32 s54, s62, 829440
  buffer_load_dwordx4 v207, s[36:39], s54 offen lds
  v_add_u32 v215, 36864, v210
  ds_read_b64_tr_b16 a[0:1], v215 offset:0
  ds_read_b64_tr_b16 a[2:3], v215 offset:1024
  ds_read_b64_tr_b16 a[4:5], v215 offset:4096
  ds_read_b64_tr_b16 a[6:7], v215 offset:5120
  ds_read_b64_tr_b16 a[8:9], v215 offset:8192
  ds_read_b64_tr_b16 a[10:11], v215 offset:9216
  ds_read_b64_tr_b16 a[12:13], v215 offset:12288
  ds_read_b64_tr_b16 a[14:15], v215 offset:13312
  s_waitcnt vmcnt(20) lgkmcnt(0)
  s_barrier
  s_add_u32 m0, s61, 0
  s_add_u32 s54, s62, 663552
  buffer_load_dwordx4 v208, s[36:39], s54 offen lds
  s_add_u32 m0, s61, 4096
  s_add_u32 s54, s62, 718848
  buffer_load_dwordx4 v208, s[36:39], s54 offen lds
  s_add_u32 m0, s61, 8192
  s_add_u32 s54, s62, 774144
  buffer_load_dwordx4 v208, s[36:39], s54 offen lds
  s_add_u32 m0, s61, 12288
  s_add_u32 s54, s62, 829440
  buffer_load_dwordx4 v208, s[36:39], s54 offen lds
  v_add_u32 v215, 53248, v210
  ds_read_b64_tr_b16 a[144:145], v215 offset:0
  ds_read_b64_tr_b16 a[146:147], v215 offset:1024
  ds_read_b64_tr_b16 a[148:149], v215 offset:4096
  ds_read_b64_tr_b16 a[150:151], v215 offset:5120
  ds_read_b64_tr_b16 a[152:153], v215 offset:8192
  ds_read_b64_tr_b16 a[154:155], v215 offset:9216
  ds_read_b64_tr_b16 a[156:157], v215 offset:12288
  ds_read_b64_tr_b16 a[158:159], v215 offset:13312
  s_waitcnt vmcnt(20) lgkmcnt(0)
  s_barrier
  s_add_u32 m0, s61, 16384
  s_add_u32 s54, s62, 884736
  buffer_load_dwordx4 v207, s[36:39], s54 offen lds
  s_add_u32 m0, s61, 20480
  s_add_u32 s54, s62, 940032
  buffer_load_dwordx4 v207, s[36:39], s54 offen lds
  s_add_u32 m0, s61, 24576
  s_add_u32 s54, s62, 995328
  buffer_load_dwordx4 v207, s[36:39], s54 offen lds
  s_add_u32 m0, s61, 28672
  s_add_u32 s54, s62, 1050624
  buffer_load_dwordx4 v207, s[36:39], s54 offen lds
  v_add_u32 v215, 69632, v210
  ds_read_b64_tr_b16 a[16:17], v215 offset:0
  ds_read_b64_tr_b16 a[18:19], v215 offset:1024
  ds_read_b64_tr_b16 a[20:21], v215 offset:4096
  ds_read_b64_tr_b16 a[22:23], v215 offset:5120
  ds_read_b64_tr_b16 a[24:25], v215 offset:8192
  ds_read_b64_tr_b16 a[26:27], v215 offset:9216
  ds_read_b64_tr_b16 a[28:29], v215 offset:12288
  ds_read_b64_tr_b16 a[30:31], v215 offset:13312
  s_waitcnt vmcnt(20) lgkmcnt(0)
  s_barrier
  s_add_u32 m0, s61, 32768
  s_add_u32 s54, s62, 884736
  buffer_load_dwordx4 v208, s[36:39], s54 offen lds
  s_add_u32 m0, s61, 36864
  s_add_u32 s54, s62, 940032
  buffer_load_dwordx4 v208, s[36:39], s54 offen lds
  s_add_u32 m0, s61, 40960
  s_add_u32 s54, s62, 995328
  buffer_load_dwordx4 v208, s[36:39], s54 offen lds
  s_add_u32 m0, s61, 45056
  s_add_u32 s54, s62, 1050624
  buffer_load_dwordx4 v208, s[36:39], s54 offen lds
  v_add_u32 v215, 86016, v210
  ds_read_b64_tr_b16 a[160:161], v215 offset:0
  ds_read_b64_tr_b16 a[162:163], v215 offset:1024
  ds_read_b64_tr_b16 a[164:165], v215 offset:4096
  ds_read_b64_tr_b16 a[166:167], v215 offset:5120
  ds_read_b64_tr_b16 a[168:169], v215 offset:8192
  ds_read_b64_tr_b16 a[170:171], v215 offset:9216
  ds_read_b64_tr_b16 a[172:173], v215 offset:12288
  ds_read_b64_tr_b16 a[174:175], v215 offset:13312
  s_waitcnt vmcnt(20) lgkmcnt(0)
  s_barrier
  s_add_u32 m0, s61, 49152
  s_add_u32 s54, s62, 1105920
  buffer_load_dwordx4 v207, s[36:39], s54 offen lds
  s_add_u32 m0, s61, 53248
  s_add_u32 s54, s62, 1161216
  buffer_load_dwordx4 v207, s[36:39], s54 offen lds
  s_add_u32 m0, s61, 57344
  s_add_u32 s54, s62, 1216512
  buffer_load_dwordx4 v207, s[36:39], s54 offen lds
  s_add_u32 m0, s61, 61440
  s_add_u32 s54, s62, 1271808
  buffer_load_dwordx4 v207, s[36:39], s54 offen lds
  v_add_u32 v215, 102400, v210
  ds_read_b64_tr_b16 a[32:33], v215 offset:0
  ds_read_b64_tr_b16 a[34:35], v215 offset:1024
  ds_read_b64_tr_b16 a[36:37], v215 offset:4096
  ds_read_b64_tr_b16 a[38:39], v215 offset:5120
  ds_read_b64_tr_b16 a[40:41], v215 offset:8192
  ds_read_b64_tr_b16 a[42:43], v215 offset:9216
  ds_read_b64_tr_b16 a[44:45], v215 offset:12288
  ds_read_b64_tr_b16 a[46:47], v215 offset:13312
  s_waitcnt vmcnt(20) lgkmcnt(0)
  s_barrier
  s_add_u32 m0, s61, 65536
  s_add_u32 s54, s62, 1105920
  buffer_load_dwordx4 v208, s[36:39], s54 offen lds
  s_add_u32 m0, s61, 69632
  s_add_u32 s54, s62, 1161216
  buffer_load_dwordx4 v208, s[36:39], s54 offen lds
  s_add_u32 m0, s61, 73728
  s_add_u32 s54, s62, 1216512
  buffer_load_dwordx4 v208, s[36:39], s54 offen lds
  s_add_u32 m0, s61, 77824
  s_add_u32 s54, s62, 1271808
  buffer_load_dwordx4 v208, s[36:39], s54 offen lds
  v_add_u32 v215, 118784, v210
  ds_read_b64_tr_b16 a[176:177], v215 offset:0
  ds_read_b64_tr_b16 a[178:179], v215 offset:1024
  ds_read_b64_tr_b16 a[180:181], v215 offset:4096
  ds_read_b64_tr_b16 a[182:183], v215 offset:5120
  ds_read_b64_tr_b16 a[184:185], v215 offset:8192
  ds_read_b64_tr_b16 a[186:187], v215 offset:9216
  ds_read_b64_tr_b16 a[188:189], v215 offset:12288
  ds_read_b64_tr_b16 a[190:191], v215 offset:13312
  s_waitcnt vmcnt(20) lgkmcnt(0)
  s_barrier
  s_add_u32 m0, s61, 81920
  s_add_u32 s54, s62, 1327104
  buffer_load_dwordx4 v207, s[36:39], s54 offen lds
  s_add_u32 m0, s61, 86016
  s_add_u32 s54, s62, 1382400
  buffer_load_dwordx4 v207, s[36:39], s54 offen lds
  s_add_u32 m0, s61, 90112
  s_add_u32 s54, s62, 1437696
  buffer_load_dwordx4 v207, s[36:39], s54 offen lds
  s_add_u32 m0, s61, 94208
  s_add_u32 s54, s62, 1492992
  buffer_load_dwordx4 v207, s[36:39], s54 offen lds
  v_add_u32 v215, 135168, v210
  ds_read_b64_tr_b16 a[48:49], v215 offset:0
  ds_read_b64_tr_b16 a[50:51], v215 offset:1024
  ds_read_b64_tr_b16 a[52:53], v215 offset:4096
  ds_read_b64_tr_b16 a[54:55], v215 offset:5120
  ds_read_b64_tr_b16 a[56:57], v215 offset:8192
  ds_read_b64_tr_b16 a[58:59], v215 offset:9216
  ds_read_b64_tr_b16 a[60:61], v215 offset:12288
  ds_read_b64_tr_b16 a[62:63], v215 offset:13312
  s_waitcnt vmcnt(20) lgkmcnt(0)
  s_barrier
  s_add_u32 m0, s61, 98304
  s_add_u32 s54, s62, 1327104
  buffer_load_dwordx4 v208, s[36:39], s54 offen lds
  s_add_u32 m0, s61, 102400
  s_add_u32 s54, s62, 1382400
  buffer_load_dwordx4 v208, s[36:39], s54 offen lds
  s_add_u32 m0, s61, 106496
  s_add_u32 s54, s62, 1437696
  buffer_load_dwordx4 v208, s[36:39], s54 offen lds
  s_add_u32 m0, s61, 110592
  s_add_u32 s54, s62, 1492992
  buffer_load_dwordx4 v208, s[36:39], s54 offen lds
  v_add_u32 v215, 36864, v210
  ds_read_b64_tr_b16 a[192:193], v215 offset:0
  ds_read_b64_tr_b16 a[194:195], v215 offset:1024
  ds_read_b64_tr_b16 a[196:197], v215 offset:4096
  ds_read_b64_tr_b16 a[198:199], v215 offset:5120
  ds_read_b64_tr_b16 a[200:201], v215 offset:8192
  ds_read_b64_tr_b16 a[202:203], v215 offset:9216
  ds_read_b64_tr_b16 a[204:205], v215 offset:12288
  ds_read_b64_tr_b16 a[206:207], v215 offset:13312
  s_waitcnt vmcnt(20) lgkmcnt(0)
  s_barrier
  s_add_u32 m0, s61, 0
  s_add_u32 s54, s62, 1548288
  buffer_load_dwordx4 v207, s[36:39], s54 offen lds
  s_add_u32 m0, s61, 4096
  s_add_u32 s54, s62, 1603584
  buffer_load_dwordx4 v207, s[36:39], s54 offen lds
  s_add_u32 m0, s61, 8192
  s_add_u32 s54, s62, 1658880
  buffer_load_dwordx4 v207, s[36:39], s54 offen lds
  s_add_u32 m0, s61, 12288
  s_add_u32 s54, s62, 1714176
  buffer_load_dwordx4 v207, s[36:39], s54 offen lds
  v_add_u32 v215, 53248, v210
  ds_read_b64_tr_b16 a[64:65], v215 offset:0
  ds_read_b64_tr_b16 a[66:67], v215 offset:1024
  ds_read_b64_tr_b16 a[68:69], v215 offset:4096
  ds_read_b64_tr_b16 a[70:71], v215 offset:5120
  ds_read_b64_tr_b16 a[72:73], v215 offset:8192
  ds_read_b64_tr_b16 a[74:75], v215 offset:9216
  ds_read_b64_tr_b16 a[76:77], v215 offset:12288
  ds_read_b64_tr_b16 a[78:79], v215 offset:13312
  s_waitcnt vmcnt(20) lgkmcnt(0)
  s_barrier
  s_add_u32 m0, s61, 16384
  s_add_u32 s54, s62, 1548288
  buffer_load_dwordx4 v208, s[36:39], s54 offen lds
  s_add_u32 m0, s61, 20480
  s_add_u32 s54, s62, 1603584
  buffer_load_dwordx4 v208, s[36:39], s54 offen lds
  s_add_u32 m0, s61, 24576
  s_add_u32 s54, s62, 1658880
  buffer_load_dwordx4 v208, s[36:39], s54 offen lds
  s_add_u32 m0, s61, 28672
  s_add_u32 s54, s62, 1714176
  buffer_load_dwordx4 v208, s[36:39], s54 offen lds
  v_add_u32 v215, 69632, v210
  ds_read_b64_tr_b16 a[208:209], v215 offset:0
  ds_read_b64_tr_b16 a[210:211], v215 offset:1024
  ds_read_b64_tr_b16 a[212:213], v215 offset:4096
  ds_read_b64_tr_b16 a[214:215], v215 offset:5120
  ds_read_b64_tr_b16 a[216:217], v215 offset:8192
  ds_read_b64_tr_b16 a[218:219], v215 offset:9216
  ds_read_b64_tr_b16 a[220:221], v215 offset:12288
  ds_read_b64_tr_b16 a[222:223], v215 offset:13312
  s_waitcnt vmcnt(20) lgkmcnt(0)
  s_barrier
  s_add_u32 m0, s61, 32768
  s_add_u32 s54, s62, 1769472
  buffer_load_dwordx4 v207, s[36:39], s54 offen lds
  s_add_u32 m0, s61, 36864
  s_add_u32 s54, s62, 1824768
  buffer_load_dwordx4 v207, s[36:39], s54 offen lds
  s_add_u32 m0, s61, 40960
  s_add_u32 s54, s62, 1880064
  buffer_load_dwordx4 v207, s[36:39], s54 offen lds
  s_add_u32 m0, s61, 45056
  s_add_u32 s54, s62, 1935360
  buffer_load_dwordx4 v207, s[36:39], s54 offen lds
  v_add_u32 v215, 86016, v210
  ds_read_b64_tr_b16 a[80:81], v215 offset:0
  ds_read_b64_tr_b16 a[82:83], v215 offset:1024
  ds_read_b64_tr_b16 a[84:85], v215 offset:4096
  ds_read_b64_tr_b16 a[86:87], v215 offset:5120
  ds_read_b64_tr_b16 a[88:89], v215 offset:8192
  ds_read_b64_tr_b16 a[90:91], v215 offset:9216
  ds_read_b64_tr_b16 a[92:93], v215 offset:12288
  ds_read_b64_tr_b16 a[94:95], v215 offset:13312
  s_waitcnt vmcnt(20) lgkmcnt(0)
  s_barrier
  s_add_u32 m0, s61, 49152
  s_add_u32 s54, s62, 1769472
  buffer_load_dwordx4 v208, s[36:39], s54 offen lds
  s_add_u32 m0, s61, 53248
  s_add_u32 s54, s62, 1824768
  buffer_load_dwordx4 v208, s[36:39], s54 offen lds
  s_add_u32 m0, s61, 57344
  s_add_u32 s54, s62, 1880064
  buffer_load_dwordx4 v208, s[36:39], s54 offen lds
  s_add_u32 m0, s61, 61440
  s_add_u32 s54, s62, 1935360
  buffer_load_dwordx4 v208, s[36:39], s54 offen lds
  v_add_u32 v215, 102400, v210
  ds_read_b64_tr_b16 a[224:225], v215 offset:0
  ds_read_b64_tr_b16 a[226:227], v215 offset:1024
  ds_read_b64_tr_b16 a[228:229], v215 offset:4096
  ds_read_b64_tr_b16 a[230:231], v215 offset:5120
  ds_read_b64_tr_b16 a[232:233], v215 offset:8192
  ds_read_b64_tr_b16 a[234:235], v215 offset:9216
  ds_read_b64_tr_b16 a[236:237], v215 offset:12288
  ds_read_b64_tr_b16 a[238:239], v215 offset:13312
  s_waitcnt vmcnt(20) lgkmcnt(0)
  s_barrier
  v_add_u32 v215, 118784, v210
  ds_read_b64_tr_b16 a[96:97], v215 offset:0
  ds_read_b64_tr_b16 a[98:99], v215 offset:1024
  ds_read_b64_tr_b16 a[100:101], v215 offset:4096
  ds_read_b64_tr_b16 a[102:103], v215 offset:5120
  ds_read_b64_tr_b16 a[104:105], v215 offset:8192
  ds_read_b64_tr_b16 a[106:107], v215 offset:9216
  ds_read_b64_tr_b16 a[108:109], v215 offset:12288
  ds_read_b64_tr_b16 a[110:111], v215 offset:13312
  s_waitcnt vmcnt(16) lgkmcnt(0)
  s_barrier
  v_add_u32 v215, 135168, v210
  ds_read_b64_tr_b16 a[240:241], v215 offset:0
  ds_read_b64_tr_b16 a[242:243], v215 offset:1024
  ds_read_b64_tr_b16 a[244:245], v215 offset:4096
  ds_read_b64_tr_b16 a[246:247], v215 offset:5120
  ds_read_b64_tr_b16 a[248:249], v215 offset:8192
  ds_read_b64_tr_b16 a[250:251], v215 offset:9216
  ds_read_b64_tr_b16 a[252:253], v215 offset:12288
  ds_read_b64_tr_b16 a[254:255], v215 offset:13312
  s_waitcnt vmcnt(12) lgkmcnt(0)
  s_barrier
  v_add_u32 v215, 36864, v210
  ds_read_b64_tr_b16 a[112:113], v215 offset:0
  ds_read_b64_tr_b16 a[114:115], v215 offset:1024
  ds_read_b64_tr_b16 a[116:117], v215 offset:4096
  ds_read_b64_tr_b16 a[118:119], v215 offset:5120
  ds_read_b64_tr_b16 a[120:121], v215 offset:8192
  ds_read_b64_tr_b16 a[122:123], v215 offset:9216
  ds_read_b64_tr_b16 a[124:125], v215 offset:12288
  ds_read_b64_tr_b16 a[126:127], v215 offset:13312
  s_waitcnt vmcnt(8) lgkmcnt(0)
  s_barrier
  v_add_u32 v215, 53248, v210
  ds_read_b64_tr_b16 v[224:225], v215 offset:0
  ds_read_b64_tr_b16 v[226:227], v215 offset:1024
  ds_read_b64_tr_b16 v[228:229], v215 offset:4096
  ds_read_b64_tr_b16 v[230:231], v215 offset:5120
  ds_read_b64_tr_b16 v[232:233], v215 offset:8192
  ds_read_b64_tr_b16 v[234:235], v215 offset:9216
  ds_read_b64_tr_b16 v[236:237], v215 offset:12288
  ds_read_b64_tr_b16 v[238:239], v215 offset:13312
  s_waitcnt vmcnt(4) lgkmcnt(0)
  s_barrier
  v_add_u32 v215, 69632, v210
  ds_read_b64_tr_b16 a[128:129], v215 offset:0
  ds_read_b64_tr_b16 a[130:131], v215 offset:1024
  ds_read_b64_tr_b16 a[132:133], v215 offset:4096
  ds_read_b64_tr_b16 a[134:135], v215 offset:5120
  ds_read_b64_tr_b16 a[136:137], v215 offset:8192
  ds_read_b64_tr_b16 a[138:139], v215 offset:9216
  ds_read_b64_tr_b16 a[140:141], v215 offset:12288
  ds_read_b64_tr_b16 a[142:143], v215 offset:13312
  s_waitcnt vmcnt(0) lgkmcnt(0)
  s_barrier
  v_add_u32 v215, 86016, v210
  ds_read_b64_tr_b16 v[240:241], v215 offset:0
  ds_read_b64_tr_b16 v[242:243], v215 offset:1024
  ds_read_b64_tr_b16 v[244:245], v215 offset:4096
  ds_read_b64_tr_b16 v[246:247], v215 offset:5120
  ds_read_b64_tr_b16 v[248:249], v215 offset:8192
  ds_read_b64_tr_b16 v[250:251], v215 offset:9216
  ds_read_b64_tr_b16 v[252:253], v215 offset:12288
  ds_read_b64_tr_b16 v[254:255], v215 offset:13312
  s_waitcnt lgkmcnt(0)
  s_barrier
  v_and_b32 v211, 31, v200
  v_mul_u32_u24 v218, 516, v211
  v_lshrrev_b32 v212, 5, v200
  v_lshl_add_u32 v218, v212, 3, v218
  s_lshl_b32 s54, s52, 6
  s_add_u32 s54, s54, 73728
  v_add_u32 v218, s54, v218
  s_lshl_b32 s60, s69, 2
  s_mul_i32 s60, s60, 36864
  s_add_u32 m0, s67, 36864
  s_nop 0
  buffer_load_dwordx4 v202, s[4:7], s60 offen offset:0 lds
  s_add_u32 m0, s67, 37760
  s_nop 0
  buffer_load_dwordx4 v202, s[4:7], s60 offen offset:128 lds
  s_add_u32 m0, s67, 38656
  s_nop 0
  buffer_load_dwordx4 v202, s[4:7], s60 offen offset:256 lds
  s_add_u32 m0, s67, 39552
  s_nop 0
  buffer_load_dwordx4 v202, s[4:7], s60 offen offset:384 lds
  s_add_u32 m0, s67, 40448
  s_nop 0
  buffer_load_dwordx4 v202, s[4:7], s60 offen offset:512 lds
  s_add_u32 m0, s67, 41344
  s_nop 0
  buffer_load_dwordx4 v202, s[4:7], s60 offen offset:640 lds
  s_add_u32 m0, s67, 42240
  s_nop 0
  buffer_load_dwordx4 v202, s[4:7], s60 offen offset:768 lds
  s_add_u32 m0, s67, 43136
  s_nop 0
  buffer_load_dwordx4 v202, s[4:7], s60 offen offset:896 lds
  s_add_u32 m0, s67, 44032
  s_nop 0
  buffer_load_dwordx4 v202, s[4:7], s60 offen offset:1024 lds
  s_add_u32 s60, s60, 36864
  ds_read_b128 v[32:35], v203 offset:0
  ds_read_b128 v[36:39], v204 offset:0
  ds_read_b128 v[40:43], v205 offset:0
  s_waitcnt lgkmcnt(2)
  v_mfma_f32_32x32x16_bf16 v[0:15], a[0:3], v[32:35], 0
  ds_read_b128 v[44:47], v206 offset:0
  v_mfma_f32_32x32x16_bf16 v[16:31], a[144:147], v[32:35], 0
  s_waitcnt lgkmcnt(2)
  v_mfma_f32_32x32x16_bf16 v[0:15], a[4:7], v[36:39], v[0:15]
  ds_read_b128 v[32:35], v203 offset:1024
  v_mfma_f32_32x32x16_bf16 v[16:31], a[148:151], v[36:39], v[16:31]
  s_waitcnt lgkmcnt(2)
  v_mfma_f32_32x32x16_bf16 v[0:15], a[8:11], v[40:43], v[0:15]
  ds_read_b128 v[36:39], v204 offset:1024
  v_mfma_f32_32x32x16_bf16 v[16:31], a[152:155], v[40:43], v[16:31]
  s_waitcnt lgkmcnt(2)
  v_mfma_f32_32x32x16_bf16 v[0:15], a[12:15], v[44:47], v[0:15]
  ds_read_b128 v[40:43], v205 offset:1024
  v_mfma_f32_32x32x16_bf16 v[16:31], a[156:159], v[44:47], v[16:31]
  s_waitcnt lgkmcnt(2)
  v_mfma_f32_32x32x16_bf16 v[0:15], a[16:19], v[32:35], v[0:15]
  ds_read_b128 v[44:47], v206 offset:1024
  v_mfma_f32_32x32x16_bf16 v[16:31], a[160:163], v[32:35], v[16:31]
  s_waitcnt lgkmcnt(2)
  v_mfma_f32_32x32x16_bf16 v[0:15], a[20:23], v[36:39], v[0:15]
  ds_read_b128 v[32:35], v203 offset:2048
  v_mfma_f32_32x32x16_bf16 v[16:31], a[164:167], v[36:39], v[16:31]
  s_waitcnt lgkmcnt(2)
  v_mfma_f32_32x32x16_bf16 v[0:15], a[24:27], v[40:43], v[0:15]
  ds_read_b128 v[36:39], v204 offset:2048
  v_mfma_f32_32x32x16_bf16 v[16:31], a[168:171], v[40:43], v[16:31]
  s_waitcnt lgkmcnt(2)
  v_mfma_f32_32x32x16_bf16 v[0:15], a[28:31], v[44:47], v[0:15]
  ds_read_b128 v[40:43], v205 offset:2048
  v_mfma_f32_32x32x16_bf16 v[16:31], a[172:175], v[44:47], v[16:31]
  s_waitcnt lgkmcnt(2)
  v_mfma_f32_32x32x16_bf16 v[0:15], a[32:35], v[32:35], v[0:15]
  ds_read_b128 v[44:47], v206 offset:2048
  v_mfma_f32_32x32x16_bf16 v[16:31], a[176:179], v[32:35], v[16:31]
  s_waitcnt lgkmcnt(2)
  v_mfma_f32_32x32x16_bf16 v[0:15], a[36:39], v[36:39], v[0:15]
  ds_read_b128 v[32:35], v203 offset:3072
  v_mfma_f32_32x32x16_bf16 v[16:31], a[180:183], v[36:39], v[16:31]
  s_waitcnt lgkmcnt(2)
  v_mfma_f32_32x32x16_bf16 v[0:15], a[40:43], v[40:43], v[0:15]
  ds_read_b128 v[36:39], v204 offset:3072
  v_mfma_f32_32x32x16_bf16 v[16:31], a[184:187], v[40:43], v[16:31]
  s_waitcnt lgkmcnt(2)
  v_mfma_f32_32x32x16_bf16 v[0:15], a[44:47], v[44:47], v[0:15]
  ds_read_b128 v[40:43], v205 offset:3072
  v_mfma_f32_32x32x16_bf16 v[16:31], a[188:191], v[44:47], v[16:31]
  s_waitcnt lgkmcnt(2)
  v_mfma_f32_32x32x16_bf16 v[0:15], a[48:51], v[32:35], v[0:15]
  ds_read_b128 v[44:47], v206 offset:3072
  v_mfma_f32_32x32x16_bf16 v[16:31], a[192:195], v[32:35], v[16:31]
  s_waitcnt lgkmcnt(2)
  v_mfma_f32_32x32x16_bf16 v[0:15], a[52:55], v[36:39], v[0:15]
  ds_read_b128 v[32:35], v203 offset:4096
  v_mfma_f32_32x32x16_bf16 v[16:31], a[196:199], v[36:39], v[16:31]
  s_waitcnt lgkmcnt(2)
  v_mfma_f32_32x32x16_bf16 v[0:15], a[56:59], v[40:43], v[0:15]
  ds_read_b128 v[36:39], v204 offset:4096
  v_mfma_f32_32x32x16_bf16 v[16:31], a[200:203], v[40:43], v[16:31]
  s_waitcnt lgkmcnt(2)
  v_mfma_f32_32x32x16_bf16 v[0:15], a[60:63], v[44:47], v[0:15]
  ds_read_b128 v[40:43], v205 offset:4096
  v_mfma_f32_32x32x16_bf16 v[16:31], a[204:207], v[44:47], v[16:31]
  s_waitcnt lgkmcnt(2)
  v_mfma_f32_32x32x16_bf16 v[0:15], a[64:67], v[32:35], v[0:15]
  ds_read_b128 v[44:47], v206 offset:4096
  v_mfma_f32_32x32x16_bf16 v[16:31], a[208:211], v[32:35], v[16:31]
  s_waitcnt lgkmcnt(2)
  v_mfma_f32_32x32x16_bf16 v[0:15], a[68:71], v[36:39], v[0:15]
  ds_read_b128 v[32:35], v203 offset:5120
  v_mfma_f32_32x32x16_bf16 v[16:31], a[212:215], v[36:39], v[16:31]
  s_waitcnt lgkmcnt(2)
  v_mfma_f32_32x32x16_bf16 v[0:15], a[72:75], v[40:43], v[0:15]
  ds_read_b128 v[36:39], v204 offset:5120
  v_mfma_f32_32x32x16_bf16 v[16:31], a[216:219], v[40:43], v[16:31]
  s_waitcnt lgkmcnt(2)
  v_mfma_f32_32x32x16_bf16 v[0:15], a[76:79], v[44:47], v[0:15]
  ds_read_b128 v[40:43], v205 offset:5120
  v_mfma_f32_32x32x16_bf16 v[16:31], a[220:223], v[44:47], v[16:31]
  s_waitcnt lgkmcnt(2)
  v_mfma_f32_32x32x16_bf16 v[0:15], a[80:83], v[32:35], v[0:15]
  ds_read_b128 v[44:47], v206 offset:5120
  v_mfma_f32_32x32x16_bf16 v[16:31], a[224:227], v[32:35], v[16:31]
  s_waitcnt lgkmcnt(2)
  v_mfma_f32_32x32x16_bf16 v[0:15], a[84:87], v[36:39], v[0:15]
  ds_read_b128 v[32:35], v203 offset:6144
  v_mfma_f32_32x32x16_bf16 v[16:31], a[228:231], v[36:39], v[16:31]
  s_waitcnt lgkmcnt(2)
  v_mfma_f32_32x32x16_bf16 v[0:15], a[88:91], v[40:43], v[0:15]
  ds_read_b128 v[36:39], v204 offset:6144
  v_mfma_f32_32x32x16_bf16 v[16:31], a[232:235], v[40:43], v[16:31]
  s_waitcnt lgkmcnt(2)
  v_mfma_f32_32x32x16_bf16 v[0:15], a[92:95], v[44:47], v[0:15]
  ds_read_b128 v[40:43], v205 offset:6144
  v_mfma_f32_32x32x16_bf16 v[16:31], a[236:239], v[44:47], v[16:31]
  s_waitcnt lgkmcnt(2)
  v_mfma_f32_32x32x16_bf16 v[0:15], a[96:99], v[32:35], v[0:15]
  ds_read_b128 v[44:47], v206 offset:6144
  v_mfma_f32_32x32x16_bf16 v[16:31], a[240:243], v[32:35], v[16:31]
  s_waitcnt lgkmcnt(2)
  v_mfma_f32_32x32x16_bf16 v[0:15], a[100:103], v[36:39], v[0:15]
  ds_read_b128 v[32:35], v203 offset:7168
  v_mfma_f32_32x32x16_bf16 v[16:31], a[244:247], v[36:39], v[16:31]
  s_waitcnt lgkmcnt(2)
  v_mfma_f32_32x32x16_bf16 v[0:15], a[104:107], v[40:43], v[0:15]
  ds_read_b128 v[36:39], v204 offset:7168
  v_mfma_f32_32x32x16_bf16 v[16:31], a[248:251], v[40:43], v[16:31]
  s_waitcnt lgkmcnt(2)
  v_mfma_f32_32x32x16_bf16 v[0:15], a[108:111], v[44:47], v[0:15]
  ds_read_b128 v[40:43], v205 offset:7168
  v_mfma_f32_32x32x16_bf16 v[16:31], a[252:255], v[44:47], v[16:31]
  s_waitcnt lgkmcnt(2)
  v_mfma_f32_32x32x16_bf16 v[0:15], a[112:115], v[32:35], v[0:15]
  ds_read_b128 v[44:47], v206 offset:7168
  v_mfma_f32_32x32x16_bf16 v[16:31], v[224:227], v[32:35], v[16:31]
  s_waitcnt lgkmcnt(2)
  v_mfma_f32_32x32x16_bf16 v[0:15], a[116:119], v[36:39], v[0:15]
  ds_read_b128 v[32:35], v203 offset:8192
  v_mfma_f32_32x32x16_bf16 v[16:31], v[228:231], v[36:39], v[16:31]
  s_waitcnt lgkmcnt(2)
  v_mfma_f32_32x32x16_bf16 v[0:15], a[120:123], v[40:43], v[0:15]
  ds_read_b128 v[36:39], v204 offset:8192
  v_mfma_f32_32x32x16_bf16 v[16:31], v[232:235], v[40:43], v[16:31]
  s_waitcnt lgkmcnt(2)
  v_mfma_f32_32x32x16_bf16 v[0:15], a[124:127], v[44:47], v[0:15]
  ds_read_b128 v[40:43], v205 offset:8192
  v_mfma_f32_32x32x16_bf16 v[16:31], v[236:239], v[44:47], v[16:31]
  s_waitcnt lgkmcnt(2)
  v_mfma_f32_32x32x16_bf16 v[0:15], a[128:131], v[32:35], v[0:15]
  ds_read_b128 v[44:47], v206 offset:8192
  v_mfma_f32_32x32x16_bf16 v[16:31], v[240:243], v[32:35], v[16:31]
  s_waitcnt lgkmcnt(2)
  v_mfma_f32_32x32x16_bf16 v[0:15], a[132:135], v[36:39], v[0:15]
  v_mfma_f32_32x32x16_bf16 v[16:31], v[244:247], v[36:39], v[16:31]
  s_waitcnt lgkmcnt(1)
  v_mfma_f32_32x32x16_bf16 v[0:15], a[136:139], v[40:43], v[0:15]
  v_mfma_f32_32x32x16_bf16 v[16:31], v[248:251], v[40:43], v[16:31]
  s_waitcnt lgkmcnt(0)
  v_mfma_f32_32x32x16_bf16 v[0:15], a[140:143], v[44:47], v[0:15]
  v_mfma_f32_32x32x16_bf16 v[16:31], v[252:255], v[44:47], v[16:31]
  s_nop 3
  v_cvt_pk_bf16_f32 v48, v0, v1
  v_cvt_pk_bf16_f32 v49, v2, v3
  ds_write2_b32 v218, v48, v49 offset0:0 offset1:1
  v_cvt_pk_bf16_f32 v48, v4, v5
  v_cvt_pk_bf16_f32 v49, v6, v7
  ds_write2_b32 v218, v48, v49 offset0:4 offset1:5
  v_cvt_pk_bf16_f32 v48, v8, v9
  v_cvt_pk_bf16_f32 v49, v10, v11
  ds_write2_b32 v218, v48, v49 offset0:8 offset1:9
  v_cvt_pk_bf16_f32 v48, v12, v13
  v_cvt_pk_bf16_f32 v49, v14, v15
  ds_write2_b32 v218, v48, v49 offset0:12 offset1:13
  v_cvt_pk_bf16_f32 v48, v16, v17
  v_cvt_pk_bf16_f32 v49, v18, v19
  ds_write2_b32 v218, v48, v49 offset0:64 offset1:65
  v_cvt_pk_bf16_f32 v48, v20, v21
  v_cvt_pk_bf16_f32 v49, v22, v23
  ds_write2_b32 v218, v48, v49 offset0:68 offset1:69
  v_cvt_pk_bf16_f32 v48, v24, v25
  v_cvt_pk_bf16_f32 v49, v26, v27
  ds_write2_b32 v218, v48, v49 offset0:72 offset1:73
  v_cvt_pk_bf16_f32 v48, v28, v29
  v_cvt_pk_bf16_f32 v49, v30, v31
  ds_write2_b32 v218, v48, v49 offset0:76 offset1:77
  v_add_u32 v218, 16512, v218
  s_waitcnt vmcnt(0) lgkmcnt(0)
  s_barrier
  s_add_u32 m0, s67, 0
  s_nop 0
  buffer_load_dwordx4 v202, s[4:7], s60 offen offset:0 lds
  s_add_u32 m0, s67, 896
  s_nop 0
  buffer_load_dwordx4 v202, s[4:7], s60 offen offset:128 lds
  s_add_u32 m0, s67, 1792
  s_nop 0
  buffer_load_dwordx4 v202, s[4:7], s60 offen offset:256 lds
  s_add_u32 m0, s67, 2688
  s_nop 0
  buffer_load_dwordx4 v202, s[4:7], s60 offen offset:384 lds
  s_add_u32 m0, s67, 3584
  s_nop 0
  buffer_load_dwordx4 v202, s[4:7], s60 offen offset:512 lds
  s_add_u32 m0, s67, 4480
  s_nop 0
  buffer_load_dwordx4 v202, s[4:7], s60 offen offset:640 lds
  s_add_u32 m0, s67, 5376
  s_nop 0
  buffer_load_dwordx4 v202, s[4:7], s60 offen offset:768 lds
  s_add_u32 m0, s67, 6272
  s_nop 0
  buffer_load_dwordx4 v202, s[4:7], s60 offen offset:896 lds
  s_add_u32 m0, s67, 7168
  s_nop 0
  buffer_load_dwordx4 v202, s[4:7], s60 offen offset:1024 lds
  s_add_u32 s60, s60, 36864
  ds_read_b128 v[32:35], v203 offset:36864
  ds_read_b128 v[36:39], v204 offset:36864
  ds_read_b128 v[40:43], v205 offset:36864
  s_waitcnt lgkmcnt(2)
  v_mfma_f32_32x32x16_bf16 v[0:15], a[0:3], v[32:35], 0
  ds_read_b128 v[44:47], v206 offset:36864
  v_mfma_f32_32x32x16_bf16 v[16:31], a[144:147], v[32:35], 0
  s_waitcnt lgkmcnt(2)
  v_mfma_f32_32x32x16_bf16 v[0:15], a[4:7], v[36:39], v[0:15]
  ds_read_b128 v[32:35], v203 offset:37888
  v_mfma_f32_32x32x16_bf16 v[16:31], a[148:151], v[36:39], v[16:31]
  s_waitcnt lgkmcnt(2)
  v_mfma_f32_32x32x16_bf16 v[0:15], a[8:11], v[40:43], v[0:15]
  ds_read_b128 v[36:39], v204 offset:37888
  v_mfma_f32_32x32x16_bf16 v[16:31], a[152:155], v[40:43], v[16:31]
  s_waitcnt lgkmcnt(2)
  v_mfma_f32_32x32x16_bf16 v[0:15], a[12:15], v[44:47], v[0:15]
  ds_read_b128 v[40:43], v205 offset:37888
  v_mfma_f32_32x32x16_bf16 v[16:31], a[156:159], v[44:47], v[16:31]
  s_waitcnt lgkmcnt(2)
  v_mfma_f32_32x32x16_bf16 v[0:15], a[16:19], v[32:35], v[0:15]
  ds_read_b128 v[44:47], v206 offset:37888
  v_mfma_f32_32x32x16_bf16 v[16:31], a[160:163], v[32:35], v[16:31]
  s_waitcnt lgkmcnt(2)
  v_mfma_f32_32x32x16_bf16 v[0:15], a[20:23], v[36:39], v[0:15]
  ds_read_b128 v[32:35], v203 offset:38912
  v_mfma_f32_32x32x16_bf16 v[16:31], a[164:167], v[36:39], v[16:31]
  s_waitcnt lgkmcnt(2)
  v_mfma_f32_32x32x16_bf16 v[0:15], a[24:27], v[40:43], v[0:15]
  ds_read_b128 v[36:39], v204 offset:38912
  v_mfma_f32_32x32x16_bf16 v[16:31], a[168:171], v[40:43], v[16:31]
  s_waitcnt lgkmcnt(2)
  v_mfma_f32_32x32x16_bf16 v[0:15], a[28:31], v[44:47], v[0:15]
  ds_read_b128 v[40:43], v205 offset:38912
  v_mfma_f32_32x32x16_bf16 v[16:31], a[172:175], v[44:47], v[16:31]
  s_waitcnt lgkmcnt(2)
  v_mfma_f32_32x32x16_bf16 v[0:15], a[32:35], v[32:35], v[0:15]
  ds_read_b128 v[44:47], v206 offset:38912
  v_mfma_f32_32x32x16_bf16 v[16:31], a[176:179], v[32:35], v[16:31]
  s_waitcnt lgkmcnt(2)
  v_mfma_f32_32x32x16_bf16 v[0:15], a[36:39], v[36:39], v[0:15]
  ds_read_b128 v[32:35], v203 offset:39936
  v_mfma_f32_32x32x16_bf16 v[16:31], a[180:183], v[36:39], v[16:31]
  s_waitcnt lgkmcnt(2)
  v_mfma_f32_32x32x16_bf16 v[0:15], a[40:43], v[40:43], v[0:15]
  ds_read_b128 v[36:39], v204 offset:39936
  v_mfma_f32_32x32x16_bf16 v[16:31], a[184:187], v[40:43], v[16:31]
  s_waitcnt lgkmcnt(2)
  v_mfma_f32_32x32x16_bf16 v[0:15], a[44:47], v[44:47], v[0:15]
  ds_read_b128 v[40:43], v205 offset:39936
  v_mfma_f32_32x32x16_bf16 v[16:31], a[188:191], v[44:47], v[16:31]
  s_waitcnt lgkmcnt(2)
  v_mfma_f32_32x32x16_bf16 v[0:15], a[48:51], v[32:35], v[0:15]
  ds_read_b128 v[44:47], v206 offset:39936
  v_mfma_f32_32x32x16_bf16 v[16:31], a[192:195], v[32:35], v[16:31]
  s_waitcnt lgkmcnt(2)
  v_mfma_f32_32x32x16_bf16 v[0:15], a[52:55], v[36:39], v[0:15]
  ds_read_b128 v[32:35], v203 offset:40960
  v_mfma_f32_32x32x16_bf16 v[16:31], a[196:199], v[36:39], v[16:31]
  s_waitcnt lgkmcnt(2)
  v_mfma_f32_32x32x16_bf16 v[0:15], a[56:59], v[40:43], v[0:15]
  ds_read_b128 v[36:39], v204 offset:40960
  v_mfma_f32_32x32x16_bf16 v[16:31], a[200:203], v[40:43], v[16:31]
  s_waitcnt lgkmcnt(2)
  v_mfma_f32_32x32x16_bf16 v[0:15], a[60:63], v[44:47], v[0:15]
  ds_read_b128 v[40:43], v205 offset:40960
  v_mfma_f32_32x32x16_bf16 v[16:31], a[204:207], v[44:47], v[16:31]
  s_waitcnt lgkmcnt(2)
  v_mfma_f32_32x32x16_bf16 v[0:15], a[64:67], v[32:35], v[0:15]
  ds_read_b128 v[44:47], v206 offset:40960
  v_mfma_f32_32x32x16_bf16 v[16:31], a[208:211], v[32:35], v[16:31]
  s_waitcnt lgkmcnt(2)
  v_mfma_f32_32x32x16_bf16 v[0:15], a[68:71], v[36:39], v[0:15]
  ds_read_b128 v[32:35], v203 offset:41984
  v_mfma_f32_32x32x16_bf16 v[16:31], a[212:215], v[36:39], v[16:31]
  s_waitcnt lgkmcnt(2)
  v_mfma_f32_32x32x16_bf16 v[0:15], a[72:75], v[40:43], v[0:15]
  ds_read_b128 v[36:39], v204 offset:41984
  v_mfma_f32_32x32x16_bf16 v[16:31], a[216:219], v[40:43], v[16:31]
  s_waitcnt lgkmcnt(2)
  v_mfma_f32_32x32x16_bf16 v[0:15], a[76:79], v[44:47], v[0:15]
  ds_read_b128 v[40:43], v205 offset:41984
  v_mfma_f32_32x32x16_bf16 v[16:31], a[220:223], v[44:47], v[16:31]
  s_waitcnt lgkmcnt(2)
  v_mfma_f32_32x32x16_bf16 v[0:15], a[80:83], v[32:35], v[0:15]
  ds_read_b128 v[44:47], v206 offset:41984
  v_mfma_f32_32x32x16_bf16 v[16:31], a[224:227], v[32:35], v[16:31]
  s_waitcnt lgkmcnt(2)
  v_mfma_f32_32x32x16_bf16 v[0:15], a[84:87], v[36:39], v[0:15]
  ds_read_b128 v[32:35], v203 offset:43008
  v_mfma_f32_32x32x16_bf16 v[16:31], a[228:231], v[36:39], v[16:31]
  s_waitcnt lgkmcnt(2)
  v_mfma_f32_32x32x16_bf16 v[0:15], a[88:91], v[40:43], v[0:15]
  ds_read_b128 v[36:39], v204 offset:43008
  v_mfma_f32_32x32x16_bf16 v[16:31], a[232:235], v[40:43], v[16:31]
  s_waitcnt lgkmcnt(2)
  v_mfma_f32_32x32x16_bf16 v[0:15], a[92:95], v[44:47], v[0:15]
  ds_read_b128 v[40:43], v205 offset:43008
  v_mfma_f32_32x32x16_bf16 v[16:31], a[236:239], v[44:47], v[16:31]
  s_waitcnt lgkmcnt(2)
  v_mfma_f32_32x32x16_bf16 v[0:15], a[96:99], v[32:35], v[0:15]
  ds_read_b128 v[44:47], v206 offset:43008
  v_mfma_f32_32x32x16_bf16 v[16:31], a[240:243], v[32:35], v[16:31]
  s_waitcnt lgkmcnt(2)
  v_mfma_f32_32x32x16_bf16 v[0:15], a[100:103], v[36:39], v[0:15]
  ds_read_b128 v[32:35], v203 offset:44032
  v_mfma_f32_32x32x16_bf16 v[16:31], a[244:247], v[36:39], v[16:31]
  s_waitcnt lgkmcnt(2)
  v_mfma_f32_32x32x16_bf16 v[0:15], a[104:107], v[40:43], v[0:15]
  ds_read_b128 v[36:39], v204 offset:44032
  v_mfma_f32_32x32x16_bf16 v[16:31], a[248:251], v[40:43], v[16:31]
  s_waitcnt lgkmcnt(2)
  v_mfma_f32_32x32x16_bf16 v[0:15], a[108:111], v[44:47], v[0:15]
  ds_read_b128 v[40:43], v205 offset:44032
  v_mfma_f32_32x32x16_bf16 v[16:31], a[252:255], v[44:47], v[16:31]
  s_waitcnt lgkmcnt(2)
  v_mfma_f32_32x32x16_bf16 v[0:15], a[112:115], v[32:35], v[0:15]
  ds_read_b128 v[44:47], v206 offset:44032
  v_mfma_f32_32x32x16_bf16 v[16:31], v[224:227], v[32:35], v[16:31]
  s_waitcnt lgkmcnt(2)
  v_mfma_f32_32x32x16_bf16 v[0:15], a[116:119], v[36:39], v[0:15]
  ds_read_b128 v[32:35], v203 offset:45056
  v_mfma_f32_32x32x16_bf16 v[16:31], v[228:231], v[36:39], v[16:31]
  s_waitcnt lgkmcnt(2)
  v_mfma_f32_32x32x16_bf16 v[0:15], a[120:123], v[40:43], v[0:15]
  ds_read_b128 v[36:39], v204 offset:45056
  v_mfma_f32_32x32x16_bf16 v[16:31], v[232:235], v[40:43], v[16:31]
  s_waitcnt lgkmcnt(2)
  v_mfma_f32_32x32x16_bf16 v[0:15], a[124:127], v[44:47], v[0:15]
  ds_read_b128 v[40:43], v205 offset:45056
  v_mfma_f32_32x32x16_bf16 v[16:31], v[236:239], v[44:47], v[16:31]
  s_waitcnt lgkmcnt(2)
  v_mfma_f32_32x32x16_bf16 v[0:15], a[128:131], v[32:35], v[0:15]
  ds_read_b128 v[44:47], v206 offset:45056
  v_mfma_f32_32x32x16_bf16 v[16:31], v[240:243], v[32:35], v[16:31]
  s_waitcnt lgkmcnt(2)
  v_mfma_f32_32x32x16_bf16 v[0:15], a[132:135], v[36:39], v[0:15]
  v_mfma_f32_32x32x16_bf16 v[16:31], v[244:247], v[36:39], v[16:31]
  s_waitcnt lgkmcnt(1)
  v_mfma_f32_32x32x16_bf16 v[0:15], a[136:139], v[40:43], v[0:15]
  v_mfma_f32_32x32x16_bf16 v[16:31], v[248:251], v[40:43], v[16:31]
  s_waitcnt lgkmcnt(0)
  v_mfma_f32_32x32x16_bf16 v[0:15], a[140:143], v[44:47], v[0:15]
  v_mfma_f32_32x32x16_bf16 v[16:31], v[252:255], v[44:47], v[16:31]
  s_nop 3
  v_cvt_pk_bf16_f32 v48, v0, v1
  v_cvt_pk_bf16_f32 v49, v2, v3
  ds_write2_b32 v218, v48, v49 offset0:0 offset1:1
  v_cvt_pk_bf16_f32 v48, v4, v5
  v_cvt_pk_bf16_f32 v49, v6, v7
  ds_write2_b32 v218, v48, v49 offset0:4 offset1:5
  v_cvt_pk_bf16_f32 v48, v8, v9
  v_cvt_pk_bf16_f32 v49, v10, v11
  ds_write2_b32 v218, v48, v49 offset0:8 offset1:9
  v_cvt_pk_bf16_f32 v48, v12, v13
  v_cvt_pk_bf16_f32 v49, v14, v15
  ds_write2_b32 v218, v48, v49 offset0:12 offset1:13
  v_cvt_pk_bf16_f32 v48, v16, v17
  v_cvt_pk_bf16_f32 v49, v18, v19
  ds_write2_b32 v218, v48, v49 offset0:64 offset1:65
  v_cvt_pk_bf16_f32 v48, v20, v21
  v_cvt_pk_bf16_f32 v49, v22, v23
  ds_write2_b32 v218, v48, v49 offset0:68 offset1:69
  v_cvt_pk_bf16_f32 v48, v24, v25
  v_cvt_pk_bf16_f32 v49, v26, v27
  ds_write2_b32 v218, v48, v49 offset0:72 offset1:73
  v_cvt_pk_bf16_f32 v48, v28, v29
  v_cvt_pk_bf16_f32 v49, v30, v31
  ds_write2_b32 v218, v48, v49 offset0:76 offset1:77
  v_add_u32 v218, 16512, v218
  s_waitcnt vmcnt(0) lgkmcnt(0)
  s_barrier
  s_add_u32 m0, s67, 36864
  s_nop 0
  buffer_load_dwordx4 v202, s[4:7], s60 offen offset:0 lds
  s_add_u32 m0, s67, 37760
  s_nop 0
  buffer_load_dwordx4 v202, s[4:7], s60 offen offset:128 lds
  s_add_u32 m0, s67, 38656
  s_nop 0
  buffer_load_dwordx4 v202, s[4:7], s60 offen offset:256 lds
  s_add_u32 m0, s67, 39552
  s_nop 0
  buffer_load_dwordx4 v202, s[4:7], s60 offen offset:384 lds
  s_add_u32 m0, s67, 40448
  s_nop 0
  buffer_load_dwordx4 v202, s[4:7], s60 offen offset:512 lds
  s_add_u32 m0, s67, 41344
  s_nop 0
  buffer_load_dwordx4 v202, s[4:7], s60 offen offset:640 lds
  s_add_u32 m0, s67, 42240
  s_nop 0
  buffer_load_dwordx4 v202, s[4:7], s60 offen offset:768 lds
  s_add_u32 m0, s67, 43136
  s_nop 0
  buffer_load_dwordx4 v202, s[4:7], s60 offen offset:896 lds
  s_add_u32 m0, s67, 44032
  s_nop 0
  buffer_load_dwordx4 v202, s[4:7], s60 offen offset:1024 lds
  s_add_u32 s60, s60, 36864
  ds_read_b128 v[32:35], v203 offset:0
  ds_read_b128 v[36:39], v204 offset:0
  ds_read_b128 v[40:43], v205 offset:0
  s_waitcnt lgkmcnt(2)
  v_mfma_f32_32x32x16_bf16 v[0:15], a[0:3], v[32:35], 0
  ds_read_b128 v[44:47], v206 offset:0
  v_mfma_f32_32x32x16_bf16 v[16:31], a[144:147], v[32:35], 0
  s_waitcnt lgkmcnt(2)
  v_mfma_f32_32x32x16_bf16 v[0:15], a[4:7], v[36:39], v[0:15]
  ds_read_b128 v[32:35], v203 offset:1024
  v_mfma_f32_32x32x16_bf16 v[16:31], a[148:151], v[36:39], v[16:31]
  s_waitcnt lgkmcnt(2)
  v_mfma_f32_32x32x16_bf16 v[0:15], a[8:11], v[40:43], v[0:15]
  ds_read_b128 v[36:39], v204 offset:1024
  v_mfma_f32_32x32x16_bf16 v[16:31], a[152:155], v[40:43], v[16:31]
  s_waitcnt lgkmcnt(2)
  v_mfma_f32_32x32x16_bf16 v[0:15], a[12:15], v[44:47], v[0:15]
  ds_read_b128 v[40:43], v205 offset:1024
  v_mfma_f32_32x32x16_bf16 v[16:31], a[156:159], v[44:47], v[16:31]
  s_waitcnt lgkmcnt(2)
  v_mfma_f32_32x32x16_bf16 v[0:15], a[16:19], v[32:35], v[0:15]
  ds_read_b128 v[44:47], v206 offset:1024
  v_mfma_f32_32x32x16_bf16 v[16:31], a[160:163], v[32:35], v[16:31]
  s_waitcnt lgkmcnt(2)
  v_mfma_f32_32x32x16_bf16 v[0:15], a[20:23], v[36:39], v[0:15]
  ds_read_b128 v[32:35], v203 offset:2048
  v_mfma_f32_32x32x16_bf16 v[16:31], a[164:167], v[36:39], v[16:31]
  s_waitcnt lgkmcnt(2)
  v_mfma_f32_32x32x16_bf16 v[0:15], a[24:27], v[40:43], v[0:15]
  ds_read_b128 v[36:39], v204 offset:2048
  v_mfma_f32_32x32x16_bf16 v[16:31], a[168:171], v[40:43], v[16:31]
  s_waitcnt lgkmcnt(2)
  v_mfma_f32_32x32x16_bf16 v[0:15], a[28:31], v[44:47], v[0:15]
  ds_read_b128 v[40:43], v205 offset:2048
  v_mfma_f32_32x32x16_bf16 v[16:31], a[172:175], v[44:47], v[16:31]
  s_waitcnt lgkmcnt(2)
  v_mfma_f32_32x32x16_bf16 v[0:15], a[32:35], v[32:35], v[0:15]
  ds_read_b128 v[44:47], v206 offset:2048
  v_mfma_f32_32x32x16_bf16 v[16:31], a[176:179], v[32:35], v[16:31]
  s_waitcnt lgkmcnt(2)
  v_mfma_f32_32x32x16_bf16 v[0:15], a[36:39], v[36:39], v[0:15]
  ds_read_b128 v[32:35], v203 offset:3072
  v_mfma_f32_32x32x16_bf16 v[16:31], a[180:183], v[36:39], v[16:31]
  s_waitcnt lgkmcnt(2)
  v_mfma_f32_32x32x16_bf16 v[0:15], a[40:43], v[40:43], v[0:15]
  ds_read_b128 v[36:39], v204 offset:3072
  v_mfma_f32_32x32x16_bf16 v[16:31], a[184:187], v[40:43], v[16:31]
  s_waitcnt lgkmcnt(2)
  v_mfma_f32_32x32x16_bf16 v[0:15], a[44:47], v[44:47], v[0:15]
  ds_read_b128 v[40:43], v205 offset:3072
  v_mfma_f32_32x32x16_bf16 v[16:31], a[188:191], v[44:47], v[16:31]
  s_waitcnt lgkmcnt(2)
  v_mfma_f32_32x32x16_bf16 v[0:15], a[48:51], v[32:35], v[0:15]
  ds_read_b128 v[44:47], v206 offset:3072
  v_mfma_f32_32x32x16_bf16 v[16:31], a[192:195], v[32:35], v[16:31]
  s_waitcnt lgkmcnt(2)
  v_mfma_f32_32x32x16_bf16 v[0:15], a[52:55], v[36:39], v[0:15]
  ds_read_b128 v[32:35], v203 offset:4096
  v_mfma_f32_32x32x16_bf16 v[16:31], a[196:199], v[36:39], v[16:31]
  s_waitcnt lgkmcnt(2)
  v_mfma_f32_32x32x16_bf16 v[0:15], a[56:59], v[40:43], v[0:15]
  ds_read_b128 v[36:39], v204 offset:4096
  v_mfma_f32_32x32x16_bf16 v[16:31], a[200:203], v[40:43], v[16:31]
  s_waitcnt lgkmcnt(2)
  v_mfma_f32_32x32x16_bf16 v[0:15], a[60:63], v[44:47], v[0:15]
  ds_read_b128 v[40:43], v205 offset:4096
  v_mfma_f32_32x32x16_bf16 v[16:31], a[204:207], v[44:47], v[16:31]
  s_waitcnt lgkmcnt(2)
  v_mfma_f32_32x32x16_bf16 v[0:15], a[64:67], v[32:35], v[0:15]
  ds_read_b128 v[44:47], v206 offset:4096
  v_mfma_f32_32x32x16_bf16 v[16:31], a[208:211], v[32:35], v[16:31]
  s_waitcnt lgkmcnt(2)
  v_mfma_f32_32x32x16_bf16 v[0:15], a[68:71], v[36:39], v[0:15]
  ds_read_b128 v[32:35], v203 offset:5120
  v_mfma_f32_32x32x16_bf16 v[16:31], a[212:215], v[36:39], v[16:31]
  s_waitcnt lgkmcnt(2)
  v_mfma_f32_32x32x16_bf16 v[0:15], a[72:75], v[40:43], v[0:15]
  ds_read_b128 v[36:39], v204 offset:5120
  v_mfma_f32_32x32x16_bf16 v[16:31], a[216:219], v[40:43], v[16:31]
  s_waitcnt lgkmcnt(2)
  v_mfma_f32_32x32x16_bf16 v[0:15], a[76:79], v[44:47], v[0:15]
  ds_read_b128 v[40:43], v205 offset:5120
  v_mfma_f32_32x32x16_bf16 v[16:31], a[220:223], v[44:47], v[16:31]
  s_waitcnt lgkmcnt(2)
  v_mfma_f32_32x32x16_bf16 v[0:15], a[80:83], v[32:35], v[0:15]
  ds_read_b128 v[44:47], v206 offset:5120
  v_mfma_f32_32x32x16_bf16 v[16:31], a[224:227], v[32:35], v[16:31]
  s_waitcnt lgkmcnt(2)
  v_mfma_f32_32x32x16_bf16 v[0:15], a[84:87], v[36:39], v[0:15]
  ds_read_b128 v[32:35], v203 offset:6144
  v_mfma_f32_32x32x16_bf16 v[16:31], a[228:231], v[36:39], v[16:31]
  s_waitcnt lgkmcnt(2)
  v_mfma_f32_32x32x16_bf16 v[0:15], a[88:91], v[40:43], v[0:15]
  ds_read_b128 v[36:39], v204 offset:6144
  v_mfma_f32_32x32x16_bf16 v[16:31], a[232:235], v[40:43], v[16:31]
  s_waitcnt lgkmcnt(2)
  v_mfma_f32_32x32x16_bf16 v[0:15], a[92:95], v[44:47], v[0:15]
  ds_read_b128 v[40:43], v205 offset:6144
  v_mfma_f32_32x32x16_bf16 v[16:31], a[236:239], v[44:47], v[16:31]
  s_waitcnt lgkmcnt(2)
  v_mfma_f32_32x32x16_bf16 v[0:15], a[96:99], v[32:35], v[0:15]
  ds_read_b128 v[44:47], v206 offset:6144
  v_mfma_f32_32x32x16_bf16 v[16:31], a[240:243], v[32:35], v[16:31]
  s_waitcnt lgkmcnt(2)
  v_mfma_f32_32x32x16_bf16 v[0:15], a[100:103], v[36:39], v[0:15]
  ds_read_b128 v[32:35], v203 offset:7168
  v_mfma_f32_32x32x16_bf16 v[16:31], a[244:247], v[36:39], v[16:31]
  s_waitcnt lgkmcnt(2)
  v_mfma_f32_32x32x16_bf16 v[0:15], a[104:107], v[40:43], v[0:15]
  ds_read_b128 v[36:39], v204 offset:7168
  v_mfma_f32_32x32x16_bf16 v[16:31], a[248:251], v[40:43], v[16:31]
  s_waitcnt lgkmcnt(2)
  v_mfma_f32_32x32x16_bf16 v[0:15], a[108:111], v[44:47], v[0:15]
  ds_read_b128 v[40:43], v205 offset:7168
  v_mfma_f32_32x32x16_bf16 v[16:31], a[252:255], v[44:47], v[16:31]
  s_waitcnt lgkmcnt(2)
  v_mfma_f32_32x32x16_bf16 v[0:15], a[112:115], v[32:35], v[0:15]
  ds_read_b128 v[44:47], v206 offset:7168
  v_mfma_f32_32x32x16_bf16 v[16:31], v[224:227], v[32:35], v[16:31]
  s_waitcnt lgkmcnt(2)
  v_mfma_f32_32x32x16_bf16 v[0:15], a[116:119], v[36:39], v[0:15]
  ds_read_b128 v[32:35], v203 offset:8192
  v_mfma_f32_32x32x16_bf16 v[16:31], v[228:231], v[36:39], v[16:31]
  s_waitcnt lgkmcnt(2)
  v_mfma_f32_32x32x16_bf16 v[0:15], a[120:123], v[40:43], v[0:15]
  ds_read_b128 v[36:39], v204 offset:8192
  v_mfma_f32_32x32x16_bf16 v[16:31], v[232:235], v[40:43], v[16:31]
  s_waitcnt lgkmcnt(2)
  v_mfma_f32_32x32x16_bf16 v[0:15], a[124:127], v[44:47], v[0:15]
  ds_read_b128 v[40:43], v205 offset:8192
  v_mfma_f32_32x32x16_bf16 v[16:31], v[236:239], v[44:47], v[16:31]
  s_waitcnt lgkmcnt(2)
  v_mfma_f32_32x32x16_bf16 v[0:15], a[128:131], v[32:35], v[0:15]
  ds_read_b128 v[44:47], v206 offset:8192
  v_mfma_f32_32x32x16_bf16 v[16:31], v[240:243], v[32:35], v[16:31]
  s_waitcnt lgkmcnt(2)
  v_mfma_f32_32x32x16_bf16 v[0:15], a[132:135], v[36:39], v[0:15]
  v_mfma_f32_32x32x16_bf16 v[16:31], v[244:247], v[36:39], v[16:31]
  s_waitcnt lgkmcnt(1)
  v_mfma_f32_32x32x16_bf16 v[0:15], a[136:139], v[40:43], v[0:15]
  v_mfma_f32_32x32x16_bf16 v[16:31], v[248:251], v[40:43], v[16:31]
  s_waitcnt lgkmcnt(0)
  v_mfma_f32_32x32x16_bf16 v[0:15], a[140:143], v[44:47], v[0:15]
  v_mfma_f32_32x32x16_bf16 v[16:31], v[252:255], v[44:47], v[16:31]
  s_nop 3
  v_cvt_pk_bf16_f32 v48, v0, v1
  v_cvt_pk_bf16_f32 v49, v2, v3
  ds_write2_b32 v218, v48, v49 offset0:0 offset1:1
  v_cvt_pk_bf16_f32 v48, v4, v5
  v_cvt_pk_bf16_f32 v49, v6, v7
  ds_write2_b32 v218, v48, v49 offset0:4 offset1:5
  v_cvt_pk_bf16_f32 v48, v8, v9
  v_cvt_pk_bf16_f32 v49, v10, v11
  ds_write2_b32 v218, v48, v49 offset0:8 offset1:9
  v_cvt_pk_bf16_f32 v48, v12, v13
  v_cvt_pk_bf16_f32 v49, v14, v15
  ds_write2_b32 v218, v48, v49 offset0:12 offset1:13
  v_cvt_pk_bf16_f32 v48, v16, v17
  v_cvt_pk_bf16_f32 v49, v18, v19
  ds_write2_b32 v218, v48, v49 offset0:64 offset1:65
  v_cvt_pk_bf16_f32 v48, v20, v21
  v_cvt_pk_bf16_f32 v49, v22, v23
  ds_write2_b32 v218, v48, v49 offset0:68 offset1:69
  v_cvt_pk_bf16_f32 v48, v24, v25
  v_cvt_pk_bf16_f32 v49, v26, v27
  ds_write2_b32 v218, v48, v49 offset0:72 offset1:73
  v_cvt_pk_bf16_f32 v48, v28, v29
  v_cvt_pk_bf16_f32 v49, v30, v31
  ds_write2_b32 v218, v48, v49 offset0:76 offset1:77
  v_add_u32 v218, 16512, v218
  s_waitcnt vmcnt(0) lgkmcnt(0)
  s_barrier
  s_add_u32 m0, s67, 0
  s_nop 0
  buffer_load_dwordx4 v202, s[4:7], s60 offen offset:0 lds
  s_add_u32 m0, s67, 896
  s_nop 0
  buffer_load_dwordx4 v202, s[4:7], s60 offen offset:128 lds
  s_add_u32 m0, s67, 1792
  s_nop 0
  buffer_load_dwordx4 v202, s[4:7], s60 offen offset:256 lds
  s_add_u32 m0, s67, 2688
  s_nop 0
  buffer_load_dwordx4 v202, s[4:7], s60 offen offset:384 lds
  s_add_u32 m0, s67, 3584
  s_nop 0
  buffer_load_dwordx4 v202, s[4:7], s60 offen offset:512 lds
  s_add_u32 m0, s67, 4480
  s_nop 0
  buffer_load_dwordx4 v202, s[4:7], s60 offen offset:640 lds
  s_add_u32 m0, s67, 5376
  s_nop 0
  buffer_load_dwordx4 v202, s[4:7], s60 offen offset:768 lds
  s_add_u32 m0, s67, 6272
  s_nop 0
  buffer_load_dwordx4 v202, s[4:7], s60 offen offset:896 lds
  s_add_u32 m0, s67, 7168
  s_nop 0
  buffer_load_dwordx4 v202, s[4:7], s60 offen offset:1024 lds
  s_add_u32 s60, s60, 36864
  ds_read_b128 v[32:35], v203 offset:36864
  ds_read_b128 v[36:39], v204 offset:36864
  ds_read_b128 v[40:43], v205 offset:36864
  s_waitcnt lgkmcnt(2)
  v_mfma_f32_32x32x16_bf16 v[0:15], a[0:3], v[32:35], 0
  ds_read_b128 v[44:47], v206 offset:36864
  v_mfma_f32_32x32x16_bf16 v[16:31], a[144:147], v[32:35], 0
  s_waitcnt lgkmcnt(2)
  v_mfma_f32_32x32x16_bf16 v[0:15], a[4:7], v[36:39], v[0:15]
  ds_read_b128 v[32:35], v203 offset:37888
  v_mfma_f32_32x32x16_bf16 v[16:31], a[148:151], v[36:39], v[16:31]
  s_waitcnt lgkmcnt(2)
  v_mfma_f32_32x32x16_bf16 v[0:15], a[8:11], v[40:43], v[0:15]
  ds_read_b128 v[36:39], v204 offset:37888
  v_mfma_f32_32x32x16_bf16 v[16:31], a[152:155], v[40:43], v[16:31]
  s_waitcnt lgkmcnt(2)
  v_mfma_f32_32x32x16_bf16 v[0:15], a[12:15], v[44:47], v[0:15]
  ds_read_b128 v[40:43], v205 offset:37888
  v_mfma_f32_32x32x16_bf16 v[16:31], a[156:159], v[44:47], v[16:31]
  s_waitcnt lgkmcnt(2)
  v_mfma_f32_32x32x16_bf16 v[0:15], a[16:19], v[32:35], v[0:15]
  ds_read_b128 v[44:47], v206 offset:37888
  v_mfma_f32_32x32x16_bf16 v[16:31], a[160:163], v[32:35], v[16:31]
  s_waitcnt lgkmcnt(2)
  v_mfma_f32_32x32x16_bf16 v[0:15], a[20:23], v[36:39], v[0:15]
  ds_read_b128 v[32:35], v203 offset:38912
  v_mfma_f32_32x32x16_bf16 v[16:31], a[164:167], v[36:39], v[16:31]
  s_waitcnt lgkmcnt(2)
  v_mfma_f32_32x32x16_bf16 v[0:15], a[24:27], v[40:43], v[0:15]
  ds_read_b128 v[36:39], v204 offset:38912
  v_mfma_f32_32x32x16_bf16 v[16:31], a[168:171], v[40:43], v[16:31]
  s_waitcnt lgkmcnt(2)
  v_mfma_f32_32x32x16_bf16 v[0:15], a[28:31], v[44:47], v[0:15]
  ds_read_b128 v[40:43], v205 offset:38912
  v_mfma_f32_32x32x16_bf16 v[16:31], a[172:175], v[44:47], v[16:31]
  s_waitcnt lgkmcnt(2)
  v_mfma_f32_32x32x16_bf16 v[0:15], a[32:35], v[32:35], v[0:15]
  ds_read_b128 v[44:47], v206 offset:38912
  v_mfma_f32_32x32x16_bf16 v[16:31], a[176:179], v[32:35], v[16:31]
  s_waitcnt lgkmcnt(2)
  v_mfma_f32_32x32x16_bf16 v[0:15], a[36:39], v[36:39], v[0:15]
  ds_read_b128 v[32:35], v203 offset:39936
  v_mfma_f32_32x32x16_bf16 v[16:31], a[180:183], v[36:39], v[16:31]
  s_waitcnt lgkmcnt(2)
  v_mfma_f32_32x32x16_bf16 v[0:15], a[40:43], v[40:43], v[0:15]
  ds_read_b128 v[36:39], v204 offset:39936
  v_mfma_f32_32x32x16_bf16 v[16:31], a[184:187], v[40:43], v[16:31]
  s_waitcnt lgkmcnt(2)
  v_mfma_f32_32x32x16_bf16 v[0:15], a[44:47], v[44:47], v[0:15]
  ds_read_b128 v[40:43], v205 offset:39936
  v_mfma_f32_32x32x16_bf16 v[16:31], a[188:191], v[44:47], v[16:31]
  s_waitcnt lgkmcnt(2)
  v_mfma_f32_32x32x16_bf16 v[0:15], a[48:51], v[32:35], v[0:15]
  ds_read_b128 v[44:47], v206 offset:39936
  v_mfma_f32_32x32x16_bf16 v[16:31], a[192:195], v[32:35], v[16:31]
  s_waitcnt lgkmcnt(2)
  v_mfma_f32_32x32x16_bf16 v[0:15], a[52:55], v[36:39], v[0:15]
  ds_read_b128 v[32:35], v203 offset:40960
  v_mfma_f32_32x32x16_bf16 v[16:31], a[196:199], v[36:39], v[16:31]
  s_waitcnt lgkmcnt(2)
  v_mfma_f32_32x32x16_bf16 v[0:15], a[56:59], v[40:43], v[0:15]
  ds_read_b128 v[36:39], v204 offset:40960
  v_mfma_f32_32x32x16_bf16 v[16:31], a[200:203], v[40:43], v[16:31]
  s_waitcnt lgkmcnt(2)
  v_mfma_f32_32x32x16_bf16 v[0:15], a[60:63], v[44:47], v[0:15]
  ds_read_b128 v[40:43], v205 offset:40960
  v_mfma_f32_32x32x16_bf16 v[16:31], a[204:207], v[44:47], v[16:31]
  s_waitcnt lgkmcnt(2)
  v_mfma_f32_32x32x16_bf16 v[0:15], a[64:67], v[32:35], v[0:15]
  ds_read_b128 v[44:47], v206 offset:40960
  v_mfma_f32_32x32x16_bf16 v[16:31], a[208:211], v[32:35], v[16:31]
  s_waitcnt lgkmcnt(2)
  v_mfma_f32_32x32x16_bf16 v[0:15], a[68:71], v[36:39], v[0:15]
  ds_read_b128 v[32:35], v203 offset:41984
  v_mfma_f32_32x32x16_bf16 v[16:31], a[212:215], v[36:39], v[16:31]
  s_waitcnt lgkmcnt(2)
  v_mfma_f32_32x32x16_bf16 v[0:15], a[72:75], v[40:43], v[0:15]
  ds_read_b128 v[36:39], v204 offset:41984
  v_mfma_f32_32x32x16_bf16 v[16:31], a[216:219], v[40:43], v[16:31]
  s_waitcnt lgkmcnt(2)
  v_mfma_f32_32x32x16_bf16 v[0:15], a[76:79], v[44:47], v[0:15]
  ds_read_b128 v[40:43], v205 offset:41984
  v_mfma_f32_32x32x16_bf16 v[16:31], a[220:223], v[44:47], v[16:31]
  s_waitcnt lgkmcnt(2)
  v_mfma_f32_32x32x16_bf16 v[0:15], a[80:83], v[32:35], v[0:15]
  ds_read_b128 v[44:47], v206 offset:41984
  v_mfma_f32_32x32x16_bf16 v[16:31], a[224:227], v[32:35], v[16:31]
  s_waitcnt lgkmcnt(2)
  v_mfma_f32_32x32x16_bf16 v[0:15], a[84:87], v[36:39], v[0:15]
  ds_read_b128 v[32:35], v203 offset:43008
  v_mfma_f32_32x32x16_bf16 v[16:31], a[228:231], v[36:39], v[16:31]
  s_waitcnt lgkmcnt(2)
  v_mfma_f32_32x32x16_bf16 v[0:15], a[88:91], v[40:43], v[0:15]
  ds_read_b128 v[36:39], v204 offset:43008
  v_mfma_f32_32x32x16_bf16 v[16:31], a[232:235], v[40:43], v[16:31]
  s_waitcnt lgkmcnt(2)
  v_mfma_f32_32x32x16_bf16 v[0:15], a[92:95], v[44:47], v[0:15]
  ds_read_b128 v[40:43], v205 offset:43008
  v_mfma_f32_32x32x16_bf16 v[16:31], a[236:239], v[44:47], v[16:31]
  s_waitcnt lgkmcnt(2)
  v_mfma_f32_32x32x16_bf16 v[0:15], a[96:99], v[32:35], v[0:15]
  ds_read_b128 v[44:47], v206 offset:43008
  v_mfma_f32_32x32x16_bf16 v[16:31], a[240:243], v[32:35], v[16:31]
  s_waitcnt lgkmcnt(2)
  v_mfma_f32_32x32x16_bf16 v[0:15], a[100:103], v[36:39], v[0:15]
  ds_read_b128 v[32:35], v203 offset:44032
  v_mfma_f32_32x32x16_bf16 v[16:31], a[244:247], v[36:39], v[16:31]
  s_waitcnt lgkmcnt(2)
  v_mfma_f32_32x32x16_bf16 v[0:15], a[104:107], v[40:43], v[0:15]
  ds_read_b128 v[36:39], v204 offset:44032
  v_mfma_f32_32x32x16_bf16 v[16:31], a[248:251], v[40:43], v[16:31]
  s_waitcnt lgkmcnt(2)
  v_mfma_f32_32x32x16_bf16 v[0:15], a[108:111], v[44:47], v[0:15]
  ds_read_b128 v[40:43], v205 offset:44032
  v_mfma_f32_32x32x16_bf16 v[16:31], a[252:255], v[44:47], v[16:31]
  s_waitcnt lgkmcnt(2)
  v_mfma_f32_32x32x16_bf16 v[0:15], a[112:115], v[32:35], v[0:15]
  ds_read_b128 v[44:47], v206 offset:44032
  v_mfma_f32_32x32x16_bf16 v[16:31], v[224:227], v[32:35], v[16:31]
  s_waitcnt lgkmcnt(2)
  v_mfma_f32_32x32x16_bf16 v[0:15], a[116:119], v[36:39], v[0:15]
  ds_read_b128 v[32:35], v203 offset:45056
  v_mfma_f32_32x32x16_bf16 v[16:31], v[228:231], v[36:39], v[16:31]
  s_waitcnt lgkmcnt(2)
  v_mfma_f32_32x32x16_bf16 v[0:15], a[120:123], v[40:43], v[0:15]
  ds_read_b128 v[36:39], v204 offset:45056
  v_mfma_f32_32x32x16_bf16 v[16:31], v[232:235], v[40:43], v[16:31]
  s_waitcnt lgkmcnt(2)
  v_mfma_f32_32x32x16_bf16 v[0:15], a[124:127], v[44:47], v[0:15]
  ds_read_b128 v[40:43], v205 offset:45056
  v_mfma_f32_32x32x16_bf16 v[16:31], v[236:239], v[44:47], v[16:31]
  s_waitcnt lgkmcnt(2)
  v_mfma_f32_32x32x16_bf16 v[0:15], a[128:131], v[32:35], v[0:15]
  ds_read_b128 v[44:47], v206 offset:45056
  v_mfma_f32_32x32x16_bf16 v[16:31], v[240:243], v[32:35], v[16:31]
  s_waitcnt lgkmcnt(2)
  v_mfma_f32_32x32x16_bf16 v[0:15], a[132:135], v[36:39], v[0:15]
  v_mfma_f32_32x32x16_bf16 v[16:31], v[244:247], v[36:39], v[16:31]
  s_waitcnt lgkmcnt(1)
  v_mfma_f32_32x32x16_bf16 v[0:15], a[136:139], v[40:43], v[0:15]
  v_mfma_f32_32x32x16_bf16 v[16:31], v[248:251], v[40:43], v[16:31]
  s_waitcnt lgkmcnt(0)
  v_mfma_f32_32x32x16_bf16 v[0:15], a[140:143], v[44:47], v[0:15]
  v_mfma_f32_32x32x16_bf16 v[16:31], v[252:255], v[44:47], v[16:31]
  s_nop 3
  v_cvt_pk_bf16_f32 v48, v0, v1
  v_cvt_pk_bf16_f32 v49, v2, v3
  ds_write2_b32 v218, v48, v49 offset0:0 offset1:1
  v_cvt_pk_bf16_f32 v48, v4, v5
  v_cvt_pk_bf16_f32 v49, v6, v7
  ds_write2_b32 v218, v48, v49 offset0:4 offset1:5
  v_cvt_pk_bf16_f32 v48, v8, v9
  v_cvt_pk_bf16_f32 v49, v10, v11
  ds_write2_b32 v218, v48, v49 offset0:8 offset1:9
  v_cvt_pk_bf16_f32 v48, v12, v13
  v_cvt_pk_bf16_f32 v49, v14, v15
  ds_write2_b32 v218, v48, v49 offset0:12 offset1:13
  v_cvt_pk_bf16_f32 v48, v16, v17
  v_cvt_pk_bf16_f32 v49, v18, v19
  ds_write2_b32 v218, v48, v49 offset0:64 offset1:65
  v_cvt_pk_bf16_f32 v48, v20, v21
  v_cvt_pk_bf16_f32 v49, v22, v23
  ds_write2_b32 v218, v48, v49 offset0:68 offset1:69
  v_cvt_pk_bf16_f32 v48, v24, v25
  v_cvt_pk_bf16_f32 v49, v26, v27
  ds_write2_b32 v218, v48, v49 offset0:72 offset1:73
  v_cvt_pk_bf16_f32 v48, v28, v29
  v_cvt_pk_bf16_f32 v49, v30, v31
  ds_write2_b32 v218, v48, v49 offset0:76 offset1:77
  v_add_u32 v218, 16512, v218
  s_waitcnt vmcnt(0) lgkmcnt(0)
  s_barrier
  ds_read_b128 v[32:35], v203 offset:0
  ds_read_b128 v[36:39], v204 offset:0
  ds_read_b128 v[40:43], v205 offset:0
  s_waitcnt lgkmcnt(2)
  v_mfma_f32_32x32x16_bf16 v[0:15], a[0:3], v[32:35], 0
  ds_read_b128 v[44:47], v206 offset:0
  v_mfma_f32_32x32x16_bf16 v[16:31], a[144:147], v[32:35], 0
  s_waitcnt lgkmcnt(2)
  v_mfma_f32_32x32x16_bf16 v[0:15], a[4:7], v[36:39], v[0:15]
  ds_read_b128 v[32:35], v203 offset:1024
  v_mfma_f32_32x32x16_bf16 v[16:31], a[148:151], v[36:39], v[16:31]
  s_waitcnt lgkmcnt(2)
  v_mfma_f32_32x32x16_bf16 v[0:15], a[8:11], v[40:43], v[0:15]
  ds_read_b128 v[36:39], v204 offset:1024
  v_mfma_f32_32x32x16_bf16 v[16:31], a[152:155], v[40:43], v[16:31]
  s_waitcnt lgkmcnt(2)
  v_mfma_f32_32x32x16_bf16 v[0:15], a[12:15], v[44:47], v[0:15]
  ds_read_b128 v[40:43], v205 offset:1024
  v_mfma_f32_32x32x16_bf16 v[16:31], a[156:159], v[44:47], v[16:31]
  s_waitcnt lgkmcnt(2)
  v_mfma_f32_32x32x16_bf16 v[0:15], a[16:19], v[32:35], v[0:15]
  ds_read_b128 v[44:47], v206 offset:1024
  v_mfma_f32_32x32x16_bf16 v[16:31], a[160:163], v[32:35], v[16:31]
  s_waitcnt lgkmcnt(2)
  v_mfma_f32_32x32x16_bf16 v[0:15], a[20:23], v[36:39], v[0:15]
  ds_read_b128 v[32:35], v203 offset:2048
  v_mfma_f32_32x32x16_bf16 v[16:31], a[164:167], v[36:39], v[16:31]
  s_waitcnt lgkmcnt(2)
  v_mfma_f32_32x32x16_bf16 v[0:15], a[24:27], v[40:43], v[0:15]
  ds_read_b128 v[36:39], v204 offset:2048
  v_mfma_f32_32x32x16_bf16 v[16:31], a[168:171], v[40:43], v[16:31]
  s_waitcnt lgkmcnt(2)
  v_mfma_f32_32x32x16_bf16 v[0:15], a[28:31], v[44:47], v[0:15]
  ds_read_b128 v[40:43], v205 offset:2048
  v_mfma_f32_32x32x16_bf16 v[16:31], a[172:175], v[44:47], v[16:31]
  s_waitcnt lgkmcnt(2)
  v_mfma_f32_32x32x16_bf16 v[0:15], a[32:35], v[32:35], v[0:15]
  ds_read_b128 v[44:47], v206 offset:2048
  v_mfma_f32_32x32x16_bf16 v[16:31], a[176:179], v[32:35], v[16:31]
  s_waitcnt lgkmcnt(2)
  v_mfma_f32_32x32x16_bf16 v[0:15], a[36:39], v[36:39], v[0:15]
  ds_read_b128 v[32:35], v203 offset:3072
  v_mfma_f32_32x32x16_bf16 v[16:31], a[180:183], v[36:39], v[16:31]
  s_waitcnt lgkmcnt(2)
  v_mfma_f32_32x32x16_bf16 v[0:15], a[40:43], v[40:43], v[0:15]
  ds_read_b128 v[36:39], v204 offset:3072
  v_mfma_f32_32x32x16_bf16 v[16:31], a[184:187], v[40:43], v[16:31]
  s_waitcnt lgkmcnt(2)
  v_mfma_f32_32x32x16_bf16 v[0:15], a[44:47], v[44:47], v[0:15]
  ds_read_b128 v[40:43], v205 offset:3072
  v_mfma_f32_32x32x16_bf16 v[16:31], a[188:191], v[44:47], v[16:31]
  s_waitcnt lgkmcnt(2)
  v_mfma_f32_32x32x16_bf16 v[0:15], a[48:51], v[32:35], v[0:15]
  ds_read_b128 v[44:47], v206 offset:3072
  v_mfma_f32_32x32x16_bf16 v[16:31], a[192:195], v[32:35], v[16:31]
  s_waitcnt lgkmcnt(2)
  v_mfma_f32_32x32x16_bf16 v[0:15], a[52:55], v[36:39], v[0:15]
  ds_read_b128 v[32:35], v203 offset:4096
  v_mfma_f32_32x32x16_bf16 v[16:31], a[196:199], v[36:39], v[16:31]
  s_waitcnt lgkmcnt(2)
  v_mfma_f32_32x32x16_bf16 v[0:15], a[56:59], v[40:43], v[0:15]
  ds_read_b128 v[36:39], v204 offset:4096
  v_mfma_f32_32x32x16_bf16 v[16:31], a[200:203], v[40:43], v[16:31]
  s_waitcnt lgkmcnt(2)
  v_mfma_f32_32x32x16_bf16 v[0:15], a[60:63], v[44:47], v[0:15]
  ds_read_b128 v[40:43], v205 offset:4096
  v_mfma_f32_32x32x16_bf16 v[16:31], a[204:207], v[44:47], v[16:31]
  s_waitcnt lgkmcnt(2)
  v_mfma_f32_32x32x16_bf16 v[0:15], a[64:67], v[32:35], v[0:15]
  ds_read_b128 v[44:47], v206 offset:4096
  v_mfma_f32_32x32x16_bf16 v[16:31], a[208:211], v[32:35], v[16:31]
  s_waitcnt lgkmcnt(2)
  v_mfma_f32_32x32x16_bf16 v[0:15], a[68:71], v[36:39], v[0:15]
  ds_read_b128 v[32:35], v203 offset:5120
  v_mfma_f32_32x32x16_bf16 v[16:31], a[212:215], v[36:39], v[16:31]
  s_waitcnt lgkmcnt(2)
  v_mfma_f32_32x32x16_bf16 v[0:15], a[72:75], v[40:43], v[0:15]
  ds_read_b128 v[36:39], v204 offset:5120
  v_mfma_f32_32x32x16_bf16 v[16:31], a[216:219], v[40:43], v[16:31]
  s_waitcnt lgkmcnt(2)
  v_mfma_f32_32x32x16_bf16 v[0:15], a[76:79], v[44:47], v[0:15]
  ds_read_b128 v[40:43], v205 offset:5120
  v_mfma_f32_32x32x16_bf16 v[16:31], a[220:223], v[44:47], v[16:31]
  s_waitcnt lgkmcnt(2)
  v_mfma_f32_32x32x16_bf16 v[0:15], a[80:83], v[32:35], v[0:15]
  ds_read_b128 v[44:47], v206 offset:5120
  v_mfma_f32_32x32x16_bf16 v[16:31], a[224:227], v[32:35], v[16:31]
  s_waitcnt lgkmcnt(2)
  v_mfma_f32_32x32x16_bf16 v[0:15], a[84:87], v[36:39], v[0:15]
  ds_read_b128 v[32:35], v203 offset:6144
  v_mfma_f32_32x32x16_bf16 v[16:31], a[228:231], v[36:39], v[16:31]
  s_waitcnt lgkmcnt(2)
  v_mfma_f32_32x32x16_bf16 v[0:15], a[88:91], v[40:43], v[0:15]
  ds_read_b128 v[36:39], v204 offset:6144
  v_mfma_f32_32x32x16_bf16 v[16:31], a[232:235], v[40:43], v[16:31]
  s_waitcnt lgkmcnt(2)
  v_mfma_f32_32x32x16_bf16 v[0:15], a[92:95], v[44:47], v[0:15]
  ds_read_b128 v[40:43], v205 offset:6144
  v_mfma_f32_32x32x16_bf16 v[16:31], a[236:239], v[44:47], v[16:31]
  s_waitcnt lgkmcnt(2)
  v_mfma_f32_32x32x16_bf16 v[0:15], a[96:99], v[32:35], v[0:15]
  ds_read_b128 v[44:47], v206 offset:6144
  v_mfma_f32_32x32x16_bf16 v[16:31], a[240:243], v[32:35], v[16:31]
  s_waitcnt lgkmcnt(2)
  v_mfma_f32_32x32x16_bf16 v[0:15], a[100:103], v[36:39], v[0:15]
  ds_read_b128 v[32:35], v203 offset:7168
  v_mfma_f32_32x32x16_bf16 v[16:31], a[244:247], v[36:39], v[16:31]
  s_waitcnt lgkmcnt(2)
  v_mfma_f32_32x32x16_bf16 v[0:15], a[104:107], v[40:43], v[0:15]
  ds_read_b128 v[36:39], v204 offset:7168
  v_mfma_f32_32x32x16_bf16 v[16:31], a[248:251], v[40:43], v[16:31]
  s_waitcnt lgkmcnt(2)
  v_mfma_f32_32x32x16_bf16 v[0:15], a[108:111], v[44:47], v[0:15]
  ds_read_b128 v[40:43], v205 offset:7168
  v_mfma_f32_32x32x16_bf16 v[16:31], a[252:255], v[44:47], v[16:31]
  s_waitcnt lgkmcnt(2)
  v_mfma_f32_32x32x16_bf16 v[0:15], a[112:115], v[32:35], v[0:15]
  ds_read_b128 v[44:47], v206 offset:7168
  v_mfma_f32_32x32x16_bf16 v[16:31], v[224:227], v[32:35], v[16:31]
  s_waitcnt lgkmcnt(2)
  v_mfma_f32_32x32x16_bf16 v[0:15], a[116:119], v[36:39], v[0:15]
  ds_read_b128 v[32:35], v203 offset:8192
  v_mfma_f32_32x32x16_bf16 v[16:31], v[228:231], v[36:39], v[16:31]
  s_waitcnt lgkmcnt(2)
  v_mfma_f32_32x32x16_bf16 v[0:15], a[120:123], v[40:43], v[0:15]
  ds_read_b128 v[36:39], v204 offset:8192
  v_mfma_f32_32x32x16_bf16 v[16:31], v[232:235], v[40:43], v[16:31]
  s_waitcnt lgkmcnt(2)
  v_mfma_f32_32x32x16_bf16 v[0:15], a[124:127], v[44:47], v[0:15]
  ds_read_b128 v[40:43], v205 offset:8192
  v_mfma_f32_32x32x16_bf16 v[16:31], v[236:239], v[44:47], v[16:31]
  s_waitcnt lgkmcnt(2)
  v_mfma_f32_32x32x16_bf16 v[0:15], a[128:131], v[32:35], v[0:15]
  ds_read_b128 v[44:47], v206 offset:8192
  v_mfma_f32_32x32x16_bf16 v[16:31], v[240:243], v[32:35], v[16:31]
  s_waitcnt lgkmcnt(2)
  v_mfma_f32_32x32x16_bf16 v[0:15], a[132:135], v[36:39], v[0:15]
  v_mfma_f32_32x32x16_bf16 v[16:31], v[244:247], v[36:39], v[16:31]
  s_waitcnt lgkmcnt(1)
  v_mfma_f32_32x32x16_bf16 v[0:15], a[136:139], v[40:43], v[0:15]
  v_mfma_f32_32x32x16_bf16 v[16:31], v[248:251], v[40:43], v[16:31]
  s_waitcnt lgkmcnt(0)
  v_mfma_f32_32x32x16_bf16 v[0:15], a[140:143], v[44:47], v[0:15]
  v_mfma_f32_32x32x16_bf16 v[16:31], v[252:255], v[44:47], v[16:31]
  s_nop 3
  v_cvt_pk_bf16_f32 v48, v0, v1
  v_cvt_pk_bf16_f32 v49, v2, v3
  ds_write2_b32 v218, v48, v49 offset0:0 offset1:1
  v_cvt_pk_bf16_f32 v48, v4, v5
  v_cvt_pk_bf16_f32 v49, v6, v7
  ds_write2_b32 v218, v48, v49 offset0:4 offset1:5
  v_cvt_pk_bf16_f32 v48, v8, v9
  v_cvt_pk_bf16_f32 v49, v10, v11
  ds_write2_b32 v218, v48, v49 offset0:8 offset1:9
  v_cvt_pk_bf16_f32 v48, v12, v13
  v_cvt_pk_bf16_f32 v49, v14, v15
  ds_write2_b32 v218, v48, v49 offset0:12 offset1:13
  v_cvt_pk_bf16_f32 v48, v16, v17
  v_cvt_pk_bf16_f32 v49, v18, v19
  ds_write2_b32 v218, v48, v49 offset0:64 offset1:65
  v_cvt_pk_bf16_f32 v48, v20, v21
  v_cvt_pk_bf16_f32 v49, v22, v23
  ds_write2_b32 v218, v48, v49 offset0:68 offset1:69
  v_cvt_pk_bf16_f32 v48, v24, v25
  v_cvt_pk_bf16_f32 v49, v26, v27
  ds_write2_b32 v218, v48, v49 offset0:72 offset1:73
  v_cvt_pk_bf16_f32 v48, v28, v29
  v_cvt_pk_bf16_f32 v49, v30, v31
  ds_write2_b32 v218, v48, v49 offset0:76 offset1:77
  v_add_u32 v218, 16512, v218
  s_waitcnt vmcnt(0) lgkmcnt(0)
  s_barrier
  v_mul_u32_u24 v219, 516, v200
  s_mul_i32 s54, s52, 36
  s_add_u32 s55, s54, 83016
  v_add_u32 v219, s55, v219
  v_mul_u32_u24 v220, 1152, v200
  s_mul_i32 s55, s68, 144
  s_add_u32 s54, s54, s55
  s_mul_i32 s55, s69, 147456
  s_add_u32 s64, s54, s55
  s_add_u32 s64, s64, 62914560
  s_lshl_b32 s66, s69, 7
  s_mov_b32 s57, 1051597459
  ds_read_b32 v0, v219 offset:7224
  ds_read_b32 v1, v219 offset:7228
  ds_read_b32 v2, v219 offset:7232
  ds_read_b32 v3, v219 offset:7236
  ds_read_b32 v4, v219 offset:7240
  ds_read_b32 v5, v219 offset:7244
  ds_read_b32 v6, v219 offset:7248
  ds_read_b32 v7, v219 offset:7252
  ds_read_b32 v8, v219 offset:7256
  ds_read_b32 v16, v219 offset:7368
  ds_read_b32 v17, v219 offset:7372
  ds_read_b32 v18, v219 offset:7376
  ds_read_b32 v19, v219 offset:7380
  ds_read_b32 v20, v219 offset:7384
  ds_read_b32 v21, v219 offset:7388
  ds_read_b32 v22, v219 offset:7392
  ds_read_b32 v23, v219 offset:7396
  ds_read_b32 v24, v219 offset:7400
  ds_read_b32 v25, v219 offset:6336
  ds_read_b32 v26, v219 offset:6340
  ds_read_b32 v27, v219 offset:6344
  ds_read_b32 v28, v219 offset:6348
  ds_read_b32 v29, v219 offset:6352
  ds_read_b32 v30, v219 offset:6356
  ds_read_b32 v31, v219 offset:6360
  ds_read_b32 v32, v219 offset:6364
  ds_read_b32 v33, v219 offset:6368
  ds_read_b32 v34, v219 offset:5304
  ds_read_b32 v35, v219 offset:5308
  ds_read_b32 v36, v219 offset:5312
  ds_read_b32 v37, v219 offset:5316
  ds_read_b32 v38, v219 offset:5320
  ds_read_b32 v39, v219 offset:5324
  ds_read_b32 v40, v219 offset:5328
  ds_read_b32 v41, v219 offset:5332
  ds_read_b32 v42, v219 offset:5336
  ds_read_b32 v43, v219 offset:4272
  ds_read_b32 v44, v219 offset:4276
  ds_read_b32 v45, v219 offset:4280
  ds_read_b32 v46, v219 offset:4284
  ds_read_b32 v47, v219 offset:4288
  ds_read_b32 v48, v219 offset:4292
  ds_read_b32 v49, v219 offset:4296
  ds_read_b32 v50, v219 offset:4300
  ds_read_b32 v51, v219 offset:4304
  ds_read_b32 v52, v219 offset:3240
  ds_read_b32 v53, v219 offset:3244
  ds_read_b32 v54, v219 offset:3248
  ds_read_b32 v55, v219 offset:3252
  ds_read_b32 v56, v219 offset:3256
  ds_read_b32 v57, v219 offset:3260
  ds_read_b32 v58, v219 offset:3264
  ds_read_b32 v59, v219 offset:3268
  ds_read_b32 v60, v219 offset:3272
  ds_read_b32 v61, v219 offset:2208
  ds_read_b32 v62, v219 offset:2212
  ds_read_b32 v63, v219 offset:2216
  ds_read_b32 v64, v219 offset:2220
  ds_read_b32 v65, v219 offset:2224
  ds_read_b32 v66, v219 offset:2228
  ds_read_b32 v67, v219 offset:2232
  ds_read_b32 v68, v219 offset:2236
  ds_read_b32 v69, v219 offset:2240
  ds_read_b32 v70, v219 offset:1176
  ds_read_b32 v71, v219 offset:1180
  ds_read_b32 v72, v219 offset:1184
  ds_read_b32 v73, v219 offset:1188
  ds_read_b32 v74, v219 offset:1192
  ds_read_b32 v75, v219 offset:1196
  ds_read_b32 v76, v219 offset:1200
  ds_read_b32 v77, v219 offset:1204
  ds_read_b32 v78, v219 offset:1208
  ds_read_b32 v79, v219 offset:144
  ds_read_b32 v80, v219 offset:148
  ds_read_b32 v81, v219 offset:152
  ds_read_b32 v82, v219 offset:156
  ds_read_b32 v83, v219 offset:160
  ds_read_b32 v84, v219 offset:164
  ds_read_b32 v85, v219 offset:168
  ds_read_b32 v86, v219 offset:172
  ds_read_b32 v87, v219 offset:176
  v_mov_b32 v100, 0
  v_mov_b32 v101, 0
  v_mov_b32 v102, 0
  v_mov_b32 v103, 0
  v_mov_b32 v104, 0
  v_mov_b32 v105, 0
  v_mov_b32 v106, 0
  v_mov_b32 v107, 0
  s_waitcnt lgkmcnt(15)
  v_dot2c_f32_bf16 v100, v0, v16
  v_dot2c_f32_bf16 v101, v0, v25
  v_dot2c_f32_bf16 v102, v0, v34
  v_dot2c_f32_bf16 v103, v0, v43
  v_dot2c_f32_bf16 v104, v0, v52
  v_dot2c_f32_bf16 v105, v0, v61
  v_dot2c_f32_bf16 v106, v0, v70
  s_waitcnt lgkmcnt(8)
  v_dot2c_f32_bf16 v107, v0, v79
  v_dot2c_f32_bf16 v100, v1, v17
  v_dot2c_f32_bf16 v101, v1, v26
  v_dot2c_f32_bf16 v102, v1, v35
  v_dot2c_f32_bf16 v103, v1, v44
  v_dot2c_f32_bf16 v104, v1, v53
  v_dot2c_f32_bf16 v105, v1, v62
  v_dot2c_f32_bf16 v106, v1, v71
  s_waitcnt lgkmcnt(7)
  v_dot2c_f32_bf16 v107, v1, v80
  v_dot2c_f32_bf16 v100, v2, v18
  v_dot2c_f32_bf16 v101, v2, v27
  v_dot2c_f32_bf16 v102, v2, v36
  v_dot2c_f32_bf16 v103, v2, v45
  v_dot2c_f32_bf16 v104, v2, v54
  v_dot2c_f32_bf16 v105, v2, v63
  v_dot2c_f32_bf16 v106, v2, v72
  s_waitcnt lgkmcnt(6)
  v_dot2c_f32_bf16 v107, v2, v81
  v_dot2c_f32_bf16 v100, v3, v19
  v_dot2c_f32_bf16 v101, v3, v28
  v_dot2c_f32_bf16 v102, v3, v37
  v_dot2c_f32_bf16 v103, v3, v46
  v_dot2c_f32_bf16 v104, v3, v55
  v_dot2c_f32_bf16 v105, v3, v64
  v_dot2c_f32_bf16 v106, v3, v73
  s_waitcnt lgkmcnt(5)
  v_dot2c_f32_bf16 v107, v3, v82
  v_dot2c_f32_bf16 v100, v4, v20
  v_dot2c_f32_bf16 v101, v4, v29
  v_dot2c_f32_bf16 v102, v4, v38
  v_dot2c_f32_bf16 v103, v4, v47
  v_dot2c_f32_bf16 v104, v4, v56
  v_dot2c_f32_bf16 v105, v4, v65
  v_dot2c_f32_bf16 v106, v4, v74
  s_waitcnt lgkmcnt(4)
  v_dot2c_f32_bf16 v107, v4, v83
  v_dot2c_f32_bf16 v100, v5, v21
  v_dot2c_f32_bf16 v101, v5, v30
  v_dot2c_f32_bf16 v102, v5, v39
  v_dot2c_f32_bf16 v103, v5, v48
  v_dot2c_f32_bf16 v104, v5, v57
  v_dot2c_f32_bf16 v105, v5, v66
  v_dot2c_f32_bf16 v106, v5, v75
  s_waitcnt lgkmcnt(3)
  v_dot2c_f32_bf16 v107, v5, v84
  v_dot2c_f32_bf16 v100, v6, v22
  v_dot2c_f32_bf16 v101, v6, v31
  v_dot2c_f32_bf16 v102, v6, v40
  v_dot2c_f32_bf16 v103, v6, v49
  v_dot2c_f32_bf16 v104, v6, v58
  v_dot2c_f32_bf16 v105, v6, v67
  v_dot2c_f32_bf16 v106, v6, v76
  s_waitcnt lgkmcnt(2)
  v_dot2c_f32_bf16 v107, v6, v85
  v_dot2c_f32_bf16 v100, v7, v23
  v_dot2c_f32_bf16 v101, v7, v32
  v_dot2c_f32_bf16 v102, v7, v41
  v_dot2c_f32_bf16 v103, v7, v50
  v_dot2c_f32_bf16 v104, v7, v59
  v_dot2c_f32_bf16 v105, v7, v68
  v_dot2c_f32_bf16 v106, v7, v77
  s_waitcnt lgkmcnt(1)
  v_dot2c_f32_bf16 v107, v7, v86
  v_dot2c_f32_bf16 v100, v8, v24
  v_dot2c_f32_bf16 v101, v8, v33
  v_dot2c_f32_bf16 v102, v8, v42
  v_dot2c_f32_bf16 v103, v8, v51
  v_dot2c_f32_bf16 v104, v8, v60
  v_dot2c_f32_bf16 v105, v8, v69
  v_dot2c_f32_bf16 v106, v8, v78
  s_waitcnt lgkmcnt(0)
  v_dot2c_f32_bf16 v107, v8, v87
  ds_read_b32 v16, v219 offset:7512
  ds_read_b32 v17, v219 offset:7516
  ds_read_b32 v18, v219 offset:7520
  ds_read_b32 v19, v219 offset:7524
  ds_read_b32 v20, v219 offset:7528
  ds_read_b32 v21, v219 offset:7532
  ds_read_b32 v22, v219 offset:7536
  ds_read_b32 v23, v219 offset:7540
  ds_read_b32 v24, v219 offset:7544
  ds_read_b32 v25, v219 offset:6480
  ds_read_b32 v26, v219 offset:6484
  ds_read_b32 v27, v219 offset:6488
  ds_read_b32 v28, v219 offset:6492
  ds_read_b32 v29, v219 offset:6496
  ds_read_b32 v30, v219 offset:6500
  ds_read_b32 v31, v219 offset:6504
  ds_read_b32 v32, v219 offset:6508
  ds_read_b32 v33, v219 offset:6512
  ds_read_b32 v34, v219 offset:5448
  ds_read_b32 v35, v219 offset:5452
  ds_read_b32 v36, v219 offset:5456
  ds_read_b32 v37, v219 offset:5460
  ds_read_b32 v38, v219 offset:5464
  ds_read_b32 v39, v219 offset:5468
  ds_read_b32 v40, v219 offset:5472
  ds_read_b32 v41, v219 offset:5476
  ds_read_b32 v42, v219 offset:5480
  ds_read_b32 v43, v219 offset:4416
  ds_read_b32 v44, v219 offset:4420
  ds_read_b32 v45, v219 offset:4424
  ds_read_b32 v46, v219 offset:4428
  ds_read_b32 v47, v219 offset:4432
  ds_read_b32 v48, v219 offset:4436
  ds_read_b32 v49, v219 offset:4440
  ds_read_b32 v50, v219 offset:4444
  ds_read_b32 v51, v219 offset:4448
  ds_read_b32 v52, v219 offset:3384
  ds_read_b32 v53, v219 offset:3388
  ds_read_b32 v54, v219 offset:3392
  ds_read_b32 v55, v219 offset:3396
  ds_read_b32 v56, v219 offset:3400
  ds_read_b32 v57, v219 offset:3404
  ds_read_b32 v58, v219 offset:3408
  ds_read_b32 v59, v219 offset:3412
  ds_read_b32 v60, v219 offset:3416
  ds_read_b32 v61, v219 offset:2352
  ds_read_b32 v62, v219 offset:2356
  ds_read_b32 v63, v219 offset:2360
  ds_read_b32 v64, v219 offset:2364
  ds_read_b32 v65, v219 offset:2368
  ds_read_b32 v66, v219 offset:2372
  ds_read_b32 v67, v219 offset:2376
  ds_read_b32 v68, v219 offset:2380
  ds_read_b32 v69, v219 offset:2384
  ds_read_b32 v70, v219 offset:1320
  ds_read_b32 v71, v219 offset:1324
  ds_read_b32 v72, v219 offset:1328
  ds_read_b32 v73, v219 offset:1332
  ds_read_b32 v74, v219 offset:1336
  ds_read_b32 v75, v219 offset:1340
  ds_read_b32 v76, v219 offset:1344
  ds_read_b32 v77, v219 offset:1348
  ds_read_b32 v78, v219 offset:1352
  ds_read_b32 v79, v219 offset:288
  ds_read_b32 v80, v219 offset:292
  ds_read_b32 v81, v219 offset:296
  ds_read_b32 v82, v219 offset:300
  ds_read_b32 v83, v219 offset:304
  ds_read_b32 v84, v219 offset:308
  ds_read_b32 v85, v219 offset:312
  ds_read_b32 v86, v219 offset:316
  ds_read_b32 v87, v219 offset:320
  v_add_u32 v211, s66, v200
  v_mov_b32 v212, 0xf149f2ca
  v_mul_f32 v100, s57, v100
  v_mul_f32 v101, s57, v101
  v_mul_f32 v102, s57, v102
  v_mul_f32 v103, s57, v103
  v_mul_f32 v104, s57, v104
  v_mul_f32 v105, s57, v105
  v_mul_f32 v106, s57, v106
  v_mul_f32 v107, s57, v107
  v_cmp_gt_u32 vcc, 2, v211
  s_nop 1
  v_cndmask_b32 v101, v101, v212, vcc
  v_cmp_gt_u32 vcc, 4, v211
  s_nop 1
  v_cndmask_b32 v102, v102, v212, vcc
  v_cmp_gt_u32 vcc, 6, v211
  s_nop 1
  v_cndmask_b32 v103, v103, v212, vcc
  v_cmp_gt_u32 vcc, 8, v211
  s_nop 1
  v_cndmask_b32 v104, v104, v212, vcc
  v_cmp_gt_u32 vcc, 10, v211
  s_nop 1
  v_cndmask_b32 v105, v105, v212, vcc
  v_cmp_gt_u32 vcc, 12, v211
  s_nop 1
  v_cndmask_b32 v106, v106, v212, vcc
  v_cmp_gt_u32 vcc, 14, v211
  s_nop 1
  v_cndmask_b32 v107, v107, v212, vcc
  v_max3_f32 v213, v100, v101, v102
  v_max3_f32 v213, v213, v103, v104
  v_max3_f32 v213, v213, v105, v106
  v_max_f32 v213, v213, v107
  v_sub_f32 v100, v100, v213
  v_sub_f32 v101, v101, v213
  v_sub_f32 v102, v102, v213
  v_sub_f32 v103, v103, v213
  v_sub_f32 v104, v104, v213
  v_sub_f32 v105, v105, v213
  v_sub_f32 v106, v106, v213
  v_sub_f32 v107, v107, v213
  v_exp_f32 v100, v100
  v_exp_f32 v101, v101
  v_exp_f32 v102, v102
  v_exp_f32 v103, v103
  v_exp_f32 v104, v104
  v_exp_f32 v105, v105
  v_exp_f32 v106, v106
  v_exp_f32 v107, v107
  v_add_f32 v213, v100, v101
  v_add_f32 v213, v213, v102
  v_add_f32 v213, v213, v103
  v_add_f32 v213, v213, v104
  v_add_f32 v213, v213, v105
  v_add_f32 v213, v213, v106
  v_add_f32 v213, v213, v107
  v_rcp_f32 v213, v213
  v_mov_b32 v214, 0
  v_mul_f32 v100, v213, v100
  v_mul_f32 v101, v213, v101
  v_mul_f32 v102, v213, v102
  v_mul_f32 v103, v213, v103
  v_mul_f32 v104, v213, v104
  v_mul_f32 v105, v213, v105
  v_mul_f32 v106, v213, v106
  v_mul_f32 v107, v213, v107
  v_mov_b32 v112, 0
  v_mov_b32 v113, 0
  v_mov_b32 v114, 0
  v_mov_b32 v115, 0
  v_mov_b32 v116, 0
  v_mov_b32 v117, 0
  v_mov_b32 v118, 0
  v_mov_b32 v119, 0
  v_mov_b32 v120, 0
  v_mov_b32 v121, 0
  v_mov_b32 v122, 0
  v_mov_b32 v123, 0
  v_mov_b32 v124, 0
  v_mov_b32 v125, 0
  v_mov_b32 v126, 0
  v_mov_b32 v127, 0
  v_mov_b32 v128, 0
  v_mov_b32 v129, 0
  v_cvt_pk_bf16_f32 v0, v100, v214
  v_cvt_pk_bf16_f32 v1, v214, v100
  s_waitcnt lgkmcnt(15)
  v_dot2c_f32_bf16 v112, v16, v0
  v_dot2c_f32_bf16 v113, v16, v1
  v_dot2c_f32_bf16 v114, v17, v0
  v_dot2c_f32_bf16 v115, v17, v1
  v_dot2c_f32_bf16 v116, v18, v0
  v_dot2c_f32_bf16 v117, v18, v1
  v_dot2c_f32_bf16 v118, v19, v0
  v_dot2c_f32_bf16 v119, v19, v1
  v_dot2c_f32_bf16 v120, v20, v0
  v_dot2c_f32_bf16 v121, v20, v1
  v_dot2c_f32_bf16 v122, v21, v0
  v_dot2c_f32_bf16 v123, v21, v1
  v_dot2c_f32_bf16 v124, v22, v0
  v_dot2c_f32_bf16 v125, v22, v1
  v_dot2c_f32_bf16 v126, v23, v0
  v_dot2c_f32_bf16 v127, v23, v1
  v_dot2c_f32_bf16 v128, v24, v0
  v_dot2c_f32_bf16 v129, v24, v1
  v_cvt_pk_bf16_f32 v2, v101, v214
  v_cvt_pk_bf16_f32 v3, v214, v101
  v_dot2c_f32_bf16 v112, v25, v2
  v_dot2c_f32_bf16 v113, v25, v3
  v_dot2c_f32_bf16 v114, v26, v2
  v_dot2c_f32_bf16 v115, v26, v3
  v_dot2c_f32_bf16 v116, v27, v2
  v_dot2c_f32_bf16 v117, v27, v3
  v_dot2c_f32_bf16 v118, v28, v2
  v_dot2c_f32_bf16 v119, v28, v3
  v_dot2c_f32_bf16 v120, v29, v2
  v_dot2c_f32_bf16 v121, v29, v3
  v_dot2c_f32_bf16 v122, v30, v2
  v_dot2c_f32_bf16 v123, v30, v3
  v_dot2c_f32_bf16 v124, v31, v2
  v_dot2c_f32_bf16 v125, v31, v3
  v_dot2c_f32_bf16 v126, v32, v2
  v_dot2c_f32_bf16 v127, v32, v3
  v_dot2c_f32_bf16 v128, v33, v2
  v_dot2c_f32_bf16 v129, v33, v3
  v_cvt_pk_bf16_f32 v0, v102, v214
  v_cvt_pk_bf16_f32 v1, v214, v102
  v_dot2c_f32_bf16 v112, v34, v0
  v_dot2c_f32_bf16 v113, v34, v1
  v_dot2c_f32_bf16 v114, v35, v0
  v_dot2c_f32_bf16 v115, v35, v1
  v_dot2c_f32_bf16 v116, v36, v0
  v_dot2c_f32_bf16 v117, v36, v1
  v_dot2c_f32_bf16 v118, v37, v0
  v_dot2c_f32_bf16 v119, v37, v1
  v_dot2c_f32_bf16 v120, v38, v0
  v_dot2c_f32_bf16 v121, v38, v1
  v_dot2c_f32_bf16 v122, v39, v0
  v_dot2c_f32_bf16 v123, v39, v1
  v_dot2c_f32_bf16 v124, v40, v0
  v_dot2c_f32_bf16 v125, v40, v1
  v_dot2c_f32_bf16 v126, v41, v0
  v_dot2c_f32_bf16 v127, v41, v1
  v_dot2c_f32_bf16 v128, v42, v0
  v_dot2c_f32_bf16 v129, v42, v1
  v_cvt_pk_bf16_f32 v2, v103, v214
  v_cvt_pk_bf16_f32 v3, v214, v103
  v_dot2c_f32_bf16 v112, v43, v2
  v_dot2c_f32_bf16 v113, v43, v3
  v_dot2c_f32_bf16 v114, v44, v2
  v_dot2c_f32_bf16 v115, v44, v3
  v_dot2c_f32_bf16 v116, v45, v2
  v_dot2c_f32_bf16 v117, v45, v3
  v_dot2c_f32_bf16 v118, v46, v2
  v_dot2c_f32_bf16 v119, v46, v3
  v_dot2c_f32_bf16 v120, v47, v2
  v_dot2c_f32_bf16 v121, v47, v3
  v_dot2c_f32_bf16 v122, v48, v2
  v_dot2c_f32_bf16 v123, v48, v3
  v_dot2c_f32_bf16 v124, v49, v2
  v_dot2c_f32_bf16 v125, v49, v3
  v_dot2c_f32_bf16 v126, v50, v2
  v_dot2c_f32_bf16 v127, v50, v3
  v_dot2c_f32_bf16 v128, v51, v2
  v_dot2c_f32_bf16 v129, v51, v3
  v_cvt_pk_bf16_f32 v0, v104, v214
  v_cvt_pk_bf16_f32 v1, v214, v104
  v_dot2c_f32_bf16 v112, v52, v0
  v_dot2c_f32_bf16 v113, v52, v1
  v_dot2c_f32_bf16 v114, v53, v0
  v_dot2c_f32_bf16 v115, v53, v1
  v_dot2c_f32_bf16 v116, v54, v0
  v_dot2c_f32_bf16 v117, v54, v1
  v_dot2c_f32_bf16 v118, v55, v0
  v_dot2c_f32_bf16 v119, v55, v1
  v_dot2c_f32_bf16 v120, v56, v0
  v_dot2c_f32_bf16 v121, v56, v1
  v_dot2c_f32_bf16 v122, v57, v0
  v_dot2c_f32_bf16 v123, v57, v1
  v_dot2c_f32_bf16 v124, v58, v0
  v_dot2c_f32_bf16 v125, v58, v1
  v_dot2c_f32_bf16 v126, v59, v0
  v_dot2c_f32_bf16 v127, v59, v1
  v_dot2c_f32_bf16 v128, v60, v0
  v_dot2c_f32_bf16 v129, v60, v1
  v_cvt_pk_bf16_f32 v2, v105, v214
  v_cvt_pk_bf16_f32 v3, v214, v105
  v_dot2c_f32_bf16 v112, v61, v2
  v_dot2c_f32_bf16 v113, v61, v3
  v_dot2c_f32_bf16 v114, v62, v2
  v_dot2c_f32_bf16 v115, v62, v3
  v_dot2c_f32_bf16 v116, v63, v2
  v_dot2c_f32_bf16 v117, v63, v3
  v_dot2c_f32_bf16 v118, v64, v2
  v_dot2c_f32_bf16 v119, v64, v3
  v_dot2c_f32_bf16 v120, v65, v2
  v_dot2c_f32_bf16 v121, v65, v3
  v_dot2c_f32_bf16 v122, v66, v2
  v_dot2c_f32_bf16 v123, v66, v3
  v_dot2c_f32_bf16 v124, v67, v2
  v_dot2c_f32_bf16 v125, v67, v3
  v_dot2c_f32_bf16 v126, v68, v2
  v_dot2c_f32_bf16 v127, v68, v3
  v_dot2c_f32_bf16 v128, v69, v2
  v_dot2c_f32_bf16 v129, v69, v3
  v_cvt_pk_bf16_f32 v0, v106, v214
  v_cvt_pk_bf16_f32 v1, v214, v106
  v_dot2c_f32_bf16 v112, v70, v0
  v_dot2c_f32_bf16 v113, v70, v1
  v_dot2c_f32_bf16 v114, v71, v0
  v_dot2c_f32_bf16 v115, v71, v1
  v_dot2c_f32_bf16 v116, v72, v0
  v_dot2c_f32_bf16 v117, v72, v1
  s_waitcnt lgkmcnt(14)
  v_dot2c_f32_bf16 v118, v73, v0
  v_dot2c_f32_bf16 v119, v73, v1
  s_waitcnt lgkmcnt(13)
  v_dot2c_f32_bf16 v120, v74, v0
  v_dot2c_f32_bf16 v121, v74, v1
  s_waitcnt lgkmcnt(12)
  v_dot2c_f32_bf16 v122, v75, v0
  v_dot2c_f32_bf16 v123, v75, v1
  s_waitcnt lgkmcnt(11)
  v_dot2c_f32_bf16 v124, v76, v0
  v_dot2c_f32_bf16 v125, v76, v1
  s_waitcnt lgkmcnt(10)
  v_dot2c_f32_bf16 v126, v77, v0
  v_dot2c_f32_bf16 v127, v77, v1
  s_waitcnt lgkmcnt(9)
  v_dot2c_f32_bf16 v128, v78, v0
  v_dot2c_f32_bf16 v129, v78, v1
  v_cvt_pk_bf16_f32 v2, v107, v214
  v_cvt_pk_bf16_f32 v3, v214, v107
  s_waitcnt lgkmcnt(8)
  v_dot2c_f32_bf16 v112, v79, v2
  v_dot2c_f32_bf16 v113, v79, v3
  s_waitcnt lgkmcnt(7)
  v_dot2c_f32_bf16 v114, v80, v2
  v_dot2c_f32_bf16 v115, v80, v3
  s_waitcnt lgkmcnt(6)
  v_dot2c_f32_bf16 v116, v81, v2
  v_dot2c_f32_bf16 v117, v81, v3
  s_waitcnt lgkmcnt(5)
  v_dot2c_f32_bf16 v118, v82, v2
  v_dot2c_f32_bf16 v119, v82, v3
  s_waitcnt lgkmcnt(4)
  v_dot2c_f32_bf16 v120, v83, v2
  v_dot2c_f32_bf16 v121, v83, v3
  s_waitcnt lgkmcnt(3)
  v_dot2c_f32_bf16 v122, v84, v2
  v_dot2c_f32_bf16 v123, v84, v3
  s_waitcnt lgkmcnt(2)
  v_dot2c_f32_bf16 v124, v85, v2
  v_dot2c_f32_bf16 v125, v85, v3
  s_waitcnt lgkmcnt(1)
  v_dot2c_f32_bf16 v126, v86, v2
  v_dot2c_f32_bf16 v127, v86, v3
  s_waitcnt lgkmcnt(0)
  v_dot2c_f32_bf16 v128, v87, v2
  v_dot2c_f32_bf16 v129, v87, v3
  v_cvt_pk_bf16_f32 v132, v112, v113
  v_cvt_pk_bf16_f32 v133, v114, v115
  v_cvt_pk_bf16_f32 v134, v116, v117
  v_cvt_pk_bf16_f32 v135, v118, v119
  v_cvt_pk_bf16_f32 v136, v120, v121
  v_cvt_pk_bf16_f32 v137, v122, v123
  v_cvt_pk_bf16_f32 v138, v124, v125
  v_cvt_pk_bf16_f32 v139, v126, v127
  v_cvt_pk_bf16_f32 v140, v128, v129
  buffer_store_dwordx4 v[132:135], v220, s[8:11], s64 offen sc1
  buffer_store_dwordx4 v[136:139], v220, s[8:11], s64 offen offset:16 sc1
  buffer_store_dword v140, v220, s[8:11], s64 offen offset:32 sc1
  v_add_u32 v219, 33024, v219
  s_add_u32 s66, s66, 64
  s_add_u32 s64, s64, 73728
  ds_read_b32 v0, v219 offset:7224
  ds_read_b32 v1, v219 offset:7228
  ds_read_b32 v2, v219 offset:7232
  ds_read_b32 v3, v219 offset:7236
  ds_read_b32 v4, v219 offset:7240
  ds_read_b32 v5, v219 offset:7244
  ds_read_b32 v6, v219 offset:7248
  ds_read_b32 v7, v219 offset:7252
  ds_read_b32 v8, v219 offset:7256
  ds_read_b32 v16, v219 offset:7368
  ds_read_b32 v17, v219 offset:7372
  ds_read_b32 v18, v219 offset:7376
  ds_read_b32 v19, v219 offset:7380
  ds_read_b32 v20, v219 offset:7384
  ds_read_b32 v21, v219 offset:7388
  ds_read_b32 v22, v219 offset:7392
  ds_read_b32 v23, v219 offset:7396
  ds_read_b32 v24, v219 offset:7400
  ds_read_b32 v25, v219 offset:6336
  ds_read_b32 v26, v219 offset:6340
  ds_read_b32 v27, v219 offset:6344
  ds_read_b32 v28, v219 offset:6348
  ds_read_b32 v29, v219 offset:6352
  ds_read_b32 v30, v219 offset:6356
  ds_read_b32 v31, v219 offset:6360
  ds_read_b32 v32, v219 offset:6364
  ds_read_b32 v33, v219 offset:6368
  ds_read_b32 v34, v219 offset:5304
  ds_read_b32 v35, v219 offset:5308
  ds_read_b32 v36, v219 offset:5312
  ds_read_b32 v37, v219 offset:5316
  ds_read_b32 v38, v219 offset:5320
  ds_read_b32 v39, v219 offset:5324
  ds_read_b32 v40, v219 offset:5328
  ds_read_b32 v41, v219 offset:5332
  ds_read_b32 v42, v219 offset:5336
  ds_read_b32 v43, v219 offset:4272
  ds_read_b32 v44, v219 offset:4276
  ds_read_b32 v45, v219 offset:4280
  ds_read_b32 v46, v219 offset:4284
  ds_read_b32 v47, v219 offset:4288
  ds_read_b32 v48, v219 offset:4292
  ds_read_b32 v49, v219 offset:4296
  ds_read_b32 v50, v219 offset:4300
  ds_read_b32 v51, v219 offset:4304
  ds_read_b32 v52, v219 offset:3240
  ds_read_b32 v53, v219 offset:3244
  ds_read_b32 v54, v219 offset:3248
  ds_read_b32 v55, v219 offset:3252
  ds_read_b32 v56, v219 offset:3256
  ds_read_b32 v57, v219 offset:3260
  ds_read_b32 v58, v219 offset:3264
  ds_read_b32 v59, v219 offset:3268
  ds_read_b32 v60, v219 offset:3272
  ds_read_b32 v61, v219 offset:2208
  ds_read_b32 v62, v219 offset:2212
  ds_read_b32 v63, v219 offset:2216
  ds_read_b32 v64, v219 offset:2220
  ds_read_b32 v65, v219 offset:2224
  ds_read_b32 v66, v219 offset:2228
  ds_read_b32 v67, v219 offset:2232
  ds_read_b32 v68, v219 offset:2236
  ds_read_b32 v69, v219 offset:2240
  ds_read_b32 v70, v219 offset:1176
  ds_read_b32 v71, v219 offset:1180
  ds_read_b32 v72, v219 offset:1184
  ds_read_b32 v73, v219 offset:1188
  ds_read_b32 v74, v219 offset:1192
  ds_read_b32 v75, v219 offset:1196
  ds_read_b32 v76, v219 offset:1200
  ds_read_b32 v77, v219 offset:1204
  ds_read_b32 v78, v219 offset:1208
  ds_read_b32 v79, v219 offset:144
  ds_read_b32 v80, v219 offset:148
  ds_read_b32 v81, v219 offset:152
  ds_read_b32 v82, v219 offset:156
  ds_read_b32 v83, v219 offset:160
  ds_read_b32 v84, v219 offset:164
  ds_read_b32 v85, v219 offset:168
  ds_read_b32 v86, v219 offset:172
  ds_read_b32 v87, v219 offset:176
  v_mov_b32 v100, 0
  v_mov_b32 v101, 0
  v_mov_b32 v102, 0
  v_mov_b32 v103, 0
  v_mov_b32 v104, 0
  v_mov_b32 v105, 0
  v_mov_b32 v106, 0
  v_mov_b32 v107, 0
  s_waitcnt lgkmcnt(15)
  v_dot2c_f32_bf16 v100, v0, v16
  v_dot2c_f32_bf16 v101, v0, v25
  v_dot2c_f32_bf16 v102, v0, v34
  v_dot2c_f32_bf16 v103, v0, v43
  v_dot2c_f32_bf16 v104, v0, v52
  v_dot2c_f32_bf16 v105, v0, v61
  v_dot2c_f32_bf16 v106, v0, v70
  s_waitcnt lgkmcnt(8)
  v_dot2c_f32_bf16 v107, v0, v79
  v_dot2c_f32_bf16 v100, v1, v17
  v_dot2c_f32_bf16 v101, v1, v26
  v_dot2c_f32_bf16 v102, v1, v35
  v_dot2c_f32_bf16 v103, v1, v44
  v_dot2c_f32_bf16 v104, v1, v53
  v_dot2c_f32_bf16 v105, v1, v62
  v_dot2c_f32_bf16 v106, v1, v71
  s_waitcnt lgkmcnt(7)
  v_dot2c_f32_bf16 v107, v1, v80
  v_dot2c_f32_bf16 v100, v2, v18
  v_dot2c_f32_bf16 v101, v2, v27
  v_dot2c_f32_bf16 v102, v2, v36
  v_dot2c_f32_bf16 v103, v2, v45
  v_dot2c_f32_bf16 v104, v2, v54
  v_dot2c_f32_bf16 v105, v2, v63
  v_dot2c_f32_bf16 v106, v2, v72
  s_waitcnt lgkmcnt(6)
  v_dot2c_f32_bf16 v107, v2, v81
  v_dot2c_f32_bf16 v100, v3, v19
  v_dot2c_f32_bf16 v101, v3, v28
  v_dot2c_f32_bf16 v102, v3, v37
  v_dot2c_f32_bf16 v103, v3, v46
  v_dot2c_f32_bf16 v104, v3, v55
  v_dot2c_f32_bf16 v105, v3, v64
  v_dot2c_f32_bf16 v106, v3, v73
  s_waitcnt lgkmcnt(5)
  v_dot2c_f32_bf16 v107, v3, v82
  v_dot2c_f32_bf16 v100, v4, v20
  v_dot2c_f32_bf16 v101, v4, v29
  v_dot2c_f32_bf16 v102, v4, v38
  v_dot2c_f32_bf16 v103, v4, v47
  v_dot2c_f32_bf16 v104, v4, v56
  v_dot2c_f32_bf16 v105, v4, v65
  v_dot2c_f32_bf16 v106, v4, v74
  s_waitcnt lgkmcnt(4)
  v_dot2c_f32_bf16 v107, v4, v83
  v_dot2c_f32_bf16 v100, v5, v21
  v_dot2c_f32_bf16 v101, v5, v30
  v_dot2c_f32_bf16 v102, v5, v39
  v_dot2c_f32_bf16 v103, v5, v48
  v_dot2c_f32_bf16 v104, v5, v57
  v_dot2c_f32_bf16 v105, v5, v66
  v_dot2c_f32_bf16 v106, v5, v75
  s_waitcnt lgkmcnt(3)
  v_dot2c_f32_bf16 v107, v5, v84
  v_dot2c_f32_bf16 v100, v6, v22
  v_dot2c_f32_bf16 v101, v6, v31
  v_dot2c_f32_bf16 v102, v6, v40
  v_dot2c_f32_bf16 v103, v6, v49
  v_dot2c_f32_bf16 v104, v6, v58
  v_dot2c_f32_bf16 v105, v6, v67
  v_dot2c_f32_bf16 v106, v6, v76
  s_waitcnt lgkmcnt(2)
  v_dot2c_f32_bf16 v107, v6, v85
  v_dot2c_f32_bf16 v100, v7, v23
  v_dot2c_f32_bf16 v101, v7, v32
  v_dot2c_f32_bf16 v102, v7, v41
  v_dot2c_f32_bf16 v103, v7, v50
  v_dot2c_f32_bf16 v104, v7, v59
  v_dot2c_f32_bf16 v105, v7, v68
  v_dot2c_f32_bf16 v106, v7, v77
  s_waitcnt lgkmcnt(1)
  v_dot2c_f32_bf16 v107, v7, v86
  v_dot2c_f32_bf16 v100, v8, v24
  v_dot2c_f32_bf16 v101, v8, v33
  v_dot2c_f32_bf16 v102, v8, v42
  v_dot2c_f32_bf16 v103, v8, v51
  v_dot2c_f32_bf16 v104, v8, v60
  v_dot2c_f32_bf16 v105, v8, v69
  v_dot2c_f32_bf16 v106, v8, v78
  s_waitcnt lgkmcnt(0)
  v_dot2c_f32_bf16 v107, v8, v87
  ds_read_b32 v16, v219 offset:7512
  ds_read_b32 v17, v219 offset:7516
  ds_read_b32 v18, v219 offset:7520
  ds_read_b32 v19, v219 offset:7524
  ds_read_b32 v20, v219 offset:7528
  ds_read_b32 v21, v219 offset:7532
  ds_read_b32 v22, v219 offset:7536
  ds_read_b32 v23, v219 offset:7540
  ds_read_b32 v24, v219 offset:7544
  ds_read_b32 v25, v219 offset:6480
  ds_read_b32 v26, v219 offset:6484
  ds_read_b32 v27, v219 offset:6488
  ds_read_b32 v28, v219 offset:6492
  ds_read_b32 v29, v219 offset:6496
  ds_read_b32 v30, v219 offset:6500
  ds_read_b32 v31, v219 offset:6504
  ds_read_b32 v32, v219 offset:6508
  ds_read_b32 v33, v219 offset:6512
  ds_read_b32 v34, v219 offset:5448
  ds_read_b32 v35, v219 offset:5452
  ds_read_b32 v36, v219 offset:5456
  ds_read_b32 v37, v219 offset:5460
  ds_read_b32 v38, v219 offset:5464
  ds_read_b32 v39, v219 offset:5468
  ds_read_b32 v40, v219 offset:5472
  ds_read_b32 v41, v219 offset:5476
  ds_read_b32 v42, v219 offset:5480
  ds_read_b32 v43, v219 offset:4416
  ds_read_b32 v44, v219 offset:4420
  ds_read_b32 v45, v219 offset:4424
  ds_read_b32 v46, v219 offset:4428
  ds_read_b32 v47, v219 offset:4432
  ds_read_b32 v48, v219 offset:4436
  ds_read_b32 v49, v219 offset:4440
  ds_read_b32 v50, v219 offset:4444
  ds_read_b32 v51, v219 offset:4448
  ds_read_b32 v52, v219 offset:3384
  ds_read_b32 v53, v219 offset:3388
  ds_read_b32 v54, v219 offset:3392
  ds_read_b32 v55, v219 offset:3396
  ds_read_b32 v56, v219 offset:3400
  ds_read_b32 v57, v219 offset:3404
  ds_read_b32 v58, v219 offset:3408
  ds_read_b32 v59, v219 offset:3412
  ds_read_b32 v60, v219 offset:3416
  ds_read_b32 v61, v219 offset:2352
  ds_read_b32 v62, v219 offset:2356
  ds_read_b32 v63, v219 offset:2360
  ds_read_b32 v64, v219 offset:2364
  ds_read_b32 v65, v219 offset:2368
  ds_read_b32 v66, v219 offset:2372
  ds_read_b32 v67, v219 offset:2376
  ds_read_b32 v68, v219 offset:2380
  ds_read_b32 v69, v219 offset:2384
  ds_read_b32 v70, v219 offset:1320
  ds_read_b32 v71, v219 offset:1324
  ds_read_b32 v72, v219 offset:1328
  ds_read_b32 v73, v219 offset:1332
  ds_read_b32 v74, v219 offset:1336
  ds_read_b32 v75, v219 offset:1340
  ds_read_b32 v76, v219 offset:1344
  ds_read_b32 v77, v219 offset:1348
  ds_read_b32 v78, v219 offset:1352
  ds_read_b32 v79, v219 offset:288
  ds_read_b32 v80, v219 offset:292
  ds_read_b32 v81, v219 offset:296
  ds_read_b32 v82, v219 offset:300
  ds_read_b32 v83, v219 offset:304
  ds_read_b32 v84, v219 offset:308
  ds_read_b32 v85, v219 offset:312
  ds_read_b32 v86, v219 offset:316
  ds_read_b32 v87, v219 offset:320
  v_add_u32 v211, s66, v200
  v_mov_b32 v212, 0xf149f2ca
  v_mul_f32 v100, s57, v100
  v_mul_f32 v101, s57, v101
  v_mul_f32 v102, s57, v102
  v_mul_f32 v103, s57, v103
  v_mul_f32 v104, s57, v104
  v_mul_f32 v105, s57, v105
  v_mul_f32 v106, s57, v106
  v_mul_f32 v107, s57, v107
  v_cmp_gt_u32 vcc, 2, v211
  s_nop 1
  v_cndmask_b32 v101, v101, v212, vcc
  v_cmp_gt_u32 vcc, 4, v211
  s_nop 1
  v_cndmask_b32 v102, v102, v212, vcc
  v_cmp_gt_u32 vcc, 6, v211
  s_nop 1
  v_cndmask_b32 v103, v103, v212, vcc
  v_cmp_gt_u32 vcc, 8, v211
  s_nop 1
  v_cndmask_b32 v104, v104, v212, vcc
  v_cmp_gt_u32 vcc, 10, v211
  s_nop 1
  v_cndmask_b32 v105, v105, v212, vcc
  v_cmp_gt_u32 vcc, 12, v211
  s_nop 1
  v_cndmask_b32 v106, v106, v212, vcc
  v_cmp_gt_u32 vcc, 14, v211
  s_nop 1
  v_cndmask_b32 v107, v107, v212, vcc
  v_max3_f32 v213, v100, v101, v102
  v_max3_f32 v213, v213, v103, v104
  v_max3_f32 v213, v213, v105, v106
  v_max_f32 v213, v213, v107
  v_sub_f32 v100, v100, v213
  v_sub_f32 v101, v101, v213
  v_sub_f32 v102, v102, v213
  v_sub_f32 v103, v103, v213
  v_sub_f32 v104, v104, v213
  v_sub_f32 v105, v105, v213
  v_sub_f32 v106, v106, v213
  v_sub_f32 v107, v107, v213
  v_exp_f32 v100, v100
  v_exp_f32 v101, v101
  v_exp_f32 v102, v102
  v_exp_f32 v103, v103
  v_exp_f32 v104, v104
  v_exp_f32 v105, v105
  v_exp_f32 v106, v106
  v_exp_f32 v107, v107
  v_add_f32 v213, v100, v101
  v_add_f32 v213, v213, v102
  v_add_f32 v213, v213, v103
  v_add_f32 v213, v213, v104
  v_add_f32 v213, v213, v105
  v_add_f32 v213, v213, v106
  v_add_f32 v213, v213, v107
  v_rcp_f32 v213, v213
  v_mov_b32 v214, 0
  v_mul_f32 v100, v213, v100
  v_mul_f32 v101, v213, v101
  v_mul_f32 v102, v213, v102
  v_mul_f32 v103, v213, v103
  v_mul_f32 v104, v213, v104
  v_mul_f32 v105, v213, v105
  v_mul_f32 v106, v213, v106
  v_mul_f32 v107, v213, v107
  v_mov_b32 v112, 0
  v_mov_b32 v113, 0
  v_mov_b32 v114, 0
  v_mov_b32 v115, 0
  v_mov_b32 v116, 0
  v_mov_b32 v117, 0
  v_mov_b32 v118, 0
  v_mov_b32 v119, 0
  v_mov_b32 v120, 0
  v_mov_b32 v121, 0
  v_mov_b32 v122, 0
  v_mov_b32 v123, 0
  v_mov_b32 v124, 0
  v_mov_b32 v125, 0
  v_mov_b32 v126, 0
  v_mov_b32 v127, 0
  v_mov_b32 v128, 0
  v_mov_b32 v129, 0
  v_cvt_pk_bf16_f32 v0, v100, v214
  v_cvt_pk_bf16_f32 v1, v214, v100
  s_waitcnt lgkmcnt(15)
  v_dot2c_f32_bf16 v112, v16, v0
  v_dot2c_f32_bf16 v113, v16, v1
  v_dot2c_f32_bf16 v114, v17, v0
  v_dot2c_f32_bf16 v115, v17, v1
  v_dot2c_f32_bf16 v116, v18, v0
  v_dot2c_f32_bf16 v117, v18, v1
  v_dot2c_f32_bf16 v118, v19, v0
  v_dot2c_f32_bf16 v119, v19, v1
  v_dot2c_f32_bf16 v120, v20, v0
  v_dot2c_f32_bf16 v121, v20, v1
  v_dot2c_f32_bf16 v122, v21, v0
  v_dot2c_f32_bf16 v123, v21, v1
  v_dot2c_f32_bf16 v124, v22, v0
  v_dot2c_f32_bf16 v125, v22, v1
  v_dot2c_f32_bf16 v126, v23, v0
  v_dot2c_f32_bf16 v127, v23, v1
  v_dot2c_f32_bf16 v128, v24, v0
  v_dot2c_f32_bf16 v129, v24, v1
  v_cvt_pk_bf16_f32 v2, v101, v214
  v_cvt_pk_bf16_f32 v3, v214, v101
  v_dot2c_f32_bf16 v112, v25, v2
  v_dot2c_f32_bf16 v113, v25, v3
  v_dot2c_f32_bf16 v114, v26, v2
  v_dot2c_f32_bf16 v115, v26, v3
  v_dot2c_f32_bf16 v116, v27, v2
  v_dot2c_f32_bf16 v117, v27, v3
  v_dot2c_f32_bf16 v118, v28, v2
  v_dot2c_f32_bf16 v119, v28, v3
  v_dot2c_f32_bf16 v120, v29, v2
  v_dot2c_f32_bf16 v121, v29, v3
  v_dot2c_f32_bf16 v122, v30, v2
  v_dot2c_f32_bf16 v123, v30, v3
  v_dot2c_f32_bf16 v124, v31, v2
  v_dot2c_f32_bf16 v125, v31, v3
  v_dot2c_f32_bf16 v126, v32, v2
  v_dot2c_f32_bf16 v127, v32, v3
  v_dot2c_f32_bf16 v128, v33, v2
  v_dot2c_f32_bf16 v129, v33, v3
  v_cvt_pk_bf16_f32 v0, v102, v214
  v_cvt_pk_bf16_f32 v1, v214, v102
  v_dot2c_f32_bf16 v112, v34, v0
  v_dot2c_f32_bf16 v113, v34, v1
  v_dot2c_f32_bf16 v114, v35, v0
  v_dot2c_f32_bf16 v115, v35, v1
  v_dot2c_f32_bf16 v116, v36, v0
  v_dot2c_f32_bf16 v117, v36, v1
  v_dot2c_f32_bf16 v118, v37, v0
  v_dot2c_f32_bf16 v119, v37, v1
  v_dot2c_f32_bf16 v120, v38, v0
  v_dot2c_f32_bf16 v121, v38, v1
  v_dot2c_f32_bf16 v122, v39, v0
  v_dot2c_f32_bf16 v123, v39, v1
  v_dot2c_f32_bf16 v124, v40, v0
  v_dot2c_f32_bf16 v125, v40, v1
  v_dot2c_f32_bf16 v126, v41, v0
  v_dot2c_f32_bf16 v127, v41, v1
  v_dot2c_f32_bf16 v128, v42, v0
  v_dot2c_f32_bf16 v129, v42, v1
  v_cvt_pk_bf16_f32 v2, v103, v214
  v_cvt_pk_bf16_f32 v3, v214, v103
  v_dot2c_f32_bf16 v112, v43, v2
  v_dot2c_f32_bf16 v113, v43, v3
  v_dot2c_f32_bf16 v114, v44, v2
  v_dot2c_f32_bf16 v115, v44, v3
  v_dot2c_f32_bf16 v116, v45, v2
  v_dot2c_f32_bf16 v117, v45, v3
  v_dot2c_f32_bf16 v118, v46, v2
  v_dot2c_f32_bf16 v119, v46, v3
  v_dot2c_f32_bf16 v120, v47, v2
  v_dot2c_f32_bf16 v121, v47, v3
  v_dot2c_f32_bf16 v122, v48, v2
  v_dot2c_f32_bf16 v123, v48, v3
  v_dot2c_f32_bf16 v124, v49, v2
  v_dot2c_f32_bf16 v125, v49, v3
  v_dot2c_f32_bf16 v126, v50, v2
  v_dot2c_f32_bf16 v127, v50, v3
  v_dot2c_f32_bf16 v128, v51, v2
  v_dot2c_f32_bf16 v129, v51, v3
  v_cvt_pk_bf16_f32 v0, v104, v214
  v_cvt_pk_bf16_f32 v1, v214, v104
  v_dot2c_f32_bf16 v112, v52, v0
  v_dot2c_f32_bf16 v113, v52, v1
  v_dot2c_f32_bf16 v114, v53, v0
  v_dot2c_f32_bf16 v115, v53, v1
  v_dot2c_f32_bf16 v116, v54, v0
  v_dot2c_f32_bf16 v117, v54, v1
  v_dot2c_f32_bf16 v118, v55, v0
  v_dot2c_f32_bf16 v119, v55, v1
  v_dot2c_f32_bf16 v120, v56, v0
  v_dot2c_f32_bf16 v121, v56, v1
  v_dot2c_f32_bf16 v122, v57, v0
  v_dot2c_f32_bf16 v123, v57, v1
  v_dot2c_f32_bf16 v124, v58, v0
  v_dot2c_f32_bf16 v125, v58, v1
  v_dot2c_f32_bf16 v126, v59, v0
  v_dot2c_f32_bf16 v127, v59, v1
  v_dot2c_f32_bf16 v128, v60, v0
  v_dot2c_f32_bf16 v129, v60, v1
  v_cvt_pk_bf16_f32 v2, v105, v214
  v_cvt_pk_bf16_f32 v3, v214, v105
  v_dot2c_f32_bf16 v112, v61, v2
  v_dot2c_f32_bf16 v113, v61, v3
  v_dot2c_f32_bf16 v114, v62, v2
  v_dot2c_f32_bf16 v115, v62, v3
  v_dot2c_f32_bf16 v116, v63, v2
  v_dot2c_f32_bf16 v117, v63, v3
  v_dot2c_f32_bf16 v118, v64, v2
  v_dot2c_f32_bf16 v119, v64, v3
  v_dot2c_f32_bf16 v120, v65, v2
  v_dot2c_f32_bf16 v121, v65, v3
  v_dot2c_f32_bf16 v122, v66, v2
  v_dot2c_f32_bf16 v123, v66, v3
  v_dot2c_f32_bf16 v124, v67, v2
  v_dot2c_f32_bf16 v125, v67, v3
  v_dot2c_f32_bf16 v126, v68, v2
  v_dot2c_f32_bf16 v127, v68, v3
  v_dot2c_f32_bf16 v128, v69, v2
  v_dot2c_f32_bf16 v129, v69, v3
  v_cvt_pk_bf16_f32 v0, v106, v214
  v_cvt_pk_bf16_f32 v1, v214, v106
  v_dot2c_f32_bf16 v112, v70, v0
  v_dot2c_f32_bf16 v113, v70, v1
  v_dot2c_f32_bf16 v114, v71, v0
  v_dot2c_f32_bf16 v115, v71, v1
  v_dot2c_f32_bf16 v116, v72, v0
  v_dot2c_f32_bf16 v117, v72, v1
  s_waitcnt lgkmcnt(14)
  v_dot2c_f32_bf16 v118, v73, v0
  v_dot2c_f32_bf16 v119, v73, v1
  s_waitcnt lgkmcnt(13)
  v_dot2c_f32_bf16 v120, v74, v0
  v_dot2c_f32_bf16 v121, v74, v1
  s_waitcnt lgkmcnt(12)
  v_dot2c_f32_bf16 v122, v75, v0
  v_dot2c_f32_bf16 v123, v75, v1
  s_waitcnt lgkmcnt(11)
  v_dot2c_f32_bf16 v124, v76, v0
  v_dot2c_f32_bf16 v125, v76, v1
  s_waitcnt lgkmcnt(10)
  v_dot2c_f32_bf16 v126, v77, v0
  v_dot2c_f32_bf16 v127, v77, v1
  s_waitcnt lgkmcnt(9)
  v_dot2c_f32_bf16 v128, v78, v0
  v_dot2c_f32_bf16 v129, v78, v1
  v_cvt_pk_bf16_f32 v2, v107, v214
  v_cvt_pk_bf16_f32 v3, v214, v107
  s_waitcnt lgkmcnt(8)
  v_dot2c_f32_bf16 v112, v79, v2
  v_dot2c_f32_bf16 v113, v79, v3
  s_waitcnt lgkmcnt(7)
  v_dot2c_f32_bf16 v114, v80, v2
  v_dot2c_f32_bf16 v115, v80, v3
  s_waitcnt lgkmcnt(6)
  v_dot2c_f32_bf16 v116, v81, v2
  v_dot2c_f32_bf16 v117, v81, v3
  s_waitcnt lgkmcnt(5)
  v_dot2c_f32_bf16 v118, v82, v2
  v_dot2c_f32_bf16 v119, v82, v3
  s_waitcnt lgkmcnt(4)
  v_dot2c_f32_bf16 v120, v83, v2
  v_dot2c_f32_bf16 v121, v83, v3
  s_waitcnt lgkmcnt(3)
  v_dot2c_f32_bf16 v122, v84, v2
  v_dot2c_f32_bf16 v123, v84, v3
  s_waitcnt lgkmcnt(2)
  v_dot2c_f32_bf16 v124, v85, v2
  v_dot2c_f32_bf16 v125, v85, v3
  s_waitcnt lgkmcnt(1)
  v_dot2c_f32_bf16 v126, v86, v2
  v_dot2c_f32_bf16 v127, v86, v3
  s_waitcnt lgkmcnt(0)
  v_dot2c_f32_bf16 v128, v87, v2
  v_dot2c_f32_bf16 v129, v87, v3
  v_cvt_pk_bf16_f32 v132, v112, v113
  v_cvt_pk_bf16_f32 v133, v114, v115
  v_cvt_pk_bf16_f32 v134, v116, v117
  v_cvt_pk_bf16_f32 v135, v118, v119
  v_cvt_pk_bf16_f32 v136, v120, v121
  v_cvt_pk_bf16_f32 v137, v122, v123
  v_cvt_pk_bf16_f32 v138, v124, v125
  v_cvt_pk_bf16_f32 v139, v126, v127
  v_cvt_pk_bf16_f32 v140, v128, v129
  buffer_store_dwordx4 v[132:135], v220, s[8:11], s64 offen sc1
  buffer_store_dwordx4 v[136:139], v220, s[8:11], s64 offen offset:16 sc1
  buffer_store_dword v140, v220, s[8:11], s64 offen offset:32 sc1
  s_mov_b32 s56, 36
  s_waitcnt vmcnt(0)
  s_barrier
  s_cmp_eq_u32 s52, 0
  s_cbranch_scc0 A_sig
  v_mov_b32 v211, 1
  v_mov_b32 v212, 0
  s_mov_b64 exec, 1
  buffer_atomic_add v211, v212, s[12:15], s56 offen
  s_mov_b64 exec, -1
A_sig:
  s_cmp_lt_u32 s53, 204
  s_cbranch_scc0 L_exit
  s_sub_u32 s54, s53, 96
  s_mul_i32 s55, s54, 3641
  s_lshr_b32 s55, s55, 16
  s_mul_i32 s56, s55, 18
  s_sub_u32 s70, s54, s56
  s_and_b32 s69, s55, 1
  s_lshr_b32 s68, s55, 1
  v_lshrrev_b32 v211, 2, v200
  v_mul_u32_u24 v211, 1152, v211
  v_and_b32 v212, 3, v200
  v_lshl_add_u32 v207, v212, 4, v211
  s_lshl_b32 s54, s70, 6
  s_mul_i32 s55, s52, 1179648
  s_add_u32 s62, s54, s55
  s_mul_i32 s55, s52, 184320
  s_add_u32 s63, s54, s55
  s_mul_i32 s61, s52, 40960
  v_bfe_u32 v211, v200, 2, 2
  v_lshlrev_b32 v212, 4, v212
  v_add_u32 v212, s61, v212
  v_lshl_add_u32 v212, v211, 6, v212
  v_lshrrev_b32 v213, 4, v200
  v_lshl_add_u32 v210, v213, 9, v212
  v_lshrrev_b32 v214, 5, v200
  v_lshl_add_u32 v209, v214, 10, v212
  v_and_b32 v214, 1, v213
  v_lshl_add_u32 v209, v214, 8, v209
  s_add_u32 m0, s61, 0
  s_add_u32 s54, s62, 0
  buffer_load_dwordx4 v207, s[28:31], s54 offen lds
  s_add_u32 m0, s61, 1024
  s_add_u32 s54, s62, 18432
  buffer_load_dwordx4 v207, s[28:31], s54 offen lds
  s_add_u32 m0, s61, 2048
  s_add_u32 s54, s62, 36864
  buffer_load_dwordx4 v207, s[28:31], s54 offen lds
  s_add_u32 m0, s61, 3072
  s_add_u32 s54, s62, 55296
  buffer_load_dwordx4 v207, s[28:31], s54 offen lds
  s_add_u32 m0, s61, 4096
  s_add_u32 s54, s62, 73728
  buffer_load_dwordx4 v207, s[28:31], s54 offen lds
  s_add_u32 m0, s61, 5120
  s_add_u32 s54, s62, 92160
  buffer_load_dwordx4 v207, s[28:31], s54 offen lds
  s_add_u32 m0, s61, 6144
  s_add_u32 s54, s62, 110592
  buffer_load_dwordx4 v207, s[28:31], s54 offen lds
  s_add_u32 m0, s61, 7168
  s_add_u32 s54, s62, 129024
  buffer_load_dwordx4 v207, s[28:31], s54 offen lds
  s_add_u32 m0, s61, 8192
  s_add_u32 s54, s62, 147456
  buffer_load_dwordx4 v207, s[28:31], s54 offen lds
  s_add_u32 m0, s61, 9216
  s_add_u32 s54, s62, 165888
  buffer_load_dwordx4 v207, s[28:31], s54 offen lds
  s_add_u32 m0, s61, 10240
  s_add_u32 s54, s62, 184320
  buffer_load_dwordx4 v207, s[28:31], s54 offen lds
  s_add_u32 m0, s61, 11264
  s_add_u32 s54, s62, 202752
  buffer_load_dwordx4 v207, s[28:31], s54 offen lds
  s_add_u32 m0, s61, 12288
  s_add_u32 s54, s62, 221184
  buffer_load_dwordx4 v207, s[28:31], s54 offen lds
  s_add_u32 m0, s61, 13312
  s_add_u32 s54, s62, 239616
  buffer_load_dwordx4 v207, s[28:31], s54 offen lds
  s_add_u32 m0, s61, 14336
  s_add_u32 s54, s62, 258048
  buffer_load_dwordx4 v207, s[28:31], s54 offen lds
  s_add_u32 m0, s61, 15360
  s_add_u32 s54, s62, 276480
  buffer_load_dwordx4 v207, s[28:31], s54 offen lds
  s_add_u32 m0, s61, 16384
  s_add_u32 s54, s62, 294912
  buffer_load_dwordx4 v207, s[28:31], s54 offen lds
  s_add_u32 m0, s61, 17408
  s_add_u32 s54, s62, 313344
  buffer_load_dwordx4 v207, s[28:31], s54 offen lds
  s_add_u32 m0, s61, 18432
  s_add_u32 s54, s62, 331776
  buffer_load_dwordx4 v207, s[28:31], s54 offen lds
  s_add_u32 m0, s61, 19456
  s_add_u32 s54, s62, 350208
  buffer_load_dwordx4 v207, s[28:31], s54 offen lds
  s_add_u32 m0, s61, 20480
  s_add_u32 s54, s62, 368640
  buffer_load_dwordx4 v207, s[28:31], s54 offen lds
  s_add_u32 m0, s61, 21504
  s_add_u32 s54, s62, 387072
  buffer_load_dwordx4 v207, s[28:31], s54 offen lds
  s_add_u32 m0, s61, 22528
  s_add_u32 s54, s62, 405504
  buffer_load_dwordx4 v207, s[28:31], s54 offen lds
  s_add_u32 m0, s61, 23552
  s_add_u32 s54, s62, 423936
  buffer_load_dwordx4 v207, s[28:31], s54 offen lds
  s_add_u32 m0, s61, 24576
  s_add_u32 s54, s62, 442368
  buffer_load_dwordx4 v207, s[28:31], s54 offen lds
  s_add_u32 m0, s61, 25600
  s_add_u32 s54, s62, 460800
  buffer_load_dwordx4 v207, s[28:31], s54 offen lds
  s_add_u32 m0, s61, 26624
  s_add_u32 s54, s62, 479232
  buffer_load_dwordx4 v207, s[28:31], s54 offen lds
  s_add_u32 m0, s61, 27648
  s_add_u32 s54, s62, 497664
  buffer_load_dwordx4 v207, s[28:31], s54 offen lds
  s_add_u32 m0, s61, 28672
  s_add_u32 s54, s62, 516096
  buffer_load_dwordx4 v207, s[28:31], s54 offen lds
  s_add_u32 m0, s61, 29696
  s_add_u32 s54, s62, 534528
  buffer_load_dwordx4 v207, s[28:31], s54 offen lds
  s_add_u32 m0, s61, 30720
  s_add_u32 s54, s62, 552960
  buffer_load_dwordx4 v207, s[28:31], s54 offen lds
  s_add_u32 m0, s61, 31744
  s_add_u32 s54, s62, 571392
  buffer_load_dwordx4 v207, s[28:31], s54 offen lds
  s_add_u32 m0, s61, 32768
  s_add_u32 s54, s62, 589824
  buffer_load_dwordx4 v207, s[28:31], s54 offen lds
  s_add_u32 m0, s61, 33792
  s_add_u32 s54, s62, 608256
  buffer_load_dwordx4 v207, s[28:31], s54 offen lds
  s_add_u32 m0, s61, 34816
  s_add_u32 s54, s62, 626688
  buffer_load_dwordx4 v207, s[28:31], s54 offen lds
  s_add_u32 m0, s61, 35840
  s_add_u32 s54, s62, 645120
  buffer_load_dwordx4 v207, s[28:31], s54 offen lds
  s_add_u32 m0, s61, 36864
  s_add_u32 s54, s62, 663552
  buffer_load_dwordx4 v207, s[28:31], s54 offen lds
  s_add_u32 m0, s61, 37888
  s_add_u32 s54, s62, 681984
  buffer_load_dwordx4 v207, s[28:31], s54 offen lds
  s_waitcnt vmcnt(36) lgkmcnt(0)
  s_add_u32 m0, s61, 38912
  s_add_u32 s54, s62, 700416
  buffer_load_dwordx4 v207, s[28:31], s54 offen lds
  s_add_u32 m0, s61, 39936
  s_add_u32 s54, s62, 718848
  buffer_load_dwordx4 v207, s[28:31], s54 offen lds
  ds_read_b64_tr_b16 a[0:1], v209 offset:0
  ds_read_b64_tr_b16 a[2:3], v209 offset:512
  ds_read_b64_tr_b16 a[4:5], v209 offset:8
  ds_read_b64_tr_b16 a[6:7], v209 offset:520
  s_waitcnt vmcnt(36) lgkmcnt(0)
  s_add_u32 m0, s61, 0
  s_add_u32 s54, s62, 737280
  buffer_load_dwordx4 v207, s[28:31], s54 offen lds
  s_add_u32 m0, s61, 1024
  s_add_u32 s54, s62, 755712
  buffer_load_dwordx4 v207, s[28:31], s54 offen lds
  ds_read_b64_tr_b16 a[8:9], v209 offset:2048
  ds_read_b64_tr_b16 a[10:11], v209 offset:2560
  ds_read_b64_tr_b16 a[12:13], v209 offset:2056
  ds_read_b64_tr_b16 a[14:15], v209 offset:2568
  s_waitcnt vmcnt(36) lgkmcnt(0)
  s_add_u32 m0, s61, 2048
  s_add_u32 s54, s62, 774144
  buffer_load_dwordx4 v207, s[28:31], s54 offen lds
  s_add_u32 m0, s61, 3072
  s_add_u32 s54, s62, 792576
  buffer_load_dwordx4 v207, s[28:31], s54 offen lds
  ds_read_b64_tr_b16 a[16:17], v209 offset:4096
  ds_read_b64_tr_b16 a[18:19], v209 offset:4608
  ds_read_b64_tr_b16 a[20:21], v209 offset:4104
  ds_read_b64_tr_b16 a[22:23], v209 offset:4616
  s_waitcnt vmcnt(36) lgkmcnt(0)
  s_add_u32 m0, s61, 4096
  s_add_u32 s54, s62, 811008
  buffer_load_dwordx4 v207, s[28:31], s54 offen lds
  s_add_u32 m0, s61, 5120
  s_add_u32 s54, s62, 829440
  buffer_load_dwordx4 v207, s[28:31], s54 offen lds
  ds_read_b64_tr_b16 a[24:25], v209 offset:6144
  ds_read_b64_tr_b16 a[26:27], v209 offset:6656
  ds_read_b64_tr_b16 a[28:29], v209 offset:6152
  ds_read_b64_tr_b16 a[30:31], v209 offset:6664
  s_waitcnt vmcnt(36) lgkmcnt(0)
  s_add_u32 m0, s61, 6144
  s_add_u32 s54, s62, 847872
  buffer_load_dwordx4 v207, s[28:31], s54 offen lds
  s_add_u32 m0, s61, 7168
  s_add_u32 s54, s62, 866304
  buffer_load_dwordx4 v207, s[28:31], s54 offen lds
  ds_read_b64_tr_b16 a[32:33], v209 offset:8192
  ds_read_b64_tr_b16 a[34:35], v209 offset:8704
  ds_read_b64_tr_b16 a[36:37], v209 offset:8200
  ds_read_b64_tr_b16 a[38:39], v209 offset:8712
  s_waitcnt vmcnt(36) lgkmcnt(0)
  s_add_u32 m0, s61, 8192
  s_add_u32 s54, s62, 884736
  buffer_load_dwordx4 v207, s[28:31], s54 offen lds
  s_add_u32 m0, s61, 9216
  s_add_u32 s54, s62, 903168
  buffer_load_dwordx4 v207, s[28:31], s54 offen lds
  ds_read_b64_tr_b16 a[40:41], v209 offset:10240
  ds_read_b64_tr_b16 a[42:43], v209 offset:10752
  ds_read_b64_tr_b16 a[44:45], v209 offset:10248
  ds_read_b64_tr_b16 a[46:47], v209 offset:10760
  s_waitcnt vmcnt(36) lgkmcnt(0)
  s_add_u32 m0, s61, 10240
  s_add_u32 s54, s62, 921600
  buffer_load_dwordx4 v207, s[28:31], s54 offen lds
  s_add_u32 m0, s61, 11264
  s_add_u32 s54, s62, 940032
  buffer_load_dwordx4 v207, s[28:31], s54 offen lds
  ds_read_b64_tr_b16 a[48:49], v209 offset:12288
  ds_read_b64_tr_b16 a[50:51], v209 offset:12800
  ds_read_b64_tr_b16 a[52:53], v209 offset:12296
  ds_read_b64_tr_b16 a[54:55], v209 offset:12808
  s_waitcnt vmcnt(36) lgkmcnt(0)
  s_add_u32 m0, s61, 12288
  s_add_u32 s54, s62, 958464
  buffer_load_dwordx4 v207, s[28:31], s54 offen lds
  s_add_u32 m0, s61, 13312
  s_add_u32 s54, s62, 976896
  buffer_load_dwordx4 v207, s[28:31], s54 offen lds
  ds_read_b64_tr_b16 a[56:57], v209 offset:14336
  ds_read_b64_tr_b16 a[58:59], v209 offset:14848
  ds_read_b64_tr_b16 a[60:61], v209 offset:14344
  ds_read_b64_tr_b16 a[62:63], v209 offset:14856
  s_waitcnt vmcnt(36) lgkmcnt(0)
  s_add_u32 m0, s61, 14336
  s_add_u32 s54, s62, 995328
  buffer_load_dwordx4 v207, s[28:31], s54 offen lds
  s_add_u32 m0, s61, 15360
  s_add_u32 s54, s62, 1013760
  buffer_load_dwordx4 v207, s[28:31], s54 offen lds
  ds_read_b64_tr_b16 a[64:65], v209 offset:16384
  ds_read_b64_tr_b16 a[66:67], v209 offset:16896
  ds_read_b64_tr_b16 a[68:69], v209 offset:16392
  ds_read_b64_tr_b16 a[70:71], v209 offset:16904
  s_waitcnt vmcnt(36) lgkmcnt(0)
  s_add_u32 m0, s61, 16384
  s_add_u32 s54, s62, 1032192
  buffer_load_dwordx4 v207, s[28:31], s54 offen lds
  s_add_u32 m0, s61, 17408
  s_add_u32 s54, s62, 1050624
  buffer_load_dwordx4 v207, s[28:31], s54 offen lds
  ds_read_b64_tr_b16 a[72:73], v209 offset:18432
  ds_read_b64_tr_b16 a[74:75], v209 offset:18944
  ds_read_b64_tr_b16 a[76:77], v209 offset:18440
  ds_read_b64_tr_b16 a[78:79], v209 offset:18952
  s_waitcnt vmcnt(36) lgkmcnt(0)
  s_add_u32 m0, s61, 18432
  s_add_u32 s54, s62, 1069056
  buffer_load_dwordx4 v207, s[28:31], s54 offen lds
  s_add_u32 m0, s61, 19456
  s_add_u32 s54, s62, 1087488
  buffer_load_dwordx4 v207, s[28:31], s54 offen lds
  ds_read_b64_tr_b16 a[80:81], v209 offset:20480
  ds_read_b64_tr_b16 a[82:83], v209 offset:20992
  ds_read_b64_tr_b16 a[84:85], v209 offset:20488
  ds_read_b64_tr_b16 a[86:87], v209 offset:21000
  s_waitcnt vmcnt(36) lgkmcnt(0)
  s_add_u32 m0, s61, 20480
  s_add_u32 s54, s62, 1105920
  buffer_load_dwordx4 v207, s[28:31], s54 offen lds
  s_add_u32 m0, s61, 21504
  s_add_u32 s54, s62, 1124352
  buffer_load_dwordx4 v207, s[28:31], s54 offen lds
  ds_read_b64_tr_b16 a[88:89], v209 offset:22528
  ds_read_b64_tr_b16 a[90:91], v209 offset:23040
  ds_read_b64_tr_b16 a[92:93], v209 offset:22536
  ds_read_b64_tr_b16 a[94:95], v209 offset:23048
  s_waitcnt vmcnt(36) lgkmcnt(0)
  s_add_u32 m0, s61, 22528
  s_add_u32 s54, s62, 1142784
  buffer_load_dwordx4 v207, s[28:31], s54 offen lds
  s_add_u32 m0, s61, 23552
  s_add_u32 s54, s62, 1161216
  buffer_load_dwordx4 v207, s[28:31], s54 offen lds
  ds_read_b64_tr_b16 a[96:97], v209 offset:24576
  ds_read_b64_tr_b16 a[98:99], v209 offset:25088
  ds_read_b64_tr_b16 a[100:101], v209 offset:24584
  ds_read_b64_tr_b16 a[102:103], v209 offset:25096
  s_waitcnt vmcnt(36) lgkmcnt(0)
  s_add_u32 m0, s61, 24576
  s_add_u32 s54, s63, 0
  buffer_load_dwordx4 v207, s[40:43], s54 offen lds
  s_add_u32 m0, s61, 25600
  s_add_u32 s54, s63, 18432
  buffer_load_dwordx4 v207, s[40:43], s54 offen lds
  ds_read_b64_tr_b16 a[104:105], v209 offset:26624
  ds_read_b64_tr_b16 a[106:107], v209 offset:27136
  ds_read_b64_tr_b16 a[108:109], v209 offset:26632
  ds_read_b64_tr_b16 a[110:111], v209 offset:27144
  s_waitcnt vmcnt(36) lgkmcnt(0)
  s_add_u32 m0, s61, 26624
  s_add_u32 s54, s63, 36864
  buffer_load_dwordx4 v207, s[40:43], s54 offen lds
  s_add_u32 m0, s61, 27648
  s_add_u32 s54, s63, 55296
  buffer_load_dwordx4 v207, s[40:43], s54 offen lds
  ds_read_b64_tr_b16 a[112:113], v209 offset:28672
  ds_read_b64_tr_b16 a[114:115], v209 offset:29184
  ds_read_b64_tr_b16 a[116:117], v209 offset:28680
  ds_read_b64_tr_b16 a[118:119], v209 offset:29192
  s_waitcnt vmcnt(36) lgkmcnt(0)
  s_add_u32 m0, s61, 28672
  s_add_u32 s54, s63, 73728
  buffer_load_dwordx4 v207, s[40:43], s54 offen lds
  s_add_u32 m0, s61, 29696
  s_add_u32 s54, s63, 92160
  buffer_load_dwordx4 v207, s[40:43], s54 offen lds
  ds_read_b64_tr_b16 a[120:121], v209 offset:30720
  ds_read_b64_tr_b16 a[122:123], v209 offset:31232
  ds_read_b64_tr_b16 a[124:125], v209 offset:30728
  ds_read_b64_tr_b16 a[126:127], v209 offset:31240
  s_waitcnt vmcnt(36) lgkmcnt(0)
  s_add_u32 m0, s61, 30720
  s_add_u32 s54, s63, 110592
  buffer_load_dwordx4 v207, s[40:43], s54 offen lds
  s_add_u32 m0, s61, 31744
  s_add_u32 s54, s63, 129024
  buffer_load_dwordx4 v207, s[40:43], s54 offen lds
  ds_read_b64_tr_b16 a[128:129], v209 offset:32768
  ds_read_b64_tr_b16 a[130:131], v209 offset:33280
  ds_read_b64_tr_b16 a[132:133], v209 offset:32776
  ds_read_b64_tr_b16 a[134:135], v209 offset:33288
  s_waitcnt vmcnt(36) lgkmcnt(0)
  s_add_u32 m0, s61, 32768
  s_add_u32 s54, s63, 147456
  buffer_load_dwordx4 v207, s[40:43], s54 offen lds
  s_add_u32 m0, s61, 33792
  s_add_u32 s54, s63, 165888
  buffer_load_dwordx4 v207, s[40:43], s54 offen lds
  ds_read_b64_tr_b16 a[136:137], v209 offset:34816
  ds_read_b64_tr_b16 a[138:139], v209 offset:35328
  ds_read_b64_tr_b16 a[140:141], v209 offset:34824
  ds_read_b64_tr_b16 a[142:143], v209 offset:35336
  s_waitcnt vmcnt(36) lgkmcnt(0)
  ds_read_b64_tr_b16 a[144:145], v209 offset:36864
  ds_read_b64_tr_b16 a[146:147], v209 offset:37376
  ds_read_b64_tr_b16 a[148:149], v209 offset:36872
  ds_read_b64_tr_b16 a[150:151], v209 offset:37384
  s_waitcnt vmcnt(34) lgkmcnt(0)
  ds_read_b64_tr_b16 a[152:153], v209 offset:38912
  ds_read_b64_tr_b16 a[154:155], v209 offset:39424
  ds_read_b64_tr_b16 a[156:157], v209 offset:38920
  ds_read_b64_tr_b16 a[158:159], v209 offset:39432
  s_waitcnt vmcnt(32) lgkmcnt(0)
  ds_read_b64_tr_b16 a[160:161], v209 offset:0
  ds_read_b64_tr_b16 a[162:163], v209 offset:512
  ds_read_b64_tr_b16 a[164:165], v209 offset:8
  ds_read_b64_tr_b16 a[166:167], v209 offset:520
  s_waitcnt vmcnt(30) lgkmcnt(0)
  ds_read_b64_tr_b16 a[168:169], v209 offset:2048
  ds_read_b64_tr_b16 a[170:171], v209 offset:2560
  ds_read_b64_tr_b16 a[172:173], v209 offset:2056
  ds_read_b64_tr_b16 a[174:175], v209 offset:2568
  s_waitcnt vmcnt(28) lgkmcnt(0)
  ds_read_b64_tr_b16 a[176:177], v209 offset:4096
  ds_read_b64_tr_b16 a[178:179], v209 offset:4608
  ds_read_b64_tr_b16 a[180:181], v209 offset:4104
  ds_read_b64_tr_b16 a[182:183], v209 offset:4616
  s_waitcnt vmcnt(26) lgkmcnt(0)
  ds_read_b64_tr_b16 a[184:185], v209 offset:6144
  ds_read_b64_tr_b16 a[186:187], v209 offset:6656
  ds_read_b64_tr_b16 a[188:189], v209 offset:6152
  ds_read_b64_tr_b16 a[190:191], v209 offset:6664
  s_waitcnt vmcnt(24) lgkmcnt(0)
  ds_read_b64_tr_b16 a[192:193], v209 offset:8192
  ds_read_b64_tr_b16 a[194:195], v209 offset:8704
  ds_read_b64_tr_b16 a[196:197], v209 offset:8200
  ds_read_b64_tr_b16 a[198:199], v209 offset:8712
  s_waitcnt vmcnt(22) lgkmcnt(0)
  ds_read_b64_tr_b16 a[200:201], v209 offset:10240
  ds_read_b64_tr_b16 a[202:203], v209 offset:10752
  ds_read_b64_tr_b16 a[204:205], v209 offset:10248
  ds_read_b64_tr_b16 a[206:207], v209 offset:10760
  s_waitcnt vmcnt(20) lgkmcnt(0)
  ds_read_b64_tr_b16 a[208:209], v209 offset:12288
  ds_read_b64_tr_b16 a[210:211], v209 offset:12800
  ds_read_b64_tr_b16 a[212:213], v209 offset:12296
  ds_read_b64_tr_b16 a[214:215], v209 offset:12808
  s_waitcnt vmcnt(18) lgkmcnt(0)
  ds_read_b64_tr_b16 a[216:217], v209 offset:14336
  ds_read_b64_tr_b16 a[218:219], v209 offset:14848
  ds_read_b64_tr_b16 a[220:221], v209 offset:14344
  ds_read_b64_tr_b16 a[222:223], v209 offset:14856
  s_waitcnt vmcnt(16) lgkmcnt(0)
  ds_read_b64_tr_b16 a[224:225], v209 offset:16384
  ds_read_b64_tr_b16 a[226:227], v209 offset:16896
  ds_read_b64_tr_b16 a[228:229], v209 offset:16392
  ds_read_b64_tr_b16 a[230:231], v209 offset:16904
  s_waitcnt vmcnt(14) lgkmcnt(0)
  ds_read_b64_tr_b16 a[232:233], v209 offset:18432
  ds_read_b64_tr_b16 a[234:235], v209 offset:18944
  ds_read_b64_tr_b16 a[236:237], v209 offset:18440
  ds_read_b64_tr_b16 a[238:239], v209 offset:18952
  s_waitcnt vmcnt(12) lgkmcnt(0)
  ds_read_b64_tr_b16 a[240:241], v209 offset:20480
  ds_read_b64_tr_b16 a[242:243], v209 offset:20992
  ds_read_b64_tr_b16 a[244:245], v209 offset:20488
  ds_read_b64_tr_b16 a[246:247], v209 offset:21000
  s_waitcnt vmcnt(10) lgkmcnt(0)
  ds_read_b64_tr_b16 a[248:249], v209 offset:22528
  ds_read_b64_tr_b16 a[250:251], v209 offset:23040
  ds_read_b64_tr_b16 a[252:253], v209 offset:22536
  ds_read_b64_tr_b16 a[254:255], v209 offset:23048
  s_waitcnt vmcnt(8) lgkmcnt(0)
  ds_read_b64_tr_b16 v[216:217], v210 offset:24576
  ds_read_b64_tr_b16 v[218:219], v210 offset:24832
  ds_read_b64_tr_b16 v[220:221], v210 offset:24584
  ds_read_b64_tr_b16 v[222:223], v210 offset:24840
  s_waitcnt vmcnt(6) lgkmcnt(0)
  ds_read_b64_tr_b16 v[224:225], v210 offset:26624
  ds_read_b64_tr_b16 v[226:227], v210 offset:26880
  ds_read_b64_tr_b16 v[228:229], v210 offset:26632
  ds_read_b64_tr_b16 v[230:231], v210 offset:26888
  s_waitcnt vmcnt(4) lgkmcnt(0)
  ds_read_b64_tr_b16 v[232:233], v210 offset:28672
  ds_read_b64_tr_b16 v[234:235], v210 offset:28928
  ds_read_b64_tr_b16 v[236:237], v210 offset:28680
  ds_read_b64_tr_b16 v[238:239], v210 offset:28936
  s_waitcnt vmcnt(2) lgkmcnt(0)
  ds_read_b64_tr_b16 v[240:241], v210 offset:30720
  ds_read_b64_tr_b16 v[242:243], v210 offset:30976
  ds_read_b64_tr_b16 v[244:245], v210 offset:30728
  ds_read_b64_tr_b16 v[246:247], v210 offset:30984
  s_waitcnt vmcnt(0) lgkmcnt(0)
  ds_read_b64_tr_b16 v[248:249], v210 offset:32768
  ds_read_b64_tr_b16 v[250:251], v210 offset:33024
  ds_read_b64_tr_b16 v[252:253], v210 offset:32776
  ds_read_b64_tr_b16 v[254:255], v210 offset:33032
  v_and_b32 v211, 15, v200
  s_lshl_b32 s54, s69, 4
  v_add_u32 v211, s54, v211
  v_lshl_add_u32 v212, v214, 5, v211
  v_lshlrev_b32 v164, 4, v212
  v_lshrrev_b32 v212, 5, v200
  v_lshl_add_u32 v164, v212, 10, v164
  v_mul_u32_u24 v167, 1152, v211
  v_lshl_add_u32 v167, v213, 4, v167
  v_lshlrev_b32 v166, 2, v211
  v_lshlrev_b32 v208, 2, v200
  s_lshl_b32 s54, s52, 11
  v_add_u32 v168, s54, v201
  s_mov_b32 s59, s68
  s_lshl_b32 s66, s68, 7
  s_add_u32 s66, s66, 356352
  s_mov_b32 s56, 128
  s_mov_b32 s57, 36
  s_waitcnt lgkmcnt(0)
  s_cmp_eq_u32 s52, 0
  s_cbranch_scc0 O_p1_d
  s_mov_b32 exec_hi, 0
  s_mov_b32 exec_lo, -1
O_p1:
  buffer_load_dword v211, v208, s[12:15], s56 offen sc1
  s_add_u32 s65, s65, 1
  s_waitcnt vmcnt(0)
  v_cmp_gt_u32 vcc, 0x700, v211
  s_cbranch_vccz O_p1_x
  s_sleep 16
  s_cmp_lt_u32 s65, 131072
  s_cbranch_scc1 O_p1
O_p1_x:
  s_mov_b64 exec, -1
O_p1_d:
  s_barrier
  s_cmp_eq_u32 s52, 0
  s_cbranch_scc0 O_a_d
  s_mov_b32 exec_hi, 0
  s_mov_b32 exec_lo, 1
O_a:
  buffer_load_dword v211, v208, s[12:15], s57 offen sc1
  s_add_u32 s65, s65, 1
  s_waitcnt vmcnt(0)
  v_cmp_gt_u32 vcc, 0x80, v211
  s_cbranch_vccz O_a_x
  s_sleep 16
  s_cmp_lt_u32 s65, 131072
  s_cbranch_scc1 O_a
O_a_x:
  s_mov_b64 exec, -1
O_a_d:
  s_barrier
O_loop:
  s_mul_i32 s64, s59, 36864
  s_mul_i32 s54, s52, 320
  s_add_u32 s55, s64, s54
  s_add_u32 s55, s55, 62914560
  s_cmp_eq_u32 s52, 3
  s_cselect_b32 s56, 268435456, s55
  buffer_load_dwordx4 v[128:131], v167, s[8:11], s55 offen offset:0 sc1
  buffer_load_dwordx4 v[132:135], v167, s[8:11], s55 offen offset:64 sc1
  buffer_load_dwordx4 v[136:139], v167, s[8:11], s55 offen offset:128 sc1
  buffer_load_dwordx4 v[140:143], v167, s[8:11], s56 offen offset:192 sc1
  buffer_load_dwordx4 v[144:147], v167, s[8:11], s56 offen offset:256 sc1
  s_lshl_b32 s55, s59, 7
  s_add_u32 s55, s55, 66060288
  buffer_load_dword v165, v166, s[8:11], s55 offen sc1
  s_waitcnt vmcnt(5)
  v_mfma_f32_16x16x32_bf16 v[156:159], v[216:219], v[128:131], 0
  v_mfma_f32_16x16x32_bf16 v[160:163], v[220:223], v[128:131], 0
  s_waitcnt vmcnt(4)
  v_mfma_f32_16x16x32_bf16 v[156:159], v[224:227], v[132:135], v[156:159]
  v_mfma_f32_16x16x32_bf16 v[160:163], v[228:231], v[132:135], v[160:163]
  s_waitcnt vmcnt(3)
  v_mfma_f32_16x16x32_bf16 v[156:159], v[232:235], v[136:139], v[156:159]
  v_mfma_f32_16x16x32_bf16 v[160:163], v[236:239], v[136:139], v[160:163]
  s_waitcnt vmcnt(2)
  v_mfma_f32_16x16x32_bf16 v[156:159], v[240:243], v[140:143], v[156:159]
  v_mfma_f32_16x16x32_bf16 v[160:163], v[244:247], v[140:143], v[160:163]
  s_waitcnt vmcnt(1)
  v_mfma_f32_16x16x32_bf16 v[156:159], v[248:251], v[144:147], v[156:159]
  v_mfma_f32_16x16x32_bf16 v[160:163], v[252:255], v[144:147], v[160:163]
  s_waitcnt vmcnt(0)
  s_nop 2
  v_mul_f32 v156, v165, v156
  v_mul_f32 v157, v165, v157
  v_mul_f32 v158, v165, v158
  v_mul_f32 v159, v165, v159
  v_mul_f32 v160, v165, v160
  v_mul_f32 v161, v165, v161
  v_mul_f32 v162, v165, v162
  v_mul_f32 v163, v165, v163
  v_sub_f32 v165, 1.0, v165
  v_cvt_pk_bf16_f32 v165, v165, v165
  v_lshlrev_b32 v165, 16, v165
  s_add_u32 s71, s59, 3
  s_lshl_b32 s55, s59, 18
  s_lshl_b32 s54, s52, 16
  s_add_u32 s55, s55, s54
  s_add_u32 s62, s55, 46137344
  s_cmp_eq_u32 s52, 0
  s_cbranch_scc0 O_b_d
  s_mov_b32 exec_hi, 0
  s_mov_b32 exec_lo, -1
O_b:
  buffer_load_dword v211, v208, s[8:11], s66 offen sc1
  s_add_u32 s65, s65, 1
  s_waitcnt vmcnt(0)
  v_cmp_gt_u32 vcc, s71, v211
  s_cbranch_vccz O_b_x
  s_sleep 1
  s_cmp_lt_u32 s65, 131072
  s_cbranch_scc1 O_b
O_b_x:
  s_mov_b64 exec, -1
O_b_d:
  s_barrier
  buffer_load_dwordx4 v[0:3], v164, s[8:11], s62 offen offset:0 sc1
  buffer_load_dwordx4 v[4:7], v164, s[8:11], s62 offen offset:2048 sc1
  s_add_u32 s62, s62, 4096
  buffer_load_dwordx4 v[8:11], v164, s[8:11], s62 offen offset:0 sc1
  buffer_load_dwordx4 v[12:15], v164, s[8:11], s62 offen offset:2048 sc1
  s_add_u32 s62, s62, 4096
  buffer_load_dwordx4 v[16:19], v164, s[8:11], s62 offen offset:0 sc1
  buffer_load_dwordx4 v[20:23], v164, s[8:11], s62 offen offset:2048 sc1
  s_add_u32 s62, s62, 4096
  buffer_load_dwordx4 v[24:27], v164, s[8:11], s62 offen offset:0 sc1
  buffer_load_dwordx4 v[28:31], v164, s[8:11], s62 offen offset:2048 sc1
  s_add_u32 s62, s62, 4096
  buffer_load_dwordx4 v[32:35], v164, s[8:11], s62 offen offset:0 sc1
  buffer_load_dwordx4 v[36:39], v164, s[8:11], s62 offen offset:2048 sc1
  s_add_u32 s62, s62, 4096
  buffer_load_dwordx4 v[40:43], v164, s[8:11], s62 offen offset:0 sc1
  buffer_load_dwordx4 v[44:47], v164, s[8:11], s62 offen offset:2048 sc1
  s_add_u32 s62, s62, 4096
  buffer_load_dwordx4 v[48:51], v164, s[8:11], s62 offen offset:0 sc1
  buffer_load_dwordx4 v[52:55], v164, s[8:11], s62 offen offset:2048 sc1
  s_add_u32 s62, s62, 4096
  buffer_load_dwordx4 v[56:59], v164, s[8:11], s62 offen offset:0 sc1
  buffer_load_dwordx4 v[60:63], v164, s[8:11], s62 offen offset:2048 sc1
  s_add_u32 s62, s62, 4096
  buffer_load_dwordx4 v[64:67], v164, s[8:11], s62 offen offset:0 sc1
  buffer_load_dwordx4 v[68:71], v164, s[8:11], s62 offen offset:2048 sc1
  s_add_u32 s62, s62, 4096
  buffer_load_dwordx4 v[72:75], v164, s[8:11], s62 offen offset:0 sc1
  buffer_load_dwordx4 v[76:79], v164, s[8:11], s62 offen offset:2048 sc1
  s_add_u32 s62, s62, 4096
  buffer_load_dwordx4 v[80:83], v164, s[8:11], s62 offen offset:0 sc1
  buffer_load_dwordx4 v[84:87], v164, s[8:11], s62 offen offset:2048 sc1
  s_add_u32 s62, s62, 4096
  buffer_load_dwordx4 v[88:91], v164, s[8:11], s62 offen offset:0 sc1
  buffer_load_dwordx4 v[92:95], v164, s[8:11], s62 offen offset:2048 sc1
  s_add_u32 s62, s62, 4096
  buffer_load_dwordx4 v[96:99], v164, s[8:11], s62 offen offset:0 sc1
  buffer_load_dwordx4 v[100:103], v164, s[8:11], s62 offen offset:2048 sc1
  s_add_u32 s62, s62, 4096
  buffer_load_dwordx4 v[104:107], v164, s[8:11], s62 offen offset:0 sc1
  buffer_load_dwordx4 v[108:111], v164, s[8:11], s62 offen offset:2048 sc1
  s_add_u32 s62, s62, 4096
  buffer_load_dwordx4 v[112:115], v164, s[8:11], s62 offen offset:0 sc1
  buffer_load_dwordx4 v[116:119], v164, s[8:11], s62 offen offset:2048 sc1
  s_add_u32 s62, s62, 4096
  buffer_load_dwordx4 v[120:123], v164, s[8:11], s62 offen offset:0 sc1
  buffer_load_dwordx4 v[124:127], v164, s[8:11], s62 offen offset:2048 sc1
  s_add_u32 s62, s62, 4096
  s_waitcnt vmcnt(31)
  v_mfma_f32_16x16x32_bf16 v[148:151], a[0:3], v[0:3], 0
  v_mfma_f32_16x16x32_bf16 v[152:155], a[4:7], v[0:3], 0
  s_waitcnt vmcnt(30)
  v_mfma_f32_16x16x32_bf16 v[148:151], a[8:11], v[4:7], v[148:151]
  v_mfma_f32_16x16x32_bf16 v[152:155], a[12:15], v[4:7], v[152:155]
  s_waitcnt vmcnt(29)
  v_mfma_f32_16x16x32_bf16 v[148:151], a[16:19], v[8:11], v[148:151]
  v_mfma_f32_16x16x32_bf16 v[152:155], a[20:23], v[8:11], v[152:155]
  s_waitcnt vmcnt(28)
  v_mfma_f32_16x16x32_bf16 v[148:151], a[24:27], v[12:15], v[148:151]
  v_mfma_f32_16x16x32_bf16 v[152:155], a[28:31], v[12:15], v[152:155]
  s_waitcnt vmcnt(27)
  v_mfma_f32_16x16x32_bf16 v[148:151], a[32:35], v[16:19], v[148:151]
  v_mfma_f32_16x16x32_bf16 v[152:155], a[36:39], v[16:19], v[152:155]
  s_waitcnt vmcnt(26)
  v_mfma_f32_16x16x32_bf16 v[148:151], a[40:43], v[20:23], v[148:151]
  v_mfma_f32_16x16x32_bf16 v[152:155], a[44:47], v[20:23], v[152:155]
  s_waitcnt vmcnt(25)
  v_mfma_f32_16x16x32_bf16 v[148:151], a[48:51], v[24:27], v[148:151]
  v_mfma_f32_16x16x32_bf16 v[152:155], a[52:55], v[24:27], v[152:155]
  s_waitcnt vmcnt(24)
  v_mfma_f32_16x16x32_bf16 v[148:151], a[56:59], v[28:31], v[148:151]
  v_mfma_f32_16x16x32_bf16 v[152:155], a[60:63], v[28:31], v[152:155]
  s_waitcnt vmcnt(23)
  v_mfma_f32_16x16x32_bf16 v[148:151], a[64:67], v[32:35], v[148:151]
  v_mfma_f32_16x16x32_bf16 v[152:155], a[68:71], v[32:35], v[152:155]
  s_waitcnt vmcnt(22)
  v_mfma_f32_16x16x32_bf16 v[148:151], a[72:75], v[36:39], v[148:151]
  v_mfma_f32_16x16x32_bf16 v[152:155], a[76:79], v[36:39], v[152:155]
  s_waitcnt vmcnt(21)
  v_mfma_f32_16x16x32_bf16 v[148:151], a[80:83], v[40:43], v[148:151]
  v_mfma_f32_16x16x32_bf16 v[152:155], a[84:87], v[40:43], v[152:155]
  s_waitcnt vmcnt(20)
  v_mfma_f32_16x16x32_bf16 v[148:151], a[88:91], v[44:47], v[148:151]
  v_mfma_f32_16x16x32_bf16 v[152:155], a[92:95], v[44:47], v[152:155]
  s_waitcnt vmcnt(19)
  v_mfma_f32_16x16x32_bf16 v[148:151], a[96:99], v[48:51], v[148:151]
  v_mfma_f32_16x16x32_bf16 v[152:155], a[100:103], v[48:51], v[152:155]
  s_waitcnt vmcnt(18)
  v_mfma_f32_16x16x32_bf16 v[148:151], a[104:107], v[52:55], v[148:151]
  v_mfma_f32_16x16x32_bf16 v[152:155], a[108:111], v[52:55], v[152:155]
  s_waitcnt vmcnt(17)
  v_mfma_f32_16x16x32_bf16 v[148:151], a[112:115], v[56:59], v[148:151]
  v_mfma_f32_16x16x32_bf16 v[152:155], a[116:119], v[56:59], v[152:155]
  s_waitcnt vmcnt(16)
  v_mfma_f32_16x16x32_bf16 v[148:151], a[120:123], v[60:63], v[148:151]
  v_mfma_f32_16x16x32_bf16 v[152:155], a[124:127], v[60:63], v[152:155]
  s_waitcnt vmcnt(15)
  v_mfma_f32_16x16x32_bf16 v[148:151], a[128:131], v[64:67], v[148:151]
  v_mfma_f32_16x16x32_bf16 v[152:155], a[132:135], v[64:67], v[152:155]
  s_waitcnt vmcnt(14)
  v_mfma_f32_16x16x32_bf16 v[148:151], a[136:139], v[68:71], v[148:151]
  v_mfma_f32_16x16x32_bf16 v[152:155], a[140:143], v[68:71], v[152:155]
  s_waitcnt vmcnt(13)
  v_mfma_f32_16x16x32_bf16 v[148:151], a[144:147], v[72:75], v[148:151]
  v_mfma_f32_16x16x32_bf16 v[152:155], a[148:151], v[72:75], v[152:155]
  s_waitcnt vmcnt(12)
  v_mfma_f32_16x16x32_bf16 v[148:151], a[152:155], v[76:79], v[148:151]
  v_mfma_f32_16x16x32_bf16 v[152:155], a[156:159], v[76:79], v[152:155]
  s_waitcnt vmcnt(11)
  v_mfma_f32_16x16x32_bf16 v[148:151], a[160:163], v[80:83], v[148:151]
  v_mfma_f32_16x16x32_bf16 v[152:155], a[164:167], v[80:83], v[152:155]
  s_waitcnt vmcnt(10)
  v_mfma_f32_16x16x32_bf16 v[148:151], a[168:171], v[84:87], v[148:151]
  v_mfma_f32_16x16x32_bf16 v[152:155], a[172:175], v[84:87], v[152:155]
  s_waitcnt vmcnt(9)
  v_mfma_f32_16x16x32_bf16 v[148:151], a[176:179], v[88:91], v[148:151]
  v_mfma_f32_16x16x32_bf16 v[152:155], a[180:183], v[88:91], v[152:155]
  s_waitcnt vmcnt(8)
  v_mfma_f32_16x16x32_bf16 v[148:151], a[184:187], v[92:95], v[148:151]
  v_mfma_f32_16x16x32_bf16 v[152:155], a[188:191], v[92:95], v[152:155]
  s_waitcnt vmcnt(7)
  v_mfma_f32_16x16x32_bf16 v[148:151], a[192:195], v[96:99], v[148:151]
  v_mfma_f32_16x16x32_bf16 v[152:155], a[196:199], v[96:99], v[152:155]
  s_waitcnt vmcnt(6)
  v_mfma_f32_16x16x32_bf16 v[148:151], a[200:203], v[100:103], v[148:151]
  v_mfma_f32_16x16x32_bf16 v[152:155], a[204:207], v[100:103], v[152:155]
  s_waitcnt vmcnt(5)
  v_mfma_f32_16x16x32_bf16 v[148:151], a[208:211], v[104:107], v[148:151]
  v_mfma_f32_16x16x32_bf16 v[152:155], a[212:215], v[104:107], v[152:155]
  s_waitcnt vmcnt(4)
  v_mfma_f32_16x16x32_bf16 v[148:151], a[216:219], v[108:111], v[148:151]
  v_mfma_f32_16x16x32_bf16 v[152:155], a[220:223], v[108:111], v[152:155]
  s_waitcnt vmcnt(3)
  v_mfma_f32_16x16x32_bf16 v[148:151], a[224:227], v[112:115], v[148:151]
  v_mfma_f32_16x16x32_bf16 v[152:155], a[228:231], v[112:115], v[152:155]
  s_waitcnt vmcnt(2)
  v_mfma_f32_16x16x32_bf16 v[148:151], a[232:235], v[116:119], v[148:151]
  v_mfma_f32_16x16x32_bf16 v[152:155], a[236:239], v[116:119], v[152:155]
  s_waitcnt vmcnt(1)
  v_mfma_f32_16x16x32_bf16 v[148:151], a[240:243], v[120:123], v[148:151]
  v_mfma_f32_16x16x32_bf16 v[152:155], a[244:247], v[120:123], v[152:155]
  s_waitcnt vmcnt(0)
  v_mfma_f32_16x16x32_bf16 v[148:151], a[248:251], v[124:127], v[148:151]
  v_mfma_f32_16x16x32_bf16 v[152:155], a[252:255], v[124:127], v[152:155]
  s_nop 3
  v_fmac_f32 v156, v165, v148
  v_fmac_f32 v157, v165, v149
  v_fmac_f32 v158, v165, v150
  v_fmac_f32 v159, v165, v151
  v_fmac_f32 v160, v165, v152
  v_fmac_f32 v161, v165, v153
  v_fmac_f32 v162, v165, v154
  v_fmac_f32 v163, v165, v155
  ds_write_b128 v168, v[156:159]
  ds_write_b128 v168, v[160:163] offset:1024
  s_lshl_b32 s54, s70, 6
  s_add_u32 s64, s64, s54
  s_mov_b32 s59, s71
  s_waitcnt lgkmcnt(0)
  s_barrier
  s_cmp_eq_u32 s52, 0
  s_cbranch_scc0 O_next
  ds_read_b128 v[0:3], v201 offset:2048
  ds_read_b128 v[4:7], v201 offset:3072
  ds_read_b128 v[8:11], v201 offset:4096
  ds_read_b128 v[12:15], v201 offset:5120
  ds_read_b128 v[16:19], v201 offset:6144
  ds_read_b128 v[20:23], v201 offset:7168
  s_waitcnt lgkmcnt(5)
  v_add_f32 v156, v156, v0
  v_add_f32 v157, v157, v1
  v_add_f32 v158, v158, v2
  v_add_f32 v159, v159, v3
  s_waitcnt lgkmcnt(4)
  v_add_f32 v160, v160, v4
  v_add_f32 v161, v161, v5
  v_add_f32 v162, v162, v6
  v_add_f32 v163, v163, v7
  s_waitcnt lgkmcnt(3)
  v_add_f32 v156, v156, v8
  v_add_f32 v157, v157, v9
  v_add_f32 v158, v158, v10
  v_add_f32 v159, v159, v11
  s_waitcnt lgkmcnt(2)
  v_add_f32 v160, v160, v12
  v_add_f32 v161, v161, v13
  v_add_f32 v162, v162, v14
  v_add_f32 v163, v163, v15
  s_waitcnt lgkmcnt(1)
  v_add_f32 v156, v156, v16
  v_add_f32 v157, v157, v17
  v_add_f32 v158, v158, v18
  v_add_f32 v159, v159, v19
  s_waitcnt lgkmcnt(0)
  v_add_f32 v160, v160, v20
  v_add_f32 v161, v161, v21
  v_add_f32 v162, v162, v22
  v_add_f32 v163, v163, v23
  v_cvt_pk_bf16_f32 v148, v156, v157
  v_cvt_pk_bf16_f32 v149, v158, v159
  v_cvt_pk_bf16_f32 v150, v160, v161
  v_cvt_pk_bf16_f32 v151, v162, v163
  buffer_store_dwordx4 v[148:151], v167, s[48:51], s64 offen
  s_nop 1
O_next:
  s_cmp_lt_u32 s59, 64
  s_cbranch_scc1 O_loop
  s_branch L_exit
L_cexit:
L_exit:
L_end:
s_endpgm
.section .rodata,"a"
.p2align 6
.amdhsa_kernel gated_mix__sliding_local_dilated__memory_aug_recurrent_mem_tr__prompt_kernel
  .amdhsa_next_free_vgpr 512
  .amdhsa_next_free_sgpr 102
  .amdhsa_accum_offset 256
  .amdhsa_group_segment_fixed_size 0
  .amdhsa_kernarg_size 112
  .amdhsa_user_sgpr_count 2
  .amdhsa_user_sgpr_kernarg_segment_ptr 1
  .amdhsa_system_sgpr_workgroup_id_x 1
.end_amdhsa_kernel
```

```asm
; @launch grid=(256,1,1) block=(256,1,1) lds=163840
.amdgcn_target "amdgcn-amd-amdhsa--gfx950"
.text
.globl gated_mix__sliding_local_dilated__memory_aug_recurrent_mem_tr__prompt_kernel
.p2align 8
.type gated_mix__sliding_local_dilated__memory_aug_recurrent_mem_tr__prompt_kernel,@function
gated_mix__sliding_local_dilated__memory_aug_recurrent_mem_tr__prompt_kernel:
  s_cmp_ge_u32 s2, 256
  s_cbranch_scc1 L_end
  s_load_dwordx2 s[4:5], s[0:1], 0
  s_load_dwordx2 s[8:9], s[0:1], 104
  s_load_dwordx2 s[12:13], s[0:1], 96
  s_load_dwordx2 s[16:17], s[0:1], 40
  s_load_dwordx2 s[20:21], s[0:1], 48
  s_load_dwordx2 s[24:25], s[0:1], 56
  s_load_dwordx2 s[28:29], s[0:1], 64
  s_load_dwordx2 s[32:33], s[0:1], 32
  s_load_dwordx2 s[36:37], s[0:1], 8
  s_load_dwordx2 s[40:41], s[0:1], 16
  s_load_dwordx2 s[44:45], s[0:1], 80
  s_load_dwordx2 s[48:49], s[0:1], 88
  s_getreg_b32 s54, hwreg(HW_REG_XCC_ID, 0, 3)
  v_lshrrev_b32 v1, 6, v0
  s_nop 0
  v_readfirstlane_b32 s52, v1
  s_mov_b32 s6, 2359296
  s_mov_b32 s7, 0x20000
  s_mov_b32 s10, 268435456
  s_mov_b32 s11, 0x20000
  s_mov_b32 s14, 256
  s_mov_b32 s15, 0x20000
  s_mov_b32 s18, 4718592
  s_mov_b32 s19, 0x20000
  s_mov_b32 s22, 4718592
  s_mov_b32 s23, 0x20000
  s_mov_b32 s26, 4718592
  s_mov_b32 s27, 0x20000
  s_mov_b32 s30, 4718592
  s_mov_b32 s31, 0x20000
  s_mov_b32 s34, 9216
  s_mov_b32 s35, 0x20000
  s_mov_b32 s38, 1990656
  s_mov_b32 s39, 0x20000
  s_mov_b32 s42, 663552
  s_mov_b32 s43, 0x20000
  s_mov_b32 s46, 1152
  s_mov_b32 s47, 0x20000
  s_mov_b32 s50, 2359296
  s_mov_b32 s51, 0x20000
  s_waitcnt lgkmcnt(0)
  s_lshr_b32 s0, s2, 3
  s_mov_b32 s2, s54
  s_mov_b32 s1, 0
  s_lshl_b32 s55, s2, 2
  s_cmp_eq_u32 s52, 0
  s_cselect_b32 s55, s55, 0x1000
  s_lshl_b32 s56, 1, s0
  v_mov_b32 v1, 0
  v_mov_b32 v35, s56
  s_mov_b64 exec, 1
  buffer_atomic_or v35, v1, s[12:15], s55 offen sc0
  s_mov_b64 exec, -1
L_role:
  s_mov_b32 s53, s0
  s_cmp_eq_u32 s2, 0
  s_cbranch_scc0 L_worker
  v_and_b32 v0, 63, v0
  v_and_b32 v1, 15, v0
  v_lshrrev_b32 v2, 4, v0
  v_and_b32 v3, 1, v2
  s_lshl_b32 s54, s52, 1
  v_add_u32 v3, s54, v3
  v_lshlrev_b32 v3, 1, v3
  v_xor_b32 v3, v3, v1
  v_lshlrev_b32 v3, 4, v3
  v_lshl_add_u32 v8, v2, 13, v3
  s_lshl_b32 s78, s53, 8
  s_lshl_b32 s54, s52, 15
  s_add_u32 s78, s78, s54
  s_mul_i32 s79, s53, 147456
  s_lshl_b32 s57, s52, 10
  s_add_u32 s57, s57, 16384
  s_getpc_b64 s[80:81]
L_pc_1:
  s_and_b32 s55, s0, 1
  s_lshl_b32 s55, s55, 2
  s_add_u32 s55, s55, s52
  s_lshl_b32 s55, s55, 10
  v_and_b32 v199, 63, v0
  v_lshl_add_u32 v199, v199, 4, s55
  v_min_u32 v199, (L_w0 - L_pc_1), v199
  global_load_dword v196, v199, s[80:81]
  s_add_u32 m0, s57, 0
  s_add_u32 s54, s78, 524288
  buffer_load_dwordx4 v8, s[16:19], s54 offen  lds
  s_add_u32 m0, s57, 4096
  s_add_u32 s54, s78, 655360
  buffer_load_dwordx4 v8, s[16:19], s54 offen  lds
  s_add_u32 m0, s57, 8192
  s_add_u32 s54, s78, 786432
  buffer_load_dwordx4 v8, s[16:19], s54 offen  lds
  s_add_u32 m0, s57, 12288
  s_add_u32 s54, s78, 917504
  buffer_load_dwordx4 v8, s[16:19], s54 offen  lds
  s_add_u32 m0, s57, 16384
  s_add_u32 s54, s78, 1048576
  buffer_load_dwordx4 v8, s[16:19], s54 offen  lds
  s_add_u32 m0, s57, 20480
  s_add_u32 s54, s78, 1179648
  buffer_load_dwordx4 v8, s[16:19], s54 offen  lds
  s_add_u32 m0, s57, 24576
  s_add_u32 s54, s78, 1310720
  buffer_load_dwordx4 v8, s[16:19], s54 offen  lds
  s_add_u32 m0, s57, 28672
  s_add_u32 s54, s78, 1441792
  buffer_load_dwordx4 v8, s[16:19], s54 offen  lds
  s_add_u32 m0, s57, 32768
  s_add_u32 s54, s78, 1572864
  buffer_load_dwordx4 v8, s[16:19], s54 offen  lds
  s_add_u32 m0, s57, 36864
  s_add_u32 s54, s78, 1703936
  buffer_load_dwordx4 v8, s[16:19], s54 offen  lds
  s_add_u32 m0, s57, 40960
  s_add_u32 s54, s78, 1835008
  buffer_load_dwordx4 v8, s[16:19], s54 offen  lds
  s_add_u32 m0, s57, 45056
  s_add_u32 s54, s78, 1966080
  buffer_load_dwordx4 v8, s[16:19], s54 offen  lds
  s_add_u32 m0, s57, 49152
  s_add_u32 s54, s78, 2097152
  buffer_load_dwordx4 v8, s[16:19], s54 offen  lds
  s_add_u32 m0, s57, 53248
  s_add_u32 s54, s78, 2228224
  buffer_load_dwordx4 v8, s[16:19], s54 offen  lds
  s_add_u32 m0, s57, 57344
  s_add_u32 s54, s78, 2359296
  buffer_load_dwordx4 v8, s[16:19], s54 offen  lds
  s_add_u32 m0, s57, 61440
  s_add_u32 s54, s78, 2490368
  buffer_load_dwordx4 v8, s[16:19], s54 offen  lds
  s_add_u32 m0, s57, 65536
  s_add_u32 s54, s78, 2621440
  buffer_load_dwordx4 v8, s[16:19], s54 offen  lds
  s_add_u32 m0, s57, 69632
  s_add_u32 s54, s78, 2752512
  buffer_load_dwordx4 v8, s[16:19], s54 offen  lds
  s_add_u32 m0, s57, 73728
  s_add_u32 s54, s78, 2883584
  buffer_load_dwordx4 v8, s[16:19], s54 offen  lds
  s_add_u32 m0, s57, 77824
  s_add_u32 s54, s78, 3014656
  buffer_load_dwordx4 v8, s[16:19], s54 offen  lds
  v_lshlrev_b32 v76, 4, v0
  v_add_u32 v75, 0x10000, v76
  v_lshrrev_b32 v3, 2, v1
  v_and_b32 v4, 1, v1
  v_lshl_add_u32 v3, v3, 1, v4
  v_bfe_u32 v4, v1, 1, 1
  v_mul_u32_u24 v74, 0xaaaa, v4
  v_add_u32 v74, 0x4444, v74
  v_mul_u32_u24 v5, 576, v3
  v_add_u32 v5, 0, v5
  v_lshl_add_u32 v78, v2, 4, v5
  v_lshl_add_u32 v77, v2, 5, v5
  v_lshl_add_u32 v77, v4, 4, v77
  v_mul_u32_u24 v15, 1152, v3
  v_lshl_add_u32 v15, v2, 5, v15
  v_lshl_add_u32 v15, v4, 4, v15
  s_lshl_b32 s54, s52, 8
  buffer_load_dwordx4 v[20:23], v15, s[32:35], s54 offen
  buffer_load_dwordx4 v[24:27], v15, s[32:35], s54 offen offset:128
  buffer_load_dwordx4 v[28:31], v15, s[32:35], 0 offen offset:1024
  v_mul_u32_u24 v79, 1152, v2
  v_lshl_add_u32 v79, v1, 2, v79
  s_lshl_b32 s54, s52, 6
  s_add_u32 s54, s54, 0
  v_add_u32 v79, s54, v79
  v_lshrrev_b32 v5, 3, v0
  v_mul_u32_u24 v68, 2176, v5
  v_and_b32 v5, 7, v0
  v_lshl_add_u32 v68, v5, 3, v68
  v_and_b32 v5, 1, v2
  v_lshlrev_b32 v5, 4, v5
  v_lshl_add_u32 v5, v1, 2, v5
  v_mov_b32 v6, 0x40000000
  v_cmp_lt_u32 vcc, 3, v1
  s_nop 1
  v_cndmask_b32 v5, v5, v6, vcc
  v_lshrrev_b32 v6, 1, v2
  v_lshl_add_u32 v69, v6, 10, v5
  v_lshl_add_u32 v70, v6, 8, v5
  v_mov_b32 v71, -1
  ds_write_b128 v76, v[68:71] offset:13824
  v_and_b32 v5, 3, v1
  v_lshrrev_b32 v6, 2, v1
  v_lshl_add_u32 v5, v5, 2, v6
  v_and_b32 v6, 1, v5
  v_lshlrev_b32 v6, 4, v6
  v_mov_b32 v7, 0x3f80
  v_lshlrev_b32 v6, v6, v7
  v_lshrrev_b32 v5, 1, v5
  v_cmp_eq_u32 vcc, 0, v5
  s_nop 1
  v_cndmask_b32 v40, 0, v6, vcc
  v_cmp_eq_u32 vcc, 1, v5
  s_nop 1
  v_cndmask_b32 v41, 0, v6, vcc
  v_cmp_eq_u32 vcc, 2, v5
  s_nop 1
  v_cndmask_b32 v42, 0, v6, vcc
  v_cmp_eq_u32 vcc, 3, v5
  s_nop 1
  v_cndmask_b32 v43, 0, v6, vcc
  ds_write_b128 v76, v[40:43] offset:14848
  s_and_b32 s54, s52, 1
  s_lshr_b32 s55, s52, 1
  v_lshrrev_b32 v3, 3, v0
  v_and_b32 v4, 1, v3
  v_lshlrev_b32 v4, 4, v4
  v_and_b32 v5, 6, v3
  v_add_u32 v4, v4, v5
  s_lshl_b32 s56, s55, 3
  s_add_u32 s56, s56, s54
  v_add_u32 v4, s56, v4
  v_mul_u32_u24 v4, 1152, v4
  v_and_b32 v5, 2, v3
  v_lshlrev_b32 v5, 1, v5
  v_and_b32 v6, 7, v0
  v_xor_b32 v6, v6, v5
  v_lshl_add_u32 v9, v6, 4, v4
  v_and_b32 v4, 1, v2
  v_lshlrev_b32 v4, 4, v4
  v_and_b32 v5, 2, v2
  v_add_u32 v4, v4, v5
  s_lshl_b32 s56, s55, 2
  s_add_u32 s56, s56, s54
  v_add_u32 v4, s56, v4
  v_mul_u32_u24 v4, 1152, v4
  v_lshlrev_b32 v6, 1, v2
  v_xor_b32 v6, v6, v1
  v_lshl_add_u32 v10, v6, 4, v4
  v_bfe_u32 v17, v1, 2, 1
  v_bfe_u32 v18, v1, 3, 1
  v_and_b32 v19, 1, v2
  v_lshrrev_b32 v72, 1, v2
  v_and_b32 v73, 3, v1
  v_lshl_add_u32 v3, v19, 1, v17
  v_lshl_add_u32 v6, v18, 2, v3
  v_lshl_add_u32 v4, v72, 4, v17
  v_lshl_add_u32 v4, v19, 2, v4
  v_lshl_add_u32 v4, v18, 3, v4
  v_lshlrev_b32 v4, 8, v4
  s_lshl_b32 s54, s52, 6
  v_lshl_add_u32 v5, v73, 3, s54
  v_lshlrev_b32 v7, 5, v6
  v_xor_b32 v5, v5, v7
  v_add_u32 v11, v4, v5
  v_xor_b32 v12, 32, v11
  v_lshl_add_u32 v4, v72, 2, v3
  v_lshlrev_b32 v4, 7, v4
  v_lshl_add_u32 v4, v73, 3, v4
  s_and_b32 s54, s52, 1
  v_xor_b32 v7, s54, v19
  v_lshl_add_u32 v7, v7, 1, v18
  v_lshl_add_u32 v13, v7, 5, v4
  v_lshlrev_b32 v4, 11, v72
  v_lshl_add_u32 v4, v73, 3, v4
  v_lshl_add_u32 v5, v3, 8, v4
  v_lshl_add_u32 v7, v18, 2, s52
  v_xor_b32 v7, v7, v3
  v_lshl_add_u32 v14, v7, 5, v5
  s_lshl_b32 s54, s53, 14
  s_lshl_b32 s55, s52, 11
  s_add_u32 s54, s54, 1048576
  s_add_u32 s58, s54, s55
  s_add_u32 s59, s58, 8192
  s_lshl_b32 s55, s52, 12
  s_add_u32 s70, s54, s55
  s_add_u32 s70, s70, 655360
  s_lshl_b32 s54, s53, 12
  s_lshl_b32 s55, s52, 10
  s_add_u32 s54, s54, s55
  s_add_u32 s68, s54, 917504
  s_lshl_b32 s54, s53, 6
  s_mul_i32 s55, s52, 17408
  s_add_u32 s55, s54, s55
  s_add_u32 s73, s55, 0
  s_add_u32 s74, s55, 69632
  s_add_u32 s75, s55, 139264
  s_add_u32 s76, s55, 208896
  s_and_b32 s56, s52, 1
  s_mul_i32 s55, s56, 17408
  s_add_u32 s55, s54, s55
  s_add_u32 s77, s55, 278528
  s_mul_i32 s54, s52, 69632
  s_mul_i32 s55, s53, 2176
  s_add_u32 s54, s54, s55
  s_add_u32 s60, s54, 0
  s_and_b32 s56, s53, 15
  s_mul_i32 s55, s56, 2176
  s_add_u32 s61, s55, 278528
  s_lshl_b32 s54, s52, 11
  s_add_u32 s64, s54, 360448
  s_mov_b32 s65, 368640
  s_lshl_b32 s55, s53, 5
  s_add_u32 s54, s54, s55
  s_add_u32 s62, s54, 376832
  s_lshr_b32 s54, s56, 3
  s_lshl_b32 s54, s54, 9
  s_and_b32 s55, s56, 7
  s_lshl_b32 s55, s55, 5
  s_add_u32 s54, s54, s55
  s_add_u32 s63, s54, 385024
  s_mov_b32 s66, 0
  s_mov_b32 s67, 0
  s_mov_b32 s72, 0
  s_mov_b32 s69, 1040356334
  s_waitcnt vmcnt(19) lgkmcnt(0)
  s_barrier
  s_add_u32 m0, s57, 81920
  s_add_u32 s54, s78, 3145728
  buffer_load_dwordx4 v8, s[16:19], s54 offen  lds
  s_add_u32 m0, s57, 86016
  s_add_u32 s54, s78, 3276800
  buffer_load_dwordx4 v8, s[16:19], s54 offen  lds
  s_add_u32 m0, s57, 90112
  s_add_u32 s54, s78, 3407872
  buffer_load_dwordx4 v8, s[16:19], s54 offen  lds
  s_add_u32 m0, s57, 94208
  s_add_u32 s54, s78, 3538944
  buffer_load_dwordx4 v8, s[16:19], s54 offen  lds
  v_add_u32 v15, 16384, v11
  v_add_u32 v16, 16384, v12
  ds_read_b64_tr_b16 v[80:81], v15 offset:0
  ds_read_b64_tr_b16 v[82:83], v15 offset:512
  ds_read_b64_tr_b16 v[84:85], v15 offset:8192
  ds_read_b64_tr_b16 v[86:87], v15 offset:8704
  ds_read_b64_tr_b16 v[88:89], v16 offset:0
  ds_read_b64_tr_b16 v[90:91], v16 offset:512
  ds_read_b64_tr_b16 v[92:93], v16 offset:8192
  ds_read_b64_tr_b16 v[94:95], v16 offset:8704
  s_waitcnt vmcnt(19) lgkmcnt(0)
  s_barrier
  s_add_u32 m0, s57, 98304
  s_add_u32 s54, s78, 3670016
  buffer_load_dwordx4 v8, s[16:19], s54 offen  lds
  s_add_u32 m0, s57, 102400
  s_add_u32 s54, s78, 3801088
  buffer_load_dwordx4 v8, s[16:19], s54 offen  lds
  s_add_u32 m0, s57, 106496
  s_add_u32 s54, s78, 3932160
  buffer_load_dwordx4 v8, s[16:19], s54 offen  lds
  s_add_u32 m0, s57, 110592
  s_add_u32 s54, s78, 4063232
  buffer_load_dwordx4 v8, s[16:19], s54 offen  lds
  v_add_u32 v15, 32768, v11
  v_add_u32 v16, 32768, v12
  ds_read_b64_tr_b16 v[96:97], v15 offset:0
  ds_read_b64_tr_b16 v[98:99], v15 offset:512
  ds_read_b64_tr_b16 v[100:101], v15 offset:8192
  ds_read_b64_tr_b16 v[102:103], v15 offset:8704
  ds_read_b64_tr_b16 v[104:105], v16 offset:0
  ds_read_b64_tr_b16 v[106:107], v16 offset:512
  ds_read_b64_tr_b16 v[108:109], v16 offset:8192
  ds_read_b64_tr_b16 v[110:111], v16 offset:8704
  s_waitcnt vmcnt(19) lgkmcnt(0)
  s_barrier
  s_add_u32 m0, s57, 114688
  s_add_u32 s54, s78, 4194304
  buffer_load_dwordx4 v8, s[16:19], s54 offen  lds
  s_add_u32 m0, s57, 118784
  s_add_u32 s54, s78, 4325376
  buffer_load_dwordx4 v8, s[16:19], s54 offen  lds
  s_add_u32 m0, s57, 122880
  s_add_u32 s54, s78, 4456448
  buffer_load_dwordx4 v8, s[16:19], s54 offen  lds
  s_add_u32 m0, s57, 126976
  s_add_u32 s54, s78, 4587520
  buffer_load_dwordx4 v8, s[16:19], s54 offen  lds
  v_add_u32 v15, 49152, v11
  v_add_u32 v16, 49152, v12
  ds_read_b64_tr_b16 v[112:113], v15 offset:0
  ds_read_b64_tr_b16 v[114:115], v15 offset:512
  ds_read_b64_tr_b16 v[116:117], v15 offset:8192
  ds_read_b64_tr_b16 v[118:119], v15 offset:8704
  ds_read_b64_tr_b16 v[120:121], v16 offset:0
  ds_read_b64_tr_b16 v[122:123], v16 offset:512
  ds_read_b64_tr_b16 v[124:125], v16 offset:8192
  ds_read_b64_tr_b16 v[126:127], v16 offset:8704
  s_waitcnt vmcnt(19) lgkmcnt(0)
  s_barrier
  s_add_u32 m0, s57, 131072
  s_add_u32 s54, s78, 524288
  buffer_load_dwordx4 v8, s[20:23], s54 offen  lds
  s_add_u32 m0, s57, 135168
  s_add_u32 s54, s78, 655360
  buffer_load_dwordx4 v8, s[20:23], s54 offen  lds
  s_add_u32 m0, s57, 139264
  s_add_u32 s54, s78, 786432
  buffer_load_dwordx4 v8, s[20:23], s54 offen  lds
  s_add_u32 m0, s57, 143360
  s_add_u32 s54, s78, 917504
  buffer_load_dwordx4 v8, s[20:23], s54 offen  lds
  v_add_u32 v15, 65536, v11
  v_add_u32 v16, 65536, v12
  ds_read_b64_tr_b16 v[128:129], v15 offset:0
  ds_read_b64_tr_b16 v[130:131], v15 offset:512
  ds_read_b64_tr_b16 v[132:133], v15 offset:8192
  ds_read_b64_tr_b16 v[134:135], v15 offset:8704
  ds_read_b64_tr_b16 v[136:137], v16 offset:0
  ds_read_b64_tr_b16 v[138:139], v16 offset:512
  ds_read_b64_tr_b16 v[140:141], v16 offset:8192
  ds_read_b64_tr_b16 v[142:143], v16 offset:8704
  s_waitcnt vmcnt(19) lgkmcnt(0)
  s_barrier
  s_add_u32 m0, s57, 0
  s_add_u32 s54, s78, 1572864
  buffer_load_dwordx4 v8, s[20:23], s54 offen  lds
  s_add_u32 m0, s57, 4096
  s_add_u32 s54, s78, 1703936
  buffer_load_dwordx4 v8, s[20:23], s54 offen  lds
  s_add_u32 m0, s57, 8192
  s_add_u32 s54, s78, 1835008
  buffer_load_dwordx4 v8, s[20:23], s54 offen  lds
  s_add_u32 m0, s57, 12288
  s_add_u32 s54, s78, 1966080
  buffer_load_dwordx4 v8, s[20:23], s54 offen  lds
  v_add_u32 v15, 81920, v11
  v_add_u32 v16, 81920, v12
  ds_read_b64_tr_b16 v[144:145], v15 offset:0
  ds_read_b64_tr_b16 v[146:147], v15 offset:512
  ds_read_b64_tr_b16 v[148:149], v15 offset:8192
  ds_read_b64_tr_b16 v[150:151], v15 offset:8704
  ds_read_b64_tr_b16 v[152:153], v16 offset:0
  ds_read_b64_tr_b16 v[154:155], v16 offset:512
  ds_read_b64_tr_b16 v[156:157], v16 offset:8192
  ds_read_b64_tr_b16 v[158:159], v16 offset:8704
  s_waitcnt vmcnt(16) lgkmcnt(0)
  s_barrier
  s_add_u32 m0, s57, 16384
  s_add_u32 s54, s78, 3145728
  buffer_load_dwordx4 v8, s[20:23], s54 offen  lds
  s_add_u32 m0, s57, 20480
  s_add_u32 s54, s78, 3276800
  buffer_load_dwordx4 v8, s[20:23], s54 offen  lds
  s_add_u32 m0, s57, 24576
  s_add_u32 s54, s78, 3407872
  buffer_load_dwordx4 v8, s[20:23], s54 offen  lds
  s_add_u32 m0, s57, 28672
  s_add_u32 s54, s78, 3538944
  buffer_load_dwordx4 v8, s[20:23], s54 offen  lds
  v_add_u32 v15, 98304, v11
  v_add_u32 v16, 98304, v12
  ds_read_b64_tr_b16 v[160:161], v15 offset:0
  ds_read_b64_tr_b16 v[162:163], v15 offset:512
  ds_read_b64_tr_b16 v[164:165], v15 offset:8192
  ds_read_b64_tr_b16 v[166:167], v15 offset:8704
  ds_read_b64_tr_b16 v[168:169], v16 offset:0
  ds_read_b64_tr_b16 v[170:171], v16 offset:512
  ds_read_b64_tr_b16 v[172:173], v16 offset:8192
  ds_read_b64_tr_b16 v[174:175], v16 offset:8704
  s_waitcnt vmcnt(16) lgkmcnt(0)
  s_barrier
  s_add_u32 m0, s57, 32768
  s_add_u32 s54, s78, 3670016
  buffer_load_dwordx4 v8, s[20:23], s54 offen  lds
  s_add_u32 m0, s57, 36864
  s_add_u32 s54, s78, 3801088
  buffer_load_dwordx4 v8, s[20:23], s54 offen  lds
  s_add_u32 m0, s57, 40960
  s_add_u32 s54, s78, 3932160
  buffer_load_dwordx4 v8, s[20:23], s54 offen  lds
  s_add_u32 m0, s57, 45056
  s_add_u32 s54, s78, 4063232
  buffer_load_dwordx4 v8, s[20:23], s54 offen  lds
  s_cmp_eq_u32 s1, 1
  s_cbranch_scc1 C_ver_ok
  v_mov_b32 v33, 16320
  s_cmp_eq_u32 s52, 0
  s_cbranch_scc0 C_ver_b
  s_waitcnt vmcnt(52)
  s_mov_b64 exec, 1
  ds_write_b32 v33, v35
  s_mov_b64 exec, -1
  s_waitcnt lgkmcnt(0)
C_ver_b:
  s_barrier
  ds_read_b32 v32, v33
  s_waitcnt lgkmcnt(0)
  v_readfirstlane_b32 s54, v32
  s_nop 0
  s_bitcmp1_b32 s54, s0
  s_cbranch_scc1 L_conf
C_ver_ok:
  v_add_u32 v15, 114688, v11
  v_add_u32 v16, 114688, v12
  ds_read_b64_tr_b16 v[176:177], v15 offset:0
  ds_read_b64_tr_b16 v[178:179], v15 offset:512
  ds_read_b64_tr_b16 v[180:181], v15 offset:8192
  ds_read_b64_tr_b16 v[182:183], v15 offset:8704
  ds_read_b64_tr_b16 v[184:185], v16 offset:0
  ds_read_b64_tr_b16 v[186:187], v16 offset:512
  ds_read_b64_tr_b16 v[188:189], v16 offset:8192
  ds_read_b64_tr_b16 v[190:191], v16 offset:8704
  s_waitcnt vmcnt(16) lgkmcnt(0)
  s_barrier
  s_add_u32 m0, s57, 49152
  s_add_u32 s54, s78, 4194304
  buffer_load_dwordx4 v8, s[20:23], s54 offen  lds
  s_add_u32 m0, s57, 53248
  s_add_u32 s54, s78, 4325376
  buffer_load_dwordx4 v8, s[20:23], s54 offen  lds
  s_add_u32 m0, s57, 57344
  s_add_u32 s54, s78, 4456448
  buffer_load_dwordx4 v8, s[20:23], s54 offen  lds
  s_add_u32 m0, s57, 61440
  s_add_u32 s54, s78, 4587520
  buffer_load_dwordx4 v8, s[20:23], s54 offen  lds
  v_add_u32 v15, 131072, v11
  v_add_u32 v16, 131072, v12
  ds_read_b64_tr_b16 v[192:193], v15 offset:0
  ds_read_b64_tr_b16 v[194:195], v15 offset:512
  ds_read_b64_tr_b16 v[196:197], v15 offset:8192
  ds_read_b64_tr_b16 v[198:199], v15 offset:8704
  ds_read_b64_tr_b16 v[200:201], v16 offset:0
  ds_read_b64_tr_b16 v[202:203], v16 offset:512
  ds_read_b64_tr_b16 v[204:205], v16 offset:8192
  ds_read_b64_tr_b16 v[206:207], v16 offset:8704
  s_waitcnt vmcnt(16) lgkmcnt(0)
  s_barrier
  s_add_u32 m0, s57, 65536
  s_add_u32 s54, s78, 0
  buffer_load_dwordx4 v8, s[24:27], s54 offen  lds
  s_add_u32 m0, s57, 69632
  s_add_u32 s54, s78, 131072
  buffer_load_dwordx4 v8, s[24:27], s54 offen  lds
  s_add_u32 m0, s57, 73728
  s_add_u32 s54, s78, 262144
  buffer_load_dwordx4 v8, s[24:27], s54 offen  lds
  s_add_u32 m0, s57, 77824
  s_add_u32 s54, s78, 393216
  buffer_load_dwordx4 v8, s[24:27], s54 offen  lds
  s_getpc_b64 s[80:81]
  v_lshlrev_b32 v7, 2, v76
  global_load_dword v35, v7, s[80:81] offset:1024
  v_mov_b32 v4, -1
  v_mov_b32 v5, -1
  v_mov_b64 v[6:7], v[4:5]
  s_lshl_b32 s56, s53, 14
  s_xor_b32 s54, s64, s56
  s_xor_b32 s55, s65, s56
  s_cmp_lt_u32 s53, 2
  s_cselect_b32 s54, s54, 268435456
  s_cselect_b32 s55, s55, 268435456
  s_lshr_b32 s56, s53, 4
  s_or_b32 s56, s56, s52
  s_cmp_eq_u32 s56, 0
  s_cselect_b32 s56, s61, 268435456
  buffer_store_dwordx4 v[4:7], v76, s[8:11], s60 offen offset:0 sc1
  buffer_store_dwordx4 v[4:7], v76, s[8:11], s60 offen offset:1024 sc1
  buffer_store_dwordx4 v[4:7], v76, s[8:11], s56 offen offset:0 sc1
  buffer_store_dwordx4 v[4:7], v76, s[8:11], s56 offen offset:1024 sc1
  buffer_store_dwordx4 v[4:7], v76, s[8:11], s54 offen offset:0 sc1
  buffer_store_dwordx4 v[4:7], v76, s[8:11], s54 offen offset:1024 sc1
  buffer_store_dwordx4 v[4:7], v76, s[8:11], s55 offen offset:0 sc1
  v_min_u32 v20, -2, v20
  v_min_u32 v21, -2, v21
  v_min_u32 v22, -2, v22
  v_min_u32 v23, -2, v23
  v_min_u32 v24, -2, v24
  v_min_u32 v25, -2, v25
  v_min_u32 v26, -2, v26
  v_min_u32 v27, -2, v27
  v_min_u32 v28, -2, v28
  v_min_u32 v29, -2, v29
  v_min_u32 v30, -2, v30
  v_min_u32 v31, -2, v31
  s_lshl_b32 s54, s52, 11
  v_add_u32 v3, s54, v76
  ds_write_b128 v3, v[20:23] offset:4608
  ds_write_b128 v3, v[24:27] offset:5632
  ds_write_b128 v76, v[28:31] offset:12800
  v_add_u32 v15, 147456, v11
  v_add_u32 v16, 147456, v12
  ds_read_b64_tr_b16 v[208:209], v15 offset:0
  ds_read_b64_tr_b16 v[210:211], v15 offset:512
  ds_read_b64_tr_b16 v[212:213], v15 offset:8192
  ds_read_b64_tr_b16 v[214:215], v15 offset:8704
  ds_read_b64_tr_b16 v[216:217], v16 offset:0
  ds_read_b64_tr_b16 v[218:219], v16 offset:512
  ds_read_b64_tr_b16 v[220:221], v16 offset:8192
  ds_read_b64_tr_b16 v[222:223], v16 offset:8704
  s_waitcnt vmcnt(24) lgkmcnt(0)
  s_barrier
  s_add_u32 m0, s57, 81920
  s_add_u32 s54, s78, 524288
  buffer_load_dwordx4 v8, s[24:27], s54 offen  lds
  s_add_u32 m0, s57, 86016
  s_add_u32 s54, s78, 655360
  buffer_load_dwordx4 v8, s[24:27], s54 offen  lds
  s_add_u32 m0, s57, 90112
  s_add_u32 s54, s78, 786432
  buffer_load_dwordx4 v8, s[24:27], s54 offen  lds
  s_add_u32 m0, s57, 94208
  s_add_u32 s54, s78, 917504
  buffer_load_dwordx4 v8, s[24:27], s54 offen  lds
  v_add_u32 v15, 16384, v11
  v_add_u32 v16, 16384, v12
  ds_read_b64_tr_b16 v[224:225], v15 offset:0
  ds_read_b64_tr_b16 v[226:227], v15 offset:512
  ds_read_b64_tr_b16 v[228:229], v15 offset:8192
  ds_read_b64_tr_b16 v[230:231], v15 offset:8704
  ds_read_b64_tr_b16 v[232:233], v16 offset:0
  ds_read_b64_tr_b16 v[234:235], v16 offset:512
  ds_read_b64_tr_b16 v[236:237], v16 offset:8192
  ds_read_b64_tr_b16 v[238:239], v16 offset:8704
  s_waitcnt vmcnt(24) lgkmcnt(0)
  s_barrier
  s_add_u32 m0, s57, 98304
  s_add_u32 s54, s78, 1048576
  buffer_load_dwordx4 v8, s[24:27], s54 offen  lds
  s_add_u32 m0, s57, 102400
  s_add_u32 s54, s78, 1179648
  buffer_load_dwordx4 v8, s[24:27], s54 offen  lds
  s_add_u32 m0, s57, 106496
  s_add_u32 s54, s78, 1310720
  buffer_load_dwordx4 v8, s[24:27], s54 offen  lds
  s_add_u32 m0, s57, 110592
  s_add_u32 s54, s78, 1441792
  buffer_load_dwordx4 v8, s[24:27], s54 offen  lds
  v_add_u32 v15, 32768, v11
  v_add_u32 v16, 32768, v12
  ds_read_b64_tr_b16 v[240:241], v15 offset:0
  ds_read_b64_tr_b16 v[242:243], v15 offset:512
  ds_read_b64_tr_b16 v[244:245], v15 offset:8192
  ds_read_b64_tr_b16 v[246:247], v15 offset:8704
  ds_read_b64_tr_b16 v[248:249], v16 offset:0
  ds_read_b64_tr_b16 v[250:251], v16 offset:512
  ds_read_b64_tr_b16 v[252:253], v16 offset:8192
  ds_read_b64_tr_b16 v[254:255], v16 offset:8704
  s_waitcnt vmcnt(24) lgkmcnt(0)
  s_barrier
  s_add_u32 m0, s57, 114688
  s_add_u32 s54, s78, 1572864
  buffer_load_dwordx4 v8, s[24:27], s54 offen  lds
  s_add_u32 m0, s57, 118784
  s_add_u32 s54, s78, 1703936
  buffer_load_dwordx4 v8, s[24:27], s54 offen  lds
  s_add_u32 m0, s57, 122880
  s_add_u32 s54, s78, 1835008
  buffer_load_dwordx4 v8, s[24:27], s54 offen  lds
  s_add_u32 m0, s57, 126976
  s_add_u32 s54, s78, 1966080
  buffer_load_dwordx4 v8, s[24:27], s54 offen  lds
  v_add_u32 v15, 49152, v11
  v_add_u32 v16, 49152, v12
  ds_read_b64_tr_b16 a[0:1], v15 offset:0
  ds_read_b64_tr_b16 a[2:3], v15 offset:512
  ds_read_b64_tr_b16 a[4:5], v15 offset:8192
  ds_read_b64_tr_b16 a[6:7], v15 offset:8704
  ds_read_b64_tr_b16 a[8:9], v16 offset:0
  ds_read_b64_tr_b16 a[10:11], v16 offset:512
  ds_read_b64_tr_b16 a[12:13], v16 offset:8192
  ds_read_b64_tr_b16 a[14:15], v16 offset:8704
  s_waitcnt vmcnt(24) lgkmcnt(0)
  s_barrier
  s_add_u32 m0, s57, 131072
  s_add_u32 s54, s78, 2097152
  buffer_load_dwordx4 v8, s[24:27], s54 offen  lds
  s_add_u32 m0, s57, 135168
  s_add_u32 s54, s78, 2228224
  buffer_load_dwordx4 v8, s[24:27], s54 offen  lds
  s_add_u32 m0, s57, 139264
  s_add_u32 s54, s78, 2359296
  buffer_load_dwordx4 v8, s[24:27], s54 offen  lds
  s_add_u32 m0, s57, 143360
  s_add_u32 s54, s78, 2490368
  buffer_load_dwordx4 v8, s[24:27], s54 offen  lds
  v_add_u32 v15, 65536, v11
  v_add_u32 v16, 65536, v12
  ds_read_b64_tr_b16 a[16:17], v15 offset:0
  ds_read_b64_tr_b16 a[18:19], v15 offset:512
  ds_read_b64_tr_b16 a[20:21], v15 offset:8192
  ds_read_b64_tr_b16 a[22:23], v15 offset:8704
  ds_read_b64_tr_b16 a[24:25], v16 offset:0
  ds_read_b64_tr_b16 a[26:27], v16 offset:512
  ds_read_b64_tr_b16 a[28:29], v16 offset:8192
  ds_read_b64_tr_b16 a[30:31], v16 offset:8704
  s_waitcnt vmcnt(24) lgkmcnt(0)
  s_barrier
  s_add_u32 m0, s57, 0
  s_add_u32 s54, s78, 2621440
  buffer_load_dwordx4 v8, s[24:27], s54 offen  lds
  s_add_u32 m0, s57, 4096
  s_add_u32 s54, s78, 2752512
  buffer_load_dwordx4 v8, s[24:27], s54 offen  lds
  s_add_u32 m0, s57, 8192
  s_add_u32 s54, s78, 2883584
  buffer_load_dwordx4 v8, s[24:27], s54 offen  lds
  s_add_u32 m0, s57, 12288
  s_add_u32 s54, s78, 3014656
  buffer_load_dwordx4 v8, s[24:27], s54 offen  lds
  v_add_u32 v15, 81920, v11
  v_add_u32 v16, 81920, v12
  ds_read_b64_tr_b16 a[32:33], v15 offset:0
  ds_read_b64_tr_b16 a[34:35], v15 offset:512
  ds_read_b64_tr_b16 a[36:37], v15 offset:8192
  ds_read_b64_tr_b16 a[38:39], v15 offset:8704
  ds_read_b64_tr_b16 a[40:41], v16 offset:0
  ds_read_b64_tr_b16 a[42:43], v16 offset:512
  ds_read_b64_tr_b16 a[44:45], v16 offset:8192
  ds_read_b64_tr_b16 a[46:47], v16 offset:8704
  s_waitcnt vmcnt(16) lgkmcnt(0)
  s_barrier
  s_add_u32 m0, s57, 16384
  s_add_u32 s54, s78, 3145728
  buffer_load_dwordx4 v8, s[24:27], s54 offen  lds
  s_add_u32 m0, s57, 20480
  s_add_u32 s54, s78, 3276800
  buffer_load_dwordx4 v8, s[24:27], s54 offen  lds
  s_add_u32 m0, s57, 24576
  s_add_u32 s54, s78, 3407872
  buffer_load_dwordx4 v8, s[24:27], s54 offen  lds
  s_add_u32 m0, s57, 28672
  s_add_u32 s54, s78, 3538944
  buffer_load_dwordx4 v8, s[24:27], s54 offen  lds
  s_getpc_b64 s[80:81]
  v_lshlrev_b32 v7, 2, v76
  global_load_dword v35, v7, s[80:81] offset:1024
  v_add_u32 v15, 98304, v11
  v_add_u32 v16, 98304, v12
  ds_read_b64_tr_b16 a[48:49], v15 offset:0
  ds_read_b64_tr_b16 a[50:51], v15 offset:512
  ds_read_b64_tr_b16 a[52:53], v15 offset:8192
  ds_read_b64_tr_b16 a[54:55], v15 offset:8704
  ds_read_b64_tr_b16 a[56:57], v16 offset:0
  ds_read_b64_tr_b16 a[58:59], v16 offset:512
  ds_read_b64_tr_b16 a[60:61], v16 offset:8192
  ds_read_b64_tr_b16 a[62:63], v16 offset:8704
  s_waitcnt vmcnt(17) lgkmcnt(0)
  s_barrier
  s_add_u32 m0, s57, 32768
  s_add_u32 s54, s78, 3670016
  buffer_load_dwordx4 v8, s[24:27], s54 offen  lds
  s_add_u32 m0, s57, 36864
  s_add_u32 s54, s78, 3801088
  buffer_load_dwordx4 v8, s[24:27], s54 offen  lds
  s_add_u32 m0, s57, 40960
  s_add_u32 s54, s78, 3932160
  buffer_load_dwordx4 v8, s[24:27], s54 offen  lds
  s_add_u32 m0, s57, 45056
  s_add_u32 s54, s78, 4063232
  buffer_load_dwordx4 v8, s[24:27], s54 offen  lds
  v_add_u32 v15, 114688, v11
  v_add_u32 v16, 114688, v12
  ds_read_b64_tr_b16 a[64:65], v15 offset:0
  ds_read_b64_tr_b16 a[66:67], v15 offset:512
  ds_read_b64_tr_b16 a[68:69], v15 offset:8192
  ds_read_b64_tr_b16 a[70:71], v15 offset:8704
  ds_read_b64_tr_b16 a[72:73], v16 offset:0
  ds_read_b64_tr_b16 a[74:75], v16 offset:512
  ds_read_b64_tr_b16 a[76:77], v16 offset:8192
  ds_read_b64_tr_b16 a[78:79], v16 offset:8704
  s_waitcnt vmcnt(17) lgkmcnt(0)
  s_barrier
  s_add_u32 m0, s57, 49152
  s_add_u32 s54, s78, 4194304
  buffer_load_dwordx4 v8, s[24:27], s54 offen  lds
  s_add_u32 m0, s57, 53248
  s_add_u32 s54, s78, 4325376
  buffer_load_dwordx4 v8, s[24:27], s54 offen  lds
  s_add_u32 m0, s57, 57344
  s_add_u32 s54, s78, 4456448
  buffer_load_dwordx4 v8, s[24:27], s54 offen  lds
  s_add_u32 m0, s57, 61440
  s_add_u32 s54, s78, 4587520
  buffer_load_dwordx4 v8, s[24:27], s54 offen  lds
  v_add_u32 v15, 131072, v11
  v_add_u32 v16, 131072, v12
  ds_read_b64_tr_b16 a[80:81], v15 offset:0
  ds_read_b64_tr_b16 a[82:83], v15 offset:512
  ds_read_b64_tr_b16 a[84:85], v15 offset:8192
  ds_read_b64_tr_b16 a[86:87], v15 offset:8704
  ds_read_b64_tr_b16 a[88:89], v16 offset:0
  ds_read_b64_tr_b16 a[90:91], v16 offset:512
  ds_read_b64_tr_b16 a[92:93], v16 offset:8192
  ds_read_b64_tr_b16 a[94:95], v16 offset:8704
  s_waitcnt vmcnt(17) lgkmcnt(0)
  s_barrier
  s_add_u32 m0, s57, 65536
  s_add_u32 s54, s79, 73728
  buffer_load_dwordx4 v10, s[28:31], s54 offen  lds
  s_add_u32 m0, s57, 69632
  s_add_u32 s54, s79, 82944
  buffer_load_dwordx4 v10, s[28:31], s54 offen  lds
  s_add_u32 m0, s57, 73728
  s_add_u32 s54, s79, 110592
  buffer_load_dwordx4 v10, s[28:31], s54 offen  lds
  s_add_u32 m0, s57, 77824
  s_add_u32 s54, s79, 119808
  buffer_load_dwordx4 v10, s[28:31], s54 offen  lds
  s_cmp_eq_u32 s52, 0
  s_cselect_b32 s54, 32, 0x1000
  v_mov_b32 v32, 1
  v_mov_b32 v7, 0
  s_mov_b64 exec, 1
  buffer_atomic_add v32, v7, s[12:15], s54 offen
  s_mov_b64 exec, -1
  v_add_u32 v15, 147456, v11
  v_add_u32 v16, 147456, v12
  ds_read_b64_tr_b16 a[96:97], v15 offset:0
  ds_read_b64_tr_b16 a[98:99], v15 offset:512
  ds_read_b64_tr_b16 a[100:101], v15 offset:8192
  ds_read_b64_tr_b16 a[102:103], v15 offset:8704
  ds_read_b64_tr_b16 a[104:105], v16 offset:0
  ds_read_b64_tr_b16 a[106:107], v16 offset:512
  ds_read_b64_tr_b16 a[108:109], v16 offset:8192
  ds_read_b64_tr_b16 a[110:111], v16 offset:8704
  s_waitcnt vmcnt(18) lgkmcnt(0)
  s_barrier
  s_add_u32 m0, s57, 81920
  s_add_u32 s54, s79, 256
  buffer_load_dwordx4 v10, s[28:31], s54 offen  lds
  s_add_u32 m0, s57, 86016
  s_add_u32 s54, s79, 9472
  buffer_load_dwordx4 v10, s[28:31], s54 offen  lds
  s_add_u32 m0, s57, 90112
  s_add_u32 s54, s79, 37120
  buffer_load_dwordx4 v10, s[28:31], s54 offen  lds
  s_add_u32 m0, s57, 94208
  s_add_u32 s54, s79, 46336
  buffer_load_dwordx4 v10, s[28:31], s54 offen  lds
  v_add_u32 v15, 16384, v11
  v_add_u32 v16, 16384, v12
  ds_read_b64_tr_b16 a[112:113], v15 offset:0
  ds_read_b64_tr_b16 a[114:115], v15 offset:512
  ds_read_b64_tr_b16 a[116:117], v15 offset:8192
  ds_read_b64_tr_b16 a[118:119], v15 offset:8704
  ds_read_b64_tr_b16 a[120:121], v16 offset:0
  ds_read_b64_tr_b16 a[122:123], v16 offset:512
  ds_read_b64_tr_b16 a[124:125], v16 offset:8192
  ds_read_b64_tr_b16 a[126:127], v16 offset:8704
  s_waitcnt vmcnt(18) lgkmcnt(0)
  s_barrier
  s_add_u32 m0, s57, 98304
  s_add_u32 s54, s79, 512
  buffer_load_dwordx4 v10, s[28:31], s54 offen  lds
  s_add_u32 m0, s57, 102400
  s_add_u32 s54, s79, 9728
  buffer_load_dwordx4 v10, s[28:31], s54 offen  lds
  s_add_u32 m0, s57, 106496
  s_add_u32 s54, s79, 37376
  buffer_load_dwordx4 v10, s[28:31], s54 offen  lds
  s_add_u32 m0, s57, 110592
  s_add_u32 s54, s79, 46592
  buffer_load_dwordx4 v10, s[28:31], s54 offen  lds
  v_add_u32 v15, 32768, v11
  v_add_u32 v16, 32768, v12
  ds_read_b64_tr_b16 a[128:129], v15 offset:0
  ds_read_b64_tr_b16 a[130:131], v15 offset:512
  ds_read_b64_tr_b16 a[132:133], v15 offset:8192
  ds_read_b64_tr_b16 a[134:135], v15 offset:8704
  ds_read_b64_tr_b16 a[136:137], v16 offset:0
  ds_read_b64_tr_b16 a[138:139], v16 offset:512
  ds_read_b64_tr_b16 a[140:141], v16 offset:8192
  ds_read_b64_tr_b16 a[142:143], v16 offset:8704
  s_waitcnt vmcnt(17) lgkmcnt(0)
  s_barrier
  s_add_u32 m0, s57, 114688
  s_add_u32 s54, s79, 768
  buffer_load_dwordx4 v10, s[28:31], s54 offen  lds
  s_add_u32 m0, s57, 118784
  s_add_u32 s54, s79, 9984
  buffer_load_dwordx4 v10, s[28:31], s54 offen  lds
  s_add_u32 m0, s57, 122880
  s_add_u32 s54, s79, 37632
  buffer_load_dwordx4 v10, s[28:31], s54 offen  lds
  s_add_u32 m0, s57, 126976
  s_add_u32 s54, s79, 46848
  buffer_load_dwordx4 v10, s[28:31], s54 offen  lds
  s_getpc_b64 s[80:81]
  v_lshlrev_b32 v7, 2, v76
  global_load_dword v35, v7, s[80:81] offset:1024
  v_add_u32 v15, 49152, v11
  v_add_u32 v16, 49152, v12
  ds_read_b64_tr_b16 a[144:145], v15 offset:0
  ds_read_b64_tr_b16 a[146:147], v15 offset:512
  ds_read_b64_tr_b16 a[148:149], v15 offset:8192
  ds_read_b64_tr_b16 a[150:151], v15 offset:8704
  ds_read_b64_tr_b16 a[152:153], v16 offset:0
  ds_read_b64_tr_b16 a[154:155], v16 offset:512
  ds_read_b64_tr_b16 a[156:157], v16 offset:8192
  ds_read_b64_tr_b16 a[158:159], v16 offset:8704
  s_waitcnt vmcnt(18) lgkmcnt(0)
  s_barrier
  s_add_u32 m0, s57, 131072
  s_add_u32 s54, s79, 74496
  buffer_load_dwordx4 v10, s[28:31], s54 offen  lds
  s_add_u32 m0, s57, 135168
  s_add_u32 s54, s79, 83712
  buffer_load_dwordx4 v10, s[28:31], s54 offen  lds
  s_add_u32 m0, s57, 139264
  s_add_u32 s54, s79, 111360
  buffer_load_dwordx4 v10, s[28:31], s54 offen  lds
  s_add_u32 m0, s57, 143360
  s_add_u32 s54, s79, 120576
  buffer_load_dwordx4 v10, s[28:31], s54 offen  lds
  v_add_u32 v15, 65536, v11
  v_add_u32 v16, 65536, v12
  ds_read_b64_tr_b16 a[160:161], v15 offset:0
  ds_read_b64_tr_b16 a[162:163], v15 offset:512
  ds_read_b64_tr_b16 a[164:165], v15 offset:8192
  ds_read_b64_tr_b16 a[166:167], v15 offset:8704
  ds_read_b64_tr_b16 a[168:169], v16 offset:0
  ds_read_b64_tr_b16 a[170:171], v16 offset:512
  ds_read_b64_tr_b16 a[172:173], v16 offset:8192
  ds_read_b64_tr_b16 a[174:175], v16 offset:8704
  s_waitcnt vmcnt(18) lgkmcnt(0)
  s_barrier
  s_add_u32 m0, s57, 0
  s_add_u32 s54, s78, 0
  buffer_load_dwordx4 v8, s[16:19], s54 offen  lds
  s_add_u32 m0, s57, 4096
  s_add_u32 s54, s78, 131072
  buffer_load_dwordx4 v8, s[16:19], s54 offen  lds
  s_add_u32 m0, s57, 8192
  s_add_u32 s54, s78, 262144
  buffer_load_dwordx4 v8, s[16:19], s54 offen  lds
  s_add_u32 m0, s57, 12288
  s_add_u32 s54, s78, 393216
  buffer_load_dwordx4 v8, s[16:19], s54 offen  lds
  v_add_u32 v15, 81920, v14
  ds_read_b64_tr_b16 a[176:177], v15 offset:0
  ds_read_b64_tr_b16 a[178:179], v15 offset:1024
  ds_read_b64_tr_b16 a[180:181], v15 offset:4096
  ds_read_b64_tr_b16 a[182:183], v15 offset:5120
  ds_read_b64_tr_b16 a[184:185], v15 offset:8192
  ds_read_b64_tr_b16 a[186:187], v15 offset:9216
  ds_read_b64_tr_b16 a[188:189], v15 offset:12288
  ds_read_b64_tr_b16 a[190:191], v15 offset:13312
  s_waitcnt vmcnt(17) lgkmcnt(0)
  s_barrier
  s_add_u32 m0, s57, 16384
  s_add_u32 s54, s78, 0
  buffer_load_dwordx4 v8, s[20:23], s54 offen  lds
  s_add_u32 m0, s57, 20480
  s_add_u32 s54, s78, 131072
  buffer_load_dwordx4 v8, s[20:23], s54 offen  lds
  s_add_u32 m0, s57, 24576
  s_add_u32 s54, s78, 262144
  buffer_load_dwordx4 v8, s[20:23], s54 offen  lds
  s_add_u32 m0, s57, 28672
  s_add_u32 s54, s78, 393216
  buffer_load_dwordx4 v8, s[20:23], s54 offen  lds
  v_add_u32 v15, 98304, v14
  ds_read_b64_tr_b16 a[192:193], v15 offset:0
  ds_read_b64_tr_b16 a[194:195], v15 offset:1024
  ds_read_b64_tr_b16 a[196:197], v15 offset:4096
  ds_read_b64_tr_b16 a[198:199], v15 offset:5120
  ds_read_b64_tr_b16 a[200:201], v15 offset:8192
  ds_read_b64_tr_b16 a[202:203], v15 offset:9216
  ds_read_b64_tr_b16 a[204:205], v15 offset:12288
  ds_read_b64_tr_b16 a[206:207], v15 offset:13312
  s_waitcnt vmcnt(17) lgkmcnt(0)
  s_barrier
  s_add_u32 m0, s57, 32768
  s_add_u32 s54, s78, 1048576
  buffer_load_dwordx4 v8, s[20:23], s54 offen  lds
  s_add_u32 m0, s57, 36864
  s_add_u32 s54, s78, 1179648
  buffer_load_dwordx4 v8, s[20:23], s54 offen  lds
  s_add_u32 m0, s57, 40960
  s_add_u32 s54, s78, 1310720
  buffer_load_dwordx4 v8, s[20:23], s54 offen  lds
  s_add_u32 m0, s57, 45056
  s_add_u32 s54, s78, 1441792
  buffer_load_dwordx4 v8, s[20:23], s54 offen  lds
  v_add_u32 v15, 114688, v14
  ds_read_b64_tr_b16 a[208:209], v15 offset:0
  ds_read_b64_tr_b16 a[210:211], v15 offset:1024
  ds_read_b64_tr_b16 a[212:213], v15 offset:4096
  ds_read_b64_tr_b16 a[214:215], v15 offset:5120
  ds_read_b64_tr_b16 a[216:217], v15 offset:8192
  ds_read_b64_tr_b16 a[218:219], v15 offset:9216
  ds_read_b64_tr_b16 a[220:221], v15 offset:12288
  ds_read_b64_tr_b16 a[222:223], v15 offset:13312
  s_waitcnt vmcnt(17) lgkmcnt(0)
  s_barrier
  s_add_u32 m0, s57, 49152
  s_add_u32 s54, s78, 2097152
  buffer_load_dwordx4 v8, s[20:23], s54 offen  lds
  s_add_u32 m0, s57, 53248
  s_add_u32 s54, s78, 2228224
  buffer_load_dwordx4 v8, s[20:23], s54 offen  lds
  s_add_u32 m0, s57, 57344
  s_add_u32 s54, s78, 2359296
  buffer_load_dwordx4 v8, s[20:23], s54 offen  lds
  s_add_u32 m0, s57, 61440
  s_add_u32 s54, s78, 2490368
  buffer_load_dwordx4 v8, s[20:23], s54 offen  lds
  v_add_u32 v15, 131072, v14
  ds_read_b64_tr_b16 a[224:225], v15 offset:0
  ds_read_b64_tr_b16 a[226:227], v15 offset:1024
  ds_read_b64_tr_b16 a[228:229], v15 offset:4096
  ds_read_b64_tr_b16 a[230:231], v15 offset:5120
  ds_read_b64_tr_b16 a[232:233], v15 offset:8192
  ds_read_b64_tr_b16 a[234:235], v15 offset:9216
  ds_read_b64_tr_b16 a[236:237], v15 offset:12288
  ds_read_b64_tr_b16 a[238:239], v15 offset:13312
  s_waitcnt vmcnt(16) lgkmcnt(0)
  s_barrier
  s_add_u32 m0, s57, 65536
  s_add_u32 s54, s78, 2621440
  buffer_load_dwordx4 v8, s[20:23], s54 offen  lds
  s_add_u32 m0, s57, 69632
  s_add_u32 s54, s78, 2752512
  buffer_load_dwordx4 v8, s[20:23], s54 offen  lds
  s_add_u32 m0, s57, 73728
  s_add_u32 s54, s78, 2883584
  buffer_load_dwordx4 v8, s[20:23], s54 offen  lds
  s_add_u32 m0, s57, 77824
  s_add_u32 s54, s78, 3014656
  buffer_load_dwordx4 v8, s[20:23], s54 offen  lds
  v_add_u32 v15, 147456, v14
  ds_read_b64_tr_b16 a[240:241], v15 offset:0
  ds_read_b64_tr_b16 a[242:243], v15 offset:1024
  ds_read_b64_tr_b16 a[244:245], v15 offset:4096
  ds_read_b64_tr_b16 a[246:247], v15 offset:5120
  ds_read_b64_tr_b16 a[248:249], v15 offset:8192
  ds_read_b64_tr_b16 a[250:251], v15 offset:9216
  ds_read_b64_tr_b16 a[252:253], v15 offset:12288
  ds_read_b64_tr_b16 a[254:255], v15 offset:13312
  s_waitcnt vmcnt(16) lgkmcnt(0)
  s_barrier
  s_add_u32 m0, s57, 81920
  s_add_u32 s54, s79, 1024
  buffer_load_dwordx4 v9, s[28:31], s54 offen  lds
  s_add_u32 m0, s57, 86016
  s_add_u32 s54, s79, 37888
  buffer_load_dwordx4 v9, s[28:31], s54 offen  lds
  s_add_u32 m0, s57, 90112
  s_add_u32 s54, s79, 74752
  buffer_load_dwordx4 v9, s[28:31], s54 offen  lds
  s_add_u32 m0, s57, 94208
  s_add_u32 s54, s79, 111616
  buffer_load_dwordx4 v9, s[28:31], s54 offen  lds
  v_add_u32 v15, 16384, v11
  v_add_u32 v16, 16384, v12
  ds_read_b64_tr_b16 v[52:53], v15 offset:0
  ds_read_b64_tr_b16 v[54:55], v15 offset:512
  ds_read_b64_tr_b16 v[56:57], v15 offset:8192
  ds_read_b64_tr_b16 v[58:59], v15 offset:8704
  ds_read_b64_tr_b16 v[60:61], v16 offset:0
  ds_read_b64_tr_b16 v[62:63], v16 offset:512
  ds_read_b64_tr_b16 v[64:65], v16 offset:8192
  ds_read_b64_tr_b16 v[66:67], v16 offset:8704
  s_waitcnt vmcnt(16) lgkmcnt(0)
  s_barrier
  s_lshl_b32 s54, s52, 12
  s_add_u32 s54, s54, 16384
  v_add_u32 v7, s54, v76
  ds_write_b128 v7, v[52:55] offset:0
  ds_write_b128 v7, v[56:59] offset:1024
  ds_write_b128 v7, v[60:63] offset:2048
  ds_write_b128 v7, v[64:67] offset:3072
  s_add_u32 m0, s57, 98304
  s_add_u32 s54, s79, 0
  buffer_load_dwordx4 v10, s[28:31], s54 offen  lds
  s_add_u32 m0, s57, 102400
  s_add_u32 s54, s79, 9216
  buffer_load_dwordx4 v10, s[28:31], s54 offen  lds
  s_add_u32 m0, s57, 106496
  s_add_u32 s54, s79, 36864
  buffer_load_dwordx4 v10, s[28:31], s54 offen  lds
  s_add_u32 m0, s57, 110592
  s_add_u32 s54, s79, 46080
  buffer_load_dwordx4 v10, s[28:31], s54 offen  lds
  v_add_u32 v15, 32768, v11
  v_add_u32 v16, 32768, v12
  ds_read_b64_tr_b16 v[36:37], v15 offset:0
  ds_read_b64_tr_b16 v[38:39], v15 offset:512
  ds_read_b64_tr_b16 v[40:41], v15 offset:8192
  ds_read_b64_tr_b16 v[42:43], v15 offset:8704
  ds_read_b64_tr_b16 v[44:45], v16 offset:0
  ds_read_b64_tr_b16 v[46:47], v16 offset:512
  ds_read_b64_tr_b16 v[48:49], v16 offset:8192
  ds_read_b64_tr_b16 v[50:51], v16 offset:8704
  s_waitcnt vmcnt(16) lgkmcnt(0)
  s_barrier
  s_lshl_b32 s54, s52, 12
  s_add_u32 s54, s54, 32768
  v_add_u32 v7, s54, v76
  ds_write_b128 v7, v[36:39] offset:0
  ds_write_b128 v7, v[40:43] offset:1024
  ds_write_b128 v7, v[44:47] offset:2048
  ds_write_b128 v7, v[48:51] offset:3072
  s_add_u32 m0, s57, 114688
  s_add_u32 s54, s79, 73984
  buffer_load_dwordx4 v10, s[28:31], s54 offen  lds
  s_add_u32 m0, s57, 118784
  s_add_u32 s54, s79, 83200
  buffer_load_dwordx4 v10, s[28:31], s54 offen  lds
  s_add_u32 m0, s57, 122880
  s_add_u32 s54, s79, 110848
  buffer_load_dwordx4 v10, s[28:31], s54 offen  lds
  s_add_u32 m0, s57, 126976
  s_add_u32 s54, s79, 120064
  buffer_load_dwordx4 v10, s[28:31], s54 offen  lds
  v_add_u32 v15, 49152, v11
  v_add_u32 v16, 49152, v12
  ds_read_b64_tr_b16 v[52:53], v15 offset:0
  ds_read_b64_tr_b16 v[54:55], v15 offset:512
  ds_read_b64_tr_b16 v[56:57], v15 offset:8192
  ds_read_b64_tr_b16 v[58:59], v15 offset:8704
  ds_read_b64_tr_b16 v[60:61], v16 offset:0
  ds_read_b64_tr_b16 v[62:63], v16 offset:512
  ds_read_b64_tr_b16 v[64:65], v16 offset:8192
  ds_read_b64_tr_b16 v[66:67], v16 offset:8704
  s_waitcnt vmcnt(16) lgkmcnt(0)
  s_barrier
  s_lshl_b32 s54, s52, 12
  s_add_u32 s54, s54, 49152
  v_add_u32 v7, s54, v76
  ds_write_b128 v7, v[52:55] offset:0
  ds_write_b128 v7, v[56:59] offset:1024
  ds_write_b128 v7, v[60:63] offset:2048
  ds_write_b128 v7, v[64:67] offset:3072
  s_add_u32 m0, s57, 131072
  s_add_u32 s54, s79, 74240
  buffer_load_dwordx4 v10, s[28:31], s54 offen  lds
  s_add_u32 m0, s57, 135168
  s_add_u32 s54, s79, 83456
  buffer_load_dwordx4 v10, s[28:31], s54 offen  lds
  s_add_u32 m0, s57, 139264
  s_add_u32 s54, s79, 111104
  buffer_load_dwordx4 v10, s[28:31], s54 offen  lds
  s_add_u32 m0, s57, 143360
  s_add_u32 s54, s79, 120320
  buffer_load_dwordx4 v10, s[28:31], s54 offen  lds
  v_lshlrev_b32 v7, 3, v76
  s_lshl_b32 s54, s52, 13
  s_add_u32 s54, s54, 360448
  s_bitcmp1_b32 s52, 0
  s_cselect_b64 exec, 0xff, -1
  buffer_load_dword v35, v7, s[8:11], s54 offen sc1
  s_mov_b64 exec, -1
  s_getpc_b64 s[80:81]
C_pc:
  s_mov_b32 s55, (L_w0 - C_pc)
  s_cmp_eq_u32 s52, 1
  s_cselect_b32 s55, (L_w1 - C_pc), s55
  s_cmp_eq_u32 s52, 2
  s_cselect_b32 s55, (L_w2 - C_pc), s55
  s_cmp_eq_u32 s52, 3
  s_cselect_b32 s55, (L_w3 - C_pc), s55
  v_lshl_add_u32 v7, v76, 3, s55
  global_load_dword v35, v7, s[80:81]
  v_add_u32 v15, 65536, v11
  v_add_u32 v16, 65536, v12
  ds_read_b64_tr_b16 v[36:37], v15 offset:0
  ds_read_b64_tr_b16 v[38:39], v15 offset:512
  ds_read_b64_tr_b16 v[40:41], v15 offset:8192
  ds_read_b64_tr_b16 v[42:43], v15 offset:8704
  ds_read_b64_tr_b16 v[44:45], v16 offset:0
  ds_read_b64_tr_b16 v[46:47], v16 offset:512
  ds_read_b64_tr_b16 v[48:49], v16 offset:8192
  ds_read_b64_tr_b16 v[50:51], v16 offset:8704
  s_waitcnt vmcnt(18) lgkmcnt(0)
  s_barrier
  s_lshl_b32 s54, s52, 12
  s_add_u32 s54, s54, 65536
  v_add_u32 v7, s54, v76
  ds_write_b128 v7, v[36:39] offset:0
  ds_write_b128 v7, v[40:43] offset:1024
  ds_write_b128 v7, v[44:47] offset:2048
  ds_write_b128 v7, v[48:51] offset:3072
  s_lshl_b32 s54, s53, 2
  s_add_u32 s54, s54, 128
  v_lshrrev_b32 v20, 2, v76
  v_writelane_b32 v20, s54, 16
  buffer_load_dword v21, v20, s[12:15], 0 offen sc1
  v_add_u32 v15, 81920, v11
  v_add_u32 v16, 81920, v12
  ds_read_b64_tr_b16 v[52:53], v15 offset:0
  ds_read_b64_tr_b16 v[54:55], v15 offset:512
  ds_read_b64_tr_b16 v[56:57], v15 offset:8192
  ds_read_b64_tr_b16 v[58:59], v15 offset:8704
  ds_read_b64_tr_b16 v[60:61], v16 offset:0
  ds_read_b64_tr_b16 v[62:63], v16 offset:512
  ds_read_b64_tr_b16 v[64:65], v16 offset:8192
  ds_read_b64_tr_b16 v[66:67], v16 offset:8704
  s_waitcnt vmcnt(15) lgkmcnt(0)
  s_barrier
  s_lshl_b32 s54, s52, 12
  s_add_u32 s54, s54, 81920
  v_add_u32 v7, s54, v76
  ds_write_b128 v7, v[52:55] offset:0
  ds_write_b128 v7, v[56:59] offset:1024
  ds_write_b128 v7, v[60:63] offset:2048
  ds_write_b128 v7, v[64:67] offset:3072
  v_add_u32 v15, 98304, v13
  s_waitcnt lgkmcnt(0)
  ds_read_b64_tr_b16 v[36:37], v15 offset:0
  ds_read_b64_tr_b16 v[38:39], v15 offset:1024
  ds_read_b64_tr_b16 v[40:41], v15 offset:2048
  ds_read_b64_tr_b16 v[42:43], v15 offset:3072
  ds_read_b64_tr_b16 v[44:45], v15 offset:4096
  ds_read_b64_tr_b16 v[46:47], v15 offset:5120
  ds_read_b64_tr_b16 v[48:49], v15 offset:6144
  ds_read_b64_tr_b16 v[50:51], v15 offset:7168
  ds_read_b64_tr_b16 v[52:53], v15 offset:8192
  ds_read_b64_tr_b16 v[54:55], v15 offset:9216
  ds_read_b64_tr_b16 v[56:57], v15 offset:10240
  ds_read_b64_tr_b16 v[58:59], v15 offset:11264
  ds_read_b64_tr_b16 v[60:61], v15 offset:12288
  ds_read_b64_tr_b16 v[62:63], v15 offset:13312
  ds_read_b64_tr_b16 v[64:65], v15 offset:14336
  ds_read_b64_tr_b16 v[66:67], v15 offset:15360
  s_waitcnt vmcnt(11) lgkmcnt(0)
  s_barrier
  s_and_b32 s54, s52, 1
  s_lshl_b32 s54, s54, 13
  s_add_u32 s54, s54, 98304
  v_add_u32 v7, s54, v76
  ds_write_b128 v7, v[36:39] offset:0
  ds_write_b128 v7, v[40:43] offset:1024
  ds_write_b128 v7, v[44:47] offset:2048
  ds_write_b128 v7, v[48:51] offset:3072
  ds_write_b128 v7, v[52:55] offset:4096
  ds_write_b128 v7, v[56:59] offset:5120
  ds_write_b128 v7, v[60:63] offset:6144
  ds_write_b128 v7, v[64:67] offset:7168
  v_add_u32 v15, 114688, v14
  ds_read_b64_tr_b16 v[52:53], v15 offset:0
  ds_read_b64_tr_b16 v[54:55], v15 offset:1024
  ds_read_b64_tr_b16 v[56:57], v15 offset:4096
  ds_read_b64_tr_b16 v[58:59], v15 offset:5120
  ds_read_b64_tr_b16 v[60:61], v15 offset:8192
  ds_read_b64_tr_b16 v[62:63], v15 offset:9216
  ds_read_b64_tr_b16 v[64:65], v15 offset:12288
  ds_read_b64_tr_b16 v[66:67], v15 offset:13312
  s_waitcnt vmcnt(7) lgkmcnt(0)
  s_barrier
  s_lshl_b32 s54, s52, 12
  s_add_u32 s54, s54, 114688
  v_add_u32 v7, s54, v76
  ds_write_b128 v7, v[52:55] offset:0
  ds_write_b128 v7, v[56:59] offset:1024
  ds_write_b128 v7, v[60:63] offset:2048
  ds_write_b128 v7, v[64:67] offset:3072
  v_add_u32 v15, 131072, v14
  ds_read_b64_tr_b16 v[36:37], v15 offset:0
  ds_read_b64_tr_b16 v[38:39], v15 offset:1024
  ds_read_b64_tr_b16 v[40:41], v15 offset:4096
  ds_read_b64_tr_b16 v[42:43], v15 offset:5120
  ds_read_b64_tr_b16 v[44:45], v15 offset:8192
  ds_read_b64_tr_b16 v[46:47], v15 offset:9216
  ds_read_b64_tr_b16 v[48:49], v15 offset:12288
  ds_read_b64_tr_b16 v[50:51], v15 offset:13312
  s_waitcnt vmcnt(3) lgkmcnt(0)
  s_barrier
  s_lshl_b32 s54, s52, 12
  s_add_u32 s54, s54, 131072
  v_add_u32 v7, s54, v76
  ds_write_b128 v7, v[36:39] offset:0
  ds_write_b128 v7, v[40:43] offset:1024
  ds_write_b128 v7, v[44:47] offset:2048
  ds_write_b128 v7, v[48:51] offset:3072
  v_add_u32 v15, 147456, v14
  ds_read_b64_tr_b16 v[52:53], v15 offset:0
  ds_read_b64_tr_b16 v[54:55], v15 offset:1024
  ds_read_b64_tr_b16 v[56:57], v15 offset:4096
  ds_read_b64_tr_b16 v[58:59], v15 offset:5120
  ds_read_b64_tr_b16 v[60:61], v15 offset:8192
  ds_read_b64_tr_b16 v[62:63], v15 offset:9216
  ds_read_b64_tr_b16 v[64:65], v15 offset:12288
  ds_read_b64_tr_b16 v[66:67], v15 offset:13312
  s_waitcnt vmcnt(0) lgkmcnt(0)
  s_barrier
  s_lshl_b32 s54, s52, 12
  s_add_u32 s54, s54, 147456
  v_add_u32 v7, s54, v76
  ds_write_b128 v7, v[52:55] offset:0
  ds_write_b128 v7, v[56:59] offset:1024
  ds_write_b128 v7, v[60:63] offset:2048
  ds_write_b128 v7, v[64:67] offset:3072
  s_waitcnt lgkmcnt(0)
  s_branch C_rd1
C_rd0:
  s_sleep 2
  buffer_load_dword v21, v20, s[12:15], 0 offen sc1
  s_waitcnt vmcnt(0)
C_rd1:
  s_mov_b32 s3, 1
  s_add_u32 s67, s67, 1
  s_cmp_ge_u32 s67, 131072
  s_cbranch_scc1 C_rd2
  v_readlane_b32 s54, v21, 8
  v_readlane_b32 s55, v21, 16
  v_readlane_b32 s56, v21, 0
  s_cmp_lt_u32 s54, 32
  s_cbranch_scc1 C_rd0
  s_and_b32 s55, s55, 0xff
  s_cmp_lt_u32 s55, 7
  s_cbranch_scc1 C_rd0
  s_cmp_eq_u32 s56, -1
  s_cselect_b32 s3, 0, 1
C_rd2:
  s_lshl_b32 s54, s3, 2
  s_add_u32 s54, s54, s52
  s_cmp_eq_u32 s54, 1
  s_cbranch_scc1 L_w1
  s_cmp_eq_u32 s54, 2
  s_cbranch_scc1 L_w2
  s_cmp_eq_u32 s54, 3
  s_cbranch_scc1 L_w3
  s_cmp_eq_u32 s54, 4
  s_cbranch_scc1 L_w4
  s_cmp_eq_u32 s54, 5
  s_cbranch_scc1 L_w5
  s_cmp_eq_u32 s54, 6
  s_cbranch_scc1 L_w6
  s_cmp_eq_u32 s54, 7
  s_cbranch_scc1 L_w7
L_w0:
  v_mov_b64 v[20:21], 0
  v_mov_b64 v[22:23], 0
  v_mov_b64 v[24:25], 0
  v_mov_b64 v[26:27], 0
  v_mov_b64 v[28:29], 0
  v_mov_b64 v[30:31], 0
  v_mov_b64 v[32:33], 0
  v_mov_b64 v[34:35], 0
  s_mov_b32 s78, 0x3f803f80
  s_mov_b32 s79, s78
  s_mov_b32 s65, 360448
  s_mov_b32 m0, 15872
  v_lshlrev_b32 v73, 2, v76
  v_mov_b32 v72, 0
  ds_read_b128 v[60:63], v76 offset:16384
  ds_read_b128 v[64:67], v76 offset:17408
  ds_read_b128 v[44:47], v76 offset:18432
  ds_read_b128 v[48:51], v76 offset:19456
  ds_read_b128 v[36:39], v76 offset:32768
  ds_read_b128 v[40:43], v76 offset:33792
  ds_read_b128 v[0:3], v76 offset:4608
  ds_read_b128 v[4:7], v76 offset:5632
  s_branch Cf0_top2
.p2align 6
Cf0_h2:
  v_lshlrev_b32 v73, 2, v76
  s_nop 15
  s_nop 11
  buffer_load_dwordx4 v[52:55], v76, s[8:11], s65 offen offset:0 sc1
  buffer_load_dwordx4 v[56:59], v76, s[8:11], s65 offen offset:1024 sc1
  s_nop 15
  s_nop 1
  buffer_load_dwordx4 v[52:55], v76, s[8:11], s65 offen offset:0 sc1
  buffer_load_dwordx4 v[56:59], v76, s[8:11], s65 offen offset:1024 sc1
  s_nop 15
  s_nop 1
  buffer_load_dwordx4 v[52:55], v76, s[8:11], s65 offen offset:0 sc1
  buffer_load_dwordx4 v[56:59], v76, s[8:11], s65 offen offset:1024 sc1
  s_waitcnt vmcnt(8)
  ds_read_b128 v[60:63], v76 offset:16384
  ds_read_b128 v[64:67], v76 offset:17408
  ds_read_b128 v[44:47], v76 offset:18432
  ds_read_b128 v[48:51], v76 offset:19456
  ds_read_b128 v[36:39], v76 offset:32768
  ds_read_b128 v[40:43], v76 offset:33792
  s_waitcnt vmcnt(4)
  v_max3_u32 v72, v52, v53, v54
  v_max3_u32 v72, v72, v55, v56
  v_max3_u32 v72, v72, v57, v58
  v_max_u32 v72, v72, v59
  ds_write_b128 v76, v[52:55] offset:4608
  ds_write_b128 v76, v[56:59] offset:5632
  v_cmp_eq_u32 vcc, -1, v72
  s_cbranch_vccnz Cf0_h2r
Cf0_h2w:
  s_waitcnt lgkmcnt(0)
  s_barrier
  ds_read_b128 v[0:3], v76 offset:4608
  ds_read_b128 v[4:7], v76 offset:5632
Cf0_top2:
  ds_read_b128 v[8:11], v76 offset:6656
  s_waitcnt lgkmcnt(2)
  v_smfmac_f32_16x16x64_bf16 v[20:23], v[0:3], v[60:67], v74
  ds_read_b128 v[60:63], v76 offset:34816
  v_smfmac_f32_16x16x64_bf16 v[24:27], v[0:3], v[44:51], v74
  buffer_load_dwordx4 v[44:47], v76, s[8:11], s58 offen offset:0 sc1
  ds_read_b128 v[64:67], v76 offset:35840
  s_waitcnt lgkmcnt(3)
  v_smfmac_f32_16x16x64_bf16 v[20:23], v[4:7], v[80:87], v74
  buffer_load_dwordx4 v[48:51], v76, s[8:11], s58 offen offset:1024 sc1
  v_smfmac_f32_16x16x64_bf16 v[28:31], v[0:3], v[36:43], v74
  buffer_load_dwordx4 v[52:55], v76, s[8:11], s59 offen offset:0 sc1
  ds_read_b128 v[36:39], v76 offset:49152
  v_smfmac_f32_16x16x64_bf16 v[24:27], v[4:7], v[88:95], v74
  buffer_load_dwordx4 v[56:59], v76, s[8:11], s59 offen offset:1024 sc1
  ds_read_b128 v[40:43], v76 offset:50176
  v_smfmac_f32_16x16x64_bf16 v[28:31], v[4:7], v[208:215], v74
  ds_read_b128 v[12:15], v76 offset:7680
  s_waitcnt lgkmcnt(5)
  v_smfmac_f32_16x16x64_bf16 v[32:35], v[4:7], v[216:223], v74
  buffer_store_dwordx4 v[16:19], v76, s[8:11], s68 offen sc1
  s_waitcnt lgkmcnt(3)
  v_smfmac_f32_16x16x64_bf16 v[32:35], v[0:3], v[60:67], v74
  buffer_load_dword v73, s[8:11], s70 offen  lds
  v_smfmac_f32_16x16x64_bf16 v[20:23], v[8:11], v[96:103], v74
  ds_read_b128 v[60:63], v76 offset:51200
  v_smfmac_f32_16x16x64_bf16 v[24:27], v[8:11], v[104:111], v74
  ds_read_b128 v[64:67], v76 offset:52224
  s_waitcnt lgkmcnt(3)
  v_smfmac_f32_16x16x64_bf16 v[28:31], v[8:11], v[36:43], v74
  ds_read_b128 v[36:39], v75 offset:0
  s_waitcnt lgkmcnt(3)
  v_smfmac_f32_16x16x64_bf16 v[20:23], v[12:15], v[112:119], v74
  ds_read_b128 v[40:43], v75 offset:1024
  v_smfmac_f32_16x16x64_bf16 v[24:27], v[12:15], v[120:127], v74
  s_barrier
  ds_read_b128 v[0:3], v76 offset:8704
  v_smfmac_f32_16x16x64_bf16 v[28:31], v[12:15], v[224:231], v74
  ds_read_b128 v[4:7], v76 offset:9728
  v_smfmac_f32_16x16x64_bf16 v[32:35], v[12:15], v[232:239], v74
  s_waitcnt lgkmcnt(4)
  v_smfmac_f32_16x16x64_bf16 v[32:35], v[8:11], v[60:67], v74
  ds_read_b128 v[60:63], v75 offset:2048
  s_waitcnt lgkmcnt(2)
  v_smfmac_f32_16x16x64_bf16 v[20:23], v[0:3], v[128:135], v74
  ds_read_b128 v[16:19], v76 offset:10752
  v_smfmac_f32_16x16x64_bf16 v[24:27], v[0:3], v[136:143], v74
  ds_read_b128 v[64:67], v75 offset:3072
  v_smfmac_f32_16x16x64_bf16 v[28:31], v[0:3], v[36:43], v74
  ds_read_b128 v[36:39], v75 offset:16384
  s_waitcnt lgkmcnt(4)
  v_smfmac_f32_16x16x64_bf16 v[20:23], v[4:7], v[144:151], v74
  ds_read_b128 v[12:15], v76 offset:11776
  v_smfmac_f32_16x16x64_bf16 v[24:27], v[4:7], v[152:159], v74
  ds_read_b128 v[40:43], v75 offset:17408
  s_waitcnt lgkmcnt(4)
  v_smfmac_f32_16x16x64_bf16 v[20:23], v[16:19], v[160:167], v74
  ds_read_b128 v[8:11], v76 offset:12800
  s_waitcnt lgkmcnt(4)
  v_smfmac_f32_16x16x64_bf16 v[32:35], v[0:3], v[60:67], v74
  ds_read_b128 v[60:63], v75 offset:18432
  v_mov_b64 v[68:69], s[78:79]
  v_smfmac_f32_16x16x64_bf16 v[24:27], v[16:19], v[168:175], v74
  ds_read_b128 v[64:67], v75 offset:19456
  s_waitcnt lgkmcnt(4)
  v_smfmac_f32_16x16x64_bf16 v[20:23], v[12:15], v[176:183], v74
  s_waitcnt lgkmcnt(3)
  v_mov_b64 v[70:71], s[78:79]
  v_smfmac_f32_16x16x64_bf16 v[28:31], v[4:7], v[36:43], v74
  s_waitcnt lgkmcnt(2)
  v_mov_b64 v[36:37], 0
  v_smfmac_f32_16x16x64_bf16 v[20:23], v[8:11], v[192:199], v74
  v_mov_b64 v[38:39], 0
  v_smfmac_f32_16x16x64_bf16 v[24:27], v[12:15], v[184:191], v74
  v_mov_b64 v[40:41], 0
  v_smfmac_f32_16x16x64_bf16 v[24:27], v[8:11], v[200:207], v74
  s_waitcnt lgkmcnt(0)
  v_add_f32 v20, v20, v22
  v_smfmac_f32_16x16x64_bf16 v[32:35], v[4:7], v[60:67], v74
  v_add_f32 v21, v21, v23
  v_smfmac_f32_16x16x64_bf16 v[28:31], v[16:19], v[240:247], v74
  v_add_f32 v24, v24, v26
  v_cvt_pk_bf16_f32 v22, v20, v24
  v_smfmac_f32_16x16x64_bf16 v[28:31], v[12:15], a[0:7], v74
  ds_write_b32 v79, v22 offset:0
  v_add_f32 v25, v25, v27
  v_cvt_pk_bf16_f32 v23, v21, v25
  v_smfmac_f32_16x16x64_bf16 v[28:31], v[8:11], a[16:23], v74
  ds_write_b32 v79, v23 offset:576
  v_cmp_u_f32 vcc, v20, v21
  v_smfmac_f32_16x16x64_bf16 v[32:35], v[16:19], v[248:255], v74
  v_mov_b64 v[42:43], 0
  v_smfmac_f32_16x16x64_bf16 v[32:35], v[12:15], a[8:15], v74
  v_add_f32 v28, v28, v30
  v_add_f32 v29, v29, v31
  v_smfmac_f32_16x16x64_bf16 v[32:35], v[8:11], a[24:31], v74
  s_cbranch_vccnz Cf0_rec
Cf0_recok:
  v_smfmac_f32_16x16x64_bf16 v[36:39], v[16:19], a[128:135], v74
  s_waitcnt lgkmcnt(0)
  s_barrier
  ds_read_b128 v[60:63], v77
  v_smfmac_f32_16x16x64_bf16 v[40:43], v[16:19], a[136:143], v74
  ds_read_b128 v[64:67], v77 offset:128
  v_add_f32 v32, v32, v34
  v_cvt_pk_bf16_f32 v30, v28, v32
  v_smfmac_f32_16x16x64_bf16 v[36:39], v[0:3], a[96:103], v74
  ds_write_b32 v79, v30 offset:256
  v_add_f32 v33, v33, v35
  v_cvt_pk_bf16_f32 v31, v29, v33
  v_smfmac_f32_16x16x64_bf16 v[40:43], v[0:3], a[104:111], v74
  ds_write_b32 v79, v31 offset:832
  v_xor_b32 v75, 0x8000, v75
  v_smfmac_f32_16x16x64_bf16 v[36:39], v[4:7], a[112:119], v74
  ds_read_b128 v[0:3], v76 offset:4608
  v_mov_b32 v29, 0
  v_smfmac_f32_16x16x64_bf16 v[40:43], v[4:7], a[120:127], v74
  s_waitcnt vmcnt(4) lgkmcnt(3)
  v_mov_b32 v30, 0
  v_mfma_f32_16x16x32_bf16 v[44:47], v[44:47], v[60:63], 0
  ds_read_b128 v[4:7], v76 offset:5632
  s_waitcnt lgkmcnt(2)
  v_mfma_f32_16x16x32_bf16 v[44:47], v[48:51], v[64:67], v[44:47]
  s_barrier
  v_smfmac_f32_16x16x64_bf16 v[36:39], v[8:11], a[160:167], v74
  ds_read_b128 v[20:23], v77 offset:256
  ds_read_b128 v[24:27], v77 offset:384
  v_smfmac_f32_16x16x64_bf16 v[40:43], v[8:11], a[168:175], v74
  ds_read_b128 v[8:11], v76 offset:6656
  v_add_f32_dpp v72, v46, v44 quad_perm:[2,3,0,1] row_mask:0xf bank_mask:0xf
  v_add_f32_dpp v73, v47, v45 quad_perm:[2,3,0,1] row_mask:0xf bank_mask:0xf
  v_smfmac_f32_16x16x64_bf16 v[36:39], v[12:15], a[144:151], v74
  s_waitcnt lgkmcnt(4)
  v_exp_f32_dpp v72, v72 quad_perm:[0,1,0,1] row_mask:0xf bank_mask:0xf
  v_smfmac_f32_16x16x64_bf16 v[40:43], v[12:15], a[152:159], v74
  ds_read_b128 v[12:15], v76 offset:7680
  v_exp_f32_dpp v73, v73 quad_perm:[0,1,0,1] row_mask:0xf bank_mask:0xf
  v_smfmac_f32_16x16x64_bf16 v[36:39], v[0:3], a[32:39], v74
  s_waitcnt lgkmcnt(2)
  v_cvt_pk_bf16_f32 v72, v72, v73
  v_mfma_f32_16x16x32_bf16 v[20:23], v[20:23], v[60:63], 0
  ds_write_b32 v78, v72 offset:512
  v_mov_b64 v[16:17], 0
  v_mfma_f32_16x16x32_bf16 v[20:23], v[24:27], v[64:67], v[20:23]
  ds_read_b128 v[44:47], v75 offset:16384
  v_mov_b64 v[18:19], 0
  v_smfmac_f32_16x16x64_bf16 v[40:43], v[0:3], a[40:47], v74
  ds_read_b128 v[48:51], v75 offset:17408
  s_waitcnt lgkmcnt(4)
  v_smfmac_f32_16x16x64_bf16 v[36:39], v[4:7], a[48:55], v74
  v_add_f32_dpp v24, v22, v20 quad_perm:[2,3,0,1] row_mask:0xf bank_mask:0xf
  v_add_f32_dpp v25, v23, v21 quad_perm:[2,3,0,1] row_mask:0xf bank_mask:0xf
  v_smfmac_f32_16x16x64_bf16 v[36:39], v[8:11], a[64:71], v74
  s_waitcnt lgkmcnt(2)
  s_barrier
  ds_read_b128 v[32:35], v78 offset:512
  v_smfmac_f32_16x16x64_bf16 v[36:39], v[12:15], a[80:87], v74
  ds_read_b128 v[60:63], v75 offset:18432
  v_mul_f32 v24, s69, v24
  v_smfmac_f32_16x16x64_bf16 v[40:43], v[4:7], a[56:63], v74
  ds_read_b128 v[64:67], v75 offset:19456
  v_mul_f32 v25, s69, v25
  v_smfmac_f32_16x16x64_bf16 v[40:43], v[8:11], a[72:79], v74
  v_exp_f32_dpp v24, v24 quad_perm:[0,1,0,1] row_mask:0xf bank_mask:0xf
  v_smfmac_f32_16x16x64_bf16 v[40:43], v[12:15], a[88:95], v74
  s_waitcnt vmcnt(2) lgkmcnt(2)
  v_exp_f32_dpp v25, v25 quad_perm:[0,1,0,1] row_mask:0xf bank_mask:0xf
  v_mfma_f32_16x16x32_bf16 v[8:11], v[32:35], v[68:71], 0
  v_add_f32 v36, v36, v38
  v_add_f32 v37, v37, v39
  v_mfma_f32_16x16x32_bf16 v[0:3], v[32:35], v[52:55], 0
  v_add_f32 v40, v40, v42
  v_add_f32 v41, v41, v43
  v_mfma_f32_16x16x32_bf16 v[4:7], v[32:35], v[56:59], 0
  v_cvt_pk_bf16_f32 v28, v24, v25
  v_cvt_pk_bf16_f32 v72, v36, v37
  v_cvt_pk_bf16_f32 v73, v40, v41
  v_mfma_f32_16x16x16_bf16 v[8:11], v[28:29], v[68:69], v[8:11]
  v_cvt_pk_bf16_f32 v31, v24, v25
  v_mov_b64 v[20:21], 0
  v_mfma_f32_16x16x16_bf16 v[0:3], v[28:29], v[72:73], v[0:3]
  ds_read_b128 v[68:71], v76 offset:13824
  v_mov_b64 v[22:23], 0
  v_mfma_f32_16x16x16_bf16 v[4:7], v[30:31], v[72:73], v[4:7]
  v_rcp_f32 v10, v8
  v_rcp_f32 v11, v9
  v_mul_f32 v0, v10, v0
  v_mul_f32 v1, v11, v1
  s_nop 0
  v_mul_f32 v4, v10, v4
  v_mul_f32 v5, v11, v5
  v_cvt_pk_bf16_f32 v2, v0, v4
  ds_write_b32 v79, v2 offset:8704
  v_cvt_pk_bf16_f32 v3, v1, v5
  ds_write_b32 v79, v3 offset:9280
  v_max3_f32 v8, v8, v9, v10
  v_max_f32 v8, v8, v11
  v_cmp_le_f32 vcc, 1317011456, v8
  v_mov_b64 v[24:25], 0
  v_mov_b64 v[26:27], 0
  s_cbranch_vccnz Cf0_mx
Cf0_mxok:
  s_waitcnt lgkmcnt(0)
  s_barrier
  ds_read_b128 v[0:3], v78 offset:8704
  ds_read_b128 v[4:7], v78 offset:8768
  ds_read_b128 v[8:11], v78 offset:8832
  ds_read_b128 v[12:15], v78 offset:8896
  s_cmp_eq_u32 s66, 63
  s_cbranch_scc1 Cf0_last
  s_waitcnt lgkmcnt(3)
  v_smfmac_f32_16x16x64_bf16 v[16:19], v[0:3], v[44:51], v74
  ds_read_b128 v[52:55], v75 offset:32768
  s_waitcnt lgkmcnt(3)
  v_smfmac_f32_16x16x64_bf16 v[16:19], v[4:7], v[60:67], v74
  ds_read_b128 v[56:59], v75 offset:33792
  s_waitcnt lgkmcnt(3)
  v_smfmac_f32_16x16x64_bf16 v[16:19], v[8:11], a[176:183], v74
  ds_read_b128 v[36:39], v75 offset:34816
  s_waitcnt lgkmcnt(3)
  v_smfmac_f32_16x16x64_bf16 v[16:19], v[12:15], a[184:191], v74
  ds_read_b128 v[40:43], v75 offset:35840
  ds_read_b128 v[44:47], v75 offset:49152
  v_smfmac_f32_16x16x64_bf16 v[20:23], v[0:3], a[192:199], v74
  ds_read_b128 v[48:51], v75 offset:50176
  ds_read_b128 v[60:63], v75 offset:51200
  v_smfmac_f32_16x16x64_bf16 v[20:23], v[4:7], a[200:207], v74
  ds_read_b128 v[64:67], v75 offset:52224
  s_waitcnt lgkmcnt(6)
  v_cvt_pk_bf16_f32 v16, v16, v17
  v_cvt_pk_bf16_f32 v17, v18, v19
  v_bfi_b32 v16, 1, s72, v16
  v_smfmac_f32_16x16x64_bf16 v[20:23], v[8:11], v[52:59], v74
  buffer_store_dwordx2 v[16:17], v68, s[8:11], s73 offen
  s_waitcnt lgkmcnt(4)
  v_smfmac_f32_16x16x64_bf16 v[20:23], v[12:15], v[36:43], v74
  v_mov_b64 v[32:33], 0
  v_smfmac_f32_16x16x64_bf16 v[24:27], v[0:3], a[208:215], v74
  v_mov_b64 v[34:35], 0
  v_smfmac_f32_16x16x64_bf16 v[24:27], v[4:7], a[216:223], v74
  s_waitcnt lgkmcnt(2)
  v_cvt_pk_bf16_f32 v20, v20, v21
  v_cvt_pk_bf16_f32 v21, v22, v23
  v_bfi_b32 v20, 1, s72, v20
  v_smfmac_f32_16x16x64_bf16 v[24:27], v[8:11], v[44:51], v74
  buffer_store_dwordx2 v[20:21], v68, s[8:11], s74 offen
  s_waitcnt lgkmcnt(0)
  v_smfmac_f32_16x16x64_bf16 v[24:27], v[12:15], v[60:67], v74
  v_smfmac_f32_16x16x64_bf16 v[32:35], v[0:3], a[224:231], v74
  v_smfmac_f32_16x16x64_bf16 v[32:35], v[4:7], a[232:239], v74
  v_cvt_pk_bf16_f32 v24, v24, v25
  v_cvt_pk_bf16_f32 v25, v26, v27
  v_bfi_b32 v24, 1, s72, v24
  v_smfmac_f32_16x16x64_bf16 v[32:35], v[8:11], a[240:247], v74
  s_nop 1
  buffer_store_dwordx2 v[24:25], v68, s[8:11], s75 offen
  v_smfmac_f32_16x16x64_bf16 v[32:35], v[12:15], a[248:255], v74
  ds_read_b128 v[0:3], v76 offset:14848
  ds_read_b64 v[16:17], v77 offset:256
  v_mov_b64 v[18:19], v[72:73]
  v_xor_b32 v75, 0x8000, v75
  s_nop 3
  v_cvt_pk_bf16_f32 v32, v32, v33
  v_cvt_pk_bf16_f32 v33, v34, v35
  v_bfi_b32 v32, 1, s72, v32
  buffer_store_dwordx2 v[32:33], v68, s[8:11], s76 offen
  v_mov_b64 v[20:21], 0
  v_mov_b64 v[22:23], 0
  v_mov_b64 v[24:25], 0
  v_mov_b64 v[26:27], 0
  v_mov_b64 v[28:29], 0
  v_mov_b64 v[30:31], 0
  v_mov_b64 v[32:33], 0
  v_mov_b64 v[34:35], 0
  s_add_u32 s58, s58, 655360
  s_add_u32 s59, s59, 655360
  s_add_u32 s70, s70, 655360
  s_add_u32 s68, s68, 655360
  s_add_u32 s66, s66, 1
  s_xor_b32 s64, s64, 16384
  s_xor_b32 s65, s65, 16384
  s_nop 15
  s_nop 3
  buffer_load_dwordx4 v[52:55], v76, s[8:11], s60 offen offset:0 sc1
  buffer_load_dwordx4 v[56:59], v76, s[8:11], s60 offen offset:1024 sc1
  s_nop 15
  s_nop 11
  buffer_load_dwordx4 v[36:39], v76, s[8:11], s60 offen offset:0 sc1
  buffer_load_dwordx4 v[40:43], v76, s[8:11], s60 offen offset:1024 sc1
  s_waitcnt lgkmcnt(0)
  s_waitcnt vmcnt(3)
  v_mfma_f32_16x16x32_bf16 v[4:7], v[0:3], v[52:55], 0
  v_bitop3_b32 v72, v52, v54, s72 bitop3:0x7e
  s_waitcnt vmcnt(2)
  v_mfma_f32_16x16x32_bf16 v[4:7], v[0:3], v[56:59], v[4:7]
  v_bitop3_b32 v73, v56, v58, s72 bitop3:0x7e
  v_bitop3_b32 v72, v72, v73, 1 bitop3:0xa8
  v_cmp_ne_u32 vcc, 0, v72
  s_nop 0
  s_cmp_eq_u64 vcc, 0
  s_cselect_b32 s54, s62, 268435456
  s_nop 0
  v_add_f32_dpp v4, v4, v4 row_ror:4 row_mask:0xf bank_mask:0xf
  v_add_f32_dpp v5, v5, v5 row_ror:4 row_mask:0xf bank_mask:0xf
  s_nop 0
  v_add_f32_dpp v4, v4, v4 row_ror:8 row_mask:0xf bank_mask:0xf
  v_add_f32_dpp v5, v5, v5 row_ror:8 row_mask:0xf bank_mask:0xf
  v_cvt_pk_bf16_f32 v4, v4, v5
  buffer_store_dword v4, v69, s[8:11], s54 offen
  s_cbranch_vccnz Cf0_h1r
  s_xor_b32 s62, s62, 16384
  buffer_store_dword v71, v69, s[8:11], s62 offen
  s_xor_b32 s72, s72, 1
  s_branch Cf0_h2
Cf0_h1r:
  s_mov_b64 exec, vcc
  buffer_load_dwordx4 v[52:55], v76, s[8:11], s60 offen offset:0 sc1
  buffer_load_dwordx4 v[56:59], v76, s[8:11], s60 offen offset:1024 sc1
  s_mov_b64 exec, -1
  s_add_u32 s67, s67, 1
  s_waitcnt vmcnt(4)
  v_mfma_f32_16x16x32_bf16 v[4:7], v[0:3], v[36:39], 0
  v_bitop3_b32 v72, v36, v38, s72 bitop3:0x7e
  s_waitcnt vmcnt(3)
  v_mfma_f32_16x16x32_bf16 v[4:7], v[0:3], v[40:43], v[4:7]
  v_bitop3_b32 v73, v40, v42, s72 bitop3:0x7e
  v_bitop3_b32 v72, v72, v73, 1 bitop3:0xa8
  v_cmp_ne_u32 vcc, 0, v72
  s_cbranch_vccz Cf0_h1p
  s_mov_b64 exec, vcc
  buffer_load_dwordx4 v[36:39], v76, s[8:11], s60 offen offset:0 sc1
  buffer_load_dwordx4 v[40:43], v76, s[8:11], s60 offen offset:1024 sc1
  s_mov_b64 exec, -1
  s_add_u32 s67, s67, 1
  s_waitcnt vmcnt(3)
  v_mfma_f32_16x16x32_bf16 v[4:7], v[0:3], v[52:55], 0
  v_bitop3_b32 v72, v52, v54, s72 bitop3:0x7e
  s_waitcnt vmcnt(2)
  v_mfma_f32_16x16x32_bf16 v[4:7], v[0:3], v[56:59], v[4:7]
  v_bitop3_b32 v73, v56, v58, s72 bitop3:0x7e
  v_bitop3_b32 v72, v72, v73, 1 bitop3:0xa8
  v_cmp_ne_u32 vcc, 0, v72
  s_cbranch_vccz Cf0_h1p
Cf0_h1s:
  s_mov_b64 exec, vcc
  buffer_load_dwordx4 v[52:55], v76, s[8:11], s60 offen offset:0 sc1
  buffer_load_dwordx4 v[56:59], v76, s[8:11], s60 offen offset:1024 sc1
  s_mov_b64 exec, -1
  s_add_u32 s67, s67, 1
  s_waitcnt vmcnt(3)
  v_mfma_f32_16x16x32_bf16 v[4:7], v[0:3], v[36:39], 0
  v_bitop3_b32 v72, v36, v38, s72 bitop3:0x7e
  s_waitcnt vmcnt(2)
  v_mfma_f32_16x16x32_bf16 v[4:7], v[0:3], v[40:43], v[4:7]
  v_bitop3_b32 v73, v40, v42, s72 bitop3:0x7e
  v_bitop3_b32 v72, v72, v73, 1 bitop3:0xa8
  v_cmp_ne_u32 vcc, 0, v72
  s_cbranch_vccz Cf0_h1p
  s_mov_b64 exec, vcc
  buffer_load_dwordx4 v[36:39], v76, s[8:11], s60 offen offset:0 sc1
  buffer_load_dwordx4 v[40:43], v76, s[8:11], s60 offen offset:1024 sc1
  s_mov_b64 exec, -1
  s_add_u32 s67, s67, 1
  s_waitcnt vmcnt(3)
  v_mfma_f32_16x16x32_bf16 v[4:7], v[0:3], v[52:55], 0
  v_bitop3_b32 v72, v52, v54, s72 bitop3:0x7e
  s_waitcnt vmcnt(2)
  v_mfma_f32_16x16x32_bf16 v[4:7], v[0:3], v[56:59], v[4:7]
  v_bitop3_b32 v73, v56, v58, s72 bitop3:0x7e
  v_bitop3_b32 v72, v72, v73, 1 bitop3:0xa8
  v_cmp_ne_u32 vcc, 0, v72
  s_cbranch_vccz Cf0_h1p
  s_cmp_lt_u32 s67, 131072
  s_cbranch_scc1 Cf0_h1s
Cf0_h1p:
  s_nop 2
  v_add_f32_dpp v4, v4, v4 row_ror:4 row_mask:0xf bank_mask:0xf
  v_add_f32_dpp v5, v5, v5 row_ror:4 row_mask:0xf bank_mask:0xf
  s_nop 0
  v_add_f32_dpp v4, v4, v4 row_ror:8 row_mask:0xf bank_mask:0xf
  v_add_f32_dpp v5, v5, v5 row_ror:8 row_mask:0xf bank_mask:0xf
  v_cvt_pk_bf16_f32 v4, v4, v5
  buffer_store_dword v4, v69, s[8:11], s62 offen
  s_xor_b32 s62, s62, 16384
  buffer_store_dword v71, v69, s[8:11], s62 offen
  s_xor_b32 s72, s72, 1
  s_branch Cf0_h2
Cf0_h2r:
  s_mov_b64 exec, vcc
  buffer_load_dwordx4 v[52:55], v76, s[8:11], s65 offen offset:0 sc1
  buffer_load_dwordx4 v[56:59], v76, s[8:11], s65 offen offset:1024 sc1
  s_mov_b64 exec, -1
  s_add_u32 s67, s67, 1
  s_waitcnt vmcnt(4)
  v_max3_u32 v72, v52, v53, v54
  v_max3_u32 v72, v72, v55, v56
  v_max3_u32 v72, v72, v57, v58
  v_max_u32 v72, v72, v59
  ds_write_b128 v76, v[52:55] offset:4608
  ds_write_b128 v76, v[56:59] offset:5632
  v_cmp_eq_u32 vcc, -1, v72
  s_cbranch_vccz Cf0_h2w
  s_mov_b64 exec, vcc
  buffer_load_dwordx4 v[52:55], v76, s[8:11], s65 offen offset:0 sc1
  buffer_load_dwordx4 v[56:59], v76, s[8:11], s65 offen offset:1024 sc1
  s_mov_b64 exec, -1
  s_add_u32 s67, s67, 1
  s_waitcnt vmcnt(4)
  v_max3_u32 v72, v52, v53, v54
  v_max3_u32 v72, v72, v55, v56
  v_max3_u32 v72, v72, v57, v58
  v_max_u32 v72, v72, v59
  ds_write_b128 v76, v[52:55] offset:4608
  ds_write_b128 v76, v[56:59] offset:5632
  v_cmp_eq_u32 vcc, -1, v72
  s_cbranch_vccz Cf0_h2w
  s_mov_b64 exec, vcc
  buffer_load_dwordx4 v[52:55], v76, s[8:11], s65 offen offset:0 sc1
  buffer_load_dwordx4 v[56:59], v76, s[8:11], s65 offen offset:1024 sc1
  s_mov_b64 exec, -1
  s_add_u32 s67, s67, 1
  s_waitcnt vmcnt(4)
  v_max3_u32 v72, v52, v53, v54
  v_max3_u32 v72, v72, v55, v56
  v_max3_u32 v72, v72, v57, v58
  v_max_u32 v72, v72, v59
  ds_write_b128 v76, v[52:55] offset:4608
  ds_write_b128 v76, v[56:59] offset:5632
  v_cmp_eq_u32 vcc, -1, v72
  s_cbranch_vccz Cf0_h2w
  s_mov_b64 exec, vcc
  buffer_load_dwordx4 v[52:55], v76, s[8:11], s65 offen offset:0 sc1
  buffer_load_dwordx4 v[56:59], v76, s[8:11], s65 offen offset:1024 sc1
  s_mov_b64 exec, -1
  s_add_u32 s67, s67, 1
  s_waitcnt vmcnt(4)
  v_max3_u32 v72, v52, v53, v54
  v_max3_u32 v72, v72, v55, v56
  v_max3_u32 v72, v72, v57, v58
  v_max_u32 v72, v72, v59
  ds_write_b128 v76, v[52:55] offset:4608
  ds_write_b128 v76, v[56:59] offset:5632
  v_cmp_eq_u32 vcc, -1, v72
  s_cbranch_vccz Cf0_h2w
  s_cmp_lt_u32 s67, 131072
  s_cbranch_scc1 Cf0_h2r
Cf0_h2ok:
  ds_write_b128 v76, v[52:55] offset:4608
  ds_write_b128 v76, v[56:59] offset:5632
  s_branch Cf0_h2w
Cf0_rec:
  s_nop 7
  s_waitcnt vmcnt(0) lgkmcnt(0)
  v_max3_u32 v72, v0, v1, v2
  v_max3_u32 v72, v72, v3, v4
  v_max3_u32 v72, v72, v5, v6
  v_max3_u32 v72, v72, v7, v8
  v_max3_u32 v72, v72, v9, v10
  v_max3_u32 v72, v72, v11, v12
  v_max3_u32 v72, v72, v13, v14
  v_max3_u32 v72, v72, v15, v16
  v_max3_u32 v72, v72, v17, v18
  v_max_u32 v72, v72, v19
  v_cmp_eq_u32 vcc, -1, v72
  s_cbranch_vccz Cf0_recok
  s_barrier
  v_mov_b64 v[20:21], 0
  v_mov_b64 v[22:23], 0
  v_mov_b64 v[24:25], 0
  v_mov_b64 v[26:27], 0
  v_mov_b64 v[28:29], 0
  v_mov_b64 v[30:31], 0
  v_mov_b64 v[32:33], 0
  v_mov_b64 v[34:35], 0
  s_waitcnt lgkmcnt(0)
  s_barrier
  ds_read_b128 v[0:3], v76 offset:4608
  ds_read_b128 v[60:63], v76 offset:16384
  ds_read_b128 v[64:67], v76 offset:17408
  s_waitcnt lgkmcnt(0)
  v_smfmac_f32_16x16x64_bf16 v[20:23], v[0:3], v[60:67], v74
  ds_read_b128 v[60:63], v76 offset:18432
  ds_read_b128 v[64:67], v76 offset:19456
  s_waitcnt lgkmcnt(0)
  v_smfmac_f32_16x16x64_bf16 v[24:27], v[0:3], v[60:67], v74
  ds_read_b128 v[60:63], v76 offset:32768
  ds_read_b128 v[64:67], v76 offset:33792
  s_waitcnt lgkmcnt(0)
  v_smfmac_f32_16x16x64_bf16 v[28:31], v[0:3], v[60:67], v74
  ds_read_b128 v[60:63], v76 offset:34816
  ds_read_b128 v[64:67], v76 offset:35840
  s_waitcnt lgkmcnt(0)
  v_smfmac_f32_16x16x64_bf16 v[32:35], v[0:3], v[60:67], v74
  ds_read_b128 v[4:7], v76 offset:5632
  s_waitcnt lgkmcnt(0)
  v_smfmac_f32_16x16x64_bf16 v[20:23], v[4:7], v[80:87], v74
  v_smfmac_f32_16x16x64_bf16 v[24:27], v[4:7], v[88:95], v74
  v_smfmac_f32_16x16x64_bf16 v[28:31], v[4:7], v[208:215], v74
  v_smfmac_f32_16x16x64_bf16 v[32:35], v[4:7], v[216:223], v74
  ds_read_b128 v[8:11], v76 offset:6656
  s_waitcnt lgkmcnt(0)
  v_smfmac_f32_16x16x64_bf16 v[20:23], v[8:11], v[96:103], v74
  v_smfmac_f32_16x16x64_bf16 v[24:27], v[8:11], v[104:111], v74
  ds_read_b128 v[60:63], v76 offset:49152
  ds_read_b128 v[64:67], v76 offset:50176
  s_waitcnt lgkmcnt(0)
  v_smfmac_f32_16x16x64_bf16 v[28:31], v[8:11], v[60:67], v74
  ds_read_b128 v[60:63], v76 offset:51200
  ds_read_b128 v[64:67], v76 offset:52224
  s_waitcnt lgkmcnt(0)
  v_smfmac_f32_16x16x64_bf16 v[32:35], v[8:11], v[60:67], v74
  ds_read_b128 v[12:15], v76 offset:7680
  s_waitcnt lgkmcnt(0)
  v_smfmac_f32_16x16x64_bf16 v[20:23], v[12:15], v[112:119], v74
  v_smfmac_f32_16x16x64_bf16 v[24:27], v[12:15], v[120:127], v74
  v_smfmac_f32_16x16x64_bf16 v[28:31], v[12:15], v[224:231], v74
  v_smfmac_f32_16x16x64_bf16 v[32:35], v[12:15], v[232:239], v74
  ds_read_b128 v[0:3], v76 offset:8704
  s_waitcnt lgkmcnt(0)
  v_smfmac_f32_16x16x64_bf16 v[20:23], v[0:3], v[128:135], v74
  v_smfmac_f32_16x16x64_bf16 v[24:27], v[0:3], v[136:143], v74
  ds_read_b128 v[60:63], v75 offset:0
  ds_read_b128 v[64:67], v75 offset:1024
  s_waitcnt lgkmcnt(0)
  v_smfmac_f32_16x16x64_bf16 v[28:31], v[0:3], v[60:67], v74
  ds_read_b128 v[60:63], v75 offset:2048
  ds_read_b128 v[64:67], v75 offset:3072
  s_waitcnt lgkmcnt(0)
  v_smfmac_f32_16x16x64_bf16 v[32:35], v[0:3], v[60:67], v74
  ds_read_b128 v[4:7], v76 offset:9728
  s_waitcnt lgkmcnt(0)
  v_smfmac_f32_16x16x64_bf16 v[20:23], v[4:7], v[144:151], v74
  v_smfmac_f32_16x16x64_bf16 v[24:27], v[4:7], v[152:159], v74
  ds_read_b128 v[60:63], v75 offset:16384
  ds_read_b128 v[64:67], v75 offset:17408
  s_waitcnt lgkmcnt(0)
  v_smfmac_f32_16x16x64_bf16 v[28:31], v[4:7], v[60:67], v74
  ds_read_b128 v[60:63], v75 offset:18432
  ds_read_b128 v[64:67], v75 offset:19456
  s_waitcnt lgkmcnt(0)
  v_smfmac_f32_16x16x64_bf16 v[32:35], v[4:7], v[60:67], v74
  ds_read_b128 v[16:19], v76 offset:10752
  s_waitcnt lgkmcnt(0)
  v_smfmac_f32_16x16x64_bf16 v[20:23], v[16:19], v[160:167], v74
  v_smfmac_f32_16x16x64_bf16 v[24:27], v[16:19], v[168:175], v74
  v_smfmac_f32_16x16x64_bf16 v[28:31], v[16:19], v[240:247], v74
  v_smfmac_f32_16x16x64_bf16 v[32:35], v[16:19], v[248:255], v74
  ds_read_b128 v[12:15], v76 offset:11776
  s_waitcnt lgkmcnt(0)
  v_smfmac_f32_16x16x64_bf16 v[20:23], v[12:15], v[176:183], v74
  v_smfmac_f32_16x16x64_bf16 v[24:27], v[12:15], v[184:191], v74
  v_smfmac_f32_16x16x64_bf16 v[28:31], v[12:15], a[0:7], v74
  v_smfmac_f32_16x16x64_bf16 v[32:35], v[12:15], a[8:15], v74
  ds_read_b128 v[8:11], v76 offset:12800
  s_waitcnt lgkmcnt(0)
  v_smfmac_f32_16x16x64_bf16 v[20:23], v[8:11], v[192:199], v74
  v_smfmac_f32_16x16x64_bf16 v[24:27], v[8:11], v[200:207], v74
  v_smfmac_f32_16x16x64_bf16 v[28:31], v[8:11], a[16:23], v74
  v_smfmac_f32_16x16x64_bf16 v[32:35], v[8:11], a[24:31], v74
  v_add_f32 v20, v20, v22
  v_add_f32 v21, v21, v23
  v_add_f32 v24, v24, v26
  v_cvt_pk_bf16_f32 v22, v20, v24
  s_nop 0
  ds_write_b32 v79, v22 offset:0
  v_add_f32 v25, v25, v27
  v_cvt_pk_bf16_f32 v23, v21, v25
  ds_write_b32 v79, v23 offset:576
  v_add_f32 v28, v28, v30
  v_add_f32 v29, v29, v31
  s_waitcnt lgkmcnt(0)
  s_nop 1
  s_branch Cf0_recok
Cf0_mx:
  s_waitcnt lgkmcnt(0)
  s_barrier
  buffer_load_dwordx4 v[0:3], v76, s[8:11], s58 offen offset:0 sc1
  ds_read_b128 v[20:23], v77 offset:0
  ds_read_b128 v[28:31], v77 offset:256
  buffer_load_dwordx4 v[4:7], v76, s[8:11], s58 offen offset:1024 sc1
  ds_read_b128 v[24:27], v77 offset:128
  ds_read_b128 v[32:35], v77 offset:384
  s_waitcnt vmcnt(1) lgkmcnt(3)
  v_mfma_f32_16x16x32_bf16 v[8:11], v[0:3], v[20:23], 0
  s_waitcnt vmcnt(0) lgkmcnt(1)
  v_mfma_f32_16x16x32_bf16 v[8:11], v[4:7], v[24:27], v[8:11]
  v_mfma_f32_16x16x32_bf16 v[12:15], v[28:31], v[20:23], 0
  s_waitcnt lgkmcnt(0)
  v_mfma_f32_16x16x32_bf16 v[12:15], v[32:35], v[24:27], v[12:15]
  v_add_f32_dpp v8, v10, v8 quad_perm:[2,3,0,1] row_mask:0xf bank_mask:0xf
  v_add_f32_dpp v9, v11, v9 quad_perm:[2,3,0,1] row_mask:0xf bank_mask:0xf
  s_nop 0
  v_mov_b32_dpp v8, v8 quad_perm:[0,1,0,1] row_mask:0xf bank_mask:0xf
  v_mov_b32_dpp v9, v9 quad_perm:[0,1,0,1] row_mask:0xf bank_mask:0xf
  s_nop 1
  v_add_f32_dpp v12, v14, v12 quad_perm:[2,3,0,1] row_mask:0xf bank_mask:0xf
  v_add_f32_dpp v13, v15, v13 quad_perm:[2,3,0,1] row_mask:0xf bank_mask:0xf
  s_nop 0
  v_mov_b32_dpp v12, v12 quad_perm:[0,1,0,1] row_mask:0xf bank_mask:0xf
  v_mov_b32_dpp v13, v13 quad_perm:[0,1,0,1] row_mask:0xf bank_mask:0xf
  v_mul_f32 v12, s69, v12
  ds_write_b32 v78, v8 offset:8704
  v_mul_f32 v13, s69, v13
  ds_write_b32 v78, v9 offset:8768
  s_waitcnt lgkmcnt(0)
  s_barrier
  ds_read_b128 v[36:39], v78 offset:8704
  ds_read_b128 v[40:43], v78 offset:8768
  s_waitcnt lgkmcnt(0)
  s_barrier
  v_max_f32 v16, v36, v37
  v_max3_f32 v16, v16, v38, v39
  v_max3_f32 v16, v16, v40, v41
  v_max3_f32 v16, v16, v42, v43
  v_max3_f32 v16, v16, v12, v13
  v_mov_b32 v17, v16
  s_nop 1
  v_permlane16_swap_b32 v16, v17
  v_max_f32 v16, v16, v17
  v_mov_b32 v17, v16
  s_nop 1
  v_permlane32_swap_b32 v16, v17
  v_max_f32 v16, v16, v17
  v_sub_f32 v36, v36, v16
  v_sub_f32 v37, v37, v16
  v_sub_f32 v38, v38, v16
  v_sub_f32 v39, v39, v16
  v_sub_f32 v40, v40, v16
  v_sub_f32 v41, v41, v16
  v_sub_f32 v42, v42, v16
  v_sub_f32 v43, v43, v16
  v_sub_f32 v12, v12, v16
  v_sub_f32 v13, v13, v16
  v_exp_f32 v36, v36
  v_exp_f32 v37, v37
  v_exp_f32 v38, v38
  v_exp_f32 v39, v39
  v_exp_f32 v40, v40
  v_exp_f32 v41, v41
  v_exp_f32 v42, v42
  v_exp_f32 v43, v43
  v_exp_f32 v12, v12
  v_exp_f32 v13, v13
  v_cvt_pk_bf16_f32 v32, v36, v40
  v_cvt_pk_bf16_f32 v33, v37, v41
  v_cvt_pk_bf16_f32 v34, v38, v42
  v_cvt_pk_bf16_f32 v35, v39, v43
  v_cvt_pk_bf16_f32 v28, v12, v13
  v_cvt_pk_bf16_f32 v31, v12, v13
  v_mov_b32 v29, 0
  v_mov_b32 v30, 0
  v_mov_b32 v68, 0x3f803f80
  v_mov_b32 v69, 0x3f803f80
  v_mov_b32 v70, 0x3f803f80
  v_mov_b32 v71, 0x3f803f80
  s_nop 1
  v_mfma_f32_16x16x32_bf16 v[8:11], v[32:35], v[68:71], 0
  v_mfma_f32_16x16x32_bf16 v[0:3], v[32:35], v[52:55], 0
  v_mfma_f32_16x16x32_bf16 v[4:7], v[32:35], v[56:59], 0
  v_mfma_f32_16x16x16_bf16 v[8:11], v[28:29], v[68:69], v[8:11]
  v_mfma_f32_16x16x16_bf16 v[0:3], v[28:29], v[72:73], v[0:3]
  v_mfma_f32_16x16x16_bf16 v[4:7], v[30:31], v[72:73], v[4:7]
  ds_read_b128 v[68:71], v76 offset:13824
  v_rcp_f32 v10, v8
  v_rcp_f32 v11, v9
  v_mul_f32 v0, v10, v0
  v_mul_f32 v1, v11, v1
  s_nop 0
  v_mul_f32 v4, v10, v4
  v_mul_f32 v5, v11, v5
  v_cvt_pk_bf16_f32 v2, v0, v4
  ds_write_b32 v79, v2 offset:8704
  v_cvt_pk_bf16_f32 v3, v1, v5
  ds_write_b32 v79, v3 offset:9280
  v_mov_b64 v[16:17], 0
  v_mov_b64 v[18:19], 0
  v_mov_b64 v[20:21], 0
  v_mov_b64 v[22:23], 0
  v_mov_b64 v[24:25], 0
  v_mov_b64 v[26:27], 0
  s_branch Cf0_mxok
Cf0_last:
  s_waitcnt lgkmcnt(0)
  ds_read_b64 v[16:17], v77 offset:256
  v_mov_b64 v[18:19], v[72:73]
  s_add_u32 s68, s68, 655360
  s_waitcnt lgkmcnt(0)
  buffer_store_dwordx4 v[16:19], v76, s[8:11], s68 offen sc1
  s_branch L_cexit
L_w1:
  v_mov_b64 v[20:21], 0
  v_mov_b64 v[22:23], 0
  v_mov_b64 v[24:25], 0
  v_mov_b64 v[26:27], 0
  v_mov_b64 v[28:29], 0
  v_mov_b64 v[30:31], 0
  v_mov_b64 v[32:33], 0
  v_mov_b64 v[34:35], 0
  s_mov_b32 s78, 0x3f803f80
  s_mov_b32 s79, s78
  s_mov_b32 s65, 360448
  s_mov_b32 m0, 15872
  v_lshlrev_b32 v73, 2, v76
  v_mov_b32 v72, 0
  ds_read_b128 v[60:63], v76 offset:20480
  ds_read_b128 v[64:67], v76 offset:21504
  ds_read_b128 v[44:47], v76 offset:22528
  ds_read_b128 v[48:51], v76 offset:23552
  ds_read_b128 v[36:39], v76 offset:36864
  ds_read_b128 v[40:43], v76 offset:37888
  ds_read_b128 v[0:3], v76 offset:4608
  ds_read_b128 v[4:7], v76 offset:5632
  s_branch Cf1_top2
.p2align 6
Cf1_h2:
  v_lshlrev_b32 v73, 2, v76
  s_nop 15
  s_nop 3
  buffer_load_dwordx4 v[52:55], v76, s[8:11], s65 offen offset:2048 sc1
  s_nop 15
  s_nop 1
  buffer_load_dwordx4 v[52:55], v76, s[8:11], s65 offen offset:2048 sc1
  s_nop 15
  s_nop 1
  buffer_load_dwordx4 v[52:55], v76, s[8:11], s65 offen offset:2048 sc1
  s_waitcnt vmcnt(5)
  ds_read_b128 v[60:63], v76 offset:20480
  ds_read_b128 v[64:67], v76 offset:21504
  ds_read_b128 v[44:47], v76 offset:22528
  ds_read_b128 v[48:51], v76 offset:23552
  ds_read_b128 v[36:39], v76 offset:36864
  ds_read_b128 v[40:43], v76 offset:37888
  s_waitcnt vmcnt(2)
  v_max3_u32 v72, v52, v53, v54
  v_max_u32 v72, v72, v55
  ds_write_b128 v76, v[52:55] offset:6656
  v_cmp_eq_u32 vcc, -1, v72
  s_cbranch_vccnz Cf1_h2r
Cf1_h2w:
  s_waitcnt lgkmcnt(0)
  s_barrier
  ds_read_b128 v[0:3], v76 offset:4608
  ds_read_b128 v[4:7], v76 offset:5632
Cf1_top2:
  ds_read_b128 v[8:11], v76 offset:6656
  s_waitcnt lgkmcnt(2)
  v_smfmac_f32_16x16x64_bf16 v[20:23], v[0:3], v[60:67], v74
  ds_read_b128 v[60:63], v76 offset:38912
  v_smfmac_f32_16x16x64_bf16 v[24:27], v[0:3], v[44:51], v74
  buffer_load_dwordx4 v[44:47], v76, s[8:11], s58 offen offset:0 sc1
  ds_read_b128 v[64:67], v76 offset:39936
  s_waitcnt lgkmcnt(3)
  v_smfmac_f32_16x16x64_bf16 v[20:23], v[4:7], v[80:87], v74
  buffer_load_dwordx4 v[48:51], v76, s[8:11], s58 offen offset:1024 sc1
  v_smfmac_f32_16x16x64_bf16 v[28:31], v[0:3], v[36:43], v74
  buffer_load_dwordx4 v[52:55], v76, s[8:11], s59 offen offset:0 sc1
  ds_read_b128 v[36:39], v76 offset:53248
  v_smfmac_f32_16x16x64_bf16 v[24:27], v[4:7], v[88:95], v74
  buffer_load_dwordx4 v[56:59], v76, s[8:11], s59 offen offset:1024 sc1
  ds_read_b128 v[40:43], v76 offset:54272
  v_smfmac_f32_16x16x64_bf16 v[28:31], v[4:7], v[208:215], v74
  ds_read_b128 v[12:15], v76 offset:7680
  s_waitcnt lgkmcnt(5)
  v_smfmac_f32_16x16x64_bf16 v[32:35], v[4:7], v[216:223], v74
  buffer_store_dwordx4 v[16:19], v76, s[8:11], s68 offen sc1
  s_waitcnt lgkmcnt(3)
  v_smfmac_f32_16x16x64_bf16 v[32:35], v[0:3], v[60:67], v74
  buffer_load_dword v73, s[8:11], s70 offen  lds
  v_smfmac_f32_16x16x64_bf16 v[20:23], v[8:11], v[96:103], v74
  ds_read_b128 v[60:63], v76 offset:55296
  v_smfmac_f32_16x16x64_bf16 v[24:27], v[8:11], v[104:111], v74
  ds_read_b128 v[64:67], v76 offset:56320
  s_waitcnt lgkmcnt(3)
  v_smfmac_f32_16x16x64_bf16 v[28:31], v[8:11], v[36:43], v74
  ds_read_b128 v[36:39], v75 offset:4096
  s_waitcnt lgkmcnt(3)
  v_smfmac_f32_16x16x64_bf16 v[20:23], v[12:15], v[112:119], v74
  ds_read_b128 v[40:43], v75 offset:5120
  v_smfmac_f32_16x16x64_bf16 v[24:27], v[12:15], v[120:127], v74
  s_barrier
  ds_read_b128 v[0:3], v76 offset:8704
  v_smfmac_f32_16x16x64_bf16 v[28:31], v[12:15], v[224:231], v74
  ds_read_b128 v[4:7], v76 offset:9728
  v_smfmac_f32_16x16x64_bf16 v[32:35], v[12:15], v[232:239], v74
  s_waitcnt lgkmcnt(4)
  v_smfmac_f32_16x16x64_bf16 v[32:35], v[8:11], v[60:67], v74
  ds_read_b128 v[60:63], v75 offset:6144
  s_waitcnt lgkmcnt(2)
  v_smfmac_f32_16x16x64_bf16 v[20:23], v[0:3], v[128:135], v74
  ds_read_b128 v[16:19], v76 offset:10752
  v_smfmac_f32_16x16x64_bf16 v[24:27], v[0:3], v[136:143], v74
  ds_read_b128 v[64:67], v75 offset:7168
  v_smfmac_f32_16x16x64_bf16 v[28:31], v[0:3], v[36:43], v74
  ds_read_b128 v[36:39], v75 offset:20480
  s_waitcnt lgkmcnt(4)
  v_smfmac_f32_16x16x64_bf16 v[20:23], v[4:7], v[144:151], v74
  ds_read_b128 v[12:15], v76 offset:11776
  v_smfmac_f32_16x16x64_bf16 v[24:27], v[4:7], v[152:159], v74
  ds_read_b128 v[40:43], v75 offset:21504
  s_waitcnt lgkmcnt(4)
  v_smfmac_f32_16x16x64_bf16 v[20:23], v[16:19], v[160:167], v74
  ds_read_b128 v[8:11], v76 offset:12800
  s_waitcnt lgkmcnt(4)
  v_smfmac_f32_16x16x64_bf16 v[32:35], v[0:3], v[60:67], v74
  ds_read_b128 v[60:63], v75 offset:22528
  v_mov_b64 v[68:69], s[78:79]
  v_smfmac_f32_16x16x64_bf16 v[24:27], v[16:19], v[168:175], v74
  ds_read_b128 v[64:67], v75 offset:23552
  s_waitcnt lgkmcnt(4)
  v_smfmac_f32_16x16x64_bf16 v[20:23], v[12:15], v[176:183], v74
  s_waitcnt lgkmcnt(3)
  v_mov_b64 v[70:71], s[78:79]
  v_smfmac_f32_16x16x64_bf16 v[28:31], v[4:7], v[36:43], v74
  s_waitcnt lgkmcnt(2)
  v_mov_b64 v[36:37], 0
  v_smfmac_f32_16x16x64_bf16 v[20:23], v[8:11], v[192:199], v74
  v_mov_b64 v[38:39], 0
  v_smfmac_f32_16x16x64_bf16 v[24:27], v[12:15], v[184:191], v74
  v_mov_b64 v[40:41], 0
  v_smfmac_f32_16x16x64_bf16 v[24:27], v[8:11], v[200:207], v74
  s_waitcnt lgkmcnt(0)
  v_add_f32 v20, v20, v22
  v_smfmac_f32_16x16x64_bf16 v[32:35], v[4:7], v[60:67], v74
  v_add_f32 v21, v21, v23
  v_smfmac_f32_16x16x64_bf16 v[28:31], v[16:19], v[240:247], v74
  v_add_f32 v24, v24, v26
  v_cvt_pk_bf16_f32 v22, v20, v24
  v_smfmac_f32_16x16x64_bf16 v[28:31], v[12:15], a[0:7], v74
  ds_write_b32 v79, v22 offset:0
  v_add_f32 v25, v25, v27
  v_cvt_pk_bf16_f32 v23, v21, v25
  v_smfmac_f32_16x16x64_bf16 v[28:31], v[8:11], a[16:23], v74
  ds_write_b32 v79, v23 offset:576
  v_cmp_u_f32 vcc, v20, v21
  v_smfmac_f32_16x16x64_bf16 v[32:35], v[16:19], v[248:255], v74
  v_mov_b64 v[42:43], 0
  v_smfmac_f32_16x16x64_bf16 v[32:35], v[12:15], a[8:15], v74
  v_add_f32 v28, v28, v30
  v_add_f32 v29, v29, v31
  v_smfmac_f32_16x16x64_bf16 v[32:35], v[8:11], a[24:31], v74
  s_cbranch_vccnz Cf1_rec
Cf1_recok:
  v_smfmac_f32_16x16x64_bf16 v[36:39], v[16:19], a[128:135], v74
  s_waitcnt lgkmcnt(0)
  s_barrier
  ds_read_b128 v[60:63], v77
  v_smfmac_f32_16x16x64_bf16 v[40:43], v[16:19], a[136:143], v74
  ds_read_b128 v[64:67], v77 offset:128
  v_add_f32 v32, v32, v34
  v_cvt_pk_bf16_f32 v30, v28, v32
  v_smfmac_f32_16x16x64_bf16 v[36:39], v[0:3], a[96:103], v74
  ds_write_b32 v79, v30 offset:256
  v_add_f32 v33, v33, v35
  v_cvt_pk_bf16_f32 v31, v29, v33
  v_smfmac_f32_16x16x64_bf16 v[40:43], v[0:3], a[104:111], v74
  ds_write_b32 v79, v31 offset:832
  v_xor_b32 v75, 0x8000, v75
  v_smfmac_f32_16x16x64_bf16 v[36:39], v[4:7], a[112:119], v74
  ds_read_b128 v[0:3], v76 offset:4608
  v_mov_b32 v29, 0
  v_smfmac_f32_16x16x64_bf16 v[40:43], v[4:7], a[120:127], v74
  s_waitcnt vmcnt(4) lgkmcnt(3)
  v_mov_b32 v30, 0
  v_mfma_f32_16x16x32_bf16 v[44:47], v[44:47], v[60:63], 0
  ds_read_b128 v[4:7], v76 offset:5632
  s_waitcnt lgkmcnt(2)
  v_mfma_f32_16x16x32_bf16 v[44:47], v[48:51], v[64:67], v[44:47]
  s_barrier
  v_smfmac_f32_16x16x64_bf16 v[36:39], v[8:11], a[160:167], v74
  ds_read_b128 v[20:23], v77 offset:256
  ds_read_b128 v[24:27], v77 offset:384
  v_smfmac_f32_16x16x64_bf16 v[40:43], v[8:11], a[168:175], v74
  ds_read_b128 v[8:11], v76 offset:6656
  v_add_f32_dpp v72, v46, v44 quad_perm:[2,3,0,1] row_mask:0xf bank_mask:0xf
  v_add_f32_dpp v73, v47, v45 quad_perm:[2,3,0,1] row_mask:0xf bank_mask:0xf
  v_smfmac_f32_16x16x64_bf16 v[36:39], v[12:15], a[144:151], v74
  s_waitcnt lgkmcnt(4)
  v_exp_f32_dpp v72, v72 quad_perm:[0,1,0,1] row_mask:0xf bank_mask:0xf
  v_smfmac_f32_16x16x64_bf16 v[40:43], v[12:15], a[152:159], v74
  ds_read_b128 v[12:15], v76 offset:7680
  v_exp_f32_dpp v73, v73 quad_perm:[0,1,0,1] row_mask:0xf bank_mask:0xf
  v_smfmac_f32_16x16x64_bf16 v[36:39], v[0:3], a[32:39], v74
  s_waitcnt lgkmcnt(2)
  v_cvt_pk_bf16_f32 v72, v72, v73
  v_mfma_f32_16x16x32_bf16 v[20:23], v[20:23], v[60:63], 0
  ds_write_b32 v78, v72 offset:516
  v_mov_b64 v[16:17], 0
  v_mfma_f32_16x16x32_bf16 v[20:23], v[24:27], v[64:67], v[20:23]
  ds_read_b128 v[44:47], v75 offset:20480
  v_mov_b64 v[18:19], 0
  v_smfmac_f32_16x16x64_bf16 v[40:43], v[0:3], a[40:47], v74
  ds_read_b128 v[48:51], v75 offset:21504
  s_waitcnt lgkmcnt(4)
  v_smfmac_f32_16x16x64_bf16 v[36:39], v[4:7], a[48:55], v74
  v_add_f32_dpp v24, v22, v20 quad_perm:[2,3,0,1] row_mask:0xf bank_mask:0xf
  v_add_f32_dpp v25, v23, v21 quad_perm:[2,3,0,1] row_mask:0xf bank_mask:0xf
  v_smfmac_f32_16x16x64_bf16 v[36:39], v[8:11], a[64:71], v74
  s_waitcnt lgkmcnt(2)
  s_barrier
  ds_read_b128 v[32:35], v78 offset:512
  v_smfmac_f32_16x16x64_bf16 v[36:39], v[12:15], a[80:87], v74
  ds_read_b128 v[60:63], v75 offset:22528
  v_mul_f32 v24, s69, v24
  v_smfmac_f32_16x16x64_bf16 v[40:43], v[4:7], a[56:63], v74
  ds_read_b128 v[64:67], v75 offset:23552
  v_mul_f32 v25, s69, v25
  v_smfmac_f32_16x16x64_bf16 v[40:43], v[8:11], a[72:79], v74
  v_exp_f32_dpp v24, v24 quad_perm:[0,1,0,1] row_mask:0xf bank_mask:0xf
  v_smfmac_f32_16x16x64_bf16 v[40:43], v[12:15], a[88:95], v74
  s_waitcnt vmcnt(2) lgkmcnt(2)
  v_exp_f32_dpp v25, v25 quad_perm:[0,1,0,1] row_mask:0xf bank_mask:0xf
  v_mfma_f32_16x16x32_bf16 v[8:11], v[32:35], v[68:71], 0
  v_add_f32 v36, v36, v38
  v_add_f32 v37, v37, v39
  v_mfma_f32_16x16x32_bf16 v[0:3], v[32:35], v[52:55], 0
  v_add_f32 v40, v40, v42
  v_add_f32 v41, v41, v43
  v_mfma_f32_16x16x32_bf16 v[4:7], v[32:35], v[56:59], 0
  v_cvt_pk_bf16_f32 v28, v24, v25
  v_cvt_pk_bf16_f32 v72, v36, v37
  v_cvt_pk_bf16_f32 v73, v40, v41
  v_mfma_f32_16x16x16_bf16 v[8:11], v[28:29], v[68:69], v[8:11]
  v_cvt_pk_bf16_f32 v31, v24, v25
  v_mov_b64 v[20:21], 0
  v_mfma_f32_16x16x16_bf16 v[0:3], v[28:29], v[72:73], v[0:3]
  ds_read_b128 v[68:71], v76 offset:13824
  v_mov_b64 v[22:23], 0
  v_mfma_f32_16x16x16_bf16 v[4:7], v[30:31], v[72:73], v[4:7]
  v_rcp_f32 v10, v8
  v_rcp_f32 v11, v9
  v_mul_f32 v0, v10, v0
  v_mul_f32 v1, v11, v1
  s_nop 0
  v_mul_f32 v4, v10, v4
  v_mul_f32 v5, v11, v5
  v_cvt_pk_bf16_f32 v2, v0, v4
  ds_write_b32 v79, v2 offset:8704
  v_cvt_pk_bf16_f32 v3, v1, v5
  ds_write_b32 v79, v3 offset:9280
  v_max3_f32 v8, v8, v9, v10
  v_max_f32 v8, v8, v11
  v_cmp_le_f32 vcc, 1317011456, v8
  v_mov_b64 v[24:25], 0
  v_mov_b64 v[26:27], 0
  s_cbranch_vccnz Cf1_mx
Cf1_mxok:
  s_waitcnt lgkmcnt(0)
  s_barrier
  ds_read_b128 v[0:3], v78 offset:8704
  ds_read_b128 v[4:7], v78 offset:8768
  ds_read_b128 v[8:11], v78 offset:8832
  ds_read_b128 v[12:15], v78 offset:8896
  s_cmp_eq_u32 s66, 63
  s_cbranch_scc1 Cf1_last
  s_waitcnt lgkmcnt(3)
  v_smfmac_f32_16x16x64_bf16 v[16:19], v[0:3], v[44:51], v74
  ds_read_b128 v[52:55], v75 offset:36864
  s_waitcnt lgkmcnt(3)
  v_smfmac_f32_16x16x64_bf16 v[16:19], v[4:7], v[60:67], v74
  ds_read_b128 v[56:59], v75 offset:37888
  s_waitcnt lgkmcnt(3)
  v_smfmac_f32_16x16x64_bf16 v[16:19], v[8:11], a[176:183], v74
  ds_read_b128 v[36:39], v75 offset:38912
  s_waitcnt lgkmcnt(3)
  v_smfmac_f32_16x16x64_bf16 v[16:19], v[12:15], a[184:191], v74
  ds_read_b128 v[40:43], v75 offset:39936
  ds_read_b128 v[44:47], v75 offset:53248
  v_smfmac_f32_16x16x64_bf16 v[20:23], v[0:3], a[192:199], v74
  ds_read_b128 v[48:51], v75 offset:54272
  ds_read_b128 v[60:63], v75 offset:55296
  v_smfmac_f32_16x16x64_bf16 v[20:23], v[4:7], a[200:207], v74
  ds_read_b128 v[64:67], v75 offset:56320
  s_waitcnt lgkmcnt(6)
  v_cvt_pk_bf16_f32 v16, v16, v17
  v_cvt_pk_bf16_f32 v17, v18, v19
  v_bfi_b32 v16, 1, s72, v16
  v_smfmac_f32_16x16x64_bf16 v[20:23], v[8:11], v[52:59], v74
  buffer_store_dwordx2 v[16:17], v68, s[8:11], s73 offen
  s_waitcnt lgkmcnt(4)
  v_smfmac_f32_16x16x64_bf16 v[20:23], v[12:15], v[36:43], v74
  v_mov_b64 v[32:33], 0
  v_smfmac_f32_16x16x64_bf16 v[24:27], v[0:3], a[208:215], v74
  v_mov_b64 v[34:35], 0
  v_smfmac_f32_16x16x64_bf16 v[24:27], v[4:7], a[216:223], v74
  s_waitcnt lgkmcnt(2)
  v_cvt_pk_bf16_f32 v20, v20, v21
  v_cvt_pk_bf16_f32 v21, v22, v23
  v_bfi_b32 v20, 1, s72, v20
  v_smfmac_f32_16x16x64_bf16 v[24:27], v[8:11], v[44:51], v74
  buffer_store_dwordx2 v[20:21], v68, s[8:11], s74 offen
  s_waitcnt lgkmcnt(0)
  v_smfmac_f32_16x16x64_bf16 v[24:27], v[12:15], v[60:67], v74
  v_smfmac_f32_16x16x64_bf16 v[32:35], v[0:3], a[224:231], v74
  v_smfmac_f32_16x16x64_bf16 v[32:35], v[4:7], a[232:239], v74
  v_cvt_pk_bf16_f32 v24, v24, v25
  v_cvt_pk_bf16_f32 v25, v26, v27
  v_bfi_b32 v24, 1, s72, v24
  v_smfmac_f32_16x16x64_bf16 v[32:35], v[8:11], a[240:247], v74
  s_nop 1
  buffer_store_dwordx2 v[24:25], v68, s[8:11], s75 offen
  v_smfmac_f32_16x16x64_bf16 v[32:35], v[12:15], a[248:255], v74
  ds_read_b128 v[0:3], v76 offset:14848
  ds_read_b64 v[16:17], v77 offset:264
  v_mov_b64 v[18:19], v[72:73]
  v_xor_b32 v75, 0x8000, v75
  s_nop 3
  v_cvt_pk_bf16_f32 v32, v32, v33
  v_cvt_pk_bf16_f32 v33, v34, v35
  v_bfi_b32 v32, 1, s72, v32
  buffer_store_dwordx2 v[32:33], v68, s[8:11], s76 offen
  v_mov_b64 v[20:21], 0
  v_mov_b64 v[22:23], 0
  v_mov_b64 v[24:25], 0
  v_mov_b64 v[26:27], 0
  v_mov_b64 v[28:29], 0
  v_mov_b64 v[30:31], 0
  v_mov_b64 v[32:33], 0
  v_mov_b64 v[34:35], 0
  s_add_u32 s58, s58, 655360
  s_add_u32 s59, s59, 655360
  s_add_u32 s70, s70, 655360
  s_add_u32 s68, s68, 655360
  s_add_u32 s66, s66, 1
  s_xor_b32 s64, s64, 16384
  s_xor_b32 s65, s65, 16384
  s_nop 15
  s_nop 15
  s_nop 7
  buffer_load_dwordx4 v[52:55], v76, s[8:11], s60 offen offset:0 sc1
  buffer_load_dwordx4 v[56:59], v76, s[8:11], s60 offen offset:1024 sc1
  s_nop 15
  s_nop 11
  buffer_load_dwordx4 v[36:39], v76, s[8:11], s60 offen offset:0 sc1
  buffer_load_dwordx4 v[40:43], v76, s[8:11], s60 offen offset:1024 sc1
  s_waitcnt lgkmcnt(0)
  s_waitcnt vmcnt(3)
  v_mfma_f32_16x16x32_bf16 v[4:7], v[0:3], v[52:55], 0
  v_bitop3_b32 v72, v52, v54, s72 bitop3:0x7e
  s_waitcnt vmcnt(2)
  v_mfma_f32_16x16x32_bf16 v[4:7], v[0:3], v[56:59], v[4:7]
  v_bitop3_b32 v73, v56, v58, s72 bitop3:0x7e
  v_bitop3_b32 v72, v72, v73, 1 bitop3:0xa8
  v_cmp_ne_u32 vcc, 0, v72
  s_nop 0
  s_cmp_eq_u64 vcc, 0
  s_cselect_b32 s54, s62, 268435456
  s_nop 0
  v_add_f32_dpp v4, v4, v4 row_ror:4 row_mask:0xf bank_mask:0xf
  v_add_f32_dpp v5, v5, v5 row_ror:4 row_mask:0xf bank_mask:0xf
  s_nop 0
  v_add_f32_dpp v4, v4, v4 row_ror:8 row_mask:0xf bank_mask:0xf
  v_add_f32_dpp v5, v5, v5 row_ror:8 row_mask:0xf bank_mask:0xf
  v_cvt_pk_bf16_f32 v4, v4, v5
  buffer_store_dword v4, v69, s[8:11], s54 offen
  s_cbranch_vccnz Cf1_h1r
  s_xor_b32 s62, s62, 16384
  buffer_store_dword v71, v69, s[8:11], s62 offen
  s_xor_b32 s72, s72, 1
  s_branch Cf1_h2
Cf1_h1r:
  s_mov_b64 exec, vcc
  buffer_load_dwordx4 v[52:55], v76, s[8:11], s60 offen offset:0 sc1
  buffer_load_dwordx4 v[56:59], v76, s[8:11], s60 offen offset:1024 sc1
  s_mov_b64 exec, -1
  s_add_u32 s67, s67, 1
  s_waitcnt vmcnt(4)
  v_mfma_f32_16x16x32_bf16 v[4:7], v[0:3], v[36:39], 0
  v_bitop3_b32 v72, v36, v38, s72 bitop3:0x7e
  s_waitcnt vmcnt(3)
  v_mfma_f32_16x16x32_bf16 v[4:7], v[0:3], v[40:43], v[4:7]
  v_bitop3_b32 v73, v40, v42, s72 bitop3:0x7e
  v_bitop3_b32 v72, v72, v73, 1 bitop3:0xa8
  v_cmp_ne_u32 vcc, 0, v72
  s_cbranch_vccz Cf1_h1p
  s_mov_b64 exec, vcc
  buffer_load_dwordx4 v[36:39], v76, s[8:11], s60 offen offset:0 sc1
  buffer_load_dwordx4 v[40:43], v76, s[8:11], s60 offen offset:1024 sc1
  s_mov_b64 exec, -1
  s_add_u32 s67, s67, 1
  s_waitcnt vmcnt(3)
  v_mfma_f32_16x16x32_bf16 v[4:7], v[0:3], v[52:55], 0
  v_bitop3_b32 v72, v52, v54, s72 bitop3:0x7e
  s_waitcnt vmcnt(2)
  v_mfma_f32_16x16x32_bf16 v[4:7], v[0:3], v[56:59], v[4:7]
  v_bitop3_b32 v73, v56, v58, s72 bitop3:0x7e
  v_bitop3_b32 v72, v72, v73, 1 bitop3:0xa8
  v_cmp_ne_u32 vcc, 0, v72
  s_cbranch_vccz Cf1_h1p
Cf1_h1s:
  s_mov_b64 exec, vcc
  buffer_load_dwordx4 v[52:55], v76, s[8:11], s60 offen offset:0 sc1
  buffer_load_dwordx4 v[56:59], v76, s[8:11], s60 offen offset:1024 sc1
  s_mov_b64 exec, -1
  s_add_u32 s67, s67, 1
  s_waitcnt vmcnt(3)
  v_mfma_f32_16x16x32_bf16 v[4:7], v[0:3], v[36:39], 0
  v_bitop3_b32 v72, v36, v38, s72 bitop3:0x7e
  s_waitcnt vmcnt(2)
  v_mfma_f32_16x16x32_bf16 v[4:7], v[0:3], v[40:43], v[4:7]
  v_bitop3_b32 v73, v40, v42, s72 bitop3:0x7e
  v_bitop3_b32 v72, v72, v73, 1 bitop3:0xa8
  v_cmp_ne_u32 vcc, 0, v72
  s_cbranch_vccz Cf1_h1p
  s_mov_b64 exec, vcc
  buffer_load_dwordx4 v[36:39], v76, s[8:11], s60 offen offset:0 sc1
  buffer_load_dwordx4 v[40:43], v76, s[8:11], s60 offen offset:1024 sc1
  s_mov_b64 exec, -1
  s_add_u32 s67, s67, 1
  s_waitcnt vmcnt(3)
  v_mfma_f32_16x16x32_bf16 v[4:7], v[0:3], v[52:55], 0
  v_bitop3_b32 v72, v52, v54, s72 bitop3:0x7e
  s_waitcnt vmcnt(2)
  v_mfma_f32_16x16x32_bf16 v[4:7], v[0:3], v[56:59], v[4:7]
  v_bitop3_b32 v73, v56, v58, s72 bitop3:0x7e
  v_bitop3_b32 v72, v72, v73, 1 bitop3:0xa8
  v_cmp_ne_u32 vcc, 0, v72
  s_cbranch_vccz Cf1_h1p
  s_cmp_lt_u32 s67, 131072
  s_cbranch_scc1 Cf1_h1s
Cf1_h1p:
  s_nop 2
  v_add_f32_dpp v4, v4, v4 row_ror:4 row_mask:0xf bank_mask:0xf
  v_add_f32_dpp v5, v5, v5 row_ror:4 row_mask:0xf bank_mask:0xf
  s_nop 0
  v_add_f32_dpp v4, v4, v4 row_ror:8 row_mask:0xf bank_mask:0xf
  v_add_f32_dpp v5, v5, v5 row_ror:8 row_mask:0xf bank_mask:0xf
  v_cvt_pk_bf16_f32 v4, v4, v5
  buffer_store_dword v4, v69, s[8:11], s62 offen
  s_xor_b32 s62, s62, 16384
  buffer_store_dword v71, v69, s[8:11], s62 offen
  s_xor_b32 s72, s72, 1
  s_branch Cf1_h2
Cf1_h2r:
  s_mov_b64 exec, vcc
  buffer_load_dwordx4 v[52:55], v76, s[8:11], s65 offen offset:2048 sc1
  s_mov_b64 exec, -1
  s_add_u32 s67, s67, 1
  s_waitcnt vmcnt(2)
  v_max3_u32 v72, v52, v53, v54
  v_max_u32 v72, v72, v55
  ds_write_b128 v76, v[52:55] offset:6656
  v_cmp_eq_u32 vcc, -1, v72
  s_cbranch_vccz Cf1_h2w
  s_mov_b64 exec, vcc
  buffer_load_dwordx4 v[52:55], v76, s[8:11], s65 offen offset:2048 sc1
  s_mov_b64 exec, -1
  s_add_u32 s67, s67, 1
  s_waitcnt vmcnt(2)
  v_max3_u32 v72, v52, v53, v54
  v_max_u32 v72, v72, v55
  ds_write_b128 v76, v[52:55] offset:6656
  v_cmp_eq_u32 vcc, -1, v72
  s_cbranch_vccz Cf1_h2w
  s_mov_b64 exec, vcc
  buffer_load_dwordx4 v[52:55], v76, s[8:11], s65 offen offset:2048 sc1
  s_mov_b64 exec, -1
  s_add_u32 s67, s67, 1
  s_waitcnt vmcnt(2)
  v_max3_u32 v72, v52, v53, v54
  v_max_u32 v72, v72, v55
  ds_write_b128 v76, v[52:55] offset:6656
  v_cmp_eq_u32 vcc, -1, v72
  s_cbranch_vccz Cf1_h2w
  s_mov_b64 exec, vcc
  buffer_load_dwordx4 v[52:55], v76, s[8:11], s65 offen offset:2048 sc1
  s_mov_b64 exec, -1
  s_add_u32 s67, s67, 1
  s_waitcnt vmcnt(2)
  v_max3_u32 v72, v52, v53, v54
  v_max_u32 v72, v72, v55
  ds_write_b128 v76, v[52:55] offset:6656
  v_cmp_eq_u32 vcc, -1, v72
  s_cbranch_vccz Cf1_h2w
  s_cmp_lt_u32 s67, 131072
  s_cbranch_scc1 Cf1_h2r
Cf1_h2ok:
  ds_write_b128 v76, v[52:55] offset:6656
  s_branch Cf1_h2w
Cf1_rec:
  s_nop 7
  s_waitcnt vmcnt(0) lgkmcnt(0)
  v_max3_u32 v72, v0, v1, v2
  v_max3_u32 v72, v72, v3, v4
  v_max3_u32 v72, v72, v5, v6
  v_max3_u32 v72, v72, v7, v8
  v_max3_u32 v72, v72, v9, v10
  v_max3_u32 v72, v72, v11, v12
  v_max3_u32 v72, v72, v13, v14
  v_max3_u32 v72, v72, v15, v16
  v_max3_u32 v72, v72, v17, v18
  v_max_u32 v72, v72, v19
  v_cmp_eq_u32 vcc, -1, v72
  s_cbranch_vccz Cf1_recok
  s_barrier
  v_mov_b64 v[20:21], 0
  v_mov_b64 v[22:23], 0
  v_mov_b64 v[24:25], 0
  v_mov_b64 v[26:27], 0
  v_mov_b64 v[28:29], 0
  v_mov_b64 v[30:31], 0
  v_mov_b64 v[32:33], 0
  v_mov_b64 v[34:35], 0
  s_waitcnt lgkmcnt(0)
  s_barrier
  ds_read_b128 v[0:3], v76 offset:4608
  ds_read_b128 v[60:63], v76 offset:20480
  ds_read_b128 v[64:67], v76 offset:21504
  s_waitcnt lgkmcnt(0)
  v_smfmac_f32_16x16x64_bf16 v[20:23], v[0:3], v[60:67], v74
  ds_read_b128 v[60:63], v76 offset:22528
  ds_read_b128 v[64:67], v76 offset:23552
  s_waitcnt lgkmcnt(0)
  v_smfmac_f32_16x16x64_bf16 v[24:27], v[0:3], v[60:67], v74
  ds_read_b128 v[60:63], v76 offset:36864
  ds_read_b128 v[64:67], v76 offset:37888
  s_waitcnt lgkmcnt(0)
  v_smfmac_f32_16x16x64_bf16 v[28:31], v[0:3], v[60:67], v74
  ds_read_b128 v[60:63], v76 offset:38912
  ds_read_b128 v[64:67], v76 offset:39936
  s_waitcnt lgkmcnt(0)
  v_smfmac_f32_16x16x64_bf16 v[32:35], v[0:3], v[60:67], v74
  ds_read_b128 v[4:7], v76 offset:5632
  s_waitcnt lgkmcnt(0)
  v_smfmac_f32_16x16x64_bf16 v[20:23], v[4:7], v[80:87], v74
  v_smfmac_f32_16x16x64_bf16 v[24:27], v[4:7], v[88:95], v74
  v_smfmac_f32_16x16x64_bf16 v[28:31], v[4:7], v[208:215], v74
  v_smfmac_f32_16x16x64_bf16 v[32:35], v[4:7], v[216:223], v74
  ds_read_b128 v[8:11], v76 offset:6656
  s_waitcnt lgkmcnt(0)
  v_smfmac_f32_16x16x64_bf16 v[20:23], v[8:11], v[96:103], v74
  v_smfmac_f32_16x16x64_bf16 v[24:27], v[8:11], v[104:111], v74
  ds_read_b128 v[60:63], v76 offset:53248
  ds_read_b128 v[64:67], v76 offset:54272
  s_waitcnt lgkmcnt(0)
  v_smfmac_f32_16x16x64_bf16 v[28:31], v[8:11], v[60:67], v74
  ds_read_b128 v[60:63], v76 offset:55296
  ds_read_b128 v[64:67], v76 offset:56320
  s_waitcnt lgkmcnt(0)
  v_smfmac_f32_16x16x64_bf16 v[32:35], v[8:11], v[60:67], v74
  ds_read_b128 v[12:15], v76 offset:7680
  s_waitcnt lgkmcnt(0)
  v_smfmac_f32_16x16x64_bf16 v[20:23], v[12:15], v[112:119], v74
  v_smfmac_f32_16x16x64_bf16 v[24:27], v[12:15], v[120:127], v74
  v_smfmac_f32_16x16x64_bf16 v[28:31], v[12:15], v[224:231], v74
  v_smfmac_f32_16x16x64_bf16 v[32:35], v[12:15], v[232:239], v74
  ds_read_b128 v[0:3], v76 offset:8704
  s_waitcnt lgkmcnt(0)
  v_smfmac_f32_16x16x64_bf16 v[20:23], v[0:3], v[128:135], v74
  v_smfmac_f32_16x16x64_bf16 v[24:27], v[0:3], v[136:143], v74
  ds_read_b128 v[60:63], v75 offset:4096
  ds_read_b128 v[64:67], v75 offset:5120
  s_waitcnt lgkmcnt(0)
  v_smfmac_f32_16x16x64_bf16 v[28:31], v[0:3], v[60:67], v74
  ds_read_b128 v[60:63], v75 offset:6144
  ds_read_b128 v[64:67], v75 offset:7168
  s_waitcnt lgkmcnt(0)
  v_smfmac_f32_16x16x64_bf16 v[32:35], v[0:3], v[60:67], v74
  ds_read_b128 v[4:7], v76 offset:9728
  s_waitcnt lgkmcnt(0)
  v_smfmac_f32_16x16x64_bf16 v[20:23], v[4:7], v[144:151], v74
  v_smfmac_f32_16x16x64_bf16 v[24:27], v[4:7], v[152:159], v74
  ds_read_b128 v[60:63], v75 offset:20480
  ds_read_b128 v[64:67], v75 offset:21504
  s_waitcnt lgkmcnt(0)
  v_smfmac_f32_16x16x64_bf16 v[28:31], v[4:7], v[60:67], v74
  ds_read_b128 v[60:63], v75 offset:22528
  ds_read_b128 v[64:67], v75 offset:23552
  s_waitcnt lgkmcnt(0)
  v_smfmac_f32_16x16x64_bf16 v[32:35], v[4:7], v[60:67], v74
  ds_read_b128 v[16:19], v76 offset:10752
  s_waitcnt lgkmcnt(0)
  v_smfmac_f32_16x16x64_bf16 v[20:23], v[16:19], v[160:167], v74
  v_smfmac_f32_16x16x64_bf16 v[24:27], v[16:19], v[168:175], v74
  v_smfmac_f32_16x16x64_bf16 v[28:31], v[16:19], v[240:247], v74
  v_smfmac_f32_16x16x64_bf16 v[32:35], v[16:19], v[248:255], v74
  ds_read_b128 v[12:15], v76 offset:11776
  s_waitcnt lgkmcnt(0)
  v_smfmac_f32_16x16x64_bf16 v[20:23], v[12:15], v[176:183], v74
  v_smfmac_f32_16x16x64_bf16 v[24:27], v[12:15], v[184:191], v74
  v_smfmac_f32_16x16x64_bf16 v[28:31], v[12:15], a[0:7], v74
  v_smfmac_f32_16x16x64_bf16 v[32:35], v[12:15], a[8:15], v74
  ds_read_b128 v[8:11], v76 offset:12800
  s_waitcnt lgkmcnt(0)
  v_smfmac_f32_16x16x64_bf16 v[20:23], v[8:11], v[192:199], v74
  v_smfmac_f32_16x16x64_bf16 v[24:27], v[8:11], v[200:207], v74
  v_smfmac_f32_16x16x64_bf16 v[28:31], v[8:11], a[16:23], v74
  v_smfmac_f32_16x16x64_bf16 v[32:35], v[8:11], a[24:31], v74
  v_add_f32 v20, v20, v22
  v_add_f32 v21, v21, v23
  v_add_f32 v24, v24, v26
  v_cvt_pk_bf16_f32 v22, v20, v24
  s_nop 0
  ds_write_b32 v79, v22 offset:0
  v_add_f32 v25, v25, v27
  v_cvt_pk_bf16_f32 v23, v21, v25
  ds_write_b32 v79, v23 offset:576
  v_add_f32 v28, v28, v30
  v_add_f32 v29, v29, v31
  s_waitcnt lgkmcnt(0)
  s_nop 1
  s_branch Cf1_recok
Cf1_mx:
  s_waitcnt lgkmcnt(0)
  s_barrier
  buffer_load_dwordx4 v[0:3], v76, s[8:11], s58 offen offset:0 sc1
  ds_read_b128 v[20:23], v77 offset:0
  ds_read_b128 v[28:31], v77 offset:256
  buffer_load_dwordx4 v[4:7], v76, s[8:11], s58 offen offset:1024 sc1
  ds_read_b128 v[24:27], v77 offset:128
  ds_read_b128 v[32:35], v77 offset:384
  s_waitcnt vmcnt(1) lgkmcnt(3)
  v_mfma_f32_16x16x32_bf16 v[8:11], v[0:3], v[20:23], 0
  s_waitcnt vmcnt(0) lgkmcnt(1)
  v_mfma_f32_16x16x32_bf16 v[8:11], v[4:7], v[24:27], v[8:11]
  v_mfma_f32_16x16x32_bf16 v[12:15], v[28:31], v[20:23], 0
  s_waitcnt lgkmcnt(0)
  v_mfma_f32_16x16x32_bf16 v[12:15], v[32:35], v[24:27], v[12:15]
  v_add_f32_dpp v8, v10, v8 quad_perm:[2,3,0,1] row_mask:0xf bank_mask:0xf
  v_add_f32_dpp v9, v11, v9 quad_perm:[2,3,0,1] row_mask:0xf bank_mask:0xf
  s_nop 0
  v_mov_b32_dpp v8, v8 quad_perm:[0,1,0,1] row_mask:0xf bank_mask:0xf
  v_mov_b32_dpp v9, v9 quad_perm:[0,1,0,1] row_mask:0xf bank_mask:0xf
  s_nop 1
  v_add_f32_dpp v12, v14, v12 quad_perm:[2,3,0,1] row_mask:0xf bank_mask:0xf
  v_add_f32_dpp v13, v15, v13 quad_perm:[2,3,0,1] row_mask:0xf bank_mask:0xf
  s_nop 0
  v_mov_b32_dpp v12, v12 quad_perm:[0,1,0,1] row_mask:0xf bank_mask:0xf
  v_mov_b32_dpp v13, v13 quad_perm:[0,1,0,1] row_mask:0xf bank_mask:0xf
  v_mul_f32 v12, s69, v12
  ds_write_b32 v78, v8 offset:8708
  v_mul_f32 v13, s69, v13
  ds_write_b32 v78, v9 offset:8772
  s_waitcnt lgkmcnt(0)
  s_barrier
  ds_read_b128 v[36:39], v78 offset:8704
  ds_read_b128 v[40:43], v78 offset:8768
  s_waitcnt lgkmcnt(0)
  s_barrier
  v_max_f32 v16, v36, v37
  v_max3_f32 v16, v16, v38, v39
  v_max3_f32 v16, v16, v40, v41
  v_max3_f32 v16, v16, v42, v43
  v_max3_f32 v16, v16, v12, v13
  v_mov_b32 v17, v16
  s_nop 1
  v_permlane16_swap_b32 v16, v17
  v_max_f32 v16, v16, v17
  v_mov_b32 v17, v16
  s_nop 1
  v_permlane32_swap_b32 v16, v17
  v_max_f32 v16, v16, v17
  v_sub_f32 v36, v36, v16
  v_sub_f32 v37, v37, v16
  v_sub_f32 v38, v38, v16
  v_sub_f32 v39, v39, v16
  v_sub_f32 v40, v40, v16
  v_sub_f32 v41, v41, v16
  v_sub_f32 v42, v42, v16
  v_sub_f32 v43, v43, v16
  v_sub_f32 v12, v12, v16
  v_sub_f32 v13, v13, v16
  v_exp_f32 v36, v36
  v_exp_f32 v37, v37
  v_exp_f32 v38, v38
  v_exp_f32 v39, v39
  v_exp_f32 v40, v40
  v_exp_f32 v41, v41
  v_exp_f32 v42, v42
  v_exp_f32 v43, v43
  v_exp_f32 v12, v12
  v_exp_f32 v13, v13
  v_cvt_pk_bf16_f32 v32, v36, v40
  v_cvt_pk_bf16_f32 v33, v37, v41
  v_cvt_pk_bf16_f32 v34, v38, v42
  v_cvt_pk_bf16_f32 v35, v39, v43
  v_cvt_pk_bf16_f32 v28, v12, v13
  v_cvt_pk_bf16_f32 v31, v12, v13
  v_mov_b32 v29, 0
  v_mov_b32 v30, 0
  v_mov_b32 v68, 0x3f803f80
  v_mov_b32 v69, 0x3f803f80
  v_mov_b32 v70, 0x3f803f80
  v_mov_b32 v71, 0x3f803f80
  s_nop 1
  v_mfma_f32_16x16x32_bf16 v[8:11], v[32:35], v[68:71], 0
  v_mfma_f32_16x16x32_bf16 v[0:3], v[32:35], v[52:55], 0
  v_mfma_f32_16x16x32_bf16 v[4:7], v[32:35], v[56:59], 0
  v_mfma_f32_16x16x16_bf16 v[8:11], v[28:29], v[68:69], v[8:11]
  v_mfma_f32_16x16x16_bf16 v[0:3], v[28:29], v[72:73], v[0:3]
  v_mfma_f32_16x16x16_bf16 v[4:7], v[30:31], v[72:73], v[4:7]
  ds_read_b128 v[68:71], v76 offset:13824
  v_rcp_f32 v10, v8
  v_rcp_f32 v11, v9
  v_mul_f32 v0, v10, v0
  v_mul_f32 v1, v11, v1
  s_nop 0
  v_mul_f32 v4, v10, v4
  v_mul_f32 v5, v11, v5
  v_cvt_pk_bf16_f32 v2, v0, v4
  ds_write_b32 v79, v2 offset:8704
  v_cvt_pk_bf16_f32 v3, v1, v5
  ds_write_b32 v79, v3 offset:9280
  v_mov_b64 v[16:17], 0
  v_mov_b64 v[18:19], 0
  v_mov_b64 v[20:21], 0
  v_mov_b64 v[22:23], 0
  v_mov_b64 v[24:25], 0
  v_mov_b64 v[26:27], 0
  s_branch Cf1_mxok
Cf1_last:
  s_waitcnt lgkmcnt(0)
  ds_read_b64 v[16:17], v77 offset:264
  v_mov_b64 v[18:19], v[72:73]
  s_add_u32 s68, s68, 655360
  s_waitcnt lgkmcnt(0)
  buffer_store_dwordx4 v[16:19], v76, s[8:11], s68 offen sc1
  s_branch L_cexit
L_w2:
  v_mov_b64 v[20:21], 0
  v_mov_b64 v[22:23], 0
  v_mov_b64 v[24:25], 0
  v_mov_b64 v[26:27], 0
  v_mov_b64 v[28:29], 0
  v_mov_b64 v[30:31], 0
  v_mov_b64 v[32:33], 0
  v_mov_b64 v[34:35], 0
  s_mov_b32 s78, 0x3f803f80
  s_mov_b32 s79, s78
  s_mov_b32 s65, 360448
  s_mov_b32 m0, 15872
  v_lshlrev_b32 v73, 2, v76
  v_mov_b32 v72, 0
  ds_read_b128 v[60:63], v76 offset:24576
  ds_read_b128 v[64:67], v76 offset:25600
  ds_read_b128 v[44:47], v76 offset:26624
  ds_read_b128 v[48:51], v76 offset:27648
  ds_read_b128 v[36:39], v76 offset:40960
  ds_read_b128 v[40:43], v76 offset:41984
  ds_read_b128 v[0:3], v76 offset:4608
  ds_read_b128 v[4:7], v76 offset:5632
  s_branch Cf2_top2
.p2align 6
Cf2_h2:
  v_lshlrev_b32 v73, 2, v76
  s_mov_b32 m0, 8704
  s_nop 3
  buffer_load_dwordx4 v[52:55], v76, s[8:11], s65 offen offset:3072 sc1
  s_nop 15
  s_nop 1
  buffer_load_dwordx4 v[52:55], v76, s[8:11], s65 offen offset:3072 sc1
  s_nop 15
  s_nop 1
  buffer_load_dwordx4 v[52:55], v76, s[8:11], s65 offen offset:3072 sc1
  s_waitcnt vmcnt(5)
  ds_read_b128 v[60:63], v76 offset:24576
  ds_read_b128 v[64:67], v76 offset:25600
  ds_read_b128 v[44:47], v76 offset:26624
  ds_read_b128 v[48:51], v76 offset:27648
  ds_read_b128 v[36:39], v76 offset:40960
  ds_read_b128 v[40:43], v76 offset:41984
  s_waitcnt vmcnt(2)
  v_max3_u32 v72, v52, v53, v54
  v_max_u32 v72, v72, v55
  ds_write_b128 v76, v[52:55] offset:7680
  v_cmp_eq_u32 vcc, -1, v72
  s_cbranch_vccnz Cf2_h2r
Cf2_h2w:
  s_waitcnt lgkmcnt(0)
  s_barrier
  ds_read_b128 v[0:3], v76 offset:4608
  ds_read_b128 v[4:7], v76 offset:5632
  buffer_load_dwordx4 v76, s[8:11], s64 offen offset:0 sc1 lds
  buffer_load_dwordx4 v76, s[8:11], s64 offen offset:1024 sc1 lds
Cf2_top2:
  ds_read_b128 v[8:11], v76 offset:6656
  s_mov_b32 m0, 15872
  s_waitcnt lgkmcnt(2)
  v_smfmac_f32_16x16x64_bf16 v[20:23], v[0:3], v[60:67], v74
  ds_read_b128 v[60:63], v76 offset:43008
  v_smfmac_f32_16x16x64_bf16 v[24:27], v[0:3], v[44:51], v74
  buffer_load_dwordx4 v[44:47], v76, s[8:11], s58 offen offset:0 sc1
  ds_read_b128 v[64:67], v76 offset:44032
  s_waitcnt lgkmcnt(3)
  v_smfmac_f32_16x16x64_bf16 v[20:23], v[4:7], v[80:87], v74
  buffer_load_dwordx4 v[48:51], v76, s[8:11], s58 offen offset:1024 sc1
  v_smfmac_f32_16x16x64_bf16 v[28:31], v[0:3], v[36:43], v74
  buffer_load_dwordx4 v[52:55], v76, s[8:11], s59 offen offset:0 sc1
  ds_read_b128 v[36:39], v76 offset:57344
  v_smfmac_f32_16x16x64_bf16 v[24:27], v[4:7], v[88:95], v74
  buffer_load_dwordx4 v[56:59], v76, s[8:11], s59 offen offset:1024 sc1
  ds_read_b128 v[40:43], v76 offset:58368
  v_smfmac_f32_16x16x64_bf16 v[28:31], v[4:7], v[208:215], v74
  ds_read_b128 v[12:15], v76 offset:7680
  s_waitcnt lgkmcnt(5)
  v_smfmac_f32_16x16x64_bf16 v[32:35], v[4:7], v[216:223], v74
  buffer_store_dwordx4 v[16:19], v76, s[8:11], s68 offen sc1
  s_waitcnt lgkmcnt(3)
  v_smfmac_f32_16x16x64_bf16 v[32:35], v[0:3], v[60:67], v74
  buffer_load_dword v73, s[8:11], s70 offen  lds
  v_smfmac_f32_16x16x64_bf16 v[20:23], v[8:11], v[96:103], v74
  ds_read_b128 v[60:63], v76 offset:59392
  v_smfmac_f32_16x16x64_bf16 v[24:27], v[8:11], v[104:111], v74
  ds_read_b128 v[64:67], v76 offset:60416
  s_waitcnt lgkmcnt(3)
  v_smfmac_f32_16x16x64_bf16 v[28:31], v[8:11], v[36:43], v74
  ds_read_b128 v[36:39], v75 offset:8192
  s_waitcnt lgkmcnt(3)
  v_smfmac_f32_16x16x64_bf16 v[20:23], v[12:15], v[112:119], v74
  s_waitcnt vmcnt(6)
  ds_read_b128 v[40:43], v75 offset:9216
  v_smfmac_f32_16x16x64_bf16 v[24:27], v[12:15], v[120:127], v74
  s_barrier
  ds_read_b128 v[0:3], v76 offset:8704
  v_smfmac_f32_16x16x64_bf16 v[28:31], v[12:15], v[224:231], v74
  ds_read_b128 v[4:7], v76 offset:9728
  v_smfmac_f32_16x16x64_bf16 v[32:35], v[12:15], v[232:239], v74
  s_waitcnt lgkmcnt(4)
  v_smfmac_f32_16x16x64_bf16 v[32:35], v[8:11], v[60:67], v74
  ds_read_b128 v[60:63], v75 offset:10240
  s_waitcnt lgkmcnt(2)
  v_smfmac_f32_16x16x64_bf16 v[20:23], v[0:3], v[128:135], v74
  ds_read_b128 v[16:19], v76 offset:10752
  v_smfmac_f32_16x16x64_bf16 v[24:27], v[0:3], v[136:143], v74
  ds_read_b128 v[64:67], v75 offset:11264
  v_smfmac_f32_16x16x64_bf16 v[28:31], v[0:3], v[36:43], v74
  ds_read_b128 v[36:39], v75 offset:24576
  s_waitcnt lgkmcnt(4)
  v_smfmac_f32_16x16x64_bf16 v[20:23], v[4:7], v[144:151], v74
  ds_read_b128 v[12:15], v76 offset:11776
  v_smfmac_f32_16x16x64_bf16 v[24:27], v[4:7], v[152:159], v74
  ds_read_b128 v[40:43], v75 offset:25600
  s_waitcnt lgkmcnt(4)
  v_smfmac_f32_16x16x64_bf16 v[20:23], v[16:19], v[160:167], v74
  ds_read_b128 v[8:11], v76 offset:12800
  s_waitcnt lgkmcnt(4)
  v_smfmac_f32_16x16x64_bf16 v[32:35], v[0:3], v[60:67], v74
  ds_read_b128 v[60:63], v75 offset:26624
  v_mov_b64 v[68:69], s[78:79]
  v_smfmac_f32_16x16x64_bf16 v[24:27], v[16:19], v[168:175], v74
  ds_read_b128 v[64:67], v75 offset:27648
  s_waitcnt lgkmcnt(4)
  v_smfmac_f32_16x16x64_bf16 v[20:23], v[12:15], v[176:183], v74
  s_waitcnt lgkmcnt(3)
  v_mov_b64 v[70:71], s[78:79]
  v_smfmac_f32_16x16x64_bf16 v[28:31], v[4:7], v[36:43], v74
  s_waitcnt lgkmcnt(2)
  v_mov_b64 v[36:37], 0
  v_smfmac_f32_16x16x64_bf16 v[20:23], v[8:11], v[192:199], v74
  v_mov_b64 v[38:39], 0
  v_smfmac_f32_16x16x64_bf16 v[24:27], v[12:15], v[184:191], v74
  v_mov_b64 v[40:41], 0
  v_smfmac_f32_16x16x64_bf16 v[24:27], v[8:11], v[200:207], v74
  s_waitcnt lgkmcnt(0)
  v_add_f32 v20, v20, v22
  v_smfmac_f32_16x16x64_bf16 v[32:35], v[4:7], v[60:67], v74
  v_add_f32 v21, v21, v23
  v_smfmac_f32_16x16x64_bf16 v[28:31], v[16:19], v[240:247], v74
  v_add_f32 v24, v24, v26
  v_cvt_pk_bf16_f32 v22, v20, v24
  v_smfmac_f32_16x16x64_bf16 v[28:31], v[12:15], a[0:7], v74
  ds_write_b32 v79, v22 offset:0
  v_add_f32 v25, v25, v27
  v_cvt_pk_bf16_f32 v23, v21, v25
  v_smfmac_f32_16x16x64_bf16 v[28:31], v[8:11], a[16:23], v74
  ds_write_b32 v79, v23 offset:576
  v_cmp_u_f32 vcc, v20, v21
  v_smfmac_f32_16x16x64_bf16 v[32:35], v[16:19], v[248:255], v74
  v_mov_b64 v[42:43], 0
  v_smfmac_f32_16x16x64_bf16 v[32:35], v[12:15], a[8:15], v74
  v_add_f32 v28, v28, v30
  v_add_f32 v29, v29, v31
  v_smfmac_f32_16x16x64_bf16 v[32:35], v[8:11], a[24:31], v74
  s_cbranch_vccnz Cf2_rec
Cf2_recok:
  v_smfmac_f32_16x16x64_bf16 v[36:39], v[16:19], a[128:135], v74
  s_waitcnt lgkmcnt(0)
  s_barrier
  ds_read_b128 v[60:63], v77
  v_smfmac_f32_16x16x64_bf16 v[40:43], v[16:19], a[136:143], v74
  ds_read_b128 v[64:67], v77 offset:128
  v_add_f32 v32, v32, v34
  v_cvt_pk_bf16_f32 v30, v28, v32
  v_smfmac_f32_16x16x64_bf16 v[36:39], v[0:3], a[96:103], v74
  ds_write_b32 v79, v30 offset:256
  v_add_f32 v33, v33, v35
  v_cvt_pk_bf16_f32 v31, v29, v33
  v_smfmac_f32_16x16x64_bf16 v[40:43], v[0:3], a[104:111], v74
  ds_write_b32 v79, v31 offset:832
  v_xor_b32 v75, 0x8000, v75
  v_smfmac_f32_16x16x64_bf16 v[36:39], v[4:7], a[112:119], v74
  ds_read_b128 v[0:3], v76 offset:4608
  v_mov_b32 v29, 0
  v_smfmac_f32_16x16x64_bf16 v[40:43], v[4:7], a[120:127], v74
  s_waitcnt vmcnt(4) lgkmcnt(3)
  v_mov_b32 v30, 0
  v_mfma_f32_16x16x32_bf16 v[44:47], v[44:47], v[60:63], 0
  ds_read_b128 v[4:7], v76 offset:5632
  s_waitcnt lgkmcnt(2)
  v_mfma_f32_16x16x32_bf16 v[44:47], v[48:51], v[64:67], v[44:47]
  s_barrier
  v_smfmac_f32_16x16x64_bf16 v[36:39], v[8:11], a[160:167], v74
  ds_read_b128 v[20:23], v77 offset:256
  ds_read_b128 v[24:27], v77 offset:384
  v_smfmac_f32_16x16x64_bf16 v[40:43], v[8:11], a[168:175], v74
  ds_read_b128 v[8:11], v76 offset:6656
  v_add_f32_dpp v72, v46, v44 quad_perm:[2,3,0,1] row_mask:0xf bank_mask:0xf
  v_add_f32_dpp v73, v47, v45 quad_perm:[2,3,0,1] row_mask:0xf bank_mask:0xf
  v_smfmac_f32_16x16x64_bf16 v[36:39], v[12:15], a[144:151], v74
  s_waitcnt lgkmcnt(4)
  v_exp_f32_dpp v72, v72 quad_perm:[0,1,0,1] row_mask:0xf bank_mask:0xf
  v_smfmac_f32_16x16x64_bf16 v[40:43], v[12:15], a[152:159], v74
  ds_read_b128 v[12:15], v76 offset:7680
  v_exp_f32_dpp v73, v73 quad_perm:[0,1,0,1] row_mask:0xf bank_mask:0xf
  v_smfmac_f32_16x16x64_bf16 v[36:39], v[0:3], a[32:39], v74
  s_waitcnt lgkmcnt(2)
  v_cvt_pk_bf16_f32 v72, v72, v73
  v_mfma_f32_16x16x32_bf16 v[20:23], v[20:23], v[60:63], 0
  ds_write_b32 v78, v72 offset:520
  v_mov_b64 v[16:17], 0
  v_mfma_f32_16x16x32_bf16 v[20:23], v[24:27], v[64:67], v[20:23]
  ds_read_b128 v[44:47], v75 offset:24576
  v_mov_b64 v[18:19], 0
  v_smfmac_f32_16x16x64_bf16 v[40:43], v[0:3], a[40:47], v74
  ds_read_b128 v[48:51], v75 offset:25600
  s_waitcnt lgkmcnt(4)
  v_smfmac_f32_16x16x64_bf16 v[36:39], v[4:7], a[48:55], v74
  v_add_f32_dpp v24, v22, v20 quad_perm:[2,3,0,1] row_mask:0xf bank_mask:0xf
  v_add_f32_dpp v25, v23, v21 quad_perm:[2,3,0,1] row_mask:0xf bank_mask:0xf
  v_smfmac_f32_16x16x64_bf16 v[36:39], v[8:11], a[64:71], v74
  s_waitcnt lgkmcnt(2)
  s_barrier
  ds_read_b128 v[32:35], v78 offset:512
  v_smfmac_f32_16x16x64_bf16 v[36:39], v[12:15], a[80:87], v74
  ds_read_b128 v[60:63], v75 offset:26624
  v_mul_f32 v24, s69, v24
  v_smfmac_f32_16x16x64_bf16 v[40:43], v[4:7], a[56:63], v74
  ds_read_b128 v[64:67], v75 offset:27648
  v_mul_f32 v25, s69, v25
  v_smfmac_f32_16x16x64_bf16 v[40:43], v[8:11], a[72:79], v74
  v_exp_f32_dpp v24, v24 quad_perm:[0,1,0,1] row_mask:0xf bank_mask:0xf
  v_smfmac_f32_16x16x64_bf16 v[40:43], v[12:15], a[88:95], v74
  s_waitcnt vmcnt(2) lgkmcnt(2)
  v_exp_f32_dpp v25, v25 quad_perm:[0,1,0,1] row_mask:0xf bank_mask:0xf
  v_mfma_f32_16x16x32_bf16 v[8:11], v[32:35], v[68:71], 0
  v_add_f32 v36, v36, v38
  v_add_f32 v37, v37, v39
  v_mfma_f32_16x16x32_bf16 v[0:3], v[32:35], v[52:55], 0
  v_add_f32 v40, v40, v42
  v_add_f32 v41, v41, v43
  v_mfma_f32_16x16x32_bf16 v[4:7], v[32:35], v[56:59], 0
  v_cvt_pk_bf16_f32 v28, v24, v25
  v_cvt_pk_bf16_f32 v72, v36, v37
  v_cvt_pk_bf16_f32 v73, v40, v41
  v_mfma_f32_16x16x16_bf16 v[8:11], v[28:29], v[68:69], v[8:11]
  v_cvt_pk_bf16_f32 v31, v24, v25
  v_mov_b64 v[20:21], 0
  v_mfma_f32_16x16x16_bf16 v[0:3], v[28:29], v[72:73], v[0:3]
  ds_read_b128 v[68:71], v76 offset:13824
  v_mov_b64 v[22:23], 0
  v_mfma_f32_16x16x16_bf16 v[4:7], v[30:31], v[72:73], v[4:7]
  v_rcp_f32 v10, v8
  v_rcp_f32 v11, v9
  v_mul_f32 v0, v10, v0
  v_mul_f32 v1, v11, v1
  s_nop 0
  v_mul_f32 v4, v10, v4
  v_mul_f32 v5, v11, v5
  v_cvt_pk_bf16_f32 v2, v0, v4
  ds_write_b32 v79, v2 offset:8704
  v_cvt_pk_bf16_f32 v3, v1, v5
  ds_write_b32 v79, v3 offset:9280
  v_max3_f32 v8, v8, v9, v10
  v_max_f32 v8, v8, v11
  v_cmp_le_f32 vcc, 1317011456, v8
  v_mov_b64 v[24:25], 0
  v_mov_b64 v[26:27], 0
  s_cbranch_vccnz Cf2_mx
Cf2_mxok:
  s_waitcnt lgkmcnt(0)
  s_barrier
  ds_read_b128 v[0:3], v78 offset:8704
  ds_read_b128 v[4:7], v78 offset:8768
  ds_read_b128 v[8:11], v78 offset:8832
  ds_read_b128 v[12:15], v78 offset:8896
  s_cmp_eq_u32 s66, 63
  s_cbranch_scc1 Cf2_last
  s_waitcnt lgkmcnt(3)
  v_smfmac_f32_16x16x64_bf16 v[16:19], v[0:3], v[44:51], v74
  ds_read_b128 v[52:55], v75 offset:40960
  s_waitcnt lgkmcnt(3)
  v_smfmac_f32_16x16x64_bf16 v[16:19], v[4:7], v[60:67], v74
  ds_read_b128 v[56:59], v75 offset:41984
  s_waitcnt lgkmcnt(3)
  v_smfmac_f32_16x16x64_bf16 v[16:19], v[8:11], a[176:183], v74
  ds_read_b128 v[36:39], v75 offset:43008
  s_waitcnt lgkmcnt(3)
  v_smfmac_f32_16x16x64_bf16 v[16:19], v[12:15], a[184:191], v74
  ds_read_b128 v[40:43], v75 offset:44032
  ds_read_b128 v[44:47], v75 offset:57344
  v_smfmac_f32_16x16x64_bf16 v[20:23], v[0:3], a[192:199], v74
  ds_read_b128 v[48:51], v75 offset:58368
  ds_read_b128 v[60:63], v75 offset:59392
  v_smfmac_f32_16x16x64_bf16 v[20:23], v[4:7], a[200:207], v74
  ds_read_b128 v[64:67], v75 offset:60416
  s_waitcnt lgkmcnt(6)
  v_cvt_pk_bf16_f32 v16, v16, v17
  v_cvt_pk_bf16_f32 v17, v18, v19
  v_bfi_b32 v16, 1, s72, v16
  v_smfmac_f32_16x16x64_bf16 v[20:23], v[8:11], v[52:59], v74
  buffer_store_dwordx2 v[16:17], v68, s[8:11], s73 offen
  s_waitcnt lgkmcnt(4)
  v_smfmac_f32_16x16x64_bf16 v[20:23], v[12:15], v[36:43], v74
  ds_read_b128 v[52:55], v75 offset:0
  v_mov_b64 v[32:33], 0
  v_smfmac_f32_16x16x64_bf16 v[24:27], v[0:3], a[208:215], v74
  ds_read_b128 v[56:59], v75 offset:1024
  v_mov_b64 v[34:35], 0
  v_smfmac_f32_16x16x64_bf16 v[24:27], v[4:7], a[216:223], v74
  ds_read_b128 v[36:39], v75 offset:2048
  s_waitcnt lgkmcnt(5)
  v_cvt_pk_bf16_f32 v20, v20, v21
  v_cvt_pk_bf16_f32 v21, v22, v23
  v_bfi_b32 v20, 1, s72, v20
  v_smfmac_f32_16x16x64_bf16 v[24:27], v[8:11], v[44:51], v74
  buffer_store_dwordx2 v[20:21], v68, s[8:11], s74 offen
  s_waitcnt lgkmcnt(3)
  v_smfmac_f32_16x16x64_bf16 v[24:27], v[12:15], v[60:67], v74
  ds_read_b128 v[40:43], v75 offset:3072
  v_mov_b64 v[28:29], 0
  v_smfmac_f32_16x16x64_bf16 v[32:35], v[0:3], a[224:231], v74
  ds_read_b128 v[44:47], v75 offset:4096
  ds_read_b128 v[48:51], v75 offset:5120
  v_smfmac_f32_16x16x64_bf16 v[32:35], v[4:7], a[232:239], v74
  ds_read_b128 v[60:63], v75 offset:6144
  v_cvt_pk_bf16_f32 v24, v24, v25
  v_cvt_pk_bf16_f32 v25, v26, v27
  v_bfi_b32 v24, 1, s72, v24
  v_smfmac_f32_16x16x64_bf16 v[32:35], v[8:11], a[240:247], v74
  buffer_store_dwordx2 v[24:25], v68, s[8:11], s75 offen
  v_mov_b64 v[30:31], 0
  v_smfmac_f32_16x16x64_bf16 v[32:35], v[12:15], a[248:255], v74
  ds_read_b128 v[64:67], v75 offset:7168
  s_waitcnt lgkmcnt(6)
  v_smfmac_f32_16x16x64_bf16 v[28:31], v[0:3], v[52:59], v74
  s_waitcnt lgkmcnt(4)
  v_smfmac_f32_16x16x64_bf16 v[28:31], v[4:7], v[36:43], v74
  s_waitcnt lgkmcnt(2)
  v_cvt_pk_bf16_f32 v32, v32, v33
  v_cvt_pk_bf16_f32 v33, v34, v35
  v_bfi_b32 v32, 1, s72, v32
  v_smfmac_f32_16x16x64_bf16 v[28:31], v[8:11], v[44:51], v74
  buffer_store_dwordx2 v[32:33], v68, s[8:11], s76 offen
  s_waitcnt lgkmcnt(0)
  v_smfmac_f32_16x16x64_bf16 v[28:31], v[12:15], v[60:67], v74
  ds_read_b128 v[0:3], v76 offset:14848
  ds_read_b64 v[16:17], v77 offset:384
  v_mov_b64 v[18:19], v[72:73]
  v_xor_b32 v75, 0x8000, v75
  s_nop 3
  v_cvt_pk_bf16_f32 v28, v28, v29
  v_cvt_pk_bf16_f32 v29, v30, v31
  v_bfi_b32 v28, 1, s72, v28
  buffer_store_dwordx2 v[28:29], v68, s[8:11], s77 offen
  v_mov_b64 v[20:21], 0
  v_mov_b64 v[22:23], 0
  v_mov_b64 v[24:25], 0
  v_mov_b64 v[26:27], 0
  v_mov_b64 v[28:29], 0
  v_mov_b64 v[30:31], 0
  v_mov_b64 v[32:33], 0
  v_mov_b64 v[34:35], 0
  s_add_u32 s58, s58, 655360
  s_add_u32 s59, s59, 655360
  s_add_u32 s70, s70, 655360
  s_add_u32 s68, s68, 655360
  s_add_u32 s66, s66, 1
  s_xor_b32 s64, s64, 16384
  s_xor_b32 s65, s65, 16384
  s_nop 15
  s_nop 15
  s_nop 7
  buffer_load_dwordx4 v[52:55], v76, s[8:11], s60 offen offset:0 sc1
  buffer_load_dwordx4 v[56:59], v76, s[8:11], s60 offen offset:1024 sc1
  s_nop 15
  s_nop 11
  buffer_load_dwordx4 v[36:39], v76, s[8:11], s60 offen offset:0 sc1
  buffer_load_dwordx4 v[40:43], v76, s[8:11], s60 offen offset:1024 sc1
  s_waitcnt lgkmcnt(0)
  s_waitcnt vmcnt(3)
  v_mfma_f32_16x16x32_bf16 v[4:7], v[0:3], v[52:55], 0
  v_bitop3_b32 v72, v52, v54, s72 bitop3:0x7e
  s_waitcnt vmcnt(2)
  v_mfma_f32_16x16x32_bf16 v[4:7], v[0:3], v[56:59], v[4:7]
  v_bitop3_b32 v73, v56, v58, s72 bitop3:0x7e
  v_bitop3_b32 v72, v72, v73, 1 bitop3:0xa8
  v_cmp_ne_u32 vcc, 0, v72
  s_nop 0
  s_cmp_eq_u64 vcc, 0
  s_cselect_b32 s54, s62, 268435456
  s_nop 0
  v_add_f32_dpp v4, v4, v4 row_ror:4 row_mask:0xf bank_mask:0xf
  v_add_f32_dpp v5, v5, v5 row_ror:4 row_mask:0xf bank_mask:0xf
  s_nop 0
  v_add_f32_dpp v4, v4, v4 row_ror:8 row_mask:0xf bank_mask:0xf
  v_add_f32_dpp v5, v5, v5 row_ror:8 row_mask:0xf bank_mask:0xf
  v_cvt_pk_bf16_f32 v4, v4, v5
  buffer_store_dword v4, v69, s[8:11], s54 offen
  s_cbranch_vccnz Cf2_h1r
  s_xor_b32 s62, s62, 16384
  buffer_store_dword v71, v69, s[8:11], s62 offen
  s_xor_b32 s72, s72, 1
  s_branch Cf2_h2
Cf2_h1r:
  s_mov_b64 exec, vcc
  buffer_load_dwordx4 v[52:55], v76, s[8:11], s60 offen offset:0 sc1
  buffer_load_dwordx4 v[56:59], v76, s[8:11], s60 offen offset:1024 sc1
  s_mov_b64 exec, -1
  s_add_u32 s67, s67, 1
  s_waitcnt vmcnt(4)
  v_mfma_f32_16x16x32_bf16 v[4:7], v[0:3], v[36:39], 0
  v_bitop3_b32 v72, v36, v38, s72 bitop3:0x7e
  s_waitcnt vmcnt(3)
  v_mfma_f32_16x16x32_bf16 v[4:7], v[0:3], v[40:43], v[4:7]
  v_bitop3_b32 v73, v40, v42, s72 bitop3:0x7e
  v_bitop3_b32 v72, v72, v73, 1 bitop3:0xa8
  v_cmp_ne_u32 vcc, 0, v72
  s_cbranch_vccz Cf2_h1p
  s_mov_b64 exec, vcc
  buffer_load_dwordx4 v[36:39], v76, s[8:11], s60 offen offset:0 sc1
  buffer_load_dwordx4 v[40:43], v76, s[8:11], s60 offen offset:1024 sc1
  s_mov_b64 exec, -1
  s_add_u32 s67, s67, 1
  s_waitcnt vmcnt(3)
  v_mfma_f32_16x16x32_bf16 v[4:7], v[0:3], v[52:55], 0
  v_bitop3_b32 v72, v52, v54, s72 bitop3:0x7e
  s_waitcnt vmcnt(2)
  v_mfma_f32_16x16x32_bf16 v[4:7], v[0:3], v[56:59], v[4:7]
  v_bitop3_b32 v73, v56, v58, s72 bitop3:0x7e
  v_bitop3_b32 v72, v72, v73, 1 bitop3:0xa8
  v_cmp_ne_u32 vcc, 0, v72
  s_cbranch_vccz Cf2_h1p
Cf2_h1s:
  s_mov_b64 exec, vcc
  buffer_load_dwordx4 v[52:55], v76, s[8:11], s60 offen offset:0 sc1
  buffer_load_dwordx4 v[56:59], v76, s[8:11], s60 offen offset:1024 sc1
  s_mov_b64 exec, -1
  s_add_u32 s67, s67, 1
  s_waitcnt vmcnt(3)
  v_mfma_f32_16x16x32_bf16 v[4:7], v[0:3], v[36:39], 0
  v_bitop3_b32 v72, v36, v38, s72 bitop3:0x7e
  s_waitcnt vmcnt(2)
  v_mfma_f32_16x16x32_bf16 v[4:7], v[0:3], v[40:43], v[4:7]
  v_bitop3_b32 v73, v40, v42, s72 bitop3:0x7e
  v_bitop3_b32 v72, v72, v73, 1 bitop3:0xa8
  v_cmp_ne_u32 vcc, 0, v72
  s_cbranch_vccz Cf2_h1p
  s_mov_b64 exec, vcc
  buffer_load_dwordx4 v[36:39], v76, s[8:11], s60 offen offset:0 sc1
  buffer_load_dwordx4 v[40:43], v76, s[8:11], s60 offen offset:1024 sc1
  s_mov_b64 exec, -1
  s_add_u32 s67, s67, 1
  s_waitcnt vmcnt(3)
  v_mfma_f32_16x16x32_bf16 v[4:7], v[0:3], v[52:55], 0
  v_bitop3_b32 v72, v52, v54, s72 bitop3:0x7e
  s_waitcnt vmcnt(2)
  v_mfma_f32_16x16x32_bf16 v[4:7], v[0:3], v[56:59], v[4:7]
  v_bitop3_b32 v73, v56, v58, s72 bitop3:0x7e
  v_bitop3_b32 v72, v72, v73, 1 bitop3:0xa8
  v_cmp_ne_u32 vcc, 0, v72
  s_cbranch_vccz Cf2_h1p
  s_cmp_lt_u32 s67, 131072
  s_cbranch_scc1 Cf2_h1s
Cf2_h1p:
  s_nop 2
  v_add_f32_dpp v4, v4, v4 row_ror:4 row_mask:0xf bank_mask:0xf
  v_add_f32_dpp v5, v5, v5 row_ror:4 row_mask:0xf bank_mask:0xf
  s_nop 0
  v_add_f32_dpp v4, v4, v4 row_ror:8 row_mask:0xf bank_mask:0xf
  v_add_f32_dpp v5, v5, v5 row_ror:8 row_mask:0xf bank_mask:0xf
  v_cvt_pk_bf16_f32 v4, v4, v5
  buffer_store_dword v4, v69, s[8:11], s62 offen
  s_xor_b32 s62, s62, 16384
  buffer_store_dword v71, v69, s[8:11], s62 offen
  s_xor_b32 s72, s72, 1
  s_branch Cf2_h2
Cf2_h2r:
  s_mov_b64 exec, vcc
  buffer_load_dwordx4 v[52:55], v76, s[8:11], s65 offen offset:3072 sc1
  s_mov_b64 exec, -1
  s_add_u32 s67, s67, 1
  s_waitcnt vmcnt(2)
  v_max3_u32 v72, v52, v53, v54
  v_max_u32 v72, v72, v55
  ds_write_b128 v76, v[52:55] offset:7680
  v_cmp_eq_u32 vcc, -1, v72
  s_cbranch_vccz Cf2_h2w
  s_mov_b64 exec, vcc
  buffer_load_dwordx4 v[52:55], v76, s[8:11], s65 offen offset:3072 sc1
  s_mov_b64 exec, -1
  s_add_u32 s67, s67, 1
  s_waitcnt vmcnt(2)
  v_max3_u32 v72, v52, v53, v54
  v_max_u32 v72, v72, v55
  ds_write_b128 v76, v[52:55] offset:7680
  v_cmp_eq_u32 vcc, -1, v72
  s_cbranch_vccz Cf2_h2w
  s_mov_b64 exec, vcc
  buffer_load_dwordx4 v[52:55], v76, s[8:11], s65 offen offset:3072 sc1
  s_mov_b64 exec, -1
  s_add_u32 s67, s67, 1
  s_waitcnt vmcnt(2)
  v_max3_u32 v72, v52, v53, v54
  v_max_u32 v72, v72, v55
  ds_write_b128 v76, v[52:55] offset:7680
  v_cmp_eq_u32 vcc, -1, v72
  s_cbranch_vccz Cf2_h2w
  s_mov_b64 exec, vcc
  buffer_load_dwordx4 v[52:55], v76, s[8:11], s65 offen offset:3072 sc1
  s_mov_b64 exec, -1
  s_add_u32 s67, s67, 1
  s_waitcnt vmcnt(2)
  v_max3_u32 v72, v52, v53, v54
  v_max_u32 v72, v72, v55
  ds_write_b128 v76, v[52:55] offset:7680
  v_cmp_eq_u32 vcc, -1, v72
  s_cbranch_vccz Cf2_h2w
  s_cmp_lt_u32 s67, 131072
  s_cbranch_scc1 Cf2_h2r
Cf2_h2ok:
  ds_write_b128 v76, v[52:55] offset:7680
  s_branch Cf2_h2w
Cf2_rec:
  s_nop 7
  s_waitcnt vmcnt(0) lgkmcnt(0)
  v_max3_u32 v72, v0, v1, v2
  v_max3_u32 v72, v72, v3, v4
  v_max3_u32 v72, v72, v5, v6
  v_max3_u32 v72, v72, v7, v8
  v_max3_u32 v72, v72, v9, v10
  v_max3_u32 v72, v72, v11, v12
  v_max3_u32 v72, v72, v13, v14
  v_max3_u32 v72, v72, v15, v16
  v_max3_u32 v72, v72, v17, v18
  v_max_u32 v72, v72, v19
  v_cmp_eq_u32 vcc, -1, v72
  s_cbranch_vccz Cf2_recok
  s_barrier
Cf2_recp:
  buffer_load_dwordx4 v[0:3], v76, s[8:11], s64 offen offset:0 sc1
  buffer_load_dwordx4 v[4:7], v76, s[8:11], s64 offen offset:1024 sc1
  s_add_u32 s67, s67, 1
  s_cmp_lt_u32 s67, 131072
  s_cselect_b32 s54, -2, -1
  s_waitcnt vmcnt(1)
  v_max3_u32 v72, v0, v1, v2
  s_waitcnt vmcnt(0)
  v_max3_u32 v72, v72, v3, v4
  v_max3_u32 v72, v72, v5, v6
  v_max_u32 v72, v72, v7
  v_cmp_lt_u32 vcc, s54, v72
  s_cbranch_vccnz Cf2_recp
  ds_write_b128 v76, v[0:3] offset:8704
  ds_write_b128 v76, v[4:7] offset:9728
  v_mov_b64 v[20:21], 0
  v_mov_b64 v[22:23], 0
  v_mov_b64 v[24:25], 0
  v_mov_b64 v[26:27], 0
  v_mov_b64 v[28:29], 0
  v_mov_b64 v[30:31], 0
  v_mov_b64 v[32:33], 0
  v_mov_b64 v[34:35], 0
  s_waitcnt lgkmcnt(0)
  s_barrier
  ds_read_b128 v[0:3], v76 offset:4608
  ds_read_b128 v[60:63], v76 offset:24576
  ds_read_b128 v[64:67], v76 offset:25600
  s_waitcnt lgkmcnt(0)
  v_smfmac_f32_16x16x64_bf16 v[20:23], v[0:3], v[60:67], v74
  ds_read_b128 v[60:63], v76 offset:26624
  ds_read_b128 v[64:67], v76 offset:27648
  s_waitcnt lgkmcnt(0)
  v_smfmac_f32_16x16x64_bf16 v[24:27], v[0:3], v[60:67], v74
  ds_read_b128 v[60:63], v76 offset:40960
  ds_read_b128 v[64:67], v76 offset:41984
  s_waitcnt lgkmcnt(0)
  v_smfmac_f32_16x16x64_bf16 v[28:31], v[0:3], v[60:67], v74
  ds_read_b128 v[60:63], v76 offset:43008
  ds_read_b128 v[64:67], v76 offset:44032
  s_waitcnt lgkmcnt(0)
  v_smfmac_f32_16x16x64_bf16 v[32:35], v[0:3], v[60:67], v74
  ds_read_b128 v[4:7], v76 offset:5632
  s_waitcnt lgkmcnt(0)
  v_smfmac_f32_16x16x64_bf16 v[20:23], v[4:7], v[80:87], v74
  v_smfmac_f32_16x16x64_bf16 v[24:27], v[4:7], v[88:95], v74
  v_smfmac_f32_16x16x64_bf16 v[28:31], v[4:7], v[208:215], v74
  v_smfmac_f32_16x16x64_bf16 v[32:35], v[4:7], v[216:223], v74
  ds_read_b128 v[8:11], v76 offset:6656
  s_waitcnt lgkmcnt(0)
  v_smfmac_f32_16x16x64_bf16 v[20:23], v[8:11], v[96:103], v74
  v_smfmac_f32_16x16x64_bf16 v[24:27], v[8:11], v[104:111], v74
  ds_read_b128 v[60:63], v76 offset:57344
  ds_read_b128 v[64:67], v76 offset:58368
  s_waitcnt lgkmcnt(0)
  v_smfmac_f32_16x16x64_bf16 v[28:31], v[8:11], v[60:67], v74
  ds_read_b128 v[60:63], v76 offset:59392
  ds_read_b128 v[64:67], v76 offset:60416
  s_waitcnt lgkmcnt(0)
  v_smfmac_f32_16x16x64_bf16 v[32:35], v[8:11], v[60:67], v74
  ds_read_b128 v[12:15], v76 offset:7680
  s_waitcnt lgkmcnt(0)
  v_smfmac_f32_16x16x64_bf16 v[20:23], v[12:15], v[112:119], v74
  v_smfmac_f32_16x16x64_bf16 v[24:27], v[12:15], v[120:127], v74
  v_smfmac_f32_16x16x64_bf16 v[28:31], v[12:15], v[224:231], v74
  v_smfmac_f32_16x16x64_bf16 v[32:35], v[12:15], v[232:239], v74
  ds_read_b128 v[0:3], v76 offset:8704
  s_waitcnt lgkmcnt(0)
  v_smfmac_f32_16x16x64_bf16 v[20:23], v[0:3], v[128:135], v74
  v_smfmac_f32_16x16x64_bf16 v[24:27], v[0:3], v[136:143], v74
  ds_read_b128 v[60:63], v75 offset:8192
  ds_read_b128 v[64:67], v75 offset:9216
  s_waitcnt lgkmcnt(0)
  v_smfmac_f32_16x16x64_bf16 v[28:31], v[0:3], v[60:67], v74
  ds_read_b128 v[60:63], v75 offset:10240
  ds_read_b128 v[64:67], v75 offset:11264
  s_waitcnt lgkmcnt(0)
  v_smfmac_f32_16x16x64_bf16 v[32:35], v[0:3], v[60:67], v74
  ds_read_b128 v[4:7], v76 offset:9728
  s_waitcnt lgkmcnt(0)
  v_smfmac_f32_16x16x64_bf16 v[20:23], v[4:7], v[144:151], v74
  v_smfmac_f32_16x16x64_bf16 v[24:27], v[4:7], v[152:159], v74
  ds_read_b128 v[60:63], v75 offset:24576
  ds_read_b128 v[64:67], v75 offset:25600
  s_waitcnt lgkmcnt(0)
  v_smfmac_f32_16x16x64_bf16 v[28:31], v[4:7], v[60:67], v74
  ds_read_b128 v[60:63], v75 offset:26624
  ds_read_b128 v[64:67], v75 offset:27648
  s_waitcnt lgkmcnt(0)
  v_smfmac_f32_16x16x64_bf16 v[32:35], v[4:7], v[60:67], v74
  ds_read_b128 v[16:19], v76 offset:10752
  s_waitcnt lgkmcnt(0)
  v_smfmac_f32_16x16x64_bf16 v[20:23], v[16:19], v[160:167], v74
  v_smfmac_f32_16x16x64_bf16 v[24:27], v[16:19], v[168:175], v74
  v_smfmac_f32_16x16x64_bf16 v[28:31], v[16:19], v[240:247], v74
  v_smfmac_f32_16x16x64_bf16 v[32:35], v[16:19], v[248:255], v74
  ds_read_b128 v[12:15], v76 offset:11776
  s_waitcnt lgkmcnt(0)
  v_smfmac_f32_16x16x64_bf16 v[20:23], v[12:15], v[176:183], v74
  v_smfmac_f32_16x16x64_bf16 v[24:27], v[12:15], v[184:191], v74
  v_smfmac_f32_16x16x64_bf16 v[28:31], v[12:15], a[0:7], v74
  v_smfmac_f32_16x16x64_bf16 v[32:35], v[12:15], a[8:15], v74
  ds_read_b128 v[8:11], v76 offset:12800
  s_waitcnt lgkmcnt(0)
  v_smfmac_f32_16x16x64_bf16 v[20:23], v[8:11], v[192:199], v74
  v_smfmac_f32_16x16x64_bf16 v[24:27], v[8:11], v[200:207], v74
  v_smfmac_f32_16x16x64_bf16 v[28:31], v[8:11], a[16:23], v74
  v_smfmac_f32_16x16x64_bf16 v[32:35], v[8:11], a[24:31], v74
  v_add_f32 v20, v20, v22
  v_add_f32 v21, v21, v23
  v_add_f32 v24, v24, v26
  v_cvt_pk_bf16_f32 v22, v20, v24
  s_nop 0
  ds_write_b32 v79, v22 offset:0
  v_add_f32 v25, v25, v27
  v_cvt_pk_bf16_f32 v23, v21, v25
  ds_write_b32 v79, v23 offset:576
  v_add_f32 v28, v28, v30
  v_add_f32 v29, v29, v31
  s_waitcnt lgkmcnt(0)
  s_nop 1
  s_branch Cf2_recok
Cf2_mx:
  s_waitcnt lgkmcnt(0)
  s_barrier
  buffer_load_dwordx4 v[0:3], v76, s[8:11], s58 offen offset:0 sc1
  ds_read_b128 v[20:23], v77 offset:0
  ds_read_b128 v[28:31], v77 offset:256
  buffer_load_dwordx4 v[4:7], v76, s[8:11], s58 offen offset:1024 sc1
  ds_read_b128 v[24:27], v77 offset:128
  ds_read_b128 v[32:35], v77 offset:384
  s_waitcnt vmcnt(1) lgkmcnt(3)
  v_mfma_f32_16x16x32_bf16 v[8:11], v[0:3], v[20:23], 0
  s_waitcnt vmcnt(0) lgkmcnt(1)
  v_mfma_f32_16x16x32_bf16 v[8:11], v[4:7], v[24:27], v[8:11]
  v_mfma_f32_16x16x32_bf16 v[12:15], v[28:31], v[20:23], 0
  s_waitcnt lgkmcnt(0)
  v_mfma_f32_16x16x32_bf16 v[12:15], v[32:35], v[24:27], v[12:15]
  v_add_f32_dpp v8, v10, v8 quad_perm:[2,3,0,1] row_mask:0xf bank_mask:0xf
  v_add_f32_dpp v9, v11, v9 quad_perm:[2,3,0,1] row_mask:0xf bank_mask:0xf
  s_nop 0
  v_mov_b32_dpp v8, v8 quad_perm:[0,1,0,1] row_mask:0xf bank_mask:0xf
  v_mov_b32_dpp v9, v9 quad_perm:[0,1,0,1] row_mask:0xf bank_mask:0xf
  s_nop 1
  v_add_f32_dpp v12, v14, v12 quad_perm:[2,3,0,1] row_mask:0xf bank_mask:0xf
  v_add_f32_dpp v13, v15, v13 quad_perm:[2,3,0,1] row_mask:0xf bank_mask:0xf
  s_nop 0
  v_mov_b32_dpp v12, v12 quad_perm:[0,1,0,1] row_mask:0xf bank_mask:0xf
  v_mov_b32_dpp v13, v13 quad_perm:[0,1,0,1] row_mask:0xf bank_mask:0xf
  v_mul_f32 v12, s69, v12
  ds_write_b32 v78, v8 offset:8712
  v_mul_f32 v13, s69, v13
  ds_write_b32 v78, v9 offset:8776
  s_waitcnt lgkmcnt(0)
  s_barrier
  ds_read_b128 v[36:39], v78 offset:8704
  ds_read_b128 v[40:43], v78 offset:8768
  s_waitcnt lgkmcnt(0)
  s_barrier
  v_max_f32 v16, v36, v37
  v_max3_f32 v16, v16, v38, v39
  v_max3_f32 v16, v16, v40, v41
  v_max3_f32 v16, v16, v42, v43
  v_max3_f32 v16, v16, v12, v13
  v_mov_b32 v17, v16
  s_nop 1
  v_permlane16_swap_b32 v16, v17
  v_max_f32 v16, v16, v17
  v_mov_b32 v17, v16
  s_nop 1
  v_permlane32_swap_b32 v16, v17
  v_max_f32 v16, v16, v17
  v_sub_f32 v36, v36, v16
  v_sub_f32 v37, v37, v16
  v_sub_f32 v38, v38, v16
  v_sub_f32 v39, v39, v16
  v_sub_f32 v40, v40, v16
  v_sub_f32 v41, v41, v16
  v_sub_f32 v42, v42, v16
  v_sub_f32 v43, v43, v16
  v_sub_f32 v12, v12, v16
  v_sub_f32 v13, v13, v16
  v_exp_f32 v36, v36
  v_exp_f32 v37, v37
  v_exp_f32 v38, v38
  v_exp_f32 v39, v39
  v_exp_f32 v40, v40
  v_exp_f32 v41, v41
  v_exp_f32 v42, v42
  v_exp_f32 v43, v43
  v_exp_f32 v12, v12
  v_exp_f32 v13, v13
  v_cvt_pk_bf16_f32 v32, v36, v40
  v_cvt_pk_bf16_f32 v33, v37, v41
  v_cvt_pk_bf16_f32 v34, v38, v42
  v_cvt_pk_bf16_f32 v35, v39, v43
  v_cvt_pk_bf16_f32 v28, v12, v13
  v_cvt_pk_bf16_f32 v31, v12, v13
  v_mov_b32 v29, 0
  v_mov_b32 v30, 0
  v_mov_b32 v68, 0x3f803f80
  v_mov_b32 v69, 0x3f803f80
  v_mov_b32 v70, 0x3f803f80
  v_mov_b32 v71, 0x3f803f80
  s_nop 1
  v_mfma_f32_16x16x32_bf16 v[8:11], v[32:35], v[68:71], 0
  v_mfma_f32_16x16x32_bf16 v[0:3], v[32:35], v[52:55], 0
  v_mfma_f32_16x16x32_bf16 v[4:7], v[32:35], v[56:59], 0
  v_mfma_f32_16x16x16_bf16 v[8:11], v[28:29], v[68:69], v[8:11]
  v_mfma_f32_16x16x16_bf16 v[0:3], v[28:29], v[72:73], v[0:3]
  v_mfma_f32_16x16x16_bf16 v[4:7], v[30:31], v[72:73], v[4:7]
  ds_read_b128 v[68:71], v76 offset:13824
  v_rcp_f32 v10, v8
  v_rcp_f32 v11, v9
  v_mul_f32 v0, v10, v0
  v_mul_f32 v1, v11, v1
  s_nop 0
  v_mul_f32 v4, v10, v4
  v_mul_f32 v5, v11, v5
  v_cvt_pk_bf16_f32 v2, v0, v4
  ds_write_b32 v79, v2 offset:8704
  v_cvt_pk_bf16_f32 v3, v1, v5
  ds_write_b32 v79, v3 offset:9280
  v_mov_b64 v[16:17], 0
  v_mov_b64 v[18:19], 0
  v_mov_b64 v[20:21], 0
  v_mov_b64 v[22:23], 0
  v_mov_b64 v[24:25], 0
  v_mov_b64 v[26:27], 0
  s_branch Cf2_mxok
Cf2_last:
  s_waitcnt lgkmcnt(0)
  ds_read_b64 v[16:17], v77 offset:384
  v_mov_b64 v[18:19], v[72:73]
  s_add_u32 s68, s68, 655360
  s_waitcnt lgkmcnt(0)
  buffer_store_dwordx4 v[16:19], v76, s[8:11], s68 offen sc1
  s_branch L_cexit
L_w3:
  v_mov_b64 v[20:21], 0
  v_mov_b64 v[22:23], 0
  v_mov_b64 v[24:25], 0
  v_mov_b64 v[26:27], 0
  v_mov_b64 v[28:29], 0
  v_mov_b64 v[30:31], 0
  v_mov_b64 v[32:33], 0
  v_mov_b64 v[34:35], 0
  s_mov_b32 s78, 0x3f803f80
  s_mov_b32 s79, s78
  s_mov_b32 s65, 360448
  s_mov_b32 m0, 15872
  v_lshlrev_b32 v73, 2, v76
  v_mov_b32 v72, 0
  ds_read_b128 v[60:63], v76 offset:28672
  ds_read_b128 v[64:67], v76 offset:29696
  ds_read_b128 v[44:47], v76 offset:30720
  ds_read_b128 v[48:51], v76 offset:31744
  ds_read_b128 v[36:39], v76 offset:45056
  ds_read_b128 v[40:43], v76 offset:46080
  ds_read_b128 v[0:3], v76 offset:4608
  ds_read_b128 v[4:7], v76 offset:5632
  s_branch Cf3_top2
.p2align 6
Cf3_h2:
  v_lshlrev_b32 v73, 2, v76
  s_mov_b32 m0, 10752
  s_waitcnt vmcnt(4)
  ds_read_b128 v[60:63], v76 offset:28672
  ds_read_b128 v[64:67], v76 offset:29696
  ds_read_b128 v[44:47], v76 offset:30720
  ds_read_b128 v[48:51], v76 offset:31744
  ds_read_b128 v[36:39], v76 offset:45056
  ds_read_b128 v[40:43], v76 offset:46080
  s_cmp_eq_u32 s66, 12
  s_cbranch_scc1 Cf3_kv2
Cf3_h2w:
  s_waitcnt lgkmcnt(0)
  s_barrier
  ds_read_b128 v[0:3], v76 offset:4608
  ds_read_b128 v[4:7], v76 offset:5632
  buffer_load_dwordx4 v76, s[8:11], s64 offen offset:0 sc1 lds
  buffer_load_dwordx4 v76, s[8:11], s64 offen offset:1024 sc1 lds
  buffer_load_dwordx4 v76, s[8:11], s64 offen offset:2048 sc1 lds
Cf3_top2:
  ds_read_b128 v[8:11], v76 offset:6656
  s_mov_b32 m0, 15872
  s_waitcnt lgkmcnt(2)
  v_smfmac_f32_16x16x64_bf16 v[20:23], v[0:3], v[60:67], v74
  ds_read_b128 v[60:63], v76 offset:47104
  v_smfmac_f32_16x16x64_bf16 v[24:27], v[0:3], v[44:51], v74
  buffer_load_dwordx4 v[44:47], v76, s[8:11], s58 offen offset:0 sc1
  ds_read_b128 v[64:67], v76 offset:48128
  s_waitcnt lgkmcnt(3)
  v_smfmac_f32_16x16x64_bf16 v[20:23], v[4:7], v[80:87], v74
  buffer_load_dwordx4 v[48:51], v76, s[8:11], s58 offen offset:1024 sc1
  v_smfmac_f32_16x16x64_bf16 v[28:31], v[0:3], v[36:43], v74
  buffer_load_dwordx4 v[52:55], v76, s[8:11], s59 offen offset:0 sc1
  ds_read_b128 v[36:39], v76 offset:61440
  v_smfmac_f32_16x16x64_bf16 v[24:27], v[4:7], v[88:95], v74
  buffer_load_dwordx4 v[56:59], v76, s[8:11], s59 offen offset:1024 sc1
  ds_read_b128 v[40:43], v76 offset:62464
  v_smfmac_f32_16x16x64_bf16 v[28:31], v[4:7], v[208:215], v74
  ds_read_b128 v[12:15], v76 offset:7680
  s_waitcnt lgkmcnt(5)
  v_smfmac_f32_16x16x64_bf16 v[32:35], v[4:7], v[216:223], v74
  buffer_store_dwordx4 v[16:19], v76, s[8:11], s68 offen sc1
  s_waitcnt lgkmcnt(3)
  v_smfmac_f32_16x16x64_bf16 v[32:35], v[0:3], v[60:67], v74
  buffer_load_dword v73, s[8:11], s70 offen  lds
  v_smfmac_f32_16x16x64_bf16 v[20:23], v[8:11], v[96:103], v74
  ds_read_b128 v[60:63], v76 offset:63488
  v_smfmac_f32_16x16x64_bf16 v[24:27], v[8:11], v[104:111], v74
  ds_read_b128 v[64:67], v76 offset:64512
  s_waitcnt lgkmcnt(3)
  v_smfmac_f32_16x16x64_bf16 v[28:31], v[8:11], v[36:43], v74
  ds_read_b128 v[36:39], v75 offset:12288
  s_waitcnt lgkmcnt(3)
  v_smfmac_f32_16x16x64_bf16 v[20:23], v[12:15], v[112:119], v74
  s_waitcnt vmcnt(6)
  ds_read_b128 v[40:43], v75 offset:13312
  v_smfmac_f32_16x16x64_bf16 v[24:27], v[12:15], v[120:127], v74
  s_barrier
  ds_read_b128 v[0:3], v76 offset:8704
  v_smfmac_f32_16x16x64_bf16 v[28:31], v[12:15], v[224:231], v74
  ds_read_b128 v[4:7], v76 offset:9728
  v_smfmac_f32_16x16x64_bf16 v[32:35], v[12:15], v[232:239], v74
  s_waitcnt lgkmcnt(4)
  v_smfmac_f32_16x16x64_bf16 v[32:35], v[8:11], v[60:67], v74
  ds_read_b128 v[60:63], v75 offset:14336
  s_waitcnt lgkmcnt(2)
  v_smfmac_f32_16x16x64_bf16 v[20:23], v[0:3], v[128:135], v74
  ds_read_b128 v[16:19], v76 offset:10752
  v_smfmac_f32_16x16x64_bf16 v[24:27], v[0:3], v[136:143], v74
  ds_read_b128 v[64:67], v75 offset:15360
  v_smfmac_f32_16x16x64_bf16 v[28:31], v[0:3], v[36:43], v74
  ds_read_b128 v[36:39], v75 offset:28672
  s_waitcnt lgkmcnt(4)
  v_smfmac_f32_16x16x64_bf16 v[20:23], v[4:7], v[144:151], v74
  ds_read_b128 v[12:15], v76 offset:11776
  v_smfmac_f32_16x16x64_bf16 v[24:27], v[4:7], v[152:159], v74
  ds_read_b128 v[40:43], v75 offset:29696
  s_waitcnt lgkmcnt(4)
  v_smfmac_f32_16x16x64_bf16 v[20:23], v[16:19], v[160:167], v74
  ds_read_b128 v[8:11], v76 offset:12800
  s_waitcnt lgkmcnt(4)
  v_smfmac_f32_16x16x64_bf16 v[32:35], v[0:3], v[60:67], v74
  ds_read_b128 v[60:63], v75 offset:30720
  v_mov_b64 v[68:69], s[78:79]
  v_smfmac_f32_16x16x64_bf16 v[24:27], v[16:19], v[168:175], v74
  ds_read_b128 v[64:67], v75 offset:31744
  s_waitcnt lgkmcnt(4)
  v_smfmac_f32_16x16x64_bf16 v[20:23], v[12:15], v[176:183], v74
  s_waitcnt lgkmcnt(3)
  v_mov_b64 v[70:71], s[78:79]
  v_smfmac_f32_16x16x64_bf16 v[28:31], v[4:7], v[36:43], v74
  s_waitcnt lgkmcnt(2)
  v_mov_b64 v[36:37], 0
  v_smfmac_f32_16x16x64_bf16 v[20:23], v[8:11], v[192:199], v74
  v_mov_b64 v[38:39], 0
  v_smfmac_f32_16x16x64_bf16 v[24:27], v[12:15], v[184:191], v74
  v_mov_b64 v[40:41], 0
  v_smfmac_f32_16x16x64_bf16 v[24:27], v[8:11], v[200:207], v74
  s_waitcnt lgkmcnt(0)
  v_add_f32 v20, v20, v22
  v_smfmac_f32_16x16x64_bf16 v[32:35], v[4:7], v[60:67], v74
  v_add_f32 v21, v21, v23
  v_smfmac_f32_16x16x64_bf16 v[28:31], v[16:19], v[240:247], v74
  v_add_f32 v24, v24, v26
  v_cvt_pk_bf16_f32 v22, v20, v24
  v_smfmac_f32_16x16x64_bf16 v[28:31], v[12:15], a[0:7], v74
  ds_write_b32 v79, v22 offset:0
  v_add_f32 v25, v25, v27
  v_cvt_pk_bf16_f32 v23, v21, v25
  v_smfmac_f32_16x16x64_bf16 v[28:31], v[8:11], a[16:23], v74
  ds_write_b32 v79, v23 offset:576
  v_cmp_u_f32 vcc, v20, v21
  v_smfmac_f32_16x16x64_bf16 v[32:35], v[16:19], v[248:255], v74
  v_mov_b64 v[42:43], 0
  v_smfmac_f32_16x16x64_bf16 v[32:35], v[12:15], a[8:15], v74
  v_add_f32 v28, v28, v30
  v_add_f32 v29, v29, v31
  v_smfmac_f32_16x16x64_bf16 v[32:35], v[8:11], a[24:31], v74
  s_cbranch_vccnz Cf3_rec
Cf3_recok:
  v_smfmac_f32_16x16x64_bf16 v[36:39], v[16:19], a[128:135], v74
  s_waitcnt lgkmcnt(0)
  s_barrier
  ds_read_b128 v[60:63], v77
  v_smfmac_f32_16x16x64_bf16 v[40:43], v[16:19], a[136:143], v74
  ds_read_b128 v[64:67], v77 offset:128
  v_add_f32 v32, v32, v34
  v_cvt_pk_bf16_f32 v30, v28, v32
  v_smfmac_f32_16x16x64_bf16 v[36:39], v[0:3], a[96:103], v74
  ds_write_b32 v79, v30 offset:256
  v_add_f32 v33, v33, v35
  v_cvt_pk_bf16_f32 v31, v29, v33
  v_smfmac_f32_16x16x64_bf16 v[40:43], v[0:3], a[104:111], v74
  ds_write_b32 v79, v31 offset:832
  v_xor_b32 v75, 0x8000, v75
  v_smfmac_f32_16x16x64_bf16 v[36:39], v[4:7], a[112:119], v74
  ds_read_b128 v[0:3], v76 offset:4608
  v_mov_b32 v29, 0
  v_smfmac_f32_16x16x64_bf16 v[40:43], v[4:7], a[120:127], v74
  s_waitcnt vmcnt(4) lgkmcnt(3)
  v_mov_b32 v30, 0
  v_mfma_f32_16x16x32_bf16 v[44:47], v[44:47], v[60:63], 0
  ds_read_b128 v[4:7], v76 offset:5632
  s_waitcnt lgkmcnt(2)
  v_mfma_f32_16x16x32_bf16 v[44:47], v[48:51], v[64:67], v[44:47]
  s_barrier
  v_smfmac_f32_16x16x64_bf16 v[36:39], v[8:11], a[160:167], v74
  ds_read_b128 v[20:23], v77 offset:256
  ds_read_b128 v[24:27], v77 offset:384
  v_smfmac_f32_16x16x64_bf16 v[40:43], v[8:11], a[168:175], v74
  ds_read_b128 v[8:11], v76 offset:6656
  v_add_f32_dpp v72, v46, v44 quad_perm:[2,3,0,1] row_mask:0xf bank_mask:0xf
  v_add_f32_dpp v73, v47, v45 quad_perm:[2,3,0,1] row_mask:0xf bank_mask:0xf
  v_smfmac_f32_16x16x64_bf16 v[36:39], v[12:15], a[144:151], v74
  s_waitcnt lgkmcnt(4)
  v_exp_f32_dpp v72, v72 quad_perm:[0,1,0,1] row_mask:0xf bank_mask:0xf
  v_smfmac_f32_16x16x64_bf16 v[40:43], v[12:15], a[152:159], v74
  ds_read_b128 v[12:15], v76 offset:7680
  v_exp_f32_dpp v73, v73 quad_perm:[0,1,0,1] row_mask:0xf bank_mask:0xf
  v_smfmac_f32_16x16x64_bf16 v[36:39], v[0:3], a[32:39], v74
  s_waitcnt lgkmcnt(2)
  v_cvt_pk_bf16_f32 v72, v72, v73
  v_mfma_f32_16x16x32_bf16 v[20:23], v[20:23], v[60:63], 0
  ds_write_b32 v78, v72 offset:524
  v_mov_b64 v[16:17], 0
  v_mfma_f32_16x16x32_bf16 v[20:23], v[24:27], v[64:67], v[20:23]
  ds_read_b128 v[44:47], v75 offset:28672
  v_mov_b64 v[18:19], 0
  v_smfmac_f32_16x16x64_bf16 v[40:43], v[0:3], a[40:47], v74
  ds_read_b128 v[48:51], v75 offset:29696
  s_waitcnt lgkmcnt(4)
  v_smfmac_f32_16x16x64_bf16 v[36:39], v[4:7], a[48:55], v74
  v_add_f32_dpp v24, v22, v20 quad_perm:[2,3,0,1] row_mask:0xf bank_mask:0xf
  v_add_f32_dpp v25, v23, v21 quad_perm:[2,3,0,1] row_mask:0xf bank_mask:0xf
  v_smfmac_f32_16x16x64_bf16 v[36:39], v[8:11], a[64:71], v74
  s_waitcnt lgkmcnt(2)
  s_barrier
  ds_read_b128 v[32:35], v78 offset:512
  v_smfmac_f32_16x16x64_bf16 v[36:39], v[12:15], a[80:87], v74
  ds_read_b128 v[60:63], v75 offset:30720
  v_mul_f32 v24, s69, v24
  v_smfmac_f32_16x16x64_bf16 v[40:43], v[4:7], a[56:63], v74
  ds_read_b128 v[64:67], v75 offset:31744
  v_mul_f32 v25, s69, v25
  v_smfmac_f32_16x16x64_bf16 v[40:43], v[8:11], a[72:79], v74
  v_exp_f32_dpp v24, v24 quad_perm:[0,1,0,1] row_mask:0xf bank_mask:0xf
  v_smfmac_f32_16x16x64_bf16 v[40:43], v[12:15], a[88:95], v74
  s_waitcnt vmcnt(2) lgkmcnt(2)
  v_exp_f32_dpp v25, v25 quad_perm:[0,1,0,1] row_mask:0xf bank_mask:0xf
  v_mfma_f32_16x16x32_bf16 v[8:11], v[32:35], v[68:71], 0
  v_add_f32 v36, v36, v38
  v_add_f32 v37, v37, v39
  v_mfma_f32_16x16x32_bf16 v[0:3], v[32:35], v[52:55], 0
  v_add_f32 v40, v40, v42
  v_add_f32 v41, v41, v43
  v_mfma_f32_16x16x32_bf16 v[4:7], v[32:35], v[56:59], 0
  v_cvt_pk_bf16_f32 v28, v24, v25
  v_cvt_pk_bf16_f32 v72, v36, v37
  v_cvt_pk_bf16_f32 v73, v40, v41
  v_mfma_f32_16x16x16_bf16 v[8:11], v[28:29], v[68:69], v[8:11]
  v_cvt_pk_bf16_f32 v31, v24, v25
  v_mov_b64 v[20:21], 0
  v_mfma_f32_16x16x16_bf16 v[0:3], v[28:29], v[72:73], v[0:3]
  ds_read_b128 v[68:71], v76 offset:13824
  v_mov_b64 v[22:23], 0
  v_mfma_f32_16x16x16_bf16 v[4:7], v[30:31], v[72:73], v[4:7]
  v_rcp_f32 v10, v8
  v_rcp_f32 v11, v9
  v_mul_f32 v0, v10, v0
  v_mul_f32 v1, v11, v1
  s_nop 0
  v_mul_f32 v4, v10, v4
  v_mul_f32 v5, v11, v5
  v_cvt_pk_bf16_f32 v2, v0, v4
  ds_write_b32 v79, v2 offset:8704
  v_cvt_pk_bf16_f32 v3, v1, v5
  ds_write_b32 v79, v3 offset:9280
  v_max3_f32 v8, v8, v9, v10
  v_max_f32 v8, v8, v11
  v_cmp_le_f32 vcc, 1317011456, v8
  v_mov_b64 v[24:25], 0
  v_mov_b64 v[26:27], 0
  s_cbranch_vccnz Cf3_mx
Cf3_mxok:
  s_waitcnt lgkmcnt(0)
  s_barrier
  ds_read_b128 v[0:3], v78 offset:8704
  ds_read_b128 v[4:7], v78 offset:8768
  ds_read_b128 v[8:11], v78 offset:8832
  ds_read_b128 v[12:15], v78 offset:8896
  s_cmp_eq_u32 s66, 63
  s_cbranch_scc1 Cf3_last
  s_waitcnt lgkmcnt(3)
  v_smfmac_f32_16x16x64_bf16 v[16:19], v[0:3], v[44:51], v74
  ds_read_b128 v[52:55], v75 offset:45056
  s_waitcnt lgkmcnt(3)
  v_smfmac_f32_16x16x64_bf16 v[16:19], v[4:7], v[60:67], v74
  ds_read_b128 v[56:59], v75 offset:46080
  s_waitcnt lgkmcnt(3)
  v_smfmac_f32_16x16x64_bf16 v[16:19], v[8:11], a[176:183], v74
  ds_read_b128 v[36:39], v75 offset:47104
  s_waitcnt lgkmcnt(3)
  v_smfmac_f32_16x16x64_bf16 v[16:19], v[12:15], a[184:191], v74
  ds_read_b128 v[40:43], v75 offset:48128
  ds_read_b128 v[44:47], v75 offset:61440
  v_smfmac_f32_16x16x64_bf16 v[20:23], v[0:3], a[192:199], v74
  ds_read_b128 v[48:51], v75 offset:62464
  ds_read_b128 v[60:63], v75 offset:63488
  v_smfmac_f32_16x16x64_bf16 v[20:23], v[4:7], a[200:207], v74
  ds_read_b128 v[64:67], v75 offset:64512
  s_waitcnt lgkmcnt(6)
  v_cvt_pk_bf16_f32 v16, v16, v17
  v_cvt_pk_bf16_f32 v17, v18, v19
  v_bfi_b32 v16, 1, s72, v16
  v_smfmac_f32_16x16x64_bf16 v[20:23], v[8:11], v[52:59], v74
  buffer_store_dwordx2 v[16:17], v68, s[8:11], s73 offen
  s_waitcnt lgkmcnt(4)
  v_smfmac_f32_16x16x64_bf16 v[20:23], v[12:15], v[36:43], v74
  ds_read_b128 v[52:55], v75 offset:8192
  v_mov_b64 v[32:33], 0
  v_smfmac_f32_16x16x64_bf16 v[24:27], v[0:3], a[208:215], v74
  ds_read_b128 v[56:59], v75 offset:9216
  v_mov_b64 v[34:35], 0
  v_smfmac_f32_16x16x64_bf16 v[24:27], v[4:7], a[216:223], v74
  ds_read_b128 v[36:39], v75 offset:10240
  s_waitcnt lgkmcnt(5)
  v_cvt_pk_bf16_f32 v20, v20, v21
  v_cvt_pk_bf16_f32 v21, v22, v23
  v_bfi_b32 v20, 1, s72, v20
  v_smfmac_f32_16x16x64_bf16 v[24:27], v[8:11], v[44:51], v74
  buffer_store_dwordx2 v[20:21], v68, s[8:11], s74 offen
  s_waitcnt lgkmcnt(3)
  v_smfmac_f32_16x16x64_bf16 v[24:27], v[12:15], v[60:67], v74
  ds_read_b128 v[40:43], v75 offset:11264
  v_mov_b64 v[28:29], 0
  v_smfmac_f32_16x16x64_bf16 v[32:35], v[0:3], a[224:231], v74
  ds_read_b128 v[44:47], v75 offset:12288
  ds_read_b128 v[48:51], v75 offset:13312
  v_smfmac_f32_16x16x64_bf16 v[32:35], v[4:7], a[232:239], v74
  ds_read_b128 v[60:63], v75 offset:14336
  v_cvt_pk_bf16_f32 v24, v24, v25
  v_cvt_pk_bf16_f32 v25, v26, v27
  v_bfi_b32 v24, 1, s72, v24
  v_smfmac_f32_16x16x64_bf16 v[32:35], v[8:11], a[240:247], v74
  buffer_store_dwordx2 v[24:25], v68, s[8:11], s75 offen
  v_mov_b64 v[30:31], 0
  v_smfmac_f32_16x16x64_bf16 v[32:35], v[12:15], a[248:255], v74
  ds_read_b128 v[64:67], v75 offset:15360
  s_waitcnt lgkmcnt(6)
  v_smfmac_f32_16x16x64_bf16 v[28:31], v[0:3], v[52:59], v74
  s_waitcnt lgkmcnt(4)
  v_smfmac_f32_16x16x64_bf16 v[28:31], v[4:7], v[36:43], v74
  s_waitcnt lgkmcnt(2)
  v_cvt_pk_bf16_f32 v32, v32, v33
  v_cvt_pk_bf16_f32 v33, v34, v35
  v_bfi_b32 v32, 1, s72, v32
  v_smfmac_f32_16x16x64_bf16 v[28:31], v[8:11], v[44:51], v74
  buffer_store_dwordx2 v[32:33], v68, s[8:11], s76 offen
  s_waitcnt lgkmcnt(0)
  v_smfmac_f32_16x16x64_bf16 v[28:31], v[12:15], v[60:67], v74
  ds_read_b128 v[52:55], v76 offset:14848
  ds_read_b64 v[16:17], v77 offset:392
  v_mov_b64 v[18:19], v[72:73]
  v_xor_b32 v75, 0x8000, v75
  s_nop 3
  v_cvt_pk_bf16_f32 v28, v28, v29
  v_cvt_pk_bf16_f32 v29, v30, v31
  v_bfi_b32 v28, 1, s72, v28
  buffer_store_dwordx2 v[28:29], v68, s[8:11], s77 offen
  v_mov_b64 v[20:21], 0
  v_mov_b64 v[22:23], 0
  v_mov_b64 v[24:25], 0
  v_mov_b64 v[26:27], 0
  v_mov_b64 v[28:29], 0
  v_mov_b64 v[30:31], 0
  v_mov_b64 v[32:33], 0
  v_mov_b64 v[34:35], 0
  s_add_u32 s58, s58, 655360
  s_add_u32 s59, s59, 655360
  s_add_u32 s70, s70, 655360
  s_add_u32 s68, s68, 655360
  s_add_u32 s66, s66, 1
  s_xor_b32 s64, s64, 16384
  s_xor_b32 s65, s65, 16384
  s_nop 15
  s_nop 15
  s_nop 15
  s_nop 9
  buffer_load_dwordx4 v[0:3], v76, s[8:11], s60 offen offset:0 sc1
  buffer_load_dwordx4 v[4:7], v76, s[8:11], s60 offen offset:1024 sc1
  buffer_load_dwordx4 v[8:11], v76, s[8:11], s61 offen offset:0 sc1
  buffer_load_dwordx4 v[12:15], v76, s[8:11], s61 offen offset:1024 sc1
  s_nop 15
  s_nop 11
  buffer_load_dwordx4 v[44:47], v76, s[8:11], s60 offen offset:0 sc1
  buffer_load_dwordx4 v[48:51], v76, s[8:11], s60 offen offset:1024 sc1
  buffer_load_dwordx4 v[60:63], v76, s[8:11], s61 offen offset:0 sc1
  buffer_load_dwordx4 v[64:67], v76, s[8:11], s61 offen offset:1024 sc1
  s_waitcnt lgkmcnt(0)
  s_cmp_eq_u32 s66, 12
  s_cbranch_scc1 Cf3_kv
Cf3_kvb:
  s_waitcnt vmcnt(7)
  v_mfma_f32_16x16x32_bf16 v[56:59], v[52:55], v[0:3], 0
  v_bitop3_b32 v72, v0, v2, s72 bitop3:0x7e
  s_waitcnt vmcnt(6)
  v_mfma_f32_16x16x32_bf16 v[56:59], v[52:55], v[4:7], v[56:59]
  v_bitop3_b32 v73, v4, v6, s72 bitop3:0x7e
  v_or_b32 v72, v72, v73
  s_waitcnt vmcnt(5)
  v_mfma_f32_16x16x32_bf16 v[36:39], v[52:55], v[8:11], 0
  v_bitop3_b32 v73, v8, v10, s72 bitop3:0x7e
  v_or_b32 v72, v72, v73
  s_waitcnt vmcnt(4)
  v_mfma_f32_16x16x32_bf16 v[36:39], v[52:55], v[12:15], v[36:39]
  v_bitop3_b32 v73, v12, v14, s72 bitop3:0x7e
  v_bitop3_b32 v72, v72, v73, 1 bitop3:0xa8
  v_cmp_ne_u32 vcc, 0, v72
  s_nop 0
  s_cmp_eq_u64 vcc, 0
  s_cselect_b32 s54, s62, 268435456
  s_cselect_b32 s55, s63, 268435456
  v_add_f32_dpp v56, v56, v56 row_ror:4 row_mask:0xf bank_mask:0xf
  v_add_f32_dpp v57, v57, v57 row_ror:4 row_mask:0xf bank_mask:0xf
  v_add_f32_dpp v36, v36, v36 row_ror:4 row_mask:0xf bank_mask:0xf
  v_add_f32_dpp v37, v37, v37 row_ror:4 row_mask:0xf bank_mask:0xf
  v_add_f32_dpp v56, v56, v56 row_ror:8 row_mask:0xf bank_mask:0xf
  v_add_f32_dpp v57, v57, v57 row_ror:8 row_mask:0xf bank_mask:0xf
  v_add_f32_dpp v36, v36, v36 row_ror:8 row_mask:0xf bank_mask:0xf
  v_add_f32_dpp v37, v37, v37 row_ror:8 row_mask:0xf bank_mask:0xf
  v_cvt_pk_bf16_f32 v56, v56, v57
  buffer_store_dword v56, v69, s[8:11], s54 offen
  v_cvt_pk_bf16_f32 v36, v36, v37
  buffer_store_dword v36, v70, s[8:11], s55 offen
  s_cbranch_vccnz Cf3_h1r
  s_xor_b32 s62, s62, 16384
  buffer_store_dword v71, v69, s[8:11], s62 offen
  s_xor_b32 s63, s63, 16384
  buffer_store_dword v71, v70, s[8:11], s63 offen
  s_xor_b32 s72, s72, 1
  s_branch Cf3_h2
Cf3_h1r:
  s_mov_b64 exec, vcc
  buffer_load_dwordx4 v[0:3], v76, s[8:11], s60 offen offset:0 sc1
  buffer_load_dwordx4 v[4:7], v76, s[8:11], s60 offen offset:1024 sc1
  buffer_load_dwordx4 v[8:11], v76, s[8:11], s61 offen offset:0 sc1
  buffer_load_dwordx4 v[12:15], v76, s[8:11], s61 offen offset:1024 sc1
  s_mov_b64 exec, -1
  s_add_u32 s67, s67, 1
  s_waitcnt vmcnt(9)
  v_mfma_f32_16x16x32_bf16 v[56:59], v[52:55], v[44:47], 0
  v_bitop3_b32 v72, v44, v46, s72 bitop3:0x7e
  s_waitcnt vmcnt(8)
  v_mfma_f32_16x16x32_bf16 v[56:59], v[52:55], v[48:51], v[56:59]
  v_bitop3_b32 v73, v48, v50, s72 bitop3:0x7e
  v_or_b32 v72, v72, v73
  s_waitcnt vmcnt(7)
  v_mfma_f32_16x16x32_bf16 v[36:39], v[52:55], v[60:63], 0
  v_bitop3_b32 v73, v60, v62, s72 bitop3:0x7e
  v_or_b32 v72, v72, v73
  s_waitcnt vmcnt(6)
  v_mfma_f32_16x16x32_bf16 v[36:39], v[52:55], v[64:67], v[36:39]
  v_bitop3_b32 v73, v64, v66, s72 bitop3:0x7e
  v_bitop3_b32 v72, v72, v73, 1 bitop3:0xa8
  v_cmp_ne_u32 vcc, 0, v72
  s_cbranch_vccz Cf3_h1p
  s_mov_b64 exec, vcc
  buffer_load_dwordx4 v[44:47], v76, s[8:11], s60 offen offset:0 sc1
  buffer_load_dwordx4 v[48:51], v76, s[8:11], s60 offen offset:1024 sc1
  buffer_load_dwordx4 v[60:63], v76, s[8:11], s61 offen offset:0 sc1
  buffer_load_dwordx4 v[64:67], v76, s[8:11], s61 offen offset:1024 sc1
  s_mov_b64 exec, -1
  s_add_u32 s67, s67, 1
  s_waitcnt vmcnt(7)
  v_mfma_f32_16x16x32_bf16 v[56:59], v[52:55], v[0:3], 0
  v_bitop3_b32 v72, v0, v2, s72 bitop3:0x7e
  s_waitcnt vmcnt(6)
  v_mfma_f32_16x16x32_bf16 v[56:59], v[52:55], v[4:7], v[56:59]
  v_bitop3_b32 v73, v4, v6, s72 bitop3:0x7e
  v_or_b32 v72, v72, v73
  s_waitcnt vmcnt(5)
  v_mfma_f32_16x16x32_bf16 v[36:39], v[52:55], v[8:11], 0
  v_bitop3_b32 v73, v8, v10, s72 bitop3:0x7e
  v_or_b32 v72, v72, v73
  s_waitcnt vmcnt(4)
  v_mfma_f32_16x16x32_bf16 v[36:39], v[52:55], v[12:15], v[36:39]
  v_bitop3_b32 v73, v12, v14, s72 bitop3:0x7e
  v_bitop3_b32 v72, v72, v73, 1 bitop3:0xa8
  v_cmp_ne_u32 vcc, 0, v72
  s_cbranch_vccz Cf3_h1p
Cf3_h1s:
  s_mov_b64 exec, vcc
  buffer_load_dwordx4 v[0:3], v76, s[8:11], s60 offen offset:0 sc1
  buffer_load_dwordx4 v[4:7], v76, s[8:11], s60 offen offset:1024 sc1
  buffer_load_dwordx4 v[8:11], v76, s[8:11], s61 offen offset:0 sc1
  buffer_load_dwordx4 v[12:15], v76, s[8:11], s61 offen offset:1024 sc1
  s_mov_b64 exec, -1
  s_add_u32 s67, s67, 1
  s_waitcnt vmcnt(7)
  v_mfma_f32_16x16x32_bf16 v[56:59], v[52:55], v[44:47], 0
  v_bitop3_b32 v72, v44, v46, s72 bitop3:0x7e
  s_waitcnt vmcnt(6)
  v_mfma_f32_16x16x32_bf16 v[56:59], v[52:55], v[48:51], v[56:59]
  v_bitop3_b32 v73, v48, v50, s72 bitop3:0x7e
  v_or_b32 v72, v72, v73
  s_waitcnt vmcnt(5)
  v_mfma_f32_16x16x32_bf16 v[36:39], v[52:55], v[60:63], 0
  v_bitop3_b32 v73, v60, v62, s72 bitop3:0x7e
  v_or_b32 v72, v72, v73
  s_waitcnt vmcnt(4)
  v_mfma_f32_16x16x32_bf16 v[36:39], v[52:55], v[64:67], v[36:39]
  v_bitop3_b32 v73, v64, v66, s72 bitop3:0x7e
  v_bitop3_b32 v72, v72, v73, 1 bitop3:0xa8
  v_cmp_ne_u32 vcc, 0, v72
  s_cbranch_vccz Cf3_h1p
  s_mov_b64 exec, vcc
  buffer_load_dwordx4 v[44:47], v76, s[8:11], s60 offen offset:0 sc1
  buffer_load_dwordx4 v[48:51], v76, s[8:11], s60 offen offset:1024 sc1
  buffer_load_dwordx4 v[60:63], v76, s[8:11], s61 offen offset:0 sc1
  buffer_load_dwordx4 v[64:67], v76, s[8:11], s61 offen offset:1024 sc1
  s_mov_b64 exec, -1
  s_add_u32 s67, s67, 1
  s_waitcnt vmcnt(7)
  v_mfma_f32_16x16x32_bf16 v[56:59], v[52:55], v[0:3], 0
  v_bitop3_b32 v72, v0, v2, s72 bitop3:0x7e
  s_waitcnt vmcnt(6)
  v_mfma_f32_16x16x32_bf16 v[56:59], v[52:55], v[4:7], v[56:59]
  v_bitop3_b32 v73, v4, v6, s72 bitop3:0x7e
  v_or_b32 v72, v72, v73
  s_waitcnt vmcnt(5)
  v_mfma_f32_16x16x32_bf16 v[36:39], v[52:55], v[8:11], 0
  v_bitop3_b32 v73, v8, v10, s72 bitop3:0x7e
  v_or_b32 v72, v72, v73
  s_waitcnt vmcnt(4)
  v_mfma_f32_16x16x32_bf16 v[36:39], v[52:55], v[12:15], v[36:39]
  v_bitop3_b32 v73, v12, v14, s72 bitop3:0x7e
  v_bitop3_b32 v72, v72, v73, 1 bitop3:0xa8
  v_cmp_ne_u32 vcc, 0, v72
  s_cbranch_vccz Cf3_h1p
  s_cmp_lt_u32 s67, 131072
  s_cbranch_scc1 Cf3_h1s
Cf3_h1p:
  s_nop 2
  v_add_f32_dpp v56, v56, v56 row_ror:4 row_mask:0xf bank_mask:0xf
  v_add_f32_dpp v57, v57, v57 row_ror:4 row_mask:0xf bank_mask:0xf
  v_add_f32_dpp v36, v36, v36 row_ror:4 row_mask:0xf bank_mask:0xf
  v_add_f32_dpp v37, v37, v37 row_ror:4 row_mask:0xf bank_mask:0xf
  v_add_f32_dpp v56, v56, v56 row_ror:8 row_mask:0xf bank_mask:0xf
  v_add_f32_dpp v57, v57, v57 row_ror:8 row_mask:0xf bank_mask:0xf
  v_add_f32_dpp v36, v36, v36 row_ror:8 row_mask:0xf bank_mask:0xf
  v_add_f32_dpp v37, v37, v37 row_ror:8 row_mask:0xf bank_mask:0xf
  v_cvt_pk_bf16_f32 v56, v56, v57
  buffer_store_dword v56, v69, s[8:11], s62 offen
  v_cvt_pk_bf16_f32 v36, v36, v37
  buffer_store_dword v36, v70, s[8:11], s63 offen
  s_xor_b32 s62, s62, 16384
  buffer_store_dword v71, v69, s[8:11], s62 offen
  s_xor_b32 s63, s63, 16384
  buffer_store_dword v71, v70, s[8:11], s63 offen
  s_xor_b32 s72, s72, 1
  s_branch Cf3_h2
Cf3_rec:
  s_nop 7
  s_waitcnt vmcnt(0) lgkmcnt(0)
  v_max3_u32 v72, v0, v1, v2
  v_max3_u32 v72, v72, v3, v4
  v_max3_u32 v72, v72, v5, v6
  v_max3_u32 v72, v72, v7, v8
  v_max3_u32 v72, v72, v9, v10
  v_max3_u32 v72, v72, v11, v12
  v_max3_u32 v72, v72, v13, v14
  v_max3_u32 v72, v72, v15, v16
  v_max3_u32 v72, v72, v17, v18
  v_max_u32 v72, v72, v19
  v_cmp_eq_u32 vcc, -1, v72
  s_cbranch_vccz Cf3_recok
  s_barrier
Cf3_recp:
  buffer_load_dwordx4 v[0:3], v76, s[8:11], s64 offen offset:0 sc1
  buffer_load_dwordx4 v[4:7], v76, s[8:11], s64 offen offset:1024 sc1
  buffer_load_dwordx4 v[8:11], v76, s[8:11], s64 offen offset:2048 sc1
  s_add_u32 s67, s67, 1
  s_cmp_lt_u32 s67, 131072
  s_cselect_b32 s54, -2, -1
  s_waitcnt vmcnt(2)
  v_max3_u32 v72, v0, v1, v2
  s_waitcnt vmcnt(1)
  v_max3_u32 v72, v72, v3, v4
  v_max3_u32 v72, v72, v5, v6
  s_waitcnt vmcnt(0)
  v_max3_u32 v72, v72, v7, v8
  v_max3_u32 v72, v72, v9, v10
  v_max_u32 v72, v72, v11
  v_cmp_lt_u32 vcc, s54, v72
  s_cbranch_vccnz Cf3_recp
  ds_write_b128 v76, v[0:3] offset:10752
  ds_write_b128 v76, v[4:7] offset:11776
  ds_write_b128 v76, v[8:11] offset:12800
  v_mov_b64 v[20:21], 0
  v_mov_b64 v[22:23], 0
  v_mov_b64 v[24:25], 0
  v_mov_b64 v[26:27], 0
  v_mov_b64 v[28:29], 0
  v_mov_b64 v[30:31], 0
  v_mov_b64 v[32:33], 0
  v_mov_b64 v[34:35], 0
  s_waitcnt lgkmcnt(0)
  s_barrier
  ds_read_b128 v[0:3], v76 offset:4608
  ds_read_b128 v[60:63], v76 offset:28672
  ds_read_b128 v[64:67], v76 offset:29696
  s_waitcnt lgkmcnt(0)
  v_smfmac_f32_16x16x64_bf16 v[20:23], v[0:3], v[60:67], v74
  ds_read_b128 v[60:63], v76 offset:30720
  ds_read_b128 v[64:67], v76 offset:31744
  s_waitcnt lgkmcnt(0)
  v_smfmac_f32_16x16x64_bf16 v[24:27], v[0:3], v[60:67], v74
  ds_read_b128 v[60:63], v76 offset:45056
  ds_read_b128 v[64:67], v76 offset:46080
  s_waitcnt lgkmcnt(0)
  v_smfmac_f32_16x16x64_bf16 v[28:31], v[0:3], v[60:67], v74
  ds_read_b128 v[60:63], v76 offset:47104
  ds_read_b128 v[64:67], v76 offset:48128
  s_waitcnt lgkmcnt(0)
  v_smfmac_f32_16x16x64_bf16 v[32:35], v[0:3], v[60:67], v74
  ds_read_b128 v[4:7], v76 offset:5632
  s_waitcnt lgkmcnt(0)
  v_smfmac_f32_16x16x64_bf16 v[20:23], v[4:7], v[80:87], v74
  v_smfmac_f32_16x16x64_bf16 v[24:27], v[4:7], v[88:95], v74
  v_smfmac_f32_16x16x64_bf16 v[28:31], v[4:7], v[208:215], v74
  v_smfmac_f32_16x16x64_bf16 v[32:35], v[4:7], v[216:223], v74
  ds_read_b128 v[8:11], v76 offset:6656
  s_waitcnt lgkmcnt(0)
  v_smfmac_f32_16x16x64_bf16 v[20:23], v[8:11], v[96:103], v74
  v_smfmac_f32_16x16x64_bf16 v[24:27], v[8:11], v[104:111], v74
  ds_read_b128 v[60:63], v76 offset:61440
  ds_read_b128 v[64:67], v76 offset:62464
  s_waitcnt lgkmcnt(0)
  v_smfmac_f32_16x16x64_bf16 v[28:31], v[8:11], v[60:67], v74
  ds_read_b128 v[60:63], v76 offset:63488
  ds_read_b128 v[64:67], v76 offset:64512
  s_waitcnt lgkmcnt(0)
  v_smfmac_f32_16x16x64_bf16 v[32:35], v[8:11], v[60:67], v74
  ds_read_b128 v[12:15], v76 offset:7680
  s_waitcnt lgkmcnt(0)
  v_smfmac_f32_16x16x64_bf16 v[20:23], v[12:15], v[112:119], v74
  v_smfmac_f32_16x16x64_bf16 v[24:27], v[12:15], v[120:127], v74
  v_smfmac_f32_16x16x64_bf16 v[28:31], v[12:15], v[224:231], v74
  v_smfmac_f32_16x16x64_bf16 v[32:35], v[12:15], v[232:239], v74
  ds_read_b128 v[0:3], v76 offset:8704
  s_waitcnt lgkmcnt(0)
  v_smfmac_f32_16x16x64_bf16 v[20:23], v[0:3], v[128:135], v74
  v_smfmac_f32_16x16x64_bf16 v[24:27], v[0:3], v[136:143], v74
  ds_read_b128 v[60:63], v75 offset:12288
  ds_read_b128 v[64:67], v75 offset:13312
  s_waitcnt lgkmcnt(0)
  v_smfmac_f32_16x16x64_bf16 v[28:31], v[0:3], v[60:67], v74
  ds_read_b128 v[60:63], v75 offset:14336
  ds_read_b128 v[64:67], v75 offset:15360
  s_waitcnt lgkmcnt(0)
  v_smfmac_f32_16x16x64_bf16 v[32:35], v[0:3], v[60:67], v74
  ds_read_b128 v[4:7], v76 offset:9728
  s_waitcnt lgkmcnt(0)
  v_smfmac_f32_16x16x64_bf16 v[20:23], v[4:7], v[144:151], v74
  v_smfmac_f32_16x16x64_bf16 v[24:27], v[4:7], v[152:159], v74
  ds_read_b128 v[60:63], v75 offset:28672
  ds_read_b128 v[64:67], v75 offset:29696
  s_waitcnt lgkmcnt(0)
  v_smfmac_f32_16x16x64_bf16 v[28:31], v[4:7], v[60:67], v74
  ds_read_b128 v[60:63], v75 offset:30720
  ds_read_b128 v[64:67], v75 offset:31744
  s_waitcnt lgkmcnt(0)
  v_smfmac_f32_16x16x64_bf16 v[32:35], v[4:7], v[60:67], v74
  ds_read_b128 v[16:19], v76 offset:10752
  s_waitcnt lgkmcnt(0)
  v_smfmac_f32_16x16x64_bf16 v[20:23], v[16:19], v[160:167], v74
  v_smfmac_f32_16x16x64_bf16 v[24:27], v[16:19], v[168:175], v74
  v_smfmac_f32_16x16x64_bf16 v[28:31], v[16:19], v[240:247], v74
  v_smfmac_f32_16x16x64_bf16 v[32:35], v[16:19], v[248:255], v74
  ds_read_b128 v[12:15], v76 offset:11776
  s_waitcnt lgkmcnt(0)
  v_smfmac_f32_16x16x64_bf16 v[20:23], v[12:15], v[176:183], v74
  v_smfmac_f32_16x16x64_bf16 v[24:27], v[12:15], v[184:191], v74
  v_smfmac_f32_16x16x64_bf16 v[28:31], v[12:15], a[0:7], v74
  v_smfmac_f32_16x16x64_bf16 v[32:35], v[12:15], a[8:15], v74
  ds_read_b128 v[8:11], v76 offset:12800
  s_waitcnt lgkmcnt(0)
  v_smfmac_f32_16x16x64_bf16 v[20:23], v[8:11], v[192:199], v74
  v_smfmac_f32_16x16x64_bf16 v[24:27], v[8:11], v[200:207], v74
  v_smfmac_f32_16x16x64_bf16 v[28:31], v[8:11], a[16:23], v74
  v_smfmac_f32_16x16x64_bf16 v[32:35], v[8:11], a[24:31], v74
  v_add_f32 v20, v20, v22
  v_add_f32 v21, v21, v23
  v_add_f32 v24, v24, v26
  v_cvt_pk_bf16_f32 v22, v20, v24
  s_nop 0
  ds_write_b32 v79, v22 offset:0
  v_add_f32 v25, v25, v27
  v_cvt_pk_bf16_f32 v23, v21, v25
  ds_write_b32 v79, v23 offset:576
  v_add_f32 v28, v28, v30
  v_add_f32 v29, v29, v31
  s_waitcnt lgkmcnt(0)
  s_nop 1
  s_branch Cf3_recok
Cf3_mx:
  s_waitcnt lgkmcnt(0)
  s_barrier
  buffer_load_dwordx4 v[0:3], v76, s[8:11], s58 offen offset:0 sc1
  ds_read_b128 v[20:23], v77 offset:0
  ds_read_b128 v[28:31], v77 offset:256
  buffer_load_dwordx4 v[4:7], v76, s[8:11], s58 offen offset:1024 sc1
  ds_read_b128 v[24:27], v77 offset:128
  ds_read_b128 v[32:35], v77 offset:384
  s_waitcnt vmcnt(1) lgkmcnt(3)
  v_mfma_f32_16x16x32_bf16 v[8:11], v[0:3], v[20:23], 0
  s_waitcnt vmcnt(0) lgkmcnt(1)
  v_mfma_f32_16x16x32_bf16 v[8:11], v[4:7], v[24:27], v[8:11]
  v_mfma_f32_16x16x32_bf16 v[12:15], v[28:31], v[20:23], 0
  s_waitcnt lgkmcnt(0)
  v_mfma_f32_16x16x32_bf16 v[12:15], v[32:35], v[24:27], v[12:15]
  v_add_f32_dpp v8, v10, v8 quad_perm:[2,3,0,1] row_mask:0xf bank_mask:0xf
  v_add_f32_dpp v9, v11, v9 quad_perm:[2,3,0,1] row_mask:0xf bank_mask:0xf
  s_nop 0
  v_mov_b32_dpp v8, v8 quad_perm:[0,1,0,1] row_mask:0xf bank_mask:0xf
  v_mov_b32_dpp v9, v9 quad_perm:[0,1,0,1] row_mask:0xf bank_mask:0xf
  s_nop 1
  v_add_f32_dpp v12, v14, v12 quad_perm:[2,3,0,1] row_mask:0xf bank_mask:0xf
  v_add_f32_dpp v13, v15, v13 quad_perm:[2,3,0,1] row_mask:0xf bank_mask:0xf
  s_nop 0
  v_mov_b32_dpp v12, v12 quad_perm:[0,1,0,1] row_mask:0xf bank_mask:0xf
  v_mov_b32_dpp v13, v13 quad_perm:[0,1,0,1] row_mask:0xf bank_mask:0xf
  v_mul_f32 v12, s69, v12
  ds_write_b32 v78, v8 offset:8716
  v_mul_f32 v13, s69, v13
  ds_write_b32 v78, v9 offset:8780
  s_waitcnt lgkmcnt(0)
  s_barrier
  ds_read_b128 v[36:39], v78 offset:8704
  ds_read_b128 v[40:43], v78 offset:8768
  s_waitcnt lgkmcnt(0)
  s_barrier
  v_max_f32 v16, v36, v37
  v_max3_f32 v16, v16, v38, v39
  v_max3_f32 v16, v16, v40, v41
  v_max3_f32 v16, v16, v42, v43
  v_max3_f32 v16, v16, v12, v13
  v_mov_b32 v17, v16
  s_nop 1
  v_permlane16_swap_b32 v16, v17
  v_max_f32 v16, v16, v17
  v_mov_b32 v17, v16
  s_nop 1
  v_permlane32_swap_b32 v16, v17
  v_max_f32 v16, v16, v17
  v_sub_f32 v36, v36, v16
  v_sub_f32 v37, v37, v16
  v_sub_f32 v38, v38, v16
  v_sub_f32 v39, v39, v16
  v_sub_f32 v40, v40, v16
  v_sub_f32 v41, v41, v16
  v_sub_f32 v42, v42, v16
  v_sub_f32 v43, v43, v16
  v_sub_f32 v12, v12, v16
  v_sub_f32 v13, v13, v16
  v_exp_f32 v36, v36
  v_exp_f32 v37, v37
  v_exp_f32 v38, v38
  v_exp_f32 v39, v39
  v_exp_f32 v40, v40
  v_exp_f32 v41, v41
  v_exp_f32 v42, v42
  v_exp_f32 v43, v43
  v_exp_f32 v12, v12
  v_exp_f32 v13, v13
  v_cvt_pk_bf16_f32 v32, v36, v40
  v_cvt_pk_bf16_f32 v33, v37, v41
  v_cvt_pk_bf16_f32 v34, v38, v42
  v_cvt_pk_bf16_f32 v35, v39, v43
  v_cvt_pk_bf16_f32 v28, v12, v13
  v_cvt_pk_bf16_f32 v31, v12, v13
  v_mov_b32 v29, 0
  v_mov_b32 v30, 0
  v_mov_b32 v68, 0x3f803f80
  v_mov_b32 v69, 0x3f803f80
  v_mov_b32 v70, 0x3f803f80
  v_mov_b32 v71, 0x3f803f80
  s_nop 1
  v_mfma_f32_16x16x32_bf16 v[8:11], v[32:35], v[68:71], 0
  v_mfma_f32_16x16x32_bf16 v[0:3], v[32:35], v[52:55], 0
  v_mfma_f32_16x16x32_bf16 v[4:7], v[32:35], v[56:59], 0
  v_mfma_f32_16x16x16_bf16 v[8:11], v[28:29], v[68:69], v[8:11]
  v_mfma_f32_16x16x16_bf16 v[0:3], v[28:29], v[72:73], v[0:3]
  v_mfma_f32_16x16x16_bf16 v[4:7], v[30:31], v[72:73], v[4:7]
  ds_read_b128 v[68:71], v76 offset:13824
  v_rcp_f32 v10, v8
  v_rcp_f32 v11, v9
  v_mul_f32 v0, v10, v0
  v_mul_f32 v1, v11, v1
  s_nop 0
  v_mul_f32 v4, v10, v4
  v_mul_f32 v5, v11, v5
  v_cvt_pk_bf16_f32 v2, v0, v4
  ds_write_b32 v79, v2 offset:8704
  v_cvt_pk_bf16_f32 v3, v1, v5
  ds_write_b32 v79, v3 offset:9280
  v_mov_b64 v[16:17], 0
  v_mov_b64 v[18:19], 0
  v_mov_b64 v[20:21], 0
  v_mov_b64 v[22:23], 0
  v_mov_b64 v[24:25], 0
  v_mov_b64 v[26:27], 0
  s_branch Cf3_mxok
Cf3_kv:
  s_lshl_b32 s56, s53, 2
  s_add_u32 s56, s56, 128
  s_load_dword s57, s[12:13], s56 glc
  s_branch Cf3_kvb
Cf3_kv2:
  s_waitcnt lgkmcnt(0)
  s_cmp_ge_u32 s57, 0x700
  s_cbranch_scc1 Cf3_h2w
  s_load_dword s57, s[12:13], s56 glc
  s_add_u32 s67, s67, 1
  s_cmp_lt_u32 s67, 131072
  s_cbranch_scc1 Cf3_kv2
  s_branch Cf3_h2w
Cf3_last:
  s_waitcnt lgkmcnt(0)
  ds_read_b64 v[16:17], v77 offset:392
  v_mov_b64 v[18:19], v[72:73]
  s_add_u32 s68, s68, 655360
  s_waitcnt lgkmcnt(0)
  buffer_store_dwordx4 v[16:19], v76, s[8:11], s68 offen sc1
  s_branch L_cexit
L_w4:
  v_mov_b64 v[20:21], 0
  v_mov_b64 v[22:23], 0
  v_mov_b64 v[24:25], 0
  v_mov_b64 v[26:27], 0
  v_mov_b64 v[28:29], 0
  v_mov_b64 v[30:31], 0
  v_mov_b64 v[32:33], 0
  v_mov_b64 v[34:35], 0
  s_mov_b32 s78, 0x3f803f80
  s_mov_b32 s79, s78
  s_mov_b32 s65, 360448
  s_mov_b32 m0, 15872
  v_lshlrev_b32 v73, 2, v76
  v_mov_b32 v72, 0
  ds_read_b128 v[60:63], v76 offset:16384
  ds_read_b128 v[64:67], v76 offset:17408
  ds_read_b128 v[44:47], v76 offset:18432
  ds_read_b128 v[48:51], v76 offset:19456
  ds_read_b128 v[36:39], v76 offset:32768
  ds_read_b128 v[40:43], v76 offset:33792
  ds_read_b128 v[0:3], v76 offset:4608
  ds_read_b128 v[4:7], v76 offset:5632
  s_branch Cs0_top2
.p2align 6
Cs0_h2:
  v_lshlrev_b32 v73, 2, v76
  s_nop 15
  s_nop 11
  buffer_load_dwordx4 v[52:55], v76, s[8:11], s65 offen offset:0 sc1
  buffer_load_dwordx4 v[56:59], v76, s[8:11], s65 offen offset:1024 sc1
  s_nop 15
  s_nop 1
  buffer_load_dwordx4 v[52:55], v76, s[8:11], s65 offen offset:0 sc1
  buffer_load_dwordx4 v[56:59], v76, s[8:11], s65 offen offset:1024 sc1
  s_nop 15
  s_nop 1
  buffer_load_dwordx4 v[52:55], v76, s[8:11], s65 offen offset:0 sc1
  buffer_load_dwordx4 v[56:59], v76, s[8:11], s65 offen offset:1024 sc1
  s_waitcnt vmcnt(8)
  ds_read_b128 v[60:63], v76 offset:16384
  ds_read_b128 v[64:67], v76 offset:17408
  ds_read_b128 v[44:47], v76 offset:18432
  ds_read_b128 v[48:51], v76 offset:19456
  ds_read_b128 v[36:39], v76 offset:32768
  ds_read_b128 v[40:43], v76 offset:33792
  s_waitcnt vmcnt(4)
  v_max3_u32 v72, v52, v53, v54
  v_max3_u32 v72, v72, v55, v56
  v_max3_u32 v72, v72, v57, v58
  v_max_u32 v72, v72, v59
  ds_write_b128 v76, v[52:55] offset:4608
  ds_write_b128 v76, v[56:59] offset:5632
  v_cmp_eq_u32 vcc, -1, v72
  s_cbranch_vccnz Cs0_h2r
Cs0_h2w:
  s_waitcnt lgkmcnt(0)
  s_barrier
  ds_read_b128 v[0:3], v76 offset:4608
  ds_read_b128 v[4:7], v76 offset:5632
Cs0_top2:
  ds_read_b128 v[8:11], v76 offset:6656
  s_waitcnt lgkmcnt(2)
  v_smfmac_f32_16x16x64_bf16 v[20:23], v[0:3], v[60:67], v74
  ds_read_b128 v[60:63], v76 offset:34816
  v_smfmac_f32_16x16x64_bf16 v[24:27], v[0:3], v[44:51], v74
  buffer_load_dwordx4 v[44:47], v76, s[8:11], s58 offen offset:0 sc1
  ds_read_b128 v[64:67], v76 offset:35840
  s_waitcnt lgkmcnt(3)
  v_smfmac_f32_16x16x64_bf16 v[20:23], v[4:7], v[80:87], v74
  buffer_load_dwordx4 v[48:51], v76, s[8:11], s58 offen offset:1024 sc1
  v_smfmac_f32_16x16x64_bf16 v[28:31], v[0:3], v[36:43], v74
  buffer_load_dwordx4 v[52:55], v76, s[8:11], s59 offen offset:0 sc1
  ds_read_b128 v[36:39], v76 offset:49152
  v_smfmac_f32_16x16x64_bf16 v[24:27], v[4:7], v[88:95], v74
  buffer_load_dwordx4 v[56:59], v76, s[8:11], s59 offen offset:1024 sc1
  ds_read_b128 v[40:43], v76 offset:50176
  v_smfmac_f32_16x16x64_bf16 v[28:31], v[4:7], v[208:215], v74
  ds_read_b128 v[12:15], v76 offset:7680
  s_waitcnt lgkmcnt(5)
  v_smfmac_f32_16x16x64_bf16 v[32:35], v[4:7], v[216:223], v74
  buffer_store_dwordx4 v[16:19], v76, s[8:11], s68 offen sc1
  s_waitcnt lgkmcnt(3)
  v_smfmac_f32_16x16x64_bf16 v[32:35], v[0:3], v[60:67], v74
  buffer_load_dword v73, s[8:11], s70 offen  lds
  v_smfmac_f32_16x16x64_bf16 v[20:23], v[8:11], v[96:103], v74
  ds_read_b128 v[60:63], v76 offset:51200
  v_smfmac_f32_16x16x64_bf16 v[24:27], v[8:11], v[104:111], v74
  ds_read_b128 v[64:67], v76 offset:52224
  s_waitcnt lgkmcnt(3)
  v_smfmac_f32_16x16x64_bf16 v[28:31], v[8:11], v[36:43], v74
  ds_read_b128 v[36:39], v75 offset:0
  s_waitcnt lgkmcnt(3)
  v_smfmac_f32_16x16x64_bf16 v[20:23], v[12:15], v[112:119], v74
  ds_read_b128 v[40:43], v75 offset:1024
  v_smfmac_f32_16x16x64_bf16 v[24:27], v[12:15], v[120:127], v74
  s_barrier
  ds_read_b128 v[0:3], v76 offset:8704
  v_smfmac_f32_16x16x64_bf16 v[28:31], v[12:15], v[224:231], v74
  ds_read_b128 v[4:7], v76 offset:9728
  v_smfmac_f32_16x16x64_bf16 v[32:35], v[12:15], v[232:239], v74
  s_waitcnt lgkmcnt(4)
  v_smfmac_f32_16x16x64_bf16 v[32:35], v[8:11], v[60:67], v74
  ds_read_b128 v[60:63], v75 offset:2048
  s_waitcnt lgkmcnt(2)
  v_smfmac_f32_16x16x64_bf16 v[20:23], v[0:3], v[128:135], v74
  ds_read_b128 v[16:19], v76 offset:10752
  v_smfmac_f32_16x16x64_bf16 v[24:27], v[0:3], v[136:143], v74
  ds_read_b128 v[64:67], v75 offset:3072
  v_smfmac_f32_16x16x64_bf16 v[28:31], v[0:3], v[36:43], v74
  ds_read_b128 v[36:39], v75 offset:16384
  s_waitcnt lgkmcnt(4)
  v_smfmac_f32_16x16x64_bf16 v[20:23], v[4:7], v[144:151], v74
  ds_read_b128 v[12:15], v76 offset:11776
  v_smfmac_f32_16x16x64_bf16 v[24:27], v[4:7], v[152:159], v74
  ds_read_b128 v[40:43], v75 offset:17408
  s_waitcnt lgkmcnt(4)
  v_smfmac_f32_16x16x64_bf16 v[20:23], v[16:19], v[160:167], v74
  ds_read_b128 v[8:11], v76 offset:12800
  s_waitcnt lgkmcnt(4)
  v_smfmac_f32_16x16x64_bf16 v[32:35], v[0:3], v[60:67], v74
  ds_read_b128 v[60:63], v75 offset:18432
  v_mov_b64 v[68:69], s[78:79]
  v_smfmac_f32_16x16x64_bf16 v[24:27], v[16:19], v[168:175], v74
  ds_read_b128 v[64:67], v75 offset:19456
  s_waitcnt lgkmcnt(4)
  v_smfmac_f32_16x16x64_bf16 v[20:23], v[12:15], v[176:183], v74
  s_waitcnt lgkmcnt(3)
  v_mov_b64 v[70:71], s[78:79]
  v_smfmac_f32_16x16x64_bf16 v[28:31], v[4:7], v[36:43], v74
  s_waitcnt lgkmcnt(2)
  v_mov_b64 v[36:37], 0
  v_smfmac_f32_16x16x64_bf16 v[20:23], v[8:11], v[192:199], v74
  v_mov_b64 v[38:39], 0
  v_smfmac_f32_16x16x64_bf16 v[24:27], v[12:15], v[184:191], v74
  v_mov_b64 v[40:41], 0
  v_smfmac_f32_16x16x64_bf16 v[24:27], v[8:11], v[200:207], v74
  s_waitcnt lgkmcnt(0)
  v_add_f32 v20, v20, v22
  v_smfmac_f32_16x16x64_bf16 v[32:35], v[4:7], v[60:67], v74
  v_add_f32 v21, v21, v23
  v_smfmac_f32_16x16x64_bf16 v[28:31], v[16:19], v[240:247], v74
  v_add_f32 v24, v24, v26
  v_cvt_pk_bf16_f32 v22, v20, v24
  v_smfmac_f32_16x16x64_bf16 v[28:31], v[12:15], a[0:7], v74
  ds_write_b32 v79, v22 offset:0
  v_add_f32 v25, v25, v27
  v_cvt_pk_bf16_f32 v23, v21, v25
  v_smfmac_f32_16x16x64_bf16 v[28:31], v[8:11], a[16:23], v74
  ds_write_b32 v79, v23 offset:576
  v_cmp_u_f32 vcc, v20, v21
  v_smfmac_f32_16x16x64_bf16 v[32:35], v[16:19], v[248:255], v74
  v_mov_b64 v[42:43], 0
  v_smfmac_f32_16x16x64_bf16 v[32:35], v[12:15], a[8:15], v74
  v_add_f32 v28, v28, v30
  v_add_f32 v29, v29, v31
  v_smfmac_f32_16x16x64_bf16 v[32:35], v[8:11], a[24:31], v74
  s_cbranch_vccnz Cs0_rec
Cs0_recok:
  v_smfmac_f32_16x16x64_bf16 v[36:39], v[16:19], a[128:135], v74
  s_waitcnt lgkmcnt(0)
  s_barrier
  ds_read_b128 v[60:63], v77
  v_smfmac_f32_16x16x64_bf16 v[40:43], v[16:19], a[136:143], v74
  ds_read_b128 v[64:67], v77 offset:128
  v_add_f32 v32, v32, v34
  v_cvt_pk_bf16_f32 v30, v28, v32
  v_smfmac_f32_16x16x64_bf16 v[36:39], v[0:3], a[96:103], v74
  ds_write_b32 v79, v30 offset:256
  v_add_f32 v33, v33, v35
  v_cvt_pk_bf16_f32 v31, v29, v33
  v_smfmac_f32_16x16x64_bf16 v[40:43], v[0:3], a[104:111], v74
  ds_write_b32 v79, v31 offset:832
  v_xor_b32 v75, 0x8000, v75
  v_smfmac_f32_16x16x64_bf16 v[36:39], v[4:7], a[112:119], v74
  ds_read_b128 v[0:3], v76 offset:4608
  v_mov_b32 v29, 0
  v_smfmac_f32_16x16x64_bf16 v[40:43], v[4:7], a[120:127], v74
  s_waitcnt vmcnt(4) lgkmcnt(3)
  v_mov_b32 v30, 0
  v_mfma_f32_16x16x32_bf16 v[44:47], v[44:47], v[60:63], 0
  ds_read_b128 v[4:7], v76 offset:5632
  s_waitcnt lgkmcnt(2)
  v_mfma_f32_16x16x32_bf16 v[44:47], v[48:51], v[64:67], v[44:47]
  s_barrier
  v_smfmac_f32_16x16x64_bf16 v[36:39], v[8:11], a[160:167], v74
  ds_read_b128 v[20:23], v77 offset:256
  ds_read_b128 v[24:27], v77 offset:384
  v_smfmac_f32_16x16x64_bf16 v[40:43], v[8:11], a[168:175], v74
  ds_read_b128 v[8:11], v76 offset:6656
  v_add_f32_dpp v72, v46, v44 quad_perm:[2,3,0,1] row_mask:0xf bank_mask:0xf
  v_add_f32_dpp v73, v47, v45 quad_perm:[2,3,0,1] row_mask:0xf bank_mask:0xf
  v_smfmac_f32_16x16x64_bf16 v[36:39], v[12:15], a[144:151], v74
  s_waitcnt lgkmcnt(4)
  v_exp_f32_dpp v72, v72 quad_perm:[0,1,0,1] row_mask:0xf bank_mask:0xf
  v_smfmac_f32_16x16x64_bf16 v[40:43], v[12:15], a[152:159], v74
  ds_read_b128 v[12:15], v76 offset:7680
  v_exp_f32_dpp v73, v73 quad_perm:[0,1,0,1] row_mask:0xf bank_mask:0xf
  v_smfmac_f32_16x16x64_bf16 v[36:39], v[0:3], a[32:39], v74
  s_waitcnt lgkmcnt(2)
  v_cvt_pk_bf16_f32 v72, v72, v73
  v_mfma_f32_16x16x32_bf16 v[20:23], v[20:23], v[60:63], 0
  ds_write_b32 v78, v72 offset:512
  v_mov_b64 v[16:17], 0
  v_mfma_f32_16x16x32_bf16 v[20:23], v[24:27], v[64:67], v[20:23]
  ds_read_b128 v[44:47], v75 offset:16384
  v_mov_b64 v[18:19], 0
  v_smfmac_f32_16x16x64_bf16 v[40:43], v[0:3], a[40:47], v74
  ds_read_b128 v[48:51], v75 offset:17408
  s_waitcnt lgkmcnt(4)
  v_smfmac_f32_16x16x64_bf16 v[36:39], v[4:7], a[48:55], v74
  v_add_f32_dpp v24, v22, v20 quad_perm:[2,3,0,1] row_mask:0xf bank_mask:0xf
  v_add_f32_dpp v25, v23, v21 quad_perm:[2,3,0,1] row_mask:0xf bank_mask:0xf
  v_smfmac_f32_16x16x64_bf16 v[36:39], v[8:11], a[64:71], v74
  s_waitcnt lgkmcnt(2)
  s_barrier
  ds_read_b128 v[32:35], v78 offset:512
  v_smfmac_f32_16x16x64_bf16 v[36:39], v[12:15], a[80:87], v74
  ds_read_b128 v[60:63], v75 offset:18432
  v_mul_f32 v24, s69, v24
  v_smfmac_f32_16x16x64_bf16 v[40:43], v[4:7], a[56:63], v74
  ds_read_b128 v[64:67], v75 offset:19456
  v_mul_f32 v25, s69, v25
  v_smfmac_f32_16x16x64_bf16 v[40:43], v[8:11], a[72:79], v74
  v_exp_f32_dpp v24, v24 quad_perm:[0,1,0,1] row_mask:0xf bank_mask:0xf
  v_smfmac_f32_16x16x64_bf16 v[40:43], v[12:15], a[88:95], v74
  s_waitcnt vmcnt(2) lgkmcnt(2)
  v_exp_f32_dpp v25, v25 quad_perm:[0,1,0,1] row_mask:0xf bank_mask:0xf
  v_mfma_f32_16x16x32_bf16 v[8:11], v[32:35], v[68:71], 0
  v_add_f32 v36, v36, v38
  v_add_f32 v37, v37, v39
  v_mfma_f32_16x16x32_bf16 v[0:3], v[32:35], v[52:55], 0
  v_add_f32 v40, v40, v42
  v_add_f32 v41, v41, v43
  v_mfma_f32_16x16x32_bf16 v[4:7], v[32:35], v[56:59], 0
  v_cvt_pk_bf16_f32 v28, v24, v25
  v_cvt_pk_bf16_f32 v72, v36, v37
  v_cvt_pk_bf16_f32 v73, v40, v41
  v_mfma_f32_16x16x16_bf16 v[8:11], v[28:29], v[68:69], v[8:11]
  v_cvt_pk_bf16_f32 v31, v24, v25
  v_mov_b64 v[20:21], 0
  v_mfma_f32_16x16x16_bf16 v[0:3], v[28:29], v[72:73], v[0:3]
  ds_read_b128 v[68:71], v76 offset:13824
  v_mov_b64 v[22:23], 0
  v_mfma_f32_16x16x16_bf16 v[4:7], v[30:31], v[72:73], v[4:7]
  v_rcp_f32 v10, v8
  v_rcp_f32 v11, v9
  v_mul_f32 v0, v10, v0
  v_mul_f32 v1, v11, v1
  s_nop 0
  v_mul_f32 v4, v10, v4
  v_mul_f32 v5, v11, v5
  v_cvt_pk_bf16_f32 v2, v0, v4
  ds_write_b32 v79, v2 offset:8704
  v_cvt_pk_bf16_f32 v3, v1, v5
  ds_write_b32 v79, v3 offset:9280
  v_max3_f32 v8, v8, v9, v10
  v_max_f32 v8, v8, v11
  v_cmp_le_f32 vcc, 1317011456, v8
  v_mov_b64 v[24:25], 0
  v_mov_b64 v[26:27], 0
  s_cbranch_vccnz Cs0_mx
Cs0_mxok:
  s_waitcnt lgkmcnt(0)
  s_barrier
  ds_read_b128 v[0:3], v78 offset:8704
  ds_read_b128 v[4:7], v78 offset:8768
  ds_read_b128 v[8:11], v78 offset:8832
  ds_read_b128 v[12:15], v78 offset:8896
  s_cmp_eq_u32 s66, 63
  s_cbranch_scc1 Cs0_last
  s_waitcnt lgkmcnt(3)
  v_smfmac_f32_16x16x64_bf16 v[16:19], v[0:3], v[44:51], v74
  ds_read_b128 v[52:55], v75 offset:32768
  s_waitcnt lgkmcnt(3)
  v_smfmac_f32_16x16x64_bf16 v[16:19], v[4:7], v[60:67], v74
  ds_read_b128 v[56:59], v75 offset:33792
  s_waitcnt lgkmcnt(3)
  v_smfmac_f32_16x16x64_bf16 v[16:19], v[8:11], a[176:183], v74
  ds_read_b128 v[36:39], v75 offset:34816
  s_waitcnt lgkmcnt(3)
  v_smfmac_f32_16x16x64_bf16 v[16:19], v[12:15], a[184:191], v74
  ds_read_b128 v[40:43], v75 offset:35840
  ds_read_b128 v[44:47], v75 offset:49152
  v_smfmac_f32_16x16x64_bf16 v[20:23], v[0:3], a[192:199], v74
  ds_read_b128 v[48:51], v75 offset:50176
  ds_read_b128 v[60:63], v75 offset:51200
  v_smfmac_f32_16x16x64_bf16 v[20:23], v[4:7], a[200:207], v74
  ds_read_b128 v[64:67], v75 offset:52224
  s_waitcnt lgkmcnt(6)
  v_cvt_pk_bf16_f32 v16, v16, v17
  v_cvt_pk_bf16_f32 v17, v18, v19
  v_bfi_b32 v16, 1, s72, v16
  v_smfmac_f32_16x16x64_bf16 v[20:23], v[8:11], v[52:59], v74
  buffer_store_dwordx2 v[16:17], v68, s[8:11], s73 offen sc1
  s_waitcnt lgkmcnt(4)
  v_smfmac_f32_16x16x64_bf16 v[20:23], v[12:15], v[36:43], v74
  v_mov_b64 v[32:33], 0
  v_smfmac_f32_16x16x64_bf16 v[24:27], v[0:3], a[208:215], v74
  v_mov_b64 v[34:35], 0
  v_smfmac_f32_16x16x64_bf16 v[24:27], v[4:7], a[216:223], v74
  s_waitcnt lgkmcnt(2)
  v_cvt_pk_bf16_f32 v20, v20, v21
  v_cvt_pk_bf16_f32 v21, v22, v23
  v_bfi_b32 v20, 1, s72, v20
  v_smfmac_f32_16x16x64_bf16 v[24:27], v[8:11], v[44:51], v74
  buffer_store_dwordx2 v[20:21], v68, s[8:11], s74 offen sc1
  s_waitcnt lgkmcnt(0)
  v_smfmac_f32_16x16x64_bf16 v[24:27], v[12:15], v[60:67], v74
  v_smfmac_f32_16x16x64_bf16 v[32:35], v[0:3], a[224:231], v74
  v_smfmac_f32_16x16x64_bf16 v[32:35], v[4:7], a[232:239], v74
  v_cvt_pk_bf16_f32 v24, v24, v25
  v_cvt_pk_bf16_f32 v25, v26, v27
  v_bfi_b32 v24, 1, s72, v24
  v_smfmac_f32_16x16x64_bf16 v[32:35], v[8:11], a[240:247], v74
  s_nop 1
  buffer_store_dwordx2 v[24:25], v68, s[8:11], s75 offen sc1
  v_smfmac_f32_16x16x64_bf16 v[32:35], v[12:15], a[248:255], v74
  ds_read_b128 v[0:3], v76 offset:14848
  ds_read_b64 v[16:17], v77 offset:256
  v_mov_b64 v[18:19], v[72:73]
  v_xor_b32 v75, 0x8000, v75
  s_nop 3
  v_cvt_pk_bf16_f32 v32, v32, v33
  v_cvt_pk_bf16_f32 v33, v34, v35
  v_bfi_b32 v32, 1, s72, v32
  buffer_store_dwordx2 v[32:33], v68, s[8:11], s76 offen sc1
  v_mov_b64 v[20:21], 0
  v_mov_b64 v[22:23], 0
  v_mov_b64 v[24:25], 0
  v_mov_b64 v[26:27], 0
  v_mov_b64 v[28:29], 0
  v_mov_b64 v[30:31], 0
  v_mov_b64 v[32:33], 0
  v_mov_b64 v[34:35], 0
  s_add_u32 s58, s58, 655360
  s_add_u32 s59, s59, 655360
  s_add_u32 s70, s70, 655360
  s_add_u32 s68, s68, 655360
  s_add_u32 s66, s66, 1
  s_xor_b32 s64, s64, 16384
  s_xor_b32 s65, s65, 16384
  s_nop 15
  s_nop 3
  buffer_load_dwordx4 v[52:55], v76, s[8:11], s60 offen offset:0 sc1
  buffer_load_dwordx4 v[56:59], v76, s[8:11], s60 offen offset:1024 sc1
  s_nop 15
  s_nop 11
  buffer_load_dwordx4 v[36:39], v76, s[8:11], s60 offen offset:0 sc1
  buffer_load_dwordx4 v[40:43], v76, s[8:11], s60 offen offset:1024 sc1
  s_waitcnt lgkmcnt(0)
  s_waitcnt vmcnt(3)
  v_mfma_f32_16x16x32_bf16 v[4:7], v[0:3], v[52:55], 0
  v_bitop3_b32 v72, v52, v54, s72 bitop3:0x7e
  s_waitcnt vmcnt(2)
  v_mfma_f32_16x16x32_bf16 v[4:7], v[0:3], v[56:59], v[4:7]
  v_bitop3_b32 v73, v56, v58, s72 bitop3:0x7e
  v_bitop3_b32 v72, v72, v73, 1 bitop3:0xa8
  v_cmp_ne_u32 vcc, 0, v72
  s_nop 0
  s_cmp_eq_u64 vcc, 0
  s_cselect_b32 s54, s62, 268435456
  s_nop 0
  v_add_f32_dpp v4, v4, v4 row_ror:4 row_mask:0xf bank_mask:0xf
  v_add_f32_dpp v5, v5, v5 row_ror:4 row_mask:0xf bank_mask:0xf
  s_nop 0
  v_add_f32_dpp v4, v4, v4 row_ror:8 row_mask:0xf bank_mask:0xf
  v_add_f32_dpp v5, v5, v5 row_ror:8 row_mask:0xf bank_mask:0xf
  v_cvt_pk_bf16_f32 v4, v4, v5
  buffer_store_dword v4, v69, s[8:11], s54 offen sc1
  s_cbranch_vccnz Cs0_h1r
  s_xor_b32 s62, s62, 16384
  buffer_store_dword v71, v69, s[8:11], s62 offen sc1
  s_xor_b32 s72, s72, 1
  s_branch Cs0_h2
Cs0_h1r:
  s_mov_b64 exec, vcc
  buffer_load_dwordx4 v[52:55], v76, s[8:11], s60 offen offset:0 sc1
  buffer_load_dwordx4 v[56:59], v76, s[8:11], s60 offen offset:1024 sc1
  s_mov_b64 exec, -1
  s_add_u32 s67, s67, 1
  s_waitcnt vmcnt(4)
  v_mfma_f32_16x16x32_bf16 v[4:7], v[0:3], v[36:39], 0
  v_bitop3_b32 v72, v36, v38, s72 bitop3:0x7e
  s_waitcnt vmcnt(3)
  v_mfma_f32_16x16x32_bf16 v[4:7], v[0:3], v[40:43], v[4:7]
  v_bitop3_b32 v73, v40, v42, s72 bitop3:0x7e
  v_bitop3_b32 v72, v72, v73, 1 bitop3:0xa8
  v_cmp_ne_u32 vcc, 0, v72
  s_cbranch_vccz Cs0_h1p
  s_mov_b64 exec, vcc
  buffer_load_dwordx4 v[36:39], v76, s[8:11], s60 offen offset:0 sc1
  buffer_load_dwordx4 v[40:43], v76, s[8:11], s60 offen offset:1024 sc1
  s_mov_b64 exec, -1
  s_add_u32 s67, s67, 1
  s_waitcnt vmcnt(3)
  v_mfma_f32_16x16x32_bf16 v[4:7], v[0:3], v[52:55], 0
  v_bitop3_b32 v72, v52, v54, s72 bitop3:0x7e
  s_waitcnt vmcnt(2)
  v_mfma_f32_16x16x32_bf16 v[4:7], v[0:3], v[56:59], v[4:7]
  v_bitop3_b32 v73, v56, v58, s72 bitop3:0x7e
  v_bitop3_b32 v72, v72, v73, 1 bitop3:0xa8
  v_cmp_ne_u32 vcc, 0, v72
  s_cbranch_vccz Cs0_h1p
Cs0_h1s:
  s_mov_b64 exec, vcc
  buffer_load_dwordx4 v[52:55], v76, s[8:11], s60 offen offset:0 sc1
  buffer_load_dwordx4 v[56:59], v76, s[8:11], s60 offen offset:1024 sc1
  s_mov_b64 exec, -1
  s_add_u32 s67, s67, 1
  s_waitcnt vmcnt(3)
  v_mfma_f32_16x16x32_bf16 v[4:7], v[0:3], v[36:39], 0
  v_bitop3_b32 v72, v36, v38, s72 bitop3:0x7e
  s_waitcnt vmcnt(2)
  v_mfma_f32_16x16x32_bf16 v[4:7], v[0:3], v[40:43], v[4:7]
  v_bitop3_b32 v73, v40, v42, s72 bitop3:0x7e
  v_bitop3_b32 v72, v72, v73, 1 bitop3:0xa8
  v_cmp_ne_u32 vcc, 0, v72
  s_cbranch_vccz Cs0_h1p
  s_mov_b64 exec, vcc
  buffer_load_dwordx4 v[36:39], v76, s[8:11], s60 offen offset:0 sc1
  buffer_load_dwordx4 v[40:43], v76, s[8:11], s60 offen offset:1024 sc1
  s_mov_b64 exec, -1
  s_add_u32 s67, s67, 1
  s_waitcnt vmcnt(3)
  v_mfma_f32_16x16x32_bf16 v[4:7], v[0:3], v[52:55], 0
  v_bitop3_b32 v72, v52, v54, s72 bitop3:0x7e
  s_waitcnt vmcnt(2)
  v_mfma_f32_16x16x32_bf16 v[4:7], v[0:3], v[56:59], v[4:7]
  v_bitop3_b32 v73, v56, v58, s72 bitop3:0x7e
  v_bitop3_b32 v72, v72, v73, 1 bitop3:0xa8
  v_cmp_ne_u32 vcc, 0, v72
  s_cbranch_vccz Cs0_h1p
  s_cmp_lt_u32 s67, 131072
  s_cbranch_scc1 Cs0_h1s
Cs0_h1p:
  s_nop 2
  v_add_f32_dpp v4, v4, v4 row_ror:4 row_mask:0xf bank_mask:0xf
  v_add_f32_dpp v5, v5, v5 row_ror:4 row_mask:0xf bank_mask:0xf
  s_nop 0
  v_add_f32_dpp v4, v4, v4 row_ror:8 row_mask:0xf bank_mask:0xf
  v_add_f32_dpp v5, v5, v5 row_ror:8 row_mask:0xf bank_mask:0xf
  v_cvt_pk_bf16_f32 v4, v4, v5
  buffer_store_dword v4, v69, s[8:11], s62 offen sc1
  s_xor_b32 s62, s62, 16384
  buffer_store_dword v71, v69, s[8:11], s62 offen sc1
  s_xor_b32 s72, s72, 1
  s_branch Cs0_h2
Cs0_h2r:
  s_mov_b64 exec, vcc
  buffer_load_dwordx4 v[52:55], v76, s[8:11], s65 offen offset:0 sc1
  buffer_load_dwordx4 v[56:59], v76, s[8:11], s65 offen offset:1024 sc1
  s_mov_b64 exec, -1
  s_add_u32 s67, s67, 1
  s_waitcnt vmcnt(4)
  v_max3_u32 v72, v52, v53, v54
  v_max3_u32 v72, v72, v55, v56
  v_max3_u32 v72, v72, v57, v58
  v_max_u32 v72, v72, v59
  ds_write_b128 v76, v[52:55] offset:4608
  ds_write_b128 v76, v[56:59] offset:5632
  v_cmp_eq_u32 vcc, -1, v72
  s_cbranch_vccz Cs0_h2w
  s_mov_b64 exec, vcc
  buffer_load_dwordx4 v[52:55], v76, s[8:11], s65 offen offset:0 sc1
  buffer_load_dwordx4 v[56:59], v76, s[8:11], s65 offen offset:1024 sc1
  s_mov_b64 exec, -1
  s_add_u32 s67, s67, 1
  s_waitcnt vmcnt(4)
  v_max3_u32 v72, v52, v53, v54
  v_max3_u32 v72, v72, v55, v56
  v_max3_u32 v72, v72, v57, v58
  v_max_u32 v72, v72, v59
  ds_write_b128 v76, v[52:55] offset:4608
  ds_write_b128 v76, v[56:59] offset:5632
  v_cmp_eq_u32 vcc, -1, v72
  s_cbranch_vccz Cs0_h2w
  s_mov_b64 exec, vcc
  buffer_load_dwordx4 v[52:55], v76, s[8:11], s65 offen offset:0 sc1
  buffer_load_dwordx4 v[56:59], v76, s[8:11], s65 offen offset:1024 sc1
  s_mov_b64 exec, -1
  s_add_u32 s67, s67, 1
  s_waitcnt vmcnt(4)
  v_max3_u32 v72, v52, v53, v54
  v_max3_u32 v72, v72, v55, v56
  v_max3_u32 v72, v72, v57, v58
  v_max_u32 v72, v72, v59
  ds_write_b128 v76, v[52:55] offset:4608
  ds_write_b128 v76, v[56:59] offset:5632
  v_cmp_eq_u32 vcc, -1, v72
  s_cbranch_vccz Cs0_h2w
  s_mov_b64 exec, vcc
  buffer_load_dwordx4 v[52:55], v76, s[8:11], s65 offen offset:0 sc1
  buffer_load_dwordx4 v[56:59], v76, s[8:11], s65 offen offset:1024 sc1
  s_mov_b64 exec, -1
  s_add_u32 s67, s67, 1
  s_waitcnt vmcnt(4)
  v_max3_u32 v72, v52, v53, v54
  v_max3_u32 v72, v72, v55, v56
  v_max3_u32 v72, v72, v57, v58
  v_max_u32 v72, v72, v59
  ds_write_b128 v76, v[52:55] offset:4608
  ds_write_b128 v76, v[56:59] offset:5632
  v_cmp_eq_u32 vcc, -1, v72
  s_cbranch_vccz Cs0_h2w
  s_cmp_lt_u32 s67, 131072
  s_cbranch_scc1 Cs0_h2r
Cs0_h2ok:
  ds_write_b128 v76, v[52:55] offset:4608
  ds_write_b128 v76, v[56:59] offset:5632
  s_branch Cs0_h2w
Cs0_rec:
  s_nop 7
  s_waitcnt vmcnt(0) lgkmcnt(0)
  v_max3_u32 v72, v0, v1, v2
  v_max3_u32 v72, v72, v3, v4
  v_max3_u32 v72, v72, v5, v6
  v_max3_u32 v72, v72, v7, v8
  v_max3_u32 v72, v72, v9, v10
  v_max3_u32 v72, v72, v11, v12
  v_max3_u32 v72, v72, v13, v14
  v_max3_u32 v72, v72, v15, v16
  v_max3_u32 v72, v72, v17, v18
  v_max_u32 v72, v72, v19
  v_cmp_eq_u32 vcc, -1, v72
  s_cbranch_vccz Cs0_recok
  s_barrier
  v_mov_b64 v[20:21], 0
  v_mov_b64 v[22:23], 0
  v_mov_b64 v[24:25], 0
  v_mov_b64 v[26:27], 0
  v_mov_b64 v[28:29], 0
  v_mov_b64 v[30:31], 0
  v_mov_b64 v[32:33], 0
  v_mov_b64 v[34:35], 0
  s_waitcnt lgkmcnt(0)
  s_barrier
  ds_read_b128 v[0:3], v76 offset:4608
  ds_read_b128 v[60:63], v76 offset:16384
  ds_read_b128 v[64:67], v76 offset:17408
  s_waitcnt lgkmcnt(0)
  v_smfmac_f32_16x16x64_bf16 v[20:23], v[0:3], v[60:67], v74
  ds_read_b128 v[60:63], v76 offset:18432
  ds_read_b128 v[64:67], v76 offset:19456
  s_waitcnt lgkmcnt(0)
  v_smfmac_f32_16x16x64_bf16 v[24:27], v[0:3], v[60:67], v74
  ds_read_b128 v[60:63], v76 offset:32768
  ds_read_b128 v[64:67], v76 offset:33792
  s_waitcnt lgkmcnt(0)
  v_smfmac_f32_16x16x64_bf16 v[28:31], v[0:3], v[60:67], v74
  ds_read_b128 v[60:63], v76 offset:34816
  ds_read_b128 v[64:67], v76 offset:35840
  s_waitcnt lgkmcnt(0)
  v_smfmac_f32_16x16x64_bf16 v[32:35], v[0:3], v[60:67], v74
  ds_read_b128 v[4:7], v76 offset:5632
  s_waitcnt lgkmcnt(0)
  v_smfmac_f32_16x16x64_bf16 v[20:23], v[4:7], v[80:87], v74
  v_smfmac_f32_16x16x64_bf16 v[24:27], v[4:7], v[88:95], v74
  v_smfmac_f32_16x16x64_bf16 v[28:31], v[4:7], v[208:215], v74
  v_smfmac_f32_16x16x64_bf16 v[32:35], v[4:7], v[216:223], v74
  ds_read_b128 v[8:11], v76 offset:6656
  s_waitcnt lgkmcnt(0)
  v_smfmac_f32_16x16x64_bf16 v[20:23], v[8:11], v[96:103], v74
  v_smfmac_f32_16x16x64_bf16 v[24:27], v[8:11], v[104:111], v74
  ds_read_b128 v[60:63], v76 offset:49152
  ds_read_b128 v[64:67], v76 offset:50176
  s_waitcnt lgkmcnt(0)
  v_smfmac_f32_16x16x64_bf16 v[28:31], v[8:11], v[60:67], v74
  ds_read_b128 v[60:63], v76 offset:51200
  ds_read_b128 v[64:67], v76 offset:52224
  s_waitcnt lgkmcnt(0)
  v_smfmac_f32_16x16x64_bf16 v[32:35], v[8:11], v[60:67], v74
  ds_read_b128 v[12:15], v76 offset:7680
  s_waitcnt lgkmcnt(0)
  v_smfmac_f32_16x16x64_bf16 v[20:23], v[12:15], v[112:119], v74
  v_smfmac_f32_16x16x64_bf16 v[24:27], v[12:15], v[120:127], v74
  v_smfmac_f32_16x16x64_bf16 v[28:31], v[12:15], v[224:231], v74
  v_smfmac_f32_16x16x64_bf16 v[32:35], v[12:15], v[232:239], v74
  ds_read_b128 v[0:3], v76 offset:8704
  s_waitcnt lgkmcnt(0)
  v_smfmac_f32_16x16x64_bf16 v[20:23], v[0:3], v[128:135], v74
  v_smfmac_f32_16x16x64_bf16 v[24:27], v[0:3], v[136:143], v74
  ds_read_b128 v[60:63], v75 offset:0
  ds_read_b128 v[64:67], v75 offset:1024
  s_waitcnt lgkmcnt(0)
  v_smfmac_f32_16x16x64_bf16 v[28:31], v[0:3], v[60:67], v74
  ds_read_b128 v[60:63], v75 offset:2048
  ds_read_b128 v[64:67], v75 offset:3072
  s_waitcnt lgkmcnt(0)
  v_smfmac_f32_16x16x64_bf16 v[32:35], v[0:3], v[60:67], v74
  ds_read_b128 v[4:7], v76 offset:9728
  s_waitcnt lgkmcnt(0)
  v_smfmac_f32_16x16x64_bf16 v[20:23], v[4:7], v[144:151], v74
  v_smfmac_f32_16x16x64_bf16 v[24:27], v[4:7], v[152:159], v74
  ds_read_b128 v[60:63], v75 offset:16384
  ds_read_b128 v[64:67], v75 offset:17408
  s_waitcnt lgkmcnt(0)
  v_smfmac_f32_16x16x64_bf16 v[28:31], v[4:7], v[60:67], v74
  ds_read_b128 v[60:63], v75 offset:18432
  ds_read_b128 v[64:67], v75 offset:19456
  s_waitcnt lgkmcnt(0)
  v_smfmac_f32_16x16x64_bf16 v[32:35], v[4:7], v[60:67], v74
  ds_read_b128 v[16:19], v76 offset:10752
  s_waitcnt lgkmcnt(0)
  v_smfmac_f32_16x16x64_bf16 v[20:23], v[16:19], v[160:167], v74
  v_smfmac_f32_16x16x64_bf16 v[24:27], v[16:19], v[168:175], v74
  v_smfmac_f32_16x16x64_bf16 v[28:31], v[16:19], v[240:247], v74
  v_smfmac_f32_16x16x64_bf16 v[32:35], v[16:19], v[248:255], v74
  ds_read_b128 v[12:15], v76 offset:11776
  s_waitcnt lgkmcnt(0)
  v_smfmac_f32_16x16x64_bf16 v[20:23], v[12:15], v[176:183], v74
  v_smfmac_f32_16x16x64_bf16 v[24:27], v[12:15], v[184:191], v74
  v_smfmac_f32_16x16x64_bf16 v[28:31], v[12:15], a[0:7], v74
  v_smfmac_f32_16x16x64_bf16 v[32:35], v[12:15], a[8:15], v74
  ds_read_b128 v[8:11], v76 offset:12800
  s_waitcnt lgkmcnt(0)
  v_smfmac_f32_16x16x64_bf16 v[20:23], v[8:11], v[192:199], v74
  v_smfmac_f32_16x16x64_bf16 v[24:27], v[8:11], v[200:207], v74
  v_smfmac_f32_16x16x64_bf16 v[28:31], v[8:11], a[16:23], v74
  v_smfmac_f32_16x16x64_bf16 v[32:35], v[8:11], a[24:31], v74
  v_add_f32 v20, v20, v22
  v_add_f32 v21, v21, v23
  v_add_f32 v24, v24, v26
  v_cvt_pk_bf16_f32 v22, v20, v24
  s_nop 0
  ds_write_b32 v79, v22 offset:0
  v_add_f32 v25, v25, v27
  v_cvt_pk_bf16_f32 v23, v21, v25
  ds_write_b32 v79, v23 offset:576
  v_add_f32 v28, v28, v30
  v_add_f32 v29, v29, v31
  s_waitcnt lgkmcnt(0)
  s_nop 1
  s_branch Cs0_recok
Cs0_mx:
  s_waitcnt lgkmcnt(0)
  s_barrier
  buffer_load_dwordx4 v[0:3], v76, s[8:11], s58 offen offset:0 sc1
  ds_read_b128 v[20:23], v77 offset:0
  ds_read_b128 v[28:31], v77 offset:256
  buffer_load_dwordx4 v[4:7], v76, s[8:11], s58 offen offset:1024 sc1
  ds_read_b128 v[24:27], v77 offset:128
  ds_read_b128 v[32:35], v77 offset:384
  s_waitcnt vmcnt(1) lgkmcnt(3)
  v_mfma_f32_16x16x32_bf16 v[8:11], v[0:3], v[20:23], 0
  s_waitcnt vmcnt(0) lgkmcnt(1)
  v_mfma_f32_16x16x32_bf16 v[8:11], v[4:7], v[24:27], v[8:11]
  v_mfma_f32_16x16x32_bf16 v[12:15], v[28:31], v[20:23], 0
  s_waitcnt lgkmcnt(0)
  v_mfma_f32_16x16x32_bf16 v[12:15], v[32:35], v[24:27], v[12:15]
  v_add_f32_dpp v8, v10, v8 quad_perm:[2,3,0,1] row_mask:0xf bank_mask:0xf
  v_add_f32_dpp v9, v11, v9 quad_perm:[2,3,0,1] row_mask:0xf bank_mask:0xf
  s_nop 0
  v_mov_b32_dpp v8, v8 quad_perm:[0,1,0,1] row_mask:0xf bank_mask:0xf
  v_mov_b32_dpp v9, v9 quad_perm:[0,1,0,1] row_mask:0xf bank_mask:0xf
  s_nop 1
  v_add_f32_dpp v12, v14, v12 quad_perm:[2,3,0,1] row_mask:0xf bank_mask:0xf
  v_add_f32_dpp v13, v15, v13 quad_perm:[2,3,0,1] row_mask:0xf bank_mask:0xf
  s_nop 0
  v_mov_b32_dpp v12, v12 quad_perm:[0,1,0,1] row_mask:0xf bank_mask:0xf
  v_mov_b32_dpp v13, v13 quad_perm:[0,1,0,1] row_mask:0xf bank_mask:0xf
  v_mul_f32 v12, s69, v12
  ds_write_b32 v78, v8 offset:8704
  v_mul_f32 v13, s69, v13
  ds_write_b32 v78, v9 offset:8768
  s_waitcnt lgkmcnt(0)
  s_barrier
  ds_read_b128 v[36:39], v78 offset:8704
  ds_read_b128 v[40:43], v78 offset:8768
  s_waitcnt lgkmcnt(0)
  s_barrier
  v_max_f32 v16, v36, v37
  v_max3_f32 v16, v16, v38, v39
  v_max3_f32 v16, v16, v40, v41
  v_max3_f32 v16, v16, v42, v43
  v_max3_f32 v16, v16, v12, v13
  v_mov_b32 v17, v16
  s_nop 1
  v_permlane16_swap_b32 v16, v17
  v_max_f32 v16, v16, v17
  v_mov_b32 v17, v16
  s_nop 1
  v_permlane32_swap_b32 v16, v17
  v_max_f32 v16, v16, v17
  v_sub_f32 v36, v36, v16
  v_sub_f32 v37, v37, v16
  v_sub_f32 v38, v38, v16
  v_sub_f32 v39, v39, v16
  v_sub_f32 v40, v40, v16
  v_sub_f32 v41, v41, v16
  v_sub_f32 v42, v42, v16
  v_sub_f32 v43, v43, v16
  v_sub_f32 v12, v12, v16
  v_sub_f32 v13, v13, v16
  v_exp_f32 v36, v36
  v_exp_f32 v37, v37
  v_exp_f32 v38, v38
  v_exp_f32 v39, v39
  v_exp_f32 v40, v40
  v_exp_f32 v41, v41
  v_exp_f32 v42, v42
  v_exp_f32 v43, v43
  v_exp_f32 v12, v12
  v_exp_f32 v13, v13
  v_cvt_pk_bf16_f32 v32, v36, v40
  v_cvt_pk_bf16_f32 v33, v37, v41
  v_cvt_pk_bf16_f32 v34, v38, v42
  v_cvt_pk_bf16_f32 v35, v39, v43
  v_cvt_pk_bf16_f32 v28, v12, v13
  v_cvt_pk_bf16_f32 v31, v12, v13
  v_mov_b32 v29, 0
  v_mov_b32 v30, 0
  v_mov_b32 v68, 0x3f803f80
  v_mov_b32 v69, 0x3f803f80
  v_mov_b32 v70, 0x3f803f80
  v_mov_b32 v71, 0x3f803f80
  s_nop 1
  v_mfma_f32_16x16x32_bf16 v[8:11], v[32:35], v[68:71], 0
  v_mfma_f32_16x16x32_bf16 v[0:3], v[32:35], v[52:55], 0
  v_mfma_f32_16x16x32_bf16 v[4:7], v[32:35], v[56:59], 0
  v_mfma_f32_16x16x16_bf16 v[8:11], v[28:29], v[68:69], v[8:11]
  v_mfma_f32_16x16x16_bf16 v[0:3], v[28:29], v[72:73], v[0:3]
  v_mfma_f32_16x16x16_bf16 v[4:7], v[30:31], v[72:73], v[4:7]
  ds_read_b128 v[68:71], v76 offset:13824
  v_rcp_f32 v10, v8
  v_rcp_f32 v11, v9
  v_mul_f32 v0, v10, v0
  v_mul_f32 v1, v11, v1
  s_nop 0
  v_mul_f32 v4, v10, v4
  v_mul_f32 v5, v11, v5
  v_cvt_pk_bf16_f32 v2, v0, v4
  ds_write_b32 v79, v2 offset:8704
  v_cvt_pk_bf16_f32 v3, v1, v5
  ds_write_b32 v79, v3 offset:9280
  v_mov_b64 v[16:17], 0
  v_mov_b64 v[18:19], 0
  v_mov_b64 v[20:21], 0
  v_mov_b64 v[22:23], 0
  v_mov_b64 v[24:25], 0
  v_mov_b64 v[26:27], 0
  s_branch Cs0_mxok
Cs0_last:
  s_waitcnt lgkmcnt(0)
  ds_read_b64 v[16:17], v77 offset:256
  v_mov_b64 v[18:19], v[72:73]
  s_add_u32 s68, s68, 655360
  s_waitcnt lgkmcnt(0)
  buffer_store_dwordx4 v[16:19], v76, s[8:11], s68 offen sc1
  s_branch L_cexit
L_w5:
  v_mov_b64 v[20:21], 0
  v_mov_b64 v[22:23], 0
  v_mov_b64 v[24:25], 0
  v_mov_b64 v[26:27], 0
  v_mov_b64 v[28:29], 0
  v_mov_b64 v[30:31], 0
  v_mov_b64 v[32:33], 0
  v_mov_b64 v[34:35], 0
  s_mov_b32 s78, 0x3f803f80
  s_mov_b32 s79, s78
  s_mov_b32 s65, 360448
  s_mov_b32 m0, 15872
  v_lshlrev_b32 v73, 2, v76
  v_mov_b32 v72, 0
  ds_read_b128 v[60:63], v76 offset:20480
  ds_read_b128 v[64:67], v76 offset:21504
  ds_read_b128 v[44:47], v76 offset:22528
  ds_read_b128 v[48:51], v76 offset:23552
  ds_read_b128 v[36:39], v76 offset:36864
  ds_read_b128 v[40:43], v76 offset:37888
  ds_read_b128 v[0:3], v76 offset:4608
  ds_read_b128 v[4:7], v76 offset:5632
  s_branch Cs1_top2
.p2align 6
Cs1_h2:
  v_lshlrev_b32 v73, 2, v76
  s_nop 15
  s_nop 3
  buffer_load_dwordx4 v[52:55], v76, s[8:11], s65 offen offset:2048 sc1
  s_nop 15
  s_nop 1
  buffer_load_dwordx4 v[52:55], v76, s[8:11], s65 offen offset:2048 sc1
  s_nop 15
  s_nop 1
  buffer_load_dwordx4 v[52:55], v76, s[8:11], s65 offen offset:2048 sc1
  s_waitcnt vmcnt(5)
  ds_read_b128 v[60:63], v76 offset:20480
  ds_read_b128 v[64:67], v76 offset:21504
  ds_read_b128 v[44:47], v76 offset:22528
  ds_read_b128 v[48:51], v76 offset:23552
  ds_read_b128 v[36:39], v76 offset:36864
  ds_read_b128 v[40:43], v76 offset:37888
  s_waitcnt vmcnt(2)
  v_max3_u32 v72, v52, v53, v54
  v_max_u32 v72, v72, v55
  ds_write_b128 v76, v[52:55] offset:6656
  v_cmp_eq_u32 vcc, -1, v72
  s_cbranch_vccnz Cs1_h2r
Cs1_h2w:
  s_waitcnt lgkmcnt(0)
  s_barrier
  ds_read_b128 v[0:3], v76 offset:4608
  ds_read_b128 v[4:7], v76 offset:5632
Cs1_top2:
  ds_read_b128 v[8:11], v76 offset:6656
  s_waitcnt lgkmcnt(2)
  v_smfmac_f32_16x16x64_bf16 v[20:23], v[0:3], v[60:67], v74
  ds_read_b128 v[60:63], v76 offset:38912
  v_smfmac_f32_16x16x64_bf16 v[24:27], v[0:3], v[44:51], v74
  buffer_load_dwordx4 v[44:47], v76, s[8:11], s58 offen offset:0 sc1
  ds_read_b128 v[64:67], v76 offset:39936
  s_waitcnt lgkmcnt(3)
  v_smfmac_f32_16x16x64_bf16 v[20:23], v[4:7], v[80:87], v74
  buffer_load_dwordx4 v[48:51], v76, s[8:11], s58 offen offset:1024 sc1
  v_smfmac_f32_16x16x64_bf16 v[28:31], v[0:3], v[36:43], v74
  buffer_load_dwordx4 v[52:55], v76, s[8:11], s59 offen offset:0 sc1
  ds_read_b128 v[36:39], v76 offset:53248
  v_smfmac_f32_16x16x64_bf16 v[24:27], v[4:7], v[88:95], v74
  buffer_load_dwordx4 v[56:59], v76, s[8:11], s59 offen offset:1024 sc1
  ds_read_b128 v[40:43], v76 offset:54272
  v_smfmac_f32_16x16x64_bf16 v[28:31], v[4:7], v[208:215], v74
  ds_read_b128 v[12:15], v76 offset:7680
  s_waitcnt lgkmcnt(5)
  v_smfmac_f32_16x16x64_bf16 v[32:35], v[4:7], v[216:223], v74
  buffer_store_dwordx4 v[16:19], v76, s[8:11], s68 offen sc1
  s_waitcnt lgkmcnt(3)
  v_smfmac_f32_16x16x64_bf16 v[32:35], v[0:3], v[60:67], v74
  buffer_load_dword v73, s[8:11], s70 offen  lds
  v_smfmac_f32_16x16x64_bf16 v[20:23], v[8:11], v[96:103], v74
  ds_read_b128 v[60:63], v76 offset:55296
  v_smfmac_f32_16x16x64_bf16 v[24:27], v[8:11], v[104:111], v74
  ds_read_b128 v[64:67], v76 offset:56320
  s_waitcnt lgkmcnt(3)
  v_smfmac_f32_16x16x64_bf16 v[28:31], v[8:11], v[36:43], v74
  ds_read_b128 v[36:39], v75 offset:4096
  s_waitcnt lgkmcnt(3)
  v_smfmac_f32_16x16x64_bf16 v[20:23], v[12:15], v[112:119], v74
  ds_read_b128 v[40:43], v75 offset:5120
  v_smfmac_f32_16x16x64_bf16 v[24:27], v[12:15], v[120:127], v74
  s_barrier
  ds_read_b128 v[0:3], v76 offset:8704
  v_smfmac_f32_16x16x64_bf16 v[28:31], v[12:15], v[224:231], v74
  ds_read_b128 v[4:7], v76 offset:9728
  v_smfmac_f32_16x16x64_bf16 v[32:35], v[12:15], v[232:239], v74
  s_waitcnt lgkmcnt(4)
  v_smfmac_f32_16x16x64_bf16 v[32:35], v[8:11], v[60:67], v74
  ds_read_b128 v[60:63], v75 offset:6144
  s_waitcnt lgkmcnt(2)
  v_smfmac_f32_16x16x64_bf16 v[20:23], v[0:3], v[128:135], v74
  ds_read_b128 v[16:19], v76 offset:10752
  v_smfmac_f32_16x16x64_bf16 v[24:27], v[0:3], v[136:143], v74
  ds_read_b128 v[64:67], v75 offset:7168
  v_smfmac_f32_16x16x64_bf16 v[28:31], v[0:3], v[36:43], v74
  ds_read_b128 v[36:39], v75 offset:20480
  s_waitcnt lgkmcnt(4)
  v_smfmac_f32_16x16x64_bf16 v[20:23], v[4:7], v[144:151], v74
  ds_read_b128 v[12:15], v76 offset:11776
  v_smfmac_f32_16x16x64_bf16 v[24:27], v[4:7], v[152:159], v74
  ds_read_b128 v[40:43], v75 offset:21504
  s_waitcnt lgkmcnt(4)
  v_smfmac_f32_16x16x64_bf16 v[20:23], v[16:19], v[160:167], v74
  ds_read_b128 v[8:11], v76 offset:12800
  s_waitcnt lgkmcnt(4)
  v_smfmac_f32_16x16x64_bf16 v[32:35], v[0:3], v[60:67], v74
  ds_read_b128 v[60:63], v75 offset:22528
  v_mov_b64 v[68:69], s[78:79]
  v_smfmac_f32_16x16x64_bf16 v[24:27], v[16:19], v[168:175], v74
  ds_read_b128 v[64:67], v75 offset:23552
  s_waitcnt lgkmcnt(4)
  v_smfmac_f32_16x16x64_bf16 v[20:23], v[12:15], v[176:183], v74
  s_waitcnt lgkmcnt(3)
  v_mov_b64 v[70:71], s[78:79]
  v_smfmac_f32_16x16x64_bf16 v[28:31], v[4:7], v[36:43], v74
  s_waitcnt lgkmcnt(2)
  v_mov_b64 v[36:37], 0
  v_smfmac_f32_16x16x64_bf16 v[20:23], v[8:11], v[192:199], v74
  v_mov_b64 v[38:39], 0
  v_smfmac_f32_16x16x64_bf16 v[24:27], v[12:15], v[184:191], v74
  v_mov_b64 v[40:41], 0
  v_smfmac_f32_16x16x64_bf16 v[24:27], v[8:11], v[200:207], v74
  s_waitcnt lgkmcnt(0)
  v_add_f32 v20, v20, v22
  v_smfmac_f32_16x16x64_bf16 v[32:35], v[4:7], v[60:67], v74
  v_add_f32 v21, v21, v23
  v_smfmac_f32_16x16x64_bf16 v[28:31], v[16:19], v[240:247], v74
  v_add_f32 v24, v24, v26
  v_cvt_pk_bf16_f32 v22, v20, v24
  v_smfmac_f32_16x16x64_bf16 v[28:31], v[12:15], a[0:7], v74
  ds_write_b32 v79, v22 offset:0
  v_add_f32 v25, v25, v27
  v_cvt_pk_bf16_f32 v23, v21, v25
  v_smfmac_f32_16x16x64_bf16 v[28:31], v[8:11], a[16:23], v74
  ds_write_b32 v79, v23 offset:576
  v_cmp_u_f32 vcc, v20, v21
  v_smfmac_f32_16x16x64_bf16 v[32:35], v[16:19], v[248:255], v74
  v_mov_b64 v[42:43], 0
  v_smfmac_f32_16x16x64_bf16 v[32:35], v[12:15], a[8:15], v74
  v_add_f32 v28, v28, v30
  v_add_f32 v29, v29, v31
  v_smfmac_f32_16x16x64_bf16 v[32:35], v[8:11], a[24:31], v74
  s_cbranch_vccnz Cs1_rec
Cs1_recok:
  v_smfmac_f32_16x16x64_bf16 v[36:39], v[16:19], a[128:135], v74
  s_waitcnt lgkmcnt(0)
  s_barrier
  ds_read_b128 v[60:63], v77
  v_smfmac_f32_16x16x64_bf16 v[40:43], v[16:19], a[136:143], v74
  ds_read_b128 v[64:67], v77 offset:128
  v_add_f32 v32, v32, v34
  v_cvt_pk_bf16_f32 v30, v28, v32
  v_smfmac_f32_16x16x64_bf16 v[36:39], v[0:3], a[96:103], v74
  ds_write_b32 v79, v30 offset:256
  v_add_f32 v33, v33, v35
  v_cvt_pk_bf16_f32 v31, v29, v33
  v_smfmac_f32_16x16x64_bf16 v[40:43], v[0:3], a[104:111], v74
  ds_write_b32 v79, v31 offset:832
  v_xor_b32 v75, 0x8000, v75
  v_smfmac_f32_16x16x64_bf16 v[36:39], v[4:7], a[112:119], v74
  ds_read_b128 v[0:3], v76 offset:4608
  v_mov_b32 v29, 0
  v_smfmac_f32_16x16x64_bf16 v[40:43], v[4:7], a[120:127], v74
  s_waitcnt vmcnt(4) lgkmcnt(3)
  v_mov_b32 v30, 0
  v_mfma_f32_16x16x32_bf16 v[44:47], v[44:47], v[60:63], 0
  ds_read_b128 v[4:7], v76 offset:5632
  s_waitcnt lgkmcnt(2)
  v_mfma_f32_16x16x32_bf16 v[44:47], v[48:51], v[64:67], v[44:47]
  s_barrier
  v_smfmac_f32_16x16x64_bf16 v[36:39], v[8:11], a[160:167], v74
  ds_read_b128 v[20:23], v77 offset:256
  ds_read_b128 v[24:27], v77 offset:384
  v_smfmac_f32_16x16x64_bf16 v[40:43], v[8:11], a[168:175], v74
  ds_read_b128 v[8:11], v76 offset:6656
  v_add_f32_dpp v72, v46, v44 quad_perm:[2,3,0,1] row_mask:0xf bank_mask:0xf
  v_add_f32_dpp v73, v47, v45 quad_perm:[2,3,0,1] row_mask:0xf bank_mask:0xf
  v_smfmac_f32_16x16x64_bf16 v[36:39], v[12:15], a[144:151], v74
  s_waitcnt lgkmcnt(4)
  v_exp_f32_dpp v72, v72 quad_perm:[0,1,0,1] row_mask:0xf bank_mask:0xf
  v_smfmac_f32_16x16x64_bf16 v[40:43], v[12:15], a[152:159], v74
  ds_read_b128 v[12:15], v76 offset:7680
  v_exp_f32_dpp v73, v73 quad_perm:[0,1,0,1] row_mask:0xf bank_mask:0xf
  v_smfmac_f32_16x16x64_bf16 v[36:39], v[0:3], a[32:39], v74
  s_waitcnt lgkmcnt(2)
  v_cvt_pk_bf16_f32 v72, v72, v73
  v_mfma_f32_16x16x32_bf16 v[20:23], v[20:23], v[60:63], 0
  ds_write_b32 v78, v72 offset:516
  v_mov_b64 v[16:17], 0
  v_mfma_f32_16x16x32_bf16 v[20:23], v[24:27], v[64:67], v[20:23]
  ds_read_b128 v[44:47], v75 offset:20480
  v_mov_b64 v[18:19], 0
  v_smfmac_f32_16x16x64_bf16 v[40:43], v[0:3], a[40:47], v74
  ds_read_b128 v[48:51], v75 offset:21504
  s_waitcnt lgkmcnt(4)
  v_smfmac_f32_16x16x64_bf16 v[36:39], v[4:7], a[48:55], v74
  v_add_f32_dpp v24, v22, v20 quad_perm:[2,3,0,1] row_mask:0xf bank_mask:0xf
  v_add_f32_dpp v25, v23, v21 quad_perm:[2,3,0,1] row_mask:0xf bank_mask:0xf
  v_smfmac_f32_16x16x64_bf16 v[36:39], v[8:11], a[64:71], v74
  s_waitcnt lgkmcnt(2)
  s_barrier
  ds_read_b128 v[32:35], v78 offset:512
  v_smfmac_f32_16x16x64_bf16 v[36:39], v[12:15], a[80:87], v74
  ds_read_b128 v[60:63], v75 offset:22528
  v_mul_f32 v24, s69, v24
  v_smfmac_f32_16x16x64_bf16 v[40:43], v[4:7], a[56:63], v74
  ds_read_b128 v[64:67], v75 offset:23552
  v_mul_f32 v25, s69, v25
  v_smfmac_f32_16x16x64_bf16 v[40:43], v[8:11], a[72:79], v74
  v_exp_f32_dpp v24, v24 quad_perm:[0,1,0,1] row_mask:0xf bank_mask:0xf
  v_smfmac_f32_16x16x64_bf16 v[40:43], v[12:15], a[88:95], v74
  s_waitcnt vmcnt(2) lgkmcnt(2)
  v_exp_f32_dpp v25, v25 quad_perm:[0,1,0,1] row_mask:0xf bank_mask:0xf
  v_mfma_f32_16x16x32_bf16 v[8:11], v[32:35], v[68:71], 0
  v_add_f32 v36, v36, v38
  v_add_f32 v37, v37, v39
  v_mfma_f32_16x16x32_bf16 v[0:3], v[32:35], v[52:55], 0
  v_add_f32 v40, v40, v42
  v_add_f32 v41, v41, v43
  v_mfma_f32_16x16x32_bf16 v[4:7], v[32:35], v[56:59], 0
  v_cvt_pk_bf16_f32 v28, v24, v25
  v_cvt_pk_bf16_f32 v72, v36, v37
  v_cvt_pk_bf16_f32 v73, v40, v41
  v_mfma_f32_16x16x16_bf16 v[8:11], v[28:29], v[68:69], v[8:11]
  v_cvt_pk_bf16_f32 v31, v24, v25
  v_mov_b64 v[20:21], 0
  v_mfma_f32_16x16x16_bf16 v[0:3], v[28:29], v[72:73], v[0:3]
  ds_read_b128 v[68:71], v76 offset:13824
  v_mov_b64 v[22:23], 0
  v_mfma_f32_16x16x16_bf16 v[4:7], v[30:31], v[72:73], v[4:7]
  v_rcp_f32 v10, v8
  v_rcp_f32 v11, v9
  v_mul_f32 v0, v10, v0
  v_mul_f32 v1, v11, v1
  s_nop 0
  v_mul_f32 v4, v10, v4
  v_mul_f32 v5, v11, v5
  v_cvt_pk_bf16_f32 v2, v0, v4
  ds_write_b32 v79, v2 offset:8704
  v_cvt_pk_bf16_f32 v3, v1, v5
  ds_write_b32 v79, v3 offset:9280
  v_max3_f32 v8, v8, v9, v10
  v_max_f32 v8, v8, v11
  v_cmp_le_f32 vcc, 1317011456, v8
  v_mov_b64 v[24:25], 0
  v_mov_b64 v[26:27], 0
  s_cbranch_vccnz Cs1_mx
Cs1_mxok:
  s_waitcnt lgkmcnt(0)
  s_barrier
  ds_read_b128 v[0:3], v78 offset:8704
  ds_read_b128 v[4:7], v78 offset:8768
  ds_read_b128 v[8:11], v78 offset:8832
  ds_read_b128 v[12:15], v78 offset:8896
  s_cmp_eq_u32 s66, 63
  s_cbranch_scc1 Cs1_last
  s_waitcnt lgkmcnt(3)
  v_smfmac_f32_16x16x64_bf16 v[16:19], v[0:3], v[44:51], v74
  ds_read_b128 v[52:55], v75 offset:36864
  s_waitcnt lgkmcnt(3)
  v_smfmac_f32_16x16x64_bf16 v[16:19], v[4:7], v[60:67], v74
  ds_read_b128 v[56:59], v75 offset:37888
  s_waitcnt lgkmcnt(3)
  v_smfmac_f32_16x16x64_bf16 v[16:19], v[8:11], a[176:183], v74
  ds_read_b128 v[36:39], v75 offset:38912
  s_waitcnt lgkmcnt(3)
  v_smfmac_f32_16x16x64_bf16 v[16:19], v[12:15], a[184:191], v74
  ds_read_b128 v[40:43], v75 offset:39936
  ds_read_b128 v[44:47], v75 offset:53248
  v_smfmac_f32_16x16x64_bf16 v[20:23], v[0:3], a[192:199], v74
  ds_read_b128 v[48:51], v75 offset:54272
  ds_read_b128 v[60:63], v75 offset:55296
  v_smfmac_f32_16x16x64_bf16 v[20:23], v[4:7], a[200:207], v74
  ds_read_b128 v[64:67], v75 offset:56320
  s_waitcnt lgkmcnt(6)
  v_cvt_pk_bf16_f32 v16, v16, v17
  v_cvt_pk_bf16_f32 v17, v18, v19
  v_bfi_b32 v16, 1, s72, v16
  v_smfmac_f32_16x16x64_bf16 v[20:23], v[8:11], v[52:59], v74
  buffer_store_dwordx2 v[16:17], v68, s[8:11], s73 offen sc1
  s_waitcnt lgkmcnt(4)
  v_smfmac_f32_16x16x64_bf16 v[20:23], v[12:15], v[36:43], v74
  v_mov_b64 v[32:33], 0
  v_smfmac_f32_16x16x64_bf16 v[24:27], v[0:3], a[208:215], v74
  v_mov_b64 v[34:35], 0
  v_smfmac_f32_16x16x64_bf16 v[24:27], v[4:7], a[216:223], v74
  s_waitcnt lgkmcnt(2)
  v_cvt_pk_bf16_f32 v20, v20, v21
  v_cvt_pk_bf16_f32 v21, v22, v23
  v_bfi_b32 v20, 1, s72, v20
  v_smfmac_f32_16x16x64_bf16 v[24:27], v[8:11], v[44:51], v74
  buffer_store_dwordx2 v[20:21], v68, s[8:11], s74 offen sc1
  s_waitcnt lgkmcnt(0)
  v_smfmac_f32_16x16x64_bf16 v[24:27], v[12:15], v[60:67], v74
  v_smfmac_f32_16x16x64_bf16 v[32:35], v[0:3], a[224:231], v74
  v_smfmac_f32_16x16x64_bf16 v[32:35], v[4:7], a[232:239], v74
  v_cvt_pk_bf16_f32 v24, v24, v25
  v_cvt_pk_bf16_f32 v25, v26, v27
  v_bfi_b32 v24, 1, s72, v24
  v_smfmac_f32_16x16x64_bf16 v[32:35], v[8:11], a[240:247], v74
  s_nop 1
  buffer_store_dwordx2 v[24:25], v68, s[8:11], s75 offen sc1
  v_smfmac_f32_16x16x64_bf16 v[32:35], v[12:15], a[248:255], v74
  ds_read_b128 v[0:3], v76 offset:14848
  ds_read_b64 v[16:17], v77 offset:264
  v_mov_b64 v[18:19], v[72:73]
  v_xor_b32 v75, 0x8000, v75
  s_nop 3
  v_cvt_pk_bf16_f32 v32, v32, v33
  v_cvt_pk_bf16_f32 v33, v34, v35
  v_bfi_b32 v32, 1, s72, v32
  buffer_store_dwordx2 v[32:33], v68, s[8:11], s76 offen sc1
  v_mov_b64 v[20:21], 0
  v_mov_b64 v[22:23], 0
  v_mov_b64 v[24:25], 0
  v_mov_b64 v[26:27], 0
  v_mov_b64 v[28:29], 0
  v_mov_b64 v[30:31], 0
  v_mov_b64 v[32:33], 0
  v_mov_b64 v[34:35], 0
  s_add_u32 s58, s58, 655360
  s_add_u32 s59, s59, 655360
  s_add_u32 s70, s70, 655360
  s_add_u32 s68, s68, 655360
  s_add_u32 s66, s66, 1
  s_xor_b32 s64, s64, 16384
  s_xor_b32 s65, s65, 16384
  s_nop 15
  s_nop 15
  s_nop 7
  buffer_load_dwordx4 v[52:55], v76, s[8:11], s60 offen offset:0 sc1
  buffer_load_dwordx4 v[56:59], v76, s[8:11], s60 offen offset:1024 sc1
  s_nop 15
  s_nop 11
  buffer_load_dwordx4 v[36:39], v76, s[8:11], s60 offen offset:0 sc1
  buffer_load_dwordx4 v[40:43], v76, s[8:11], s60 offen offset:1024 sc1
  s_waitcnt lgkmcnt(0)
  s_waitcnt vmcnt(3)
  v_mfma_f32_16x16x32_bf16 v[4:7], v[0:3], v[52:55], 0
  v_bitop3_b32 v72, v52, v54, s72 bitop3:0x7e
  s_waitcnt vmcnt(2)
  v_mfma_f32_16x16x32_bf16 v[4:7], v[0:3], v[56:59], v[4:7]
  v_bitop3_b32 v73, v56, v58, s72 bitop3:0x7e
  v_bitop3_b32 v72, v72, v73, 1 bitop3:0xa8
  v_cmp_ne_u32 vcc, 0, v72
  s_nop 0
  s_cmp_eq_u64 vcc, 0
  s_cselect_b32 s54, s62, 268435456
  s_nop 0
  v_add_f32_dpp v4, v4, v4 row_ror:4 row_mask:0xf bank_mask:0xf
  v_add_f32_dpp v5, v5, v5 row_ror:4 row_mask:0xf bank_mask:0xf
  s_nop 0
  v_add_f32_dpp v4, v4, v4 row_ror:8 row_mask:0xf bank_mask:0xf
  v_add_f32_dpp v5, v5, v5 row_ror:8 row_mask:0xf bank_mask:0xf
  v_cvt_pk_bf16_f32 v4, v4, v5
  buffer_store_dword v4, v69, s[8:11], s54 offen sc1
  s_cbranch_vccnz Cs1_h1r
  s_xor_b32 s62, s62, 16384
  buffer_store_dword v71, v69, s[8:11], s62 offen sc1
  s_xor_b32 s72, s72, 1
  s_branch Cs1_h2
Cs1_h1r:
  s_mov_b64 exec, vcc
  buffer_load_dwordx4 v[52:55], v76, s[8:11], s60 offen offset:0 sc1
  buffer_load_dwordx4 v[56:59], v76, s[8:11], s60 offen offset:1024 sc1
  s_mov_b64 exec, -1
  s_add_u32 s67, s67, 1
  s_waitcnt vmcnt(4)
  v_mfma_f32_16x16x32_bf16 v[4:7], v[0:3], v[36:39], 0
  v_bitop3_b32 v72, v36, v38, s72 bitop3:0x7e
  s_waitcnt vmcnt(3)
  v_mfma_f32_16x16x32_bf16 v[4:7], v[0:3], v[40:43], v[4:7]
  v_bitop3_b32 v73, v40, v42, s72 bitop3:0x7e
  v_bitop3_b32 v72, v72, v73, 1 bitop3:0xa8
  v_cmp_ne_u32 vcc, 0, v72
  s_cbranch_vccz Cs1_h1p
  s_mov_b64 exec, vcc
  buffer_load_dwordx4 v[36:39], v76, s[8:11], s60 offen offset:0 sc1
  buffer_load_dwordx4 v[40:43], v76, s[8:11], s60 offen offset:1024 sc1
  s_mov_b64 exec, -1
  s_add_u32 s67, s67, 1
  s_waitcnt vmcnt(3)
  v_mfma_f32_16x16x32_bf16 v[4:7], v[0:3], v[52:55], 0
  v_bitop3_b32 v72, v52, v54, s72 bitop3:0x7e
  s_waitcnt vmcnt(2)
  v_mfma_f32_16x16x32_bf16 v[4:7], v[0:3], v[56:59], v[4:7]
  v_bitop3_b32 v73, v56, v58, s72 bitop3:0x7e
  v_bitop3_b32 v72, v72, v73, 1 bitop3:0xa8
  v_cmp_ne_u32 vcc, 0, v72
  s_cbranch_vccz Cs1_h1p
Cs1_h1s:
  s_mov_b64 exec, vcc
  buffer_load_dwordx4 v[52:55], v76, s[8:11], s60 offen offset:0 sc1
  buffer_load_dwordx4 v[56:59], v76, s[8:11], s60 offen offset:1024 sc1
  s_mov_b64 exec, -1
  s_add_u32 s67, s67, 1
  s_waitcnt vmcnt(3)
  v_mfma_f32_16x16x32_bf16 v[4:7], v[0:3], v[36:39], 0
  v_bitop3_b32 v72, v36, v38, s72 bitop3:0x7e
  s_waitcnt vmcnt(2)
  v_mfma_f32_16x16x32_bf16 v[4:7], v[0:3], v[40:43], v[4:7]
  v_bitop3_b32 v73, v40, v42, s72 bitop3:0x7e
  v_bitop3_b32 v72, v72, v73, 1 bitop3:0xa8
  v_cmp_ne_u32 vcc, 0, v72
  s_cbranch_vccz Cs1_h1p
  s_mov_b64 exec, vcc
  buffer_load_dwordx4 v[36:39], v76, s[8:11], s60 offen offset:0 sc1
  buffer_load_dwordx4 v[40:43], v76, s[8:11], s60 offen offset:1024 sc1
  s_mov_b64 exec, -1
  s_add_u32 s67, s67, 1
  s_waitcnt vmcnt(3)
  v_mfma_f32_16x16x32_bf16 v[4:7], v[0:3], v[52:55], 0
  v_bitop3_b32 v72, v52, v54, s72 bitop3:0x7e
  s_waitcnt vmcnt(2)
  v_mfma_f32_16x16x32_bf16 v[4:7], v[0:3], v[56:59], v[4:7]
  v_bitop3_b32 v73, v56, v58, s72 bitop3:0x7e
  v_bitop3_b32 v72, v72, v73, 1 bitop3:0xa8
  v_cmp_ne_u32 vcc, 0, v72
  s_cbranch_vccz Cs1_h1p
  s_cmp_lt_u32 s67, 131072
  s_cbranch_scc1 Cs1_h1s
Cs1_h1p:
  s_nop 2
  v_add_f32_dpp v4, v4, v4 row_ror:4 row_mask:0xf bank_mask:0xf
  v_add_f32_dpp v5, v5, v5 row_ror:4 row_mask:0xf bank_mask:0xf
  s_nop 0
  v_add_f32_dpp v4, v4, v4 row_ror:8 row_mask:0xf bank_mask:0xf
  v_add_f32_dpp v5, v5, v5 row_ror:8 row_mask:0xf bank_mask:0xf
  v_cvt_pk_bf16_f32 v4, v4, v5
  buffer_store_dword v4, v69, s[8:11], s62 offen sc1
  s_xor_b32 s62, s62, 16384
  buffer_store_dword v71, v69, s[8:11], s62 offen sc1
  s_xor_b32 s72, s72, 1
  s_branch Cs1_h2
Cs1_h2r:
  s_mov_b64 exec, vcc
  buffer_load_dwordx4 v[52:55], v76, s[8:11], s65 offen offset:2048 sc1
  s_mov_b64 exec, -1
  s_add_u32 s67, s67, 1
  s_waitcnt vmcnt(2)
  v_max3_u32 v72, v52, v53, v54
  v_max_u32 v72, v72, v55
  ds_write_b128 v76, v[52:55] offset:6656
  v_cmp_eq_u32 vcc, -1, v72
  s_cbranch_vccz Cs1_h2w
  s_mov_b64 exec, vcc
  buffer_load_dwordx4 v[52:55], v76, s[8:11], s65 offen offset:2048 sc1
  s_mov_b64 exec, -1
  s_add_u32 s67, s67, 1
  s_waitcnt vmcnt(2)
  v_max3_u32 v72, v52, v53, v54
  v_max_u32 v72, v72, v55
  ds_write_b128 v76, v[52:55] offset:6656
  v_cmp_eq_u32 vcc, -1, v72
  s_cbranch_vccz Cs1_h2w
  s_mov_b64 exec, vcc
  buffer_load_dwordx4 v[52:55], v76, s[8:11], s65 offen offset:2048 sc1
  s_mov_b64 exec, -1
  s_add_u32 s67, s67, 1
  s_waitcnt vmcnt(2)
  v_max3_u32 v72, v52, v53, v54
  v_max_u32 v72, v72, v55
  ds_write_b128 v76, v[52:55] offset:6656
  v_cmp_eq_u32 vcc, -1, v72
  s_cbranch_vccz Cs1_h2w
  s_mov_b64 exec, vcc
  buffer_load_dwordx4 v[52:55], v76, s[8:11], s65 offen offset:2048 sc1
  s_mov_b64 exec, -1
  s_add_u32 s67, s67, 1
  s_waitcnt vmcnt(2)
  v_max3_u32 v72, v52, v53, v54
  v_max_u32 v72, v72, v55
  ds_write_b128 v76, v[52:55] offset:6656
  v_cmp_eq_u32 vcc, -1, v72
  s_cbranch_vccz Cs1_h2w
  s_cmp_lt_u32 s67, 131072
  s_cbranch_scc1 Cs1_h2r
Cs1_h2ok:
  ds_write_b128 v76, v[52:55] offset:6656
  s_branch Cs1_h2w
Cs1_rec:
  s_nop 7
  s_waitcnt vmcnt(0) lgkmcnt(0)
  v_max3_u32 v72, v0, v1, v2
  v_max3_u32 v72, v72, v3, v4
  v_max3_u32 v72, v72, v5, v6
  v_max3_u32 v72, v72, v7, v8
  v_max3_u32 v72, v72, v9, v10
  v_max3_u32 v72, v72, v11, v12
  v_max3_u32 v72, v72, v13, v14
  v_max3_u32 v72, v72, v15, v16
  v_max3_u32 v72, v72, v17, v18
  v_max_u32 v72, v72, v19
  v_cmp_eq_u32 vcc, -1, v72
  s_cbranch_vccz Cs1_recok
  s_barrier
  v_mov_b64 v[20:21], 0
  v_mov_b64 v[22:23], 0
  v_mov_b64 v[24:25], 0
  v_mov_b64 v[26:27], 0
  v_mov_b64 v[28:29], 0
  v_mov_b64 v[30:31], 0
  v_mov_b64 v[32:33], 0
  v_mov_b64 v[34:35], 0
  s_waitcnt lgkmcnt(0)
  s_barrier
  ds_read_b128 v[0:3], v76 offset:4608
  ds_read_b128 v[60:63], v76 offset:20480
  ds_read_b128 v[64:67], v76 offset:21504
  s_waitcnt lgkmcnt(0)
  v_smfmac_f32_16x16x64_bf16 v[20:23], v[0:3], v[60:67], v74
  ds_read_b128 v[60:63], v76 offset:22528
  ds_read_b128 v[64:67], v76 offset:23552
  s_waitcnt lgkmcnt(0)
  v_smfmac_f32_16x16x64_bf16 v[24:27], v[0:3], v[60:67], v74
  ds_read_b128 v[60:63], v76 offset:36864
  ds_read_b128 v[64:67], v76 offset:37888
  s_waitcnt lgkmcnt(0)
  v_smfmac_f32_16x16x64_bf16 v[28:31], v[0:3], v[60:67], v74
  ds_read_b128 v[60:63], v76 offset:38912
  ds_read_b128 v[64:67], v76 offset:39936
  s_waitcnt lgkmcnt(0)
  v_smfmac_f32_16x16x64_bf16 v[32:35], v[0:3], v[60:67], v74
  ds_read_b128 v[4:7], v76 offset:5632
  s_waitcnt lgkmcnt(0)
  v_smfmac_f32_16x16x64_bf16 v[20:23], v[4:7], v[80:87], v74
  v_smfmac_f32_16x16x64_bf16 v[24:27], v[4:7], v[88:95], v74
  v_smfmac_f32_16x16x64_bf16 v[28:31], v[4:7], v[208:215], v74
  v_smfmac_f32_16x16x64_bf16 v[32:35], v[4:7], v[216:223], v74
  ds_read_b128 v[8:11], v76 offset:6656
  s_waitcnt lgkmcnt(0)
  v_smfmac_f32_16x16x64_bf16 v[20:23], v[8:11], v[96:103], v74
  v_smfmac_f32_16x16x64_bf16 v[24:27], v[8:11], v[104:111], v74
  ds_read_b128 v[60:63], v76 offset:53248
  ds_read_b128 v[64:67], v76 offset:54272
  s_waitcnt lgkmcnt(0)
  v_smfmac_f32_16x16x64_bf16 v[28:31], v[8:11], v[60:67], v74
  ds_read_b128 v[60:63], v76 offset:55296
  ds_read_b128 v[64:67], v76 offset:56320
  s_waitcnt lgkmcnt(0)
  v_smfmac_f32_16x16x64_bf16 v[32:35], v[8:11], v[60:67], v74
  ds_read_b128 v[12:15], v76 offset:7680
  s_waitcnt lgkmcnt(0)
  v_smfmac_f32_16x16x64_bf16 v[20:23], v[12:15], v[112:119], v74
  v_smfmac_f32_16x16x64_bf16 v[24:27], v[12:15], v[120:127], v74
  v_smfmac_f32_16x16x64_bf16 v[28:31], v[12:15], v[224:231], v74
  v_smfmac_f32_16x16x64_bf16 v[32:35], v[12:15], v[232:239], v74
  ds_read_b128 v[0:3], v76 offset:8704
  s_waitcnt lgkmcnt(0)
  v_smfmac_f32_16x16x64_bf16 v[20:23], v[0:3], v[128:135], v74
  v_smfmac_f32_16x16x64_bf16 v[24:27], v[0:3], v[136:143], v74
  ds_read_b128 v[60:63], v75 offset:4096
  ds_read_b128 v[64:67], v75 offset:5120
  s_waitcnt lgkmcnt(0)
  v_smfmac_f32_16x16x64_bf16 v[28:31], v[0:3], v[60:67], v74
  ds_read_b128 v[60:63], v75 offset:6144
  ds_read_b128 v[64:67], v75 offset:7168
  s_waitcnt lgkmcnt(0)
  v_smfmac_f32_16x16x64_bf16 v[32:35], v[0:3], v[60:67], v74
  ds_read_b128 v[4:7], v76 offset:9728
  s_waitcnt lgkmcnt(0)
  v_smfmac_f32_16x16x64_bf16 v[20:23], v[4:7], v[144:151], v74
  v_smfmac_f32_16x16x64_bf16 v[24:27], v[4:7], v[152:159], v74
  ds_read_b128 v[60:63], v75 offset:20480
  ds_read_b128 v[64:67], v75 offset:21504
  s_waitcnt lgkmcnt(0)
  v_smfmac_f32_16x16x64_bf16 v[28:31], v[4:7], v[60:67], v74
  ds_read_b128 v[60:63], v75 offset:22528
  ds_read_b128 v[64:67], v75 offset:23552
  s_waitcnt lgkmcnt(0)
  v_smfmac_f32_16x16x64_bf16 v[32:35], v[4:7], v[60:67], v74
  ds_read_b128 v[16:19], v76 offset:10752
  s_waitcnt lgkmcnt(0)
  v_smfmac_f32_16x16x64_bf16 v[20:23], v[16:19], v[160:167], v74
  v_smfmac_f32_16x16x64_bf16 v[24:27], v[16:19], v[168:175], v74
  v_smfmac_f32_16x16x64_bf16 v[28:31], v[16:19], v[240:247], v74
  v_smfmac_f32_16x16x64_bf16 v[32:35], v[16:19], v[248:255], v74
  ds_read_b128 v[12:15], v76 offset:11776
  s_waitcnt lgkmcnt(0)
  v_smfmac_f32_16x16x64_bf16 v[20:23], v[12:15], v[176:183], v74
  v_smfmac_f32_16x16x64_bf16 v[24:27], v[12:15], v[184:191], v74
  v_smfmac_f32_16x16x64_bf16 v[28:31], v[12:15], a[0:7], v74
  v_smfmac_f32_16x16x64_bf16 v[32:35], v[12:15], a[8:15], v74
  ds_read_b128 v[8:11], v76 offset:12800
  s_waitcnt lgkmcnt(0)
  v_smfmac_f32_16x16x64_bf16 v[20:23], v[8:11], v[192:199], v74
  v_smfmac_f32_16x16x64_bf16 v[24:27], v[8:11], v[200:207], v74
  v_smfmac_f32_16x16x64_bf16 v[28:31], v[8:11], a[16:23], v74
  v_smfmac_f32_16x16x64_bf16 v[32:35], v[8:11], a[24:31], v74
  v_add_f32 v20, v20, v22
  v_add_f32 v21, v21, v23
  v_add_f32 v24, v24, v26
  v_cvt_pk_bf16_f32 v22, v20, v24
  s_nop 0
  ds_write_b32 v79, v22 offset:0
  v_add_f32 v25, v25, v27
  v_cvt_pk_bf16_f32 v23, v21, v25
  ds_write_b32 v79, v23 offset:576
  v_add_f32 v28, v28, v30
  v_add_f32 v29, v29, v31
  s_waitcnt lgkmcnt(0)
  s_nop 1
  s_branch Cs1_recok
Cs1_mx:
  s_waitcnt lgkmcnt(0)
  s_barrier
  buffer_load_dwordx4 v[0:3], v76, s[8:11], s58 offen offset:0 sc1
  ds_read_b128 v[20:23], v77 offset:0
  ds_read_b128 v[28:31], v77 offset:256
  buffer_load_dwordx4 v[4:7], v76, s[8:11], s58 offen offset:1024 sc1
  ds_read_b128 v[24:27], v77 offset:128
  ds_read_b128 v[32:35], v77 offset:384
  s_waitcnt vmcnt(1) lgkmcnt(3)
  v_mfma_f32_16x16x32_bf16 v[8:11], v[0:3], v[20:23], 0
  s_waitcnt vmcnt(0) lgkmcnt(1)
  v_mfma_f32_16x16x32_bf16 v[8:11], v[4:7], v[24:27], v[8:11]
  v_mfma_f32_16x16x32_bf16 v[12:15], v[28:31], v[20:23], 0
  s_waitcnt lgkmcnt(0)
  v_mfma_f32_16x16x32_bf16 v[12:15], v[32:35], v[24:27], v[12:15]
  v_add_f32_dpp v8, v10, v8 quad_perm:[2,3,0,1] row_mask:0xf bank_mask:0xf
  v_add_f32_dpp v9, v11, v9 quad_perm:[2,3,0,1] row_mask:0xf bank_mask:0xf
  s_nop 0
  v_mov_b32_dpp v8, v8 quad_perm:[0,1,0,1] row_mask:0xf bank_mask:0xf
  v_mov_b32_dpp v9, v9 quad_perm:[0,1,0,1] row_mask:0xf bank_mask:0xf
  s_nop 1
  v_add_f32_dpp v12, v14, v12 quad_perm:[2,3,0,1] row_mask:0xf bank_mask:0xf
  v_add_f32_dpp v13, v15, v13 quad_perm:[2,3,0,1] row_mask:0xf bank_mask:0xf
  s_nop 0
  v_mov_b32_dpp v12, v12 quad_perm:[0,1,0,1] row_mask:0xf bank_mask:0xf
  v_mov_b32_dpp v13, v13 quad_perm:[0,1,0,1] row_mask:0xf bank_mask:0xf
  v_mul_f32 v12, s69, v12
  ds_write_b32 v78, v8 offset:8708
  v_mul_f32 v13, s69, v13
  ds_write_b32 v78, v9 offset:8772
  s_waitcnt lgkmcnt(0)
  s_barrier
  ds_read_b128 v[36:39], v78 offset:8704
  ds_read_b128 v[40:43], v78 offset:8768
  s_waitcnt lgkmcnt(0)
  s_barrier
  v_max_f32 v16, v36, v37
  v_max3_f32 v16, v16, v38, v39
  v_max3_f32 v16, v16, v40, v41
  v_max3_f32 v16, v16, v42, v43
  v_max3_f32 v16, v16, v12, v13
  v_mov_b32 v17, v16
  s_nop 1
  v_permlane16_swap_b32 v16, v17
  v_max_f32 v16, v16, v17
  v_mov_b32 v17, v16
  s_nop 1
  v_permlane32_swap_b32 v16, v17
  v_max_f32 v16, v16, v17
  v_sub_f32 v36, v36, v16
  v_sub_f32 v37, v37, v16
  v_sub_f32 v38, v38, v16
  v_sub_f32 v39, v39, v16
  v_sub_f32 v40, v40, v16
  v_sub_f32 v41, v41, v16
  v_sub_f32 v42, v42, v16
  v_sub_f32 v43, v43, v16
  v_sub_f32 v12, v12, v16
  v_sub_f32 v13, v13, v16
  v_exp_f32 v36, v36
  v_exp_f32 v37, v37
  v_exp_f32 v38, v38
  v_exp_f32 v39, v39
  v_exp_f32 v40, v40
  v_exp_f32 v41, v41
  v_exp_f32 v42, v42
  v_exp_f32 v43, v43
  v_exp_f32 v12, v12
  v_exp_f32 v13, v13
  v_cvt_pk_bf16_f32 v32, v36, v40
  v_cvt_pk_bf16_f32 v33, v37, v41
  v_cvt_pk_bf16_f32 v34, v38, v42
  v_cvt_pk_bf16_f32 v35, v39, v43
  v_cvt_pk_bf16_f32 v28, v12, v13
  v_cvt_pk_bf16_f32 v31, v12, v13
  v_mov_b32 v29, 0
  v_mov_b32 v30, 0
  v_mov_b32 v68, 0x3f803f80
  v_mov_b32 v69, 0x3f803f80
  v_mov_b32 v70, 0x3f803f80
  v_mov_b32 v71, 0x3f803f80
  s_nop 1
  v_mfma_f32_16x16x32_bf16 v[8:11], v[32:35], v[68:71], 0
  v_mfma_f32_16x16x32_bf16 v[0:3], v[32:35], v[52:55], 0
  v_mfma_f32_16x16x32_bf16 v[4:7], v[32:35], v[56:59], 0
  v_mfma_f32_16x16x16_bf16 v[8:11], v[28:29], v[68:69], v[8:11]
  v_mfma_f32_16x16x16_bf16 v[0:3], v[28:29], v[72:73], v[0:3]
  v_mfma_f32_16x16x16_bf16 v[4:7], v[30:31], v[72:73], v[4:7]
  ds_read_b128 v[68:71], v76 offset:13824
  v_rcp_f32 v10, v8
  v_rcp_f32 v11, v9
  v_mul_f32 v0, v10, v0
  v_mul_f32 v1, v11, v1
  s_nop 0
  v_mul_f32 v4, v10, v4
  v_mul_f32 v5, v11, v5
  v_cvt_pk_bf16_f32 v2, v0, v4
  ds_write_b32 v79, v2 offset:8704
  v_cvt_pk_bf16_f32 v3, v1, v5
  ds_write_b32 v79, v3 offset:9280
  v_mov_b64 v[16:17], 0
  v_mov_b64 v[18:19], 0
  v_mov_b64 v[20:21], 0
  v_mov_b64 v[22:23], 0
  v_mov_b64 v[24:25], 0
  v_mov_b64 v[26:27], 0
  s_branch Cs1_mxok
Cs1_last:
  s_waitcnt lgkmcnt(0)
  ds_read_b64 v[16:17], v77 offset:264
  v_mov_b64 v[18:19], v[72:73]
  s_add_u32 s68, s68, 655360
  s_waitcnt lgkmcnt(0)
  buffer_store_dwordx4 v[16:19], v76, s[8:11], s68 offen sc1
  s_branch L_cexit
L_w6:
  v_mov_b64 v[20:21], 0
  v_mov_b64 v[22:23], 0
  v_mov_b64 v[24:25], 0
  v_mov_b64 v[26:27], 0
  v_mov_b64 v[28:29], 0
  v_mov_b64 v[30:31], 0
  v_mov_b64 v[32:33], 0
  v_mov_b64 v[34:35], 0
  s_mov_b32 s78, 0x3f803f80
  s_mov_b32 s79, s78
  s_mov_b32 s65, 360448
  s_mov_b32 m0, 15872
  v_lshlrev_b32 v73, 2, v76
  v_mov_b32 v72, 0
  ds_read_b128 v[60:63], v76 offset:24576
  ds_read_b128 v[64:67], v76 offset:25600
  ds_read_b128 v[44:47], v76 offset:26624
  ds_read_b128 v[48:51], v76 offset:27648
  ds_read_b128 v[36:39], v76 offset:40960
  ds_read_b128 v[40:43], v76 offset:41984
  ds_read_b128 v[0:3], v76 offset:4608
  ds_read_b128 v[4:7], v76 offset:5632
  s_branch Cs2_top2
.p2align 6
Cs2_h2:
  v_lshlrev_b32 v73, 2, v76
  s_mov_b32 m0, 8704
  s_nop 3
  buffer_load_dwordx4 v[52:55], v76, s[8:11], s65 offen offset:3072 sc1
  s_nop 15
  s_nop 1
  buffer_load_dwordx4 v[52:55], v76, s[8:11], s65 offen offset:3072 sc1
  s_nop 15
  s_nop 1
  buffer_load_dwordx4 v[52:55], v76, s[8:11], s65 offen offset:3072 sc1
  s_waitcnt vmcnt(5)
  ds_read_b128 v[60:63], v76 offset:24576
  ds_read_b128 v[64:67], v76 offset:25600
  ds_read_b128 v[44:47], v76 offset:26624
  ds_read_b128 v[48:51], v76 offset:27648
  ds_read_b128 v[36:39], v76 offset:40960
  ds_read_b128 v[40:43], v76 offset:41984
  s_waitcnt vmcnt(2)
  v_max3_u32 v72, v52, v53, v54
  v_max_u32 v72, v72, v55
  ds_write_b128 v76, v[52:55] offset:7680
  v_cmp_eq_u32 vcc, -1, v72
  s_cbranch_vccnz Cs2_h2r
Cs2_h2w:
  s_waitcnt lgkmcnt(0)
  s_barrier
  ds_read_b128 v[0:3], v76 offset:4608
  ds_read_b128 v[4:7], v76 offset:5632
  buffer_load_dwordx4 v76, s[8:11], s64 offen offset:0 sc1 lds
  buffer_load_dwordx4 v76, s[8:11], s64 offen offset:1024 sc1 lds
Cs2_top2:
  ds_read_b128 v[8:11], v76 offset:6656
  s_mov_b32 m0, 15872
  s_waitcnt lgkmcnt(2)
  v_smfmac_f32_16x16x64_bf16 v[20:23], v[0:3], v[60:67], v74
  ds_read_b128 v[60:63], v76 offset:43008
  v_smfmac_f32_16x16x64_bf16 v[24:27], v[0:3], v[44:51], v74
  buffer_load_dwordx4 v[44:47], v76, s[8:11], s58 offen offset:0 sc1
  ds_read_b128 v[64:67], v76 offset:44032
  s_waitcnt lgkmcnt(3)
  v_smfmac_f32_16x16x64_bf16 v[20:23], v[4:7], v[80:87], v74
  buffer_load_dwordx4 v[48:51], v76, s[8:11], s58 offen offset:1024 sc1
  v_smfmac_f32_16x16x64_bf16 v[28:31], v[0:3], v[36:43], v74
  buffer_load_dwordx4 v[52:55], v76, s[8:11], s59 offen offset:0 sc1
  ds_read_b128 v[36:39], v76 offset:57344
  v_smfmac_f32_16x16x64_bf16 v[24:27], v[4:7], v[88:95], v74
  buffer_load_dwordx4 v[56:59], v76, s[8:11], s59 offen offset:1024 sc1
  ds_read_b128 v[40:43], v76 offset:58368
  v_smfmac_f32_16x16x64_bf16 v[28:31], v[4:7], v[208:215], v74
  ds_read_b128 v[12:15], v76 offset:7680
  s_waitcnt lgkmcnt(5)
  v_smfmac_f32_16x16x64_bf16 v[32:35], v[4:7], v[216:223], v74
  buffer_store_dwordx4 v[16:19], v76, s[8:11], s68 offen sc1
  s_waitcnt lgkmcnt(3)
  v_smfmac_f32_16x16x64_bf16 v[32:35], v[0:3], v[60:67], v74
  buffer_load_dword v73, s[8:11], s70 offen  lds
  v_smfmac_f32_16x16x64_bf16 v[20:23], v[8:11], v[96:103], v74
  ds_read_b128 v[60:63], v76 offset:59392
  v_smfmac_f32_16x16x64_bf16 v[24:27], v[8:11], v[104:111], v74
  ds_read_b128 v[64:67], v76 offset:60416
  s_waitcnt lgkmcnt(3)
  v_smfmac_f32_16x16x64_bf16 v[28:31], v[8:11], v[36:43], v74
  ds_read_b128 v[36:39], v75 offset:8192
  s_waitcnt lgkmcnt(3)
  v_smfmac_f32_16x16x64_bf16 v[20:23], v[12:15], v[112:119], v74
  s_waitcnt vmcnt(6)
  ds_read_b128 v[40:43], v75 offset:9216
  v_smfmac_f32_16x16x64_bf16 v[24:27], v[12:15], v[120:127], v74
  s_barrier
  ds_read_b128 v[0:3], v76 offset:8704
  v_smfmac_f32_16x16x64_bf16 v[28:31], v[12:15], v[224:231], v74
  ds_read_b128 v[4:7], v76 offset:9728
  v_smfmac_f32_16x16x64_bf16 v[32:35], v[12:15], v[232:239], v74
  s_waitcnt lgkmcnt(4)
  v_smfmac_f32_16x16x64_bf16 v[32:35], v[8:11], v[60:67], v74
  ds_read_b128 v[60:63], v75 offset:10240
  s_waitcnt lgkmcnt(2)
  v_smfmac_f32_16x16x64_bf16 v[20:23], v[0:3], v[128:135], v74
  ds_read_b128 v[16:19], v76 offset:10752
  v_smfmac_f32_16x16x64_bf16 v[24:27], v[0:3], v[136:143], v74
  ds_read_b128 v[64:67], v75 offset:11264
  v_smfmac_f32_16x16x64_bf16 v[28:31], v[0:3], v[36:43], v74
  ds_read_b128 v[36:39], v75 offset:24576
  s_waitcnt lgkmcnt(4)
  v_smfmac_f32_16x16x64_bf16 v[20:23], v[4:7], v[144:151], v74
  ds_read_b128 v[12:15], v76 offset:11776
  v_smfmac_f32_16x16x64_bf16 v[24:27], v[4:7], v[152:159], v74
  ds_read_b128 v[40:43], v75 offset:25600
  s_waitcnt lgkmcnt(4)
  v_smfmac_f32_16x16x64_bf16 v[20:23], v[16:19], v[160:167], v74
  ds_read_b128 v[8:11], v76 offset:12800
  s_waitcnt lgkmcnt(4)
  v_smfmac_f32_16x16x64_bf16 v[32:35], v[0:3], v[60:67], v74
  ds_read_b128 v[60:63], v75 offset:26624
  v_mov_b64 v[68:69], s[78:79]
  v_smfmac_f32_16x16x64_bf16 v[24:27], v[16:19], v[168:175], v74
  ds_read_b128 v[64:67], v75 offset:27648
  s_waitcnt lgkmcnt(4)
  v_smfmac_f32_16x16x64_bf16 v[20:23], v[12:15], v[176:183], v74
  s_waitcnt lgkmcnt(3)
  v_mov_b64 v[70:71], s[78:79]
  v_smfmac_f32_16x16x64_bf16 v[28:31], v[4:7], v[36:43], v74
  s_waitcnt lgkmcnt(2)
  v_mov_b64 v[36:37], 0
  v_smfmac_f32_16x16x64_bf16 v[20:23], v[8:11], v[192:199], v74
  v_mov_b64 v[38:39], 0
  v_smfmac_f32_16x16x64_bf16 v[24:27], v[12:15], v[184:191], v74
  v_mov_b64 v[40:41], 0
  v_smfmac_f32_16x16x64_bf16 v[24:27], v[8:11], v[200:207], v74
  s_waitcnt lgkmcnt(0)
  v_add_f32 v20, v20, v22
  v_smfmac_f32_16x16x64_bf16 v[32:35], v[4:7], v[60:67], v74
  v_add_f32 v21, v21, v23
  v_smfmac_f32_16x16x64_bf16 v[28:31], v[16:19], v[240:247], v74
  v_add_f32 v24, v24, v26
  v_cvt_pk_bf16_f32 v22, v20, v24
  v_smfmac_f32_16x16x64_bf16 v[28:31], v[12:15], a[0:7], v74
  ds_write_b32 v79, v22 offset:0
  v_add_f32 v25, v25, v27
  v_cvt_pk_bf16_f32 v23, v21, v25
  v_smfmac_f32_16x16x64_bf16 v[28:31], v[8:11], a[16:23], v74
  ds_write_b32 v79, v23 offset:576
  v_cmp_u_f32 vcc, v20, v21
  v_smfmac_f32_16x16x64_bf16 v[32:35], v[16:19], v[248:255], v74
  v_mov_b64 v[42:43], 0
  v_smfmac_f32_16x16x64_bf16 v[32:35], v[12:15], a[8:15], v74
  v_add_f32 v28, v28, v30
  v_add_f32 v29, v29, v31
  v_smfmac_f32_16x16x64_bf16 v[32:35], v[8:11], a[24:31], v74
  s_cbranch_vccnz Cs2_rec
Cs2_recok:
  v_smfmac_f32_16x16x64_bf16 v[36:39], v[16:19], a[128:135], v74
  s_waitcnt lgkmcnt(0)
  s_barrier
  ds_read_b128 v[60:63], v77
  v_smfmac_f32_16x16x64_bf16 v[40:43], v[16:19], a[136:143], v74
  ds_read_b128 v[64:67], v77 offset:128
  v_add_f32 v32, v32, v34
  v_cvt_pk_bf16_f32 v30, v28, v32
  v_smfmac_f32_16x16x64_bf16 v[36:39], v[0:3], a[96:103], v74
  ds_write_b32 v79, v30 offset:256
  v_add_f32 v33, v33, v35
  v_cvt_pk_bf16_f32 v31, v29, v33
  v_smfmac_f32_16x16x64_bf16 v[40:43], v[0:3], a[104:111], v74
  ds_write_b32 v79, v31 offset:832
  v_xor_b32 v75, 0x8000, v75
  v_smfmac_f32_16x16x64_bf16 v[36:39], v[4:7], a[112:119], v74
  ds_read_b128 v[0:3], v76 offset:4608
  v_mov_b32 v29, 0
  v_smfmac_f32_16x16x64_bf16 v[40:43], v[4:7], a[120:127], v74
  s_waitcnt vmcnt(4) lgkmcnt(3)
  v_mov_b32 v30, 0
  v_mfma_f32_16x16x32_bf16 v[44:47], v[44:47], v[60:63], 0
  ds_read_b128 v[4:7], v76 offset:5632
  s_waitcnt lgkmcnt(2)
  v_mfma_f32_16x16x32_bf16 v[44:47], v[48:51], v[64:67], v[44:47]
  s_barrier
  v_smfmac_f32_16x16x64_bf16 v[36:39], v[8:11], a[160:167], v74
  ds_read_b128 v[20:23], v77 offset:256
  ds_read_b128 v[24:27], v77 offset:384
  v_smfmac_f32_16x16x64_bf16 v[40:43], v[8:11], a[168:175], v74
  ds_read_b128 v[8:11], v76 offset:6656
  v_add_f32_dpp v72, v46, v44 quad_perm:[2,3,0,1] row_mask:0xf bank_mask:0xf
  v_add_f32_dpp v73, v47, v45 quad_perm:[2,3,0,1] row_mask:0xf bank_mask:0xf
  v_smfmac_f32_16x16x64_bf16 v[36:39], v[12:15], a[144:151], v74
  s_waitcnt lgkmcnt(4)
  v_exp_f32_dpp v72, v72 quad_perm:[0,1,0,1] row_mask:0xf bank_mask:0xf
  v_smfmac_f32_16x16x64_bf16 v[40:43], v[12:15], a[152:159], v74
  ds_read_b128 v[12:15], v76 offset:7680
  v_exp_f32_dpp v73, v73 quad_perm:[0,1,0,1] row_mask:0xf bank_mask:0xf
  v_smfmac_f32_16x16x64_bf16 v[36:39], v[0:3], a[32:39], v74
  s_waitcnt lgkmcnt(2)
  v_cvt_pk_bf16_f32 v72, v72, v73
  v_mfma_f32_16x16x32_bf16 v[20:23], v[20:23], v[60:63], 0
  ds_write_b32 v78, v72 offset:520
  v_mov_b64 v[16:17], 0
  v_mfma_f32_16x16x32_bf16 v[20:23], v[24:27], v[64:67], v[20:23]
  ds_read_b128 v[44:47], v75 offset:24576
  v_mov_b64 v[18:19], 0
  v_smfmac_f32_16x16x64_bf16 v[40:43], v[0:3], a[40:47], v74
  ds_read_b128 v[48:51], v75 offset:25600
  s_waitcnt lgkmcnt(4)
  v_smfmac_f32_16x16x64_bf16 v[36:39], v[4:7], a[48:55], v74
  v_add_f32_dpp v24, v22, v20 quad_perm:[2,3,0,1] row_mask:0xf bank_mask:0xf
  v_add_f32_dpp v25, v23, v21 quad_perm:[2,3,0,1] row_mask:0xf bank_mask:0xf
  v_smfmac_f32_16x16x64_bf16 v[36:39], v[8:11], a[64:71], v74
  s_waitcnt lgkmcnt(2)
  s_barrier
  ds_read_b128 v[32:35], v78 offset:512
  v_smfmac_f32_16x16x64_bf16 v[36:39], v[12:15], a[80:87], v74
  ds_read_b128 v[60:63], v75 offset:26624
  v_mul_f32 v24, s69, v24
  v_smfmac_f32_16x16x64_bf16 v[40:43], v[4:7], a[56:63], v74
  ds_read_b128 v[64:67], v75 offset:27648
  v_mul_f32 v25, s69, v25
  v_smfmac_f32_16x16x64_bf16 v[40:43], v[8:11], a[72:79], v74
  v_exp_f32_dpp v24, v24 quad_perm:[0,1,0,1] row_mask:0xf bank_mask:0xf
  v_smfmac_f32_16x16x64_bf16 v[40:43], v[12:15], a[88:95], v74
  s_waitcnt vmcnt(2) lgkmcnt(2)
  v_exp_f32_dpp v25, v25 quad_perm:[0,1,0,1] row_mask:0xf bank_mask:0xf
  v_mfma_f32_16x16x32_bf16 v[8:11], v[32:35], v[68:71], 0
  v_add_f32 v36, v36, v38
  v_add_f32 v37, v37, v39
  v_mfma_f32_16x16x32_bf16 v[0:3], v[32:35], v[52:55], 0
  v_add_f32 v40, v40, v42
  v_add_f32 v41, v41, v43
  v_mfma_f32_16x16x32_bf16 v[4:7], v[32:35], v[56:59], 0
  v_cvt_pk_bf16_f32 v28, v24, v25
  v_cvt_pk_bf16_f32 v72, v36, v37
  v_cvt_pk_bf16_f32 v73, v40, v41
  v_mfma_f32_16x16x16_bf16 v[8:11], v[28:29], v[68:69], v[8:11]
  v_cvt_pk_bf16_f32 v31, v24, v25
  v_mov_b64 v[20:21], 0
  v_mfma_f32_16x16x16_bf16 v[0:3], v[28:29], v[72:73], v[0:3]
  ds_read_b128 v[68:71], v76 offset:13824
  v_mov_b64 v[22:23], 0
  v_mfma_f32_16x16x16_bf16 v[4:7], v[30:31], v[72:73], v[4:7]
  v_rcp_f32 v10, v8
  v_rcp_f32 v11, v9
  v_mul_f32 v0, v10, v0
  v_mul_f32 v1, v11, v1
  s_nop 0
  v_mul_f32 v4, v10, v4
  v_mul_f32 v5, v11, v5
  v_cvt_pk_bf16_f32 v2, v0, v4
  ds_write_b32 v79, v2 offset:8704
  v_cvt_pk_bf16_f32 v3, v1, v5
  ds_write_b32 v79, v3 offset:9280
  v_max3_f32 v8, v8, v9, v10
  v_max_f32 v8, v8, v11
  v_cmp_le_f32 vcc, 1317011456, v8
  v_mov_b64 v[24:25], 0
  v_mov_b64 v[26:27], 0
  s_cbranch_vccnz Cs2_mx
Cs2_mxok:
  s_waitcnt lgkmcnt(0)
  s_barrier
  ds_read_b128 v[0:3], v78 offset:8704
  ds_read_b128 v[4:7], v78 offset:8768
  ds_read_b128 v[8:11], v78 offset:8832
  ds_read_b128 v[12:15], v78 offset:8896
  s_cmp_eq_u32 s66, 63
  s_cbranch_scc1 Cs2_last
  s_waitcnt lgkmcnt(3)
  v_smfmac_f32_16x16x64_bf16 v[16:19], v[0:3], v[44:51], v74
  ds_read_b128 v[52:55], v75 offset:40960
  s_waitcnt lgkmcnt(3)
  v_smfmac_f32_16x16x64_bf16 v[16:19], v[4:7], v[60:67], v74
  ds_read_b128 v[56:59], v75 offset:41984
  s_waitcnt lgkmcnt(3)
  v_smfmac_f32_16x16x64_bf16 v[16:19], v[8:11], a[176:183], v74
  ds_read_b128 v[36:39], v75 offset:43008
  s_waitcnt lgkmcnt(3)
  v_smfmac_f32_16x16x64_bf16 v[16:19], v[12:15], a[184:191], v74
  ds_read_b128 v[40:43], v75 offset:44032
  ds_read_b128 v[44:47], v75 offset:57344
  v_smfmac_f32_16x16x64_bf16 v[20:23], v[0:3], a[192:199], v74
  ds_read_b128 v[48:51], v75 offset:58368
  ds_read_b128 v[60:63], v75 offset:59392
  v_smfmac_f32_16x16x64_bf16 v[20:23], v[4:7], a[200:207], v74
  ds_read_b128 v[64:67], v75 offset:60416
  s_waitcnt lgkmcnt(6)
  v_cvt_pk_bf16_f32 v16, v16, v17
  v_cvt_pk_bf16_f32 v17, v18, v19
  v_bfi_b32 v16, 1, s72, v16
  v_smfmac_f32_16x16x64_bf16 v[20:23], v[8:11], v[52:59], v74
  buffer_store_dwordx2 v[16:17], v68, s[8:11], s73 offen sc1
  s_waitcnt lgkmcnt(4)
  v_smfmac_f32_16x16x64_bf16 v[20:23], v[12:15], v[36:43], v74
  ds_read_b128 v[52:55], v75 offset:0
  v_mov_b64 v[32:33], 0
  v_smfmac_f32_16x16x64_bf16 v[24:27], v[0:3], a[208:215], v74
  ds_read_b128 v[56:59], v75 offset:1024
  v_mov_b64 v[34:35], 0
  v_smfmac_f32_16x16x64_bf16 v[24:27], v[4:7], a[216:223], v74
  ds_read_b128 v[36:39], v75 offset:2048
  s_waitcnt lgkmcnt(5)
  v_cvt_pk_bf16_f32 v20, v20, v21
  v_cvt_pk_bf16_f32 v21, v22, v23
  v_bfi_b32 v20, 1, s72, v20
  v_smfmac_f32_16x16x64_bf16 v[24:27], v[8:11], v[44:51], v74
  buffer_store_dwordx2 v[20:21], v68, s[8:11], s74 offen sc1
  s_waitcnt lgkmcnt(3)
  v_smfmac_f32_16x16x64_bf16 v[24:27], v[12:15], v[60:67], v74
  ds_read_b128 v[40:43], v75 offset:3072
  v_mov_b64 v[28:29], 0
  v_smfmac_f32_16x16x64_bf16 v[32:35], v[0:3], a[224:231], v74
  ds_read_b128 v[44:47], v75 offset:4096
  ds_read_b128 v[48:51], v75 offset:5120
  v_smfmac_f32_16x16x64_bf16 v[32:35], v[4:7], a[232:239], v74
  ds_read_b128 v[60:63], v75 offset:6144
  v_cvt_pk_bf16_f32 v24, v24, v25
  v_cvt_pk_bf16_f32 v25, v26, v27
  v_bfi_b32 v24, 1, s72, v24
  v_smfmac_f32_16x16x64_bf16 v[32:35], v[8:11], a[240:247], v74
  buffer_store_dwordx2 v[24:25], v68, s[8:11], s75 offen sc1
  v_mov_b64 v[30:31], 0
  v_smfmac_f32_16x16x64_bf16 v[32:35], v[12:15], a[248:255], v74
  ds_read_b128 v[64:67], v75 offset:7168
  s_waitcnt lgkmcnt(6)
  v_smfmac_f32_16x16x64_bf16 v[28:31], v[0:3], v[52:59], v74
  s_waitcnt lgkmcnt(4)
  v_smfmac_f32_16x16x64_bf16 v[28:31], v[4:7], v[36:43], v74
  s_waitcnt lgkmcnt(2)
  v_cvt_pk_bf16_f32 v32, v32, v33
  v_cvt_pk_bf16_f32 v33, v34, v35
  v_bfi_b32 v32, 1, s72, v32
  v_smfmac_f32_16x16x64_bf16 v[28:31], v[8:11], v[44:51], v74
  buffer_store_dwordx2 v[32:33], v68, s[8:11], s76 offen sc1
  s_waitcnt lgkmcnt(0)
  v_smfmac_f32_16x16x64_bf16 v[28:31], v[12:15], v[60:67], v74
  ds_read_b128 v[0:3], v76 offset:14848
  ds_read_b64 v[16:17], v77 offset:384
  v_mov_b64 v[18:19], v[72:73]
  v_xor_b32 v75, 0x8000, v75
  s_nop 3
  v_cvt_pk_bf16_f32 v28, v28, v29
  v_cvt_pk_bf16_f32 v29, v30, v31
  v_bfi_b32 v28, 1, s72, v28
  buffer_store_dwordx2 v[28:29], v68, s[8:11], s77 offen sc1
  v_mov_b64 v[20:21], 0
  v_mov_b64 v[22:23], 0
  v_mov_b64 v[24:25], 0
  v_mov_b64 v[26:27], 0
  v_mov_b64 v[28:29], 0
  v_mov_b64 v[30:31], 0
  v_mov_b64 v[32:33], 0
  v_mov_b64 v[34:35], 0
  s_add_u32 s58, s58, 655360
  s_add_u32 s59, s59, 655360
  s_add_u32 s70, s70, 655360
  s_add_u32 s68, s68, 655360
  s_add_u32 s66, s66, 1
  s_xor_b32 s64, s64, 16384
  s_xor_b32 s65, s65, 16384
  s_nop 15
  s_nop 15
  s_nop 7
  buffer_load_dwordx4 v[52:55], v76, s[8:11], s60 offen offset:0 sc1
  buffer_load_dwordx4 v[56:59], v76, s[8:11], s60 offen offset:1024 sc1
  s_nop 15
  s_nop 11
  buffer_load_dwordx4 v[36:39], v76, s[8:11], s60 offen offset:0 sc1
  buffer_load_dwordx4 v[40:43], v76, s[8:11], s60 offen offset:1024 sc1
  s_waitcnt lgkmcnt(0)
  s_waitcnt vmcnt(3)
  v_mfma_f32_16x16x32_bf16 v[4:7], v[0:3], v[52:55], 0
  v_bitop3_b32 v72, v52, v54, s72 bitop3:0x7e
  s_waitcnt vmcnt(2)
  v_mfma_f32_16x16x32_bf16 v[4:7], v[0:3], v[56:59], v[4:7]
  v_bitop3_b32 v73, v56, v58, s72 bitop3:0x7e
  v_bitop3_b32 v72, v72, v73, 1 bitop3:0xa8
  v_cmp_ne_u32 vcc, 0, v72
  s_nop 0
  s_cmp_eq_u64 vcc, 0
  s_cselect_b32 s54, s62, 268435456
  s_nop 0
  v_add_f32_dpp v4, v4, v4 row_ror:4 row_mask:0xf bank_mask:0xf
  v_add_f32_dpp v5, v5, v5 row_ror:4 row_mask:0xf bank_mask:0xf
  s_nop 0
  v_add_f32_dpp v4, v4, v4 row_ror:8 row_mask:0xf bank_mask:0xf
  v_add_f32_dpp v5, v5, v5 row_ror:8 row_mask:0xf bank_mask:0xf
  v_cvt_pk_bf16_f32 v4, v4, v5
  buffer_store_dword v4, v69, s[8:11], s54 offen sc1
  s_cbranch_vccnz Cs2_h1r
  s_xor_b32 s62, s62, 16384
  buffer_store_dword v71, v69, s[8:11], s62 offen sc1
  s_xor_b32 s72, s72, 1
  s_branch Cs2_h2
Cs2_h1r:
  s_mov_b64 exec, vcc
  buffer_load_dwordx4 v[52:55], v76, s[8:11], s60 offen offset:0 sc1
  buffer_load_dwordx4 v[56:59], v76, s[8:11], s60 offen offset:1024 sc1
  s_mov_b64 exec, -1
  s_add_u32 s67, s67, 1
  s_waitcnt vmcnt(4)
  v_mfma_f32_16x16x32_bf16 v[4:7], v[0:3], v[36:39], 0
  v_bitop3_b32 v72, v36, v38, s72 bitop3:0x7e
  s_waitcnt vmcnt(3)
  v_mfma_f32_16x16x32_bf16 v[4:7], v[0:3], v[40:43], v[4:7]
  v_bitop3_b32 v73, v40, v42, s72 bitop3:0x7e
  v_bitop3_b32 v72, v72, v73, 1 bitop3:0xa8
  v_cmp_ne_u32 vcc, 0, v72
  s_cbranch_vccz Cs2_h1p
  s_mov_b64 exec, vcc
  buffer_load_dwordx4 v[36:39], v76, s[8:11], s60 offen offset:0 sc1
  buffer_load_dwordx4 v[40:43], v76, s[8:11], s60 offen offset:1024 sc1
  s_mov_b64 exec, -1
  s_add_u32 s67, s67, 1
  s_waitcnt vmcnt(3)
  v_mfma_f32_16x16x32_bf16 v[4:7], v[0:3], v[52:55], 0
  v_bitop3_b32 v72, v52, v54, s72 bitop3:0x7e
  s_waitcnt vmcnt(2)
  v_mfma_f32_16x16x32_bf16 v[4:7], v[0:3], v[56:59], v[4:7]
  v_bitop3_b32 v73, v56, v58, s72 bitop3:0x7e
  v_bitop3_b32 v72, v72, v73, 1 bitop3:0xa8
  v_cmp_ne_u32 vcc, 0, v72
  s_cbranch_vccz Cs2_h1p
Cs2_h1s:
  s_mov_b64 exec, vcc
  buffer_load_dwordx4 v[52:55], v76, s[8:11], s60 offen offset:0 sc1
  buffer_load_dwordx4 v[56:59], v76, s[8:11], s60 offen offset:1024 sc1
  s_mov_b64 exec, -1
  s_add_u32 s67, s67, 1
  s_waitcnt vmcnt(3)
  v_mfma_f32_16x16x32_bf16 v[4:7], v[0:3], v[36:39], 0
  v_bitop3_b32 v72, v36, v38, s72 bitop3:0x7e
  s_waitcnt vmcnt(2)
  v_mfma_f32_16x16x32_bf16 v[4:7], v[0:3], v[40:43], v[4:7]
  v_bitop3_b32 v73, v40, v42, s72 bitop3:0x7e
  v_bitop3_b32 v72, v72, v73, 1 bitop3:0xa8
  v_cmp_ne_u32 vcc, 0, v72
  s_cbranch_vccz Cs2_h1p
  s_mov_b64 exec, vcc
  buffer_load_dwordx4 v[36:39], v76, s[8:11], s60 offen offset:0 sc1
  buffer_load_dwordx4 v[40:43], v76, s[8:11], s60 offen offset:1024 sc1
  s_mov_b64 exec, -1
  s_add_u32 s67, s67, 1
  s_waitcnt vmcnt(3)
  v_mfma_f32_16x16x32_bf16 v[4:7], v[0:3], v[52:55], 0
  v_bitop3_b32 v72, v52, v54, s72 bitop3:0x7e
  s_waitcnt vmcnt(2)
  v_mfma_f32_16x16x32_bf16 v[4:7], v[0:3], v[56:59], v[4:7]
  v_bitop3_b32 v73, v56, v58, s72 bitop3:0x7e
  v_bitop3_b32 v72, v72, v73, 1 bitop3:0xa8
  v_cmp_ne_u32 vcc, 0, v72
  s_cbranch_vccz Cs2_h1p
  s_cmp_lt_u32 s67, 131072
  s_cbranch_scc1 Cs2_h1s
Cs2_h1p:
  s_nop 2
  v_add_f32_dpp v4, v4, v4 row_ror:4 row_mask:0xf bank_mask:0xf
  v_add_f32_dpp v5, v5, v5 row_ror:4 row_mask:0xf bank_mask:0xf
  s_nop 0
  v_add_f32_dpp v4, v4, v4 row_ror:8 row_mask:0xf bank_mask:0xf
  v_add_f32_dpp v5, v5, v5 row_ror:8 row_mask:0xf bank_mask:0xf
  v_cvt_pk_bf16_f32 v4, v4, v5
  buffer_store_dword v4, v69, s[8:11], s62 offen sc1
  s_xor_b32 s62, s62, 16384
  buffer_store_dword v71, v69, s[8:11], s62 offen sc1
  s_xor_b32 s72, s72, 1
  s_branch Cs2_h2
Cs2_h2r:
  s_mov_b64 exec, vcc
  buffer_load_dwordx4 v[52:55], v76, s[8:11], s65 offen offset:3072 sc1
  s_mov_b64 exec, -1
  s_add_u32 s67, s67, 1
  s_waitcnt vmcnt(2)
  v_max3_u32 v72, v52, v53, v54
  v_max_u32 v72, v72, v55
  ds_write_b128 v76, v[52:55] offset:7680
  v_cmp_eq_u32 vcc, -1, v72
  s_cbranch_vccz Cs2_h2w
  s_mov_b64 exec, vcc
  buffer_load_dwordx4 v[52:55], v76, s[8:11], s65 offen offset:3072 sc1
  s_mov_b64 exec, -1
  s_add_u32 s67, s67, 1
  s_waitcnt vmcnt(2)
  v_max3_u32 v72, v52, v53, v54
  v_max_u32 v72, v72, v55
  ds_write_b128 v76, v[52:55] offset:7680
  v_cmp_eq_u32 vcc, -1, v72
  s_cbranch_vccz Cs2_h2w
  s_mov_b64 exec, vcc
  buffer_load_dwordx4 v[52:55], v76, s[8:11], s65 offen offset:3072 sc1
  s_mov_b64 exec, -1
  s_add_u32 s67, s67, 1
  s_waitcnt vmcnt(2)
  v_max3_u32 v72, v52, v53, v54
  v_max_u32 v72, v72, v55
  ds_write_b128 v76, v[52:55] offset:7680
  v_cmp_eq_u32 vcc, -1, v72
  s_cbranch_vccz Cs2_h2w
  s_mov_b64 exec, vcc
  buffer_load_dwordx4 v[52:55], v76, s[8:11], s65 offen offset:3072 sc1
  s_mov_b64 exec, -1
  s_add_u32 s67, s67, 1
  s_waitcnt vmcnt(2)
  v_max3_u32 v72, v52, v53, v54
  v_max_u32 v72, v72, v55
  ds_write_b128 v76, v[52:55] offset:7680
  v_cmp_eq_u32 vcc, -1, v72
  s_cbranch_vccz Cs2_h2w
  s_cmp_lt_u32 s67, 131072
  s_cbranch_scc1 Cs2_h2r
Cs2_h2ok:
  ds_write_b128 v76, v[52:55] offset:7680
  s_branch Cs2_h2w
Cs2_rec:
  s_nop 7
  s_waitcnt vmcnt(0) lgkmcnt(0)
  v_max3_u32 v72, v0, v1, v2
  v_max3_u32 v72, v72, v3, v4
  v_max3_u32 v72, v72, v5, v6
  v_max3_u32 v72, v72, v7, v8
  v_max3_u32 v72, v72, v9, v10
  v_max3_u32 v72, v72, v11, v12
  v_max3_u32 v72, v72, v13, v14
  v_max3_u32 v72, v72, v15, v16
  v_max3_u32 v72, v72, v17, v18
  v_max_u32 v72, v72, v19
  v_cmp_eq_u32 vcc, -1, v72
  s_cbranch_vccz Cs2_recok
  s_barrier
Cs2_recp:
  buffer_load_dwordx4 v[0:3], v76, s[8:11], s64 offen offset:0 sc1
  buffer_load_dwordx4 v[4:7], v76, s[8:11], s64 offen offset:1024 sc1
  s_add_u32 s67, s67, 1
  s_cmp_lt_u32 s67, 131072
  s_cselect_b32 s54, -2, -1
  s_waitcnt vmcnt(1)
  v_max3_u32 v72, v0, v1, v2
  s_waitcnt vmcnt(0)
  v_max3_u32 v72, v72, v3, v4
  v_max3_u32 v72, v72, v5, v6
  v_max_u32 v72, v72, v7
  v_cmp_lt_u32 vcc, s54, v72
  s_cbranch_vccnz Cs2_recp
  ds_write_b128 v76, v[0:3] offset:8704
  ds_write_b128 v76, v[4:7] offset:9728
  v_mov_b64 v[20:21], 0
  v_mov_b64 v[22:23], 0
  v_mov_b64 v[24:25], 0
  v_mov_b64 v[26:27], 0
  v_mov_b64 v[28:29], 0
  v_mov_b64 v[30:31], 0
  v_mov_b64 v[32:33], 0
  v_mov_b64 v[34:35], 0
  s_waitcnt lgkmcnt(0)
  s_barrier
  ds_read_b128 v[0:3], v76 offset:4608
  ds_read_b128 v[60:63], v76 offset:24576
  ds_read_b128 v[64:67], v76 offset:25600
  s_waitcnt lgkmcnt(0)
  v_smfmac_f32_16x16x64_bf16 v[20:23], v[0:3], v[60:67], v74
  ds_read_b128 v[60:63], v76 offset:26624
  ds_read_b128 v[64:67], v76 offset:27648
  s_waitcnt lgkmcnt(0)
  v_smfmac_f32_16x16x64_bf16 v[24:27], v[0:3], v[60:67], v74
  ds_read_b128 v[60:63], v76 offset:40960
  ds_read_b128 v[64:67], v76 offset:41984
  s_waitcnt lgkmcnt(0)
  v_smfmac_f32_16x16x64_bf16 v[28:31], v[0:3], v[60:67], v74
  ds_read_b128 v[60:63], v76 offset:43008
  ds_read_b128 v[64:67], v76 offset:44032
  s_waitcnt lgkmcnt(0)
  v_smfmac_f32_16x16x64_bf16 v[32:35], v[0:3], v[60:67], v74
  ds_read_b128 v[4:7], v76 offset:5632
  s_waitcnt lgkmcnt(0)
  v_smfmac_f32_16x16x64_bf16 v[20:23], v[4:7], v[80:87], v74
  v_smfmac_f32_16x16x64_bf16 v[24:27], v[4:7], v[88:95], v74
  v_smfmac_f32_16x16x64_bf16 v[28:31], v[4:7], v[208:215], v74
  v_smfmac_f32_16x16x64_bf16 v[32:35], v[4:7], v[216:223], v74
  ds_read_b128 v[8:11], v76 offset:6656
  s_waitcnt lgkmcnt(0)
  v_smfmac_f32_16x16x64_bf16 v[20:23], v[8:11], v[96:103], v74
  v_smfmac_f32_16x16x64_bf16 v[24:27], v[8:11], v[104:111], v74
  ds_read_b128 v[60:63], v76 offset:57344
  ds_read_b128 v[64:67], v76 offset:58368
  s_waitcnt lgkmcnt(0)
  v_smfmac_f32_16x16x64_bf16 v[28:31], v[8:11], v[60:67], v74
  ds_read_b128 v[60:63], v76 offset:59392
  ds_read_b128 v[64:67], v76 offset:60416
  s_waitcnt lgkmcnt(0)
  v_smfmac_f32_16x16x64_bf16 v[32:35], v[8:11], v[60:67], v74
  ds_read_b128 v[12:15], v76 offset:7680
  s_waitcnt lgkmcnt(0)
  v_smfmac_f32_16x16x64_bf16 v[20:23], v[12:15], v[112:119], v74
  v_smfmac_f32_16x16x64_bf16 v[24:27], v[12:15], v[120:127], v74
  v_smfmac_f32_16x16x64_bf16 v[28:31], v[12:15], v[224:231], v74
  v_smfmac_f32_16x16x64_bf16 v[32:35], v[12:15], v[232:239], v74
  ds_read_b128 v[0:3], v76 offset:8704
  s_waitcnt lgkmcnt(0)
  v_smfmac_f32_16x16x64_bf16 v[20:23], v[0:3], v[128:135], v74
  v_smfmac_f32_16x16x64_bf16 v[24:27], v[0:3], v[136:143], v74
  ds_read_b128 v[60:63], v75 offset:8192
  ds_read_b128 v[64:67], v75 offset:9216
  s_waitcnt lgkmcnt(0)
  v_smfmac_f32_16x16x64_bf16 v[28:31], v[0:3], v[60:67], v74
  ds_read_b128 v[60:63], v75 offset:10240
  ds_read_b128 v[64:67], v75 offset:11264
  s_waitcnt lgkmcnt(0)
  v_smfmac_f32_16x16x64_bf16 v[32:35], v[0:3], v[60:67], v74
  ds_read_b128 v[4:7], v76 offset:9728
  s_waitcnt lgkmcnt(0)
  v_smfmac_f32_16x16x64_bf16 v[20:23], v[4:7], v[144:151], v74
  v_smfmac_f32_16x16x64_bf16 v[24:27], v[4:7], v[152:159], v74
  ds_read_b128 v[60:63], v75 offset:24576
  ds_read_b128 v[64:67], v75 offset:25600
  s_waitcnt lgkmcnt(0)
  v_smfmac_f32_16x16x64_bf16 v[28:31], v[4:7], v[60:67], v74
  ds_read_b128 v[60:63], v75 offset:26624
  ds_read_b128 v[64:67], v75 offset:27648
  s_waitcnt lgkmcnt(0)
  v_smfmac_f32_16x16x64_bf16 v[32:35], v[4:7], v[60:67], v74
  ds_read_b128 v[16:19], v76 offset:10752
  s_waitcnt lgkmcnt(0)
  v_smfmac_f32_16x16x64_bf16 v[20:23], v[16:19], v[160:167], v74
  v_smfmac_f32_16x16x64_bf16 v[24:27], v[16:19], v[168:175], v74
  v_smfmac_f32_16x16x64_bf16 v[28:31], v[16:19], v[240:247], v74
  v_smfmac_f32_16x16x64_bf16 v[32:35], v[16:19], v[248:255], v74
  ds_read_b128 v[12:15], v76 offset:11776
  s_waitcnt lgkmcnt(0)
  v_smfmac_f32_16x16x64_bf16 v[20:23], v[12:15], v[176:183], v74
  v_smfmac_f32_16x16x64_bf16 v[24:27], v[12:15], v[184:191], v74
  v_smfmac_f32_16x16x64_bf16 v[28:31], v[12:15], a[0:7], v74
  v_smfmac_f32_16x16x64_bf16 v[32:35], v[12:15], a[8:15], v74
  ds_read_b128 v[8:11], v76 offset:12800
  s_waitcnt lgkmcnt(0)
  v_smfmac_f32_16x16x64_bf16 v[20:23], v[8:11], v[192:199], v74
  v_smfmac_f32_16x16x64_bf16 v[24:27], v[8:11], v[200:207], v74
  v_smfmac_f32_16x16x64_bf16 v[28:31], v[8:11], a[16:23], v74
  v_smfmac_f32_16x16x64_bf16 v[32:35], v[8:11], a[24:31], v74
  v_add_f32 v20, v20, v22
  v_add_f32 v21, v21, v23
  v_add_f32 v24, v24, v26
  v_cvt_pk_bf16_f32 v22, v20, v24
  s_nop 0
  ds_write_b32 v79, v22 offset:0
  v_add_f32 v25, v25, v27
  v_cvt_pk_bf16_f32 v23, v21, v25
  ds_write_b32 v79, v23 offset:576
  v_add_f32 v28, v28, v30
  v_add_f32 v29, v29, v31
  s_waitcnt lgkmcnt(0)
  s_nop 1
  s_branch Cs2_recok
Cs2_mx:
  s_waitcnt lgkmcnt(0)
  s_barrier
  buffer_load_dwordx4 v[0:3], v76, s[8:11], s58 offen offset:0 sc1
  ds_read_b128 v[20:23], v77 offset:0
  ds_read_b128 v[28:31], v77 offset:256
  buffer_load_dwordx4 v[4:7], v76, s[8:11], s58 offen offset:1024 sc1
  ds_read_b128 v[24:27], v77 offset:128
  ds_read_b128 v[32:35], v77 offset:384
  s_waitcnt vmcnt(1) lgkmcnt(3)
  v_mfma_f32_16x16x32_bf16 v[8:11], v[0:3], v[20:23], 0
  s_waitcnt vmcnt(0) lgkmcnt(1)
  v_mfma_f32_16x16x32_bf16 v[8:11], v[4:7], v[24:27], v[8:11]
  v_mfma_f32_16x16x32_bf16 v[12:15], v[28:31], v[20:23], 0
  s_waitcnt lgkmcnt(0)
  v_mfma_f32_16x16x32_bf16 v[12:15], v[32:35], v[24:27], v[12:15]
  v_add_f32_dpp v8, v10, v8 quad_perm:[2,3,0,1] row_mask:0xf bank_mask:0xf
  v_add_f32_dpp v9, v11, v9 quad_perm:[2,3,0,1] row_mask:0xf bank_mask:0xf
  s_nop 0
  v_mov_b32_dpp v8, v8 quad_perm:[0,1,0,1] row_mask:0xf bank_mask:0xf
  v_mov_b32_dpp v9, v9 quad_perm:[0,1,0,1] row_mask:0xf bank_mask:0xf
  s_nop 1
  v_add_f32_dpp v12, v14, v12 quad_perm:[2,3,0,1] row_mask:0xf bank_mask:0xf
  v_add_f32_dpp v13, v15, v13 quad_perm:[2,3,0,1] row_mask:0xf bank_mask:0xf
  s_nop 0
  v_mov_b32_dpp v12, v12 quad_perm:[0,1,0,1] row_mask:0xf bank_mask:0xf
  v_mov_b32_dpp v13, v13 quad_perm:[0,1,0,1] row_mask:0xf bank_mask:0xf
  v_mul_f32 v12, s69, v12
  ds_write_b32 v78, v8 offset:8712
  v_mul_f32 v13, s69, v13
  ds_write_b32 v78, v9 offset:8776
  s_waitcnt lgkmcnt(0)
  s_barrier
  ds_read_b128 v[36:39], v78 offset:8704
  ds_read_b128 v[40:43], v78 offset:8768
  s_waitcnt lgkmcnt(0)
  s_barrier
  v_max_f32 v16, v36, v37
  v_max3_f32 v16, v16, v38, v39
  v_max3_f32 v16, v16, v40, v41
  v_max3_f32 v16, v16, v42, v43
  v_max3_f32 v16, v16, v12, v13
  v_mov_b32 v17, v16
  s_nop 1
  v_permlane16_swap_b32 v16, v17
  v_max_f32 v16, v16, v17
  v_mov_b32 v17, v16
  s_nop 1
  v_permlane32_swap_b32 v16, v17
  v_max_f32 v16, v16, v17
  v_sub_f32 v36, v36, v16
  v_sub_f32 v37, v37, v16
  v_sub_f32 v38, v38, v16
  v_sub_f32 v39, v39, v16
  v_sub_f32 v40, v40, v16
  v_sub_f32 v41, v41, v16
  v_sub_f32 v42, v42, v16
  v_sub_f32 v43, v43, v16
  v_sub_f32 v12, v12, v16
  v_sub_f32 v13, v13, v16
  v_exp_f32 v36, v36
  v_exp_f32 v37, v37
  v_exp_f32 v38, v38
  v_exp_f32 v39, v39
  v_exp_f32 v40, v40
  v_exp_f32 v41, v41
  v_exp_f32 v42, v42
  v_exp_f32 v43, v43
  v_exp_f32 v12, v12
  v_exp_f32 v13, v13
  v_cvt_pk_bf16_f32 v32, v36, v40
  v_cvt_pk_bf16_f32 v33, v37, v41
  v_cvt_pk_bf16_f32 v34, v38, v42
  v_cvt_pk_bf16_f32 v35, v39, v43
  v_cvt_pk_bf16_f32 v28, v12, v13
  v_cvt_pk_bf16_f32 v31, v12, v13
  v_mov_b32 v29, 0
  v_mov_b32 v30, 0
  v_mov_b32 v68, 0x3f803f80
  v_mov_b32 v69, 0x3f803f80
  v_mov_b32 v70, 0x3f803f80
  v_mov_b32 v71, 0x3f803f80
  s_nop 1
  v_mfma_f32_16x16x32_bf16 v[8:11], v[32:35], v[68:71], 0
  v_mfma_f32_16x16x32_bf16 v[0:3], v[32:35], v[52:55], 0
  v_mfma_f32_16x16x32_bf16 v[4:7], v[32:35], v[56:59], 0
  v_mfma_f32_16x16x16_bf16 v[8:11], v[28:29], v[68:69], v[8:11]
  v_mfma_f32_16x16x16_bf16 v[0:3], v[28:29], v[72:73], v[0:3]
  v_mfma_f32_16x16x16_bf16 v[4:7], v[30:31], v[72:73], v[4:7]
  ds_read_b128 v[68:71], v76 offset:13824
  v_rcp_f32 v10, v8
  v_rcp_f32 v11, v9
  v_mul_f32 v0, v10, v0
  v_mul_f32 v1, v11, v1
  s_nop 0
  v_mul_f32 v4, v10, v4
  v_mul_f32 v5, v11, v5
  v_cvt_pk_bf16_f32 v2, v0, v4
  ds_write_b32 v79, v2 offset:8704
  v_cvt_pk_bf16_f32 v3, v1, v5
  ds_write_b32 v79, v3 offset:9280
  v_mov_b64 v[16:17], 0
  v_mov_b64 v[18:19], 0
  v_mov_b64 v[20:21], 0
  v_mov_b64 v[22:23], 0
  v_mov_b64 v[24:25], 0
  v_mov_b64 v[26:27], 0
  s_branch Cs2_mxok
Cs2_last:
  s_waitcnt lgkmcnt(0)
  ds_read_b64 v[16:17], v77 offset:384
  v_mov_b64 v[18:19], v[72:73]
  s_add_u32 s68, s68, 655360
  s_waitcnt lgkmcnt(0)
  buffer_store_dwordx4 v[16:19], v76, s[8:11], s68 offen sc1
  s_branch L_cexit
L_w7:
  v_mov_b64 v[20:21], 0
  v_mov_b64 v[22:23], 0
  v_mov_b64 v[24:25], 0
  v_mov_b64 v[26:27], 0
  v_mov_b64 v[28:29], 0
  v_mov_b64 v[30:31], 0
  v_mov_b64 v[32:33], 0
  v_mov_b64 v[34:35], 0
  s_mov_b32 s78, 0x3f803f80
  s_mov_b32 s79, s78
  s_mov_b32 s65, 360448
  s_mov_b32 m0, 15872
  v_lshlrev_b32 v73, 2, v76
  v_mov_b32 v72, 0
  ds_read_b128 v[60:63], v76 offset:28672
  ds_read_b128 v[64:67], v76 offset:29696
  ds_read_b128 v[44:47], v76 offset:30720
  ds_read_b128 v[48:51], v76 offset:31744
  ds_read_b128 v[36:39], v76 offset:45056
  ds_read_b128 v[40:43], v76 offset:46080
  ds_read_b128 v[0:3], v76 offset:4608
  ds_read_b128 v[4:7], v76 offset:5632
  s_branch Cs3_top2
.p2align 6
Cs3_h2:
  v_lshlrev_b32 v73, 2, v76
  s_mov_b32 m0, 10752
  s_waitcnt vmcnt(4)
  ds_read_b128 v[60:63], v76 offset:28672
  ds_read_b128 v[64:67], v76 offset:29696
  ds_read_b128 v[44:47], v76 offset:30720
  ds_read_b128 v[48:51], v76 offset:31744
  ds_read_b128 v[36:39], v76 offset:45056
  ds_read_b128 v[40:43], v76 offset:46080
  s_cmp_eq_u32 s66, 12
  s_cbranch_scc1 Cs3_kv2
Cs3_h2w:
  s_waitcnt lgkmcnt(0)
  s_barrier
  ds_read_b128 v[0:3], v76 offset:4608
  ds_read_b128 v[4:7], v76 offset:5632
  buffer_load_dwordx4 v76, s[8:11], s64 offen offset:0 sc1 lds
  buffer_load_dwordx4 v76, s[8:11], s64 offen offset:1024 sc1 lds
  buffer_load_dwordx4 v76, s[8:11], s64 offen offset:2048 sc1 lds
Cs3_top2:
  ds_read_b128 v[8:11], v76 offset:6656
  s_mov_b32 m0, 15872
  s_waitcnt lgkmcnt(2)
  v_smfmac_f32_16x16x64_bf16 v[20:23], v[0:3], v[60:67], v74
  ds_read_b128 v[60:63], v76 offset:47104
  v_smfmac_f32_16x16x64_bf16 v[24:27], v[0:3], v[44:51], v74
  buffer_load_dwordx4 v[44:47], v76, s[8:11], s58 offen offset:0 sc1
  ds_read_b128 v[64:67], v76 offset:48128
  s_waitcnt lgkmcnt(3)
  v_smfmac_f32_16x16x64_bf16 v[20:23], v[4:7], v[80:87], v74
  buffer_load_dwordx4 v[48:51], v76, s[8:11], s58 offen offset:1024 sc1
  v_smfmac_f32_16x16x64_bf16 v[28:31], v[0:3], v[36:43], v74
  buffer_load_dwordx4 v[52:55], v76, s[8:11], s59 offen offset:0 sc1
  ds_read_b128 v[36:39], v76 offset:61440
  v_smfmac_f32_16x16x64_bf16 v[24:27], v[4:7], v[88:95], v74
  buffer_load_dwordx4 v[56:59], v76, s[8:11], s59 offen offset:1024 sc1
  ds_read_b128 v[40:43], v76 offset:62464
  v_smfmac_f32_16x16x64_bf16 v[28:31], v[4:7], v[208:215], v74
  ds_read_b128 v[12:15], v76 offset:7680
  s_waitcnt lgkmcnt(5)
  v_smfmac_f32_16x16x64_bf16 v[32:35], v[4:7], v[216:223], v74
  buffer_store_dwordx4 v[16:19], v76, s[8:11], s68 offen sc1
  s_waitcnt lgkmcnt(3)
  v_smfmac_f32_16x16x64_bf16 v[32:35], v[0:3], v[60:67], v74
  buffer_load_dword v73, s[8:11], s70 offen  lds
  v_smfmac_f32_16x16x64_bf16 v[20:23], v[8:11], v[96:103], v74
  ds_read_b128 v[60:63], v76 offset:63488
  v_smfmac_f32_16x16x64_bf16 v[24:27], v[8:11], v[104:111], v74
  ds_read_b128 v[64:67], v76 offset:64512
  s_waitcnt lgkmcnt(3)
  v_smfmac_f32_16x16x64_bf16 v[28:31], v[8:11], v[36:43], v74
  ds_read_b128 v[36:39], v75 offset:12288
  s_waitcnt lgkmcnt(3)
  v_smfmac_f32_16x16x64_bf16 v[20:23], v[12:15], v[112:119], v74
  s_waitcnt vmcnt(6)
  ds_read_b128 v[40:43], v75 offset:13312
  v_smfmac_f32_16x16x64_bf16 v[24:27], v[12:15], v[120:127], v74
  s_barrier
  ds_read_b128 v[0:3], v76 offset:8704
  v_smfmac_f32_16x16x64_bf16 v[28:31], v[12:15], v[224:231], v74
  ds_read_b128 v[4:7], v76 offset:9728
  v_smfmac_f32_16x16x64_bf16 v[32:35], v[12:15], v[232:239], v74
  s_waitcnt lgkmcnt(4)
  v_smfmac_f32_16x16x64_bf16 v[32:35], v[8:11], v[60:67], v74
  ds_read_b128 v[60:63], v75 offset:14336
  s_waitcnt lgkmcnt(2)
  v_smfmac_f32_16x16x64_bf16 v[20:23], v[0:3], v[128:135], v74
  ds_read_b128 v[16:19], v76 offset:10752
  v_smfmac_f32_16x16x64_bf16 v[24:27], v[0:3], v[136:143], v74
  ds_read_b128 v[64:67], v75 offset:15360
  v_smfmac_f32_16x16x64_bf16 v[28:31], v[0:3], v[36:43], v74
  ds_read_b128 v[36:39], v75 offset:28672
  s_waitcnt lgkmcnt(4)
  v_smfmac_f32_16x16x64_bf16 v[20:23], v[4:7], v[144:151], v74
  ds_read_b128 v[12:15], v76 offset:11776
  v_smfmac_f32_16x16x64_bf16 v[24:27], v[4:7], v[152:159], v74
  ds_read_b128 v[40:43], v75 offset:29696
  s_waitcnt lgkmcnt(4)
  v_smfmac_f32_16x16x64_bf16 v[20:23], v[16:19], v[160:167], v74
  ds_read_b128 v[8:11], v76 offset:12800
  s_waitcnt lgkmcnt(4)
  v_smfmac_f32_16x16x64_bf16 v[32:35], v[0:3], v[60:67], v74
  ds_read_b128 v[60:63], v75 offset:30720
  v_mov_b64 v[68:69], s[78:79]
  v_smfmac_f32_16x16x64_bf16 v[24:27], v[16:19], v[168:175], v74
  ds_read_b128 v[64:67], v75 offset:31744
  s_waitcnt lgkmcnt(4)
  v_smfmac_f32_16x16x64_bf16 v[20:23], v[12:15], v[176:183], v74
  s_waitcnt lgkmcnt(3)
  v_mov_b64 v[70:71], s[78:79]
  v_smfmac_f32_16x16x64_bf16 v[28:31], v[4:7], v[36:43], v74
  s_waitcnt lgkmcnt(2)
  v_mov_b64 v[36:37], 0
  v_smfmac_f32_16x16x64_bf16 v[20:23], v[8:11], v[192:199], v74
  v_mov_b64 v[38:39], 0
  v_smfmac_f32_16x16x64_bf16 v[24:27], v[12:15], v[184:191], v74
  v_mov_b64 v[40:41], 0
  v_smfmac_f32_16x16x64_bf16 v[24:27], v[8:11], v[200:207], v74
  s_waitcnt lgkmcnt(0)
  v_add_f32 v20, v20, v22
  v_smfmac_f32_16x16x64_bf16 v[32:35], v[4:7], v[60:67], v74
  v_add_f32 v21, v21, v23
  v_smfmac_f32_16x16x64_bf16 v[28:31], v[16:19], v[240:247], v74
  v_add_f32 v24, v24, v26
  v_cvt_pk_bf16_f32 v22, v20, v24
  v_smfmac_f32_16x16x64_bf16 v[28:31], v[12:15], a[0:7], v74
  ds_write_b32 v79, v22 offset:0
  v_add_f32 v25, v25, v27
  v_cvt_pk_bf16_f32 v23, v21, v25
  v_smfmac_f32_16x16x64_bf16 v[28:31], v[8:11], a[16:23], v74
  ds_write_b32 v79, v23 offset:576
  v_cmp_u_f32 vcc, v20, v21
  v_smfmac_f32_16x16x64_bf16 v[32:35], v[16:19], v[248:255], v74
  v_mov_b64 v[42:43], 0
  v_smfmac_f32_16x16x64_bf16 v[32:35], v[12:15], a[8:15], v74
  v_add_f32 v28, v28, v30
  v_add_f32 v29, v29, v31
  v_smfmac_f32_16x16x64_bf16 v[32:35], v[8:11], a[24:31], v74
  s_cbranch_vccnz Cs3_rec
Cs3_recok:
  v_smfmac_f32_16x16x64_bf16 v[36:39], v[16:19], a[128:135], v74
  s_waitcnt lgkmcnt(0)
  s_barrier
  ds_read_b128 v[60:63], v77
  v_smfmac_f32_16x16x64_bf16 v[40:43], v[16:19], a[136:143], v74
  ds_read_b128 v[64:67], v77 offset:128
  v_add_f32 v32, v32, v34
  v_cvt_pk_bf16_f32 v30, v28, v32
  v_smfmac_f32_16x16x64_bf16 v[36:39], v[0:3], a[96:103], v74
  ds_write_b32 v79, v30 offset:256
  v_add_f32 v33, v33, v35
  v_cvt_pk_bf16_f32 v31, v29, v33
  v_smfmac_f32_16x16x64_bf16 v[40:43], v[0:3], a[104:111], v74
  ds_write_b32 v79, v31 offset:832
  v_xor_b32 v75, 0x8000, v75
  v_smfmac_f32_16x16x64_bf16 v[36:39], v[4:7], a[112:119], v74
  ds_read_b128 v[0:3], v76 offset:4608
  v_mov_b32 v29, 0
  v_smfmac_f32_16x16x64_bf16 v[40:43], v[4:7], a[120:127], v74
  s_waitcnt vmcnt(4) lgkmcnt(3)
  v_mov_b32 v30, 0
  v_mfma_f32_16x16x32_bf16 v[44:47], v[44:47], v[60:63], 0
  ds_read_b128 v[4:7], v76 offset:5632
  s_waitcnt lgkmcnt(2)
  v_mfma_f32_16x16x32_bf16 v[44:47], v[48:51], v[64:67], v[44:47]
  s_barrier
  v_smfmac_f32_16x16x64_bf16 v[36:39], v[8:11], a[160:167], v74
  ds_read_b128 v[20:23], v77 offset:256
  ds_read_b128 v[24:27], v77 offset:384
  v_smfmac_f32_16x16x64_bf16 v[40:43], v[8:11], a[168:175], v74
  ds_read_b128 v[8:11], v76 offset:6656
  v_add_f32_dpp v72, v46, v44 quad_perm:[2,3,0,1] row_mask:0xf bank_mask:0xf
  v_add_f32_dpp v73, v47, v45 quad_perm:[2,3,0,1] row_mask:0xf bank_mask:0xf
  v_smfmac_f32_16x16x64_bf16 v[36:39], v[12:15], a[144:151], v74
  s_waitcnt lgkmcnt(4)
  v_exp_f32_dpp v72, v72 quad_perm:[0,1,0,1] row_mask:0xf bank_mask:0xf
  v_smfmac_f32_16x16x64_bf16 v[40:43], v[12:15], a[152:159], v74
  ds_read_b128 v[12:15], v76 offset:7680
  v_exp_f32_dpp v73, v73 quad_perm:[0,1,0,1] row_mask:0xf bank_mask:0xf
  v_smfmac_f32_16x16x64_bf16 v[36:39], v[0:3], a[32:39], v74
  s_waitcnt lgkmcnt(2)
  v_cvt_pk_bf16_f32 v72, v72, v73
  v_mfma_f32_16x16x32_bf16 v[20:23], v[20:23], v[60:63], 0
  ds_write_b32 v78, v72 offset:524
  v_mov_b64 v[16:17], 0
  v_mfma_f32_16x16x32_bf16 v[20:23], v[24:27], v[64:67], v[20:23]
  ds_read_b128 v[44:47], v75 offset:28672
  v_mov_b64 v[18:19], 0
  v_smfmac_f32_16x16x64_bf16 v[40:43], v[0:3], a[40:47], v74
  ds_read_b128 v[48:51], v75 offset:29696
  s_waitcnt lgkmcnt(4)
  v_smfmac_f32_16x16x64_bf16 v[36:39], v[4:7], a[48:55], v74
  v_add_f32_dpp v24, v22, v20 quad_perm:[2,3,0,1] row_mask:0xf bank_mask:0xf
  v_add_f32_dpp v25, v23, v21 quad_perm:[2,3,0,1] row_mask:0xf bank_mask:0xf
  v_smfmac_f32_16x16x64_bf16 v[36:39], v[8:11], a[64:71], v74
  s_waitcnt lgkmcnt(2)
  s_barrier
  ds_read_b128 v[32:35], v78 offset:512
  v_smfmac_f32_16x16x64_bf16 v[36:39], v[12:15], a[80:87], v74
  ds_read_b128 v[60:63], v75 offset:30720
  v_mul_f32 v24, s69, v24
  v_smfmac_f32_16x16x64_bf16 v[40:43], v[4:7], a[56:63], v74
  ds_read_b128 v[64:67], v75 offset:31744
  v_mul_f32 v25, s69, v25
  v_smfmac_f32_16x16x64_bf16 v[40:43], v[8:11], a[72:79], v74
  v_exp_f32_dpp v24, v24 quad_perm:[0,1,0,1] row_mask:0xf bank_mask:0xf
  v_smfmac_f32_16x16x64_bf16 v[40:43], v[12:15], a[88:95], v74
  s_waitcnt vmcnt(2) lgkmcnt(2)
  v_exp_f32_dpp v25, v25 quad_perm:[0,1,0,1] row_mask:0xf bank_mask:0xf
  v_mfma_f32_16x16x32_bf16 v[8:11], v[32:35], v[68:71], 0
  v_add_f32 v36, v36, v38
  v_add_f32 v37, v37, v39
  v_mfma_f32_16x16x32_bf16 v[0:3], v[32:35], v[52:55], 0
  v_add_f32 v40, v40, v42
  v_add_f32 v41, v41, v43
  v_mfma_f32_16x16x32_bf16 v[4:7], v[32:35], v[56:59], 0
  v_cvt_pk_bf16_f32 v28, v24, v25
  v_cvt_pk_bf16_f32 v72, v36, v37
  v_cvt_pk_bf16_f32 v73, v40, v41
  v_mfma_f32_16x16x16_bf16 v[8:11], v[28:29], v[68:69], v[8:11]
  v_cvt_pk_bf16_f32 v31, v24, v25
  v_mov_b64 v[20:21], 0
  v_mfma_f32_16x16x16_bf16 v[0:3], v[28:29], v[72:73], v[0:3]
  ds_read_b128 v[68:71], v76 offset:13824
  v_mov_b64 v[22:23], 0
  v_mfma_f32_16x16x16_bf16 v[4:7], v[30:31], v[72:73], v[4:7]
  v_rcp_f32 v10, v8
  v_rcp_f32 v11, v9
  v_mul_f32 v0, v10, v0
  v_mul_f32 v1, v11, v1
  s_nop 0
  v_mul_f32 v4, v10, v4
  v_mul_f32 v5, v11, v5
  v_cvt_pk_bf16_f32 v2, v0, v4
  ds_write_b32 v79, v2 offset:8704
  v_cvt_pk_bf16_f32 v3, v1, v5
  ds_write_b32 v79, v3 offset:9280
  v_max3_f32 v8, v8, v9, v10
  v_max_f32 v8, v8, v11
  v_cmp_le_f32 vcc, 1317011456, v8
  v_mov_b64 v[24:25], 0
  v_mov_b64 v[26:27], 0
  s_cbranch_vccnz Cs3_mx
Cs3_mxok:
  s_waitcnt lgkmcnt(0)
  s_barrier
  ds_read_b128 v[0:3], v78 offset:8704
  ds_read_b128 v[4:7], v78 offset:8768
  ds_read_b128 v[8:11], v78 offset:8832
  ds_read_b128 v[12:15], v78 offset:8896
  s_cmp_eq_u32 s66, 63
  s_cbranch_scc1 Cs3_last
  s_waitcnt lgkmcnt(3)
  v_smfmac_f32_16x16x64_bf16 v[16:19], v[0:3], v[44:51], v74
  ds_read_b128 v[52:55], v75 offset:45056
  s_waitcnt lgkmcnt(3)
  v_smfmac_f32_16x16x64_bf16 v[16:19], v[4:7], v[60:67], v74
  ds_read_b128 v[56:59], v75 offset:46080
  s_waitcnt lgkmcnt(3)
  v_smfmac_f32_16x16x64_bf16 v[16:19], v[8:11], a[176:183], v74
  ds_read_b128 v[36:39], v75 offset:47104
  s_waitcnt lgkmcnt(3)
  v_smfmac_f32_16x16x64_bf16 v[16:19], v[12:15], a[184:191], v74
  ds_read_b128 v[40:43], v75 offset:48128
  ds_read_b128 v[44:47], v75 offset:61440
  v_smfmac_f32_16x16x64_bf16 v[20:23], v[0:3], a[192:199], v74
  ds_read_b128 v[48:51], v75 offset:62464
  ds_read_b128 v[60:63], v75 offset:63488
  v_smfmac_f32_16x16x64_bf16 v[20:23], v[4:7], a[200:207], v74
  ds_read_b128 v[64:67], v75 offset:64512
  s_waitcnt lgkmcnt(6)
  v_cvt_pk_bf16_f32 v16, v16, v17
  v_cvt_pk_bf16_f32 v17, v18, v19
  v_bfi_b32 v16, 1, s72, v16
  v_smfmac_f32_16x16x64_bf16 v[20:23], v[8:11], v[52:59], v74
  buffer_store_dwordx2 v[16:17], v68, s[8:11], s73 offen sc1
  s_waitcnt lgkmcnt(4)
  v_smfmac_f32_16x16x64_bf16 v[20:23], v[12:15], v[36:43], v74
  ds_read_b128 v[52:55], v75 offset:8192
  v_mov_b64 v[32:33], 0
  v_smfmac_f32_16x16x64_bf16 v[24:27], v[0:3], a[208:215], v74
  ds_read_b128 v[56:59], v75 offset:9216
  v_mov_b64 v[34:35], 0
  v_smfmac_f32_16x16x64_bf16 v[24:27], v[4:7], a[216:223], v74
  ds_read_b128 v[36:39], v75 offset:10240
  s_waitcnt lgkmcnt(5)
  v_cvt_pk_bf16_f32 v20, v20, v21
  v_cvt_pk_bf16_f32 v21, v22, v23
  v_bfi_b32 v20, 1, s72, v20
  v_smfmac_f32_16x16x64_bf16 v[24:27], v[8:11], v[44:51], v74
  buffer_store_dwordx2 v[20:21], v68, s[8:11], s74 offen sc1
  s_waitcnt lgkmcnt(3)
  v_smfmac_f32_16x16x64_bf16 v[24:27], v[12:15], v[60:67], v74
  ds_read_b128 v[40:43], v75 offset:11264
  v_mov_b64 v[28:29], 0
  v_smfmac_f32_16x16x64_bf16 v[32:35], v[0:3], a[224:231], v74
  ds_read_b128 v[44:47], v75 offset:12288
  ds_read_b128 v[48:51], v75 offset:13312
  v_smfmac_f32_16x16x64_bf16 v[32:35], v[4:7], a[232:239], v74
  ds_read_b128 v[60:63], v75 offset:14336
  v_cvt_pk_bf16_f32 v24, v24, v25
  v_cvt_pk_bf16_f32 v25, v26, v27
  v_bfi_b32 v24, 1, s72, v24
  v_smfmac_f32_16x16x64_bf16 v[32:35], v[8:11], a[240:247], v74
  buffer_store_dwordx2 v[24:25], v68, s[8:11], s75 offen sc1
  v_mov_b64 v[30:31], 0
  v_smfmac_f32_16x16x64_bf16 v[32:35], v[12:15], a[248:255], v74
  ds_read_b128 v[64:67], v75 offset:15360
  s_waitcnt lgkmcnt(6)
  v_smfmac_f32_16x16x64_bf16 v[28:31], v[0:3], v[52:59], v74
  s_waitcnt lgkmcnt(4)
  v_smfmac_f32_16x16x64_bf16 v[28:31], v[4:7], v[36:43], v74
  s_waitcnt lgkmcnt(2)
  v_cvt_pk_bf16_f32 v32, v32, v33
  v_cvt_pk_bf16_f32 v33, v34, v35
  v_bfi_b32 v32, 1, s72, v32
  v_smfmac_f32_16x16x64_bf16 v[28:31], v[8:11], v[44:51], v74
  buffer_store_dwordx2 v[32:33], v68, s[8:11], s76 offen sc1
  s_waitcnt lgkmcnt(0)
  v_smfmac_f32_16x16x64_bf16 v[28:31], v[12:15], v[60:67], v74
  ds_read_b128 v[52:55], v76 offset:14848
  ds_read_b64 v[16:17], v77 offset:392
  v_mov_b64 v[18:19], v[72:73]
  v_xor_b32 v75, 0x8000, v75
  s_nop 3
  v_cvt_pk_bf16_f32 v28, v28, v29
  v_cvt_pk_bf16_f32 v29, v30, v31
  v_bfi_b32 v28, 1, s72, v28
  buffer_store_dwordx2 v[28:29], v68, s[8:11], s77 offen sc1
  v_mov_b64 v[20:21], 0
  v_mov_b64 v[22:23], 0
  v_mov_b64 v[24:25], 0
  v_mov_b64 v[26:27], 0
  v_mov_b64 v[28:29], 0
  v_mov_b64 v[30:31], 0
  v_mov_b64 v[32:33], 0
  v_mov_b64 v[34:35], 0
  s_add_u32 s58, s58, 655360
  s_add_u32 s59, s59, 655360
  s_add_u32 s70, s70, 655360
  s_add_u32 s68, s68, 655360
  s_add_u32 s66, s66, 1
  s_xor_b32 s64, s64, 16384
  s_xor_b32 s65, s65, 16384
  s_nop 15
  s_nop 15
  s_nop 15
  s_nop 9
  buffer_load_dwordx4 v[0:3], v76, s[8:11], s60 offen offset:0 sc1
  buffer_load_dwordx4 v[4:7], v76, s[8:11], s60 offen offset:1024 sc1
  buffer_load_dwordx4 v[8:11], v76, s[8:11], s61 offen offset:0 sc1
  buffer_load_dwordx4 v[12:15], v76, s[8:11], s61 offen offset:1024 sc1
  s_nop 15
  s_nop 11
  buffer_load_dwordx4 v[44:47], v76, s[8:11], s60 offen offset:0 sc1
  buffer_load_dwordx4 v[48:51], v76, s[8:11], s60 offen offset:1024 sc1
  buffer_load_dwordx4 v[60:63], v76, s[8:11], s61 offen offset:0 sc1
  buffer_load_dwordx4 v[64:67], v76, s[8:11], s61 offen offset:1024 sc1
  s_waitcnt lgkmcnt(0)
  s_cmp_eq_u32 s66, 12
  s_cbranch_scc1 Cs3_kv
Cs3_kvb:
  s_waitcnt vmcnt(7)
  v_mfma_f32_16x16x32_bf16 v[56:59], v[52:55], v[0:3], 0
  v_bitop3_b32 v72, v0, v2, s72 bitop3:0x7e
  s_waitcnt vmcnt(6)
  v_mfma_f32_16x16x32_bf16 v[56:59], v[52:55], v[4:7], v[56:59]
  v_bitop3_b32 v73, v4, v6, s72 bitop3:0x7e
  v_or_b32 v72, v72, v73
  s_waitcnt vmcnt(5)
  v_mfma_f32_16x16x32_bf16 v[36:39], v[52:55], v[8:11], 0
  v_bitop3_b32 v73, v8, v10, s72 bitop3:0x7e
  v_or_b32 v72, v72, v73
  s_waitcnt vmcnt(4)
  v_mfma_f32_16x16x32_bf16 v[36:39], v[52:55], v[12:15], v[36:39]
  v_bitop3_b32 v73, v12, v14, s72 bitop3:0x7e
  v_bitop3_b32 v72, v72, v73, 1 bitop3:0xa8
  v_cmp_ne_u32 vcc, 0, v72
  s_nop 0
  s_cmp_eq_u64 vcc, 0
  s_cselect_b32 s54, s62, 268435456
  s_cselect_b32 s55, s63, 268435456
  v_add_f32_dpp v56, v56, v56 row_ror:4 row_mask:0xf bank_mask:0xf
  v_add_f32_dpp v57, v57, v57 row_ror:4 row_mask:0xf bank_mask:0xf
  v_add_f32_dpp v36, v36, v36 row_ror:4 row_mask:0xf bank_mask:0xf
  v_add_f32_dpp v37, v37, v37 row_ror:4 row_mask:0xf bank_mask:0xf
  v_add_f32_dpp v56, v56, v56 row_ror:8 row_mask:0xf bank_mask:0xf
  v_add_f32_dpp v57, v57, v57 row_ror:8 row_mask:0xf bank_mask:0xf
  v_add_f32_dpp v36, v36, v36 row_ror:8 row_mask:0xf bank_mask:0xf
  v_add_f32_dpp v37, v37, v37 row_ror:8 row_mask:0xf bank_mask:0xf
  v_cvt_pk_bf16_f32 v56, v56, v57
  buffer_store_dword v56, v69, s[8:11], s54 offen sc1
  v_cvt_pk_bf16_f32 v36, v36, v37
  buffer_store_dword v36, v70, s[8:11], s55 offen sc1
  s_cbranch_vccnz Cs3_h1r
  s_xor_b32 s62, s62, 16384
  buffer_store_dword v71, v69, s[8:11], s62 offen sc1
  s_xor_b32 s63, s63, 16384
  buffer_store_dword v71, v70, s[8:11], s63 offen sc1
  s_xor_b32 s72, s72, 1
  s_branch Cs3_h2
Cs3_h1r:
  s_mov_b64 exec, vcc
  buffer_load_dwordx4 v[0:3], v76, s[8:11], s60 offen offset:0 sc1
  buffer_load_dwordx4 v[4:7], v76, s[8:11], s60 offen offset:1024 sc1
  buffer_load_dwordx4 v[8:11], v76, s[8:11], s61 offen offset:0 sc1
  buffer_load_dwordx4 v[12:15], v76, s[8:11], s61 offen offset:1024 sc1
  s_mov_b64 exec, -1
  s_add_u32 s67, s67, 1
  s_waitcnt vmcnt(9)
  v_mfma_f32_16x16x32_bf16 v[56:59], v[52:55], v[44:47], 0
  v_bitop3_b32 v72, v44, v46, s72 bitop3:0x7e
  s_waitcnt vmcnt(8)
  v_mfma_f32_16x16x32_bf16 v[56:59], v[52:55], v[48:51], v[56:59]
  v_bitop3_b32 v73, v48, v50, s72 bitop3:0x7e
  v_or_b32 v72, v72, v73
  s_waitcnt vmcnt(7)
  v_mfma_f32_16x16x32_bf16 v[36:39], v[52:55], v[60:63], 0
  v_bitop3_b32 v73, v60, v62, s72 bitop3:0x7e
  v_or_b32 v72, v72, v73
  s_waitcnt vmcnt(6)
  v_mfma_f32_16x16x32_bf16 v[36:39], v[52:55], v[64:67], v[36:39]
  v_bitop3_b32 v73, v64, v66, s72 bitop3:0x7e
  v_bitop3_b32 v72, v72, v73, 1 bitop3:0xa8
  v_cmp_ne_u32 vcc, 0, v72
  s_cbranch_vccz Cs3_h1p
  s_mov_b64 exec, vcc
  buffer_load_dwordx4 v[44:47], v76, s[8:11], s60 offen offset:0 sc1
  buffer_load_dwordx4 v[48:51], v76, s[8:11], s60 offen offset:1024 sc1
  buffer_load_dwordx4 v[60:63], v76, s[8:11], s61 offen offset:0 sc1
  buffer_load_dwordx4 v[64:67], v76, s[8:11], s61 offen offset:1024 sc1
  s_mov_b64 exec, -1
  s_add_u32 s67, s67, 1
  s_waitcnt vmcnt(7)
  v_mfma_f32_16x16x32_bf16 v[56:59], v[52:55], v[0:3], 0
  v_bitop3_b32 v72, v0, v2, s72 bitop3:0x7e
  s_waitcnt vmcnt(6)
  v_mfma_f32_16x16x32_bf16 v[56:59], v[52:55], v[4:7], v[56:59]
  v_bitop3_b32 v73, v4, v6, s72 bitop3:0x7e
  v_or_b32 v72, v72, v73
  s_waitcnt vmcnt(5)
  v_mfma_f32_16x16x32_bf16 v[36:39], v[52:55], v[8:11], 0
  v_bitop3_b32 v73, v8, v10, s72 bitop3:0x7e
  v_or_b32 v72, v72, v73
  s_waitcnt vmcnt(4)
  v_mfma_f32_16x16x32_bf16 v[36:39], v[52:55], v[12:15], v[36:39]
  v_bitop3_b32 v73, v12, v14, s72 bitop3:0x7e
  v_bitop3_b32 v72, v72, v73, 1 bitop3:0xa8
  v_cmp_ne_u32 vcc, 0, v72
  s_cbranch_vccz Cs3_h1p
Cs3_h1s:
  s_mov_b64 exec, vcc
  buffer_load_dwordx4 v[0:3], v76, s[8:11], s60 offen offset:0 sc1
  buffer_load_dwordx4 v[4:7], v76, s[8:11], s60 offen offset:1024 sc1
  buffer_load_dwordx4 v[8:11], v76, s[8:11], s61 offen offset:0 sc1
  buffer_load_dwordx4 v[12:15], v76, s[8:11], s61 offen offset:1024 sc1
  s_mov_b64 exec, -1
  s_add_u32 s67, s67, 1
  s_waitcnt vmcnt(7)
  v_mfma_f32_16x16x32_bf16 v[56:59], v[52:55], v[44:47], 0
  v_bitop3_b32 v72, v44, v46, s72 bitop3:0x7e
  s_waitcnt vmcnt(6)
  v_mfma_f32_16x16x32_bf16 v[56:59], v[52:55], v[48:51], v[56:59]
  v_bitop3_b32 v73, v48, v50, s72 bitop3:0x7e
  v_or_b32 v72, v72, v73
  s_waitcnt vmcnt(5)
  v_mfma_f32_16x16x32_bf16 v[36:39], v[52:55], v[60:63], 0
  v_bitop3_b32 v73, v60, v62, s72 bitop3:0x7e
  v_or_b32 v72, v72, v73
  s_waitcnt vmcnt(4)
  v_mfma_f32_16x16x32_bf16 v[36:39], v[52:55], v[64:67], v[36:39]
  v_bitop3_b32 v73, v64, v66, s72 bitop3:0x7e
  v_bitop3_b32 v72, v72, v73, 1 bitop3:0xa8
  v_cmp_ne_u32 vcc, 0, v72
  s_cbranch_vccz Cs3_h1p
  s_mov_b64 exec, vcc
  buffer_load_dwordx4 v[44:47], v76, s[8:11], s60 offen offset:0 sc1
  buffer_load_dwordx4 v[48:51], v76, s[8:11], s60 offen offset:1024 sc1
  buffer_load_dwordx4 v[60:63], v76, s[8:11], s61 offen offset:0 sc1
  buffer_load_dwordx4 v[64:67], v76, s[8:11], s61 offen offset:1024 sc1
  s_mov_b64 exec, -1
  s_add_u32 s67, s67, 1
  s_waitcnt vmcnt(7)
  v_mfma_f32_16x16x32_bf16 v[56:59], v[52:55], v[0:3], 0
  v_bitop3_b32 v72, v0, v2, s72 bitop3:0x7e
  s_waitcnt vmcnt(6)
  v_mfma_f32_16x16x32_bf16 v[56:59], v[52:55], v[4:7], v[56:59]
  v_bitop3_b32 v73, v4, v6, s72 bitop3:0x7e
  v_or_b32 v72, v72, v73
  s_waitcnt vmcnt(5)
  v_mfma_f32_16x16x32_bf16 v[36:39], v[52:55], v[8:11], 0
  v_bitop3_b32 v73, v8, v10, s72 bitop3:0x7e
  v_or_b32 v72, v72, v73
  s_waitcnt vmcnt(4)
  v_mfma_f32_16x16x32_bf16 v[36:39], v[52:55], v[12:15], v[36:39]
  v_bitop3_b32 v73, v12, v14, s72 bitop3:0x7e
  v_bitop3_b32 v72, v72, v73, 1 bitop3:0xa8
  v_cmp_ne_u32 vcc, 0, v72
  s_cbranch_vccz Cs3_h1p
  s_cmp_lt_u32 s67, 131072
  s_cbranch_scc1 Cs3_h1s
Cs3_h1p:
  s_nop 2
  v_add_f32_dpp v56, v56, v56 row_ror:4 row_mask:0xf bank_mask:0xf
  v_add_f32_dpp v57, v57, v57 row_ror:4 row_mask:0xf bank_mask:0xf
  v_add_f32_dpp v36, v36, v36 row_ror:4 row_mask:0xf bank_mask:0xf
  v_add_f32_dpp v37, v37, v37 row_ror:4 row_mask:0xf bank_mask:0xf
  v_add_f32_dpp v56, v56, v56 row_ror:8 row_mask:0xf bank_mask:0xf
  v_add_f32_dpp v57, v57, v57 row_ror:8 row_mask:0xf bank_mask:0xf
  v_add_f32_dpp v36, v36, v36 row_ror:8 row_mask:0xf bank_mask:0xf
  v_add_f32_dpp v37, v37, v37 row_ror:8 row_mask:0xf bank_mask:0xf
  v_cvt_pk_bf16_f32 v56, v56, v57
  buffer_store_dword v56, v69, s[8:11], s62 offen sc1
  v_cvt_pk_bf16_f32 v36, v36, v37
  buffer_store_dword v36, v70, s[8:11], s63 offen sc1
  s_xor_b32 s62, s62, 16384
  buffer_store_dword v71, v69, s[8:11], s62 offen sc1
  s_xor_b32 s63, s63, 16384
  buffer_store_dword v71, v70, s[8:11], s63 offen sc1
  s_xor_b32 s72, s72, 1
  s_branch Cs3_h2
Cs3_rec:
  s_nop 7
  s_waitcnt vmcnt(0) lgkmcnt(0)
  v_max3_u32 v72, v0, v1, v2
  v_max3_u32 v72, v72, v3, v4
  v_max3_u32 v72, v72, v5, v6
  v_max3_u32 v72, v72, v7, v8
  v_max3_u32 v72, v72, v9, v10
  v_max3_u32 v72, v72, v11, v12
  v_max3_u32 v72, v72, v13, v14
  v_max3_u32 v72, v72, v15, v16
  v_max3_u32 v72, v72, v17, v18
  v_max_u32 v72, v72, v19
  v_cmp_eq_u32 vcc, -1, v72
  s_cbranch_vccz Cs3_recok
  s_barrier
Cs3_recp:
  buffer_load_dwordx4 v[0:3], v76, s[8:11], s64 offen offset:0 sc1
  buffer_load_dwordx4 v[4:7], v76, s[8:11], s64 offen offset:1024 sc1
  buffer_load_dwordx4 v[8:11], v76, s[8:11], s64 offen offset:2048 sc1
  s_add_u32 s67, s67, 1
  s_cmp_lt_u32 s67, 131072
  s_cselect_b32 s54, -2, -1
  s_waitcnt vmcnt(2)
  v_max3_u32 v72, v0, v1, v2
  s_waitcnt vmcnt(1)
  v_max3_u32 v72, v72, v3, v4
  v_max3_u32 v72, v72, v5, v6
  s_waitcnt vmcnt(0)
  v_max3_u32 v72, v72, v7, v8
  v_max3_u32 v72, v72, v9, v10
  v_max_u32 v72, v72, v11
  v_cmp_lt_u32 vcc, s54, v72
  s_cbranch_vccnz Cs3_recp
  ds_write_b128 v76, v[0:3] offset:10752
  ds_write_b128 v76, v[4:7] offset:11776
  ds_write_b128 v76, v[8:11] offset:12800
  v_mov_b64 v[20:21], 0
  v_mov_b64 v[22:23], 0
  v_mov_b64 v[24:25], 0
  v_mov_b64 v[26:27], 0
  v_mov_b64 v[28:29], 0
  v_mov_b64 v[30:31], 0
  v_mov_b64 v[32:33], 0
  v_mov_b64 v[34:35], 0
  s_waitcnt lgkmcnt(0)
  s_barrier
  ds_read_b128 v[0:3], v76 offset:4608
  ds_read_b128 v[60:63], v76 offset:28672
  ds_read_b128 v[64:67], v76 offset:29696
  s_waitcnt lgkmcnt(0)
  v_smfmac_f32_16x16x64_bf16 v[20:23], v[0:3], v[60:67], v74
  ds_read_b128 v[60:63], v76 offset:30720
  ds_read_b128 v[64:67], v76 offset:31744
  s_waitcnt lgkmcnt(0)
  v_smfmac_f32_16x16x64_bf16 v[24:27], v[0:3], v[60:67], v74
  ds_read_b128 v[60:63], v76 offset:45056
  ds_read_b128 v[64:67], v76 offset:46080
  s_waitcnt lgkmcnt(0)
  v_smfmac_f32_16x16x64_bf16 v[28:31], v[0:3], v[60:67], v74
  ds_read_b128 v[60:63], v76 offset:47104
  ds_read_b128 v[64:67], v76 offset:48128
  s_waitcnt lgkmcnt(0)
  v_smfmac_f32_16x16x64_bf16 v[32:35], v[0:3], v[60:67], v74
  ds_read_b128 v[4:7], v76 offset:5632
  s_waitcnt lgkmcnt(0)
  v_smfmac_f32_16x16x64_bf16 v[20:23], v[4:7], v[80:87], v74
  v_smfmac_f32_16x16x64_bf16 v[24:27], v[4:7], v[88:95], v74
  v_smfmac_f32_16x16x64_bf16 v[28:31], v[4:7], v[208:215], v74
  v_smfmac_f32_16x16x64_bf16 v[32:35], v[4:7], v[216:223], v74
  ds_read_b128 v[8:11], v76 offset:6656
  s_waitcnt lgkmcnt(0)
  v_smfmac_f32_16x16x64_bf16 v[20:23], v[8:11], v[96:103], v74
  v_smfmac_f32_16x16x64_bf16 v[24:27], v[8:11], v[104:111], v74
  ds_read_b128 v[60:63], v76 offset:61440
  ds_read_b128 v[64:67], v76 offset:62464
  s_waitcnt lgkmcnt(0)
  v_smfmac_f32_16x16x64_bf16 v[28:31], v[8:11], v[60:67], v74
  ds_read_b128 v[60:63], v76 offset:63488
  ds_read_b128 v[64:67], v76 offset:64512
  s_waitcnt lgkmcnt(0)
  v_smfmac_f32_16x16x64_bf16 v[32:35], v[8:11], v[60:67], v74
  ds_read_b128 v[12:15], v76 offset:7680
  s_waitcnt lgkmcnt(0)
  v_smfmac_f32_16x16x64_bf16 v[20:23], v[12:15], v[112:119], v74
  v_smfmac_f32_16x16x64_bf16 v[24:27], v[12:15], v[120:127], v74
  v_smfmac_f32_16x16x64_bf16 v[28:31], v[12:15], v[224:231], v74
  v_smfmac_f32_16x16x64_bf16 v[32:35], v[12:15], v[232:239], v74
  ds_read_b128 v[0:3], v76 offset:8704
  s_waitcnt lgkmcnt(0)
  v_smfmac_f32_16x16x64_bf16 v[20:23], v[0:3], v[128:135], v74
  v_smfmac_f32_16x16x64_bf16 v[24:27], v[0:3], v[136:143], v74
  ds_read_b128 v[60:63], v75 offset:12288
  ds_read_b128 v[64:67], v75 offset:13312
  s_waitcnt lgkmcnt(0)
  v_smfmac_f32_16x16x64_bf16 v[28:31], v[0:3], v[60:67], v74
  ds_read_b128 v[60:63], v75 offset:14336
  ds_read_b128 v[64:67], v75 offset:15360
  s_waitcnt lgkmcnt(0)
  v_smfmac_f32_16x16x64_bf16 v[32:35], v[0:3], v[60:67], v74
  ds_read_b128 v[4:7], v76 offset:9728
  s_waitcnt lgkmcnt(0)
  v_smfmac_f32_16x16x64_bf16 v[20:23], v[4:7], v[144:151], v74
  v_smfmac_f32_16x16x64_bf16 v[24:27], v[4:7], v[152:159], v74
  ds_read_b128 v[60:63], v75 offset:28672
  ds_read_b128 v[64:67], v75 offset:29696
  s_waitcnt lgkmcnt(0)
  v_smfmac_f32_16x16x64_bf16 v[28:31], v[4:7], v[60:67], v74
  ds_read_b128 v[60:63], v75 offset:30720
  ds_read_b128 v[64:67], v75 offset:31744
  s_waitcnt lgkmcnt(0)
  v_smfmac_f32_16x16x64_bf16 v[32:35], v[4:7], v[60:67], v74
  ds_read_b128 v[16:19], v76 offset:10752
  s_waitcnt lgkmcnt(0)
  v_smfmac_f32_16x16x64_bf16 v[20:23], v[16:19], v[160:167], v74
  v_smfmac_f32_16x16x64_bf16 v[24:27], v[16:19], v[168:175], v74
  v_smfmac_f32_16x16x64_bf16 v[28:31], v[16:19], v[240:247], v74
  v_smfmac_f32_16x16x64_bf16 v[32:35], v[16:19], v[248:255], v74
  ds_read_b128 v[12:15], v76 offset:11776
  s_waitcnt lgkmcnt(0)
  v_smfmac_f32_16x16x64_bf16 v[20:23], v[12:15], v[176:183], v74
  v_smfmac_f32_16x16x64_bf16 v[24:27], v[12:15], v[184:191], v74
  v_smfmac_f32_16x16x64_bf16 v[28:31], v[12:15], a[0:7], v74
  v_smfmac_f32_16x16x64_bf16 v[32:35], v[12:15], a[8:15], v74
  ds_read_b128 v[8:11], v76 offset:12800
  s_waitcnt lgkmcnt(0)
  v_smfmac_f32_16x16x64_bf16 v[20:23], v[8:11], v[192:199], v74
  v_smfmac_f32_16x16x64_bf16 v[24:27], v[8:11], v[200:207], v74
  v_smfmac_f32_16x16x64_bf16 v[28:31], v[8:11], a[16:23], v74
  v_smfmac_f32_16x16x64_bf16 v[32:35], v[8:11], a[24:31], v74
  v_add_f32 v20, v20, v22
  v_add_f32 v21, v21, v23
  v_add_f32 v24, v24, v26
  v_cvt_pk_bf16_f32 v22, v20, v24
  s_nop 0
  ds_write_b32 v79, v22 offset:0
  v_add_f32 v25, v25, v27
  v_cvt_pk_bf16_f32 v23, v21, v25
  ds_write_b32 v79, v23 offset:576
  v_add_f32 v28, v28, v30
  v_add_f32 v29, v29, v31
  s_waitcnt lgkmcnt(0)
  s_nop 1
  s_branch Cs3_recok
Cs3_mx:
  s_waitcnt lgkmcnt(0)
  s_barrier
  buffer_load_dwordx4 v[0:3], v76, s[8:11], s58 offen offset:0 sc1
  ds_read_b128 v[20:23], v77 offset:0
  ds_read_b128 v[28:31], v77 offset:256
  buffer_load_dwordx4 v[4:7], v76, s[8:11], s58 offen offset:1024 sc1
  ds_read_b128 v[24:27], v77 offset:128
  ds_read_b128 v[32:35], v77 offset:384
  s_waitcnt vmcnt(1) lgkmcnt(3)
  v_mfma_f32_16x16x32_bf16 v[8:11], v[0:3], v[20:23], 0
  s_waitcnt vmcnt(0) lgkmcnt(1)
  v_mfma_f32_16x16x32_bf16 v[8:11], v[4:7], v[24:27], v[8:11]
  v_mfma_f32_16x16x32_bf16 v[12:15], v[28:31], v[20:23], 0
  s_waitcnt lgkmcnt(0)
  v_mfma_f32_16x16x32_bf16 v[12:15], v[32:35], v[24:27], v[12:15]
  v_add_f32_dpp v8, v10, v8 quad_perm:[2,3,0,1] row_mask:0xf bank_mask:0xf
  v_add_f32_dpp v9, v11, v9 quad_perm:[2,3,0,1] row_mask:0xf bank_mask:0xf
  s_nop 0
  v_mov_b32_dpp v8, v8 quad_perm:[0,1,0,1] row_mask:0xf bank_mask:0xf
  v_mov_b32_dpp v9, v9 quad_perm:[0,1,0,1] row_mask:0xf bank_mask:0xf
  s_nop 1
  v_add_f32_dpp v12, v14, v12 quad_perm:[2,3,0,1] row_mask:0xf bank_mask:0xf
  v_add_f32_dpp v13, v15, v13 quad_perm:[2,3,0,1] row_mask:0xf bank_mask:0xf
  s_nop 0
  v_mov_b32_dpp v12, v12 quad_perm:[0,1,0,1] row_mask:0xf bank_mask:0xf
  v_mov_b32_dpp v13, v13 quad_perm:[0,1,0,1] row_mask:0xf bank_mask:0xf
  v_mul_f32 v12, s69, v12
  ds_write_b32 v78, v8 offset:8716
  v_mul_f32 v13, s69, v13
  ds_write_b32 v78, v9 offset:8780
  s_waitcnt lgkmcnt(0)
  s_barrier
  ds_read_b128 v[36:39], v78 offset:8704
  ds_read_b128 v[40:43], v78 offset:8768
  s_waitcnt lgkmcnt(0)
  s_barrier
  v_max_f32 v16, v36, v37
  v_max3_f32 v16, v16, v38, v39
  v_max3_f32 v16, v16, v40, v41
  v_max3_f32 v16, v16, v42, v43
  v_max3_f32 v16, v16, v12, v13
  v_mov_b32 v17, v16
  s_nop 1
  v_permlane16_swap_b32 v16, v17
  v_max_f32 v16, v16, v17
  v_mov_b32 v17, v16
  s_nop 1
  v_permlane32_swap_b32 v16, v17
  v_max_f32 v16, v16, v17
  v_sub_f32 v36, v36, v16
  v_sub_f32 v37, v37, v16
  v_sub_f32 v38, v38, v16
  v_sub_f32 v39, v39, v16
  v_sub_f32 v40, v40, v16
  v_sub_f32 v41, v41, v16
  v_sub_f32 v42, v42, v16
  v_sub_f32 v43, v43, v16
  v_sub_f32 v12, v12, v16
  v_sub_f32 v13, v13, v16
  v_exp_f32 v36, v36
  v_exp_f32 v37, v37
  v_exp_f32 v38, v38
  v_exp_f32 v39, v39
  v_exp_f32 v40, v40
  v_exp_f32 v41, v41
  v_exp_f32 v42, v42
  v_exp_f32 v43, v43
  v_exp_f32 v12, v12
  v_exp_f32 v13, v13
  v_cvt_pk_bf16_f32 v32, v36, v40
  v_cvt_pk_bf16_f32 v33, v37, v41
  v_cvt_pk_bf16_f32 v34, v38, v42
  v_cvt_pk_bf16_f32 v35, v39, v43
  v_cvt_pk_bf16_f32 v28, v12, v13
  v_cvt_pk_bf16_f32 v31, v12, v13
  v_mov_b32 v29, 0
  v_mov_b32 v30, 0
  v_mov_b32 v68, 0x3f803f80
  v_mov_b32 v69, 0x3f803f80
  v_mov_b32 v70, 0x3f803f80
  v_mov_b32 v71, 0x3f803f80
  s_nop 1
  v_mfma_f32_16x16x32_bf16 v[8:11], v[32:35], v[68:71], 0
  v_mfma_f32_16x16x32_bf16 v[0:3], v[32:35], v[52:55], 0
  v_mfma_f32_16x16x32_bf16 v[4:7], v[32:35], v[56:59], 0
  v_mfma_f32_16x16x16_bf16 v[8:11], v[28:29], v[68:69], v[8:11]
  v_mfma_f32_16x16x16_bf16 v[0:3], v[28:29], v[72:73], v[0:3]
  v_mfma_f32_16x16x16_bf16 v[4:7], v[30:31], v[72:73], v[4:7]
  ds_read_b128 v[68:71], v76 offset:13824
  v_rcp_f32 v10, v8
  v_rcp_f32 v11, v9
  v_mul_f32 v0, v10, v0
  v_mul_f32 v1, v11, v1
  s_nop 0
  v_mul_f32 v4, v10, v4
  v_mul_f32 v5, v11, v5
  v_cvt_pk_bf16_f32 v2, v0, v4
  ds_write_b32 v79, v2 offset:8704
  v_cvt_pk_bf16_f32 v3, v1, v5
  ds_write_b32 v79, v3 offset:9280
  v_mov_b64 v[16:17], 0
  v_mov_b64 v[18:19], 0
  v_mov_b64 v[20:21], 0
  v_mov_b64 v[22:23], 0
  v_mov_b64 v[24:25], 0
  v_mov_b64 v[26:27], 0
  s_branch Cs3_mxok
Cs3_kv:
  s_lshl_b32 s56, s53, 2
  s_add_u32 s56, s56, 128
  s_load_dword s57, s[12:13], s56 glc
  s_branch Cs3_kvb
Cs3_kv2:
  s_waitcnt lgkmcnt(0)
  s_cmp_ge_u32 s57, 0x700
  s_cbranch_scc1 Cs3_h2w
  s_load_dword s57, s[12:13], s56 glc
  s_add_u32 s67, s67, 1
  s_cmp_lt_u32 s67, 131072
  s_cbranch_scc1 Cs3_kv2
  s_branch Cs3_h2w
Cs3_last:
  s_waitcnt lgkmcnt(0)
  ds_read_b64 v[16:17], v77 offset:392
  v_mov_b64 v[18:19], v[72:73]
  s_add_u32 s68, s68, 655360
  s_waitcnt lgkmcnt(0)
  buffer_store_dwordx4 v[16:19], v76, s[8:11], s68 offen sc1
  s_branch L_cexit
L_conf:
  s_waitcnt vmcnt(0) lgkmcnt(0)
  s_barrier
  s_cmp_eq_u32 s52, 0
  s_cbranch_scc0 L_cf2
  s_mov_b64 exec, 1
  s_lshl_b32 s57, s2, 2
  v_mov_b32 v1, 0
L_cf0:
  s_cmp_eq_u32 s54, -1
  s_cbranch_scc1 L_cf1
  s_mov_b32 s55, s54
  s_lshr_b64 s[54:55], s[54:55], s0
  s_ff0_i32_b32 s56, s54
  s_add_u32 s0, s0, s56
  s_and_b32 s0, s0, 31
  s_lshl_b32 s56, 1, s0
  v_mov_b32 v35, s56
  buffer_atomic_or v35, v1, s[12:15], s57 offen sc0
  s_waitcnt vmcnt(0)
  v_readfirstlane_b32 s54, v35
  s_nop 0
  s_bitcmp1_b32 s54, s0
  s_cbranch_scc1 L_cf0
  v_mov_b32 v35, s0
  s_branch L_cf3
L_cf1:
  v_mov_b32 v35, 1
  buffer_atomic_add v35, v1, s[12:15], 0 offen offset:40 sc0
  s_waitcnt vmcnt(0)
  v_add_u32 v35, 32, v35
L_cf3:
  ds_write_b32 v33, v35
  s_mov_b64 exec, -1
  s_waitcnt lgkmcnt(0)
L_cf2:
  s_barrier
  ds_read_b32 v32, v33
  s_waitcnt lgkmcnt(0)
  v_readfirstlane_b32 s0, v32
  s_mov_b32 s1, 1
  s_cmp_lt_u32 s0, 32
  s_cbranch_scc1 L_role
  s_sub_u32 s53, s0, 32
  s_mov_b32 s57, 0
L_sur:
  s_load_dwordx16 s[60:75], s[12:13], 0 glc
  s_add_u32 s57, s57, 1
  s_waitcnt lgkmcnt(0)
  s_mov_b32 s55, s70
  s_bcnt1_i32_b32 s56, s60
  s_add_u32 s55, s55, s56
  s_bcnt1_i32_b32 s56, s61
  s_add_u32 s55, s55, s56
  s_bcnt1_i32_b32 s56, s62
  s_add_u32 s55, s55, s56
  s_bcnt1_i32_b32 s56, s63
  s_add_u32 s55, s55, s56
  s_bcnt1_i32_b32 s56, s64
  s_add_u32 s55, s55, s56
  s_bcnt1_i32_b32 s56, s65
  s_add_u32 s55, s55, s56
  s_bcnt1_i32_b32 s56, s66
  s_add_u32 s55, s55, s56
  s_bcnt1_i32_b32 s56, s67
  s_add_u32 s55, s55, s56
  s_cmp_ge_u32 s57, 131072
  s_cbranch_scc1 L_end
  s_cmp_lt_u32 s55, 256
  s_cbranch_scc1 L_sur
  s_mov_b32 s2, 0
  s_mov_b32 s54, s60
  s_bcnt0_i32_b32 s56, s54
  s_cmp_lt_u32 s53, s56
  s_cbranch_scc1 L_sur2
  s_sub_u32 s53, s53, s56
  s_mov_b32 s2, 1
  s_mov_b32 s54, s61
  s_bcnt0_i32_b32 s56, s54
  s_cmp_lt_u32 s53, s56
  s_cbranch_scc1 L_sur2
  s_sub_u32 s53, s53, s56
  s_mov_b32 s2, 2
  s_mov_b32 s54, s62
  s_bcnt0_i32_b32 s56, s54
  s_cmp_lt_u32 s53, s56
  s_cbranch_scc1 L_sur2
  s_sub_u32 s53, s53, s56
  s_mov_b32 s2, 3
  s_mov_b32 s54, s63
  s_bcnt0_i32_b32 s56, s54
  s_cmp_lt_u32 s53, s56
  s_cbranch_scc1 L_sur2
  s_sub_u32 s53, s53, s56
  s_mov_b32 s2, 4
  s_mov_b32 s54, s64
  s_bcnt0_i32_b32 s56, s54
  s_cmp_lt_u32 s53, s56
  s_cbranch_scc1 L_sur2
  s_sub_u32 s53, s53, s56
  s_mov_b32 s2, 5
  s_mov_b32 s54, s65
  s_bcnt0_i32_b32 s56, s54
  s_cmp_lt_u32 s53, s56
  s_cbranch_scc1 L_sur2
  s_sub_u32 s53, s53, s56
  s_mov_b32 s2, 6
  s_mov_b32 s54, s66
  s_bcnt0_i32_b32 s56, s54
  s_cmp_lt_u32 s53, s56
  s_cbranch_scc1 L_sur2
  s_sub_u32 s53, s53, s56
  s_mov_b32 s2, 7
  s_mov_b32 s54, s67
  s_bcnt0_i32_b32 s56, s54
  s_cmp_lt_u32 s53, s56
  s_cbranch_scc1 L_sur2
  s_sub_u32 s53, s53, s56
  s_branch L_end
L_sur2:
  s_ff0_i32_b32 s0, s54
  s_bitset1_b32 s54, s0
  s_sub_u32 s53, s53, 1
  s_cbranch_scc0 L_sur2
  s_branch L_role
L_worker:
  s_lshl_b32 s54, s2, 2
  s_lshr_b32 s54, 1412567136, s54
  s_and_b32 s54, s54, 7
  s_lshl_b32 s54, s54, 5
  s_add_u32 s53, s53, s54
  s_getpc_b64 s[80:81]
L_pc_2:
  s_and_b32 s55, s0, 1
  s_lshl_b32 s55, s55, 2
  s_add_u32 s55, s55, s52
  s_lshl_b32 s55, s55, 13
  v_and_b32 v199, 63, v0
  v_lshl_add_u32 v199, v199, 7, s55
  v_min_u32 v199, (L_end - L_pc_2), v199
  global_load_dword v196, v199, s[80:81]
  v_and_b32 v200, 63, v0
  v_lshlrev_b32 v201, 4, v200
  v_lshrrev_b32 v211, 3, v200
  s_lshl_b32 s54, s52, 3
  v_add_u32 v211, s54, v211
  v_bfe_u32 v212, v211, 1, 3
  v_and_b32 v213, 7, v200
  v_xor_b32 v212, v212, v213
  v_mul_u32_u24 v211, 1152, v211
  v_lshl_add_u32 v202, v212, 4, v211
  s_mul_i32 s67, s52, 9216
  v_and_b32 v211, 31, v200
  v_lshrrev_b32 v212, 3, v211
  v_mul_u32_u24 v212, 9216, v212
  v_and_b32 v213, 7, v211
  v_lshl_add_u32 v212, v213, 7, v212
  v_bfe_u32 v213, v211, 1, 3
  v_lshrrev_b32 v214, 5, v200
  v_xor_b32 v213, v213, v214
  v_lshl_add_u32 v203, v213, 4, v212
  v_xor_b32 v204, 32, v203
  v_xor_b32 v205, 64, v203
  v_xor_b32 v206, 0x60, v203
  v_bfe_u32 v211, v200, 2, 2
  v_lshl_add_u32 v212, v214, 3, v211
  v_lshlrev_b32 v212, 8, v212
  v_xor_b32 v211, s52, v211
  v_lshl_add_u32 v212, v211, 6, v212
  v_bfe_u32 v213, v200, 4, 1
  v_and_b32 v211, 3, v200
  v_lshl_add_u32 v210, v213, 5, v212
  v_lshl_add_u32 v210, v211, 3, v210
  v_lshl_add_u32 v209, v213, 4, v212
  v_and_b32 v213, 1, v211
  v_lshl_add_u32 v209, v213, 3, v209
  v_lshrrev_b32 v213, 1, v211
  v_lshl_add_u32 v209, v213, 5, v209
  s_mov_b32 s65, 0
  s_mul_i32 s58, s53, 9363
  s_lshr_b32 s58, s58, 16
  s_mul_i32 s54, s58, 7
  s_sub_u32 s59, s53, s54
  s_mul_i32 s60, s59, 36864
  s_add_u32 m0, s67, 0
  s_nop 0
  buffer_load_dwordx4 v202, s[4:7], s60 offen offset:0 lds
  s_add_u32 m0, s67, 896
  s_nop 0
  buffer_load_dwordx4 v202, s[4:7], s60 offen offset:128 lds
  s_add_u32 m0, s67, 1792
  s_nop 0
  buffer_load_dwordx4 v202, s[4:7], s60 offen offset:256 lds
  s_add_u32 m0, s67, 2688
  s_nop 0
  buffer_load_dwordx4 v202, s[4:7], s60 offen offset:384 lds
  s_add_u32 m0, s67, 3584
  s_nop 0
  buffer_load_dwordx4 v202, s[4:7], s60 offen offset:512 lds
  s_add_u32 m0, s67, 4480
  s_nop 0
  buffer_load_dwordx4 v202, s[4:7], s60 offen offset:640 lds
  s_add_u32 m0, s67, 5376
  s_nop 0
  buffer_load_dwordx4 v202, s[4:7], s60 offen offset:768 lds
  s_add_u32 m0, s67, 6272
  s_nop 0
  buffer_load_dwordx4 v202, s[4:7], s60 offen offset:896 lds
  s_add_u32 m0, s67, 7168
  s_nop 0
  buffer_load_dwordx4 v202, s[4:7], s60 offen offset:1024 lds
  v_lshrrev_b32 v211, 4, v200
  v_lshlrev_b32 v212, 2, v211
  v_and_b32 v213, 15, v200
  v_xor_b32 v212, v212, v213
  v_lshlrev_b32 v212, 4, v212
  v_lshl_add_u32 v207, v211, 13, v212
  s_lshl_b32 s62, s58, 8
  s_lshl_b32 s54, s52, 15
  s_add_u32 s62, s62, s54
  s_lshl_b32 s61, s52, 10
  s_add_u32 s61, s61, 36864
  s_add_u32 m0, s61, 0
  s_add_u32 s54, s62, 0
  buffer_load_dwordx4 v207, s[20:23], s54 offen lds
  s_add_u32 m0, s61, 4096
  s_add_u32 s54, s62, 131072
  buffer_load_dwordx4 v207, s[20:23], s54 offen lds
  s_add_u32 m0, s61, 8192
  s_add_u32 s54, s62, 262144
  buffer_load_dwordx4 v207, s[20:23], s54 offen lds
  s_add_u32 m0, s61, 12288
  s_add_u32 s54, s62, 393216
  buffer_load_dwordx4 v207, s[20:23], s54 offen lds
  s_add_u32 m0, s61, 16384
  s_add_u32 s54, s62, 0
  buffer_load_dwordx4 v207, s[24:27], s54 offen lds
  s_add_u32 m0, s61, 20480
  s_add_u32 s54, s62, 131072
  buffer_load_dwordx4 v207, s[24:27], s54 offen lds
  s_add_u32 m0, s61, 24576
  s_add_u32 s54, s62, 262144
  buffer_load_dwordx4 v207, s[24:27], s54 offen lds
  s_add_u32 m0, s61, 28672
  s_add_u32 s54, s62, 393216
  buffer_load_dwordx4 v207, s[24:27], s54 offen lds
  s_add_u32 m0, s61, 32768
  s_add_u32 s54, s62, 524288
  buffer_load_dwordx4 v207, s[20:23], s54 offen lds
  s_add_u32 m0, s61, 36864
  s_add_u32 s54, s62, 655360
  buffer_load_dwordx4 v207, s[20:23], s54 offen lds
  s_add_u32 m0, s61, 40960
  s_add_u32 s54, s62, 786432
  buffer_load_dwordx4 v207, s[20:23], s54 offen lds
  s_add_u32 m0, s61, 45056
  s_add_u32 s54, s62, 917504
  buffer_load_dwordx4 v207, s[20:23], s54 offen lds
  s_add_u32 m0, s61, 49152
  s_add_u32 s54, s62, 524288
  buffer_load_dwordx4 v207, s[24:27], s54 offen lds
  s_add_u32 m0, s61, 53248
  s_add_u32 s54, s62, 655360
  buffer_load_dwordx4 v207, s[24:27], s54 offen lds
  s_add_u32 m0, s61, 57344
  s_add_u32 s54, s62, 786432
  buffer_load_dwordx4 v207, s[24:27], s54 offen lds
  s_add_u32 m0, s61, 61440
  s_add_u32 s54, s62, 917504
  buffer_load_dwordx4 v207, s[24:27], s54 offen lds
  s_add_u32 m0, s61, 65536
  s_add_u32 s54, s62, 1048576
  buffer_load_dwordx4 v207, s[20:23], s54 offen lds
  s_add_u32 m0, s61, 69632
  s_add_u32 s54, s62, 1179648
  buffer_load_dwordx4 v207, s[20:23], s54 offen lds
  s_add_u32 m0, s61, 73728
  s_add_u32 s54, s62, 1310720
  buffer_load_dwordx4 v207, s[20:23], s54 offen lds
  s_add_u32 m0, s61, 77824
  s_add_u32 s54, s62, 1441792
  buffer_load_dwordx4 v207, s[20:23], s54 offen lds
  s_add_u32 m0, s61, 81920
  s_add_u32 s54, s62, 1048576
  buffer_load_dwordx4 v207, s[24:27], s54 offen lds
  s_add_u32 m0, s61, 86016
  s_add_u32 s54, s62, 1179648
  buffer_load_dwordx4 v207, s[24:27], s54 offen lds
  s_add_u32 m0, s61, 90112
  s_add_u32 s54, s62, 1310720
  buffer_load_dwordx4 v207, s[24:27], s54 offen lds
  s_add_u32 m0, s61, 94208
  s_add_u32 s54, s62, 1441792
  buffer_load_dwordx4 v207, s[24:27], s54 offen lds
  v_bfe_u32 v211, v200, 3, 2
  v_lshlrev_b32 v216, 11, v211
  v_bfe_u32 v211, v200, 1, 2
  v_lshl_add_u32 v216, v211, 6, v216
  v_lshrrev_b32 v212, 5, v200
  v_lshl_add_u32 v216, v212, 5, v216
  v_and_b32 v211, 1, v200
  v_lshl_add_u32 v216, v211, 4, v216
  v_bfe_u32 v211, v200, 4, 1
  v_lshlrev_b32 v217, 10, v211
  v_lshl_add_u32 v217, v212, 9, v217
  v_and_b32 v211, 15, v200
  v_lshl_add_u32 v217, v211, 4, v217
  s_lshl_b32 s54, s52, 11
  s_add_u32 s54, s54, 8192
  v_add_u32 v217, s54, v217
  s_cmp_eq_u32 s1, 1
  s_cbranch_scc1 W_ver_ok
  v_mov_b32 v33, 163832
  s_cmp_eq_u32 s52, 0
  s_cbranch_scc0 W_ver_b
  s_waitcnt vmcnt(34)
  s_mov_b64 exec, 1
  ds_write_b32 v33, v35
  s_mov_b64 exec, -1
  s_waitcnt lgkmcnt(0)
W_ver_b:
  s_barrier
  ds_read_b32 v32, v33
  s_waitcnt lgkmcnt(0)
  v_readfirstlane_b32 s54, v32
  s_nop 0
  s_bitcmp1_b32 s54, s0
  s_cbranch_scc1 L_conf
W_ver_ok:
  s_waitcnt vmcnt(20) lgkmcnt(0)
  s_barrier
  s_add_u32 m0, s61, 98304
  s_add_u32 s54, s62, 1572864
  buffer_load_dwordx4 v207, s[20:23], s54 offen lds
  s_add_u32 m0, s61, 102400
  s_add_u32 s54, s62, 1703936
  buffer_load_dwordx4 v207, s[20:23], s54 offen lds
  s_add_u32 m0, s61, 106496
  s_add_u32 s54, s62, 1835008
  buffer_load_dwordx4 v207, s[20:23], s54 offen lds
  s_add_u32 m0, s61, 110592
  s_add_u32 s54, s62, 1966080
  buffer_load_dwordx4 v207, s[20:23], s54 offen lds
  v_add_u32 v215, 36864, v209
  ds_read_b64_tr_b16 a[0:1], v215 offset:0
  ds_read_b64_tr_b16 a[2:3], v215 offset:1024
  ds_read_b64_tr_b16 a[4:5], v215 offset:4096
  ds_read_b64_tr_b16 a[6:7], v215 offset:5120
  ds_read_b64_tr_b16 a[8:9], v215 offset:8192
  ds_read_b64_tr_b16 a[10:11], v215 offset:9216
  ds_read_b64_tr_b16 a[12:13], v215 offset:12288
  ds_read_b64_tr_b16 a[14:15], v215 offset:13312
  s_waitcnt vmcnt(20) lgkmcnt(0)
  s_barrier
  s_add_u32 m0, s61, 0
  s_add_u32 s54, s62, 1572864
  buffer_load_dwordx4 v207, s[24:27], s54 offen lds
  s_add_u32 m0, s61, 4096
  s_add_u32 s54, s62, 1703936
  buffer_load_dwordx4 v207, s[24:27], s54 offen lds
  s_add_u32 m0, s61, 8192
  s_add_u32 s54, s62, 1835008
  buffer_load_dwordx4 v207, s[24:27], s54 offen lds
  s_add_u32 m0, s61, 12288
  s_add_u32 s54, s62, 1966080
  buffer_load_dwordx4 v207, s[24:27], s54 offen lds
  v_add_u32 v215, 53248, v210
  ds_read_b64_tr_b16 a[144:145], v215 offset:0
  ds_read_b64_tr_b16 a[146:147], v215 offset:1024
  ds_read_b64_tr_b16 a[148:149], v215 offset:4096
  ds_read_b64_tr_b16 a[150:151], v215 offset:5120
  ds_read_b64_tr_b16 a[152:153], v215 offset:8192
  ds_read_b64_tr_b16 a[154:155], v215 offset:9216
  ds_read_b64_tr_b16 a[156:157], v215 offset:12288
  ds_read_b64_tr_b16 a[158:159], v215 offset:13312
  s_waitcnt vmcnt(20) lgkmcnt(0)
  s_barrier
  s_add_u32 m0, s61, 16384
  s_add_u32 s54, s62, 2097152
  buffer_load_dwordx4 v207, s[20:23], s54 offen lds
  s_add_u32 m0, s61, 20480
  s_add_u32 s54, s62, 2228224
  buffer_load_dwordx4 v207, s[20:23], s54 offen lds
  s_add_u32 m0, s61, 24576
  s_add_u32 s54, s62, 2359296
  buffer_load_dwordx4 v207, s[20:23], s54 offen lds
  s_add_u32 m0, s61, 28672
  s_add_u32 s54, s62, 2490368
  buffer_load_dwordx4 v207, s[20:23], s54 offen lds
  v_add_u32 v215, 69632, v209
  ds_read_b64_tr_b16 a[16:17], v215 offset:0
  ds_read_b64_tr_b16 a[18:19], v215 offset:1024
  ds_read_b64_tr_b16 a[20:21], v215 offset:4096
  ds_read_b64_tr_b16 a[22:23], v215 offset:5120
  ds_read_b64_tr_b16 a[24:25], v215 offset:8192
  ds_read_b64_tr_b16 a[26:27], v215 offset:9216
  ds_read_b64_tr_b16 a[28:29], v215 offset:12288
  ds_read_b64_tr_b16 a[30:31], v215 offset:13312
  s_waitcnt vmcnt(20) lgkmcnt(0)
  s_barrier
  s_add_u32 m0, s61, 32768
  s_add_u32 s54, s62, 2097152
  buffer_load_dwordx4 v207, s[24:27], s54 offen lds
  s_add_u32 m0, s61, 36864
  s_add_u32 s54, s62, 2228224
  buffer_load_dwordx4 v207, s[24:27], s54 offen lds
  s_add_u32 m0, s61, 40960
  s_add_u32 s54, s62, 2359296
  buffer_load_dwordx4 v207, s[24:27], s54 offen lds
  s_add_u32 m0, s61, 45056
  s_add_u32 s54, s62, 2490368
  buffer_load_dwordx4 v207, s[24:27], s54 offen lds
  v_add_u32 v215, 86016, v210
  ds_read_b64_tr_b16 a[160:161], v215 offset:0
  ds_read_b64_tr_b16 a[162:163], v215 offset:1024
  ds_read_b64_tr_b16 a[164:165], v215 offset:4096
  ds_read_b64_tr_b16 a[166:167], v215 offset:5120
  ds_read_b64_tr_b16 a[168:169], v215 offset:8192
  ds_read_b64_tr_b16 a[170:171], v215 offset:9216
  ds_read_b64_tr_b16 a[172:173], v215 offset:12288
  ds_read_b64_tr_b16 a[174:175], v215 offset:13312
  s_waitcnt vmcnt(20) lgkmcnt(0)
  s_barrier
  s_add_u32 m0, s61, 49152
  s_add_u32 s54, s62, 2621440
  buffer_load_dwordx4 v207, s[20:23], s54 offen lds
  s_add_u32 m0, s61, 53248
  s_add_u32 s54, s62, 2752512
  buffer_load_dwordx4 v207, s[20:23], s54 offen lds
  s_add_u32 m0, s61, 57344
  s_add_u32 s54, s62, 2883584
  buffer_load_dwordx4 v207, s[20:23], s54 offen lds
  s_add_u32 m0, s61, 61440
  s_add_u32 s54, s62, 3014656
  buffer_load_dwordx4 v207, s[20:23], s54 offen lds
  v_add_u32 v215, 102400, v209
  ds_read_b64_tr_b16 a[32:33], v215 offset:0
  ds_read_b64_tr_b16 a[34:35], v215 offset:1024
  ds_read_b64_tr_b16 a[36:37], v215 offset:4096
  ds_read_b64_tr_b16 a[38:39], v215 offset:5120
  ds_read_b64_tr_b16 a[40:41], v215 offset:8192
  ds_read_b64_tr_b16 a[42:43], v215 offset:9216
  ds_read_b64_tr_b16 a[44:45], v215 offset:12288
  ds_read_b64_tr_b16 a[46:47], v215 offset:13312
  s_waitcnt vmcnt(20) lgkmcnt(0)
  s_barrier
  s_add_u32 m0, s61, 65536
  s_add_u32 s54, s62, 2621440
  buffer_load_dwordx4 v207, s[24:27], s54 offen lds
  s_add_u32 m0, s61, 69632
  s_add_u32 s54, s62, 2752512
  buffer_load_dwordx4 v207, s[24:27], s54 offen lds
  s_add_u32 m0, s61, 73728
  s_add_u32 s54, s62, 2883584
  buffer_load_dwordx4 v207, s[24:27], s54 offen lds
  s_add_u32 m0, s61, 77824
  s_add_u32 s54, s62, 3014656
  buffer_load_dwordx4 v207, s[24:27], s54 offen lds
  v_add_u32 v215, 118784, v210
  ds_read_b64_tr_b16 a[176:177], v215 offset:0
  ds_read_b64_tr_b16 a[178:179], v215 offset:1024
  ds_read_b64_tr_b16 a[180:181], v215 offset:4096
  ds_read_b64_tr_b16 a[182:183], v215 offset:5120
  ds_read_b64_tr_b16 a[184:185], v215 offset:8192
  ds_read_b64_tr_b16 a[186:187], v215 offset:9216
  ds_read_b64_tr_b16 a[188:189], v215 offset:12288
  ds_read_b64_tr_b16 a[190:191], v215 offset:13312
  s_waitcnt vmcnt(20) lgkmcnt(0)
  s_barrier
  s_add_u32 m0, s61, 81920
  s_add_u32 s54, s62, 3145728
  buffer_load_dwordx4 v207, s[20:23], s54 offen lds
  s_add_u32 m0, s61, 86016
  s_add_u32 s54, s62, 3276800
  buffer_load_dwordx4 v207, s[20:23], s54 offen lds
  s_add_u32 m0, s61, 90112
  s_add_u32 s54, s62, 3407872
  buffer_load_dwordx4 v207, s[20:23], s54 offen lds
  s_add_u32 m0, s61, 94208
  s_add_u32 s54, s62, 3538944
  buffer_load_dwordx4 v207, s[20:23], s54 offen lds
  v_add_u32 v215, 135168, v209
  ds_read_b64_tr_b16 a[48:49], v215 offset:0
  ds_read_b64_tr_b16 a[50:51], v215 offset:1024
  ds_read_b64_tr_b16 a[52:53], v215 offset:4096
  ds_read_b64_tr_b16 a[54:55], v215 offset:5120
  ds_read_b64_tr_b16 a[56:57], v215 offset:8192
  ds_read_b64_tr_b16 a[58:59], v215 offset:9216
  ds_read_b64_tr_b16 a[60:61], v215 offset:12288
  ds_read_b64_tr_b16 a[62:63], v215 offset:13312
  s_waitcnt vmcnt(20) lgkmcnt(0)
  s_barrier
  s_add_u32 m0, s61, 98304
  s_add_u32 s54, s62, 3145728
  buffer_load_dwordx4 v207, s[24:27], s54 offen lds
  s_add_u32 m0, s61, 102400
  s_add_u32 s54, s62, 3276800
  buffer_load_dwordx4 v207, s[24:27], s54 offen lds
  s_add_u32 m0, s61, 106496
  s_add_u32 s54, s62, 3407872
  buffer_load_dwordx4 v207, s[24:27], s54 offen lds
  s_add_u32 m0, s61, 110592
  s_add_u32 s54, s62, 3538944
  buffer_load_dwordx4 v207, s[24:27], s54 offen lds
  v_add_u32 v215, 36864, v210
  ds_read_b64_tr_b16 a[192:193], v215 offset:0
  ds_read_b64_tr_b16 a[194:195], v215 offset:1024
  ds_read_b64_tr_b16 a[196:197], v215 offset:4096
  ds_read_b64_tr_b16 a[198:199], v215 offset:5120
  ds_read_b64_tr_b16 a[200:201], v215 offset:8192
  ds_read_b64_tr_b16 a[202:203], v215 offset:9216
  ds_read_b64_tr_b16 a[204:205], v215 offset:12288
  ds_read_b64_tr_b16 a[206:207], v215 offset:13312
  s_waitcnt vmcnt(20) lgkmcnt(0)
  s_barrier
  s_add_u32 m0, s61, 0
  s_add_u32 s54, s62, 3670016
  buffer_load_dwordx4 v207, s[20:23], s54 offen lds
  s_add_u32 m0, s61, 4096
  s_add_u32 s54, s62, 3801088
  buffer_load_dwordx4 v207, s[20:23], s54 offen lds
  s_add_u32 m0, s61, 8192
  s_add_u32 s54, s62, 3932160
  buffer_load_dwordx4 v207, s[20:23], s54 offen lds
  s_add_u32 m0, s61, 12288
  s_add_u32 s54, s62, 4063232
  buffer_load_dwordx4 v207, s[20:23], s54 offen lds
  v_add_u32 v215, 53248, v209
  ds_read_b64_tr_b16 a[64:65], v215 offset:0
  ds_read_b64_tr_b16 a[66:67], v215 offset:1024
  ds_read_b64_tr_b16 a[68:69], v215 offset:4096
  ds_read_b64_tr_b16 a[70:71], v215 offset:5120
  ds_read_b64_tr_b16 a[72:73], v215 offset:8192
  ds_read_b64_tr_b16 a[74:75], v215 offset:9216
  ds_read_b64_tr_b16 a[76:77], v215 offset:12288
  ds_read_b64_tr_b16 a[78:79], v215 offset:13312
  s_waitcnt vmcnt(20) lgkmcnt(0)
  s_barrier
  s_add_u32 m0, s61, 16384
  s_add_u32 s54, s62, 3670016
  buffer_load_dwordx4 v207, s[24:27], s54 offen lds
  s_add_u32 m0, s61, 20480
  s_add_u32 s54, s62, 3801088
  buffer_load_dwordx4 v207, s[24:27], s54 offen lds
  s_add_u32 m0, s61, 24576
  s_add_u32 s54, s62, 3932160
  buffer_load_dwordx4 v207, s[24:27], s54 offen lds
  s_add_u32 m0, s61, 28672
  s_add_u32 s54, s62, 4063232
  buffer_load_dwordx4 v207, s[24:27], s54 offen lds
  v_add_u32 v215, 69632, v210
  ds_read_b64_tr_b16 a[208:209], v215 offset:0
  ds_read_b64_tr_b16 a[210:211], v215 offset:1024
  ds_read_b64_tr_b16 a[212:213], v215 offset:4096
  ds_read_b64_tr_b16 a[214:215], v215 offset:5120
  ds_read_b64_tr_b16 a[216:217], v215 offset:8192
  ds_read_b64_tr_b16 a[218:219], v215 offset:9216
  ds_read_b64_tr_b16 a[220:221], v215 offset:12288
  ds_read_b64_tr_b16 a[222:223], v215 offset:13312
  s_waitcnt vmcnt(20) lgkmcnt(0)
  s_barrier
  s_add_u32 m0, s61, 32768
  s_add_u32 s54, s62, 4194304
  buffer_load_dwordx4 v207, s[20:23], s54 offen lds
  s_add_u32 m0, s61, 36864
  s_add_u32 s54, s62, 4325376
  buffer_load_dwordx4 v207, s[20:23], s54 offen lds
  s_add_u32 m0, s61, 40960
  s_add_u32 s54, s62, 4456448
  buffer_load_dwordx4 v207, s[20:23], s54 offen lds
  s_add_u32 m0, s61, 45056
  s_add_u32 s54, s62, 4587520
  buffer_load_dwordx4 v207, s[20:23], s54 offen lds
  v_add_u32 v215, 86016, v209
  ds_read_b64_tr_b16 a[80:81], v215 offset:0
  ds_read_b64_tr_b16 a[82:83], v215 offset:1024
  ds_read_b64_tr_b16 a[84:85], v215 offset:4096
  ds_read_b64_tr_b16 a[86:87], v215 offset:5120
  ds_read_b64_tr_b16 a[88:89], v215 offset:8192
  ds_read_b64_tr_b16 a[90:91], v215 offset:9216
  ds_read_b64_tr_b16 a[92:93], v215 offset:12288
  ds_read_b64_tr_b16 a[94:95], v215 offset:13312
  s_waitcnt vmcnt(20) lgkmcnt(0)
  s_barrier
  s_add_u32 m0, s61, 49152
  s_add_u32 s54, s62, 4194304
  buffer_load_dwordx4 v207, s[24:27], s54 offen lds
  s_add_u32 m0, s61, 53248
  s_add_u32 s54, s62, 4325376
  buffer_load_dwordx4 v207, s[24:27], s54 offen lds
  s_add_u32 m0, s61, 57344
  s_add_u32 s54, s62, 4456448
  buffer_load_dwordx4 v207, s[24:27], s54 offen lds
  s_add_u32 m0, s61, 61440
  s_add_u32 s54, s62, 4587520
  buffer_load_dwordx4 v207, s[24:27], s54 offen lds
  s_mul_i32 s54, s53, 21120
  s_lshl_b32 s55, s52, 13
  s_add_u32 s54, s54, s55
  s_cmp_eq_u32 s52, 3
  s_cselect_b32 s54, 0x10000000, s54
  v_lshlrev_b32 v211, 3, v201
  buffer_load_dword v196, v211, s[28:31], s54 offen
  v_add_u32 v215, 102400, v210
  ds_read_b64_tr_b16 a[224:225], v215 offset:0
  ds_read_b64_tr_b16 a[226:227], v215 offset:1024
  ds_read_b64_tr_b16 a[228:229], v215 offset:4096
  ds_read_b64_tr_b16 a[230:231], v215 offset:5120
  ds_read_b64_tr_b16 a[232:233], v215 offset:8192
  ds_read_b64_tr_b16 a[234:235], v215 offset:9216
  ds_read_b64_tr_b16 a[236:237], v215 offset:12288
  ds_read_b64_tr_b16 a[238:239], v215 offset:13312
  s_waitcnt vmcnt(21) lgkmcnt(0)
  s_barrier
  s_lshl_b32 s54, s53, 13
  s_lshr_b32 s55, s53, 6
  s_or_b32 s55, s55, s52
  s_cmp_eq_u32 s55, 0
  s_cselect_b32 s54, s54, 0x10000000
  v_lshlrev_b32 v211, 3, v201
  buffer_load_dword v196, v211, s[16:19], s54 offen
  v_add_u32 v215, 118784, v209
  ds_read_b64_tr_b16 a[96:97], v215 offset:0
  ds_read_b64_tr_b16 a[98:99], v215 offset:1024
  ds_read_b64_tr_b16 a[100:101], v215 offset:4096
  ds_read_b64_tr_b16 a[102:103], v215 offset:5120
  ds_read_b64_tr_b16 a[104:105], v215 offset:8192
  ds_read_b64_tr_b16 a[106:107], v215 offset:9216
  ds_read_b64_tr_b16 a[108:109], v215 offset:12288
  ds_read_b64_tr_b16 a[110:111], v215 offset:13312
  s_waitcnt vmcnt(18) lgkmcnt(0)
  s_barrier
  v_add_u32 v215, 135168, v210
  ds_read_b64_tr_b16 a[240:241], v215 offset:0
  ds_read_b64_tr_b16 a[242:243], v215 offset:1024
  ds_read_b64_tr_b16 a[244:245], v215 offset:4096
  ds_read_b64_tr_b16 a[246:247], v215 offset:5120
  ds_read_b64_tr_b16 a[248:249], v215 offset:8192
  ds_read_b64_tr_b16 a[250:251], v215 offset:9216
  ds_read_b64_tr_b16 a[252:253], v215 offset:12288
  ds_read_b64_tr_b16 a[254:255], v215 offset:13312
  s_waitcnt vmcnt(14) lgkmcnt(0)
  s_barrier
  v_add_u32 v215, 36864, v209
  ds_read_b64_tr_b16 a[112:113], v215 offset:0
  ds_read_b64_tr_b16 a[114:115], v215 offset:1024
  ds_read_b64_tr_b16 a[116:117], v215 offset:4096
  ds_read_b64_tr_b16 a[118:119], v215 offset:5120
  ds_read_b64_tr_b16 a[120:121], v215 offset:8192
  ds_read_b64_tr_b16 a[122:123], v215 offset:9216
  ds_read_b64_tr_b16 a[124:125], v215 offset:12288
  ds_read_b64_tr_b16 a[126:127], v215 offset:13312
  s_waitcnt vmcnt(10) lgkmcnt(0)
  s_barrier
  v_add_u32 v215, 53248, v210
  ds_read_b64_tr_b16 v[224:225], v215 offset:0
  ds_read_b64_tr_b16 v[226:227], v215 offset:1024
  ds_read_b64_tr_b16 v[228:229], v215 offset:4096
  ds_read_b64_tr_b16 v[230:231], v215 offset:5120
  ds_read_b64_tr_b16 v[232:233], v215 offset:8192
  ds_read_b64_tr_b16 v[234:235], v215 offset:9216
  ds_read_b64_tr_b16 v[236:237], v215 offset:12288
  ds_read_b64_tr_b16 v[238:239], v215 offset:13312
  s_waitcnt vmcnt(6) lgkmcnt(0)
  s_barrier
  v_add_u32 v215, 69632, v209
  ds_read_b64_tr_b16 a[128:129], v215 offset:0
  ds_read_b64_tr_b16 a[130:131], v215 offset:1024
  ds_read_b64_tr_b16 a[132:133], v215 offset:4096
  ds_read_b64_tr_b16 a[134:135], v215 offset:5120
  ds_read_b64_tr_b16 a[136:137], v215 offset:8192
  ds_read_b64_tr_b16 a[138:139], v215 offset:9216
  ds_read_b64_tr_b16 a[140:141], v215 offset:12288
  ds_read_b64_tr_b16 a[142:143], v215 offset:13312
  s_waitcnt vmcnt(2) lgkmcnt(0)
  s_barrier
  v_add_u32 v215, 86016, v210
  ds_read_b64_tr_b16 v[240:241], v215 offset:0
  ds_read_b64_tr_b16 v[242:243], v215 offset:1024
  ds_read_b64_tr_b16 v[244:245], v215 offset:4096
  ds_read_b64_tr_b16 v[246:247], v215 offset:5120
  ds_read_b64_tr_b16 v[248:249], v215 offset:8192
  ds_read_b64_tr_b16 v[250:251], v215 offset:9216
  ds_read_b64_tr_b16 v[252:253], v215 offset:12288
  ds_read_b64_tr_b16 v[254:255], v215 offset:13312
  s_waitcnt lgkmcnt(0)
  s_barrier
  s_lshr_b32 s55, s53, 1
  s_and_b32 s56, s53, 1
  s_lshl_b32 s56, s56, 7
  s_lshl_b32 s55, s55, 2
  s_add_u32 s55, s55, s56
  s_add_u32 s55, s55, 356352
  s_cmp_lt_u32 s53, 64
  s_cselect_b32 s71, s55, 268435456
  v_mov_b32 v211, 0
  s_mov_b64 exec, 1
  buffer_store_dword v211, v211, s[8:11], s71 offen sc1
  s_mov_b64 exec, -1
  s_mov_b32 s68, 1040356334
  s_lshl_b32 s69, s52, 9
  s_lshl_b32 s70, s58, 2
  s_add_u32 s70, s70, 128
  s_mul_i32 s66, s58, -12288
  s_lshl_b32 s54, s52, 10
  s_add_u32 s66, s66, s54
  s_add_u32 s66, s66, 524288
  v_mov_b32 v64, -1
  v_mov_b32 v65, -1
  v_mov_b32 v66, -1
  v_mov_b32 v67, -1
KV_loop:
  s_add_u32 s60, s60, 258048
  s_add_u32 m0, s67, 36864
  s_nop 0
  buffer_load_dwordx4 v202, s[4:7], s60 offen offset:0 lds
  s_add_u32 m0, s67, 37760
  s_nop 0
  buffer_load_dwordx4 v202, s[4:7], s60 offen offset:128 lds
  s_add_u32 m0, s67, 38656
  s_nop 0
  buffer_load_dwordx4 v202, s[4:7], s60 offen offset:256 lds
  s_add_u32 m0, s67, 39552
  s_nop 0
  buffer_load_dwordx4 v202, s[4:7], s60 offen offset:384 lds
  s_add_u32 m0, s67, 40448
  s_nop 0
  buffer_load_dwordx4 v202, s[4:7], s60 offen offset:512 lds
  s_add_u32 m0, s67, 41344
  s_nop 0
  buffer_load_dwordx4 v202, s[4:7], s60 offen offset:640 lds
  s_add_u32 m0, s67, 42240
  s_nop 0
  buffer_load_dwordx4 v202, s[4:7], s60 offen offset:768 lds
  s_add_u32 m0, s67, 43136
  s_nop 0
  buffer_load_dwordx4 v202, s[4:7], s60 offen offset:896 lds
  s_add_u32 m0, s67, 44032
  s_nop 0
  buffer_load_dwordx4 v202, s[4:7], s60 offen offset:1024 lds
  ds_read_b128 v[32:35], v203 offset:0
  ds_read_b128 v[36:39], v204 offset:0
  ds_read_b128 v[40:43], v205 offset:0
  s_waitcnt lgkmcnt(2)
  v_mfma_f32_32x32x16_bf16 v[0:15], a[0:3], v[32:35], 0
  ds_read_b128 v[44:47], v206 offset:0
  v_mfma_f32_32x32x16_bf16 v[16:31], v[32:35], a[144:147], 0
  s_waitcnt lgkmcnt(2)
  v_mfma_f32_32x32x16_bf16 v[0:15], a[4:7], v[36:39], v[0:15]
  ds_read_b128 v[32:35], v203 offset:1024
  v_mfma_f32_32x32x16_bf16 v[16:31], v[36:39], a[148:151], v[16:31]
  s_waitcnt lgkmcnt(2)
  v_mfma_f32_32x32x16_bf16 v[0:15], a[8:11], v[40:43], v[0:15]
  ds_read_b128 v[36:39], v204 offset:1024
  v_mfma_f32_32x32x16_bf16 v[16:31], v[40:43], a[152:155], v[16:31]
  s_waitcnt lgkmcnt(2)
  v_mfma_f32_32x32x16_bf16 v[0:15], a[12:15], v[44:47], v[0:15]
  ds_read_b128 v[40:43], v205 offset:1024
  v_mfma_f32_32x32x16_bf16 v[16:31], v[44:47], a[156:159], v[16:31]
  s_waitcnt lgkmcnt(2)
  v_mfma_f32_32x32x16_bf16 v[0:15], a[16:19], v[32:35], v[0:15]
  ds_read_b128 v[44:47], v206 offset:1024
  v_mfma_f32_32x32x16_bf16 v[16:31], v[32:35], a[160:163], v[16:31]
  s_waitcnt lgkmcnt(2)
  v_mfma_f32_32x32x16_bf16 v[0:15], a[20:23], v[36:39], v[0:15]
  ds_read_b128 v[32:35], v203 offset:2048
  v_mfma_f32_32x32x16_bf16 v[16:31], v[36:39], a[164:167], v[16:31]
  s_waitcnt lgkmcnt(2)
  v_mfma_f32_32x32x16_bf16 v[0:15], a[24:27], v[40:43], v[0:15]
  ds_read_b128 v[36:39], v204 offset:2048
  v_mfma_f32_32x32x16_bf16 v[16:31], v[40:43], a[168:171], v[16:31]
  s_waitcnt lgkmcnt(2)
  v_mfma_f32_32x32x16_bf16 v[0:15], a[28:31], v[44:47], v[0:15]
  ds_read_b128 v[40:43], v205 offset:2048
  v_mfma_f32_32x32x16_bf16 v[16:31], v[44:47], a[172:175], v[16:31]
  s_waitcnt lgkmcnt(2)
  v_mfma_f32_32x32x16_bf16 v[0:15], a[32:35], v[32:35], v[0:15]
  ds_read_b128 v[44:47], v206 offset:2048
  v_mfma_f32_32x32x16_bf16 v[16:31], v[32:35], a[176:179], v[16:31]
  s_waitcnt lgkmcnt(2)
  v_mfma_f32_32x32x16_bf16 v[0:15], a[36:39], v[36:39], v[0:15]
  ds_read_b128 v[32:35], v203 offset:3072
  v_mfma_f32_32x32x16_bf16 v[16:31], v[36:39], a[180:183], v[16:31]
  s_waitcnt lgkmcnt(2)
  v_mfma_f32_32x32x16_bf16 v[0:15], a[40:43], v[40:43], v[0:15]
  ds_read_b128 v[36:39], v204 offset:3072
  v_mfma_f32_32x32x16_bf16 v[16:31], v[40:43], a[184:187], v[16:31]
  s_waitcnt lgkmcnt(2)
  v_mfma_f32_32x32x16_bf16 v[0:15], a[44:47], v[44:47], v[0:15]
  ds_read_b128 v[40:43], v205 offset:3072
  v_mfma_f32_32x32x16_bf16 v[16:31], v[44:47], a[188:191], v[16:31]
  s_waitcnt lgkmcnt(2)
  v_mfma_f32_32x32x16_bf16 v[0:15], a[48:51], v[32:35], v[0:15]
  ds_read_b128 v[44:47], v206 offset:3072
  v_mfma_f32_32x32x16_bf16 v[16:31], v[32:35], a[192:195], v[16:31]
  s_waitcnt lgkmcnt(2)
  v_mfma_f32_32x32x16_bf16 v[0:15], a[52:55], v[36:39], v[0:15]
  ds_read_b128 v[32:35], v203 offset:4096
  v_mfma_f32_32x32x16_bf16 v[16:31], v[36:39], a[196:199], v[16:31]
  s_waitcnt lgkmcnt(2)
  v_mfma_f32_32x32x16_bf16 v[0:15], a[56:59], v[40:43], v[0:15]
  ds_read_b128 v[36:39], v204 offset:4096
  v_mfma_f32_32x32x16_bf16 v[16:31], v[40:43], a[200:203], v[16:31]
  s_waitcnt lgkmcnt(2)
  v_mfma_f32_32x32x16_bf16 v[0:15], a[60:63], v[44:47], v[0:15]
  ds_read_b128 v[40:43], v205 offset:4096
  v_mfma_f32_32x32x16_bf16 v[16:31], v[44:47], a[204:207], v[16:31]
  s_waitcnt lgkmcnt(2)
  v_mfma_f32_32x32x16_bf16 v[0:15], a[64:67], v[32:35], v[0:15]
  ds_read_b128 v[44:47], v206 offset:4096
  v_mfma_f32_32x32x16_bf16 v[16:31], v[32:35], a[208:211], v[16:31]
  s_waitcnt lgkmcnt(2)
  v_mfma_f32_32x32x16_bf16 v[0:15], a[68:71], v[36:39], v[0:15]
  ds_read_b128 v[32:35], v203 offset:5120
  v_mfma_f32_32x32x16_bf16 v[16:31], v[36:39], a[212:215], v[16:31]
  s_waitcnt lgkmcnt(2)
  v_mfma_f32_32x32x16_bf16 v[0:15], a[72:75], v[40:43], v[0:15]
  ds_read_b128 v[36:39], v204 offset:5120
  v_mfma_f32_32x32x16_bf16 v[16:31], v[40:43], a[216:219], v[16:31]
  s_waitcnt lgkmcnt(2)
  v_mfma_f32_32x32x16_bf16 v[0:15], a[76:79], v[44:47], v[0:15]
  ds_read_b128 v[40:43], v205 offset:5120
  v_mfma_f32_32x32x16_bf16 v[16:31], v[44:47], a[220:223], v[16:31]
  s_waitcnt lgkmcnt(2)
  v_mfma_f32_32x32x16_bf16 v[0:15], a[80:83], v[32:35], v[0:15]
  ds_read_b128 v[44:47], v206 offset:5120
  v_mfma_f32_32x32x16_bf16 v[16:31], v[32:35], a[224:227], v[16:31]
  s_waitcnt lgkmcnt(2)
  v_mfma_f32_32x32x16_bf16 v[0:15], a[84:87], v[36:39], v[0:15]
  ds_read_b128 v[32:35], v203 offset:6144
  v_mfma_f32_32x32x16_bf16 v[16:31], v[36:39], a[228:231], v[16:31]
  s_waitcnt lgkmcnt(2)
  v_mfma_f32_32x32x16_bf16 v[0:15], a[88:91], v[40:43], v[0:15]
  ds_read_b128 v[36:39], v204 offset:6144
  v_mfma_f32_32x32x16_bf16 v[16:31], v[40:43], a[232:235], v[16:31]
  s_waitcnt lgkmcnt(2)
  v_mfma_f32_32x32x16_bf16 v[0:15], a[92:95], v[44:47], v[0:15]
  ds_read_b128 v[40:43], v205 offset:6144
  v_mfma_f32_32x32x16_bf16 v[16:31], v[44:47], a[236:239], v[16:31]
  s_waitcnt lgkmcnt(2)
  v_mfma_f32_32x32x16_bf16 v[0:15], a[96:99], v[32:35], v[0:15]
  ds_read_b128 v[44:47], v206 offset:6144
  v_mfma_f32_32x32x16_bf16 v[16:31], v[32:35], a[240:243], v[16:31]
  s_waitcnt lgkmcnt(2)
  v_mfma_f32_32x32x16_bf16 v[0:15], a[100:103], v[36:39], v[0:15]
  ds_read_b128 v[32:35], v203 offset:7168
  v_mfma_f32_32x32x16_bf16 v[16:31], v[36:39], a[244:247], v[16:31]
  s_waitcnt lgkmcnt(2)
  v_mfma_f32_32x32x16_bf16 v[0:15], a[104:107], v[40:43], v[0:15]
  ds_read_b128 v[36:39], v204 offset:7168
  v_mfma_f32_32x32x16_bf16 v[16:31], v[40:43], a[248:251], v[16:31]
  s_waitcnt lgkmcnt(2)
  v_mfma_f32_32x32x16_bf16 v[0:15], a[108:111], v[44:47], v[0:15]
  ds_read_b128 v[40:43], v205 offset:7168
  v_mfma_f32_32x32x16_bf16 v[16:31], v[44:47], a[252:255], v[16:31]
  s_waitcnt lgkmcnt(2)
  v_mfma_f32_32x32x16_bf16 v[0:15], a[112:115], v[32:35], v[0:15]
  ds_read_b128 v[44:47], v206 offset:7168
  v_mfma_f32_32x32x16_bf16 v[16:31], v[32:35], v[224:227], v[16:31]
  s_waitcnt lgkmcnt(2)
  v_mfma_f32_32x32x16_bf16 v[0:15], a[116:119], v[36:39], v[0:15]
  ds_read_b128 v[32:35], v203 offset:8192
  v_mfma_f32_32x32x16_bf16 v[16:31], v[36:39], v[228:231], v[16:31]
  s_waitcnt lgkmcnt(2)
  v_mfma_f32_32x32x16_bf16 v[0:15], a[120:123], v[40:43], v[0:15]
  ds_read_b128 v[36:39], v204 offset:8192
  v_mfma_f32_32x32x16_bf16 v[16:31], v[40:43], v[232:235], v[16:31]
  s_waitcnt lgkmcnt(2)
  v_mfma_f32_32x32x16_bf16 v[0:15], a[124:127], v[44:47], v[0:15]
  ds_read_b128 v[40:43], v205 offset:8192
  v_mfma_f32_32x32x16_bf16 v[16:31], v[44:47], v[236:239], v[16:31]
  s_waitcnt lgkmcnt(2)
  v_mfma_f32_32x32x16_bf16 v[0:15], a[128:131], v[32:35], v[0:15]
  ds_read_b128 v[44:47], v206 offset:8192
  v_mfma_f32_32x32x16_bf16 v[16:31], v[32:35], v[240:243], v[16:31]
  s_waitcnt lgkmcnt(2)
  v_mfma_f32_32x32x16_bf16 v[0:15], a[132:135], v[36:39], v[0:15]
  v_mfma_f32_32x32x16_bf16 v[16:31], v[36:39], v[244:247], v[16:31]
  s_waitcnt lgkmcnt(1)
  v_mfma_f32_32x32x16_bf16 v[0:15], a[136:139], v[40:43], v[0:15]
  v_mfma_f32_32x32x16_bf16 v[16:31], v[40:43], v[248:251], v[16:31]
  s_waitcnt lgkmcnt(0)
  v_mfma_f32_32x32x16_bf16 v[0:15], a[140:143], v[44:47], v[0:15]
  v_mfma_f32_32x32x16_bf16 v[16:31], v[44:47], v[252:255], v[16:31]
  s_mul_i32 s64, s59, 655360
  s_lshl_b32 s55, s58, 14
  s_add_u32 s64, s64, s55
  s_add_u32 s64, s64, 1048576
  s_add_u32 s55, s64, s69
  v_mul_f32 v0, s68, v0
  v_mul_f32 v1, s68, v1
  v_mul_f32 v2, s68, v2
  v_mul_f32 v3, s68, v3
  v_mul_f32 v4, s68, v4
  v_mul_f32 v5, s68, v5
  v_mul_f32 v6, s68, v6
  v_mul_f32 v7, s68, v7
  v_mul_f32 v8, s68, v8
  v_mul_f32 v9, s68, v9
  v_mul_f32 v10, s68, v10
  v_mul_f32 v11, s68, v11
  v_mul_f32 v12, s68, v12
  v_mul_f32 v13, s68, v13
  v_mul_f32 v14, s68, v14
  v_mul_f32 v15, s68, v15
  v_cvt_pk_bf16_f32 v48, v0, v4
  v_cvt_pk_bf16_f32 v49, v1, v5
  v_cvt_pk_bf16_f32 v50, v2, v6
  v_cvt_pk_bf16_f32 v51, v3, v7
  buffer_store_dwordx4 v[48:51], v216, s[8:11], s55 offen offset:0 sc1
  v_cvt_pk_bf16_f32 v52, v8, v12
  v_cvt_pk_bf16_f32 v53, v9, v13
  v_cvt_pk_bf16_f32 v54, v10, v14
  v_cvt_pk_bf16_f32 v55, v11, v15
  buffer_store_dwordx4 v[52:55], v216, s[8:11], s55 offen offset:256 sc1
  v_cvt_pk_bf16_f32 v56, v16, v17
  v_cvt_pk_bf16_f32 v57, v20, v21
  v_cvt_pk_bf16_f32 v58, v24, v25
  v_cvt_pk_bf16_f32 v59, v28, v29
  buffer_store_dwordx4 v[56:59], v217, s[8:11], s64 offen offset:0 sc1
  v_cvt_pk_bf16_f32 v60, v18, v19
  v_cvt_pk_bf16_f32 v61, v22, v23
  v_cvt_pk_bf16_f32 v62, v26, v27
  v_cvt_pk_bf16_f32 v63, v30, v31
  buffer_store_dwordx4 v[60:63], v217, s[8:11], s64 offen offset:256 sc1
  s_add_u32 s55, s64, s66
  buffer_store_dwordx4 v[64:67], v201, s[8:11], s55 offen sc1
  s_add_u32 s59, s59, 7
  s_cmp_ge_u32 s59, 64
  s_cbranch_scc1 KV_done
  s_waitcnt vmcnt(5)
  s_barrier
  s_add_u32 s60, s60, 258048
  s_add_u32 m0, s67, 0
  s_nop 0
  buffer_load_dwordx4 v202, s[4:7], s60 offen offset:0 lds
  s_add_u32 m0, s67, 896
  s_nop 0
  buffer_load_dwordx4 v202, s[4:7], s60 offen offset:128 lds
  s_add_u32 m0, s67, 1792
  s_nop 0
  buffer_load_dwordx4 v202, s[4:7], s60 offen offset:256 lds
  s_add_u32 m0, s67, 2688
  s_nop 0
  buffer_load_dwordx4 v202, s[4:7], s60 offen offset:384 lds
  s_add_u32 m0, s67, 3584
  s_nop 0
  buffer_load_dwordx4 v202, s[4:7], s60 offen offset:512 lds
  s_add_u32 m0, s67, 4480
  s_nop 0
  buffer_load_dwordx4 v202, s[4:7], s60 offen offset:640 lds
  s_add_u32 m0, s67, 5376
  s_nop 0
  buffer_load_dwordx4 v202, s[4:7], s60 offen offset:768 lds
  s_add_u32 m0, s67, 6272
  s_nop 0
  buffer_load_dwordx4 v202, s[4:7], s60 offen offset:896 lds
  s_add_u32 m0, s67, 7168
  s_nop 0
  buffer_load_dwordx4 v202, s[4:7], s60 offen offset:1024 lds
  ds_read_b128 v[32:35], v203 offset:36864
  ds_read_b128 v[36:39], v204 offset:36864
  ds_read_b128 v[40:43], v205 offset:36864
  s_waitcnt lgkmcnt(2)
  v_mfma_f32_32x32x16_bf16 v[0:15], a[0:3], v[32:35], 0
  ds_read_b128 v[44:47], v206 offset:36864
  v_mfma_f32_32x32x16_bf16 v[16:31], v[32:35], a[144:147], 0
  s_waitcnt lgkmcnt(2)
  v_mfma_f32_32x32x16_bf16 v[0:15], a[4:7], v[36:39], v[0:15]
  ds_read_b128 v[32:35], v203 offset:37888
  v_mfma_f32_32x32x16_bf16 v[16:31], v[36:39], a[148:151], v[16:31]
  s_waitcnt lgkmcnt(2)
  v_mfma_f32_32x32x16_bf16 v[0:15], a[8:11], v[40:43], v[0:15]
  ds_read_b128 v[36:39], v204 offset:37888
  v_mfma_f32_32x32x16_bf16 v[16:31], v[40:43], a[152:155], v[16:31]
  s_waitcnt lgkmcnt(2)
  v_mfma_f32_32x32x16_bf16 v[0:15], a[12:15], v[44:47], v[0:15]
  ds_read_b128 v[40:43], v205 offset:37888
  v_mfma_f32_32x32x16_bf16 v[16:31], v[44:47], a[156:159], v[16:31]
  s_waitcnt lgkmcnt(2)
  v_mfma_f32_32x32x16_bf16 v[0:15], a[16:19], v[32:35], v[0:15]
  ds_read_b128 v[44:47], v206 offset:37888
  v_mfma_f32_32x32x16_bf16 v[16:31], v[32:35], a[160:163], v[16:31]
  s_waitcnt lgkmcnt(2)
  v_mfma_f32_32x32x16_bf16 v[0:15], a[20:23], v[36:39], v[0:15]
  ds_read_b128 v[32:35], v203 offset:38912
  v_mfma_f32_32x32x16_bf16 v[16:31], v[36:39], a[164:167], v[16:31]
  s_waitcnt lgkmcnt(2)
  v_mfma_f32_32x32x16_bf16 v[0:15], a[24:27], v[40:43], v[0:15]
  ds_read_b128 v[36:39], v204 offset:38912
  v_mfma_f32_32x32x16_bf16 v[16:31], v[40:43], a[168:171], v[16:31]
  s_waitcnt lgkmcnt(2)
  v_mfma_f32_32x32x16_bf16 v[0:15], a[28:31], v[44:47], v[0:15]
  ds_read_b128 v[40:43], v205 offset:38912
  v_mfma_f32_32x32x16_bf16 v[16:31], v[44:47], a[172:175], v[16:31]
  s_waitcnt lgkmcnt(2)
  v_mfma_f32_32x32x16_bf16 v[0:15], a[32:35], v[32:35], v[0:15]
  ds_read_b128 v[44:47], v206 offset:38912
  v_mfma_f32_32x32x16_bf16 v[16:31], v[32:35], a[176:179], v[16:31]
  s_waitcnt lgkmcnt(2)
  v_mfma_f32_32x32x16_bf16 v[0:15], a[36:39], v[36:39], v[0:15]
  ds_read_b128 v[32:35], v203 offset:39936
  v_mfma_f32_32x32x16_bf16 v[16:31], v[36:39], a[180:183], v[16:31]
  s_waitcnt lgkmcnt(2)
  v_mfma_f32_32x32x16_bf16 v[0:15], a[40:43], v[40:43], v[0:15]
  ds_read_b128 v[36:39], v204 offset:39936
  v_mfma_f32_32x32x16_bf16 v[16:31], v[40:43], a[184:187], v[16:31]
  s_waitcnt lgkmcnt(2)
  v_mfma_f32_32x32x16_bf16 v[0:15], a[44:47], v[44:47], v[0:15]
  ds_read_b128 v[40:43], v205 offset:39936
  v_mfma_f32_32x32x16_bf16 v[16:31], v[44:47], a[188:191], v[16:31]
  s_waitcnt lgkmcnt(2)
  v_mfma_f32_32x32x16_bf16 v[0:15], a[48:51], v[32:35], v[0:15]
  ds_read_b128 v[44:47], v206 offset:39936
  v_mfma_f32_32x32x16_bf16 v[16:31], v[32:35], a[192:195], v[16:31]
  s_waitcnt lgkmcnt(2)
  v_mfma_f32_32x32x16_bf16 v[0:15], a[52:55], v[36:39], v[0:15]
  ds_read_b128 v[32:35], v203 offset:40960
  v_mfma_f32_32x32x16_bf16 v[16:31], v[36:39], a[196:199], v[16:31]
  s_waitcnt lgkmcnt(2)
  v_mfma_f32_32x32x16_bf16 v[0:15], a[56:59], v[40:43], v[0:15]
  ds_read_b128 v[36:39], v204 offset:40960
  v_mfma_f32_32x32x16_bf16 v[16:31], v[40:43], a[200:203], v[16:31]
  s_waitcnt lgkmcnt(2)
  v_mfma_f32_32x32x16_bf16 v[0:15], a[60:63], v[44:47], v[0:15]
  ds_read_b128 v[40:43], v205 offset:40960
  v_mfma_f32_32x32x16_bf16 v[16:31], v[44:47], a[204:207], v[16:31]
  s_waitcnt lgkmcnt(2)
  v_mfma_f32_32x32x16_bf16 v[0:15], a[64:67], v[32:35], v[0:15]
  ds_read_b128 v[44:47], v206 offset:40960
  v_mfma_f32_32x32x16_bf16 v[16:31], v[32:35], a[208:211], v[16:31]
  s_waitcnt lgkmcnt(2)
  v_mfma_f32_32x32x16_bf16 v[0:15], a[68:71], v[36:39], v[0:15]
  ds_read_b128 v[32:35], v203 offset:41984
  v_mfma_f32_32x32x16_bf16 v[16:31], v[36:39], a[212:215], v[16:31]
  s_waitcnt lgkmcnt(2)
  v_mfma_f32_32x32x16_bf16 v[0:15], a[72:75], v[40:43], v[0:15]
  ds_read_b128 v[36:39], v204 offset:41984
  v_mfma_f32_32x32x16_bf16 v[16:31], v[40:43], a[216:219], v[16:31]
  s_waitcnt lgkmcnt(2)
  v_mfma_f32_32x32x16_bf16 v[0:15], a[76:79], v[44:47], v[0:15]
  ds_read_b128 v[40:43], v205 offset:41984
  v_mfma_f32_32x32x16_bf16 v[16:31], v[44:47], a[220:223], v[16:31]
  s_waitcnt lgkmcnt(2)
  v_mfma_f32_32x32x16_bf16 v[0:15], a[80:83], v[32:35], v[0:15]
  ds_read_b128 v[44:47], v206 offset:41984
  v_mfma_f32_32x32x16_bf16 v[16:31], v[32:35], a[224:227], v[16:31]
  s_waitcnt lgkmcnt(2)
  v_mfma_f32_32x32x16_bf16 v[0:15], a[84:87], v[36:39], v[0:15]
  ds_read_b128 v[32:35], v203 offset:43008
  v_mfma_f32_32x32x16_bf16 v[16:31], v[36:39], a[228:231], v[16:31]
  s_waitcnt lgkmcnt(2)
  v_mfma_f32_32x32x16_bf16 v[0:15], a[88:91], v[40:43], v[0:15]
  ds_read_b128 v[36:39], v204 offset:43008
  v_mfma_f32_32x32x16_bf16 v[16:31], v[40:43], a[232:235], v[16:31]
  s_waitcnt lgkmcnt(2)
  v_mfma_f32_32x32x16_bf16 v[0:15], a[92:95], v[44:47], v[0:15]
  ds_read_b128 v[40:43], v205 offset:43008
  v_mfma_f32_32x32x16_bf16 v[16:31], v[44:47], a[236:239], v[16:31]
  s_waitcnt lgkmcnt(2)
  v_mfma_f32_32x32x16_bf16 v[0:15], a[96:99], v[32:35], v[0:15]
  ds_read_b128 v[44:47], v206 offset:43008
  v_mfma_f32_32x32x16_bf16 v[16:31], v[32:35], a[240:243], v[16:31]
  s_waitcnt lgkmcnt(2)
  v_mfma_f32_32x32x16_bf16 v[0:15], a[100:103], v[36:39], v[0:15]
  ds_read_b128 v[32:35], v203 offset:44032
  v_mfma_f32_32x32x16_bf16 v[16:31], v[36:39], a[244:247], v[16:31]
  s_waitcnt lgkmcnt(2)
  v_mfma_f32_32x32x16_bf16 v[0:15], a[104:107], v[40:43], v[0:15]
  ds_read_b128 v[36:39], v204 offset:44032
  v_mfma_f32_32x32x16_bf16 v[16:31], v[40:43], a[248:251], v[16:31]
  s_waitcnt lgkmcnt(2)
  v_mfma_f32_32x32x16_bf16 v[0:15], a[108:111], v[44:47], v[0:15]
  ds_read_b128 v[40:43], v205 offset:44032
  v_mfma_f32_32x32x16_bf16 v[16:31], v[44:47], a[252:255], v[16:31]
  s_waitcnt lgkmcnt(2)
  v_mfma_f32_32x32x16_bf16 v[0:15], a[112:115], v[32:35], v[0:15]
  ds_read_b128 v[44:47], v206 offset:44032
  v_mfma_f32_32x32x16_bf16 v[16:31], v[32:35], v[224:227], v[16:31]
  s_waitcnt lgkmcnt(2)
  v_mfma_f32_32x32x16_bf16 v[0:15], a[116:119], v[36:39], v[0:15]
  ds_read_b128 v[32:35], v203 offset:45056
  v_mfma_f32_32x32x16_bf16 v[16:31], v[36:39], v[228:231], v[16:31]
  s_waitcnt lgkmcnt(2)
  v_mfma_f32_32x32x16_bf16 v[0:15], a[120:123], v[40:43], v[0:15]
  ds_read_b128 v[36:39], v204 offset:45056
  v_mfma_f32_32x32x16_bf16 v[16:31], v[40:43], v[232:235], v[16:31]
  s_waitcnt lgkmcnt(2)
  v_mfma_f32_32x32x16_bf16 v[0:15], a[124:127], v[44:47], v[0:15]
  ds_read_b128 v[40:43], v205 offset:45056
  v_mfma_f32_32x32x16_bf16 v[16:31], v[44:47], v[236:239], v[16:31]
  s_waitcnt lgkmcnt(2)
  v_mfma_f32_32x32x16_bf16 v[0:15], a[128:131], v[32:35], v[0:15]
  ds_read_b128 v[44:47], v206 offset:45056
  v_mfma_f32_32x32x16_bf16 v[16:31], v[32:35], v[240:243], v[16:31]
  s_waitcnt lgkmcnt(2)
  v_mfma_f32_32x32x16_bf16 v[0:15], a[132:135], v[36:39], v[0:15]
  v_mfma_f32_32x32x16_bf16 v[16:31], v[36:39], v[244:247], v[16:31]
  s_waitcnt lgkmcnt(1)
  v_mfma_f32_32x32x16_bf16 v[0:15], a[136:139], v[40:43], v[0:15]
  v_mfma_f32_32x32x16_bf16 v[16:31], v[40:43], v[248:251], v[16:31]
  s_waitcnt lgkmcnt(0)
  v_mfma_f32_32x32x16_bf16 v[0:15], a[140:143], v[44:47], v[0:15]
  v_mfma_f32_32x32x16_bf16 v[16:31], v[44:47], v[252:255], v[16:31]
  s_mul_i32 s64, s59, 655360
  s_lshl_b32 s55, s58, 14
  s_add_u32 s64, s64, s55
  s_add_u32 s64, s64, 1048576
  s_add_u32 s55, s64, s69
  v_mul_f32 v0, s68, v0
  v_mul_f32 v1, s68, v1
  v_mul_f32 v2, s68, v2
  v_mul_f32 v3, s68, v3
  v_mul_f32 v4, s68, v4
  v_mul_f32 v5, s68, v5
  v_mul_f32 v6, s68, v6
  v_mul_f32 v7, s68, v7
  v_mul_f32 v8, s68, v8
  v_mul_f32 v9, s68, v9
  v_mul_f32 v10, s68, v10
  v_mul_f32 v11, s68, v11
  v_mul_f32 v12, s68, v12
  v_mul_f32 v13, s68, v13
  v_mul_f32 v14, s68, v14
  v_mul_f32 v15, s68, v15
  v_cvt_pk_bf16_f32 v48, v0, v4
  v_cvt_pk_bf16_f32 v49, v1, v5
  v_cvt_pk_bf16_f32 v50, v2, v6
  v_cvt_pk_bf16_f32 v51, v3, v7
  buffer_store_dwordx4 v[48:51], v216, s[8:11], s55 offen offset:0 sc1
  v_cvt_pk_bf16_f32 v52, v8, v12
  v_cvt_pk_bf16_f32 v53, v9, v13
  v_cvt_pk_bf16_f32 v54, v10, v14
  v_cvt_pk_bf16_f32 v55, v11, v15
  buffer_store_dwordx4 v[52:55], v216, s[8:11], s55 offen offset:256 sc1
  v_cvt_pk_bf16_f32 v56, v16, v17
  v_cvt_pk_bf16_f32 v57, v20, v21
  v_cvt_pk_bf16_f32 v58, v24, v25
  v_cvt_pk_bf16_f32 v59, v28, v29
  buffer_store_dwordx4 v[56:59], v217, s[8:11], s64 offen offset:0 sc1
  v_cvt_pk_bf16_f32 v60, v18, v19
  v_cvt_pk_bf16_f32 v61, v22, v23
  v_cvt_pk_bf16_f32 v62, v26, v27
  v_cvt_pk_bf16_f32 v63, v30, v31
  buffer_store_dwordx4 v[60:63], v217, s[8:11], s64 offen offset:256 sc1
  s_add_u32 s55, s64, s66
  buffer_store_dwordx4 v[64:67], v201, s[8:11], s55 offen sc1
  s_add_u32 s59, s59, 7
  s_cmp_ge_u32 s59, 64
  s_cbranch_scc1 KV_done
  s_sub_u32 s54, s59, 14
  s_cmp_lt_u32 s54, 7
  s_cbranch_scc1 KV_early
  s_waitcnt vmcnt(5)
  s_barrier
KV_cont:
  s_branch KV_loop
KV_early:
  s_waitcnt vmcnt(0)
  s_barrier
  s_cmp_eq_u32 s52, 0
  s_cbranch_scc0 KV_sig0
  v_mov_b32 v211, 1
  v_mov_b32 v212, 0
  s_mov_b64 exec, 1
  buffer_atomic_add v211, v212, s[12:15], s70 offen
  s_mov_b64 exec, -1
KV_sig0:
  s_branch KV_cont
KV_done:
  s_waitcnt vmcnt(0)
  s_barrier
  s_cmp_eq_u32 s52, 0
  s_cbranch_scc0 KV_sig
  v_mov_b32 v211, 256
  v_mov_b32 v212, 0
  s_mov_b64 exec, 1
  buffer_atomic_add v211, v212, s[12:15], s70 offen
  s_mov_b64 exec, -1
KV_sig:
  s_cmp_ge_u32 s53, 192
  s_cbranch_scc1 L_exit
  s_cmp_lt_u32 s53, 64
  s_cbranch_scc1 W_h
  s_sub_u32 s54, s53, 64
  s_lshr_b32 s68, s54, 4
  s_and_b32 s69, s54, 15
  s_lshl_b32 s60, s69, 2
  s_sub_u32 s60, s60, 1
  s_max_i32 s60, s60, 0
  s_mul_i32 s60, s60, 36864
  s_add_u32 m0, s67, 0
  s_nop 0
  buffer_load_dwordx4 v202, s[4:7], s60 offen offset:0 lds
  s_add_u32 m0, s67, 896
  s_nop 0
  buffer_load_dwordx4 v202, s[4:7], s60 offen offset:128 lds
  s_add_u32 m0, s67, 1792
  s_nop 0
  buffer_load_dwordx4 v202, s[4:7], s60 offen offset:256 lds
  s_add_u32 m0, s67, 2688
  s_nop 0
  buffer_load_dwordx4 v202, s[4:7], s60 offen offset:384 lds
  s_add_u32 m0, s67, 3584
  s_nop 0
  buffer_load_dwordx4 v202, s[4:7], s60 offen offset:512 lds
  s_add_u32 m0, s67, 4480
  s_nop 0
  buffer_load_dwordx4 v202, s[4:7], s60 offen offset:640 lds
  s_add_u32 m0, s67, 5376
  s_nop 0
  buffer_load_dwordx4 v202, s[4:7], s60 offen offset:768 lds
  s_add_u32 m0, s67, 6272
  s_nop 0
  buffer_load_dwordx4 v202, s[4:7], s60 offen offset:896 lds
  s_add_u32 m0, s67, 7168
  s_nop 0
  buffer_load_dwordx4 v202, s[4:7], s60 offen offset:1024 lds
  v_and_b32 v211, 15, v200
  v_mul_u32_u24 v211, 72, v211
  v_lshrrev_b32 v212, 4, v200
  v_mul_u32_u24 v213, 1152, v212
  v_add_u32 v213, v213, v211
  s_lshl_b32 s54, s54, 2
  s_add_u32 s70, s54, s52
  s_mul_i32 s55, s70, 4608
  buffer_load_dwordx4 v[48:51], v213, s[4:7], s55 offen offset:0
  buffer_load_dwordx4 v[52:55], v213, s[4:7], s55 offen offset:16
  buffer_load_dwordx4 v[56:59], v213, s[4:7], s55 offen offset:32
  buffer_load_dwordx4 v[60:63], v213, s[4:7], s55 offen offset:48
  buffer_load_dwordx2 v[64:65], v213, s[4:7], s55 offen offset:64
  buffer_load_dwordx4 v[68:71], v211, s[44:47], 0 offen offset:0
  buffer_load_dwordx4 v[72:75], v211, s[44:47], 0 offen offset:16
  buffer_load_dwordx4 v[76:79], v211, s[44:47], 0 offen offset:32
  buffer_load_dwordx4 v[80:83], v211, s[44:47], 0 offen offset:48
  buffer_load_dwordx2 v[84:85], v211, s[44:47], 0 offen offset:64
  v_mov_b32 v0, 0
  v_mov_b32 v1, 0x3f803f80
  s_waitcnt vmcnt(9)
  v_lshlrev_b32 v2, 16, v48
  s_waitcnt vmcnt(4)
  v_lshlrev_b32 v3, 16, v68
  v_and_b32 v4, 0xffff0000, v48
  v_and_b32 v5, 0xffff0000, v68
  v_mul_f32 v2, v2, v3
  v_mul_f32 v4, v4, v5
  v_cvt_pk_bf16_f32 v2, v2, v4
  v_lshlrev_b32 v3, 16, v2
  v_and_b32 v4, 0xffff0000, v2
  v_add_f32 v0, v0, v3
  v_add_f32 v0, v0, v4
  v_lshlrev_b32 v2, 16, v49
  v_lshlrev_b32 v3, 16, v69
  v_and_b32 v4, 0xffff0000, v49
  v_and_b32 v5, 0xffff0000, v69
  v_mul_f32 v2, v2, v3
  v_mul_f32 v4, v4, v5
  v_cvt_pk_bf16_f32 v2, v2, v4
  v_lshlrev_b32 v3, 16, v2
  v_and_b32 v4, 0xffff0000, v2
  v_add_f32 v0, v0, v3
  v_add_f32 v0, v0, v4
  v_lshlrev_b32 v2, 16, v50
  v_lshlrev_b32 v3, 16, v70
  v_and_b32 v4, 0xffff0000, v50
  v_and_b32 v5, 0xffff0000, v70
  v_mul_f32 v2, v2, v3
  v_mul_f32 v4, v4, v5
  v_cvt_pk_bf16_f32 v2, v2, v4
  v_lshlrev_b32 v3, 16, v2
  v_and_b32 v4, 0xffff0000, v2
  v_add_f32 v0, v0, v3
  v_add_f32 v0, v0, v4
  v_lshlrev_b32 v2, 16, v51
  v_lshlrev_b32 v3, 16, v71
  v_and_b32 v4, 0xffff0000, v51
  v_and_b32 v5, 0xffff0000, v71
  v_mul_f32 v2, v2, v3
  v_mul_f32 v4, v4, v5
  v_cvt_pk_bf16_f32 v2, v2, v4
  v_lshlrev_b32 v3, 16, v2
  v_and_b32 v4, 0xffff0000, v2
  v_add_f32 v0, v0, v3
  v_add_f32 v0, v0, v4
  v_lshlrev_b32 v2, 16, v52
  s_waitcnt vmcnt(3)
  v_lshlrev_b32 v3, 16, v72
  v_and_b32 v4, 0xffff0000, v52
  v_and_b32 v5, 0xffff0000, v72
  v_mul_f32 v2, v2, v3
  v_mul_f32 v4, v4, v5
  v_cvt_pk_bf16_f32 v2, v2, v4
  v_lshlrev_b32 v3, 16, v2
  v_and_b32 v4, 0xffff0000, v2
  v_add_f32 v0, v0, v3
  v_add_f32 v0, v0, v4
  v_lshlrev_b32 v2, 16, v53
  v_lshlrev_b32 v3, 16, v73
  v_and_b32 v4, 0xffff0000, v53
  v_and_b32 v5, 0xffff0000, v73
  v_mul_f32 v2, v2, v3
  v_mul_f32 v4, v4, v5
  v_cvt_pk_bf16_f32 v2, v2, v4
  v_lshlrev_b32 v3, 16, v2
  v_and_b32 v4, 0xffff0000, v2
  v_add_f32 v0, v0, v3
  v_add_f32 v0, v0, v4
  v_lshlrev_b32 v2, 16, v54
  v_lshlrev_b32 v3, 16, v74
  v_and_b32 v4, 0xffff0000, v54
  v_and_b32 v5, 0xffff0000, v74
  v_mul_f32 v2, v2, v3
  v_mul_f32 v4, v4, v5
  v_cvt_pk_bf16_f32 v2, v2, v4
  v_lshlrev_b32 v3, 16, v2
  v_and_b32 v4, 0xffff0000, v2
  v_add_f32 v0, v0, v3
  v_add_f32 v0, v0, v4
  v_lshlrev_b32 v2, 16, v55
  v_lshlrev_b32 v3, 16, v75
  v_and_b32 v4, 0xffff0000, v55
  v_and_b32 v5, 0xffff0000, v75
  v_mul_f32 v2, v2, v3
  v_mul_f32 v4, v4, v5
  v_cvt_pk_bf16_f32 v2, v2, v4
  v_lshlrev_b32 v3, 16, v2
  v_and_b32 v4, 0xffff0000, v2
  v_add_f32 v0, v0, v3
  v_add_f32 v0, v0, v4
  v_lshlrev_b32 v2, 16, v56
  s_waitcnt vmcnt(2)
  v_lshlrev_b32 v3, 16, v76
  v_and_b32 v4, 0xffff0000, v56
  v_and_b32 v5, 0xffff0000, v76
  v_mul_f32 v2, v2, v3
  v_mul_f32 v4, v4, v5
  v_cvt_pk_bf16_f32 v2, v2, v4
  v_lshlrev_b32 v3, 16, v2
  v_and_b32 v4, 0xffff0000, v2
  v_add_f32 v0, v0, v3
  v_add_f32 v0, v0, v4
  v_lshlrev_b32 v2, 16, v57
  v_lshlrev_b32 v3, 16, v77
  v_and_b32 v4, 0xffff0000, v57
  v_and_b32 v5, 0xffff0000, v77
  v_mul_f32 v2, v2, v3
  v_mul_f32 v4, v4, v5
  v_cvt_pk_bf16_f32 v2, v2, v4
  v_lshlrev_b32 v3, 16, v2
  v_and_b32 v4, 0xffff0000, v2
  v_add_f32 v0, v0, v3
  v_add_f32 v0, v0, v4
  v_lshlrev_b32 v2, 16, v58
  v_lshlrev_b32 v3, 16, v78
  v_and_b32 v4, 0xffff0000, v58
  v_and_b32 v5, 0xffff0000, v78
  v_mul_f32 v2, v2, v3
  v_mul_f32 v4, v4, v5
  v_cvt_pk_bf16_f32 v2, v2, v4
  v_lshlrev_b32 v3, 16, v2
  v_and_b32 v4, 0xffff0000, v2
  v_add_f32 v0, v0, v3
  v_add_f32 v0, v0, v4
  v_lshlrev_b32 v2, 16, v59
  v_lshlrev_b32 v3, 16, v79
  v_and_b32 v4, 0xffff0000, v59
  v_and_b32 v5, 0xffff0000, v79
  v_mul_f32 v2, v2, v3
  v_mul_f32 v4, v4, v5
  v_cvt_pk_bf16_f32 v2, v2, v4
  v_lshlrev_b32 v3, 16, v2
  v_and_b32 v4, 0xffff0000, v2
  v_add_f32 v0, v0, v3
  v_add_f32 v0, v0, v4
  v_lshlrev_b32 v2, 16, v60
  s_waitcnt vmcnt(1)
  v_lshlrev_b32 v3, 16, v80
  v_and_b32 v4, 0xffff0000, v60
  v_and_b32 v5, 0xffff0000, v80
  v_mul_f32 v2, v2, v3
  v_mul_f32 v4, v4, v5
  v_cvt_pk_bf16_f32 v2, v2, v4
  v_lshlrev_b32 v3, 16, v2
  v_and_b32 v4, 0xffff0000, v2
  v_add_f32 v0, v0, v3
  v_add_f32 v0, v0, v4
  v_lshlrev_b32 v2, 16, v61
  v_lshlrev_b32 v3, 16, v81
  v_and_b32 v4, 0xffff0000, v61
  v_and_b32 v5, 0xffff0000, v81
  v_mul_f32 v2, v2, v3
  v_mul_f32 v4, v4, v5
  v_cvt_pk_bf16_f32 v2, v2, v4
  v_lshlrev_b32 v3, 16, v2
  v_and_b32 v4, 0xffff0000, v2
  v_add_f32 v0, v0, v3
  v_add_f32 v0, v0, v4
  v_lshlrev_b32 v2, 16, v62
  v_lshlrev_b32 v3, 16, v82
  v_and_b32 v4, 0xffff0000, v62
  v_and_b32 v5, 0xffff0000, v82
  v_mul_f32 v2, v2, v3
  v_mul_f32 v4, v4, v5
  v_cvt_pk_bf16_f32 v2, v2, v4
  v_lshlrev_b32 v3, 16, v2
  v_and_b32 v4, 0xffff0000, v2
  v_add_f32 v0, v0, v3
  v_add_f32 v0, v0, v4
  v_lshlrev_b32 v2, 16, v63
  v_lshlrev_b32 v3, 16, v83
  v_and_b32 v4, 0xffff0000, v63
  v_and_b32 v5, 0xffff0000, v83
  v_mul_f32 v2, v2, v3
  v_mul_f32 v4, v4, v5
  v_cvt_pk_bf16_f32 v2, v2, v4
  v_lshlrev_b32 v3, 16, v2
  v_and_b32 v4, 0xffff0000, v2
  v_add_f32 v0, v0, v3
  v_add_f32 v0, v0, v4
  v_lshlrev_b32 v2, 16, v64
  s_waitcnt vmcnt(0)
  v_lshlrev_b32 v3, 16, v84
  v_and_b32 v4, 0xffff0000, v64
  v_and_b32 v5, 0xffff0000, v84
  v_mul_f32 v2, v2, v3
  v_mul_f32 v4, v4, v5
  v_cvt_pk_bf16_f32 v2, v2, v4
  v_lshlrev_b32 v3, 16, v2
  v_and_b32 v4, 0xffff0000, v2
  v_add_f32 v0, v0, v3
  v_add_f32 v0, v0, v4
  v_lshlrev_b32 v2, 16, v65
  v_lshlrev_b32 v3, 16, v85
  v_and_b32 v4, 0xffff0000, v65
  v_and_b32 v5, 0xffff0000, v85
  v_mul_f32 v2, v2, v3
  v_mul_f32 v4, v4, v5
  v_cvt_pk_bf16_f32 v2, v2, v4
  v_lshlrev_b32 v3, 16, v2
  v_and_b32 v4, 0xffff0000, v2
  v_add_f32 v0, v0, v3
  v_add_f32 v0, v0, v4
  s_nop 1
  v_add_f32_dpp v0, v0, v0 row_ror:1 row_mask:0xf bank_mask:0xf
  s_nop 1
  v_add_f32_dpp v0, v0, v0 row_ror:2 row_mask:0xf bank_mask:0xf
  s_nop 1
  v_add_f32_dpp v0, v0, v0 row_ror:4 row_mask:0xf bank_mask:0xf
  s_nop 1
  v_add_f32_dpp v0, v0, v0 row_ror:8 row_mask:0xf bank_mask:0xf
  v_cvt_pk_bf16_f32 v0, v0, v0
  v_lshlrev_b32 v0, 16, v0
  v_mul_f32 v0, 3216550459, v0
  v_exp_f32 v0, v0
  s_nop 0
  v_add_f32 v0, 1.0, v0
  v_rcp_f32 v0, v0
  s_nop 0
  v_cvt_pk_bf16_f32 v0, v0, v0
  v_lshlrev_b32 v0, 16, v0
  v_lshlrev_b32 v212, 2, v212
  s_lshl_b32 s55, s70, 4
  s_add_u32 s55, s55, 66060288
  s_mov_b32 exec_lo, 0x00010001
  s_mov_b32 exec_hi, 0x00010001
  buffer_store_dword v0, v212, s[8:11], s55 offen sc1
  s_mov_b64 exec, -1
  v_lshrrev_b32 v211, 4, v200
  v_lshlrev_b32 v212, 2, v211
  v_and_b32 v213, 15, v200
  v_xor_b32 v212, v212, v213
  v_mul_u32_u24 v211, 3456, v211
  v_mov_b32 v2, 0x40000000
  v_add_u32 v213, 0, v212
  v_mul_u32_u24 v214, 57, v213
  v_lshrrev_b32 v214, 9, v214
  v_mul_u32_u24 v214, 1008, v214
  v_lshl_add_u32 v214, v213, 4, v214
  v_add_u32 v214, v214, v211
  v_cmp_lt_u32 vcc, 26, v213
  s_nop 1
  v_cndmask_b32 v207, v214, v2, vcc
  v_add_u32 v213, 16, v212
  v_mul_u32_u24 v214, 57, v213
  v_lshrrev_b32 v214, 9, v214
  v_mul_u32_u24 v214, 1008, v214
  v_lshl_add_u32 v214, v213, 4, v214
  v_add_u32 v214, v214, v211
  v_cmp_lt_u32 vcc, 26, v213
  s_nop 1
  v_cndmask_b32 v208, v214, v2, vcc
  s_mul_i32 s62, s68, 144
  s_mul_i32 s54, s52, 13824
  s_add_u32 s62, s62, s54
  s_waitcnt vmcnt(0)
  s_lshl_b32 s61, s52, 10
  s_add_u32 s61, s61, 36864
  s_add_u32 m0, s61, 0
  s_add_u32 s54, s62, 0
  buffer_load_dwordx4 v207, s[36:39], s54 offen lds
  s_add_u32 m0, s61, 4096
  s_add_u32 s54, s62, 55296
  buffer_load_dwordx4 v207, s[36:39], s54 offen lds
  s_add_u32 m0, s61, 8192
  s_add_u32 s54, s62, 110592
  buffer_load_dwordx4 v207, s[36:39], s54 offen lds
  s_add_u32 m0, s61, 12288
  s_add_u32 s54, s62, 165888
  buffer_load_dwordx4 v207, s[36:39], s54 offen lds
  s_add_u32 m0, s61, 16384
  s_add_u32 s54, s62, 0
  buffer_load_dwordx4 v208, s[36:39], s54 offen lds
  s_add_u32 m0, s61, 20480
  s_add_u32 s54, s62, 55296
  buffer_load_dwordx4 v208, s[36:39], s54 offen lds
  s_add_u32 m0, s61, 24576
  s_add_u32 s54, s62, 110592
  buffer_load_dwordx4 v208, s[36:39], s54 offen lds
  s_add_u32 m0, s61, 28672
  s_add_u32 s54, s62, 165888
  buffer_load_dwordx4 v208, s[36:39], s54 offen lds
  s_add_u32 m0, s61, 32768
  s_add_u32 s54, s62, 221184
  buffer_load_dwordx4 v207, s[36:39], s54 offen lds
  s_add_u32 m0, s61, 36864
  s_add_u32 s54, s62, 276480
  buffer_load_dwordx4 v207, s[36:39], s54 offen lds
  s_add_u32 m0, s61, 40960
  s_add_u32 s54, s62, 331776
  buffer_load_dwordx4 v207, s[36:39], s54 offen lds
  s_add_u32 m0, s61, 45056
  s_add_u32 s54, s62, 387072
  buffer_load_dwordx4 v207, s[36:39], s54 offen lds
  s_add_u32 m0, s61, 49152
  s_add_u32 s54, s62, 221184
  buffer_load_dwordx4 v208, s[36:39], s54 offen lds
  s_add_u32 m0, s61, 53248
  s_add_u32 s54, s62, 276480
  buffer_load_dwordx4 v208, s[36:39], s54 offen lds
  s_add_u32 m0, s61, 57344
  s_add_u32 s54, s62, 331776
  buffer_load_dwordx4 v208, s[36:39], s54 offen lds
  s_add_u32 m0, s61, 61440
  s_add_u32 s54, s62, 387072
  buffer_load_dwordx4 v208, s[36:39], s54 offen lds
  s_add_u32 m0, s61, 65536
  s_add_u32 s54, s62, 442368
  buffer_load_dwordx4 v207, s[36:39], s54 offen lds
  s_add_u32 m0, s61, 69632
  s_add_u32 s54, s62, 497664
  buffer_load_dwordx4 v207, s[36:39], s54 offen lds
  s_add_u32 m0, s61, 73728
  s_add_u32 s54, s62, 552960
  buffer_load_dwordx4 v207, s[36:39], s54 offen lds
  s_add_u32 m0, s61, 77824
  s_add_u32 s54, s62, 608256
  buffer_load_dwordx4 v207, s[36:39], s54 offen lds
  s_add_u32 m0, s61, 81920
  s_add_u32 s54, s62, 442368
  buffer_load_dwordx4 v208, s[36:39], s54 offen lds
  s_add_u32 m0, s61, 86016
  s_add_u32 s54, s62, 497664
  buffer_load_dwordx4 v208, s[36:39], s54 offen lds
  s_add_u32 m0, s61, 90112
  s_add_u32 s54, s62, 552960
  buffer_load_dwordx4 v208, s[36:39], s54 offen lds
  s_add_u32 m0, s61, 94208
  s_add_u32 s54, s62, 608256
  buffer_load_dwordx4 v208, s[36:39], s54 offen lds
  s_waitcnt vmcnt(20) lgkmcnt(0)
  s_barrier
  s_add_u32 m0, s61, 98304
  s_add_u32 s54, s62, 663552
  buffer_load_dwordx4 v207, s[36:39], s54 offen lds
  s_add_u32 m0, s61, 102400
  s_add_u32 s54, s62, 718848
  buffer_load_dwordx4 v207, s[36:39], s54 offen lds
  s_add_u32 m0, s61, 106496
  s_add_u32 s54, s62, 774144
  buffer_load_dwordx4 v207, s[36:39], s54 offen lds
  s_add_u32 m0, s61, 110592
  s_add_u32 s54, s62, 829440
  buffer_load_dwordx4 v207, s[36:39], s54 offen lds
  v_add_u32 v215, 36864, v210
  ds_read_b64_tr_b16 a[0:1], v215 offset:0
  ds_read_b64_tr_b16 a[2:3], v215 offset:1024
  ds_read_b64_tr_b16 a[4:5], v215 offset:4096
  ds_read_b64_tr_b16 a[6:7], v215 offset:5120
  ds_read_b64_tr_b16 a[8:9], v215 offset:8192
  ds_read_b64_tr_b16 a[10:11], v215 offset:9216
  ds_read_b64_tr_b16 a[12:13], v215 offset:12288
  ds_read_b64_tr_b16 a[14:15], v215 offset:13312
  s_waitcnt vmcnt(20) lgkmcnt(0)
  s_barrier
  s_add_u32 m0, s61, 0
  s_add_u32 s54, s62, 663552
  buffer_load_dwordx4 v208, s[36:39], s54 offen lds
  s_add_u32 m0, s61, 4096
  s_add_u32 s54, s62, 718848
  buffer_load_dwordx4 v208, s[36:39], s54 offen lds
  s_add_u32 m0, s61, 8192
  s_add_u32 s54, s62, 774144
  buffer_load_dwordx4 v208, s[36:39], s54 offen lds
  s_add_u32 m0, s61, 12288
  s_add_u32 s54, s62, 829440
  buffer_load_dwordx4 v208, s[36:39], s54 offen lds
  v_add_u32 v215, 53248, v210
  ds_read_b64_tr_b16 a[144:145], v215 offset:0
  ds_read_b64_tr_b16 a[146:147], v215 offset:1024
  ds_read_b64_tr_b16 a[148:149], v215 offset:4096
  ds_read_b64_tr_b16 a[150:151], v215 offset:5120
  ds_read_b64_tr_b16 a[152:153], v215 offset:8192
  ds_read_b64_tr_b16 a[154:155], v215 offset:9216
  ds_read_b64_tr_b16 a[156:157], v215 offset:12288
  ds_read_b64_tr_b16 a[158:159], v215 offset:13312
  s_waitcnt vmcnt(20) lgkmcnt(0)
  s_barrier
  s_add_u32 m0, s61, 16384
  s_add_u32 s54, s62, 884736
  buffer_load_dwordx4 v207, s[36:39], s54 offen lds
  s_add_u32 m0, s61, 20480
  s_add_u32 s54, s62, 940032
  buffer_load_dwordx4 v207, s[36:39], s54 offen lds
  s_add_u32 m0, s61, 24576
  s_add_u32 s54, s62, 995328
  buffer_load_dwordx4 v207, s[36:39], s54 offen lds
  s_add_u32 m0, s61, 28672
  s_add_u32 s54, s62, 1050624
  buffer_load_dwordx4 v207, s[36:39], s54 offen lds
  v_add_u32 v215, 69632, v210
  ds_read_b64_tr_b16 a[16:17], v215 offset:0
  ds_read_b64_tr_b16 a[18:19], v215 offset:1024
  ds_read_b64_tr_b16 a[20:21], v215 offset:4096
  ds_read_b64_tr_b16 a[22:23], v215 offset:5120
  ds_read_b64_tr_b16 a[24:25], v215 offset:8192
  ds_read_b64_tr_b16 a[26:27], v215 offset:9216
  ds_read_b64_tr_b16 a[28:29], v215 offset:12288
  ds_read_b64_tr_b16 a[30:31], v215 offset:13312
  s_waitcnt vmcnt(20) lgkmcnt(0)
  s_barrier
  s_add_u32 m0, s61, 32768
  s_add_u32 s54, s62, 884736
  buffer_load_dwordx4 v208, s[36:39], s54 offen lds
  s_add_u32 m0, s61, 36864
  s_add_u32 s54, s62, 940032
  buffer_load_dwordx4 v208, s[36:39], s54 offen lds
  s_add_u32 m0, s61, 40960
  s_add_u32 s54, s62, 995328
  buffer_load_dwordx4 v208, s[36:39], s54 offen lds
  s_add_u32 m0, s61, 45056
  s_add_u32 s54, s62, 1050624
  buffer_load_dwordx4 v208, s[36:39], s54 offen lds
  v_add_u32 v215, 86016, v210
  ds_read_b64_tr_b16 a[160:161], v215 offset:0
  ds_read_b64_tr_b16 a[162:163], v215 offset:1024
  ds_read_b64_tr_b16 a[164:165], v215 offset:4096
  ds_read_b64_tr_b16 a[166:167], v215 offset:5120
  ds_read_b64_tr_b16 a[168:169], v215 offset:8192
  ds_read_b64_tr_b16 a[170:171], v215 offset:9216
  ds_read_b64_tr_b16 a[172:173], v215 offset:12288
  ds_read_b64_tr_b16 a[174:175], v215 offset:13312
  s_waitcnt vmcnt(20) lgkmcnt(0)
  s_barrier
  s_add_u32 m0, s61, 49152
  s_add_u32 s54, s62, 1105920
  buffer_load_dwordx4 v207, s[36:39], s54 offen lds
  s_add_u32 m0, s61, 53248
  s_add_u32 s54, s62, 1161216
  buffer_load_dwordx4 v207, s[36:39], s54 offen lds
  s_add_u32 m0, s61, 57344
  s_add_u32 s54, s62, 1216512
  buffer_load_dwordx4 v207, s[36:39], s54 offen lds
  s_add_u32 m0, s61, 61440
  s_add_u32 s54, s62, 1271808
  buffer_load_dwordx4 v207, s[36:39], s54 offen lds
  v_add_u32 v215, 102400, v210
  ds_read_b64_tr_b16 a[32:33], v215 offset:0
  ds_read_b64_tr_b16 a[34:35], v215 offset:1024
  ds_read_b64_tr_b16 a[36:37], v215 offset:4096
  ds_read_b64_tr_b16 a[38:39], v215 offset:5120
  ds_read_b64_tr_b16 a[40:41], v215 offset:8192
  ds_read_b64_tr_b16 a[42:43], v215 offset:9216
  ds_read_b64_tr_b16 a[44:45], v215 offset:12288
  ds_read_b64_tr_b16 a[46:47], v215 offset:13312
  s_waitcnt vmcnt(20) lgkmcnt(0)
  s_barrier
  s_add_u32 m0, s61, 65536
  s_add_u32 s54, s62, 1105920
  buffer_load_dwordx4 v208, s[36:39], s54 offen lds
  s_add_u32 m0, s61, 69632
  s_add_u32 s54, s62, 1161216
  buffer_load_dwordx4 v208, s[36:39], s54 offen lds
  s_add_u32 m0, s61, 73728
  s_add_u32 s54, s62, 1216512
  buffer_load_dwordx4 v208, s[36:39], s54 offen lds
  s_add_u32 m0, s61, 77824
  s_add_u32 s54, s62, 1271808
  buffer_load_dwordx4 v208, s[36:39], s54 offen lds
  v_add_u32 v215, 118784, v210
  ds_read_b64_tr_b16 a[176:177], v215 offset:0
  ds_read_b64_tr_b16 a[178:179], v215 offset:1024
  ds_read_b64_tr_b16 a[180:181], v215 offset:4096
  ds_read_b64_tr_b16 a[182:183], v215 offset:5120
  ds_read_b64_tr_b16 a[184:185], v215 offset:8192
  ds_read_b64_tr_b16 a[186:187], v215 offset:9216
  ds_read_b64_tr_b16 a[188:189], v215 offset:12288
  ds_read_b64_tr_b16 a[190:191], v215 offset:13312
  s_waitcnt vmcnt(20) lgkmcnt(0)
  s_barrier
  s_add_u32 m0, s61, 81920
  s_add_u32 s54, s62, 1327104
  buffer_load_dwordx4 v207, s[36:39], s54 offen lds
  s_add_u32 m0, s61, 86016
  s_add_u32 s54, s62, 1382400
  buffer_load_dwordx4 v207, s[36:39], s54 offen lds
  s_add_u32 m0, s61, 90112
  s_add_u32 s54, s62, 1437696
  buffer_load_dwordx4 v207, s[36:39], s54 offen lds
  s_add_u32 m0, s61, 94208
  s_add_u32 s54, s62, 1492992
  buffer_load_dwordx4 v207, s[36:39], s54 offen lds
  v_add_u32 v215, 135168, v210
  ds_read_b64_tr_b16 a[48:49], v215 offset:0
  ds_read_b64_tr_b16 a[50:51], v215 offset:1024
  ds_read_b64_tr_b16 a[52:53], v215 offset:4096
  ds_read_b64_tr_b16 a[54:55], v215 offset:5120
  ds_read_b64_tr_b16 a[56:57], v215 offset:8192
  ds_read_b64_tr_b16 a[58:59], v215 offset:9216
  ds_read_b64_tr_b16 a[60:61], v215 offset:12288
  ds_read_b64_tr_b16 a[62:63], v215 offset:13312
  s_waitcnt vmcnt(20) lgkmcnt(0)
  s_barrier
  s_add_u32 m0, s61, 98304
  s_add_u32 s54, s62, 1327104
  buffer_load_dwordx4 v208, s[36:39], s54 offen lds
  s_add_u32 m0, s61, 102400
  s_add_u32 s54, s62, 1382400
  buffer_load_dwordx4 v208, s[36:39], s54 offen lds
  s_add_u32 m0, s61, 106496
  s_add_u32 s54, s62, 1437696
  buffer_load_dwordx4 v208, s[36:39], s54 offen lds
  s_add_u32 m0, s61, 110592
  s_add_u32 s54, s62, 1492992
  buffer_load_dwordx4 v208, s[36:39], s54 offen lds
  v_add_u32 v215, 36864, v210
  ds_read_b64_tr_b16 a[192:193], v215 offset:0
  ds_read_b64_tr_b16 a[194:195], v215 offset:1024
  ds_read_b64_tr_b16 a[196:197], v215 offset:4096
  ds_read_b64_tr_b16 a[198:199], v215 offset:5120
  ds_read_b64_tr_b16 a[200:201], v215 offset:8192
  ds_read_b64_tr_b16 a[202:203], v215 offset:9216
  ds_read_b64_tr_b16 a[204:205], v215 offset:12288
  ds_read_b64_tr_b16 a[206:207], v215 offset:13312
  s_waitcnt vmcnt(20) lgkmcnt(0)
  s_barrier
  s_add_u32 m0, s61, 0
  s_add_u32 s54, s62, 1548288
  buffer_load_dwordx4 v207, s[36:39], s54 offen lds
  s_add_u32 m0, s61, 4096
  s_add_u32 s54, s62, 1603584
  buffer_load_dwordx4 v207, s[36:39], s54 offen lds
  s_add_u32 m0, s61, 8192
  s_add_u32 s54, s62, 1658880
  buffer_load_dwordx4 v207, s[36:39], s54 offen lds
  s_add_u32 m0, s61, 12288
  s_add_u32 s54, s62, 1714176
  buffer_load_dwordx4 v207, s[36:39], s54 offen lds
  v_add_u32 v215, 53248, v210
  ds_read_b64_tr_b16 a[64:65], v215 offset:0
  ds_read_b64_tr_b16 a[66:67], v215 offset:1024
  ds_read_b64_tr_b16 a[68:69], v215 offset:4096
  ds_read_b64_tr_b16 a[70:71], v215 offset:5120
  ds_read_b64_tr_b16 a[72:73], v215 offset:8192
  ds_read_b64_tr_b16 a[74:75], v215 offset:9216
  ds_read_b64_tr_b16 a[76:77], v215 offset:12288
  ds_read_b64_tr_b16 a[78:79], v215 offset:13312
  s_waitcnt vmcnt(20) lgkmcnt(0)
  s_barrier
  s_add_u32 m0, s61, 16384
  s_add_u32 s54, s62, 1548288
  buffer_load_dwordx4 v208, s[36:39], s54 offen lds
  s_add_u32 m0, s61, 20480
  s_add_u32 s54, s62, 1603584
  buffer_load_dwordx4 v208, s[36:39], s54 offen lds
  s_add_u32 m0, s61, 24576
  s_add_u32 s54, s62, 1658880
  buffer_load_dwordx4 v208, s[36:39], s54 offen lds
  s_add_u32 m0, s61, 28672
  s_add_u32 s54, s62, 1714176
  buffer_load_dwordx4 v208, s[36:39], s54 offen lds
  v_add_u32 v215, 69632, v210
  ds_read_b64_tr_b16 a[208:209], v215 offset:0
  ds_read_b64_tr_b16 a[210:211], v215 offset:1024
  ds_read_b64_tr_b16 a[212:213], v215 offset:4096
  ds_read_b64_tr_b16 a[214:215], v215 offset:5120
  ds_read_b64_tr_b16 a[216:217], v215 offset:8192
  ds_read_b64_tr_b16 a[218:219], v215 offset:9216
  ds_read_b64_tr_b16 a[220:221], v215 offset:12288
  ds_read_b64_tr_b16 a[222:223], v215 offset:13312
  s_waitcnt vmcnt(20) lgkmcnt(0)
  s_barrier
  s_add_u32 m0, s61, 32768
  s_add_u32 s54, s62, 1769472
  buffer_load_dwordx4 v207, s[36:39], s54 offen lds
  s_add_u32 m0, s61, 36864
  s_add_u32 s54, s62, 1824768
  buffer_load_dwordx4 v207, s[36:39], s54 offen lds
  s_add_u32 m0, s61, 40960
  s_add_u32 s54, s62, 1880064
  buffer_load_dwordx4 v207, s[36:39], s54 offen lds
  s_add_u32 m0, s61, 45056
  s_add_u32 s54, s62, 1935360
  buffer_load_dwordx4 v207, s[36:39], s54 offen lds
  v_add_u32 v215, 86016, v210
  ds_read_b64_tr_b16 a[80:81], v215 offset:0
  ds_read_b64_tr_b16 a[82:83], v215 offset:1024
  ds_read_b64_tr_b16 a[84:85], v215 offset:4096
  ds_read_b64_tr_b16 a[86:87], v215 offset:5120
  ds_read_b64_tr_b16 a[88:89], v215 offset:8192
  ds_read_b64_tr_b16 a[90:91], v215 offset:9216
  ds_read_b64_tr_b16 a[92:93], v215 offset:12288
  ds_read_b64_tr_b16 a[94:95], v215 offset:13312
  s_waitcnt vmcnt(20) lgkmcnt(0)
  s_barrier
  s_add_u32 m0, s61, 49152
  s_add_u32 s54, s62, 1769472
  buffer_load_dwordx4 v208, s[36:39], s54 offen lds
  s_add_u32 m0, s61, 53248
  s_add_u32 s54, s62, 1824768
  buffer_load_dwordx4 v208, s[36:39], s54 offen lds
  s_add_u32 m0, s61, 57344
  s_add_u32 s54, s62, 1880064
  buffer_load_dwordx4 v208, s[36:39], s54 offen lds
  s_add_u32 m0, s61, 61440
  s_add_u32 s54, s62, 1935360
  buffer_load_dwordx4 v208, s[36:39], s54 offen lds
  v_add_u32 v215, 102400, v210
  ds_read_b64_tr_b16 a[224:225], v215 offset:0
  ds_read_b64_tr_b16 a[226:227], v215 offset:1024
  ds_read_b64_tr_b16 a[228:229], v215 offset:4096
  ds_read_b64_tr_b16 a[230:231], v215 offset:5120
  ds_read_b64_tr_b16 a[232:233], v215 offset:8192
  ds_read_b64_tr_b16 a[234:235], v215 offset:9216
  ds_read_b64_tr_b16 a[236:237], v215 offset:12288
  ds_read_b64_tr_b16 a[238:239], v215 offset:13312
  s_waitcnt vmcnt(20) lgkmcnt(0)
  s_barrier
  v_add_u32 v215, 118784, v210
  ds_read_b64_tr_b16 a[96:97], v215 offset:0
  ds_read_b64_tr_b16 a[98:99], v215 offset:1024
  ds_read_b64_tr_b16 a[100:101], v215 offset:4096
  ds_read_b64_tr_b16 a[102:103], v215 offset:5120
  ds_read_b64_tr_b16 a[104:105], v215 offset:8192
  ds_read_b64_tr_b16 a[106:107], v215 offset:9216
  ds_read_b64_tr_b16 a[108:109], v215 offset:12288
  ds_read_b64_tr_b16 a[110:111], v215 offset:13312
  s_waitcnt vmcnt(16) lgkmcnt(0)
  s_barrier
  v_add_u32 v215, 135168, v210
  ds_read_b64_tr_b16 a[240:241], v215 offset:0
  ds_read_b64_tr_b16 a[242:243], v215 offset:1024
  ds_read_b64_tr_b16 a[244:245], v215 offset:4096
  ds_read_b64_tr_b16 a[246:247], v215 offset:5120
  ds_read_b64_tr_b16 a[248:249], v215 offset:8192
  ds_read_b64_tr_b16 a[250:251], v215 offset:9216
  ds_read_b64_tr_b16 a[252:253], v215 offset:12288
  ds_read_b64_tr_b16 a[254:255], v215 offset:13312
  s_waitcnt vmcnt(12) lgkmcnt(0)
  s_barrier
  v_add_u32 v215, 36864, v210
  ds_read_b64_tr_b16 a[112:113], v215 offset:0
  ds_read_b64_tr_b16 a[114:115], v215 offset:1024
  ds_read_b64_tr_b16 a[116:117], v215 offset:4096
  ds_read_b64_tr_b16 a[118:119], v215 offset:5120
  ds_read_b64_tr_b16 a[120:121], v215 offset:8192
  ds_read_b64_tr_b16 a[122:123], v215 offset:9216
  ds_read_b64_tr_b16 a[124:125], v215 offset:12288
  ds_read_b64_tr_b16 a[126:127], v215 offset:13312
  s_waitcnt vmcnt(8) lgkmcnt(0)
  s_barrier
  v_add_u32 v215, 53248, v210
  ds_read_b64_tr_b16 v[224:225], v215 offset:0
  ds_read_b64_tr_b16 v[226:227], v215 offset:1024
  ds_read_b64_tr_b16 v[228:229], v215 offset:4096
  ds_read_b64_tr_b16 v[230:231], v215 offset:5120
  ds_read_b64_tr_b16 v[232:233], v215 offset:8192
  ds_read_b64_tr_b16 v[234:235], v215 offset:9216
  ds_read_b64_tr_b16 v[236:237], v215 offset:12288
  ds_read_b64_tr_b16 v[238:239], v215 offset:13312
  s_waitcnt vmcnt(4) lgkmcnt(0)
  s_barrier
  v_add_u32 v215, 69632, v210
  ds_read_b64_tr_b16 a[128:129], v215 offset:0
  ds_read_b64_tr_b16 a[130:131], v215 offset:1024
  ds_read_b64_tr_b16 a[132:133], v215 offset:4096
  ds_read_b64_tr_b16 a[134:135], v215 offset:5120
  ds_read_b64_tr_b16 a[136:137], v215 offset:8192
  ds_read_b64_tr_b16 a[138:139], v215 offset:9216
  ds_read_b64_tr_b16 a[140:141], v215 offset:12288
  ds_read_b64_tr_b16 a[142:143], v215 offset:13312
  s_waitcnt vmcnt(0) lgkmcnt(0)
  s_barrier
  v_add_u32 v215, 86016, v210
  ds_read_b64_tr_b16 v[240:241], v215 offset:0
  ds_read_b64_tr_b16 v[242:243], v215 offset:1024
  ds_read_b64_tr_b16 v[244:245], v215 offset:4096
  ds_read_b64_tr_b16 v[246:247], v215 offset:5120
  ds_read_b64_tr_b16 v[248:249], v215 offset:8192
  ds_read_b64_tr_b16 v[250:251], v215 offset:9216
  ds_read_b64_tr_b16 v[252:253], v215 offset:12288
  ds_read_b64_tr_b16 v[254:255], v215 offset:13312
  s_waitcnt lgkmcnt(0)
  s_barrier
  v_and_b32 v211, 31, v200
  v_mul_u32_u24 v218, 516, v211
  v_lshrrev_b32 v212, 5, v200
  v_lshl_add_u32 v218, v212, 3, v218
  s_lshl_b32 s54, s52, 6
  s_add_u32 s54, s54, 73728
  v_add_u32 v218, s54, v218
  s_lshl_b32 s60, s69, 2
  s_mul_i32 s60, s60, 36864
  s_add_u32 m0, s67, 36864
  s_nop 0
  buffer_load_dwordx4 v202, s[4:7], s60 offen offset:0 lds
  s_add_u32 m0, s67, 37760
  s_nop 0
  buffer_load_dwordx4 v202, s[4:7], s60 offen offset:128 lds
  s_add_u32 m0, s67, 38656
  s_nop 0
  buffer_load_dwordx4 v202, s[4:7], s60 offen offset:256 lds
  s_add_u32 m0, s67, 39552
  s_nop 0
  buffer_load_dwordx4 v202, s[4:7], s60 offen offset:384 lds
  s_add_u32 m0, s67, 40448
  s_nop 0
  buffer_load_dwordx4 v202, s[4:7], s60 offen offset:512 lds
  s_add_u32 m0, s67, 41344
  s_nop 0
  buffer_load_dwordx4 v202, s[4:7], s60 offen offset:640 lds
  s_add_u32 m0, s67, 42240
  s_nop 0
  buffer_load_dwordx4 v202, s[4:7], s60 offen offset:768 lds
  s_add_u32 m0, s67, 43136
  s_nop 0
  buffer_load_dwordx4 v202, s[4:7], s60 offen offset:896 lds
  s_add_u32 m0, s67, 44032
  s_nop 0
  buffer_load_dwordx4 v202, s[4:7], s60 offen offset:1024 lds
  s_add_u32 s60, s60, 36864
  ds_read_b128 v[32:35], v203 offset:0
  ds_read_b128 v[36:39], v204 offset:0
  ds_read_b128 v[40:43], v205 offset:0
  s_waitcnt lgkmcnt(2)
  v_mfma_f32_32x32x16_bf16 v[0:15], a[0:3], v[32:35], 0
  ds_read_b128 v[44:47], v206 offset:0
  v_mfma_f32_32x32x16_bf16 v[16:31], a[144:147], v[32:35], 0
  s_waitcnt lgkmcnt(2)
  v_mfma_f32_32x32x16_bf16 v[0:15], a[4:7], v[36:39], v[0:15]
  ds_read_b128 v[32:35], v203 offset:1024
  v_mfma_f32_32x32x16_bf16 v[16:31], a[148:151], v[36:39], v[16:31]
  s_waitcnt lgkmcnt(2)
  v_mfma_f32_32x32x16_bf16 v[0:15], a[8:11], v[40:43], v[0:15]
  ds_read_b128 v[36:39], v204 offset:1024
  v_mfma_f32_32x32x16_bf16 v[16:31], a[152:155], v[40:43], v[16:31]
  s_waitcnt lgkmcnt(2)
  v_mfma_f32_32x32x16_bf16 v[0:15], a[12:15], v[44:47], v[0:15]
  ds_read_b128 v[40:43], v205 offset:1024
  v_mfma_f32_32x32x16_bf16 v[16:31], a[156:159], v[44:47], v[16:31]
  s_waitcnt lgkmcnt(2)
  v_mfma_f32_32x32x16_bf16 v[0:15], a[16:19], v[32:35], v[0:15]
  ds_read_b128 v[44:47], v206 offset:1024
  v_mfma_f32_32x32x16_bf16 v[16:31], a[160:163], v[32:35], v[16:31]
  s_waitcnt lgkmcnt(2)
  v_mfma_f32_32x32x16_bf16 v[0:15], a[20:23], v[36:39], v[0:15]
  ds_read_b128 v[32:35], v203 offset:2048
  v_mfma_f32_32x32x16_bf16 v[16:31], a[164:167], v[36:39], v[16:31]
  s_waitcnt lgkmcnt(2)
  v_mfma_f32_32x32x16_bf16 v[0:15], a[24:27], v[40:43], v[0:15]
  ds_read_b128 v[36:39], v204 offset:2048
  v_mfma_f32_32x32x16_bf16 v[16:31], a[168:171], v[40:43], v[16:31]
  s_waitcnt lgkmcnt(2)
  v_mfma_f32_32x32x16_bf16 v[0:15], a[28:31], v[44:47], v[0:15]
  ds_read_b128 v[40:43], v205 offset:2048
  v_mfma_f32_32x32x16_bf16 v[16:31], a[172:175], v[44:47], v[16:31]
  s_waitcnt lgkmcnt(2)
  v_mfma_f32_32x32x16_bf16 v[0:15], a[32:35], v[32:35], v[0:15]
  ds_read_b128 v[44:47], v206 offset:2048
  v_mfma_f32_32x32x16_bf16 v[16:31], a[176:179], v[32:35], v[16:31]
  s_waitcnt lgkmcnt(2)
  v_mfma_f32_32x32x16_bf16 v[0:15], a[36:39], v[36:39], v[0:15]
  ds_read_b128 v[32:35], v203 offset:3072
  v_mfma_f32_32x32x16_bf16 v[16:31], a[180:183], v[36:39], v[16:31]
  s_waitcnt lgkmcnt(2)
  v_mfma_f32_32x32x16_bf16 v[0:15], a[40:43], v[40:43], v[0:15]
  ds_read_b128 v[36:39], v204 offset:3072
  v_mfma_f32_32x32x16_bf16 v[16:31], a[184:187], v[40:43], v[16:31]
  s_waitcnt lgkmcnt(2)
  v_mfma_f32_32x32x16_bf16 v[0:15], a[44:47], v[44:47], v[0:15]
  ds_read_b128 v[40:43], v205 offset:3072
  v_mfma_f32_32x32x16_bf16 v[16:31], a[188:191], v[44:47], v[16:31]
  s_waitcnt lgkmcnt(2)
  v_mfma_f32_32x32x16_bf16 v[0:15], a[48:51], v[32:35], v[0:15]
  ds_read_b128 v[44:47], v206 offset:3072
  v_mfma_f32_32x32x16_bf16 v[16:31], a[192:195], v[32:35], v[16:31]
  s_waitcnt lgkmcnt(2)
  v_mfma_f32_32x32x16_bf16 v[0:15], a[52:55], v[36:39], v[0:15]
  ds_read_b128 v[32:35], v203 offset:4096
  v_mfma_f32_32x32x16_bf16 v[16:31], a[196:199], v[36:39], v[16:31]
  s_waitcnt lgkmcnt(2)
  v_mfma_f32_32x32x16_bf16 v[0:15], a[56:59], v[40:43], v[0:15]
  ds_read_b128 v[36:39], v204 offset:4096
  v_mfma_f32_32x32x16_bf16 v[16:31], a[200:203], v[40:43], v[16:31]
  s_waitcnt lgkmcnt(2)
  v_mfma_f32_32x32x16_bf16 v[0:15], a[60:63], v[44:47], v[0:15]
  ds_read_b128 v[40:43], v205 offset:4096
  v_mfma_f32_32x32x16_bf16 v[16:31], a[204:207], v[44:47], v[16:31]
  s_waitcnt lgkmcnt(2)
  v_mfma_f32_32x32x16_bf16 v[0:15], a[64:67], v[32:35], v[0:15]
  ds_read_b128 v[44:47], v206 offset:4096
  v_mfma_f32_32x32x16_bf16 v[16:31], a[208:211], v[32:35], v[16:31]
  s_waitcnt lgkmcnt(2)
  v_mfma_f32_32x32x16_bf16 v[0:15], a[68:71], v[36:39], v[0:15]
  ds_read_b128 v[32:35], v203 offset:5120
  v_mfma_f32_32x32x16_bf16 v[16:31], a[212:215], v[36:39], v[16:31]
  s_waitcnt lgkmcnt(2)
  v_mfma_f32_32x32x16_bf16 v[0:15], a[72:75], v[40:43], v[0:15]
  ds_read_b128 v[36:39], v204 offset:5120
  v_mfma_f32_32x32x16_bf16 v[16:31], a[216:219], v[40:43], v[16:31]
  s_waitcnt lgkmcnt(2)
  v_mfma_f32_32x32x16_bf16 v[0:15], a[76:79], v[44:47], v[0:15]
  ds_read_b128 v[40:43], v205 offset:5120
  v_mfma_f32_32x32x16_bf16 v[16:31], a[220:223], v[44:47], v[16:31]
  s_waitcnt lgkmcnt(2)
  v_mfma_f32_32x32x16_bf16 v[0:15], a[80:83], v[32:35], v[0:15]
  ds_read_b128 v[44:47], v206 offset:5120
  v_mfma_f32_32x32x16_bf16 v[16:31], a[224:227], v[32:35], v[16:31]
  s_waitcnt lgkmcnt(2)
  v_mfma_f32_32x32x16_bf16 v[0:15], a[84:87], v[36:39], v[0:15]
  ds_read_b128 v[32:35], v203 offset:6144
  v_mfma_f32_32x32x16_bf16 v[16:31], a[228:231], v[36:39], v[16:31]
  s_waitcnt lgkmcnt(2)
  v_mfma_f32_32x32x16_bf16 v[0:15], a[88:91], v[40:43], v[0:15]
  ds_read_b128 v[36:39], v204 offset:6144
  v_mfma_f32_32x32x16_bf16 v[16:31], a[232:235], v[40:43], v[16:31]
  s_waitcnt lgkmcnt(2)
  v_mfma_f32_32x32x16_bf16 v[0:15], a[92:95], v[44:47], v[0:15]
  ds_read_b128 v[40:43], v205 offset:6144
  v_mfma_f32_32x32x16_bf16 v[16:31], a[236:239], v[44:47], v[16:31]
  s_waitcnt lgkmcnt(2)
  v_mfma_f32_32x32x16_bf16 v[0:15], a[96:99], v[32:35], v[0:15]
  ds_read_b128 v[44:47], v206 offset:6144
  v_mfma_f32_32x32x16_bf16 v[16:31], a[240:243], v[32:35], v[16:31]
  s_waitcnt lgkmcnt(2)
  v_mfma_f32_32x32x16_bf16 v[0:15], a[100:103], v[36:39], v[0:15]
  ds_read_b128 v[32:35], v203 offset:7168
  v_mfma_f32_32x32x16_bf16 v[16:31], a[244:247], v[36:39], v[16:31]
  s_waitcnt lgkmcnt(2)
  v_mfma_f32_32x32x16_bf16 v[0:15], a[104:107], v[40:43], v[0:15]
  ds_read_b128 v[36:39], v204 offset:7168
  v_mfma_f32_32x32x16_bf16 v[16:31], a[248:251], v[40:43], v[16:31]
  s_waitcnt lgkmcnt(2)
  v_mfma_f32_32x32x16_bf16 v[0:15], a[108:111], v[44:47], v[0:15]
  ds_read_b128 v[40:43], v205 offset:7168
  v_mfma_f32_32x32x16_bf16 v[16:31], a[252:255], v[44:47], v[16:31]
  s_waitcnt lgkmcnt(2)
  v_mfma_f32_32x32x16_bf16 v[0:15], a[112:115], v[32:35], v[0:15]
  ds_read_b128 v[44:47], v206 offset:7168
  v_mfma_f32_32x32x16_bf16 v[16:31], v[224:227], v[32:35], v[16:31]
  s_waitcnt lgkmcnt(2)
  v_mfma_f32_32x32x16_bf16 v[0:15], a[116:119], v[36:39], v[0:15]
  ds_read_b128 v[32:35], v203 offset:8192
  v_mfma_f32_32x32x16_bf16 v[16:31], v[228:231], v[36:39], v[16:31]
  s_waitcnt lgkmcnt(2)
  v_mfma_f32_32x32x16_bf16 v[0:15], a[120:123], v[40:43], v[0:15]
  ds_read_b128 v[36:39], v204 offset:8192
  v_mfma_f32_32x32x16_bf16 v[16:31], v[232:235], v[40:43], v[16:31]
  s_waitcnt lgkmcnt(2)
  v_mfma_f32_32x32x16_bf16 v[0:15], a[124:127], v[44:47], v[0:15]
  ds_read_b128 v[40:43], v205 offset:8192
  v_mfma_f32_32x32x16_bf16 v[16:31], v[236:239], v[44:47], v[16:31]
  s_waitcnt lgkmcnt(2)
  v_mfma_f32_32x32x16_bf16 v[0:15], a[128:131], v[32:35], v[0:15]
  ds_read_b128 v[44:47], v206 offset:8192
  v_mfma_f32_32x32x16_bf16 v[16:31], v[240:243], v[32:35], v[16:31]
  s_waitcnt lgkmcnt(2)
  v_mfma_f32_32x32x16_bf16 v[0:15], a[132:135], v[36:39], v[0:15]
  v_mfma_f32_32x32x16_bf16 v[16:31], v[244:247], v[36:39], v[16:31]
  s_waitcnt lgkmcnt(1)
  v_mfma_f32_32x32x16_bf16 v[0:15], a[136:139], v[40:43], v[0:15]
  v_mfma_f32_32x32x16_bf16 v[16:31], v[248:251], v[40:43], v[16:31]
  s_waitcnt lgkmcnt(0)
  v_mfma_f32_32x32x16_bf16 v[0:15], a[140:143], v[44:47], v[0:15]
  v_mfma_f32_32x32x16_bf16 v[16:31], v[252:255], v[44:47], v[16:31]
  s_nop 3
  v_cvt_pk_bf16_f32 v48, v0, v1
  v_cvt_pk_bf16_f32 v49, v2, v3
  ds_write2_b32 v218, v48, v49 offset0:0 offset1:1
  v_cvt_pk_bf16_f32 v48, v4, v5
  v_cvt_pk_bf16_f32 v49, v6, v7
  ds_write2_b32 v218, v48, v49 offset0:4 offset1:5
  v_cvt_pk_bf16_f32 v48, v8, v9
  v_cvt_pk_bf16_f32 v49, v10, v11
  ds_write2_b32 v218, v48, v49 offset0:8 offset1:9
  v_cvt_pk_bf16_f32 v48, v12, v13
  v_cvt_pk_bf16_f32 v49, v14, v15
  ds_write2_b32 v218, v48, v49 offset0:12 offset1:13
  v_cvt_pk_bf16_f32 v48, v16, v17
  v_cvt_pk_bf16_f32 v49, v18, v19
  ds_write2_b32 v218, v48, v49 offset0:64 offset1:65
  v_cvt_pk_bf16_f32 v48, v20, v21
  v_cvt_pk_bf16_f32 v49, v22, v23
  ds_write2_b32 v218, v48, v49 offset0:68 offset1:69
  v_cvt_pk_bf16_f32 v48, v24, v25
  v_cvt_pk_bf16_f32 v49, v26, v27
  ds_write2_b32 v218, v48, v49 offset0:72 offset1:73
  v_cvt_pk_bf16_f32 v48, v28, v29
  v_cvt_pk_bf16_f32 v49, v30, v31
  ds_write2_b32 v218, v48, v49 offset0:76 offset1:77
  v_add_u32 v218, 16512, v218
  s_waitcnt vmcnt(0) lgkmcnt(0)
  s_barrier
  s_add_u32 m0, s67, 0
  s_nop 0
  buffer_load_dwordx4 v202, s[4:7], s60 offen offset:0 lds
  s_add_u32 m0, s67, 896
  s_nop 0
  buffer_load_dwordx4 v202, s[4:7], s60 offen offset:128 lds
  s_add_u32 m0, s67, 1792
  s_nop 0
  buffer_load_dwordx4 v202, s[4:7], s60 offen offset:256 lds
  s_add_u32 m0, s67, 2688
  s_nop 0
  buffer_load_dwordx4 v202, s[4:7], s60 offen offset:384 lds
  s_add_u32 m0, s67, 3584
  s_nop 0
  buffer_load_dwordx4 v202, s[4:7], s60 offen offset:512 lds
  s_add_u32 m0, s67, 4480
  s_nop 0
  buffer_load_dwordx4 v202, s[4:7], s60 offen offset:640 lds
  s_add_u32 m0, s67, 5376
  s_nop 0
  buffer_load_dwordx4 v202, s[4:7], s60 offen offset:768 lds
  s_add_u32 m0, s67, 6272
  s_nop 0
  buffer_load_dwordx4 v202, s[4:7], s60 offen offset:896 lds
  s_add_u32 m0, s67, 7168
  s_nop 0
  buffer_load_dwordx4 v202, s[4:7], s60 offen offset:1024 lds
  s_add_u32 s60, s60, 36864
  ds_read_b128 v[32:35], v203 offset:36864
  ds_read_b128 v[36:39], v204 offset:36864
  ds_read_b128 v[40:43], v205 offset:36864
  s_waitcnt lgkmcnt(2)
  v_mfma_f32_32x32x16_bf16 v[0:15], a[0:3], v[32:35], 0
  ds_read_b128 v[44:47], v206 offset:36864
  v_mfma_f32_32x32x16_bf16 v[16:31], a[144:147], v[32:35], 0
  s_waitcnt lgkmcnt(2)
  v_mfma_f32_32x32x16_bf16 v[0:15], a[4:7], v[36:39], v[0:15]
  ds_read_b128 v[32:35], v203 offset:37888
  v_mfma_f32_32x32x16_bf16 v[16:31], a[148:151], v[36:39], v[16:31]
  s_waitcnt lgkmcnt(2)
  v_mfma_f32_32x32x16_bf16 v[0:15], a[8:11], v[40:43], v[0:15]
  ds_read_b128 v[36:39], v204 offset:37888
  v_mfma_f32_32x32x16_bf16 v[16:31], a[152:155], v[40:43], v[16:31]
  s_waitcnt lgkmcnt(2)
  v_mfma_f32_32x32x16_bf16 v[0:15], a[12:15], v[44:47], v[0:15]
  ds_read_b128 v[40:43], v205 offset:37888
  v_mfma_f32_32x32x16_bf16 v[16:31], a[156:159], v[44:47], v[16:31]
  s_waitcnt lgkmcnt(2)
  v_mfma_f32_32x32x16_bf16 v[0:15], a[16:19], v[32:35], v[0:15]
  ds_read_b128 v[44:47], v206 offset:37888
  v_mfma_f32_32x32x16_bf16 v[16:31], a[160:163], v[32:35], v[16:31]
  s_waitcnt lgkmcnt(2)
  v_mfma_f32_32x32x16_bf16 v[0:15], a[20:23], v[36:39], v[0:15]
  ds_read_b128 v[32:35], v203 offset:38912
  v_mfma_f32_32x32x16_bf16 v[16:31], a[164:167], v[36:39], v[16:31]
  s_waitcnt lgkmcnt(2)
  v_mfma_f32_32x32x16_bf16 v[0:15], a[24:27], v[40:43], v[0:15]
  ds_read_b128 v[36:39], v204 offset:38912
  v_mfma_f32_32x32x16_bf16 v[16:31], a[168:171], v[40:43], v[16:31]
  s_waitcnt lgkmcnt(2)
  v_mfma_f32_32x32x16_bf16 v[0:15], a[28:31], v[44:47], v[0:15]
  ds_read_b128 v[40:43], v205 offset:38912
  v_mfma_f32_32x32x16_bf16 v[16:31], a[172:175], v[44:47], v[16:31]
  s_waitcnt lgkmcnt(2)
  v_mfma_f32_32x32x16_bf16 v[0:15], a[32:35], v[32:35], v[0:15]
  ds_read_b128 v[44:47], v206 offset:38912
  v_mfma_f32_32x32x16_bf16 v[16:31], a[176:179], v[32:35], v[16:31]
  s_waitcnt lgkmcnt(2)
  v_mfma_f32_32x32x16_bf16 v[0:15], a[36:39], v[36:39], v[0:15]
  ds_read_b128 v[32:35], v203 offset:39936
  v_mfma_f32_32x32x16_bf16 v[16:31], a[180:183], v[36:39], v[16:31]
  s_waitcnt lgkmcnt(2)
  v_mfma_f32_32x32x16_bf16 v[0:15], a[40:43], v[40:43], v[0:15]
  ds_read_b128 v[36:39], v204 offset:39936
  v_mfma_f32_32x32x16_bf16 v[16:31], a[184:187], v[40:43], v[16:31]
  s_waitcnt lgkmcnt(2)
  v_mfma_f32_32x32x16_bf16 v[0:15], a[44:47], v[44:47], v[0:15]
  ds_read_b128 v[40:43], v205 offset:39936
  v_mfma_f32_32x32x16_bf16 v[16:31], a[188:191], v[44:47], v[16:31]
  s_waitcnt lgkmcnt(2)
  v_mfma_f32_32x32x16_bf16 v[0:15], a[48:51], v[32:35], v[0:15]
  ds_read_b128 v[44:47], v206 offset:39936
  v_mfma_f32_32x32x16_bf16 v[16:31], a[192:195], v[32:35], v[16:31]
  s_waitcnt lgkmcnt(2)
  v_mfma_f32_32x32x16_bf16 v[0:15], a[52:55], v[36:39], v[0:15]
  ds_read_b128 v[32:35], v203 offset:40960
  v_mfma_f32_32x32x16_bf16 v[16:31], a[196:199], v[36:39], v[16:31]
  s_waitcnt lgkmcnt(2)
  v_mfma_f32_32x32x16_bf16 v[0:15], a[56:59], v[40:43], v[0:15]
  ds_read_b128 v[36:39], v204 offset:40960
  v_mfma_f32_32x32x16_bf16 v[16:31], a[200:203], v[40:43], v[16:31]
  s_waitcnt lgkmcnt(2)
  v_mfma_f32_32x32x16_bf16 v[0:15], a[60:63], v[44:47], v[0:15]
  ds_read_b128 v[40:43], v205 offset:40960
  v_mfma_f32_32x32x16_bf16 v[16:31], a[204:207], v[44:47], v[16:31]
  s_waitcnt lgkmcnt(2)
  v_mfma_f32_32x32x16_bf16 v[0:15], a[64:67], v[32:35], v[0:15]
  ds_read_b128 v[44:47], v206 offset:40960
  v_mfma_f32_32x32x16_bf16 v[16:31], a[208:211], v[32:35], v[16:31]
  s_waitcnt lgkmcnt(2)
  v_mfma_f32_32x32x16_bf16 v[0:15], a[68:71], v[36:39], v[0:15]
  ds_read_b128 v[32:35], v203 offset:41984
  v_mfma_f32_32x32x16_bf16 v[16:31], a[212:215], v[36:39], v[16:31]
  s_waitcnt lgkmcnt(2)
  v_mfma_f32_32x32x16_bf16 v[0:15], a[72:75], v[40:43], v[0:15]
  ds_read_b128 v[36:39], v204 offset:41984
  v_mfma_f32_32x32x16_bf16 v[16:31], a[216:219], v[40:43], v[16:31]
  s_waitcnt lgkmcnt(2)
  v_mfma_f32_32x32x16_bf16 v[0:15], a[76:79], v[44:47], v[0:15]
  ds_read_b128 v[40:43], v205 offset:41984
  v_mfma_f32_32x32x16_bf16 v[16:31], a[220:223], v[44:47], v[16:31]
  s_waitcnt lgkmcnt(2)
  v_mfma_f32_32x32x16_bf16 v[0:15], a[80:83], v[32:35], v[0:15]
  ds_read_b128 v[44:47], v206 offset:41984
  v_mfma_f32_32x32x16_bf16 v[16:31], a[224:227], v[32:35], v[16:31]
  s_waitcnt lgkmcnt(2)
  v_mfma_f32_32x32x16_bf16 v[0:15], a[84:87], v[36:39], v[0:15]
  ds_read_b128 v[32:35], v203 offset:43008
  v_mfma_f32_32x32x16_bf16 v[16:31], a[228:231], v[36:39], v[16:31]
  s_waitcnt lgkmcnt(2)
  v_mfma_f32_32x32x16_bf16 v[0:15], a[88:91], v[40:43], v[0:15]
  ds_read_b128 v[36:39], v204 offset:43008
  v_mfma_f32_32x32x16_bf16 v[16:31], a[232:235], v[40:43], v[16:31]
  s_waitcnt lgkmcnt(2)
  v_mfma_f32_32x32x16_bf16 v[0:15], a[92:95], v[44:47], v[0:15]
  ds_read_b128 v[40:43], v205 offset:43008
  v_mfma_f32_32x32x16_bf16 v[16:31], a[236:239], v[44:47], v[16:31]
  s_waitcnt lgkmcnt(2)
  v_mfma_f32_32x32x16_bf16 v[0:15], a[96:99], v[32:35], v[0:15]
  ds_read_b128 v[44:47], v206 offset:43008
  v_mfma_f32_32x32x16_bf16 v[16:31], a[240:243], v[32:35], v[16:31]
  s_waitcnt lgkmcnt(2)
  v_mfma_f32_32x32x16_bf16 v[0:15], a[100:103], v[36:39], v[0:15]
  ds_read_b128 v[32:35], v203 offset:44032
  v_mfma_f32_32x32x16_bf16 v[16:31], a[244:247], v[36:39], v[16:31]
  s_waitcnt lgkmcnt(2)
  v_mfma_f32_32x32x16_bf16 v[0:15], a[104:107], v[40:43], v[0:15]
  ds_read_b128 v[36:39], v204 offset:44032
  v_mfma_f32_32x32x16_bf16 v[16:31], a[248:251], v[40:43], v[16:31]
  s_waitcnt lgkmcnt(2)
  v_mfma_f32_32x32x16_bf16 v[0:15], a[108:111], v[44:47], v[0:15]
  ds_read_b128 v[40:43], v205 offset:44032
  v_mfma_f32_32x32x16_bf16 v[16:31], a[252:255], v[44:47], v[16:31]
  s_waitcnt lgkmcnt(2)
  v_mfma_f32_32x32x16_bf16 v[0:15], a[112:115], v[32:35], v[0:15]
  ds_read_b128 v[44:47], v206 offset:44032
  v_mfma_f32_32x32x16_bf16 v[16:31], v[224:227], v[32:35], v[16:31]
  s_waitcnt lgkmcnt(2)
  v_mfma_f32_32x32x16_bf16 v[0:15], a[116:119], v[36:39], v[0:15]
  ds_read_b128 v[32:35], v203 offset:45056
  v_mfma_f32_32x32x16_bf16 v[16:31], v[228:231], v[36:39], v[16:31]
  s_waitcnt lgkmcnt(2)
  v_mfma_f32_32x32x16_bf16 v[0:15], a[120:123], v[40:43], v[0:15]
  ds_read_b128 v[36:39], v204 offset:45056
  v_mfma_f32_32x32x16_bf16 v[16:31], v[232:235], v[40:43], v[16:31]
  s_waitcnt lgkmcnt(2)
  v_mfma_f32_32x32x16_bf16 v[0:15], a[124:127], v[44:47], v[0:15]
  ds_read_b128 v[40:43], v205 offset:45056
  v_mfma_f32_32x32x16_bf16 v[16:31], v[236:239], v[44:47], v[16:31]
  s_waitcnt lgkmcnt(2)
  v_mfma_f32_32x32x16_bf16 v[0:15], a[128:131], v[32:35], v[0:15]
  ds_read_b128 v[44:47], v206 offset:45056
  v_mfma_f32_32x32x16_bf16 v[16:31], v[240:243], v[32:35], v[16:31]
  s_waitcnt lgkmcnt(2)
  v_mfma_f32_32x32x16_bf16 v[0:15], a[132:135], v[36:39], v[0:15]
  v_mfma_f32_32x32x16_bf16 v[16:31], v[244:247], v[36:39], v[16:31]
  s_waitcnt lgkmcnt(1)
  v_mfma_f32_32x32x16_bf16 v[0:15], a[136:139], v[40:43], v[0:15]
  v_mfma_f32_32x32x16_bf16 v[16:31], v[248:251], v[40:43], v[16:31]
  s_waitcnt lgkmcnt(0)
  v_mfma_f32_32x32x16_bf16 v[0:15], a[140:143], v[44:47], v[0:15]
  v_mfma_f32_32x32x16_bf16 v[16:31], v[252:255], v[44:47], v[16:31]
  s_nop 3
  v_cvt_pk_bf16_f32 v48, v0, v1
  v_cvt_pk_bf16_f32 v49, v2, v3
  ds_write2_b32 v218, v48, v49 offset0:0 offset1:1
  v_cvt_pk_bf16_f32 v48, v4, v5
  v_cvt_pk_bf16_f32 v49, v6, v7
  ds_write2_b32 v218, v48, v49 offset0:4 offset1:5
  v_cvt_pk_bf16_f32 v48, v8, v9
  v_cvt_pk_bf16_f32 v49, v10, v11
  ds_write2_b32 v218, v48, v49 offset0:8 offset1:9
  v_cvt_pk_bf16_f32 v48, v12, v13
  v_cvt_pk_bf16_f32 v49, v14, v15
  ds_write2_b32 v218, v48, v49 offset0:12 offset1:13
  v_cvt_pk_bf16_f32 v48, v16, v17
  v_cvt_pk_bf16_f32 v49, v18, v19
  ds_write2_b32 v218, v48, v49 offset0:64 offset1:65
  v_cvt_pk_bf16_f32 v48, v20, v21
  v_cvt_pk_bf16_f32 v49, v22, v23
  ds_write2_b32 v218, v48, v49 offset0:68 offset1:69
  v_cvt_pk_bf16_f32 v48, v24, v25
  v_cvt_pk_bf16_f32 v49, v26, v27
  ds_write2_b32 v218, v48, v49 offset0:72 offset1:73
  v_cvt_pk_bf16_f32 v48, v28, v29
  v_cvt_pk_bf16_f32 v49, v30, v31
  ds_write2_b32 v218, v48, v49 offset0:76 offset1:77
  v_add_u32 v218, 16512, v218
  s_waitcnt vmcnt(0) lgkmcnt(0)
  s_barrier
  s_add_u32 m0, s67, 36864
  s_nop 0
  buffer_load_dwordx4 v202, s[4:7], s60 offen offset:0 lds
  s_add_u32 m0, s67, 37760
  s_nop 0
  buffer_load_dwordx4 v202, s[4:7], s60 offen offset:128 lds
  s_add_u32 m0, s67, 38656
  s_nop 0
  buffer_load_dwordx4 v202, s[4:7], s60 offen offset:256 lds
  s_add_u32 m0, s67, 39552
  s_nop 0
  buffer_load_dwordx4 v202, s[4:7], s60 offen offset:384 lds
  s_add_u32 m0, s67, 40448
  s_nop 0
  buffer_load_dwordx4 v202, s[4:7], s60 offen offset:512 lds
  s_add_u32 m0, s67, 41344
  s_nop 0
  buffer_load_dwordx4 v202, s[4:7], s60 offen offset:640 lds
  s_add_u32 m0, s67, 42240
  s_nop 0
  buffer_load_dwordx4 v202, s[4:7], s60 offen offset:768 lds
  s_add_u32 m0, s67, 43136
  s_nop 0
  buffer_load_dwordx4 v202, s[4:7], s60 offen offset:896 lds
  s_add_u32 m0, s67, 44032
  s_nop 0
  buffer_load_dwordx4 v202, s[4:7], s60 offen offset:1024 lds
  s_add_u32 s60, s60, 36864
  ds_read_b128 v[32:35], v203 offset:0
  ds_read_b128 v[36:39], v204 offset:0
  ds_read_b128 v[40:43], v205 offset:0
  s_waitcnt lgkmcnt(2)
  v_mfma_f32_32x32x16_bf16 v[0:15], a[0:3], v[32:35], 0
  ds_read_b128 v[44:47], v206 offset:0
  v_mfma_f32_32x32x16_bf16 v[16:31], a[144:147], v[32:35], 0
  s_waitcnt lgkmcnt(2)
  v_mfma_f32_32x32x16_bf16 v[0:15], a[4:7], v[36:39], v[0:15]
  ds_read_b128 v[32:35], v203 offset:1024
  v_mfma_f32_32x32x16_bf16 v[16:31], a[148:151], v[36:39], v[16:31]
  s_waitcnt lgkmcnt(2)
  v_mfma_f32_32x32x16_bf16 v[0:15], a[8:11], v[40:43], v[0:15]
  ds_read_b128 v[36:39], v204 offset:1024
  v_mfma_f32_32x32x16_bf16 v[16:31], a[152:155], v[40:43], v[16:31]
  s_waitcnt lgkmcnt(2)
  v_mfma_f32_32x32x16_bf16 v[0:15], a[12:15], v[44:47], v[0:15]
  ds_read_b128 v[40:43], v205 offset:1024
  v_mfma_f32_32x32x16_bf16 v[16:31], a[156:159], v[44:47], v[16:31]
  s_waitcnt lgkmcnt(2)
  v_mfma_f32_32x32x16_bf16 v[0:15], a[16:19], v[32:35], v[0:15]
  ds_read_b128 v[44:47], v206 offset:1024
  v_mfma_f32_32x32x16_bf16 v[16:31], a[160:163], v[32:35], v[16:31]
  s_waitcnt lgkmcnt(2)
  v_mfma_f32_32x32x16_bf16 v[0:15], a[20:23], v[36:39], v[0:15]
  ds_read_b128 v[32:35], v203 offset:2048
  v_mfma_f32_32x32x16_bf16 v[16:31], a[164:167], v[36:39], v[16:31]
  s_waitcnt lgkmcnt(2)
  v_mfma_f32_32x32x16_bf16 v[0:15], a[24:27], v[40:43], v[0:15]
  ds_read_b128 v[36:39], v204 offset:2048
  v_mfma_f32_32x32x16_bf16 v[16:31], a[168:171], v[40:43], v[16:31]
  s_waitcnt lgkmcnt(2)
  v_mfma_f32_32x32x16_bf16 v[0:15], a[28:31], v[44:47], v[0:15]
  ds_read_b128 v[40:43], v205 offset:2048
  v_mfma_f32_32x32x16_bf16 v[16:31], a[172:175], v[44:47], v[16:31]
  s_waitcnt lgkmcnt(2)
  v_mfma_f32_32x32x16_bf16 v[0:15], a[32:35], v[32:35], v[0:15]
  ds_read_b128 v[44:47], v206 offset:2048
  v_mfma_f32_32x32x16_bf16 v[16:31], a[176:179], v[32:35], v[16:31]
  s_waitcnt lgkmcnt(2)
  v_mfma_f32_32x32x16_bf16 v[0:15], a[36:39], v[36:39], v[0:15]
  ds_read_b128 v[32:35], v203 offset:3072
  v_mfma_f32_32x32x16_bf16 v[16:31], a[180:183], v[36:39], v[16:31]
  s_waitcnt lgkmcnt(2)
  v_mfma_f32_32x32x16_bf16 v[0:15], a[40:43], v[40:43], v[0:15]
  ds_read_b128 v[36:39], v204 offset:3072
  v_mfma_f32_32x32x16_bf16 v[16:31], a[184:187], v[40:43], v[16:31]
  s_waitcnt lgkmcnt(2)
  v_mfma_f32_32x32x16_bf16 v[0:15], a[44:47], v[44:47], v[0:15]
  ds_read_b128 v[40:43], v205 offset:3072
  v_mfma_f32_32x32x16_bf16 v[16:31], a[188:191], v[44:47], v[16:31]
  s_waitcnt lgkmcnt(2)
  v_mfma_f32_32x32x16_bf16 v[0:15], a[48:51], v[32:35], v[0:15]
  ds_read_b128 v[44:47], v206 offset:3072
  v_mfma_f32_32x32x16_bf16 v[16:31], a[192:195], v[32:35], v[16:31]
  s_waitcnt lgkmcnt(2)
  v_mfma_f32_32x32x16_bf16 v[0:15], a[52:55], v[36:39], v[0:15]
  ds_read_b128 v[32:35], v203 offset:4096
  v_mfma_f32_32x32x16_bf16 v[16:31], a[196:199], v[36:39], v[16:31]
  s_waitcnt lgkmcnt(2)
  v_mfma_f32_32x32x16_bf16 v[0:15], a[56:59], v[40:43], v[0:15]
  ds_read_b128 v[36:39], v204 offset:4096
  v_mfma_f32_32x32x16_bf16 v[16:31], a[200:203], v[40:43], v[16:31]
  s_waitcnt lgkmcnt(2)
  v_mfma_f32_32x32x16_bf16 v[0:15], a[60:63], v[44:47], v[0:15]
  ds_read_b128 v[40:43], v205 offset:4096
  v_mfma_f32_32x32x16_bf16 v[16:31], a[204:207], v[44:47], v[16:31]
  s_waitcnt lgkmcnt(2)
  v_mfma_f32_32x32x16_bf16 v[0:15], a[64:67], v[32:35], v[0:15]
  ds_read_b128 v[44:47], v206 offset:4096
  v_mfma_f32_32x32x16_bf16 v[16:31], a[208:211], v[32:35], v[16:31]
  s_waitcnt lgkmcnt(2)
  v_mfma_f32_32x32x16_bf16 v[0:15], a[68:71], v[36:39], v[0:15]
  ds_read_b128 v[32:35], v203 offset:5120
  v_mfma_f32_32x32x16_bf16 v[16:31], a[212:215], v[36:39], v[16:31]
  s_waitcnt lgkmcnt(2)
  v_mfma_f32_32x32x16_bf16 v[0:15], a[72:75], v[40:43], v[0:15]
  ds_read_b128 v[36:39], v204 offset:5120
  v_mfma_f32_32x32x16_bf16 v[16:31], a[216:219], v[40:43], v[16:31]
  s_waitcnt lgkmcnt(2)
  v_mfma_f32_32x32x16_bf16 v[0:15], a[76:79], v[44:47], v[0:15]
  ds_read_b128 v[40:43], v205 offset:5120
  v_mfma_f32_32x32x16_bf16 v[16:31], a[220:223], v[44:47], v[16:31]
  s_waitcnt lgkmcnt(2)
  v_mfma_f32_32x32x16_bf16 v[0:15], a[80:83], v[32:35], v[0:15]
  ds_read_b128 v[44:47], v206 offset:5120
  v_mfma_f32_32x32x16_bf16 v[16:31], a[224:227], v[32:35], v[16:31]
  s_waitcnt lgkmcnt(2)
  v_mfma_f32_32x32x16_bf16 v[0:15], a[84:87], v[36:39], v[0:15]
  ds_read_b128 v[32:35], v203 offset:6144
  v_mfma_f32_32x32x16_bf16 v[16:31], a[228:231], v[36:39], v[16:31]
  s_waitcnt lgkmcnt(2)
  v_mfma_f32_32x32x16_bf16 v[0:15], a[88:91], v[40:43], v[0:15]
  ds_read_b128 v[36:39], v204 offset:6144
  v_mfma_f32_32x32x16_bf16 v[16:31], a[232:235], v[40:43], v[16:31]
  s_waitcnt lgkmcnt(2)
  v_mfma_f32_32x32x16_bf16 v[0:15], a[92:95], v[44:47], v[0:15]
  ds_read_b128 v[40:43], v205 offset:6144
  v_mfma_f32_32x32x16_bf16 v[16:31], a[236:239], v[44:47], v[16:31]
  s_waitcnt lgkmcnt(2)
  v_mfma_f32_32x32x16_bf16 v[0:15], a[96:99], v[32:35], v[0:15]
  ds_read_b128 v[44:47], v206 offset:6144
  v_mfma_f32_32x32x16_bf16 v[16:31], a[240:243], v[32:35], v[16:31]
  s_waitcnt lgkmcnt(2)
  v_mfma_f32_32x32x16_bf16 v[0:15], a[100:103], v[36:39], v[0:15]
  ds_read_b128 v[32:35], v203 offset:7168
  v_mfma_f32_32x32x16_bf16 v[16:31], a[244:247], v[36:39], v[16:31]
  s_waitcnt lgkmcnt(2)
  v_mfma_f32_32x32x16_bf16 v[0:15], a[104:107], v[40:43], v[0:15]
  ds_read_b128 v[36:39], v204 offset:7168
  v_mfma_f32_32x32x16_bf16 v[16:31], a[248:251], v[40:43], v[16:31]
  s_waitcnt lgkmcnt(2)
  v_mfma_f32_32x32x16_bf16 v[0:15], a[108:111], v[44:47], v[0:15]
  ds_read_b128 v[40:43], v205 offset:7168
  v_mfma_f32_32x32x16_bf16 v[16:31], a[252:255], v[44:47], v[16:31]
  s_waitcnt lgkmcnt(2)
  v_mfma_f32_32x32x16_bf16 v[0:15], a[112:115], v[32:35], v[0:15]
  ds_read_b128 v[44:47], v206 offset:7168
  v_mfma_f32_32x32x16_bf16 v[16:31], v[224:227], v[32:35], v[16:31]
  s_waitcnt lgkmcnt(2)
  v_mfma_f32_32x32x16_bf16 v[0:15], a[116:119], v[36:39], v[0:15]
  ds_read_b128 v[32:35], v203 offset:8192
  v_mfma_f32_32x32x16_bf16 v[16:31], v[228:231], v[36:39], v[16:31]
  s_waitcnt lgkmcnt(2)
  v_mfma_f32_32x32x16_bf16 v[0:15], a[120:123], v[40:43], v[0:15]
  ds_read_b128 v[36:39], v204 offset:8192
  v_mfma_f32_32x32x16_bf16 v[16:31], v[232:235], v[40:43], v[16:31]
  s_waitcnt lgkmcnt(2)
  v_mfma_f32_32x32x16_bf16 v[0:15], a[124:127], v[44:47], v[0:15]
  ds_read_b128 v[40:43], v205 offset:8192
  v_mfma_f32_32x32x16_bf16 v[16:31], v[236:239], v[44:47], v[16:31]
  s_waitcnt lgkmcnt(2)
  v_mfma_f32_32x32x16_bf16 v[0:15], a[128:131], v[32:35], v[0:15]
  ds_read_b128 v[44:47], v206 offset:8192
  v_mfma_f32_32x32x16_bf16 v[16:31], v[240:243], v[32:35], v[16:31]
  s_waitcnt lgkmcnt(2)
  v_mfma_f32_32x32x16_bf16 v[0:15], a[132:135], v[36:39], v[0:15]
  v_mfma_f32_32x32x16_bf16 v[16:31], v[244:247], v[36:39], v[16:31]
  s_waitcnt lgkmcnt(1)
  v_mfma_f32_32x32x16_bf16 v[0:15], a[136:139], v[40:43], v[0:15]
  v_mfma_f32_32x32x16_bf16 v[16:31], v[248:251], v[40:43], v[16:31]
  s_waitcnt lgkmcnt(0)
  v_mfma_f32_32x32x16_bf16 v[0:15], a[140:143], v[44:47], v[0:15]
  v_mfma_f32_32x32x16_bf16 v[16:31], v[252:255], v[44:47], v[16:31]
  s_nop 3
  v_cvt_pk_bf16_f32 v48, v0, v1
  v_cvt_pk_bf16_f32 v49, v2, v3
  ds_write2_b32 v218, v48, v49 offset0:0 offset1:1
  v_cvt_pk_bf16_f32 v48, v4, v5
  v_cvt_pk_bf16_f32 v49, v6, v7
  ds_write2_b32 v218, v48, v49 offset0:4 offset1:5
  v_cvt_pk_bf16_f32 v48, v8, v9
  v_cvt_pk_bf16_f32 v49, v10, v11
  ds_write2_b32 v218, v48, v49 offset0:8 offset1:9
  v_cvt_pk_bf16_f32 v48, v12, v13
  v_cvt_pk_bf16_f32 v49, v14, v15
  ds_write2_b32 v218, v48, v49 offset0:12 offset1:13
  v_cvt_pk_bf16_f32 v48, v16, v17
  v_cvt_pk_bf16_f32 v49, v18, v19
  ds_write2_b32 v218, v48, v49 offset0:64 offset1:65
  v_cvt_pk_bf16_f32 v48, v20, v21
  v_cvt_pk_bf16_f32 v49, v22, v23
  ds_write2_b32 v218, v48, v49 offset0:68 offset1:69
  v_cvt_pk_bf16_f32 v48, v24, v25
  v_cvt_pk_bf16_f32 v49, v26, v27
  ds_write2_b32 v218, v48, v49 offset0:72 offset1:73
  v_cvt_pk_bf16_f32 v48, v28, v29
  v_cvt_pk_bf16_f32 v49, v30, v31
  ds_write2_b32 v218, v48, v49 offset0:76 offset1:77
  v_add_u32 v218, 16512, v218
  s_waitcnt vmcnt(0) lgkmcnt(0)
  s_barrier
  s_add_u32 m0, s67, 0
  s_nop 0
  buffer_load_dwordx4 v202, s[4:7], s60 offen offset:0 lds
  s_add_u32 m0, s67, 896
  s_nop 0
  buffer_load_dwordx4 v202, s[4:7], s60 offen offset:128 lds
  s_add_u32 m0, s67, 1792
  s_nop 0
  buffer_load_dwordx4 v202, s[4:7], s60 offen offset:256 lds
  s_add_u32 m0, s67, 2688
  s_nop 0
  buffer_load_dwordx4 v202, s[4:7], s60 offen offset:384 lds
  s_add_u32 m0, s67, 3584
  s_nop 0
  buffer_load_dwordx4 v202, s[4:7], s60 offen offset:512 lds
  s_add_u32 m0, s67, 4480
  s_nop 0
  buffer_load_dwordx4 v202, s[4:7], s60 offen offset:640 lds
  s_add_u32 m0, s67, 5376
  s_nop 0
  buffer_load_dwordx4 v202, s[4:7], s60 offen offset:768 lds
  s_add_u32 m0, s67, 6272
  s_nop 0
  buffer_load_dwordx4 v202, s[4:7], s60 offen offset:896 lds
  s_add_u32 m0, s67, 7168
  s_nop 0
  buffer_load_dwordx4 v202, s[4:7], s60 offen offset:1024 lds
  s_add_u32 s60, s60, 36864
  ds_read_b128 v[32:35], v203 offset:36864
  ds_read_b128 v[36:39], v204 offset:36864
  ds_read_b128 v[40:43], v205 offset:36864
  s_waitcnt lgkmcnt(2)
  v_mfma_f32_32x32x16_bf16 v[0:15], a[0:3], v[32:35], 0
  ds_read_b128 v[44:47], v206 offset:36864
  v_mfma_f32_32x32x16_bf16 v[16:31], a[144:147], v[32:35], 0
  s_waitcnt lgkmcnt(2)
  v_mfma_f32_32x32x16_bf16 v[0:15], a[4:7], v[36:39], v[0:15]
  ds_read_b128 v[32:35], v203 offset:37888
  v_mfma_f32_32x32x16_bf16 v[16:31], a[148:151], v[36:39], v[16:31]
  s_waitcnt lgkmcnt(2)
  v_mfma_f32_32x32x16_bf16 v[0:15], a[8:11], v[40:43], v[0:15]
  ds_read_b128 v[36:39], v204 offset:37888
  v_mfma_f32_32x32x16_bf16 v[16:31], a[152:155], v[40:43], v[16:31]
  s_waitcnt lgkmcnt(2)
  v_mfma_f32_32x32x16_bf16 v[0:15], a[12:15], v[44:47], v[0:15]
  ds_read_b128 v[40:43], v205 offset:37888
  v_mfma_f32_32x32x16_bf16 v[16:31], a[156:159], v[44:47], v[16:31]
  s_waitcnt lgkmcnt(2)
  v_mfma_f32_32x32x16_bf16 v[0:15], a[16:19], v[32:35], v[0:15]
  ds_read_b128 v[44:47], v206 offset:37888
  v_mfma_f32_32x32x16_bf16 v[16:31], a[160:163], v[32:35], v[16:31]
  s_waitcnt lgkmcnt(2)
  v_mfma_f32_32x32x16_bf16 v[0:15], a[20:23], v[36:39], v[0:15]
  ds_read_b128 v[32:35], v203 offset:38912
  v_mfma_f32_32x32x16_bf16 v[16:31], a[164:167], v[36:39], v[16:31]
  s_waitcnt lgkmcnt(2)
  v_mfma_f32_32x32x16_bf16 v[0:15], a[24:27], v[40:43], v[0:15]
  ds_read_b128 v[36:39], v204 offset:38912
  v_mfma_f32_32x32x16_bf16 v[16:31], a[168:171], v[40:43], v[16:31]
  s_waitcnt lgkmcnt(2)
  v_mfma_f32_32x32x16_bf16 v[0:15], a[28:31], v[44:47], v[0:15]
  ds_read_b128 v[40:43], v205 offset:38912
  v_mfma_f32_32x32x16_bf16 v[16:31], a[172:175], v[44:47], v[16:31]
  s_waitcnt lgkmcnt(2)
  v_mfma_f32_32x32x16_bf16 v[0:15], a[32:35], v[32:35], v[0:15]
  ds_read_b128 v[44:47], v206 offset:38912
  v_mfma_f32_32x32x16_bf16 v[16:31], a[176:179], v[32:35], v[16:31]
  s_waitcnt lgkmcnt(2)
  v_mfma_f32_32x32x16_bf16 v[0:15], a[36:39], v[36:39], v[0:15]
  ds_read_b128 v[32:35], v203 offset:39936
  v_mfma_f32_32x32x16_bf16 v[16:31], a[180:183], v[36:39], v[16:31]
  s_waitcnt lgkmcnt(2)
  v_mfma_f32_32x32x16_bf16 v[0:15], a[40:43], v[40:43], v[0:15]
  ds_read_b128 v[36:39], v204 offset:39936
  v_mfma_f32_32x32x16_bf16 v[16:31], a[184:187], v[40:43], v[16:31]
  s_waitcnt lgkmcnt(2)
  v_mfma_f32_32x32x16_bf16 v[0:15], a[44:47], v[44:47], v[0:15]
  ds_read_b128 v[40:43], v205 offset:39936
  v_mfma_f32_32x32x16_bf16 v[16:31], a[188:191], v[44:47], v[16:31]
  s_waitcnt lgkmcnt(2)
  v_mfma_f32_32x32x16_bf16 v[0:15], a[48:51], v[32:35], v[0:15]
  ds_read_b128 v[44:47], v206 offset:39936
  v_mfma_f32_32x32x16_bf16 v[16:31], a[192:195], v[32:35], v[16:31]
  s_waitcnt lgkmcnt(2)
  v_mfma_f32_32x32x16_bf16 v[0:15], a[52:55], v[36:39], v[0:15]
  ds_read_b128 v[32:35], v203 offset:40960
  v_mfma_f32_32x32x16_bf16 v[16:31], a[196:199], v[36:39], v[16:31]
  s_waitcnt lgkmcnt(2)
  v_mfma_f32_32x32x16_bf16 v[0:15], a[56:59], v[40:43], v[0:15]
  ds_read_b128 v[36:39], v204 offset:40960
  v_mfma_f32_32x32x16_bf16 v[16:31], a[200:203], v[40:43], v[16:31]
  s_waitcnt lgkmcnt(2)
  v_mfma_f32_32x32x16_bf16 v[0:15], a[60:63], v[44:47], v[0:15]
  ds_read_b128 v[40:43], v205 offset:40960
  v_mfma_f32_32x32x16_bf16 v[16:31], a[204:207], v[44:47], v[16:31]
  s_waitcnt lgkmcnt(2)
  v_mfma_f32_32x32x16_bf16 v[0:15], a[64:67], v[32:35], v[0:15]
  ds_read_b128 v[44:47], v206 offset:40960
  v_mfma_f32_32x32x16_bf16 v[16:31], a[208:211], v[32:35], v[16:31]
  s_waitcnt lgkmcnt(2)
  v_mfma_f32_32x32x16_bf16 v[0:15], a[68:71], v[36:39], v[0:15]
  ds_read_b128 v[32:35], v203 offset:41984
  v_mfma_f32_32x32x16_bf16 v[16:31], a[212:215], v[36:39], v[16:31]
  s_waitcnt lgkmcnt(2)
  v_mfma_f32_32x32x16_bf16 v[0:15], a[72:75], v[40:43], v[0:15]
  ds_read_b128 v[36:39], v204 offset:41984
  v_mfma_f32_32x32x16_bf16 v[16:31], a[216:219], v[40:43], v[16:31]
  s_waitcnt lgkmcnt(2)
  v_mfma_f32_32x32x16_bf16 v[0:15], a[76:79], v[44:47], v[0:15]
  ds_read_b128 v[40:43], v205 offset:41984
  v_mfma_f32_32x32x16_bf16 v[16:31], a[220:223], v[44:47], v[16:31]
  s_waitcnt lgkmcnt(2)
  v_mfma_f32_32x32x16_bf16 v[0:15], a[80:83], v[32:35], v[0:15]
  ds_read_b128 v[44:47], v206 offset:41984
  v_mfma_f32_32x32x16_bf16 v[16:31], a[224:227], v[32:35], v[16:31]
  s_waitcnt lgkmcnt(2)
  v_mfma_f32_32x32x16_bf16 v[0:15], a[84:87], v[36:39], v[0:15]
  ds_read_b128 v[32:35], v203 offset:43008
  v_mfma_f32_32x32x16_bf16 v[16:31], a[228:231], v[36:39], v[16:31]
  s_waitcnt lgkmcnt(2)
  v_mfma_f32_32x32x16_bf16 v[0:15], a[88:91], v[40:43], v[0:15]
  ds_read_b128 v[36:39], v204 offset:43008
  v_mfma_f32_32x32x16_bf16 v[16:31], a[232:235], v[40:43], v[16:31]
  s_waitcnt lgkmcnt(2)
  v_mfma_f32_32x32x16_bf16 v[0:15], a[92:95], v[44:47], v[0:15]
  ds_read_b128 v[40:43], v205 offset:43008
  v_mfma_f32_32x32x16_bf16 v[16:31], a[236:239], v[44:47], v[16:31]
  s_waitcnt lgkmcnt(2)
  v_mfma_f32_32x32x16_bf16 v[0:15], a[96:99], v[32:35], v[0:15]
  ds_read_b128 v[44:47], v206 offset:43008
  v_mfma_f32_32x32x16_bf16 v[16:31], a[240:243], v[32:35], v[16:31]
  s_waitcnt lgkmcnt(2)
  v_mfma_f32_32x32x16_bf16 v[0:15], a[100:103], v[36:39], v[0:15]
  ds_read_b128 v[32:35], v203 offset:44032
  v_mfma_f32_32x32x16_bf16 v[16:31], a[244:247], v[36:39], v[16:31]
  s_waitcnt lgkmcnt(2)
  v_mfma_f32_32x32x16_bf16 v[0:15], a[104:107], v[40:43], v[0:15]
  ds_read_b128 v[36:39], v204 offset:44032
  v_mfma_f32_32x32x16_bf16 v[16:31], a[248:251], v[40:43], v[16:31]
  s_waitcnt lgkmcnt(2)
  v_mfma_f32_32x32x16_bf16 v[0:15], a[108:111], v[44:47], v[0:15]
  ds_read_b128 v[40:43], v205 offset:44032
  v_mfma_f32_32x32x16_bf16 v[16:31], a[252:255], v[44:47], v[16:31]
  s_waitcnt lgkmcnt(2)
  v_mfma_f32_32x32x16_bf16 v[0:15], a[112:115], v[32:35], v[0:15]
  ds_read_b128 v[44:47], v206 offset:44032
  v_mfma_f32_32x32x16_bf16 v[16:31], v[224:227], v[32:35], v[16:31]
  s_waitcnt lgkmcnt(2)
  v_mfma_f32_32x32x16_bf16 v[0:15], a[116:119], v[36:39], v[0:15]
  ds_read_b128 v[32:35], v203 offset:45056
  v_mfma_f32_32x32x16_bf16 v[16:31], v[228:231], v[36:39], v[16:31]
  s_waitcnt lgkmcnt(2)
  v_mfma_f32_32x32x16_bf16 v[0:15], a[120:123], v[40:43], v[0:15]
  ds_read_b128 v[36:39], v204 offset:45056
  v_mfma_f32_32x32x16_bf16 v[16:31], v[232:235], v[40:43], v[16:31]
  s_waitcnt lgkmcnt(2)
  v_mfma_f32_32x32x16_bf16 v[0:15], a[124:127], v[44:47], v[0:15]
  ds_read_b128 v[40:43], v205 offset:45056
  v_mfma_f32_32x32x16_bf16 v[16:31], v[236:239], v[44:47], v[16:31]
  s_waitcnt lgkmcnt(2)
  v_mfma_f32_32x32x16_bf16 v[0:15], a[128:131], v[32:35], v[0:15]
  ds_read_b128 v[44:47], v206 offset:45056
  v_mfma_f32_32x32x16_bf16 v[16:31], v[240:243], v[32:35], v[16:31]
  s_waitcnt lgkmcnt(2)
  v_mfma_f32_32x32x16_bf16 v[0:15], a[132:135], v[36:39], v[0:15]
  v_mfma_f32_32x32x16_bf16 v[16:31], v[244:247], v[36:39], v[16:31]
  s_waitcnt lgkmcnt(1)
  v_mfma_f32_32x32x16_bf16 v[0:15], a[136:139], v[40:43], v[0:15]
  v_mfma_f32_32x32x16_bf16 v[16:31], v[248:251], v[40:43], v[16:31]
  s_waitcnt lgkmcnt(0)
  v_mfma_f32_32x32x16_bf16 v[0:15], a[140:143], v[44:47], v[0:15]
  v_mfma_f32_32x32x16_bf16 v[16:31], v[252:255], v[44:47], v[16:31]
  s_nop 3
  v_cvt_pk_bf16_f32 v48, v0, v1
  v_cvt_pk_bf16_f32 v49, v2, v3
  ds_write2_b32 v218, v48, v49 offset0:0 offset1:1
  v_cvt_pk_bf16_f32 v48, v4, v5
  v_cvt_pk_bf16_f32 v49, v6, v7
  ds_write2_b32 v218, v48, v49 offset0:4 offset1:5
  v_cvt_pk_bf16_f32 v48, v8, v9
  v_cvt_pk_bf16_f32 v49, v10, v11
  ds_write2_b32 v218, v48, v49 offset0:8 offset1:9
  v_cvt_pk_bf16_f32 v48, v12, v13
  v_cvt_pk_bf16_f32 v49, v14, v15
  ds_write2_b32 v218, v48, v49 offset0:12 offset1:13
  v_cvt_pk_bf16_f32 v48, v16, v17
  v_cvt_pk_bf16_f32 v49, v18, v19
  ds_write2_b32 v218, v48, v49 offset0:64 offset1:65
  v_cvt_pk_bf16_f32 v48, v20, v21
  v_cvt_pk_bf16_f32 v49, v22, v23
  ds_write2_b32 v218, v48, v49 offset0:68 offset1:69
  v_cvt_pk_bf16_f32 v48, v24, v25
  v_cvt_pk_bf16_f32 v49, v26, v27
  ds_write2_b32 v218, v48, v49 offset0:72 offset1:73
  v_cvt_pk_bf16_f32 v48, v28, v29
  v_cvt_pk_bf16_f32 v49, v30, v31
  ds_write2_b32 v218, v48, v49 offset0:76 offset1:77
  v_add_u32 v218, 16512, v218
  s_waitcnt vmcnt(0) lgkmcnt(0)
  s_barrier
  ds_read_b128 v[32:35], v203 offset:0
  ds_read_b128 v[36:39], v204 offset:0
  ds_read_b128 v[40:43], v205 offset:0
  s_waitcnt lgkmcnt(2)
  v_mfma_f32_32x32x16_bf16 v[0:15], a[0:3], v[32:35], 0
  ds_read_b128 v[44:47], v206 offset:0
  v_mfma_f32_32x32x16_bf16 v[16:31], a[144:147], v[32:35], 0
  s_waitcnt lgkmcnt(2)
  v_mfma_f32_32x32x16_bf16 v[0:15], a[4:7], v[36:39], v[0:15]
  ds_read_b128 v[32:35], v203 offset:1024
  v_mfma_f32_32x32x16_bf16 v[16:31], a[148:151], v[36:39], v[16:31]
  s_waitcnt lgkmcnt(2)
  v_mfma_f32_32x32x16_bf16 v[0:15], a[8:11], v[40:43], v[0:15]
  ds_read_b128 v[36:39], v204 offset:1024
  v_mfma_f32_32x32x16_bf16 v[16:31], a[152:155], v[40:43], v[16:31]
  s_waitcnt lgkmcnt(2)
  v_mfma_f32_32x32x16_bf16 v[0:15], a[12:15], v[44:47], v[0:15]
  ds_read_b128 v[40:43], v205 offset:1024
  v_mfma_f32_32x32x16_bf16 v[16:31], a[156:159], v[44:47], v[16:31]
  s_waitcnt lgkmcnt(2)
  v_mfma_f32_32x32x16_bf16 v[0:15], a[16:19], v[32:35], v[0:15]
  ds_read_b128 v[44:47], v206 offset:1024
  v_mfma_f32_32x32x16_bf16 v[16:31], a[160:163], v[32:35], v[16:31]
  s_waitcnt lgkmcnt(2)
  v_mfma_f32_32x32x16_bf16 v[0:15], a[20:23], v[36:39], v[0:15]
  ds_read_b128 v[32:35], v203 offset:2048
  v_mfma_f32_32x32x16_bf16 v[16:31], a[164:167], v[36:39], v[16:31]
  s_waitcnt lgkmcnt(2)
  v_mfma_f32_32x32x16_bf16 v[0:15], a[24:27], v[40:43], v[0:15]
  ds_read_b128 v[36:39], v204 offset:2048
  v_mfma_f32_32x32x16_bf16 v[16:31], a[168:171], v[40:43], v[16:31]
  s_waitcnt lgkmcnt(2)
  v_mfma_f32_32x32x16_bf16 v[0:15], a[28:31], v[44:47], v[0:15]
  ds_read_b128 v[40:43], v205 offset:2048
  v_mfma_f32_32x32x16_bf16 v[16:31], a[172:175], v[44:47], v[16:31]
  s_waitcnt lgkmcnt(2)
  v_mfma_f32_32x32x16_bf16 v[0:15], a[32:35], v[32:35], v[0:15]
  ds_read_b128 v[44:47], v206 offset:2048
  v_mfma_f32_32x32x16_bf16 v[16:31], a[176:179], v[32:35], v[16:31]
  s_waitcnt lgkmcnt(2)
  v_mfma_f32_32x32x16_bf16 v[0:15], a[36:39], v[36:39], v[0:15]
  ds_read_b128 v[32:35], v203 offset:3072
  v_mfma_f32_32x32x16_bf16 v[16:31], a[180:183], v[36:39], v[16:31]
  s_waitcnt lgkmcnt(2)
  v_mfma_f32_32x32x16_bf16 v[0:15], a[40:43], v[40:43], v[0:15]
  ds_read_b128 v[36:39], v204 offset:3072
  v_mfma_f32_32x32x16_bf16 v[16:31], a[184:187], v[40:43], v[16:31]
  s_waitcnt lgkmcnt(2)
  v_mfma_f32_32x32x16_bf16 v[0:15], a[44:47], v[44:47], v[0:15]
  ds_read_b128 v[40:43], v205 offset:3072
  v_mfma_f32_32x32x16_bf16 v[16:31], a[188:191], v[44:47], v[16:31]
  s_waitcnt lgkmcnt(2)
  v_mfma_f32_32x32x16_bf16 v[0:15], a[48:51], v[32:35], v[0:15]
  ds_read_b128 v[44:47], v206 offset:3072
  v_mfma_f32_32x32x16_bf16 v[16:31], a[192:195], v[32:35], v[16:31]
  s_waitcnt lgkmcnt(2)
  v_mfma_f32_32x32x16_bf16 v[0:15], a[52:55], v[36:39], v[0:15]
  ds_read_b128 v[32:35], v203 offset:4096
  v_mfma_f32_32x32x16_bf16 v[16:31], a[196:199], v[36:39], v[16:31]
  s_waitcnt lgkmcnt(2)
  v_mfma_f32_32x32x16_bf16 v[0:15], a[56:59], v[40:43], v[0:15]
  ds_read_b128 v[36:39], v204 offset:4096
  v_mfma_f32_32x32x16_bf16 v[16:31], a[200:203], v[40:43], v[16:31]
  s_waitcnt lgkmcnt(2)
  v_mfma_f32_32x32x16_bf16 v[0:15], a[60:63], v[44:47], v[0:15]
  ds_read_b128 v[40:43], v205 offset:4096
  v_mfma_f32_32x32x16_bf16 v[16:31], a[204:207], v[44:47], v[16:31]
  s_waitcnt lgkmcnt(2)
  v_mfma_f32_32x32x16_bf16 v[0:15], a[64:67], v[32:35], v[0:15]
  ds_read_b128 v[44:47], v206 offset:4096
  v_mfma_f32_32x32x16_bf16 v[16:31], a[208:211], v[32:35], v[16:31]
  s_waitcnt lgkmcnt(2)
  v_mfma_f32_32x32x16_bf16 v[0:15], a[68:71], v[36:39], v[0:15]
  ds_read_b128 v[32:35], v203 offset:5120
  v_mfma_f32_32x32x16_bf16 v[16:31], a[212:215], v[36:39], v[16:31]
  s_waitcnt lgkmcnt(2)
  v_mfma_f32_32x32x16_bf16 v[0:15], a[72:75], v[40:43], v[0:15]
  ds_read_b128 v[36:39], v204 offset:5120
  v_mfma_f32_32x32x16_bf16 v[16:31], a[216:219], v[40:43], v[16:31]
  s_waitcnt lgkmcnt(2)
  v_mfma_f32_32x32x16_bf16 v[0:15], a[76:79], v[44:47], v[0:15]
  ds_read_b128 v[40:43], v205 offset:5120
  v_mfma_f32_32x32x16_bf16 v[16:31], a[220:223], v[44:47], v[16:31]
  s_waitcnt lgkmcnt(2)
  v_mfma_f32_32x32x16_bf16 v[0:15], a[80:83], v[32:35], v[0:15]
  ds_read_b128 v[44:47], v206 offset:5120
  v_mfma_f32_32x32x16_bf16 v[16:31], a[224:227], v[32:35], v[16:31]
  s_waitcnt lgkmcnt(2)
  v_mfma_f32_32x32x16_bf16 v[0:15], a[84:87], v[36:39], v[0:15]
  ds_read_b128 v[32:35], v203 offset:6144
  v_mfma_f32_32x32x16_bf16 v[16:31], a[228:231], v[36:39], v[16:31]
  s_waitcnt lgkmcnt(2)
  v_mfma_f32_32x32x16_bf16 v[0:15], a[88:91], v[40:43], v[0:15]
  ds_read_b128 v[36:39], v204 offset:6144
  v_mfma_f32_32x32x16_bf16 v[16:31], a[232:235], v[40:43], v[16:31]
  s_waitcnt lgkmcnt(2)
  v_mfma_f32_32x32x16_bf16 v[0:15], a[92:95], v[44:47], v[0:15]
  ds_read_b128 v[40:43], v205 offset:6144
  v_mfma_f32_32x32x16_bf16 v[16:31], a[236:239], v[44:47], v[16:31]
  s_waitcnt lgkmcnt(2)
  v_mfma_f32_32x32x16_bf16 v[0:15], a[96:99], v[32:35], v[0:15]
  ds_read_b128 v[44:47], v206 offset:6144
  v_mfma_f32_32x32x16_bf16 v[16:31], a[240:243], v[32:35], v[16:31]
  s_waitcnt lgkmcnt(2)
  v_mfma_f32_32x32x16_bf16 v[0:15], a[100:103], v[36:39], v[0:15]
  ds_read_b128 v[32:35], v203 offset:7168
  v_mfma_f32_32x32x16_bf16 v[16:31], a[244:247], v[36:39], v[16:31]
  s_waitcnt lgkmcnt(2)
  v_mfma_f32_32x32x16_bf16 v[0:15], a[104:107], v[40:43], v[0:15]
  ds_read_b128 v[36:39], v204 offset:7168
  v_mfma_f32_32x32x16_bf16 v[16:31], a[248:251], v[40:43], v[16:31]
  s_waitcnt lgkmcnt(2)
  v_mfma_f32_32x32x16_bf16 v[0:15], a[108:111], v[44:47], v[0:15]
  ds_read_b128 v[40:43], v205 offset:7168
  v_mfma_f32_32x32x16_bf16 v[16:31], a[252:255], v[44:47], v[16:31]
  s_waitcnt lgkmcnt(2)
  v_mfma_f32_32x32x16_bf16 v[0:15], a[112:115], v[32:35], v[0:15]
  ds_read_b128 v[44:47], v206 offset:7168
  v_mfma_f32_32x32x16_bf16 v[16:31], v[224:227], v[32:35], v[16:31]
  s_waitcnt lgkmcnt(2)
  v_mfma_f32_32x32x16_bf16 v[0:15], a[116:119], v[36:39], v[0:15]
  ds_read_b128 v[32:35], v203 offset:8192
  v_mfma_f32_32x32x16_bf16 v[16:31], v[228:231], v[36:39], v[16:31]
  s_waitcnt lgkmcnt(2)
  v_mfma_f32_32x32x16_bf16 v[0:15], a[120:123], v[40:43], v[0:15]
  ds_read_b128 v[36:39], v204 offset:8192
  v_mfma_f32_32x32x16_bf16 v[16:31], v[232:235], v[40:43], v[16:31]
  s_waitcnt lgkmcnt(2)
  v_mfma_f32_32x32x16_bf16 v[0:15], a[124:127], v[44:47], v[0:15]
  ds_read_b128 v[40:43], v205 offset:8192
  v_mfma_f32_32x32x16_bf16 v[16:31], v[236:239], v[44:47], v[16:31]
  s_waitcnt lgkmcnt(2)
  v_mfma_f32_32x32x16_bf16 v[0:15], a[128:131], v[32:35], v[0:15]
  ds_read_b128 v[44:47], v206 offset:8192
  v_mfma_f32_32x32x16_bf16 v[16:31], v[240:243], v[32:35], v[16:31]
  s_waitcnt lgkmcnt(2)
  v_mfma_f32_32x32x16_bf16 v[0:15], a[132:135], v[36:39], v[0:15]
  v_mfma_f32_32x32x16_bf16 v[16:31], v[244:247], v[36:39], v[16:31]
  s_waitcnt lgkmcnt(1)
  v_mfma_f32_32x32x16_bf16 v[0:15], a[136:139], v[40:43], v[0:15]
  v_mfma_f32_32x32x16_bf16 v[16:31], v[248:251], v[40:43], v[16:31]
  s_waitcnt lgkmcnt(0)
  v_mfma_f32_32x32x16_bf16 v[0:15], a[140:143], v[44:47], v[0:15]
  v_mfma_f32_32x32x16_bf16 v[16:31], v[252:255], v[44:47], v[16:31]
  s_nop 3
  v_cvt_pk_bf16_f32 v48, v0, v1
  v_cvt_pk_bf16_f32 v49, v2, v3
  ds_write2_b32 v218, v48, v49 offset0:0 offset1:1
  v_cvt_pk_bf16_f32 v48, v4, v5
  v_cvt_pk_bf16_f32 v49, v6, v7
  ds_write2_b32 v218, v48, v49 offset0:4 offset1:5
  v_cvt_pk_bf16_f32 v48, v8, v9
  v_cvt_pk_bf16_f32 v49, v10, v11
  ds_write2_b32 v218, v48, v49 offset0:8 offset1:9
  v_cvt_pk_bf16_f32 v48, v12, v13
  v_cvt_pk_bf16_f32 v49, v14, v15
  ds_write2_b32 v218, v48, v49 offset0:12 offset1:13
  v_cvt_pk_bf16_f32 v48, v16, v17
  v_cvt_pk_bf16_f32 v49, v18, v19
  ds_write2_b32 v218, v48, v49 offset0:64 offset1:65
  v_cvt_pk_bf16_f32 v48, v20, v21
  v_cvt_pk_bf16_f32 v49, v22, v23
  ds_write2_b32 v218, v48, v49 offset0:68 offset1:69
  v_cvt_pk_bf16_f32 v48, v24, v25
  v_cvt_pk_bf16_f32 v49, v26, v27
  ds_write2_b32 v218, v48, v49 offset0:72 offset1:73
  v_cvt_pk_bf16_f32 v48, v28, v29
  v_cvt_pk_bf16_f32 v49, v30, v31
  ds_write2_b32 v218, v48, v49 offset0:76 offset1:77
  v_add_u32 v218, 16512, v218
  s_waitcnt vmcnt(0) lgkmcnt(0)
  s_barrier
  v_mul_u32_u24 v219, 516, v200
  s_mul_i32 s54, s52, 36
  s_add_u32 s55, s54, 83016
  v_add_u32 v219, s55, v219
  v_mul_u32_u24 v220, 1152, v200
  s_mul_i32 s55, s68, 144
  s_add_u32 s54, s54, s55
  s_mul_i32 s55, s69, 147456
  s_add_u32 s64, s54, s55
  s_add_u32 s64, s64, 62914560
  s_lshl_b32 s66, s69, 7
  s_mov_b32 s57, 1051597459
  ds_read_b32 v0, v219 offset:7224
  ds_read_b32 v1, v219 offset:7228
  ds_read_b32 v2, v219 offset:7232
  ds_read_b32 v3, v219 offset:7236
  ds_read_b32 v4, v219 offset:7240
  ds_read_b32 v5, v219 offset:7244
  ds_read_b32 v6, v219 offset:7248
  ds_read_b32 v7, v219 offset:7252
  ds_read_b32 v8, v219 offset:7256
  ds_read_b32 v16, v219 offset:7368
  ds_read_b32 v17, v219 offset:7372
  ds_read_b32 v18, v219 offset:7376
  ds_read_b32 v19, v219 offset:7380
  ds_read_b32 v20, v219 offset:7384
  ds_read_b32 v21, v219 offset:7388
  ds_read_b32 v22, v219 offset:7392
  ds_read_b32 v23, v219 offset:7396
  ds_read_b32 v24, v219 offset:7400
  ds_read_b32 v25, v219 offset:6336
  ds_read_b32 v26, v219 offset:6340
  ds_read_b32 v27, v219 offset:6344
  ds_read_b32 v28, v219 offset:6348
  ds_read_b32 v29, v219 offset:6352
  ds_read_b32 v30, v219 offset:6356
  ds_read_b32 v31, v219 offset:6360
  ds_read_b32 v32, v219 offset:6364
  ds_read_b32 v33, v219 offset:6368
  ds_read_b32 v34, v219 offset:5304
  ds_read_b32 v35, v219 offset:5308
  ds_read_b32 v36, v219 offset:5312
  ds_read_b32 v37, v219 offset:5316
  ds_read_b32 v38, v219 offset:5320
  ds_read_b32 v39, v219 offset:5324
  ds_read_b32 v40, v219 offset:5328
  ds_read_b32 v41, v219 offset:5332
  ds_read_b32 v42, v219 offset:5336
  ds_read_b32 v43, v219 offset:4272
  ds_read_b32 v44, v219 offset:4276
  ds_read_b32 v45, v219 offset:4280
  ds_read_b32 v46, v219 offset:4284
  ds_read_b32 v47, v219 offset:4288
  ds_read_b32 v48, v219 offset:4292
  ds_read_b32 v49, v219 offset:4296
  ds_read_b32 v50, v219 offset:4300
  ds_read_b32 v51, v219 offset:4304
  ds_read_b32 v52, v219 offset:3240
  ds_read_b32 v53, v219 offset:3244
  ds_read_b32 v54, v219 offset:3248
  ds_read_b32 v55, v219 offset:3252
  ds_read_b32 v56, v219 offset:3256
  ds_read_b32 v57, v219 offset:3260
  ds_read_b32 v58, v219 offset:3264
  ds_read_b32 v59, v219 offset:3268
  ds_read_b32 v60, v219 offset:3272
  ds_read_b32 v61, v219 offset:2208
  ds_read_b32 v62, v219 offset:2212
  ds_read_b32 v63, v219 offset:2216
  ds_read_b32 v64, v219 offset:2220
  ds_read_b32 v65, v219 offset:2224
  ds_read_b32 v66, v219 offset:2228
  ds_read_b32 v67, v219 offset:2232
  ds_read_b32 v68, v219 offset:2236
  ds_read_b32 v69, v219 offset:2240
  ds_read_b32 v70, v219 offset:1176
  ds_read_b32 v71, v219 offset:1180
  ds_read_b32 v72, v219 offset:1184
  ds_read_b32 v73, v219 offset:1188
  ds_read_b32 v74, v219 offset:1192
  ds_read_b32 v75, v219 offset:1196
  ds_read_b32 v76, v219 offset:1200
  ds_read_b32 v77, v219 offset:1204
  ds_read_b32 v78, v219 offset:1208
  ds_read_b32 v79, v219 offset:144
  ds_read_b32 v80, v219 offset:148
  ds_read_b32 v81, v219 offset:152
  ds_read_b32 v82, v219 offset:156
  ds_read_b32 v83, v219 offset:160
  ds_read_b32 v84, v219 offset:164
  ds_read_b32 v85, v219 offset:168
  ds_read_b32 v86, v219 offset:172
  ds_read_b32 v87, v219 offset:176
  v_mov_b32 v100, 0
  v_mov_b32 v101, 0
  v_mov_b32 v102, 0
  v_mov_b32 v103, 0
  v_mov_b32 v104, 0
  v_mov_b32 v105, 0
  v_mov_b32 v106, 0
  v_mov_b32 v107, 0
  s_waitcnt lgkmcnt(15)
  v_dot2c_f32_bf16 v100, v0, v16
  v_dot2c_f32_bf16 v101, v0, v25
  v_dot2c_f32_bf16 v102, v0, v34
  v_dot2c_f32_bf16 v103, v0, v43
  v_dot2c_f32_bf16 v104, v0, v52
  v_dot2c_f32_bf16 v105, v0, v61
  v_dot2c_f32_bf16 v106, v0, v70
  s_waitcnt lgkmcnt(8)
  v_dot2c_f32_bf16 v107, v0, v79
  v_dot2c_f32_bf16 v100, v1, v17
  v_dot2c_f32_bf16 v101, v1, v26
  v_dot2c_f32_bf16 v102, v1, v35
  v_dot2c_f32_bf16 v103, v1, v44
  v_dot2c_f32_bf16 v104, v1, v53
  v_dot2c_f32_bf16 v105, v1, v62
  v_dot2c_f32_bf16 v106, v1, v71
  s_waitcnt lgkmcnt(7)
  v_dot2c_f32_bf16 v107, v1, v80
  v_dot2c_f32_bf16 v100, v2, v18
  v_dot2c_f32_bf16 v101, v2, v27
  v_dot2c_f32_bf16 v102, v2, v36
  v_dot2c_f32_bf16 v103, v2, v45
  v_dot2c_f32_bf16 v104, v2, v54
  v_dot2c_f32_bf16 v105, v2, v63
  v_dot2c_f32_bf16 v106, v2, v72
  s_waitcnt lgkmcnt(6)
  v_dot2c_f32_bf16 v107, v2, v81
  v_dot2c_f32_bf16 v100, v3, v19
  v_dot2c_f32_bf16 v101, v3, v28
  v_dot2c_f32_bf16 v102, v3, v37
  v_dot2c_f32_bf16 v103, v3, v46
  v_dot2c_f32_bf16 v104, v3, v55
  v_dot2c_f32_bf16 v105, v3, v64
  v_dot2c_f32_bf16 v106, v3, v73
  s_waitcnt lgkmcnt(5)
  v_dot2c_f32_bf16 v107, v3, v82
  v_dot2c_f32_bf16 v100, v4, v20
  v_dot2c_f32_bf16 v101, v4, v29
  v_dot2c_f32_bf16 v102, v4, v38
  v_dot2c_f32_bf16 v103, v4, v47
  v_dot2c_f32_bf16 v104, v4, v56
  v_dot2c_f32_bf16 v105, v4, v65
  v_dot2c_f32_bf16 v106, v4, v74
  s_waitcnt lgkmcnt(4)
  v_dot2c_f32_bf16 v107, v4, v83
  v_dot2c_f32_bf16 v100, v5, v21
  v_dot2c_f32_bf16 v101, v5, v30
  v_dot2c_f32_bf16 v102, v5, v39
  v_dot2c_f32_bf16 v103, v5, v48
  v_dot2c_f32_bf16 v104, v5, v57
  v_dot2c_f32_bf16 v105, v5, v66
  v_dot2c_f32_bf16 v106, v5, v75
  s_waitcnt lgkmcnt(3)
  v_dot2c_f32_bf16 v107, v5, v84
  v_dot2c_f32_bf16 v100, v6, v22
  v_dot2c_f32_bf16 v101, v6, v31
  v_dot2c_f32_bf16 v102, v6, v40
  v_dot2c_f32_bf16 v103, v6, v49
  v_dot2c_f32_bf16 v104, v6, v58
  v_dot2c_f32_bf16 v105, v6, v67
  v_dot2c_f32_bf16 v106, v6, v76
  s_waitcnt lgkmcnt(2)
  v_dot2c_f32_bf16 v107, v6, v85
  v_dot2c_f32_bf16 v100, v7, v23
  v_dot2c_f32_bf16 v101, v7, v32
  v_dot2c_f32_bf16 v102, v7, v41
  v_dot2c_f32_bf16 v103, v7, v50
  v_dot2c_f32_bf16 v104, v7, v59
  v_dot2c_f32_bf16 v105, v7, v68
  v_dot2c_f32_bf16 v106, v7, v77
  s_waitcnt lgkmcnt(1)
  v_dot2c_f32_bf16 v107, v7, v86
  v_dot2c_f32_bf16 v100, v8, v24
  v_dot2c_f32_bf16 v101, v8, v33
  v_dot2c_f32_bf16 v102, v8, v42
  v_dot2c_f32_bf16 v103, v8, v51
  v_dot2c_f32_bf16 v104, v8, v60
  v_dot2c_f32_bf16 v105, v8, v69
  v_dot2c_f32_bf16 v106, v8, v78
  s_waitcnt lgkmcnt(0)
  v_dot2c_f32_bf16 v107, v8, v87
  ds_read_b32 v16, v219 offset:7512
  ds_read_b32 v17, v219 offset:7516
  ds_read_b32 v18, v219 offset:7520
  ds_read_b32 v19, v219 offset:7524
  ds_read_b32 v20, v219 offset:7528
  ds_read_b32 v21, v219 offset:7532
  ds_read_b32 v22, v219 offset:7536
  ds_read_b32 v23, v219 offset:7540
  ds_read_b32 v24, v219 offset:7544
  ds_read_b32 v25, v219 offset:6480
  ds_read_b32 v26, v219 offset:6484
  ds_read_b32 v27, v219 offset:6488
  ds_read_b32 v28, v219 offset:6492
  ds_read_b32 v29, v219 offset:6496
  ds_read_b32 v30, v219 offset:6500
  ds_read_b32 v31, v219 offset:6504
  ds_read_b32 v32, v219 offset:6508
  ds_read_b32 v33, v219 offset:6512
  ds_read_b32 v34, v219 offset:5448
  ds_read_b32 v35, v219 offset:5452
  ds_read_b32 v36, v219 offset:5456
  ds_read_b32 v37, v219 offset:5460
  ds_read_b32 v38, v219 offset:5464
  ds_read_b32 v39, v219 offset:5468
  ds_read_b32 v40, v219 offset:5472
  ds_read_b32 v41, v219 offset:5476
  ds_read_b32 v42, v219 offset:5480
  ds_read_b32 v43, v219 offset:4416
  ds_read_b32 v44, v219 offset:4420
  ds_read_b32 v45, v219 offset:4424
  ds_read_b32 v46, v219 offset:4428
  ds_read_b32 v47, v219 offset:4432
  ds_read_b32 v48, v219 offset:4436
  ds_read_b32 v49, v219 offset:4440
  ds_read_b32 v50, v219 offset:4444
  ds_read_b32 v51, v219 offset:4448
  ds_read_b32 v52, v219 offset:3384
  ds_read_b32 v53, v219 offset:3388
  ds_read_b32 v54, v219 offset:3392
  ds_read_b32 v55, v219 offset:3396
  ds_read_b32 v56, v219 offset:3400
  ds_read_b32 v57, v219 offset:3404
  ds_read_b32 v58, v219 offset:3408
  ds_read_b32 v59, v219 offset:3412
  ds_read_b32 v60, v219 offset:3416
  ds_read_b32 v61, v219 offset:2352
  ds_read_b32 v62, v219 offset:2356
  ds_read_b32 v63, v219 offset:2360
  ds_read_b32 v64, v219 offset:2364
  ds_read_b32 v65, v219 offset:2368
  ds_read_b32 v66, v219 offset:2372
  ds_read_b32 v67, v219 offset:2376
  ds_read_b32 v68, v219 offset:2380
  ds_read_b32 v69, v219 offset:2384
  ds_read_b32 v70, v219 offset:1320
  ds_read_b32 v71, v219 offset:1324
  ds_read_b32 v72, v219 offset:1328
  ds_read_b32 v73, v219 offset:1332
  ds_read_b32 v74, v219 offset:1336
  ds_read_b32 v75, v219 offset:1340
  ds_read_b32 v76, v219 offset:1344
  ds_read_b32 v77, v219 offset:1348
  ds_read_b32 v78, v219 offset:1352
  ds_read_b32 v79, v219 offset:288
  ds_read_b32 v80, v219 offset:292
  ds_read_b32 v81, v219 offset:296
  ds_read_b32 v82, v219 offset:300
  ds_read_b32 v83, v219 offset:304
  ds_read_b32 v84, v219 offset:308
  ds_read_b32 v85, v219 offset:312
  ds_read_b32 v86, v219 offset:316
  ds_read_b32 v87, v219 offset:320
  v_add_u32 v211, s66, v200
  v_mov_b32 v212, 0xf149f2ca
  v_mul_f32 v100, s57, v100
  v_mul_f32 v101, s57, v101
  v_mul_f32 v102, s57, v102
  v_mul_f32 v103, s57, v103
  v_mul_f32 v104, s57, v104
  v_mul_f32 v105, s57, v105
  v_mul_f32 v106, s57, v106
  v_mul_f32 v107, s57, v107
  v_cmp_gt_u32 vcc, 2, v211
  s_nop 1
  v_cndmask_b32 v101, v101, v212, vcc
  v_cmp_gt_u32 vcc, 4, v211
  s_nop 1
  v_cndmask_b32 v102, v102, v212, vcc
  v_cmp_gt_u32 vcc, 6, v211
  s_nop 1
  v_cndmask_b32 v103, v103, v212, vcc
  v_cmp_gt_u32 vcc, 8, v211
  s_nop 1
  v_cndmask_b32 v104, v104, v212, vcc
  v_cmp_gt_u32 vcc, 10, v211
  s_nop 1
  v_cndmask_b32 v105, v105, v212, vcc
  v_cmp_gt_u32 vcc, 12, v211
  s_nop 1
  v_cndmask_b32 v106, v106, v212, vcc
  v_cmp_gt_u32 vcc, 14, v211
  s_nop 1
  v_cndmask_b32 v107, v107, v212, vcc
  v_max3_f32 v213, v100, v101, v102
  v_max3_f32 v213, v213, v103, v104
  v_max3_f32 v213, v213, v105, v106
  v_max_f32 v213, v213, v107
  v_sub_f32 v100, v100, v213
  v_sub_f32 v101, v101, v213
  v_sub_f32 v102, v102, v213
  v_sub_f32 v103, v103, v213
  v_sub_f32 v104, v104, v213
  v_sub_f32 v105, v105, v213
  v_sub_f32 v106, v106, v213
  v_sub_f32 v107, v107, v213
  v_exp_f32 v100, v100
  v_exp_f32 v101, v101
  v_exp_f32 v102, v102
  v_exp_f32 v103, v103
  v_exp_f32 v104, v104
  v_exp_f32 v105, v105
  v_exp_f32 v106, v106
  v_exp_f32 v107, v107
  v_add_f32 v213, v100, v101
  v_add_f32 v213, v213, v102
  v_add_f32 v213, v213, v103
  v_add_f32 v213, v213, v104
  v_add_f32 v213, v213, v105
  v_add_f32 v213, v213, v106
  v_add_f32 v213, v213, v107
  v_rcp_f32 v213, v213
  v_mov_b32 v214, 0
  v_mul_f32 v100, v213, v100
  v_mul_f32 v101, v213, v101
  v_mul_f32 v102, v213, v102
  v_mul_f32 v103, v213, v103
  v_mul_f32 v104, v213, v104
  v_mul_f32 v105, v213, v105
  v_mul_f32 v106, v213, v106
  v_mul_f32 v107, v213, v107
  v_mov_b32 v112, 0
  v_mov_b32 v113, 0
  v_mov_b32 v114, 0
  v_mov_b32 v115, 0
  v_mov_b32 v116, 0
  v_mov_b32 v117, 0
  v_mov_b32 v118, 0
  v_mov_b32 v119, 0
  v_mov_b32 v120, 0
  v_mov_b32 v121, 0
  v_mov_b32 v122, 0
  v_mov_b32 v123, 0
  v_mov_b32 v124, 0
  v_mov_b32 v125, 0
  v_mov_b32 v126, 0
  v_mov_b32 v127, 0
  v_mov_b32 v128, 0
  v_mov_b32 v129, 0
  v_cvt_pk_bf16_f32 v0, v100, v214
  v_cvt_pk_bf16_f32 v1, v214, v100
  s_waitcnt lgkmcnt(15)
  v_dot2c_f32_bf16 v112, v16, v0
  v_dot2c_f32_bf16 v113, v16, v1
  v_dot2c_f32_bf16 v114, v17, v0
  v_dot2c_f32_bf16 v115, v17, v1
  v_dot2c_f32_bf16 v116, v18, v0
  v_dot2c_f32_bf16 v117, v18, v1
  v_dot2c_f32_bf16 v118, v19, v0
  v_dot2c_f32_bf16 v119, v19, v1
  v_dot2c_f32_bf16 v120, v20, v0
  v_dot2c_f32_bf16 v121, v20, v1
  v_dot2c_f32_bf16 v122, v21, v0
  v_dot2c_f32_bf16 v123, v21, v1
  v_dot2c_f32_bf16 v124, v22, v0
  v_dot2c_f32_bf16 v125, v22, v1
  v_dot2c_f32_bf16 v126, v23, v0
  v_dot2c_f32_bf16 v127, v23, v1
  v_dot2c_f32_bf16 v128, v24, v0
  v_dot2c_f32_bf16 v129, v24, v1
  v_cvt_pk_bf16_f32 v2, v101, v214
  v_cvt_pk_bf16_f32 v3, v214, v101
  v_dot2c_f32_bf16 v112, v25, v2
  v_dot2c_f32_bf16 v113, v25, v3
  v_dot2c_f32_bf16 v114, v26, v2
  v_dot2c_f32_bf16 v115, v26, v3
  v_dot2c_f32_bf16 v116, v27, v2
  v_dot2c_f32_bf16 v117, v27, v3
  v_dot2c_f32_bf16 v118, v28, v2
  v_dot2c_f32_bf16 v119, v28, v3
  v_dot2c_f32_bf16 v120, v29, v2
  v_dot2c_f32_bf16 v121, v29, v3
  v_dot2c_f32_bf16 v122, v30, v2
  v_dot2c_f32_bf16 v123, v30, v3
  v_dot2c_f32_bf16 v124, v31, v2
  v_dot2c_f32_bf16 v125, v31, v3
  v_dot2c_f32_bf16 v126, v32, v2
  v_dot2c_f32_bf16 v127, v32, v3
  v_dot2c_f32_bf16 v128, v33, v2
  v_dot2c_f32_bf16 v129, v33, v3
  v_cvt_pk_bf16_f32 v0, v102, v214
  v_cvt_pk_bf16_f32 v1, v214, v102
  v_dot2c_f32_bf16 v112, v34, v0
  v_dot2c_f32_bf16 v113, v34, v1
  v_dot2c_f32_bf16 v114, v35, v0
  v_dot2c_f32_bf16 v115, v35, v1
  v_dot2c_f32_bf16 v116, v36, v0
  v_dot2c_f32_bf16 v117, v36, v1
  v_dot2c_f32_bf16 v118, v37, v0
  v_dot2c_f32_bf16 v119, v37, v1
  v_dot2c_f32_bf16 v120, v38, v0
  v_dot2c_f32_bf16 v121, v38, v1
  v_dot2c_f32_bf16 v122, v39, v0
  v_dot2c_f32_bf16 v123, v39, v1
  v_dot2c_f32_bf16 v124, v40, v0
  v_dot2c_f32_bf16 v125, v40, v1
  v_dot2c_f32_bf16 v126, v41, v0
  v_dot2c_f32_bf16 v127, v41, v1
  v_dot2c_f32_bf16 v128, v42, v0
  v_dot2c_f32_bf16 v129, v42, v1
  v_cvt_pk_bf16_f32 v2, v103, v214
  v_cvt_pk_bf16_f32 v3, v214, v103
  v_dot2c_f32_bf16 v112, v43, v2
  v_dot2c_f32_bf16 v113, v43, v3
  v_dot2c_f32_bf16 v114, v44, v2
  v_dot2c_f32_bf16 v115, v44, v3
  v_dot2c_f32_bf16 v116, v45, v2
  v_dot2c_f32_bf16 v117, v45, v3
  v_dot2c_f32_bf16 v118, v46, v2
  v_dot2c_f32_bf16 v119, v46, v3
  v_dot2c_f32_bf16 v120, v47, v2
  v_dot2c_f32_bf16 v121, v47, v3
  v_dot2c_f32_bf16 v122, v48, v2
  v_dot2c_f32_bf16 v123, v48, v3
  v_dot2c_f32_bf16 v124, v49, v2
  v_dot2c_f32_bf16 v125, v49, v3
  v_dot2c_f32_bf16 v126, v50, v2
  v_dot2c_f32_bf16 v127, v50, v3
  v_dot2c_f32_bf16 v128, v51, v2
  v_dot2c_f32_bf16 v129, v51, v3
  v_cvt_pk_bf16_f32 v0, v104, v214
  v_cvt_pk_bf16_f32 v1, v214, v104
  v_dot2c_f32_bf16 v112, v52, v0
  v_dot2c_f32_bf16 v113, v52, v1
  v_dot2c_f32_bf16 v114, v53, v0
  v_dot2c_f32_bf16 v115, v53, v1
  v_dot2c_f32_bf16 v116, v54, v0
  v_dot2c_f32_bf16 v117, v54, v1
  v_dot2c_f32_bf16 v118, v55, v0
  v_dot2c_f32_bf16 v119, v55, v1
  v_dot2c_f32_bf16 v120, v56, v0
  v_dot2c_f32_bf16 v121, v56, v1
  v_dot2c_f32_bf16 v122, v57, v0
  v_dot2c_f32_bf16 v123, v57, v1
  v_dot2c_f32_bf16 v124, v58, v0
  v_dot2c_f32_bf16 v125, v58, v1
  v_dot2c_f32_bf16 v126, v59, v0
  v_dot2c_f32_bf16 v127, v59, v1
  v_dot2c_f32_bf16 v128, v60, v0
  v_dot2c_f32_bf16 v129, v60, v1
  v_cvt_pk_bf16_f32 v2, v105, v214
  v_cvt_pk_bf16_f32 v3, v214, v105
  v_dot2c_f32_bf16 v112, v61, v2
  v_dot2c_f32_bf16 v113, v61, v3
  v_dot2c_f32_bf16 v114, v62, v2
  v_dot2c_f32_bf16 v115, v62, v3
  v_dot2c_f32_bf16 v116, v63, v2
  v_dot2c_f32_bf16 v117, v63, v3
  v_dot2c_f32_bf16 v118, v64, v2
  v_dot2c_f32_bf16 v119, v64, v3
  v_dot2c_f32_bf16 v120, v65, v2
  v_dot2c_f32_bf16 v121, v65, v3
  v_dot2c_f32_bf16 v122, v66, v2
  v_dot2c_f32_bf16 v123, v66, v3
  v_dot2c_f32_bf16 v124, v67, v2
  v_dot2c_f32_bf16 v125, v67, v3
  v_dot2c_f32_bf16 v126, v68, v2
  v_dot2c_f32_bf16 v127, v68, v3
  v_dot2c_f32_bf16 v128, v69, v2
  v_dot2c_f32_bf16 v129, v69, v3
  v_cvt_pk_bf16_f32 v0, v106, v214
  v_cvt_pk_bf16_f32 v1, v214, v106
  v_dot2c_f32_bf16 v112, v70, v0
  v_dot2c_f32_bf16 v113, v70, v1
  v_dot2c_f32_bf16 v114, v71, v0
  v_dot2c_f32_bf16 v115, v71, v1
  v_dot2c_f32_bf16 v116, v72, v0
  v_dot2c_f32_bf16 v117, v72, v1
  s_waitcnt lgkmcnt(14)
  v_dot2c_f32_bf16 v118, v73, v0
  v_dot2c_f32_bf16 v119, v73, v1
  s_waitcnt lgkmcnt(13)
  v_dot2c_f32_bf16 v120, v74, v0
  v_dot2c_f32_bf16 v121, v74, v1
  s_waitcnt lgkmcnt(12)
  v_dot2c_f32_bf16 v122, v75, v0
  v_dot2c_f32_bf16 v123, v75, v1
  s_waitcnt lgkmcnt(11)
  v_dot2c_f32_bf16 v124, v76, v0
  v_dot2c_f32_bf16 v125, v76, v1
  s_waitcnt lgkmcnt(10)
  v_dot2c_f32_bf16 v126, v77, v0
  v_dot2c_f32_bf16 v127, v77, v1
  s_waitcnt lgkmcnt(9)
  v_dot2c_f32_bf16 v128, v78, v0
  v_dot2c_f32_bf16 v129, v78, v1
  v_cvt_pk_bf16_f32 v2, v107, v214
  v_cvt_pk_bf16_f32 v3, v214, v107
  s_waitcnt lgkmcnt(8)
  v_dot2c_f32_bf16 v112, v79, v2
  v_dot2c_f32_bf16 v113, v79, v3
  s_waitcnt lgkmcnt(7)
  v_dot2c_f32_bf16 v114, v80, v2
  v_dot2c_f32_bf16 v115, v80, v3
  s_waitcnt lgkmcnt(6)
  v_dot2c_f32_bf16 v116, v81, v2
  v_dot2c_f32_bf16 v117, v81, v3
  s_waitcnt lgkmcnt(5)
  v_dot2c_f32_bf16 v118, v82, v2
  v_dot2c_f32_bf16 v119, v82, v3
  s_waitcnt lgkmcnt(4)
  v_dot2c_f32_bf16 v120, v83, v2
  v_dot2c_f32_bf16 v121, v83, v3
  s_waitcnt lgkmcnt(3)
  v_dot2c_f32_bf16 v122, v84, v2
  v_dot2c_f32_bf16 v123, v84, v3
  s_waitcnt lgkmcnt(2)
  v_dot2c_f32_bf16 v124, v85, v2
  v_dot2c_f32_bf16 v125, v85, v3
  s_waitcnt lgkmcnt(1)
  v_dot2c_f32_bf16 v126, v86, v2
  v_dot2c_f32_bf16 v127, v86, v3
  s_waitcnt lgkmcnt(0)
  v_dot2c_f32_bf16 v128, v87, v2
  v_dot2c_f32_bf16 v129, v87, v3
  v_cvt_pk_bf16_f32 v132, v112, v113
  v_cvt_pk_bf16_f32 v133, v114, v115
  v_cvt_pk_bf16_f32 v134, v116, v117
  v_cvt_pk_bf16_f32 v135, v118, v119
  v_cvt_pk_bf16_f32 v136, v120, v121
  v_cvt_pk_bf16_f32 v137, v122, v123
  v_cvt_pk_bf16_f32 v138, v124, v125
  v_cvt_pk_bf16_f32 v139, v126, v127
  v_cvt_pk_bf16_f32 v140, v128, v129
  buffer_store_dwordx4 v[132:135], v220, s[8:11], s64 offen sc1
  buffer_store_dwordx4 v[136:139], v220, s[8:11], s64 offen offset:16 sc1
  buffer_store_dword v140, v220, s[8:11], s64 offen offset:32 sc1
  v_add_u32 v219, 33024, v219
  s_add_u32 s66, s66, 64
  s_add_u32 s64, s64, 73728
  ds_read_b32 v0, v219 offset:7224
  ds_read_b32 v1, v219 offset:7228
  ds_read_b32 v2, v219 offset:7232
  ds_read_b32 v3, v219 offset:7236
  ds_read_b32 v4, v219 offset:7240
  ds_read_b32 v5, v219 offset:7244
  ds_read_b32 v6, v219 offset:7248
  ds_read_b32 v7, v219 offset:7252
  ds_read_b32 v8, v219 offset:7256
  ds_read_b32 v16, v219 offset:7368
  ds_read_b32 v17, v219 offset:7372
  ds_read_b32 v18, v219 offset:7376
  ds_read_b32 v19, v219 offset:7380
  ds_read_b32 v20, v219 offset:7384
  ds_read_b32 v21, v219 offset:7388
  ds_read_b32 v22, v219 offset:7392
  ds_read_b32 v23, v219 offset:7396
  ds_read_b32 v24, v219 offset:7400
  ds_read_b32 v25, v219 offset:6336
  ds_read_b32 v26, v219 offset:6340
  ds_read_b32 v27, v219 offset:6344
  ds_read_b32 v28, v219 offset:6348
  ds_read_b32 v29, v219 offset:6352
  ds_read_b32 v30, v219 offset:6356
  ds_read_b32 v31, v219 offset:6360
  ds_read_b32 v32, v219 offset:6364
  ds_read_b32 v33, v219 offset:6368
  ds_read_b32 v34, v219 offset:5304
  ds_read_b32 v35, v219 offset:5308
  ds_read_b32 v36, v219 offset:5312
  ds_read_b32 v37, v219 offset:5316
  ds_read_b32 v38, v219 offset:5320
  ds_read_b32 v39, v219 offset:5324
  ds_read_b32 v40, v219 offset:5328
  ds_read_b32 v41, v219 offset:5332
  ds_read_b32 v42, v219 offset:5336
  ds_read_b32 v43, v219 offset:4272
  ds_read_b32 v44, v219 offset:4276
  ds_read_b32 v45, v219 offset:4280
  ds_read_b32 v46, v219 offset:4284
  ds_read_b32 v47, v219 offset:4288
  ds_read_b32 v48, v219 offset:4292
  ds_read_b32 v49, v219 offset:4296
  ds_read_b32 v50, v219 offset:4300
  ds_read_b32 v51, v219 offset:4304
  ds_read_b32 v52, v219 offset:3240
  ds_read_b32 v53, v219 offset:3244
  ds_read_b32 v54, v219 offset:3248
  ds_read_b32 v55, v219 offset:3252
  ds_read_b32 v56, v219 offset:3256
  ds_read_b32 v57, v219 offset:3260
  ds_read_b32 v58, v219 offset:3264
  ds_read_b32 v59, v219 offset:3268
  ds_read_b32 v60, v219 offset:3272
  ds_read_b32 v61, v219 offset:2208
  ds_read_b32 v62, v219 offset:2212
  ds_read_b32 v63, v219 offset:2216
  ds_read_b32 v64, v219 offset:2220
  ds_read_b32 v65, v219 offset:2224
  ds_read_b32 v66, v219 offset:2228
  ds_read_b32 v67, v219 offset:2232
  ds_read_b32 v68, v219 offset:2236
  ds_read_b32 v69, v219 offset:2240
  ds_read_b32 v70, v219 offset:1176
  ds_read_b32 v71, v219 offset:1180
  ds_read_b32 v72, v219 offset:1184
  ds_read_b32 v73, v219 offset:1188
  ds_read_b32 v74, v219 offset:1192
  ds_read_b32 v75, v219 offset:1196
  ds_read_b32 v76, v219 offset:1200
  ds_read_b32 v77, v219 offset:1204
  ds_read_b32 v78, v219 offset:1208
  ds_read_b32 v79, v219 offset:144
  ds_read_b32 v80, v219 offset:148
  ds_read_b32 v81, v219 offset:152
  ds_read_b32 v82, v219 offset:156
  ds_read_b32 v83, v219 offset:160
  ds_read_b32 v84, v219 offset:164
  ds_read_b32 v85, v219 offset:168
  ds_read_b32 v86, v219 offset:172
  ds_read_b32 v87, v219 offset:176
  v_mov_b32 v100, 0
  v_mov_b32 v101, 0
  v_mov_b32 v102, 0
  v_mov_b32 v103, 0
  v_mov_b32 v104, 0
  v_mov_b32 v105, 0
  v_mov_b32 v106, 0
  v_mov_b32 v107, 0
  s_waitcnt lgkmcnt(15)
  v_dot2c_f32_bf16 v100, v0, v16
  v_dot2c_f32_bf16 v101, v0, v25
  v_dot2c_f32_bf16 v102, v0, v34
  v_dot2c_f32_bf16 v103, v0, v43
  v_dot2c_f32_bf16 v104, v0, v52
  v_dot2c_f32_bf16 v105, v0, v61
  v_dot2c_f32_bf16 v106, v0, v70
  s_waitcnt lgkmcnt(8)
  v_dot2c_f32_bf16 v107, v0, v79
  v_dot2c_f32_bf16 v100, v1, v17
  v_dot2c_f32_bf16 v101, v1, v26
  v_dot2c_f32_bf16 v102, v1, v35
  v_dot2c_f32_bf16 v103, v1, v44
  v_dot2c_f32_bf16 v104, v1, v53
  v_dot2c_f32_bf16 v105, v1, v62
  v_dot2c_f32_bf16 v106, v1, v71
  s_waitcnt lgkmcnt(7)
  v_dot2c_f32_bf16 v107, v1, v80
  v_dot2c_f32_bf16 v100, v2, v18
  v_dot2c_f32_bf16 v101, v2, v27
  v_dot2c_f32_bf16 v102, v2, v36
  v_dot2c_f32_bf16 v103, v2, v45
  v_dot2c_f32_bf16 v104, v2, v54
  v_dot2c_f32_bf16 v105, v2, v63
  v_dot2c_f32_bf16 v106, v2, v72
  s_waitcnt lgkmcnt(6)
  v_dot2c_f32_bf16 v107, v2, v81
  v_dot2c_f32_bf16 v100, v3, v19
  v_dot2c_f32_bf16 v101, v3, v28
  v_dot2c_f32_bf16 v102, v3, v37
  v_dot2c_f32_bf16 v103, v3, v46
  v_dot2c_f32_bf16 v104, v3, v55
  v_dot2c_f32_bf16 v105, v3, v64
  v_dot2c_f32_bf16 v106, v3, v73
  s_waitcnt lgkmcnt(5)
  v_dot2c_f32_bf16 v107, v3, v82
  v_dot2c_f32_bf16 v100, v4, v20
  v_dot2c_f32_bf16 v101, v4, v29
  v_dot2c_f32_bf16 v102, v4, v38
  v_dot2c_f32_bf16 v103, v4, v47
  v_dot2c_f32_bf16 v104, v4, v56
  v_dot2c_f32_bf16 v105, v4, v65
  v_dot2c_f32_bf16 v106, v4, v74
  s_waitcnt lgkmcnt(4)
  v_dot2c_f32_bf16 v107, v4, v83
  v_dot2c_f32_bf16 v100, v5, v21
  v_dot2c_f32_bf16 v101, v5, v30
  v_dot2c_f32_bf16 v102, v5, v39
  v_dot2c_f32_bf16 v103, v5, v48
  v_dot2c_f32_bf16 v104, v5, v57
  v_dot2c_f32_bf16 v105, v5, v66
  v_dot2c_f32_bf16 v106, v5, v75
  s_waitcnt lgkmcnt(3)
  v_dot2c_f32_bf16 v107, v5, v84
  v_dot2c_f32_bf16 v100, v6, v22
  v_dot2c_f32_bf16 v101, v6, v31
  v_dot2c_f32_bf16 v102, v6, v40
  v_dot2c_f32_bf16 v103, v6, v49
  v_dot2c_f32_bf16 v104, v6, v58
  v_dot2c_f32_bf16 v105, v6, v67
  v_dot2c_f32_bf16 v106, v6, v76
  s_waitcnt lgkmcnt(2)
  v_dot2c_f32_bf16 v107, v6, v85
  v_dot2c_f32_bf16 v100, v7, v23
  v_dot2c_f32_bf16 v101, v7, v32
  v_dot2c_f32_bf16 v102, v7, v41
  v_dot2c_f32_bf16 v103, v7, v50
  v_dot2c_f32_bf16 v104, v7, v59
  v_dot2c_f32_bf16 v105, v7, v68
  v_dot2c_f32_bf16 v106, v7, v77
  s_waitcnt lgkmcnt(1)
  v_dot2c_f32_bf16 v107, v7, v86
  v_dot2c_f32_bf16 v100, v8, v24
  v_dot2c_f32_bf16 v101, v8, v33
  v_dot2c_f32_bf16 v102, v8, v42
  v_dot2c_f32_bf16 v103, v8, v51
  v_dot2c_f32_bf16 v104, v8, v60
  v_dot2c_f32_bf16 v105, v8, v69
  v_dot2c_f32_bf16 v106, v8, v78
  s_waitcnt lgkmcnt(0)
  v_dot2c_f32_bf16 v107, v8, v87
  ds_read_b32 v16, v219 offset:7512
  ds_read_b32 v17, v219 offset:7516
  ds_read_b32 v18, v219 offset:7520
  ds_read_b32 v19, v219 offset:7524
  ds_read_b32 v20, v219 offset:7528
  ds_read_b32 v21, v219 offset:7532
  ds_read_b32 v22, v219 offset:7536
  ds_read_b32 v23, v219 offset:7540
  ds_read_b32 v24, v219 offset:7544
  ds_read_b32 v25, v219 offset:6480
  ds_read_b32 v26, v219 offset:6484
  ds_read_b32 v27, v219 offset:6488
  ds_read_b32 v28, v219 offset:6492
  ds_read_b32 v29, v219 offset:6496
  ds_read_b32 v30, v219 offset:6500
  ds_read_b32 v31, v219 offset:6504
  ds_read_b32 v32, v219 offset:6508
  ds_read_b32 v33, v219 offset:6512
  ds_read_b32 v34, v219 offset:5448
  ds_read_b32 v35, v219 offset:5452
  ds_read_b32 v36, v219 offset:5456
  ds_read_b32 v37, v219 offset:5460
  ds_read_b32 v38, v219 offset:5464
  ds_read_b32 v39, v219 offset:5468
  ds_read_b32 v40, v219 offset:5472
  ds_read_b32 v41, v219 offset:5476
  ds_read_b32 v42, v219 offset:5480
  ds_read_b32 v43, v219 offset:4416
  ds_read_b32 v44, v219 offset:4420
  ds_read_b32 v45, v219 offset:4424
  ds_read_b32 v46, v219 offset:4428
  ds_read_b32 v47, v219 offset:4432
  ds_read_b32 v48, v219 offset:4436
  ds_read_b32 v49, v219 offset:4440
  ds_read_b32 v50, v219 offset:4444
  ds_read_b32 v51, v219 offset:4448
  ds_read_b32 v52, v219 offset:3384
  ds_read_b32 v53, v219 offset:3388
  ds_read_b32 v54, v219 offset:3392
  ds_read_b32 v55, v219 offset:3396
  ds_read_b32 v56, v219 offset:3400
  ds_read_b32 v57, v219 offset:3404
  ds_read_b32 v58, v219 offset:3408
  ds_read_b32 v59, v219 offset:3412
  ds_read_b32 v60, v219 offset:3416
  ds_read_b32 v61, v219 offset:2352
  ds_read_b32 v62, v219 offset:2356
  ds_read_b32 v63, v219 offset:2360
  ds_read_b32 v64, v219 offset:2364
  ds_read_b32 v65, v219 offset:2368
  ds_read_b32 v66, v219 offset:2372
  ds_read_b32 v67, v219 offset:2376
  ds_read_b32 v68, v219 offset:2380
  ds_read_b32 v69, v219 offset:2384
  ds_read_b32 v70, v219 offset:1320
  ds_read_b32 v71, v219 offset:1324
  ds_read_b32 v72, v219 offset:1328
  ds_read_b32 v73, v219 offset:1332
  ds_read_b32 v74, v219 offset:1336
  ds_read_b32 v75, v219 offset:1340
  ds_read_b32 v76, v219 offset:1344
  ds_read_b32 v77, v219 offset:1348
  ds_read_b32 v78, v219 offset:1352
  ds_read_b32 v79, v219 offset:288
  ds_read_b32 v80, v219 offset:292
  ds_read_b32 v81, v219 offset:296
  ds_read_b32 v82, v219 offset:300
  ds_read_b32 v83, v219 offset:304
  ds_read_b32 v84, v219 offset:308
  ds_read_b32 v85, v219 offset:312
  ds_read_b32 v86, v219 offset:316
  ds_read_b32 v87, v219 offset:320
  v_add_u32 v211, s66, v200
  v_mov_b32 v212, 0xf149f2ca
  v_mul_f32 v100, s57, v100
  v_mul_f32 v101, s57, v101
  v_mul_f32 v102, s57, v102
  v_mul_f32 v103, s57, v103
  v_mul_f32 v104, s57, v104
  v_mul_f32 v105, s57, v105
  v_mul_f32 v106, s57, v106
  v_mul_f32 v107, s57, v107
  v_cmp_gt_u32 vcc, 2, v211
  s_nop 1
  v_cndmask_b32 v101, v101, v212, vcc
  v_cmp_gt_u32 vcc, 4, v211
  s_nop 1
  v_cndmask_b32 v102, v102, v212, vcc
  v_cmp_gt_u32 vcc, 6, v211
  s_nop 1
  v_cndmask_b32 v103, v103, v212, vcc
  v_cmp_gt_u32 vcc, 8, v211
  s_nop 1
  v_cndmask_b32 v104, v104, v212, vcc
  v_cmp_gt_u32 vcc, 10, v211
  s_nop 1
  v_cndmask_b32 v105, v105, v212, vcc
  v_cmp_gt_u32 vcc, 12, v211
  s_nop 1
  v_cndmask_b32 v106, v106, v212, vcc
  v_cmp_gt_u32 vcc, 14, v211
  s_nop 1
  v_cndmask_b32 v107, v107, v212, vcc
  v_max3_f32 v213, v100, v101, v102
  v_max3_f32 v213, v213, v103, v104
  v_max3_f32 v213, v213, v105, v106
  v_max_f32 v213, v213, v107
  v_sub_f32 v100, v100, v213
  v_sub_f32 v101, v101, v213
  v_sub_f32 v102, v102, v213
  v_sub_f32 v103, v103, v213
  v_sub_f32 v104, v104, v213
  v_sub_f32 v105, v105, v213
  v_sub_f32 v106, v106, v213
  v_sub_f32 v107, v107, v213
  v_exp_f32 v100, v100
  v_exp_f32 v101, v101
  v_exp_f32 v102, v102
  v_exp_f32 v103, v103
  v_exp_f32 v104, v104
  v_exp_f32 v105, v105
  v_exp_f32 v106, v106
  v_exp_f32 v107, v107
  v_add_f32 v213, v100, v101
  v_add_f32 v213, v213, v102
  v_add_f32 v213, v213, v103
  v_add_f32 v213, v213, v104
  v_add_f32 v213, v213, v105
  v_add_f32 v213, v213, v106
  v_add_f32 v213, v213, v107
  v_rcp_f32 v213, v213
  v_mov_b32 v214, 0
  v_mul_f32 v100, v213, v100
  v_mul_f32 v101, v213, v101
  v_mul_f32 v102, v213, v102
  v_mul_f32 v103, v213, v103
  v_mul_f32 v104, v213, v104
  v_mul_f32 v105, v213, v105
  v_mul_f32 v106, v213, v106
  v_mul_f32 v107, v213, v107
  v_mov_b32 v112, 0
  v_mov_b32 v113, 0
  v_mov_b32 v114, 0
  v_mov_b32 v115, 0
  v_mov_b32 v116, 0
  v_mov_b32 v117, 0
  v_mov_b32 v118, 0
  v_mov_b32 v119, 0
  v_mov_b32 v120, 0
  v_mov_b32 v121, 0
  v_mov_b32 v122, 0
  v_mov_b32 v123, 0
  v_mov_b32 v124, 0
  v_mov_b32 v125, 0
  v_mov_b32 v126, 0
  v_mov_b32 v127, 0
  v_mov_b32 v128, 0
  v_mov_b32 v129, 0
  v_cvt_pk_bf16_f32 v0, v100, v214
  v_cvt_pk_bf16_f32 v1, v214, v100
  s_waitcnt lgkmcnt(15)
  v_dot2c_f32_bf16 v112, v16, v0
  v_dot2c_f32_bf16 v113, v16, v1
  v_dot2c_f32_bf16 v114, v17, v0
  v_dot2c_f32_bf16 v115, v17, v1
  v_dot2c_f32_bf16 v116, v18, v0
  v_dot2c_f32_bf16 v117, v18, v1
  v_dot2c_f32_bf16 v118, v19, v0
  v_dot2c_f32_bf16 v119, v19, v1
  v_dot2c_f32_bf16 v120, v20, v0
  v_dot2c_f32_bf16 v121, v20, v1
  v_dot2c_f32_bf16 v122, v21, v0
  v_dot2c_f32_bf16 v123, v21, v1
  v_dot2c_f32_bf16 v124, v22, v0
  v_dot2c_f32_bf16 v125, v22, v1
  v_dot2c_f32_bf16 v126, v23, v0
  v_dot2c_f32_bf16 v127, v23, v1
  v_dot2c_f32_bf16 v128, v24, v0
  v_dot2c_f32_bf16 v129, v24, v1
  v_cvt_pk_bf16_f32 v2, v101, v214
  v_cvt_pk_bf16_f32 v3, v214, v101
  v_dot2c_f32_bf16 v112, v25, v2
  v_dot2c_f32_bf16 v113, v25, v3
  v_dot2c_f32_bf16 v114, v26, v2
  v_dot2c_f32_bf16 v115, v26, v3
  v_dot2c_f32_bf16 v116, v27, v2
  v_dot2c_f32_bf16 v117, v27, v3
  v_dot2c_f32_bf16 v118, v28, v2
  v_dot2c_f32_bf16 v119, v28, v3
  v_dot2c_f32_bf16 v120, v29, v2
  v_dot2c_f32_bf16 v121, v29, v3
  v_dot2c_f32_bf16 v122, v30, v2
  v_dot2c_f32_bf16 v123, v30, v3
  v_dot2c_f32_bf16 v124, v31, v2
  v_dot2c_f32_bf16 v125, v31, v3
  v_dot2c_f32_bf16 v126, v32, v2
  v_dot2c_f32_bf16 v127, v32, v3
  v_dot2c_f32_bf16 v128, v33, v2
  v_dot2c_f32_bf16 v129, v33, v3
  v_cvt_pk_bf16_f32 v0, v102, v214
  v_cvt_pk_bf16_f32 v1, v214, v102
  v_dot2c_f32_bf16 v112, v34, v0
  v_dot2c_f32_bf16 v113, v34, v1
  v_dot2c_f32_bf16 v114, v35, v0
  v_dot2c_f32_bf16 v115, v35, v1
  v_dot2c_f32_bf16 v116, v36, v0
  v_dot2c_f32_bf16 v117, v36, v1
  v_dot2c_f32_bf16 v118, v37, v0
  v_dot2c_f32_bf16 v119, v37, v1
  v_dot2c_f32_bf16 v120, v38, v0
  v_dot2c_f32_bf16 v121, v38, v1
  v_dot2c_f32_bf16 v122, v39, v0
  v_dot2c_f32_bf16 v123, v39, v1
  v_dot2c_f32_bf16 v124, v40, v0
  v_dot2c_f32_bf16 v125, v40, v1
  v_dot2c_f32_bf16 v126, v41, v0
  v_dot2c_f32_bf16 v127, v41, v1
  v_dot2c_f32_bf16 v128, v42, v0
  v_dot2c_f32_bf16 v129, v42, v1
  v_cvt_pk_bf16_f32 v2, v103, v214
  v_cvt_pk_bf16_f32 v3, v214, v103
  v_dot2c_f32_bf16 v112, v43, v2
  v_dot2c_f32_bf16 v113, v43, v3
  v_dot2c_f32_bf16 v114, v44, v2
  v_dot2c_f32_bf16 v115, v44, v3
  v_dot2c_f32_bf16 v116, v45, v2
  v_dot2c_f32_bf16 v117, v45, v3
  v_dot2c_f32_bf16 v118, v46, v2
  v_dot2c_f32_bf16 v119, v46, v3
  v_dot2c_f32_bf16 v120, v47, v2
  v_dot2c_f32_bf16 v121, v47, v3
  v_dot2c_f32_bf16 v122, v48, v2
  v_dot2c_f32_bf16 v123, v48, v3
  v_dot2c_f32_bf16 v124, v49, v2
  v_dot2c_f32_bf16 v125, v49, v3
  v_dot2c_f32_bf16 v126, v50, v2
  v_dot2c_f32_bf16 v127, v50, v3
  v_dot2c_f32_bf16 v128, v51, v2
  v_dot2c_f32_bf16 v129, v51, v3
  v_cvt_pk_bf16_f32 v0, v104, v214
  v_cvt_pk_bf16_f32 v1, v214, v104
  v_dot2c_f32_bf16 v112, v52, v0
  v_dot2c_f32_bf16 v113, v52, v1
  v_dot2c_f32_bf16 v114, v53, v0
  v_dot2c_f32_bf16 v115, v53, v1
  v_dot2c_f32_bf16 v116, v54, v0
  v_dot2c_f32_bf16 v117, v54, v1
  v_dot2c_f32_bf16 v118, v55, v0
  v_dot2c_f32_bf16 v119, v55, v1
  v_dot2c_f32_bf16 v120, v56, v0
  v_dot2c_f32_bf16 v121, v56, v1
  v_dot2c_f32_bf16 v122, v57, v0
  v_dot2c_f32_bf16 v123, v57, v1
  v_dot2c_f32_bf16 v124, v58, v0
  v_dot2c_f32_bf16 v125, v58, v1
  v_dot2c_f32_bf16 v126, v59, v0
  v_dot2c_f32_bf16 v127, v59, v1
  v_dot2c_f32_bf16 v128, v60, v0
  v_dot2c_f32_bf16 v129, v60, v1
  v_cvt_pk_bf16_f32 v2, v105, v214
  v_cvt_pk_bf16_f32 v3, v214, v105
  v_dot2c_f32_bf16 v112, v61, v2
  v_dot2c_f32_bf16 v113, v61, v3
  v_dot2c_f32_bf16 v114, v62, v2
  v_dot2c_f32_bf16 v115, v62, v3
  v_dot2c_f32_bf16 v116, v63, v2
  v_dot2c_f32_bf16 v117, v63, v3
  v_dot2c_f32_bf16 v118, v64, v2
  v_dot2c_f32_bf16 v119, v64, v3
  v_dot2c_f32_bf16 v120, v65, v2
  v_dot2c_f32_bf16 v121, v65, v3
  v_dot2c_f32_bf16 v122, v66, v2
  v_dot2c_f32_bf16 v123, v66, v3
  v_dot2c_f32_bf16 v124, v67, v2
  v_dot2c_f32_bf16 v125, v67, v3
  v_dot2c_f32_bf16 v126, v68, v2
  v_dot2c_f32_bf16 v127, v68, v3
  v_dot2c_f32_bf16 v128, v69, v2
  v_dot2c_f32_bf16 v129, v69, v3
  v_cvt_pk_bf16_f32 v0, v106, v214
  v_cvt_pk_bf16_f32 v1, v214, v106
  v_dot2c_f32_bf16 v112, v70, v0
  v_dot2c_f32_bf16 v113, v70, v1
  v_dot2c_f32_bf16 v114, v71, v0
  v_dot2c_f32_bf16 v115, v71, v1
  v_dot2c_f32_bf16 v116, v72, v0
  v_dot2c_f32_bf16 v117, v72, v1
  s_waitcnt lgkmcnt(14)
  v_dot2c_f32_bf16 v118, v73, v0
  v_dot2c_f32_bf16 v119, v73, v1
  s_waitcnt lgkmcnt(13)
  v_dot2c_f32_bf16 v120, v74, v0
  v_dot2c_f32_bf16 v121, v74, v1
  s_waitcnt lgkmcnt(12)
  v_dot2c_f32_bf16 v122, v75, v0
  v_dot2c_f32_bf16 v123, v75, v1
  s_waitcnt lgkmcnt(11)
  v_dot2c_f32_bf16 v124, v76, v0
  v_dot2c_f32_bf16 v125, v76, v1
  s_waitcnt lgkmcnt(10)
  v_dot2c_f32_bf16 v126, v77, v0
  v_dot2c_f32_bf16 v127, v77, v1
  s_waitcnt lgkmcnt(9)
  v_dot2c_f32_bf16 v128, v78, v0
  v_dot2c_f32_bf16 v129, v78, v1
  v_cvt_pk_bf16_f32 v2, v107, v214
  v_cvt_pk_bf16_f32 v3, v214, v107
  s_waitcnt lgkmcnt(8)
  v_dot2c_f32_bf16 v112, v79, v2
  v_dot2c_f32_bf16 v113, v79, v3
  s_waitcnt lgkmcnt(7)
  v_dot2c_f32_bf16 v114, v80, v2
  v_dot2c_f32_bf16 v115, v80, v3
  s_waitcnt lgkmcnt(6)
  v_dot2c_f32_bf16 v116, v81, v2
  v_dot2c_f32_bf16 v117, v81, v3
  s_waitcnt lgkmcnt(5)
  v_dot2c_f32_bf16 v118, v82, v2
  v_dot2c_f32_bf16 v119, v82, v3
  s_waitcnt lgkmcnt(4)
  v_dot2c_f32_bf16 v120, v83, v2
  v_dot2c_f32_bf16 v121, v83, v3
  s_waitcnt lgkmcnt(3)
  v_dot2c_f32_bf16 v122, v84, v2
  v_dot2c_f32_bf16 v123, v84, v3
  s_waitcnt lgkmcnt(2)
  v_dot2c_f32_bf16 v124, v85, v2
  v_dot2c_f32_bf16 v125, v85, v3
  s_waitcnt lgkmcnt(1)
  v_dot2c_f32_bf16 v126, v86, v2
  v_dot2c_f32_bf16 v127, v86, v3
  s_waitcnt lgkmcnt(0)
  v_dot2c_f32_bf16 v128, v87, v2
  v_dot2c_f32_bf16 v129, v87, v3
  v_cvt_pk_bf16_f32 v132, v112, v113
  v_cvt_pk_bf16_f32 v133, v114, v115
  v_cvt_pk_bf16_f32 v134, v116, v117
  v_cvt_pk_bf16_f32 v135, v118, v119
  v_cvt_pk_bf16_f32 v136, v120, v121
  v_cvt_pk_bf16_f32 v137, v122, v123
  v_cvt_pk_bf16_f32 v138, v124, v125
  v_cvt_pk_bf16_f32 v139, v126, v127
  v_cvt_pk_bf16_f32 v140, v128, v129
  buffer_store_dwordx4 v[132:135], v220, s[8:11], s64 offen sc1
  buffer_store_dwordx4 v[136:139], v220, s[8:11], s64 offen offset:16 sc1
  buffer_store_dword v140, v220, s[8:11], s64 offen offset:32 sc1
  s_mov_b32 s56, 36
  s_waitcnt vmcnt(0)
  s_barrier
  s_cmp_eq_u32 s52, 0
  s_cbranch_scc0 A_sig
  v_mov_b32 v211, 1
  v_mov_b32 v212, 0
  s_mov_b64 exec, 1
  buffer_atomic_add v211, v212, s[12:15], s56 offen
  s_mov_b64 exec, -1
A_sig:
  s_cmp_lt_u32 s53, 172
  s_cbranch_scc0 L_exit
  s_sub_u32 s54, s53, 64
  s_mul_i32 s55, s54, 3641
  s_lshr_b32 s55, s55, 16
  s_mul_i32 s56, s55, 18
  s_sub_u32 s70, s54, s56
  s_and_b32 s69, s55, 1
  s_lshr_b32 s68, s55, 1
  v_lshrrev_b32 v211, 2, v200
  v_mul_u32_u24 v211, 1152, v211
  v_and_b32 v212, 3, v200
  v_lshl_add_u32 v207, v212, 4, v211
  s_lshl_b32 s54, s70, 6
  s_mul_i32 s55, s52, 1179648
  s_add_u32 s62, s54, s55
  s_mul_i32 s55, s52, 184320
  s_add_u32 s63, s54, s55
  s_mul_i32 s61, s52, 40960
  v_bfe_u32 v211, v200, 2, 2
  v_lshlrev_b32 v212, 4, v212
  v_add_u32 v212, s61, v212
  v_lshl_add_u32 v212, v211, 6, v212
  v_lshrrev_b32 v213, 4, v200
  v_lshl_add_u32 v210, v213, 9, v212
  v_lshrrev_b32 v214, 5, v200
  v_lshl_add_u32 v209, v214, 10, v212
  v_and_b32 v214, 1, v213
  v_lshl_add_u32 v209, v214, 8, v209
  s_add_u32 m0, s61, 0
  s_add_u32 s54, s62, 0
  buffer_load_dwordx4 v207, s[28:31], s54 offen lds
  s_add_u32 m0, s61, 1024
  s_add_u32 s54, s62, 18432
  buffer_load_dwordx4 v207, s[28:31], s54 offen lds
  s_add_u32 m0, s61, 2048
  s_add_u32 s54, s62, 36864
  buffer_load_dwordx4 v207, s[28:31], s54 offen lds
  s_add_u32 m0, s61, 3072
  s_add_u32 s54, s62, 55296
  buffer_load_dwordx4 v207, s[28:31], s54 offen lds
  s_add_u32 m0, s61, 4096
  s_add_u32 s54, s62, 73728
  buffer_load_dwordx4 v207, s[28:31], s54 offen lds
  s_add_u32 m0, s61, 5120
  s_add_u32 s54, s62, 92160
  buffer_load_dwordx4 v207, s[28:31], s54 offen lds
  s_add_u32 m0, s61, 6144
  s_add_u32 s54, s62, 110592
  buffer_load_dwordx4 v207, s[28:31], s54 offen lds
  s_add_u32 m0, s61, 7168
  s_add_u32 s54, s62, 129024
  buffer_load_dwordx4 v207, s[28:31], s54 offen lds
  s_add_u32 m0, s61, 8192
  s_add_u32 s54, s62, 147456
  buffer_load_dwordx4 v207, s[28:31], s54 offen lds
  s_add_u32 m0, s61, 9216
  s_add_u32 s54, s62, 165888
  buffer_load_dwordx4 v207, s[28:31], s54 offen lds
  s_add_u32 m0, s61, 10240
  s_add_u32 s54, s62, 184320
  buffer_load_dwordx4 v207, s[28:31], s54 offen lds
  s_add_u32 m0, s61, 11264
  s_add_u32 s54, s62, 202752
  buffer_load_dwordx4 v207, s[28:31], s54 offen lds
  s_add_u32 m0, s61, 12288
  s_add_u32 s54, s62, 221184
  buffer_load_dwordx4 v207, s[28:31], s54 offen lds
  s_add_u32 m0, s61, 13312
  s_add_u32 s54, s62, 239616
  buffer_load_dwordx4 v207, s[28:31], s54 offen lds
  s_add_u32 m0, s61, 14336
  s_add_u32 s54, s62, 258048
  buffer_load_dwordx4 v207, s[28:31], s54 offen lds
  s_add_u32 m0, s61, 15360
  s_add_u32 s54, s62, 276480
  buffer_load_dwordx4 v207, s[28:31], s54 offen lds
  s_add_u32 m0, s61, 16384
  s_add_u32 s54, s62, 294912
  buffer_load_dwordx4 v207, s[28:31], s54 offen lds
  s_add_u32 m0, s61, 17408
  s_add_u32 s54, s62, 313344
  buffer_load_dwordx4 v207, s[28:31], s54 offen lds
  s_add_u32 m0, s61, 18432
  s_add_u32 s54, s62, 331776
  buffer_load_dwordx4 v207, s[28:31], s54 offen lds
  s_add_u32 m0, s61, 19456
  s_add_u32 s54, s62, 350208
  buffer_load_dwordx4 v207, s[28:31], s54 offen lds
  s_add_u32 m0, s61, 20480
  s_add_u32 s54, s62, 368640
  buffer_load_dwordx4 v207, s[28:31], s54 offen lds
  s_add_u32 m0, s61, 21504
  s_add_u32 s54, s62, 387072
  buffer_load_dwordx4 v207, s[28:31], s54 offen lds
  s_add_u32 m0, s61, 22528
  s_add_u32 s54, s62, 405504
  buffer_load_dwordx4 v207, s[28:31], s54 offen lds
  s_add_u32 m0, s61, 23552
  s_add_u32 s54, s62, 423936
  buffer_load_dwordx4 v207, s[28:31], s54 offen lds
  s_add_u32 m0, s61, 24576
  s_add_u32 s54, s62, 442368
  buffer_load_dwordx4 v207, s[28:31], s54 offen lds
  s_add_u32 m0, s61, 25600
  s_add_u32 s54, s62, 460800
  buffer_load_dwordx4 v207, s[28:31], s54 offen lds
  s_add_u32 m0, s61, 26624
  s_add_u32 s54, s62, 479232
  buffer_load_dwordx4 v207, s[28:31], s54 offen lds
  s_add_u32 m0, s61, 27648
  s_add_u32 s54, s62, 497664
  buffer_load_dwordx4 v207, s[28:31], s54 offen lds
  s_add_u32 m0, s61, 28672
  s_add_u32 s54, s62, 516096
  buffer_load_dwordx4 v207, s[28:31], s54 offen lds
  s_add_u32 m0, s61, 29696
  s_add_u32 s54, s62, 534528
  buffer_load_dwordx4 v207, s[28:31], s54 offen lds
  s_add_u32 m0, s61, 30720
  s_add_u32 s54, s62, 552960
  buffer_load_dwordx4 v207, s[28:31], s54 offen lds
  s_add_u32 m0, s61, 31744
  s_add_u32 s54, s62, 571392
  buffer_load_dwordx4 v207, s[28:31], s54 offen lds
  s_add_u32 m0, s61, 32768
  s_add_u32 s54, s62, 589824
  buffer_load_dwordx4 v207, s[28:31], s54 offen lds
  s_add_u32 m0, s61, 33792
  s_add_u32 s54, s62, 608256
  buffer_load_dwordx4 v207, s[28:31], s54 offen lds
  s_add_u32 m0, s61, 34816
  s_add_u32 s54, s62, 626688
  buffer_load_dwordx4 v207, s[28:31], s54 offen lds
  s_add_u32 m0, s61, 35840
  s_add_u32 s54, s62, 645120
  buffer_load_dwordx4 v207, s[28:31], s54 offen lds
  s_add_u32 m0, s61, 36864
  s_add_u32 s54, s62, 663552
  buffer_load_dwordx4 v207, s[28:31], s54 offen lds
  s_add_u32 m0, s61, 37888
  s_add_u32 s54, s62, 681984
  buffer_load_dwordx4 v207, s[28:31], s54 offen lds
  s_waitcnt vmcnt(36) lgkmcnt(0)
  s_add_u32 m0, s61, 38912
  s_add_u32 s54, s62, 700416
  buffer_load_dwordx4 v207, s[28:31], s54 offen lds
  s_add_u32 m0, s61, 39936
  s_add_u32 s54, s62, 718848
  buffer_load_dwordx4 v207, s[28:31], s54 offen lds
  ds_read_b64_tr_b16 a[0:1], v209 offset:0
  ds_read_b64_tr_b16 a[2:3], v209 offset:512
  ds_read_b64_tr_b16 a[4:5], v209 offset:8
  ds_read_b64_tr_b16 a[6:7], v209 offset:520
  s_waitcnt vmcnt(36) lgkmcnt(0)
  s_add_u32 m0, s61, 0
  s_add_u32 s54, s62, 737280
  buffer_load_dwordx4 v207, s[28:31], s54 offen lds
  s_add_u32 m0, s61, 1024
  s_add_u32 s54, s62, 755712
  buffer_load_dwordx4 v207, s[28:31], s54 offen lds
  ds_read_b64_tr_b16 a[8:9], v209 offset:2048
  ds_read_b64_tr_b16 a[10:11], v209 offset:2560
  ds_read_b64_tr_b16 a[12:13], v209 offset:2056
  ds_read_b64_tr_b16 a[14:15], v209 offset:2568
  s_waitcnt vmcnt(36) lgkmcnt(0)
  s_add_u32 m0, s61, 2048
  s_add_u32 s54, s62, 774144
  buffer_load_dwordx4 v207, s[28:31], s54 offen lds
  s_add_u32 m0, s61, 3072
  s_add_u32 s54, s62, 792576
  buffer_load_dwordx4 v207, s[28:31], s54 offen lds
  ds_read_b64_tr_b16 a[16:17], v209 offset:4096
  ds_read_b64_tr_b16 a[18:19], v209 offset:4608
  ds_read_b64_tr_b16 a[20:21], v209 offset:4104
  ds_read_b64_tr_b16 a[22:23], v209 offset:4616
  s_waitcnt vmcnt(36) lgkmcnt(0)
  s_add_u32 m0, s61, 4096
  s_add_u32 s54, s62, 811008
  buffer_load_dwordx4 v207, s[28:31], s54 offen lds
  s_add_u32 m0, s61, 5120
  s_add_u32 s54, s62, 829440
  buffer_load_dwordx4 v207, s[28:31], s54 offen lds
  ds_read_b64_tr_b16 a[24:25], v209 offset:6144
  ds_read_b64_tr_b16 a[26:27], v209 offset:6656
  ds_read_b64_tr_b16 a[28:29], v209 offset:6152
  ds_read_b64_tr_b16 a[30:31], v209 offset:6664
  s_waitcnt vmcnt(36) lgkmcnt(0)
  s_add_u32 m0, s61, 6144
  s_add_u32 s54, s62, 847872
  buffer_load_dwordx4 v207, s[28:31], s54 offen lds
  s_add_u32 m0, s61, 7168
  s_add_u32 s54, s62, 866304
  buffer_load_dwordx4 v207, s[28:31], s54 offen lds
  ds_read_b64_tr_b16 a[32:33], v209 offset:8192
  ds_read_b64_tr_b16 a[34:35], v209 offset:8704
  ds_read_b64_tr_b16 a[36:37], v209 offset:8200
  ds_read_b64_tr_b16 a[38:39], v209 offset:8712
  s_waitcnt vmcnt(36) lgkmcnt(0)
  s_add_u32 m0, s61, 8192
  s_add_u32 s54, s62, 884736
  buffer_load_dwordx4 v207, s[28:31], s54 offen lds
  s_add_u32 m0, s61, 9216
  s_add_u32 s54, s62, 903168
  buffer_load_dwordx4 v207, s[28:31], s54 offen lds
  ds_read_b64_tr_b16 a[40:41], v209 offset:10240
  ds_read_b64_tr_b16 a[42:43], v209 offset:10752
  ds_read_b64_tr_b16 a[44:45], v209 offset:10248
  ds_read_b64_tr_b16 a[46:47], v209 offset:10760
  s_waitcnt vmcnt(36) lgkmcnt(0)
  s_add_u32 m0, s61, 10240
  s_add_u32 s54, s62, 921600
  buffer_load_dwordx4 v207, s[28:31], s54 offen lds
  s_add_u32 m0, s61, 11264
  s_add_u32 s54, s62, 940032
  buffer_load_dwordx4 v207, s[28:31], s54 offen lds
  ds_read_b64_tr_b16 a[48:49], v209 offset:12288
  ds_read_b64_tr_b16 a[50:51], v209 offset:12800
  ds_read_b64_tr_b16 a[52:53], v209 offset:12296
  ds_read_b64_tr_b16 a[54:55], v209 offset:12808
  s_waitcnt vmcnt(36) lgkmcnt(0)
  s_add_u32 m0, s61, 12288
  s_add_u32 s54, s62, 958464
  buffer_load_dwordx4 v207, s[28:31], s54 offen lds
  s_add_u32 m0, s61, 13312
  s_add_u32 s54, s62, 976896
  buffer_load_dwordx4 v207, s[28:31], s54 offen lds
  ds_read_b64_tr_b16 a[56:57], v209 offset:14336
  ds_read_b64_tr_b16 a[58:59], v209 offset:14848
  ds_read_b64_tr_b16 a[60:61], v209 offset:14344
  ds_read_b64_tr_b16 a[62:63], v209 offset:14856
  s_waitcnt vmcnt(36) lgkmcnt(0)
  s_add_u32 m0, s61, 14336
  s_add_u32 s54, s62, 995328
  buffer_load_dwordx4 v207, s[28:31], s54 offen lds
  s_add_u32 m0, s61, 15360
  s_add_u32 s54, s62, 1013760
  buffer_load_dwordx4 v207, s[28:31], s54 offen lds
  ds_read_b64_tr_b16 a[64:65], v209 offset:16384
  ds_read_b64_tr_b16 a[66:67], v209 offset:16896
  ds_read_b64_tr_b16 a[68:69], v209 offset:16392
  ds_read_b64_tr_b16 a[70:71], v209 offset:16904
  s_waitcnt vmcnt(36) lgkmcnt(0)
  s_add_u32 m0, s61, 16384
  s_add_u32 s54, s62, 1032192
  buffer_load_dwordx4 v207, s[28:31], s54 offen lds
  s_add_u32 m0, s61, 17408
  s_add_u32 s54, s62, 1050624
  buffer_load_dwordx4 v207, s[28:31], s54 offen lds
  ds_read_b64_tr_b16 a[72:73], v209 offset:18432
  ds_read_b64_tr_b16 a[74:75], v209 offset:18944
  ds_read_b64_tr_b16 a[76:77], v209 offset:18440
  ds_read_b64_tr_b16 a[78:79], v209 offset:18952
  s_waitcnt vmcnt(36) lgkmcnt(0)
  s_add_u32 m0, s61, 18432
  s_add_u32 s54, s62, 1069056
  buffer_load_dwordx4 v207, s[28:31], s54 offen lds
  s_add_u32 m0, s61, 19456
  s_add_u32 s54, s62, 1087488
  buffer_load_dwordx4 v207, s[28:31], s54 offen lds
  ds_read_b64_tr_b16 a[80:81], v209 offset:20480
  ds_read_b64_tr_b16 a[82:83], v209 offset:20992
  ds_read_b64_tr_b16 a[84:85], v209 offset:20488
  ds_read_b64_tr_b16 a[86:87], v209 offset:21000
  s_waitcnt vmcnt(36) lgkmcnt(0)
  s_add_u32 m0, s61, 20480
  s_add_u32 s54, s62, 1105920
  buffer_load_dwordx4 v207, s[28:31], s54 offen lds
  s_add_u32 m0, s61, 21504
  s_add_u32 s54, s62, 1124352
  buffer_load_dwordx4 v207, s[28:31], s54 offen lds
  ds_read_b64_tr_b16 a[88:89], v209 offset:22528
  ds_read_b64_tr_b16 a[90:91], v209 offset:23040
  ds_read_b64_tr_b16 a[92:93], v209 offset:22536
  ds_read_b64_tr_b16 a[94:95], v209 offset:23048
  s_waitcnt vmcnt(36) lgkmcnt(0)
  s_add_u32 m0, s61, 22528
  s_add_u32 s54, s62, 1142784
  buffer_load_dwordx4 v207, s[28:31], s54 offen lds
  s_add_u32 m0, s61, 23552
  s_add_u32 s54, s62, 1161216
  buffer_load_dwordx4 v207, s[28:31], s54 offen lds
  ds_read_b64_tr_b16 a[96:97], v209 offset:24576
  ds_read_b64_tr_b16 a[98:99], v209 offset:25088
  ds_read_b64_tr_b16 a[100:101], v209 offset:24584
  ds_read_b64_tr_b16 a[102:103], v209 offset:25096
  s_waitcnt vmcnt(36) lgkmcnt(0)
  s_add_u32 m0, s61, 24576
  s_add_u32 s54, s63, 0
  buffer_load_dwordx4 v207, s[40:43], s54 offen lds
  s_add_u32 m0, s61, 25600
  s_add_u32 s54, s63, 18432
  buffer_load_dwordx4 v207, s[40:43], s54 offen lds
  ds_read_b64_tr_b16 a[104:105], v209 offset:26624
  ds_read_b64_tr_b16 a[106:107], v209 offset:27136
  ds_read_b64_tr_b16 a[108:109], v209 offset:26632
  ds_read_b64_tr_b16 a[110:111], v209 offset:27144
  s_waitcnt vmcnt(36) lgkmcnt(0)
  s_add_u32 m0, s61, 26624
  s_add_u32 s54, s63, 36864
  buffer_load_dwordx4 v207, s[40:43], s54 offen lds
  s_add_u32 m0, s61, 27648
  s_add_u32 s54, s63, 55296
  buffer_load_dwordx4 v207, s[40:43], s54 offen lds
  ds_read_b64_tr_b16 a[112:113], v209 offset:28672
  ds_read_b64_tr_b16 a[114:115], v209 offset:29184
  ds_read_b64_tr_b16 a[116:117], v209 offset:28680
  ds_read_b64_tr_b16 a[118:119], v209 offset:29192
  s_waitcnt vmcnt(36) lgkmcnt(0)
  s_add_u32 m0, s61, 28672
  s_add_u32 s54, s63, 73728
  buffer_load_dwordx4 v207, s[40:43], s54 offen lds
  s_add_u32 m0, s61, 29696
  s_add_u32 s54, s63, 92160
  buffer_load_dwordx4 v207, s[40:43], s54 offen lds
  ds_read_b64_tr_b16 a[120:121], v209 offset:30720
  ds_read_b64_tr_b16 a[122:123], v209 offset:31232
  ds_read_b64_tr_b16 a[124:125], v209 offset:30728
  ds_read_b64_tr_b16 a[126:127], v209 offset:31240
  s_waitcnt vmcnt(36) lgkmcnt(0)
  s_add_u32 m0, s61, 30720
  s_add_u32 s54, s63, 110592
  buffer_load_dwordx4 v207, s[40:43], s54 offen lds
  s_add_u32 m0, s61, 31744
  s_add_u32 s54, s63, 129024
  buffer_load_dwordx4 v207, s[40:43], s54 offen lds
  ds_read_b64_tr_b16 a[128:129], v209 offset:32768
  ds_read_b64_tr_b16 a[130:131], v209 offset:33280
  ds_read_b64_tr_b16 a[132:133], v209 offset:32776
  ds_read_b64_tr_b16 a[134:135], v209 offset:33288
  s_waitcnt vmcnt(36) lgkmcnt(0)
  s_add_u32 m0, s61, 32768
  s_add_u32 s54, s63, 147456
  buffer_load_dwordx4 v207, s[40:43], s54 offen lds
  s_add_u32 m0, s61, 33792
  s_add_u32 s54, s63, 165888
  buffer_load_dwordx4 v207, s[40:43], s54 offen lds
  ds_read_b64_tr_b16 a[136:137], v209 offset:34816
  ds_read_b64_tr_b16 a[138:139], v209 offset:35328
  ds_read_b64_tr_b16 a[140:141], v209 offset:34824
  ds_read_b64_tr_b16 a[142:143], v209 offset:35336
  s_waitcnt vmcnt(36) lgkmcnt(0)
  ds_read_b64_tr_b16 a[144:145], v209 offset:36864
  ds_read_b64_tr_b16 a[146:147], v209 offset:37376
  ds_read_b64_tr_b16 a[148:149], v209 offset:36872
  ds_read_b64_tr_b16 a[150:151], v209 offset:37384
  s_waitcnt vmcnt(34) lgkmcnt(0)
  ds_read_b64_tr_b16 a[152:153], v209 offset:38912
  ds_read_b64_tr_b16 a[154:155], v209 offset:39424
  ds_read_b64_tr_b16 a[156:157], v209 offset:38920
  ds_read_b64_tr_b16 a[158:159], v209 offset:39432
  s_waitcnt vmcnt(32) lgkmcnt(0)
  ds_read_b64_tr_b16 a[160:161], v209 offset:0
  ds_read_b64_tr_b16 a[162:163], v209 offset:512
  ds_read_b64_tr_b16 a[164:165], v209 offset:8
  ds_read_b64_tr_b16 a[166:167], v209 offset:520
  s_waitcnt vmcnt(30) lgkmcnt(0)
  ds_read_b64_tr_b16 a[168:169], v209 offset:2048
  ds_read_b64_tr_b16 a[170:171], v209 offset:2560
  ds_read_b64_tr_b16 a[172:173], v209 offset:2056
  ds_read_b64_tr_b16 a[174:175], v209 offset:2568
  s_waitcnt vmcnt(28) lgkmcnt(0)
  ds_read_b64_tr_b16 a[176:177], v209 offset:4096
  ds_read_b64_tr_b16 a[178:179], v209 offset:4608
  ds_read_b64_tr_b16 a[180:181], v209 offset:4104
  ds_read_b64_tr_b16 a[182:183], v209 offset:4616
  s_waitcnt vmcnt(26) lgkmcnt(0)
  ds_read_b64_tr_b16 a[184:185], v209 offset:6144
  ds_read_b64_tr_b16 a[186:187], v209 offset:6656
  ds_read_b64_tr_b16 a[188:189], v209 offset:6152
  ds_read_b64_tr_b16 a[190:191], v209 offset:6664
  s_waitcnt vmcnt(24) lgkmcnt(0)
  ds_read_b64_tr_b16 a[192:193], v209 offset:8192
  ds_read_b64_tr_b16 a[194:195], v209 offset:8704
  ds_read_b64_tr_b16 a[196:197], v209 offset:8200
  ds_read_b64_tr_b16 a[198:199], v209 offset:8712
  s_waitcnt vmcnt(22) lgkmcnt(0)
  ds_read_b64_tr_b16 a[200:201], v209 offset:10240
  ds_read_b64_tr_b16 a[202:203], v209 offset:10752
  ds_read_b64_tr_b16 a[204:205], v209 offset:10248
  ds_read_b64_tr_b16 a[206:207], v209 offset:10760
  s_waitcnt vmcnt(20) lgkmcnt(0)
  ds_read_b64_tr_b16 a[208:209], v209 offset:12288
  ds_read_b64_tr_b16 a[210:211], v209 offset:12800
  ds_read_b64_tr_b16 a[212:213], v209 offset:12296
  ds_read_b64_tr_b16 a[214:215], v209 offset:12808
  s_waitcnt vmcnt(18) lgkmcnt(0)
  ds_read_b64_tr_b16 a[216:217], v209 offset:14336
  ds_read_b64_tr_b16 a[218:219], v209 offset:14848
  ds_read_b64_tr_b16 a[220:221], v209 offset:14344
  ds_read_b64_tr_b16 a[222:223], v209 offset:14856
  s_waitcnt vmcnt(16) lgkmcnt(0)
  ds_read_b64_tr_b16 a[224:225], v209 offset:16384
  ds_read_b64_tr_b16 a[226:227], v209 offset:16896
  ds_read_b64_tr_b16 a[228:229], v209 offset:16392
  ds_read_b64_tr_b16 a[230:231], v209 offset:16904
  s_waitcnt vmcnt(14) lgkmcnt(0)
  ds_read_b64_tr_b16 a[232:233], v209 offset:18432
  ds_read_b64_tr_b16 a[234:235], v209 offset:18944
  ds_read_b64_tr_b16 a[236:237], v209 offset:18440
  ds_read_b64_tr_b16 a[238:239], v209 offset:18952
  s_waitcnt vmcnt(12) lgkmcnt(0)
  ds_read_b64_tr_b16 a[240:241], v209 offset:20480
  ds_read_b64_tr_b16 a[242:243], v209 offset:20992
  ds_read_b64_tr_b16 a[244:245], v209 offset:20488
  ds_read_b64_tr_b16 a[246:247], v209 offset:21000
  s_waitcnt vmcnt(10) lgkmcnt(0)
  ds_read_b64_tr_b16 a[248:249], v209 offset:22528
  ds_read_b64_tr_b16 a[250:251], v209 offset:23040
  ds_read_b64_tr_b16 a[252:253], v209 offset:22536
  ds_read_b64_tr_b16 a[254:255], v209 offset:23048
  s_waitcnt vmcnt(8) lgkmcnt(0)
  ds_read_b64_tr_b16 v[216:217], v210 offset:24576
  ds_read_b64_tr_b16 v[218:219], v210 offset:24832
  ds_read_b64_tr_b16 v[220:221], v210 offset:24584
  ds_read_b64_tr_b16 v[222:223], v210 offset:24840
  s_waitcnt vmcnt(6) lgkmcnt(0)
  ds_read_b64_tr_b16 v[224:225], v210 offset:26624
  ds_read_b64_tr_b16 v[226:227], v210 offset:26880
  ds_read_b64_tr_b16 v[228:229], v210 offset:26632
  ds_read_b64_tr_b16 v[230:231], v210 offset:26888
  s_waitcnt vmcnt(4) lgkmcnt(0)
  ds_read_b64_tr_b16 v[232:233], v210 offset:28672
  ds_read_b64_tr_b16 v[234:235], v210 offset:28928
  ds_read_b64_tr_b16 v[236:237], v210 offset:28680
  ds_read_b64_tr_b16 v[238:239], v210 offset:28936
  s_waitcnt vmcnt(2) lgkmcnt(0)
  ds_read_b64_tr_b16 v[240:241], v210 offset:30720
  ds_read_b64_tr_b16 v[242:243], v210 offset:30976
  ds_read_b64_tr_b16 v[244:245], v210 offset:30728
  ds_read_b64_tr_b16 v[246:247], v210 offset:30984
  s_waitcnt vmcnt(0) lgkmcnt(0)
  ds_read_b64_tr_b16 v[248:249], v210 offset:32768
  ds_read_b64_tr_b16 v[250:251], v210 offset:33024
  ds_read_b64_tr_b16 v[252:253], v210 offset:32776
  ds_read_b64_tr_b16 v[254:255], v210 offset:33032
  v_and_b32 v211, 15, v200
  s_lshl_b32 s54, s69, 4
  v_add_u32 v211, s54, v211
  v_lshl_add_u32 v212, v214, 5, v211
  v_lshlrev_b32 v164, 4, v212
  v_lshrrev_b32 v212, 5, v200
  v_lshl_add_u32 v164, v212, 10, v164
  v_mul_u32_u24 v167, 1152, v211
  v_lshl_add_u32 v167, v213, 4, v167
  v_lshlrev_b32 v166, 2, v211
  v_lshlrev_b32 v208, 2, v200
  s_lshl_b32 s54, s52, 11
  v_add_u32 v168, s54, v201
  s_mov_b32 s59, s68
  s_mov_b32 s56, 128
  s_mov_b32 s57, 36
  s_waitcnt lgkmcnt(0)
  s_cmp_eq_u32 s52, 0
  s_cbranch_scc0 O_p1_d
  s_mov_b32 exec_hi, 0
  s_mov_b32 exec_lo, -1
O_p1:
  buffer_load_dword v211, v208, s[12:15], s56 offen sc1
  s_add_u32 s65, s65, 1
  s_waitcnt vmcnt(0)
  v_cmp_gt_u32 vcc, 0x700, v211
  s_cbranch_vccz O_p1_x
  s_sleep 16
  s_cmp_lt_u32 s65, 131072
  s_cbranch_scc1 O_p1
O_p1_x:
  s_mov_b64 exec, -1
O_p1_d:
  s_barrier
  s_cmp_eq_u32 s52, 0
  s_cbranch_scc0 O_a_d
  s_mov_b32 exec_hi, 0
  s_mov_b32 exec_lo, 1
O_a:
  buffer_load_dword v211, v208, s[12:15], s57 offen sc1
  s_add_u32 s65, s65, 1
  s_waitcnt vmcnt(0)
  v_cmp_gt_u32 vcc, 0x80, v211
  s_cbranch_vccz O_a_x
  s_sleep 16
  s_cmp_lt_u32 s65, 131072
  s_cbranch_scc1 O_a
O_a_x:
  s_mov_b64 exec, -1
O_a_d:
  s_barrier
  s_mul_i32 s55, s59, 36864
  s_mul_i32 s54, s52, 320
  s_add_u32 s55, s55, s54
  s_add_u32 s55, s55, 62914560
  s_cmp_eq_u32 s52, 3
  s_cselect_b32 s56, 268435456, s55
  buffer_load_dwordx4 v[128:131], v167, s[8:11], s55 offen offset:0 sc1
  buffer_load_dwordx4 v[132:135], v167, s[8:11], s55 offen offset:64 sc1
  buffer_load_dwordx4 v[136:139], v167, s[8:11], s55 offen offset:128 sc1
  buffer_load_dwordx4 v[140:143], v167, s[8:11], s56 offen offset:192 sc1
  buffer_load_dwordx4 v[144:147], v167, s[8:11], s56 offen offset:256 sc1
  s_lshl_b32 s55, s59, 7
  s_add_u32 s55, s55, 66060288
  buffer_load_dword v171, v166, s[8:11], s55 offen sc1
  v_mov_b32 v169, 0
  s_mov_b32 s66, 356352
  s_waitcnt vmcnt(0)
O_loop:
  v_mfma_f32_16x16x32_bf16 v[156:159], v[216:219], v[128:131], 0
  v_mfma_f32_16x16x32_bf16 v[160:163], v[220:223], v[128:131], 0
  v_mfma_f32_16x16x32_bf16 v[156:159], v[224:227], v[132:135], v[156:159]
  v_mfma_f32_16x16x32_bf16 v[160:163], v[228:231], v[132:135], v[160:163]
  v_mfma_f32_16x16x32_bf16 v[156:159], v[232:235], v[136:139], v[156:159]
  v_mfma_f32_16x16x32_bf16 v[160:163], v[236:239], v[136:139], v[160:163]
  v_mfma_f32_16x16x32_bf16 v[156:159], v[240:243], v[140:143], v[156:159]
  v_mfma_f32_16x16x32_bf16 v[160:163], v[244:247], v[140:143], v[160:163]
  v_mfma_f32_16x16x32_bf16 v[156:159], v[248:251], v[144:147], v[156:159]
  v_mfma_f32_16x16x32_bf16 v[160:163], v[252:255], v[144:147], v[160:163]
  s_mul_i32 s64, s59, 36864
  s_lshl_b32 s54, s70, 6
  s_add_u32 s64, s64, s54
  s_add_u32 s71, s59, 2
  s_lshl_b32 s55, s59, 18
  s_lshl_b32 s54, s52, 16
  s_add_u32 s55, s55, s54
  s_add_u32 s63, s55, 46137344
  s_and_b32 s54, s59, 1
  s_lshl_b32 s54, s54, 2
  s_add_u32 s54, s54, s52
  s_lshl_b32 s54, s54, 3
  s_lshl_b64 s[72:73], 0xff, s54
  v_sub_f32 v165, 1.0, v171
  v_cvt_pk_bf16_f32 v165, v165, v165
  v_lshlrev_b32 v165, 16, v165
  v_mul_f32 v156, v171, v156
  v_mul_f32 v157, v171, v157
  v_mul_f32 v158, v171, v158
  v_mul_f32 v159, v171, v159
  v_mul_f32 v160, v171, v160
  v_mul_f32 v161, v171, v161
  v_mul_f32 v162, v171, v162
  v_mul_f32 v163, v171, v163
  s_branch O_pc
O_pl:
  s_sleep 1
  buffer_load_dword v169, v208, s[8:11], s66 offen sc1
  s_add_u32 s65, s65, 1
  s_cmp_ge_u32 s65, 131072
  s_cbranch_scc1 O_ld
  s_waitcnt vmcnt(0)
O_pc:
  v_cmp_gt_u32 vcc, s71, v169
  s_nop 0
  s_and_b64 vcc, vcc, s[72:73]
  s_cbranch_scc1 O_pl
O_ld:
  s_mov_b32 s62, s63
  buffer_load_dwordx4 v[0:3], v164, s[8:11], s62 offen offset:0 sc1
  buffer_load_dwordx4 v[4:7], v164, s[8:11], s62 offen offset:2048 sc1
  s_add_u32 s62, s62, 4096
  buffer_load_dwordx4 v[8:11], v164, s[8:11], s62 offen offset:0 sc1
  buffer_load_dwordx4 v[12:15], v164, s[8:11], s62 offen offset:2048 sc1
  s_add_u32 s62, s62, 4096
  buffer_load_dwordx4 v[16:19], v164, s[8:11], s62 offen offset:0 sc1
  buffer_load_dwordx4 v[20:23], v164, s[8:11], s62 offen offset:2048 sc1
  s_add_u32 s62, s62, 4096
  buffer_load_dwordx4 v[24:27], v164, s[8:11], s62 offen offset:0 sc1
  buffer_load_dwordx4 v[28:31], v164, s[8:11], s62 offen offset:2048 sc1
  s_add_u32 s62, s62, 4096
  buffer_load_dwordx4 v[32:35], v164, s[8:11], s62 offen offset:0 sc1
  buffer_load_dwordx4 v[36:39], v164, s[8:11], s62 offen offset:2048 sc1
  s_add_u32 s62, s62, 4096
  buffer_load_dwordx4 v[40:43], v164, s[8:11], s62 offen offset:0 sc1
  buffer_load_dwordx4 v[44:47], v164, s[8:11], s62 offen offset:2048 sc1
  s_add_u32 s62, s62, 4096
  buffer_load_dwordx4 v[48:51], v164, s[8:11], s62 offen offset:0 sc1
  buffer_load_dwordx4 v[52:55], v164, s[8:11], s62 offen offset:2048 sc1
  s_add_u32 s62, s62, 4096
  buffer_load_dwordx4 v[56:59], v164, s[8:11], s62 offen offset:0 sc1
  buffer_load_dwordx4 v[60:63], v164, s[8:11], s62 offen offset:2048 sc1
  s_add_u32 s62, s62, 4096
  buffer_load_dwordx4 v[64:67], v164, s[8:11], s62 offen offset:0 sc1
  buffer_load_dwordx4 v[68:71], v164, s[8:11], s62 offen offset:2048 sc1
  s_add_u32 s62, s62, 4096
  buffer_load_dwordx4 v[72:75], v164, s[8:11], s62 offen offset:0 sc1
  buffer_load_dwordx4 v[76:79], v164, s[8:11], s62 offen offset:2048 sc1
  s_add_u32 s62, s62, 4096
  buffer_load_dwordx4 v[80:83], v164, s[8:11], s62 offen offset:0 sc1
  buffer_load_dwordx4 v[84:87], v164, s[8:11], s62 offen offset:2048 sc1
  s_add_u32 s62, s62, 4096
  buffer_load_dwordx4 v[88:91], v164, s[8:11], s62 offen offset:0 sc1
  buffer_load_dwordx4 v[92:95], v164, s[8:11], s62 offen offset:2048 sc1
  s_add_u32 s62, s62, 4096
  buffer_load_dwordx4 v[96:99], v164, s[8:11], s62 offen offset:0 sc1
  buffer_load_dwordx4 v[100:103], v164, s[8:11], s62 offen offset:2048 sc1
  s_add_u32 s62, s62, 4096
  buffer_load_dwordx4 v[104:107], v164, s[8:11], s62 offen offset:0 sc1
  buffer_load_dwordx4 v[108:111], v164, s[8:11], s62 offen offset:2048 sc1
  s_add_u32 s62, s62, 4096
  buffer_load_dwordx4 v[112:115], v164, s[8:11], s62 offen offset:0 sc1
  buffer_load_dwordx4 v[116:119], v164, s[8:11], s62 offen offset:2048 sc1
  s_add_u32 s62, s62, 4096
  buffer_load_dwordx4 v[120:123], v164, s[8:11], s62 offen offset:0 sc1
  buffer_load_dwordx4 v[124:127], v164, s[8:11], s62 offen offset:2048 sc1
  s_add_u32 s62, s62, 4096
  s_add_u32 s57, s59, 3
  s_min_u32 s74, s57, 63
  s_mul_i32 s55, s74, 36864
  s_mul_i32 s54, s52, 320
  s_add_u32 s55, s55, s54
  s_add_u32 s55, s55, 62914560
  s_cmp_eq_u32 s52, 3
  s_cselect_b32 s56, 268435456, s55
  buffer_load_dwordx4 v[128:131], v167, s[8:11], s55 offen offset:0 sc1
  buffer_load_dwordx4 v[132:135], v167, s[8:11], s55 offen offset:64 sc1
  buffer_load_dwordx4 v[136:139], v167, s[8:11], s55 offen offset:128 sc1
  buffer_load_dwordx4 v[140:143], v167, s[8:11], s56 offen offset:192 sc1
  buffer_load_dwordx4 v[144:147], v167, s[8:11], s56 offen offset:256 sc1
  s_lshl_b32 s55, s74, 7
  s_add_u32 s55, s55, 66060288
  buffer_load_dword v171, v166, s[8:11], s55 offen sc1
  s_add_u32 s65, s65, 1
  s_cmp_lt_u32 s65, 131072
  s_cselect_b32 s54, -2, -1
  s_waitcnt vmcnt(37)
  v_mfma_f32_16x16x32_bf16 v[148:151], a[0:3], v[0:3], 0
  v_mfma_f32_16x16x32_bf16 v[152:155], a[4:7], v[0:3], 0
  v_max3_u32 v170, v0, v1, v0
  v_max3_u32 v170, v2, v3, v170
  s_waitcnt vmcnt(36)
  v_mfma_f32_16x16x32_bf16 v[148:151], a[8:11], v[4:7], v[148:151]
  v_mfma_f32_16x16x32_bf16 v[152:155], a[12:15], v[4:7], v[152:155]
  v_max3_u32 v170, v4, v5, v170
  v_max3_u32 v170, v6, v7, v170
  s_waitcnt vmcnt(35)
  v_mfma_f32_16x16x32_bf16 v[148:151], a[16:19], v[8:11], v[148:151]
  v_mfma_f32_16x16x32_bf16 v[152:155], a[20:23], v[8:11], v[152:155]
  v_max3_u32 v170, v8, v9, v170
  v_max3_u32 v170, v10, v11, v170
  s_waitcnt vmcnt(34)
  v_mfma_f32_16x16x32_bf16 v[148:151], a[24:27], v[12:15], v[148:151]
  v_mfma_f32_16x16x32_bf16 v[152:155], a[28:31], v[12:15], v[152:155]
  v_max3_u32 v170, v12, v13, v170
  v_max3_u32 v170, v14, v15, v170
  s_waitcnt vmcnt(33)
  v_mfma_f32_16x16x32_bf16 v[148:151], a[32:35], v[16:19], v[148:151]
  v_mfma_f32_16x16x32_bf16 v[152:155], a[36:39], v[16:19], v[152:155]
  v_max3_u32 v170, v16, v17, v170
  v_max3_u32 v170, v18, v19, v170
  s_waitcnt vmcnt(32)
  v_mfma_f32_16x16x32_bf16 v[148:151], a[40:43], v[20:23], v[148:151]
  v_mfma_f32_16x16x32_bf16 v[152:155], a[44:47], v[20:23], v[152:155]
  v_max3_u32 v170, v20, v21, v170
  v_max3_u32 v170, v22, v23, v170
  s_waitcnt vmcnt(31)
  v_mfma_f32_16x16x32_bf16 v[148:151], a[48:51], v[24:27], v[148:151]
  v_mfma_f32_16x16x32_bf16 v[152:155], a[52:55], v[24:27], v[152:155]
  v_max3_u32 v170, v24, v25, v170
  v_max3_u32 v170, v26, v27, v170
  s_waitcnt vmcnt(30)
  v_mfma_f32_16x16x32_bf16 v[148:151], a[56:59], v[28:31], v[148:151]
  v_mfma_f32_16x16x32_bf16 v[152:155], a[60:63], v[28:31], v[152:155]
  v_max3_u32 v170, v28, v29, v170
  v_max3_u32 v170, v30, v31, v170
  s_waitcnt vmcnt(29)
  v_mfma_f32_16x16x32_bf16 v[148:151], a[64:67], v[32:35], v[148:151]
  v_mfma_f32_16x16x32_bf16 v[152:155], a[68:71], v[32:35], v[152:155]
  v_max3_u32 v170, v32, v33, v170
  v_max3_u32 v170, v34, v35, v170
  s_waitcnt vmcnt(28)
  v_mfma_f32_16x16x32_bf16 v[148:151], a[72:75], v[36:39], v[148:151]
  v_mfma_f32_16x16x32_bf16 v[152:155], a[76:79], v[36:39], v[152:155]
  v_max3_u32 v170, v36, v37, v170
  v_max3_u32 v170, v38, v39, v170
  s_waitcnt vmcnt(27)
  v_mfma_f32_16x16x32_bf16 v[148:151], a[80:83], v[40:43], v[148:151]
  v_mfma_f32_16x16x32_bf16 v[152:155], a[84:87], v[40:43], v[152:155]
  v_max3_u32 v170, v40, v41, v170
  v_max3_u32 v170, v42, v43, v170
  s_waitcnt vmcnt(26)
  v_mfma_f32_16x16x32_bf16 v[148:151], a[88:91], v[44:47], v[148:151]
  v_mfma_f32_16x16x32_bf16 v[152:155], a[92:95], v[44:47], v[152:155]
  v_max3_u32 v170, v44, v45, v170
  v_max3_u32 v170, v46, v47, v170
  s_waitcnt vmcnt(25)
  v_mfma_f32_16x16x32_bf16 v[148:151], a[96:99], v[48:51], v[148:151]
  v_mfma_f32_16x16x32_bf16 v[152:155], a[100:103], v[48:51], v[152:155]
  v_max3_u32 v170, v48, v49, v170
  v_max3_u32 v170, v50, v51, v170
  s_waitcnt vmcnt(24)
  v_mfma_f32_16x16x32_bf16 v[148:151], a[104:107], v[52:55], v[148:151]
  v_mfma_f32_16x16x32_bf16 v[152:155], a[108:111], v[52:55], v[152:155]
  v_max3_u32 v170, v52, v53, v170
  v_max3_u32 v170, v54, v55, v170
  s_waitcnt vmcnt(23)
  v_mfma_f32_16x16x32_bf16 v[148:151], a[112:115], v[56:59], v[148:151]
  v_mfma_f32_16x16x32_bf16 v[152:155], a[116:119], v[56:59], v[152:155]
  v_max3_u32 v170, v56, v57, v170
  v_max3_u32 v170, v58, v59, v170
  s_waitcnt vmcnt(22)
  v_mfma_f32_16x16x32_bf16 v[148:151], a[120:123], v[60:63], v[148:151]
  v_mfma_f32_16x16x32_bf16 v[152:155], a[124:127], v[60:63], v[152:155]
  v_max3_u32 v170, v60, v61, v170
  v_max3_u32 v170, v62, v63, v170
  s_waitcnt vmcnt(21)
  v_mfma_f32_16x16x32_bf16 v[148:151], a[128:131], v[64:67], v[148:151]
  v_mfma_f32_16x16x32_bf16 v[152:155], a[132:135], v[64:67], v[152:155]
  v_max3_u32 v170, v64, v65, v170
  v_max3_u32 v170, v66, v67, v170
  s_waitcnt vmcnt(20)
  v_mfma_f32_16x16x32_bf16 v[148:151], a[136:139], v[68:71], v[148:151]
  v_mfma_f32_16x16x32_bf16 v[152:155], a[140:143], v[68:71], v[152:155]
  v_max3_u32 v170, v68, v69, v170
  v_max3_u32 v170, v70, v71, v170
  s_waitcnt vmcnt(19)
  v_mfma_f32_16x16x32_bf16 v[148:151], a[144:147], v[72:75], v[148:151]
  v_mfma_f32_16x16x32_bf16 v[152:155], a[148:151], v[72:75], v[152:155]
  v_max3_u32 v170, v72, v73, v170
  v_max3_u32 v170, v74, v75, v170
  s_waitcnt vmcnt(18)
  v_mfma_f32_16x16x32_bf16 v[148:151], a[152:155], v[76:79], v[148:151]
  v_mfma_f32_16x16x32_bf16 v[152:155], a[156:159], v[76:79], v[152:155]
  v_max3_u32 v170, v76, v77, v170
  v_max3_u32 v170, v78, v79, v170
  s_waitcnt vmcnt(17)
  v_mfma_f32_16x16x32_bf16 v[148:151], a[160:163], v[80:83], v[148:151]
  v_mfma_f32_16x16x32_bf16 v[152:155], a[164:167], v[80:83], v[152:155]
  v_max3_u32 v170, v80, v81, v170
  v_max3_u32 v170, v82, v83, v170
  s_waitcnt vmcnt(16)
  v_mfma_f32_16x16x32_bf16 v[148:151], a[168:171], v[84:87], v[148:151]
  v_mfma_f32_16x16x32_bf16 v[152:155], a[172:175], v[84:87], v[152:155]
  v_max3_u32 v170, v84, v85, v170
  v_max3_u32 v170, v86, v87, v170
  s_waitcnt vmcnt(15)
  v_mfma_f32_16x16x32_bf16 v[148:151], a[176:179], v[88:91], v[148:151]
  v_mfma_f32_16x16x32_bf16 v[152:155], a[180:183], v[88:91], v[152:155]
  v_max3_u32 v170, v88, v89, v170
  v_max3_u32 v170, v90, v91, v170
  s_waitcnt vmcnt(14)
  v_mfma_f32_16x16x32_bf16 v[148:151], a[184:187], v[92:95], v[148:151]
  v_mfma_f32_16x16x32_bf16 v[152:155], a[188:191], v[92:95], v[152:155]
  v_max3_u32 v170, v92, v93, v170
  v_max3_u32 v170, v94, v95, v170
  s_waitcnt vmcnt(13)
  v_mfma_f32_16x16x32_bf16 v[148:151], a[192:195], v[96:99], v[148:151]
  v_mfma_f32_16x16x32_bf16 v[152:155], a[196:199], v[96:99], v[152:155]
  v_max3_u32 v170, v96, v97, v170
  v_max3_u32 v170, v98, v99, v170
  s_waitcnt vmcnt(12)
  v_mfma_f32_16x16x32_bf16 v[148:151], a[200:203], v[100:103], v[148:151]
  v_mfma_f32_16x16x32_bf16 v[152:155], a[204:207], v[100:103], v[152:155]
  v_max3_u32 v170, v100, v101, v170
  v_max3_u32 v170, v102, v103, v170
  s_waitcnt vmcnt(11)
  v_mfma_f32_16x16x32_bf16 v[148:151], a[208:211], v[104:107], v[148:151]
  v_mfma_f32_16x16x32_bf16 v[152:155], a[212:215], v[104:107], v[152:155]
  v_max3_u32 v170, v104, v105, v170
  v_max3_u32 v170, v106, v107, v170
  s_waitcnt vmcnt(10)
  v_mfma_f32_16x16x32_bf16 v[148:151], a[216:219], v[108:111], v[148:151]
  v_mfma_f32_16x16x32_bf16 v[152:155], a[220:223], v[108:111], v[152:155]
  v_max3_u32 v170, v108, v109, v170
  v_max3_u32 v170, v110, v111, v170
  s_waitcnt vmcnt(9)
  v_mfma_f32_16x16x32_bf16 v[148:151], a[224:227], v[112:115], v[148:151]
  v_mfma_f32_16x16x32_bf16 v[152:155], a[228:231], v[112:115], v[152:155]
  v_max3_u32 v170, v112, v113, v170
  v_max3_u32 v170, v114, v115, v170
  s_waitcnt vmcnt(8)
  v_mfma_f32_16x16x32_bf16 v[148:151], a[232:235], v[116:119], v[148:151]
  v_mfma_f32_16x16x32_bf16 v[152:155], a[236:239], v[116:119], v[152:155]
  v_max3_u32 v170, v116, v117, v170
  v_max3_u32 v170, v118, v119, v170
  s_waitcnt vmcnt(7)
  v_mfma_f32_16x16x32_bf16 v[148:151], a[240:243], v[120:123], v[148:151]
  v_mfma_f32_16x16x32_bf16 v[152:155], a[244:247], v[120:123], v[152:155]
  v_max3_u32 v170, v120, v121, v170
  v_max3_u32 v170, v122, v123, v170
  s_waitcnt vmcnt(6)
  v_mfma_f32_16x16x32_bf16 v[148:151], a[248:251], v[124:127], v[148:151]
  v_mfma_f32_16x16x32_bf16 v[152:155], a[252:255], v[124:127], v[152:155]
  v_max3_u32 v170, v124, v125, v170
  v_max3_u32 v170, v126, v127, v170
  v_cmp_lt_u32 vcc, s54, v170
  s_cbranch_vccnz O_ld
  v_fmac_f32 v156, v165, v148
  v_fmac_f32 v157, v165, v149
  v_fmac_f32 v158, v165, v150
  v_fmac_f32 v159, v165, v151
  v_fmac_f32 v160, v165, v152
  v_fmac_f32 v161, v165, v153
  v_fmac_f32 v162, v165, v154
  v_fmac_f32 v163, v165, v155
  ds_write_b128 v168, v[156:159]
  ds_write_b128 v168, v[160:163] offset:1024
  v_xor_b32 v168, 0x2000, v168
  s_mov_b32 s59, s57
  s_waitcnt lgkmcnt(0)
  s_barrier
  s_cmp_eq_u32 s52, 0
  s_cbranch_scc0 O_next
  v_xor_b32 v211, 0x2000, v168
  ds_read_b128 v[0:3], v211 offset:2048
  ds_read_b128 v[4:7], v211 offset:3072
  ds_read_b128 v[8:11], v211 offset:4096
  ds_read_b128 v[12:15], v211 offset:5120
  ds_read_b128 v[16:19], v211 offset:6144
  ds_read_b128 v[20:23], v211 offset:7168
  s_waitcnt lgkmcnt(5)
  v_add_f32 v156, v156, v0
  v_add_f32 v157, v157, v1
  v_add_f32 v158, v158, v2
  v_add_f32 v159, v159, v3
  s_waitcnt lgkmcnt(4)
  v_add_f32 v160, v160, v4
  v_add_f32 v161, v161, v5
  v_add_f32 v162, v162, v6
  v_add_f32 v163, v163, v7
  s_waitcnt lgkmcnt(3)
  v_add_f32 v156, v156, v8
  v_add_f32 v157, v157, v9
  v_add_f32 v158, v158, v10
  v_add_f32 v159, v159, v11
  s_waitcnt lgkmcnt(2)
  v_add_f32 v160, v160, v12
  v_add_f32 v161, v161, v13
  v_add_f32 v162, v162, v14
  v_add_f32 v163, v163, v15
  s_waitcnt lgkmcnt(1)
  v_add_f32 v156, v156, v16
  v_add_f32 v157, v157, v17
  v_add_f32 v158, v158, v18
  v_add_f32 v159, v159, v19
  s_waitcnt lgkmcnt(0)
  v_add_f32 v160, v160, v20
  v_add_f32 v161, v161, v21
  v_add_f32 v162, v162, v22
  v_add_f32 v163, v163, v23
  v_cvt_pk_bf16_f32 v148, v156, v157
  v_cvt_pk_bf16_f32 v149, v158, v159
  v_cvt_pk_bf16_f32 v150, v160, v161
  v_cvt_pk_bf16_f32 v151, v162, v163
  buffer_store_dwordx4 v[148:151], v167, s[48:51], s64 offen
  s_waitcnt vmcnt(1)
  s_branch O_nx2
O_next:
  s_waitcnt vmcnt(0)
O_nx2:
  s_cmp_lt_u32 s59, 64
  s_cbranch_scc1 O_loop
  s_branch L_exit
W_h:
  s_lshr_b32 s58, s53, 1
  s_and_b32 s59, s53, 1
  s_mul_i32 s60, s59, 36864
  s_add_u32 m0, s67, 0
  s_nop 0
  buffer_load_dwordx4 v202, s[4:7], s60 offen offset:0 lds
  s_add_u32 m0, s67, 896
  s_nop 0
  buffer_load_dwordx4 v202, s[4:7], s60 offen offset:128 lds
  s_add_u32 m0, s67, 1792
  s_nop 0
  buffer_load_dwordx4 v202, s[4:7], s60 offen offset:256 lds
  s_add_u32 m0, s67, 2688
  s_nop 0
  buffer_load_dwordx4 v202, s[4:7], s60 offen offset:384 lds
  s_add_u32 m0, s67, 3584
  s_nop 0
  buffer_load_dwordx4 v202, s[4:7], s60 offen offset:512 lds
  s_add_u32 m0, s67, 4480
  s_nop 0
  buffer_load_dwordx4 v202, s[4:7], s60 offen offset:640 lds
  s_add_u32 m0, s67, 5376
  s_nop 0
  buffer_load_dwordx4 v202, s[4:7], s60 offen offset:768 lds
  s_add_u32 m0, s67, 6272
  s_nop 0
  buffer_load_dwordx4 v202, s[4:7], s60 offen offset:896 lds
  s_add_u32 m0, s67, 7168
  s_nop 0
  buffer_load_dwordx4 v202, s[4:7], s60 offen offset:1024 lds
  v_lshrrev_b32 v211, 4, v200
  v_lshlrev_b32 v212, 2, v211
  v_and_b32 v213, 15, v200
  v_xor_b32 v212, v212, v213
  v_lshlrev_b32 v212, 4, v212
  v_lshl_add_u32 v207, v211, 13, v212
  s_lshl_b32 s62, s58, 8
  s_lshl_b32 s54, s52, 15
  s_add_u32 s62, s62, s54
  s_lshl_b32 s61, s52, 10
  s_add_u32 s61, s61, 36864
  s_add_u32 m0, s61, 0
  s_add_u32 s54, s62, 0
  buffer_load_dwordx4 v207, s[16:19], s54 offen lds
  s_add_u32 m0, s61, 4096
  s_add_u32 s54, s62, 131072
  buffer_load_dwordx4 v207, s[16:19], s54 offen lds
  s_add_u32 m0, s61, 8192
  s_add_u32 s54, s62, 262144
  buffer_load_dwordx4 v207, s[16:19], s54 offen lds
  s_add_u32 m0, s61, 12288
  s_add_u32 s54, s62, 393216
  buffer_load_dwordx4 v207, s[16:19], s54 offen lds
  s_add_u32 m0, s61, 16384
  s_add_u32 s54, s62, 524288
  buffer_load_dwordx4 v207, s[16:19], s54 offen lds
  s_add_u32 m0, s61, 20480
  s_add_u32 s54, s62, 655360
  buffer_load_dwordx4 v207, s[16:19], s54 offen lds
  s_add_u32 m0, s61, 24576
  s_add_u32 s54, s62, 786432
  buffer_load_dwordx4 v207, s[16:19], s54 offen lds
  s_add_u32 m0, s61, 28672
  s_add_u32 s54, s62, 917504
  buffer_load_dwordx4 v207, s[16:19], s54 offen lds
  s_add_u32 m0, s61, 32768
  s_add_u32 s54, s62, 1048576
  buffer_load_dwordx4 v207, s[16:19], s54 offen lds
  s_add_u32 m0, s61, 36864
  s_add_u32 s54, s62, 1179648
  buffer_load_dwordx4 v207, s[16:19], s54 offen lds
  s_add_u32 m0, s61, 40960
  s_add_u32 s54, s62, 1310720
  buffer_load_dwordx4 v207, s[16:19], s54 offen lds
  s_add_u32 m0, s61, 45056
  s_add_u32 s54, s62, 1441792
  buffer_load_dwordx4 v207, s[16:19], s54 offen lds
  s_add_u32 m0, s61, 49152
  s_add_u32 s54, s62, 1572864
  buffer_load_dwordx4 v207, s[16:19], s54 offen lds
  s_add_u32 m0, s61, 53248
  s_add_u32 s54, s62, 1703936
  buffer_load_dwordx4 v207, s[16:19], s54 offen lds
  s_add_u32 m0, s61, 57344
  s_add_u32 s54, s62, 1835008
  buffer_load_dwordx4 v207, s[16:19], s54 offen lds
  s_add_u32 m0, s61, 61440
  s_add_u32 s54, s62, 1966080
  buffer_load_dwordx4 v207, s[16:19], s54 offen lds
  s_add_u32 m0, s61, 65536
  s_add_u32 s54, s62, 2097152
  buffer_load_dwordx4 v207, s[16:19], s54 offen lds
  s_add_u32 m0, s61, 69632
  s_add_u32 s54, s62, 2228224
  buffer_load_dwordx4 v207, s[16:19], s54 offen lds
  s_add_u32 m0, s61, 73728
  s_add_u32 s54, s62, 2359296
  buffer_load_dwordx4 v207, s[16:19], s54 offen lds
  s_add_u32 m0, s61, 77824
  s_add_u32 s54, s62, 2490368
  buffer_load_dwordx4 v207, s[16:19], s54 offen lds
  s_add_u32 m0, s61, 81920
  s_add_u32 s54, s62, 2621440
  buffer_load_dwordx4 v207, s[16:19], s54 offen lds
  s_add_u32 m0, s61, 86016
  s_add_u32 s54, s62, 2752512
  buffer_load_dwordx4 v207, s[16:19], s54 offen lds
  s_add_u32 m0, s61, 90112
  s_add_u32 s54, s62, 2883584
  buffer_load_dwordx4 v207, s[16:19], s54 offen lds
  s_add_u32 m0, s61, 94208
  s_add_u32 s54, s62, 3014656
  buffer_load_dwordx4 v207, s[16:19], s54 offen lds
  s_waitcnt vmcnt(20) lgkmcnt(0)
  s_barrier
  s_add_u32 m0, s61, 98304
  s_add_u32 s54, s62, 3145728
  buffer_load_dwordx4 v207, s[16:19], s54 offen lds
  s_add_u32 m0, s61, 102400
  s_add_u32 s54, s62, 3276800
  buffer_load_dwordx4 v207, s[16:19], s54 offen lds
  s_add_u32 m0, s61, 106496
  s_add_u32 s54, s62, 3407872
  buffer_load_dwordx4 v207, s[16:19], s54 offen lds
  s_add_u32 m0, s61, 110592
  s_add_u32 s54, s62, 3538944
  buffer_load_dwordx4 v207, s[16:19], s54 offen lds
  v_add_u32 v215, 36864, v209
  ds_read_b64_tr_b16 a[0:1], v215 offset:0
  ds_read_b64_tr_b16 a[2:3], v215 offset:1024
  ds_read_b64_tr_b16 a[4:5], v215 offset:4096
  ds_read_b64_tr_b16 a[6:7], v215 offset:5120
  ds_read_b64_tr_b16 a[8:9], v215 offset:8192
  ds_read_b64_tr_b16 a[10:11], v215 offset:9216
  ds_read_b64_tr_b16 a[12:13], v215 offset:12288
  ds_read_b64_tr_b16 a[14:15], v215 offset:13312
  s_waitcnt vmcnt(20) lgkmcnt(0)
  s_barrier
  s_add_u32 m0, s61, 0
  s_add_u32 s54, s62, 3670016
  buffer_load_dwordx4 v207, s[16:19], s54 offen lds
  s_add_u32 m0, s61, 4096
  s_add_u32 s54, s62, 3801088
  buffer_load_dwordx4 v207, s[16:19], s54 offen lds
  s_add_u32 m0, s61, 8192
  s_add_u32 s54, s62, 3932160
  buffer_load_dwordx4 v207, s[16:19], s54 offen lds
  s_add_u32 m0, s61, 12288
  s_add_u32 s54, s62, 4063232
  buffer_load_dwordx4 v207, s[16:19], s54 offen lds
  v_add_u32 v215, 53248, v209
  ds_read_b64_tr_b16 a[16:17], v215 offset:0
  ds_read_b64_tr_b16 a[18:19], v215 offset:1024
  ds_read_b64_tr_b16 a[20:21], v215 offset:4096
  ds_read_b64_tr_b16 a[22:23], v215 offset:5120
  ds_read_b64_tr_b16 a[24:25], v215 offset:8192
  ds_read_b64_tr_b16 a[26:27], v215 offset:9216
  ds_read_b64_tr_b16 a[28:29], v215 offset:12288
  ds_read_b64_tr_b16 a[30:31], v215 offset:13312
  s_waitcnt vmcnt(20) lgkmcnt(0)
  s_barrier
  s_add_u32 m0, s61, 16384
  s_add_u32 s54, s62, 4194304
  buffer_load_dwordx4 v207, s[16:19], s54 offen lds
  s_add_u32 m0, s61, 20480
  s_add_u32 s54, s62, 4325376
  buffer_load_dwordx4 v207, s[16:19], s54 offen lds
  s_add_u32 m0, s61, 24576
  s_add_u32 s54, s62, 4456448
  buffer_load_dwordx4 v207, s[16:19], s54 offen lds
  s_add_u32 m0, s61, 28672
  s_add_u32 s54, s62, 4587520
  buffer_load_dwordx4 v207, s[16:19], s54 offen lds
  v_add_u32 v215, 69632, v209
  ds_read_b64_tr_b16 a[32:33], v215 offset:0
  ds_read_b64_tr_b16 a[34:35], v215 offset:1024
  ds_read_b64_tr_b16 a[36:37], v215 offset:4096
  ds_read_b64_tr_b16 a[38:39], v215 offset:5120
  ds_read_b64_tr_b16 a[40:41], v215 offset:8192
  ds_read_b64_tr_b16 a[42:43], v215 offset:9216
  ds_read_b64_tr_b16 a[44:45], v215 offset:12288
  ds_read_b64_tr_b16 a[46:47], v215 offset:13312
  s_waitcnt vmcnt(20) lgkmcnt(0)
  s_barrier
  v_add_u32 v215, 86016, v209
  ds_read_b64_tr_b16 a[48:49], v215 offset:0
  ds_read_b64_tr_b16 a[50:51], v215 offset:1024
  ds_read_b64_tr_b16 a[52:53], v215 offset:4096
  ds_read_b64_tr_b16 a[54:55], v215 offset:5120
  ds_read_b64_tr_b16 a[56:57], v215 offset:8192
  ds_read_b64_tr_b16 a[58:59], v215 offset:9216
  ds_read_b64_tr_b16 a[60:61], v215 offset:12288
  ds_read_b64_tr_b16 a[62:63], v215 offset:13312
  s_waitcnt vmcnt(16) lgkmcnt(0)
  s_barrier
  v_add_u32 v215, 102400, v209
  ds_read_b64_tr_b16 a[64:65], v215 offset:0
  ds_read_b64_tr_b16 a[66:67], v215 offset:1024
  ds_read_b64_tr_b16 a[68:69], v215 offset:4096
  ds_read_b64_tr_b16 a[70:71], v215 offset:5120
  ds_read_b64_tr_b16 a[72:73], v215 offset:8192
  ds_read_b64_tr_b16 a[74:75], v215 offset:9216
  ds_read_b64_tr_b16 a[76:77], v215 offset:12288
  ds_read_b64_tr_b16 a[78:79], v215 offset:13312
  s_waitcnt vmcnt(12) lgkmcnt(0)
  s_barrier
  v_add_u32 v215, 118784, v209
  ds_read_b64_tr_b16 a[80:81], v215 offset:0
  ds_read_b64_tr_b16 a[82:83], v215 offset:1024
  ds_read_b64_tr_b16 a[84:85], v215 offset:4096
  ds_read_b64_tr_b16 a[86:87], v215 offset:5120
  ds_read_b64_tr_b16 a[88:89], v215 offset:8192
  ds_read_b64_tr_b16 a[90:91], v215 offset:9216
  ds_read_b64_tr_b16 a[92:93], v215 offset:12288
  ds_read_b64_tr_b16 a[94:95], v215 offset:13312
  s_waitcnt vmcnt(8) lgkmcnt(0)
  s_barrier
  v_add_u32 v215, 135168, v209
  ds_read_b64_tr_b16 a[96:97], v215 offset:0
  ds_read_b64_tr_b16 a[98:99], v215 offset:1024
  ds_read_b64_tr_b16 a[100:101], v215 offset:4096
  ds_read_b64_tr_b16 a[102:103], v215 offset:5120
  ds_read_b64_tr_b16 a[104:105], v215 offset:8192
  ds_read_b64_tr_b16 a[106:107], v215 offset:9216
  ds_read_b64_tr_b16 a[108:109], v215 offset:12288
  ds_read_b64_tr_b16 a[110:111], v215 offset:13312
  s_waitcnt vmcnt(4) lgkmcnt(0)
  s_barrier
  v_add_u32 v215, 36864, v209
  ds_read_b64_tr_b16 a[112:113], v215 offset:0
  ds_read_b64_tr_b16 a[114:115], v215 offset:1024
  ds_read_b64_tr_b16 a[116:117], v215 offset:4096
  ds_read_b64_tr_b16 a[118:119], v215 offset:5120
  ds_read_b64_tr_b16 a[120:121], v215 offset:8192
  ds_read_b64_tr_b16 a[122:123], v215 offset:9216
  ds_read_b64_tr_b16 a[124:125], v215 offset:12288
  ds_read_b64_tr_b16 a[126:127], v215 offset:13312
  s_waitcnt vmcnt(0) lgkmcnt(0)
  s_barrier
  v_add_u32 v215, 53248, v209
  ds_read_b64_tr_b16 a[128:129], v215 offset:0
  ds_read_b64_tr_b16 a[130:131], v215 offset:1024
  ds_read_b64_tr_b16 a[132:133], v215 offset:4096
  ds_read_b64_tr_b16 a[134:135], v215 offset:5120
  ds_read_b64_tr_b16 a[136:137], v215 offset:8192
  ds_read_b64_tr_b16 a[138:139], v215 offset:9216
  ds_read_b64_tr_b16 a[140:141], v215 offset:12288
  ds_read_b64_tr_b16 a[142:143], v215 offset:13312
  s_waitcnt lgkmcnt(0)
  s_barrier
  v_and_b32 v211, 31, v200
  v_lshrrev_b32 v212, 5, v200
  v_lshlrev_b32 v213, 2, v212
  v_sub_u32 v211, v211, v213
  v_mov_b32 v214, 0xf149f2ca
  v_cmp_gt_i32 vcc, 0, v211
  s_nop 1
  v_cndmask_b32 v48, 0, v214, vcc
  v_cmp_gt_i32 vcc, 1, v211
  s_nop 1
  v_cndmask_b32 v49, 0, v214, vcc
  v_cmp_gt_i32 vcc, 2, v211
  s_nop 1
  v_cndmask_b32 v50, 0, v214, vcc
  v_cmp_gt_i32 vcc, 3, v211
  s_nop 1
  v_cndmask_b32 v51, 0, v214, vcc
  v_cmp_gt_i32 vcc, 8, v211
  s_nop 1
  v_cndmask_b32 v52, 0, v214, vcc
  v_cmp_gt_i32 vcc, 9, v211
  s_nop 1
  v_cndmask_b32 v53, 0, v214, vcc
  v_cmp_gt_i32 vcc, 10, v211
  s_nop 1
  v_cndmask_b32 v54, 0, v214, vcc
  v_cmp_gt_i32 vcc, 11, v211
  s_nop 1
  v_cndmask_b32 v55, 0, v214, vcc
  v_cmp_gt_i32 vcc, 16, v211
  s_nop 1
  v_cndmask_b32 v56, 0, v214, vcc
  v_cmp_gt_i32 vcc, 17, v211
  s_nop 1
  v_cndmask_b32 v57, 0, v214, vcc
  v_cmp_gt_i32 vcc, 18, v211
  s_nop 1
  v_cndmask_b32 v58, 0, v214, vcc
  v_cmp_gt_i32 vcc, 19, v211
  s_nop 1
  v_cndmask_b32 v59, 0, v214, vcc
  v_cmp_gt_i32 vcc, 24, v211
  s_nop 1
  v_cndmask_b32 v60, 0, v214, vcc
  v_cmp_gt_i32 vcc, 25, v211
  s_nop 1
  v_cndmask_b32 v61, 0, v214, vcc
  v_cmp_gt_i32 vcc, 26, v211
  s_nop 1
  v_cndmask_b32 v62, 0, v214, vcc
  v_cmp_gt_i32 vcc, 27, v211
  s_nop 1
  v_cndmask_b32 v63, 0, v214, vcc
  v_and_b32 v218, 0xff, v216
  v_add_u32 v218, 81920, v218
  v_and_b32 v211, 15, v200
  v_lshl_add_u32 v211, v212, 5, v211
  v_lshlrev_b32 v219, 3, v211
  v_bfe_u32 v211, v200, 4, 1
  v_lshl_add_u32 v219, v211, 2, v219
  s_lshl_b32 s54, s52, 9
  s_add_u32 s54, s54, 83968
  v_add_u32 v219, s54, v219
  v_lshl_add_u32 v221, v200, 3, s54
  s_lshr_b32 s54, s52, 1
  s_lshl_b32 s54, s54, 10
  s_and_b32 s55, s52, 1
  s_lshl_b32 s55, s55, 3
  s_add_u32 s54, s54, s55
  s_add_u32 s54, s54, 81920
  v_add_u32 v220, s54, v201
  s_lshl_b32 s54, s52, 11
  s_add_u32 s54, s54, 73728
  v_add_u32 v215, s54, v201
  v_add_u32 v208, 73728, v201
  s_mov_b32 s68, 1040356334
  s_cmp_eq_u32 s52, 0
  s_cselect_b32 s71, s71, 268435456
  s_lshl_b32 s56, s58, 2
  s_add_u32 s56, s56, 128
  v_mov_b32 v176, -1
  v_mov_b32 v177, -1
  v_mov_b32 v178, -1
  v_mov_b32 v179, -1
  s_cmp_eq_u32 s52, 0
  s_cbranch_scc0 AT_p1_d
  s_mov_b32 exec_hi, 0
  s_mov_b32 exec_lo, 1
AT_p1:
  buffer_load_dword v211, v201, s[12:15], s56 offen sc1
  s_add_u32 s65, s65, 1
  s_waitcnt vmcnt(0)
  v_cmp_gt_u32 vcc, 0x700, v211
  s_cbranch_vccz AT_p1_x
  s_sleep 8
  s_cmp_lt_u32 s65, 131072
  s_cbranch_scc1 AT_p1
AT_p1_x:
  s_mov_b64 exec, -1
AT_p1_d:
  s_barrier
  s_mov_b32 s74, s59
  s_mul_i32 s66, s59, 655360
  s_lshl_b32 s55, s58, 14
  s_add_u32 s55, s55, s66
  s_add_u32 s55, s55, 1048576
  s_lshl_b32 s73, s58, 2
  s_add_u32 s73, s73, s52
  s_lshl_b32 s72, s59, 7
  s_add_u32 s72, s72, s73
  s_lshl_b32 s72, s72, 11
  s_add_u32 s72, s72, 46137344
  s_lshl_b32 s73, s73, 10
  s_add_u32 s73, s73, s66
  s_add_u32 s73, s73, 1572864
  s_add_u32 s59, s59, 2
  buffer_load_dwordx4 v[128:131], v216, s[8:11], s55 offen offset:0 sc1
  buffer_load_dwordx4 v[132:135], v216, s[8:11], s55 offen offset:256 sc1
  buffer_load_dwordx4 v[136:139], v216, s[8:11], s55 offen offset:512 sc1
  buffer_load_dwordx4 v[140:143], v216, s[8:11], s55 offen offset:768 sc1
  buffer_load_dwordx4 v[144:147], v216, s[8:11], s55 offen offset:1024 sc1
  buffer_load_dwordx4 v[148:151], v216, s[8:11], s55 offen offset:1280 sc1
  buffer_load_dwordx4 v[152:155], v216, s[8:11], s55 offen offset:1536 sc1
  buffer_load_dwordx4 v[156:159], v216, s[8:11], s55 offen offset:1792 sc1
  buffer_load_dwordx4 v[160:163], v217, s[8:11], s55 offen offset:0 sc1
  buffer_load_dwordx4 v[164:167], v217, s[8:11], s55 offen offset:256 sc1
  s_add_u32 s60, s60, 73728
  s_add_u32 m0, s67, 36864
  s_nop 0
  buffer_load_dwordx4 v202, s[4:7], s60 offen offset:0 lds
  s_add_u32 m0, s67, 37760
  s_nop 0
  buffer_load_dwordx4 v202, s[4:7], s60 offen offset:128 lds
  s_add_u32 m0, s67, 38656
  s_nop 0
  buffer_load_dwordx4 v202, s[4:7], s60 offen offset:256 lds
  s_add_u32 m0, s67, 39552
  s_nop 0
  buffer_load_dwordx4 v202, s[4:7], s60 offen offset:384 lds
  s_add_u32 m0, s67, 40448
  s_nop 0
  buffer_load_dwordx4 v202, s[4:7], s60 offen offset:512 lds
  s_add_u32 m0, s67, 41344
  s_nop 0
  buffer_load_dwordx4 v202, s[4:7], s60 offen offset:640 lds
  s_add_u32 m0, s67, 42240
  s_nop 0
  buffer_load_dwordx4 v202, s[4:7], s60 offen offset:768 lds
  s_add_u32 m0, s67, 43136
  s_nop 0
  buffer_load_dwordx4 v202, s[4:7], s60 offen offset:896 lds
  s_add_u32 m0, s67, 44032
  s_nop 0
  buffer_load_dwordx4 v202, s[4:7], s60 offen offset:1024 lds
  buffer_store_dwordx4 v[176:179], v201, s[8:11], s72 offen offset:0 sc1
  buffer_store_dwordx4 v[176:179], v201, s[8:11], s72 offen offset:1024 sc1
  ds_read_b128 v[32:35], v203 offset:0
  ds_read_b128 v[36:39], v204 offset:0
  ds_read_b128 v[40:43], v205 offset:0
  s_waitcnt lgkmcnt(2)
  v_mfma_f32_32x32x16_bf16 v[240:255], a[0:3], v[32:35], 0
  ds_read_b128 v[44:47], v206 offset:0
  s_waitcnt lgkmcnt(2)
  v_mfma_f32_32x32x16_bf16 v[240:255], a[4:7], v[36:39], v[240:255]
  ds_read_b128 v[32:35], v203 offset:1024
  s_waitcnt lgkmcnt(2)
  v_mfma_f32_32x32x16_bf16 v[240:255], a[8:11], v[40:43], v[240:255]
  ds_read_b128 v[36:39], v204 offset:1024
  s_waitcnt lgkmcnt(2)
  v_mfma_f32_32x32x16_bf16 v[240:255], a[12:15], v[44:47], v[240:255]
  ds_read_b128 v[40:43], v205 offset:1024
  s_waitcnt lgkmcnt(2)
  v_mfma_f32_32x32x16_bf16 v[240:255], a[16:19], v[32:35], v[240:255]
  ds_read_b128 v[44:47], v206 offset:1024
  s_waitcnt lgkmcnt(2)
  v_mfma_f32_32x32x16_bf16 v[240:255], a[20:23], v[36:39], v[240:255]
  ds_read_b128 v[32:35], v203 offset:2048
  s_waitcnt lgkmcnt(2)
  v_mfma_f32_32x32x16_bf16 v[240:255], a[24:27], v[40:43], v[240:255]
  ds_read_b128 v[36:39], v204 offset:2048
  s_waitcnt lgkmcnt(2)
  v_mfma_f32_32x32x16_bf16 v[240:255], a[28:31], v[44:47], v[240:255]
  ds_read_b128 v[40:43], v205 offset:2048
  s_waitcnt lgkmcnt(2)
  v_mfma_f32_32x32x16_bf16 v[240:255], a[32:35], v[32:35], v[240:255]
  ds_read_b128 v[44:47], v206 offset:2048
  s_waitcnt lgkmcnt(2)
  v_mfma_f32_32x32x16_bf16 v[240:255], a[36:39], v[36:39], v[240:255]
  ds_read_b128 v[32:35], v203 offset:3072
  s_waitcnt lgkmcnt(2)
  v_mfma_f32_32x32x16_bf16 v[240:255], a[40:43], v[40:43], v[240:255]
  ds_read_b128 v[36:39], v204 offset:3072
  s_waitcnt lgkmcnt(2)
  v_mfma_f32_32x32x16_bf16 v[240:255], a[44:47], v[44:47], v[240:255]
  ds_read_b128 v[40:43], v205 offset:3072
  s_waitcnt lgkmcnt(2)
  v_mfma_f32_32x32x16_bf16 v[240:255], a[48:51], v[32:35], v[240:255]
  ds_read_b128 v[44:47], v206 offset:3072
  s_waitcnt lgkmcnt(2)
  v_mfma_f32_32x32x16_bf16 v[240:255], a[52:55], v[36:39], v[240:255]
  ds_read_b128 v[32:35], v203 offset:4096
  s_waitcnt lgkmcnt(2)
  v_mfma_f32_32x32x16_bf16 v[240:255], a[56:59], v[40:43], v[240:255]
  ds_read_b128 v[36:39], v204 offset:4096
  s_waitcnt lgkmcnt(2)
  v_mfma_f32_32x32x16_bf16 v[240:255], a[60:63], v[44:47], v[240:255]
  ds_read_b128 v[40:43], v205 offset:4096
  s_waitcnt lgkmcnt(2)
  v_mfma_f32_32x32x16_bf16 v[240:255], a[64:67], v[32:35], v[240:255]
  ds_read_b128 v[44:47], v206 offset:4096
  s_waitcnt lgkmcnt(2)
  v_mfma_f32_32x32x16_bf16 v[240:255], a[68:71], v[36:39], v[240:255]
  ds_read_b128 v[32:35], v203 offset:5120
  s_waitcnt lgkmcnt(2)
  v_mfma_f32_32x32x16_bf16 v[240:255], a[72:75], v[40:43], v[240:255]
  ds_read_b128 v[36:39], v204 offset:5120
  s_waitcnt lgkmcnt(2)
  v_mfma_f32_32x32x16_bf16 v[240:255], a[76:79], v[44:47], v[240:255]
  ds_read_b128 v[40:43], v205 offset:5120
  s_waitcnt lgkmcnt(2)
  v_mfma_f32_32x32x16_bf16 v[240:255], a[80:83], v[32:35], v[240:255]
  ds_read_b128 v[44:47], v206 offset:5120
  s_waitcnt lgkmcnt(2)
  v_mfma_f32_32x32x16_bf16 v[240:255], a[84:87], v[36:39], v[240:255]
  ds_read_b128 v[32:35], v203 offset:6144
  s_waitcnt lgkmcnt(2)
  v_mfma_f32_32x32x16_bf16 v[240:255], a[88:91], v[40:43], v[240:255]
  ds_read_b128 v[36:39], v204 offset:6144
  s_waitcnt lgkmcnt(2)
  v_mfma_f32_32x32x16_bf16 v[240:255], a[92:95], v[44:47], v[240:255]
  ds_read_b128 v[40:43], v205 offset:6144
  s_waitcnt lgkmcnt(2)
  v_mfma_f32_32x32x16_bf16 v[240:255], a[96:99], v[32:35], v[240:255]
  ds_read_b128 v[44:47], v206 offset:6144
  s_waitcnt lgkmcnt(2)
  v_mfma_f32_32x32x16_bf16 v[240:255], a[100:103], v[36:39], v[240:255]
  ds_read_b128 v[32:35], v203 offset:7168
  s_waitcnt lgkmcnt(2)
  v_mfma_f32_32x32x16_bf16 v[240:255], a[104:107], v[40:43], v[240:255]
  ds_read_b128 v[36:39], v204 offset:7168
  s_waitcnt lgkmcnt(2)
  v_mfma_f32_32x32x16_bf16 v[240:255], a[108:111], v[44:47], v[240:255]
  ds_read_b128 v[40:43], v205 offset:7168
  s_waitcnt lgkmcnt(2)
  v_mfma_f32_32x32x16_bf16 v[240:255], a[112:115], v[32:35], v[240:255]
  ds_read_b128 v[44:47], v206 offset:7168
  s_waitcnt lgkmcnt(2)
  v_mfma_f32_32x32x16_bf16 v[240:255], a[116:119], v[36:39], v[240:255]
  ds_read_b128 v[32:35], v203 offset:8192
  s_waitcnt lgkmcnt(2)
  v_mfma_f32_32x32x16_bf16 v[240:255], a[120:123], v[40:43], v[240:255]
  ds_read_b128 v[36:39], v204 offset:8192
  s_waitcnt lgkmcnt(2)
  v_mfma_f32_32x32x16_bf16 v[240:255], a[124:127], v[44:47], v[240:255]
  ds_read_b128 v[40:43], v205 offset:8192
  s_waitcnt lgkmcnt(2)
  v_mfma_f32_32x32x16_bf16 v[240:255], a[128:131], v[32:35], v[240:255]
  ds_read_b128 v[44:47], v206 offset:8192
  s_waitcnt lgkmcnt(2)
  v_mfma_f32_32x32x16_bf16 v[240:255], a[132:135], v[36:39], v[240:255]
  s_waitcnt lgkmcnt(1)
  v_mfma_f32_32x32x16_bf16 v[240:255], a[136:139], v[40:43], v[240:255]
  s_waitcnt lgkmcnt(0)
  v_mfma_f32_32x32x16_bf16 v[240:255], a[140:143], v[44:47], v[240:255]
  s_nop 11
  v_cvt_pk_bf16_f32 v16, v240, v244
  v_cvt_pk_bf16_f32 v17, v241, v245
  v_cvt_pk_bf16_f32 v18, v242, v246
  v_cvt_pk_bf16_f32 v19, v243, v247
  ds_write_b128 v215, v[16:19] offset:0
  v_cvt_pk_bf16_f32 v20, v248, v252
  v_cvt_pk_bf16_f32 v21, v249, v253
  v_cvt_pk_bf16_f32 v22, v250, v254
  v_cvt_pk_bf16_f32 v23, v251, v255
  ds_write_b128 v215, v[20:23] offset:1024
  s_waitcnt lgkmcnt(0)
  s_barrier
  ds_read_b128 v[96:99], v208 offset:0
  ds_read_b128 v[100:103], v208 offset:1024
  ds_read_b128 v[104:107], v208 offset:2048
  ds_read_b128 v[108:111], v208 offset:3072
  ds_read_b128 v[112:115], v208 offset:4096
  ds_read_b128 v[116:119], v208 offset:5120
  ds_read_b128 v[120:123], v208 offset:6144
  ds_read_b128 v[124:127], v208 offset:7168
  s_waitcnt vmcnt(20) lgkmcnt(7)
  v_mfma_f32_32x32x16_bf16 v[64:79], v[128:131], v[96:99], v[48:63]
  s_waitcnt vmcnt(19) lgkmcnt(6)
  v_mfma_f32_32x32x16_bf16 v[64:79], v[132:135], v[100:103], v[64:79]
  s_waitcnt vmcnt(18) lgkmcnt(5)
  v_mfma_f32_32x32x16_bf16 v[64:79], v[136:139], v[104:107], v[64:79]
  s_waitcnt vmcnt(17) lgkmcnt(4)
  v_mfma_f32_32x32x16_bf16 v[64:79], v[140:143], v[108:111], v[64:79]
  s_waitcnt vmcnt(16) lgkmcnt(3)
  v_mfma_f32_32x32x16_bf16 v[64:79], v[144:147], v[112:115], v[64:79]
  s_waitcnt vmcnt(15) lgkmcnt(2)
  v_mfma_f32_32x32x16_bf16 v[64:79], v[148:151], v[116:119], v[64:79]
  s_waitcnt vmcnt(14) lgkmcnt(1)
  v_mfma_f32_32x32x16_bf16 v[64:79], v[152:155], v[120:123], v[64:79]
  s_waitcnt vmcnt(13) lgkmcnt(0)
  v_mfma_f32_32x32x16_bf16 v[64:79], v[156:159], v[124:127], v[64:79]
  s_nop 11
  v_max3_f32 v180, v64, v65, v66
  v_max3_f32 v180, v180, v67, v68
  v_max3_f32 v180, v180, v69, v70
  v_max3_f32 v180, v180, v71, v72
  v_max3_f32 v180, v180, v73, v74
  v_max3_f32 v180, v180, v75, v76
  v_max3_f32 v180, v180, v77, v78
  v_max_f32 v180, v180, v79
  v_mov_b32 v181, v180
  s_nop 1
  v_permlane32_swap_b32 v180, v181
  v_max_f32 v180, v180, v181
  v_sub_f32 v64, v64, v180
  v_sub_f32 v65, v65, v180
  v_sub_f32 v66, v66, v180
  v_sub_f32 v67, v67, v180
  v_sub_f32 v68, v68, v180
  v_sub_f32 v69, v69, v180
  v_sub_f32 v70, v70, v180
  v_sub_f32 v71, v71, v180
  v_sub_f32 v72, v72, v180
  v_sub_f32 v73, v73, v180
  v_sub_f32 v74, v74, v180
  v_sub_f32 v75, v75, v180
  v_sub_f32 v76, v76, v180
  v_sub_f32 v77, v77, v180
  v_sub_f32 v78, v78, v180
  v_sub_f32 v79, v79, v180
  v_exp_f32 v64, v64
  v_exp_f32 v65, v65
  v_exp_f32 v66, v66
  v_exp_f32 v67, v67
  v_exp_f32 v68, v68
  v_exp_f32 v69, v69
  v_exp_f32 v70, v70
  v_exp_f32 v71, v71
  v_exp_f32 v72, v72
  v_exp_f32 v73, v73
  v_exp_f32 v74, v74
  v_exp_f32 v75, v75
  v_exp_f32 v76, v76
  v_exp_f32 v77, v77
  v_exp_f32 v78, v78
  v_exp_f32 v79, v79
  v_cvt_pk_bf16_f32 v20, v64, v65
  v_cvt_pk_bf16_f32 v21, v68, v69
  v_cvt_pk_bf16_f32 v22, v72, v73
  v_cvt_pk_bf16_f32 v23, v76, v77
  v_cvt_pk_bf16_f32 v24, v66, v67
  v_cvt_pk_bf16_f32 v25, v70, v71
  v_cvt_pk_bf16_f32 v26, v74, v75
  v_cvt_pk_bf16_f32 v27, v78, v79
  s_waitcnt vmcnt(12)
  v_mfma_f32_32x32x16_bf16 v[0:15], v[160:163], v[20:23], 0
  v_add_f32 v182, v64, v65
  v_add_f32 v182, v182, v66
  v_add_f32 v182, v182, v67
  v_add_f32 v182, v182, v68
  v_add_f32 v182, v182, v69
  v_add_f32 v182, v182, v70
  v_add_f32 v182, v182, v71
  s_waitcnt vmcnt(11)
  v_mfma_f32_32x32x16_bf16 v[0:15], v[164:167], v[24:27], v[0:15]
  v_add_f32 v182, v182, v72
  v_add_f32 v182, v182, v73
  v_add_f32 v182, v182, v74
  v_add_f32 v182, v182, v75
  v_add_f32 v182, v182, v76
  v_add_f32 v182, v182, v77
  v_add_f32 v182, v182, v78
  v_add_f32 v182, v182, v79
  s_waitcnt vmcnt(0)
  s_barrier
AT_loop:
  s_cmp_ge_u32 s59, 64
  s_cbranch_scc1 AT_l0
  s_mov_b32 s77, s59
  s_mul_i32 s66, s59, 655360
  s_lshl_b32 s55, s58, 14
  s_add_u32 s55, s55, s66
  s_add_u32 s55, s55, 1048576
  s_lshl_b32 s76, s58, 2
  s_add_u32 s76, s76, s52
  s_lshl_b32 s75, s59, 7
  s_add_u32 s75, s75, s76
  s_lshl_b32 s75, s75, 11
  s_add_u32 s75, s75, 46137344
  s_lshl_b32 s76, s76, 10
  s_add_u32 s76, s76, s66
  s_add_u32 s76, s76, 1572864
  s_add_u32 s59, s59, 2
  buffer_load_dwordx4 v[128:131], v216, s[8:11], s55 offen offset:0 sc1
  buffer_load_dwordx4 v[132:135], v216, s[8:11], s55 offen offset:256 sc1
  buffer_load_dwordx4 v[136:139], v216, s[8:11], s55 offen offset:512 sc1
  buffer_load_dwordx4 v[140:143], v216, s[8:11], s55 offen offset:768 sc1
  buffer_load_dwordx4 v[144:147], v216, s[8:11], s55 offen offset:1024 sc1
  buffer_load_dwordx4 v[148:151], v216, s[8:11], s55 offen offset:1280 sc1
  buffer_load_dwordx4 v[152:155], v216, s[8:11], s55 offen offset:1536 sc1
  buffer_load_dwordx4 v[156:159], v216, s[8:11], s55 offen offset:1792 sc1
  buffer_load_dwordx4 v[160:163], v217, s[8:11], s55 offen offset:0 sc1
  buffer_load_dwordx4 v[164:167], v217, s[8:11], s55 offen offset:256 sc1
  s_or_b32 s70, s73, 0xc00
  buffer_load_dword v172, off, s[8:11], s70 sc1
  s_add_u32 s60, s60, 73728
  s_add_u32 m0, s67, 0
  s_nop 0
  buffer_load_dwordx4 v202, s[4:7], s60 offen offset:0 lds
  s_add_u32 m0, s67, 896
  s_nop 0
  buffer_load_dwordx4 v202, s[4:7], s60 offen offset:128 lds
  s_add_u32 m0, s67, 1792
  s_nop 0
  buffer_load_dwordx4 v202, s[4:7], s60 offen offset:256 lds
  s_add_u32 m0, s67, 2688
  s_nop 0
  buffer_load_dwordx4 v202, s[4:7], s60 offen offset:384 lds
  s_add_u32 m0, s67, 3584
  s_nop 0
  buffer_load_dwordx4 v202, s[4:7], s60 offen offset:512 lds
  s_add_u32 m0, s67, 4480
  s_nop 0
  buffer_load_dwordx4 v202, s[4:7], s60 offen offset:640 lds
  s_add_u32 m0, s67, 5376
  s_nop 0
  buffer_load_dwordx4 v202, s[4:7], s60 offen offset:768 lds
  s_add_u32 m0, s67, 6272
  s_nop 0
  buffer_load_dwordx4 v202, s[4:7], s60 offen offset:896 lds
  s_add_u32 m0, s67, 7168
  s_nop 0
  buffer_load_dwordx4 v202, s[4:7], s60 offen offset:1024 lds
  buffer_store_dwordx4 v[176:179], v201, s[8:11], s75 offen offset:0 sc1
  buffer_store_dwordx4 v[176:179], v201, s[8:11], s75 offen offset:1024 sc1
  ds_read_b128 v[32:35], v203 offset:36864
  ds_read_b128 v[36:39], v204 offset:36864
  ds_read_b128 v[40:43], v205 offset:36864
  s_waitcnt lgkmcnt(2)
  v_mfma_f32_32x32x16_bf16 v[240:255], a[0:3], v[32:35], 0
  ds_read_b128 v[44:47], v206 offset:36864
  s_waitcnt lgkmcnt(2)
  v_mfma_f32_32x32x16_bf16 v[240:255], a[4:7], v[36:39], v[240:255]
  ds_read_b128 v[32:35], v203 offset:37888
  s_waitcnt lgkmcnt(2)
  v_mfma_f32_32x32x16_bf16 v[240:255], a[8:11], v[40:43], v[240:255]
  ds_read_b128 v[36:39], v204 offset:37888
  s_waitcnt lgkmcnt(2)
  v_mfma_f32_32x32x16_bf16 v[240:255], a[12:15], v[44:47], v[240:255]
  ds_read_b128 v[40:43], v205 offset:37888
  s_waitcnt lgkmcnt(2)
  v_mfma_f32_32x32x16_bf16 v[240:255], a[16:19], v[32:35], v[240:255]
  ds_read_b128 v[44:47], v206 offset:37888
  s_waitcnt lgkmcnt(2)
  v_mfma_f32_32x32x16_bf16 v[240:255], a[20:23], v[36:39], v[240:255]
  ds_read_b128 v[32:35], v203 offset:38912
  s_waitcnt lgkmcnt(2)
  v_mfma_f32_32x32x16_bf16 v[240:255], a[24:27], v[40:43], v[240:255]
  ds_read_b128 v[36:39], v204 offset:38912
  s_waitcnt lgkmcnt(2)
  v_mfma_f32_32x32x16_bf16 v[240:255], a[28:31], v[44:47], v[240:255]
  ds_read_b128 v[40:43], v205 offset:38912
  s_waitcnt lgkmcnt(2)
  v_mfma_f32_32x32x16_bf16 v[240:255], a[32:35], v[32:35], v[240:255]
  ds_read_b128 v[44:47], v206 offset:38912
  s_waitcnt lgkmcnt(2)
  v_mfma_f32_32x32x16_bf16 v[240:255], a[36:39], v[36:39], v[240:255]
  ds_read_b128 v[32:35], v203 offset:39936
  s_waitcnt lgkmcnt(2)
  v_mfma_f32_32x32x16_bf16 v[240:255], a[40:43], v[40:43], v[240:255]
  ds_read_b128 v[36:39], v204 offset:39936
  s_waitcnt lgkmcnt(2)
  v_mfma_f32_32x32x16_bf16 v[240:255], a[44:47], v[44:47], v[240:255]
  ds_read_b128 v[40:43], v205 offset:39936
  s_waitcnt lgkmcnt(2)
  v_mfma_f32_32x32x16_bf16 v[240:255], a[48:51], v[32:35], v[240:255]
  ds_read_b128 v[44:47], v206 offset:39936
  s_waitcnt lgkmcnt(2)
  v_mfma_f32_32x32x16_bf16 v[240:255], a[52:55], v[36:39], v[240:255]
  ds_read_b128 v[32:35], v203 offset:40960
  s_waitcnt lgkmcnt(2)
  v_mfma_f32_32x32x16_bf16 v[240:255], a[56:59], v[40:43], v[240:255]
  ds_read_b128 v[36:39], v204 offset:40960
  s_waitcnt lgkmcnt(2)
  v_mfma_f32_32x32x16_bf16 v[240:255], a[60:63], v[44:47], v[240:255]
  ds_read_b128 v[40:43], v205 offset:40960
  s_waitcnt lgkmcnt(2)
  v_mfma_f32_32x32x16_bf16 v[240:255], a[64:67], v[32:35], v[240:255]
  ds_read_b128 v[44:47], v206 offset:40960
  s_waitcnt lgkmcnt(2)
  v_mfma_f32_32x32x16_bf16 v[240:255], a[68:71], v[36:39], v[240:255]
  ds_read_b128 v[32:35], v203 offset:41984
  s_waitcnt lgkmcnt(2)
  v_mfma_f32_32x32x16_bf16 v[240:255], a[72:75], v[40:43], v[240:255]
  ds_read_b128 v[36:39], v204 offset:41984
  s_waitcnt lgkmcnt(2)
  v_mfma_f32_32x32x16_bf16 v[240:255], a[76:79], v[44:47], v[240:255]
  ds_read_b128 v[40:43], v205 offset:41984
  s_waitcnt lgkmcnt(2)
  v_mfma_f32_32x32x16_bf16 v[240:255], a[80:83], v[32:35], v[240:255]
  ds_read_b128 v[44:47], v206 offset:41984
  s_waitcnt lgkmcnt(2)
  v_mfma_f32_32x32x16_bf16 v[240:255], a[84:87], v[36:39], v[240:255]
  ds_read_b128 v[32:35], v203 offset:43008
  s_waitcnt lgkmcnt(2)
  v_mfma_f32_32x32x16_bf16 v[240:255], a[88:91], v[40:43], v[240:255]
  ds_read_b128 v[36:39], v204 offset:43008
  s_waitcnt lgkmcnt(2)
  v_mfma_f32_32x32x16_bf16 v[240:255], a[92:95], v[44:47], v[240:255]
  ds_read_b128 v[40:43], v205 offset:43008
  s_waitcnt lgkmcnt(2)
  v_mfma_f32_32x32x16_bf16 v[240:255], a[96:99], v[32:35], v[240:255]
  ds_read_b128 v[44:47], v206 offset:43008
  s_waitcnt lgkmcnt(2)
  v_mfma_f32_32x32x16_bf16 v[240:255], a[100:103], v[36:39], v[240:255]
  ds_read_b128 v[32:35], v203 offset:44032
  s_waitcnt lgkmcnt(2)
  v_mfma_f32_32x32x16_bf16 v[240:255], a[104:107], v[40:43], v[240:255]
  ds_read_b128 v[36:39], v204 offset:44032
  s_waitcnt lgkmcnt(2)
  v_mfma_f32_32x32x16_bf16 v[240:255], a[108:111], v[44:47], v[240:255]
  ds_read_b128 v[40:43], v205 offset:44032
  s_waitcnt lgkmcnt(2)
  v_mfma_f32_32x32x16_bf16 v[240:255], a[112:115], v[32:35], v[240:255]
  ds_read_b128 v[44:47], v206 offset:44032
  s_waitcnt lgkmcnt(2)
  v_mfma_f32_32x32x16_bf16 v[240:255], a[116:119], v[36:39], v[240:255]
  ds_read_b128 v[32:35], v203 offset:45056
  s_waitcnt lgkmcnt(2)
  v_mfma_f32_32x32x16_bf16 v[240:255], a[120:123], v[40:43], v[240:255]
  ds_read_b128 v[36:39], v204 offset:45056
  s_waitcnt lgkmcnt(2)
  v_mfma_f32_32x32x16_bf16 v[240:255], a[124:127], v[44:47], v[240:255]
  ds_read_b128 v[40:43], v205 offset:45056
  s_waitcnt lgkmcnt(2)
  v_mfma_f32_32x32x16_bf16 v[240:255], a[128:131], v[32:35], v[240:255]
  ds_read_b128 v[44:47], v206 offset:45056
  s_waitcnt lgkmcnt(2)
  v_mfma_f32_32x32x16_bf16 v[240:255], a[132:135], v[36:39], v[240:255]
  s_waitcnt lgkmcnt(1)
  v_mfma_f32_32x32x16_bf16 v[240:255], a[136:139], v[40:43], v[240:255]
  s_waitcnt lgkmcnt(0)
  v_mfma_f32_32x32x16_bf16 v[240:255], a[140:143], v[44:47], v[240:255]
  s_nop 11
  v_cvt_pk_bf16_f32 v16, v240, v244
  v_cvt_pk_bf16_f32 v17, v241, v245
  v_cvt_pk_bf16_f32 v18, v242, v246
  v_cvt_pk_bf16_f32 v19, v243, v247
  ds_write_b128 v215, v[16:19] offset:0
  v_cvt_pk_bf16_f32 v20, v248, v252
  v_cvt_pk_bf16_f32 v21, v249, v253
  v_cvt_pk_bf16_f32 v22, v250, v254
  v_cvt_pk_bf16_f32 v23, v251, v255
  ds_write_b128 v215, v[20:23] offset:1024
  s_waitcnt lgkmcnt(0)
  s_barrier
  ds_read_b128 a[144:147], v208 offset:0
  ds_read_b128 a[148:151], v208 offset:1024
  ds_read_b128 a[152:155], v208 offset:2048
  ds_read_b128 a[156:159], v208 offset:3072
  ds_read_b128 a[160:163], v208 offset:4096
  ds_read_b128 a[164:167], v208 offset:5120
  ds_read_b128 a[168:171], v208 offset:6144
  ds_read_b128 a[172:175], v208 offset:7168
  s_waitcnt vmcnt(11)
  v_cmp_eq_u32 vcc, -1, v172
  s_mov_b32 s69, 0
  s_cbranch_vccnz AT_e1
  s_mov_b32 s69, 1
  buffer_load_dwordx4 v[172:175], v201, s[8:11], s73 offen sc1
AT_e1:
  s_waitcnt lgkmcnt(7)
  v_mfma_f32_32x32x16_bf16 v[64:79], v[128:131], a[144:147], v[48:63]
  s_waitcnt lgkmcnt(6)
  v_mfma_f32_32x32x16_bf16 v[64:79], v[132:135], a[148:151], v[64:79]
  s_waitcnt lgkmcnt(5)
  v_mfma_f32_32x32x16_bf16 v[64:79], v[136:139], a[152:155], v[64:79]
  s_waitcnt lgkmcnt(4)
  v_mfma_f32_32x32x16_bf16 v[64:79], v[140:143], a[156:159], v[64:79]
  s_waitcnt lgkmcnt(3)
  v_mfma_f32_32x32x16_bf16 v[64:79], v[144:147], a[160:163], v[64:79]
  s_waitcnt lgkmcnt(2)
  v_mfma_f32_32x32x16_bf16 v[64:79], v[148:151], a[164:167], v[64:79]
  s_waitcnt lgkmcnt(1)
  v_mfma_f32_32x32x16_bf16 v[64:79], v[152:155], a[168:171], v[64:79]
  s_waitcnt lgkmcnt(0)
  v_mfma_f32_32x32x16_bf16 v[64:79], v[156:159], a[172:175], v[64:79]
  s_nop 11
  v_max3_f32 v184, v64, v65, v66
  v_max3_f32 v184, v184, v67, v68
  v_max3_f32 v184, v184, v69, v70
  v_max3_f32 v184, v184, v71, v72
  v_max3_f32 v184, v184, v73, v74
  v_max3_f32 v184, v184, v75, v76
  v_max3_f32 v184, v184, v77, v78
  v_max_f32 v184, v184, v79
  v_mov_b32 v185, v184
  s_nop 1
  v_permlane32_swap_b32 v184, v185
  v_max_f32 v184, v184, v185
  v_sub_f32 v64, v64, v184
  v_sub_f32 v65, v65, v184
  v_sub_f32 v66, v66, v184
  v_sub_f32 v67, v67, v184
  v_sub_f32 v68, v68, v184
  v_sub_f32 v69, v69, v184
  v_sub_f32 v70, v70, v184
  v_sub_f32 v71, v71, v184
  v_sub_f32 v72, v72, v184
  v_sub_f32 v73, v73, v184
  v_sub_f32 v74, v74, v184
  v_sub_f32 v75, v75, v184
  v_sub_f32 v76, v76, v184
  v_sub_f32 v77, v77, v184
  v_sub_f32 v78, v78, v184
  v_sub_f32 v79, v79, v184
  v_exp_f32 v64, v64
  v_exp_f32 v65, v65
  v_exp_f32 v66, v66
  v_exp_f32 v67, v67
  v_exp_f32 v68, v68
  v_exp_f32 v69, v69
  v_exp_f32 v70, v70
  v_exp_f32 v71, v71
  v_exp_f32 v72, v72
  v_exp_f32 v73, v73
  v_exp_f32 v74, v74
  v_exp_f32 v75, v75
  v_exp_f32 v76, v76
  v_exp_f32 v77, v77
  v_exp_f32 v78, v78
  v_exp_f32 v79, v79
  v_cvt_pk_bf16_f32 v20, v64, v65
  v_cvt_pk_bf16_f32 v21, v68, v69
  v_cvt_pk_bf16_f32 v22, v72, v73
  v_cvt_pk_bf16_f32 v23, v76, v77
  v_cvt_pk_bf16_f32 v24, v66, v67
  v_cvt_pk_bf16_f32 v25, v70, v71
  v_cvt_pk_bf16_f32 v26, v74, v75
  v_cvt_pk_bf16_f32 v27, v78, v79
  v_mfma_f32_32x32x16_bf16 v[224:239], v[160:163], v[20:23], 0
  v_add_f32 v186, v64, v65
  v_add_f32 v186, v186, v66
  v_add_f32 v186, v186, v67
  v_add_f32 v186, v186, v68
  v_add_f32 v186, v186, v69
  v_add_f32 v186, v186, v70
  v_add_f32 v186, v186, v71
  v_mfma_f32_32x32x16_bf16 v[224:239], v[164:167], v[24:27], v[224:239]
  v_add_f32 v186, v186, v72
  v_add_f32 v186, v186, v73
  v_add_f32 v186, v186, v74
  v_add_f32 v186, v186, v75
  v_add_f32 v186, v186, v76
  v_add_f32 v186, v186, v77
  v_add_f32 v186, v186, v78
  v_add_f32 v186, v186, v79
AT_l0:
  s_cmp_eq_u32 s69, 1
  s_cbranch_scc1 AT_v0
  s_cmp_ge_u32 s74, 62
  s_cbranch_scc1 AT_k0
  s_branch AT_c0
AT_h0:
  s_sleep 2
AT_c0:
  buffer_load_dword v172, off, s[8:11], s70 sc1
  s_add_u32 s65, s65, 1
  s_cmp_lt_u32 s65, 131072
  s_cselect_b32 s54, -2, -1
  s_waitcnt vmcnt(0)
  v_cmp_lt_u32 vcc, s54, v172
  s_cbranch_vccnz AT_h0
AT_k0:
  buffer_load_dwordx4 v[172:175], v201, s[8:11], s73 offen sc1
AT_v0:
  s_mov_b32 s69, 0
  s_add_u32 s65, s65, 1
  s_cmp_lt_u32 s65, 131072
  s_cselect_b32 s54, -2, -1
  s_waitcnt vmcnt(0)
  ds_write_b64 v220, v[172:173] offset:0
  ds_write_b64 v221, v[174:175] offset:0
  v_max3_u32 v213, v172, v173, v174
  v_max_u32 v213, v213, v175
  v_cmp_lt_u32 vcc, s54, v213
  s_cbranch_vccnz AT_k0
  s_waitcnt lgkmcnt(0)
  s_barrier
  ds_read_b128 v[128:131], v218 offset:0
  ds_read_b128 v[132:135], v218 offset:256
  ds_read_b128 v[136:139], v218 offset:512
  ds_read_b128 v[140:143], v218 offset:768
  ds_read_b128 v[144:147], v218 offset:1024
  ds_read_b128 v[148:151], v218 offset:1280
  ds_read_b128 v[152:155], v218 offset:1536
  ds_read_b128 v[156:159], v218 offset:1792
  ds_read_b32 v168, v219 offset:0
  ds_read_b32 v169, v219 offset:128
  s_waitcnt lgkmcnt(9)
  v_mfma_f32_32x32x16_bf16 v[80:95], v[128:131], v[96:99], 0
  s_waitcnt lgkmcnt(8)
  v_mfma_f32_32x32x16_bf16 v[80:95], v[132:135], v[100:103], v[80:95]
  s_waitcnt lgkmcnt(7)
  v_mfma_f32_32x32x16_bf16 v[80:95], v[136:139], v[104:107], v[80:95]
  s_waitcnt lgkmcnt(6)
  v_mfma_f32_32x32x16_bf16 v[80:95], v[140:143], v[108:111], v[80:95]
  s_waitcnt lgkmcnt(5)
  v_mfma_f32_32x32x16_bf16 v[80:95], v[144:147], v[112:115], v[80:95]
  s_waitcnt lgkmcnt(4)
  v_mfma_f32_32x32x16_bf16 v[80:95], v[148:151], v[116:119], v[80:95]
  s_waitcnt lgkmcnt(3)
  v_mfma_f32_32x32x16_bf16 v[80:95], v[152:155], v[120:123], v[80:95]
  s_waitcnt lgkmcnt(2)
  v_mfma_f32_32x32x16_bf16 v[80:95], v[156:159], v[124:127], v[80:95]
  s_add_u32 s74, s74, 2
  v_mov_b32 v212, s74
  s_nop 9
  v_mul_f32 v80, s68, v80
  v_mul_f32 v81, s68, v81
  v_mul_f32 v82, s68, v82
  v_mul_f32 v83, s68, v83
  v_max3_f32 v84, v180, v80, v81
  v_max3_f32 v84, v84, v82, v83
  v_mov_b32 v85, v84
  s_nop 1
  v_permlane32_swap_b32 v84, v85
  v_max_f32 v84, v84, v85
  v_sub_f32 v86, v180, v84
  v_sub_f32 v80, v80, v84
  v_sub_f32 v81, v81, v84
  v_sub_f32 v82, v82, v84
  v_sub_f32 v83, v83, v84
  v_exp_f32 v86, v86
  v_exp_f32 v80, v80
  v_exp_f32 v81, v81
  v_exp_f32 v82, v82
  v_exp_f32 v83, v83
  v_fma_f32 v182, v182, v86, v80
  v_add_f32 v84, v81, v82
  v_add_f32 v182, v182, v83
  v_add_f32 v182, v182, v84
  v_mov_b32 v183, v182
  s_nop 1
  v_permlane32_swap_b32 v182, v183
  v_add_f32 v182, v182, v183
  v_rcp_f32 v182, v182
  s_nop 0
  v_mul_f32 v86, v86, v182
  v_mul_f32 v80, v182, v80
  v_mul_f32 v81, v182, v81
  v_mul_f32 v82, v182, v82
  v_mul_f32 v83, v182, v83
  v_cvt_pk_bf16_f32 v28, v80, v81
  v_cvt_pk_bf16_f32 v29, v82, v83
  v_mul_f32 v0, v86, v0
  v_mul_f32 v1, v86, v1
  v_mul_f32 v2, v86, v2
  v_mul_f32 v3, v86, v3
  v_mul_f32 v4, v86, v4
  v_mul_f32 v5, v86, v5
  v_mul_f32 v6, v86, v6
  v_mul_f32 v7, v86, v7
  v_mul_f32 v8, v86, v8
  v_mul_f32 v9, v86, v9
  v_mul_f32 v10, v86, v10
  v_mul_f32 v11, v86, v11
  v_mul_f32 v12, v86, v12
  v_mul_f32 v13, v86, v13
  v_mul_f32 v14, v86, v14
  v_mul_f32 v15, v86, v15
  s_waitcnt lgkmcnt(0)
  s_nop 0
  v_mfma_f32_32x32x8_bf16 v[0:15], v[168:169], v[28:29], v[0:15]
  s_nop 11
  v_cvt_pk_bf16_f32 v20, v0, v1
  v_cvt_pk_bf16_f32 v21, v2, v3
  v_cvt_pk_bf16_f32 v22, v4, v5
  v_cvt_pk_bf16_f32 v23, v6, v7
  buffer_store_dwordx4 v[20:23], v201, s[8:11], s72 offen offset:0 sc1
  v_cvt_pk_bf16_f32 v24, v8, v9
  v_cvt_pk_bf16_f32 v25, v10, v11
  v_cvt_pk_bf16_f32 v26, v12, v13
  v_cvt_pk_bf16_f32 v27, v14, v15
  buffer_store_dwordx4 v[24:27], v201, s[8:11], s72 offen offset:1024 sc1
  s_mov_b64 exec, 1
  buffer_store_dword v212, v201, s[8:11], s71 offen sc1
  s_mov_b64 exec, -1
  s_cmp_ge_u32 s74, 64
  s_cbranch_scc1 L_exit
  s_cmp_ge_u32 s59, 64
  s_cbranch_scc1 AT_l1
  s_mov_b32 s74, s59
  s_mul_i32 s66, s59, 655360
  s_lshl_b32 s55, s58, 14
  s_add_u32 s55, s55, s66
  s_add_u32 s55, s55, 1048576
  s_lshl_b32 s73, s58, 2
  s_add_u32 s73, s73, s52
  s_lshl_b32 s72, s59, 7
  s_add_u32 s72, s72, s73
  s_lshl_b32 s72, s72, 11
  s_add_u32 s72, s72, 46137344
  s_lshl_b32 s73, s73, 10
  s_add_u32 s73, s73, s66
  s_add_u32 s73, s73, 1572864
  s_add_u32 s59, s59, 2
  buffer_load_dwordx4 v[128:131], v216, s[8:11], s55 offen offset:0 sc1
  buffer_load_dwordx4 v[132:135], v216, s[8:11], s55 offen offset:256 sc1
  buffer_load_dwordx4 v[136:139], v216, s[8:11], s55 offen offset:512 sc1
  buffer_load_dwordx4 v[140:143], v216, s[8:11], s55 offen offset:768 sc1
  buffer_load_dwordx4 v[144:147], v216, s[8:11], s55 offen offset:1024 sc1
  buffer_load_dwordx4 v[148:151], v216, s[8:11], s55 offen offset:1280 sc1
  buffer_load_dwordx4 v[152:155], v216, s[8:11], s55 offen offset:1536 sc1
  buffer_load_dwordx4 v[156:159], v216, s[8:11], s55 offen offset:1792 sc1
  buffer_load_dwordx4 v[160:163], v217, s[8:11], s55 offen offset:0 sc1
  buffer_load_dwordx4 v[164:167], v217, s[8:11], s55 offen offset:256 sc1
  s_or_b32 s70, s76, 0xc00
  buffer_load_dword v172, off, s[8:11], s70 sc1
  s_add_u32 s60, s60, 73728
  s_add_u32 m0, s67, 36864
  s_nop 0
  buffer_load_dwordx4 v202, s[4:7], s60 offen offset:0 lds
  s_add_u32 m0, s67, 37760
  s_nop 0
  buffer_load_dwordx4 v202, s[4:7], s60 offen offset:128 lds
  s_add_u32 m0, s67, 38656
  s_nop 0
  buffer_load_dwordx4 v202, s[4:7], s60 offen offset:256 lds
  s_add_u32 m0, s67, 39552
  s_nop 0
  buffer_load_dwordx4 v202, s[4:7], s60 offen offset:384 lds
  s_add_u32 m0, s67, 40448
  s_nop 0
  buffer_load_dwordx4 v202, s[4:7], s60 offen offset:512 lds
  s_add_u32 m0, s67, 41344
  s_nop 0
  buffer_load_dwordx4 v202, s[4:7], s60 offen offset:640 lds
  s_add_u32 m0, s67, 42240
  s_nop 0
  buffer_load_dwordx4 v202, s[4:7], s60 offen offset:768 lds
  s_add_u32 m0, s67, 43136
  s_nop 0
  buffer_load_dwordx4 v202, s[4:7], s60 offen offset:896 lds
  s_add_u32 m0, s67, 44032
  s_nop 0
  buffer_load_dwordx4 v202, s[4:7], s60 offen offset:1024 lds
  buffer_store_dwordx4 v[176:179], v201, s[8:11], s72 offen offset:0 sc1
  buffer_store_dwordx4 v[176:179], v201, s[8:11], s72 offen offset:1024 sc1
  ds_read_b128 v[32:35], v203 offset:0
  ds_read_b128 v[36:39], v204 offset:0
  ds_read_b128 v[40:43], v205 offset:0
  s_waitcnt lgkmcnt(2)
  v_mfma_f32_32x32x16_bf16 v[240:255], a[0:3], v[32:35], 0
  ds_read_b128 v[44:47], v206 offset:0
  s_waitcnt lgkmcnt(2)
  v_mfma_f32_32x32x16_bf16 v[240:255], a[4:7], v[36:39], v[240:255]
  ds_read_b128 v[32:35], v203 offset:1024
  s_waitcnt lgkmcnt(2)
  v_mfma_f32_32x32x16_bf16 v[240:255], a[8:11], v[40:43], v[240:255]
  ds_read_b128 v[36:39], v204 offset:1024
  s_waitcnt lgkmcnt(2)
  v_mfma_f32_32x32x16_bf16 v[240:255], a[12:15], v[44:47], v[240:255]
  ds_read_b128 v[40:43], v205 offset:1024
  s_waitcnt lgkmcnt(2)
  v_mfma_f32_32x32x16_bf16 v[240:255], a[16:19], v[32:35], v[240:255]
  ds_read_b128 v[44:47], v206 offset:1024
  s_waitcnt lgkmcnt(2)
  v_mfma_f32_32x32x16_bf16 v[240:255], a[20:23], v[36:39], v[240:255]
  ds_read_b128 v[32:35], v203 offset:2048
  s_waitcnt lgkmcnt(2)
  v_mfma_f32_32x32x16_bf16 v[240:255], a[24:27], v[40:43], v[240:255]
  ds_read_b128 v[36:39], v204 offset:2048
  s_waitcnt lgkmcnt(2)
  v_mfma_f32_32x32x16_bf16 v[240:255], a[28:31], v[44:47], v[240:255]
  ds_read_b128 v[40:43], v205 offset:2048
  s_waitcnt lgkmcnt(2)
  v_mfma_f32_32x32x16_bf16 v[240:255], a[32:35], v[32:35], v[240:255]
  ds_read_b128 v[44:47], v206 offset:2048
  s_waitcnt lgkmcnt(2)
  v_mfma_f32_32x32x16_bf16 v[240:255], a[36:39], v[36:39], v[240:255]
  ds_read_b128 v[32:35], v203 offset:3072
  s_waitcnt lgkmcnt(2)
  v_mfma_f32_32x32x16_bf16 v[240:255], a[40:43], v[40:43], v[240:255]
  ds_read_b128 v[36:39], v204 offset:3072
  s_waitcnt lgkmcnt(2)
  v_mfma_f32_32x32x16_bf16 v[240:255], a[44:47], v[44:47], v[240:255]
  ds_read_b128 v[40:43], v205 offset:3072
  s_waitcnt lgkmcnt(2)
  v_mfma_f32_32x32x16_bf16 v[240:255], a[48:51], v[32:35], v[240:255]
  ds_read_b128 v[44:47], v206 offset:3072
  s_waitcnt lgkmcnt(2)
  v_mfma_f32_32x32x16_bf16 v[240:255], a[52:55], v[36:39], v[240:255]
  ds_read_b128 v[32:35], v203 offset:4096
  s_waitcnt lgkmcnt(2)
  v_mfma_f32_32x32x16_bf16 v[240:255], a[56:59], v[40:43], v[240:255]
  ds_read_b128 v[36:39], v204 offset:4096
  s_waitcnt lgkmcnt(2)
  v_mfma_f32_32x32x16_bf16 v[240:255], a[60:63], v[44:47], v[240:255]
  ds_read_b128 v[40:43], v205 offset:4096
  s_waitcnt lgkmcnt(2)
  v_mfma_f32_32x32x16_bf16 v[240:255], a[64:67], v[32:35], v[240:255]
  ds_read_b128 v[44:47], v206 offset:4096
  s_waitcnt lgkmcnt(2)
  v_mfma_f32_32x32x16_bf16 v[240:255], a[68:71], v[36:39], v[240:255]
  ds_read_b128 v[32:35], v203 offset:5120
  s_waitcnt lgkmcnt(2)
  v_mfma_f32_32x32x16_bf16 v[240:255], a[72:75], v[40:43], v[240:255]
  ds_read_b128 v[36:39], v204 offset:5120
  s_waitcnt lgkmcnt(2)
  v_mfma_f32_32x32x16_bf16 v[240:255], a[76:79], v[44:47], v[240:255]
  ds_read_b128 v[40:43], v205 offset:5120
  s_waitcnt lgkmcnt(2)
  v_mfma_f32_32x32x16_bf16 v[240:255], a[80:83], v[32:35], v[240:255]
  ds_read_b128 v[44:47], v206 offset:5120
  s_waitcnt lgkmcnt(2)
  v_mfma_f32_32x32x16_bf16 v[240:255], a[84:87], v[36:39], v[240:255]
  ds_read_b128 v[32:35], v203 offset:6144
  s_waitcnt lgkmcnt(2)
  v_mfma_f32_32x32x16_bf16 v[240:255], a[88:91], v[40:43], v[240:255]
  ds_read_b128 v[36:39], v204 offset:6144
  s_waitcnt lgkmcnt(2)
  v_mfma_f32_32x32x16_bf16 v[240:255], a[92:95], v[44:47], v[240:255]
  ds_read_b128 v[40:43], v205 offset:6144
  s_waitcnt lgkmcnt(2)
  v_mfma_f32_32x32x16_bf16 v[240:255], a[96:99], v[32:35], v[240:255]
  ds_read_b128 v[44:47], v206 offset:6144
  s_waitcnt lgkmcnt(2)
  v_mfma_f32_32x32x16_bf16 v[240:255], a[100:103], v[36:39], v[240:255]
  ds_read_b128 v[32:35], v203 offset:7168
  s_waitcnt lgkmcnt(2)
  v_mfma_f32_32x32x16_bf16 v[240:255], a[104:107], v[40:43], v[240:255]
  ds_read_b128 v[36:39], v204 offset:7168
  s_waitcnt lgkmcnt(2)
  v_mfma_f32_32x32x16_bf16 v[240:255], a[108:111], v[44:47], v[240:255]
  ds_read_b128 v[40:43], v205 offset:7168
  s_waitcnt lgkmcnt(2)
  v_mfma_f32_32x32x16_bf16 v[240:255], a[112:115], v[32:35], v[240:255]
  ds_read_b128 v[44:47], v206 offset:7168
  s_waitcnt lgkmcnt(2)
  v_mfma_f32_32x32x16_bf16 v[240:255], a[116:119], v[36:39], v[240:255]
  ds_read_b128 v[32:35], v203 offset:8192
  s_waitcnt lgkmcnt(2)
  v_mfma_f32_32x32x16_bf16 v[240:255], a[120:123], v[40:43], v[240:255]
  ds_read_b128 v[36:39], v204 offset:8192
  s_waitcnt lgkmcnt(2)
  v_mfma_f32_32x32x16_bf16 v[240:255], a[124:127], v[44:47], v[240:255]
  ds_read_b128 v[40:43], v205 offset:8192
  s_waitcnt lgkmcnt(2)
  v_mfma_f32_32x32x16_bf16 v[240:255], a[128:131], v[32:35], v[240:255]
  ds_read_b128 v[44:47], v206 offset:8192
  s_waitcnt lgkmcnt(2)
  v_mfma_f32_32x32x16_bf16 v[240:255], a[132:135], v[36:39], v[240:255]
  s_waitcnt lgkmcnt(1)
  v_mfma_f32_32x32x16_bf16 v[240:255], a[136:139], v[40:43], v[240:255]
  s_waitcnt lgkmcnt(0)
  v_mfma_f32_32x32x16_bf16 v[240:255], a[140:143], v[44:47], v[240:255]
  s_nop 11
  v_cvt_pk_bf16_f32 v16, v240, v244
  v_cvt_pk_bf16_f32 v17, v241, v245
  v_cvt_pk_bf16_f32 v18, v242, v246
  v_cvt_pk_bf16_f32 v19, v243, v247
  ds_write_b128 v215, v[16:19] offset:0
  v_cvt_pk_bf16_f32 v20, v248, v252
  v_cvt_pk_bf16_f32 v21, v249, v253
  v_cvt_pk_bf16_f32 v22, v250, v254
  v_cvt_pk_bf16_f32 v23, v251, v255
  ds_write_b128 v215, v[20:23] offset:1024
  s_waitcnt lgkmcnt(0)
  s_barrier
  ds_read_b128 v[96:99], v208 offset:0
  ds_read_b128 v[100:103], v208 offset:1024
  ds_read_b128 v[104:107], v208 offset:2048
  ds_read_b128 v[108:111], v208 offset:3072
  ds_read_b128 v[112:115], v208 offset:4096
  ds_read_b128 v[116:119], v208 offset:5120
  ds_read_b128 v[120:123], v208 offset:6144
  ds_read_b128 v[124:127], v208 offset:7168
  s_waitcnt vmcnt(11)
  v_cmp_eq_u32 vcc, -1, v172
  s_mov_b32 s69, 0
  s_cbranch_vccnz AT_e0
  s_mov_b32 s69, 1
  buffer_load_dwordx4 v[172:175], v201, s[8:11], s76 offen sc1
AT_e0:
  s_waitcnt lgkmcnt(7)
  v_mfma_f32_32x32x16_bf16 v[64:79], v[128:131], v[96:99], v[48:63]
  s_waitcnt lgkmcnt(6)
  v_mfma_f32_32x32x16_bf16 v[64:79], v[132:135], v[100:103], v[64:79]
  s_waitcnt lgkmcnt(5)
  v_mfma_f32_32x32x16_bf16 v[64:79], v[136:139], v[104:107], v[64:79]
  s_waitcnt lgkmcnt(4)
  v_mfma_f32_32x32x16_bf16 v[64:79], v[140:143], v[108:111], v[64:79]
  s_waitcnt lgkmcnt(3)
  v_mfma_f32_32x32x16_bf16 v[64:79], v[144:147], v[112:115], v[64:79]
  s_waitcnt lgkmcnt(2)
  v_mfma_f32_32x32x16_bf16 v[64:79], v[148:151], v[116:119], v[64:79]
  s_waitcnt lgkmcnt(1)
  v_mfma_f32_32x32x16_bf16 v[64:79], v[152:155], v[120:123], v[64:79]
  s_waitcnt lgkmcnt(0)
  v_mfma_f32_32x32x16_bf16 v[64:79], v[156:159], v[124:127], v[64:79]
  s_nop 11
  v_max3_f32 v180, v64, v65, v66
  v_max3_f32 v180, v180, v67, v68
  v_max3_f32 v180, v180, v69, v70
  v_max3_f32 v180, v180, v71, v72
  v_max3_f32 v180, v180, v73, v74
  v_max3_f32 v180, v180, v75, v76
  v_max3_f32 v180, v180, v77, v78
  v_max_f32 v180, v180, v79
  v_mov_b32 v181, v180
  s_nop 1
  v_permlane32_swap_b32 v180, v181
  v_max_f32 v180, v180, v181
  v_sub_f32 v64, v64, v180
  v_sub_f32 v65, v65, v180
  v_sub_f32 v66, v66, v180
  v_sub_f32 v67, v67, v180
  v_sub_f32 v68, v68, v180
  v_sub_f32 v69, v69, v180
  v_sub_f32 v70, v70, v180
  v_sub_f32 v71, v71, v180
  v_sub_f32 v72, v72, v180
  v_sub_f32 v73, v73, v180
  v_sub_f32 v74, v74, v180
  v_sub_f32 v75, v75, v180
  v_sub_f32 v76, v76, v180
  v_sub_f32 v77, v77, v180
  v_sub_f32 v78, v78, v180
  v_sub_f32 v79, v79, v180
  v_exp_f32 v64, v64
  v_exp_f32 v65, v65
  v_exp_f32 v66, v66
  v_exp_f32 v67, v67
  v_exp_f32 v68, v68
  v_exp_f32 v69, v69
  v_exp_f32 v70, v70
  v_exp_f32 v71, v71
  v_exp_f32 v72, v72
  v_exp_f32 v73, v73
  v_exp_f32 v74, v74
  v_exp_f32 v75, v75
  v_exp_f32 v76, v76
  v_exp_f32 v77, v77
  v_exp_f32 v78, v78
  v_exp_f32 v79, v79
  v_cvt_pk_bf16_f32 v20, v64, v65
  v_cvt_pk_bf16_f32 v21, v68, v69
  v_cvt_pk_bf16_f32 v22, v72, v73
  v_cvt_pk_bf16_f32 v23, v76, v77
  v_cvt_pk_bf16_f32 v24, v66, v67
  v_cvt_pk_bf16_f32 v25, v70, v71
  v_cvt_pk_bf16_f32 v26, v74, v75
  v_cvt_pk_bf16_f32 v27, v78, v79
  v_mfma_f32_32x32x16_bf16 v[0:15], v[160:163], v[20:23], 0
  v_add_f32 v182, v64, v65
  v_add_f32 v182, v182, v66
  v_add_f32 v182, v182, v67
  v_add_f32 v182, v182, v68
  v_add_f32 v182, v182, v69
  v_add_f32 v182, v182, v70
  v_add_f32 v182, v182, v71
  v_mfma_f32_32x32x16_bf16 v[0:15], v[164:167], v[24:27], v[0:15]
  v_add_f32 v182, v182, v72
  v_add_f32 v182, v182, v73
  v_add_f32 v182, v182, v74
  v_add_f32 v182, v182, v75
  v_add_f32 v182, v182, v76
  v_add_f32 v182, v182, v77
  v_add_f32 v182, v182, v78
  v_add_f32 v182, v182, v79
AT_l1:
  s_cmp_eq_u32 s69, 1
  s_cbranch_scc1 AT_v1
  s_cmp_ge_u32 s77, 62
  s_cbranch_scc1 AT_k1
  s_branch AT_c1
AT_h1:
  s_sleep 2
AT_c1:
  buffer_load_dword v172, off, s[8:11], s70 sc1
  s_add_u32 s65, s65, 1
  s_cmp_lt_u32 s65, 131072
  s_cselect_b32 s54, -2, -1
  s_waitcnt vmcnt(0)
  v_cmp_lt_u32 vcc, s54, v172
  s_cbranch_vccnz AT_h1
AT_k1:
  buffer_load_dwordx4 v[172:175], v201, s[8:11], s76 offen sc1
AT_v1:
  s_mov_b32 s69, 0
  s_add_u32 s65, s65, 1
  s_cmp_lt_u32 s65, 131072
  s_cselect_b32 s54, -2, -1
  s_waitcnt vmcnt(0)
  ds_write_b64 v220, v[172:173] offset:4096
  ds_write_b64 v221, v[174:175] offset:4096
  v_max3_u32 v213, v172, v173, v174
  v_max_u32 v213, v213, v175
  v_cmp_lt_u32 vcc, s54, v213
  s_cbranch_vccnz AT_k1
  s_waitcnt lgkmcnt(0)
  s_barrier
  ds_read_b128 v[128:131], v218 offset:4096
  ds_read_b128 v[132:135], v218 offset:4352
  ds_read_b128 v[136:139], v218 offset:4608
  ds_read_b128 v[140:143], v218 offset:4864
  ds_read_b128 v[144:147], v218 offset:5120
  ds_read_b128 v[148:151], v218 offset:5376
  ds_read_b128 v[152:155], v218 offset:5632
  ds_read_b128 v[156:159], v218 offset:5888
  ds_read_b32 v168, v219 offset:4096
  ds_read_b32 v169, v219 offset:4224
  s_waitcnt lgkmcnt(9)
  v_mfma_f32_32x32x16_bf16 v[80:95], v[128:131], a[144:147], 0
  s_waitcnt lgkmcnt(8)
  v_mfma_f32_32x32x16_bf16 v[80:95], v[132:135], a[148:151], v[80:95]
  s_waitcnt lgkmcnt(7)
  v_mfma_f32_32x32x16_bf16 v[80:95], v[136:139], a[152:155], v[80:95]
  s_waitcnt lgkmcnt(6)
  v_mfma_f32_32x32x16_bf16 v[80:95], v[140:143], a[156:159], v[80:95]
  s_waitcnt lgkmcnt(5)
  v_mfma_f32_32x32x16_bf16 v[80:95], v[144:147], a[160:163], v[80:95]
  s_waitcnt lgkmcnt(4)
  v_mfma_f32_32x32x16_bf16 v[80:95], v[148:151], a[164:167], v[80:95]
  s_waitcnt lgkmcnt(3)
  v_mfma_f32_32x32x16_bf16 v[80:95], v[152:155], a[168:171], v[80:95]
  s_waitcnt lgkmcnt(2)
  v_mfma_f32_32x32x16_bf16 v[80:95], v[156:159], a[172:175], v[80:95]
  s_add_u32 s77, s77, 2
  v_mov_b32 v212, s77
  s_nop 9
  v_mul_f32 v80, s68, v80
  v_mul_f32 v81, s68, v81
  v_mul_f32 v82, s68, v82
  v_mul_f32 v83, s68, v83
  v_max3_f32 v84, v184, v80, v81
  v_max3_f32 v84, v84, v82, v83
  v_mov_b32 v85, v84
  s_nop 1
  v_permlane32_swap_b32 v84, v85
  v_max_f32 v84, v84, v85
  v_sub_f32 v86, v184, v84
  v_sub_f32 v80, v80, v84
  v_sub_f32 v81, v81, v84
  v_sub_f32 v82, v82, v84
  v_sub_f32 v83, v83, v84
  v_exp_f32 v86, v86
  v_exp_f32 v80, v80
  v_exp_f32 v81, v81
  v_exp_f32 v82, v82
  v_exp_f32 v83, v83
  v_fma_f32 v186, v186, v86, v80
  v_add_f32 v84, v81, v82
  v_add_f32 v186, v186, v83
  v_add_f32 v186, v186, v84
  v_mov_b32 v187, v186
  s_nop 1
  v_permlane32_swap_b32 v186, v187
  v_add_f32 v186, v186, v187
  v_rcp_f32 v186, v186
  s_nop 0
  v_mul_f32 v86, v86, v186
  v_mul_f32 v80, v186, v80
  v_mul_f32 v81, v186, v81
  v_mul_f32 v82, v186, v82
  v_mul_f32 v83, v186, v83
  v_cvt_pk_bf16_f32 v28, v80, v81
  v_cvt_pk_bf16_f32 v29, v82, v83
  v_mul_f32 v224, v86, v224
  v_mul_f32 v225, v86, v225
  v_mul_f32 v226, v86, v226
  v_mul_f32 v227, v86, v227
  v_mul_f32 v228, v86, v228
  v_mul_f32 v229, v86, v229
  v_mul_f32 v230, v86, v230
  v_mul_f32 v231, v86, v231
  v_mul_f32 v232, v86, v232
  v_mul_f32 v233, v86, v233
  v_mul_f32 v234, v86, v234
  v_mul_f32 v235, v86, v235
  v_mul_f32 v236, v86, v236
  v_mul_f32 v237, v86, v237
  v_mul_f32 v238, v86, v238
  v_mul_f32 v239, v86, v239
  s_waitcnt lgkmcnt(0)
  s_nop 0
  v_mfma_f32_32x32x8_bf16 v[224:239], v[168:169], v[28:29], v[224:239]
  s_nop 11
  v_cvt_pk_bf16_f32 v20, v224, v225
  v_cvt_pk_bf16_f32 v21, v226, v227
  v_cvt_pk_bf16_f32 v22, v228, v229
  v_cvt_pk_bf16_f32 v23, v230, v231
  buffer_store_dwordx4 v[20:23], v201, s[8:11], s75 offen offset:0 sc1
  v_cvt_pk_bf16_f32 v24, v232, v233
  v_cvt_pk_bf16_f32 v25, v234, v235
  v_cvt_pk_bf16_f32 v26, v236, v237
  v_cvt_pk_bf16_f32 v27, v238, v239
  buffer_store_dwordx4 v[24:27], v201, s[8:11], s75 offen offset:1024 sc1
  s_mov_b64 exec, 1
  buffer_store_dword v212, v201, s[8:11], s71 offen sc1
  s_mov_b64 exec, -1
  s_cmp_ge_u32 s77, 64
  s_cbranch_scc1 L_exit
  s_branch AT_loop
L_cexit:
L_exit:
L_end:
s_endpgm
.section .rodata,"a"
.p2align 6
.amdhsa_kernel gated_mix__sliding_local_dilated__memory_aug_recurrent_mem_tr__prompt_kernel
  .amdhsa_next_free_vgpr 512
  .amdhsa_next_free_sgpr 102
  .amdhsa_accum_offset 256
  .amdhsa_group_segment_fixed_size 0
  .amdhsa_kernarg_size 112
  .amdhsa_user_sgpr_count 2
  .amdhsa_user_sgpr_kernarg_segment_ptr 1
  .amdhsa_system_sgpr_workgroup_id_x 1
.end_amdhsa_kernel
```

```asm
; @launch grid=(256,1,1) block=(256,1,1) lds=163840
.amdgcn_target "amdgcn-amd-amdhsa--gfx950"
.text
.globl gated_mix__sliding_local_dilated__memory_aug_recurrent_mem_tr__prompt_kernel
.p2align 8
.type gated_mix__sliding_local_dilated__memory_aug_recurrent_mem_tr__prompt_kernel,@function
gated_mix__sliding_local_dilated__memory_aug_recurrent_mem_tr__prompt_kernel:
  s_cmp_ge_u32 s2, 256
  s_cbranch_scc1 L_end
  s_load_dwordx2 s[4:5], s[0:1], 0
  s_load_dwordx2 s[8:9], s[0:1], 104
  s_load_dwordx2 s[12:13], s[0:1], 96
  s_load_dwordx2 s[16:17], s[0:1], 40
  s_load_dwordx2 s[20:21], s[0:1], 48
  s_load_dwordx2 s[24:25], s[0:1], 56
  s_load_dwordx2 s[28:29], s[0:1], 64
  s_load_dwordx2 s[32:33], s[0:1], 32
  s_load_dwordx2 s[36:37], s[0:1], 8
  s_load_dwordx2 s[40:41], s[0:1], 16
  s_load_dwordx2 s[44:45], s[0:1], 80
  s_load_dwordx2 s[48:49], s[0:1], 88
  s_getreg_b32 s54, hwreg(HW_REG_XCC_ID, 0, 3)
  v_lshrrev_b32 v1, 6, v0
  s_nop 0
  v_readfirstlane_b32 s52, v1
  s_mov_b32 s6, 2359296
  s_mov_b32 s7, 0x20000
  s_mov_b32 s10, 268435456
  s_mov_b32 s11, 0x20000
  s_mov_b32 s14, 256
  s_mov_b32 s15, 0x20000
  s_mov_b32 s18, 4718592
  s_mov_b32 s19, 0x20000
  s_mov_b32 s22, 4718592
  s_mov_b32 s23, 0x20000
  s_mov_b32 s26, 4718592
  s_mov_b32 s27, 0x20000
  s_mov_b32 s30, 4718592
  s_mov_b32 s31, 0x20000
  s_mov_b32 s34, 9216
  s_mov_b32 s35, 0x20000
  s_mov_b32 s38, 1990656
  s_mov_b32 s39, 0x20000
  s_mov_b32 s42, 663552
  s_mov_b32 s43, 0x20000
  s_mov_b32 s46, 1152
  s_mov_b32 s47, 0x20000
  s_mov_b32 s50, 2359296
  s_mov_b32 s51, 0x20000
  s_waitcnt lgkmcnt(0)
  s_lshr_b32 s0, s2, 3
  s_mov_b32 s2, s54
  s_mov_b32 s1, 0
  s_lshl_b32 s55, s2, 2
  s_cmp_eq_u32 s52, 0
  s_cselect_b32 s55, s55, 0x1000
  s_lshl_b32 s56, 1, s0
  v_mov_b32 v1, 0
  v_mov_b32 v35, s56
  s_mov_b64 exec, 1
  buffer_atomic_or v35, v1, s[12:15], s55 offen sc0
  s_mov_b64 exec, -1
L_role:
  s_mov_b32 s53, s0
  s_cmp_eq_u32 s2, 0
  s_cbranch_scc0 L_worker
  v_and_b32 v0, 63, v0
  v_and_b32 v1, 15, v0
  v_lshrrev_b32 v2, 4, v0
  v_and_b32 v3, 1, v2
  s_lshl_b32 s54, s52, 1
  v_add_u32 v3, s54, v3
  v_lshlrev_b32 v3, 1, v3
  v_xor_b32 v3, v3, v1
  v_lshlrev_b32 v3, 4, v3
  v_lshl_add_u32 v8, v2, 13, v3
  s_lshl_b32 s78, s53, 8
  s_lshl_b32 s54, s52, 15
  s_add_u32 s78, s78, s54
  s_mul_i32 s79, s53, 147456
  s_lshl_b32 s57, s52, 10
  s_add_u32 s57, s57, 16384
  s_getpc_b64 s[80:81]
L_pc_1:
  s_and_b32 s55, s0, 1
  s_lshl_b32 s55, s55, 2
  s_add_u32 s55, s55, s52
  s_lshl_b32 s55, s55, 10
  v_and_b32 v199, 63, v0
  v_lshl_add_u32 v199, v199, 4, s55
  v_min_u32 v199, (L_w0 - L_pc_1), v199
  global_load_dword v196, v199, s[80:81]
  s_add_u32 m0, s57, 0
  s_add_u32 s54, s78, 524288
  buffer_load_dwordx4 v8, s[16:19], s54 offen  lds
  s_add_u32 m0, s57, 4096
  s_add_u32 s54, s78, 655360
  buffer_load_dwordx4 v8, s[16:19], s54 offen  lds
  s_add_u32 m0, s57, 8192
  s_add_u32 s54, s78, 786432
  buffer_load_dwordx4 v8, s[16:19], s54 offen  lds
  s_add_u32 m0, s57, 12288
  s_add_u32 s54, s78, 917504
  buffer_load_dwordx4 v8, s[16:19], s54 offen  lds
  s_add_u32 m0, s57, 16384
  s_add_u32 s54, s78, 1048576
  buffer_load_dwordx4 v8, s[16:19], s54 offen  lds
  s_add_u32 m0, s57, 20480
  s_add_u32 s54, s78, 1179648
  buffer_load_dwordx4 v8, s[16:19], s54 offen  lds
  s_add_u32 m0, s57, 24576
  s_add_u32 s54, s78, 1310720
  buffer_load_dwordx4 v8, s[16:19], s54 offen  lds
  s_add_u32 m0, s57, 28672
  s_add_u32 s54, s78, 1441792
  buffer_load_dwordx4 v8, s[16:19], s54 offen  lds
  s_add_u32 m0, s57, 32768
  s_add_u32 s54, s78, 1572864
  buffer_load_dwordx4 v8, s[16:19], s54 offen  lds
  s_add_u32 m0, s57, 36864
  s_add_u32 s54, s78, 1703936
  buffer_load_dwordx4 v8, s[16:19], s54 offen  lds
  s_add_u32 m0, s57, 40960
  s_add_u32 s54, s78, 1835008
  buffer_load_dwordx4 v8, s[16:19], s54 offen  lds
  s_add_u32 m0, s57, 45056
  s_add_u32 s54, s78, 1966080
  buffer_load_dwordx4 v8, s[16:19], s54 offen  lds
  s_add_u32 m0, s57, 49152
  s_add_u32 s54, s78, 2097152
  buffer_load_dwordx4 v8, s[16:19], s54 offen  lds
  s_add_u32 m0, s57, 53248
  s_add_u32 s54, s78, 2228224
  buffer_load_dwordx4 v8, s[16:19], s54 offen  lds
  s_add_u32 m0, s57, 57344
  s_add_u32 s54, s78, 2359296
  buffer_load_dwordx4 v8, s[16:19], s54 offen  lds
  s_add_u32 m0, s57, 61440
  s_add_u32 s54, s78, 2490368
  buffer_load_dwordx4 v8, s[16:19], s54 offen  lds
  s_add_u32 m0, s57, 65536
  s_add_u32 s54, s78, 2621440
  buffer_load_dwordx4 v8, s[16:19], s54 offen  lds
  s_add_u32 m0, s57, 69632
  s_add_u32 s54, s78, 2752512
  buffer_load_dwordx4 v8, s[16:19], s54 offen  lds
  s_add_u32 m0, s57, 73728
  s_add_u32 s54, s78, 2883584
  buffer_load_dwordx4 v8, s[16:19], s54 offen  lds
  s_add_u32 m0, s57, 77824
  s_add_u32 s54, s78, 3014656
  buffer_load_dwordx4 v8, s[16:19], s54 offen  lds
  v_lshlrev_b32 v76, 4, v0
  v_add_u32 v75, 0x10000, v76
  v_lshrrev_b32 v3, 2, v1
  v_and_b32 v4, 1, v1
  v_lshl_add_u32 v3, v3, 1, v4
  v_bfe_u32 v4, v1, 1, 1
  v_mul_u32_u24 v74, 0xaaaa, v4
  v_add_u32 v74, 0x4444, v74
  v_mul_u32_u24 v5, 576, v3
  v_add_u32 v5, 0, v5
  v_lshl_add_u32 v78, v2, 4, v5
  v_lshl_add_u32 v77, v2, 5, v5
  v_lshl_add_u32 v77, v4, 4, v77
  v_mul_u32_u24 v15, 1152, v3
  v_lshl_add_u32 v15, v2, 5, v15
  v_lshl_add_u32 v15, v4, 4, v15
  s_lshl_b32 s54, s52, 8
  buffer_load_dwordx4 v[20:23], v15, s[32:35], s54 offen
  buffer_load_dwordx4 v[24:27], v15, s[32:35], s54 offen offset:128
  buffer_load_dwordx4 v[28:31], v15, s[32:35], 0 offen offset:1024
  v_mul_u32_u24 v79, 1152, v2
  v_lshl_add_u32 v79, v1, 2, v79
  s_lshl_b32 s54, s52, 6
  s_add_u32 s54, s54, 0
  v_add_u32 v79, s54, v79
  v_lshrrev_b32 v5, 3, v0
  v_mul_u32_u24 v68, 2176, v5
  v_and_b32 v5, 7, v0
  v_lshl_add_u32 v68, v5, 3, v68
  v_and_b32 v5, 1, v2
  v_lshlrev_b32 v5, 4, v5
  v_lshl_add_u32 v5, v1, 2, v5
  v_mov_b32 v6, 0x40000000
  v_cmp_lt_u32 vcc, 3, v1
  s_nop 1
  v_cndmask_b32 v5, v5, v6, vcc
  v_lshrrev_b32 v6, 1, v2
  v_lshl_add_u32 v69, v6, 10, v5
  v_lshl_add_u32 v70, v6, 8, v5
  v_mov_b32 v71, -1
  ds_write_b128 v76, v[68:71] offset:13824
  v_and_b32 v5, 3, v1
  v_lshrrev_b32 v6, 2, v1
  v_lshl_add_u32 v5, v5, 2, v6
  v_and_b32 v6, 1, v5
  v_lshlrev_b32 v6, 4, v6
  v_mov_b32 v7, 0x3f80
  v_lshlrev_b32 v6, v6, v7
  v_lshrrev_b32 v5, 1, v5
  v_cmp_eq_u32 vcc, 0, v5
  s_nop 1
  v_cndmask_b32 v40, 0, v6, vcc
  v_cmp_eq_u32 vcc, 1, v5
  s_nop 1
  v_cndmask_b32 v41, 0, v6, vcc
  v_cmp_eq_u32 vcc, 2, v5
  s_nop 1
  v_cndmask_b32 v42, 0, v6, vcc
  v_cmp_eq_u32 vcc, 3, v5
  s_nop 1
  v_cndmask_b32 v43, 0, v6, vcc
  ds_write_b128 v76, v[40:43] offset:14848
  s_and_b32 s54, s52, 1
  s_lshr_b32 s55, s52, 1
  v_lshrrev_b32 v3, 3, v0
  v_and_b32 v4, 1, v3
  v_lshlrev_b32 v4, 4, v4
  v_and_b32 v5, 6, v3
  v_add_u32 v4, v4, v5
  s_lshl_b32 s56, s55, 3
  s_add_u32 s56, s56, s54
  v_add_u32 v4, s56, v4
  v_mul_u32_u24 v4, 1152, v4
  v_and_b32 v5, 2, v3
  v_lshlrev_b32 v5, 1, v5
  v_and_b32 v6, 7, v0
  v_xor_b32 v6, v6, v5
  v_lshl_add_u32 v9, v6, 4, v4
  v_and_b32 v4, 1, v2
  v_lshlrev_b32 v4, 4, v4
  v_and_b32 v5, 2, v2
  v_add_u32 v4, v4, v5
  s_lshl_b32 s56, s55, 2
  s_add_u32 s56, s56, s54
  v_add_u32 v4, s56, v4
  v_mul_u32_u24 v4, 1152, v4
  v_lshlrev_b32 v6, 1, v2
  v_xor_b32 v6, v6, v1
  v_lshl_add_u32 v10, v6, 4, v4
  v_bfe_u32 v17, v1, 2, 1
  v_bfe_u32 v18, v1, 3, 1
  v_and_b32 v19, 1, v2
  v_lshrrev_b32 v72, 1, v2
  v_and_b32 v73, 3, v1
  v_lshl_add_u32 v3, v19, 1, v17
  v_lshl_add_u32 v6, v18, 2, v3
  v_lshl_add_u32 v4, v72, 4, v17
  v_lshl_add_u32 v4, v19, 2, v4
  v_lshl_add_u32 v4, v18, 3, v4
  v_lshlrev_b32 v4, 8, v4
  s_lshl_b32 s54, s52, 6
  v_lshl_add_u32 v5, v73, 3, s54
  v_lshlrev_b32 v7, 5, v6
  v_xor_b32 v5, v5, v7
  v_add_u32 v11, v4, v5
  v_xor_b32 v12, 32, v11
  v_lshl_add_u32 v4, v72, 2, v3
  v_lshlrev_b32 v4, 7, v4
  v_lshl_add_u32 v4, v73, 3, v4
  s_and_b32 s54, s52, 1
  v_xor_b32 v7, s54, v19
  v_lshl_add_u32 v7, v7, 1, v18
  v_lshl_add_u32 v13, v7, 5, v4
  v_lshlrev_b32 v4, 11, v72
  v_lshl_add_u32 v4, v73, 3, v4
  v_lshl_add_u32 v5, v3, 8, v4
  v_lshl_add_u32 v7, v18, 2, s52
  v_xor_b32 v7, v7, v3
  v_lshl_add_u32 v14, v7, 5, v5
  s_lshl_b32 s54, s53, 14
  s_lshl_b32 s55, s52, 11
  s_add_u32 s54, s54, 1048576
  s_add_u32 s58, s54, s55
  s_add_u32 s59, s58, 8192
  s_lshl_b32 s55, s52, 12
  s_add_u32 s70, s54, s55
  s_add_u32 s70, s70, 655360
  s_lshl_b32 s54, s53, 12
  s_lshl_b32 s55, s52, 10
  s_add_u32 s54, s54, s55
  s_add_u32 s68, s54, 917504
  s_lshl_b32 s54, s53, 6
  s_mul_i32 s55, s52, 17408
  s_add_u32 s55, s54, s55
  s_add_u32 s73, s55, 0
  s_add_u32 s74, s55, 69632
  s_add_u32 s75, s55, 139264
  s_add_u32 s76, s55, 208896
  s_and_b32 s56, s52, 1
  s_mul_i32 s55, s56, 17408
  s_add_u32 s55, s54, s55
  s_add_u32 s77, s55, 278528
  s_mul_i32 s54, s52, 69632
  s_mul_i32 s55, s53, 2176
  s_add_u32 s54, s54, s55
  s_add_u32 s60, s54, 0
  s_and_b32 s56, s53, 15
  s_mul_i32 s55, s56, 2176
  s_add_u32 s61, s55, 278528
  s_lshl_b32 s54, s52, 11
  s_add_u32 s64, s54, 360448
  s_mov_b32 s65, 368640
  s_lshl_b32 s55, s53, 5
  s_add_u32 s54, s54, s55
  s_add_u32 s62, s54, 376832
  s_lshr_b32 s54, s56, 3
  s_lshl_b32 s54, s54, 9
  s_and_b32 s55, s56, 7
  s_lshl_b32 s55, s55, 5
  s_add_u32 s54, s54, s55
  s_add_u32 s63, s54, 385024
  s_mov_b32 s66, 0
  s_mov_b32 s67, 0
  s_mov_b32 s72, 0
  s_mov_b32 s69, 1040356334
  s_waitcnt vmcnt(19) lgkmcnt(0)
  s_barrier
  s_add_u32 m0, s57, 81920
  s_add_u32 s54, s78, 3145728
  buffer_load_dwordx4 v8, s[16:19], s54 offen  lds
  s_add_u32 m0, s57, 86016
  s_add_u32 s54, s78, 3276800
  buffer_load_dwordx4 v8, s[16:19], s54 offen  lds
  s_add_u32 m0, s57, 90112
  s_add_u32 s54, s78, 3407872
  buffer_load_dwordx4 v8, s[16:19], s54 offen  lds
  s_add_u32 m0, s57, 94208
  s_add_u32 s54, s78, 3538944
  buffer_load_dwordx4 v8, s[16:19], s54 offen  lds
  v_add_u32 v15, 16384, v11
  v_add_u32 v16, 16384, v12
  ds_read_b64_tr_b16 v[80:81], v15 offset:0
  ds_read_b64_tr_b16 v[82:83], v15 offset:512
  ds_read_b64_tr_b16 v[84:85], v15 offset:8192
  ds_read_b64_tr_b16 v[86:87], v15 offset:8704
  ds_read_b64_tr_b16 v[88:89], v16 offset:0
  ds_read_b64_tr_b16 v[90:91], v16 offset:512
  ds_read_b64_tr_b16 v[92:93], v16 offset:8192
  ds_read_b64_tr_b16 v[94:95], v16 offset:8704
  s_waitcnt vmcnt(19) lgkmcnt(0)
  s_barrier
  s_add_u32 m0, s57, 98304
  s_add_u32 s54, s78, 3670016
  buffer_load_dwordx4 v8, s[16:19], s54 offen  lds
  s_add_u32 m0, s57, 102400
  s_add_u32 s54, s78, 3801088
  buffer_load_dwordx4 v8, s[16:19], s54 offen  lds
  s_add_u32 m0, s57, 106496
  s_add_u32 s54, s78, 3932160
  buffer_load_dwordx4 v8, s[16:19], s54 offen  lds
  s_add_u32 m0, s57, 110592
  s_add_u32 s54, s78, 4063232
  buffer_load_dwordx4 v8, s[16:19], s54 offen  lds
  v_add_u32 v15, 32768, v11
  v_add_u32 v16, 32768, v12
  ds_read_b64_tr_b16 v[96:97], v15 offset:0
  ds_read_b64_tr_b16 v[98:99], v15 offset:512
  ds_read_b64_tr_b16 v[100:101], v15 offset:8192
  ds_read_b64_tr_b16 v[102:103], v15 offset:8704
  ds_read_b64_tr_b16 v[104:105], v16 offset:0
  ds_read_b64_tr_b16 v[106:107], v16 offset:512
  ds_read_b64_tr_b16 v[108:109], v16 offset:8192
  ds_read_b64_tr_b16 v[110:111], v16 offset:8704
  s_waitcnt vmcnt(19) lgkmcnt(0)
  s_barrier
  s_add_u32 m0, s57, 114688
  s_add_u32 s54, s78, 4194304
  buffer_load_dwordx4 v8, s[16:19], s54 offen  lds
  s_add_u32 m0, s57, 118784
  s_add_u32 s54, s78, 4325376
  buffer_load_dwordx4 v8, s[16:19], s54 offen  lds
  s_add_u32 m0, s57, 122880
  s_add_u32 s54, s78, 4456448
  buffer_load_dwordx4 v8, s[16:19], s54 offen  lds
  s_add_u32 m0, s57, 126976
  s_add_u32 s54, s78, 4587520
  buffer_load_dwordx4 v8, s[16:19], s54 offen  lds
  v_add_u32 v15, 49152, v11
  v_add_u32 v16, 49152, v12
  ds_read_b64_tr_b16 v[112:113], v15 offset:0
  ds_read_b64_tr_b16 v[114:115], v15 offset:512
  ds_read_b64_tr_b16 v[116:117], v15 offset:8192
  ds_read_b64_tr_b16 v[118:119], v15 offset:8704
  ds_read_b64_tr_b16 v[120:121], v16 offset:0
  ds_read_b64_tr_b16 v[122:123], v16 offset:512
  ds_read_b64_tr_b16 v[124:125], v16 offset:8192
  ds_read_b64_tr_b16 v[126:127], v16 offset:8704
  s_waitcnt vmcnt(19) lgkmcnt(0)
  s_barrier
  s_add_u32 m0, s57, 131072
  s_add_u32 s54, s78, 524288
  buffer_load_dwordx4 v8, s[20:23], s54 offen  lds
  s_add_u32 m0, s57, 135168
  s_add_u32 s54, s78, 655360
  buffer_load_dwordx4 v8, s[20:23], s54 offen  lds
  s_add_u32 m0, s57, 139264
  s_add_u32 s54, s78, 786432
  buffer_load_dwordx4 v8, s[20:23], s54 offen  lds
  s_add_u32 m0, s57, 143360
  s_add_u32 s54, s78, 917504
  buffer_load_dwordx4 v8, s[20:23], s54 offen  lds
  v_add_u32 v15, 65536, v11
  v_add_u32 v16, 65536, v12
  ds_read_b64_tr_b16 v[128:129], v15 offset:0
  ds_read_b64_tr_b16 v[130:131], v15 offset:512
  ds_read_b64_tr_b16 v[132:133], v15 offset:8192
  ds_read_b64_tr_b16 v[134:135], v15 offset:8704
  ds_read_b64_tr_b16 v[136:137], v16 offset:0
  ds_read_b64_tr_b16 v[138:139], v16 offset:512
  ds_read_b64_tr_b16 v[140:141], v16 offset:8192
  ds_read_b64_tr_b16 v[142:143], v16 offset:8704
  s_waitcnt vmcnt(19) lgkmcnt(0)
  s_barrier
  s_add_u32 m0, s57, 0
  s_add_u32 s54, s78, 1572864
  buffer_load_dwordx4 v8, s[20:23], s54 offen  lds
  s_add_u32 m0, s57, 4096
  s_add_u32 s54, s78, 1703936
  buffer_load_dwordx4 v8, s[20:23], s54 offen  lds
  s_add_u32 m0, s57, 8192
  s_add_u32 s54, s78, 1835008
  buffer_load_dwordx4 v8, s[20:23], s54 offen  lds
  s_add_u32 m0, s57, 12288
  s_add_u32 s54, s78, 1966080
  buffer_load_dwordx4 v8, s[20:23], s54 offen  lds
  v_add_u32 v15, 81920, v11
  v_add_u32 v16, 81920, v12
  ds_read_b64_tr_b16 v[144:145], v15 offset:0
  ds_read_b64_tr_b16 v[146:147], v15 offset:512
  ds_read_b64_tr_b16 v[148:149], v15 offset:8192
  ds_read_b64_tr_b16 v[150:151], v15 offset:8704
  ds_read_b64_tr_b16 v[152:153], v16 offset:0
  ds_read_b64_tr_b16 v[154:155], v16 offset:512
  ds_read_b64_tr_b16 v[156:157], v16 offset:8192
  ds_read_b64_tr_b16 v[158:159], v16 offset:8704
  s_waitcnt vmcnt(16) lgkmcnt(0)
  s_barrier
  s_add_u32 m0, s57, 16384
  s_add_u32 s54, s78, 3145728
  buffer_load_dwordx4 v8, s[20:23], s54 offen  lds
  s_add_u32 m0, s57, 20480
  s_add_u32 s54, s78, 3276800
  buffer_load_dwordx4 v8, s[20:23], s54 offen  lds
  s_add_u32 m0, s57, 24576
  s_add_u32 s54, s78, 3407872
  buffer_load_dwordx4 v8, s[20:23], s54 offen  lds
  s_add_u32 m0, s57, 28672
  s_add_u32 s54, s78, 3538944
  buffer_load_dwordx4 v8, s[20:23], s54 offen  lds
  v_add_u32 v15, 98304, v11
  v_add_u32 v16, 98304, v12
  ds_read_b64_tr_b16 v[160:161], v15 offset:0
  ds_read_b64_tr_b16 v[162:163], v15 offset:512
  ds_read_b64_tr_b16 v[164:165], v15 offset:8192
  ds_read_b64_tr_b16 v[166:167], v15 offset:8704
  ds_read_b64_tr_b16 v[168:169], v16 offset:0
  ds_read_b64_tr_b16 v[170:171], v16 offset:512
  ds_read_b64_tr_b16 v[172:173], v16 offset:8192
  ds_read_b64_tr_b16 v[174:175], v16 offset:8704
  s_waitcnt vmcnt(16) lgkmcnt(0)
  s_barrier
  s_add_u32 m0, s57, 32768
  s_add_u32 s54, s78, 3670016
  buffer_load_dwordx4 v8, s[20:23], s54 offen  lds
  s_add_u32 m0, s57, 36864
  s_add_u32 s54, s78, 3801088
  buffer_load_dwordx4 v8, s[20:23], s54 offen  lds
  s_add_u32 m0, s57, 40960
  s_add_u32 s54, s78, 3932160
  buffer_load_dwordx4 v8, s[20:23], s54 offen  lds
  s_add_u32 m0, s57, 45056
  s_add_u32 s54, s78, 4063232
  buffer_load_dwordx4 v8, s[20:23], s54 offen  lds
  s_cmp_eq_u32 s1, 1
  s_cbranch_scc1 C_ver_ok
  v_mov_b32 v33, 16320
  s_cmp_eq_u32 s52, 0
  s_cbranch_scc0 C_ver_b
  s_waitcnt vmcnt(52)
  s_mov_b64 exec, 1
  ds_write_b32 v33, v35
  s_mov_b64 exec, -1
  s_waitcnt lgkmcnt(0)
C_ver_b:
  s_barrier
  ds_read_b32 v32, v33
  s_waitcnt lgkmcnt(0)
  v_readfirstlane_b32 s54, v32
  s_nop 0
  s_bitcmp1_b32 s54, s0
  s_cbranch_scc1 L_conf
C_ver_ok:
  v_add_u32 v15, 114688, v11
  v_add_u32 v16, 114688, v12
  ds_read_b64_tr_b16 v[176:177], v15 offset:0
  ds_read_b64_tr_b16 v[178:179], v15 offset:512
  ds_read_b64_tr_b16 v[180:181], v15 offset:8192
  ds_read_b64_tr_b16 v[182:183], v15 offset:8704
  ds_read_b64_tr_b16 v[184:185], v16 offset:0
  ds_read_b64_tr_b16 v[186:187], v16 offset:512
  ds_read_b64_tr_b16 v[188:189], v16 offset:8192
  ds_read_b64_tr_b16 v[190:191], v16 offset:8704
  s_waitcnt vmcnt(16) lgkmcnt(0)
  s_barrier
  s_add_u32 m0, s57, 49152
  s_add_u32 s54, s78, 4194304
  buffer_load_dwordx4 v8, s[20:23], s54 offen  lds
  s_add_u32 m0, s57, 53248
  s_add_u32 s54, s78, 4325376
  buffer_load_dwordx4 v8, s[20:23], s54 offen  lds
  s_add_u32 m0, s57, 57344
  s_add_u32 s54, s78, 4456448
  buffer_load_dwordx4 v8, s[20:23], s54 offen  lds
  s_add_u32 m0, s57, 61440
  s_add_u32 s54, s78, 4587520
  buffer_load_dwordx4 v8, s[20:23], s54 offen  lds
  v_add_u32 v15, 131072, v11
  v_add_u32 v16, 131072, v12
  ds_read_b64_tr_b16 v[192:193], v15 offset:0
  ds_read_b64_tr_b16 v[194:195], v15 offset:512
  ds_read_b64_tr_b16 v[196:197], v15 offset:8192
  ds_read_b64_tr_b16 v[198:199], v15 offset:8704
  ds_read_b64_tr_b16 v[200:201], v16 offset:0
  ds_read_b64_tr_b16 v[202:203], v16 offset:512
  ds_read_b64_tr_b16 v[204:205], v16 offset:8192
  ds_read_b64_tr_b16 v[206:207], v16 offset:8704
  s_waitcnt vmcnt(16) lgkmcnt(0)
  s_barrier
  s_add_u32 m0, s57, 65536
  s_add_u32 s54, s78, 0
  buffer_load_dwordx4 v8, s[24:27], s54 offen  lds
  s_add_u32 m0, s57, 69632
  s_add_u32 s54, s78, 131072
  buffer_load_dwordx4 v8, s[24:27], s54 offen  lds
  s_add_u32 m0, s57, 73728
  s_add_u32 s54, s78, 262144
  buffer_load_dwordx4 v8, s[24:27], s54 offen  lds
  s_add_u32 m0, s57, 77824
  s_add_u32 s54, s78, 393216
  buffer_load_dwordx4 v8, s[24:27], s54 offen  lds
  s_getpc_b64 s[80:81]
  v_lshlrev_b32 v7, 2, v76
  global_load_dword v35, v7, s[80:81] offset:1024
  v_min_u32 v20, -2, v20
  v_min_u32 v21, -2, v21
  v_min_u32 v22, -2, v22
  v_min_u32 v23, -2, v23
  v_min_u32 v24, -2, v24
  v_min_u32 v25, -2, v25
  v_min_u32 v26, -2, v26
  v_min_u32 v27, -2, v27
  v_min_u32 v28, -2, v28
  v_min_u32 v29, -2, v29
  v_min_u32 v30, -2, v30
  v_min_u32 v31, -2, v31
  s_lshl_b32 s54, s52, 11
  v_add_u32 v3, s54, v76
  ds_write_b128 v3, v[20:23] offset:4608
  ds_write_b128 v3, v[24:27] offset:5632
  ds_write_b128 v76, v[28:31] offset:12800
  v_add_u32 v15, 147456, v11
  v_add_u32 v16, 147456, v12
  ds_read_b64_tr_b16 v[208:209], v15 offset:0
  ds_read_b64_tr_b16 v[210:211], v15 offset:512
  ds_read_b64_tr_b16 v[212:213], v15 offset:8192
  ds_read_b64_tr_b16 v[214:215], v15 offset:8704
  ds_read_b64_tr_b16 v[216:217], v16 offset:0
  ds_read_b64_tr_b16 v[218:219], v16 offset:512
  ds_read_b64_tr_b16 v[220:221], v16 offset:8192
  ds_read_b64_tr_b16 v[222:223], v16 offset:8704
  s_waitcnt vmcnt(17) lgkmcnt(0)
  s_barrier
  s_add_u32 m0, s57, 81920
  s_add_u32 s54, s78, 524288
  buffer_load_dwordx4 v8, s[24:27], s54 offen  lds
  s_add_u32 m0, s57, 86016
  s_add_u32 s54, s78, 655360
  buffer_load_dwordx4 v8, s[24:27], s54 offen  lds
  s_add_u32 m0, s57, 90112
  s_add_u32 s54, s78, 786432
  buffer_load_dwordx4 v8, s[24:27], s54 offen  lds
  s_add_u32 m0, s57, 94208
  s_add_u32 s54, s78, 917504
  buffer_load_dwordx4 v8, s[24:27], s54 offen  lds
  v_add_u32 v15, 16384, v11
  v_add_u32 v16, 16384, v12
  ds_read_b64_tr_b16 v[224:225], v15 offset:0
  ds_read_b64_tr_b16 v[226:227], v15 offset:512
  ds_read_b64_tr_b16 v[228:229], v15 offset:8192
  ds_read_b64_tr_b16 v[230:231], v15 offset:8704
  ds_read_b64_tr_b16 v[232:233], v16 offset:0
  ds_read_b64_tr_b16 v[234:235], v16 offset:512
  ds_read_b64_tr_b16 v[236:237], v16 offset:8192
  ds_read_b64_tr_b16 v[238:239], v16 offset:8704
  s_waitcnt vmcnt(17) lgkmcnt(0)
  s_barrier
  s_add_u32 m0, s57, 98304
  s_add_u32 s54, s78, 1048576
  buffer_load_dwordx4 v8, s[24:27], s54 offen  lds
  s_add_u32 m0, s57, 102400
  s_add_u32 s54, s78, 1179648
  buffer_load_dwordx4 v8, s[24:27], s54 offen  lds
  s_add_u32 m0, s57, 106496
  s_add_u32 s54, s78, 1310720
  buffer_load_dwordx4 v8, s[24:27], s54 offen  lds
  s_add_u32 m0, s57, 110592
  s_add_u32 s54, s78, 1441792
  buffer_load_dwordx4 v8, s[24:27], s54 offen  lds
  v_add_u32 v15, 32768, v11
  v_add_u32 v16, 32768, v12
  ds_read_b64_tr_b16 v[240:241], v15 offset:0
  ds_read_b64_tr_b16 v[242:243], v15 offset:512
  ds_read_b64_tr_b16 v[244:245], v15 offset:8192
  ds_read_b64_tr_b16 v[246:247], v15 offset:8704
  ds_read_b64_tr_b16 v[248:249], v16 offset:0
  ds_read_b64_tr_b16 v[250:251], v16 offset:512
  ds_read_b64_tr_b16 v[252:253], v16 offset:8192
  ds_read_b64_tr_b16 v[254:255], v16 offset:8704
  s_waitcnt vmcnt(17) lgkmcnt(0)
  s_barrier
  s_add_u32 m0, s57, 114688
  s_add_u32 s54, s78, 1572864
  buffer_load_dwordx4 v8, s[24:27], s54 offen  lds
  s_add_u32 m0, s57, 118784
  s_add_u32 s54, s78, 1703936
  buffer_load_dwordx4 v8, s[24:27], s54 offen  lds
  s_add_u32 m0, s57, 122880
  s_add_u32 s54, s78, 1835008
  buffer_load_dwordx4 v8, s[24:27], s54 offen  lds
  s_add_u32 m0, s57, 126976
  s_add_u32 s54, s78, 1966080
  buffer_load_dwordx4 v8, s[24:27], s54 offen  lds
  v_add_u32 v15, 49152, v11
  v_add_u32 v16, 49152, v12
  ds_read_b64_tr_b16 a[0:1], v15 offset:0
  ds_read_b64_tr_b16 a[2:3], v15 offset:512
  ds_read_b64_tr_b16 a[4:5], v15 offset:8192
  ds_read_b64_tr_b16 a[6:7], v15 offset:8704
  ds_read_b64_tr_b16 a[8:9], v16 offset:0
  ds_read_b64_tr_b16 a[10:11], v16 offset:512
  ds_read_b64_tr_b16 a[12:13], v16 offset:8192
  ds_read_b64_tr_b16 a[14:15], v16 offset:8704
  s_waitcnt vmcnt(17) lgkmcnt(0)
  s_barrier
  s_add_u32 m0, s57, 131072
  s_add_u32 s54, s78, 2097152
  buffer_load_dwordx4 v8, s[24:27], s54 offen  lds
  s_add_u32 m0, s57, 135168
  s_add_u32 s54, s78, 2228224
  buffer_load_dwordx4 v8, s[24:27], s54 offen  lds
  s_add_u32 m0, s57, 139264
  s_add_u32 s54, s78, 2359296
  buffer_load_dwordx4 v8, s[24:27], s54 offen  lds
  s_add_u32 m0, s57, 143360
  s_add_u32 s54, s78, 2490368
  buffer_load_dwordx4 v8, s[24:27], s54 offen  lds
  v_add_u32 v15, 65536, v11
  v_add_u32 v16, 65536, v12
  ds_read_b64_tr_b16 a[16:17], v15 offset:0
  ds_read_b64_tr_b16 a[18:19], v15 offset:512
  ds_read_b64_tr_b16 a[20:21], v15 offset:8192
  ds_read_b64_tr_b16 a[22:23], v15 offset:8704
  ds_read_b64_tr_b16 a[24:25], v16 offset:0
  ds_read_b64_tr_b16 a[26:27], v16 offset:512
  ds_read_b64_tr_b16 a[28:29], v16 offset:8192
  ds_read_b64_tr_b16 a[30:31], v16 offset:8704
  s_waitcnt vmcnt(17) lgkmcnt(0)
  s_barrier
  s_add_u32 m0, s57, 0
  s_add_u32 s54, s78, 2621440
  buffer_load_dwordx4 v8, s[24:27], s54 offen  lds
  s_add_u32 m0, s57, 4096
  s_add_u32 s54, s78, 2752512
  buffer_load_dwordx4 v8, s[24:27], s54 offen  lds
  s_add_u32 m0, s57, 8192
  s_add_u32 s54, s78, 2883584
  buffer_load_dwordx4 v8, s[24:27], s54 offen  lds
  s_add_u32 m0, s57, 12288
  s_add_u32 s54, s78, 3014656
  buffer_load_dwordx4 v8, s[24:27], s54 offen  lds
  v_add_u32 v15, 81920, v11
  v_add_u32 v16, 81920, v12
  ds_read_b64_tr_b16 a[32:33], v15 offset:0
  ds_read_b64_tr_b16 a[34:35], v15 offset:512
  ds_read_b64_tr_b16 a[36:37], v15 offset:8192
  ds_read_b64_tr_b16 a[38:39], v15 offset:8704
  ds_read_b64_tr_b16 a[40:41], v16 offset:0
  ds_read_b64_tr_b16 a[42:43], v16 offset:512
  ds_read_b64_tr_b16 a[44:45], v16 offset:8192
  ds_read_b64_tr_b16 a[46:47], v16 offset:8704
  s_waitcnt vmcnt(16) lgkmcnt(0)
  s_barrier
  s_add_u32 m0, s57, 16384
  s_add_u32 s54, s78, 3145728
  buffer_load_dwordx4 v8, s[24:27], s54 offen  lds
  s_add_u32 m0, s57, 20480
  s_add_u32 s54, s78, 3276800
  buffer_load_dwordx4 v8, s[24:27], s54 offen  lds
  s_add_u32 m0, s57, 24576
  s_add_u32 s54, s78, 3407872
  buffer_load_dwordx4 v8, s[24:27], s54 offen  lds
  s_add_u32 m0, s57, 28672
  s_add_u32 s54, s78, 3538944
  buffer_load_dwordx4 v8, s[24:27], s54 offen  lds
  s_getpc_b64 s[80:81]
  v_lshlrev_b32 v7, 2, v76
  global_load_dword v35, v7, s[80:81] offset:1024
  v_add_u32 v15, 98304, v11
  v_add_u32 v16, 98304, v12
  ds_read_b64_tr_b16 a[48:49], v15 offset:0
  ds_read_b64_tr_b16 a[50:51], v15 offset:512
  ds_read_b64_tr_b16 a[52:53], v15 offset:8192
  ds_read_b64_tr_b16 a[54:55], v15 offset:8704
  ds_read_b64_tr_b16 a[56:57], v16 offset:0
  ds_read_b64_tr_b16 a[58:59], v16 offset:512
  ds_read_b64_tr_b16 a[60:61], v16 offset:8192
  ds_read_b64_tr_b16 a[62:63], v16 offset:8704
  s_waitcnt vmcnt(17) lgkmcnt(0)
  s_barrier
  s_add_u32 m0, s57, 32768
  s_add_u32 s54, s78, 3670016
  buffer_load_dwordx4 v8, s[24:27], s54 offen  lds
  s_add_u32 m0, s57, 36864
  s_add_u32 s54, s78, 3801088
  buffer_load_dwordx4 v8, s[24:27], s54 offen  lds
  s_add_u32 m0, s57, 40960
  s_add_u32 s54, s78, 3932160
  buffer_load_dwordx4 v8, s[24:27], s54 offen  lds
  s_add_u32 m0, s57, 45056
  s_add_u32 s54, s78, 4063232
  buffer_load_dwordx4 v8, s[24:27], s54 offen  lds
  v_add_u32 v15, 114688, v11
  v_add_u32 v16, 114688, v12
  ds_read_b64_tr_b16 a[64:65], v15 offset:0
  ds_read_b64_tr_b16 a[66:67], v15 offset:512
  ds_read_b64_tr_b16 a[68:69], v15 offset:8192
  ds_read_b64_tr_b16 a[70:71], v15 offset:8704
  ds_read_b64_tr_b16 a[72:73], v16 offset:0
  ds_read_b64_tr_b16 a[74:75], v16 offset:512
  ds_read_b64_tr_b16 a[76:77], v16 offset:8192
  ds_read_b64_tr_b16 a[78:79], v16 offset:8704
  s_waitcnt vmcnt(17) lgkmcnt(0)
  s_barrier
  s_add_u32 m0, s57, 49152
  s_add_u32 s54, s78, 4194304
  buffer_load_dwordx4 v8, s[24:27], s54 offen  lds
  s_add_u32 m0, s57, 53248
  s_add_u32 s54, s78, 4325376
  buffer_load_dwordx4 v8, s[24:27], s54 offen  lds
  s_add_u32 m0, s57, 57344
  s_add_u32 s54, s78, 4456448
  buffer_load_dwordx4 v8, s[24:27], s54 offen  lds
  s_add_u32 m0, s57, 61440
  s_add_u32 s54, s78, 4587520
  buffer_load_dwordx4 v8, s[24:27], s54 offen  lds
  v_add_u32 v15, 131072, v11
  v_add_u32 v16, 131072, v12
  ds_read_b64_tr_b16 a[80:81], v15 offset:0
  ds_read_b64_tr_b16 a[82:83], v15 offset:512
  ds_read_b64_tr_b16 a[84:85], v15 offset:8192
  ds_read_b64_tr_b16 a[86:87], v15 offset:8704
  ds_read_b64_tr_b16 a[88:89], v16 offset:0
  ds_read_b64_tr_b16 a[90:91], v16 offset:512
  ds_read_b64_tr_b16 a[92:93], v16 offset:8192
  ds_read_b64_tr_b16 a[94:95], v16 offset:8704
  s_waitcnt vmcnt(17) lgkmcnt(0)
  s_barrier
  s_add_u32 m0, s57, 65536
  s_add_u32 s54, s79, 73728
  buffer_load_dwordx4 v10, s[28:31], s54 offen  lds
  s_add_u32 m0, s57, 69632
  s_add_u32 s54, s79, 82944
  buffer_load_dwordx4 v10, s[28:31], s54 offen  lds
  s_add_u32 m0, s57, 73728
  s_add_u32 s54, s79, 110592
  buffer_load_dwordx4 v10, s[28:31], s54 offen  lds
  s_add_u32 m0, s57, 77824
  s_add_u32 s54, s79, 119808
  buffer_load_dwordx4 v10, s[28:31], s54 offen  lds
  v_add_u32 v15, 147456, v11
  v_add_u32 v16, 147456, v12
  ds_read_b64_tr_b16 a[96:97], v15 offset:0
  ds_read_b64_tr_b16 a[98:99], v15 offset:512
  ds_read_b64_tr_b16 a[100:101], v15 offset:8192
  ds_read_b64_tr_b16 a[102:103], v15 offset:8704
  ds_read_b64_tr_b16 a[104:105], v16 offset:0
  ds_read_b64_tr_b16 a[106:107], v16 offset:512
  ds_read_b64_tr_b16 a[108:109], v16 offset:8192
  ds_read_b64_tr_b16 a[110:111], v16 offset:8704
  s_waitcnt vmcnt(17) lgkmcnt(0)
  s_barrier
  s_add_u32 m0, s57, 81920
  s_add_u32 s54, s79, 256
  buffer_load_dwordx4 v10, s[28:31], s54 offen  lds
  s_add_u32 m0, s57, 86016
  s_add_u32 s54, s79, 9472
  buffer_load_dwordx4 v10, s[28:31], s54 offen  lds
  s_add_u32 m0, s57, 90112
  s_add_u32 s54, s79, 37120
  buffer_load_dwordx4 v10, s[28:31], s54 offen  lds
  s_add_u32 m0, s57, 94208
  s_add_u32 s54, s79, 46336
  buffer_load_dwordx4 v10, s[28:31], s54 offen  lds
  v_add_u32 v15, 16384, v11
  v_add_u32 v16, 16384, v12
  ds_read_b64_tr_b16 a[112:113], v15 offset:0
  ds_read_b64_tr_b16 a[114:115], v15 offset:512
  ds_read_b64_tr_b16 a[116:117], v15 offset:8192
  ds_read_b64_tr_b16 a[118:119], v15 offset:8704
  ds_read_b64_tr_b16 a[120:121], v16 offset:0
  ds_read_b64_tr_b16 a[122:123], v16 offset:512
  ds_read_b64_tr_b16 a[124:125], v16 offset:8192
  ds_read_b64_tr_b16 a[126:127], v16 offset:8704
  s_waitcnt vmcnt(17) lgkmcnt(0)
  s_barrier
  s_add_u32 m0, s57, 98304
  s_add_u32 s54, s79, 512
  buffer_load_dwordx4 v10, s[28:31], s54 offen  lds
  s_add_u32 m0, s57, 102400
  s_add_u32 s54, s79, 9728
  buffer_load_dwordx4 v10, s[28:31], s54 offen  lds
  s_add_u32 m0, s57, 106496
  s_add_u32 s54, s79, 37376
  buffer_load_dwordx4 v10, s[28:31], s54 offen  lds
  s_add_u32 m0, s57, 110592
  s_add_u32 s54, s79, 46592
  buffer_load_dwordx4 v10, s[28:31], s54 offen  lds
  v_add_u32 v15, 32768, v11
  v_add_u32 v16, 32768, v12
  ds_read_b64_tr_b16 a[128:129], v15 offset:0
  ds_read_b64_tr_b16 a[130:131], v15 offset:512
  ds_read_b64_tr_b16 a[132:133], v15 offset:8192
  ds_read_b64_tr_b16 a[134:135], v15 offset:8704
  ds_read_b64_tr_b16 a[136:137], v16 offset:0
  ds_read_b64_tr_b16 a[138:139], v16 offset:512
  ds_read_b64_tr_b16 a[140:141], v16 offset:8192
  ds_read_b64_tr_b16 a[142:143], v16 offset:8704
  s_waitcnt vmcnt(16) lgkmcnt(0)
  s_barrier
  s_add_u32 m0, s57, 114688
  s_add_u32 s54, s79, 768
  buffer_load_dwordx4 v10, s[28:31], s54 offen  lds
  s_add_u32 m0, s57, 118784
  s_add_u32 s54, s79, 9984
  buffer_load_dwordx4 v10, s[28:31], s54 offen  lds
  s_add_u32 m0, s57, 122880
  s_add_u32 s54, s79, 37632
  buffer_load_dwordx4 v10, s[28:31], s54 offen  lds
  s_add_u32 m0, s57, 126976
  s_add_u32 s54, s79, 46848
  buffer_load_dwordx4 v10, s[28:31], s54 offen  lds
  s_getpc_b64 s[80:81]
  v_lshlrev_b32 v7, 2, v76
  global_load_dword v35, v7, s[80:81] offset:1024
  v_add_u32 v15, 49152, v11
  v_add_u32 v16, 49152, v12
  ds_read_b64_tr_b16 a[144:145], v15 offset:0
  ds_read_b64_tr_b16 a[146:147], v15 offset:512
  ds_read_b64_tr_b16 a[148:149], v15 offset:8192
  ds_read_b64_tr_b16 a[150:151], v15 offset:8704
  ds_read_b64_tr_b16 a[152:153], v16 offset:0
  ds_read_b64_tr_b16 a[154:155], v16 offset:512
  ds_read_b64_tr_b16 a[156:157], v16 offset:8192
  ds_read_b64_tr_b16 a[158:159], v16 offset:8704
  s_waitcnt vmcnt(17) lgkmcnt(0)
  s_barrier
  s_add_u32 m0, s57, 131072
  s_add_u32 s54, s79, 74496
  buffer_load_dwordx4 v10, s[28:31], s54 offen  lds
  s_add_u32 m0, s57, 135168
  s_add_u32 s54, s79, 83712
  buffer_load_dwordx4 v10, s[28:31], s54 offen  lds
  s_add_u32 m0, s57, 139264
  s_add_u32 s54, s79, 111360
  buffer_load_dwordx4 v10, s[28:31], s54 offen  lds
  s_add_u32 m0, s57, 143360
  s_add_u32 s54, s79, 120576
  buffer_load_dwordx4 v10, s[28:31], s54 offen  lds
  v_add_u32 v15, 65536, v11
  v_add_u32 v16, 65536, v12
  ds_read_b64_tr_b16 a[160:161], v15 offset:0
  ds_read_b64_tr_b16 a[162:163], v15 offset:512
  ds_read_b64_tr_b16 a[164:165], v15 offset:8192
  ds_read_b64_tr_b16 a[166:167], v15 offset:8704
  ds_read_b64_tr_b16 a[168:169], v16 offset:0
  ds_read_b64_tr_b16 a[170:171], v16 offset:512
  ds_read_b64_tr_b16 a[172:173], v16 offset:8192
  ds_read_b64_tr_b16 a[174:175], v16 offset:8704
  s_waitcnt vmcnt(17) lgkmcnt(0)
  s_barrier
  s_add_u32 m0, s57, 0
  s_add_u32 s54, s78, 0
  buffer_load_dwordx4 v8, s[16:19], s54 offen  lds
  s_add_u32 m0, s57, 4096
  s_add_u32 s54, s78, 131072
  buffer_load_dwordx4 v8, s[16:19], s54 offen  lds
  s_add_u32 m0, s57, 8192
  s_add_u32 s54, s78, 262144
  buffer_load_dwordx4 v8, s[16:19], s54 offen  lds
  s_add_u32 m0, s57, 12288
  s_add_u32 s54, s78, 393216
  buffer_load_dwordx4 v8, s[16:19], s54 offen  lds
  v_add_u32 v15, 81920, v14
  ds_read_b64_tr_b16 a[176:177], v15 offset:0
  ds_read_b64_tr_b16 a[178:179], v15 offset:1024
  ds_read_b64_tr_b16 a[180:181], v15 offset:4096
  ds_read_b64_tr_b16 a[182:183], v15 offset:5120
  ds_read_b64_tr_b16 a[184:185], v15 offset:8192
  ds_read_b64_tr_b16 a[186:187], v15 offset:9216
  ds_read_b64_tr_b16 a[188:189], v15 offset:12288
  ds_read_b64_tr_b16 a[190:191], v15 offset:13312
  s_waitcnt vmcnt(17) lgkmcnt(0)
  s_barrier
  s_add_u32 m0, s57, 16384
  s_add_u32 s54, s78, 0
  buffer_load_dwordx4 v8, s[20:23], s54 offen  lds
  s_add_u32 m0, s57, 20480
  s_add_u32 s54, s78, 131072
  buffer_load_dwordx4 v8, s[20:23], s54 offen  lds
  s_add_u32 m0, s57, 24576
  s_add_u32 s54, s78, 262144
  buffer_load_dwordx4 v8, s[20:23], s54 offen  lds
  s_add_u32 m0, s57, 28672
  s_add_u32 s54, s78, 393216
  buffer_load_dwordx4 v8, s[20:23], s54 offen  lds
  v_add_u32 v15, 98304, v14
  ds_read_b64_tr_b16 a[192:193], v15 offset:0
  ds_read_b64_tr_b16 a[194:195], v15 offset:1024
  ds_read_b64_tr_b16 a[196:197], v15 offset:4096
  ds_read_b64_tr_b16 a[198:199], v15 offset:5120
  ds_read_b64_tr_b16 a[200:201], v15 offset:8192
  ds_read_b64_tr_b16 a[202:203], v15 offset:9216
  ds_read_b64_tr_b16 a[204:205], v15 offset:12288
  ds_read_b64_tr_b16 a[206:207], v15 offset:13312
  s_waitcnt vmcnt(17) lgkmcnt(0)
  s_barrier
  s_add_u32 m0, s57, 32768
  s_add_u32 s54, s78, 1048576
  buffer_load_dwordx4 v8, s[20:23], s54 offen  lds
  s_add_u32 m0, s57, 36864
  s_add_u32 s54, s78, 1179648
  buffer_load_dwordx4 v8, s[20:23], s54 offen  lds
  s_add_u32 m0, s57, 40960
  s_add_u32 s54, s78, 1310720
  buffer_load_dwordx4 v8, s[20:23], s54 offen  lds
  s_add_u32 m0, s57, 45056
  s_add_u32 s54, s78, 1441792
  buffer_load_dwordx4 v8, s[20:23], s54 offen  lds
  v_add_u32 v15, 114688, v14
  ds_read_b64_tr_b16 a[208:209], v15 offset:0
  ds_read_b64_tr_b16 a[210:211], v15 offset:1024
  ds_read_b64_tr_b16 a[212:213], v15 offset:4096
  ds_read_b64_tr_b16 a[214:215], v15 offset:5120
  ds_read_b64_tr_b16 a[216:217], v15 offset:8192
  ds_read_b64_tr_b16 a[218:219], v15 offset:9216
  ds_read_b64_tr_b16 a[220:221], v15 offset:12288
  ds_read_b64_tr_b16 a[222:223], v15 offset:13312
  s_waitcnt vmcnt(17) lgkmcnt(0)
  s_barrier
  s_add_u32 m0, s57, 49152
  s_add_u32 s54, s78, 2097152
  buffer_load_dwordx4 v8, s[20:23], s54 offen  lds
  s_add_u32 m0, s57, 53248
  s_add_u32 s54, s78, 2228224
  buffer_load_dwordx4 v8, s[20:23], s54 offen  lds
  s_add_u32 m0, s57, 57344
  s_add_u32 s54, s78, 2359296
  buffer_load_dwordx4 v8, s[20:23], s54 offen  lds
  s_add_u32 m0, s57, 61440
  s_add_u32 s54, s78, 2490368
  buffer_load_dwordx4 v8, s[20:23], s54 offen  lds
  v_add_u32 v15, 131072, v14
  ds_read_b64_tr_b16 a[224:225], v15 offset:0
  ds_read_b64_tr_b16 a[226:227], v15 offset:1024
  ds_read_b64_tr_b16 a[228:229], v15 offset:4096
  ds_read_b64_tr_b16 a[230:231], v15 offset:5120
  ds_read_b64_tr_b16 a[232:233], v15 offset:8192
  ds_read_b64_tr_b16 a[234:235], v15 offset:9216
  ds_read_b64_tr_b16 a[236:237], v15 offset:12288
  ds_read_b64_tr_b16 a[238:239], v15 offset:13312
  s_waitcnt vmcnt(16) lgkmcnt(0)
  s_barrier
  s_add_u32 m0, s57, 65536
  s_add_u32 s54, s78, 2621440
  buffer_load_dwordx4 v8, s[20:23], s54 offen  lds
  s_add_u32 m0, s57, 69632
  s_add_u32 s54, s78, 2752512
  buffer_load_dwordx4 v8, s[20:23], s54 offen  lds
  s_add_u32 m0, s57, 73728
  s_add_u32 s54, s78, 2883584
  buffer_load_dwordx4 v8, s[20:23], s54 offen  lds
  s_add_u32 m0, s57, 77824
  s_add_u32 s54, s78, 3014656
  buffer_load_dwordx4 v8, s[20:23], s54 offen  lds
  v_add_u32 v15, 147456, v14
  ds_read_b64_tr_b16 a[240:241], v15 offset:0
  ds_read_b64_tr_b16 a[242:243], v15 offset:1024
  ds_read_b64_tr_b16 a[244:245], v15 offset:4096
  ds_read_b64_tr_b16 a[246:247], v15 offset:5120
  ds_read_b64_tr_b16 a[248:249], v15 offset:8192
  ds_read_b64_tr_b16 a[250:251], v15 offset:9216
  ds_read_b64_tr_b16 a[252:253], v15 offset:12288
  ds_read_b64_tr_b16 a[254:255], v15 offset:13312
  s_waitcnt vmcnt(16) lgkmcnt(0)
  s_barrier
  s_add_u32 m0, s57, 81920
  s_add_u32 s54, s79, 1024
  buffer_load_dwordx4 v9, s[28:31], s54 offen  lds
  s_add_u32 m0, s57, 86016
  s_add_u32 s54, s79, 37888
  buffer_load_dwordx4 v9, s[28:31], s54 offen  lds
  s_add_u32 m0, s57, 90112
  s_add_u32 s54, s79, 74752
  buffer_load_dwordx4 v9, s[28:31], s54 offen  lds
  s_add_u32 m0, s57, 94208
  s_add_u32 s54, s79, 111616
  buffer_load_dwordx4 v9, s[28:31], s54 offen  lds
  v_add_u32 v15, 16384, v11
  v_add_u32 v16, 16384, v12
  ds_read_b64_tr_b16 v[52:53], v15 offset:0
  ds_read_b64_tr_b16 v[54:55], v15 offset:512
  ds_read_b64_tr_b16 v[56:57], v15 offset:8192
  ds_read_b64_tr_b16 v[58:59], v15 offset:8704
  ds_read_b64_tr_b16 v[60:61], v16 offset:0
  ds_read_b64_tr_b16 v[62:63], v16 offset:512
  ds_read_b64_tr_b16 v[64:65], v16 offset:8192
  ds_read_b64_tr_b16 v[66:67], v16 offset:8704
  s_waitcnt vmcnt(16) lgkmcnt(0)
  s_barrier
  s_lshl_b32 s54, s52, 12
  s_add_u32 s54, s54, 16384
  v_add_u32 v7, s54, v76
  ds_write_b128 v7, v[52:55] offset:0
  ds_write_b128 v7, v[56:59] offset:1024
  ds_write_b128 v7, v[60:63] offset:2048
  ds_write_b128 v7, v[64:67] offset:3072
  s_add_u32 m0, s57, 98304
  s_add_u32 s54, s79, 0
  buffer_load_dwordx4 v10, s[28:31], s54 offen  lds
  s_add_u32 m0, s57, 102400
  s_add_u32 s54, s79, 9216
  buffer_load_dwordx4 v10, s[28:31], s54 offen  lds
  s_add_u32 m0, s57, 106496
  s_add_u32 s54, s79, 36864
  buffer_load_dwordx4 v10, s[28:31], s54 offen  lds
  s_add_u32 m0, s57, 110592
  s_add_u32 s54, s79, 46080
  buffer_load_dwordx4 v10, s[28:31], s54 offen  lds
  v_add_u32 v15, 32768, v11
  v_add_u32 v16, 32768, v12
  ds_read_b64_tr_b16 v[36:37], v15 offset:0
  ds_read_b64_tr_b16 v[38:39], v15 offset:512
  ds_read_b64_tr_b16 v[40:41], v15 offset:8192
  ds_read_b64_tr_b16 v[42:43], v15 offset:8704
  ds_read_b64_tr_b16 v[44:45], v16 offset:0
  ds_read_b64_tr_b16 v[46:47], v16 offset:512
  ds_read_b64_tr_b16 v[48:49], v16 offset:8192
  ds_read_b64_tr_b16 v[50:51], v16 offset:8704
  s_waitcnt vmcnt(16) lgkmcnt(0)
  s_barrier
  s_lshl_b32 s54, s52, 12
  s_add_u32 s54, s54, 32768
  v_add_u32 v7, s54, v76
  ds_write_b128 v7, v[36:39] offset:0
  ds_write_b128 v7, v[40:43] offset:1024
  ds_write_b128 v7, v[44:47] offset:2048
  ds_write_b128 v7, v[48:51] offset:3072
  s_add_u32 m0, s57, 114688
  s_add_u32 s54, s79, 73984
  buffer_load_dwordx4 v10, s[28:31], s54 offen  lds
  s_add_u32 m0, s57, 118784
  s_add_u32 s54, s79, 83200
  buffer_load_dwordx4 v10, s[28:31], s54 offen  lds
  s_add_u32 m0, s57, 122880
  s_add_u32 s54, s79, 110848
  buffer_load_dwordx4 v10, s[28:31], s54 offen  lds
  s_add_u32 m0, s57, 126976
  s_add_u32 s54, s79, 120064
  buffer_load_dwordx4 v10, s[28:31], s54 offen  lds
  v_add_u32 v15, 49152, v11
  v_add_u32 v16, 49152, v12
  ds_read_b64_tr_b16 v[52:53], v15 offset:0
  ds_read_b64_tr_b16 v[54:55], v15 offset:512
  ds_read_b64_tr_b16 v[56:57], v15 offset:8192
  ds_read_b64_tr_b16 v[58:59], v15 offset:8704
  ds_read_b64_tr_b16 v[60:61], v16 offset:0
  ds_read_b64_tr_b16 v[62:63], v16 offset:512
  ds_read_b64_tr_b16 v[64:65], v16 offset:8192
  ds_read_b64_tr_b16 v[66:67], v16 offset:8704
  s_waitcnt vmcnt(16) lgkmcnt(0)
  s_barrier
  s_lshl_b32 s54, s52, 12
  s_add_u32 s54, s54, 49152
  v_add_u32 v7, s54, v76
  ds_write_b128 v7, v[52:55] offset:0
  ds_write_b128 v7, v[56:59] offset:1024
  ds_write_b128 v7, v[60:63] offset:2048
  ds_write_b128 v7, v[64:67] offset:3072
  s_add_u32 m0, s57, 131072
  s_add_u32 s54, s79, 74240
  buffer_load_dwordx4 v10, s[28:31], s54 offen  lds
  s_add_u32 m0, s57, 135168
  s_add_u32 s54, s79, 83456
  buffer_load_dwordx4 v10, s[28:31], s54 offen  lds
  s_add_u32 m0, s57, 139264
  s_add_u32 s54, s79, 111104
  buffer_load_dwordx4 v10, s[28:31], s54 offen  lds
  s_add_u32 m0, s57, 143360
  s_add_u32 s54, s79, 120320
  buffer_load_dwordx4 v10, s[28:31], s54 offen  lds
  v_lshlrev_b32 v7, 3, v76
  s_lshl_b32 s54, s52, 13
  s_add_u32 s54, s54, 360448
  s_bitcmp1_b32 s52, 0
  s_cselect_b64 exec, 0xff, -1
  buffer_load_dword v35, v7, s[8:11], s54 offen sc1
  s_mov_b64 exec, -1
  s_getpc_b64 s[80:81]
C_pc:
  s_mov_b32 s55, (L_w0 - C_pc)
  s_cmp_eq_u32 s52, 1
  s_cselect_b32 s55, (L_w1 - C_pc), s55
  s_cmp_eq_u32 s52, 2
  s_cselect_b32 s55, (L_w2 - C_pc), s55
  s_cmp_eq_u32 s52, 3
  s_cselect_b32 s55, (L_w3 - C_pc), s55
  v_lshl_add_u32 v7, v76, 3, s55
  global_load_dword v35, v7, s[80:81]
  v_add_u32 v15, 65536, v11
  v_add_u32 v16, 65536, v12
  ds_read_b64_tr_b16 v[36:37], v15 offset:0
  ds_read_b64_tr_b16 v[38:39], v15 offset:512
  ds_read_b64_tr_b16 v[40:41], v15 offset:8192
  ds_read_b64_tr_b16 v[42:43], v15 offset:8704
  ds_read_b64_tr_b16 v[44:45], v16 offset:0
  ds_read_b64_tr_b16 v[46:47], v16 offset:512
  ds_read_b64_tr_b16 v[48:49], v16 offset:8192
  ds_read_b64_tr_b16 v[50:51], v16 offset:8704
  s_waitcnt vmcnt(18) lgkmcnt(0)
  s_barrier
  s_lshl_b32 s54, s52, 12
  s_add_u32 s54, s54, 65536
  v_add_u32 v7, s54, v76
  ds_write_b128 v7, v[36:39] offset:0
  ds_write_b128 v7, v[40:43] offset:1024
  ds_write_b128 v7, v[44:47] offset:2048
  ds_write_b128 v7, v[48:51] offset:3072
  v_lshrrev_b32 v20, 2, v76
  buffer_load_dword v21, v20, s[12:15], 0 offen sc1
  v_add_u32 v15, 81920, v11
  v_add_u32 v16, 81920, v12
  ds_read_b64_tr_b16 v[52:53], v15 offset:0
  ds_read_b64_tr_b16 v[54:55], v15 offset:512
  ds_read_b64_tr_b16 v[56:57], v15 offset:8192
  ds_read_b64_tr_b16 v[58:59], v15 offset:8704
  ds_read_b64_tr_b16 v[60:61], v16 offset:0
  ds_read_b64_tr_b16 v[62:63], v16 offset:512
  ds_read_b64_tr_b16 v[64:65], v16 offset:8192
  ds_read_b64_tr_b16 v[66:67], v16 offset:8704
  s_waitcnt vmcnt(15) lgkmcnt(0)
  s_barrier
  s_lshl_b32 s54, s52, 12
  s_add_u32 s54, s54, 81920
  v_add_u32 v7, s54, v76
  ds_write_b128 v7, v[52:55] offset:0
  ds_write_b128 v7, v[56:59] offset:1024
  ds_write_b128 v7, v[60:63] offset:2048
  ds_write_b128 v7, v[64:67] offset:3072
  v_add_u32 v15, 98304, v13
  s_waitcnt lgkmcnt(0)
  ds_read_b64_tr_b16 v[36:37], v15 offset:0
  ds_read_b64_tr_b16 v[38:39], v15 offset:1024
  ds_read_b64_tr_b16 v[40:41], v15 offset:2048
  ds_read_b64_tr_b16 v[42:43], v15 offset:3072
  ds_read_b64_tr_b16 v[44:45], v15 offset:4096
  ds_read_b64_tr_b16 v[46:47], v15 offset:5120
  ds_read_b64_tr_b16 v[48:49], v15 offset:6144
  ds_read_b64_tr_b16 v[50:51], v15 offset:7168
  ds_read_b64_tr_b16 v[52:53], v15 offset:8192
  ds_read_b64_tr_b16 v[54:55], v15 offset:9216
  ds_read_b64_tr_b16 v[56:57], v15 offset:10240
  ds_read_b64_tr_b16 v[58:59], v15 offset:11264
  ds_read_b64_tr_b16 v[60:61], v15 offset:12288
  ds_read_b64_tr_b16 v[62:63], v15 offset:13312
  ds_read_b64_tr_b16 v[64:65], v15 offset:14336
  ds_read_b64_tr_b16 v[66:67], v15 offset:15360
  s_waitcnt vmcnt(11) lgkmcnt(0)
  s_barrier
  s_and_b32 s54, s52, 1
  s_lshl_b32 s54, s54, 13
  s_add_u32 s54, s54, 98304
  v_add_u32 v7, s54, v76
  ds_write_b128 v7, v[36:39] offset:0
  ds_write_b128 v7, v[40:43] offset:1024
  ds_write_b128 v7, v[44:47] offset:2048
  ds_write_b128 v7, v[48:51] offset:3072
  ds_write_b128 v7, v[52:55] offset:4096
  ds_write_b128 v7, v[56:59] offset:5120
  ds_write_b128 v7, v[60:63] offset:6144
  ds_write_b128 v7, v[64:67] offset:7168
  v_add_u32 v15, 114688, v14
  ds_read_b64_tr_b16 v[52:53], v15 offset:0
  ds_read_b64_tr_b16 v[54:55], v15 offset:1024
  ds_read_b64_tr_b16 v[56:57], v15 offset:4096
  ds_read_b64_tr_b16 v[58:59], v15 offset:5120
  ds_read_b64_tr_b16 v[60:61], v15 offset:8192
  ds_read_b64_tr_b16 v[62:63], v15 offset:9216
  ds_read_b64_tr_b16 v[64:65], v15 offset:12288
  ds_read_b64_tr_b16 v[66:67], v15 offset:13312
  s_waitcnt vmcnt(7) lgkmcnt(0)
  s_barrier
  s_lshl_b32 s54, s52, 12
  s_add_u32 s54, s54, 114688
  v_add_u32 v7, s54, v76
  ds_write_b128 v7, v[52:55] offset:0
  ds_write_b128 v7, v[56:59] offset:1024
  ds_write_b128 v7, v[60:63] offset:2048
  ds_write_b128 v7, v[64:67] offset:3072
  v_add_u32 v15, 131072, v14
  ds_read_b64_tr_b16 v[36:37], v15 offset:0
  ds_read_b64_tr_b16 v[38:39], v15 offset:1024
  ds_read_b64_tr_b16 v[40:41], v15 offset:4096
  ds_read_b64_tr_b16 v[42:43], v15 offset:5120
  ds_read_b64_tr_b16 v[44:45], v15 offset:8192
  ds_read_b64_tr_b16 v[46:47], v15 offset:9216
  ds_read_b64_tr_b16 v[48:49], v15 offset:12288
  ds_read_b64_tr_b16 v[50:51], v15 offset:13312
  s_waitcnt vmcnt(3) lgkmcnt(0)
  s_barrier
  s_lshl_b32 s54, s52, 12
  s_add_u32 s54, s54, 131072
  v_add_u32 v7, s54, v76
  ds_write_b128 v7, v[36:39] offset:0
  ds_write_b128 v7, v[40:43] offset:1024
  ds_write_b128 v7, v[44:47] offset:2048
  ds_write_b128 v7, v[48:51] offset:3072
  v_add_u32 v15, 147456, v14
  ds_read_b64_tr_b16 v[52:53], v15 offset:0
  ds_read_b64_tr_b16 v[54:55], v15 offset:1024
  ds_read_b64_tr_b16 v[56:57], v15 offset:4096
  ds_read_b64_tr_b16 v[58:59], v15 offset:5120
  ds_read_b64_tr_b16 v[60:61], v15 offset:8192
  ds_read_b64_tr_b16 v[62:63], v15 offset:9216
  ds_read_b64_tr_b16 v[64:65], v15 offset:12288
  ds_read_b64_tr_b16 v[66:67], v15 offset:13312
  s_waitcnt vmcnt(0) lgkmcnt(0)
  s_barrier
  s_lshl_b32 s54, s52, 12
  s_add_u32 s54, s54, 147456
  v_add_u32 v7, s54, v76
  ds_write_b128 v7, v[52:55] offset:0
  ds_write_b128 v7, v[56:59] offset:1024
  ds_write_b128 v7, v[60:63] offset:2048
  ds_write_b128 v7, v[64:67] offset:3072
  s_waitcnt lgkmcnt(0)
  s_branch C_rd1
C_rd0:
  s_sleep 2
  buffer_load_dword v21, v20, s[12:15], 0 offen sc1
  s_waitcnt vmcnt(0)
C_rd1:
  v_and_b32 v22, 0xff, v21
  v_cmp_gt_u32 vcc, 7, v22
  v_readlane_b32 s56, v21, 0
  s_mov_b32 s3, 1
  s_add_u32 s67, s67, 1
  s_cmp_ge_u32 s67, 131072
  s_cbranch_scc1 C_rd2
  s_cmp_lg_u32 vcc_hi, 0
  s_cbranch_scc1 C_rd0
  s_mov_b32 s3, 0
  s_cmp_eq_u32 s56, -1
  s_cbranch_scc1 C_rd2
  s_mov_b32 s3, 1
  v_readlane_b32 s54, v21, 10
  v_readlane_b32 s55, v21, 0
  s_nop 0
  s_bcnt1_i32_b32 s55, s55
  s_add_u32 s54, s54, s55
  v_readlane_b32 s55, v21, 1
  s_nop 0
  s_bcnt1_i32_b32 s55, s55
  s_add_u32 s54, s54, s55
  v_readlane_b32 s55, v21, 2
  s_nop 0
  s_bcnt1_i32_b32 s55, s55
  s_add_u32 s54, s54, s55
  v_readlane_b32 s55, v21, 3
  s_nop 0
  s_bcnt1_i32_b32 s55, s55
  s_add_u32 s54, s54, s55
  v_readlane_b32 s55, v21, 4
  s_nop 0
  s_bcnt1_i32_b32 s55, s55
  s_add_u32 s54, s54, s55
  v_readlane_b32 s55, v21, 5
  s_nop 0
  s_bcnt1_i32_b32 s55, s55
  s_add_u32 s54, s54, s55
  v_readlane_b32 s55, v21, 6
  s_nop 0
  s_bcnt1_i32_b32 s55, s55
  s_add_u32 s54, s54, s55
  v_readlane_b32 s55, v21, 7
  s_nop 0
  s_bcnt1_i32_b32 s55, s55
  s_add_u32 s54, s54, s55
  s_cmp_lt_u32 s54, 256
  s_cbranch_scc1 C_rd0
C_rd2:
  s_lshl_b32 s54, s3, 2
  s_add_u32 s54, s54, s52
  s_cmp_eq_u32 s54, 1
  s_cbranch_scc1 L_w1
  s_cmp_eq_u32 s54, 2
  s_cbranch_scc1 L_w2
  s_cmp_eq_u32 s54, 3
  s_cbranch_scc1 L_w3
  s_cmp_eq_u32 s54, 4
  s_cbranch_scc1 L_w4
  s_cmp_eq_u32 s54, 5
  s_cbranch_scc1 L_w5
  s_cmp_eq_u32 s54, 6
  s_cbranch_scc1 L_w6
  s_cmp_eq_u32 s54, 7
  s_cbranch_scc1 L_w7
L_w0:
  v_mov_b64 v[20:21], 0
  v_mov_b64 v[22:23], 0
  v_mov_b64 v[24:25], 0
  v_mov_b64 v[26:27], 0
  v_mov_b64 v[28:29], 0
  v_mov_b64 v[30:31], 0
  v_mov_b64 v[32:33], 0
  v_mov_b64 v[34:35], 0
  s_mov_b32 s78, 0x3f803f80
  s_mov_b32 s79, s78
  s_mov_b32 s65, 360448
  s_mov_b32 m0, 15872
  v_lshlrev_b32 v73, 2, v76
  v_mov_b32 v72, 0
  ds_read_b128 v[60:63], v76 offset:16384
  ds_read_b128 v[64:67], v76 offset:17408
  ds_read_b128 v[44:47], v76 offset:18432
  ds_read_b128 v[48:51], v76 offset:19456
  ds_read_b128 v[36:39], v76 offset:32768
  ds_read_b128 v[40:43], v76 offset:33792
  ds_read_b128 v[0:3], v76 offset:4608
  ds_read_b128 v[4:7], v76 offset:5632
  s_branch Cf0_top2
.p2align 6
Cf0_h2:
  v_lshlrev_b32 v73, 2, v76
  s_nop 15
  s_nop 15
  s_nop 3
  buffer_load_dwordx4 v[52:55], v76, s[8:11], s65 offen offset:0 sc1
  buffer_load_dwordx4 v[56:59], v76, s[8:11], s65 offen offset:1024 sc1
  s_nop 15
  s_nop 3
  buffer_load_dwordx4 v[52:55], v76, s[8:11], s65 offen offset:0 sc1
  buffer_load_dwordx4 v[56:59], v76, s[8:11], s65 offen offset:1024 sc1
  s_nop 15
  s_nop 3
  buffer_load_dwordx4 v[52:55], v76, s[8:11], s65 offen offset:0 sc1
  buffer_load_dwordx4 v[56:59], v76, s[8:11], s65 offen offset:1024 sc1
  s_waitcnt vmcnt(8)
  ds_read_b128 v[60:63], v76 offset:16384
  ds_read_b128 v[64:67], v76 offset:17408
  ds_read_b128 v[44:47], v76 offset:18432
  ds_read_b128 v[48:51], v76 offset:19456
  ds_read_b128 v[36:39], v76 offset:32768
  ds_read_b128 v[40:43], v76 offset:33792
  s_waitcnt vmcnt(4)
  v_max3_u32 v72, v52, v53, v54
  v_max3_u32 v72, v72, v55, v56
  v_max3_u32 v72, v72, v57, v58
  v_max_u32 v72, v72, v59
  ds_write_b128 v76, v[52:55] offset:4608
  ds_write_b128 v76, v[56:59] offset:5632
  v_cmp_eq_u32 vcc, -1, v72
  s_cbranch_vccnz Cf0_h2r
Cf0_h2w:
  s_waitcnt lgkmcnt(0)
  s_barrier
  ds_read_b128 v[0:3], v76 offset:4608
  ds_read_b128 v[4:7], v76 offset:5632
Cf0_top2:
  ds_read_b128 v[8:11], v76 offset:6656
  s_waitcnt lgkmcnt(2)
  v_smfmac_f32_16x16x64_bf16 v[20:23], v[0:3], v[60:67], v74
  ds_read_b128 v[60:63], v76 offset:34816
  v_smfmac_f32_16x16x64_bf16 v[24:27], v[0:3], v[44:51], v74
  buffer_load_dwordx4 v[44:47], v76, s[8:11], s58 offen offset:0 sc1
  ds_read_b128 v[64:67], v76 offset:35840
  s_waitcnt lgkmcnt(3)
  v_smfmac_f32_16x16x64_bf16 v[20:23], v[4:7], v[80:87], v74
  buffer_load_dwordx4 v[48:51], v76, s[8:11], s58 offen offset:1024 sc1
  v_smfmac_f32_16x16x64_bf16 v[28:31], v[0:3], v[36:43], v74
  buffer_load_dwordx4 v[52:55], v76, s[8:11], s59 offen offset:0 sc1
  ds_read_b128 v[36:39], v76 offset:49152
  v_smfmac_f32_16x16x64_bf16 v[24:27], v[4:7], v[88:95], v74
  buffer_load_dwordx4 v[56:59], v76, s[8:11], s59 offen offset:1024 sc1
  ds_read_b128 v[40:43], v76 offset:50176
  v_smfmac_f32_16x16x64_bf16 v[28:31], v[4:7], v[208:215], v74
  ds_read_b128 v[12:15], v76 offset:7680
  s_waitcnt lgkmcnt(5)
  v_smfmac_f32_16x16x64_bf16 v[32:35], v[4:7], v[216:223], v74
  buffer_store_dwordx4 v[16:19], v76, s[8:11], s68 offen sc1
  s_waitcnt lgkmcnt(3)
  v_smfmac_f32_16x16x64_bf16 v[32:35], v[0:3], v[60:67], v74
  buffer_load_dword v73, s[8:11], s70 offen  lds
  v_smfmac_f32_16x16x64_bf16 v[20:23], v[8:11], v[96:103], v74
  ds_read_b128 v[60:63], v76 offset:51200
  v_smfmac_f32_16x16x64_bf16 v[24:27], v[8:11], v[104:111], v74
  ds_read_b128 v[64:67], v76 offset:52224
  s_waitcnt lgkmcnt(3)
  v_smfmac_f32_16x16x64_bf16 v[28:31], v[8:11], v[36:43], v74
  ds_read_b128 v[36:39], v75 offset:0
  s_waitcnt lgkmcnt(3)
  v_smfmac_f32_16x16x64_bf16 v[20:23], v[12:15], v[112:119], v74
  ds_read_b128 v[40:43], v75 offset:1024
  v_smfmac_f32_16x16x64_bf16 v[24:27], v[12:15], v[120:127], v74
  v_smfmac_f32_16x16x64_bf16 v[28:31], v[12:15], v[224:231], v74
  s_barrier
  ds_read_b128 v[0:3], v76 offset:8704
  v_smfmac_f32_16x16x64_bf16 v[32:35], v[12:15], v[232:239], v74
  ds_read_b128 v[4:7], v76 offset:9728
  s_waitcnt lgkmcnt(4)
  v_smfmac_f32_16x16x64_bf16 v[32:35], v[8:11], v[60:67], v74
  ds_read_b128 v[60:63], v75 offset:2048
  s_waitcnt lgkmcnt(2)
  v_smfmac_f32_16x16x64_bf16 v[20:23], v[0:3], v[128:135], v74
  ds_read_b128 v[16:19], v76 offset:10752
  v_smfmac_f32_16x16x64_bf16 v[24:27], v[0:3], v[136:143], v74
  ds_read_b128 v[64:67], v75 offset:3072
  v_smfmac_f32_16x16x64_bf16 v[28:31], v[0:3], v[36:43], v74
  ds_read_b128 v[36:39], v75 offset:16384
  s_waitcnt lgkmcnt(4)
  v_smfmac_f32_16x16x64_bf16 v[20:23], v[4:7], v[144:151], v74
  ds_read_b128 v[12:15], v76 offset:11776
  v_smfmac_f32_16x16x64_bf16 v[24:27], v[4:7], v[152:159], v74
  ds_read_b128 v[40:43], v75 offset:17408
  s_waitcnt lgkmcnt(4)
  v_smfmac_f32_16x16x64_bf16 v[20:23], v[16:19], v[160:167], v74
  ds_read_b128 v[8:11], v76 offset:12800
  s_waitcnt lgkmcnt(4)
  v_smfmac_f32_16x16x64_bf16 v[32:35], v[0:3], v[60:67], v74
  ds_read_b128 v[60:63], v75 offset:18432
  v_mov_b64 v[68:69], s[78:79]
  v_smfmac_f32_16x16x64_bf16 v[24:27], v[16:19], v[168:175], v74
  ds_read_b128 v[64:67], v75 offset:19456
  s_waitcnt lgkmcnt(4)
  v_smfmac_f32_16x16x64_bf16 v[20:23], v[12:15], v[176:183], v74
  s_waitcnt lgkmcnt(3)
  v_mov_b64 v[70:71], s[78:79]
  v_smfmac_f32_16x16x64_bf16 v[28:31], v[4:7], v[36:43], v74
  s_waitcnt lgkmcnt(2)
  v_mov_b64 v[36:37], 0
  v_smfmac_f32_16x16x64_bf16 v[20:23], v[8:11], v[192:199], v74
  v_mov_b64 v[38:39], 0
  v_smfmac_f32_16x16x64_bf16 v[24:27], v[12:15], v[184:191], v74
  v_mov_b64 v[40:41], 0
  v_smfmac_f32_16x16x64_bf16 v[24:27], v[8:11], v[200:207], v74
  s_waitcnt lgkmcnt(0)
  v_add_f32 v20, v20, v22
  v_smfmac_f32_16x16x64_bf16 v[32:35], v[4:7], v[60:67], v74
  v_add_f32 v21, v21, v23
  v_smfmac_f32_16x16x64_bf16 v[28:31], v[16:19], v[240:247], v74
  v_add_f32 v24, v24, v26
  v_cvt_pk_bf16_f32 v22, v20, v24
  v_smfmac_f32_16x16x64_bf16 v[28:31], v[12:15], a[0:7], v74
  ds_write_b32 v79, v22 offset:0
  v_add_f32 v25, v25, v27
  v_cvt_pk_bf16_f32 v23, v21, v25
  v_smfmac_f32_16x16x64_bf16 v[28:31], v[8:11], a[16:23], v74
  ds_write_b32 v79, v23 offset:576
  v_cmp_u_f32 vcc, v20, v21
  v_smfmac_f32_16x16x64_bf16 v[32:35], v[16:19], v[248:255], v74
  v_mov_b64 v[42:43], 0
  v_smfmac_f32_16x16x64_bf16 v[32:35], v[12:15], a[8:15], v74
  v_add_f32 v28, v28, v30
  v_add_f32 v29, v29, v31
  v_smfmac_f32_16x16x64_bf16 v[32:35], v[8:11], a[24:31], v74
  s_cbranch_vccnz Cf0_rec
Cf0_recok:
  v_smfmac_f32_16x16x64_bf16 v[36:39], v[16:19], a[128:135], v74
  s_waitcnt lgkmcnt(0)
  s_barrier
  ds_read_b128 v[60:63], v77
  v_smfmac_f32_16x16x64_bf16 v[40:43], v[16:19], a[136:143], v74
  ds_read_b128 v[64:67], v77 offset:128
  v_add_f32 v32, v32, v34
  v_cvt_pk_bf16_f32 v30, v28, v32
  v_smfmac_f32_16x16x64_bf16 v[36:39], v[0:3], a[96:103], v74
  ds_write_b32 v79, v30 offset:256
  v_add_f32 v33, v33, v35
  v_cvt_pk_bf16_f32 v31, v29, v33
  v_smfmac_f32_16x16x64_bf16 v[40:43], v[0:3], a[104:111], v74
  ds_write_b32 v79, v31 offset:832
  v_xor_b32 v75, 0x8000, v75
  v_smfmac_f32_16x16x64_bf16 v[36:39], v[4:7], a[112:119], v74
  ds_read_b128 v[0:3], v76 offset:4608
  v_mov_b32 v29, 0
  v_smfmac_f32_16x16x64_bf16 v[40:43], v[4:7], a[120:127], v74
  s_waitcnt vmcnt(4) lgkmcnt(3)
  v_mov_b32 v30, 0
  v_mfma_f32_16x16x32_bf16 v[44:47], v[44:47], v[60:63], 0
  ds_read_b128 v[4:7], v76 offset:5632
  s_waitcnt lgkmcnt(2)
  v_mfma_f32_16x16x32_bf16 v[44:47], v[48:51], v[64:67], v[44:47]
  s_barrier
  v_smfmac_f32_16x16x64_bf16 v[36:39], v[8:11], a[160:167], v74
  ds_read_b128 v[20:23], v77 offset:256
  ds_read_b128 v[24:27], v77 offset:384
  v_smfmac_f32_16x16x64_bf16 v[40:43], v[8:11], a[168:175], v74
  ds_read_b128 v[8:11], v76 offset:6656
  v_add_f32_dpp v72, v46, v44 quad_perm:[2,3,0,1] row_mask:0xf bank_mask:0xf
  v_add_f32_dpp v73, v47, v45 quad_perm:[2,3,0,1] row_mask:0xf bank_mask:0xf
  v_smfmac_f32_16x16x64_bf16 v[36:39], v[12:15], a[144:151], v74
  s_waitcnt lgkmcnt(4)
  v_exp_f32_dpp v72, v72 quad_perm:[0,1,0,1] row_mask:0xf bank_mask:0xf
  v_smfmac_f32_16x16x64_bf16 v[40:43], v[12:15], a[152:159], v74
  ds_read_b128 v[12:15], v76 offset:7680
  v_exp_f32_dpp v73, v73 quad_perm:[0,1,0,1] row_mask:0xf bank_mask:0xf
  v_smfmac_f32_16x16x64_bf16 v[36:39], v[0:3], a[32:39], v74
  s_waitcnt lgkmcnt(2)
  v_cvt_pk_bf16_f32 v72, v72, v73
  v_mfma_f32_16x16x32_bf16 v[20:23], v[20:23], v[60:63], 0
  ds_write_b32 v78, v72 offset:512
  v_mov_b64 v[16:17], 0
  v_mfma_f32_16x16x32_bf16 v[20:23], v[24:27], v[64:67], v[20:23]
  ds_read_b128 v[44:47], v75 offset:16384
  v_mov_b64 v[18:19], 0
  v_smfmac_f32_16x16x64_bf16 v[40:43], v[0:3], a[40:47], v74
  ds_read_b128 v[48:51], v75 offset:17408
  s_waitcnt lgkmcnt(4)
  v_smfmac_f32_16x16x64_bf16 v[36:39], v[4:7], a[48:55], v74
  v_add_f32_dpp v24, v22, v20 quad_perm:[2,3,0,1] row_mask:0xf bank_mask:0xf
  v_add_f32_dpp v25, v23, v21 quad_perm:[2,3,0,1] row_mask:0xf bank_mask:0xf
  v_smfmac_f32_16x16x64_bf16 v[36:39], v[8:11], a[64:71], v74
  s_waitcnt lgkmcnt(2)
  s_barrier
  ds_read_b128 v[32:35], v78 offset:512
  v_smfmac_f32_16x16x64_bf16 v[36:39], v[12:15], a[80:87], v74
  ds_read_b128 v[60:63], v75 offset:18432
  v_mul_f32 v24, s69, v24
  v_smfmac_f32_16x16x64_bf16 v[40:43], v[4:7], a[56:63], v74
  ds_read_b128 v[64:67], v75 offset:19456
  v_mul_f32 v25, s69, v25
  v_smfmac_f32_16x16x64_bf16 v[40:43], v[8:11], a[72:79], v74
  v_exp_f32_dpp v24, v24 quad_perm:[0,1,0,1] row_mask:0xf bank_mask:0xf
  v_smfmac_f32_16x16x64_bf16 v[40:43], v[12:15], a[88:95], v74
  s_waitcnt vmcnt(2) lgkmcnt(2)
  v_exp_f32_dpp v25, v25 quad_perm:[0,1,0,1] row_mask:0xf bank_mask:0xf
  v_mfma_f32_16x16x32_bf16 v[8:11], v[32:35], v[68:71], 0
  v_add_f32 v36, v36, v38
  v_add_f32 v37, v37, v39
  v_mfma_f32_16x16x32_bf16 v[0:3], v[32:35], v[52:55], 0
  v_add_f32 v40, v40, v42
  v_add_f32 v41, v41, v43
  v_mfma_f32_16x16x32_bf16 v[4:7], v[32:35], v[56:59], 0
  v_cvt_pk_bf16_f32 v28, v24, v25
  v_cvt_pk_bf16_f32 v72, v36, v37
  v_cvt_pk_bf16_f32 v73, v40, v41
  v_mfma_f32_16x16x16_bf16 v[8:11], v[28:29], v[68:69], v[8:11]
  v_cvt_pk_bf16_f32 v31, v24, v25
  v_mov_b64 v[20:21], 0
  v_mfma_f32_16x16x16_bf16 v[0:3], v[28:29], v[72:73], v[0:3]
  ds_read_b128 v[68:71], v76 offset:13824
  v_mov_b64 v[22:23], 0
  v_mfma_f32_16x16x16_bf16 v[4:7], v[30:31], v[72:73], v[4:7]
  v_rcp_f32 v10, v8
  v_rcp_f32 v11, v9
  v_mul_f32 v0, v10, v0
  v_mul_f32 v1, v11, v1
  s_nop 0
  v_mul_f32 v4, v10, v4
  v_mul_f32 v5, v11, v5
  v_cvt_pk_bf16_f32 v2, v0, v4
  ds_write_b32 v79, v2 offset:8704
  v_cvt_pk_bf16_f32 v3, v1, v5
  ds_write_b32 v79, v3 offset:9280
  v_max3_f32 v8, v8, v9, v10
  v_max_f32 v8, v8, v11
  v_cmp_le_f32 vcc, 1317011456, v8
  v_mov_b64 v[24:25], 0
  v_mov_b64 v[26:27], 0
  s_cbranch_vccnz Cf0_mx
Cf0_mxok:
  s_waitcnt lgkmcnt(0)
  s_barrier
  ds_read_b128 v[0:3], v78 offset:8704
  ds_read_b128 v[4:7], v78 offset:8768
  ds_read_b128 v[8:11], v78 offset:8832
  ds_read_b128 v[12:15], v78 offset:8896
  s_cmp_eq_u32 s66, 63
  s_cbranch_scc1 Cf0_last
  s_waitcnt lgkmcnt(3)
  v_smfmac_f32_16x16x64_bf16 v[16:19], v[0:3], v[44:51], v74
  ds_read_b128 v[52:55], v75 offset:32768
  s_waitcnt lgkmcnt(3)
  v_smfmac_f32_16x16x64_bf16 v[16:19], v[4:7], v[60:67], v74
  ds_read_b128 v[56:59], v75 offset:33792
  s_waitcnt lgkmcnt(3)
  v_smfmac_f32_16x16x64_bf16 v[16:19], v[8:11], a[176:183], v74
  ds_read_b128 v[36:39], v75 offset:34816
  s_waitcnt lgkmcnt(3)
  v_smfmac_f32_16x16x64_bf16 v[16:19], v[12:15], a[184:191], v74
  ds_read_b128 v[40:43], v75 offset:35840
  ds_read_b128 v[44:47], v75 offset:49152
  v_smfmac_f32_16x16x64_bf16 v[20:23], v[0:3], a[192:199], v74
  ds_read_b128 v[48:51], v75 offset:50176
  ds_read_b128 v[60:63], v75 offset:51200
  v_smfmac_f32_16x16x64_bf16 v[20:23], v[4:7], a[200:207], v74
  ds_read_b128 v[64:67], v75 offset:52224
  s_waitcnt lgkmcnt(6)
  v_cvt_pk_bf16_f32 v16, v16, v17
  v_cvt_pk_bf16_f32 v17, v18, v19
  v_bfi_b32 v16, 1, s72, v16
  v_smfmac_f32_16x16x64_bf16 v[20:23], v[8:11], v[52:59], v74
  buffer_store_dwordx2 v[16:17], v68, s[8:11], s73 offen
  s_waitcnt lgkmcnt(4)
  v_smfmac_f32_16x16x64_bf16 v[20:23], v[12:15], v[36:43], v74
  v_mov_b64 v[32:33], 0
  v_smfmac_f32_16x16x64_bf16 v[24:27], v[0:3], a[208:215], v74
  v_mov_b64 v[34:35], 0
  v_smfmac_f32_16x16x64_bf16 v[24:27], v[4:7], a[216:223], v74
  s_waitcnt lgkmcnt(2)
  v_cvt_pk_bf16_f32 v20, v20, v21
  v_cvt_pk_bf16_f32 v21, v22, v23
  v_bfi_b32 v20, 1, s72, v20
  v_smfmac_f32_16x16x64_bf16 v[24:27], v[8:11], v[44:51], v74
  buffer_store_dwordx2 v[20:21], v68, s[8:11], s74 offen
  s_waitcnt lgkmcnt(0)
  v_smfmac_f32_16x16x64_bf16 v[24:27], v[12:15], v[60:67], v74
  v_smfmac_f32_16x16x64_bf16 v[32:35], v[0:3], a[224:231], v74
  v_smfmac_f32_16x16x64_bf16 v[32:35], v[4:7], a[232:239], v74
  v_cvt_pk_bf16_f32 v24, v24, v25
  v_cvt_pk_bf16_f32 v25, v26, v27
  v_bfi_b32 v24, 1, s72, v24
  v_smfmac_f32_16x16x64_bf16 v[32:35], v[8:11], a[240:247], v74
  s_nop 1
  buffer_store_dwordx2 v[24:25], v68, s[8:11], s75 offen
  v_smfmac_f32_16x16x64_bf16 v[32:35], v[12:15], a[248:255], v74
  ds_read_b128 v[0:3], v76 offset:14848
  ds_read_b64 v[16:17], v77 offset:256
  v_mov_b64 v[18:19], v[72:73]
  v_xor_b32 v75, 0x8000, v75
  s_nop 3
  v_cvt_pk_bf16_f32 v32, v32, v33
  v_cvt_pk_bf16_f32 v33, v34, v35
  v_bfi_b32 v32, 1, s72, v32
  buffer_store_dwordx2 v[32:33], v68, s[8:11], s76 offen
  v_mov_b64 v[20:21], 0
  v_mov_b64 v[22:23], 0
  v_mov_b64 v[24:25], 0
  v_mov_b64 v[26:27], 0
  v_mov_b64 v[28:29], 0
  v_mov_b64 v[30:31], 0
  v_mov_b64 v[32:33], 0
  v_mov_b64 v[34:35], 0
  s_add_u32 s58, s58, 655360
  s_add_u32 s59, s59, 655360
  s_add_u32 s70, s70, 655360
  s_add_u32 s68, s68, 655360
  s_add_u32 s66, s66, 1
  s_xor_b32 s64, s64, 16384
  s_xor_b32 s65, s65, 16384
  s_nop 15
  s_nop 3
  buffer_load_dwordx4 v[52:55], v76, s[8:11], s60 offen offset:0 sc1
  buffer_load_dwordx4 v[56:59], v76, s[8:11], s60 offen offset:1024 sc1
  s_nop 15
  s_nop 11
  buffer_load_dwordx4 v[36:39], v76, s[8:11], s60 offen offset:0 sc1
  buffer_load_dwordx4 v[40:43], v76, s[8:11], s60 offen offset:1024 sc1
  s_waitcnt lgkmcnt(0)
  s_waitcnt vmcnt(3)
  v_mfma_f32_16x16x32_bf16 v[4:7], v[0:3], v[52:55], 0
  v_bitop3_b32 v72, v52, v54, s72 bitop3:0x7e
  s_waitcnt vmcnt(2)
  v_mfma_f32_16x16x32_bf16 v[4:7], v[0:3], v[56:59], v[4:7]
  v_bitop3_b32 v73, v56, v58, s72 bitop3:0x7e
  v_bitop3_b32 v72, v72, v73, 1 bitop3:0xa8
  v_cmp_ne_u32 vcc, 0, v72
  s_cbranch_vccnz Cf0_h1r
  s_nop 2
  v_add_f32_dpp v4, v4, v4 row_ror:4 row_mask:0xf bank_mask:0xf
  v_add_f32_dpp v5, v5, v5 row_ror:4 row_mask:0xf bank_mask:0xf
  s_nop 0
  v_add_f32_dpp v4, v4, v4 row_ror:8 row_mask:0xf bank_mask:0xf
  v_add_f32_dpp v5, v5, v5 row_ror:8 row_mask:0xf bank_mask:0xf
  v_cvt_pk_bf16_f32 v4, v4, v5
  buffer_store_dword v4, v69, s[8:11], s62 offen
  s_xor_b32 s62, s62, 16384
  buffer_store_dword v71, v69, s[8:11], s62 offen
  s_xor_b32 s72, s72, 1
  s_branch Cf0_h2
Cf0_h1r:
  s_mov_b64 exec, vcc
  buffer_load_dwordx4 v[52:55], v76, s[8:11], s60 offen offset:0 sc1
  buffer_load_dwordx4 v[56:59], v76, s[8:11], s60 offen offset:1024 sc1
  s_mov_b64 exec, -1
  s_add_u32 s67, s67, 1
  s_waitcnt vmcnt(3)
  v_mfma_f32_16x16x32_bf16 v[4:7], v[0:3], v[36:39], 0
  v_bitop3_b32 v72, v36, v38, s72 bitop3:0x7e
  s_waitcnt vmcnt(2)
  v_mfma_f32_16x16x32_bf16 v[4:7], v[0:3], v[40:43], v[4:7]
  v_bitop3_b32 v73, v40, v42, s72 bitop3:0x7e
  v_bitop3_b32 v72, v72, v73, 1 bitop3:0xa8
  v_cmp_ne_u32 vcc, 0, v72
  s_cbranch_vccz Cf0_h1p
  s_mov_b64 exec, vcc
  buffer_load_dwordx4 v[36:39], v76, s[8:11], s60 offen offset:0 sc1
  buffer_load_dwordx4 v[40:43], v76, s[8:11], s60 offen offset:1024 sc1
  s_mov_b64 exec, -1
  s_add_u32 s67, s67, 1
  s_waitcnt vmcnt(3)
  v_mfma_f32_16x16x32_bf16 v[4:7], v[0:3], v[52:55], 0
  v_bitop3_b32 v72, v52, v54, s72 bitop3:0x7e
  s_waitcnt vmcnt(2)
  v_mfma_f32_16x16x32_bf16 v[4:7], v[0:3], v[56:59], v[4:7]
  v_bitop3_b32 v73, v56, v58, s72 bitop3:0x7e
  v_bitop3_b32 v72, v72, v73, 1 bitop3:0xa8
  v_cmp_ne_u32 vcc, 0, v72
  s_cbranch_vccz Cf0_h1p
Cf0_h1s:
  s_mov_b64 exec, vcc
  buffer_load_dwordx4 v[52:55], v76, s[8:11], s60 offen offset:0 sc1
  buffer_load_dwordx4 v[56:59], v76, s[8:11], s60 offen offset:1024 sc1
  s_mov_b64 exec, -1
  s_add_u32 s67, s67, 1
  s_waitcnt vmcnt(3)
  v_mfma_f32_16x16x32_bf16 v[4:7], v[0:3], v[36:39], 0
  v_bitop3_b32 v72, v36, v38, s72 bitop3:0x7e
  s_waitcnt vmcnt(2)
  v_mfma_f32_16x16x32_bf16 v[4:7], v[0:3], v[40:43], v[4:7]
  v_bitop3_b32 v73, v40, v42, s72 bitop3:0x7e
  v_bitop3_b32 v72, v72, v73, 1 bitop3:0xa8
  v_cmp_ne_u32 vcc, 0, v72
  s_cbranch_vccz Cf0_h1p
  s_mov_b64 exec, vcc
  buffer_load_dwordx4 v[36:39], v76, s[8:11], s60 offen offset:0 sc1
  buffer_load_dwordx4 v[40:43], v76, s[8:11], s60 offen offset:1024 sc1
  s_mov_b64 exec, -1
  s_add_u32 s67, s67, 1
  s_waitcnt vmcnt(3)
  v_mfma_f32_16x16x32_bf16 v[4:7], v[0:3], v[52:55], 0
  v_bitop3_b32 v72, v52, v54, s72 bitop3:0x7e
  s_waitcnt vmcnt(2)
  v_mfma_f32_16x16x32_bf16 v[4:7], v[0:3], v[56:59], v[4:7]
  v_bitop3_b32 v73, v56, v58, s72 bitop3:0x7e
  v_bitop3_b32 v72, v72, v73, 1 bitop3:0xa8
  v_cmp_ne_u32 vcc, 0, v72
  s_cbranch_vccz Cf0_h1p
  s_cmp_lt_u32 s67, 131072
  s_cbranch_scc1 Cf0_h1s
Cf0_h1p:
  s_nop 2
  v_add_f32_dpp v4, v4, v4 row_ror:4 row_mask:0xf bank_mask:0xf
  v_add_f32_dpp v5, v5, v5 row_ror:4 row_mask:0xf bank_mask:0xf
  s_nop 0
  v_add_f32_dpp v4, v4, v4 row_ror:8 row_mask:0xf bank_mask:0xf
  v_add_f32_dpp v5, v5, v5 row_ror:8 row_mask:0xf bank_mask:0xf
  v_cvt_pk_bf16_f32 v4, v4, v5
  buffer_store_dword v4, v69, s[8:11], s62 offen
  s_xor_b32 s62, s62, 16384
  buffer_store_dword v71, v69, s[8:11], s62 offen
  s_xor_b32 s72, s72, 1
  s_branch Cf0_h2
Cf0_h2r:
  s_mov_b64 exec, vcc
  buffer_load_dwordx4 v[52:55], v76, s[8:11], s65 offen offset:0 sc1
  buffer_load_dwordx4 v[56:59], v76, s[8:11], s65 offen offset:1024 sc1
  s_mov_b64 exec, -1
  s_add_u32 s67, s67, 1
  s_waitcnt vmcnt(4)
  v_max3_u32 v72, v52, v53, v54
  v_max3_u32 v72, v72, v55, v56
  v_max3_u32 v72, v72, v57, v58
  v_max_u32 v72, v72, v59
  ds_write_b128 v76, v[52:55] offset:4608
  ds_write_b128 v76, v[56:59] offset:5632
  v_cmp_eq_u32 vcc, -1, v72
  s_cbranch_vccz Cf0_h2w
  s_mov_b64 exec, vcc
  buffer_load_dwordx4 v[52:55], v76, s[8:11], s65 offen offset:0 sc1
  buffer_load_dwordx4 v[56:59], v76, s[8:11], s65 offen offset:1024 sc1
  s_mov_b64 exec, -1
  s_add_u32 s67, s67, 1
  s_waitcnt vmcnt(4)
  v_max3_u32 v72, v52, v53, v54
  v_max3_u32 v72, v72, v55, v56
  v_max3_u32 v72, v72, v57, v58
  v_max_u32 v72, v72, v59
  ds_write_b128 v76, v[52:55] offset:4608
  ds_write_b128 v76, v[56:59] offset:5632
  v_cmp_eq_u32 vcc, -1, v72
  s_cbranch_vccz Cf0_h2w
  s_mov_b64 exec, vcc
  buffer_load_dwordx4 v[52:55], v76, s[8:11], s65 offen offset:0 sc1
  buffer_load_dwordx4 v[56:59], v76, s[8:11], s65 offen offset:1024 sc1
  s_mov_b64 exec, -1
  s_add_u32 s67, s67, 1
  s_waitcnt vmcnt(4)
  v_max3_u32 v72, v52, v53, v54
  v_max3_u32 v72, v72, v55, v56
  v_max3_u32 v72, v72, v57, v58
  v_max_u32 v72, v72, v59
  ds_write_b128 v76, v[52:55] offset:4608
  ds_write_b128 v76, v[56:59] offset:5632
  v_cmp_eq_u32 vcc, -1, v72
  s_cbranch_vccz Cf0_h2w
  s_mov_b64 exec, vcc
  buffer_load_dwordx4 v[52:55], v76, s[8:11], s65 offen offset:0 sc1
  buffer_load_dwordx4 v[56:59], v76, s[8:11], s65 offen offset:1024 sc1
  s_mov_b64 exec, -1
  s_add_u32 s67, s67, 1
  s_waitcnt vmcnt(4)
  v_max3_u32 v72, v52, v53, v54
  v_max3_u32 v72, v72, v55, v56
  v_max3_u32 v72, v72, v57, v58
  v_max_u32 v72, v72, v59
  ds_write_b128 v76, v[52:55] offset:4608
  ds_write_b128 v76, v[56:59] offset:5632
  v_cmp_eq_u32 vcc, -1, v72
  s_cbranch_vccz Cf0_h2w
  s_cmp_lt_u32 s67, 131072
  s_cbranch_scc1 Cf0_h2r
Cf0_h2ok:
  ds_write_b128 v76, v[52:55] offset:4608
  ds_write_b128 v76, v[56:59] offset:5632
  s_branch Cf0_h2w
Cf0_rec:
  s_nop 7
  s_waitcnt vmcnt(0) lgkmcnt(0)
  v_max3_u32 v72, v0, v1, v2
  v_max3_u32 v72, v72, v3, v4
  v_max3_u32 v72, v72, v5, v6
  v_max3_u32 v72, v72, v7, v8
  v_max3_u32 v72, v72, v9, v10
  v_max3_u32 v72, v72, v11, v12
  v_max3_u32 v72, v72, v13, v14
  v_max3_u32 v72, v72, v15, v16
  v_max3_u32 v72, v72, v17, v18
  v_max_u32 v72, v72, v19
  v_cmp_eq_u32 vcc, -1, v72
  s_cbranch_vccz Cf0_recok
  s_barrier
  v_mov_b64 v[20:21], 0
  v_mov_b64 v[22:23], 0
  v_mov_b64 v[24:25], 0
  v_mov_b64 v[26:27], 0
  v_mov_b64 v[28:29], 0
  v_mov_b64 v[30:31], 0
  v_mov_b64 v[32:33], 0
  v_mov_b64 v[34:35], 0
  s_waitcnt lgkmcnt(0)
  s_barrier
  ds_read_b128 v[0:3], v76 offset:4608
  ds_read_b128 v[60:63], v76 offset:16384
  ds_read_b128 v[64:67], v76 offset:17408
  s_waitcnt lgkmcnt(0)
  v_smfmac_f32_16x16x64_bf16 v[20:23], v[0:3], v[60:67], v74
  ds_read_b128 v[60:63], v76 offset:18432
  ds_read_b128 v[64:67], v76 offset:19456
  s_waitcnt lgkmcnt(0)
  v_smfmac_f32_16x16x64_bf16 v[24:27], v[0:3], v[60:67], v74
  ds_read_b128 v[60:63], v76 offset:32768
  ds_read_b128 v[64:67], v76 offset:33792
  s_waitcnt lgkmcnt(0)
  v_smfmac_f32_16x16x64_bf16 v[28:31], v[0:3], v[60:67], v74
  ds_read_b128 v[60:63], v76 offset:34816
  ds_read_b128 v[64:67], v76 offset:35840
  s_waitcnt lgkmcnt(0)
  v_smfmac_f32_16x16x64_bf16 v[32:35], v[0:3], v[60:67], v74
  ds_read_b128 v[4:7], v76 offset:5632
  s_waitcnt lgkmcnt(0)
  v_smfmac_f32_16x16x64_bf16 v[20:23], v[4:7], v[80:87], v74
  v_smfmac_f32_16x16x64_bf16 v[24:27], v[4:7], v[88:95], v74
  v_smfmac_f32_16x16x64_bf16 v[28:31], v[4:7], v[208:215], v74
  v_smfmac_f32_16x16x64_bf16 v[32:35], v[4:7], v[216:223], v74
  ds_read_b128 v[8:11], v76 offset:6656
  s_waitcnt lgkmcnt(0)
  v_smfmac_f32_16x16x64_bf16 v[20:23], v[8:11], v[96:103], v74
  v_smfmac_f32_16x16x64_bf16 v[24:27], v[8:11], v[104:111], v74
  ds_read_b128 v[60:63], v76 offset:49152
  ds_read_b128 v[64:67], v76 offset:50176
  s_waitcnt lgkmcnt(0)
  v_smfmac_f32_16x16x64_bf16 v[28:31], v[8:11], v[60:67], v74
  ds_read_b128 v[60:63], v76 offset:51200
  ds_read_b128 v[64:67], v76 offset:52224
  s_waitcnt lgkmcnt(0)
  v_smfmac_f32_16x16x64_bf16 v[32:35], v[8:11], v[60:67], v74
  ds_read_b128 v[12:15], v76 offset:7680
  s_waitcnt lgkmcnt(0)
  v_smfmac_f32_16x16x64_bf16 v[20:23], v[12:15], v[112:119], v74
  v_smfmac_f32_16x16x64_bf16 v[24:27], v[12:15], v[120:127], v74
  v_smfmac_f32_16x16x64_bf16 v[28:31], v[12:15], v[224:231], v74
  v_smfmac_f32_16x16x64_bf16 v[32:35], v[12:15], v[232:239], v74
  ds_read_b128 v[0:3], v76 offset:8704
  s_waitcnt lgkmcnt(0)
  v_smfmac_f32_16x16x64_bf16 v[20:23], v[0:3], v[128:135], v74
  v_smfmac_f32_16x16x64_bf16 v[24:27], v[0:3], v[136:143], v74
  ds_read_b128 v[60:63], v75 offset:0
  ds_read_b128 v[64:67], v75 offset:1024
  s_waitcnt lgkmcnt(0)
  v_smfmac_f32_16x16x64_bf16 v[28:31], v[0:3], v[60:67], v74
  ds_read_b128 v[60:63], v75 offset:2048
  ds_read_b128 v[64:67], v75 offset:3072
  s_waitcnt lgkmcnt(0)
  v_smfmac_f32_16x16x64_bf16 v[32:35], v[0:3], v[60:67], v74
  ds_read_b128 v[4:7], v76 offset:9728
  s_waitcnt lgkmcnt(0)
  v_smfmac_f32_16x16x64_bf16 v[20:23], v[4:7], v[144:151], v74
  v_smfmac_f32_16x16x64_bf16 v[24:27], v[4:7], v[152:159], v74
  ds_read_b128 v[60:63], v75 offset:16384
  ds_read_b128 v[64:67], v75 offset:17408
  s_waitcnt lgkmcnt(0)
  v_smfmac_f32_16x16x64_bf16 v[28:31], v[4:7], v[60:67], v74
  ds_read_b128 v[60:63], v75 offset:18432
  ds_read_b128 v[64:67], v75 offset:19456
  s_waitcnt lgkmcnt(0)
  v_smfmac_f32_16x16x64_bf16 v[32:35], v[4:7], v[60:67], v74
  ds_read_b128 v[16:19], v76 offset:10752
  s_waitcnt lgkmcnt(0)
  v_smfmac_f32_16x16x64_bf16 v[20:23], v[16:19], v[160:167], v74
  v_smfmac_f32_16x16x64_bf16 v[24:27], v[16:19], v[168:175], v74
  v_smfmac_f32_16x16x64_bf16 v[28:31], v[16:19], v[240:247], v74
  v_smfmac_f32_16x16x64_bf16 v[32:35], v[16:19], v[248:255], v74
  ds_read_b128 v[12:15], v76 offset:11776
  s_waitcnt lgkmcnt(0)
  v_smfmac_f32_16x16x64_bf16 v[20:23], v[12:15], v[176:183], v74
  v_smfmac_f32_16x16x64_bf16 v[24:27], v[12:15], v[184:191], v74
  v_smfmac_f32_16x16x64_bf16 v[28:31], v[12:15], a[0:7], v74
  v_smfmac_f32_16x16x64_bf16 v[32:35], v[12:15], a[8:15], v74
  ds_read_b128 v[8:11], v76 offset:12800
  s_waitcnt lgkmcnt(0)
  v_smfmac_f32_16x16x64_bf16 v[20:23], v[8:11], v[192:199], v74
  v_smfmac_f32_16x16x64_bf16 v[24:27], v[8:11], v[200:207], v74
  v_smfmac_f32_16x16x64_bf16 v[28:31], v[8:11], a[16:23], v74
  v_smfmac_f32_16x16x64_bf16 v[32:35], v[8:11], a[24:31], v74
  v_add_f32 v20, v20, v22
  v_add_f32 v21, v21, v23
  v_add_f32 v24, v24, v26
  v_cvt_pk_bf16_f32 v22, v20, v24
  s_nop 0
  ds_write_b32 v79, v22 offset:0
  v_add_f32 v25, v25, v27
  v_cvt_pk_bf16_f32 v23, v21, v25
  ds_write_b32 v79, v23 offset:576
  v_add_f32 v28, v28, v30
  v_add_f32 v29, v29, v31
  s_waitcnt lgkmcnt(0)
  s_nop 1
  s_branch Cf0_recok
Cf0_mx:
  s_waitcnt lgkmcnt(0)
  s_barrier
  buffer_load_dwordx4 v[0:3], v76, s[8:11], s58 offen offset:0 sc1
  ds_read_b128 v[20:23], v77 offset:0
  ds_read_b128 v[28:31], v77 offset:256
  buffer_load_dwordx4 v[4:7], v76, s[8:11], s58 offen offset:1024 sc1
  ds_read_b128 v[24:27], v77 offset:128
  ds_read_b128 v[32:35], v77 offset:384
  s_waitcnt vmcnt(1) lgkmcnt(3)
  v_mfma_f32_16x16x32_bf16 v[8:11], v[0:3], v[20:23], 0
  s_waitcnt vmcnt(0) lgkmcnt(1)
  v_mfma_f32_16x16x32_bf16 v[8:11], v[4:7], v[24:27], v[8:11]
  v_mfma_f32_16x16x32_bf16 v[12:15], v[28:31], v[20:23], 0
  s_waitcnt lgkmcnt(0)
  v_mfma_f32_16x16x32_bf16 v[12:15], v[32:35], v[24:27], v[12:15]
  v_add_f32_dpp v8, v10, v8 quad_perm:[2,3,0,1] row_mask:0xf bank_mask:0xf
  v_add_f32_dpp v9, v11, v9 quad_perm:[2,3,0,1] row_mask:0xf bank_mask:0xf
  s_nop 0
  v_mov_b32_dpp v8, v8 quad_perm:[0,1,0,1] row_mask:0xf bank_mask:0xf
  v_mov_b32_dpp v9, v9 quad_perm:[0,1,0,1] row_mask:0xf bank_mask:0xf
  s_nop 1
  v_add_f32_dpp v12, v14, v12 quad_perm:[2,3,0,1] row_mask:0xf bank_mask:0xf
  v_add_f32_dpp v13, v15, v13 quad_perm:[2,3,0,1] row_mask:0xf bank_mask:0xf
  s_nop 0
  v_mov_b32_dpp v12, v12 quad_perm:[0,1,0,1] row_mask:0xf bank_mask:0xf
  v_mov_b32_dpp v13, v13 quad_perm:[0,1,0,1] row_mask:0xf bank_mask:0xf
  v_mul_f32 v12, s69, v12
  ds_write_b32 v78, v8 offset:8704
  v_mul_f32 v13, s69, v13
  ds_write_b32 v78, v9 offset:8768
  s_waitcnt lgkmcnt(0)
  s_barrier
  ds_read_b128 v[36:39], v78 offset:8704
  ds_read_b128 v[40:43], v78 offset:8768
  s_waitcnt lgkmcnt(0)
  s_barrier
  v_max_f32 v16, v36, v37
  v_max3_f32 v16, v16, v38, v39
  v_max3_f32 v16, v16, v40, v41
  v_max3_f32 v16, v16, v42, v43
  v_max3_f32 v16, v16, v12, v13
  v_mov_b32 v17, v16
  s_nop 1
  v_permlane16_swap_b32 v16, v17
  v_max_f32 v16, v16, v17
  v_mov_b32 v17, v16
  s_nop 1
  v_permlane32_swap_b32 v16, v17
  v_max_f32 v16, v16, v17
  v_sub_f32 v36, v36, v16
  v_sub_f32 v37, v37, v16
  v_sub_f32 v38, v38, v16
  v_sub_f32 v39, v39, v16
  v_sub_f32 v40, v40, v16
  v_sub_f32 v41, v41, v16
  v_sub_f32 v42, v42, v16
  v_sub_f32 v43, v43, v16
  v_sub_f32 v12, v12, v16
  v_sub_f32 v13, v13, v16
  v_exp_f32 v36, v36
  v_exp_f32 v37, v37
  v_exp_f32 v38, v38
  v_exp_f32 v39, v39
  v_exp_f32 v40, v40
  v_exp_f32 v41, v41
  v_exp_f32 v42, v42
  v_exp_f32 v43, v43
  v_exp_f32 v12, v12
  v_exp_f32 v13, v13
  v_cvt_pk_bf16_f32 v32, v36, v40
  v_cvt_pk_bf16_f32 v33, v37, v41
  v_cvt_pk_bf16_f32 v34, v38, v42
  v_cvt_pk_bf16_f32 v35, v39, v43
  v_cvt_pk_bf16_f32 v28, v12, v13
  v_cvt_pk_bf16_f32 v31, v12, v13
  v_mov_b32 v29, 0
  v_mov_b32 v30, 0
  v_mov_b32 v68, 0x3f803f80
  v_mov_b32 v69, 0x3f803f80
  v_mov_b32 v70, 0x3f803f80
  v_mov_b32 v71, 0x3f803f80
  s_nop 1
  v_mfma_f32_16x16x32_bf16 v[8:11], v[32:35], v[68:71], 0
  v_mfma_f32_16x16x32_bf16 v[0:3], v[32:35], v[52:55], 0
  v_mfma_f32_16x16x32_bf16 v[4:7], v[32:35], v[56:59], 0
  v_mfma_f32_16x16x16_bf16 v[8:11], v[28:29], v[68:69], v[8:11]
  v_mfma_f32_16x16x16_bf16 v[0:3], v[28:29], v[72:73], v[0:3]
  v_mfma_f32_16x16x16_bf16 v[4:7], v[30:31], v[72:73], v[4:7]
  ds_read_b128 v[68:71], v76 offset:13824
  v_rcp_f32 v10, v8
  v_rcp_f32 v11, v9
  v_mul_f32 v0, v10, v0
  v_mul_f32 v1, v11, v1
  s_nop 0
  v_mul_f32 v4, v10, v4
  v_mul_f32 v5, v11, v5
  v_cvt_pk_bf16_f32 v2, v0, v4
  ds_write_b32 v79, v2 offset:8704
  v_cvt_pk_bf16_f32 v3, v1, v5
  ds_write_b32 v79, v3 offset:9280
  v_mov_b64 v[16:17], 0
  v_mov_b64 v[18:19], 0
  v_mov_b64 v[20:21], 0
  v_mov_b64 v[22:23], 0
  v_mov_b64 v[24:25], 0
  v_mov_b64 v[26:27], 0
  s_branch Cf0_mxok
Cf0_last:
  s_waitcnt lgkmcnt(0)
  ds_read_b64 v[16:17], v77 offset:256
  v_mov_b64 v[18:19], v[72:73]
  s_add_u32 s68, s68, 655360
  s_waitcnt lgkmcnt(0)
  buffer_store_dwordx4 v[16:19], v76, s[8:11], s68 offen sc1
  s_branch L_cexit
L_w1:
  v_mov_b64 v[20:21], 0
  v_mov_b64 v[22:23], 0
  v_mov_b64 v[24:25], 0
  v_mov_b64 v[26:27], 0
  v_mov_b64 v[28:29], 0
  v_mov_b64 v[30:31], 0
  v_mov_b64 v[32:33], 0
  v_mov_b64 v[34:35], 0
  s_mov_b32 s78, 0x3f803f80
  s_mov_b32 s79, s78
  s_mov_b32 s65, 360448
  s_mov_b32 m0, 15872
  v_lshlrev_b32 v73, 2, v76
  v_mov_b32 v72, 0
  ds_read_b128 v[60:63], v76 offset:20480
  ds_read_b128 v[64:67], v76 offset:21504
  ds_read_b128 v[44:47], v76 offset:22528
  ds_read_b128 v[48:51], v76 offset:23552
  ds_read_b128 v[36:39], v76 offset:36864
  ds_read_b128 v[40:43], v76 offset:37888
  ds_read_b128 v[0:3], v76 offset:4608
  ds_read_b128 v[4:7], v76 offset:5632
  s_branch Cf1_top2
.p2align 6
Cf1_h2:
  v_lshlrev_b32 v73, 2, v76
  s_nop 15
  s_nop 11
  buffer_load_dwordx4 v[52:55], v76, s[8:11], s65 offen offset:2048 sc1
  s_nop 15
  s_nop 3
  buffer_load_dwordx4 v[52:55], v76, s[8:11], s65 offen offset:2048 sc1
  s_nop 15
  s_nop 3
  buffer_load_dwordx4 v[52:55], v76, s[8:11], s65 offen offset:2048 sc1
  s_waitcnt vmcnt(5)
  ds_read_b128 v[60:63], v76 offset:20480
  ds_read_b128 v[64:67], v76 offset:21504
  ds_read_b128 v[44:47], v76 offset:22528
  ds_read_b128 v[48:51], v76 offset:23552
  ds_read_b128 v[36:39], v76 offset:36864
  ds_read_b128 v[40:43], v76 offset:37888
  s_waitcnt vmcnt(2)
  v_max3_u32 v72, v52, v53, v54
  v_max_u32 v72, v72, v55
  ds_write_b128 v76, v[52:55] offset:6656
  v_cmp_eq_u32 vcc, -1, v72
  s_cbranch_vccnz Cf1_h2r
Cf1_h2w:
  s_waitcnt lgkmcnt(0)
  s_barrier
  ds_read_b128 v[0:3], v76 offset:4608
  ds_read_b128 v[4:7], v76 offset:5632
Cf1_top2:
  ds_read_b128 v[8:11], v76 offset:6656
  s_waitcnt lgkmcnt(2)
  v_smfmac_f32_16x16x64_bf16 v[20:23], v[0:3], v[60:67], v74
  ds_read_b128 v[60:63], v76 offset:38912
  v_smfmac_f32_16x16x64_bf16 v[24:27], v[0:3], v[44:51], v74
  buffer_load_dwordx4 v[44:47], v76, s[8:11], s58 offen offset:0 sc1
  ds_read_b128 v[64:67], v76 offset:39936
  s_waitcnt lgkmcnt(3)
  v_smfmac_f32_16x16x64_bf16 v[20:23], v[4:7], v[80:87], v74
  buffer_load_dwordx4 v[48:51], v76, s[8:11], s58 offen offset:1024 sc1
  v_smfmac_f32_16x16x64_bf16 v[28:31], v[0:3], v[36:43], v74
  buffer_load_dwordx4 v[52:55], v76, s[8:11], s59 offen offset:0 sc1
  ds_read_b128 v[36:39], v76 offset:53248
  v_smfmac_f32_16x16x64_bf16 v[24:27], v[4:7], v[88:95], v74
  buffer_load_dwordx4 v[56:59], v76, s[8:11], s59 offen offset:1024 sc1
  ds_read_b128 v[40:43], v76 offset:54272
  v_smfmac_f32_16x16x64_bf16 v[28:31], v[4:7], v[208:215], v74
  ds_read_b128 v[12:15], v76 offset:7680
  s_waitcnt lgkmcnt(5)
  v_smfmac_f32_16x16x64_bf16 v[32:35], v[4:7], v[216:223], v74
  buffer_store_dwordx4 v[16:19], v76, s[8:11], s68 offen sc1
  s_waitcnt lgkmcnt(3)
  v_smfmac_f32_16x16x64_bf16 v[32:35], v[0:3], v[60:67], v74
  buffer_load_dword v73, s[8:11], s70 offen  lds
  v_smfmac_f32_16x16x64_bf16 v[20:23], v[8:11], v[96:103], v74
  ds_read_b128 v[60:63], v76 offset:55296
  v_smfmac_f32_16x16x64_bf16 v[24:27], v[8:11], v[104:111], v74
  ds_read_b128 v[64:67], v76 offset:56320
  s_waitcnt lgkmcnt(3)
  v_smfmac_f32_16x16x64_bf16 v[28:31], v[8:11], v[36:43], v74
  ds_read_b128 v[36:39], v75 offset:4096
  s_waitcnt lgkmcnt(3)
  v_smfmac_f32_16x16x64_bf16 v[20:23], v[12:15], v[112:119], v74
  ds_read_b128 v[40:43], v75 offset:5120
  v_smfmac_f32_16x16x64_bf16 v[24:27], v[12:15], v[120:127], v74
  v_smfmac_f32_16x16x64_bf16 v[28:31], v[12:15], v[224:231], v74
  s_barrier
  ds_read_b128 v[0:3], v76 offset:8704
  v_smfmac_f32_16x16x64_bf16 v[32:35], v[12:15], v[232:239], v74
  ds_read_b128 v[4:7], v76 offset:9728
  s_waitcnt lgkmcnt(4)
  v_smfmac_f32_16x16x64_bf16 v[32:35], v[8:11], v[60:67], v74
  ds_read_b128 v[60:63], v75 offset:6144
  s_waitcnt lgkmcnt(2)
  v_smfmac_f32_16x16x64_bf16 v[20:23], v[0:3], v[128:135], v74
  ds_read_b128 v[16:19], v76 offset:10752
  v_smfmac_f32_16x16x64_bf16 v[24:27], v[0:3], v[136:143], v74
  ds_read_b128 v[64:67], v75 offset:7168
  v_smfmac_f32_16x16x64_bf16 v[28:31], v[0:3], v[36:43], v74
  ds_read_b128 v[36:39], v75 offset:20480
  s_waitcnt lgkmcnt(4)
  v_smfmac_f32_16x16x64_bf16 v[20:23], v[4:7], v[144:151], v74
  ds_read_b128 v[12:15], v76 offset:11776
  v_smfmac_f32_16x16x64_bf16 v[24:27], v[4:7], v[152:159], v74
  ds_read_b128 v[40:43], v75 offset:21504
  s_waitcnt lgkmcnt(4)
  v_smfmac_f32_16x16x64_bf16 v[20:23], v[16:19], v[160:167], v74
  ds_read_b128 v[8:11], v76 offset:12800
  s_waitcnt lgkmcnt(4)
  v_smfmac_f32_16x16x64_bf16 v[32:35], v[0:3], v[60:67], v74
  ds_read_b128 v[60:63], v75 offset:22528
  v_mov_b64 v[68:69], s[78:79]
  v_smfmac_f32_16x16x64_bf16 v[24:27], v[16:19], v[168:175], v74
  ds_read_b128 v[64:67], v75 offset:23552
  s_waitcnt lgkmcnt(4)
  v_smfmac_f32_16x16x64_bf16 v[20:23], v[12:15], v[176:183], v74
  s_waitcnt lgkmcnt(3)
  v_mov_b64 v[70:71], s[78:79]
  v_smfmac_f32_16x16x64_bf16 v[28:31], v[4:7], v[36:43], v74
  s_waitcnt lgkmcnt(2)
  v_mov_b64 v[36:37], 0
  v_smfmac_f32_16x16x64_bf16 v[20:23], v[8:11], v[192:199], v74
  v_mov_b64 v[38:39], 0
  v_smfmac_f32_16x16x64_bf16 v[24:27], v[12:15], v[184:191], v74
  v_mov_b64 v[40:41], 0
  v_smfmac_f32_16x16x64_bf16 v[24:27], v[8:11], v[200:207], v74
  s_waitcnt lgkmcnt(0)
  v_add_f32 v20, v20, v22
  v_smfmac_f32_16x16x64_bf16 v[32:35], v[4:7], v[60:67], v74
  v_add_f32 v21, v21, v23
  v_smfmac_f32_16x16x64_bf16 v[28:31], v[16:19], v[240:247], v74
  v_add_f32 v24, v24, v26
  v_cvt_pk_bf16_f32 v22, v20, v24
  v_smfmac_f32_16x16x64_bf16 v[28:31], v[12:15], a[0:7], v74
  ds_write_b32 v79, v22 offset:0
  v_add_f32 v25, v25, v27
  v_cvt_pk_bf16_f32 v23, v21, v25
  v_smfmac_f32_16x16x64_bf16 v[28:31], v[8:11], a[16:23], v74
  ds_write_b32 v79, v23 offset:576
  v_cmp_u_f32 vcc, v20, v21
  v_smfmac_f32_16x16x64_bf16 v[32:35], v[16:19], v[248:255], v74
  v_mov_b64 v[42:43], 0
  v_smfmac_f32_16x16x64_bf16 v[32:35], v[12:15], a[8:15], v74
  v_add_f32 v28, v28, v30
  v_add_f32 v29, v29, v31
  v_smfmac_f32_16x16x64_bf16 v[32:35], v[8:11], a[24:31], v74
  s_cbranch_vccnz Cf1_rec
Cf1_recok:
  v_smfmac_f32_16x16x64_bf16 v[36:39], v[16:19], a[128:135], v74
  s_waitcnt lgkmcnt(0)
  s_barrier
  ds_read_b128 v[60:63], v77
  v_smfmac_f32_16x16x64_bf16 v[40:43], v[16:19], a[136:143], v74
  ds_read_b128 v[64:67], v77 offset:128
  v_add_f32 v32, v32, v34
  v_cvt_pk_bf16_f32 v30, v28, v32
  v_smfmac_f32_16x16x64_bf16 v[36:39], v[0:3], a[96:103], v74
  ds_write_b32 v79, v30 offset:256
  v_add_f32 v33, v33, v35
  v_cvt_pk_bf16_f32 v31, v29, v33
  v_smfmac_f32_16x16x64_bf16 v[40:43], v[0:3], a[104:111], v74
  ds_write_b32 v79, v31 offset:832
  v_xor_b32 v75, 0x8000, v75
  v_smfmac_f32_16x16x64_bf16 v[36:39], v[4:7], a[112:119], v74
  ds_read_b128 v[0:3], v76 offset:4608
  v_mov_b32 v29, 0
  v_smfmac_f32_16x16x64_bf16 v[40:43], v[4:7], a[120:127], v74
  s_waitcnt vmcnt(4) lgkmcnt(3)
  v_mov_b32 v30, 0
  v_mfma_f32_16x16x32_bf16 v[44:47], v[44:47], v[60:63], 0
  ds_read_b128 v[4:7], v76 offset:5632
  s_waitcnt lgkmcnt(2)
  v_mfma_f32_16x16x32_bf16 v[44:47], v[48:51], v[64:67], v[44:47]
  s_barrier
  v_smfmac_f32_16x16x64_bf16 v[36:39], v[8:11], a[160:167], v74
  ds_read_b128 v[20:23], v77 offset:256
  ds_read_b128 v[24:27], v77 offset:384
  v_smfmac_f32_16x16x64_bf16 v[40:43], v[8:11], a[168:175], v74
  ds_read_b128 v[8:11], v76 offset:6656
  v_add_f32_dpp v72, v46, v44 quad_perm:[2,3,0,1] row_mask:0xf bank_mask:0xf
  v_add_f32_dpp v73, v47, v45 quad_perm:[2,3,0,1] row_mask:0xf bank_mask:0xf
  v_smfmac_f32_16x16x64_bf16 v[36:39], v[12:15], a[144:151], v74
  s_waitcnt lgkmcnt(4)
  v_exp_f32_dpp v72, v72 quad_perm:[0,1,0,1] row_mask:0xf bank_mask:0xf
  v_smfmac_f32_16x16x64_bf16 v[40:43], v[12:15], a[152:159], v74
  ds_read_b128 v[12:15], v76 offset:7680
  v_exp_f32_dpp v73, v73 quad_perm:[0,1,0,1] row_mask:0xf bank_mask:0xf
  v_smfmac_f32_16x16x64_bf16 v[36:39], v[0:3], a[32:39], v74
  s_waitcnt lgkmcnt(2)
  v_cvt_pk_bf16_f32 v72, v72, v73
  v_mfma_f32_16x16x32_bf16 v[20:23], v[20:23], v[60:63], 0
  ds_write_b32 v78, v72 offset:516
  v_mov_b64 v[16:17], 0
  v_mfma_f32_16x16x32_bf16 v[20:23], v[24:27], v[64:67], v[20:23]
  ds_read_b128 v[44:47], v75 offset:20480
  v_mov_b64 v[18:19], 0
  v_smfmac_f32_16x16x64_bf16 v[40:43], v[0:3], a[40:47], v74
  ds_read_b128 v[48:51], v75 offset:21504
  s_waitcnt lgkmcnt(4)
  v_smfmac_f32_16x16x64_bf16 v[36:39], v[4:7], a[48:55], v74
  v_add_f32_dpp v24, v22, v20 quad_perm:[2,3,0,1] row_mask:0xf bank_mask:0xf
  v_add_f32_dpp v25, v23, v21 quad_perm:[2,3,0,1] row_mask:0xf bank_mask:0xf
  v_smfmac_f32_16x16x64_bf16 v[36:39], v[8:11], a[64:71], v74
  s_waitcnt lgkmcnt(2)
  s_barrier
  ds_read_b128 v[32:35], v78 offset:512
  v_smfmac_f32_16x16x64_bf16 v[36:39], v[12:15], a[80:87], v74
  ds_read_b128 v[60:63], v75 offset:22528
  v_mul_f32 v24, s69, v24
  v_smfmac_f32_16x16x64_bf16 v[40:43], v[4:7], a[56:63], v74
  ds_read_b128 v[64:67], v75 offset:23552
  v_mul_f32 v25, s69, v25
  v_smfmac_f32_16x16x64_bf16 v[40:43], v[8:11], a[72:79], v74
  v_exp_f32_dpp v24, v24 quad_perm:[0,1,0,1] row_mask:0xf bank_mask:0xf
  v_smfmac_f32_16x16x64_bf16 v[40:43], v[12:15], a[88:95], v74
  s_waitcnt vmcnt(2) lgkmcnt(2)
  v_exp_f32_dpp v25, v25 quad_perm:[0,1,0,1] row_mask:0xf bank_mask:0xf
  v_mfma_f32_16x16x32_bf16 v[8:11], v[32:35], v[68:71], 0
  v_add_f32 v36, v36, v38
  v_add_f32 v37, v37, v39
  v_mfma_f32_16x16x32_bf16 v[0:3], v[32:35], v[52:55], 0
  v_add_f32 v40, v40, v42
  v_add_f32 v41, v41, v43
  v_mfma_f32_16x16x32_bf16 v[4:7], v[32:35], v[56:59], 0
  v_cvt_pk_bf16_f32 v28, v24, v25
  v_cvt_pk_bf16_f32 v72, v36, v37
  v_cvt_pk_bf16_f32 v73, v40, v41
  v_mfma_f32_16x16x16_bf16 v[8:11], v[28:29], v[68:69], v[8:11]
  v_cvt_pk_bf16_f32 v31, v24, v25
  v_mov_b64 v[20:21], 0
  v_mfma_f32_16x16x16_bf16 v[0:3], v[28:29], v[72:73], v[0:3]
  ds_read_b128 v[68:71], v76 offset:13824
  v_mov_b64 v[22:23], 0
  v_mfma_f32_16x16x16_bf16 v[4:7], v[30:31], v[72:73], v[4:7]
  v_rcp_f32 v10, v8
  v_rcp_f32 v11, v9
  v_mul_f32 v0, v10, v0
  v_mul_f32 v1, v11, v1
  s_nop 0
  v_mul_f32 v4, v10, v4
  v_mul_f32 v5, v11, v5
  v_cvt_pk_bf16_f32 v2, v0, v4
  ds_write_b32 v79, v2 offset:8704
  v_cvt_pk_bf16_f32 v3, v1, v5
  ds_write_b32 v79, v3 offset:9280
  v_max3_f32 v8, v8, v9, v10
  v_max_f32 v8, v8, v11
  v_cmp_le_f32 vcc, 1317011456, v8
  v_mov_b64 v[24:25], 0
  v_mov_b64 v[26:27], 0
  s_cbranch_vccnz Cf1_mx
Cf1_mxok:
  s_waitcnt lgkmcnt(0)
  s_barrier
  ds_read_b128 v[0:3], v78 offset:8704
  ds_read_b128 v[4:7], v78 offset:8768
  ds_read_b128 v[8:11], v78 offset:8832
  ds_read_b128 v[12:15], v78 offset:8896
  s_cmp_eq_u32 s66, 63
  s_cbranch_scc1 Cf1_last
  s_waitcnt lgkmcnt(3)
  v_smfmac_f32_16x16x64_bf16 v[16:19], v[0:3], v[44:51], v74
  ds_read_b128 v[52:55], v75 offset:36864
  s_waitcnt lgkmcnt(3)
  v_smfmac_f32_16x16x64_bf16 v[16:19], v[4:7], v[60:67], v74
  ds_read_b128 v[56:59], v75 offset:37888
  s_waitcnt lgkmcnt(3)
  v_smfmac_f32_16x16x64_bf16 v[16:19], v[8:11], a[176:183], v74
  ds_read_b128 v[36:39], v75 offset:38912
  s_waitcnt lgkmcnt(3)
  v_smfmac_f32_16x16x64_bf16 v[16:19], v[12:15], a[184:191], v74
  ds_read_b128 v[40:43], v75 offset:39936
  ds_read_b128 v[44:47], v75 offset:53248
  v_smfmac_f32_16x16x64_bf16 v[20:23], v[0:3], a[192:199], v74
  ds_read_b128 v[48:51], v75 offset:54272
  ds_read_b128 v[60:63], v75 offset:55296
  v_smfmac_f32_16x16x64_bf16 v[20:23], v[4:7], a[200:207], v74
  ds_read_b128 v[64:67], v75 offset:56320
  s_waitcnt lgkmcnt(6)
  v_cvt_pk_bf16_f32 v16, v16, v17
  v_cvt_pk_bf16_f32 v17, v18, v19
  v_bfi_b32 v16, 1, s72, v16
  v_smfmac_f32_16x16x64_bf16 v[20:23], v[8:11], v[52:59], v74
  buffer_store_dwordx2 v[16:17], v68, s[8:11], s73 offen
  s_waitcnt lgkmcnt(4)
  v_smfmac_f32_16x16x64_bf16 v[20:23], v[12:15], v[36:43], v74
  v_mov_b64 v[32:33], 0
  v_smfmac_f32_16x16x64_bf16 v[24:27], v[0:3], a[208:215], v74
  v_mov_b64 v[34:35], 0
  v_smfmac_f32_16x16x64_bf16 v[24:27], v[4:7], a[216:223], v74
  s_waitcnt lgkmcnt(2)
  v_cvt_pk_bf16_f32 v20, v20, v21
  v_cvt_pk_bf16_f32 v21, v22, v23
  v_bfi_b32 v20, 1, s72, v20
  v_smfmac_f32_16x16x64_bf16 v[24:27], v[8:11], v[44:51], v74
  buffer_store_dwordx2 v[20:21], v68, s[8:11], s74 offen
  s_waitcnt lgkmcnt(0)
  v_smfmac_f32_16x16x64_bf16 v[24:27], v[12:15], v[60:67], v74
  v_smfmac_f32_16x16x64_bf16 v[32:35], v[0:3], a[224:231], v74
  v_smfmac_f32_16x16x64_bf16 v[32:35], v[4:7], a[232:239], v74
  v_cvt_pk_bf16_f32 v24, v24, v25
  v_cvt_pk_bf16_f32 v25, v26, v27
  v_bfi_b32 v24, 1, s72, v24
  v_smfmac_f32_16x16x64_bf16 v[32:35], v[8:11], a[240:247], v74
  s_nop 1
  buffer_store_dwordx2 v[24:25], v68, s[8:11], s75 offen
  v_smfmac_f32_16x16x64_bf16 v[32:35], v[12:15], a[248:255], v74
  ds_read_b128 v[0:3], v76 offset:14848
  ds_read_b64 v[16:17], v77 offset:264
  v_mov_b64 v[18:19], v[72:73]
  v_xor_b32 v75, 0x8000, v75
  s_nop 3
  v_cvt_pk_bf16_f32 v32, v32, v33
  v_cvt_pk_bf16_f32 v33, v34, v35
  v_bfi_b32 v32, 1, s72, v32
  buffer_store_dwordx2 v[32:33], v68, s[8:11], s76 offen
  v_mov_b64 v[20:21], 0
  v_mov_b64 v[22:23], 0
  v_mov_b64 v[24:25], 0
  v_mov_b64 v[26:27], 0
  v_mov_b64 v[28:29], 0
  v_mov_b64 v[30:31], 0
  v_mov_b64 v[32:33], 0
  v_mov_b64 v[34:35], 0
  s_add_u32 s58, s58, 655360
  s_add_u32 s59, s59, 655360
  s_add_u32 s70, s70, 655360
  s_add_u32 s68, s68, 655360
  s_add_u32 s66, s66, 1
  s_xor_b32 s64, s64, 16384
  s_xor_b32 s65, s65, 16384
  s_nop 15
  s_nop 15
  s_nop 7
  buffer_load_dwordx4 v[52:55], v76, s[8:11], s60 offen offset:0 sc1
  buffer_load_dwordx4 v[56:59], v76, s[8:11], s60 offen offset:1024 sc1
  s_nop 15
  s_nop 11
  buffer_load_dwordx4 v[36:39], v76, s[8:11], s60 offen offset:0 sc1
  buffer_load_dwordx4 v[40:43], v76, s[8:11], s60 offen offset:1024 sc1
  s_waitcnt lgkmcnt(0)
  s_waitcnt vmcnt(3)
  v_mfma_f32_16x16x32_bf16 v[4:7], v[0:3], v[52:55], 0
  v_bitop3_b32 v72, v52, v54, s72 bitop3:0x7e
  s_waitcnt vmcnt(2)
  v_mfma_f32_16x16x32_bf16 v[4:7], v[0:3], v[56:59], v[4:7]
  v_bitop3_b32 v73, v56, v58, s72 bitop3:0x7e
  v_bitop3_b32 v72, v72, v73, 1 bitop3:0xa8
  v_cmp_ne_u32 vcc, 0, v72
  s_cbranch_vccnz Cf1_h1r
  s_nop 2
  v_add_f32_dpp v4, v4, v4 row_ror:4 row_mask:0xf bank_mask:0xf
  v_add_f32_dpp v5, v5, v5 row_ror:4 row_mask:0xf bank_mask:0xf
  s_nop 0
  v_add_f32_dpp v4, v4, v4 row_ror:8 row_mask:0xf bank_mask:0xf
  v_add_f32_dpp v5, v5, v5 row_ror:8 row_mask:0xf bank_mask:0xf
  v_cvt_pk_bf16_f32 v4, v4, v5
  buffer_store_dword v4, v69, s[8:11], s62 offen
  s_xor_b32 s62, s62, 16384
  buffer_store_dword v71, v69, s[8:11], s62 offen
  s_xor_b32 s72, s72, 1
  s_branch Cf1_h2
Cf1_h1r:
  s_mov_b64 exec, vcc
  buffer_load_dwordx4 v[52:55], v76, s[8:11], s60 offen offset:0 sc1
  buffer_load_dwordx4 v[56:59], v76, s[8:11], s60 offen offset:1024 sc1
  s_mov_b64 exec, -1
  s_add_u32 s67, s67, 1
  s_waitcnt vmcnt(3)
  v_mfma_f32_16x16x32_bf16 v[4:7], v[0:3], v[36:39], 0
  v_bitop3_b32 v72, v36, v38, s72 bitop3:0x7e
  s_waitcnt vmcnt(2)
  v_mfma_f32_16x16x32_bf16 v[4:7], v[0:3], v[40:43], v[4:7]
  v_bitop3_b32 v73, v40, v42, s72 bitop3:0x7e
  v_bitop3_b32 v72, v72, v73, 1 bitop3:0xa8
  v_cmp_ne_u32 vcc, 0, v72
  s_cbranch_vccz Cf1_h1p
  s_mov_b64 exec, vcc
  buffer_load_dwordx4 v[36:39], v76, s[8:11], s60 offen offset:0 sc1
  buffer_load_dwordx4 v[40:43], v76, s[8:11], s60 offen offset:1024 sc1
  s_mov_b64 exec, -1
  s_add_u32 s67, s67, 1
  s_waitcnt vmcnt(3)
  v_mfma_f32_16x16x32_bf16 v[4:7], v[0:3], v[52:55], 0
  v_bitop3_b32 v72, v52, v54, s72 bitop3:0x7e
  s_waitcnt vmcnt(2)
  v_mfma_f32_16x16x32_bf16 v[4:7], v[0:3], v[56:59], v[4:7]
  v_bitop3_b32 v73, v56, v58, s72 bitop3:0x7e
  v_bitop3_b32 v72, v72, v73, 1 bitop3:0xa8
  v_cmp_ne_u32 vcc, 0, v72
  s_cbranch_vccz Cf1_h1p
Cf1_h1s:
  s_mov_b64 exec, vcc
  buffer_load_dwordx4 v[52:55], v76, s[8:11], s60 offen offset:0 sc1
  buffer_load_dwordx4 v[56:59], v76, s[8:11], s60 offen offset:1024 sc1
  s_mov_b64 exec, -1
  s_add_u32 s67, s67, 1
  s_waitcnt vmcnt(3)
  v_mfma_f32_16x16x32_bf16 v[4:7], v[0:3], v[36:39], 0
  v_bitop3_b32 v72, v36, v38, s72 bitop3:0x7e
  s_waitcnt vmcnt(2)
  v_mfma_f32_16x16x32_bf16 v[4:7], v[0:3], v[40:43], v[4:7]
  v_bitop3_b32 v73, v40, v42, s72 bitop3:0x7e
  v_bitop3_b32 v72, v72, v73, 1 bitop3:0xa8
  v_cmp_ne_u32 vcc, 0, v72
  s_cbranch_vccz Cf1_h1p
  s_mov_b64 exec, vcc
  buffer_load_dwordx4 v[36:39], v76, s[8:11], s60 offen offset:0 sc1
  buffer_load_dwordx4 v[40:43], v76, s[8:11], s60 offen offset:1024 sc1
  s_mov_b64 exec, -1
  s_add_u32 s67, s67, 1
  s_waitcnt vmcnt(3)
  v_mfma_f32_16x16x32_bf16 v[4:7], v[0:3], v[52:55], 0
  v_bitop3_b32 v72, v52, v54, s72 bitop3:0x7e
  s_waitcnt vmcnt(2)
  v_mfma_f32_16x16x32_bf16 v[4:7], v[0:3], v[56:59], v[4:7]
  v_bitop3_b32 v73, v56, v58, s72 bitop3:0x7e
  v_bitop3_b32 v72, v72, v73, 1 bitop3:0xa8
  v_cmp_ne_u32 vcc, 0, v72
  s_cbranch_vccz Cf1_h1p
  s_cmp_lt_u32 s67, 131072
  s_cbranch_scc1 Cf1_h1s
Cf1_h1p:
  s_nop 2
  v_add_f32_dpp v4, v4, v4 row_ror:4 row_mask:0xf bank_mask:0xf
  v_add_f32_dpp v5, v5, v5 row_ror:4 row_mask:0xf bank_mask:0xf
  s_nop 0
  v_add_f32_dpp v4, v4, v4 row_ror:8 row_mask:0xf bank_mask:0xf
  v_add_f32_dpp v5, v5, v5 row_ror:8 row_mask:0xf bank_mask:0xf
  v_cvt_pk_bf16_f32 v4, v4, v5
  buffer_store_dword v4, v69, s[8:11], s62 offen
  s_xor_b32 s62, s62, 16384
  buffer_store_dword v71, v69, s[8:11], s62 offen
  s_xor_b32 s72, s72, 1
  s_branch Cf1_h2
Cf1_h2r:
  s_mov_b64 exec, vcc
  buffer_load_dwordx4 v[52:55], v76, s[8:11], s65 offen offset:2048 sc1
  s_mov_b64 exec, -1
  s_add_u32 s67, s67, 1
  s_waitcnt vmcnt(2)
  v_max3_u32 v72, v52, v53, v54
  v_max_u32 v72, v72, v55
  ds_write_b128 v76, v[52:55] offset:6656
  v_cmp_eq_u32 vcc, -1, v72
  s_cbranch_vccz Cf1_h2w
  s_mov_b64 exec, vcc
  buffer_load_dwordx4 v[52:55], v76, s[8:11], s65 offen offset:2048 sc1
  s_mov_b64 exec, -1
  s_add_u32 s67, s67, 1
  s_waitcnt vmcnt(2)
  v_max3_u32 v72, v52, v53, v54
  v_max_u32 v72, v72, v55
  ds_write_b128 v76, v[52:55] offset:6656
  v_cmp_eq_u32 vcc, -1, v72
  s_cbranch_vccz Cf1_h2w
  s_mov_b64 exec, vcc
  buffer_load_dwordx4 v[52:55], v76, s[8:11], s65 offen offset:2048 sc1
  s_mov_b64 exec, -1
  s_add_u32 s67, s67, 1
  s_waitcnt vmcnt(2)
  v_max3_u32 v72, v52, v53, v54
  v_max_u32 v72, v72, v55
  ds_write_b128 v76, v[52:55] offset:6656
  v_cmp_eq_u32 vcc, -1, v72
  s_cbranch_vccz Cf1_h2w
  s_mov_b64 exec, vcc
  buffer_load_dwordx4 v[52:55], v76, s[8:11], s65 offen offset:2048 sc1
  s_mov_b64 exec, -1
  s_add_u32 s67, s67, 1
  s_waitcnt vmcnt(2)
  v_max3_u32 v72, v52, v53, v54
  v_max_u32 v72, v72, v55
  ds_write_b128 v76, v[52:55] offset:6656
  v_cmp_eq_u32 vcc, -1, v72
  s_cbranch_vccz Cf1_h2w
  s_cmp_lt_u32 s67, 131072
  s_cbranch_scc1 Cf1_h2r
Cf1_h2ok:
  ds_write_b128 v76, v[52:55] offset:6656
  s_branch Cf1_h2w
Cf1_rec:
  s_nop 7
  s_waitcnt vmcnt(0) lgkmcnt(0)
  v_max3_u32 v72, v0, v1, v2
  v_max3_u32 v72, v72, v3, v4
  v_max3_u32 v72, v72, v5, v6
  v_max3_u32 v72, v72, v7, v8
  v_max3_u32 v72, v72, v9, v10
  v_max3_u32 v72, v72, v11, v12
  v_max3_u32 v72, v72, v13, v14
  v_max3_u32 v72, v72, v15, v16
  v_max3_u32 v72, v72, v17, v18
  v_max_u32 v72, v72, v19
  v_cmp_eq_u32 vcc, -1, v72
  s_cbranch_vccz Cf1_recok
  s_barrier
  v_mov_b64 v[20:21], 0
  v_mov_b64 v[22:23], 0
  v_mov_b64 v[24:25], 0
  v_mov_b64 v[26:27], 0
  v_mov_b64 v[28:29], 0
  v_mov_b64 v[30:31], 0
  v_mov_b64 v[32:33], 0
  v_mov_b64 v[34:35], 0
  s_waitcnt lgkmcnt(0)
  s_barrier
  ds_read_b128 v[0:3], v76 offset:4608
  ds_read_b128 v[60:63], v76 offset:20480
  ds_read_b128 v[64:67], v76 offset:21504
  s_waitcnt lgkmcnt(0)
  v_smfmac_f32_16x16x64_bf16 v[20:23], v[0:3], v[60:67], v74
  ds_read_b128 v[60:63], v76 offset:22528
  ds_read_b128 v[64:67], v76 offset:23552
  s_waitcnt lgkmcnt(0)
  v_smfmac_f32_16x16x64_bf16 v[24:27], v[0:3], v[60:67], v74
  ds_read_b128 v[60:63], v76 offset:36864
  ds_read_b128 v[64:67], v76 offset:37888
  s_waitcnt lgkmcnt(0)
  v_smfmac_f32_16x16x64_bf16 v[28:31], v[0:3], v[60:67], v74
  ds_read_b128 v[60:63], v76 offset:38912
  ds_read_b128 v[64:67], v76 offset:39936
  s_waitcnt lgkmcnt(0)
  v_smfmac_f32_16x16x64_bf16 v[32:35], v[0:3], v[60:67], v74
  ds_read_b128 v[4:7], v76 offset:5632
  s_waitcnt lgkmcnt(0)
  v_smfmac_f32_16x16x64_bf16 v[20:23], v[4:7], v[80:87], v74
  v_smfmac_f32_16x16x64_bf16 v[24:27], v[4:7], v[88:95], v74
  v_smfmac_f32_16x16x64_bf16 v[28:31], v[4:7], v[208:215], v74
  v_smfmac_f32_16x16x64_bf16 v[32:35], v[4:7], v[216:223], v74
  ds_read_b128 v[8:11], v76 offset:6656
  s_waitcnt lgkmcnt(0)
  v_smfmac_f32_16x16x64_bf16 v[20:23], v[8:11], v[96:103], v74
  v_smfmac_f32_16x16x64_bf16 v[24:27], v[8:11], v[104:111], v74
  ds_read_b128 v[60:63], v76 offset:53248
  ds_read_b128 v[64:67], v76 offset:54272
  s_waitcnt lgkmcnt(0)
  v_smfmac_f32_16x16x64_bf16 v[28:31], v[8:11], v[60:67], v74
  ds_read_b128 v[60:63], v76 offset:55296
  ds_read_b128 v[64:67], v76 offset:56320
  s_waitcnt lgkmcnt(0)
  v_smfmac_f32_16x16x64_bf16 v[32:35], v[8:11], v[60:67], v74
  ds_read_b128 v[12:15], v76 offset:7680
  s_waitcnt lgkmcnt(0)
  v_smfmac_f32_16x16x64_bf16 v[20:23], v[12:15], v[112:119], v74
  v_smfmac_f32_16x16x64_bf16 v[24:27], v[12:15], v[120:127], v74
  v_smfmac_f32_16x16x64_bf16 v[28:31], v[12:15], v[224:231], v74
  v_smfmac_f32_16x16x64_bf16 v[32:35], v[12:15], v[232:239], v74
  ds_read_b128 v[0:3], v76 offset:8704
  s_waitcnt lgkmcnt(0)
  v_smfmac_f32_16x16x64_bf16 v[20:23], v[0:3], v[128:135], v74
  v_smfmac_f32_16x16x64_bf16 v[24:27], v[0:3], v[136:143], v74
  ds_read_b128 v[60:63], v75 offset:4096
  ds_read_b128 v[64:67], v75 offset:5120
  s_waitcnt lgkmcnt(0)
  v_smfmac_f32_16x16x64_bf16 v[28:31], v[0:3], v[60:67], v74
  ds_read_b128 v[60:63], v75 offset:6144
  ds_read_b128 v[64:67], v75 offset:7168
  s_waitcnt lgkmcnt(0)
  v_smfmac_f32_16x16x64_bf16 v[32:35], v[0:3], v[60:67], v74
  ds_read_b128 v[4:7], v76 offset:9728
  s_waitcnt lgkmcnt(0)
  v_smfmac_f32_16x16x64_bf16 v[20:23], v[4:7], v[144:151], v74
  v_smfmac_f32_16x16x64_bf16 v[24:27], v[4:7], v[152:159], v74
  ds_read_b128 v[60:63], v75 offset:20480
  ds_read_b128 v[64:67], v75 offset:21504
  s_waitcnt lgkmcnt(0)
  v_smfmac_f32_16x16x64_bf16 v[28:31], v[4:7], v[60:67], v74
  ds_read_b128 v[60:63], v75 offset:22528
  ds_read_b128 v[64:67], v75 offset:23552
  s_waitcnt lgkmcnt(0)
  v_smfmac_f32_16x16x64_bf16 v[32:35], v[4:7], v[60:67], v74
  ds_read_b128 v[16:19], v76 offset:10752
  s_waitcnt lgkmcnt(0)
  v_smfmac_f32_16x16x64_bf16 v[20:23], v[16:19], v[160:167], v74
  v_smfmac_f32_16x16x64_bf16 v[24:27], v[16:19], v[168:175], v74
  v_smfmac_f32_16x16x64_bf16 v[28:31], v[16:19], v[240:247], v74
  v_smfmac_f32_16x16x64_bf16 v[32:35], v[16:19], v[248:255], v74
  ds_read_b128 v[12:15], v76 offset:11776
  s_waitcnt lgkmcnt(0)
  v_smfmac_f32_16x16x64_bf16 v[20:23], v[12:15], v[176:183], v74
  v_smfmac_f32_16x16x64_bf16 v[24:27], v[12:15], v[184:191], v74
  v_smfmac_f32_16x16x64_bf16 v[28:31], v[12:15], a[0:7], v74
  v_smfmac_f32_16x16x64_bf16 v[32:35], v[12:15], a[8:15], v74
  ds_read_b128 v[8:11], v76 offset:12800
  s_waitcnt lgkmcnt(0)
  v_smfmac_f32_16x16x64_bf16 v[20:23], v[8:11], v[192:199], v74
  v_smfmac_f32_16x16x64_bf16 v[24:27], v[8:11], v[200:207], v74
  v_smfmac_f32_16x16x64_bf16 v[28:31], v[8:11], a[16:23], v74
  v_smfmac_f32_16x16x64_bf16 v[32:35], v[8:11], a[24:31], v74
  v_add_f32 v20, v20, v22
  v_add_f32 v21, v21, v23
  v_add_f32 v24, v24, v26
  v_cvt_pk_bf16_f32 v22, v20, v24
  s_nop 0
  ds_write_b32 v79, v22 offset:0
  v_add_f32 v25, v25, v27
  v_cvt_pk_bf16_f32 v23, v21, v25
  ds_write_b32 v79, v23 offset:576
  v_add_f32 v28, v28, v30
  v_add_f32 v29, v29, v31
  s_waitcnt lgkmcnt(0)
  s_nop 1
  s_branch Cf1_recok
Cf1_mx:
  s_waitcnt lgkmcnt(0)
  s_barrier
  buffer_load_dwordx4 v[0:3], v76, s[8:11], s58 offen offset:0 sc1
  ds_read_b128 v[20:23], v77 offset:0
  ds_read_b128 v[28:31], v77 offset:256
  buffer_load_dwordx4 v[4:7], v76, s[8:11], s58 offen offset:1024 sc1
  ds_read_b128 v[24:27], v77 offset:128
  ds_read_b128 v[32:35], v77 offset:384
  s_waitcnt vmcnt(1) lgkmcnt(3)
  v_mfma_f32_16x16x32_bf16 v[8:11], v[0:3], v[20:23], 0
  s_waitcnt vmcnt(0) lgkmcnt(1)
  v_mfma_f32_16x16x32_bf16 v[8:11], v[4:7], v[24:27], v[8:11]
  v_mfma_f32_16x16x32_bf16 v[12:15], v[28:31], v[20:23], 0
  s_waitcnt lgkmcnt(0)
  v_mfma_f32_16x16x32_bf16 v[12:15], v[32:35], v[24:27], v[12:15]
  v_add_f32_dpp v8, v10, v8 quad_perm:[2,3,0,1] row_mask:0xf bank_mask:0xf
  v_add_f32_dpp v9, v11, v9 quad_perm:[2,3,0,1] row_mask:0xf bank_mask:0xf
  s_nop 0
  v_mov_b32_dpp v8, v8 quad_perm:[0,1,0,1] row_mask:0xf bank_mask:0xf
  v_mov_b32_dpp v9, v9 quad_perm:[0,1,0,1] row_mask:0xf bank_mask:0xf
  s_nop 1
  v_add_f32_dpp v12, v14, v12 quad_perm:[2,3,0,1] row_mask:0xf bank_mask:0xf
  v_add_f32_dpp v13, v15, v13 quad_perm:[2,3,0,1] row_mask:0xf bank_mask:0xf
  s_nop 0
  v_mov_b32_dpp v12, v12 quad_perm:[0,1,0,1] row_mask:0xf bank_mask:0xf
  v_mov_b32_dpp v13, v13 quad_perm:[0,1,0,1] row_mask:0xf bank_mask:0xf
  v_mul_f32 v12, s69, v12
  ds_write_b32 v78, v8 offset:8708
  v_mul_f32 v13, s69, v13
  ds_write_b32 v78, v9 offset:8772
  s_waitcnt lgkmcnt(0)
  s_barrier
  ds_read_b128 v[36:39], v78 offset:8704
  ds_read_b128 v[40:43], v78 offset:8768
  s_waitcnt lgkmcnt(0)
  s_barrier
  v_max_f32 v16, v36, v37
  v_max3_f32 v16, v16, v38, v39
  v_max3_f32 v16, v16, v40, v41
  v_max3_f32 v16, v16, v42, v43
  v_max3_f32 v16, v16, v12, v13
  v_mov_b32 v17, v16
  s_nop 1
  v_permlane16_swap_b32 v16, v17
  v_max_f32 v16, v16, v17
  v_mov_b32 v17, v16
  s_nop 1
  v_permlane32_swap_b32 v16, v17
  v_max_f32 v16, v16, v17
  v_sub_f32 v36, v36, v16
  v_sub_f32 v37, v37, v16
  v_sub_f32 v38, v38, v16
  v_sub_f32 v39, v39, v16
  v_sub_f32 v40, v40, v16
  v_sub_f32 v41, v41, v16
  v_sub_f32 v42, v42, v16
  v_sub_f32 v43, v43, v16
  v_sub_f32 v12, v12, v16
  v_sub_f32 v13, v13, v16
  v_exp_f32 v36, v36
  v_exp_f32 v37, v37
  v_exp_f32 v38, v38
  v_exp_f32 v39, v39
  v_exp_f32 v40, v40
  v_exp_f32 v41, v41
  v_exp_f32 v42, v42
  v_exp_f32 v43, v43
  v_exp_f32 v12, v12
  v_exp_f32 v13, v13
  v_cvt_pk_bf16_f32 v32, v36, v40
  v_cvt_pk_bf16_f32 v33, v37, v41
  v_cvt_pk_bf16_f32 v34, v38, v42
  v_cvt_pk_bf16_f32 v35, v39, v43
  v_cvt_pk_bf16_f32 v28, v12, v13
  v_cvt_pk_bf16_f32 v31, v12, v13
  v_mov_b32 v29, 0
  v_mov_b32 v30, 0
  v_mov_b32 v68, 0x3f803f80
  v_mov_b32 v69, 0x3f803f80
  v_mov_b32 v70, 0x3f803f80
  v_mov_b32 v71, 0x3f803f80
  s_nop 1
  v_mfma_f32_16x16x32_bf16 v[8:11], v[32:35], v[68:71], 0
  v_mfma_f32_16x16x32_bf16 v[0:3], v[32:35], v[52:55], 0
  v_mfma_f32_16x16x32_bf16 v[4:7], v[32:35], v[56:59], 0
  v_mfma_f32_16x16x16_bf16 v[8:11], v[28:29], v[68:69], v[8:11]
  v_mfma_f32_16x16x16_bf16 v[0:3], v[28:29], v[72:73], v[0:3]
  v_mfma_f32_16x16x16_bf16 v[4:7], v[30:31], v[72:73], v[4:7]
  ds_read_b128 v[68:71], v76 offset:13824
  v_rcp_f32 v10, v8
  v_rcp_f32 v11, v9
  v_mul_f32 v0, v10, v0
  v_mul_f32 v1, v11, v1
  s_nop 0
  v_mul_f32 v4, v10, v4
  v_mul_f32 v5, v11, v5
  v_cvt_pk_bf16_f32 v2, v0, v4
  ds_write_b32 v79, v2 offset:8704
  v_cvt_pk_bf16_f32 v3, v1, v5
  ds_write_b32 v79, v3 offset:9280
  v_mov_b64 v[16:17], 0
  v_mov_b64 v[18:19], 0
  v_mov_b64 v[20:21], 0
  v_mov_b64 v[22:23], 0
  v_mov_b64 v[24:25], 0
  v_mov_b64 v[26:27], 0
  s_branch Cf1_mxok
Cf1_last:
  s_waitcnt lgkmcnt(0)
  ds_read_b64 v[16:17], v77 offset:264
  v_mov_b64 v[18:19], v[72:73]
  s_add_u32 s68, s68, 655360
  s_waitcnt lgkmcnt(0)
  buffer_store_dwordx4 v[16:19], v76, s[8:11], s68 offen sc1
  s_branch L_cexit
L_w2:
  v_mov_b64 v[20:21], 0
  v_mov_b64 v[22:23], 0
  v_mov_b64 v[24:25], 0
  v_mov_b64 v[26:27], 0
  v_mov_b64 v[28:29], 0
  v_mov_b64 v[30:31], 0
  v_mov_b64 v[32:33], 0
  v_mov_b64 v[34:35], 0
  s_mov_b32 s78, 0x3f803f80
  s_mov_b32 s79, s78
  s_mov_b32 s65, 360448
  s_mov_b32 m0, 15872
  v_lshlrev_b32 v73, 2, v76
  v_mov_b32 v72, 0
  ds_read_b128 v[60:63], v76 offset:24576
  ds_read_b128 v[64:67], v76 offset:25600
  ds_read_b128 v[44:47], v76 offset:26624
  ds_read_b128 v[48:51], v76 offset:27648
  ds_read_b128 v[36:39], v76 offset:40960
  ds_read_b128 v[40:43], v76 offset:41984
  ds_read_b128 v[0:3], v76 offset:4608
  ds_read_b128 v[4:7], v76 offset:5632
  s_branch Cf2_top2
.p2align 6
Cf2_h2:
  v_lshlrev_b32 v73, 2, v76
  s_mov_b32 m0, 8704
  s_nop 11
  buffer_load_dwordx4 v[52:55], v76, s[8:11], s65 offen offset:3072 sc1
  s_nop 15
  s_nop 3
  buffer_load_dwordx4 v[52:55], v76, s[8:11], s65 offen offset:3072 sc1
  s_nop 15
  s_nop 3
  buffer_load_dwordx4 v[52:55], v76, s[8:11], s65 offen offset:3072 sc1
  s_waitcnt vmcnt(5)
  ds_read_b128 v[60:63], v76 offset:24576
  ds_read_b128 v[64:67], v76 offset:25600
  ds_read_b128 v[44:47], v76 offset:26624
  ds_read_b128 v[48:51], v76 offset:27648
  ds_read_b128 v[36:39], v76 offset:40960
  ds_read_b128 v[40:43], v76 offset:41984
  s_waitcnt vmcnt(2)
  v_max3_u32 v72, v52, v53, v54
  v_max_u32 v72, v72, v55
  ds_write_b128 v76, v[52:55] offset:7680
  v_cmp_eq_u32 vcc, -1, v72
  s_cbranch_vccnz Cf2_h2r
Cf2_h2w:
  s_waitcnt lgkmcnt(0)
  s_barrier
  ds_read_b128 v[0:3], v76 offset:4608
  ds_read_b128 v[4:7], v76 offset:5632
  buffer_load_dwordx4 v76, s[8:11], s64 offen offset:0 sc1 lds
  buffer_load_dwordx4 v76, s[8:11], s64 offen offset:1024 sc1 lds
Cf2_top2:
  ds_read_b128 v[8:11], v76 offset:6656
  s_mov_b32 m0, 15872
  s_waitcnt lgkmcnt(2)
  v_smfmac_f32_16x16x64_bf16 v[20:23], v[0:3], v[60:67], v74
  ds_read_b128 v[60:63], v76 offset:43008
  v_smfmac_f32_16x16x64_bf16 v[24:27], v[0:3], v[44:51], v74
  buffer_load_dwordx4 v[44:47], v76, s[8:11], s58 offen offset:0 sc1
  ds_read_b128 v[64:67], v76 offset:44032
  s_waitcnt lgkmcnt(3)
  v_smfmac_f32_16x16x64_bf16 v[20:23], v[4:7], v[80:87], v74
  buffer_load_dwordx4 v[48:51], v76, s[8:11], s58 offen offset:1024 sc1
  v_smfmac_f32_16x16x64_bf16 v[28:31], v[0:3], v[36:43], v74
  buffer_load_dwordx4 v[52:55], v76, s[8:11], s59 offen offset:0 sc1
  ds_read_b128 v[36:39], v76 offset:57344
  v_smfmac_f32_16x16x64_bf16 v[24:27], v[4:7], v[88:95], v74
  buffer_load_dwordx4 v[56:59], v76, s[8:11], s59 offen offset:1024 sc1
  ds_read_b128 v[40:43], v76 offset:58368
  v_smfmac_f32_16x16x64_bf16 v[28:31], v[4:7], v[208:215], v74
  ds_read_b128 v[12:15], v76 offset:7680
  s_waitcnt lgkmcnt(5)
  v_smfmac_f32_16x16x64_bf16 v[32:35], v[4:7], v[216:223], v74
  buffer_store_dwordx4 v[16:19], v76, s[8:11], s68 offen sc1
  s_waitcnt lgkmcnt(3)
  v_smfmac_f32_16x16x64_bf16 v[32:35], v[0:3], v[60:67], v74
  buffer_load_dword v73, s[8:11], s70 offen  lds
  v_smfmac_f32_16x16x64_bf16 v[20:23], v[8:11], v[96:103], v74
  ds_read_b128 v[60:63], v76 offset:59392
  v_smfmac_f32_16x16x64_bf16 v[24:27], v[8:11], v[104:111], v74
  ds_read_b128 v[64:67], v76 offset:60416
  s_waitcnt lgkmcnt(3)
  v_smfmac_f32_16x16x64_bf16 v[28:31], v[8:11], v[36:43], v74
  ds_read_b128 v[36:39], v75 offset:8192
  s_waitcnt lgkmcnt(3)
  v_smfmac_f32_16x16x64_bf16 v[20:23], v[12:15], v[112:119], v74
  ds_read_b128 v[40:43], v75 offset:9216
  v_smfmac_f32_16x16x64_bf16 v[24:27], v[12:15], v[120:127], v74
  s_waitcnt vmcnt(6)
  v_smfmac_f32_16x16x64_bf16 v[28:31], v[12:15], v[224:231], v74
  s_barrier
  ds_read_b128 v[0:3], v76 offset:8704
  v_smfmac_f32_16x16x64_bf16 v[32:35], v[12:15], v[232:239], v74
  ds_read_b128 v[4:7], v76 offset:9728
  s_waitcnt lgkmcnt(4)
  v_smfmac_f32_16x16x64_bf16 v[32:35], v[8:11], v[60:67], v74
  ds_read_b128 v[60:63], v75 offset:10240
  s_waitcnt lgkmcnt(2)
  v_smfmac_f32_16x16x64_bf16 v[20:23], v[0:3], v[128:135], v74
  ds_read_b128 v[16:19], v76 offset:10752
  v_smfmac_f32_16x16x64_bf16 v[24:27], v[0:3], v[136:143], v74
  ds_read_b128 v[64:67], v75 offset:11264
  v_smfmac_f32_16x16x64_bf16 v[28:31], v[0:3], v[36:43], v74
  ds_read_b128 v[36:39], v75 offset:24576
  s_waitcnt lgkmcnt(4)
  v_smfmac_f32_16x16x64_bf16 v[20:23], v[4:7], v[144:151], v74
  ds_read_b128 v[12:15], v76 offset:11776
  v_smfmac_f32_16x16x64_bf16 v[24:27], v[4:7], v[152:159], v74
  ds_read_b128 v[40:43], v75 offset:25600
  s_waitcnt lgkmcnt(4)
  v_smfmac_f32_16x16x64_bf16 v[20:23], v[16:19], v[160:167], v74
  ds_read_b128 v[8:11], v76 offset:12800
  s_waitcnt lgkmcnt(4)
  v_smfmac_f32_16x16x64_bf16 v[32:35], v[0:3], v[60:67], v74
  ds_read_b128 v[60:63], v75 offset:26624
  v_mov_b64 v[68:69], s[78:79]
  v_smfmac_f32_16x16x64_bf16 v[24:27], v[16:19], v[168:175], v74
  ds_read_b128 v[64:67], v75 offset:27648
  s_waitcnt lgkmcnt(4)
  v_smfmac_f32_16x16x64_bf16 v[20:23], v[12:15], v[176:183], v74
  s_waitcnt lgkmcnt(3)
  v_mov_b64 v[70:71], s[78:79]
  v_smfmac_f32_16x16x64_bf16 v[28:31], v[4:7], v[36:43], v74
  s_waitcnt lgkmcnt(2)
  v_mov_b64 v[36:37], 0
  v_smfmac_f32_16x16x64_bf16 v[20:23], v[8:11], v[192:199], v74
  v_mov_b64 v[38:39], 0
  v_smfmac_f32_16x16x64_bf16 v[24:27], v[12:15], v[184:191], v74
  v_mov_b64 v[40:41], 0
  v_smfmac_f32_16x16x64_bf16 v[24:27], v[8:11], v[200:207], v74
  s_waitcnt lgkmcnt(0)
  v_add_f32 v20, v20, v22
  v_smfmac_f32_16x16x64_bf16 v[32:35], v[4:7], v[60:67], v74
  v_add_f32 v21, v21, v23
  v_smfmac_f32_16x16x64_bf16 v[28:31], v[16:19], v[240:247], v74
  v_add_f32 v24, v24, v26
  v_cvt_pk_bf16_f32 v22, v20, v24
  v_smfmac_f32_16x16x64_bf16 v[28:31], v[12:15], a[0:7], v74
  ds_write_b32 v79, v22 offset:0
  v_add_f32 v25, v25, v27
  v_cvt_pk_bf16_f32 v23, v21, v25
  v_smfmac_f32_16x16x64_bf16 v[28:31], v[8:11], a[16:23], v74
  ds_write_b32 v79, v23 offset:576
  v_cmp_u_f32 vcc, v20, v21
  v_smfmac_f32_16x16x64_bf16 v[32:35], v[16:19], v[248:255], v74
  v_mov_b64 v[42:43], 0
  v_smfmac_f32_16x16x64_bf16 v[32:35], v[12:15], a[8:15], v74
  v_add_f32 v28, v28, v30
  v_add_f32 v29, v29, v31
  v_smfmac_f32_16x16x64_bf16 v[32:35], v[8:11], a[24:31], v74
  s_cbranch_vccnz Cf2_rec
Cf2_recok:
  v_smfmac_f32_16x16x64_bf16 v[36:39], v[16:19], a[128:135], v74
  s_waitcnt lgkmcnt(0)
  s_barrier
  ds_read_b128 v[60:63], v77
  v_smfmac_f32_16x16x64_bf16 v[40:43], v[16:19], a[136:143], v74
  ds_read_b128 v[64:67], v77 offset:128
  v_add_f32 v32, v32, v34
  v_cvt_pk_bf16_f32 v30, v28, v32
  v_smfmac_f32_16x16x64_bf16 v[36:39], v[0:3], a[96:103], v74
  ds_write_b32 v79, v30 offset:256
  v_add_f32 v33, v33, v35
  v_cvt_pk_bf16_f32 v31, v29, v33
  v_smfmac_f32_16x16x64_bf16 v[40:43], v[0:3], a[104:111], v74
  ds_write_b32 v79, v31 offset:832
  v_xor_b32 v75, 0x8000, v75
  v_smfmac_f32_16x16x64_bf16 v[36:39], v[4:7], a[112:119], v74
  ds_read_b128 v[0:3], v76 offset:4608
  v_mov_b32 v29, 0
  v_smfmac_f32_16x16x64_bf16 v[40:43], v[4:7], a[120:127], v74
  s_waitcnt vmcnt(4) lgkmcnt(3)
  v_mov_b32 v30, 0
  v_mfma_f32_16x16x32_bf16 v[44:47], v[44:47], v[60:63], 0
  ds_read_b128 v[4:7], v76 offset:5632
  s_waitcnt lgkmcnt(2)
  v_mfma_f32_16x16x32_bf16 v[44:47], v[48:51], v[64:67], v[44:47]
  s_barrier
  v_smfmac_f32_16x16x64_bf16 v[36:39], v[8:11], a[160:167], v74
  ds_read_b128 v[20:23], v77 offset:256
  ds_read_b128 v[24:27], v77 offset:384
  v_smfmac_f32_16x16x64_bf16 v[40:43], v[8:11], a[168:175], v74
  ds_read_b128 v[8:11], v76 offset:6656
  v_add_f32_dpp v72, v46, v44 quad_perm:[2,3,0,1] row_mask:0xf bank_mask:0xf
  v_add_f32_dpp v73, v47, v45 quad_perm:[2,3,0,1] row_mask:0xf bank_mask:0xf
  v_smfmac_f32_16x16x64_bf16 v[36:39], v[12:15], a[144:151], v74
  s_waitcnt lgkmcnt(4)
  v_exp_f32_dpp v72, v72 quad_perm:[0,1,0,1] row_mask:0xf bank_mask:0xf
  v_smfmac_f32_16x16x64_bf16 v[40:43], v[12:15], a[152:159], v74
  ds_read_b128 v[12:15], v76 offset:7680
  v_exp_f32_dpp v73, v73 quad_perm:[0,1,0,1] row_mask:0xf bank_mask:0xf
  v_smfmac_f32_16x16x64_bf16 v[36:39], v[0:3], a[32:39], v74
  s_waitcnt lgkmcnt(2)
  v_cvt_pk_bf16_f32 v72, v72, v73
  v_mfma_f32_16x16x32_bf16 v[20:23], v[20:23], v[60:63], 0
  ds_write_b32 v78, v72 offset:520
  v_mov_b64 v[16:17], 0
  v_mfma_f32_16x16x32_bf16 v[20:23], v[24:27], v[64:67], v[20:23]
  ds_read_b128 v[44:47], v75 offset:24576
  v_mov_b64 v[18:19], 0
  v_smfmac_f32_16x16x64_bf16 v[40:43], v[0:3], a[40:47], v74
  ds_read_b128 v[48:51], v75 offset:25600
  s_waitcnt lgkmcnt(4)
  v_smfmac_f32_16x16x64_bf16 v[36:39], v[4:7], a[48:55], v74
  v_add_f32_dpp v24, v22, v20 quad_perm:[2,3,0,1] row_mask:0xf bank_mask:0xf
  v_add_f32_dpp v25, v23, v21 quad_perm:[2,3,0,1] row_mask:0xf bank_mask:0xf
  v_smfmac_f32_16x16x64_bf16 v[36:39], v[8:11], a[64:71], v74
  s_waitcnt lgkmcnt(2)
  s_barrier
  ds_read_b128 v[32:35], v78 offset:512
  v_smfmac_f32_16x16x64_bf16 v[36:39], v[12:15], a[80:87], v74
  ds_read_b128 v[60:63], v75 offset:26624
  v_mul_f32 v24, s69, v24
  v_smfmac_f32_16x16x64_bf16 v[40:43], v[4:7], a[56:63], v74
  ds_read_b128 v[64:67], v75 offset:27648
  v_mul_f32 v25, s69, v25
  v_smfmac_f32_16x16x64_bf16 v[40:43], v[8:11], a[72:79], v74
  v_exp_f32_dpp v24, v24 quad_perm:[0,1,0,1] row_mask:0xf bank_mask:0xf
  v_smfmac_f32_16x16x64_bf16 v[40:43], v[12:15], a[88:95], v74
  s_waitcnt vmcnt(2) lgkmcnt(2)
  v_exp_f32_dpp v25, v25 quad_perm:[0,1,0,1] row_mask:0xf bank_mask:0xf
  v_mfma_f32_16x16x32_bf16 v[8:11], v[32:35], v[68:71], 0
  v_add_f32 v36, v36, v38
  v_add_f32 v37, v37, v39
  v_mfma_f32_16x16x32_bf16 v[0:3], v[32:35], v[52:55], 0
  v_add_f32 v40, v40, v42
  v_add_f32 v41, v41, v43
  v_mfma_f32_16x16x32_bf16 v[4:7], v[32:35], v[56:59], 0
  v_cvt_pk_bf16_f32 v28, v24, v25
  v_cvt_pk_bf16_f32 v72, v36, v37
  v_cvt_pk_bf16_f32 v73, v40, v41
  v_mfma_f32_16x16x16_bf16 v[8:11], v[28:29], v[68:69], v[8:11]
  v_cvt_pk_bf16_f32 v31, v24, v25
  v_mov_b64 v[20:21], 0
  v_mfma_f32_16x16x16_bf16 v[0:3], v[28:29], v[72:73], v[0:3]
  ds_read_b128 v[68:71], v76 offset:13824
  v_mov_b64 v[22:23], 0
  v_mfma_f32_16x16x16_bf16 v[4:7], v[30:31], v[72:73], v[4:7]
  v_rcp_f32 v10, v8
  v_rcp_f32 v11, v9
  v_mul_f32 v0, v10, v0
  v_mul_f32 v1, v11, v1
  s_nop 0
  v_mul_f32 v4, v10, v4
  v_mul_f32 v5, v11, v5
  v_cvt_pk_bf16_f32 v2, v0, v4
  ds_write_b32 v79, v2 offset:8704
  v_cvt_pk_bf16_f32 v3, v1, v5
  ds_write_b32 v79, v3 offset:9280
  v_max3_f32 v8, v8, v9, v10
  v_max_f32 v8, v8, v11
  v_cmp_le_f32 vcc, 1317011456, v8
  v_mov_b64 v[24:25], 0
  v_mov_b64 v[26:27], 0
  s_cbranch_vccnz Cf2_mx
Cf2_mxok:
  s_waitcnt lgkmcnt(0)
  s_barrier
  ds_read_b128 v[0:3], v78 offset:8704
  ds_read_b128 v[4:7], v78 offset:8768
  ds_read_b128 v[8:11], v78 offset:8832
  ds_read_b128 v[12:15], v78 offset:8896
  s_cmp_eq_u32 s66, 63
  s_cbranch_scc1 Cf2_last
  s_waitcnt lgkmcnt(3)
  v_smfmac_f32_16x16x64_bf16 v[16:19], v[0:3], v[44:51], v74
  ds_read_b128 v[52:55], v75 offset:40960
  s_waitcnt lgkmcnt(3)
  v_smfmac_f32_16x16x64_bf16 v[16:19], v[4:7], v[60:67], v74
  ds_read_b128 v[56:59], v75 offset:41984
  s_waitcnt lgkmcnt(3)
  v_smfmac_f32_16x16x64_bf16 v[16:19], v[8:11], a[176:183], v74
  ds_read_b128 v[36:39], v75 offset:43008
  s_waitcnt lgkmcnt(3)
  v_smfmac_f32_16x16x64_bf16 v[16:19], v[12:15], a[184:191], v74
  ds_read_b128 v[40:43], v75 offset:44032
  ds_read_b128 v[44:47], v75 offset:57344
  v_smfmac_f32_16x16x64_bf16 v[20:23], v[0:3], a[192:199], v74
  ds_read_b128 v[48:51], v75 offset:58368
  ds_read_b128 v[60:63], v75 offset:59392
  v_smfmac_f32_16x16x64_bf16 v[20:23], v[4:7], a[200:207], v74
  ds_read_b128 v[64:67], v75 offset:60416
  s_waitcnt lgkmcnt(6)
  v_cvt_pk_bf16_f32 v16, v16, v17
  v_cvt_pk_bf16_f32 v17, v18, v19
  v_bfi_b32 v16, 1, s72, v16
  v_smfmac_f32_16x16x64_bf16 v[20:23], v[8:11], v[52:59], v74
  buffer_store_dwordx2 v[16:17], v68, s[8:11], s73 offen
  s_waitcnt lgkmcnt(4)
  v_smfmac_f32_16x16x64_bf16 v[20:23], v[12:15], v[36:43], v74
  ds_read_b128 v[52:55], v75 offset:0
  v_mov_b64 v[32:33], 0
  v_smfmac_f32_16x16x64_bf16 v[24:27], v[0:3], a[208:215], v74
  ds_read_b128 v[56:59], v75 offset:1024
  v_mov_b64 v[34:35], 0
  v_smfmac_f32_16x16x64_bf16 v[24:27], v[4:7], a[216:223], v74
  ds_read_b128 v[36:39], v75 offset:2048
  s_waitcnt lgkmcnt(5)
  v_cvt_pk_bf16_f32 v20, v20, v21
  v_cvt_pk_bf16_f32 v21, v22, v23
  v_bfi_b32 v20, 1, s72, v20
  v_smfmac_f32_16x16x64_bf16 v[24:27], v[8:11], v[44:51], v74
  buffer_store_dwordx2 v[20:21], v68, s[8:11], s74 offen
  s_waitcnt lgkmcnt(3)
  v_smfmac_f32_16x16x64_bf16 v[24:27], v[12:15], v[60:67], v74
  ds_read_b128 v[40:43], v75 offset:3072
  v_mov_b64 v[28:29], 0
  v_smfmac_f32_16x16x64_bf16 v[32:35], v[0:3], a[224:231], v74
  ds_read_b128 v[44:47], v75 offset:4096
  ds_read_b128 v[48:51], v75 offset:5120
  v_smfmac_f32_16x16x64_bf16 v[32:35], v[4:7], a[232:239], v74
  ds_read_b128 v[60:63], v75 offset:6144
  v_cvt_pk_bf16_f32 v24, v24, v25
  v_cvt_pk_bf16_f32 v25, v26, v27
  v_bfi_b32 v24, 1, s72, v24
  v_smfmac_f32_16x16x64_bf16 v[32:35], v[8:11], a[240:247], v74
  buffer_store_dwordx2 v[24:25], v68, s[8:11], s75 offen
  v_mov_b64 v[30:31], 0
  v_smfmac_f32_16x16x64_bf16 v[32:35], v[12:15], a[248:255], v74
  ds_read_b128 v[64:67], v75 offset:7168
  s_waitcnt lgkmcnt(6)
  v_smfmac_f32_16x16x64_bf16 v[28:31], v[0:3], v[52:59], v74
  s_waitcnt lgkmcnt(4)
  v_smfmac_f32_16x16x64_bf16 v[28:31], v[4:7], v[36:43], v74
  s_waitcnt lgkmcnt(2)
  v_cvt_pk_bf16_f32 v32, v32, v33
  v_cvt_pk_bf16_f32 v33, v34, v35
  v_bfi_b32 v32, 1, s72, v32
  v_smfmac_f32_16x16x64_bf16 v[28:31], v[8:11], v[44:51], v74
  buffer_store_dwordx2 v[32:33], v68, s[8:11], s76 offen
  s_waitcnt lgkmcnt(0)
  v_smfmac_f32_16x16x64_bf16 v[28:31], v[12:15], v[60:67], v74
  ds_read_b128 v[0:3], v76 offset:14848
  ds_read_b64 v[16:17], v77 offset:384
  v_mov_b64 v[18:19], v[72:73]
  v_xor_b32 v75, 0x8000, v75
  s_nop 3
  v_cvt_pk_bf16_f32 v28, v28, v29
  v_cvt_pk_bf16_f32 v29, v30, v31
  v_bfi_b32 v28, 1, s72, v28
  buffer_store_dwordx2 v[28:29], v68, s[8:11], s77 offen
  v_mov_b64 v[20:21], 0
  v_mov_b64 v[22:23], 0
  v_mov_b64 v[24:25], 0
  v_mov_b64 v[26:27], 0
  v_mov_b64 v[28:29], 0
  v_mov_b64 v[30:31], 0
  v_mov_b64 v[32:33], 0
  v_mov_b64 v[34:35], 0
  s_add_u32 s58, s58, 655360
  s_add_u32 s59, s59, 655360
  s_add_u32 s70, s70, 655360
  s_add_u32 s68, s68, 655360
  s_add_u32 s66, s66, 1
  s_xor_b32 s64, s64, 16384
  s_xor_b32 s65, s65, 16384
  s_nop 15
  s_nop 15
  s_nop 7
  buffer_load_dwordx4 v[52:55], v76, s[8:11], s60 offen offset:0 sc1
  buffer_load_dwordx4 v[56:59], v76, s[8:11], s60 offen offset:1024 sc1
  s_nop 15
  s_nop 11
  buffer_load_dwordx4 v[36:39], v76, s[8:11], s60 offen offset:0 sc1
  buffer_load_dwordx4 v[40:43], v76, s[8:11], s60 offen offset:1024 sc1
  s_waitcnt lgkmcnt(0)
  s_waitcnt vmcnt(3)
  v_mfma_f32_16x16x32_bf16 v[4:7], v[0:3], v[52:55], 0
  v_bitop3_b32 v72, v52, v54, s72 bitop3:0x7e
  s_waitcnt vmcnt(2)
  v_mfma_f32_16x16x32_bf16 v[4:7], v[0:3], v[56:59], v[4:7]
  v_bitop3_b32 v73, v56, v58, s72 bitop3:0x7e
  v_bitop3_b32 v72, v72, v73, 1 bitop3:0xa8
  v_cmp_ne_u32 vcc, 0, v72
  s_cbranch_vccnz Cf2_h1r
  s_nop 2
  v_add_f32_dpp v4, v4, v4 row_ror:4 row_mask:0xf bank_mask:0xf
  v_add_f32_dpp v5, v5, v5 row_ror:4 row_mask:0xf bank_mask:0xf
  s_nop 0
  v_add_f32_dpp v4, v4, v4 row_ror:8 row_mask:0xf bank_mask:0xf
  v_add_f32_dpp v5, v5, v5 row_ror:8 row_mask:0xf bank_mask:0xf
  v_cvt_pk_bf16_f32 v4, v4, v5
  buffer_store_dword v4, v69, s[8:11], s62 offen
  s_xor_b32 s62, s62, 16384
  buffer_store_dword v71, v69, s[8:11], s62 offen
  s_xor_b32 s72, s72, 1
  s_branch Cf2_h2
Cf2_h1r:
  s_mov_b64 exec, vcc
  buffer_load_dwordx4 v[52:55], v76, s[8:11], s60 offen offset:0 sc1
  buffer_load_dwordx4 v[56:59], v76, s[8:11], s60 offen offset:1024 sc1
  s_mov_b64 exec, -1
  s_add_u32 s67, s67, 1
  s_waitcnt vmcnt(3)
  v_mfma_f32_16x16x32_bf16 v[4:7], v[0:3], v[36:39], 0
  v_bitop3_b32 v72, v36, v38, s72 bitop3:0x7e
  s_waitcnt vmcnt(2)
  v_mfma_f32_16x16x32_bf16 v[4:7], v[0:3], v[40:43], v[4:7]
  v_bitop3_b32 v73, v40, v42, s72 bitop3:0x7e
  v_bitop3_b32 v72, v72, v73, 1 bitop3:0xa8
  v_cmp_ne_u32 vcc, 0, v72
  s_cbranch_vccz Cf2_h1p
  s_mov_b64 exec, vcc
  buffer_load_dwordx4 v[36:39], v76, s[8:11], s60 offen offset:0 sc1
  buffer_load_dwordx4 v[40:43], v76, s[8:11], s60 offen offset:1024 sc1
  s_mov_b64 exec, -1
  s_add_u32 s67, s67, 1
  s_waitcnt vmcnt(3)
  v_mfma_f32_16x16x32_bf16 v[4:7], v[0:3], v[52:55], 0
  v_bitop3_b32 v72, v52, v54, s72 bitop3:0x7e
  s_waitcnt vmcnt(2)
  v_mfma_f32_16x16x32_bf16 v[4:7], v[0:3], v[56:59], v[4:7]
  v_bitop3_b32 v73, v56, v58, s72 bitop3:0x7e
  v_bitop3_b32 v72, v72, v73, 1 bitop3:0xa8
  v_cmp_ne_u32 vcc, 0, v72
  s_cbranch_vccz Cf2_h1p
Cf2_h1s:
  s_mov_b64 exec, vcc
  buffer_load_dwordx4 v[52:55], v76, s[8:11], s60 offen offset:0 sc1
  buffer_load_dwordx4 v[56:59], v76, s[8:11], s60 offen offset:1024 sc1
  s_mov_b64 exec, -1
  s_add_u32 s67, s67, 1
  s_waitcnt vmcnt(3)
  v_mfma_f32_16x16x32_bf16 v[4:7], v[0:3], v[36:39], 0
  v_bitop3_b32 v72, v36, v38, s72 bitop3:0x7e
  s_waitcnt vmcnt(2)
  v_mfma_f32_16x16x32_bf16 v[4:7], v[0:3], v[40:43], v[4:7]
  v_bitop3_b32 v73, v40, v42, s72 bitop3:0x7e
  v_bitop3_b32 v72, v72, v73, 1 bitop3:0xa8
  v_cmp_ne_u32 vcc, 0, v72
  s_cbranch_vccz Cf2_h1p
  s_mov_b64 exec, vcc
  buffer_load_dwordx4 v[36:39], v76, s[8:11], s60 offen offset:0 sc1
  buffer_load_dwordx4 v[40:43], v76, s[8:11], s60 offen offset:1024 sc1
  s_mov_b64 exec, -1
  s_add_u32 s67, s67, 1
  s_waitcnt vmcnt(3)
  v_mfma_f32_16x16x32_bf16 v[4:7], v[0:3], v[52:55], 0
  v_bitop3_b32 v72, v52, v54, s72 bitop3:0x7e
  s_waitcnt vmcnt(2)
  v_mfma_f32_16x16x32_bf16 v[4:7], v[0:3], v[56:59], v[4:7]
  v_bitop3_b32 v73, v56, v58, s72 bitop3:0x7e
  v_bitop3_b32 v72, v72, v73, 1 bitop3:0xa8
  v_cmp_ne_u32 vcc, 0, v72
  s_cbranch_vccz Cf2_h1p
  s_cmp_lt_u32 s67, 131072
  s_cbranch_scc1 Cf2_h1s
Cf2_h1p:
  s_nop 2
  v_add_f32_dpp v4, v4, v4 row_ror:4 row_mask:0xf bank_mask:0xf
  v_add_f32_dpp v5, v5, v5 row_ror:4 row_mask:0xf bank_mask:0xf
  s_nop 0
  v_add_f32_dpp v4, v4, v4 row_ror:8 row_mask:0xf bank_mask:0xf
  v_add_f32_dpp v5, v5, v5 row_ror:8 row_mask:0xf bank_mask:0xf
  v_cvt_pk_bf16_f32 v4, v4, v5
  buffer_store_dword v4, v69, s[8:11], s62 offen
  s_xor_b32 s62, s62, 16384
  buffer_store_dword v71, v69, s[8:11], s62 offen
  s_xor_b32 s72, s72, 1
  s_branch Cf2_h2
Cf2_h2r:
  s_mov_b64 exec, vcc
  buffer_load_dwordx4 v[52:55], v76, s[8:11], s65 offen offset:3072 sc1
  s_mov_b64 exec, -1
  s_add_u32 s67, s67, 1
  s_waitcnt vmcnt(2)
  v_max3_u32 v72, v52, v53, v54
  v_max_u32 v72, v72, v55
  ds_write_b128 v76, v[52:55] offset:7680
  v_cmp_eq_u32 vcc, -1, v72
  s_cbranch_vccz Cf2_h2w
  s_mov_b64 exec, vcc
  buffer_load_dwordx4 v[52:55], v76, s[8:11], s65 offen offset:3072 sc1
  s_mov_b64 exec, -1
  s_add_u32 s67, s67, 1
  s_waitcnt vmcnt(2)
  v_max3_u32 v72, v52, v53, v54
  v_max_u32 v72, v72, v55
  ds_write_b128 v76, v[52:55] offset:7680
  v_cmp_eq_u32 vcc, -1, v72
  s_cbranch_vccz Cf2_h2w
  s_mov_b64 exec, vcc
  buffer_load_dwordx4 v[52:55], v76, s[8:11], s65 offen offset:3072 sc1
  s_mov_b64 exec, -1
  s_add_u32 s67, s67, 1
  s_waitcnt vmcnt(2)
  v_max3_u32 v72, v52, v53, v54
  v_max_u32 v72, v72, v55
  ds_write_b128 v76, v[52:55] offset:7680
  v_cmp_eq_u32 vcc, -1, v72
  s_cbranch_vccz Cf2_h2w
  s_mov_b64 exec, vcc
  buffer_load_dwordx4 v[52:55], v76, s[8:11], s65 offen offset:3072 sc1
  s_mov_b64 exec, -1
  s_add_u32 s67, s67, 1
  s_waitcnt vmcnt(2)
  v_max3_u32 v72, v52, v53, v54
  v_max_u32 v72, v72, v55
  ds_write_b128 v76, v[52:55] offset:7680
  v_cmp_eq_u32 vcc, -1, v72
  s_cbranch_vccz Cf2_h2w
  s_cmp_lt_u32 s67, 131072
  s_cbranch_scc1 Cf2_h2r
Cf2_h2ok:
  ds_write_b128 v76, v[52:55] offset:7680
  s_branch Cf2_h2w
Cf2_rec:
  s_nop 7
  s_waitcnt vmcnt(0) lgkmcnt(0)
  v_max3_u32 v72, v0, v1, v2
  v_max3_u32 v72, v72, v3, v4
  v_max3_u32 v72, v72, v5, v6
  v_max3_u32 v72, v72, v7, v8
  v_max3_u32 v72, v72, v9, v10
  v_max3_u32 v72, v72, v11, v12
  v_max3_u32 v72, v72, v13, v14
  v_max3_u32 v72, v72, v15, v16
  v_max3_u32 v72, v72, v17, v18
  v_max_u32 v72, v72, v19
  v_cmp_eq_u32 vcc, -1, v72
  s_cbranch_vccz Cf2_recok
  s_barrier
Cf2_recp:
  buffer_load_dwordx4 v[0:3], v76, s[8:11], s64 offen offset:0 sc1
  buffer_load_dwordx4 v[4:7], v76, s[8:11], s64 offen offset:1024 sc1
  s_add_u32 s67, s67, 1
  s_cmp_lt_u32 s67, 131072
  s_cselect_b32 s54, -2, -1
  s_waitcnt vmcnt(1)
  v_max3_u32 v72, v0, v1, v2
  s_waitcnt vmcnt(0)
  v_max3_u32 v72, v72, v3, v4
  v_max3_u32 v72, v72, v5, v6
  v_max_u32 v72, v72, v7
  v_cmp_lt_u32 vcc, s54, v72
  s_cbranch_vccnz Cf2_recp
  ds_write_b128 v76, v[0:3] offset:8704
  ds_write_b128 v76, v[4:7] offset:9728
  v_mov_b64 v[20:21], 0
  v_mov_b64 v[22:23], 0
  v_mov_b64 v[24:25], 0
  v_mov_b64 v[26:27], 0
  v_mov_b64 v[28:29], 0
  v_mov_b64 v[30:31], 0
  v_mov_b64 v[32:33], 0
  v_mov_b64 v[34:35], 0
  s_waitcnt lgkmcnt(0)
  s_barrier
  ds_read_b128 v[0:3], v76 offset:4608
  ds_read_b128 v[60:63], v76 offset:24576
  ds_read_b128 v[64:67], v76 offset:25600
  s_waitcnt lgkmcnt(0)
  v_smfmac_f32_16x16x64_bf16 v[20:23], v[0:3], v[60:67], v74
  ds_read_b128 v[60:63], v76 offset:26624
  ds_read_b128 v[64:67], v76 offset:27648
  s_waitcnt lgkmcnt(0)
  v_smfmac_f32_16x16x64_bf16 v[24:27], v[0:3], v[60:67], v74
  ds_read_b128 v[60:63], v76 offset:40960
  ds_read_b128 v[64:67], v76 offset:41984
  s_waitcnt lgkmcnt(0)
  v_smfmac_f32_16x16x64_bf16 v[28:31], v[0:3], v[60:67], v74
  ds_read_b128 v[60:63], v76 offset:43008
  ds_read_b128 v[64:67], v76 offset:44032
  s_waitcnt lgkmcnt(0)
  v_smfmac_f32_16x16x64_bf16 v[32:35], v[0:3], v[60:67], v74
  ds_read_b128 v[4:7], v76 offset:5632
  s_waitcnt lgkmcnt(0)
  v_smfmac_f32_16x16x64_bf16 v[20:23], v[4:7], v[80:87], v74
  v_smfmac_f32_16x16x64_bf16 v[24:27], v[4:7], v[88:95], v74
  v_smfmac_f32_16x16x64_bf16 v[28:31], v[4:7], v[208:215], v74
  v_smfmac_f32_16x16x64_bf16 v[32:35], v[4:7], v[216:223], v74
  ds_read_b128 v[8:11], v76 offset:6656
  s_waitcnt lgkmcnt(0)
  v_smfmac_f32_16x16x64_bf16 v[20:23], v[8:11], v[96:103], v74
  v_smfmac_f32_16x16x64_bf16 v[24:27], v[8:11], v[104:111], v74
  ds_read_b128 v[60:63], v76 offset:57344
  ds_read_b128 v[64:67], v76 offset:58368
  s_waitcnt lgkmcnt(0)
  v_smfmac_f32_16x16x64_bf16 v[28:31], v[8:11], v[60:67], v74
  ds_read_b128 v[60:63], v76 offset:59392
  ds_read_b128 v[64:67], v76 offset:60416
  s_waitcnt lgkmcnt(0)
  v_smfmac_f32_16x16x64_bf16 v[32:35], v[8:11], v[60:67], v74
  ds_read_b128 v[12:15], v76 offset:7680
  s_waitcnt lgkmcnt(0)
  v_smfmac_f32_16x16x64_bf16 v[20:23], v[12:15], v[112:119], v74
  v_smfmac_f32_16x16x64_bf16 v[24:27], v[12:15], v[120:127], v74
  v_smfmac_f32_16x16x64_bf16 v[28:31], v[12:15], v[224:231], v74
  v_smfmac_f32_16x16x64_bf16 v[32:35], v[12:15], v[232:239], v74
  ds_read_b128 v[0:3], v76 offset:8704
  s_waitcnt lgkmcnt(0)
  v_smfmac_f32_16x16x64_bf16 v[20:23], v[0:3], v[128:135], v74
  v_smfmac_f32_16x16x64_bf16 v[24:27], v[0:3], v[136:143], v74
  ds_read_b128 v[60:63], v75 offset:8192
  ds_read_b128 v[64:67], v75 offset:9216
  s_waitcnt lgkmcnt(0)
  v_smfmac_f32_16x16x64_bf16 v[28:31], v[0:3], v[60:67], v74
  ds_read_b128 v[60:63], v75 offset:10240
  ds_read_b128 v[64:67], v75 offset:11264
  s_waitcnt lgkmcnt(0)
  v_smfmac_f32_16x16x64_bf16 v[32:35], v[0:3], v[60:67], v74
  ds_read_b128 v[4:7], v76 offset:9728
  s_waitcnt lgkmcnt(0)
  v_smfmac_f32_16x16x64_bf16 v[20:23], v[4:7], v[144:151], v74
  v_smfmac_f32_16x16x64_bf16 v[24:27], v[4:7], v[152:159], v74
  ds_read_b128 v[60:63], v75 offset:24576
  ds_read_b128 v[64:67], v75 offset:25600
  s_waitcnt lgkmcnt(0)
  v_smfmac_f32_16x16x64_bf16 v[28:31], v[4:7], v[60:67], v74
  ds_read_b128 v[60:63], v75 offset:26624
  ds_read_b128 v[64:67], v75 offset:27648
  s_waitcnt lgkmcnt(0)
  v_smfmac_f32_16x16x64_bf16 v[32:35], v[4:7], v[60:67], v74
  ds_read_b128 v[16:19], v76 offset:10752
  s_waitcnt lgkmcnt(0)
  v_smfmac_f32_16x16x64_bf16 v[20:23], v[16:19], v[160:167], v74
  v_smfmac_f32_16x16x64_bf16 v[24:27], v[16:19], v[168:175], v74
  v_smfmac_f32_16x16x64_bf16 v[28:31], v[16:19], v[240:247], v74
  v_smfmac_f32_16x16x64_bf16 v[32:35], v[16:19], v[248:255], v74
  ds_read_b128 v[12:15], v76 offset:11776
  s_waitcnt lgkmcnt(0)
  v_smfmac_f32_16x16x64_bf16 v[20:23], v[12:15], v[176:183], v74
  v_smfmac_f32_16x16x64_bf16 v[24:27], v[12:15], v[184:191], v74
  v_smfmac_f32_16x16x64_bf16 v[28:31], v[12:15], a[0:7], v74
  v_smfmac_f32_16x16x64_bf16 v[32:35], v[12:15], a[8:15], v74
  ds_read_b128 v[8:11], v76 offset:12800
  s_waitcnt lgkmcnt(0)
  v_smfmac_f32_16x16x64_bf16 v[20:23], v[8:11], v[192:199], v74
  v_smfmac_f32_16x16x64_bf16 v[24:27], v[8:11], v[200:207], v74
  v_smfmac_f32_16x16x64_bf16 v[28:31], v[8:11], a[16:23], v74
  v_smfmac_f32_16x16x64_bf16 v[32:35], v[8:11], a[24:31], v74
  v_add_f32 v20, v20, v22
  v_add_f32 v21, v21, v23
  v_add_f32 v24, v24, v26
  v_cvt_pk_bf16_f32 v22, v20, v24
  s_nop 0
  ds_write_b32 v79, v22 offset:0
  v_add_f32 v25, v25, v27
  v_cvt_pk_bf16_f32 v23, v21, v25
  ds_write_b32 v79, v23 offset:576
  v_add_f32 v28, v28, v30
  v_add_f32 v29, v29, v31
  s_waitcnt lgkmcnt(0)
  s_nop 1
  s_branch Cf2_recok
Cf2_mx:
  s_waitcnt lgkmcnt(0)
  s_barrier
  buffer_load_dwordx4 v[0:3], v76, s[8:11], s58 offen offset:0 sc1
  ds_read_b128 v[20:23], v77 offset:0
  ds_read_b128 v[28:31], v77 offset:256
  buffer_load_dwordx4 v[4:7], v76, s[8:11], s58 offen offset:1024 sc1
  ds_read_b128 v[24:27], v77 offset:128
  ds_read_b128 v[32:35], v77 offset:384
  s_waitcnt vmcnt(1) lgkmcnt(3)
  v_mfma_f32_16x16x32_bf16 v[8:11], v[0:3], v[20:23], 0
  s_waitcnt vmcnt(0) lgkmcnt(1)
  v_mfma_f32_16x16x32_bf16 v[8:11], v[4:7], v[24:27], v[8:11]
  v_mfma_f32_16x16x32_bf16 v[12:15], v[28:31], v[20:23], 0
  s_waitcnt lgkmcnt(0)
  v_mfma_f32_16x16x32_bf16 v[12:15], v[32:35], v[24:27], v[12:15]
  v_add_f32_dpp v8, v10, v8 quad_perm:[2,3,0,1] row_mask:0xf bank_mask:0xf
  v_add_f32_dpp v9, v11, v9 quad_perm:[2,3,0,1] row_mask:0xf bank_mask:0xf
  s_nop 0
  v_mov_b32_dpp v8, v8 quad_perm:[0,1,0,1] row_mask:0xf bank_mask:0xf
  v_mov_b32_dpp v9, v9 quad_perm:[0,1,0,1] row_mask:0xf bank_mask:0xf
  s_nop 1
  v_add_f32_dpp v12, v14, v12 quad_perm:[2,3,0,1] row_mask:0xf bank_mask:0xf
  v_add_f32_dpp v13, v15, v13 quad_perm:[2,3,0,1] row_mask:0xf bank_mask:0xf
  s_nop 0
  v_mov_b32_dpp v12, v12 quad_perm:[0,1,0,1] row_mask:0xf bank_mask:0xf
  v_mov_b32_dpp v13, v13 quad_perm:[0,1,0,1] row_mask:0xf bank_mask:0xf
  v_mul_f32 v12, s69, v12
  ds_write_b32 v78, v8 offset:8712
  v_mul_f32 v13, s69, v13
  ds_write_b32 v78, v9 offset:8776
  s_waitcnt lgkmcnt(0)
  s_barrier
  ds_read_b128 v[36:39], v78 offset:8704
  ds_read_b128 v[40:43], v78 offset:8768
  s_waitcnt lgkmcnt(0)
  s_barrier
  v_max_f32 v16, v36, v37
  v_max3_f32 v16, v16, v38, v39
  v_max3_f32 v16, v16, v40, v41
  v_max3_f32 v16, v16, v42, v43
  v_max3_f32 v16, v16, v12, v13
  v_mov_b32 v17, v16
  s_nop 1
  v_permlane16_swap_b32 v16, v17
  v_max_f32 v16, v16, v17
  v_mov_b32 v17, v16
  s_nop 1
  v_permlane32_swap_b32 v16, v17
  v_max_f32 v16, v16, v17
  v_sub_f32 v36, v36, v16
  v_sub_f32 v37, v37, v16
  v_sub_f32 v38, v38, v16
  v_sub_f32 v39, v39, v16
  v_sub_f32 v40, v40, v16
  v_sub_f32 v41, v41, v16
  v_sub_f32 v42, v42, v16
  v_sub_f32 v43, v43, v16
  v_sub_f32 v12, v12, v16
  v_sub_f32 v13, v13, v16
  v_exp_f32 v36, v36
  v_exp_f32 v37, v37
  v_exp_f32 v38, v38
  v_exp_f32 v39, v39
  v_exp_f32 v40, v40
  v_exp_f32 v41, v41
  v_exp_f32 v42, v42
  v_exp_f32 v43, v43
  v_exp_f32 v12, v12
  v_exp_f32 v13, v13
  v_cvt_pk_bf16_f32 v32, v36, v40
  v_cvt_pk_bf16_f32 v33, v37, v41
  v_cvt_pk_bf16_f32 v34, v38, v42
  v_cvt_pk_bf16_f32 v35, v39, v43
  v_cvt_pk_bf16_f32 v28, v12, v13
  v_cvt_pk_bf16_f32 v31, v12, v13
  v_mov_b32 v29, 0
  v_mov_b32 v30, 0
  v_mov_b32 v68, 0x3f803f80
  v_mov_b32 v69, 0x3f803f80
  v_mov_b32 v70, 0x3f803f80
  v_mov_b32 v71, 0x3f803f80
  s_nop 1
  v_mfma_f32_16x16x32_bf16 v[8:11], v[32:35], v[68:71], 0
  v_mfma_f32_16x16x32_bf16 v[0:3], v[32:35], v[52:55], 0
  v_mfma_f32_16x16x32_bf16 v[4:7], v[32:35], v[56:59], 0
  v_mfma_f32_16x16x16_bf16 v[8:11], v[28:29], v[68:69], v[8:11]
  v_mfma_f32_16x16x16_bf16 v[0:3], v[28:29], v[72:73], v[0:3]
  v_mfma_f32_16x16x16_bf16 v[4:7], v[30:31], v[72:73], v[4:7]
  ds_read_b128 v[68:71], v76 offset:13824
  v_rcp_f32 v10, v8
  v_rcp_f32 v11, v9
  v_mul_f32 v0, v10, v0
  v_mul_f32 v1, v11, v1
  s_nop 0
  v_mul_f32 v4, v10, v4
  v_mul_f32 v5, v11, v5
  v_cvt_pk_bf16_f32 v2, v0, v4
  ds_write_b32 v79, v2 offset:8704
  v_cvt_pk_bf16_f32 v3, v1, v5
  ds_write_b32 v79, v3 offset:9280
  v_mov_b64 v[16:17], 0
  v_mov_b64 v[18:19], 0
  v_mov_b64 v[20:21], 0
  v_mov_b64 v[22:23], 0
  v_mov_b64 v[24:25], 0
  v_mov_b64 v[26:27], 0
  s_branch Cf2_mxok
Cf2_last:
  s_waitcnt lgkmcnt(0)
  ds_read_b64 v[16:17], v77 offset:384
  v_mov_b64 v[18:19], v[72:73]
  s_add_u32 s68, s68, 655360
  s_waitcnt lgkmcnt(0)
  buffer_store_dwordx4 v[16:19], v76, s[8:11], s68 offen sc1
  s_branch L_cexit
L_w3:
  v_mov_b64 v[20:21], 0
  v_mov_b64 v[22:23], 0
  v_mov_b64 v[24:25], 0
  v_mov_b64 v[26:27], 0
  v_mov_b64 v[28:29], 0
  v_mov_b64 v[30:31], 0
  v_mov_b64 v[32:33], 0
  v_mov_b64 v[34:35], 0
  s_mov_b32 s78, 0x3f803f80
  s_mov_b32 s79, s78
  s_mov_b32 s65, 360448
  s_mov_b32 m0, 15872
  v_lshlrev_b32 v73, 2, v76
  v_mov_b32 v72, 0
  ds_read_b128 v[60:63], v76 offset:28672
  ds_read_b128 v[64:67], v76 offset:29696
  ds_read_b128 v[44:47], v76 offset:30720
  ds_read_b128 v[48:51], v76 offset:31744
  ds_read_b128 v[36:39], v76 offset:45056
  ds_read_b128 v[40:43], v76 offset:46080
  ds_read_b128 v[0:3], v76 offset:4608
  ds_read_b128 v[4:7], v76 offset:5632
  s_branch Cf3_top2
.p2align 6
Cf3_h2:
  v_lshlrev_b32 v73, 2, v76
  s_mov_b32 m0, 10752
  s_waitcnt vmcnt(4)
  ds_read_b128 v[60:63], v76 offset:28672
  ds_read_b128 v[64:67], v76 offset:29696
  ds_read_b128 v[44:47], v76 offset:30720
  ds_read_b128 v[48:51], v76 offset:31744
  ds_read_b128 v[36:39], v76 offset:45056
  ds_read_b128 v[40:43], v76 offset:46080
  s_cmp_eq_u32 s66, 12
  s_cbranch_scc1 Cf3_kv2
Cf3_h2w:
  s_waitcnt lgkmcnt(0)
  s_barrier
  ds_read_b128 v[0:3], v76 offset:4608
  ds_read_b128 v[4:7], v76 offset:5632
  buffer_load_dwordx4 v76, s[8:11], s64 offen offset:0 sc1 lds
  buffer_load_dwordx4 v76, s[8:11], s64 offen offset:1024 sc1 lds
  buffer_load_dwordx4 v76, s[8:11], s64 offen offset:2048 sc1 lds
Cf3_top2:
  ds_read_b128 v[8:11], v76 offset:6656
  s_mov_b32 m0, 15872
  s_waitcnt lgkmcnt(2)
  v_smfmac_f32_16x16x64_bf16 v[20:23], v[0:3], v[60:67], v74
  ds_read_b128 v[60:63], v76 offset:47104
  v_smfmac_f32_16x16x64_bf16 v[24:27], v[0:3], v[44:51], v74
  buffer_load_dwordx4 v[44:47], v76, s[8:11], s58 offen offset:0 sc1
  ds_read_b128 v[64:67], v76 offset:48128
  s_waitcnt lgkmcnt(3)
  v_smfmac_f32_16x16x64_bf16 v[20:23], v[4:7], v[80:87], v74
  buffer_load_dwordx4 v[48:51], v76, s[8:11], s58 offen offset:1024 sc1
  v_smfmac_f32_16x16x64_bf16 v[28:31], v[0:3], v[36:43], v74
  buffer_load_dwordx4 v[52:55], v76, s[8:11], s59 offen offset:0 sc1
  ds_read_b128 v[36:39], v76 offset:61440
  v_smfmac_f32_16x16x64_bf16 v[24:27], v[4:7], v[88:95], v74
  buffer_load_dwordx4 v[56:59], v76, s[8:11], s59 offen offset:1024 sc1
  ds_read_b128 v[40:43], v76 offset:62464
  v_smfmac_f32_16x16x64_bf16 v[28:31], v[4:7], v[208:215], v74
  ds_read_b128 v[12:15], v76 offset:7680
  s_waitcnt lgkmcnt(5)
  v_smfmac_f32_16x16x64_bf16 v[32:35], v[4:7], v[216:223], v74
  buffer_store_dwordx4 v[16:19], v76, s[8:11], s68 offen sc1
  s_waitcnt lgkmcnt(3)
  v_smfmac_f32_16x16x64_bf16 v[32:35], v[0:3], v[60:67], v74
  buffer_load_dword v73, s[8:11], s70 offen  lds
  v_smfmac_f32_16x16x64_bf16 v[20:23], v[8:11], v[96:103], v74
  ds_read_b128 v[60:63], v76 offset:63488
  v_smfmac_f32_16x16x64_bf16 v[24:27], v[8:11], v[104:111], v74
  ds_read_b128 v[64:67], v76 offset:64512
  s_waitcnt lgkmcnt(3)
  v_smfmac_f32_16x16x64_bf16 v[28:31], v[8:11], v[36:43], v74
  ds_read_b128 v[36:39], v75 offset:12288
  s_waitcnt lgkmcnt(3)
  v_smfmac_f32_16x16x64_bf16 v[20:23], v[12:15], v[112:119], v74
  ds_read_b128 v[40:43], v75 offset:13312
  v_smfmac_f32_16x16x64_bf16 v[24:27], v[12:15], v[120:127], v74
  s_waitcnt vmcnt(6)
  v_smfmac_f32_16x16x64_bf16 v[28:31], v[12:15], v[224:231], v74
  s_barrier
  ds_read_b128 v[0:3], v76 offset:8704
  v_smfmac_f32_16x16x64_bf16 v[32:35], v[12:15], v[232:239], v74
  ds_read_b128 v[4:7], v76 offset:9728
  s_waitcnt lgkmcnt(4)
  v_smfmac_f32_16x16x64_bf16 v[32:35], v[8:11], v[60:67], v74
  ds_read_b128 v[60:63], v75 offset:14336
  s_waitcnt lgkmcnt(2)
  v_smfmac_f32_16x16x64_bf16 v[20:23], v[0:3], v[128:135], v74
  ds_read_b128 v[16:19], v76 offset:10752
  v_smfmac_f32_16x16x64_bf16 v[24:27], v[0:3], v[136:143], v74
  ds_read_b128 v[64:67], v75 offset:15360
  v_smfmac_f32_16x16x64_bf16 v[28:31], v[0:3], v[36:43], v74
  ds_read_b128 v[36:39], v75 offset:28672
  s_waitcnt lgkmcnt(4)
  v_smfmac_f32_16x16x64_bf16 v[20:23], v[4:7], v[144:151], v74
  ds_read_b128 v[12:15], v76 offset:11776
  v_smfmac_f32_16x16x64_bf16 v[24:27], v[4:7], v[152:159], v74
  ds_read_b128 v[40:43], v75 offset:29696
  s_waitcnt lgkmcnt(4)
  v_smfmac_f32_16x16x64_bf16 v[20:23], v[16:19], v[160:167], v74
  ds_read_b128 v[8:11], v76 offset:12800
  s_waitcnt lgkmcnt(4)
  v_smfmac_f32_16x16x64_bf16 v[32:35], v[0:3], v[60:67], v74
  ds_read_b128 v[60:63], v75 offset:30720
  v_mov_b64 v[68:69], s[78:79]
  v_smfmac_f32_16x16x64_bf16 v[24:27], v[16:19], v[168:175], v74
  ds_read_b128 v[64:67], v75 offset:31744
  s_waitcnt lgkmcnt(4)
  v_smfmac_f32_16x16x64_bf16 v[20:23], v[12:15], v[176:183], v74
  s_waitcnt lgkmcnt(3)
  v_mov_b64 v[70:71], s[78:79]
  v_smfmac_f32_16x16x64_bf16 v[28:31], v[4:7], v[36:43], v74
  s_waitcnt lgkmcnt(2)
  v_mov_b64 v[36:37], 0
  v_smfmac_f32_16x16x64_bf16 v[20:23], v[8:11], v[192:199], v74
  v_mov_b64 v[38:39], 0
  v_smfmac_f32_16x16x64_bf16 v[24:27], v[12:15], v[184:191], v74
  v_mov_b64 v[40:41], 0
  v_smfmac_f32_16x16x64_bf16 v[24:27], v[8:11], v[200:207], v74
  s_waitcnt lgkmcnt(0)
  v_add_f32 v20, v20, v22
  v_smfmac_f32_16x16x64_bf16 v[32:35], v[4:7], v[60:67], v74
  v_add_f32 v21, v21, v23
  v_smfmac_f32_16x16x64_bf16 v[28:31], v[16:19], v[240:247], v74
  v_add_f32 v24, v24, v26
  v_cvt_pk_bf16_f32 v22, v20, v24
  v_smfmac_f32_16x16x64_bf16 v[28:31], v[12:15], a[0:7], v74
  ds_write_b32 v79, v22 offset:0
  v_add_f32 v25, v25, v27
  v_cvt_pk_bf16_f32 v23, v21, v25
  v_smfmac_f32_16x16x64_bf16 v[28:31], v[8:11], a[16:23], v74
  ds_write_b32 v79, v23 offset:576
  v_cmp_u_f32 vcc, v20, v21
  v_smfmac_f32_16x16x64_bf16 v[32:35], v[16:19], v[248:255], v74
  v_mov_b64 v[42:43], 0
  v_smfmac_f32_16x16x64_bf16 v[32:35], v[12:15], a[8:15], v74
  v_add_f32 v28, v28, v30
  v_add_f32 v29, v29, v31
  v_smfmac_f32_16x16x64_bf16 v[32:35], v[8:11], a[24:31], v74
  s_cbranch_vccnz Cf3_rec
Cf3_recok:
  v_smfmac_f32_16x16x64_bf16 v[36:39], v[16:19], a[128:135], v74
  s_waitcnt lgkmcnt(0)
  s_barrier
  ds_read_b128 v[60:63], v77
  v_smfmac_f32_16x16x64_bf16 v[40:43], v[16:19], a[136:143], v74
  ds_read_b128 v[64:67], v77 offset:128
  v_add_f32 v32, v32, v34
  v_cvt_pk_bf16_f32 v30, v28, v32
  v_smfmac_f32_16x16x64_bf16 v[36:39], v[0:3], a[96:103], v74
  ds_write_b32 v79, v30 offset:256
  v_add_f32 v33, v33, v35
  v_cvt_pk_bf16_f32 v31, v29, v33
  v_smfmac_f32_16x16x64_bf16 v[40:43], v[0:3], a[104:111], v74
  ds_write_b32 v79, v31 offset:832
  v_xor_b32 v75, 0x8000, v75
  v_smfmac_f32_16x16x64_bf16 v[36:39], v[4:7], a[112:119], v74
  ds_read_b128 v[0:3], v76 offset:4608
  v_mov_b32 v29, 0
  v_smfmac_f32_16x16x64_bf16 v[40:43], v[4:7], a[120:127], v74
  s_waitcnt vmcnt(4) lgkmcnt(3)
  v_mov_b32 v30, 0
  v_mfma_f32_16x16x32_bf16 v[44:47], v[44:47], v[60:63], 0
  ds_read_b128 v[4:7], v76 offset:5632
  s_waitcnt lgkmcnt(2)
  v_mfma_f32_16x16x32_bf16 v[44:47], v[48:51], v[64:67], v[44:47]
  s_barrier
  v_smfmac_f32_16x16x64_bf16 v[36:39], v[8:11], a[160:167], v74
  ds_read_b128 v[20:23], v77 offset:256
  ds_read_b128 v[24:27], v77 offset:384
  v_smfmac_f32_16x16x64_bf16 v[40:43], v[8:11], a[168:175], v74
  ds_read_b128 v[8:11], v76 offset:6656
  v_add_f32_dpp v72, v46, v44 quad_perm:[2,3,0,1] row_mask:0xf bank_mask:0xf
  v_add_f32_dpp v73, v47, v45 quad_perm:[2,3,0,1] row_mask:0xf bank_mask:0xf
  v_smfmac_f32_16x16x64_bf16 v[36:39], v[12:15], a[144:151], v74
  s_waitcnt lgkmcnt(4)
  v_exp_f32_dpp v72, v72 quad_perm:[0,1,0,1] row_mask:0xf bank_mask:0xf
  v_smfmac_f32_16x16x64_bf16 v[40:43], v[12:15], a[152:159], v74
  ds_read_b128 v[12:15], v76 offset:7680
  v_exp_f32_dpp v73, v73 quad_perm:[0,1,0,1] row_mask:0xf bank_mask:0xf
  v_smfmac_f32_16x16x64_bf16 v[36:39], v[0:3], a[32:39], v74
  s_waitcnt lgkmcnt(2)
  v_cvt_pk_bf16_f32 v72, v72, v73
  v_mfma_f32_16x16x32_bf16 v[20:23], v[20:23], v[60:63], 0
  ds_write_b32 v78, v72 offset:524
  v_mov_b64 v[16:17], 0
  v_mfma_f32_16x16x32_bf16 v[20:23], v[24:27], v[64:67], v[20:23]
  ds_read_b128 v[44:47], v75 offset:28672
  v_mov_b64 v[18:19], 0
  v_smfmac_f32_16x16x64_bf16 v[40:43], v[0:3], a[40:47], v74
  ds_read_b128 v[48:51], v75 offset:29696
  s_waitcnt lgkmcnt(4)
  v_smfmac_f32_16x16x64_bf16 v[36:39], v[4:7], a[48:55], v74
  v_add_f32_dpp v24, v22, v20 quad_perm:[2,3,0,1] row_mask:0xf bank_mask:0xf
  v_add_f32_dpp v25, v23, v21 quad_perm:[2,3,0,1] row_mask:0xf bank_mask:0xf
  v_smfmac_f32_16x16x64_bf16 v[36:39], v[8:11], a[64:71], v74
  s_waitcnt lgkmcnt(2)
  s_barrier
  ds_read_b128 v[32:35], v78 offset:512
  v_smfmac_f32_16x16x64_bf16 v[36:39], v[12:15], a[80:87], v74
  ds_read_b128 v[60:63], v75 offset:30720
  v_mul_f32 v24, s69, v24
  v_smfmac_f32_16x16x64_bf16 v[40:43], v[4:7], a[56:63], v74
  ds_read_b128 v[64:67], v75 offset:31744
  v_mul_f32 v25, s69, v25
  v_smfmac_f32_16x16x64_bf16 v[40:43], v[8:11], a[72:79], v74
  v_exp_f32_dpp v24, v24 quad_perm:[0,1,0,1] row_mask:0xf bank_mask:0xf
  v_smfmac_f32_16x16x64_bf16 v[40:43], v[12:15], a[88:95], v74
  s_waitcnt vmcnt(2) lgkmcnt(2)
  v_exp_f32_dpp v25, v25 quad_perm:[0,1,0,1] row_mask:0xf bank_mask:0xf
  v_mfma_f32_16x16x32_bf16 v[8:11], v[32:35], v[68:71], 0
  v_add_f32 v36, v36, v38
  v_add_f32 v37, v37, v39
  v_mfma_f32_16x16x32_bf16 v[0:3], v[32:35], v[52:55], 0
  v_add_f32 v40, v40, v42
  v_add_f32 v41, v41, v43
  v_mfma_f32_16x16x32_bf16 v[4:7], v[32:35], v[56:59], 0
  v_cvt_pk_bf16_f32 v28, v24, v25
  v_cvt_pk_bf16_f32 v72, v36, v37
  v_cvt_pk_bf16_f32 v73, v40, v41
  v_mfma_f32_16x16x16_bf16 v[8:11], v[28:29], v[68:69], v[8:11]
  v_cvt_pk_bf16_f32 v31, v24, v25
  v_mov_b64 v[20:21], 0
  v_mfma_f32_16x16x16_bf16 v[0:3], v[28:29], v[72:73], v[0:3]
  ds_read_b128 v[68:71], v76 offset:13824
  v_mov_b64 v[22:23], 0
  v_mfma_f32_16x16x16_bf16 v[4:7], v[30:31], v[72:73], v[4:7]
  v_rcp_f32 v10, v8
  v_rcp_f32 v11, v9
  v_mul_f32 v0, v10, v0
  v_mul_f32 v1, v11, v1
  s_nop 0
  v_mul_f32 v4, v10, v4
  v_mul_f32 v5, v11, v5
  v_cvt_pk_bf16_f32 v2, v0, v4
  ds_write_b32 v79, v2 offset:8704
  v_cvt_pk_bf16_f32 v3, v1, v5
  ds_write_b32 v79, v3 offset:9280
  v_max3_f32 v8, v8, v9, v10
  v_max_f32 v8, v8, v11
  v_cmp_le_f32 vcc, 1317011456, v8
  v_mov_b64 v[24:25], 0
  v_mov_b64 v[26:27], 0
  s_cbranch_vccnz Cf3_mx
Cf3_mxok:
  s_waitcnt lgkmcnt(0)
  s_barrier
  ds_read_b128 v[0:3], v78 offset:8704
  ds_read_b128 v[4:7], v78 offset:8768
  ds_read_b128 v[8:11], v78 offset:8832
  ds_read_b128 v[12:15], v78 offset:8896
  s_cmp_eq_u32 s66, 63
  s_cbranch_scc1 Cf3_last
  s_waitcnt lgkmcnt(3)
  v_smfmac_f32_16x16x64_bf16 v[16:19], v[0:3], v[44:51], v74
  ds_read_b128 v[52:55], v75 offset:45056
  s_waitcnt lgkmcnt(3)
  v_smfmac_f32_16x16x64_bf16 v[16:19], v[4:7], v[60:67], v74
  ds_read_b128 v[56:59], v75 offset:46080
  s_waitcnt lgkmcnt(3)
  v_smfmac_f32_16x16x64_bf16 v[16:19], v[8:11], a[176:183], v74
  ds_read_b128 v[36:39], v75 offset:47104
  s_waitcnt lgkmcnt(3)
  v_smfmac_f32_16x16x64_bf16 v[16:19], v[12:15], a[184:191], v74
  ds_read_b128 v[40:43], v75 offset:48128
  ds_read_b128 v[44:47], v75 offset:61440
  v_smfmac_f32_16x16x64_bf16 v[20:23], v[0:3], a[192:199], v74
  ds_read_b128 v[48:51], v75 offset:62464
  ds_read_b128 v[60:63], v75 offset:63488
  v_smfmac_f32_16x16x64_bf16 v[20:23], v[4:7], a[200:207], v74
  ds_read_b128 v[64:67], v75 offset:64512
  s_waitcnt lgkmcnt(6)
  v_cvt_pk_bf16_f32 v16, v16, v17
  v_cvt_pk_bf16_f32 v17, v18, v19
  v_bfi_b32 v16, 1, s72, v16
  v_smfmac_f32_16x16x64_bf16 v[20:23], v[8:11], v[52:59], v74
  buffer_store_dwordx2 v[16:17], v68, s[8:11], s73 offen
  s_waitcnt lgkmcnt(4)
  v_smfmac_f32_16x16x64_bf16 v[20:23], v[12:15], v[36:43], v74
  ds_read_b128 v[52:55], v75 offset:8192
  v_mov_b64 v[32:33], 0
  v_smfmac_f32_16x16x64_bf16 v[24:27], v[0:3], a[208:215], v74
  ds_read_b128 v[56:59], v75 offset:9216
  v_mov_b64 v[34:35], 0
  v_smfmac_f32_16x16x64_bf16 v[24:27], v[4:7], a[216:223], v74
  ds_read_b128 v[36:39], v75 offset:10240
  s_waitcnt lgkmcnt(5)
  v_cvt_pk_bf16_f32 v20, v20, v21
  v_cvt_pk_bf16_f32 v21, v22, v23
  v_bfi_b32 v20, 1, s72, v20
  v_smfmac_f32_16x16x64_bf16 v[24:27], v[8:11], v[44:51], v74
  buffer_store_dwordx2 v[20:21], v68, s[8:11], s74 offen
  s_waitcnt lgkmcnt(3)
  v_smfmac_f32_16x16x64_bf16 v[24:27], v[12:15], v[60:67], v74
  ds_read_b128 v[40:43], v75 offset:11264
  v_mov_b64 v[28:29], 0
  v_smfmac_f32_16x16x64_bf16 v[32:35], v[0:3], a[224:231], v74
  ds_read_b128 v[44:47], v75 offset:12288
  ds_read_b128 v[48:51], v75 offset:13312
  v_smfmac_f32_16x16x64_bf16 v[32:35], v[4:7], a[232:239], v74
  ds_read_b128 v[60:63], v75 offset:14336
  v_cvt_pk_bf16_f32 v24, v24, v25
  v_cvt_pk_bf16_f32 v25, v26, v27
  v_bfi_b32 v24, 1, s72, v24
  v_smfmac_f32_16x16x64_bf16 v[32:35], v[8:11], a[240:247], v74
  buffer_store_dwordx2 v[24:25], v68, s[8:11], s75 offen
  v_mov_b64 v[30:31], 0
  v_smfmac_f32_16x16x64_bf16 v[32:35], v[12:15], a[248:255], v74
  ds_read_b128 v[64:67], v75 offset:15360
  s_waitcnt lgkmcnt(6)
  v_smfmac_f32_16x16x64_bf16 v[28:31], v[0:3], v[52:59], v74
  s_waitcnt lgkmcnt(4)
  v_smfmac_f32_16x16x64_bf16 v[28:31], v[4:7], v[36:43], v74
  s_waitcnt lgkmcnt(2)
  v_cvt_pk_bf16_f32 v32, v32, v33
  v_cvt_pk_bf16_f32 v33, v34, v35
  v_bfi_b32 v32, 1, s72, v32
  v_smfmac_f32_16x16x64_bf16 v[28:31], v[8:11], v[44:51], v74
  buffer_store_dwordx2 v[32:33], v68, s[8:11], s76 offen
  s_waitcnt lgkmcnt(0)
  v_smfmac_f32_16x16x64_bf16 v[28:31], v[12:15], v[60:67], v74
  ds_read_b128 v[52:55], v76 offset:14848
  ds_read_b64 v[16:17], v77 offset:392
  v_mov_b64 v[18:19], v[72:73]
  v_xor_b32 v75, 0x8000, v75
  s_nop 3
  v_cvt_pk_bf16_f32 v28, v28, v29
  v_cvt_pk_bf16_f32 v29, v30, v31
  v_bfi_b32 v28, 1, s72, v28
  buffer_store_dwordx2 v[28:29], v68, s[8:11], s77 offen
  v_mov_b64 v[20:21], 0
  v_mov_b64 v[22:23], 0
  v_mov_b64 v[24:25], 0
  v_mov_b64 v[26:27], 0
  v_mov_b64 v[28:29], 0
  v_mov_b64 v[30:31], 0
  v_mov_b64 v[32:33], 0
  v_mov_b64 v[34:35], 0
  s_add_u32 s58, s58, 655360
  s_add_u32 s59, s59, 655360
  s_add_u32 s70, s70, 655360
  s_add_u32 s68, s68, 655360
  s_add_u32 s66, s66, 1
  s_xor_b32 s64, s64, 16384
  s_xor_b32 s65, s65, 16384
  s_nop 15
  s_nop 15
  s_nop 15
  s_nop 9
  buffer_load_dwordx4 v[0:3], v76, s[8:11], s60 offen offset:0 sc1
  buffer_load_dwordx4 v[4:7], v76, s[8:11], s60 offen offset:1024 sc1
  buffer_load_dwordx4 v[8:11], v76, s[8:11], s61 offen offset:0 sc1
  buffer_load_dwordx4 v[12:15], v76, s[8:11], s61 offen offset:1024 sc1
  s_nop 15
  s_nop 11
  buffer_load_dwordx4 v[44:47], v76, s[8:11], s60 offen offset:0 sc1
  buffer_load_dwordx4 v[48:51], v76, s[8:11], s60 offen offset:1024 sc1
  buffer_load_dwordx4 v[60:63], v76, s[8:11], s61 offen offset:0 sc1
  buffer_load_dwordx4 v[64:67], v76, s[8:11], s61 offen offset:1024 sc1
  s_waitcnt lgkmcnt(0)
  s_cmp_eq_u32 s66, 12
  s_cbranch_scc1 Cf3_kv
Cf3_kvb:
  s_waitcnt vmcnt(7)
  v_mfma_f32_16x16x32_bf16 v[56:59], v[52:55], v[0:3], 0
  v_bitop3_b32 v72, v0, v2, s72 bitop3:0x7e
  s_waitcnt vmcnt(6)
  v_mfma_f32_16x16x32_bf16 v[56:59], v[52:55], v[4:7], v[56:59]
  v_bitop3_b32 v73, v4, v6, s72 bitop3:0x7e
  v_or_b32 v72, v72, v73
  s_waitcnt vmcnt(5)
  v_mfma_f32_16x16x32_bf16 v[36:39], v[52:55], v[8:11], 0
  v_bitop3_b32 v73, v8, v10, s72 bitop3:0x7e
  v_or_b32 v72, v72, v73
  s_waitcnt vmcnt(4)
  v_mfma_f32_16x16x32_bf16 v[36:39], v[52:55], v[12:15], v[36:39]
  v_bitop3_b32 v73, v12, v14, s72 bitop3:0x7e
  v_bitop3_b32 v72, v72, v73, 1 bitop3:0xa8
  v_cmp_ne_u32 vcc, 0, v72
  s_cbranch_vccnz Cf3_h1r
  v_add_f32_dpp v56, v56, v56 row_ror:4 row_mask:0xf bank_mask:0xf
  v_add_f32_dpp v57, v57, v57 row_ror:4 row_mask:0xf bank_mask:0xf
  s_nop 0
  v_add_f32_dpp v36, v36, v36 row_ror:4 row_mask:0xf bank_mask:0xf
  v_add_f32_dpp v37, v37, v37 row_ror:4 row_mask:0xf bank_mask:0xf
  v_add_f32_dpp v56, v56, v56 row_ror:8 row_mask:0xf bank_mask:0xf
  v_add_f32_dpp v57, v57, v57 row_ror:8 row_mask:0xf bank_mask:0xf
  v_add_f32_dpp v36, v36, v36 row_ror:8 row_mask:0xf bank_mask:0xf
  v_add_f32_dpp v37, v37, v37 row_ror:8 row_mask:0xf bank_mask:0xf
  v_cvt_pk_bf16_f32 v56, v56, v57
  buffer_store_dword v56, v69, s[8:11], s62 offen
  v_cvt_pk_bf16_f32 v36, v36, v37
  buffer_store_dword v36, v70, s[8:11], s63 offen
  s_xor_b32 s62, s62, 16384
  buffer_store_dword v71, v69, s[8:11], s62 offen
  s_xor_b32 s63, s63, 16384
  buffer_store_dword v71, v70, s[8:11], s63 offen
  s_xor_b32 s72, s72, 1
  s_branch Cf3_h2
Cf3_h1r:
  s_mov_b64 exec, vcc
  buffer_load_dwordx4 v[0:3], v76, s[8:11], s60 offen offset:0 sc1
  buffer_load_dwordx4 v[4:7], v76, s[8:11], s60 offen offset:1024 sc1
  buffer_load_dwordx4 v[8:11], v76, s[8:11], s61 offen offset:0 sc1
  buffer_load_dwordx4 v[12:15], v76, s[8:11], s61 offen offset:1024 sc1
  s_mov_b64 exec, -1
  s_add_u32 s67, s67, 1
  s_waitcnt vmcnt(7)
  v_mfma_f32_16x16x32_bf16 v[56:59], v[52:55], v[44:47], 0
  v_bitop3_b32 v72, v44, v46, s72 bitop3:0x7e
  s_waitcnt vmcnt(6)
  v_mfma_f32_16x16x32_bf16 v[56:59], v[52:55], v[48:51], v[56:59]
  v_bitop3_b32 v73, v48, v50, s72 bitop3:0x7e
  v_or_b32 v72, v72, v73
  s_waitcnt vmcnt(5)
  v_mfma_f32_16x16x32_bf16 v[36:39], v[52:55], v[60:63], 0
  v_bitop3_b32 v73, v60, v62, s72 bitop3:0x7e
  v_or_b32 v72, v72, v73
  s_waitcnt vmcnt(4)
  v_mfma_f32_16x16x32_bf16 v[36:39], v[52:55], v[64:67], v[36:39]
  v_bitop3_b32 v73, v64, v66, s72 bitop3:0x7e
  v_bitop3_b32 v72, v72, v73, 1 bitop3:0xa8
  v_cmp_ne_u32 vcc, 0, v72
  s_cbranch_vccz Cf3_h1p
  s_mov_b64 exec, vcc
  buffer_load_dwordx4 v[44:47], v76, s[8:11], s60 offen offset:0 sc1
  buffer_load_dwordx4 v[48:51], v76, s[8:11], s60 offen offset:1024 sc1
  buffer_load_dwordx4 v[60:63], v76, s[8:11], s61 offen offset:0 sc1
  buffer_load_dwordx4 v[64:67], v76, s[8:11], s61 offen offset:1024 sc1
  s_mov_b64 exec, -1
  s_add_u32 s67, s67, 1
  s_waitcnt vmcnt(7)
  v_mfma_f32_16x16x32_bf16 v[56:59], v[52:55], v[0:3], 0
  v_bitop3_b32 v72, v0, v2, s72 bitop3:0x7e
  s_waitcnt vmcnt(6)
  v_mfma_f32_16x16x32_bf16 v[56:59], v[52:55], v[4:7], v[56:59]
  v_bitop3_b32 v73, v4, v6, s72 bitop3:0x7e
  v_or_b32 v72, v72, v73
  s_waitcnt vmcnt(5)
  v_mfma_f32_16x16x32_bf16 v[36:39], v[52:55], v[8:11], 0
  v_bitop3_b32 v73, v8, v10, s72 bitop3:0x7e
  v_or_b32 v72, v72, v73
  s_waitcnt vmcnt(4)
  v_mfma_f32_16x16x32_bf16 v[36:39], v[52:55], v[12:15], v[36:39]
  v_bitop3_b32 v73, v12, v14, s72 bitop3:0x7e
  v_bitop3_b32 v72, v72, v73, 1 bitop3:0xa8
  v_cmp_ne_u32 vcc, 0, v72
  s_cbranch_vccz Cf3_h1p
Cf3_h1s:
  s_mov_b64 exec, vcc
  buffer_load_dwordx4 v[0:3], v76, s[8:11], s60 offen offset:0 sc1
  buffer_load_dwordx4 v[4:7], v76, s[8:11], s60 offen offset:1024 sc1
  buffer_load_dwordx4 v[8:11], v76, s[8:11], s61 offen offset:0 sc1
  buffer_load_dwordx4 v[12:15], v76, s[8:11], s61 offen offset:1024 sc1
  s_mov_b64 exec, -1
  s_add_u32 s67, s67, 1
  s_waitcnt vmcnt(7)
  v_mfma_f32_16x16x32_bf16 v[56:59], v[52:55], v[44:47], 0
  v_bitop3_b32 v72, v44, v46, s72 bitop3:0x7e
  s_waitcnt vmcnt(6)
  v_mfma_f32_16x16x32_bf16 v[56:59], v[52:55], v[48:51], v[56:59]
  v_bitop3_b32 v73, v48, v50, s72 bitop3:0x7e
  v_or_b32 v72, v72, v73
  s_waitcnt vmcnt(5)
  v_mfma_f32_16x16x32_bf16 v[36:39], v[52:55], v[60:63], 0
  v_bitop3_b32 v73, v60, v62, s72 bitop3:0x7e
  v_or_b32 v72, v72, v73
  s_waitcnt vmcnt(4)
  v_mfma_f32_16x16x32_bf16 v[36:39], v[52:55], v[64:67], v[36:39]
  v_bitop3_b32 v73, v64, v66, s72 bitop3:0x7e
  v_bitop3_b32 v72, v72, v73, 1 bitop3:0xa8
  v_cmp_ne_u32 vcc, 0, v72
  s_cbranch_vccz Cf3_h1p
  s_mov_b64 exec, vcc
  buffer_load_dwordx4 v[44:47], v76, s[8:11], s60 offen offset:0 sc1
  buffer_load_dwordx4 v[48:51], v76, s[8:11], s60 offen offset:1024 sc1
  buffer_load_dwordx4 v[60:63], v76, s[8:11], s61 offen offset:0 sc1
  buffer_load_dwordx4 v[64:67], v76, s[8:11], s61 offen offset:1024 sc1
  s_mov_b64 exec, -1
  s_add_u32 s67, s67, 1
  s_waitcnt vmcnt(7)
  v_mfma_f32_16x16x32_bf16 v[56:59], v[52:55], v[0:3], 0
  v_bitop3_b32 v72, v0, v2, s72 bitop3:0x7e
  s_waitcnt vmcnt(6)
  v_mfma_f32_16x16x32_bf16 v[56:59], v[52:55], v[4:7], v[56:59]
  v_bitop3_b32 v73, v4, v6, s72 bitop3:0x7e
  v_or_b32 v72, v72, v73
  s_waitcnt vmcnt(5)
  v_mfma_f32_16x16x32_bf16 v[36:39], v[52:55], v[8:11], 0
  v_bitop3_b32 v73, v8, v10, s72 bitop3:0x7e
  v_or_b32 v72, v72, v73
  s_waitcnt vmcnt(4)
  v_mfma_f32_16x16x32_bf16 v[36:39], v[52:55], v[12:15], v[36:39]
  v_bitop3_b32 v73, v12, v14, s72 bitop3:0x7e
  v_bitop3_b32 v72, v72, v73, 1 bitop3:0xa8
  v_cmp_ne_u32 vcc, 0, v72
  s_cbranch_vccz Cf3_h1p
  s_cmp_lt_u32 s67, 131072
  s_cbranch_scc1 Cf3_h1s
Cf3_h1p:
  s_nop 2
  v_add_f32_dpp v56, v56, v56 row_ror:4 row_mask:0xf bank_mask:0xf
  v_add_f32_dpp v57, v57, v57 row_ror:4 row_mask:0xf bank_mask:0xf
  v_add_f32_dpp v36, v36, v36 row_ror:4 row_mask:0xf bank_mask:0xf
  v_add_f32_dpp v37, v37, v37 row_ror:4 row_mask:0xf bank_mask:0xf
  v_add_f32_dpp v56, v56, v56 row_ror:8 row_mask:0xf bank_mask:0xf
  v_add_f32_dpp v57, v57, v57 row_ror:8 row_mask:0xf bank_mask:0xf
  v_add_f32_dpp v36, v36, v36 row_ror:8 row_mask:0xf bank_mask:0xf
  v_add_f32_dpp v37, v37, v37 row_ror:8 row_mask:0xf bank_mask:0xf
  v_cvt_pk_bf16_f32 v56, v56, v57
  buffer_store_dword v56, v69, s[8:11], s62 offen
  v_cvt_pk_bf16_f32 v36, v36, v37
  buffer_store_dword v36, v70, s[8:11], s63 offen
  s_xor_b32 s62, s62, 16384
  buffer_store_dword v71, v69, s[8:11], s62 offen
  s_xor_b32 s63, s63, 16384
  buffer_store_dword v71, v70, s[8:11], s63 offen
  s_xor_b32 s72, s72, 1
  s_branch Cf3_h2
Cf3_rec:
  s_nop 7
  s_waitcnt vmcnt(0) lgkmcnt(0)
  v_max3_u32 v72, v0, v1, v2
  v_max3_u32 v72, v72, v3, v4
  v_max3_u32 v72, v72, v5, v6
  v_max3_u32 v72, v72, v7, v8
  v_max3_u32 v72, v72, v9, v10
  v_max3_u32 v72, v72, v11, v12
  v_max3_u32 v72, v72, v13, v14
  v_max3_u32 v72, v72, v15, v16
  v_max3_u32 v72, v72, v17, v18
  v_max_u32 v72, v72, v19
  v_cmp_eq_u32 vcc, -1, v72
  s_cbranch_vccz Cf3_recok
  s_barrier
Cf3_recp:
  buffer_load_dwordx4 v[0:3], v76, s[8:11], s64 offen offset:0 sc1
  buffer_load_dwordx4 v[4:7], v76, s[8:11], s64 offen offset:1024 sc1
  buffer_load_dwordx4 v[8:11], v76, s[8:11], s64 offen offset:2048 sc1
  s_add_u32 s67, s67, 1
  s_cmp_lt_u32 s67, 131072
  s_cselect_b32 s54, -2, -1
  s_waitcnt vmcnt(2)
  v_max3_u32 v72, v0, v1, v2
  s_waitcnt vmcnt(1)
  v_max3_u32 v72, v72, v3, v4
  v_max3_u32 v72, v72, v5, v6
  s_waitcnt vmcnt(0)
  v_max3_u32 v72, v72, v7, v8
  v_max3_u32 v72, v72, v9, v10
  v_max_u32 v72, v72, v11
  v_cmp_lt_u32 vcc, s54, v72
  s_cbranch_vccnz Cf3_recp
  ds_write_b128 v76, v[0:3] offset:10752
  ds_write_b128 v76, v[4:7] offset:11776
  ds_write_b128 v76, v[8:11] offset:12800
  v_mov_b64 v[20:21], 0
  v_mov_b64 v[22:23], 0
  v_mov_b64 v[24:25], 0
  v_mov_b64 v[26:27], 0
  v_mov_b64 v[28:29], 0
  v_mov_b64 v[30:31], 0
  v_mov_b64 v[32:33], 0
  v_mov_b64 v[34:35], 0
  s_waitcnt lgkmcnt(0)
  s_barrier
  ds_read_b128 v[0:3], v76 offset:4608
  ds_read_b128 v[60:63], v76 offset:28672
  ds_read_b128 v[64:67], v76 offset:29696
  s_waitcnt lgkmcnt(0)
  v_smfmac_f32_16x16x64_bf16 v[20:23], v[0:3], v[60:67], v74
  ds_read_b128 v[60:63], v76 offset:30720
  ds_read_b128 v[64:67], v76 offset:31744
  s_waitcnt lgkmcnt(0)
  v_smfmac_f32_16x16x64_bf16 v[24:27], v[0:3], v[60:67], v74
  ds_read_b128 v[60:63], v76 offset:45056
  ds_read_b128 v[64:67], v76 offset:46080
  s_waitcnt lgkmcnt(0)
  v_smfmac_f32_16x16x64_bf16 v[28:31], v[0:3], v[60:67], v74
  ds_read_b128 v[60:63], v76 offset:47104
  ds_read_b128 v[64:67], v76 offset:48128
  s_waitcnt lgkmcnt(0)
  v_smfmac_f32_16x16x64_bf16 v[32:35], v[0:3], v[60:67], v74
  ds_read_b128 v[4:7], v76 offset:5632
  s_waitcnt lgkmcnt(0)
  v_smfmac_f32_16x16x64_bf16 v[20:23], v[4:7], v[80:87], v74
  v_smfmac_f32_16x16x64_bf16 v[24:27], v[4:7], v[88:95], v74
  v_smfmac_f32_16x16x64_bf16 v[28:31], v[4:7], v[208:215], v74
  v_smfmac_f32_16x16x64_bf16 v[32:35], v[4:7], v[216:223], v74
  ds_read_b128 v[8:11], v76 offset:6656
  s_waitcnt lgkmcnt(0)
  v_smfmac_f32_16x16x64_bf16 v[20:23], v[8:11], v[96:103], v74
  v_smfmac_f32_16x16x64_bf16 v[24:27], v[8:11], v[104:111], v74
  ds_read_b128 v[60:63], v76 offset:61440
  ds_read_b128 v[64:67], v76 offset:62464
  s_waitcnt lgkmcnt(0)
  v_smfmac_f32_16x16x64_bf16 v[28:31], v[8:11], v[60:67], v74
  ds_read_b128 v[60:63], v76 offset:63488
  ds_read_b128 v[64:67], v76 offset:64512
  s_waitcnt lgkmcnt(0)
  v_smfmac_f32_16x16x64_bf16 v[32:35], v[8:11], v[60:67], v74
  ds_read_b128 v[12:15], v76 offset:7680
  s_waitcnt lgkmcnt(0)
  v_smfmac_f32_16x16x64_bf16 v[20:23], v[12:15], v[112:119], v74
  v_smfmac_f32_16x16x64_bf16 v[24:27], v[12:15], v[120:127], v74
  v_smfmac_f32_16x16x64_bf16 v[28:31], v[12:15], v[224:231], v74
  v_smfmac_f32_16x16x64_bf16 v[32:35], v[12:15], v[232:239], v74
  ds_read_b128 v[0:3], v76 offset:8704
  s_waitcnt lgkmcnt(0)
  v_smfmac_f32_16x16x64_bf16 v[20:23], v[0:3], v[128:135], v74
  v_smfmac_f32_16x16x64_bf16 v[24:27], v[0:3], v[136:143], v74
  ds_read_b128 v[60:63], v75 offset:12288
  ds_read_b128 v[64:67], v75 offset:13312
  s_waitcnt lgkmcnt(0)
  v_smfmac_f32_16x16x64_bf16 v[28:31], v[0:3], v[60:67], v74
  ds_read_b128 v[60:63], v75 offset:14336
  ds_read_b128 v[64:67], v75 offset:15360
  s_waitcnt lgkmcnt(0)
  v_smfmac_f32_16x16x64_bf16 v[32:35], v[0:3], v[60:67], v74
  ds_read_b128 v[4:7], v76 offset:9728
  s_waitcnt lgkmcnt(0)
  v_smfmac_f32_16x16x64_bf16 v[20:23], v[4:7], v[144:151], v74
  v_smfmac_f32_16x16x64_bf16 v[24:27], v[4:7], v[152:159], v74
  ds_read_b128 v[60:63], v75 offset:28672
  ds_read_b128 v[64:67], v75 offset:29696
  s_waitcnt lgkmcnt(0)
  v_smfmac_f32_16x16x64_bf16 v[28:31], v[4:7], v[60:67], v74
  ds_read_b128 v[60:63], v75 offset:30720
  ds_read_b128 v[64:67], v75 offset:31744
  s_waitcnt lgkmcnt(0)
  v_smfmac_f32_16x16x64_bf16 v[32:35], v[4:7], v[60:67], v74
  ds_read_b128 v[16:19], v76 offset:10752
  s_waitcnt lgkmcnt(0)
  v_smfmac_f32_16x16x64_bf16 v[20:23], v[16:19], v[160:167], v74
  v_smfmac_f32_16x16x64_bf16 v[24:27], v[16:19], v[168:175], v74
  v_smfmac_f32_16x16x64_bf16 v[28:31], v[16:19], v[240:247], v74
  v_smfmac_f32_16x16x64_bf16 v[32:35], v[16:19], v[248:255], v74
  ds_read_b128 v[12:15], v76 offset:11776
  s_waitcnt lgkmcnt(0)
  v_smfmac_f32_16x16x64_bf16 v[20:23], v[12:15], v[176:183], v74
  v_smfmac_f32_16x16x64_bf16 v[24:27], v[12:15], v[184:191], v74
  v_smfmac_f32_16x16x64_bf16 v[28:31], v[12:15], a[0:7], v74
  v_smfmac_f32_16x16x64_bf16 v[32:35], v[12:15], a[8:15], v74
  ds_read_b128 v[8:11], v76 offset:12800
  s_waitcnt lgkmcnt(0)
  v_smfmac_f32_16x16x64_bf16 v[20:23], v[8:11], v[192:199], v74
  v_smfmac_f32_16x16x64_bf16 v[24:27], v[8:11], v[200:207], v74
  v_smfmac_f32_16x16x64_bf16 v[28:31], v[8:11], a[16:23], v74
  v_smfmac_f32_16x16x64_bf16 v[32:35], v[8:11], a[24:31], v74
  v_add_f32 v20, v20, v22
  v_add_f32 v21, v21, v23
  v_add_f32 v24, v24, v26
  v_cvt_pk_bf16_f32 v22, v20, v24
  s_nop 0
  ds_write_b32 v79, v22 offset:0
  v_add_f32 v25, v25, v27
  v_cvt_pk_bf16_f32 v23, v21, v25
  ds_write_b32 v79, v23 offset:576
  v_add_f32 v28, v28, v30
  v_add_f32 v29, v29, v31
  s_waitcnt lgkmcnt(0)
  s_nop 1
  s_branch Cf3_recok
Cf3_mx:
  s_waitcnt lgkmcnt(0)
  s_barrier
  buffer_load_dwordx4 v[0:3], v76, s[8:11], s58 offen offset:0 sc1
  ds_read_b128 v[20:23], v77 offset:0
  ds_read_b128 v[28:31], v77 offset:256
  buffer_load_dwordx4 v[4:7], v76, s[8:11], s58 offen offset:1024 sc1
  ds_read_b128 v[24:27], v77 offset:128
  ds_read_b128 v[32:35], v77 offset:384
  s_waitcnt vmcnt(1) lgkmcnt(3)
  v_mfma_f32_16x16x32_bf16 v[8:11], v[0:3], v[20:23], 0
  s_waitcnt vmcnt(0) lgkmcnt(1)
  v_mfma_f32_16x16x32_bf16 v[8:11], v[4:7], v[24:27], v[8:11]
  v_mfma_f32_16x16x32_bf16 v[12:15], v[28:31], v[20:23], 0
  s_waitcnt lgkmcnt(0)
  v_mfma_f32_16x16x32_bf16 v[12:15], v[32:35], v[24:27], v[12:15]
  v_add_f32_dpp v8, v10, v8 quad_perm:[2,3,0,1] row_mask:0xf bank_mask:0xf
  v_add_f32_dpp v9, v11, v9 quad_perm:[2,3,0,1] row_mask:0xf bank_mask:0xf
  s_nop 0
  v_mov_b32_dpp v8, v8 quad_perm:[0,1,0,1] row_mask:0xf bank_mask:0xf
  v_mov_b32_dpp v9, v9 quad_perm:[0,1,0,1] row_mask:0xf bank_mask:0xf
  s_nop 1
  v_add_f32_dpp v12, v14, v12 quad_perm:[2,3,0,1] row_mask:0xf bank_mask:0xf
  v_add_f32_dpp v13, v15, v13 quad_perm:[2,3,0,1] row_mask:0xf bank_mask:0xf
  s_nop 0
  v_mov_b32_dpp v12, v12 quad_perm:[0,1,0,1] row_mask:0xf bank_mask:0xf
  v_mov_b32_dpp v13, v13 quad_perm:[0,1,0,1] row_mask:0xf bank_mask:0xf
  v_mul_f32 v12, s69, v12
  ds_write_b32 v78, v8 offset:8716
  v_mul_f32 v13, s69, v13
  ds_write_b32 v78, v9 offset:8780
  s_waitcnt lgkmcnt(0)
  s_barrier
  ds_read_b128 v[36:39], v78 offset:8704
  ds_read_b128 v[40:43], v78 offset:8768
  s_waitcnt lgkmcnt(0)
  s_barrier
  v_max_f32 v16, v36, v37
  v_max3_f32 v16, v16, v38, v39
  v_max3_f32 v16, v16, v40, v41
  v_max3_f32 v16, v16, v42, v43
  v_max3_f32 v16, v16, v12, v13
  v_mov_b32 v17, v16
  s_nop 1
  v_permlane16_swap_b32 v16, v17
  v_max_f32 v16, v16, v17
  v_mov_b32 v17, v16
  s_nop 1
  v_permlane32_swap_b32 v16, v17
  v_max_f32 v16, v16, v17
  v_sub_f32 v36, v36, v16
  v_sub_f32 v37, v37, v16
  v_sub_f32 v38, v38, v16
  v_sub_f32 v39, v39, v16
  v_sub_f32 v40, v40, v16
  v_sub_f32 v41, v41, v16
  v_sub_f32 v42, v42, v16
  v_sub_f32 v43, v43, v16
  v_sub_f32 v12, v12, v16
  v_sub_f32 v13, v13, v16
  v_exp_f32 v36, v36
  v_exp_f32 v37, v37
  v_exp_f32 v38, v38
  v_exp_f32 v39, v39
  v_exp_f32 v40, v40
  v_exp_f32 v41, v41
  v_exp_f32 v42, v42
  v_exp_f32 v43, v43
  v_exp_f32 v12, v12
  v_exp_f32 v13, v13
  v_cvt_pk_bf16_f32 v32, v36, v40
  v_cvt_pk_bf16_f32 v33, v37, v41
  v_cvt_pk_bf16_f32 v34, v38, v42
  v_cvt_pk_bf16_f32 v35, v39, v43
  v_cvt_pk_bf16_f32 v28, v12, v13
  v_cvt_pk_bf16_f32 v31, v12, v13
  v_mov_b32 v29, 0
  v_mov_b32 v30, 0
  v_mov_b32 v68, 0x3f803f80
  v_mov_b32 v69, 0x3f803f80
  v_mov_b32 v70, 0x3f803f80
  v_mov_b32 v71, 0x3f803f80
  s_nop 1
  v_mfma_f32_16x16x32_bf16 v[8:11], v[32:35], v[68:71], 0
  v_mfma_f32_16x16x32_bf16 v[0:3], v[32:35], v[52:55], 0
  v_mfma_f32_16x16x32_bf16 v[4:7], v[32:35], v[56:59], 0
  v_mfma_f32_16x16x16_bf16 v[8:11], v[28:29], v[68:69], v[8:11]
  v_mfma_f32_16x16x16_bf16 v[0:3], v[28:29], v[72:73], v[0:3]
  v_mfma_f32_16x16x16_bf16 v[4:7], v[30:31], v[72:73], v[4:7]
  ds_read_b128 v[68:71], v76 offset:13824
  v_rcp_f32 v10, v8
  v_rcp_f32 v11, v9
  v_mul_f32 v0, v10, v0
  v_mul_f32 v1, v11, v1
  s_nop 0
  v_mul_f32 v4, v10, v4
  v_mul_f32 v5, v11, v5
  v_cvt_pk_bf16_f32 v2, v0, v4
  ds_write_b32 v79, v2 offset:8704
  v_cvt_pk_bf16_f32 v3, v1, v5
  ds_write_b32 v79, v3 offset:9280
  v_mov_b64 v[16:17], 0
  v_mov_b64 v[18:19], 0
  v_mov_b64 v[20:21], 0
  v_mov_b64 v[22:23], 0
  v_mov_b64 v[24:25], 0
  v_mov_b64 v[26:27], 0
  s_branch Cf3_mxok
Cf3_kv:
  s_lshl_b32 s56, s53, 2
  s_add_u32 s56, s56, 128
  s_load_dword s57, s[12:13], s56 glc
  s_branch Cf3_kvb
Cf3_kv2:
  s_waitcnt lgkmcnt(0)
  s_cmp_ge_u32 s57, 0x700
  s_cbranch_scc1 Cf3_h2w
  s_load_dword s57, s[12:13], s56 glc
  s_add_u32 s67, s67, 1
  s_cmp_lt_u32 s67, 131072
  s_cbranch_scc1 Cf3_kv2
  s_branch Cf3_h2w
Cf3_last:
  s_waitcnt lgkmcnt(0)
  ds_read_b64 v[16:17], v77 offset:392
  v_mov_b64 v[18:19], v[72:73]
  s_add_u32 s68, s68, 655360
  s_waitcnt lgkmcnt(0)
  buffer_store_dwordx4 v[16:19], v76, s[8:11], s68 offen sc1
  s_branch L_cexit
L_w4:
  v_mov_b64 v[20:21], 0
  v_mov_b64 v[22:23], 0
  v_mov_b64 v[24:25], 0
  v_mov_b64 v[26:27], 0
  v_mov_b64 v[28:29], 0
  v_mov_b64 v[30:31], 0
  v_mov_b64 v[32:33], 0
  v_mov_b64 v[34:35], 0
  s_mov_b32 s78, 0x3f803f80
  s_mov_b32 s79, s78
  s_mov_b32 s65, 360448
  s_mov_b32 m0, 15872
  v_lshlrev_b32 v73, 2, v76
  v_mov_b32 v72, 0
  ds_read_b128 v[60:63], v76 offset:16384
  ds_read_b128 v[64:67], v76 offset:17408
  ds_read_b128 v[44:47], v76 offset:18432
  ds_read_b128 v[48:51], v76 offset:19456
  ds_read_b128 v[36:39], v76 offset:32768
  ds_read_b128 v[40:43], v76 offset:33792
  ds_read_b128 v[0:3], v76 offset:4608
  ds_read_b128 v[4:7], v76 offset:5632
  s_branch Cs0_top2
.p2align 6
Cs0_h2:
  v_lshlrev_b32 v73, 2, v76
  s_nop 15
  s_nop 15
  s_nop 3
  buffer_load_dwordx4 v[52:55], v76, s[8:11], s65 offen offset:0 sc1
  buffer_load_dwordx4 v[56:59], v76, s[8:11], s65 offen offset:1024 sc1
  s_nop 15
  s_nop 3
  buffer_load_dwordx4 v[52:55], v76, s[8:11], s65 offen offset:0 sc1
  buffer_load_dwordx4 v[56:59], v76, s[8:11], s65 offen offset:1024 sc1
  s_nop 15
  s_nop 3
  buffer_load_dwordx4 v[52:55], v76, s[8:11], s65 offen offset:0 sc1
  buffer_load_dwordx4 v[56:59], v76, s[8:11], s65 offen offset:1024 sc1
  s_waitcnt vmcnt(8)
  ds_read_b128 v[60:63], v76 offset:16384
  ds_read_b128 v[64:67], v76 offset:17408
  ds_read_b128 v[44:47], v76 offset:18432
  ds_read_b128 v[48:51], v76 offset:19456
  ds_read_b128 v[36:39], v76 offset:32768
  ds_read_b128 v[40:43], v76 offset:33792
  s_waitcnt vmcnt(4)
  v_max3_u32 v72, v52, v53, v54
  v_max3_u32 v72, v72, v55, v56
  v_max3_u32 v72, v72, v57, v58
  v_max_u32 v72, v72, v59
  ds_write_b128 v76, v[52:55] offset:4608
  ds_write_b128 v76, v[56:59] offset:5632
  v_cmp_eq_u32 vcc, -1, v72
  s_cbranch_vccnz Cs0_h2r
Cs0_h2w:
  s_waitcnt lgkmcnt(0)
  s_barrier
  ds_read_b128 v[0:3], v76 offset:4608
  ds_read_b128 v[4:7], v76 offset:5632
Cs0_top2:
  ds_read_b128 v[8:11], v76 offset:6656
  s_waitcnt lgkmcnt(2)
  v_smfmac_f32_16x16x64_bf16 v[20:23], v[0:3], v[60:67], v74
  ds_read_b128 v[60:63], v76 offset:34816
  v_smfmac_f32_16x16x64_bf16 v[24:27], v[0:3], v[44:51], v74
  buffer_load_dwordx4 v[44:47], v76, s[8:11], s58 offen offset:0 sc1
  ds_read_b128 v[64:67], v76 offset:35840
  s_waitcnt lgkmcnt(3)
  v_smfmac_f32_16x16x64_bf16 v[20:23], v[4:7], v[80:87], v74
  buffer_load_dwordx4 v[48:51], v76, s[8:11], s58 offen offset:1024 sc1
  v_smfmac_f32_16x16x64_bf16 v[28:31], v[0:3], v[36:43], v74
  buffer_load_dwordx4 v[52:55], v76, s[8:11], s59 offen offset:0 sc1
  ds_read_b128 v[36:39], v76 offset:49152
  v_smfmac_f32_16x16x64_bf16 v[24:27], v[4:7], v[88:95], v74
  buffer_load_dwordx4 v[56:59], v76, s[8:11], s59 offen offset:1024 sc1
  ds_read_b128 v[40:43], v76 offset:50176
  v_smfmac_f32_16x16x64_bf16 v[28:31], v[4:7], v[208:215], v74
  ds_read_b128 v[12:15], v76 offset:7680
  s_waitcnt lgkmcnt(5)
  v_smfmac_f32_16x16x64_bf16 v[32:35], v[4:7], v[216:223], v74
  buffer_store_dwordx4 v[16:19], v76, s[8:11], s68 offen sc1
  s_waitcnt lgkmcnt(3)
  v_smfmac_f32_16x16x64_bf16 v[32:35], v[0:3], v[60:67], v74
  buffer_load_dword v73, s[8:11], s70 offen  lds
  v_smfmac_f32_16x16x64_bf16 v[20:23], v[8:11], v[96:103], v74
  ds_read_b128 v[60:63], v76 offset:51200
  v_smfmac_f32_16x16x64_bf16 v[24:27], v[8:11], v[104:111], v74
  ds_read_b128 v[64:67], v76 offset:52224
  s_waitcnt lgkmcnt(3)
  v_smfmac_f32_16x16x64_bf16 v[28:31], v[8:11], v[36:43], v74
  ds_read_b128 v[36:39], v75 offset:0
  s_waitcnt lgkmcnt(3)
  v_smfmac_f32_16x16x64_bf16 v[20:23], v[12:15], v[112:119], v74
  ds_read_b128 v[40:43], v75 offset:1024
  v_smfmac_f32_16x16x64_bf16 v[24:27], v[12:15], v[120:127], v74
  v_smfmac_f32_16x16x64_bf16 v[28:31], v[12:15], v[224:231], v74
  s_barrier
  ds_read_b128 v[0:3], v76 offset:8704
  v_smfmac_f32_16x16x64_bf16 v[32:35], v[12:15], v[232:239], v74
  ds_read_b128 v[4:7], v76 offset:9728
  s_waitcnt lgkmcnt(4)
  v_smfmac_f32_16x16x64_bf16 v[32:35], v[8:11], v[60:67], v74
  ds_read_b128 v[60:63], v75 offset:2048
  s_waitcnt lgkmcnt(2)
  v_smfmac_f32_16x16x64_bf16 v[20:23], v[0:3], v[128:135], v74
  ds_read_b128 v[16:19], v76 offset:10752
  v_smfmac_f32_16x16x64_bf16 v[24:27], v[0:3], v[136:143], v74
  ds_read_b128 v[64:67], v75 offset:3072
  v_smfmac_f32_16x16x64_bf16 v[28:31], v[0:3], v[36:43], v74
  ds_read_b128 v[36:39], v75 offset:16384
  s_waitcnt lgkmcnt(4)
  v_smfmac_f32_16x16x64_bf16 v[20:23], v[4:7], v[144:151], v74
  ds_read_b128 v[12:15], v76 offset:11776
  v_smfmac_f32_16x16x64_bf16 v[24:27], v[4:7], v[152:159], v74
  ds_read_b128 v[40:43], v75 offset:17408
  s_waitcnt lgkmcnt(4)
  v_smfmac_f32_16x16x64_bf16 v[20:23], v[16:19], v[160:167], v74
  ds_read_b128 v[8:11], v76 offset:12800
  s_waitcnt lgkmcnt(4)
  v_smfmac_f32_16x16x64_bf16 v[32:35], v[0:3], v[60:67], v74
  ds_read_b128 v[60:63], v75 offset:18432
  v_mov_b64 v[68:69], s[78:79]
  v_smfmac_f32_16x16x64_bf16 v[24:27], v[16:19], v[168:175], v74
  ds_read_b128 v[64:67], v75 offset:19456
  s_waitcnt lgkmcnt(4)
  v_smfmac_f32_16x16x64_bf16 v[20:23], v[12:15], v[176:183], v74
  s_waitcnt lgkmcnt(3)
  v_mov_b64 v[70:71], s[78:79]
  v_smfmac_f32_16x16x64_bf16 v[28:31], v[4:7], v[36:43], v74
  s_waitcnt lgkmcnt(2)
  v_mov_b64 v[36:37], 0
  v_smfmac_f32_16x16x64_bf16 v[20:23], v[8:11], v[192:199], v74
  v_mov_b64 v[38:39], 0
  v_smfmac_f32_16x16x64_bf16 v[24:27], v[12:15], v[184:191], v74
  v_mov_b64 v[40:41], 0
  v_smfmac_f32_16x16x64_bf16 v[24:27], v[8:11], v[200:207], v74
  s_waitcnt lgkmcnt(0)
  v_add_f32 v20, v20, v22
  v_smfmac_f32_16x16x64_bf16 v[32:35], v[4:7], v[60:67], v74
  v_add_f32 v21, v21, v23
  v_smfmac_f32_16x16x64_bf16 v[28:31], v[16:19], v[240:247], v74
  v_add_f32 v24, v24, v26
  v_cvt_pk_bf16_f32 v22, v20, v24
  v_smfmac_f32_16x16x64_bf16 v[28:31], v[12:15], a[0:7], v74
  ds_write_b32 v79, v22 offset:0
  v_add_f32 v25, v25, v27
  v_cvt_pk_bf16_f32 v23, v21, v25
  v_smfmac_f32_16x16x64_bf16 v[28:31], v[8:11], a[16:23], v74
  ds_write_b32 v79, v23 offset:576
  v_cmp_u_f32 vcc, v20, v21
  v_smfmac_f32_16x16x64_bf16 v[32:35], v[16:19], v[248:255], v74
  v_mov_b64 v[42:43], 0
  v_smfmac_f32_16x16x64_bf16 v[32:35], v[12:15], a[8:15], v74
  v_add_f32 v28, v28, v30
  v_add_f32 v29, v29, v31
  v_smfmac_f32_16x16x64_bf16 v[32:35], v[8:11], a[24:31], v74
  s_cbranch_vccnz Cs0_rec
Cs0_recok:
  v_smfmac_f32_16x16x64_bf16 v[36:39], v[16:19], a[128:135], v74
  s_waitcnt lgkmcnt(0)
  s_barrier
  ds_read_b128 v[60:63], v77
  v_smfmac_f32_16x16x64_bf16 v[40:43], v[16:19], a[136:143], v74
  ds_read_b128 v[64:67], v77 offset:128
  v_add_f32 v32, v32, v34
  v_cvt_pk_bf16_f32 v30, v28, v32
  v_smfmac_f32_16x16x64_bf16 v[36:39], v[0:3], a[96:103], v74
  ds_write_b32 v79, v30 offset:256
  v_add_f32 v33, v33, v35
  v_cvt_pk_bf16_f32 v31, v29, v33
  v_smfmac_f32_16x16x64_bf16 v[40:43], v[0:3], a[104:111], v74
  ds_write_b32 v79, v31 offset:832
  v_xor_b32 v75, 0x8000, v75
  v_smfmac_f32_16x16x64_bf16 v[36:39], v[4:7], a[112:119], v74
  ds_read_b128 v[0:3], v76 offset:4608
  v_mov_b32 v29, 0
  v_smfmac_f32_16x16x64_bf16 v[40:43], v[4:7], a[120:127], v74
  s_waitcnt vmcnt(4) lgkmcnt(3)
  v_mov_b32 v30, 0
  v_mfma_f32_16x16x32_bf16 v[44:47], v[44:47], v[60:63], 0
  ds_read_b128 v[4:7], v76 offset:5632
  s_waitcnt lgkmcnt(2)
  v_mfma_f32_16x16x32_bf16 v[44:47], v[48:51], v[64:67], v[44:47]
  s_barrier
  v_smfmac_f32_16x16x64_bf16 v[36:39], v[8:11], a[160:167], v74
  ds_read_b128 v[20:23], v77 offset:256
  ds_read_b128 v[24:27], v77 offset:384
  v_smfmac_f32_16x16x64_bf16 v[40:43], v[8:11], a[168:175], v74
  ds_read_b128 v[8:11], v76 offset:6656
  v_add_f32_dpp v72, v46, v44 quad_perm:[2,3,0,1] row_mask:0xf bank_mask:0xf
  v_add_f32_dpp v73, v47, v45 quad_perm:[2,3,0,1] row_mask:0xf bank_mask:0xf
  v_smfmac_f32_16x16x64_bf16 v[36:39], v[12:15], a[144:151], v74
  s_waitcnt lgkmcnt(4)
  v_exp_f32_dpp v72, v72 quad_perm:[0,1,0,1] row_mask:0xf bank_mask:0xf
  v_smfmac_f32_16x16x64_bf16 v[40:43], v[12:15], a[152:159], v74
  ds_read_b128 v[12:15], v76 offset:7680
  v_exp_f32_dpp v73, v73 quad_perm:[0,1,0,1] row_mask:0xf bank_mask:0xf
  v_smfmac_f32_16x16x64_bf16 v[36:39], v[0:3], a[32:39], v74
  s_waitcnt lgkmcnt(2)
  v_cvt_pk_bf16_f32 v72, v72, v73
  v_mfma_f32_16x16x32_bf16 v[20:23], v[20:23], v[60:63], 0
  ds_write_b32 v78, v72 offset:512
  v_mov_b64 v[16:17], 0
  v_mfma_f32_16x16x32_bf16 v[20:23], v[24:27], v[64:67], v[20:23]
  ds_read_b128 v[44:47], v75 offset:16384
  v_mov_b64 v[18:19], 0
  v_smfmac_f32_16x16x64_bf16 v[40:43], v[0:3], a[40:47], v74
  ds_read_b128 v[48:51], v75 offset:17408
  s_waitcnt lgkmcnt(4)
  v_smfmac_f32_16x16x64_bf16 v[36:39], v[4:7], a[48:55], v74
  v_add_f32_dpp v24, v22, v20 quad_perm:[2,3,0,1] row_mask:0xf bank_mask:0xf
  v_add_f32_dpp v25, v23, v21 quad_perm:[2,3,0,1] row_mask:0xf bank_mask:0xf
  v_smfmac_f32_16x16x64_bf16 v[36:39], v[8:11], a[64:71], v74
  s_waitcnt lgkmcnt(2)
  s_barrier
  ds_read_b128 v[32:35], v78 offset:512
  v_smfmac_f32_16x16x64_bf16 v[36:39], v[12:15], a[80:87], v74
  ds_read_b128 v[60:63], v75 offset:18432
  v_mul_f32 v24, s69, v24
  v_smfmac_f32_16x16x64_bf16 v[40:43], v[4:7], a[56:63], v74
  ds_read_b128 v[64:67], v75 offset:19456
  v_mul_f32 v25, s69, v25
  v_smfmac_f32_16x16x64_bf16 v[40:43], v[8:11], a[72:79], v74
  v_exp_f32_dpp v24, v24 quad_perm:[0,1,0,1] row_mask:0xf bank_mask:0xf
  v_smfmac_f32_16x16x64_bf16 v[40:43], v[12:15], a[88:95], v74
  s_waitcnt vmcnt(2) lgkmcnt(2)
  v_exp_f32_dpp v25, v25 quad_perm:[0,1,0,1] row_mask:0xf bank_mask:0xf
  v_mfma_f32_16x16x32_bf16 v[8:11], v[32:35], v[68:71], 0
  v_add_f32 v36, v36, v38
  v_add_f32 v37, v37, v39
  v_mfma_f32_16x16x32_bf16 v[0:3], v[32:35], v[52:55], 0
  v_add_f32 v40, v40, v42
  v_add_f32 v41, v41, v43
  v_mfma_f32_16x16x32_bf16 v[4:7], v[32:35], v[56:59], 0
  v_cvt_pk_bf16_f32 v28, v24, v25
  v_cvt_pk_bf16_f32 v72, v36, v37
  v_cvt_pk_bf16_f32 v73, v40, v41
  v_mfma_f32_16x16x16_bf16 v[8:11], v[28:29], v[68:69], v[8:11]
  v_cvt_pk_bf16_f32 v31, v24, v25
  v_mov_b64 v[20:21], 0
  v_mfma_f32_16x16x16_bf16 v[0:3], v[28:29], v[72:73], v[0:3]
  ds_read_b128 v[68:71], v76 offset:13824
  v_mov_b64 v[22:23], 0
  v_mfma_f32_16x16x16_bf16 v[4:7], v[30:31], v[72:73], v[4:7]
  v_rcp_f32 v10, v8
  v_rcp_f32 v11, v9
  v_mul_f32 v0, v10, v0
  v_mul_f32 v1, v11, v1
  s_nop 0
  v_mul_f32 v4, v10, v4
  v_mul_f32 v5, v11, v5
  v_cvt_pk_bf16_f32 v2, v0, v4
  ds_write_b32 v79, v2 offset:8704
  v_cvt_pk_bf16_f32 v3, v1, v5
  ds_write_b32 v79, v3 offset:9280
  v_max3_f32 v8, v8, v9, v10
  v_max_f32 v8, v8, v11
  v_cmp_le_f32 vcc, 1317011456, v8
  v_mov_b64 v[24:25], 0
  v_mov_b64 v[26:27], 0
  s_cbranch_vccnz Cs0_mx
Cs0_mxok:
  s_waitcnt lgkmcnt(0)
  s_barrier
  ds_read_b128 v[0:3], v78 offset:8704
  ds_read_b128 v[4:7], v78 offset:8768
  ds_read_b128 v[8:11], v78 offset:8832
  ds_read_b128 v[12:15], v78 offset:8896
  s_cmp_eq_u32 s66, 63
  s_cbranch_scc1 Cs0_last
  s_waitcnt lgkmcnt(3)
  v_smfmac_f32_16x16x64_bf16 v[16:19], v[0:3], v[44:51], v74
  ds_read_b128 v[52:55], v75 offset:32768
  s_waitcnt lgkmcnt(3)
  v_smfmac_f32_16x16x64_bf16 v[16:19], v[4:7], v[60:67], v74
  ds_read_b128 v[56:59], v75 offset:33792
  s_waitcnt lgkmcnt(3)
  v_smfmac_f32_16x16x64_bf16 v[16:19], v[8:11], a[176:183], v74
  ds_read_b128 v[36:39], v75 offset:34816
  s_waitcnt lgkmcnt(3)
  v_smfmac_f32_16x16x64_bf16 v[16:19], v[12:15], a[184:191], v74
  ds_read_b128 v[40:43], v75 offset:35840
  ds_read_b128 v[44:47], v75 offset:49152
  v_smfmac_f32_16x16x64_bf16 v[20:23], v[0:3], a[192:199], v74
  ds_read_b128 v[48:51], v75 offset:50176
  ds_read_b128 v[60:63], v75 offset:51200
  v_smfmac_f32_16x16x64_bf16 v[20:23], v[4:7], a[200:207], v74
  ds_read_b128 v[64:67], v75 offset:52224
  s_waitcnt lgkmcnt(6)
  v_cvt_pk_bf16_f32 v16, v16, v17
  v_cvt_pk_bf16_f32 v17, v18, v19
  v_bfi_b32 v16, 1, s72, v16
  v_smfmac_f32_16x16x64_bf16 v[20:23], v[8:11], v[52:59], v74
  buffer_store_dwordx2 v[16:17], v68, s[8:11], s73 offen sc1
  s_waitcnt lgkmcnt(4)
  v_smfmac_f32_16x16x64_bf16 v[20:23], v[12:15], v[36:43], v74
  v_mov_b64 v[32:33], 0
  v_smfmac_f32_16x16x64_bf16 v[24:27], v[0:3], a[208:215], v74
  v_mov_b64 v[34:35], 0
  v_smfmac_f32_16x16x64_bf16 v[24:27], v[4:7], a[216:223], v74
  s_waitcnt lgkmcnt(2)
  v_cvt_pk_bf16_f32 v20, v20, v21
  v_cvt_pk_bf16_f32 v21, v22, v23
  v_bfi_b32 v20, 1, s72, v20
  v_smfmac_f32_16x16x64_bf16 v[24:27], v[8:11], v[44:51], v74
  buffer_store_dwordx2 v[20:21], v68, s[8:11], s74 offen sc1
  s_waitcnt lgkmcnt(0)
  v_smfmac_f32_16x16x64_bf16 v[24:27], v[12:15], v[60:67], v74
  v_smfmac_f32_16x16x64_bf16 v[32:35], v[0:3], a[224:231], v74
  v_smfmac_f32_16x16x64_bf16 v[32:35], v[4:7], a[232:239], v74
  v_cvt_pk_bf16_f32 v24, v24, v25
  v_cvt_pk_bf16_f32 v25, v26, v27
  v_bfi_b32 v24, 1, s72, v24
  v_smfmac_f32_16x16x64_bf16 v[32:35], v[8:11], a[240:247], v74
  s_nop 1
  buffer_store_dwordx2 v[24:25], v68, s[8:11], s75 offen sc1
  v_smfmac_f32_16x16x64_bf16 v[32:35], v[12:15], a[248:255], v74
  ds_read_b128 v[0:3], v76 offset:14848
  ds_read_b64 v[16:17], v77 offset:256
  v_mov_b64 v[18:19], v[72:73]
  v_xor_b32 v75, 0x8000, v75
  s_nop 3
  v_cvt_pk_bf16_f32 v32, v32, v33
  v_cvt_pk_bf16_f32 v33, v34, v35
  v_bfi_b32 v32, 1, s72, v32
  buffer_store_dwordx2 v[32:33], v68, s[8:11], s76 offen sc1
  v_mov_b64 v[20:21], 0
  v_mov_b64 v[22:23], 0
  v_mov_b64 v[24:25], 0
  v_mov_b64 v[26:27], 0
  v_mov_b64 v[28:29], 0
  v_mov_b64 v[30:31], 0
  v_mov_b64 v[32:33], 0
  v_mov_b64 v[34:35], 0
  s_add_u32 s58, s58, 655360
  s_add_u32 s59, s59, 655360
  s_add_u32 s70, s70, 655360
  s_add_u32 s68, s68, 655360
  s_add_u32 s66, s66, 1
  s_xor_b32 s64, s64, 16384
  s_xor_b32 s65, s65, 16384
  s_nop 15
  s_nop 3
  buffer_load_dwordx4 v[52:55], v76, s[8:11], s60 offen offset:0 sc1
  buffer_load_dwordx4 v[56:59], v76, s[8:11], s60 offen offset:1024 sc1
  s_nop 15
  s_nop 11
  buffer_load_dwordx4 v[36:39], v76, s[8:11], s60 offen offset:0 sc1
  buffer_load_dwordx4 v[40:43], v76, s[8:11], s60 offen offset:1024 sc1
  s_waitcnt lgkmcnt(0)
  s_waitcnt vmcnt(3)
  v_mfma_f32_16x16x32_bf16 v[4:7], v[0:3], v[52:55], 0
  v_bitop3_b32 v72, v52, v54, s72 bitop3:0x7e
  s_waitcnt vmcnt(2)
  v_mfma_f32_16x16x32_bf16 v[4:7], v[0:3], v[56:59], v[4:7]
  v_bitop3_b32 v73, v56, v58, s72 bitop3:0x7e
  v_bitop3_b32 v72, v72, v73, 1 bitop3:0xa8
  v_cmp_ne_u32 vcc, 0, v72
  s_cbranch_vccnz Cs0_h1r
  s_nop 2
  v_add_f32_dpp v4, v4, v4 row_ror:4 row_mask:0xf bank_mask:0xf
  v_add_f32_dpp v5, v5, v5 row_ror:4 row_mask:0xf bank_mask:0xf
  s_nop 0
  v_add_f32_dpp v4, v4, v4 row_ror:8 row_mask:0xf bank_mask:0xf
  v_add_f32_dpp v5, v5, v5 row_ror:8 row_mask:0xf bank_mask:0xf
  v_cvt_pk_bf16_f32 v4, v4, v5
  buffer_store_dword v4, v69, s[8:11], s62 offen sc1
  s_xor_b32 s62, s62, 16384
  buffer_store_dword v71, v69, s[8:11], s62 offen sc1
  s_xor_b32 s72, s72, 1
  s_branch Cs0_h2
Cs0_h1r:
  s_mov_b64 exec, vcc
  buffer_load_dwordx4 v[52:55], v76, s[8:11], s60 offen offset:0 sc1
  buffer_load_dwordx4 v[56:59], v76, s[8:11], s60 offen offset:1024 sc1
  s_mov_b64 exec, -1
  s_add_u32 s67, s67, 1
  s_waitcnt vmcnt(3)
  v_mfma_f32_16x16x32_bf16 v[4:7], v[0:3], v[36:39], 0
  v_bitop3_b32 v72, v36, v38, s72 bitop3:0x7e
  s_waitcnt vmcnt(2)
  v_mfma_f32_16x16x32_bf16 v[4:7], v[0:3], v[40:43], v[4:7]
  v_bitop3_b32 v73, v40, v42, s72 bitop3:0x7e
  v_bitop3_b32 v72, v72, v73, 1 bitop3:0xa8
  v_cmp_ne_u32 vcc, 0, v72
  s_cbranch_vccz Cs0_h1p
  s_mov_b64 exec, vcc
  buffer_load_dwordx4 v[36:39], v76, s[8:11], s60 offen offset:0 sc1
  buffer_load_dwordx4 v[40:43], v76, s[8:11], s60 offen offset:1024 sc1
  s_mov_b64 exec, -1
  s_add_u32 s67, s67, 1
  s_waitcnt vmcnt(3)
  v_mfma_f32_16x16x32_bf16 v[4:7], v[0:3], v[52:55], 0
  v_bitop3_b32 v72, v52, v54, s72 bitop3:0x7e
  s_waitcnt vmcnt(2)
  v_mfma_f32_16x16x32_bf16 v[4:7], v[0:3], v[56:59], v[4:7]
  v_bitop3_b32 v73, v56, v58, s72 bitop3:0x7e
  v_bitop3_b32 v72, v72, v73, 1 bitop3:0xa8
  v_cmp_ne_u32 vcc, 0, v72
  s_cbranch_vccz Cs0_h1p
Cs0_h1s:
  s_mov_b64 exec, vcc
  buffer_load_dwordx4 v[52:55], v76, s[8:11], s60 offen offset:0 sc1
  buffer_load_dwordx4 v[56:59], v76, s[8:11], s60 offen offset:1024 sc1
  s_mov_b64 exec, -1
  s_add_u32 s67, s67, 1
  s_waitcnt vmcnt(3)
  v_mfma_f32_16x16x32_bf16 v[4:7], v[0:3], v[36:39], 0
  v_bitop3_b32 v72, v36, v38, s72 bitop3:0x7e
  s_waitcnt vmcnt(2)
  v_mfma_f32_16x16x32_bf16 v[4:7], v[0:3], v[40:43], v[4:7]
  v_bitop3_b32 v73, v40, v42, s72 bitop3:0x7e
  v_bitop3_b32 v72, v72, v73, 1 bitop3:0xa8
  v_cmp_ne_u32 vcc, 0, v72
  s_cbranch_vccz Cs0_h1p
  s_mov_b64 exec, vcc
  buffer_load_dwordx4 v[36:39], v76, s[8:11], s60 offen offset:0 sc1
  buffer_load_dwordx4 v[40:43], v76, s[8:11], s60 offen offset:1024 sc1
  s_mov_b64 exec, -1
  s_add_u32 s67, s67, 1
  s_waitcnt vmcnt(3)
  v_mfma_f32_16x16x32_bf16 v[4:7], v[0:3], v[52:55], 0
  v_bitop3_b32 v72, v52, v54, s72 bitop3:0x7e
  s_waitcnt vmcnt(2)
  v_mfma_f32_16x16x32_bf16 v[4:7], v[0:3], v[56:59], v[4:7]
  v_bitop3_b32 v73, v56, v58, s72 bitop3:0x7e
  v_bitop3_b32 v72, v72, v73, 1 bitop3:0xa8
  v_cmp_ne_u32 vcc, 0, v72
  s_cbranch_vccz Cs0_h1p
  s_cmp_lt_u32 s67, 131072
  s_cbranch_scc1 Cs0_h1s
Cs0_h1p:
  s_nop 2
  v_add_f32_dpp v4, v4, v4 row_ror:4 row_mask:0xf bank_mask:0xf
  v_add_f32_dpp v5, v5, v5 row_ror:4 row_mask:0xf bank_mask:0xf
  s_nop 0
  v_add_f32_dpp v4, v4, v4 row_ror:8 row_mask:0xf bank_mask:0xf
  v_add_f32_dpp v5, v5, v5 row_ror:8 row_mask:0xf bank_mask:0xf
  v_cvt_pk_bf16_f32 v4, v4, v5
  buffer_store_dword v4, v69, s[8:11], s62 offen sc1
  s_xor_b32 s62, s62, 16384
  buffer_store_dword v71, v69, s[8:11], s62 offen sc1
  s_xor_b32 s72, s72, 1
  s_branch Cs0_h2
Cs0_h2r:
  s_mov_b64 exec, vcc
  buffer_load_dwordx4 v[52:55], v76, s[8:11], s65 offen offset:0 sc1
  buffer_load_dwordx4 v[56:59], v76, s[8:11], s65 offen offset:1024 sc1
  s_mov_b64 exec, -1
  s_add_u32 s67, s67, 1
  s_waitcnt vmcnt(4)
  v_max3_u32 v72, v52, v53, v54
  v_max3_u32 v72, v72, v55, v56
  v_max3_u32 v72, v72, v57, v58
  v_max_u32 v72, v72, v59
  ds_write_b128 v76, v[52:55] offset:4608
  ds_write_b128 v76, v[56:59] offset:5632
  v_cmp_eq_u32 vcc, -1, v72
  s_cbranch_vccz Cs0_h2w
  s_mov_b64 exec, vcc
  buffer_load_dwordx4 v[52:55], v76, s[8:11], s65 offen offset:0 sc1
  buffer_load_dwordx4 v[56:59], v76, s[8:11], s65 offen offset:1024 sc1
  s_mov_b64 exec, -1
  s_add_u32 s67, s67, 1
  s_waitcnt vmcnt(4)
  v_max3_u32 v72, v52, v53, v54
  v_max3_u32 v72, v72, v55, v56
  v_max3_u32 v72, v72, v57, v58
  v_max_u32 v72, v72, v59
  ds_write_b128 v76, v[52:55] offset:4608
  ds_write_b128 v76, v[56:59] offset:5632
  v_cmp_eq_u32 vcc, -1, v72
  s_cbranch_vccz Cs0_h2w
  s_mov_b64 exec, vcc
  buffer_load_dwordx4 v[52:55], v76, s[8:11], s65 offen offset:0 sc1
  buffer_load_dwordx4 v[56:59], v76, s[8:11], s65 offen offset:1024 sc1
  s_mov_b64 exec, -1
  s_add_u32 s67, s67, 1
  s_waitcnt vmcnt(4)
  v_max3_u32 v72, v52, v53, v54
  v_max3_u32 v72, v72, v55, v56
  v_max3_u32 v72, v72, v57, v58
  v_max_u32 v72, v72, v59
  ds_write_b128 v76, v[52:55] offset:4608
  ds_write_b128 v76, v[56:59] offset:5632
  v_cmp_eq_u32 vcc, -1, v72
  s_cbranch_vccz Cs0_h2w
  s_mov_b64 exec, vcc
  buffer_load_dwordx4 v[52:55], v76, s[8:11], s65 offen offset:0 sc1
  buffer_load_dwordx4 v[56:59], v76, s[8:11], s65 offen offset:1024 sc1
  s_mov_b64 exec, -1
  s_add_u32 s67, s67, 1
  s_waitcnt vmcnt(4)
  v_max3_u32 v72, v52, v53, v54
  v_max3_u32 v72, v72, v55, v56
  v_max3_u32 v72, v72, v57, v58
  v_max_u32 v72, v72, v59
  ds_write_b128 v76, v[52:55] offset:4608
  ds_write_b128 v76, v[56:59] offset:5632
  v_cmp_eq_u32 vcc, -1, v72
  s_cbranch_vccz Cs0_h2w
  s_cmp_lt_u32 s67, 131072
  s_cbranch_scc1 Cs0_h2r
Cs0_h2ok:
  ds_write_b128 v76, v[52:55] offset:4608
  ds_write_b128 v76, v[56:59] offset:5632
  s_branch Cs0_h2w
Cs0_rec:
  s_nop 7
  s_waitcnt vmcnt(0) lgkmcnt(0)
  v_max3_u32 v72, v0, v1, v2
  v_max3_u32 v72, v72, v3, v4
  v_max3_u32 v72, v72, v5, v6
  v_max3_u32 v72, v72, v7, v8
  v_max3_u32 v72, v72, v9, v10
  v_max3_u32 v72, v72, v11, v12
  v_max3_u32 v72, v72, v13, v14
  v_max3_u32 v72, v72, v15, v16
  v_max3_u32 v72, v72, v17, v18
  v_max_u32 v72, v72, v19
  v_cmp_eq_u32 vcc, -1, v72
  s_cbranch_vccz Cs0_recok
  s_barrier
  v_mov_b64 v[20:21], 0
  v_mov_b64 v[22:23], 0
  v_mov_b64 v[24:25], 0
  v_mov_b64 v[26:27], 0
  v_mov_b64 v[28:29], 0
  v_mov_b64 v[30:31], 0
  v_mov_b64 v[32:33], 0
  v_mov_b64 v[34:35], 0
  s_waitcnt lgkmcnt(0)
  s_barrier
  ds_read_b128 v[0:3], v76 offset:4608
  ds_read_b128 v[60:63], v76 offset:16384
  ds_read_b128 v[64:67], v76 offset:17408
  s_waitcnt lgkmcnt(0)
  v_smfmac_f32_16x16x64_bf16 v[20:23], v[0:3], v[60:67], v74
  ds_read_b128 v[60:63], v76 offset:18432
  ds_read_b128 v[64:67], v76 offset:19456
  s_waitcnt lgkmcnt(0)
  v_smfmac_f32_16x16x64_bf16 v[24:27], v[0:3], v[60:67], v74
  ds_read_b128 v[60:63], v76 offset:32768
  ds_read_b128 v[64:67], v76 offset:33792
  s_waitcnt lgkmcnt(0)
  v_smfmac_f32_16x16x64_bf16 v[28:31], v[0:3], v[60:67], v74
  ds_read_b128 v[60:63], v76 offset:34816
  ds_read_b128 v[64:67], v76 offset:35840
  s_waitcnt lgkmcnt(0)
  v_smfmac_f32_16x16x64_bf16 v[32:35], v[0:3], v[60:67], v74
  ds_read_b128 v[4:7], v76 offset:5632
  s_waitcnt lgkmcnt(0)
  v_smfmac_f32_16x16x64_bf16 v[20:23], v[4:7], v[80:87], v74
  v_smfmac_f32_16x16x64_bf16 v[24:27], v[4:7], v[88:95], v74
  v_smfmac_f32_16x16x64_bf16 v[28:31], v[4:7], v[208:215], v74
  v_smfmac_f32_16x16x64_bf16 v[32:35], v[4:7], v[216:223], v74
  ds_read_b128 v[8:11], v76 offset:6656
  s_waitcnt lgkmcnt(0)
  v_smfmac_f32_16x16x64_bf16 v[20:23], v[8:11], v[96:103], v74
  v_smfmac_f32_16x16x64_bf16 v[24:27], v[8:11], v[104:111], v74
  ds_read_b128 v[60:63], v76 offset:49152
  ds_read_b128 v[64:67], v76 offset:50176
  s_waitcnt lgkmcnt(0)
  v_smfmac_f32_16x16x64_bf16 v[28:31], v[8:11], v[60:67], v74
  ds_read_b128 v[60:63], v76 offset:51200
  ds_read_b128 v[64:67], v76 offset:52224
  s_waitcnt lgkmcnt(0)
  v_smfmac_f32_16x16x64_bf16 v[32:35], v[8:11], v[60:67], v74
  ds_read_b128 v[12:15], v76 offset:7680
  s_waitcnt lgkmcnt(0)
  v_smfmac_f32_16x16x64_bf16 v[20:23], v[12:15], v[112:119], v74
  v_smfmac_f32_16x16x64_bf16 v[24:27], v[12:15], v[120:127], v74
  v_smfmac_f32_16x16x64_bf16 v[28:31], v[12:15], v[224:231], v74
  v_smfmac_f32_16x16x64_bf16 v[32:35], v[12:15], v[232:239], v74
  ds_read_b128 v[0:3], v76 offset:8704
  s_waitcnt lgkmcnt(0)
  v_smfmac_f32_16x16x64_bf16 v[20:23], v[0:3], v[128:135], v74
  v_smfmac_f32_16x16x64_bf16 v[24:27], v[0:3], v[136:143], v74
  ds_read_b128 v[60:63], v75 offset:0
  ds_read_b128 v[64:67], v75 offset:1024
  s_waitcnt lgkmcnt(0)
  v_smfmac_f32_16x16x64_bf16 v[28:31], v[0:3], v[60:67], v74
  ds_read_b128 v[60:63], v75 offset:2048
  ds_read_b128 v[64:67], v75 offset:3072
  s_waitcnt lgkmcnt(0)
  v_smfmac_f32_16x16x64_bf16 v[32:35], v[0:3], v[60:67], v74
  ds_read_b128 v[4:7], v76 offset:9728
  s_waitcnt lgkmcnt(0)
  v_smfmac_f32_16x16x64_bf16 v[20:23], v[4:7], v[144:151], v74
  v_smfmac_f32_16x16x64_bf16 v[24:27], v[4:7], v[152:159], v74
  ds_read_b128 v[60:63], v75 offset:16384
  ds_read_b128 v[64:67], v75 offset:17408
  s_waitcnt lgkmcnt(0)
  v_smfmac_f32_16x16x64_bf16 v[28:31], v[4:7], v[60:67], v74
  ds_read_b128 v[60:63], v75 offset:18432
  ds_read_b128 v[64:67], v75 offset:19456
  s_waitcnt lgkmcnt(0)
  v_smfmac_f32_16x16x64_bf16 v[32:35], v[4:7], v[60:67], v74
  ds_read_b128 v[16:19], v76 offset:10752
  s_waitcnt lgkmcnt(0)
  v_smfmac_f32_16x16x64_bf16 v[20:23], v[16:19], v[160:167], v74
  v_smfmac_f32_16x16x64_bf16 v[24:27], v[16:19], v[168:175], v74
  v_smfmac_f32_16x16x64_bf16 v[28:31], v[16:19], v[240:247], v74
  v_smfmac_f32_16x16x64_bf16 v[32:35], v[16:19], v[248:255], v74
  ds_read_b128 v[12:15], v76 offset:11776
  s_waitcnt lgkmcnt(0)
  v_smfmac_f32_16x16x64_bf16 v[20:23], v[12:15], v[176:183], v74
  v_smfmac_f32_16x16x64_bf16 v[24:27], v[12:15], v[184:191], v74
  v_smfmac_f32_16x16x64_bf16 v[28:31], v[12:15], a[0:7], v74
  v_smfmac_f32_16x16x64_bf16 v[32:35], v[12:15], a[8:15], v74
  ds_read_b128 v[8:11], v76 offset:12800
  s_waitcnt lgkmcnt(0)
  v_smfmac_f32_16x16x64_bf16 v[20:23], v[8:11], v[192:199], v74
  v_smfmac_f32_16x16x64_bf16 v[24:27], v[8:11], v[200:207], v74
  v_smfmac_f32_16x16x64_bf16 v[28:31], v[8:11], a[16:23], v74
  v_smfmac_f32_16x16x64_bf16 v[32:35], v[8:11], a[24:31], v74
  v_add_f32 v20, v20, v22
  v_add_f32 v21, v21, v23
  v_add_f32 v24, v24, v26
  v_cvt_pk_bf16_f32 v22, v20, v24
  s_nop 0
  ds_write_b32 v79, v22 offset:0
  v_add_f32 v25, v25, v27
  v_cvt_pk_bf16_f32 v23, v21, v25
  ds_write_b32 v79, v23 offset:576
  v_add_f32 v28, v28, v30
  v_add_f32 v29, v29, v31
  s_waitcnt lgkmcnt(0)
  s_nop 1
  s_branch Cs0_recok
Cs0_mx:
  s_waitcnt lgkmcnt(0)
  s_barrier
  buffer_load_dwordx4 v[0:3], v76, s[8:11], s58 offen offset:0 sc1
  ds_read_b128 v[20:23], v77 offset:0
  ds_read_b128 v[28:31], v77 offset:256
  buffer_load_dwordx4 v[4:7], v76, s[8:11], s58 offen offset:1024 sc1
  ds_read_b128 v[24:27], v77 offset:128
  ds_read_b128 v[32:35], v77 offset:384
  s_waitcnt vmcnt(1) lgkmcnt(3)
  v_mfma_f32_16x16x32_bf16 v[8:11], v[0:3], v[20:23], 0
  s_waitcnt vmcnt(0) lgkmcnt(1)
  v_mfma_f32_16x16x32_bf16 v[8:11], v[4:7], v[24:27], v[8:11]
  v_mfma_f32_16x16x32_bf16 v[12:15], v[28:31], v[20:23], 0
  s_waitcnt lgkmcnt(0)
  v_mfma_f32_16x16x32_bf16 v[12:15], v[32:35], v[24:27], v[12:15]
  v_add_f32_dpp v8, v10, v8 quad_perm:[2,3,0,1] row_mask:0xf bank_mask:0xf
  v_add_f32_dpp v9, v11, v9 quad_perm:[2,3,0,1] row_mask:0xf bank_mask:0xf
  s_nop 0
  v_mov_b32_dpp v8, v8 quad_perm:[0,1,0,1] row_mask:0xf bank_mask:0xf
  v_mov_b32_dpp v9, v9 quad_perm:[0,1,0,1] row_mask:0xf bank_mask:0xf
  s_nop 1
  v_add_f32_dpp v12, v14, v12 quad_perm:[2,3,0,1] row_mask:0xf bank_mask:0xf
  v_add_f32_dpp v13, v15, v13 quad_perm:[2,3,0,1] row_mask:0xf bank_mask:0xf
  s_nop 0
  v_mov_b32_dpp v12, v12 quad_perm:[0,1,0,1] row_mask:0xf bank_mask:0xf
  v_mov_b32_dpp v13, v13 quad_perm:[0,1,0,1] row_mask:0xf bank_mask:0xf
  v_mul_f32 v12, s69, v12
  ds_write_b32 v78, v8 offset:8704
  v_mul_f32 v13, s69, v13
  ds_write_b32 v78, v9 offset:8768
  s_waitcnt lgkmcnt(0)
  s_barrier
  ds_read_b128 v[36:39], v78 offset:8704
  ds_read_b128 v[40:43], v78 offset:8768
  s_waitcnt lgkmcnt(0)
  s_barrier
  v_max_f32 v16, v36, v37
  v_max3_f32 v16, v16, v38, v39
  v_max3_f32 v16, v16, v40, v41
  v_max3_f32 v16, v16, v42, v43
  v_max3_f32 v16, v16, v12, v13
  v_mov_b32 v17, v16
  s_nop 1
  v_permlane16_swap_b32 v16, v17
  v_max_f32 v16, v16, v17
  v_mov_b32 v17, v16
  s_nop 1
  v_permlane32_swap_b32 v16, v17
  v_max_f32 v16, v16, v17
  v_sub_f32 v36, v36, v16
  v_sub_f32 v37, v37, v16
  v_sub_f32 v38, v38, v16
  v_sub_f32 v39, v39, v16
  v_sub_f32 v40, v40, v16
  v_sub_f32 v41, v41, v16
  v_sub_f32 v42, v42, v16
  v_sub_f32 v43, v43, v16
  v_sub_f32 v12, v12, v16
  v_sub_f32 v13, v13, v16
  v_exp_f32 v36, v36
  v_exp_f32 v37, v37
  v_exp_f32 v38, v38
  v_exp_f32 v39, v39
  v_exp_f32 v40, v40
  v_exp_f32 v41, v41
  v_exp_f32 v42, v42
  v_exp_f32 v43, v43
  v_exp_f32 v12, v12
  v_exp_f32 v13, v13
  v_cvt_pk_bf16_f32 v32, v36, v40
  v_cvt_pk_bf16_f32 v33, v37, v41
  v_cvt_pk_bf16_f32 v34, v38, v42
  v_cvt_pk_bf16_f32 v35, v39, v43
  v_cvt_pk_bf16_f32 v28, v12, v13
  v_cvt_pk_bf16_f32 v31, v12, v13
  v_mov_b32 v29, 0
  v_mov_b32 v30, 0
  v_mov_b32 v68, 0x3f803f80
  v_mov_b32 v69, 0x3f803f80
  v_mov_b32 v70, 0x3f803f80
  v_mov_b32 v71, 0x3f803f80
  s_nop 1
  v_mfma_f32_16x16x32_bf16 v[8:11], v[32:35], v[68:71], 0
  v_mfma_f32_16x16x32_bf16 v[0:3], v[32:35], v[52:55], 0
  v_mfma_f32_16x16x32_bf16 v[4:7], v[32:35], v[56:59], 0
  v_mfma_f32_16x16x16_bf16 v[8:11], v[28:29], v[68:69], v[8:11]
  v_mfma_f32_16x16x16_bf16 v[0:3], v[28:29], v[72:73], v[0:3]
  v_mfma_f32_16x16x16_bf16 v[4:7], v[30:31], v[72:73], v[4:7]
  ds_read_b128 v[68:71], v76 offset:13824
  v_rcp_f32 v10, v8
  v_rcp_f32 v11, v9
  v_mul_f32 v0, v10, v0
  v_mul_f32 v1, v11, v1
  s_nop 0
  v_mul_f32 v4, v10, v4
  v_mul_f32 v5, v11, v5
  v_cvt_pk_bf16_f32 v2, v0, v4
  ds_write_b32 v79, v2 offset:8704
  v_cvt_pk_bf16_f32 v3, v1, v5
  ds_write_b32 v79, v3 offset:9280
  v_mov_b64 v[16:17], 0
  v_mov_b64 v[18:19], 0
  v_mov_b64 v[20:21], 0
  v_mov_b64 v[22:23], 0
  v_mov_b64 v[24:25], 0
  v_mov_b64 v[26:27], 0
  s_branch Cs0_mxok
Cs0_last:
  s_waitcnt lgkmcnt(0)
  ds_read_b64 v[16:17], v77 offset:256
  v_mov_b64 v[18:19], v[72:73]
  s_add_u32 s68, s68, 655360
  s_waitcnt lgkmcnt(0)
  buffer_store_dwordx4 v[16:19], v76, s[8:11], s68 offen sc1
  s_branch L_cexit
L_w5:
  v_mov_b64 v[20:21], 0
  v_mov_b64 v[22:23], 0
  v_mov_b64 v[24:25], 0
  v_mov_b64 v[26:27], 0
  v_mov_b64 v[28:29], 0
  v_mov_b64 v[30:31], 0
  v_mov_b64 v[32:33], 0
  v_mov_b64 v[34:35], 0
  s_mov_b32 s78, 0x3f803f80
  s_mov_b32 s79, s78
  s_mov_b32 s65, 360448
  s_mov_b32 m0, 15872
  v_lshlrev_b32 v73, 2, v76
  v_mov_b32 v72, 0
  ds_read_b128 v[60:63], v76 offset:20480
  ds_read_b128 v[64:67], v76 offset:21504
  ds_read_b128 v[44:47], v76 offset:22528
  ds_read_b128 v[48:51], v76 offset:23552
  ds_read_b128 v[36:39], v76 offset:36864
  ds_read_b128 v[40:43], v76 offset:37888
  ds_read_b128 v[0:3], v76 offset:4608
  ds_read_b128 v[4:7], v76 offset:5632
  s_branch Cs1_top2
.p2align 6
Cs1_h2:
  v_lshlrev_b32 v73, 2, v76
  s_nop 15
  s_nop 11
  buffer_load_dwordx4 v[52:55], v76, s[8:11], s65 offen offset:2048 sc1
  s_nop 15
  s_nop 3
  buffer_load_dwordx4 v[52:55], v76, s[8:11], s65 offen offset:2048 sc1
  s_nop 15
  s_nop 3
  buffer_load_dwordx4 v[52:55], v76, s[8:11], s65 offen offset:2048 sc1
  s_waitcnt vmcnt(5)
  ds_read_b128 v[60:63], v76 offset:20480
  ds_read_b128 v[64:67], v76 offset:21504
  ds_read_b128 v[44:47], v76 offset:22528
  ds_read_b128 v[48:51], v76 offset:23552
  ds_read_b128 v[36:39], v76 offset:36864
  ds_read_b128 v[40:43], v76 offset:37888
  s_waitcnt vmcnt(2)
  v_max3_u32 v72, v52, v53, v54
  v_max_u32 v72, v72, v55
  ds_write_b128 v76, v[52:55] offset:6656
  v_cmp_eq_u32 vcc, -1, v72
  s_cbranch_vccnz Cs1_h2r
Cs1_h2w:
  s_waitcnt lgkmcnt(0)
  s_barrier
  ds_read_b128 v[0:3], v76 offset:4608
  ds_read_b128 v[4:7], v76 offset:5632
Cs1_top2:
  ds_read_b128 v[8:11], v76 offset:6656
  s_waitcnt lgkmcnt(2)
  v_smfmac_f32_16x16x64_bf16 v[20:23], v[0:3], v[60:67], v74
  ds_read_b128 v[60:63], v76 offset:38912
  v_smfmac_f32_16x16x64_bf16 v[24:27], v[0:3], v[44:51], v74
  buffer_load_dwordx4 v[44:47], v76, s[8:11], s58 offen offset:0 sc1
  ds_read_b128 v[64:67], v76 offset:39936
  s_waitcnt lgkmcnt(3)
  v_smfmac_f32_16x16x64_bf16 v[20:23], v[4:7], v[80:87], v74
  buffer_load_dwordx4 v[48:51], v76, s[8:11], s58 offen offset:1024 sc1
  v_smfmac_f32_16x16x64_bf16 v[28:31], v[0:3], v[36:43], v74
  buffer_load_dwordx4 v[52:55], v76, s[8:11], s59 offen offset:0 sc1
  ds_read_b128 v[36:39], v76 offset:53248
  v_smfmac_f32_16x16x64_bf16 v[24:27], v[4:7], v[88:95], v74
  buffer_load_dwordx4 v[56:59], v76, s[8:11], s59 offen offset:1024 sc1
  ds_read_b128 v[40:43], v76 offset:54272
  v_smfmac_f32_16x16x64_bf16 v[28:31], v[4:7], v[208:215], v74
  ds_read_b128 v[12:15], v76 offset:7680
  s_waitcnt lgkmcnt(5)
  v_smfmac_f32_16x16x64_bf16 v[32:35], v[4:7], v[216:223], v74
  buffer_store_dwordx4 v[16:19], v76, s[8:11], s68 offen sc1
  s_waitcnt lgkmcnt(3)
  v_smfmac_f32_16x16x64_bf16 v[32:35], v[0:3], v[60:67], v74
  buffer_load_dword v73, s[8:11], s70 offen  lds
  v_smfmac_f32_16x16x64_bf16 v[20:23], v[8:11], v[96:103], v74
  ds_read_b128 v[60:63], v76 offset:55296
  v_smfmac_f32_16x16x64_bf16 v[24:27], v[8:11], v[104:111], v74
  ds_read_b128 v[64:67], v76 offset:56320
  s_waitcnt lgkmcnt(3)
  v_smfmac_f32_16x16x64_bf16 v[28:31], v[8:11], v[36:43], v74
  ds_read_b128 v[36:39], v75 offset:4096
  s_waitcnt lgkmcnt(3)
  v_smfmac_f32_16x16x64_bf16 v[20:23], v[12:15], v[112:119], v74
  ds_read_b128 v[40:43], v75 offset:5120
  v_smfmac_f32_16x16x64_bf16 v[24:27], v[12:15], v[120:127], v74
  v_smfmac_f32_16x16x64_bf16 v[28:31], v[12:15], v[224:231], v74
  s_barrier
  ds_read_b128 v[0:3], v76 offset:8704
  v_smfmac_f32_16x16x64_bf16 v[32:35], v[12:15], v[232:239], v74
  ds_read_b128 v[4:7], v76 offset:9728
  s_waitcnt lgkmcnt(4)
  v_smfmac_f32_16x16x64_bf16 v[32:35], v[8:11], v[60:67], v74
  ds_read_b128 v[60:63], v75 offset:6144
  s_waitcnt lgkmcnt(2)
  v_smfmac_f32_16x16x64_bf16 v[20:23], v[0:3], v[128:135], v74
  ds_read_b128 v[16:19], v76 offset:10752
  v_smfmac_f32_16x16x64_bf16 v[24:27], v[0:3], v[136:143], v74
  ds_read_b128 v[64:67], v75 offset:7168
  v_smfmac_f32_16x16x64_bf16 v[28:31], v[0:3], v[36:43], v74
  ds_read_b128 v[36:39], v75 offset:20480
  s_waitcnt lgkmcnt(4)
  v_smfmac_f32_16x16x64_bf16 v[20:23], v[4:7], v[144:151], v74
  ds_read_b128 v[12:15], v76 offset:11776
  v_smfmac_f32_16x16x64_bf16 v[24:27], v[4:7], v[152:159], v74
  ds_read_b128 v[40:43], v75 offset:21504
  s_waitcnt lgkmcnt(4)
  v_smfmac_f32_16x16x64_bf16 v[20:23], v[16:19], v[160:167], v74
  ds_read_b128 v[8:11], v76 offset:12800
  s_waitcnt lgkmcnt(4)
  v_smfmac_f32_16x16x64_bf16 v[32:35], v[0:3], v[60:67], v74
  ds_read_b128 v[60:63], v75 offset:22528
  v_mov_b64 v[68:69], s[78:79]
  v_smfmac_f32_16x16x64_bf16 v[24:27], v[16:19], v[168:175], v74
  ds_read_b128 v[64:67], v75 offset:23552
  s_waitcnt lgkmcnt(4)
  v_smfmac_f32_16x16x64_bf16 v[20:23], v[12:15], v[176:183], v74
  s_waitcnt lgkmcnt(3)
  v_mov_b64 v[70:71], s[78:79]
  v_smfmac_f32_16x16x64_bf16 v[28:31], v[4:7], v[36:43], v74
  s_waitcnt lgkmcnt(2)
  v_mov_b64 v[36:37], 0
  v_smfmac_f32_16x16x64_bf16 v[20:23], v[8:11], v[192:199], v74
  v_mov_b64 v[38:39], 0
  v_smfmac_f32_16x16x64_bf16 v[24:27], v[12:15], v[184:191], v74
  v_mov_b64 v[40:41], 0
  v_smfmac_f32_16x16x64_bf16 v[24:27], v[8:11], v[200:207], v74
  s_waitcnt lgkmcnt(0)
  v_add_f32 v20, v20, v22
  v_smfmac_f32_16x16x64_bf16 v[32:35], v[4:7], v[60:67], v74
  v_add_f32 v21, v21, v23
  v_smfmac_f32_16x16x64_bf16 v[28:31], v[16:19], v[240:247], v74
  v_add_f32 v24, v24, v26
  v_cvt_pk_bf16_f32 v22, v20, v24
  v_smfmac_f32_16x16x64_bf16 v[28:31], v[12:15], a[0:7], v74
  ds_write_b32 v79, v22 offset:0
  v_add_f32 v25, v25, v27
  v_cvt_pk_bf16_f32 v23, v21, v25
  v_smfmac_f32_16x16x64_bf16 v[28:31], v[8:11], a[16:23], v74
  ds_write_b32 v79, v23 offset:576
  v_cmp_u_f32 vcc, v20, v21
  v_smfmac_f32_16x16x64_bf16 v[32:35], v[16:19], v[248:255], v74
  v_mov_b64 v[42:43], 0
  v_smfmac_f32_16x16x64_bf16 v[32:35], v[12:15], a[8:15], v74
  v_add_f32 v28, v28, v30
  v_add_f32 v29, v29, v31
  v_smfmac_f32_16x16x64_bf16 v[32:35], v[8:11], a[24:31], v74
  s_cbranch_vccnz Cs1_rec
Cs1_recok:
  v_smfmac_f32_16x16x64_bf16 v[36:39], v[16:19], a[128:135], v74
  s_waitcnt lgkmcnt(0)
  s_barrier
  ds_read_b128 v[60:63], v77
  v_smfmac_f32_16x16x64_bf16 v[40:43], v[16:19], a[136:143], v74
  ds_read_b128 v[64:67], v77 offset:128
  v_add_f32 v32, v32, v34
  v_cvt_pk_bf16_f32 v30, v28, v32
  v_smfmac_f32_16x16x64_bf16 v[36:39], v[0:3], a[96:103], v74
  ds_write_b32 v79, v30 offset:256
  v_add_f32 v33, v33, v35
  v_cvt_pk_bf16_f32 v31, v29, v33
  v_smfmac_f32_16x16x64_bf16 v[40:43], v[0:3], a[104:111], v74
  ds_write_b32 v79, v31 offset:832
  v_xor_b32 v75, 0x8000, v75
  v_smfmac_f32_16x16x64_bf16 v[36:39], v[4:7], a[112:119], v74
  ds_read_b128 v[0:3], v76 offset:4608
  v_mov_b32 v29, 0
  v_smfmac_f32_16x16x64_bf16 v[40:43], v[4:7], a[120:127], v74
  s_waitcnt vmcnt(4) lgkmcnt(3)
  v_mov_b32 v30, 0
  v_mfma_f32_16x16x32_bf16 v[44:47], v[44:47], v[60:63], 0
  ds_read_b128 v[4:7], v76 offset:5632
  s_waitcnt lgkmcnt(2)
  v_mfma_f32_16x16x32_bf16 v[44:47], v[48:51], v[64:67], v[44:47]
  s_barrier
  v_smfmac_f32_16x16x64_bf16 v[36:39], v[8:11], a[160:167], v74
  ds_read_b128 v[20:23], v77 offset:256
  ds_read_b128 v[24:27], v77 offset:384
  v_smfmac_f32_16x16x64_bf16 v[40:43], v[8:11], a[168:175], v74
  ds_read_b128 v[8:11], v76 offset:6656
  v_add_f32_dpp v72, v46, v44 quad_perm:[2,3,0,1] row_mask:0xf bank_mask:0xf
  v_add_f32_dpp v73, v47, v45 quad_perm:[2,3,0,1] row_mask:0xf bank_mask:0xf
  v_smfmac_f32_16x16x64_bf16 v[36:39], v[12:15], a[144:151], v74
  s_waitcnt lgkmcnt(4)
  v_exp_f32_dpp v72, v72 quad_perm:[0,1,0,1] row_mask:0xf bank_mask:0xf
  v_smfmac_f32_16x16x64_bf16 v[40:43], v[12:15], a[152:159], v74
  ds_read_b128 v[12:15], v76 offset:7680
  v_exp_f32_dpp v73, v73 quad_perm:[0,1,0,1] row_mask:0xf bank_mask:0xf
  v_smfmac_f32_16x16x64_bf16 v[36:39], v[0:3], a[32:39], v74
  s_waitcnt lgkmcnt(2)
  v_cvt_pk_bf16_f32 v72, v72, v73
  v_mfma_f32_16x16x32_bf16 v[20:23], v[20:23], v[60:63], 0
  ds_write_b32 v78, v72 offset:516
  v_mov_b64 v[16:17], 0
  v_mfma_f32_16x16x32_bf16 v[20:23], v[24:27], v[64:67], v[20:23]
  ds_read_b128 v[44:47], v75 offset:20480
  v_mov_b64 v[18:19], 0
  v_smfmac_f32_16x16x64_bf16 v[40:43], v[0:3], a[40:47], v74
  ds_read_b128 v[48:51], v75 offset:21504
  s_waitcnt lgkmcnt(4)
  v_smfmac_f32_16x16x64_bf16 v[36:39], v[4:7], a[48:55], v74
  v_add_f32_dpp v24, v22, v20 quad_perm:[2,3,0,1] row_mask:0xf bank_mask:0xf
  v_add_f32_dpp v25, v23, v21 quad_perm:[2,3,0,1] row_mask:0xf bank_mask:0xf
  v_smfmac_f32_16x16x64_bf16 v[36:39], v[8:11], a[64:71], v74
  s_waitcnt lgkmcnt(2)
  s_barrier
  ds_read_b128 v[32:35], v78 offset:512
  v_smfmac_f32_16x16x64_bf16 v[36:39], v[12:15], a[80:87], v74
  ds_read_b128 v[60:63], v75 offset:22528
  v_mul_f32 v24, s69, v24
  v_smfmac_f32_16x16x64_bf16 v[40:43], v[4:7], a[56:63], v74
  ds_read_b128 v[64:67], v75 offset:23552
  v_mul_f32 v25, s69, v25
  v_smfmac_f32_16x16x64_bf16 v[40:43], v[8:11], a[72:79], v74
  v_exp_f32_dpp v24, v24 quad_perm:[0,1,0,1] row_mask:0xf bank_mask:0xf
  v_smfmac_f32_16x16x64_bf16 v[40:43], v[12:15], a[88:95], v74
  s_waitcnt vmcnt(2) lgkmcnt(2)
  v_exp_f32_dpp v25, v25 quad_perm:[0,1,0,1] row_mask:0xf bank_mask:0xf
  v_mfma_f32_16x16x32_bf16 v[8:11], v[32:35], v[68:71], 0
  v_add_f32 v36, v36, v38
  v_add_f32 v37, v37, v39
  v_mfma_f32_16x16x32_bf16 v[0:3], v[32:35], v[52:55], 0
  v_add_f32 v40, v40, v42
  v_add_f32 v41, v41, v43
  v_mfma_f32_16x16x32_bf16 v[4:7], v[32:35], v[56:59], 0
  v_cvt_pk_bf16_f32 v28, v24, v25
  v_cvt_pk_bf16_f32 v72, v36, v37
  v_cvt_pk_bf16_f32 v73, v40, v41
  v_mfma_f32_16x16x16_bf16 v[8:11], v[28:29], v[68:69], v[8:11]
  v_cvt_pk_bf16_f32 v31, v24, v25
  v_mov_b64 v[20:21], 0
  v_mfma_f32_16x16x16_bf16 v[0:3], v[28:29], v[72:73], v[0:3]
  ds_read_b128 v[68:71], v76 offset:13824
  v_mov_b64 v[22:23], 0
  v_mfma_f32_16x16x16_bf16 v[4:7], v[30:31], v[72:73], v[4:7]
  v_rcp_f32 v10, v8
  v_rcp_f32 v11, v9
  v_mul_f32 v0, v10, v0
  v_mul_f32 v1, v11, v1
  s_nop 0
  v_mul_f32 v4, v10, v4
  v_mul_f32 v5, v11, v5
  v_cvt_pk_bf16_f32 v2, v0, v4
  ds_write_b32 v79, v2 offset:8704
  v_cvt_pk_bf16_f32 v3, v1, v5
  ds_write_b32 v79, v3 offset:9280
  v_max3_f32 v8, v8, v9, v10
  v_max_f32 v8, v8, v11
  v_cmp_le_f32 vcc, 1317011456, v8
  v_mov_b64 v[24:25], 0
  v_mov_b64 v[26:27], 0
  s_cbranch_vccnz Cs1_mx
Cs1_mxok:
  s_waitcnt lgkmcnt(0)
  s_barrier
  ds_read_b128 v[0:3], v78 offset:8704
  ds_read_b128 v[4:7], v78 offset:8768
  ds_read_b128 v[8:11], v78 offset:8832
  ds_read_b128 v[12:15], v78 offset:8896
  s_cmp_eq_u32 s66, 63
  s_cbranch_scc1 Cs1_last
  s_waitcnt lgkmcnt(3)
  v_smfmac_f32_16x16x64_bf16 v[16:19], v[0:3], v[44:51], v74
  ds_read_b128 v[52:55], v75 offset:36864
  s_waitcnt lgkmcnt(3)
  v_smfmac_f32_16x16x64_bf16 v[16:19], v[4:7], v[60:67], v74
  ds_read_b128 v[56:59], v75 offset:37888
  s_waitcnt lgkmcnt(3)
  v_smfmac_f32_16x16x64_bf16 v[16:19], v[8:11], a[176:183], v74
  ds_read_b128 v[36:39], v75 offset:38912
  s_waitcnt lgkmcnt(3)
  v_smfmac_f32_16x16x64_bf16 v[16:19], v[12:15], a[184:191], v74
  ds_read_b128 v[40:43], v75 offset:39936
  ds_read_b128 v[44:47], v75 offset:53248
  v_smfmac_f32_16x16x64_bf16 v[20:23], v[0:3], a[192:199], v74
  ds_read_b128 v[48:51], v75 offset:54272
  ds_read_b128 v[60:63], v75 offset:55296
  v_smfmac_f32_16x16x64_bf16 v[20:23], v[4:7], a[200:207], v74
  ds_read_b128 v[64:67], v75 offset:56320
  s_waitcnt lgkmcnt(6)
  v_cvt_pk_bf16_f32 v16, v16, v17
  v_cvt_pk_bf16_f32 v17, v18, v19
  v_bfi_b32 v16, 1, s72, v16
  v_smfmac_f32_16x16x64_bf16 v[20:23], v[8:11], v[52:59], v74
  buffer_store_dwordx2 v[16:17], v68, s[8:11], s73 offen sc1
  s_waitcnt lgkmcnt(4)
  v_smfmac_f32_16x16x64_bf16 v[20:23], v[12:15], v[36:43], v74
  v_mov_b64 v[32:33], 0
  v_smfmac_f32_16x16x64_bf16 v[24:27], v[0:3], a[208:215], v74
  v_mov_b64 v[34:35], 0
  v_smfmac_f32_16x16x64_bf16 v[24:27], v[4:7], a[216:223], v74
  s_waitcnt lgkmcnt(2)
  v_cvt_pk_bf16_f32 v20, v20, v21
  v_cvt_pk_bf16_f32 v21, v22, v23
  v_bfi_b32 v20, 1, s72, v20
  v_smfmac_f32_16x16x64_bf16 v[24:27], v[8:11], v[44:51], v74
  buffer_store_dwordx2 v[20:21], v68, s[8:11], s74 offen sc1
  s_waitcnt lgkmcnt(0)
  v_smfmac_f32_16x16x64_bf16 v[24:27], v[12:15], v[60:67], v74
  v_smfmac_f32_16x16x64_bf16 v[32:35], v[0:3], a[224:231], v74
  v_smfmac_f32_16x16x64_bf16 v[32:35], v[4:7], a[232:239], v74
  v_cvt_pk_bf16_f32 v24, v24, v25
  v_cvt_pk_bf16_f32 v25, v26, v27
  v_bfi_b32 v24, 1, s72, v24
  v_smfmac_f32_16x16x64_bf16 v[32:35], v[8:11], a[240:247], v74
  s_nop 1
  buffer_store_dwordx2 v[24:25], v68, s[8:11], s75 offen sc1
  v_smfmac_f32_16x16x64_bf16 v[32:35], v[12:15], a[248:255], v74
  ds_read_b128 v[0:3], v76 offset:14848
  ds_read_b64 v[16:17], v77 offset:264
  v_mov_b64 v[18:19], v[72:73]
  v_xor_b32 v75, 0x8000, v75
  s_nop 3
  v_cvt_pk_bf16_f32 v32, v32, v33
  v_cvt_pk_bf16_f32 v33, v34, v35
  v_bfi_b32 v32, 1, s72, v32
  buffer_store_dwordx2 v[32:33], v68, s[8:11], s76 offen sc1
  v_mov_b64 v[20:21], 0
  v_mov_b64 v[22:23], 0
  v_mov_b64 v[24:25], 0
  v_mov_b64 v[26:27], 0
  v_mov_b64 v[28:29], 0
  v_mov_b64 v[30:31], 0
  v_mov_b64 v[32:33], 0
  v_mov_b64 v[34:35], 0
  s_add_u32 s58, s58, 655360
  s_add_u32 s59, s59, 655360
  s_add_u32 s70, s70, 655360
  s_add_u32 s68, s68, 655360
  s_add_u32 s66, s66, 1
  s_xor_b32 s64, s64, 16384
  s_xor_b32 s65, s65, 16384
  s_nop 15
  s_nop 15
  s_nop 7
  buffer_load_dwordx4 v[52:55], v76, s[8:11], s60 offen offset:0 sc1
  buffer_load_dwordx4 v[56:59], v76, s[8:11], s60 offen offset:1024 sc1
  s_nop 15
  s_nop 11
  buffer_load_dwordx4 v[36:39], v76, s[8:11], s60 offen offset:0 sc1
  buffer_load_dwordx4 v[40:43], v76, s[8:11], s60 offen offset:1024 sc1
  s_waitcnt lgkmcnt(0)
  s_waitcnt vmcnt(3)
  v_mfma_f32_16x16x32_bf16 v[4:7], v[0:3], v[52:55], 0
  v_bitop3_b32 v72, v52, v54, s72 bitop3:0x7e
  s_waitcnt vmcnt(2)
  v_mfma_f32_16x16x32_bf16 v[4:7], v[0:3], v[56:59], v[4:7]
  v_bitop3_b32 v73, v56, v58, s72 bitop3:0x7e
  v_bitop3_b32 v72, v72, v73, 1 bitop3:0xa8
  v_cmp_ne_u32 vcc, 0, v72
  s_cbranch_vccnz Cs1_h1r
  s_nop 2
  v_add_f32_dpp v4, v4, v4 row_ror:4 row_mask:0xf bank_mask:0xf
  v_add_f32_dpp v5, v5, v5 row_ror:4 row_mask:0xf bank_mask:0xf
  s_nop 0
  v_add_f32_dpp v4, v4, v4 row_ror:8 row_mask:0xf bank_mask:0xf
  v_add_f32_dpp v5, v5, v5 row_ror:8 row_mask:0xf bank_mask:0xf
  v_cvt_pk_bf16_f32 v4, v4, v5
  buffer_store_dword v4, v69, s[8:11], s62 offen sc1
  s_xor_b32 s62, s62, 16384
  buffer_store_dword v71, v69, s[8:11], s62 offen sc1
  s_xor_b32 s72, s72, 1
  s_branch Cs1_h2
Cs1_h1r:
  s_mov_b64 exec, vcc
  buffer_load_dwordx4 v[52:55], v76, s[8:11], s60 offen offset:0 sc1
  buffer_load_dwordx4 v[56:59], v76, s[8:11], s60 offen offset:1024 sc1
  s_mov_b64 exec, -1
  s_add_u32 s67, s67, 1
  s_waitcnt vmcnt(3)
  v_mfma_f32_16x16x32_bf16 v[4:7], v[0:3], v[36:39], 0
  v_bitop3_b32 v72, v36, v38, s72 bitop3:0x7e
  s_waitcnt vmcnt(2)
  v_mfma_f32_16x16x32_bf16 v[4:7], v[0:3], v[40:43], v[4:7]
  v_bitop3_b32 v73, v40, v42, s72 bitop3:0x7e
  v_bitop3_b32 v72, v72, v73, 1 bitop3:0xa8
  v_cmp_ne_u32 vcc, 0, v72
  s_cbranch_vccz Cs1_h1p
  s_mov_b64 exec, vcc
  buffer_load_dwordx4 v[36:39], v76, s[8:11], s60 offen offset:0 sc1
  buffer_load_dwordx4 v[40:43], v76, s[8:11], s60 offen offset:1024 sc1
  s_mov_b64 exec, -1
  s_add_u32 s67, s67, 1
  s_waitcnt vmcnt(3)
  v_mfma_f32_16x16x32_bf16 v[4:7], v[0:3], v[52:55], 0
  v_bitop3_b32 v72, v52, v54, s72 bitop3:0x7e
  s_waitcnt vmcnt(2)
  v_mfma_f32_16x16x32_bf16 v[4:7], v[0:3], v[56:59], v[4:7]
  v_bitop3_b32 v73, v56, v58, s72 bitop3:0x7e
  v_bitop3_b32 v72, v72, v73, 1 bitop3:0xa8
  v_cmp_ne_u32 vcc, 0, v72
  s_cbranch_vccz Cs1_h1p
Cs1_h1s:
  s_mov_b64 exec, vcc
  buffer_load_dwordx4 v[52:55], v76, s[8:11], s60 offen offset:0 sc1
  buffer_load_dwordx4 v[56:59], v76, s[8:11], s60 offen offset:1024 sc1
  s_mov_b64 exec, -1
  s_add_u32 s67, s67, 1
  s_waitcnt vmcnt(3)
  v_mfma_f32_16x16x32_bf16 v[4:7], v[0:3], v[36:39], 0
  v_bitop3_b32 v72, v36, v38, s72 bitop3:0x7e
  s_waitcnt vmcnt(2)
  v_mfma_f32_16x16x32_bf16 v[4:7], v[0:3], v[40:43], v[4:7]
  v_bitop3_b32 v73, v40, v42, s72 bitop3:0x7e
  v_bitop3_b32 v72, v72, v73, 1 bitop3:0xa8
  v_cmp_ne_u32 vcc, 0, v72
  s_cbranch_vccz Cs1_h1p
  s_mov_b64 exec, vcc
  buffer_load_dwordx4 v[36:39], v76, s[8:11], s60 offen offset:0 sc1
  buffer_load_dwordx4 v[40:43], v76, s[8:11], s60 offen offset:1024 sc1
  s_mov_b64 exec, -1
  s_add_u32 s67, s67, 1
  s_waitcnt vmcnt(3)
  v_mfma_f32_16x16x32_bf16 v[4:7], v[0:3], v[52:55], 0
  v_bitop3_b32 v72, v52, v54, s72 bitop3:0x7e
  s_waitcnt vmcnt(2)
  v_mfma_f32_16x16x32_bf16 v[4:7], v[0:3], v[56:59], v[4:7]
  v_bitop3_b32 v73, v56, v58, s72 bitop3:0x7e
  v_bitop3_b32 v72, v72, v73, 1 bitop3:0xa8
  v_cmp_ne_u32 vcc, 0, v72
  s_cbranch_vccz Cs1_h1p
  s_cmp_lt_u32 s67, 131072
  s_cbranch_scc1 Cs1_h1s
Cs1_h1p:
  s_nop 2
  v_add_f32_dpp v4, v4, v4 row_ror:4 row_mask:0xf bank_mask:0xf
  v_add_f32_dpp v5, v5, v5 row_ror:4 row_mask:0xf bank_mask:0xf
  s_nop 0
  v_add_f32_dpp v4, v4, v4 row_ror:8 row_mask:0xf bank_mask:0xf
  v_add_f32_dpp v5, v5, v5 row_ror:8 row_mask:0xf bank_mask:0xf
  v_cvt_pk_bf16_f32 v4, v4, v5
  buffer_store_dword v4, v69, s[8:11], s62 offen sc1
  s_xor_b32 s62, s62, 16384
  buffer_store_dword v71, v69, s[8:11], s62 offen sc1
  s_xor_b32 s72, s72, 1
  s_branch Cs1_h2
Cs1_h2r:
  s_mov_b64 exec, vcc
  buffer_load_dwordx4 v[52:55], v76, s[8:11], s65 offen offset:2048 sc1
  s_mov_b64 exec, -1
  s_add_u32 s67, s67, 1
  s_waitcnt vmcnt(2)
  v_max3_u32 v72, v52, v53, v54
  v_max_u32 v72, v72, v55
  ds_write_b128 v76, v[52:55] offset:6656
  v_cmp_eq_u32 vcc, -1, v72
  s_cbranch_vccz Cs1_h2w
  s_mov_b64 exec, vcc
  buffer_load_dwordx4 v[52:55], v76, s[8:11], s65 offen offset:2048 sc1
  s_mov_b64 exec, -1
  s_add_u32 s67, s67, 1
  s_waitcnt vmcnt(2)
  v_max3_u32 v72, v52, v53, v54
  v_max_u32 v72, v72, v55
  ds_write_b128 v76, v[52:55] offset:6656
  v_cmp_eq_u32 vcc, -1, v72
  s_cbranch_vccz Cs1_h2w
  s_mov_b64 exec, vcc
  buffer_load_dwordx4 v[52:55], v76, s[8:11], s65 offen offset:2048 sc1
  s_mov_b64 exec, -1
  s_add_u32 s67, s67, 1
  s_waitcnt vmcnt(2)
  v_max3_u32 v72, v52, v53, v54
  v_max_u32 v72, v72, v55
  ds_write_b128 v76, v[52:55] offset:6656
  v_cmp_eq_u32 vcc, -1, v72
  s_cbranch_vccz Cs1_h2w
  s_mov_b64 exec, vcc
  buffer_load_dwordx4 v[52:55], v76, s[8:11], s65 offen offset:2048 sc1
  s_mov_b64 exec, -1
  s_add_u32 s67, s67, 1
  s_waitcnt vmcnt(2)
  v_max3_u32 v72, v52, v53, v54
  v_max_u32 v72, v72, v55
  ds_write_b128 v76, v[52:55] offset:6656
  v_cmp_eq_u32 vcc, -1, v72
  s_cbranch_vccz Cs1_h2w
  s_cmp_lt_u32 s67, 131072
  s_cbranch_scc1 Cs1_h2r
Cs1_h2ok:
  ds_write_b128 v76, v[52:55] offset:6656
  s_branch Cs1_h2w
Cs1_rec:
  s_nop 7
  s_waitcnt vmcnt(0) lgkmcnt(0)
  v_max3_u32 v72, v0, v1, v2
  v_max3_u32 v72, v72, v3, v4
  v_max3_u32 v72, v72, v5, v6
  v_max3_u32 v72, v72, v7, v8
  v_max3_u32 v72, v72, v9, v10
  v_max3_u32 v72, v72, v11, v12
  v_max3_u32 v72, v72, v13, v14
  v_max3_u32 v72, v72, v15, v16
  v_max3_u32 v72, v72, v17, v18
  v_max_u32 v72, v72, v19
  v_cmp_eq_u32 vcc, -1, v72
  s_cbranch_vccz Cs1_recok
  s_barrier
  v_mov_b64 v[20:21], 0
  v_mov_b64 v[22:23], 0
  v_mov_b64 v[24:25], 0
  v_mov_b64 v[26:27], 0
  v_mov_b64 v[28:29], 0
  v_mov_b64 v[30:31], 0
  v_mov_b64 v[32:33], 0
  v_mov_b64 v[34:35], 0
  s_waitcnt lgkmcnt(0)
  s_barrier
  ds_read_b128 v[0:3], v76 offset:4608
  ds_read_b128 v[60:63], v76 offset:20480
  ds_read_b128 v[64:67], v76 offset:21504
  s_waitcnt lgkmcnt(0)
  v_smfmac_f32_16x16x64_bf16 v[20:23], v[0:3], v[60:67], v74
  ds_read_b128 v[60:63], v76 offset:22528
  ds_read_b128 v[64:67], v76 offset:23552
  s_waitcnt lgkmcnt(0)
  v_smfmac_f32_16x16x64_bf16 v[24:27], v[0:3], v[60:67], v74
  ds_read_b128 v[60:63], v76 offset:36864
  ds_read_b128 v[64:67], v76 offset:37888
  s_waitcnt lgkmcnt(0)
  v_smfmac_f32_16x16x64_bf16 v[28:31], v[0:3], v[60:67], v74
  ds_read_b128 v[60:63], v76 offset:38912
  ds_read_b128 v[64:67], v76 offset:39936
  s_waitcnt lgkmcnt(0)
  v_smfmac_f32_16x16x64_bf16 v[32:35], v[0:3], v[60:67], v74
  ds_read_b128 v[4:7], v76 offset:5632
  s_waitcnt lgkmcnt(0)
  v_smfmac_f32_16x16x64_bf16 v[20:23], v[4:7], v[80:87], v74
  v_smfmac_f32_16x16x64_bf16 v[24:27], v[4:7], v[88:95], v74
  v_smfmac_f32_16x16x64_bf16 v[28:31], v[4:7], v[208:215], v74
  v_smfmac_f32_16x16x64_bf16 v[32:35], v[4:7], v[216:223], v74
  ds_read_b128 v[8:11], v76 offset:6656
  s_waitcnt lgkmcnt(0)
  v_smfmac_f32_16x16x64_bf16 v[20:23], v[8:11], v[96:103], v74
  v_smfmac_f32_16x16x64_bf16 v[24:27], v[8:11], v[104:111], v74
  ds_read_b128 v[60:63], v76 offset:53248
  ds_read_b128 v[64:67], v76 offset:54272
  s_waitcnt lgkmcnt(0)
  v_smfmac_f32_16x16x64_bf16 v[28:31], v[8:11], v[60:67], v74
  ds_read_b128 v[60:63], v76 offset:55296
  ds_read_b128 v[64:67], v76 offset:56320
  s_waitcnt lgkmcnt(0)
  v_smfmac_f32_16x16x64_bf16 v[32:35], v[8:11], v[60:67], v74
  ds_read_b128 v[12:15], v76 offset:7680
  s_waitcnt lgkmcnt(0)
  v_smfmac_f32_16x16x64_bf16 v[20:23], v[12:15], v[112:119], v74
  v_smfmac_f32_16x16x64_bf16 v[24:27], v[12:15], v[120:127], v74
  v_smfmac_f32_16x16x64_bf16 v[28:31], v[12:15], v[224:231], v74
  v_smfmac_f32_16x16x64_bf16 v[32:35], v[12:15], v[232:239], v74
  ds_read_b128 v[0:3], v76 offset:8704
  s_waitcnt lgkmcnt(0)
  v_smfmac_f32_16x16x64_bf16 v[20:23], v[0:3], v[128:135], v74
  v_smfmac_f32_16x16x64_bf16 v[24:27], v[0:3], v[136:143], v74
  ds_read_b128 v[60:63], v75 offset:4096
  ds_read_b128 v[64:67], v75 offset:5120
  s_waitcnt lgkmcnt(0)
  v_smfmac_f32_16x16x64_bf16 v[28:31], v[0:3], v[60:67], v74
  ds_read_b128 v[60:63], v75 offset:6144
  ds_read_b128 v[64:67], v75 offset:7168
  s_waitcnt lgkmcnt(0)
  v_smfmac_f32_16x16x64_bf16 v[32:35], v[0:3], v[60:67], v74
  ds_read_b128 v[4:7], v76 offset:9728
  s_waitcnt lgkmcnt(0)
  v_smfmac_f32_16x16x64_bf16 v[20:23], v[4:7], v[144:151], v74
  v_smfmac_f32_16x16x64_bf16 v[24:27], v[4:7], v[152:159], v74
  ds_read_b128 v[60:63], v75 offset:20480
  ds_read_b128 v[64:67], v75 offset:21504
  s_waitcnt lgkmcnt(0)
  v_smfmac_f32_16x16x64_bf16 v[28:31], v[4:7], v[60:67], v74
  ds_read_b128 v[60:63], v75 offset:22528
  ds_read_b128 v[64:67], v75 offset:23552
  s_waitcnt lgkmcnt(0)
  v_smfmac_f32_16x16x64_bf16 v[32:35], v[4:7], v[60:67], v74
  ds_read_b128 v[16:19], v76 offset:10752
  s_waitcnt lgkmcnt(0)
  v_smfmac_f32_16x16x64_bf16 v[20:23], v[16:19], v[160:167], v74
  v_smfmac_f32_16x16x64_bf16 v[24:27], v[16:19], v[168:175], v74
  v_smfmac_f32_16x16x64_bf16 v[28:31], v[16:19], v[240:247], v74
  v_smfmac_f32_16x16x64_bf16 v[32:35], v[16:19], v[248:255], v74
  ds_read_b128 v[12:15], v76 offset:11776
  s_waitcnt lgkmcnt(0)
  v_smfmac_f32_16x16x64_bf16 v[20:23], v[12:15], v[176:183], v74
  v_smfmac_f32_16x16x64_bf16 v[24:27], v[12:15], v[184:191], v74
  v_smfmac_f32_16x16x64_bf16 v[28:31], v[12:15], a[0:7], v74
  v_smfmac_f32_16x16x64_bf16 v[32:35], v[12:15], a[8:15], v74
  ds_read_b128 v[8:11], v76 offset:12800
  s_waitcnt lgkmcnt(0)
  v_smfmac_f32_16x16x64_bf16 v[20:23], v[8:11], v[192:199], v74
  v_smfmac_f32_16x16x64_bf16 v[24:27], v[8:11], v[200:207], v74
  v_smfmac_f32_16x16x64_bf16 v[28:31], v[8:11], a[16:23], v74
  v_smfmac_f32_16x16x64_bf16 v[32:35], v[8:11], a[24:31], v74
  v_add_f32 v20, v20, v22
  v_add_f32 v21, v21, v23
  v_add_f32 v24, v24, v26
  v_cvt_pk_bf16_f32 v22, v20, v24
  s_nop 0
  ds_write_b32 v79, v22 offset:0
  v_add_f32 v25, v25, v27
  v_cvt_pk_bf16_f32 v23, v21, v25
  ds_write_b32 v79, v23 offset:576
  v_add_f32 v28, v28, v30
  v_add_f32 v29, v29, v31
  s_waitcnt lgkmcnt(0)
  s_nop 1
  s_branch Cs1_recok
Cs1_mx:
  s_waitcnt lgkmcnt(0)
  s_barrier
  buffer_load_dwordx4 v[0:3], v76, s[8:11], s58 offen offset:0 sc1
  ds_read_b128 v[20:23], v77 offset:0
  ds_read_b128 v[28:31], v77 offset:256
  buffer_load_dwordx4 v[4:7], v76, s[8:11], s58 offen offset:1024 sc1
  ds_read_b128 v[24:27], v77 offset:128
  ds_read_b128 v[32:35], v77 offset:384
  s_waitcnt vmcnt(1) lgkmcnt(3)
  v_mfma_f32_16x16x32_bf16 v[8:11], v[0:3], v[20:23], 0
  s_waitcnt vmcnt(0) lgkmcnt(1)
  v_mfma_f32_16x16x32_bf16 v[8:11], v[4:7], v[24:27], v[8:11]
  v_mfma_f32_16x16x32_bf16 v[12:15], v[28:31], v[20:23], 0
  s_waitcnt lgkmcnt(0)
  v_mfma_f32_16x16x32_bf16 v[12:15], v[32:35], v[24:27], v[12:15]
  v_add_f32_dpp v8, v10, v8 quad_perm:[2,3,0,1] row_mask:0xf bank_mask:0xf
  v_add_f32_dpp v9, v11, v9 quad_perm:[2,3,0,1] row_mask:0xf bank_mask:0xf
  s_nop 0
  v_mov_b32_dpp v8, v8 quad_perm:[0,1,0,1] row_mask:0xf bank_mask:0xf
  v_mov_b32_dpp v9, v9 quad_perm:[0,1,0,1] row_mask:0xf bank_mask:0xf
  s_nop 1
  v_add_f32_dpp v12, v14, v12 quad_perm:[2,3,0,1] row_mask:0xf bank_mask:0xf
  v_add_f32_dpp v13, v15, v13 quad_perm:[2,3,0,1] row_mask:0xf bank_mask:0xf
  s_nop 0
  v_mov_b32_dpp v12, v12 quad_perm:[0,1,0,1] row_mask:0xf bank_mask:0xf
  v_mov_b32_dpp v13, v13 quad_perm:[0,1,0,1] row_mask:0xf bank_mask:0xf
  v_mul_f32 v12, s69, v12
  ds_write_b32 v78, v8 offset:8708
  v_mul_f32 v13, s69, v13
  ds_write_b32 v78, v9 offset:8772
  s_waitcnt lgkmcnt(0)
  s_barrier
  ds_read_b128 v[36:39], v78 offset:8704
  ds_read_b128 v[40:43], v78 offset:8768
  s_waitcnt lgkmcnt(0)
  s_barrier
  v_max_f32 v16, v36, v37
  v_max3_f32 v16, v16, v38, v39
  v_max3_f32 v16, v16, v40, v41
  v_max3_f32 v16, v16, v42, v43
  v_max3_f32 v16, v16, v12, v13
  v_mov_b32 v17, v16
  s_nop 1
  v_permlane16_swap_b32 v16, v17
  v_max_f32 v16, v16, v17
  v_mov_b32 v17, v16
  s_nop 1
  v_permlane32_swap_b32 v16, v17
  v_max_f32 v16, v16, v17
  v_sub_f32 v36, v36, v16
  v_sub_f32 v37, v37, v16
  v_sub_f32 v38, v38, v16
  v_sub_f32 v39, v39, v16
  v_sub_f32 v40, v40, v16
  v_sub_f32 v41, v41, v16
  v_sub_f32 v42, v42, v16
  v_sub_f32 v43, v43, v16
  v_sub_f32 v12, v12, v16
  v_sub_f32 v13, v13, v16
  v_exp_f32 v36, v36
  v_exp_f32 v37, v37
  v_exp_f32 v38, v38
  v_exp_f32 v39, v39
  v_exp_f32 v40, v40
  v_exp_f32 v41, v41
  v_exp_f32 v42, v42
  v_exp_f32 v43, v43
  v_exp_f32 v12, v12
  v_exp_f32 v13, v13
  v_cvt_pk_bf16_f32 v32, v36, v40
  v_cvt_pk_bf16_f32 v33, v37, v41
  v_cvt_pk_bf16_f32 v34, v38, v42
  v_cvt_pk_bf16_f32 v35, v39, v43
  v_cvt_pk_bf16_f32 v28, v12, v13
  v_cvt_pk_bf16_f32 v31, v12, v13
  v_mov_b32 v29, 0
  v_mov_b32 v30, 0
  v_mov_b32 v68, 0x3f803f80
  v_mov_b32 v69, 0x3f803f80
  v_mov_b32 v70, 0x3f803f80
  v_mov_b32 v71, 0x3f803f80
  s_nop 1
  v_mfma_f32_16x16x32_bf16 v[8:11], v[32:35], v[68:71], 0
  v_mfma_f32_16x16x32_bf16 v[0:3], v[32:35], v[52:55], 0
  v_mfma_f32_16x16x32_bf16 v[4:7], v[32:35], v[56:59], 0
  v_mfma_f32_16x16x16_bf16 v[8:11], v[28:29], v[68:69], v[8:11]
  v_mfma_f32_16x16x16_bf16 v[0:3], v[28:29], v[72:73], v[0:3]
  v_mfma_f32_16x16x16_bf16 v[4:7], v[30:31], v[72:73], v[4:7]
  ds_read_b128 v[68:71], v76 offset:13824
  v_rcp_f32 v10, v8
  v_rcp_f32 v11, v9
  v_mul_f32 v0, v10, v0
  v_mul_f32 v1, v11, v1
  s_nop 0
  v_mul_f32 v4, v10, v4
  v_mul_f32 v5, v11, v5
  v_cvt_pk_bf16_f32 v2, v0, v4
  ds_write_b32 v79, v2 offset:8704
  v_cvt_pk_bf16_f32 v3, v1, v5
  ds_write_b32 v79, v3 offset:9280
  v_mov_b64 v[16:17], 0
  v_mov_b64 v[18:19], 0
  v_mov_b64 v[20:21], 0
  v_mov_b64 v[22:23], 0
  v_mov_b64 v[24:25], 0
  v_mov_b64 v[26:27], 0
  s_branch Cs1_mxok
Cs1_last:
  s_waitcnt lgkmcnt(0)
  ds_read_b64 v[16:17], v77 offset:264
  v_mov_b64 v[18:19], v[72:73]
  s_add_u32 s68, s68, 655360
  s_waitcnt lgkmcnt(0)
  buffer_store_dwordx4 v[16:19], v76, s[8:11], s68 offen sc1
  s_branch L_cexit
L_w6:
  v_mov_b64 v[20:21], 0
  v_mov_b64 v[22:23], 0
  v_mov_b64 v[24:25], 0
  v_mov_b64 v[26:27], 0
  v_mov_b64 v[28:29], 0
  v_mov_b64 v[30:31], 0
  v_mov_b64 v[32:33], 0
  v_mov_b64 v[34:35], 0
  s_mov_b32 s78, 0x3f803f80
  s_mov_b32 s79, s78
  s_mov_b32 s65, 360448
  s_mov_b32 m0, 15872
  v_lshlrev_b32 v73, 2, v76
  v_mov_b32 v72, 0
  ds_read_b128 v[60:63], v76 offset:24576
  ds_read_b128 v[64:67], v76 offset:25600
  ds_read_b128 v[44:47], v76 offset:26624
  ds_read_b128 v[48:51], v76 offset:27648
  ds_read_b128 v[36:39], v76 offset:40960
  ds_read_b128 v[40:43], v76 offset:41984
  ds_read_b128 v[0:3], v76 offset:4608
  ds_read_b128 v[4:7], v76 offset:5632
  s_branch Cs2_top2
.p2align 6
Cs2_h2:
  v_lshlrev_b32 v73, 2, v76
  s_mov_b32 m0, 8704
  s_nop 11
  buffer_load_dwordx4 v[52:55], v76, s[8:11], s65 offen offset:3072 sc1
  s_nop 15
  s_nop 3
  buffer_load_dwordx4 v[52:55], v76, s[8:11], s65 offen offset:3072 sc1
  s_nop 15
  s_nop 3
  buffer_load_dwordx4 v[52:55], v76, s[8:11], s65 offen offset:3072 sc1
  s_waitcnt vmcnt(5)
  ds_read_b128 v[60:63], v76 offset:24576
  ds_read_b128 v[64:67], v76 offset:25600
  ds_read_b128 v[44:47], v76 offset:26624
  ds_read_b128 v[48:51], v76 offset:27648
  ds_read_b128 v[36:39], v76 offset:40960
  ds_read_b128 v[40:43], v76 offset:41984
  s_waitcnt vmcnt(2)
  v_max3_u32 v72, v52, v53, v54
  v_max_u32 v72, v72, v55
  ds_write_b128 v76, v[52:55] offset:7680
  v_cmp_eq_u32 vcc, -1, v72
  s_cbranch_vccnz Cs2_h2r
Cs2_h2w:
  s_waitcnt lgkmcnt(0)
  s_barrier
  ds_read_b128 v[0:3], v76 offset:4608
  ds_read_b128 v[4:7], v76 offset:5632
  buffer_load_dwordx4 v76, s[8:11], s64 offen offset:0 sc1 lds
  buffer_load_dwordx4 v76, s[8:11], s64 offen offset:1024 sc1 lds
Cs2_top2:
  ds_read_b128 v[8:11], v76 offset:6656
  s_mov_b32 m0, 15872
  s_waitcnt lgkmcnt(2)
  v_smfmac_f32_16x16x64_bf16 v[20:23], v[0:3], v[60:67], v74
  ds_read_b128 v[60:63], v76 offset:43008
  v_smfmac_f32_16x16x64_bf16 v[24:27], v[0:3], v[44:51], v74
  buffer_load_dwordx4 v[44:47], v76, s[8:11], s58 offen offset:0 sc1
  ds_read_b128 v[64:67], v76 offset:44032
  s_waitcnt lgkmcnt(3)
  v_smfmac_f32_16x16x64_bf16 v[20:23], v[4:7], v[80:87], v74
  buffer_load_dwordx4 v[48:51], v76, s[8:11], s58 offen offset:1024 sc1
  v_smfmac_f32_16x16x64_bf16 v[28:31], v[0:3], v[36:43], v74
  buffer_load_dwordx4 v[52:55], v76, s[8:11], s59 offen offset:0 sc1
  ds_read_b128 v[36:39], v76 offset:57344
  v_smfmac_f32_16x16x64_bf16 v[24:27], v[4:7], v[88:95], v74
  buffer_load_dwordx4 v[56:59], v76, s[8:11], s59 offen offset:1024 sc1
  ds_read_b128 v[40:43], v76 offset:58368
  v_smfmac_f32_16x16x64_bf16 v[28:31], v[4:7], v[208:215], v74
  ds_read_b128 v[12:15], v76 offset:7680
  s_waitcnt lgkmcnt(5)
  v_smfmac_f32_16x16x64_bf16 v[32:35], v[4:7], v[216:223], v74
  buffer_store_dwordx4 v[16:19], v76, s[8:11], s68 offen sc1
  s_waitcnt lgkmcnt(3)
  v_smfmac_f32_16x16x64_bf16 v[32:35], v[0:3], v[60:67], v74
  buffer_load_dword v73, s[8:11], s70 offen  lds
  v_smfmac_f32_16x16x64_bf16 v[20:23], v[8:11], v[96:103], v74
  ds_read_b128 v[60:63], v76 offset:59392
  v_smfmac_f32_16x16x64_bf16 v[24:27], v[8:11], v[104:111], v74
  ds_read_b128 v[64:67], v76 offset:60416
  s_waitcnt lgkmcnt(3)
  v_smfmac_f32_16x16x64_bf16 v[28:31], v[8:11], v[36:43], v74
  ds_read_b128 v[36:39], v75 offset:8192
  s_waitcnt lgkmcnt(3)
  v_smfmac_f32_16x16x64_bf16 v[20:23], v[12:15], v[112:119], v74
  ds_read_b128 v[40:43], v75 offset:9216
  v_smfmac_f32_16x16x64_bf16 v[24:27], v[12:15], v[120:127], v74
  s_waitcnt vmcnt(6)
  v_smfmac_f32_16x16x64_bf16 v[28:31], v[12:15], v[224:231], v74
  s_barrier
  ds_read_b128 v[0:3], v76 offset:8704
  v_smfmac_f32_16x16x64_bf16 v[32:35], v[12:15], v[232:239], v74
  ds_read_b128 v[4:7], v76 offset:9728
  s_waitcnt lgkmcnt(4)
  v_smfmac_f32_16x16x64_bf16 v[32:35], v[8:11], v[60:67], v74
  ds_read_b128 v[60:63], v75 offset:10240
  s_waitcnt lgkmcnt(2)
  v_smfmac_f32_16x16x64_bf16 v[20:23], v[0:3], v[128:135], v74
  ds_read_b128 v[16:19], v76 offset:10752
  v_smfmac_f32_16x16x64_bf16 v[24:27], v[0:3], v[136:143], v74
  ds_read_b128 v[64:67], v75 offset:11264
  v_smfmac_f32_16x16x64_bf16 v[28:31], v[0:3], v[36:43], v74
  ds_read_b128 v[36:39], v75 offset:24576
  s_waitcnt lgkmcnt(4)
  v_smfmac_f32_16x16x64_bf16 v[20:23], v[4:7], v[144:151], v74
  ds_read_b128 v[12:15], v76 offset:11776
  v_smfmac_f32_16x16x64_bf16 v[24:27], v[4:7], v[152:159], v74
  ds_read_b128 v[40:43], v75 offset:25600
  s_waitcnt lgkmcnt(4)
  v_smfmac_f32_16x16x64_bf16 v[20:23], v[16:19], v[160:167], v74
  ds_read_b128 v[8:11], v76 offset:12800
  s_waitcnt lgkmcnt(4)
  v_smfmac_f32_16x16x64_bf16 v[32:35], v[0:3], v[60:67], v74
  ds_read_b128 v[60:63], v75 offset:26624
  v_mov_b64 v[68:69], s[78:79]
  v_smfmac_f32_16x16x64_bf16 v[24:27], v[16:19], v[168:175], v74
  ds_read_b128 v[64:67], v75 offset:27648
  s_waitcnt lgkmcnt(4)
  v_smfmac_f32_16x16x64_bf16 v[20:23], v[12:15], v[176:183], v74
  s_waitcnt lgkmcnt(3)
  v_mov_b64 v[70:71], s[78:79]
  v_smfmac_f32_16x16x64_bf16 v[28:31], v[4:7], v[36:43], v74
  s_waitcnt lgkmcnt(2)
  v_mov_b64 v[36:37], 0
  v_smfmac_f32_16x16x64_bf16 v[20:23], v[8:11], v[192:199], v74
  v_mov_b64 v[38:39], 0
  v_smfmac_f32_16x16x64_bf16 v[24:27], v[12:15], v[184:191], v74
  v_mov_b64 v[40:41], 0
  v_smfmac_f32_16x16x64_bf16 v[24:27], v[8:11], v[200:207], v74
  s_waitcnt lgkmcnt(0)
  v_add_f32 v20, v20, v22
  v_smfmac_f32_16x16x64_bf16 v[32:35], v[4:7], v[60:67], v74
  v_add_f32 v21, v21, v23
  v_smfmac_f32_16x16x64_bf16 v[28:31], v[16:19], v[240:247], v74
  v_add_f32 v24, v24, v26
  v_cvt_pk_bf16_f32 v22, v20, v24
  v_smfmac_f32_16x16x64_bf16 v[28:31], v[12:15], a[0:7], v74
  ds_write_b32 v79, v22 offset:0
  v_add_f32 v25, v25, v27
  v_cvt_pk_bf16_f32 v23, v21, v25
  v_smfmac_f32_16x16x64_bf16 v[28:31], v[8:11], a[16:23], v74
  ds_write_b32 v79, v23 offset:576
  v_cmp_u_f32 vcc, v20, v21
  v_smfmac_f32_16x16x64_bf16 v[32:35], v[16:19], v[248:255], v74
  v_mov_b64 v[42:43], 0
  v_smfmac_f32_16x16x64_bf16 v[32:35], v[12:15], a[8:15], v74
  v_add_f32 v28, v28, v30
  v_add_f32 v29, v29, v31
  v_smfmac_f32_16x16x64_bf16 v[32:35], v[8:11], a[24:31], v74
  s_cbranch_vccnz Cs2_rec
Cs2_recok:
  v_smfmac_f32_16x16x64_bf16 v[36:39], v[16:19], a[128:135], v74
  s_waitcnt lgkmcnt(0)
  s_barrier
  ds_read_b128 v[60:63], v77
  v_smfmac_f32_16x16x64_bf16 v[40:43], v[16:19], a[136:143], v74
  ds_read_b128 v[64:67], v77 offset:128
  v_add_f32 v32, v32, v34
  v_cvt_pk_bf16_f32 v30, v28, v32
  v_smfmac_f32_16x16x64_bf16 v[36:39], v[0:3], a[96:103], v74
  ds_write_b32 v79, v30 offset:256
  v_add_f32 v33, v33, v35
  v_cvt_pk_bf16_f32 v31, v29, v33
  v_smfmac_f32_16x16x64_bf16 v[40:43], v[0:3], a[104:111], v74
  ds_write_b32 v79, v31 offset:832
  v_xor_b32 v75, 0x8000, v75
  v_smfmac_f32_16x16x64_bf16 v[36:39], v[4:7], a[112:119], v74
  ds_read_b128 v[0:3], v76 offset:4608
  v_mov_b32 v29, 0
  v_smfmac_f32_16x16x64_bf16 v[40:43], v[4:7], a[120:127], v74
  s_waitcnt vmcnt(4) lgkmcnt(3)
  v_mov_b32 v30, 0
  v_mfma_f32_16x16x32_bf16 v[44:47], v[44:47], v[60:63], 0
  ds_read_b128 v[4:7], v76 offset:5632
  s_waitcnt lgkmcnt(2)
  v_mfma_f32_16x16x32_bf16 v[44:47], v[48:51], v[64:67], v[44:47]
  s_barrier
  v_smfmac_f32_16x16x64_bf16 v[36:39], v[8:11], a[160:167], v74
  ds_read_b128 v[20:23], v77 offset:256
  ds_read_b128 v[24:27], v77 offset:384
  v_smfmac_f32_16x16x64_bf16 v[40:43], v[8:11], a[168:175], v74
  ds_read_b128 v[8:11], v76 offset:6656
  v_add_f32_dpp v72, v46, v44 quad_perm:[2,3,0,1] row_mask:0xf bank_mask:0xf
  v_add_f32_dpp v73, v47, v45 quad_perm:[2,3,0,1] row_mask:0xf bank_mask:0xf
  v_smfmac_f32_16x16x64_bf16 v[36:39], v[12:15], a[144:151], v74
  s_waitcnt lgkmcnt(4)
  v_exp_f32_dpp v72, v72 quad_perm:[0,1,0,1] row_mask:0xf bank_mask:0xf
  v_smfmac_f32_16x16x64_bf16 v[40:43], v[12:15], a[152:159], v74
  ds_read_b128 v[12:15], v76 offset:7680
  v_exp_f32_dpp v73, v73 quad_perm:[0,1,0,1] row_mask:0xf bank_mask:0xf
  v_smfmac_f32_16x16x64_bf16 v[36:39], v[0:3], a[32:39], v74
  s_waitcnt lgkmcnt(2)
  v_cvt_pk_bf16_f32 v72, v72, v73
  v_mfma_f32_16x16x32_bf16 v[20:23], v[20:23], v[60:63], 0
  ds_write_b32 v78, v72 offset:520
  v_mov_b64 v[16:17], 0
  v_mfma_f32_16x16x32_bf16 v[20:23], v[24:27], v[64:67], v[20:23]
  ds_read_b128 v[44:47], v75 offset:24576
  v_mov_b64 v[18:19], 0
  v_smfmac_f32_16x16x64_bf16 v[40:43], v[0:3], a[40:47], v74
  ds_read_b128 v[48:51], v75 offset:25600
  s_waitcnt lgkmcnt(4)
  v_smfmac_f32_16x16x64_bf16 v[36:39], v[4:7], a[48:55], v74
  v_add_f32_dpp v24, v22, v20 quad_perm:[2,3,0,1] row_mask:0xf bank_mask:0xf
  v_add_f32_dpp v25, v23, v21 quad_perm:[2,3,0,1] row_mask:0xf bank_mask:0xf
  v_smfmac_f32_16x16x64_bf16 v[36:39], v[8:11], a[64:71], v74
  s_waitcnt lgkmcnt(2)
  s_barrier
  ds_read_b128 v[32:35], v78 offset:512
  v_smfmac_f32_16x16x64_bf16 v[36:39], v[12:15], a[80:87], v74
  ds_read_b128 v[60:63], v75 offset:26624
  v_mul_f32 v24, s69, v24
  v_smfmac_f32_16x16x64_bf16 v[40:43], v[4:7], a[56:63], v74
  ds_read_b128 v[64:67], v75 offset:27648
  v_mul_f32 v25, s69, v25
  v_smfmac_f32_16x16x64_bf16 v[40:43], v[8:11], a[72:79], v74
  v_exp_f32_dpp v24, v24 quad_perm:[0,1,0,1] row_mask:0xf bank_mask:0xf
  v_smfmac_f32_16x16x64_bf16 v[40:43], v[12:15], a[88:95], v74
  s_waitcnt vmcnt(2) lgkmcnt(2)
  v_exp_f32_dpp v25, v25 quad_perm:[0,1,0,1] row_mask:0xf bank_mask:0xf
  v_mfma_f32_16x16x32_bf16 v[8:11], v[32:35], v[68:71], 0
  v_add_f32 v36, v36, v38
  v_add_f32 v37, v37, v39
  v_mfma_f32_16x16x32_bf16 v[0:3], v[32:35], v[52:55], 0
  v_add_f32 v40, v40, v42
  v_add_f32 v41, v41, v43
  v_mfma_f32_16x16x32_bf16 v[4:7], v[32:35], v[56:59], 0
  v_cvt_pk_bf16_f32 v28, v24, v25
  v_cvt_pk_bf16_f32 v72, v36, v37
  v_cvt_pk_bf16_f32 v73, v40, v41
  v_mfma_f32_16x16x16_bf16 v[8:11], v[28:29], v[68:69], v[8:11]
  v_cvt_pk_bf16_f32 v31, v24, v25
  v_mov_b64 v[20:21], 0
  v_mfma_f32_16x16x16_bf16 v[0:3], v[28:29], v[72:73], v[0:3]
  ds_read_b128 v[68:71], v76 offset:13824
  v_mov_b64 v[22:23], 0
  v_mfma_f32_16x16x16_bf16 v[4:7], v[30:31], v[72:73], v[4:7]
  v_rcp_f32 v10, v8
  v_rcp_f32 v11, v9
  v_mul_f32 v0, v10, v0
  v_mul_f32 v1, v11, v1
  s_nop 0
  v_mul_f32 v4, v10, v4
  v_mul_f32 v5, v11, v5
  v_cvt_pk_bf16_f32 v2, v0, v4
  ds_write_b32 v79, v2 offset:8704
  v_cvt_pk_bf16_f32 v3, v1, v5
  ds_write_b32 v79, v3 offset:9280
  v_max3_f32 v8, v8, v9, v10
  v_max_f32 v8, v8, v11
  v_cmp_le_f32 vcc, 1317011456, v8
  v_mov_b64 v[24:25], 0
  v_mov_b64 v[26:27], 0
  s_cbranch_vccnz Cs2_mx
Cs2_mxok:
  s_waitcnt lgkmcnt(0)
  s_barrier
  ds_read_b128 v[0:3], v78 offset:8704
  ds_read_b128 v[4:7], v78 offset:8768
  ds_read_b128 v[8:11], v78 offset:8832
  ds_read_b128 v[12:15], v78 offset:8896
  s_cmp_eq_u32 s66, 63
  s_cbranch_scc1 Cs2_last
  s_waitcnt lgkmcnt(3)
  v_smfmac_f32_16x16x64_bf16 v[16:19], v[0:3], v[44:51], v74
  ds_read_b128 v[52:55], v75 offset:40960
  s_waitcnt lgkmcnt(3)
  v_smfmac_f32_16x16x64_bf16 v[16:19], v[4:7], v[60:67], v74
  ds_read_b128 v[56:59], v75 offset:41984
  s_waitcnt lgkmcnt(3)
  v_smfmac_f32_16x16x64_bf16 v[16:19], v[8:11], a[176:183], v74
  ds_read_b128 v[36:39], v75 offset:43008
  s_waitcnt lgkmcnt(3)
  v_smfmac_f32_16x16x64_bf16 v[16:19], v[12:15], a[184:191], v74
  ds_read_b128 v[40:43], v75 offset:44032
  ds_read_b128 v[44:47], v75 offset:57344
  v_smfmac_f32_16x16x64_bf16 v[20:23], v[0:3], a[192:199], v74
  ds_read_b128 v[48:51], v75 offset:58368
  ds_read_b128 v[60:63], v75 offset:59392
  v_smfmac_f32_16x16x64_bf16 v[20:23], v[4:7], a[200:207], v74
  ds_read_b128 v[64:67], v75 offset:60416
  s_waitcnt lgkmcnt(6)
  v_cvt_pk_bf16_f32 v16, v16, v17
  v_cvt_pk_bf16_f32 v17, v18, v19
  v_bfi_b32 v16, 1, s72, v16
  v_smfmac_f32_16x16x64_bf16 v[20:23], v[8:11], v[52:59], v74
  buffer_store_dwordx2 v[16:17], v68, s[8:11], s73 offen sc1
  s_waitcnt lgkmcnt(4)
  v_smfmac_f32_16x16x64_bf16 v[20:23], v[12:15], v[36:43], v74
  ds_read_b128 v[52:55], v75 offset:0
  v_mov_b64 v[32:33], 0
  v_smfmac_f32_16x16x64_bf16 v[24:27], v[0:3], a[208:215], v74
  ds_read_b128 v[56:59], v75 offset:1024
  v_mov_b64 v[34:35], 0
  v_smfmac_f32_16x16x64_bf16 v[24:27], v[4:7], a[216:223], v74
  ds_read_b128 v[36:39], v75 offset:2048
  s_waitcnt lgkmcnt(5)
  v_cvt_pk_bf16_f32 v20, v20, v21
  v_cvt_pk_bf16_f32 v21, v22, v23
  v_bfi_b32 v20, 1, s72, v20
  v_smfmac_f32_16x16x64_bf16 v[24:27], v[8:11], v[44:51], v74
  buffer_store_dwordx2 v[20:21], v68, s[8:11], s74 offen sc1
  s_waitcnt lgkmcnt(3)
  v_smfmac_f32_16x16x64_bf16 v[24:27], v[12:15], v[60:67], v74
  ds_read_b128 v[40:43], v75 offset:3072
  v_mov_b64 v[28:29], 0
  v_smfmac_f32_16x16x64_bf16 v[32:35], v[0:3], a[224:231], v74
  ds_read_b128 v[44:47], v75 offset:4096
  ds_read_b128 v[48:51], v75 offset:5120
  v_smfmac_f32_16x16x64_bf16 v[32:35], v[4:7], a[232:239], v74
  ds_read_b128 v[60:63], v75 offset:6144
  v_cvt_pk_bf16_f32 v24, v24, v25
  v_cvt_pk_bf16_f32 v25, v26, v27
  v_bfi_b32 v24, 1, s72, v24
  v_smfmac_f32_16x16x64_bf16 v[32:35], v[8:11], a[240:247], v74
  buffer_store_dwordx2 v[24:25], v68, s[8:11], s75 offen sc1
  v_mov_b64 v[30:31], 0
  v_smfmac_f32_16x16x64_bf16 v[32:35], v[12:15], a[248:255], v74
  ds_read_b128 v[64:67], v75 offset:7168
  s_waitcnt lgkmcnt(6)
  v_smfmac_f32_16x16x64_bf16 v[28:31], v[0:3], v[52:59], v74
  s_waitcnt lgkmcnt(4)
  v_smfmac_f32_16x16x64_bf16 v[28:31], v[4:7], v[36:43], v74
  s_waitcnt lgkmcnt(2)
  v_cvt_pk_bf16_f32 v32, v32, v33
  v_cvt_pk_bf16_f32 v33, v34, v35
  v_bfi_b32 v32, 1, s72, v32
  v_smfmac_f32_16x16x64_bf16 v[28:31], v[8:11], v[44:51], v74
  buffer_store_dwordx2 v[32:33], v68, s[8:11], s76 offen sc1
  s_waitcnt lgkmcnt(0)
  v_smfmac_f32_16x16x64_bf16 v[28:31], v[12:15], v[60:67], v74
  ds_read_b128 v[0:3], v76 offset:14848
  ds_read_b64 v[16:17], v77 offset:384
  v_mov_b64 v[18:19], v[72:73]
  v_xor_b32 v75, 0x8000, v75
  s_nop 3
  v_cvt_pk_bf16_f32 v28, v28, v29
  v_cvt_pk_bf16_f32 v29, v30, v31
  v_bfi_b32 v28, 1, s72, v28
  buffer_store_dwordx2 v[28:29], v68, s[8:11], s77 offen sc1
  v_mov_b64 v[20:21], 0
  v_mov_b64 v[22:23], 0
  v_mov_b64 v[24:25], 0
  v_mov_b64 v[26:27], 0
  v_mov_b64 v[28:29], 0
  v_mov_b64 v[30:31], 0
  v_mov_b64 v[32:33], 0
  v_mov_b64 v[34:35], 0
  s_add_u32 s58, s58, 655360
  s_add_u32 s59, s59, 655360
  s_add_u32 s70, s70, 655360
  s_add_u32 s68, s68, 655360
  s_add_u32 s66, s66, 1
  s_xor_b32 s64, s64, 16384
  s_xor_b32 s65, s65, 16384
  s_nop 15
  s_nop 15
  s_nop 7
  buffer_load_dwordx4 v[52:55], v76, s[8:11], s60 offen offset:0 sc1
  buffer_load_dwordx4 v[56:59], v76, s[8:11], s60 offen offset:1024 sc1
  s_nop 15
  s_nop 11
  buffer_load_dwordx4 v[36:39], v76, s[8:11], s60 offen offset:0 sc1
  buffer_load_dwordx4 v[40:43], v76, s[8:11], s60 offen offset:1024 sc1
  s_waitcnt lgkmcnt(0)
  s_waitcnt vmcnt(3)
  v_mfma_f32_16x16x32_bf16 v[4:7], v[0:3], v[52:55], 0
  v_bitop3_b32 v72, v52, v54, s72 bitop3:0x7e
  s_waitcnt vmcnt(2)
  v_mfma_f32_16x16x32_bf16 v[4:7], v[0:3], v[56:59], v[4:7]
  v_bitop3_b32 v73, v56, v58, s72 bitop3:0x7e
  v_bitop3_b32 v72, v72, v73, 1 bitop3:0xa8
  v_cmp_ne_u32 vcc, 0, v72
  s_cbranch_vccnz Cs2_h1r
  s_nop 2
  v_add_f32_dpp v4, v4, v4 row_ror:4 row_mask:0xf bank_mask:0xf
  v_add_f32_dpp v5, v5, v5 row_ror:4 row_mask:0xf bank_mask:0xf
  s_nop 0
  v_add_f32_dpp v4, v4, v4 row_ror:8 row_mask:0xf bank_mask:0xf
  v_add_f32_dpp v5, v5, v5 row_ror:8 row_mask:0xf bank_mask:0xf
  v_cvt_pk_bf16_f32 v4, v4, v5
  buffer_store_dword v4, v69, s[8:11], s62 offen sc1
  s_xor_b32 s62, s62, 16384
  buffer_store_dword v71, v69, s[8:11], s62 offen sc1
  s_xor_b32 s72, s72, 1
  s_branch Cs2_h2
Cs2_h1r:
  s_mov_b64 exec, vcc
  buffer_load_dwordx4 v[52:55], v76, s[8:11], s60 offen offset:0 sc1
  buffer_load_dwordx4 v[56:59], v76, s[8:11], s60 offen offset:1024 sc1
  s_mov_b64 exec, -1
  s_add_u32 s67, s67, 1
  s_waitcnt vmcnt(3)
  v_mfma_f32_16x16x32_bf16 v[4:7], v[0:3], v[36:39], 0
  v_bitop3_b32 v72, v36, v38, s72 bitop3:0x7e
  s_waitcnt vmcnt(2)
  v_mfma_f32_16x16x32_bf16 v[4:7], v[0:3], v[40:43], v[4:7]
  v_bitop3_b32 v73, v40, v42, s72 bitop3:0x7e
  v_bitop3_b32 v72, v72, v73, 1 bitop3:0xa8
  v_cmp_ne_u32 vcc, 0, v72
  s_cbranch_vccz Cs2_h1p
  s_mov_b64 exec, vcc
  buffer_load_dwordx4 v[36:39], v76, s[8:11], s60 offen offset:0 sc1
  buffer_load_dwordx4 v[40:43], v76, s[8:11], s60 offen offset:1024 sc1
  s_mov_b64 exec, -1
  s_add_u32 s67, s67, 1
  s_waitcnt vmcnt(3)
  v_mfma_f32_16x16x32_bf16 v[4:7], v[0:3], v[52:55], 0
  v_bitop3_b32 v72, v52, v54, s72 bitop3:0x7e
  s_waitcnt vmcnt(2)
  v_mfma_f32_16x16x32_bf16 v[4:7], v[0:3], v[56:59], v[4:7]
  v_bitop3_b32 v73, v56, v58, s72 bitop3:0x7e
  v_bitop3_b32 v72, v72, v73, 1 bitop3:0xa8
  v_cmp_ne_u32 vcc, 0, v72
  s_cbranch_vccz Cs2_h1p
Cs2_h1s:
  s_mov_b64 exec, vcc
  buffer_load_dwordx4 v[52:55], v76, s[8:11], s60 offen offset:0 sc1
  buffer_load_dwordx4 v[56:59], v76, s[8:11], s60 offen offset:1024 sc1
  s_mov_b64 exec, -1
  s_add_u32 s67, s67, 1
  s_waitcnt vmcnt(3)
  v_mfma_f32_16x16x32_bf16 v[4:7], v[0:3], v[36:39], 0
  v_bitop3_b32 v72, v36, v38, s72 bitop3:0x7e
  s_waitcnt vmcnt(2)
  v_mfma_f32_16x16x32_bf16 v[4:7], v[0:3], v[40:43], v[4:7]
  v_bitop3_b32 v73, v40, v42, s72 bitop3:0x7e
  v_bitop3_b32 v72, v72, v73, 1 bitop3:0xa8
  v_cmp_ne_u32 vcc, 0, v72
  s_cbranch_vccz Cs2_h1p
  s_mov_b64 exec, vcc
  buffer_load_dwordx4 v[36:39], v76, s[8:11], s60 offen offset:0 sc1
  buffer_load_dwordx4 v[40:43], v76, s[8:11], s60 offen offset:1024 sc1
  s_mov_b64 exec, -1
  s_add_u32 s67, s67, 1
  s_waitcnt vmcnt(3)
  v_mfma_f32_16x16x32_bf16 v[4:7], v[0:3], v[52:55], 0
  v_bitop3_b32 v72, v52, v54, s72 bitop3:0x7e
  s_waitcnt vmcnt(2)
  v_mfma_f32_16x16x32_bf16 v[4:7], v[0:3], v[56:59], v[4:7]
  v_bitop3_b32 v73, v56, v58, s72 bitop3:0x7e
  v_bitop3_b32 v72, v72, v73, 1 bitop3:0xa8
  v_cmp_ne_u32 vcc, 0, v72
  s_cbranch_vccz Cs2_h1p
  s_cmp_lt_u32 s67, 131072
  s_cbranch_scc1 Cs2_h1s
Cs2_h1p:
  s_nop 2
  v_add_f32_dpp v4, v4, v4 row_ror:4 row_mask:0xf bank_mask:0xf
  v_add_f32_dpp v5, v5, v5 row_ror:4 row_mask:0xf bank_mask:0xf
  s_nop 0
  v_add_f32_dpp v4, v4, v4 row_ror:8 row_mask:0xf bank_mask:0xf
  v_add_f32_dpp v5, v5, v5 row_ror:8 row_mask:0xf bank_mask:0xf
  v_cvt_pk_bf16_f32 v4, v4, v5
  buffer_store_dword v4, v69, s[8:11], s62 offen sc1
  s_xor_b32 s62, s62, 16384
  buffer_store_dword v71, v69, s[8:11], s62 offen sc1
  s_xor_b32 s72, s72, 1
  s_branch Cs2_h2
Cs2_h2r:
  s_mov_b64 exec, vcc
  buffer_load_dwordx4 v[52:55], v76, s[8:11], s65 offen offset:3072 sc1
  s_mov_b64 exec, -1
  s_add_u32 s67, s67, 1
  s_waitcnt vmcnt(2)
  v_max3_u32 v72, v52, v53, v54
  v_max_u32 v72, v72, v55
  ds_write_b128 v76, v[52:55] offset:7680
  v_cmp_eq_u32 vcc, -1, v72
  s_cbranch_vccz Cs2_h2w
  s_mov_b64 exec, vcc
  buffer_load_dwordx4 v[52:55], v76, s[8:11], s65 offen offset:3072 sc1
  s_mov_b64 exec, -1
  s_add_u32 s67, s67, 1
  s_waitcnt vmcnt(2)
  v_max3_u32 v72, v52, v53, v54
  v_max_u32 v72, v72, v55
  ds_write_b128 v76, v[52:55] offset:7680
  v_cmp_eq_u32 vcc, -1, v72
  s_cbranch_vccz Cs2_h2w
  s_mov_b64 exec, vcc
  buffer_load_dwordx4 v[52:55], v76, s[8:11], s65 offen offset:3072 sc1
  s_mov_b64 exec, -1
  s_add_u32 s67, s67, 1
  s_waitcnt vmcnt(2)
  v_max3_u32 v72, v52, v53, v54
  v_max_u32 v72, v72, v55
  ds_write_b128 v76, v[52:55] offset:7680
  v_cmp_eq_u32 vcc, -1, v72
  s_cbranch_vccz Cs2_h2w
  s_mov_b64 exec, vcc
  buffer_load_dwordx4 v[52:55], v76, s[8:11], s65 offen offset:3072 sc1
  s_mov_b64 exec, -1
  s_add_u32 s67, s67, 1
  s_waitcnt vmcnt(2)
  v_max3_u32 v72, v52, v53, v54
  v_max_u32 v72, v72, v55
  ds_write_b128 v76, v[52:55] offset:7680
  v_cmp_eq_u32 vcc, -1, v72
  s_cbranch_vccz Cs2_h2w
  s_cmp_lt_u32 s67, 131072
  s_cbranch_scc1 Cs2_h2r
Cs2_h2ok:
  ds_write_b128 v76, v[52:55] offset:7680
  s_branch Cs2_h2w
Cs2_rec:
  s_nop 7
  s_waitcnt vmcnt(0) lgkmcnt(0)
  v_max3_u32 v72, v0, v1, v2
  v_max3_u32 v72, v72, v3, v4
  v_max3_u32 v72, v72, v5, v6
  v_max3_u32 v72, v72, v7, v8
  v_max3_u32 v72, v72, v9, v10
  v_max3_u32 v72, v72, v11, v12
  v_max3_u32 v72, v72, v13, v14
  v_max3_u32 v72, v72, v15, v16
  v_max3_u32 v72, v72, v17, v18
  v_max_u32 v72, v72, v19
  v_cmp_eq_u32 vcc, -1, v72
  s_cbranch_vccz Cs2_recok
  s_barrier
Cs2_recp:
  buffer_load_dwordx4 v[0:3], v76, s[8:11], s64 offen offset:0 sc1
  buffer_load_dwordx4 v[4:7], v76, s[8:11], s64 offen offset:1024 sc1
  s_add_u32 s67, s67, 1
  s_cmp_lt_u32 s67, 131072
  s_cselect_b32 s54, -2, -1
  s_waitcnt vmcnt(1)
  v_max3_u32 v72, v0, v1, v2
  s_waitcnt vmcnt(0)
  v_max3_u32 v72, v72, v3, v4
  v_max3_u32 v72, v72, v5, v6
  v_max_u32 v72, v72, v7
  v_cmp_lt_u32 vcc, s54, v72
  s_cbranch_vccnz Cs2_recp
  ds_write_b128 v76, v[0:3] offset:8704
  ds_write_b128 v76, v[4:7] offset:9728
  v_mov_b64 v[20:21], 0
  v_mov_b64 v[22:23], 0
  v_mov_b64 v[24:25], 0
  v_mov_b64 v[26:27], 0
  v_mov_b64 v[28:29], 0
  v_mov_b64 v[30:31], 0
  v_mov_b64 v[32:33], 0
  v_mov_b64 v[34:35], 0
  s_waitcnt lgkmcnt(0)
  s_barrier
  ds_read_b128 v[0:3], v76 offset:4608
  ds_read_b128 v[60:63], v76 offset:24576
  ds_read_b128 v[64:67], v76 offset:25600
  s_waitcnt lgkmcnt(0)
  v_smfmac_f32_16x16x64_bf16 v[20:23], v[0:3], v[60:67], v74
  ds_read_b128 v[60:63], v76 offset:26624
  ds_read_b128 v[64:67], v76 offset:27648
  s_waitcnt lgkmcnt(0)
  v_smfmac_f32_16x16x64_bf16 v[24:27], v[0:3], v[60:67], v74
  ds_read_b128 v[60:63], v76 offset:40960
  ds_read_b128 v[64:67], v76 offset:41984
  s_waitcnt lgkmcnt(0)
  v_smfmac_f32_16x16x64_bf16 v[28:31], v[0:3], v[60:67], v74
  ds_read_b128 v[60:63], v76 offset:43008
  ds_read_b128 v[64:67], v76 offset:44032
  s_waitcnt lgkmcnt(0)
  v_smfmac_f32_16x16x64_bf16 v[32:35], v[0:3], v[60:67], v74
  ds_read_b128 v[4:7], v76 offset:5632
  s_waitcnt lgkmcnt(0)
  v_smfmac_f32_16x16x64_bf16 v[20:23], v[4:7], v[80:87], v74
  v_smfmac_f32_16x16x64_bf16 v[24:27], v[4:7], v[88:95], v74
  v_smfmac_f32_16x16x64_bf16 v[28:31], v[4:7], v[208:215], v74
  v_smfmac_f32_16x16x64_bf16 v[32:35], v[4:7], v[216:223], v74
  ds_read_b128 v[8:11], v76 offset:6656
  s_waitcnt lgkmcnt(0)
  v_smfmac_f32_16x16x64_bf16 v[20:23], v[8:11], v[96:103], v74
  v_smfmac_f32_16x16x64_bf16 v[24:27], v[8:11], v[104:111], v74
  ds_read_b128 v[60:63], v76 offset:57344
  ds_read_b128 v[64:67], v76 offset:58368
  s_waitcnt lgkmcnt(0)
  v_smfmac_f32_16x16x64_bf16 v[28:31], v[8:11], v[60:67], v74
  ds_read_b128 v[60:63], v76 offset:59392
  ds_read_b128 v[64:67], v76 offset:60416
  s_waitcnt lgkmcnt(0)
  v_smfmac_f32_16x16x64_bf16 v[32:35], v[8:11], v[60:67], v74
  ds_read_b128 v[12:15], v76 offset:7680
  s_waitcnt lgkmcnt(0)
  v_smfmac_f32_16x16x64_bf16 v[20:23], v[12:15], v[112:119], v74
  v_smfmac_f32_16x16x64_bf16 v[24:27], v[12:15], v[120:127], v74
  v_smfmac_f32_16x16x64_bf16 v[28:31], v[12:15], v[224:231], v74
  v_smfmac_f32_16x16x64_bf16 v[32:35], v[12:15], v[232:239], v74
  ds_read_b128 v[0:3], v76 offset:8704
  s_waitcnt lgkmcnt(0)
  v_smfmac_f32_16x16x64_bf16 v[20:23], v[0:3], v[128:135], v74
  v_smfmac_f32_16x16x64_bf16 v[24:27], v[0:3], v[136:143], v74
  ds_read_b128 v[60:63], v75 offset:8192
  ds_read_b128 v[64:67], v75 offset:9216
  s_waitcnt lgkmcnt(0)
  v_smfmac_f32_16x16x64_bf16 v[28:31], v[0:3], v[60:67], v74
  ds_read_b128 v[60:63], v75 offset:10240
  ds_read_b128 v[64:67], v75 offset:11264
  s_waitcnt lgkmcnt(0)
  v_smfmac_f32_16x16x64_bf16 v[32:35], v[0:3], v[60:67], v74
  ds_read_b128 v[4:7], v76 offset:9728
  s_waitcnt lgkmcnt(0)
  v_smfmac_f32_16x16x64_bf16 v[20:23], v[4:7], v[144:151], v74
  v_smfmac_f32_16x16x64_bf16 v[24:27], v[4:7], v[152:159], v74
  ds_read_b128 v[60:63], v75 offset:24576
  ds_read_b128 v[64:67], v75 offset:25600
  s_waitcnt lgkmcnt(0)
  v_smfmac_f32_16x16x64_bf16 v[28:31], v[4:7], v[60:67], v74
  ds_read_b128 v[60:63], v75 offset:26624
  ds_read_b128 v[64:67], v75 offset:27648
  s_waitcnt lgkmcnt(0)
  v_smfmac_f32_16x16x64_bf16 v[32:35], v[4:7], v[60:67], v74
  ds_read_b128 v[16:19], v76 offset:10752
  s_waitcnt lgkmcnt(0)
  v_smfmac_f32_16x16x64_bf16 v[20:23], v[16:19], v[160:167], v74
  v_smfmac_f32_16x16x64_bf16 v[24:27], v[16:19], v[168:175], v74
  v_smfmac_f32_16x16x64_bf16 v[28:31], v[16:19], v[240:247], v74
  v_smfmac_f32_16x16x64_bf16 v[32:35], v[16:19], v[248:255], v74
  ds_read_b128 v[12:15], v76 offset:11776
  s_waitcnt lgkmcnt(0)
  v_smfmac_f32_16x16x64_bf16 v[20:23], v[12:15], v[176:183], v74
  v_smfmac_f32_16x16x64_bf16 v[24:27], v[12:15], v[184:191], v74
  v_smfmac_f32_16x16x64_bf16 v[28:31], v[12:15], a[0:7], v74
  v_smfmac_f32_16x16x64_bf16 v[32:35], v[12:15], a[8:15], v74
  ds_read_b128 v[8:11], v76 offset:12800
  s_waitcnt lgkmcnt(0)
  v_smfmac_f32_16x16x64_bf16 v[20:23], v[8:11], v[192:199], v74
  v_smfmac_f32_16x16x64_bf16 v[24:27], v[8:11], v[200:207], v74
  v_smfmac_f32_16x16x64_bf16 v[28:31], v[8:11], a[16:23], v74
  v_smfmac_f32_16x16x64_bf16 v[32:35], v[8:11], a[24:31], v74
  v_add_f32 v20, v20, v22
  v_add_f32 v21, v21, v23
  v_add_f32 v24, v24, v26
  v_cvt_pk_bf16_f32 v22, v20, v24
  s_nop 0
  ds_write_b32 v79, v22 offset:0
  v_add_f32 v25, v25, v27
  v_cvt_pk_bf16_f32 v23, v21, v25
  ds_write_b32 v79, v23 offset:576
  v_add_f32 v28, v28, v30
  v_add_f32 v29, v29, v31
  s_waitcnt lgkmcnt(0)
  s_nop 1
  s_branch Cs2_recok
Cs2_mx:
  s_waitcnt lgkmcnt(0)
  s_barrier
  buffer_load_dwordx4 v[0:3], v76, s[8:11], s58 offen offset:0 sc1
  ds_read_b128 v[20:23], v77 offset:0
  ds_read_b128 v[28:31], v77 offset:256
  buffer_load_dwordx4 v[4:7], v76, s[8:11], s58 offen offset:1024 sc1
  ds_read_b128 v[24:27], v77 offset:128
  ds_read_b128 v[32:35], v77 offset:384
  s_waitcnt vmcnt(1) lgkmcnt(3)
  v_mfma_f32_16x16x32_bf16 v[8:11], v[0:3], v[20:23], 0
  s_waitcnt vmcnt(0) lgkmcnt(1)
  v_mfma_f32_16x16x32_bf16 v[8:11], v[4:7], v[24:27], v[8:11]
  v_mfma_f32_16x16x32_bf16 v[12:15], v[28:31], v[20:23], 0
  s_waitcnt lgkmcnt(0)
  v_mfma_f32_16x16x32_bf16 v[12:15], v[32:35], v[24:27], v[12:15]
  v_add_f32_dpp v8, v10, v8 quad_perm:[2,3,0,1] row_mask:0xf bank_mask:0xf
  v_add_f32_dpp v9, v11, v9 quad_perm:[2,3,0,1] row_mask:0xf bank_mask:0xf
  s_nop 0
  v_mov_b32_dpp v8, v8 quad_perm:[0,1,0,1] row_mask:0xf bank_mask:0xf
  v_mov_b32_dpp v9, v9 quad_perm:[0,1,0,1] row_mask:0xf bank_mask:0xf
  s_nop 1
  v_add_f32_dpp v12, v14, v12 quad_perm:[2,3,0,1] row_mask:0xf bank_mask:0xf
  v_add_f32_dpp v13, v15, v13 quad_perm:[2,3,0,1] row_mask:0xf bank_mask:0xf
  s_nop 0
  v_mov_b32_dpp v12, v12 quad_perm:[0,1,0,1] row_mask:0xf bank_mask:0xf
  v_mov_b32_dpp v13, v13 quad_perm:[0,1,0,1] row_mask:0xf bank_mask:0xf
  v_mul_f32 v12, s69, v12
  ds_write_b32 v78, v8 offset:8712
  v_mul_f32 v13, s69, v13
  ds_write_b32 v78, v9 offset:8776
  s_waitcnt lgkmcnt(0)
  s_barrier
  ds_read_b128 v[36:39], v78 offset:8704
  ds_read_b128 v[40:43], v78 offset:8768
  s_waitcnt lgkmcnt(0)
  s_barrier
  v_max_f32 v16, v36, v37
  v_max3_f32 v16, v16, v38, v39
  v_max3_f32 v16, v16, v40, v41
  v_max3_f32 v16, v16, v42, v43
  v_max3_f32 v16, v16, v12, v13
  v_mov_b32 v17, v16
  s_nop 1
  v_permlane16_swap_b32 v16, v17
  v_max_f32 v16, v16, v17
  v_mov_b32 v17, v16
  s_nop 1
  v_permlane32_swap_b32 v16, v17
  v_max_f32 v16, v16, v17
  v_sub_f32 v36, v36, v16
  v_sub_f32 v37, v37, v16
  v_sub_f32 v38, v38, v16
  v_sub_f32 v39, v39, v16
  v_sub_f32 v40, v40, v16
  v_sub_f32 v41, v41, v16
  v_sub_f32 v42, v42, v16
  v_sub_f32 v43, v43, v16
  v_sub_f32 v12, v12, v16
  v_sub_f32 v13, v13, v16
  v_exp_f32 v36, v36
  v_exp_f32 v37, v37
  v_exp_f32 v38, v38
  v_exp_f32 v39, v39
  v_exp_f32 v40, v40
  v_exp_f32 v41, v41
  v_exp_f32 v42, v42
  v_exp_f32 v43, v43
  v_exp_f32 v12, v12
  v_exp_f32 v13, v13
  v_cvt_pk_bf16_f32 v32, v36, v40
  v_cvt_pk_bf16_f32 v33, v37, v41
  v_cvt_pk_bf16_f32 v34, v38, v42
  v_cvt_pk_bf16_f32 v35, v39, v43
  v_cvt_pk_bf16_f32 v28, v12, v13
  v_cvt_pk_bf16_f32 v31, v12, v13
  v_mov_b32 v29, 0
  v_mov_b32 v30, 0
  v_mov_b32 v68, 0x3f803f80
  v_mov_b32 v69, 0x3f803f80
  v_mov_b32 v70, 0x3f803f80
  v_mov_b32 v71, 0x3f803f80
  s_nop 1
  v_mfma_f32_16x16x32_bf16 v[8:11], v[32:35], v[68:71], 0
  v_mfma_f32_16x16x32_bf16 v[0:3], v[32:35], v[52:55], 0
  v_mfma_f32_16x16x32_bf16 v[4:7], v[32:35], v[56:59], 0
  v_mfma_f32_16x16x16_bf16 v[8:11], v[28:29], v[68:69], v[8:11]
  v_mfma_f32_16x16x16_bf16 v[0:3], v[28:29], v[72:73], v[0:3]
  v_mfma_f32_16x16x16_bf16 v[4:7], v[30:31], v[72:73], v[4:7]
  ds_read_b128 v[68:71], v76 offset:13824
  v_rcp_f32 v10, v8
  v_rcp_f32 v11, v9
  v_mul_f32 v0, v10, v0
  v_mul_f32 v1, v11, v1
  s_nop 0
  v_mul_f32 v4, v10, v4
  v_mul_f32 v5, v11, v5
  v_cvt_pk_bf16_f32 v2, v0, v4
  ds_write_b32 v79, v2 offset:8704
  v_cvt_pk_bf16_f32 v3, v1, v5
  ds_write_b32 v79, v3 offset:9280
  v_mov_b64 v[16:17], 0
  v_mov_b64 v[18:19], 0
  v_mov_b64 v[20:21], 0
  v_mov_b64 v[22:23], 0
  v_mov_b64 v[24:25], 0
  v_mov_b64 v[26:27], 0
  s_branch Cs2_mxok
Cs2_last:
  s_waitcnt lgkmcnt(0)
  ds_read_b64 v[16:17], v77 offset:384
  v_mov_b64 v[18:19], v[72:73]
  s_add_u32 s68, s68, 655360
  s_waitcnt lgkmcnt(0)
  buffer_store_dwordx4 v[16:19], v76, s[8:11], s68 offen sc1
  s_branch L_cexit
L_w7:
  v_mov_b64 v[20:21], 0
  v_mov_b64 v[22:23], 0
  v_mov_b64 v[24:25], 0
  v_mov_b64 v[26:27], 0
  v_mov_b64 v[28:29], 0
  v_mov_b64 v[30:31], 0
  v_mov_b64 v[32:33], 0
  v_mov_b64 v[34:35], 0
  s_mov_b32 s78, 0x3f803f80
  s_mov_b32 s79, s78
  s_mov_b32 s65, 360448
  s_mov_b32 m0, 15872
  v_lshlrev_b32 v73, 2, v76
  v_mov_b32 v72, 0
  ds_read_b128 v[60:63], v76 offset:28672
  ds_read_b128 v[64:67], v76 offset:29696
  ds_read_b128 v[44:47], v76 offset:30720
  ds_read_b128 v[48:51], v76 offset:31744
  ds_read_b128 v[36:39], v76 offset:45056
  ds_read_b128 v[40:43], v76 offset:46080
  ds_read_b128 v[0:3], v76 offset:4608
  ds_read_b128 v[4:7], v76 offset:5632
  s_branch Cs3_top2
.p2align 6
Cs3_h2:
  v_lshlrev_b32 v73, 2, v76
  s_mov_b32 m0, 10752
  s_waitcnt vmcnt(4)
  ds_read_b128 v[60:63], v76 offset:28672
  ds_read_b128 v[64:67], v76 offset:29696
  ds_read_b128 v[44:47], v76 offset:30720
  ds_read_b128 v[48:51], v76 offset:31744
  ds_read_b128 v[36:39], v76 offset:45056
  ds_read_b128 v[40:43], v76 offset:46080
  s_cmp_eq_u32 s66, 12
  s_cbranch_scc1 Cs3_kv2
Cs3_h2w:
  s_waitcnt lgkmcnt(0)
  s_barrier
  ds_read_b128 v[0:3], v76 offset:4608
  ds_read_b128 v[4:7], v76 offset:5632
  buffer_load_dwordx4 v76, s[8:11], s64 offen offset:0 sc1 lds
  buffer_load_dwordx4 v76, s[8:11], s64 offen offset:1024 sc1 lds
  buffer_load_dwordx4 v76, s[8:11], s64 offen offset:2048 sc1 lds
Cs3_top2:
  ds_read_b128 v[8:11], v76 offset:6656
  s_mov_b32 m0, 15872
  s_waitcnt lgkmcnt(2)
  v_smfmac_f32_16x16x64_bf16 v[20:23], v[0:3], v[60:67], v74
  ds_read_b128 v[60:63], v76 offset:47104
  v_smfmac_f32_16x16x64_bf16 v[24:27], v[0:3], v[44:51], v74
  buffer_load_dwordx4 v[44:47], v76, s[8:11], s58 offen offset:0 sc1
  ds_read_b128 v[64:67], v76 offset:48128
  s_waitcnt lgkmcnt(3)
  v_smfmac_f32_16x16x64_bf16 v[20:23], v[4:7], v[80:87], v74
  buffer_load_dwordx4 v[48:51], v76, s[8:11], s58 offen offset:1024 sc1
  v_smfmac_f32_16x16x64_bf16 v[28:31], v[0:3], v[36:43], v74
  buffer_load_dwordx4 v[52:55], v76, s[8:11], s59 offen offset:0 sc1
  ds_read_b128 v[36:39], v76 offset:61440
  v_smfmac_f32_16x16x64_bf16 v[24:27], v[4:7], v[88:95], v74
  buffer_load_dwordx4 v[56:59], v76, s[8:11], s59 offen offset:1024 sc1
  ds_read_b128 v[40:43], v76 offset:62464
  v_smfmac_f32_16x16x64_bf16 v[28:31], v[4:7], v[208:215], v74
  ds_read_b128 v[12:15], v76 offset:7680
  s_waitcnt lgkmcnt(5)
  v_smfmac_f32_16x16x64_bf16 v[32:35], v[4:7], v[216:223], v74
  buffer_store_dwordx4 v[16:19], v76, s[8:11], s68 offen sc1
  s_waitcnt lgkmcnt(3)
  v_smfmac_f32_16x16x64_bf16 v[32:35], v[0:3], v[60:67], v74
  buffer_load_dword v73, s[8:11], s70 offen  lds
  v_smfmac_f32_16x16x64_bf16 v[20:23], v[8:11], v[96:103], v74
  ds_read_b128 v[60:63], v76 offset:63488
  v_smfmac_f32_16x16x64_bf16 v[24:27], v[8:11], v[104:111], v74
  ds_read_b128 v[64:67], v76 offset:64512
  s_waitcnt lgkmcnt(3)
  v_smfmac_f32_16x16x64_bf16 v[28:31], v[8:11], v[36:43], v74
  ds_read_b128 v[36:39], v75 offset:12288
  s_waitcnt lgkmcnt(3)
  v_smfmac_f32_16x16x64_bf16 v[20:23], v[12:15], v[112:119], v74
  ds_read_b128 v[40:43], v75 offset:13312
  v_smfmac_f32_16x16x64_bf16 v[24:27], v[12:15], v[120:127], v74
  s_waitcnt vmcnt(6)
  v_smfmac_f32_16x16x64_bf16 v[28:31], v[12:15], v[224:231], v74
  s_barrier
  ds_read_b128 v[0:3], v76 offset:8704
  v_smfmac_f32_16x16x64_bf16 v[32:35], v[12:15], v[232:239], v74
  ds_read_b128 v[4:7], v76 offset:9728
  s_waitcnt lgkmcnt(4)
  v_smfmac_f32_16x16x64_bf16 v[32:35], v[8:11], v[60:67], v74
  ds_read_b128 v[60:63], v75 offset:14336
  s_waitcnt lgkmcnt(2)
  v_smfmac_f32_16x16x64_bf16 v[20:23], v[0:3], v[128:135], v74
  ds_read_b128 v[16:19], v76 offset:10752
  v_smfmac_f32_16x16x64_bf16 v[24:27], v[0:3], v[136:143], v74
  ds_read_b128 v[64:67], v75 offset:15360
  v_smfmac_f32_16x16x64_bf16 v[28:31], v[0:3], v[36:43], v74
  ds_read_b128 v[36:39], v75 offset:28672
  s_waitcnt lgkmcnt(4)
  v_smfmac_f32_16x16x64_bf16 v[20:23], v[4:7], v[144:151], v74
  ds_read_b128 v[12:15], v76 offset:11776
  v_smfmac_f32_16x16x64_bf16 v[24:27], v[4:7], v[152:159], v74
  ds_read_b128 v[40:43], v75 offset:29696
  s_waitcnt lgkmcnt(4)
  v_smfmac_f32_16x16x64_bf16 v[20:23], v[16:19], v[160:167], v74
  ds_read_b128 v[8:11], v76 offset:12800
  s_waitcnt lgkmcnt(4)
  v_smfmac_f32_16x16x64_bf16 v[32:35], v[0:3], v[60:67], v74
  ds_read_b128 v[60:63], v75 offset:30720
  v_mov_b64 v[68:69], s[78:79]
  v_smfmac_f32_16x16x64_bf16 v[24:27], v[16:19], v[168:175], v74
  ds_read_b128 v[64:67], v75 offset:31744
  s_waitcnt lgkmcnt(4)
  v_smfmac_f32_16x16x64_bf16 v[20:23], v[12:15], v[176:183], v74
  s_waitcnt lgkmcnt(3)
  v_mov_b64 v[70:71], s[78:79]
  v_smfmac_f32_16x16x64_bf16 v[28:31], v[4:7], v[36:43], v74
  s_waitcnt lgkmcnt(2)
  v_mov_b64 v[36:37], 0
  v_smfmac_f32_16x16x64_bf16 v[20:23], v[8:11], v[192:199], v74
  v_mov_b64 v[38:39], 0
  v_smfmac_f32_16x16x64_bf16 v[24:27], v[12:15], v[184:191], v74
  v_mov_b64 v[40:41], 0
  v_smfmac_f32_16x16x64_bf16 v[24:27], v[8:11], v[200:207], v74
  s_waitcnt lgkmcnt(0)
  v_add_f32 v20, v20, v22
  v_smfmac_f32_16x16x64_bf16 v[32:35], v[4:7], v[60:67], v74
  v_add_f32 v21, v21, v23
  v_smfmac_f32_16x16x64_bf16 v[28:31], v[16:19], v[240:247], v74
  v_add_f32 v24, v24, v26
  v_cvt_pk_bf16_f32 v22, v20, v24
  v_smfmac_f32_16x16x64_bf16 v[28:31], v[12:15], a[0:7], v74
  ds_write_b32 v79, v22 offset:0
  v_add_f32 v25, v25, v27
  v_cvt_pk_bf16_f32 v23, v21, v25
  v_smfmac_f32_16x16x64_bf16 v[28:31], v[8:11], a[16:23], v74
  ds_write_b32 v79, v23 offset:576
  v_cmp_u_f32 vcc, v20, v21
  v_smfmac_f32_16x16x64_bf16 v[32:35], v[16:19], v[248:255], v74
  v_mov_b64 v[42:43], 0
  v_smfmac_f32_16x16x64_bf16 v[32:35], v[12:15], a[8:15], v74
  v_add_f32 v28, v28, v30
  v_add_f32 v29, v29, v31
  v_smfmac_f32_16x16x64_bf16 v[32:35], v[8:11], a[24:31], v74
  s_cbranch_vccnz Cs3_rec
Cs3_recok:
  v_smfmac_f32_16x16x64_bf16 v[36:39], v[16:19], a[128:135], v74
  s_waitcnt lgkmcnt(0)
  s_barrier
  ds_read_b128 v[60:63], v77
  v_smfmac_f32_16x16x64_bf16 v[40:43], v[16:19], a[136:143], v74
  ds_read_b128 v[64:67], v77 offset:128
  v_add_f32 v32, v32, v34
  v_cvt_pk_bf16_f32 v30, v28, v32
  v_smfmac_f32_16x16x64_bf16 v[36:39], v[0:3], a[96:103], v74
  ds_write_b32 v79, v30 offset:256
  v_add_f32 v33, v33, v35
  v_cvt_pk_bf16_f32 v31, v29, v33
  v_smfmac_f32_16x16x64_bf16 v[40:43], v[0:3], a[104:111], v74
  ds_write_b32 v79, v31 offset:832
  v_xor_b32 v75, 0x8000, v75
  v_smfmac_f32_16x16x64_bf16 v[36:39], v[4:7], a[112:119], v74
  ds_read_b128 v[0:3], v76 offset:4608
  v_mov_b32 v29, 0
  v_smfmac_f32_16x16x64_bf16 v[40:43], v[4:7], a[120:127], v74
  s_waitcnt vmcnt(4) lgkmcnt(3)
  v_mov_b32 v30, 0
  v_mfma_f32_16x16x32_bf16 v[44:47], v[44:47], v[60:63], 0
  ds_read_b128 v[4:7], v76 offset:5632
  s_waitcnt lgkmcnt(2)
  v_mfma_f32_16x16x32_bf16 v[44:47], v[48:51], v[64:67], v[44:47]
  s_barrier
  v_smfmac_f32_16x16x64_bf16 v[36:39], v[8:11], a[160:167], v74
  ds_read_b128 v[20:23], v77 offset:256
  ds_read_b128 v[24:27], v77 offset:384
  v_smfmac_f32_16x16x64_bf16 v[40:43], v[8:11], a[168:175], v74
  ds_read_b128 v[8:11], v76 offset:6656
  v_add_f32_dpp v72, v46, v44 quad_perm:[2,3,0,1] row_mask:0xf bank_mask:0xf
  v_add_f32_dpp v73, v47, v45 quad_perm:[2,3,0,1] row_mask:0xf bank_mask:0xf
  v_smfmac_f32_16x16x64_bf16 v[36:39], v[12:15], a[144:151], v74
  s_waitcnt lgkmcnt(4)
  v_exp_f32_dpp v72, v72 quad_perm:[0,1,0,1] row_mask:0xf bank_mask:0xf
  v_smfmac_f32_16x16x64_bf16 v[40:43], v[12:15], a[152:159], v74
  ds_read_b128 v[12:15], v76 offset:7680
  v_exp_f32_dpp v73, v73 quad_perm:[0,1,0,1] row_mask:0xf bank_mask:0xf
  v_smfmac_f32_16x16x64_bf16 v[36:39], v[0:3], a[32:39], v74
  s_waitcnt lgkmcnt(2)
  v_cvt_pk_bf16_f32 v72, v72, v73
  v_mfma_f32_16x16x32_bf16 v[20:23], v[20:23], v[60:63], 0
  ds_write_b32 v78, v72 offset:524
  v_mov_b64 v[16:17], 0
  v_mfma_f32_16x16x32_bf16 v[20:23], v[24:27], v[64:67], v[20:23]
  ds_read_b128 v[44:47], v75 offset:28672
  v_mov_b64 v[18:19], 0
  v_smfmac_f32_16x16x64_bf16 v[40:43], v[0:3], a[40:47], v74
  ds_read_b128 v[48:51], v75 offset:29696
  s_waitcnt lgkmcnt(4)
  v_smfmac_f32_16x16x64_bf16 v[36:39], v[4:7], a[48:55], v74
  v_add_f32_dpp v24, v22, v20 quad_perm:[2,3,0,1] row_mask:0xf bank_mask:0xf
  v_add_f32_dpp v25, v23, v21 quad_perm:[2,3,0,1] row_mask:0xf bank_mask:0xf
  v_smfmac_f32_16x16x64_bf16 v[36:39], v[8:11], a[64:71], v74
  s_waitcnt lgkmcnt(2)
  s_barrier
  ds_read_b128 v[32:35], v78 offset:512
  v_smfmac_f32_16x16x64_bf16 v[36:39], v[12:15], a[80:87], v74
  ds_read_b128 v[60:63], v75 offset:30720
  v_mul_f32 v24, s69, v24
  v_smfmac_f32_16x16x64_bf16 v[40:43], v[4:7], a[56:63], v74
  ds_read_b128 v[64:67], v75 offset:31744
  v_mul_f32 v25, s69, v25
  v_smfmac_f32_16x16x64_bf16 v[40:43], v[8:11], a[72:79], v74
  v_exp_f32_dpp v24, v24 quad_perm:[0,1,0,1] row_mask:0xf bank_mask:0xf
  v_smfmac_f32_16x16x64_bf16 v[40:43], v[12:15], a[88:95], v74
  s_waitcnt vmcnt(2) lgkmcnt(2)
  v_exp_f32_dpp v25, v25 quad_perm:[0,1,0,1] row_mask:0xf bank_mask:0xf
  v_mfma_f32_16x16x32_bf16 v[8:11], v[32:35], v[68:71], 0
  v_add_f32 v36, v36, v38
  v_add_f32 v37, v37, v39
  v_mfma_f32_16x16x32_bf16 v[0:3], v[32:35], v[52:55], 0
  v_add_f32 v40, v40, v42
  v_add_f32 v41, v41, v43
  v_mfma_f32_16x16x32_bf16 v[4:7], v[32:35], v[56:59], 0
  v_cvt_pk_bf16_f32 v28, v24, v25
  v_cvt_pk_bf16_f32 v72, v36, v37
  v_cvt_pk_bf16_f32 v73, v40, v41
  v_mfma_f32_16x16x16_bf16 v[8:11], v[28:29], v[68:69], v[8:11]
  v_cvt_pk_bf16_f32 v31, v24, v25
  v_mov_b64 v[20:21], 0
  v_mfma_f32_16x16x16_bf16 v[0:3], v[28:29], v[72:73], v[0:3]
  ds_read_b128 v[68:71], v76 offset:13824
  v_mov_b64 v[22:23], 0
  v_mfma_f32_16x16x16_bf16 v[4:7], v[30:31], v[72:73], v[4:7]
  v_rcp_f32 v10, v8
  v_rcp_f32 v11, v9
  v_mul_f32 v0, v10, v0
  v_mul_f32 v1, v11, v1
  s_nop 0
  v_mul_f32 v4, v10, v4
  v_mul_f32 v5, v11, v5
  v_cvt_pk_bf16_f32 v2, v0, v4
  ds_write_b32 v79, v2 offset:8704
  v_cvt_pk_bf16_f32 v3, v1, v5
  ds_write_b32 v79, v3 offset:9280
  v_max3_f32 v8, v8, v9, v10
  v_max_f32 v8, v8, v11
  v_cmp_le_f32 vcc, 1317011456, v8
  v_mov_b64 v[24:25], 0
  v_mov_b64 v[26:27], 0
  s_cbranch_vccnz Cs3_mx
Cs3_mxok:
  s_waitcnt lgkmcnt(0)
  s_barrier
  ds_read_b128 v[0:3], v78 offset:8704
  ds_read_b128 v[4:7], v78 offset:8768
  ds_read_b128 v[8:11], v78 offset:8832
  ds_read_b128 v[12:15], v78 offset:8896
  s_cmp_eq_u32 s66, 63
  s_cbranch_scc1 Cs3_last
  s_waitcnt lgkmcnt(3)
  v_smfmac_f32_16x16x64_bf16 v[16:19], v[0:3], v[44:51], v74
  ds_read_b128 v[52:55], v75 offset:45056
  s_waitcnt lgkmcnt(3)
  v_smfmac_f32_16x16x64_bf16 v[16:19], v[4:7], v[60:67], v74
  ds_read_b128 v[56:59], v75 offset:46080
  s_waitcnt lgkmcnt(3)
  v_smfmac_f32_16x16x64_bf16 v[16:19], v[8:11], a[176:183], v74
  ds_read_b128 v[36:39], v75 offset:47104
  s_waitcnt lgkmcnt(3)
  v_smfmac_f32_16x16x64_bf16 v[16:19], v[12:15], a[184:191], v74
  ds_read_b128 v[40:43], v75 offset:48128
  ds_read_b128 v[44:47], v75 offset:61440
  v_smfmac_f32_16x16x64_bf16 v[20:23], v[0:3], a[192:199], v74
  ds_read_b128 v[48:51], v75 offset:62464
  ds_read_b128 v[60:63], v75 offset:63488
  v_smfmac_f32_16x16x64_bf16 v[20:23], v[4:7], a[200:207], v74
  ds_read_b128 v[64:67], v75 offset:64512
  s_waitcnt lgkmcnt(6)
  v_cvt_pk_bf16_f32 v16, v16, v17
  v_cvt_pk_bf16_f32 v17, v18, v19
  v_bfi_b32 v16, 1, s72, v16
  v_smfmac_f32_16x16x64_bf16 v[20:23], v[8:11], v[52:59], v74
  buffer_store_dwordx2 v[16:17], v68, s[8:11], s73 offen sc1
  s_waitcnt lgkmcnt(4)
  v_smfmac_f32_16x16x64_bf16 v[20:23], v[12:15], v[36:43], v74
  ds_read_b128 v[52:55], v75 offset:8192
  v_mov_b64 v[32:33], 0
  v_smfmac_f32_16x16x64_bf16 v[24:27], v[0:3], a[208:215], v74
  ds_read_b128 v[56:59], v75 offset:9216
  v_mov_b64 v[34:35], 0
  v_smfmac_f32_16x16x64_bf16 v[24:27], v[4:7], a[216:223], v74
  ds_read_b128 v[36:39], v75 offset:10240
  s_waitcnt lgkmcnt(5)
  v_cvt_pk_bf16_f32 v20, v20, v21
  v_cvt_pk_bf16_f32 v21, v22, v23
  v_bfi_b32 v20, 1, s72, v20
  v_smfmac_f32_16x16x64_bf16 v[24:27], v[8:11], v[44:51], v74
  buffer_store_dwordx2 v[20:21], v68, s[8:11], s74 offen sc1
  s_waitcnt lgkmcnt(3)
  v_smfmac_f32_16x16x64_bf16 v[24:27], v[12:15], v[60:67], v74
  ds_read_b128 v[40:43], v75 offset:11264
  v_mov_b64 v[28:29], 0
  v_smfmac_f32_16x16x64_bf16 v[32:35], v[0:3], a[224:231], v74
  ds_read_b128 v[44:47], v75 offset:12288
  ds_read_b128 v[48:51], v75 offset:13312
  v_smfmac_f32_16x16x64_bf16 v[32:35], v[4:7], a[232:239], v74
  ds_read_b128 v[60:63], v75 offset:14336
  v_cvt_pk_bf16_f32 v24, v24, v25
  v_cvt_pk_bf16_f32 v25, v26, v27
  v_bfi_b32 v24, 1, s72, v24
  v_smfmac_f32_16x16x64_bf16 v[32:35], v[8:11], a[240:247], v74
  buffer_store_dwordx2 v[24:25], v68, s[8:11], s75 offen sc1
  v_mov_b64 v[30:31], 0
  v_smfmac_f32_16x16x64_bf16 v[32:35], v[12:15], a[248:255], v74
  ds_read_b128 v[64:67], v75 offset:15360
  s_waitcnt lgkmcnt(6)
  v_smfmac_f32_16x16x64_bf16 v[28:31], v[0:3], v[52:59], v74
  s_waitcnt lgkmcnt(4)
  v_smfmac_f32_16x16x64_bf16 v[28:31], v[4:7], v[36:43], v74
  s_waitcnt lgkmcnt(2)
  v_cvt_pk_bf16_f32 v32, v32, v33
  v_cvt_pk_bf16_f32 v33, v34, v35
  v_bfi_b32 v32, 1, s72, v32
  v_smfmac_f32_16x16x64_bf16 v[28:31], v[8:11], v[44:51], v74
  buffer_store_dwordx2 v[32:33], v68, s[8:11], s76 offen sc1
  s_waitcnt lgkmcnt(0)
  v_smfmac_f32_16x16x64_bf16 v[28:31], v[12:15], v[60:67], v74
  ds_read_b128 v[52:55], v76 offset:14848
  ds_read_b64 v[16:17], v77 offset:392
  v_mov_b64 v[18:19], v[72:73]
  v_xor_b32 v75, 0x8000, v75
  s_nop 3
  v_cvt_pk_bf16_f32 v28, v28, v29
  v_cvt_pk_bf16_f32 v29, v30, v31
  v_bfi_b32 v28, 1, s72, v28
  buffer_store_dwordx2 v[28:29], v68, s[8:11], s77 offen sc1
  v_mov_b64 v[20:21], 0
  v_mov_b64 v[22:23], 0
  v_mov_b64 v[24:25], 0
  v_mov_b64 v[26:27], 0
  v_mov_b64 v[28:29], 0
  v_mov_b64 v[30:31], 0
  v_mov_b64 v[32:33], 0
  v_mov_b64 v[34:35], 0
  s_add_u32 s58, s58, 655360
  s_add_u32 s59, s59, 655360
  s_add_u32 s70, s70, 655360
  s_add_u32 s68, s68, 655360
  s_add_u32 s66, s66, 1
  s_xor_b32 s64, s64, 16384
  s_xor_b32 s65, s65, 16384
  s_nop 15
  s_nop 15
  s_nop 15
  s_nop 9
  buffer_load_dwordx4 v[0:3], v76, s[8:11], s60 offen offset:0 sc1
  buffer_load_dwordx4 v[4:7], v76, s[8:11], s60 offen offset:1024 sc1
  buffer_load_dwordx4 v[8:11], v76, s[8:11], s61 offen offset:0 sc1
  buffer_load_dwordx4 v[12:15], v76, s[8:11], s61 offen offset:1024 sc1
  s_nop 15
  s_nop 11
  buffer_load_dwordx4 v[44:47], v76, s[8:11], s60 offen offset:0 sc1
  buffer_load_dwordx4 v[48:51], v76, s[8:11], s60 offen offset:1024 sc1
  buffer_load_dwordx4 v[60:63], v76, s[8:11], s61 offen offset:0 sc1
  buffer_load_dwordx4 v[64:67], v76, s[8:11], s61 offen offset:1024 sc1
  s_waitcnt lgkmcnt(0)
  s_cmp_eq_u32 s66, 12
  s_cbranch_scc1 Cs3_kv
Cs3_kvb:
  s_waitcnt vmcnt(7)
  v_mfma_f32_16x16x32_bf16 v[56:59], v[52:55], v[0:3], 0
  v_bitop3_b32 v72, v0, v2, s72 bitop3:0x7e
  s_waitcnt vmcnt(6)
  v_mfma_f32_16x16x32_bf16 v[56:59], v[52:55], v[4:7], v[56:59]
  v_bitop3_b32 v73, v4, v6, s72 bitop3:0x7e
  v_or_b32 v72, v72, v73
  s_waitcnt vmcnt(5)
  v_mfma_f32_16x16x32_bf16 v[36:39], v[52:55], v[8:11], 0
  v_bitop3_b32 v73, v8, v10, s72 bitop3:0x7e
  v_or_b32 v72, v72, v73
  s_waitcnt vmcnt(4)
  v_mfma_f32_16x16x32_bf16 v[36:39], v[52:55], v[12:15], v[36:39]
  v_bitop3_b32 v73, v12, v14, s72 bitop3:0x7e
  v_bitop3_b32 v72, v72, v73, 1 bitop3:0xa8
  v_cmp_ne_u32 vcc, 0, v72
  s_cbranch_vccnz Cs3_h1r
  v_add_f32_dpp v56, v56, v56 row_ror:4 row_mask:0xf bank_mask:0xf
  v_add_f32_dpp v57, v57, v57 row_ror:4 row_mask:0xf bank_mask:0xf
  s_nop 0
  v_add_f32_dpp v36, v36, v36 row_ror:4 row_mask:0xf bank_mask:0xf
  v_add_f32_dpp v37, v37, v37 row_ror:4 row_mask:0xf bank_mask:0xf
  v_add_f32_dpp v56, v56, v56 row_ror:8 row_mask:0xf bank_mask:0xf
  v_add_f32_dpp v57, v57, v57 row_ror:8 row_mask:0xf bank_mask:0xf
  v_add_f32_dpp v36, v36, v36 row_ror:8 row_mask:0xf bank_mask:0xf
  v_add_f32_dpp v37, v37, v37 row_ror:8 row_mask:0xf bank_mask:0xf
  v_cvt_pk_bf16_f32 v56, v56, v57
  buffer_store_dword v56, v69, s[8:11], s62 offen sc1
  v_cvt_pk_bf16_f32 v36, v36, v37
  buffer_store_dword v36, v70, s[8:11], s63 offen sc1
  s_xor_b32 s62, s62, 16384
  buffer_store_dword v71, v69, s[8:11], s62 offen sc1
  s_xor_b32 s63, s63, 16384
  buffer_store_dword v71, v70, s[8:11], s63 offen sc1
  s_xor_b32 s72, s72, 1
  s_branch Cs3_h2
Cs3_h1r:
  s_mov_b64 exec, vcc
  buffer_load_dwordx4 v[0:3], v76, s[8:11], s60 offen offset:0 sc1
  buffer_load_dwordx4 v[4:7], v76, s[8:11], s60 offen offset:1024 sc1
  buffer_load_dwordx4 v[8:11], v76, s[8:11], s61 offen offset:0 sc1
  buffer_load_dwordx4 v[12:15], v76, s[8:11], s61 offen offset:1024 sc1
  s_mov_b64 exec, -1
  s_add_u32 s67, s67, 1
  s_waitcnt vmcnt(7)
  v_mfma_f32_16x16x32_bf16 v[56:59], v[52:55], v[44:47], 0
  v_bitop3_b32 v72, v44, v46, s72 bitop3:0x7e
  s_waitcnt vmcnt(6)
  v_mfma_f32_16x16x32_bf16 v[56:59], v[52:55], v[48:51], v[56:59]
  v_bitop3_b32 v73, v48, v50, s72 bitop3:0x7e
  v_or_b32 v72, v72, v73
  s_waitcnt vmcnt(5)
  v_mfma_f32_16x16x32_bf16 v[36:39], v[52:55], v[60:63], 0
  v_bitop3_b32 v73, v60, v62, s72 bitop3:0x7e
  v_or_b32 v72, v72, v73
  s_waitcnt vmcnt(4)
  v_mfma_f32_16x16x32_bf16 v[36:39], v[52:55], v[64:67], v[36:39]
  v_bitop3_b32 v73, v64, v66, s72 bitop3:0x7e
  v_bitop3_b32 v72, v72, v73, 1 bitop3:0xa8
  v_cmp_ne_u32 vcc, 0, v72
  s_cbranch_vccz Cs3_h1p
  s_mov_b64 exec, vcc
  buffer_load_dwordx4 v[44:47], v76, s[8:11], s60 offen offset:0 sc1
  buffer_load_dwordx4 v[48:51], v76, s[8:11], s60 offen offset:1024 sc1
  buffer_load_dwordx4 v[60:63], v76, s[8:11], s61 offen offset:0 sc1
  buffer_load_dwordx4 v[64:67], v76, s[8:11], s61 offen offset:1024 sc1
  s_mov_b64 exec, -1
  s_add_u32 s67, s67, 1
  s_waitcnt vmcnt(7)
  v_mfma_f32_16x16x32_bf16 v[56:59], v[52:55], v[0:3], 0
  v_bitop3_b32 v72, v0, v2, s72 bitop3:0x7e
  s_waitcnt vmcnt(6)
  v_mfma_f32_16x16x32_bf16 v[56:59], v[52:55], v[4:7], v[56:59]
  v_bitop3_b32 v73, v4, v6, s72 bitop3:0x7e
  v_or_b32 v72, v72, v73
  s_waitcnt vmcnt(5)
  v_mfma_f32_16x16x32_bf16 v[36:39], v[52:55], v[8:11], 0
  v_bitop3_b32 v73, v8, v10, s72 bitop3:0x7e
  v_or_b32 v72, v72, v73
  s_waitcnt vmcnt(4)
  v_mfma_f32_16x16x32_bf16 v[36:39], v[52:55], v[12:15], v[36:39]
  v_bitop3_b32 v73, v12, v14, s72 bitop3:0x7e
  v_bitop3_b32 v72, v72, v73, 1 bitop3:0xa8
  v_cmp_ne_u32 vcc, 0, v72
  s_cbranch_vccz Cs3_h1p
Cs3_h1s:
  s_mov_b64 exec, vcc
  buffer_load_dwordx4 v[0:3], v76, s[8:11], s60 offen offset:0 sc1
  buffer_load_dwordx4 v[4:7], v76, s[8:11], s60 offen offset:1024 sc1
  buffer_load_dwordx4 v[8:11], v76, s[8:11], s61 offen offset:0 sc1
  buffer_load_dwordx4 v[12:15], v76, s[8:11], s61 offen offset:1024 sc1
  s_mov_b64 exec, -1
  s_add_u32 s67, s67, 1
  s_waitcnt vmcnt(7)
  v_mfma_f32_16x16x32_bf16 v[56:59], v[52:55], v[44:47], 0
  v_bitop3_b32 v72, v44, v46, s72 bitop3:0x7e
  s_waitcnt vmcnt(6)
  v_mfma_f32_16x16x32_bf16 v[56:59], v[52:55], v[48:51], v[56:59]
  v_bitop3_b32 v73, v48, v50, s72 bitop3:0x7e
  v_or_b32 v72, v72, v73
  s_waitcnt vmcnt(5)
  v_mfma_f32_16x16x32_bf16 v[36:39], v[52:55], v[60:63], 0
  v_bitop3_b32 v73, v60, v62, s72 bitop3:0x7e
  v_or_b32 v72, v72, v73
  s_waitcnt vmcnt(4)
  v_mfma_f32_16x16x32_bf16 v[36:39], v[52:55], v[64:67], v[36:39]
  v_bitop3_b32 v73, v64, v66, s72 bitop3:0x7e
  v_bitop3_b32 v72, v72, v73, 1 bitop3:0xa8
  v_cmp_ne_u32 vcc, 0, v72
  s_cbranch_vccz Cs3_h1p
  s_mov_b64 exec, vcc
  buffer_load_dwordx4 v[44:47], v76, s[8:11], s60 offen offset:0 sc1
  buffer_load_dwordx4 v[48:51], v76, s[8:11], s60 offen offset:1024 sc1
  buffer_load_dwordx4 v[60:63], v76, s[8:11], s61 offen offset:0 sc1
  buffer_load_dwordx4 v[64:67], v76, s[8:11], s61 offen offset:1024 sc1
  s_mov_b64 exec, -1
  s_add_u32 s67, s67, 1
  s_waitcnt vmcnt(7)
  v_mfma_f32_16x16x32_bf16 v[56:59], v[52:55], v[0:3], 0
  v_bitop3_b32 v72, v0, v2, s72 bitop3:0x7e
  s_waitcnt vmcnt(6)
  v_mfma_f32_16x16x32_bf16 v[56:59], v[52:55], v[4:7], v[56:59]
  v_bitop3_b32 v73, v4, v6, s72 bitop3:0x7e
  v_or_b32 v72, v72, v73
  s_waitcnt vmcnt(5)
  v_mfma_f32_16x16x32_bf16 v[36:39], v[52:55], v[8:11], 0
  v_bitop3_b32 v73, v8, v10, s72 bitop3:0x7e
  v_or_b32 v72, v72, v73
  s_waitcnt vmcnt(4)
  v_mfma_f32_16x16x32_bf16 v[36:39], v[52:55], v[12:15], v[36:39]
  v_bitop3_b32 v73, v12, v14, s72 bitop3:0x7e
  v_bitop3_b32 v72, v72, v73, 1 bitop3:0xa8
  v_cmp_ne_u32 vcc, 0, v72
  s_cbranch_vccz Cs3_h1p
  s_cmp_lt_u32 s67, 131072
  s_cbranch_scc1 Cs3_h1s
Cs3_h1p:
  s_nop 2
  v_add_f32_dpp v56, v56, v56 row_ror:4 row_mask:0xf bank_mask:0xf
  v_add_f32_dpp v57, v57, v57 row_ror:4 row_mask:0xf bank_mask:0xf
  v_add_f32_dpp v36, v36, v36 row_ror:4 row_mask:0xf bank_mask:0xf
  v_add_f32_dpp v37, v37, v37 row_ror:4 row_mask:0xf bank_mask:0xf
  v_add_f32_dpp v56, v56, v56 row_ror:8 row_mask:0xf bank_mask:0xf
  v_add_f32_dpp v57, v57, v57 row_ror:8 row_mask:0xf bank_mask:0xf
  v_add_f32_dpp v36, v36, v36 row_ror:8 row_mask:0xf bank_mask:0xf
  v_add_f32_dpp v37, v37, v37 row_ror:8 row_mask:0xf bank_mask:0xf
  v_cvt_pk_bf16_f32 v56, v56, v57
  buffer_store_dword v56, v69, s[8:11], s62 offen sc1
  v_cvt_pk_bf16_f32 v36, v36, v37
  buffer_store_dword v36, v70, s[8:11], s63 offen sc1
  s_xor_b32 s62, s62, 16384
  buffer_store_dword v71, v69, s[8:11], s62 offen sc1
  s_xor_b32 s63, s63, 16384
  buffer_store_dword v71, v70, s[8:11], s63 offen sc1
  s_xor_b32 s72, s72, 1
  s_branch Cs3_h2
Cs3_rec:
  s_nop 7
  s_waitcnt vmcnt(0) lgkmcnt(0)
  v_max3_u32 v72, v0, v1, v2
  v_max3_u32 v72, v72, v3, v4
  v_max3_u32 v72, v72, v5, v6
  v_max3_u32 v72, v72, v7, v8
  v_max3_u32 v72, v72, v9, v10
  v_max3_u32 v72, v72, v11, v12
  v_max3_u32 v72, v72, v13, v14
  v_max3_u32 v72, v72, v15, v16
  v_max3_u32 v72, v72, v17, v18
  v_max_u32 v72, v72, v19
  v_cmp_eq_u32 vcc, -1, v72
  s_cbranch_vccz Cs3_recok
  s_barrier
Cs3_recp:
  buffer_load_dwordx4 v[0:3], v76, s[8:11], s64 offen offset:0 sc1
  buffer_load_dwordx4 v[4:7], v76, s[8:11], s64 offen offset:1024 sc1
  buffer_load_dwordx4 v[8:11], v76, s[8:11], s64 offen offset:2048 sc1
  s_add_u32 s67, s67, 1
  s_cmp_lt_u32 s67, 131072
  s_cselect_b32 s54, -2, -1
  s_waitcnt vmcnt(2)
  v_max3_u32 v72, v0, v1, v2
  s_waitcnt vmcnt(1)
  v_max3_u32 v72, v72, v3, v4
  v_max3_u32 v72, v72, v5, v6
  s_waitcnt vmcnt(0)
  v_max3_u32 v72, v72, v7, v8
  v_max3_u32 v72, v72, v9, v10
  v_max_u32 v72, v72, v11
  v_cmp_lt_u32 vcc, s54, v72
  s_cbranch_vccnz Cs3_recp
  ds_write_b128 v76, v[0:3] offset:10752
  ds_write_b128 v76, v[4:7] offset:11776
  ds_write_b128 v76, v[8:11] offset:12800
  v_mov_b64 v[20:21], 0
  v_mov_b64 v[22:23], 0
  v_mov_b64 v[24:25], 0
  v_mov_b64 v[26:27], 0
  v_mov_b64 v[28:29], 0
  v_mov_b64 v[30:31], 0
  v_mov_b64 v[32:33], 0
  v_mov_b64 v[34:35], 0
  s_waitcnt lgkmcnt(0)
  s_barrier
  ds_read_b128 v[0:3], v76 offset:4608
  ds_read_b128 v[60:63], v76 offset:28672
  ds_read_b128 v[64:67], v76 offset:29696
  s_waitcnt lgkmcnt(0)
  v_smfmac_f32_16x16x64_bf16 v[20:23], v[0:3], v[60:67], v74
  ds_read_b128 v[60:63], v76 offset:30720
  ds_read_b128 v[64:67], v76 offset:31744
  s_waitcnt lgkmcnt(0)
  v_smfmac_f32_16x16x64_bf16 v[24:27], v[0:3], v[60:67], v74
  ds_read_b128 v[60:63], v76 offset:45056
  ds_read_b128 v[64:67], v76 offset:46080
  s_waitcnt lgkmcnt(0)
  v_smfmac_f32_16x16x64_bf16 v[28:31], v[0:3], v[60:67], v74
  ds_read_b128 v[60:63], v76 offset:47104
  ds_read_b128 v[64:67], v76 offset:48128
  s_waitcnt lgkmcnt(0)
  v_smfmac_f32_16x16x64_bf16 v[32:35], v[0:3], v[60:67], v74
  ds_read_b128 v[4:7], v76 offset:5632
  s_waitcnt lgkmcnt(0)
  v_smfmac_f32_16x16x64_bf16 v[20:23], v[4:7], v[80:87], v74
  v_smfmac_f32_16x16x64_bf16 v[24:27], v[4:7], v[88:95], v74
  v_smfmac_f32_16x16x64_bf16 v[28:31], v[4:7], v[208:215], v74
  v_smfmac_f32_16x16x64_bf16 v[32:35], v[4:7], v[216:223], v74
  ds_read_b128 v[8:11], v76 offset:6656
  s_waitcnt lgkmcnt(0)
  v_smfmac_f32_16x16x64_bf16 v[20:23], v[8:11], v[96:103], v74
  v_smfmac_f32_16x16x64_bf16 v[24:27], v[8:11], v[104:111], v74
  ds_read_b128 v[60:63], v76 offset:61440
  ds_read_b128 v[64:67], v76 offset:62464
  s_waitcnt lgkmcnt(0)
  v_smfmac_f32_16x16x64_bf16 v[28:31], v[8:11], v[60:67], v74
  ds_read_b128 v[60:63], v76 offset:63488
  ds_read_b128 v[64:67], v76 offset:64512
  s_waitcnt lgkmcnt(0)
  v_smfmac_f32_16x16x64_bf16 v[32:35], v[8:11], v[60:67], v74
  ds_read_b128 v[12:15], v76 offset:7680
  s_waitcnt lgkmcnt(0)
  v_smfmac_f32_16x16x64_bf16 v[20:23], v[12:15], v[112:119], v74
  v_smfmac_f32_16x16x64_bf16 v[24:27], v[12:15], v[120:127], v74
  v_smfmac_f32_16x16x64_bf16 v[28:31], v[12:15], v[224:231], v74
  v_smfmac_f32_16x16x64_bf16 v[32:35], v[12:15], v[232:239], v74
  ds_read_b128 v[0:3], v76 offset:8704
  s_waitcnt lgkmcnt(0)
  v_smfmac_f32_16x16x64_bf16 v[20:23], v[0:3], v[128:135], v74
  v_smfmac_f32_16x16x64_bf16 v[24:27], v[0:3], v[136:143], v74
  ds_read_b128 v[60:63], v75 offset:12288
  ds_read_b128 v[64:67], v75 offset:13312
  s_waitcnt lgkmcnt(0)
  v_smfmac_f32_16x16x64_bf16 v[28:31], v[0:3], v[60:67], v74
  ds_read_b128 v[60:63], v75 offset:14336
  ds_read_b128 v[64:67], v75 offset:15360
  s_waitcnt lgkmcnt(0)
  v_smfmac_f32_16x16x64_bf16 v[32:35], v[0:3], v[60:67], v74
  ds_read_b128 v[4:7], v76 offset:9728
  s_waitcnt lgkmcnt(0)
  v_smfmac_f32_16x16x64_bf16 v[20:23], v[4:7], v[144:151], v74
  v_smfmac_f32_16x16x64_bf16 v[24:27], v[4:7], v[152:159], v74
  ds_read_b128 v[60:63], v75 offset:28672
  ds_read_b128 v[64:67], v75 offset:29696
  s_waitcnt lgkmcnt(0)
  v_smfmac_f32_16x16x64_bf16 v[28:31], v[4:7], v[60:67], v74
  ds_read_b128 v[60:63], v75 offset:30720
  ds_read_b128 v[64:67], v75 offset:31744
  s_waitcnt lgkmcnt(0)
  v_smfmac_f32_16x16x64_bf16 v[32:35], v[4:7], v[60:67], v74
  ds_read_b128 v[16:19], v76 offset:10752
  s_waitcnt lgkmcnt(0)
  v_smfmac_f32_16x16x64_bf16 v[20:23], v[16:19], v[160:167], v74
  v_smfmac_f32_16x16x64_bf16 v[24:27], v[16:19], v[168:175], v74
  v_smfmac_f32_16x16x64_bf16 v[28:31], v[16:19], v[240:247], v74
  v_smfmac_f32_16x16x64_bf16 v[32:35], v[16:19], v[248:255], v74
  ds_read_b128 v[12:15], v76 offset:11776
  s_waitcnt lgkmcnt(0)
  v_smfmac_f32_16x16x64_bf16 v[20:23], v[12:15], v[176:183], v74
  v_smfmac_f32_16x16x64_bf16 v[24:27], v[12:15], v[184:191], v74
  v_smfmac_f32_16x16x64_bf16 v[28:31], v[12:15], a[0:7], v74
  v_smfmac_f32_16x16x64_bf16 v[32:35], v[12:15], a[8:15], v74
  ds_read_b128 v[8:11], v76 offset:12800
  s_waitcnt lgkmcnt(0)
  v_smfmac_f32_16x16x64_bf16 v[20:23], v[8:11], v[192:199], v74
  v_smfmac_f32_16x16x64_bf16 v[24:27], v[8:11], v[200:207], v74
  v_smfmac_f32_16x16x64_bf16 v[28:31], v[8:11], a[16:23], v74
  v_smfmac_f32_16x16x64_bf16 v[32:35], v[8:11], a[24:31], v74
  v_add_f32 v20, v20, v22
  v_add_f32 v21, v21, v23
  v_add_f32 v24, v24, v26
  v_cvt_pk_bf16_f32 v22, v20, v24
  s_nop 0
  ds_write_b32 v79, v22 offset:0
  v_add_f32 v25, v25, v27
  v_cvt_pk_bf16_f32 v23, v21, v25
  ds_write_b32 v79, v23 offset:576
  v_add_f32 v28, v28, v30
  v_add_f32 v29, v29, v31
  s_waitcnt lgkmcnt(0)
  s_nop 1
  s_branch Cs3_recok
Cs3_mx:
  s_waitcnt lgkmcnt(0)
  s_barrier
  buffer_load_dwordx4 v[0:3], v76, s[8:11], s58 offen offset:0 sc1
  ds_read_b128 v[20:23], v77 offset:0
  ds_read_b128 v[28:31], v77 offset:256
  buffer_load_dwordx4 v[4:7], v76, s[8:11], s58 offen offset:1024 sc1
  ds_read_b128 v[24:27], v77 offset:128
  ds_read_b128 v[32:35], v77 offset:384
  s_waitcnt vmcnt(1) lgkmcnt(3)
  v_mfma_f32_16x16x32_bf16 v[8:11], v[0:3], v[20:23], 0
  s_waitcnt vmcnt(0) lgkmcnt(1)
  v_mfma_f32_16x16x32_bf16 v[8:11], v[4:7], v[24:27], v[8:11]
  v_mfma_f32_16x16x32_bf16 v[12:15], v[28:31], v[20:23], 0
  s_waitcnt lgkmcnt(0)
  v_mfma_f32_16x16x32_bf16 v[12:15], v[32:35], v[24:27], v[12:15]
  v_add_f32_dpp v8, v10, v8 quad_perm:[2,3,0,1] row_mask:0xf bank_mask:0xf
  v_add_f32_dpp v9, v11, v9 quad_perm:[2,3,0,1] row_mask:0xf bank_mask:0xf
  s_nop 0
  v_mov_b32_dpp v8, v8 quad_perm:[0,1,0,1] row_mask:0xf bank_mask:0xf
  v_mov_b32_dpp v9, v9 quad_perm:[0,1,0,1] row_mask:0xf bank_mask:0xf
  s_nop 1
  v_add_f32_dpp v12, v14, v12 quad_perm:[2,3,0,1] row_mask:0xf bank_mask:0xf
  v_add_f32_dpp v13, v15, v13 quad_perm:[2,3,0,1] row_mask:0xf bank_mask:0xf
  s_nop 0
  v_mov_b32_dpp v12, v12 quad_perm:[0,1,0,1] row_mask:0xf bank_mask:0xf
  v_mov_b32_dpp v13, v13 quad_perm:[0,1,0,1] row_mask:0xf bank_mask:0xf
  v_mul_f32 v12, s69, v12
  ds_write_b32 v78, v8 offset:8716
  v_mul_f32 v13, s69, v13
  ds_write_b32 v78, v9 offset:8780
  s_waitcnt lgkmcnt(0)
  s_barrier
  ds_read_b128 v[36:39], v78 offset:8704
  ds_read_b128 v[40:43], v78 offset:8768
  s_waitcnt lgkmcnt(0)
  s_barrier
  v_max_f32 v16, v36, v37
  v_max3_f32 v16, v16, v38, v39
  v_max3_f32 v16, v16, v40, v41
  v_max3_f32 v16, v16, v42, v43
  v_max3_f32 v16, v16, v12, v13
  v_mov_b32 v17, v16
  s_nop 1
  v_permlane16_swap_b32 v16, v17
  v_max_f32 v16, v16, v17
  v_mov_b32 v17, v16
  s_nop 1
  v_permlane32_swap_b32 v16, v17
  v_max_f32 v16, v16, v17
  v_sub_f32 v36, v36, v16
  v_sub_f32 v37, v37, v16
  v_sub_f32 v38, v38, v16
  v_sub_f32 v39, v39, v16
  v_sub_f32 v40, v40, v16
  v_sub_f32 v41, v41, v16
  v_sub_f32 v42, v42, v16
  v_sub_f32 v43, v43, v16
  v_sub_f32 v12, v12, v16
  v_sub_f32 v13, v13, v16
  v_exp_f32 v36, v36
  v_exp_f32 v37, v37
  v_exp_f32 v38, v38
  v_exp_f32 v39, v39
  v_exp_f32 v40, v40
  v_exp_f32 v41, v41
  v_exp_f32 v42, v42
  v_exp_f32 v43, v43
  v_exp_f32 v12, v12
  v_exp_f32 v13, v13
  v_cvt_pk_bf16_f32 v32, v36, v40
  v_cvt_pk_bf16_f32 v33, v37, v41
  v_cvt_pk_bf16_f32 v34, v38, v42
  v_cvt_pk_bf16_f32 v35, v39, v43
  v_cvt_pk_bf16_f32 v28, v12, v13
  v_cvt_pk_bf16_f32 v31, v12, v13
  v_mov_b32 v29, 0
  v_mov_b32 v30, 0
  v_mov_b32 v68, 0x3f803f80
  v_mov_b32 v69, 0x3f803f80
  v_mov_b32 v70, 0x3f803f80
  v_mov_b32 v71, 0x3f803f80
  s_nop 1
  v_mfma_f32_16x16x32_bf16 v[8:11], v[32:35], v[68:71], 0
  v_mfma_f32_16x16x32_bf16 v[0:3], v[32:35], v[52:55], 0
  v_mfma_f32_16x16x32_bf16 v[4:7], v[32:35], v[56:59], 0
  v_mfma_f32_16x16x16_bf16 v[8:11], v[28:29], v[68:69], v[8:11]
  v_mfma_f32_16x16x16_bf16 v[0:3], v[28:29], v[72:73], v[0:3]
  v_mfma_f32_16x16x16_bf16 v[4:7], v[30:31], v[72:73], v[4:7]
  ds_read_b128 v[68:71], v76 offset:13824
  v_rcp_f32 v10, v8
  v_rcp_f32 v11, v9
  v_mul_f32 v0, v10, v0
  v_mul_f32 v1, v11, v1
  s_nop 0
  v_mul_f32 v4, v10, v4
  v_mul_f32 v5, v11, v5
  v_cvt_pk_bf16_f32 v2, v0, v4
  ds_write_b32 v79, v2 offset:8704
  v_cvt_pk_bf16_f32 v3, v1, v5
  ds_write_b32 v79, v3 offset:9280
  v_mov_b64 v[16:17], 0
  v_mov_b64 v[18:19], 0
  v_mov_b64 v[20:21], 0
  v_mov_b64 v[22:23], 0
  v_mov_b64 v[24:25], 0
  v_mov_b64 v[26:27], 0
  s_branch Cs3_mxok
Cs3_kv:
  s_lshl_b32 s56, s53, 2
  s_add_u32 s56, s56, 128
  s_load_dword s57, s[12:13], s56 glc
  s_branch Cs3_kvb
Cs3_kv2:
  s_waitcnt lgkmcnt(0)
  s_cmp_ge_u32 s57, 0x700
  s_cbranch_scc1 Cs3_h2w
  s_load_dword s57, s[12:13], s56 glc
  s_add_u32 s67, s67, 1
  s_cmp_lt_u32 s67, 131072
  s_cbranch_scc1 Cs3_kv2
  s_branch Cs3_h2w
Cs3_last:
  s_waitcnt lgkmcnt(0)
  ds_read_b64 v[16:17], v77 offset:392
  v_mov_b64 v[18:19], v[72:73]
  s_add_u32 s68, s68, 655360
  s_waitcnt lgkmcnt(0)
  buffer_store_dwordx4 v[16:19], v76, s[8:11], s68 offen sc1
  s_branch L_cexit
L_conf:
  s_waitcnt vmcnt(0) lgkmcnt(0)
  s_barrier
  s_cmp_eq_u32 s52, 0
  s_cbranch_scc0 L_cf2
  s_mov_b64 exec, 1
  s_lshl_b32 s57, s2, 2
  v_mov_b32 v1, 0
L_cf0:
  s_cmp_eq_u32 s54, -1
  s_cbranch_scc1 L_cf1
  s_mov_b32 s55, s54
  s_lshr_b64 s[54:55], s[54:55], s0
  s_ff0_i32_b32 s56, s54
  s_add_u32 s0, s0, s56
  s_and_b32 s0, s0, 31
  s_lshl_b32 s56, 1, s0
  v_mov_b32 v35, s56
  buffer_atomic_or v35, v1, s[12:15], s57 offen sc0
  s_waitcnt vmcnt(0)
  v_readfirstlane_b32 s54, v35
  s_nop 0
  s_bitcmp1_b32 s54, s0
  s_cbranch_scc1 L_cf0
  v_mov_b32 v35, s0
  s_branch L_cf3
L_cf1:
  v_mov_b32 v35, 1
  buffer_atomic_add v35, v1, s[12:15], 0 offen offset:40 sc0
  s_waitcnt vmcnt(0)
  v_add_u32 v35, 32, v35
L_cf3:
  ds_write_b32 v33, v35
  s_mov_b64 exec, -1
  s_waitcnt lgkmcnt(0)
L_cf2:
  s_barrier
  ds_read_b32 v32, v33
  s_waitcnt lgkmcnt(0)
  v_readfirstlane_b32 s0, v32
  s_mov_b32 s1, 1
  s_cmp_lt_u32 s0, 32
  s_cbranch_scc1 L_role
  s_sub_u32 s53, s0, 32
  s_mov_b32 s57, 0
L_sur:
  s_load_dwordx16 s[60:75], s[12:13], 0 glc
  s_add_u32 s57, s57, 1
  s_waitcnt lgkmcnt(0)
  s_mov_b32 s55, s70
  s_bcnt1_i32_b32 s56, s60
  s_add_u32 s55, s55, s56
  s_bcnt1_i32_b32 s56, s61
  s_add_u32 s55, s55, s56
  s_bcnt1_i32_b32 s56, s62
  s_add_u32 s55, s55, s56
  s_bcnt1_i32_b32 s56, s63
  s_add_u32 s55, s55, s56
  s_bcnt1_i32_b32 s56, s64
  s_add_u32 s55, s55, s56
  s_bcnt1_i32_b32 s56, s65
  s_add_u32 s55, s55, s56
  s_bcnt1_i32_b32 s56, s66
  s_add_u32 s55, s55, s56
  s_bcnt1_i32_b32 s56, s67
  s_add_u32 s55, s55, s56
  s_cmp_ge_u32 s57, 131072
  s_cbranch_scc1 L_end
  s_cmp_lt_u32 s55, 256
  s_cbranch_scc1 L_sur
  s_mov_b32 s2, 0
  s_mov_b32 s54, s60
  s_bcnt0_i32_b32 s56, s54
  s_cmp_lt_u32 s53, s56
  s_cbranch_scc1 L_sur2
  s_sub_u32 s53, s53, s56
  s_mov_b32 s2, 1
  s_mov_b32 s54, s61
  s_bcnt0_i32_b32 s56, s54
  s_cmp_lt_u32 s53, s56
  s_cbranch_scc1 L_sur2
  s_sub_u32 s53, s53, s56
  s_mov_b32 s2, 2
  s_mov_b32 s54, s62
  s_bcnt0_i32_b32 s56, s54
  s_cmp_lt_u32 s53, s56
  s_cbranch_scc1 L_sur2
  s_sub_u32 s53, s53, s56
  s_mov_b32 s2, 3
  s_mov_b32 s54, s63
  s_bcnt0_i32_b32 s56, s54
  s_cmp_lt_u32 s53, s56
  s_cbranch_scc1 L_sur2
  s_sub_u32 s53, s53, s56
  s_mov_b32 s2, 4
  s_mov_b32 s54, s64
  s_bcnt0_i32_b32 s56, s54
  s_cmp_lt_u32 s53, s56
  s_cbranch_scc1 L_sur2
  s_sub_u32 s53, s53, s56
  s_mov_b32 s2, 5
  s_mov_b32 s54, s65
  s_bcnt0_i32_b32 s56, s54
  s_cmp_lt_u32 s53, s56
  s_cbranch_scc1 L_sur2
  s_sub_u32 s53, s53, s56
  s_mov_b32 s2, 6
  s_mov_b32 s54, s66
  s_bcnt0_i32_b32 s56, s54
  s_cmp_lt_u32 s53, s56
  s_cbranch_scc1 L_sur2
  s_sub_u32 s53, s53, s56
  s_mov_b32 s2, 7
  s_mov_b32 s54, s67
  s_bcnt0_i32_b32 s56, s54
  s_cmp_lt_u32 s53, s56
  s_cbranch_scc1 L_sur2
  s_sub_u32 s53, s53, s56
  s_branch L_end
L_sur2:
  s_ff0_i32_b32 s0, s54
  s_bitset1_b32 s54, s0
  s_sub_u32 s53, s53, 1
  s_cbranch_scc0 L_sur2
  s_branch L_role
L_worker:
  s_lshl_b32 s54, s2, 2
  s_lshr_b32 s54, 1412567136, s54
  s_and_b32 s54, s54, 7
  s_lshl_b32 s54, s54, 5
  s_add_u32 s53, s53, s54
  s_getpc_b64 s[80:81]
L_pc_2:
  s_and_b32 s55, s0, 1
  s_lshl_b32 s55, s55, 2
  s_add_u32 s55, s55, s52
  s_lshl_b32 s55, s55, 13
  v_and_b32 v199, 63, v0
  v_lshl_add_u32 v199, v199, 7, s55
  s_sub_u32 s82, s80, (L_pc_2 - L_w0)
  s_subb_u32 s83, s81, 0
  v_min_u32 v198, (L_w4 - L_w0), v199
  global_load_dword v196, v198, s[82:83]
  v_min_u32 v199, (L_end - L_pc_2), v199
  global_load_dword v196, v199, s[80:81]
  v_and_b32 v200, 63, v0
  v_lshlrev_b32 v201, 4, v200
  v_lshrrev_b32 v211, 3, v200
  s_lshl_b32 s54, s52, 3
  v_add_u32 v211, s54, v211
  v_bfe_u32 v212, v211, 1, 3
  v_and_b32 v213, 7, v200
  v_xor_b32 v212, v212, v213
  v_mul_u32_u24 v211, 1152, v211
  v_lshl_add_u32 v202, v212, 4, v211
  s_mul_i32 s67, s52, 9216
  v_and_b32 v211, 31, v200
  v_lshrrev_b32 v212, 3, v211
  v_mul_u32_u24 v212, 9216, v212
  v_and_b32 v213, 7, v211
  v_lshl_add_u32 v212, v213, 7, v212
  v_bfe_u32 v213, v211, 1, 3
  v_lshrrev_b32 v214, 5, v200
  v_xor_b32 v213, v213, v214
  v_lshl_add_u32 v203, v213, 4, v212
  v_xor_b32 v204, 32, v203
  v_xor_b32 v205, 64, v203
  v_xor_b32 v206, 0x60, v203
  v_bfe_u32 v211, v200, 2, 2
  v_lshl_add_u32 v212, v214, 3, v211
  v_lshlrev_b32 v212, 8, v212
  v_xor_b32 v211, s52, v211
  v_lshl_add_u32 v212, v211, 6, v212
  v_bfe_u32 v213, v200, 4, 1
  v_and_b32 v211, 3, v200
  v_lshl_add_u32 v210, v213, 5, v212
  v_lshl_add_u32 v210, v211, 3, v210
  v_lshl_add_u32 v209, v213, 4, v212
  v_and_b32 v213, 1, v211
  v_lshl_add_u32 v209, v213, 3, v209
  v_lshrrev_b32 v213, 1, v211
  v_lshl_add_u32 v209, v213, 5, v209
  s_mov_b32 s65, 0
  s_mul_i32 s58, s53, 9363
  s_lshr_b32 s58, s58, 16
  s_mul_i32 s54, s58, 7
  s_sub_u32 s59, s53, s54
  s_mul_i32 s60, s59, 36864
  s_add_u32 m0, s67, 0
  s_nop 0
  buffer_load_dwordx4 v202, s[4:7], s60 offen offset:0 lds
  s_add_u32 m0, s67, 896
  s_nop 0
  buffer_load_dwordx4 v202, s[4:7], s60 offen offset:128 lds
  s_add_u32 m0, s67, 1792
  s_nop 0
  buffer_load_dwordx4 v202, s[4:7], s60 offen offset:256 lds
  s_add_u32 m0, s67, 2688
  s_nop 0
  buffer_load_dwordx4 v202, s[4:7], s60 offen offset:384 lds
  s_add_u32 m0, s67, 3584
  s_nop 0
  buffer_load_dwordx4 v202, s[4:7], s60 offen offset:512 lds
  s_add_u32 m0, s67, 4480
  s_nop 0
  buffer_load_dwordx4 v202, s[4:7], s60 offen offset:640 lds
  s_add_u32 m0, s67, 5376
  s_nop 0
  buffer_load_dwordx4 v202, s[4:7], s60 offen offset:768 lds
  s_add_u32 m0, s67, 6272
  s_nop 0
  buffer_load_dwordx4 v202, s[4:7], s60 offen offset:896 lds
  s_add_u32 m0, s67, 7168
  s_nop 0
  buffer_load_dwordx4 v202, s[4:7], s60 offen offset:1024 lds
  v_lshrrev_b32 v211, 4, v200
  v_lshlrev_b32 v212, 2, v211
  v_and_b32 v213, 15, v200
  v_xor_b32 v212, v212, v213
  v_lshlrev_b32 v212, 4, v212
  v_lshl_add_u32 v207, v211, 13, v212
  s_lshl_b32 s62, s58, 8
  s_lshl_b32 s54, s52, 15
  s_add_u32 s62, s62, s54
  s_lshl_b32 s61, s52, 10
  s_add_u32 s61, s61, 36864
  s_add_u32 m0, s61, 0
  s_add_u32 s54, s62, 0
  buffer_load_dwordx4 v207, s[20:23], s54 offen lds
  s_add_u32 m0, s61, 4096
  s_add_u32 s54, s62, 131072
  buffer_load_dwordx4 v207, s[20:23], s54 offen lds
  s_add_u32 m0, s61, 8192
  s_add_u32 s54, s62, 262144
  buffer_load_dwordx4 v207, s[20:23], s54 offen lds
  s_add_u32 m0, s61, 12288
  s_add_u32 s54, s62, 393216
  buffer_load_dwordx4 v207, s[20:23], s54 offen lds
  s_add_u32 m0, s61, 16384
  s_add_u32 s54, s62, 0
  buffer_load_dwordx4 v207, s[24:27], s54 offen lds
  s_add_u32 m0, s61, 20480
  s_add_u32 s54, s62, 131072
  buffer_load_dwordx4 v207, s[24:27], s54 offen lds
  s_add_u32 m0, s61, 24576
  s_add_u32 s54, s62, 262144
  buffer_load_dwordx4 v207, s[24:27], s54 offen lds
  s_add_u32 m0, s61, 28672
  s_add_u32 s54, s62, 393216
  buffer_load_dwordx4 v207, s[24:27], s54 offen lds
  s_add_u32 m0, s61, 32768
  s_add_u32 s54, s62, 524288
  buffer_load_dwordx4 v207, s[20:23], s54 offen lds
  s_add_u32 m0, s61, 36864
  s_add_u32 s54, s62, 655360
  buffer_load_dwordx4 v207, s[20:23], s54 offen lds
  s_add_u32 m0, s61, 40960
  s_add_u32 s54, s62, 786432
  buffer_load_dwordx4 v207, s[20:23], s54 offen lds
  s_add_u32 m0, s61, 45056
  s_add_u32 s54, s62, 917504
  buffer_load_dwordx4 v207, s[20:23], s54 offen lds
  s_add_u32 m0, s61, 49152
  s_add_u32 s54, s62, 524288
  buffer_load_dwordx4 v207, s[24:27], s54 offen lds
  s_add_u32 m0, s61, 53248
  s_add_u32 s54, s62, 655360
  buffer_load_dwordx4 v207, s[24:27], s54 offen lds
  s_add_u32 m0, s61, 57344
  s_add_u32 s54, s62, 786432
  buffer_load_dwordx4 v207, s[24:27], s54 offen lds
  s_add_u32 m0, s61, 61440
  s_add_u32 s54, s62, 917504
  buffer_load_dwordx4 v207, s[24:27], s54 offen lds
  s_add_u32 m0, s61, 65536
  s_add_u32 s54, s62, 1048576
  buffer_load_dwordx4 v207, s[20:23], s54 offen lds
  s_add_u32 m0, s61, 69632
  s_add_u32 s54, s62, 1179648
  buffer_load_dwordx4 v207, s[20:23], s54 offen lds
  s_add_u32 m0, s61, 73728
  s_add_u32 s54, s62, 1310720
  buffer_load_dwordx4 v207, s[20:23], s54 offen lds
  s_add_u32 m0, s61, 77824
  s_add_u32 s54, s62, 1441792
  buffer_load_dwordx4 v207, s[20:23], s54 offen lds
  s_add_u32 m0, s61, 81920
  s_add_u32 s54, s62, 1048576
  buffer_load_dwordx4 v207, s[24:27], s54 offen lds
  s_add_u32 m0, s61, 86016
  s_add_u32 s54, s62, 1179648
  buffer_load_dwordx4 v207, s[24:27], s54 offen lds
  s_add_u32 m0, s61, 90112
  s_add_u32 s54, s62, 1310720
  buffer_load_dwordx4 v207, s[24:27], s54 offen lds
  s_add_u32 m0, s61, 94208
  s_add_u32 s54, s62, 1441792
  buffer_load_dwordx4 v207, s[24:27], s54 offen lds
  v_bfe_u32 v211, v200, 3, 2
  v_lshlrev_b32 v216, 11, v211
  v_bfe_u32 v211, v200, 1, 2
  v_lshl_add_u32 v216, v211, 6, v216
  v_lshrrev_b32 v212, 5, v200
  v_lshl_add_u32 v216, v212, 5, v216
  v_and_b32 v211, 1, v200
  v_lshl_add_u32 v216, v211, 4, v216
  v_bfe_u32 v211, v200, 4, 1
  v_lshlrev_b32 v217, 10, v211
  v_lshl_add_u32 v217, v212, 9, v217
  v_and_b32 v211, 15, v200
  v_lshl_add_u32 v217, v211, 4, v217
  s_lshl_b32 s54, s52, 11
  s_add_u32 s54, s54, 8192
  v_add_u32 v217, s54, v217
  s_cmp_eq_u32 s1, 1
  s_cbranch_scc1 W_ver_ok
  v_mov_b32 v33, 163832
  s_cmp_eq_u32 s52, 0
  s_cbranch_scc0 W_ver_b
  s_waitcnt vmcnt(35)
  s_mov_b64 exec, 1
  ds_write_b32 v33, v35
  s_mov_b64 exec, -1
  s_waitcnt lgkmcnt(0)
W_ver_b:
  s_barrier
  ds_read_b32 v32, v33
  s_waitcnt lgkmcnt(0)
  v_readfirstlane_b32 s54, v32
  s_nop 0
  s_bitcmp1_b32 s54, s0
  s_cbranch_scc1 L_conf
W_ver_ok:
  s_waitcnt vmcnt(20) lgkmcnt(0)
  s_barrier
  s_add_u32 m0, s61, 98304
  s_add_u32 s54, s62, 1572864
  buffer_load_dwordx4 v207, s[20:23], s54 offen lds
  s_add_u32 m0, s61, 102400
  s_add_u32 s54, s62, 1703936
  buffer_load_dwordx4 v207, s[20:23], s54 offen lds
  s_add_u32 m0, s61, 106496
  s_add_u32 s54, s62, 1835008
  buffer_load_dwordx4 v207, s[20:23], s54 offen lds
  s_add_u32 m0, s61, 110592
  s_add_u32 s54, s62, 1966080
  buffer_load_dwordx4 v207, s[20:23], s54 offen lds
  v_add_u32 v215, 36864, v209
  ds_read_b64_tr_b16 a[0:1], v215 offset:0
  ds_read_b64_tr_b16 a[2:3], v215 offset:1024
  ds_read_b64_tr_b16 a[4:5], v215 offset:4096
  ds_read_b64_tr_b16 a[6:7], v215 offset:5120
  ds_read_b64_tr_b16 a[8:9], v215 offset:8192
  ds_read_b64_tr_b16 a[10:11], v215 offset:9216
  ds_read_b64_tr_b16 a[12:13], v215 offset:12288
  ds_read_b64_tr_b16 a[14:15], v215 offset:13312
  s_waitcnt vmcnt(20) lgkmcnt(0)
  s_barrier
  s_add_u32 m0, s61, 0
  s_add_u32 s54, s62, 1572864
  buffer_load_dwordx4 v207, s[24:27], s54 offen lds
  s_add_u32 m0, s61, 4096
  s_add_u32 s54, s62, 1703936
  buffer_load_dwordx4 v207, s[24:27], s54 offen lds
  s_add_u32 m0, s61, 8192
  s_add_u32 s54, s62, 1835008
  buffer_load_dwordx4 v207, s[24:27], s54 offen lds
  s_add_u32 m0, s61, 12288
  s_add_u32 s54, s62, 1966080
  buffer_load_dwordx4 v207, s[24:27], s54 offen lds
  v_add_u32 v215, 53248, v210
  ds_read_b64_tr_b16 a[144:145], v215 offset:0
  ds_read_b64_tr_b16 a[146:147], v215 offset:1024
  ds_read_b64_tr_b16 a[148:149], v215 offset:4096
  ds_read_b64_tr_b16 a[150:151], v215 offset:5120
  ds_read_b64_tr_b16 a[152:153], v215 offset:8192
  ds_read_b64_tr_b16 a[154:155], v215 offset:9216
  ds_read_b64_tr_b16 a[156:157], v215 offset:12288
  ds_read_b64_tr_b16 a[158:159], v215 offset:13312
  s_waitcnt vmcnt(20) lgkmcnt(0)
  s_barrier
  s_add_u32 m0, s61, 16384
  s_add_u32 s54, s62, 2097152
  buffer_load_dwordx4 v207, s[20:23], s54 offen lds
  s_add_u32 m0, s61, 20480
  s_add_u32 s54, s62, 2228224
  buffer_load_dwordx4 v207, s[20:23], s54 offen lds
  s_add_u32 m0, s61, 24576
  s_add_u32 s54, s62, 2359296
  buffer_load_dwordx4 v207, s[20:23], s54 offen lds
  s_add_u32 m0, s61, 28672
  s_add_u32 s54, s62, 2490368
  buffer_load_dwordx4 v207, s[20:23], s54 offen lds
  v_add_u32 v215, 69632, v209
  ds_read_b64_tr_b16 a[16:17], v215 offset:0
  ds_read_b64_tr_b16 a[18:19], v215 offset:1024
  ds_read_b64_tr_b16 a[20:21], v215 offset:4096
  ds_read_b64_tr_b16 a[22:23], v215 offset:5120
  ds_read_b64_tr_b16 a[24:25], v215 offset:8192
  ds_read_b64_tr_b16 a[26:27], v215 offset:9216
  ds_read_b64_tr_b16 a[28:29], v215 offset:12288
  ds_read_b64_tr_b16 a[30:31], v215 offset:13312
  s_waitcnt vmcnt(20) lgkmcnt(0)
  s_barrier
  s_add_u32 m0, s61, 32768
  s_add_u32 s54, s62, 2097152
  buffer_load_dwordx4 v207, s[24:27], s54 offen lds
  s_add_u32 m0, s61, 36864
  s_add_u32 s54, s62, 2228224
  buffer_load_dwordx4 v207, s[24:27], s54 offen lds
  s_add_u32 m0, s61, 40960
  s_add_u32 s54, s62, 2359296
  buffer_load_dwordx4 v207, s[24:27], s54 offen lds
  s_add_u32 m0, s61, 45056
  s_add_u32 s54, s62, 2490368
  buffer_load_dwordx4 v207, s[24:27], s54 offen lds
  v_add_u32 v215, 86016, v210
  ds_read_b64_tr_b16 a[160:161], v215 offset:0
  ds_read_b64_tr_b16 a[162:163], v215 offset:1024
  ds_read_b64_tr_b16 a[164:165], v215 offset:4096
  ds_read_b64_tr_b16 a[166:167], v215 offset:5120
  ds_read_b64_tr_b16 a[168:169], v215 offset:8192
  ds_read_b64_tr_b16 a[170:171], v215 offset:9216
  ds_read_b64_tr_b16 a[172:173], v215 offset:12288
  ds_read_b64_tr_b16 a[174:175], v215 offset:13312
  s_waitcnt vmcnt(20) lgkmcnt(0)
  s_barrier
  s_add_u32 m0, s61, 49152
  s_add_u32 s54, s62, 2621440
  buffer_load_dwordx4 v207, s[20:23], s54 offen lds
  s_add_u32 m0, s61, 53248
  s_add_u32 s54, s62, 2752512
  buffer_load_dwordx4 v207, s[20:23], s54 offen lds
  s_add_u32 m0, s61, 57344
  s_add_u32 s54, s62, 2883584
  buffer_load_dwordx4 v207, s[20:23], s54 offen lds
  s_add_u32 m0, s61, 61440
  s_add_u32 s54, s62, 3014656
  buffer_load_dwordx4 v207, s[20:23], s54 offen lds
  v_add_u32 v215, 102400, v209
  ds_read_b64_tr_b16 a[32:33], v215 offset:0
  ds_read_b64_tr_b16 a[34:35], v215 offset:1024
  ds_read_b64_tr_b16 a[36:37], v215 offset:4096
  ds_read_b64_tr_b16 a[38:39], v215 offset:5120
  ds_read_b64_tr_b16 a[40:41], v215 offset:8192
  ds_read_b64_tr_b16 a[42:43], v215 offset:9216
  ds_read_b64_tr_b16 a[44:45], v215 offset:12288
  ds_read_b64_tr_b16 a[46:47], v215 offset:13312
  s_waitcnt vmcnt(20) lgkmcnt(0)
  s_barrier
  s_add_u32 m0, s61, 65536
  s_add_u32 s54, s62, 2621440
  buffer_load_dwordx4 v207, s[24:27], s54 offen lds
  s_add_u32 m0, s61, 69632
  s_add_u32 s54, s62, 2752512
  buffer_load_dwordx4 v207, s[24:27], s54 offen lds
  s_add_u32 m0, s61, 73728
  s_add_u32 s54, s62, 2883584
  buffer_load_dwordx4 v207, s[24:27], s54 offen lds
  s_add_u32 m0, s61, 77824
  s_add_u32 s54, s62, 3014656
  buffer_load_dwordx4 v207, s[24:27], s54 offen lds
  v_add_u32 v215, 118784, v210
  ds_read_b64_tr_b16 a[176:177], v215 offset:0
  ds_read_b64_tr_b16 a[178:179], v215 offset:1024
  ds_read_b64_tr_b16 a[180:181], v215 offset:4096
  ds_read_b64_tr_b16 a[182:183], v215 offset:5120
  ds_read_b64_tr_b16 a[184:185], v215 offset:8192
  ds_read_b64_tr_b16 a[186:187], v215 offset:9216
  ds_read_b64_tr_b16 a[188:189], v215 offset:12288
  ds_read_b64_tr_b16 a[190:191], v215 offset:13312
  s_waitcnt vmcnt(20) lgkmcnt(0)
  s_barrier
  s_add_u32 m0, s61, 81920
  s_add_u32 s54, s62, 3145728
  buffer_load_dwordx4 v207, s[20:23], s54 offen lds
  s_add_u32 m0, s61, 86016
  s_add_u32 s54, s62, 3276800
  buffer_load_dwordx4 v207, s[20:23], s54 offen lds
  s_add_u32 m0, s61, 90112
  s_add_u32 s54, s62, 3407872
  buffer_load_dwordx4 v207, s[20:23], s54 offen lds
  s_add_u32 m0, s61, 94208
  s_add_u32 s54, s62, 3538944
  buffer_load_dwordx4 v207, s[20:23], s54 offen lds
  v_add_u32 v215, 135168, v209
  ds_read_b64_tr_b16 a[48:49], v215 offset:0
  ds_read_b64_tr_b16 a[50:51], v215 offset:1024
  ds_read_b64_tr_b16 a[52:53], v215 offset:4096
  ds_read_b64_tr_b16 a[54:55], v215 offset:5120
  ds_read_b64_tr_b16 a[56:57], v215 offset:8192
  ds_read_b64_tr_b16 a[58:59], v215 offset:9216
  ds_read_b64_tr_b16 a[60:61], v215 offset:12288
  ds_read_b64_tr_b16 a[62:63], v215 offset:13312
  s_waitcnt vmcnt(20) lgkmcnt(0)
  s_barrier
  s_add_u32 m0, s61, 98304
  s_add_u32 s54, s62, 3145728
  buffer_load_dwordx4 v207, s[24:27], s54 offen lds
  s_add_u32 m0, s61, 102400
  s_add_u32 s54, s62, 3276800
  buffer_load_dwordx4 v207, s[24:27], s54 offen lds
  s_add_u32 m0, s61, 106496
  s_add_u32 s54, s62, 3407872
  buffer_load_dwordx4 v207, s[24:27], s54 offen lds
  s_add_u32 m0, s61, 110592
  s_add_u32 s54, s62, 3538944
  buffer_load_dwordx4 v207, s[24:27], s54 offen lds
  v_add_u32 v215, 36864, v210
  ds_read_b64_tr_b16 a[192:193], v215 offset:0
  ds_read_b64_tr_b16 a[194:195], v215 offset:1024
  ds_read_b64_tr_b16 a[196:197], v215 offset:4096
  ds_read_b64_tr_b16 a[198:199], v215 offset:5120
  ds_read_b64_tr_b16 a[200:201], v215 offset:8192
  ds_read_b64_tr_b16 a[202:203], v215 offset:9216
  ds_read_b64_tr_b16 a[204:205], v215 offset:12288
  ds_read_b64_tr_b16 a[206:207], v215 offset:13312
  s_waitcnt vmcnt(20) lgkmcnt(0)
  s_barrier
  s_add_u32 m0, s61, 0
  s_add_u32 s54, s62, 3670016
  buffer_load_dwordx4 v207, s[20:23], s54 offen lds
  s_add_u32 m0, s61, 4096
  s_add_u32 s54, s62, 3801088
  buffer_load_dwordx4 v207, s[20:23], s54 offen lds
  s_add_u32 m0, s61, 8192
  s_add_u32 s54, s62, 3932160
  buffer_load_dwordx4 v207, s[20:23], s54 offen lds
  s_add_u32 m0, s61, 12288
  s_add_u32 s54, s62, 4063232
  buffer_load_dwordx4 v207, s[20:23], s54 offen lds
  v_add_u32 v215, 53248, v209
  ds_read_b64_tr_b16 a[64:65], v215 offset:0
  ds_read_b64_tr_b16 a[66:67], v215 offset:1024
  ds_read_b64_tr_b16 a[68:69], v215 offset:4096
  ds_read_b64_tr_b16 a[70:71], v215 offset:5120
  ds_read_b64_tr_b16 a[72:73], v215 offset:8192
  ds_read_b64_tr_b16 a[74:75], v215 offset:9216
  ds_read_b64_tr_b16 a[76:77], v215 offset:12288
  ds_read_b64_tr_b16 a[78:79], v215 offset:13312
  s_waitcnt vmcnt(20) lgkmcnt(0)
  s_barrier
  s_add_u32 m0, s61, 16384
  s_add_u32 s54, s62, 3670016
  buffer_load_dwordx4 v207, s[24:27], s54 offen lds
  s_add_u32 m0, s61, 20480
  s_add_u32 s54, s62, 3801088
  buffer_load_dwordx4 v207, s[24:27], s54 offen lds
  s_add_u32 m0, s61, 24576
  s_add_u32 s54, s62, 3932160
  buffer_load_dwordx4 v207, s[24:27], s54 offen lds
  s_add_u32 m0, s61, 28672
  s_add_u32 s54, s62, 4063232
  buffer_load_dwordx4 v207, s[24:27], s54 offen lds
  v_add_u32 v215, 69632, v210
  ds_read_b64_tr_b16 a[208:209], v215 offset:0
  ds_read_b64_tr_b16 a[210:211], v215 offset:1024
  ds_read_b64_tr_b16 a[212:213], v215 offset:4096
  ds_read_b64_tr_b16 a[214:215], v215 offset:5120
  ds_read_b64_tr_b16 a[216:217], v215 offset:8192
  ds_read_b64_tr_b16 a[218:219], v215 offset:9216
  ds_read_b64_tr_b16 a[220:221], v215 offset:12288
  ds_read_b64_tr_b16 a[222:223], v215 offset:13312
  s_waitcnt vmcnt(20) lgkmcnt(0)
  s_barrier
  s_add_u32 m0, s61, 32768
  s_add_u32 s54, s62, 4194304
  buffer_load_dwordx4 v207, s[20:23], s54 offen lds
  s_add_u32 m0, s61, 36864
  s_add_u32 s54, s62, 4325376
  buffer_load_dwordx4 v207, s[20:23], s54 offen lds
  s_add_u32 m0, s61, 40960
  s_add_u32 s54, s62, 4456448
  buffer_load_dwordx4 v207, s[20:23], s54 offen lds
  s_add_u32 m0, s61, 45056
  s_add_u32 s54, s62, 4587520
  buffer_load_dwordx4 v207, s[20:23], s54 offen lds
  v_add_u32 v215, 86016, v209
  ds_read_b64_tr_b16 a[80:81], v215 offset:0
  ds_read_b64_tr_b16 a[82:83], v215 offset:1024
  ds_read_b64_tr_b16 a[84:85], v215 offset:4096
  ds_read_b64_tr_b16 a[86:87], v215 offset:5120
  ds_read_b64_tr_b16 a[88:89], v215 offset:8192
  ds_read_b64_tr_b16 a[90:91], v215 offset:9216
  ds_read_b64_tr_b16 a[92:93], v215 offset:12288
  ds_read_b64_tr_b16 a[94:95], v215 offset:13312
  s_waitcnt vmcnt(20) lgkmcnt(0)
  s_barrier
  s_add_u32 m0, s61, 49152
  s_add_u32 s54, s62, 4194304
  buffer_load_dwordx4 v207, s[24:27], s54 offen lds
  s_add_u32 m0, s61, 53248
  s_add_u32 s54, s62, 4325376
  buffer_load_dwordx4 v207, s[24:27], s54 offen lds
  s_add_u32 m0, s61, 57344
  s_add_u32 s54, s62, 4456448
  buffer_load_dwordx4 v207, s[24:27], s54 offen lds
  s_add_u32 m0, s61, 61440
  s_add_u32 s54, s62, 4587520
  buffer_load_dwordx4 v207, s[24:27], s54 offen lds
  s_mul_i32 s54, s53, 21120
  s_lshl_b32 s55, s52, 13
  s_add_u32 s54, s54, s55
  s_cmp_eq_u32 s52, 3
  s_cselect_b32 s54, 0x10000000, s54
  v_lshlrev_b32 v211, 3, v201
  buffer_load_dword v196, v211, s[28:31], s54 offen
  v_add_u32 v215, 102400, v210
  ds_read_b64_tr_b16 a[224:225], v215 offset:0
  ds_read_b64_tr_b16 a[226:227], v215 offset:1024
  ds_read_b64_tr_b16 a[228:229], v215 offset:4096
  ds_read_b64_tr_b16 a[230:231], v215 offset:5120
  ds_read_b64_tr_b16 a[232:233], v215 offset:8192
  ds_read_b64_tr_b16 a[234:235], v215 offset:9216
  ds_read_b64_tr_b16 a[236:237], v215 offset:12288
  ds_read_b64_tr_b16 a[238:239], v215 offset:13312
  s_waitcnt vmcnt(21) lgkmcnt(0)
  s_barrier
  s_lshl_b32 s54, s53, 13
  s_lshr_b32 s55, s53, 6
  s_or_b32 s55, s55, s52
  s_cmp_eq_u32 s55, 0
  s_cselect_b32 s54, s54, 0x10000000
  v_lshlrev_b32 v211, 3, v201
  buffer_load_dword v196, v211, s[16:19], s54 offen
  v_add_u32 v215, 118784, v209
  ds_read_b64_tr_b16 a[96:97], v215 offset:0
  ds_read_b64_tr_b16 a[98:99], v215 offset:1024
  ds_read_b64_tr_b16 a[100:101], v215 offset:4096
  ds_read_b64_tr_b16 a[102:103], v215 offset:5120
  ds_read_b64_tr_b16 a[104:105], v215 offset:8192
  ds_read_b64_tr_b16 a[106:107], v215 offset:9216
  ds_read_b64_tr_b16 a[108:109], v215 offset:12288
  ds_read_b64_tr_b16 a[110:111], v215 offset:13312
  s_waitcnt vmcnt(18) lgkmcnt(0)
  s_barrier
  v_add_u32 v215, 135168, v210
  ds_read_b64_tr_b16 a[240:241], v215 offset:0
  ds_read_b64_tr_b16 a[242:243], v215 offset:1024
  ds_read_b64_tr_b16 a[244:245], v215 offset:4096
  ds_read_b64_tr_b16 a[246:247], v215 offset:5120
  ds_read_b64_tr_b16 a[248:249], v215 offset:8192
  ds_read_b64_tr_b16 a[250:251], v215 offset:9216
  ds_read_b64_tr_b16 a[252:253], v215 offset:12288
  ds_read_b64_tr_b16 a[254:255], v215 offset:13312
  s_waitcnt vmcnt(14) lgkmcnt(0)
  s_barrier
  v_add_u32 v215, 36864, v209
  ds_read_b64_tr_b16 a[112:113], v215 offset:0
  ds_read_b64_tr_b16 a[114:115], v215 offset:1024
  ds_read_b64_tr_b16 a[116:117], v215 offset:4096
  ds_read_b64_tr_b16 a[118:119], v215 offset:5120
  ds_read_b64_tr_b16 a[120:121], v215 offset:8192
  ds_read_b64_tr_b16 a[122:123], v215 offset:9216
  ds_read_b64_tr_b16 a[124:125], v215 offset:12288
  ds_read_b64_tr_b16 a[126:127], v215 offset:13312
  s_waitcnt vmcnt(10) lgkmcnt(0)
  s_barrier
  v_add_u32 v215, 53248, v210
  ds_read_b64_tr_b16 v[224:225], v215 offset:0
  ds_read_b64_tr_b16 v[226:227], v215 offset:1024
  ds_read_b64_tr_b16 v[228:229], v215 offset:4096
  ds_read_b64_tr_b16 v[230:231], v215 offset:5120
  ds_read_b64_tr_b16 v[232:233], v215 offset:8192
  ds_read_b64_tr_b16 v[234:235], v215 offset:9216
  ds_read_b64_tr_b16 v[236:237], v215 offset:12288
  ds_read_b64_tr_b16 v[238:239], v215 offset:13312
  s_waitcnt vmcnt(6) lgkmcnt(0)
  s_barrier
  v_add_u32 v215, 69632, v209
  ds_read_b64_tr_b16 a[128:129], v215 offset:0
  ds_read_b64_tr_b16 a[130:131], v215 offset:1024
  ds_read_b64_tr_b16 a[132:133], v215 offset:4096
  ds_read_b64_tr_b16 a[134:135], v215 offset:5120
  ds_read_b64_tr_b16 a[136:137], v215 offset:8192
  ds_read_b64_tr_b16 a[138:139], v215 offset:9216
  ds_read_b64_tr_b16 a[140:141], v215 offset:12288
  ds_read_b64_tr_b16 a[142:143], v215 offset:13312
  s_waitcnt vmcnt(2) lgkmcnt(0)
  s_barrier
  v_add_u32 v215, 86016, v210
  ds_read_b64_tr_b16 v[240:241], v215 offset:0
  ds_read_b64_tr_b16 v[242:243], v215 offset:1024
  ds_read_b64_tr_b16 v[244:245], v215 offset:4096
  ds_read_b64_tr_b16 v[246:247], v215 offset:5120
  ds_read_b64_tr_b16 v[248:249], v215 offset:8192
  ds_read_b64_tr_b16 v[250:251], v215 offset:9216
  ds_read_b64_tr_b16 v[252:253], v215 offset:12288
  ds_read_b64_tr_b16 v[254:255], v215 offset:13312
  s_waitcnt lgkmcnt(0)
  s_barrier
  s_lshr_b32 s55, s53, 1
  s_and_b32 s56, s53, 1
  s_lshl_b32 s56, s56, 7
  s_lshl_b32 s55, s55, 2
  s_add_u32 s55, s55, s56
  s_add_u32 s55, s55, 356352
  s_cmp_lt_u32 s53, 64
  s_cselect_b32 s71, s55, 268435456
  v_mov_b32 v211, 0
  s_mov_b64 exec, 1
  buffer_store_dword v211, v211, s[8:11], s71 offen sc1
  s_mov_b64 exec, -1
  s_mov_b32 s68, 1040356334
  s_lshl_b32 s69, s52, 9
  s_lshl_b32 s70, s58, 2
  s_add_u32 s70, s70, 128
  s_mul_i32 s66, s58, -12288
  s_lshl_b32 s54, s52, 10
  s_add_u32 s66, s66, s54
  s_add_u32 s66, s66, 524288
  v_mov_b32 v64, -1
  v_mov_b32 v65, -1
  v_mov_b32 v66, -1
  v_mov_b32 v67, -1
  s_cmp_eq_u32 s59, 0
  s_cbranch_scc0 KV_na
  s_mul_i32 s54, s58, 2176
  s_mul_i32 s55, s52, 69632
  s_add_u32 s55, s55, s54
  s_add_u32 s55, s55, 0
  s_add_u32 s54, s54, 278528
  s_lshl_b32 s56, s58, 14
  s_mul_i32 s57, s52, 3072
  s_add_u32 s56, s56, s57
  s_add_u32 s56, s56, 360448
  s_cmp_lt_u32 s58, 2
  s_cselect_b32 s56, s56, 268435456
  s_cmp_eq_u32 s52, 0
  s_cselect_b32 s54, s54, 268435456
  buffer_store_dwordx4 v[64:67], v201, s[8:11], s55 offen offset:0 sc1
  buffer_store_dwordx4 v[64:67], v201, s[8:11], s55 offen offset:1024 sc1
  buffer_store_dwordx4 v[64:67], v201, s[8:11], s54 offen offset:0 sc1
  buffer_store_dwordx4 v[64:67], v201, s[8:11], s54 offen offset:1024 sc1
  buffer_store_dwordx4 v[64:67], v201, s[8:11], s56 offen offset:0 sc1
  buffer_store_dwordx4 v[64:67], v201, s[8:11], s56 offen offset:1024 sc1
  buffer_store_dwordx4 v[64:67], v201, s[8:11], s56 offen offset:2048 sc1
KV_na:
KV_loop:
  s_add_u32 s60, s60, 258048
  s_add_u32 m0, s67, 36864
  s_nop 0
  buffer_load_dwordx4 v202, s[4:7], s60 offen offset:0 lds
  s_add_u32 m0, s67, 37760
  s_nop 0
  buffer_load_dwordx4 v202, s[4:7], s60 offen offset:128 lds
  s_add_u32 m0, s67, 38656
  s_nop 0
  buffer_load_dwordx4 v202, s[4:7], s60 offen offset:256 lds
  s_add_u32 m0, s67, 39552
  s_nop 0
  buffer_load_dwordx4 v202, s[4:7], s60 offen offset:384 lds
  s_add_u32 m0, s67, 40448
  s_nop 0
  buffer_load_dwordx4 v202, s[4:7], s60 offen offset:512 lds
  s_add_u32 m0, s67, 41344
  s_nop 0
  buffer_load_dwordx4 v202, s[4:7], s60 offen offset:640 lds
  s_add_u32 m0, s67, 42240
  s_nop 0
  buffer_load_dwordx4 v202, s[4:7], s60 offen offset:768 lds
  s_add_u32 m0, s67, 43136
  s_nop 0
  buffer_load_dwordx4 v202, s[4:7], s60 offen offset:896 lds
  s_add_u32 m0, s67, 44032
  s_nop 0
  buffer_load_dwordx4 v202, s[4:7], s60 offen offset:1024 lds
  ds_read_b128 v[32:35], v203 offset:0
  ds_read_b128 v[36:39], v204 offset:0
  ds_read_b128 v[40:43], v205 offset:0
  s_waitcnt lgkmcnt(2)
  v_mfma_f32_32x32x16_bf16 v[0:15], a[0:3], v[32:35], 0
  ds_read_b128 v[44:47], v206 offset:0
  v_mfma_f32_32x32x16_bf16 v[16:31], v[32:35], a[144:147], 0
  s_waitcnt lgkmcnt(2)
  v_mfma_f32_32x32x16_bf16 v[0:15], a[4:7], v[36:39], v[0:15]
  ds_read_b128 v[32:35], v203 offset:1024
  v_mfma_f32_32x32x16_bf16 v[16:31], v[36:39], a[148:151], v[16:31]
  s_waitcnt lgkmcnt(2)
  v_mfma_f32_32x32x16_bf16 v[0:15], a[8:11], v[40:43], v[0:15]
  ds_read_b128 v[36:39], v204 offset:1024
  v_mfma_f32_32x32x16_bf16 v[16:31], v[40:43], a[152:155], v[16:31]
  s_waitcnt lgkmcnt(2)
  v_mfma_f32_32x32x16_bf16 v[0:15], a[12:15], v[44:47], v[0:15]
  ds_read_b128 v[40:43], v205 offset:1024
  v_mfma_f32_32x32x16_bf16 v[16:31], v[44:47], a[156:159], v[16:31]
  s_waitcnt lgkmcnt(2)
  v_mfma_f32_32x32x16_bf16 v[0:15], a[16:19], v[32:35], v[0:15]
  ds_read_b128 v[44:47], v206 offset:1024
  v_mfma_f32_32x32x16_bf16 v[16:31], v[32:35], a[160:163], v[16:31]
  s_waitcnt lgkmcnt(2)
  v_mfma_f32_32x32x16_bf16 v[0:15], a[20:23], v[36:39], v[0:15]
  ds_read_b128 v[32:35], v203 offset:2048
  v_mfma_f32_32x32x16_bf16 v[16:31], v[36:39], a[164:167], v[16:31]
  s_waitcnt lgkmcnt(2)
  v_mfma_f32_32x32x16_bf16 v[0:15], a[24:27], v[40:43], v[0:15]
  ds_read_b128 v[36:39], v204 offset:2048
  v_mfma_f32_32x32x16_bf16 v[16:31], v[40:43], a[168:171], v[16:31]
  s_waitcnt lgkmcnt(2)
  v_mfma_f32_32x32x16_bf16 v[0:15], a[28:31], v[44:47], v[0:15]
  ds_read_b128 v[40:43], v205 offset:2048
  v_mfma_f32_32x32x16_bf16 v[16:31], v[44:47], a[172:175], v[16:31]
  s_waitcnt lgkmcnt(2)
  v_mfma_f32_32x32x16_bf16 v[0:15], a[32:35], v[32:35], v[0:15]
  ds_read_b128 v[44:47], v206 offset:2048
  v_mfma_f32_32x32x16_bf16 v[16:31], v[32:35], a[176:179], v[16:31]
  s_waitcnt lgkmcnt(2)
  v_mfma_f32_32x32x16_bf16 v[0:15], a[36:39], v[36:39], v[0:15]
  ds_read_b128 v[32:35], v203 offset:3072
  v_mfma_f32_32x32x16_bf16 v[16:31], v[36:39], a[180:183], v[16:31]
  s_waitcnt lgkmcnt(2)
  v_mfma_f32_32x32x16_bf16 v[0:15], a[40:43], v[40:43], v[0:15]
  ds_read_b128 v[36:39], v204 offset:3072
  v_mfma_f32_32x32x16_bf16 v[16:31], v[40:43], a[184:187], v[16:31]
  s_waitcnt lgkmcnt(2)
  v_mfma_f32_32x32x16_bf16 v[0:15], a[44:47], v[44:47], v[0:15]
  ds_read_b128 v[40:43], v205 offset:3072
  v_mfma_f32_32x32x16_bf16 v[16:31], v[44:47], a[188:191], v[16:31]
  s_waitcnt lgkmcnt(2)
  v_mfma_f32_32x32x16_bf16 v[0:15], a[48:51], v[32:35], v[0:15]
  ds_read_b128 v[44:47], v206 offset:3072
  v_mfma_f32_32x32x16_bf16 v[16:31], v[32:35], a[192:195], v[16:31]
  s_waitcnt lgkmcnt(2)
  v_mfma_f32_32x32x16_bf16 v[0:15], a[52:55], v[36:39], v[0:15]
  ds_read_b128 v[32:35], v203 offset:4096
  v_mfma_f32_32x32x16_bf16 v[16:31], v[36:39], a[196:199], v[16:31]
  s_waitcnt lgkmcnt(2)
  v_mfma_f32_32x32x16_bf16 v[0:15], a[56:59], v[40:43], v[0:15]
  ds_read_b128 v[36:39], v204 offset:4096
  v_mfma_f32_32x32x16_bf16 v[16:31], v[40:43], a[200:203], v[16:31]
  s_waitcnt lgkmcnt(2)
  v_mfma_f32_32x32x16_bf16 v[0:15], a[60:63], v[44:47], v[0:15]
  ds_read_b128 v[40:43], v205 offset:4096
  v_mfma_f32_32x32x16_bf16 v[16:31], v[44:47], a[204:207], v[16:31]
  s_waitcnt lgkmcnt(2)
  v_mfma_f32_32x32x16_bf16 v[0:15], a[64:67], v[32:35], v[0:15]
  ds_read_b128 v[44:47], v206 offset:4096
  v_mfma_f32_32x32x16_bf16 v[16:31], v[32:35], a[208:211], v[16:31]
  s_waitcnt lgkmcnt(2)
  v_mfma_f32_32x32x16_bf16 v[0:15], a[68:71], v[36:39], v[0:15]
  ds_read_b128 v[32:35], v203 offset:5120
  v_mfma_f32_32x32x16_bf16 v[16:31], v[36:39], a[212:215], v[16:31]
  s_waitcnt lgkmcnt(2)
  v_mfma_f32_32x32x16_bf16 v[0:15], a[72:75], v[40:43], v[0:15]
  ds_read_b128 v[36:39], v204 offset:5120
  v_mfma_f32_32x32x16_bf16 v[16:31], v[40:43], a[216:219], v[16:31]
  s_waitcnt lgkmcnt(2)
  v_mfma_f32_32x32x16_bf16 v[0:15], a[76:79], v[44:47], v[0:15]
  ds_read_b128 v[40:43], v205 offset:5120
  v_mfma_f32_32x32x16_bf16 v[16:31], v[44:47], a[220:223], v[16:31]
  s_waitcnt lgkmcnt(2)
  v_mfma_f32_32x32x16_bf16 v[0:15], a[80:83], v[32:35], v[0:15]
  ds_read_b128 v[44:47], v206 offset:5120
  v_mfma_f32_32x32x16_bf16 v[16:31], v[32:35], a[224:227], v[16:31]
  s_waitcnt lgkmcnt(2)
  v_mfma_f32_32x32x16_bf16 v[0:15], a[84:87], v[36:39], v[0:15]
  ds_read_b128 v[32:35], v203 offset:6144
  v_mfma_f32_32x32x16_bf16 v[16:31], v[36:39], a[228:231], v[16:31]
  s_waitcnt lgkmcnt(2)
  v_mfma_f32_32x32x16_bf16 v[0:15], a[88:91], v[40:43], v[0:15]
  ds_read_b128 v[36:39], v204 offset:6144
  v_mfma_f32_32x32x16_bf16 v[16:31], v[40:43], a[232:235], v[16:31]
  s_waitcnt lgkmcnt(2)
  v_mfma_f32_32x32x16_bf16 v[0:15], a[92:95], v[44:47], v[0:15]
  ds_read_b128 v[40:43], v205 offset:6144
  v_mfma_f32_32x32x16_bf16 v[16:31], v[44:47], a[236:239], v[16:31]
  s_waitcnt lgkmcnt(2)
  v_mfma_f32_32x32x16_bf16 v[0:15], a[96:99], v[32:35], v[0:15]
  ds_read_b128 v[44:47], v206 offset:6144
  v_mfma_f32_32x32x16_bf16 v[16:31], v[32:35], a[240:243], v[16:31]
  s_waitcnt lgkmcnt(2)
  v_mfma_f32_32x32x16_bf16 v[0:15], a[100:103], v[36:39], v[0:15]
  ds_read_b128 v[32:35], v203 offset:7168
  v_mfma_f32_32x32x16_bf16 v[16:31], v[36:39], a[244:247], v[16:31]
  s_waitcnt lgkmcnt(2)
  v_mfma_f32_32x32x16_bf16 v[0:15], a[104:107], v[40:43], v[0:15]
  ds_read_b128 v[36:39], v204 offset:7168
  v_mfma_f32_32x32x16_bf16 v[16:31], v[40:43], a[248:251], v[16:31]
  s_waitcnt lgkmcnt(2)
  v_mfma_f32_32x32x16_bf16 v[0:15], a[108:111], v[44:47], v[0:15]
  ds_read_b128 v[40:43], v205 offset:7168
  v_mfma_f32_32x32x16_bf16 v[16:31], v[44:47], a[252:255], v[16:31]
  s_waitcnt lgkmcnt(2)
  v_mfma_f32_32x32x16_bf16 v[0:15], a[112:115], v[32:35], v[0:15]
  ds_read_b128 v[44:47], v206 offset:7168
  v_mfma_f32_32x32x16_bf16 v[16:31], v[32:35], v[224:227], v[16:31]
  s_waitcnt lgkmcnt(2)
  v_mfma_f32_32x32x16_bf16 v[0:15], a[116:119], v[36:39], v[0:15]
  ds_read_b128 v[32:35], v203 offset:8192
  v_mfma_f32_32x32x16_bf16 v[16:31], v[36:39], v[228:231], v[16:31]
  s_waitcnt lgkmcnt(2)
  v_mfma_f32_32x32x16_bf16 v[0:15], a[120:123], v[40:43], v[0:15]
  ds_read_b128 v[36:39], v204 offset:8192
  v_mfma_f32_32x32x16_bf16 v[16:31], v[40:43], v[232:235], v[16:31]
  s_waitcnt lgkmcnt(2)
  v_mfma_f32_32x32x16_bf16 v[0:15], a[124:127], v[44:47], v[0:15]
  ds_read_b128 v[40:43], v205 offset:8192
  v_mfma_f32_32x32x16_bf16 v[16:31], v[44:47], v[236:239], v[16:31]
  s_waitcnt lgkmcnt(2)
  v_mfma_f32_32x32x16_bf16 v[0:15], a[128:131], v[32:35], v[0:15]
  ds_read_b128 v[44:47], v206 offset:8192
  v_mfma_f32_32x32x16_bf16 v[16:31], v[32:35], v[240:243], v[16:31]
  s_waitcnt lgkmcnt(2)
  v_mfma_f32_32x32x16_bf16 v[0:15], a[132:135], v[36:39], v[0:15]
  v_mfma_f32_32x32x16_bf16 v[16:31], v[36:39], v[244:247], v[16:31]
  s_waitcnt lgkmcnt(1)
  v_mfma_f32_32x32x16_bf16 v[0:15], a[136:139], v[40:43], v[0:15]
  v_mfma_f32_32x32x16_bf16 v[16:31], v[40:43], v[248:251], v[16:31]
  s_waitcnt lgkmcnt(0)
  v_mfma_f32_32x32x16_bf16 v[0:15], a[140:143], v[44:47], v[0:15]
  v_mfma_f32_32x32x16_bf16 v[16:31], v[44:47], v[252:255], v[16:31]
  s_mul_i32 s64, s59, 655360
  s_lshl_b32 s55, s58, 14
  s_add_u32 s64, s64, s55
  s_add_u32 s64, s64, 1048576
  s_add_u32 s55, s64, s69
  v_mul_f32 v0, s68, v0
  v_mul_f32 v1, s68, v1
  v_mul_f32 v2, s68, v2
  v_mul_f32 v3, s68, v3
  v_mul_f32 v4, s68, v4
  v_mul_f32 v5, s68, v5
  v_mul_f32 v6, s68, v6
  v_mul_f32 v7, s68, v7
  v_mul_f32 v8, s68, v8
  v_mul_f32 v9, s68, v9
  v_mul_f32 v10, s68, v10
  v_mul_f32 v11, s68, v11
  v_mul_f32 v12, s68, v12
  v_mul_f32 v13, s68, v13
  v_mul_f32 v14, s68, v14
  v_mul_f32 v15, s68, v15
  v_cvt_pk_bf16_f32 v48, v0, v4
  v_cvt_pk_bf16_f32 v49, v1, v5
  v_cvt_pk_bf16_f32 v50, v2, v6
  v_cvt_pk_bf16_f32 v51, v3, v7
  buffer_store_dwordx4 v[48:51], v216, s[8:11], s55 offen offset:0 sc1
  v_cvt_pk_bf16_f32 v52, v8, v12
  v_cvt_pk_bf16_f32 v53, v9, v13
  v_cvt_pk_bf16_f32 v54, v10, v14
  v_cvt_pk_bf16_f32 v55, v11, v15
  buffer_store_dwordx4 v[52:55], v216, s[8:11], s55 offen offset:256 sc1
  v_cvt_pk_bf16_f32 v56, v16, v17
  v_cvt_pk_bf16_f32 v57, v20, v21
  v_cvt_pk_bf16_f32 v58, v24, v25
  v_cvt_pk_bf16_f32 v59, v28, v29
  buffer_store_dwordx4 v[56:59], v217, s[8:11], s64 offen offset:0 sc1
  v_cvt_pk_bf16_f32 v60, v18, v19
  v_cvt_pk_bf16_f32 v61, v22, v23
  v_cvt_pk_bf16_f32 v62, v26, v27
  v_cvt_pk_bf16_f32 v63, v30, v31
  buffer_store_dwordx4 v[60:63], v217, s[8:11], s64 offen offset:256 sc1
  s_add_u32 s55, s64, s66
  buffer_store_dwordx4 v[64:67], v201, s[8:11], s55 offen sc1
  s_add_u32 s59, s59, 7
  s_cmp_ge_u32 s59, 64
  s_cbranch_scc1 KV_done
  s_waitcnt vmcnt(5)
  s_barrier
  s_add_u32 s60, s60, 258048
  s_add_u32 m0, s67, 0
  s_nop 0
  buffer_load_dwordx4 v202, s[4:7], s60 offen offset:0 lds
  s_add_u32 m0, s67, 896
  s_nop 0
  buffer_load_dwordx4 v202, s[4:7], s60 offen offset:128 lds
  s_add_u32 m0, s67, 1792
  s_nop 0
  buffer_load_dwordx4 v202, s[4:7], s60 offen offset:256 lds
  s_add_u32 m0, s67, 2688
  s_nop 0
  buffer_load_dwordx4 v202, s[4:7], s60 offen offset:384 lds
  s_add_u32 m0, s67, 3584
  s_nop 0
  buffer_load_dwordx4 v202, s[4:7], s60 offen offset:512 lds
  s_add_u32 m0, s67, 4480
  s_nop 0
  buffer_load_dwordx4 v202, s[4:7], s60 offen offset:640 lds
  s_add_u32 m0, s67, 5376
  s_nop 0
  buffer_load_dwordx4 v202, s[4:7], s60 offen offset:768 lds
  s_add_u32 m0, s67, 6272
  s_nop 0
  buffer_load_dwordx4 v202, s[4:7], s60 offen offset:896 lds
  s_add_u32 m0, s67, 7168
  s_nop 0
  buffer_load_dwordx4 v202, s[4:7], s60 offen offset:1024 lds
  ds_read_b128 v[32:35], v203 offset:36864
  ds_read_b128 v[36:39], v204 offset:36864
  ds_read_b128 v[40:43], v205 offset:36864
  s_waitcnt lgkmcnt(2)
  v_mfma_f32_32x32x16_bf16 v[0:15], a[0:3], v[32:35], 0
  ds_read_b128 v[44:47], v206 offset:36864
  v_mfma_f32_32x32x16_bf16 v[16:31], v[32:35], a[144:147], 0
  s_waitcnt lgkmcnt(2)
  v_mfma_f32_32x32x16_bf16 v[0:15], a[4:7], v[36:39], v[0:15]
  ds_read_b128 v[32:35], v203 offset:37888
  v_mfma_f32_32x32x16_bf16 v[16:31], v[36:39], a[148:151], v[16:31]
  s_waitcnt lgkmcnt(2)
  v_mfma_f32_32x32x16_bf16 v[0:15], a[8:11], v[40:43], v[0:15]
  ds_read_b128 v[36:39], v204 offset:37888
  v_mfma_f32_32x32x16_bf16 v[16:31], v[40:43], a[152:155], v[16:31]
  s_waitcnt lgkmcnt(2)
  v_mfma_f32_32x32x16_bf16 v[0:15], a[12:15], v[44:47], v[0:15]
  ds_read_b128 v[40:43], v205 offset:37888
  v_mfma_f32_32x32x16_bf16 v[16:31], v[44:47], a[156:159], v[16:31]
  s_waitcnt lgkmcnt(2)
  v_mfma_f32_32x32x16_bf16 v[0:15], a[16:19], v[32:35], v[0:15]
  ds_read_b128 v[44:47], v206 offset:37888
  v_mfma_f32_32x32x16_bf16 v[16:31], v[32:35], a[160:163], v[16:31]
  s_waitcnt lgkmcnt(2)
  v_mfma_f32_32x32x16_bf16 v[0:15], a[20:23], v[36:39], v[0:15]
  ds_read_b128 v[32:35], v203 offset:38912
  v_mfma_f32_32x32x16_bf16 v[16:31], v[36:39], a[164:167], v[16:31]
  s_waitcnt lgkmcnt(2)
  v_mfma_f32_32x32x16_bf16 v[0:15], a[24:27], v[40:43], v[0:15]
  ds_read_b128 v[36:39], v204 offset:38912
  v_mfma_f32_32x32x16_bf16 v[16:31], v[40:43], a[168:171], v[16:31]
  s_waitcnt lgkmcnt(2)
  v_mfma_f32_32x32x16_bf16 v[0:15], a[28:31], v[44:47], v[0:15]
  ds_read_b128 v[40:43], v205 offset:38912
  v_mfma_f32_32x32x16_bf16 v[16:31], v[44:47], a[172:175], v[16:31]
  s_waitcnt lgkmcnt(2)
  v_mfma_f32_32x32x16_bf16 v[0:15], a[32:35], v[32:35], v[0:15]
  ds_read_b128 v[44:47], v206 offset:38912
  v_mfma_f32_32x32x16_bf16 v[16:31], v[32:35], a[176:179], v[16:31]
  s_waitcnt lgkmcnt(2)
  v_mfma_f32_32x32x16_bf16 v[0:15], a[36:39], v[36:39], v[0:15]
  ds_read_b128 v[32:35], v203 offset:39936
  v_mfma_f32_32x32x16_bf16 v[16:31], v[36:39], a[180:183], v[16:31]
  s_waitcnt lgkmcnt(2)
  v_mfma_f32_32x32x16_bf16 v[0:15], a[40:43], v[40:43], v[0:15]
  ds_read_b128 v[36:39], v204 offset:39936
  v_mfma_f32_32x32x16_bf16 v[16:31], v[40:43], a[184:187], v[16:31]
  s_waitcnt lgkmcnt(2)
  v_mfma_f32_32x32x16_bf16 v[0:15], a[44:47], v[44:47], v[0:15]
  ds_read_b128 v[40:43], v205 offset:39936
  v_mfma_f32_32x32x16_bf16 v[16:31], v[44:47], a[188:191], v[16:31]
  s_waitcnt lgkmcnt(2)
  v_mfma_f32_32x32x16_bf16 v[0:15], a[48:51], v[32:35], v[0:15]
  ds_read_b128 v[44:47], v206 offset:39936
  v_mfma_f32_32x32x16_bf16 v[16:31], v[32:35], a[192:195], v[16:31]
  s_waitcnt lgkmcnt(2)
  v_mfma_f32_32x32x16_bf16 v[0:15], a[52:55], v[36:39], v[0:15]
  ds_read_b128 v[32:35], v203 offset:40960
  v_mfma_f32_32x32x16_bf16 v[16:31], v[36:39], a[196:199], v[16:31]
  s_waitcnt lgkmcnt(2)
  v_mfma_f32_32x32x16_bf16 v[0:15], a[56:59], v[40:43], v[0:15]
  ds_read_b128 v[36:39], v204 offset:40960
  v_mfma_f32_32x32x16_bf16 v[16:31], v[40:43], a[200:203], v[16:31]
  s_waitcnt lgkmcnt(2)
  v_mfma_f32_32x32x16_bf16 v[0:15], a[60:63], v[44:47], v[0:15]
  ds_read_b128 v[40:43], v205 offset:40960
  v_mfma_f32_32x32x16_bf16 v[16:31], v[44:47], a[204:207], v[16:31]
  s_waitcnt lgkmcnt(2)
  v_mfma_f32_32x32x16_bf16 v[0:15], a[64:67], v[32:35], v[0:15]
  ds_read_b128 v[44:47], v206 offset:40960
  v_mfma_f32_32x32x16_bf16 v[16:31], v[32:35], a[208:211], v[16:31]
  s_waitcnt lgkmcnt(2)
  v_mfma_f32_32x32x16_bf16 v[0:15], a[68:71], v[36:39], v[0:15]
  ds_read_b128 v[32:35], v203 offset:41984
  v_mfma_f32_32x32x16_bf16 v[16:31], v[36:39], a[212:215], v[16:31]
  s_waitcnt lgkmcnt(2)
  v_mfma_f32_32x32x16_bf16 v[0:15], a[72:75], v[40:43], v[0:15]
  ds_read_b128 v[36:39], v204 offset:41984
  v_mfma_f32_32x32x16_bf16 v[16:31], v[40:43], a[216:219], v[16:31]
  s_waitcnt lgkmcnt(2)
  v_mfma_f32_32x32x16_bf16 v[0:15], a[76:79], v[44:47], v[0:15]
  ds_read_b128 v[40:43], v205 offset:41984
  v_mfma_f32_32x32x16_bf16 v[16:31], v[44:47], a[220:223], v[16:31]
  s_waitcnt lgkmcnt(2)
  v_mfma_f32_32x32x16_bf16 v[0:15], a[80:83], v[32:35], v[0:15]
  ds_read_b128 v[44:47], v206 offset:41984
  v_mfma_f32_32x32x16_bf16 v[16:31], v[32:35], a[224:227], v[16:31]
  s_waitcnt lgkmcnt(2)
  v_mfma_f32_32x32x16_bf16 v[0:15], a[84:87], v[36:39], v[0:15]
  ds_read_b128 v[32:35], v203 offset:43008
  v_mfma_f32_32x32x16_bf16 v[16:31], v[36:39], a[228:231], v[16:31]
  s_waitcnt lgkmcnt(2)
  v_mfma_f32_32x32x16_bf16 v[0:15], a[88:91], v[40:43], v[0:15]
  ds_read_b128 v[36:39], v204 offset:43008
  v_mfma_f32_32x32x16_bf16 v[16:31], v[40:43], a[232:235], v[16:31]
  s_waitcnt lgkmcnt(2)
  v_mfma_f32_32x32x16_bf16 v[0:15], a[92:95], v[44:47], v[0:15]
  ds_read_b128 v[40:43], v205 offset:43008
  v_mfma_f32_32x32x16_bf16 v[16:31], v[44:47], a[236:239], v[16:31]
  s_waitcnt lgkmcnt(2)
  v_mfma_f32_32x32x16_bf16 v[0:15], a[96:99], v[32:35], v[0:15]
  ds_read_b128 v[44:47], v206 offset:43008
  v_mfma_f32_32x32x16_bf16 v[16:31], v[32:35], a[240:243], v[16:31]
  s_waitcnt lgkmcnt(2)
  v_mfma_f32_32x32x16_bf16 v[0:15], a[100:103], v[36:39], v[0:15]
  ds_read_b128 v[32:35], v203 offset:44032
  v_mfma_f32_32x32x16_bf16 v[16:31], v[36:39], a[244:247], v[16:31]
  s_waitcnt lgkmcnt(2)
  v_mfma_f32_32x32x16_bf16 v[0:15], a[104:107], v[40:43], v[0:15]
  ds_read_b128 v[36:39], v204 offset:44032
  v_mfma_f32_32x32x16_bf16 v[16:31], v[40:43], a[248:251], v[16:31]
  s_waitcnt lgkmcnt(2)
  v_mfma_f32_32x32x16_bf16 v[0:15], a[108:111], v[44:47], v[0:15]
  ds_read_b128 v[40:43], v205 offset:44032
  v_mfma_f32_32x32x16_bf16 v[16:31], v[44:47], a[252:255], v[16:31]
  s_waitcnt lgkmcnt(2)
  v_mfma_f32_32x32x16_bf16 v[0:15], a[112:115], v[32:35], v[0:15]
  ds_read_b128 v[44:47], v206 offset:44032
  v_mfma_f32_32x32x16_bf16 v[16:31], v[32:35], v[224:227], v[16:31]
  s_waitcnt lgkmcnt(2)
  v_mfma_f32_32x32x16_bf16 v[0:15], a[116:119], v[36:39], v[0:15]
  ds_read_b128 v[32:35], v203 offset:45056
  v_mfma_f32_32x32x16_bf16 v[16:31], v[36:39], v[228:231], v[16:31]
  s_waitcnt lgkmcnt(2)
  v_mfma_f32_32x32x16_bf16 v[0:15], a[120:123], v[40:43], v[0:15]
  ds_read_b128 v[36:39], v204 offset:45056
  v_mfma_f32_32x32x16_bf16 v[16:31], v[40:43], v[232:235], v[16:31]
  s_waitcnt lgkmcnt(2)
  v_mfma_f32_32x32x16_bf16 v[0:15], a[124:127], v[44:47], v[0:15]
  ds_read_b128 v[40:43], v205 offset:45056
  v_mfma_f32_32x32x16_bf16 v[16:31], v[44:47], v[236:239], v[16:31]
  s_waitcnt lgkmcnt(2)
  v_mfma_f32_32x32x16_bf16 v[0:15], a[128:131], v[32:35], v[0:15]
  ds_read_b128 v[44:47], v206 offset:45056
  v_mfma_f32_32x32x16_bf16 v[16:31], v[32:35], v[240:243], v[16:31]
  s_waitcnt lgkmcnt(2)
  v_mfma_f32_32x32x16_bf16 v[0:15], a[132:135], v[36:39], v[0:15]
  v_mfma_f32_32x32x16_bf16 v[16:31], v[36:39], v[244:247], v[16:31]
  s_waitcnt lgkmcnt(1)
  v_mfma_f32_32x32x16_bf16 v[0:15], a[136:139], v[40:43], v[0:15]
  v_mfma_f32_32x32x16_bf16 v[16:31], v[40:43], v[248:251], v[16:31]
  s_waitcnt lgkmcnt(0)
  v_mfma_f32_32x32x16_bf16 v[0:15], a[140:143], v[44:47], v[0:15]
  v_mfma_f32_32x32x16_bf16 v[16:31], v[44:47], v[252:255], v[16:31]
  s_mul_i32 s64, s59, 655360
  s_lshl_b32 s55, s58, 14
  s_add_u32 s64, s64, s55
  s_add_u32 s64, s64, 1048576
  s_add_u32 s55, s64, s69
  v_mul_f32 v0, s68, v0
  v_mul_f32 v1, s68, v1
  v_mul_f32 v2, s68, v2
  v_mul_f32 v3, s68, v3
  v_mul_f32 v4, s68, v4
  v_mul_f32 v5, s68, v5
  v_mul_f32 v6, s68, v6
  v_mul_f32 v7, s68, v7
  v_mul_f32 v8, s68, v8
  v_mul_f32 v9, s68, v9
  v_mul_f32 v10, s68, v10
  v_mul_f32 v11, s68, v11
  v_mul_f32 v12, s68, v12
  v_mul_f32 v13, s68, v13
  v_mul_f32 v14, s68, v14
  v_mul_f32 v15, s68, v15
  v_cvt_pk_bf16_f32 v48, v0, v4
  v_cvt_pk_bf16_f32 v49, v1, v5
  v_cvt_pk_bf16_f32 v50, v2, v6
  v_cvt_pk_bf16_f32 v51, v3, v7
  buffer_store_dwordx4 v[48:51], v216, s[8:11], s55 offen offset:0 sc1
  v_cvt_pk_bf16_f32 v52, v8, v12
  v_cvt_pk_bf16_f32 v53, v9, v13
  v_cvt_pk_bf16_f32 v54, v10, v14
  v_cvt_pk_bf16_f32 v55, v11, v15
  buffer_store_dwordx4 v[52:55], v216, s[8:11], s55 offen offset:256 sc1
  v_cvt_pk_bf16_f32 v56, v16, v17
  v_cvt_pk_bf16_f32 v57, v20, v21
  v_cvt_pk_bf16_f32 v58, v24, v25
  v_cvt_pk_bf16_f32 v59, v28, v29
  buffer_store_dwordx4 v[56:59], v217, s[8:11], s64 offen offset:0 sc1
  v_cvt_pk_bf16_f32 v60, v18, v19
  v_cvt_pk_bf16_f32 v61, v22, v23
  v_cvt_pk_bf16_f32 v62, v26, v27
  v_cvt_pk_bf16_f32 v63, v30, v31
  buffer_store_dwordx4 v[60:63], v217, s[8:11], s64 offen offset:256 sc1
  s_add_u32 s55, s64, s66
  buffer_store_dwordx4 v[64:67], v201, s[8:11], s55 offen sc1
  s_add_u32 s59, s59, 7
  s_cmp_ge_u32 s59, 64
  s_cbranch_scc1 KV_done
  s_sub_u32 s54, s59, 14
  s_cmp_lt_u32 s54, 7
  s_cbranch_scc1 KV_early
  s_waitcnt vmcnt(5)
  s_barrier
KV_cont:
  s_branch KV_loop
KV_early:
  s_waitcnt vmcnt(0)
  s_barrier
  s_cmp_eq_u32 s52, 0
  s_cbranch_scc0 KV_sig0
  v_mov_b32 v211, 1
  v_mov_b32 v212, 0
  s_mov_b64 exec, 1
  buffer_atomic_add v211, v212, s[12:15], s70 offen
  s_mov_b64 exec, -1
KV_sig0:
  s_branch KV_cont
KV_done:
  s_waitcnt vmcnt(0)
  s_barrier
  s_cmp_eq_u32 s52, 0
  s_cbranch_scc0 KV_sig
  v_mov_b32 v211, 256
  v_mov_b32 v212, 0
  s_mov_b64 exec, 1
  buffer_atomic_add v211, v212, s[12:15], s70 offen
  s_mov_b64 exec, -1
KV_sig:
  s_cmp_ge_u32 s53, 192
  s_cbranch_scc1 L_exit
  s_cmp_lt_u32 s53, 64
  s_cbranch_scc1 W_h
  s_sub_u32 s54, s53, 64
  s_lshr_b32 s68, s54, 4
  s_and_b32 s69, s54, 15
  s_lshl_b32 s60, s69, 2
  s_sub_u32 s60, s60, 1
  s_max_i32 s60, s60, 0
  s_mul_i32 s60, s60, 36864
  s_add_u32 m0, s67, 0
  s_nop 0
  buffer_load_dwordx4 v202, s[4:7], s60 offen offset:0 lds
  s_add_u32 m0, s67, 896
  s_nop 0
  buffer_load_dwordx4 v202, s[4:7], s60 offen offset:128 lds
  s_add_u32 m0, s67, 1792
  s_nop 0
  buffer_load_dwordx4 v202, s[4:7], s60 offen offset:256 lds
  s_add_u32 m0, s67, 2688
  s_nop 0
  buffer_load_dwordx4 v202, s[4:7], s60 offen offset:384 lds
  s_add_u32 m0, s67, 3584
  s_nop 0
  buffer_load_dwordx4 v202, s[4:7], s60 offen offset:512 lds
  s_add_u32 m0, s67, 4480
  s_nop 0
  buffer_load_dwordx4 v202, s[4:7], s60 offen offset:640 lds
  s_add_u32 m0, s67, 5376
  s_nop 0
  buffer_load_dwordx4 v202, s[4:7], s60 offen offset:768 lds
  s_add_u32 m0, s67, 6272
  s_nop 0
  buffer_load_dwordx4 v202, s[4:7], s60 offen offset:896 lds
  s_add_u32 m0, s67, 7168
  s_nop 0
  buffer_load_dwordx4 v202, s[4:7], s60 offen offset:1024 lds
  v_and_b32 v211, 15, v200
  v_mul_u32_u24 v211, 72, v211
  v_lshrrev_b32 v212, 4, v200
  v_mul_u32_u24 v213, 1152, v212
  v_add_u32 v213, v213, v211
  s_lshl_b32 s54, s54, 2
  s_add_u32 s70, s54, s52
  s_mul_i32 s55, s70, 4608
  buffer_load_dwordx4 v[48:51], v213, s[4:7], s55 offen offset:0
  buffer_load_dwordx4 v[52:55], v213, s[4:7], s55 offen offset:16
  buffer_load_dwordx4 v[56:59], v213, s[4:7], s55 offen offset:32
  buffer_load_dwordx4 v[60:63], v213, s[4:7], s55 offen offset:48
  buffer_load_dwordx2 v[64:65], v213, s[4:7], s55 offen offset:64
  buffer_load_dwordx4 v[68:71], v211, s[44:47], 0 offen offset:0
  buffer_load_dwordx4 v[72:75], v211, s[44:47], 0 offen offset:16
  buffer_load_dwordx4 v[76:79], v211, s[44:47], 0 offen offset:32
  buffer_load_dwordx4 v[80:83], v211, s[44:47], 0 offen offset:48
  buffer_load_dwordx2 v[84:85], v211, s[44:47], 0 offen offset:64
  v_mov_b32 v0, 0
  v_mov_b32 v1, 0x3f803f80
  s_waitcnt vmcnt(9)
  v_lshlrev_b32 v2, 16, v48
  s_waitcnt vmcnt(4)
  v_lshlrev_b32 v3, 16, v68
  v_and_b32 v4, 0xffff0000, v48
  v_and_b32 v5, 0xffff0000, v68
  v_mul_f32 v2, v2, v3
  v_mul_f32 v4, v4, v5
  v_cvt_pk_bf16_f32 v2, v2, v4
  v_lshlrev_b32 v3, 16, v2
  v_and_b32 v4, 0xffff0000, v2
  v_add_f32 v0, v0, v3
  v_add_f32 v0, v0, v4
  v_lshlrev_b32 v2, 16, v49
  v_lshlrev_b32 v3, 16, v69
  v_and_b32 v4, 0xffff0000, v49
  v_and_b32 v5, 0xffff0000, v69
  v_mul_f32 v2, v2, v3
  v_mul_f32 v4, v4, v5
  v_cvt_pk_bf16_f32 v2, v2, v4
  v_lshlrev_b32 v3, 16, v2
  v_and_b32 v4, 0xffff0000, v2
  v_add_f32 v0, v0, v3
  v_add_f32 v0, v0, v4
  v_lshlrev_b32 v2, 16, v50
  v_lshlrev_b32 v3, 16, v70
  v_and_b32 v4, 0xffff0000, v50
  v_and_b32 v5, 0xffff0000, v70
  v_mul_f32 v2, v2, v3
  v_mul_f32 v4, v4, v5
  v_cvt_pk_bf16_f32 v2, v2, v4
  v_lshlrev_b32 v3, 16, v2
  v_and_b32 v4, 0xffff0000, v2
  v_add_f32 v0, v0, v3
  v_add_f32 v0, v0, v4
  v_lshlrev_b32 v2, 16, v51
  v_lshlrev_b32 v3, 16, v71
  v_and_b32 v4, 0xffff0000, v51
  v_and_b32 v5, 0xffff0000, v71
  v_mul_f32 v2, v2, v3
  v_mul_f32 v4, v4, v5
  v_cvt_pk_bf16_f32 v2, v2, v4
  v_lshlrev_b32 v3, 16, v2
  v_and_b32 v4, 0xffff0000, v2
  v_add_f32 v0, v0, v3
  v_add_f32 v0, v0, v4
  v_lshlrev_b32 v2, 16, v52
  s_waitcnt vmcnt(3)
  v_lshlrev_b32 v3, 16, v72
  v_and_b32 v4, 0xffff0000, v52
  v_and_b32 v5, 0xffff0000, v72
  v_mul_f32 v2, v2, v3
  v_mul_f32 v4, v4, v5
  v_cvt_pk_bf16_f32 v2, v2, v4
  v_lshlrev_b32 v3, 16, v2
  v_and_b32 v4, 0xffff0000, v2
  v_add_f32 v0, v0, v3
  v_add_f32 v0, v0, v4
  v_lshlrev_b32 v2, 16, v53
  v_lshlrev_b32 v3, 16, v73
  v_and_b32 v4, 0xffff0000, v53
  v_and_b32 v5, 0xffff0000, v73
  v_mul_f32 v2, v2, v3
  v_mul_f32 v4, v4, v5
  v_cvt_pk_bf16_f32 v2, v2, v4
  v_lshlrev_b32 v3, 16, v2
  v_and_b32 v4, 0xffff0000, v2
  v_add_f32 v0, v0, v3
  v_add_f32 v0, v0, v4
  v_lshlrev_b32 v2, 16, v54
  v_lshlrev_b32 v3, 16, v74
  v_and_b32 v4, 0xffff0000, v54
  v_and_b32 v5, 0xffff0000, v74
  v_mul_f32 v2, v2, v3
  v_mul_f32 v4, v4, v5
  v_cvt_pk_bf16_f32 v2, v2, v4
  v_lshlrev_b32 v3, 16, v2
  v_and_b32 v4, 0xffff0000, v2
  v_add_f32 v0, v0, v3
  v_add_f32 v0, v0, v4
  v_lshlrev_b32 v2, 16, v55
  v_lshlrev_b32 v3, 16, v75
  v_and_b32 v4, 0xffff0000, v55
  v_and_b32 v5, 0xffff0000, v75
  v_mul_f32 v2, v2, v3
  v_mul_f32 v4, v4, v5
  v_cvt_pk_bf16_f32 v2, v2, v4
  v_lshlrev_b32 v3, 16, v2
  v_and_b32 v4, 0xffff0000, v2
  v_add_f32 v0, v0, v3
  v_add_f32 v0, v0, v4
  v_lshlrev_b32 v2, 16, v56
  s_waitcnt vmcnt(2)
  v_lshlrev_b32 v3, 16, v76
  v_and_b32 v4, 0xffff0000, v56
  v_and_b32 v5, 0xffff0000, v76
  v_mul_f32 v2, v2, v3
  v_mul_f32 v4, v4, v5
  v_cvt_pk_bf16_f32 v2, v2, v4
  v_lshlrev_b32 v3, 16, v2
  v_and_b32 v4, 0xffff0000, v2
  v_add_f32 v0, v0, v3
  v_add_f32 v0, v0, v4
  v_lshlrev_b32 v2, 16, v57
  v_lshlrev_b32 v3, 16, v77
  v_and_b32 v4, 0xffff0000, v57
  v_and_b32 v5, 0xffff0000, v77
  v_mul_f32 v2, v2, v3
  v_mul_f32 v4, v4, v5
  v_cvt_pk_bf16_f32 v2, v2, v4
  v_lshlrev_b32 v3, 16, v2
  v_and_b32 v4, 0xffff0000, v2
  v_add_f32 v0, v0, v3
  v_add_f32 v0, v0, v4
  v_lshlrev_b32 v2, 16, v58
  v_lshlrev_b32 v3, 16, v78
  v_and_b32 v4, 0xffff0000, v58
  v_and_b32 v5, 0xffff0000, v78
  v_mul_f32 v2, v2, v3
  v_mul_f32 v4, v4, v5
  v_cvt_pk_bf16_f32 v2, v2, v4
  v_lshlrev_b32 v3, 16, v2
  v_and_b32 v4, 0xffff0000, v2
  v_add_f32 v0, v0, v3
  v_add_f32 v0, v0, v4
  v_lshlrev_b32 v2, 16, v59
  v_lshlrev_b32 v3, 16, v79
  v_and_b32 v4, 0xffff0000, v59
  v_and_b32 v5, 0xffff0000, v79
  v_mul_f32 v2, v2, v3
  v_mul_f32 v4, v4, v5
  v_cvt_pk_bf16_f32 v2, v2, v4
  v_lshlrev_b32 v3, 16, v2
  v_and_b32 v4, 0xffff0000, v2
  v_add_f32 v0, v0, v3
  v_add_f32 v0, v0, v4
  v_lshlrev_b32 v2, 16, v60
  s_waitcnt vmcnt(1)
  v_lshlrev_b32 v3, 16, v80
  v_and_b32 v4, 0xffff0000, v60
  v_and_b32 v5, 0xffff0000, v80
  v_mul_f32 v2, v2, v3
  v_mul_f32 v4, v4, v5
  v_cvt_pk_bf16_f32 v2, v2, v4
  v_lshlrev_b32 v3, 16, v2
  v_and_b32 v4, 0xffff0000, v2
  v_add_f32 v0, v0, v3
  v_add_f32 v0, v0, v4
  v_lshlrev_b32 v2, 16, v61
  v_lshlrev_b32 v3, 16, v81
  v_and_b32 v4, 0xffff0000, v61
  v_and_b32 v5, 0xffff0000, v81
  v_mul_f32 v2, v2, v3
  v_mul_f32 v4, v4, v5
  v_cvt_pk_bf16_f32 v2, v2, v4
  v_lshlrev_b32 v3, 16, v2
  v_and_b32 v4, 0xffff0000, v2
  v_add_f32 v0, v0, v3
  v_add_f32 v0, v0, v4
  v_lshlrev_b32 v2, 16, v62
  v_lshlrev_b32 v3, 16, v82
  v_and_b32 v4, 0xffff0000, v62
  v_and_b32 v5, 0xffff0000, v82
  v_mul_f32 v2, v2, v3
  v_mul_f32 v4, v4, v5
  v_cvt_pk_bf16_f32 v2, v2, v4
  v_lshlrev_b32 v3, 16, v2
  v_and_b32 v4, 0xffff0000, v2
  v_add_f32 v0, v0, v3
  v_add_f32 v0, v0, v4
  v_lshlrev_b32 v2, 16, v63
  v_lshlrev_b32 v3, 16, v83
  v_and_b32 v4, 0xffff0000, v63
  v_and_b32 v5, 0xffff0000, v83
  v_mul_f32 v2, v2, v3
  v_mul_f32 v4, v4, v5
  v_cvt_pk_bf16_f32 v2, v2, v4
  v_lshlrev_b32 v3, 16, v2
  v_and_b32 v4, 0xffff0000, v2
  v_add_f32 v0, v0, v3
  v_add_f32 v0, v0, v4
  v_lshlrev_b32 v2, 16, v64
  s_waitcnt vmcnt(0)
  v_lshlrev_b32 v3, 16, v84
  v_and_b32 v4, 0xffff0000, v64
  v_and_b32 v5, 0xffff0000, v84
  v_mul_f32 v2, v2, v3
  v_mul_f32 v4, v4, v5
  v_cvt_pk_bf16_f32 v2, v2, v4
  v_lshlrev_b32 v3, 16, v2
  v_and_b32 v4, 0xffff0000, v2
  v_add_f32 v0, v0, v3
  v_add_f32 v0, v0, v4
  v_lshlrev_b32 v2, 16, v65
  v_lshlrev_b32 v3, 16, v85
  v_and_b32 v4, 0xffff0000, v65
  v_and_b32 v5, 0xffff0000, v85
  v_mul_f32 v2, v2, v3
  v_mul_f32 v4, v4, v5
  v_cvt_pk_bf16_f32 v2, v2, v4
  v_lshlrev_b32 v3, 16, v2
  v_and_b32 v4, 0xffff0000, v2
  v_add_f32 v0, v0, v3
  v_add_f32 v0, v0, v4
  s_nop 1
  v_add_f32_dpp v0, v0, v0 row_ror:1 row_mask:0xf bank_mask:0xf
  s_nop 1
  v_add_f32_dpp v0, v0, v0 row_ror:2 row_mask:0xf bank_mask:0xf
  s_nop 1
  v_add_f32_dpp v0, v0, v0 row_ror:4 row_mask:0xf bank_mask:0xf
  s_nop 1
  v_add_f32_dpp v0, v0, v0 row_ror:8 row_mask:0xf bank_mask:0xf
  v_cvt_pk_bf16_f32 v0, v0, v0
  v_lshlrev_b32 v0, 16, v0
  v_mul_f32 v0, 3216550459, v0
  v_exp_f32 v0, v0
  s_nop 0
  v_add_f32 v0, 1.0, v0
  v_rcp_f32 v0, v0
  s_nop 0
  v_cvt_pk_bf16_f32 v0, v0, v0
  v_lshlrev_b32 v0, 16, v0
  v_lshlrev_b32 v212, 2, v212
  s_lshl_b32 s55, s70, 4
  s_add_u32 s55, s55, 66060288
  s_mov_b32 exec_lo, 0x00010001
  s_mov_b32 exec_hi, 0x00010001
  buffer_store_dword v0, v212, s[8:11], s55 offen sc1
  s_mov_b64 exec, -1
  v_lshrrev_b32 v211, 4, v200
  v_lshlrev_b32 v212, 2, v211
  v_and_b32 v213, 15, v200
  v_xor_b32 v212, v212, v213
  v_mul_u32_u24 v211, 3456, v211
  v_mov_b32 v2, 0x40000000
  v_add_u32 v213, 0, v212
  v_mul_u32_u24 v214, 57, v213
  v_lshrrev_b32 v214, 9, v214
  v_mul_u32_u24 v214, 1008, v214
  v_lshl_add_u32 v214, v213, 4, v214
  v_add_u32 v214, v214, v211
  v_cmp_lt_u32 vcc, 26, v213
  s_nop 1
  v_cndmask_b32 v207, v214, v2, vcc
  v_add_u32 v213, 16, v212
  v_mul_u32_u24 v214, 57, v213
  v_lshrrev_b32 v214, 9, v214
  v_mul_u32_u24 v214, 1008, v214
  v_lshl_add_u32 v214, v213, 4, v214
  v_add_u32 v214, v214, v211
  v_cmp_lt_u32 vcc, 26, v213
  s_nop 1
  v_cndmask_b32 v208, v214, v2, vcc
  s_mul_i32 s62, s68, 144
  s_mul_i32 s54, s52, 13824
  s_add_u32 s62, s62, s54
  s_waitcnt vmcnt(0)
  s_lshl_b32 s61, s52, 10
  s_add_u32 s61, s61, 36864
  s_add_u32 m0, s61, 0
  s_add_u32 s54, s62, 0
  buffer_load_dwordx4 v207, s[36:39], s54 offen lds
  s_add_u32 m0, s61, 4096
  s_add_u32 s54, s62, 55296
  buffer_load_dwordx4 v207, s[36:39], s54 offen lds
  s_add_u32 m0, s61, 8192
  s_add_u32 s54, s62, 110592
  buffer_load_dwordx4 v207, s[36:39], s54 offen lds
  s_add_u32 m0, s61, 12288
  s_add_u32 s54, s62, 165888
  buffer_load_dwordx4 v207, s[36:39], s54 offen lds
  s_add_u32 m0, s61, 16384
  s_add_u32 s54, s62, 0
  buffer_load_dwordx4 v208, s[36:39], s54 offen lds
  s_add_u32 m0, s61, 20480
  s_add_u32 s54, s62, 55296
  buffer_load_dwordx4 v208, s[36:39], s54 offen lds
  s_add_u32 m0, s61, 24576
  s_add_u32 s54, s62, 110592
  buffer_load_dwordx4 v208, s[36:39], s54 offen lds
  s_add_u32 m0, s61, 28672
  s_add_u32 s54, s62, 165888
  buffer_load_dwordx4 v208, s[36:39], s54 offen lds
  s_add_u32 m0, s61, 32768
  s_add_u32 s54, s62, 221184
  buffer_load_dwordx4 v207, s[36:39], s54 offen lds
  s_add_u32 m0, s61, 36864
  s_add_u32 s54, s62, 276480
  buffer_load_dwordx4 v207, s[36:39], s54 offen lds
  s_add_u32 m0, s61, 40960
  s_add_u32 s54, s62, 331776
  buffer_load_dwordx4 v207, s[36:39], s54 offen lds
  s_add_u32 m0, s61, 45056
  s_add_u32 s54, s62, 387072
  buffer_load_dwordx4 v207, s[36:39], s54 offen lds
  s_add_u32 m0, s61, 49152
  s_add_u32 s54, s62, 221184
  buffer_load_dwordx4 v208, s[36:39], s54 offen lds
  s_add_u32 m0, s61, 53248
  s_add_u32 s54, s62, 276480
  buffer_load_dwordx4 v208, s[36:39], s54 offen lds
  s_add_u32 m0, s61, 57344
  s_add_u32 s54, s62, 331776
  buffer_load_dwordx4 v208, s[36:39], s54 offen lds
  s_add_u32 m0, s61, 61440
  s_add_u32 s54, s62, 387072
  buffer_load_dwordx4 v208, s[36:39], s54 offen lds
  s_add_u32 m0, s61, 65536
  s_add_u32 s54, s62, 442368
  buffer_load_dwordx4 v207, s[36:39], s54 offen lds
  s_add_u32 m0, s61, 69632
  s_add_u32 s54, s62, 497664
  buffer_load_dwordx4 v207, s[36:39], s54 offen lds
  s_add_u32 m0, s61, 73728
  s_add_u32 s54, s62, 552960
  buffer_load_dwordx4 v207, s[36:39], s54 offen lds
  s_add_u32 m0, s61, 77824
  s_add_u32 s54, s62, 608256
  buffer_load_dwordx4 v207, s[36:39], s54 offen lds
  s_add_u32 m0, s61, 81920
  s_add_u32 s54, s62, 442368
  buffer_load_dwordx4 v208, s[36:39], s54 offen lds
  s_add_u32 m0, s61, 86016
  s_add_u32 s54, s62, 497664
  buffer_load_dwordx4 v208, s[36:39], s54 offen lds
  s_add_u32 m0, s61, 90112
  s_add_u32 s54, s62, 552960
  buffer_load_dwordx4 v208, s[36:39], s54 offen lds
  s_add_u32 m0, s61, 94208
  s_add_u32 s54, s62, 608256
  buffer_load_dwordx4 v208, s[36:39], s54 offen lds
  s_waitcnt vmcnt(20) lgkmcnt(0)
  s_barrier
  s_add_u32 m0, s61, 98304
  s_add_u32 s54, s62, 663552
  buffer_load_dwordx4 v207, s[36:39], s54 offen lds
  s_add_u32 m0, s61, 102400
  s_add_u32 s54, s62, 718848
  buffer_load_dwordx4 v207, s[36:39], s54 offen lds
  s_add_u32 m0, s61, 106496
  s_add_u32 s54, s62, 774144
  buffer_load_dwordx4 v207, s[36:39], s54 offen lds
  s_add_u32 m0, s61, 110592
  s_add_u32 s54, s62, 829440
  buffer_load_dwordx4 v207, s[36:39], s54 offen lds
  v_add_u32 v215, 36864, v210
  ds_read_b64_tr_b16 a[0:1], v215 offset:0
  ds_read_b64_tr_b16 a[2:3], v215 offset:1024
  ds_read_b64_tr_b16 a[4:5], v215 offset:4096
  ds_read_b64_tr_b16 a[6:7], v215 offset:5120
  ds_read_b64_tr_b16 a[8:9], v215 offset:8192
  ds_read_b64_tr_b16 a[10:11], v215 offset:9216
  ds_read_b64_tr_b16 a[12:13], v215 offset:12288
  ds_read_b64_tr_b16 a[14:15], v215 offset:13312
  s_waitcnt vmcnt(20) lgkmcnt(0)
  s_barrier
  s_add_u32 m0, s61, 0
  s_add_u32 s54, s62, 663552
  buffer_load_dwordx4 v208, s[36:39], s54 offen lds
  s_add_u32 m0, s61, 4096
  s_add_u32 s54, s62, 718848
  buffer_load_dwordx4 v208, s[36:39], s54 offen lds
  s_add_u32 m0, s61, 8192
  s_add_u32 s54, s62, 774144
  buffer_load_dwordx4 v208, s[36:39], s54 offen lds
  s_add_u32 m0, s61, 12288
  s_add_u32 s54, s62, 829440
  buffer_load_dwordx4 v208, s[36:39], s54 offen lds
  v_add_u32 v215, 53248, v210
  ds_read_b64_tr_b16 a[144:145], v215 offset:0
  ds_read_b64_tr_b16 a[146:147], v215 offset:1024
  ds_read_b64_tr_b16 a[148:149], v215 offset:4096
  ds_read_b64_tr_b16 a[150:151], v215 offset:5120
  ds_read_b64_tr_b16 a[152:153], v215 offset:8192
  ds_read_b64_tr_b16 a[154:155], v215 offset:9216
  ds_read_b64_tr_b16 a[156:157], v215 offset:12288
  ds_read_b64_tr_b16 a[158:159], v215 offset:13312
  s_waitcnt vmcnt(20) lgkmcnt(0)
  s_barrier
  s_add_u32 m0, s61, 16384
  s_add_u32 s54, s62, 884736
  buffer_load_dwordx4 v207, s[36:39], s54 offen lds
  s_add_u32 m0, s61, 20480
  s_add_u32 s54, s62, 940032
  buffer_load_dwordx4 v207, s[36:39], s54 offen lds
  s_add_u32 m0, s61, 24576
  s_add_u32 s54, s62, 995328
  buffer_load_dwordx4 v207, s[36:39], s54 offen lds
  s_add_u32 m0, s61, 28672
  s_add_u32 s54, s62, 1050624
  buffer_load_dwordx4 v207, s[36:39], s54 offen lds
  v_add_u32 v215, 69632, v210
  ds_read_b64_tr_b16 a[16:17], v215 offset:0
  ds_read_b64_tr_b16 a[18:19], v215 offset:1024
  ds_read_b64_tr_b16 a[20:21], v215 offset:4096
  ds_read_b64_tr_b16 a[22:23], v215 offset:5120
  ds_read_b64_tr_b16 a[24:25], v215 offset:8192
  ds_read_b64_tr_b16 a[26:27], v215 offset:9216
  ds_read_b64_tr_b16 a[28:29], v215 offset:12288
  ds_read_b64_tr_b16 a[30:31], v215 offset:13312
  s_waitcnt vmcnt(20) lgkmcnt(0)
  s_barrier
  s_add_u32 m0, s61, 32768
  s_add_u32 s54, s62, 884736
  buffer_load_dwordx4 v208, s[36:39], s54 offen lds
  s_add_u32 m0, s61, 36864
  s_add_u32 s54, s62, 940032
  buffer_load_dwordx4 v208, s[36:39], s54 offen lds
  s_add_u32 m0, s61, 40960
  s_add_u32 s54, s62, 995328
  buffer_load_dwordx4 v208, s[36:39], s54 offen lds
  s_add_u32 m0, s61, 45056
  s_add_u32 s54, s62, 1050624
  buffer_load_dwordx4 v208, s[36:39], s54 offen lds
  v_add_u32 v215, 86016, v210
  ds_read_b64_tr_b16 a[160:161], v215 offset:0
  ds_read_b64_tr_b16 a[162:163], v215 offset:1024
  ds_read_b64_tr_b16 a[164:165], v215 offset:4096
  ds_read_b64_tr_b16 a[166:167], v215 offset:5120
  ds_read_b64_tr_b16 a[168:169], v215 offset:8192
  ds_read_b64_tr_b16 a[170:171], v215 offset:9216
  ds_read_b64_tr_b16 a[172:173], v215 offset:12288
  ds_read_b64_tr_b16 a[174:175], v215 offset:13312
  s_waitcnt vmcnt(20) lgkmcnt(0)
  s_barrier
  s_add_u32 m0, s61, 49152
  s_add_u32 s54, s62, 1105920
  buffer_load_dwordx4 v207, s[36:39], s54 offen lds
  s_add_u32 m0, s61, 53248
  s_add_u32 s54, s62, 1161216
  buffer_load_dwordx4 v207, s[36:39], s54 offen lds
  s_add_u32 m0, s61, 57344
  s_add_u32 s54, s62, 1216512
  buffer_load_dwordx4 v207, s[36:39], s54 offen lds
  s_add_u32 m0, s61, 61440
  s_add_u32 s54, s62, 1271808
  buffer_load_dwordx4 v207, s[36:39], s54 offen lds
  v_add_u32 v215, 102400, v210
  ds_read_b64_tr_b16 a[32:33], v215 offset:0
  ds_read_b64_tr_b16 a[34:35], v215 offset:1024
  ds_read_b64_tr_b16 a[36:37], v215 offset:4096
  ds_read_b64_tr_b16 a[38:39], v215 offset:5120
  ds_read_b64_tr_b16 a[40:41], v215 offset:8192
  ds_read_b64_tr_b16 a[42:43], v215 offset:9216
  ds_read_b64_tr_b16 a[44:45], v215 offset:12288
  ds_read_b64_tr_b16 a[46:47], v215 offset:13312
  s_waitcnt vmcnt(20) lgkmcnt(0)
  s_barrier
  s_add_u32 m0, s61, 65536
  s_add_u32 s54, s62, 1105920
  buffer_load_dwordx4 v208, s[36:39], s54 offen lds
  s_add_u32 m0, s61, 69632
  s_add_u32 s54, s62, 1161216
  buffer_load_dwordx4 v208, s[36:39], s54 offen lds
  s_add_u32 m0, s61, 73728
  s_add_u32 s54, s62, 1216512
  buffer_load_dwordx4 v208, s[36:39], s54 offen lds
  s_add_u32 m0, s61, 77824
  s_add_u32 s54, s62, 1271808
  buffer_load_dwordx4 v208, s[36:39], s54 offen lds
  v_add_u32 v215, 118784, v210
  ds_read_b64_tr_b16 a[176:177], v215 offset:0
  ds_read_b64_tr_b16 a[178:179], v215 offset:1024
  ds_read_b64_tr_b16 a[180:181], v215 offset:4096
  ds_read_b64_tr_b16 a[182:183], v215 offset:5120
  ds_read_b64_tr_b16 a[184:185], v215 offset:8192
  ds_read_b64_tr_b16 a[186:187], v215 offset:9216
  ds_read_b64_tr_b16 a[188:189], v215 offset:12288
  ds_read_b64_tr_b16 a[190:191], v215 offset:13312
  s_waitcnt vmcnt(20) lgkmcnt(0)
  s_barrier
  s_add_u32 m0, s61, 81920
  s_add_u32 s54, s62, 1327104
  buffer_load_dwordx4 v207, s[36:39], s54 offen lds
  s_add_u32 m0, s61, 86016
  s_add_u32 s54, s62, 1382400
  buffer_load_dwordx4 v207, s[36:39], s54 offen lds
  s_add_u32 m0, s61, 90112
  s_add_u32 s54, s62, 1437696
  buffer_load_dwordx4 v207, s[36:39], s54 offen lds
  s_add_u32 m0, s61, 94208
  s_add_u32 s54, s62, 1492992
  buffer_load_dwordx4 v207, s[36:39], s54 offen lds
  v_add_u32 v215, 135168, v210
  ds_read_b64_tr_b16 a[48:49], v215 offset:0
  ds_read_b64_tr_b16 a[50:51], v215 offset:1024
  ds_read_b64_tr_b16 a[52:53], v215 offset:4096
  ds_read_b64_tr_b16 a[54:55], v215 offset:5120
  ds_read_b64_tr_b16 a[56:57], v215 offset:8192
  ds_read_b64_tr_b16 a[58:59], v215 offset:9216
  ds_read_b64_tr_b16 a[60:61], v215 offset:12288
  ds_read_b64_tr_b16 a[62:63], v215 offset:13312
  s_waitcnt vmcnt(20) lgkmcnt(0)
  s_barrier
  s_add_u32 m0, s61, 98304
  s_add_u32 s54, s62, 1327104
  buffer_load_dwordx4 v208, s[36:39], s54 offen lds
  s_add_u32 m0, s61, 102400
  s_add_u32 s54, s62, 1382400
  buffer_load_dwordx4 v208, s[36:39], s54 offen lds
  s_add_u32 m0, s61, 106496
  s_add_u32 s54, s62, 1437696
  buffer_load_dwordx4 v208, s[36:39], s54 offen lds
  s_add_u32 m0, s61, 110592
  s_add_u32 s54, s62, 1492992
  buffer_load_dwordx4 v208, s[36:39], s54 offen lds
  v_add_u32 v215, 36864, v210
  ds_read_b64_tr_b16 a[192:193], v215 offset:0
  ds_read_b64_tr_b16 a[194:195], v215 offset:1024
  ds_read_b64_tr_b16 a[196:197], v215 offset:4096
  ds_read_b64_tr_b16 a[198:199], v215 offset:5120
  ds_read_b64_tr_b16 a[200:201], v215 offset:8192
  ds_read_b64_tr_b16 a[202:203], v215 offset:9216
  ds_read_b64_tr_b16 a[204:205], v215 offset:12288
  ds_read_b64_tr_b16 a[206:207], v215 offset:13312
  s_waitcnt vmcnt(20) lgkmcnt(0)
  s_barrier
  s_add_u32 m0, s61, 0
  s_add_u32 s54, s62, 1548288
  buffer_load_dwordx4 v207, s[36:39], s54 offen lds
  s_add_u32 m0, s61, 4096
  s_add_u32 s54, s62, 1603584
  buffer_load_dwordx4 v207, s[36:39], s54 offen lds
  s_add_u32 m0, s61, 8192
  s_add_u32 s54, s62, 1658880
  buffer_load_dwordx4 v207, s[36:39], s54 offen lds
  s_add_u32 m0, s61, 12288
  s_add_u32 s54, s62, 1714176
  buffer_load_dwordx4 v207, s[36:39], s54 offen lds
  v_add_u32 v215, 53248, v210
  ds_read_b64_tr_b16 a[64:65], v215 offset:0
  ds_read_b64_tr_b16 a[66:67], v215 offset:1024
  ds_read_b64_tr_b16 a[68:69], v215 offset:4096
  ds_read_b64_tr_b16 a[70:71], v215 offset:5120
  ds_read_b64_tr_b16 a[72:73], v215 offset:8192
  ds_read_b64_tr_b16 a[74:75], v215 offset:9216
  ds_read_b64_tr_b16 a[76:77], v215 offset:12288
  ds_read_b64_tr_b16 a[78:79], v215 offset:13312
  s_waitcnt vmcnt(20) lgkmcnt(0)
  s_barrier
  s_add_u32 m0, s61, 16384
  s_add_u32 s54, s62, 1548288
  buffer_load_dwordx4 v208, s[36:39], s54 offen lds
  s_add_u32 m0, s61, 20480
  s_add_u32 s54, s62, 1603584
  buffer_load_dwordx4 v208, s[36:39], s54 offen lds
  s_add_u32 m0, s61, 24576
  s_add_u32 s54, s62, 1658880
  buffer_load_dwordx4 v208, s[36:39], s54 offen lds
  s_add_u32 m0, s61, 28672
  s_add_u32 s54, s62, 1714176
  buffer_load_dwordx4 v208, s[36:39], s54 offen lds
  v_add_u32 v215, 69632, v210
  ds_read_b64_tr_b16 a[208:209], v215 offset:0
  ds_read_b64_tr_b16 a[210:211], v215 offset:1024
  ds_read_b64_tr_b16 a[212:213], v215 offset:4096
  ds_read_b64_tr_b16 a[214:215], v215 offset:5120
  ds_read_b64_tr_b16 a[216:217], v215 offset:8192
  ds_read_b64_tr_b16 a[218:219], v215 offset:9216
  ds_read_b64_tr_b16 a[220:221], v215 offset:12288
  ds_read_b64_tr_b16 a[222:223], v215 offset:13312
  s_waitcnt vmcnt(20) lgkmcnt(0)
  s_barrier
  s_add_u32 m0, s61, 32768
  s_add_u32 s54, s62, 1769472
  buffer_load_dwordx4 v207, s[36:39], s54 offen lds
  s_add_u32 m0, s61, 36864
  s_add_u32 s54, s62, 1824768
  buffer_load_dwordx4 v207, s[36:39], s54 offen lds
  s_add_u32 m0, s61, 40960
  s_add_u32 s54, s62, 1880064
  buffer_load_dwordx4 v207, s[36:39], s54 offen lds
  s_add_u32 m0, s61, 45056
  s_add_u32 s54, s62, 1935360
  buffer_load_dwordx4 v207, s[36:39], s54 offen lds
  v_add_u32 v215, 86016, v210
  ds_read_b64_tr_b16 a[80:81], v215 offset:0
  ds_read_b64_tr_b16 a[82:83], v215 offset:1024
  ds_read_b64_tr_b16 a[84:85], v215 offset:4096
  ds_read_b64_tr_b16 a[86:87], v215 offset:5120
  ds_read_b64_tr_b16 a[88:89], v215 offset:8192
  ds_read_b64_tr_b16 a[90:91], v215 offset:9216
  ds_read_b64_tr_b16 a[92:93], v215 offset:12288
  ds_read_b64_tr_b16 a[94:95], v215 offset:13312
  s_waitcnt vmcnt(20) lgkmcnt(0)
  s_barrier
  s_add_u32 m0, s61, 49152
  s_add_u32 s54, s62, 1769472
  buffer_load_dwordx4 v208, s[36:39], s54 offen lds
  s_add_u32 m0, s61, 53248
  s_add_u32 s54, s62, 1824768
  buffer_load_dwordx4 v208, s[36:39], s54 offen lds
  s_add_u32 m0, s61, 57344
  s_add_u32 s54, s62, 1880064
  buffer_load_dwordx4 v208, s[36:39], s54 offen lds
  s_add_u32 m0, s61, 61440
  s_add_u32 s54, s62, 1935360
  buffer_load_dwordx4 v208, s[36:39], s54 offen lds
  v_add_u32 v215, 102400, v210
  ds_read_b64_tr_b16 a[224:225], v215 offset:0
  ds_read_b64_tr_b16 a[226:227], v215 offset:1024
  ds_read_b64_tr_b16 a[228:229], v215 offset:4096
  ds_read_b64_tr_b16 a[230:231], v215 offset:5120
  ds_read_b64_tr_b16 a[232:233], v215 offset:8192
  ds_read_b64_tr_b16 a[234:235], v215 offset:9216
  ds_read_b64_tr_b16 a[236:237], v215 offset:12288
  ds_read_b64_tr_b16 a[238:239], v215 offset:13312
  s_waitcnt vmcnt(20) lgkmcnt(0)
  s_barrier
  v_add_u32 v215, 118784, v210
  ds_read_b64_tr_b16 a[96:97], v215 offset:0
  ds_read_b64_tr_b16 a[98:99], v215 offset:1024
  ds_read_b64_tr_b16 a[100:101], v215 offset:4096
  ds_read_b64_tr_b16 a[102:103], v215 offset:5120
  ds_read_b64_tr_b16 a[104:105], v215 offset:8192
  ds_read_b64_tr_b16 a[106:107], v215 offset:9216
  ds_read_b64_tr_b16 a[108:109], v215 offset:12288
  ds_read_b64_tr_b16 a[110:111], v215 offset:13312
  s_waitcnt vmcnt(16) lgkmcnt(0)
  s_barrier
  v_add_u32 v215, 135168, v210
  ds_read_b64_tr_b16 a[240:241], v215 offset:0
  ds_read_b64_tr_b16 a[242:243], v215 offset:1024
  ds_read_b64_tr_b16 a[244:245], v215 offset:4096
  ds_read_b64_tr_b16 a[246:247], v215 offset:5120
  ds_read_b64_tr_b16 a[248:249], v215 offset:8192
  ds_read_b64_tr_b16 a[250:251], v215 offset:9216
  ds_read_b64_tr_b16 a[252:253], v215 offset:12288
  ds_read_b64_tr_b16 a[254:255], v215 offset:13312
  s_waitcnt vmcnt(12) lgkmcnt(0)
  s_barrier
  v_add_u32 v215, 36864, v210
  ds_read_b64_tr_b16 a[112:113], v215 offset:0
  ds_read_b64_tr_b16 a[114:115], v215 offset:1024
  ds_read_b64_tr_b16 a[116:117], v215 offset:4096
  ds_read_b64_tr_b16 a[118:119], v215 offset:5120
  ds_read_b64_tr_b16 a[120:121], v215 offset:8192
  ds_read_b64_tr_b16 a[122:123], v215 offset:9216
  ds_read_b64_tr_b16 a[124:125], v215 offset:12288
  ds_read_b64_tr_b16 a[126:127], v215 offset:13312
  s_waitcnt vmcnt(8) lgkmcnt(0)
  s_barrier
  v_add_u32 v215, 53248, v210
  ds_read_b64_tr_b16 v[224:225], v215 offset:0
  ds_read_b64_tr_b16 v[226:227], v215 offset:1024
  ds_read_b64_tr_b16 v[228:229], v215 offset:4096
  ds_read_b64_tr_b16 v[230:231], v215 offset:5120
  ds_read_b64_tr_b16 v[232:233], v215 offset:8192
  ds_read_b64_tr_b16 v[234:235], v215 offset:9216
  ds_read_b64_tr_b16 v[236:237], v215 offset:12288
  ds_read_b64_tr_b16 v[238:239], v215 offset:13312
  s_waitcnt vmcnt(4) lgkmcnt(0)
  s_barrier
  v_add_u32 v215, 69632, v210
  ds_read_b64_tr_b16 a[128:129], v215 offset:0
  ds_read_b64_tr_b16 a[130:131], v215 offset:1024
  ds_read_b64_tr_b16 a[132:133], v215 offset:4096
  ds_read_b64_tr_b16 a[134:135], v215 offset:5120
  ds_read_b64_tr_b16 a[136:137], v215 offset:8192
  ds_read_b64_tr_b16 a[138:139], v215 offset:9216
  ds_read_b64_tr_b16 a[140:141], v215 offset:12288
  ds_read_b64_tr_b16 a[142:143], v215 offset:13312
  s_waitcnt vmcnt(0) lgkmcnt(0)
  s_barrier
  v_add_u32 v215, 86016, v210
  ds_read_b64_tr_b16 v[240:241], v215 offset:0
  ds_read_b64_tr_b16 v[242:243], v215 offset:1024
  ds_read_b64_tr_b16 v[244:245], v215 offset:4096
  ds_read_b64_tr_b16 v[246:247], v215 offset:5120
  ds_read_b64_tr_b16 v[248:249], v215 offset:8192
  ds_read_b64_tr_b16 v[250:251], v215 offset:9216
  ds_read_b64_tr_b16 v[252:253], v215 offset:12288
  ds_read_b64_tr_b16 v[254:255], v215 offset:13312
  s_waitcnt lgkmcnt(0)
  s_barrier
  v_and_b32 v211, 31, v200
  v_mul_u32_u24 v218, 516, v211
  v_lshrrev_b32 v212, 5, v200
  v_lshl_add_u32 v218, v212, 3, v218
  s_lshl_b32 s54, s52, 6
  s_add_u32 s54, s54, 73728
  v_add_u32 v218, s54, v218
  s_lshl_b32 s60, s69, 2
  s_mul_i32 s60, s60, 36864
  s_add_u32 m0, s67, 36864
  s_nop 0
  buffer_load_dwordx4 v202, s[4:7], s60 offen offset:0 lds
  s_add_u32 m0, s67, 37760
  s_nop 0
  buffer_load_dwordx4 v202, s[4:7], s60 offen offset:128 lds
  s_add_u32 m0, s67, 38656
  s_nop 0
  buffer_load_dwordx4 v202, s[4:7], s60 offen offset:256 lds
  s_add_u32 m0, s67, 39552
  s_nop 0
  buffer_load_dwordx4 v202, s[4:7], s60 offen offset:384 lds
  s_add_u32 m0, s67, 40448
  s_nop 0
  buffer_load_dwordx4 v202, s[4:7], s60 offen offset:512 lds
  s_add_u32 m0, s67, 41344
  s_nop 0
  buffer_load_dwordx4 v202, s[4:7], s60 offen offset:640 lds
  s_add_u32 m0, s67, 42240
  s_nop 0
  buffer_load_dwordx4 v202, s[4:7], s60 offen offset:768 lds
  s_add_u32 m0, s67, 43136
  s_nop 0
  buffer_load_dwordx4 v202, s[4:7], s60 offen offset:896 lds
  s_add_u32 m0, s67, 44032
  s_nop 0
  buffer_load_dwordx4 v202, s[4:7], s60 offen offset:1024 lds
  s_add_u32 s60, s60, 36864
  ds_read_b128 v[32:35], v203 offset:0
  ds_read_b128 v[36:39], v204 offset:0
  ds_read_b128 v[40:43], v205 offset:0
  s_waitcnt lgkmcnt(2)
  v_mfma_f32_32x32x16_bf16 v[0:15], a[0:3], v[32:35], 0
  ds_read_b128 v[44:47], v206 offset:0
  v_mfma_f32_32x32x16_bf16 v[16:31], a[144:147], v[32:35], 0
  s_waitcnt lgkmcnt(2)
  v_mfma_f32_32x32x16_bf16 v[0:15], a[4:7], v[36:39], v[0:15]
  ds_read_b128 v[32:35], v203 offset:1024
  v_mfma_f32_32x32x16_bf16 v[16:31], a[148:151], v[36:39], v[16:31]
  s_waitcnt lgkmcnt(2)
  v_mfma_f32_32x32x16_bf16 v[0:15], a[8:11], v[40:43], v[0:15]
  ds_read_b128 v[36:39], v204 offset:1024
  v_mfma_f32_32x32x16_bf16 v[16:31], a[152:155], v[40:43], v[16:31]
  s_waitcnt lgkmcnt(2)
  v_mfma_f32_32x32x16_bf16 v[0:15], a[12:15], v[44:47], v[0:15]
  ds_read_b128 v[40:43], v205 offset:1024
  v_mfma_f32_32x32x16_bf16 v[16:31], a[156:159], v[44:47], v[16:31]
  s_waitcnt lgkmcnt(2)
  v_mfma_f32_32x32x16_bf16 v[0:15], a[16:19], v[32:35], v[0:15]
  ds_read_b128 v[44:47], v206 offset:1024
  v_mfma_f32_32x32x16_bf16 v[16:31], a[160:163], v[32:35], v[16:31]
  s_waitcnt lgkmcnt(2)
  v_mfma_f32_32x32x16_bf16 v[0:15], a[20:23], v[36:39], v[0:15]
  ds_read_b128 v[32:35], v203 offset:2048
  v_mfma_f32_32x32x16_bf16 v[16:31], a[164:167], v[36:39], v[16:31]
  s_waitcnt lgkmcnt(2)
  v_mfma_f32_32x32x16_bf16 v[0:15], a[24:27], v[40:43], v[0:15]
  ds_read_b128 v[36:39], v204 offset:2048
  v_mfma_f32_32x32x16_bf16 v[16:31], a[168:171], v[40:43], v[16:31]
  s_waitcnt lgkmcnt(2)
  v_mfma_f32_32x32x16_bf16 v[0:15], a[28:31], v[44:47], v[0:15]
  ds_read_b128 v[40:43], v205 offset:2048
  v_mfma_f32_32x32x16_bf16 v[16:31], a[172:175], v[44:47], v[16:31]
  s_waitcnt lgkmcnt(2)
  v_mfma_f32_32x32x16_bf16 v[0:15], a[32:35], v[32:35], v[0:15]
  ds_read_b128 v[44:47], v206 offset:2048
  v_mfma_f32_32x32x16_bf16 v[16:31], a[176:179], v[32:35], v[16:31]
  s_waitcnt lgkmcnt(2)
  v_mfma_f32_32x32x16_bf16 v[0:15], a[36:39], v[36:39], v[0:15]
  ds_read_b128 v[32:35], v203 offset:3072
  v_mfma_f32_32x32x16_bf16 v[16:31], a[180:183], v[36:39], v[16:31]
  s_waitcnt lgkmcnt(2)
  v_mfma_f32_32x32x16_bf16 v[0:15], a[40:43], v[40:43], v[0:15]
  ds_read_b128 v[36:39], v204 offset:3072
  v_mfma_f32_32x32x16_bf16 v[16:31], a[184:187], v[40:43], v[16:31]
  s_waitcnt lgkmcnt(2)
  v_mfma_f32_32x32x16_bf16 v[0:15], a[44:47], v[44:47], v[0:15]
  ds_read_b128 v[40:43], v205 offset:3072
  v_mfma_f32_32x32x16_bf16 v[16:31], a[188:191], v[44:47], v[16:31]
  s_waitcnt lgkmcnt(2)
  v_mfma_f32_32x32x16_bf16 v[0:15], a[48:51], v[32:35], v[0:15]
  ds_read_b128 v[44:47], v206 offset:3072
  v_mfma_f32_32x32x16_bf16 v[16:31], a[192:195], v[32:35], v[16:31]
  s_waitcnt lgkmcnt(2)
  v_mfma_f32_32x32x16_bf16 v[0:15], a[52:55], v[36:39], v[0:15]
  ds_read_b128 v[32:35], v203 offset:4096
  v_mfma_f32_32x32x16_bf16 v[16:31], a[196:199], v[36:39], v[16:31]
  s_waitcnt lgkmcnt(2)
  v_mfma_f32_32x32x16_bf16 v[0:15], a[56:59], v[40:43], v[0:15]
  ds_read_b128 v[36:39], v204 offset:4096
  v_mfma_f32_32x32x16_bf16 v[16:31], a[200:203], v[40:43], v[16:31]
  s_waitcnt lgkmcnt(2)
  v_mfma_f32_32x32x16_bf16 v[0:15], a[60:63], v[44:47], v[0:15]
  ds_read_b128 v[40:43], v205 offset:4096
  v_mfma_f32_32x32x16_bf16 v[16:31], a[204:207], v[44:47], v[16:31]
  s_waitcnt lgkmcnt(2)
  v_mfma_f32_32x32x16_bf16 v[0:15], a[64:67], v[32:35], v[0:15]
  ds_read_b128 v[44:47], v206 offset:4096
  v_mfma_f32_32x32x16_bf16 v[16:31], a[208:211], v[32:35], v[16:31]
  s_waitcnt lgkmcnt(2)
  v_mfma_f32_32x32x16_bf16 v[0:15], a[68:71], v[36:39], v[0:15]
  ds_read_b128 v[32:35], v203 offset:5120
  v_mfma_f32_32x32x16_bf16 v[16:31], a[212:215], v[36:39], v[16:31]
  s_waitcnt lgkmcnt(2)
  v_mfma_f32_32x32x16_bf16 v[0:15], a[72:75], v[40:43], v[0:15]
  ds_read_b128 v[36:39], v204 offset:5120
  v_mfma_f32_32x32x16_bf16 v[16:31], a[216:219], v[40:43], v[16:31]
  s_waitcnt lgkmcnt(2)
  v_mfma_f32_32x32x16_bf16 v[0:15], a[76:79], v[44:47], v[0:15]
  ds_read_b128 v[40:43], v205 offset:5120
  v_mfma_f32_32x32x16_bf16 v[16:31], a[220:223], v[44:47], v[16:31]
  s_waitcnt lgkmcnt(2)
  v_mfma_f32_32x32x16_bf16 v[0:15], a[80:83], v[32:35], v[0:15]
  ds_read_b128 v[44:47], v206 offset:5120
  v_mfma_f32_32x32x16_bf16 v[16:31], a[224:227], v[32:35], v[16:31]
  s_waitcnt lgkmcnt(2)
  v_mfma_f32_32x32x16_bf16 v[0:15], a[84:87], v[36:39], v[0:15]
  ds_read_b128 v[32:35], v203 offset:6144
  v_mfma_f32_32x32x16_bf16 v[16:31], a[228:231], v[36:39], v[16:31]
  s_waitcnt lgkmcnt(2)
  v_mfma_f32_32x32x16_bf16 v[0:15], a[88:91], v[40:43], v[0:15]
  ds_read_b128 v[36:39], v204 offset:6144
  v_mfma_f32_32x32x16_bf16 v[16:31], a[232:235], v[40:43], v[16:31]
  s_waitcnt lgkmcnt(2)
  v_mfma_f32_32x32x16_bf16 v[0:15], a[92:95], v[44:47], v[0:15]
  ds_read_b128 v[40:43], v205 offset:6144
  v_mfma_f32_32x32x16_bf16 v[16:31], a[236:239], v[44:47], v[16:31]
  s_waitcnt lgkmcnt(2)
  v_mfma_f32_32x32x16_bf16 v[0:15], a[96:99], v[32:35], v[0:15]
  ds_read_b128 v[44:47], v206 offset:6144
  v_mfma_f32_32x32x16_bf16 v[16:31], a[240:243], v[32:35], v[16:31]
  s_waitcnt lgkmcnt(2)
  v_mfma_f32_32x32x16_bf16 v[0:15], a[100:103], v[36:39], v[0:15]
  ds_read_b128 v[32:35], v203 offset:7168
  v_mfma_f32_32x32x16_bf16 v[16:31], a[244:247], v[36:39], v[16:31]
  s_waitcnt lgkmcnt(2)
  v_mfma_f32_32x32x16_bf16 v[0:15], a[104:107], v[40:43], v[0:15]
  ds_read_b128 v[36:39], v204 offset:7168
  v_mfma_f32_32x32x16_bf16 v[16:31], a[248:251], v[40:43], v[16:31]
  s_waitcnt lgkmcnt(2)
  v_mfma_f32_32x32x16_bf16 v[0:15], a[108:111], v[44:47], v[0:15]
  ds_read_b128 v[40:43], v205 offset:7168
  v_mfma_f32_32x32x16_bf16 v[16:31], a[252:255], v[44:47], v[16:31]
  s_waitcnt lgkmcnt(2)
  v_mfma_f32_32x32x16_bf16 v[0:15], a[112:115], v[32:35], v[0:15]
  ds_read_b128 v[44:47], v206 offset:7168
  v_mfma_f32_32x32x16_bf16 v[16:31], v[224:227], v[32:35], v[16:31]
  s_waitcnt lgkmcnt(2)
  v_mfma_f32_32x32x16_bf16 v[0:15], a[116:119], v[36:39], v[0:15]
  ds_read_b128 v[32:35], v203 offset:8192
  v_mfma_f32_32x32x16_bf16 v[16:31], v[228:231], v[36:39], v[16:31]
  s_waitcnt lgkmcnt(2)
  v_mfma_f32_32x32x16_bf16 v[0:15], a[120:123], v[40:43], v[0:15]
  ds_read_b128 v[36:39], v204 offset:8192
  v_mfma_f32_32x32x16_bf16 v[16:31], v[232:235], v[40:43], v[16:31]
  s_waitcnt lgkmcnt(2)
  v_mfma_f32_32x32x16_bf16 v[0:15], a[124:127], v[44:47], v[0:15]
  ds_read_b128 v[40:43], v205 offset:8192
  v_mfma_f32_32x32x16_bf16 v[16:31], v[236:239], v[44:47], v[16:31]
  s_waitcnt lgkmcnt(2)
  v_mfma_f32_32x32x16_bf16 v[0:15], a[128:131], v[32:35], v[0:15]
  ds_read_b128 v[44:47], v206 offset:8192
  v_mfma_f32_32x32x16_bf16 v[16:31], v[240:243], v[32:35], v[16:31]
  s_waitcnt lgkmcnt(2)
  v_mfma_f32_32x32x16_bf16 v[0:15], a[132:135], v[36:39], v[0:15]
  v_mfma_f32_32x32x16_bf16 v[16:31], v[244:247], v[36:39], v[16:31]
  s_waitcnt lgkmcnt(1)
  v_mfma_f32_32x32x16_bf16 v[0:15], a[136:139], v[40:43], v[0:15]
  v_mfma_f32_32x32x16_bf16 v[16:31], v[248:251], v[40:43], v[16:31]
  s_waitcnt lgkmcnt(0)
  v_mfma_f32_32x32x16_bf16 v[0:15], a[140:143], v[44:47], v[0:15]
  v_mfma_f32_32x32x16_bf16 v[16:31], v[252:255], v[44:47], v[16:31]
  s_nop 3
  v_cvt_pk_bf16_f32 v48, v0, v1
  v_cvt_pk_bf16_f32 v49, v2, v3
  ds_write2_b32 v218, v48, v49 offset0:0 offset1:1
  v_cvt_pk_bf16_f32 v48, v4, v5
  v_cvt_pk_bf16_f32 v49, v6, v7
  ds_write2_b32 v218, v48, v49 offset0:4 offset1:5
  v_cvt_pk_bf16_f32 v48, v8, v9
  v_cvt_pk_bf16_f32 v49, v10, v11
  ds_write2_b32 v218, v48, v49 offset0:8 offset1:9
  v_cvt_pk_bf16_f32 v48, v12, v13
  v_cvt_pk_bf16_f32 v49, v14, v15
  ds_write2_b32 v218, v48, v49 offset0:12 offset1:13
  v_cvt_pk_bf16_f32 v48, v16, v17
  v_cvt_pk_bf16_f32 v49, v18, v19
  ds_write2_b32 v218, v48, v49 offset0:64 offset1:65
  v_cvt_pk_bf16_f32 v48, v20, v21
  v_cvt_pk_bf16_f32 v49, v22, v23
  ds_write2_b32 v218, v48, v49 offset0:68 offset1:69
  v_cvt_pk_bf16_f32 v48, v24, v25
  v_cvt_pk_bf16_f32 v49, v26, v27
  ds_write2_b32 v218, v48, v49 offset0:72 offset1:73
  v_cvt_pk_bf16_f32 v48, v28, v29
  v_cvt_pk_bf16_f32 v49, v30, v31
  ds_write2_b32 v218, v48, v49 offset0:76 offset1:77
  v_add_u32 v218, 16512, v218
  s_waitcnt vmcnt(0) lgkmcnt(0)
  s_barrier
  s_add_u32 m0, s67, 0
  s_nop 0
  buffer_load_dwordx4 v202, s[4:7], s60 offen offset:0 lds
  s_add_u32 m0, s67, 896
  s_nop 0
  buffer_load_dwordx4 v202, s[4:7], s60 offen offset:128 lds
  s_add_u32 m0, s67, 1792
  s_nop 0
  buffer_load_dwordx4 v202, s[4:7], s60 offen offset:256 lds
  s_add_u32 m0, s67, 2688
  s_nop 0
  buffer_load_dwordx4 v202, s[4:7], s60 offen offset:384 lds
  s_add_u32 m0, s67, 3584
  s_nop 0
  buffer_load_dwordx4 v202, s[4:7], s60 offen offset:512 lds
  s_add_u32 m0, s67, 4480
  s_nop 0
  buffer_load_dwordx4 v202, s[4:7], s60 offen offset:640 lds
  s_add_u32 m0, s67, 5376
  s_nop 0
  buffer_load_dwordx4 v202, s[4:7], s60 offen offset:768 lds
  s_add_u32 m0, s67, 6272
  s_nop 0
  buffer_load_dwordx4 v202, s[4:7], s60 offen offset:896 lds
  s_add_u32 m0, s67, 7168
  s_nop 0
  buffer_load_dwordx4 v202, s[4:7], s60 offen offset:1024 lds
  s_add_u32 s60, s60, 36864
  ds_read_b128 v[32:35], v203 offset:36864
  ds_read_b128 v[36:39], v204 offset:36864
  ds_read_b128 v[40:43], v205 offset:36864
  s_waitcnt lgkmcnt(2)
  v_mfma_f32_32x32x16_bf16 v[0:15], a[0:3], v[32:35], 0
  ds_read_b128 v[44:47], v206 offset:36864
  v_mfma_f32_32x32x16_bf16 v[16:31], a[144:147], v[32:35], 0
  s_waitcnt lgkmcnt(2)
  v_mfma_f32_32x32x16_bf16 v[0:15], a[4:7], v[36:39], v[0:15]
  ds_read_b128 v[32:35], v203 offset:37888
  v_mfma_f32_32x32x16_bf16 v[16:31], a[148:151], v[36:39], v[16:31]
  s_waitcnt lgkmcnt(2)
  v_mfma_f32_32x32x16_bf16 v[0:15], a[8:11], v[40:43], v[0:15]
  ds_read_b128 v[36:39], v204 offset:37888
  v_mfma_f32_32x32x16_bf16 v[16:31], a[152:155], v[40:43], v[16:31]
  s_waitcnt lgkmcnt(2)
  v_mfma_f32_32x32x16_bf16 v[0:15], a[12:15], v[44:47], v[0:15]
  ds_read_b128 v[40:43], v205 offset:37888
  v_mfma_f32_32x32x16_bf16 v[16:31], a[156:159], v[44:47], v[16:31]
  s_waitcnt lgkmcnt(2)
  v_mfma_f32_32x32x16_bf16 v[0:15], a[16:19], v[32:35], v[0:15]
  ds_read_b128 v[44:47], v206 offset:37888
  v_mfma_f32_32x32x16_bf16 v[16:31], a[160:163], v[32:35], v[16:31]
  s_waitcnt lgkmcnt(2)
  v_mfma_f32_32x32x16_bf16 v[0:15], a[20:23], v[36:39], v[0:15]
  ds_read_b128 v[32:35], v203 offset:38912
  v_mfma_f32_32x32x16_bf16 v[16:31], a[164:167], v[36:39], v[16:31]
  s_waitcnt lgkmcnt(2)
  v_mfma_f32_32x32x16_bf16 v[0:15], a[24:27], v[40:43], v[0:15]
  ds_read_b128 v[36:39], v204 offset:38912
  v_mfma_f32_32x32x16_bf16 v[16:31], a[168:171], v[40:43], v[16:31]
  s_waitcnt lgkmcnt(2)
  v_mfma_f32_32x32x16_bf16 v[0:15], a[28:31], v[44:47], v[0:15]
  ds_read_b128 v[40:43], v205 offset:38912
  v_mfma_f32_32x32x16_bf16 v[16:31], a[172:175], v[44:47], v[16:31]
  s_waitcnt lgkmcnt(2)
  v_mfma_f32_32x32x16_bf16 v[0:15], a[32:35], v[32:35], v[0:15]
  ds_read_b128 v[44:47], v206 offset:38912
  v_mfma_f32_32x32x16_bf16 v[16:31], a[176:179], v[32:35], v[16:31]
  s_waitcnt lgkmcnt(2)
  v_mfma_f32_32x32x16_bf16 v[0:15], a[36:39], v[36:39], v[0:15]
  ds_read_b128 v[32:35], v203 offset:39936
  v_mfma_f32_32x32x16_bf16 v[16:31], a[180:183], v[36:39], v[16:31]
  s_waitcnt lgkmcnt(2)
  v_mfma_f32_32x32x16_bf16 v[0:15], a[40:43], v[40:43], v[0:15]
  ds_read_b128 v[36:39], v204 offset:39936
  v_mfma_f32_32x32x16_bf16 v[16:31], a[184:187], v[40:43], v[16:31]
  s_waitcnt lgkmcnt(2)
  v_mfma_f32_32x32x16_bf16 v[0:15], a[44:47], v[44:47], v[0:15]
  ds_read_b128 v[40:43], v205 offset:39936
  v_mfma_f32_32x32x16_bf16 v[16:31], a[188:191], v[44:47], v[16:31]
  s_waitcnt lgkmcnt(2)
  v_mfma_f32_32x32x16_bf16 v[0:15], a[48:51], v[32:35], v[0:15]
  ds_read_b128 v[44:47], v206 offset:39936
  v_mfma_f32_32x32x16_bf16 v[16:31], a[192:195], v[32:35], v[16:31]
  s_waitcnt lgkmcnt(2)
  v_mfma_f32_32x32x16_bf16 v[0:15], a[52:55], v[36:39], v[0:15]
  ds_read_b128 v[32:35], v203 offset:40960
  v_mfma_f32_32x32x16_bf16 v[16:31], a[196:199], v[36:39], v[16:31]
  s_waitcnt lgkmcnt(2)
  v_mfma_f32_32x32x16_bf16 v[0:15], a[56:59], v[40:43], v[0:15]
  ds_read_b128 v[36:39], v204 offset:40960
  v_mfma_f32_32x32x16_bf16 v[16:31], a[200:203], v[40:43], v[16:31]
  s_waitcnt lgkmcnt(2)
  v_mfma_f32_32x32x16_bf16 v[0:15], a[60:63], v[44:47], v[0:15]
  ds_read_b128 v[40:43], v205 offset:40960
  v_mfma_f32_32x32x16_bf16 v[16:31], a[204:207], v[44:47], v[16:31]
  s_waitcnt lgkmcnt(2)
  v_mfma_f32_32x32x16_bf16 v[0:15], a[64:67], v[32:35], v[0:15]
  ds_read_b128 v[44:47], v206 offset:40960
  v_mfma_f32_32x32x16_bf16 v[16:31], a[208:211], v[32:35], v[16:31]
  s_waitcnt lgkmcnt(2)
  v_mfma_f32_32x32x16_bf16 v[0:15], a[68:71], v[36:39], v[0:15]
  ds_read_b128 v[32:35], v203 offset:41984
  v_mfma_f32_32x32x16_bf16 v[16:31], a[212:215], v[36:39], v[16:31]
  s_waitcnt lgkmcnt(2)
  v_mfma_f32_32x32x16_bf16 v[0:15], a[72:75], v[40:43], v[0:15]
  ds_read_b128 v[36:39], v204 offset:41984
  v_mfma_f32_32x32x16_bf16 v[16:31], a[216:219], v[40:43], v[16:31]
  s_waitcnt lgkmcnt(2)
  v_mfma_f32_32x32x16_bf16 v[0:15], a[76:79], v[44:47], v[0:15]
  ds_read_b128 v[40:43], v205 offset:41984
  v_mfma_f32_32x32x16_bf16 v[16:31], a[220:223], v[44:47], v[16:31]
  s_waitcnt lgkmcnt(2)
  v_mfma_f32_32x32x16_bf16 v[0:15], a[80:83], v[32:35], v[0:15]
  ds_read_b128 v[44:47], v206 offset:41984
  v_mfma_f32_32x32x16_bf16 v[16:31], a[224:227], v[32:35], v[16:31]
  s_waitcnt lgkmcnt(2)
  v_mfma_f32_32x32x16_bf16 v[0:15], a[84:87], v[36:39], v[0:15]
  ds_read_b128 v[32:35], v203 offset:43008
  v_mfma_f32_32x32x16_bf16 v[16:31], a[228:231], v[36:39], v[16:31]
  s_waitcnt lgkmcnt(2)
  v_mfma_f32_32x32x16_bf16 v[0:15], a[88:91], v[40:43], v[0:15]
  ds_read_b128 v[36:39], v204 offset:43008
  v_mfma_f32_32x32x16_bf16 v[16:31], a[232:235], v[40:43], v[16:31]
  s_waitcnt lgkmcnt(2)
  v_mfma_f32_32x32x16_bf16 v[0:15], a[92:95], v[44:47], v[0:15]
  ds_read_b128 v[40:43], v205 offset:43008
  v_mfma_f32_32x32x16_bf16 v[16:31], a[236:239], v[44:47], v[16:31]
  s_waitcnt lgkmcnt(2)
  v_mfma_f32_32x32x16_bf16 v[0:15], a[96:99], v[32:35], v[0:15]
  ds_read_b128 v[44:47], v206 offset:43008
  v_mfma_f32_32x32x16_bf16 v[16:31], a[240:243], v[32:35], v[16:31]
  s_waitcnt lgkmcnt(2)
  v_mfma_f32_32x32x16_bf16 v[0:15], a[100:103], v[36:39], v[0:15]
  ds_read_b128 v[32:35], v203 offset:44032
  v_mfma_f32_32x32x16_bf16 v[16:31], a[244:247], v[36:39], v[16:31]
  s_waitcnt lgkmcnt(2)
  v_mfma_f32_32x32x16_bf16 v[0:15], a[104:107], v[40:43], v[0:15]
  ds_read_b128 v[36:39], v204 offset:44032
  v_mfma_f32_32x32x16_bf16 v[16:31], a[248:251], v[40:43], v[16:31]
  s_waitcnt lgkmcnt(2)
  v_mfma_f32_32x32x16_bf16 v[0:15], a[108:111], v[44:47], v[0:15]
  ds_read_b128 v[40:43], v205 offset:44032
  v_mfma_f32_32x32x16_bf16 v[16:31], a[252:255], v[44:47], v[16:31]
  s_waitcnt lgkmcnt(2)
  v_mfma_f32_32x32x16_bf16 v[0:15], a[112:115], v[32:35], v[0:15]
  ds_read_b128 v[44:47], v206 offset:44032
  v_mfma_f32_32x32x16_bf16 v[16:31], v[224:227], v[32:35], v[16:31]
  s_waitcnt lgkmcnt(2)
  v_mfma_f32_32x32x16_bf16 v[0:15], a[116:119], v[36:39], v[0:15]
  ds_read_b128 v[32:35], v203 offset:45056
  v_mfma_f32_32x32x16_bf16 v[16:31], v[228:231], v[36:39], v[16:31]
  s_waitcnt lgkmcnt(2)
  v_mfma_f32_32x32x16_bf16 v[0:15], a[120:123], v[40:43], v[0:15]
  ds_read_b128 v[36:39], v204 offset:45056
  v_mfma_f32_32x32x16_bf16 v[16:31], v[232:235], v[40:43], v[16:31]
  s_waitcnt lgkmcnt(2)
  v_mfma_f32_32x32x16_bf16 v[0:15], a[124:127], v[44:47], v[0:15]
  ds_read_b128 v[40:43], v205 offset:45056
  v_mfma_f32_32x32x16_bf16 v[16:31], v[236:239], v[44:47], v[16:31]
  s_waitcnt lgkmcnt(2)
  v_mfma_f32_32x32x16_bf16 v[0:15], a[128:131], v[32:35], v[0:15]
  ds_read_b128 v[44:47], v206 offset:45056
  v_mfma_f32_32x32x16_bf16 v[16:31], v[240:243], v[32:35], v[16:31]
  s_waitcnt lgkmcnt(2)
  v_mfma_f32_32x32x16_bf16 v[0:15], a[132:135], v[36:39], v[0:15]
  v_mfma_f32_32x32x16_bf16 v[16:31], v[244:247], v[36:39], v[16:31]
  s_waitcnt lgkmcnt(1)
  v_mfma_f32_32x32x16_bf16 v[0:15], a[136:139], v[40:43], v[0:15]
  v_mfma_f32_32x32x16_bf16 v[16:31], v[248:251], v[40:43], v[16:31]
  s_waitcnt lgkmcnt(0)
  v_mfma_f32_32x32x16_bf16 v[0:15], a[140:143], v[44:47], v[0:15]
  v_mfma_f32_32x32x16_bf16 v[16:31], v[252:255], v[44:47], v[16:31]
  s_nop 3
  v_cvt_pk_bf16_f32 v48, v0, v1
  v_cvt_pk_bf16_f32 v49, v2, v3
  ds_write2_b32 v218, v48, v49 offset0:0 offset1:1
  v_cvt_pk_bf16_f32 v48, v4, v5
  v_cvt_pk_bf16_f32 v49, v6, v7
  ds_write2_b32 v218, v48, v49 offset0:4 offset1:5
  v_cvt_pk_bf16_f32 v48, v8, v9
  v_cvt_pk_bf16_f32 v49, v10, v11
  ds_write2_b32 v218, v48, v49 offset0:8 offset1:9
  v_cvt_pk_bf16_f32 v48, v12, v13
  v_cvt_pk_bf16_f32 v49, v14, v15
  ds_write2_b32 v218, v48, v49 offset0:12 offset1:13
  v_cvt_pk_bf16_f32 v48, v16, v17
  v_cvt_pk_bf16_f32 v49, v18, v19
  ds_write2_b32 v218, v48, v49 offset0:64 offset1:65
  v_cvt_pk_bf16_f32 v48, v20, v21
  v_cvt_pk_bf16_f32 v49, v22, v23
  ds_write2_b32 v218, v48, v49 offset0:68 offset1:69
  v_cvt_pk_bf16_f32 v48, v24, v25
  v_cvt_pk_bf16_f32 v49, v26, v27
  ds_write2_b32 v218, v48, v49 offset0:72 offset1:73
  v_cvt_pk_bf16_f32 v48, v28, v29
  v_cvt_pk_bf16_f32 v49, v30, v31
  ds_write2_b32 v218, v48, v49 offset0:76 offset1:77
  v_add_u32 v218, 16512, v218
  s_waitcnt vmcnt(0) lgkmcnt(0)
  s_barrier
  s_add_u32 m0, s67, 36864
  s_nop 0
  buffer_load_dwordx4 v202, s[4:7], s60 offen offset:0 lds
  s_add_u32 m0, s67, 37760
  s_nop 0
  buffer_load_dwordx4 v202, s[4:7], s60 offen offset:128 lds
  s_add_u32 m0, s67, 38656
  s_nop 0
  buffer_load_dwordx4 v202, s[4:7], s60 offen offset:256 lds
  s_add_u32 m0, s67, 39552
  s_nop 0
  buffer_load_dwordx4 v202, s[4:7], s60 offen offset:384 lds
  s_add_u32 m0, s67, 40448
  s_nop 0
  buffer_load_dwordx4 v202, s[4:7], s60 offen offset:512 lds
  s_add_u32 m0, s67, 41344
  s_nop 0
  buffer_load_dwordx4 v202, s[4:7], s60 offen offset:640 lds
  s_add_u32 m0, s67, 42240
  s_nop 0
  buffer_load_dwordx4 v202, s[4:7], s60 offen offset:768 lds
  s_add_u32 m0, s67, 43136
  s_nop 0
  buffer_load_dwordx4 v202, s[4:7], s60 offen offset:896 lds
  s_add_u32 m0, s67, 44032
  s_nop 0
  buffer_load_dwordx4 v202, s[4:7], s60 offen offset:1024 lds
  s_add_u32 s60, s60, 36864
  ds_read_b128 v[32:35], v203 offset:0
  ds_read_b128 v[36:39], v204 offset:0
  ds_read_b128 v[40:43], v205 offset:0
  s_waitcnt lgkmcnt(2)
  v_mfma_f32_32x32x16_bf16 v[0:15], a[0:3], v[32:35], 0
  ds_read_b128 v[44:47], v206 offset:0
  v_mfma_f32_32x32x16_bf16 v[16:31], a[144:147], v[32:35], 0
  s_waitcnt lgkmcnt(2)
  v_mfma_f32_32x32x16_bf16 v[0:15], a[4:7], v[36:39], v[0:15]
  ds_read_b128 v[32:35], v203 offset:1024
  v_mfma_f32_32x32x16_bf16 v[16:31], a[148:151], v[36:39], v[16:31]
  s_waitcnt lgkmcnt(2)
  v_mfma_f32_32x32x16_bf16 v[0:15], a[8:11], v[40:43], v[0:15]
  ds_read_b128 v[36:39], v204 offset:1024
  v_mfma_f32_32x32x16_bf16 v[16:31], a[152:155], v[40:43], v[16:31]
  s_waitcnt lgkmcnt(2)
  v_mfma_f32_32x32x16_bf16 v[0:15], a[12:15], v[44:47], v[0:15]
  ds_read_b128 v[40:43], v205 offset:1024
  v_mfma_f32_32x32x16_bf16 v[16:31], a[156:159], v[44:47], v[16:31]
  s_waitcnt lgkmcnt(2)
  v_mfma_f32_32x32x16_bf16 v[0:15], a[16:19], v[32:35], v[0:15]
  ds_read_b128 v[44:47], v206 offset:1024
  v_mfma_f32_32x32x16_bf16 v[16:31], a[160:163], v[32:35], v[16:31]
  s_waitcnt lgkmcnt(2)
  v_mfma_f32_32x32x16_bf16 v[0:15], a[20:23], v[36:39], v[0:15]
  ds_read_b128 v[32:35], v203 offset:2048
  v_mfma_f32_32x32x16_bf16 v[16:31], a[164:167], v[36:39], v[16:31]
  s_waitcnt lgkmcnt(2)
  v_mfma_f32_32x32x16_bf16 v[0:15], a[24:27], v[40:43], v[0:15]
  ds_read_b128 v[36:39], v204 offset:2048
  v_mfma_f32_32x32x16_bf16 v[16:31], a[168:171], v[40:43], v[16:31]
  s_waitcnt lgkmcnt(2)
  v_mfma_f32_32x32x16_bf16 v[0:15], a[28:31], v[44:47], v[0:15]
  ds_read_b128 v[40:43], v205 offset:2048
  v_mfma_f32_32x32x16_bf16 v[16:31], a[172:175], v[44:47], v[16:31]
  s_waitcnt lgkmcnt(2)
  v_mfma_f32_32x32x16_bf16 v[0:15], a[32:35], v[32:35], v[0:15]
  ds_read_b128 v[44:47], v206 offset:2048
  v_mfma_f32_32x32x16_bf16 v[16:31], a[176:179], v[32:35], v[16:31]
  s_waitcnt lgkmcnt(2)
  v_mfma_f32_32x32x16_bf16 v[0:15], a[36:39], v[36:39], v[0:15]
  ds_read_b128 v[32:35], v203 offset:3072
  v_mfma_f32_32x32x16_bf16 v[16:31], a[180:183], v[36:39], v[16:31]
  s_waitcnt lgkmcnt(2)
  v_mfma_f32_32x32x16_bf16 v[0:15], a[40:43], v[40:43], v[0:15]
  ds_read_b128 v[36:39], v204 offset:3072
  v_mfma_f32_32x32x16_bf16 v[16:31], a[184:187], v[40:43], v[16:31]
  s_waitcnt lgkmcnt(2)
  v_mfma_f32_32x32x16_bf16 v[0:15], a[44:47], v[44:47], v[0:15]
  ds_read_b128 v[40:43], v205 offset:3072
  v_mfma_f32_32x32x16_bf16 v[16:31], a[188:191], v[44:47], v[16:31]
  s_waitcnt lgkmcnt(2)
  v_mfma_f32_32x32x16_bf16 v[0:15], a[48:51], v[32:35], v[0:15]
  ds_read_b128 v[44:47], v206 offset:3072
  v_mfma_f32_32x32x16_bf16 v[16:31], a[192:195], v[32:35], v[16:31]
  s_waitcnt lgkmcnt(2)
  v_mfma_f32_32x32x16_bf16 v[0:15], a[52:55], v[36:39], v[0:15]
  ds_read_b128 v[32:35], v203 offset:4096
  v_mfma_f32_32x32x16_bf16 v[16:31], a[196:199], v[36:39], v[16:31]
  s_waitcnt lgkmcnt(2)
  v_mfma_f32_32x32x16_bf16 v[0:15], a[56:59], v[40:43], v[0:15]
  ds_read_b128 v[36:39], v204 offset:4096
  v_mfma_f32_32x32x16_bf16 v[16:31], a[200:203], v[40:43], v[16:31]
  s_waitcnt lgkmcnt(2)
  v_mfma_f32_32x32x16_bf16 v[0:15], a[60:63], v[44:47], v[0:15]
  ds_read_b128 v[40:43], v205 offset:4096
  v_mfma_f32_32x32x16_bf16 v[16:31], a[204:207], v[44:47], v[16:31]
  s_waitcnt lgkmcnt(2)
  v_mfma_f32_32x32x16_bf16 v[0:15], a[64:67], v[32:35], v[0:15]
  ds_read_b128 v[44:47], v206 offset:4096
  v_mfma_f32_32x32x16_bf16 v[16:31], a[208:211], v[32:35], v[16:31]
  s_waitcnt lgkmcnt(2)
  v_mfma_f32_32x32x16_bf16 v[0:15], a[68:71], v[36:39], v[0:15]
  ds_read_b128 v[32:35], v203 offset:5120
  v_mfma_f32_32x32x16_bf16 v[16:31], a[212:215], v[36:39], v[16:31]
  s_waitcnt lgkmcnt(2)
  v_mfma_f32_32x32x16_bf16 v[0:15], a[72:75], v[40:43], v[0:15]
  ds_read_b128 v[36:39], v204 offset:5120
  v_mfma_f32_32x32x16_bf16 v[16:31], a[216:219], v[40:43], v[16:31]
  s_waitcnt lgkmcnt(2)
  v_mfma_f32_32x32x16_bf16 v[0:15], a[76:79], v[44:47], v[0:15]
  ds_read_b128 v[40:43], v205 offset:5120
  v_mfma_f32_32x32x16_bf16 v[16:31], a[220:223], v[44:47], v[16:31]
  s_waitcnt lgkmcnt(2)
  v_mfma_f32_32x32x16_bf16 v[0:15], a[80:83], v[32:35], v[0:15]
  ds_read_b128 v[44:47], v206 offset:5120
  v_mfma_f32_32x32x16_bf16 v[16:31], a[224:227], v[32:35], v[16:31]
  s_waitcnt lgkmcnt(2)
  v_mfma_f32_32x32x16_bf16 v[0:15], a[84:87], v[36:39], v[0:15]
  ds_read_b128 v[32:35], v203 offset:6144
  v_mfma_f32_32x32x16_bf16 v[16:31], a[228:231], v[36:39], v[16:31]
  s_waitcnt lgkmcnt(2)
  v_mfma_f32_32x32x16_bf16 v[0:15], a[88:91], v[40:43], v[0:15]
  ds_read_b128 v[36:39], v204 offset:6144
  v_mfma_f32_32x32x16_bf16 v[16:31], a[232:235], v[40:43], v[16:31]
  s_waitcnt lgkmcnt(2)
  v_mfma_f32_32x32x16_bf16 v[0:15], a[92:95], v[44:47], v[0:15]
  ds_read_b128 v[40:43], v205 offset:6144
  v_mfma_f32_32x32x16_bf16 v[16:31], a[236:239], v[44:47], v[16:31]
  s_waitcnt lgkmcnt(2)
  v_mfma_f32_32x32x16_bf16 v[0:15], a[96:99], v[32:35], v[0:15]
  ds_read_b128 v[44:47], v206 offset:6144
  v_mfma_f32_32x32x16_bf16 v[16:31], a[240:243], v[32:35], v[16:31]
  s_waitcnt lgkmcnt(2)
  v_mfma_f32_32x32x16_bf16 v[0:15], a[100:103], v[36:39], v[0:15]
  ds_read_b128 v[32:35], v203 offset:7168
  v_mfma_f32_32x32x16_bf16 v[16:31], a[244:247], v[36:39], v[16:31]
  s_waitcnt lgkmcnt(2)
  v_mfma_f32_32x32x16_bf16 v[0:15], a[104:107], v[40:43], v[0:15]
  ds_read_b128 v[36:39], v204 offset:7168
  v_mfma_f32_32x32x16_bf16 v[16:31], a[248:251], v[40:43], v[16:31]
  s_waitcnt lgkmcnt(2)
  v_mfma_f32_32x32x16_bf16 v[0:15], a[108:111], v[44:47], v[0:15]
  ds_read_b128 v[40:43], v205 offset:7168
  v_mfma_f32_32x32x16_bf16 v[16:31], a[252:255], v[44:47], v[16:31]
  s_waitcnt lgkmcnt(2)
  v_mfma_f32_32x32x16_bf16 v[0:15], a[112:115], v[32:35], v[0:15]
  ds_read_b128 v[44:47], v206 offset:7168
  v_mfma_f32_32x32x16_bf16 v[16:31], v[224:227], v[32:35], v[16:31]
  s_waitcnt lgkmcnt(2)
  v_mfma_f32_32x32x16_bf16 v[0:15], a[116:119], v[36:39], v[0:15]
  ds_read_b128 v[32:35], v203 offset:8192
  v_mfma_f32_32x32x16_bf16 v[16:31], v[228:231], v[36:39], v[16:31]
  s_waitcnt lgkmcnt(2)
  v_mfma_f32_32x32x16_bf16 v[0:15], a[120:123], v[40:43], v[0:15]
  ds_read_b128 v[36:39], v204 offset:8192
  v_mfma_f32_32x32x16_bf16 v[16:31], v[232:235], v[40:43], v[16:31]
  s_waitcnt lgkmcnt(2)
  v_mfma_f32_32x32x16_bf16 v[0:15], a[124:127], v[44:47], v[0:15]
  ds_read_b128 v[40:43], v205 offset:8192
  v_mfma_f32_32x32x16_bf16 v[16:31], v[236:239], v[44:47], v[16:31]
  s_waitcnt lgkmcnt(2)
  v_mfma_f32_32x32x16_bf16 v[0:15], a[128:131], v[32:35], v[0:15]
  ds_read_b128 v[44:47], v206 offset:8192
  v_mfma_f32_32x32x16_bf16 v[16:31], v[240:243], v[32:35], v[16:31]
  s_waitcnt lgkmcnt(2)
  v_mfma_f32_32x32x16_bf16 v[0:15], a[132:135], v[36:39], v[0:15]
  v_mfma_f32_32x32x16_bf16 v[16:31], v[244:247], v[36:39], v[16:31]
  s_waitcnt lgkmcnt(1)
  v_mfma_f32_32x32x16_bf16 v[0:15], a[136:139], v[40:43], v[0:15]
  v_mfma_f32_32x32x16_bf16 v[16:31], v[248:251], v[40:43], v[16:31]
  s_waitcnt lgkmcnt(0)
  v_mfma_f32_32x32x16_bf16 v[0:15], a[140:143], v[44:47], v[0:15]
  v_mfma_f32_32x32x16_bf16 v[16:31], v[252:255], v[44:47], v[16:31]
  s_nop 3
  v_cvt_pk_bf16_f32 v48, v0, v1
  v_cvt_pk_bf16_f32 v49, v2, v3
  ds_write2_b32 v218, v48, v49 offset0:0 offset1:1
  v_cvt_pk_bf16_f32 v48, v4, v5
  v_cvt_pk_bf16_f32 v49, v6, v7
  ds_write2_b32 v218, v48, v49 offset0:4 offset1:5
  v_cvt_pk_bf16_f32 v48, v8, v9
  v_cvt_pk_bf16_f32 v49, v10, v11
  ds_write2_b32 v218, v48, v49 offset0:8 offset1:9
  v_cvt_pk_bf16_f32 v48, v12, v13
  v_cvt_pk_bf16_f32 v49, v14, v15
  ds_write2_b32 v218, v48, v49 offset0:12 offset1:13
  v_cvt_pk_bf16_f32 v48, v16, v17
  v_cvt_pk_bf16_f32 v49, v18, v19
  ds_write2_b32 v218, v48, v49 offset0:64 offset1:65
  v_cvt_pk_bf16_f32 v48, v20, v21
  v_cvt_pk_bf16_f32 v49, v22, v23
  ds_write2_b32 v218, v48, v49 offset0:68 offset1:69
  v_cvt_pk_bf16_f32 v48, v24, v25
  v_cvt_pk_bf16_f32 v49, v26, v27
  ds_write2_b32 v218, v48, v49 offset0:72 offset1:73
  v_cvt_pk_bf16_f32 v48, v28, v29
  v_cvt_pk_bf16_f32 v49, v30, v31
  ds_write2_b32 v218, v48, v49 offset0:76 offset1:77
  v_add_u32 v218, 16512, v218
  s_waitcnt vmcnt(0) lgkmcnt(0)
  s_barrier
  s_add_u32 m0, s67, 0
  s_nop 0
  buffer_load_dwordx4 v202, s[4:7], s60 offen offset:0 lds
  s_add_u32 m0, s67, 896
  s_nop 0
  buffer_load_dwordx4 v202, s[4:7], s60 offen offset:128 lds
  s_add_u32 m0, s67, 1792
  s_nop 0
  buffer_load_dwordx4 v202, s[4:7], s60 offen offset:256 lds
  s_add_u32 m0, s67, 2688
  s_nop 0
  buffer_load_dwordx4 v202, s[4:7], s60 offen offset:384 lds
  s_add_u32 m0, s67, 3584
  s_nop 0
  buffer_load_dwordx4 v202, s[4:7], s60 offen offset:512 lds
  s_add_u32 m0, s67, 4480
  s_nop 0
  buffer_load_dwordx4 v202, s[4:7], s60 offen offset:640 lds
  s_add_u32 m0, s67, 5376
  s_nop 0
  buffer_load_dwordx4 v202, s[4:7], s60 offen offset:768 lds
  s_add_u32 m0, s67, 6272
  s_nop 0
  buffer_load_dwordx4 v202, s[4:7], s60 offen offset:896 lds
  s_add_u32 m0, s67, 7168
  s_nop 0
  buffer_load_dwordx4 v202, s[4:7], s60 offen offset:1024 lds
  s_add_u32 s60, s60, 36864
  ds_read_b128 v[32:35], v203 offset:36864
  ds_read_b128 v[36:39], v204 offset:36864
  ds_read_b128 v[40:43], v205 offset:36864
  s_waitcnt lgkmcnt(2)
  v_mfma_f32_32x32x16_bf16 v[0:15], a[0:3], v[32:35], 0
  ds_read_b128 v[44:47], v206 offset:36864
  v_mfma_f32_32x32x16_bf16 v[16:31], a[144:147], v[32:35], 0
  s_waitcnt lgkmcnt(2)
  v_mfma_f32_32x32x16_bf16 v[0:15], a[4:7], v[36:39], v[0:15]
  ds_read_b128 v[32:35], v203 offset:37888
  v_mfma_f32_32x32x16_bf16 v[16:31], a[148:151], v[36:39], v[16:31]
  s_waitcnt lgkmcnt(2)
  v_mfma_f32_32x32x16_bf16 v[0:15], a[8:11], v[40:43], v[0:15]
  ds_read_b128 v[36:39], v204 offset:37888
  v_mfma_f32_32x32x16_bf16 v[16:31], a[152:155], v[40:43], v[16:31]
  s_waitcnt lgkmcnt(2)
  v_mfma_f32_32x32x16_bf16 v[0:15], a[12:15], v[44:47], v[0:15]
  ds_read_b128 v[40:43], v205 offset:37888
  v_mfma_f32_32x32x16_bf16 v[16:31], a[156:159], v[44:47], v[16:31]
  s_waitcnt lgkmcnt(2)
  v_mfma_f32_32x32x16_bf16 v[0:15], a[16:19], v[32:35], v[0:15]
  ds_read_b128 v[44:47], v206 offset:37888
  v_mfma_f32_32x32x16_bf16 v[16:31], a[160:163], v[32:35], v[16:31]
  s_waitcnt lgkmcnt(2)
  v_mfma_f32_32x32x16_bf16 v[0:15], a[20:23], v[36:39], v[0:15]
  ds_read_b128 v[32:35], v203 offset:38912
  v_mfma_f32_32x32x16_bf16 v[16:31], a[164:167], v[36:39], v[16:31]
  s_waitcnt lgkmcnt(2)
  v_mfma_f32_32x32x16_bf16 v[0:15], a[24:27], v[40:43], v[0:15]
  ds_read_b128 v[36:39], v204 offset:38912
  v_mfma_f32_32x32x16_bf16 v[16:31], a[168:171], v[40:43], v[16:31]
  s_waitcnt lgkmcnt(2)
  v_mfma_f32_32x32x16_bf16 v[0:15], a[28:31], v[44:47], v[0:15]
  ds_read_b128 v[40:43], v205 offset:38912
  v_mfma_f32_32x32x16_bf16 v[16:31], a[172:175], v[44:47], v[16:31]
  s_waitcnt lgkmcnt(2)
  v_mfma_f32_32x32x16_bf16 v[0:15], a[32:35], v[32:35], v[0:15]
  ds_read_b128 v[44:47], v206 offset:38912
  v_mfma_f32_32x32x16_bf16 v[16:31], a[176:179], v[32:35], v[16:31]
  s_waitcnt lgkmcnt(2)
  v_mfma_f32_32x32x16_bf16 v[0:15], a[36:39], v[36:39], v[0:15]
  ds_read_b128 v[32:35], v203 offset:39936
  v_mfma_f32_32x32x16_bf16 v[16:31], a[180:183], v[36:39], v[16:31]
  s_waitcnt lgkmcnt(2)
  v_mfma_f32_32x32x16_bf16 v[0:15], a[40:43], v[40:43], v[0:15]
  ds_read_b128 v[36:39], v204 offset:39936
  v_mfma_f32_32x32x16_bf16 v[16:31], a[184:187], v[40:43], v[16:31]
  s_waitcnt lgkmcnt(2)
  v_mfma_f32_32x32x16_bf16 v[0:15], a[44:47], v[44:47], v[0:15]
  ds_read_b128 v[40:43], v205 offset:39936
  v_mfma_f32_32x32x16_bf16 v[16:31], a[188:191], v[44:47], v[16:31]
  s_waitcnt lgkmcnt(2)
  v_mfma_f32_32x32x16_bf16 v[0:15], a[48:51], v[32:35], v[0:15]
  ds_read_b128 v[44:47], v206 offset:39936
  v_mfma_f32_32x32x16_bf16 v[16:31], a[192:195], v[32:35], v[16:31]
  s_waitcnt lgkmcnt(2)
  v_mfma_f32_32x32x16_bf16 v[0:15], a[52:55], v[36:39], v[0:15]
  ds_read_b128 v[32:35], v203 offset:40960
  v_mfma_f32_32x32x16_bf16 v[16:31], a[196:199], v[36:39], v[16:31]
  s_waitcnt lgkmcnt(2)
  v_mfma_f32_32x32x16_bf16 v[0:15], a[56:59], v[40:43], v[0:15]
  ds_read_b128 v[36:39], v204 offset:40960
  v_mfma_f32_32x32x16_bf16 v[16:31], a[200:203], v[40:43], v[16:31]
  s_waitcnt lgkmcnt(2)
  v_mfma_f32_32x32x16_bf16 v[0:15], a[60:63], v[44:47], v[0:15]
  ds_read_b128 v[40:43], v205 offset:40960
  v_mfma_f32_32x32x16_bf16 v[16:31], a[204:207], v[44:47], v[16:31]
  s_waitcnt lgkmcnt(2)
  v_mfma_f32_32x32x16_bf16 v[0:15], a[64:67], v[32:35], v[0:15]
  ds_read_b128 v[44:47], v206 offset:40960
  v_mfma_f32_32x32x16_bf16 v[16:31], a[208:211], v[32:35], v[16:31]
  s_waitcnt lgkmcnt(2)
  v_mfma_f32_32x32x16_bf16 v[0:15], a[68:71], v[36:39], v[0:15]
  ds_read_b128 v[32:35], v203 offset:41984
  v_mfma_f32_32x32x16_bf16 v[16:31], a[212:215], v[36:39], v[16:31]
  s_waitcnt lgkmcnt(2)
  v_mfma_f32_32x32x16_bf16 v[0:15], a[72:75], v[40:43], v[0:15]
  ds_read_b128 v[36:39], v204 offset:41984
  v_mfma_f32_32x32x16_bf16 v[16:31], a[216:219], v[40:43], v[16:31]
  s_waitcnt lgkmcnt(2)
  v_mfma_f32_32x32x16_bf16 v[0:15], a[76:79], v[44:47], v[0:15]
  ds_read_b128 v[40:43], v205 offset:41984
  v_mfma_f32_32x32x16_bf16 v[16:31], a[220:223], v[44:47], v[16:31]
  s_waitcnt lgkmcnt(2)
  v_mfma_f32_32x32x16_bf16 v[0:15], a[80:83], v[32:35], v[0:15]
  ds_read_b128 v[44:47], v206 offset:41984
  v_mfma_f32_32x32x16_bf16 v[16:31], a[224:227], v[32:35], v[16:31]
  s_waitcnt lgkmcnt(2)
  v_mfma_f32_32x32x16_bf16 v[0:15], a[84:87], v[36:39], v[0:15]
  ds_read_b128 v[32:35], v203 offset:43008
  v_mfma_f32_32x32x16_bf16 v[16:31], a[228:231], v[36:39], v[16:31]
  s_waitcnt lgkmcnt(2)
  v_mfma_f32_32x32x16_bf16 v[0:15], a[88:91], v[40:43], v[0:15]
  ds_read_b128 v[36:39], v204 offset:43008
  v_mfma_f32_32x32x16_bf16 v[16:31], a[232:235], v[40:43], v[16:31]
  s_waitcnt lgkmcnt(2)
  v_mfma_f32_32x32x16_bf16 v[0:15], a[92:95], v[44:47], v[0:15]
  ds_read_b128 v[40:43], v205 offset:43008
  v_mfma_f32_32x32x16_bf16 v[16:31], a[236:239], v[44:47], v[16:31]
  s_waitcnt lgkmcnt(2)
  v_mfma_f32_32x32x16_bf16 v[0:15], a[96:99], v[32:35], v[0:15]
  ds_read_b128 v[44:47], v206 offset:43008
  v_mfma_f32_32x32x16_bf16 v[16:31], a[240:243], v[32:35], v[16:31]
  s_waitcnt lgkmcnt(2)
  v_mfma_f32_32x32x16_bf16 v[0:15], a[100:103], v[36:39], v[0:15]
  ds_read_b128 v[32:35], v203 offset:44032
  v_mfma_f32_32x32x16_bf16 v[16:31], a[244:247], v[36:39], v[16:31]
  s_waitcnt lgkmcnt(2)
  v_mfma_f32_32x32x16_bf16 v[0:15], a[104:107], v[40:43], v[0:15]
  ds_read_b128 v[36:39], v204 offset:44032
  v_mfma_f32_32x32x16_bf16 v[16:31], a[248:251], v[40:43], v[16:31]
  s_waitcnt lgkmcnt(2)
  v_mfma_f32_32x32x16_bf16 v[0:15], a[108:111], v[44:47], v[0:15]
  ds_read_b128 v[40:43], v205 offset:44032
  v_mfma_f32_32x32x16_bf16 v[16:31], a[252:255], v[44:47], v[16:31]
  s_waitcnt lgkmcnt(2)
  v_mfma_f32_32x32x16_bf16 v[0:15], a[112:115], v[32:35], v[0:15]
  ds_read_b128 v[44:47], v206 offset:44032
  v_mfma_f32_32x32x16_bf16 v[16:31], v[224:227], v[32:35], v[16:31]
  s_waitcnt lgkmcnt(2)
  v_mfma_f32_32x32x16_bf16 v[0:15], a[116:119], v[36:39], v[0:15]
  ds_read_b128 v[32:35], v203 offset:45056
  v_mfma_f32_32x32x16_bf16 v[16:31], v[228:231], v[36:39], v[16:31]
  s_waitcnt lgkmcnt(2)
  v_mfma_f32_32x32x16_bf16 v[0:15], a[120:123], v[40:43], v[0:15]
  ds_read_b128 v[36:39], v204 offset:45056
  v_mfma_f32_32x32x16_bf16 v[16:31], v[232:235], v[40:43], v[16:31]
  s_waitcnt lgkmcnt(2)
  v_mfma_f32_32x32x16_bf16 v[0:15], a[124:127], v[44:47], v[0:15]
  ds_read_b128 v[40:43], v205 offset:45056
  v_mfma_f32_32x32x16_bf16 v[16:31], v[236:239], v[44:47], v[16:31]
  s_waitcnt lgkmcnt(2)
  v_mfma_f32_32x32x16_bf16 v[0:15], a[128:131], v[32:35], v[0:15]
  ds_read_b128 v[44:47], v206 offset:45056
  v_mfma_f32_32x32x16_bf16 v[16:31], v[240:243], v[32:35], v[16:31]
  s_waitcnt lgkmcnt(2)
  v_mfma_f32_32x32x16_bf16 v[0:15], a[132:135], v[36:39], v[0:15]
  v_mfma_f32_32x32x16_bf16 v[16:31], v[244:247], v[36:39], v[16:31]
  s_waitcnt lgkmcnt(1)
  v_mfma_f32_32x32x16_bf16 v[0:15], a[136:139], v[40:43], v[0:15]
  v_mfma_f32_32x32x16_bf16 v[16:31], v[248:251], v[40:43], v[16:31]
  s_waitcnt lgkmcnt(0)
  v_mfma_f32_32x32x16_bf16 v[0:15], a[140:143], v[44:47], v[0:15]
  v_mfma_f32_32x32x16_bf16 v[16:31], v[252:255], v[44:47], v[16:31]
  s_nop 3
  v_cvt_pk_bf16_f32 v48, v0, v1
  v_cvt_pk_bf16_f32 v49, v2, v3
  ds_write2_b32 v218, v48, v49 offset0:0 offset1:1
  v_cvt_pk_bf16_f32 v48, v4, v5
  v_cvt_pk_bf16_f32 v49, v6, v7
  ds_write2_b32 v218, v48, v49 offset0:4 offset1:5
  v_cvt_pk_bf16_f32 v48, v8, v9
  v_cvt_pk_bf16_f32 v49, v10, v11
  ds_write2_b32 v218, v48, v49 offset0:8 offset1:9
  v_cvt_pk_bf16_f32 v48, v12, v13
  v_cvt_pk_bf16_f32 v49, v14, v15
  ds_write2_b32 v218, v48, v49 offset0:12 offset1:13
  v_cvt_pk_bf16_f32 v48, v16, v17
  v_cvt_pk_bf16_f32 v49, v18, v19
  ds_write2_b32 v218, v48, v49 offset0:64 offset1:65
  v_cvt_pk_bf16_f32 v48, v20, v21
  v_cvt_pk_bf16_f32 v49, v22, v23
  ds_write2_b32 v218, v48, v49 offset0:68 offset1:69
  v_cvt_pk_bf16_f32 v48, v24, v25
  v_cvt_pk_bf16_f32 v49, v26, v27
  ds_write2_b32 v218, v48, v49 offset0:72 offset1:73
  v_cvt_pk_bf16_f32 v48, v28, v29
  v_cvt_pk_bf16_f32 v49, v30, v31
  ds_write2_b32 v218, v48, v49 offset0:76 offset1:77
  v_add_u32 v218, 16512, v218
  s_waitcnt vmcnt(0) lgkmcnt(0)
  s_barrier
  ds_read_b128 v[32:35], v203 offset:0
  ds_read_b128 v[36:39], v204 offset:0
  ds_read_b128 v[40:43], v205 offset:0
  s_waitcnt lgkmcnt(2)
  v_mfma_f32_32x32x16_bf16 v[0:15], a[0:3], v[32:35], 0
  ds_read_b128 v[44:47], v206 offset:0
  v_mfma_f32_32x32x16_bf16 v[16:31], a[144:147], v[32:35], 0
  s_waitcnt lgkmcnt(2)
  v_mfma_f32_32x32x16_bf16 v[0:15], a[4:7], v[36:39], v[0:15]
  ds_read_b128 v[32:35], v203 offset:1024
  v_mfma_f32_32x32x16_bf16 v[16:31], a[148:151], v[36:39], v[16:31]
  s_waitcnt lgkmcnt(2)
  v_mfma_f32_32x32x16_bf16 v[0:15], a[8:11], v[40:43], v[0:15]
  ds_read_b128 v[36:39], v204 offset:1024
  v_mfma_f32_32x32x16_bf16 v[16:31], a[152:155], v[40:43], v[16:31]
  s_waitcnt lgkmcnt(2)
  v_mfma_f32_32x32x16_bf16 v[0:15], a[12:15], v[44:47], v[0:15]
  ds_read_b128 v[40:43], v205 offset:1024
  v_mfma_f32_32x32x16_bf16 v[16:31], a[156:159], v[44:47], v[16:31]
  s_waitcnt lgkmcnt(2)
  v_mfma_f32_32x32x16_bf16 v[0:15], a[16:19], v[32:35], v[0:15]
  ds_read_b128 v[44:47], v206 offset:1024
  v_mfma_f32_32x32x16_bf16 v[16:31], a[160:163], v[32:35], v[16:31]
  s_waitcnt lgkmcnt(2)
  v_mfma_f32_32x32x16_bf16 v[0:15], a[20:23], v[36:39], v[0:15]
  ds_read_b128 v[32:35], v203 offset:2048
  v_mfma_f32_32x32x16_bf16 v[16:31], a[164:167], v[36:39], v[16:31]
  s_waitcnt lgkmcnt(2)
  v_mfma_f32_32x32x16_bf16 v[0:15], a[24:27], v[40:43], v[0:15]
  ds_read_b128 v[36:39], v204 offset:2048
  v_mfma_f32_32x32x16_bf16 v[16:31], a[168:171], v[40:43], v[16:31]
  s_waitcnt lgkmcnt(2)
  v_mfma_f32_32x32x16_bf16 v[0:15], a[28:31], v[44:47], v[0:15]
  ds_read_b128 v[40:43], v205 offset:2048
  v_mfma_f32_32x32x16_bf16 v[16:31], a[172:175], v[44:47], v[16:31]
  s_waitcnt lgkmcnt(2)
  v_mfma_f32_32x32x16_bf16 v[0:15], a[32:35], v[32:35], v[0:15]
  ds_read_b128 v[44:47], v206 offset:2048
  v_mfma_f32_32x32x16_bf16 v[16:31], a[176:179], v[32:35], v[16:31]
  s_waitcnt lgkmcnt(2)
  v_mfma_f32_32x32x16_bf16 v[0:15], a[36:39], v[36:39], v[0:15]
  ds_read_b128 v[32:35], v203 offset:3072
  v_mfma_f32_32x32x16_bf16 v[16:31], a[180:183], v[36:39], v[16:31]
  s_waitcnt lgkmcnt(2)
  v_mfma_f32_32x32x16_bf16 v[0:15], a[40:43], v[40:43], v[0:15]
  ds_read_b128 v[36:39], v204 offset:3072
  v_mfma_f32_32x32x16_bf16 v[16:31], a[184:187], v[40:43], v[16:31]
  s_waitcnt lgkmcnt(2)
  v_mfma_f32_32x32x16_bf16 v[0:15], a[44:47], v[44:47], v[0:15]
  ds_read_b128 v[40:43], v205 offset:3072
  v_mfma_f32_32x32x16_bf16 v[16:31], a[188:191], v[44:47], v[16:31]
  s_waitcnt lgkmcnt(2)
  v_mfma_f32_32x32x16_bf16 v[0:15], a[48:51], v[32:35], v[0:15]
  ds_read_b128 v[44:47], v206 offset:3072
  v_mfma_f32_32x32x16_bf16 v[16:31], a[192:195], v[32:35], v[16:31]
  s_waitcnt lgkmcnt(2)
  v_mfma_f32_32x32x16_bf16 v[0:15], a[52:55], v[36:39], v[0:15]
  ds_read_b128 v[32:35], v203 offset:4096
  v_mfma_f32_32x32x16_bf16 v[16:31], a[196:199], v[36:39], v[16:31]
  s_waitcnt lgkmcnt(2)
  v_mfma_f32_32x32x16_bf16 v[0:15], a[56:59], v[40:43], v[0:15]
  ds_read_b128 v[36:39], v204 offset:4096
  v_mfma_f32_32x32x16_bf16 v[16:31], a[200:203], v[40:43], v[16:31]
  s_waitcnt lgkmcnt(2)
  v_mfma_f32_32x32x16_bf16 v[0:15], a[60:63], v[44:47], v[0:15]
  ds_read_b128 v[40:43], v205 offset:4096
  v_mfma_f32_32x32x16_bf16 v[16:31], a[204:207], v[44:47], v[16:31]
  s_waitcnt lgkmcnt(2)
  v_mfma_f32_32x32x16_bf16 v[0:15], a[64:67], v[32:35], v[0:15]
  ds_read_b128 v[44:47], v206 offset:4096
  v_mfma_f32_32x32x16_bf16 v[16:31], a[208:211], v[32:35], v[16:31]
  s_waitcnt lgkmcnt(2)
  v_mfma_f32_32x32x16_bf16 v[0:15], a[68:71], v[36:39], v[0:15]
  ds_read_b128 v[32:35], v203 offset:5120
  v_mfma_f32_32x32x16_bf16 v[16:31], a[212:215], v[36:39], v[16:31]
  s_waitcnt lgkmcnt(2)
  v_mfma_f32_32x32x16_bf16 v[0:15], a[72:75], v[40:43], v[0:15]
  ds_read_b128 v[36:39], v204 offset:5120
  v_mfma_f32_32x32x16_bf16 v[16:31], a[216:219], v[40:43], v[16:31]
  s_waitcnt lgkmcnt(2)
  v_mfma_f32_32x32x16_bf16 v[0:15], a[76:79], v[44:47], v[0:15]
  ds_read_b128 v[40:43], v205 offset:5120
  v_mfma_f32_32x32x16_bf16 v[16:31], a[220:223], v[44:47], v[16:31]
  s_waitcnt lgkmcnt(2)
  v_mfma_f32_32x32x16_bf16 v[0:15], a[80:83], v[32:35], v[0:15]
  ds_read_b128 v[44:47], v206 offset:5120
  v_mfma_f32_32x32x16_bf16 v[16:31], a[224:227], v[32:35], v[16:31]
  s_waitcnt lgkmcnt(2)
  v_mfma_f32_32x32x16_bf16 v[0:15], a[84:87], v[36:39], v[0:15]
  ds_read_b128 v[32:35], v203 offset:6144
  v_mfma_f32_32x32x16_bf16 v[16:31], a[228:231], v[36:39], v[16:31]
  s_waitcnt lgkmcnt(2)
  v_mfma_f32_32x32x16_bf16 v[0:15], a[88:91], v[40:43], v[0:15]
  ds_read_b128 v[36:39], v204 offset:6144
  v_mfma_f32_32x32x16_bf16 v[16:31], a[232:235], v[40:43], v[16:31]
  s_waitcnt lgkmcnt(2)
  v_mfma_f32_32x32x16_bf16 v[0:15], a[92:95], v[44:47], v[0:15]
  ds_read_b128 v[40:43], v205 offset:6144
  v_mfma_f32_32x32x16_bf16 v[16:31], a[236:239], v[44:47], v[16:31]
  s_waitcnt lgkmcnt(2)
  v_mfma_f32_32x32x16_bf16 v[0:15], a[96:99], v[32:35], v[0:15]
  ds_read_b128 v[44:47], v206 offset:6144
  v_mfma_f32_32x32x16_bf16 v[16:31], a[240:243], v[32:35], v[16:31]
  s_waitcnt lgkmcnt(2)
  v_mfma_f32_32x32x16_bf16 v[0:15], a[100:103], v[36:39], v[0:15]
  ds_read_b128 v[32:35], v203 offset:7168
  v_mfma_f32_32x32x16_bf16 v[16:31], a[244:247], v[36:39], v[16:31]
  s_waitcnt lgkmcnt(2)
  v_mfma_f32_32x32x16_bf16 v[0:15], a[104:107], v[40:43], v[0:15]
  ds_read_b128 v[36:39], v204 offset:7168
  v_mfma_f32_32x32x16_bf16 v[16:31], a[248:251], v[40:43], v[16:31]
  s_waitcnt lgkmcnt(2)
  v_mfma_f32_32x32x16_bf16 v[0:15], a[108:111], v[44:47], v[0:15]
  ds_read_b128 v[40:43], v205 offset:7168
  v_mfma_f32_32x32x16_bf16 v[16:31], a[252:255], v[44:47], v[16:31]
  s_waitcnt lgkmcnt(2)
  v_mfma_f32_32x32x16_bf16 v[0:15], a[112:115], v[32:35], v[0:15]
  ds_read_b128 v[44:47], v206 offset:7168
  v_mfma_f32_32x32x16_bf16 v[16:31], v[224:227], v[32:35], v[16:31]
  s_waitcnt lgkmcnt(2)
  v_mfma_f32_32x32x16_bf16 v[0:15], a[116:119], v[36:39], v[0:15]
  ds_read_b128 v[32:35], v203 offset:8192
  v_mfma_f32_32x32x16_bf16 v[16:31], v[228:231], v[36:39], v[16:31]
  s_waitcnt lgkmcnt(2)
  v_mfma_f32_32x32x16_bf16 v[0:15], a[120:123], v[40:43], v[0:15]
  ds_read_b128 v[36:39], v204 offset:8192
  v_mfma_f32_32x32x16_bf16 v[16:31], v[232:235], v[40:43], v[16:31]
  s_waitcnt lgkmcnt(2)
  v_mfma_f32_32x32x16_bf16 v[0:15], a[124:127], v[44:47], v[0:15]
  ds_read_b128 v[40:43], v205 offset:8192
  v_mfma_f32_32x32x16_bf16 v[16:31], v[236:239], v[44:47], v[16:31]
  s_waitcnt lgkmcnt(2)
  v_mfma_f32_32x32x16_bf16 v[0:15], a[128:131], v[32:35], v[0:15]
  ds_read_b128 v[44:47], v206 offset:8192
  v_mfma_f32_32x32x16_bf16 v[16:31], v[240:243], v[32:35], v[16:31]
  s_waitcnt lgkmcnt(2)
  v_mfma_f32_32x32x16_bf16 v[0:15], a[132:135], v[36:39], v[0:15]
  v_mfma_f32_32x32x16_bf16 v[16:31], v[244:247], v[36:39], v[16:31]
  s_waitcnt lgkmcnt(1)
  v_mfma_f32_32x32x16_bf16 v[0:15], a[136:139], v[40:43], v[0:15]
  v_mfma_f32_32x32x16_bf16 v[16:31], v[248:251], v[40:43], v[16:31]
  s_waitcnt lgkmcnt(0)
  v_mfma_f32_32x32x16_bf16 v[0:15], a[140:143], v[44:47], v[0:15]
  v_mfma_f32_32x32x16_bf16 v[16:31], v[252:255], v[44:47], v[16:31]
  s_nop 3
  v_cvt_pk_bf16_f32 v48, v0, v1
  v_cvt_pk_bf16_f32 v49, v2, v3
  ds_write2_b32 v218, v48, v49 offset0:0 offset1:1
  v_cvt_pk_bf16_f32 v48, v4, v5
  v_cvt_pk_bf16_f32 v49, v6, v7
  ds_write2_b32 v218, v48, v49 offset0:4 offset1:5
  v_cvt_pk_bf16_f32 v48, v8, v9
  v_cvt_pk_bf16_f32 v49, v10, v11
  ds_write2_b32 v218, v48, v49 offset0:8 offset1:9
  v_cvt_pk_bf16_f32 v48, v12, v13
  v_cvt_pk_bf16_f32 v49, v14, v15
  ds_write2_b32 v218, v48, v49 offset0:12 offset1:13
  v_cvt_pk_bf16_f32 v48, v16, v17
  v_cvt_pk_bf16_f32 v49, v18, v19
  ds_write2_b32 v218, v48, v49 offset0:64 offset1:65
  v_cvt_pk_bf16_f32 v48, v20, v21
  v_cvt_pk_bf16_f32 v49, v22, v23
  ds_write2_b32 v218, v48, v49 offset0:68 offset1:69
  v_cvt_pk_bf16_f32 v48, v24, v25
  v_cvt_pk_bf16_f32 v49, v26, v27
  ds_write2_b32 v218, v48, v49 offset0:72 offset1:73
  v_cvt_pk_bf16_f32 v48, v28, v29
  v_cvt_pk_bf16_f32 v49, v30, v31
  ds_write2_b32 v218, v48, v49 offset0:76 offset1:77
  v_add_u32 v218, 16512, v218
  s_waitcnt vmcnt(0) lgkmcnt(0)
  s_barrier
  v_mul_u32_u24 v219, 516, v200
  s_mul_i32 s54, s52, 36
  s_add_u32 s55, s54, 83016
  v_add_u32 v219, s55, v219
  v_mul_u32_u24 v220, 1152, v200
  s_mul_i32 s55, s68, 144
  s_add_u32 s54, s54, s55
  s_mul_i32 s55, s69, 147456
  s_add_u32 s64, s54, s55
  s_add_u32 s64, s64, 62914560
  s_lshl_b32 s66, s69, 7
  s_mov_b32 s57, 1051597459
  ds_read_b32 v0, v219 offset:7224
  ds_read_b32 v1, v219 offset:7228
  ds_read_b32 v2, v219 offset:7232
  ds_read_b32 v3, v219 offset:7236
  ds_read_b32 v4, v219 offset:7240
  ds_read_b32 v5, v219 offset:7244
  ds_read_b32 v6, v219 offset:7248
  ds_read_b32 v7, v219 offset:7252
  ds_read_b32 v8, v219 offset:7256
  ds_read_b32 v16, v219 offset:7368
  ds_read_b32 v17, v219 offset:7372
  ds_read_b32 v18, v219 offset:7376
  ds_read_b32 v19, v219 offset:7380
  ds_read_b32 v20, v219 offset:7384
  ds_read_b32 v21, v219 offset:7388
  ds_read_b32 v22, v219 offset:7392
  ds_read_b32 v23, v219 offset:7396
  ds_read_b32 v24, v219 offset:7400
  ds_read_b32 v25, v219 offset:6336
  ds_read_b32 v26, v219 offset:6340
  ds_read_b32 v27, v219 offset:6344
  ds_read_b32 v28, v219 offset:6348
  ds_read_b32 v29, v219 offset:6352
  ds_read_b32 v30, v219 offset:6356
  ds_read_b32 v31, v219 offset:6360
  ds_read_b32 v32, v219 offset:6364
  ds_read_b32 v33, v219 offset:6368
  ds_read_b32 v34, v219 offset:5304
  ds_read_b32 v35, v219 offset:5308
  ds_read_b32 v36, v219 offset:5312
  ds_read_b32 v37, v219 offset:5316
  ds_read_b32 v38, v219 offset:5320
  ds_read_b32 v39, v219 offset:5324
  ds_read_b32 v40, v219 offset:5328
  ds_read_b32 v41, v219 offset:5332
  ds_read_b32 v42, v219 offset:5336
  ds_read_b32 v43, v219 offset:4272
  ds_read_b32 v44, v219 offset:4276
  ds_read_b32 v45, v219 offset:4280
  ds_read_b32 v46, v219 offset:4284
  ds_read_b32 v47, v219 offset:4288
  ds_read_b32 v48, v219 offset:4292
  ds_read_b32 v49, v219 offset:4296
  ds_read_b32 v50, v219 offset:4300
  ds_read_b32 v51, v219 offset:4304
  ds_read_b32 v52, v219 offset:3240
  ds_read_b32 v53, v219 offset:3244
  ds_read_b32 v54, v219 offset:3248
  ds_read_b32 v55, v219 offset:3252
  ds_read_b32 v56, v219 offset:3256
  ds_read_b32 v57, v219 offset:3260
  ds_read_b32 v58, v219 offset:3264
  ds_read_b32 v59, v219 offset:3268
  ds_read_b32 v60, v219 offset:3272
  ds_read_b32 v61, v219 offset:2208
  ds_read_b32 v62, v219 offset:2212
  ds_read_b32 v63, v219 offset:2216
  ds_read_b32 v64, v219 offset:2220
  ds_read_b32 v65, v219 offset:2224
  ds_read_b32 v66, v219 offset:2228
  ds_read_b32 v67, v219 offset:2232
  ds_read_b32 v68, v219 offset:2236
  ds_read_b32 v69, v219 offset:2240
  ds_read_b32 v70, v219 offset:1176
  ds_read_b32 v71, v219 offset:1180
  ds_read_b32 v72, v219 offset:1184
  ds_read_b32 v73, v219 offset:1188
  ds_read_b32 v74, v219 offset:1192
  ds_read_b32 v75, v219 offset:1196
  ds_read_b32 v76, v219 offset:1200
  ds_read_b32 v77, v219 offset:1204
  ds_read_b32 v78, v219 offset:1208
  ds_read_b32 v79, v219 offset:144
  ds_read_b32 v80, v219 offset:148
  ds_read_b32 v81, v219 offset:152
  ds_read_b32 v82, v219 offset:156
  ds_read_b32 v83, v219 offset:160
  ds_read_b32 v84, v219 offset:164
  ds_read_b32 v85, v219 offset:168
  ds_read_b32 v86, v219 offset:172
  ds_read_b32 v87, v219 offset:176
  v_mov_b32 v100, 0
  v_mov_b32 v101, 0
  v_mov_b32 v102, 0
  v_mov_b32 v103, 0
  v_mov_b32 v104, 0
  v_mov_b32 v105, 0
  v_mov_b32 v106, 0
  v_mov_b32 v107, 0
  s_waitcnt lgkmcnt(15)
  v_dot2c_f32_bf16 v100, v0, v16
  v_dot2c_f32_bf16 v101, v0, v25
  v_dot2c_f32_bf16 v102, v0, v34
  v_dot2c_f32_bf16 v103, v0, v43
  v_dot2c_f32_bf16 v104, v0, v52
  v_dot2c_f32_bf16 v105, v0, v61
  v_dot2c_f32_bf16 v106, v0, v70
  s_waitcnt lgkmcnt(8)
  v_dot2c_f32_bf16 v107, v0, v79
  v_dot2c_f32_bf16 v100, v1, v17
  v_dot2c_f32_bf16 v101, v1, v26
  v_dot2c_f32_bf16 v102, v1, v35
  v_dot2c_f32_bf16 v103, v1, v44
  v_dot2c_f32_bf16 v104, v1, v53
  v_dot2c_f32_bf16 v105, v1, v62
  v_dot2c_f32_bf16 v106, v1, v71
  s_waitcnt lgkmcnt(7)
  v_dot2c_f32_bf16 v107, v1, v80
  v_dot2c_f32_bf16 v100, v2, v18
  v_dot2c_f32_bf16 v101, v2, v27
  v_dot2c_f32_bf16 v102, v2, v36
  v_dot2c_f32_bf16 v103, v2, v45
  v_dot2c_f32_bf16 v104, v2, v54
  v_dot2c_f32_bf16 v105, v2, v63
  v_dot2c_f32_bf16 v106, v2, v72
  s_waitcnt lgkmcnt(6)
  v_dot2c_f32_bf16 v107, v2, v81
  v_dot2c_f32_bf16 v100, v3, v19
  v_dot2c_f32_bf16 v101, v3, v28
  v_dot2c_f32_bf16 v102, v3, v37
  v_dot2c_f32_bf16 v103, v3, v46
  v_dot2c_f32_bf16 v104, v3, v55
  v_dot2c_f32_bf16 v105, v3, v64
  v_dot2c_f32_bf16 v106, v3, v73
  s_waitcnt lgkmcnt(5)
  v_dot2c_f32_bf16 v107, v3, v82
  v_dot2c_f32_bf16 v100, v4, v20
  v_dot2c_f32_bf16 v101, v4, v29
  v_dot2c_f32_bf16 v102, v4, v38
  v_dot2c_f32_bf16 v103, v4, v47
  v_dot2c_f32_bf16 v104, v4, v56
  v_dot2c_f32_bf16 v105, v4, v65
  v_dot2c_f32_bf16 v106, v4, v74
  s_waitcnt lgkmcnt(4)
  v_dot2c_f32_bf16 v107, v4, v83
  v_dot2c_f32_bf16 v100, v5, v21
  v_dot2c_f32_bf16 v101, v5, v30
  v_dot2c_f32_bf16 v102, v5, v39
  v_dot2c_f32_bf16 v103, v5, v48
  v_dot2c_f32_bf16 v104, v5, v57
  v_dot2c_f32_bf16 v105, v5, v66
  v_dot2c_f32_bf16 v106, v5, v75
  s_waitcnt lgkmcnt(3)
  v_dot2c_f32_bf16 v107, v5, v84
  v_dot2c_f32_bf16 v100, v6, v22
  v_dot2c_f32_bf16 v101, v6, v31
  v_dot2c_f32_bf16 v102, v6, v40
  v_dot2c_f32_bf16 v103, v6, v49
  v_dot2c_f32_bf16 v104, v6, v58
  v_dot2c_f32_bf16 v105, v6, v67
  v_dot2c_f32_bf16 v106, v6, v76
  s_waitcnt lgkmcnt(2)
  v_dot2c_f32_bf16 v107, v6, v85
  v_dot2c_f32_bf16 v100, v7, v23
  v_dot2c_f32_bf16 v101, v7, v32
  v_dot2c_f32_bf16 v102, v7, v41
  v_dot2c_f32_bf16 v103, v7, v50
  v_dot2c_f32_bf16 v104, v7, v59
  v_dot2c_f32_bf16 v105, v7, v68
  v_dot2c_f32_bf16 v106, v7, v77
  s_waitcnt lgkmcnt(1)
  v_dot2c_f32_bf16 v107, v7, v86
  v_dot2c_f32_bf16 v100, v8, v24
  v_dot2c_f32_bf16 v101, v8, v33
  v_dot2c_f32_bf16 v102, v8, v42
  v_dot2c_f32_bf16 v103, v8, v51
  v_dot2c_f32_bf16 v104, v8, v60
  v_dot2c_f32_bf16 v105, v8, v69
  v_dot2c_f32_bf16 v106, v8, v78
  s_waitcnt lgkmcnt(0)
  v_dot2c_f32_bf16 v107, v8, v87
  ds_read_b32 v16, v219 offset:7512
  ds_read_b32 v17, v219 offset:7516
  ds_read_b32 v18, v219 offset:7520
  ds_read_b32 v19, v219 offset:7524
  ds_read_b32 v20, v219 offset:7528
  ds_read_b32 v21, v219 offset:7532
  ds_read_b32 v22, v219 offset:7536
  ds_read_b32 v23, v219 offset:7540
  ds_read_b32 v24, v219 offset:7544
  ds_read_b32 v25, v219 offset:6480
  ds_read_b32 v26, v219 offset:6484
  ds_read_b32 v27, v219 offset:6488
  ds_read_b32 v28, v219 offset:6492
  ds_read_b32 v29, v219 offset:6496
  ds_read_b32 v30, v219 offset:6500
  ds_read_b32 v31, v219 offset:6504
  ds_read_b32 v32, v219 offset:6508
  ds_read_b32 v33, v219 offset:6512
  ds_read_b32 v34, v219 offset:5448
  ds_read_b32 v35, v219 offset:5452
  ds_read_b32 v36, v219 offset:5456
  ds_read_b32 v37, v219 offset:5460
  ds_read_b32 v38, v219 offset:5464
  ds_read_b32 v39, v219 offset:5468
  ds_read_b32 v40, v219 offset:5472
  ds_read_b32 v41, v219 offset:5476
  ds_read_b32 v42, v219 offset:5480
  ds_read_b32 v43, v219 offset:4416
  ds_read_b32 v44, v219 offset:4420
  ds_read_b32 v45, v219 offset:4424
  ds_read_b32 v46, v219 offset:4428
  ds_read_b32 v47, v219 offset:4432
  ds_read_b32 v48, v219 offset:4436
  ds_read_b32 v49, v219 offset:4440
  ds_read_b32 v50, v219 offset:4444
  ds_read_b32 v51, v219 offset:4448
  ds_read_b32 v52, v219 offset:3384
  ds_read_b32 v53, v219 offset:3388
  ds_read_b32 v54, v219 offset:3392
  ds_read_b32 v55, v219 offset:3396
  ds_read_b32 v56, v219 offset:3400
  ds_read_b32 v57, v219 offset:3404
  ds_read_b32 v58, v219 offset:3408
  ds_read_b32 v59, v219 offset:3412
  ds_read_b32 v60, v219 offset:3416
  ds_read_b32 v61, v219 offset:2352
  ds_read_b32 v62, v219 offset:2356
  ds_read_b32 v63, v219 offset:2360
  ds_read_b32 v64, v219 offset:2364
  ds_read_b32 v65, v219 offset:2368
  ds_read_b32 v66, v219 offset:2372
  ds_read_b32 v67, v219 offset:2376
  ds_read_b32 v68, v219 offset:2380
  ds_read_b32 v69, v219 offset:2384
  ds_read_b32 v70, v219 offset:1320
  ds_read_b32 v71, v219 offset:1324
  ds_read_b32 v72, v219 offset:1328
  ds_read_b32 v73, v219 offset:1332
  ds_read_b32 v74, v219 offset:1336
  ds_read_b32 v75, v219 offset:1340
  ds_read_b32 v76, v219 offset:1344
  ds_read_b32 v77, v219 offset:1348
  ds_read_b32 v78, v219 offset:1352
  ds_read_b32 v79, v219 offset:288
  ds_read_b32 v80, v219 offset:292
  ds_read_b32 v81, v219 offset:296
  ds_read_b32 v82, v219 offset:300
  ds_read_b32 v83, v219 offset:304
  ds_read_b32 v84, v219 offset:308
  ds_read_b32 v85, v219 offset:312
  ds_read_b32 v86, v219 offset:316
  ds_read_b32 v87, v219 offset:320
  v_add_u32 v211, s66, v200
  v_mov_b32 v212, 0xf149f2ca
  v_mul_f32 v100, s57, v100
  v_mul_f32 v101, s57, v101
  v_mul_f32 v102, s57, v102
  v_mul_f32 v103, s57, v103
  v_mul_f32 v104, s57, v104
  v_mul_f32 v105, s57, v105
  v_mul_f32 v106, s57, v106
  v_mul_f32 v107, s57, v107
  v_cmp_gt_u32 vcc, 2, v211
  s_nop 1
  v_cndmask_b32 v101, v101, v212, vcc
  v_cmp_gt_u32 vcc, 4, v211
  s_nop 1
  v_cndmask_b32 v102, v102, v212, vcc
  v_cmp_gt_u32 vcc, 6, v211
  s_nop 1
  v_cndmask_b32 v103, v103, v212, vcc
  v_cmp_gt_u32 vcc, 8, v211
  s_nop 1
  v_cndmask_b32 v104, v104, v212, vcc
  v_cmp_gt_u32 vcc, 10, v211
  s_nop 1
  v_cndmask_b32 v105, v105, v212, vcc
  v_cmp_gt_u32 vcc, 12, v211
  s_nop 1
  v_cndmask_b32 v106, v106, v212, vcc
  v_cmp_gt_u32 vcc, 14, v211
  s_nop 1
  v_cndmask_b32 v107, v107, v212, vcc
  v_max3_f32 v213, v100, v101, v102
  v_max3_f32 v213, v213, v103, v104
  v_max3_f32 v213, v213, v105, v106
  v_max_f32 v213, v213, v107
  v_sub_f32 v100, v100, v213
  v_sub_f32 v101, v101, v213
  v_sub_f32 v102, v102, v213
  v_sub_f32 v103, v103, v213
  v_sub_f32 v104, v104, v213
  v_sub_f32 v105, v105, v213
  v_sub_f32 v106, v106, v213
  v_sub_f32 v107, v107, v213
  v_exp_f32 v100, v100
  v_exp_f32 v101, v101
  v_exp_f32 v102, v102
  v_exp_f32 v103, v103
  v_exp_f32 v104, v104
  v_exp_f32 v105, v105
  v_exp_f32 v106, v106
  v_exp_f32 v107, v107
  v_add_f32 v213, v100, v101
  v_add_f32 v213, v213, v102
  v_add_f32 v213, v213, v103
  v_add_f32 v213, v213, v104
  v_add_f32 v213, v213, v105
  v_add_f32 v213, v213, v106
  v_add_f32 v213, v213, v107
  v_rcp_f32 v213, v213
  v_mov_b32 v214, 0
  v_mul_f32 v100, v213, v100
  v_mul_f32 v101, v213, v101
  v_mul_f32 v102, v213, v102
  v_mul_f32 v103, v213, v103
  v_mul_f32 v104, v213, v104
  v_mul_f32 v105, v213, v105
  v_mul_f32 v106, v213, v106
  v_mul_f32 v107, v213, v107
  v_mov_b32 v112, 0
  v_mov_b32 v113, 0
  v_mov_b32 v114, 0
  v_mov_b32 v115, 0
  v_mov_b32 v116, 0
  v_mov_b32 v117, 0
  v_mov_b32 v118, 0
  v_mov_b32 v119, 0
  v_mov_b32 v120, 0
  v_mov_b32 v121, 0
  v_mov_b32 v122, 0
  v_mov_b32 v123, 0
  v_mov_b32 v124, 0
  v_mov_b32 v125, 0
  v_mov_b32 v126, 0
  v_mov_b32 v127, 0
  v_mov_b32 v128, 0
  v_mov_b32 v129, 0
  v_cvt_pk_bf16_f32 v0, v100, v214
  v_cvt_pk_bf16_f32 v1, v214, v100
  s_waitcnt lgkmcnt(15)
  v_dot2c_f32_bf16 v112, v16, v0
  v_dot2c_f32_bf16 v113, v16, v1
  v_dot2c_f32_bf16 v114, v17, v0
  v_dot2c_f32_bf16 v115, v17, v1
  v_dot2c_f32_bf16 v116, v18, v0
  v_dot2c_f32_bf16 v117, v18, v1
  v_dot2c_f32_bf16 v118, v19, v0
  v_dot2c_f32_bf16 v119, v19, v1
  v_dot2c_f32_bf16 v120, v20, v0
  v_dot2c_f32_bf16 v121, v20, v1
  v_dot2c_f32_bf16 v122, v21, v0
  v_dot2c_f32_bf16 v123, v21, v1
  v_dot2c_f32_bf16 v124, v22, v0
  v_dot2c_f32_bf16 v125, v22, v1
  v_dot2c_f32_bf16 v126, v23, v0
  v_dot2c_f32_bf16 v127, v23, v1
  v_dot2c_f32_bf16 v128, v24, v0
  v_dot2c_f32_bf16 v129, v24, v1
  v_cvt_pk_bf16_f32 v2, v101, v214
  v_cvt_pk_bf16_f32 v3, v214, v101
  v_dot2c_f32_bf16 v112, v25, v2
  v_dot2c_f32_bf16 v113, v25, v3
  v_dot2c_f32_bf16 v114, v26, v2
  v_dot2c_f32_bf16 v115, v26, v3
  v_dot2c_f32_bf16 v116, v27, v2
  v_dot2c_f32_bf16 v117, v27, v3
  v_dot2c_f32_bf16 v118, v28, v2
  v_dot2c_f32_bf16 v119, v28, v3
  v_dot2c_f32_bf16 v120, v29, v2
  v_dot2c_f32_bf16 v121, v29, v3
  v_dot2c_f32_bf16 v122, v30, v2
  v_dot2c_f32_bf16 v123, v30, v3
  v_dot2c_f32_bf16 v124, v31, v2
  v_dot2c_f32_bf16 v125, v31, v3
  v_dot2c_f32_bf16 v126, v32, v2
  v_dot2c_f32_bf16 v127, v32, v3
  v_dot2c_f32_bf16 v128, v33, v2
  v_dot2c_f32_bf16 v129, v33, v3
  v_cvt_pk_bf16_f32 v0, v102, v214
  v_cvt_pk_bf16_f32 v1, v214, v102
  v_dot2c_f32_bf16 v112, v34, v0
  v_dot2c_f32_bf16 v113, v34, v1
  v_dot2c_f32_bf16 v114, v35, v0
  v_dot2c_f32_bf16 v115, v35, v1
  v_dot2c_f32_bf16 v116, v36, v0
  v_dot2c_f32_bf16 v117, v36, v1
  v_dot2c_f32_bf16 v118, v37, v0
  v_dot2c_f32_bf16 v119, v37, v1
  v_dot2c_f32_bf16 v120, v38, v0
  v_dot2c_f32_bf16 v121, v38, v1
  v_dot2c_f32_bf16 v122, v39, v0
  v_dot2c_f32_bf16 v123, v39, v1
  v_dot2c_f32_bf16 v124, v40, v0
  v_dot2c_f32_bf16 v125, v40, v1
  v_dot2c_f32_bf16 v126, v41, v0
  v_dot2c_f32_bf16 v127, v41, v1
  v_dot2c_f32_bf16 v128, v42, v0
  v_dot2c_f32_bf16 v129, v42, v1
  v_cvt_pk_bf16_f32 v2, v103, v214
  v_cvt_pk_bf16_f32 v3, v214, v103
  v_dot2c_f32_bf16 v112, v43, v2
  v_dot2c_f32_bf16 v113, v43, v3
  v_dot2c_f32_bf16 v114, v44, v2
  v_dot2c_f32_bf16 v115, v44, v3
  v_dot2c_f32_bf16 v116, v45, v2
  v_dot2c_f32_bf16 v117, v45, v3
  v_dot2c_f32_bf16 v118, v46, v2
  v_dot2c_f32_bf16 v119, v46, v3
  v_dot2c_f32_bf16 v120, v47, v2
  v_dot2c_f32_bf16 v121, v47, v3
  v_dot2c_f32_bf16 v122, v48, v2
  v_dot2c_f32_bf16 v123, v48, v3
  v_dot2c_f32_bf16 v124, v49, v2
  v_dot2c_f32_bf16 v125, v49, v3
  v_dot2c_f32_bf16 v126, v50, v2
  v_dot2c_f32_bf16 v127, v50, v3
  v_dot2c_f32_bf16 v128, v51, v2
  v_dot2c_f32_bf16 v129, v51, v3
  v_cvt_pk_bf16_f32 v0, v104, v214
  v_cvt_pk_bf16_f32 v1, v214, v104
  v_dot2c_f32_bf16 v112, v52, v0
  v_dot2c_f32_bf16 v113, v52, v1
  v_dot2c_f32_bf16 v114, v53, v0
  v_dot2c_f32_bf16 v115, v53, v1
  v_dot2c_f32_bf16 v116, v54, v0
  v_dot2c_f32_bf16 v117, v54, v1
  v_dot2c_f32_bf16 v118, v55, v0
  v_dot2c_f32_bf16 v119, v55, v1
  v_dot2c_f32_bf16 v120, v56, v0
  v_dot2c_f32_bf16 v121, v56, v1
  v_dot2c_f32_bf16 v122, v57, v0
  v_dot2c_f32_bf16 v123, v57, v1
  v_dot2c_f32_bf16 v124, v58, v0
  v_dot2c_f32_bf16 v125, v58, v1
  v_dot2c_f32_bf16 v126, v59, v0
  v_dot2c_f32_bf16 v127, v59, v1
  v_dot2c_f32_bf16 v128, v60, v0
  v_dot2c_f32_bf16 v129, v60, v1
  v_cvt_pk_bf16_f32 v2, v105, v214
  v_cvt_pk_bf16_f32 v3, v214, v105
  v_dot2c_f32_bf16 v112, v61, v2
  v_dot2c_f32_bf16 v113, v61, v3
  v_dot2c_f32_bf16 v114, v62, v2
  v_dot2c_f32_bf16 v115, v62, v3
  v_dot2c_f32_bf16 v116, v63, v2
  v_dot2c_f32_bf16 v117, v63, v3
  v_dot2c_f32_bf16 v118, v64, v2
  v_dot2c_f32_bf16 v119, v64, v3
  v_dot2c_f32_bf16 v120, v65, v2
  v_dot2c_f32_bf16 v121, v65, v3
  v_dot2c_f32_bf16 v122, v66, v2
  v_dot2c_f32_bf16 v123, v66, v3
  v_dot2c_f32_bf16 v124, v67, v2
  v_dot2c_f32_bf16 v125, v67, v3
  v_dot2c_f32_bf16 v126, v68, v2
  v_dot2c_f32_bf16 v127, v68, v3
  v_dot2c_f32_bf16 v128, v69, v2
  v_dot2c_f32_bf16 v129, v69, v3
  v_cvt_pk_bf16_f32 v0, v106, v214
  v_cvt_pk_bf16_f32 v1, v214, v106
  v_dot2c_f32_bf16 v112, v70, v0
  v_dot2c_f32_bf16 v113, v70, v1
  v_dot2c_f32_bf16 v114, v71, v0
  v_dot2c_f32_bf16 v115, v71, v1
  v_dot2c_f32_bf16 v116, v72, v0
  v_dot2c_f32_bf16 v117, v72, v1
  s_waitcnt lgkmcnt(14)
  v_dot2c_f32_bf16 v118, v73, v0
  v_dot2c_f32_bf16 v119, v73, v1
  s_waitcnt lgkmcnt(13)
  v_dot2c_f32_bf16 v120, v74, v0
  v_dot2c_f32_bf16 v121, v74, v1
  s_waitcnt lgkmcnt(12)
  v_dot2c_f32_bf16 v122, v75, v0
  v_dot2c_f32_bf16 v123, v75, v1
  s_waitcnt lgkmcnt(11)
  v_dot2c_f32_bf16 v124, v76, v0
  v_dot2c_f32_bf16 v125, v76, v1
  s_waitcnt lgkmcnt(10)
  v_dot2c_f32_bf16 v126, v77, v0
  v_dot2c_f32_bf16 v127, v77, v1
  s_waitcnt lgkmcnt(9)
  v_dot2c_f32_bf16 v128, v78, v0
  v_dot2c_f32_bf16 v129, v78, v1
  v_cvt_pk_bf16_f32 v2, v107, v214
  v_cvt_pk_bf16_f32 v3, v214, v107
  s_waitcnt lgkmcnt(8)
  v_dot2c_f32_bf16 v112, v79, v2
  v_dot2c_f32_bf16 v113, v79, v3
  s_waitcnt lgkmcnt(7)
  v_dot2c_f32_bf16 v114, v80, v2
  v_dot2c_f32_bf16 v115, v80, v3
  s_waitcnt lgkmcnt(6)
  v_dot2c_f32_bf16 v116, v81, v2
  v_dot2c_f32_bf16 v117, v81, v3
  s_waitcnt lgkmcnt(5)
  v_dot2c_f32_bf16 v118, v82, v2
  v_dot2c_f32_bf16 v119, v82, v3
  s_waitcnt lgkmcnt(4)
  v_dot2c_f32_bf16 v120, v83, v2
  v_dot2c_f32_bf16 v121, v83, v3
  s_waitcnt lgkmcnt(3)
  v_dot2c_f32_bf16 v122, v84, v2
  v_dot2c_f32_bf16 v123, v84, v3
  s_waitcnt lgkmcnt(2)
  v_dot2c_f32_bf16 v124, v85, v2
  v_dot2c_f32_bf16 v125, v85, v3
  s_waitcnt lgkmcnt(1)
  v_dot2c_f32_bf16 v126, v86, v2
  v_dot2c_f32_bf16 v127, v86, v3
  s_waitcnt lgkmcnt(0)
  v_dot2c_f32_bf16 v128, v87, v2
  v_dot2c_f32_bf16 v129, v87, v3
  v_cvt_pk_bf16_f32 v132, v112, v113
  v_cvt_pk_bf16_f32 v133, v114, v115
  v_cvt_pk_bf16_f32 v134, v116, v117
  v_cvt_pk_bf16_f32 v135, v118, v119
  v_cvt_pk_bf16_f32 v136, v120, v121
  v_cvt_pk_bf16_f32 v137, v122, v123
  v_cvt_pk_bf16_f32 v138, v124, v125
  v_cvt_pk_bf16_f32 v139, v126, v127
  v_cvt_pk_bf16_f32 v140, v128, v129
  buffer_store_dwordx4 v[132:135], v220, s[8:11], s64 offen sc1
  buffer_store_dwordx4 v[136:139], v220, s[8:11], s64 offen offset:16 sc1
  buffer_store_dword v140, v220, s[8:11], s64 offen offset:32 sc1
  v_add_u32 v219, 33024, v219
  s_add_u32 s66, s66, 64
  s_add_u32 s64, s64, 73728
  ds_read_b32 v0, v219 offset:7224
  ds_read_b32 v1, v219 offset:7228
  ds_read_b32 v2, v219 offset:7232
  ds_read_b32 v3, v219 offset:7236
  ds_read_b32 v4, v219 offset:7240
  ds_read_b32 v5, v219 offset:7244
  ds_read_b32 v6, v219 offset:7248
  ds_read_b32 v7, v219 offset:7252
  ds_read_b32 v8, v219 offset:7256
  ds_read_b32 v16, v219 offset:7368
  ds_read_b32 v17, v219 offset:7372
  ds_read_b32 v18, v219 offset:7376
  ds_read_b32 v19, v219 offset:7380
  ds_read_b32 v20, v219 offset:7384
  ds_read_b32 v21, v219 offset:7388
  ds_read_b32 v22, v219 offset:7392
  ds_read_b32 v23, v219 offset:7396
  ds_read_b32 v24, v219 offset:7400
  ds_read_b32 v25, v219 offset:6336
  ds_read_b32 v26, v219 offset:6340
  ds_read_b32 v27, v219 offset:6344
  ds_read_b32 v28, v219 offset:6348
  ds_read_b32 v29, v219 offset:6352
  ds_read_b32 v30, v219 offset:6356
  ds_read_b32 v31, v219 offset:6360
  ds_read_b32 v32, v219 offset:6364
  ds_read_b32 v33, v219 offset:6368
  ds_read_b32 v34, v219 offset:5304
  ds_read_b32 v35, v219 offset:5308
  ds_read_b32 v36, v219 offset:5312
  ds_read_b32 v37, v219 offset:5316
  ds_read_b32 v38, v219 offset:5320
  ds_read_b32 v39, v219 offset:5324
  ds_read_b32 v40, v219 offset:5328
  ds_read_b32 v41, v219 offset:5332
  ds_read_b32 v42, v219 offset:5336
  ds_read_b32 v43, v219 offset:4272
  ds_read_b32 v44, v219 offset:4276
  ds_read_b32 v45, v219 offset:4280
  ds_read_b32 v46, v219 offset:4284
  ds_read_b32 v47, v219 offset:4288
  ds_read_b32 v48, v219 offset:4292
  ds_read_b32 v49, v219 offset:4296
  ds_read_b32 v50, v219 offset:4300
  ds_read_b32 v51, v219 offset:4304
  ds_read_b32 v52, v219 offset:3240
  ds_read_b32 v53, v219 offset:3244
  ds_read_b32 v54, v219 offset:3248
  ds_read_b32 v55, v219 offset:3252
  ds_read_b32 v56, v219 offset:3256
  ds_read_b32 v57, v219 offset:3260
  ds_read_b32 v58, v219 offset:3264
  ds_read_b32 v59, v219 offset:3268
  ds_read_b32 v60, v219 offset:3272
  ds_read_b32 v61, v219 offset:2208
  ds_read_b32 v62, v219 offset:2212
  ds_read_b32 v63, v219 offset:2216
  ds_read_b32 v64, v219 offset:2220
  ds_read_b32 v65, v219 offset:2224
  ds_read_b32 v66, v219 offset:2228
  ds_read_b32 v67, v219 offset:2232
  ds_read_b32 v68, v219 offset:2236
  ds_read_b32 v69, v219 offset:2240
  ds_read_b32 v70, v219 offset:1176
  ds_read_b32 v71, v219 offset:1180
  ds_read_b32 v72, v219 offset:1184
  ds_read_b32 v73, v219 offset:1188
  ds_read_b32 v74, v219 offset:1192
  ds_read_b32 v75, v219 offset:1196
  ds_read_b32 v76, v219 offset:1200
  ds_read_b32 v77, v219 offset:1204
  ds_read_b32 v78, v219 offset:1208
  ds_read_b32 v79, v219 offset:144
  ds_read_b32 v80, v219 offset:148
  ds_read_b32 v81, v219 offset:152
  ds_read_b32 v82, v219 offset:156
  ds_read_b32 v83, v219 offset:160
  ds_read_b32 v84, v219 offset:164
  ds_read_b32 v85, v219 offset:168
  ds_read_b32 v86, v219 offset:172
  ds_read_b32 v87, v219 offset:176
  v_mov_b32 v100, 0
  v_mov_b32 v101, 0
  v_mov_b32 v102, 0
  v_mov_b32 v103, 0
  v_mov_b32 v104, 0
  v_mov_b32 v105, 0
  v_mov_b32 v106, 0
  v_mov_b32 v107, 0
  s_waitcnt lgkmcnt(15)
  v_dot2c_f32_bf16 v100, v0, v16
  v_dot2c_f32_bf16 v101, v0, v25
  v_dot2c_f32_bf16 v102, v0, v34
  v_dot2c_f32_bf16 v103, v0, v43
  v_dot2c_f32_bf16 v104, v0, v52
  v_dot2c_f32_bf16 v105, v0, v61
  v_dot2c_f32_bf16 v106, v0, v70
  s_waitcnt lgkmcnt(8)
  v_dot2c_f32_bf16 v107, v0, v79
  v_dot2c_f32_bf16 v100, v1, v17
  v_dot2c_f32_bf16 v101, v1, v26
  v_dot2c_f32_bf16 v102, v1, v35
  v_dot2c_f32_bf16 v103, v1, v44
  v_dot2c_f32_bf16 v104, v1, v53
  v_dot2c_f32_bf16 v105, v1, v62
  v_dot2c_f32_bf16 v106, v1, v71
  s_waitcnt lgkmcnt(7)
  v_dot2c_f32_bf16 v107, v1, v80
  v_dot2c_f32_bf16 v100, v2, v18
  v_dot2c_f32_bf16 v101, v2, v27
  v_dot2c_f32_bf16 v102, v2, v36
  v_dot2c_f32_bf16 v103, v2, v45
  v_dot2c_f32_bf16 v104, v2, v54
  v_dot2c_f32_bf16 v105, v2, v63
  v_dot2c_f32_bf16 v106, v2, v72
  s_waitcnt lgkmcnt(6)
  v_dot2c_f32_bf16 v107, v2, v81
  v_dot2c_f32_bf16 v100, v3, v19
  v_dot2c_f32_bf16 v101, v3, v28
  v_dot2c_f32_bf16 v102, v3, v37
  v_dot2c_f32_bf16 v103, v3, v46
  v_dot2c_f32_bf16 v104, v3, v55
  v_dot2c_f32_bf16 v105, v3, v64
  v_dot2c_f32_bf16 v106, v3, v73
  s_waitcnt lgkmcnt(5)
  v_dot2c_f32_bf16 v107, v3, v82
  v_dot2c_f32_bf16 v100, v4, v20
  v_dot2c_f32_bf16 v101, v4, v29
  v_dot2c_f32_bf16 v102, v4, v38
  v_dot2c_f32_bf16 v103, v4, v47
  v_dot2c_f32_bf16 v104, v4, v56
  v_dot2c_f32_bf16 v105, v4, v65
  v_dot2c_f32_bf16 v106, v4, v74
  s_waitcnt lgkmcnt(4)
  v_dot2c_f32_bf16 v107, v4, v83
  v_dot2c_f32_bf16 v100, v5, v21
  v_dot2c_f32_bf16 v101, v5, v30
  v_dot2c_f32_bf16 v102, v5, v39
  v_dot2c_f32_bf16 v103, v5, v48
  v_dot2c_f32_bf16 v104, v5, v57
  v_dot2c_f32_bf16 v105, v5, v66
  v_dot2c_f32_bf16 v106, v5, v75
  s_waitcnt lgkmcnt(3)
  v_dot2c_f32_bf16 v107, v5, v84
  v_dot2c_f32_bf16 v100, v6, v22
  v_dot2c_f32_bf16 v101, v6, v31
  v_dot2c_f32_bf16 v102, v6, v40
  v_dot2c_f32_bf16 v103, v6, v49
  v_dot2c_f32_bf16 v104, v6, v58
  v_dot2c_f32_bf16 v105, v6, v67
  v_dot2c_f32_bf16 v106, v6, v76
  s_waitcnt lgkmcnt(2)
  v_dot2c_f32_bf16 v107, v6, v85
  v_dot2c_f32_bf16 v100, v7, v23
  v_dot2c_f32_bf16 v101, v7, v32
  v_dot2c_f32_bf16 v102, v7, v41
  v_dot2c_f32_bf16 v103, v7, v50
  v_dot2c_f32_bf16 v104, v7, v59
  v_dot2c_f32_bf16 v105, v7, v68
  v_dot2c_f32_bf16 v106, v7, v77
  s_waitcnt lgkmcnt(1)
  v_dot2c_f32_bf16 v107, v7, v86
  v_dot2c_f32_bf16 v100, v8, v24
  v_dot2c_f32_bf16 v101, v8, v33
  v_dot2c_f32_bf16 v102, v8, v42
  v_dot2c_f32_bf16 v103, v8, v51
  v_dot2c_f32_bf16 v104, v8, v60
  v_dot2c_f32_bf16 v105, v8, v69
  v_dot2c_f32_bf16 v106, v8, v78
  s_waitcnt lgkmcnt(0)
  v_dot2c_f32_bf16 v107, v8, v87
  ds_read_b32 v16, v219 offset:7512
  ds_read_b32 v17, v219 offset:7516
  ds_read_b32 v18, v219 offset:7520
  ds_read_b32 v19, v219 offset:7524
  ds_read_b32 v20, v219 offset:7528
  ds_read_b32 v21, v219 offset:7532
  ds_read_b32 v22, v219 offset:7536
  ds_read_b32 v23, v219 offset:7540
  ds_read_b32 v24, v219 offset:7544
  ds_read_b32 v25, v219 offset:6480
  ds_read_b32 v26, v219 offset:6484
  ds_read_b32 v27, v219 offset:6488
  ds_read_b32 v28, v219 offset:6492
  ds_read_b32 v29, v219 offset:6496
  ds_read_b32 v30, v219 offset:6500
  ds_read_b32 v31, v219 offset:6504
  ds_read_b32 v32, v219 offset:6508
  ds_read_b32 v33, v219 offset:6512
  ds_read_b32 v34, v219 offset:5448
  ds_read_b32 v35, v219 offset:5452
  ds_read_b32 v36, v219 offset:5456
  ds_read_b32 v37, v219 offset:5460
  ds_read_b32 v38, v219 offset:5464
  ds_read_b32 v39, v219 offset:5468
  ds_read_b32 v40, v219 offset:5472
  ds_read_b32 v41, v219 offset:5476
  ds_read_b32 v42, v219 offset:5480
  ds_read_b32 v43, v219 offset:4416
  ds_read_b32 v44, v219 offset:4420
  ds_read_b32 v45, v219 offset:4424
  ds_read_b32 v46, v219 offset:4428
  ds_read_b32 v47, v219 offset:4432
  ds_read_b32 v48, v219 offset:4436
  ds_read_b32 v49, v219 offset:4440
  ds_read_b32 v50, v219 offset:4444
  ds_read_b32 v51, v219 offset:4448
  ds_read_b32 v52, v219 offset:3384
  ds_read_b32 v53, v219 offset:3388
  ds_read_b32 v54, v219 offset:3392
  ds_read_b32 v55, v219 offset:3396
  ds_read_b32 v56, v219 offset:3400
  ds_read_b32 v57, v219 offset:3404
  ds_read_b32 v58, v219 offset:3408
  ds_read_b32 v59, v219 offset:3412
  ds_read_b32 v60, v219 offset:3416
  ds_read_b32 v61, v219 offset:2352
  ds_read_b32 v62, v219 offset:2356
  ds_read_b32 v63, v219 offset:2360
  ds_read_b32 v64, v219 offset:2364
  ds_read_b32 v65, v219 offset:2368
  ds_read_b32 v66, v219 offset:2372
  ds_read_b32 v67, v219 offset:2376
  ds_read_b32 v68, v219 offset:2380
  ds_read_b32 v69, v219 offset:2384
  ds_read_b32 v70, v219 offset:1320
  ds_read_b32 v71, v219 offset:1324
  ds_read_b32 v72, v219 offset:1328
  ds_read_b32 v73, v219 offset:1332
  ds_read_b32 v74, v219 offset:1336
  ds_read_b32 v75, v219 offset:1340
  ds_read_b32 v76, v219 offset:1344
  ds_read_b32 v77, v219 offset:1348
  ds_read_b32 v78, v219 offset:1352
  ds_read_b32 v79, v219 offset:288
  ds_read_b32 v80, v219 offset:292
  ds_read_b32 v81, v219 offset:296
  ds_read_b32 v82, v219 offset:300
  ds_read_b32 v83, v219 offset:304
  ds_read_b32 v84, v219 offset:308
  ds_read_b32 v85, v219 offset:312
  ds_read_b32 v86, v219 offset:316
  ds_read_b32 v87, v219 offset:320
  v_add_u32 v211, s66, v200
  v_mov_b32 v212, 0xf149f2ca
  v_mul_f32 v100, s57, v100
  v_mul_f32 v101, s57, v101
  v_mul_f32 v102, s57, v102
  v_mul_f32 v103, s57, v103
  v_mul_f32 v104, s57, v104
  v_mul_f32 v105, s57, v105
  v_mul_f32 v106, s57, v106
  v_mul_f32 v107, s57, v107
  v_cmp_gt_u32 vcc, 2, v211
  s_nop 1
  v_cndmask_b32 v101, v101, v212, vcc
  v_cmp_gt_u32 vcc, 4, v211
  s_nop 1
  v_cndmask_b32 v102, v102, v212, vcc
  v_cmp_gt_u32 vcc, 6, v211
  s_nop 1
  v_cndmask_b32 v103, v103, v212, vcc
  v_cmp_gt_u32 vcc, 8, v211
  s_nop 1
  v_cndmask_b32 v104, v104, v212, vcc
  v_cmp_gt_u32 vcc, 10, v211
  s_nop 1
  v_cndmask_b32 v105, v105, v212, vcc
  v_cmp_gt_u32 vcc, 12, v211
  s_nop 1
  v_cndmask_b32 v106, v106, v212, vcc
  v_cmp_gt_u32 vcc, 14, v211
  s_nop 1
  v_cndmask_b32 v107, v107, v212, vcc
  v_max3_f32 v213, v100, v101, v102
  v_max3_f32 v213, v213, v103, v104
  v_max3_f32 v213, v213, v105, v106
  v_max_f32 v213, v213, v107
  v_sub_f32 v100, v100, v213
  v_sub_f32 v101, v101, v213
  v_sub_f32 v102, v102, v213
  v_sub_f32 v103, v103, v213
  v_sub_f32 v104, v104, v213
  v_sub_f32 v105, v105, v213
  v_sub_f32 v106, v106, v213
  v_sub_f32 v107, v107, v213
  v_exp_f32 v100, v100
  v_exp_f32 v101, v101
  v_exp_f32 v102, v102
  v_exp_f32 v103, v103
  v_exp_f32 v104, v104
  v_exp_f32 v105, v105
  v_exp_f32 v106, v106
  v_exp_f32 v107, v107
  v_add_f32 v213, v100, v101
  v_add_f32 v213, v213, v102
  v_add_f32 v213, v213, v103
  v_add_f32 v213, v213, v104
  v_add_f32 v213, v213, v105
  v_add_f32 v213, v213, v106
  v_add_f32 v213, v213, v107
  v_rcp_f32 v213, v213
  v_mov_b32 v214, 0
  v_mul_f32 v100, v213, v100
  v_mul_f32 v101, v213, v101
  v_mul_f32 v102, v213, v102
  v_mul_f32 v103, v213, v103
  v_mul_f32 v104, v213, v104
  v_mul_f32 v105, v213, v105
  v_mul_f32 v106, v213, v106
  v_mul_f32 v107, v213, v107
  v_mov_b32 v112, 0
  v_mov_b32 v113, 0
  v_mov_b32 v114, 0
  v_mov_b32 v115, 0
  v_mov_b32 v116, 0
  v_mov_b32 v117, 0
  v_mov_b32 v118, 0
  v_mov_b32 v119, 0
  v_mov_b32 v120, 0
  v_mov_b32 v121, 0
  v_mov_b32 v122, 0
  v_mov_b32 v123, 0
  v_mov_b32 v124, 0
  v_mov_b32 v125, 0
  v_mov_b32 v126, 0
  v_mov_b32 v127, 0
  v_mov_b32 v128, 0
  v_mov_b32 v129, 0
  v_cvt_pk_bf16_f32 v0, v100, v214
  v_cvt_pk_bf16_f32 v1, v214, v100
  s_waitcnt lgkmcnt(15)
  v_dot2c_f32_bf16 v112, v16, v0
  v_dot2c_f32_bf16 v113, v16, v1
  v_dot2c_f32_bf16 v114, v17, v0
  v_dot2c_f32_bf16 v115, v17, v1
  v_dot2c_f32_bf16 v116, v18, v0
  v_dot2c_f32_bf16 v117, v18, v1
  v_dot2c_f32_bf16 v118, v19, v0
  v_dot2c_f32_bf16 v119, v19, v1
  v_dot2c_f32_bf16 v120, v20, v0
  v_dot2c_f32_bf16 v121, v20, v1
  v_dot2c_f32_bf16 v122, v21, v0
  v_dot2c_f32_bf16 v123, v21, v1
  v_dot2c_f32_bf16 v124, v22, v0
  v_dot2c_f32_bf16 v125, v22, v1
  v_dot2c_f32_bf16 v126, v23, v0
  v_dot2c_f32_bf16 v127, v23, v1
  v_dot2c_f32_bf16 v128, v24, v0
  v_dot2c_f32_bf16 v129, v24, v1
  v_cvt_pk_bf16_f32 v2, v101, v214
  v_cvt_pk_bf16_f32 v3, v214, v101
  v_dot2c_f32_bf16 v112, v25, v2
  v_dot2c_f32_bf16 v113, v25, v3
  v_dot2c_f32_bf16 v114, v26, v2
  v_dot2c_f32_bf16 v115, v26, v3
  v_dot2c_f32_bf16 v116, v27, v2
  v_dot2c_f32_bf16 v117, v27, v3
  v_dot2c_f32_bf16 v118, v28, v2
  v_dot2c_f32_bf16 v119, v28, v3
  v_dot2c_f32_bf16 v120, v29, v2
  v_dot2c_f32_bf16 v121, v29, v3
  v_dot2c_f32_bf16 v122, v30, v2
  v_dot2c_f32_bf16 v123, v30, v3
  v_dot2c_f32_bf16 v124, v31, v2
  v_dot2c_f32_bf16 v125, v31, v3
  v_dot2c_f32_bf16 v126, v32, v2
  v_dot2c_f32_bf16 v127, v32, v3
  v_dot2c_f32_bf16 v128, v33, v2
  v_dot2c_f32_bf16 v129, v33, v3
  v_cvt_pk_bf16_f32 v0, v102, v214
  v_cvt_pk_bf16_f32 v1, v214, v102
  v_dot2c_f32_bf16 v112, v34, v0
  v_dot2c_f32_bf16 v113, v34, v1
  v_dot2c_f32_bf16 v114, v35, v0
  v_dot2c_f32_bf16 v115, v35, v1
  v_dot2c_f32_bf16 v116, v36, v0
  v_dot2c_f32_bf16 v117, v36, v1
  v_dot2c_f32_bf16 v118, v37, v0
  v_dot2c_f32_bf16 v119, v37, v1
  v_dot2c_f32_bf16 v120, v38, v0
  v_dot2c_f32_bf16 v121, v38, v1
  v_dot2c_f32_bf16 v122, v39, v0
  v_dot2c_f32_bf16 v123, v39, v1
  v_dot2c_f32_bf16 v124, v40, v0
  v_dot2c_f32_bf16 v125, v40, v1
  v_dot2c_f32_bf16 v126, v41, v0
  v_dot2c_f32_bf16 v127, v41, v1
  v_dot2c_f32_bf16 v128, v42, v0
  v_dot2c_f32_bf16 v129, v42, v1
  v_cvt_pk_bf16_f32 v2, v103, v214
  v_cvt_pk_bf16_f32 v3, v214, v103
  v_dot2c_f32_bf16 v112, v43, v2
  v_dot2c_f32_bf16 v113, v43, v3
  v_dot2c_f32_bf16 v114, v44, v2
  v_dot2c_f32_bf16 v115, v44, v3
  v_dot2c_f32_bf16 v116, v45, v2
  v_dot2c_f32_bf16 v117, v45, v3
  v_dot2c_f32_bf16 v118, v46, v2
  v_dot2c_f32_bf16 v119, v46, v3
  v_dot2c_f32_bf16 v120, v47, v2
  v_dot2c_f32_bf16 v121, v47, v3
  v_dot2c_f32_bf16 v122, v48, v2
  v_dot2c_f32_bf16 v123, v48, v3
  v_dot2c_f32_bf16 v124, v49, v2
  v_dot2c_f32_bf16 v125, v49, v3
  v_dot2c_f32_bf16 v126, v50, v2
  v_dot2c_f32_bf16 v127, v50, v3
  v_dot2c_f32_bf16 v128, v51, v2
  v_dot2c_f32_bf16 v129, v51, v3
  v_cvt_pk_bf16_f32 v0, v104, v214
  v_cvt_pk_bf16_f32 v1, v214, v104
  v_dot2c_f32_bf16 v112, v52, v0
  v_dot2c_f32_bf16 v113, v52, v1
  v_dot2c_f32_bf16 v114, v53, v0
  v_dot2c_f32_bf16 v115, v53, v1
  v_dot2c_f32_bf16 v116, v54, v0
  v_dot2c_f32_bf16 v117, v54, v1
  v_dot2c_f32_bf16 v118, v55, v0
  v_dot2c_f32_bf16 v119, v55, v1
  v_dot2c_f32_bf16 v120, v56, v0
  v_dot2c_f32_bf16 v121, v56, v1
  v_dot2c_f32_bf16 v122, v57, v0
  v_dot2c_f32_bf16 v123, v57, v1
  v_dot2c_f32_bf16 v124, v58, v0
  v_dot2c_f32_bf16 v125, v58, v1
  v_dot2c_f32_bf16 v126, v59, v0
  v_dot2c_f32_bf16 v127, v59, v1
  v_dot2c_f32_bf16 v128, v60, v0
  v_dot2c_f32_bf16 v129, v60, v1
  v_cvt_pk_bf16_f32 v2, v105, v214
  v_cvt_pk_bf16_f32 v3, v214, v105
  v_dot2c_f32_bf16 v112, v61, v2
  v_dot2c_f32_bf16 v113, v61, v3
  v_dot2c_f32_bf16 v114, v62, v2
  v_dot2c_f32_bf16 v115, v62, v3
  v_dot2c_f32_bf16 v116, v63, v2
  v_dot2c_f32_bf16 v117, v63, v3
  v_dot2c_f32_bf16 v118, v64, v2
  v_dot2c_f32_bf16 v119, v64, v3
  v_dot2c_f32_bf16 v120, v65, v2
  v_dot2c_f32_bf16 v121, v65, v3
  v_dot2c_f32_bf16 v122, v66, v2
  v_dot2c_f32_bf16 v123, v66, v3
  v_dot2c_f32_bf16 v124, v67, v2
  v_dot2c_f32_bf16 v125, v67, v3
  v_dot2c_f32_bf16 v126, v68, v2
  v_dot2c_f32_bf16 v127, v68, v3
  v_dot2c_f32_bf16 v128, v69, v2
  v_dot2c_f32_bf16 v129, v69, v3
  v_cvt_pk_bf16_f32 v0, v106, v214
  v_cvt_pk_bf16_f32 v1, v214, v106
  v_dot2c_f32_bf16 v112, v70, v0
  v_dot2c_f32_bf16 v113, v70, v1
  v_dot2c_f32_bf16 v114, v71, v0
  v_dot2c_f32_bf16 v115, v71, v1
  v_dot2c_f32_bf16 v116, v72, v0
  v_dot2c_f32_bf16 v117, v72, v1
  s_waitcnt lgkmcnt(14)
  v_dot2c_f32_bf16 v118, v73, v0
  v_dot2c_f32_bf16 v119, v73, v1
  s_waitcnt lgkmcnt(13)
  v_dot2c_f32_bf16 v120, v74, v0
  v_dot2c_f32_bf16 v121, v74, v1
  s_waitcnt lgkmcnt(12)
  v_dot2c_f32_bf16 v122, v75, v0
  v_dot2c_f32_bf16 v123, v75, v1
  s_waitcnt lgkmcnt(11)
  v_dot2c_f32_bf16 v124, v76, v0
  v_dot2c_f32_bf16 v125, v76, v1
  s_waitcnt lgkmcnt(10)
  v_dot2c_f32_bf16 v126, v77, v0
  v_dot2c_f32_bf16 v127, v77, v1
  s_waitcnt lgkmcnt(9)
  v_dot2c_f32_bf16 v128, v78, v0
  v_dot2c_f32_bf16 v129, v78, v1
  v_cvt_pk_bf16_f32 v2, v107, v214
  v_cvt_pk_bf16_f32 v3, v214, v107
  s_waitcnt lgkmcnt(8)
  v_dot2c_f32_bf16 v112, v79, v2
  v_dot2c_f32_bf16 v113, v79, v3
  s_waitcnt lgkmcnt(7)
  v_dot2c_f32_bf16 v114, v80, v2
  v_dot2c_f32_bf16 v115, v80, v3
  s_waitcnt lgkmcnt(6)
  v_dot2c_f32_bf16 v116, v81, v2
  v_dot2c_f32_bf16 v117, v81, v3
  s_waitcnt lgkmcnt(5)
  v_dot2c_f32_bf16 v118, v82, v2
  v_dot2c_f32_bf16 v119, v82, v3
  s_waitcnt lgkmcnt(4)
  v_dot2c_f32_bf16 v120, v83, v2
  v_dot2c_f32_bf16 v121, v83, v3
  s_waitcnt lgkmcnt(3)
  v_dot2c_f32_bf16 v122, v84, v2
  v_dot2c_f32_bf16 v123, v84, v3
  s_waitcnt lgkmcnt(2)
  v_dot2c_f32_bf16 v124, v85, v2
  v_dot2c_f32_bf16 v125, v85, v3
  s_waitcnt lgkmcnt(1)
  v_dot2c_f32_bf16 v126, v86, v2
  v_dot2c_f32_bf16 v127, v86, v3
  s_waitcnt lgkmcnt(0)
  v_dot2c_f32_bf16 v128, v87, v2
  v_dot2c_f32_bf16 v129, v87, v3
  v_cvt_pk_bf16_f32 v132, v112, v113
  v_cvt_pk_bf16_f32 v133, v114, v115
  v_cvt_pk_bf16_f32 v134, v116, v117
  v_cvt_pk_bf16_f32 v135, v118, v119
  v_cvt_pk_bf16_f32 v136, v120, v121
  v_cvt_pk_bf16_f32 v137, v122, v123
  v_cvt_pk_bf16_f32 v138, v124, v125
  v_cvt_pk_bf16_f32 v139, v126, v127
  v_cvt_pk_bf16_f32 v140, v128, v129
  buffer_store_dwordx4 v[132:135], v220, s[8:11], s64 offen sc1
  buffer_store_dwordx4 v[136:139], v220, s[8:11], s64 offen offset:16 sc1
  buffer_store_dword v140, v220, s[8:11], s64 offen offset:32 sc1
  s_mov_b32 s56, 36
  s_waitcnt vmcnt(0)
  s_barrier
  s_cmp_eq_u32 s52, 0
  s_cbranch_scc0 A_sig
  v_mov_b32 v211, 1
  v_mov_b32 v212, 0
  s_mov_b64 exec, 1
  buffer_atomic_add v211, v212, s[12:15], s56 offen
  s_mov_b64 exec, -1
A_sig:
  s_and_b32 s54, s53, 31
  s_cmp_lt_u32 s54, 27
  s_cbranch_scc0 L_exit
  s_and_b32 s54, s53, 31
  s_mul_i32 s68, s54, 57
  s_lshr_b32 s68, s68, 9
  s_mul_i32 s56, s68, 9
  s_sub_u32 s70, s54, s56
  s_bfe_u32 s55, s53, 0x10005
  s_mul_i32 s55, s55, 9
  s_add_u32 s70, s70, s55
  s_bfe_u32 s69, s53, 0x10006
  v_lshrrev_b32 v211, 2, v200
  v_mul_u32_u24 v211, 1152, v211
  v_and_b32 v212, 3, v200
  v_lshl_add_u32 v207, v212, 4, v211
  s_lshl_b32 s54, s70, 6
  s_mul_i32 s55, s52, 1179648
  s_add_u32 s62, s54, s55
  s_mul_i32 s55, s52, 184320
  s_add_u32 s63, s54, s55
  s_mul_i32 s61, s52, 40960
  v_bfe_u32 v211, v200, 2, 2
  v_lshlrev_b32 v212, 4, v212
  v_add_u32 v212, s61, v212
  v_lshl_add_u32 v212, v211, 6, v212
  v_lshrrev_b32 v213, 4, v200
  v_lshl_add_u32 v210, v213, 9, v212
  v_lshrrev_b32 v214, 5, v200
  v_lshl_add_u32 v209, v214, 10, v212
  v_and_b32 v214, 1, v213
  v_lshl_add_u32 v209, v214, 8, v209
  s_add_u32 m0, s61, 0
  s_add_u32 s54, s62, 0
  buffer_load_dwordx4 v207, s[28:31], s54 offen lds
  s_add_u32 m0, s61, 1024
  s_add_u32 s54, s62, 18432
  buffer_load_dwordx4 v207, s[28:31], s54 offen lds
  s_add_u32 m0, s61, 2048
  s_add_u32 s54, s62, 36864
  buffer_load_dwordx4 v207, s[28:31], s54 offen lds
  s_add_u32 m0, s61, 3072
  s_add_u32 s54, s62, 55296
  buffer_load_dwordx4 v207, s[28:31], s54 offen lds
  s_add_u32 m0, s61, 4096
  s_add_u32 s54, s62, 73728
  buffer_load_dwordx4 v207, s[28:31], s54 offen lds
  s_add_u32 m0, s61, 5120
  s_add_u32 s54, s62, 92160
  buffer_load_dwordx4 v207, s[28:31], s54 offen lds
  s_add_u32 m0, s61, 6144
  s_add_u32 s54, s62, 110592
  buffer_load_dwordx4 v207, s[28:31], s54 offen lds
  s_add_u32 m0, s61, 7168
  s_add_u32 s54, s62, 129024
  buffer_load_dwordx4 v207, s[28:31], s54 offen lds
  s_add_u32 m0, s61, 8192
  s_add_u32 s54, s62, 147456
  buffer_load_dwordx4 v207, s[28:31], s54 offen lds
  s_add_u32 m0, s61, 9216
  s_add_u32 s54, s62, 165888
  buffer_load_dwordx4 v207, s[28:31], s54 offen lds
  s_add_u32 m0, s61, 10240
  s_add_u32 s54, s62, 184320
  buffer_load_dwordx4 v207, s[28:31], s54 offen lds
  s_add_u32 m0, s61, 11264
  s_add_u32 s54, s62, 202752
  buffer_load_dwordx4 v207, s[28:31], s54 offen lds
  s_add_u32 m0, s61, 12288
  s_add_u32 s54, s62, 221184
  buffer_load_dwordx4 v207, s[28:31], s54 offen lds
  s_add_u32 m0, s61, 13312
  s_add_u32 s54, s62, 239616
  buffer_load_dwordx4 v207, s[28:31], s54 offen lds
  s_add_u32 m0, s61, 14336
  s_add_u32 s54, s62, 258048
  buffer_load_dwordx4 v207, s[28:31], s54 offen lds
  s_add_u32 m0, s61, 15360
  s_add_u32 s54, s62, 276480
  buffer_load_dwordx4 v207, s[28:31], s54 offen lds
  s_add_u32 m0, s61, 16384
  s_add_u32 s54, s62, 294912
  buffer_load_dwordx4 v207, s[28:31], s54 offen lds
  s_add_u32 m0, s61, 17408
  s_add_u32 s54, s62, 313344
  buffer_load_dwordx4 v207, s[28:31], s54 offen lds
  s_add_u32 m0, s61, 18432
  s_add_u32 s54, s62, 331776
  buffer_load_dwordx4 v207, s[28:31], s54 offen lds
  s_add_u32 m0, s61, 19456
  s_add_u32 s54, s62, 350208
  buffer_load_dwordx4 v207, s[28:31], s54 offen lds
  s_add_u32 m0, s61, 20480
  s_add_u32 s54, s62, 368640
  buffer_load_dwordx4 v207, s[28:31], s54 offen lds
  s_add_u32 m0, s61, 21504
  s_add_u32 s54, s62, 387072
  buffer_load_dwordx4 v207, s[28:31], s54 offen lds
  s_add_u32 m0, s61, 22528
  s_add_u32 s54, s62, 405504
  buffer_load_dwordx4 v207, s[28:31], s54 offen lds
  s_add_u32 m0, s61, 23552
  s_add_u32 s54, s62, 423936
  buffer_load_dwordx4 v207, s[28:31], s54 offen lds
  s_add_u32 m0, s61, 24576
  s_add_u32 s54, s62, 442368
  buffer_load_dwordx4 v207, s[28:31], s54 offen lds
  s_add_u32 m0, s61, 25600
  s_add_u32 s54, s62, 460800
  buffer_load_dwordx4 v207, s[28:31], s54 offen lds
  s_add_u32 m0, s61, 26624
  s_add_u32 s54, s62, 479232
  buffer_load_dwordx4 v207, s[28:31], s54 offen lds
  s_add_u32 m0, s61, 27648
  s_add_u32 s54, s62, 497664
  buffer_load_dwordx4 v207, s[28:31], s54 offen lds
  s_add_u32 m0, s61, 28672
  s_add_u32 s54, s62, 516096
  buffer_load_dwordx4 v207, s[28:31], s54 offen lds
  s_add_u32 m0, s61, 29696
  s_add_u32 s54, s62, 534528
  buffer_load_dwordx4 v207, s[28:31], s54 offen lds
  s_add_u32 m0, s61, 30720
  s_add_u32 s54, s62, 552960
  buffer_load_dwordx4 v207, s[28:31], s54 offen lds
  s_add_u32 m0, s61, 31744
  s_add_u32 s54, s62, 571392
  buffer_load_dwordx4 v207, s[28:31], s54 offen lds
  s_add_u32 m0, s61, 32768
  s_add_u32 s54, s62, 589824
  buffer_load_dwordx4 v207, s[28:31], s54 offen lds
  s_add_u32 m0, s61, 33792
  s_add_u32 s54, s62, 608256
  buffer_load_dwordx4 v207, s[28:31], s54 offen lds
  s_add_u32 m0, s61, 34816
  s_add_u32 s54, s62, 626688
  buffer_load_dwordx4 v207, s[28:31], s54 offen lds
  s_add_u32 m0, s61, 35840
  s_add_u32 s54, s62, 645120
  buffer_load_dwordx4 v207, s[28:31], s54 offen lds
  s_add_u32 m0, s61, 36864
  s_add_u32 s54, s62, 663552
  buffer_load_dwordx4 v207, s[28:31], s54 offen lds
  s_add_u32 m0, s61, 37888
  s_add_u32 s54, s62, 681984
  buffer_load_dwordx4 v207, s[28:31], s54 offen lds
  s_waitcnt vmcnt(36) lgkmcnt(0)
  s_add_u32 m0, s61, 38912
  s_add_u32 s54, s62, 700416
  buffer_load_dwordx4 v207, s[28:31], s54 offen lds
  s_add_u32 m0, s61, 39936
  s_add_u32 s54, s62, 718848
  buffer_load_dwordx4 v207, s[28:31], s54 offen lds
  ds_read_b64_tr_b16 a[0:1], v209 offset:0
  ds_read_b64_tr_b16 a[2:3], v209 offset:512
  ds_read_b64_tr_b16 a[4:5], v209 offset:8
  ds_read_b64_tr_b16 a[6:7], v209 offset:520
  s_waitcnt vmcnt(36) lgkmcnt(0)
  s_add_u32 m0, s61, 0
  s_add_u32 s54, s62, 737280
  buffer_load_dwordx4 v207, s[28:31], s54 offen lds
  s_add_u32 m0, s61, 1024
  s_add_u32 s54, s62, 755712
  buffer_load_dwordx4 v207, s[28:31], s54 offen lds
  ds_read_b64_tr_b16 a[8:9], v209 offset:2048
  ds_read_b64_tr_b16 a[10:11], v209 offset:2560
  ds_read_b64_tr_b16 a[12:13], v209 offset:2056
  ds_read_b64_tr_b16 a[14:15], v209 offset:2568
  s_waitcnt vmcnt(36) lgkmcnt(0)
  s_add_u32 m0, s61, 2048
  s_add_u32 s54, s62, 774144
  buffer_load_dwordx4 v207, s[28:31], s54 offen lds
  s_add_u32 m0, s61, 3072
  s_add_u32 s54, s62, 792576
  buffer_load_dwordx4 v207, s[28:31], s54 offen lds
  ds_read_b64_tr_b16 a[16:17], v209 offset:4096
  ds_read_b64_tr_b16 a[18:19], v209 offset:4608
  ds_read_b64_tr_b16 a[20:21], v209 offset:4104
  ds_read_b64_tr_b16 a[22:23], v209 offset:4616
  s_waitcnt vmcnt(36) lgkmcnt(0)
  s_add_u32 m0, s61, 4096
  s_add_u32 s54, s62, 811008
  buffer_load_dwordx4 v207, s[28:31], s54 offen lds
  s_add_u32 m0, s61, 5120
  s_add_u32 s54, s62, 829440
  buffer_load_dwordx4 v207, s[28:31], s54 offen lds
  ds_read_b64_tr_b16 a[24:25], v209 offset:6144
  ds_read_b64_tr_b16 a[26:27], v209 offset:6656
  ds_read_b64_tr_b16 a[28:29], v209 offset:6152
  ds_read_b64_tr_b16 a[30:31], v209 offset:6664
  s_waitcnt vmcnt(36) lgkmcnt(0)
  s_add_u32 m0, s61, 6144
  s_add_u32 s54, s62, 847872
  buffer_load_dwordx4 v207, s[28:31], s54 offen lds
  s_add_u32 m0, s61, 7168
  s_add_u32 s54, s62, 866304
  buffer_load_dwordx4 v207, s[28:31], s54 offen lds
  ds_read_b64_tr_b16 a[32:33], v209 offset:8192
  ds_read_b64_tr_b16 a[34:35], v209 offset:8704
  ds_read_b64_tr_b16 a[36:37], v209 offset:8200
  ds_read_b64_tr_b16 a[38:39], v209 offset:8712
  s_waitcnt vmcnt(36) lgkmcnt(0)
  s_add_u32 m0, s61, 8192
  s_add_u32 s54, s62, 884736
  buffer_load_dwordx4 v207, s[28:31], s54 offen lds
  s_add_u32 m0, s61, 9216
  s_add_u32 s54, s62, 903168
  buffer_load_dwordx4 v207, s[28:31], s54 offen lds
  ds_read_b64_tr_b16 a[40:41], v209 offset:10240
  ds_read_b64_tr_b16 a[42:43], v209 offset:10752
  ds_read_b64_tr_b16 a[44:45], v209 offset:10248
  ds_read_b64_tr_b16 a[46:47], v209 offset:10760
  s_waitcnt vmcnt(36) lgkmcnt(0)
  s_add_u32 m0, s61, 10240
  s_add_u32 s54, s62, 921600
  buffer_load_dwordx4 v207, s[28:31], s54 offen lds
  s_add_u32 m0, s61, 11264
  s_add_u32 s54, s62, 940032
  buffer_load_dwordx4 v207, s[28:31], s54 offen lds
  ds_read_b64_tr_b16 a[48:49], v209 offset:12288
  ds_read_b64_tr_b16 a[50:51], v209 offset:12800
  ds_read_b64_tr_b16 a[52:53], v209 offset:12296
  ds_read_b64_tr_b16 a[54:55], v209 offset:12808
  s_waitcnt vmcnt(36) lgkmcnt(0)
  s_add_u32 m0, s61, 12288
  s_add_u32 s54, s62, 958464
  buffer_load_dwordx4 v207, s[28:31], s54 offen lds
  s_add_u32 m0, s61, 13312
  s_add_u32 s54, s62, 976896
  buffer_load_dwordx4 v207, s[28:31], s54 offen lds
  ds_read_b64_tr_b16 a[56:57], v209 offset:14336
  ds_read_b64_tr_b16 a[58:59], v209 offset:14848
  ds_read_b64_tr_b16 a[60:61], v209 offset:14344
  ds_read_b64_tr_b16 a[62:63], v209 offset:14856
  s_waitcnt vmcnt(36) lgkmcnt(0)
  s_add_u32 m0, s61, 14336
  s_add_u32 s54, s62, 995328
  buffer_load_dwordx4 v207, s[28:31], s54 offen lds
  s_add_u32 m0, s61, 15360
  s_add_u32 s54, s62, 1013760
  buffer_load_dwordx4 v207, s[28:31], s54 offen lds
  ds_read_b64_tr_b16 a[64:65], v209 offset:16384
  ds_read_b64_tr_b16 a[66:67], v209 offset:16896
  ds_read_b64_tr_b16 a[68:69], v209 offset:16392
  ds_read_b64_tr_b16 a[70:71], v209 offset:16904
  s_waitcnt vmcnt(36) lgkmcnt(0)
  s_add_u32 m0, s61, 16384
  s_add_u32 s54, s62, 1032192
  buffer_load_dwordx4 v207, s[28:31], s54 offen lds
  s_add_u32 m0, s61, 17408
  s_add_u32 s54, s62, 1050624
  buffer_load_dwordx4 v207, s[28:31], s54 offen lds
  ds_read_b64_tr_b16 a[72:73], v209 offset:18432
  ds_read_b64_tr_b16 a[74:75], v209 offset:18944
  ds_read_b64_tr_b16 a[76:77], v209 offset:18440
  ds_read_b64_tr_b16 a[78:79], v209 offset:18952
  s_waitcnt vmcnt(36) lgkmcnt(0)
  s_add_u32 m0, s61, 18432
  s_add_u32 s54, s62, 1069056
  buffer_load_dwordx4 v207, s[28:31], s54 offen lds
  s_add_u32 m0, s61, 19456
  s_add_u32 s54, s62, 1087488
  buffer_load_dwordx4 v207, s[28:31], s54 offen lds
  ds_read_b64_tr_b16 a[80:81], v209 offset:20480
  ds_read_b64_tr_b16 a[82:83], v209 offset:20992
  ds_read_b64_tr_b16 a[84:85], v209 offset:20488
  ds_read_b64_tr_b16 a[86:87], v209 offset:21000
  s_waitcnt vmcnt(36) lgkmcnt(0)
  s_add_u32 m0, s61, 20480
  s_add_u32 s54, s62, 1105920
  buffer_load_dwordx4 v207, s[28:31], s54 offen lds
  s_add_u32 m0, s61, 21504
  s_add_u32 s54, s62, 1124352
  buffer_load_dwordx4 v207, s[28:31], s54 offen lds
  ds_read_b64_tr_b16 a[88:89], v209 offset:22528
  ds_read_b64_tr_b16 a[90:91], v209 offset:23040
  ds_read_b64_tr_b16 a[92:93], v209 offset:22536
  ds_read_b64_tr_b16 a[94:95], v209 offset:23048
  s_waitcnt vmcnt(36) lgkmcnt(0)
  s_add_u32 m0, s61, 22528
  s_add_u32 s54, s62, 1142784
  buffer_load_dwordx4 v207, s[28:31], s54 offen lds
  s_add_u32 m0, s61, 23552
  s_add_u32 s54, s62, 1161216
  buffer_load_dwordx4 v207, s[28:31], s54 offen lds
  ds_read_b64_tr_b16 a[96:97], v209 offset:24576
  ds_read_b64_tr_b16 a[98:99], v209 offset:25088
  ds_read_b64_tr_b16 a[100:101], v209 offset:24584
  ds_read_b64_tr_b16 a[102:103], v209 offset:25096
  s_waitcnt vmcnt(36) lgkmcnt(0)
  s_add_u32 m0, s61, 24576
  s_add_u32 s54, s63, 0
  buffer_load_dwordx4 v207, s[40:43], s54 offen lds
  s_add_u32 m0, s61, 25600
  s_add_u32 s54, s63, 18432
  buffer_load_dwordx4 v207, s[40:43], s54 offen lds
  ds_read_b64_tr_b16 a[104:105], v209 offset:26624
  ds_read_b64_tr_b16 a[106:107], v209 offset:27136
  ds_read_b64_tr_b16 a[108:109], v209 offset:26632
  ds_read_b64_tr_b16 a[110:111], v209 offset:27144
  s_waitcnt vmcnt(36) lgkmcnt(0)
  s_add_u32 m0, s61, 26624
  s_add_u32 s54, s63, 36864
  buffer_load_dwordx4 v207, s[40:43], s54 offen lds
  s_add_u32 m0, s61, 27648
  s_add_u32 s54, s63, 55296
  buffer_load_dwordx4 v207, s[40:43], s54 offen lds
  ds_read_b64_tr_b16 a[112:113], v209 offset:28672
  ds_read_b64_tr_b16 a[114:115], v209 offset:29184
  ds_read_b64_tr_b16 a[116:117], v209 offset:28680
  ds_read_b64_tr_b16 a[118:119], v209 offset:29192
  s_waitcnt vmcnt(36) lgkmcnt(0)
  s_add_u32 m0, s61, 28672
  s_add_u32 s54, s63, 73728
  buffer_load_dwordx4 v207, s[40:43], s54 offen lds
  s_add_u32 m0, s61, 29696
  s_add_u32 s54, s63, 92160
  buffer_load_dwordx4 v207, s[40:43], s54 offen lds
  ds_read_b64_tr_b16 a[120:121], v209 offset:30720
  ds_read_b64_tr_b16 a[122:123], v209 offset:31232
  ds_read_b64_tr_b16 a[124:125], v209 offset:30728
  ds_read_b64_tr_b16 a[126:127], v209 offset:31240
  s_waitcnt vmcnt(36) lgkmcnt(0)
  s_add_u32 m0, s61, 30720
  s_add_u32 s54, s63, 110592
  buffer_load_dwordx4 v207, s[40:43], s54 offen lds
  s_add_u32 m0, s61, 31744
  s_add_u32 s54, s63, 129024
  buffer_load_dwordx4 v207, s[40:43], s54 offen lds
  ds_read_b64_tr_b16 a[128:129], v209 offset:32768
  ds_read_b64_tr_b16 a[130:131], v209 offset:33280
  ds_read_b64_tr_b16 a[132:133], v209 offset:32776
  ds_read_b64_tr_b16 a[134:135], v209 offset:33288
  s_waitcnt vmcnt(36) lgkmcnt(0)
  s_add_u32 m0, s61, 32768
  s_add_u32 s54, s63, 147456
  buffer_load_dwordx4 v207, s[40:43], s54 offen lds
  s_add_u32 m0, s61, 33792
  s_add_u32 s54, s63, 165888
  buffer_load_dwordx4 v207, s[40:43], s54 offen lds
  ds_read_b64_tr_b16 a[136:137], v209 offset:34816
  ds_read_b64_tr_b16 a[138:139], v209 offset:35328
  ds_read_b64_tr_b16 a[140:141], v209 offset:34824
  ds_read_b64_tr_b16 a[142:143], v209 offset:35336
  s_waitcnt vmcnt(36) lgkmcnt(0)
  ds_read_b64_tr_b16 a[144:145], v209 offset:36864
  ds_read_b64_tr_b16 a[146:147], v209 offset:37376
  ds_read_b64_tr_b16 a[148:149], v209 offset:36872
  ds_read_b64_tr_b16 a[150:151], v209 offset:37384
  s_waitcnt vmcnt(34) lgkmcnt(0)
  ds_read_b64_tr_b16 a[152:153], v209 offset:38912
  ds_read_b64_tr_b16 a[154:155], v209 offset:39424
  ds_read_b64_tr_b16 a[156:157], v209 offset:38920
  ds_read_b64_tr_b16 a[158:159], v209 offset:39432
  s_waitcnt vmcnt(32) lgkmcnt(0)
  ds_read_b64_tr_b16 a[160:161], v209 offset:0
  ds_read_b64_tr_b16 a[162:163], v209 offset:512
  ds_read_b64_tr_b16 a[164:165], v209 offset:8
  ds_read_b64_tr_b16 a[166:167], v209 offset:520
  s_waitcnt vmcnt(30) lgkmcnt(0)
  ds_read_b64_tr_b16 a[168:169], v209 offset:2048
  ds_read_b64_tr_b16 a[170:171], v209 offset:2560
  ds_read_b64_tr_b16 a[172:173], v209 offset:2056
  ds_read_b64_tr_b16 a[174:175], v209 offset:2568
  s_waitcnt vmcnt(28) lgkmcnt(0)
  ds_read_b64_tr_b16 a[176:177], v209 offset:4096
  ds_read_b64_tr_b16 a[178:179], v209 offset:4608
  ds_read_b64_tr_b16 a[180:181], v209 offset:4104
  ds_read_b64_tr_b16 a[182:183], v209 offset:4616
  s_waitcnt vmcnt(26) lgkmcnt(0)
  ds_read_b64_tr_b16 a[184:185], v209 offset:6144
  ds_read_b64_tr_b16 a[186:187], v209 offset:6656
  ds_read_b64_tr_b16 a[188:189], v209 offset:6152
  ds_read_b64_tr_b16 a[190:191], v209 offset:6664
  s_waitcnt vmcnt(24) lgkmcnt(0)
  ds_read_b64_tr_b16 a[192:193], v209 offset:8192
  ds_read_b64_tr_b16 a[194:195], v209 offset:8704
  ds_read_b64_tr_b16 a[196:197], v209 offset:8200
  ds_read_b64_tr_b16 a[198:199], v209 offset:8712
  s_waitcnt vmcnt(22) lgkmcnt(0)
  ds_read_b64_tr_b16 a[200:201], v209 offset:10240
  ds_read_b64_tr_b16 a[202:203], v209 offset:10752
  ds_read_b64_tr_b16 a[204:205], v209 offset:10248
  ds_read_b64_tr_b16 a[206:207], v209 offset:10760
  s_waitcnt vmcnt(20) lgkmcnt(0)
  ds_read_b64_tr_b16 a[208:209], v209 offset:12288
  ds_read_b64_tr_b16 a[210:211], v209 offset:12800
  ds_read_b64_tr_b16 a[212:213], v209 offset:12296
  ds_read_b64_tr_b16 a[214:215], v209 offset:12808
  s_waitcnt vmcnt(18) lgkmcnt(0)
  ds_read_b64_tr_b16 a[216:217], v209 offset:14336
  ds_read_b64_tr_b16 a[218:219], v209 offset:14848
  ds_read_b64_tr_b16 a[220:221], v209 offset:14344
  ds_read_b64_tr_b16 a[222:223], v209 offset:14856
  s_waitcnt vmcnt(16) lgkmcnt(0)
  ds_read_b64_tr_b16 a[224:225], v209 offset:16384
  ds_read_b64_tr_b16 a[226:227], v209 offset:16896
  ds_read_b64_tr_b16 a[228:229], v209 offset:16392
  ds_read_b64_tr_b16 a[230:231], v209 offset:16904
  s_waitcnt vmcnt(14) lgkmcnt(0)
  ds_read_b64_tr_b16 a[232:233], v209 offset:18432
  ds_read_b64_tr_b16 a[234:235], v209 offset:18944
  ds_read_b64_tr_b16 a[236:237], v209 offset:18440
  ds_read_b64_tr_b16 a[238:239], v209 offset:18952
  s_waitcnt vmcnt(12) lgkmcnt(0)
  ds_read_b64_tr_b16 a[240:241], v209 offset:20480
  ds_read_b64_tr_b16 a[242:243], v209 offset:20992
  ds_read_b64_tr_b16 a[244:245], v209 offset:20488
  ds_read_b64_tr_b16 a[246:247], v209 offset:21000
  s_waitcnt vmcnt(10) lgkmcnt(0)
  ds_read_b64_tr_b16 a[248:249], v209 offset:22528
  ds_read_b64_tr_b16 a[250:251], v209 offset:23040
  ds_read_b64_tr_b16 a[252:253], v209 offset:22536
  ds_read_b64_tr_b16 a[254:255], v209 offset:23048
  s_waitcnt vmcnt(8) lgkmcnt(0)
  ds_read_b64_tr_b16 v[216:217], v210 offset:24576
  ds_read_b64_tr_b16 v[218:219], v210 offset:24832
  ds_read_b64_tr_b16 v[220:221], v210 offset:24584
  ds_read_b64_tr_b16 v[222:223], v210 offset:24840
  s_waitcnt vmcnt(6) lgkmcnt(0)
  ds_read_b64_tr_b16 v[224:225], v210 offset:26624
  ds_read_b64_tr_b16 v[226:227], v210 offset:26880
  ds_read_b64_tr_b16 v[228:229], v210 offset:26632
  ds_read_b64_tr_b16 v[230:231], v210 offset:26888
  s_waitcnt vmcnt(4) lgkmcnt(0)
  ds_read_b64_tr_b16 v[232:233], v210 offset:28672
  ds_read_b64_tr_b16 v[234:235], v210 offset:28928
  ds_read_b64_tr_b16 v[236:237], v210 offset:28680
  ds_read_b64_tr_b16 v[238:239], v210 offset:28936
  s_waitcnt vmcnt(2) lgkmcnt(0)
  ds_read_b64_tr_b16 v[240:241], v210 offset:30720
  ds_read_b64_tr_b16 v[242:243], v210 offset:30976
  ds_read_b64_tr_b16 v[244:245], v210 offset:30728
  ds_read_b64_tr_b16 v[246:247], v210 offset:30984
  s_waitcnt vmcnt(0) lgkmcnt(0)
  ds_read_b64_tr_b16 v[248:249], v210 offset:32768
  ds_read_b64_tr_b16 v[250:251], v210 offset:33024
  ds_read_b64_tr_b16 v[252:253], v210 offset:32776
  ds_read_b64_tr_b16 v[254:255], v210 offset:33032
  v_and_b32 v211, 15, v200
  s_lshl_b32 s54, s69, 4
  v_add_u32 v211, s54, v211
  v_lshl_add_u32 v212, v214, 5, v211
  v_lshlrev_b32 v164, 4, v212
  v_lshrrev_b32 v212, 5, v200
  v_lshl_add_u32 v164, v212, 10, v164
  v_mul_u32_u24 v167, 1152, v211
  v_lshl_add_u32 v167, v213, 4, v167
  v_lshlrev_b32 v166, 2, v211
  v_lshlrev_b32 v208, 2, v200
  s_lshl_b32 s54, s52, 11
  v_add_u32 v168, s54, v201
  s_mov_b32 s59, s68
  s_mov_b32 s56, 128
  s_mov_b32 s57, 36
  s_waitcnt lgkmcnt(0)
  s_cmp_eq_u32 s52, 0
  s_cbranch_scc0 O_p1_d
  s_mov_b32 exec_hi, 0
  s_mov_b32 exec_lo, -1
O_p1:
  buffer_load_dword v211, v208, s[12:15], s56 offen sc1
  s_add_u32 s65, s65, 1
  s_waitcnt vmcnt(0)
  v_cmp_gt_u32 vcc, 0x700, v211
  s_cbranch_vccz O_p1_x
  s_sleep 16
  s_cmp_lt_u32 s65, 131072
  s_cbranch_scc1 O_p1
O_p1_x:
  s_mov_b64 exec, -1
O_p1_d:
  s_barrier
  s_cmp_eq_u32 s52, 0
  s_cbranch_scc0 O_a_d
  s_mov_b32 exec_hi, 0
  s_mov_b32 exec_lo, 1
O_a:
  buffer_load_dword v211, v208, s[12:15], s57 offen sc1
  s_add_u32 s65, s65, 1
  s_waitcnt vmcnt(0)
  v_cmp_gt_u32 vcc, 0x80, v211
  s_cbranch_vccz O_a_x
  s_sleep 16
  s_cmp_lt_u32 s65, 131072
  s_cbranch_scc1 O_a
O_a_x:
  s_mov_b64 exec, -1
O_a_d:
  s_barrier
  s_cmp_ge_u32 s70, 9
  s_cselect_b32 s54, 9, 0
  s_sub_u32 s54, s70, s54
  s_and_b32 s54, s54, 7
  s_lshl_b32 s54, s54, 13
  s_lshl_b32 s55, s69, 8
  s_add_u32 s54, s54, s55
  v_lshrrev_b32 v211, 2, v200
  v_lshl_add_u32 v172, v211, 9, s54
  v_and_b32 v211, 3, v200
  v_lshl_add_u32 v172, v211, 6, v172
  s_mul_i32 s55, s59, 36864
  s_mul_i32 s54, s52, 320
  s_add_u32 s55, s55, s54
  s_add_u32 s55, s55, 62914560
  s_cmp_eq_u32 s52, 3
  s_cselect_b32 s56, 268435456, s55
  buffer_load_dwordx4 v[128:131], v167, s[8:11], s55 offen offset:0 sc1
  buffer_load_dwordx4 v[132:135], v167, s[8:11], s55 offen offset:64 sc1
  buffer_load_dwordx4 v[136:139], v167, s[8:11], s55 offen offset:128 sc1
  buffer_load_dwordx4 v[140:143], v167, s[8:11], s56 offen offset:192 sc1
  buffer_load_dwordx4 v[144:147], v167, s[8:11], s56 offen offset:256 sc1
  s_lshl_b32 s55, s59, 7
  s_add_u32 s55, s55, 66060288
  buffer_load_dword v171, v166, s[8:11], s55 offen sc1
  v_mov_b32 v169, 0
  s_mov_b32 s66, 356352
  s_waitcnt vmcnt(0)
O_loop:
  v_mfma_f32_16x16x32_bf16 v[156:159], v[216:219], v[128:131], 0
  v_mfma_f32_16x16x32_bf16 v[160:163], v[220:223], v[128:131], 0
  v_mfma_f32_16x16x32_bf16 v[156:159], v[224:227], v[132:135], v[156:159]
  v_mfma_f32_16x16x32_bf16 v[160:163], v[228:231], v[132:135], v[160:163]
  v_mfma_f32_16x16x32_bf16 v[156:159], v[232:235], v[136:139], v[156:159]
  v_mfma_f32_16x16x32_bf16 v[160:163], v[236:239], v[136:139], v[160:163]
  v_mfma_f32_16x16x32_bf16 v[156:159], v[240:243], v[140:143], v[156:159]
  v_mfma_f32_16x16x32_bf16 v[160:163], v[244:247], v[140:143], v[160:163]
  v_mfma_f32_16x16x32_bf16 v[156:159], v[248:251], v[144:147], v[156:159]
  v_mfma_f32_16x16x32_bf16 v[160:163], v[252:255], v[144:147], v[160:163]
  s_mul_i32 s64, s59, 36864
  s_lshl_b32 s54, s70, 6
  s_add_u32 s64, s64, s54
  s_add_u32 s71, s59, 2
  s_lshl_b32 s55, s59, 18
  s_lshl_b32 s54, s52, 16
  s_add_u32 s55, s55, s54
  s_add_u32 s63, s55, 46137344
  s_and_b32 s54, s59, 1
  s_lshl_b32 s54, s54, 2
  s_add_u32 s54, s54, s52
  s_lshl_b32 s54, s54, 3
  s_lshl_b64 s[72:73], 0xff, s54
  v_sub_f32 v165, 1.0, v171
  v_cvt_pk_bf16_f32 v165, v165, v165
  v_lshlrev_b32 v165, 16, v165
  v_mul_f32 v156, v171, v156
  v_mul_f32 v157, v171, v157
  v_mul_f32 v158, v171, v158
  v_mul_f32 v159, v171, v159
  v_mul_f32 v160, v171, v160
  v_mul_f32 v161, v171, v161
  v_mul_f32 v162, v171, v162
  v_mul_f32 v163, v171, v163
  s_branch O_pc
O_pl:
  s_sleep 1
  buffer_load_dword v169, v208, s[8:11], s66 offen sc1
  s_add_u32 s65, s65, 1
  s_cmp_ge_u32 s65, 131072
  s_cbranch_scc1 O_ld
  s_waitcnt vmcnt(0)
O_pc:
  v_cmp_gt_u32 vcc, s71, v169
  s_nop 0
  s_and_b64 vcc, vcc, s[72:73]
  s_cbranch_scc1 O_pl
O_ld:
  s_mov_b32 s62, s63
  buffer_load_dword v173, v172, s[8:11], s63 offen sc1
  buffer_load_dwordx4 v[0:3], v164, s[8:11], s62 offen offset:0 sc1
  buffer_load_dwordx4 v[4:7], v164, s[8:11], s62 offen offset:2048 sc1
  s_add_u32 s62, s62, 4096
  buffer_load_dwordx4 v[8:11], v164, s[8:11], s62 offen offset:0 sc1
  buffer_load_dwordx4 v[12:15], v164, s[8:11], s62 offen offset:2048 sc1
  s_add_u32 s62, s62, 4096
  buffer_load_dwordx4 v[16:19], v164, s[8:11], s62 offen offset:0 sc1
  buffer_load_dwordx4 v[20:23], v164, s[8:11], s62 offen offset:2048 sc1
  s_add_u32 s62, s62, 4096
  buffer_load_dwordx4 v[24:27], v164, s[8:11], s62 offen offset:0 sc1
  buffer_load_dwordx4 v[28:31], v164, s[8:11], s62 offen offset:2048 sc1
  s_add_u32 s62, s62, 4096
  buffer_load_dwordx4 v[32:35], v164, s[8:11], s62 offen offset:0 sc1
  buffer_load_dwordx4 v[36:39], v164, s[8:11], s62 offen offset:2048 sc1
  s_add_u32 s62, s62, 4096
  buffer_load_dwordx4 v[40:43], v164, s[8:11], s62 offen offset:0 sc1
  buffer_load_dwordx4 v[44:47], v164, s[8:11], s62 offen offset:2048 sc1
  s_add_u32 s62, s62, 4096
  buffer_load_dwordx4 v[48:51], v164, s[8:11], s62 offen offset:0 sc1
  buffer_load_dwordx4 v[52:55], v164, s[8:11], s62 offen offset:2048 sc1
  s_add_u32 s62, s62, 4096
  buffer_load_dwordx4 v[56:59], v164, s[8:11], s62 offen offset:0 sc1
  buffer_load_dwordx4 v[60:63], v164, s[8:11], s62 offen offset:2048 sc1
  s_add_u32 s62, s62, 4096
  buffer_load_dwordx4 v[64:67], v164, s[8:11], s62 offen offset:0 sc1
  buffer_load_dwordx4 v[68:71], v164, s[8:11], s62 offen offset:2048 sc1
  s_add_u32 s62, s62, 4096
  buffer_load_dwordx4 v[72:75], v164, s[8:11], s62 offen offset:0 sc1
  buffer_load_dwordx4 v[76:79], v164, s[8:11], s62 offen offset:2048 sc1
  s_add_u32 s62, s62, 4096
  buffer_load_dwordx4 v[80:83], v164, s[8:11], s62 offen offset:0 sc1
  buffer_load_dwordx4 v[84:87], v164, s[8:11], s62 offen offset:2048 sc1
  s_add_u32 s62, s62, 4096
  buffer_load_dwordx4 v[88:91], v164, s[8:11], s62 offen offset:0 sc1
  buffer_load_dwordx4 v[92:95], v164, s[8:11], s62 offen offset:2048 sc1
  s_add_u32 s62, s62, 4096
  buffer_load_dwordx4 v[96:99], v164, s[8:11], s62 offen offset:0 sc1
  buffer_load_dwordx4 v[100:103], v164, s[8:11], s62 offen offset:2048 sc1
  s_add_u32 s62, s62, 4096
  buffer_load_dwordx4 v[104:107], v164, s[8:11], s62 offen offset:0 sc1
  buffer_load_dwordx4 v[108:111], v164, s[8:11], s62 offen offset:2048 sc1
  s_add_u32 s62, s62, 4096
  buffer_load_dwordx4 v[112:115], v164, s[8:11], s62 offen offset:0 sc1
  buffer_load_dwordx4 v[116:119], v164, s[8:11], s62 offen offset:2048 sc1
  s_add_u32 s62, s62, 4096
  buffer_load_dwordx4 v[120:123], v164, s[8:11], s62 offen offset:0 sc1
  buffer_load_dwordx4 v[124:127], v164, s[8:11], s62 offen offset:2048 sc1
  s_add_u32 s62, s62, 4096
  s_add_u32 s57, s59, 3
  s_min_u32 s74, s57, 63
  s_mul_i32 s55, s74, 36864
  s_mul_i32 s54, s52, 320
  s_add_u32 s55, s55, s54
  s_add_u32 s55, s55, 62914560
  s_cmp_eq_u32 s52, 3
  s_cselect_b32 s56, 268435456, s55
  buffer_load_dwordx4 v[128:131], v167, s[8:11], s55 offen offset:0 sc1
  buffer_load_dwordx4 v[132:135], v167, s[8:11], s55 offen offset:64 sc1
  buffer_load_dwordx4 v[136:139], v167, s[8:11], s55 offen offset:128 sc1
  buffer_load_dwordx4 v[140:143], v167, s[8:11], s56 offen offset:192 sc1
  buffer_load_dwordx4 v[144:147], v167, s[8:11], s56 offen offset:256 sc1
  s_lshl_b32 s55, s74, 7
  s_add_u32 s55, s55, 66060288
  buffer_load_dword v171, v166, s[8:11], s55 offen sc1
  s_add_u32 s65, s65, 1
  s_cmp_lt_u32 s65, 131072
  s_cselect_b32 s54, -2, -1
  s_waitcnt vmcnt(37)
  v_mfma_f32_16x16x32_bf16 v[148:151], a[0:3], v[0:3], 0
  v_mfma_f32_16x16x32_bf16 v[152:155], a[4:7], v[0:3], 0
  v_max3_u32 v170, v0, v1, v0
  v_max3_u32 v170, v2, v3, v170
  s_waitcnt vmcnt(36)
  v_mfma_f32_16x16x32_bf16 v[148:151], a[8:11], v[4:7], v[148:151]
  v_mfma_f32_16x16x32_bf16 v[152:155], a[12:15], v[4:7], v[152:155]
  v_max3_u32 v170, v4, v5, v170
  v_max3_u32 v170, v6, v7, v170
  s_waitcnt vmcnt(35)
  v_mfma_f32_16x16x32_bf16 v[148:151], a[16:19], v[8:11], v[148:151]
  v_mfma_f32_16x16x32_bf16 v[152:155], a[20:23], v[8:11], v[152:155]
  v_max3_u32 v170, v8, v9, v170
  v_max3_u32 v170, v10, v11, v170
  s_waitcnt vmcnt(34)
  v_mfma_f32_16x16x32_bf16 v[148:151], a[24:27], v[12:15], v[148:151]
  v_mfma_f32_16x16x32_bf16 v[152:155], a[28:31], v[12:15], v[152:155]
  v_max3_u32 v170, v12, v13, v170
  v_max3_u32 v170, v14, v15, v170
  s_waitcnt vmcnt(33)
  v_mfma_f32_16x16x32_bf16 v[148:151], a[32:35], v[16:19], v[148:151]
  v_mfma_f32_16x16x32_bf16 v[152:155], a[36:39], v[16:19], v[152:155]
  v_max3_u32 v170, v16, v17, v170
  v_max3_u32 v170, v18, v19, v170
  s_waitcnt vmcnt(32)
  v_mfma_f32_16x16x32_bf16 v[148:151], a[40:43], v[20:23], v[148:151]
  v_mfma_f32_16x16x32_bf16 v[152:155], a[44:47], v[20:23], v[152:155]
  v_max3_u32 v170, v20, v21, v170
  v_max3_u32 v170, v22, v23, v170
  s_waitcnt vmcnt(31)
  v_mfma_f32_16x16x32_bf16 v[148:151], a[48:51], v[24:27], v[148:151]
  v_mfma_f32_16x16x32_bf16 v[152:155], a[52:55], v[24:27], v[152:155]
  v_max3_u32 v170, v24, v25, v170
  v_max3_u32 v170, v26, v27, v170
  s_waitcnt vmcnt(30)
  v_mfma_f32_16x16x32_bf16 v[148:151], a[56:59], v[28:31], v[148:151]
  v_mfma_f32_16x16x32_bf16 v[152:155], a[60:63], v[28:31], v[152:155]
  v_max3_u32 v170, v28, v29, v170
  v_max3_u32 v170, v30, v31, v170
  s_waitcnt vmcnt(29)
  v_mfma_f32_16x16x32_bf16 v[148:151], a[64:67], v[32:35], v[148:151]
  v_mfma_f32_16x16x32_bf16 v[152:155], a[68:71], v[32:35], v[152:155]
  v_max3_u32 v170, v32, v33, v170
  v_max3_u32 v170, v34, v35, v170
  s_waitcnt vmcnt(28)
  v_mfma_f32_16x16x32_bf16 v[148:151], a[72:75], v[36:39], v[148:151]
  v_mfma_f32_16x16x32_bf16 v[152:155], a[76:79], v[36:39], v[152:155]
  v_max3_u32 v170, v36, v37, v170
  v_max3_u32 v170, v38, v39, v170
  s_waitcnt vmcnt(27)
  v_mfma_f32_16x16x32_bf16 v[148:151], a[80:83], v[40:43], v[148:151]
  v_mfma_f32_16x16x32_bf16 v[152:155], a[84:87], v[40:43], v[152:155]
  v_max3_u32 v170, v40, v41, v170
  v_max3_u32 v170, v42, v43, v170
  s_waitcnt vmcnt(26)
  v_mfma_f32_16x16x32_bf16 v[148:151], a[88:91], v[44:47], v[148:151]
  v_mfma_f32_16x16x32_bf16 v[152:155], a[92:95], v[44:47], v[152:155]
  v_max3_u32 v170, v44, v45, v170
  v_max3_u32 v170, v46, v47, v170
  s_waitcnt vmcnt(25)
  v_mfma_f32_16x16x32_bf16 v[148:151], a[96:99], v[48:51], v[148:151]
  v_mfma_f32_16x16x32_bf16 v[152:155], a[100:103], v[48:51], v[152:155]
  v_max3_u32 v170, v48, v49, v170
  v_max3_u32 v170, v50, v51, v170
  s_waitcnt vmcnt(24)
  v_mfma_f32_16x16x32_bf16 v[148:151], a[104:107], v[52:55], v[148:151]
  v_mfma_f32_16x16x32_bf16 v[152:155], a[108:111], v[52:55], v[152:155]
  v_max3_u32 v170, v52, v53, v170
  v_max3_u32 v170, v54, v55, v170
  s_waitcnt vmcnt(23)
  v_mfma_f32_16x16x32_bf16 v[148:151], a[112:115], v[56:59], v[148:151]
  v_mfma_f32_16x16x32_bf16 v[152:155], a[116:119], v[56:59], v[152:155]
  v_max3_u32 v170, v56, v57, v170
  v_max3_u32 v170, v58, v59, v170
  s_waitcnt vmcnt(22)
  v_mfma_f32_16x16x32_bf16 v[148:151], a[120:123], v[60:63], v[148:151]
  v_mfma_f32_16x16x32_bf16 v[152:155], a[124:127], v[60:63], v[152:155]
  v_max3_u32 v170, v60, v61, v170
  v_max3_u32 v170, v62, v63, v170
  s_waitcnt vmcnt(21)
  v_mfma_f32_16x16x32_bf16 v[148:151], a[128:131], v[64:67], v[148:151]
  v_mfma_f32_16x16x32_bf16 v[152:155], a[132:135], v[64:67], v[152:155]
  v_max3_u32 v170, v64, v65, v170
  v_max3_u32 v170, v66, v67, v170
  s_waitcnt vmcnt(20)
  v_mfma_f32_16x16x32_bf16 v[148:151], a[136:139], v[68:71], v[148:151]
  v_mfma_f32_16x16x32_bf16 v[152:155], a[140:143], v[68:71], v[152:155]
  v_max3_u32 v170, v68, v69, v170
  v_max3_u32 v170, v70, v71, v170
  s_waitcnt vmcnt(19)
  v_mfma_f32_16x16x32_bf16 v[148:151], a[144:147], v[72:75], v[148:151]
  v_mfma_f32_16x16x32_bf16 v[152:155], a[148:151], v[72:75], v[152:155]
  v_max3_u32 v170, v72, v73, v170
  v_max3_u32 v170, v74, v75, v170
  s_waitcnt vmcnt(18)
  v_mfma_f32_16x16x32_bf16 v[148:151], a[152:155], v[76:79], v[148:151]
  v_mfma_f32_16x16x32_bf16 v[152:155], a[156:159], v[76:79], v[152:155]
  v_max3_u32 v170, v76, v77, v170
  v_max3_u32 v170, v78, v79, v170
  s_waitcnt vmcnt(17)
  v_mfma_f32_16x16x32_bf16 v[148:151], a[160:163], v[80:83], v[148:151]
  v_mfma_f32_16x16x32_bf16 v[152:155], a[164:167], v[80:83], v[152:155]
  v_max3_u32 v170, v80, v81, v170
  v_max3_u32 v170, v82, v83, v170
  s_waitcnt vmcnt(16)
  v_mfma_f32_16x16x32_bf16 v[148:151], a[168:171], v[84:87], v[148:151]
  v_mfma_f32_16x16x32_bf16 v[152:155], a[172:175], v[84:87], v[152:155]
  v_max3_u32 v170, v84, v85, v170
  v_max3_u32 v170, v86, v87, v170
  s_waitcnt vmcnt(15)
  v_mfma_f32_16x16x32_bf16 v[148:151], a[176:179], v[88:91], v[148:151]
  v_mfma_f32_16x16x32_bf16 v[152:155], a[180:183], v[88:91], v[152:155]
  v_max3_u32 v170, v88, v89, v170
  v_max3_u32 v170, v90, v91, v170
  s_waitcnt vmcnt(14)
  v_mfma_f32_16x16x32_bf16 v[148:151], a[184:187], v[92:95], v[148:151]
  v_mfma_f32_16x16x32_bf16 v[152:155], a[188:191], v[92:95], v[152:155]
  v_max3_u32 v170, v92, v93, v170
  v_max3_u32 v170, v94, v95, v170
  s_waitcnt vmcnt(13)
  v_mfma_f32_16x16x32_bf16 v[148:151], a[192:195], v[96:99], v[148:151]
  v_mfma_f32_16x16x32_bf16 v[152:155], a[196:199], v[96:99], v[152:155]
  v_max3_u32 v170, v96, v97, v170
  v_max3_u32 v170, v98, v99, v170
  s_waitcnt vmcnt(12)
  v_mfma_f32_16x16x32_bf16 v[148:151], a[200:203], v[100:103], v[148:151]
  v_mfma_f32_16x16x32_bf16 v[152:155], a[204:207], v[100:103], v[152:155]
  v_max3_u32 v170, v100, v101, v170
  v_max3_u32 v170, v102, v103, v170
  s_waitcnt vmcnt(11)
  v_mfma_f32_16x16x32_bf16 v[148:151], a[208:211], v[104:107], v[148:151]
  v_mfma_f32_16x16x32_bf16 v[152:155], a[212:215], v[104:107], v[152:155]
  v_max3_u32 v170, v104, v105, v170
  v_max3_u32 v170, v106, v107, v170
  s_waitcnt vmcnt(10)
  v_mfma_f32_16x16x32_bf16 v[148:151], a[216:219], v[108:111], v[148:151]
  v_mfma_f32_16x16x32_bf16 v[152:155], a[220:223], v[108:111], v[152:155]
  v_max3_u32 v170, v108, v109, v170
  v_max3_u32 v170, v110, v111, v170
  s_waitcnt vmcnt(9)
  v_mfma_f32_16x16x32_bf16 v[148:151], a[224:227], v[112:115], v[148:151]
  v_mfma_f32_16x16x32_bf16 v[152:155], a[228:231], v[112:115], v[152:155]
  v_max3_u32 v170, v112, v113, v170
  v_max3_u32 v170, v114, v115, v170
  s_waitcnt vmcnt(8)
  v_mfma_f32_16x16x32_bf16 v[148:151], a[232:235], v[116:119], v[148:151]
  v_mfma_f32_16x16x32_bf16 v[152:155], a[236:239], v[116:119], v[152:155]
  v_max3_u32 v170, v116, v117, v170
  v_max3_u32 v170, v118, v119, v170
  s_waitcnt vmcnt(7)
  v_mfma_f32_16x16x32_bf16 v[148:151], a[240:243], v[120:123], v[148:151]
  v_mfma_f32_16x16x32_bf16 v[152:155], a[244:247], v[120:123], v[152:155]
  v_max3_u32 v170, v120, v121, v170
  v_max3_u32 v170, v122, v123, v170
  s_waitcnt vmcnt(6)
  v_mfma_f32_16x16x32_bf16 v[148:151], a[248:251], v[124:127], v[148:151]
  v_mfma_f32_16x16x32_bf16 v[152:155], a[252:255], v[124:127], v[152:155]
  v_max3_u32 v170, v124, v125, v170
  v_max3_u32 v170, v126, v127, v170
  v_cmp_lt_u32 vcc, s54, v170
  s_cbranch_vccnz O_ld
  v_fmac_f32 v156, v165, v148
  v_fmac_f32 v157, v165, v149
  v_fmac_f32 v158, v165, v150
  v_fmac_f32 v159, v165, v151
  v_fmac_f32 v160, v165, v152
  v_fmac_f32 v161, v165, v153
  v_fmac_f32 v162, v165, v154
  v_fmac_f32 v163, v165, v155
  ds_write_b128 v168, v[156:159]
  ds_write_b128 v168, v[160:163] offset:1024
  v_xor_b32 v168, 0x2000, v168
  s_mov_b32 s59, s57
  s_waitcnt lgkmcnt(0)
  s_barrier
  s_cmp_eq_u32 s52, 0
  s_cbranch_scc0 O_next
  v_xor_b32 v211, 0x2000, v168
  ds_read_b128 v[0:3], v211 offset:2048
  ds_read_b128 v[4:7], v211 offset:3072
  ds_read_b128 v[8:11], v211 offset:4096
  ds_read_b128 v[12:15], v211 offset:5120
  ds_read_b128 v[16:19], v211 offset:6144
  ds_read_b128 v[20:23], v211 offset:7168
  s_waitcnt lgkmcnt(5)
  v_add_f32 v156, v156, v0
  v_add_f32 v157, v157, v1
  v_add_f32 v158, v158, v2
  v_add_f32 v159, v159, v3
  s_waitcnt lgkmcnt(4)
  v_add_f32 v160, v160, v4
  v_add_f32 v161, v161, v5
  v_add_f32 v162, v162, v6
  v_add_f32 v163, v163, v7
  s_waitcnt lgkmcnt(3)
  v_add_f32 v156, v156, v8
  v_add_f32 v157, v157, v9
  v_add_f32 v158, v158, v10
  v_add_f32 v159, v159, v11
  s_waitcnt lgkmcnt(2)
  v_add_f32 v160, v160, v12
  v_add_f32 v161, v161, v13
  v_add_f32 v162, v162, v14
  v_add_f32 v163, v163, v15
  s_waitcnt lgkmcnt(1)
  v_add_f32 v156, v156, v16
  v_add_f32 v157, v157, v17
  v_add_f32 v158, v158, v18
  v_add_f32 v159, v159, v19
  s_waitcnt lgkmcnt(0)
  v_add_f32 v160, v160, v20
  v_add_f32 v161, v161, v21
  v_add_f32 v162, v162, v22
  v_add_f32 v163, v163, v23
  v_cvt_pk_bf16_f32 v148, v156, v157
  v_cvt_pk_bf16_f32 v149, v158, v159
  v_cvt_pk_bf16_f32 v150, v160, v161
  v_cvt_pk_bf16_f32 v151, v162, v163
  buffer_store_dwordx4 v[148:151], v167, s[48:51], s64 offen
  s_waitcnt vmcnt(1)
  s_branch O_nx2
O_next:
  s_waitcnt vmcnt(0)
O_nx2:
  s_cmp_lt_u32 s59, 64
  s_cbranch_scc1 O_loop
  s_branch L_exit
W_h:
  s_lshr_b32 s58, s53, 1
  s_and_b32 s59, s53, 1
  s_mul_i32 s60, s59, 36864
  s_add_u32 m0, s67, 0
  s_nop 0
  buffer_load_dwordx4 v202, s[4:7], s60 offen offset:0 lds
  s_add_u32 m0, s67, 896
  s_nop 0
  buffer_load_dwordx4 v202, s[4:7], s60 offen offset:128 lds
  s_add_u32 m0, s67, 1792
  s_nop 0
  buffer_load_dwordx4 v202, s[4:7], s60 offen offset:256 lds
  s_add_u32 m0, s67, 2688
  s_nop 0
  buffer_load_dwordx4 v202, s[4:7], s60 offen offset:384 lds
  s_add_u32 m0, s67, 3584
  s_nop 0
  buffer_load_dwordx4 v202, s[4:7], s60 offen offset:512 lds
  s_add_u32 m0, s67, 4480
  s_nop 0
  buffer_load_dwordx4 v202, s[4:7], s60 offen offset:640 lds
  s_add_u32 m0, s67, 5376
  s_nop 0
  buffer_load_dwordx4 v202, s[4:7], s60 offen offset:768 lds
  s_add_u32 m0, s67, 6272
  s_nop 0
  buffer_load_dwordx4 v202, s[4:7], s60 offen offset:896 lds
  s_add_u32 m0, s67, 7168
  s_nop 0
  buffer_load_dwordx4 v202, s[4:7], s60 offen offset:1024 lds
  v_lshrrev_b32 v211, 4, v200
  v_lshlrev_b32 v212, 2, v211
  v_and_b32 v213, 15, v200
  v_xor_b32 v212, v212, v213
  v_lshlrev_b32 v212, 4, v212
  v_lshl_add_u32 v207, v211, 13, v212
  s_lshl_b32 s62, s58, 8
  s_lshl_b32 s54, s52, 15
  s_add_u32 s62, s62, s54
  s_lshl_b32 s61, s52, 10
  s_add_u32 s61, s61, 36864
  s_add_u32 m0, s61, 0
  s_add_u32 s54, s62, 0
  buffer_load_dwordx4 v207, s[16:19], s54 offen lds
  s_add_u32 m0, s61, 4096
  s_add_u32 s54, s62, 131072
  buffer_load_dwordx4 v207, s[16:19], s54 offen lds
  s_add_u32 m0, s61, 8192
  s_add_u32 s54, s62, 262144
  buffer_load_dwordx4 v207, s[16:19], s54 offen lds
  s_add_u32 m0, s61, 12288
  s_add_u32 s54, s62, 393216
  buffer_load_dwordx4 v207, s[16:19], s54 offen lds
  s_add_u32 m0, s61, 16384
  s_add_u32 s54, s62, 524288
  buffer_load_dwordx4 v207, s[16:19], s54 offen lds
  s_add_u32 m0, s61, 20480
  s_add_u32 s54, s62, 655360
  buffer_load_dwordx4 v207, s[16:19], s54 offen lds
  s_add_u32 m0, s61, 24576
  s_add_u32 s54, s62, 786432
  buffer_load_dwordx4 v207, s[16:19], s54 offen lds
  s_add_u32 m0, s61, 28672
  s_add_u32 s54, s62, 917504
  buffer_load_dwordx4 v207, s[16:19], s54 offen lds
  s_add_u32 m0, s61, 32768
  s_add_u32 s54, s62, 1048576
  buffer_load_dwordx4 v207, s[16:19], s54 offen lds
  s_add_u32 m0, s61, 36864
  s_add_u32 s54, s62, 1179648
  buffer_load_dwordx4 v207, s[16:19], s54 offen lds
  s_add_u32 m0, s61, 40960
  s_add_u32 s54, s62, 1310720
  buffer_load_dwordx4 v207, s[16:19], s54 offen lds
  s_add_u32 m0, s61, 45056
  s_add_u32 s54, s62, 1441792
  buffer_load_dwordx4 v207, s[16:19], s54 offen lds
  s_add_u32 m0, s61, 49152
  s_add_u32 s54, s62, 1572864
  buffer_load_dwordx4 v207, s[16:19], s54 offen lds
  s_add_u32 m0, s61, 53248
  s_add_u32 s54, s62, 1703936
  buffer_load_dwordx4 v207, s[16:19], s54 offen lds
  s_add_u32 m0, s61, 57344
  s_add_u32 s54, s62, 1835008
  buffer_load_dwordx4 v207, s[16:19], s54 offen lds
  s_add_u32 m0, s61, 61440
  s_add_u32 s54, s62, 1966080
  buffer_load_dwordx4 v207, s[16:19], s54 offen lds
  s_add_u32 m0, s61, 65536
  s_add_u32 s54, s62, 2097152
  buffer_load_dwordx4 v207, s[16:19], s54 offen lds
  s_add_u32 m0, s61, 69632
  s_add_u32 s54, s62, 2228224
  buffer_load_dwordx4 v207, s[16:19], s54 offen lds
  s_add_u32 m0, s61, 73728
  s_add_u32 s54, s62, 2359296
  buffer_load_dwordx4 v207, s[16:19], s54 offen lds
  s_add_u32 m0, s61, 77824
  s_add_u32 s54, s62, 2490368
  buffer_load_dwordx4 v207, s[16:19], s54 offen lds
  s_add_u32 m0, s61, 81920
  s_add_u32 s54, s62, 2621440
  buffer_load_dwordx4 v207, s[16:19], s54 offen lds
  s_add_u32 m0, s61, 86016
  s_add_u32 s54, s62, 2752512
  buffer_load_dwordx4 v207, s[16:19], s54 offen lds
  s_add_u32 m0, s61, 90112
  s_add_u32 s54, s62, 2883584
  buffer_load_dwordx4 v207, s[16:19], s54 offen lds
  s_add_u32 m0, s61, 94208
  s_add_u32 s54, s62, 3014656
  buffer_load_dwordx4 v207, s[16:19], s54 offen lds
  s_waitcnt vmcnt(20) lgkmcnt(0)
  s_barrier
  s_add_u32 m0, s61, 98304
  s_add_u32 s54, s62, 3145728
  buffer_load_dwordx4 v207, s[16:19], s54 offen lds
  s_add_u32 m0, s61, 102400
  s_add_u32 s54, s62, 3276800
  buffer_load_dwordx4 v207, s[16:19], s54 offen lds
  s_add_u32 m0, s61, 106496
  s_add_u32 s54, s62, 3407872
  buffer_load_dwordx4 v207, s[16:19], s54 offen lds
  s_add_u32 m0, s61, 110592
  s_add_u32 s54, s62, 3538944
  buffer_load_dwordx4 v207, s[16:19], s54 offen lds
  v_add_u32 v215, 36864, v209
  ds_read_b64_tr_b16 a[0:1], v215 offset:0
  ds_read_b64_tr_b16 a[2:3], v215 offset:1024
  ds_read_b64_tr_b16 a[4:5], v215 offset:4096
  ds_read_b64_tr_b16 a[6:7], v215 offset:5120
  ds_read_b64_tr_b16 a[8:9], v215 offset:8192
  ds_read_b64_tr_b16 a[10:11], v215 offset:9216
  ds_read_b64_tr_b16 a[12:13], v215 offset:12288
  ds_read_b64_tr_b16 a[14:15], v215 offset:13312
  s_waitcnt vmcnt(20) lgkmcnt(0)
  s_barrier
  s_add_u32 m0, s61, 0
  s_add_u32 s54, s62, 3670016
  buffer_load_dwordx4 v207, s[16:19], s54 offen lds
  s_add_u32 m0, s61, 4096
  s_add_u32 s54, s62, 3801088
  buffer_load_dwordx4 v207, s[16:19], s54 offen lds
  s_add_u32 m0, s61, 8192
  s_add_u32 s54, s62, 3932160
  buffer_load_dwordx4 v207, s[16:19], s54 offen lds
  s_add_u32 m0, s61, 12288
  s_add_u32 s54, s62, 4063232
  buffer_load_dwordx4 v207, s[16:19], s54 offen lds
  v_add_u32 v215, 53248, v209
  ds_read_b64_tr_b16 a[16:17], v215 offset:0
  ds_read_b64_tr_b16 a[18:19], v215 offset:1024
  ds_read_b64_tr_b16 a[20:21], v215 offset:4096
  ds_read_b64_tr_b16 a[22:23], v215 offset:5120
  ds_read_b64_tr_b16 a[24:25], v215 offset:8192
  ds_read_b64_tr_b16 a[26:27], v215 offset:9216
  ds_read_b64_tr_b16 a[28:29], v215 offset:12288
  ds_read_b64_tr_b16 a[30:31], v215 offset:13312
  s_waitcnt vmcnt(20) lgkmcnt(0)
  s_barrier
  s_add_u32 m0, s61, 16384
  s_add_u32 s54, s62, 4194304
  buffer_load_dwordx4 v207, s[16:19], s54 offen lds
  s_add_u32 m0, s61, 20480
  s_add_u32 s54, s62, 4325376
  buffer_load_dwordx4 v207, s[16:19], s54 offen lds
  s_add_u32 m0, s61, 24576
  s_add_u32 s54, s62, 4456448
  buffer_load_dwordx4 v207, s[16:19], s54 offen lds
  s_add_u32 m0, s61, 28672
  s_add_u32 s54, s62, 4587520
  buffer_load_dwordx4 v207, s[16:19], s54 offen lds
  v_add_u32 v215, 69632, v209
  ds_read_b64_tr_b16 a[32:33], v215 offset:0
  ds_read_b64_tr_b16 a[34:35], v215 offset:1024
  ds_read_b64_tr_b16 a[36:37], v215 offset:4096
  ds_read_b64_tr_b16 a[38:39], v215 offset:5120
  ds_read_b64_tr_b16 a[40:41], v215 offset:8192
  ds_read_b64_tr_b16 a[42:43], v215 offset:9216
  ds_read_b64_tr_b16 a[44:45], v215 offset:12288
  ds_read_b64_tr_b16 a[46:47], v215 offset:13312
  s_waitcnt vmcnt(20) lgkmcnt(0)
  s_barrier
  v_add_u32 v215, 86016, v209
  ds_read_b64_tr_b16 a[48:49], v215 offset:0
  ds_read_b64_tr_b16 a[50:51], v215 offset:1024
  ds_read_b64_tr_b16 a[52:53], v215 offset:4096
  ds_read_b64_tr_b16 a[54:55], v215 offset:5120
  ds_read_b64_tr_b16 a[56:57], v215 offset:8192
  ds_read_b64_tr_b16 a[58:59], v215 offset:9216
  ds_read_b64_tr_b16 a[60:61], v215 offset:12288
  ds_read_b64_tr_b16 a[62:63], v215 offset:13312
  s_waitcnt vmcnt(16) lgkmcnt(0)
  s_barrier
  v_add_u32 v215, 102400, v209
  ds_read_b64_tr_b16 a[64:65], v215 offset:0
  ds_read_b64_tr_b16 a[66:67], v215 offset:1024
  ds_read_b64_tr_b16 a[68:69], v215 offset:4096
  ds_read_b64_tr_b16 a[70:71], v215 offset:5120
  ds_read_b64_tr_b16 a[72:73], v215 offset:8192
  ds_read_b64_tr_b16 a[74:75], v215 offset:9216
  ds_read_b64_tr_b16 a[76:77], v215 offset:12288
  ds_read_b64_tr_b16 a[78:79], v215 offset:13312
  s_waitcnt vmcnt(12) lgkmcnt(0)
  s_barrier
  v_add_u32 v215, 118784, v209
  ds_read_b64_tr_b16 a[80:81], v215 offset:0
  ds_read_b64_tr_b16 a[82:83], v215 offset:1024
  ds_read_b64_tr_b16 a[84:85], v215 offset:4096
  ds_read_b64_tr_b16 a[86:87], v215 offset:5120
  ds_read_b64_tr_b16 a[88:89], v215 offset:8192
  ds_read_b64_tr_b16 a[90:91], v215 offset:9216
  ds_read_b64_tr_b16 a[92:93], v215 offset:12288
  ds_read_b64_tr_b16 a[94:95], v215 offset:13312
  s_waitcnt vmcnt(8) lgkmcnt(0)
  s_barrier
  v_add_u32 v215, 135168, v209
  ds_read_b64_tr_b16 a[96:97], v215 offset:0
  ds_read_b64_tr_b16 a[98:99], v215 offset:1024
  ds_read_b64_tr_b16 a[100:101], v215 offset:4096
  ds_read_b64_tr_b16 a[102:103], v215 offset:5120
  ds_read_b64_tr_b16 a[104:105], v215 offset:8192
  ds_read_b64_tr_b16 a[106:107], v215 offset:9216
  ds_read_b64_tr_b16 a[108:109], v215 offset:12288
  ds_read_b64_tr_b16 a[110:111], v215 offset:13312
  s_waitcnt vmcnt(4) lgkmcnt(0)
  s_barrier
  v_add_u32 v215, 36864, v209
  ds_read_b64_tr_b16 a[112:113], v215 offset:0
  ds_read_b64_tr_b16 a[114:115], v215 offset:1024
  ds_read_b64_tr_b16 a[116:117], v215 offset:4096
  ds_read_b64_tr_b16 a[118:119], v215 offset:5120
  ds_read_b64_tr_b16 a[120:121], v215 offset:8192
  ds_read_b64_tr_b16 a[122:123], v215 offset:9216
  ds_read_b64_tr_b16 a[124:125], v215 offset:12288
  ds_read_b64_tr_b16 a[126:127], v215 offset:13312
  s_waitcnt vmcnt(0) lgkmcnt(0)
  s_barrier
  v_add_u32 v215, 53248, v209
  ds_read_b64_tr_b16 a[128:129], v215 offset:0
  ds_read_b64_tr_b16 a[130:131], v215 offset:1024
  ds_read_b64_tr_b16 a[132:133], v215 offset:4096
  ds_read_b64_tr_b16 a[134:135], v215 offset:5120
  ds_read_b64_tr_b16 a[136:137], v215 offset:8192
  ds_read_b64_tr_b16 a[138:139], v215 offset:9216
  ds_read_b64_tr_b16 a[140:141], v215 offset:12288
  ds_read_b64_tr_b16 a[142:143], v215 offset:13312
  s_waitcnt lgkmcnt(0)
  s_barrier
  v_and_b32 v211, 31, v200
  v_lshrrev_b32 v212, 5, v200
  v_lshlrev_b32 v213, 2, v212
  v_sub_u32 v211, v211, v213
  v_mov_b32 v214, 0xf149f2ca
  v_cmp_gt_i32 vcc, 0, v211
  s_nop 1
  v_cndmask_b32 v48, 0, v214, vcc
  v_cmp_gt_i32 vcc, 1, v211
  s_nop 1
  v_cndmask_b32 v49, 0, v214, vcc
  v_cmp_gt_i32 vcc, 2, v211
  s_nop 1
  v_cndmask_b32 v50, 0, v214, vcc
  v_cmp_gt_i32 vcc, 3, v211
  s_nop 1
  v_cndmask_b32 v51, 0, v214, vcc
  v_cmp_gt_i32 vcc, 8, v211
  s_nop 1
  v_cndmask_b32 v52, 0, v214, vcc
  v_cmp_gt_i32 vcc, 9, v211
  s_nop 1
  v_cndmask_b32 v53, 0, v214, vcc
  v_cmp_gt_i32 vcc, 10, v211
  s_nop 1
  v_cndmask_b32 v54, 0, v214, vcc
  v_cmp_gt_i32 vcc, 11, v211
  s_nop 1
  v_cndmask_b32 v55, 0, v214, vcc
  v_cmp_gt_i32 vcc, 16, v211
  s_nop 1
  v_cndmask_b32 v56, 0, v214, vcc
  v_cmp_gt_i32 vcc, 17, v211
  s_nop 1
  v_cndmask_b32 v57, 0, v214, vcc
  v_cmp_gt_i32 vcc, 18, v211
  s_nop 1
  v_cndmask_b32 v58, 0, v214, vcc
  v_cmp_gt_i32 vcc, 19, v211
  s_nop 1
  v_cndmask_b32 v59, 0, v214, vcc
  v_cmp_gt_i32 vcc, 24, v211
  s_nop 1
  v_cndmask_b32 v60, 0, v214, vcc
  v_cmp_gt_i32 vcc, 25, v211
  s_nop 1
  v_cndmask_b32 v61, 0, v214, vcc
  v_cmp_gt_i32 vcc, 26, v211
  s_nop 1
  v_cndmask_b32 v62, 0, v214, vcc
  v_cmp_gt_i32 vcc, 27, v211
  s_nop 1
  v_cndmask_b32 v63, 0, v214, vcc
  v_and_b32 v218, 0xff, v216
  v_add_u32 v218, 81920, v218
  v_and_b32 v211, 15, v200
  v_lshl_add_u32 v211, v212, 5, v211
  v_lshlrev_b32 v219, 3, v211
  v_bfe_u32 v211, v200, 4, 1
  v_lshl_add_u32 v219, v211, 2, v219
  s_lshl_b32 s54, s52, 9
  s_add_u32 s54, s54, 83968
  v_add_u32 v219, s54, v219
  v_lshl_add_u32 v221, v200, 3, s54
  s_lshr_b32 s54, s52, 1
  s_lshl_b32 s54, s54, 10
  s_and_b32 s55, s52, 1
  s_lshl_b32 s55, s55, 3
  s_add_u32 s54, s54, s55
  s_add_u32 s54, s54, 81920
  v_add_u32 v220, s54, v201
  s_lshl_b32 s54, s52, 11
  s_add_u32 s54, s54, 73728
  v_add_u32 v215, s54, v201
  v_add_u32 v208, 73728, v201
  s_mov_b32 s68, 1040356334
  s_cmp_eq_u32 s52, 0
  s_cselect_b32 s71, s71, 268435456
  s_lshl_b32 s56, s58, 2
  s_add_u32 s56, s56, 128
  v_mov_b32 v176, -1
  v_mov_b32 v177, -1
  v_mov_b32 v178, -1
  v_mov_b32 v179, -1
  s_cmp_eq_u32 s52, 0
  s_cbranch_scc0 AT_p1_d
  s_mov_b32 exec_hi, 0
  s_mov_b32 exec_lo, 1
AT_p1:
  buffer_load_dword v211, v201, s[12:15], s56 offen sc1
  s_add_u32 s65, s65, 1
  s_waitcnt vmcnt(0)
  v_cmp_gt_u32 vcc, 0x700, v211
  s_cbranch_vccz AT_p1_x
  s_sleep 8
  s_cmp_lt_u32 s65, 131072
  s_cbranch_scc1 AT_p1
AT_p1_x:
  s_mov_b64 exec, -1
AT_p1_d:
  s_barrier
  s_mov_b32 s74, s59
  s_mul_i32 s66, s59, 655360
  s_lshl_b32 s55, s58, 14
  s_add_u32 s55, s55, s66
  s_add_u32 s55, s55, 1048576
  s_lshl_b32 s73, s58, 2
  s_add_u32 s73, s73, s52
  s_lshl_b32 s72, s59, 7
  s_add_u32 s72, s72, s73
  s_lshl_b32 s72, s72, 11
  s_add_u32 s72, s72, 46137344
  s_lshl_b32 s73, s73, 10
  s_add_u32 s73, s73, s66
  s_add_u32 s73, s73, 1572864
  s_add_u32 s59, s59, 2
  buffer_load_dwordx4 v[128:131], v216, s[8:11], s55 offen offset:0 sc1
  buffer_load_dwordx4 v[132:135], v216, s[8:11], s55 offen offset:256 sc1
  buffer_load_dwordx4 v[136:139], v216, s[8:11], s55 offen offset:512 sc1
  buffer_load_dwordx4 v[140:143], v216, s[8:11], s55 offen offset:768 sc1
  buffer_load_dwordx4 v[144:147], v216, s[8:11], s55 offen offset:1024 sc1
  buffer_load_dwordx4 v[148:151], v216, s[8:11], s55 offen offset:1280 sc1
  buffer_load_dwordx4 v[152:155], v216, s[8:11], s55 offen offset:1536 sc1
  buffer_load_dwordx4 v[156:159], v216, s[8:11], s55 offen offset:1792 sc1
  buffer_load_dwordx4 v[160:163], v217, s[8:11], s55 offen offset:0 sc1
  buffer_load_dwordx4 v[164:167], v217, s[8:11], s55 offen offset:256 sc1
  s_add_u32 s60, s60, 73728
  s_add_u32 m0, s67, 36864
  s_nop 0
  buffer_load_dwordx4 v202, s[4:7], s60 offen offset:0 lds
  s_add_u32 m0, s67, 37760
  s_nop 0
  buffer_load_dwordx4 v202, s[4:7], s60 offen offset:128 lds
  s_add_u32 m0, s67, 38656
  s_nop 0
  buffer_load_dwordx4 v202, s[4:7], s60 offen offset:256 lds
  s_add_u32 m0, s67, 39552
  s_nop 0
  buffer_load_dwordx4 v202, s[4:7], s60 offen offset:384 lds
  s_add_u32 m0, s67, 40448
  s_nop 0
  buffer_load_dwordx4 v202, s[4:7], s60 offen offset:512 lds
  s_add_u32 m0, s67, 41344
  s_nop 0
  buffer_load_dwordx4 v202, s[4:7], s60 offen offset:640 lds
  s_add_u32 m0, s67, 42240
  s_nop 0
  buffer_load_dwordx4 v202, s[4:7], s60 offen offset:768 lds
  s_add_u32 m0, s67, 43136
  s_nop 0
  buffer_load_dwordx4 v202, s[4:7], s60 offen offset:896 lds
  s_add_u32 m0, s67, 44032
  s_nop 0
  buffer_load_dwordx4 v202, s[4:7], s60 offen offset:1024 lds
  buffer_store_dwordx4 v[176:179], v201, s[8:11], s72 offen offset:0 sc1
  buffer_store_dwordx4 v[176:179], v201, s[8:11], s72 offen offset:1024 sc1
  ds_read_b128 v[32:35], v203 offset:0
  ds_read_b128 v[36:39], v204 offset:0
  ds_read_b128 v[40:43], v205 offset:0
  s_waitcnt lgkmcnt(2)
  v_mfma_f32_32x32x16_bf16 v[240:255], a[0:3], v[32:35], 0
  ds_read_b128 v[44:47], v206 offset:0
  s_waitcnt lgkmcnt(2)
  v_mfma_f32_32x32x16_bf16 v[240:255], a[4:7], v[36:39], v[240:255]
  ds_read_b128 v[32:35], v203 offset:1024
  s_waitcnt lgkmcnt(2)
  v_mfma_f32_32x32x16_bf16 v[240:255], a[8:11], v[40:43], v[240:255]
  ds_read_b128 v[36:39], v204 offset:1024
  s_waitcnt lgkmcnt(2)
  v_mfma_f32_32x32x16_bf16 v[240:255], a[12:15], v[44:47], v[240:255]
  ds_read_b128 v[40:43], v205 offset:1024
  s_waitcnt lgkmcnt(2)
  v_mfma_f32_32x32x16_bf16 v[240:255], a[16:19], v[32:35], v[240:255]
  ds_read_b128 v[44:47], v206 offset:1024
  s_waitcnt lgkmcnt(2)
  v_mfma_f32_32x32x16_bf16 v[240:255], a[20:23], v[36:39], v[240:255]
  ds_read_b128 v[32:35], v203 offset:2048
  s_waitcnt lgkmcnt(2)
  v_mfma_f32_32x32x16_bf16 v[240:255], a[24:27], v[40:43], v[240:255]
  ds_read_b128 v[36:39], v204 offset:2048
  s_waitcnt lgkmcnt(2)
  v_mfma_f32_32x32x16_bf16 v[240:255], a[28:31], v[44:47], v[240:255]
  ds_read_b128 v[40:43], v205 offset:2048
  s_waitcnt lgkmcnt(2)
  v_mfma_f32_32x32x16_bf16 v[240:255], a[32:35], v[32:35], v[240:255]
  ds_read_b128 v[44:47], v206 offset:2048
  s_waitcnt lgkmcnt(2)
  v_mfma_f32_32x32x16_bf16 v[240:255], a[36:39], v[36:39], v[240:255]
  ds_read_b128 v[32:35], v203 offset:3072
  s_waitcnt lgkmcnt(2)
  v_mfma_f32_32x32x16_bf16 v[240:255], a[40:43], v[40:43], v[240:255]
  ds_read_b128 v[36:39], v204 offset:3072
  s_waitcnt lgkmcnt(2)
  v_mfma_f32_32x32x16_bf16 v[240:255], a[44:47], v[44:47], v[240:255]
  ds_read_b128 v[40:43], v205 offset:3072
  s_waitcnt lgkmcnt(2)
  v_mfma_f32_32x32x16_bf16 v[240:255], a[48:51], v[32:35], v[240:255]
  ds_read_b128 v[44:47], v206 offset:3072
  s_waitcnt lgkmcnt(2)
  v_mfma_f32_32x32x16_bf16 v[240:255], a[52:55], v[36:39], v[240:255]
  ds_read_b128 v[32:35], v203 offset:4096
  s_waitcnt lgkmcnt(2)
  v_mfma_f32_32x32x16_bf16 v[240:255], a[56:59], v[40:43], v[240:255]
  ds_read_b128 v[36:39], v204 offset:4096
  s_waitcnt lgkmcnt(2)
  v_mfma_f32_32x32x16_bf16 v[240:255], a[60:63], v[44:47], v[240:255]
  ds_read_b128 v[40:43], v205 offset:4096
  s_waitcnt lgkmcnt(2)
  v_mfma_f32_32x32x16_bf16 v[240:255], a[64:67], v[32:35], v[240:255]
  ds_read_b128 v[44:47], v206 offset:4096
  s_waitcnt lgkmcnt(2)
  v_mfma_f32_32x32x16_bf16 v[240:255], a[68:71], v[36:39], v[240:255]
  ds_read_b128 v[32:35], v203 offset:5120
  s_waitcnt lgkmcnt(2)
  v_mfma_f32_32x32x16_bf16 v[240:255], a[72:75], v[40:43], v[240:255]
  ds_read_b128 v[36:39], v204 offset:5120
  s_waitcnt lgkmcnt(2)
  v_mfma_f32_32x32x16_bf16 v[240:255], a[76:79], v[44:47], v[240:255]
  ds_read_b128 v[40:43], v205 offset:5120
  s_waitcnt lgkmcnt(2)
  v_mfma_f32_32x32x16_bf16 v[240:255], a[80:83], v[32:35], v[240:255]
  ds_read_b128 v[44:47], v206 offset:5120
  s_waitcnt lgkmcnt(2)
  v_mfma_f32_32x32x16_bf16 v[240:255], a[84:87], v[36:39], v[240:255]
  ds_read_b128 v[32:35], v203 offset:6144
  s_waitcnt lgkmcnt(2)
  v_mfma_f32_32x32x16_bf16 v[240:255], a[88:91], v[40:43], v[240:255]
  ds_read_b128 v[36:39], v204 offset:6144
  s_waitcnt lgkmcnt(2)
  v_mfma_f32_32x32x16_bf16 v[240:255], a[92:95], v[44:47], v[240:255]
  ds_read_b128 v[40:43], v205 offset:6144
  s_waitcnt lgkmcnt(2)
  v_mfma_f32_32x32x16_bf16 v[240:255], a[96:99], v[32:35], v[240:255]
  ds_read_b128 v[44:47], v206 offset:6144
  s_waitcnt lgkmcnt(2)
  v_mfma_f32_32x32x16_bf16 v[240:255], a[100:103], v[36:39], v[240:255]
  ds_read_b128 v[32:35], v203 offset:7168
  s_waitcnt lgkmcnt(2)
  v_mfma_f32_32x32x16_bf16 v[240:255], a[104:107], v[40:43], v[240:255]
  ds_read_b128 v[36:39], v204 offset:7168
  s_waitcnt lgkmcnt(2)
  v_mfma_f32_32x32x16_bf16 v[240:255], a[108:111], v[44:47], v[240:255]
  ds_read_b128 v[40:43], v205 offset:7168
  s_waitcnt lgkmcnt(2)
  v_mfma_f32_32x32x16_bf16 v[240:255], a[112:115], v[32:35], v[240:255]
  ds_read_b128 v[44:47], v206 offset:7168
  s_waitcnt lgkmcnt(2)
  v_mfma_f32_32x32x16_bf16 v[240:255], a[116:119], v[36:39], v[240:255]
  ds_read_b128 v[32:35], v203 offset:8192
  s_waitcnt lgkmcnt(2)
  v_mfma_f32_32x32x16_bf16 v[240:255], a[120:123], v[40:43], v[240:255]
  ds_read_b128 v[36:39], v204 offset:8192
  s_waitcnt lgkmcnt(2)
  v_mfma_f32_32x32x16_bf16 v[240:255], a[124:127], v[44:47], v[240:255]
  ds_read_b128 v[40:43], v205 offset:8192
  s_waitcnt lgkmcnt(2)
  v_mfma_f32_32x32x16_bf16 v[240:255], a[128:131], v[32:35], v[240:255]
  ds_read_b128 v[44:47], v206 offset:8192
  s_waitcnt lgkmcnt(2)
  v_mfma_f32_32x32x16_bf16 v[240:255], a[132:135], v[36:39], v[240:255]
  s_waitcnt lgkmcnt(1)
  v_mfma_f32_32x32x16_bf16 v[240:255], a[136:139], v[40:43], v[240:255]
  s_waitcnt lgkmcnt(0)
  v_mfma_f32_32x32x16_bf16 v[240:255], a[140:143], v[44:47], v[240:255]
  s_nop 11
  v_cvt_pk_bf16_f32 v16, v240, v244
  v_cvt_pk_bf16_f32 v17, v241, v245
  v_cvt_pk_bf16_f32 v18, v242, v246
  v_cvt_pk_bf16_f32 v19, v243, v247
  ds_write_b128 v215, v[16:19] offset:0
  v_cvt_pk_bf16_f32 v20, v248, v252
  v_cvt_pk_bf16_f32 v21, v249, v253
  v_cvt_pk_bf16_f32 v22, v250, v254
  v_cvt_pk_bf16_f32 v23, v251, v255
  ds_write_b128 v215, v[20:23] offset:1024
  s_waitcnt lgkmcnt(0)
  s_barrier
  ds_read_b128 v[96:99], v208 offset:0
  ds_read_b128 v[100:103], v208 offset:1024
  ds_read_b128 v[104:107], v208 offset:2048
  ds_read_b128 v[108:111], v208 offset:3072
  ds_read_b128 v[112:115], v208 offset:4096
  ds_read_b128 v[116:119], v208 offset:5120
  ds_read_b128 v[120:123], v208 offset:6144
  ds_read_b128 v[124:127], v208 offset:7168
  s_waitcnt vmcnt(20) lgkmcnt(7)
  v_mfma_f32_32x32x16_bf16 v[64:79], v[128:131], v[96:99], v[48:63]
  s_waitcnt vmcnt(19) lgkmcnt(6)
  v_mfma_f32_32x32x16_bf16 v[64:79], v[132:135], v[100:103], v[64:79]
  s_waitcnt vmcnt(18) lgkmcnt(5)
  v_mfma_f32_32x32x16_bf16 v[64:79], v[136:139], v[104:107], v[64:79]
  s_waitcnt vmcnt(17) lgkmcnt(4)
  v_mfma_f32_32x32x16_bf16 v[64:79], v[140:143], v[108:111], v[64:79]
  s_waitcnt vmcnt(16) lgkmcnt(3)
  v_mfma_f32_32x32x16_bf16 v[64:79], v[144:147], v[112:115], v[64:79]
  s_waitcnt vmcnt(15) lgkmcnt(2)
  v_mfma_f32_32x32x16_bf16 v[64:79], v[148:151], v[116:119], v[64:79]
  s_waitcnt vmcnt(14) lgkmcnt(1)
  v_mfma_f32_32x32x16_bf16 v[64:79], v[152:155], v[120:123], v[64:79]
  s_waitcnt vmcnt(13) lgkmcnt(0)
  v_mfma_f32_32x32x16_bf16 v[64:79], v[156:159], v[124:127], v[64:79]
  s_nop 11
  v_max3_f32 v180, v64, v65, v66
  v_max3_f32 v180, v180, v67, v68
  v_max3_f32 v180, v180, v69, v70
  v_max3_f32 v180, v180, v71, v72
  v_max3_f32 v180, v180, v73, v74
  v_max3_f32 v180, v180, v75, v76
  v_max3_f32 v180, v180, v77, v78
  v_max_f32 v180, v180, v79
  v_mov_b32 v181, v180
  s_nop 1
  v_permlane32_swap_b32 v180, v181
  v_max_f32 v180, v180, v181
  v_sub_f32 v64, v64, v180
  v_sub_f32 v65, v65, v180
  v_sub_f32 v66, v66, v180
  v_sub_f32 v67, v67, v180
  v_sub_f32 v68, v68, v180
  v_sub_f32 v69, v69, v180
  v_sub_f32 v70, v70, v180
  v_sub_f32 v71, v71, v180
  v_sub_f32 v72, v72, v180
  v_sub_f32 v73, v73, v180
  v_sub_f32 v74, v74, v180
  v_sub_f32 v75, v75, v180
  v_sub_f32 v76, v76, v180
  v_sub_f32 v77, v77, v180
  v_sub_f32 v78, v78, v180
  v_sub_f32 v79, v79, v180
  v_exp_f32 v64, v64
  v_exp_f32 v65, v65
  v_exp_f32 v66, v66
  v_exp_f32 v67, v67
  v_exp_f32 v68, v68
  v_exp_f32 v69, v69
  v_exp_f32 v70, v70
  v_exp_f32 v71, v71
  v_exp_f32 v72, v72
  v_exp_f32 v73, v73
  v_exp_f32 v74, v74
  v_exp_f32 v75, v75
  v_exp_f32 v76, v76
  v_exp_f32 v77, v77
  v_exp_f32 v78, v78
  v_exp_f32 v79, v79
  v_cvt_pk_bf16_f32 v20, v64, v65
  v_cvt_pk_bf16_f32 v21, v68, v69
  v_cvt_pk_bf16_f32 v22, v72, v73
  v_cvt_pk_bf16_f32 v23, v76, v77
  v_cvt_pk_bf16_f32 v24, v66, v67
  v_cvt_pk_bf16_f32 v25, v70, v71
  v_cvt_pk_bf16_f32 v26, v74, v75
  v_cvt_pk_bf16_f32 v27, v78, v79
  s_waitcnt vmcnt(12)
  v_mfma_f32_32x32x16_bf16 v[0:15], v[160:163], v[20:23], 0
  v_add_f32 v182, v64, v65
  v_add_f32 v182, v182, v66
  v_add_f32 v182, v182, v67
  v_add_f32 v182, v182, v68
  v_add_f32 v182, v182, v69
  v_add_f32 v182, v182, v70
  v_add_f32 v182, v182, v71
  s_waitcnt vmcnt(11)
  v_mfma_f32_32x32x16_bf16 v[0:15], v[164:167], v[24:27], v[0:15]
  v_add_f32 v182, v182, v72
  v_add_f32 v182, v182, v73
  v_add_f32 v182, v182, v74
  v_add_f32 v182, v182, v75
  v_add_f32 v182, v182, v76
  v_add_f32 v182, v182, v77
  v_add_f32 v182, v182, v78
  v_add_f32 v182, v182, v79
  s_waitcnt vmcnt(0)
  s_barrier
AT_loop:
  s_cmp_ge_u32 s59, 64
  s_cbranch_scc1 AT_l0
  s_mov_b32 s77, s59
  s_mul_i32 s66, s59, 655360
  s_lshl_b32 s55, s58, 14
  s_add_u32 s55, s55, s66
  s_add_u32 s55, s55, 1048576
  s_lshl_b32 s76, s58, 2
  s_add_u32 s76, s76, s52
  s_lshl_b32 s75, s59, 7
  s_add_u32 s75, s75, s76
  s_lshl_b32 s75, s75, 11
  s_add_u32 s75, s75, 46137344
  s_lshl_b32 s76, s76, 10
  s_add_u32 s76, s76, s66
  s_add_u32 s76, s76, 1572864
  s_add_u32 s59, s59, 2
  buffer_load_dwordx4 v[128:131], v216, s[8:11], s55 offen offset:0 sc1
  buffer_load_dwordx4 v[132:135], v216, s[8:11], s55 offen offset:256 sc1
  buffer_load_dwordx4 v[136:139], v216, s[8:11], s55 offen offset:512 sc1
  buffer_load_dwordx4 v[140:143], v216, s[8:11], s55 offen offset:768 sc1
  buffer_load_dwordx4 v[144:147], v216, s[8:11], s55 offen offset:1024 sc1
  buffer_load_dwordx4 v[148:151], v216, s[8:11], s55 offen offset:1280 sc1
  buffer_load_dwordx4 v[152:155], v216, s[8:11], s55 offen offset:1536 sc1
  buffer_load_dwordx4 v[156:159], v216, s[8:11], s55 offen offset:1792 sc1
  buffer_load_dwordx4 v[160:163], v217, s[8:11], s55 offen offset:0 sc1
  buffer_load_dwordx4 v[164:167], v217, s[8:11], s55 offen offset:256 sc1
  s_or_b32 s70, s73, 0xc00
  buffer_load_dword v172, off, s[8:11], s70 sc1
  s_add_u32 s60, s60, 73728
  s_add_u32 m0, s67, 0
  s_nop 0
  buffer_load_dwordx4 v202, s[4:7], s60 offen offset:0 lds
  s_add_u32 m0, s67, 896
  s_nop 0
  buffer_load_dwordx4 v202, s[4:7], s60 offen offset:128 lds
  s_add_u32 m0, s67, 1792
  s_nop 0
  buffer_load_dwordx4 v202, s[4:7], s60 offen offset:256 lds
  s_add_u32 m0, s67, 2688
  s_nop 0
  buffer_load_dwordx4 v202, s[4:7], s60 offen offset:384 lds
  s_add_u32 m0, s67, 3584
  s_nop 0
  buffer_load_dwordx4 v202, s[4:7], s60 offen offset:512 lds
  s_add_u32 m0, s67, 4480
  s_nop 0
  buffer_load_dwordx4 v202, s[4:7], s60 offen offset:640 lds
  s_add_u32 m0, s67, 5376
  s_nop 0
  buffer_load_dwordx4 v202, s[4:7], s60 offen offset:768 lds
  s_add_u32 m0, s67, 6272
  s_nop 0
  buffer_load_dwordx4 v202, s[4:7], s60 offen offset:896 lds
  s_add_u32 m0, s67, 7168
  s_nop 0
  buffer_load_dwordx4 v202, s[4:7], s60 offen offset:1024 lds
  buffer_store_dwordx4 v[176:179], v201, s[8:11], s75 offen offset:0 sc1
  buffer_store_dwordx4 v[176:179], v201, s[8:11], s75 offen offset:1024 sc1
  ds_read_b128 v[32:35], v203 offset:36864
  ds_read_b128 v[36:39], v204 offset:36864
  ds_read_b128 v[40:43], v205 offset:36864
  s_waitcnt lgkmcnt(2)
  v_mfma_f32_32x32x16_bf16 v[240:255], a[0:3], v[32:35], 0
  ds_read_b128 v[44:47], v206 offset:36864
  s_waitcnt lgkmcnt(2)
  v_mfma_f32_32x32x16_bf16 v[240:255], a[4:7], v[36:39], v[240:255]
  ds_read_b128 v[32:35], v203 offset:37888
  s_waitcnt lgkmcnt(2)
  v_mfma_f32_32x32x16_bf16 v[240:255], a[8:11], v[40:43], v[240:255]
  ds_read_b128 v[36:39], v204 offset:37888
  s_waitcnt lgkmcnt(2)
  v_mfma_f32_32x32x16_bf16 v[240:255], a[12:15], v[44:47], v[240:255]
  ds_read_b128 v[40:43], v205 offset:37888
  s_waitcnt lgkmcnt(2)
  v_mfma_f32_32x32x16_bf16 v[240:255], a[16:19], v[32:35], v[240:255]
  ds_read_b128 v[44:47], v206 offset:37888
  s_waitcnt lgkmcnt(2)
  v_mfma_f32_32x32x16_bf16 v[240:255], a[20:23], v[36:39], v[240:255]
  ds_read_b128 v[32:35], v203 offset:38912
  s_waitcnt lgkmcnt(2)
  v_mfma_f32_32x32x16_bf16 v[240:255], a[24:27], v[40:43], v[240:255]
  ds_read_b128 v[36:39], v204 offset:38912
  s_waitcnt lgkmcnt(2)
  v_mfma_f32_32x32x16_bf16 v[240:255], a[28:31], v[44:47], v[240:255]
  ds_read_b128 v[40:43], v205 offset:38912
  s_waitcnt lgkmcnt(2)
  v_mfma_f32_32x32x16_bf16 v[240:255], a[32:35], v[32:35], v[240:255]
  ds_read_b128 v[44:47], v206 offset:38912
  s_waitcnt lgkmcnt(2)
  v_mfma_f32_32x32x16_bf16 v[240:255], a[36:39], v[36:39], v[240:255]
  ds_read_b128 v[32:35], v203 offset:39936
  s_waitcnt lgkmcnt(2)
  v_mfma_f32_32x32x16_bf16 v[240:255], a[40:43], v[40:43], v[240:255]
  ds_read_b128 v[36:39], v204 offset:39936
  s_waitcnt lgkmcnt(2)
  v_mfma_f32_32x32x16_bf16 v[240:255], a[44:47], v[44:47], v[240:255]
  ds_read_b128 v[40:43], v205 offset:39936
  s_waitcnt lgkmcnt(2)
  v_mfma_f32_32x32x16_bf16 v[240:255], a[48:51], v[32:35], v[240:255]
  ds_read_b128 v[44:47], v206 offset:39936
  s_waitcnt lgkmcnt(2)
  v_mfma_f32_32x32x16_bf16 v[240:255], a[52:55], v[36:39], v[240:255]
  ds_read_b128 v[32:35], v203 offset:40960
  s_waitcnt lgkmcnt(2)
  v_mfma_f32_32x32x16_bf16 v[240:255], a[56:59], v[40:43], v[240:255]
  ds_read_b128 v[36:39], v204 offset:40960
  s_waitcnt lgkmcnt(2)
  v_mfma_f32_32x32x16_bf16 v[240:255], a[60:63], v[44:47], v[240:255]
  ds_read_b128 v[40:43], v205 offset:40960
  s_waitcnt lgkmcnt(2)
  v_mfma_f32_32x32x16_bf16 v[240:255], a[64:67], v[32:35], v[240:255]
  ds_read_b128 v[44:47], v206 offset:40960
  s_waitcnt lgkmcnt(2)
  v_mfma_f32_32x32x16_bf16 v[240:255], a[68:71], v[36:39], v[240:255]
  ds_read_b128 v[32:35], v203 offset:41984
  s_waitcnt lgkmcnt(2)
  v_mfma_f32_32x32x16_bf16 v[240:255], a[72:75], v[40:43], v[240:255]
  ds_read_b128 v[36:39], v204 offset:41984
  s_waitcnt lgkmcnt(2)
  v_mfma_f32_32x32x16_bf16 v[240:255], a[76:79], v[44:47], v[240:255]
  ds_read_b128 v[40:43], v205 offset:41984
  s_waitcnt lgkmcnt(2)
  v_mfma_f32_32x32x16_bf16 v[240:255], a[80:83], v[32:35], v[240:255]
  ds_read_b128 v[44:47], v206 offset:41984
  s_waitcnt lgkmcnt(2)
  v_mfma_f32_32x32x16_bf16 v[240:255], a[84:87], v[36:39], v[240:255]
  ds_read_b128 v[32:35], v203 offset:43008
  s_waitcnt lgkmcnt(2)
  v_mfma_f32_32x32x16_bf16 v[240:255], a[88:91], v[40:43], v[240:255]
  ds_read_b128 v[36:39], v204 offset:43008
  s_waitcnt lgkmcnt(2)
  v_mfma_f32_32x32x16_bf16 v[240:255], a[92:95], v[44:47], v[240:255]
  ds_read_b128 v[40:43], v205 offset:43008
  s_waitcnt lgkmcnt(2)
  v_mfma_f32_32x32x16_bf16 v[240:255], a[96:99], v[32:35], v[240:255]
  ds_read_b128 v[44:47], v206 offset:43008
  s_waitcnt lgkmcnt(2)
  v_mfma_f32_32x32x16_bf16 v[240:255], a[100:103], v[36:39], v[240:255]
  ds_read_b128 v[32:35], v203 offset:44032
  s_waitcnt lgkmcnt(2)
  v_mfma_f32_32x32x16_bf16 v[240:255], a[104:107], v[40:43], v[240:255]
  ds_read_b128 v[36:39], v204 offset:44032
  s_waitcnt lgkmcnt(2)
  v_mfma_f32_32x32x16_bf16 v[240:255], a[108:111], v[44:47], v[240:255]
  ds_read_b128 v[40:43], v205 offset:44032
  s_waitcnt lgkmcnt(2)
  v_mfma_f32_32x32x16_bf16 v[240:255], a[112:115], v[32:35], v[240:255]
  ds_read_b128 v[44:47], v206 offset:44032
  s_waitcnt lgkmcnt(2)
  v_mfma_f32_32x32x16_bf16 v[240:255], a[116:119], v[36:39], v[240:255]
  ds_read_b128 v[32:35], v203 offset:45056
  s_waitcnt lgkmcnt(2)
  v_mfma_f32_32x32x16_bf16 v[240:255], a[120:123], v[40:43], v[240:255]
  ds_read_b128 v[36:39], v204 offset:45056
  s_waitcnt lgkmcnt(2)
  v_mfma_f32_32x32x16_bf16 v[240:255], a[124:127], v[44:47], v[240:255]
  ds_read_b128 v[40:43], v205 offset:45056
  s_waitcnt lgkmcnt(2)
  v_mfma_f32_32x32x16_bf16 v[240:255], a[128:131], v[32:35], v[240:255]
  ds_read_b128 v[44:47], v206 offset:45056
  s_waitcnt lgkmcnt(2)
  v_mfma_f32_32x32x16_bf16 v[240:255], a[132:135], v[36:39], v[240:255]
  s_waitcnt lgkmcnt(1)
  v_mfma_f32_32x32x16_bf16 v[240:255], a[136:139], v[40:43], v[240:255]
  s_waitcnt lgkmcnt(0)
  v_mfma_f32_32x32x16_bf16 v[240:255], a[140:143], v[44:47], v[240:255]
  s_nop 11
  v_cvt_pk_bf16_f32 v16, v240, v244
  v_cvt_pk_bf16_f32 v17, v241, v245
  v_cvt_pk_bf16_f32 v18, v242, v246
  v_cvt_pk_bf16_f32 v19, v243, v247
  ds_write_b128 v215, v[16:19] offset:0
  v_cvt_pk_bf16_f32 v20, v248, v252
  v_cvt_pk_bf16_f32 v21, v249, v253
  v_cvt_pk_bf16_f32 v22, v250, v254
  v_cvt_pk_bf16_f32 v23, v251, v255
  ds_write_b128 v215, v[20:23] offset:1024
  s_waitcnt lgkmcnt(0)
  s_barrier
  ds_read_b128 a[144:147], v208 offset:0
  ds_read_b128 a[148:151], v208 offset:1024
  ds_read_b128 a[152:155], v208 offset:2048
  ds_read_b128 a[156:159], v208 offset:3072
  ds_read_b128 a[160:163], v208 offset:4096
  ds_read_b128 a[164:167], v208 offset:5120
  ds_read_b128 a[168:171], v208 offset:6144
  ds_read_b128 a[172:175], v208 offset:7168
  s_waitcnt vmcnt(11)
  v_cmp_eq_u32 vcc, -1, v172
  s_mov_b32 s69, 0
  s_cbranch_vccnz AT_e1
  s_mov_b32 s69, 1
  buffer_load_dwordx4 v[172:175], v201, s[8:11], s73 offen sc1
AT_e1:
  s_waitcnt lgkmcnt(7)
  v_mfma_f32_32x32x16_bf16 v[64:79], v[128:131], a[144:147], v[48:63]
  s_waitcnt lgkmcnt(6)
  v_mfma_f32_32x32x16_bf16 v[64:79], v[132:135], a[148:151], v[64:79]
  s_waitcnt lgkmcnt(5)
  v_mfma_f32_32x32x16_bf16 v[64:79], v[136:139], a[152:155], v[64:79]
  s_waitcnt lgkmcnt(4)
  v_mfma_f32_32x32x16_bf16 v[64:79], v[140:143], a[156:159], v[64:79]
  s_waitcnt lgkmcnt(3)
  v_mfma_f32_32x32x16_bf16 v[64:79], v[144:147], a[160:163], v[64:79]
  s_waitcnt lgkmcnt(2)
  v_mfma_f32_32x32x16_bf16 v[64:79], v[148:151], a[164:167], v[64:79]
  s_waitcnt lgkmcnt(1)
  v_mfma_f32_32x32x16_bf16 v[64:79], v[152:155], a[168:171], v[64:79]
  s_waitcnt lgkmcnt(0)
  v_mfma_f32_32x32x16_bf16 v[64:79], v[156:159], a[172:175], v[64:79]
  s_nop 11
  v_max3_f32 v184, v64, v65, v66
  v_max3_f32 v184, v184, v67, v68
  v_max3_f32 v184, v184, v69, v70
  v_max3_f32 v184, v184, v71, v72
  v_max3_f32 v184, v184, v73, v74
  v_max3_f32 v184, v184, v75, v76
  v_max3_f32 v184, v184, v77, v78
  v_max_f32 v184, v184, v79
  v_mov_b32 v185, v184
  s_nop 1
  v_permlane32_swap_b32 v184, v185
  v_max_f32 v184, v184, v185
  v_sub_f32 v64, v64, v184
  v_sub_f32 v65, v65, v184
  v_sub_f32 v66, v66, v184
  v_sub_f32 v67, v67, v184
  v_sub_f32 v68, v68, v184
  v_sub_f32 v69, v69, v184
  v_sub_f32 v70, v70, v184
  v_sub_f32 v71, v71, v184
  v_sub_f32 v72, v72, v184
  v_sub_f32 v73, v73, v184
  v_sub_f32 v74, v74, v184
  v_sub_f32 v75, v75, v184
  v_sub_f32 v76, v76, v184
  v_sub_f32 v77, v77, v184
  v_sub_f32 v78, v78, v184
  v_sub_f32 v79, v79, v184
  v_exp_f32 v64, v64
  v_exp_f32 v65, v65
  v_exp_f32 v66, v66
  v_exp_f32 v67, v67
  v_exp_f32 v68, v68
  v_exp_f32 v69, v69
  v_exp_f32 v70, v70
  v_exp_f32 v71, v71
  v_exp_f32 v72, v72
  v_exp_f32 v73, v73
  v_exp_f32 v74, v74
  v_exp_f32 v75, v75
  v_exp_f32 v76, v76
  v_exp_f32 v77, v77
  v_exp_f32 v78, v78
  v_exp_f32 v79, v79
  v_cvt_pk_bf16_f32 v20, v64, v65
  v_cvt_pk_bf16_f32 v21, v68, v69
  v_cvt_pk_bf16_f32 v22, v72, v73
  v_cvt_pk_bf16_f32 v23, v76, v77
  v_cvt_pk_bf16_f32 v24, v66, v67
  v_cvt_pk_bf16_f32 v25, v70, v71
  v_cvt_pk_bf16_f32 v26, v74, v75
  v_cvt_pk_bf16_f32 v27, v78, v79
  v_mfma_f32_32x32x16_bf16 v[224:239], v[160:163], v[20:23], 0
  v_add_f32 v186, v64, v65
  v_add_f32 v186, v186, v66
  v_add_f32 v186, v186, v67
  v_add_f32 v186, v186, v68
  v_add_f32 v186, v186, v69
  v_add_f32 v186, v186, v70
  v_add_f32 v186, v186, v71
  v_mfma_f32_32x32x16_bf16 v[224:239], v[164:167], v[24:27], v[224:239]
  v_add_f32 v186, v186, v72
  v_add_f32 v186, v186, v73
  v_add_f32 v186, v186, v74
  v_add_f32 v186, v186, v75
  v_add_f32 v186, v186, v76
  v_add_f32 v186, v186, v77
  v_add_f32 v186, v186, v78
  v_add_f32 v186, v186, v79
AT_l0:
  s_cmp_eq_u32 s69, 1
  s_cbranch_scc1 AT_v0
  s_cmp_ge_u32 s74, 62
  s_cbranch_scc1 AT_k0
  s_branch AT_c0
AT_h0:
  s_sleep 2
AT_c0:
  buffer_load_dword v172, off, s[8:11], s70 sc1
  s_add_u32 s65, s65, 1
  s_cmp_lt_u32 s65, 131072
  s_cselect_b32 s54, -2, -1
  s_waitcnt vmcnt(0)
  v_cmp_lt_u32 vcc, s54, v172
  s_cbranch_vccnz AT_h0
AT_k0:
  buffer_load_dwordx4 v[172:175], v201, s[8:11], s73 offen sc1
AT_v0:
  s_mov_b32 s69, 0
  s_add_u32 s65, s65, 1
  s_cmp_lt_u32 s65, 131072
  s_cselect_b32 s54, -2, -1
  s_waitcnt vmcnt(0)
  ds_write_b64 v220, v[172:173] offset:0
  ds_write_b64 v221, v[174:175] offset:0
  v_max3_u32 v213, v172, v173, v174
  v_max_u32 v213, v213, v175
  v_cmp_lt_u32 vcc, s54, v213
  s_cbranch_vccnz AT_k0
  s_waitcnt lgkmcnt(0)
  s_barrier
  ds_read_b128 v[128:131], v218 offset:0
  ds_read_b128 v[132:135], v218 offset:256
  ds_read_b128 v[136:139], v218 offset:512
  ds_read_b128 v[140:143], v218 offset:768
  ds_read_b128 v[144:147], v218 offset:1024
  ds_read_b128 v[148:151], v218 offset:1280
  ds_read_b128 v[152:155], v218 offset:1536
  ds_read_b128 v[156:159], v218 offset:1792
  ds_read_b32 v168, v219 offset:0
  ds_read_b32 v169, v219 offset:128
  s_waitcnt lgkmcnt(9)
  v_mfma_f32_32x32x16_bf16 v[80:95], v[128:131], v[96:99], 0
  s_waitcnt lgkmcnt(8)
  v_mfma_f32_32x32x16_bf16 v[80:95], v[132:135], v[100:103], v[80:95]
  s_waitcnt lgkmcnt(7)
  v_mfma_f32_32x32x16_bf16 v[80:95], v[136:139], v[104:107], v[80:95]
  s_waitcnt lgkmcnt(6)
  v_mfma_f32_32x32x16_bf16 v[80:95], v[140:143], v[108:111], v[80:95]
  s_waitcnt lgkmcnt(5)
  v_mfma_f32_32x32x16_bf16 v[80:95], v[144:147], v[112:115], v[80:95]
  s_waitcnt lgkmcnt(4)
  v_mfma_f32_32x32x16_bf16 v[80:95], v[148:151], v[116:119], v[80:95]
  s_waitcnt lgkmcnt(3)
  v_mfma_f32_32x32x16_bf16 v[80:95], v[152:155], v[120:123], v[80:95]
  s_waitcnt lgkmcnt(2)
  v_mfma_f32_32x32x16_bf16 v[80:95], v[156:159], v[124:127], v[80:95]
  s_add_u32 s74, s74, 2
  v_mov_b32 v212, s74
  s_nop 9
  v_mul_f32 v80, s68, v80
  v_mul_f32 v81, s68, v81
  v_mul_f32 v82, s68, v82
  v_mul_f32 v83, s68, v83
  v_max3_f32 v84, v180, v80, v81
  v_max3_f32 v84, v84, v82, v83
  v_mov_b32 v85, v84
  s_nop 1
  v_permlane32_swap_b32 v84, v85
  v_max_f32 v84, v84, v85
  v_sub_f32 v86, v180, v84
  v_sub_f32 v80, v80, v84
  v_sub_f32 v81, v81, v84
  v_sub_f32 v82, v82, v84
  v_sub_f32 v83, v83, v84
  v_exp_f32 v86, v86
  v_exp_f32 v80, v80
  v_exp_f32 v81, v81
  v_exp_f32 v82, v82
  v_exp_f32 v83, v83
  v_fma_f32 v182, v182, v86, v80
  v_add_f32 v84, v81, v82
  v_add_f32 v182, v182, v83
  v_add_f32 v182, v182, v84
  v_mov_b32 v183, v182
  s_nop 1
  v_permlane32_swap_b32 v182, v183
  v_add_f32 v182, v182, v183
  v_rcp_f32 v182, v182
  s_nop 0
  v_mul_f32 v86, v86, v182
  v_mul_f32 v80, v182, v80
  v_mul_f32 v81, v182, v81
  v_mul_f32 v82, v182, v82
  v_mul_f32 v83, v182, v83
  v_cvt_pk_bf16_f32 v28, v80, v81
  v_cvt_pk_bf16_f32 v29, v82, v83
  v_mul_f32 v0, v86, v0
  v_mul_f32 v1, v86, v1
  v_mul_f32 v2, v86, v2
  v_mul_f32 v3, v86, v3
  v_mul_f32 v4, v86, v4
  v_mul_f32 v5, v86, v5
  v_mul_f32 v6, v86, v6
  v_mul_f32 v7, v86, v7
  v_mul_f32 v8, v86, v8
  v_mul_f32 v9, v86, v9
  v_mul_f32 v10, v86, v10
  v_mul_f32 v11, v86, v11
  v_mul_f32 v12, v86, v12
  v_mul_f32 v13, v86, v13
  v_mul_f32 v14, v86, v14
  v_mul_f32 v15, v86, v15
  s_waitcnt lgkmcnt(0)
  s_nop 0
  v_mfma_f32_32x32x8_bf16 v[0:15], v[168:169], v[28:29], v[0:15]
  s_nop 11
  v_cvt_pk_bf16_f32 v20, v0, v1
  v_cvt_pk_bf16_f32 v21, v2, v3
  v_cvt_pk_bf16_f32 v22, v4, v5
  v_cvt_pk_bf16_f32 v23, v6, v7
  buffer_store_dwordx4 v[20:23], v201, s[8:11], s72 offen offset:0 sc1
  v_cvt_pk_bf16_f32 v24, v8, v9
  v_cvt_pk_bf16_f32 v25, v10, v11
  v_cvt_pk_bf16_f32 v26, v12, v13
  v_cvt_pk_bf16_f32 v27, v14, v15
  buffer_store_dwordx4 v[24:27], v201, s[8:11], s72 offen offset:1024 sc1
  s_mov_b64 exec, 1
  buffer_store_dword v212, v201, s[8:11], s71 offen sc1
  s_mov_b64 exec, -1
  s_cmp_ge_u32 s74, 64
  s_cbranch_scc1 L_exit
  s_cmp_ge_u32 s59, 64
  s_cbranch_scc1 AT_l1
  s_mov_b32 s74, s59
  s_mul_i32 s66, s59, 655360
  s_lshl_b32 s55, s58, 14
  s_add_u32 s55, s55, s66
  s_add_u32 s55, s55, 1048576
  s_lshl_b32 s73, s58, 2
  s_add_u32 s73, s73, s52
  s_lshl_b32 s72, s59, 7
  s_add_u32 s72, s72, s73
  s_lshl_b32 s72, s72, 11
  s_add_u32 s72, s72, 46137344
  s_lshl_b32 s73, s73, 10
  s_add_u32 s73, s73, s66
  s_add_u32 s73, s73, 1572864
  s_add_u32 s59, s59, 2
  buffer_load_dwordx4 v[128:131], v216, s[8:11], s55 offen offset:0 sc1
  buffer_load_dwordx4 v[132:135], v216, s[8:11], s55 offen offset:256 sc1
  buffer_load_dwordx4 v[136:139], v216, s[8:11], s55 offen offset:512 sc1
  buffer_load_dwordx4 v[140:143], v216, s[8:11], s55 offen offset:768 sc1
  buffer_load_dwordx4 v[144:147], v216, s[8:11], s55 offen offset:1024 sc1
  buffer_load_dwordx4 v[148:151], v216, s[8:11], s55 offen offset:1280 sc1
  buffer_load_dwordx4 v[152:155], v216, s[8:11], s55 offen offset:1536 sc1
  buffer_load_dwordx4 v[156:159], v216, s[8:11], s55 offen offset:1792 sc1
  buffer_load_dwordx4 v[160:163], v217, s[8:11], s55 offen offset:0 sc1
  buffer_load_dwordx4 v[164:167], v217, s[8:11], s55 offen offset:256 sc1
  s_or_b32 s70, s76, 0xc00
  buffer_load_dword v172, off, s[8:11], s70 sc1
  s_add_u32 s60, s60, 73728
  s_add_u32 m0, s67, 36864
  s_nop 0
  buffer_load_dwordx4 v202, s[4:7], s60 offen offset:0 lds
  s_add_u32 m0, s67, 37760
  s_nop 0
  buffer_load_dwordx4 v202, s[4:7], s60 offen offset:128 lds
  s_add_u32 m0, s67, 38656
  s_nop 0
  buffer_load_dwordx4 v202, s[4:7], s60 offen offset:256 lds
  s_add_u32 m0, s67, 39552
  s_nop 0
  buffer_load_dwordx4 v202, s[4:7], s60 offen offset:384 lds
  s_add_u32 m0, s67, 40448
  s_nop 0
  buffer_load_dwordx4 v202, s[4:7], s60 offen offset:512 lds
  s_add_u32 m0, s67, 41344
  s_nop 0
  buffer_load_dwordx4 v202, s[4:7], s60 offen offset:640 lds
  s_add_u32 m0, s67, 42240
  s_nop 0
  buffer_load_dwordx4 v202, s[4:7], s60 offen offset:768 lds
  s_add_u32 m0, s67, 43136
  s_nop 0
  buffer_load_dwordx4 v202, s[4:7], s60 offen offset:896 lds
  s_add_u32 m0, s67, 44032
  s_nop 0
  buffer_load_dwordx4 v202, s[4:7], s60 offen offset:1024 lds
  buffer_store_dwordx4 v[176:179], v201, s[8:11], s72 offen offset:0 sc1
  buffer_store_dwordx4 v[176:179], v201, s[8:11], s72 offen offset:1024 sc1
  ds_read_b128 v[32:35], v203 offset:0
  ds_read_b128 v[36:39], v204 offset:0
  ds_read_b128 v[40:43], v205 offset:0
  s_waitcnt lgkmcnt(2)
  v_mfma_f32_32x32x16_bf16 v[240:255], a[0:3], v[32:35], 0
  ds_read_b128 v[44:47], v206 offset:0
  s_waitcnt lgkmcnt(2)
  v_mfma_f32_32x32x16_bf16 v[240:255], a[4:7], v[36:39], v[240:255]
  ds_read_b128 v[32:35], v203 offset:1024
  s_waitcnt lgkmcnt(2)
  v_mfma_f32_32x32x16_bf16 v[240:255], a[8:11], v[40:43], v[240:255]
  ds_read_b128 v[36:39], v204 offset:1024
  s_waitcnt lgkmcnt(2)
  v_mfma_f32_32x32x16_bf16 v[240:255], a[12:15], v[44:47], v[240:255]
  ds_read_b128 v[40:43], v205 offset:1024
  s_waitcnt lgkmcnt(2)
  v_mfma_f32_32x32x16_bf16 v[240:255], a[16:19], v[32:35], v[240:255]
  ds_read_b128 v[44:47], v206 offset:1024
  s_waitcnt lgkmcnt(2)
  v_mfma_f32_32x32x16_bf16 v[240:255], a[20:23], v[36:39], v[240:255]
  ds_read_b128 v[32:35], v203 offset:2048
  s_waitcnt lgkmcnt(2)
  v_mfma_f32_32x32x16_bf16 v[240:255], a[24:27], v[40:43], v[240:255]
  ds_read_b128 v[36:39], v204 offset:2048
  s_waitcnt lgkmcnt(2)
  v_mfma_f32_32x32x16_bf16 v[240:255], a[28:31], v[44:47], v[240:255]
  ds_read_b128 v[40:43], v205 offset:2048
  s_waitcnt lgkmcnt(2)
  v_mfma_f32_32x32x16_bf16 v[240:255], a[32:35], v[32:35], v[240:255]
  ds_read_b128 v[44:47], v206 offset:2048
  s_waitcnt lgkmcnt(2)
  v_mfma_f32_32x32x16_bf16 v[240:255], a[36:39], v[36:39], v[240:255]
  ds_read_b128 v[32:35], v203 offset:3072
  s_waitcnt lgkmcnt(2)
  v_mfma_f32_32x32x16_bf16 v[240:255], a[40:43], v[40:43], v[240:255]
  ds_read_b128 v[36:39], v204 offset:3072
  s_waitcnt lgkmcnt(2)
  v_mfma_f32_32x32x16_bf16 v[240:255], a[44:47], v[44:47], v[240:255]
  ds_read_b128 v[40:43], v205 offset:3072
  s_waitcnt lgkmcnt(2)
  v_mfma_f32_32x32x16_bf16 v[240:255], a[48:51], v[32:35], v[240:255]
  ds_read_b128 v[44:47], v206 offset:3072
  s_waitcnt lgkmcnt(2)
  v_mfma_f32_32x32x16_bf16 v[240:255], a[52:55], v[36:39], v[240:255]
  ds_read_b128 v[32:35], v203 offset:4096
  s_waitcnt lgkmcnt(2)
  v_mfma_f32_32x32x16_bf16 v[240:255], a[56:59], v[40:43], v[240:255]
  ds_read_b128 v[36:39], v204 offset:4096
  s_waitcnt lgkmcnt(2)
  v_mfma_f32_32x32x16_bf16 v[240:255], a[60:63], v[44:47], v[240:255]
  ds_read_b128 v[40:43], v205 offset:4096
  s_waitcnt lgkmcnt(2)
  v_mfma_f32_32x32x16_bf16 v[240:255], a[64:67], v[32:35], v[240:255]
  ds_read_b128 v[44:47], v206 offset:4096
  s_waitcnt lgkmcnt(2)
  v_mfma_f32_32x32x16_bf16 v[240:255], a[68:71], v[36:39], v[240:255]
  ds_read_b128 v[32:35], v203 offset:5120
  s_waitcnt lgkmcnt(2)
  v_mfma_f32_32x32x16_bf16 v[240:255], a[72:75], v[40:43], v[240:255]
  ds_read_b128 v[36:39], v204 offset:5120
  s_waitcnt lgkmcnt(2)
  v_mfma_f32_32x32x16_bf16 v[240:255], a[76:79], v[44:47], v[240:255]
  ds_read_b128 v[40:43], v205 offset:5120
  s_waitcnt lgkmcnt(2)
  v_mfma_f32_32x32x16_bf16 v[240:255], a[80:83], v[32:35], v[240:255]
  ds_read_b128 v[44:47], v206 offset:5120
  s_waitcnt lgkmcnt(2)
  v_mfma_f32_32x32x16_bf16 v[240:255], a[84:87], v[36:39], v[240:255]
  ds_read_b128 v[32:35], v203 offset:6144
  s_waitcnt lgkmcnt(2)
  v_mfma_f32_32x32x16_bf16 v[240:255], a[88:91], v[40:43], v[240:255]
  ds_read_b128 v[36:39], v204 offset:6144
  s_waitcnt lgkmcnt(2)
  v_mfma_f32_32x32x16_bf16 v[240:255], a[92:95], v[44:47], v[240:255]
  ds_read_b128 v[40:43], v205 offset:6144
  s_waitcnt lgkmcnt(2)
  v_mfma_f32_32x32x16_bf16 v[240:255], a[96:99], v[32:35], v[240:255]
  ds_read_b128 v[44:47], v206 offset:6144
  s_waitcnt lgkmcnt(2)
  v_mfma_f32_32x32x16_bf16 v[240:255], a[100:103], v[36:39], v[240:255]
  ds_read_b128 v[32:35], v203 offset:7168
  s_waitcnt lgkmcnt(2)
  v_mfma_f32_32x32x16_bf16 v[240:255], a[104:107], v[40:43], v[240:255]
  ds_read_b128 v[36:39], v204 offset:7168
  s_waitcnt lgkmcnt(2)
  v_mfma_f32_32x32x16_bf16 v[240:255], a[108:111], v[44:47], v[240:255]
  ds_read_b128 v[40:43], v205 offset:7168
  s_waitcnt lgkmcnt(2)
  v_mfma_f32_32x32x16_bf16 v[240:255], a[112:115], v[32:35], v[240:255]
  ds_read_b128 v[44:47], v206 offset:7168
  s_waitcnt lgkmcnt(2)
  v_mfma_f32_32x32x16_bf16 v[240:255], a[116:119], v[36:39], v[240:255]
  ds_read_b128 v[32:35], v203 offset:8192
  s_waitcnt lgkmcnt(2)
  v_mfma_f32_32x32x16_bf16 v[240:255], a[120:123], v[40:43], v[240:255]
  ds_read_b128 v[36:39], v204 offset:8192
  s_waitcnt lgkmcnt(2)
  v_mfma_f32_32x32x16_bf16 v[240:255], a[124:127], v[44:47], v[240:255]
  ds_read_b128 v[40:43], v205 offset:8192
  s_waitcnt lgkmcnt(2)
  v_mfma_f32_32x32x16_bf16 v[240:255], a[128:131], v[32:35], v[240:255]
  ds_read_b128 v[44:47], v206 offset:8192
  s_waitcnt lgkmcnt(2)
  v_mfma_f32_32x32x16_bf16 v[240:255], a[132:135], v[36:39], v[240:255]
  s_waitcnt lgkmcnt(1)
  v_mfma_f32_32x32x16_bf16 v[240:255], a[136:139], v[40:43], v[240:255]
  s_waitcnt lgkmcnt(0)
  v_mfma_f32_32x32x16_bf16 v[240:255], a[140:143], v[44:47], v[240:255]
  s_nop 11
  v_cvt_pk_bf16_f32 v16, v240, v244
  v_cvt_pk_bf16_f32 v17, v241, v245
  v_cvt_pk_bf16_f32 v18, v242, v246
  v_cvt_pk_bf16_f32 v19, v243, v247
  ds_write_b128 v215, v[16:19] offset:0
  v_cvt_pk_bf16_f32 v20, v248, v252
  v_cvt_pk_bf16_f32 v21, v249, v253
  v_cvt_pk_bf16_f32 v22, v250, v254
  v_cvt_pk_bf16_f32 v23, v251, v255
  ds_write_b128 v215, v[20:23] offset:1024
  s_waitcnt lgkmcnt(0)
  s_barrier
  ds_read_b128 v[96:99], v208 offset:0
  ds_read_b128 v[100:103], v208 offset:1024
  ds_read_b128 v[104:107], v208 offset:2048
  ds_read_b128 v[108:111], v208 offset:3072
  ds_read_b128 v[112:115], v208 offset:4096
  ds_read_b128 v[116:119], v208 offset:5120
  ds_read_b128 v[120:123], v208 offset:6144
  ds_read_b128 v[124:127], v208 offset:7168
  s_waitcnt vmcnt(11)
  v_cmp_eq_u32 vcc, -1, v172
  s_mov_b32 s69, 0
  s_cbranch_vccnz AT_e0
  s_mov_b32 s69, 1
  buffer_load_dwordx4 v[172:175], v201, s[8:11], s76 offen sc1
AT_e0:
  s_waitcnt lgkmcnt(7)
  v_mfma_f32_32x32x16_bf16 v[64:79], v[128:131], v[96:99], v[48:63]
  s_waitcnt lgkmcnt(6)
  v_mfma_f32_32x32x16_bf16 v[64:79], v[132:135], v[100:103], v[64:79]
  s_waitcnt lgkmcnt(5)
  v_mfma_f32_32x32x16_bf16 v[64:79], v[136:139], v[104:107], v[64:79]
  s_waitcnt lgkmcnt(4)
  v_mfma_f32_32x32x16_bf16 v[64:79], v[140:143], v[108:111], v[64:79]
  s_waitcnt lgkmcnt(3)
  v_mfma_f32_32x32x16_bf16 v[64:79], v[144:147], v[112:115], v[64:79]
  s_waitcnt lgkmcnt(2)
  v_mfma_f32_32x32x16_bf16 v[64:79], v[148:151], v[116:119], v[64:79]
  s_waitcnt lgkmcnt(1)
  v_mfma_f32_32x32x16_bf16 v[64:79], v[152:155], v[120:123], v[64:79]
  s_waitcnt lgkmcnt(0)
  v_mfma_f32_32x32x16_bf16 v[64:79], v[156:159], v[124:127], v[64:79]
  s_nop 11
  v_max3_f32 v180, v64, v65, v66
  v_max3_f32 v180, v180, v67, v68
  v_max3_f32 v180, v180, v69, v70
  v_max3_f32 v180, v180, v71, v72
  v_max3_f32 v180, v180, v73, v74
  v_max3_f32 v180, v180, v75, v76
  v_max3_f32 v180, v180, v77, v78
  v_max_f32 v180, v180, v79
  v_mov_b32 v181, v180
  s_nop 1
  v_permlane32_swap_b32 v180, v181
  v_max_f32 v180, v180, v181
  v_sub_f32 v64, v64, v180
  v_sub_f32 v65, v65, v180
  v_sub_f32 v66, v66, v180
  v_sub_f32 v67, v67, v180
  v_sub_f32 v68, v68, v180
  v_sub_f32 v69, v69, v180
  v_sub_f32 v70, v70, v180
  v_sub_f32 v71, v71, v180
  v_sub_f32 v72, v72, v180
  v_sub_f32 v73, v73, v180
  v_sub_f32 v74, v74, v180
  v_sub_f32 v75, v75, v180
  v_sub_f32 v76, v76, v180
  v_sub_f32 v77, v77, v180
  v_sub_f32 v78, v78, v180
  v_sub_f32 v79, v79, v180
  v_exp_f32 v64, v64
  v_exp_f32 v65, v65
  v_exp_f32 v66, v66
  v_exp_f32 v67, v67
  v_exp_f32 v68, v68
  v_exp_f32 v69, v69
  v_exp_f32 v70, v70
  v_exp_f32 v71, v71
  v_exp_f32 v72, v72
  v_exp_f32 v73, v73
  v_exp_f32 v74, v74
  v_exp_f32 v75, v75
  v_exp_f32 v76, v76
  v_exp_f32 v77, v77
  v_exp_f32 v78, v78
  v_exp_f32 v79, v79
  v_cvt_pk_bf16_f32 v20, v64, v65
  v_cvt_pk_bf16_f32 v21, v68, v69
  v_cvt_pk_bf16_f32 v22, v72, v73
  v_cvt_pk_bf16_f32 v23, v76, v77
  v_cvt_pk_bf16_f32 v24, v66, v67
  v_cvt_pk_bf16_f32 v25, v70, v71
  v_cvt_pk_bf16_f32 v26, v74, v75
  v_cvt_pk_bf16_f32 v27, v78, v79
  v_mfma_f32_32x32x16_bf16 v[0:15], v[160:163], v[20:23], 0
  v_add_f32 v182, v64, v65
  v_add_f32 v182, v182, v66
  v_add_f32 v182, v182, v67
  v_add_f32 v182, v182, v68
  v_add_f32 v182, v182, v69
  v_add_f32 v182, v182, v70
  v_add_f32 v182, v182, v71
  v_mfma_f32_32x32x16_bf16 v[0:15], v[164:167], v[24:27], v[0:15]
  v_add_f32 v182, v182, v72
  v_add_f32 v182, v182, v73
  v_add_f32 v182, v182, v74
  v_add_f32 v182, v182, v75
  v_add_f32 v182, v182, v76
  v_add_f32 v182, v182, v77
  v_add_f32 v182, v182, v78
  v_add_f32 v182, v182, v79
AT_l1:
  s_cmp_eq_u32 s69, 1
  s_cbranch_scc1 AT_v1
  s_cmp_ge_u32 s77, 62
  s_cbranch_scc1 AT_k1
  s_branch AT_c1
AT_h1:
  s_sleep 2
AT_c1:
  buffer_load_dword v172, off, s[8:11], s70 sc1
  s_add_u32 s65, s65, 1
  s_cmp_lt_u32 s65, 131072
  s_cselect_b32 s54, -2, -1
  s_waitcnt vmcnt(0)
  v_cmp_lt_u32 vcc, s54, v172
  s_cbranch_vccnz AT_h1
AT_k1:
  buffer_load_dwordx4 v[172:175], v201, s[8:11], s76 offen sc1
AT_v1:
  s_mov_b32 s69, 0
  s_add_u32 s65, s65, 1
  s_cmp_lt_u32 s65, 131072
  s_cselect_b32 s54, -2, -1
  s_waitcnt vmcnt(0)
  ds_write_b64 v220, v[172:173] offset:4096
  ds_write_b64 v221, v[174:175] offset:4096
  v_max3_u32 v213, v172, v173, v174
  v_max_u32 v213, v213, v175
  v_cmp_lt_u32 vcc, s54, v213
  s_cbranch_vccnz AT_k1
  s_waitcnt lgkmcnt(0)
  s_barrier
  ds_read_b128 v[128:131], v218 offset:4096
  ds_read_b128 v[132:135], v218 offset:4352
  ds_read_b128 v[136:139], v218 offset:4608
  ds_read_b128 v[140:143], v218 offset:4864
  ds_read_b128 v[144:147], v218 offset:5120
  ds_read_b128 v[148:151], v218 offset:5376
  ds_read_b128 v[152:155], v218 offset:5632
  ds_read_b128 v[156:159], v218 offset:5888
  ds_read_b32 v168, v219 offset:4096
  ds_read_b32 v169, v219 offset:4224
  s_waitcnt lgkmcnt(9)
  v_mfma_f32_32x32x16_bf16 v[80:95], v[128:131], a[144:147], 0
  s_waitcnt lgkmcnt(8)
  v_mfma_f32_32x32x16_bf16 v[80:95], v[132:135], a[148:151], v[80:95]
  s_waitcnt lgkmcnt(7)
  v_mfma_f32_32x32x16_bf16 v[80:95], v[136:139], a[152:155], v[80:95]
  s_waitcnt lgkmcnt(6)
  v_mfma_f32_32x32x16_bf16 v[80:95], v[140:143], a[156:159], v[80:95]
  s_waitcnt lgkmcnt(5)
  v_mfma_f32_32x32x16_bf16 v[80:95], v[144:147], a[160:163], v[80:95]
  s_waitcnt lgkmcnt(4)
  v_mfma_f32_32x32x16_bf16 v[80:95], v[148:151], a[164:167], v[80:95]
  s_waitcnt lgkmcnt(3)
  v_mfma_f32_32x32x16_bf16 v[80:95], v[152:155], a[168:171], v[80:95]
  s_waitcnt lgkmcnt(2)
  v_mfma_f32_32x32x16_bf16 v[80:95], v[156:159], a[172:175], v[80:95]
  s_add_u32 s77, s77, 2
  v_mov_b32 v212, s77
  s_nop 9
  v_mul_f32 v80, s68, v80
  v_mul_f32 v81, s68, v81
  v_mul_f32 v82, s68, v82
  v_mul_f32 v83, s68, v83
  v_max3_f32 v84, v184, v80, v81
  v_max3_f32 v84, v84, v82, v83
  v_mov_b32 v85, v84
  s_nop 1
  v_permlane32_swap_b32 v84, v85
  v_max_f32 v84, v84, v85
  v_sub_f32 v86, v184, v84
  v_sub_f32 v80, v80, v84
  v_sub_f32 v81, v81, v84
  v_sub_f32 v82, v82, v84
  v_sub_f32 v83, v83, v84
  v_exp_f32 v86, v86
  v_exp_f32 v80, v80
  v_exp_f32 v81, v81
  v_exp_f32 v82, v82
  v_exp_f32 v83, v83
  v_fma_f32 v186, v186, v86, v80
  v_add_f32 v84, v81, v82
  v_add_f32 v186, v186, v83
  v_add_f32 v186, v186, v84
  v_mov_b32 v187, v186
  s_nop 1
  v_permlane32_swap_b32 v186, v187
  v_add_f32 v186, v186, v187
  v_rcp_f32 v186, v186
  s_nop 0
  v_mul_f32 v86, v86, v186
  v_mul_f32 v80, v186, v80
  v_mul_f32 v81, v186, v81
  v_mul_f32 v82, v186, v82
  v_mul_f32 v83, v186, v83
  v_cvt_pk_bf16_f32 v28, v80, v81
  v_cvt_pk_bf16_f32 v29, v82, v83
  v_mul_f32 v224, v86, v224
  v_mul_f32 v225, v86, v225
  v_mul_f32 v226, v86, v226
  v_mul_f32 v227, v86, v227
  v_mul_f32 v228, v86, v228
  v_mul_f32 v229, v86, v229
  v_mul_f32 v230, v86, v230
  v_mul_f32 v231, v86, v231
  v_mul_f32 v232, v86, v232
  v_mul_f32 v233, v86, v233
  v_mul_f32 v234, v86, v234
  v_mul_f32 v235, v86, v235
  v_mul_f32 v236, v86, v236
  v_mul_f32 v237, v86, v237
  v_mul_f32 v238, v86, v238
  v_mul_f32 v239, v86, v239
  s_waitcnt lgkmcnt(0)
  s_nop 0
  v_mfma_f32_32x32x8_bf16 v[224:239], v[168:169], v[28:29], v[224:239]
  s_nop 11
  v_cvt_pk_bf16_f32 v20, v224, v225
  v_cvt_pk_bf16_f32 v21, v226, v227
  v_cvt_pk_bf16_f32 v22, v228, v229
  v_cvt_pk_bf16_f32 v23, v230, v231
  buffer_store_dwordx4 v[20:23], v201, s[8:11], s75 offen offset:0 sc1
  v_cvt_pk_bf16_f32 v24, v232, v233
  v_cvt_pk_bf16_f32 v25, v234, v235
  v_cvt_pk_bf16_f32 v26, v236, v237
  v_cvt_pk_bf16_f32 v27, v238, v239
  buffer_store_dwordx4 v[24:27], v201, s[8:11], s75 offen offset:1024 sc1
  s_mov_b64 exec, 1
  buffer_store_dword v212, v201, s[8:11], s71 offen sc1
  s_mov_b64 exec, -1
  s_cmp_ge_u32 s77, 64
  s_cbranch_scc1 L_exit
  s_branch AT_loop
L_cexit:
L_exit:
L_end:
s_endpgm
.section .rodata,"a"
.p2align 6
.amdhsa_kernel gated_mix__sliding_local_dilated__memory_aug_recurrent_mem_tr__prompt_kernel
  .amdhsa_next_free_vgpr 512
  .amdhsa_next_free_sgpr 102
  .amdhsa_accum_offset 256
  .amdhsa_group_segment_fixed_size 0
  .amdhsa_kernarg_size 112
  .amdhsa_user_sgpr_count 2
  .amdhsa_user_sgpr_kernarg_segment_ptr 1
  .amdhsa_system_sgpr_workgroup_id_x 1
.end_amdhsa_kernel
```

```asm
; @launch grid=(256,1,1) block=(256,1,1) lds=163840
.amdgcn_target "amdgcn-amd-amdhsa--gfx950"
.text
.globl gated_mix__sliding_local_dilated__memory_aug_recurrent_mem_tr__prompt_kernel
.p2align 8
.type gated_mix__sliding_local_dilated__memory_aug_recurrent_mem_tr__prompt_kernel,@function
gated_mix__sliding_local_dilated__memory_aug_recurrent_mem_tr__prompt_kernel:
  s_cmp_ge_u32 s2, 256
  s_cbranch_scc1 L_end
  s_load_dwordx2 s[4:5], s[0:1], 0
  s_load_dwordx2 s[8:9], s[0:1], 104
  s_load_dwordx2 s[12:13], s[0:1], 96
  s_load_dwordx2 s[16:17], s[0:1], 40
  s_load_dwordx2 s[20:21], s[0:1], 48
  s_load_dwordx2 s[24:25], s[0:1], 56
  s_load_dwordx2 s[28:29], s[0:1], 64
  s_load_dwordx2 s[32:33], s[0:1], 32
  s_load_dwordx2 s[36:37], s[0:1], 8
  s_load_dwordx2 s[40:41], s[0:1], 16
  s_load_dwordx2 s[44:45], s[0:1], 80
  s_load_dwordx2 s[48:49], s[0:1], 88
  s_getreg_b32 s54, hwreg(HW_REG_XCC_ID, 0, 3)
  v_lshrrev_b32 v1, 6, v0
  s_nop 0
  v_readfirstlane_b32 s52, v1
  s_mov_b32 s6, 2359296
  s_mov_b32 s7, 0x20000
  s_mov_b32 s10, 268435456
  s_mov_b32 s11, 0x20000
  s_mov_b32 s14, 256
  s_mov_b32 s15, 0x20000
  s_mov_b32 s18, 4718592
  s_mov_b32 s19, 0x20000
  s_mov_b32 s22, 4718592
  s_mov_b32 s23, 0x20000
  s_mov_b32 s26, 4718592
  s_mov_b32 s27, 0x20000
  s_mov_b32 s30, 4718592
  s_mov_b32 s31, 0x20000
  s_mov_b32 s34, 9216
  s_mov_b32 s35, 0x20000
  s_mov_b32 s38, 1990656
  s_mov_b32 s39, 0x20000
  s_mov_b32 s42, 663552
  s_mov_b32 s43, 0x20000
  s_mov_b32 s46, 1152
  s_mov_b32 s47, 0x20000
  s_mov_b32 s50, 2359296
  s_mov_b32 s51, 0x20000
  s_waitcnt lgkmcnt(0)
  s_lshr_b32 s0, s2, 3
  s_mov_b32 s2, s54
  s_mov_b32 s1, 0
  s_lshl_b32 s55, s2, 2
  s_cmp_eq_u32 s52, 0
  s_cselect_b32 s55, s55, 0x1000
  s_lshl_b32 s56, 1, s0
  v_mov_b32 v1, 0
  v_mov_b32 v35, s56
  s_mov_b64 exec, 1
  buffer_atomic_or v35, v1, s[12:15], s55 offen sc0
  s_mov_b64 exec, -1
L_role:
  s_mov_b32 s53, s0
  s_cmp_eq_u32 s2, 0
  s_cbranch_scc0 L_worker
  v_and_b32 v0, 63, v0
  v_and_b32 v1, 15, v0
  v_lshrrev_b32 v2, 4, v0
  v_and_b32 v3, 1, v2
  s_lshl_b32 s54, s52, 1
  v_add_u32 v3, s54, v3
  v_lshlrev_b32 v3, 1, v3
  v_xor_b32 v3, v3, v1
  v_lshlrev_b32 v3, 4, v3
  v_lshl_add_u32 v8, v2, 13, v3
  s_lshl_b32 s78, s53, 8
  s_lshl_b32 s54, s52, 15
  s_add_u32 s78, s78, s54
  s_mul_i32 s79, s53, 147456
  s_lshl_b32 s57, s52, 10
  s_add_u32 s57, s57, 16384
  s_getpc_b64 s[80:81]
L_pc_1:
  s_and_b32 s55, s0, 1
  s_lshl_b32 s55, s55, 2
  s_add_u32 s55, s55, s52
  s_lshl_b32 s55, s55, 10
  v_and_b32 v199, 63, v0
  v_lshl_add_u32 v199, v199, 4, s55
  v_min_u32 v199, (L_w0 - L_pc_1), v199
  global_load_dword v196, v199, s[80:81]
  s_add_u32 m0, s57, 0
  s_add_u32 s54, s78, 524288
  buffer_load_dwordx4 v8, s[16:19], s54 offen  lds
  s_add_u32 m0, s57, 4096
  s_add_u32 s54, s78, 655360
  buffer_load_dwordx4 v8, s[16:19], s54 offen  lds
  s_add_u32 m0, s57, 8192
  s_add_u32 s54, s78, 786432
  buffer_load_dwordx4 v8, s[16:19], s54 offen  lds
  s_add_u32 m0, s57, 12288
  s_add_u32 s54, s78, 917504
  buffer_load_dwordx4 v8, s[16:19], s54 offen  lds
  s_add_u32 m0, s57, 16384
  s_add_u32 s54, s78, 1048576
  buffer_load_dwordx4 v8, s[16:19], s54 offen  lds
  s_add_u32 m0, s57, 20480
  s_add_u32 s54, s78, 1179648
  buffer_load_dwordx4 v8, s[16:19], s54 offen  lds
  s_add_u32 m0, s57, 24576
  s_add_u32 s54, s78, 1310720
  buffer_load_dwordx4 v8, s[16:19], s54 offen  lds
  s_add_u32 m0, s57, 28672
  s_add_u32 s54, s78, 1441792
  buffer_load_dwordx4 v8, s[16:19], s54 offen  lds
  s_add_u32 m0, s57, 32768
  s_add_u32 s54, s78, 1572864
  buffer_load_dwordx4 v8, s[16:19], s54 offen  lds
  s_add_u32 m0, s57, 36864
  s_add_u32 s54, s78, 1703936
  buffer_load_dwordx4 v8, s[16:19], s54 offen  lds
  s_add_u32 m0, s57, 40960
  s_add_u32 s54, s78, 1835008
  buffer_load_dwordx4 v8, s[16:19], s54 offen  lds
  s_add_u32 m0, s57, 45056
  s_add_u32 s54, s78, 1966080
  buffer_load_dwordx4 v8, s[16:19], s54 offen  lds
  s_add_u32 m0, s57, 49152
  s_add_u32 s54, s78, 2097152
  buffer_load_dwordx4 v8, s[16:19], s54 offen  lds
  s_add_u32 m0, s57, 53248
  s_add_u32 s54, s78, 2228224
  buffer_load_dwordx4 v8, s[16:19], s54 offen  lds
  s_add_u32 m0, s57, 57344
  s_add_u32 s54, s78, 2359296
  buffer_load_dwordx4 v8, s[16:19], s54 offen  lds
  s_add_u32 m0, s57, 61440
  s_add_u32 s54, s78, 2490368
  buffer_load_dwordx4 v8, s[16:19], s54 offen  lds
  s_add_u32 m0, s57, 65536
  s_add_u32 s54, s78, 2621440
  buffer_load_dwordx4 v8, s[16:19], s54 offen  lds
  s_add_u32 m0, s57, 69632
  s_add_u32 s54, s78, 2752512
  buffer_load_dwordx4 v8, s[16:19], s54 offen  lds
  s_add_u32 m0, s57, 73728
  s_add_u32 s54, s78, 2883584
  buffer_load_dwordx4 v8, s[16:19], s54 offen  lds
  s_add_u32 m0, s57, 77824
  s_add_u32 s54, s78, 3014656
  buffer_load_dwordx4 v8, s[16:19], s54 offen  lds
  v_lshlrev_b32 v76, 4, v0
  v_add_u32 v75, 0x10000, v76
  v_lshrrev_b32 v3, 2, v1
  v_and_b32 v4, 1, v1
  v_lshl_add_u32 v3, v3, 1, v4
  v_bfe_u32 v4, v1, 1, 1
  v_mul_u32_u24 v74, 0xaaaa, v4
  v_add_u32 v74, 0x4444, v74
  v_mul_u32_u24 v5, 576, v3
  v_add_u32 v5, 0, v5
  v_lshl_add_u32 v78, v2, 4, v5
  v_lshl_add_u32 v77, v2, 5, v5
  v_lshl_add_u32 v77, v4, 4, v77
  v_mul_u32_u24 v15, 1152, v3
  v_lshl_add_u32 v15, v2, 5, v15
  v_lshl_add_u32 v15, v4, 4, v15
  s_lshl_b32 s54, s52, 8
  buffer_load_dwordx4 v[20:23], v15, s[32:35], s54 offen
  buffer_load_dwordx4 v[24:27], v15, s[32:35], s54 offen offset:128
  buffer_load_dwordx4 v[28:31], v15, s[32:35], 0 offen offset:1024
  v_mul_u32_u24 v79, 1152, v2
  v_lshl_add_u32 v79, v1, 2, v79
  s_lshl_b32 s54, s52, 6
  s_add_u32 s54, s54, 0
  v_add_u32 v79, s54, v79
  v_lshrrev_b32 v5, 3, v0
  v_mul_u32_u24 v68, 2176, v5
  v_and_b32 v5, 7, v0
  v_lshl_add_u32 v68, v5, 3, v68
  v_and_b32 v5, 1, v2
  v_lshlrev_b32 v5, 4, v5
  v_lshl_add_u32 v5, v1, 2, v5
  v_mov_b32 v6, 0x40000000
  v_cmp_lt_u32 vcc, 3, v1
  s_nop 1
  v_cndmask_b32 v5, v5, v6, vcc
  v_lshrrev_b32 v6, 1, v2
  v_lshl_add_u32 v69, v6, 10, v5
  v_lshl_add_u32 v70, v6, 8, v5
  v_mov_b32 v71, -1
  ds_write_b128 v76, v[68:71] offset:13824
  v_and_b32 v5, 3, v1
  v_lshrrev_b32 v6, 2, v1
  v_lshl_add_u32 v5, v5, 2, v6
  v_and_b32 v6, 1, v5
  v_lshlrev_b32 v6, 4, v6
  v_mov_b32 v7, 0x3f80
  v_lshlrev_b32 v6, v6, v7
  v_lshrrev_b32 v5, 1, v5
  v_cmp_eq_u32 vcc, 0, v5
  s_nop 1
  v_cndmask_b32 v40, 0, v6, vcc
  v_cmp_eq_u32 vcc, 1, v5
  s_nop 1
  v_cndmask_b32 v41, 0, v6, vcc
  v_cmp_eq_u32 vcc, 2, v5
  s_nop 1
  v_cndmask_b32 v42, 0, v6, vcc
  v_cmp_eq_u32 vcc, 3, v5
  s_nop 1
  v_cndmask_b32 v43, 0, v6, vcc
  ds_write_b128 v76, v[40:43] offset:14848
  s_and_b32 s54, s52, 1
  s_lshr_b32 s55, s52, 1
  v_lshrrev_b32 v3, 3, v0
  v_and_b32 v4, 1, v3
  v_lshlrev_b32 v4, 4, v4
  v_and_b32 v5, 6, v3
  v_add_u32 v4, v4, v5
  s_lshl_b32 s56, s55, 3
  s_add_u32 s56, s56, s54
  v_add_u32 v4, s56, v4
  v_mul_u32_u24 v4, 1152, v4
  v_and_b32 v5, 2, v3
  v_lshlrev_b32 v5, 1, v5
  v_and_b32 v6, 7, v0
  v_xor_b32 v6, v6, v5
  v_lshl_add_u32 v9, v6, 4, v4
  v_and_b32 v4, 1, v2
  v_lshlrev_b32 v4, 4, v4
  v_and_b32 v5, 2, v2
  v_add_u32 v4, v4, v5
  s_lshl_b32 s56, s55, 2
  s_add_u32 s56, s56, s54
  v_add_u32 v4, s56, v4
  v_mul_u32_u24 v4, 1152, v4
  v_lshlrev_b32 v6, 1, v2
  v_xor_b32 v6, v6, v1
  v_lshl_add_u32 v10, v6, 4, v4
  v_bfe_u32 v17, v1, 2, 1
  v_bfe_u32 v18, v1, 3, 1
  v_and_b32 v19, 1, v2
  v_lshrrev_b32 v72, 1, v2
  v_and_b32 v73, 3, v1
  v_lshl_add_u32 v3, v19, 1, v17
  v_lshl_add_u32 v6, v18, 2, v3
  v_lshl_add_u32 v4, v72, 4, v17
  v_lshl_add_u32 v4, v19, 2, v4
  v_lshl_add_u32 v4, v18, 3, v4
  v_lshlrev_b32 v4, 8, v4
  s_lshl_b32 s54, s52, 6
  v_lshl_add_u32 v5, v73, 3, s54
  v_lshlrev_b32 v7, 5, v6
  v_xor_b32 v5, v5, v7
  v_add_u32 v11, v4, v5
  v_xor_b32 v12, 32, v11
  v_lshl_add_u32 v4, v72, 2, v3
  v_lshlrev_b32 v4, 7, v4
  v_lshl_add_u32 v4, v73, 3, v4
  s_and_b32 s54, s52, 1
  v_xor_b32 v7, s54, v19
  v_lshl_add_u32 v7, v7, 1, v18
  v_lshl_add_u32 v13, v7, 5, v4
  v_lshlrev_b32 v4, 11, v72
  v_lshl_add_u32 v4, v73, 3, v4
  v_lshl_add_u32 v5, v3, 8, v4
  v_lshl_add_u32 v7, v18, 2, s52
  v_xor_b32 v7, v7, v3
  v_lshl_add_u32 v14, v7, 5, v5
  s_lshl_b32 s54, s53, 14
  s_lshl_b32 s55, s52, 11
  s_add_u32 s54, s54, 1048576
  s_add_u32 s58, s54, s55
  s_add_u32 s59, s58, 8192
  s_lshl_b32 s55, s52, 12
  s_add_u32 s70, s54, s55
  s_add_u32 s70, s70, 655360
  s_lshl_b32 s54, s53, 12
  s_lshl_b32 s55, s52, 10
  s_add_u32 s54, s54, s55
  s_add_u32 s68, s54, 917504
  s_lshl_b32 s54, s53, 6
  s_mul_i32 s55, s52, 17408
  s_add_u32 s55, s54, s55
  s_add_u32 s73, s55, 0
  s_add_u32 s74, s55, 69632
  s_add_u32 s75, s55, 139264
  s_add_u32 s76, s55, 208896
  s_and_b32 s56, s52, 1
  s_mul_i32 s55, s56, 17408
  s_add_u32 s55, s54, s55
  s_add_u32 s77, s55, 278528
  s_mul_i32 s54, s52, 69632
  s_mul_i32 s55, s53, 2176
  s_add_u32 s54, s54, s55
  s_add_u32 s60, s54, 0
  s_and_b32 s56, s53, 15
  s_mul_i32 s55, s56, 2176
  s_add_u32 s61, s55, 278528
  s_lshl_b32 s54, s52, 11
  s_add_u32 s64, s54, 360448
  s_mov_b32 s65, 368640
  s_lshl_b32 s55, s53, 5
  s_add_u32 s54, s54, s55
  s_add_u32 s62, s54, 376832
  s_lshr_b32 s54, s56, 3
  s_lshl_b32 s54, s54, 9
  s_and_b32 s55, s56, 7
  s_lshl_b32 s55, s55, 5
  s_add_u32 s54, s54, s55
  s_add_u32 s63, s54, 385024
  s_mov_b32 s66, 0
  s_mov_b32 s67, 0
  s_mov_b32 s72, 0
  s_mov_b32 s69, 1040356334
  s_waitcnt vmcnt(19) lgkmcnt(0)
  s_barrier
  s_add_u32 m0, s57, 81920
  s_add_u32 s54, s78, 3145728
  buffer_load_dwordx4 v8, s[16:19], s54 offen  lds
  s_add_u32 m0, s57, 86016
  s_add_u32 s54, s78, 3276800
  buffer_load_dwordx4 v8, s[16:19], s54 offen  lds
  s_add_u32 m0, s57, 90112
  s_add_u32 s54, s78, 3407872
  buffer_load_dwordx4 v8, s[16:19], s54 offen  lds
  s_add_u32 m0, s57, 94208
  s_add_u32 s54, s78, 3538944
  buffer_load_dwordx4 v8, s[16:19], s54 offen  lds
  v_add_u32 v15, 16384, v11
  v_add_u32 v16, 16384, v12
  ds_read_b64_tr_b16 v[80:81], v15 offset:0
  ds_read_b64_tr_b16 v[82:83], v15 offset:512
  ds_read_b64_tr_b16 v[84:85], v15 offset:8192
  ds_read_b64_tr_b16 v[86:87], v15 offset:8704
  ds_read_b64_tr_b16 v[88:89], v16 offset:0
  ds_read_b64_tr_b16 v[90:91], v16 offset:512
  ds_read_b64_tr_b16 v[92:93], v16 offset:8192
  ds_read_b64_tr_b16 v[94:95], v16 offset:8704
  s_waitcnt vmcnt(19) lgkmcnt(0)
  s_barrier
  s_add_u32 m0, s57, 98304
  s_add_u32 s54, s78, 3670016
  buffer_load_dwordx4 v8, s[16:19], s54 offen  lds
  s_add_u32 m0, s57, 102400
  s_add_u32 s54, s78, 3801088
  buffer_load_dwordx4 v8, s[16:19], s54 offen  lds
  s_add_u32 m0, s57, 106496
  s_add_u32 s54, s78, 3932160
  buffer_load_dwordx4 v8, s[16:19], s54 offen  lds
  s_add_u32 m0, s57, 110592
  s_add_u32 s54, s78, 4063232
  buffer_load_dwordx4 v8, s[16:19], s54 offen  lds
  v_add_u32 v15, 32768, v11
  v_add_u32 v16, 32768, v12
  ds_read_b64_tr_b16 v[96:97], v15 offset:0
  ds_read_b64_tr_b16 v[98:99], v15 offset:512
  ds_read_b64_tr_b16 v[100:101], v15 offset:8192
  ds_read_b64_tr_b16 v[102:103], v15 offset:8704
  ds_read_b64_tr_b16 v[104:105], v16 offset:0
  ds_read_b64_tr_b16 v[106:107], v16 offset:512
  ds_read_b64_tr_b16 v[108:109], v16 offset:8192
  ds_read_b64_tr_b16 v[110:111], v16 offset:8704
  s_waitcnt vmcnt(19) lgkmcnt(0)
  s_barrier
  s_add_u32 m0, s57, 114688
  s_add_u32 s54, s78, 4194304
  buffer_load_dwordx4 v8, s[16:19], s54 offen  lds
  s_add_u32 m0, s57, 118784
  s_add_u32 s54, s78, 4325376
  buffer_load_dwordx4 v8, s[16:19], s54 offen  lds
  s_add_u32 m0, s57, 122880
  s_add_u32 s54, s78, 4456448
  buffer_load_dwordx4 v8, s[16:19], s54 offen  lds
  s_add_u32 m0, s57, 126976
  s_add_u32 s54, s78, 4587520
  buffer_load_dwordx4 v8, s[16:19], s54 offen  lds
  v_add_u32 v15, 49152, v11
  v_add_u32 v16, 49152, v12
  ds_read_b64_tr_b16 v[112:113], v15 offset:0
  ds_read_b64_tr_b16 v[114:115], v15 offset:512
  ds_read_b64_tr_b16 v[116:117], v15 offset:8192
  ds_read_b64_tr_b16 v[118:119], v15 offset:8704
  ds_read_b64_tr_b16 v[120:121], v16 offset:0
  ds_read_b64_tr_b16 v[122:123], v16 offset:512
  ds_read_b64_tr_b16 v[124:125], v16 offset:8192
  ds_read_b64_tr_b16 v[126:127], v16 offset:8704
  s_waitcnt vmcnt(19) lgkmcnt(0)
  s_barrier
  s_add_u32 m0, s57, 131072
  s_add_u32 s54, s78, 524288
  buffer_load_dwordx4 v8, s[20:23], s54 offen  lds
  s_add_u32 m0, s57, 135168
  s_add_u32 s54, s78, 655360
  buffer_load_dwordx4 v8, s[20:23], s54 offen  lds
  s_add_u32 m0, s57, 139264
  s_add_u32 s54, s78, 786432
  buffer_load_dwordx4 v8, s[20:23], s54 offen  lds
  s_add_u32 m0, s57, 143360
  s_add_u32 s54, s78, 917504
  buffer_load_dwordx4 v8, s[20:23], s54 offen  lds
  v_add_u32 v15, 65536, v11
  v_add_u32 v16, 65536, v12
  ds_read_b64_tr_b16 v[128:129], v15 offset:0
  ds_read_b64_tr_b16 v[130:131], v15 offset:512
  ds_read_b64_tr_b16 v[132:133], v15 offset:8192
  ds_read_b64_tr_b16 v[134:135], v15 offset:8704
  ds_read_b64_tr_b16 v[136:137], v16 offset:0
  ds_read_b64_tr_b16 v[138:139], v16 offset:512
  ds_read_b64_tr_b16 v[140:141], v16 offset:8192
  ds_read_b64_tr_b16 v[142:143], v16 offset:8704
  s_waitcnt vmcnt(19) lgkmcnt(0)
  s_barrier
  s_add_u32 m0, s57, 0
  s_add_u32 s54, s78, 1572864
  buffer_load_dwordx4 v8, s[20:23], s54 offen  lds
  s_add_u32 m0, s57, 4096
  s_add_u32 s54, s78, 1703936
  buffer_load_dwordx4 v8, s[20:23], s54 offen  lds
  s_add_u32 m0, s57, 8192
  s_add_u32 s54, s78, 1835008
  buffer_load_dwordx4 v8, s[20:23], s54 offen  lds
  s_add_u32 m0, s57, 12288
  s_add_u32 s54, s78, 1966080
  buffer_load_dwordx4 v8, s[20:23], s54 offen  lds
  v_add_u32 v15, 81920, v11
  v_add_u32 v16, 81920, v12
  ds_read_b64_tr_b16 v[144:145], v15 offset:0
  ds_read_b64_tr_b16 v[146:147], v15 offset:512
  ds_read_b64_tr_b16 v[148:149], v15 offset:8192
  ds_read_b64_tr_b16 v[150:151], v15 offset:8704
  ds_read_b64_tr_b16 v[152:153], v16 offset:0
  ds_read_b64_tr_b16 v[154:155], v16 offset:512
  ds_read_b64_tr_b16 v[156:157], v16 offset:8192
  ds_read_b64_tr_b16 v[158:159], v16 offset:8704
  s_waitcnt vmcnt(16) lgkmcnt(0)
  s_barrier
  s_add_u32 m0, s57, 16384
  s_add_u32 s54, s78, 3145728
  buffer_load_dwordx4 v8, s[20:23], s54 offen  lds
  s_add_u32 m0, s57, 20480
  s_add_u32 s54, s78, 3276800
  buffer_load_dwordx4 v8, s[20:23], s54 offen  lds
  s_add_u32 m0, s57, 24576
  s_add_u32 s54, s78, 3407872
  buffer_load_dwordx4 v8, s[20:23], s54 offen  lds
  s_add_u32 m0, s57, 28672
  s_add_u32 s54, s78, 3538944
  buffer_load_dwordx4 v8, s[20:23], s54 offen  lds
  v_add_u32 v15, 98304, v11
  v_add_u32 v16, 98304, v12
  ds_read_b64_tr_b16 v[160:161], v15 offset:0
  ds_read_b64_tr_b16 v[162:163], v15 offset:512
  ds_read_b64_tr_b16 v[164:165], v15 offset:8192
  ds_read_b64_tr_b16 v[166:167], v15 offset:8704
  ds_read_b64_tr_b16 v[168:169], v16 offset:0
  ds_read_b64_tr_b16 v[170:171], v16 offset:512
  ds_read_b64_tr_b16 v[172:173], v16 offset:8192
  ds_read_b64_tr_b16 v[174:175], v16 offset:8704
  s_waitcnt vmcnt(16) lgkmcnt(0)
  s_barrier
  s_add_u32 m0, s57, 32768
  s_add_u32 s54, s78, 3670016
  buffer_load_dwordx4 v8, s[20:23], s54 offen  lds
  s_add_u32 m0, s57, 36864
  s_add_u32 s54, s78, 3801088
  buffer_load_dwordx4 v8, s[20:23], s54 offen  lds
  s_add_u32 m0, s57, 40960
  s_add_u32 s54, s78, 3932160
  buffer_load_dwordx4 v8, s[20:23], s54 offen  lds
  s_add_u32 m0, s57, 45056
  s_add_u32 s54, s78, 4063232
  buffer_load_dwordx4 v8, s[20:23], s54 offen  lds
  s_cmp_eq_u32 s1, 1
  s_cbranch_scc1 C_ver_ok
  v_mov_b32 v33, 16320
  s_cmp_eq_u32 s52, 0
  s_cbranch_scc0 C_ver_b
  s_waitcnt vmcnt(52)
  s_mov_b64 exec, 1
  ds_write_b32 v33, v35
  s_mov_b64 exec, -1
  s_waitcnt lgkmcnt(0)
C_ver_b:
  s_barrier
  ds_read_b32 v32, v33
  s_waitcnt lgkmcnt(0)
  v_readfirstlane_b32 s54, v32
  s_nop 0
  s_bitcmp1_b32 s54, s0
  s_cbranch_scc1 L_conf
C_ver_ok:
  v_add_u32 v15, 114688, v11
  v_add_u32 v16, 114688, v12
  ds_read_b64_tr_b16 v[176:177], v15 offset:0
  ds_read_b64_tr_b16 v[178:179], v15 offset:512
  ds_read_b64_tr_b16 v[180:181], v15 offset:8192
  ds_read_b64_tr_b16 v[182:183], v15 offset:8704
  ds_read_b64_tr_b16 v[184:185], v16 offset:0
  ds_read_b64_tr_b16 v[186:187], v16 offset:512
  ds_read_b64_tr_b16 v[188:189], v16 offset:8192
  ds_read_b64_tr_b16 v[190:191], v16 offset:8704
  s_waitcnt vmcnt(16) lgkmcnt(0)
  s_barrier
  s_add_u32 m0, s57, 49152
  s_add_u32 s54, s78, 4194304
  buffer_load_dwordx4 v8, s[20:23], s54 offen  lds
  s_add_u32 m0, s57, 53248
  s_add_u32 s54, s78, 4325376
  buffer_load_dwordx4 v8, s[20:23], s54 offen  lds
  s_add_u32 m0, s57, 57344
  s_add_u32 s54, s78, 4456448
  buffer_load_dwordx4 v8, s[20:23], s54 offen  lds
  s_add_u32 m0, s57, 61440
  s_add_u32 s54, s78, 4587520
  buffer_load_dwordx4 v8, s[20:23], s54 offen  lds
  v_add_u32 v15, 131072, v11
  v_add_u32 v16, 131072, v12
  ds_read_b64_tr_b16 v[192:193], v15 offset:0
  ds_read_b64_tr_b16 v[194:195], v15 offset:512
  ds_read_b64_tr_b16 v[196:197], v15 offset:8192
  ds_read_b64_tr_b16 v[198:199], v15 offset:8704
  ds_read_b64_tr_b16 v[200:201], v16 offset:0
  ds_read_b64_tr_b16 v[202:203], v16 offset:512
  ds_read_b64_tr_b16 v[204:205], v16 offset:8192
  ds_read_b64_tr_b16 v[206:207], v16 offset:8704
  s_waitcnt vmcnt(16) lgkmcnt(0)
  s_barrier
  s_add_u32 m0, s57, 65536
  s_add_u32 s54, s78, 0
  buffer_load_dwordx4 v8, s[24:27], s54 offen  lds
  s_add_u32 m0, s57, 69632
  s_add_u32 s54, s78, 131072
  buffer_load_dwordx4 v8, s[24:27], s54 offen  lds
  s_add_u32 m0, s57, 73728
  s_add_u32 s54, s78, 262144
  buffer_load_dwordx4 v8, s[24:27], s54 offen  lds
  s_add_u32 m0, s57, 77824
  s_add_u32 s54, s78, 393216
  buffer_load_dwordx4 v8, s[24:27], s54 offen  lds
  s_getpc_b64 s[80:81]
  v_lshlrev_b32 v7, 2, v76
  global_load_dword v35, v7, s[80:81] offset:1024
  v_min_u32 v20, -2, v20
  v_min_u32 v21, -2, v21
  v_min_u32 v22, -2, v22
  v_min_u32 v23, -2, v23
  v_min_u32 v24, -2, v24
  v_min_u32 v25, -2, v25
  v_min_u32 v26, -2, v26
  v_min_u32 v27, -2, v27
  v_min_u32 v28, -2, v28
  v_min_u32 v29, -2, v29
  v_min_u32 v30, -2, v30
  v_min_u32 v31, -2, v31
  s_lshl_b32 s54, s52, 11
  v_add_u32 v3, s54, v76
  ds_write_b128 v3, v[20:23] offset:4608
  ds_write_b128 v3, v[24:27] offset:5632
  ds_write_b128 v76, v[28:31] offset:12800
  v_add_u32 v15, 147456, v11
  v_add_u32 v16, 147456, v12
  ds_read_b64_tr_b16 v[208:209], v15 offset:0
  ds_read_b64_tr_b16 v[210:211], v15 offset:512
  ds_read_b64_tr_b16 v[212:213], v15 offset:8192
  ds_read_b64_tr_b16 v[214:215], v15 offset:8704
  ds_read_b64_tr_b16 v[216:217], v16 offset:0
  ds_read_b64_tr_b16 v[218:219], v16 offset:512
  ds_read_b64_tr_b16 v[220:221], v16 offset:8192
  ds_read_b64_tr_b16 v[222:223], v16 offset:8704
  s_waitcnt vmcnt(17) lgkmcnt(0)
  s_barrier
  s_add_u32 m0, s57, 81920
  s_add_u32 s54, s78, 524288
  buffer_load_dwordx4 v8, s[24:27], s54 offen  lds
  s_add_u32 m0, s57, 86016
  s_add_u32 s54, s78, 655360
  buffer_load_dwordx4 v8, s[24:27], s54 offen  lds
  s_add_u32 m0, s57, 90112
  s_add_u32 s54, s78, 786432
  buffer_load_dwordx4 v8, s[24:27], s54 offen  lds
  s_add_u32 m0, s57, 94208
  s_add_u32 s54, s78, 917504
  buffer_load_dwordx4 v8, s[24:27], s54 offen  lds
  v_add_u32 v15, 16384, v11
  v_add_u32 v16, 16384, v12
  ds_read_b64_tr_b16 v[224:225], v15 offset:0
  ds_read_b64_tr_b16 v[226:227], v15 offset:512
  ds_read_b64_tr_b16 v[228:229], v15 offset:8192
  ds_read_b64_tr_b16 v[230:231], v15 offset:8704
  ds_read_b64_tr_b16 v[232:233], v16 offset:0
  ds_read_b64_tr_b16 v[234:235], v16 offset:512
  ds_read_b64_tr_b16 v[236:237], v16 offset:8192
  ds_read_b64_tr_b16 v[238:239], v16 offset:8704
  s_waitcnt vmcnt(17) lgkmcnt(0)
  s_barrier
  s_add_u32 m0, s57, 98304
  s_add_u32 s54, s78, 1048576
  buffer_load_dwordx4 v8, s[24:27], s54 offen  lds
  s_add_u32 m0, s57, 102400
  s_add_u32 s54, s78, 1179648
  buffer_load_dwordx4 v8, s[24:27], s54 offen  lds
  s_add_u32 m0, s57, 106496
  s_add_u32 s54, s78, 1310720
  buffer_load_dwordx4 v8, s[24:27], s54 offen  lds
  s_add_u32 m0, s57, 110592
  s_add_u32 s54, s78, 1441792
  buffer_load_dwordx4 v8, s[24:27], s54 offen  lds
  v_add_u32 v15, 32768, v11
  v_add_u32 v16, 32768, v12
  ds_read_b64_tr_b16 v[240:241], v15 offset:0
  ds_read_b64_tr_b16 v[242:243], v15 offset:512
  ds_read_b64_tr_b16 v[244:245], v15 offset:8192
  ds_read_b64_tr_b16 v[246:247], v15 offset:8704
  ds_read_b64_tr_b16 v[248:249], v16 offset:0
  ds_read_b64_tr_b16 v[250:251], v16 offset:512
  ds_read_b64_tr_b16 v[252:253], v16 offset:8192
  ds_read_b64_tr_b16 v[254:255], v16 offset:8704
  s_waitcnt vmcnt(17) lgkmcnt(0)
  s_barrier
  s_add_u32 m0, s57, 114688
  s_add_u32 s54, s78, 1572864
  buffer_load_dwordx4 v8, s[24:27], s54 offen  lds
  s_add_u32 m0, s57, 118784
  s_add_u32 s54, s78, 1703936
  buffer_load_dwordx4 v8, s[24:27], s54 offen  lds
  s_add_u32 m0, s57, 122880
  s_add_u32 s54, s78, 1835008
  buffer_load_dwordx4 v8, s[24:27], s54 offen  lds
  s_add_u32 m0, s57, 126976
  s_add_u32 s54, s78, 1966080
  buffer_load_dwordx4 v8, s[24:27], s54 offen  lds
  v_add_u32 v15, 49152, v11
  v_add_u32 v16, 49152, v12
  ds_read_b64_tr_b16 a[0:1], v15 offset:0
  ds_read_b64_tr_b16 a[2:3], v15 offset:512
  ds_read_b64_tr_b16 a[4:5], v15 offset:8192
  ds_read_b64_tr_b16 a[6:7], v15 offset:8704
  ds_read_b64_tr_b16 a[8:9], v16 offset:0
  ds_read_b64_tr_b16 a[10:11], v16 offset:512
  ds_read_b64_tr_b16 a[12:13], v16 offset:8192
  ds_read_b64_tr_b16 a[14:15], v16 offset:8704
  s_waitcnt vmcnt(17) lgkmcnt(0)
  s_barrier
  s_add_u32 m0, s57, 131072
  s_add_u32 s54, s78, 2097152
  buffer_load_dwordx4 v8, s[24:27], s54 offen  lds
  s_add_u32 m0, s57, 135168
  s_add_u32 s54, s78, 2228224
  buffer_load_dwordx4 v8, s[24:27], s54 offen  lds
  s_add_u32 m0, s57, 139264
  s_add_u32 s54, s78, 2359296
  buffer_load_dwordx4 v8, s[24:27], s54 offen  lds
  s_add_u32 m0, s57, 143360
  s_add_u32 s54, s78, 2490368
  buffer_load_dwordx4 v8, s[24:27], s54 offen  lds
  v_add_u32 v15, 65536, v11
  v_add_u32 v16, 65536, v12
  ds_read_b64_tr_b16 a[16:17], v15 offset:0
  ds_read_b64_tr_b16 a[18:19], v15 offset:512
  ds_read_b64_tr_b16 a[20:21], v15 offset:8192
  ds_read_b64_tr_b16 a[22:23], v15 offset:8704
  ds_read_b64_tr_b16 a[24:25], v16 offset:0
  ds_read_b64_tr_b16 a[26:27], v16 offset:512
  ds_read_b64_tr_b16 a[28:29], v16 offset:8192
  ds_read_b64_tr_b16 a[30:31], v16 offset:8704
  s_waitcnt vmcnt(17) lgkmcnt(0)
  s_barrier
  s_add_u32 m0, s57, 0
  s_add_u32 s54, s78, 2621440
  buffer_load_dwordx4 v8, s[24:27], s54 offen  lds
  s_add_u32 m0, s57, 4096
  s_add_u32 s54, s78, 2752512
  buffer_load_dwordx4 v8, s[24:27], s54 offen  lds
  s_add_u32 m0, s57, 8192
  s_add_u32 s54, s78, 2883584
  buffer_load_dwordx4 v8, s[24:27], s54 offen  lds
  s_add_u32 m0, s57, 12288
  s_add_u32 s54, s78, 3014656
  buffer_load_dwordx4 v8, s[24:27], s54 offen  lds
  v_add_u32 v15, 81920, v11
  v_add_u32 v16, 81920, v12
  ds_read_b64_tr_b16 a[32:33], v15 offset:0
  ds_read_b64_tr_b16 a[34:35], v15 offset:512
  ds_read_b64_tr_b16 a[36:37], v15 offset:8192
  ds_read_b64_tr_b16 a[38:39], v15 offset:8704
  ds_read_b64_tr_b16 a[40:41], v16 offset:0
  ds_read_b64_tr_b16 a[42:43], v16 offset:512
  ds_read_b64_tr_b16 a[44:45], v16 offset:8192
  ds_read_b64_tr_b16 a[46:47], v16 offset:8704
  s_waitcnt vmcnt(16) lgkmcnt(0)
  s_barrier
  s_add_u32 m0, s57, 16384
  s_add_u32 s54, s78, 3145728
  buffer_load_dwordx4 v8, s[24:27], s54 offen  lds
  s_add_u32 m0, s57, 20480
  s_add_u32 s54, s78, 3276800
  buffer_load_dwordx4 v8, s[24:27], s54 offen  lds
  s_add_u32 m0, s57, 24576
  s_add_u32 s54, s78, 3407872
  buffer_load_dwordx4 v8, s[24:27], s54 offen  lds
  s_add_u32 m0, s57, 28672
  s_add_u32 s54, s78, 3538944
  buffer_load_dwordx4 v8, s[24:27], s54 offen  lds
  s_getpc_b64 s[80:81]
  v_lshlrev_b32 v7, 2, v76
  global_load_dword v35, v7, s[80:81] offset:1024
  v_add_u32 v15, 98304, v11
  v_add_u32 v16, 98304, v12
  ds_read_b64_tr_b16 a[48:49], v15 offset:0
  ds_read_b64_tr_b16 a[50:51], v15 offset:512
  ds_read_b64_tr_b16 a[52:53], v15 offset:8192
  ds_read_b64_tr_b16 a[54:55], v15 offset:8704
  ds_read_b64_tr_b16 a[56:57], v16 offset:0
  ds_read_b64_tr_b16 a[58:59], v16 offset:512
  ds_read_b64_tr_b16 a[60:61], v16 offset:8192
  ds_read_b64_tr_b16 a[62:63], v16 offset:8704
  s_waitcnt vmcnt(17) lgkmcnt(0)
  s_barrier
  s_add_u32 m0, s57, 32768
  s_add_u32 s54, s78, 3670016
  buffer_load_dwordx4 v8, s[24:27], s54 offen  lds
  s_add_u32 m0, s57, 36864
  s_add_u32 s54, s78, 3801088
  buffer_load_dwordx4 v8, s[24:27], s54 offen  lds
  s_add_u32 m0, s57, 40960
  s_add_u32 s54, s78, 3932160
  buffer_load_dwordx4 v8, s[24:27], s54 offen  lds
  s_add_u32 m0, s57, 45056
  s_add_u32 s54, s78, 4063232
  buffer_load_dwordx4 v8, s[24:27], s54 offen  lds
  v_add_u32 v15, 114688, v11
  v_add_u32 v16, 114688, v12
  ds_read_b64_tr_b16 a[64:65], v15 offset:0
  ds_read_b64_tr_b16 a[66:67], v15 offset:512
  ds_read_b64_tr_b16 a[68:69], v15 offset:8192
  ds_read_b64_tr_b16 a[70:71], v15 offset:8704
  ds_read_b64_tr_b16 a[72:73], v16 offset:0
  ds_read_b64_tr_b16 a[74:75], v16 offset:512
  ds_read_b64_tr_b16 a[76:77], v16 offset:8192
  ds_read_b64_tr_b16 a[78:79], v16 offset:8704
  s_waitcnt vmcnt(17) lgkmcnt(0)
  s_barrier
  s_add_u32 m0, s57, 49152
  s_add_u32 s54, s78, 4194304
  buffer_load_dwordx4 v8, s[24:27], s54 offen  lds
  s_add_u32 m0, s57, 53248
  s_add_u32 s54, s78, 4325376
  buffer_load_dwordx4 v8, s[24:27], s54 offen  lds
  s_add_u32 m0, s57, 57344
  s_add_u32 s54, s78, 4456448
  buffer_load_dwordx4 v8, s[24:27], s54 offen  lds
  s_add_u32 m0, s57, 61440
  s_add_u32 s54, s78, 4587520
  buffer_load_dwordx4 v8, s[24:27], s54 offen  lds
  v_add_u32 v15, 131072, v11
  v_add_u32 v16, 131072, v12
  ds_read_b64_tr_b16 a[80:81], v15 offset:0
  ds_read_b64_tr_b16 a[82:83], v15 offset:512
  ds_read_b64_tr_b16 a[84:85], v15 offset:8192
  ds_read_b64_tr_b16 a[86:87], v15 offset:8704
  ds_read_b64_tr_b16 a[88:89], v16 offset:0
  ds_read_b64_tr_b16 a[90:91], v16 offset:512
  ds_read_b64_tr_b16 a[92:93], v16 offset:8192
  ds_read_b64_tr_b16 a[94:95], v16 offset:8704
  s_waitcnt vmcnt(17) lgkmcnt(0)
  s_barrier
  s_add_u32 m0, s57, 65536
  s_add_u32 s54, s79, 73728
  buffer_load_dwordx4 v10, s[28:31], s54 offen  lds
  s_add_u32 m0, s57, 69632
  s_add_u32 s54, s79, 82944
  buffer_load_dwordx4 v10, s[28:31], s54 offen  lds
  s_add_u32 m0, s57, 73728
  s_add_u32 s54, s79, 110592
  buffer_load_dwordx4 v10, s[28:31], s54 offen  lds
  s_add_u32 m0, s57, 77824
  s_add_u32 s54, s79, 119808
  buffer_load_dwordx4 v10, s[28:31], s54 offen  lds
  v_add_u32 v15, 147456, v11
  v_add_u32 v16, 147456, v12
  ds_read_b64_tr_b16 a[96:97], v15 offset:0
  ds_read_b64_tr_b16 a[98:99], v15 offset:512
  ds_read_b64_tr_b16 a[100:101], v15 offset:8192
  ds_read_b64_tr_b16 a[102:103], v15 offset:8704
  ds_read_b64_tr_b16 a[104:105], v16 offset:0
  ds_read_b64_tr_b16 a[106:107], v16 offset:512
  ds_read_b64_tr_b16 a[108:109], v16 offset:8192
  ds_read_b64_tr_b16 a[110:111], v16 offset:8704
  s_waitcnt vmcnt(17) lgkmcnt(0)
  s_barrier
  s_add_u32 m0, s57, 81920
  s_add_u32 s54, s79, 256
  buffer_load_dwordx4 v10, s[28:31], s54 offen  lds
  s_add_u32 m0, s57, 86016
  s_add_u32 s54, s79, 9472
  buffer_load_dwordx4 v10, s[28:31], s54 offen  lds
  s_add_u32 m0, s57, 90112
  s_add_u32 s54, s79, 37120
  buffer_load_dwordx4 v10, s[28:31], s54 offen  lds
  s_add_u32 m0, s57, 94208
  s_add_u32 s54, s79, 46336
  buffer_load_dwordx4 v10, s[28:31], s54 offen  lds
  v_add_u32 v15, 16384, v11
  v_add_u32 v16, 16384, v12
  ds_read_b64_tr_b16 a[112:113], v15 offset:0
  ds_read_b64_tr_b16 a[114:115], v15 offset:512
  ds_read_b64_tr_b16 a[116:117], v15 offset:8192
  ds_read_b64_tr_b16 a[118:119], v15 offset:8704
  ds_read_b64_tr_b16 a[120:121], v16 offset:0
  ds_read_b64_tr_b16 a[122:123], v16 offset:512
  ds_read_b64_tr_b16 a[124:125], v16 offset:8192
  ds_read_b64_tr_b16 a[126:127], v16 offset:8704
  s_waitcnt vmcnt(17) lgkmcnt(0)
  s_barrier
  s_add_u32 m0, s57, 98304
  s_add_u32 s54, s79, 512
  buffer_load_dwordx4 v10, s[28:31], s54 offen  lds
  s_add_u32 m0, s57, 102400
  s_add_u32 s54, s79, 9728
  buffer_load_dwordx4 v10, s[28:31], s54 offen  lds
  s_add_u32 m0, s57, 106496
  s_add_u32 s54, s79, 37376
  buffer_load_dwordx4 v10, s[28:31], s54 offen  lds
  s_add_u32 m0, s57, 110592
  s_add_u32 s54, s79, 46592
  buffer_load_dwordx4 v10, s[28:31], s54 offen  lds
  v_add_u32 v15, 32768, v11
  v_add_u32 v16, 32768, v12
  ds_read_b64_tr_b16 a[128:129], v15 offset:0
  ds_read_b64_tr_b16 a[130:131], v15 offset:512
  ds_read_b64_tr_b16 a[132:133], v15 offset:8192
  ds_read_b64_tr_b16 a[134:135], v15 offset:8704
  ds_read_b64_tr_b16 a[136:137], v16 offset:0
  ds_read_b64_tr_b16 a[138:139], v16 offset:512
  ds_read_b64_tr_b16 a[140:141], v16 offset:8192
  ds_read_b64_tr_b16 a[142:143], v16 offset:8704
  s_waitcnt vmcnt(16) lgkmcnt(0)
  s_barrier
  s_add_u32 m0, s57, 114688
  s_add_u32 s54, s79, 768
  buffer_load_dwordx4 v10, s[28:31], s54 offen  lds
  s_add_u32 m0, s57, 118784
  s_add_u32 s54, s79, 9984
  buffer_load_dwordx4 v10, s[28:31], s54 offen  lds
  s_add_u32 m0, s57, 122880
  s_add_u32 s54, s79, 37632
  buffer_load_dwordx4 v10, s[28:31], s54 offen  lds
  s_add_u32 m0, s57, 126976
  s_add_u32 s54, s79, 46848
  buffer_load_dwordx4 v10, s[28:31], s54 offen  lds
  s_getpc_b64 s[80:81]
  v_lshlrev_b32 v7, 2, v76
  global_load_dword v35, v7, s[80:81] offset:1024
  v_add_u32 v15, 49152, v11
  v_add_u32 v16, 49152, v12
  ds_read_b64_tr_b16 a[144:145], v15 offset:0
  ds_read_b64_tr_b16 a[146:147], v15 offset:512
  ds_read_b64_tr_b16 a[148:149], v15 offset:8192
  ds_read_b64_tr_b16 a[150:151], v15 offset:8704
  ds_read_b64_tr_b16 a[152:153], v16 offset:0
  ds_read_b64_tr_b16 a[154:155], v16 offset:512
  ds_read_b64_tr_b16 a[156:157], v16 offset:8192
  ds_read_b64_tr_b16 a[158:159], v16 offset:8704
  s_waitcnt vmcnt(17) lgkmcnt(0)
  s_barrier
  s_add_u32 m0, s57, 131072
  s_add_u32 s54, s79, 74496
  buffer_load_dwordx4 v10, s[28:31], s54 offen  lds
  s_add_u32 m0, s57, 135168
  s_add_u32 s54, s79, 83712
  buffer_load_dwordx4 v10, s[28:31], s54 offen  lds
  s_add_u32 m0, s57, 139264
  s_add_u32 s54, s79, 111360
  buffer_load_dwordx4 v10, s[28:31], s54 offen  lds
  s_add_u32 m0, s57, 143360
  s_add_u32 s54, s79, 120576
  buffer_load_dwordx4 v10, s[28:31], s54 offen  lds
  v_add_u32 v15, 65536, v11
  v_add_u32 v16, 65536, v12
  ds_read_b64_tr_b16 a[160:161], v15 offset:0
  ds_read_b64_tr_b16 a[162:163], v15 offset:512
  ds_read_b64_tr_b16 a[164:165], v15 offset:8192
  ds_read_b64_tr_b16 a[166:167], v15 offset:8704
  ds_read_b64_tr_b16 a[168:169], v16 offset:0
  ds_read_b64_tr_b16 a[170:171], v16 offset:512
  ds_read_b64_tr_b16 a[172:173], v16 offset:8192
  ds_read_b64_tr_b16 a[174:175], v16 offset:8704
  s_waitcnt vmcnt(17) lgkmcnt(0)
  s_barrier
  s_add_u32 m0, s57, 0
  s_add_u32 s54, s78, 0
  buffer_load_dwordx4 v8, s[16:19], s54 offen  lds
  s_add_u32 m0, s57, 4096
  s_add_u32 s54, s78, 131072
  buffer_load_dwordx4 v8, s[16:19], s54 offen  lds
  s_add_u32 m0, s57, 8192
  s_add_u32 s54, s78, 262144
  buffer_load_dwordx4 v8, s[16:19], s54 offen  lds
  s_add_u32 m0, s57, 12288
  s_add_u32 s54, s78, 393216
  buffer_load_dwordx4 v8, s[16:19], s54 offen  lds
  v_add_u32 v15, 81920, v14
  ds_read_b64_tr_b16 a[176:177], v15 offset:0
  ds_read_b64_tr_b16 a[178:179], v15 offset:1024
  ds_read_b64_tr_b16 a[180:181], v15 offset:4096
  ds_read_b64_tr_b16 a[182:183], v15 offset:5120
  ds_read_b64_tr_b16 a[184:185], v15 offset:8192
  ds_read_b64_tr_b16 a[186:187], v15 offset:9216
  ds_read_b64_tr_b16 a[188:189], v15 offset:12288
  ds_read_b64_tr_b16 a[190:191], v15 offset:13312
  s_waitcnt vmcnt(17) lgkmcnt(0)
  s_barrier
  s_add_u32 m0, s57, 16384
  s_add_u32 s54, s78, 0
  buffer_load_dwordx4 v8, s[20:23], s54 offen  lds
  s_add_u32 m0, s57, 20480
  s_add_u32 s54, s78, 131072
  buffer_load_dwordx4 v8, s[20:23], s54 offen  lds
  s_add_u32 m0, s57, 24576
  s_add_u32 s54, s78, 262144
  buffer_load_dwordx4 v8, s[20:23], s54 offen  lds
  s_add_u32 m0, s57, 28672
  s_add_u32 s54, s78, 393216
  buffer_load_dwordx4 v8, s[20:23], s54 offen  lds
  v_add_u32 v15, 98304, v14
  ds_read_b64_tr_b16 a[192:193], v15 offset:0
  ds_read_b64_tr_b16 a[194:195], v15 offset:1024
  ds_read_b64_tr_b16 a[196:197], v15 offset:4096
  ds_read_b64_tr_b16 a[198:199], v15 offset:5120
  ds_read_b64_tr_b16 a[200:201], v15 offset:8192
  ds_read_b64_tr_b16 a[202:203], v15 offset:9216
  ds_read_b64_tr_b16 a[204:205], v15 offset:12288
  ds_read_b64_tr_b16 a[206:207], v15 offset:13312
  s_waitcnt vmcnt(17) lgkmcnt(0)
  s_barrier
  s_add_u32 m0, s57, 32768
  s_add_u32 s54, s78, 1048576
  buffer_load_dwordx4 v8, s[20:23], s54 offen  lds
  s_add_u32 m0, s57, 36864
  s_add_u32 s54, s78, 1179648
  buffer_load_dwordx4 v8, s[20:23], s54 offen  lds
  s_add_u32 m0, s57, 40960
  s_add_u32 s54, s78, 1310720
  buffer_load_dwordx4 v8, s[20:23], s54 offen  lds
  s_add_u32 m0, s57, 45056
  s_add_u32 s54, s78, 1441792
  buffer_load_dwordx4 v8, s[20:23], s54 offen  lds
  v_add_u32 v15, 114688, v14
  ds_read_b64_tr_b16 a[208:209], v15 offset:0
  ds_read_b64_tr_b16 a[210:211], v15 offset:1024
  ds_read_b64_tr_b16 a[212:213], v15 offset:4096
  ds_read_b64_tr_b16 a[214:215], v15 offset:5120
  ds_read_b64_tr_b16 a[216:217], v15 offset:8192
  ds_read_b64_tr_b16 a[218:219], v15 offset:9216
  ds_read_b64_tr_b16 a[220:221], v15 offset:12288
  ds_read_b64_tr_b16 a[222:223], v15 offset:13312
  s_waitcnt vmcnt(17) lgkmcnt(0)
  s_barrier
  s_add_u32 m0, s57, 49152
  s_add_u32 s54, s78, 2097152
  buffer_load_dwordx4 v8, s[20:23], s54 offen  lds
  s_add_u32 m0, s57, 53248
  s_add_u32 s54, s78, 2228224
  buffer_load_dwordx4 v8, s[20:23], s54 offen  lds
  s_add_u32 m0, s57, 57344
  s_add_u32 s54, s78, 2359296
  buffer_load_dwordx4 v8, s[20:23], s54 offen  lds
  s_add_u32 m0, s57, 61440
  s_add_u32 s54, s78, 2490368
  buffer_load_dwordx4 v8, s[20:23], s54 offen  lds
  v_add_u32 v15, 131072, v14
  ds_read_b64_tr_b16 a[224:225], v15 offset:0
  ds_read_b64_tr_b16 a[226:227], v15 offset:1024
  ds_read_b64_tr_b16 a[228:229], v15 offset:4096
  ds_read_b64_tr_b16 a[230:231], v15 offset:5120
  ds_read_b64_tr_b16 a[232:233], v15 offset:8192
  ds_read_b64_tr_b16 a[234:235], v15 offset:9216
  ds_read_b64_tr_b16 a[236:237], v15 offset:12288
  ds_read_b64_tr_b16 a[238:239], v15 offset:13312
  s_waitcnt vmcnt(16) lgkmcnt(0)
  s_barrier
  s_add_u32 m0, s57, 65536
  s_add_u32 s54, s78, 2621440
  buffer_load_dwordx4 v8, s[20:23], s54 offen  lds
  s_add_u32 m0, s57, 69632
  s_add_u32 s54, s78, 2752512
  buffer_load_dwordx4 v8, s[20:23], s54 offen  lds
  s_add_u32 m0, s57, 73728
  s_add_u32 s54, s78, 2883584
  buffer_load_dwordx4 v8, s[20:23], s54 offen  lds
  s_add_u32 m0, s57, 77824
  s_add_u32 s54, s78, 3014656
  buffer_load_dwordx4 v8, s[20:23], s54 offen  lds
  v_add_u32 v15, 147456, v14
  ds_read_b64_tr_b16 a[240:241], v15 offset:0
  ds_read_b64_tr_b16 a[242:243], v15 offset:1024
  ds_read_b64_tr_b16 a[244:245], v15 offset:4096
  ds_read_b64_tr_b16 a[246:247], v15 offset:5120
  ds_read_b64_tr_b16 a[248:249], v15 offset:8192
  ds_read_b64_tr_b16 a[250:251], v15 offset:9216
  ds_read_b64_tr_b16 a[252:253], v15 offset:12288
  ds_read_b64_tr_b16 a[254:255], v15 offset:13312
  s_waitcnt vmcnt(16) lgkmcnt(0)
  s_barrier
  s_add_u32 m0, s57, 81920
  s_add_u32 s54, s79, 1024
  buffer_load_dwordx4 v9, s[28:31], s54 offen  lds
  s_add_u32 m0, s57, 86016
  s_add_u32 s54, s79, 37888
  buffer_load_dwordx4 v9, s[28:31], s54 offen  lds
  s_add_u32 m0, s57, 90112
  s_add_u32 s54, s79, 74752
  buffer_load_dwordx4 v9, s[28:31], s54 offen  lds
  s_add_u32 m0, s57, 94208
  s_add_u32 s54, s79, 111616
  buffer_load_dwordx4 v9, s[28:31], s54 offen  lds
  v_add_u32 v15, 16384, v11
  v_add_u32 v16, 16384, v12
  ds_read_b64_tr_b16 v[52:53], v15 offset:0
  ds_read_b64_tr_b16 v[54:55], v15 offset:512
  ds_read_b64_tr_b16 v[56:57], v15 offset:8192
  ds_read_b64_tr_b16 v[58:59], v15 offset:8704
  ds_read_b64_tr_b16 v[60:61], v16 offset:0
  ds_read_b64_tr_b16 v[62:63], v16 offset:512
  ds_read_b64_tr_b16 v[64:65], v16 offset:8192
  ds_read_b64_tr_b16 v[66:67], v16 offset:8704
  s_waitcnt vmcnt(16) lgkmcnt(0)
  s_barrier
  s_lshl_b32 s54, s52, 12
  s_add_u32 s54, s54, 16384
  v_add_u32 v7, s54, v76
  ds_write_b128 v7, v[52:55] offset:0
  ds_write_b128 v7, v[56:59] offset:1024
  ds_write_b128 v7, v[60:63] offset:2048
  ds_write_b128 v7, v[64:67] offset:3072
  s_add_u32 m0, s57, 98304
  s_add_u32 s54, s79, 0
  buffer_load_dwordx4 v10, s[28:31], s54 offen  lds
  s_add_u32 m0, s57, 102400
  s_add_u32 s54, s79, 9216
  buffer_load_dwordx4 v10, s[28:31], s54 offen  lds
  s_add_u32 m0, s57, 106496
  s_add_u32 s54, s79, 36864
  buffer_load_dwordx4 v10, s[28:31], s54 offen  lds
  s_add_u32 m0, s57, 110592
  s_add_u32 s54, s79, 46080
  buffer_load_dwordx4 v10, s[28:31], s54 offen  lds
  v_add_u32 v15, 32768, v11
  v_add_u32 v16, 32768, v12
  ds_read_b64_tr_b16 v[36:37], v15 offset:0
  ds_read_b64_tr_b16 v[38:39], v15 offset:512
  ds_read_b64_tr_b16 v[40:41], v15 offset:8192
  ds_read_b64_tr_b16 v[42:43], v15 offset:8704
  ds_read_b64_tr_b16 v[44:45], v16 offset:0
  ds_read_b64_tr_b16 v[46:47], v16 offset:512
  ds_read_b64_tr_b16 v[48:49], v16 offset:8192
  ds_read_b64_tr_b16 v[50:51], v16 offset:8704
  s_waitcnt vmcnt(16) lgkmcnt(0)
  s_barrier
  s_lshl_b32 s54, s52, 12
  s_add_u32 s54, s54, 32768
  v_add_u32 v7, s54, v76
  ds_write_b128 v7, v[36:39] offset:0
  ds_write_b128 v7, v[40:43] offset:1024
  ds_write_b128 v7, v[44:47] offset:2048
  ds_write_b128 v7, v[48:51] offset:3072
  s_add_u32 m0, s57, 114688
  s_add_u32 s54, s79, 73984
  buffer_load_dwordx4 v10, s[28:31], s54 offen  lds
  s_add_u32 m0, s57, 118784
  s_add_u32 s54, s79, 83200
  buffer_load_dwordx4 v10, s[28:31], s54 offen  lds
  s_add_u32 m0, s57, 122880
  s_add_u32 s54, s79, 110848
  buffer_load_dwordx4 v10, s[28:31], s54 offen  lds
  s_add_u32 m0, s57, 126976
  s_add_u32 s54, s79, 120064
  buffer_load_dwordx4 v10, s[28:31], s54 offen  lds
  v_add_u32 v15, 49152, v11
  v_add_u32 v16, 49152, v12
  ds_read_b64_tr_b16 v[52:53], v15 offset:0
  ds_read_b64_tr_b16 v[54:55], v15 offset:512
  ds_read_b64_tr_b16 v[56:57], v15 offset:8192
  ds_read_b64_tr_b16 v[58:59], v15 offset:8704
  ds_read_b64_tr_b16 v[60:61], v16 offset:0
  ds_read_b64_tr_b16 v[62:63], v16 offset:512
  ds_read_b64_tr_b16 v[64:65], v16 offset:8192
  ds_read_b64_tr_b16 v[66:67], v16 offset:8704
  s_waitcnt vmcnt(16) lgkmcnt(0)
  s_barrier
  s_lshl_b32 s54, s52, 12
  s_add_u32 s54, s54, 49152
  v_add_u32 v7, s54, v76
  ds_write_b128 v7, v[52:55] offset:0
  ds_write_b128 v7, v[56:59] offset:1024
  ds_write_b128 v7, v[60:63] offset:2048
  ds_write_b128 v7, v[64:67] offset:3072
  s_add_u32 m0, s57, 131072
  s_add_u32 s54, s79, 74240
  buffer_load_dwordx4 v10, s[28:31], s54 offen  lds
  s_add_u32 m0, s57, 135168
  s_add_u32 s54, s79, 83456
  buffer_load_dwordx4 v10, s[28:31], s54 offen  lds
  s_add_u32 m0, s57, 139264
  s_add_u32 s54, s79, 111104
  buffer_load_dwordx4 v10, s[28:31], s54 offen  lds
  s_add_u32 m0, s57, 143360
  s_add_u32 s54, s79, 120320
  buffer_load_dwordx4 v10, s[28:31], s54 offen  lds
  v_lshlrev_b32 v7, 3, v76
  s_lshl_b32 s54, s52, 13
  s_add_u32 s54, s54, 360448
  s_bitcmp1_b32 s52, 0
  s_cselect_b64 exec, 0xff, -1
  buffer_load_dword v35, v7, s[8:11], s54 offen sc1
  s_mov_b64 exec, -1
  s_getpc_b64 s[80:81]
C_pc:
  s_mov_b32 s55, (L_w0 - C_pc)
  s_cmp_eq_u32 s52, 1
  s_cselect_b32 s55, (L_w1 - C_pc), s55
  s_cmp_eq_u32 s52, 2
  s_cselect_b32 s55, (L_w2 - C_pc), s55
  s_cmp_eq_u32 s52, 3
  s_cselect_b32 s55, (L_w3 - C_pc), s55
  v_lshl_add_u32 v7, v76, 3, s55
  global_load_dword v35, v7, s[80:81]
  v_add_u32 v15, 65536, v11
  v_add_u32 v16, 65536, v12
  ds_read_b64_tr_b16 v[36:37], v15 offset:0
  ds_read_b64_tr_b16 v[38:39], v15 offset:512
  ds_read_b64_tr_b16 v[40:41], v15 offset:8192
  ds_read_b64_tr_b16 v[42:43], v15 offset:8704
  ds_read_b64_tr_b16 v[44:45], v16 offset:0
  ds_read_b64_tr_b16 v[46:47], v16 offset:512
  ds_read_b64_tr_b16 v[48:49], v16 offset:8192
  ds_read_b64_tr_b16 v[50:51], v16 offset:8704
  s_waitcnt vmcnt(18) lgkmcnt(0)
  s_barrier
  s_lshl_b32 s54, s52, 12
  s_add_u32 s54, s54, 65536
  v_add_u32 v7, s54, v76
  ds_write_b128 v7, v[36:39] offset:0
  ds_write_b128 v7, v[40:43] offset:1024
  ds_write_b128 v7, v[44:47] offset:2048
  ds_write_b128 v7, v[48:51] offset:3072
  v_lshrrev_b32 v20, 2, v76
  buffer_load_dword v21, v20, s[12:15], 0 offen sc1
  v_add_u32 v15, 81920, v11
  v_add_u32 v16, 81920, v12
  ds_read_b64_tr_b16 v[52:53], v15 offset:0
  ds_read_b64_tr_b16 v[54:55], v15 offset:512
  ds_read_b64_tr_b16 v[56:57], v15 offset:8192
  ds_read_b64_tr_b16 v[58:59], v15 offset:8704
  ds_read_b64_tr_b16 v[60:61], v16 offset:0
  ds_read_b64_tr_b16 v[62:63], v16 offset:512
  ds_read_b64_tr_b16 v[64:65], v16 offset:8192
  ds_read_b64_tr_b16 v[66:67], v16 offset:8704
  s_waitcnt vmcnt(15) lgkmcnt(0)
  s_barrier
  s_lshl_b32 s54, s52, 12
  s_add_u32 s54, s54, 81920
  v_add_u32 v7, s54, v76
  ds_write_b128 v7, v[52:55] offset:0
  ds_write_b128 v7, v[56:59] offset:1024
  ds_write_b128 v7, v[60:63] offset:2048
  ds_write_b128 v7, v[64:67] offset:3072
  v_add_u32 v15, 98304, v13
  s_waitcnt lgkmcnt(0)
  ds_read_b64_tr_b16 v[36:37], v15 offset:0
  ds_read_b64_tr_b16 v[38:39], v15 offset:1024
  ds_read_b64_tr_b16 v[40:41], v15 offset:2048
  ds_read_b64_tr_b16 v[42:43], v15 offset:3072
  ds_read_b64_tr_b16 v[44:45], v15 offset:4096
  ds_read_b64_tr_b16 v[46:47], v15 offset:5120
  ds_read_b64_tr_b16 v[48:49], v15 offset:6144
  ds_read_b64_tr_b16 v[50:51], v15 offset:7168
  ds_read_b64_tr_b16 v[52:53], v15 offset:8192
  ds_read_b64_tr_b16 v[54:55], v15 offset:9216
  ds_read_b64_tr_b16 v[56:57], v15 offset:10240
  ds_read_b64_tr_b16 v[58:59], v15 offset:11264
  ds_read_b64_tr_b16 v[60:61], v15 offset:12288
  ds_read_b64_tr_b16 v[62:63], v15 offset:13312
  ds_read_b64_tr_b16 v[64:65], v15 offset:14336
  ds_read_b64_tr_b16 v[66:67], v15 offset:15360
  s_waitcnt vmcnt(11) lgkmcnt(0)
  s_barrier
  s_and_b32 s54, s52, 1
  s_lshl_b32 s54, s54, 13
  s_add_u32 s54, s54, 98304
  v_add_u32 v7, s54, v76
  ds_write_b128 v7, v[36:39] offset:0
  ds_write_b128 v7, v[40:43] offset:1024
  ds_write_b128 v7, v[44:47] offset:2048
  ds_write_b128 v7, v[48:51] offset:3072
  ds_write_b128 v7, v[52:55] offset:4096
  ds_write_b128 v7, v[56:59] offset:5120
  ds_write_b128 v7, v[60:63] offset:6144
  ds_write_b128 v7, v[64:67] offset:7168
  v_add_u32 v15, 114688, v14
  ds_read_b64_tr_b16 v[52:53], v15 offset:0
  ds_read_b64_tr_b16 v[54:55], v15 offset:1024
  ds_read_b64_tr_b16 v[56:57], v15 offset:4096
  ds_read_b64_tr_b16 v[58:59], v15 offset:5120
  ds_read_b64_tr_b16 v[60:61], v15 offset:8192
  ds_read_b64_tr_b16 v[62:63], v15 offset:9216
  ds_read_b64_tr_b16 v[64:65], v15 offset:12288
  ds_read_b64_tr_b16 v[66:67], v15 offset:13312
  s_waitcnt vmcnt(7) lgkmcnt(0)
  s_barrier
  s_lshl_b32 s54, s52, 12
  s_add_u32 s54, s54, 114688
  v_add_u32 v7, s54, v76
  ds_write_b128 v7, v[52:55] offset:0
  ds_write_b128 v7, v[56:59] offset:1024
  ds_write_b128 v7, v[60:63] offset:2048
  ds_write_b128 v7, v[64:67] offset:3072
  v_add_u32 v15, 131072, v14
  ds_read_b64_tr_b16 v[36:37], v15 offset:0
  ds_read_b64_tr_b16 v[38:39], v15 offset:1024
  ds_read_b64_tr_b16 v[40:41], v15 offset:4096
  ds_read_b64_tr_b16 v[42:43], v15 offset:5120
  ds_read_b64_tr_b16 v[44:45], v15 offset:8192
  ds_read_b64_tr_b16 v[46:47], v15 offset:9216
  ds_read_b64_tr_b16 v[48:49], v15 offset:12288
  ds_read_b64_tr_b16 v[50:51], v15 offset:13312
  s_waitcnt vmcnt(3) lgkmcnt(0)
  s_barrier
  s_lshl_b32 s54, s52, 12
  s_add_u32 s54, s54, 131072
  v_add_u32 v7, s54, v76
  ds_write_b128 v7, v[36:39] offset:0
  ds_write_b128 v7, v[40:43] offset:1024
  ds_write_b128 v7, v[44:47] offset:2048
  ds_write_b128 v7, v[48:51] offset:3072
  v_add_u32 v15, 147456, v14
  ds_read_b64_tr_b16 v[52:53], v15 offset:0
  ds_read_b64_tr_b16 v[54:55], v15 offset:1024
  ds_read_b64_tr_b16 v[56:57], v15 offset:4096
  ds_read_b64_tr_b16 v[58:59], v15 offset:5120
  ds_read_b64_tr_b16 v[60:61], v15 offset:8192
  ds_read_b64_tr_b16 v[62:63], v15 offset:9216
  ds_read_b64_tr_b16 v[64:65], v15 offset:12288
  ds_read_b64_tr_b16 v[66:67], v15 offset:13312
  s_waitcnt vmcnt(0) lgkmcnt(0)
  s_barrier
  s_lshl_b32 s54, s52, 12
  s_add_u32 s54, s54, 147456
  v_add_u32 v7, s54, v76
  ds_write_b128 v7, v[52:55] offset:0
  ds_write_b128 v7, v[56:59] offset:1024
  ds_write_b128 v7, v[60:63] offset:2048
  ds_write_b128 v7, v[64:67] offset:3072
  s_waitcnt lgkmcnt(0)
  s_branch C_rd1
C_rd0:
  s_sleep 2
  buffer_load_dword v21, v20, s[12:15], 0 offen sc1
  s_waitcnt vmcnt(0)
C_rd1:
  v_and_b32 v22, 0xff, v21
  v_cmp_gt_u32 vcc, 7, v22
  v_readlane_b32 s56, v21, 0
  s_mov_b32 s3, 1
  s_add_u32 s67, s67, 1
  s_cmp_ge_u32 s67, 131072
  s_cbranch_scc1 C_rd2
  s_cmp_lg_u32 vcc_hi, 0
  s_cbranch_scc1 C_rd0
  s_mov_b32 s3, 0
  s_cmp_eq_u32 s56, -1
  s_cbranch_scc1 C_rd2
  s_mov_b32 s3, 1
  v_readlane_b32 s54, v21, 10
  v_readlane_b32 s55, v21, 0
  s_nop 0
  s_bcnt1_i32_b32 s55, s55
  s_add_u32 s54, s54, s55
  v_readlane_b32 s55, v21, 1
  s_nop 0
  s_bcnt1_i32_b32 s55, s55
  s_add_u32 s54, s54, s55
  v_readlane_b32 s55, v21, 2
  s_nop 0
  s_bcnt1_i32_b32 s55, s55
  s_add_u32 s54, s54, s55
  v_readlane_b32 s55, v21, 3
  s_nop 0
  s_bcnt1_i32_b32 s55, s55
  s_add_u32 s54, s54, s55
  v_readlane_b32 s55, v21, 4
  s_nop 0
  s_bcnt1_i32_b32 s55, s55
  s_add_u32 s54, s54, s55
  v_readlane_b32 s55, v21, 5
  s_nop 0
  s_bcnt1_i32_b32 s55, s55
  s_add_u32 s54, s54, s55
  v_readlane_b32 s55, v21, 6
  s_nop 0
  s_bcnt1_i32_b32 s55, s55
  s_add_u32 s54, s54, s55
  v_readlane_b32 s55, v21, 7
  s_nop 0
  s_bcnt1_i32_b32 s55, s55
  s_add_u32 s54, s54, s55
  s_cmp_lt_u32 s54, 256
  s_cbranch_scc1 C_rd0
C_rd2:
  s_lshl_b32 s54, s3, 2
  s_add_u32 s54, s54, s52
  s_cmp_eq_u32 s54, 1
  s_cbranch_scc1 L_w1
  s_cmp_eq_u32 s54, 2
  s_cbranch_scc1 L_w2
  s_cmp_eq_u32 s54, 3
  s_cbranch_scc1 L_w3
  s_cmp_eq_u32 s54, 4
  s_cbranch_scc1 L_w4
  s_cmp_eq_u32 s54, 5
  s_cbranch_scc1 L_w5
  s_cmp_eq_u32 s54, 6
  s_cbranch_scc1 L_w6
  s_cmp_eq_u32 s54, 7
  s_cbranch_scc1 L_w7
L_w0:
  v_mov_b64 v[20:21], 0
  v_mov_b64 v[22:23], 0
  v_mov_b64 v[24:25], 0
  v_mov_b64 v[26:27], 0
  v_mov_b64 v[28:29], 0
  v_mov_b64 v[30:31], 0
  v_mov_b64 v[32:33], 0
  v_mov_b64 v[34:35], 0
  s_mov_b32 s78, 0x3f803f80
  s_mov_b32 s79, s78
  s_mov_b32 s65, 360448
  s_mov_b32 m0, 15872
  s_lshl_b32 s71, s53, 2
  s_add_u32 s71, s71, 128
  s_movk_i32 s56, 0x1000
  v_lshlrev_b32 v73, 2, v76
  v_mov_b32 v72, 0
  s_mov_b64 s[16:17], s[8:9]
  s_mov_b32 s18, 268435456
  s_mov_b32 s19, 0x20000
  s_getpc_b64 s[20:21]
Cf0_pc:
  s_add_u32 s20, s20, (Cf0_last - Cf0_pc)
  s_addc_u32 s21, s21, 0
  buffer_load_dwordx4 v[52:55], v76, s[8:11], s59 offen offset:0 sc1
  buffer_load_dwordx4 v[56:59], v76, s[8:11], s59 offen offset:1024 sc1
  ds_read_b128 v[60:63], v76 offset:16384
  ds_read_b128 v[64:67], v76 offset:17408
  ds_read_b128 v[44:47], v76 offset:18432
  ds_read_b128 v[48:51], v76 offset:19456
  ds_read_b128 v[36:39], v76 offset:32768
  ds_read_b128 v[40:43], v76 offset:33792
  ds_read_b128 v[0:3], v76 offset:4608
  ds_read_b128 v[4:7], v76 offset:5632
  s_waitcnt lgkmcnt(0)
  s_branch Cf0_top2
.p2align 6
Cf0_h2:
  v_lshlrev_b32 v73, 2, v76
  s_mov_b32 m0, 8704
  s_add_u32 s55, s65, 4096
  s_nop 15
  s_nop 11
  buffer_load_dwordx4 v[0:3], v76, s[8:11], s65 offen offset:0 sc1
  buffer_load_dwordx4 v[4:7], v76, s[8:11], s65 offen offset:1024 sc1
  s_nop 15
  s_nop 3
  buffer_load_dwordx4 v[0:3], v76, s[8:11], s65 offen offset:0 sc1
  buffer_load_dwordx4 v[4:7], v76, s[8:11], s65 offen offset:1024 sc1
  s_nop 15
  s_nop 3
  buffer_load_dwordx4 v[0:3], v76, s[8:11], s65 offen offset:0 sc1
  buffer_load_dwordx4 v[4:7], v76, s[8:11], s65 offen offset:1024 sc1
  s_waitcnt vmcnt(8)
  ds_read_b128 v[60:63], v76 offset:16384
  ds_read_b128 v[64:67], v76 offset:17408
  ds_read_b128 v[44:47], v76 offset:18432
  ds_read_b128 v[48:51], v76 offset:19456
  ds_read_b128 v[36:39], v76 offset:32768
  ds_read_b128 v[40:43], v76 offset:33792
  buffer_load_dwordx4 v[52:55], v76, s[8:11], s59 offen offset:0 sc1
  buffer_load_dwordx4 v[56:59], v76, s[8:11], s59 offen offset:1024 sc1
  s_waitcnt vmcnt(6)
  v_max3_u32 v72, v0, v1, v2
  v_max3_u32 v72, v72, v3, v4
  v_max3_u32 v72, v72, v5, v6
  v_max_u32 v72, v72, v7
  ds_write_b128 v76, v[0:3] offset:4608
  ds_write_b128 v76, v[4:7] offset:5632
  v_cmp_eq_u32 vcc, -1, v72
  s_cbranch_vccnz Cf0_h2r
Cf0_h2w:
  s_cmp_eq_u32 s66, 63
  s_waitcnt lgkmcnt(0)
  s_barrier
  buffer_load_dwordx4 v76, s[8:11], s55 offen offset:0 sc1 lds
  buffer_load_dwordx4 v76, s[8:11], s55 offen offset:1024 sc1 lds
  buffer_load_dwordx4 v76, s[8:11], s55 offen offset:2048 sc1 lds
  buffer_load_dwordx4 v76, s[8:11], s55 offen offset:3072 sc1 lds
  s_cbranch_scc1 Cf0_last
Cf0_top2:
  ds_read_b128 v[8:11], v76 offset:6656
  s_mov_b32 m0, 15872
  v_smfmac_f32_16x16x64_bf16 v[20:23], v[0:3], v[60:67], v74
  ds_read_b128 v[60:63], v76 offset:34816
  v_smfmac_f32_16x16x64_bf16 v[24:27], v[0:3], v[44:51], v74
  buffer_load_dwordx4 v[44:47], v76, s[8:11], s58 offen offset:0 sc1
  ds_read_b128 v[64:67], v76 offset:35840
  v_smfmac_f32_16x16x64_bf16 v[20:23], v[4:7], v[80:87], v74
  buffer_load_dwordx4 v[48:51], v76, s[8:11], s58 offen offset:1024 sc1
  v_smfmac_f32_16x16x64_bf16 v[28:31], v[0:3], v[36:43], v74
  ds_read_b128 v[36:39], v76 offset:49152
  v_smfmac_f32_16x16x64_bf16 v[24:27], v[4:7], v[88:95], v74
  ds_read_b128 v[40:43], v76 offset:50176
  s_waitcnt lgkmcnt(4)
  v_smfmac_f32_16x16x64_bf16 v[28:31], v[4:7], v[208:215], v74
  ds_read_b128 v[12:15], v76 offset:7680
  v_smfmac_f32_16x16x64_bf16 v[32:35], v[4:7], v[216:223], v74
  buffer_store_dwordx4 v[16:19], v76, s[8:11], s68 offen sc1
  s_waitcnt lgkmcnt(3)
  v_smfmac_f32_16x16x64_bf16 v[32:35], v[0:3], v[60:67], v74
  buffer_load_dword v73, s[16:19], s70 offen  lds
  v_smfmac_f32_16x16x64_bf16 v[20:23], v[8:11], v[96:103], v74
  ds_read_b128 v[60:63], v76 offset:51200
  v_smfmac_f32_16x16x64_bf16 v[24:27], v[8:11], v[104:111], v74
  ds_read_b128 v[64:67], v76 offset:52224
  s_waitcnt lgkmcnt(3)
  v_smfmac_f32_16x16x64_bf16 v[28:31], v[8:11], v[36:43], v74
  ds_read_b128 v[36:39], v75 offset:0
  s_waitcnt lgkmcnt(3)
  v_smfmac_f32_16x16x64_bf16 v[20:23], v[12:15], v[112:119], v74
  ds_read_b128 v[40:43], v75 offset:1024
  v_smfmac_f32_16x16x64_bf16 v[24:27], v[12:15], v[120:127], v74
  s_waitcnt vmcnt(4)
  v_smfmac_f32_16x16x64_bf16 v[28:31], v[12:15], v[224:231], v74
  s_barrier
  ds_read_b128 v[0:3], v76 offset:8704
  v_smfmac_f32_16x16x64_bf16 v[32:35], v[12:15], v[232:239], v74
  ds_read_b128 v[4:7], v76 offset:9728
  s_waitcnt lgkmcnt(4)
  v_smfmac_f32_16x16x64_bf16 v[32:35], v[8:11], v[60:67], v74
  ds_read_b128 v[60:63], v75 offset:2048
  s_waitcnt lgkmcnt(2)
  v_smfmac_f32_16x16x64_bf16 v[20:23], v[0:3], v[128:135], v74
  ds_read_b128 v[16:19], v76 offset:10752
  v_smfmac_f32_16x16x64_bf16 v[24:27], v[0:3], v[136:143], v74
  ds_read_b128 v[64:67], v75 offset:3072
  v_smfmac_f32_16x16x64_bf16 v[28:31], v[0:3], v[36:43], v74
  ds_read_b128 v[36:39], v75 offset:16384
  s_waitcnt lgkmcnt(4)
  v_smfmac_f32_16x16x64_bf16 v[20:23], v[4:7], v[144:151], v74
  ds_read_b128 v[12:15], v76 offset:11776
  v_smfmac_f32_16x16x64_bf16 v[24:27], v[4:7], v[152:159], v74
  ds_read_b128 v[40:43], v75 offset:17408
  s_waitcnt lgkmcnt(4)
  v_smfmac_f32_16x16x64_bf16 v[20:23], v[16:19], v[160:167], v74
  ds_read_b128 v[8:11], v76 offset:12800
  s_waitcnt lgkmcnt(4)
  v_smfmac_f32_16x16x64_bf16 v[32:35], v[0:3], v[60:67], v74
  ds_read_b128 v[60:63], v75 offset:18432
  v_mov_b64 v[68:69], s[78:79]
  v_smfmac_f32_16x16x64_bf16 v[24:27], v[16:19], v[168:175], v74
  ds_read_b128 v[64:67], v75 offset:19456
  s_waitcnt lgkmcnt(4)
  v_smfmac_f32_16x16x64_bf16 v[20:23], v[12:15], v[176:183], v74
  s_waitcnt lgkmcnt(3)
  v_mov_b64 v[70:71], s[78:79]
  v_smfmac_f32_16x16x64_bf16 v[28:31], v[4:7], v[36:43], v74
  s_waitcnt lgkmcnt(2)
  v_mov_b64 v[36:37], 0
  v_smfmac_f32_16x16x64_bf16 v[20:23], v[8:11], v[192:199], v74
  v_mov_b64 v[38:39], 0
  v_smfmac_f32_16x16x64_bf16 v[24:27], v[12:15], v[184:191], v74
  v_mov_b64 v[40:41], 0
  v_smfmac_f32_16x16x64_bf16 v[24:27], v[8:11], v[200:207], v74
  s_waitcnt lgkmcnt(0)
  v_add_f32 v20, v20, v22
  v_smfmac_f32_16x16x64_bf16 v[32:35], v[4:7], v[60:67], v74
  v_add_f32 v21, v21, v23
  v_smfmac_f32_16x16x64_bf16 v[28:31], v[16:19], v[240:247], v74
  v_add_f32 v24, v24, v26
  v_cvt_pk_bf16_f32 v22, v20, v24
  v_smfmac_f32_16x16x64_bf16 v[28:31], v[12:15], a[0:7], v74
  ds_write_b32 v79, v22 offset:0
  v_add_f32 v25, v25, v27
  v_cvt_pk_bf16_f32 v23, v21, v25
  v_smfmac_f32_16x16x64_bf16 v[28:31], v[8:11], a[16:23], v74
  ds_write_b32 v79, v23 offset:576
  v_cmp_u_f32 vcc, v20, v21
  v_smfmac_f32_16x16x64_bf16 v[32:35], v[16:19], v[248:255], v74
  v_mov_b64 v[42:43], 0
  v_smfmac_f32_16x16x64_bf16 v[32:35], v[12:15], a[8:15], v74
  v_add_f32 v28, v28, v30
  v_add_f32 v29, v29, v31
  v_smfmac_f32_16x16x64_bf16 v[32:35], v[8:11], a[24:31], v74
  s_cbranch_vccnz Cf0_rec
Cf0_recok:
  v_smfmac_f32_16x16x64_bf16 v[36:39], v[16:19], a[128:135], v74
  s_waitcnt lgkmcnt(0)
  s_barrier
  ds_read_b128 v[60:63], v77
  v_smfmac_f32_16x16x64_bf16 v[40:43], v[16:19], a[136:143], v74
  ds_read_b128 v[64:67], v77 offset:128
  v_add_f32 v32, v32, v34
  v_cvt_pk_bf16_f32 v30, v28, v32
  v_smfmac_f32_16x16x64_bf16 v[36:39], v[0:3], a[96:103], v74
  ds_write_b32 v79, v30 offset:256
  v_add_f32 v33, v33, v35
  v_cvt_pk_bf16_f32 v31, v29, v33
  v_smfmac_f32_16x16x64_bf16 v[40:43], v[0:3], a[104:111], v74
  ds_write_b32 v79, v31 offset:832
  v_xor_b32 v75, 0x8000, v75
  v_smfmac_f32_16x16x64_bf16 v[36:39], v[4:7], a[112:119], v74
  ds_read_b128 v[0:3], v76 offset:4608
  v_mov_b32 v29, 0
  v_smfmac_f32_16x16x64_bf16 v[40:43], v[4:7], a[120:127], v74
  s_waitcnt vmcnt(2) lgkmcnt(3)
  v_mov_b32 v30, 0
  v_mfma_f32_16x16x32_bf16 v[44:47], v[44:47], v[60:63], 0
  ds_read_b128 v[4:7], v76 offset:5632
  s_waitcnt lgkmcnt(2)
  v_mfma_f32_16x16x32_bf16 v[44:47], v[48:51], v[64:67], v[44:47]
  s_barrier
  v_smfmac_f32_16x16x64_bf16 v[36:39], v[8:11], a[160:167], v74
  ds_read_b128 v[20:23], v77 offset:256
  ds_read_b128 v[24:27], v77 offset:384
  v_smfmac_f32_16x16x64_bf16 v[40:43], v[8:11], a[168:175], v74
  ds_read_b128 v[8:11], v76 offset:6656
  v_add_f32_dpp v72, v46, v44 quad_perm:[2,3,0,1] row_mask:0xf bank_mask:0xf
  v_add_f32_dpp v73, v47, v45 quad_perm:[2,3,0,1] row_mask:0xf bank_mask:0xf
  v_smfmac_f32_16x16x64_bf16 v[36:39], v[12:15], a[144:151], v74
  s_waitcnt lgkmcnt(4)
  v_exp_f32_dpp v72, v72 quad_perm:[0,1,0,1] row_mask:0xf bank_mask:0xf
  v_smfmac_f32_16x16x64_bf16 v[40:43], v[12:15], a[152:159], v74
  ds_read_b128 v[12:15], v76 offset:7680
  v_exp_f32_dpp v73, v73 quad_perm:[0,1,0,1] row_mask:0xf bank_mask:0xf
  v_smfmac_f32_16x16x64_bf16 v[36:39], v[0:3], a[32:39], v74
  s_waitcnt lgkmcnt(2)
  v_cvt_pk_bf16_f32 v72, v72, v73
  v_mfma_f32_16x16x32_bf16 v[20:23], v[20:23], v[60:63], 0
  ds_write_b32 v78, v72 offset:512
  v_mov_b64 v[16:17], 0
  v_mfma_f32_16x16x32_bf16 v[20:23], v[24:27], v[64:67], v[20:23]
  ds_read_b128 v[44:47], v75 offset:16384
  v_mov_b64 v[18:19], 0
  v_smfmac_f32_16x16x64_bf16 v[40:43], v[0:3], a[40:47], v74
  ds_read_b128 v[48:51], v75 offset:17408
  s_waitcnt lgkmcnt(4)
  v_smfmac_f32_16x16x64_bf16 v[36:39], v[4:7], a[48:55], v74
  v_add_f32_dpp v24, v22, v20 quad_perm:[2,3,0,1] row_mask:0xf bank_mask:0xf
  v_add_f32_dpp v25, v23, v21 quad_perm:[2,3,0,1] row_mask:0xf bank_mask:0xf
  v_smfmac_f32_16x16x64_bf16 v[36:39], v[8:11], a[64:71], v74
  s_waitcnt lgkmcnt(2)
  s_barrier
  ds_read_b128 v[32:35], v78 offset:512
  v_smfmac_f32_16x16x64_bf16 v[36:39], v[12:15], a[80:87], v74
  ds_read_b128 v[60:63], v75 offset:18432
  v_mul_f32 v24, s69, v24
  v_smfmac_f32_16x16x64_bf16 v[40:43], v[4:7], a[56:63], v74
  ds_read_b128 v[64:67], v75 offset:19456
  v_mul_f32 v25, s69, v25
  v_smfmac_f32_16x16x64_bf16 v[40:43], v[8:11], a[72:79], v74
  v_exp_f32_dpp v24, v24 quad_perm:[0,1,0,1] row_mask:0xf bank_mask:0xf
  v_smfmac_f32_16x16x64_bf16 v[40:43], v[12:15], a[88:95], v74
  s_waitcnt lgkmcnt(2)
  v_exp_f32_dpp v25, v25 quad_perm:[0,1,0,1] row_mask:0xf bank_mask:0xf
  v_mfma_f32_16x16x32_bf16 v[8:11], v[32:35], v[68:71], 0
  v_add_f32 v36, v36, v38
  v_add_f32 v37, v37, v39
  v_mfma_f32_16x16x32_bf16 v[0:3], v[32:35], v[52:55], 0
  v_add_f32 v40, v40, v42
  v_add_f32 v41, v41, v43
  v_mfma_f32_16x16x32_bf16 v[4:7], v[32:35], v[56:59], 0
  v_cvt_pk_bf16_f32 v28, v24, v25
  v_cvt_pk_bf16_f32 v72, v36, v37
  v_cvt_pk_bf16_f32 v73, v40, v41
  v_mfma_f32_16x16x16_bf16 v[8:11], v[28:29], v[68:69], v[8:11]
  v_cvt_pk_bf16_f32 v31, v24, v25
  v_mov_b64 v[20:21], 0
  v_mfma_f32_16x16x16_bf16 v[0:3], v[28:29], v[72:73], v[0:3]
  ds_read_b128 v[68:71], v76 offset:13824
  v_mov_b64 v[22:23], 0
  v_mfma_f32_16x16x16_bf16 v[4:7], v[30:31], v[72:73], v[4:7]
  v_rcp_f32 v10, v8
  v_rcp_f32 v11, v9
  v_mul_f32 v0, v10, v0
  v_mul_f32 v1, v11, v1
  s_nop 0
  v_mul_f32 v4, v10, v4
  v_mul_f32 v5, v11, v5
  v_cvt_pk_bf16_f32 v2, v0, v4
  ds_write_b32 v79, v2 offset:8704
  v_cvt_pk_bf16_f32 v3, v1, v5
  ds_write_b32 v79, v3 offset:9280
  v_max3_f32 v8, v8, v9, v10
  v_max_f32 v8, v8, v11
  v_cmp_le_f32 vcc, 1317011456, v8
  v_mov_b64 v[24:25], 0
  v_mov_b64 v[26:27], 0
  s_cbranch_vccnz Cf0_mx
Cf0_mxok:
  s_waitcnt lgkmcnt(0)
  s_barrier
  ds_read_b128 v[0:3], v78 offset:8704
  ds_read_b128 v[4:7], v78 offset:8768
  ds_read_b128 v[8:11], v78 offset:8832
  ds_read_b128 v[12:15], v78 offset:8896
  s_waitcnt lgkmcnt(3)
  v_smfmac_f32_16x16x64_bf16 v[16:19], v[0:3], v[44:51], v74
  ds_read_b128 v[52:55], v75 offset:32768
  s_waitcnt lgkmcnt(3)
  v_smfmac_f32_16x16x64_bf16 v[16:19], v[4:7], v[60:67], v74
  ds_read_b128 v[56:59], v75 offset:33792
  s_waitcnt lgkmcnt(3)
  v_smfmac_f32_16x16x64_bf16 v[16:19], v[8:11], a[176:183], v74
  ds_read_b128 v[36:39], v75 offset:34816
  s_waitcnt lgkmcnt(3)
  v_smfmac_f32_16x16x64_bf16 v[16:19], v[12:15], a[184:191], v74
  ds_read_b128 v[40:43], v75 offset:35840
  ds_read_b128 v[44:47], v75 offset:49152
  v_smfmac_f32_16x16x64_bf16 v[20:23], v[0:3], a[192:199], v74
  ds_read_b128 v[48:51], v75 offset:50176
  ds_read_b128 v[60:63], v75 offset:51200
  v_smfmac_f32_16x16x64_bf16 v[20:23], v[4:7], a[200:207], v74
  ds_read_b128 v[64:67], v75 offset:52224
  s_waitcnt lgkmcnt(6)
  v_cvt_pk_bf16_f32 v16, v16, v17
  v_cvt_pk_bf16_f32 v17, v18, v19
  v_bfi_b32 v16, 1, s72, v16
  v_smfmac_f32_16x16x64_bf16 v[20:23], v[8:11], v[52:59], v74
  buffer_store_dwordx2 v[16:17], v68, s[8:11], s73 offen
  s_waitcnt lgkmcnt(4)
  v_smfmac_f32_16x16x64_bf16 v[20:23], v[12:15], v[36:43], v74
  v_mov_b64 v[32:33], 0
  v_smfmac_f32_16x16x64_bf16 v[24:27], v[0:3], a[208:215], v74
  v_mov_b64 v[34:35], 0
  v_smfmac_f32_16x16x64_bf16 v[24:27], v[4:7], a[216:223], v74
  s_waitcnt lgkmcnt(2)
  v_cvt_pk_bf16_f32 v20, v20, v21
  v_cvt_pk_bf16_f32 v21, v22, v23
  v_bfi_b32 v20, 1, s72, v20
  v_smfmac_f32_16x16x64_bf16 v[24:27], v[8:11], v[44:51], v74
  buffer_store_dwordx2 v[20:21], v68, s[8:11], s74 offen
  s_waitcnt lgkmcnt(0)
  v_smfmac_f32_16x16x64_bf16 v[24:27], v[12:15], v[60:67], v74
  v_smfmac_f32_16x16x64_bf16 v[32:35], v[0:3], a[224:231], v74
  v_smfmac_f32_16x16x64_bf16 v[32:35], v[4:7], a[232:239], v74
  v_cvt_pk_bf16_f32 v24, v24, v25
  v_cvt_pk_bf16_f32 v25, v26, v27
  v_bfi_b32 v24, 1, s72, v24
  v_smfmac_f32_16x16x64_bf16 v[32:35], v[8:11], a[240:247], v74
  s_nop 1
  buffer_store_dwordx2 v[24:25], v68, s[8:11], s75 offen
  v_smfmac_f32_16x16x64_bf16 v[32:35], v[12:15], a[248:255], v74
  ds_read_b128 v[0:3], v76 offset:14848
  ds_read_b64 v[16:17], v77 offset:256
  v_mov_b64 v[18:19], v[72:73]
  v_xor_b32 v75, 0x8000, v75
  s_nop 3
  v_cvt_pk_bf16_f32 v32, v32, v33
  v_cvt_pk_bf16_f32 v33, v34, v35
  v_bfi_b32 v32, 1, s72, v32
  buffer_store_dwordx2 v[32:33], v68, s[8:11], s76 offen
  v_mov_b64 v[20:21], 0
  v_mov_b64 v[22:23], 0
  v_mov_b64 v[24:25], 0
  v_mov_b64 v[26:27], 0
  v_mov_b64 v[28:29], 0
  v_mov_b64 v[30:31], 0
  v_mov_b64 v[32:33], 0
  v_mov_b64 v[34:35], 0
  s_add_u32 s58, s58, 655360
  s_add_u32 s59, s59, 655360
  s_add_u32 s70, s70, 655360
  s_add_u32 s68, s68, 655360
  s_add_u32 s66, s66, 1
  s_xor_b32 s64, s64, 16384
  s_xor_b32 s65, s65, 16384
  s_cmp_eq_u32 s66, 62
  s_cselect_b64 s[16:17], s[20:21], s[16:17]
  s_cselect_b32 s18, (Cf0_done - Cf0_last), s18
  s_cselect_b32 s70, 0, s70
  s_cmp_eq_u32 s66, 63
  s_cselect_b32 s59, 268435456, s59
  s_nop 13
  buffer_load_dwordx4 v[52:55], v76, s[8:11], s60 offen offset:0 sc1
  buffer_load_dwordx4 v[56:59], v76, s[8:11], s60 offen offset:1024 sc1
  s_nop 15
  s_nop 11
  buffer_load_dwordx4 v[36:39], v76, s[8:11], s60 offen offset:0 sc1
  buffer_load_dwordx4 v[40:43], v76, s[8:11], s60 offen offset:1024 sc1
  s_waitcnt lgkmcnt(0)
  s_waitcnt vmcnt(3)
  v_mfma_f32_16x16x32_bf16 v[4:7], v[0:3], v[52:55], 0
  v_bitop3_b32 v72, v52, v54, s72 bitop3:0x7e
  s_waitcnt vmcnt(2)
  v_mfma_f32_16x16x32_bf16 v[4:7], v[0:3], v[56:59], v[4:7]
  v_bitop3_b32 v73, v56, v58, s72 bitop3:0x7e
  v_bitop3_b32 v72, v72, v73, 1 bitop3:0xa8
  v_cmp_ne_u32 vcc, 0, v72
  s_cbranch_vccnz Cf0_h1r
  s_nop 2
  v_add_f32_dpp v4, v4, v4 row_ror:4 row_mask:0xf bank_mask:0xf
  v_add_f32_dpp v5, v5, v5 row_ror:4 row_mask:0xf bank_mask:0xf
  s_nop 0
  v_add_f32_dpp v4, v4, v4 row_ror:8 row_mask:0xf bank_mask:0xf
  v_add_f32_dpp v5, v5, v5 row_ror:8 row_mask:0xf bank_mask:0xf
  v_cvt_pk_bf16_f32 v4, v4, v5
  buffer_store_dword v4, v69, s[8:11], s62 offen
  s_xor_b32 s62, s62, 16384
  buffer_store_dword v71, v69, s[8:11], s62 offen
  s_xor_b32 s72, s72, 1
  s_branch Cf0_h2
Cf0_h1r:
  s_mov_b64 exec, vcc
  buffer_load_dwordx4 v[52:55], v76, s[8:11], s60 offen offset:0 sc1
  buffer_load_dwordx4 v[56:59], v76, s[8:11], s60 offen offset:1024 sc1
  s_mov_b64 exec, -1
  s_add_u32 s67, s67, 1
  s_waitcnt vmcnt(3)
  v_mfma_f32_16x16x32_bf16 v[4:7], v[0:3], v[36:39], 0
  v_bitop3_b32 v72, v36, v38, s72 bitop3:0x7e
  s_waitcnt vmcnt(2)
  v_mfma_f32_16x16x32_bf16 v[4:7], v[0:3], v[40:43], v[4:7]
  v_bitop3_b32 v73, v40, v42, s72 bitop3:0x7e
  v_bitop3_b32 v72, v72, v73, 1 bitop3:0xa8
  v_cmp_ne_u32 vcc, 0, v72
  s_cbranch_vccz Cf0_h1p
  s_mov_b64 exec, vcc
  buffer_load_dwordx4 v[36:39], v76, s[8:11], s60 offen offset:0 sc1
  buffer_load_dwordx4 v[40:43], v76, s[8:11], s60 offen offset:1024 sc1
  s_mov_b64 exec, -1
  s_add_u32 s67, s67, 1
  s_waitcnt vmcnt(3)
  v_mfma_f32_16x16x32_bf16 v[4:7], v[0:3], v[52:55], 0
  v_bitop3_b32 v72, v52, v54, s72 bitop3:0x7e
  s_waitcnt vmcnt(2)
  v_mfma_f32_16x16x32_bf16 v[4:7], v[0:3], v[56:59], v[4:7]
  v_bitop3_b32 v73, v56, v58, s72 bitop3:0x7e
  v_bitop3_b32 v72, v72, v73, 1 bitop3:0xa8
  v_cmp_ne_u32 vcc, 0, v72
  s_cbranch_vccz Cf0_h1p
Cf0_h1s:
  s_mov_b64 exec, vcc
  buffer_load_dwordx4 v[52:55], v76, s[8:11], s60 offen offset:0 sc1
  buffer_load_dwordx4 v[56:59], v76, s[8:11], s60 offen offset:1024 sc1
  s_mov_b64 exec, -1
  s_add_u32 s67, s67, 1
  s_waitcnt vmcnt(3)
  v_mfma_f32_16x16x32_bf16 v[4:7], v[0:3], v[36:39], 0
  v_bitop3_b32 v72, v36, v38, s72 bitop3:0x7e
  s_waitcnt vmcnt(2)
  v_mfma_f32_16x16x32_bf16 v[4:7], v[0:3], v[40:43], v[4:7]
  v_bitop3_b32 v73, v40, v42, s72 bitop3:0x7e
  v_bitop3_b32 v72, v72, v73, 1 bitop3:0xa8
  v_cmp_ne_u32 vcc, 0, v72
  s_cbranch_vccz Cf0_h1p
  s_mov_b64 exec, vcc
  buffer_load_dwordx4 v[36:39], v76, s[8:11], s60 offen offset:0 sc1
  buffer_load_dwordx4 v[40:43], v76, s[8:11], s60 offen offset:1024 sc1
  s_mov_b64 exec, -1
  s_add_u32 s67, s67, 1
  s_waitcnt vmcnt(3)
  v_mfma_f32_16x16x32_bf16 v[4:7], v[0:3], v[52:55], 0
  v_bitop3_b32 v72, v52, v54, s72 bitop3:0x7e
  s_waitcnt vmcnt(2)
  v_mfma_f32_16x16x32_bf16 v[4:7], v[0:3], v[56:59], v[4:7]
  v_bitop3_b32 v73, v56, v58, s72 bitop3:0x7e
  v_bitop3_b32 v72, v72, v73, 1 bitop3:0xa8
  v_cmp_ne_u32 vcc, 0, v72
  s_cbranch_vccz Cf0_h1p
  s_cmp_lt_u32 s67, 131072
  s_cbranch_scc1 Cf0_h1s
Cf0_h1p:
  s_nop 2
  v_add_f32_dpp v4, v4, v4 row_ror:4 row_mask:0xf bank_mask:0xf
  v_add_f32_dpp v5, v5, v5 row_ror:4 row_mask:0xf bank_mask:0xf
  s_nop 0
  v_add_f32_dpp v4, v4, v4 row_ror:8 row_mask:0xf bank_mask:0xf
  v_add_f32_dpp v5, v5, v5 row_ror:8 row_mask:0xf bank_mask:0xf
  v_cvt_pk_bf16_f32 v4, v4, v5
  buffer_store_dword v4, v69, s[8:11], s62 offen
  s_xor_b32 s62, s62, 16384
  buffer_store_dword v71, v69, s[8:11], s62 offen
  s_xor_b32 s72, s72, 1
  s_branch Cf0_h2
Cf0_h2r:
  s_mov_b64 exec, vcc
  buffer_load_dwordx4 v[0:3], v76, s[8:11], s65 offen offset:0 sc1
  buffer_load_dwordx4 v[4:7], v76, s[8:11], s65 offen offset:1024 sc1
  s_mov_b64 exec, -1
  s_add_u32 s67, s67, 1
  s_waitcnt vmcnt(6)
  v_max3_u32 v72, v0, v1, v2
  v_max3_u32 v72, v72, v3, v4
  v_max3_u32 v72, v72, v5, v6
  v_max_u32 v72, v72, v7
  ds_write_b128 v76, v[0:3] offset:4608
  ds_write_b128 v76, v[4:7] offset:5632
  v_cmp_eq_u32 vcc, -1, v72
  s_cbranch_vccz Cf0_h2w
  s_mov_b64 exec, vcc
  buffer_load_dwordx4 v[0:3], v76, s[8:11], s65 offen offset:0 sc1
  buffer_load_dwordx4 v[4:7], v76, s[8:11], s65 offen offset:1024 sc1
  s_mov_b64 exec, -1
  s_add_u32 s67, s67, 1
  s_waitcnt vmcnt(6)
  v_max3_u32 v72, v0, v1, v2
  v_max3_u32 v72, v72, v3, v4
  v_max3_u32 v72, v72, v5, v6
  v_max_u32 v72, v72, v7
  ds_write_b128 v76, v[0:3] offset:4608
  ds_write_b128 v76, v[4:7] offset:5632
  v_cmp_eq_u32 vcc, -1, v72
  s_cbranch_vccz Cf0_h2w
Cf0_h2s:
  s_mov_b64 exec, vcc
  buffer_load_dwordx4 v[0:3], v76, s[8:11], s65 offen offset:0 sc1
  buffer_load_dwordx4 v[4:7], v76, s[8:11], s65 offen offset:1024 sc1
  s_mov_b64 exec, -1
  s_add_u32 s67, s67, 1
  s_waitcnt vmcnt(4)
  v_max3_u32 v72, v0, v1, v2
  v_max3_u32 v72, v72, v3, v4
  v_max3_u32 v72, v72, v5, v6
  v_max_u32 v72, v72, v7
  ds_write_b128 v76, v[0:3] offset:4608
  ds_write_b128 v76, v[4:7] offset:5632
  v_cmp_eq_u32 vcc, -1, v72
  s_cbranch_vccz Cf0_h2w
  s_mov_b64 exec, vcc
  buffer_load_dwordx4 v[0:3], v76, s[8:11], s65 offen offset:0 sc1
  buffer_load_dwordx4 v[4:7], v76, s[8:11], s65 offen offset:1024 sc1
  s_mov_b64 exec, -1
  s_add_u32 s67, s67, 1
  s_waitcnt vmcnt(4)
  v_max3_u32 v72, v0, v1, v2
  v_max3_u32 v72, v72, v3, v4
  v_max3_u32 v72, v72, v5, v6
  v_max_u32 v72, v72, v7
  ds_write_b128 v76, v[0:3] offset:4608
  ds_write_b128 v76, v[4:7] offset:5632
  v_cmp_eq_u32 vcc, -1, v72
  s_cbranch_vccz Cf0_h2w
  s_mov_b64 exec, vcc
  buffer_load_dwordx4 v[0:3], v76, s[8:11], s65 offen offset:0 sc1
  buffer_load_dwordx4 v[4:7], v76, s[8:11], s65 offen offset:1024 sc1
  s_mov_b64 exec, -1
  s_add_u32 s67, s67, 1
  s_waitcnt vmcnt(4)
  v_max3_u32 v72, v0, v1, v2
  v_max3_u32 v72, v72, v3, v4
  v_max3_u32 v72, v72, v5, v6
  v_max_u32 v72, v72, v7
  ds_write_b128 v76, v[0:3] offset:4608
  ds_write_b128 v76, v[4:7] offset:5632
  v_cmp_eq_u32 vcc, -1, v72
  s_cbranch_vccz Cf0_h2w
  s_cmp_lt_u32 s67, 131072
  s_cbranch_scc1 Cf0_h2s
Cf0_h2ok:
  ds_write_b128 v76, v[0:3] offset:4608
  ds_write_b128 v76, v[4:7] offset:5632
  s_branch Cf0_h2w
Cf0_rec:
  s_nop 7
  s_waitcnt vmcnt(0) lgkmcnt(0)
  v_max3_u32 v72, v0, v1, v2
  v_max3_u32 v72, v72, v3, v4
  v_max3_u32 v72, v72, v5, v6
  v_max3_u32 v72, v72, v7, v8
  v_max3_u32 v72, v72, v9, v10
  v_max3_u32 v72, v72, v11, v12
  v_max3_u32 v72, v72, v13, v14
  v_max3_u32 v72, v72, v15, v16
  v_max3_u32 v72, v72, v17, v18
  v_max_u32 v72, v72, v19
  v_cmp_eq_u32 vcc, -1, v72
  s_cbranch_vccz Cf0_recok
  s_barrier
  v_mov_b64 v[20:21], 0
  v_mov_b64 v[22:23], 0
  v_mov_b64 v[24:25], 0
  v_mov_b64 v[26:27], 0
  v_mov_b64 v[28:29], 0
  v_mov_b64 v[30:31], 0
  v_mov_b64 v[32:33], 0
  v_mov_b64 v[34:35], 0
  s_waitcnt lgkmcnt(0)
  s_barrier
  ds_read_b128 v[0:3], v76 offset:4608
  ds_read_b128 v[60:63], v76 offset:16384
  ds_read_b128 v[64:67], v76 offset:17408
  s_waitcnt lgkmcnt(0)
  v_smfmac_f32_16x16x64_bf16 v[20:23], v[0:3], v[60:67], v74
  ds_read_b128 v[60:63], v76 offset:18432
  ds_read_b128 v[64:67], v76 offset:19456
  s_waitcnt lgkmcnt(0)
  v_smfmac_f32_16x16x64_bf16 v[24:27], v[0:3], v[60:67], v74
  ds_read_b128 v[60:63], v76 offset:32768
  ds_read_b128 v[64:67], v76 offset:33792
  s_waitcnt lgkmcnt(0)
  v_smfmac_f32_16x16x64_bf16 v[28:31], v[0:3], v[60:67], v74
  ds_read_b128 v[60:63], v76 offset:34816
  ds_read_b128 v[64:67], v76 offset:35840
  s_waitcnt lgkmcnt(0)
  v_smfmac_f32_16x16x64_bf16 v[32:35], v[0:3], v[60:67], v74
  ds_read_b128 v[4:7], v76 offset:5632
  s_waitcnt lgkmcnt(0)
  v_smfmac_f32_16x16x64_bf16 v[20:23], v[4:7], v[80:87], v74
  v_smfmac_f32_16x16x64_bf16 v[24:27], v[4:7], v[88:95], v74
  v_smfmac_f32_16x16x64_bf16 v[28:31], v[4:7], v[208:215], v74
  v_smfmac_f32_16x16x64_bf16 v[32:35], v[4:7], v[216:223], v74
  ds_read_b128 v[8:11], v76 offset:6656
  s_waitcnt lgkmcnt(0)
  v_smfmac_f32_16x16x64_bf16 v[20:23], v[8:11], v[96:103], v74
  v_smfmac_f32_16x16x64_bf16 v[24:27], v[8:11], v[104:111], v74
  ds_read_b128 v[60:63], v76 offset:49152
  ds_read_b128 v[64:67], v76 offset:50176
  s_waitcnt lgkmcnt(0)
  v_smfmac_f32_16x16x64_bf16 v[28:31], v[8:11], v[60:67], v74
  ds_read_b128 v[60:63], v76 offset:51200
  ds_read_b128 v[64:67], v76 offset:52224
  s_waitcnt lgkmcnt(0)
  v_smfmac_f32_16x16x64_bf16 v[32:35], v[8:11], v[60:67], v74
  ds_read_b128 v[12:15], v76 offset:7680
  s_waitcnt lgkmcnt(0)
  v_smfmac_f32_16x16x64_bf16 v[20:23], v[12:15], v[112:119], v74
  v_smfmac_f32_16x16x64_bf16 v[24:27], v[12:15], v[120:127], v74
  v_smfmac_f32_16x16x64_bf16 v[28:31], v[12:15], v[224:231], v74
  v_smfmac_f32_16x16x64_bf16 v[32:35], v[12:15], v[232:239], v74
  ds_read_b128 v[0:3], v76 offset:8704
  s_waitcnt lgkmcnt(0)
  v_smfmac_f32_16x16x64_bf16 v[20:23], v[0:3], v[128:135], v74
  v_smfmac_f32_16x16x64_bf16 v[24:27], v[0:3], v[136:143], v74
  ds_read_b128 v[60:63], v75 offset:0
  ds_read_b128 v[64:67], v75 offset:1024
  s_waitcnt lgkmcnt(0)
  v_smfmac_f32_16x16x64_bf16 v[28:31], v[0:3], v[60:67], v74
  ds_read_b128 v[60:63], v75 offset:2048
  ds_read_b128 v[64:67], v75 offset:3072
  s_waitcnt lgkmcnt(0)
  v_smfmac_f32_16x16x64_bf16 v[32:35], v[0:3], v[60:67], v74
  ds_read_b128 v[4:7], v76 offset:9728
  s_waitcnt lgkmcnt(0)
  v_smfmac_f32_16x16x64_bf16 v[20:23], v[4:7], v[144:151], v74
  v_smfmac_f32_16x16x64_bf16 v[24:27], v[4:7], v[152:159], v74
  ds_read_b128 v[60:63], v75 offset:16384
  ds_read_b128 v[64:67], v75 offset:17408
  s_waitcnt lgkmcnt(0)
  v_smfmac_f32_16x16x64_bf16 v[28:31], v[4:7], v[60:67], v74
  ds_read_b128 v[60:63], v75 offset:18432
  ds_read_b128 v[64:67], v75 offset:19456
  s_waitcnt lgkmcnt(0)
  v_smfmac_f32_16x16x64_bf16 v[32:35], v[4:7], v[60:67], v74
  ds_read_b128 v[16:19], v76 offset:10752
  s_waitcnt lgkmcnt(0)
  v_smfmac_f32_16x16x64_bf16 v[20:23], v[16:19], v[160:167], v74
  v_smfmac_f32_16x16x64_bf16 v[24:27], v[16:19], v[168:175], v74
  v_smfmac_f32_16x16x64_bf16 v[28:31], v[16:19], v[240:247], v74
  v_smfmac_f32_16x16x64_bf16 v[32:35], v[16:19], v[248:255], v74
  ds_read_b128 v[12:15], v76 offset:11776
  s_waitcnt lgkmcnt(0)
  v_smfmac_f32_16x16x64_bf16 v[20:23], v[12:15], v[176:183], v74
  v_smfmac_f32_16x16x64_bf16 v[24:27], v[12:15], v[184:191], v74
  v_smfmac_f32_16x16x64_bf16 v[28:31], v[12:15], a[0:7], v74
  v_smfmac_f32_16x16x64_bf16 v[32:35], v[12:15], a[8:15], v74
  ds_read_b128 v[8:11], v76 offset:12800
  s_waitcnt lgkmcnt(0)
  v_smfmac_f32_16x16x64_bf16 v[20:23], v[8:11], v[192:199], v74
  v_smfmac_f32_16x16x64_bf16 v[24:27], v[8:11], v[200:207], v74
  v_smfmac_f32_16x16x64_bf16 v[28:31], v[8:11], a[16:23], v74
  v_smfmac_f32_16x16x64_bf16 v[32:35], v[8:11], a[24:31], v74
  v_add_f32 v20, v20, v22
  v_add_f32 v21, v21, v23
  v_add_f32 v24, v24, v26
  v_cvt_pk_bf16_f32 v22, v20, v24
  s_nop 0
  ds_write_b32 v79, v22 offset:0
  v_add_f32 v25, v25, v27
  v_cvt_pk_bf16_f32 v23, v21, v25
  ds_write_b32 v79, v23 offset:576
  v_add_f32 v28, v28, v30
  v_add_f32 v29, v29, v31
  s_waitcnt lgkmcnt(0)
  s_nop 1
  s_branch Cf0_recok
Cf0_mx:
  s_waitcnt lgkmcnt(0)
  s_barrier
  buffer_load_dwordx4 v[0:3], v76, s[8:11], s58 offen offset:0 sc1
  ds_read_b128 v[20:23], v77 offset:0
  ds_read_b128 v[28:31], v77 offset:256
  buffer_load_dwordx4 v[4:7], v76, s[8:11], s58 offen offset:1024 sc1
  ds_read_b128 v[24:27], v77 offset:128
  ds_read_b128 v[32:35], v77 offset:384
  s_waitcnt vmcnt(1) lgkmcnt(3)
  v_mfma_f32_16x16x32_bf16 v[8:11], v[0:3], v[20:23], 0
  s_waitcnt vmcnt(0) lgkmcnt(1)
  v_mfma_f32_16x16x32_bf16 v[8:11], v[4:7], v[24:27], v[8:11]
  v_mfma_f32_16x16x32_bf16 v[12:15], v[28:31], v[20:23], 0
  s_waitcnt lgkmcnt(0)
  v_mfma_f32_16x16x32_bf16 v[12:15], v[32:35], v[24:27], v[12:15]
  v_add_f32_dpp v8, v10, v8 quad_perm:[2,3,0,1] row_mask:0xf bank_mask:0xf
  v_add_f32_dpp v9, v11, v9 quad_perm:[2,3,0,1] row_mask:0xf bank_mask:0xf
  s_nop 0
  v_mov_b32_dpp v8, v8 quad_perm:[0,1,0,1] row_mask:0xf bank_mask:0xf
  v_mov_b32_dpp v9, v9 quad_perm:[0,1,0,1] row_mask:0xf bank_mask:0xf
  s_nop 1
  v_add_f32_dpp v12, v14, v12 quad_perm:[2,3,0,1] row_mask:0xf bank_mask:0xf
  v_add_f32_dpp v13, v15, v13 quad_perm:[2,3,0,1] row_mask:0xf bank_mask:0xf
  s_nop 0
  v_mov_b32_dpp v12, v12 quad_perm:[0,1,0,1] row_mask:0xf bank_mask:0xf
  v_mov_b32_dpp v13, v13 quad_perm:[0,1,0,1] row_mask:0xf bank_mask:0xf
  v_mul_f32 v12, s69, v12
  ds_write_b32 v78, v8 offset:8704
  v_mul_f32 v13, s69, v13
  ds_write_b32 v78, v9 offset:8768
  s_waitcnt lgkmcnt(0)
  s_barrier
  ds_read_b128 v[36:39], v78 offset:8704
  ds_read_b128 v[40:43], v78 offset:8768
  s_waitcnt lgkmcnt(0)
  s_barrier
  v_max_f32 v16, v36, v37
  v_max3_f32 v16, v16, v38, v39
  v_max3_f32 v16, v16, v40, v41
  v_max3_f32 v16, v16, v42, v43
  v_max3_f32 v16, v16, v12, v13
  v_mov_b32 v17, v16
  s_nop 1
  v_permlane16_swap_b32 v16, v17
  v_max_f32 v16, v16, v17
  v_mov_b32 v17, v16
  s_nop 1
  v_permlane32_swap_b32 v16, v17
  v_max_f32 v16, v16, v17
  v_sub_f32 v36, v36, v16
  v_sub_f32 v37, v37, v16
  v_sub_f32 v38, v38, v16
  v_sub_f32 v39, v39, v16
  v_sub_f32 v40, v40, v16
  v_sub_f32 v41, v41, v16
  v_sub_f32 v42, v42, v16
  v_sub_f32 v43, v43, v16
  v_sub_f32 v12, v12, v16
  v_sub_f32 v13, v13, v16
  v_exp_f32 v36, v36
  v_exp_f32 v37, v37
  v_exp_f32 v38, v38
  v_exp_f32 v39, v39
  v_exp_f32 v40, v40
  v_exp_f32 v41, v41
  v_exp_f32 v42, v42
  v_exp_f32 v43, v43
  v_exp_f32 v12, v12
  v_exp_f32 v13, v13
  v_cvt_pk_bf16_f32 v32, v36, v40
  v_cvt_pk_bf16_f32 v33, v37, v41
  v_cvt_pk_bf16_f32 v34, v38, v42
  v_cvt_pk_bf16_f32 v35, v39, v43
  v_cvt_pk_bf16_f32 v28, v12, v13
  v_cvt_pk_bf16_f32 v31, v12, v13
  v_mov_b32 v29, 0
  v_mov_b32 v30, 0
  v_mov_b32 v68, 0x3f803f80
  v_mov_b32 v69, 0x3f803f80
  v_mov_b32 v70, 0x3f803f80
  v_mov_b32 v71, 0x3f803f80
  s_nop 1
  v_mfma_f32_16x16x32_bf16 v[8:11], v[32:35], v[68:71], 0
  v_mfma_f32_16x16x32_bf16 v[0:3], v[32:35], v[52:55], 0
  v_mfma_f32_16x16x32_bf16 v[4:7], v[32:35], v[56:59], 0
  v_mfma_f32_16x16x16_bf16 v[8:11], v[28:29], v[68:69], v[8:11]
  v_mfma_f32_16x16x16_bf16 v[0:3], v[28:29], v[72:73], v[0:3]
  v_mfma_f32_16x16x16_bf16 v[4:7], v[30:31], v[72:73], v[4:7]
  ds_read_b128 v[68:71], v76 offset:13824
  v_rcp_f32 v10, v8
  v_rcp_f32 v11, v9
  v_mul_f32 v0, v10, v0
  v_mul_f32 v1, v11, v1
  s_nop 0
  v_mul_f32 v4, v10, v4
  v_mul_f32 v5, v11, v5
  v_cvt_pk_bf16_f32 v2, v0, v4
  ds_write_b32 v79, v2 offset:8704
  v_cvt_pk_bf16_f32 v3, v1, v5
  ds_write_b32 v79, v3 offset:9280
  v_mov_b64 v[16:17], 0
  v_mov_b64 v[18:19], 0
  v_mov_b64 v[20:21], 0
  v_mov_b64 v[22:23], 0
  v_mov_b64 v[24:25], 0
  v_mov_b64 v[26:27], 0
  s_branch Cf0_mxok
Cf0_last:
  ds_read_b128 v[8:11], v76 offset:6656
  ds_read_b128 v[12:15], v76 offset:7680
  ds_read_b128 v[60:63], v76 offset:34816
  ds_read_b128 v[64:67], v76 offset:35840
  ds_read_b128 v[44:47], v76 offset:49152
  ds_read_b128 v[48:51], v76 offset:50176
  v_smfmac_f32_16x16x64_bf16 v[28:31], v[0:3], v[36:43], v74
  v_smfmac_f32_16x16x64_bf16 v[20:23], v[0:3], a[32:39], v74
  ds_read_b128 v[36:39], v76 offset:51200
  ds_read_b128 v[40:43], v76 offset:52224
  v_smfmac_f32_16x16x64_bf16 v[24:27], v[0:3], a[40:47], v74
  v_smfmac_f32_16x16x64_bf16 v[20:23], v[4:7], a[48:55], v74
  buffer_store_dwordx4 v[16:19], v76, s[8:11], s68 offen sc1
  v_smfmac_f32_16x16x64_bf16 v[24:27], v[4:7], a[56:63], v74
  s_waitcnt lgkmcnt(4)
  v_smfmac_f32_16x16x64_bf16 v[28:31], v[4:7], v[208:215], v74
  v_smfmac_f32_16x16x64_bf16 v[32:35], v[4:7], v[216:223], v74
  s_waitcnt lgkmcnt(2)
  v_smfmac_f32_16x16x64_bf16 v[32:35], v[0:3], v[60:67], v74
  v_smfmac_f32_16x16x64_bf16 v[20:23], v[8:11], a[64:71], v74
  ds_read_b128 v[60:63], v75 offset:0
  ds_read_b128 v[64:67], v75 offset:1024
  v_smfmac_f32_16x16x64_bf16 v[24:27], v[8:11], a[72:79], v74
  v_smfmac_f32_16x16x64_bf16 v[28:31], v[8:11], v[44:51], v74
  v_smfmac_f32_16x16x64_bf16 v[20:23], v[12:15], a[80:87], v74
  ds_read_b128 v[44:47], v75 offset:2048
  ds_read_b128 v[48:51], v75 offset:3072
  v_smfmac_f32_16x16x64_bf16 v[24:27], v[12:15], a[88:95], v74
  s_waitcnt lgkmcnt(4)
  v_smfmac_f32_16x16x64_bf16 v[28:31], v[12:15], v[224:231], v74
  v_smfmac_f32_16x16x64_bf16 v[32:35], v[12:15], v[232:239], v74
  v_smfmac_f32_16x16x64_bf16 v[32:35], v[8:11], v[36:43], v74
  ds_read_b128 v[36:39], v75 offset:16384
  ds_read_b128 v[40:43], v75 offset:17408
  s_waitcnt vmcnt(1)
  s_barrier
Cf0_lastr:
  ds_read_b128 v[0:3], v76 offset:8704
  ds_read_b128 v[4:7], v76 offset:9728
  ds_read_b128 v[16:19], v76 offset:10752
  ds_read_b128 v[12:15], v76 offset:11776
  ds_read_b128 v[8:11], v76 offset:12800
  s_waitcnt lgkmcnt(4)
  v_max3_u32 v72, v0, v1, v2
  s_waitcnt lgkmcnt(3)
  v_max3_u32 v72, v72, v3, v4
  v_max3_u32 v72, v72, v5, v6
  s_waitcnt lgkmcnt(0)
  v_max3_u32 v72, v72, v7, v8
  v_max3_u32 v72, v72, v9, v10
  v_max3_u32 v72, v72, v11, v12
  v_max3_u32 v72, v72, v13, v14
  v_max3_u32 v72, v72, v15, v16
  v_max3_u32 v72, v72, v17, v18
  v_max_u32 v72, v72, v19
  v_cmp_eq_u32 vcc, -1, v72
  s_cbranch_vccnz Cf0_lastp
Cf0_lastg:
  v_smfmac_f32_16x16x64_bf16 v[28:31], v[0:3], v[60:67], v74
  ds_read_b128 v[60:63], v75 offset:18432
  ds_read_b128 v[64:67], v75 offset:19456
  v_smfmac_f32_16x16x64_bf16 v[32:35], v[0:3], v[44:51], v74
  v_smfmac_f32_16x16x64_bf16 v[28:31], v[4:7], v[36:43], v74
  v_smfmac_f32_16x16x64_bf16 v[28:31], v[16:19], v[240:247], v74
  v_smfmac_f32_16x16x64_bf16 v[28:31], v[12:15], a[0:7], v74
  v_smfmac_f32_16x16x64_bf16 v[28:31], v[8:11], a[16:23], v74
  v_smfmac_f32_16x16x64_bf16 v[32:35], v[16:19], v[248:255], v74
  v_smfmac_f32_16x16x64_bf16 v[32:35], v[12:15], a[8:15], v74
  s_waitcnt lgkmcnt(0)
  v_smfmac_f32_16x16x64_bf16 v[32:35], v[8:11], a[24:31], v74
  v_smfmac_f32_16x16x64_bf16 v[32:35], v[4:7], v[60:67], v74
  v_smfmac_f32_16x16x64_bf16 v[20:23], v[0:3], a[96:103], v74
  v_smfmac_f32_16x16x64_bf16 v[20:23], v[4:7], a[112:119], v74
  v_add_f32 v28, v28, v30
  v_add_f32 v32, v32, v34
  v_cvt_pk_bf16_f32 v30, v28, v32
  v_smfmac_f32_16x16x64_bf16 v[20:23], v[16:19], a[128:135], v74
  ds_write_b32 v79, v30 offset:256
  v_add_f32 v29, v29, v31
  v_add_f32 v33, v33, v35
  v_cvt_pk_bf16_f32 v31, v29, v33
  v_smfmac_f32_16x16x64_bf16 v[20:23], v[12:15], a[144:151], v74
  ds_write_b32 v79, v31 offset:832
  v_smfmac_f32_16x16x64_bf16 v[20:23], v[8:11], a[160:167], v74
  v_smfmac_f32_16x16x64_bf16 v[24:27], v[0:3], a[104:111], v74
  v_smfmac_f32_16x16x64_bf16 v[24:27], v[4:7], a[120:127], v74
  v_smfmac_f32_16x16x64_bf16 v[24:27], v[16:19], a[136:143], v74
  s_waitcnt lgkmcnt(0)
  s_barrier
  ds_read_b64 v[52:53], v77 offset:256
  v_add_f32 v20, v20, v22
  v_smfmac_f32_16x16x64_bf16 v[24:27], v[12:15], a[152:159], v74
  v_add_f32 v21, v21, v23
  v_smfmac_f32_16x16x64_bf16 v[24:27], v[8:11], a[168:175], v74
  v_cvt_pk_bf16_f32 v54, v20, v21
  s_add_u32 s68, s68, 655360
  s_nop 3
  v_add_f32 v24, v24, v26
  v_add_f32 v25, v25, v27
  v_cvt_pk_bf16_f32 v55, v24, v25
  s_waitcnt lgkmcnt(0)
  buffer_store_dwordx4 v[52:55], v76, s[8:11], s68 offen sc1
  s_branch Cf0_done
Cf0_lastp:
  s_add_u32 s72, s72, 2
  s_cmp_ge_u32 s72, 131072
  s_cbranch_scc1 Cf0_lastg
  s_barrier
  buffer_load_dwordx4 v76, s[8:11], s55 offen offset:0 sc1 lds
  buffer_load_dwordx4 v76, s[8:11], s55 offen offset:1024 sc1 lds
  buffer_load_dwordx4 v76, s[8:11], s55 offen offset:2048 sc1 lds
  buffer_load_dwordx4 v76, s[8:11], s55 offen offset:3072 sc1 lds
  s_waitcnt vmcnt(0)
  s_barrier
  s_branch Cf0_lastr
Cf0_done:
  s_branch L_cexit
L_w1:
  v_mov_b64 v[20:21], 0
  v_mov_b64 v[22:23], 0
  v_mov_b64 v[24:25], 0
  v_mov_b64 v[26:27], 0
  v_mov_b64 v[28:29], 0
  v_mov_b64 v[30:31], 0
  v_mov_b64 v[32:33], 0
  v_mov_b64 v[34:35], 0
  s_mov_b32 s78, 0x3f803f80
  s_mov_b32 s79, s78
  s_mov_b32 s65, 360448
  s_mov_b32 m0, 15872
  s_lshl_b32 s71, s53, 2
  s_add_u32 s71, s71, 128
  s_movk_i32 s56, 0x1000
  v_lshlrev_b32 v73, 2, v76
  v_mov_b32 v72, 0
  s_mov_b64 s[16:17], s[8:9]
  s_mov_b32 s18, 268435456
  s_mov_b32 s19, 0x20000
  s_getpc_b64 s[20:21]
Cf1_pc:
  s_add_u32 s20, s20, (Cf1_last - Cf1_pc)
  s_addc_u32 s21, s21, 0
  buffer_load_dwordx4 v[52:55], v76, s[8:11], s59 offen offset:0 sc1
  buffer_load_dwordx4 v[56:59], v76, s[8:11], s59 offen offset:1024 sc1
  ds_read_b128 v[60:63], v76 offset:20480
  ds_read_b128 v[64:67], v76 offset:21504
  ds_read_b128 v[44:47], v76 offset:22528
  ds_read_b128 v[48:51], v76 offset:23552
  ds_read_b128 v[36:39], v76 offset:36864
  ds_read_b128 v[40:43], v76 offset:37888
  ds_read_b128 v[0:3], v76 offset:4608
  ds_read_b128 v[4:7], v76 offset:5632
  ds_read_b128 v[8:11], v76 offset:6656
  s_waitcnt lgkmcnt(0)
  s_branch Cf1_top2
.p2align 6
Cf1_h2:
  v_lshlrev_b32 v73, 2, v76
  s_nop 15
  s_nop 3
  buffer_load_dwordx4 v[8:11], v76, s[8:11], s65 offen offset:2048 sc1
  s_nop 15
  s_nop 3
  buffer_load_dwordx4 v[8:11], v76, s[8:11], s65 offen offset:2048 sc1
  s_nop 15
  s_nop 3
  buffer_load_dwordx4 v[8:11], v76, s[8:11], s65 offen offset:2048 sc1
  s_waitcnt vmcnt(5)
  ds_read_b128 v[60:63], v76 offset:20480
  ds_read_b128 v[64:67], v76 offset:21504
  ds_read_b128 v[44:47], v76 offset:22528
  ds_read_b128 v[48:51], v76 offset:23552
  ds_read_b128 v[36:39], v76 offset:36864
  ds_read_b128 v[40:43], v76 offset:37888
  buffer_load_dwordx4 v[52:55], v76, s[8:11], s59 offen offset:0 sc1
  buffer_load_dwordx4 v[56:59], v76, s[8:11], s59 offen offset:1024 sc1
  s_waitcnt vmcnt(4)
  v_max3_u32 v72, v8, v9, v10
  v_max_u32 v72, v72, v11
  ds_write_b128 v76, v[8:11] offset:6656
  v_cmp_eq_u32 vcc, -1, v72
  s_cbranch_vccnz Cf1_h2r
Cf1_h2w:
  s_cmp_eq_u32 s66, 63
  s_waitcnt lgkmcnt(0)
  s_barrier
  ds_read_b128 v[0:3], v76 offset:4608
  ds_read_b128 v[4:7], v76 offset:5632
  s_cbranch_scc1 Cf1_last
Cf1_top2:
  s_waitcnt lgkmcnt(1)
  v_smfmac_f32_16x16x64_bf16 v[20:23], v[0:3], v[60:67], v74
  ds_read_b128 v[60:63], v76 offset:38912
  v_smfmac_f32_16x16x64_bf16 v[24:27], v[0:3], v[44:51], v74
  buffer_load_dwordx4 v[44:47], v76, s[8:11], s58 offen offset:0 sc1
  ds_read_b128 v[64:67], v76 offset:39936
  s_waitcnt lgkmcnt(2)
  v_smfmac_f32_16x16x64_bf16 v[20:23], v[4:7], v[80:87], v74
  buffer_load_dwordx4 v[48:51], v76, s[8:11], s58 offen offset:1024 sc1
  v_smfmac_f32_16x16x64_bf16 v[28:31], v[0:3], v[36:43], v74
  ds_read_b128 v[36:39], v76 offset:53248
  v_smfmac_f32_16x16x64_bf16 v[24:27], v[4:7], v[88:95], v74
  ds_read_b128 v[40:43], v76 offset:54272
  v_smfmac_f32_16x16x64_bf16 v[28:31], v[4:7], v[208:215], v74
  ds_read_b128 v[12:15], v76 offset:7680
  v_smfmac_f32_16x16x64_bf16 v[32:35], v[4:7], v[216:223], v74
  buffer_store_dwordx4 v[16:19], v76, s[8:11], s68 offen sc1
  s_waitcnt lgkmcnt(3)
  v_smfmac_f32_16x16x64_bf16 v[32:35], v[0:3], v[60:67], v74
  buffer_load_dword v73, s[16:19], s70 offen  lds
  v_smfmac_f32_16x16x64_bf16 v[20:23], v[8:11], v[96:103], v74
  ds_read_b128 v[60:63], v76 offset:55296
  v_smfmac_f32_16x16x64_bf16 v[24:27], v[8:11], v[104:111], v74
  ds_read_b128 v[64:67], v76 offset:56320
  s_waitcnt lgkmcnt(3)
  v_smfmac_f32_16x16x64_bf16 v[28:31], v[8:11], v[36:43], v74
  ds_read_b128 v[36:39], v75 offset:4096
  s_waitcnt lgkmcnt(3)
  v_smfmac_f32_16x16x64_bf16 v[20:23], v[12:15], v[112:119], v74
  ds_read_b128 v[40:43], v75 offset:5120
  v_smfmac_f32_16x16x64_bf16 v[24:27], v[12:15], v[120:127], v74
  s_waitcnt vmcnt(4)
  v_smfmac_f32_16x16x64_bf16 v[28:31], v[12:15], v[224:231], v74
  s_barrier
  ds_read_b128 v[0:3], v76 offset:8704
  v_smfmac_f32_16x16x64_bf16 v[32:35], v[12:15], v[232:239], v74
  ds_read_b128 v[4:7], v76 offset:9728
  s_waitcnt lgkmcnt(4)
  v_smfmac_f32_16x16x64_bf16 v[32:35], v[8:11], v[60:67], v74
  ds_read_b128 v[60:63], v75 offset:6144
  s_waitcnt lgkmcnt(2)
  v_smfmac_f32_16x16x64_bf16 v[20:23], v[0:3], v[128:135], v74
  ds_read_b128 v[16:19], v76 offset:10752
  v_smfmac_f32_16x16x64_bf16 v[24:27], v[0:3], v[136:143], v74
  ds_read_b128 v[64:67], v75 offset:7168
  v_smfmac_f32_16x16x64_bf16 v[28:31], v[0:3], v[36:43], v74
  ds_read_b128 v[36:39], v75 offset:20480
  s_waitcnt lgkmcnt(4)
  v_smfmac_f32_16x16x64_bf16 v[20:23], v[4:7], v[144:151], v74
  ds_read_b128 v[12:15], v76 offset:11776
  v_smfmac_f32_16x16x64_bf16 v[24:27], v[4:7], v[152:159], v74
  ds_read_b128 v[40:43], v75 offset:21504
  s_waitcnt lgkmcnt(4)
  v_smfmac_f32_16x16x64_bf16 v[20:23], v[16:19], v[160:167], v74
  ds_read_b128 v[8:11], v76 offset:12800
  s_waitcnt lgkmcnt(4)
  v_smfmac_f32_16x16x64_bf16 v[32:35], v[0:3], v[60:67], v74
  ds_read_b128 v[60:63], v75 offset:22528
  v_mov_b64 v[68:69], s[78:79]
  v_smfmac_f32_16x16x64_bf16 v[24:27], v[16:19], v[168:175], v74
  ds_read_b128 v[64:67], v75 offset:23552
  s_waitcnt lgkmcnt(4)
  v_smfmac_f32_16x16x64_bf16 v[20:23], v[12:15], v[176:183], v74
  s_waitcnt lgkmcnt(3)
  v_mov_b64 v[70:71], s[78:79]
  v_smfmac_f32_16x16x64_bf16 v[28:31], v[4:7], v[36:43], v74
  s_waitcnt lgkmcnt(2)
  v_mov_b64 v[36:37], 0
  v_smfmac_f32_16x16x64_bf16 v[20:23], v[8:11], v[192:199], v74
  v_mov_b64 v[38:39], 0
  v_smfmac_f32_16x16x64_bf16 v[24:27], v[12:15], v[184:191], v74
  v_mov_b64 v[40:41], 0
  v_smfmac_f32_16x16x64_bf16 v[24:27], v[8:11], v[200:207], v74
  s_waitcnt lgkmcnt(0)
  v_add_f32 v20, v20, v22
  v_smfmac_f32_16x16x64_bf16 v[32:35], v[4:7], v[60:67], v74
  v_add_f32 v21, v21, v23
  v_smfmac_f32_16x16x64_bf16 v[28:31], v[16:19], v[240:247], v74
  v_add_f32 v24, v24, v26
  v_cvt_pk_bf16_f32 v22, v20, v24
  v_smfmac_f32_16x16x64_bf16 v[28:31], v[12:15], a[0:7], v74
  ds_write_b32 v79, v22 offset:0
  v_add_f32 v25, v25, v27
  v_cvt_pk_bf16_f32 v23, v21, v25
  v_smfmac_f32_16x16x64_bf16 v[28:31], v[8:11], a[16:23], v74
  ds_write_b32 v79, v23 offset:576
  v_cmp_u_f32 vcc, v20, v21
  v_smfmac_f32_16x16x64_bf16 v[32:35], v[16:19], v[248:255], v74
  v_mov_b64 v[42:43], 0
  v_smfmac_f32_16x16x64_bf16 v[32:35], v[12:15], a[8:15], v74
  v_add_f32 v28, v28, v30
  v_add_f32 v29, v29, v31
  v_smfmac_f32_16x16x64_bf16 v[32:35], v[8:11], a[24:31], v74
  s_cbranch_vccnz Cf1_rec
Cf1_recok:
  v_smfmac_f32_16x16x64_bf16 v[36:39], v[16:19], a[128:135], v74
  s_waitcnt lgkmcnt(0)
  s_barrier
  ds_read_b128 v[60:63], v77
  v_smfmac_f32_16x16x64_bf16 v[40:43], v[16:19], a[136:143], v74
  ds_read_b128 v[64:67], v77 offset:128
  v_add_f32 v32, v32, v34
  v_cvt_pk_bf16_f32 v30, v28, v32
  v_smfmac_f32_16x16x64_bf16 v[36:39], v[0:3], a[96:103], v74
  ds_write_b32 v79, v30 offset:256
  v_add_f32 v33, v33, v35
  v_cvt_pk_bf16_f32 v31, v29, v33
  v_smfmac_f32_16x16x64_bf16 v[40:43], v[0:3], a[104:111], v74
  ds_write_b32 v79, v31 offset:832
  v_xor_b32 v75, 0x8000, v75
  v_smfmac_f32_16x16x64_bf16 v[36:39], v[4:7], a[112:119], v74
  ds_read_b128 v[0:3], v76 offset:4608
  v_mov_b32 v29, 0
  v_smfmac_f32_16x16x64_bf16 v[40:43], v[4:7], a[120:127], v74
  s_waitcnt vmcnt(2) lgkmcnt(3)
  v_mov_b32 v30, 0
  v_mfma_f32_16x16x32_bf16 v[44:47], v[44:47], v[60:63], 0
  ds_read_b128 v[4:7], v76 offset:5632
  s_waitcnt lgkmcnt(2)
  v_mfma_f32_16x16x32_bf16 v[44:47], v[48:51], v[64:67], v[44:47]
  s_barrier
  v_smfmac_f32_16x16x64_bf16 v[36:39], v[8:11], a[160:167], v74
  ds_read_b128 v[20:23], v77 offset:256
  ds_read_b128 v[24:27], v77 offset:384
  v_smfmac_f32_16x16x64_bf16 v[40:43], v[8:11], a[168:175], v74
  ds_read_b128 v[8:11], v76 offset:6656
  v_add_f32_dpp v72, v46, v44 quad_perm:[2,3,0,1] row_mask:0xf bank_mask:0xf
  v_add_f32_dpp v73, v47, v45 quad_perm:[2,3,0,1] row_mask:0xf bank_mask:0xf
  v_smfmac_f32_16x16x64_bf16 v[36:39], v[12:15], a[144:151], v74
  s_waitcnt lgkmcnt(4)
  v_exp_f32_dpp v72, v72 quad_perm:[0,1,0,1] row_mask:0xf bank_mask:0xf
  v_smfmac_f32_16x16x64_bf16 v[40:43], v[12:15], a[152:159], v74
  ds_read_b128 v[12:15], v76 offset:7680
  v_exp_f32_dpp v73, v73 quad_perm:[0,1,0,1] row_mask:0xf bank_mask:0xf
  v_smfmac_f32_16x16x64_bf16 v[36:39], v[0:3], a[32:39], v74
  s_waitcnt lgkmcnt(2)
  v_cvt_pk_bf16_f32 v72, v72, v73
  v_mfma_f32_16x16x32_bf16 v[20:23], v[20:23], v[60:63], 0
  ds_write_b32 v78, v72 offset:516
  v_mov_b64 v[16:17], 0
  v_mfma_f32_16x16x32_bf16 v[20:23], v[24:27], v[64:67], v[20:23]
  ds_read_b128 v[44:47], v75 offset:20480
  v_mov_b64 v[18:19], 0
  v_smfmac_f32_16x16x64_bf16 v[40:43], v[0:3], a[40:47], v74
  ds_read_b128 v[48:51], v75 offset:21504
  s_waitcnt lgkmcnt(4)
  v_smfmac_f32_16x16x64_bf16 v[36:39], v[4:7], a[48:55], v74
  v_add_f32_dpp v24, v22, v20 quad_perm:[2,3,0,1] row_mask:0xf bank_mask:0xf
  v_add_f32_dpp v25, v23, v21 quad_perm:[2,3,0,1] row_mask:0xf bank_mask:0xf
  v_smfmac_f32_16x16x64_bf16 v[36:39], v[8:11], a[64:71], v74
  s_waitcnt lgkmcnt(2)
  s_barrier
  ds_read_b128 v[32:35], v78 offset:512
  v_smfmac_f32_16x16x64_bf16 v[36:39], v[12:15], a[80:87], v74
  ds_read_b128 v[60:63], v75 offset:22528
  v_mul_f32 v24, s69, v24
  v_smfmac_f32_16x16x64_bf16 v[40:43], v[4:7], a[56:63], v74
  ds_read_b128 v[64:67], v75 offset:23552
  v_mul_f32 v25, s69, v25
  v_smfmac_f32_16x16x64_bf16 v[40:43], v[8:11], a[72:79], v74
  v_exp_f32_dpp v24, v24 quad_perm:[0,1,0,1] row_mask:0xf bank_mask:0xf
  v_smfmac_f32_16x16x64_bf16 v[40:43], v[12:15], a[88:95], v74
  s_waitcnt lgkmcnt(2)
  v_exp_f32_dpp v25, v25 quad_perm:[0,1,0,1] row_mask:0xf bank_mask:0xf
  v_mfma_f32_16x16x32_bf16 v[8:11], v[32:35], v[68:71], 0
  v_add_f32 v36, v36, v38
  v_add_f32 v37, v37, v39
  v_mfma_f32_16x16x32_bf16 v[0:3], v[32:35], v[52:55], 0
  v_add_f32 v40, v40, v42
  v_add_f32 v41, v41, v43
  v_mfma_f32_16x16x32_bf16 v[4:7], v[32:35], v[56:59], 0
  v_cvt_pk_bf16_f32 v28, v24, v25
  v_cvt_pk_bf16_f32 v72, v36, v37
  v_cvt_pk_bf16_f32 v73, v40, v41
  v_mfma_f32_16x16x16_bf16 v[8:11], v[28:29], v[68:69], v[8:11]
  v_cvt_pk_bf16_f32 v31, v24, v25
  v_mov_b64 v[20:21], 0
  v_mfma_f32_16x16x16_bf16 v[0:3], v[28:29], v[72:73], v[0:3]
  ds_read_b128 v[68:71], v76 offset:13824
  v_mov_b64 v[22:23], 0
  v_mfma_f32_16x16x16_bf16 v[4:7], v[30:31], v[72:73], v[4:7]
  v_rcp_f32 v10, v8
  v_rcp_f32 v11, v9
  v_mul_f32 v0, v10, v0
  v_mul_f32 v1, v11, v1
  s_nop 0
  v_mul_f32 v4, v10, v4
  v_mul_f32 v5, v11, v5
  v_cvt_pk_bf16_f32 v2, v0, v4
  ds_write_b32 v79, v2 offset:8704
  v_cvt_pk_bf16_f32 v3, v1, v5
  ds_write_b32 v79, v3 offset:9280
  v_max3_f32 v8, v8, v9, v10
  v_max_f32 v8, v8, v11
  v_cmp_le_f32 vcc, 1317011456, v8
  v_mov_b64 v[24:25], 0
  v_mov_b64 v[26:27], 0
  s_cbranch_vccnz Cf1_mx
Cf1_mxok:
  s_waitcnt lgkmcnt(0)
  s_barrier
  ds_read_b128 v[0:3], v78 offset:8704
  ds_read_b128 v[4:7], v78 offset:8768
  ds_read_b128 v[8:11], v78 offset:8832
  ds_read_b128 v[12:15], v78 offset:8896
  s_waitcnt lgkmcnt(3)
  v_smfmac_f32_16x16x64_bf16 v[16:19], v[0:3], v[44:51], v74
  ds_read_b128 v[52:55], v75 offset:36864
  s_waitcnt lgkmcnt(3)
  v_smfmac_f32_16x16x64_bf16 v[16:19], v[4:7], v[60:67], v74
  ds_read_b128 v[56:59], v75 offset:37888
  s_waitcnt lgkmcnt(3)
  v_smfmac_f32_16x16x64_bf16 v[16:19], v[8:11], a[176:183], v74
  ds_read_b128 v[36:39], v75 offset:38912
  s_waitcnt lgkmcnt(3)
  v_smfmac_f32_16x16x64_bf16 v[16:19], v[12:15], a[184:191], v74
  ds_read_b128 v[40:43], v75 offset:39936
  ds_read_b128 v[44:47], v75 offset:53248
  v_smfmac_f32_16x16x64_bf16 v[20:23], v[0:3], a[192:199], v74
  ds_read_b128 v[48:51], v75 offset:54272
  ds_read_b128 v[60:63], v75 offset:55296
  v_smfmac_f32_16x16x64_bf16 v[20:23], v[4:7], a[200:207], v74
  ds_read_b128 v[64:67], v75 offset:56320
  s_waitcnt lgkmcnt(6)
  v_cvt_pk_bf16_f32 v16, v16, v17
  v_cvt_pk_bf16_f32 v17, v18, v19
  v_bfi_b32 v16, 1, s72, v16
  v_smfmac_f32_16x16x64_bf16 v[20:23], v[8:11], v[52:59], v74
  buffer_store_dwordx2 v[16:17], v68, s[8:11], s73 offen
  s_waitcnt lgkmcnt(4)
  v_smfmac_f32_16x16x64_bf16 v[20:23], v[12:15], v[36:43], v74
  v_mov_b64 v[32:33], 0
  v_smfmac_f32_16x16x64_bf16 v[24:27], v[0:3], a[208:215], v74
  v_mov_b64 v[34:35], 0
  v_smfmac_f32_16x16x64_bf16 v[24:27], v[4:7], a[216:223], v74
  s_waitcnt lgkmcnt(2)
  v_cvt_pk_bf16_f32 v20, v20, v21
  v_cvt_pk_bf16_f32 v21, v22, v23
  v_bfi_b32 v20, 1, s72, v20
  v_smfmac_f32_16x16x64_bf16 v[24:27], v[8:11], v[44:51], v74
  buffer_store_dwordx2 v[20:21], v68, s[8:11], s74 offen
  s_waitcnt lgkmcnt(0)
  v_smfmac_f32_16x16x64_bf16 v[24:27], v[12:15], v[60:67], v74
  v_smfmac_f32_16x16x64_bf16 v[32:35], v[0:3], a[224:231], v74
  v_smfmac_f32_16x16x64_bf16 v[32:35], v[4:7], a[232:239], v74
  v_cvt_pk_bf16_f32 v24, v24, v25
  v_cvt_pk_bf16_f32 v25, v26, v27
  v_bfi_b32 v24, 1, s72, v24
  v_smfmac_f32_16x16x64_bf16 v[32:35], v[8:11], a[240:247], v74
  s_nop 1
  buffer_store_dwordx2 v[24:25], v68, s[8:11], s75 offen
  v_smfmac_f32_16x16x64_bf16 v[32:35], v[12:15], a[248:255], v74
  ds_read_b128 v[0:3], v76 offset:14848
  ds_read_b64 v[16:17], v77 offset:264
  v_mov_b64 v[18:19], v[72:73]
  v_xor_b32 v75, 0x8000, v75
  s_nop 3
  v_cvt_pk_bf16_f32 v32, v32, v33
  v_cvt_pk_bf16_f32 v33, v34, v35
  v_bfi_b32 v32, 1, s72, v32
  buffer_store_dwordx2 v[32:33], v68, s[8:11], s76 offen
  v_mov_b64 v[20:21], 0
  v_mov_b64 v[22:23], 0
  v_mov_b64 v[24:25], 0
  v_mov_b64 v[26:27], 0
  v_mov_b64 v[28:29], 0
  v_mov_b64 v[30:31], 0
  v_mov_b64 v[32:33], 0
  v_mov_b64 v[34:35], 0
  s_add_u32 s58, s58, 655360
  s_add_u32 s59, s59, 655360
  s_add_u32 s70, s70, 655360
  s_add_u32 s68, s68, 655360
  s_add_u32 s66, s66, 1
  s_xor_b32 s64, s64, 16384
  s_xor_b32 s65, s65, 16384
  s_cmp_eq_u32 s66, 62
  s_cselect_b64 s[16:17], s[20:21], s[16:17]
  s_cselect_b32 s18, (Cf1_done - Cf1_last), s18
  s_cselect_b32 s70, 0, s70
  s_cmp_eq_u32 s66, 63
  s_cselect_b32 s59, 268435456, s59
  s_nop 15
  s_nop 15
  s_nop 1
  buffer_load_dwordx4 v[52:55], v76, s[8:11], s60 offen offset:0 sc1
  buffer_load_dwordx4 v[56:59], v76, s[8:11], s60 offen offset:1024 sc1
  s_nop 15
  s_nop 11
  buffer_load_dwordx4 v[36:39], v76, s[8:11], s60 offen offset:0 sc1
  buffer_load_dwordx4 v[40:43], v76, s[8:11], s60 offen offset:1024 sc1
  s_waitcnt lgkmcnt(0)
  s_waitcnt vmcnt(3)
  v_mfma_f32_16x16x32_bf16 v[4:7], v[0:3], v[52:55], 0
  v_bitop3_b32 v72, v52, v54, s72 bitop3:0x7e
  s_waitcnt vmcnt(2)
  v_mfma_f32_16x16x32_bf16 v[4:7], v[0:3], v[56:59], v[4:7]
  v_bitop3_b32 v73, v56, v58, s72 bitop3:0x7e
  v_bitop3_b32 v72, v72, v73, 1 bitop3:0xa8
  v_cmp_ne_u32 vcc, 0, v72
  s_cbranch_vccnz Cf1_h1r
  s_nop 2
  v_add_f32_dpp v4, v4, v4 row_ror:4 row_mask:0xf bank_mask:0xf
  v_add_f32_dpp v5, v5, v5 row_ror:4 row_mask:0xf bank_mask:0xf
  s_nop 0
  v_add_f32_dpp v4, v4, v4 row_ror:8 row_mask:0xf bank_mask:0xf
  v_add_f32_dpp v5, v5, v5 row_ror:8 row_mask:0xf bank_mask:0xf
  v_cvt_pk_bf16_f32 v4, v4, v5
  buffer_store_dword v4, v69, s[8:11], s62 offen
  s_xor_b32 s62, s62, 16384
  buffer_store_dword v71, v69, s[8:11], s62 offen
  s_xor_b32 s72, s72, 1
  s_branch Cf1_h2
Cf1_h1r:
  s_mov_b64 exec, vcc
  buffer_load_dwordx4 v[52:55], v76, s[8:11], s60 offen offset:0 sc1
  buffer_load_dwordx4 v[56:59], v76, s[8:11], s60 offen offset:1024 sc1
  s_mov_b64 exec, -1
  s_add_u32 s67, s67, 1
  s_waitcnt vmcnt(3)
  v_mfma_f32_16x16x32_bf16 v[4:7], v[0:3], v[36:39], 0
  v_bitop3_b32 v72, v36, v38, s72 bitop3:0x7e
  s_waitcnt vmcnt(2)
  v_mfma_f32_16x16x32_bf16 v[4:7], v[0:3], v[40:43], v[4:7]
  v_bitop3_b32 v73, v40, v42, s72 bitop3:0x7e
  v_bitop3_b32 v72, v72, v73, 1 bitop3:0xa8
  v_cmp_ne_u32 vcc, 0, v72
  s_cbranch_vccz Cf1_h1p
  s_mov_b64 exec, vcc
  buffer_load_dwordx4 v[36:39], v76, s[8:11], s60 offen offset:0 sc1
  buffer_load_dwordx4 v[40:43], v76, s[8:11], s60 offen offset:1024 sc1
  s_mov_b64 exec, -1
  s_add_u32 s67, s67, 1
  s_waitcnt vmcnt(3)
  v_mfma_f32_16x16x32_bf16 v[4:7], v[0:3], v[52:55], 0
  v_bitop3_b32 v72, v52, v54, s72 bitop3:0x7e
  s_waitcnt vmcnt(2)
  v_mfma_f32_16x16x32_bf16 v[4:7], v[0:3], v[56:59], v[4:7]
  v_bitop3_b32 v73, v56, v58, s72 bitop3:0x7e
  v_bitop3_b32 v72, v72, v73, 1 bitop3:0xa8
  v_cmp_ne_u32 vcc, 0, v72
  s_cbranch_vccz Cf1_h1p
Cf1_h1s:
  s_mov_b64 exec, vcc
  buffer_load_dwordx4 v[52:55], v76, s[8:11], s60 offen offset:0 sc1
  buffer_load_dwordx4 v[56:59], v76, s[8:11], s60 offen offset:1024 sc1
  s_mov_b64 exec, -1
  s_add_u32 s67, s67, 1
  s_waitcnt vmcnt(3)
  v_mfma_f32_16x16x32_bf16 v[4:7], v[0:3], v[36:39], 0
  v_bitop3_b32 v72, v36, v38, s72 bitop3:0x7e
  s_waitcnt vmcnt(2)
  v_mfma_f32_16x16x32_bf16 v[4:7], v[0:3], v[40:43], v[4:7]
  v_bitop3_b32 v73, v40, v42, s72 bitop3:0x7e
  v_bitop3_b32 v72, v72, v73, 1 bitop3:0xa8
  v_cmp_ne_u32 vcc, 0, v72
  s_cbranch_vccz Cf1_h1p
  s_mov_b64 exec, vcc
  buffer_load_dwordx4 v[36:39], v76, s[8:11], s60 offen offset:0 sc1
  buffer_load_dwordx4 v[40:43], v76, s[8:11], s60 offen offset:1024 sc1
  s_mov_b64 exec, -1
  s_add_u32 s67, s67, 1
  s_waitcnt vmcnt(3)
  v_mfma_f32_16x16x32_bf16 v[4:7], v[0:3], v[52:55], 0
  v_bitop3_b32 v72, v52, v54, s72 bitop3:0x7e
  s_waitcnt vmcnt(2)
  v_mfma_f32_16x16x32_bf16 v[4:7], v[0:3], v[56:59], v[4:7]
  v_bitop3_b32 v73, v56, v58, s72 bitop3:0x7e
  v_bitop3_b32 v72, v72, v73, 1 bitop3:0xa8
  v_cmp_ne_u32 vcc, 0, v72
  s_cbranch_vccz Cf1_h1p
  s_cmp_lt_u32 s67, 131072
  s_cbranch_scc1 Cf1_h1s
Cf1_h1p:
  s_nop 2
  v_add_f32_dpp v4, v4, v4 row_ror:4 row_mask:0xf bank_mask:0xf
  v_add_f32_dpp v5, v5, v5 row_ror:4 row_mask:0xf bank_mask:0xf
  s_nop 0
  v_add_f32_dpp v4, v4, v4 row_ror:8 row_mask:0xf bank_mask:0xf
  v_add_f32_dpp v5, v5, v5 row_ror:8 row_mask:0xf bank_mask:0xf
  v_cvt_pk_bf16_f32 v4, v4, v5
  buffer_store_dword v4, v69, s[8:11], s62 offen
  s_xor_b32 s62, s62, 16384
  buffer_store_dword v71, v69, s[8:11], s62 offen
  s_xor_b32 s72, s72, 1
  s_branch Cf1_h2
Cf1_h2r:
  s_mov_b64 exec, vcc
  buffer_load_dwordx4 v[8:11], v76, s[8:11], s65 offen offset:2048 sc1
  s_mov_b64 exec, -1
  s_add_u32 s67, s67, 1
  s_waitcnt vmcnt(4)
  v_max3_u32 v72, v8, v9, v10
  v_max_u32 v72, v72, v11
  ds_write_b128 v76, v[8:11] offset:6656
  v_cmp_eq_u32 vcc, -1, v72
  s_cbranch_vccz Cf1_h2w
  s_mov_b64 exec, vcc
  buffer_load_dwordx4 v[8:11], v76, s[8:11], s65 offen offset:2048 sc1
  s_mov_b64 exec, -1
  s_add_u32 s67, s67, 1
  s_waitcnt vmcnt(4)
  v_max3_u32 v72, v8, v9, v10
  v_max_u32 v72, v72, v11
  ds_write_b128 v76, v[8:11] offset:6656
  v_cmp_eq_u32 vcc, -1, v72
  s_cbranch_vccz Cf1_h2w
Cf1_h2s:
  s_mov_b64 exec, vcc
  buffer_load_dwordx4 v[8:11], v76, s[8:11], s65 offen offset:2048 sc1
  s_mov_b64 exec, -1
  s_add_u32 s67, s67, 1
  s_waitcnt vmcnt(2)
  v_max3_u32 v72, v8, v9, v10
  v_max_u32 v72, v72, v11
  ds_write_b128 v76, v[8:11] offset:6656
  v_cmp_eq_u32 vcc, -1, v72
  s_cbranch_vccz Cf1_h2w
  s_mov_b64 exec, vcc
  buffer_load_dwordx4 v[8:11], v76, s[8:11], s65 offen offset:2048 sc1
  s_mov_b64 exec, -1
  s_add_u32 s67, s67, 1
  s_waitcnt vmcnt(2)
  v_max3_u32 v72, v8, v9, v10
  v_max_u32 v72, v72, v11
  ds_write_b128 v76, v[8:11] offset:6656
  v_cmp_eq_u32 vcc, -1, v72
  s_cbranch_vccz Cf1_h2w
  s_mov_b64 exec, vcc
  buffer_load_dwordx4 v[8:11], v76, s[8:11], s65 offen offset:2048 sc1
  s_mov_b64 exec, -1
  s_add_u32 s67, s67, 1
  s_waitcnt vmcnt(2)
  v_max3_u32 v72, v8, v9, v10
  v_max_u32 v72, v72, v11
  ds_write_b128 v76, v[8:11] offset:6656
  v_cmp_eq_u32 vcc, -1, v72
  s_cbranch_vccz Cf1_h2w
  s_cmp_lt_u32 s67, 131072
  s_cbranch_scc1 Cf1_h2s
Cf1_h2ok:
  ds_write_b128 v76, v[8:11] offset:6656
  s_branch Cf1_h2w
Cf1_rec:
  s_nop 7
  s_waitcnt vmcnt(0) lgkmcnt(0)
  v_max3_u32 v72, v0, v1, v2
  v_max3_u32 v72, v72, v3, v4
  v_max3_u32 v72, v72, v5, v6
  v_max3_u32 v72, v72, v7, v8
  v_max3_u32 v72, v72, v9, v10
  v_max3_u32 v72, v72, v11, v12
  v_max3_u32 v72, v72, v13, v14
  v_max3_u32 v72, v72, v15, v16
  v_max3_u32 v72, v72, v17, v18
  v_max_u32 v72, v72, v19
  v_cmp_eq_u32 vcc, -1, v72
  s_cbranch_vccz Cf1_recok
  s_barrier
  v_mov_b64 v[20:21], 0
  v_mov_b64 v[22:23], 0
  v_mov_b64 v[24:25], 0
  v_mov_b64 v[26:27], 0
  v_mov_b64 v[28:29], 0
  v_mov_b64 v[30:31], 0
  v_mov_b64 v[32:33], 0
  v_mov_b64 v[34:35], 0
  s_waitcnt lgkmcnt(0)
  s_barrier
  ds_read_b128 v[0:3], v76 offset:4608
  ds_read_b128 v[60:63], v76 offset:20480
  ds_read_b128 v[64:67], v76 offset:21504
  s_waitcnt lgkmcnt(0)
  v_smfmac_f32_16x16x64_bf16 v[20:23], v[0:3], v[60:67], v74
  ds_read_b128 v[60:63], v76 offset:22528
  ds_read_b128 v[64:67], v76 offset:23552
  s_waitcnt lgkmcnt(0)
  v_smfmac_f32_16x16x64_bf16 v[24:27], v[0:3], v[60:67], v74
  ds_read_b128 v[60:63], v76 offset:36864
  ds_read_b128 v[64:67], v76 offset:37888
  s_waitcnt lgkmcnt(0)
  v_smfmac_f32_16x16x64_bf16 v[28:31], v[0:3], v[60:67], v74
  ds_read_b128 v[60:63], v76 offset:38912
  ds_read_b128 v[64:67], v76 offset:39936
  s_waitcnt lgkmcnt(0)
  v_smfmac_f32_16x16x64_bf16 v[32:35], v[0:3], v[60:67], v74
  ds_read_b128 v[4:7], v76 offset:5632
  s_waitcnt lgkmcnt(0)
  v_smfmac_f32_16x16x64_bf16 v[20:23], v[4:7], v[80:87], v74
  v_smfmac_f32_16x16x64_bf16 v[24:27], v[4:7], v[88:95], v74
  v_smfmac_f32_16x16x64_bf16 v[28:31], v[4:7], v[208:215], v74
  v_smfmac_f32_16x16x64_bf16 v[32:35], v[4:7], v[216:223], v74
  ds_read_b128 v[8:11], v76 offset:6656
  s_waitcnt lgkmcnt(0)
  v_smfmac_f32_16x16x64_bf16 v[20:23], v[8:11], v[96:103], v74
  v_smfmac_f32_16x16x64_bf16 v[24:27], v[8:11], v[104:111], v74
  ds_read_b128 v[60:63], v76 offset:53248
  ds_read_b128 v[64:67], v76 offset:54272
  s_waitcnt lgkmcnt(0)
  v_smfmac_f32_16x16x64_bf16 v[28:31], v[8:11], v[60:67], v74
  ds_read_b128 v[60:63], v76 offset:55296
  ds_read_b128 v[64:67], v76 offset:56320
  s_waitcnt lgkmcnt(0)
  v_smfmac_f32_16x16x64_bf16 v[32:35], v[8:11], v[60:67], v74
  ds_read_b128 v[12:15], v76 offset:7680
  s_waitcnt lgkmcnt(0)
  v_smfmac_f32_16x16x64_bf16 v[20:23], v[12:15], v[112:119], v74
  v_smfmac_f32_16x16x64_bf16 v[24:27], v[12:15], v[120:127], v74
  v_smfmac_f32_16x16x64_bf16 v[28:31], v[12:15], v[224:231], v74
  v_smfmac_f32_16x16x64_bf16 v[32:35], v[12:15], v[232:239], v74
  ds_read_b128 v[0:3], v76 offset:8704
  s_waitcnt lgkmcnt(0)
  v_smfmac_f32_16x16x64_bf16 v[20:23], v[0:3], v[128:135], v74
  v_smfmac_f32_16x16x64_bf16 v[24:27], v[0:3], v[136:143], v74
  ds_read_b128 v[60:63], v75 offset:4096
  ds_read_b128 v[64:67], v75 offset:5120
  s_waitcnt lgkmcnt(0)
  v_smfmac_f32_16x16x64_bf16 v[28:31], v[0:3], v[60:67], v74
  ds_read_b128 v[60:63], v75 offset:6144
  ds_read_b128 v[64:67], v75 offset:7168
  s_waitcnt lgkmcnt(0)
  v_smfmac_f32_16x16x64_bf16 v[32:35], v[0:3], v[60:67], v74
  ds_read_b128 v[4:7], v76 offset:9728
  s_waitcnt lgkmcnt(0)
  v_smfmac_f32_16x16x64_bf16 v[20:23], v[4:7], v[144:151], v74
  v_smfmac_f32_16x16x64_bf16 v[24:27], v[4:7], v[152:159], v74
  ds_read_b128 v[60:63], v75 offset:20480
  ds_read_b128 v[64:67], v75 offset:21504
  s_waitcnt lgkmcnt(0)
  v_smfmac_f32_16x16x64_bf16 v[28:31], v[4:7], v[60:67], v74
  ds_read_b128 v[60:63], v75 offset:22528
  ds_read_b128 v[64:67], v75 offset:23552
  s_waitcnt lgkmcnt(0)
  v_smfmac_f32_16x16x64_bf16 v[32:35], v[4:7], v[60:67], v74
  ds_read_b128 v[16:19], v76 offset:10752
  s_waitcnt lgkmcnt(0)
  v_smfmac_f32_16x16x64_bf16 v[20:23], v[16:19], v[160:167], v74
  v_smfmac_f32_16x16x64_bf16 v[24:27], v[16:19], v[168:175], v74
  v_smfmac_f32_16x16x64_bf16 v[28:31], v[16:19], v[240:247], v74
  v_smfmac_f32_16x16x64_bf16 v[32:35], v[16:19], v[248:255], v74
  ds_read_b128 v[12:15], v76 offset:11776
  s_waitcnt lgkmcnt(0)
  v_smfmac_f32_16x16x64_bf16 v[20:23], v[12:15], v[176:183], v74
  v_smfmac_f32_16x16x64_bf16 v[24:27], v[12:15], v[184:191], v74
  v_smfmac_f32_16x16x64_bf16 v[28:31], v[12:15], a[0:7], v74
  v_smfmac_f32_16x16x64_bf16 v[32:35], v[12:15], a[8:15], v74
  ds_read_b128 v[8:11], v76 offset:12800
  s_waitcnt lgkmcnt(0)
  v_smfmac_f32_16x16x64_bf16 v[20:23], v[8:11], v[192:199], v74
  v_smfmac_f32_16x16x64_bf16 v[24:27], v[8:11], v[200:207], v74
  v_smfmac_f32_16x16x64_bf16 v[28:31], v[8:11], a[16:23], v74
  v_smfmac_f32_16x16x64_bf16 v[32:35], v[8:11], a[24:31], v74
  v_add_f32 v20, v20, v22
  v_add_f32 v21, v21, v23
  v_add_f32 v24, v24, v26
  v_cvt_pk_bf16_f32 v22, v20, v24
  s_nop 0
  ds_write_b32 v79, v22 offset:0
  v_add_f32 v25, v25, v27
  v_cvt_pk_bf16_f32 v23, v21, v25
  ds_write_b32 v79, v23 offset:576
  v_add_f32 v28, v28, v30
  v_add_f32 v29, v29, v31
  s_waitcnt lgkmcnt(0)
  s_nop 1
  s_branch Cf1_recok
Cf1_mx:
  s_waitcnt lgkmcnt(0)
  s_barrier
  buffer_load_dwordx4 v[0:3], v76, s[8:11], s58 offen offset:0 sc1
  ds_read_b128 v[20:23], v77 offset:0
  ds_read_b128 v[28:31], v77 offset:256
  buffer_load_dwordx4 v[4:7], v76, s[8:11], s58 offen offset:1024 sc1
  ds_read_b128 v[24:27], v77 offset:128
  ds_read_b128 v[32:35], v77 offset:384
  s_waitcnt vmcnt(1) lgkmcnt(3)
  v_mfma_f32_16x16x32_bf16 v[8:11], v[0:3], v[20:23], 0
  s_waitcnt vmcnt(0) lgkmcnt(1)
  v_mfma_f32_16x16x32_bf16 v[8:11], v[4:7], v[24:27], v[8:11]
  v_mfma_f32_16x16x32_bf16 v[12:15], v[28:31], v[20:23], 0
  s_waitcnt lgkmcnt(0)
  v_mfma_f32_16x16x32_bf16 v[12:15], v[32:35], v[24:27], v[12:15]
  v_add_f32_dpp v8, v10, v8 quad_perm:[2,3,0,1] row_mask:0xf bank_mask:0xf
  v_add_f32_dpp v9, v11, v9 quad_perm:[2,3,0,1] row_mask:0xf bank_mask:0xf
  s_nop 0
  v_mov_b32_dpp v8, v8 quad_perm:[0,1,0,1] row_mask:0xf bank_mask:0xf
  v_mov_b32_dpp v9, v9 quad_perm:[0,1,0,1] row_mask:0xf bank_mask:0xf
  s_nop 1
  v_add_f32_dpp v12, v14, v12 quad_perm:[2,3,0,1] row_mask:0xf bank_mask:0xf
  v_add_f32_dpp v13, v15, v13 quad_perm:[2,3,0,1] row_mask:0xf bank_mask:0xf
  s_nop 0
  v_mov_b32_dpp v12, v12 quad_perm:[0,1,0,1] row_mask:0xf bank_mask:0xf
  v_mov_b32_dpp v13, v13 quad_perm:[0,1,0,1] row_mask:0xf bank_mask:0xf
  v_mul_f32 v12, s69, v12
  ds_write_b32 v78, v8 offset:8708
  v_mul_f32 v13, s69, v13
  ds_write_b32 v78, v9 offset:8772
  s_waitcnt lgkmcnt(0)
  s_barrier
  ds_read_b128 v[36:39], v78 offset:8704
  ds_read_b128 v[40:43], v78 offset:8768
  s_waitcnt lgkmcnt(0)
  s_barrier
  v_max_f32 v16, v36, v37
  v_max3_f32 v16, v16, v38, v39
  v_max3_f32 v16, v16, v40, v41
  v_max3_f32 v16, v16, v42, v43
  v_max3_f32 v16, v16, v12, v13
  v_mov_b32 v17, v16
  s_nop 1
  v_permlane16_swap_b32 v16, v17
  v_max_f32 v16, v16, v17
  v_mov_b32 v17, v16
  s_nop 1
  v_permlane32_swap_b32 v16, v17
  v_max_f32 v16, v16, v17
  v_sub_f32 v36, v36, v16
  v_sub_f32 v37, v37, v16
  v_sub_f32 v38, v38, v16
  v_sub_f32 v39, v39, v16
  v_sub_f32 v40, v40, v16
  v_sub_f32 v41, v41, v16
  v_sub_f32 v42, v42, v16
  v_sub_f32 v43, v43, v16
  v_sub_f32 v12, v12, v16
  v_sub_f32 v13, v13, v16
  v_exp_f32 v36, v36
  v_exp_f32 v37, v37
  v_exp_f32 v38, v38
  v_exp_f32 v39, v39
  v_exp_f32 v40, v40
  v_exp_f32 v41, v41
  v_exp_f32 v42, v42
  v_exp_f32 v43, v43
  v_exp_f32 v12, v12
  v_exp_f32 v13, v13
  v_cvt_pk_bf16_f32 v32, v36, v40
  v_cvt_pk_bf16_f32 v33, v37, v41
  v_cvt_pk_bf16_f32 v34, v38, v42
  v_cvt_pk_bf16_f32 v35, v39, v43
  v_cvt_pk_bf16_f32 v28, v12, v13
  v_cvt_pk_bf16_f32 v31, v12, v13
  v_mov_b32 v29, 0
  v_mov_b32 v30, 0
  v_mov_b32 v68, 0x3f803f80
  v_mov_b32 v69, 0x3f803f80
  v_mov_b32 v70, 0x3f803f80
  v_mov_b32 v71, 0x3f803f80
  s_nop 1
  v_mfma_f32_16x16x32_bf16 v[8:11], v[32:35], v[68:71], 0
  v_mfma_f32_16x16x32_bf16 v[0:3], v[32:35], v[52:55], 0
  v_mfma_f32_16x16x32_bf16 v[4:7], v[32:35], v[56:59], 0
  v_mfma_f32_16x16x16_bf16 v[8:11], v[28:29], v[68:69], v[8:11]
  v_mfma_f32_16x16x16_bf16 v[0:3], v[28:29], v[72:73], v[0:3]
  v_mfma_f32_16x16x16_bf16 v[4:7], v[30:31], v[72:73], v[4:7]
  ds_read_b128 v[68:71], v76 offset:13824
  v_rcp_f32 v10, v8
  v_rcp_f32 v11, v9
  v_mul_f32 v0, v10, v0
  v_mul_f32 v1, v11, v1
  s_nop 0
  v_mul_f32 v4, v10, v4
  v_mul_f32 v5, v11, v5
  v_cvt_pk_bf16_f32 v2, v0, v4
  ds_write_b32 v79, v2 offset:8704
  v_cvt_pk_bf16_f32 v3, v1, v5
  ds_write_b32 v79, v3 offset:9280
  v_mov_b64 v[16:17], 0
  v_mov_b64 v[18:19], 0
  v_mov_b64 v[20:21], 0
  v_mov_b64 v[22:23], 0
  v_mov_b64 v[24:25], 0
  v_mov_b64 v[26:27], 0
  s_branch Cf1_mxok
Cf1_last:
  ds_read_b128 v[12:15], v76 offset:7680
  ds_read_b128 v[60:63], v76 offset:38912
  ds_read_b128 v[64:67], v76 offset:39936
  ds_read_b128 v[44:47], v76 offset:53248
  ds_read_b128 v[48:51], v76 offset:54272
  s_waitcnt lgkmcnt(6)
  v_smfmac_f32_16x16x64_bf16 v[28:31], v[0:3], v[36:43], v74
  v_smfmac_f32_16x16x64_bf16 v[20:23], v[0:3], a[32:39], v74
  ds_read_b128 v[36:39], v76 offset:55296
  ds_read_b128 v[40:43], v76 offset:56320
  v_smfmac_f32_16x16x64_bf16 v[24:27], v[0:3], a[40:47], v74
  s_waitcnt lgkmcnt(7)
  v_smfmac_f32_16x16x64_bf16 v[20:23], v[4:7], a[48:55], v74
  buffer_store_dwordx4 v[16:19], v76, s[8:11], s68 offen sc1
  v_smfmac_f32_16x16x64_bf16 v[24:27], v[4:7], a[56:63], v74
  s_waitcnt lgkmcnt(4)
  v_smfmac_f32_16x16x64_bf16 v[28:31], v[4:7], v[208:215], v74
  v_smfmac_f32_16x16x64_bf16 v[32:35], v[4:7], v[216:223], v74
  s_waitcnt lgkmcnt(2)
  v_smfmac_f32_16x16x64_bf16 v[32:35], v[0:3], v[60:67], v74
  v_smfmac_f32_16x16x64_bf16 v[20:23], v[8:11], a[64:71], v74
  ds_read_b128 v[60:63], v75 offset:4096
  ds_read_b128 v[64:67], v75 offset:5120
  v_smfmac_f32_16x16x64_bf16 v[24:27], v[8:11], a[72:79], v74
  v_smfmac_f32_16x16x64_bf16 v[28:31], v[8:11], v[44:51], v74
  v_smfmac_f32_16x16x64_bf16 v[20:23], v[12:15], a[80:87], v74
  ds_read_b128 v[44:47], v75 offset:6144
  ds_read_b128 v[48:51], v75 offset:7168
  v_smfmac_f32_16x16x64_bf16 v[24:27], v[12:15], a[88:95], v74
  s_waitcnt lgkmcnt(4)
  v_smfmac_f32_16x16x64_bf16 v[28:31], v[12:15], v[224:231], v74
  v_smfmac_f32_16x16x64_bf16 v[32:35], v[12:15], v[232:239], v74
  v_smfmac_f32_16x16x64_bf16 v[32:35], v[8:11], v[36:43], v74
  ds_read_b128 v[36:39], v75 offset:20480
  ds_read_b128 v[40:43], v75 offset:21504
  s_waitcnt vmcnt(1)
  s_barrier
Cf1_lastr:
  ds_read_b128 v[0:3], v76 offset:8704
  ds_read_b128 v[4:7], v76 offset:9728
  ds_read_b128 v[16:19], v76 offset:10752
  ds_read_b128 v[12:15], v76 offset:11776
  ds_read_b128 v[8:11], v76 offset:12800
  s_waitcnt lgkmcnt(4)
  v_max3_u32 v72, v0, v1, v2
  s_waitcnt lgkmcnt(3)
  v_max3_u32 v72, v72, v3, v4
  v_max3_u32 v72, v72, v5, v6
  s_waitcnt lgkmcnt(0)
  v_max3_u32 v72, v72, v7, v8
  v_max3_u32 v72, v72, v9, v10
  v_max3_u32 v72, v72, v11, v12
  v_max3_u32 v72, v72, v13, v14
  v_max3_u32 v72, v72, v15, v16
  v_max3_u32 v72, v72, v17, v18
  v_max_u32 v72, v72, v19
  v_cmp_eq_u32 vcc, -1, v72
  s_cbranch_vccnz Cf1_lastp
Cf1_lastg:
  v_smfmac_f32_16x16x64_bf16 v[28:31], v[0:3], v[60:67], v74
  ds_read_b128 v[60:63], v75 offset:22528
  ds_read_b128 v[64:67], v75 offset:23552
  v_smfmac_f32_16x16x64_bf16 v[32:35], v[0:3], v[44:51], v74
  v_smfmac_f32_16x16x64_bf16 v[28:31], v[4:7], v[36:43], v74
  v_smfmac_f32_16x16x64_bf16 v[28:31], v[16:19], v[240:247], v74
  v_smfmac_f32_16x16x64_bf16 v[28:31], v[12:15], a[0:7], v74
  v_smfmac_f32_16x16x64_bf16 v[28:31], v[8:11], a[16:23], v74
  v_smfmac_f32_16x16x64_bf16 v[32:35], v[16:19], v[248:255], v74
  v_smfmac_f32_16x16x64_bf16 v[32:35], v[12:15], a[8:15], v74
  s_waitcnt lgkmcnt(0)
  v_smfmac_f32_16x16x64_bf16 v[32:35], v[8:11], a[24:31], v74
  v_smfmac_f32_16x16x64_bf16 v[32:35], v[4:7], v[60:67], v74
  v_smfmac_f32_16x16x64_bf16 v[20:23], v[0:3], a[96:103], v74
  v_smfmac_f32_16x16x64_bf16 v[20:23], v[4:7], a[112:119], v74
  v_add_f32 v28, v28, v30
  v_add_f32 v32, v32, v34
  v_cvt_pk_bf16_f32 v30, v28, v32
  v_smfmac_f32_16x16x64_bf16 v[20:23], v[16:19], a[128:135], v74
  ds_write_b32 v79, v30 offset:256
  v_add_f32 v29, v29, v31
  v_add_f32 v33, v33, v35
  v_cvt_pk_bf16_f32 v31, v29, v33
  v_smfmac_f32_16x16x64_bf16 v[20:23], v[12:15], a[144:151], v74
  ds_write_b32 v79, v31 offset:832
  v_smfmac_f32_16x16x64_bf16 v[20:23], v[8:11], a[160:167], v74
  v_smfmac_f32_16x16x64_bf16 v[24:27], v[0:3], a[104:111], v74
  v_smfmac_f32_16x16x64_bf16 v[24:27], v[4:7], a[120:127], v74
  v_smfmac_f32_16x16x64_bf16 v[24:27], v[16:19], a[136:143], v74
  s_waitcnt lgkmcnt(0)
  s_barrier
  ds_read_b64 v[52:53], v77 offset:264
  v_add_f32 v20, v20, v22
  v_smfmac_f32_16x16x64_bf16 v[24:27], v[12:15], a[152:159], v74
  v_add_f32 v21, v21, v23
  v_smfmac_f32_16x16x64_bf16 v[24:27], v[8:11], a[168:175], v74
  v_cvt_pk_bf16_f32 v54, v20, v21
  s_add_u32 s68, s68, 655360
  s_nop 3
  v_add_f32 v24, v24, v26
  v_add_f32 v25, v25, v27
  v_cvt_pk_bf16_f32 v55, v24, v25
  s_waitcnt lgkmcnt(0)
  buffer_store_dwordx4 v[52:55], v76, s[8:11], s68 offen sc1
  s_branch Cf1_done
Cf1_lastp:
  s_add_u32 s72, s72, 2
  s_cmp_ge_u32 s72, 131072
  s_cbranch_scc1 Cf1_lastg
  s_barrier
  s_waitcnt vmcnt(0)
  s_barrier
  s_branch Cf1_lastr
Cf1_done:
  s_branch L_cexit
L_w2:
  v_mov_b64 v[20:21], 0
  v_mov_b64 v[22:23], 0
  v_mov_b64 v[24:25], 0
  v_mov_b64 v[26:27], 0
  v_mov_b64 v[28:29], 0
  v_mov_b64 v[30:31], 0
  v_mov_b64 v[32:33], 0
  v_mov_b64 v[34:35], 0
  s_mov_b32 s78, 0x3f803f80
  s_mov_b32 s79, s78
  s_mov_b32 s65, 360448
  s_mov_b32 m0, 15872
  s_lshl_b32 s71, s53, 2
  s_add_u32 s71, s71, 128
  s_movk_i32 s56, 0x1000
  v_lshlrev_b32 v73, 2, v76
  v_mov_b32 v72, 0
  s_mov_b64 s[16:17], s[8:9]
  s_mov_b32 s18, 268435456
  s_mov_b32 s19, 0x20000
  s_getpc_b64 s[20:21]
Cf2_pc:
  s_add_u32 s20, s20, (Cf2_last - Cf2_pc)
  s_addc_u32 s21, s21, 0
  buffer_load_dwordx4 v[52:55], v76, s[8:11], s59 offen offset:0 sc1
  buffer_load_dwordx4 v[56:59], v76, s[8:11], s59 offen offset:1024 sc1
  ds_read_b128 v[60:63], v76 offset:24576
  ds_read_b128 v[64:67], v76 offset:25600
  ds_read_b128 v[44:47], v76 offset:26624
  ds_read_b128 v[48:51], v76 offset:27648
  ds_read_b128 v[36:39], v76 offset:40960
  ds_read_b128 v[40:43], v76 offset:41984
  ds_read_b128 v[0:3], v76 offset:4608
  ds_read_b128 v[4:7], v76 offset:5632
  ds_read_b128 v[12:15], v76 offset:7680
  s_waitcnt lgkmcnt(0)
  s_branch Cf2_top2
.p2align 6
Cf2_h2:
  v_lshlrev_b32 v73, 2, v76
  s_nop 3
  buffer_load_dwordx4 v[12:15], v76, s[8:11], s65 offen offset:3072 sc1
  s_nop 15
  s_nop 3
  buffer_load_dwordx4 v[12:15], v76, s[8:11], s65 offen offset:3072 sc1
  s_nop 15
  s_nop 3
  buffer_load_dwordx4 v[12:15], v76, s[8:11], s65 offen offset:3072 sc1
  s_waitcnt vmcnt(5)
  ds_read_b128 v[60:63], v76 offset:24576
  ds_read_b128 v[64:67], v76 offset:25600
  ds_read_b128 v[44:47], v76 offset:26624
  ds_read_b128 v[48:51], v76 offset:27648
  ds_read_b128 v[36:39], v76 offset:40960
  ds_read_b128 v[40:43], v76 offset:41984
  buffer_load_dwordx4 v[52:55], v76, s[8:11], s59 offen offset:0 sc1
  buffer_load_dwordx4 v[56:59], v76, s[8:11], s59 offen offset:1024 sc1
  s_waitcnt vmcnt(4)
  v_max3_u32 v72, v12, v13, v14
  v_max_u32 v72, v72, v15
  ds_write_b128 v76, v[12:15] offset:7680
  v_cmp_eq_u32 vcc, -1, v72
  s_cbranch_vccnz Cf2_h2r
Cf2_h2w:
  s_cmp_eq_u32 s66, 63
  s_waitcnt lgkmcnt(0)
  s_barrier
  ds_read_b128 v[0:3], v76 offset:4608
  ds_read_b128 v[4:7], v76 offset:5632
  s_cbranch_scc1 Cf2_last
Cf2_top2:
  ds_read_b128 v[8:11], v76 offset:6656
  s_waitcnt lgkmcnt(2)
  v_smfmac_f32_16x16x64_bf16 v[20:23], v[0:3], v[60:67], v74
  ds_read_b128 v[60:63], v76 offset:43008
  v_smfmac_f32_16x16x64_bf16 v[24:27], v[0:3], v[44:51], v74
  buffer_load_dwordx4 v[44:47], v76, s[8:11], s58 offen offset:0 sc1
  ds_read_b128 v[64:67], v76 offset:44032
  s_waitcnt lgkmcnt(3)
  v_smfmac_f32_16x16x64_bf16 v[20:23], v[4:7], v[80:87], v74
  buffer_load_dwordx4 v[48:51], v76, s[8:11], s58 offen offset:1024 sc1
  v_smfmac_f32_16x16x64_bf16 v[28:31], v[0:3], v[36:43], v74
  ds_read_b128 v[36:39], v76 offset:57344
  v_smfmac_f32_16x16x64_bf16 v[24:27], v[4:7], v[88:95], v74
  ds_read_b128 v[40:43], v76 offset:58368
  s_waitcnt lgkmcnt(4)
  v_smfmac_f32_16x16x64_bf16 v[28:31], v[4:7], v[208:215], v74
  v_smfmac_f32_16x16x64_bf16 v[32:35], v[4:7], v[216:223], v74
  buffer_store_dwordx4 v[16:19], v76, s[8:11], s68 offen sc1
  s_waitcnt lgkmcnt(2)
  v_smfmac_f32_16x16x64_bf16 v[32:35], v[0:3], v[60:67], v74
  buffer_load_dword v73, s[16:19], s70 offen  lds
  v_smfmac_f32_16x16x64_bf16 v[20:23], v[8:11], v[96:103], v74
  ds_read_b128 v[60:63], v76 offset:59392
  v_smfmac_f32_16x16x64_bf16 v[24:27], v[8:11], v[104:111], v74
  ds_read_b128 v[64:67], v76 offset:60416
  s_waitcnt lgkmcnt(2)
  v_smfmac_f32_16x16x64_bf16 v[28:31], v[8:11], v[36:43], v74
  ds_read_b128 v[36:39], v75 offset:8192
  v_smfmac_f32_16x16x64_bf16 v[20:23], v[12:15], v[112:119], v74
  ds_read_b128 v[40:43], v75 offset:9216
  v_smfmac_f32_16x16x64_bf16 v[24:27], v[12:15], v[120:127], v74
  s_waitcnt vmcnt(4)
  v_smfmac_f32_16x16x64_bf16 v[28:31], v[12:15], v[224:231], v74
  s_barrier
  ds_read_b128 v[0:3], v76 offset:8704
  v_smfmac_f32_16x16x64_bf16 v[32:35], v[12:15], v[232:239], v74
  ds_read_b128 v[4:7], v76 offset:9728
  s_waitcnt lgkmcnt(4)
  v_smfmac_f32_16x16x64_bf16 v[32:35], v[8:11], v[60:67], v74
  ds_read_b128 v[60:63], v75 offset:10240
  s_waitcnt lgkmcnt(2)
  v_smfmac_f32_16x16x64_bf16 v[20:23], v[0:3], v[128:135], v74
  ds_read_b128 v[16:19], v76 offset:10752
  v_smfmac_f32_16x16x64_bf16 v[24:27], v[0:3], v[136:143], v74
  ds_read_b128 v[64:67], v75 offset:11264
  v_smfmac_f32_16x16x64_bf16 v[28:31], v[0:3], v[36:43], v74
  ds_read_b128 v[36:39], v75 offset:24576
  s_waitcnt lgkmcnt(4)
  v_smfmac_f32_16x16x64_bf16 v[20:23], v[4:7], v[144:151], v74
  ds_read_b128 v[12:15], v76 offset:11776
  v_smfmac_f32_16x16x64_bf16 v[24:27], v[4:7], v[152:159], v74
  ds_read_b128 v[40:43], v75 offset:25600
  s_waitcnt lgkmcnt(4)
  v_smfmac_f32_16x16x64_bf16 v[20:23], v[16:19], v[160:167], v74
  ds_read_b128 v[8:11], v76 offset:12800
  s_waitcnt lgkmcnt(4)
  v_smfmac_f32_16x16x64_bf16 v[32:35], v[0:3], v[60:67], v74
  ds_read_b128 v[60:63], v75 offset:26624
  v_mov_b64 v[68:69], s[78:79]
  v_smfmac_f32_16x16x64_bf16 v[24:27], v[16:19], v[168:175], v74
  ds_read_b128 v[64:67], v75 offset:27648
  s_waitcnt lgkmcnt(4)
  v_smfmac_f32_16x16x64_bf16 v[20:23], v[12:15], v[176:183], v74
  s_waitcnt lgkmcnt(3)
  v_mov_b64 v[70:71], s[78:79]
  v_smfmac_f32_16x16x64_bf16 v[28:31], v[4:7], v[36:43], v74
  s_waitcnt lgkmcnt(2)
  v_mov_b64 v[36:37], 0
  v_smfmac_f32_16x16x64_bf16 v[20:23], v[8:11], v[192:199], v74
  v_mov_b64 v[38:39], 0
  v_smfmac_f32_16x16x64_bf16 v[24:27], v[12:15], v[184:191], v74
  v_mov_b64 v[40:41], 0
  v_smfmac_f32_16x16x64_bf16 v[24:27], v[8:11], v[200:207], v74
  s_waitcnt lgkmcnt(0)
  v_add_f32 v20, v20, v22
  v_smfmac_f32_16x16x64_bf16 v[32:35], v[4:7], v[60:67], v74
  v_add_f32 v21, v21, v23
  v_smfmac_f32_16x16x64_bf16 v[28:31], v[16:19], v[240:247], v74
  v_add_f32 v24, v24, v26
  v_cvt_pk_bf16_f32 v22, v20, v24
  v_smfmac_f32_16x16x64_bf16 v[28:31], v[12:15], a[0:7], v74
  ds_write_b32 v79, v22 offset:0
  v_add_f32 v25, v25, v27
  v_cvt_pk_bf16_f32 v23, v21, v25
  v_smfmac_f32_16x16x64_bf16 v[28:31], v[8:11], a[16:23], v74
  ds_write_b32 v79, v23 offset:576
  v_cmp_u_f32 vcc, v20, v21
  v_smfmac_f32_16x16x64_bf16 v[32:35], v[16:19], v[248:255], v74
  v_mov_b64 v[42:43], 0
  v_smfmac_f32_16x16x64_bf16 v[32:35], v[12:15], a[8:15], v74
  v_add_f32 v28, v28, v30
  v_add_f32 v29, v29, v31
  v_smfmac_f32_16x16x64_bf16 v[32:35], v[8:11], a[24:31], v74
  s_cbranch_vccnz Cf2_rec
Cf2_recok:
  v_smfmac_f32_16x16x64_bf16 v[36:39], v[16:19], a[128:135], v74
  s_waitcnt lgkmcnt(0)
  s_barrier
  ds_read_b128 v[60:63], v77
  v_smfmac_f32_16x16x64_bf16 v[40:43], v[16:19], a[136:143], v74
  ds_read_b128 v[64:67], v77 offset:128
  v_add_f32 v32, v32, v34
  v_cvt_pk_bf16_f32 v30, v28, v32
  v_smfmac_f32_16x16x64_bf16 v[36:39], v[0:3], a[96:103], v74
  ds_write_b32 v79, v30 offset:256
  v_add_f32 v33, v33, v35
  v_cvt_pk_bf16_f32 v31, v29, v33
  v_smfmac_f32_16x16x64_bf16 v[40:43], v[0:3], a[104:111], v74
  ds_write_b32 v79, v31 offset:832
  v_xor_b32 v75, 0x8000, v75
  v_smfmac_f32_16x16x64_bf16 v[36:39], v[4:7], a[112:119], v74
  ds_read_b128 v[0:3], v76 offset:4608
  v_mov_b32 v29, 0
  v_smfmac_f32_16x16x64_bf16 v[40:43], v[4:7], a[120:127], v74
  s_waitcnt vmcnt(2) lgkmcnt(3)
  v_mov_b32 v30, 0
  v_mfma_f32_16x16x32_bf16 v[44:47], v[44:47], v[60:63], 0
  ds_read_b128 v[4:7], v76 offset:5632
  s_waitcnt lgkmcnt(2)
  v_mfma_f32_16x16x32_bf16 v[44:47], v[48:51], v[64:67], v[44:47]
  s_barrier
  v_smfmac_f32_16x16x64_bf16 v[36:39], v[8:11], a[160:167], v74
  ds_read_b128 v[20:23], v77 offset:256
  ds_read_b128 v[24:27], v77 offset:384
  v_smfmac_f32_16x16x64_bf16 v[40:43], v[8:11], a[168:175], v74
  ds_read_b128 v[8:11], v76 offset:6656
  v_add_f32_dpp v72, v46, v44 quad_perm:[2,3,0,1] row_mask:0xf bank_mask:0xf
  v_add_f32_dpp v73, v47, v45 quad_perm:[2,3,0,1] row_mask:0xf bank_mask:0xf
  v_smfmac_f32_16x16x64_bf16 v[36:39], v[12:15], a[144:151], v74
  s_waitcnt lgkmcnt(4)
  v_exp_f32_dpp v72, v72 quad_perm:[0,1,0,1] row_mask:0xf bank_mask:0xf
  v_smfmac_f32_16x16x64_bf16 v[40:43], v[12:15], a[152:159], v74
  ds_read_b128 v[12:15], v76 offset:7680
  v_exp_f32_dpp v73, v73 quad_perm:[0,1,0,1] row_mask:0xf bank_mask:0xf
  v_smfmac_f32_16x16x64_bf16 v[36:39], v[0:3], a[32:39], v74
  s_waitcnt lgkmcnt(2)
  v_cvt_pk_bf16_f32 v72, v72, v73
  v_mfma_f32_16x16x32_bf16 v[20:23], v[20:23], v[60:63], 0
  ds_write_b32 v78, v72 offset:520
  v_mov_b64 v[16:17], 0
  v_mfma_f32_16x16x32_bf16 v[20:23], v[24:27], v[64:67], v[20:23]
  ds_read_b128 v[44:47], v75 offset:24576
  v_mov_b64 v[18:19], 0
  v_smfmac_f32_16x16x64_bf16 v[40:43], v[0:3], a[40:47], v74
  ds_read_b128 v[48:51], v75 offset:25600
  s_waitcnt lgkmcnt(4)
  v_smfmac_f32_16x16x64_bf16 v[36:39], v[4:7], a[48:55], v74
  v_add_f32_dpp v24, v22, v20 quad_perm:[2,3,0,1] row_mask:0xf bank_mask:0xf
  v_add_f32_dpp v25, v23, v21 quad_perm:[2,3,0,1] row_mask:0xf bank_mask:0xf
  v_smfmac_f32_16x16x64_bf16 v[36:39], v[8:11], a[64:71], v74
  s_waitcnt lgkmcnt(2)
  s_barrier
  ds_read_b128 v[32:35], v78 offset:512
  v_smfmac_f32_16x16x64_bf16 v[36:39], v[12:15], a[80:87], v74
  ds_read_b128 v[60:63], v75 offset:26624
  v_mul_f32 v24, s69, v24
  v_smfmac_f32_16x16x64_bf16 v[40:43], v[4:7], a[56:63], v74
  ds_read_b128 v[64:67], v75 offset:27648
  v_mul_f32 v25, s69, v25
  v_smfmac_f32_16x16x64_bf16 v[40:43], v[8:11], a[72:79], v74
  v_exp_f32_dpp v24, v24 quad_perm:[0,1,0,1] row_mask:0xf bank_mask:0xf
  v_smfmac_f32_16x16x64_bf16 v[40:43], v[12:15], a[88:95], v74
  s_waitcnt lgkmcnt(2)
  v_exp_f32_dpp v25, v25 quad_perm:[0,1,0,1] row_mask:0xf bank_mask:0xf
  v_mfma_f32_16x16x32_bf16 v[8:11], v[32:35], v[68:71], 0
  v_add_f32 v36, v36, v38
  v_add_f32 v37, v37, v39
  v_mfma_f32_16x16x32_bf16 v[0:3], v[32:35], v[52:55], 0
  v_add_f32 v40, v40, v42
  v_add_f32 v41, v41, v43
  v_mfma_f32_16x16x32_bf16 v[4:7], v[32:35], v[56:59], 0
  v_cvt_pk_bf16_f32 v28, v24, v25
  v_cvt_pk_bf16_f32 v72, v36, v37
  v_cvt_pk_bf16_f32 v73, v40, v41
  v_mfma_f32_16x16x16_bf16 v[8:11], v[28:29], v[68:69], v[8:11]
  v_cvt_pk_bf16_f32 v31, v24, v25
  v_mov_b64 v[20:21], 0
  v_mfma_f32_16x16x16_bf16 v[0:3], v[28:29], v[72:73], v[0:3]
  ds_read_b128 v[68:71], v76 offset:13824
  v_mov_b64 v[22:23], 0
  v_mfma_f32_16x16x16_bf16 v[4:7], v[30:31], v[72:73], v[4:7]
  v_rcp_f32 v10, v8
  v_rcp_f32 v11, v9
  v_mul_f32 v0, v10, v0
  v_mul_f32 v1, v11, v1
  s_nop 0
  v_mul_f32 v4, v10, v4
  v_mul_f32 v5, v11, v5
  v_cvt_pk_bf16_f32 v2, v0, v4
  ds_write_b32 v79, v2 offset:8704
  v_cvt_pk_bf16_f32 v3, v1, v5
  ds_write_b32 v79, v3 offset:9280
  v_max3_f32 v8, v8, v9, v10
  v_max_f32 v8, v8, v11
  v_cmp_le_f32 vcc, 1317011456, v8
  v_mov_b64 v[24:25], 0
  v_mov_b64 v[26:27], 0
  s_cbranch_vccnz Cf2_mx
Cf2_mxok:
  s_waitcnt lgkmcnt(0)
  s_barrier
  ds_read_b128 v[0:3], v78 offset:8704
  ds_read_b128 v[4:7], v78 offset:8768
  ds_read_b128 v[8:11], v78 offset:8832
  ds_read_b128 v[12:15], v78 offset:8896
  s_waitcnt lgkmcnt(3)
  v_smfmac_f32_16x16x64_bf16 v[16:19], v[0:3], v[44:51], v74
  ds_read_b128 v[52:55], v75 offset:40960
  s_waitcnt lgkmcnt(3)
  v_smfmac_f32_16x16x64_bf16 v[16:19], v[4:7], v[60:67], v74
  ds_read_b128 v[56:59], v75 offset:41984
  s_waitcnt lgkmcnt(3)
  v_smfmac_f32_16x16x64_bf16 v[16:19], v[8:11], a[176:183], v74
  ds_read_b128 v[36:39], v75 offset:43008
  s_waitcnt lgkmcnt(3)
  v_smfmac_f32_16x16x64_bf16 v[16:19], v[12:15], a[184:191], v74
  ds_read_b128 v[40:43], v75 offset:44032
  ds_read_b128 v[44:47], v75 offset:57344
  v_smfmac_f32_16x16x64_bf16 v[20:23], v[0:3], a[192:199], v74
  ds_read_b128 v[48:51], v75 offset:58368
  ds_read_b128 v[60:63], v75 offset:59392
  v_smfmac_f32_16x16x64_bf16 v[20:23], v[4:7], a[200:207], v74
  ds_read_b128 v[64:67], v75 offset:60416
  s_waitcnt lgkmcnt(6)
  v_cvt_pk_bf16_f32 v16, v16, v17
  v_cvt_pk_bf16_f32 v17, v18, v19
  v_bfi_b32 v16, 1, s72, v16
  v_smfmac_f32_16x16x64_bf16 v[20:23], v[8:11], v[52:59], v74
  buffer_store_dwordx2 v[16:17], v68, s[8:11], s73 offen
  s_waitcnt lgkmcnt(4)
  v_smfmac_f32_16x16x64_bf16 v[20:23], v[12:15], v[36:43], v74
  ds_read_b128 v[52:55], v75 offset:0
  v_mov_b64 v[32:33], 0
  v_smfmac_f32_16x16x64_bf16 v[24:27], v[0:3], a[208:215], v74
  ds_read_b128 v[56:59], v75 offset:1024
  v_mov_b64 v[34:35], 0
  v_smfmac_f32_16x16x64_bf16 v[24:27], v[4:7], a[216:223], v74
  ds_read_b128 v[36:39], v75 offset:2048
  s_waitcnt lgkmcnt(5)
  v_cvt_pk_bf16_f32 v20, v20, v21
  v_cvt_pk_bf16_f32 v21, v22, v23
  v_bfi_b32 v20, 1, s72, v20
  v_smfmac_f32_16x16x64_bf16 v[24:27], v[8:11], v[44:51], v74
  buffer_store_dwordx2 v[20:21], v68, s[8:11], s74 offen
  s_waitcnt lgkmcnt(3)
  v_smfmac_f32_16x16x64_bf16 v[24:27], v[12:15], v[60:67], v74
  ds_read_b128 v[40:43], v75 offset:3072
  v_mov_b64 v[28:29], 0
  v_smfmac_f32_16x16x64_bf16 v[32:35], v[0:3], a[224:231], v74
  ds_read_b128 v[44:47], v75 offset:4096
  ds_read_b128 v[48:51], v75 offset:5120
  v_smfmac_f32_16x16x64_bf16 v[32:35], v[4:7], a[232:239], v74
  ds_read_b128 v[60:63], v75 offset:6144
  v_cvt_pk_bf16_f32 v24, v24, v25
  v_cvt_pk_bf16_f32 v25, v26, v27
  v_bfi_b32 v24, 1, s72, v24
  v_smfmac_f32_16x16x64_bf16 v[32:35], v[8:11], a[240:247], v74
  buffer_store_dwordx2 v[24:25], v68, s[8:11], s75 offen
  v_mov_b64 v[30:31], 0
  v_smfmac_f32_16x16x64_bf16 v[32:35], v[12:15], a[248:255], v74
  ds_read_b128 v[64:67], v75 offset:7168
  s_waitcnt lgkmcnt(6)
  v_smfmac_f32_16x16x64_bf16 v[28:31], v[0:3], v[52:59], v74
  s_waitcnt lgkmcnt(4)
  v_smfmac_f32_16x16x64_bf16 v[28:31], v[4:7], v[36:43], v74
  s_waitcnt lgkmcnt(2)
  v_cvt_pk_bf16_f32 v32, v32, v33
  v_cvt_pk_bf16_f32 v33, v34, v35
  v_bfi_b32 v32, 1, s72, v32
  v_smfmac_f32_16x16x64_bf16 v[28:31], v[8:11], v[44:51], v74
  buffer_store_dwordx2 v[32:33], v68, s[8:11], s76 offen
  s_waitcnt lgkmcnt(0)
  v_smfmac_f32_16x16x64_bf16 v[28:31], v[12:15], v[60:67], v74
  ds_read_b128 v[0:3], v76 offset:14848
  ds_read_b64 v[16:17], v77 offset:384
  v_mov_b64 v[18:19], v[72:73]
  v_xor_b32 v75, 0x8000, v75
  s_nop 3
  v_cvt_pk_bf16_f32 v28, v28, v29
  v_cvt_pk_bf16_f32 v29, v30, v31
  v_bfi_b32 v28, 1, s72, v28
  buffer_store_dwordx2 v[28:29], v68, s[8:11], s77 offen
  v_mov_b64 v[20:21], 0
  v_mov_b64 v[22:23], 0
  v_mov_b64 v[24:25], 0
  v_mov_b64 v[26:27], 0
  v_mov_b64 v[28:29], 0
  v_mov_b64 v[30:31], 0
  v_mov_b64 v[32:33], 0
  v_mov_b64 v[34:35], 0
  s_add_u32 s58, s58, 655360
  s_add_u32 s59, s59, 655360
  s_add_u32 s70, s70, 655360
  s_add_u32 s68, s68, 655360
  s_add_u32 s66, s66, 1
  s_xor_b32 s64, s64, 16384
  s_xor_b32 s65, s65, 16384
  s_cmp_eq_u32 s66, 62
  s_cselect_b64 s[16:17], s[20:21], s[16:17]
  s_cselect_b32 s18, (Cf2_done - Cf2_last), s18
  s_cselect_b32 s70, 0, s70
  s_cmp_eq_u32 s66, 63
  s_cselect_b32 s59, 268435456, s59
  s_nop 15
  s_nop 15
  s_nop 1
  buffer_load_dwordx4 v[52:55], v76, s[8:11], s60 offen offset:0 sc1
  buffer_load_dwordx4 v[56:59], v76, s[8:11], s60 offen offset:1024 sc1
  s_nop 15
  s_nop 11
  buffer_load_dwordx4 v[36:39], v76, s[8:11], s60 offen offset:0 sc1
  buffer_load_dwordx4 v[40:43], v76, s[8:11], s60 offen offset:1024 sc1
  s_waitcnt lgkmcnt(0)
  s_waitcnt vmcnt(3)
  v_mfma_f32_16x16x32_bf16 v[4:7], v[0:3], v[52:55], 0
  v_bitop3_b32 v72, v52, v54, s72 bitop3:0x7e
  s_waitcnt vmcnt(2)
  v_mfma_f32_16x16x32_bf16 v[4:7], v[0:3], v[56:59], v[4:7]
  v_bitop3_b32 v73, v56, v58, s72 bitop3:0x7e
  v_bitop3_b32 v72, v72, v73, 1 bitop3:0xa8
  v_cmp_ne_u32 vcc, 0, v72
  s_cbranch_vccnz Cf2_h1r
  s_nop 2
  v_add_f32_dpp v4, v4, v4 row_ror:4 row_mask:0xf bank_mask:0xf
  v_add_f32_dpp v5, v5, v5 row_ror:4 row_mask:0xf bank_mask:0xf
  s_nop 0
  v_add_f32_dpp v4, v4, v4 row_ror:8 row_mask:0xf bank_mask:0xf
  v_add_f32_dpp v5, v5, v5 row_ror:8 row_mask:0xf bank_mask:0xf
  v_cvt_pk_bf16_f32 v4, v4, v5
  buffer_store_dword v4, v69, s[8:11], s62 offen
  s_xor_b32 s62, s62, 16384
  buffer_store_dword v71, v69, s[8:11], s62 offen
  s_xor_b32 s72, s72, 1
  s_branch Cf2_h2
Cf2_h1r:
  s_mov_b64 exec, vcc
  buffer_load_dwordx4 v[52:55], v76, s[8:11], s60 offen offset:0 sc1
  buffer_load_dwordx4 v[56:59], v76, s[8:11], s60 offen offset:1024 sc1
  s_mov_b64 exec, -1
  s_add_u32 s67, s67, 1
  s_waitcnt vmcnt(3)
  v_mfma_f32_16x16x32_bf16 v[4:7], v[0:3], v[36:39], 0
  v_bitop3_b32 v72, v36, v38, s72 bitop3:0x7e
  s_waitcnt vmcnt(2)
  v_mfma_f32_16x16x32_bf16 v[4:7], v[0:3], v[40:43], v[4:7]
  v_bitop3_b32 v73, v40, v42, s72 bitop3:0x7e
  v_bitop3_b32 v72, v72, v73, 1 bitop3:0xa8
  v_cmp_ne_u32 vcc, 0, v72
  s_cbranch_vccz Cf2_h1p
  s_mov_b64 exec, vcc
  buffer_load_dwordx4 v[36:39], v76, s[8:11], s60 offen offset:0 sc1
  buffer_load_dwordx4 v[40:43], v76, s[8:11], s60 offen offset:1024 sc1
  s_mov_b64 exec, -1
  s_add_u32 s67, s67, 1
  s_waitcnt vmcnt(3)
  v_mfma_f32_16x16x32_bf16 v[4:7], v[0:3], v[52:55], 0
  v_bitop3_b32 v72, v52, v54, s72 bitop3:0x7e
  s_waitcnt vmcnt(2)
  v_mfma_f32_16x16x32_bf16 v[4:7], v[0:3], v[56:59], v[4:7]
  v_bitop3_b32 v73, v56, v58, s72 bitop3:0x7e
  v_bitop3_b32 v72, v72, v73, 1 bitop3:0xa8
  v_cmp_ne_u32 vcc, 0, v72
  s_cbranch_vccz Cf2_h1p
Cf2_h1s:
  s_mov_b64 exec, vcc
  buffer_load_dwordx4 v[52:55], v76, s[8:11], s60 offen offset:0 sc1
  buffer_load_dwordx4 v[56:59], v76, s[8:11], s60 offen offset:1024 sc1
  s_mov_b64 exec, -1
  s_add_u32 s67, s67, 1
  s_waitcnt vmcnt(3)
  v_mfma_f32_16x16x32_bf16 v[4:7], v[0:3], v[36:39], 0
  v_bitop3_b32 v72, v36, v38, s72 bitop3:0x7e
  s_waitcnt vmcnt(2)
  v_mfma_f32_16x16x32_bf16 v[4:7], v[0:3], v[40:43], v[4:7]
  v_bitop3_b32 v73, v40, v42, s72 bitop3:0x7e
  v_bitop3_b32 v72, v72, v73, 1 bitop3:0xa8
  v_cmp_ne_u32 vcc, 0, v72
  s_cbranch_vccz Cf2_h1p
  s_mov_b64 exec, vcc
  buffer_load_dwordx4 v[36:39], v76, s[8:11], s60 offen offset:0 sc1
  buffer_load_dwordx4 v[40:43], v76, s[8:11], s60 offen offset:1024 sc1
  s_mov_b64 exec, -1
  s_add_u32 s67, s67, 1
  s_waitcnt vmcnt(3)
  v_mfma_f32_16x16x32_bf16 v[4:7], v[0:3], v[52:55], 0
  v_bitop3_b32 v72, v52, v54, s72 bitop3:0x7e
  s_waitcnt vmcnt(2)
  v_mfma_f32_16x16x32_bf16 v[4:7], v[0:3], v[56:59], v[4:7]
  v_bitop3_b32 v73, v56, v58, s72 bitop3:0x7e
  v_bitop3_b32 v72, v72, v73, 1 bitop3:0xa8
  v_cmp_ne_u32 vcc, 0, v72
  s_cbranch_vccz Cf2_h1p
  s_cmp_lt_u32 s67, 131072
  s_cbranch_scc1 Cf2_h1s
Cf2_h1p:
  s_nop 2
  v_add_f32_dpp v4, v4, v4 row_ror:4 row_mask:0xf bank_mask:0xf
  v_add_f32_dpp v5, v5, v5 row_ror:4 row_mask:0xf bank_mask:0xf
  s_nop 0
  v_add_f32_dpp v4, v4, v4 row_ror:8 row_mask:0xf bank_mask:0xf
  v_add_f32_dpp v5, v5, v5 row_ror:8 row_mask:0xf bank_mask:0xf
  v_cvt_pk_bf16_f32 v4, v4, v5
  buffer_store_dword v4, v69, s[8:11], s62 offen
  s_xor_b32 s62, s62, 16384
  buffer_store_dword v71, v69, s[8:11], s62 offen
  s_xor_b32 s72, s72, 1
  s_branch Cf2_h2
Cf2_h2r:
  s_mov_b64 exec, vcc
  buffer_load_dwordx4 v[12:15], v76, s[8:11], s65 offen offset:3072 sc1
  s_mov_b64 exec, -1
  s_add_u32 s67, s67, 1
  s_waitcnt vmcnt(4)
  v_max3_u32 v72, v12, v13, v14
  v_max_u32 v72, v72, v15
  ds_write_b128 v76, v[12:15] offset:7680
  v_cmp_eq_u32 vcc, -1, v72
  s_cbranch_vccz Cf2_h2w
  s_mov_b64 exec, vcc
  buffer_load_dwordx4 v[12:15], v76, s[8:11], s65 offen offset:3072 sc1
  s_mov_b64 exec, -1
  s_add_u32 s67, s67, 1
  s_waitcnt vmcnt(4)
  v_max3_u32 v72, v12, v13, v14
  v_max_u32 v72, v72, v15
  ds_write_b128 v76, v[12:15] offset:7680
  v_cmp_eq_u32 vcc, -1, v72
  s_cbranch_vccz Cf2_h2w
Cf2_h2s:
  s_mov_b64 exec, vcc
  buffer_load_dwordx4 v[12:15], v76, s[8:11], s65 offen offset:3072 sc1
  s_mov_b64 exec, -1
  s_add_u32 s67, s67, 1
  s_waitcnt vmcnt(2)
  v_max3_u32 v72, v12, v13, v14
  v_max_u32 v72, v72, v15
  ds_write_b128 v76, v[12:15] offset:7680
  v_cmp_eq_u32 vcc, -1, v72
  s_cbranch_vccz Cf2_h2w
  s_mov_b64 exec, vcc
  buffer_load_dwordx4 v[12:15], v76, s[8:11], s65 offen offset:3072 sc1
  s_mov_b64 exec, -1
  s_add_u32 s67, s67, 1
  s_waitcnt vmcnt(2)
  v_max3_u32 v72, v12, v13, v14
  v_max_u32 v72, v72, v15
  ds_write_b128 v76, v[12:15] offset:7680
  v_cmp_eq_u32 vcc, -1, v72
  s_cbranch_vccz Cf2_h2w
  s_mov_b64 exec, vcc
  buffer_load_dwordx4 v[12:15], v76, s[8:11], s65 offen offset:3072 sc1
  s_mov_b64 exec, -1
  s_add_u32 s67, s67, 1
  s_waitcnt vmcnt(2)
  v_max3_u32 v72, v12, v13, v14
  v_max_u32 v72, v72, v15
  ds_write_b128 v76, v[12:15] offset:7680
  v_cmp_eq_u32 vcc, -1, v72
  s_cbranch_vccz Cf2_h2w
  s_cmp_lt_u32 s67, 131072
  s_cbranch_scc1 Cf2_h2s
Cf2_h2ok:
  ds_write_b128 v76, v[12:15] offset:7680
  s_branch Cf2_h2w
Cf2_rec:
  s_nop 7
  s_waitcnt vmcnt(0) lgkmcnt(0)
  v_max3_u32 v72, v0, v1, v2
  v_max3_u32 v72, v72, v3, v4
  v_max3_u32 v72, v72, v5, v6
  v_max3_u32 v72, v72, v7, v8
  v_max3_u32 v72, v72, v9, v10
  v_max3_u32 v72, v72, v11, v12
  v_max3_u32 v72, v72, v13, v14
  v_max3_u32 v72, v72, v15, v16
  v_max3_u32 v72, v72, v17, v18
  v_max_u32 v72, v72, v19
  v_cmp_eq_u32 vcc, -1, v72
  s_cbranch_vccz Cf2_recok
  s_barrier
Cf2_recp:
  buffer_load_dwordx4 v[0:3], v76, s[8:11], s64 offen offset:0 sc1
  buffer_load_dwordx4 v[4:7], v76, s[8:11], s64 offen offset:1024 sc1
  s_add_u32 s67, s67, 1
  s_cmp_lt_u32 s67, 131072
  s_cselect_b32 s54, -2, -1
  s_waitcnt vmcnt(1)
  v_max3_u32 v72, v0, v1, v2
  s_waitcnt vmcnt(0)
  v_max3_u32 v72, v72, v3, v4
  v_max3_u32 v72, v72, v5, v6
  v_max_u32 v72, v72, v7
  v_cmp_lt_u32 vcc, s54, v72
  s_cbranch_vccnz Cf2_recp
  ds_write_b128 v76, v[0:3] offset:8704
  ds_write_b128 v76, v[4:7] offset:9728
  v_mov_b64 v[20:21], 0
  v_mov_b64 v[22:23], 0
  v_mov_b64 v[24:25], 0
  v_mov_b64 v[26:27], 0
  v_mov_b64 v[28:29], 0
  v_mov_b64 v[30:31], 0
  v_mov_b64 v[32:33], 0
  v_mov_b64 v[34:35], 0
  s_waitcnt lgkmcnt(0)
  s_barrier
  ds_read_b128 v[0:3], v76 offset:4608
  ds_read_b128 v[60:63], v76 offset:24576
  ds_read_b128 v[64:67], v76 offset:25600
  s_waitcnt lgkmcnt(0)
  v_smfmac_f32_16x16x64_bf16 v[20:23], v[0:3], v[60:67], v74
  ds_read_b128 v[60:63], v76 offset:26624
  ds_read_b128 v[64:67], v76 offset:27648
  s_waitcnt lgkmcnt(0)
  v_smfmac_f32_16x16x64_bf16 v[24:27], v[0:3], v[60:67], v74
  ds_read_b128 v[60:63], v76 offset:40960
  ds_read_b128 v[64:67], v76 offset:41984
  s_waitcnt lgkmcnt(0)
  v_smfmac_f32_16x16x64_bf16 v[28:31], v[0:3], v[60:67], v74
  ds_read_b128 v[60:63], v76 offset:43008
  ds_read_b128 v[64:67], v76 offset:44032
  s_waitcnt lgkmcnt(0)
  v_smfmac_f32_16x16x64_bf16 v[32:35], v[0:3], v[60:67], v74
  ds_read_b128 v[4:7], v76 offset:5632
  s_waitcnt lgkmcnt(0)
  v_smfmac_f32_16x16x64_bf16 v[20:23], v[4:7], v[80:87], v74
  v_smfmac_f32_16x16x64_bf16 v[24:27], v[4:7], v[88:95], v74
  v_smfmac_f32_16x16x64_bf16 v[28:31], v[4:7], v[208:215], v74
  v_smfmac_f32_16x16x64_bf16 v[32:35], v[4:7], v[216:223], v74
  ds_read_b128 v[8:11], v76 offset:6656
  s_waitcnt lgkmcnt(0)
  v_smfmac_f32_16x16x64_bf16 v[20:23], v[8:11], v[96:103], v74
  v_smfmac_f32_16x16x64_bf16 v[24:27], v[8:11], v[104:111], v74
  ds_read_b128 v[60:63], v76 offset:57344
  ds_read_b128 v[64:67], v76 offset:58368
  s_waitcnt lgkmcnt(0)
  v_smfmac_f32_16x16x64_bf16 v[28:31], v[8:11], v[60:67], v74
  ds_read_b128 v[60:63], v76 offset:59392
  ds_read_b128 v[64:67], v76 offset:60416
  s_waitcnt lgkmcnt(0)
  v_smfmac_f32_16x16x64_bf16 v[32:35], v[8:11], v[60:67], v74
  ds_read_b128 v[12:15], v76 offset:7680
  s_waitcnt lgkmcnt(0)
  v_smfmac_f32_16x16x64_bf16 v[20:23], v[12:15], v[112:119], v74
  v_smfmac_f32_16x16x64_bf16 v[24:27], v[12:15], v[120:127], v74
  v_smfmac_f32_16x16x64_bf16 v[28:31], v[12:15], v[224:231], v74
  v_smfmac_f32_16x16x64_bf16 v[32:35], v[12:15], v[232:239], v74
  ds_read_b128 v[0:3], v76 offset:8704
  s_waitcnt lgkmcnt(0)
  v_smfmac_f32_16x16x64_bf16 v[20:23], v[0:3], v[128:135], v74
  v_smfmac_f32_16x16x64_bf16 v[24:27], v[0:3], v[136:143], v74
  ds_read_b128 v[60:63], v75 offset:8192
  ds_read_b128 v[64:67], v75 offset:9216
  s_waitcnt lgkmcnt(0)
  v_smfmac_f32_16x16x64_bf16 v[28:31], v[0:3], v[60:67], v74
  ds_read_b128 v[60:63], v75 offset:10240
  ds_read_b128 v[64:67], v75 offset:11264
  s_waitcnt lgkmcnt(0)
  v_smfmac_f32_16x16x64_bf16 v[32:35], v[0:3], v[60:67], v74
  ds_read_b128 v[4:7], v76 offset:9728
  s_waitcnt lgkmcnt(0)
  v_smfmac_f32_16x16x64_bf16 v[20:23], v[4:7], v[144:151], v74
  v_smfmac_f32_16x16x64_bf16 v[24:27], v[4:7], v[152:159], v74
  ds_read_b128 v[60:63], v75 offset:24576
  ds_read_b128 v[64:67], v75 offset:25600
  s_waitcnt lgkmcnt(0)
  v_smfmac_f32_16x16x64_bf16 v[28:31], v[4:7], v[60:67], v74
  ds_read_b128 v[60:63], v75 offset:26624
  ds_read_b128 v[64:67], v75 offset:27648
  s_waitcnt lgkmcnt(0)
  v_smfmac_f32_16x16x64_bf16 v[32:35], v[4:7], v[60:67], v74
  ds_read_b128 v[16:19], v76 offset:10752
  s_waitcnt lgkmcnt(0)
  v_smfmac_f32_16x16x64_bf16 v[20:23], v[16:19], v[160:167], v74
  v_smfmac_f32_16x16x64_bf16 v[24:27], v[16:19], v[168:175], v74
  v_smfmac_f32_16x16x64_bf16 v[28:31], v[16:19], v[240:247], v74
  v_smfmac_f32_16x16x64_bf16 v[32:35], v[16:19], v[248:255], v74
  ds_read_b128 v[12:15], v76 offset:11776
  s_waitcnt lgkmcnt(0)
  v_smfmac_f32_16x16x64_bf16 v[20:23], v[12:15], v[176:183], v74
  v_smfmac_f32_16x16x64_bf16 v[24:27], v[12:15], v[184:191], v74
  v_smfmac_f32_16x16x64_bf16 v[28:31], v[12:15], a[0:7], v74
  v_smfmac_f32_16x16x64_bf16 v[32:35], v[12:15], a[8:15], v74
  ds_read_b128 v[8:11], v76 offset:12800
  s_waitcnt lgkmcnt(0)
  v_smfmac_f32_16x16x64_bf16 v[20:23], v[8:11], v[192:199], v74
  v_smfmac_f32_16x16x64_bf16 v[24:27], v[8:11], v[200:207], v74
  v_smfmac_f32_16x16x64_bf16 v[28:31], v[8:11], a[16:23], v74
  v_smfmac_f32_16x16x64_bf16 v[32:35], v[8:11], a[24:31], v74
  v_add_f32 v20, v20, v22
  v_add_f32 v21, v21, v23
  v_add_f32 v24, v24, v26
  v_cvt_pk_bf16_f32 v22, v20, v24
  s_nop 0
  ds_write_b32 v79, v22 offset:0
  v_add_f32 v25, v25, v27
  v_cvt_pk_bf16_f32 v23, v21, v25
  ds_write_b32 v79, v23 offset:576
  v_add_f32 v28, v28, v30
  v_add_f32 v29, v29, v31
  s_waitcnt lgkmcnt(0)
  s_nop 1
  s_branch Cf2_recok
Cf2_mx:
  s_waitcnt lgkmcnt(0)
  s_barrier
  buffer_load_dwordx4 v[0:3], v76, s[8:11], s58 offen offset:0 sc1
  ds_read_b128 v[20:23], v77 offset:0
  ds_read_b128 v[28:31], v77 offset:256
  buffer_load_dwordx4 v[4:7], v76, s[8:11], s58 offen offset:1024 sc1
  ds_read_b128 v[24:27], v77 offset:128
  ds_read_b128 v[32:35], v77 offset:384
  s_waitcnt vmcnt(1) lgkmcnt(3)
  v_mfma_f32_16x16x32_bf16 v[8:11], v[0:3], v[20:23], 0
  s_waitcnt vmcnt(0) lgkmcnt(1)
  v_mfma_f32_16x16x32_bf16 v[8:11], v[4:7], v[24:27], v[8:11]
  v_mfma_f32_16x16x32_bf16 v[12:15], v[28:31], v[20:23], 0
  s_waitcnt lgkmcnt(0)
  v_mfma_f32_16x16x32_bf16 v[12:15], v[32:35], v[24:27], v[12:15]
  v_add_f32_dpp v8, v10, v8 quad_perm:[2,3,0,1] row_mask:0xf bank_mask:0xf
  v_add_f32_dpp v9, v11, v9 quad_perm:[2,3,0,1] row_mask:0xf bank_mask:0xf
  s_nop 0
  v_mov_b32_dpp v8, v8 quad_perm:[0,1,0,1] row_mask:0xf bank_mask:0xf
  v_mov_b32_dpp v9, v9 quad_perm:[0,1,0,1] row_mask:0xf bank_mask:0xf
  s_nop 1
  v_add_f32_dpp v12, v14, v12 quad_perm:[2,3,0,1] row_mask:0xf bank_mask:0xf
  v_add_f32_dpp v13, v15, v13 quad_perm:[2,3,0,1] row_mask:0xf bank_mask:0xf
  s_nop 0
  v_mov_b32_dpp v12, v12 quad_perm:[0,1,0,1] row_mask:0xf bank_mask:0xf
  v_mov_b32_dpp v13, v13 quad_perm:[0,1,0,1] row_mask:0xf bank_mask:0xf
  v_mul_f32 v12, s69, v12
  ds_write_b32 v78, v8 offset:8712
  v_mul_f32 v13, s69, v13
  ds_write_b32 v78, v9 offset:8776
  s_waitcnt lgkmcnt(0)
  s_barrier
  ds_read_b128 v[36:39], v78 offset:8704
  ds_read_b128 v[40:43], v78 offset:8768
  s_waitcnt lgkmcnt(0)
  s_barrier
  v_max_f32 v16, v36, v37
  v_max3_f32 v16, v16, v38, v39
  v_max3_f32 v16, v16, v40, v41
  v_max3_f32 v16, v16, v42, v43
  v_max3_f32 v16, v16, v12, v13
  v_mov_b32 v17, v16
  s_nop 1
  v_permlane16_swap_b32 v16, v17
  v_max_f32 v16, v16, v17
  v_mov_b32 v17, v16
  s_nop 1
  v_permlane32_swap_b32 v16, v17
  v_max_f32 v16, v16, v17
  v_sub_f32 v36, v36, v16
  v_sub_f32 v37, v37, v16
  v_sub_f32 v38, v38, v16
  v_sub_f32 v39, v39, v16
  v_sub_f32 v40, v40, v16
  v_sub_f32 v41, v41, v16
  v_sub_f32 v42, v42, v16
  v_sub_f32 v43, v43, v16
  v_sub_f32 v12, v12, v16
  v_sub_f32 v13, v13, v16
  v_exp_f32 v36, v36
  v_exp_f32 v37, v37
  v_exp_f32 v38, v38
  v_exp_f32 v39, v39
  v_exp_f32 v40, v40
  v_exp_f32 v41, v41
  v_exp_f32 v42, v42
  v_exp_f32 v43, v43
  v_exp_f32 v12, v12
  v_exp_f32 v13, v13
  v_cvt_pk_bf16_f32 v32, v36, v40
  v_cvt_pk_bf16_f32 v33, v37, v41
  v_cvt_pk_bf16_f32 v34, v38, v42
  v_cvt_pk_bf16_f32 v35, v39, v43
  v_cvt_pk_bf16_f32 v28, v12, v13
  v_cvt_pk_bf16_f32 v31, v12, v13
  v_mov_b32 v29, 0
  v_mov_b32 v30, 0
  v_mov_b32 v68, 0x3f803f80
  v_mov_b32 v69, 0x3f803f80
  v_mov_b32 v70, 0x3f803f80
  v_mov_b32 v71, 0x3f803f80
  s_nop 1
  v_mfma_f32_16x16x32_bf16 v[8:11], v[32:35], v[68:71], 0
  v_mfma_f32_16x16x32_bf16 v[0:3], v[32:35], v[52:55], 0
  v_mfma_f32_16x16x32_bf16 v[4:7], v[32:35], v[56:59], 0
  v_mfma_f32_16x16x16_bf16 v[8:11], v[28:29], v[68:69], v[8:11]
  v_mfma_f32_16x16x16_bf16 v[0:3], v[28:29], v[72:73], v[0:3]
  v_mfma_f32_16x16x16_bf16 v[4:7], v[30:31], v[72:73], v[4:7]
  ds_read_b128 v[68:71], v76 offset:13824
  v_rcp_f32 v10, v8
  v_rcp_f32 v11, v9
  v_mul_f32 v0, v10, v0
  v_mul_f32 v1, v11, v1
  s_nop 0
  v_mul_f32 v4, v10, v4
  v_mul_f32 v5, v11, v5
  v_cvt_pk_bf16_f32 v2, v0, v4
  ds_write_b32 v79, v2 offset:8704
  v_cvt_pk_bf16_f32 v3, v1, v5
  ds_write_b32 v79, v3 offset:9280
  v_mov_b64 v[16:17], 0
  v_mov_b64 v[18:19], 0
  v_mov_b64 v[20:21], 0
  v_mov_b64 v[22:23], 0
  v_mov_b64 v[24:25], 0
  v_mov_b64 v[26:27], 0
  s_branch Cf2_mxok
Cf2_last:
  ds_read_b128 v[8:11], v76 offset:6656
  ds_read_b128 v[60:63], v76 offset:43008
  ds_read_b128 v[64:67], v76 offset:44032
  ds_read_b128 v[44:47], v76 offset:57344
  ds_read_b128 v[48:51], v76 offset:58368
  s_waitcnt lgkmcnt(6)
  v_smfmac_f32_16x16x64_bf16 v[28:31], v[0:3], v[36:43], v74
  v_smfmac_f32_16x16x64_bf16 v[20:23], v[0:3], a[32:39], v74
  ds_read_b128 v[36:39], v76 offset:59392
  ds_read_b128 v[40:43], v76 offset:60416
  v_smfmac_f32_16x16x64_bf16 v[24:27], v[0:3], a[40:47], v74
  s_waitcnt lgkmcnt(7)
  v_smfmac_f32_16x16x64_bf16 v[20:23], v[4:7], a[48:55], v74
  buffer_store_dwordx4 v[16:19], v76, s[8:11], s68 offen sc1
  v_smfmac_f32_16x16x64_bf16 v[24:27], v[4:7], a[56:63], v74
  s_waitcnt lgkmcnt(4)
  v_smfmac_f32_16x16x64_bf16 v[28:31], v[4:7], v[208:215], v74
  v_smfmac_f32_16x16x64_bf16 v[32:35], v[4:7], v[216:223], v74
  s_waitcnt lgkmcnt(2)
  v_smfmac_f32_16x16x64_bf16 v[32:35], v[0:3], v[60:67], v74
  v_smfmac_f32_16x16x64_bf16 v[20:23], v[8:11], a[64:71], v74
  ds_read_b128 v[60:63], v75 offset:8192
  ds_read_b128 v[64:67], v75 offset:9216
  v_smfmac_f32_16x16x64_bf16 v[24:27], v[8:11], a[72:79], v74
  v_smfmac_f32_16x16x64_bf16 v[28:31], v[8:11], v[44:51], v74
  v_smfmac_f32_16x16x64_bf16 v[20:23], v[12:15], a[80:87], v74
  ds_read_b128 v[44:47], v75 offset:10240
  ds_read_b128 v[48:51], v75 offset:11264
  v_smfmac_f32_16x16x64_bf16 v[24:27], v[12:15], a[88:95], v74
  s_waitcnt lgkmcnt(4)
  v_smfmac_f32_16x16x64_bf16 v[28:31], v[12:15], v[224:231], v74
  v_smfmac_f32_16x16x64_bf16 v[32:35], v[12:15], v[232:239], v74
  v_smfmac_f32_16x16x64_bf16 v[32:35], v[8:11], v[36:43], v74
  ds_read_b128 v[36:39], v75 offset:24576
  ds_read_b128 v[40:43], v75 offset:25600
  s_waitcnt vmcnt(1)
  s_barrier
Cf2_lastr:
  ds_read_b128 v[0:3], v76 offset:8704
  ds_read_b128 v[4:7], v76 offset:9728
  ds_read_b128 v[16:19], v76 offset:10752
  ds_read_b128 v[12:15], v76 offset:11776
  ds_read_b128 v[8:11], v76 offset:12800
  s_waitcnt lgkmcnt(4)
  v_max3_u32 v72, v0, v1, v2
  s_waitcnt lgkmcnt(3)
  v_max3_u32 v72, v72, v3, v4
  v_max3_u32 v72, v72, v5, v6
  s_waitcnt lgkmcnt(0)
  v_max3_u32 v72, v72, v7, v8
  v_max3_u32 v72, v72, v9, v10
  v_max3_u32 v72, v72, v11, v12
  v_max3_u32 v72, v72, v13, v14
  v_max3_u32 v72, v72, v15, v16
  v_max3_u32 v72, v72, v17, v18
  v_max_u32 v72, v72, v19
  v_cmp_eq_u32 vcc, -1, v72
  s_cbranch_vccnz Cf2_lastp
Cf2_lastg:
  v_smfmac_f32_16x16x64_bf16 v[28:31], v[0:3], v[60:67], v74
  ds_read_b128 v[60:63], v75 offset:26624
  ds_read_b128 v[64:67], v75 offset:27648
  v_smfmac_f32_16x16x64_bf16 v[32:35], v[0:3], v[44:51], v74
  v_smfmac_f32_16x16x64_bf16 v[28:31], v[4:7], v[36:43], v74
  v_smfmac_f32_16x16x64_bf16 v[28:31], v[16:19], v[240:247], v74
  v_smfmac_f32_16x16x64_bf16 v[28:31], v[12:15], a[0:7], v74
  v_smfmac_f32_16x16x64_bf16 v[28:31], v[8:11], a[16:23], v74
  v_smfmac_f32_16x16x64_bf16 v[32:35], v[16:19], v[248:255], v74
  v_smfmac_f32_16x16x64_bf16 v[32:35], v[12:15], a[8:15], v74
  s_waitcnt lgkmcnt(0)
  v_smfmac_f32_16x16x64_bf16 v[32:35], v[8:11], a[24:31], v74
  v_smfmac_f32_16x16x64_bf16 v[32:35], v[4:7], v[60:67], v74
  v_smfmac_f32_16x16x64_bf16 v[20:23], v[0:3], a[96:103], v74
  v_smfmac_f32_16x16x64_bf16 v[20:23], v[4:7], a[112:119], v74
  v_add_f32 v28, v28, v30
  v_add_f32 v32, v32, v34
  v_cvt_pk_bf16_f32 v30, v28, v32
  v_smfmac_f32_16x16x64_bf16 v[20:23], v[16:19], a[128:135], v74
  ds_write_b32 v79, v30 offset:256
  v_add_f32 v29, v29, v31
  v_add_f32 v33, v33, v35
  v_cvt_pk_bf16_f32 v31, v29, v33
  v_smfmac_f32_16x16x64_bf16 v[20:23], v[12:15], a[144:151], v74
  ds_write_b32 v79, v31 offset:832
  v_smfmac_f32_16x16x64_bf16 v[20:23], v[8:11], a[160:167], v74
  v_smfmac_f32_16x16x64_bf16 v[24:27], v[0:3], a[104:111], v74
  v_smfmac_f32_16x16x64_bf16 v[24:27], v[4:7], a[120:127], v74
  v_smfmac_f32_16x16x64_bf16 v[24:27], v[16:19], a[136:143], v74
  s_waitcnt lgkmcnt(0)
  s_barrier
  ds_read_b64 v[52:53], v77 offset:384
  v_add_f32 v20, v20, v22
  v_smfmac_f32_16x16x64_bf16 v[24:27], v[12:15], a[152:159], v74
  v_add_f32 v21, v21, v23
  v_smfmac_f32_16x16x64_bf16 v[24:27], v[8:11], a[168:175], v74
  v_cvt_pk_bf16_f32 v54, v20, v21
  s_add_u32 s68, s68, 655360
  s_nop 3
  v_add_f32 v24, v24, v26
  v_add_f32 v25, v25, v27
  v_cvt_pk_bf16_f32 v55, v24, v25
  s_waitcnt lgkmcnt(0)
  buffer_store_dwordx4 v[52:55], v76, s[8:11], s68 offen sc1
  s_branch Cf2_done
Cf2_lastp:
  s_add_u32 s72, s72, 2
  s_cmp_ge_u32 s72, 131072
  s_cbranch_scc1 Cf2_lastg
  s_barrier
  s_waitcnt vmcnt(0)
  s_barrier
  s_branch Cf2_lastr
Cf2_done:
  s_branch L_cexit
L_w3:
  v_mov_b64 v[20:21], 0
  v_mov_b64 v[22:23], 0
  v_mov_b64 v[24:25], 0
  v_mov_b64 v[26:27], 0
  v_mov_b64 v[28:29], 0
  v_mov_b64 v[30:31], 0
  v_mov_b64 v[32:33], 0
  v_mov_b64 v[34:35], 0
  s_mov_b32 s78, 0x3f803f80
  s_mov_b32 s79, s78
  s_mov_b32 s65, 360448
  s_mov_b32 m0, 16128
  s_lshl_b32 s71, s53, 2
  s_add_u32 s71, s71, 128
  s_movk_i32 s56, 0x1000
  v_lshlrev_b32 v73, 2, v76
  v_mov_b32 v72, 0
  s_mov_b64 s[16:17], s[8:9]
  s_mov_b32 s18, 268435456
  s_mov_b32 s19, 0x20000
  s_getpc_b64 s[20:21]
Cf3_pc:
  s_add_u32 s20, s20, (Cf3_last - Cf3_pc)
  s_addc_u32 s21, s21, 0
  buffer_load_dwordx4 v[52:55], v76, s[8:11], s59 offen offset:0 sc1
  buffer_load_dwordx4 v[56:59], v76, s[8:11], s59 offen offset:1024 sc1
  ds_read_b128 v[60:63], v76 offset:28672
  ds_read_b128 v[64:67], v76 offset:29696
  ds_read_b128 v[44:47], v76 offset:30720
  ds_read_b128 v[48:51], v76 offset:31744
  ds_read_b128 v[36:39], v76 offset:45056
  ds_read_b128 v[40:43], v76 offset:46080
  ds_read_b128 v[0:3], v76 offset:4608
  ds_read_b128 v[4:7], v76 offset:5632
  s_waitcnt lgkmcnt(0)
  s_branch Cf3_top2
.p2align 6
Cf3_h2:
  v_lshlrev_b32 v73, 2, v76
  s_mov_b32 m0, 12800
  s_add_u32 s55, s65, 8192
  s_waitcnt vmcnt(4)
  ds_read_b128 v[60:63], v76 offset:28672
  ds_read_b128 v[64:67], v76 offset:29696
  ds_read_b128 v[44:47], v76 offset:30720
  ds_read_b128 v[48:51], v76 offset:31744
  ds_read_b128 v[36:39], v76 offset:45056
  ds_read_b128 v[40:43], v76 offset:46080
  buffer_load_dwordx4 v[52:55], v76, s[8:11], s59 offen offset:0 sc1
  buffer_load_dwordx4 v[56:59], v76, s[8:11], s59 offen offset:1024 sc1
  s_cmp_eq_u32 s66, 12
  s_cselect_b32 s56, s71, 0x1000
  ds_read_b32 v72, v76 offset:16128
  s_cmp_eq_u32 s66, 13
  s_cselect_b32 s54, 0x700, 0
  s_waitcnt lgkmcnt(0)
  v_readfirstlane_b32 s57, v72
  s_nop 0
  s_cmp_lt_u32 s57, s54
  s_cbranch_scc1 Cf3_kv3
Cf3_h2w:
  s_cmp_eq_u32 s66, 63
  s_waitcnt lgkmcnt(0)
  s_barrier
  ds_read_b128 v[0:3], v76 offset:4608
  ds_read_b128 v[4:7], v76 offset:5632
  buffer_load_dwordx4 v76, s[8:11], s55 offen offset:0 sc1 lds
  s_cbranch_scc1 Cf3_last
Cf3_top2:
  ds_read_b128 v[8:11], v76 offset:6656
  s_mov_b32 m0, 16128
  s_waitcnt lgkmcnt(2)
  v_smfmac_f32_16x16x64_bf16 v[20:23], v[0:3], v[60:67], v74
  ds_read_b128 v[60:63], v76 offset:47104
  v_smfmac_f32_16x16x64_bf16 v[24:27], v[0:3], v[44:51], v74
  buffer_load_dwordx4 v[44:47], v76, s[8:11], s58 offen offset:0 sc1
  ds_read_b128 v[64:67], v76 offset:48128
  s_waitcnt lgkmcnt(3)
  v_smfmac_f32_16x16x64_bf16 v[20:23], v[4:7], v[80:87], v74
  buffer_load_dwordx4 v[48:51], v76, s[8:11], s58 offen offset:1024 sc1
  v_smfmac_f32_16x16x64_bf16 v[28:31], v[0:3], v[36:43], v74
  ds_read_b128 v[36:39], v76 offset:61440
  v_smfmac_f32_16x16x64_bf16 v[24:27], v[4:7], v[88:95], v74
  ds_read_b128 v[40:43], v76 offset:62464
  s_waitcnt lgkmcnt(4)
  v_smfmac_f32_16x16x64_bf16 v[28:31], v[4:7], v[208:215], v74
  ds_read_b128 v[12:15], v76 offset:7680
  v_smfmac_f32_16x16x64_bf16 v[32:35], v[4:7], v[216:223], v74
  buffer_store_dwordx4 v[16:19], v76, s[8:11], s68 offen sc1
  s_waitcnt lgkmcnt(3)
  v_smfmac_f32_16x16x64_bf16 v[32:35], v[0:3], v[60:67], v74
  buffer_load_dword v73, s[16:19], s70 offen  lds
  v_smfmac_f32_16x16x64_bf16 v[20:23], v[8:11], v[96:103], v74
  ds_read_b128 v[60:63], v76 offset:63488
  v_smfmac_f32_16x16x64_bf16 v[24:27], v[8:11], v[104:111], v74
  ds_read_b128 v[64:67], v76 offset:64512
  s_waitcnt lgkmcnt(3)
  v_smfmac_f32_16x16x64_bf16 v[28:31], v[8:11], v[36:43], v74
  ds_read_b128 v[36:39], v75 offset:12288
  s_waitcnt lgkmcnt(3)
  v_smfmac_f32_16x16x64_bf16 v[20:23], v[12:15], v[112:119], v74
  buffer_load_dword off, s[12:15], s56 sc1 lds
  ds_read_b128 v[40:43], v75 offset:13312
  v_smfmac_f32_16x16x64_bf16 v[24:27], v[12:15], v[120:127], v74
  s_waitcnt vmcnt(5)
  v_smfmac_f32_16x16x64_bf16 v[28:31], v[12:15], v[224:231], v74
  s_barrier
  ds_read_b128 v[0:3], v76 offset:8704
  v_smfmac_f32_16x16x64_bf16 v[32:35], v[12:15], v[232:239], v74
  ds_read_b128 v[4:7], v76 offset:9728
  s_waitcnt lgkmcnt(4)
  v_smfmac_f32_16x16x64_bf16 v[32:35], v[8:11], v[60:67], v74
  ds_read_b128 v[60:63], v75 offset:14336
  s_waitcnt lgkmcnt(2)
  v_smfmac_f32_16x16x64_bf16 v[20:23], v[0:3], v[128:135], v74
  ds_read_b128 v[16:19], v76 offset:10752
  v_smfmac_f32_16x16x64_bf16 v[24:27], v[0:3], v[136:143], v74
  ds_read_b128 v[64:67], v75 offset:15360
  v_smfmac_f32_16x16x64_bf16 v[28:31], v[0:3], v[36:43], v74
  ds_read_b128 v[36:39], v75 offset:28672
  s_waitcnt lgkmcnt(4)
  v_smfmac_f32_16x16x64_bf16 v[20:23], v[4:7], v[144:151], v74
  ds_read_b128 v[12:15], v76 offset:11776
  v_smfmac_f32_16x16x64_bf16 v[24:27], v[4:7], v[152:159], v74
  ds_read_b128 v[40:43], v75 offset:29696
  s_waitcnt lgkmcnt(4)
  v_smfmac_f32_16x16x64_bf16 v[20:23], v[16:19], v[160:167], v74
  ds_read_b128 v[8:11], v76 offset:12800
  s_waitcnt lgkmcnt(4)
  v_smfmac_f32_16x16x64_bf16 v[32:35], v[0:3], v[60:67], v74
  ds_read_b128 v[60:63], v75 offset:30720
  v_mov_b64 v[68:69], s[78:79]
  v_smfmac_f32_16x16x64_bf16 v[24:27], v[16:19], v[168:175], v74
  ds_read_b128 v[64:67], v75 offset:31744
  s_waitcnt lgkmcnt(4)
  v_smfmac_f32_16x16x64_bf16 v[20:23], v[12:15], v[176:183], v74
  s_waitcnt lgkmcnt(3)
  v_mov_b64 v[70:71], s[78:79]
  v_smfmac_f32_16x16x64_bf16 v[28:31], v[4:7], v[36:43], v74
  s_waitcnt lgkmcnt(2)
  v_mov_b64 v[36:37], 0
  v_smfmac_f32_16x16x64_bf16 v[20:23], v[8:11], v[192:199], v74
  v_mov_b64 v[38:39], 0
  v_smfmac_f32_16x16x64_bf16 v[24:27], v[12:15], v[184:191], v74
  v_mov_b64 v[40:41], 0
  v_smfmac_f32_16x16x64_bf16 v[24:27], v[8:11], v[200:207], v74
  s_waitcnt lgkmcnt(0)
  v_add_f32 v20, v20, v22
  v_smfmac_f32_16x16x64_bf16 v[32:35], v[4:7], v[60:67], v74
  v_add_f32 v21, v21, v23
  v_smfmac_f32_16x16x64_bf16 v[28:31], v[16:19], v[240:247], v74
  v_add_f32 v24, v24, v26
  v_cvt_pk_bf16_f32 v22, v20, v24
  v_smfmac_f32_16x16x64_bf16 v[28:31], v[12:15], a[0:7], v74
  ds_write_b32 v79, v22 offset:0
  v_add_f32 v25, v25, v27
  v_cvt_pk_bf16_f32 v23, v21, v25
  v_smfmac_f32_16x16x64_bf16 v[28:31], v[8:11], a[16:23], v74
  ds_write_b32 v79, v23 offset:576
  v_cmp_u_f32 vcc, v20, v21
  v_smfmac_f32_16x16x64_bf16 v[32:35], v[16:19], v[248:255], v74
  v_mov_b64 v[42:43], 0
  v_smfmac_f32_16x16x64_bf16 v[32:35], v[12:15], a[8:15], v74
  v_add_f32 v28, v28, v30
  v_add_f32 v29, v29, v31
  v_smfmac_f32_16x16x64_bf16 v[32:35], v[8:11], a[24:31], v74
  s_cbranch_vccnz Cf3_rec
Cf3_recok:
  v_smfmac_f32_16x16x64_bf16 v[36:39], v[16:19], a[128:135], v74
  s_waitcnt lgkmcnt(0)
  s_barrier
  ds_read_b128 v[60:63], v77
  v_smfmac_f32_16x16x64_bf16 v[40:43], v[16:19], a[136:143], v74
  ds_read_b128 v[64:67], v77 offset:128
  v_add_f32 v32, v32, v34
  v_cvt_pk_bf16_f32 v30, v28, v32
  v_smfmac_f32_16x16x64_bf16 v[36:39], v[0:3], a[96:103], v74
  ds_write_b32 v79, v30 offset:256
  v_add_f32 v33, v33, v35
  v_cvt_pk_bf16_f32 v31, v29, v33
  v_smfmac_f32_16x16x64_bf16 v[40:43], v[0:3], a[104:111], v74
  ds_write_b32 v79, v31 offset:832
  v_xor_b32 v75, 0x8000, v75
  v_smfmac_f32_16x16x64_bf16 v[36:39], v[4:7], a[112:119], v74
  ds_read_b128 v[0:3], v76 offset:4608
  v_mov_b32 v29, 0
  v_smfmac_f32_16x16x64_bf16 v[40:43], v[4:7], a[120:127], v74
  s_waitcnt vmcnt(3) lgkmcnt(3)
  v_mov_b32 v30, 0
  v_mfma_f32_16x16x32_bf16 v[44:47], v[44:47], v[60:63], 0
  ds_read_b128 v[4:7], v76 offset:5632
  s_waitcnt lgkmcnt(2)
  v_mfma_f32_16x16x32_bf16 v[44:47], v[48:51], v[64:67], v[44:47]
  s_barrier
  v_smfmac_f32_16x16x64_bf16 v[36:39], v[8:11], a[160:167], v74
  ds_read_b128 v[20:23], v77 offset:256
  ds_read_b128 v[24:27], v77 offset:384
  v_smfmac_f32_16x16x64_bf16 v[40:43], v[8:11], a[168:175], v74
  ds_read_b128 v[8:11], v76 offset:6656
  v_add_f32_dpp v72, v46, v44 quad_perm:[2,3,0,1] row_mask:0xf bank_mask:0xf
  v_add_f32_dpp v73, v47, v45 quad_perm:[2,3,0,1] row_mask:0xf bank_mask:0xf
  v_smfmac_f32_16x16x64_bf16 v[36:39], v[12:15], a[144:151], v74
  s_waitcnt lgkmcnt(4)
  v_exp_f32_dpp v72, v72 quad_perm:[0,1,0,1] row_mask:0xf bank_mask:0xf
  v_smfmac_f32_16x16x64_bf16 v[40:43], v[12:15], a[152:159], v74
  ds_read_b128 v[12:15], v76 offset:7680
  v_exp_f32_dpp v73, v73 quad_perm:[0,1,0,1] row_mask:0xf bank_mask:0xf
  v_smfmac_f32_16x16x64_bf16 v[36:39], v[0:3], a[32:39], v74
  s_waitcnt lgkmcnt(2)
  v_cvt_pk_bf16_f32 v72, v72, v73
  v_mfma_f32_16x16x32_bf16 v[20:23], v[20:23], v[60:63], 0
  ds_write_b32 v78, v72 offset:524
  v_mov_b64 v[16:17], 0
  v_mfma_f32_16x16x32_bf16 v[20:23], v[24:27], v[64:67], v[20:23]
  ds_read_b128 v[44:47], v75 offset:28672
  v_mov_b64 v[18:19], 0
  v_smfmac_f32_16x16x64_bf16 v[40:43], v[0:3], a[40:47], v74
  ds_read_b128 v[48:51], v75 offset:29696
  s_waitcnt lgkmcnt(4)
  v_smfmac_f32_16x16x64_bf16 v[36:39], v[4:7], a[48:55], v74
  v_add_f32_dpp v24, v22, v20 quad_perm:[2,3,0,1] row_mask:0xf bank_mask:0xf
  v_add_f32_dpp v25, v23, v21 quad_perm:[2,3,0,1] row_mask:0xf bank_mask:0xf
  v_smfmac_f32_16x16x64_bf16 v[36:39], v[8:11], a[64:71], v74
  s_waitcnt lgkmcnt(2)
  s_barrier
  ds_read_b128 v[32:35], v78 offset:512
  v_smfmac_f32_16x16x64_bf16 v[36:39], v[12:15], a[80:87], v74
  ds_read_b128 v[60:63], v75 offset:30720
  v_mul_f32 v24, s69, v24
  v_smfmac_f32_16x16x64_bf16 v[40:43], v[4:7], a[56:63], v74
  ds_read_b128 v[64:67], v75 offset:31744
  v_mul_f32 v25, s69, v25
  v_smfmac_f32_16x16x64_bf16 v[40:43], v[8:11], a[72:79], v74
  v_exp_f32_dpp v24, v24 quad_perm:[0,1,0,1] row_mask:0xf bank_mask:0xf
  v_smfmac_f32_16x16x64_bf16 v[40:43], v[12:15], a[88:95], v74
  s_waitcnt lgkmcnt(2)
  v_exp_f32_dpp v25, v25 quad_perm:[0,1,0,1] row_mask:0xf bank_mask:0xf
  v_mfma_f32_16x16x32_bf16 v[8:11], v[32:35], v[68:71], 0
  v_add_f32 v36, v36, v38
  v_add_f32 v37, v37, v39
  v_mfma_f32_16x16x32_bf16 v[0:3], v[32:35], v[52:55], 0
  v_add_f32 v40, v40, v42
  v_add_f32 v41, v41, v43
  v_mfma_f32_16x16x32_bf16 v[4:7], v[32:35], v[56:59], 0
  v_cvt_pk_bf16_f32 v28, v24, v25
  v_cvt_pk_bf16_f32 v72, v36, v37
  v_cvt_pk_bf16_f32 v73, v40, v41
  v_mfma_f32_16x16x16_bf16 v[8:11], v[28:29], v[68:69], v[8:11]
  v_cvt_pk_bf16_f32 v31, v24, v25
  v_mov_b64 v[20:21], 0
  v_mfma_f32_16x16x16_bf16 v[0:3], v[28:29], v[72:73], v[0:3]
  ds_read_b128 v[68:71], v76 offset:13824
  v_mov_b64 v[22:23], 0
  v_mfma_f32_16x16x16_bf16 v[4:7], v[30:31], v[72:73], v[4:7]
  v_rcp_f32 v10, v8
  v_rcp_f32 v11, v9
  v_mul_f32 v0, v10, v0
  v_mul_f32 v1, v11, v1
  s_nop 0
  v_mul_f32 v4, v10, v4
  v_mul_f32 v5, v11, v5
  v_cvt_pk_bf16_f32 v2, v0, v4
  ds_write_b32 v79, v2 offset:8704
  v_cvt_pk_bf16_f32 v3, v1, v5
  ds_write_b32 v79, v3 offset:9280
  v_max3_f32 v8, v8, v9, v10
  v_max_f32 v8, v8, v11
  v_cmp_le_f32 vcc, 1317011456, v8
  v_mov_b64 v[24:25], 0
  v_mov_b64 v[26:27], 0
  s_cbranch_vccnz Cf3_mx
Cf3_mxok:
  s_waitcnt lgkmcnt(0)
  s_barrier
  ds_read_b128 v[0:3], v78 offset:8704
  ds_read_b128 v[4:7], v78 offset:8768
  ds_read_b128 v[8:11], v78 offset:8832
  ds_read_b128 v[12:15], v78 offset:8896
  s_waitcnt lgkmcnt(3)
  v_smfmac_f32_16x16x64_bf16 v[16:19], v[0:3], v[44:51], v74
  ds_read_b128 v[52:55], v75 offset:45056
  s_waitcnt lgkmcnt(3)
  v_smfmac_f32_16x16x64_bf16 v[16:19], v[4:7], v[60:67], v74
  ds_read_b128 v[56:59], v75 offset:46080
  s_waitcnt lgkmcnt(3)
  v_smfmac_f32_16x16x64_bf16 v[16:19], v[8:11], a[176:183], v74
  ds_read_b128 v[36:39], v75 offset:47104
  s_waitcnt lgkmcnt(3)
  v_smfmac_f32_16x16x64_bf16 v[16:19], v[12:15], a[184:191], v74
  ds_read_b128 v[40:43], v75 offset:48128
  ds_read_b128 v[44:47], v75 offset:61440
  v_smfmac_f32_16x16x64_bf16 v[20:23], v[0:3], a[192:199], v74
  ds_read_b128 v[48:51], v75 offset:62464
  ds_read_b128 v[60:63], v75 offset:63488
  v_smfmac_f32_16x16x64_bf16 v[20:23], v[4:7], a[200:207], v74
  ds_read_b128 v[64:67], v75 offset:64512
  s_waitcnt lgkmcnt(6)
  v_cvt_pk_bf16_f32 v16, v16, v17
  v_cvt_pk_bf16_f32 v17, v18, v19
  v_bfi_b32 v16, 1, s72, v16
  v_smfmac_f32_16x16x64_bf16 v[20:23], v[8:11], v[52:59], v74
  buffer_store_dwordx2 v[16:17], v68, s[8:11], s73 offen
  s_waitcnt lgkmcnt(4)
  v_smfmac_f32_16x16x64_bf16 v[20:23], v[12:15], v[36:43], v74
  ds_read_b128 v[52:55], v75 offset:8192
  v_mov_b64 v[32:33], 0
  v_smfmac_f32_16x16x64_bf16 v[24:27], v[0:3], a[208:215], v74
  ds_read_b128 v[56:59], v75 offset:9216
  v_mov_b64 v[34:35], 0
  v_smfmac_f32_16x16x64_bf16 v[24:27], v[4:7], a[216:223], v74
  ds_read_b128 v[36:39], v75 offset:10240
  s_waitcnt lgkmcnt(5)
  v_cvt_pk_bf16_f32 v20, v20, v21
  v_cvt_pk_bf16_f32 v21, v22, v23
  v_bfi_b32 v20, 1, s72, v20
  v_smfmac_f32_16x16x64_bf16 v[24:27], v[8:11], v[44:51], v74
  buffer_store_dwordx2 v[20:21], v68, s[8:11], s74 offen
  s_waitcnt lgkmcnt(3)
  v_smfmac_f32_16x16x64_bf16 v[24:27], v[12:15], v[60:67], v74
  ds_read_b128 v[40:43], v75 offset:11264
  v_mov_b64 v[28:29], 0
  v_smfmac_f32_16x16x64_bf16 v[32:35], v[0:3], a[224:231], v74
  ds_read_b128 v[44:47], v75 offset:12288
  ds_read_b128 v[48:51], v75 offset:13312
  v_smfmac_f32_16x16x64_bf16 v[32:35], v[4:7], a[232:239], v74
  ds_read_b128 v[60:63], v75 offset:14336
  v_cvt_pk_bf16_f32 v24, v24, v25
  v_cvt_pk_bf16_f32 v25, v26, v27
  v_bfi_b32 v24, 1, s72, v24
  v_smfmac_f32_16x16x64_bf16 v[32:35], v[8:11], a[240:247], v74
  buffer_store_dwordx2 v[24:25], v68, s[8:11], s75 offen
  v_mov_b64 v[30:31], 0
  v_smfmac_f32_16x16x64_bf16 v[32:35], v[12:15], a[248:255], v74
  ds_read_b128 v[64:67], v75 offset:15360
  s_waitcnt lgkmcnt(6)
  v_smfmac_f32_16x16x64_bf16 v[28:31], v[0:3], v[52:59], v74
  s_waitcnt lgkmcnt(4)
  v_smfmac_f32_16x16x64_bf16 v[28:31], v[4:7], v[36:43], v74
  s_waitcnt lgkmcnt(2)
  v_cvt_pk_bf16_f32 v32, v32, v33
  v_cvt_pk_bf16_f32 v33, v34, v35
  v_bfi_b32 v32, 1, s72, v32
  v_smfmac_f32_16x16x64_bf16 v[28:31], v[8:11], v[44:51], v74
  buffer_store_dwordx2 v[32:33], v68, s[8:11], s76 offen
  s_waitcnt lgkmcnt(0)
  v_smfmac_f32_16x16x64_bf16 v[28:31], v[12:15], v[60:67], v74
  ds_read_b128 v[52:55], v76 offset:14848
  ds_read_b64 v[16:17], v77 offset:392
  v_mov_b64 v[18:19], v[72:73]
  v_xor_b32 v75, 0x8000, v75
  s_nop 3
  v_cvt_pk_bf16_f32 v28, v28, v29
  v_cvt_pk_bf16_f32 v29, v30, v31
  v_bfi_b32 v28, 1, s72, v28
  buffer_store_dwordx2 v[28:29], v68, s[8:11], s77 offen
  v_mov_b64 v[20:21], 0
  v_mov_b64 v[22:23], 0
  v_mov_b64 v[24:25], 0
  v_mov_b64 v[26:27], 0
  v_mov_b64 v[28:29], 0
  v_mov_b64 v[30:31], 0
  v_mov_b64 v[32:33], 0
  v_mov_b64 v[34:35], 0
  s_add_u32 s58, s58, 655360
  s_add_u32 s59, s59, 655360
  s_add_u32 s70, s70, 655360
  s_add_u32 s68, s68, 655360
  s_add_u32 s66, s66, 1
  s_xor_b32 s64, s64, 16384
  s_xor_b32 s65, s65, 16384
  s_cmp_eq_u32 s66, 62
  s_cselect_b64 s[16:17], s[20:21], s[16:17]
  s_cselect_b32 s18, (Cf3_done - Cf3_last), s18
  s_cselect_b32 s70, 0, s70
  s_cmp_eq_u32 s66, 63
  s_cselect_b32 s59, 268435456, s59
  s_nop 15
  s_nop 15
  s_nop 15
  s_nop 3
  buffer_load_dwordx4 v[0:3], v76, s[8:11], s60 offen offset:0 sc1
  buffer_load_dwordx4 v[4:7], v76, s[8:11], s60 offen offset:1024 sc1
  buffer_load_dwordx4 v[8:11], v76, s[8:11], s61 offen offset:0 sc1
  buffer_load_dwordx4 v[12:15], v76, s[8:11], s61 offen offset:1024 sc1
  s_nop 15
  s_nop 11
  buffer_load_dwordx4 v[44:47], v76, s[8:11], s60 offen offset:0 sc1
  buffer_load_dwordx4 v[48:51], v76, s[8:11], s60 offen offset:1024 sc1
  buffer_load_dwordx4 v[60:63], v76, s[8:11], s61 offen offset:0 sc1
  buffer_load_dwordx4 v[64:67], v76, s[8:11], s61 offen offset:1024 sc1
  s_waitcnt lgkmcnt(0)
  s_waitcnt vmcnt(7)
  v_mfma_f32_16x16x32_bf16 v[56:59], v[52:55], v[0:3], 0
  v_bitop3_b32 v72, v0, v2, s72 bitop3:0x7e
  s_waitcnt vmcnt(6)
  v_mfma_f32_16x16x32_bf16 v[56:59], v[52:55], v[4:7], v[56:59]
  v_bitop3_b32 v73, v4, v6, s72 bitop3:0x7e
  v_or_b32 v72, v72, v73
  s_waitcnt vmcnt(5)
  v_mfma_f32_16x16x32_bf16 v[36:39], v[52:55], v[8:11], 0
  v_bitop3_b32 v73, v8, v10, s72 bitop3:0x7e
  v_or_b32 v72, v72, v73
  s_waitcnt vmcnt(4)
  v_mfma_f32_16x16x32_bf16 v[36:39], v[52:55], v[12:15], v[36:39]
  v_bitop3_b32 v73, v12, v14, s72 bitop3:0x7e
  v_bitop3_b32 v72, v72, v73, 1 bitop3:0xa8
  v_cmp_ne_u32 vcc, 0, v72
  s_cbranch_vccnz Cf3_h1r
  v_add_f32_dpp v56, v56, v56 row_ror:4 row_mask:0xf bank_mask:0xf
  v_add_f32_dpp v57, v57, v57 row_ror:4 row_mask:0xf bank_mask:0xf
  s_nop 0
  v_add_f32_dpp v36, v36, v36 row_ror:4 row_mask:0xf bank_mask:0xf
  v_add_f32_dpp v37, v37, v37 row_ror:4 row_mask:0xf bank_mask:0xf
  v_add_f32_dpp v56, v56, v56 row_ror:8 row_mask:0xf bank_mask:0xf
  v_add_f32_dpp v57, v57, v57 row_ror:8 row_mask:0xf bank_mask:0xf
  v_add_f32_dpp v36, v36, v36 row_ror:8 row_mask:0xf bank_mask:0xf
  v_add_f32_dpp v37, v37, v37 row_ror:8 row_mask:0xf bank_mask:0xf
  v_cvt_pk_bf16_f32 v56, v56, v57
  buffer_store_dword v56, v69, s[8:11], s62 offen
  v_cvt_pk_bf16_f32 v36, v36, v37
  buffer_store_dword v36, v70, s[8:11], s63 offen
  s_xor_b32 s62, s62, 16384
  buffer_store_dword v71, v69, s[8:11], s62 offen
  s_xor_b32 s63, s63, 16384
  buffer_store_dword v71, v70, s[8:11], s63 offen
  s_xor_b32 s72, s72, 1
  s_branch Cf3_h2
Cf3_h1r:
  s_mov_b64 exec, vcc
  buffer_load_dwordx4 v[0:3], v76, s[8:11], s60 offen offset:0 sc1
  buffer_load_dwordx4 v[4:7], v76, s[8:11], s60 offen offset:1024 sc1
  buffer_load_dwordx4 v[8:11], v76, s[8:11], s61 offen offset:0 sc1
  buffer_load_dwordx4 v[12:15], v76, s[8:11], s61 offen offset:1024 sc1
  s_mov_b64 exec, -1
  s_add_u32 s67, s67, 1
  s_waitcnt vmcnt(7)
  v_mfma_f32_16x16x32_bf16 v[56:59], v[52:55], v[44:47], 0
  v_bitop3_b32 v72, v44, v46, s72 bitop3:0x7e
  s_waitcnt vmcnt(6)
  v_mfma_f32_16x16x32_bf16 v[56:59], v[52:55], v[48:51], v[56:59]
  v_bitop3_b32 v73, v48, v50, s72 bitop3:0x7e
  v_or_b32 v72, v72, v73
  s_waitcnt vmcnt(5)
  v_mfma_f32_16x16x32_bf16 v[36:39], v[52:55], v[60:63], 0
  v_bitop3_b32 v73, v60, v62, s72 bitop3:0x7e
  v_or_b32 v72, v72, v73
  s_waitcnt vmcnt(4)
  v_mfma_f32_16x16x32_bf16 v[36:39], v[52:55], v[64:67], v[36:39]
  v_bitop3_b32 v73, v64, v66, s72 bitop3:0x7e
  v_bitop3_b32 v72, v72, v73, 1 bitop3:0xa8
  v_cmp_ne_u32 vcc, 0, v72
  s_cbranch_vccz Cf3_h1p
  s_mov_b64 exec, vcc
  buffer_load_dwordx4 v[44:47], v76, s[8:11], s60 offen offset:0 sc1
  buffer_load_dwordx4 v[48:51], v76, s[8:11], s60 offen offset:1024 sc1
  buffer_load_dwordx4 v[60:63], v76, s[8:11], s61 offen offset:0 sc1
  buffer_load_dwordx4 v[64:67], v76, s[8:11], s61 offen offset:1024 sc1
  s_mov_b64 exec, -1
  s_add_u32 s67, s67, 1
  s_waitcnt vmcnt(7)
  v_mfma_f32_16x16x32_bf16 v[56:59], v[52:55], v[0:3], 0
  v_bitop3_b32 v72, v0, v2, s72 bitop3:0x7e
  s_waitcnt vmcnt(6)
  v_mfma_f32_16x16x32_bf16 v[56:59], v[52:55], v[4:7], v[56:59]
  v_bitop3_b32 v73, v4, v6, s72 bitop3:0x7e
  v_or_b32 v72, v72, v73
  s_waitcnt vmcnt(5)
  v_mfma_f32_16x16x32_bf16 v[36:39], v[52:55], v[8:11], 0
  v_bitop3_b32 v73, v8, v10, s72 bitop3:0x7e
  v_or_b32 v72, v72, v73
  s_waitcnt vmcnt(4)
  v_mfma_f32_16x16x32_bf16 v[36:39], v[52:55], v[12:15], v[36:39]
  v_bitop3_b32 v73, v12, v14, s72 bitop3:0x7e
  v_bitop3_b32 v72, v72, v73, 1 bitop3:0xa8
  v_cmp_ne_u32 vcc, 0, v72
  s_cbranch_vccz Cf3_h1p
Cf3_h1s:
  s_mov_b64 exec, vcc
  buffer_load_dwordx4 v[0:3], v76, s[8:11], s60 offen offset:0 sc1
  buffer_load_dwordx4 v[4:7], v76, s[8:11], s60 offen offset:1024 sc1
  buffer_load_dwordx4 v[8:11], v76, s[8:11], s61 offen offset:0 sc1
  buffer_load_dwordx4 v[12:15], v76, s[8:11], s61 offen offset:1024 sc1
  s_mov_b64 exec, -1
  s_add_u32 s67, s67, 1
  s_waitcnt vmcnt(7)
  v_mfma_f32_16x16x32_bf16 v[56:59], v[52:55], v[44:47], 0
  v_bitop3_b32 v72, v44, v46, s72 bitop3:0x7e
  s_waitcnt vmcnt(6)
  v_mfma_f32_16x16x32_bf16 v[56:59], v[52:55], v[48:51], v[56:59]
  v_bitop3_b32 v73, v48, v50, s72 bitop3:0x7e
  v_or_b32 v72, v72, v73
  s_waitcnt vmcnt(5)
  v_mfma_f32_16x16x32_bf16 v[36:39], v[52:55], v[60:63], 0
  v_bitop3_b32 v73, v60, v62, s72 bitop3:0x7e
  v_or_b32 v72, v72, v73
  s_waitcnt vmcnt(4)
  v_mfma_f32_16x16x32_bf16 v[36:39], v[52:55], v[64:67], v[36:39]
  v_bitop3_b32 v73, v64, v66, s72 bitop3:0x7e
  v_bitop3_b32 v72, v72, v73, 1 bitop3:0xa8
  v_cmp_ne_u32 vcc, 0, v72
  s_cbranch_vccz Cf3_h1p
  s_mov_b64 exec, vcc
  buffer_load_dwordx4 v[44:47], v76, s[8:11], s60 offen offset:0 sc1
  buffer_load_dwordx4 v[48:51], v76, s[8:11], s60 offen offset:1024 sc1
  buffer_load_dwordx4 v[60:63], v76, s[8:11], s61 offen offset:0 sc1
  buffer_load_dwordx4 v[64:67], v76, s[8:11], s61 offen offset:1024 sc1
  s_mov_b64 exec, -1
  s_add_u32 s67, s67, 1
  s_waitcnt vmcnt(7)
  v_mfma_f32_16x16x32_bf16 v[56:59], v[52:55], v[0:3], 0
  v_bitop3_b32 v72, v0, v2, s72 bitop3:0x7e
  s_waitcnt vmcnt(6)
  v_mfma_f32_16x16x32_bf16 v[56:59], v[52:55], v[4:7], v[56:59]
  v_bitop3_b32 v73, v4, v6, s72 bitop3:0x7e
  v_or_b32 v72, v72, v73
  s_waitcnt vmcnt(5)
  v_mfma_f32_16x16x32_bf16 v[36:39], v[52:55], v[8:11], 0
  v_bitop3_b32 v73, v8, v10, s72 bitop3:0x7e
  v_or_b32 v72, v72, v73
  s_waitcnt vmcnt(4)
  v_mfma_f32_16x16x32_bf16 v[36:39], v[52:55], v[12:15], v[36:39]
  v_bitop3_b32 v73, v12, v14, s72 bitop3:0x7e
  v_bitop3_b32 v72, v72, v73, 1 bitop3:0xa8
  v_cmp_ne_u32 vcc, 0, v72
  s_cbranch_vccz Cf3_h1p
  s_cmp_lt_u32 s67, 131072
  s_cbranch_scc1 Cf3_h1s
Cf3_h1p:
  s_nop 2
  v_add_f32_dpp v56, v56, v56 row_ror:4 row_mask:0xf bank_mask:0xf
  v_add_f32_dpp v57, v57, v57 row_ror:4 row_mask:0xf bank_mask:0xf
  v_add_f32_dpp v36, v36, v36 row_ror:4 row_mask:0xf bank_mask:0xf
  v_add_f32_dpp v37, v37, v37 row_ror:4 row_mask:0xf bank_mask:0xf
  v_add_f32_dpp v56, v56, v56 row_ror:8 row_mask:0xf bank_mask:0xf
  v_add_f32_dpp v57, v57, v57 row_ror:8 row_mask:0xf bank_mask:0xf
  v_add_f32_dpp v36, v36, v36 row_ror:8 row_mask:0xf bank_mask:0xf
  v_add_f32_dpp v37, v37, v37 row_ror:8 row_mask:0xf bank_mask:0xf
  v_cvt_pk_bf16_f32 v56, v56, v57
  buffer_store_dword v56, v69, s[8:11], s62 offen
  v_cvt_pk_bf16_f32 v36, v36, v37
  buffer_store_dword v36, v70, s[8:11], s63 offen
  s_xor_b32 s62, s62, 16384
  buffer_store_dword v71, v69, s[8:11], s62 offen
  s_xor_b32 s63, s63, 16384
  buffer_store_dword v71, v70, s[8:11], s63 offen
  s_xor_b32 s72, s72, 1
  s_branch Cf3_h2
Cf3_rec:
  s_nop 7
  s_waitcnt vmcnt(0) lgkmcnt(0)
  v_max3_u32 v72, v0, v1, v2
  v_max3_u32 v72, v72, v3, v4
  v_max3_u32 v72, v72, v5, v6
  v_max3_u32 v72, v72, v7, v8
  v_max3_u32 v72, v72, v9, v10
  v_max3_u32 v72, v72, v11, v12
  v_max3_u32 v72, v72, v13, v14
  v_max3_u32 v72, v72, v15, v16
  v_max3_u32 v72, v72, v17, v18
  v_max_u32 v72, v72, v19
  v_cmp_eq_u32 vcc, -1, v72
  s_cbranch_vccz Cf3_recok
  s_barrier
Cf3_recp:
  buffer_load_dwordx4 v[0:3], v76, s[8:11], s64 offen offset:0 sc1
  buffer_load_dwordx4 v[4:7], v76, s[8:11], s64 offen offset:1024 sc1
  buffer_load_dwordx4 v[8:11], v76, s[8:11], s64 offen offset:2048 sc1
  s_add_u32 s67, s67, 1
  s_cmp_lt_u32 s67, 131072
  s_cselect_b32 s54, -2, -1
  s_waitcnt vmcnt(2)
  v_max3_u32 v72, v0, v1, v2
  s_waitcnt vmcnt(1)
  v_max3_u32 v72, v72, v3, v4
  v_max3_u32 v72, v72, v5, v6
  s_waitcnt vmcnt(0)
  v_max3_u32 v72, v72, v7, v8
  v_max3_u32 v72, v72, v9, v10
  v_max_u32 v72, v72, v11
  v_cmp_lt_u32 vcc, s54, v72
  s_cbranch_vccnz Cf3_recp
  ds_write_b128 v76, v[0:3] offset:10752
  ds_write_b128 v76, v[4:7] offset:11776
  ds_write_b128 v76, v[8:11] offset:12800
  v_mov_b64 v[20:21], 0
  v_mov_b64 v[22:23], 0
  v_mov_b64 v[24:25], 0
  v_mov_b64 v[26:27], 0
  v_mov_b64 v[28:29], 0
  v_mov_b64 v[30:31], 0
  v_mov_b64 v[32:33], 0
  v_mov_b64 v[34:35], 0
  s_waitcnt lgkmcnt(0)
  s_barrier
  ds_read_b128 v[0:3], v76 offset:4608
  ds_read_b128 v[60:63], v76 offset:28672
  ds_read_b128 v[64:67], v76 offset:29696
  s_waitcnt lgkmcnt(0)
  v_smfmac_f32_16x16x64_bf16 v[20:23], v[0:3], v[60:67], v74
  ds_read_b128 v[60:63], v76 offset:30720
  ds_read_b128 v[64:67], v76 offset:31744
  s_waitcnt lgkmcnt(0)
  v_smfmac_f32_16x16x64_bf16 v[24:27], v[0:3], v[60:67], v74
  ds_read_b128 v[60:63], v76 offset:45056
  ds_read_b128 v[64:67], v76 offset:46080
  s_waitcnt lgkmcnt(0)
  v_smfmac_f32_16x16x64_bf16 v[28:31], v[0:3], v[60:67], v74
  ds_read_b128 v[60:63], v76 offset:47104
  ds_read_b128 v[64:67], v76 offset:48128
  s_waitcnt lgkmcnt(0)
  v_smfmac_f32_16x16x64_bf16 v[32:35], v[0:3], v[60:67], v74
  ds_read_b128 v[4:7], v76 offset:5632
  s_waitcnt lgkmcnt(0)
  v_smfmac_f32_16x16x64_bf16 v[20:23], v[4:7], v[80:87], v74
  v_smfmac_f32_16x16x64_bf16 v[24:27], v[4:7], v[88:95], v74
  v_smfmac_f32_16x16x64_bf16 v[28:31], v[4:7], v[208:215], v74
  v_smfmac_f32_16x16x64_bf16 v[32:35], v[4:7], v[216:223], v74
  ds_read_b128 v[8:11], v76 offset:6656
  s_waitcnt lgkmcnt(0)
  v_smfmac_f32_16x16x64_bf16 v[20:23], v[8:11], v[96:103], v74
  v_smfmac_f32_16x16x64_bf16 v[24:27], v[8:11], v[104:111], v74
  ds_read_b128 v[60:63], v76 offset:61440
  ds_read_b128 v[64:67], v76 offset:62464
  s_waitcnt lgkmcnt(0)
  v_smfmac_f32_16x16x64_bf16 v[28:31], v[8:11], v[60:67], v74
  ds_read_b128 v[60:63], v76 offset:63488
  ds_read_b128 v[64:67], v76 offset:64512
  s_waitcnt lgkmcnt(0)
  v_smfmac_f32_16x16x64_bf16 v[32:35], v[8:11], v[60:67], v74
  ds_read_b128 v[12:15], v76 offset:7680
  s_waitcnt lgkmcnt(0)
  v_smfmac_f32_16x16x64_bf16 v[20:23], v[12:15], v[112:119], v74
  v_smfmac_f32_16x16x64_bf16 v[24:27], v[12:15], v[120:127], v74
  v_smfmac_f32_16x16x64_bf16 v[28:31], v[12:15], v[224:231], v74
  v_smfmac_f32_16x16x64_bf16 v[32:35], v[12:15], v[232:239], v74
  ds_read_b128 v[0:3], v76 offset:8704
  s_waitcnt lgkmcnt(0)
  v_smfmac_f32_16x16x64_bf16 v[20:23], v[0:3], v[128:135], v74
  v_smfmac_f32_16x16x64_bf16 v[24:27], v[0:3], v[136:143], v74
  ds_read_b128 v[60:63], v75 offset:12288
  ds_read_b128 v[64:67], v75 offset:13312
  s_waitcnt lgkmcnt(0)
  v_smfmac_f32_16x16x64_bf16 v[28:31], v[0:3], v[60:67], v74
  ds_read_b128 v[60:63], v75 offset:14336
  ds_read_b128 v[64:67], v75 offset:15360
  s_waitcnt lgkmcnt(0)
  v_smfmac_f32_16x16x64_bf16 v[32:35], v[0:3], v[60:67], v74
  ds_read_b128 v[4:7], v76 offset:9728
  s_waitcnt lgkmcnt(0)
  v_smfmac_f32_16x16x64_bf16 v[20:23], v[4:7], v[144:151], v74
  v_smfmac_f32_16x16x64_bf16 v[24:27], v[4:7], v[152:159], v74
  ds_read_b128 v[60:63], v75 offset:28672
  ds_read_b128 v[64:67], v75 offset:29696
  s_waitcnt lgkmcnt(0)
  v_smfmac_f32_16x16x64_bf16 v[28:31], v[4:7], v[60:67], v74
  ds_read_b128 v[60:63], v75 offset:30720
  ds_read_b128 v[64:67], v75 offset:31744
  s_waitcnt lgkmcnt(0)
  v_smfmac_f32_16x16x64_bf16 v[32:35], v[4:7], v[60:67], v74
  ds_read_b128 v[16:19], v76 offset:10752
  s_waitcnt lgkmcnt(0)
  v_smfmac_f32_16x16x64_bf16 v[20:23], v[16:19], v[160:167], v74
  v_smfmac_f32_16x16x64_bf16 v[24:27], v[16:19], v[168:175], v74
  v_smfmac_f32_16x16x64_bf16 v[28:31], v[16:19], v[240:247], v74
  v_smfmac_f32_16x16x64_bf16 v[32:35], v[16:19], v[248:255], v74
  ds_read_b128 v[12:15], v76 offset:11776
  s_waitcnt lgkmcnt(0)
  v_smfmac_f32_16x16x64_bf16 v[20:23], v[12:15], v[176:183], v74
  v_smfmac_f32_16x16x64_bf16 v[24:27], v[12:15], v[184:191], v74
  v_smfmac_f32_16x16x64_bf16 v[28:31], v[12:15], a[0:7], v74
  v_smfmac_f32_16x16x64_bf16 v[32:35], v[12:15], a[8:15], v74
  ds_read_b128 v[8:11], v76 offset:12800
  s_waitcnt lgkmcnt(0)
  v_smfmac_f32_16x16x64_bf16 v[20:23], v[8:11], v[192:199], v74
  v_smfmac_f32_16x16x64_bf16 v[24:27], v[8:11], v[200:207], v74
  v_smfmac_f32_16x16x64_bf16 v[28:31], v[8:11], a[16:23], v74
  v_smfmac_f32_16x16x64_bf16 v[32:35], v[8:11], a[24:31], v74
  v_add_f32 v20, v20, v22
  v_add_f32 v21, v21, v23
  v_add_f32 v24, v24, v26
  v_cvt_pk_bf16_f32 v22, v20, v24
  s_nop 0
  ds_write_b32 v79, v22 offset:0
  v_add_f32 v25, v25, v27
  v_cvt_pk_bf16_f32 v23, v21, v25
  ds_write_b32 v79, v23 offset:576
  v_add_f32 v28, v28, v30
  v_add_f32 v29, v29, v31
  s_waitcnt lgkmcnt(0)
  s_nop 1
  s_branch Cf3_recok
Cf3_mx:
  s_waitcnt lgkmcnt(0)
  s_barrier
  buffer_load_dwordx4 v[0:3], v76, s[8:11], s58 offen offset:0 sc1
  ds_read_b128 v[20:23], v77 offset:0
  ds_read_b128 v[28:31], v77 offset:256
  buffer_load_dwordx4 v[4:7], v76, s[8:11], s58 offen offset:1024 sc1
  ds_read_b128 v[24:27], v77 offset:128
  ds_read_b128 v[32:35], v77 offset:384
  s_waitcnt vmcnt(1) lgkmcnt(3)
  v_mfma_f32_16x16x32_bf16 v[8:11], v[0:3], v[20:23], 0
  s_waitcnt vmcnt(0) lgkmcnt(1)
  v_mfma_f32_16x16x32_bf16 v[8:11], v[4:7], v[24:27], v[8:11]
  v_mfma_f32_16x16x32_bf16 v[12:15], v[28:31], v[20:23], 0
  s_waitcnt lgkmcnt(0)
  v_mfma_f32_16x16x32_bf16 v[12:15], v[32:35], v[24:27], v[12:15]
  v_add_f32_dpp v8, v10, v8 quad_perm:[2,3,0,1] row_mask:0xf bank_mask:0xf
  v_add_f32_dpp v9, v11, v9 quad_perm:[2,3,0,1] row_mask:0xf bank_mask:0xf
  s_nop 0
  v_mov_b32_dpp v8, v8 quad_perm:[0,1,0,1] row_mask:0xf bank_mask:0xf
  v_mov_b32_dpp v9, v9 quad_perm:[0,1,0,1] row_mask:0xf bank_mask:0xf
  s_nop 1
  v_add_f32_dpp v12, v14, v12 quad_perm:[2,3,0,1] row_mask:0xf bank_mask:0xf
  v_add_f32_dpp v13, v15, v13 quad_perm:[2,3,0,1] row_mask:0xf bank_mask:0xf
  s_nop 0
  v_mov_b32_dpp v12, v12 quad_perm:[0,1,0,1] row_mask:0xf bank_mask:0xf
  v_mov_b32_dpp v13, v13 quad_perm:[0,1,0,1] row_mask:0xf bank_mask:0xf
  v_mul_f32 v12, s69, v12
  ds_write_b32 v78, v8 offset:8716
  v_mul_f32 v13, s69, v13
  ds_write_b32 v78, v9 offset:8780
  s_waitcnt lgkmcnt(0)
  s_barrier
  ds_read_b128 v[36:39], v78 offset:8704
  ds_read_b128 v[40:43], v78 offset:8768
  s_waitcnt lgkmcnt(0)
  s_barrier
  v_max_f32 v16, v36, v37
  v_max3_f32 v16, v16, v38, v39
  v_max3_f32 v16, v16, v40, v41
  v_max3_f32 v16, v16, v42, v43
  v_max3_f32 v16, v16, v12, v13
  v_mov_b32 v17, v16
  s_nop 1
  v_permlane16_swap_b32 v16, v17
  v_max_f32 v16, v16, v17
  v_mov_b32 v17, v16
  s_nop 1
  v_permlane32_swap_b32 v16, v17
  v_max_f32 v16, v16, v17
  v_sub_f32 v36, v36, v16
  v_sub_f32 v37, v37, v16
  v_sub_f32 v38, v38, v16
  v_sub_f32 v39, v39, v16
  v_sub_f32 v40, v40, v16
  v_sub_f32 v41, v41, v16
  v_sub_f32 v42, v42, v16
  v_sub_f32 v43, v43, v16
  v_sub_f32 v12, v12, v16
  v_sub_f32 v13, v13, v16
  v_exp_f32 v36, v36
  v_exp_f32 v37, v37
  v_exp_f32 v38, v38
  v_exp_f32 v39, v39
  v_exp_f32 v40, v40
  v_exp_f32 v41, v41
  v_exp_f32 v42, v42
  v_exp_f32 v43, v43
  v_exp_f32 v12, v12
  v_exp_f32 v13, v13
  v_cvt_pk_bf16_f32 v32, v36, v40
  v_cvt_pk_bf16_f32 v33, v37, v41
  v_cvt_pk_bf16_f32 v34, v38, v42
  v_cvt_pk_bf16_f32 v35, v39, v43
  v_cvt_pk_bf16_f32 v28, v12, v13
  v_cvt_pk_bf16_f32 v31, v12, v13
  v_mov_b32 v29, 0
  v_mov_b32 v30, 0
  v_mov_b32 v68, 0x3f803f80
  v_mov_b32 v69, 0x3f803f80
  v_mov_b32 v70, 0x3f803f80
  v_mov_b32 v71, 0x3f803f80
  s_nop 1
  v_mfma_f32_16x16x32_bf16 v[8:11], v[32:35], v[68:71], 0
  v_mfma_f32_16x16x32_bf16 v[0:3], v[32:35], v[52:55], 0
  v_mfma_f32_16x16x32_bf16 v[4:7], v[32:35], v[56:59], 0
  v_mfma_f32_16x16x16_bf16 v[8:11], v[28:29], v[68:69], v[8:11]
  v_mfma_f32_16x16x16_bf16 v[0:3], v[28:29], v[72:73], v[0:3]
  v_mfma_f32_16x16x16_bf16 v[4:7], v[30:31], v[72:73], v[4:7]
  ds_read_b128 v[68:71], v76 offset:13824
  v_rcp_f32 v10, v8
  v_rcp_f32 v11, v9
  v_mul_f32 v0, v10, v0
  v_mul_f32 v1, v11, v1
  s_nop 0
  v_mul_f32 v4, v10, v4
  v_mul_f32 v5, v11, v5
  v_cvt_pk_bf16_f32 v2, v0, v4
  ds_write_b32 v79, v2 offset:8704
  v_cvt_pk_bf16_f32 v3, v1, v5
  ds_write_b32 v79, v3 offset:9280
  v_mov_b64 v[16:17], 0
  v_mov_b64 v[18:19], 0
  v_mov_b64 v[20:21], 0
  v_mov_b64 v[22:23], 0
  v_mov_b64 v[24:25], 0
  v_mov_b64 v[26:27], 0
  s_branch Cf3_mxok
Cf3_kv3:
  s_waitcnt lgkmcnt(0)
  s_cmp_ge_u32 s57, 0x700
  s_cbranch_scc1 Cf3_h2w
  s_load_dword s57, s[12:13], s71 glc
  s_add_u32 s67, s67, 1
  s_cmp_lt_u32 s67, 131072
  s_cbranch_scc1 Cf3_kv3
  s_branch Cf3_h2w
Cf3_last:
  ds_read_b128 v[8:11], v76 offset:6656
  ds_read_b128 v[12:15], v76 offset:7680
  ds_read_b128 v[60:63], v76 offset:47104
  ds_read_b128 v[64:67], v76 offset:48128
  ds_read_b128 v[44:47], v76 offset:61440
  ds_read_b128 v[48:51], v76 offset:62464
  s_waitcnt lgkmcnt(7)
  v_smfmac_f32_16x16x64_bf16 v[28:31], v[0:3], v[36:43], v74
  v_smfmac_f32_16x16x64_bf16 v[20:23], v[0:3], a[32:39], v74
  ds_read_b128 v[36:39], v76 offset:63488
  ds_read_b128 v[40:43], v76 offset:64512
  v_smfmac_f32_16x16x64_bf16 v[24:27], v[0:3], a[40:47], v74
  s_waitcnt lgkmcnt(8)
  v_smfmac_f32_16x16x64_bf16 v[20:23], v[4:7], a[48:55], v74
  buffer_store_dwordx4 v[16:19], v76, s[8:11], s68 offen sc1
  v_smfmac_f32_16x16x64_bf16 v[24:27], v[4:7], a[56:63], v74
  s_waitcnt lgkmcnt(4)
  v_smfmac_f32_16x16x64_bf16 v[28:31], v[4:7], v[208:215], v74
  v_smfmac_f32_16x16x64_bf16 v[32:35], v[4:7], v[216:223], v74
  s_waitcnt lgkmcnt(2)
  v_smfmac_f32_16x16x64_bf16 v[32:35], v[0:3], v[60:67], v74
  v_smfmac_f32_16x16x64_bf16 v[20:23], v[8:11], a[64:71], v74
  ds_read_b128 v[60:63], v75 offset:12288
  ds_read_b128 v[64:67], v75 offset:13312
  v_smfmac_f32_16x16x64_bf16 v[24:27], v[8:11], a[72:79], v74
  v_smfmac_f32_16x16x64_bf16 v[28:31], v[8:11], v[44:51], v74
  v_smfmac_f32_16x16x64_bf16 v[20:23], v[12:15], a[80:87], v74
  ds_read_b128 v[44:47], v75 offset:14336
  ds_read_b128 v[48:51], v75 offset:15360
  v_smfmac_f32_16x16x64_bf16 v[24:27], v[12:15], a[88:95], v74
  s_waitcnt lgkmcnt(4)
  v_smfmac_f32_16x16x64_bf16 v[28:31], v[12:15], v[224:231], v74
  v_smfmac_f32_16x16x64_bf16 v[32:35], v[12:15], v[232:239], v74
  v_smfmac_f32_16x16x64_bf16 v[32:35], v[8:11], v[36:43], v74
  ds_read_b128 v[36:39], v75 offset:28672
  ds_read_b128 v[40:43], v75 offset:29696
  s_waitcnt vmcnt(1)
  s_barrier
Cf3_lastr:
  ds_read_b128 v[0:3], v76 offset:8704
  ds_read_b128 v[4:7], v76 offset:9728
  ds_read_b128 v[16:19], v76 offset:10752
  ds_read_b128 v[12:15], v76 offset:11776
  ds_read_b128 v[8:11], v76 offset:12800
  s_waitcnt lgkmcnt(4)
  v_max3_u32 v72, v0, v1, v2
  s_waitcnt lgkmcnt(3)
  v_max3_u32 v72, v72, v3, v4
  v_max3_u32 v72, v72, v5, v6
  s_waitcnt lgkmcnt(0)
  v_max3_u32 v72, v72, v7, v8
  v_max3_u32 v72, v72, v9, v10
  v_max3_u32 v72, v72, v11, v12
  v_max3_u32 v72, v72, v13, v14
  v_max3_u32 v72, v72, v15, v16
  v_max3_u32 v72, v72, v17, v18
  v_max_u32 v72, v72, v19
  v_cmp_eq_u32 vcc, -1, v72
  s_cbranch_vccnz Cf3_lastp
Cf3_lastg:
  v_smfmac_f32_16x16x64_bf16 v[28:31], v[0:3], v[60:67], v74
  ds_read_b128 v[60:63], v75 offset:30720
  ds_read_b128 v[64:67], v75 offset:31744
  v_smfmac_f32_16x16x64_bf16 v[32:35], v[0:3], v[44:51], v74
  v_smfmac_f32_16x16x64_bf16 v[28:31], v[4:7], v[36:43], v74
  v_smfmac_f32_16x16x64_bf16 v[28:31], v[16:19], v[240:247], v74
  v_smfmac_f32_16x16x64_bf16 v[28:31], v[12:15], a[0:7], v74
  v_smfmac_f32_16x16x64_bf16 v[28:31], v[8:11], a[16:23], v74
  v_smfmac_f32_16x16x64_bf16 v[32:35], v[16:19], v[248:255], v74
  v_smfmac_f32_16x16x64_bf16 v[32:35], v[12:15], a[8:15], v74
  s_waitcnt lgkmcnt(0)
  v_smfmac_f32_16x16x64_bf16 v[32:35], v[8:11], a[24:31], v74
  v_smfmac_f32_16x16x64_bf16 v[32:35], v[4:7], v[60:67], v74
  v_smfmac_f32_16x16x64_bf16 v[20:23], v[0:3], a[96:103], v74
  v_smfmac_f32_16x16x64_bf16 v[20:23], v[4:7], a[112:119], v74
  v_add_f32 v28, v28, v30
  v_add_f32 v32, v32, v34
  v_cvt_pk_bf16_f32 v30, v28, v32
  v_smfmac_f32_16x16x64_bf16 v[20:23], v[16:19], a[128:135], v74
  ds_write_b32 v79, v30 offset:256
  v_add_f32 v29, v29, v31
  v_add_f32 v33, v33, v35
  v_cvt_pk_bf16_f32 v31, v29, v33
  v_smfmac_f32_16x16x64_bf16 v[20:23], v[12:15], a[144:151], v74
  ds_write_b32 v79, v31 offset:832
  v_smfmac_f32_16x16x64_bf16 v[20:23], v[8:11], a[160:167], v74
  v_smfmac_f32_16x16x64_bf16 v[24:27], v[0:3], a[104:111], v74
  v_smfmac_f32_16x16x64_bf16 v[24:27], v[4:7], a[120:127], v74
  v_smfmac_f32_16x16x64_bf16 v[24:27], v[16:19], a[136:143], v74
  s_waitcnt lgkmcnt(0)
  s_barrier
  ds_read_b64 v[52:53], v77 offset:392
  v_add_f32 v20, v20, v22
  v_smfmac_f32_16x16x64_bf16 v[24:27], v[12:15], a[152:159], v74
  v_add_f32 v21, v21, v23
  v_smfmac_f32_16x16x64_bf16 v[24:27], v[8:11], a[168:175], v74
  v_cvt_pk_bf16_f32 v54, v20, v21
  s_add_u32 s68, s68, 655360
  s_nop 3
  v_add_f32 v24, v24, v26
  v_add_f32 v25, v25, v27
  v_cvt_pk_bf16_f32 v55, v24, v25
  s_waitcnt lgkmcnt(0)
  buffer_store_dwordx4 v[52:55], v76, s[8:11], s68 offen sc1
  s_branch Cf3_done
Cf3_lastp:
  s_add_u32 s72, s72, 2
  s_cmp_ge_u32 s72, 131072
  s_cbranch_scc1 Cf3_lastg
  s_barrier
  buffer_load_dwordx4 v76, s[8:11], s55 offen offset:0 sc1 lds
  s_waitcnt vmcnt(0)
  s_barrier
  s_branch Cf3_lastr
Cf3_done:
  s_branch L_cexit
L_w4:
  v_mov_b64 v[20:21], 0
  v_mov_b64 v[22:23], 0
  v_mov_b64 v[24:25], 0
  v_mov_b64 v[26:27], 0
  v_mov_b64 v[28:29], 0
  v_mov_b64 v[30:31], 0
  v_mov_b64 v[32:33], 0
  v_mov_b64 v[34:35], 0
  s_mov_b32 s78, 0x3f803f80
  s_mov_b32 s79, s78
  s_mov_b32 s65, 360448
  s_mov_b32 m0, 15872
  s_lshl_b32 s71, s53, 2
  s_add_u32 s71, s71, 128
  s_movk_i32 s56, 0x1000
  v_lshlrev_b32 v73, 2, v76
  v_mov_b32 v72, 0
  s_mov_b64 s[16:17], s[8:9]
  s_mov_b32 s18, 268435456
  s_mov_b32 s19, 0x20000
  s_getpc_b64 s[20:21]
Cs0_pc:
  s_add_u32 s20, s20, (Cs0_last - Cs0_pc)
  s_addc_u32 s21, s21, 0
  buffer_load_dwordx4 v[52:55], v76, s[8:11], s59 offen offset:0 sc1
  buffer_load_dwordx4 v[56:59], v76, s[8:11], s59 offen offset:1024 sc1
  ds_read_b128 v[60:63], v76 offset:16384
  ds_read_b128 v[64:67], v76 offset:17408
  ds_read_b128 v[44:47], v76 offset:18432
  ds_read_b128 v[48:51], v76 offset:19456
  ds_read_b128 v[36:39], v76 offset:32768
  ds_read_b128 v[40:43], v76 offset:33792
  ds_read_b128 v[0:3], v76 offset:4608
  ds_read_b128 v[4:7], v76 offset:5632
  s_waitcnt lgkmcnt(0)
  s_branch Cs0_top2
.p2align 6
Cs0_h2:
  v_lshlrev_b32 v73, 2, v76
  s_mov_b32 m0, 8704
  s_add_u32 s55, s65, 4096
  s_nop 15
  s_nop 11
  buffer_load_dwordx4 v[0:3], v76, s[8:11], s65 offen offset:0 sc1
  buffer_load_dwordx4 v[4:7], v76, s[8:11], s65 offen offset:1024 sc1
  s_nop 15
  s_nop 3
  buffer_load_dwordx4 v[0:3], v76, s[8:11], s65 offen offset:0 sc1
  buffer_load_dwordx4 v[4:7], v76, s[8:11], s65 offen offset:1024 sc1
  s_nop 15
  s_nop 3
  buffer_load_dwordx4 v[0:3], v76, s[8:11], s65 offen offset:0 sc1
  buffer_load_dwordx4 v[4:7], v76, s[8:11], s65 offen offset:1024 sc1
  s_waitcnt vmcnt(8)
  ds_read_b128 v[60:63], v76 offset:16384
  ds_read_b128 v[64:67], v76 offset:17408
  ds_read_b128 v[44:47], v76 offset:18432
  ds_read_b128 v[48:51], v76 offset:19456
  ds_read_b128 v[36:39], v76 offset:32768
  ds_read_b128 v[40:43], v76 offset:33792
  buffer_load_dwordx4 v[52:55], v76, s[8:11], s59 offen offset:0 sc1
  buffer_load_dwordx4 v[56:59], v76, s[8:11], s59 offen offset:1024 sc1
  s_waitcnt vmcnt(6)
  v_max3_u32 v72, v0, v1, v2
  v_max3_u32 v72, v72, v3, v4
  v_max3_u32 v72, v72, v5, v6
  v_max_u32 v72, v72, v7
  ds_write_b128 v76, v[0:3] offset:4608
  ds_write_b128 v76, v[4:7] offset:5632
  v_cmp_eq_u32 vcc, -1, v72
  s_cbranch_vccnz Cs0_h2r
Cs0_h2w:
  s_cmp_eq_u32 s66, 63
  s_waitcnt lgkmcnt(0)
  s_barrier
  buffer_load_dwordx4 v76, s[8:11], s55 offen offset:0 sc1 lds
  buffer_load_dwordx4 v76, s[8:11], s55 offen offset:1024 sc1 lds
  buffer_load_dwordx4 v76, s[8:11], s55 offen offset:2048 sc1 lds
  buffer_load_dwordx4 v76, s[8:11], s55 offen offset:3072 sc1 lds
  s_cbranch_scc1 Cs0_last
Cs0_top2:
  ds_read_b128 v[8:11], v76 offset:6656
  s_mov_b32 m0, 15872
  v_smfmac_f32_16x16x64_bf16 v[20:23], v[0:3], v[60:67], v74
  ds_read_b128 v[60:63], v76 offset:34816
  v_smfmac_f32_16x16x64_bf16 v[24:27], v[0:3], v[44:51], v74
  buffer_load_dwordx4 v[44:47], v76, s[8:11], s58 offen offset:0 sc1
  ds_read_b128 v[64:67], v76 offset:35840
  v_smfmac_f32_16x16x64_bf16 v[20:23], v[4:7], v[80:87], v74
  buffer_load_dwordx4 v[48:51], v76, s[8:11], s58 offen offset:1024 sc1
  v_smfmac_f32_16x16x64_bf16 v[28:31], v[0:3], v[36:43], v74
  ds_read_b128 v[36:39], v76 offset:49152
  v_smfmac_f32_16x16x64_bf16 v[24:27], v[4:7], v[88:95], v74
  ds_read_b128 v[40:43], v76 offset:50176
  s_waitcnt lgkmcnt(4)
  v_smfmac_f32_16x16x64_bf16 v[28:31], v[4:7], v[208:215], v74
  ds_read_b128 v[12:15], v76 offset:7680
  v_smfmac_f32_16x16x64_bf16 v[32:35], v[4:7], v[216:223], v74
  buffer_store_dwordx4 v[16:19], v76, s[8:11], s68 offen sc1
  s_waitcnt lgkmcnt(3)
  v_smfmac_f32_16x16x64_bf16 v[32:35], v[0:3], v[60:67], v74
  buffer_load_dword v73, s[16:19], s70 offen  lds
  v_smfmac_f32_16x16x64_bf16 v[20:23], v[8:11], v[96:103], v74
  ds_read_b128 v[60:63], v76 offset:51200
  v_smfmac_f32_16x16x64_bf16 v[24:27], v[8:11], v[104:111], v74
  ds_read_b128 v[64:67], v76 offset:52224
  s_waitcnt lgkmcnt(3)
  v_smfmac_f32_16x16x64_bf16 v[28:31], v[8:11], v[36:43], v74
  ds_read_b128 v[36:39], v75 offset:0
  s_waitcnt lgkmcnt(3)
  v_smfmac_f32_16x16x64_bf16 v[20:23], v[12:15], v[112:119], v74
  ds_read_b128 v[40:43], v75 offset:1024
  v_smfmac_f32_16x16x64_bf16 v[24:27], v[12:15], v[120:127], v74
  s_waitcnt vmcnt(4)
  v_smfmac_f32_16x16x64_bf16 v[28:31], v[12:15], v[224:231], v74
  s_barrier
  ds_read_b128 v[0:3], v76 offset:8704
  v_smfmac_f32_16x16x64_bf16 v[32:35], v[12:15], v[232:239], v74
  ds_read_b128 v[4:7], v76 offset:9728
  s_waitcnt lgkmcnt(4)
  v_smfmac_f32_16x16x64_bf16 v[32:35], v[8:11], v[60:67], v74
  ds_read_b128 v[60:63], v75 offset:2048
  s_waitcnt lgkmcnt(2)
  v_smfmac_f32_16x16x64_bf16 v[20:23], v[0:3], v[128:135], v74
  ds_read_b128 v[16:19], v76 offset:10752
  v_smfmac_f32_16x16x64_bf16 v[24:27], v[0:3], v[136:143], v74
  ds_read_b128 v[64:67], v75 offset:3072
  v_smfmac_f32_16x16x64_bf16 v[28:31], v[0:3], v[36:43], v74
  ds_read_b128 v[36:39], v75 offset:16384
  s_waitcnt lgkmcnt(4)
  v_smfmac_f32_16x16x64_bf16 v[20:23], v[4:7], v[144:151], v74
  ds_read_b128 v[12:15], v76 offset:11776
  v_smfmac_f32_16x16x64_bf16 v[24:27], v[4:7], v[152:159], v74
  ds_read_b128 v[40:43], v75 offset:17408
  s_waitcnt lgkmcnt(4)
  v_smfmac_f32_16x16x64_bf16 v[20:23], v[16:19], v[160:167], v74
  ds_read_b128 v[8:11], v76 offset:12800
  s_waitcnt lgkmcnt(4)
  v_smfmac_f32_16x16x64_bf16 v[32:35], v[0:3], v[60:67], v74
  ds_read_b128 v[60:63], v75 offset:18432
  v_mov_b64 v[68:69], s[78:79]
  v_smfmac_f32_16x16x64_bf16 v[24:27], v[16:19], v[168:175], v74
  ds_read_b128 v[64:67], v75 offset:19456
  s_waitcnt lgkmcnt(4)
  v_smfmac_f32_16x16x64_bf16 v[20:23], v[12:15], v[176:183], v74
  s_waitcnt lgkmcnt(3)
  v_mov_b64 v[70:71], s[78:79]
  v_smfmac_f32_16x16x64_bf16 v[28:31], v[4:7], v[36:43], v74
  s_waitcnt lgkmcnt(2)
  v_mov_b64 v[36:37], 0
  v_smfmac_f32_16x16x64_bf16 v[20:23], v[8:11], v[192:199], v74
  v_mov_b64 v[38:39], 0
  v_smfmac_f32_16x16x64_bf16 v[24:27], v[12:15], v[184:191], v74
  v_mov_b64 v[40:41], 0
  v_smfmac_f32_16x16x64_bf16 v[24:27], v[8:11], v[200:207], v74
  s_waitcnt lgkmcnt(0)
  v_add_f32 v20, v20, v22
  v_smfmac_f32_16x16x64_bf16 v[32:35], v[4:7], v[60:67], v74
  v_add_f32 v21, v21, v23
  v_smfmac_f32_16x16x64_bf16 v[28:31], v[16:19], v[240:247], v74
  v_add_f32 v24, v24, v26
  v_cvt_pk_bf16_f32 v22, v20, v24
  v_smfmac_f32_16x16x64_bf16 v[28:31], v[12:15], a[0:7], v74
  ds_write_b32 v79, v22 offset:0
  v_add_f32 v25, v25, v27
  v_cvt_pk_bf16_f32 v23, v21, v25
  v_smfmac_f32_16x16x64_bf16 v[28:31], v[8:11], a[16:23], v74
  ds_write_b32 v79, v23 offset:576
  v_cmp_u_f32 vcc, v20, v21
  v_smfmac_f32_16x16x64_bf16 v[32:35], v[16:19], v[248:255], v74
  v_mov_b64 v[42:43], 0
  v_smfmac_f32_16x16x64_bf16 v[32:35], v[12:15], a[8:15], v74
  v_add_f32 v28, v28, v30
  v_add_f32 v29, v29, v31
  v_smfmac_f32_16x16x64_bf16 v[32:35], v[8:11], a[24:31], v74
  s_cbranch_vccnz Cs0_rec
Cs0_recok:
  v_smfmac_f32_16x16x64_bf16 v[36:39], v[16:19], a[128:135], v74
  s_waitcnt lgkmcnt(0)
  s_barrier
  ds_read_b128 v[60:63], v77
  v_smfmac_f32_16x16x64_bf16 v[40:43], v[16:19], a[136:143], v74
  ds_read_b128 v[64:67], v77 offset:128
  v_add_f32 v32, v32, v34
  v_cvt_pk_bf16_f32 v30, v28, v32
  v_smfmac_f32_16x16x64_bf16 v[36:39], v[0:3], a[96:103], v74
  ds_write_b32 v79, v30 offset:256
  v_add_f32 v33, v33, v35
  v_cvt_pk_bf16_f32 v31, v29, v33
  v_smfmac_f32_16x16x64_bf16 v[40:43], v[0:3], a[104:111], v74
  ds_write_b32 v79, v31 offset:832
  v_xor_b32 v75, 0x8000, v75
  v_smfmac_f32_16x16x64_bf16 v[36:39], v[4:7], a[112:119], v74
  ds_read_b128 v[0:3], v76 offset:4608
  v_mov_b32 v29, 0
  v_smfmac_f32_16x16x64_bf16 v[40:43], v[4:7], a[120:127], v74
  s_waitcnt vmcnt(2) lgkmcnt(3)
  v_mov_b32 v30, 0
  v_mfma_f32_16x16x32_bf16 v[44:47], v[44:47], v[60:63], 0
  ds_read_b128 v[4:7], v76 offset:5632
  s_waitcnt lgkmcnt(2)
  v_mfma_f32_16x16x32_bf16 v[44:47], v[48:51], v[64:67], v[44:47]
  s_barrier
  v_smfmac_f32_16x16x64_bf16 v[36:39], v[8:11], a[160:167], v74
  ds_read_b128 v[20:23], v77 offset:256
  ds_read_b128 v[24:27], v77 offset:384
  v_smfmac_f32_16x16x64_bf16 v[40:43], v[8:11], a[168:175], v74
  ds_read_b128 v[8:11], v76 offset:6656
  v_add_f32_dpp v72, v46, v44 quad_perm:[2,3,0,1] row_mask:0xf bank_mask:0xf
  v_add_f32_dpp v73, v47, v45 quad_perm:[2,3,0,1] row_mask:0xf bank_mask:0xf
  v_smfmac_f32_16x16x64_bf16 v[36:39], v[12:15], a[144:151], v74
  s_waitcnt lgkmcnt(4)
  v_exp_f32_dpp v72, v72 quad_perm:[0,1,0,1] row_mask:0xf bank_mask:0xf
  v_smfmac_f32_16x16x64_bf16 v[40:43], v[12:15], a[152:159], v74
  ds_read_b128 v[12:15], v76 offset:7680
  v_exp_f32_dpp v73, v73 quad_perm:[0,1,0,1] row_mask:0xf bank_mask:0xf
  v_smfmac_f32_16x16x64_bf16 v[36:39], v[0:3], a[32:39], v74
  s_waitcnt lgkmcnt(2)
  v_cvt_pk_bf16_f32 v72, v72, v73
  v_mfma_f32_16x16x32_bf16 v[20:23], v[20:23], v[60:63], 0
  ds_write_b32 v78, v72 offset:512
  v_mov_b64 v[16:17], 0
  v_mfma_f32_16x16x32_bf16 v[20:23], v[24:27], v[64:67], v[20:23]
  ds_read_b128 v[44:47], v75 offset:16384
  v_mov_b64 v[18:19], 0
  v_smfmac_f32_16x16x64_bf16 v[40:43], v[0:3], a[40:47], v74
  ds_read_b128 v[48:51], v75 offset:17408
  s_waitcnt lgkmcnt(4)
  v_smfmac_f32_16x16x64_bf16 v[36:39], v[4:7], a[48:55], v74
  v_add_f32_dpp v24, v22, v20 quad_perm:[2,3,0,1] row_mask:0xf bank_mask:0xf
  v_add_f32_dpp v25, v23, v21 quad_perm:[2,3,0,1] row_mask:0xf bank_mask:0xf
  v_smfmac_f32_16x16x64_bf16 v[36:39], v[8:11], a[64:71], v74
  s_waitcnt lgkmcnt(2)
  s_barrier
  ds_read_b128 v[32:35], v78 offset:512
  v_smfmac_f32_16x16x64_bf16 v[36:39], v[12:15], a[80:87], v74
  ds_read_b128 v[60:63], v75 offset:18432
  v_mul_f32 v24, s69, v24
  v_smfmac_f32_16x16x64_bf16 v[40:43], v[4:7], a[56:63], v74
  ds_read_b128 v[64:67], v75 offset:19456
  v_mul_f32 v25, s69, v25
  v_smfmac_f32_16x16x64_bf16 v[40:43], v[8:11], a[72:79], v74
  v_exp_f32_dpp v24, v24 quad_perm:[0,1,0,1] row_mask:0xf bank_mask:0xf
  v_smfmac_f32_16x16x64_bf16 v[40:43], v[12:15], a[88:95], v74
  s_waitcnt lgkmcnt(2)
  v_exp_f32_dpp v25, v25 quad_perm:[0,1,0,1] row_mask:0xf bank_mask:0xf
  v_mfma_f32_16x16x32_bf16 v[8:11], v[32:35], v[68:71], 0
  v_add_f32 v36, v36, v38
  v_add_f32 v37, v37, v39
  v_mfma_f32_16x16x32_bf16 v[0:3], v[32:35], v[52:55], 0
  v_add_f32 v40, v40, v42
  v_add_f32 v41, v41, v43
  v_mfma_f32_16x16x32_bf16 v[4:7], v[32:35], v[56:59], 0
  v_cvt_pk_bf16_f32 v28, v24, v25
  v_cvt_pk_bf16_f32 v72, v36, v37
  v_cvt_pk_bf16_f32 v73, v40, v41
  v_mfma_f32_16x16x16_bf16 v[8:11], v[28:29], v[68:69], v[8:11]
  v_cvt_pk_bf16_f32 v31, v24, v25
  v_mov_b64 v[20:21], 0
  v_mfma_f32_16x16x16_bf16 v[0:3], v[28:29], v[72:73], v[0:3]
  ds_read_b128 v[68:71], v76 offset:13824
  v_mov_b64 v[22:23], 0
  v_mfma_f32_16x16x16_bf16 v[4:7], v[30:31], v[72:73], v[4:7]
  v_rcp_f32 v10, v8
  v_rcp_f32 v11, v9
  v_mul_f32 v0, v10, v0
  v_mul_f32 v1, v11, v1
  s_nop 0
  v_mul_f32 v4, v10, v4
  v_mul_f32 v5, v11, v5
  v_cvt_pk_bf16_f32 v2, v0, v4
  ds_write_b32 v79, v2 offset:8704
  v_cvt_pk_bf16_f32 v3, v1, v5
  ds_write_b32 v79, v3 offset:9280
  v_max3_f32 v8, v8, v9, v10
  v_max_f32 v8, v8, v11
  v_cmp_le_f32 vcc, 1317011456, v8
  v_mov_b64 v[24:25], 0
  v_mov_b64 v[26:27], 0
  s_cbranch_vccnz Cs0_mx
Cs0_mxok:
  s_waitcnt lgkmcnt(0)
  s_barrier
  ds_read_b128 v[0:3], v78 offset:8704
  ds_read_b128 v[4:7], v78 offset:8768
  ds_read_b128 v[8:11], v78 offset:8832
  ds_read_b128 v[12:15], v78 offset:8896
  s_waitcnt lgkmcnt(3)
  v_smfmac_f32_16x16x64_bf16 v[16:19], v[0:3], v[44:51], v74
  ds_read_b128 v[52:55], v75 offset:32768
  s_waitcnt lgkmcnt(3)
  v_smfmac_f32_16x16x64_bf16 v[16:19], v[4:7], v[60:67], v74
  ds_read_b128 v[56:59], v75 offset:33792
  s_waitcnt lgkmcnt(3)
  v_smfmac_f32_16x16x64_bf16 v[16:19], v[8:11], a[176:183], v74
  ds_read_b128 v[36:39], v75 offset:34816
  s_waitcnt lgkmcnt(3)
  v_smfmac_f32_16x16x64_bf16 v[16:19], v[12:15], a[184:191], v74
  ds_read_b128 v[40:43], v75 offset:35840
  ds_read_b128 v[44:47], v75 offset:49152
  v_smfmac_f32_16x16x64_bf16 v[20:23], v[0:3], a[192:199], v74
  ds_read_b128 v[48:51], v75 offset:50176
  ds_read_b128 v[60:63], v75 offset:51200
  v_smfmac_f32_16x16x64_bf16 v[20:23], v[4:7], a[200:207], v74
  ds_read_b128 v[64:67], v75 offset:52224
  s_waitcnt lgkmcnt(6)
  v_cvt_pk_bf16_f32 v16, v16, v17
  v_cvt_pk_bf16_f32 v17, v18, v19
  v_bfi_b32 v16, 1, s72, v16
  v_smfmac_f32_16x16x64_bf16 v[20:23], v[8:11], v[52:59], v74
  buffer_store_dwordx2 v[16:17], v68, s[8:11], s73 offen sc1
  s_waitcnt lgkmcnt(4)
  v_smfmac_f32_16x16x64_bf16 v[20:23], v[12:15], v[36:43], v74
  v_mov_b64 v[32:33], 0
  v_smfmac_f32_16x16x64_bf16 v[24:27], v[0:3], a[208:215], v74
  v_mov_b64 v[34:35], 0
  v_smfmac_f32_16x16x64_bf16 v[24:27], v[4:7], a[216:223], v74
  s_waitcnt lgkmcnt(2)
  v_cvt_pk_bf16_f32 v20, v20, v21
  v_cvt_pk_bf16_f32 v21, v22, v23
  v_bfi_b32 v20, 1, s72, v20
  v_smfmac_f32_16x16x64_bf16 v[24:27], v[8:11], v[44:51], v74
  buffer_store_dwordx2 v[20:21], v68, s[8:11], s74 offen sc1
  s_waitcnt lgkmcnt(0)
  v_smfmac_f32_16x16x64_bf16 v[24:27], v[12:15], v[60:67], v74
  v_smfmac_f32_16x16x64_bf16 v[32:35], v[0:3], a[224:231], v74
  v_smfmac_f32_16x16x64_bf16 v[32:35], v[4:7], a[232:239], v74
  v_cvt_pk_bf16_f32 v24, v24, v25
  v_cvt_pk_bf16_f32 v25, v26, v27
  v_bfi_b32 v24, 1, s72, v24
  v_smfmac_f32_16x16x64_bf16 v[32:35], v[8:11], a[240:247], v74
  s_nop 1
  buffer_store_dwordx2 v[24:25], v68, s[8:11], s75 offen sc1
  v_smfmac_f32_16x16x64_bf16 v[32:35], v[12:15], a[248:255], v74
  ds_read_b128 v[0:3], v76 offset:14848
  ds_read_b64 v[16:17], v77 offset:256
  v_mov_b64 v[18:19], v[72:73]
  v_xor_b32 v75, 0x8000, v75
  s_nop 3
  v_cvt_pk_bf16_f32 v32, v32, v33
  v_cvt_pk_bf16_f32 v33, v34, v35
  v_bfi_b32 v32, 1, s72, v32
  buffer_store_dwordx2 v[32:33], v68, s[8:11], s76 offen sc1
  v_mov_b64 v[20:21], 0
  v_mov_b64 v[22:23], 0
  v_mov_b64 v[24:25], 0
  v_mov_b64 v[26:27], 0
  v_mov_b64 v[28:29], 0
  v_mov_b64 v[30:31], 0
  v_mov_b64 v[32:33], 0
  v_mov_b64 v[34:35], 0
  s_add_u32 s58, s58, 655360
  s_add_u32 s59, s59, 655360
  s_add_u32 s70, s70, 655360
  s_add_u32 s68, s68, 655360
  s_add_u32 s66, s66, 1
  s_xor_b32 s64, s64, 16384
  s_xor_b32 s65, s65, 16384
  s_cmp_eq_u32 s66, 62
  s_cselect_b64 s[16:17], s[20:21], s[16:17]
  s_cselect_b32 s18, (Cs0_done - Cs0_last), s18
  s_cselect_b32 s70, 0, s70
  s_cmp_eq_u32 s66, 63
  s_cselect_b32 s59, 268435456, s59
  s_nop 13
  buffer_load_dwordx4 v[52:55], v76, s[8:11], s60 offen offset:0 sc1
  buffer_load_dwordx4 v[56:59], v76, s[8:11], s60 offen offset:1024 sc1
  s_nop 15
  s_nop 11
  buffer_load_dwordx4 v[36:39], v76, s[8:11], s60 offen offset:0 sc1
  buffer_load_dwordx4 v[40:43], v76, s[8:11], s60 offen offset:1024 sc1
  s_waitcnt lgkmcnt(0)
  s_waitcnt vmcnt(3)
  v_mfma_f32_16x16x32_bf16 v[4:7], v[0:3], v[52:55], 0
  v_bitop3_b32 v72, v52, v54, s72 bitop3:0x7e
  s_waitcnt vmcnt(2)
  v_mfma_f32_16x16x32_bf16 v[4:7], v[0:3], v[56:59], v[4:7]
  v_bitop3_b32 v73, v56, v58, s72 bitop3:0x7e
  v_bitop3_b32 v72, v72, v73, 1 bitop3:0xa8
  v_cmp_ne_u32 vcc, 0, v72
  s_cbranch_vccnz Cs0_h1r
  s_nop 2
  v_add_f32_dpp v4, v4, v4 row_ror:4 row_mask:0xf bank_mask:0xf
  v_add_f32_dpp v5, v5, v5 row_ror:4 row_mask:0xf bank_mask:0xf
  s_nop 0
  v_add_f32_dpp v4, v4, v4 row_ror:8 row_mask:0xf bank_mask:0xf
  v_add_f32_dpp v5, v5, v5 row_ror:8 row_mask:0xf bank_mask:0xf
  v_cvt_pk_bf16_f32 v4, v4, v5
  buffer_store_dword v4, v69, s[8:11], s62 offen sc1
  s_xor_b32 s62, s62, 16384
  buffer_store_dword v71, v69, s[8:11], s62 offen sc1
  s_xor_b32 s72, s72, 1
  s_branch Cs0_h2
Cs0_h1r:
  s_mov_b64 exec, vcc
  buffer_load_dwordx4 v[52:55], v76, s[8:11], s60 offen offset:0 sc1
  buffer_load_dwordx4 v[56:59], v76, s[8:11], s60 offen offset:1024 sc1
  s_mov_b64 exec, -1
  s_add_u32 s67, s67, 1
  s_waitcnt vmcnt(3)
  v_mfma_f32_16x16x32_bf16 v[4:7], v[0:3], v[36:39], 0
  v_bitop3_b32 v72, v36, v38, s72 bitop3:0x7e
  s_waitcnt vmcnt(2)
  v_mfma_f32_16x16x32_bf16 v[4:7], v[0:3], v[40:43], v[4:7]
  v_bitop3_b32 v73, v40, v42, s72 bitop3:0x7e
  v_bitop3_b32 v72, v72, v73, 1 bitop3:0xa8
  v_cmp_ne_u32 vcc, 0, v72
  s_cbranch_vccz Cs0_h1p
  s_mov_b64 exec, vcc
  buffer_load_dwordx4 v[36:39], v76, s[8:11], s60 offen offset:0 sc1
  buffer_load_dwordx4 v[40:43], v76, s[8:11], s60 offen offset:1024 sc1
  s_mov_b64 exec, -1
  s_add_u32 s67, s67, 1
  s_waitcnt vmcnt(3)
  v_mfma_f32_16x16x32_bf16 v[4:7], v[0:3], v[52:55], 0
  v_bitop3_b32 v72, v52, v54, s72 bitop3:0x7e
  s_waitcnt vmcnt(2)
  v_mfma_f32_16x16x32_bf16 v[4:7], v[0:3], v[56:59], v[4:7]
  v_bitop3_b32 v73, v56, v58, s72 bitop3:0x7e
  v_bitop3_b32 v72, v72, v73, 1 bitop3:0xa8
  v_cmp_ne_u32 vcc, 0, v72
  s_cbranch_vccz Cs0_h1p
Cs0_h1s:
  s_mov_b64 exec, vcc
  buffer_load_dwordx4 v[52:55], v76, s[8:11], s60 offen offset:0 sc1
  buffer_load_dwordx4 v[56:59], v76, s[8:11], s60 offen offset:1024 sc1
  s_mov_b64 exec, -1
  s_add_u32 s67, s67, 1
  s_waitcnt vmcnt(3)
  v_mfma_f32_16x16x32_bf16 v[4:7], v[0:3], v[36:39], 0
  v_bitop3_b32 v72, v36, v38, s72 bitop3:0x7e
  s_waitcnt vmcnt(2)
  v_mfma_f32_16x16x32_bf16 v[4:7], v[0:3], v[40:43], v[4:7]
  v_bitop3_b32 v73, v40, v42, s72 bitop3:0x7e
  v_bitop3_b32 v72, v72, v73, 1 bitop3:0xa8
  v_cmp_ne_u32 vcc, 0, v72
  s_cbranch_vccz Cs0_h1p
  s_mov_b64 exec, vcc
  buffer_load_dwordx4 v[36:39], v76, s[8:11], s60 offen offset:0 sc1
  buffer_load_dwordx4 v[40:43], v76, s[8:11], s60 offen offset:1024 sc1
  s_mov_b64 exec, -1
  s_add_u32 s67, s67, 1
  s_waitcnt vmcnt(3)
  v_mfma_f32_16x16x32_bf16 v[4:7], v[0:3], v[52:55], 0
  v_bitop3_b32 v72, v52, v54, s72 bitop3:0x7e
  s_waitcnt vmcnt(2)
  v_mfma_f32_16x16x32_bf16 v[4:7], v[0:3], v[56:59], v[4:7]
  v_bitop3_b32 v73, v56, v58, s72 bitop3:0x7e
  v_bitop3_b32 v72, v72, v73, 1 bitop3:0xa8
  v_cmp_ne_u32 vcc, 0, v72
  s_cbranch_vccz Cs0_h1p
  s_cmp_lt_u32 s67, 131072
  s_cbranch_scc1 Cs0_h1s
Cs0_h1p:
  s_nop 2
  v_add_f32_dpp v4, v4, v4 row_ror:4 row_mask:0xf bank_mask:0xf
  v_add_f32_dpp v5, v5, v5 row_ror:4 row_mask:0xf bank_mask:0xf
  s_nop 0
  v_add_f32_dpp v4, v4, v4 row_ror:8 row_mask:0xf bank_mask:0xf
  v_add_f32_dpp v5, v5, v5 row_ror:8 row_mask:0xf bank_mask:0xf
  v_cvt_pk_bf16_f32 v4, v4, v5
  buffer_store_dword v4, v69, s[8:11], s62 offen sc1
  s_xor_b32 s62, s62, 16384
  buffer_store_dword v71, v69, s[8:11], s62 offen sc1
  s_xor_b32 s72, s72, 1
  s_branch Cs0_h2
Cs0_h2r:
  s_mov_b64 exec, vcc
  buffer_load_dwordx4 v[0:3], v76, s[8:11], s65 offen offset:0 sc1
  buffer_load_dwordx4 v[4:7], v76, s[8:11], s65 offen offset:1024 sc1
  s_mov_b64 exec, -1
  s_add_u32 s67, s67, 1
  s_waitcnt vmcnt(6)
  v_max3_u32 v72, v0, v1, v2
  v_max3_u32 v72, v72, v3, v4
  v_max3_u32 v72, v72, v5, v6
  v_max_u32 v72, v72, v7
  ds_write_b128 v76, v[0:3] offset:4608
  ds_write_b128 v76, v[4:7] offset:5632
  v_cmp_eq_u32 vcc, -1, v72
  s_cbranch_vccz Cs0_h2w
  s_mov_b64 exec, vcc
  buffer_load_dwordx4 v[0:3], v76, s[8:11], s65 offen offset:0 sc1
  buffer_load_dwordx4 v[4:7], v76, s[8:11], s65 offen offset:1024 sc1
  s_mov_b64 exec, -1
  s_add_u32 s67, s67, 1
  s_waitcnt vmcnt(6)
  v_max3_u32 v72, v0, v1, v2
  v_max3_u32 v72, v72, v3, v4
  v_max3_u32 v72, v72, v5, v6
  v_max_u32 v72, v72, v7
  ds_write_b128 v76, v[0:3] offset:4608
  ds_write_b128 v76, v[4:7] offset:5632
  v_cmp_eq_u32 vcc, -1, v72
  s_cbranch_vccz Cs0_h2w
Cs0_h2s:
  s_mov_b64 exec, vcc
  buffer_load_dwordx4 v[0:3], v76, s[8:11], s65 offen offset:0 sc1
  buffer_load_dwordx4 v[4:7], v76, s[8:11], s65 offen offset:1024 sc1
  s_mov_b64 exec, -1
  s_add_u32 s67, s67, 1
  s_waitcnt vmcnt(4)
  v_max3_u32 v72, v0, v1, v2
  v_max3_u32 v72, v72, v3, v4
  v_max3_u32 v72, v72, v5, v6
  v_max_u32 v72, v72, v7
  ds_write_b128 v76, v[0:3] offset:4608
  ds_write_b128 v76, v[4:7] offset:5632
  v_cmp_eq_u32 vcc, -1, v72
  s_cbranch_vccz Cs0_h2w
  s_mov_b64 exec, vcc
  buffer_load_dwordx4 v[0:3], v76, s[8:11], s65 offen offset:0 sc1
  buffer_load_dwordx4 v[4:7], v76, s[8:11], s65 offen offset:1024 sc1
  s_mov_b64 exec, -1
  s_add_u32 s67, s67, 1
  s_waitcnt vmcnt(4)
  v_max3_u32 v72, v0, v1, v2
  v_max3_u32 v72, v72, v3, v4
  v_max3_u32 v72, v72, v5, v6
  v_max_u32 v72, v72, v7
  ds_write_b128 v76, v[0:3] offset:4608
  ds_write_b128 v76, v[4:7] offset:5632
  v_cmp_eq_u32 vcc, -1, v72
  s_cbranch_vccz Cs0_h2w
  s_mov_b64 exec, vcc
  buffer_load_dwordx4 v[0:3], v76, s[8:11], s65 offen offset:0 sc1
  buffer_load_dwordx4 v[4:7], v76, s[8:11], s65 offen offset:1024 sc1
  s_mov_b64 exec, -1
  s_add_u32 s67, s67, 1
  s_waitcnt vmcnt(4)
  v_max3_u32 v72, v0, v1, v2
  v_max3_u32 v72, v72, v3, v4
  v_max3_u32 v72, v72, v5, v6
  v_max_u32 v72, v72, v7
  ds_write_b128 v76, v[0:3] offset:4608
  ds_write_b128 v76, v[4:7] offset:5632
  v_cmp_eq_u32 vcc, -1, v72
  s_cbranch_vccz Cs0_h2w
  s_cmp_lt_u32 s67, 131072
  s_cbranch_scc1 Cs0_h2s
Cs0_h2ok:
  ds_write_b128 v76, v[0:3] offset:4608
  ds_write_b128 v76, v[4:7] offset:5632
  s_branch Cs0_h2w
Cs0_rec:
  s_nop 7
  s_waitcnt vmcnt(0) lgkmcnt(0)
  v_max3_u32 v72, v0, v1, v2
  v_max3_u32 v72, v72, v3, v4
  v_max3_u32 v72, v72, v5, v6
  v_max3_u32 v72, v72, v7, v8
  v_max3_u32 v72, v72, v9, v10
  v_max3_u32 v72, v72, v11, v12
  v_max3_u32 v72, v72, v13, v14
  v_max3_u32 v72, v72, v15, v16
  v_max3_u32 v72, v72, v17, v18
  v_max_u32 v72, v72, v19
  v_cmp_eq_u32 vcc, -1, v72
  s_cbranch_vccz Cs0_recok
  s_barrier
  v_mov_b64 v[20:21], 0
  v_mov_b64 v[22:23], 0
  v_mov_b64 v[24:25], 0
  v_mov_b64 v[26:27], 0
  v_mov_b64 v[28:29], 0
  v_mov_b64 v[30:31], 0
  v_mov_b64 v[32:33], 0
  v_mov_b64 v[34:35], 0
  s_waitcnt lgkmcnt(0)
  s_barrier
  ds_read_b128 v[0:3], v76 offset:4608
  ds_read_b128 v[60:63], v76 offset:16384
  ds_read_b128 v[64:67], v76 offset:17408
  s_waitcnt lgkmcnt(0)
  v_smfmac_f32_16x16x64_bf16 v[20:23], v[0:3], v[60:67], v74
  ds_read_b128 v[60:63], v76 offset:18432
  ds_read_b128 v[64:67], v76 offset:19456
  s_waitcnt lgkmcnt(0)
  v_smfmac_f32_16x16x64_bf16 v[24:27], v[0:3], v[60:67], v74
  ds_read_b128 v[60:63], v76 offset:32768
  ds_read_b128 v[64:67], v76 offset:33792
  s_waitcnt lgkmcnt(0)
  v_smfmac_f32_16x16x64_bf16 v[28:31], v[0:3], v[60:67], v74
  ds_read_b128 v[60:63], v76 offset:34816
  ds_read_b128 v[64:67], v76 offset:35840
  s_waitcnt lgkmcnt(0)
  v_smfmac_f32_16x16x64_bf16 v[32:35], v[0:3], v[60:67], v74
  ds_read_b128 v[4:7], v76 offset:5632
  s_waitcnt lgkmcnt(0)
  v_smfmac_f32_16x16x64_bf16 v[20:23], v[4:7], v[80:87], v74
  v_smfmac_f32_16x16x64_bf16 v[24:27], v[4:7], v[88:95], v74
  v_smfmac_f32_16x16x64_bf16 v[28:31], v[4:7], v[208:215], v74
  v_smfmac_f32_16x16x64_bf16 v[32:35], v[4:7], v[216:223], v74
  ds_read_b128 v[8:11], v76 offset:6656
  s_waitcnt lgkmcnt(0)
  v_smfmac_f32_16x16x64_bf16 v[20:23], v[8:11], v[96:103], v74
  v_smfmac_f32_16x16x64_bf16 v[24:27], v[8:11], v[104:111], v74
  ds_read_b128 v[60:63], v76 offset:49152
  ds_read_b128 v[64:67], v76 offset:50176
  s_waitcnt lgkmcnt(0)
  v_smfmac_f32_16x16x64_bf16 v[28:31], v[8:11], v[60:67], v74
  ds_read_b128 v[60:63], v76 offset:51200
  ds_read_b128 v[64:67], v76 offset:52224
  s_waitcnt lgkmcnt(0)
  v_smfmac_f32_16x16x64_bf16 v[32:35], v[8:11], v[60:67], v74
  ds_read_b128 v[12:15], v76 offset:7680
  s_waitcnt lgkmcnt(0)
  v_smfmac_f32_16x16x64_bf16 v[20:23], v[12:15], v[112:119], v74
  v_smfmac_f32_16x16x64_bf16 v[24:27], v[12:15], v[120:127], v74
  v_smfmac_f32_16x16x64_bf16 v[28:31], v[12:15], v[224:231], v74
  v_smfmac_f32_16x16x64_bf16 v[32:35], v[12:15], v[232:239], v74
  ds_read_b128 v[0:3], v76 offset:8704
  s_waitcnt lgkmcnt(0)
  v_smfmac_f32_16x16x64_bf16 v[20:23], v[0:3], v[128:135], v74
  v_smfmac_f32_16x16x64_bf16 v[24:27], v[0:3], v[136:143], v74
  ds_read_b128 v[60:63], v75 offset:0
  ds_read_b128 v[64:67], v75 offset:1024
  s_waitcnt lgkmcnt(0)
  v_smfmac_f32_16x16x64_bf16 v[28:31], v[0:3], v[60:67], v74
  ds_read_b128 v[60:63], v75 offset:2048
  ds_read_b128 v[64:67], v75 offset:3072
  s_waitcnt lgkmcnt(0)
  v_smfmac_f32_16x16x64_bf16 v[32:35], v[0:3], v[60:67], v74
  ds_read_b128 v[4:7], v76 offset:9728
  s_waitcnt lgkmcnt(0)
  v_smfmac_f32_16x16x64_bf16 v[20:23], v[4:7], v[144:151], v74
  v_smfmac_f32_16x16x64_bf16 v[24:27], v[4:7], v[152:159], v74
  ds_read_b128 v[60:63], v75 offset:16384
  ds_read_b128 v[64:67], v75 offset:17408
  s_waitcnt lgkmcnt(0)
  v_smfmac_f32_16x16x64_bf16 v[28:31], v[4:7], v[60:67], v74
  ds_read_b128 v[60:63], v75 offset:18432
  ds_read_b128 v[64:67], v75 offset:19456
  s_waitcnt lgkmcnt(0)
  v_smfmac_f32_16x16x64_bf16 v[32:35], v[4:7], v[60:67], v74
  ds_read_b128 v[16:19], v76 offset:10752
  s_waitcnt lgkmcnt(0)
  v_smfmac_f32_16x16x64_bf16 v[20:23], v[16:19], v[160:167], v74
  v_smfmac_f32_16x16x64_bf16 v[24:27], v[16:19], v[168:175], v74
  v_smfmac_f32_16x16x64_bf16 v[28:31], v[16:19], v[240:247], v74
  v_smfmac_f32_16x16x64_bf16 v[32:35], v[16:19], v[248:255], v74
  ds_read_b128 v[12:15], v76 offset:11776
  s_waitcnt lgkmcnt(0)
  v_smfmac_f32_16x16x64_bf16 v[20:23], v[12:15], v[176:183], v74
  v_smfmac_f32_16x16x64_bf16 v[24:27], v[12:15], v[184:191], v74
  v_smfmac_f32_16x16x64_bf16 v[28:31], v[12:15], a[0:7], v74
  v_smfmac_f32_16x16x64_bf16 v[32:35], v[12:15], a[8:15], v74
  ds_read_b128 v[8:11], v76 offset:12800
  s_waitcnt lgkmcnt(0)
  v_smfmac_f32_16x16x64_bf16 v[20:23], v[8:11], v[192:199], v74
  v_smfmac_f32_16x16x64_bf16 v[24:27], v[8:11], v[200:207], v74
  v_smfmac_f32_16x16x64_bf16 v[28:31], v[8:11], a[16:23], v74
  v_smfmac_f32_16x16x64_bf16 v[32:35], v[8:11], a[24:31], v74
  v_add_f32 v20, v20, v22
  v_add_f32 v21, v21, v23
  v_add_f32 v24, v24, v26
  v_cvt_pk_bf16_f32 v22, v20, v24
  s_nop 0
  ds_write_b32 v79, v22 offset:0
  v_add_f32 v25, v25, v27
  v_cvt_pk_bf16_f32 v23, v21, v25
  ds_write_b32 v79, v23 offset:576
  v_add_f32 v28, v28, v30
  v_add_f32 v29, v29, v31
  s_waitcnt lgkmcnt(0)
  s_nop 1
  s_branch Cs0_recok
Cs0_mx:
  s_waitcnt lgkmcnt(0)
  s_barrier
  buffer_load_dwordx4 v[0:3], v76, s[8:11], s58 offen offset:0 sc1
  ds_read_b128 v[20:23], v77 offset:0
  ds_read_b128 v[28:31], v77 offset:256
  buffer_load_dwordx4 v[4:7], v76, s[8:11], s58 offen offset:1024 sc1
  ds_read_b128 v[24:27], v77 offset:128
  ds_read_b128 v[32:35], v77 offset:384
  s_waitcnt vmcnt(1) lgkmcnt(3)
  v_mfma_f32_16x16x32_bf16 v[8:11], v[0:3], v[20:23], 0
  s_waitcnt vmcnt(0) lgkmcnt(1)
  v_mfma_f32_16x16x32_bf16 v[8:11], v[4:7], v[24:27], v[8:11]
  v_mfma_f32_16x16x32_bf16 v[12:15], v[28:31], v[20:23], 0
  s_waitcnt lgkmcnt(0)
  v_mfma_f32_16x16x32_bf16 v[12:15], v[32:35], v[24:27], v[12:15]
  v_add_f32_dpp v8, v10, v8 quad_perm:[2,3,0,1] row_mask:0xf bank_mask:0xf
  v_add_f32_dpp v9, v11, v9 quad_perm:[2,3,0,1] row_mask:0xf bank_mask:0xf
  s_nop 0
  v_mov_b32_dpp v8, v8 quad_perm:[0,1,0,1] row_mask:0xf bank_mask:0xf
  v_mov_b32_dpp v9, v9 quad_perm:[0,1,0,1] row_mask:0xf bank_mask:0xf
  s_nop 1
  v_add_f32_dpp v12, v14, v12 quad_perm:[2,3,0,1] row_mask:0xf bank_mask:0xf
  v_add_f32_dpp v13, v15, v13 quad_perm:[2,3,0,1] row_mask:0xf bank_mask:0xf
  s_nop 0
  v_mov_b32_dpp v12, v12 quad_perm:[0,1,0,1] row_mask:0xf bank_mask:0xf
  v_mov_b32_dpp v13, v13 quad_perm:[0,1,0,1] row_mask:0xf bank_mask:0xf
  v_mul_f32 v12, s69, v12
  ds_write_b32 v78, v8 offset:8704
  v_mul_f32 v13, s69, v13
  ds_write_b32 v78, v9 offset:8768
  s_waitcnt lgkmcnt(0)
  s_barrier
  ds_read_b128 v[36:39], v78 offset:8704
  ds_read_b128 v[40:43], v78 offset:8768
  s_waitcnt lgkmcnt(0)
  s_barrier
  v_max_f32 v16, v36, v37
  v_max3_f32 v16, v16, v38, v39
  v_max3_f32 v16, v16, v40, v41
  v_max3_f32 v16, v16, v42, v43
  v_max3_f32 v16, v16, v12, v13
  v_mov_b32 v17, v16
  s_nop 1
  v_permlane16_swap_b32 v16, v17
  v_max_f32 v16, v16, v17
  v_mov_b32 v17, v16
  s_nop 1
  v_permlane32_swap_b32 v16, v17
  v_max_f32 v16, v16, v17
  v_sub_f32 v36, v36, v16
  v_sub_f32 v37, v37, v16
  v_sub_f32 v38, v38, v16
  v_sub_f32 v39, v39, v16
  v_sub_f32 v40, v40, v16
  v_sub_f32 v41, v41, v16
  v_sub_f32 v42, v42, v16
  v_sub_f32 v43, v43, v16
  v_sub_f32 v12, v12, v16
  v_sub_f32 v13, v13, v16
  v_exp_f32 v36, v36
  v_exp_f32 v37, v37
  v_exp_f32 v38, v38
  v_exp_f32 v39, v39
  v_exp_f32 v40, v40
  v_exp_f32 v41, v41
  v_exp_f32 v42, v42
  v_exp_f32 v43, v43
  v_exp_f32 v12, v12
  v_exp_f32 v13, v13
  v_cvt_pk_bf16_f32 v32, v36, v40
  v_cvt_pk_bf16_f32 v33, v37, v41
  v_cvt_pk_bf16_f32 v34, v38, v42
  v_cvt_pk_bf16_f32 v35, v39, v43
  v_cvt_pk_bf16_f32 v28, v12, v13
  v_cvt_pk_bf16_f32 v31, v12, v13
  v_mov_b32 v29, 0
  v_mov_b32 v30, 0
  v_mov_b32 v68, 0x3f803f80
  v_mov_b32 v69, 0x3f803f80
  v_mov_b32 v70, 0x3f803f80
  v_mov_b32 v71, 0x3f803f80
  s_nop 1
  v_mfma_f32_16x16x32_bf16 v[8:11], v[32:35], v[68:71], 0
  v_mfma_f32_16x16x32_bf16 v[0:3], v[32:35], v[52:55], 0
  v_mfma_f32_16x16x32_bf16 v[4:7], v[32:35], v[56:59], 0
  v_mfma_f32_16x16x16_bf16 v[8:11], v[28:29], v[68:69], v[8:11]
  v_mfma_f32_16x16x16_bf16 v[0:3], v[28:29], v[72:73], v[0:3]
  v_mfma_f32_16x16x16_bf16 v[4:7], v[30:31], v[72:73], v[4:7]
  ds_read_b128 v[68:71], v76 offset:13824
  v_rcp_f32 v10, v8
  v_rcp_f32 v11, v9
  v_mul_f32 v0, v10, v0
  v_mul_f32 v1, v11, v1
  s_nop 0
  v_mul_f32 v4, v10, v4
  v_mul_f32 v5, v11, v5
  v_cvt_pk_bf16_f32 v2, v0, v4
  ds_write_b32 v79, v2 offset:8704
  v_cvt_pk_bf16_f32 v3, v1, v5
  ds_write_b32 v79, v3 offset:9280
  v_mov_b64 v[16:17], 0
  v_mov_b64 v[18:19], 0
  v_mov_b64 v[20:21], 0
  v_mov_b64 v[22:23], 0
  v_mov_b64 v[24:25], 0
  v_mov_b64 v[26:27], 0
  s_branch Cs0_mxok
Cs0_last:
  ds_read_b128 v[8:11], v76 offset:6656
  ds_read_b128 v[12:15], v76 offset:7680
  ds_read_b128 v[60:63], v76 offset:34816
  ds_read_b128 v[64:67], v76 offset:35840
  ds_read_b128 v[44:47], v76 offset:49152
  ds_read_b128 v[48:51], v76 offset:50176
  v_smfmac_f32_16x16x64_bf16 v[28:31], v[0:3], v[36:43], v74
  v_smfmac_f32_16x16x64_bf16 v[20:23], v[0:3], a[32:39], v74
  ds_read_b128 v[36:39], v76 offset:51200
  ds_read_b128 v[40:43], v76 offset:52224
  v_smfmac_f32_16x16x64_bf16 v[24:27], v[0:3], a[40:47], v74
  v_smfmac_f32_16x16x64_bf16 v[20:23], v[4:7], a[48:55], v74
  buffer_store_dwordx4 v[16:19], v76, s[8:11], s68 offen sc1
  v_smfmac_f32_16x16x64_bf16 v[24:27], v[4:7], a[56:63], v74
  s_waitcnt lgkmcnt(4)
  v_smfmac_f32_16x16x64_bf16 v[28:31], v[4:7], v[208:215], v74
  v_smfmac_f32_16x16x64_bf16 v[32:35], v[4:7], v[216:223], v74
  s_waitcnt lgkmcnt(2)
  v_smfmac_f32_16x16x64_bf16 v[32:35], v[0:3], v[60:67], v74
  v_smfmac_f32_16x16x64_bf16 v[20:23], v[8:11], a[64:71], v74
  ds_read_b128 v[60:63], v75 offset:0
  ds_read_b128 v[64:67], v75 offset:1024
  v_smfmac_f32_16x16x64_bf16 v[24:27], v[8:11], a[72:79], v74
  v_smfmac_f32_16x16x64_bf16 v[28:31], v[8:11], v[44:51], v74
  v_smfmac_f32_16x16x64_bf16 v[20:23], v[12:15], a[80:87], v74
  ds_read_b128 v[44:47], v75 offset:2048
  ds_read_b128 v[48:51], v75 offset:3072
  v_smfmac_f32_16x16x64_bf16 v[24:27], v[12:15], a[88:95], v74
  s_waitcnt lgkmcnt(4)
  v_smfmac_f32_16x16x64_bf16 v[28:31], v[12:15], v[224:231], v74
  v_smfmac_f32_16x16x64_bf16 v[32:35], v[12:15], v[232:239], v74
  v_smfmac_f32_16x16x64_bf16 v[32:35], v[8:11], v[36:43], v74
  ds_read_b128 v[36:39], v75 offset:16384
  ds_read_b128 v[40:43], v75 offset:17408
  s_waitcnt vmcnt(1)
  s_barrier
Cs0_lastr:
  ds_read_b128 v[0:3], v76 offset:8704
  ds_read_b128 v[4:7], v76 offset:9728
  ds_read_b128 v[16:19], v76 offset:10752
  ds_read_b128 v[12:15], v76 offset:11776
  ds_read_b128 v[8:11], v76 offset:12800
  s_waitcnt lgkmcnt(4)
  v_max3_u32 v72, v0, v1, v2
  s_waitcnt lgkmcnt(3)
  v_max3_u32 v72, v72, v3, v4
  v_max3_u32 v72, v72, v5, v6
  s_waitcnt lgkmcnt(0)
  v_max3_u32 v72, v72, v7, v8
  v_max3_u32 v72, v72, v9, v10
  v_max3_u32 v72, v72, v11, v12
  v_max3_u32 v72, v72, v13, v14
  v_max3_u32 v72, v72, v15, v16
  v_max3_u32 v72, v72, v17, v18
  v_max_u32 v72, v72, v19
  v_cmp_eq_u32 vcc, -1, v72
  s_cbranch_vccnz Cs0_lastp
Cs0_lastg:
  v_smfmac_f32_16x16x64_bf16 v[28:31], v[0:3], v[60:67], v74
  ds_read_b128 v[60:63], v75 offset:18432
  ds_read_b128 v[64:67], v75 offset:19456
  v_smfmac_f32_16x16x64_bf16 v[32:35], v[0:3], v[44:51], v74
  v_smfmac_f32_16x16x64_bf16 v[28:31], v[4:7], v[36:43], v74
  v_smfmac_f32_16x16x64_bf16 v[28:31], v[16:19], v[240:247], v74
  v_smfmac_f32_16x16x64_bf16 v[28:31], v[12:15], a[0:7], v74
  v_smfmac_f32_16x16x64_bf16 v[28:31], v[8:11], a[16:23], v74
  v_smfmac_f32_16x16x64_bf16 v[32:35], v[16:19], v[248:255], v74
  v_smfmac_f32_16x16x64_bf16 v[32:35], v[12:15], a[8:15], v74
  s_waitcnt lgkmcnt(0)
  v_smfmac_f32_16x16x64_bf16 v[32:35], v[8:11], a[24:31], v74
  v_smfmac_f32_16x16x64_bf16 v[32:35], v[4:7], v[60:67], v74
  v_smfmac_f32_16x16x64_bf16 v[20:23], v[0:3], a[96:103], v74
  v_smfmac_f32_16x16x64_bf16 v[20:23], v[4:7], a[112:119], v74
  v_add_f32 v28, v28, v30
  v_add_f32 v32, v32, v34
  v_cvt_pk_bf16_f32 v30, v28, v32
  v_smfmac_f32_16x16x64_bf16 v[20:23], v[16:19], a[128:135], v74
  ds_write_b32 v79, v30 offset:256
  v_add_f32 v29, v29, v31
  v_add_f32 v33, v33, v35
  v_cvt_pk_bf16_f32 v31, v29, v33
  v_smfmac_f32_16x16x64_bf16 v[20:23], v[12:15], a[144:151], v74
  ds_write_b32 v79, v31 offset:832
  v_smfmac_f32_16x16x64_bf16 v[20:23], v[8:11], a[160:167], v74
  v_smfmac_f32_16x16x64_bf16 v[24:27], v[0:3], a[104:111], v74
  v_smfmac_f32_16x16x64_bf16 v[24:27], v[4:7], a[120:127], v74
  v_smfmac_f32_16x16x64_bf16 v[24:27], v[16:19], a[136:143], v74
  s_waitcnt lgkmcnt(0)
  s_barrier
  ds_read_b64 v[52:53], v77 offset:256
  v_add_f32 v20, v20, v22
  v_smfmac_f32_16x16x64_bf16 v[24:27], v[12:15], a[152:159], v74
  v_add_f32 v21, v21, v23
  v_smfmac_f32_16x16x64_bf16 v[24:27], v[8:11], a[168:175], v74
  v_cvt_pk_bf16_f32 v54, v20, v21
  s_add_u32 s68, s68, 655360
  s_nop 3
  v_add_f32 v24, v24, v26
  v_add_f32 v25, v25, v27
  v_cvt_pk_bf16_f32 v55, v24, v25
  s_waitcnt lgkmcnt(0)
  buffer_store_dwordx4 v[52:55], v76, s[8:11], s68 offen sc1
  s_branch Cs0_done
Cs0_lastp:
  s_add_u32 s72, s72, 2
  s_cmp_ge_u32 s72, 131072
  s_cbranch_scc1 Cs0_lastg
  s_barrier
  buffer_load_dwordx4 v76, s[8:11], s55 offen offset:0 sc1 lds
  buffer_load_dwordx4 v76, s[8:11], s55 offen offset:1024 sc1 lds
  buffer_load_dwordx4 v76, s[8:11], s55 offen offset:2048 sc1 lds
  buffer_load_dwordx4 v76, s[8:11], s55 offen offset:3072 sc1 lds
  s_waitcnt vmcnt(0)
  s_barrier
  s_branch Cs0_lastr
Cs0_done:
  s_branch L_cexit
L_w5:
  v_mov_b64 v[20:21], 0
  v_mov_b64 v[22:23], 0
  v_mov_b64 v[24:25], 0
  v_mov_b64 v[26:27], 0
  v_mov_b64 v[28:29], 0
  v_mov_b64 v[30:31], 0
  v_mov_b64 v[32:33], 0
  v_mov_b64 v[34:35], 0
  s_mov_b32 s78, 0x3f803f80
  s_mov_b32 s79, s78
  s_mov_b32 s65, 360448
  s_mov_b32 m0, 15872
  s_lshl_b32 s71, s53, 2
  s_add_u32 s71, s71, 128
  s_movk_i32 s56, 0x1000
  v_lshlrev_b32 v73, 2, v76
  v_mov_b32 v72, 0
  s_mov_b64 s[16:17], s[8:9]
  s_mov_b32 s18, 268435456
  s_mov_b32 s19, 0x20000
  s_getpc_b64 s[20:21]
Cs1_pc:
  s_add_u32 s20, s20, (Cs1_last - Cs1_pc)
  s_addc_u32 s21, s21, 0
  buffer_load_dwordx4 v[52:55], v76, s[8:11], s59 offen offset:0 sc1
  buffer_load_dwordx4 v[56:59], v76, s[8:11], s59 offen offset:1024 sc1
  ds_read_b128 v[60:63], v76 offset:20480
  ds_read_b128 v[64:67], v76 offset:21504
  ds_read_b128 v[44:47], v76 offset:22528
  ds_read_b128 v[48:51], v76 offset:23552
  ds_read_b128 v[36:39], v76 offset:36864
  ds_read_b128 v[40:43], v76 offset:37888
  ds_read_b128 v[0:3], v76 offset:4608
  ds_read_b128 v[4:7], v76 offset:5632
  ds_read_b128 v[8:11], v76 offset:6656
  s_waitcnt lgkmcnt(0)
  s_branch Cs1_top2
.p2align 6
Cs1_h2:
  v_lshlrev_b32 v73, 2, v76
  s_nop 15
  s_nop 3
  buffer_load_dwordx4 v[8:11], v76, s[8:11], s65 offen offset:2048 sc1
  s_nop 15
  s_nop 3
  buffer_load_dwordx4 v[8:11], v76, s[8:11], s65 offen offset:2048 sc1
  s_nop 15
  s_nop 3
  buffer_load_dwordx4 v[8:11], v76, s[8:11], s65 offen offset:2048 sc1
  s_waitcnt vmcnt(5)
  ds_read_b128 v[60:63], v76 offset:20480
  ds_read_b128 v[64:67], v76 offset:21504
  ds_read_b128 v[44:47], v76 offset:22528
  ds_read_b128 v[48:51], v76 offset:23552
  ds_read_b128 v[36:39], v76 offset:36864
  ds_read_b128 v[40:43], v76 offset:37888
  buffer_load_dwordx4 v[52:55], v76, s[8:11], s59 offen offset:0 sc1
  buffer_load_dwordx4 v[56:59], v76, s[8:11], s59 offen offset:1024 sc1
  s_waitcnt vmcnt(4)
  v_max3_u32 v72, v8, v9, v10
  v_max_u32 v72, v72, v11
  ds_write_b128 v76, v[8:11] offset:6656
  v_cmp_eq_u32 vcc, -1, v72
  s_cbranch_vccnz Cs1_h2r
Cs1_h2w:
  s_cmp_eq_u32 s66, 63
  s_waitcnt lgkmcnt(0)
  s_barrier
  ds_read_b128 v[0:3], v76 offset:4608
  ds_read_b128 v[4:7], v76 offset:5632
  s_cbranch_scc1 Cs1_last
Cs1_top2:
  s_waitcnt lgkmcnt(1)
  v_smfmac_f32_16x16x64_bf16 v[20:23], v[0:3], v[60:67], v74
  ds_read_b128 v[60:63], v76 offset:38912
  v_smfmac_f32_16x16x64_bf16 v[24:27], v[0:3], v[44:51], v74
  buffer_load_dwordx4 v[44:47], v76, s[8:11], s58 offen offset:0 sc1
  ds_read_b128 v[64:67], v76 offset:39936
  s_waitcnt lgkmcnt(2)
  v_smfmac_f32_16x16x64_bf16 v[20:23], v[4:7], v[80:87], v74
  buffer_load_dwordx4 v[48:51], v76, s[8:11], s58 offen offset:1024 sc1
  v_smfmac_f32_16x16x64_bf16 v[28:31], v[0:3], v[36:43], v74
  ds_read_b128 v[36:39], v76 offset:53248
  v_smfmac_f32_16x16x64_bf16 v[24:27], v[4:7], v[88:95], v74
  ds_read_b128 v[40:43], v76 offset:54272
  v_smfmac_f32_16x16x64_bf16 v[28:31], v[4:7], v[208:215], v74
  ds_read_b128 v[12:15], v76 offset:7680
  v_smfmac_f32_16x16x64_bf16 v[32:35], v[4:7], v[216:223], v74
  buffer_store_dwordx4 v[16:19], v76, s[8:11], s68 offen sc1
  s_waitcnt lgkmcnt(3)
  v_smfmac_f32_16x16x64_bf16 v[32:35], v[0:3], v[60:67], v74
  buffer_load_dword v73, s[16:19], s70 offen  lds
  v_smfmac_f32_16x16x64_bf16 v[20:23], v[8:11], v[96:103], v74
  ds_read_b128 v[60:63], v76 offset:55296
  v_smfmac_f32_16x16x64_bf16 v[24:27], v[8:11], v[104:111], v74
  ds_read_b128 v[64:67], v76 offset:56320
  s_waitcnt lgkmcnt(3)
  v_smfmac_f32_16x16x64_bf16 v[28:31], v[8:11], v[36:43], v74
  ds_read_b128 v[36:39], v75 offset:4096
  s_waitcnt lgkmcnt(3)
  v_smfmac_f32_16x16x64_bf16 v[20:23], v[12:15], v[112:119], v74
  ds_read_b128 v[40:43], v75 offset:5120
  v_smfmac_f32_16x16x64_bf16 v[24:27], v[12:15], v[120:127], v74
  s_waitcnt vmcnt(4)
  v_smfmac_f32_16x16x64_bf16 v[28:31], v[12:15], v[224:231], v74
  s_barrier
  ds_read_b128 v[0:3], v76 offset:8704
  v_smfmac_f32_16x16x64_bf16 v[32:35], v[12:15], v[232:239], v74
  ds_read_b128 v[4:7], v76 offset:9728
  s_waitcnt lgkmcnt(4)
  v_smfmac_f32_16x16x64_bf16 v[32:35], v[8:11], v[60:67], v74
  ds_read_b128 v[60:63], v75 offset:6144
  s_waitcnt lgkmcnt(2)
  v_smfmac_f32_16x16x64_bf16 v[20:23], v[0:3], v[128:135], v74
  ds_read_b128 v[16:19], v76 offset:10752
  v_smfmac_f32_16x16x64_bf16 v[24:27], v[0:3], v[136:143], v74
  ds_read_b128 v[64:67], v75 offset:7168
  v_smfmac_f32_16x16x64_bf16 v[28:31], v[0:3], v[36:43], v74
  ds_read_b128 v[36:39], v75 offset:20480
  s_waitcnt lgkmcnt(4)
  v_smfmac_f32_16x16x64_bf16 v[20:23], v[4:7], v[144:151], v74
  ds_read_b128 v[12:15], v76 offset:11776
  v_smfmac_f32_16x16x64_bf16 v[24:27], v[4:7], v[152:159], v74
  ds_read_b128 v[40:43], v75 offset:21504
  s_waitcnt lgkmcnt(4)
  v_smfmac_f32_16x16x64_bf16 v[20:23], v[16:19], v[160:167], v74
  ds_read_b128 v[8:11], v76 offset:12800
  s_waitcnt lgkmcnt(4)
  v_smfmac_f32_16x16x64_bf16 v[32:35], v[0:3], v[60:67], v74
  ds_read_b128 v[60:63], v75 offset:22528
  v_mov_b64 v[68:69], s[78:79]
  v_smfmac_f32_16x16x64_bf16 v[24:27], v[16:19], v[168:175], v74
  ds_read_b128 v[64:67], v75 offset:23552
  s_waitcnt lgkmcnt(4)
  v_smfmac_f32_16x16x64_bf16 v[20:23], v[12:15], v[176:183], v74
  s_waitcnt lgkmcnt(3)
  v_mov_b64 v[70:71], s[78:79]
  v_smfmac_f32_16x16x64_bf16 v[28:31], v[4:7], v[36:43], v74
  s_waitcnt lgkmcnt(2)
  v_mov_b64 v[36:37], 0
  v_smfmac_f32_16x16x64_bf16 v[20:23], v[8:11], v[192:199], v74
  v_mov_b64 v[38:39], 0
  v_smfmac_f32_16x16x64_bf16 v[24:27], v[12:15], v[184:191], v74
  v_mov_b64 v[40:41], 0
  v_smfmac_f32_16x16x64_bf16 v[24:27], v[8:11], v[200:207], v74
  s_waitcnt lgkmcnt(0)
  v_add_f32 v20, v20, v22
  v_smfmac_f32_16x16x64_bf16 v[32:35], v[4:7], v[60:67], v74
  v_add_f32 v21, v21, v23
  v_smfmac_f32_16x16x64_bf16 v[28:31], v[16:19], v[240:247], v74
  v_add_f32 v24, v24, v26
  v_cvt_pk_bf16_f32 v22, v20, v24
  v_smfmac_f32_16x16x64_bf16 v[28:31], v[12:15], a[0:7], v74
  ds_write_b32 v79, v22 offset:0
  v_add_f32 v25, v25, v27
  v_cvt_pk_bf16_f32 v23, v21, v25
  v_smfmac_f32_16x16x64_bf16 v[28:31], v[8:11], a[16:23], v74
  ds_write_b32 v79, v23 offset:576
  v_cmp_u_f32 vcc, v20, v21
  v_smfmac_f32_16x16x64_bf16 v[32:35], v[16:19], v[248:255], v74
  v_mov_b64 v[42:43], 0
  v_smfmac_f32_16x16x64_bf16 v[32:35], v[12:15], a[8:15], v74
  v_add_f32 v28, v28, v30
  v_add_f32 v29, v29, v31
  v_smfmac_f32_16x16x64_bf16 v[32:35], v[8:11], a[24:31], v74
  s_cbranch_vccnz Cs1_rec
Cs1_recok:
  v_smfmac_f32_16x16x64_bf16 v[36:39], v[16:19], a[128:135], v74
  s_waitcnt lgkmcnt(0)
  s_barrier
  ds_read_b128 v[60:63], v77
  v_smfmac_f32_16x16x64_bf16 v[40:43], v[16:19], a[136:143], v74
  ds_read_b128 v[64:67], v77 offset:128
  v_add_f32 v32, v32, v34
  v_cvt_pk_bf16_f32 v30, v28, v32
  v_smfmac_f32_16x16x64_bf16 v[36:39], v[0:3], a[96:103], v74
  ds_write_b32 v79, v30 offset:256
  v_add_f32 v33, v33, v35
  v_cvt_pk_bf16_f32 v31, v29, v33
  v_smfmac_f32_16x16x64_bf16 v[40:43], v[0:3], a[104:111], v74
  ds_write_b32 v79, v31 offset:832
  v_xor_b32 v75, 0x8000, v75
  v_smfmac_f32_16x16x64_bf16 v[36:39], v[4:7], a[112:119], v74
  ds_read_b128 v[0:3], v76 offset:4608
  v_mov_b32 v29, 0
  v_smfmac_f32_16x16x64_bf16 v[40:43], v[4:7], a[120:127], v74
  s_waitcnt vmcnt(2) lgkmcnt(3)
  v_mov_b32 v30, 0
  v_mfma_f32_16x16x32_bf16 v[44:47], v[44:47], v[60:63], 0
  ds_read_b128 v[4:7], v76 offset:5632
  s_waitcnt lgkmcnt(2)
  v_mfma_f32_16x16x32_bf16 v[44:47], v[48:51], v[64:67], v[44:47]
  s_barrier
  v_smfmac_f32_16x16x64_bf16 v[36:39], v[8:11], a[160:167], v74
  ds_read_b128 v[20:23], v77 offset:256
  ds_read_b128 v[24:27], v77 offset:384
  v_smfmac_f32_16x16x64_bf16 v[40:43], v[8:11], a[168:175], v74
  ds_read_b128 v[8:11], v76 offset:6656
  v_add_f32_dpp v72, v46, v44 quad_perm:[2,3,0,1] row_mask:0xf bank_mask:0xf
  v_add_f32_dpp v73, v47, v45 quad_perm:[2,3,0,1] row_mask:0xf bank_mask:0xf
  v_smfmac_f32_16x16x64_bf16 v[36:39], v[12:15], a[144:151], v74
  s_waitcnt lgkmcnt(4)
  v_exp_f32_dpp v72, v72 quad_perm:[0,1,0,1] row_mask:0xf bank_mask:0xf
  v_smfmac_f32_16x16x64_bf16 v[40:43], v[12:15], a[152:159], v74
  ds_read_b128 v[12:15], v76 offset:7680
  v_exp_f32_dpp v73, v73 quad_perm:[0,1,0,1] row_mask:0xf bank_mask:0xf
  v_smfmac_f32_16x16x64_bf16 v[36:39], v[0:3], a[32:39], v74
  s_waitcnt lgkmcnt(2)
  v_cvt_pk_bf16_f32 v72, v72, v73
  v_mfma_f32_16x16x32_bf16 v[20:23], v[20:23], v[60:63], 0
  ds_write_b32 v78, v72 offset:516
  v_mov_b64 v[16:17], 0
  v_mfma_f32_16x16x32_bf16 v[20:23], v[24:27], v[64:67], v[20:23]
  ds_read_b128 v[44:47], v75 offset:20480
  v_mov_b64 v[18:19], 0
  v_smfmac_f32_16x16x64_bf16 v[40:43], v[0:3], a[40:47], v74
  ds_read_b128 v[48:51], v75 offset:21504
  s_waitcnt lgkmcnt(4)
  v_smfmac_f32_16x16x64_bf16 v[36:39], v[4:7], a[48:55], v74
  v_add_f32_dpp v24, v22, v20 quad_perm:[2,3,0,1] row_mask:0xf bank_mask:0xf
  v_add_f32_dpp v25, v23, v21 quad_perm:[2,3,0,1] row_mask:0xf bank_mask:0xf
  v_smfmac_f32_16x16x64_bf16 v[36:39], v[8:11], a[64:71], v74
  s_waitcnt lgkmcnt(2)
  s_barrier
  ds_read_b128 v[32:35], v78 offset:512
  v_smfmac_f32_16x16x64_bf16 v[36:39], v[12:15], a[80:87], v74
  ds_read_b128 v[60:63], v75 offset:22528
  v_mul_f32 v24, s69, v24
  v_smfmac_f32_16x16x64_bf16 v[40:43], v[4:7], a[56:63], v74
  ds_read_b128 v[64:67], v75 offset:23552
  v_mul_f32 v25, s69, v25
  v_smfmac_f32_16x16x64_bf16 v[40:43], v[8:11], a[72:79], v74
  v_exp_f32_dpp v24, v24 quad_perm:[0,1,0,1] row_mask:0xf bank_mask:0xf
  v_smfmac_f32_16x16x64_bf16 v[40:43], v[12:15], a[88:95], v74
  s_waitcnt lgkmcnt(2)
  v_exp_f32_dpp v25, v25 quad_perm:[0,1,0,1] row_mask:0xf bank_mask:0xf
  v_mfma_f32_16x16x32_bf16 v[8:11], v[32:35], v[68:71], 0
  v_add_f32 v36, v36, v38
  v_add_f32 v37, v37, v39
  v_mfma_f32_16x16x32_bf16 v[0:3], v[32:35], v[52:55], 0
  v_add_f32 v40, v40, v42
  v_add_f32 v41, v41, v43
  v_mfma_f32_16x16x32_bf16 v[4:7], v[32:35], v[56:59], 0
  v_cvt_pk_bf16_f32 v28, v24, v25
  v_cvt_pk_bf16_f32 v72, v36, v37
  v_cvt_pk_bf16_f32 v73, v40, v41
  v_mfma_f32_16x16x16_bf16 v[8:11], v[28:29], v[68:69], v[8:11]
  v_cvt_pk_bf16_f32 v31, v24, v25
  v_mov_b64 v[20:21], 0
  v_mfma_f32_16x16x16_bf16 v[0:3], v[28:29], v[72:73], v[0:3]
  ds_read_b128 v[68:71], v76 offset:13824
  v_mov_b64 v[22:23], 0
  v_mfma_f32_16x16x16_bf16 v[4:7], v[30:31], v[72:73], v[4:7]
  v_rcp_f32 v10, v8
  v_rcp_f32 v11, v9
  v_mul_f32 v0, v10, v0
  v_mul_f32 v1, v11, v1
  s_nop 0
  v_mul_f32 v4, v10, v4
  v_mul_f32 v5, v11, v5
  v_cvt_pk_bf16_f32 v2, v0, v4
  ds_write_b32 v79, v2 offset:8704
  v_cvt_pk_bf16_f32 v3, v1, v5
  ds_write_b32 v79, v3 offset:9280
  v_max3_f32 v8, v8, v9, v10
  v_max_f32 v8, v8, v11
  v_cmp_le_f32 vcc, 1317011456, v8
  v_mov_b64 v[24:25], 0
  v_mov_b64 v[26:27], 0
  s_cbranch_vccnz Cs1_mx
Cs1_mxok:
  s_waitcnt lgkmcnt(0)
  s_barrier
  ds_read_b128 v[0:3], v78 offset:8704
  ds_read_b128 v[4:7], v78 offset:8768
  ds_read_b128 v[8:11], v78 offset:8832
  ds_read_b128 v[12:15], v78 offset:8896
  s_waitcnt lgkmcnt(3)
  v_smfmac_f32_16x16x64_bf16 v[16:19], v[0:3], v[44:51], v74
  ds_read_b128 v[52:55], v75 offset:36864
  s_waitcnt lgkmcnt(3)
  v_smfmac_f32_16x16x64_bf16 v[16:19], v[4:7], v[60:67], v74
  ds_read_b128 v[56:59], v75 offset:37888
  s_waitcnt lgkmcnt(3)
  v_smfmac_f32_16x16x64_bf16 v[16:19], v[8:11], a[176:183], v74
  ds_read_b128 v[36:39], v75 offset:38912
  s_waitcnt lgkmcnt(3)
  v_smfmac_f32_16x16x64_bf16 v[16:19], v[12:15], a[184:191], v74
  ds_read_b128 v[40:43], v75 offset:39936
  ds_read_b128 v[44:47], v75 offset:53248
  v_smfmac_f32_16x16x64_bf16 v[20:23], v[0:3], a[192:199], v74
  ds_read_b128 v[48:51], v75 offset:54272
  ds_read_b128 v[60:63], v75 offset:55296
  v_smfmac_f32_16x16x64_bf16 v[20:23], v[4:7], a[200:207], v74
  ds_read_b128 v[64:67], v75 offset:56320
  s_waitcnt lgkmcnt(6)
  v_cvt_pk_bf16_f32 v16, v16, v17
  v_cvt_pk_bf16_f32 v17, v18, v19
  v_bfi_b32 v16, 1, s72, v16
  v_smfmac_f32_16x16x64_bf16 v[20:23], v[8:11], v[52:59], v74
  buffer_store_dwordx2 v[16:17], v68, s[8:11], s73 offen sc1
  s_waitcnt lgkmcnt(4)
  v_smfmac_f32_16x16x64_bf16 v[20:23], v[12:15], v[36:43], v74
  v_mov_b64 v[32:33], 0
  v_smfmac_f32_16x16x64_bf16 v[24:27], v[0:3], a[208:215], v74
  v_mov_b64 v[34:35], 0
  v_smfmac_f32_16x16x64_bf16 v[24:27], v[4:7], a[216:223], v74
  s_waitcnt lgkmcnt(2)
  v_cvt_pk_bf16_f32 v20, v20, v21
  v_cvt_pk_bf16_f32 v21, v22, v23
  v_bfi_b32 v20, 1, s72, v20
  v_smfmac_f32_16x16x64_bf16 v[24:27], v[8:11], v[44:51], v74
  buffer_store_dwordx2 v[20:21], v68, s[8:11], s74 offen sc1
  s_waitcnt lgkmcnt(0)
  v_smfmac_f32_16x16x64_bf16 v[24:27], v[12:15], v[60:67], v74
  v_smfmac_f32_16x16x64_bf16 v[32:35], v[0:3], a[224:231], v74
  v_smfmac_f32_16x16x64_bf16 v[32:35], v[4:7], a[232:239], v74
  v_cvt_pk_bf16_f32 v24, v24, v25
  v_cvt_pk_bf16_f32 v25, v26, v27
  v_bfi_b32 v24, 1, s72, v24
  v_smfmac_f32_16x16x64_bf16 v[32:35], v[8:11], a[240:247], v74
  s_nop 1
  buffer_store_dwordx2 v[24:25], v68, s[8:11], s75 offen sc1
  v_smfmac_f32_16x16x64_bf16 v[32:35], v[12:15], a[248:255], v74
  ds_read_b128 v[0:3], v76 offset:14848
  ds_read_b64 v[16:17], v77 offset:264
  v_mov_b64 v[18:19], v[72:73]
  v_xor_b32 v75, 0x8000, v75
  s_nop 3
  v_cvt_pk_bf16_f32 v32, v32, v33
  v_cvt_pk_bf16_f32 v33, v34, v35
  v_bfi_b32 v32, 1, s72, v32
  buffer_store_dwordx2 v[32:33], v68, s[8:11], s76 offen sc1
  v_mov_b64 v[20:21], 0
  v_mov_b64 v[22:23], 0
  v_mov_b64 v[24:25], 0
  v_mov_b64 v[26:27], 0
  v_mov_b64 v[28:29], 0
  v_mov_b64 v[30:31], 0
  v_mov_b64 v[32:33], 0
  v_mov_b64 v[34:35], 0
  s_add_u32 s58, s58, 655360
  s_add_u32 s59, s59, 655360
  s_add_u32 s70, s70, 655360
  s_add_u32 s68, s68, 655360
  s_add_u32 s66, s66, 1
  s_xor_b32 s64, s64, 16384
  s_xor_b32 s65, s65, 16384
  s_cmp_eq_u32 s66, 62
  s_cselect_b64 s[16:17], s[20:21], s[16:17]
  s_cselect_b32 s18, (Cs1_done - Cs1_last), s18
  s_cselect_b32 s70, 0, s70
  s_cmp_eq_u32 s66, 63
  s_cselect_b32 s59, 268435456, s59
  s_nop 15
  s_nop 15
  s_nop 1
  buffer_load_dwordx4 v[52:55], v76, s[8:11], s60 offen offset:0 sc1
  buffer_load_dwordx4 v[56:59], v76, s[8:11], s60 offen offset:1024 sc1
  s_nop 15
  s_nop 11
  buffer_load_dwordx4 v[36:39], v76, s[8:11], s60 offen offset:0 sc1
  buffer_load_dwordx4 v[40:43], v76, s[8:11], s60 offen offset:1024 sc1
  s_waitcnt lgkmcnt(0)
  s_waitcnt vmcnt(3)
  v_mfma_f32_16x16x32_bf16 v[4:7], v[0:3], v[52:55], 0
  v_bitop3_b32 v72, v52, v54, s72 bitop3:0x7e
  s_waitcnt vmcnt(2)
  v_mfma_f32_16x16x32_bf16 v[4:7], v[0:3], v[56:59], v[4:7]
  v_bitop3_b32 v73, v56, v58, s72 bitop3:0x7e
  v_bitop3_b32 v72, v72, v73, 1 bitop3:0xa8
  v_cmp_ne_u32 vcc, 0, v72
  s_cbranch_vccnz Cs1_h1r
  s_nop 2
  v_add_f32_dpp v4, v4, v4 row_ror:4 row_mask:0xf bank_mask:0xf
  v_add_f32_dpp v5, v5, v5 row_ror:4 row_mask:0xf bank_mask:0xf
  s_nop 0
  v_add_f32_dpp v4, v4, v4 row_ror:8 row_mask:0xf bank_mask:0xf
  v_add_f32_dpp v5, v5, v5 row_ror:8 row_mask:0xf bank_mask:0xf
  v_cvt_pk_bf16_f32 v4, v4, v5
  buffer_store_dword v4, v69, s[8:11], s62 offen sc1
  s_xor_b32 s62, s62, 16384
  buffer_store_dword v71, v69, s[8:11], s62 offen sc1
  s_xor_b32 s72, s72, 1
  s_branch Cs1_h2
Cs1_h1r:
  s_mov_b64 exec, vcc
  buffer_load_dwordx4 v[52:55], v76, s[8:11], s60 offen offset:0 sc1
  buffer_load_dwordx4 v[56:59], v76, s[8:11], s60 offen offset:1024 sc1
  s_mov_b64 exec, -1
  s_add_u32 s67, s67, 1
  s_waitcnt vmcnt(3)
  v_mfma_f32_16x16x32_bf16 v[4:7], v[0:3], v[36:39], 0
  v_bitop3_b32 v72, v36, v38, s72 bitop3:0x7e
  s_waitcnt vmcnt(2)
  v_mfma_f32_16x16x32_bf16 v[4:7], v[0:3], v[40:43], v[4:7]
  v_bitop3_b32 v73, v40, v42, s72 bitop3:0x7e
  v_bitop3_b32 v72, v72, v73, 1 bitop3:0xa8
  v_cmp_ne_u32 vcc, 0, v72
  s_cbranch_vccz Cs1_h1p
  s_mov_b64 exec, vcc
  buffer_load_dwordx4 v[36:39], v76, s[8:11], s60 offen offset:0 sc1
  buffer_load_dwordx4 v[40:43], v76, s[8:11], s60 offen offset:1024 sc1
  s_mov_b64 exec, -1
  s_add_u32 s67, s67, 1
  s_waitcnt vmcnt(3)
  v_mfma_f32_16x16x32_bf16 v[4:7], v[0:3], v[52:55], 0
  v_bitop3_b32 v72, v52, v54, s72 bitop3:0x7e
  s_waitcnt vmcnt(2)
  v_mfma_f32_16x16x32_bf16 v[4:7], v[0:3], v[56:59], v[4:7]
  v_bitop3_b32 v73, v56, v58, s72 bitop3:0x7e
  v_bitop3_b32 v72, v72, v73, 1 bitop3:0xa8
  v_cmp_ne_u32 vcc, 0, v72
  s_cbranch_vccz Cs1_h1p
Cs1_h1s:
  s_mov_b64 exec, vcc
  buffer_load_dwordx4 v[52:55], v76, s[8:11], s60 offen offset:0 sc1
  buffer_load_dwordx4 v[56:59], v76, s[8:11], s60 offen offset:1024 sc1
  s_mov_b64 exec, -1
  s_add_u32 s67, s67, 1
  s_waitcnt vmcnt(3)
  v_mfma_f32_16x16x32_bf16 v[4:7], v[0:3], v[36:39], 0
  v_bitop3_b32 v72, v36, v38, s72 bitop3:0x7e
  s_waitcnt vmcnt(2)
  v_mfma_f32_16x16x32_bf16 v[4:7], v[0:3], v[40:43], v[4:7]
  v_bitop3_b32 v73, v40, v42, s72 bitop3:0x7e
  v_bitop3_b32 v72, v72, v73, 1 bitop3:0xa8
  v_cmp_ne_u32 vcc, 0, v72
  s_cbranch_vccz Cs1_h1p
  s_mov_b64 exec, vcc
  buffer_load_dwordx4 v[36:39], v76, s[8:11], s60 offen offset:0 sc1
  buffer_load_dwordx4 v[40:43], v76, s[8:11], s60 offen offset:1024 sc1
  s_mov_b64 exec, -1
  s_add_u32 s67, s67, 1
  s_waitcnt vmcnt(3)
  v_mfma_f32_16x16x32_bf16 v[4:7], v[0:3], v[52:55], 0
  v_bitop3_b32 v72, v52, v54, s72 bitop3:0x7e
  s_waitcnt vmcnt(2)
  v_mfma_f32_16x16x32_bf16 v[4:7], v[0:3], v[56:59], v[4:7]
  v_bitop3_b32 v73, v56, v58, s72 bitop3:0x7e
  v_bitop3_b32 v72, v72, v73, 1 bitop3:0xa8
  v_cmp_ne_u32 vcc, 0, v72
  s_cbranch_vccz Cs1_h1p
  s_cmp_lt_u32 s67, 131072
  s_cbranch_scc1 Cs1_h1s
Cs1_h1p:
  s_nop 2
  v_add_f32_dpp v4, v4, v4 row_ror:4 row_mask:0xf bank_mask:0xf
  v_add_f32_dpp v5, v5, v5 row_ror:4 row_mask:0xf bank_mask:0xf
  s_nop 0
  v_add_f32_dpp v4, v4, v4 row_ror:8 row_mask:0xf bank_mask:0xf
  v_add_f32_dpp v5, v5, v5 row_ror:8 row_mask:0xf bank_mask:0xf
  v_cvt_pk_bf16_f32 v4, v4, v5
  buffer_store_dword v4, v69, s[8:11], s62 offen sc1
  s_xor_b32 s62, s62, 16384
  buffer_store_dword v71, v69, s[8:11], s62 offen sc1
  s_xor_b32 s72, s72, 1
  s_branch Cs1_h2
Cs1_h2r:
  s_mov_b64 exec, vcc
  buffer_load_dwordx4 v[8:11], v76, s[8:11], s65 offen offset:2048 sc1
  s_mov_b64 exec, -1
  s_add_u32 s67, s67, 1
  s_waitcnt vmcnt(4)
  v_max3_u32 v72, v8, v9, v10
  v_max_u32 v72, v72, v11
  ds_write_b128 v76, v[8:11] offset:6656
  v_cmp_eq_u32 vcc, -1, v72
  s_cbranch_vccz Cs1_h2w
  s_mov_b64 exec, vcc
  buffer_load_dwordx4 v[8:11], v76, s[8:11], s65 offen offset:2048 sc1
  s_mov_b64 exec, -1
  s_add_u32 s67, s67, 1
  s_waitcnt vmcnt(4)
  v_max3_u32 v72, v8, v9, v10
  v_max_u32 v72, v72, v11
  ds_write_b128 v76, v[8:11] offset:6656
  v_cmp_eq_u32 vcc, -1, v72
  s_cbranch_vccz Cs1_h2w
Cs1_h2s:
  s_mov_b64 exec, vcc
  buffer_load_dwordx4 v[8:11], v76, s[8:11], s65 offen offset:2048 sc1
  s_mov_b64 exec, -1
  s_add_u32 s67, s67, 1
  s_waitcnt vmcnt(2)
  v_max3_u32 v72, v8, v9, v10
  v_max_u32 v72, v72, v11
  ds_write_b128 v76, v[8:11] offset:6656
  v_cmp_eq_u32 vcc, -1, v72
  s_cbranch_vccz Cs1_h2w
  s_mov_b64 exec, vcc
  buffer_load_dwordx4 v[8:11], v76, s[8:11], s65 offen offset:2048 sc1
  s_mov_b64 exec, -1
  s_add_u32 s67, s67, 1
  s_waitcnt vmcnt(2)
  v_max3_u32 v72, v8, v9, v10
  v_max_u32 v72, v72, v11
  ds_write_b128 v76, v[8:11] offset:6656
  v_cmp_eq_u32 vcc, -1, v72
  s_cbranch_vccz Cs1_h2w
  s_mov_b64 exec, vcc
  buffer_load_dwordx4 v[8:11], v76, s[8:11], s65 offen offset:2048 sc1
  s_mov_b64 exec, -1
  s_add_u32 s67, s67, 1
  s_waitcnt vmcnt(2)
  v_max3_u32 v72, v8, v9, v10
  v_max_u32 v72, v72, v11
  ds_write_b128 v76, v[8:11] offset:6656
  v_cmp_eq_u32 vcc, -1, v72
  s_cbranch_vccz Cs1_h2w
  s_cmp_lt_u32 s67, 131072
  s_cbranch_scc1 Cs1_h2s
Cs1_h2ok:
  ds_write_b128 v76, v[8:11] offset:6656
  s_branch Cs1_h2w
Cs1_rec:
  s_nop 7
  s_waitcnt vmcnt(0) lgkmcnt(0)
  v_max3_u32 v72, v0, v1, v2
  v_max3_u32 v72, v72, v3, v4
  v_max3_u32 v72, v72, v5, v6
  v_max3_u32 v72, v72, v7, v8
  v_max3_u32 v72, v72, v9, v10
  v_max3_u32 v72, v72, v11, v12
  v_max3_u32 v72, v72, v13, v14
  v_max3_u32 v72, v72, v15, v16
  v_max3_u32 v72, v72, v17, v18
  v_max_u32 v72, v72, v19
  v_cmp_eq_u32 vcc, -1, v72
  s_cbranch_vccz Cs1_recok
  s_barrier
  v_mov_b64 v[20:21], 0
  v_mov_b64 v[22:23], 0
  v_mov_b64 v[24:25], 0
  v_mov_b64 v[26:27], 0
  v_mov_b64 v[28:29], 0
  v_mov_b64 v[30:31], 0
  v_mov_b64 v[32:33], 0
  v_mov_b64 v[34:35], 0
  s_waitcnt lgkmcnt(0)
  s_barrier
  ds_read_b128 v[0:3], v76 offset:4608
  ds_read_b128 v[60:63], v76 offset:20480
  ds_read_b128 v[64:67], v76 offset:21504
  s_waitcnt lgkmcnt(0)
  v_smfmac_f32_16x16x64_bf16 v[20:23], v[0:3], v[60:67], v74
  ds_read_b128 v[60:63], v76 offset:22528
  ds_read_b128 v[64:67], v76 offset:23552
  s_waitcnt lgkmcnt(0)
  v_smfmac_f32_16x16x64_bf16 v[24:27], v[0:3], v[60:67], v74
  ds_read_b128 v[60:63], v76 offset:36864
  ds_read_b128 v[64:67], v76 offset:37888
  s_waitcnt lgkmcnt(0)
  v_smfmac_f32_16x16x64_bf16 v[28:31], v[0:3], v[60:67], v74
  ds_read_b128 v[60:63], v76 offset:38912
  ds_read_b128 v[64:67], v76 offset:39936
  s_waitcnt lgkmcnt(0)
  v_smfmac_f32_16x16x64_bf16 v[32:35], v[0:3], v[60:67], v74
  ds_read_b128 v[4:7], v76 offset:5632
  s_waitcnt lgkmcnt(0)
  v_smfmac_f32_16x16x64_bf16 v[20:23], v[4:7], v[80:87], v74
  v_smfmac_f32_16x16x64_bf16 v[24:27], v[4:7], v[88:95], v74
  v_smfmac_f32_16x16x64_bf16 v[28:31], v[4:7], v[208:215], v74
  v_smfmac_f32_16x16x64_bf16 v[32:35], v[4:7], v[216:223], v74
  ds_read_b128 v[8:11], v76 offset:6656
  s_waitcnt lgkmcnt(0)
  v_smfmac_f32_16x16x64_bf16 v[20:23], v[8:11], v[96:103], v74
  v_smfmac_f32_16x16x64_bf16 v[24:27], v[8:11], v[104:111], v74
  ds_read_b128 v[60:63], v76 offset:53248
  ds_read_b128 v[64:67], v76 offset:54272
  s_waitcnt lgkmcnt(0)
  v_smfmac_f32_16x16x64_bf16 v[28:31], v[8:11], v[60:67], v74
  ds_read_b128 v[60:63], v76 offset:55296
  ds_read_b128 v[64:67], v76 offset:56320
  s_waitcnt lgkmcnt(0)
  v_smfmac_f32_16x16x64_bf16 v[32:35], v[8:11], v[60:67], v74
  ds_read_b128 v[12:15], v76 offset:7680
  s_waitcnt lgkmcnt(0)
  v_smfmac_f32_16x16x64_bf16 v[20:23], v[12:15], v[112:119], v74
  v_smfmac_f32_16x16x64_bf16 v[24:27], v[12:15], v[120:127], v74
  v_smfmac_f32_16x16x64_bf16 v[28:31], v[12:15], v[224:231], v74
  v_smfmac_f32_16x16x64_bf16 v[32:35], v[12:15], v[232:239], v74
  ds_read_b128 v[0:3], v76 offset:8704
  s_waitcnt lgkmcnt(0)
  v_smfmac_f32_16x16x64_bf16 v[20:23], v[0:3], v[128:135], v74
  v_smfmac_f32_16x16x64_bf16 v[24:27], v[0:3], v[136:143], v74
  ds_read_b128 v[60:63], v75 offset:4096
  ds_read_b128 v[64:67], v75 offset:5120
  s_waitcnt lgkmcnt(0)
  v_smfmac_f32_16x16x64_bf16 v[28:31], v[0:3], v[60:67], v74
  ds_read_b128 v[60:63], v75 offset:6144
  ds_read_b128 v[64:67], v75 offset:7168
  s_waitcnt lgkmcnt(0)
  v_smfmac_f32_16x16x64_bf16 v[32:35], v[0:3], v[60:67], v74
  ds_read_b128 v[4:7], v76 offset:9728
  s_waitcnt lgkmcnt(0)
  v_smfmac_f32_16x16x64_bf16 v[20:23], v[4:7], v[144:151], v74
  v_smfmac_f32_16x16x64_bf16 v[24:27], v[4:7], v[152:159], v74
  ds_read_b128 v[60:63], v75 offset:20480
  ds_read_b128 v[64:67], v75 offset:21504
  s_waitcnt lgkmcnt(0)
  v_smfmac_f32_16x16x64_bf16 v[28:31], v[4:7], v[60:67], v74
  ds_read_b128 v[60:63], v75 offset:22528
  ds_read_b128 v[64:67], v75 offset:23552
  s_waitcnt lgkmcnt(0)
  v_smfmac_f32_16x16x64_bf16 v[32:35], v[4:7], v[60:67], v74
  ds_read_b128 v[16:19], v76 offset:10752
  s_waitcnt lgkmcnt(0)
  v_smfmac_f32_16x16x64_bf16 v[20:23], v[16:19], v[160:167], v74
  v_smfmac_f32_16x16x64_bf16 v[24:27], v[16:19], v[168:175], v74
  v_smfmac_f32_16x16x64_bf16 v[28:31], v[16:19], v[240:247], v74
  v_smfmac_f32_16x16x64_bf16 v[32:35], v[16:19], v[248:255], v74
  ds_read_b128 v[12:15], v76 offset:11776
  s_waitcnt lgkmcnt(0)
  v_smfmac_f32_16x16x64_bf16 v[20:23], v[12:15], v[176:183], v74
  v_smfmac_f32_16x16x64_bf16 v[24:27], v[12:15], v[184:191], v74
  v_smfmac_f32_16x16x64_bf16 v[28:31], v[12:15], a[0:7], v74
  v_smfmac_f32_16x16x64_bf16 v[32:35], v[12:15], a[8:15], v74
  ds_read_b128 v[8:11], v76 offset:12800
  s_waitcnt lgkmcnt(0)
  v_smfmac_f32_16x16x64_bf16 v[20:23], v[8:11], v[192:199], v74
  v_smfmac_f32_16x16x64_bf16 v[24:27], v[8:11], v[200:207], v74
  v_smfmac_f32_16x16x64_bf16 v[28:31], v[8:11], a[16:23], v74
  v_smfmac_f32_16x16x64_bf16 v[32:35], v[8:11], a[24:31], v74
  v_add_f32 v20, v20, v22
  v_add_f32 v21, v21, v23
  v_add_f32 v24, v24, v26
  v_cvt_pk_bf16_f32 v22, v20, v24
  s_nop 0
  ds_write_b32 v79, v22 offset:0
  v_add_f32 v25, v25, v27
  v_cvt_pk_bf16_f32 v23, v21, v25
  ds_write_b32 v79, v23 offset:576
  v_add_f32 v28, v28, v30
  v_add_f32 v29, v29, v31
  s_waitcnt lgkmcnt(0)
  s_nop 1
  s_branch Cs1_recok
Cs1_mx:
  s_waitcnt lgkmcnt(0)
  s_barrier
  buffer_load_dwordx4 v[0:3], v76, s[8:11], s58 offen offset:0 sc1
  ds_read_b128 v[20:23], v77 offset:0
  ds_read_b128 v[28:31], v77 offset:256
  buffer_load_dwordx4 v[4:7], v76, s[8:11], s58 offen offset:1024 sc1
  ds_read_b128 v[24:27], v77 offset:128
  ds_read_b128 v[32:35], v77 offset:384
  s_waitcnt vmcnt(1) lgkmcnt(3)
  v_mfma_f32_16x16x32_bf16 v[8:11], v[0:3], v[20:23], 0
  s_waitcnt vmcnt(0) lgkmcnt(1)
  v_mfma_f32_16x16x32_bf16 v[8:11], v[4:7], v[24:27], v[8:11]
  v_mfma_f32_16x16x32_bf16 v[12:15], v[28:31], v[20:23], 0
  s_waitcnt lgkmcnt(0)
  v_mfma_f32_16x16x32_bf16 v[12:15], v[32:35], v[24:27], v[12:15]
  v_add_f32_dpp v8, v10, v8 quad_perm:[2,3,0,1] row_mask:0xf bank_mask:0xf
  v_add_f32_dpp v9, v11, v9 quad_perm:[2,3,0,1] row_mask:0xf bank_mask:0xf
  s_nop 0
  v_mov_b32_dpp v8, v8 quad_perm:[0,1,0,1] row_mask:0xf bank_mask:0xf
  v_mov_b32_dpp v9, v9 quad_perm:[0,1,0,1] row_mask:0xf bank_mask:0xf
  s_nop 1
  v_add_f32_dpp v12, v14, v12 quad_perm:[2,3,0,1] row_mask:0xf bank_mask:0xf
  v_add_f32_dpp v13, v15, v13 quad_perm:[2,3,0,1] row_mask:0xf bank_mask:0xf
  s_nop 0
  v_mov_b32_dpp v12, v12 quad_perm:[0,1,0,1] row_mask:0xf bank_mask:0xf
  v_mov_b32_dpp v13, v13 quad_perm:[0,1,0,1] row_mask:0xf bank_mask:0xf
  v_mul_f32 v12, s69, v12
  ds_write_b32 v78, v8 offset:8708
  v_mul_f32 v13, s69, v13
  ds_write_b32 v78, v9 offset:8772
  s_waitcnt lgkmcnt(0)
  s_barrier
  ds_read_b128 v[36:39], v78 offset:8704
  ds_read_b128 v[40:43], v78 offset:8768
  s_waitcnt lgkmcnt(0)
  s_barrier
  v_max_f32 v16, v36, v37
  v_max3_f32 v16, v16, v38, v39
  v_max3_f32 v16, v16, v40, v41
  v_max3_f32 v16, v16, v42, v43
  v_max3_f32 v16, v16, v12, v13
  v_mov_b32 v17, v16
  s_nop 1
  v_permlane16_swap_b32 v16, v17
  v_max_f32 v16, v16, v17
  v_mov_b32 v17, v16
  s_nop 1
  v_permlane32_swap_b32 v16, v17
  v_max_f32 v16, v16, v17
  v_sub_f32 v36, v36, v16
  v_sub_f32 v37, v37, v16
  v_sub_f32 v38, v38, v16
  v_sub_f32 v39, v39, v16
  v_sub_f32 v40, v40, v16
  v_sub_f32 v41, v41, v16
  v_sub_f32 v42, v42, v16
  v_sub_f32 v43, v43, v16
  v_sub_f32 v12, v12, v16
  v_sub_f32 v13, v13, v16
  v_exp_f32 v36, v36
  v_exp_f32 v37, v37
  v_exp_f32 v38, v38
  v_exp_f32 v39, v39
  v_exp_f32 v40, v40
  v_exp_f32 v41, v41
  v_exp_f32 v42, v42
  v_exp_f32 v43, v43
  v_exp_f32 v12, v12
  v_exp_f32 v13, v13
  v_cvt_pk_bf16_f32 v32, v36, v40
  v_cvt_pk_bf16_f32 v33, v37, v41
  v_cvt_pk_bf16_f32 v34, v38, v42
  v_cvt_pk_bf16_f32 v35, v39, v43
  v_cvt_pk_bf16_f32 v28, v12, v13
  v_cvt_pk_bf16_f32 v31, v12, v13
  v_mov_b32 v29, 0
  v_mov_b32 v30, 0
  v_mov_b32 v68, 0x3f803f80
  v_mov_b32 v69, 0x3f803f80
  v_mov_b32 v70, 0x3f803f80
  v_mov_b32 v71, 0x3f803f80
  s_nop 1
  v_mfma_f32_16x16x32_bf16 v[8:11], v[32:35], v[68:71], 0
  v_mfma_f32_16x16x32_bf16 v[0:3], v[32:35], v[52:55], 0
  v_mfma_f32_16x16x32_bf16 v[4:7], v[32:35], v[56:59], 0
  v_mfma_f32_16x16x16_bf16 v[8:11], v[28:29], v[68:69], v[8:11]
  v_mfma_f32_16x16x16_bf16 v[0:3], v[28:29], v[72:73], v[0:3]
  v_mfma_f32_16x16x16_bf16 v[4:7], v[30:31], v[72:73], v[4:7]
  ds_read_b128 v[68:71], v76 offset:13824
  v_rcp_f32 v10, v8
  v_rcp_f32 v11, v9
  v_mul_f32 v0, v10, v0
  v_mul_f32 v1, v11, v1
  s_nop 0
  v_mul_f32 v4, v10, v4
  v_mul_f32 v5, v11, v5
  v_cvt_pk_bf16_f32 v2, v0, v4
  ds_write_b32 v79, v2 offset:8704
  v_cvt_pk_bf16_f32 v3, v1, v5
  ds_write_b32 v79, v3 offset:9280
  v_mov_b64 v[16:17], 0
  v_mov_b64 v[18:19], 0
  v_mov_b64 v[20:21], 0
  v_mov_b64 v[22:23], 0
  v_mov_b64 v[24:25], 0
  v_mov_b64 v[26:27], 0
  s_branch Cs1_mxok
Cs1_last:
  ds_read_b128 v[12:15], v76 offset:7680
  ds_read_b128 v[60:63], v76 offset:38912
  ds_read_b128 v[64:67], v76 offset:39936
  ds_read_b128 v[44:47], v76 offset:53248
  ds_read_b128 v[48:51], v76 offset:54272
  s_waitcnt lgkmcnt(6)
  v_smfmac_f32_16x16x64_bf16 v[28:31], v[0:3], v[36:43], v74
  v_smfmac_f32_16x16x64_bf16 v[20:23], v[0:3], a[32:39], v74
  ds_read_b128 v[36:39], v76 offset:55296
  ds_read_b128 v[40:43], v76 offset:56320
  v_smfmac_f32_16x16x64_bf16 v[24:27], v[0:3], a[40:47], v74
  s_waitcnt lgkmcnt(7)
  v_smfmac_f32_16x16x64_bf16 v[20:23], v[4:7], a[48:55], v74
  buffer_store_dwordx4 v[16:19], v76, s[8:11], s68 offen sc1
  v_smfmac_f32_16x16x64_bf16 v[24:27], v[4:7], a[56:63], v74
  s_waitcnt lgkmcnt(4)
  v_smfmac_f32_16x16x64_bf16 v[28:31], v[4:7], v[208:215], v74
  v_smfmac_f32_16x16x64_bf16 v[32:35], v[4:7], v[216:223], v74
  s_waitcnt lgkmcnt(2)
  v_smfmac_f32_16x16x64_bf16 v[32:35], v[0:3], v[60:67], v74
  v_smfmac_f32_16x16x64_bf16 v[20:23], v[8:11], a[64:71], v74
  ds_read_b128 v[60:63], v75 offset:4096
  ds_read_b128 v[64:67], v75 offset:5120
  v_smfmac_f32_16x16x64_bf16 v[24:27], v[8:11], a[72:79], v74
  v_smfmac_f32_16x16x64_bf16 v[28:31], v[8:11], v[44:51], v74
  v_smfmac_f32_16x16x64_bf16 v[20:23], v[12:15], a[80:87], v74
  ds_read_b128 v[44:47], v75 offset:6144
  ds_read_b128 v[48:51], v75 offset:7168
  v_smfmac_f32_16x16x64_bf16 v[24:27], v[12:15], a[88:95], v74
  s_waitcnt lgkmcnt(4)
  v_smfmac_f32_16x16x64_bf16 v[28:31], v[12:15], v[224:231], v74
  v_smfmac_f32_16x16x64_bf16 v[32:35], v[12:15], v[232:239], v74
  v_smfmac_f32_16x16x64_bf16 v[32:35], v[8:11], v[36:43], v74
  ds_read_b128 v[36:39], v75 offset:20480
  ds_read_b128 v[40:43], v75 offset:21504
  s_waitcnt vmcnt(1)
  s_barrier
Cs1_lastr:
  ds_read_b128 v[0:3], v76 offset:8704
  ds_read_b128 v[4:7], v76 offset:9728
  ds_read_b128 v[16:19], v76 offset:10752
  ds_read_b128 v[12:15], v76 offset:11776
  ds_read_b128 v[8:11], v76 offset:12800
  s_waitcnt lgkmcnt(4)
  v_max3_u32 v72, v0, v1, v2
  s_waitcnt lgkmcnt(3)
  v_max3_u32 v72, v72, v3, v4
  v_max3_u32 v72, v72, v5, v6
  s_waitcnt lgkmcnt(0)
  v_max3_u32 v72, v72, v7, v8
  v_max3_u32 v72, v72, v9, v10
  v_max3_u32 v72, v72, v11, v12
  v_max3_u32 v72, v72, v13, v14
  v_max3_u32 v72, v72, v15, v16
  v_max3_u32 v72, v72, v17, v18
  v_max_u32 v72, v72, v19
  v_cmp_eq_u32 vcc, -1, v72
  s_cbranch_vccnz Cs1_lastp
Cs1_lastg:
  v_smfmac_f32_16x16x64_bf16 v[28:31], v[0:3], v[60:67], v74
  ds_read_b128 v[60:63], v75 offset:22528
  ds_read_b128 v[64:67], v75 offset:23552
  v_smfmac_f32_16x16x64_bf16 v[32:35], v[0:3], v[44:51], v74
  v_smfmac_f32_16x16x64_bf16 v[28:31], v[4:7], v[36:43], v74
  v_smfmac_f32_16x16x64_bf16 v[28:31], v[16:19], v[240:247], v74
  v_smfmac_f32_16x16x64_bf16 v[28:31], v[12:15], a[0:7], v74
  v_smfmac_f32_16x16x64_bf16 v[28:31], v[8:11], a[16:23], v74
  v_smfmac_f32_16x16x64_bf16 v[32:35], v[16:19], v[248:255], v74
  v_smfmac_f32_16x16x64_bf16 v[32:35], v[12:15], a[8:15], v74
  s_waitcnt lgkmcnt(0)
  v_smfmac_f32_16x16x64_bf16 v[32:35], v[8:11], a[24:31], v74
  v_smfmac_f32_16x16x64_bf16 v[32:35], v[4:7], v[60:67], v74
  v_smfmac_f32_16x16x64_bf16 v[20:23], v[0:3], a[96:103], v74
  v_smfmac_f32_16x16x64_bf16 v[20:23], v[4:7], a[112:119], v74
  v_add_f32 v28, v28, v30
  v_add_f32 v32, v32, v34
  v_cvt_pk_bf16_f32 v30, v28, v32
  v_smfmac_f32_16x16x64_bf16 v[20:23], v[16:19], a[128:135], v74
  ds_write_b32 v79, v30 offset:256
  v_add_f32 v29, v29, v31
  v_add_f32 v33, v33, v35
  v_cvt_pk_bf16_f32 v31, v29, v33
  v_smfmac_f32_16x16x64_bf16 v[20:23], v[12:15], a[144:151], v74
  ds_write_b32 v79, v31 offset:832
  v_smfmac_f32_16x16x64_bf16 v[20:23], v[8:11], a[160:167], v74
  v_smfmac_f32_16x16x64_bf16 v[24:27], v[0:3], a[104:111], v74
  v_smfmac_f32_16x16x64_bf16 v[24:27], v[4:7], a[120:127], v74
  v_smfmac_f32_16x16x64_bf16 v[24:27], v[16:19], a[136:143], v74
  s_waitcnt lgkmcnt(0)
  s_barrier
  ds_read_b64 v[52:53], v77 offset:264
  v_add_f32 v20, v20, v22
  v_smfmac_f32_16x16x64_bf16 v[24:27], v[12:15], a[152:159], v74
  v_add_f32 v21, v21, v23
  v_smfmac_f32_16x16x64_bf16 v[24:27], v[8:11], a[168:175], v74
  v_cvt_pk_bf16_f32 v54, v20, v21
  s_add_u32 s68, s68, 655360
  s_nop 3
  v_add_f32 v24, v24, v26
  v_add_f32 v25, v25, v27
  v_cvt_pk_bf16_f32 v55, v24, v25
  s_waitcnt lgkmcnt(0)
  buffer_store_dwordx4 v[52:55], v76, s[8:11], s68 offen sc1
  s_branch Cs1_done
Cs1_lastp:
  s_add_u32 s72, s72, 2
  s_cmp_ge_u32 s72, 131072
  s_cbranch_scc1 Cs1_lastg
  s_barrier
  s_waitcnt vmcnt(0)
  s_barrier
  s_branch Cs1_lastr
Cs1_done:
  s_branch L_cexit
L_w6:
  v_mov_b64 v[20:21], 0
  v_mov_b64 v[22:23], 0
  v_mov_b64 v[24:25], 0
  v_mov_b64 v[26:27], 0
  v_mov_b64 v[28:29], 0
  v_mov_b64 v[30:31], 0
  v_mov_b64 v[32:33], 0
  v_mov_b64 v[34:35], 0
  s_mov_b32 s78, 0x3f803f80
  s_mov_b32 s79, s78
  s_mov_b32 s65, 360448
  s_mov_b32 m0, 15872
  s_lshl_b32 s71, s53, 2
  s_add_u32 s71, s71, 128
  s_movk_i32 s56, 0x1000
  v_lshlrev_b32 v73, 2, v76
  v_mov_b32 v72, 0
  s_mov_b64 s[16:17], s[8:9]
  s_mov_b32 s18, 268435456
  s_mov_b32 s19, 0x20000
  s_getpc_b64 s[20:21]
Cs2_pc:
  s_add_u32 s20, s20, (Cs2_last - Cs2_pc)
  s_addc_u32 s21, s21, 0
  buffer_load_dwordx4 v[52:55], v76, s[8:11], s59 offen offset:0 sc1
  buffer_load_dwordx4 v[56:59], v76, s[8:11], s59 offen offset:1024 sc1
  ds_read_b128 v[60:63], v76 offset:24576
  ds_read_b128 v[64:67], v76 offset:25600
  ds_read_b128 v[44:47], v76 offset:26624
  ds_read_b128 v[48:51], v76 offset:27648
  ds_read_b128 v[36:39], v76 offset:40960
  ds_read_b128 v[40:43], v76 offset:41984
  ds_read_b128 v[0:3], v76 offset:4608
  ds_read_b128 v[4:7], v76 offset:5632
  ds_read_b128 v[12:15], v76 offset:7680
  s_waitcnt lgkmcnt(0)
  s_branch Cs2_top2
.p2align 6
Cs2_h2:
  v_lshlrev_b32 v73, 2, v76
  s_nop 3
  buffer_load_dwordx4 v[12:15], v76, s[8:11], s65 offen offset:3072 sc1
  s_nop 15
  s_nop 3
  buffer_load_dwordx4 v[12:15], v76, s[8:11], s65 offen offset:3072 sc1
  s_nop 15
  s_nop 3
  buffer_load_dwordx4 v[12:15], v76, s[8:11], s65 offen offset:3072 sc1
  s_waitcnt vmcnt(5)
  ds_read_b128 v[60:63], v76 offset:24576
  ds_read_b128 v[64:67], v76 offset:25600
  ds_read_b128 v[44:47], v76 offset:26624
  ds_read_b128 v[48:51], v76 offset:27648
  ds_read_b128 v[36:39], v76 offset:40960
  ds_read_b128 v[40:43], v76 offset:41984
  buffer_load_dwordx4 v[52:55], v76, s[8:11], s59 offen offset:0 sc1
  buffer_load_dwordx4 v[56:59], v76, s[8:11], s59 offen offset:1024 sc1
  s_waitcnt vmcnt(4)
  v_max3_u32 v72, v12, v13, v14
  v_max_u32 v72, v72, v15
  ds_write_b128 v76, v[12:15] offset:7680
  v_cmp_eq_u32 vcc, -1, v72
  s_cbranch_vccnz Cs2_h2r
Cs2_h2w:
  s_cmp_eq_u32 s66, 63
  s_waitcnt lgkmcnt(0)
  s_barrier
  ds_read_b128 v[0:3], v76 offset:4608
  ds_read_b128 v[4:7], v76 offset:5632
  s_cbranch_scc1 Cs2_last
Cs2_top2:
  ds_read_b128 v[8:11], v76 offset:6656
  s_waitcnt lgkmcnt(2)
  v_smfmac_f32_16x16x64_bf16 v[20:23], v[0:3], v[60:67], v74
  ds_read_b128 v[60:63], v76 offset:43008
  v_smfmac_f32_16x16x64_bf16 v[24:27], v[0:3], v[44:51], v74
  buffer_load_dwordx4 v[44:47], v76, s[8:11], s58 offen offset:0 sc1
  ds_read_b128 v[64:67], v76 offset:44032
  s_waitcnt lgkmcnt(3)
  v_smfmac_f32_16x16x64_bf16 v[20:23], v[4:7], v[80:87], v74
  buffer_load_dwordx4 v[48:51], v76, s[8:11], s58 offen offset:1024 sc1
  v_smfmac_f32_16x16x64_bf16 v[28:31], v[0:3], v[36:43], v74
  ds_read_b128 v[36:39], v76 offset:57344
  v_smfmac_f32_16x16x64_bf16 v[24:27], v[4:7], v[88:95], v74
  ds_read_b128 v[40:43], v76 offset:58368
  s_waitcnt lgkmcnt(4)
  v_smfmac_f32_16x16x64_bf16 v[28:31], v[4:7], v[208:215], v74
  v_smfmac_f32_16x16x64_bf16 v[32:35], v[4:7], v[216:223], v74
  buffer_store_dwordx4 v[16:19], v76, s[8:11], s68 offen sc1
  s_waitcnt lgkmcnt(2)
  v_smfmac_f32_16x16x64_bf16 v[32:35], v[0:3], v[60:67], v74
  buffer_load_dword v73, s[16:19], s70 offen  lds
  v_smfmac_f32_16x16x64_bf16 v[20:23], v[8:11], v[96:103], v74
  ds_read_b128 v[60:63], v76 offset:59392
  v_smfmac_f32_16x16x64_bf16 v[24:27], v[8:11], v[104:111], v74
  ds_read_b128 v[64:67], v76 offset:60416
  s_waitcnt lgkmcnt(2)
  v_smfmac_f32_16x16x64_bf16 v[28:31], v[8:11], v[36:43], v74
  ds_read_b128 v[36:39], v75 offset:8192
  v_smfmac_f32_16x16x64_bf16 v[20:23], v[12:15], v[112:119], v74
  ds_read_b128 v[40:43], v75 offset:9216
  v_smfmac_f32_16x16x64_bf16 v[24:27], v[12:15], v[120:127], v74
  s_waitcnt vmcnt(4)
  v_smfmac_f32_16x16x64_bf16 v[28:31], v[12:15], v[224:231], v74
  s_barrier
  ds_read_b128 v[0:3], v76 offset:8704
  v_smfmac_f32_16x16x64_bf16 v[32:35], v[12:15], v[232:239], v74
  ds_read_b128 v[4:7], v76 offset:9728
  s_waitcnt lgkmcnt(4)
  v_smfmac_f32_16x16x64_bf16 v[32:35], v[8:11], v[60:67], v74
  ds_read_b128 v[60:63], v75 offset:10240
  s_waitcnt lgkmcnt(2)
  v_smfmac_f32_16x16x64_bf16 v[20:23], v[0:3], v[128:135], v74
  ds_read_b128 v[16:19], v76 offset:10752
  v_smfmac_f32_16x16x64_bf16 v[24:27], v[0:3], v[136:143], v74
  ds_read_b128 v[64:67], v75 offset:11264
  v_smfmac_f32_16x16x64_bf16 v[28:31], v[0:3], v[36:43], v74
  ds_read_b128 v[36:39], v75 offset:24576
  s_waitcnt lgkmcnt(4)
  v_smfmac_f32_16x16x64_bf16 v[20:23], v[4:7], v[144:151], v74
  ds_read_b128 v[12:15], v76 offset:11776
  v_smfmac_f32_16x16x64_bf16 v[24:27], v[4:7], v[152:159], v74
  ds_read_b128 v[40:43], v75 offset:25600
  s_waitcnt lgkmcnt(4)
  v_smfmac_f32_16x16x64_bf16 v[20:23], v[16:19], v[160:167], v74
  ds_read_b128 v[8:11], v76 offset:12800
  s_waitcnt lgkmcnt(4)
  v_smfmac_f32_16x16x64_bf16 v[32:35], v[0:3], v[60:67], v74
  ds_read_b128 v[60:63], v75 offset:26624
  v_mov_b64 v[68:69], s[78:79]
  v_smfmac_f32_16x16x64_bf16 v[24:27], v[16:19], v[168:175], v74
  ds_read_b128 v[64:67], v75 offset:27648
  s_waitcnt lgkmcnt(4)
  v_smfmac_f32_16x16x64_bf16 v[20:23], v[12:15], v[176:183], v74
  s_waitcnt lgkmcnt(3)
  v_mov_b64 v[70:71], s[78:79]
  v_smfmac_f32_16x16x64_bf16 v[28:31], v[4:7], v[36:43], v74
  s_waitcnt lgkmcnt(2)
  v_mov_b64 v[36:37], 0
  v_smfmac_f32_16x16x64_bf16 v[20:23], v[8:11], v[192:199], v74
  v_mov_b64 v[38:39], 0
  v_smfmac_f32_16x16x64_bf16 v[24:27], v[12:15], v[184:191], v74
  v_mov_b64 v[40:41], 0
  v_smfmac_f32_16x16x64_bf16 v[24:27], v[8:11], v[200:207], v74
  s_waitcnt lgkmcnt(0)
  v_add_f32 v20, v20, v22
  v_smfmac_f32_16x16x64_bf16 v[32:35], v[4:7], v[60:67], v74
  v_add_f32 v21, v21, v23
  v_smfmac_f32_16x16x64_bf16 v[28:31], v[16:19], v[240:247], v74
  v_add_f32 v24, v24, v26
  v_cvt_pk_bf16_f32 v22, v20, v24
  v_smfmac_f32_16x16x64_bf16 v[28:31], v[12:15], a[0:7], v74
  ds_write_b32 v79, v22 offset:0
  v_add_f32 v25, v25, v27
  v_cvt_pk_bf16_f32 v23, v21, v25
  v_smfmac_f32_16x16x64_bf16 v[28:31], v[8:11], a[16:23], v74
  ds_write_b32 v79, v23 offset:576
  v_cmp_u_f32 vcc, v20, v21
  v_smfmac_f32_16x16x64_bf16 v[32:35], v[16:19], v[248:255], v74
  v_mov_b64 v[42:43], 0
  v_smfmac_f32_16x16x64_bf16 v[32:35], v[12:15], a[8:15], v74
  v_add_f32 v28, v28, v30
  v_add_f32 v29, v29, v31
  v_smfmac_f32_16x16x64_bf16 v[32:35], v[8:11], a[24:31], v74
  s_cbranch_vccnz Cs2_rec
Cs2_recok:
  v_smfmac_f32_16x16x64_bf16 v[36:39], v[16:19], a[128:135], v74
  s_waitcnt lgkmcnt(0)
  s_barrier
  ds_read_b128 v[60:63], v77
  v_smfmac_f32_16x16x64_bf16 v[40:43], v[16:19], a[136:143], v74
  ds_read_b128 v[64:67], v77 offset:128
  v_add_f32 v32, v32, v34
  v_cvt_pk_bf16_f32 v30, v28, v32
  v_smfmac_f32_16x16x64_bf16 v[36:39], v[0:3], a[96:103], v74
  ds_write_b32 v79, v30 offset:256
  v_add_f32 v33, v33, v35
  v_cvt_pk_bf16_f32 v31, v29, v33
  v_smfmac_f32_16x16x64_bf16 v[40:43], v[0:3], a[104:111], v74
  ds_write_b32 v79, v31 offset:832
  v_xor_b32 v75, 0x8000, v75
  v_smfmac_f32_16x16x64_bf16 v[36:39], v[4:7], a[112:119], v74
  ds_read_b128 v[0:3], v76 offset:4608
  v_mov_b32 v29, 0
  v_smfmac_f32_16x16x64_bf16 v[40:43], v[4:7], a[120:127], v74
  s_waitcnt vmcnt(2) lgkmcnt(3)
  v_mov_b32 v30, 0
  v_mfma_f32_16x16x32_bf16 v[44:47], v[44:47], v[60:63], 0
  ds_read_b128 v[4:7], v76 offset:5632
  s_waitcnt lgkmcnt(2)
  v_mfma_f32_16x16x32_bf16 v[44:47], v[48:51], v[64:67], v[44:47]
  s_barrier
  v_smfmac_f32_16x16x64_bf16 v[36:39], v[8:11], a[160:167], v74
  ds_read_b128 v[20:23], v77 offset:256
  ds_read_b128 v[24:27], v77 offset:384
  v_smfmac_f32_16x16x64_bf16 v[40:43], v[8:11], a[168:175], v74
  ds_read_b128 v[8:11], v76 offset:6656
  v_add_f32_dpp v72, v46, v44 quad_perm:[2,3,0,1] row_mask:0xf bank_mask:0xf
  v_add_f32_dpp v73, v47, v45 quad_perm:[2,3,0,1] row_mask:0xf bank_mask:0xf
  v_smfmac_f32_16x16x64_bf16 v[36:39], v[12:15], a[144:151], v74
  s_waitcnt lgkmcnt(4)
  v_exp_f32_dpp v72, v72 quad_perm:[0,1,0,1] row_mask:0xf bank_mask:0xf
  v_smfmac_f32_16x16x64_bf16 v[40:43], v[12:15], a[152:159], v74
  ds_read_b128 v[12:15], v76 offset:7680
  v_exp_f32_dpp v73, v73 quad_perm:[0,1,0,1] row_mask:0xf bank_mask:0xf
  v_smfmac_f32_16x16x64_bf16 v[36:39], v[0:3], a[32:39], v74
  s_waitcnt lgkmcnt(2)
  v_cvt_pk_bf16_f32 v72, v72, v73
  v_mfma_f32_16x16x32_bf16 v[20:23], v[20:23], v[60:63], 0
  ds_write_b32 v78, v72 offset:520
  v_mov_b64 v[16:17], 0
  v_mfma_f32_16x16x32_bf16 v[20:23], v[24:27], v[64:67], v[20:23]
  ds_read_b128 v[44:47], v75 offset:24576
  v_mov_b64 v[18:19], 0
  v_smfmac_f32_16x16x64_bf16 v[40:43], v[0:3], a[40:47], v74
  ds_read_b128 v[48:51], v75 offset:25600
  s_waitcnt lgkmcnt(4)
  v_smfmac_f32_16x16x64_bf16 v[36:39], v[4:7], a[48:55], v74
  v_add_f32_dpp v24, v22, v20 quad_perm:[2,3,0,1] row_mask:0xf bank_mask:0xf
  v_add_f32_dpp v25, v23, v21 quad_perm:[2,3,0,1] row_mask:0xf bank_mask:0xf
  v_smfmac_f32_16x16x64_bf16 v[36:39], v[8:11], a[64:71], v74
  s_waitcnt lgkmcnt(2)
  s_barrier
  ds_read_b128 v[32:35], v78 offset:512
  v_smfmac_f32_16x16x64_bf16 v[36:39], v[12:15], a[80:87], v74
  ds_read_b128 v[60:63], v75 offset:26624
  v_mul_f32 v24, s69, v24
  v_smfmac_f32_16x16x64_bf16 v[40:43], v[4:7], a[56:63], v74
  ds_read_b128 v[64:67], v75 offset:27648
  v_mul_f32 v25, s69, v25
  v_smfmac_f32_16x16x64_bf16 v[40:43], v[8:11], a[72:79], v74
  v_exp_f32_dpp v24, v24 quad_perm:[0,1,0,1] row_mask:0xf bank_mask:0xf
  v_smfmac_f32_16x16x64_bf16 v[40:43], v[12:15], a[88:95], v74
  s_waitcnt lgkmcnt(2)
  v_exp_f32_dpp v25, v25 quad_perm:[0,1,0,1] row_mask:0xf bank_mask:0xf
  v_mfma_f32_16x16x32_bf16 v[8:11], v[32:35], v[68:71], 0
  v_add_f32 v36, v36, v38
  v_add_f32 v37, v37, v39
  v_mfma_f32_16x16x32_bf16 v[0:3], v[32:35], v[52:55], 0
  v_add_f32 v40, v40, v42
  v_add_f32 v41, v41, v43
  v_mfma_f32_16x16x32_bf16 v[4:7], v[32:35], v[56:59], 0
  v_cvt_pk_bf16_f32 v28, v24, v25
  v_cvt_pk_bf16_f32 v72, v36, v37
  v_cvt_pk_bf16_f32 v73, v40, v41
  v_mfma_f32_16x16x16_bf16 v[8:11], v[28:29], v[68:69], v[8:11]
  v_cvt_pk_bf16_f32 v31, v24, v25
  v_mov_b64 v[20:21], 0
  v_mfma_f32_16x16x16_bf16 v[0:3], v[28:29], v[72:73], v[0:3]
  ds_read_b128 v[68:71], v76 offset:13824
  v_mov_b64 v[22:23], 0
  v_mfma_f32_16x16x16_bf16 v[4:7], v[30:31], v[72:73], v[4:7]
  v_rcp_f32 v10, v8
  v_rcp_f32 v11, v9
  v_mul_f32 v0, v10, v0
  v_mul_f32 v1, v11, v1
  s_nop 0
  v_mul_f32 v4, v10, v4
  v_mul_f32 v5, v11, v5
  v_cvt_pk_bf16_f32 v2, v0, v4
  ds_write_b32 v79, v2 offset:8704
  v_cvt_pk_bf16_f32 v3, v1, v5
  ds_write_b32 v79, v3 offset:9280
  v_max3_f32 v8, v8, v9, v10
  v_max_f32 v8, v8, v11
  v_cmp_le_f32 vcc, 1317011456, v8
  v_mov_b64 v[24:25], 0
  v_mov_b64 v[26:27], 0
  s_cbranch_vccnz Cs2_mx
Cs2_mxok:
  s_waitcnt lgkmcnt(0)
  s_barrier
  ds_read_b128 v[0:3], v78 offset:8704
  ds_read_b128 v[4:7], v78 offset:8768
  ds_read_b128 v[8:11], v78 offset:8832
  ds_read_b128 v[12:15], v78 offset:8896
  s_waitcnt lgkmcnt(3)
  v_smfmac_f32_16x16x64_bf16 v[16:19], v[0:3], v[44:51], v74
  ds_read_b128 v[52:55], v75 offset:40960
  s_waitcnt lgkmcnt(3)
  v_smfmac_f32_16x16x64_bf16 v[16:19], v[4:7], v[60:67], v74
  ds_read_b128 v[56:59], v75 offset:41984
  s_waitcnt lgkmcnt(3)
  v_smfmac_f32_16x16x64_bf16 v[16:19], v[8:11], a[176:183], v74
  ds_read_b128 v[36:39], v75 offset:43008
  s_waitcnt lgkmcnt(3)
  v_smfmac_f32_16x16x64_bf16 v[16:19], v[12:15], a[184:191], v74
  ds_read_b128 v[40:43], v75 offset:44032
  ds_read_b128 v[44:47], v75 offset:57344
  v_smfmac_f32_16x16x64_bf16 v[20:23], v[0:3], a[192:199], v74
  ds_read_b128 v[48:51], v75 offset:58368
  ds_read_b128 v[60:63], v75 offset:59392
  v_smfmac_f32_16x16x64_bf16 v[20:23], v[4:7], a[200:207], v74
  ds_read_b128 v[64:67], v75 offset:60416
  s_waitcnt lgkmcnt(6)
  v_cvt_pk_bf16_f32 v16, v16, v17
  v_cvt_pk_bf16_f32 v17, v18, v19
  v_bfi_b32 v16, 1, s72, v16
  v_smfmac_f32_16x16x64_bf16 v[20:23], v[8:11], v[52:59], v74
  buffer_store_dwordx2 v[16:17], v68, s[8:11], s73 offen sc1
  s_waitcnt lgkmcnt(4)
  v_smfmac_f32_16x16x64_bf16 v[20:23], v[12:15], v[36:43], v74
  ds_read_b128 v[52:55], v75 offset:0
  v_mov_b64 v[32:33], 0
  v_smfmac_f32_16x16x64_bf16 v[24:27], v[0:3], a[208:215], v74
  ds_read_b128 v[56:59], v75 offset:1024
  v_mov_b64 v[34:35], 0
  v_smfmac_f32_16x16x64_bf16 v[24:27], v[4:7], a[216:223], v74
  ds_read_b128 v[36:39], v75 offset:2048
  s_waitcnt lgkmcnt(5)
  v_cvt_pk_bf16_f32 v20, v20, v21
  v_cvt_pk_bf16_f32 v21, v22, v23
  v_bfi_b32 v20, 1, s72, v20
  v_smfmac_f32_16x16x64_bf16 v[24:27], v[8:11], v[44:51], v74
  buffer_store_dwordx2 v[20:21], v68, s[8:11], s74 offen sc1
  s_waitcnt lgkmcnt(3)
  v_smfmac_f32_16x16x64_bf16 v[24:27], v[12:15], v[60:67], v74
  ds_read_b128 v[40:43], v75 offset:3072
  v_mov_b64 v[28:29], 0
  v_smfmac_f32_16x16x64_bf16 v[32:35], v[0:3], a[224:231], v74
  ds_read_b128 v[44:47], v75 offset:4096
  ds_read_b128 v[48:51], v75 offset:5120
  v_smfmac_f32_16x16x64_bf16 v[32:35], v[4:7], a[232:239], v74
  ds_read_b128 v[60:63], v75 offset:6144
  v_cvt_pk_bf16_f32 v24, v24, v25
  v_cvt_pk_bf16_f32 v25, v26, v27
  v_bfi_b32 v24, 1, s72, v24
  v_smfmac_f32_16x16x64_bf16 v[32:35], v[8:11], a[240:247], v74
  buffer_store_dwordx2 v[24:25], v68, s[8:11], s75 offen sc1
  v_mov_b64 v[30:31], 0
  v_smfmac_f32_16x16x64_bf16 v[32:35], v[12:15], a[248:255], v74
  ds_read_b128 v[64:67], v75 offset:7168
  s_waitcnt lgkmcnt(6)
  v_smfmac_f32_16x16x64_bf16 v[28:31], v[0:3], v[52:59], v74
  s_waitcnt lgkmcnt(4)
  v_smfmac_f32_16x16x64_bf16 v[28:31], v[4:7], v[36:43], v74
  s_waitcnt lgkmcnt(2)
  v_cvt_pk_bf16_f32 v32, v32, v33
  v_cvt_pk_bf16_f32 v33, v34, v35
  v_bfi_b32 v32, 1, s72, v32
  v_smfmac_f32_16x16x64_bf16 v[28:31], v[8:11], v[44:51], v74
  buffer_store_dwordx2 v[32:33], v68, s[8:11], s76 offen sc1
  s_waitcnt lgkmcnt(0)
  v_smfmac_f32_16x16x64_bf16 v[28:31], v[12:15], v[60:67], v74
  ds_read_b128 v[0:3], v76 offset:14848
  ds_read_b64 v[16:17], v77 offset:384
  v_mov_b64 v[18:19], v[72:73]
  v_xor_b32 v75, 0x8000, v75
  s_nop 3
  v_cvt_pk_bf16_f32 v28, v28, v29
  v_cvt_pk_bf16_f32 v29, v30, v31
  v_bfi_b32 v28, 1, s72, v28
  buffer_store_dwordx2 v[28:29], v68, s[8:11], s77 offen sc1
  v_mov_b64 v[20:21], 0
  v_mov_b64 v[22:23], 0
  v_mov_b64 v[24:25], 0
  v_mov_b64 v[26:27], 0
  v_mov_b64 v[28:29], 0
  v_mov_b64 v[30:31], 0
  v_mov_b64 v[32:33], 0
  v_mov_b64 v[34:35], 0
  s_add_u32 s58, s58, 655360
  s_add_u32 s59, s59, 655360
  s_add_u32 s70, s70, 655360
  s_add_u32 s68, s68, 655360
  s_add_u32 s66, s66, 1
  s_xor_b32 s64, s64, 16384
  s_xor_b32 s65, s65, 16384
  s_cmp_eq_u32 s66, 62
  s_cselect_b64 s[16:17], s[20:21], s[16:17]
  s_cselect_b32 s18, (Cs2_done - Cs2_last), s18
  s_cselect_b32 s70, 0, s70
  s_cmp_eq_u32 s66, 63
  s_cselect_b32 s59, 268435456, s59
  s_nop 15
  s_nop 15
  s_nop 1
  buffer_load_dwordx4 v[52:55], v76, s[8:11], s60 offen offset:0 sc1
  buffer_load_dwordx4 v[56:59], v76, s[8:11], s60 offen offset:1024 sc1
  s_nop 15
  s_nop 11
  buffer_load_dwordx4 v[36:39], v76, s[8:11], s60 offen offset:0 sc1
  buffer_load_dwordx4 v[40:43], v76, s[8:11], s60 offen offset:1024 sc1
  s_waitcnt lgkmcnt(0)
  s_waitcnt vmcnt(3)
  v_mfma_f32_16x16x32_bf16 v[4:7], v[0:3], v[52:55], 0
  v_bitop3_b32 v72, v52, v54, s72 bitop3:0x7e
  s_waitcnt vmcnt(2)
  v_mfma_f32_16x16x32_bf16 v[4:7], v[0:3], v[56:59], v[4:7]
  v_bitop3_b32 v73, v56, v58, s72 bitop3:0x7e
  v_bitop3_b32 v72, v72, v73, 1 bitop3:0xa8
  v_cmp_ne_u32 vcc, 0, v72
  s_cbranch_vccnz Cs2_h1r
  s_nop 2
  v_add_f32_dpp v4, v4, v4 row_ror:4 row_mask:0xf bank_mask:0xf
  v_add_f32_dpp v5, v5, v5 row_ror:4 row_mask:0xf bank_mask:0xf
  s_nop 0
  v_add_f32_dpp v4, v4, v4 row_ror:8 row_mask:0xf bank_mask:0xf
  v_add_f32_dpp v5, v5, v5 row_ror:8 row_mask:0xf bank_mask:0xf
  v_cvt_pk_bf16_f32 v4, v4, v5
  buffer_store_dword v4, v69, s[8:11], s62 offen sc1
  s_xor_b32 s62, s62, 16384
  buffer_store_dword v71, v69, s[8:11], s62 offen sc1
  s_xor_b32 s72, s72, 1
  s_branch Cs2_h2
Cs2_h1r:
  s_mov_b64 exec, vcc
  buffer_load_dwordx4 v[52:55], v76, s[8:11], s60 offen offset:0 sc1
  buffer_load_dwordx4 v[56:59], v76, s[8:11], s60 offen offset:1024 sc1
  s_mov_b64 exec, -1
  s_add_u32 s67, s67, 1
  s_waitcnt vmcnt(3)
  v_mfma_f32_16x16x32_bf16 v[4:7], v[0:3], v[36:39], 0
  v_bitop3_b32 v72, v36, v38, s72 bitop3:0x7e
  s_waitcnt vmcnt(2)
  v_mfma_f32_16x16x32_bf16 v[4:7], v[0:3], v[40:43], v[4:7]
  v_bitop3_b32 v73, v40, v42, s72 bitop3:0x7e
  v_bitop3_b32 v72, v72, v73, 1 bitop3:0xa8
  v_cmp_ne_u32 vcc, 0, v72
  s_cbranch_vccz Cs2_h1p
  s_mov_b64 exec, vcc
  buffer_load_dwordx4 v[36:39], v76, s[8:11], s60 offen offset:0 sc1
  buffer_load_dwordx4 v[40:43], v76, s[8:11], s60 offen offset:1024 sc1
  s_mov_b64 exec, -1
  s_add_u32 s67, s67, 1
  s_waitcnt vmcnt(3)
  v_mfma_f32_16x16x32_bf16 v[4:7], v[0:3], v[52:55], 0
  v_bitop3_b32 v72, v52, v54, s72 bitop3:0x7e
  s_waitcnt vmcnt(2)
  v_mfma_f32_16x16x32_bf16 v[4:7], v[0:3], v[56:59], v[4:7]
  v_bitop3_b32 v73, v56, v58, s72 bitop3:0x7e
  v_bitop3_b32 v72, v72, v73, 1 bitop3:0xa8
  v_cmp_ne_u32 vcc, 0, v72
  s_cbranch_vccz Cs2_h1p
Cs2_h1s:
  s_mov_b64 exec, vcc
  buffer_load_dwordx4 v[52:55], v76, s[8:11], s60 offen offset:0 sc1
  buffer_load_dwordx4 v[56:59], v76, s[8:11], s60 offen offset:1024 sc1
  s_mov_b64 exec, -1
  s_add_u32 s67, s67, 1
  s_waitcnt vmcnt(3)
  v_mfma_f32_16x16x32_bf16 v[4:7], v[0:3], v[36:39], 0
  v_bitop3_b32 v72, v36, v38, s72 bitop3:0x7e
  s_waitcnt vmcnt(2)
  v_mfma_f32_16x16x32_bf16 v[4:7], v[0:3], v[40:43], v[4:7]
  v_bitop3_b32 v73, v40, v42, s72 bitop3:0x7e
  v_bitop3_b32 v72, v72, v73, 1 bitop3:0xa8
  v_cmp_ne_u32 vcc, 0, v72
  s_cbranch_vccz Cs2_h1p
  s_mov_b64 exec, vcc
  buffer_load_dwordx4 v[36:39], v76, s[8:11], s60 offen offset:0 sc1
  buffer_load_dwordx4 v[40:43], v76, s[8:11], s60 offen offset:1024 sc1
  s_mov_b64 exec, -1
  s_add_u32 s67, s67, 1
  s_waitcnt vmcnt(3)
  v_mfma_f32_16x16x32_bf16 v[4:7], v[0:3], v[52:55], 0
  v_bitop3_b32 v72, v52, v54, s72 bitop3:0x7e
  s_waitcnt vmcnt(2)
  v_mfma_f32_16x16x32_bf16 v[4:7], v[0:3], v[56:59], v[4:7]
  v_bitop3_b32 v73, v56, v58, s72 bitop3:0x7e
  v_bitop3_b32 v72, v72, v73, 1 bitop3:0xa8
  v_cmp_ne_u32 vcc, 0, v72
  s_cbranch_vccz Cs2_h1p
  s_cmp_lt_u32 s67, 131072
  s_cbranch_scc1 Cs2_h1s
Cs2_h1p:
  s_nop 2
  v_add_f32_dpp v4, v4, v4 row_ror:4 row_mask:0xf bank_mask:0xf
  v_add_f32_dpp v5, v5, v5 row_ror:4 row_mask:0xf bank_mask:0xf
  s_nop 0
  v_add_f32_dpp v4, v4, v4 row_ror:8 row_mask:0xf bank_mask:0xf
  v_add_f32_dpp v5, v5, v5 row_ror:8 row_mask:0xf bank_mask:0xf
  v_cvt_pk_bf16_f32 v4, v4, v5
  buffer_store_dword v4, v69, s[8:11], s62 offen sc1
  s_xor_b32 s62, s62, 16384
  buffer_store_dword v71, v69, s[8:11], s62 offen sc1
  s_xor_b32 s72, s72, 1
  s_branch Cs2_h2
Cs2_h2r:
  s_mov_b64 exec, vcc
  buffer_load_dwordx4 v[12:15], v76, s[8:11], s65 offen offset:3072 sc1
  s_mov_b64 exec, -1
  s_add_u32 s67, s67, 1
  s_waitcnt vmcnt(4)
  v_max3_u32 v72, v12, v13, v14
  v_max_u32 v72, v72, v15
  ds_write_b128 v76, v[12:15] offset:7680
  v_cmp_eq_u32 vcc, -1, v72
  s_cbranch_vccz Cs2_h2w
  s_mov_b64 exec, vcc
  buffer_load_dwordx4 v[12:15], v76, s[8:11], s65 offen offset:3072 sc1
  s_mov_b64 exec, -1
  s_add_u32 s67, s67, 1
  s_waitcnt vmcnt(4)
  v_max3_u32 v72, v12, v13, v14
  v_max_u32 v72, v72, v15
  ds_write_b128 v76, v[12:15] offset:7680
  v_cmp_eq_u32 vcc, -1, v72
  s_cbranch_vccz Cs2_h2w
Cs2_h2s:
  s_mov_b64 exec, vcc
  buffer_load_dwordx4 v[12:15], v76, s[8:11], s65 offen offset:3072 sc1
  s_mov_b64 exec, -1
  s_add_u32 s67, s67, 1
  s_waitcnt vmcnt(2)
  v_max3_u32 v72, v12, v13, v14
  v_max_u32 v72, v72, v15
  ds_write_b128 v76, v[12:15] offset:7680
  v_cmp_eq_u32 vcc, -1, v72
  s_cbranch_vccz Cs2_h2w
  s_mov_b64 exec, vcc
  buffer_load_dwordx4 v[12:15], v76, s[8:11], s65 offen offset:3072 sc1
  s_mov_b64 exec, -1
  s_add_u32 s67, s67, 1
  s_waitcnt vmcnt(2)
  v_max3_u32 v72, v12, v13, v14
  v_max_u32 v72, v72, v15
  ds_write_b128 v76, v[12:15] offset:7680
  v_cmp_eq_u32 vcc, -1, v72
  s_cbranch_vccz Cs2_h2w
  s_mov_b64 exec, vcc
  buffer_load_dwordx4 v[12:15], v76, s[8:11], s65 offen offset:3072 sc1
  s_mov_b64 exec, -1
  s_add_u32 s67, s67, 1
  s_waitcnt vmcnt(2)
  v_max3_u32 v72, v12, v13, v14
  v_max_u32 v72, v72, v15
  ds_write_b128 v76, v[12:15] offset:7680
  v_cmp_eq_u32 vcc, -1, v72
  s_cbranch_vccz Cs2_h2w
  s_cmp_lt_u32 s67, 131072
  s_cbranch_scc1 Cs2_h2s
Cs2_h2ok:
  ds_write_b128 v76, v[12:15] offset:7680
  s_branch Cs2_h2w
Cs2_rec:
  s_nop 7
  s_waitcnt vmcnt(0) lgkmcnt(0)
  v_max3_u32 v72, v0, v1, v2
  v_max3_u32 v72, v72, v3, v4
  v_max3_u32 v72, v72, v5, v6
  v_max3_u32 v72, v72, v7, v8
  v_max3_u32 v72, v72, v9, v10
  v_max3_u32 v72, v72, v11, v12
  v_max3_u32 v72, v72, v13, v14
  v_max3_u32 v72, v72, v15, v16
  v_max3_u32 v72, v72, v17, v18
  v_max_u32 v72, v72, v19
  v_cmp_eq_u32 vcc, -1, v72
  s_cbranch_vccz Cs2_recok
  s_barrier
Cs2_recp:
  buffer_load_dwordx4 v[0:3], v76, s[8:11], s64 offen offset:0 sc1
  buffer_load_dwordx4 v[4:7], v76, s[8:11], s64 offen offset:1024 sc1
  s_add_u32 s67, s67, 1
  s_cmp_lt_u32 s67, 131072
  s_cselect_b32 s54, -2, -1
  s_waitcnt vmcnt(1)
  v_max3_u32 v72, v0, v1, v2
  s_waitcnt vmcnt(0)
  v_max3_u32 v72, v72, v3, v4
  v_max3_u32 v72, v72, v5, v6
  v_max_u32 v72, v72, v7
  v_cmp_lt_u32 vcc, s54, v72
  s_cbranch_vccnz Cs2_recp
  ds_write_b128 v76, v[0:3] offset:8704
  ds_write_b128 v76, v[4:7] offset:9728
  v_mov_b64 v[20:21], 0
  v_mov_b64 v[22:23], 0
  v_mov_b64 v[24:25], 0
  v_mov_b64 v[26:27], 0
  v_mov_b64 v[28:29], 0
  v_mov_b64 v[30:31], 0
  v_mov_b64 v[32:33], 0
  v_mov_b64 v[34:35], 0
  s_waitcnt lgkmcnt(0)
  s_barrier
  ds_read_b128 v[0:3], v76 offset:4608
  ds_read_b128 v[60:63], v76 offset:24576
  ds_read_b128 v[64:67], v76 offset:25600
  s_waitcnt lgkmcnt(0)
  v_smfmac_f32_16x16x64_bf16 v[20:23], v[0:3], v[60:67], v74
  ds_read_b128 v[60:63], v76 offset:26624
  ds_read_b128 v[64:67], v76 offset:27648
  s_waitcnt lgkmcnt(0)
  v_smfmac_f32_16x16x64_bf16 v[24:27], v[0:3], v[60:67], v74
  ds_read_b128 v[60:63], v76 offset:40960
  ds_read_b128 v[64:67], v76 offset:41984
  s_waitcnt lgkmcnt(0)
  v_smfmac_f32_16x16x64_bf16 v[28:31], v[0:3], v[60:67], v74
  ds_read_b128 v[60:63], v76 offset:43008
  ds_read_b128 v[64:67], v76 offset:44032
  s_waitcnt lgkmcnt(0)
  v_smfmac_f32_16x16x64_bf16 v[32:35], v[0:3], v[60:67], v74
  ds_read_b128 v[4:7], v76 offset:5632
  s_waitcnt lgkmcnt(0)
  v_smfmac_f32_16x16x64_bf16 v[20:23], v[4:7], v[80:87], v74
  v_smfmac_f32_16x16x64_bf16 v[24:27], v[4:7], v[88:95], v74
  v_smfmac_f32_16x16x64_bf16 v[28:31], v[4:7], v[208:215], v74
  v_smfmac_f32_16x16x64_bf16 v[32:35], v[4:7], v[216:223], v74
  ds_read_b128 v[8:11], v76 offset:6656
  s_waitcnt lgkmcnt(0)
  v_smfmac_f32_16x16x64_bf16 v[20:23], v[8:11], v[96:103], v74
  v_smfmac_f32_16x16x64_bf16 v[24:27], v[8:11], v[104:111], v74
  ds_read_b128 v[60:63], v76 offset:57344
  ds_read_b128 v[64:67], v76 offset:58368
  s_waitcnt lgkmcnt(0)
  v_smfmac_f32_16x16x64_bf16 v[28:31], v[8:11], v[60:67], v74
  ds_read_b128 v[60:63], v76 offset:59392
  ds_read_b128 v[64:67], v76 offset:60416
  s_waitcnt lgkmcnt(0)
  v_smfmac_f32_16x16x64_bf16 v[32:35], v[8:11], v[60:67], v74
  ds_read_b128 v[12:15], v76 offset:7680
  s_waitcnt lgkmcnt(0)
  v_smfmac_f32_16x16x64_bf16 v[20:23], v[12:15], v[112:119], v74
  v_smfmac_f32_16x16x64_bf16 v[24:27], v[12:15], v[120:127], v74
  v_smfmac_f32_16x16x64_bf16 v[28:31], v[12:15], v[224:231], v74
  v_smfmac_f32_16x16x64_bf16 v[32:35], v[12:15], v[232:239], v74
  ds_read_b128 v[0:3], v76 offset:8704
  s_waitcnt lgkmcnt(0)
  v_smfmac_f32_16x16x64_bf16 v[20:23], v[0:3], v[128:135], v74
  v_smfmac_f32_16x16x64_bf16 v[24:27], v[0:3], v[136:143], v74
  ds_read_b128 v[60:63], v75 offset:8192
  ds_read_b128 v[64:67], v75 offset:9216
  s_waitcnt lgkmcnt(0)
  v_smfmac_f32_16x16x64_bf16 v[28:31], v[0:3], v[60:67], v74
  ds_read_b128 v[60:63], v75 offset:10240
  ds_read_b128 v[64:67], v75 offset:11264
  s_waitcnt lgkmcnt(0)
  v_smfmac_f32_16x16x64_bf16 v[32:35], v[0:3], v[60:67], v74
  ds_read_b128 v[4:7], v76 offset:9728
  s_waitcnt lgkmcnt(0)
  v_smfmac_f32_16x16x64_bf16 v[20:23], v[4:7], v[144:151], v74
  v_smfmac_f32_16x16x64_bf16 v[24:27], v[4:7], v[152:159], v74
  ds_read_b128 v[60:63], v75 offset:24576
  ds_read_b128 v[64:67], v75 offset:25600
  s_waitcnt lgkmcnt(0)
  v_smfmac_f32_16x16x64_bf16 v[28:31], v[4:7], v[60:67], v74
  ds_read_b128 v[60:63], v75 offset:26624
  ds_read_b128 v[64:67], v75 offset:27648
  s_waitcnt lgkmcnt(0)
  v_smfmac_f32_16x16x64_bf16 v[32:35], v[4:7], v[60:67], v74
  ds_read_b128 v[16:19], v76 offset:10752
  s_waitcnt lgkmcnt(0)
  v_smfmac_f32_16x16x64_bf16 v[20:23], v[16:19], v[160:167], v74
  v_smfmac_f32_16x16x64_bf16 v[24:27], v[16:19], v[168:175], v74
  v_smfmac_f32_16x16x64_bf16 v[28:31], v[16:19], v[240:247], v74
  v_smfmac_f32_16x16x64_bf16 v[32:35], v[16:19], v[248:255], v74
  ds_read_b128 v[12:15], v76 offset:11776
  s_waitcnt lgkmcnt(0)
  v_smfmac_f32_16x16x64_bf16 v[20:23], v[12:15], v[176:183], v74
  v_smfmac_f32_16x16x64_bf16 v[24:27], v[12:15], v[184:191], v74
  v_smfmac_f32_16x16x64_bf16 v[28:31], v[12:15], a[0:7], v74
  v_smfmac_f32_16x16x64_bf16 v[32:35], v[12:15], a[8:15], v74
  ds_read_b128 v[8:11], v76 offset:12800
  s_waitcnt lgkmcnt(0)
  v_smfmac_f32_16x16x64_bf16 v[20:23], v[8:11], v[192:199], v74
  v_smfmac_f32_16x16x64_bf16 v[24:27], v[8:11], v[200:207], v74
  v_smfmac_f32_16x16x64_bf16 v[28:31], v[8:11], a[16:23], v74
  v_smfmac_f32_16x16x64_bf16 v[32:35], v[8:11], a[24:31], v74
  v_add_f32 v20, v20, v22
  v_add_f32 v21, v21, v23
  v_add_f32 v24, v24, v26
  v_cvt_pk_bf16_f32 v22, v20, v24
  s_nop 0
  ds_write_b32 v79, v22 offset:0
  v_add_f32 v25, v25, v27
  v_cvt_pk_bf16_f32 v23, v21, v25
  ds_write_b32 v79, v23 offset:576
  v_add_f32 v28, v28, v30
  v_add_f32 v29, v29, v31
  s_waitcnt lgkmcnt(0)
  s_nop 1
  s_branch Cs2_recok
Cs2_mx:
  s_waitcnt lgkmcnt(0)
  s_barrier
  buffer_load_dwordx4 v[0:3], v76, s[8:11], s58 offen offset:0 sc1
  ds_read_b128 v[20:23], v77 offset:0
  ds_read_b128 v[28:31], v77 offset:256
  buffer_load_dwordx4 v[4:7], v76, s[8:11], s58 offen offset:1024 sc1
  ds_read_b128 v[24:27], v77 offset:128
  ds_read_b128 v[32:35], v77 offset:384
  s_waitcnt vmcnt(1) lgkmcnt(3)
  v_mfma_f32_16x16x32_bf16 v[8:11], v[0:3], v[20:23], 0
  s_waitcnt vmcnt(0) lgkmcnt(1)
  v_mfma_f32_16x16x32_bf16 v[8:11], v[4:7], v[24:27], v[8:11]
  v_mfma_f32_16x16x32_bf16 v[12:15], v[28:31], v[20:23], 0
  s_waitcnt lgkmcnt(0)
  v_mfma_f32_16x16x32_bf16 v[12:15], v[32:35], v[24:27], v[12:15]
  v_add_f32_dpp v8, v10, v8 quad_perm:[2,3,0,1] row_mask:0xf bank_mask:0xf
  v_add_f32_dpp v9, v11, v9 quad_perm:[2,3,0,1] row_mask:0xf bank_mask:0xf
  s_nop 0
  v_mov_b32_dpp v8, v8 quad_perm:[0,1,0,1] row_mask:0xf bank_mask:0xf
  v_mov_b32_dpp v9, v9 quad_perm:[0,1,0,1] row_mask:0xf bank_mask:0xf
  s_nop 1
  v_add_f32_dpp v12, v14, v12 quad_perm:[2,3,0,1] row_mask:0xf bank_mask:0xf
  v_add_f32_dpp v13, v15, v13 quad_perm:[2,3,0,1] row_mask:0xf bank_mask:0xf
  s_nop 0
  v_mov_b32_dpp v12, v12 quad_perm:[0,1,0,1] row_mask:0xf bank_mask:0xf
  v_mov_b32_dpp v13, v13 quad_perm:[0,1,0,1] row_mask:0xf bank_mask:0xf
  v_mul_f32 v12, s69, v12
  ds_write_b32 v78, v8 offset:8712
  v_mul_f32 v13, s69, v13
  ds_write_b32 v78, v9 offset:8776
  s_waitcnt lgkmcnt(0)
  s_barrier
  ds_read_b128 v[36:39], v78 offset:8704
  ds_read_b128 v[40:43], v78 offset:8768
  s_waitcnt lgkmcnt(0)
  s_barrier
  v_max_f32 v16, v36, v37
  v_max3_f32 v16, v16, v38, v39
  v_max3_f32 v16, v16, v40, v41
  v_max3_f32 v16, v16, v42, v43
  v_max3_f32 v16, v16, v12, v13
  v_mov_b32 v17, v16
  s_nop 1
  v_permlane16_swap_b32 v16, v17
  v_max_f32 v16, v16, v17
  v_mov_b32 v17, v16
  s_nop 1
  v_permlane32_swap_b32 v16, v17
  v_max_f32 v16, v16, v17
  v_sub_f32 v36, v36, v16
  v_sub_f32 v37, v37, v16
  v_sub_f32 v38, v38, v16
  v_sub_f32 v39, v39, v16
  v_sub_f32 v40, v40, v16
  v_sub_f32 v41, v41, v16
  v_sub_f32 v42, v42, v16
  v_sub_f32 v43, v43, v16
  v_sub_f32 v12, v12, v16
  v_sub_f32 v13, v13, v16
  v_exp_f32 v36, v36
  v_exp_f32 v37, v37
  v_exp_f32 v38, v38
  v_exp_f32 v39, v39
  v_exp_f32 v40, v40
  v_exp_f32 v41, v41
  v_exp_f32 v42, v42
  v_exp_f32 v43, v43
  v_exp_f32 v12, v12
  v_exp_f32 v13, v13
  v_cvt_pk_bf16_f32 v32, v36, v40
  v_cvt_pk_bf16_f32 v33, v37, v41
  v_cvt_pk_bf16_f32 v34, v38, v42
  v_cvt_pk_bf16_f32 v35, v39, v43
  v_cvt_pk_bf16_f32 v28, v12, v13
  v_cvt_pk_bf16_f32 v31, v12, v13
  v_mov_b32 v29, 0
  v_mov_b32 v30, 0
  v_mov_b32 v68, 0x3f803f80
  v_mov_b32 v69, 0x3f803f80
  v_mov_b32 v70, 0x3f803f80
  v_mov_b32 v71, 0x3f803f80
  s_nop 1
  v_mfma_f32_16x16x32_bf16 v[8:11], v[32:35], v[68:71], 0
  v_mfma_f32_16x16x32_bf16 v[0:3], v[32:35], v[52:55], 0
  v_mfma_f32_16x16x32_bf16 v[4:7], v[32:35], v[56:59], 0
  v_mfma_f32_16x16x16_bf16 v[8:11], v[28:29], v[68:69], v[8:11]
  v_mfma_f32_16x16x16_bf16 v[0:3], v[28:29], v[72:73], v[0:3]
  v_mfma_f32_16x16x16_bf16 v[4:7], v[30:31], v[72:73], v[4:7]
  ds_read_b128 v[68:71], v76 offset:13824
  v_rcp_f32 v10, v8
  v_rcp_f32 v11, v9
  v_mul_f32 v0, v10, v0
  v_mul_f32 v1, v11, v1
  s_nop 0
  v_mul_f32 v4, v10, v4
  v_mul_f32 v5, v11, v5
  v_cvt_pk_bf16_f32 v2, v0, v4
  ds_write_b32 v79, v2 offset:8704
  v_cvt_pk_bf16_f32 v3, v1, v5
  ds_write_b32 v79, v3 offset:9280
  v_mov_b64 v[16:17], 0
  v_mov_b64 v[18:19], 0
  v_mov_b64 v[20:21], 0
  v_mov_b64 v[22:23], 0
  v_mov_b64 v[24:25], 0
  v_mov_b64 v[26:27], 0
  s_branch Cs2_mxok
Cs2_last:
  ds_read_b128 v[8:11], v76 offset:6656
  ds_read_b128 v[60:63], v76 offset:43008
  ds_read_b128 v[64:67], v76 offset:44032
  ds_read_b128 v[44:47], v76 offset:57344
  ds_read_b128 v[48:51], v76 offset:58368
  s_waitcnt lgkmcnt(6)
  v_smfmac_f32_16x16x64_bf16 v[28:31], v[0:3], v[36:43], v74
  v_smfmac_f32_16x16x64_bf16 v[20:23], v[0:3], a[32:39], v74
  ds_read_b128 v[36:39], v76 offset:59392
  ds_read_b128 v[40:43], v76 offset:60416
  v_smfmac_f32_16x16x64_bf16 v[24:27], v[0:3], a[40:47], v74
  s_waitcnt lgkmcnt(7)
  v_smfmac_f32_16x16x64_bf16 v[20:23], v[4:7], a[48:55], v74
  buffer_store_dwordx4 v[16:19], v76, s[8:11], s68 offen sc1
  v_smfmac_f32_16x16x64_bf16 v[24:27], v[4:7], a[56:63], v74
  s_waitcnt lgkmcnt(4)
  v_smfmac_f32_16x16x64_bf16 v[28:31], v[4:7], v[208:215], v74
  v_smfmac_f32_16x16x64_bf16 v[32:35], v[4:7], v[216:223], v74
  s_waitcnt lgkmcnt(2)
  v_smfmac_f32_16x16x64_bf16 v[32:35], v[0:3], v[60:67], v74
  v_smfmac_f32_16x16x64_bf16 v[20:23], v[8:11], a[64:71], v74
  ds_read_b128 v[60:63], v75 offset:8192
  ds_read_b128 v[64:67], v75 offset:9216
  v_smfmac_f32_16x16x64_bf16 v[24:27], v[8:11], a[72:79], v74
  v_smfmac_f32_16x16x64_bf16 v[28:31], v[8:11], v[44:51], v74
  v_smfmac_f32_16x16x64_bf16 v[20:23], v[12:15], a[80:87], v74
  ds_read_b128 v[44:47], v75 offset:10240
  ds_read_b128 v[48:51], v75 offset:11264
  v_smfmac_f32_16x16x64_bf16 v[24:27], v[12:15], a[88:95], v74
  s_waitcnt lgkmcnt(4)
  v_smfmac_f32_16x16x64_bf16 v[28:31], v[12:15], v[224:231], v74
  v_smfmac_f32_16x16x64_bf16 v[32:35], v[12:15], v[232:239], v74
  v_smfmac_f32_16x16x64_bf16 v[32:35], v[8:11], v[36:43], v74
  ds_read_b128 v[36:39], v75 offset:24576
  ds_read_b128 v[40:43], v75 offset:25600
  s_waitcnt vmcnt(1)
  s_barrier
Cs2_lastr:
  ds_read_b128 v[0:3], v76 offset:8704
  ds_read_b128 v[4:7], v76 offset:9728
  ds_read_b128 v[16:19], v76 offset:10752
  ds_read_b128 v[12:15], v76 offset:11776
  ds_read_b128 v[8:11], v76 offset:12800
  s_waitcnt lgkmcnt(4)
  v_max3_u32 v72, v0, v1, v2
  s_waitcnt lgkmcnt(3)
  v_max3_u32 v72, v72, v3, v4
  v_max3_u32 v72, v72, v5, v6
  s_waitcnt lgkmcnt(0)
  v_max3_u32 v72, v72, v7, v8
  v_max3_u32 v72, v72, v9, v10
  v_max3_u32 v72, v72, v11, v12
  v_max3_u32 v72, v72, v13, v14
  v_max3_u32 v72, v72, v15, v16
  v_max3_u32 v72, v72, v17, v18
  v_max_u32 v72, v72, v19
  v_cmp_eq_u32 vcc, -1, v72
  s_cbranch_vccnz Cs2_lastp
Cs2_lastg:
  v_smfmac_f32_16x16x64_bf16 v[28:31], v[0:3], v[60:67], v74
  ds_read_b128 v[60:63], v75 offset:26624
  ds_read_b128 v[64:67], v75 offset:27648
  v_smfmac_f32_16x16x64_bf16 v[32:35], v[0:3], v[44:51], v74
  v_smfmac_f32_16x16x64_bf16 v[28:31], v[4:7], v[36:43], v74
  v_smfmac_f32_16x16x64_bf16 v[28:31], v[16:19], v[240:247], v74
  v_smfmac_f32_16x16x64_bf16 v[28:31], v[12:15], a[0:7], v74
  v_smfmac_f32_16x16x64_bf16 v[28:31], v[8:11], a[16:23], v74
  v_smfmac_f32_16x16x64_bf16 v[32:35], v[16:19], v[248:255], v74
  v_smfmac_f32_16x16x64_bf16 v[32:35], v[12:15], a[8:15], v74
  s_waitcnt lgkmcnt(0)
  v_smfmac_f32_16x16x64_bf16 v[32:35], v[8:11], a[24:31], v74
  v_smfmac_f32_16x16x64_bf16 v[32:35], v[4:7], v[60:67], v74
  v_smfmac_f32_16x16x64_bf16 v[20:23], v[0:3], a[96:103], v74
  v_smfmac_f32_16x16x64_bf16 v[20:23], v[4:7], a[112:119], v74
  v_add_f32 v28, v28, v30
  v_add_f32 v32, v32, v34
  v_cvt_pk_bf16_f32 v30, v28, v32
  v_smfmac_f32_16x16x64_bf16 v[20:23], v[16:19], a[128:135], v74
  ds_write_b32 v79, v30 offset:256
  v_add_f32 v29, v29, v31
  v_add_f32 v33, v33, v35
  v_cvt_pk_bf16_f32 v31, v29, v33
  v_smfmac_f32_16x16x64_bf16 v[20:23], v[12:15], a[144:151], v74
  ds_write_b32 v79, v31 offset:832
  v_smfmac_f32_16x16x64_bf16 v[20:23], v[8:11], a[160:167], v74
  v_smfmac_f32_16x16x64_bf16 v[24:27], v[0:3], a[104:111], v74
  v_smfmac_f32_16x16x64_bf16 v[24:27], v[4:7], a[120:127], v74
  v_smfmac_f32_16x16x64_bf16 v[24:27], v[16:19], a[136:143], v74
  s_waitcnt lgkmcnt(0)
  s_barrier
  ds_read_b64 v[52:53], v77 offset:384
  v_add_f32 v20, v20, v22
  v_smfmac_f32_16x16x64_bf16 v[24:27], v[12:15], a[152:159], v74
  v_add_f32 v21, v21, v23
  v_smfmac_f32_16x16x64_bf16 v[24:27], v[8:11], a[168:175], v74
  v_cvt_pk_bf16_f32 v54, v20, v21
  s_add_u32 s68, s68, 655360
  s_nop 3
  v_add_f32 v24, v24, v26
  v_add_f32 v25, v25, v27
  v_cvt_pk_bf16_f32 v55, v24, v25
  s_waitcnt lgkmcnt(0)
  buffer_store_dwordx4 v[52:55], v76, s[8:11], s68 offen sc1
  s_branch Cs2_done
Cs2_lastp:
  s_add_u32 s72, s72, 2
  s_cmp_ge_u32 s72, 131072
  s_cbranch_scc1 Cs2_lastg
  s_barrier
  s_waitcnt vmcnt(0)
  s_barrier
  s_branch Cs2_lastr
Cs2_done:
  s_branch L_cexit
L_w7:
  v_mov_b64 v[20:21], 0
  v_mov_b64 v[22:23], 0
  v_mov_b64 v[24:25], 0
  v_mov_b64 v[26:27], 0
  v_mov_b64 v[28:29], 0
  v_mov_b64 v[30:31], 0
  v_mov_b64 v[32:33], 0
  v_mov_b64 v[34:35], 0
  s_mov_b32 s78, 0x3f803f80
  s_mov_b32 s79, s78
  s_mov_b32 s65, 360448
  s_mov_b32 m0, 16128
  s_lshl_b32 s71, s53, 2
  s_add_u32 s71, s71, 128
  s_movk_i32 s56, 0x1000
  v_lshlrev_b32 v73, 2, v76
  v_mov_b32 v72, 0
  s_mov_b64 s[16:17], s[8:9]
  s_mov_b32 s18, 268435456
  s_mov_b32 s19, 0x20000
  s_getpc_b64 s[20:21]
Cs3_pc:
  s_add_u32 s20, s20, (Cs3_last - Cs3_pc)
  s_addc_u32 s21, s21, 0
  buffer_load_dwordx4 v[52:55], v76, s[8:11], s59 offen offset:0 sc1
  buffer_load_dwordx4 v[56:59], v76, s[8:11], s59 offen offset:1024 sc1
  ds_read_b128 v[60:63], v76 offset:28672
  ds_read_b128 v[64:67], v76 offset:29696
  ds_read_b128 v[44:47], v76 offset:30720
  ds_read_b128 v[48:51], v76 offset:31744
  ds_read_b128 v[36:39], v76 offset:45056
  ds_read_b128 v[40:43], v76 offset:46080
  ds_read_b128 v[0:3], v76 offset:4608
  ds_read_b128 v[4:7], v76 offset:5632
  s_waitcnt lgkmcnt(0)
  s_branch Cs3_top2
.p2align 6
Cs3_h2:
  v_lshlrev_b32 v73, 2, v76
  s_mov_b32 m0, 12800
  s_add_u32 s55, s65, 8192
  s_waitcnt vmcnt(4)
  ds_read_b128 v[60:63], v76 offset:28672
  ds_read_b128 v[64:67], v76 offset:29696
  ds_read_b128 v[44:47], v76 offset:30720
  ds_read_b128 v[48:51], v76 offset:31744
  ds_read_b128 v[36:39], v76 offset:45056
  ds_read_b128 v[40:43], v76 offset:46080
  buffer_load_dwordx4 v[52:55], v76, s[8:11], s59 offen offset:0 sc1
  buffer_load_dwordx4 v[56:59], v76, s[8:11], s59 offen offset:1024 sc1
  s_cmp_eq_u32 s66, 12
  s_cselect_b32 s56, s71, 0x1000
  ds_read_b32 v72, v76 offset:16128
  s_cmp_eq_u32 s66, 13
  s_cselect_b32 s54, 0x700, 0
  s_waitcnt lgkmcnt(0)
  v_readfirstlane_b32 s57, v72
  s_nop 0
  s_cmp_lt_u32 s57, s54
  s_cbranch_scc1 Cs3_kv3
Cs3_h2w:
  s_cmp_eq_u32 s66, 63
  s_waitcnt lgkmcnt(0)
  s_barrier
  ds_read_b128 v[0:3], v76 offset:4608
  ds_read_b128 v[4:7], v76 offset:5632
  buffer_load_dwordx4 v76, s[8:11], s55 offen offset:0 sc1 lds
  s_cbranch_scc1 Cs3_last
Cs3_top2:
  ds_read_b128 v[8:11], v76 offset:6656
  s_mov_b32 m0, 16128
  s_waitcnt lgkmcnt(2)
  v_smfmac_f32_16x16x64_bf16 v[20:23], v[0:3], v[60:67], v74
  ds_read_b128 v[60:63], v76 offset:47104
  v_smfmac_f32_16x16x64_bf16 v[24:27], v[0:3], v[44:51], v74
  buffer_load_dwordx4 v[44:47], v76, s[8:11], s58 offen offset:0 sc1
  ds_read_b128 v[64:67], v76 offset:48128
  s_waitcnt lgkmcnt(3)
  v_smfmac_f32_16x16x64_bf16 v[20:23], v[4:7], v[80:87], v74
  buffer_load_dwordx4 v[48:51], v76, s[8:11], s58 offen offset:1024 sc1
  v_smfmac_f32_16x16x64_bf16 v[28:31], v[0:3], v[36:43], v74
  ds_read_b128 v[36:39], v76 offset:61440
  v_smfmac_f32_16x16x64_bf16 v[24:27], v[4:7], v[88:95], v74
  ds_read_b128 v[40:43], v76 offset:62464
  s_waitcnt lgkmcnt(4)
  v_smfmac_f32_16x16x64_bf16 v[28:31], v[4:7], v[208:215], v74
  ds_read_b128 v[12:15], v76 offset:7680
  v_smfmac_f32_16x16x64_bf16 v[32:35], v[4:7], v[216:223], v74
  buffer_store_dwordx4 v[16:19], v76, s[8:11], s68 offen sc1
  s_waitcnt lgkmcnt(3)
  v_smfmac_f32_16x16x64_bf16 v[32:35], v[0:3], v[60:67], v74
  buffer_load_dword v73, s[16:19], s70 offen  lds
  v_smfmac_f32_16x16x64_bf16 v[20:23], v[8:11], v[96:103], v74
  ds_read_b128 v[60:63], v76 offset:63488
  v_smfmac_f32_16x16x64_bf16 v[24:27], v[8:11], v[104:111], v74
  ds_read_b128 v[64:67], v76 offset:64512
  s_waitcnt lgkmcnt(3)
  v_smfmac_f32_16x16x64_bf16 v[28:31], v[8:11], v[36:43], v74
  ds_read_b128 v[36:39], v75 offset:12288
  s_waitcnt lgkmcnt(3)
  v_smfmac_f32_16x16x64_bf16 v[20:23], v[12:15], v[112:119], v74
  buffer_load_dword off, s[12:15], s56 sc1 lds
  ds_read_b128 v[40:43], v75 offset:13312
  v_smfmac_f32_16x16x64_bf16 v[24:27], v[12:15], v[120:127], v74
  s_waitcnt vmcnt(5)
  v_smfmac_f32_16x16x64_bf16 v[28:31], v[12:15], v[224:231], v74
  s_barrier
  ds_read_b128 v[0:3], v76 offset:8704
  v_smfmac_f32_16x16x64_bf16 v[32:35], v[12:15], v[232:239], v74
  ds_read_b128 v[4:7], v76 offset:9728
  s_waitcnt lgkmcnt(4)
  v_smfmac_f32_16x16x64_bf16 v[32:35], v[8:11], v[60:67], v74
  ds_read_b128 v[60:63], v75 offset:14336
  s_waitcnt lgkmcnt(2)
  v_smfmac_f32_16x16x64_bf16 v[20:23], v[0:3], v[128:135], v74
  ds_read_b128 v[16:19], v76 offset:10752
  v_smfmac_f32_16x16x64_bf16 v[24:27], v[0:3], v[136:143], v74
  ds_read_b128 v[64:67], v75 offset:15360
  v_smfmac_f32_16x16x64_bf16 v[28:31], v[0:3], v[36:43], v74
  ds_read_b128 v[36:39], v75 offset:28672
  s_waitcnt lgkmcnt(4)
  v_smfmac_f32_16x16x64_bf16 v[20:23], v[4:7], v[144:151], v74
  ds_read_b128 v[12:15], v76 offset:11776
  v_smfmac_f32_16x16x64_bf16 v[24:27], v[4:7], v[152:159], v74
  ds_read_b128 v[40:43], v75 offset:29696
  s_waitcnt lgkmcnt(4)
  v_smfmac_f32_16x16x64_bf16 v[20:23], v[16:19], v[160:167], v74
  ds_read_b128 v[8:11], v76 offset:12800
  s_waitcnt lgkmcnt(4)
  v_smfmac_f32_16x16x64_bf16 v[32:35], v[0:3], v[60:67], v74
  ds_read_b128 v[60:63], v75 offset:30720
  v_mov_b64 v[68:69], s[78:79]
  v_smfmac_f32_16x16x64_bf16 v[24:27], v[16:19], v[168:175], v74
  ds_read_b128 v[64:67], v75 offset:31744
  s_waitcnt lgkmcnt(4)
  v_smfmac_f32_16x16x64_bf16 v[20:23], v[12:15], v[176:183], v74
  s_waitcnt lgkmcnt(3)
  v_mov_b64 v[70:71], s[78:79]
  v_smfmac_f32_16x16x64_bf16 v[28:31], v[4:7], v[36:43], v74
  s_waitcnt lgkmcnt(2)
  v_mov_b64 v[36:37], 0
  v_smfmac_f32_16x16x64_bf16 v[20:23], v[8:11], v[192:199], v74
  v_mov_b64 v[38:39], 0
  v_smfmac_f32_16x16x64_bf16 v[24:27], v[12:15], v[184:191], v74
  v_mov_b64 v[40:41], 0
  v_smfmac_f32_16x16x64_bf16 v[24:27], v[8:11], v[200:207], v74
  s_waitcnt lgkmcnt(0)
  v_add_f32 v20, v20, v22
  v_smfmac_f32_16x16x64_bf16 v[32:35], v[4:7], v[60:67], v74
  v_add_f32 v21, v21, v23
  v_smfmac_f32_16x16x64_bf16 v[28:31], v[16:19], v[240:247], v74
  v_add_f32 v24, v24, v26
  v_cvt_pk_bf16_f32 v22, v20, v24
  v_smfmac_f32_16x16x64_bf16 v[28:31], v[12:15], a[0:7], v74
  ds_write_b32 v79, v22 offset:0
  v_add_f32 v25, v25, v27
  v_cvt_pk_bf16_f32 v23, v21, v25
  v_smfmac_f32_16x16x64_bf16 v[28:31], v[8:11], a[16:23], v74
  ds_write_b32 v79, v23 offset:576
  v_cmp_u_f32 vcc, v20, v21
  v_smfmac_f32_16x16x64_bf16 v[32:35], v[16:19], v[248:255], v74
  v_mov_b64 v[42:43], 0
  v_smfmac_f32_16x16x64_bf16 v[32:35], v[12:15], a[8:15], v74
  v_add_f32 v28, v28, v30
  v_add_f32 v29, v29, v31
  v_smfmac_f32_16x16x64_bf16 v[32:35], v[8:11], a[24:31], v74
  s_cbranch_vccnz Cs3_rec
Cs3_recok:
  v_smfmac_f32_16x16x64_bf16 v[36:39], v[16:19], a[128:135], v74
  s_waitcnt lgkmcnt(0)
  s_barrier
  ds_read_b128 v[60:63], v77
  v_smfmac_f32_16x16x64_bf16 v[40:43], v[16:19], a[136:143], v74
  ds_read_b128 v[64:67], v77 offset:128
  v_add_f32 v32, v32, v34
  v_cvt_pk_bf16_f32 v30, v28, v32
  v_smfmac_f32_16x16x64_bf16 v[36:39], v[0:3], a[96:103], v74
  ds_write_b32 v79, v30 offset:256
  v_add_f32 v33, v33, v35
  v_cvt_pk_bf16_f32 v31, v29, v33
  v_smfmac_f32_16x16x64_bf16 v[40:43], v[0:3], a[104:111], v74
  ds_write_b32 v79, v31 offset:832
  v_xor_b32 v75, 0x8000, v75
  v_smfmac_f32_16x16x64_bf16 v[36:39], v[4:7], a[112:119], v74
  ds_read_b128 v[0:3], v76 offset:4608
  v_mov_b32 v29, 0
  v_smfmac_f32_16x16x64_bf16 v[40:43], v[4:7], a[120:127], v74
  s_waitcnt vmcnt(3) lgkmcnt(3)
  v_mov_b32 v30, 0
  v_mfma_f32_16x16x32_bf16 v[44:47], v[44:47], v[60:63], 0
  ds_read_b128 v[4:7], v76 offset:5632
  s_waitcnt lgkmcnt(2)
  v_mfma_f32_16x16x32_bf16 v[44:47], v[48:51], v[64:67], v[44:47]
  s_barrier
  v_smfmac_f32_16x16x64_bf16 v[36:39], v[8:11], a[160:167], v74
  ds_read_b128 v[20:23], v77 offset:256
  ds_read_b128 v[24:27], v77 offset:384
  v_smfmac_f32_16x16x64_bf16 v[40:43], v[8:11], a[168:175], v74
  ds_read_b128 v[8:11], v76 offset:6656
  v_add_f32_dpp v72, v46, v44 quad_perm:[2,3,0,1] row_mask:0xf bank_mask:0xf
  v_add_f32_dpp v73, v47, v45 quad_perm:[2,3,0,1] row_mask:0xf bank_mask:0xf
  v_smfmac_f32_16x16x64_bf16 v[36:39], v[12:15], a[144:151], v74
  s_waitcnt lgkmcnt(4)
  v_exp_f32_dpp v72, v72 quad_perm:[0,1,0,1] row_mask:0xf bank_mask:0xf
  v_smfmac_f32_16x16x64_bf16 v[40:43], v[12:15], a[152:159], v74
  ds_read_b128 v[12:15], v76 offset:7680
  v_exp_f32_dpp v73, v73 quad_perm:[0,1,0,1] row_mask:0xf bank_mask:0xf
  v_smfmac_f32_16x16x64_bf16 v[36:39], v[0:3], a[32:39], v74
  s_waitcnt lgkmcnt(2)
  v_cvt_pk_bf16_f32 v72, v72, v73
  v_mfma_f32_16x16x32_bf16 v[20:23], v[20:23], v[60:63], 0
  ds_write_b32 v78, v72 offset:524
  v_mov_b64 v[16:17], 0
  v_mfma_f32_16x16x32_bf16 v[20:23], v[24:27], v[64:67], v[20:23]
  ds_read_b128 v[44:47], v75 offset:28672
  v_mov_b64 v[18:19], 0
  v_smfmac_f32_16x16x64_bf16 v[40:43], v[0:3], a[40:47], v74
  ds_read_b128 v[48:51], v75 offset:29696
  s_waitcnt lgkmcnt(4)
  v_smfmac_f32_16x16x64_bf16 v[36:39], v[4:7], a[48:55], v74
  v_add_f32_dpp v24, v22, v20 quad_perm:[2,3,0,1] row_mask:0xf bank_mask:0xf
  v_add_f32_dpp v25, v23, v21 quad_perm:[2,3,0,1] row_mask:0xf bank_mask:0xf
  v_smfmac_f32_16x16x64_bf16 v[36:39], v[8:11], a[64:71], v74
  s_waitcnt lgkmcnt(2)
  s_barrier
  ds_read_b128 v[32:35], v78 offset:512
  v_smfmac_f32_16x16x64_bf16 v[36:39], v[12:15], a[80:87], v74
  ds_read_b128 v[60:63], v75 offset:30720
  v_mul_f32 v24, s69, v24
  v_smfmac_f32_16x16x64_bf16 v[40:43], v[4:7], a[56:63], v74
  ds_read_b128 v[64:67], v75 offset:31744
  v_mul_f32 v25, s69, v25
  v_smfmac_f32_16x16x64_bf16 v[40:43], v[8:11], a[72:79], v74
  v_exp_f32_dpp v24, v24 quad_perm:[0,1,0,1] row_mask:0xf bank_mask:0xf
  v_smfmac_f32_16x16x64_bf16 v[40:43], v[12:15], a[88:95], v74
  s_waitcnt lgkmcnt(2)
  v_exp_f32_dpp v25, v25 quad_perm:[0,1,0,1] row_mask:0xf bank_mask:0xf
  v_mfma_f32_16x16x32_bf16 v[8:11], v[32:35], v[68:71], 0
  v_add_f32 v36, v36, v38
  v_add_f32 v37, v37, v39
  v_mfma_f32_16x16x32_bf16 v[0:3], v[32:35], v[52:55], 0
  v_add_f32 v40, v40, v42
  v_add_f32 v41, v41, v43
  v_mfma_f32_16x16x32_bf16 v[4:7], v[32:35], v[56:59], 0
  v_cvt_pk_bf16_f32 v28, v24, v25
  v_cvt_pk_bf16_f32 v72, v36, v37
  v_cvt_pk_bf16_f32 v73, v40, v41
  v_mfma_f32_16x16x16_bf16 v[8:11], v[28:29], v[68:69], v[8:11]
  v_cvt_pk_bf16_f32 v31, v24, v25
  v_mov_b64 v[20:21], 0
  v_mfma_f32_16x16x16_bf16 v[0:3], v[28:29], v[72:73], v[0:3]
  ds_read_b128 v[68:71], v76 offset:13824
  v_mov_b64 v[22:23], 0
  v_mfma_f32_16x16x16_bf16 v[4:7], v[30:31], v[72:73], v[4:7]
  v_rcp_f32 v10, v8
  v_rcp_f32 v11, v9
  v_mul_f32 v0, v10, v0
  v_mul_f32 v1, v11, v1
  s_nop 0
  v_mul_f32 v4, v10, v4
  v_mul_f32 v5, v11, v5
  v_cvt_pk_bf16_f32 v2, v0, v4
  ds_write_b32 v79, v2 offset:8704
  v_cvt_pk_bf16_f32 v3, v1, v5
  ds_write_b32 v79, v3 offset:9280
  v_max3_f32 v8, v8, v9, v10
  v_max_f32 v8, v8, v11
  v_cmp_le_f32 vcc, 1317011456, v8
  v_mov_b64 v[24:25], 0
  v_mov_b64 v[26:27], 0
  s_cbranch_vccnz Cs3_mx
Cs3_mxok:
  s_waitcnt lgkmcnt(0)
  s_barrier
  ds_read_b128 v[0:3], v78 offset:8704
  ds_read_b128 v[4:7], v78 offset:8768
  ds_read_b128 v[8:11], v78 offset:8832
  ds_read_b128 v[12:15], v78 offset:8896
  s_waitcnt lgkmcnt(3)
  v_smfmac_f32_16x16x64_bf16 v[16:19], v[0:3], v[44:51], v74
  ds_read_b128 v[52:55], v75 offset:45056
  s_waitcnt lgkmcnt(3)
  v_smfmac_f32_16x16x64_bf16 v[16:19], v[4:7], v[60:67], v74
  ds_read_b128 v[56:59], v75 offset:46080
  s_waitcnt lgkmcnt(3)
  v_smfmac_f32_16x16x64_bf16 v[16:19], v[8:11], a[176:183], v74
  ds_read_b128 v[36:39], v75 offset:47104
  s_waitcnt lgkmcnt(3)
  v_smfmac_f32_16x16x64_bf16 v[16:19], v[12:15], a[184:191], v74
  ds_read_b128 v[40:43], v75 offset:48128
  ds_read_b128 v[44:47], v75 offset:61440
  v_smfmac_f32_16x16x64_bf16 v[20:23], v[0:3], a[192:199], v74
  ds_read_b128 v[48:51], v75 offset:62464
  ds_read_b128 v[60:63], v75 offset:63488
  v_smfmac_f32_16x16x64_bf16 v[20:23], v[4:7], a[200:207], v74
  ds_read_b128 v[64:67], v75 offset:64512
  s_waitcnt lgkmcnt(6)
  v_cvt_pk_bf16_f32 v16, v16, v17
  v_cvt_pk_bf16_f32 v17, v18, v19
  v_bfi_b32 v16, 1, s72, v16
  v_smfmac_f32_16x16x64_bf16 v[20:23], v[8:11], v[52:59], v74
  buffer_store_dwordx2 v[16:17], v68, s[8:11], s73 offen sc1
  s_waitcnt lgkmcnt(4)
  v_smfmac_f32_16x16x64_bf16 v[20:23], v[12:15], v[36:43], v74
  ds_read_b128 v[52:55], v75 offset:8192
  v_mov_b64 v[32:33], 0
  v_smfmac_f32_16x16x64_bf16 v[24:27], v[0:3], a[208:215], v74
  ds_read_b128 v[56:59], v75 offset:9216
  v_mov_b64 v[34:35], 0
  v_smfmac_f32_16x16x64_bf16 v[24:27], v[4:7], a[216:223], v74
  ds_read_b128 v[36:39], v75 offset:10240
  s_waitcnt lgkmcnt(5)
  v_cvt_pk_bf16_f32 v20, v20, v21
  v_cvt_pk_bf16_f32 v21, v22, v23
  v_bfi_b32 v20, 1, s72, v20
  v_smfmac_f32_16x16x64_bf16 v[24:27], v[8:11], v[44:51], v74
  buffer_store_dwordx2 v[20:21], v68, s[8:11], s74 offen sc1
  s_waitcnt lgkmcnt(3)
  v_smfmac_f32_16x16x64_bf16 v[24:27], v[12:15], v[60:67], v74
  ds_read_b128 v[40:43], v75 offset:11264
  v_mov_b64 v[28:29], 0
  v_smfmac_f32_16x16x64_bf16 v[32:35], v[0:3], a[224:231], v74
  ds_read_b128 v[44:47], v75 offset:12288
  ds_read_b128 v[48:51], v75 offset:13312
  v_smfmac_f32_16x16x64_bf16 v[32:35], v[4:7], a[232:239], v74
  ds_read_b128 v[60:63], v75 offset:14336
  v_cvt_pk_bf16_f32 v24, v24, v25
  v_cvt_pk_bf16_f32 v25, v26, v27
  v_bfi_b32 v24, 1, s72, v24
  v_smfmac_f32_16x16x64_bf16 v[32:35], v[8:11], a[240:247], v74
  buffer_store_dwordx2 v[24:25], v68, s[8:11], s75 offen sc1
  v_mov_b64 v[30:31], 0
  v_smfmac_f32_16x16x64_bf16 v[32:35], v[12:15], a[248:255], v74
  ds_read_b128 v[64:67], v75 offset:15360
  s_waitcnt lgkmcnt(6)
  v_smfmac_f32_16x16x64_bf16 v[28:31], v[0:3], v[52:59], v74
  s_waitcnt lgkmcnt(4)
  v_smfmac_f32_16x16x64_bf16 v[28:31], v[4:7], v[36:43], v74
  s_waitcnt lgkmcnt(2)
  v_cvt_pk_bf16_f32 v32, v32, v33
  v_cvt_pk_bf16_f32 v33, v34, v35
  v_bfi_b32 v32, 1, s72, v32
  v_smfmac_f32_16x16x64_bf16 v[28:31], v[8:11], v[44:51], v74
  buffer_store_dwordx2 v[32:33], v68, s[8:11], s76 offen sc1
  s_waitcnt lgkmcnt(0)
  v_smfmac_f32_16x16x64_bf16 v[28:31], v[12:15], v[60:67], v74
  ds_read_b128 v[52:55], v76 offset:14848
  ds_read_b64 v[16:17], v77 offset:392
  v_mov_b64 v[18:19], v[72:73]
  v_xor_b32 v75, 0x8000, v75
  s_nop 3
  v_cvt_pk_bf16_f32 v28, v28, v29
  v_cvt_pk_bf16_f32 v29, v30, v31
  v_bfi_b32 v28, 1, s72, v28
  buffer_store_dwordx2 v[28:29], v68, s[8:11], s77 offen sc1
  v_mov_b64 v[20:21], 0
  v_mov_b64 v[22:23], 0
  v_mov_b64 v[24:25], 0
  v_mov_b64 v[26:27], 0
  v_mov_b64 v[28:29], 0
  v_mov_b64 v[30:31], 0
  v_mov_b64 v[32:33], 0
  v_mov_b64 v[34:35], 0
  s_add_u32 s58, s58, 655360
  s_add_u32 s59, s59, 655360
  s_add_u32 s70, s70, 655360
  s_add_u32 s68, s68, 655360
  s_add_u32 s66, s66, 1
  s_xor_b32 s64, s64, 16384
  s_xor_b32 s65, s65, 16384
  s_cmp_eq_u32 s66, 62
  s_cselect_b64 s[16:17], s[20:21], s[16:17]
  s_cselect_b32 s18, (Cs3_done - Cs3_last), s18
  s_cselect_b32 s70, 0, s70
  s_cmp_eq_u32 s66, 63
  s_cselect_b32 s59, 268435456, s59
  s_nop 15
  s_nop 15
  s_nop 15
  s_nop 3
  buffer_load_dwordx4 v[0:3], v76, s[8:11], s60 offen offset:0 sc1
  buffer_load_dwordx4 v[4:7], v76, s[8:11], s60 offen offset:1024 sc1
  buffer_load_dwordx4 v[8:11], v76, s[8:11], s61 offen offset:0 sc1
  buffer_load_dwordx4 v[12:15], v76, s[8:11], s61 offen offset:1024 sc1
  s_nop 15
  s_nop 11
  buffer_load_dwordx4 v[44:47], v76, s[8:11], s60 offen offset:0 sc1
  buffer_load_dwordx4 v[48:51], v76, s[8:11], s60 offen offset:1024 sc1
  buffer_load_dwordx4 v[60:63], v76, s[8:11], s61 offen offset:0 sc1
  buffer_load_dwordx4 v[64:67], v76, s[8:11], s61 offen offset:1024 sc1
  s_waitcnt lgkmcnt(0)
  s_waitcnt vmcnt(7)
  v_mfma_f32_16x16x32_bf16 v[56:59], v[52:55], v[0:3], 0
  v_bitop3_b32 v72, v0, v2, s72 bitop3:0x7e
  s_waitcnt vmcnt(6)
  v_mfma_f32_16x16x32_bf16 v[56:59], v[52:55], v[4:7], v[56:59]
  v_bitop3_b32 v73, v4, v6, s72 bitop3:0x7e
  v_or_b32 v72, v72, v73
  s_waitcnt vmcnt(5)
  v_mfma_f32_16x16x32_bf16 v[36:39], v[52:55], v[8:11], 0
  v_bitop3_b32 v73, v8, v10, s72 bitop3:0x7e
  v_or_b32 v72, v72, v73
  s_waitcnt vmcnt(4)
  v_mfma_f32_16x16x32_bf16 v[36:39], v[52:55], v[12:15], v[36:39]
  v_bitop3_b32 v73, v12, v14, s72 bitop3:0x7e
  v_bitop3_b32 v72, v72, v73, 1 bitop3:0xa8
  v_cmp_ne_u32 vcc, 0, v72
  s_cbranch_vccnz Cs3_h1r
  v_add_f32_dpp v56, v56, v56 row_ror:4 row_mask:0xf bank_mask:0xf
  v_add_f32_dpp v57, v57, v57 row_ror:4 row_mask:0xf bank_mask:0xf
  s_nop 0
  v_add_f32_dpp v36, v36, v36 row_ror:4 row_mask:0xf bank_mask:0xf
  v_add_f32_dpp v37, v37, v37 row_ror:4 row_mask:0xf bank_mask:0xf
  v_add_f32_dpp v56, v56, v56 row_ror:8 row_mask:0xf bank_mask:0xf
  v_add_f32_dpp v57, v57, v57 row_ror:8 row_mask:0xf bank_mask:0xf
  v_add_f32_dpp v36, v36, v36 row_ror:8 row_mask:0xf bank_mask:0xf
  v_add_f32_dpp v37, v37, v37 row_ror:8 row_mask:0xf bank_mask:0xf
  v_cvt_pk_bf16_f32 v56, v56, v57
  buffer_store_dword v56, v69, s[8:11], s62 offen sc1
  v_cvt_pk_bf16_f32 v36, v36, v37
  buffer_store_dword v36, v70, s[8:11], s63 offen sc1
  s_xor_b32 s62, s62, 16384
  buffer_store_dword v71, v69, s[8:11], s62 offen sc1
  s_xor_b32 s63, s63, 16384
  buffer_store_dword v71, v70, s[8:11], s63 offen sc1
  s_xor_b32 s72, s72, 1
  s_branch Cs3_h2
Cs3_h1r:
  s_mov_b64 exec, vcc
  buffer_load_dwordx4 v[0:3], v76, s[8:11], s60 offen offset:0 sc1
  buffer_load_dwordx4 v[4:7], v76, s[8:11], s60 offen offset:1024 sc1
  buffer_load_dwordx4 v[8:11], v76, s[8:11], s61 offen offset:0 sc1
  buffer_load_dwordx4 v[12:15], v76, s[8:11], s61 offen offset:1024 sc1
  s_mov_b64 exec, -1
  s_add_u32 s67, s67, 1
  s_waitcnt vmcnt(7)
  v_mfma_f32_16x16x32_bf16 v[56:59], v[52:55], v[44:47], 0
  v_bitop3_b32 v72, v44, v46, s72 bitop3:0x7e
  s_waitcnt vmcnt(6)
  v_mfma_f32_16x16x32_bf16 v[56:59], v[52:55], v[48:51], v[56:59]
  v_bitop3_b32 v73, v48, v50, s72 bitop3:0x7e
  v_or_b32 v72, v72, v73
  s_waitcnt vmcnt(5)
  v_mfma_f32_16x16x32_bf16 v[36:39], v[52:55], v[60:63], 0
  v_bitop3_b32 v73, v60, v62, s72 bitop3:0x7e
  v_or_b32 v72, v72, v73
  s_waitcnt vmcnt(4)
  v_mfma_f32_16x16x32_bf16 v[36:39], v[52:55], v[64:67], v[36:39]
  v_bitop3_b32 v73, v64, v66, s72 bitop3:0x7e
  v_bitop3_b32 v72, v72, v73, 1 bitop3:0xa8
  v_cmp_ne_u32 vcc, 0, v72
  s_cbranch_vccz Cs3_h1p
  s_mov_b64 exec, vcc
  buffer_load_dwordx4 v[44:47], v76, s[8:11], s60 offen offset:0 sc1
  buffer_load_dwordx4 v[48:51], v76, s[8:11], s60 offen offset:1024 sc1
  buffer_load_dwordx4 v[60:63], v76, s[8:11], s61 offen offset:0 sc1
  buffer_load_dwordx4 v[64:67], v76, s[8:11], s61 offen offset:1024 sc1
  s_mov_b64 exec, -1
  s_add_u32 s67, s67, 1
  s_waitcnt vmcnt(7)
  v_mfma_f32_16x16x32_bf16 v[56:59], v[52:55], v[0:3], 0
  v_bitop3_b32 v72, v0, v2, s72 bitop3:0x7e
  s_waitcnt vmcnt(6)
  v_mfma_f32_16x16x32_bf16 v[56:59], v[52:55], v[4:7], v[56:59]
  v_bitop3_b32 v73, v4, v6, s72 bitop3:0x7e
  v_or_b32 v72, v72, v73
  s_waitcnt vmcnt(5)
  v_mfma_f32_16x16x32_bf16 v[36:39], v[52:55], v[8:11], 0
  v_bitop3_b32 v73, v8, v10, s72 bitop3:0x7e
  v_or_b32 v72, v72, v73
  s_waitcnt vmcnt(4)
  v_mfma_f32_16x16x32_bf16 v[36:39], v[52:55], v[12:15], v[36:39]
  v_bitop3_b32 v73, v12, v14, s72 bitop3:0x7e
  v_bitop3_b32 v72, v72, v73, 1 bitop3:0xa8
  v_cmp_ne_u32 vcc, 0, v72
  s_cbranch_vccz Cs3_h1p
Cs3_h1s:
  s_mov_b64 exec, vcc
  buffer_load_dwordx4 v[0:3], v76, s[8:11], s60 offen offset:0 sc1
  buffer_load_dwordx4 v[4:7], v76, s[8:11], s60 offen offset:1024 sc1
  buffer_load_dwordx4 v[8:11], v76, s[8:11], s61 offen offset:0 sc1
  buffer_load_dwordx4 v[12:15], v76, s[8:11], s61 offen offset:1024 sc1
  s_mov_b64 exec, -1
  s_add_u32 s67, s67, 1
  s_waitcnt vmcnt(7)
  v_mfma_f32_16x16x32_bf16 v[56:59], v[52:55], v[44:47], 0
  v_bitop3_b32 v72, v44, v46, s72 bitop3:0x7e
  s_waitcnt vmcnt(6)
  v_mfma_f32_16x16x32_bf16 v[56:59], v[52:55], v[48:51], v[56:59]
  v_bitop3_b32 v73, v48, v50, s72 bitop3:0x7e
  v_or_b32 v72, v72, v73
  s_waitcnt vmcnt(5)
  v_mfma_f32_16x16x32_bf16 v[36:39], v[52:55], v[60:63], 0
  v_bitop3_b32 v73, v60, v62, s72 bitop3:0x7e
  v_or_b32 v72, v72, v73
  s_waitcnt vmcnt(4)
  v_mfma_f32_16x16x32_bf16 v[36:39], v[52:55], v[64:67], v[36:39]
  v_bitop3_b32 v73, v64, v66, s72 bitop3:0x7e
  v_bitop3_b32 v72, v72, v73, 1 bitop3:0xa8
  v_cmp_ne_u32 vcc, 0, v72
  s_cbranch_vccz Cs3_h1p
  s_mov_b64 exec, vcc
  buffer_load_dwordx4 v[44:47], v76, s[8:11], s60 offen offset:0 sc1
  buffer_load_dwordx4 v[48:51], v76, s[8:11], s60 offen offset:1024 sc1
  buffer_load_dwordx4 v[60:63], v76, s[8:11], s61 offen offset:0 sc1
  buffer_load_dwordx4 v[64:67], v76, s[8:11], s61 offen offset:1024 sc1
  s_mov_b64 exec, -1
  s_add_u32 s67, s67, 1
  s_waitcnt vmcnt(7)
  v_mfma_f32_16x16x32_bf16 v[56:59], v[52:55], v[0:3], 0
  v_bitop3_b32 v72, v0, v2, s72 bitop3:0x7e
  s_waitcnt vmcnt(6)
  v_mfma_f32_16x16x32_bf16 v[56:59], v[52:55], v[4:7], v[56:59]
  v_bitop3_b32 v73, v4, v6, s72 bitop3:0x7e
  v_or_b32 v72, v72, v73
  s_waitcnt vmcnt(5)
  v_mfma_f32_16x16x32_bf16 v[36:39], v[52:55], v[8:11], 0
  v_bitop3_b32 v73, v8, v10, s72 bitop3:0x7e
  v_or_b32 v72, v72, v73
  s_waitcnt vmcnt(4)
  v_mfma_f32_16x16x32_bf16 v[36:39], v[52:55], v[12:15], v[36:39]
  v_bitop3_b32 v73, v12, v14, s72 bitop3:0x7e
  v_bitop3_b32 v72, v72, v73, 1 bitop3:0xa8
  v_cmp_ne_u32 vcc, 0, v72
  s_cbranch_vccz Cs3_h1p
  s_cmp_lt_u32 s67, 131072
  s_cbranch_scc1 Cs3_h1s
Cs3_h1p:
  s_nop 2
  v_add_f32_dpp v56, v56, v56 row_ror:4 row_mask:0xf bank_mask:0xf
  v_add_f32_dpp v57, v57, v57 row_ror:4 row_mask:0xf bank_mask:0xf
  v_add_f32_dpp v36, v36, v36 row_ror:4 row_mask:0xf bank_mask:0xf
  v_add_f32_dpp v37, v37, v37 row_ror:4 row_mask:0xf bank_mask:0xf
  v_add_f32_dpp v56, v56, v56 row_ror:8 row_mask:0xf bank_mask:0xf
  v_add_f32_dpp v57, v57, v57 row_ror:8 row_mask:0xf bank_mask:0xf
  v_add_f32_dpp v36, v36, v36 row_ror:8 row_mask:0xf bank_mask:0xf
  v_add_f32_dpp v37, v37, v37 row_ror:8 row_mask:0xf bank_mask:0xf
  v_cvt_pk_bf16_f32 v56, v56, v57
  buffer_store_dword v56, v69, s[8:11], s62 offen sc1
  v_cvt_pk_bf16_f32 v36, v36, v37
  buffer_store_dword v36, v70, s[8:11], s63 offen sc1
  s_xor_b32 s62, s62, 16384
  buffer_store_dword v71, v69, s[8:11], s62 offen sc1
  s_xor_b32 s63, s63, 16384
  buffer_store_dword v71, v70, s[8:11], s63 offen sc1
  s_xor_b32 s72, s72, 1
  s_branch Cs3_h2
Cs3_rec:
  s_nop 7
  s_waitcnt vmcnt(0) lgkmcnt(0)
  v_max3_u32 v72, v0, v1, v2
  v_max3_u32 v72, v72, v3, v4
  v_max3_u32 v72, v72, v5, v6
  v_max3_u32 v72, v72, v7, v8
  v_max3_u32 v72, v72, v9, v10
  v_max3_u32 v72, v72, v11, v12
  v_max3_u32 v72, v72, v13, v14
  v_max3_u32 v72, v72, v15, v16
  v_max3_u32 v72, v72, v17, v18
  v_max_u32 v72, v72, v19
  v_cmp_eq_u32 vcc, -1, v72
  s_cbranch_vccz Cs3_recok
  s_barrier
Cs3_recp:
  buffer_load_dwordx4 v[0:3], v76, s[8:11], s64 offen offset:0 sc1
  buffer_load_dwordx4 v[4:7], v76, s[8:11], s64 offen offset:1024 sc1
  buffer_load_dwordx4 v[8:11], v76, s[8:11], s64 offen offset:2048 sc1
  s_add_u32 s67, s67, 1
  s_cmp_lt_u32 s67, 131072
  s_cselect_b32 s54, -2, -1
  s_waitcnt vmcnt(2)
  v_max3_u32 v72, v0, v1, v2
  s_waitcnt vmcnt(1)
  v_max3_u32 v72, v72, v3, v4
  v_max3_u32 v72, v72, v5, v6
  s_waitcnt vmcnt(0)
  v_max3_u32 v72, v72, v7, v8
  v_max3_u32 v72, v72, v9, v10
  v_max_u32 v72, v72, v11
  v_cmp_lt_u32 vcc, s54, v72
  s_cbranch_vccnz Cs3_recp
  ds_write_b128 v76, v[0:3] offset:10752
  ds_write_b128 v76, v[4:7] offset:11776
  ds_write_b128 v76, v[8:11] offset:12800
  v_mov_b64 v[20:21], 0
  v_mov_b64 v[22:23], 0
  v_mov_b64 v[24:25], 0
  v_mov_b64 v[26:27], 0
  v_mov_b64 v[28:29], 0
  v_mov_b64 v[30:31], 0
  v_mov_b64 v[32:33], 0
  v_mov_b64 v[34:35], 0
  s_waitcnt lgkmcnt(0)
  s_barrier
  ds_read_b128 v[0:3], v76 offset:4608
  ds_read_b128 v[60:63], v76 offset:28672
  ds_read_b128 v[64:67], v76 offset:29696
  s_waitcnt lgkmcnt(0)
  v_smfmac_f32_16x16x64_bf16 v[20:23], v[0:3], v[60:67], v74
  ds_read_b128 v[60:63], v76 offset:30720
  ds_read_b128 v[64:67], v76 offset:31744
  s_waitcnt lgkmcnt(0)
  v_smfmac_f32_16x16x64_bf16 v[24:27], v[0:3], v[60:67], v74
  ds_read_b128 v[60:63], v76 offset:45056
  ds_read_b128 v[64:67], v76 offset:46080
  s_waitcnt lgkmcnt(0)
  v_smfmac_f32_16x16x64_bf16 v[28:31], v[0:3], v[60:67], v74
  ds_read_b128 v[60:63], v76 offset:47104
  ds_read_b128 v[64:67], v76 offset:48128
  s_waitcnt lgkmcnt(0)
  v_smfmac_f32_16x16x64_bf16 v[32:35], v[0:3], v[60:67], v74
  ds_read_b128 v[4:7], v76 offset:5632
  s_waitcnt lgkmcnt(0)
  v_smfmac_f32_16x16x64_bf16 v[20:23], v[4:7], v[80:87], v74
  v_smfmac_f32_16x16x64_bf16 v[24:27], v[4:7], v[88:95], v74
  v_smfmac_f32_16x16x64_bf16 v[28:31], v[4:7], v[208:215], v74
  v_smfmac_f32_16x16x64_bf16 v[32:35], v[4:7], v[216:223], v74
  ds_read_b128 v[8:11], v76 offset:6656
  s_waitcnt lgkmcnt(0)
  v_smfmac_f32_16x16x64_bf16 v[20:23], v[8:11], v[96:103], v74
  v_smfmac_f32_16x16x64_bf16 v[24:27], v[8:11], v[104:111], v74
  ds_read_b128 v[60:63], v76 offset:61440
  ds_read_b128 v[64:67], v76 offset:62464
  s_waitcnt lgkmcnt(0)
  v_smfmac_f32_16x16x64_bf16 v[28:31], v[8:11], v[60:67], v74
  ds_read_b128 v[60:63], v76 offset:63488
  ds_read_b128 v[64:67], v76 offset:64512
  s_waitcnt lgkmcnt(0)
  v_smfmac_f32_16x16x64_bf16 v[32:35], v[8:11], v[60:67], v74
  ds_read_b128 v[12:15], v76 offset:7680
  s_waitcnt lgkmcnt(0)
  v_smfmac_f32_16x16x64_bf16 v[20:23], v[12:15], v[112:119], v74
  v_smfmac_f32_16x16x64_bf16 v[24:27], v[12:15], v[120:127], v74
  v_smfmac_f32_16x16x64_bf16 v[28:31], v[12:15], v[224:231], v74
  v_smfmac_f32_16x16x64_bf16 v[32:35], v[12:15], v[232:239], v74
  ds_read_b128 v[0:3], v76 offset:8704
  s_waitcnt lgkmcnt(0)
  v_smfmac_f32_16x16x64_bf16 v[20:23], v[0:3], v[128:135], v74
  v_smfmac_f32_16x16x64_bf16 v[24:27], v[0:3], v[136:143], v74
  ds_read_b128 v[60:63], v75 offset:12288
  ds_read_b128 v[64:67], v75 offset:13312
  s_waitcnt lgkmcnt(0)
  v_smfmac_f32_16x16x64_bf16 v[28:31], v[0:3], v[60:67], v74
  ds_read_b128 v[60:63], v75 offset:14336
  ds_read_b128 v[64:67], v75 offset:15360
  s_waitcnt lgkmcnt(0)
  v_smfmac_f32_16x16x64_bf16 v[32:35], v[0:3], v[60:67], v74
  ds_read_b128 v[4:7], v76 offset:9728
  s_waitcnt lgkmcnt(0)
  v_smfmac_f32_16x16x64_bf16 v[20:23], v[4:7], v[144:151], v74
  v_smfmac_f32_16x16x64_bf16 v[24:27], v[4:7], v[152:159], v74
  ds_read_b128 v[60:63], v75 offset:28672
  ds_read_b128 v[64:67], v75 offset:29696
  s_waitcnt lgkmcnt(0)
  v_smfmac_f32_16x16x64_bf16 v[28:31], v[4:7], v[60:67], v74
  ds_read_b128 v[60:63], v75 offset:30720
  ds_read_b128 v[64:67], v75 offset:31744
  s_waitcnt lgkmcnt(0)
  v_smfmac_f32_16x16x64_bf16 v[32:35], v[4:7], v[60:67], v74
  ds_read_b128 v[16:19], v76 offset:10752
  s_waitcnt lgkmcnt(0)
  v_smfmac_f32_16x16x64_bf16 v[20:23], v[16:19], v[160:167], v74
  v_smfmac_f32_16x16x64_bf16 v[24:27], v[16:19], v[168:175], v74
  v_smfmac_f32_16x16x64_bf16 v[28:31], v[16:19], v[240:247], v74
  v_smfmac_f32_16x16x64_bf16 v[32:35], v[16:19], v[248:255], v74
  ds_read_b128 v[12:15], v76 offset:11776
  s_waitcnt lgkmcnt(0)
  v_smfmac_f32_16x16x64_bf16 v[20:23], v[12:15], v[176:183], v74
  v_smfmac_f32_16x16x64_bf16 v[24:27], v[12:15], v[184:191], v74
  v_smfmac_f32_16x16x64_bf16 v[28:31], v[12:15], a[0:7], v74
  v_smfmac_f32_16x16x64_bf16 v[32:35], v[12:15], a[8:15], v74
  ds_read_b128 v[8:11], v76 offset:12800
  s_waitcnt lgkmcnt(0)
  v_smfmac_f32_16x16x64_bf16 v[20:23], v[8:11], v[192:199], v74
  v_smfmac_f32_16x16x64_bf16 v[24:27], v[8:11], v[200:207], v74
  v_smfmac_f32_16x16x64_bf16 v[28:31], v[8:11], a[16:23], v74
  v_smfmac_f32_16x16x64_bf16 v[32:35], v[8:11], a[24:31], v74
  v_add_f32 v20, v20, v22
  v_add_f32 v21, v21, v23
  v_add_f32 v24, v24, v26
  v_cvt_pk_bf16_f32 v22, v20, v24
  s_nop 0
  ds_write_b32 v79, v22 offset:0
  v_add_f32 v25, v25, v27
  v_cvt_pk_bf16_f32 v23, v21, v25
  ds_write_b32 v79, v23 offset:576
  v_add_f32 v28, v28, v30
  v_add_f32 v29, v29, v31
  s_waitcnt lgkmcnt(0)
  s_nop 1
  s_branch Cs3_recok
Cs3_mx:
  s_waitcnt lgkmcnt(0)
  s_barrier
  buffer_load_dwordx4 v[0:3], v76, s[8:11], s58 offen offset:0 sc1
  ds_read_b128 v[20:23], v77 offset:0
  ds_read_b128 v[28:31], v77 offset:256
  buffer_load_dwordx4 v[4:7], v76, s[8:11], s58 offen offset:1024 sc1
  ds_read_b128 v[24:27], v77 offset:128
  ds_read_b128 v[32:35], v77 offset:384
  s_waitcnt vmcnt(1) lgkmcnt(3)
  v_mfma_f32_16x16x32_bf16 v[8:11], v[0:3], v[20:23], 0
  s_waitcnt vmcnt(0) lgkmcnt(1)
  v_mfma_f32_16x16x32_bf16 v[8:11], v[4:7], v[24:27], v[8:11]
  v_mfma_f32_16x16x32_bf16 v[12:15], v[28:31], v[20:23], 0
  s_waitcnt lgkmcnt(0)
  v_mfma_f32_16x16x32_bf16 v[12:15], v[32:35], v[24:27], v[12:15]
  v_add_f32_dpp v8, v10, v8 quad_perm:[2,3,0,1] row_mask:0xf bank_mask:0xf
  v_add_f32_dpp v9, v11, v9 quad_perm:[2,3,0,1] row_mask:0xf bank_mask:0xf
  s_nop 0
  v_mov_b32_dpp v8, v8 quad_perm:[0,1,0,1] row_mask:0xf bank_mask:0xf
  v_mov_b32_dpp v9, v9 quad_perm:[0,1,0,1] row_mask:0xf bank_mask:0xf
  s_nop 1
  v_add_f32_dpp v12, v14, v12 quad_perm:[2,3,0,1] row_mask:0xf bank_mask:0xf
  v_add_f32_dpp v13, v15, v13 quad_perm:[2,3,0,1] row_mask:0xf bank_mask:0xf
  s_nop 0
  v_mov_b32_dpp v12, v12 quad_perm:[0,1,0,1] row_mask:0xf bank_mask:0xf
  v_mov_b32_dpp v13, v13 quad_perm:[0,1,0,1] row_mask:0xf bank_mask:0xf
  v_mul_f32 v12, s69, v12
  ds_write_b32 v78, v8 offset:8716
  v_mul_f32 v13, s69, v13
  ds_write_b32 v78, v9 offset:8780
  s_waitcnt lgkmcnt(0)
  s_barrier
  ds_read_b128 v[36:39], v78 offset:8704
  ds_read_b128 v[40:43], v78 offset:8768
  s_waitcnt lgkmcnt(0)
  s_barrier
  v_max_f32 v16, v36, v37
  v_max3_f32 v16, v16, v38, v39
  v_max3_f32 v16, v16, v40, v41
  v_max3_f32 v16, v16, v42, v43
  v_max3_f32 v16, v16, v12, v13
  v_mov_b32 v17, v16
  s_nop 1
  v_permlane16_swap_b32 v16, v17
  v_max_f32 v16, v16, v17
  v_mov_b32 v17, v16
  s_nop 1
  v_permlane32_swap_b32 v16, v17
  v_max_f32 v16, v16, v17
  v_sub_f32 v36, v36, v16
  v_sub_f32 v37, v37, v16
  v_sub_f32 v38, v38, v16
  v_sub_f32 v39, v39, v16
  v_sub_f32 v40, v40, v16
  v_sub_f32 v41, v41, v16
  v_sub_f32 v42, v42, v16
  v_sub_f32 v43, v43, v16
  v_sub_f32 v12, v12, v16
  v_sub_f32 v13, v13, v16
  v_exp_f32 v36, v36
  v_exp_f32 v37, v37
  v_exp_f32 v38, v38
  v_exp_f32 v39, v39
  v_exp_f32 v40, v40
  v_exp_f32 v41, v41
  v_exp_f32 v42, v42
  v_exp_f32 v43, v43
  v_exp_f32 v12, v12
  v_exp_f32 v13, v13
  v_cvt_pk_bf16_f32 v32, v36, v40
  v_cvt_pk_bf16_f32 v33, v37, v41
  v_cvt_pk_bf16_f32 v34, v38, v42
  v_cvt_pk_bf16_f32 v35, v39, v43
  v_cvt_pk_bf16_f32 v28, v12, v13
  v_cvt_pk_bf16_f32 v31, v12, v13
  v_mov_b32 v29, 0
  v_mov_b32 v30, 0
  v_mov_b32 v68, 0x3f803f80
  v_mov_b32 v69, 0x3f803f80
  v_mov_b32 v70, 0x3f803f80
  v_mov_b32 v71, 0x3f803f80
  s_nop 1
  v_mfma_f32_16x16x32_bf16 v[8:11], v[32:35], v[68:71], 0
  v_mfma_f32_16x16x32_bf16 v[0:3], v[32:35], v[52:55], 0
  v_mfma_f32_16x16x32_bf16 v[4:7], v[32:35], v[56:59], 0
  v_mfma_f32_16x16x16_bf16 v[8:11], v[28:29], v[68:69], v[8:11]
  v_mfma_f32_16x16x16_bf16 v[0:3], v[28:29], v[72:73], v[0:3]
  v_mfma_f32_16x16x16_bf16 v[4:7], v[30:31], v[72:73], v[4:7]
  ds_read_b128 v[68:71], v76 offset:13824
  v_rcp_f32 v10, v8
  v_rcp_f32 v11, v9
  v_mul_f32 v0, v10, v0
  v_mul_f32 v1, v11, v1
  s_nop 0
  v_mul_f32 v4, v10, v4
  v_mul_f32 v5, v11, v5
  v_cvt_pk_bf16_f32 v2, v0, v4
  ds_write_b32 v79, v2 offset:8704
  v_cvt_pk_bf16_f32 v3, v1, v5
  ds_write_b32 v79, v3 offset:9280
  v_mov_b64 v[16:17], 0
  v_mov_b64 v[18:19], 0
  v_mov_b64 v[20:21], 0
  v_mov_b64 v[22:23], 0
  v_mov_b64 v[24:25], 0
  v_mov_b64 v[26:27], 0
  s_branch Cs3_mxok
Cs3_kv3:
  s_waitcnt lgkmcnt(0)
  s_cmp_ge_u32 s57, 0x700
  s_cbranch_scc1 Cs3_h2w
  s_load_dword s57, s[12:13], s71 glc
  s_add_u32 s67, s67, 1
  s_cmp_lt_u32 s67, 131072
  s_cbranch_scc1 Cs3_kv3
  s_branch Cs3_h2w
Cs3_last:
  ds_read_b128 v[8:11], v76 offset:6656
  ds_read_b128 v[12:15], v76 offset:7680
  ds_read_b128 v[60:63], v76 offset:47104
  ds_read_b128 v[64:67], v76 offset:48128
  ds_read_b128 v[44:47], v76 offset:61440
  ds_read_b128 v[48:51], v76 offset:62464
  s_waitcnt lgkmcnt(7)
  v_smfmac_f32_16x16x64_bf16 v[28:31], v[0:3], v[36:43], v74
  v_smfmac_f32_16x16x64_bf16 v[20:23], v[0:3], a[32:39], v74
  ds_read_b128 v[36:39], v76 offset:63488
  ds_read_b128 v[40:43], v76 offset:64512
  v_smfmac_f32_16x16x64_bf16 v[24:27], v[0:3], a[40:47], v74
  s_waitcnt lgkmcnt(8)
  v_smfmac_f32_16x16x64_bf16 v[20:23], v[4:7], a[48:55], v74
  buffer_store_dwordx4 v[16:19], v76, s[8:11], s68 offen sc1
  v_smfmac_f32_16x16x64_bf16 v[24:27], v[4:7], a[56:63], v74
  s_waitcnt lgkmcnt(4)
  v_smfmac_f32_16x16x64_bf16 v[28:31], v[4:7], v[208:215], v74
  v_smfmac_f32_16x16x64_bf16 v[32:35], v[4:7], v[216:223], v74
  s_waitcnt lgkmcnt(2)
  v_smfmac_f32_16x16x64_bf16 v[32:35], v[0:3], v[60:67], v74
  v_smfmac_f32_16x16x64_bf16 v[20:23], v[8:11], a[64:71], v74
  ds_read_b128 v[60:63], v75 offset:12288
  ds_read_b128 v[64:67], v75 offset:13312
  v_smfmac_f32_16x16x64_bf16 v[24:27], v[8:11], a[72:79], v74
  v_smfmac_f32_16x16x64_bf16 v[28:31], v[8:11], v[44:51], v74
  v_smfmac_f32_16x16x64_bf16 v[20:23], v[12:15], a[80:87], v74
  ds_read_b128 v[44:47], v75 offset:14336
  ds_read_b128 v[48:51], v75 offset:15360
  v_smfmac_f32_16x16x64_bf16 v[24:27], v[12:15], a[88:95], v74
  s_waitcnt lgkmcnt(4)
  v_smfmac_f32_16x16x64_bf16 v[28:31], v[12:15], v[224:231], v74
  v_smfmac_f32_16x16x64_bf16 v[32:35], v[12:15], v[232:239], v74
  v_smfmac_f32_16x16x64_bf16 v[32:35], v[8:11], v[36:43], v74
  ds_read_b128 v[36:39], v75 offset:28672
  ds_read_b128 v[40:43], v75 offset:29696
  s_waitcnt vmcnt(1)
  s_barrier
Cs3_lastr:
  ds_read_b128 v[0:3], v76 offset:8704
  ds_read_b128 v[4:7], v76 offset:9728
  ds_read_b128 v[16:19], v76 offset:10752
  ds_read_b128 v[12:15], v76 offset:11776
  ds_read_b128 v[8:11], v76 offset:12800
  s_waitcnt lgkmcnt(4)
  v_max3_u32 v72, v0, v1, v2
  s_waitcnt lgkmcnt(3)
  v_max3_u32 v72, v72, v3, v4
  v_max3_u32 v72, v72, v5, v6
  s_waitcnt lgkmcnt(0)
  v_max3_u32 v72, v72, v7, v8
  v_max3_u32 v72, v72, v9, v10
  v_max3_u32 v72, v72, v11, v12
  v_max3_u32 v72, v72, v13, v14
  v_max3_u32 v72, v72, v15, v16
  v_max3_u32 v72, v72, v17, v18
  v_max_u32 v72, v72, v19
  v_cmp_eq_u32 vcc, -1, v72
  s_cbranch_vccnz Cs3_lastp
Cs3_lastg:
  v_smfmac_f32_16x16x64_bf16 v[28:31], v[0:3], v[60:67], v74
  ds_read_b128 v[60:63], v75 offset:30720
  ds_read_b128 v[64:67], v75 offset:31744
  v_smfmac_f32_16x16x64_bf16 v[32:35], v[0:3], v[44:51], v74
  v_smfmac_f32_16x16x64_bf16 v[28:31], v[4:7], v[36:43], v74
  v_smfmac_f32_16x16x64_bf16 v[28:31], v[16:19], v[240:247], v74
  v_smfmac_f32_16x16x64_bf16 v[28:31], v[12:15], a[0:7], v74
  v_smfmac_f32_16x16x64_bf16 v[28:31], v[8:11], a[16:23], v74
  v_smfmac_f32_16x16x64_bf16 v[32:35], v[16:19], v[248:255], v74
  v_smfmac_f32_16x16x64_bf16 v[32:35], v[12:15], a[8:15], v74
  s_waitcnt lgkmcnt(0)
  v_smfmac_f32_16x16x64_bf16 v[32:35], v[8:11], a[24:31], v74
  v_smfmac_f32_16x16x64_bf16 v[32:35], v[4:7], v[60:67], v74
  v_smfmac_f32_16x16x64_bf16 v[20:23], v[0:3], a[96:103], v74
  v_smfmac_f32_16x16x64_bf16 v[20:23], v[4:7], a[112:119], v74
  v_add_f32 v28, v28, v30
  v_add_f32 v32, v32, v34
  v_cvt_pk_bf16_f32 v30, v28, v32
  v_smfmac_f32_16x16x64_bf16 v[20:23], v[16:19], a[128:135], v74
  ds_write_b32 v79, v30 offset:256
  v_add_f32 v29, v29, v31
  v_add_f32 v33, v33, v35
  v_cvt_pk_bf16_f32 v31, v29, v33
  v_smfmac_f32_16x16x64_bf16 v[20:23], v[12:15], a[144:151], v74
  ds_write_b32 v79, v31 offset:832
  v_smfmac_f32_16x16x64_bf16 v[20:23], v[8:11], a[160:167], v74
  v_smfmac_f32_16x16x64_bf16 v[24:27], v[0:3], a[104:111], v74
  v_smfmac_f32_16x16x64_bf16 v[24:27], v[4:7], a[120:127], v74
  v_smfmac_f32_16x16x64_bf16 v[24:27], v[16:19], a[136:143], v74
  s_waitcnt lgkmcnt(0)
  s_barrier
  ds_read_b64 v[52:53], v77 offset:392
  v_add_f32 v20, v20, v22
  v_smfmac_f32_16x16x64_bf16 v[24:27], v[12:15], a[152:159], v74
  v_add_f32 v21, v21, v23
  v_smfmac_f32_16x16x64_bf16 v[24:27], v[8:11], a[168:175], v74
  v_cvt_pk_bf16_f32 v54, v20, v21
  s_add_u32 s68, s68, 655360
  s_nop 3
  v_add_f32 v24, v24, v26
  v_add_f32 v25, v25, v27
  v_cvt_pk_bf16_f32 v55, v24, v25
  s_waitcnt lgkmcnt(0)
  buffer_store_dwordx4 v[52:55], v76, s[8:11], s68 offen sc1
  s_branch Cs3_done
Cs3_lastp:
  s_add_u32 s72, s72, 2
  s_cmp_ge_u32 s72, 131072
  s_cbranch_scc1 Cs3_lastg
  s_barrier
  buffer_load_dwordx4 v76, s[8:11], s55 offen offset:0 sc1 lds
  s_waitcnt vmcnt(0)
  s_barrier
  s_branch Cs3_lastr
Cs3_done:
  s_branch L_cexit
L_conf:
  s_waitcnt vmcnt(0) lgkmcnt(0)
  s_barrier
  s_cmp_eq_u32 s52, 0
  s_cbranch_scc0 L_cf2
  s_mov_b64 exec, 1
  s_lshl_b32 s57, s2, 2
  v_mov_b32 v1, 0
L_cf0:
  s_cmp_eq_u32 s54, -1
  s_cbranch_scc1 L_cf1
  s_mov_b32 s55, s54
  s_lshr_b64 s[54:55], s[54:55], s0
  s_ff0_i32_b32 s56, s54
  s_add_u32 s0, s0, s56
  s_and_b32 s0, s0, 31
  s_lshl_b32 s56, 1, s0
  v_mov_b32 v35, s56
  buffer_atomic_or v35, v1, s[12:15], s57 offen sc0
  s_waitcnt vmcnt(0)
  v_readfirstlane_b32 s54, v35
  s_nop 0
  s_bitcmp1_b32 s54, s0
  s_cbranch_scc1 L_cf0
  v_mov_b32 v35, s0
  s_branch L_cf3
L_cf1:
  v_mov_b32 v35, 1
  buffer_atomic_add v35, v1, s[12:15], 0 offen offset:40 sc0
  s_waitcnt vmcnt(0)
  v_add_u32 v35, 32, v35
L_cf3:
  ds_write_b32 v33, v35
  s_mov_b64 exec, -1
  s_waitcnt lgkmcnt(0)
L_cf2:
  s_barrier
  ds_read_b32 v32, v33
  s_waitcnt lgkmcnt(0)
  v_readfirstlane_b32 s0, v32
  s_mov_b32 s1, 1
  s_cmp_lt_u32 s0, 32
  s_cbranch_scc1 L_role
  s_sub_u32 s53, s0, 32
  s_mov_b32 s57, 0
L_sur:
  s_load_dwordx16 s[60:75], s[12:13], 0 glc
  s_add_u32 s57, s57, 1
  s_waitcnt lgkmcnt(0)
  s_mov_b32 s55, s70
  s_bcnt1_i32_b32 s56, s60
  s_add_u32 s55, s55, s56
  s_bcnt1_i32_b32 s56, s61
  s_add_u32 s55, s55, s56
  s_bcnt1_i32_b32 s56, s62
  s_add_u32 s55, s55, s56
  s_bcnt1_i32_b32 s56, s63
  s_add_u32 s55, s55, s56
  s_bcnt1_i32_b32 s56, s64
  s_add_u32 s55, s55, s56
  s_bcnt1_i32_b32 s56, s65
  s_add_u32 s55, s55, s56
  s_bcnt1_i32_b32 s56, s66
  s_add_u32 s55, s55, s56
  s_bcnt1_i32_b32 s56, s67
  s_add_u32 s55, s55, s56
  s_cmp_ge_u32 s57, 131072
  s_cbranch_scc1 L_end
  s_cmp_lt_u32 s55, 256
  s_cbranch_scc1 L_sur
  s_mov_b32 s2, 0
  s_mov_b32 s54, s60
  s_bcnt0_i32_b32 s56, s54
  s_cmp_lt_u32 s53, s56
  s_cbranch_scc1 L_sur2
  s_sub_u32 s53, s53, s56
  s_mov_b32 s2, 1
  s_mov_b32 s54, s61
  s_bcnt0_i32_b32 s56, s54
  s_cmp_lt_u32 s53, s56
  s_cbranch_scc1 L_sur2
  s_sub_u32 s53, s53, s56
  s_mov_b32 s2, 2
  s_mov_b32 s54, s62
  s_bcnt0_i32_b32 s56, s54
  s_cmp_lt_u32 s53, s56
  s_cbranch_scc1 L_sur2
  s_sub_u32 s53, s53, s56
  s_mov_b32 s2, 3
  s_mov_b32 s54, s63
  s_bcnt0_i32_b32 s56, s54
  s_cmp_lt_u32 s53, s56
  s_cbranch_scc1 L_sur2
  s_sub_u32 s53, s53, s56
  s_mov_b32 s2, 4
  s_mov_b32 s54, s64
  s_bcnt0_i32_b32 s56, s54
  s_cmp_lt_u32 s53, s56
  s_cbranch_scc1 L_sur2
  s_sub_u32 s53, s53, s56
  s_mov_b32 s2, 5
  s_mov_b32 s54, s65
  s_bcnt0_i32_b32 s56, s54
  s_cmp_lt_u32 s53, s56
  s_cbranch_scc1 L_sur2
  s_sub_u32 s53, s53, s56
  s_mov_b32 s2, 6
  s_mov_b32 s54, s66
  s_bcnt0_i32_b32 s56, s54
  s_cmp_lt_u32 s53, s56
  s_cbranch_scc1 L_sur2
  s_sub_u32 s53, s53, s56
  s_mov_b32 s2, 7
  s_mov_b32 s54, s67
  s_bcnt0_i32_b32 s56, s54
  s_cmp_lt_u32 s53, s56
  s_cbranch_scc1 L_sur2
  s_sub_u32 s53, s53, s56
  s_branch L_end
L_sur2:
  s_ff0_i32_b32 s0, s54
  s_bitset1_b32 s54, s0
  s_sub_u32 s53, s53, 1
  s_cbranch_scc0 L_sur2
  s_branch L_role
L_worker:
  s_lshl_b32 s54, s2, 2
  s_lshr_b32 s54, 1412567136, s54
  s_and_b32 s54, s54, 7
  s_lshl_b32 s54, s54, 5
  s_add_u32 s53, s53, s54
  s_getpc_b64 s[80:81]
L_pc_2:
  s_and_b32 s55, s0, 1
  s_lshl_b32 s55, s55, 2
  s_add_u32 s55, s55, s52
  s_lshl_b32 s55, s55, 13
  v_and_b32 v199, 63, v0
  v_lshl_add_u32 v199, v199, 7, s55
  s_sub_u32 s82, s80, (L_pc_2 - L_w0)
  s_subb_u32 s83, s81, 0
  v_min_u32 v198, (L_w4 - L_w0), v199
  global_load_dword v196, v198, s[82:83]
  v_min_u32 v199, (L_end - L_pc_2), v199
  global_load_dword v196, v199, s[80:81]
  v_and_b32 v200, 63, v0
  v_lshlrev_b32 v201, 4, v200
  v_lshrrev_b32 v211, 3, v200
  s_lshl_b32 s54, s52, 3
  v_add_u32 v211, s54, v211
  v_bfe_u32 v212, v211, 1, 3
  v_and_b32 v213, 7, v200
  v_xor_b32 v212, v212, v213
  v_mul_u32_u24 v211, 1152, v211
  v_lshl_add_u32 v202, v212, 4, v211
  s_mul_i32 s67, s52, 9216
  v_and_b32 v211, 31, v200
  v_lshrrev_b32 v212, 3, v211
  v_mul_u32_u24 v212, 9216, v212
  v_and_b32 v213, 7, v211
  v_lshl_add_u32 v212, v213, 7, v212
  v_bfe_u32 v213, v211, 1, 3
  v_lshrrev_b32 v214, 5, v200
  v_xor_b32 v213, v213, v214
  v_lshl_add_u32 v203, v213, 4, v212
  v_xor_b32 v204, 32, v203
  v_xor_b32 v205, 64, v203
  v_xor_b32 v206, 0x60, v203
  v_bfe_u32 v211, v200, 2, 2
  v_lshl_add_u32 v212, v214, 3, v211
  v_lshlrev_b32 v212, 8, v212
  v_xor_b32 v211, s52, v211
  v_lshl_add_u32 v212, v211, 6, v212
  v_bfe_u32 v213, v200, 4, 1
  v_and_b32 v211, 3, v200
  v_lshl_add_u32 v210, v213, 5, v212
  v_lshl_add_u32 v210, v211, 3, v210
  v_lshl_add_u32 v209, v213, 4, v212
  v_and_b32 v213, 1, v211
  v_lshl_add_u32 v209, v213, 3, v209
  v_lshrrev_b32 v213, 1, v211
  v_lshl_add_u32 v209, v213, 5, v209
  s_mov_b32 s65, 0
  s_mul_i32 s58, s53, 9363
  s_lshr_b32 s58, s58, 16
  s_mul_i32 s54, s58, 7
  s_sub_u32 s59, s53, s54
  s_mul_i32 s60, s59, 36864
  s_add_u32 m0, s67, 0
  s_nop 0
  buffer_load_dwordx4 v202, s[4:7], s60 offen offset:0 lds
  s_add_u32 m0, s67, 896
  s_nop 0
  buffer_load_dwordx4 v202, s[4:7], s60 offen offset:128 lds
  s_add_u32 m0, s67, 1792
  s_nop 0
  buffer_load_dwordx4 v202, s[4:7], s60 offen offset:256 lds
  s_add_u32 m0, s67, 2688
  s_nop 0
  buffer_load_dwordx4 v202, s[4:7], s60 offen offset:384 lds
  s_add_u32 m0, s67, 3584
  s_nop 0
  buffer_load_dwordx4 v202, s[4:7], s60 offen offset:512 lds
  s_add_u32 m0, s67, 4480
  s_nop 0
  buffer_load_dwordx4 v202, s[4:7], s60 offen offset:640 lds
  s_add_u32 m0, s67, 5376
  s_nop 0
  buffer_load_dwordx4 v202, s[4:7], s60 offen offset:768 lds
  s_add_u32 m0, s67, 6272
  s_nop 0
  buffer_load_dwordx4 v202, s[4:7], s60 offen offset:896 lds
  s_add_u32 m0, s67, 7168
  s_nop 0
  buffer_load_dwordx4 v202, s[4:7], s60 offen offset:1024 lds
  v_lshrrev_b32 v211, 4, v200
  v_lshlrev_b32 v212, 2, v211
  v_and_b32 v213, 15, v200
  v_xor_b32 v212, v212, v213
  v_lshlrev_b32 v212, 4, v212
  v_lshl_add_u32 v207, v211, 13, v212
  s_lshl_b32 s62, s58, 8
  s_lshl_b32 s54, s52, 15
  s_add_u32 s62, s62, s54
  s_lshl_b32 s61, s52, 10
  s_add_u32 s61, s61, 36864
  s_add_u32 m0, s61, 0
  s_add_u32 s54, s62, 0
  buffer_load_dwordx4 v207, s[20:23], s54 offen lds
  s_add_u32 m0, s61, 4096
  s_add_u32 s54, s62, 131072
  buffer_load_dwordx4 v207, s[20:23], s54 offen lds
  s_add_u32 m0, s61, 8192
  s_add_u32 s54, s62, 262144
  buffer_load_dwordx4 v207, s[20:23], s54 offen lds
  s_add_u32 m0, s61, 12288
  s_add_u32 s54, s62, 393216
  buffer_load_dwordx4 v207, s[20:23], s54 offen lds
  s_add_u32 m0, s61, 16384
  s_add_u32 s54, s62, 0
  buffer_load_dwordx4 v207, s[24:27], s54 offen lds
  s_add_u32 m0, s61, 20480
  s_add_u32 s54, s62, 131072
  buffer_load_dwordx4 v207, s[24:27], s54 offen lds
  s_add_u32 m0, s61, 24576
  s_add_u32 s54, s62, 262144
  buffer_load_dwordx4 v207, s[24:27], s54 offen lds
  s_add_u32 m0, s61, 28672
  s_add_u32 s54, s62, 393216
  buffer_load_dwordx4 v207, s[24:27], s54 offen lds
  s_add_u32 m0, s61, 32768
  s_add_u32 s54, s62, 524288
  buffer_load_dwordx4 v207, s[20:23], s54 offen lds
  s_add_u32 m0, s61, 36864
  s_add_u32 s54, s62, 655360
  buffer_load_dwordx4 v207, s[20:23], s54 offen lds
  s_add_u32 m0, s61, 40960
  s_add_u32 s54, s62, 786432
  buffer_load_dwordx4 v207, s[20:23], s54 offen lds
  s_add_u32 m0, s61, 45056
  s_add_u32 s54, s62, 917504
  buffer_load_dwordx4 v207, s[20:23], s54 offen lds
  s_add_u32 m0, s61, 49152
  s_add_u32 s54, s62, 524288
  buffer_load_dwordx4 v207, s[24:27], s54 offen lds
  s_add_u32 m0, s61, 53248
  s_add_u32 s54, s62, 655360
  buffer_load_dwordx4 v207, s[24:27], s54 offen lds
  s_add_u32 m0, s61, 57344
  s_add_u32 s54, s62, 786432
  buffer_load_dwordx4 v207, s[24:27], s54 offen lds
  s_add_u32 m0, s61, 61440
  s_add_u32 s54, s62, 917504
  buffer_load_dwordx4 v207, s[24:27], s54 offen lds
  s_add_u32 m0, s61, 65536
  s_add_u32 s54, s62, 1048576
  buffer_load_dwordx4 v207, s[20:23], s54 offen lds
  s_add_u32 m0, s61, 69632
  s_add_u32 s54, s62, 1179648
  buffer_load_dwordx4 v207, s[20:23], s54 offen lds
  s_add_u32 m0, s61, 73728
  s_add_u32 s54, s62, 1310720
  buffer_load_dwordx4 v207, s[20:23], s54 offen lds
  s_add_u32 m0, s61, 77824
  s_add_u32 s54, s62, 1441792
  buffer_load_dwordx4 v207, s[20:23], s54 offen lds
  s_add_u32 m0, s61, 81920
  s_add_u32 s54, s62, 1048576
  buffer_load_dwordx4 v207, s[24:27], s54 offen lds
  s_add_u32 m0, s61, 86016
  s_add_u32 s54, s62, 1179648
  buffer_load_dwordx4 v207, s[24:27], s54 offen lds
  s_add_u32 m0, s61, 90112
  s_add_u32 s54, s62, 1310720
  buffer_load_dwordx4 v207, s[24:27], s54 offen lds
  s_add_u32 m0, s61, 94208
  s_add_u32 s54, s62, 1441792
  buffer_load_dwordx4 v207, s[24:27], s54 offen lds
  v_bfe_u32 v211, v200, 3, 2
  v_lshlrev_b32 v216, 11, v211
  v_bfe_u32 v211, v200, 1, 2
  v_lshl_add_u32 v216, v211, 6, v216
  v_lshrrev_b32 v212, 5, v200
  v_lshl_add_u32 v216, v212, 5, v216
  v_and_b32 v211, 1, v200
  v_lshl_add_u32 v216, v211, 4, v216
  v_bfe_u32 v211, v200, 4, 1
  v_lshlrev_b32 v217, 10, v211
  v_lshl_add_u32 v217, v212, 9, v217
  v_and_b32 v211, 15, v200
  v_lshl_add_u32 v217, v211, 4, v217
  s_lshl_b32 s54, s52, 11
  s_add_u32 s54, s54, 8192
  v_add_u32 v217, s54, v217
  s_cmp_eq_u32 s1, 1
  s_cbranch_scc1 W_ver_ok
  v_mov_b32 v33, 163832
  s_cmp_eq_u32 s52, 0
  s_cbranch_scc0 W_ver_b
  s_waitcnt vmcnt(35)
  s_mov_b64 exec, 1
  ds_write_b32 v33, v35
  s_mov_b64 exec, -1
  s_waitcnt lgkmcnt(0)
W_ver_b:
  s_barrier
  ds_read_b32 v32, v33
  s_waitcnt lgkmcnt(0)
  v_readfirstlane_b32 s54, v32
  s_nop 0
  s_bitcmp1_b32 s54, s0
  s_cbranch_scc1 L_conf
W_ver_ok:
  s_waitcnt vmcnt(20) lgkmcnt(0)
  s_barrier
  s_add_u32 m0, s61, 98304
  s_add_u32 s54, s62, 1572864
  buffer_load_dwordx4 v207, s[20:23], s54 offen lds
  s_add_u32 m0, s61, 102400
  s_add_u32 s54, s62, 1703936
  buffer_load_dwordx4 v207, s[20:23], s54 offen lds
  s_add_u32 m0, s61, 106496
  s_add_u32 s54, s62, 1835008
  buffer_load_dwordx4 v207, s[20:23], s54 offen lds
  s_add_u32 m0, s61, 110592
  s_add_u32 s54, s62, 1966080
  buffer_load_dwordx4 v207, s[20:23], s54 offen lds
  v_add_u32 v215, 36864, v209
  ds_read_b64_tr_b16 a[0:1], v215 offset:0
  ds_read_b64_tr_b16 a[2:3], v215 offset:1024
  ds_read_b64_tr_b16 a[4:5], v215 offset:4096
  ds_read_b64_tr_b16 a[6:7], v215 offset:5120
  ds_read_b64_tr_b16 a[8:9], v215 offset:8192
  ds_read_b64_tr_b16 a[10:11], v215 offset:9216
  ds_read_b64_tr_b16 a[12:13], v215 offset:12288
  ds_read_b64_tr_b16 a[14:15], v215 offset:13312
  s_waitcnt vmcnt(20) lgkmcnt(0)
  s_barrier
  s_add_u32 m0, s61, 0
  s_add_u32 s54, s62, 1572864
  buffer_load_dwordx4 v207, s[24:27], s54 offen lds
  s_add_u32 m0, s61, 4096
  s_add_u32 s54, s62, 1703936
  buffer_load_dwordx4 v207, s[24:27], s54 offen lds
  s_add_u32 m0, s61, 8192
  s_add_u32 s54, s62, 1835008
  buffer_load_dwordx4 v207, s[24:27], s54 offen lds
  s_add_u32 m0, s61, 12288
  s_add_u32 s54, s62, 1966080
  buffer_load_dwordx4 v207, s[24:27], s54 offen lds
  v_add_u32 v215, 53248, v210
  ds_read_b64_tr_b16 a[144:145], v215 offset:0
  ds_read_b64_tr_b16 a[146:147], v215 offset:1024
  ds_read_b64_tr_b16 a[148:149], v215 offset:4096
  ds_read_b64_tr_b16 a[150:151], v215 offset:5120
  ds_read_b64_tr_b16 a[152:153], v215 offset:8192
  ds_read_b64_tr_b16 a[154:155], v215 offset:9216
  ds_read_b64_tr_b16 a[156:157], v215 offset:12288
  ds_read_b64_tr_b16 a[158:159], v215 offset:13312
  s_waitcnt vmcnt(20) lgkmcnt(0)
  s_barrier
  s_add_u32 m0, s61, 16384
  s_add_u32 s54, s62, 2097152
  buffer_load_dwordx4 v207, s[20:23], s54 offen lds
  s_add_u32 m0, s61, 20480
  s_add_u32 s54, s62, 2228224
  buffer_load_dwordx4 v207, s[20:23], s54 offen lds
  s_add_u32 m0, s61, 24576
  s_add_u32 s54, s62, 2359296
  buffer_load_dwordx4 v207, s[20:23], s54 offen lds
  s_add_u32 m0, s61, 28672
  s_add_u32 s54, s62, 2490368
  buffer_load_dwordx4 v207, s[20:23], s54 offen lds
  v_add_u32 v215, 69632, v209
  ds_read_b64_tr_b16 a[16:17], v215 offset:0
  ds_read_b64_tr_b16 a[18:19], v215 offset:1024
  ds_read_b64_tr_b16 a[20:21], v215 offset:4096
  ds_read_b64_tr_b16 a[22:23], v215 offset:5120
  ds_read_b64_tr_b16 a[24:25], v215 offset:8192
  ds_read_b64_tr_b16 a[26:27], v215 offset:9216
  ds_read_b64_tr_b16 a[28:29], v215 offset:12288
  ds_read_b64_tr_b16 a[30:31], v215 offset:13312
  s_waitcnt vmcnt(20) lgkmcnt(0)
  s_barrier
  s_add_u32 m0, s61, 32768
  s_add_u32 s54, s62, 2097152
  buffer_load_dwordx4 v207, s[24:27], s54 offen lds
  s_add_u32 m0, s61, 36864
  s_add_u32 s54, s62, 2228224
  buffer_load_dwordx4 v207, s[24:27], s54 offen lds
  s_add_u32 m0, s61, 40960
  s_add_u32 s54, s62, 2359296
  buffer_load_dwordx4 v207, s[24:27], s54 offen lds
  s_add_u32 m0, s61, 45056
  s_add_u32 s54, s62, 2490368
  buffer_load_dwordx4 v207, s[24:27], s54 offen lds
  v_add_u32 v215, 86016, v210
  ds_read_b64_tr_b16 a[160:161], v215 offset:0
  ds_read_b64_tr_b16 a[162:163], v215 offset:1024
  ds_read_b64_tr_b16 a[164:165], v215 offset:4096
  ds_read_b64_tr_b16 a[166:167], v215 offset:5120
  ds_read_b64_tr_b16 a[168:169], v215 offset:8192
  ds_read_b64_tr_b16 a[170:171], v215 offset:9216
  ds_read_b64_tr_b16 a[172:173], v215 offset:12288
  ds_read_b64_tr_b16 a[174:175], v215 offset:13312
  s_waitcnt vmcnt(20) lgkmcnt(0)
  s_barrier
  s_add_u32 m0, s61, 49152
  s_add_u32 s54, s62, 2621440
  buffer_load_dwordx4 v207, s[20:23], s54 offen lds
  s_add_u32 m0, s61, 53248
  s_add_u32 s54, s62, 2752512
  buffer_load_dwordx4 v207, s[20:23], s54 offen lds
  s_add_u32 m0, s61, 57344
  s_add_u32 s54, s62, 2883584
  buffer_load_dwordx4 v207, s[20:23], s54 offen lds
  s_add_u32 m0, s61, 61440
  s_add_u32 s54, s62, 3014656
  buffer_load_dwordx4 v207, s[20:23], s54 offen lds
  v_add_u32 v215, 102400, v209
  ds_read_b64_tr_b16 a[32:33], v215 offset:0
  ds_read_b64_tr_b16 a[34:35], v215 offset:1024
  ds_read_b64_tr_b16 a[36:37], v215 offset:4096
  ds_read_b64_tr_b16 a[38:39], v215 offset:5120
  ds_read_b64_tr_b16 a[40:41], v215 offset:8192
  ds_read_b64_tr_b16 a[42:43], v215 offset:9216
  ds_read_b64_tr_b16 a[44:45], v215 offset:12288
  ds_read_b64_tr_b16 a[46:47], v215 offset:13312
  s_waitcnt vmcnt(20) lgkmcnt(0)
  s_barrier
  s_add_u32 m0, s61, 65536
  s_add_u32 s54, s62, 2621440
  buffer_load_dwordx4 v207, s[24:27], s54 offen lds
  s_add_u32 m0, s61, 69632
  s_add_u32 s54, s62, 2752512
  buffer_load_dwordx4 v207, s[24:27], s54 offen lds
  s_add_u32 m0, s61, 73728
  s_add_u32 s54, s62, 2883584
  buffer_load_dwordx4 v207, s[24:27], s54 offen lds
  s_add_u32 m0, s61, 77824
  s_add_u32 s54, s62, 3014656
  buffer_load_dwordx4 v207, s[24:27], s54 offen lds
  v_add_u32 v215, 118784, v210
  ds_read_b64_tr_b16 a[176:177], v215 offset:0
  ds_read_b64_tr_b16 a[178:179], v215 offset:1024
  ds_read_b64_tr_b16 a[180:181], v215 offset:4096
  ds_read_b64_tr_b16 a[182:183], v215 offset:5120
  ds_read_b64_tr_b16 a[184:185], v215 offset:8192
  ds_read_b64_tr_b16 a[186:187], v215 offset:9216
  ds_read_b64_tr_b16 a[188:189], v215 offset:12288
  ds_read_b64_tr_b16 a[190:191], v215 offset:13312
  s_waitcnt vmcnt(20) lgkmcnt(0)
  s_barrier
  s_add_u32 m0, s61, 81920
  s_add_u32 s54, s62, 3145728
  buffer_load_dwordx4 v207, s[20:23], s54 offen lds
  s_add_u32 m0, s61, 86016
  s_add_u32 s54, s62, 3276800
  buffer_load_dwordx4 v207, s[20:23], s54 offen lds
  s_add_u32 m0, s61, 90112
  s_add_u32 s54, s62, 3407872
  buffer_load_dwordx4 v207, s[20:23], s54 offen lds
  s_add_u32 m0, s61, 94208
  s_add_u32 s54, s62, 3538944
  buffer_load_dwordx4 v207, s[20:23], s54 offen lds
  v_add_u32 v215, 135168, v209
  ds_read_b64_tr_b16 a[48:49], v215 offset:0
  ds_read_b64_tr_b16 a[50:51], v215 offset:1024
  ds_read_b64_tr_b16 a[52:53], v215 offset:4096
  ds_read_b64_tr_b16 a[54:55], v215 offset:5120
  ds_read_b64_tr_b16 a[56:57], v215 offset:8192
  ds_read_b64_tr_b16 a[58:59], v215 offset:9216
  ds_read_b64_tr_b16 a[60:61], v215 offset:12288
  ds_read_b64_tr_b16 a[62:63], v215 offset:13312
  s_waitcnt vmcnt(20) lgkmcnt(0)
  s_barrier
  s_add_u32 m0, s61, 98304
  s_add_u32 s54, s62, 3145728
  buffer_load_dwordx4 v207, s[24:27], s54 offen lds
  s_add_u32 m0, s61, 102400
  s_add_u32 s54, s62, 3276800
  buffer_load_dwordx4 v207, s[24:27], s54 offen lds
  s_add_u32 m0, s61, 106496
  s_add_u32 s54, s62, 3407872
  buffer_load_dwordx4 v207, s[24:27], s54 offen lds
  s_add_u32 m0, s61, 110592
  s_add_u32 s54, s62, 3538944
  buffer_load_dwordx4 v207, s[24:27], s54 offen lds
  v_add_u32 v215, 36864, v210
  ds_read_b64_tr_b16 a[192:193], v215 offset:0
  ds_read_b64_tr_b16 a[194:195], v215 offset:1024
  ds_read_b64_tr_b16 a[196:197], v215 offset:4096
  ds_read_b64_tr_b16 a[198:199], v215 offset:5120
  ds_read_b64_tr_b16 a[200:201], v215 offset:8192
  ds_read_b64_tr_b16 a[202:203], v215 offset:9216
  ds_read_b64_tr_b16 a[204:205], v215 offset:12288
  ds_read_b64_tr_b16 a[206:207], v215 offset:13312
  s_waitcnt vmcnt(20) lgkmcnt(0)
  s_barrier
  s_add_u32 m0, s61, 0
  s_add_u32 s54, s62, 3670016
  buffer_load_dwordx4 v207, s[20:23], s54 offen lds
  s_add_u32 m0, s61, 4096
  s_add_u32 s54, s62, 3801088
  buffer_load_dwordx4 v207, s[20:23], s54 offen lds
  s_add_u32 m0, s61, 8192
  s_add_u32 s54, s62, 3932160
  buffer_load_dwordx4 v207, s[20:23], s54 offen lds
  s_add_u32 m0, s61, 12288
  s_add_u32 s54, s62, 4063232
  buffer_load_dwordx4 v207, s[20:23], s54 offen lds
  v_add_u32 v215, 53248, v209
  ds_read_b64_tr_b16 a[64:65], v215 offset:0
  ds_read_b64_tr_b16 a[66:67], v215 offset:1024
  ds_read_b64_tr_b16 a[68:69], v215 offset:4096
  ds_read_b64_tr_b16 a[70:71], v215 offset:5120
  ds_read_b64_tr_b16 a[72:73], v215 offset:8192
  ds_read_b64_tr_b16 a[74:75], v215 offset:9216
  ds_read_b64_tr_b16 a[76:77], v215 offset:12288
  ds_read_b64_tr_b16 a[78:79], v215 offset:13312
  s_waitcnt vmcnt(20) lgkmcnt(0)
  s_barrier
  s_add_u32 m0, s61, 16384
  s_add_u32 s54, s62, 3670016
  buffer_load_dwordx4 v207, s[24:27], s54 offen lds
  s_add_u32 m0, s61, 20480
  s_add_u32 s54, s62, 3801088
  buffer_load_dwordx4 v207, s[24:27], s54 offen lds
  s_add_u32 m0, s61, 24576
  s_add_u32 s54, s62, 3932160
  buffer_load_dwordx4 v207, s[24:27], s54 offen lds
  s_add_u32 m0, s61, 28672
  s_add_u32 s54, s62, 4063232
  buffer_load_dwordx4 v207, s[24:27], s54 offen lds
  v_add_u32 v215, 69632, v210
  ds_read_b64_tr_b16 a[208:209], v215 offset:0
  ds_read_b64_tr_b16 a[210:211], v215 offset:1024
  ds_read_b64_tr_b16 a[212:213], v215 offset:4096
  ds_read_b64_tr_b16 a[214:215], v215 offset:5120
  ds_read_b64_tr_b16 a[216:217], v215 offset:8192
  ds_read_b64_tr_b16 a[218:219], v215 offset:9216
  ds_read_b64_tr_b16 a[220:221], v215 offset:12288
  ds_read_b64_tr_b16 a[222:223], v215 offset:13312
  s_waitcnt vmcnt(20) lgkmcnt(0)
  s_barrier
  s_add_u32 m0, s61, 32768
  s_add_u32 s54, s62, 4194304
  buffer_load_dwordx4 v207, s[20:23], s54 offen lds
  s_add_u32 m0, s61, 36864
  s_add_u32 s54, s62, 4325376
  buffer_load_dwordx4 v207, s[20:23], s54 offen lds
  s_add_u32 m0, s61, 40960
  s_add_u32 s54, s62, 4456448
  buffer_load_dwordx4 v207, s[20:23], s54 offen lds
  s_add_u32 m0, s61, 45056
  s_add_u32 s54, s62, 4587520
  buffer_load_dwordx4 v207, s[20:23], s54 offen lds
  v_add_u32 v215, 86016, v209
  ds_read_b64_tr_b16 a[80:81], v215 offset:0
  ds_read_b64_tr_b16 a[82:83], v215 offset:1024
  ds_read_b64_tr_b16 a[84:85], v215 offset:4096
  ds_read_b64_tr_b16 a[86:87], v215 offset:5120
  ds_read_b64_tr_b16 a[88:89], v215 offset:8192
  ds_read_b64_tr_b16 a[90:91], v215 offset:9216
  ds_read_b64_tr_b16 a[92:93], v215 offset:12288
  ds_read_b64_tr_b16 a[94:95], v215 offset:13312
  s_waitcnt vmcnt(20) lgkmcnt(0)
  s_barrier
  s_add_u32 m0, s61, 49152
  s_add_u32 s54, s62, 4194304
  buffer_load_dwordx4 v207, s[24:27], s54 offen lds
  s_add_u32 m0, s61, 53248
  s_add_u32 s54, s62, 4325376
  buffer_load_dwordx4 v207, s[24:27], s54 offen lds
  s_add_u32 m0, s61, 57344
  s_add_u32 s54, s62, 4456448
  buffer_load_dwordx4 v207, s[24:27], s54 offen lds
  s_add_u32 m0, s61, 61440
  s_add_u32 s54, s62, 4587520
  buffer_load_dwordx4 v207, s[24:27], s54 offen lds
  s_mul_i32 s54, s53, 21120
  s_lshl_b32 s55, s52, 13
  s_add_u32 s54, s54, s55
  s_cmp_eq_u32 s52, 3
  s_cselect_b32 s54, 0x10000000, s54
  v_lshlrev_b32 v211, 3, v201
  buffer_load_dword v196, v211, s[28:31], s54 offen
  v_add_u32 v215, 102400, v210
  ds_read_b64_tr_b16 a[224:225], v215 offset:0
  ds_read_b64_tr_b16 a[226:227], v215 offset:1024
  ds_read_b64_tr_b16 a[228:229], v215 offset:4096
  ds_read_b64_tr_b16 a[230:231], v215 offset:5120
  ds_read_b64_tr_b16 a[232:233], v215 offset:8192
  ds_read_b64_tr_b16 a[234:235], v215 offset:9216
  ds_read_b64_tr_b16 a[236:237], v215 offset:12288
  ds_read_b64_tr_b16 a[238:239], v215 offset:13312
  s_waitcnt vmcnt(21) lgkmcnt(0)
  s_barrier
  s_lshl_b32 s54, s53, 13
  s_lshr_b32 s55, s53, 6
  s_or_b32 s55, s55, s52
  s_cmp_eq_u32 s55, 0
  s_cselect_b32 s54, s54, 0x10000000
  v_lshlrev_b32 v211, 3, v201
  buffer_load_dword v196, v211, s[16:19], s54 offen
  v_add_u32 v215, 118784, v209
  ds_read_b64_tr_b16 a[96:97], v215 offset:0
  ds_read_b64_tr_b16 a[98:99], v215 offset:1024
  ds_read_b64_tr_b16 a[100:101], v215 offset:4096
  ds_read_b64_tr_b16 a[102:103], v215 offset:5120
  ds_read_b64_tr_b16 a[104:105], v215 offset:8192
  ds_read_b64_tr_b16 a[106:107], v215 offset:9216
  ds_read_b64_tr_b16 a[108:109], v215 offset:12288
  ds_read_b64_tr_b16 a[110:111], v215 offset:13312
  s_waitcnt vmcnt(18) lgkmcnt(0)
  s_barrier
  v_add_u32 v215, 135168, v210
  ds_read_b64_tr_b16 a[240:241], v215 offset:0
  ds_read_b64_tr_b16 a[242:243], v215 offset:1024
  ds_read_b64_tr_b16 a[244:245], v215 offset:4096
  ds_read_b64_tr_b16 a[246:247], v215 offset:5120
  ds_read_b64_tr_b16 a[248:249], v215 offset:8192
  ds_read_b64_tr_b16 a[250:251], v215 offset:9216
  ds_read_b64_tr_b16 a[252:253], v215 offset:12288
  ds_read_b64_tr_b16 a[254:255], v215 offset:13312
  s_waitcnt vmcnt(14) lgkmcnt(0)
  s_barrier
  v_add_u32 v215, 36864, v209
  ds_read_b64_tr_b16 a[112:113], v215 offset:0
  ds_read_b64_tr_b16 a[114:115], v215 offset:1024
  ds_read_b64_tr_b16 a[116:117], v215 offset:4096
  ds_read_b64_tr_b16 a[118:119], v215 offset:5120
  ds_read_b64_tr_b16 a[120:121], v215 offset:8192
  ds_read_b64_tr_b16 a[122:123], v215 offset:9216
  ds_read_b64_tr_b16 a[124:125], v215 offset:12288
  ds_read_b64_tr_b16 a[126:127], v215 offset:13312
  s_waitcnt vmcnt(10) lgkmcnt(0)
  s_barrier
  v_add_u32 v215, 53248, v210
  ds_read_b64_tr_b16 v[224:225], v215 offset:0
  ds_read_b64_tr_b16 v[226:227], v215 offset:1024
  ds_read_b64_tr_b16 v[228:229], v215 offset:4096
  ds_read_b64_tr_b16 v[230:231], v215 offset:5120
  ds_read_b64_tr_b16 v[232:233], v215 offset:8192
  ds_read_b64_tr_b16 v[234:235], v215 offset:9216
  ds_read_b64_tr_b16 v[236:237], v215 offset:12288
  ds_read_b64_tr_b16 v[238:239], v215 offset:13312
  s_waitcnt vmcnt(6) lgkmcnt(0)
  s_barrier
  v_add_u32 v215, 69632, v209
  ds_read_b64_tr_b16 a[128:129], v215 offset:0
  ds_read_b64_tr_b16 a[130:131], v215 offset:1024
  ds_read_b64_tr_b16 a[132:133], v215 offset:4096
  ds_read_b64_tr_b16 a[134:135], v215 offset:5120
  ds_read_b64_tr_b16 a[136:137], v215 offset:8192
  ds_read_b64_tr_b16 a[138:139], v215 offset:9216
  ds_read_b64_tr_b16 a[140:141], v215 offset:12288
  ds_read_b64_tr_b16 a[142:143], v215 offset:13312
  s_waitcnt vmcnt(2) lgkmcnt(0)
  s_barrier
  v_add_u32 v215, 86016, v210
  ds_read_b64_tr_b16 v[240:241], v215 offset:0
  ds_read_b64_tr_b16 v[242:243], v215 offset:1024
  ds_read_b64_tr_b16 v[244:245], v215 offset:4096
  ds_read_b64_tr_b16 v[246:247], v215 offset:5120
  ds_read_b64_tr_b16 v[248:249], v215 offset:8192
  ds_read_b64_tr_b16 v[250:251], v215 offset:9216
  ds_read_b64_tr_b16 v[252:253], v215 offset:12288
  ds_read_b64_tr_b16 v[254:255], v215 offset:13312
  s_waitcnt lgkmcnt(0)
  s_barrier
  s_lshr_b32 s55, s53, 1
  s_and_b32 s56, s53, 1
  s_lshl_b32 s56, s56, 7
  s_lshl_b32 s55, s55, 2
  s_add_u32 s55, s55, s56
  s_add_u32 s55, s55, 356352
  s_cmp_lt_u32 s53, 64
  s_cselect_b32 s71, s55, 268435456
  v_mov_b32 v211, 0
  s_mov_b64 exec, 1
  buffer_store_dword v211, v211, s[8:11], s71 offen sc1
  s_mov_b64 exec, -1
  s_mov_b32 s68, 1040356334
  s_lshl_b32 s69, s52, 9
  s_lshl_b32 s70, s58, 2
  s_add_u32 s70, s70, 128
  s_mul_i32 s66, s58, -12288
  s_lshl_b32 s54, s52, 10
  s_add_u32 s66, s66, s54
  s_add_u32 s66, s66, 524288
  v_mov_b32 v64, -1
  v_mov_b32 v65, -1
  v_mov_b32 v66, -1
  v_mov_b32 v67, -1
  s_cmp_eq_u32 s59, 0
  s_cbranch_scc0 KV_na
  s_mul_i32 s54, s58, 2176
  s_mul_i32 s55, s52, 69632
  s_add_u32 s55, s55, s54
  s_add_u32 s55, s55, 0
  s_add_u32 s54, s54, 278528
  s_lshl_b32 s56, s58, 14
  s_mul_i32 s57, s52, 3072
  s_add_u32 s56, s56, s57
  s_add_u32 s56, s56, 360448
  s_cmp_lt_u32 s58, 2
  s_cselect_b32 s56, s56, 268435456
  s_cmp_eq_u32 s52, 0
  s_cselect_b32 s54, s54, 268435456
  buffer_store_dwordx4 v[64:67], v201, s[8:11], s55 offen offset:0 sc1
  buffer_store_dwordx4 v[64:67], v201, s[8:11], s55 offen offset:1024 sc1
  buffer_store_dwordx4 v[64:67], v201, s[8:11], s54 offen offset:0 sc1
  buffer_store_dwordx4 v[64:67], v201, s[8:11], s54 offen offset:1024 sc1
  buffer_store_dwordx4 v[64:67], v201, s[8:11], s56 offen offset:0 sc1
  buffer_store_dwordx4 v[64:67], v201, s[8:11], s56 offen offset:1024 sc1
  buffer_store_dwordx4 v[64:67], v201, s[8:11], s56 offen offset:2048 sc1
KV_na:
  s_add_u32 s60, s60, 258048
  ds_read_b128 v[32:35], v203 offset:0
  ds_read_b128 v[36:39], v204 offset:0
  ds_read_b128 v[40:43], v205 offset:0
  s_waitcnt lgkmcnt(2)
  v_mfma_f32_32x32x16_bf16 v[0:15], a[0:3], v[32:35], 0
  ds_read_b128 v[44:47], v206 offset:0
  s_add_u32 m0, s67, 36864
  s_nop 0
  buffer_load_dwordx4 v202, s[4:7], s60 offen offset:0 lds
  v_mfma_f32_32x32x16_bf16 v[16:31], v[32:35], a[144:147], 0
  s_waitcnt lgkmcnt(2)
  v_mfma_f32_32x32x16_bf16 v[0:15], a[4:7], v[36:39], v[0:15]
  ds_read_b128 v[32:35], v203 offset:1024
  s_add_u32 m0, s67, 37760
  s_nop 0
  buffer_load_dwordx4 v202, s[4:7], s60 offen offset:128 lds
  v_mfma_f32_32x32x16_bf16 v[16:31], v[36:39], a[148:151], v[16:31]
  s_waitcnt lgkmcnt(2)
  v_mfma_f32_32x32x16_bf16 v[0:15], a[8:11], v[40:43], v[0:15]
  ds_read_b128 v[36:39], v204 offset:1024
  s_add_u32 m0, s67, 38656
  s_nop 0
  buffer_load_dwordx4 v202, s[4:7], s60 offen offset:256 lds
  v_mfma_f32_32x32x16_bf16 v[16:31], v[40:43], a[152:155], v[16:31]
  s_waitcnt lgkmcnt(2)
  v_mfma_f32_32x32x16_bf16 v[0:15], a[12:15], v[44:47], v[0:15]
  ds_read_b128 v[40:43], v205 offset:1024
  s_add_u32 m0, s67, 39552
  s_nop 0
  buffer_load_dwordx4 v202, s[4:7], s60 offen offset:384 lds
  v_mfma_f32_32x32x16_bf16 v[16:31], v[44:47], a[156:159], v[16:31]
  s_waitcnt lgkmcnt(2)
  v_mfma_f32_32x32x16_bf16 v[0:15], a[16:19], v[32:35], v[0:15]
  ds_read_b128 v[44:47], v206 offset:1024
  s_add_u32 m0, s67, 40448
  s_nop 0
  buffer_load_dwordx4 v202, s[4:7], s60 offen offset:512 lds
  v_mfma_f32_32x32x16_bf16 v[16:31], v[32:35], a[160:163], v[16:31]
  s_waitcnt lgkmcnt(2)
  v_mfma_f32_32x32x16_bf16 v[0:15], a[20:23], v[36:39], v[0:15]
  ds_read_b128 v[32:35], v203 offset:2048
  s_add_u32 m0, s67, 41344
  s_nop 0
  buffer_load_dwordx4 v202, s[4:7], s60 offen offset:640 lds
  v_mfma_f32_32x32x16_bf16 v[16:31], v[36:39], a[164:167], v[16:31]
  s_waitcnt lgkmcnt(2)
  v_mfma_f32_32x32x16_bf16 v[0:15], a[24:27], v[40:43], v[0:15]
  ds_read_b128 v[36:39], v204 offset:2048
  s_add_u32 m0, s67, 42240
  s_nop 0
  buffer_load_dwordx4 v202, s[4:7], s60 offen offset:768 lds
  v_mfma_f32_32x32x16_bf16 v[16:31], v[40:43], a[168:171], v[16:31]
  s_waitcnt lgkmcnt(2)
  v_mfma_f32_32x32x16_bf16 v[0:15], a[28:31], v[44:47], v[0:15]
  ds_read_b128 v[40:43], v205 offset:2048
  s_add_u32 m0, s67, 43136
  s_nop 0
  buffer_load_dwordx4 v202, s[4:7], s60 offen offset:896 lds
  v_mfma_f32_32x32x16_bf16 v[16:31], v[44:47], a[172:175], v[16:31]
  s_waitcnt lgkmcnt(2)
  v_mfma_f32_32x32x16_bf16 v[0:15], a[32:35], v[32:35], v[0:15]
  ds_read_b128 v[44:47], v206 offset:2048
  s_add_u32 m0, s67, 44032
  s_nop 0
  buffer_load_dwordx4 v202, s[4:7], s60 offen offset:1024 lds
  v_mfma_f32_32x32x16_bf16 v[16:31], v[32:35], a[176:179], v[16:31]
  s_waitcnt lgkmcnt(2)
  v_mfma_f32_32x32x16_bf16 v[0:15], a[36:39], v[36:39], v[0:15]
  ds_read_b128 v[32:35], v203 offset:3072
  v_mfma_f32_32x32x16_bf16 v[16:31], v[36:39], a[180:183], v[16:31]
  s_waitcnt lgkmcnt(2)
  v_mfma_f32_32x32x16_bf16 v[0:15], a[40:43], v[40:43], v[0:15]
  ds_read_b128 v[36:39], v204 offset:3072
  v_mfma_f32_32x32x16_bf16 v[16:31], v[40:43], a[184:187], v[16:31]
  s_waitcnt lgkmcnt(2)
  v_mfma_f32_32x32x16_bf16 v[0:15], a[44:47], v[44:47], v[0:15]
  ds_read_b128 v[40:43], v205 offset:3072
  v_mfma_f32_32x32x16_bf16 v[16:31], v[44:47], a[188:191], v[16:31]
  s_waitcnt lgkmcnt(2)
  v_mfma_f32_32x32x16_bf16 v[0:15], a[48:51], v[32:35], v[0:15]
  ds_read_b128 v[44:47], v206 offset:3072
  v_mfma_f32_32x32x16_bf16 v[16:31], v[32:35], a[192:195], v[16:31]
  s_waitcnt lgkmcnt(2)
  v_mfma_f32_32x32x16_bf16 v[0:15], a[52:55], v[36:39], v[0:15]
  ds_read_b128 v[32:35], v203 offset:4096
  v_mfma_f32_32x32x16_bf16 v[16:31], v[36:39], a[196:199], v[16:31]
  s_waitcnt lgkmcnt(2)
  v_mfma_f32_32x32x16_bf16 v[0:15], a[56:59], v[40:43], v[0:15]
  ds_read_b128 v[36:39], v204 offset:4096
  v_mfma_f32_32x32x16_bf16 v[16:31], v[40:43], a[200:203], v[16:31]
  s_waitcnt lgkmcnt(2)
  v_mfma_f32_32x32x16_bf16 v[0:15], a[60:63], v[44:47], v[0:15]
  ds_read_b128 v[40:43], v205 offset:4096
  v_mfma_f32_32x32x16_bf16 v[16:31], v[44:47], a[204:207], v[16:31]
  s_waitcnt lgkmcnt(2)
  v_mfma_f32_32x32x16_bf16 v[0:15], a[64:67], v[32:35], v[0:15]
  ds_read_b128 v[44:47], v206 offset:4096
  v_mfma_f32_32x32x16_bf16 v[16:31], v[32:35], a[208:211], v[16:31]
  s_waitcnt lgkmcnt(2)
  v_mfma_f32_32x32x16_bf16 v[0:15], a[68:71], v[36:39], v[0:15]
  ds_read_b128 v[32:35], v203 offset:5120
  v_mfma_f32_32x32x16_bf16 v[16:31], v[36:39], a[212:215], v[16:31]
  s_waitcnt lgkmcnt(2)
  v_mfma_f32_32x32x16_bf16 v[0:15], a[72:75], v[40:43], v[0:15]
  ds_read_b128 v[36:39], v204 offset:5120
  v_mfma_f32_32x32x16_bf16 v[16:31], v[40:43], a[216:219], v[16:31]
  s_waitcnt lgkmcnt(2)
  v_mfma_f32_32x32x16_bf16 v[0:15], a[76:79], v[44:47], v[0:15]
  ds_read_b128 v[40:43], v205 offset:5120
  v_mfma_f32_32x32x16_bf16 v[16:31], v[44:47], a[220:223], v[16:31]
  s_waitcnt lgkmcnt(2)
  v_mfma_f32_32x32x16_bf16 v[0:15], a[80:83], v[32:35], v[0:15]
  ds_read_b128 v[44:47], v206 offset:5120
  v_mfma_f32_32x32x16_bf16 v[16:31], v[32:35], a[224:227], v[16:31]
  s_waitcnt lgkmcnt(2)
  v_mfma_f32_32x32x16_bf16 v[0:15], a[84:87], v[36:39], v[0:15]
  ds_read_b128 v[32:35], v203 offset:6144
  v_mfma_f32_32x32x16_bf16 v[16:31], v[36:39], a[228:231], v[16:31]
  s_waitcnt lgkmcnt(2)
  v_mfma_f32_32x32x16_bf16 v[0:15], a[88:91], v[40:43], v[0:15]
  ds_read_b128 v[36:39], v204 offset:6144
  v_mfma_f32_32x32x16_bf16 v[16:31], v[40:43], a[232:235], v[16:31]
  s_waitcnt lgkmcnt(2)
  v_mfma_f32_32x32x16_bf16 v[0:15], a[92:95], v[44:47], v[0:15]
  ds_read_b128 v[40:43], v205 offset:6144
  v_mfma_f32_32x32x16_bf16 v[16:31], v[44:47], a[236:239], v[16:31]
  s_waitcnt lgkmcnt(2)
  v_mfma_f32_32x32x16_bf16 v[0:15], a[96:99], v[32:35], v[0:15]
  ds_read_b128 v[44:47], v206 offset:6144
  v_mfma_f32_32x32x16_bf16 v[16:31], v[32:35], a[240:243], v[16:31]
  s_waitcnt lgkmcnt(2)
  v_mfma_f32_32x32x16_bf16 v[0:15], a[100:103], v[36:39], v[0:15]
  ds_read_b128 v[32:35], v203 offset:7168
  v_mfma_f32_32x32x16_bf16 v[16:31], v[36:39], a[244:247], v[16:31]
  s_waitcnt lgkmcnt(2)
  v_mfma_f32_32x32x16_bf16 v[0:15], a[104:107], v[40:43], v[0:15]
  ds_read_b128 v[36:39], v204 offset:7168
  v_mfma_f32_32x32x16_bf16 v[16:31], v[40:43], a[248:251], v[16:31]
  s_waitcnt lgkmcnt(2)
  v_mfma_f32_32x32x16_bf16 v[0:15], a[108:111], v[44:47], v[0:15]
  ds_read_b128 v[40:43], v205 offset:7168
  v_mfma_f32_32x32x16_bf16 v[16:31], v[44:47], a[252:255], v[16:31]
  s_waitcnt lgkmcnt(2)
  v_mfma_f32_32x32x16_bf16 v[0:15], a[112:115], v[32:35], v[0:15]
  ds_read_b128 v[44:47], v206 offset:7168
  v_mfma_f32_32x32x16_bf16 v[16:31], v[32:35], v[224:227], v[16:31]
  s_waitcnt lgkmcnt(2)
  v_mfma_f32_32x32x16_bf16 v[0:15], a[116:119], v[36:39], v[0:15]
  ds_read_b128 v[32:35], v203 offset:8192
  v_mfma_f32_32x32x16_bf16 v[16:31], v[36:39], v[228:231], v[16:31]
  s_waitcnt lgkmcnt(2)
  v_mfma_f32_32x32x16_bf16 v[0:15], a[120:123], v[40:43], v[0:15]
  ds_read_b128 v[36:39], v204 offset:8192
  v_mfma_f32_32x32x16_bf16 v[16:31], v[40:43], v[232:235], v[16:31]
  s_waitcnt lgkmcnt(2)
  v_mfma_f32_32x32x16_bf16 v[0:15], a[124:127], v[44:47], v[0:15]
  ds_read_b128 v[40:43], v205 offset:8192
  v_mfma_f32_32x32x16_bf16 v[16:31], v[44:47], v[236:239], v[16:31]
  s_waitcnt lgkmcnt(2)
  v_mfma_f32_32x32x16_bf16 v[0:15], a[128:131], v[32:35], v[0:15]
  ds_read_b128 v[44:47], v206 offset:8192
  v_mfma_f32_32x32x16_bf16 v[16:31], v[32:35], v[240:243], v[16:31]
  s_waitcnt lgkmcnt(2)
  v_mfma_f32_32x32x16_bf16 v[0:15], a[132:135], v[36:39], v[0:15]
  v_mfma_f32_32x32x16_bf16 v[16:31], v[36:39], v[244:247], v[16:31]
  s_waitcnt lgkmcnt(1)
  v_mfma_f32_32x32x16_bf16 v[0:15], a[136:139], v[40:43], v[0:15]
  v_mfma_f32_32x32x16_bf16 v[16:31], v[40:43], v[248:251], v[16:31]
  s_waitcnt lgkmcnt(0)
  v_mfma_f32_32x32x16_bf16 v[0:15], a[140:143], v[44:47], v[0:15]
  v_mfma_f32_32x32x16_bf16 v[16:31], v[44:47], v[252:255], v[16:31]
  s_mul_i32 s64, s59, 655360
  s_lshl_b32 s55, s58, 14
  s_add_u32 s64, s64, s55
  s_add_u32 s64, s64, 1048576
  s_add_u32 s72, s64, s69
  s_add_u32 s73, s64, s66
  s_add_u32 s59, s59, 7
  s_waitcnt vmcnt(0)
  s_barrier
KV_loop:
  s_add_u32 s60, s60, 258048
  ds_read_b128 v[32:35], v203 offset:36864
  ds_read_b128 v[36:39], v204 offset:36864
  ds_read_b128 v[40:43], v205 offset:36864
  s_waitcnt lgkmcnt(2)
  v_mfma_f32_32x32x16_bf16 v[68:83], a[0:3], v[32:35], 0
  ds_read_b128 v[44:47], v206 offset:36864
  s_add_u32 m0, s67, 0
  s_nop 0
  buffer_load_dwordx4 v202, s[4:7], s60 offen offset:0 lds
  v_mfma_f32_32x32x16_bf16 v[84:99], v[32:35], a[144:147], 0
  s_waitcnt lgkmcnt(2)
  v_mfma_f32_32x32x16_bf16 v[68:83], a[4:7], v[36:39], v[68:83]
  ds_read_b128 v[32:35], v203 offset:37888
  s_add_u32 m0, s67, 896
  s_nop 0
  buffer_load_dwordx4 v202, s[4:7], s60 offen offset:128 lds
  v_mfma_f32_32x32x16_bf16 v[84:99], v[36:39], a[148:151], v[84:99]
  s_waitcnt lgkmcnt(2)
  v_mfma_f32_32x32x16_bf16 v[68:83], a[8:11], v[40:43], v[68:83]
  ds_read_b128 v[36:39], v204 offset:37888
  s_add_u32 m0, s67, 1792
  s_nop 0
  buffer_load_dwordx4 v202, s[4:7], s60 offen offset:256 lds
  v_mfma_f32_32x32x16_bf16 v[84:99], v[40:43], a[152:155], v[84:99]
  s_waitcnt lgkmcnt(2)
  v_mfma_f32_32x32x16_bf16 v[68:83], a[12:15], v[44:47], v[68:83]
  ds_read_b128 v[40:43], v205 offset:37888
  s_add_u32 m0, s67, 2688
  s_nop 0
  buffer_load_dwordx4 v202, s[4:7], s60 offen offset:384 lds
  v_mfma_f32_32x32x16_bf16 v[84:99], v[44:47], a[156:159], v[84:99]
  s_waitcnt lgkmcnt(2)
  v_mfma_f32_32x32x16_bf16 v[68:83], a[16:19], v[32:35], v[68:83]
  ds_read_b128 v[44:47], v206 offset:37888
  s_add_u32 m0, s67, 3584
  s_nop 0
  buffer_load_dwordx4 v202, s[4:7], s60 offen offset:512 lds
  v_mfma_f32_32x32x16_bf16 v[84:99], v[32:35], a[160:163], v[84:99]
  s_waitcnt lgkmcnt(2)
  v_mfma_f32_32x32x16_bf16 v[68:83], a[20:23], v[36:39], v[68:83]
  ds_read_b128 v[32:35], v203 offset:38912
  s_add_u32 m0, s67, 4480
  s_nop 0
  buffer_load_dwordx4 v202, s[4:7], s60 offen offset:640 lds
  v_mfma_f32_32x32x16_bf16 v[84:99], v[36:39], a[164:167], v[84:99]
  s_waitcnt lgkmcnt(2)
  v_mfma_f32_32x32x16_bf16 v[68:83], a[24:27], v[40:43], v[68:83]
  ds_read_b128 v[36:39], v204 offset:38912
  s_add_u32 m0, s67, 5376
  s_nop 0
  buffer_load_dwordx4 v202, s[4:7], s60 offen offset:768 lds
  v_mfma_f32_32x32x16_bf16 v[84:99], v[40:43], a[168:171], v[84:99]
  s_waitcnt lgkmcnt(2)
  v_mfma_f32_32x32x16_bf16 v[68:83], a[28:31], v[44:47], v[68:83]
  ds_read_b128 v[40:43], v205 offset:38912
  s_add_u32 m0, s67, 6272
  s_nop 0
  buffer_load_dwordx4 v202, s[4:7], s60 offen offset:896 lds
  v_mfma_f32_32x32x16_bf16 v[84:99], v[44:47], a[172:175], v[84:99]
  s_waitcnt lgkmcnt(2)
  v_mfma_f32_32x32x16_bf16 v[68:83], a[32:35], v[32:35], v[68:83]
  ds_read_b128 v[44:47], v206 offset:38912
  s_add_u32 m0, s67, 7168
  s_nop 0
  buffer_load_dwordx4 v202, s[4:7], s60 offen offset:1024 lds
  v_mfma_f32_32x32x16_bf16 v[84:99], v[32:35], a[176:179], v[84:99]
  s_waitcnt lgkmcnt(2)
  v_mfma_f32_32x32x16_bf16 v[68:83], a[36:39], v[36:39], v[68:83]
  ds_read_b128 v[32:35], v203 offset:39936
  v_mul_f32 v0, s68, v0
  v_mul_f32 v1, s68, v1
  v_mul_f32 v2, s68, v2
  v_mul_f32 v3, s68, v3
  v_mfma_f32_32x32x16_bf16 v[84:99], v[36:39], a[180:183], v[84:99]
  v_mul_f32 v4, s68, v4
  v_mul_f32 v5, s68, v5
  v_mul_f32 v6, s68, v6
  v_mul_f32 v7, s68, v7
  s_waitcnt lgkmcnt(2)
  v_mfma_f32_32x32x16_bf16 v[68:83], a[40:43], v[40:43], v[68:83]
  ds_read_b128 v[36:39], v204 offset:39936
  v_cvt_pk_bf16_f32 v48, v0, v4
  v_cvt_pk_bf16_f32 v49, v1, v5
  v_cvt_pk_bf16_f32 v50, v2, v6
  v_cvt_pk_bf16_f32 v51, v3, v7
  v_mfma_f32_32x32x16_bf16 v[84:99], v[40:43], a[184:187], v[84:99]
  buffer_store_dwordx4 v[48:51], v216, s[8:11], s72 offen offset:0 sc1
  s_waitcnt lgkmcnt(2)
  v_mfma_f32_32x32x16_bf16 v[68:83], a[44:47], v[44:47], v[68:83]
  ds_read_b128 v[40:43], v205 offset:39936
  v_mfma_f32_32x32x16_bf16 v[84:99], v[44:47], a[188:191], v[84:99]
  s_waitcnt lgkmcnt(2)
  v_mfma_f32_32x32x16_bf16 v[68:83], a[48:51], v[32:35], v[68:83]
  ds_read_b128 v[44:47], v206 offset:39936
  v_mul_f32 v8, s68, v8
  v_mul_f32 v9, s68, v9
  v_mul_f32 v10, s68, v10
  v_mul_f32 v11, s68, v11
  v_mfma_f32_32x32x16_bf16 v[84:99], v[32:35], a[192:195], v[84:99]
  v_mul_f32 v12, s68, v12
  v_mul_f32 v13, s68, v13
  v_mul_f32 v14, s68, v14
  v_mul_f32 v15, s68, v15
  s_waitcnt lgkmcnt(2)
  v_mfma_f32_32x32x16_bf16 v[68:83], a[52:55], v[36:39], v[68:83]
  ds_read_b128 v[32:35], v203 offset:40960
  v_cvt_pk_bf16_f32 v52, v8, v12
  v_cvt_pk_bf16_f32 v53, v9, v13
  v_cvt_pk_bf16_f32 v54, v10, v14
  v_cvt_pk_bf16_f32 v55, v11, v15
  v_mfma_f32_32x32x16_bf16 v[84:99], v[36:39], a[196:199], v[84:99]
  buffer_store_dwordx4 v[52:55], v216, s[8:11], s72 offen offset:256 sc1
  s_waitcnt lgkmcnt(2)
  v_mfma_f32_32x32x16_bf16 v[68:83], a[56:59], v[40:43], v[68:83]
  ds_read_b128 v[36:39], v204 offset:40960
  v_mfma_f32_32x32x16_bf16 v[84:99], v[40:43], a[200:203], v[84:99]
  s_waitcnt lgkmcnt(2)
  v_mfma_f32_32x32x16_bf16 v[68:83], a[60:63], v[44:47], v[68:83]
  ds_read_b128 v[40:43], v205 offset:40960
  v_cvt_pk_bf16_f32 v56, v16, v17
  v_cvt_pk_bf16_f32 v57, v20, v21
  v_cvt_pk_bf16_f32 v58, v24, v25
  v_cvt_pk_bf16_f32 v59, v28, v29
  v_mfma_f32_32x32x16_bf16 v[84:99], v[44:47], a[204:207], v[84:99]
  buffer_store_dwordx4 v[56:59], v217, s[8:11], s64 offen offset:0 sc1
  s_waitcnt lgkmcnt(2)
  v_mfma_f32_32x32x16_bf16 v[68:83], a[64:67], v[32:35], v[68:83]
  ds_read_b128 v[44:47], v206 offset:40960
  v_mfma_f32_32x32x16_bf16 v[84:99], v[32:35], a[208:211], v[84:99]
  s_waitcnt lgkmcnt(2)
  v_mfma_f32_32x32x16_bf16 v[68:83], a[68:71], v[36:39], v[68:83]
  ds_read_b128 v[32:35], v203 offset:41984
  v_cvt_pk_bf16_f32 v60, v18, v19
  v_cvt_pk_bf16_f32 v61, v22, v23
  v_cvt_pk_bf16_f32 v62, v26, v27
  v_cvt_pk_bf16_f32 v63, v30, v31
  v_mfma_f32_32x32x16_bf16 v[84:99], v[36:39], a[212:215], v[84:99]
  buffer_store_dwordx4 v[60:63], v217, s[8:11], s64 offen offset:256 sc1
  s_waitcnt lgkmcnt(2)
  v_mfma_f32_32x32x16_bf16 v[68:83], a[72:75], v[40:43], v[68:83]
  ds_read_b128 v[36:39], v204 offset:41984
  v_mfma_f32_32x32x16_bf16 v[84:99], v[40:43], a[216:219], v[84:99]
  s_waitcnt lgkmcnt(2)
  v_mfma_f32_32x32x16_bf16 v[68:83], a[76:79], v[44:47], v[68:83]
  ds_read_b128 v[40:43], v205 offset:41984
  buffer_store_dwordx4 v[64:67], v201, s[8:11], s73 offen sc1
  v_mfma_f32_32x32x16_bf16 v[84:99], v[44:47], a[220:223], v[84:99]
  s_waitcnt lgkmcnt(2)
  v_mfma_f32_32x32x16_bf16 v[68:83], a[80:83], v[32:35], v[68:83]
  ds_read_b128 v[44:47], v206 offset:41984
  v_mfma_f32_32x32x16_bf16 v[84:99], v[32:35], a[224:227], v[84:99]
  s_waitcnt lgkmcnt(2)
  v_mfma_f32_32x32x16_bf16 v[68:83], a[84:87], v[36:39], v[68:83]
  ds_read_b128 v[32:35], v203 offset:43008
  v_mfma_f32_32x32x16_bf16 v[84:99], v[36:39], a[228:231], v[84:99]
  s_waitcnt lgkmcnt(2)
  v_mfma_f32_32x32x16_bf16 v[68:83], a[88:91], v[40:43], v[68:83]
  ds_read_b128 v[36:39], v204 offset:43008
  v_mfma_f32_32x32x16_bf16 v[84:99], v[40:43], a[232:235], v[84:99]
  s_waitcnt lgkmcnt(2)
  v_mfma_f32_32x32x16_bf16 v[68:83], a[92:95], v[44:47], v[68:83]
  ds_read_b128 v[40:43], v205 offset:43008
  v_mfma_f32_32x32x16_bf16 v[84:99], v[44:47], a[236:239], v[84:99]
  s_waitcnt lgkmcnt(2)
  v_mfma_f32_32x32x16_bf16 v[68:83], a[96:99], v[32:35], v[68:83]
  ds_read_b128 v[44:47], v206 offset:43008
  v_mfma_f32_32x32x16_bf16 v[84:99], v[32:35], a[240:243], v[84:99]
  s_waitcnt lgkmcnt(2)
  v_mfma_f32_32x32x16_bf16 v[68:83], a[100:103], v[36:39], v[68:83]
  ds_read_b128 v[32:35], v203 offset:44032
  v_mfma_f32_32x32x16_bf16 v[84:99], v[36:39], a[244:247], v[84:99]
  s_waitcnt lgkmcnt(2)
  v_mfma_f32_32x32x16_bf16 v[68:83], a[104:107], v[40:43], v[68:83]
  ds_read_b128 v[36:39], v204 offset:44032
  v_mfma_f32_32x32x16_bf16 v[84:99], v[40:43], a[248:251], v[84:99]
  s_waitcnt lgkmcnt(2)
  v_mfma_f32_32x32x16_bf16 v[68:83], a[108:111], v[44:47], v[68:83]
  ds_read_b128 v[40:43], v205 offset:44032
  v_mfma_f32_32x32x16_bf16 v[84:99], v[44:47], a[252:255], v[84:99]
  s_waitcnt lgkmcnt(2)
  v_mfma_f32_32x32x16_bf16 v[68:83], a[112:115], v[32:35], v[68:83]
  ds_read_b128 v[44:47], v206 offset:44032
  v_mfma_f32_32x32x16_bf16 v[84:99], v[32:35], v[224:227], v[84:99]
  s_waitcnt lgkmcnt(2)
  v_mfma_f32_32x32x16_bf16 v[68:83], a[116:119], v[36:39], v[68:83]
  ds_read_b128 v[32:35], v203 offset:45056
  v_mfma_f32_32x32x16_bf16 v[84:99], v[36:39], v[228:231], v[84:99]
  s_waitcnt lgkmcnt(2)
  v_mfma_f32_32x32x16_bf16 v[68:83], a[120:123], v[40:43], v[68:83]
  ds_read_b128 v[36:39], v204 offset:45056
  v_mfma_f32_32x32x16_bf16 v[84:99], v[40:43], v[232:235], v[84:99]
  s_waitcnt lgkmcnt(2)
  v_mfma_f32_32x32x16_bf16 v[68:83], a[124:127], v[44:47], v[68:83]
  ds_read_b128 v[40:43], v205 offset:45056
  v_mfma_f32_32x32x16_bf16 v[84:99], v[44:47], v[236:239], v[84:99]
  s_waitcnt lgkmcnt(2)
  v_mfma_f32_32x32x16_bf16 v[68:83], a[128:131], v[32:35], v[68:83]
  ds_read_b128 v[44:47], v206 offset:45056
  v_mfma_f32_32x32x16_bf16 v[84:99], v[32:35], v[240:243], v[84:99]
  s_waitcnt lgkmcnt(2)
  v_mfma_f32_32x32x16_bf16 v[68:83], a[132:135], v[36:39], v[68:83]
  v_mfma_f32_32x32x16_bf16 v[84:99], v[36:39], v[244:247], v[84:99]
  s_waitcnt lgkmcnt(1)
  v_mfma_f32_32x32x16_bf16 v[68:83], a[136:139], v[40:43], v[68:83]
  v_mfma_f32_32x32x16_bf16 v[84:99], v[40:43], v[248:251], v[84:99]
  s_waitcnt lgkmcnt(0)
  v_mfma_f32_32x32x16_bf16 v[68:83], a[140:143], v[44:47], v[68:83]
  v_mfma_f32_32x32x16_bf16 v[84:99], v[44:47], v[252:255], v[84:99]
  s_mul_i32 s64, s59, 655360
  s_lshl_b32 s55, s58, 14
  s_add_u32 s64, s64, s55
  s_add_u32 s64, s64, 1048576
  s_add_u32 s72, s64, s69
  s_add_u32 s73, s64, s66
  s_add_u32 s59, s59, 7
  s_cmp_ge_u32 s59, 64
  s_cbranch_scc1 KV_done1
  s_waitcnt vmcnt(5)
  s_barrier
  s_add_u32 s60, s60, 258048
  ds_read_b128 v[32:35], v203 offset:0
  ds_read_b128 v[36:39], v204 offset:0
  ds_read_b128 v[40:43], v205 offset:0
  s_waitcnt lgkmcnt(2)
  v_mfma_f32_32x32x16_bf16 v[0:15], a[0:3], v[32:35], 0
  ds_read_b128 v[44:47], v206 offset:0
  s_add_u32 m0, s67, 36864
  s_nop 0
  buffer_load_dwordx4 v202, s[4:7], s60 offen offset:0 lds
  v_mfma_f32_32x32x16_bf16 v[16:31], v[32:35], a[144:147], 0
  s_waitcnt lgkmcnt(2)
  v_mfma_f32_32x32x16_bf16 v[0:15], a[4:7], v[36:39], v[0:15]
  ds_read_b128 v[32:35], v203 offset:1024
  s_add_u32 m0, s67, 37760
  s_nop 0
  buffer_load_dwordx4 v202, s[4:7], s60 offen offset:128 lds
  v_mfma_f32_32x32x16_bf16 v[16:31], v[36:39], a[148:151], v[16:31]
  s_waitcnt lgkmcnt(2)
  v_mfma_f32_32x32x16_bf16 v[0:15], a[8:11], v[40:43], v[0:15]
  ds_read_b128 v[36:39], v204 offset:1024
  s_add_u32 m0, s67, 38656
  s_nop 0
  buffer_load_dwordx4 v202, s[4:7], s60 offen offset:256 lds
  v_mfma_f32_32x32x16_bf16 v[16:31], v[40:43], a[152:155], v[16:31]
  s_waitcnt lgkmcnt(2)
  v_mfma_f32_32x32x16_bf16 v[0:15], a[12:15], v[44:47], v[0:15]
  ds_read_b128 v[40:43], v205 offset:1024
  s_add_u32 m0, s67, 39552
  s_nop 0
  buffer_load_dwordx4 v202, s[4:7], s60 offen offset:384 lds
  v_mfma_f32_32x32x16_bf16 v[16:31], v[44:47], a[156:159], v[16:31]
  s_waitcnt lgkmcnt(2)
  v_mfma_f32_32x32x16_bf16 v[0:15], a[16:19], v[32:35], v[0:15]
  ds_read_b128 v[44:47], v206 offset:1024
  s_add_u32 m0, s67, 40448
  s_nop 0
  buffer_load_dwordx4 v202, s[4:7], s60 offen offset:512 lds
  v_mfma_f32_32x32x16_bf16 v[16:31], v[32:35], a[160:163], v[16:31]
  s_waitcnt lgkmcnt(2)
  v_mfma_f32_32x32x16_bf16 v[0:15], a[20:23], v[36:39], v[0:15]
  ds_read_b128 v[32:35], v203 offset:2048
  s_add_u32 m0, s67, 41344
  s_nop 0
  buffer_load_dwordx4 v202, s[4:7], s60 offen offset:640 lds
  v_mfma_f32_32x32x16_bf16 v[16:31], v[36:39], a[164:167], v[16:31]
  s_waitcnt lgkmcnt(2)
  v_mfma_f32_32x32x16_bf16 v[0:15], a[24:27], v[40:43], v[0:15]
  ds_read_b128 v[36:39], v204 offset:2048
  s_add_u32 m0, s67, 42240
  s_nop 0
  buffer_load_dwordx4 v202, s[4:7], s60 offen offset:768 lds
  v_mfma_f32_32x32x16_bf16 v[16:31], v[40:43], a[168:171], v[16:31]
  s_waitcnt lgkmcnt(2)
  v_mfma_f32_32x32x16_bf16 v[0:15], a[28:31], v[44:47], v[0:15]
  ds_read_b128 v[40:43], v205 offset:2048
  s_add_u32 m0, s67, 43136
  s_nop 0
  buffer_load_dwordx4 v202, s[4:7], s60 offen offset:896 lds
  v_mfma_f32_32x32x16_bf16 v[16:31], v[44:47], a[172:175], v[16:31]
  s_waitcnt lgkmcnt(2)
  v_mfma_f32_32x32x16_bf16 v[0:15], a[32:35], v[32:35], v[0:15]
  ds_read_b128 v[44:47], v206 offset:2048
  s_add_u32 m0, s67, 44032
  s_nop 0
  buffer_load_dwordx4 v202, s[4:7], s60 offen offset:1024 lds
  v_mfma_f32_32x32x16_bf16 v[16:31], v[32:35], a[176:179], v[16:31]
  s_waitcnt lgkmcnt(2)
  v_mfma_f32_32x32x16_bf16 v[0:15], a[36:39], v[36:39], v[0:15]
  ds_read_b128 v[32:35], v203 offset:3072
  v_mul_f32 v68, s68, v68
  v_mul_f32 v69, s68, v69
  v_mul_f32 v70, s68, v70
  v_mul_f32 v71, s68, v71
  v_mfma_f32_32x32x16_bf16 v[16:31], v[36:39], a[180:183], v[16:31]
  v_mul_f32 v72, s68, v72
  v_mul_f32 v73, s68, v73
  v_mul_f32 v74, s68, v74
  v_mul_f32 v75, s68, v75
  s_waitcnt lgkmcnt(2)
  v_mfma_f32_32x32x16_bf16 v[0:15], a[40:43], v[40:43], v[0:15]
  ds_read_b128 v[36:39], v204 offset:3072
  v_cvt_pk_bf16_f32 v48, v68, v72
  v_cvt_pk_bf16_f32 v49, v69, v73
  v_cvt_pk_bf16_f32 v50, v70, v74
  v_cvt_pk_bf16_f32 v51, v71, v75
  v_mfma_f32_32x32x16_bf16 v[16:31], v[40:43], a[184:187], v[16:31]
  buffer_store_dwordx4 v[48:51], v216, s[8:11], s72 offen offset:0 sc1
  s_waitcnt lgkmcnt(2)
  v_mfma_f32_32x32x16_bf16 v[0:15], a[44:47], v[44:47], v[0:15]
  ds_read_b128 v[40:43], v205 offset:3072
  v_mfma_f32_32x32x16_bf16 v[16:31], v[44:47], a[188:191], v[16:31]
  s_waitcnt lgkmcnt(2)
  v_mfma_f32_32x32x16_bf16 v[0:15], a[48:51], v[32:35], v[0:15]
  ds_read_b128 v[44:47], v206 offset:3072
  v_mul_f32 v76, s68, v76
  v_mul_f32 v77, s68, v77
  v_mul_f32 v78, s68, v78
  v_mul_f32 v79, s68, v79
  v_mfma_f32_32x32x16_bf16 v[16:31], v[32:35], a[192:195], v[16:31]
  v_mul_f32 v80, s68, v80
  v_mul_f32 v81, s68, v81
  v_mul_f32 v82, s68, v82
  v_mul_f32 v83, s68, v83
  s_waitcnt lgkmcnt(2)
  v_mfma_f32_32x32x16_bf16 v[0:15], a[52:55], v[36:39], v[0:15]
  ds_read_b128 v[32:35], v203 offset:4096
  v_cvt_pk_bf16_f32 v52, v76, v80
  v_cvt_pk_bf16_f32 v53, v77, v81
  v_cvt_pk_bf16_f32 v54, v78, v82
  v_cvt_pk_bf16_f32 v55, v79, v83
  v_mfma_f32_32x32x16_bf16 v[16:31], v[36:39], a[196:199], v[16:31]
  buffer_store_dwordx4 v[52:55], v216, s[8:11], s72 offen offset:256 sc1
  s_waitcnt lgkmcnt(2)
  v_mfma_f32_32x32x16_bf16 v[0:15], a[56:59], v[40:43], v[0:15]
  ds_read_b128 v[36:39], v204 offset:4096
  v_mfma_f32_32x32x16_bf16 v[16:31], v[40:43], a[200:203], v[16:31]
  s_waitcnt lgkmcnt(2)
  v_mfma_f32_32x32x16_bf16 v[0:15], a[60:63], v[44:47], v[0:15]
  ds_read_b128 v[40:43], v205 offset:4096
  v_cvt_pk_bf16_f32 v56, v84, v85
  v_cvt_pk_bf16_f32 v57, v88, v89
  v_cvt_pk_bf16_f32 v58, v92, v93
  v_cvt_pk_bf16_f32 v59, v96, v97
  v_mfma_f32_32x32x16_bf16 v[16:31], v[44:47], a[204:207], v[16:31]
  buffer_store_dwordx4 v[56:59], v217, s[8:11], s64 offen offset:0 sc1
  s_waitcnt lgkmcnt(2)
  v_mfma_f32_32x32x16_bf16 v[0:15], a[64:67], v[32:35], v[0:15]
  ds_read_b128 v[44:47], v206 offset:4096
  v_mfma_f32_32x32x16_bf16 v[16:31], v[32:35], a[208:211], v[16:31]
  s_waitcnt lgkmcnt(2)
  v_mfma_f32_32x32x16_bf16 v[0:15], a[68:71], v[36:39], v[0:15]
  ds_read_b128 v[32:35], v203 offset:5120
  v_cvt_pk_bf16_f32 v60, v86, v87
  v_cvt_pk_bf16_f32 v61, v90, v91
  v_cvt_pk_bf16_f32 v62, v94, v95
  v_cvt_pk_bf16_f32 v63, v98, v99
  v_mfma_f32_32x32x16_bf16 v[16:31], v[36:39], a[212:215], v[16:31]
  buffer_store_dwordx4 v[60:63], v217, s[8:11], s64 offen offset:256 sc1
  s_waitcnt lgkmcnt(2)
  v_mfma_f32_32x32x16_bf16 v[0:15], a[72:75], v[40:43], v[0:15]
  ds_read_b128 v[36:39], v204 offset:5120
  v_mfma_f32_32x32x16_bf16 v[16:31], v[40:43], a[216:219], v[16:31]
  s_waitcnt lgkmcnt(2)
  v_mfma_f32_32x32x16_bf16 v[0:15], a[76:79], v[44:47], v[0:15]
  ds_read_b128 v[40:43], v205 offset:5120
  buffer_store_dwordx4 v[64:67], v201, s[8:11], s73 offen sc1
  v_mfma_f32_32x32x16_bf16 v[16:31], v[44:47], a[220:223], v[16:31]
  s_waitcnt lgkmcnt(2)
  v_mfma_f32_32x32x16_bf16 v[0:15], a[80:83], v[32:35], v[0:15]
  ds_read_b128 v[44:47], v206 offset:5120
  v_mfma_f32_32x32x16_bf16 v[16:31], v[32:35], a[224:227], v[16:31]
  s_waitcnt lgkmcnt(2)
  v_mfma_f32_32x32x16_bf16 v[0:15], a[84:87], v[36:39], v[0:15]
  ds_read_b128 v[32:35], v203 offset:6144
  v_mfma_f32_32x32x16_bf16 v[16:31], v[36:39], a[228:231], v[16:31]
  s_waitcnt lgkmcnt(2)
  v_mfma_f32_32x32x16_bf16 v[0:15], a[88:91], v[40:43], v[0:15]
  ds_read_b128 v[36:39], v204 offset:6144
  v_mfma_f32_32x32x16_bf16 v[16:31], v[40:43], a[232:235], v[16:31]
  s_waitcnt lgkmcnt(2)
  v_mfma_f32_32x32x16_bf16 v[0:15], a[92:95], v[44:47], v[0:15]
  ds_read_b128 v[40:43], v205 offset:6144
  v_mfma_f32_32x32x16_bf16 v[16:31], v[44:47], a[236:239], v[16:31]
  s_waitcnt lgkmcnt(2)
  v_mfma_f32_32x32x16_bf16 v[0:15], a[96:99], v[32:35], v[0:15]
  ds_read_b128 v[44:47], v206 offset:6144
  v_mfma_f32_32x32x16_bf16 v[16:31], v[32:35], a[240:243], v[16:31]
  s_waitcnt lgkmcnt(2)
  v_mfma_f32_32x32x16_bf16 v[0:15], a[100:103], v[36:39], v[0:15]
  ds_read_b128 v[32:35], v203 offset:7168
  v_mfma_f32_32x32x16_bf16 v[16:31], v[36:39], a[244:247], v[16:31]
  s_waitcnt lgkmcnt(2)
  v_mfma_f32_32x32x16_bf16 v[0:15], a[104:107], v[40:43], v[0:15]
  ds_read_b128 v[36:39], v204 offset:7168
  v_mfma_f32_32x32x16_bf16 v[16:31], v[40:43], a[248:251], v[16:31]
  s_waitcnt lgkmcnt(2)
  v_mfma_f32_32x32x16_bf16 v[0:15], a[108:111], v[44:47], v[0:15]
  ds_read_b128 v[40:43], v205 offset:7168
  v_mfma_f32_32x32x16_bf16 v[16:31], v[44:47], a[252:255], v[16:31]
  s_waitcnt lgkmcnt(2)
  v_mfma_f32_32x32x16_bf16 v[0:15], a[112:115], v[32:35], v[0:15]
  ds_read_b128 v[44:47], v206 offset:7168
  v_mfma_f32_32x32x16_bf16 v[16:31], v[32:35], v[224:227], v[16:31]
  s_waitcnt lgkmcnt(2)
  v_mfma_f32_32x32x16_bf16 v[0:15], a[116:119], v[36:39], v[0:15]
  ds_read_b128 v[32:35], v203 offset:8192
  v_mfma_f32_32x32x16_bf16 v[16:31], v[36:39], v[228:231], v[16:31]
  s_waitcnt lgkmcnt(2)
  v_mfma_f32_32x32x16_bf16 v[0:15], a[120:123], v[40:43], v[0:15]
  ds_read_b128 v[36:39], v204 offset:8192
  v_mfma_f32_32x32x16_bf16 v[16:31], v[40:43], v[232:235], v[16:31]
  s_waitcnt lgkmcnt(2)
  v_mfma_f32_32x32x16_bf16 v[0:15], a[124:127], v[44:47], v[0:15]
  ds_read_b128 v[40:43], v205 offset:8192
  v_mfma_f32_32x32x16_bf16 v[16:31], v[44:47], v[236:239], v[16:31]
  s_waitcnt lgkmcnt(2)
  v_mfma_f32_32x32x16_bf16 v[0:15], a[128:131], v[32:35], v[0:15]
  ds_read_b128 v[44:47], v206 offset:8192
  v_mfma_f32_32x32x16_bf16 v[16:31], v[32:35], v[240:243], v[16:31]
  s_waitcnt lgkmcnt(2)
  v_mfma_f32_32x32x16_bf16 v[0:15], a[132:135], v[36:39], v[0:15]
  v_mfma_f32_32x32x16_bf16 v[16:31], v[36:39], v[244:247], v[16:31]
  s_waitcnt lgkmcnt(1)
  v_mfma_f32_32x32x16_bf16 v[0:15], a[136:139], v[40:43], v[0:15]
  v_mfma_f32_32x32x16_bf16 v[16:31], v[40:43], v[248:251], v[16:31]
  s_waitcnt lgkmcnt(0)
  v_mfma_f32_32x32x16_bf16 v[0:15], a[140:143], v[44:47], v[0:15]
  v_mfma_f32_32x32x16_bf16 v[16:31], v[44:47], v[252:255], v[16:31]
  s_mul_i32 s64, s59, 655360
  s_lshl_b32 s55, s58, 14
  s_add_u32 s64, s64, s55
  s_add_u32 s64, s64, 1048576
  s_add_u32 s72, s64, s69
  s_add_u32 s73, s64, s66
  s_add_u32 s59, s59, 7
  s_cmp_ge_u32 s59, 64
  s_cbranch_scc1 KV_done0
  s_sub_u32 s54, s59, 21
  s_cmp_lt_u32 s54, 7
  s_cbranch_scc1 KV_early
  s_waitcnt vmcnt(5)
  s_barrier
KV_cont:
  s_branch KV_loop
KV_early:
  s_waitcnt vmcnt(0)
  s_barrier
  s_cmp_eq_u32 s52, 0
  s_cbranch_scc0 KV_sig0
  v_mov_b32 v211, 1
  v_mov_b32 v212, 0
  s_mov_b64 exec, 1
  buffer_atomic_add v211, v212, s[12:15], s70 offen
  s_mov_b64 exec, -1
KV_sig0:
  s_branch KV_cont
KV_done1:
  s_nop 11
  v_mul_f32 v68, s68, v68
  v_mul_f32 v69, s68, v69
  v_mul_f32 v70, s68, v70
  v_mul_f32 v71, s68, v71
  v_mul_f32 v72, s68, v72
  v_mul_f32 v73, s68, v73
  v_mul_f32 v74, s68, v74
  v_mul_f32 v75, s68, v75
  v_cvt_pk_bf16_f32 v48, v68, v72
  v_cvt_pk_bf16_f32 v49, v69, v73
  v_cvt_pk_bf16_f32 v50, v70, v74
  v_cvt_pk_bf16_f32 v51, v71, v75
  buffer_store_dwordx4 v[48:51], v216, s[8:11], s72 offen offset:0 sc1
  v_mul_f32 v76, s68, v76
  v_mul_f32 v77, s68, v77
  v_mul_f32 v78, s68, v78
  v_mul_f32 v79, s68, v79
  v_mul_f32 v80, s68, v80
  v_mul_f32 v81, s68, v81
  v_mul_f32 v82, s68, v82
  v_mul_f32 v83, s68, v83
  v_cvt_pk_bf16_f32 v52, v76, v80
  v_cvt_pk_bf16_f32 v53, v77, v81
  v_cvt_pk_bf16_f32 v54, v78, v82
  v_cvt_pk_bf16_f32 v55, v79, v83
  buffer_store_dwordx4 v[52:55], v216, s[8:11], s72 offen offset:256 sc1
  v_cvt_pk_bf16_f32 v56, v84, v85
  v_cvt_pk_bf16_f32 v57, v88, v89
  v_cvt_pk_bf16_f32 v58, v92, v93
  v_cvt_pk_bf16_f32 v59, v96, v97
  buffer_store_dwordx4 v[56:59], v217, s[8:11], s64 offen offset:0 sc1
  v_cvt_pk_bf16_f32 v60, v86, v87
  v_cvt_pk_bf16_f32 v61, v90, v91
  v_cvt_pk_bf16_f32 v62, v94, v95
  v_cvt_pk_bf16_f32 v63, v98, v99
  buffer_store_dwordx4 v[60:63], v217, s[8:11], s64 offen offset:256 sc1
  buffer_store_dwordx4 v[64:67], v201, s[8:11], s73 offen sc1
  s_branch KV_fin
KV_done0:
  s_nop 11
  v_mul_f32 v0, s68, v0
  v_mul_f32 v1, s68, v1
  v_mul_f32 v2, s68, v2
  v_mul_f32 v3, s68, v3
  v_mul_f32 v4, s68, v4
  v_mul_f32 v5, s68, v5
  v_mul_f32 v6, s68, v6
  v_mul_f32 v7, s68, v7
  v_cvt_pk_bf16_f32 v48, v0, v4
  v_cvt_pk_bf16_f32 v49, v1, v5
  v_cvt_pk_bf16_f32 v50, v2, v6
  v_cvt_pk_bf16_f32 v51, v3, v7
  buffer_store_dwordx4 v[48:51], v216, s[8:11], s72 offen offset:0 sc1
  v_mul_f32 v8, s68, v8
  v_mul_f32 v9, s68, v9
  v_mul_f32 v10, s68, v10
  v_mul_f32 v11, s68, v11
  v_mul_f32 v12, s68, v12
  v_mul_f32 v13, s68, v13
  v_mul_f32 v14, s68, v14
  v_mul_f32 v15, s68, v15
  v_cvt_pk_bf16_f32 v52, v8, v12
  v_cvt_pk_bf16_f32 v53, v9, v13
  v_cvt_pk_bf16_f32 v54, v10, v14
  v_cvt_pk_bf16_f32 v55, v11, v15
  buffer_store_dwordx4 v[52:55], v216, s[8:11], s72 offen offset:256 sc1
  v_cvt_pk_bf16_f32 v56, v16, v17
  v_cvt_pk_bf16_f32 v57, v20, v21
  v_cvt_pk_bf16_f32 v58, v24, v25
  v_cvt_pk_bf16_f32 v59, v28, v29
  buffer_store_dwordx4 v[56:59], v217, s[8:11], s64 offen offset:0 sc1
  v_cvt_pk_bf16_f32 v60, v18, v19
  v_cvt_pk_bf16_f32 v61, v22, v23
  v_cvt_pk_bf16_f32 v62, v26, v27
  v_cvt_pk_bf16_f32 v63, v30, v31
  buffer_store_dwordx4 v[60:63], v217, s[8:11], s64 offen offset:256 sc1
  buffer_store_dwordx4 v[64:67], v201, s[8:11], s73 offen sc1
KV_fin:
  s_waitcnt vmcnt(0)
  s_barrier
  s_cmp_eq_u32 s52, 0
  s_cbranch_scc0 KV_sig
  v_mov_b32 v211, 256
  v_mov_b32 v212, 0
  s_mov_b64 exec, 1
  buffer_atomic_add v211, v212, s[12:15], s70 offen
  s_mov_b64 exec, -1
KV_sig:
  s_cmp_ge_u32 s53, 192
  s_cbranch_scc1 L_exit
  s_cmp_lt_u32 s53, 64
  s_cbranch_scc1 W_h
  s_sub_u32 s54, s53, 64
  s_lshr_b32 s68, s54, 4
  s_and_b32 s69, s54, 15
  s_lshl_b32 s60, s69, 2
  s_sub_u32 s60, s60, 1
  s_max_i32 s60, s60, 0
  s_mul_i32 s60, s60, 36864
  s_add_u32 m0, s67, 0
  s_nop 0
  buffer_load_dwordx4 v202, s[4:7], s60 offen offset:0 lds
  s_add_u32 m0, s67, 896
  s_nop 0
  buffer_load_dwordx4 v202, s[4:7], s60 offen offset:128 lds
  s_add_u32 m0, s67, 1792
  s_nop 0
  buffer_load_dwordx4 v202, s[4:7], s60 offen offset:256 lds
  s_add_u32 m0, s67, 2688
  s_nop 0
  buffer_load_dwordx4 v202, s[4:7], s60 offen offset:384 lds
  s_add_u32 m0, s67, 3584
  s_nop 0
  buffer_load_dwordx4 v202, s[4:7], s60 offen offset:512 lds
  s_add_u32 m0, s67, 4480
  s_nop 0
  buffer_load_dwordx4 v202, s[4:7], s60 offen offset:640 lds
  s_add_u32 m0, s67, 5376
  s_nop 0
  buffer_load_dwordx4 v202, s[4:7], s60 offen offset:768 lds
  s_add_u32 m0, s67, 6272
  s_nop 0
  buffer_load_dwordx4 v202, s[4:7], s60 offen offset:896 lds
  s_add_u32 m0, s67, 7168
  s_nop 0
  buffer_load_dwordx4 v202, s[4:7], s60 offen offset:1024 lds
  v_and_b32 v211, 15, v200
  v_mul_u32_u24 v211, 72, v211
  v_lshrrev_b32 v212, 4, v200
  v_mul_u32_u24 v213, 1152, v212
  v_add_u32 v213, v213, v211
  s_lshl_b32 s54, s54, 2
  s_add_u32 s70, s54, s52
  s_mul_i32 s55, s70, 4608
  buffer_load_dwordx4 v[48:51], v213, s[4:7], s55 offen offset:0
  buffer_load_dwordx4 v[52:55], v213, s[4:7], s55 offen offset:16
  buffer_load_dwordx4 v[56:59], v213, s[4:7], s55 offen offset:32
  buffer_load_dwordx4 v[60:63], v213, s[4:7], s55 offen offset:48
  buffer_load_dwordx2 v[64:65], v213, s[4:7], s55 offen offset:64
  buffer_load_dwordx4 v[68:71], v211, s[44:47], 0 offen offset:0
  buffer_load_dwordx4 v[72:75], v211, s[44:47], 0 offen offset:16
  buffer_load_dwordx4 v[76:79], v211, s[44:47], 0 offen offset:32
  buffer_load_dwordx4 v[80:83], v211, s[44:47], 0 offen offset:48
  buffer_load_dwordx2 v[84:85], v211, s[44:47], 0 offen offset:64
  v_mov_b32 v0, 0
  v_mov_b32 v1, 0x3f803f80
  s_waitcnt vmcnt(9)
  v_lshlrev_b32 v2, 16, v48
  s_waitcnt vmcnt(4)
  v_lshlrev_b32 v3, 16, v68
  v_and_b32 v4, 0xffff0000, v48
  v_and_b32 v5, 0xffff0000, v68
  v_mul_f32 v2, v2, v3
  v_mul_f32 v4, v4, v5
  v_cvt_pk_bf16_f32 v2, v2, v4
  v_lshlrev_b32 v3, 16, v2
  v_and_b32 v4, 0xffff0000, v2
  v_add_f32 v0, v0, v3
  v_add_f32 v0, v0, v4
  v_lshlrev_b32 v2, 16, v49
  v_lshlrev_b32 v3, 16, v69
  v_and_b32 v4, 0xffff0000, v49
  v_and_b32 v5, 0xffff0000, v69
  v_mul_f32 v2, v2, v3
  v_mul_f32 v4, v4, v5
  v_cvt_pk_bf16_f32 v2, v2, v4
  v_lshlrev_b32 v3, 16, v2
  v_and_b32 v4, 0xffff0000, v2
  v_add_f32 v0, v0, v3
  v_add_f32 v0, v0, v4
  v_lshlrev_b32 v2, 16, v50
  v_lshlrev_b32 v3, 16, v70
  v_and_b32 v4, 0xffff0000, v50
  v_and_b32 v5, 0xffff0000, v70
  v_mul_f32 v2, v2, v3
  v_mul_f32 v4, v4, v5
  v_cvt_pk_bf16_f32 v2, v2, v4
  v_lshlrev_b32 v3, 16, v2
  v_and_b32 v4, 0xffff0000, v2
  v_add_f32 v0, v0, v3
  v_add_f32 v0, v0, v4
  v_lshlrev_b32 v2, 16, v51
  v_lshlrev_b32 v3, 16, v71
  v_and_b32 v4, 0xffff0000, v51
  v_and_b32 v5, 0xffff0000, v71
  v_mul_f32 v2, v2, v3
  v_mul_f32 v4, v4, v5
  v_cvt_pk_bf16_f32 v2, v2, v4
  v_lshlrev_b32 v3, 16, v2
  v_and_b32 v4, 0xffff0000, v2
  v_add_f32 v0, v0, v3
  v_add_f32 v0, v0, v4
  v_lshlrev_b32 v2, 16, v52
  s_waitcnt vmcnt(3)
  v_lshlrev_b32 v3, 16, v72
  v_and_b32 v4, 0xffff0000, v52
  v_and_b32 v5, 0xffff0000, v72
  v_mul_f32 v2, v2, v3
  v_mul_f32 v4, v4, v5
  v_cvt_pk_bf16_f32 v2, v2, v4
  v_lshlrev_b32 v3, 16, v2
  v_and_b32 v4, 0xffff0000, v2
  v_add_f32 v0, v0, v3
  v_add_f32 v0, v0, v4
  v_lshlrev_b32 v2, 16, v53
  v_lshlrev_b32 v3, 16, v73
  v_and_b32 v4, 0xffff0000, v53
  v_and_b32 v5, 0xffff0000, v73
  v_mul_f32 v2, v2, v3
  v_mul_f32 v4, v4, v5
  v_cvt_pk_bf16_f32 v2, v2, v4
  v_lshlrev_b32 v3, 16, v2
  v_and_b32 v4, 0xffff0000, v2
  v_add_f32 v0, v0, v3
  v_add_f32 v0, v0, v4
  v_lshlrev_b32 v2, 16, v54
  v_lshlrev_b32 v3, 16, v74
  v_and_b32 v4, 0xffff0000, v54
  v_and_b32 v5, 0xffff0000, v74
  v_mul_f32 v2, v2, v3
  v_mul_f32 v4, v4, v5
  v_cvt_pk_bf16_f32 v2, v2, v4
  v_lshlrev_b32 v3, 16, v2
  v_and_b32 v4, 0xffff0000, v2
  v_add_f32 v0, v0, v3
  v_add_f32 v0, v0, v4
  v_lshlrev_b32 v2, 16, v55
  v_lshlrev_b32 v3, 16, v75
  v_and_b32 v4, 0xffff0000, v55
  v_and_b32 v5, 0xffff0000, v75
  v_mul_f32 v2, v2, v3
  v_mul_f32 v4, v4, v5
  v_cvt_pk_bf16_f32 v2, v2, v4
  v_lshlrev_b32 v3, 16, v2
  v_and_b32 v4, 0xffff0000, v2
  v_add_f32 v0, v0, v3
  v_add_f32 v0, v0, v4
  v_lshlrev_b32 v2, 16, v56
  s_waitcnt vmcnt(2)
  v_lshlrev_b32 v3, 16, v76
  v_and_b32 v4, 0xffff0000, v56
  v_and_b32 v5, 0xffff0000, v76
  v_mul_f32 v2, v2, v3
  v_mul_f32 v4, v4, v5
  v_cvt_pk_bf16_f32 v2, v2, v4
  v_lshlrev_b32 v3, 16, v2
  v_and_b32 v4, 0xffff0000, v2
  v_add_f32 v0, v0, v3
  v_add_f32 v0, v0, v4
  v_lshlrev_b32 v2, 16, v57
  v_lshlrev_b32 v3, 16, v77
  v_and_b32 v4, 0xffff0000, v57
  v_and_b32 v5, 0xffff0000, v77
  v_mul_f32 v2, v2, v3
  v_mul_f32 v4, v4, v5
  v_cvt_pk_bf16_f32 v2, v2, v4
  v_lshlrev_b32 v3, 16, v2
  v_and_b32 v4, 0xffff0000, v2
  v_add_f32 v0, v0, v3
  v_add_f32 v0, v0, v4
  v_lshlrev_b32 v2, 16, v58
  v_lshlrev_b32 v3, 16, v78
  v_and_b32 v4, 0xffff0000, v58
  v_and_b32 v5, 0xffff0000, v78
  v_mul_f32 v2, v2, v3
  v_mul_f32 v4, v4, v5
  v_cvt_pk_bf16_f32 v2, v2, v4
  v_lshlrev_b32 v3, 16, v2
  v_and_b32 v4, 0xffff0000, v2
  v_add_f32 v0, v0, v3
  v_add_f32 v0, v0, v4
  v_lshlrev_b32 v2, 16, v59
  v_lshlrev_b32 v3, 16, v79
  v_and_b32 v4, 0xffff0000, v59
  v_and_b32 v5, 0xffff0000, v79
  v_mul_f32 v2, v2, v3
  v_mul_f32 v4, v4, v5
  v_cvt_pk_bf16_f32 v2, v2, v4
  v_lshlrev_b32 v3, 16, v2
  v_and_b32 v4, 0xffff0000, v2
  v_add_f32 v0, v0, v3
  v_add_f32 v0, v0, v4
  v_lshlrev_b32 v2, 16, v60
  s_waitcnt vmcnt(1)
  v_lshlrev_b32 v3, 16, v80
  v_and_b32 v4, 0xffff0000, v60
  v_and_b32 v5, 0xffff0000, v80
  v_mul_f32 v2, v2, v3
  v_mul_f32 v4, v4, v5
  v_cvt_pk_bf16_f32 v2, v2, v4
  v_lshlrev_b32 v3, 16, v2
  v_and_b32 v4, 0xffff0000, v2
  v_add_f32 v0, v0, v3
  v_add_f32 v0, v0, v4
  v_lshlrev_b32 v2, 16, v61
  v_lshlrev_b32 v3, 16, v81
  v_and_b32 v4, 0xffff0000, v61
  v_and_b32 v5, 0xffff0000, v81
  v_mul_f32 v2, v2, v3
  v_mul_f32 v4, v4, v5
  v_cvt_pk_bf16_f32 v2, v2, v4
  v_lshlrev_b32 v3, 16, v2
  v_and_b32 v4, 0xffff0000, v2
  v_add_f32 v0, v0, v3
  v_add_f32 v0, v0, v4
  v_lshlrev_b32 v2, 16, v62
  v_lshlrev_b32 v3, 16, v82
  v_and_b32 v4, 0xffff0000, v62
  v_and_b32 v5, 0xffff0000, v82
  v_mul_f32 v2, v2, v3
  v_mul_f32 v4, v4, v5
  v_cvt_pk_bf16_f32 v2, v2, v4
  v_lshlrev_b32 v3, 16, v2
  v_and_b32 v4, 0xffff0000, v2
  v_add_f32 v0, v0, v3
  v_add_f32 v0, v0, v4
  v_lshlrev_b32 v2, 16, v63
  v_lshlrev_b32 v3, 16, v83
  v_and_b32 v4, 0xffff0000, v63
  v_and_b32 v5, 0xffff0000, v83
  v_mul_f32 v2, v2, v3
  v_mul_f32 v4, v4, v5
  v_cvt_pk_bf16_f32 v2, v2, v4
  v_lshlrev_b32 v3, 16, v2
  v_and_b32 v4, 0xffff0000, v2
  v_add_f32 v0, v0, v3
  v_add_f32 v0, v0, v4
  v_lshlrev_b32 v2, 16, v64
  s_waitcnt vmcnt(0)
  v_lshlrev_b32 v3, 16, v84
  v_and_b32 v4, 0xffff0000, v64
  v_and_b32 v5, 0xffff0000, v84
  v_mul_f32 v2, v2, v3
  v_mul_f32 v4, v4, v5
  v_cvt_pk_bf16_f32 v2, v2, v4
  v_lshlrev_b32 v3, 16, v2
  v_and_b32 v4, 0xffff0000, v2
  v_add_f32 v0, v0, v3
  v_add_f32 v0, v0, v4
  v_lshlrev_b32 v2, 16, v65
  v_lshlrev_b32 v3, 16, v85
  v_and_b32 v4, 0xffff0000, v65
  v_and_b32 v5, 0xffff0000, v85
  v_mul_f32 v2, v2, v3
  v_mul_f32 v4, v4, v5
  v_cvt_pk_bf16_f32 v2, v2, v4
  v_lshlrev_b32 v3, 16, v2
  v_and_b32 v4, 0xffff0000, v2
  v_add_f32 v0, v0, v3
  v_add_f32 v0, v0, v4
  s_nop 1
  v_add_f32_dpp v0, v0, v0 row_ror:1 row_mask:0xf bank_mask:0xf
  s_nop 1
  v_add_f32_dpp v0, v0, v0 row_ror:2 row_mask:0xf bank_mask:0xf
  s_nop 1
  v_add_f32_dpp v0, v0, v0 row_ror:4 row_mask:0xf bank_mask:0xf
  s_nop 1
  v_add_f32_dpp v0, v0, v0 row_ror:8 row_mask:0xf bank_mask:0xf
  v_cvt_pk_bf16_f32 v0, v0, v0
  v_lshlrev_b32 v0, 16, v0
  v_mul_f32 v0, 3216550459, v0
  v_exp_f32 v0, v0
  s_nop 0
  v_add_f32 v0, 1.0, v0
  v_rcp_f32 v0, v0
  s_nop 0
  v_cvt_pk_bf16_f32 v0, v0, v0
  v_lshlrev_b32 v0, 16, v0
  v_lshlrev_b32 v212, 2, v212
  s_lshl_b32 s55, s70, 4
  s_add_u32 s55, s55, 66060288
  s_mov_b32 exec_lo, 0x00010001
  s_mov_b32 exec_hi, 0x00010001
  buffer_store_dword v0, v212, s[8:11], s55 offen sc1
  s_mov_b64 exec, -1
  v_lshrrev_b32 v211, 4, v200
  v_lshlrev_b32 v212, 2, v211
  v_and_b32 v213, 15, v200
  v_xor_b32 v212, v212, v213
  v_mul_u32_u24 v211, 3456, v211
  v_mov_b32 v2, 0x40000000
  v_add_u32 v213, 0, v212
  v_mul_u32_u24 v214, 57, v213
  v_lshrrev_b32 v214, 9, v214
  v_mul_u32_u24 v214, 1008, v214
  v_lshl_add_u32 v214, v213, 4, v214
  v_add_u32 v214, v214, v211
  v_cmp_lt_u32 vcc, 26, v213
  s_nop 1
  v_cndmask_b32 v207, v214, v2, vcc
  v_add_u32 v213, 16, v212
  v_mul_u32_u24 v214, 57, v213
  v_lshrrev_b32 v214, 9, v214
  v_mul_u32_u24 v214, 1008, v214
  v_lshl_add_u32 v214, v213, 4, v214
  v_add_u32 v214, v214, v211
  v_cmp_lt_u32 vcc, 26, v213
  s_nop 1
  v_cndmask_b32 v208, v214, v2, vcc
  s_mul_i32 s62, s68, 144
  s_mul_i32 s54, s52, 13824
  s_add_u32 s62, s62, s54
  s_waitcnt vmcnt(0)
  s_lshl_b32 s61, s52, 10
  s_add_u32 s61, s61, 36864
  s_add_u32 m0, s61, 0
  s_add_u32 s54, s62, 0
  buffer_load_dwordx4 v207, s[36:39], s54 offen lds
  s_add_u32 m0, s61, 4096
  s_add_u32 s54, s62, 55296
  buffer_load_dwordx4 v207, s[36:39], s54 offen lds
  s_add_u32 m0, s61, 8192
  s_add_u32 s54, s62, 110592
  buffer_load_dwordx4 v207, s[36:39], s54 offen lds
  s_add_u32 m0, s61, 12288
  s_add_u32 s54, s62, 165888
  buffer_load_dwordx4 v207, s[36:39], s54 offen lds
  s_add_u32 m0, s61, 16384
  s_add_u32 s54, s62, 0
  buffer_load_dwordx4 v208, s[36:39], s54 offen lds
  s_add_u32 m0, s61, 20480
  s_add_u32 s54, s62, 55296
  buffer_load_dwordx4 v208, s[36:39], s54 offen lds
  s_add_u32 m0, s61, 24576
  s_add_u32 s54, s62, 110592
  buffer_load_dwordx4 v208, s[36:39], s54 offen lds
  s_add_u32 m0, s61, 28672
  s_add_u32 s54, s62, 165888
  buffer_load_dwordx4 v208, s[36:39], s54 offen lds
  s_add_u32 m0, s61, 32768
  s_add_u32 s54, s62, 221184
  buffer_load_dwordx4 v207, s[36:39], s54 offen lds
  s_add_u32 m0, s61, 36864
  s_add_u32 s54, s62, 276480
  buffer_load_dwordx4 v207, s[36:39], s54 offen lds
  s_add_u32 m0, s61, 40960
  s_add_u32 s54, s62, 331776
  buffer_load_dwordx4 v207, s[36:39], s54 offen lds
  s_add_u32 m0, s61, 45056
  s_add_u32 s54, s62, 387072
  buffer_load_dwordx4 v207, s[36:39], s54 offen lds
  s_add_u32 m0, s61, 49152
  s_add_u32 s54, s62, 221184
  buffer_load_dwordx4 v208, s[36:39], s54 offen lds
  s_add_u32 m0, s61, 53248
  s_add_u32 s54, s62, 276480
  buffer_load_dwordx4 v208, s[36:39], s54 offen lds
  s_add_u32 m0, s61, 57344
  s_add_u32 s54, s62, 331776
  buffer_load_dwordx4 v208, s[36:39], s54 offen lds
  s_add_u32 m0, s61, 61440
  s_add_u32 s54, s62, 387072
  buffer_load_dwordx4 v208, s[36:39], s54 offen lds
  s_add_u32 m0, s61, 65536
  s_add_u32 s54, s62, 442368
  buffer_load_dwordx4 v207, s[36:39], s54 offen lds
  s_add_u32 m0, s61, 69632
  s_add_u32 s54, s62, 497664
  buffer_load_dwordx4 v207, s[36:39], s54 offen lds
  s_add_u32 m0, s61, 73728
  s_add_u32 s54, s62, 552960
  buffer_load_dwordx4 v207, s[36:39], s54 offen lds
  s_add_u32 m0, s61, 77824
  s_add_u32 s54, s62, 608256
  buffer_load_dwordx4 v207, s[36:39], s54 offen lds
  s_add_u32 m0, s61, 81920
  s_add_u32 s54, s62, 442368
  buffer_load_dwordx4 v208, s[36:39], s54 offen lds
  s_add_u32 m0, s61, 86016
  s_add_u32 s54, s62, 497664
  buffer_load_dwordx4 v208, s[36:39], s54 offen lds
  s_add_u32 m0, s61, 90112
  s_add_u32 s54, s62, 552960
  buffer_load_dwordx4 v208, s[36:39], s54 offen lds
  s_add_u32 m0, s61, 94208
  s_add_u32 s54, s62, 608256
  buffer_load_dwordx4 v208, s[36:39], s54 offen lds
  s_waitcnt vmcnt(20) lgkmcnt(0)
  s_barrier
  s_add_u32 m0, s61, 98304
  s_add_u32 s54, s62, 663552
  buffer_load_dwordx4 v207, s[36:39], s54 offen lds
  s_add_u32 m0, s61, 102400
  s_add_u32 s54, s62, 718848
  buffer_load_dwordx4 v207, s[36:39], s54 offen lds
  s_add_u32 m0, s61, 106496
  s_add_u32 s54, s62, 774144
  buffer_load_dwordx4 v207, s[36:39], s54 offen lds
  s_add_u32 m0, s61, 110592
  s_add_u32 s54, s62, 829440
  buffer_load_dwordx4 v207, s[36:39], s54 offen lds
  v_add_u32 v215, 36864, v210
  ds_read_b64_tr_b16 a[0:1], v215 offset:0
  ds_read_b64_tr_b16 a[2:3], v215 offset:1024
  ds_read_b64_tr_b16 a[4:5], v215 offset:4096
  ds_read_b64_tr_b16 a[6:7], v215 offset:5120
  ds_read_b64_tr_b16 a[8:9], v215 offset:8192
  ds_read_b64_tr_b16 a[10:11], v215 offset:9216
  ds_read_b64_tr_b16 a[12:13], v215 offset:12288
  ds_read_b64_tr_b16 a[14:15], v215 offset:13312
  s_waitcnt vmcnt(20) lgkmcnt(0)
  s_barrier
  s_add_u32 m0, s61, 0
  s_add_u32 s54, s62, 663552
  buffer_load_dwordx4 v208, s[36:39], s54 offen lds
  s_add_u32 m0, s61, 4096
  s_add_u32 s54, s62, 718848
  buffer_load_dwordx4 v208, s[36:39], s54 offen lds
  s_add_u32 m0, s61, 8192
  s_add_u32 s54, s62, 774144
  buffer_load_dwordx4 v208, s[36:39], s54 offen lds
  s_add_u32 m0, s61, 12288
  s_add_u32 s54, s62, 829440
  buffer_load_dwordx4 v208, s[36:39], s54 offen lds
  v_add_u32 v215, 53248, v210
  ds_read_b64_tr_b16 a[144:145], v215 offset:0
  ds_read_b64_tr_b16 a[146:147], v215 offset:1024
  ds_read_b64_tr_b16 a[148:149], v215 offset:4096
  ds_read_b64_tr_b16 a[150:151], v215 offset:5120
  ds_read_b64_tr_b16 a[152:153], v215 offset:8192
  ds_read_b64_tr_b16 a[154:155], v215 offset:9216
  ds_read_b64_tr_b16 a[156:157], v215 offset:12288
  ds_read_b64_tr_b16 a[158:159], v215 offset:13312
  s_waitcnt vmcnt(20) lgkmcnt(0)
  s_barrier
  s_add_u32 m0, s61, 16384
  s_add_u32 s54, s62, 884736
  buffer_load_dwordx4 v207, s[36:39], s54 offen lds
  s_add_u32 m0, s61, 20480
  s_add_u32 s54, s62, 940032
  buffer_load_dwordx4 v207, s[36:39], s54 offen lds
  s_add_u32 m0, s61, 24576
  s_add_u32 s54, s62, 995328
  buffer_load_dwordx4 v207, s[36:39], s54 offen lds
  s_add_u32 m0, s61, 28672
  s_add_u32 s54, s62, 1050624
  buffer_load_dwordx4 v207, s[36:39], s54 offen lds
  v_add_u32 v215, 69632, v210
  ds_read_b64_tr_b16 a[16:17], v215 offset:0
  ds_read_b64_tr_b16 a[18:19], v215 offset:1024
  ds_read_b64_tr_b16 a[20:21], v215 offset:4096
  ds_read_b64_tr_b16 a[22:23], v215 offset:5120
  ds_read_b64_tr_b16 a[24:25], v215 offset:8192
  ds_read_b64_tr_b16 a[26:27], v215 offset:9216
  ds_read_b64_tr_b16 a[28:29], v215 offset:12288
  ds_read_b64_tr_b16 a[30:31], v215 offset:13312
  s_waitcnt vmcnt(20) lgkmcnt(0)
  s_barrier
  s_add_u32 m0, s61, 32768
  s_add_u32 s54, s62, 884736
  buffer_load_dwordx4 v208, s[36:39], s54 offen lds
  s_add_u32 m0, s61, 36864
  s_add_u32 s54, s62, 940032
  buffer_load_dwordx4 v208, s[36:39], s54 offen lds
  s_add_u32 m0, s61, 40960
  s_add_u32 s54, s62, 995328
  buffer_load_dwordx4 v208, s[36:39], s54 offen lds
  s_add_u32 m0, s61, 45056
  s_add_u32 s54, s62, 1050624
  buffer_load_dwordx4 v208, s[36:39], s54 offen lds
  v_add_u32 v215, 86016, v210
  ds_read_b64_tr_b16 a[160:161], v215 offset:0
  ds_read_b64_tr_b16 a[162:163], v215 offset:1024
  ds_read_b64_tr_b16 a[164:165], v215 offset:4096
  ds_read_b64_tr_b16 a[166:167], v215 offset:5120
  ds_read_b64_tr_b16 a[168:169], v215 offset:8192
  ds_read_b64_tr_b16 a[170:171], v215 offset:9216
  ds_read_b64_tr_b16 a[172:173], v215 offset:12288
  ds_read_b64_tr_b16 a[174:175], v215 offset:13312
  s_waitcnt vmcnt(20) lgkmcnt(0)
  s_barrier
  s_add_u32 m0, s61, 49152
  s_add_u32 s54, s62, 1105920
  buffer_load_dwordx4 v207, s[36:39], s54 offen lds
  s_add_u32 m0, s61, 53248
  s_add_u32 s54, s62, 1161216
  buffer_load_dwordx4 v207, s[36:39], s54 offen lds
  s_add_u32 m0, s61, 57344
  s_add_u32 s54, s62, 1216512
  buffer_load_dwordx4 v207, s[36:39], s54 offen lds
  s_add_u32 m0, s61, 61440
  s_add_u32 s54, s62, 1271808
  buffer_load_dwordx4 v207, s[36:39], s54 offen lds
  v_add_u32 v215, 102400, v210
  ds_read_b64_tr_b16 a[32:33], v215 offset:0
  ds_read_b64_tr_b16 a[34:35], v215 offset:1024
  ds_read_b64_tr_b16 a[36:37], v215 offset:4096
  ds_read_b64_tr_b16 a[38:39], v215 offset:5120
  ds_read_b64_tr_b16 a[40:41], v215 offset:8192
  ds_read_b64_tr_b16 a[42:43], v215 offset:9216
  ds_read_b64_tr_b16 a[44:45], v215 offset:12288
  ds_read_b64_tr_b16 a[46:47], v215 offset:13312
  s_waitcnt vmcnt(20) lgkmcnt(0)
  s_barrier
  s_add_u32 m0, s61, 65536
  s_add_u32 s54, s62, 1105920
  buffer_load_dwordx4 v208, s[36:39], s54 offen lds
  s_add_u32 m0, s61, 69632
  s_add_u32 s54, s62, 1161216
  buffer_load_dwordx4 v208, s[36:39], s54 offen lds
  s_add_u32 m0, s61, 73728
  s_add_u32 s54, s62, 1216512
  buffer_load_dwordx4 v208, s[36:39], s54 offen lds
  s_add_u32 m0, s61, 77824
  s_add_u32 s54, s62, 1271808
  buffer_load_dwordx4 v208, s[36:39], s54 offen lds
  v_add_u32 v215, 118784, v210
  ds_read_b64_tr_b16 a[176:177], v215 offset:0
  ds_read_b64_tr_b16 a[178:179], v215 offset:1024
  ds_read_b64_tr_b16 a[180:181], v215 offset:4096
  ds_read_b64_tr_b16 a[182:183], v215 offset:5120
  ds_read_b64_tr_b16 a[184:185], v215 offset:8192
  ds_read_b64_tr_b16 a[186:187], v215 offset:9216
  ds_read_b64_tr_b16 a[188:189], v215 offset:12288
  ds_read_b64_tr_b16 a[190:191], v215 offset:13312
  s_waitcnt vmcnt(20) lgkmcnt(0)
  s_barrier
  s_add_u32 m0, s61, 81920
  s_add_u32 s54, s62, 1327104
  buffer_load_dwordx4 v207, s[36:39], s54 offen lds
  s_add_u32 m0, s61, 86016
  s_add_u32 s54, s62, 1382400
  buffer_load_dwordx4 v207, s[36:39], s54 offen lds
  s_add_u32 m0, s61, 90112
  s_add_u32 s54, s62, 1437696
  buffer_load_dwordx4 v207, s[36:39], s54 offen lds
  s_add_u32 m0, s61, 94208
  s_add_u32 s54, s62, 1492992
  buffer_load_dwordx4 v207, s[36:39], s54 offen lds
  v_add_u32 v215, 135168, v210
  ds_read_b64_tr_b16 a[48:49], v215 offset:0
  ds_read_b64_tr_b16 a[50:51], v215 offset:1024
  ds_read_b64_tr_b16 a[52:53], v215 offset:4096
  ds_read_b64_tr_b16 a[54:55], v215 offset:5120
  ds_read_b64_tr_b16 a[56:57], v215 offset:8192
  ds_read_b64_tr_b16 a[58:59], v215 offset:9216
  ds_read_b64_tr_b16 a[60:61], v215 offset:12288
  ds_read_b64_tr_b16 a[62:63], v215 offset:13312
  s_waitcnt vmcnt(20) lgkmcnt(0)
  s_barrier
  s_add_u32 m0, s61, 98304
  s_add_u32 s54, s62, 1327104
  buffer_load_dwordx4 v208, s[36:39], s54 offen lds
  s_add_u32 m0, s61, 102400
  s_add_u32 s54, s62, 1382400
  buffer_load_dwordx4 v208, s[36:39], s54 offen lds
  s_add_u32 m0, s61, 106496
  s_add_u32 s54, s62, 1437696
  buffer_load_dwordx4 v208, s[36:39], s54 offen lds
  s_add_u32 m0, s61, 110592
  s_add_u32 s54, s62, 1492992
  buffer_load_dwordx4 v208, s[36:39], s54 offen lds
  v_add_u32 v215, 36864, v210
  ds_read_b64_tr_b16 a[192:193], v215 offset:0
  ds_read_b64_tr_b16 a[194:195], v215 offset:1024
  ds_read_b64_tr_b16 a[196:197], v215 offset:4096
  ds_read_b64_tr_b16 a[198:199], v215 offset:5120
  ds_read_b64_tr_b16 a[200:201], v215 offset:8192
  ds_read_b64_tr_b16 a[202:203], v215 offset:9216
  ds_read_b64_tr_b16 a[204:205], v215 offset:12288
  ds_read_b64_tr_b16 a[206:207], v215 offset:13312
  s_waitcnt vmcnt(20) lgkmcnt(0)
  s_barrier
  s_add_u32 m0, s61, 0
  s_add_u32 s54, s62, 1548288
  buffer_load_dwordx4 v207, s[36:39], s54 offen lds
  s_add_u32 m0, s61, 4096
  s_add_u32 s54, s62, 1603584
  buffer_load_dwordx4 v207, s[36:39], s54 offen lds
  s_add_u32 m0, s61, 8192
  s_add_u32 s54, s62, 1658880
  buffer_load_dwordx4 v207, s[36:39], s54 offen lds
  s_add_u32 m0, s61, 12288
  s_add_u32 s54, s62, 1714176
  buffer_load_dwordx4 v207, s[36:39], s54 offen lds
  v_add_u32 v215, 53248, v210
  ds_read_b64_tr_b16 a[64:65], v215 offset:0
  ds_read_b64_tr_b16 a[66:67], v215 offset:1024
  ds_read_b64_tr_b16 a[68:69], v215 offset:4096
  ds_read_b64_tr_b16 a[70:71], v215 offset:5120
  ds_read_b64_tr_b16 a[72:73], v215 offset:8192
  ds_read_b64_tr_b16 a[74:75], v215 offset:9216
  ds_read_b64_tr_b16 a[76:77], v215 offset:12288
  ds_read_b64_tr_b16 a[78:79], v215 offset:13312
  s_waitcnt vmcnt(20) lgkmcnt(0)
  s_barrier
  s_add_u32 m0, s61, 16384
  s_add_u32 s54, s62, 1548288
  buffer_load_dwordx4 v208, s[36:39], s54 offen lds
  s_add_u32 m0, s61, 20480
  s_add_u32 s54, s62, 1603584
  buffer_load_dwordx4 v208, s[36:39], s54 offen lds
  s_add_u32 m0, s61, 24576
  s_add_u32 s54, s62, 1658880
  buffer_load_dwordx4 v208, s[36:39], s54 offen lds
  s_add_u32 m0, s61, 28672
  s_add_u32 s54, s62, 1714176
  buffer_load_dwordx4 v208, s[36:39], s54 offen lds
  v_add_u32 v215, 69632, v210
  ds_read_b64_tr_b16 a[208:209], v215 offset:0
  ds_read_b64_tr_b16 a[210:211], v215 offset:1024
  ds_read_b64_tr_b16 a[212:213], v215 offset:4096
  ds_read_b64_tr_b16 a[214:215], v215 offset:5120
  ds_read_b64_tr_b16 a[216:217], v215 offset:8192
  ds_read_b64_tr_b16 a[218:219], v215 offset:9216
  ds_read_b64_tr_b16 a[220:221], v215 offset:12288
  ds_read_b64_tr_b16 a[222:223], v215 offset:13312
  s_waitcnt vmcnt(20) lgkmcnt(0)
  s_barrier
  s_add_u32 m0, s61, 32768
  s_add_u32 s54, s62, 1769472
  buffer_load_dwordx4 v207, s[36:39], s54 offen lds
  s_add_u32 m0, s61, 36864
  s_add_u32 s54, s62, 1824768
  buffer_load_dwordx4 v207, s[36:39], s54 offen lds
  s_add_u32 m0, s61, 40960
  s_add_u32 s54, s62, 1880064
  buffer_load_dwordx4 v207, s[36:39], s54 offen lds
  s_add_u32 m0, s61, 45056
  s_add_u32 s54, s62, 1935360
  buffer_load_dwordx4 v207, s[36:39], s54 offen lds
  v_add_u32 v215, 86016, v210
  ds_read_b64_tr_b16 a[80:81], v215 offset:0
  ds_read_b64_tr_b16 a[82:83], v215 offset:1024
  ds_read_b64_tr_b16 a[84:85], v215 offset:4096
  ds_read_b64_tr_b16 a[86:87], v215 offset:5120
  ds_read_b64_tr_b16 a[88:89], v215 offset:8192
  ds_read_b64_tr_b16 a[90:91], v215 offset:9216
  ds_read_b64_tr_b16 a[92:93], v215 offset:12288
  ds_read_b64_tr_b16 a[94:95], v215 offset:13312
  s_waitcnt vmcnt(20) lgkmcnt(0)
  s_barrier
  s_add_u32 m0, s61, 49152
  s_add_u32 s54, s62, 1769472
  buffer_load_dwordx4 v208, s[36:39], s54 offen lds
  s_add_u32 m0, s61, 53248
  s_add_u32 s54, s62, 1824768
  buffer_load_dwordx4 v208, s[36:39], s54 offen lds
  s_add_u32 m0, s61, 57344
  s_add_u32 s54, s62, 1880064
  buffer_load_dwordx4 v208, s[36:39], s54 offen lds
  s_add_u32 m0, s61, 61440
  s_add_u32 s54, s62, 1935360
  buffer_load_dwordx4 v208, s[36:39], s54 offen lds
  v_add_u32 v215, 102400, v210
  ds_read_b64_tr_b16 a[224:225], v215 offset:0
  ds_read_b64_tr_b16 a[226:227], v215 offset:1024
  ds_read_b64_tr_b16 a[228:229], v215 offset:4096
  ds_read_b64_tr_b16 a[230:231], v215 offset:5120
  ds_read_b64_tr_b16 a[232:233], v215 offset:8192
  ds_read_b64_tr_b16 a[234:235], v215 offset:9216
  ds_read_b64_tr_b16 a[236:237], v215 offset:12288
  ds_read_b64_tr_b16 a[238:239], v215 offset:13312
  s_waitcnt vmcnt(20) lgkmcnt(0)
  s_barrier
  v_add_u32 v215, 118784, v210
  ds_read_b64_tr_b16 a[96:97], v215 offset:0
  ds_read_b64_tr_b16 a[98:99], v215 offset:1024
  ds_read_b64_tr_b16 a[100:101], v215 offset:4096
  ds_read_b64_tr_b16 a[102:103], v215 offset:5120
  ds_read_b64_tr_b16 a[104:105], v215 offset:8192
  ds_read_b64_tr_b16 a[106:107], v215 offset:9216
  ds_read_b64_tr_b16 a[108:109], v215 offset:12288
  ds_read_b64_tr_b16 a[110:111], v215 offset:13312
  s_waitcnt vmcnt(16) lgkmcnt(0)
  s_barrier
  v_add_u32 v215, 135168, v210
  ds_read_b64_tr_b16 a[240:241], v215 offset:0
  ds_read_b64_tr_b16 a[242:243], v215 offset:1024
  ds_read_b64_tr_b16 a[244:245], v215 offset:4096
  ds_read_b64_tr_b16 a[246:247], v215 offset:5120
  ds_read_b64_tr_b16 a[248:249], v215 offset:8192
  ds_read_b64_tr_b16 a[250:251], v215 offset:9216
  ds_read_b64_tr_b16 a[252:253], v215 offset:12288
  ds_read_b64_tr_b16 a[254:255], v215 offset:13312
  s_waitcnt vmcnt(12) lgkmcnt(0)
  s_barrier
  v_add_u32 v215, 36864, v210
  ds_read_b64_tr_b16 a[112:113], v215 offset:0
  ds_read_b64_tr_b16 a[114:115], v215 offset:1024
  ds_read_b64_tr_b16 a[116:117], v215 offset:4096
  ds_read_b64_tr_b16 a[118:119], v215 offset:5120
  ds_read_b64_tr_b16 a[120:121], v215 offset:8192
  ds_read_b64_tr_b16 a[122:123], v215 offset:9216
  ds_read_b64_tr_b16 a[124:125], v215 offset:12288
  ds_read_b64_tr_b16 a[126:127], v215 offset:13312
  s_waitcnt vmcnt(8) lgkmcnt(0)
  s_barrier
  v_add_u32 v215, 53248, v210
  ds_read_b64_tr_b16 v[224:225], v215 offset:0
  ds_read_b64_tr_b16 v[226:227], v215 offset:1024
  ds_read_b64_tr_b16 v[228:229], v215 offset:4096
  ds_read_b64_tr_b16 v[230:231], v215 offset:5120
  ds_read_b64_tr_b16 v[232:233], v215 offset:8192
  ds_read_b64_tr_b16 v[234:235], v215 offset:9216
  ds_read_b64_tr_b16 v[236:237], v215 offset:12288
  ds_read_b64_tr_b16 v[238:239], v215 offset:13312
  s_waitcnt vmcnt(4) lgkmcnt(0)
  s_barrier
  v_add_u32 v215, 69632, v210
  ds_read_b64_tr_b16 a[128:129], v215 offset:0
  ds_read_b64_tr_b16 a[130:131], v215 offset:1024
  ds_read_b64_tr_b16 a[132:133], v215 offset:4096
  ds_read_b64_tr_b16 a[134:135], v215 offset:5120
  ds_read_b64_tr_b16 a[136:137], v215 offset:8192
  ds_read_b64_tr_b16 a[138:139], v215 offset:9216
  ds_read_b64_tr_b16 a[140:141], v215 offset:12288
  ds_read_b64_tr_b16 a[142:143], v215 offset:13312
  s_waitcnt vmcnt(0) lgkmcnt(0)
  s_barrier
  v_add_u32 v215, 86016, v210
  ds_read_b64_tr_b16 v[240:241], v215 offset:0
  ds_read_b64_tr_b16 v[242:243], v215 offset:1024
  ds_read_b64_tr_b16 v[244:245], v215 offset:4096
  ds_read_b64_tr_b16 v[246:247], v215 offset:5120
  ds_read_b64_tr_b16 v[248:249], v215 offset:8192
  ds_read_b64_tr_b16 v[250:251], v215 offset:9216
  ds_read_b64_tr_b16 v[252:253], v215 offset:12288
  ds_read_b64_tr_b16 v[254:255], v215 offset:13312
  s_waitcnt lgkmcnt(0)
  s_barrier
  v_and_b32 v211, 31, v200
  v_mul_u32_u24 v218, 516, v211
  v_lshrrev_b32 v212, 5, v200
  v_lshl_add_u32 v218, v212, 3, v218
  s_lshl_b32 s54, s52, 6
  s_add_u32 s54, s54, 73728
  v_add_u32 v218, s54, v218
  s_lshl_b32 s60, s69, 2
  s_mul_i32 s60, s60, 36864
  ds_read_b128 v[32:35], v203 offset:0
  ds_read_b128 v[36:39], v204 offset:0
  ds_read_b128 v[40:43], v205 offset:0
  s_waitcnt lgkmcnt(2)
  v_mfma_f32_32x32x16_bf16 v[0:15], a[0:3], v[32:35], 0
  ds_read_b128 v[44:47], v206 offset:0
  s_add_u32 m0, s67, 36864
  s_nop 0
  buffer_load_dwordx4 v202, s[4:7], s60 offen offset:0 lds
  v_mfma_f32_32x32x16_bf16 v[16:31], a[144:147], v[32:35], 0
  s_waitcnt lgkmcnt(2)
  v_mfma_f32_32x32x16_bf16 v[0:15], a[4:7], v[36:39], v[0:15]
  ds_read_b128 v[32:35], v203 offset:1024
  s_add_u32 m0, s67, 37760
  s_nop 0
  buffer_load_dwordx4 v202, s[4:7], s60 offen offset:128 lds
  v_mfma_f32_32x32x16_bf16 v[16:31], a[148:151], v[36:39], v[16:31]
  s_waitcnt lgkmcnt(2)
  v_mfma_f32_32x32x16_bf16 v[0:15], a[8:11], v[40:43], v[0:15]
  ds_read_b128 v[36:39], v204 offset:1024
  s_add_u32 m0, s67, 38656
  s_nop 0
  buffer_load_dwordx4 v202, s[4:7], s60 offen offset:256 lds
  v_mfma_f32_32x32x16_bf16 v[16:31], a[152:155], v[40:43], v[16:31]
  s_waitcnt lgkmcnt(2)
  v_mfma_f32_32x32x16_bf16 v[0:15], a[12:15], v[44:47], v[0:15]
  ds_read_b128 v[40:43], v205 offset:1024
  s_add_u32 m0, s67, 39552
  s_nop 0
  buffer_load_dwordx4 v202, s[4:7], s60 offen offset:384 lds
  v_mfma_f32_32x32x16_bf16 v[16:31], a[156:159], v[44:47], v[16:31]
  s_waitcnt lgkmcnt(2)
  v_mfma_f32_32x32x16_bf16 v[0:15], a[16:19], v[32:35], v[0:15]
  ds_read_b128 v[44:47], v206 offset:1024
  s_add_u32 m0, s67, 40448
  s_nop 0
  buffer_load_dwordx4 v202, s[4:7], s60 offen offset:512 lds
  v_mfma_f32_32x32x16_bf16 v[16:31], a[160:163], v[32:35], v[16:31]
  s_waitcnt lgkmcnt(2)
  v_mfma_f32_32x32x16_bf16 v[0:15], a[20:23], v[36:39], v[0:15]
  ds_read_b128 v[32:35], v203 offset:2048
  s_add_u32 m0, s67, 41344
  s_nop 0
  buffer_load_dwordx4 v202, s[4:7], s60 offen offset:640 lds
  v_mfma_f32_32x32x16_bf16 v[16:31], a[164:167], v[36:39], v[16:31]
  s_waitcnt lgkmcnt(2)
  v_mfma_f32_32x32x16_bf16 v[0:15], a[24:27], v[40:43], v[0:15]
  ds_read_b128 v[36:39], v204 offset:2048
  s_add_u32 m0, s67, 42240
  s_nop 0
  buffer_load_dwordx4 v202, s[4:7], s60 offen offset:768 lds
  v_mfma_f32_32x32x16_bf16 v[16:31], a[168:171], v[40:43], v[16:31]
  s_waitcnt lgkmcnt(2)
  v_mfma_f32_32x32x16_bf16 v[0:15], a[28:31], v[44:47], v[0:15]
  ds_read_b128 v[40:43], v205 offset:2048
  s_add_u32 m0, s67, 43136
  s_nop 0
  buffer_load_dwordx4 v202, s[4:7], s60 offen offset:896 lds
  v_mfma_f32_32x32x16_bf16 v[16:31], a[172:175], v[44:47], v[16:31]
  s_waitcnt lgkmcnt(2)
  v_mfma_f32_32x32x16_bf16 v[0:15], a[32:35], v[32:35], v[0:15]
  ds_read_b128 v[44:47], v206 offset:2048
  s_add_u32 m0, s67, 44032
  s_nop 0
  buffer_load_dwordx4 v202, s[4:7], s60 offen offset:1024 lds
  v_mfma_f32_32x32x16_bf16 v[16:31], a[176:179], v[32:35], v[16:31]
  s_waitcnt lgkmcnt(2)
  v_mfma_f32_32x32x16_bf16 v[0:15], a[36:39], v[36:39], v[0:15]
  ds_read_b128 v[32:35], v203 offset:3072
  v_mfma_f32_32x32x16_bf16 v[16:31], a[180:183], v[36:39], v[16:31]
  s_waitcnt lgkmcnt(2)
  v_mfma_f32_32x32x16_bf16 v[0:15], a[40:43], v[40:43], v[0:15]
  ds_read_b128 v[36:39], v204 offset:3072
  v_mfma_f32_32x32x16_bf16 v[16:31], a[184:187], v[40:43], v[16:31]
  s_waitcnt lgkmcnt(2)
  v_mfma_f32_32x32x16_bf16 v[0:15], a[44:47], v[44:47], v[0:15]
  ds_read_b128 v[40:43], v205 offset:3072
  v_mfma_f32_32x32x16_bf16 v[16:31], a[188:191], v[44:47], v[16:31]
  s_waitcnt lgkmcnt(2)
  v_mfma_f32_32x32x16_bf16 v[0:15], a[48:51], v[32:35], v[0:15]
  ds_read_b128 v[44:47], v206 offset:3072
  v_mfma_f32_32x32x16_bf16 v[16:31], a[192:195], v[32:35], v[16:31]
  s_waitcnt lgkmcnt(2)
  v_mfma_f32_32x32x16_bf16 v[0:15], a[52:55], v[36:39], v[0:15]
  ds_read_b128 v[32:35], v203 offset:4096
  v_mfma_f32_32x32x16_bf16 v[16:31], a[196:199], v[36:39], v[16:31]
  s_waitcnt lgkmcnt(2)
  v_mfma_f32_32x32x16_bf16 v[0:15], a[56:59], v[40:43], v[0:15]
  ds_read_b128 v[36:39], v204 offset:4096
  v_mfma_f32_32x32x16_bf16 v[16:31], a[200:203], v[40:43], v[16:31]
  s_waitcnt lgkmcnt(2)
  v_mfma_f32_32x32x16_bf16 v[0:15], a[60:63], v[44:47], v[0:15]
  ds_read_b128 v[40:43], v205 offset:4096
  v_mfma_f32_32x32x16_bf16 v[16:31], a[204:207], v[44:47], v[16:31]
  s_waitcnt lgkmcnt(2)
  v_mfma_f32_32x32x16_bf16 v[0:15], a[64:67], v[32:35], v[0:15]
  ds_read_b128 v[44:47], v206 offset:4096
  v_mfma_f32_32x32x16_bf16 v[16:31], a[208:211], v[32:35], v[16:31]
  s_waitcnt lgkmcnt(2)
  v_mfma_f32_32x32x16_bf16 v[0:15], a[68:71], v[36:39], v[0:15]
  ds_read_b128 v[32:35], v203 offset:5120
  v_mfma_f32_32x32x16_bf16 v[16:31], a[212:215], v[36:39], v[16:31]
  s_waitcnt lgkmcnt(2)
  v_mfma_f32_32x32x16_bf16 v[0:15], a[72:75], v[40:43], v[0:15]
  ds_read_b128 v[36:39], v204 offset:5120
  v_mfma_f32_32x32x16_bf16 v[16:31], a[216:219], v[40:43], v[16:31]
  s_waitcnt lgkmcnt(2)
  v_mfma_f32_32x32x16_bf16 v[0:15], a[76:79], v[44:47], v[0:15]
  ds_read_b128 v[40:43], v205 offset:5120
  v_mfma_f32_32x32x16_bf16 v[16:31], a[220:223], v[44:47], v[16:31]
  s_waitcnt lgkmcnt(2)
  v_mfma_f32_32x32x16_bf16 v[0:15], a[80:83], v[32:35], v[0:15]
  ds_read_b128 v[44:47], v206 offset:5120
  v_mfma_f32_32x32x16_bf16 v[16:31], a[224:227], v[32:35], v[16:31]
  s_waitcnt lgkmcnt(2)
  v_mfma_f32_32x32x16_bf16 v[0:15], a[84:87], v[36:39], v[0:15]
  ds_read_b128 v[32:35], v203 offset:6144
  v_mfma_f32_32x32x16_bf16 v[16:31], a[228:231], v[36:39], v[16:31]
  s_waitcnt lgkmcnt(2)
  v_mfma_f32_32x32x16_bf16 v[0:15], a[88:91], v[40:43], v[0:15]
  ds_read_b128 v[36:39], v204 offset:6144
  v_mfma_f32_32x32x16_bf16 v[16:31], a[232:235], v[40:43], v[16:31]
  s_waitcnt lgkmcnt(2)
  v_mfma_f32_32x32x16_bf16 v[0:15], a[92:95], v[44:47], v[0:15]
  ds_read_b128 v[40:43], v205 offset:6144
  v_mfma_f32_32x32x16_bf16 v[16:31], a[236:239], v[44:47], v[16:31]
  s_waitcnt lgkmcnt(2)
  v_mfma_f32_32x32x16_bf16 v[0:15], a[96:99], v[32:35], v[0:15]
  ds_read_b128 v[44:47], v206 offset:6144
  v_mfma_f32_32x32x16_bf16 v[16:31], a[240:243], v[32:35], v[16:31]
  s_waitcnt lgkmcnt(2)
  v_mfma_f32_32x32x16_bf16 v[0:15], a[100:103], v[36:39], v[0:15]
  ds_read_b128 v[32:35], v203 offset:7168
  v_mfma_f32_32x32x16_bf16 v[16:31], a[244:247], v[36:39], v[16:31]
  s_waitcnt lgkmcnt(2)
  v_mfma_f32_32x32x16_bf16 v[0:15], a[104:107], v[40:43], v[0:15]
  ds_read_b128 v[36:39], v204 offset:7168
  v_mfma_f32_32x32x16_bf16 v[16:31], a[248:251], v[40:43], v[16:31]
  s_waitcnt lgkmcnt(2)
  v_mfma_f32_32x32x16_bf16 v[0:15], a[108:111], v[44:47], v[0:15]
  ds_read_b128 v[40:43], v205 offset:7168
  v_mfma_f32_32x32x16_bf16 v[16:31], a[252:255], v[44:47], v[16:31]
  s_waitcnt lgkmcnt(2)
  v_mfma_f32_32x32x16_bf16 v[0:15], a[112:115], v[32:35], v[0:15]
  ds_read_b128 v[44:47], v206 offset:7168
  v_mfma_f32_32x32x16_bf16 v[16:31], v[224:227], v[32:35], v[16:31]
  s_waitcnt lgkmcnt(2)
  v_mfma_f32_32x32x16_bf16 v[0:15], a[116:119], v[36:39], v[0:15]
  ds_read_b128 v[32:35], v203 offset:8192
  v_mfma_f32_32x32x16_bf16 v[16:31], v[228:231], v[36:39], v[16:31]
  s_waitcnt lgkmcnt(2)
  v_mfma_f32_32x32x16_bf16 v[0:15], a[120:123], v[40:43], v[0:15]
  ds_read_b128 v[36:39], v204 offset:8192
  v_mfma_f32_32x32x16_bf16 v[16:31], v[232:235], v[40:43], v[16:31]
  s_waitcnt lgkmcnt(2)
  v_mfma_f32_32x32x16_bf16 v[0:15], a[124:127], v[44:47], v[0:15]
  ds_read_b128 v[40:43], v205 offset:8192
  v_mfma_f32_32x32x16_bf16 v[16:31], v[236:239], v[44:47], v[16:31]
  s_waitcnt lgkmcnt(2)
  v_mfma_f32_32x32x16_bf16 v[0:15], a[128:131], v[32:35], v[0:15]
  ds_read_b128 v[44:47], v206 offset:8192
  v_mfma_f32_32x32x16_bf16 v[16:31], v[240:243], v[32:35], v[16:31]
  s_waitcnt lgkmcnt(2)
  v_mfma_f32_32x32x16_bf16 v[0:15], a[132:135], v[36:39], v[0:15]
  v_mfma_f32_32x32x16_bf16 v[16:31], v[244:247], v[36:39], v[16:31]
  s_waitcnt lgkmcnt(1)
  v_mfma_f32_32x32x16_bf16 v[0:15], a[136:139], v[40:43], v[0:15]
  v_mfma_f32_32x32x16_bf16 v[16:31], v[248:251], v[40:43], v[16:31]
  s_waitcnt lgkmcnt(0)
  v_mfma_f32_32x32x16_bf16 v[0:15], a[140:143], v[44:47], v[0:15]
  v_mfma_f32_32x32x16_bf16 v[16:31], v[252:255], v[44:47], v[16:31]
  s_add_u32 s60, s60, 36864
  s_nop 2
  v_cvt_pk_bf16_f32 v48, v0, v1
  v_cvt_pk_bf16_f32 v49, v2, v3
  ds_write2_b32 v218, v48, v49 offset0:0 offset1:1
  v_cvt_pk_bf16_f32 v48, v4, v5
  v_cvt_pk_bf16_f32 v49, v6, v7
  ds_write2_b32 v218, v48, v49 offset0:4 offset1:5
  v_cvt_pk_bf16_f32 v48, v8, v9
  v_cvt_pk_bf16_f32 v49, v10, v11
  ds_write2_b32 v218, v48, v49 offset0:8 offset1:9
  v_cvt_pk_bf16_f32 v48, v12, v13
  v_cvt_pk_bf16_f32 v49, v14, v15
  ds_write2_b32 v218, v48, v49 offset0:12 offset1:13
  v_cvt_pk_bf16_f32 v48, v16, v17
  v_cvt_pk_bf16_f32 v49, v18, v19
  ds_write2_b32 v218, v48, v49 offset0:64 offset1:65
  v_cvt_pk_bf16_f32 v48, v20, v21
  v_cvt_pk_bf16_f32 v49, v22, v23
  ds_write2_b32 v218, v48, v49 offset0:68 offset1:69
  v_cvt_pk_bf16_f32 v48, v24, v25
  v_cvt_pk_bf16_f32 v49, v26, v27
  ds_write2_b32 v218, v48, v49 offset0:72 offset1:73
  v_cvt_pk_bf16_f32 v48, v28, v29
  v_cvt_pk_bf16_f32 v49, v30, v31
  ds_write2_b32 v218, v48, v49 offset0:76 offset1:77
  v_add_u32 v218, 16512, v218
  s_waitcnt vmcnt(0) lgkmcnt(0)
  s_barrier
  ds_read_b128 v[32:35], v203 offset:36864
  ds_read_b128 v[36:39], v204 offset:36864
  ds_read_b128 v[40:43], v205 offset:36864
  s_waitcnt lgkmcnt(2)
  v_mfma_f32_32x32x16_bf16 v[0:15], a[0:3], v[32:35], 0
  ds_read_b128 v[44:47], v206 offset:36864
  s_add_u32 m0, s67, 0
  s_nop 0
  buffer_load_dwordx4 v202, s[4:7], s60 offen offset:0 lds
  v_mfma_f32_32x32x16_bf16 v[16:31], a[144:147], v[32:35], 0
  s_waitcnt lgkmcnt(2)
  v_mfma_f32_32x32x16_bf16 v[0:15], a[4:7], v[36:39], v[0:15]
  ds_read_b128 v[32:35], v203 offset:37888
  s_add_u32 m0, s67, 896
  s_nop 0
  buffer_load_dwordx4 v202, s[4:7], s60 offen offset:128 lds
  v_mfma_f32_32x32x16_bf16 v[16:31], a[148:151], v[36:39], v[16:31]
  s_waitcnt lgkmcnt(2)
  v_mfma_f32_32x32x16_bf16 v[0:15], a[8:11], v[40:43], v[0:15]
  ds_read_b128 v[36:39], v204 offset:37888
  s_add_u32 m0, s67, 1792
  s_nop 0
  buffer_load_dwordx4 v202, s[4:7], s60 offen offset:256 lds
  v_mfma_f32_32x32x16_bf16 v[16:31], a[152:155], v[40:43], v[16:31]
  s_waitcnt lgkmcnt(2)
  v_mfma_f32_32x32x16_bf16 v[0:15], a[12:15], v[44:47], v[0:15]
  ds_read_b128 v[40:43], v205 offset:37888
  s_add_u32 m0, s67, 2688
  s_nop 0
  buffer_load_dwordx4 v202, s[4:7], s60 offen offset:384 lds
  v_mfma_f32_32x32x16_bf16 v[16:31], a[156:159], v[44:47], v[16:31]
  s_waitcnt lgkmcnt(2)
  v_mfma_f32_32x32x16_bf16 v[0:15], a[16:19], v[32:35], v[0:15]
  ds_read_b128 v[44:47], v206 offset:37888
  s_add_u32 m0, s67, 3584
  s_nop 0
  buffer_load_dwordx4 v202, s[4:7], s60 offen offset:512 lds
  v_mfma_f32_32x32x16_bf16 v[16:31], a[160:163], v[32:35], v[16:31]
  s_waitcnt lgkmcnt(2)
  v_mfma_f32_32x32x16_bf16 v[0:15], a[20:23], v[36:39], v[0:15]
  ds_read_b128 v[32:35], v203 offset:38912
  s_add_u32 m0, s67, 4480
  s_nop 0
  buffer_load_dwordx4 v202, s[4:7], s60 offen offset:640 lds
  v_mfma_f32_32x32x16_bf16 v[16:31], a[164:167], v[36:39], v[16:31]
  s_waitcnt lgkmcnt(2)
  v_mfma_f32_32x32x16_bf16 v[0:15], a[24:27], v[40:43], v[0:15]
  ds_read_b128 v[36:39], v204 offset:38912
  s_add_u32 m0, s67, 5376
  s_nop 0
  buffer_load_dwordx4 v202, s[4:7], s60 offen offset:768 lds
  v_mfma_f32_32x32x16_bf16 v[16:31], a[168:171], v[40:43], v[16:31]
  s_waitcnt lgkmcnt(2)
  v_mfma_f32_32x32x16_bf16 v[0:15], a[28:31], v[44:47], v[0:15]
  ds_read_b128 v[40:43], v205 offset:38912
  s_add_u32 m0, s67, 6272
  s_nop 0
  buffer_load_dwordx4 v202, s[4:7], s60 offen offset:896 lds
  v_mfma_f32_32x32x16_bf16 v[16:31], a[172:175], v[44:47], v[16:31]
  s_waitcnt lgkmcnt(2)
  v_mfma_f32_32x32x16_bf16 v[0:15], a[32:35], v[32:35], v[0:15]
  ds_read_b128 v[44:47], v206 offset:38912
  s_add_u32 m0, s67, 7168
  s_nop 0
  buffer_load_dwordx4 v202, s[4:7], s60 offen offset:1024 lds
  v_mfma_f32_32x32x16_bf16 v[16:31], a[176:179], v[32:35], v[16:31]
  s_waitcnt lgkmcnt(2)
  v_mfma_f32_32x32x16_bf16 v[0:15], a[36:39], v[36:39], v[0:15]
  ds_read_b128 v[32:35], v203 offset:39936
  v_mfma_f32_32x32x16_bf16 v[16:31], a[180:183], v[36:39], v[16:31]
  s_waitcnt lgkmcnt(2)
  v_mfma_f32_32x32x16_bf16 v[0:15], a[40:43], v[40:43], v[0:15]
  ds_read_b128 v[36:39], v204 offset:39936
  v_mfma_f32_32x32x16_bf16 v[16:31], a[184:187], v[40:43], v[16:31]
  s_waitcnt lgkmcnt(2)
  v_mfma_f32_32x32x16_bf16 v[0:15], a[44:47], v[44:47], v[0:15]
  ds_read_b128 v[40:43], v205 offset:39936
  v_mfma_f32_32x32x16_bf16 v[16:31], a[188:191], v[44:47], v[16:31]
  s_waitcnt lgkmcnt(2)
  v_mfma_f32_32x32x16_bf16 v[0:15], a[48:51], v[32:35], v[0:15]
  ds_read_b128 v[44:47], v206 offset:39936
  v_mfma_f32_32x32x16_bf16 v[16:31], a[192:195], v[32:35], v[16:31]
  s_waitcnt lgkmcnt(2)
  v_mfma_f32_32x32x16_bf16 v[0:15], a[52:55], v[36:39], v[0:15]
  ds_read_b128 v[32:35], v203 offset:40960
  v_mfma_f32_32x32x16_bf16 v[16:31], a[196:199], v[36:39], v[16:31]
  s_waitcnt lgkmcnt(2)
  v_mfma_f32_32x32x16_bf16 v[0:15], a[56:59], v[40:43], v[0:15]
  ds_read_b128 v[36:39], v204 offset:40960
  v_mfma_f32_32x32x16_bf16 v[16:31], a[200:203], v[40:43], v[16:31]
  s_waitcnt lgkmcnt(2)
  v_mfma_f32_32x32x16_bf16 v[0:15], a[60:63], v[44:47], v[0:15]
  ds_read_b128 v[40:43], v205 offset:40960
  v_mfma_f32_32x32x16_bf16 v[16:31], a[204:207], v[44:47], v[16:31]
  s_waitcnt lgkmcnt(2)
  v_mfma_f32_32x32x16_bf16 v[0:15], a[64:67], v[32:35], v[0:15]
  ds_read_b128 v[44:47], v206 offset:40960
  v_mfma_f32_32x32x16_bf16 v[16:31], a[208:211], v[32:35], v[16:31]
  s_waitcnt lgkmcnt(2)
  v_mfma_f32_32x32x16_bf16 v[0:15], a[68:71], v[36:39], v[0:15]
  ds_read_b128 v[32:35], v203 offset:41984
  v_mfma_f32_32x32x16_bf16 v[16:31], a[212:215], v[36:39], v[16:31]
  s_waitcnt lgkmcnt(2)
  v_mfma_f32_32x32x16_bf16 v[0:15], a[72:75], v[40:43], v[0:15]
  ds_read_b128 v[36:39], v204 offset:41984
  v_mfma_f32_32x32x16_bf16 v[16:31], a[216:219], v[40:43], v[16:31]
  s_waitcnt lgkmcnt(2)
  v_mfma_f32_32x32x16_bf16 v[0:15], a[76:79], v[44:47], v[0:15]
  ds_read_b128 v[40:43], v205 offset:41984
  v_mfma_f32_32x32x16_bf16 v[16:31], a[220:223], v[44:47], v[16:31]
  s_waitcnt lgkmcnt(2)
  v_mfma_f32_32x32x16_bf16 v[0:15], a[80:83], v[32:35], v[0:15]
  ds_read_b128 v[44:47], v206 offset:41984
  v_mfma_f32_32x32x16_bf16 v[16:31], a[224:227], v[32:35], v[16:31]
  s_waitcnt lgkmcnt(2)
  v_mfma_f32_32x32x16_bf16 v[0:15], a[84:87], v[36:39], v[0:15]
  ds_read_b128 v[32:35], v203 offset:43008
  v_mfma_f32_32x32x16_bf16 v[16:31], a[228:231], v[36:39], v[16:31]
  s_waitcnt lgkmcnt(2)
  v_mfma_f32_32x32x16_bf16 v[0:15], a[88:91], v[40:43], v[0:15]
  ds_read_b128 v[36:39], v204 offset:43008
  v_mfma_f32_32x32x16_bf16 v[16:31], a[232:235], v[40:43], v[16:31]
  s_waitcnt lgkmcnt(2)
  v_mfma_f32_32x32x16_bf16 v[0:15], a[92:95], v[44:47], v[0:15]
  ds_read_b128 v[40:43], v205 offset:43008
  v_mfma_f32_32x32x16_bf16 v[16:31], a[236:239], v[44:47], v[16:31]
  s_waitcnt lgkmcnt(2)
  v_mfma_f32_32x32x16_bf16 v[0:15], a[96:99], v[32:35], v[0:15]
  ds_read_b128 v[44:47], v206 offset:43008
  v_mfma_f32_32x32x16_bf16 v[16:31], a[240:243], v[32:35], v[16:31]
  s_waitcnt lgkmcnt(2)
  v_mfma_f32_32x32x16_bf16 v[0:15], a[100:103], v[36:39], v[0:15]
  ds_read_b128 v[32:35], v203 offset:44032
  v_mfma_f32_32x32x16_bf16 v[16:31], a[244:247], v[36:39], v[16:31]
  s_waitcnt lgkmcnt(2)
  v_mfma_f32_32x32x16_bf16 v[0:15], a[104:107], v[40:43], v[0:15]
  ds_read_b128 v[36:39], v204 offset:44032
  v_mfma_f32_32x32x16_bf16 v[16:31], a[248:251], v[40:43], v[16:31]
  s_waitcnt lgkmcnt(2)
  v_mfma_f32_32x32x16_bf16 v[0:15], a[108:111], v[44:47], v[0:15]
  ds_read_b128 v[40:43], v205 offset:44032
  v_mfma_f32_32x32x16_bf16 v[16:31], a[252:255], v[44:47], v[16:31]
  s_waitcnt lgkmcnt(2)
  v_mfma_f32_32x32x16_bf16 v[0:15], a[112:115], v[32:35], v[0:15]
  ds_read_b128 v[44:47], v206 offset:44032
  v_mfma_f32_32x32x16_bf16 v[16:31], v[224:227], v[32:35], v[16:31]
  s_waitcnt lgkmcnt(2)
  v_mfma_f32_32x32x16_bf16 v[0:15], a[116:119], v[36:39], v[0:15]
  ds_read_b128 v[32:35], v203 offset:45056
  v_mfma_f32_32x32x16_bf16 v[16:31], v[228:231], v[36:39], v[16:31]
  s_waitcnt lgkmcnt(2)
  v_mfma_f32_32x32x16_bf16 v[0:15], a[120:123], v[40:43], v[0:15]
  ds_read_b128 v[36:39], v204 offset:45056
  v_mfma_f32_32x32x16_bf16 v[16:31], v[232:235], v[40:43], v[16:31]
  s_waitcnt lgkmcnt(2)
  v_mfma_f32_32x32x16_bf16 v[0:15], a[124:127], v[44:47], v[0:15]
  ds_read_b128 v[40:43], v205 offset:45056
  v_mfma_f32_32x32x16_bf16 v[16:31], v[236:239], v[44:47], v[16:31]
  s_waitcnt lgkmcnt(2)
  v_mfma_f32_32x32x16_bf16 v[0:15], a[128:131], v[32:35], v[0:15]
  ds_read_b128 v[44:47], v206 offset:45056
  v_mfma_f32_32x32x16_bf16 v[16:31], v[240:243], v[32:35], v[16:31]
  s_waitcnt lgkmcnt(2)
  v_mfma_f32_32x32x16_bf16 v[0:15], a[132:135], v[36:39], v[0:15]
  v_mfma_f32_32x32x16_bf16 v[16:31], v[244:247], v[36:39], v[16:31]
  s_waitcnt lgkmcnt(1)
  v_mfma_f32_32x32x16_bf16 v[0:15], a[136:139], v[40:43], v[0:15]
  v_mfma_f32_32x32x16_bf16 v[16:31], v[248:251], v[40:43], v[16:31]
  s_waitcnt lgkmcnt(0)
  v_mfma_f32_32x32x16_bf16 v[0:15], a[140:143], v[44:47], v[0:15]
  v_mfma_f32_32x32x16_bf16 v[16:31], v[252:255], v[44:47], v[16:31]
  s_add_u32 s60, s60, 36864
  s_nop 2
  v_cvt_pk_bf16_f32 v48, v0, v1
  v_cvt_pk_bf16_f32 v49, v2, v3
  ds_write2_b32 v218, v48, v49 offset0:0 offset1:1
  v_cvt_pk_bf16_f32 v48, v4, v5
  v_cvt_pk_bf16_f32 v49, v6, v7
  ds_write2_b32 v218, v48, v49 offset0:4 offset1:5
  v_cvt_pk_bf16_f32 v48, v8, v9
  v_cvt_pk_bf16_f32 v49, v10, v11
  ds_write2_b32 v218, v48, v49 offset0:8 offset1:9
  v_cvt_pk_bf16_f32 v48, v12, v13
  v_cvt_pk_bf16_f32 v49, v14, v15
  ds_write2_b32 v218, v48, v49 offset0:12 offset1:13
  v_cvt_pk_bf16_f32 v48, v16, v17
  v_cvt_pk_bf16_f32 v49, v18, v19
  ds_write2_b32 v218, v48, v49 offset0:64 offset1:65
  v_cvt_pk_bf16_f32 v48, v20, v21
  v_cvt_pk_bf16_f32 v49, v22, v23
  ds_write2_b32 v218, v48, v49 offset0:68 offset1:69
  v_cvt_pk_bf16_f32 v48, v24, v25
  v_cvt_pk_bf16_f32 v49, v26, v27
  ds_write2_b32 v218, v48, v49 offset0:72 offset1:73
  v_cvt_pk_bf16_f32 v48, v28, v29
  v_cvt_pk_bf16_f32 v49, v30, v31
  ds_write2_b32 v218, v48, v49 offset0:76 offset1:77
  v_add_u32 v218, 16512, v218
  s_waitcnt vmcnt(0) lgkmcnt(0)
  s_barrier
  ds_read_b128 v[32:35], v203 offset:0
  ds_read_b128 v[36:39], v204 offset:0
  ds_read_b128 v[40:43], v205 offset:0
  s_waitcnt lgkmcnt(2)
  v_mfma_f32_32x32x16_bf16 v[0:15], a[0:3], v[32:35], 0
  ds_read_b128 v[44:47], v206 offset:0
  s_add_u32 m0, s67, 36864
  s_nop 0
  buffer_load_dwordx4 v202, s[4:7], s60 offen offset:0 lds
  v_mfma_f32_32x32x16_bf16 v[16:31], a[144:147], v[32:35], 0
  s_waitcnt lgkmcnt(2)
  v_mfma_f32_32x32x16_bf16 v[0:15], a[4:7], v[36:39], v[0:15]
  ds_read_b128 v[32:35], v203 offset:1024
  s_add_u32 m0, s67, 37760
  s_nop 0
  buffer_load_dwordx4 v202, s[4:7], s60 offen offset:128 lds
  v_mfma_f32_32x32x16_bf16 v[16:31], a[148:151], v[36:39], v[16:31]
  s_waitcnt lgkmcnt(2)
  v_mfma_f32_32x32x16_bf16 v[0:15], a[8:11], v[40:43], v[0:15]
  ds_read_b128 v[36:39], v204 offset:1024
  s_add_u32 m0, s67, 38656
  s_nop 0
  buffer_load_dwordx4 v202, s[4:7], s60 offen offset:256 lds
  v_mfma_f32_32x32x16_bf16 v[16:31], a[152:155], v[40:43], v[16:31]
  s_waitcnt lgkmcnt(2)
  v_mfma_f32_32x32x16_bf16 v[0:15], a[12:15], v[44:47], v[0:15]
  ds_read_b128 v[40:43], v205 offset:1024
  s_add_u32 m0, s67, 39552
  s_nop 0
  buffer_load_dwordx4 v202, s[4:7], s60 offen offset:384 lds
  v_mfma_f32_32x32x16_bf16 v[16:31], a[156:159], v[44:47], v[16:31]
  s_waitcnt lgkmcnt(2)
  v_mfma_f32_32x32x16_bf16 v[0:15], a[16:19], v[32:35], v[0:15]
  ds_read_b128 v[44:47], v206 offset:1024
  s_add_u32 m0, s67, 40448
  s_nop 0
  buffer_load_dwordx4 v202, s[4:7], s60 offen offset:512 lds
  v_mfma_f32_32x32x16_bf16 v[16:31], a[160:163], v[32:35], v[16:31]
  s_waitcnt lgkmcnt(2)
  v_mfma_f32_32x32x16_bf16 v[0:15], a[20:23], v[36:39], v[0:15]
  ds_read_b128 v[32:35], v203 offset:2048
  s_add_u32 m0, s67, 41344
  s_nop 0
  buffer_load_dwordx4 v202, s[4:7], s60 offen offset:640 lds
  v_mfma_f32_32x32x16_bf16 v[16:31], a[164:167], v[36:39], v[16:31]
  s_waitcnt lgkmcnt(2)
  v_mfma_f32_32x32x16_bf16 v[0:15], a[24:27], v[40:43], v[0:15]
  ds_read_b128 v[36:39], v204 offset:2048
  s_add_u32 m0, s67, 42240
  s_nop 0
  buffer_load_dwordx4 v202, s[4:7], s60 offen offset:768 lds
  v_mfma_f32_32x32x16_bf16 v[16:31], a[168:171], v[40:43], v[16:31]
  s_waitcnt lgkmcnt(2)
  v_mfma_f32_32x32x16_bf16 v[0:15], a[28:31], v[44:47], v[0:15]
  ds_read_b128 v[40:43], v205 offset:2048
  s_add_u32 m0, s67, 43136
  s_nop 0
  buffer_load_dwordx4 v202, s[4:7], s60 offen offset:896 lds
  v_mfma_f32_32x32x16_bf16 v[16:31], a[172:175], v[44:47], v[16:31]
  s_waitcnt lgkmcnt(2)
  v_mfma_f32_32x32x16_bf16 v[0:15], a[32:35], v[32:35], v[0:15]
  ds_read_b128 v[44:47], v206 offset:2048
  s_add_u32 m0, s67, 44032
  s_nop 0
  buffer_load_dwordx4 v202, s[4:7], s60 offen offset:1024 lds
  v_mfma_f32_32x32x16_bf16 v[16:31], a[176:179], v[32:35], v[16:31]
  s_waitcnt lgkmcnt(2)
  v_mfma_f32_32x32x16_bf16 v[0:15], a[36:39], v[36:39], v[0:15]
  ds_read_b128 v[32:35], v203 offset:3072
  v_mfma_f32_32x32x16_bf16 v[16:31], a[180:183], v[36:39], v[16:31]
  s_waitcnt lgkmcnt(2)
  v_mfma_f32_32x32x16_bf16 v[0:15], a[40:43], v[40:43], v[0:15]
  ds_read_b128 v[36:39], v204 offset:3072
  v_mfma_f32_32x32x16_bf16 v[16:31], a[184:187], v[40:43], v[16:31]
  s_waitcnt lgkmcnt(2)
  v_mfma_f32_32x32x16_bf16 v[0:15], a[44:47], v[44:47], v[0:15]
  ds_read_b128 v[40:43], v205 offset:3072
  v_mfma_f32_32x32x16_bf16 v[16:31], a[188:191], v[44:47], v[16:31]
  s_waitcnt lgkmcnt(2)
  v_mfma_f32_32x32x16_bf16 v[0:15], a[48:51], v[32:35], v[0:15]
  ds_read_b128 v[44:47], v206 offset:3072
  v_mfma_f32_32x32x16_bf16 v[16:31], a[192:195], v[32:35], v[16:31]
  s_waitcnt lgkmcnt(2)
  v_mfma_f32_32x32x16_bf16 v[0:15], a[52:55], v[36:39], v[0:15]
  ds_read_b128 v[32:35], v203 offset:4096
  v_mfma_f32_32x32x16_bf16 v[16:31], a[196:199], v[36:39], v[16:31]
  s_waitcnt lgkmcnt(2)
  v_mfma_f32_32x32x16_bf16 v[0:15], a[56:59], v[40:43], v[0:15]
  ds_read_b128 v[36:39], v204 offset:4096
  v_mfma_f32_32x32x16_bf16 v[16:31], a[200:203], v[40:43], v[16:31]
  s_waitcnt lgkmcnt(2)
  v_mfma_f32_32x32x16_bf16 v[0:15], a[60:63], v[44:47], v[0:15]
  ds_read_b128 v[40:43], v205 offset:4096
  v_mfma_f32_32x32x16_bf16 v[16:31], a[204:207], v[44:47], v[16:31]
  s_waitcnt lgkmcnt(2)
  v_mfma_f32_32x32x16_bf16 v[0:15], a[64:67], v[32:35], v[0:15]
  ds_read_b128 v[44:47], v206 offset:4096
  v_mfma_f32_32x32x16_bf16 v[16:31], a[208:211], v[32:35], v[16:31]
  s_waitcnt lgkmcnt(2)
  v_mfma_f32_32x32x16_bf16 v[0:15], a[68:71], v[36:39], v[0:15]
  ds_read_b128 v[32:35], v203 offset:5120
  v_mfma_f32_32x32x16_bf16 v[16:31], a[212:215], v[36:39], v[16:31]
  s_waitcnt lgkmcnt(2)
  v_mfma_f32_32x32x16_bf16 v[0:15], a[72:75], v[40:43], v[0:15]
  ds_read_b128 v[36:39], v204 offset:5120
  v_mfma_f32_32x32x16_bf16 v[16:31], a[216:219], v[40:43], v[16:31]
  s_waitcnt lgkmcnt(2)
  v_mfma_f32_32x32x16_bf16 v[0:15], a[76:79], v[44:47], v[0:15]
  ds_read_b128 v[40:43], v205 offset:5120
  v_mfma_f32_32x32x16_bf16 v[16:31], a[220:223], v[44:47], v[16:31]
  s_waitcnt lgkmcnt(2)
  v_mfma_f32_32x32x16_bf16 v[0:15], a[80:83], v[32:35], v[0:15]
  ds_read_b128 v[44:47], v206 offset:5120
  v_mfma_f32_32x32x16_bf16 v[16:31], a[224:227], v[32:35], v[16:31]
  s_waitcnt lgkmcnt(2)
  v_mfma_f32_32x32x16_bf16 v[0:15], a[84:87], v[36:39], v[0:15]
  ds_read_b128 v[32:35], v203 offset:6144
  v_mfma_f32_32x32x16_bf16 v[16:31], a[228:231], v[36:39], v[16:31]
  s_waitcnt lgkmcnt(2)
  v_mfma_f32_32x32x16_bf16 v[0:15], a[88:91], v[40:43], v[0:15]
  ds_read_b128 v[36:39], v204 offset:6144
  v_mfma_f32_32x32x16_bf16 v[16:31], a[232:235], v[40:43], v[16:31]
  s_waitcnt lgkmcnt(2)
  v_mfma_f32_32x32x16_bf16 v[0:15], a[92:95], v[44:47], v[0:15]
  ds_read_b128 v[40:43], v205 offset:6144
  v_mfma_f32_32x32x16_bf16 v[16:31], a[236:239], v[44:47], v[16:31]
  s_waitcnt lgkmcnt(2)
  v_mfma_f32_32x32x16_bf16 v[0:15], a[96:99], v[32:35], v[0:15]
  ds_read_b128 v[44:47], v206 offset:6144
  v_mfma_f32_32x32x16_bf16 v[16:31], a[240:243], v[32:35], v[16:31]
  s_waitcnt lgkmcnt(2)
  v_mfma_f32_32x32x16_bf16 v[0:15], a[100:103], v[36:39], v[0:15]
  ds_read_b128 v[32:35], v203 offset:7168
  v_mfma_f32_32x32x16_bf16 v[16:31], a[244:247], v[36:39], v[16:31]
  s_waitcnt lgkmcnt(2)
  v_mfma_f32_32x32x16_bf16 v[0:15], a[104:107], v[40:43], v[0:15]
  ds_read_b128 v[36:39], v204 offset:7168
  v_mfma_f32_32x32x16_bf16 v[16:31], a[248:251], v[40:43], v[16:31]
  s_waitcnt lgkmcnt(2)
  v_mfma_f32_32x32x16_bf16 v[0:15], a[108:111], v[44:47], v[0:15]
  ds_read_b128 v[40:43], v205 offset:7168
  v_mfma_f32_32x32x16_bf16 v[16:31], a[252:255], v[44:47], v[16:31]
  s_waitcnt lgkmcnt(2)
  v_mfma_f32_32x32x16_bf16 v[0:15], a[112:115], v[32:35], v[0:15]
  ds_read_b128 v[44:47], v206 offset:7168
  v_mfma_f32_32x32x16_bf16 v[16:31], v[224:227], v[32:35], v[16:31]
  s_waitcnt lgkmcnt(2)
  v_mfma_f32_32x32x16_bf16 v[0:15], a[116:119], v[36:39], v[0:15]
  ds_read_b128 v[32:35], v203 offset:8192
  v_mfma_f32_32x32x16_bf16 v[16:31], v[228:231], v[36:39], v[16:31]
  s_waitcnt lgkmcnt(2)
  v_mfma_f32_32x32x16_bf16 v[0:15], a[120:123], v[40:43], v[0:15]
  ds_read_b128 v[36:39], v204 offset:8192
  v_mfma_f32_32x32x16_bf16 v[16:31], v[232:235], v[40:43], v[16:31]
  s_waitcnt lgkmcnt(2)
  v_mfma_f32_32x32x16_bf16 v[0:15], a[124:127], v[44:47], v[0:15]
  ds_read_b128 v[40:43], v205 offset:8192
  v_mfma_f32_32x32x16_bf16 v[16:31], v[236:239], v[44:47], v[16:31]
  s_waitcnt lgkmcnt(2)
  v_mfma_f32_32x32x16_bf16 v[0:15], a[128:131], v[32:35], v[0:15]
  ds_read_b128 v[44:47], v206 offset:8192
  v_mfma_f32_32x32x16_bf16 v[16:31], v[240:243], v[32:35], v[16:31]
  s_waitcnt lgkmcnt(2)
  v_mfma_f32_32x32x16_bf16 v[0:15], a[132:135], v[36:39], v[0:15]
  v_mfma_f32_32x32x16_bf16 v[16:31], v[244:247], v[36:39], v[16:31]
  s_waitcnt lgkmcnt(1)
  v_mfma_f32_32x32x16_bf16 v[0:15], a[136:139], v[40:43], v[0:15]
  v_mfma_f32_32x32x16_bf16 v[16:31], v[248:251], v[40:43], v[16:31]
  s_waitcnt lgkmcnt(0)
  v_mfma_f32_32x32x16_bf16 v[0:15], a[140:143], v[44:47], v[0:15]
  v_mfma_f32_32x32x16_bf16 v[16:31], v[252:255], v[44:47], v[16:31]
  s_add_u32 s60, s60, 36864
  s_nop 2
  v_cvt_pk_bf16_f32 v48, v0, v1
  v_cvt_pk_bf16_f32 v49, v2, v3
  ds_write2_b32 v218, v48, v49 offset0:0 offset1:1
  v_cvt_pk_bf16_f32 v48, v4, v5
  v_cvt_pk_bf16_f32 v49, v6, v7
  ds_write2_b32 v218, v48, v49 offset0:4 offset1:5
  v_cvt_pk_bf16_f32 v48, v8, v9
  v_cvt_pk_bf16_f32 v49, v10, v11
  ds_write2_b32 v218, v48, v49 offset0:8 offset1:9
  v_cvt_pk_bf16_f32 v48, v12, v13
  v_cvt_pk_bf16_f32 v49, v14, v15
  ds_write2_b32 v218, v48, v49 offset0:12 offset1:13
  v_cvt_pk_bf16_f32 v48, v16, v17
  v_cvt_pk_bf16_f32 v49, v18, v19
  ds_write2_b32 v218, v48, v49 offset0:64 offset1:65
  v_cvt_pk_bf16_f32 v48, v20, v21
  v_cvt_pk_bf16_f32 v49, v22, v23
  ds_write2_b32 v218, v48, v49 offset0:68 offset1:69
  v_cvt_pk_bf16_f32 v48, v24, v25
  v_cvt_pk_bf16_f32 v49, v26, v27
  ds_write2_b32 v218, v48, v49 offset0:72 offset1:73
  v_cvt_pk_bf16_f32 v48, v28, v29
  v_cvt_pk_bf16_f32 v49, v30, v31
  ds_write2_b32 v218, v48, v49 offset0:76 offset1:77
  v_add_u32 v218, 16512, v218
  s_waitcnt vmcnt(0) lgkmcnt(0)
  s_barrier
  ds_read_b128 v[32:35], v203 offset:36864
  ds_read_b128 v[36:39], v204 offset:36864
  ds_read_b128 v[40:43], v205 offset:36864
  s_waitcnt lgkmcnt(2)
  v_mfma_f32_32x32x16_bf16 v[0:15], a[0:3], v[32:35], 0
  ds_read_b128 v[44:47], v206 offset:36864
  s_add_u32 m0, s67, 0
  s_nop 0
  buffer_load_dwordx4 v202, s[4:7], s60 offen offset:0 lds
  v_mfma_f32_32x32x16_bf16 v[16:31], a[144:147], v[32:35], 0
  s_waitcnt lgkmcnt(2)
  v_mfma_f32_32x32x16_bf16 v[0:15], a[4:7], v[36:39], v[0:15]
  ds_read_b128 v[32:35], v203 offset:37888
  s_add_u32 m0, s67, 896
  s_nop 0
  buffer_load_dwordx4 v202, s[4:7], s60 offen offset:128 lds
  v_mfma_f32_32x32x16_bf16 v[16:31], a[148:151], v[36:39], v[16:31]
  s_waitcnt lgkmcnt(2)
  v_mfma_f32_32x32x16_bf16 v[0:15], a[8:11], v[40:43], v[0:15]
  ds_read_b128 v[36:39], v204 offset:37888
  s_add_u32 m0, s67, 1792
  s_nop 0
  buffer_load_dwordx4 v202, s[4:7], s60 offen offset:256 lds
  v_mfma_f32_32x32x16_bf16 v[16:31], a[152:155], v[40:43], v[16:31]
  s_waitcnt lgkmcnt(2)
  v_mfma_f32_32x32x16_bf16 v[0:15], a[12:15], v[44:47], v[0:15]
  ds_read_b128 v[40:43], v205 offset:37888
  s_add_u32 m0, s67, 2688
  s_nop 0
  buffer_load_dwordx4 v202, s[4:7], s60 offen offset:384 lds
  v_mfma_f32_32x32x16_bf16 v[16:31], a[156:159], v[44:47], v[16:31]
  s_waitcnt lgkmcnt(2)
  v_mfma_f32_32x32x16_bf16 v[0:15], a[16:19], v[32:35], v[0:15]
  ds_read_b128 v[44:47], v206 offset:37888
  s_add_u32 m0, s67, 3584
  s_nop 0
  buffer_load_dwordx4 v202, s[4:7], s60 offen offset:512 lds
  v_mfma_f32_32x32x16_bf16 v[16:31], a[160:163], v[32:35], v[16:31]
  s_waitcnt lgkmcnt(2)
  v_mfma_f32_32x32x16_bf16 v[0:15], a[20:23], v[36:39], v[0:15]
  ds_read_b128 v[32:35], v203 offset:38912
  s_add_u32 m0, s67, 4480
  s_nop 0
  buffer_load_dwordx4 v202, s[4:7], s60 offen offset:640 lds
  v_mfma_f32_32x32x16_bf16 v[16:31], a[164:167], v[36:39], v[16:31]
  s_waitcnt lgkmcnt(2)
  v_mfma_f32_32x32x16_bf16 v[0:15], a[24:27], v[40:43], v[0:15]
  ds_read_b128 v[36:39], v204 offset:38912
  s_add_u32 m0, s67, 5376
  s_nop 0
  buffer_load_dwordx4 v202, s[4:7], s60 offen offset:768 lds
  v_mfma_f32_32x32x16_bf16 v[16:31], a[168:171], v[40:43], v[16:31]
  s_waitcnt lgkmcnt(2)
  v_mfma_f32_32x32x16_bf16 v[0:15], a[28:31], v[44:47], v[0:15]
  ds_read_b128 v[40:43], v205 offset:38912
  s_add_u32 m0, s67, 6272
  s_nop 0
  buffer_load_dwordx4 v202, s[4:7], s60 offen offset:896 lds
  v_mfma_f32_32x32x16_bf16 v[16:31], a[172:175], v[44:47], v[16:31]
  s_waitcnt lgkmcnt(2)
  v_mfma_f32_32x32x16_bf16 v[0:15], a[32:35], v[32:35], v[0:15]
  ds_read_b128 v[44:47], v206 offset:38912
  s_add_u32 m0, s67, 7168
  s_nop 0
  buffer_load_dwordx4 v202, s[4:7], s60 offen offset:1024 lds
  v_mfma_f32_32x32x16_bf16 v[16:31], a[176:179], v[32:35], v[16:31]
  s_waitcnt lgkmcnt(2)
  v_mfma_f32_32x32x16_bf16 v[0:15], a[36:39], v[36:39], v[0:15]
  ds_read_b128 v[32:35], v203 offset:39936
  v_mfma_f32_32x32x16_bf16 v[16:31], a[180:183], v[36:39], v[16:31]
  s_waitcnt lgkmcnt(2)
  v_mfma_f32_32x32x16_bf16 v[0:15], a[40:43], v[40:43], v[0:15]
  ds_read_b128 v[36:39], v204 offset:39936
  v_mfma_f32_32x32x16_bf16 v[16:31], a[184:187], v[40:43], v[16:31]
  s_waitcnt lgkmcnt(2)
  v_mfma_f32_32x32x16_bf16 v[0:15], a[44:47], v[44:47], v[0:15]
  ds_read_b128 v[40:43], v205 offset:39936
  v_mfma_f32_32x32x16_bf16 v[16:31], a[188:191], v[44:47], v[16:31]
  s_waitcnt lgkmcnt(2)
  v_mfma_f32_32x32x16_bf16 v[0:15], a[48:51], v[32:35], v[0:15]
  ds_read_b128 v[44:47], v206 offset:39936
  v_mfma_f32_32x32x16_bf16 v[16:31], a[192:195], v[32:35], v[16:31]
  s_waitcnt lgkmcnt(2)
  v_mfma_f32_32x32x16_bf16 v[0:15], a[52:55], v[36:39], v[0:15]
  ds_read_b128 v[32:35], v203 offset:40960
  v_mfma_f32_32x32x16_bf16 v[16:31], a[196:199], v[36:39], v[16:31]
  s_waitcnt lgkmcnt(2)
  v_mfma_f32_32x32x16_bf16 v[0:15], a[56:59], v[40:43], v[0:15]
  ds_read_b128 v[36:39], v204 offset:40960
  v_mfma_f32_32x32x16_bf16 v[16:31], a[200:203], v[40:43], v[16:31]
  s_waitcnt lgkmcnt(2)
  v_mfma_f32_32x32x16_bf16 v[0:15], a[60:63], v[44:47], v[0:15]
  ds_read_b128 v[40:43], v205 offset:40960
  v_mfma_f32_32x32x16_bf16 v[16:31], a[204:207], v[44:47], v[16:31]
  s_waitcnt lgkmcnt(2)
  v_mfma_f32_32x32x16_bf16 v[0:15], a[64:67], v[32:35], v[0:15]
  ds_read_b128 v[44:47], v206 offset:40960
  v_mfma_f32_32x32x16_bf16 v[16:31], a[208:211], v[32:35], v[16:31]
  s_waitcnt lgkmcnt(2)
  v_mfma_f32_32x32x16_bf16 v[0:15], a[68:71], v[36:39], v[0:15]
  ds_read_b128 v[32:35], v203 offset:41984
  v_mfma_f32_32x32x16_bf16 v[16:31], a[212:215], v[36:39], v[16:31]
  s_waitcnt lgkmcnt(2)
  v_mfma_f32_32x32x16_bf16 v[0:15], a[72:75], v[40:43], v[0:15]
  ds_read_b128 v[36:39], v204 offset:41984
  v_mfma_f32_32x32x16_bf16 v[16:31], a[216:219], v[40:43], v[16:31]
  s_waitcnt lgkmcnt(2)
  v_mfma_f32_32x32x16_bf16 v[0:15], a[76:79], v[44:47], v[0:15]
  ds_read_b128 v[40:43], v205 offset:41984
  v_mfma_f32_32x32x16_bf16 v[16:31], a[220:223], v[44:47], v[16:31]
  s_waitcnt lgkmcnt(2)
  v_mfma_f32_32x32x16_bf16 v[0:15], a[80:83], v[32:35], v[0:15]
  ds_read_b128 v[44:47], v206 offset:41984
  v_mfma_f32_32x32x16_bf16 v[16:31], a[224:227], v[32:35], v[16:31]
  s_waitcnt lgkmcnt(2)
  v_mfma_f32_32x32x16_bf16 v[0:15], a[84:87], v[36:39], v[0:15]
  ds_read_b128 v[32:35], v203 offset:43008
  v_mfma_f32_32x32x16_bf16 v[16:31], a[228:231], v[36:39], v[16:31]
  s_waitcnt lgkmcnt(2)
  v_mfma_f32_32x32x16_bf16 v[0:15], a[88:91], v[40:43], v[0:15]
  ds_read_b128 v[36:39], v204 offset:43008
  v_mfma_f32_32x32x16_bf16 v[16:31], a[232:235], v[40:43], v[16:31]
  s_waitcnt lgkmcnt(2)
  v_mfma_f32_32x32x16_bf16 v[0:15], a[92:95], v[44:47], v[0:15]
  ds_read_b128 v[40:43], v205 offset:43008
  v_mfma_f32_32x32x16_bf16 v[16:31], a[236:239], v[44:47], v[16:31]
  s_waitcnt lgkmcnt(2)
  v_mfma_f32_32x32x16_bf16 v[0:15], a[96:99], v[32:35], v[0:15]
  ds_read_b128 v[44:47], v206 offset:43008
  v_mfma_f32_32x32x16_bf16 v[16:31], a[240:243], v[32:35], v[16:31]
  s_waitcnt lgkmcnt(2)
  v_mfma_f32_32x32x16_bf16 v[0:15], a[100:103], v[36:39], v[0:15]
  ds_read_b128 v[32:35], v203 offset:44032
  v_mfma_f32_32x32x16_bf16 v[16:31], a[244:247], v[36:39], v[16:31]
  s_waitcnt lgkmcnt(2)
  v_mfma_f32_32x32x16_bf16 v[0:15], a[104:107], v[40:43], v[0:15]
  ds_read_b128 v[36:39], v204 offset:44032
  v_mfma_f32_32x32x16_bf16 v[16:31], a[248:251], v[40:43], v[16:31]
  s_waitcnt lgkmcnt(2)
  v_mfma_f32_32x32x16_bf16 v[0:15], a[108:111], v[44:47], v[0:15]
  ds_read_b128 v[40:43], v205 offset:44032
  v_mfma_f32_32x32x16_bf16 v[16:31], a[252:255], v[44:47], v[16:31]
  s_waitcnt lgkmcnt(2)
  v_mfma_f32_32x32x16_bf16 v[0:15], a[112:115], v[32:35], v[0:15]
  ds_read_b128 v[44:47], v206 offset:44032
  v_mfma_f32_32x32x16_bf16 v[16:31], v[224:227], v[32:35], v[16:31]
  s_waitcnt lgkmcnt(2)
  v_mfma_f32_32x32x16_bf16 v[0:15], a[116:119], v[36:39], v[0:15]
  ds_read_b128 v[32:35], v203 offset:45056
  v_mfma_f32_32x32x16_bf16 v[16:31], v[228:231], v[36:39], v[16:31]
  s_waitcnt lgkmcnt(2)
  v_mfma_f32_32x32x16_bf16 v[0:15], a[120:123], v[40:43], v[0:15]
  ds_read_b128 v[36:39], v204 offset:45056
  v_mfma_f32_32x32x16_bf16 v[16:31], v[232:235], v[40:43], v[16:31]
  s_waitcnt lgkmcnt(2)
  v_mfma_f32_32x32x16_bf16 v[0:15], a[124:127], v[44:47], v[0:15]
  ds_read_b128 v[40:43], v205 offset:45056
  v_mfma_f32_32x32x16_bf16 v[16:31], v[236:239], v[44:47], v[16:31]
  s_waitcnt lgkmcnt(2)
  v_mfma_f32_32x32x16_bf16 v[0:15], a[128:131], v[32:35], v[0:15]
  ds_read_b128 v[44:47], v206 offset:45056
  v_mfma_f32_32x32x16_bf16 v[16:31], v[240:243], v[32:35], v[16:31]
  s_waitcnt lgkmcnt(2)
  v_mfma_f32_32x32x16_bf16 v[0:15], a[132:135], v[36:39], v[0:15]
  v_mfma_f32_32x32x16_bf16 v[16:31], v[244:247], v[36:39], v[16:31]
  s_waitcnt lgkmcnt(1)
  v_mfma_f32_32x32x16_bf16 v[0:15], a[136:139], v[40:43], v[0:15]
  v_mfma_f32_32x32x16_bf16 v[16:31], v[248:251], v[40:43], v[16:31]
  s_waitcnt lgkmcnt(0)
  v_mfma_f32_32x32x16_bf16 v[0:15], a[140:143], v[44:47], v[0:15]
  v_mfma_f32_32x32x16_bf16 v[16:31], v[252:255], v[44:47], v[16:31]
  s_add_u32 s60, s60, 36864
  s_nop 2
  v_cvt_pk_bf16_f32 v48, v0, v1
  v_cvt_pk_bf16_f32 v49, v2, v3
  ds_write2_b32 v218, v48, v49 offset0:0 offset1:1
  v_cvt_pk_bf16_f32 v48, v4, v5
  v_cvt_pk_bf16_f32 v49, v6, v7
  ds_write2_b32 v218, v48, v49 offset0:4 offset1:5
  v_cvt_pk_bf16_f32 v48, v8, v9
  v_cvt_pk_bf16_f32 v49, v10, v11
  ds_write2_b32 v218, v48, v49 offset0:8 offset1:9
  v_cvt_pk_bf16_f32 v48, v12, v13
  v_cvt_pk_bf16_f32 v49, v14, v15
  ds_write2_b32 v218, v48, v49 offset0:12 offset1:13
  v_cvt_pk_bf16_f32 v48, v16, v17
  v_cvt_pk_bf16_f32 v49, v18, v19
  ds_write2_b32 v218, v48, v49 offset0:64 offset1:65
  v_cvt_pk_bf16_f32 v48, v20, v21
  v_cvt_pk_bf16_f32 v49, v22, v23
  ds_write2_b32 v218, v48, v49 offset0:68 offset1:69
  v_cvt_pk_bf16_f32 v48, v24, v25
  v_cvt_pk_bf16_f32 v49, v26, v27
  ds_write2_b32 v218, v48, v49 offset0:72 offset1:73
  v_cvt_pk_bf16_f32 v48, v28, v29
  v_cvt_pk_bf16_f32 v49, v30, v31
  ds_write2_b32 v218, v48, v49 offset0:76 offset1:77
  v_add_u32 v218, 16512, v218
  s_waitcnt vmcnt(0) lgkmcnt(0)
  s_barrier
  ds_read_b128 v[32:35], v203 offset:0
  ds_read_b128 v[36:39], v204 offset:0
  ds_read_b128 v[40:43], v205 offset:0
  s_waitcnt lgkmcnt(2)
  v_mfma_f32_32x32x16_bf16 v[0:15], a[0:3], v[32:35], 0
  ds_read_b128 v[44:47], v206 offset:0
  v_mfma_f32_32x32x16_bf16 v[16:31], a[144:147], v[32:35], 0
  s_waitcnt lgkmcnt(2)
  v_mfma_f32_32x32x16_bf16 v[0:15], a[4:7], v[36:39], v[0:15]
  ds_read_b128 v[32:35], v203 offset:1024
  v_mfma_f32_32x32x16_bf16 v[16:31], a[148:151], v[36:39], v[16:31]
  s_waitcnt lgkmcnt(2)
  v_mfma_f32_32x32x16_bf16 v[0:15], a[8:11], v[40:43], v[0:15]
  ds_read_b128 v[36:39], v204 offset:1024
  v_mfma_f32_32x32x16_bf16 v[16:31], a[152:155], v[40:43], v[16:31]
  s_waitcnt lgkmcnt(2)
  v_mfma_f32_32x32x16_bf16 v[0:15], a[12:15], v[44:47], v[0:15]
  ds_read_b128 v[40:43], v205 offset:1024
  v_mfma_f32_32x32x16_bf16 v[16:31], a[156:159], v[44:47], v[16:31]
  s_waitcnt lgkmcnt(2)
  v_mfma_f32_32x32x16_bf16 v[0:15], a[16:19], v[32:35], v[0:15]
  ds_read_b128 v[44:47], v206 offset:1024
  v_mfma_f32_32x32x16_bf16 v[16:31], a[160:163], v[32:35], v[16:31]
  s_waitcnt lgkmcnt(2)
  v_mfma_f32_32x32x16_bf16 v[0:15], a[20:23], v[36:39], v[0:15]
  ds_read_b128 v[32:35], v203 offset:2048
  v_mfma_f32_32x32x16_bf16 v[16:31], a[164:167], v[36:39], v[16:31]
  s_waitcnt lgkmcnt(2)
  v_mfma_f32_32x32x16_bf16 v[0:15], a[24:27], v[40:43], v[0:15]
  ds_read_b128 v[36:39], v204 offset:2048
  v_mfma_f32_32x32x16_bf16 v[16:31], a[168:171], v[40:43], v[16:31]
  s_waitcnt lgkmcnt(2)
  v_mfma_f32_32x32x16_bf16 v[0:15], a[28:31], v[44:47], v[0:15]
  ds_read_b128 v[40:43], v205 offset:2048
  v_mfma_f32_32x32x16_bf16 v[16:31], a[172:175], v[44:47], v[16:31]
  s_waitcnt lgkmcnt(2)
  v_mfma_f32_32x32x16_bf16 v[0:15], a[32:35], v[32:35], v[0:15]
  ds_read_b128 v[44:47], v206 offset:2048
  v_mfma_f32_32x32x16_bf16 v[16:31], a[176:179], v[32:35], v[16:31]
  s_waitcnt lgkmcnt(2)
  v_mfma_f32_32x32x16_bf16 v[0:15], a[36:39], v[36:39], v[0:15]
  ds_read_b128 v[32:35], v203 offset:3072
  v_mfma_f32_32x32x16_bf16 v[16:31], a[180:183], v[36:39], v[16:31]
  s_waitcnt lgkmcnt(2)
  v_mfma_f32_32x32x16_bf16 v[0:15], a[40:43], v[40:43], v[0:15]
  ds_read_b128 v[36:39], v204 offset:3072
  v_mfma_f32_32x32x16_bf16 v[16:31], a[184:187], v[40:43], v[16:31]
  s_waitcnt lgkmcnt(2)
  v_mfma_f32_32x32x16_bf16 v[0:15], a[44:47], v[44:47], v[0:15]
  ds_read_b128 v[40:43], v205 offset:3072
  v_mfma_f32_32x32x16_bf16 v[16:31], a[188:191], v[44:47], v[16:31]
  s_waitcnt lgkmcnt(2)
  v_mfma_f32_32x32x16_bf16 v[0:15], a[48:51], v[32:35], v[0:15]
  ds_read_b128 v[44:47], v206 offset:3072
  v_mfma_f32_32x32x16_bf16 v[16:31], a[192:195], v[32:35], v[16:31]
  s_waitcnt lgkmcnt(2)
  v_mfma_f32_32x32x16_bf16 v[0:15], a[52:55], v[36:39], v[0:15]
  ds_read_b128 v[32:35], v203 offset:4096
  v_mfma_f32_32x32x16_bf16 v[16:31], a[196:199], v[36:39], v[16:31]
  s_waitcnt lgkmcnt(2)
  v_mfma_f32_32x32x16_bf16 v[0:15], a[56:59], v[40:43], v[0:15]
  ds_read_b128 v[36:39], v204 offset:4096
  v_mfma_f32_32x32x16_bf16 v[16:31], a[200:203], v[40:43], v[16:31]
  s_waitcnt lgkmcnt(2)
  v_mfma_f32_32x32x16_bf16 v[0:15], a[60:63], v[44:47], v[0:15]
  ds_read_b128 v[40:43], v205 offset:4096
  v_mfma_f32_32x32x16_bf16 v[16:31], a[204:207], v[44:47], v[16:31]
  s_waitcnt lgkmcnt(2)
  v_mfma_f32_32x32x16_bf16 v[0:15], a[64:67], v[32:35], v[0:15]
  ds_read_b128 v[44:47], v206 offset:4096
  v_mfma_f32_32x32x16_bf16 v[16:31], a[208:211], v[32:35], v[16:31]
  s_waitcnt lgkmcnt(2)
  v_mfma_f32_32x32x16_bf16 v[0:15], a[68:71], v[36:39], v[0:15]
  ds_read_b128 v[32:35], v203 offset:5120
  v_mfma_f32_32x32x16_bf16 v[16:31], a[212:215], v[36:39], v[16:31]
  s_waitcnt lgkmcnt(2)
  v_mfma_f32_32x32x16_bf16 v[0:15], a[72:75], v[40:43], v[0:15]
  ds_read_b128 v[36:39], v204 offset:5120
  v_mfma_f32_32x32x16_bf16 v[16:31], a[216:219], v[40:43], v[16:31]
  s_waitcnt lgkmcnt(2)
  v_mfma_f32_32x32x16_bf16 v[0:15], a[76:79], v[44:47], v[0:15]
  ds_read_b128 v[40:43], v205 offset:5120
  v_mfma_f32_32x32x16_bf16 v[16:31], a[220:223], v[44:47], v[16:31]
  s_waitcnt lgkmcnt(2)
  v_mfma_f32_32x32x16_bf16 v[0:15], a[80:83], v[32:35], v[0:15]
  ds_read_b128 v[44:47], v206 offset:5120
  v_mfma_f32_32x32x16_bf16 v[16:31], a[224:227], v[32:35], v[16:31]
  s_waitcnt lgkmcnt(2)
  v_mfma_f32_32x32x16_bf16 v[0:15], a[84:87], v[36:39], v[0:15]
  ds_read_b128 v[32:35], v203 offset:6144
  v_mfma_f32_32x32x16_bf16 v[16:31], a[228:231], v[36:39], v[16:31]
  s_waitcnt lgkmcnt(2)
  v_mfma_f32_32x32x16_bf16 v[0:15], a[88:91], v[40:43], v[0:15]
  ds_read_b128 v[36:39], v204 offset:6144
  v_mfma_f32_32x32x16_bf16 v[16:31], a[232:235], v[40:43], v[16:31]
  s_waitcnt lgkmcnt(2)
  v_mfma_f32_32x32x16_bf16 v[0:15], a[92:95], v[44:47], v[0:15]
  ds_read_b128 v[40:43], v205 offset:6144
  v_mfma_f32_32x32x16_bf16 v[16:31], a[236:239], v[44:47], v[16:31]
  s_waitcnt lgkmcnt(2)
  v_mfma_f32_32x32x16_bf16 v[0:15], a[96:99], v[32:35], v[0:15]
  ds_read_b128 v[44:47], v206 offset:6144
  v_mfma_f32_32x32x16_bf16 v[16:31], a[240:243], v[32:35], v[16:31]
  s_waitcnt lgkmcnt(2)
  v_mfma_f32_32x32x16_bf16 v[0:15], a[100:103], v[36:39], v[0:15]
  ds_read_b128 v[32:35], v203 offset:7168
  v_mfma_f32_32x32x16_bf16 v[16:31], a[244:247], v[36:39], v[16:31]
  s_waitcnt lgkmcnt(2)
  v_mfma_f32_32x32x16_bf16 v[0:15], a[104:107], v[40:43], v[0:15]
  ds_read_b128 v[36:39], v204 offset:7168
  v_mfma_f32_32x32x16_bf16 v[16:31], a[248:251], v[40:43], v[16:31]
  s_waitcnt lgkmcnt(2)
  v_mfma_f32_32x32x16_bf16 v[0:15], a[108:111], v[44:47], v[0:15]
  ds_read_b128 v[40:43], v205 offset:7168
  v_mfma_f32_32x32x16_bf16 v[16:31], a[252:255], v[44:47], v[16:31]
  s_waitcnt lgkmcnt(2)
  v_mfma_f32_32x32x16_bf16 v[0:15], a[112:115], v[32:35], v[0:15]
  ds_read_b128 v[44:47], v206 offset:7168
  v_mfma_f32_32x32x16_bf16 v[16:31], v[224:227], v[32:35], v[16:31]
  s_waitcnt lgkmcnt(2)
  v_mfma_f32_32x32x16_bf16 v[0:15], a[116:119], v[36:39], v[0:15]
  ds_read_b128 v[32:35], v203 offset:8192
  v_mfma_f32_32x32x16_bf16 v[16:31], v[228:231], v[36:39], v[16:31]
  s_waitcnt lgkmcnt(2)
  v_mfma_f32_32x32x16_bf16 v[0:15], a[120:123], v[40:43], v[0:15]
  ds_read_b128 v[36:39], v204 offset:8192
  v_mfma_f32_32x32x16_bf16 v[16:31], v[232:235], v[40:43], v[16:31]
  s_waitcnt lgkmcnt(2)
  v_mfma_f32_32x32x16_bf16 v[0:15], a[124:127], v[44:47], v[0:15]
  ds_read_b128 v[40:43], v205 offset:8192
  v_mfma_f32_32x32x16_bf16 v[16:31], v[236:239], v[44:47], v[16:31]
  s_waitcnt lgkmcnt(2)
  v_mfma_f32_32x32x16_bf16 v[0:15], a[128:131], v[32:35], v[0:15]
  ds_read_b128 v[44:47], v206 offset:8192
  v_mfma_f32_32x32x16_bf16 v[16:31], v[240:243], v[32:35], v[16:31]
  s_waitcnt lgkmcnt(2)
  v_mfma_f32_32x32x16_bf16 v[0:15], a[132:135], v[36:39], v[0:15]
  v_mfma_f32_32x32x16_bf16 v[16:31], v[244:247], v[36:39], v[16:31]
  s_waitcnt lgkmcnt(1)
  v_mfma_f32_32x32x16_bf16 v[0:15], a[136:139], v[40:43], v[0:15]
  v_mfma_f32_32x32x16_bf16 v[16:31], v[248:251], v[40:43], v[16:31]
  s_waitcnt lgkmcnt(0)
  v_mfma_f32_32x32x16_bf16 v[0:15], a[140:143], v[44:47], v[0:15]
  v_mfma_f32_32x32x16_bf16 v[16:31], v[252:255], v[44:47], v[16:31]
  s_add_u32 s60, s60, 36864
  s_nop 2
  v_cvt_pk_bf16_f32 v48, v0, v1
  v_cvt_pk_bf16_f32 v49, v2, v3
  ds_write2_b32 v218, v48, v49 offset0:0 offset1:1
  v_cvt_pk_bf16_f32 v48, v4, v5
  v_cvt_pk_bf16_f32 v49, v6, v7
  ds_write2_b32 v218, v48, v49 offset0:4 offset1:5
  v_cvt_pk_bf16_f32 v48, v8, v9
  v_cvt_pk_bf16_f32 v49, v10, v11
  ds_write2_b32 v218, v48, v49 offset0:8 offset1:9
  v_cvt_pk_bf16_f32 v48, v12, v13
  v_cvt_pk_bf16_f32 v49, v14, v15
  ds_write2_b32 v218, v48, v49 offset0:12 offset1:13
  v_cvt_pk_bf16_f32 v48, v16, v17
  v_cvt_pk_bf16_f32 v49, v18, v19
  ds_write2_b32 v218, v48, v49 offset0:64 offset1:65
  v_cvt_pk_bf16_f32 v48, v20, v21
  v_cvt_pk_bf16_f32 v49, v22, v23
  ds_write2_b32 v218, v48, v49 offset0:68 offset1:69
  v_cvt_pk_bf16_f32 v48, v24, v25
  v_cvt_pk_bf16_f32 v49, v26, v27
  ds_write2_b32 v218, v48, v49 offset0:72 offset1:73
  v_cvt_pk_bf16_f32 v48, v28, v29
  v_cvt_pk_bf16_f32 v49, v30, v31
  ds_write2_b32 v218, v48, v49 offset0:76 offset1:77
  v_add_u32 v218, 16512, v218
  s_waitcnt vmcnt(0) lgkmcnt(0)
  s_barrier
  v_mul_u32_u24 v219, 516, v200
  s_mul_i32 s54, s52, 36
  s_add_u32 s55, s54, 83016
  v_add_u32 v219, s55, v219
  v_mul_u32_u24 v220, 1152, v200
  s_mul_i32 s55, s68, 144
  s_add_u32 s54, s54, s55
  s_mul_i32 s55, s69, 147456
  s_add_u32 s64, s54, s55
  s_add_u32 s64, s64, 62914560
  s_lshl_b32 s66, s69, 7
  s_mov_b32 s57, 1051597459
  ds_read_b32 v0, v219 offset:7224
  ds_read_b32 v1, v219 offset:7228
  ds_read_b32 v2, v219 offset:7232
  ds_read_b32 v3, v219 offset:7236
  ds_read_b32 v4, v219 offset:7240
  ds_read_b32 v5, v219 offset:7244
  ds_read_b32 v6, v219 offset:7248
  ds_read_b32 v7, v219 offset:7252
  ds_read_b32 v8, v219 offset:7256
  ds_read_b32 v16, v219 offset:7368
  ds_read_b32 v17, v219 offset:7372
  ds_read_b32 v18, v219 offset:7376
  ds_read_b32 v19, v219 offset:7380
  ds_read_b32 v20, v219 offset:7384
  ds_read_b32 v21, v219 offset:7388
  ds_read_b32 v22, v219 offset:7392
  ds_read_b32 v23, v219 offset:7396
  ds_read_b32 v24, v219 offset:7400
  ds_read_b32 v25, v219 offset:6336
  ds_read_b32 v26, v219 offset:6340
  ds_read_b32 v27, v219 offset:6344
  ds_read_b32 v28, v219 offset:6348
  ds_read_b32 v29, v219 offset:6352
  ds_read_b32 v30, v219 offset:6356
  ds_read_b32 v31, v219 offset:6360
  ds_read_b32 v32, v219 offset:6364
  ds_read_b32 v33, v219 offset:6368
  ds_read_b32 v34, v219 offset:5304
  ds_read_b32 v35, v219 offset:5308
  ds_read_b32 v36, v219 offset:5312
  ds_read_b32 v37, v219 offset:5316
  ds_read_b32 v38, v219 offset:5320
  ds_read_b32 v39, v219 offset:5324
  ds_read_b32 v40, v219 offset:5328
  ds_read_b32 v41, v219 offset:5332
  ds_read_b32 v42, v219 offset:5336
  ds_read_b32 v43, v219 offset:4272
  ds_read_b32 v44, v219 offset:4276
  ds_read_b32 v45, v219 offset:4280
  ds_read_b32 v46, v219 offset:4284
  ds_read_b32 v47, v219 offset:4288
  ds_read_b32 v48, v219 offset:4292
  ds_read_b32 v49, v219 offset:4296
  ds_read_b32 v50, v219 offset:4300
  ds_read_b32 v51, v219 offset:4304
  ds_read_b32 v52, v219 offset:3240
  ds_read_b32 v53, v219 offset:3244
  ds_read_b32 v54, v219 offset:3248
  ds_read_b32 v55, v219 offset:3252
  ds_read_b32 v56, v219 offset:3256
  ds_read_b32 v57, v219 offset:3260
  ds_read_b32 v58, v219 offset:3264
  ds_read_b32 v59, v219 offset:3268
  ds_read_b32 v60, v219 offset:3272
  ds_read_b32 v61, v219 offset:2208
  ds_read_b32 v62, v219 offset:2212
  ds_read_b32 v63, v219 offset:2216
  ds_read_b32 v64, v219 offset:2220
  ds_read_b32 v65, v219 offset:2224
  ds_read_b32 v66, v219 offset:2228
  ds_read_b32 v67, v219 offset:2232
  ds_read_b32 v68, v219 offset:2236
  ds_read_b32 v69, v219 offset:2240
  ds_read_b32 v70, v219 offset:1176
  ds_read_b32 v71, v219 offset:1180
  ds_read_b32 v72, v219 offset:1184
  ds_read_b32 v73, v219 offset:1188
  ds_read_b32 v74, v219 offset:1192
  ds_read_b32 v75, v219 offset:1196
  ds_read_b32 v76, v219 offset:1200
  ds_read_b32 v77, v219 offset:1204
  ds_read_b32 v78, v219 offset:1208
  ds_read_b32 v79, v219 offset:144
  ds_read_b32 v80, v219 offset:148
  ds_read_b32 v81, v219 offset:152
  ds_read_b32 v82, v219 offset:156
  ds_read_b32 v83, v219 offset:160
  ds_read_b32 v84, v219 offset:164
  ds_read_b32 v85, v219 offset:168
  ds_read_b32 v86, v219 offset:172
  ds_read_b32 v87, v219 offset:176
  v_mov_b32 v100, 0
  v_mov_b32 v101, 0
  v_mov_b32 v102, 0
  v_mov_b32 v103, 0
  v_mov_b32 v104, 0
  v_mov_b32 v105, 0
  v_mov_b32 v106, 0
  v_mov_b32 v107, 0
  s_waitcnt lgkmcnt(15)
  v_dot2c_f32_bf16 v100, v0, v16
  v_dot2c_f32_bf16 v101, v0, v25
  v_dot2c_f32_bf16 v102, v0, v34
  v_dot2c_f32_bf16 v103, v0, v43
  v_dot2c_f32_bf16 v104, v0, v52
  v_dot2c_f32_bf16 v105, v0, v61
  v_dot2c_f32_bf16 v106, v0, v70
  s_waitcnt lgkmcnt(8)
  v_dot2c_f32_bf16 v107, v0, v79
  v_dot2c_f32_bf16 v100, v1, v17
  v_dot2c_f32_bf16 v101, v1, v26
  v_dot2c_f32_bf16 v102, v1, v35
  v_dot2c_f32_bf16 v103, v1, v44
  v_dot2c_f32_bf16 v104, v1, v53
  v_dot2c_f32_bf16 v105, v1, v62
  v_dot2c_f32_bf16 v106, v1, v71
  s_waitcnt lgkmcnt(7)
  v_dot2c_f32_bf16 v107, v1, v80
  v_dot2c_f32_bf16 v100, v2, v18
  v_dot2c_f32_bf16 v101, v2, v27
  v_dot2c_f32_bf16 v102, v2, v36
  v_dot2c_f32_bf16 v103, v2, v45
  v_dot2c_f32_bf16 v104, v2, v54
  v_dot2c_f32_bf16 v105, v2, v63
  v_dot2c_f32_bf16 v106, v2, v72
  s_waitcnt lgkmcnt(6)
  v_dot2c_f32_bf16 v107, v2, v81
  v_dot2c_f32_bf16 v100, v3, v19
  v_dot2c_f32_bf16 v101, v3, v28
  v_dot2c_f32_bf16 v102, v3, v37
  v_dot2c_f32_bf16 v103, v3, v46
  v_dot2c_f32_bf16 v104, v3, v55
  v_dot2c_f32_bf16 v105, v3, v64
  v_dot2c_f32_bf16 v106, v3, v73
  s_waitcnt lgkmcnt(5)
  v_dot2c_f32_bf16 v107, v3, v82
  v_dot2c_f32_bf16 v100, v4, v20
  v_dot2c_f32_bf16 v101, v4, v29
  v_dot2c_f32_bf16 v102, v4, v38
  v_dot2c_f32_bf16 v103, v4, v47
  v_dot2c_f32_bf16 v104, v4, v56
  v_dot2c_f32_bf16 v105, v4, v65
  v_dot2c_f32_bf16 v106, v4, v74
  s_waitcnt lgkmcnt(4)
  v_dot2c_f32_bf16 v107, v4, v83
  v_dot2c_f32_bf16 v100, v5, v21
  v_dot2c_f32_bf16 v101, v5, v30
  v_dot2c_f32_bf16 v102, v5, v39
  v_dot2c_f32_bf16 v103, v5, v48
  v_dot2c_f32_bf16 v104, v5, v57
  v_dot2c_f32_bf16 v105, v5, v66
  v_dot2c_f32_bf16 v106, v5, v75
  s_waitcnt lgkmcnt(3)
  v_dot2c_f32_bf16 v107, v5, v84
  v_dot2c_f32_bf16 v100, v6, v22
  v_dot2c_f32_bf16 v101, v6, v31
  v_dot2c_f32_bf16 v102, v6, v40
  v_dot2c_f32_bf16 v103, v6, v49
  v_dot2c_f32_bf16 v104, v6, v58
  v_dot2c_f32_bf16 v105, v6, v67
  v_dot2c_f32_bf16 v106, v6, v76
  s_waitcnt lgkmcnt(2)
  v_dot2c_f32_bf16 v107, v6, v85
  v_dot2c_f32_bf16 v100, v7, v23
  v_dot2c_f32_bf16 v101, v7, v32
  v_dot2c_f32_bf16 v102, v7, v41
  v_dot2c_f32_bf16 v103, v7, v50
  v_dot2c_f32_bf16 v104, v7, v59
  v_dot2c_f32_bf16 v105, v7, v68
  v_dot2c_f32_bf16 v106, v7, v77
  s_waitcnt lgkmcnt(1)
  v_dot2c_f32_bf16 v107, v7, v86
  v_dot2c_f32_bf16 v100, v8, v24
  v_dot2c_f32_bf16 v101, v8, v33
  v_dot2c_f32_bf16 v102, v8, v42
  v_dot2c_f32_bf16 v103, v8, v51
  v_dot2c_f32_bf16 v104, v8, v60
  v_dot2c_f32_bf16 v105, v8, v69
  v_dot2c_f32_bf16 v106, v8, v78
  s_waitcnt lgkmcnt(0)
  v_dot2c_f32_bf16 v107, v8, v87
  ds_read_b32 v16, v219 offset:7512
  ds_read_b32 v17, v219 offset:7516
  ds_read_b32 v18, v219 offset:7520
  ds_read_b32 v19, v219 offset:7524
  ds_read_b32 v20, v219 offset:7528
  ds_read_b32 v21, v219 offset:7532
  ds_read_b32 v22, v219 offset:7536
  ds_read_b32 v23, v219 offset:7540
  ds_read_b32 v24, v219 offset:7544
  ds_read_b32 v25, v219 offset:6480
  ds_read_b32 v26, v219 offset:6484
  ds_read_b32 v27, v219 offset:6488
  ds_read_b32 v28, v219 offset:6492
  ds_read_b32 v29, v219 offset:6496
  ds_read_b32 v30, v219 offset:6500
  ds_read_b32 v31, v219 offset:6504
  ds_read_b32 v32, v219 offset:6508
  ds_read_b32 v33, v219 offset:6512
  ds_read_b32 v34, v219 offset:5448
  ds_read_b32 v35, v219 offset:5452
  ds_read_b32 v36, v219 offset:5456
  ds_read_b32 v37, v219 offset:5460
  ds_read_b32 v38, v219 offset:5464
  ds_read_b32 v39, v219 offset:5468
  ds_read_b32 v40, v219 offset:5472
  ds_read_b32 v41, v219 offset:5476
  ds_read_b32 v42, v219 offset:5480
  ds_read_b32 v43, v219 offset:4416
  ds_read_b32 v44, v219 offset:4420
  ds_read_b32 v45, v219 offset:4424
  ds_read_b32 v46, v219 offset:4428
  ds_read_b32 v47, v219 offset:4432
  ds_read_b32 v48, v219 offset:4436
  ds_read_b32 v49, v219 offset:4440
  ds_read_b32 v50, v219 offset:4444
  ds_read_b32 v51, v219 offset:4448
  ds_read_b32 v52, v219 offset:3384
  ds_read_b32 v53, v219 offset:3388
  ds_read_b32 v54, v219 offset:3392
  ds_read_b32 v55, v219 offset:3396
  ds_read_b32 v56, v219 offset:3400
  ds_read_b32 v57, v219 offset:3404
  ds_read_b32 v58, v219 offset:3408
  ds_read_b32 v59, v219 offset:3412
  ds_read_b32 v60, v219 offset:3416
  ds_read_b32 v61, v219 offset:2352
  ds_read_b32 v62, v219 offset:2356
  ds_read_b32 v63, v219 offset:2360
  ds_read_b32 v64, v219 offset:2364
  ds_read_b32 v65, v219 offset:2368
  ds_read_b32 v66, v219 offset:2372
  ds_read_b32 v67, v219 offset:2376
  ds_read_b32 v68, v219 offset:2380
  ds_read_b32 v69, v219 offset:2384
  ds_read_b32 v70, v219 offset:1320
  ds_read_b32 v71, v219 offset:1324
  ds_read_b32 v72, v219 offset:1328
  ds_read_b32 v73, v219 offset:1332
  ds_read_b32 v74, v219 offset:1336
  ds_read_b32 v75, v219 offset:1340
  ds_read_b32 v76, v219 offset:1344
  ds_read_b32 v77, v219 offset:1348
  ds_read_b32 v78, v219 offset:1352
  ds_read_b32 v79, v219 offset:288
  ds_read_b32 v80, v219 offset:292
  ds_read_b32 v81, v219 offset:296
  ds_read_b32 v82, v219 offset:300
  ds_read_b32 v83, v219 offset:304
  ds_read_b32 v84, v219 offset:308
  ds_read_b32 v85, v219 offset:312
  ds_read_b32 v86, v219 offset:316
  ds_read_b32 v87, v219 offset:320
  v_add_u32 v211, s66, v200
  v_mov_b32 v212, 0xf149f2ca
  v_mul_f32 v100, s57, v100
  v_mul_f32 v101, s57, v101
  v_mul_f32 v102, s57, v102
  v_mul_f32 v103, s57, v103
  v_mul_f32 v104, s57, v104
  v_mul_f32 v105, s57, v105
  v_mul_f32 v106, s57, v106
  v_mul_f32 v107, s57, v107
  v_cmp_gt_u32 vcc, 2, v211
  s_nop 1
  v_cndmask_b32 v101, v101, v212, vcc
  v_cmp_gt_u32 vcc, 4, v211
  s_nop 1
  v_cndmask_b32 v102, v102, v212, vcc
  v_cmp_gt_u32 vcc, 6, v211
  s_nop 1
  v_cndmask_b32 v103, v103, v212, vcc
  v_cmp_gt_u32 vcc, 8, v211
  s_nop 1
  v_cndmask_b32 v104, v104, v212, vcc
  v_cmp_gt_u32 vcc, 10, v211
  s_nop 1
  v_cndmask_b32 v105, v105, v212, vcc
  v_cmp_gt_u32 vcc, 12, v211
  s_nop 1
  v_cndmask_b32 v106, v106, v212, vcc
  v_cmp_gt_u32 vcc, 14, v211
  s_nop 1
  v_cndmask_b32 v107, v107, v212, vcc
  v_max3_f32 v213, v100, v101, v102
  v_max3_f32 v213, v213, v103, v104
  v_max3_f32 v213, v213, v105, v106
  v_max_f32 v213, v213, v107
  v_sub_f32 v100, v100, v213
  v_sub_f32 v101, v101, v213
  v_sub_f32 v102, v102, v213
  v_sub_f32 v103, v103, v213
  v_sub_f32 v104, v104, v213
  v_sub_f32 v105, v105, v213
  v_sub_f32 v106, v106, v213
  v_sub_f32 v107, v107, v213
  v_exp_f32 v100, v100
  v_exp_f32 v101, v101
  v_exp_f32 v102, v102
  v_exp_f32 v103, v103
  v_exp_f32 v104, v104
  v_exp_f32 v105, v105
  v_exp_f32 v106, v106
  v_exp_f32 v107, v107
  v_add_f32 v213, v100, v101
  v_add_f32 v213, v213, v102
  v_add_f32 v213, v213, v103
  v_add_f32 v213, v213, v104
  v_add_f32 v213, v213, v105
  v_add_f32 v213, v213, v106
  v_add_f32 v213, v213, v107
  v_rcp_f32 v213, v213
  v_mov_b32 v214, 0
  v_mul_f32 v100, v213, v100
  v_mul_f32 v101, v213, v101
  v_mul_f32 v102, v213, v102
  v_mul_f32 v103, v213, v103
  v_mul_f32 v104, v213, v104
  v_mul_f32 v105, v213, v105
  v_mul_f32 v106, v213, v106
  v_mul_f32 v107, v213, v107
  v_mov_b32 v112, 0
  v_mov_b32 v113, 0
  v_mov_b32 v114, 0
  v_mov_b32 v115, 0
  v_mov_b32 v116, 0
  v_mov_b32 v117, 0
  v_mov_b32 v118, 0
  v_mov_b32 v119, 0
  v_mov_b32 v120, 0
  v_mov_b32 v121, 0
  v_mov_b32 v122, 0
  v_mov_b32 v123, 0
  v_mov_b32 v124, 0
  v_mov_b32 v125, 0
  v_mov_b32 v126, 0
  v_mov_b32 v127, 0
  v_mov_b32 v128, 0
  v_mov_b32 v129, 0
  v_cvt_pk_bf16_f32 v0, v100, v214
  v_cvt_pk_bf16_f32 v1, v214, v100
  s_waitcnt lgkmcnt(15)
  v_dot2c_f32_bf16 v112, v16, v0
  v_dot2c_f32_bf16 v113, v16, v1
  v_dot2c_f32_bf16 v114, v17, v0
  v_dot2c_f32_bf16 v115, v17, v1
  v_dot2c_f32_bf16 v116, v18, v0
  v_dot2c_f32_bf16 v117, v18, v1
  v_dot2c_f32_bf16 v118, v19, v0
  v_dot2c_f32_bf16 v119, v19, v1
  v_dot2c_f32_bf16 v120, v20, v0
  v_dot2c_f32_bf16 v121, v20, v1
  v_dot2c_f32_bf16 v122, v21, v0
  v_dot2c_f32_bf16 v123, v21, v1
  v_dot2c_f32_bf16 v124, v22, v0
  v_dot2c_f32_bf16 v125, v22, v1
  v_dot2c_f32_bf16 v126, v23, v0
  v_dot2c_f32_bf16 v127, v23, v1
  v_dot2c_f32_bf16 v128, v24, v0
  v_dot2c_f32_bf16 v129, v24, v1
  v_cvt_pk_bf16_f32 v2, v101, v214
  v_cvt_pk_bf16_f32 v3, v214, v101
  v_dot2c_f32_bf16 v112, v25, v2
  v_dot2c_f32_bf16 v113, v25, v3
  v_dot2c_f32_bf16 v114, v26, v2
  v_dot2c_f32_bf16 v115, v26, v3
  v_dot2c_f32_bf16 v116, v27, v2
  v_dot2c_f32_bf16 v117, v27, v3
  v_dot2c_f32_bf16 v118, v28, v2
  v_dot2c_f32_bf16 v119, v28, v3
  v_dot2c_f32_bf16 v120, v29, v2
  v_dot2c_f32_bf16 v121, v29, v3
  v_dot2c_f32_bf16 v122, v30, v2
  v_dot2c_f32_bf16 v123, v30, v3
  v_dot2c_f32_bf16 v124, v31, v2
  v_dot2c_f32_bf16 v125, v31, v3
  v_dot2c_f32_bf16 v126, v32, v2
  v_dot2c_f32_bf16 v127, v32, v3
  v_dot2c_f32_bf16 v128, v33, v2
  v_dot2c_f32_bf16 v129, v33, v3
  v_cvt_pk_bf16_f32 v0, v102, v214
  v_cvt_pk_bf16_f32 v1, v214, v102
  v_dot2c_f32_bf16 v112, v34, v0
  v_dot2c_f32_bf16 v113, v34, v1
  v_dot2c_f32_bf16 v114, v35, v0
  v_dot2c_f32_bf16 v115, v35, v1
  v_dot2c_f32_bf16 v116, v36, v0
  v_dot2c_f32_bf16 v117, v36, v1
  v_dot2c_f32_bf16 v118, v37, v0
  v_dot2c_f32_bf16 v119, v37, v1
  v_dot2c_f32_bf16 v120, v38, v0
  v_dot2c_f32_bf16 v121, v38, v1
  v_dot2c_f32_bf16 v122, v39, v0
  v_dot2c_f32_bf16 v123, v39, v1
  v_dot2c_f32_bf16 v124, v40, v0
  v_dot2c_f32_bf16 v125, v40, v1
  v_dot2c_f32_bf16 v126, v41, v0
  v_dot2c_f32_bf16 v127, v41, v1
  v_dot2c_f32_bf16 v128, v42, v0
  v_dot2c_f32_bf16 v129, v42, v1
  v_cvt_pk_bf16_f32 v2, v103, v214
  v_cvt_pk_bf16_f32 v3, v214, v103
  v_dot2c_f32_bf16 v112, v43, v2
  v_dot2c_f32_bf16 v113, v43, v3
  v_dot2c_f32_bf16 v114, v44, v2
  v_dot2c_f32_bf16 v115, v44, v3
  v_dot2c_f32_bf16 v116, v45, v2
  v_dot2c_f32_bf16 v117, v45, v3
  v_dot2c_f32_bf16 v118, v46, v2
  v_dot2c_f32_bf16 v119, v46, v3
  v_dot2c_f32_bf16 v120, v47, v2
  v_dot2c_f32_bf16 v121, v47, v3
  v_dot2c_f32_bf16 v122, v48, v2
  v_dot2c_f32_bf16 v123, v48, v3
  v_dot2c_f32_bf16 v124, v49, v2
  v_dot2c_f32_bf16 v125, v49, v3
  v_dot2c_f32_bf16 v126, v50, v2
  v_dot2c_f32_bf16 v127, v50, v3
  v_dot2c_f32_bf16 v128, v51, v2
  v_dot2c_f32_bf16 v129, v51, v3
  v_cvt_pk_bf16_f32 v0, v104, v214
  v_cvt_pk_bf16_f32 v1, v214, v104
  v_dot2c_f32_bf16 v112, v52, v0
  v_dot2c_f32_bf16 v113, v52, v1
  v_dot2c_f32_bf16 v114, v53, v0
  v_dot2c_f32_bf16 v115, v53, v1
  v_dot2c_f32_bf16 v116, v54, v0
  v_dot2c_f32_bf16 v117, v54, v1
  v_dot2c_f32_bf16 v118, v55, v0
  v_dot2c_f32_bf16 v119, v55, v1
  v_dot2c_f32_bf16 v120, v56, v0
  v_dot2c_f32_bf16 v121, v56, v1
  v_dot2c_f32_bf16 v122, v57, v0
  v_dot2c_f32_bf16 v123, v57, v1
  v_dot2c_f32_bf16 v124, v58, v0
  v_dot2c_f32_bf16 v125, v58, v1
  v_dot2c_f32_bf16 v126, v59, v0
  v_dot2c_f32_bf16 v127, v59, v1
  v_dot2c_f32_bf16 v128, v60, v0
  v_dot2c_f32_bf16 v129, v60, v1
  v_cvt_pk_bf16_f32 v2, v105, v214
  v_cvt_pk_bf16_f32 v3, v214, v105
  v_dot2c_f32_bf16 v112, v61, v2
  v_dot2c_f32_bf16 v113, v61, v3
  v_dot2c_f32_bf16 v114, v62, v2
  v_dot2c_f32_bf16 v115, v62, v3
  v_dot2c_f32_bf16 v116, v63, v2
  v_dot2c_f32_bf16 v117, v63, v3
  v_dot2c_f32_bf16 v118, v64, v2
  v_dot2c_f32_bf16 v119, v64, v3
  v_dot2c_f32_bf16 v120, v65, v2
  v_dot2c_f32_bf16 v121, v65, v3
  v_dot2c_f32_bf16 v122, v66, v2
  v_dot2c_f32_bf16 v123, v66, v3
  v_dot2c_f32_bf16 v124, v67, v2
  v_dot2c_f32_bf16 v125, v67, v3
  v_dot2c_f32_bf16 v126, v68, v2
  v_dot2c_f32_bf16 v127, v68, v3
  v_dot2c_f32_bf16 v128, v69, v2
  v_dot2c_f32_bf16 v129, v69, v3
  v_cvt_pk_bf16_f32 v0, v106, v214
  v_cvt_pk_bf16_f32 v1, v214, v106
  v_dot2c_f32_bf16 v112, v70, v0
  v_dot2c_f32_bf16 v113, v70, v1
  v_dot2c_f32_bf16 v114, v71, v0
  v_dot2c_f32_bf16 v115, v71, v1
  v_dot2c_f32_bf16 v116, v72, v0
  v_dot2c_f32_bf16 v117, v72, v1
  s_waitcnt lgkmcnt(14)
  v_dot2c_f32_bf16 v118, v73, v0
  v_dot2c_f32_bf16 v119, v73, v1
  s_waitcnt lgkmcnt(13)
  v_dot2c_f32_bf16 v120, v74, v0
  v_dot2c_f32_bf16 v121, v74, v1
  s_waitcnt lgkmcnt(12)
  v_dot2c_f32_bf16 v122, v75, v0
  v_dot2c_f32_bf16 v123, v75, v1
  s_waitcnt lgkmcnt(11)
  v_dot2c_f32_bf16 v124, v76, v0
  v_dot2c_f32_bf16 v125, v76, v1
  s_waitcnt lgkmcnt(10)
  v_dot2c_f32_bf16 v126, v77, v0
  v_dot2c_f32_bf16 v127, v77, v1
  s_waitcnt lgkmcnt(9)
  v_dot2c_f32_bf16 v128, v78, v0
  v_dot2c_f32_bf16 v129, v78, v1
  v_cvt_pk_bf16_f32 v2, v107, v214
  v_cvt_pk_bf16_f32 v3, v214, v107
  s_waitcnt lgkmcnt(8)
  v_dot2c_f32_bf16 v112, v79, v2
  v_dot2c_f32_bf16 v113, v79, v3
  s_waitcnt lgkmcnt(7)
  v_dot2c_f32_bf16 v114, v80, v2
  v_dot2c_f32_bf16 v115, v80, v3
  s_waitcnt lgkmcnt(6)
  v_dot2c_f32_bf16 v116, v81, v2
  v_dot2c_f32_bf16 v117, v81, v3
  s_waitcnt lgkmcnt(5)
  v_dot2c_f32_bf16 v118, v82, v2
  v_dot2c_f32_bf16 v119, v82, v3
  s_waitcnt lgkmcnt(4)
  v_dot2c_f32_bf16 v120, v83, v2
  v_dot2c_f32_bf16 v121, v83, v3
  s_waitcnt lgkmcnt(3)
  v_dot2c_f32_bf16 v122, v84, v2
  v_dot2c_f32_bf16 v123, v84, v3
  s_waitcnt lgkmcnt(2)
  v_dot2c_f32_bf16 v124, v85, v2
  v_dot2c_f32_bf16 v125, v85, v3
  s_waitcnt lgkmcnt(1)
  v_dot2c_f32_bf16 v126, v86, v2
  v_dot2c_f32_bf16 v127, v86, v3
  s_waitcnt lgkmcnt(0)
  v_dot2c_f32_bf16 v128, v87, v2
  v_dot2c_f32_bf16 v129, v87, v3
  v_cvt_pk_bf16_f32 v132, v112, v113
  v_cvt_pk_bf16_f32 v133, v114, v115
  v_cvt_pk_bf16_f32 v134, v116, v117
  v_cvt_pk_bf16_f32 v135, v118, v119
  v_cvt_pk_bf16_f32 v136, v120, v121
  v_cvt_pk_bf16_f32 v137, v122, v123
  v_cvt_pk_bf16_f32 v138, v124, v125
  v_cvt_pk_bf16_f32 v139, v126, v127
  v_cvt_pk_bf16_f32 v140, v128, v129
  buffer_store_dwordx4 v[132:135], v220, s[8:11], s64 offen sc1
  buffer_store_dwordx4 v[136:139], v220, s[8:11], s64 offen offset:16 sc1
  buffer_store_dword v140, v220, s[8:11], s64 offen offset:32 sc1
  v_add_u32 v219, 33024, v219
  s_add_u32 s66, s66, 64
  s_add_u32 s64, s64, 73728
  ds_read_b32 v0, v219 offset:7224
  ds_read_b32 v1, v219 offset:7228
  ds_read_b32 v2, v219 offset:7232
  ds_read_b32 v3, v219 offset:7236
  ds_read_b32 v4, v219 offset:7240
  ds_read_b32 v5, v219 offset:7244
  ds_read_b32 v6, v219 offset:7248
  ds_read_b32 v7, v219 offset:7252
  ds_read_b32 v8, v219 offset:7256
  ds_read_b32 v16, v219 offset:7368
  ds_read_b32 v17, v219 offset:7372
  ds_read_b32 v18, v219 offset:7376
  ds_read_b32 v19, v219 offset:7380
  ds_read_b32 v20, v219 offset:7384
  ds_read_b32 v21, v219 offset:7388
  ds_read_b32 v22, v219 offset:7392
  ds_read_b32 v23, v219 offset:7396
  ds_read_b32 v24, v219 offset:7400
  ds_read_b32 v25, v219 offset:6336
  ds_read_b32 v26, v219 offset:6340
  ds_read_b32 v27, v219 offset:6344
  ds_read_b32 v28, v219 offset:6348
  ds_read_b32 v29, v219 offset:6352
  ds_read_b32 v30, v219 offset:6356
  ds_read_b32 v31, v219 offset:6360
  ds_read_b32 v32, v219 offset:6364
  ds_read_b32 v33, v219 offset:6368
  ds_read_b32 v34, v219 offset:5304
  ds_read_b32 v35, v219 offset:5308
  ds_read_b32 v36, v219 offset:5312
  ds_read_b32 v37, v219 offset:5316
  ds_read_b32 v38, v219 offset:5320
  ds_read_b32 v39, v219 offset:5324
  ds_read_b32 v40, v219 offset:5328
  ds_read_b32 v41, v219 offset:5332
  ds_read_b32 v42, v219 offset:5336
  ds_read_b32 v43, v219 offset:4272
  ds_read_b32 v44, v219 offset:4276
  ds_read_b32 v45, v219 offset:4280
  ds_read_b32 v46, v219 offset:4284
  ds_read_b32 v47, v219 offset:4288
  ds_read_b32 v48, v219 offset:4292
  ds_read_b32 v49, v219 offset:4296
  ds_read_b32 v50, v219 offset:4300
  ds_read_b32 v51, v219 offset:4304
  ds_read_b32 v52, v219 offset:3240
  ds_read_b32 v53, v219 offset:3244
  ds_read_b32 v54, v219 offset:3248
  ds_read_b32 v55, v219 offset:3252
  ds_read_b32 v56, v219 offset:3256
  ds_read_b32 v57, v219 offset:3260
  ds_read_b32 v58, v219 offset:3264
  ds_read_b32 v59, v219 offset:3268
  ds_read_b32 v60, v219 offset:3272
  ds_read_b32 v61, v219 offset:2208
  ds_read_b32 v62, v219 offset:2212
  ds_read_b32 v63, v219 offset:2216
  ds_read_b32 v64, v219 offset:2220
  ds_read_b32 v65, v219 offset:2224
  ds_read_b32 v66, v219 offset:2228
  ds_read_b32 v67, v219 offset:2232
  ds_read_b32 v68, v219 offset:2236
  ds_read_b32 v69, v219 offset:2240
  ds_read_b32 v70, v219 offset:1176
  ds_read_b32 v71, v219 offset:1180
  ds_read_b32 v72, v219 offset:1184
  ds_read_b32 v73, v219 offset:1188
  ds_read_b32 v74, v219 offset:1192
  ds_read_b32 v75, v219 offset:1196
  ds_read_b32 v76, v219 offset:1200
  ds_read_b32 v77, v219 offset:1204
  ds_read_b32 v78, v219 offset:1208
  ds_read_b32 v79, v219 offset:144
  ds_read_b32 v80, v219 offset:148
  ds_read_b32 v81, v219 offset:152
  ds_read_b32 v82, v219 offset:156
  ds_read_b32 v83, v219 offset:160
  ds_read_b32 v84, v219 offset:164
  ds_read_b32 v85, v219 offset:168
  ds_read_b32 v86, v219 offset:172
  ds_read_b32 v87, v219 offset:176
  v_mov_b32 v100, 0
  v_mov_b32 v101, 0
  v_mov_b32 v102, 0
  v_mov_b32 v103, 0
  v_mov_b32 v104, 0
  v_mov_b32 v105, 0
  v_mov_b32 v106, 0
  v_mov_b32 v107, 0
  s_waitcnt lgkmcnt(15)
  v_dot2c_f32_bf16 v100, v0, v16
  v_dot2c_f32_bf16 v101, v0, v25
  v_dot2c_f32_bf16 v102, v0, v34
  v_dot2c_f32_bf16 v103, v0, v43
  v_dot2c_f32_bf16 v104, v0, v52
  v_dot2c_f32_bf16 v105, v0, v61
  v_dot2c_f32_bf16 v106, v0, v70
  s_waitcnt lgkmcnt(8)
  v_dot2c_f32_bf16 v107, v0, v79
  v_dot2c_f32_bf16 v100, v1, v17
  v_dot2c_f32_bf16 v101, v1, v26
  v_dot2c_f32_bf16 v102, v1, v35
  v_dot2c_f32_bf16 v103, v1, v44
  v_dot2c_f32_bf16 v104, v1, v53
  v_dot2c_f32_bf16 v105, v1, v62
  v_dot2c_f32_bf16 v106, v1, v71
  s_waitcnt lgkmcnt(7)
  v_dot2c_f32_bf16 v107, v1, v80
  v_dot2c_f32_bf16 v100, v2, v18
  v_dot2c_f32_bf16 v101, v2, v27
  v_dot2c_f32_bf16 v102, v2, v36
  v_dot2c_f32_bf16 v103, v2, v45
  v_dot2c_f32_bf16 v104, v2, v54
  v_dot2c_f32_bf16 v105, v2, v63
  v_dot2c_f32_bf16 v106, v2, v72
  s_waitcnt lgkmcnt(6)
  v_dot2c_f32_bf16 v107, v2, v81
  v_dot2c_f32_bf16 v100, v3, v19
  v_dot2c_f32_bf16 v101, v3, v28
  v_dot2c_f32_bf16 v102, v3, v37
  v_dot2c_f32_bf16 v103, v3, v46
  v_dot2c_f32_bf16 v104, v3, v55
  v_dot2c_f32_bf16 v105, v3, v64
  v_dot2c_f32_bf16 v106, v3, v73
  s_waitcnt lgkmcnt(5)
  v_dot2c_f32_bf16 v107, v3, v82
  v_dot2c_f32_bf16 v100, v4, v20
  v_dot2c_f32_bf16 v101, v4, v29
  v_dot2c_f32_bf16 v102, v4, v38
  v_dot2c_f32_bf16 v103, v4, v47
  v_dot2c_f32_bf16 v104, v4, v56
  v_dot2c_f32_bf16 v105, v4, v65
  v_dot2c_f32_bf16 v106, v4, v74
  s_waitcnt lgkmcnt(4)
  v_dot2c_f32_bf16 v107, v4, v83
  v_dot2c_f32_bf16 v100, v5, v21
  v_dot2c_f32_bf16 v101, v5, v30
  v_dot2c_f32_bf16 v102, v5, v39
  v_dot2c_f32_bf16 v103, v5, v48
  v_dot2c_f32_bf16 v104, v5, v57
  v_dot2c_f32_bf16 v105, v5, v66
  v_dot2c_f32_bf16 v106, v5, v75
  s_waitcnt lgkmcnt(3)
  v_dot2c_f32_bf16 v107, v5, v84
  v_dot2c_f32_bf16 v100, v6, v22
  v_dot2c_f32_bf16 v101, v6, v31
  v_dot2c_f32_bf16 v102, v6, v40
  v_dot2c_f32_bf16 v103, v6, v49
  v_dot2c_f32_bf16 v104, v6, v58
  v_dot2c_f32_bf16 v105, v6, v67
  v_dot2c_f32_bf16 v106, v6, v76
  s_waitcnt lgkmcnt(2)
  v_dot2c_f32_bf16 v107, v6, v85
  v_dot2c_f32_bf16 v100, v7, v23
  v_dot2c_f32_bf16 v101, v7, v32
  v_dot2c_f32_bf16 v102, v7, v41
  v_dot2c_f32_bf16 v103, v7, v50
  v_dot2c_f32_bf16 v104, v7, v59
  v_dot2c_f32_bf16 v105, v7, v68
  v_dot2c_f32_bf16 v106, v7, v77
  s_waitcnt lgkmcnt(1)
  v_dot2c_f32_bf16 v107, v7, v86
  v_dot2c_f32_bf16 v100, v8, v24
  v_dot2c_f32_bf16 v101, v8, v33
  v_dot2c_f32_bf16 v102, v8, v42
  v_dot2c_f32_bf16 v103, v8, v51
  v_dot2c_f32_bf16 v104, v8, v60
  v_dot2c_f32_bf16 v105, v8, v69
  v_dot2c_f32_bf16 v106, v8, v78
  s_waitcnt lgkmcnt(0)
  v_dot2c_f32_bf16 v107, v8, v87
  ds_read_b32 v16, v219 offset:7512
  ds_read_b32 v17, v219 offset:7516
  ds_read_b32 v18, v219 offset:7520
  ds_read_b32 v19, v219 offset:7524
  ds_read_b32 v20, v219 offset:7528
  ds_read_b32 v21, v219 offset:7532
  ds_read_b32 v22, v219 offset:7536
  ds_read_b32 v23, v219 offset:7540
  ds_read_b32 v24, v219 offset:7544
  ds_read_b32 v25, v219 offset:6480
  ds_read_b32 v26, v219 offset:6484
  ds_read_b32 v27, v219 offset:6488
  ds_read_b32 v28, v219 offset:6492
  ds_read_b32 v29, v219 offset:6496
  ds_read_b32 v30, v219 offset:6500
  ds_read_b32 v31, v219 offset:6504
  ds_read_b32 v32, v219 offset:6508
  ds_read_b32 v33, v219 offset:6512
  ds_read_b32 v34, v219 offset:5448
  ds_read_b32 v35, v219 offset:5452
  ds_read_b32 v36, v219 offset:5456
  ds_read_b32 v37, v219 offset:5460
  ds_read_b32 v38, v219 offset:5464
  ds_read_b32 v39, v219 offset:5468
  ds_read_b32 v40, v219 offset:5472
  ds_read_b32 v41, v219 offset:5476
  ds_read_b32 v42, v219 offset:5480
  ds_read_b32 v43, v219 offset:4416
  ds_read_b32 v44, v219 offset:4420
  ds_read_b32 v45, v219 offset:4424
  ds_read_b32 v46, v219 offset:4428
  ds_read_b32 v47, v219 offset:4432
  ds_read_b32 v48, v219 offset:4436
  ds_read_b32 v49, v219 offset:4440
  ds_read_b32 v50, v219 offset:4444
  ds_read_b32 v51, v219 offset:4448
  ds_read_b32 v52, v219 offset:3384
  ds_read_b32 v53, v219 offset:3388
  ds_read_b32 v54, v219 offset:3392
  ds_read_b32 v55, v219 offset:3396
  ds_read_b32 v56, v219 offset:3400
  ds_read_b32 v57, v219 offset:3404
  ds_read_b32 v58, v219 offset:3408
  ds_read_b32 v59, v219 offset:3412
  ds_read_b32 v60, v219 offset:3416
  ds_read_b32 v61, v219 offset:2352
  ds_read_b32 v62, v219 offset:2356
  ds_read_b32 v63, v219 offset:2360
  ds_read_b32 v64, v219 offset:2364
  ds_read_b32 v65, v219 offset:2368
  ds_read_b32 v66, v219 offset:2372
  ds_read_b32 v67, v219 offset:2376
  ds_read_b32 v68, v219 offset:2380
  ds_read_b32 v69, v219 offset:2384
  ds_read_b32 v70, v219 offset:1320
  ds_read_b32 v71, v219 offset:1324
  ds_read_b32 v72, v219 offset:1328
  ds_read_b32 v73, v219 offset:1332
  ds_read_b32 v74, v219 offset:1336
  ds_read_b32 v75, v219 offset:1340
  ds_read_b32 v76, v219 offset:1344
  ds_read_b32 v77, v219 offset:1348
  ds_read_b32 v78, v219 offset:1352
  ds_read_b32 v79, v219 offset:288
  ds_read_b32 v80, v219 offset:292
  ds_read_b32 v81, v219 offset:296
  ds_read_b32 v82, v219 offset:300
  ds_read_b32 v83, v219 offset:304
  ds_read_b32 v84, v219 offset:308
  ds_read_b32 v85, v219 offset:312
  ds_read_b32 v86, v219 offset:316
  ds_read_b32 v87, v219 offset:320
  v_add_u32 v211, s66, v200
  v_mov_b32 v212, 0xf149f2ca
  v_mul_f32 v100, s57, v100
  v_mul_f32 v101, s57, v101
  v_mul_f32 v102, s57, v102
  v_mul_f32 v103, s57, v103
  v_mul_f32 v104, s57, v104
  v_mul_f32 v105, s57, v105
  v_mul_f32 v106, s57, v106
  v_mul_f32 v107, s57, v107
  v_cmp_gt_u32 vcc, 2, v211
  s_nop 1
  v_cndmask_b32 v101, v101, v212, vcc
  v_cmp_gt_u32 vcc, 4, v211
  s_nop 1
  v_cndmask_b32 v102, v102, v212, vcc
  v_cmp_gt_u32 vcc, 6, v211
  s_nop 1
  v_cndmask_b32 v103, v103, v212, vcc
  v_cmp_gt_u32 vcc, 8, v211
  s_nop 1
  v_cndmask_b32 v104, v104, v212, vcc
  v_cmp_gt_u32 vcc, 10, v211
  s_nop 1
  v_cndmask_b32 v105, v105, v212, vcc
  v_cmp_gt_u32 vcc, 12, v211
  s_nop 1
  v_cndmask_b32 v106, v106, v212, vcc
  v_cmp_gt_u32 vcc, 14, v211
  s_nop 1
  v_cndmask_b32 v107, v107, v212, vcc
  v_max3_f32 v213, v100, v101, v102
  v_max3_f32 v213, v213, v103, v104
  v_max3_f32 v213, v213, v105, v106
  v_max_f32 v213, v213, v107
  v_sub_f32 v100, v100, v213
  v_sub_f32 v101, v101, v213
  v_sub_f32 v102, v102, v213
  v_sub_f32 v103, v103, v213
  v_sub_f32 v104, v104, v213
  v_sub_f32 v105, v105, v213
  v_sub_f32 v106, v106, v213
  v_sub_f32 v107, v107, v213
  v_exp_f32 v100, v100
  v_exp_f32 v101, v101
  v_exp_f32 v102, v102
  v_exp_f32 v103, v103
  v_exp_f32 v104, v104
  v_exp_f32 v105, v105
  v_exp_f32 v106, v106
  v_exp_f32 v107, v107
  v_add_f32 v213, v100, v101
  v_add_f32 v213, v213, v102
  v_add_f32 v213, v213, v103
  v_add_f32 v213, v213, v104
  v_add_f32 v213, v213, v105
  v_add_f32 v213, v213, v106
  v_add_f32 v213, v213, v107
  v_rcp_f32 v213, v213
  v_mov_b32 v214, 0
  v_mul_f32 v100, v213, v100
  v_mul_f32 v101, v213, v101
  v_mul_f32 v102, v213, v102
  v_mul_f32 v103, v213, v103
  v_mul_f32 v104, v213, v104
  v_mul_f32 v105, v213, v105
  v_mul_f32 v106, v213, v106
  v_mul_f32 v107, v213, v107
  v_mov_b32 v112, 0
  v_mov_b32 v113, 0
  v_mov_b32 v114, 0
  v_mov_b32 v115, 0
  v_mov_b32 v116, 0
  v_mov_b32 v117, 0
  v_mov_b32 v118, 0
  v_mov_b32 v119, 0
  v_mov_b32 v120, 0
  v_mov_b32 v121, 0
  v_mov_b32 v122, 0
  v_mov_b32 v123, 0
  v_mov_b32 v124, 0
  v_mov_b32 v125, 0
  v_mov_b32 v126, 0
  v_mov_b32 v127, 0
  v_mov_b32 v128, 0
  v_mov_b32 v129, 0
  v_cvt_pk_bf16_f32 v0, v100, v214
  v_cvt_pk_bf16_f32 v1, v214, v100
  s_waitcnt lgkmcnt(15)
  v_dot2c_f32_bf16 v112, v16, v0
  v_dot2c_f32_bf16 v113, v16, v1
  v_dot2c_f32_bf16 v114, v17, v0
  v_dot2c_f32_bf16 v115, v17, v1
  v_dot2c_f32_bf16 v116, v18, v0
  v_dot2c_f32_bf16 v117, v18, v1
  v_dot2c_f32_bf16 v118, v19, v0
  v_dot2c_f32_bf16 v119, v19, v1
  v_dot2c_f32_bf16 v120, v20, v0
  v_dot2c_f32_bf16 v121, v20, v1
  v_dot2c_f32_bf16 v122, v21, v0
  v_dot2c_f32_bf16 v123, v21, v1
  v_dot2c_f32_bf16 v124, v22, v0
  v_dot2c_f32_bf16 v125, v22, v1
  v_dot2c_f32_bf16 v126, v23, v0
  v_dot2c_f32_bf16 v127, v23, v1
  v_dot2c_f32_bf16 v128, v24, v0
  v_dot2c_f32_bf16 v129, v24, v1
  v_cvt_pk_bf16_f32 v2, v101, v214
  v_cvt_pk_bf16_f32 v3, v214, v101
  v_dot2c_f32_bf16 v112, v25, v2
  v_dot2c_f32_bf16 v113, v25, v3
  v_dot2c_f32_bf16 v114, v26, v2
  v_dot2c_f32_bf16 v115, v26, v3
  v_dot2c_f32_bf16 v116, v27, v2
  v_dot2c_f32_bf16 v117, v27, v3
  v_dot2c_f32_bf16 v118, v28, v2
  v_dot2c_f32_bf16 v119, v28, v3
  v_dot2c_f32_bf16 v120, v29, v2
  v_dot2c_f32_bf16 v121, v29, v3
  v_dot2c_f32_bf16 v122, v30, v2
  v_dot2c_f32_bf16 v123, v30, v3
  v_dot2c_f32_bf16 v124, v31, v2
  v_dot2c_f32_bf16 v125, v31, v3
  v_dot2c_f32_bf16 v126, v32, v2
  v_dot2c_f32_bf16 v127, v32, v3
  v_dot2c_f32_bf16 v128, v33, v2
  v_dot2c_f32_bf16 v129, v33, v3
  v_cvt_pk_bf16_f32 v0, v102, v214
  v_cvt_pk_bf16_f32 v1, v214, v102
  v_dot2c_f32_bf16 v112, v34, v0
  v_dot2c_f32_bf16 v113, v34, v1
  v_dot2c_f32_bf16 v114, v35, v0
  v_dot2c_f32_bf16 v115, v35, v1
  v_dot2c_f32_bf16 v116, v36, v0
  v_dot2c_f32_bf16 v117, v36, v1
  v_dot2c_f32_bf16 v118, v37, v0
  v_dot2c_f32_bf16 v119, v37, v1
  v_dot2c_f32_bf16 v120, v38, v0
  v_dot2c_f32_bf16 v121, v38, v1
  v_dot2c_f32_bf16 v122, v39, v0
  v_dot2c_f32_bf16 v123, v39, v1
  v_dot2c_f32_bf16 v124, v40, v0
  v_dot2c_f32_bf16 v125, v40, v1
  v_dot2c_f32_bf16 v126, v41, v0
  v_dot2c_f32_bf16 v127, v41, v1
  v_dot2c_f32_bf16 v128, v42, v0
  v_dot2c_f32_bf16 v129, v42, v1
  v_cvt_pk_bf16_f32 v2, v103, v214
  v_cvt_pk_bf16_f32 v3, v214, v103
  v_dot2c_f32_bf16 v112, v43, v2
  v_dot2c_f32_bf16 v113, v43, v3
  v_dot2c_f32_bf16 v114, v44, v2
  v_dot2c_f32_bf16 v115, v44, v3
  v_dot2c_f32_bf16 v116, v45, v2
  v_dot2c_f32_bf16 v117, v45, v3
  v_dot2c_f32_bf16 v118, v46, v2
  v_dot2c_f32_bf16 v119, v46, v3
  v_dot2c_f32_bf16 v120, v47, v2
  v_dot2c_f32_bf16 v121, v47, v3
  v_dot2c_f32_bf16 v122, v48, v2
  v_dot2c_f32_bf16 v123, v48, v3
  v_dot2c_f32_bf16 v124, v49, v2
  v_dot2c_f32_bf16 v125, v49, v3
  v_dot2c_f32_bf16 v126, v50, v2
  v_dot2c_f32_bf16 v127, v50, v3
  v_dot2c_f32_bf16 v128, v51, v2
  v_dot2c_f32_bf16 v129, v51, v3
  v_cvt_pk_bf16_f32 v0, v104, v214
  v_cvt_pk_bf16_f32 v1, v214, v104
  v_dot2c_f32_bf16 v112, v52, v0
  v_dot2c_f32_bf16 v113, v52, v1
  v_dot2c_f32_bf16 v114, v53, v0
  v_dot2c_f32_bf16 v115, v53, v1
  v_dot2c_f32_bf16 v116, v54, v0
  v_dot2c_f32_bf16 v117, v54, v1
  v_dot2c_f32_bf16 v118, v55, v0
  v_dot2c_f32_bf16 v119, v55, v1
  v_dot2c_f32_bf16 v120, v56, v0
  v_dot2c_f32_bf16 v121, v56, v1
  v_dot2c_f32_bf16 v122, v57, v0
  v_dot2c_f32_bf16 v123, v57, v1
  v_dot2c_f32_bf16 v124, v58, v0
  v_dot2c_f32_bf16 v125, v58, v1
  v_dot2c_f32_bf16 v126, v59, v0
  v_dot2c_f32_bf16 v127, v59, v1
  v_dot2c_f32_bf16 v128, v60, v0
  v_dot2c_f32_bf16 v129, v60, v1
  v_cvt_pk_bf16_f32 v2, v105, v214
  v_cvt_pk_bf16_f32 v3, v214, v105
  v_dot2c_f32_bf16 v112, v61, v2
  v_dot2c_f32_bf16 v113, v61, v3
  v_dot2c_f32_bf16 v114, v62, v2
  v_dot2c_f32_bf16 v115, v62, v3
  v_dot2c_f32_bf16 v116, v63, v2
  v_dot2c_f32_bf16 v117, v63, v3
  v_dot2c_f32_bf16 v118, v64, v2
  v_dot2c_f32_bf16 v119, v64, v3
  v_dot2c_f32_bf16 v120, v65, v2
  v_dot2c_f32_bf16 v121, v65, v3
  v_dot2c_f32_bf16 v122, v66, v2
  v_dot2c_f32_bf16 v123, v66, v3
  v_dot2c_f32_bf16 v124, v67, v2
  v_dot2c_f32_bf16 v125, v67, v3
  v_dot2c_f32_bf16 v126, v68, v2
  v_dot2c_f32_bf16 v127, v68, v3
  v_dot2c_f32_bf16 v128, v69, v2
  v_dot2c_f32_bf16 v129, v69, v3
  v_cvt_pk_bf16_f32 v0, v106, v214
  v_cvt_pk_bf16_f32 v1, v214, v106
  v_dot2c_f32_bf16 v112, v70, v0
  v_dot2c_f32_bf16 v113, v70, v1
  v_dot2c_f32_bf16 v114, v71, v0
  v_dot2c_f32_bf16 v115, v71, v1
  v_dot2c_f32_bf16 v116, v72, v0
  v_dot2c_f32_bf16 v117, v72, v1
  s_waitcnt lgkmcnt(14)
  v_dot2c_f32_bf16 v118, v73, v0
  v_dot2c_f32_bf16 v119, v73, v1
  s_waitcnt lgkmcnt(13)
  v_dot2c_f32_bf16 v120, v74, v0
  v_dot2c_f32_bf16 v121, v74, v1
  s_waitcnt lgkmcnt(12)
  v_dot2c_f32_bf16 v122, v75, v0
  v_dot2c_f32_bf16 v123, v75, v1
  s_waitcnt lgkmcnt(11)
  v_dot2c_f32_bf16 v124, v76, v0
  v_dot2c_f32_bf16 v125, v76, v1
  s_waitcnt lgkmcnt(10)
  v_dot2c_f32_bf16 v126, v77, v0
  v_dot2c_f32_bf16 v127, v77, v1
  s_waitcnt lgkmcnt(9)
  v_dot2c_f32_bf16 v128, v78, v0
  v_dot2c_f32_bf16 v129, v78, v1
  v_cvt_pk_bf16_f32 v2, v107, v214
  v_cvt_pk_bf16_f32 v3, v214, v107
  s_waitcnt lgkmcnt(8)
  v_dot2c_f32_bf16 v112, v79, v2
  v_dot2c_f32_bf16 v113, v79, v3
  s_waitcnt lgkmcnt(7)
  v_dot2c_f32_bf16 v114, v80, v2
  v_dot2c_f32_bf16 v115, v80, v3
  s_waitcnt lgkmcnt(6)
  v_dot2c_f32_bf16 v116, v81, v2
  v_dot2c_f32_bf16 v117, v81, v3
  s_waitcnt lgkmcnt(5)
  v_dot2c_f32_bf16 v118, v82, v2
  v_dot2c_f32_bf16 v119, v82, v3
  s_waitcnt lgkmcnt(4)
  v_dot2c_f32_bf16 v120, v83, v2
  v_dot2c_f32_bf16 v121, v83, v3
  s_waitcnt lgkmcnt(3)
  v_dot2c_f32_bf16 v122, v84, v2
  v_dot2c_f32_bf16 v123, v84, v3
  s_waitcnt lgkmcnt(2)
  v_dot2c_f32_bf16 v124, v85, v2
  v_dot2c_f32_bf16 v125, v85, v3
  s_waitcnt lgkmcnt(1)
  v_dot2c_f32_bf16 v126, v86, v2
  v_dot2c_f32_bf16 v127, v86, v3
  s_waitcnt lgkmcnt(0)
  v_dot2c_f32_bf16 v128, v87, v2
  v_dot2c_f32_bf16 v129, v87, v3
  v_cvt_pk_bf16_f32 v132, v112, v113
  v_cvt_pk_bf16_f32 v133, v114, v115
  v_cvt_pk_bf16_f32 v134, v116, v117
  v_cvt_pk_bf16_f32 v135, v118, v119
  v_cvt_pk_bf16_f32 v136, v120, v121
  v_cvt_pk_bf16_f32 v137, v122, v123
  v_cvt_pk_bf16_f32 v138, v124, v125
  v_cvt_pk_bf16_f32 v139, v126, v127
  v_cvt_pk_bf16_f32 v140, v128, v129
  buffer_store_dwordx4 v[132:135], v220, s[8:11], s64 offen sc1
  buffer_store_dwordx4 v[136:139], v220, s[8:11], s64 offen offset:16 sc1
  buffer_store_dword v140, v220, s[8:11], s64 offen offset:32 sc1
  s_mov_b32 s56, 36
  s_waitcnt vmcnt(0)
  s_barrier
  s_cmp_eq_u32 s52, 0
  s_cbranch_scc0 A_sig
  v_mov_b32 v211, 1
  v_mov_b32 v212, 0
  s_mov_b64 exec, 1
  buffer_atomic_add v211, v212, s[12:15], s56 offen
  s_mov_b64 exec, -1
A_sig:
  s_and_b32 s54, s53, 31
  s_cmp_lt_u32 s54, 27
  s_cbranch_scc0 L_exit
  s_and_b32 s54, s53, 31
  s_mul_i32 s68, s54, 57
  s_lshr_b32 s68, s68, 9
  s_mul_i32 s56, s68, 9
  s_sub_u32 s70, s54, s56
  s_bfe_u32 s55, s53, 0x10005
  s_mul_i32 s55, s55, 9
  s_add_u32 s70, s70, s55
  s_bfe_u32 s69, s53, 0x10006
  v_lshrrev_b32 v211, 2, v200
  v_mul_u32_u24 v211, 1152, v211
  v_and_b32 v212, 3, v200
  v_lshl_add_u32 v207, v212, 4, v211
  s_lshl_b32 s54, s70, 6
  s_mul_i32 s55, s52, 1179648
  s_add_u32 s62, s54, s55
  s_mul_i32 s55, s52, 184320
  s_add_u32 s63, s54, s55
  s_mul_i32 s61, s52, 40960
  v_bfe_u32 v211, v200, 2, 2
  v_lshlrev_b32 v212, 4, v212
  v_add_u32 v212, s61, v212
  v_lshl_add_u32 v212, v211, 6, v212
  v_lshrrev_b32 v213, 4, v200
  v_lshl_add_u32 v210, v213, 9, v212
  v_lshrrev_b32 v214, 5, v200
  v_lshl_add_u32 v209, v214, 10, v212
  v_and_b32 v214, 1, v213
  v_lshl_add_u32 v209, v214, 8, v209
  s_add_u32 m0, s61, 0
  s_add_u32 s54, s62, 0
  buffer_load_dwordx4 v207, s[28:31], s54 offen lds
  s_add_u32 m0, s61, 1024
  s_add_u32 s54, s62, 18432
  buffer_load_dwordx4 v207, s[28:31], s54 offen lds
  s_add_u32 m0, s61, 2048
  s_add_u32 s54, s62, 36864
  buffer_load_dwordx4 v207, s[28:31], s54 offen lds
  s_add_u32 m0, s61, 3072
  s_add_u32 s54, s62, 55296
  buffer_load_dwordx4 v207, s[28:31], s54 offen lds
  s_add_u32 m0, s61, 4096
  s_add_u32 s54, s62, 73728
  buffer_load_dwordx4 v207, s[28:31], s54 offen lds
  s_add_u32 m0, s61, 5120
  s_add_u32 s54, s62, 92160
  buffer_load_dwordx4 v207, s[28:31], s54 offen lds
  s_add_u32 m0, s61, 6144
  s_add_u32 s54, s62, 110592
  buffer_load_dwordx4 v207, s[28:31], s54 offen lds
  s_add_u32 m0, s61, 7168
  s_add_u32 s54, s62, 129024
  buffer_load_dwordx4 v207, s[28:31], s54 offen lds
  s_add_u32 m0, s61, 8192
  s_add_u32 s54, s62, 147456
  buffer_load_dwordx4 v207, s[28:31], s54 offen lds
  s_add_u32 m0, s61, 9216
  s_add_u32 s54, s62, 165888
  buffer_load_dwordx4 v207, s[28:31], s54 offen lds
  s_add_u32 m0, s61, 10240
  s_add_u32 s54, s62, 184320
  buffer_load_dwordx4 v207, s[28:31], s54 offen lds
  s_add_u32 m0, s61, 11264
  s_add_u32 s54, s62, 202752
  buffer_load_dwordx4 v207, s[28:31], s54 offen lds
  s_add_u32 m0, s61, 12288
  s_add_u32 s54, s62, 221184
  buffer_load_dwordx4 v207, s[28:31], s54 offen lds
  s_add_u32 m0, s61, 13312
  s_add_u32 s54, s62, 239616
  buffer_load_dwordx4 v207, s[28:31], s54 offen lds
  s_add_u32 m0, s61, 14336
  s_add_u32 s54, s62, 258048
  buffer_load_dwordx4 v207, s[28:31], s54 offen lds
  s_add_u32 m0, s61, 15360
  s_add_u32 s54, s62, 276480
  buffer_load_dwordx4 v207, s[28:31], s54 offen lds
  s_add_u32 m0, s61, 16384
  s_add_u32 s54, s62, 294912
  buffer_load_dwordx4 v207, s[28:31], s54 offen lds
  s_add_u32 m0, s61, 17408
  s_add_u32 s54, s62, 313344
  buffer_load_dwordx4 v207, s[28:31], s54 offen lds
  s_add_u32 m0, s61, 18432
  s_add_u32 s54, s62, 331776
  buffer_load_dwordx4 v207, s[28:31], s54 offen lds
  s_add_u32 m0, s61, 19456
  s_add_u32 s54, s62, 350208
  buffer_load_dwordx4 v207, s[28:31], s54 offen lds
  s_add_u32 m0, s61, 20480
  s_add_u32 s54, s62, 368640
  buffer_load_dwordx4 v207, s[28:31], s54 offen lds
  s_add_u32 m0, s61, 21504
  s_add_u32 s54, s62, 387072
  buffer_load_dwordx4 v207, s[28:31], s54 offen lds
  s_add_u32 m0, s61, 22528
  s_add_u32 s54, s62, 405504
  buffer_load_dwordx4 v207, s[28:31], s54 offen lds
  s_add_u32 m0, s61, 23552
  s_add_u32 s54, s62, 423936
  buffer_load_dwordx4 v207, s[28:31], s54 offen lds
  s_add_u32 m0, s61, 24576
  s_add_u32 s54, s62, 442368
  buffer_load_dwordx4 v207, s[28:31], s54 offen lds
  s_add_u32 m0, s61, 25600
  s_add_u32 s54, s62, 460800
  buffer_load_dwordx4 v207, s[28:31], s54 offen lds
  s_add_u32 m0, s61, 26624
  s_add_u32 s54, s62, 479232
  buffer_load_dwordx4 v207, s[28:31], s54 offen lds
  s_add_u32 m0, s61, 27648
  s_add_u32 s54, s62, 497664
  buffer_load_dwordx4 v207, s[28:31], s54 offen lds
  s_add_u32 m0, s61, 28672
  s_add_u32 s54, s62, 516096
  buffer_load_dwordx4 v207, s[28:31], s54 offen lds
  s_add_u32 m0, s61, 29696
  s_add_u32 s54, s62, 534528
  buffer_load_dwordx4 v207, s[28:31], s54 offen lds
  s_add_u32 m0, s61, 30720
  s_add_u32 s54, s62, 552960
  buffer_load_dwordx4 v207, s[28:31], s54 offen lds
  s_add_u32 m0, s61, 31744
  s_add_u32 s54, s62, 571392
  buffer_load_dwordx4 v207, s[28:31], s54 offen lds
  s_add_u32 m0, s61, 32768
  s_add_u32 s54, s62, 589824
  buffer_load_dwordx4 v207, s[28:31], s54 offen lds
  s_add_u32 m0, s61, 33792
  s_add_u32 s54, s62, 608256
  buffer_load_dwordx4 v207, s[28:31], s54 offen lds
  s_add_u32 m0, s61, 34816
  s_add_u32 s54, s62, 626688
  buffer_load_dwordx4 v207, s[28:31], s54 offen lds
  s_add_u32 m0, s61, 35840
  s_add_u32 s54, s62, 645120
  buffer_load_dwordx4 v207, s[28:31], s54 offen lds
  s_add_u32 m0, s61, 36864
  s_add_u32 s54, s62, 663552
  buffer_load_dwordx4 v207, s[28:31], s54 offen lds
  s_add_u32 m0, s61, 37888
  s_add_u32 s54, s62, 681984
  buffer_load_dwordx4 v207, s[28:31], s54 offen lds
  s_waitcnt vmcnt(36) lgkmcnt(0)
  s_add_u32 m0, s61, 38912
  s_add_u32 s54, s62, 700416
  buffer_load_dwordx4 v207, s[28:31], s54 offen lds
  s_add_u32 m0, s61, 39936
  s_add_u32 s54, s62, 718848
  buffer_load_dwordx4 v207, s[28:31], s54 offen lds
  ds_read_b64_tr_b16 a[0:1], v209 offset:0
  ds_read_b64_tr_b16 a[2:3], v209 offset:512
  ds_read_b64_tr_b16 a[4:5], v209 offset:8
  ds_read_b64_tr_b16 a[6:7], v209 offset:520
  s_waitcnt vmcnt(36) lgkmcnt(0)
  s_add_u32 m0, s61, 0
  s_add_u32 s54, s62, 737280
  buffer_load_dwordx4 v207, s[28:31], s54 offen lds
  s_add_u32 m0, s61, 1024
  s_add_u32 s54, s62, 755712
  buffer_load_dwordx4 v207, s[28:31], s54 offen lds
  ds_read_b64_tr_b16 a[8:9], v209 offset:2048
  ds_read_b64_tr_b16 a[10:11], v209 offset:2560
  ds_read_b64_tr_b16 a[12:13], v209 offset:2056
  ds_read_b64_tr_b16 a[14:15], v209 offset:2568
  s_waitcnt vmcnt(36) lgkmcnt(0)
  s_add_u32 m0, s61, 2048
  s_add_u32 s54, s62, 774144
  buffer_load_dwordx4 v207, s[28:31], s54 offen lds
  s_add_u32 m0, s61, 3072
  s_add_u32 s54, s62, 792576
  buffer_load_dwordx4 v207, s[28:31], s54 offen lds
  ds_read_b64_tr_b16 a[16:17], v209 offset:4096
  ds_read_b64_tr_b16 a[18:19], v209 offset:4608
  ds_read_b64_tr_b16 a[20:21], v209 offset:4104
  ds_read_b64_tr_b16 a[22:23], v209 offset:4616
  s_waitcnt vmcnt(36) lgkmcnt(0)
  s_add_u32 m0, s61, 4096
  s_add_u32 s54, s62, 811008
  buffer_load_dwordx4 v207, s[28:31], s54 offen lds
  s_add_u32 m0, s61, 5120
  s_add_u32 s54, s62, 829440
  buffer_load_dwordx4 v207, s[28:31], s54 offen lds
  ds_read_b64_tr_b16 a[24:25], v209 offset:6144
  ds_read_b64_tr_b16 a[26:27], v209 offset:6656
  ds_read_b64_tr_b16 a[28:29], v209 offset:6152
  ds_read_b64_tr_b16 a[30:31], v209 offset:6664
  s_waitcnt vmcnt(36) lgkmcnt(0)
  s_add_u32 m0, s61, 6144
  s_add_u32 s54, s62, 847872
  buffer_load_dwordx4 v207, s[28:31], s54 offen lds
  s_add_u32 m0, s61, 7168
  s_add_u32 s54, s62, 866304
  buffer_load_dwordx4 v207, s[28:31], s54 offen lds
  ds_read_b64_tr_b16 a[32:33], v209 offset:8192
  ds_read_b64_tr_b16 a[34:35], v209 offset:8704
  ds_read_b64_tr_b16 a[36:37], v209 offset:8200
  ds_read_b64_tr_b16 a[38:39], v209 offset:8712
  s_waitcnt vmcnt(36) lgkmcnt(0)
  s_add_u32 m0, s61, 8192
  s_add_u32 s54, s62, 884736
  buffer_load_dwordx4 v207, s[28:31], s54 offen lds
  s_add_u32 m0, s61, 9216
  s_add_u32 s54, s62, 903168
  buffer_load_dwordx4 v207, s[28:31], s54 offen lds
  ds_read_b64_tr_b16 a[40:41], v209 offset:10240
  ds_read_b64_tr_b16 a[42:43], v209 offset:10752
  ds_read_b64_tr_b16 a[44:45], v209 offset:10248
  ds_read_b64_tr_b16 a[46:47], v209 offset:10760
  s_waitcnt vmcnt(36) lgkmcnt(0)
  s_add_u32 m0, s61, 10240
  s_add_u32 s54, s62, 921600
  buffer_load_dwordx4 v207, s[28:31], s54 offen lds
  s_add_u32 m0, s61, 11264
  s_add_u32 s54, s62, 940032
  buffer_load_dwordx4 v207, s[28:31], s54 offen lds
  ds_read_b64_tr_b16 a[48:49], v209 offset:12288
  ds_read_b64_tr_b16 a[50:51], v209 offset:12800
  ds_read_b64_tr_b16 a[52:53], v209 offset:12296
  ds_read_b64_tr_b16 a[54:55], v209 offset:12808
  s_waitcnt vmcnt(36) lgkmcnt(0)
  s_add_u32 m0, s61, 12288
  s_add_u32 s54, s62, 958464
  buffer_load_dwordx4 v207, s[28:31], s54 offen lds
  s_add_u32 m0, s61, 13312
  s_add_u32 s54, s62, 976896
  buffer_load_dwordx4 v207, s[28:31], s54 offen lds
  ds_read_b64_tr_b16 a[56:57], v209 offset:14336
  ds_read_b64_tr_b16 a[58:59], v209 offset:14848
  ds_read_b64_tr_b16 a[60:61], v209 offset:14344
  ds_read_b64_tr_b16 a[62:63], v209 offset:14856
  s_waitcnt vmcnt(36) lgkmcnt(0)
  s_add_u32 m0, s61, 14336
  s_add_u32 s54, s62, 995328
  buffer_load_dwordx4 v207, s[28:31], s54 offen lds
  s_add_u32 m0, s61, 15360
  s_add_u32 s54, s62, 1013760
  buffer_load_dwordx4 v207, s[28:31], s54 offen lds
  ds_read_b64_tr_b16 a[64:65], v209 offset:16384
  ds_read_b64_tr_b16 a[66:67], v209 offset:16896
  ds_read_b64_tr_b16 a[68:69], v209 offset:16392
  ds_read_b64_tr_b16 a[70:71], v209 offset:16904
  s_waitcnt vmcnt(36) lgkmcnt(0)
  s_add_u32 m0, s61, 16384
  s_add_u32 s54, s62, 1032192
  buffer_load_dwordx4 v207, s[28:31], s54 offen lds
  s_add_u32 m0, s61, 17408
  s_add_u32 s54, s62, 1050624
  buffer_load_dwordx4 v207, s[28:31], s54 offen lds
  ds_read_b64_tr_b16 a[72:73], v209 offset:18432
  ds_read_b64_tr_b16 a[74:75], v209 offset:18944
  ds_read_b64_tr_b16 a[76:77], v209 offset:18440
  ds_read_b64_tr_b16 a[78:79], v209 offset:18952
  s_waitcnt vmcnt(36) lgkmcnt(0)
  s_add_u32 m0, s61, 18432
  s_add_u32 s54, s62, 1069056
  buffer_load_dwordx4 v207, s[28:31], s54 offen lds
  s_add_u32 m0, s61, 19456
  s_add_u32 s54, s62, 1087488
  buffer_load_dwordx4 v207, s[28:31], s54 offen lds
  ds_read_b64_tr_b16 a[80:81], v209 offset:20480
  ds_read_b64_tr_b16 a[82:83], v209 offset:20992
  ds_read_b64_tr_b16 a[84:85], v209 offset:20488
  ds_read_b64_tr_b16 a[86:87], v209 offset:21000
  s_waitcnt vmcnt(36) lgkmcnt(0)
  s_add_u32 m0, s61, 20480
  s_add_u32 s54, s62, 1105920
  buffer_load_dwordx4 v207, s[28:31], s54 offen lds
  s_add_u32 m0, s61, 21504
  s_add_u32 s54, s62, 1124352
  buffer_load_dwordx4 v207, s[28:31], s54 offen lds
  ds_read_b64_tr_b16 a[88:89], v209 offset:22528
  ds_read_b64_tr_b16 a[90:91], v209 offset:23040
  ds_read_b64_tr_b16 a[92:93], v209 offset:22536
  ds_read_b64_tr_b16 a[94:95], v209 offset:23048
  s_waitcnt vmcnt(36) lgkmcnt(0)
  s_add_u32 m0, s61, 22528
  s_add_u32 s54, s62, 1142784
  buffer_load_dwordx4 v207, s[28:31], s54 offen lds
  s_add_u32 m0, s61, 23552
  s_add_u32 s54, s62, 1161216
  buffer_load_dwordx4 v207, s[28:31], s54 offen lds
  ds_read_b64_tr_b16 a[96:97], v209 offset:24576
  ds_read_b64_tr_b16 a[98:99], v209 offset:25088
  ds_read_b64_tr_b16 a[100:101], v209 offset:24584
  ds_read_b64_tr_b16 a[102:103], v209 offset:25096
  s_waitcnt vmcnt(36) lgkmcnt(0)
  s_add_u32 m0, s61, 24576
  s_add_u32 s54, s63, 0
  buffer_load_dwordx4 v207, s[40:43], s54 offen lds
  s_add_u32 m0, s61, 25600
  s_add_u32 s54, s63, 18432
  buffer_load_dwordx4 v207, s[40:43], s54 offen lds
  ds_read_b64_tr_b16 a[104:105], v209 offset:26624
  ds_read_b64_tr_b16 a[106:107], v209 offset:27136
  ds_read_b64_tr_b16 a[108:109], v209 offset:26632
  ds_read_b64_tr_b16 a[110:111], v209 offset:27144
  s_waitcnt vmcnt(36) lgkmcnt(0)
  s_add_u32 m0, s61, 26624
  s_add_u32 s54, s63, 36864
  buffer_load_dwordx4 v207, s[40:43], s54 offen lds
  s_add_u32 m0, s61, 27648
  s_add_u32 s54, s63, 55296
  buffer_load_dwordx4 v207, s[40:43], s54 offen lds
  ds_read_b64_tr_b16 a[112:113], v209 offset:28672
  ds_read_b64_tr_b16 a[114:115], v209 offset:29184
  ds_read_b64_tr_b16 a[116:117], v209 offset:28680
  ds_read_b64_tr_b16 a[118:119], v209 offset:29192
  s_waitcnt vmcnt(36) lgkmcnt(0)
  s_add_u32 m0, s61, 28672
  s_add_u32 s54, s63, 73728
  buffer_load_dwordx4 v207, s[40:43], s54 offen lds
  s_add_u32 m0, s61, 29696
  s_add_u32 s54, s63, 92160
  buffer_load_dwordx4 v207, s[40:43], s54 offen lds
  ds_read_b64_tr_b16 a[120:121], v209 offset:30720
  ds_read_b64_tr_b16 a[122:123], v209 offset:31232
  ds_read_b64_tr_b16 a[124:125], v209 offset:30728
  ds_read_b64_tr_b16 a[126:127], v209 offset:31240
  s_waitcnt vmcnt(36) lgkmcnt(0)
  s_add_u32 m0, s61, 30720
  s_add_u32 s54, s63, 110592
  buffer_load_dwordx4 v207, s[40:43], s54 offen lds
  s_add_u32 m0, s61, 31744
  s_add_u32 s54, s63, 129024
  buffer_load_dwordx4 v207, s[40:43], s54 offen lds
  ds_read_b64_tr_b16 a[128:129], v209 offset:32768
  ds_read_b64_tr_b16 a[130:131], v209 offset:33280
  ds_read_b64_tr_b16 a[132:133], v209 offset:32776
  ds_read_b64_tr_b16 a[134:135], v209 offset:33288
  s_waitcnt vmcnt(36) lgkmcnt(0)
  s_add_u32 m0, s61, 32768
  s_add_u32 s54, s63, 147456
  buffer_load_dwordx4 v207, s[40:43], s54 offen lds
  s_add_u32 m0, s61, 33792
  s_add_u32 s54, s63, 165888
  buffer_load_dwordx4 v207, s[40:43], s54 offen lds
  ds_read_b64_tr_b16 a[136:137], v209 offset:34816
  ds_read_b64_tr_b16 a[138:139], v209 offset:35328
  ds_read_b64_tr_b16 a[140:141], v209 offset:34824
  ds_read_b64_tr_b16 a[142:143], v209 offset:35336
  s_waitcnt vmcnt(36) lgkmcnt(0)
  ds_read_b64_tr_b16 a[144:145], v209 offset:36864
  ds_read_b64_tr_b16 a[146:147], v209 offset:37376
  ds_read_b64_tr_b16 a[148:149], v209 offset:36872
  ds_read_b64_tr_b16 a[150:151], v209 offset:37384
  s_waitcnt vmcnt(34) lgkmcnt(0)
  ds_read_b64_tr_b16 a[152:153], v209 offset:38912
  ds_read_b64_tr_b16 a[154:155], v209 offset:39424
  ds_read_b64_tr_b16 a[156:157], v209 offset:38920
  ds_read_b64_tr_b16 a[158:159], v209 offset:39432
  s_waitcnt vmcnt(32) lgkmcnt(0)
  ds_read_b64_tr_b16 a[160:161], v209 offset:0
  ds_read_b64_tr_b16 a[162:163], v209 offset:512
  ds_read_b64_tr_b16 a[164:165], v209 offset:8
  ds_read_b64_tr_b16 a[166:167], v209 offset:520
  s_waitcnt vmcnt(30) lgkmcnt(0)
  ds_read_b64_tr_b16 a[168:169], v209 offset:2048
  ds_read_b64_tr_b16 a[170:171], v209 offset:2560
  ds_read_b64_tr_b16 a[172:173], v209 offset:2056
  ds_read_b64_tr_b16 a[174:175], v209 offset:2568
  s_waitcnt vmcnt(28) lgkmcnt(0)
  ds_read_b64_tr_b16 a[176:177], v209 offset:4096
  ds_read_b64_tr_b16 a[178:179], v209 offset:4608
  ds_read_b64_tr_b16 a[180:181], v209 offset:4104
  ds_read_b64_tr_b16 a[182:183], v209 offset:4616
  s_waitcnt vmcnt(26) lgkmcnt(0)
  ds_read_b64_tr_b16 a[184:185], v209 offset:6144
  ds_read_b64_tr_b16 a[186:187], v209 offset:6656
  ds_read_b64_tr_b16 a[188:189], v209 offset:6152
  ds_read_b64_tr_b16 a[190:191], v209 offset:6664
  s_waitcnt vmcnt(24) lgkmcnt(0)
  ds_read_b64_tr_b16 a[192:193], v209 offset:8192
  ds_read_b64_tr_b16 a[194:195], v209 offset:8704
  ds_read_b64_tr_b16 a[196:197], v209 offset:8200
  ds_read_b64_tr_b16 a[198:199], v209 offset:8712
  s_waitcnt vmcnt(22) lgkmcnt(0)
  ds_read_b64_tr_b16 a[200:201], v209 offset:10240
  ds_read_b64_tr_b16 a[202:203], v209 offset:10752
  ds_read_b64_tr_b16 a[204:205], v209 offset:10248
  ds_read_b64_tr_b16 a[206:207], v209 offset:10760
  s_waitcnt vmcnt(20) lgkmcnt(0)
  ds_read_b64_tr_b16 a[208:209], v209 offset:12288
  ds_read_b64_tr_b16 a[210:211], v209 offset:12800
  ds_read_b64_tr_b16 a[212:213], v209 offset:12296
  ds_read_b64_tr_b16 a[214:215], v209 offset:12808
  s_waitcnt vmcnt(18) lgkmcnt(0)
  ds_read_b64_tr_b16 a[216:217], v209 offset:14336
  ds_read_b64_tr_b16 a[218:219], v209 offset:14848
  ds_read_b64_tr_b16 a[220:221], v209 offset:14344
  ds_read_b64_tr_b16 a[222:223], v209 offset:14856
  s_waitcnt vmcnt(16) lgkmcnt(0)
  ds_read_b64_tr_b16 a[224:225], v209 offset:16384
  ds_read_b64_tr_b16 a[226:227], v209 offset:16896
  ds_read_b64_tr_b16 a[228:229], v209 offset:16392
  ds_read_b64_tr_b16 a[230:231], v209 offset:16904
  s_waitcnt vmcnt(14) lgkmcnt(0)
  ds_read_b64_tr_b16 a[232:233], v209 offset:18432
  ds_read_b64_tr_b16 a[234:235], v209 offset:18944
  ds_read_b64_tr_b16 a[236:237], v209 offset:18440
  ds_read_b64_tr_b16 a[238:239], v209 offset:18952
  s_waitcnt vmcnt(12) lgkmcnt(0)
  ds_read_b64_tr_b16 a[240:241], v209 offset:20480
  ds_read_b64_tr_b16 a[242:243], v209 offset:20992
  ds_read_b64_tr_b16 a[244:245], v209 offset:20488
  ds_read_b64_tr_b16 a[246:247], v209 offset:21000
  s_waitcnt vmcnt(10) lgkmcnt(0)
  ds_read_b64_tr_b16 a[248:249], v209 offset:22528
  ds_read_b64_tr_b16 a[250:251], v209 offset:23040
  ds_read_b64_tr_b16 a[252:253], v209 offset:22536
  ds_read_b64_tr_b16 a[254:255], v209 offset:23048
  s_waitcnt vmcnt(8) lgkmcnt(0)
  ds_read_b64_tr_b16 v[216:217], v210 offset:24576
  ds_read_b64_tr_b16 v[218:219], v210 offset:24832
  ds_read_b64_tr_b16 v[220:221], v210 offset:24584
  ds_read_b64_tr_b16 v[222:223], v210 offset:24840
  s_waitcnt vmcnt(6) lgkmcnt(0)
  ds_read_b64_tr_b16 v[224:225], v210 offset:26624
  ds_read_b64_tr_b16 v[226:227], v210 offset:26880
  ds_read_b64_tr_b16 v[228:229], v210 offset:26632
  ds_read_b64_tr_b16 v[230:231], v210 offset:26888
  s_waitcnt vmcnt(4) lgkmcnt(0)
  ds_read_b64_tr_b16 v[232:233], v210 offset:28672
  ds_read_b64_tr_b16 v[234:235], v210 offset:28928
  ds_read_b64_tr_b16 v[236:237], v210 offset:28680
  ds_read_b64_tr_b16 v[238:239], v210 offset:28936
  s_waitcnt vmcnt(2) lgkmcnt(0)
  ds_read_b64_tr_b16 v[240:241], v210 offset:30720
  ds_read_b64_tr_b16 v[242:243], v210 offset:30976
  ds_read_b64_tr_b16 v[244:245], v210 offset:30728
  ds_read_b64_tr_b16 v[246:247], v210 offset:30984
  s_waitcnt vmcnt(0) lgkmcnt(0)
  ds_read_b64_tr_b16 v[248:249], v210 offset:32768
  ds_read_b64_tr_b16 v[250:251], v210 offset:33024
  ds_read_b64_tr_b16 v[252:253], v210 offset:32776
  ds_read_b64_tr_b16 v[254:255], v210 offset:33032
  v_and_b32 v211, 15, v200
  s_lshl_b32 s54, s69, 4
  v_add_u32 v211, s54, v211
  v_lshl_add_u32 v212, v214, 5, v211
  v_lshlrev_b32 v164, 4, v212
  v_lshrrev_b32 v212, 5, v200
  v_lshl_add_u32 v164, v212, 10, v164
  v_mul_u32_u24 v167, 1152, v211
  v_lshl_add_u32 v167, v213, 4, v167
  v_lshlrev_b32 v166, 2, v211
  v_lshlrev_b32 v208, 2, v200
  s_lshl_b32 s54, s52, 11
  v_add_u32 v168, s54, v201
  s_mov_b32 s59, s68
  s_mov_b32 s56, 128
  s_mov_b32 s57, 36
  s_waitcnt lgkmcnt(0)
  s_cmp_eq_u32 s52, 0
  s_cbranch_scc0 O_p1_d
  s_mov_b32 exec_hi, 0
  s_mov_b32 exec_lo, -1
O_p1:
  buffer_load_dword v211, v208, s[12:15], s56 offen sc1
  s_add_u32 s65, s65, 1
  s_waitcnt vmcnt(0)
  v_cmp_gt_u32 vcc, 0x700, v211
  s_cbranch_vccz O_p1_x
  s_sleep 16
  s_cmp_lt_u32 s65, 131072
  s_cbranch_scc1 O_p1
O_p1_x:
  s_mov_b64 exec, -1
O_p1_d:
  s_barrier
  s_cmp_eq_u32 s52, 0
  s_cbranch_scc0 O_a_d
  s_mov_b32 exec_hi, 0
  s_mov_b32 exec_lo, 1
O_a:
  buffer_load_dword v211, v208, s[12:15], s57 offen sc1
  s_add_u32 s65, s65, 1
  s_waitcnt vmcnt(0)
  v_cmp_gt_u32 vcc, 0x80, v211
  s_cbranch_vccz O_a_x
  s_sleep 16
  s_cmp_lt_u32 s65, 131072
  s_cbranch_scc1 O_a
O_a_x:
  s_mov_b64 exec, -1
O_a_d:
  s_barrier
  s_cmp_ge_u32 s70, 9
  s_cselect_b32 s54, 9, 0
  s_sub_u32 s54, s70, s54
  s_and_b32 s54, s54, 7
  s_lshl_b32 s54, s54, 13
  s_lshl_b32 s55, s69, 8
  s_add_u32 s54, s54, s55
  v_lshrrev_b32 v211, 2, v200
  v_lshl_add_u32 v172, v211, 9, s54
  v_and_b32 v211, 3, v200
  v_lshl_add_u32 v172, v211, 6, v172
  s_mul_i32 s55, s59, 36864
  s_mul_i32 s54, s52, 320
  s_add_u32 s55, s55, s54
  s_add_u32 s55, s55, 62914560
  s_cmp_eq_u32 s52, 3
  s_cselect_b32 s56, 268435456, s55
  buffer_load_dwordx4 v[128:131], v167, s[8:11], s55 offen offset:0 sc1
  buffer_load_dwordx4 v[132:135], v167, s[8:11], s55 offen offset:64 sc1
  buffer_load_dwordx4 v[136:139], v167, s[8:11], s55 offen offset:128 sc1
  buffer_load_dwordx4 v[140:143], v167, s[8:11], s56 offen offset:192 sc1
  buffer_load_dwordx4 v[144:147], v167, s[8:11], s56 offen offset:256 sc1
  s_lshl_b32 s55, s59, 7
  s_add_u32 s55, s55, 66060288
  buffer_load_dword v171, v166, s[8:11], s55 offen sc1
  v_mov_b32 v169, 0
  s_mov_b32 s66, 356352
  s_waitcnt vmcnt(0)
O_loop:
  v_mfma_f32_16x16x32_bf16 v[156:159], v[216:219], v[128:131], 0
  v_mfma_f32_16x16x32_bf16 v[160:163], v[220:223], v[128:131], 0
  v_mfma_f32_16x16x32_bf16 v[156:159], v[224:227], v[132:135], v[156:159]
  v_mfma_f32_16x16x32_bf16 v[160:163], v[228:231], v[132:135], v[160:163]
  v_mfma_f32_16x16x32_bf16 v[156:159], v[232:235], v[136:139], v[156:159]
  v_mfma_f32_16x16x32_bf16 v[160:163], v[236:239], v[136:139], v[160:163]
  v_mfma_f32_16x16x32_bf16 v[156:159], v[240:243], v[140:143], v[156:159]
  v_mfma_f32_16x16x32_bf16 v[160:163], v[244:247], v[140:143], v[160:163]
  v_mfma_f32_16x16x32_bf16 v[156:159], v[248:251], v[144:147], v[156:159]
  v_mfma_f32_16x16x32_bf16 v[160:163], v[252:255], v[144:147], v[160:163]
  s_mul_i32 s64, s59, 36864
  s_lshl_b32 s54, s70, 6
  s_add_u32 s64, s64, s54
  s_add_u32 s71, s59, 2
  s_lshl_b32 s55, s59, 18
  s_lshl_b32 s54, s52, 16
  s_add_u32 s55, s55, s54
  s_add_u32 s63, s55, 46137344
  s_and_b32 s54, s59, 1
  s_lshl_b32 s54, s54, 2
  s_add_u32 s54, s54, s52
  s_lshl_b32 s54, s54, 3
  s_lshl_b64 s[72:73], 0xff, s54
  v_sub_f32 v165, 1.0, v171
  v_cvt_pk_bf16_f32 v165, v165, v165
  v_lshlrev_b32 v165, 16, v165
  v_mul_f32 v156, v171, v156
  v_mul_f32 v157, v171, v157
  v_mul_f32 v158, v171, v158
  v_mul_f32 v159, v171, v159
  v_mul_f32 v160, v171, v160
  v_mul_f32 v161, v171, v161
  v_mul_f32 v162, v171, v162
  v_mul_f32 v163, v171, v163
  s_branch O_pc
O_pl:
  s_sleep 1
  buffer_load_dword v169, v208, s[8:11], s66 offen sc1
  s_add_u32 s65, s65, 1
  s_cmp_ge_u32 s65, 131072
  s_cbranch_scc1 O_ld
  s_waitcnt vmcnt(0)
O_pc:
  v_cmp_gt_u32 vcc, s71, v169
  s_nop 0
  s_and_b64 vcc, vcc, s[72:73]
  s_cbranch_scc1 O_pl
O_ld:
  s_mov_b32 s62, s63
  buffer_load_dword v173, v172, s[8:11], s63 offen sc1
  buffer_load_dwordx4 v[0:3], v164, s[8:11], s62 offen offset:0 sc1
  buffer_load_dwordx4 v[4:7], v164, s[8:11], s62 offen offset:2048 sc1
  s_add_u32 s62, s62, 4096
  buffer_load_dwordx4 v[8:11], v164, s[8:11], s62 offen offset:0 sc1
  buffer_load_dwordx4 v[12:15], v164, s[8:11], s62 offen offset:2048 sc1
  s_add_u32 s62, s62, 4096
  buffer_load_dwordx4 v[16:19], v164, s[8:11], s62 offen offset:0 sc1
  buffer_load_dwordx4 v[20:23], v164, s[8:11], s62 offen offset:2048 sc1
  s_add_u32 s62, s62, 4096
  buffer_load_dwordx4 v[24:27], v164, s[8:11], s62 offen offset:0 sc1
  buffer_load_dwordx4 v[28:31], v164, s[8:11], s62 offen offset:2048 sc1
  s_add_u32 s62, s62, 4096
  buffer_load_dwordx4 v[32:35], v164, s[8:11], s62 offen offset:0 sc1
  buffer_load_dwordx4 v[36:39], v164, s[8:11], s62 offen offset:2048 sc1
  s_add_u32 s62, s62, 4096
  buffer_load_dwordx4 v[40:43], v164, s[8:11], s62 offen offset:0 sc1
  buffer_load_dwordx4 v[44:47], v164, s[8:11], s62 offen offset:2048 sc1
  s_add_u32 s62, s62, 4096
  buffer_load_dwordx4 v[48:51], v164, s[8:11], s62 offen offset:0 sc1
  buffer_load_dwordx4 v[52:55], v164, s[8:11], s62 offen offset:2048 sc1
  s_add_u32 s62, s62, 4096
  buffer_load_dwordx4 v[56:59], v164, s[8:11], s62 offen offset:0 sc1
  buffer_load_dwordx4 v[60:63], v164, s[8:11], s62 offen offset:2048 sc1
  s_add_u32 s62, s62, 4096
  buffer_load_dwordx4 v[64:67], v164, s[8:11], s62 offen offset:0 sc1
  buffer_load_dwordx4 v[68:71], v164, s[8:11], s62 offen offset:2048 sc1
  s_add_u32 s62, s62, 4096
  buffer_load_dwordx4 v[72:75], v164, s[8:11], s62 offen offset:0 sc1
  buffer_load_dwordx4 v[76:79], v164, s[8:11], s62 offen offset:2048 sc1
  s_add_u32 s62, s62, 4096
  buffer_load_dwordx4 v[80:83], v164, s[8:11], s62 offen offset:0 sc1
  buffer_load_dwordx4 v[84:87], v164, s[8:11], s62 offen offset:2048 sc1
  s_add_u32 s62, s62, 4096
  buffer_load_dwordx4 v[88:91], v164, s[8:11], s62 offen offset:0 sc1
  buffer_load_dwordx4 v[92:95], v164, s[8:11], s62 offen offset:2048 sc1
  s_add_u32 s62, s62, 4096
  buffer_load_dwordx4 v[96:99], v164, s[8:11], s62 offen offset:0 sc1
  buffer_load_dwordx4 v[100:103], v164, s[8:11], s62 offen offset:2048 sc1
  s_add_u32 s62, s62, 4096
  buffer_load_dwordx4 v[104:107], v164, s[8:11], s62 offen offset:0 sc1
  buffer_load_dwordx4 v[108:111], v164, s[8:11], s62 offen offset:2048 sc1
  s_add_u32 s62, s62, 4096
  buffer_load_dwordx4 v[112:115], v164, s[8:11], s62 offen offset:0 sc1
  buffer_load_dwordx4 v[116:119], v164, s[8:11], s62 offen offset:2048 sc1
  s_add_u32 s62, s62, 4096
  buffer_load_dwordx4 v[120:123], v164, s[8:11], s62 offen offset:0 sc1
  buffer_load_dwordx4 v[124:127], v164, s[8:11], s62 offen offset:2048 sc1
  s_add_u32 s62, s62, 4096
  s_add_u32 s57, s59, 3
  s_min_u32 s74, s57, 63
  s_mul_i32 s55, s74, 36864
  s_mul_i32 s54, s52, 320
  s_add_u32 s55, s55, s54
  s_add_u32 s55, s55, 62914560
  s_cmp_eq_u32 s52, 3
  s_cselect_b32 s56, 268435456, s55
  buffer_load_dwordx4 v[128:131], v167, s[8:11], s55 offen offset:0 sc1
  buffer_load_dwordx4 v[132:135], v167, s[8:11], s55 offen offset:64 sc1
  buffer_load_dwordx4 v[136:139], v167, s[8:11], s55 offen offset:128 sc1
  buffer_load_dwordx4 v[140:143], v167, s[8:11], s56 offen offset:192 sc1
  buffer_load_dwordx4 v[144:147], v167, s[8:11], s56 offen offset:256 sc1
  s_lshl_b32 s55, s74, 7
  s_add_u32 s55, s55, 66060288
  buffer_load_dword v171, v166, s[8:11], s55 offen sc1
  s_add_u32 s65, s65, 1
  s_cmp_lt_u32 s65, 131072
  s_cselect_b32 s54, -2, -1
  s_waitcnt vmcnt(37)
  v_mfma_f32_16x16x32_bf16 v[148:151], a[0:3], v[0:3], 0
  v_mfma_f32_16x16x32_bf16 v[152:155], a[4:7], v[0:3], 0
  v_max3_u32 v170, v0, v1, v0
  v_max3_u32 v170, v2, v3, v170
  s_waitcnt vmcnt(36)
  v_mfma_f32_16x16x32_bf16 v[148:151], a[8:11], v[4:7], v[148:151]
  v_mfma_f32_16x16x32_bf16 v[152:155], a[12:15], v[4:7], v[152:155]
  v_max3_u32 v170, v4, v5, v170
  v_max3_u32 v170, v6, v7, v170
  s_waitcnt vmcnt(35)
  v_mfma_f32_16x16x32_bf16 v[148:151], a[16:19], v[8:11], v[148:151]
  v_mfma_f32_16x16x32_bf16 v[152:155], a[20:23], v[8:11], v[152:155]
  v_max3_u32 v170, v8, v9, v170
  v_max3_u32 v170, v10, v11, v170
  s_waitcnt vmcnt(34)
  v_mfma_f32_16x16x32_bf16 v[148:151], a[24:27], v[12:15], v[148:151]
  v_mfma_f32_16x16x32_bf16 v[152:155], a[28:31], v[12:15], v[152:155]
  v_max3_u32 v170, v12, v13, v170
  v_max3_u32 v170, v14, v15, v170
  s_waitcnt vmcnt(33)
  v_mfma_f32_16x16x32_bf16 v[148:151], a[32:35], v[16:19], v[148:151]
  v_mfma_f32_16x16x32_bf16 v[152:155], a[36:39], v[16:19], v[152:155]
  v_max3_u32 v170, v16, v17, v170
  v_max3_u32 v170, v18, v19, v170
  s_waitcnt vmcnt(32)
  v_mfma_f32_16x16x32_bf16 v[148:151], a[40:43], v[20:23], v[148:151]
  v_mfma_f32_16x16x32_bf16 v[152:155], a[44:47], v[20:23], v[152:155]
  v_max3_u32 v170, v20, v21, v170
  v_max3_u32 v170, v22, v23, v170
  s_waitcnt vmcnt(31)
  v_mfma_f32_16x16x32_bf16 v[148:151], a[48:51], v[24:27], v[148:151]
  v_mfma_f32_16x16x32_bf16 v[152:155], a[52:55], v[24:27], v[152:155]
  v_max3_u32 v170, v24, v25, v170
  v_max3_u32 v170, v26, v27, v170
  s_waitcnt vmcnt(30)
  v_mfma_f32_16x16x32_bf16 v[148:151], a[56:59], v[28:31], v[148:151]
  v_mfma_f32_16x16x32_bf16 v[152:155], a[60:63], v[28:31], v[152:155]
  v_max3_u32 v170, v28, v29, v170
  v_max3_u32 v170, v30, v31, v170
  s_waitcnt vmcnt(29)
  v_mfma_f32_16x16x32_bf16 v[148:151], a[64:67], v[32:35], v[148:151]
  v_mfma_f32_16x16x32_bf16 v[152:155], a[68:71], v[32:35], v[152:155]
  v_max3_u32 v170, v32, v33, v170
  v_max3_u32 v170, v34, v35, v170
  s_waitcnt vmcnt(28)
  v_mfma_f32_16x16x32_bf16 v[148:151], a[72:75], v[36:39], v[148:151]
  v_mfma_f32_16x16x32_bf16 v[152:155], a[76:79], v[36:39], v[152:155]
  v_max3_u32 v170, v36, v37, v170
  v_max3_u32 v170, v38, v39, v170
  s_waitcnt vmcnt(27)
  v_mfma_f32_16x16x32_bf16 v[148:151], a[80:83], v[40:43], v[148:151]
  v_mfma_f32_16x16x32_bf16 v[152:155], a[84:87], v[40:43], v[152:155]
  v_max3_u32 v170, v40, v41, v170
  v_max3_u32 v170, v42, v43, v170
  s_waitcnt vmcnt(26)
  v_mfma_f32_16x16x32_bf16 v[148:151], a[88:91], v[44:47], v[148:151]
  v_mfma_f32_16x16x32_bf16 v[152:155], a[92:95], v[44:47], v[152:155]
  v_max3_u32 v170, v44, v45, v170
  v_max3_u32 v170, v46, v47, v170
  s_waitcnt vmcnt(25)
  v_mfma_f32_16x16x32_bf16 v[148:151], a[96:99], v[48:51], v[148:151]
  v_mfma_f32_16x16x32_bf16 v[152:155], a[100:103], v[48:51], v[152:155]
  v_max3_u32 v170, v48, v49, v170
  v_max3_u32 v170, v50, v51, v170
  s_waitcnt vmcnt(24)
  v_mfma_f32_16x16x32_bf16 v[148:151], a[104:107], v[52:55], v[148:151]
  v_mfma_f32_16x16x32_bf16 v[152:155], a[108:111], v[52:55], v[152:155]
  v_max3_u32 v170, v52, v53, v170
  v_max3_u32 v170, v54, v55, v170
  s_waitcnt vmcnt(23)
  v_mfma_f32_16x16x32_bf16 v[148:151], a[112:115], v[56:59], v[148:151]
  v_mfma_f32_16x16x32_bf16 v[152:155], a[116:119], v[56:59], v[152:155]
  v_max3_u32 v170, v56, v57, v170
  v_max3_u32 v170, v58, v59, v170
  s_waitcnt vmcnt(22)
  v_mfma_f32_16x16x32_bf16 v[148:151], a[120:123], v[60:63], v[148:151]
  v_mfma_f32_16x16x32_bf16 v[152:155], a[124:127], v[60:63], v[152:155]
  v_max3_u32 v170, v60, v61, v170
  v_max3_u32 v170, v62, v63, v170
  s_waitcnt vmcnt(21)
  v_mfma_f32_16x16x32_bf16 v[148:151], a[128:131], v[64:67], v[148:151]
  v_mfma_f32_16x16x32_bf16 v[152:155], a[132:135], v[64:67], v[152:155]
  v_max3_u32 v170, v64, v65, v170
  v_max3_u32 v170, v66, v67, v170
  s_waitcnt vmcnt(20)
  v_mfma_f32_16x16x32_bf16 v[148:151], a[136:139], v[68:71], v[148:151]
  v_mfma_f32_16x16x32_bf16 v[152:155], a[140:143], v[68:71], v[152:155]
  v_max3_u32 v170, v68, v69, v170
  v_max3_u32 v170, v70, v71, v170
  s_waitcnt vmcnt(19)
  v_mfma_f32_16x16x32_bf16 v[148:151], a[144:147], v[72:75], v[148:151]
  v_mfma_f32_16x16x32_bf16 v[152:155], a[148:151], v[72:75], v[152:155]
  v_max3_u32 v170, v72, v73, v170
  v_max3_u32 v170, v74, v75, v170
  s_waitcnt vmcnt(18)
  v_mfma_f32_16x16x32_bf16 v[148:151], a[152:155], v[76:79], v[148:151]
  v_mfma_f32_16x16x32_bf16 v[152:155], a[156:159], v[76:79], v[152:155]
  v_max3_u32 v170, v76, v77, v170
  v_max3_u32 v170, v78, v79, v170
  s_waitcnt vmcnt(17)
  v_mfma_f32_16x16x32_bf16 v[148:151], a[160:163], v[80:83], v[148:151]
  v_mfma_f32_16x16x32_bf16 v[152:155], a[164:167], v[80:83], v[152:155]
  v_max3_u32 v170, v80, v81, v170
  v_max3_u32 v170, v82, v83, v170
  s_waitcnt vmcnt(16)
  v_mfma_f32_16x16x32_bf16 v[148:151], a[168:171], v[84:87], v[148:151]
  v_mfma_f32_16x16x32_bf16 v[152:155], a[172:175], v[84:87], v[152:155]
  v_max3_u32 v170, v84, v85, v170
  v_max3_u32 v170, v86, v87, v170
  s_waitcnt vmcnt(15)
  v_mfma_f32_16x16x32_bf16 v[148:151], a[176:179], v[88:91], v[148:151]
  v_mfma_f32_16x16x32_bf16 v[152:155], a[180:183], v[88:91], v[152:155]
  v_max3_u32 v170, v88, v89, v170
  v_max3_u32 v170, v90, v91, v170
  s_waitcnt vmcnt(14)
  v_mfma_f32_16x16x32_bf16 v[148:151], a[184:187], v[92:95], v[148:151]
  v_mfma_f32_16x16x32_bf16 v[152:155], a[188:191], v[92:95], v[152:155]
  v_max3_u32 v170, v92, v93, v170
  v_max3_u32 v170, v94, v95, v170
  s_waitcnt vmcnt(13)
  v_mfma_f32_16x16x32_bf16 v[148:151], a[192:195], v[96:99], v[148:151]
  v_mfma_f32_16x16x32_bf16 v[152:155], a[196:199], v[96:99], v[152:155]
  v_max3_u32 v170, v96, v97, v170
  v_max3_u32 v170, v98, v99, v170
  s_waitcnt vmcnt(12)
  v_mfma_f32_16x16x32_bf16 v[148:151], a[200:203], v[100:103], v[148:151]
  v_mfma_f32_16x16x32_bf16 v[152:155], a[204:207], v[100:103], v[152:155]
  v_max3_u32 v170, v100, v101, v170
  v_max3_u32 v170, v102, v103, v170
  s_waitcnt vmcnt(11)
  v_mfma_f32_16x16x32_bf16 v[148:151], a[208:211], v[104:107], v[148:151]
  v_mfma_f32_16x16x32_bf16 v[152:155], a[212:215], v[104:107], v[152:155]
  v_max3_u32 v170, v104, v105, v170
  v_max3_u32 v170, v106, v107, v170
  s_waitcnt vmcnt(10)
  v_mfma_f32_16x16x32_bf16 v[148:151], a[216:219], v[108:111], v[148:151]
  v_mfma_f32_16x16x32_bf16 v[152:155], a[220:223], v[108:111], v[152:155]
  v_max3_u32 v170, v108, v109, v170
  v_max3_u32 v170, v110, v111, v170
  s_waitcnt vmcnt(9)
  v_mfma_f32_16x16x32_bf16 v[148:151], a[224:227], v[112:115], v[148:151]
  v_mfma_f32_16x16x32_bf16 v[152:155], a[228:231], v[112:115], v[152:155]
  v_max3_u32 v170, v112, v113, v170
  v_max3_u32 v170, v114, v115, v170
  s_waitcnt vmcnt(8)
  v_mfma_f32_16x16x32_bf16 v[148:151], a[232:235], v[116:119], v[148:151]
  v_mfma_f32_16x16x32_bf16 v[152:155], a[236:239], v[116:119], v[152:155]
  v_max3_u32 v170, v116, v117, v170
  v_max3_u32 v170, v118, v119, v170
  s_waitcnt vmcnt(7)
  v_mfma_f32_16x16x32_bf16 v[148:151], a[240:243], v[120:123], v[148:151]
  v_mfma_f32_16x16x32_bf16 v[152:155], a[244:247], v[120:123], v[152:155]
  v_max3_u32 v170, v120, v121, v170
  v_max3_u32 v170, v122, v123, v170
  s_waitcnt vmcnt(6)
  v_mfma_f32_16x16x32_bf16 v[148:151], a[248:251], v[124:127], v[148:151]
  v_mfma_f32_16x16x32_bf16 v[152:155], a[252:255], v[124:127], v[152:155]
  v_max3_u32 v170, v124, v125, v170
  v_max3_u32 v170, v126, v127, v170
  v_cmp_lt_u32 vcc, s54, v170
  s_cbranch_vccnz O_ld
  v_fmac_f32 v156, v165, v148
  v_fmac_f32 v157, v165, v149
  v_fmac_f32 v158, v165, v150
  v_fmac_f32 v159, v165, v151
  v_fmac_f32 v160, v165, v152
  v_fmac_f32 v161, v165, v153
  v_fmac_f32 v162, v165, v154
  v_fmac_f32 v163, v165, v155
  ds_write_b128 v168, v[156:159]
  ds_write_b128 v168, v[160:163] offset:1024
  v_xor_b32 v168, 0x2000, v168
  s_mov_b32 s59, s57
  s_waitcnt lgkmcnt(0)
  s_barrier
  s_cmp_eq_u32 s52, 0
  s_cbranch_scc0 O_next
  v_xor_b32 v211, 0x2000, v168
  ds_read_b128 v[0:3], v211 offset:2048
  ds_read_b128 v[4:7], v211 offset:3072
  ds_read_b128 v[8:11], v211 offset:4096
  ds_read_b128 v[12:15], v211 offset:5120
  ds_read_b128 v[16:19], v211 offset:6144
  ds_read_b128 v[20:23], v211 offset:7168
  s_waitcnt lgkmcnt(5)
  v_add_f32 v156, v156, v0
  v_add_f32 v157, v157, v1
  v_add_f32 v158, v158, v2
  v_add_f32 v159, v159, v3
  s_waitcnt lgkmcnt(4)
  v_add_f32 v160, v160, v4
  v_add_f32 v161, v161, v5
  v_add_f32 v162, v162, v6
  v_add_f32 v163, v163, v7
  s_waitcnt lgkmcnt(3)
  v_add_f32 v156, v156, v8
  v_add_f32 v157, v157, v9
  v_add_f32 v158, v158, v10
  v_add_f32 v159, v159, v11
  s_waitcnt lgkmcnt(2)
  v_add_f32 v160, v160, v12
  v_add_f32 v161, v161, v13
  v_add_f32 v162, v162, v14
  v_add_f32 v163, v163, v15
  s_waitcnt lgkmcnt(1)
  v_add_f32 v156, v156, v16
  v_add_f32 v157, v157, v17
  v_add_f32 v158, v158, v18
  v_add_f32 v159, v159, v19
  s_waitcnt lgkmcnt(0)
  v_add_f32 v160, v160, v20
  v_add_f32 v161, v161, v21
  v_add_f32 v162, v162, v22
  v_add_f32 v163, v163, v23
  v_cvt_pk_bf16_f32 v148, v156, v157
  v_cvt_pk_bf16_f32 v149, v158, v159
  v_cvt_pk_bf16_f32 v150, v160, v161
  v_cvt_pk_bf16_f32 v151, v162, v163
  buffer_store_dwordx4 v[148:151], v167, s[48:51], s64 offen
  s_waitcnt vmcnt(1)
  s_branch O_nx2
O_next:
  s_waitcnt vmcnt(0)
O_nx2:
  s_cmp_lt_u32 s59, 64
  s_cbranch_scc1 O_loop
  s_branch L_exit
W_h:
  s_lshr_b32 s58, s53, 1
  s_and_b32 s59, s53, 1
  s_mul_i32 s60, s59, 36864
  s_add_u32 m0, s67, 0
  s_nop 0
  buffer_load_dwordx4 v202, s[4:7], s60 offen offset:0 lds
  s_add_u32 m0, s67, 896
  s_nop 0
  buffer_load_dwordx4 v202, s[4:7], s60 offen offset:128 lds
  s_add_u32 m0, s67, 1792
  s_nop 0
  buffer_load_dwordx4 v202, s[4:7], s60 offen offset:256 lds
  s_add_u32 m0, s67, 2688
  s_nop 0
  buffer_load_dwordx4 v202, s[4:7], s60 offen offset:384 lds
  s_add_u32 m0, s67, 3584
  s_nop 0
  buffer_load_dwordx4 v202, s[4:7], s60 offen offset:512 lds
  s_add_u32 m0, s67, 4480
  s_nop 0
  buffer_load_dwordx4 v202, s[4:7], s60 offen offset:640 lds
  s_add_u32 m0, s67, 5376
  s_nop 0
  buffer_load_dwordx4 v202, s[4:7], s60 offen offset:768 lds
  s_add_u32 m0, s67, 6272
  s_nop 0
  buffer_load_dwordx4 v202, s[4:7], s60 offen offset:896 lds
  s_add_u32 m0, s67, 7168
  s_nop 0
  buffer_load_dwordx4 v202, s[4:7], s60 offen offset:1024 lds
  v_lshrrev_b32 v211, 4, v200
  v_lshlrev_b32 v212, 2, v211
  v_and_b32 v213, 15, v200
  v_xor_b32 v212, v212, v213
  v_lshlrev_b32 v212, 4, v212
  v_lshl_add_u32 v207, v211, 13, v212
  s_lshl_b32 s62, s58, 8
  s_lshl_b32 s54, s52, 15
  s_add_u32 s62, s62, s54
  s_lshl_b32 s61, s52, 10
  s_add_u32 s61, s61, 36864
  s_add_u32 m0, s61, 0
  s_add_u32 s54, s62, 0
  buffer_load_dwordx4 v207, s[16:19], s54 offen lds
  s_add_u32 m0, s61, 4096
  s_add_u32 s54, s62, 131072
  buffer_load_dwordx4 v207, s[16:19], s54 offen lds
  s_add_u32 m0, s61, 8192
  s_add_u32 s54, s62, 262144
  buffer_load_dwordx4 v207, s[16:19], s54 offen lds
  s_add_u32 m0, s61, 12288
  s_add_u32 s54, s62, 393216
  buffer_load_dwordx4 v207, s[16:19], s54 offen lds
  s_add_u32 m0, s61, 16384
  s_add_u32 s54, s62, 524288
  buffer_load_dwordx4 v207, s[16:19], s54 offen lds
  s_add_u32 m0, s61, 20480
  s_add_u32 s54, s62, 655360
  buffer_load_dwordx4 v207, s[16:19], s54 offen lds
  s_add_u32 m0, s61, 24576
  s_add_u32 s54, s62, 786432
  buffer_load_dwordx4 v207, s[16:19], s54 offen lds
  s_add_u32 m0, s61, 28672
  s_add_u32 s54, s62, 917504
  buffer_load_dwordx4 v207, s[16:19], s54 offen lds
  s_add_u32 m0, s61, 32768
  s_add_u32 s54, s62, 1048576
  buffer_load_dwordx4 v207, s[16:19], s54 offen lds
  s_add_u32 m0, s61, 36864
  s_add_u32 s54, s62, 1179648
  buffer_load_dwordx4 v207, s[16:19], s54 offen lds
  s_add_u32 m0, s61, 40960
  s_add_u32 s54, s62, 1310720
  buffer_load_dwordx4 v207, s[16:19], s54 offen lds
  s_add_u32 m0, s61, 45056
  s_add_u32 s54, s62, 1441792
  buffer_load_dwordx4 v207, s[16:19], s54 offen lds
  s_add_u32 m0, s61, 49152
  s_add_u32 s54, s62, 1572864
  buffer_load_dwordx4 v207, s[16:19], s54 offen lds
  s_add_u32 m0, s61, 53248
  s_add_u32 s54, s62, 1703936
  buffer_load_dwordx4 v207, s[16:19], s54 offen lds
  s_add_u32 m0, s61, 57344
  s_add_u32 s54, s62, 1835008
  buffer_load_dwordx4 v207, s[16:19], s54 offen lds
  s_add_u32 m0, s61, 61440
  s_add_u32 s54, s62, 1966080
  buffer_load_dwordx4 v207, s[16:19], s54 offen lds
  s_add_u32 m0, s61, 65536
  s_add_u32 s54, s62, 2097152
  buffer_load_dwordx4 v207, s[16:19], s54 offen lds
  s_add_u32 m0, s61, 69632
  s_add_u32 s54, s62, 2228224
  buffer_load_dwordx4 v207, s[16:19], s54 offen lds
  s_add_u32 m0, s61, 73728
  s_add_u32 s54, s62, 2359296
  buffer_load_dwordx4 v207, s[16:19], s54 offen lds
  s_add_u32 m0, s61, 77824
  s_add_u32 s54, s62, 2490368
  buffer_load_dwordx4 v207, s[16:19], s54 offen lds
  s_add_u32 m0, s61, 81920
  s_add_u32 s54, s62, 2621440
  buffer_load_dwordx4 v207, s[16:19], s54 offen lds
  s_add_u32 m0, s61, 86016
  s_add_u32 s54, s62, 2752512
  buffer_load_dwordx4 v207, s[16:19], s54 offen lds
  s_add_u32 m0, s61, 90112
  s_add_u32 s54, s62, 2883584
  buffer_load_dwordx4 v207, s[16:19], s54 offen lds
  s_add_u32 m0, s61, 94208
  s_add_u32 s54, s62, 3014656
  buffer_load_dwordx4 v207, s[16:19], s54 offen lds
  s_waitcnt vmcnt(20) lgkmcnt(0)
  s_barrier
  s_add_u32 m0, s61, 98304
  s_add_u32 s54, s62, 3145728
  buffer_load_dwordx4 v207, s[16:19], s54 offen lds
  s_add_u32 m0, s61, 102400
  s_add_u32 s54, s62, 3276800
  buffer_load_dwordx4 v207, s[16:19], s54 offen lds
  s_add_u32 m0, s61, 106496
  s_add_u32 s54, s62, 3407872
  buffer_load_dwordx4 v207, s[16:19], s54 offen lds
  s_add_u32 m0, s61, 110592
  s_add_u32 s54, s62, 3538944
  buffer_load_dwordx4 v207, s[16:19], s54 offen lds
  v_add_u32 v215, 36864, v209
  ds_read_b64_tr_b16 a[0:1], v215 offset:0
  ds_read_b64_tr_b16 a[2:3], v215 offset:1024
  ds_read_b64_tr_b16 a[4:5], v215 offset:4096
  ds_read_b64_tr_b16 a[6:7], v215 offset:5120
  ds_read_b64_tr_b16 a[8:9], v215 offset:8192
  ds_read_b64_tr_b16 a[10:11], v215 offset:9216
  ds_read_b64_tr_b16 a[12:13], v215 offset:12288
  ds_read_b64_tr_b16 a[14:15], v215 offset:13312
  s_waitcnt vmcnt(20) lgkmcnt(0)
  s_barrier
  s_add_u32 m0, s61, 0
  s_add_u32 s54, s62, 3670016
  buffer_load_dwordx4 v207, s[16:19], s54 offen lds
  s_add_u32 m0, s61, 4096
  s_add_u32 s54, s62, 3801088
  buffer_load_dwordx4 v207, s[16:19], s54 offen lds
  s_add_u32 m0, s61, 8192
  s_add_u32 s54, s62, 3932160
  buffer_load_dwordx4 v207, s[16:19], s54 offen lds
  s_add_u32 m0, s61, 12288
  s_add_u32 s54, s62, 4063232
  buffer_load_dwordx4 v207, s[16:19], s54 offen lds
  v_add_u32 v215, 53248, v209
  ds_read_b64_tr_b16 a[16:17], v215 offset:0
  ds_read_b64_tr_b16 a[18:19], v215 offset:1024
  ds_read_b64_tr_b16 a[20:21], v215 offset:4096
  ds_read_b64_tr_b16 a[22:23], v215 offset:5120
  ds_read_b64_tr_b16 a[24:25], v215 offset:8192
  ds_read_b64_tr_b16 a[26:27], v215 offset:9216
  ds_read_b64_tr_b16 a[28:29], v215 offset:12288
  ds_read_b64_tr_b16 a[30:31], v215 offset:13312
  s_waitcnt vmcnt(20) lgkmcnt(0)
  s_barrier
  s_add_u32 m0, s61, 16384
  s_add_u32 s54, s62, 4194304
  buffer_load_dwordx4 v207, s[16:19], s54 offen lds
  s_add_u32 m0, s61, 20480
  s_add_u32 s54, s62, 4325376
  buffer_load_dwordx4 v207, s[16:19], s54 offen lds
  s_add_u32 m0, s61, 24576
  s_add_u32 s54, s62, 4456448
  buffer_load_dwordx4 v207, s[16:19], s54 offen lds
  s_add_u32 m0, s61, 28672
  s_add_u32 s54, s62, 4587520
  buffer_load_dwordx4 v207, s[16:19], s54 offen lds
  v_add_u32 v215, 69632, v209
  ds_read_b64_tr_b16 a[32:33], v215 offset:0
  ds_read_b64_tr_b16 a[34:35], v215 offset:1024
  ds_read_b64_tr_b16 a[36:37], v215 offset:4096
  ds_read_b64_tr_b16 a[38:39], v215 offset:5120
  ds_read_b64_tr_b16 a[40:41], v215 offset:8192
  ds_read_b64_tr_b16 a[42:43], v215 offset:9216
  ds_read_b64_tr_b16 a[44:45], v215 offset:12288
  ds_read_b64_tr_b16 a[46:47], v215 offset:13312
  s_waitcnt vmcnt(20) lgkmcnt(0)
  s_barrier
  v_add_u32 v215, 86016, v209
  ds_read_b64_tr_b16 a[48:49], v215 offset:0
  ds_read_b64_tr_b16 a[50:51], v215 offset:1024
  ds_read_b64_tr_b16 a[52:53], v215 offset:4096
  ds_read_b64_tr_b16 a[54:55], v215 offset:5120
  ds_read_b64_tr_b16 a[56:57], v215 offset:8192
  ds_read_b64_tr_b16 a[58:59], v215 offset:9216
  ds_read_b64_tr_b16 a[60:61], v215 offset:12288
  ds_read_b64_tr_b16 a[62:63], v215 offset:13312
  s_waitcnt vmcnt(16) lgkmcnt(0)
  s_barrier
  v_add_u32 v215, 102400, v209
  ds_read_b64_tr_b16 a[64:65], v215 offset:0
  ds_read_b64_tr_b16 a[66:67], v215 offset:1024
  ds_read_b64_tr_b16 a[68:69], v215 offset:4096
  ds_read_b64_tr_b16 a[70:71], v215 offset:5120
  ds_read_b64_tr_b16 a[72:73], v215 offset:8192
  ds_read_b64_tr_b16 a[74:75], v215 offset:9216
  ds_read_b64_tr_b16 a[76:77], v215 offset:12288
  ds_read_b64_tr_b16 a[78:79], v215 offset:13312
  s_waitcnt vmcnt(12) lgkmcnt(0)
  s_barrier
  v_add_u32 v215, 118784, v209
  ds_read_b64_tr_b16 a[80:81], v215 offset:0
  ds_read_b64_tr_b16 a[82:83], v215 offset:1024
  ds_read_b64_tr_b16 a[84:85], v215 offset:4096
  ds_read_b64_tr_b16 a[86:87], v215 offset:5120
  ds_read_b64_tr_b16 a[88:89], v215 offset:8192
  ds_read_b64_tr_b16 a[90:91], v215 offset:9216
  ds_read_b64_tr_b16 a[92:93], v215 offset:12288
  ds_read_b64_tr_b16 a[94:95], v215 offset:13312
  s_waitcnt vmcnt(8) lgkmcnt(0)
  s_barrier
  v_add_u32 v215, 135168, v209
  ds_read_b64_tr_b16 a[96:97], v215 offset:0
  ds_read_b64_tr_b16 a[98:99], v215 offset:1024
  ds_read_b64_tr_b16 a[100:101], v215 offset:4096
  ds_read_b64_tr_b16 a[102:103], v215 offset:5120
  ds_read_b64_tr_b16 a[104:105], v215 offset:8192
  ds_read_b64_tr_b16 a[106:107], v215 offset:9216
  ds_read_b64_tr_b16 a[108:109], v215 offset:12288
  ds_read_b64_tr_b16 a[110:111], v215 offset:13312
  s_waitcnt vmcnt(4) lgkmcnt(0)
  s_barrier
  v_add_u32 v215, 36864, v209
  ds_read_b64_tr_b16 a[112:113], v215 offset:0
  ds_read_b64_tr_b16 a[114:115], v215 offset:1024
  ds_read_b64_tr_b16 a[116:117], v215 offset:4096
  ds_read_b64_tr_b16 a[118:119], v215 offset:5120
  ds_read_b64_tr_b16 a[120:121], v215 offset:8192
  ds_read_b64_tr_b16 a[122:123], v215 offset:9216
  ds_read_b64_tr_b16 a[124:125], v215 offset:12288
  ds_read_b64_tr_b16 a[126:127], v215 offset:13312
  s_waitcnt vmcnt(0) lgkmcnt(0)
  s_barrier
  v_add_u32 v215, 53248, v209
  ds_read_b64_tr_b16 a[128:129], v215 offset:0
  ds_read_b64_tr_b16 a[130:131], v215 offset:1024
  ds_read_b64_tr_b16 a[132:133], v215 offset:4096
  ds_read_b64_tr_b16 a[134:135], v215 offset:5120
  ds_read_b64_tr_b16 a[136:137], v215 offset:8192
  ds_read_b64_tr_b16 a[138:139], v215 offset:9216
  ds_read_b64_tr_b16 a[140:141], v215 offset:12288
  ds_read_b64_tr_b16 a[142:143], v215 offset:13312
  s_waitcnt lgkmcnt(0)
  s_barrier
  v_and_b32 v211, 31, v200
  v_lshrrev_b32 v212, 5, v200
  v_lshlrev_b32 v213, 2, v212
  v_sub_u32 v211, v211, v213
  v_mov_b32 v214, 0xf149f2ca
  v_cmp_gt_i32 vcc, 0, v211
  s_nop 1
  v_cndmask_b32 v48, 0, v214, vcc
  v_cmp_gt_i32 vcc, 1, v211
  s_nop 1
  v_cndmask_b32 v49, 0, v214, vcc
  v_cmp_gt_i32 vcc, 2, v211
  s_nop 1
  v_cndmask_b32 v50, 0, v214, vcc
  v_cmp_gt_i32 vcc, 3, v211
  s_nop 1
  v_cndmask_b32 v51, 0, v214, vcc
  v_cmp_gt_i32 vcc, 8, v211
  s_nop 1
  v_cndmask_b32 v52, 0, v214, vcc
  v_cmp_gt_i32 vcc, 9, v211
  s_nop 1
  v_cndmask_b32 v53, 0, v214, vcc
  v_cmp_gt_i32 vcc, 10, v211
  s_nop 1
  v_cndmask_b32 v54, 0, v214, vcc
  v_cmp_gt_i32 vcc, 11, v211
  s_nop 1
  v_cndmask_b32 v55, 0, v214, vcc
  v_cmp_gt_i32 vcc, 16, v211
  s_nop 1
  v_cndmask_b32 v56, 0, v214, vcc
  v_cmp_gt_i32 vcc, 17, v211
  s_nop 1
  v_cndmask_b32 v57, 0, v214, vcc
  v_cmp_gt_i32 vcc, 18, v211
  s_nop 1
  v_cndmask_b32 v58, 0, v214, vcc
  v_cmp_gt_i32 vcc, 19, v211
  s_nop 1
  v_cndmask_b32 v59, 0, v214, vcc
  v_cmp_gt_i32 vcc, 24, v211
  s_nop 1
  v_cndmask_b32 v60, 0, v214, vcc
  v_cmp_gt_i32 vcc, 25, v211
  s_nop 1
  v_cndmask_b32 v61, 0, v214, vcc
  v_cmp_gt_i32 vcc, 26, v211
  s_nop 1
  v_cndmask_b32 v62, 0, v214, vcc
  v_cmp_gt_i32 vcc, 27, v211
  s_nop 1
  v_cndmask_b32 v63, 0, v214, vcc
  v_and_b32 v218, 0xff, v216
  v_add_u32 v218, 81920, v218
  v_and_b32 v211, 15, v200
  v_lshl_add_u32 v211, v212, 5, v211
  v_lshlrev_b32 v219, 3, v211
  v_bfe_u32 v211, v200, 4, 1
  v_lshl_add_u32 v219, v211, 2, v219
  s_lshl_b32 s54, s52, 9
  s_add_u32 s54, s54, 83968
  v_add_u32 v219, s54, v219
  v_lshl_add_u32 v221, v200, 3, s54
  s_lshr_b32 s54, s52, 1
  s_lshl_b32 s54, s54, 10
  s_and_b32 s55, s52, 1
  s_lshl_b32 s55, s55, 3
  s_add_u32 s54, s54, s55
  s_add_u32 s54, s54, 81920
  v_add_u32 v220, s54, v201
  s_lshl_b32 s54, s52, 11
  s_add_u32 s54, s54, 73728
  v_add_u32 v215, s54, v201
  v_add_u32 v208, 73728, v201
  s_mov_b32 s68, 1040356334
  s_cmp_eq_u32 s52, 0
  s_cselect_b32 s71, s71, 268435456
  s_lshl_b32 s56, s58, 2
  s_add_u32 s56, s56, 128
  v_mov_b32 v176, -1
  v_mov_b32 v177, -1
  v_mov_b32 v178, -1
  v_mov_b32 v179, -1
  s_cmp_eq_u32 s52, 0
  s_cbranch_scc0 AT_p1_d
  s_mov_b32 exec_hi, 0
  s_mov_b32 exec_lo, 1
AT_p1:
  buffer_load_dword v211, v201, s[12:15], s56 offen sc1
  s_add_u32 s65, s65, 1
  s_waitcnt vmcnt(0)
  v_cmp_gt_u32 vcc, 0x700, v211
  s_cbranch_vccz AT_p1_x
  s_sleep 8
  s_cmp_lt_u32 s65, 131072
  s_cbranch_scc1 AT_p1
AT_p1_x:
  s_mov_b64 exec, -1
AT_p1_d:
  s_barrier
  s_mov_b32 s74, s59
  s_mul_i32 s66, s59, 655360
  s_lshl_b32 s55, s58, 14
  s_add_u32 s55, s55, s66
  s_add_u32 s55, s55, 1048576
  s_lshl_b32 s73, s58, 2
  s_add_u32 s73, s73, s52
  s_lshl_b32 s72, s59, 7
  s_add_u32 s72, s72, s73
  s_lshl_b32 s72, s72, 11
  s_add_u32 s72, s72, 46137344
  s_lshl_b32 s73, s73, 10
  s_add_u32 s73, s73, s66
  s_add_u32 s73, s73, 1572864
  s_add_u32 s59, s59, 2
  buffer_load_dwordx4 v[128:131], v216, s[8:11], s55 offen offset:0 sc1
  buffer_load_dwordx4 v[132:135], v216, s[8:11], s55 offen offset:256 sc1
  buffer_load_dwordx4 v[136:139], v216, s[8:11], s55 offen offset:512 sc1
  buffer_load_dwordx4 v[140:143], v216, s[8:11], s55 offen offset:768 sc1
  buffer_load_dwordx4 v[144:147], v216, s[8:11], s55 offen offset:1024 sc1
  buffer_load_dwordx4 v[148:151], v216, s[8:11], s55 offen offset:1280 sc1
  buffer_load_dwordx4 v[152:155], v216, s[8:11], s55 offen offset:1536 sc1
  buffer_load_dwordx4 v[156:159], v216, s[8:11], s55 offen offset:1792 sc1
  buffer_load_dwordx4 v[160:163], v217, s[8:11], s55 offen offset:0 sc1
  buffer_load_dwordx4 v[164:167], v217, s[8:11], s55 offen offset:256 sc1
  s_add_u32 s60, s60, 73728
  ds_read_b128 v[32:35], v203 offset:0
  ds_read_b128 v[36:39], v204 offset:0
  ds_read_b128 v[40:43], v205 offset:0
  s_waitcnt lgkmcnt(2)
  v_mfma_f32_32x32x16_bf16 v[240:255], a[0:3], v[32:35], 0
  ds_read_b128 v[44:47], v206 offset:0
  s_add_u32 m0, s67, 36864
  s_nop 0
  buffer_load_dwordx4 v202, s[4:7], s60 offen offset:0 lds
  s_waitcnt lgkmcnt(2)
  v_mfma_f32_32x32x16_bf16 v[240:255], a[4:7], v[36:39], v[240:255]
  ds_read_b128 v[32:35], v203 offset:1024
  s_waitcnt lgkmcnt(2)
  v_mfma_f32_32x32x16_bf16 v[240:255], a[8:11], v[40:43], v[240:255]
  ds_read_b128 v[36:39], v204 offset:1024
  s_add_u32 m0, s67, 37760
  s_nop 0
  buffer_load_dwordx4 v202, s[4:7], s60 offen offset:128 lds
  s_waitcnt lgkmcnt(2)
  v_mfma_f32_32x32x16_bf16 v[240:255], a[12:15], v[44:47], v[240:255]
  ds_read_b128 v[40:43], v205 offset:1024
  s_waitcnt lgkmcnt(2)
  v_mfma_f32_32x32x16_bf16 v[240:255], a[16:19], v[32:35], v[240:255]
  ds_read_b128 v[44:47], v206 offset:1024
  s_add_u32 m0, s67, 38656
  s_nop 0
  buffer_load_dwordx4 v202, s[4:7], s60 offen offset:256 lds
  s_waitcnt lgkmcnt(2)
  v_mfma_f32_32x32x16_bf16 v[240:255], a[20:23], v[36:39], v[240:255]
  ds_read_b128 v[32:35], v203 offset:2048
  s_waitcnt lgkmcnt(2)
  v_mfma_f32_32x32x16_bf16 v[240:255], a[24:27], v[40:43], v[240:255]
  ds_read_b128 v[36:39], v204 offset:2048
  s_add_u32 m0, s67, 39552
  s_nop 0
  buffer_load_dwordx4 v202, s[4:7], s60 offen offset:384 lds
  s_waitcnt lgkmcnt(2)
  v_mfma_f32_32x32x16_bf16 v[240:255], a[28:31], v[44:47], v[240:255]
  ds_read_b128 v[40:43], v205 offset:2048
  s_waitcnt lgkmcnt(2)
  v_mfma_f32_32x32x16_bf16 v[240:255], a[32:35], v[32:35], v[240:255]
  ds_read_b128 v[44:47], v206 offset:2048
  s_add_u32 m0, s67, 40448
  s_nop 0
  buffer_load_dwordx4 v202, s[4:7], s60 offen offset:512 lds
  s_waitcnt lgkmcnt(2)
  v_mfma_f32_32x32x16_bf16 v[240:255], a[36:39], v[36:39], v[240:255]
  ds_read_b128 v[32:35], v203 offset:3072
  s_waitcnt lgkmcnt(2)
  v_mfma_f32_32x32x16_bf16 v[240:255], a[40:43], v[40:43], v[240:255]
  ds_read_b128 v[36:39], v204 offset:3072
  s_add_u32 m0, s67, 41344
  s_nop 0
  buffer_load_dwordx4 v202, s[4:7], s60 offen offset:640 lds
  s_waitcnt lgkmcnt(2)
  v_mfma_f32_32x32x16_bf16 v[240:255], a[44:47], v[44:47], v[240:255]
  ds_read_b128 v[40:43], v205 offset:3072
  s_waitcnt lgkmcnt(2)
  v_mfma_f32_32x32x16_bf16 v[240:255], a[48:51], v[32:35], v[240:255]
  ds_read_b128 v[44:47], v206 offset:3072
  s_add_u32 m0, s67, 42240
  s_nop 0
  buffer_load_dwordx4 v202, s[4:7], s60 offen offset:768 lds
  s_waitcnt lgkmcnt(2)
  v_mfma_f32_32x32x16_bf16 v[240:255], a[52:55], v[36:39], v[240:255]
  ds_read_b128 v[32:35], v203 offset:4096
  s_waitcnt lgkmcnt(2)
  v_mfma_f32_32x32x16_bf16 v[240:255], a[56:59], v[40:43], v[240:255]
  ds_read_b128 v[36:39], v204 offset:4096
  s_add_u32 m0, s67, 43136
  s_nop 0
  buffer_load_dwordx4 v202, s[4:7], s60 offen offset:896 lds
  s_waitcnt lgkmcnt(2)
  v_mfma_f32_32x32x16_bf16 v[240:255], a[60:63], v[44:47], v[240:255]
  ds_read_b128 v[40:43], v205 offset:4096
  s_waitcnt lgkmcnt(2)
  v_mfma_f32_32x32x16_bf16 v[240:255], a[64:67], v[32:35], v[240:255]
  ds_read_b128 v[44:47], v206 offset:4096
  s_add_u32 m0, s67, 44032
  s_nop 0
  buffer_load_dwordx4 v202, s[4:7], s60 offen offset:1024 lds
  s_waitcnt lgkmcnt(2)
  v_mfma_f32_32x32x16_bf16 v[240:255], a[68:71], v[36:39], v[240:255]
  ds_read_b128 v[32:35], v203 offset:5120
  s_waitcnt lgkmcnt(2)
  v_mfma_f32_32x32x16_bf16 v[240:255], a[72:75], v[40:43], v[240:255]
  ds_read_b128 v[36:39], v204 offset:5120
  buffer_store_dwordx4 v[176:179], v201, s[8:11], s72 offen offset:0 sc1
  s_waitcnt lgkmcnt(2)
  v_mfma_f32_32x32x16_bf16 v[240:255], a[76:79], v[44:47], v[240:255]
  ds_read_b128 v[40:43], v205 offset:5120
  s_waitcnt lgkmcnt(2)
  v_mfma_f32_32x32x16_bf16 v[240:255], a[80:83], v[32:35], v[240:255]
  ds_read_b128 v[44:47], v206 offset:5120
  buffer_store_dwordx4 v[176:179], v201, s[8:11], s72 offen offset:1024 sc1
  s_waitcnt lgkmcnt(2)
  v_mfma_f32_32x32x16_bf16 v[240:255], a[84:87], v[36:39], v[240:255]
  ds_read_b128 v[32:35], v203 offset:6144
  s_waitcnt lgkmcnt(2)
  v_mfma_f32_32x32x16_bf16 v[240:255], a[88:91], v[40:43], v[240:255]
  ds_read_b128 v[36:39], v204 offset:6144
  s_waitcnt lgkmcnt(2)
  v_mfma_f32_32x32x16_bf16 v[240:255], a[92:95], v[44:47], v[240:255]
  ds_read_b128 v[40:43], v205 offset:6144
  s_waitcnt lgkmcnt(2)
  v_mfma_f32_32x32x16_bf16 v[240:255], a[96:99], v[32:35], v[240:255]
  ds_read_b128 v[44:47], v206 offset:6144
  s_waitcnt lgkmcnt(2)
  v_mfma_f32_32x32x16_bf16 v[240:255], a[100:103], v[36:39], v[240:255]
  ds_read_b128 v[32:35], v203 offset:7168
  s_waitcnt lgkmcnt(2)
  v_mfma_f32_32x32x16_bf16 v[240:255], a[104:107], v[40:43], v[240:255]
  ds_read_b128 v[36:39], v204 offset:7168
  s_waitcnt lgkmcnt(2)
  v_mfma_f32_32x32x16_bf16 v[240:255], a[108:111], v[44:47], v[240:255]
  ds_read_b128 v[40:43], v205 offset:7168
  s_waitcnt lgkmcnt(2)
  v_mfma_f32_32x32x16_bf16 v[240:255], a[112:115], v[32:35], v[240:255]
  ds_read_b128 v[44:47], v206 offset:7168
  s_waitcnt lgkmcnt(2)
  v_mfma_f32_32x32x16_bf16 v[240:255], a[116:119], v[36:39], v[240:255]
  ds_read_b128 v[32:35], v203 offset:8192
  s_waitcnt lgkmcnt(2)
  v_mfma_f32_32x32x16_bf16 v[240:255], a[120:123], v[40:43], v[240:255]
  ds_read_b128 v[36:39], v204 offset:8192
  s_waitcnt lgkmcnt(2)
  v_mfma_f32_32x32x16_bf16 v[240:255], a[124:127], v[44:47], v[240:255]
  ds_read_b128 v[40:43], v205 offset:8192
  s_waitcnt lgkmcnt(2)
  v_mfma_f32_32x32x16_bf16 v[240:255], a[128:131], v[32:35], v[240:255]
  ds_read_b128 v[44:47], v206 offset:8192
  s_waitcnt lgkmcnt(2)
  v_mfma_f32_32x32x16_bf16 v[240:255], a[132:135], v[36:39], v[240:255]
  s_waitcnt lgkmcnt(1)
  v_mfma_f32_32x32x16_bf16 v[240:255], a[136:139], v[40:43], v[240:255]
  s_waitcnt lgkmcnt(0)
  v_mfma_f32_32x32x16_bf16 v[240:255], a[140:143], v[44:47], v[240:255]
  s_nop 11
  v_cvt_pk_bf16_f32 v16, v240, v244
  v_cvt_pk_bf16_f32 v17, v241, v245
  v_cvt_pk_bf16_f32 v18, v242, v246
  v_cvt_pk_bf16_f32 v19, v243, v247
  ds_write_b128 v215, v[16:19] offset:0
  v_cvt_pk_bf16_f32 v20, v248, v252
  v_cvt_pk_bf16_f32 v21, v249, v253
  v_cvt_pk_bf16_f32 v22, v250, v254
  v_cvt_pk_bf16_f32 v23, v251, v255
  ds_write_b128 v215, v[20:23] offset:1024
  s_waitcnt lgkmcnt(0)
  s_barrier
  ds_read_b128 v[96:99], v208 offset:0
  ds_read_b128 v[100:103], v208 offset:1024
  ds_read_b128 v[104:107], v208 offset:2048
  ds_read_b128 v[108:111], v208 offset:3072
  ds_read_b128 v[112:115], v208 offset:4096
  ds_read_b128 v[116:119], v208 offset:5120
  ds_read_b128 v[120:123], v208 offset:6144
  ds_read_b128 v[124:127], v208 offset:7168
  s_waitcnt vmcnt(20) lgkmcnt(7)
  v_mfma_f32_32x32x16_bf16 v[64:79], v[128:131], v[96:99], v[48:63]
  s_waitcnt vmcnt(19) lgkmcnt(6)
  v_mfma_f32_32x32x16_bf16 v[64:79], v[132:135], v[100:103], v[64:79]
  s_waitcnt vmcnt(18) lgkmcnt(5)
  v_mfma_f32_32x32x16_bf16 v[64:79], v[136:139], v[104:107], v[64:79]
  s_waitcnt vmcnt(17) lgkmcnt(4)
  v_mfma_f32_32x32x16_bf16 v[64:79], v[140:143], v[108:111], v[64:79]
  s_waitcnt vmcnt(16) lgkmcnt(3)
  v_mfma_f32_32x32x16_bf16 v[64:79], v[144:147], v[112:115], v[64:79]
  s_waitcnt vmcnt(15) lgkmcnt(2)
  v_mfma_f32_32x32x16_bf16 v[64:79], v[148:151], v[116:119], v[64:79]
  s_waitcnt vmcnt(14) lgkmcnt(1)
  v_mfma_f32_32x32x16_bf16 v[64:79], v[152:155], v[120:123], v[64:79]
  s_waitcnt vmcnt(13) lgkmcnt(0)
  v_mfma_f32_32x32x16_bf16 v[64:79], v[156:159], v[124:127], v[64:79]
  s_nop 11
  v_max3_f32 v180, v64, v65, v66
  v_max3_f32 v180, v180, v67, v68
  v_max3_f32 v180, v180, v69, v70
  v_max3_f32 v180, v180, v71, v72
  v_max3_f32 v180, v180, v73, v74
  v_max3_f32 v180, v180, v75, v76
  v_max3_f32 v180, v180, v77, v78
  v_max_f32 v180, v180, v79
  v_mov_b32 v181, v180
  s_nop 1
  v_permlane32_swap_b32 v180, v181
  v_max_f32 v180, v180, v181
  v_sub_f32 v64, v64, v180
  v_sub_f32 v65, v65, v180
  v_sub_f32 v66, v66, v180
  v_sub_f32 v67, v67, v180
  v_sub_f32 v68, v68, v180
  v_sub_f32 v69, v69, v180
  v_sub_f32 v70, v70, v180
  v_sub_f32 v71, v71, v180
  v_sub_f32 v72, v72, v180
  v_sub_f32 v73, v73, v180
  v_sub_f32 v74, v74, v180
  v_sub_f32 v75, v75, v180
  v_sub_f32 v76, v76, v180
  v_sub_f32 v77, v77, v180
  v_sub_f32 v78, v78, v180
  v_sub_f32 v79, v79, v180
  v_exp_f32 v64, v64
  v_exp_f32 v65, v65
  v_exp_f32 v66, v66
  v_exp_f32 v67, v67
  v_exp_f32 v68, v68
  v_exp_f32 v69, v69
  v_exp_f32 v70, v70
  v_exp_f32 v71, v71
  v_exp_f32 v72, v72
  v_exp_f32 v73, v73
  v_exp_f32 v74, v74
  v_exp_f32 v75, v75
  v_exp_f32 v76, v76
  v_exp_f32 v77, v77
  v_exp_f32 v78, v78
  v_exp_f32 v79, v79
  v_cvt_pk_bf16_f32 v20, v64, v65
  v_cvt_pk_bf16_f32 v21, v68, v69
  v_cvt_pk_bf16_f32 v22, v72, v73
  v_cvt_pk_bf16_f32 v23, v76, v77
  v_cvt_pk_bf16_f32 v24, v66, v67
  v_cvt_pk_bf16_f32 v25, v70, v71
  v_cvt_pk_bf16_f32 v26, v74, v75
  v_cvt_pk_bf16_f32 v27, v78, v79
  s_waitcnt vmcnt(12)
  v_mfma_f32_32x32x16_bf16 v[0:15], v[160:163], v[20:23], 0
  v_add_f32 v182, v64, v65
  v_add_f32 v182, v182, v66
  v_add_f32 v182, v182, v67
  v_add_f32 v182, v182, v68
  v_add_f32 v182, v182, v69
  v_add_f32 v182, v182, v70
  v_add_f32 v182, v182, v71
  s_waitcnt vmcnt(11)
  v_mfma_f32_32x32x16_bf16 v[0:15], v[164:167], v[24:27], v[0:15]
  v_add_f32 v182, v182, v72
  v_add_f32 v182, v182, v73
  v_add_f32 v182, v182, v74
  v_add_f32 v182, v182, v75
  v_add_f32 v182, v182, v76
  v_add_f32 v182, v182, v77
  v_add_f32 v182, v182, v78
  v_add_f32 v182, v182, v79
  s_waitcnt vmcnt(0)
  s_barrier
AT_loop:
  s_cmp_ge_u32 s59, 64
  s_cbranch_scc1 AT_l0
  s_mov_b32 s77, s59
  s_mul_i32 s66, s59, 655360
  s_lshl_b32 s55, s58, 14
  s_add_u32 s55, s55, s66
  s_add_u32 s55, s55, 1048576
  s_lshl_b32 s76, s58, 2
  s_add_u32 s76, s76, s52
  s_lshl_b32 s75, s59, 7
  s_add_u32 s75, s75, s76
  s_lshl_b32 s75, s75, 11
  s_add_u32 s75, s75, 46137344
  s_lshl_b32 s76, s76, 10
  s_add_u32 s76, s76, s66
  s_add_u32 s76, s76, 1572864
  s_add_u32 s59, s59, 2
  buffer_load_dwordx4 v[128:131], v216, s[8:11], s55 offen offset:0 sc1
  buffer_load_dwordx4 v[132:135], v216, s[8:11], s55 offen offset:256 sc1
  buffer_load_dwordx4 v[136:139], v216, s[8:11], s55 offen offset:512 sc1
  buffer_load_dwordx4 v[140:143], v216, s[8:11], s55 offen offset:768 sc1
  buffer_load_dwordx4 v[144:147], v216, s[8:11], s55 offen offset:1024 sc1
  buffer_load_dwordx4 v[148:151], v216, s[8:11], s55 offen offset:1280 sc1
  buffer_load_dwordx4 v[152:155], v216, s[8:11], s55 offen offset:1536 sc1
  buffer_load_dwordx4 v[156:159], v216, s[8:11], s55 offen offset:1792 sc1
  buffer_load_dwordx4 v[160:163], v217, s[8:11], s55 offen offset:0 sc1
  buffer_load_dwordx4 v[164:167], v217, s[8:11], s55 offen offset:256 sc1
  s_or_b32 s70, s73, 0xc00
  buffer_load_dword v172, off, s[8:11], s70 sc1
  s_add_u32 s60, s60, 73728
  ds_read_b128 v[32:35], v203 offset:36864
  ds_read_b128 v[36:39], v204 offset:36864
  ds_read_b128 v[40:43], v205 offset:36864
  s_waitcnt lgkmcnt(2)
  v_mfma_f32_32x32x16_bf16 v[240:255], a[0:3], v[32:35], 0
  ds_read_b128 v[44:47], v206 offset:36864
  s_add_u32 m0, s67, 0
  s_nop 0
  buffer_load_dwordx4 v202, s[4:7], s60 offen offset:0 lds
  s_waitcnt lgkmcnt(2)
  v_mfma_f32_32x32x16_bf16 v[240:255], a[4:7], v[36:39], v[240:255]
  ds_read_b128 v[32:35], v203 offset:37888
  s_waitcnt lgkmcnt(2)
  v_mfma_f32_32x32x16_bf16 v[240:255], a[8:11], v[40:43], v[240:255]
  ds_read_b128 v[36:39], v204 offset:37888
  s_add_u32 m0, s67, 896
  s_nop 0
  buffer_load_dwordx4 v202, s[4:7], s60 offen offset:128 lds
  s_waitcnt lgkmcnt(2)
  v_mfma_f32_32x32x16_bf16 v[240:255], a[12:15], v[44:47], v[240:255]
  ds_read_b128 v[40:43], v205 offset:37888
  s_waitcnt lgkmcnt(2)
  v_mfma_f32_32x32x16_bf16 v[240:255], a[16:19], v[32:35], v[240:255]
  ds_read_b128 v[44:47], v206 offset:37888
  s_add_u32 m0, s67, 1792
  s_nop 0
  buffer_load_dwordx4 v202, s[4:7], s60 offen offset:256 lds
  s_waitcnt lgkmcnt(2)
  v_mfma_f32_32x32x16_bf16 v[240:255], a[20:23], v[36:39], v[240:255]
  ds_read_b128 v[32:35], v203 offset:38912
  s_waitcnt lgkmcnt(2)
  v_mfma_f32_32x32x16_bf16 v[240:255], a[24:27], v[40:43], v[240:255]
  ds_read_b128 v[36:39], v204 offset:38912
  s_add_u32 m0, s67, 2688
  s_nop 0
  buffer_load_dwordx4 v202, s[4:7], s60 offen offset:384 lds
  s_waitcnt lgkmcnt(2)
  v_mfma_f32_32x32x16_bf16 v[240:255], a[28:31], v[44:47], v[240:255]
  ds_read_b128 v[40:43], v205 offset:38912
  s_waitcnt lgkmcnt(2)
  v_mfma_f32_32x32x16_bf16 v[240:255], a[32:35], v[32:35], v[240:255]
  ds_read_b128 v[44:47], v206 offset:38912
  s_add_u32 m0, s67, 3584
  s_nop 0
  buffer_load_dwordx4 v202, s[4:7], s60 offen offset:512 lds
  s_waitcnt lgkmcnt(2)
  v_mfma_f32_32x32x16_bf16 v[240:255], a[36:39], v[36:39], v[240:255]
  ds_read_b128 v[32:35], v203 offset:39936
  s_waitcnt lgkmcnt(2)
  v_mfma_f32_32x32x16_bf16 v[240:255], a[40:43], v[40:43], v[240:255]
  ds_read_b128 v[36:39], v204 offset:39936
  s_add_u32 m0, s67, 4480
  s_nop 0
  buffer_load_dwordx4 v202, s[4:7], s60 offen offset:640 lds
  s_waitcnt lgkmcnt(2)
  v_mfma_f32_32x32x16_bf16 v[240:255], a[44:47], v[44:47], v[240:255]
  ds_read_b128 v[40:43], v205 offset:39936
  s_waitcnt lgkmcnt(2)
  v_mfma_f32_32x32x16_bf16 v[240:255], a[48:51], v[32:35], v[240:255]
  ds_read_b128 v[44:47], v206 offset:39936
  s_add_u32 m0, s67, 5376
  s_nop 0
  buffer_load_dwordx4 v202, s[4:7], s60 offen offset:768 lds
  s_waitcnt lgkmcnt(2)
  v_mfma_f32_32x32x16_bf16 v[240:255], a[52:55], v[36:39], v[240:255]
  ds_read_b128 v[32:35], v203 offset:40960
  s_waitcnt lgkmcnt(2)
  v_mfma_f32_32x32x16_bf16 v[240:255], a[56:59], v[40:43], v[240:255]
  ds_read_b128 v[36:39], v204 offset:40960
  s_add_u32 m0, s67, 6272
  s_nop 0
  buffer_load_dwordx4 v202, s[4:7], s60 offen offset:896 lds
  s_waitcnt lgkmcnt(2)
  v_mfma_f32_32x32x16_bf16 v[240:255], a[60:63], v[44:47], v[240:255]
  ds_read_b128 v[40:43], v205 offset:40960
  s_waitcnt lgkmcnt(2)
  v_mfma_f32_32x32x16_bf16 v[240:255], a[64:67], v[32:35], v[240:255]
  ds_read_b128 v[44:47], v206 offset:40960
  s_add_u32 m0, s67, 7168
  s_nop 0
  buffer_load_dwordx4 v202, s[4:7], s60 offen offset:1024 lds
  s_waitcnt lgkmcnt(2)
  v_mfma_f32_32x32x16_bf16 v[240:255], a[68:71], v[36:39], v[240:255]
  ds_read_b128 v[32:35], v203 offset:41984
  s_waitcnt lgkmcnt(2)
  v_mfma_f32_32x32x16_bf16 v[240:255], a[72:75], v[40:43], v[240:255]
  ds_read_b128 v[36:39], v204 offset:41984
  buffer_store_dwordx4 v[176:179], v201, s[8:11], s75 offen offset:0 sc1
  s_waitcnt lgkmcnt(2)
  v_mfma_f32_32x32x16_bf16 v[240:255], a[76:79], v[44:47], v[240:255]
  ds_read_b128 v[40:43], v205 offset:41984
  s_waitcnt lgkmcnt(2)
  v_mfma_f32_32x32x16_bf16 v[240:255], a[80:83], v[32:35], v[240:255]
  ds_read_b128 v[44:47], v206 offset:41984
  buffer_store_dwordx4 v[176:179], v201, s[8:11], s75 offen offset:1024 sc1
  s_waitcnt lgkmcnt(2)
  v_mfma_f32_32x32x16_bf16 v[240:255], a[84:87], v[36:39], v[240:255]
  ds_read_b128 v[32:35], v203 offset:43008
  s_waitcnt lgkmcnt(2)
  v_mfma_f32_32x32x16_bf16 v[240:255], a[88:91], v[40:43], v[240:255]
  ds_read_b128 v[36:39], v204 offset:43008
  s_waitcnt lgkmcnt(2)
  v_mfma_f32_32x32x16_bf16 v[240:255], a[92:95], v[44:47], v[240:255]
  ds_read_b128 v[40:43], v205 offset:43008
  s_waitcnt lgkmcnt(2)
  v_mfma_f32_32x32x16_bf16 v[240:255], a[96:99], v[32:35], v[240:255]
  ds_read_b128 v[44:47], v206 offset:43008
  s_waitcnt lgkmcnt(2)
  v_mfma_f32_32x32x16_bf16 v[240:255], a[100:103], v[36:39], v[240:255]
  ds_read_b128 v[32:35], v203 offset:44032
  s_waitcnt lgkmcnt(2)
  v_mfma_f32_32x32x16_bf16 v[240:255], a[104:107], v[40:43], v[240:255]
  ds_read_b128 v[36:39], v204 offset:44032
  s_waitcnt lgkmcnt(2)
  v_mfma_f32_32x32x16_bf16 v[240:255], a[108:111], v[44:47], v[240:255]
  ds_read_b128 v[40:43], v205 offset:44032
  s_waitcnt lgkmcnt(2)
  v_mfma_f32_32x32x16_bf16 v[240:255], a[112:115], v[32:35], v[240:255]
  ds_read_b128 v[44:47], v206 offset:44032
  s_waitcnt lgkmcnt(2)
  v_mfma_f32_32x32x16_bf16 v[240:255], a[116:119], v[36:39], v[240:255]
  ds_read_b128 v[32:35], v203 offset:45056
  s_waitcnt lgkmcnt(2)
  v_mfma_f32_32x32x16_bf16 v[240:255], a[120:123], v[40:43], v[240:255]
  ds_read_b128 v[36:39], v204 offset:45056
  s_waitcnt lgkmcnt(2)
  v_mfma_f32_32x32x16_bf16 v[240:255], a[124:127], v[44:47], v[240:255]
  ds_read_b128 v[40:43], v205 offset:45056
  s_waitcnt lgkmcnt(2)
  v_mfma_f32_32x32x16_bf16 v[240:255], a[128:131], v[32:35], v[240:255]
  ds_read_b128 v[44:47], v206 offset:45056
  s_waitcnt lgkmcnt(2)
  v_mfma_f32_32x32x16_bf16 v[240:255], a[132:135], v[36:39], v[240:255]
  s_waitcnt lgkmcnt(1)
  v_mfma_f32_32x32x16_bf16 v[240:255], a[136:139], v[40:43], v[240:255]
  s_waitcnt lgkmcnt(0)
  v_mfma_f32_32x32x16_bf16 v[240:255], a[140:143], v[44:47], v[240:255]
  s_nop 11
  v_cvt_pk_bf16_f32 v16, v240, v244
  v_cvt_pk_bf16_f32 v17, v241, v245
  v_cvt_pk_bf16_f32 v18, v242, v246
  v_cvt_pk_bf16_f32 v19, v243, v247
  ds_write_b128 v215, v[16:19] offset:0
  v_cvt_pk_bf16_f32 v20, v248, v252
  v_cvt_pk_bf16_f32 v21, v249, v253
  v_cvt_pk_bf16_f32 v22, v250, v254
  v_cvt_pk_bf16_f32 v23, v251, v255
  ds_write_b128 v215, v[20:23] offset:1024
  s_waitcnt lgkmcnt(0)
  s_barrier
  ds_read_b128 a[144:147], v208 offset:0
  ds_read_b128 a[148:151], v208 offset:1024
  ds_read_b128 a[152:155], v208 offset:2048
  ds_read_b128 a[156:159], v208 offset:3072
  ds_read_b128 a[160:163], v208 offset:4096
  ds_read_b128 a[164:167], v208 offset:5120
  ds_read_b128 a[168:171], v208 offset:6144
  ds_read_b128 a[172:175], v208 offset:7168
  s_waitcnt vmcnt(11)
  v_cmp_eq_u32 vcc, -1, v172
  s_mov_b32 s69, 0
  s_cbranch_vccnz AT_e1
  s_mov_b32 s69, 1
  buffer_load_dwordx4 v[172:175], v201, s[8:11], s73 offen sc1
AT_e1:
  s_waitcnt lgkmcnt(7)
  v_mfma_f32_32x32x16_bf16 v[64:79], v[128:131], a[144:147], v[48:63]
  s_waitcnt lgkmcnt(6)
  v_mfma_f32_32x32x16_bf16 v[64:79], v[132:135], a[148:151], v[64:79]
  s_waitcnt lgkmcnt(5)
  v_mfma_f32_32x32x16_bf16 v[64:79], v[136:139], a[152:155], v[64:79]
  s_waitcnt lgkmcnt(4)
  v_mfma_f32_32x32x16_bf16 v[64:79], v[140:143], a[156:159], v[64:79]
  s_waitcnt lgkmcnt(3)
  v_mfma_f32_32x32x16_bf16 v[64:79], v[144:147], a[160:163], v[64:79]
  s_waitcnt lgkmcnt(2)
  v_mfma_f32_32x32x16_bf16 v[64:79], v[148:151], a[164:167], v[64:79]
  s_waitcnt lgkmcnt(1)
  v_mfma_f32_32x32x16_bf16 v[64:79], v[152:155], a[168:171], v[64:79]
  s_waitcnt lgkmcnt(0)
  v_mfma_f32_32x32x16_bf16 v[64:79], v[156:159], a[172:175], v[64:79]
  s_nop 11
  v_max3_f32 v184, v64, v65, v66
  v_max3_f32 v184, v184, v67, v68
  v_max3_f32 v184, v184, v69, v70
  v_max3_f32 v184, v184, v71, v72
  v_max3_f32 v184, v184, v73, v74
  v_max3_f32 v184, v184, v75, v76
  v_max3_f32 v184, v184, v77, v78
  v_max_f32 v184, v184, v79
  v_mov_b32 v185, v184
  s_nop 1
  v_permlane32_swap_b32 v184, v185
  v_max_f32 v184, v184, v185
  v_sub_f32 v64, v64, v184
  v_sub_f32 v65, v65, v184
  v_sub_f32 v66, v66, v184
  v_sub_f32 v67, v67, v184
  v_sub_f32 v68, v68, v184
  v_sub_f32 v69, v69, v184
  v_sub_f32 v70, v70, v184
  v_sub_f32 v71, v71, v184
  v_sub_f32 v72, v72, v184
  v_sub_f32 v73, v73, v184
  v_sub_f32 v74, v74, v184
  v_sub_f32 v75, v75, v184
  v_sub_f32 v76, v76, v184
  v_sub_f32 v77, v77, v184
  v_sub_f32 v78, v78, v184
  v_sub_f32 v79, v79, v184
  v_exp_f32 v64, v64
  v_exp_f32 v65, v65
  v_exp_f32 v66, v66
  v_exp_f32 v67, v67
  v_exp_f32 v68, v68
  v_exp_f32 v69, v69
  v_exp_f32 v70, v70
  v_exp_f32 v71, v71
  v_exp_f32 v72, v72
  v_exp_f32 v73, v73
  v_exp_f32 v74, v74
  v_exp_f32 v75, v75
  v_exp_f32 v76, v76
  v_exp_f32 v77, v77
  v_exp_f32 v78, v78
  v_exp_f32 v79, v79
  v_cvt_pk_bf16_f32 v20, v64, v65
  v_cvt_pk_bf16_f32 v21, v68, v69
  v_cvt_pk_bf16_f32 v22, v72, v73
  v_cvt_pk_bf16_f32 v23, v76, v77
  v_cvt_pk_bf16_f32 v24, v66, v67
  v_cvt_pk_bf16_f32 v25, v70, v71
  v_cvt_pk_bf16_f32 v26, v74, v75
  v_cvt_pk_bf16_f32 v27, v78, v79
  v_mfma_f32_32x32x16_bf16 v[224:239], v[160:163], v[20:23], 0
  v_add_f32 v186, v64, v65
  v_add_f32 v186, v186, v66
  v_add_f32 v186, v186, v67
  v_add_f32 v186, v186, v68
  v_add_f32 v186, v186, v69
  v_add_f32 v186, v186, v70
  v_add_f32 v186, v186, v71
  v_mfma_f32_32x32x16_bf16 v[224:239], v[164:167], v[24:27], v[224:239]
  v_add_f32 v186, v186, v72
  v_add_f32 v186, v186, v73
  v_add_f32 v186, v186, v74
  v_add_f32 v186, v186, v75
  v_add_f32 v186, v186, v76
  v_add_f32 v186, v186, v77
  v_add_f32 v186, v186, v78
  v_add_f32 v186, v186, v79
AT_l0:
  s_cmp_eq_u32 s69, 1
  s_cbranch_scc1 AT_v0
  s_cmp_ge_u32 s74, 62
  s_cbranch_scc1 AT_k0
  s_branch AT_c0
AT_h0:
  s_sleep 2
AT_c0:
  buffer_load_dword v172, off, s[8:11], s70 sc1
  s_add_u32 s65, s65, 1
  s_cmp_lt_u32 s65, 131072
  s_cselect_b32 s54, -2, -1
  s_waitcnt vmcnt(0)
  v_cmp_lt_u32 vcc, s54, v172
  s_cbranch_vccnz AT_h0
AT_k0:
  buffer_load_dwordx4 v[172:175], v201, s[8:11], s73 offen sc1
AT_v0:
  s_mov_b32 s69, 0
  s_add_u32 s65, s65, 1
  s_cmp_lt_u32 s65, 131072
  s_cselect_b32 s54, -2, -1
  s_waitcnt vmcnt(0)
  ds_write_b64 v220, v[172:173] offset:0
  ds_write_b64 v221, v[174:175] offset:0
  v_max3_u32 v213, v172, v173, v174
  v_max_u32 v213, v213, v175
  v_cmp_lt_u32 vcc, s54, v213
  s_cbranch_vccnz AT_k0
  s_waitcnt lgkmcnt(0)
  s_barrier
  ds_read_b128 v[128:131], v218 offset:0
  ds_read_b128 v[132:135], v218 offset:256
  ds_read_b128 v[136:139], v218 offset:512
  ds_read_b128 v[140:143], v218 offset:768
  ds_read_b128 v[144:147], v218 offset:1024
  ds_read_b128 v[148:151], v218 offset:1280
  ds_read_b128 v[152:155], v218 offset:1536
  ds_read_b128 v[156:159], v218 offset:1792
  ds_read_b32 v168, v219 offset:0
  ds_read_b32 v169, v219 offset:128
  s_waitcnt lgkmcnt(9)
  v_mfma_f32_32x32x16_bf16 v[80:95], v[128:131], v[96:99], 0
  s_waitcnt lgkmcnt(8)
  v_mfma_f32_32x32x16_bf16 v[80:95], v[132:135], v[100:103], v[80:95]
  s_waitcnt lgkmcnt(7)
  v_mfma_f32_32x32x16_bf16 v[80:95], v[136:139], v[104:107], v[80:95]
  s_waitcnt lgkmcnt(6)
  v_mfma_f32_32x32x16_bf16 v[80:95], v[140:143], v[108:111], v[80:95]
  s_waitcnt lgkmcnt(5)
  v_mfma_f32_32x32x16_bf16 v[80:95], v[144:147], v[112:115], v[80:95]
  s_waitcnt lgkmcnt(4)
  v_mfma_f32_32x32x16_bf16 v[80:95], v[148:151], v[116:119], v[80:95]
  s_waitcnt lgkmcnt(3)
  v_mfma_f32_32x32x16_bf16 v[80:95], v[152:155], v[120:123], v[80:95]
  s_waitcnt lgkmcnt(2)
  v_mfma_f32_32x32x16_bf16 v[80:95], v[156:159], v[124:127], v[80:95]
  s_add_u32 s74, s74, 2
  v_mov_b32 v212, s74
  s_nop 9
  v_mul_f32 v80, s68, v80
  v_mul_f32 v81, s68, v81
  v_mul_f32 v82, s68, v82
  v_mul_f32 v83, s68, v83
  v_max3_f32 v84, v180, v80, v81
  v_max3_f32 v84, v84, v82, v83
  v_mov_b32 v85, v84
  s_nop 1
  v_permlane32_swap_b32 v84, v85
  v_max_f32 v84, v84, v85
  v_sub_f32 v86, v180, v84
  v_sub_f32 v80, v80, v84
  v_sub_f32 v81, v81, v84
  v_sub_f32 v82, v82, v84
  v_sub_f32 v83, v83, v84
  v_exp_f32 v86, v86
  v_exp_f32 v80, v80
  v_exp_f32 v81, v81
  v_exp_f32 v82, v82
  v_exp_f32 v83, v83
  v_fma_f32 v182, v182, v86, v80
  v_add_f32 v84, v81, v82
  v_add_f32 v182, v182, v83
  v_add_f32 v182, v182, v84
  v_mov_b32 v183, v182
  s_nop 1
  v_permlane32_swap_b32 v182, v183
  v_add_f32 v182, v182, v183
  v_rcp_f32 v182, v182
  s_nop 0
  v_mul_f32 v86, v86, v182
  v_mul_f32 v80, v182, v80
  v_mul_f32 v81, v182, v81
  v_mul_f32 v82, v182, v82
  v_mul_f32 v83, v182, v83
  v_cvt_pk_bf16_f32 v28, v80, v81
  v_cvt_pk_bf16_f32 v29, v82, v83
  v_mul_f32 v0, v86, v0
  v_mul_f32 v1, v86, v1
  v_mul_f32 v2, v86, v2
  v_mul_f32 v3, v86, v3
  v_mul_f32 v4, v86, v4
  v_mul_f32 v5, v86, v5
  v_mul_f32 v6, v86, v6
  v_mul_f32 v7, v86, v7
  v_mul_f32 v8, v86, v8
  v_mul_f32 v9, v86, v9
  v_mul_f32 v10, v86, v10
  v_mul_f32 v11, v86, v11
  v_mul_f32 v12, v86, v12
  v_mul_f32 v13, v86, v13
  v_mul_f32 v14, v86, v14
  v_mul_f32 v15, v86, v15
  s_waitcnt lgkmcnt(0)
  s_nop 0
  v_mfma_f32_32x32x8_bf16 v[0:15], v[168:169], v[28:29], v[0:15]
  s_nop 11
  v_cvt_pk_bf16_f32 v20, v0, v1
  v_cvt_pk_bf16_f32 v21, v2, v3
  v_cvt_pk_bf16_f32 v22, v4, v5
  v_cvt_pk_bf16_f32 v23, v6, v7
  buffer_store_dwordx4 v[20:23], v201, s[8:11], s72 offen offset:0 sc1
  v_cvt_pk_bf16_f32 v24, v8, v9
  v_cvt_pk_bf16_f32 v25, v10, v11
  v_cvt_pk_bf16_f32 v26, v12, v13
  v_cvt_pk_bf16_f32 v27, v14, v15
  buffer_store_dwordx4 v[24:27], v201, s[8:11], s72 offen offset:1024 sc1
  s_mov_b64 exec, 1
  buffer_store_dword v212, v201, s[8:11], s71 offen sc1
  s_mov_b64 exec, -1
  s_cmp_ge_u32 s74, 64
  s_cbranch_scc1 L_exit
  s_cmp_ge_u32 s59, 64
  s_cbranch_scc1 AT_l1
  s_mov_b32 s74, s59
  s_mul_i32 s66, s59, 655360
  s_lshl_b32 s55, s58, 14
  s_add_u32 s55, s55, s66
  s_add_u32 s55, s55, 1048576
  s_lshl_b32 s73, s58, 2
  s_add_u32 s73, s73, s52
  s_lshl_b32 s72, s59, 7
  s_add_u32 s72, s72, s73
  s_lshl_b32 s72, s72, 11
  s_add_u32 s72, s72, 46137344
  s_lshl_b32 s73, s73, 10
  s_add_u32 s73, s73, s66
  s_add_u32 s73, s73, 1572864
  s_add_u32 s59, s59, 2
  buffer_load_dwordx4 v[128:131], v216, s[8:11], s55 offen offset:0 sc1
  buffer_load_dwordx4 v[132:135], v216, s[8:11], s55 offen offset:256 sc1
  buffer_load_dwordx4 v[136:139], v216, s[8:11], s55 offen offset:512 sc1
  buffer_load_dwordx4 v[140:143], v216, s[8:11], s55 offen offset:768 sc1
  buffer_load_dwordx4 v[144:147], v216, s[8:11], s55 offen offset:1024 sc1
  buffer_load_dwordx4 v[148:151], v216, s[8:11], s55 offen offset:1280 sc1
  buffer_load_dwordx4 v[152:155], v216, s[8:11], s55 offen offset:1536 sc1
  buffer_load_dwordx4 v[156:159], v216, s[8:11], s55 offen offset:1792 sc1
  buffer_load_dwordx4 v[160:163], v217, s[8:11], s55 offen offset:0 sc1
  buffer_load_dwordx4 v[164:167], v217, s[8:11], s55 offen offset:256 sc1
  s_or_b32 s70, s76, 0xc00
  buffer_load_dword v172, off, s[8:11], s70 sc1
  s_add_u32 s60, s60, 73728
  ds_read_b128 v[32:35], v203 offset:0
  ds_read_b128 v[36:39], v204 offset:0
  ds_read_b128 v[40:43], v205 offset:0
  s_waitcnt lgkmcnt(2)
  v_mfma_f32_32x32x16_bf16 v[240:255], a[0:3], v[32:35], 0
  ds_read_b128 v[44:47], v206 offset:0
  s_add_u32 m0, s67, 36864
  s_nop 0
  buffer_load_dwordx4 v202, s[4:7], s60 offen offset:0 lds
  s_waitcnt lgkmcnt(2)
  v_mfma_f32_32x32x16_bf16 v[240:255], a[4:7], v[36:39], v[240:255]
  ds_read_b128 v[32:35], v203 offset:1024
  s_waitcnt lgkmcnt(2)
  v_mfma_f32_32x32x16_bf16 v[240:255], a[8:11], v[40:43], v[240:255]
  ds_read_b128 v[36:39], v204 offset:1024
  s_add_u32 m0, s67, 37760
  s_nop 0
  buffer_load_dwordx4 v202, s[4:7], s60 offen offset:128 lds
  s_waitcnt lgkmcnt(2)
  v_mfma_f32_32x32x16_bf16 v[240:255], a[12:15], v[44:47], v[240:255]
  ds_read_b128 v[40:43], v205 offset:1024
  s_waitcnt lgkmcnt(2)
  v_mfma_f32_32x32x16_bf16 v[240:255], a[16:19], v[32:35], v[240:255]
  ds_read_b128 v[44:47], v206 offset:1024
  s_add_u32 m0, s67, 38656
  s_nop 0
  buffer_load_dwordx4 v202, s[4:7], s60 offen offset:256 lds
  s_waitcnt lgkmcnt(2)
  v_mfma_f32_32x32x16_bf16 v[240:255], a[20:23], v[36:39], v[240:255]
  ds_read_b128 v[32:35], v203 offset:2048
  s_waitcnt lgkmcnt(2)
  v_mfma_f32_32x32x16_bf16 v[240:255], a[24:27], v[40:43], v[240:255]
  ds_read_b128 v[36:39], v204 offset:2048
  s_add_u32 m0, s67, 39552
  s_nop 0
  buffer_load_dwordx4 v202, s[4:7], s60 offen offset:384 lds
  s_waitcnt lgkmcnt(2)
  v_mfma_f32_32x32x16_bf16 v[240:255], a[28:31], v[44:47], v[240:255]
  ds_read_b128 v[40:43], v205 offset:2048
  s_waitcnt lgkmcnt(2)
  v_mfma_f32_32x32x16_bf16 v[240:255], a[32:35], v[32:35], v[240:255]
  ds_read_b128 v[44:47], v206 offset:2048
  s_add_u32 m0, s67, 40448
  s_nop 0
  buffer_load_dwordx4 v202, s[4:7], s60 offen offset:512 lds
  s_waitcnt lgkmcnt(2)
  v_mfma_f32_32x32x16_bf16 v[240:255], a[36:39], v[36:39], v[240:255]
  ds_read_b128 v[32:35], v203 offset:3072
  s_waitcnt lgkmcnt(2)
  v_mfma_f32_32x32x16_bf16 v[240:255], a[40:43], v[40:43], v[240:255]
  ds_read_b128 v[36:39], v204 offset:3072
  s_add_u32 m0, s67, 41344
  s_nop 0
  buffer_load_dwordx4 v202, s[4:7], s60 offen offset:640 lds
  s_waitcnt lgkmcnt(2)
  v_mfma_f32_32x32x16_bf16 v[240:255], a[44:47], v[44:47], v[240:255]
  ds_read_b128 v[40:43], v205 offset:3072
  s_waitcnt lgkmcnt(2)
  v_mfma_f32_32x32x16_bf16 v[240:255], a[48:51], v[32:35], v[240:255]
  ds_read_b128 v[44:47], v206 offset:3072
  s_add_u32 m0, s67, 42240
  s_nop 0
  buffer_load_dwordx4 v202, s[4:7], s60 offen offset:768 lds
  s_waitcnt lgkmcnt(2)
  v_mfma_f32_32x32x16_bf16 v[240:255], a[52:55], v[36:39], v[240:255]
  ds_read_b128 v[32:35], v203 offset:4096
  s_waitcnt lgkmcnt(2)
  v_mfma_f32_32x32x16_bf16 v[240:255], a[56:59], v[40:43], v[240:255]
  ds_read_b128 v[36:39], v204 offset:4096
  s_add_u32 m0, s67, 43136
  s_nop 0
  buffer_load_dwordx4 v202, s[4:7], s60 offen offset:896 lds
  s_waitcnt lgkmcnt(2)
  v_mfma_f32_32x32x16_bf16 v[240:255], a[60:63], v[44:47], v[240:255]
  ds_read_b128 v[40:43], v205 offset:4096
  s_waitcnt lgkmcnt(2)
  v_mfma_f32_32x32x16_bf16 v[240:255], a[64:67], v[32:35], v[240:255]
  ds_read_b128 v[44:47], v206 offset:4096
  s_add_u32 m0, s67, 44032
  s_nop 0
  buffer_load_dwordx4 v202, s[4:7], s60 offen offset:1024 lds
  s_waitcnt lgkmcnt(2)
  v_mfma_f32_32x32x16_bf16 v[240:255], a[68:71], v[36:39], v[240:255]
  ds_read_b128 v[32:35], v203 offset:5120
  s_waitcnt lgkmcnt(2)
  v_mfma_f32_32x32x16_bf16 v[240:255], a[72:75], v[40:43], v[240:255]
  ds_read_b128 v[36:39], v204 offset:5120
  buffer_store_dwordx4 v[176:179], v201, s[8:11], s72 offen offset:0 sc1
  s_waitcnt lgkmcnt(2)
  v_mfma_f32_32x32x16_bf16 v[240:255], a[76:79], v[44:47], v[240:255]
  ds_read_b128 v[40:43], v205 offset:5120
  s_waitcnt lgkmcnt(2)
  v_mfma_f32_32x32x16_bf16 v[240:255], a[80:83], v[32:35], v[240:255]
  ds_read_b128 v[44:47], v206 offset:5120
  buffer_store_dwordx4 v[176:179], v201, s[8:11], s72 offen offset:1024 sc1
  s_waitcnt lgkmcnt(2)
  v_mfma_f32_32x32x16_bf16 v[240:255], a[84:87], v[36:39], v[240:255]
  ds_read_b128 v[32:35], v203 offset:6144
  s_waitcnt lgkmcnt(2)
  v_mfma_f32_32x32x16_bf16 v[240:255], a[88:91], v[40:43], v[240:255]
  ds_read_b128 v[36:39], v204 offset:6144
  s_waitcnt lgkmcnt(2)
  v_mfma_f32_32x32x16_bf16 v[240:255], a[92:95], v[44:47], v[240:255]
  ds_read_b128 v[40:43], v205 offset:6144
  s_waitcnt lgkmcnt(2)
  v_mfma_f32_32x32x16_bf16 v[240:255], a[96:99], v[32:35], v[240:255]
  ds_read_b128 v[44:47], v206 offset:6144
  s_waitcnt lgkmcnt(2)
  v_mfma_f32_32x32x16_bf16 v[240:255], a[100:103], v[36:39], v[240:255]
  ds_read_b128 v[32:35], v203 offset:7168
  s_waitcnt lgkmcnt(2)
  v_mfma_f32_32x32x16_bf16 v[240:255], a[104:107], v[40:43], v[240:255]
  ds_read_b128 v[36:39], v204 offset:7168
  s_waitcnt lgkmcnt(2)
  v_mfma_f32_32x32x16_bf16 v[240:255], a[108:111], v[44:47], v[240:255]
  ds_read_b128 v[40:43], v205 offset:7168
  s_waitcnt lgkmcnt(2)
  v_mfma_f32_32x32x16_bf16 v[240:255], a[112:115], v[32:35], v[240:255]
  ds_read_b128 v[44:47], v206 offset:7168
  s_waitcnt lgkmcnt(2)
  v_mfma_f32_32x32x16_bf16 v[240:255], a[116:119], v[36:39], v[240:255]
  ds_read_b128 v[32:35], v203 offset:8192
  s_waitcnt lgkmcnt(2)
  v_mfma_f32_32x32x16_bf16 v[240:255], a[120:123], v[40:43], v[240:255]
  ds_read_b128 v[36:39], v204 offset:8192
  s_waitcnt lgkmcnt(2)
  v_mfma_f32_32x32x16_bf16 v[240:255], a[124:127], v[44:47], v[240:255]
  ds_read_b128 v[40:43], v205 offset:8192
  s_waitcnt lgkmcnt(2)
  v_mfma_f32_32x32x16_bf16 v[240:255], a[128:131], v[32:35], v[240:255]
  ds_read_b128 v[44:47], v206 offset:8192
  s_waitcnt lgkmcnt(2)
  v_mfma_f32_32x32x16_bf16 v[240:255], a[132:135], v[36:39], v[240:255]
  s_waitcnt lgkmcnt(1)
  v_mfma_f32_32x32x16_bf16 v[240:255], a[136:139], v[40:43], v[240:255]
  s_waitcnt lgkmcnt(0)
  v_mfma_f32_32x32x16_bf16 v[240:255], a[140:143], v[44:47], v[240:255]
  s_nop 11
  v_cvt_pk_bf16_f32 v16, v240, v244
  v_cvt_pk_bf16_f32 v17, v241, v245
  v_cvt_pk_bf16_f32 v18, v242, v246
  v_cvt_pk_bf16_f32 v19, v243, v247
  ds_write_b128 v215, v[16:19] offset:0
  v_cvt_pk_bf16_f32 v20, v248, v252
  v_cvt_pk_bf16_f32 v21, v249, v253
  v_cvt_pk_bf16_f32 v22, v250, v254
  v_cvt_pk_bf16_f32 v23, v251, v255
  ds_write_b128 v215, v[20:23] offset:1024
  s_waitcnt lgkmcnt(0)
  s_barrier
  ds_read_b128 v[96:99], v208 offset:0
  ds_read_b128 v[100:103], v208 offset:1024
  ds_read_b128 v[104:107], v208 offset:2048
  ds_read_b128 v[108:111], v208 offset:3072
  ds_read_b128 v[112:115], v208 offset:4096
  ds_read_b128 v[116:119], v208 offset:5120
  ds_read_b128 v[120:123], v208 offset:6144
  ds_read_b128 v[124:127], v208 offset:7168
  s_waitcnt vmcnt(11)
  v_cmp_eq_u32 vcc, -1, v172
  s_mov_b32 s69, 0
  s_cbranch_vccnz AT_e0
  s_mov_b32 s69, 1
  buffer_load_dwordx4 v[172:175], v201, s[8:11], s76 offen sc1
AT_e0:
  s_waitcnt lgkmcnt(7)
  v_mfma_f32_32x32x16_bf16 v[64:79], v[128:131], v[96:99], v[48:63]
  s_waitcnt lgkmcnt(6)
  v_mfma_f32_32x32x16_bf16 v[64:79], v[132:135], v[100:103], v[64:79]
  s_waitcnt lgkmcnt(5)
  v_mfma_f32_32x32x16_bf16 v[64:79], v[136:139], v[104:107], v[64:79]
  s_waitcnt lgkmcnt(4)
  v_mfma_f32_32x32x16_bf16 v[64:79], v[140:143], v[108:111], v[64:79]
  s_waitcnt lgkmcnt(3)
  v_mfma_f32_32x32x16_bf16 v[64:79], v[144:147], v[112:115], v[64:79]
  s_waitcnt lgkmcnt(2)
  v_mfma_f32_32x32x16_bf16 v[64:79], v[148:151], v[116:119], v[64:79]
  s_waitcnt lgkmcnt(1)
  v_mfma_f32_32x32x16_bf16 v[64:79], v[152:155], v[120:123], v[64:79]
  s_waitcnt lgkmcnt(0)
  v_mfma_f32_32x32x16_bf16 v[64:79], v[156:159], v[124:127], v[64:79]
  s_nop 11
  v_max3_f32 v180, v64, v65, v66
  v_max3_f32 v180, v180, v67, v68
  v_max3_f32 v180, v180, v69, v70
  v_max3_f32 v180, v180, v71, v72
  v_max3_f32 v180, v180, v73, v74
  v_max3_f32 v180, v180, v75, v76
  v_max3_f32 v180, v180, v77, v78
  v_max_f32 v180, v180, v79
  v_mov_b32 v181, v180
  s_nop 1
  v_permlane32_swap_b32 v180, v181
  v_max_f32 v180, v180, v181
  v_sub_f32 v64, v64, v180
  v_sub_f32 v65, v65, v180
  v_sub_f32 v66, v66, v180
  v_sub_f32 v67, v67, v180
  v_sub_f32 v68, v68, v180
  v_sub_f32 v69, v69, v180
  v_sub_f32 v70, v70, v180
  v_sub_f32 v71, v71, v180
  v_sub_f32 v72, v72, v180
  v_sub_f32 v73, v73, v180
  v_sub_f32 v74, v74, v180
  v_sub_f32 v75, v75, v180
  v_sub_f32 v76, v76, v180
  v_sub_f32 v77, v77, v180
  v_sub_f32 v78, v78, v180
  v_sub_f32 v79, v79, v180
  v_exp_f32 v64, v64
  v_exp_f32 v65, v65
  v_exp_f32 v66, v66
  v_exp_f32 v67, v67
  v_exp_f32 v68, v68
  v_exp_f32 v69, v69
  v_exp_f32 v70, v70
  v_exp_f32 v71, v71
  v_exp_f32 v72, v72
  v_exp_f32 v73, v73
  v_exp_f32 v74, v74
  v_exp_f32 v75, v75
  v_exp_f32 v76, v76
  v_exp_f32 v77, v77
  v_exp_f32 v78, v78
  v_exp_f32 v79, v79
  v_cvt_pk_bf16_f32 v20, v64, v65
  v_cvt_pk_bf16_f32 v21, v68, v69
  v_cvt_pk_bf16_f32 v22, v72, v73
  v_cvt_pk_bf16_f32 v23, v76, v77
  v_cvt_pk_bf16_f32 v24, v66, v67
  v_cvt_pk_bf16_f32 v25, v70, v71
  v_cvt_pk_bf16_f32 v26, v74, v75
  v_cvt_pk_bf16_f32 v27, v78, v79
  v_mfma_f32_32x32x16_bf16 v[0:15], v[160:163], v[20:23], 0
  v_add_f32 v182, v64, v65
  v_add_f32 v182, v182, v66
  v_add_f32 v182, v182, v67
  v_add_f32 v182, v182, v68
  v_add_f32 v182, v182, v69
  v_add_f32 v182, v182, v70
  v_add_f32 v182, v182, v71
  v_mfma_f32_32x32x16_bf16 v[0:15], v[164:167], v[24:27], v[0:15]
  v_add_f32 v182, v182, v72
  v_add_f32 v182, v182, v73
  v_add_f32 v182, v182, v74
  v_add_f32 v182, v182, v75
  v_add_f32 v182, v182, v76
  v_add_f32 v182, v182, v77
  v_add_f32 v182, v182, v78
  v_add_f32 v182, v182, v79
AT_l1:
  s_cmp_eq_u32 s69, 1
  s_cbranch_scc1 AT_v1
  s_cmp_ge_u32 s77, 62
  s_cbranch_scc1 AT_k1
  s_branch AT_c1
AT_h1:
  s_sleep 2
AT_c1:
  buffer_load_dword v172, off, s[8:11], s70 sc1
  s_add_u32 s65, s65, 1
  s_cmp_lt_u32 s65, 131072
  s_cselect_b32 s54, -2, -1
  s_waitcnt vmcnt(0)
  v_cmp_lt_u32 vcc, s54, v172
  s_cbranch_vccnz AT_h1
AT_k1:
  buffer_load_dwordx4 v[172:175], v201, s[8:11], s76 offen sc1
AT_v1:
  s_mov_b32 s69, 0
  s_add_u32 s65, s65, 1
  s_cmp_lt_u32 s65, 131072
  s_cselect_b32 s54, -2, -1
  s_waitcnt vmcnt(0)
  ds_write_b64 v220, v[172:173] offset:4096
  ds_write_b64 v221, v[174:175] offset:4096
  v_max3_u32 v213, v172, v173, v174
  v_max_u32 v213, v213, v175
  v_cmp_lt_u32 vcc, s54, v213
  s_cbranch_vccnz AT_k1
  s_waitcnt lgkmcnt(0)
  s_barrier
  ds_read_b128 v[128:131], v218 offset:4096
  ds_read_b128 v[132:135], v218 offset:4352
  ds_read_b128 v[136:139], v218 offset:4608
  ds_read_b128 v[140:143], v218 offset:4864
  ds_read_b128 v[144:147], v218 offset:5120
  ds_read_b128 v[148:151], v218 offset:5376
  ds_read_b128 v[152:155], v218 offset:5632
  ds_read_b128 v[156:159], v218 offset:5888
  ds_read_b32 v168, v219 offset:4096
  ds_read_b32 v169, v219 offset:4224
  s_waitcnt lgkmcnt(9)
  v_mfma_f32_32x32x16_bf16 v[80:95], v[128:131], a[144:147], 0
  s_waitcnt lgkmcnt(8)
  v_mfma_f32_32x32x16_bf16 v[80:95], v[132:135], a[148:151], v[80:95]
  s_waitcnt lgkmcnt(7)
  v_mfma_f32_32x32x16_bf16 v[80:95], v[136:139], a[152:155], v[80:95]
  s_waitcnt lgkmcnt(6)
  v_mfma_f32_32x32x16_bf16 v[80:95], v[140:143], a[156:159], v[80:95]
  s_waitcnt lgkmcnt(5)
  v_mfma_f32_32x32x16_bf16 v[80:95], v[144:147], a[160:163], v[80:95]
  s_waitcnt lgkmcnt(4)
  v_mfma_f32_32x32x16_bf16 v[80:95], v[148:151], a[164:167], v[80:95]
  s_waitcnt lgkmcnt(3)
  v_mfma_f32_32x32x16_bf16 v[80:95], v[152:155], a[168:171], v[80:95]
  s_waitcnt lgkmcnt(2)
  v_mfma_f32_32x32x16_bf16 v[80:95], v[156:159], a[172:175], v[80:95]
  s_add_u32 s77, s77, 2
  v_mov_b32 v212, s77
  s_nop 9
  v_mul_f32 v80, s68, v80
  v_mul_f32 v81, s68, v81
  v_mul_f32 v82, s68, v82
  v_mul_f32 v83, s68, v83
  v_max3_f32 v84, v184, v80, v81
  v_max3_f32 v84, v84, v82, v83
  v_mov_b32 v85, v84
  s_nop 1
  v_permlane32_swap_b32 v84, v85
  v_max_f32 v84, v84, v85
  v_sub_f32 v86, v184, v84
  v_sub_f32 v80, v80, v84
  v_sub_f32 v81, v81, v84
  v_sub_f32 v82, v82, v84
  v_sub_f32 v83, v83, v84
  v_exp_f32 v86, v86
  v_exp_f32 v80, v80
  v_exp_f32 v81, v81
  v_exp_f32 v82, v82
  v_exp_f32 v83, v83
  v_fma_f32 v186, v186, v86, v80
  v_add_f32 v84, v81, v82
  v_add_f32 v186, v186, v83
  v_add_f32 v186, v186, v84
  v_mov_b32 v187, v186
  s_nop 1
  v_permlane32_swap_b32 v186, v187
  v_add_f32 v186, v186, v187
  v_rcp_f32 v186, v186
  s_nop 0
  v_mul_f32 v86, v86, v186
  v_mul_f32 v80, v186, v80
  v_mul_f32 v81, v186, v81
  v_mul_f32 v82, v186, v82
  v_mul_f32 v83, v186, v83
  v_cvt_pk_bf16_f32 v28, v80, v81
  v_cvt_pk_bf16_f32 v29, v82, v83
  v_mul_f32 v224, v86, v224
  v_mul_f32 v225, v86, v225
  v_mul_f32 v226, v86, v226
  v_mul_f32 v227, v86, v227
  v_mul_f32 v228, v86, v228
  v_mul_f32 v229, v86, v229
  v_mul_f32 v230, v86, v230
  v_mul_f32 v231, v86, v231
  v_mul_f32 v232, v86, v232
  v_mul_f32 v233, v86, v233
  v_mul_f32 v234, v86, v234
  v_mul_f32 v235, v86, v235
  v_mul_f32 v236, v86, v236
  v_mul_f32 v237, v86, v237
  v_mul_f32 v238, v86, v238
  v_mul_f32 v239, v86, v239
  s_waitcnt lgkmcnt(0)
  s_nop 0
  v_mfma_f32_32x32x8_bf16 v[224:239], v[168:169], v[28:29], v[224:239]
  s_nop 11
  v_cvt_pk_bf16_f32 v20, v224, v225
  v_cvt_pk_bf16_f32 v21, v226, v227
  v_cvt_pk_bf16_f32 v22, v228, v229
  v_cvt_pk_bf16_f32 v23, v230, v231
  buffer_store_dwordx4 v[20:23], v201, s[8:11], s75 offen offset:0 sc1
  v_cvt_pk_bf16_f32 v24, v232, v233
  v_cvt_pk_bf16_f32 v25, v234, v235
  v_cvt_pk_bf16_f32 v26, v236, v237
  v_cvt_pk_bf16_f32 v27, v238, v239
  buffer_store_dwordx4 v[24:27], v201, s[8:11], s75 offen offset:1024 sc1
  s_mov_b64 exec, 1
  buffer_store_dword v212, v201, s[8:11], s71 offen sc1
  s_mov_b64 exec, -1
  s_cmp_ge_u32 s77, 64
  s_cbranch_scc1 L_exit
  s_branch AT_loop
L_cexit:
L_exit:
L_end:
s_endpgm
.section .rodata,"a"
.p2align 6
.amdhsa_kernel gated_mix__sliding_local_dilated__memory_aug_recurrent_mem_tr__prompt_kernel
  .amdhsa_next_free_vgpr 512
  .amdhsa_next_free_sgpr 102
  .amdhsa_accum_offset 256
  .amdhsa_group_segment_fixed_size 0
  .amdhsa_kernarg_size 112
  .amdhsa_user_sgpr_count 2
  .amdhsa_user_sgpr_kernarg_segment_ptr 1
  .amdhsa_system_sgpr_workgroup_id_x 1
.end_amdhsa_kernel
```

```asm
; @launch grid=(256,1,1) block=(256,1,1) lds=163840
.amdgcn_target "amdgcn-amd-amdhsa--gfx950"
.text
.globl gated_mix__sliding_local_dilated__memory_aug_recurrent_mem_tr__prompt_kernel
.p2align 8
.type gated_mix__sliding_local_dilated__memory_aug_recurrent_mem_tr__prompt_kernel,@function
gated_mix__sliding_local_dilated__memory_aug_recurrent_mem_tr__prompt_kernel:
  s_cmp_ge_u32 s2, 256
  s_cbranch_scc1 L_end
  s_load_dwordx2 s[4:5], s[0:1], 0
  s_load_dwordx2 s[8:9], s[0:1], 104
  s_load_dwordx2 s[12:13], s[0:1], 96
  s_load_dwordx2 s[16:17], s[0:1], 40
  s_load_dwordx2 s[20:21], s[0:1], 48
  s_load_dwordx2 s[24:25], s[0:1], 56
  s_load_dwordx2 s[28:29], s[0:1], 64
  s_load_dwordx2 s[32:33], s[0:1], 32
  s_load_dwordx2 s[36:37], s[0:1], 8
  s_load_dwordx2 s[40:41], s[0:1], 16
  s_load_dwordx2 s[44:45], s[0:1], 80
  s_load_dwordx2 s[48:49], s[0:1], 88
  s_getreg_b32 s54, hwreg(HW_REG_XCC_ID, 0, 3)
  v_lshrrev_b32 v1, 6, v0
  s_nop 0
  v_readfirstlane_b32 s52, v1
  s_mov_b32 s6, 2359296
  s_mov_b32 s7, 0x20000
  s_mov_b32 s10, 268435456
  s_mov_b32 s11, 0x20000
  s_mov_b32 s14, 256
  s_mov_b32 s15, 0x20000
  s_mov_b32 s18, 4718592
  s_mov_b32 s19, 0x20000
  s_mov_b32 s22, 4718592
  s_mov_b32 s23, 0x20000
  s_mov_b32 s26, 4718592
  s_mov_b32 s27, 0x20000
  s_mov_b32 s30, 4718592
  s_mov_b32 s31, 0x20000
  s_mov_b32 s34, 9216
  s_mov_b32 s35, 0x20000
  s_mov_b32 s38, 1990656
  s_mov_b32 s39, 0x20000
  s_mov_b32 s42, 663552
  s_mov_b32 s43, 0x20000
  s_mov_b32 s46, 1152
  s_mov_b32 s47, 0x20000
  s_mov_b32 s50, 2359296
  s_mov_b32 s51, 0x20000
  s_waitcnt lgkmcnt(0)
  s_lshr_b32 s0, s2, 3
  s_mov_b32 s2, s54
  s_mov_b32 s1, 0
  s_lshl_b32 s55, s2, 2
  s_cmp_eq_u32 s52, 0
  s_cselect_b32 s55, s55, 0x1000
  s_lshl_b32 s56, 1, s0
  v_mov_b32 v1, 0
  v_mov_b32 v35, s56
  s_mov_b64 exec, 1
  buffer_atomic_or v35, v1, s[12:15], s55 offen sc0
  s_mov_b64 exec, -1
L_role:
  s_mov_b32 s53, s0
  s_cmp_eq_u32 s2, 0
  s_cbranch_scc0 L_worker
  v_and_b32 v0, 63, v0
  v_and_b32 v1, 15, v0
  v_lshrrev_b32 v2, 4, v0
  v_and_b32 v3, 1, v2
  s_lshl_b32 s54, s52, 1
  v_add_u32 v3, s54, v3
  v_lshlrev_b32 v3, 1, v3
  v_xor_b32 v3, v3, v1
  v_lshlrev_b32 v3, 4, v3
  v_lshl_add_u32 v8, v2, 13, v3
  s_lshl_b32 s78, s53, 8
  s_lshl_b32 s54, s52, 15
  s_add_u32 s78, s78, s54
  s_mul_i32 s79, s53, 147456
  s_lshl_b32 s57, s52, 10
  s_add_u32 s57, s57, 16384
  s_getpc_b64 s[80:81]
L_pc_1:
  s_and_b32 s55, s0, 1
  s_lshl_b32 s55, s55, 2
  s_add_u32 s55, s55, s52
  s_lshl_b32 s55, s55, 10
  v_and_b32 v199, 63, v0
  v_lshl_add_u32 v199, v199, 4, s55
  v_min_u32 v199, (L_w0 - L_pc_1), v199
  global_load_dword v196, v199, s[80:81]
  s_add_u32 m0, s57, 0
  s_add_u32 s54, s78, 524288
  buffer_load_dwordx4 v8, s[16:19], s54 offen  lds
  s_add_u32 m0, s57, 4096
  s_add_u32 s54, s78, 655360
  buffer_load_dwordx4 v8, s[16:19], s54 offen  lds
  s_add_u32 m0, s57, 8192
  s_add_u32 s54, s78, 786432
  buffer_load_dwordx4 v8, s[16:19], s54 offen  lds
  s_add_u32 m0, s57, 12288
  s_add_u32 s54, s78, 917504
  buffer_load_dwordx4 v8, s[16:19], s54 offen  lds
  s_add_u32 m0, s57, 16384
  s_add_u32 s54, s78, 1048576
  buffer_load_dwordx4 v8, s[16:19], s54 offen  lds
  s_add_u32 m0, s57, 20480
  s_add_u32 s54, s78, 1179648
  buffer_load_dwordx4 v8, s[16:19], s54 offen  lds
  s_add_u32 m0, s57, 24576
  s_add_u32 s54, s78, 1310720
  buffer_load_dwordx4 v8, s[16:19], s54 offen  lds
  s_add_u32 m0, s57, 28672
  s_add_u32 s54, s78, 1441792
  buffer_load_dwordx4 v8, s[16:19], s54 offen  lds
  s_add_u32 m0, s57, 32768
  s_add_u32 s54, s78, 1572864
  buffer_load_dwordx4 v8, s[16:19], s54 offen  lds
  s_add_u32 m0, s57, 36864
  s_add_u32 s54, s78, 1703936
  buffer_load_dwordx4 v8, s[16:19], s54 offen  lds
  s_add_u32 m0, s57, 40960
  s_add_u32 s54, s78, 1835008
  buffer_load_dwordx4 v8, s[16:19], s54 offen  lds
  s_add_u32 m0, s57, 45056
  s_add_u32 s54, s78, 1966080
  buffer_load_dwordx4 v8, s[16:19], s54 offen  lds
  s_add_u32 m0, s57, 49152
  s_add_u32 s54, s78, 2097152
  buffer_load_dwordx4 v8, s[16:19], s54 offen  lds
  s_add_u32 m0, s57, 53248
  s_add_u32 s54, s78, 2228224
  buffer_load_dwordx4 v8, s[16:19], s54 offen  lds
  s_add_u32 m0, s57, 57344
  s_add_u32 s54, s78, 2359296
  buffer_load_dwordx4 v8, s[16:19], s54 offen  lds
  s_add_u32 m0, s57, 61440
  s_add_u32 s54, s78, 2490368
  buffer_load_dwordx4 v8, s[16:19], s54 offen  lds
  s_add_u32 m0, s57, 65536
  s_add_u32 s54, s78, 2621440
  buffer_load_dwordx4 v8, s[16:19], s54 offen  lds
  s_add_u32 m0, s57, 69632
  s_add_u32 s54, s78, 2752512
  buffer_load_dwordx4 v8, s[16:19], s54 offen  lds
  s_add_u32 m0, s57, 73728
  s_add_u32 s54, s78, 2883584
  buffer_load_dwordx4 v8, s[16:19], s54 offen  lds
  s_add_u32 m0, s57, 77824
  s_add_u32 s54, s78, 3014656
  buffer_load_dwordx4 v8, s[16:19], s54 offen  lds
  v_lshlrev_b32 v76, 4, v0
  v_add_u32 v75, 0x10000, v76
  v_lshrrev_b32 v3, 2, v1
  v_and_b32 v4, 1, v1
  v_lshl_add_u32 v3, v3, 1, v4
  v_bfe_u32 v4, v1, 1, 1
  v_mul_u32_u24 v74, 0xaaaa, v4
  v_add_u32 v74, 0x4444, v74
  v_mul_u32_u24 v5, 576, v3
  v_add_u32 v5, 0, v5
  v_lshl_add_u32 v78, v2, 4, v5
  v_lshl_add_u32 v77, v2, 5, v5
  v_lshl_add_u32 v77, v4, 4, v77
  v_mul_u32_u24 v15, 1152, v3
  v_lshl_add_u32 v15, v2, 5, v15
  v_lshl_add_u32 v15, v4, 4, v15
  s_lshl_b32 s54, s52, 8
  buffer_load_dwordx4 v[20:23], v15, s[32:35], s54 offen
  buffer_load_dwordx4 v[24:27], v15, s[32:35], s54 offen offset:128
  buffer_load_dwordx4 v[28:31], v15, s[32:35], 0 offen offset:1024
  v_mul_u32_u24 v79, 1152, v2
  v_lshl_add_u32 v79, v1, 2, v79
  s_lshl_b32 s54, s52, 6
  s_add_u32 s54, s54, 0
  v_add_u32 v79, s54, v79
  v_lshrrev_b32 v5, 3, v0
  v_mul_u32_u24 v68, 2176, v5
  v_and_b32 v5, 7, v0
  v_lshl_add_u32 v68, v5, 3, v68
  v_and_b32 v5, 1, v2
  v_lshlrev_b32 v5, 4, v5
  v_lshl_add_u32 v5, v1, 2, v5
  v_mov_b32 v6, 0x40000000
  v_cmp_lt_u32 vcc, 3, v1
  s_nop 1
  v_cndmask_b32 v5, v5, v6, vcc
  v_lshrrev_b32 v6, 1, v2
  v_lshl_add_u32 v69, v6, 10, v5
  v_lshl_add_u32 v70, v6, 8, v5
  v_mov_b32 v71, -1
  ds_write_b128 v76, v[68:71] offset:13824
  v_and_b32 v5, 3, v1
  v_lshrrev_b32 v6, 2, v1
  v_lshl_add_u32 v5, v5, 2, v6
  v_and_b32 v6, 1, v5
  v_lshlrev_b32 v6, 4, v6
  v_mov_b32 v7, 0x3f80
  v_lshlrev_b32 v6, v6, v7
  v_lshrrev_b32 v5, 1, v5
  v_cmp_eq_u32 vcc, 0, v5
  s_nop 1
  v_cndmask_b32 v40, 0, v6, vcc
  v_cmp_eq_u32 vcc, 1, v5
  s_nop 1
  v_cndmask_b32 v41, 0, v6, vcc
  v_cmp_eq_u32 vcc, 2, v5
  s_nop 1
  v_cndmask_b32 v42, 0, v6, vcc
  v_cmp_eq_u32 vcc, 3, v5
  s_nop 1
  v_cndmask_b32 v43, 0, v6, vcc
  ds_write_b128 v76, v[40:43] offset:14848
  s_and_b32 s54, s52, 1
  s_lshr_b32 s55, s52, 1
  v_lshrrev_b32 v3, 3, v0
  v_and_b32 v4, 1, v3
  v_lshlrev_b32 v4, 4, v4
  v_and_b32 v5, 6, v3
  v_add_u32 v4, v4, v5
  s_lshl_b32 s56, s55, 3
  s_add_u32 s56, s56, s54
  v_add_u32 v4, s56, v4
  v_mul_u32_u24 v4, 1152, v4
  v_and_b32 v5, 2, v3
  v_lshlrev_b32 v5, 1, v5
  v_and_b32 v6, 7, v0
  v_xor_b32 v6, v6, v5
  v_lshl_add_u32 v9, v6, 4, v4
  v_and_b32 v4, 1, v2
  v_lshlrev_b32 v4, 4, v4
  v_and_b32 v5, 2, v2
  v_add_u32 v4, v4, v5
  s_lshl_b32 s56, s55, 2
  s_add_u32 s56, s56, s54
  v_add_u32 v4, s56, v4
  v_mul_u32_u24 v4, 1152, v4
  v_lshlrev_b32 v6, 1, v2
  v_xor_b32 v6, v6, v1
  v_lshl_add_u32 v10, v6, 4, v4
  v_bfe_u32 v17, v1, 2, 1
  v_bfe_u32 v18, v1, 3, 1
  v_and_b32 v19, 1, v2
  v_lshrrev_b32 v72, 1, v2
  v_and_b32 v73, 3, v1
  v_lshl_add_u32 v3, v19, 1, v17
  v_lshl_add_u32 v6, v18, 2, v3
  v_lshl_add_u32 v4, v72, 4, v17
  v_lshl_add_u32 v4, v19, 2, v4
  v_lshl_add_u32 v4, v18, 3, v4
  v_lshlrev_b32 v4, 8, v4
  s_lshl_b32 s54, s52, 6
  v_lshl_add_u32 v5, v73, 3, s54
  v_lshlrev_b32 v7, 5, v6
  v_xor_b32 v5, v5, v7
  v_add_u32 v11, v4, v5
  v_xor_b32 v12, 32, v11
  v_lshl_add_u32 v4, v72, 2, v3
  v_lshlrev_b32 v4, 7, v4
  v_lshl_add_u32 v4, v73, 3, v4
  s_and_b32 s54, s52, 1
  v_xor_b32 v7, s54, v19
  v_lshl_add_u32 v7, v7, 1, v18
  v_lshl_add_u32 v13, v7, 5, v4
  v_lshlrev_b32 v4, 11, v72
  v_lshl_add_u32 v4, v73, 3, v4
  v_lshl_add_u32 v5, v3, 8, v4
  v_lshl_add_u32 v7, v18, 2, s52
  v_xor_b32 v7, v7, v3
  v_lshl_add_u32 v14, v7, 5, v5
  s_lshl_b32 s54, s53, 14
  s_lshl_b32 s55, s52, 11
  s_add_u32 s54, s54, 1048576
  s_add_u32 s58, s54, s55
  s_add_u32 s59, s58, 8192
  s_lshl_b32 s55, s52, 12
  s_add_u32 s70, s54, s55
  s_add_u32 s70, s70, 655360
  s_lshl_b32 s54, s53, 12
  s_lshl_b32 s55, s52, 10
  s_add_u32 s54, s54, s55
  s_add_u32 s68, s54, 917504
  s_lshl_b32 s54, s53, 6
  s_mul_i32 s55, s52, 17408
  s_add_u32 s55, s54, s55
  s_add_u32 s73, s55, 0
  s_add_u32 s74, s55, 69632
  s_add_u32 s75, s55, 139264
  s_add_u32 s76, s55, 208896
  s_and_b32 s56, s52, 1
  s_mul_i32 s55, s56, 17408
  s_add_u32 s55, s54, s55
  s_add_u32 s77, s55, 278528
  s_mul_i32 s54, s52, 69632
  s_mul_i32 s55, s53, 2176
  s_add_u32 s54, s54, s55
  s_add_u32 s60, s54, 0
  s_and_b32 s56, s53, 15
  s_mul_i32 s55, s56, 2176
  s_add_u32 s61, s55, 278528
  s_lshl_b32 s54, s52, 11
  s_add_u32 s64, s54, 360448
  s_mov_b32 s65, 368640
  s_lshl_b32 s55, s53, 5
  s_add_u32 s54, s54, s55
  s_add_u32 s62, s54, 376832
  s_lshr_b32 s54, s56, 3
  s_lshl_b32 s54, s54, 9
  s_and_b32 s55, s56, 7
  s_lshl_b32 s55, s55, 5
  s_add_u32 s54, s54, s55
  s_add_u32 s63, s54, 385024
  s_mov_b32 s66, 0
  s_mov_b32 s67, 0
  s_mov_b32 s72, 0
  s_mov_b32 s69, 1040356334
  s_waitcnt vmcnt(19) lgkmcnt(0)
  s_barrier
  s_add_u32 m0, s57, 81920
  s_add_u32 s54, s78, 3670016
  buffer_load_dwordx4 v8, s[16:19], s54 offen  lds
  s_add_u32 m0, s57, 86016
  s_add_u32 s54, s78, 3801088
  buffer_load_dwordx4 v8, s[16:19], s54 offen  lds
  s_add_u32 m0, s57, 90112
  s_add_u32 s54, s78, 3932160
  buffer_load_dwordx4 v8, s[16:19], s54 offen  lds
  s_add_u32 m0, s57, 94208
  s_add_u32 s54, s78, 4063232
  buffer_load_dwordx4 v8, s[16:19], s54 offen  lds
  v_add_u32 v15, 16384, v11
  v_add_u32 v16, 16384, v12
  ds_read_b64_tr_b16 v[80:81], v15 offset:0
  ds_read_b64_tr_b16 v[82:83], v15 offset:512
  ds_read_b64_tr_b16 v[84:85], v15 offset:8192
  ds_read_b64_tr_b16 v[86:87], v15 offset:8704
  ds_read_b64_tr_b16 v[88:89], v16 offset:0
  ds_read_b64_tr_b16 v[90:91], v16 offset:512
  ds_read_b64_tr_b16 v[92:93], v16 offset:8192
  ds_read_b64_tr_b16 v[94:95], v16 offset:8704
  s_waitcnt vmcnt(19) lgkmcnt(0)
  s_barrier
  s_add_u32 m0, s57, 98304
  s_add_u32 s54, s78, 4194304
  buffer_load_dwordx4 v8, s[16:19], s54 offen  lds
  s_add_u32 m0, s57, 102400
  s_add_u32 s54, s78, 4325376
  buffer_load_dwordx4 v8, s[16:19], s54 offen  lds
  s_add_u32 m0, s57, 106496
  s_add_u32 s54, s78, 4456448
  buffer_load_dwordx4 v8, s[16:19], s54 offen  lds
  s_add_u32 m0, s57, 110592
  s_add_u32 s54, s78, 4587520
  buffer_load_dwordx4 v8, s[16:19], s54 offen  lds
  v_add_u32 v15, 32768, v11
  v_add_u32 v16, 32768, v12
  ds_read_b64_tr_b16 v[96:97], v15 offset:0
  ds_read_b64_tr_b16 v[98:99], v15 offset:512
  ds_read_b64_tr_b16 v[100:101], v15 offset:8192
  ds_read_b64_tr_b16 v[102:103], v15 offset:8704
  ds_read_b64_tr_b16 v[104:105], v16 offset:0
  ds_read_b64_tr_b16 v[106:107], v16 offset:512
  ds_read_b64_tr_b16 v[108:109], v16 offset:8192
  ds_read_b64_tr_b16 v[110:111], v16 offset:8704
  s_waitcnt vmcnt(19) lgkmcnt(0)
  s_barrier
  s_add_u32 m0, s57, 114688
  s_add_u32 s54, s78, 524288
  buffer_load_dwordx4 v8, s[20:23], s54 offen  lds
  s_add_u32 m0, s57, 118784
  s_add_u32 s54, s78, 655360
  buffer_load_dwordx4 v8, s[20:23], s54 offen  lds
  s_add_u32 m0, s57, 122880
  s_add_u32 s54, s78, 786432
  buffer_load_dwordx4 v8, s[20:23], s54 offen  lds
  s_add_u32 m0, s57, 126976
  s_add_u32 s54, s78, 917504
  buffer_load_dwordx4 v8, s[20:23], s54 offen  lds
  v_add_u32 v15, 49152, v11
  v_add_u32 v16, 49152, v12
  ds_read_b64_tr_b16 v[112:113], v15 offset:0
  ds_read_b64_tr_b16 v[114:115], v15 offset:512
  ds_read_b64_tr_b16 v[116:117], v15 offset:8192
  ds_read_b64_tr_b16 v[118:119], v15 offset:8704
  ds_read_b64_tr_b16 v[120:121], v16 offset:0
  ds_read_b64_tr_b16 v[122:123], v16 offset:512
  ds_read_b64_tr_b16 v[124:125], v16 offset:8192
  ds_read_b64_tr_b16 v[126:127], v16 offset:8704
  s_waitcnt vmcnt(19) lgkmcnt(0)
  s_barrier
  s_add_u32 m0, s57, 131072
  s_add_u32 s54, s78, 1048576
  buffer_load_dwordx4 v8, s[20:23], s54 offen  lds
  s_add_u32 m0, s57, 135168
  s_add_u32 s54, s78, 1179648
  buffer_load_dwordx4 v8, s[20:23], s54 offen  lds
  s_add_u32 m0, s57, 139264
  s_add_u32 s54, s78, 1310720
  buffer_load_dwordx4 v8, s[20:23], s54 offen  lds
  s_add_u32 m0, s57, 143360
  s_add_u32 s54, s78, 1441792
  buffer_load_dwordx4 v8, s[20:23], s54 offen  lds
  v_add_u32 v15, 65536, v11
  v_add_u32 v16, 65536, v12
  ds_read_b64_tr_b16 v[128:129], v15 offset:0
  ds_read_b64_tr_b16 v[130:131], v15 offset:512
  ds_read_b64_tr_b16 v[132:133], v15 offset:8192
  ds_read_b64_tr_b16 v[134:135], v15 offset:8704
  ds_read_b64_tr_b16 v[136:137], v16 offset:0
  ds_read_b64_tr_b16 v[138:139], v16 offset:512
  ds_read_b64_tr_b16 v[140:141], v16 offset:8192
  ds_read_b64_tr_b16 v[142:143], v16 offset:8704
  s_waitcnt vmcnt(19) lgkmcnt(0)
  s_barrier
  s_add_u32 m0, s57, 0
  s_add_u32 s54, s78, 1572864
  buffer_load_dwordx4 v8, s[20:23], s54 offen  lds
  s_add_u32 m0, s57, 4096
  s_add_u32 s54, s78, 1703936
  buffer_load_dwordx4 v8, s[20:23], s54 offen  lds
  s_add_u32 m0, s57, 8192
  s_add_u32 s54, s78, 1835008
  buffer_load_dwordx4 v8, s[20:23], s54 offen  lds
  s_add_u32 m0, s57, 12288
  s_add_u32 s54, s78, 1966080
  buffer_load_dwordx4 v8, s[20:23], s54 offen  lds
  v_add_u32 v15, 81920, v11
  v_add_u32 v16, 81920, v12
  ds_read_b64_tr_b16 v[144:145], v15 offset:0
  ds_read_b64_tr_b16 v[146:147], v15 offset:512
  ds_read_b64_tr_b16 v[148:149], v15 offset:8192
  ds_read_b64_tr_b16 v[150:151], v15 offset:8704
  ds_read_b64_tr_b16 v[152:153], v16 offset:0
  ds_read_b64_tr_b16 v[154:155], v16 offset:512
  ds_read_b64_tr_b16 v[156:157], v16 offset:8192
  ds_read_b64_tr_b16 v[158:159], v16 offset:8704
  s_waitcnt vmcnt(16) lgkmcnt(0)
  s_barrier
  s_add_u32 m0, s57, 16384
  s_add_u32 s54, s78, 3145728
  buffer_load_dwordx4 v8, s[20:23], s54 offen  lds
  s_add_u32 m0, s57, 20480
  s_add_u32 s54, s78, 3276800
  buffer_load_dwordx4 v8, s[20:23], s54 offen  lds
  s_add_u32 m0, s57, 24576
  s_add_u32 s54, s78, 3407872
  buffer_load_dwordx4 v8, s[20:23], s54 offen  lds
  s_add_u32 m0, s57, 28672
  s_add_u32 s54, s78, 3538944
  buffer_load_dwordx4 v8, s[20:23], s54 offen  lds
  v_add_u32 v15, 98304, v11
  v_add_u32 v16, 98304, v12
  ds_read_b64_tr_b16 v[160:161], v15 offset:0
  ds_read_b64_tr_b16 v[162:163], v15 offset:512
  ds_read_b64_tr_b16 v[164:165], v15 offset:8192
  ds_read_b64_tr_b16 v[166:167], v15 offset:8704
  ds_read_b64_tr_b16 v[168:169], v16 offset:0
  ds_read_b64_tr_b16 v[170:171], v16 offset:512
  ds_read_b64_tr_b16 v[172:173], v16 offset:8192
  ds_read_b64_tr_b16 v[174:175], v16 offset:8704
  s_waitcnt vmcnt(16) lgkmcnt(0)
  s_barrier
  s_add_u32 m0, s57, 32768
  s_add_u32 s54, s78, 3670016
  buffer_load_dwordx4 v8, s[20:23], s54 offen  lds
  s_add_u32 m0, s57, 36864
  s_add_u32 s54, s78, 3801088
  buffer_load_dwordx4 v8, s[20:23], s54 offen  lds
  s_add_u32 m0, s57, 40960
  s_add_u32 s54, s78, 3932160
  buffer_load_dwordx4 v8, s[20:23], s54 offen  lds
  s_add_u32 m0, s57, 45056
  s_add_u32 s54, s78, 4063232
  buffer_load_dwordx4 v8, s[20:23], s54 offen  lds
  s_cmp_eq_u32 s1, 1
  s_cbranch_scc1 C_ver_ok
  v_mov_b32 v33, 16320
  s_cmp_eq_u32 s52, 0
  s_cbranch_scc0 C_ver_b
  s_waitcnt vmcnt(52)
  s_mov_b64 exec, 1
  ds_write_b32 v33, v35
  s_mov_b64 exec, -1
  s_waitcnt lgkmcnt(0)
C_ver_b:
  s_barrier
  ds_read_b32 v32, v33
  s_waitcnt lgkmcnt(0)
  v_readfirstlane_b32 s54, v32
  s_nop 0
  s_bitcmp1_b32 s54, s0
  s_cbranch_scc1 L_conf
C_ver_ok:
  v_add_u32 v15, 114688, v11
  v_add_u32 v16, 114688, v12
  ds_read_b64_tr_b16 v[176:177], v15 offset:0
  ds_read_b64_tr_b16 v[178:179], v15 offset:512
  ds_read_b64_tr_b16 v[180:181], v15 offset:8192
  ds_read_b64_tr_b16 v[182:183], v15 offset:8704
  ds_read_b64_tr_b16 v[184:185], v16 offset:0
  ds_read_b64_tr_b16 v[186:187], v16 offset:512
  ds_read_b64_tr_b16 v[188:189], v16 offset:8192
  ds_read_b64_tr_b16 v[190:191], v16 offset:8704
  s_waitcnt vmcnt(16) lgkmcnt(0)
  s_barrier
  s_add_u32 m0, s57, 49152
  s_add_u32 s54, s78, 4194304
  buffer_load_dwordx4 v8, s[20:23], s54 offen  lds
  s_add_u32 m0, s57, 53248
  s_add_u32 s54, s78, 4325376
  buffer_load_dwordx4 v8, s[20:23], s54 offen  lds
  s_add_u32 m0, s57, 57344
  s_add_u32 s54, s78, 4456448
  buffer_load_dwordx4 v8, s[20:23], s54 offen  lds
  s_add_u32 m0, s57, 61440
  s_add_u32 s54, s78, 4587520
  buffer_load_dwordx4 v8, s[20:23], s54 offen  lds
  v_add_u32 v15, 131072, v11
  v_add_u32 v16, 131072, v12
  ds_read_b64_tr_b16 v[192:193], v15 offset:0
  ds_read_b64_tr_b16 v[194:195], v15 offset:512
  ds_read_b64_tr_b16 v[196:197], v15 offset:8192
  ds_read_b64_tr_b16 v[198:199], v15 offset:8704
  ds_read_b64_tr_b16 v[200:201], v16 offset:0
  ds_read_b64_tr_b16 v[202:203], v16 offset:512
  ds_read_b64_tr_b16 v[204:205], v16 offset:8192
  ds_read_b64_tr_b16 v[206:207], v16 offset:8704
  s_waitcnt vmcnt(16) lgkmcnt(0)
  s_barrier
  s_add_u32 m0, s57, 65536
  s_add_u32 s54, s78, 0
  buffer_load_dwordx4 v8, s[24:27], s54 offen  lds
  s_add_u32 m0, s57, 69632
  s_add_u32 s54, s78, 131072
  buffer_load_dwordx4 v8, s[24:27], s54 offen  lds
  s_add_u32 m0, s57, 73728
  s_add_u32 s54, s78, 262144
  buffer_load_dwordx4 v8, s[24:27], s54 offen  lds
  s_add_u32 m0, s57, 77824
  s_add_u32 s54, s78, 393216
  buffer_load_dwordx4 v8, s[24:27], s54 offen  lds
  s_getpc_b64 s[80:81]
  v_lshlrev_b32 v7, 2, v76
  global_load_dword v35, v7, s[80:81] offset:1024
  v_min_u32 v20, -2, v20
  v_min_u32 v21, -2, v21
  v_min_u32 v22, -2, v22
  v_min_u32 v23, -2, v23
  v_min_u32 v24, -2, v24
  v_min_u32 v25, -2, v25
  v_min_u32 v26, -2, v26
  v_min_u32 v27, -2, v27
  v_min_u32 v28, -2, v28
  v_min_u32 v29, -2, v29
  v_min_u32 v30, -2, v30
  v_min_u32 v31, -2, v31
  s_lshl_b32 s54, s52, 11
  v_add_u32 v3, s54, v76
  ds_write_b128 v3, v[20:23] offset:4608
  ds_write_b128 v3, v[24:27] offset:5632
  ds_write_b128 v76, v[28:31] offset:12800
  v_add_u32 v15, 147456, v11
  v_add_u32 v16, 147456, v12
  ds_read_b64_tr_b16 v[208:209], v15 offset:0
  ds_read_b64_tr_b16 v[210:211], v15 offset:512
  ds_read_b64_tr_b16 v[212:213], v15 offset:8192
  ds_read_b64_tr_b16 v[214:215], v15 offset:8704
  ds_read_b64_tr_b16 v[216:217], v16 offset:0
  ds_read_b64_tr_b16 v[218:219], v16 offset:512
  ds_read_b64_tr_b16 v[220:221], v16 offset:8192
  ds_read_b64_tr_b16 v[222:223], v16 offset:8704
  s_waitcnt vmcnt(17) lgkmcnt(0)
  s_barrier
  s_add_u32 m0, s57, 81920
  s_add_u32 s54, s78, 524288
  buffer_load_dwordx4 v8, s[24:27], s54 offen  lds
  s_add_u32 m0, s57, 86016
  s_add_u32 s54, s78, 655360
  buffer_load_dwordx4 v8, s[24:27], s54 offen  lds
  s_add_u32 m0, s57, 90112
  s_add_u32 s54, s78, 786432
  buffer_load_dwordx4 v8, s[24:27], s54 offen  lds
  s_add_u32 m0, s57, 94208
  s_add_u32 s54, s78, 917504
  buffer_load_dwordx4 v8, s[24:27], s54 offen  lds
  v_add_u32 v15, 16384, v11
  v_add_u32 v16, 16384, v12
  ds_read_b64_tr_b16 v[224:225], v15 offset:0
  ds_read_b64_tr_b16 v[226:227], v15 offset:512
  ds_read_b64_tr_b16 v[228:229], v15 offset:8192
  ds_read_b64_tr_b16 v[230:231], v15 offset:8704
  ds_read_b64_tr_b16 v[232:233], v16 offset:0
  ds_read_b64_tr_b16 v[234:235], v16 offset:512
  ds_read_b64_tr_b16 v[236:237], v16 offset:8192
  ds_read_b64_tr_b16 v[238:239], v16 offset:8704
  s_waitcnt vmcnt(17) lgkmcnt(0)
  s_barrier
  s_add_u32 m0, s57, 98304
  s_add_u32 s54, s78, 1048576
  buffer_load_dwordx4 v8, s[24:27], s54 offen  lds
  s_add_u32 m0, s57, 102400
  s_add_u32 s54, s78, 1179648
  buffer_load_dwordx4 v8, s[24:27], s54 offen  lds
  s_add_u32 m0, s57, 106496
  s_add_u32 s54, s78, 1310720
  buffer_load_dwordx4 v8, s[24:27], s54 offen  lds
  s_add_u32 m0, s57, 110592
  s_add_u32 s54, s78, 1441792
  buffer_load_dwordx4 v8, s[24:27], s54 offen  lds
  v_add_u32 v15, 32768, v11
  v_add_u32 v16, 32768, v12
  ds_read_b64_tr_b16 v[240:241], v15 offset:0
  ds_read_b64_tr_b16 v[242:243], v15 offset:512
  ds_read_b64_tr_b16 v[244:245], v15 offset:8192
  ds_read_b64_tr_b16 v[246:247], v15 offset:8704
  ds_read_b64_tr_b16 v[248:249], v16 offset:0
  ds_read_b64_tr_b16 v[250:251], v16 offset:512
  ds_read_b64_tr_b16 v[252:253], v16 offset:8192
  ds_read_b64_tr_b16 v[254:255], v16 offset:8704
  s_waitcnt vmcnt(17) lgkmcnt(0)
  s_barrier
  s_add_u32 m0, s57, 114688
  s_add_u32 s54, s78, 1572864
  buffer_load_dwordx4 v8, s[24:27], s54 offen  lds
  s_add_u32 m0, s57, 118784
  s_add_u32 s54, s78, 1703936
  buffer_load_dwordx4 v8, s[24:27], s54 offen  lds
  s_add_u32 m0, s57, 122880
  s_add_u32 s54, s78, 1835008
  buffer_load_dwordx4 v8, s[24:27], s54 offen  lds
  s_add_u32 m0, s57, 126976
  s_add_u32 s54, s78, 1966080
  buffer_load_dwordx4 v8, s[24:27], s54 offen  lds
  v_add_u32 v15, 49152, v11
  v_add_u32 v16, 49152, v12
  ds_read_b64_tr_b16 a[0:1], v15 offset:0
  ds_read_b64_tr_b16 a[2:3], v15 offset:512
  ds_read_b64_tr_b16 a[4:5], v15 offset:8192
  ds_read_b64_tr_b16 a[6:7], v15 offset:8704
  ds_read_b64_tr_b16 a[8:9], v16 offset:0
  ds_read_b64_tr_b16 a[10:11], v16 offset:512
  ds_read_b64_tr_b16 a[12:13], v16 offset:8192
  ds_read_b64_tr_b16 a[14:15], v16 offset:8704
  s_waitcnt vmcnt(17) lgkmcnt(0)
  s_barrier
  s_add_u32 m0, s57, 131072
  s_add_u32 s54, s78, 2097152
  buffer_load_dwordx4 v8, s[24:27], s54 offen  lds
  s_add_u32 m0, s57, 135168
  s_add_u32 s54, s78, 2228224
  buffer_load_dwordx4 v8, s[24:27], s54 offen  lds
  s_add_u32 m0, s57, 139264
  s_add_u32 s54, s78, 2359296
  buffer_load_dwordx4 v8, s[24:27], s54 offen  lds
  s_add_u32 m0, s57, 143360
  s_add_u32 s54, s78, 2490368
  buffer_load_dwordx4 v8, s[24:27], s54 offen  lds
  v_add_u32 v15, 65536, v11
  v_add_u32 v16, 65536, v12
  ds_read_b64_tr_b16 a[16:17], v15 offset:0
  ds_read_b64_tr_b16 a[18:19], v15 offset:512
  ds_read_b64_tr_b16 a[20:21], v15 offset:8192
  ds_read_b64_tr_b16 a[22:23], v15 offset:8704
  ds_read_b64_tr_b16 a[24:25], v16 offset:0
  ds_read_b64_tr_b16 a[26:27], v16 offset:512
  ds_read_b64_tr_b16 a[28:29], v16 offset:8192
  ds_read_b64_tr_b16 a[30:31], v16 offset:8704
  s_waitcnt vmcnt(17) lgkmcnt(0)
  s_barrier
  s_add_u32 m0, s57, 0
  s_add_u32 s54, s78, 2621440
  buffer_load_dwordx4 v8, s[24:27], s54 offen  lds
  s_add_u32 m0, s57, 4096
  s_add_u32 s54, s78, 2752512
  buffer_load_dwordx4 v8, s[24:27], s54 offen  lds
  s_add_u32 m0, s57, 8192
  s_add_u32 s54, s78, 2883584
  buffer_load_dwordx4 v8, s[24:27], s54 offen  lds
  s_add_u32 m0, s57, 12288
  s_add_u32 s54, s78, 3014656
  buffer_load_dwordx4 v8, s[24:27], s54 offen  lds
  v_add_u32 v15, 81920, v11
  v_add_u32 v16, 81920, v12
  ds_read_b64_tr_b16 a[32:33], v15 offset:0
  ds_read_b64_tr_b16 a[34:35], v15 offset:512
  ds_read_b64_tr_b16 a[36:37], v15 offset:8192
  ds_read_b64_tr_b16 a[38:39], v15 offset:8704
  ds_read_b64_tr_b16 a[40:41], v16 offset:0
  ds_read_b64_tr_b16 a[42:43], v16 offset:512
  ds_read_b64_tr_b16 a[44:45], v16 offset:8192
  ds_read_b64_tr_b16 a[46:47], v16 offset:8704
  s_waitcnt vmcnt(16) lgkmcnt(0)
  s_barrier
  s_add_u32 m0, s57, 16384
  s_add_u32 s54, s78, 3145728
  buffer_load_dwordx4 v8, s[24:27], s54 offen  lds
  s_add_u32 m0, s57, 20480
  s_add_u32 s54, s78, 3276800
  buffer_load_dwordx4 v8, s[24:27], s54 offen  lds
  s_add_u32 m0, s57, 24576
  s_add_u32 s54, s78, 3407872
  buffer_load_dwordx4 v8, s[24:27], s54 offen  lds
  s_add_u32 m0, s57, 28672
  s_add_u32 s54, s78, 3538944
  buffer_load_dwordx4 v8, s[24:27], s54 offen  lds
  s_getpc_b64 s[80:81]
  v_lshlrev_b32 v7, 2, v76
  global_load_dword v35, v7, s[80:81] offset:1024
  v_add_u32 v15, 98304, v11
  v_add_u32 v16, 98304, v12
  ds_read_b64_tr_b16 a[48:49], v15 offset:0
  ds_read_b64_tr_b16 a[50:51], v15 offset:512
  ds_read_b64_tr_b16 a[52:53], v15 offset:8192
  ds_read_b64_tr_b16 a[54:55], v15 offset:8704
  ds_read_b64_tr_b16 a[56:57], v16 offset:0
  ds_read_b64_tr_b16 a[58:59], v16 offset:512
  ds_read_b64_tr_b16 a[60:61], v16 offset:8192
  ds_read_b64_tr_b16 a[62:63], v16 offset:8704
  s_waitcnt vmcnt(17) lgkmcnt(0)
  s_barrier
  s_add_u32 m0, s57, 32768
  s_add_u32 s54, s78, 3670016
  buffer_load_dwordx4 v8, s[24:27], s54 offen  lds
  s_add_u32 m0, s57, 36864
  s_add_u32 s54, s78, 3801088
  buffer_load_dwordx4 v8, s[24:27], s54 offen  lds
  s_add_u32 m0, s57, 40960
  s_add_u32 s54, s78, 3932160
  buffer_load_dwordx4 v8, s[24:27], s54 offen  lds
  s_add_u32 m0, s57, 45056
  s_add_u32 s54, s78, 4063232
  buffer_load_dwordx4 v8, s[24:27], s54 offen  lds
  v_add_u32 v15, 114688, v11
  v_add_u32 v16, 114688, v12
  ds_read_b64_tr_b16 a[64:65], v15 offset:0
  ds_read_b64_tr_b16 a[66:67], v15 offset:512
  ds_read_b64_tr_b16 a[68:69], v15 offset:8192
  ds_read_b64_tr_b16 a[70:71], v15 offset:8704
  ds_read_b64_tr_b16 a[72:73], v16 offset:0
  ds_read_b64_tr_b16 a[74:75], v16 offset:512
  ds_read_b64_tr_b16 a[76:77], v16 offset:8192
  ds_read_b64_tr_b16 a[78:79], v16 offset:8704
  s_waitcnt vmcnt(17) lgkmcnt(0)
  s_barrier
  s_add_u32 m0, s57, 49152
  s_add_u32 s54, s78, 4194304
  buffer_load_dwordx4 v8, s[24:27], s54 offen  lds
  s_add_u32 m0, s57, 53248
  s_add_u32 s54, s78, 4325376
  buffer_load_dwordx4 v8, s[24:27], s54 offen  lds
  s_add_u32 m0, s57, 57344
  s_add_u32 s54, s78, 4456448
  buffer_load_dwordx4 v8, s[24:27], s54 offen  lds
  s_add_u32 m0, s57, 61440
  s_add_u32 s54, s78, 4587520
  buffer_load_dwordx4 v8, s[24:27], s54 offen  lds
  v_add_u32 v15, 131072, v11
  v_add_u32 v16, 131072, v12
  ds_read_b64_tr_b16 a[80:81], v15 offset:0
  ds_read_b64_tr_b16 a[82:83], v15 offset:512
  ds_read_b64_tr_b16 a[84:85], v15 offset:8192
  ds_read_b64_tr_b16 a[86:87], v15 offset:8704
  ds_read_b64_tr_b16 a[88:89], v16 offset:0
  ds_read_b64_tr_b16 a[90:91], v16 offset:512
  ds_read_b64_tr_b16 a[92:93], v16 offset:8192
  ds_read_b64_tr_b16 a[94:95], v16 offset:8704
  s_waitcnt vmcnt(17) lgkmcnt(0)
  s_barrier
  s_add_u32 m0, s57, 65536
  s_add_u32 s54, s79, 73728
  buffer_load_dwordx4 v10, s[28:31], s54 offen  lds
  s_add_u32 m0, s57, 69632
  s_add_u32 s54, s79, 82944
  buffer_load_dwordx4 v10, s[28:31], s54 offen  lds
  s_add_u32 m0, s57, 73728
  s_add_u32 s54, s79, 110592
  buffer_load_dwordx4 v10, s[28:31], s54 offen  lds
  s_add_u32 m0, s57, 77824
  s_add_u32 s54, s79, 119808
  buffer_load_dwordx4 v10, s[28:31], s54 offen  lds
  v_add_u32 v15, 147456, v11
  v_add_u32 v16, 147456, v12
  ds_read_b64_tr_b16 a[96:97], v15 offset:0
  ds_read_b64_tr_b16 a[98:99], v15 offset:512
  ds_read_b64_tr_b16 a[100:101], v15 offset:8192
  ds_read_b64_tr_b16 a[102:103], v15 offset:8704
  ds_read_b64_tr_b16 a[104:105], v16 offset:0
  ds_read_b64_tr_b16 a[106:107], v16 offset:512
  ds_read_b64_tr_b16 a[108:109], v16 offset:8192
  ds_read_b64_tr_b16 a[110:111], v16 offset:8704
  s_waitcnt vmcnt(17) lgkmcnt(0)
  s_barrier
  s_add_u32 m0, s57, 81920
  s_add_u32 s54, s79, 256
  buffer_load_dwordx4 v10, s[28:31], s54 offen  lds
  s_add_u32 m0, s57, 86016
  s_add_u32 s54, s79, 9472
  buffer_load_dwordx4 v10, s[28:31], s54 offen  lds
  s_add_u32 m0, s57, 90112
  s_add_u32 s54, s79, 37120
  buffer_load_dwordx4 v10, s[28:31], s54 offen  lds
  s_add_u32 m0, s57, 94208
  s_add_u32 s54, s79, 46336
  buffer_load_dwordx4 v10, s[28:31], s54 offen  lds
  v_add_u32 v15, 16384, v11
  v_add_u32 v16, 16384, v12
  ds_read_b64_tr_b16 a[112:113], v15 offset:0
  ds_read_b64_tr_b16 a[114:115], v15 offset:512
  ds_read_b64_tr_b16 a[116:117], v15 offset:8192
  ds_read_b64_tr_b16 a[118:119], v15 offset:8704
  ds_read_b64_tr_b16 a[120:121], v16 offset:0
  ds_read_b64_tr_b16 a[122:123], v16 offset:512
  ds_read_b64_tr_b16 a[124:125], v16 offset:8192
  ds_read_b64_tr_b16 a[126:127], v16 offset:8704
  s_waitcnt vmcnt(17) lgkmcnt(0)
  s_barrier
  s_add_u32 m0, s57, 98304
  s_add_u32 s54, s79, 512
  buffer_load_dwordx4 v10, s[28:31], s54 offen  lds
  s_add_u32 m0, s57, 102400
  s_add_u32 s54, s79, 9728
  buffer_load_dwordx4 v10, s[28:31], s54 offen  lds
  s_add_u32 m0, s57, 106496
  s_add_u32 s54, s79, 37376
  buffer_load_dwordx4 v10, s[28:31], s54 offen  lds
  s_add_u32 m0, s57, 110592
  s_add_u32 s54, s79, 46592
  buffer_load_dwordx4 v10, s[28:31], s54 offen  lds
  v_add_u32 v15, 32768, v11
  v_add_u32 v16, 32768, v12
  ds_read_b64_tr_b16 a[128:129], v15 offset:0
  ds_read_b64_tr_b16 a[130:131], v15 offset:512
  ds_read_b64_tr_b16 a[132:133], v15 offset:8192
  ds_read_b64_tr_b16 a[134:135], v15 offset:8704
  ds_read_b64_tr_b16 a[136:137], v16 offset:0
  ds_read_b64_tr_b16 a[138:139], v16 offset:512
  ds_read_b64_tr_b16 a[140:141], v16 offset:8192
  ds_read_b64_tr_b16 a[142:143], v16 offset:8704
  s_waitcnt vmcnt(16) lgkmcnt(0)
  s_barrier
  s_add_u32 m0, s57, 114688
  s_add_u32 s54, s79, 768
  buffer_load_dwordx4 v10, s[28:31], s54 offen  lds
  s_add_u32 m0, s57, 118784
  s_add_u32 s54, s79, 9984
  buffer_load_dwordx4 v10, s[28:31], s54 offen  lds
  s_add_u32 m0, s57, 122880
  s_add_u32 s54, s79, 37632
  buffer_load_dwordx4 v10, s[28:31], s54 offen  lds
  s_add_u32 m0, s57, 126976
  s_add_u32 s54, s79, 46848
  buffer_load_dwordx4 v10, s[28:31], s54 offen  lds
  s_getpc_b64 s[80:81]
  v_lshlrev_b32 v7, 2, v76
  global_load_dword v35, v7, s[80:81] offset:1024
  v_add_u32 v15, 49152, v11
  v_add_u32 v16, 49152, v12
  ds_read_b64_tr_b16 a[144:145], v15 offset:0
  ds_read_b64_tr_b16 a[146:147], v15 offset:512
  ds_read_b64_tr_b16 a[148:149], v15 offset:8192
  ds_read_b64_tr_b16 a[150:151], v15 offset:8704
  ds_read_b64_tr_b16 a[152:153], v16 offset:0
  ds_read_b64_tr_b16 a[154:155], v16 offset:512
  ds_read_b64_tr_b16 a[156:157], v16 offset:8192
  ds_read_b64_tr_b16 a[158:159], v16 offset:8704
  s_waitcnt vmcnt(17) lgkmcnt(0)
  s_barrier
  s_add_u32 m0, s57, 131072
  s_add_u32 s54, s79, 74496
  buffer_load_dwordx4 v10, s[28:31], s54 offen  lds
  s_add_u32 m0, s57, 135168
  s_add_u32 s54, s79, 83712
  buffer_load_dwordx4 v10, s[28:31], s54 offen  lds
  s_add_u32 m0, s57, 139264
  s_add_u32 s54, s79, 111360
  buffer_load_dwordx4 v10, s[28:31], s54 offen  lds
  s_add_u32 m0, s57, 143360
  s_add_u32 s54, s79, 120576
  buffer_load_dwordx4 v10, s[28:31], s54 offen  lds
  v_add_u32 v15, 65536, v11
  v_add_u32 v16, 65536, v12
  ds_read_b64_tr_b16 a[160:161], v15 offset:0
  ds_read_b64_tr_b16 a[162:163], v15 offset:512
  ds_read_b64_tr_b16 a[164:165], v15 offset:8192
  ds_read_b64_tr_b16 a[166:167], v15 offset:8704
  ds_read_b64_tr_b16 a[168:169], v16 offset:0
  ds_read_b64_tr_b16 a[170:171], v16 offset:512
  ds_read_b64_tr_b16 a[172:173], v16 offset:8192
  ds_read_b64_tr_b16 a[174:175], v16 offset:8704
  s_waitcnt vmcnt(17) lgkmcnt(0)
  s_barrier
  s_add_u32 m0, s57, 0
  s_add_u32 s54, s78, 0
  buffer_load_dwordx4 v8, s[16:19], s54 offen  lds
  s_add_u32 m0, s57, 4096
  s_add_u32 s54, s78, 131072
  buffer_load_dwordx4 v8, s[16:19], s54 offen  lds
  s_add_u32 m0, s57, 8192
  s_add_u32 s54, s78, 262144
  buffer_load_dwordx4 v8, s[16:19], s54 offen  lds
  s_add_u32 m0, s57, 12288
  s_add_u32 s54, s78, 393216
  buffer_load_dwordx4 v8, s[16:19], s54 offen  lds
  v_add_u32 v15, 81920, v14
  ds_read_b64_tr_b16 a[176:177], v15 offset:0
  ds_read_b64_tr_b16 a[178:179], v15 offset:1024
  ds_read_b64_tr_b16 a[180:181], v15 offset:4096
  ds_read_b64_tr_b16 a[182:183], v15 offset:5120
  ds_read_b64_tr_b16 a[184:185], v15 offset:8192
  ds_read_b64_tr_b16 a[186:187], v15 offset:9216
  ds_read_b64_tr_b16 a[188:189], v15 offset:12288
  ds_read_b64_tr_b16 a[190:191], v15 offset:13312
  s_waitcnt vmcnt(17) lgkmcnt(0)
  s_barrier
  s_add_u32 m0, s57, 16384
  s_add_u32 s54, s78, 0
  buffer_load_dwordx4 v8, s[20:23], s54 offen  lds
  s_add_u32 m0, s57, 20480
  s_add_u32 s54, s78, 131072
  buffer_load_dwordx4 v8, s[20:23], s54 offen  lds
  s_add_u32 m0, s57, 24576
  s_add_u32 s54, s78, 262144
  buffer_load_dwordx4 v8, s[20:23], s54 offen  lds
  s_add_u32 m0, s57, 28672
  s_add_u32 s54, s78, 393216
  buffer_load_dwordx4 v8, s[20:23], s54 offen  lds
  v_add_u32 v15, 98304, v14
  ds_read_b64_tr_b16 a[192:193], v15 offset:0
  ds_read_b64_tr_b16 a[194:195], v15 offset:1024
  ds_read_b64_tr_b16 a[196:197], v15 offset:4096
  ds_read_b64_tr_b16 a[198:199], v15 offset:5120
  ds_read_b64_tr_b16 a[200:201], v15 offset:8192
  ds_read_b64_tr_b16 a[202:203], v15 offset:9216
  ds_read_b64_tr_b16 a[204:205], v15 offset:12288
  ds_read_b64_tr_b16 a[206:207], v15 offset:13312
  s_waitcnt vmcnt(17) lgkmcnt(0)
  s_barrier
  s_add_u32 m0, s57, 32768
  s_add_u32 s54, s78, 2097152
  buffer_load_dwordx4 v8, s[20:23], s54 offen  lds
  s_add_u32 m0, s57, 36864
  s_add_u32 s54, s78, 2228224
  buffer_load_dwordx4 v8, s[20:23], s54 offen  lds
  s_add_u32 m0, s57, 40960
  s_add_u32 s54, s78, 2359296
  buffer_load_dwordx4 v8, s[20:23], s54 offen  lds
  s_add_u32 m0, s57, 45056
  s_add_u32 s54, s78, 2490368
  buffer_load_dwordx4 v8, s[20:23], s54 offen  lds
  v_add_u32 v15, 114688, v14
  ds_read_b64_tr_b16 a[208:209], v15 offset:0
  ds_read_b64_tr_b16 a[210:211], v15 offset:1024
  ds_read_b64_tr_b16 a[212:213], v15 offset:4096
  ds_read_b64_tr_b16 a[214:215], v15 offset:5120
  ds_read_b64_tr_b16 a[216:217], v15 offset:8192
  ds_read_b64_tr_b16 a[218:219], v15 offset:9216
  ds_read_b64_tr_b16 a[220:221], v15 offset:12288
  ds_read_b64_tr_b16 a[222:223], v15 offset:13312
  s_waitcnt vmcnt(17) lgkmcnt(0)
  s_barrier
  s_add_u32 m0, s57, 49152
  s_add_u32 s54, s78, 3145728
  buffer_load_dwordx4 v8, s[16:19], s54 offen  lds
  s_add_u32 m0, s57, 53248
  s_add_u32 s54, s78, 3276800
  buffer_load_dwordx4 v8, s[16:19], s54 offen  lds
  s_add_u32 m0, s57, 57344
  s_add_u32 s54, s78, 3407872
  buffer_load_dwordx4 v8, s[16:19], s54 offen  lds
  s_add_u32 m0, s57, 61440
  s_add_u32 s54, s78, 3538944
  buffer_load_dwordx4 v8, s[16:19], s54 offen  lds
  v_add_u32 v15, 131072, v14
  ds_read_b64_tr_b16 a[224:225], v15 offset:0
  ds_read_b64_tr_b16 a[226:227], v15 offset:1024
  ds_read_b64_tr_b16 a[228:229], v15 offset:4096
  ds_read_b64_tr_b16 a[230:231], v15 offset:5120
  ds_read_b64_tr_b16 a[232:233], v15 offset:8192
  ds_read_b64_tr_b16 a[234:235], v15 offset:9216
  ds_read_b64_tr_b16 a[236:237], v15 offset:12288
  ds_read_b64_tr_b16 a[238:239], v15 offset:13312
  s_waitcnt vmcnt(16) lgkmcnt(0)
  s_barrier
  s_add_u32 m0, s57, 65536
  s_add_u32 s54, s78, 2621440
  buffer_load_dwordx4 v8, s[20:23], s54 offen  lds
  s_add_u32 m0, s57, 69632
  s_add_u32 s54, s78, 2752512
  buffer_load_dwordx4 v8, s[20:23], s54 offen  lds
  s_add_u32 m0, s57, 73728
  s_add_u32 s54, s78, 2883584
  buffer_load_dwordx4 v8, s[20:23], s54 offen  lds
  s_add_u32 m0, s57, 77824
  s_add_u32 s54, s78, 3014656
  buffer_load_dwordx4 v8, s[20:23], s54 offen  lds
  v_add_u32 v15, 147456, v14
  ds_read_b64_tr_b16 a[240:241], v15 offset:0
  ds_read_b64_tr_b16 a[242:243], v15 offset:1024
  ds_read_b64_tr_b16 a[244:245], v15 offset:4096
  ds_read_b64_tr_b16 a[246:247], v15 offset:5120
  ds_read_b64_tr_b16 a[248:249], v15 offset:8192
  ds_read_b64_tr_b16 a[250:251], v15 offset:9216
  ds_read_b64_tr_b16 a[252:253], v15 offset:12288
  ds_read_b64_tr_b16 a[254:255], v15 offset:13312
  s_waitcnt vmcnt(16) lgkmcnt(0)
  s_barrier
  s_add_u32 m0, s57, 81920
  s_add_u32 s54, s79, 1024
  buffer_load_dwordx4 v9, s[28:31], s54 offen  lds
  s_add_u32 m0, s57, 86016
  s_add_u32 s54, s79, 37888
  buffer_load_dwordx4 v9, s[28:31], s54 offen  lds
  s_add_u32 m0, s57, 90112
  s_add_u32 s54, s79, 74752
  buffer_load_dwordx4 v9, s[28:31], s54 offen  lds
  s_add_u32 m0, s57, 94208
  s_add_u32 s54, s79, 111616
  buffer_load_dwordx4 v9, s[28:31], s54 offen  lds
  v_add_u32 v15, 16384, v11
  v_add_u32 v16, 16384, v12
  ds_read_b64_tr_b16 v[52:53], v15 offset:0
  ds_read_b64_tr_b16 v[54:55], v15 offset:512
  ds_read_b64_tr_b16 v[56:57], v15 offset:8192
  ds_read_b64_tr_b16 v[58:59], v15 offset:8704
  ds_read_b64_tr_b16 v[60:61], v16 offset:0
  ds_read_b64_tr_b16 v[62:63], v16 offset:512
  ds_read_b64_tr_b16 v[64:65], v16 offset:8192
  ds_read_b64_tr_b16 v[66:67], v16 offset:8704
  s_waitcnt vmcnt(16) lgkmcnt(0)
  s_barrier
  s_lshl_b32 s54, s52, 12
  s_add_u32 s54, s54, 16384
  v_add_u32 v7, s54, v76
  ds_write_b128 v7, v[52:55] offset:0
  ds_write_b128 v7, v[56:59] offset:1024
  ds_write_b128 v7, v[60:63] offset:2048
  ds_write_b128 v7, v[64:67] offset:3072
  s_add_u32 m0, s57, 98304
  s_add_u32 s54, s79, 0
  buffer_load_dwordx4 v10, s[28:31], s54 offen  lds
  s_add_u32 m0, s57, 102400
  s_add_u32 s54, s79, 9216
  buffer_load_dwordx4 v10, s[28:31], s54 offen  lds
  s_add_u32 m0, s57, 106496
  s_add_u32 s54, s79, 36864
  buffer_load_dwordx4 v10, s[28:31], s54 offen  lds
  s_add_u32 m0, s57, 110592
  s_add_u32 s54, s79, 46080
  buffer_load_dwordx4 v10, s[28:31], s54 offen  lds
  v_add_u32 v15, 32768, v11
  v_add_u32 v16, 32768, v12
  ds_read_b64_tr_b16 v[36:37], v15 offset:0
  ds_read_b64_tr_b16 v[38:39], v15 offset:512
  ds_read_b64_tr_b16 v[40:41], v15 offset:8192
  ds_read_b64_tr_b16 v[42:43], v15 offset:8704
  ds_read_b64_tr_b16 v[44:45], v16 offset:0
  ds_read_b64_tr_b16 v[46:47], v16 offset:512
  ds_read_b64_tr_b16 v[48:49], v16 offset:8192
  ds_read_b64_tr_b16 v[50:51], v16 offset:8704
  s_waitcnt vmcnt(16) lgkmcnt(0)
  s_barrier
  s_lshl_b32 s54, s52, 12
  s_add_u32 s54, s54, 32768
  v_add_u32 v7, s54, v76
  ds_write_b128 v7, v[36:39] offset:0
  ds_write_b128 v7, v[40:43] offset:1024
  ds_write_b128 v7, v[44:47] offset:2048
  ds_write_b128 v7, v[48:51] offset:3072
  s_add_u32 m0, s57, 114688
  s_add_u32 s54, s79, 73984
  buffer_load_dwordx4 v10, s[28:31], s54 offen  lds
  s_add_u32 m0, s57, 118784
  s_add_u32 s54, s79, 83200
  buffer_load_dwordx4 v10, s[28:31], s54 offen  lds
  s_add_u32 m0, s57, 122880
  s_add_u32 s54, s79, 110848
  buffer_load_dwordx4 v10, s[28:31], s54 offen  lds
  s_add_u32 m0, s57, 126976
  s_add_u32 s54, s79, 120064
  buffer_load_dwordx4 v10, s[28:31], s54 offen  lds
  v_add_u32 v15, 49152, v11
  v_add_u32 v16, 49152, v12
  ds_read_b64_tr_b16 v[52:53], v15 offset:0
  ds_read_b64_tr_b16 v[54:55], v15 offset:512
  ds_read_b64_tr_b16 v[56:57], v15 offset:8192
  ds_read_b64_tr_b16 v[58:59], v15 offset:8704
  ds_read_b64_tr_b16 v[60:61], v16 offset:0
  ds_read_b64_tr_b16 v[62:63], v16 offset:512
  ds_read_b64_tr_b16 v[64:65], v16 offset:8192
  ds_read_b64_tr_b16 v[66:67], v16 offset:8704
  s_waitcnt vmcnt(16) lgkmcnt(0)
  s_barrier
  s_lshl_b32 s54, s52, 12
  s_add_u32 s54, s54, 49152
  v_add_u32 v7, s54, v76
  ds_write_b128 v7, v[52:55] offset:0
  ds_write_b128 v7, v[56:59] offset:1024
  ds_write_b128 v7, v[60:63] offset:2048
  ds_write_b128 v7, v[64:67] offset:3072
  s_add_u32 m0, s57, 131072
  s_add_u32 s54, s79, 74240
  buffer_load_dwordx4 v10, s[28:31], s54 offen  lds
  s_add_u32 m0, s57, 135168
  s_add_u32 s54, s79, 83456
  buffer_load_dwordx4 v10, s[28:31], s54 offen  lds
  s_add_u32 m0, s57, 139264
  s_add_u32 s54, s79, 111104
  buffer_load_dwordx4 v10, s[28:31], s54 offen  lds
  s_add_u32 m0, s57, 143360
  s_add_u32 s54, s79, 120320
  buffer_load_dwordx4 v10, s[28:31], s54 offen  lds
  v_lshlrev_b32 v7, 3, v76
  s_lshl_b32 s54, s52, 13
  s_add_u32 s54, s54, 360448
  s_bitcmp1_b32 s52, 0
  s_cselect_b64 exec, 0xff, -1
  buffer_load_dword v35, v7, s[8:11], s54 offen sc1
  s_mov_b64 exec, -1
  s_getpc_b64 s[80:81]
C_pc:
  s_mov_b32 s55, (L_w0 - C_pc)
  s_cmp_eq_u32 s52, 1
  s_cselect_b32 s55, (L_w1 - C_pc), s55
  s_cmp_eq_u32 s52, 2
  s_cselect_b32 s55, (L_w2 - C_pc), s55
  s_cmp_eq_u32 s52, 3
  s_cselect_b32 s55, (L_w3 - C_pc), s55
  v_lshl_add_u32 v7, v76, 3, s55
  global_load_dword v35, v7, s[80:81]
  v_add_u32 v15, 65536, v11
  v_add_u32 v16, 65536, v12
  ds_read_b64_tr_b16 v[36:37], v15 offset:0
  ds_read_b64_tr_b16 v[38:39], v15 offset:512
  ds_read_b64_tr_b16 v[40:41], v15 offset:8192
  ds_read_b64_tr_b16 v[42:43], v15 offset:8704
  ds_read_b64_tr_b16 v[44:45], v16 offset:0
  ds_read_b64_tr_b16 v[46:47], v16 offset:512
  ds_read_b64_tr_b16 v[48:49], v16 offset:8192
  ds_read_b64_tr_b16 v[50:51], v16 offset:8704
  s_waitcnt vmcnt(18) lgkmcnt(0)
  s_barrier
  s_lshl_b32 s54, s52, 12
  s_add_u32 s54, s54, 65536
  v_add_u32 v7, s54, v76
  ds_write_b128 v7, v[36:39] offset:0
  ds_write_b128 v7, v[40:43] offset:1024
  ds_write_b128 v7, v[44:47] offset:2048
  ds_write_b128 v7, v[48:51] offset:3072
  v_lshrrev_b32 v20, 2, v76
  buffer_load_dword v21, v20, s[12:15], 0 offen sc1
  v_add_u32 v15, 81920, v11
  v_add_u32 v16, 81920, v12
  ds_read_b64_tr_b16 v[52:53], v15 offset:0
  ds_read_b64_tr_b16 v[54:55], v15 offset:512
  ds_read_b64_tr_b16 v[56:57], v15 offset:8192
  ds_read_b64_tr_b16 v[58:59], v15 offset:8704
  ds_read_b64_tr_b16 v[60:61], v16 offset:0
  ds_read_b64_tr_b16 v[62:63], v16 offset:512
  ds_read_b64_tr_b16 v[64:65], v16 offset:8192
  ds_read_b64_tr_b16 v[66:67], v16 offset:8704
  s_waitcnt vmcnt(15) lgkmcnt(0)
  s_barrier
  s_lshl_b32 s54, s52, 12
  s_add_u32 s54, s54, 81920
  v_add_u32 v7, s54, v76
  ds_write_b128 v7, v[52:55] offset:0
  ds_write_b128 v7, v[56:59] offset:1024
  ds_write_b128 v7, v[60:63] offset:2048
  ds_write_b128 v7, v[64:67] offset:3072
  v_add_u32 v15, 98304, v13
  s_waitcnt lgkmcnt(0)
  ds_read_b64_tr_b16 v[36:37], v15 offset:0
  ds_read_b64_tr_b16 v[38:39], v15 offset:1024
  ds_read_b64_tr_b16 v[40:41], v15 offset:2048
  ds_read_b64_tr_b16 v[42:43], v15 offset:3072
  ds_read_b64_tr_b16 v[44:45], v15 offset:4096
  ds_read_b64_tr_b16 v[46:47], v15 offset:5120
  ds_read_b64_tr_b16 v[48:49], v15 offset:6144
  ds_read_b64_tr_b16 v[50:51], v15 offset:7168
  ds_read_b64_tr_b16 v[52:53], v15 offset:8192
  ds_read_b64_tr_b16 v[54:55], v15 offset:9216
  ds_read_b64_tr_b16 v[56:57], v15 offset:10240
  ds_read_b64_tr_b16 v[58:59], v15 offset:11264
  ds_read_b64_tr_b16 v[60:61], v15 offset:12288
  ds_read_b64_tr_b16 v[62:63], v15 offset:13312
  ds_read_b64_tr_b16 v[64:65], v15 offset:14336
  ds_read_b64_tr_b16 v[66:67], v15 offset:15360
  s_waitcnt vmcnt(11) lgkmcnt(0)
  s_barrier
  s_and_b32 s54, s52, 1
  s_lshl_b32 s54, s54, 13
  s_add_u32 s54, s54, 98304
  v_add_u32 v7, s54, v76
  ds_write_b128 v7, v[36:39] offset:0
  ds_write_b128 v7, v[40:43] offset:1024
  ds_write_b128 v7, v[44:47] offset:2048
  ds_write_b128 v7, v[48:51] offset:3072
  ds_write_b128 v7, v[52:55] offset:4096
  ds_write_b128 v7, v[56:59] offset:5120
  ds_write_b128 v7, v[60:63] offset:6144
  ds_write_b128 v7, v[64:67] offset:7168
  v_add_u32 v15, 114688, v14
  ds_read_b64_tr_b16 v[52:53], v15 offset:0
  ds_read_b64_tr_b16 v[54:55], v15 offset:1024
  ds_read_b64_tr_b16 v[56:57], v15 offset:4096
  ds_read_b64_tr_b16 v[58:59], v15 offset:5120
  ds_read_b64_tr_b16 v[60:61], v15 offset:8192
  ds_read_b64_tr_b16 v[62:63], v15 offset:9216
  ds_read_b64_tr_b16 v[64:65], v15 offset:12288
  ds_read_b64_tr_b16 v[66:67], v15 offset:13312
  s_waitcnt vmcnt(7) lgkmcnt(0)
  s_barrier
  s_lshl_b32 s54, s52, 12
  s_add_u32 s54, s54, 114688
  v_add_u32 v7, s54, v76
  ds_write_b128 v7, v[52:55] offset:0
  ds_write_b128 v7, v[56:59] offset:1024
  ds_write_b128 v7, v[60:63] offset:2048
  ds_write_b128 v7, v[64:67] offset:3072
  v_add_u32 v15, 131072, v14
  ds_read_b64_tr_b16 v[36:37], v15 offset:0
  ds_read_b64_tr_b16 v[38:39], v15 offset:1024
  ds_read_b64_tr_b16 v[40:41], v15 offset:4096
  ds_read_b64_tr_b16 v[42:43], v15 offset:5120
  ds_read_b64_tr_b16 v[44:45], v15 offset:8192
  ds_read_b64_tr_b16 v[46:47], v15 offset:9216
  ds_read_b64_tr_b16 v[48:49], v15 offset:12288
  ds_read_b64_tr_b16 v[50:51], v15 offset:13312
  s_waitcnt vmcnt(3) lgkmcnt(0)
  s_barrier
  s_lshl_b32 s54, s52, 12
  s_add_u32 s54, s54, 131072
  v_add_u32 v7, s54, v76
  ds_write_b128 v7, v[36:39] offset:0
  ds_write_b128 v7, v[40:43] offset:1024
  ds_write_b128 v7, v[44:47] offset:2048
  ds_write_b128 v7, v[48:51] offset:3072
  v_add_u32 v15, 147456, v14
  ds_read_b64_tr_b16 v[52:53], v15 offset:0
  ds_read_b64_tr_b16 v[54:55], v15 offset:1024
  ds_read_b64_tr_b16 v[56:57], v15 offset:4096
  ds_read_b64_tr_b16 v[58:59], v15 offset:5120
  ds_read_b64_tr_b16 v[60:61], v15 offset:8192
  ds_read_b64_tr_b16 v[62:63], v15 offset:9216
  ds_read_b64_tr_b16 v[64:65], v15 offset:12288
  ds_read_b64_tr_b16 v[66:67], v15 offset:13312
  s_waitcnt vmcnt(0) lgkmcnt(0)
  s_barrier
  s_lshl_b32 s54, s52, 12
  s_add_u32 s54, s54, 147456
  v_add_u32 v7, s54, v76
  ds_write_b128 v7, v[52:55] offset:0
  ds_write_b128 v7, v[56:59] offset:1024
  ds_write_b128 v7, v[60:63] offset:2048
  ds_write_b128 v7, v[64:67] offset:3072
  s_waitcnt lgkmcnt(0)
  s_branch C_rd1
C_rd0:
  s_sleep 2
  buffer_load_dword v21, v20, s[12:15], 0 offen sc1
  s_waitcnt vmcnt(0)
C_rd1:
  v_and_b32 v22, 0xff, v21
  v_cmp_gt_u32 vcc, 7, v22
  v_readlane_b32 s56, v21, 0
  s_mov_b32 s3, 1
  s_add_u32 s67, s67, 1
  s_cmp_ge_u32 s67, 131072
  s_cbranch_scc1 C_rd2
  s_cmp_lg_u32 vcc_hi, 0
  s_cbranch_scc1 C_rd0
  s_mov_b32 s3, 0
  s_cmp_eq_u32 s56, -1
  s_cbranch_scc1 C_rd2
  s_mov_b32 s3, 1
  v_readlane_b32 s54, v21, 10
  v_readlane_b32 s55, v21, 0
  s_nop 0
  s_bcnt1_i32_b32 s55, s55
  s_add_u32 s54, s54, s55
  v_readlane_b32 s55, v21, 1
  s_nop 0
  s_bcnt1_i32_b32 s55, s55
  s_add_u32 s54, s54, s55
  v_readlane_b32 s55, v21, 2
  s_nop 0
  s_bcnt1_i32_b32 s55, s55
  s_add_u32 s54, s54, s55
  v_readlane_b32 s55, v21, 3
  s_nop 0
  s_bcnt1_i32_b32 s55, s55
  s_add_u32 s54, s54, s55
  v_readlane_b32 s55, v21, 4
  s_nop 0
  s_bcnt1_i32_b32 s55, s55
  s_add_u32 s54, s54, s55
  v_readlane_b32 s55, v21, 5
  s_nop 0
  s_bcnt1_i32_b32 s55, s55
  s_add_u32 s54, s54, s55
  v_readlane_b32 s55, v21, 6
  s_nop 0
  s_bcnt1_i32_b32 s55, s55
  s_add_u32 s54, s54, s55
  v_readlane_b32 s55, v21, 7
  s_nop 0
  s_bcnt1_i32_b32 s55, s55
  s_add_u32 s54, s54, s55
  s_cmp_lt_u32 s54, 256
  s_cbranch_scc1 C_rd0
C_rd2:
  s_lshl_b32 s54, s3, 2
  s_add_u32 s54, s54, s52
  s_cmp_eq_u32 s54, 1
  s_cbranch_scc1 L_w1
  s_cmp_eq_u32 s54, 2
  s_cbranch_scc1 L_w2
  s_cmp_eq_u32 s54, 3
  s_cbranch_scc1 L_w3
  s_cmp_eq_u32 s54, 4
  s_cbranch_scc1 L_w4
  s_cmp_eq_u32 s54, 5
  s_cbranch_scc1 L_w5
  s_cmp_eq_u32 s54, 6
  s_cbranch_scc1 L_w6
  s_cmp_eq_u32 s54, 7
  s_cbranch_scc1 L_w7
L_w0:
  v_mov_b64 v[20:21], 0
  v_mov_b64 v[22:23], 0
  v_mov_b64 v[24:25], 0
  v_mov_b64 v[26:27], 0
  v_mov_b64 v[28:29], 0
  v_mov_b64 v[30:31], 0
  v_mov_b64 v[32:33], 0
  v_mov_b64 v[34:35], 0
  s_mov_b32 s78, 0x3f803f80
  s_mov_b32 s79, s78
  s_mov_b32 s65, 360448
  s_mov_b32 m0, 16128
  s_lshl_b32 s71, s53, 2
  s_add_u32 s71, s71, 128
  s_movk_i32 s56, 0x1000
  v_lshlrev_b32 v73, 2, v76
  v_mov_b32 v72, 0
  s_mov_b64 s[16:17], s[8:9]
  s_mov_b32 s18, 268435456
  s_mov_b32 s19, 0x20000
  s_getpc_b64 s[20:21]
Cf0_pc:
  s_add_u32 s20, s20, (Cf0_last - Cf0_pc)
  s_addc_u32 s21, s21, 0
  v_mov_b32 v68, 14880
  buffer_load_dwordx4 v[52:55], v76, s[8:11], s59 offen offset:0 sc1
  buffer_load_dwordx4 v[56:59], v76, s[8:11], s59 offen offset:1024 sc1
  ds_read_b128 v[60:63], v76 offset:16384
  ds_read_b128 v[64:67], v76 offset:17408
  ds_read_b128 v[44:47], v76 offset:18432
  ds_read_b128 v[48:51], v76 offset:19456
  ds_read_b128 v[36:39], v76 offset:32768
  ds_read_b128 v[40:43], v76 offset:33792
  ds_read_b128 v[0:3], v76 offset:4608
  ds_read_b128 v[4:7], v76 offset:5632
  ds_read_b128 v[8:11], v76 offset:6656
  ds_read_b128 v[12:15], v76 offset:7680
  s_waitcnt lgkmcnt(0)
  s_mov_b32 m0, 0
  s_mov_b32 s55, 268435456
  s_cmp_eq_u32 s66, 1
  s_branch Cf0_top2
.p2align 6
Cf0_h2:
  v_lshlrev_b32 v73, 2, v76
  s_mov_b32 m0, 10752
  s_add_u32 s55, s65, 6144
  s_cmp_eq_u32 s66, 12
  s_cselect_b32 s56, s71, 0x1000
  ds_read_b32 v72, v76 offset:16128
  s_cmp_eq_u32 s66, 13
  s_cselect_b32 s54, 0x700, 0
  s_waitcnt lgkmcnt(0)
  v_readfirstlane_b32 s57, v72
  s_nop 0
  s_cmp_lt_u32 s57, s54
  s_cbranch_scc1 Cf0_kv3
Cf0_kvb:
  s_nop 1
  buffer_load_dwordx4 v[0:3], v76, s[8:11], s65 offen offset:0 sc1
  s_nop 15
  s_nop 3
  buffer_load_dwordx4 v[0:3], v76, s[8:11], s65 offen offset:0 sc1
  s_nop 15
  s_nop 3
  buffer_load_dwordx4 v[0:3], v76, s[8:11], s65 offen offset:0 sc1
  s_waitcnt vmcnt(5)
  ds_read_b128 v[60:63], v76 offset:16384
  ds_read_b128 v[64:67], v76 offset:17408
  ds_read_b128 v[44:47], v76 offset:18432
  ds_read_b128 v[48:51], v76 offset:19456
  ds_read_b128 v[36:39], v76 offset:32768
  ds_read_b128 v[40:43], v76 offset:33792
  buffer_load_dwordx4 v[52:55], v76, s[8:11], s59 offen offset:0 sc1
  buffer_load_dwordx4 v[56:59], v76, s[8:11], s59 offen offset:1024 sc1
  s_waitcnt vmcnt(4)
  v_max3_u32 v72, v0, v1, v2
  v_max_u32 v72, v72, v3
  ds_write_b128 v76, v[0:3] offset:4608
  v_cmp_eq_u32 vcc, -1, v72
  s_cbranch_vccnz Cf0_h2r
Cf0_h2w:
  s_cmp_eq_u32 s66, 63
  s_waitcnt lgkmcnt(0)
  s_barrier
  ds_read_b128 v[4:7], v76 offset:5632
  buffer_load_dwordx4 v76, s[8:11], s55 offen offset:0 sc1 lds
  buffer_load_dwordx4 v76, s[8:11], s55 offen offset:1024 sc1 lds
Cf0_top2:
  v_smfmac_f32_16x16x64_bf16 v[24:27], v[0:3], v[44:51], v74
  s_cbranch_scc1 Cf0_last
  v_smfmac_f32_16x16x64_bf16 v[20:23], v[0:3], v[60:67], v74
  ds_read_b128 v[60:63], v76 offset:34816
  ds_read_b128 v[64:67], v76 offset:35840
  v_smfmac_f32_16x16x64_bf16 v[28:31], v[0:3], v[36:43], v74
  buffer_load_dwordx4 v76, s[8:11], s55 offen offset:2048 sc1 lds
  s_waitcnt lgkmcnt(2)
  v_smfmac_f32_16x16x64_bf16 v[20:23], v[4:7], v[80:87], v74
  buffer_load_dwordx4 v[44:47], v76, s[8:11], s58 offen offset:0 sc1
  ds_read_b128 v[8:11], v76 offset:6656
  v_smfmac_f32_16x16x64_bf16 v[24:27], v[4:7], v[88:95], v74
  buffer_load_dwordx4 v[48:51], v76, s[8:11], s58 offen offset:1024 sc1
  s_mov_b32 m0, 16128
  v_smfmac_f32_16x16x64_bf16 v[28:31], v[4:7], v[192:199], v74
  ds_read_b128 v[12:15], v76 offset:7680
  v_smfmac_f32_16x16x64_bf16 v[32:35], v[4:7], v[200:207], v74
  ds_read_b128 v[36:39], v76 offset:49152
  s_waitcnt lgkmcnt(3)
  v_smfmac_f32_16x16x64_bf16 v[32:35], v[0:3], v[60:67], v74
  ds_read_b128 v[40:43], v76 offset:50176
  s_waitcnt lgkmcnt(3)
  v_smfmac_f32_16x16x64_bf16 v[20:23], v[8:11], v[96:103], v74
  buffer_store_dwordx4 v[16:19], v76, s[8:11], s68 offen sc1
  v_smfmac_f32_16x16x64_bf16 v[24:27], v[8:11], v[104:111], v74
  s_waitcnt vmcnt(6)
  ds_read_b128 v[60:63], v76 offset:51200
  v_smfmac_f32_16x16x64_bf16 v[28:31], v[8:11], v[208:215], v74
  s_barrier
  v_smfmac_f32_16x16x64_bf16 v[32:35], v[8:11], v[216:223], v74
  buffer_load_dword v73, s[16:19], s70 offen lds
  ds_read_b128 v[4:7], v76 offset:8704
  s_waitcnt lgkmcnt(4)
  v_smfmac_f32_16x16x64_bf16 v[20:23], v[12:15], v[112:119], v74
  ds_read_b128 v[64:67], v76 offset:52224
  v_smfmac_f32_16x16x64_bf16 v[24:27], v[12:15], v[120:127], v74
  ds_read_b128 v[0:3], v76 offset:9728
  v_smfmac_f32_16x16x64_bf16 v[28:31], v[12:15], v[224:231], v74
  buffer_load_dword off, s[12:15], s56 sc1 lds
  v_smfmac_f32_16x16x64_bf16 v[32:35], v[12:15], v[232:239], v74
  s_waitcnt lgkmcnt(2)
  v_smfmac_f32_16x16x64_bf16 v[28:31], v[4:7], v[36:43], v74
  s_waitcnt vmcnt(5)
  ds_read_b128 v[36:39], v75 offset:0
  ds_read_b128 v[40:43], v75 offset:1024
  s_waitcnt lgkmcnt(3)
  v_smfmac_f32_16x16x64_bf16 v[32:35], v[4:7], v[60:67], v74
  s_barrier
  ds_read_b128 v[16:19], v76 offset:10752
  v_smfmac_f32_16x16x64_bf16 v[20:23], v[4:7], v[128:135], v74
  ds_read_b128 v[60:63], v75 offset:2048
  ds_read_b128 v[64:67], v75 offset:3072
  v_smfmac_f32_16x16x64_bf16 v[24:27], v[4:7], v[136:143], v74
  ds_read_b128 v[8:11], v76 offset:11776
  s_waitcnt lgkmcnt(6)
  v_smfmac_f32_16x16x64_bf16 v[20:23], v[0:3], v[144:151], v74
  ds_read_b128 v[12:15], v76 offset:12800
  v_smfmac_f32_16x16x64_bf16 v[24:27], v[0:3], v[152:159], v74
  s_waitcnt lgkmcnt(4)
  v_smfmac_f32_16x16x64_bf16 v[20:23], v[16:19], v[36:43], v74
  ds_read_b128 v[36:39], v75 offset:16384
  s_waitcnt lgkmcnt(3)
  v_smfmac_f32_16x16x64_bf16 v[24:27], v[16:19], v[60:67], v74
  ds_read_b128 v[40:43], v75 offset:17408
  s_waitcnt lgkmcnt(3)
  v_smfmac_f32_16x16x64_bf16 v[20:23], v[8:11], v[160:167], v74
  ds_read_b128 v[60:63], v75 offset:18432
  s_waitcnt lgkmcnt(3)
  v_smfmac_f32_16x16x64_bf16 v[20:23], v[12:15], v[176:183], v74
  ds_read_b128 v[64:67], v75 offset:19456
  v_smfmac_f32_16x16x64_bf16 v[24:27], v[8:11], v[168:175], v74
  v_mov_b64 v[70:71], s[78:79]
  v_smfmac_f32_16x16x64_bf16 v[24:27], v[12:15], v[184:191], v74
  s_waitcnt lgkmcnt(2)
  v_add_f32 v20, v20, v22
  v_smfmac_f32_16x16x64_bf16 v[28:31], v[0:3], v[36:43], v74
  ds_read_b128 v[36:39], v68
  s_waitcnt lgkmcnt(1)
  v_add_f32 v21, v21, v23
  v_smfmac_f32_16x16x64_bf16 v[32:35], v[0:3], v[60:67], v74
  ds_read_b128 v[40:43], v68
  v_add_f32 v24, v24, v26
  v_smfmac_f32_16x16x64_bf16 v[28:31], v[16:19], v[240:247], v74
  v_cvt_pk_bf16_f32 v22, v20, v24
  v_smfmac_f32_16x16x64_bf16 v[28:31], v[8:11], a[0:7], v74
  ds_write_b32 v79, v22 offset:0
  v_add_f32 v25, v25, v27
  v_cvt_pk_bf16_f32 v23, v21, v25
  v_smfmac_f32_16x16x64_bf16 v[28:31], v[12:15], a[16:23], v74
  ds_write_b32 v79, v23 offset:576
  v_cmp_u_f32 vcc, v20, v21
  v_smfmac_f32_16x16x64_bf16 v[32:35], v[16:19], v[248:255], v74
  v_mov_b64 v[68:69], s[78:79]
  v_smfmac_f32_16x16x64_bf16 v[32:35], v[8:11], a[8:15], v74
  v_add_f32 v28, v28, v30
  v_add_f32 v29, v29, v31
  v_smfmac_f32_16x16x64_bf16 v[32:35], v[12:15], a[24:31], v74
  s_cbranch_vccnz Cf0_rec
Cf0_recok:
  s_waitcnt lgkmcnt(3)
  v_smfmac_f32_16x16x64_bf16 v[36:39], v[16:19], a[128:135], v74
  s_waitcnt lgkmcnt(0)
  s_barrier
  ds_read_b128 v[60:63], v77
  v_smfmac_f32_16x16x64_bf16 v[40:43], v[16:19], a[136:143], v74
  ds_read_b128 v[64:67], v77 offset:128
  v_add_f32 v32, v32, v34
  v_cvt_pk_bf16_f32 v30, v28, v32
  v_smfmac_f32_16x16x64_bf16 v[36:39], v[0:3], a[112:119], v74
  ds_write_b32 v79, v30 offset:256
  v_add_f32 v33, v33, v35
  v_cvt_pk_bf16_f32 v31, v29, v33
  v_smfmac_f32_16x16x64_bf16 v[40:43], v[0:3], a[120:127], v74
  ds_write_b32 v79, v31 offset:832
  v_xor_b32 v75, 0x8000, v75
  v_smfmac_f32_16x16x64_bf16 v[36:39], v[4:7], a[96:103], v74
  ds_read_b128 v[0:3], v76 offset:4608
  v_mov_b32 v29, 0
  v_smfmac_f32_16x16x64_bf16 v[40:43], v[4:7], a[104:111], v74
  s_waitcnt vmcnt(3) lgkmcnt(3)
  v_mov_b32 v30, 0
  v_mfma_f32_16x16x32_bf16 v[44:47], v[44:47], v[60:63], 0
  ds_read_b128 v[4:7], v76 offset:5632
  s_waitcnt lgkmcnt(2)
  v_mfma_f32_16x16x32_bf16 v[44:47], v[48:51], v[64:67], v[44:47]
  s_barrier
  v_smfmac_f32_16x16x64_bf16 v[36:39], v[8:11], a[144:151], v74
  ds_read_b128 v[20:23], v77 offset:256
  ds_read_b128 v[24:27], v77 offset:384
  v_smfmac_f32_16x16x64_bf16 v[40:43], v[8:11], a[152:159], v74
  ds_read_b128 v[8:11], v76 offset:6656
  v_add_f32_dpp v72, v46, v44 quad_perm:[2,3,0,1] row_mask:0xf bank_mask:0xf
  v_add_f32_dpp v73, v47, v45 quad_perm:[2,3,0,1] row_mask:0xf bank_mask:0xf
  v_smfmac_f32_16x16x64_bf16 v[36:39], v[12:15], a[160:167], v74
  s_waitcnt lgkmcnt(4)
  v_exp_f32_dpp v72, v72 quad_perm:[0,1,0,1] row_mask:0xf bank_mask:0xf
  v_smfmac_f32_16x16x64_bf16 v[40:43], v[12:15], a[168:175], v74
  ds_read_b128 v[12:15], v76 offset:7680
  v_exp_f32_dpp v73, v73 quad_perm:[0,1,0,1] row_mask:0xf bank_mask:0xf
  v_smfmac_f32_16x16x64_bf16 v[36:39], v[0:3], a[32:39], v74
  s_waitcnt lgkmcnt(2)
  v_cvt_pk_bf16_f32 v72, v72, v73
  v_mfma_f32_16x16x32_bf16 v[20:23], v[20:23], v[60:63], 0
  ds_write_b32 v78, v72 offset:512
  v_mov_b64 v[16:17], 0
  v_mfma_f32_16x16x32_bf16 v[20:23], v[24:27], v[64:67], v[20:23]
  ds_read_b128 v[44:47], v75 offset:16384
  v_mov_b64 v[18:19], 0
  v_smfmac_f32_16x16x64_bf16 v[40:43], v[0:3], a[40:47], v74
  ds_read_b128 v[48:51], v75 offset:17408
  s_waitcnt lgkmcnt(4)
  v_smfmac_f32_16x16x64_bf16 v[36:39], v[4:7], a[48:55], v74
  v_add_f32_dpp v24, v22, v20 quad_perm:[2,3,0,1] row_mask:0xf bank_mask:0xf
  v_add_f32_dpp v25, v23, v21 quad_perm:[2,3,0,1] row_mask:0xf bank_mask:0xf
  v_smfmac_f32_16x16x64_bf16 v[36:39], v[8:11], a[64:71], v74
  s_waitcnt lgkmcnt(2)
  s_barrier
  ds_read_b128 v[32:35], v78 offset:512
  v_smfmac_f32_16x16x64_bf16 v[36:39], v[12:15], a[80:87], v74
  ds_read_b128 v[60:63], v75 offset:18432
  v_mul_f32 v24, s69, v24
  v_smfmac_f32_16x16x64_bf16 v[40:43], v[4:7], a[56:63], v74
  ds_read_b128 v[64:67], v75 offset:19456
  v_mul_f32 v25, s69, v25
  v_smfmac_f32_16x16x64_bf16 v[40:43], v[8:11], a[72:79], v74
  v_exp_f32_dpp v24, v24 quad_perm:[0,1,0,1] row_mask:0xf bank_mask:0xf
  v_smfmac_f32_16x16x64_bf16 v[40:43], v[12:15], a[88:95], v74
  s_waitcnt lgkmcnt(2)
  v_exp_f32_dpp v25, v25 quad_perm:[0,1,0,1] row_mask:0xf bank_mask:0xf
  v_mfma_f32_16x16x32_bf16 v[8:11], v[32:35], v[68:71], 0
  v_add_f32 v36, v36, v38
  v_add_f32 v37, v37, v39
  v_mfma_f32_16x16x32_bf16 v[0:3], v[32:35], v[52:55], 0
  v_add_f32 v40, v40, v42
  v_add_f32 v41, v41, v43
  v_mfma_f32_16x16x32_bf16 v[4:7], v[32:35], v[56:59], 0
  v_cvt_pk_bf16_f32 v28, v24, v25
  v_cvt_pk_bf16_f32 v72, v36, v37
  v_cvt_pk_bf16_f32 v73, v40, v41
  v_mfma_f32_16x16x16_bf16 v[8:11], v[28:29], v[68:69], v[8:11]
  v_cvt_pk_bf16_f32 v31, v24, v25
  v_mov_b64 v[20:21], 0
  v_mfma_f32_16x16x16_bf16 v[0:3], v[28:29], v[72:73], v[0:3]
  ds_read_b128 v[68:71], v76 offset:13824
  v_mov_b64 v[22:23], 0
  v_mfma_f32_16x16x16_bf16 v[4:7], v[30:31], v[72:73], v[4:7]
  v_rcp_f32 v10, v8
  v_rcp_f32 v11, v9
  v_mul_f32 v0, v10, v0
  v_mul_f32 v1, v11, v1
  s_nop 0
  v_mul_f32 v4, v10, v4
  v_mul_f32 v5, v11, v5
  v_cvt_pk_bf16_f32 v2, v0, v4
  ds_write_b32 v79, v2 offset:8704
  v_cvt_pk_bf16_f32 v3, v1, v5
  ds_write_b32 v79, v3 offset:9280
  v_max3_f32 v8, v8, v9, v10
  v_max_f32 v8, v8, v11
  v_cmp_le_f32 vcc, 1317011456, v8
  v_mov_b64 v[24:25], 0
  v_mov_b64 v[26:27], 0
  s_cbranch_vccnz Cf0_mx
Cf0_mxok:
  s_waitcnt lgkmcnt(0)
  s_barrier
  ds_read_b128 v[0:3], v78 offset:8704
  ds_read_b128 v[4:7], v78 offset:8768
  ds_read_b128 v[8:11], v78 offset:8832
  ds_read_b128 v[12:15], v78 offset:8896
  s_waitcnt lgkmcnt(3)
  v_smfmac_f32_16x16x64_bf16 v[16:19], v[0:3], v[44:51], v74
  ds_read_b128 v[52:55], v75 offset:32768
  s_waitcnt lgkmcnt(3)
  v_smfmac_f32_16x16x64_bf16 v[16:19], v[4:7], v[60:67], v74
  ds_read_b128 v[56:59], v75 offset:33792
  s_waitcnt lgkmcnt(3)
  v_smfmac_f32_16x16x64_bf16 v[16:19], v[8:11], a[176:183], v74
  ds_read_b128 v[36:39], v75 offset:34816
  s_waitcnt lgkmcnt(3)
  v_smfmac_f32_16x16x64_bf16 v[16:19], v[12:15], a[184:191], v74
  ds_read_b128 v[40:43], v75 offset:35840
  ds_read_b128 v[44:47], v75 offset:49152
  v_smfmac_f32_16x16x64_bf16 v[20:23], v[0:3], a[192:199], v74
  ds_read_b128 v[48:51], v75 offset:50176
  ds_read_b128 v[60:63], v75 offset:51200
  v_smfmac_f32_16x16x64_bf16 v[20:23], v[4:7], a[200:207], v74
  ds_read_b128 v[64:67], v75 offset:52224
  s_waitcnt lgkmcnt(6)
  v_cvt_pk_bf16_f32 v16, v16, v17
  v_cvt_pk_bf16_f32 v17, v18, v19
  v_bfi_b32 v16, 1, s72, v16
  v_smfmac_f32_16x16x64_bf16 v[20:23], v[8:11], v[52:59], v74
  buffer_store_dwordx2 v[16:17], v68, s[8:11], s73 offen
  s_waitcnt lgkmcnt(4)
  v_smfmac_f32_16x16x64_bf16 v[20:23], v[12:15], v[36:43], v74
  v_mov_b64 v[32:33], 0
  v_smfmac_f32_16x16x64_bf16 v[24:27], v[0:3], a[208:215], v74
  v_mov_b64 v[34:35], 0
  v_smfmac_f32_16x16x64_bf16 v[24:27], v[4:7], a[216:223], v74
  s_waitcnt lgkmcnt(2)
  v_cvt_pk_bf16_f32 v20, v20, v21
  v_cvt_pk_bf16_f32 v21, v22, v23
  v_bfi_b32 v20, 1, s72, v20
  v_smfmac_f32_16x16x64_bf16 v[24:27], v[8:11], v[44:51], v74
  buffer_store_dwordx2 v[20:21], v68, s[8:11], s74 offen
  s_waitcnt lgkmcnt(0)
  v_smfmac_f32_16x16x64_bf16 v[24:27], v[12:15], v[60:67], v74
  v_smfmac_f32_16x16x64_bf16 v[32:35], v[0:3], a[224:231], v74
  v_smfmac_f32_16x16x64_bf16 v[32:35], v[4:7], a[232:239], v74
  v_cvt_pk_bf16_f32 v24, v24, v25
  v_cvt_pk_bf16_f32 v25, v26, v27
  v_bfi_b32 v24, 1, s72, v24
  v_smfmac_f32_16x16x64_bf16 v[32:35], v[8:11], a[240:247], v74
  s_nop 1
  buffer_store_dwordx2 v[24:25], v68, s[8:11], s75 offen
  v_smfmac_f32_16x16x64_bf16 v[32:35], v[12:15], a[248:255], v74
  ds_read_b128 v[0:3], v76 offset:14848
  ds_read_b64 v[16:17], v77 offset:256
  v_mov_b64 v[18:19], v[72:73]
  v_xor_b32 v75, 0x8000, v75
  s_nop 3
  v_cvt_pk_bf16_f32 v32, v32, v33
  v_cvt_pk_bf16_f32 v33, v34, v35
  v_bfi_b32 v32, 1, s72, v32
  buffer_store_dwordx2 v[32:33], v68, s[8:11], s76 offen
  v_mov_b64 v[20:21], 0
  v_mov_b64 v[22:23], 0
  v_mov_b64 v[24:25], 0
  v_mov_b64 v[26:27], 0
  v_mov_b64 v[28:29], 0
  v_mov_b64 v[30:31], 0
  v_mov_b64 v[32:33], 0
  v_mov_b64 v[34:35], 0
  v_mov_b32 v68, 14880
  s_add_u32 s58, s58, 655360
  s_add_u32 s59, s59, 655360
  s_add_u32 s70, s70, 655360
  s_add_u32 s68, s68, 655360
  s_add_u32 s66, s66, 1
  s_xor_b32 s64, s64, 16384
  s_xor_b32 s65, s65, 16384
  s_cmp_eq_u32 s66, 62
  s_cselect_b64 s[16:17], s[20:21], s[16:17]
  s_cselect_b32 s18, (Cf0_done - Cf0_last), s18
  s_cselect_b32 s70, 0, s70
  s_cmp_eq_u32 s66, 63
  s_cselect_b32 s59, 268435456, s59
  s_nop 13
  buffer_load_dwordx4 v[52:55], v76, s[8:11], s60 offen offset:0 sc1
  buffer_load_dwordx4 v[56:59], v76, s[8:11], s60 offen offset:1024 sc1
  s_nop 15
  s_nop 11
  buffer_load_dwordx4 v[36:39], v76, s[8:11], s60 offen offset:0 sc1
  buffer_load_dwordx4 v[40:43], v76, s[8:11], s60 offen offset:1024 sc1
  s_waitcnt lgkmcnt(0)
  s_waitcnt vmcnt(3)
  v_mfma_f32_16x16x32_bf16 v[4:7], v[0:3], v[52:55], 0
  v_bitop3_b32 v72, v52, v54, s72 bitop3:0x7e
  s_waitcnt vmcnt(2)
  v_mfma_f32_16x16x32_bf16 v[4:7], v[0:3], v[56:59], v[4:7]
  v_bitop3_b32 v73, v56, v58, s72 bitop3:0x7e
  v_bitop3_b32 v72, v72, v73, 1 bitop3:0xa8
  v_cmp_ne_u32 vcc, 0, v72
  s_cbranch_vccnz Cf0_h1r
  s_nop 2
  v_add_f32_dpp v4, v4, v4 row_ror:4 row_mask:0xf bank_mask:0xf
  v_add_f32_dpp v5, v5, v5 row_ror:4 row_mask:0xf bank_mask:0xf
  s_nop 0
  v_add_f32_dpp v4, v4, v4 row_ror:8 row_mask:0xf bank_mask:0xf
  v_add_f32_dpp v5, v5, v5 row_ror:8 row_mask:0xf bank_mask:0xf
  v_cvt_pk_bf16_f32 v4, v4, v5
  buffer_store_dword v4, v69, s[8:11], s62 offen
  s_xor_b32 s62, s62, 16384
  buffer_store_dword v71, v69, s[8:11], s62 offen
  s_xor_b32 s72, s72, 1
  s_branch Cf0_h2
Cf0_h1r:
  s_mov_b64 exec, vcc
  buffer_load_dwordx4 v[52:55], v76, s[8:11], s60 offen offset:0 sc1
  buffer_load_dwordx4 v[56:59], v76, s[8:11], s60 offen offset:1024 sc1
  s_mov_b64 exec, -1
  s_add_u32 s67, s67, 1
  s_waitcnt vmcnt(3)
  v_mfma_f32_16x16x32_bf16 v[4:7], v[0:3], v[36:39], 0
  v_bitop3_b32 v72, v36, v38, s72 bitop3:0x7e
  s_waitcnt vmcnt(2)
  v_mfma_f32_16x16x32_bf16 v[4:7], v[0:3], v[40:43], v[4:7]
  v_bitop3_b32 v73, v40, v42, s72 bitop3:0x7e
  v_bitop3_b32 v72, v72, v73, 1 bitop3:0xa8
  v_cmp_ne_u32 vcc, 0, v72
  s_cbranch_vccz Cf0_h1p
  s_mov_b64 exec, vcc
  buffer_load_dwordx4 v[36:39], v76, s[8:11], s60 offen offset:0 sc1
  buffer_load_dwordx4 v[40:43], v76, s[8:11], s60 offen offset:1024 sc1
  s_mov_b64 exec, -1
  s_add_u32 s67, s67, 1
  s_waitcnt vmcnt(3)
  v_mfma_f32_16x16x32_bf16 v[4:7], v[0:3], v[52:55], 0
  v_bitop3_b32 v72, v52, v54, s72 bitop3:0x7e
  s_waitcnt vmcnt(2)
  v_mfma_f32_16x16x32_bf16 v[4:7], v[0:3], v[56:59], v[4:7]
  v_bitop3_b32 v73, v56, v58, s72 bitop3:0x7e
  v_bitop3_b32 v72, v72, v73, 1 bitop3:0xa8
  v_cmp_ne_u32 vcc, 0, v72
  s_cbranch_vccz Cf0_h1p
Cf0_h1s:
  s_mov_b64 exec, vcc
  buffer_load_dwordx4 v[52:55], v76, s[8:11], s60 offen offset:0 sc1
  buffer_load_dwordx4 v[56:59], v76, s[8:11], s60 offen offset:1024 sc1
  s_mov_b64 exec, -1
  s_add_u32 s67, s67, 1
  s_waitcnt vmcnt(3)
  v_mfma_f32_16x16x32_bf16 v[4:7], v[0:3], v[36:39], 0
  v_bitop3_b32 v72, v36, v38, s72 bitop3:0x7e
  s_waitcnt vmcnt(2)
  v_mfma_f32_16x16x32_bf16 v[4:7], v[0:3], v[40:43], v[4:7]
  v_bitop3_b32 v73, v40, v42, s72 bitop3:0x7e
  v_bitop3_b32 v72, v72, v73, 1 bitop3:0xa8
  v_cmp_ne_u32 vcc, 0, v72
  s_cbranch_vccz Cf0_h1p
  s_mov_b64 exec, vcc
  buffer_load_dwordx4 v[36:39], v76, s[8:11], s60 offen offset:0 sc1
  buffer_load_dwordx4 v[40:43], v76, s[8:11], s60 offen offset:1024 sc1
  s_mov_b64 exec, -1
  s_add_u32 s67, s67, 1
  s_waitcnt vmcnt(3)
  v_mfma_f32_16x16x32_bf16 v[4:7], v[0:3], v[52:55], 0
  v_bitop3_b32 v72, v52, v54, s72 bitop3:0x7e
  s_waitcnt vmcnt(2)
  v_mfma_f32_16x16x32_bf16 v[4:7], v[0:3], v[56:59], v[4:7]
  v_bitop3_b32 v73, v56, v58, s72 bitop3:0x7e
  v_bitop3_b32 v72, v72, v73, 1 bitop3:0xa8
  v_cmp_ne_u32 vcc, 0, v72
  s_cbranch_vccz Cf0_h1p
  s_cmp_lt_u32 s67, 131072
  s_cbranch_scc1 Cf0_h1s
Cf0_h1p:
  s_nop 2
  v_add_f32_dpp v4, v4, v4 row_ror:4 row_mask:0xf bank_mask:0xf
  v_add_f32_dpp v5, v5, v5 row_ror:4 row_mask:0xf bank_mask:0xf
  s_nop 0
  v_add_f32_dpp v4, v4, v4 row_ror:8 row_mask:0xf bank_mask:0xf
  v_add_f32_dpp v5, v5, v5 row_ror:8 row_mask:0xf bank_mask:0xf
  v_cvt_pk_bf16_f32 v4, v4, v5
  buffer_store_dword v4, v69, s[8:11], s62 offen
  s_xor_b32 s62, s62, 16384
  buffer_store_dword v71, v69, s[8:11], s62 offen
  s_xor_b32 s72, s72, 1
  s_branch Cf0_h2
Cf0_h2r:
  s_mov_b64 exec, vcc
  buffer_load_dwordx4 v[0:3], v76, s[8:11], s65 offen offset:0 sc1
  s_mov_b64 exec, -1
  s_add_u32 s67, s67, 1
  s_waitcnt vmcnt(4)
  v_max3_u32 v72, v0, v1, v2
  v_max_u32 v72, v72, v3
  ds_write_b128 v76, v[0:3] offset:4608
  v_cmp_eq_u32 vcc, -1, v72
  s_cbranch_vccz Cf0_h2w
  s_mov_b64 exec, vcc
  buffer_load_dwordx4 v[0:3], v76, s[8:11], s65 offen offset:0 sc1
  s_mov_b64 exec, -1
  s_add_u32 s67, s67, 1
  s_waitcnt vmcnt(4)
  v_max3_u32 v72, v0, v1, v2
  v_max_u32 v72, v72, v3
  ds_write_b128 v76, v[0:3] offset:4608
  v_cmp_eq_u32 vcc, -1, v72
  s_cbranch_vccz Cf0_h2w
Cf0_h2s:
  s_mov_b64 exec, vcc
  buffer_load_dwordx4 v[0:3], v76, s[8:11], s65 offen offset:0 sc1
  s_mov_b64 exec, -1
  s_add_u32 s67, s67, 1
  s_waitcnt vmcnt(2)
  v_max3_u32 v72, v0, v1, v2
  v_max_u32 v72, v72, v3
  ds_write_b128 v76, v[0:3] offset:4608
  v_cmp_eq_u32 vcc, -1, v72
  s_cbranch_vccz Cf0_h2w
  s_mov_b64 exec, vcc
  buffer_load_dwordx4 v[0:3], v76, s[8:11], s65 offen offset:0 sc1
  s_mov_b64 exec, -1
  s_add_u32 s67, s67, 1
  s_waitcnt vmcnt(2)
  v_max3_u32 v72, v0, v1, v2
  v_max_u32 v72, v72, v3
  ds_write_b128 v76, v[0:3] offset:4608
  v_cmp_eq_u32 vcc, -1, v72
  s_cbranch_vccz Cf0_h2w
  s_mov_b64 exec, vcc
  buffer_load_dwordx4 v[0:3], v76, s[8:11], s65 offen offset:0 sc1
  s_mov_b64 exec, -1
  s_add_u32 s67, s67, 1
  s_waitcnt vmcnt(2)
  v_max3_u32 v72, v0, v1, v2
  v_max_u32 v72, v72, v3
  ds_write_b128 v76, v[0:3] offset:4608
  v_cmp_eq_u32 vcc, -1, v72
  s_cbranch_vccz Cf0_h2w
  s_cmp_lt_u32 s67, 131072
  s_cbranch_scc1 Cf0_h2s
  s_branch Cf0_h2w
Cf0_rec:
  s_nop 7
  s_waitcnt vmcnt(0) lgkmcnt(0)
  v_max3_u32 v72, v0, v1, v2
  v_max3_u32 v72, v72, v3, v4
  v_max3_u32 v72, v72, v5, v6
  v_max3_u32 v72, v72, v7, v8
  v_max3_u32 v72, v72, v9, v10
  v_max3_u32 v72, v72, v11, v12
  v_max3_u32 v72, v72, v13, v14
  v_max3_u32 v72, v72, v15, v16
  v_max3_u32 v72, v72, v17, v18
  v_max_u32 v72, v72, v19
  v_cmp_eq_u32 vcc, -1, v72
  s_cbranch_vccz Cf0_recok
  s_barrier
  v_mov_b64 v[20:21], 0
  v_mov_b64 v[22:23], 0
  v_mov_b64 v[24:25], 0
  v_mov_b64 v[26:27], 0
  v_mov_b64 v[28:29], 0
  v_mov_b64 v[30:31], 0
  v_mov_b64 v[32:33], 0
  v_mov_b64 v[34:35], 0
  s_waitcnt lgkmcnt(0)
  s_barrier
  ds_read_b128 v[0:3], v76 offset:4608
  ds_read_b128 v[60:63], v76 offset:16384
  ds_read_b128 v[64:67], v76 offset:17408
  s_waitcnt lgkmcnt(0)
  v_smfmac_f32_16x16x64_bf16 v[20:23], v[0:3], v[60:67], v74
  ds_read_b128 v[60:63], v76 offset:18432
  ds_read_b128 v[64:67], v76 offset:19456
  s_waitcnt lgkmcnt(0)
  v_smfmac_f32_16x16x64_bf16 v[24:27], v[0:3], v[60:67], v74
  ds_read_b128 v[60:63], v76 offset:32768
  ds_read_b128 v[64:67], v76 offset:33792
  s_waitcnt lgkmcnt(0)
  v_smfmac_f32_16x16x64_bf16 v[28:31], v[0:3], v[60:67], v74
  ds_read_b128 v[60:63], v76 offset:34816
  ds_read_b128 v[64:67], v76 offset:35840
  s_waitcnt lgkmcnt(0)
  v_smfmac_f32_16x16x64_bf16 v[32:35], v[0:3], v[60:67], v74
  ds_read_b128 v[4:7], v76 offset:5632
  s_waitcnt lgkmcnt(0)
  v_smfmac_f32_16x16x64_bf16 v[20:23], v[4:7], v[80:87], v74
  v_smfmac_f32_16x16x64_bf16 v[24:27], v[4:7], v[88:95], v74
  v_smfmac_f32_16x16x64_bf16 v[28:31], v[4:7], v[192:199], v74
  v_smfmac_f32_16x16x64_bf16 v[32:35], v[4:7], v[200:207], v74
  ds_read_b128 v[8:11], v76 offset:6656
  s_waitcnt lgkmcnt(0)
  v_smfmac_f32_16x16x64_bf16 v[20:23], v[8:11], v[96:103], v74
  v_smfmac_f32_16x16x64_bf16 v[24:27], v[8:11], v[104:111], v74
  v_smfmac_f32_16x16x64_bf16 v[28:31], v[8:11], v[208:215], v74
  v_smfmac_f32_16x16x64_bf16 v[32:35], v[8:11], v[216:223], v74
  ds_read_b128 v[12:15], v76 offset:7680
  s_waitcnt lgkmcnt(0)
  v_smfmac_f32_16x16x64_bf16 v[20:23], v[12:15], v[112:119], v74
  v_smfmac_f32_16x16x64_bf16 v[24:27], v[12:15], v[120:127], v74
  v_smfmac_f32_16x16x64_bf16 v[28:31], v[12:15], v[224:231], v74
  v_smfmac_f32_16x16x64_bf16 v[32:35], v[12:15], v[232:239], v74
  ds_read_b128 v[4:7], v76 offset:8704
  s_waitcnt lgkmcnt(0)
  v_smfmac_f32_16x16x64_bf16 v[20:23], v[4:7], v[128:135], v74
  v_smfmac_f32_16x16x64_bf16 v[24:27], v[4:7], v[136:143], v74
  ds_read_b128 v[60:63], v76 offset:49152
  ds_read_b128 v[64:67], v76 offset:50176
  s_waitcnt lgkmcnt(0)
  v_smfmac_f32_16x16x64_bf16 v[28:31], v[4:7], v[60:67], v74
  ds_read_b128 v[60:63], v76 offset:51200
  ds_read_b128 v[64:67], v76 offset:52224
  s_waitcnt lgkmcnt(0)
  v_smfmac_f32_16x16x64_bf16 v[32:35], v[4:7], v[60:67], v74
  ds_read_b128 v[0:3], v76 offset:9728
  s_waitcnt lgkmcnt(0)
  v_smfmac_f32_16x16x64_bf16 v[20:23], v[0:3], v[144:151], v74
  v_smfmac_f32_16x16x64_bf16 v[24:27], v[0:3], v[152:159], v74
  ds_read_b128 v[60:63], v75 offset:16384
  ds_read_b128 v[64:67], v75 offset:17408
  s_waitcnt lgkmcnt(0)
  v_smfmac_f32_16x16x64_bf16 v[28:31], v[0:3], v[60:67], v74
  ds_read_b128 v[60:63], v75 offset:18432
  ds_read_b128 v[64:67], v75 offset:19456
  s_waitcnt lgkmcnt(0)
  v_smfmac_f32_16x16x64_bf16 v[32:35], v[0:3], v[60:67], v74
  ds_read_b128 v[16:19], v76 offset:10752
  ds_read_b128 v[60:63], v75 offset:0
  ds_read_b128 v[64:67], v75 offset:1024
  s_waitcnt lgkmcnt(0)
  v_smfmac_f32_16x16x64_bf16 v[20:23], v[16:19], v[60:67], v74
  ds_read_b128 v[60:63], v75 offset:2048
  ds_read_b128 v[64:67], v75 offset:3072
  s_waitcnt lgkmcnt(0)
  v_smfmac_f32_16x16x64_bf16 v[24:27], v[16:19], v[60:67], v74
  v_smfmac_f32_16x16x64_bf16 v[28:31], v[16:19], v[240:247], v74
  v_smfmac_f32_16x16x64_bf16 v[32:35], v[16:19], v[248:255], v74
  ds_read_b128 v[8:11], v76 offset:11776
  s_waitcnt lgkmcnt(0)
  v_smfmac_f32_16x16x64_bf16 v[20:23], v[8:11], v[160:167], v74
  v_smfmac_f32_16x16x64_bf16 v[24:27], v[8:11], v[168:175], v74
  v_smfmac_f32_16x16x64_bf16 v[28:31], v[8:11], a[0:7], v74
  v_smfmac_f32_16x16x64_bf16 v[32:35], v[8:11], a[8:15], v74
  ds_read_b128 v[12:15], v76 offset:12800
  s_waitcnt lgkmcnt(0)
  v_smfmac_f32_16x16x64_bf16 v[20:23], v[12:15], v[176:183], v74
  v_smfmac_f32_16x16x64_bf16 v[24:27], v[12:15], v[184:191], v74
  v_smfmac_f32_16x16x64_bf16 v[28:31], v[12:15], a[16:23], v74
  v_smfmac_f32_16x16x64_bf16 v[32:35], v[12:15], a[24:31], v74
  v_add_f32 v20, v20, v22
  v_add_f32 v21, v21, v23
  v_add_f32 v24, v24, v26
  v_cvt_pk_bf16_f32 v22, v20, v24
  s_nop 0
  ds_write_b32 v79, v22 offset:0
  v_add_f32 v25, v25, v27
  v_cvt_pk_bf16_f32 v23, v21, v25
  ds_write_b32 v79, v23 offset:576
  v_add_f32 v28, v28, v30
  v_add_f32 v29, v29, v31
  s_waitcnt lgkmcnt(0)
  s_nop 1
  s_branch Cf0_recok
Cf0_mx:
  s_waitcnt lgkmcnt(0)
  s_barrier
  buffer_load_dwordx4 v[0:3], v76, s[8:11], s58 offen offset:0 sc1
  ds_read_b128 v[20:23], v77 offset:0
  ds_read_b128 v[28:31], v77 offset:256
  buffer_load_dwordx4 v[4:7], v76, s[8:11], s58 offen offset:1024 sc1
  ds_read_b128 v[24:27], v77 offset:128
  ds_read_b128 v[32:35], v77 offset:384
  s_waitcnt vmcnt(1) lgkmcnt(3)
  v_mfma_f32_16x16x32_bf16 v[8:11], v[0:3], v[20:23], 0
  s_waitcnt vmcnt(0) lgkmcnt(1)
  v_mfma_f32_16x16x32_bf16 v[8:11], v[4:7], v[24:27], v[8:11]
  v_mfma_f32_16x16x32_bf16 v[12:15], v[28:31], v[20:23], 0
  s_waitcnt lgkmcnt(0)
  v_mfma_f32_16x16x32_bf16 v[12:15], v[32:35], v[24:27], v[12:15]
  v_add_f32_dpp v8, v10, v8 quad_perm:[2,3,0,1] row_mask:0xf bank_mask:0xf
  v_add_f32_dpp v9, v11, v9 quad_perm:[2,3,0,1] row_mask:0xf bank_mask:0xf
  s_nop 0
  v_mov_b32_dpp v8, v8 quad_perm:[0,1,0,1] row_mask:0xf bank_mask:0xf
  v_mov_b32_dpp v9, v9 quad_perm:[0,1,0,1] row_mask:0xf bank_mask:0xf
  s_nop 1
  v_add_f32_dpp v12, v14, v12 quad_perm:[2,3,0,1] row_mask:0xf bank_mask:0xf
  v_add_f32_dpp v13, v15, v13 quad_perm:[2,3,0,1] row_mask:0xf bank_mask:0xf
  s_nop 0
  v_mov_b32_dpp v12, v12 quad_perm:[0,1,0,1] row_mask:0xf bank_mask:0xf
  v_mov_b32_dpp v13, v13 quad_perm:[0,1,0,1] row_mask:0xf bank_mask:0xf
  v_mul_f32 v12, s69, v12
  ds_write_b32 v78, v8 offset:8704
  v_mul_f32 v13, s69, v13
  ds_write_b32 v78, v9 offset:8768
  s_waitcnt lgkmcnt(0)
  s_barrier
  ds_read_b128 v[36:39], v78 offset:8704
  ds_read_b128 v[40:43], v78 offset:8768
  s_waitcnt lgkmcnt(0)
  s_barrier
  v_max_f32 v16, v36, v37
  v_max3_f32 v16, v16, v38, v39
  v_max3_f32 v16, v16, v40, v41
  v_max3_f32 v16, v16, v42, v43
  v_max3_f32 v16, v16, v12, v13
  v_mov_b32 v17, v16
  s_nop 1
  v_permlane16_swap_b32 v16, v17
  v_max_f32 v16, v16, v17
  v_mov_b32 v17, v16
  s_nop 1
  v_permlane32_swap_b32 v16, v17
  v_max_f32 v16, v16, v17
  v_sub_f32 v36, v36, v16
  v_sub_f32 v37, v37, v16
  v_sub_f32 v38, v38, v16
  v_sub_f32 v39, v39, v16
  v_sub_f32 v40, v40, v16
  v_sub_f32 v41, v41, v16
  v_sub_f32 v42, v42, v16
  v_sub_f32 v43, v43, v16
  v_sub_f32 v12, v12, v16
  v_sub_f32 v13, v13, v16
  v_exp_f32 v36, v36
  v_exp_f32 v37, v37
  v_exp_f32 v38, v38
  v_exp_f32 v39, v39
  v_exp_f32 v40, v40
  v_exp_f32 v41, v41
  v_exp_f32 v42, v42
  v_exp_f32 v43, v43
  v_exp_f32 v12, v12
  v_exp_f32 v13, v13
  v_cvt_pk_bf16_f32 v32, v36, v40
  v_cvt_pk_bf16_f32 v33, v37, v41
  v_cvt_pk_bf16_f32 v34, v38, v42
  v_cvt_pk_bf16_f32 v35, v39, v43
  v_cvt_pk_bf16_f32 v28, v12, v13
  v_cvt_pk_bf16_f32 v31, v12, v13
  v_mov_b32 v29, 0
  v_mov_b32 v30, 0
  v_mov_b32 v68, 0x3f803f80
  v_mov_b32 v69, 0x3f803f80
  v_mov_b32 v70, 0x3f803f80
  v_mov_b32 v71, 0x3f803f80
  s_nop 1
  v_mfma_f32_16x16x32_bf16 v[8:11], v[32:35], v[68:71], 0
  v_mfma_f32_16x16x32_bf16 v[0:3], v[32:35], v[52:55], 0
  v_mfma_f32_16x16x32_bf16 v[4:7], v[32:35], v[56:59], 0
  v_mfma_f32_16x16x16_bf16 v[8:11], v[28:29], v[68:69], v[8:11]
  v_mfma_f32_16x16x16_bf16 v[0:3], v[28:29], v[72:73], v[0:3]
  v_mfma_f32_16x16x16_bf16 v[4:7], v[30:31], v[72:73], v[4:7]
  ds_read_b128 v[68:71], v76 offset:13824
  v_rcp_f32 v10, v8
  v_rcp_f32 v11, v9
  v_mul_f32 v0, v10, v0
  v_mul_f32 v1, v11, v1
  s_nop 0
  v_mul_f32 v4, v10, v4
  v_mul_f32 v5, v11, v5
  v_cvt_pk_bf16_f32 v2, v0, v4
  ds_write_b32 v79, v2 offset:8704
  v_cvt_pk_bf16_f32 v3, v1, v5
  ds_write_b32 v79, v3 offset:9280
  v_mov_b64 v[16:17], 0
  v_mov_b64 v[18:19], 0
  v_mov_b64 v[20:21], 0
  v_mov_b64 v[22:23], 0
  v_mov_b64 v[24:25], 0
  v_mov_b64 v[26:27], 0
  s_branch Cf0_mxok
Cf0_kv3:
  s_waitcnt lgkmcnt(0)
  s_cmp_ge_u32 s57, 0x700
  s_cbranch_scc1 Cf0_kvb
  s_load_dword s57, s[12:13], s71 glc
  s_add_u32 s67, s67, 1
  s_cmp_lt_u32 s67, 131072
  s_cbranch_scc1 Cf0_kv3
  s_waitcnt lgkmcnt(0)
  s_branch Cf0_kvb
Cf0_last:
  buffer_load_dwordx4 v76, s[8:11], s55 offen offset:2048 sc1 lds
  ds_read_b128 v[8:11], v76 offset:6656
  ds_read_b128 v[12:15], v76 offset:7680
  ds_read_b128 v[60:63], v76 offset:34816
  ds_read_b128 v[64:67], v76 offset:35840
  ds_read_b128 v[44:47], v76 offset:49152
  ds_read_b128 v[48:51], v76 offset:50176
  s_nop 3
  v_mov_b64 v[20:21], 0
  v_mov_b64 v[22:23], 0
  v_mov_b64 v[24:25], 0
  v_mov_b64 v[26:27], 0
  v_smfmac_f32_16x16x64_bf16 v[28:31], v[0:3], v[36:43], v74
  s_waitcnt lgkmcnt(6)
  v_smfmac_f32_16x16x64_bf16 v[20:23], v[0:3], a[32:39], v74
  ds_read_b128 v[36:39], v76 offset:51200
  ds_read_b128 v[40:43], v76 offset:52224
  v_smfmac_f32_16x16x64_bf16 v[24:27], v[0:3], a[40:47], v74
  v_smfmac_f32_16x16x64_bf16 v[20:23], v[4:7], a[48:55], v74
  buffer_store_dwordx4 v[16:19], v76, s[8:11], s68 offen sc1
  s_waitcnt lgkmcnt(4)
  v_smfmac_f32_16x16x64_bf16 v[24:27], v[4:7], a[56:63], v74
  v_smfmac_f32_16x16x64_bf16 v[28:31], v[4:7], v[192:199], v74
  v_smfmac_f32_16x16x64_bf16 v[32:35], v[4:7], v[200:207], v74
  v_smfmac_f32_16x16x64_bf16 v[32:35], v[0:3], v[60:67], v74
  v_smfmac_f32_16x16x64_bf16 v[20:23], v[8:11], a[64:71], v74
  ds_read_b128 v[60:63], v75 offset:16384
  ds_read_b128 v[64:67], v75 offset:17408
  v_smfmac_f32_16x16x64_bf16 v[24:27], v[8:11], a[72:79], v74
  v_smfmac_f32_16x16x64_bf16 v[28:31], v[8:11], v[208:215], v74
  v_smfmac_f32_16x16x64_bf16 v[20:23], v[12:15], a[80:87], v74
  v_smfmac_f32_16x16x64_bf16 v[24:27], v[12:15], a[88:95], v74
  v_smfmac_f32_16x16x64_bf16 v[28:31], v[12:15], v[224:231], v74
  v_smfmac_f32_16x16x64_bf16 v[32:35], v[12:15], v[232:239], v74
  v_smfmac_f32_16x16x64_bf16 v[32:35], v[8:11], v[216:223], v74
  s_waitcnt vmcnt(4)
  s_waitcnt vmcnt(1)
  s_barrier
Cf0_lastr:
  ds_read_b128 v[4:7], v76 offset:8704
  ds_read_b128 v[0:3], v76 offset:9728
  ds_read_b128 v[16:19], v76 offset:10752
  ds_read_b128 v[8:11], v76 offset:11776
  ds_read_b128 v[12:15], v76 offset:12800
  s_waitcnt lgkmcnt(3)
  v_max3_u32 v72, v0, v1, v2
  v_max3_u32 v72, v72, v3, v4
  v_max3_u32 v72, v72, v5, v6
  s_waitcnt lgkmcnt(1)
  v_max3_u32 v72, v72, v7, v8
  v_max3_u32 v72, v72, v9, v10
  s_waitcnt lgkmcnt(0)
  v_max3_u32 v72, v72, v11, v12
  v_max3_u32 v72, v72, v13, v14
  v_max3_u32 v72, v72, v15, v16
  v_max3_u32 v72, v72, v17, v18
  v_max_u32 v72, v72, v19
  v_cmp_eq_u32 vcc, -1, v72
  s_cbranch_vccnz Cf0_lastp
Cf0_lastg:
  v_smfmac_f32_16x16x64_bf16 v[28:31], v[4:7], v[44:51], v74
  ds_read_b128 v[44:47], v75 offset:18432
  ds_read_b128 v[48:51], v75 offset:19456
  v_smfmac_f32_16x16x64_bf16 v[32:35], v[4:7], v[36:43], v74
  v_smfmac_f32_16x16x64_bf16 v[28:31], v[0:3], v[60:67], v74
  v_smfmac_f32_16x16x64_bf16 v[28:31], v[16:19], v[240:247], v74
  v_smfmac_f32_16x16x64_bf16 v[28:31], v[8:11], a[0:7], v74
  v_smfmac_f32_16x16x64_bf16 v[28:31], v[12:15], a[16:23], v74
  v_smfmac_f32_16x16x64_bf16 v[32:35], v[16:19], v[248:255], v74
  v_smfmac_f32_16x16x64_bf16 v[32:35], v[8:11], a[8:15], v74
  s_waitcnt lgkmcnt(0)
  v_smfmac_f32_16x16x64_bf16 v[32:35], v[12:15], a[24:31], v74
  v_smfmac_f32_16x16x64_bf16 v[32:35], v[0:3], v[44:51], v74
  v_smfmac_f32_16x16x64_bf16 v[20:23], v[4:7], a[96:103], v74
  v_smfmac_f32_16x16x64_bf16 v[20:23], v[0:3], a[112:119], v74
  v_add_f32 v28, v28, v30
  v_add_f32 v32, v32, v34
  v_cvt_pk_bf16_f32 v30, v28, v32
  v_smfmac_f32_16x16x64_bf16 v[20:23], v[16:19], a[128:135], v74
  ds_write_b32 v79, v30 offset:256
  v_add_f32 v29, v29, v31
  v_add_f32 v33, v33, v35
  v_cvt_pk_bf16_f32 v31, v29, v33
  v_smfmac_f32_16x16x64_bf16 v[20:23], v[8:11], a[144:151], v74
  ds_write_b32 v79, v31 offset:832
  v_smfmac_f32_16x16x64_bf16 v[20:23], v[12:15], a[160:167], v74
  v_smfmac_f32_16x16x64_bf16 v[24:27], v[4:7], a[104:111], v74
  v_smfmac_f32_16x16x64_bf16 v[24:27], v[0:3], a[120:127], v74
  v_smfmac_f32_16x16x64_bf16 v[24:27], v[16:19], a[136:143], v74
  s_waitcnt lgkmcnt(0)
  s_barrier
  ds_read_b64 v[52:53], v77 offset:256
  v_add_f32 v20, v20, v22
  v_smfmac_f32_16x16x64_bf16 v[24:27], v[8:11], a[152:159], v74
  v_add_f32 v21, v21, v23
  v_smfmac_f32_16x16x64_bf16 v[24:27], v[12:15], a[168:175], v74
  v_cvt_pk_bf16_f32 v54, v20, v21
  s_add_u32 s68, s68, 655360
  s_nop 3
  v_add_f32 v24, v24, v26
  v_add_f32 v25, v25, v27
  v_cvt_pk_bf16_f32 v55, v24, v25
  s_waitcnt lgkmcnt(0)
  buffer_store_dwordx4 v[52:55], v76, s[8:11], s68 offen sc1
  s_branch Cf0_done
Cf0_lastp:
  s_add_u32 s72, s72, 2
  s_cmp_ge_u32 s72, 131072
  s_cbranch_scc1 Cf0_lastg
  s_barrier
  buffer_load_dwordx4 v76, s[8:11], s55 offen offset:0 sc1 lds
  buffer_load_dwordx4 v76, s[8:11], s55 offen offset:1024 sc1 lds
  buffer_load_dwordx4 v76, s[8:11], s55 offen offset:2048 sc1 lds
  s_waitcnt vmcnt(0)
  s_barrier
  s_branch Cf0_lastr
Cf0_done:
  s_branch L_cexit
L_w1:
  v_mov_b64 v[20:21], 0
  v_mov_b64 v[22:23], 0
  v_mov_b64 v[24:25], 0
  v_mov_b64 v[26:27], 0
  v_mov_b64 v[28:29], 0
  v_mov_b64 v[30:31], 0
  v_mov_b64 v[32:33], 0
  v_mov_b64 v[34:35], 0
  s_mov_b32 s78, 0x3f803f80
  s_mov_b32 s79, s78
  s_mov_b32 s65, 360448
  s_mov_b32 m0, 15872
  s_lshl_b32 s71, s53, 2
  s_add_u32 s71, s71, 128
  s_movk_i32 s56, 0x1000
  v_lshlrev_b32 v73, 2, v76
  v_mov_b32 v72, 0
  s_mov_b64 s[16:17], s[8:9]
  s_mov_b32 s18, 268435456
  s_mov_b32 s19, 0x20000
  s_getpc_b64 s[20:21]
Cf1_pc:
  s_add_u32 s20, s20, (Cf1_last - Cf1_pc)
  s_addc_u32 s21, s21, 0
  v_mov_b32 v68, 14880
  buffer_load_dwordx4 v[52:55], v76, s[8:11], s59 offen offset:0 sc1
  buffer_load_dwordx4 v[56:59], v76, s[8:11], s59 offen offset:1024 sc1
  ds_read_b128 v[60:63], v76 offset:20480
  ds_read_b128 v[64:67], v76 offset:21504
  ds_read_b128 v[44:47], v76 offset:22528
  ds_read_b128 v[48:51], v76 offset:23552
  ds_read_b128 v[36:39], v76 offset:36864
  ds_read_b128 v[40:43], v76 offset:37888
  ds_read_b128 v[0:3], v76 offset:4608
  ds_read_b128 v[4:7], v76 offset:5632
  ds_read_b128 v[8:11], v76 offset:6656
  ds_read_b128 v[12:15], v76 offset:7680
  s_waitcnt lgkmcnt(0)
  s_cmp_eq_u32 s66, 1
  s_branch Cf1_top2
.p2align 6
Cf1_h2:
  v_lshlrev_b32 v73, 2, v76
  s_nop 15
  s_nop 3
  buffer_load_dwordx4 v[8:11], v76, s[8:11], s65 offen offset:2048 sc1
  s_nop 15
  s_nop 3
  buffer_load_dwordx4 v[8:11], v76, s[8:11], s65 offen offset:2048 sc1
  s_nop 15
  s_nop 3
  buffer_load_dwordx4 v[8:11], v76, s[8:11], s65 offen offset:2048 sc1
  s_waitcnt vmcnt(5)
  ds_read_b128 v[60:63], v76 offset:20480
  ds_read_b128 v[64:67], v76 offset:21504
  ds_read_b128 v[44:47], v76 offset:22528
  ds_read_b128 v[48:51], v76 offset:23552
  ds_read_b128 v[36:39], v76 offset:36864
  ds_read_b128 v[40:43], v76 offset:37888
  buffer_load_dwordx4 v[52:55], v76, s[8:11], s59 offen offset:0 sc1
  buffer_load_dwordx4 v[56:59], v76, s[8:11], s59 offen offset:1024 sc1
  s_waitcnt vmcnt(4)
  v_max3_u32 v72, v8, v9, v10
  v_max_u32 v72, v72, v11
  ds_write_b128 v76, v[8:11] offset:6656
  v_cmp_eq_u32 vcc, -1, v72
  s_cbranch_vccnz Cf1_h2r
Cf1_h2w:
  s_cmp_eq_u32 s66, 63
  s_waitcnt lgkmcnt(0)
  s_barrier
  ds_read_b128 v[0:3], v76 offset:4608
Cf1_top2:
  v_smfmac_f32_16x16x64_bf16 v[20:23], v[8:11], v[96:103], v74
  s_cbranch_scc1 Cf1_last
  v_smfmac_f32_16x16x64_bf16 v[24:27], v[8:11], v[104:111], v74
  ds_read_b128 v[4:7], v76 offset:5632
  v_smfmac_f32_16x16x64_bf16 v[28:31], v[8:11], v[208:215], v74
  ds_read_b128 v[12:15], v76 offset:7680
  v_smfmac_f32_16x16x64_bf16 v[32:35], v[8:11], v[216:223], v74
  s_waitcnt lgkmcnt(2)
  v_smfmac_f32_16x16x64_bf16 v[24:27], v[0:3], v[44:51], v74
  buffer_load_dwordx4 v[44:47], v76, s[8:11], s58 offen offset:0 sc1
  v_smfmac_f32_16x16x64_bf16 v[20:23], v[0:3], v[60:67], v74
  buffer_load_dwordx4 v[48:51], v76, s[8:11], s58 offen offset:1024 sc1
  ds_read_b128 v[60:63], v76 offset:38912
  v_smfmac_f32_16x16x64_bf16 v[28:31], v[0:3], v[36:43], v74
  ds_read_b128 v[64:67], v76 offset:39936
  s_waitcnt lgkmcnt(3)
  v_smfmac_f32_16x16x64_bf16 v[20:23], v[4:7], v[80:87], v74
  ds_read_b128 v[36:39], v76 offset:53248
  v_smfmac_f32_16x16x64_bf16 v[24:27], v[4:7], v[88:95], v74
  ds_read_b128 v[40:43], v76 offset:54272
  s_waitcnt lgkmcnt(4)
  v_smfmac_f32_16x16x64_bf16 v[28:31], v[4:7], v[192:199], v74
  buffer_store_dwordx4 v[16:19], v76, s[8:11], s68 offen sc1
  s_waitcnt vmcnt(3)
  v_smfmac_f32_16x16x64_bf16 v[32:35], v[4:7], v[200:207], v74
  s_barrier
  s_waitcnt lgkmcnt(2)
  v_smfmac_f32_16x16x64_bf16 v[32:35], v[0:3], v[60:67], v74
  buffer_load_dword v73, s[16:19], s70 offen lds
  ds_read_b128 v[8:11], v76 offset:8704
  v_smfmac_f32_16x16x64_bf16 v[20:23], v[12:15], v[112:119], v74
  ds_read_b128 v[60:63], v76 offset:55296
  ds_read_b128 v[64:67], v76 offset:56320
  v_smfmac_f32_16x16x64_bf16 v[24:27], v[12:15], v[120:127], v74
  ds_read_b128 v[4:7], v76 offset:9728
  v_smfmac_f32_16x16x64_bf16 v[28:31], v[12:15], v[224:231], v74
  v_smfmac_f32_16x16x64_bf16 v[32:35], v[12:15], v[232:239], v74
  s_waitcnt lgkmcnt(3)
  v_smfmac_f32_16x16x64_bf16 v[28:31], v[8:11], v[36:43], v74
  ds_read_b128 v[36:39], v75 offset:4096
  ds_read_b128 v[40:43], v75 offset:5120
  s_waitcnt lgkmcnt(3)
  v_smfmac_f32_16x16x64_bf16 v[32:35], v[8:11], v[60:67], v74
  s_barrier
  ds_read_b128 v[16:19], v76 offset:10752
  v_smfmac_f32_16x16x64_bf16 v[20:23], v[8:11], v[128:135], v74
  ds_read_b128 v[60:63], v75 offset:6144
  ds_read_b128 v[64:67], v75 offset:7168
  v_smfmac_f32_16x16x64_bf16 v[24:27], v[8:11], v[136:143], v74
  ds_read_b128 v[0:3], v76 offset:11776
  s_waitcnt lgkmcnt(6)
  v_smfmac_f32_16x16x64_bf16 v[20:23], v[4:7], v[144:151], v74
  ds_read_b128 v[12:15], v76 offset:12800
  v_smfmac_f32_16x16x64_bf16 v[24:27], v[4:7], v[152:159], v74
  s_waitcnt lgkmcnt(4)
  v_smfmac_f32_16x16x64_bf16 v[20:23], v[16:19], v[36:43], v74
  ds_read_b128 v[36:39], v75 offset:20480
  s_waitcnt lgkmcnt(3)
  v_smfmac_f32_16x16x64_bf16 v[24:27], v[16:19], v[60:67], v74
  ds_read_b128 v[40:43], v75 offset:21504
  s_waitcnt lgkmcnt(3)
  v_smfmac_f32_16x16x64_bf16 v[20:23], v[0:3], v[160:167], v74
  ds_read_b128 v[60:63], v75 offset:22528
  s_waitcnt lgkmcnt(3)
  v_smfmac_f32_16x16x64_bf16 v[20:23], v[12:15], v[176:183], v74
  ds_read_b128 v[64:67], v75 offset:23552
  v_smfmac_f32_16x16x64_bf16 v[24:27], v[0:3], v[168:175], v74
  v_mov_b64 v[70:71], s[78:79]
  v_smfmac_f32_16x16x64_bf16 v[24:27], v[12:15], v[184:191], v74
  s_waitcnt lgkmcnt(2)
  v_add_f32 v20, v20, v22
  v_smfmac_f32_16x16x64_bf16 v[28:31], v[4:7], v[36:43], v74
  ds_read_b128 v[36:39], v68
  s_waitcnt lgkmcnt(1)
  v_add_f32 v21, v21, v23
  v_smfmac_f32_16x16x64_bf16 v[32:35], v[4:7], v[60:67], v74
  ds_read_b128 v[40:43], v68
  v_add_f32 v24, v24, v26
  v_smfmac_f32_16x16x64_bf16 v[28:31], v[16:19], v[240:247], v74
  v_cvt_pk_bf16_f32 v22, v20, v24
  v_smfmac_f32_16x16x64_bf16 v[28:31], v[0:3], a[0:7], v74
  ds_write_b32 v79, v22 offset:0
  v_add_f32 v25, v25, v27
  v_cvt_pk_bf16_f32 v23, v21, v25
  v_smfmac_f32_16x16x64_bf16 v[28:31], v[12:15], a[16:23], v74
  ds_write_b32 v79, v23 offset:576
  v_cmp_u_f32 vcc, v20, v21
  v_smfmac_f32_16x16x64_bf16 v[32:35], v[16:19], v[248:255], v74
  v_mov_b64 v[68:69], s[78:79]
  v_smfmac_f32_16x16x64_bf16 v[32:35], v[0:3], a[8:15], v74
  v_add_f32 v28, v28, v30
  v_add_f32 v29, v29, v31
  v_smfmac_f32_16x16x64_bf16 v[32:35], v[12:15], a[24:31], v74
  s_cbranch_vccnz Cf1_rec
Cf1_recok:
  s_waitcnt lgkmcnt(3)
  v_smfmac_f32_16x16x64_bf16 v[36:39], v[16:19], a[128:135], v74
  s_waitcnt lgkmcnt(0)
  s_barrier
  ds_read_b128 v[60:63], v77
  v_smfmac_f32_16x16x64_bf16 v[40:43], v[16:19], a[136:143], v74
  ds_read_b128 v[64:67], v77 offset:128
  v_add_f32 v32, v32, v34
  v_cvt_pk_bf16_f32 v30, v28, v32
  v_smfmac_f32_16x16x64_bf16 v[36:39], v[0:3], a[144:151], v74
  ds_write_b32 v79, v30 offset:256
  v_add_f32 v33, v33, v35
  v_cvt_pk_bf16_f32 v31, v29, v33
  v_smfmac_f32_16x16x64_bf16 v[40:43], v[0:3], a[152:159], v74
  ds_write_b32 v79, v31 offset:832
  v_xor_b32 v75, 0x8000, v75
  v_smfmac_f32_16x16x64_bf16 v[36:39], v[4:7], a[112:119], v74
  ds_read_b128 v[0:3], v76 offset:4608
  v_mov_b32 v29, 0
  v_smfmac_f32_16x16x64_bf16 v[40:43], v[4:7], a[120:127], v74
  s_waitcnt vmcnt(2) lgkmcnt(3)
  v_mov_b32 v30, 0
  v_mfma_f32_16x16x32_bf16 v[44:47], v[44:47], v[60:63], 0
  ds_read_b128 v[4:7], v76 offset:5632
  s_waitcnt lgkmcnt(2)
  v_mfma_f32_16x16x32_bf16 v[44:47], v[48:51], v[64:67], v[44:47]
  s_barrier
  v_smfmac_f32_16x16x64_bf16 v[36:39], v[8:11], a[96:103], v74
  ds_read_b128 v[20:23], v77 offset:256
  ds_read_b128 v[24:27], v77 offset:384
  v_smfmac_f32_16x16x64_bf16 v[40:43], v[8:11], a[104:111], v74
  ds_read_b128 v[8:11], v76 offset:6656
  v_add_f32_dpp v72, v46, v44 quad_perm:[2,3,0,1] row_mask:0xf bank_mask:0xf
  v_add_f32_dpp v73, v47, v45 quad_perm:[2,3,0,1] row_mask:0xf bank_mask:0xf
  v_smfmac_f32_16x16x64_bf16 v[36:39], v[12:15], a[160:167], v74
  s_waitcnt lgkmcnt(4)
  v_exp_f32_dpp v72, v72 quad_perm:[0,1,0,1] row_mask:0xf bank_mask:0xf
  v_smfmac_f32_16x16x64_bf16 v[40:43], v[12:15], a[168:175], v74
  ds_read_b128 v[12:15], v76 offset:7680
  v_exp_f32_dpp v73, v73 quad_perm:[0,1,0,1] row_mask:0xf bank_mask:0xf
  v_smfmac_f32_16x16x64_bf16 v[36:39], v[0:3], a[32:39], v74
  s_waitcnt lgkmcnt(2)
  v_cvt_pk_bf16_f32 v72, v72, v73
  v_mfma_f32_16x16x32_bf16 v[20:23], v[20:23], v[60:63], 0
  ds_write_b32 v78, v72 offset:516
  v_mov_b64 v[16:17], 0
  v_mfma_f32_16x16x32_bf16 v[20:23], v[24:27], v[64:67], v[20:23]
  ds_read_b128 v[44:47], v75 offset:20480
  v_mov_b64 v[18:19], 0
  v_smfmac_f32_16x16x64_bf16 v[40:43], v[0:3], a[40:47], v74
  ds_read_b128 v[48:51], v75 offset:21504
  s_waitcnt lgkmcnt(4)
  v_smfmac_f32_16x16x64_bf16 v[36:39], v[4:7], a[48:55], v74
  v_add_f32_dpp v24, v22, v20 quad_perm:[2,3,0,1] row_mask:0xf bank_mask:0xf
  v_add_f32_dpp v25, v23, v21 quad_perm:[2,3,0,1] row_mask:0xf bank_mask:0xf
  v_smfmac_f32_16x16x64_bf16 v[36:39], v[8:11], a[64:71], v74
  s_waitcnt lgkmcnt(2)
  s_barrier
  ds_read_b128 v[32:35], v78 offset:512
  v_smfmac_f32_16x16x64_bf16 v[36:39], v[12:15], a[80:87], v74
  ds_read_b128 v[60:63], v75 offset:22528
  v_mul_f32 v24, s69, v24
  v_smfmac_f32_16x16x64_bf16 v[40:43], v[4:7], a[56:63], v74
  ds_read_b128 v[64:67], v75 offset:23552
  v_mul_f32 v25, s69, v25
  v_smfmac_f32_16x16x64_bf16 v[40:43], v[8:11], a[72:79], v74
  v_exp_f32_dpp v24, v24 quad_perm:[0,1,0,1] row_mask:0xf bank_mask:0xf
  v_smfmac_f32_16x16x64_bf16 v[40:43], v[12:15], a[88:95], v74
  s_waitcnt lgkmcnt(2)
  v_exp_f32_dpp v25, v25 quad_perm:[0,1,0,1] row_mask:0xf bank_mask:0xf
  v_mfma_f32_16x16x32_bf16 v[8:11], v[32:35], v[68:71], 0
  v_add_f32 v36, v36, v38
  v_add_f32 v37, v37, v39
  v_mfma_f32_16x16x32_bf16 v[0:3], v[32:35], v[52:55], 0
  v_add_f32 v40, v40, v42
  v_add_f32 v41, v41, v43
  v_mfma_f32_16x16x32_bf16 v[4:7], v[32:35], v[56:59], 0
  v_cvt_pk_bf16_f32 v28, v24, v25
  v_cvt_pk_bf16_f32 v72, v36, v37
  v_cvt_pk_bf16_f32 v73, v40, v41
  v_mfma_f32_16x16x16_bf16 v[8:11], v[28:29], v[68:69], v[8:11]
  v_cvt_pk_bf16_f32 v31, v24, v25
  v_mov_b64 v[20:21], 0
  v_mfma_f32_16x16x16_bf16 v[0:3], v[28:29], v[72:73], v[0:3]
  ds_read_b128 v[68:71], v76 offset:13824
  v_mov_b64 v[22:23], 0
  v_mfma_f32_16x16x16_bf16 v[4:7], v[30:31], v[72:73], v[4:7]
  v_rcp_f32 v10, v8
  v_rcp_f32 v11, v9
  v_mul_f32 v0, v10, v0
  v_mul_f32 v1, v11, v1
  s_nop 0
  v_mul_f32 v4, v10, v4
  v_mul_f32 v5, v11, v5
  v_cvt_pk_bf16_f32 v2, v0, v4
  ds_write_b32 v79, v2 offset:8704
  v_cvt_pk_bf16_f32 v3, v1, v5
  ds_write_b32 v79, v3 offset:9280
  v_max3_f32 v8, v8, v9, v10
  v_max_f32 v8, v8, v11
  v_cmp_le_f32 vcc, 1317011456, v8
  v_mov_b64 v[24:25], 0
  v_mov_b64 v[26:27], 0
  s_cbranch_vccnz Cf1_mx
Cf1_mxok:
  s_waitcnt lgkmcnt(0)
  s_barrier
  ds_read_b128 v[0:3], v78 offset:8704
  ds_read_b128 v[4:7], v78 offset:8768
  ds_read_b128 v[8:11], v78 offset:8832
  ds_read_b128 v[12:15], v78 offset:8896
  s_waitcnt lgkmcnt(3)
  v_smfmac_f32_16x16x64_bf16 v[16:19], v[0:3], v[44:51], v74
  ds_read_b128 v[52:55], v75 offset:36864
  s_waitcnt lgkmcnt(3)
  v_smfmac_f32_16x16x64_bf16 v[16:19], v[4:7], v[60:67], v74
  ds_read_b128 v[56:59], v75 offset:37888
  s_waitcnt lgkmcnt(3)
  v_smfmac_f32_16x16x64_bf16 v[16:19], v[8:11], a[176:183], v74
  ds_read_b128 v[36:39], v75 offset:38912
  s_waitcnt lgkmcnt(3)
  v_smfmac_f32_16x16x64_bf16 v[16:19], v[12:15], a[184:191], v74
  ds_read_b128 v[40:43], v75 offset:39936
  ds_read_b128 v[44:47], v75 offset:53248
  v_smfmac_f32_16x16x64_bf16 v[20:23], v[0:3], a[192:199], v74
  ds_read_b128 v[48:51], v75 offset:54272
  ds_read_b128 v[60:63], v75 offset:55296
  v_smfmac_f32_16x16x64_bf16 v[20:23], v[4:7], a[200:207], v74
  ds_read_b128 v[64:67], v75 offset:56320
  s_waitcnt lgkmcnt(6)
  v_cvt_pk_bf16_f32 v16, v16, v17
  v_cvt_pk_bf16_f32 v17, v18, v19
  v_bfi_b32 v16, 1, s72, v16
  v_smfmac_f32_16x16x64_bf16 v[20:23], v[8:11], v[52:59], v74
  buffer_store_dwordx2 v[16:17], v68, s[8:11], s73 offen
  s_waitcnt lgkmcnt(4)
  v_smfmac_f32_16x16x64_bf16 v[20:23], v[12:15], v[36:43], v74
  v_mov_b64 v[32:33], 0
  v_smfmac_f32_16x16x64_bf16 v[24:27], v[0:3], a[208:215], v74
  v_mov_b64 v[34:35], 0
  v_smfmac_f32_16x16x64_bf16 v[24:27], v[4:7], a[216:223], v74
  s_waitcnt lgkmcnt(2)
  v_cvt_pk_bf16_f32 v20, v20, v21
  v_cvt_pk_bf16_f32 v21, v22, v23
  v_bfi_b32 v20, 1, s72, v20
  v_smfmac_f32_16x16x64_bf16 v[24:27], v[8:11], v[44:51], v74
  buffer_store_dwordx2 v[20:21], v68, s[8:11], s74 offen
  s_waitcnt lgkmcnt(0)
  v_smfmac_f32_16x16x64_bf16 v[24:27], v[12:15], v[60:67], v74
  v_smfmac_f32_16x16x64_bf16 v[32:35], v[0:3], a[224:231], v74
  v_smfmac_f32_16x16x64_bf16 v[32:35], v[4:7], a[232:239], v74
  v_cvt_pk_bf16_f32 v24, v24, v25
  v_cvt_pk_bf16_f32 v25, v26, v27
  v_bfi_b32 v24, 1, s72, v24
  v_smfmac_f32_16x16x64_bf16 v[32:35], v[8:11], a[240:247], v74
  s_nop 1
  buffer_store_dwordx2 v[24:25], v68, s[8:11], s75 offen
  v_smfmac_f32_16x16x64_bf16 v[32:35], v[12:15], a[248:255], v74
  ds_read_b128 v[0:3], v76 offset:14848
  ds_read_b64 v[16:17], v77 offset:264
  v_mov_b64 v[18:19], v[72:73]
  v_xor_b32 v75, 0x8000, v75
  s_nop 3
  v_cvt_pk_bf16_f32 v32, v32, v33
  v_cvt_pk_bf16_f32 v33, v34, v35
  v_bfi_b32 v32, 1, s72, v32
  buffer_store_dwordx2 v[32:33], v68, s[8:11], s76 offen
  v_mov_b64 v[20:21], 0
  v_mov_b64 v[22:23], 0
  v_mov_b64 v[24:25], 0
  v_mov_b64 v[26:27], 0
  v_mov_b64 v[28:29], 0
  v_mov_b64 v[30:31], 0
  v_mov_b64 v[32:33], 0
  v_mov_b64 v[34:35], 0
  v_mov_b32 v68, 14880
  s_add_u32 s58, s58, 655360
  s_add_u32 s59, s59, 655360
  s_add_u32 s70, s70, 655360
  s_add_u32 s68, s68, 655360
  s_add_u32 s66, s66, 1
  s_xor_b32 s64, s64, 16384
  s_xor_b32 s65, s65, 16384
  s_cmp_eq_u32 s66, 62
  s_cselect_b64 s[16:17], s[20:21], s[16:17]
  s_cselect_b32 s18, (Cf1_done - Cf1_last), s18
  s_cselect_b32 s70, 0, s70
  s_cmp_eq_u32 s66, 63
  s_cselect_b32 s59, 268435456, s59
  s_nop 15
  s_nop 15
  s_nop 1
  buffer_load_dwordx4 v[52:55], v76, s[8:11], s60 offen offset:0 sc1
  buffer_load_dwordx4 v[56:59], v76, s[8:11], s60 offen offset:1024 sc1
  s_nop 15
  s_nop 11
  buffer_load_dwordx4 v[36:39], v76, s[8:11], s60 offen offset:0 sc1
  buffer_load_dwordx4 v[40:43], v76, s[8:11], s60 offen offset:1024 sc1
  s_waitcnt lgkmcnt(0)
  s_waitcnt vmcnt(3)
  v_mfma_f32_16x16x32_bf16 v[4:7], v[0:3], v[52:55], 0
  v_bitop3_b32 v72, v52, v54, s72 bitop3:0x7e
  s_waitcnt vmcnt(2)
  v_mfma_f32_16x16x32_bf16 v[4:7], v[0:3], v[56:59], v[4:7]
  v_bitop3_b32 v73, v56, v58, s72 bitop3:0x7e
  v_bitop3_b32 v72, v72, v73, 1 bitop3:0xa8
  v_cmp_ne_u32 vcc, 0, v72
  s_cbranch_vccnz Cf1_h1r
  s_nop 2
  v_add_f32_dpp v4, v4, v4 row_ror:4 row_mask:0xf bank_mask:0xf
  v_add_f32_dpp v5, v5, v5 row_ror:4 row_mask:0xf bank_mask:0xf
  s_nop 0
  v_add_f32_dpp v4, v4, v4 row_ror:8 row_mask:0xf bank_mask:0xf
  v_add_f32_dpp v5, v5, v5 row_ror:8 row_mask:0xf bank_mask:0xf
  v_cvt_pk_bf16_f32 v4, v4, v5
  buffer_store_dword v4, v69, s[8:11], s62 offen
  s_xor_b32 s62, s62, 16384
  buffer_store_dword v71, v69, s[8:11], s62 offen
  s_xor_b32 s72, s72, 1
  s_branch Cf1_h2
Cf1_h1r:
  s_mov_b64 exec, vcc
  buffer_load_dwordx4 v[52:55], v76, s[8:11], s60 offen offset:0 sc1
  buffer_load_dwordx4 v[56:59], v76, s[8:11], s60 offen offset:1024 sc1
  s_mov_b64 exec, -1
  s_add_u32 s67, s67, 1
  s_waitcnt vmcnt(3)
  v_mfma_f32_16x16x32_bf16 v[4:7], v[0:3], v[36:39], 0
  v_bitop3_b32 v72, v36, v38, s72 bitop3:0x7e
  s_waitcnt vmcnt(2)
  v_mfma_f32_16x16x32_bf16 v[4:7], v[0:3], v[40:43], v[4:7]
  v_bitop3_b32 v73, v40, v42, s72 bitop3:0x7e
  v_bitop3_b32 v72, v72, v73, 1 bitop3:0xa8
  v_cmp_ne_u32 vcc, 0, v72
  s_cbranch_vccz Cf1_h1p
  s_mov_b64 exec, vcc
  buffer_load_dwordx4 v[36:39], v76, s[8:11], s60 offen offset:0 sc1
  buffer_load_dwordx4 v[40:43], v76, s[8:11], s60 offen offset:1024 sc1
  s_mov_b64 exec, -1
  s_add_u32 s67, s67, 1
  s_waitcnt vmcnt(3)
  v_mfma_f32_16x16x32_bf16 v[4:7], v[0:3], v[52:55], 0
  v_bitop3_b32 v72, v52, v54, s72 bitop3:0x7e
  s_waitcnt vmcnt(2)
  v_mfma_f32_16x16x32_bf16 v[4:7], v[0:3], v[56:59], v[4:7]
  v_bitop3_b32 v73, v56, v58, s72 bitop3:0x7e
  v_bitop3_b32 v72, v72, v73, 1 bitop3:0xa8
  v_cmp_ne_u32 vcc, 0, v72
  s_cbranch_vccz Cf1_h1p
Cf1_h1s:
  s_mov_b64 exec, vcc
  buffer_load_dwordx4 v[52:55], v76, s[8:11], s60 offen offset:0 sc1
  buffer_load_dwordx4 v[56:59], v76, s[8:11], s60 offen offset:1024 sc1
  s_mov_b64 exec, -1
  s_add_u32 s67, s67, 1
  s_waitcnt vmcnt(3)
  v_mfma_f32_16x16x32_bf16 v[4:7], v[0:3], v[36:39], 0
  v_bitop3_b32 v72, v36, v38, s72 bitop3:0x7e
  s_waitcnt vmcnt(2)
  v_mfma_f32_16x16x32_bf16 v[4:7], v[0:3], v[40:43], v[4:7]
  v_bitop3_b32 v73, v40, v42, s72 bitop3:0x7e
  v_bitop3_b32 v72, v72, v73, 1 bitop3:0xa8
  v_cmp_ne_u32 vcc, 0, v72
  s_cbranch_vccz Cf1_h1p
  s_mov_b64 exec, vcc
  buffer_load_dwordx4 v[36:39], v76, s[8:11], s60 offen offset:0 sc1
  buffer_load_dwordx4 v[40:43], v76, s[8:11], s60 offen offset:1024 sc1
  s_mov_b64 exec, -1
  s_add_u32 s67, s67, 1
  s_waitcnt vmcnt(3)
  v_mfma_f32_16x16x32_bf16 v[4:7], v[0:3], v[52:55], 0
  v_bitop3_b32 v72, v52, v54, s72 bitop3:0x7e
  s_waitcnt vmcnt(2)
  v_mfma_f32_16x16x32_bf16 v[4:7], v[0:3], v[56:59], v[4:7]
  v_bitop3_b32 v73, v56, v58, s72 bitop3:0x7e
  v_bitop3_b32 v72, v72, v73, 1 bitop3:0xa8
  v_cmp_ne_u32 vcc, 0, v72
  s_cbranch_vccz Cf1_h1p
  s_cmp_lt_u32 s67, 131072
  s_cbranch_scc1 Cf1_h1s
Cf1_h1p:
  s_nop 2
  v_add_f32_dpp v4, v4, v4 row_ror:4 row_mask:0xf bank_mask:0xf
  v_add_f32_dpp v5, v5, v5 row_ror:4 row_mask:0xf bank_mask:0xf
  s_nop 0
  v_add_f32_dpp v4, v4, v4 row_ror:8 row_mask:0xf bank_mask:0xf
  v_add_f32_dpp v5, v5, v5 row_ror:8 row_mask:0xf bank_mask:0xf
  v_cvt_pk_bf16_f32 v4, v4, v5
  buffer_store_dword v4, v69, s[8:11], s62 offen
  s_xor_b32 s62, s62, 16384
  buffer_store_dword v71, v69, s[8:11], s62 offen
  s_xor_b32 s72, s72, 1
  s_branch Cf1_h2
Cf1_h2r:
  s_mov_b64 exec, vcc
  buffer_load_dwordx4 v[8:11], v76, s[8:11], s65 offen offset:2048 sc1
  s_mov_b64 exec, -1
  s_add_u32 s67, s67, 1
  s_waitcnt vmcnt(4)
  v_max3_u32 v72, v8, v9, v10
  v_max_u32 v72, v72, v11
  ds_write_b128 v76, v[8:11] offset:6656
  v_cmp_eq_u32 vcc, -1, v72
  s_cbranch_vccz Cf1_h2w
  s_mov_b64 exec, vcc
  buffer_load_dwordx4 v[8:11], v76, s[8:11], s65 offen offset:2048 sc1
  s_mov_b64 exec, -1
  s_add_u32 s67, s67, 1
  s_waitcnt vmcnt(4)
  v_max3_u32 v72, v8, v9, v10
  v_max_u32 v72, v72, v11
  ds_write_b128 v76, v[8:11] offset:6656
  v_cmp_eq_u32 vcc, -1, v72
  s_cbranch_vccz Cf1_h2w
Cf1_h2s:
  s_mov_b64 exec, vcc
  buffer_load_dwordx4 v[8:11], v76, s[8:11], s65 offen offset:2048 sc1
  s_mov_b64 exec, -1
  s_add_u32 s67, s67, 1
  s_waitcnt vmcnt(2)
  v_max3_u32 v72, v8, v9, v10
  v_max_u32 v72, v72, v11
  ds_write_b128 v76, v[8:11] offset:6656
  v_cmp_eq_u32 vcc, -1, v72
  s_cbranch_vccz Cf1_h2w
  s_mov_b64 exec, vcc
  buffer_load_dwordx4 v[8:11], v76, s[8:11], s65 offen offset:2048 sc1
  s_mov_b64 exec, -1
  s_add_u32 s67, s67, 1
  s_waitcnt vmcnt(2)
  v_max3_u32 v72, v8, v9, v10
  v_max_u32 v72, v72, v11
  ds_write_b128 v76, v[8:11] offset:6656
  v_cmp_eq_u32 vcc, -1, v72
  s_cbranch_vccz Cf1_h2w
  s_mov_b64 exec, vcc
  buffer_load_dwordx4 v[8:11], v76, s[8:11], s65 offen offset:2048 sc1
  s_mov_b64 exec, -1
  s_add_u32 s67, s67, 1
  s_waitcnt vmcnt(2)
  v_max3_u32 v72, v8, v9, v10
  v_max_u32 v72, v72, v11
  ds_write_b128 v76, v[8:11] offset:6656
  v_cmp_eq_u32 vcc, -1, v72
  s_cbranch_vccz Cf1_h2w
  s_cmp_lt_u32 s67, 131072
  s_cbranch_scc1 Cf1_h2s
  s_branch Cf1_h2w
Cf1_rec:
  s_nop 7
  s_waitcnt vmcnt(0) lgkmcnt(0)
  v_max3_u32 v72, v0, v1, v2
  v_max3_u32 v72, v72, v3, v4
  v_max3_u32 v72, v72, v5, v6
  v_max3_u32 v72, v72, v7, v8
  v_max3_u32 v72, v72, v9, v10
  v_max3_u32 v72, v72, v11, v12
  v_max3_u32 v72, v72, v13, v14
  v_max3_u32 v72, v72, v15, v16
  v_max3_u32 v72, v72, v17, v18
  v_max_u32 v72, v72, v19
  v_cmp_eq_u32 vcc, -1, v72
  s_cbranch_vccz Cf1_recok
  s_barrier
  v_mov_b64 v[20:21], 0
  v_mov_b64 v[22:23], 0
  v_mov_b64 v[24:25], 0
  v_mov_b64 v[26:27], 0
  v_mov_b64 v[28:29], 0
  v_mov_b64 v[30:31], 0
  v_mov_b64 v[32:33], 0
  v_mov_b64 v[34:35], 0
  s_waitcnt lgkmcnt(0)
  s_barrier
  ds_read_b128 v[0:3], v76 offset:4608
  ds_read_b128 v[60:63], v76 offset:20480
  ds_read_b128 v[64:67], v76 offset:21504
  s_waitcnt lgkmcnt(0)
  v_smfmac_f32_16x16x64_bf16 v[20:23], v[0:3], v[60:67], v74
  ds_read_b128 v[60:63], v76 offset:22528
  ds_read_b128 v[64:67], v76 offset:23552
  s_waitcnt lgkmcnt(0)
  v_smfmac_f32_16x16x64_bf16 v[24:27], v[0:3], v[60:67], v74
  ds_read_b128 v[60:63], v76 offset:36864
  ds_read_b128 v[64:67], v76 offset:37888
  s_waitcnt lgkmcnt(0)
  v_smfmac_f32_16x16x64_bf16 v[28:31], v[0:3], v[60:67], v74
  ds_read_b128 v[60:63], v76 offset:38912
  ds_read_b128 v[64:67], v76 offset:39936
  s_waitcnt lgkmcnt(0)
  v_smfmac_f32_16x16x64_bf16 v[32:35], v[0:3], v[60:67], v74
  ds_read_b128 v[4:7], v76 offset:5632
  s_waitcnt lgkmcnt(0)
  v_smfmac_f32_16x16x64_bf16 v[20:23], v[4:7], v[80:87], v74
  v_smfmac_f32_16x16x64_bf16 v[24:27], v[4:7], v[88:95], v74
  v_smfmac_f32_16x16x64_bf16 v[28:31], v[4:7], v[192:199], v74
  v_smfmac_f32_16x16x64_bf16 v[32:35], v[4:7], v[200:207], v74
  ds_read_b128 v[8:11], v76 offset:6656
  s_waitcnt lgkmcnt(0)
  v_smfmac_f32_16x16x64_bf16 v[20:23], v[8:11], v[96:103], v74
  v_smfmac_f32_16x16x64_bf16 v[24:27], v[8:11], v[104:111], v74
  v_smfmac_f32_16x16x64_bf16 v[28:31], v[8:11], v[208:215], v74
  v_smfmac_f32_16x16x64_bf16 v[32:35], v[8:11], v[216:223], v74
  ds_read_b128 v[12:15], v76 offset:7680
  s_waitcnt lgkmcnt(0)
  v_smfmac_f32_16x16x64_bf16 v[20:23], v[12:15], v[112:119], v74
  v_smfmac_f32_16x16x64_bf16 v[24:27], v[12:15], v[120:127], v74
  v_smfmac_f32_16x16x64_bf16 v[28:31], v[12:15], v[224:231], v74
  v_smfmac_f32_16x16x64_bf16 v[32:35], v[12:15], v[232:239], v74
  ds_read_b128 v[8:11], v76 offset:8704
  s_waitcnt lgkmcnt(0)
  v_smfmac_f32_16x16x64_bf16 v[20:23], v[8:11], v[128:135], v74
  v_smfmac_f32_16x16x64_bf16 v[24:27], v[8:11], v[136:143], v74
  ds_read_b128 v[60:63], v76 offset:53248
  ds_read_b128 v[64:67], v76 offset:54272
  s_waitcnt lgkmcnt(0)
  v_smfmac_f32_16x16x64_bf16 v[28:31], v[8:11], v[60:67], v74
  ds_read_b128 v[60:63], v76 offset:55296
  ds_read_b128 v[64:67], v76 offset:56320
  s_waitcnt lgkmcnt(0)
  v_smfmac_f32_16x16x64_bf16 v[32:35], v[8:11], v[60:67], v74
  ds_read_b128 v[4:7], v76 offset:9728
  s_waitcnt lgkmcnt(0)
  v_smfmac_f32_16x16x64_bf16 v[20:23], v[4:7], v[144:151], v74
  v_smfmac_f32_16x16x64_bf16 v[24:27], v[4:7], v[152:159], v74
  ds_read_b128 v[60:63], v75 offset:20480
  ds_read_b128 v[64:67], v75 offset:21504
  s_waitcnt lgkmcnt(0)
  v_smfmac_f32_16x16x64_bf16 v[28:31], v[4:7], v[60:67], v74
  ds_read_b128 v[60:63], v75 offset:22528
  ds_read_b128 v[64:67], v75 offset:23552
  s_waitcnt lgkmcnt(0)
  v_smfmac_f32_16x16x64_bf16 v[32:35], v[4:7], v[60:67], v74
  ds_read_b128 v[16:19], v76 offset:10752
  ds_read_b128 v[60:63], v75 offset:4096
  ds_read_b128 v[64:67], v75 offset:5120
  s_waitcnt lgkmcnt(0)
  v_smfmac_f32_16x16x64_bf16 v[20:23], v[16:19], v[60:67], v74
  ds_read_b128 v[60:63], v75 offset:6144
  ds_read_b128 v[64:67], v75 offset:7168
  s_waitcnt lgkmcnt(0)
  v_smfmac_f32_16x16x64_bf16 v[24:27], v[16:19], v[60:67], v74
  v_smfmac_f32_16x16x64_bf16 v[28:31], v[16:19], v[240:247], v74
  v_smfmac_f32_16x16x64_bf16 v[32:35], v[16:19], v[248:255], v74
  ds_read_b128 v[0:3], v76 offset:11776
  s_waitcnt lgkmcnt(0)
  v_smfmac_f32_16x16x64_bf16 v[20:23], v[0:3], v[160:167], v74
  v_smfmac_f32_16x16x64_bf16 v[24:27], v[0:3], v[168:175], v74
  v_smfmac_f32_16x16x64_bf16 v[28:31], v[0:3], a[0:7], v74
  v_smfmac_f32_16x16x64_bf16 v[32:35], v[0:3], a[8:15], v74
  ds_read_b128 v[12:15], v76 offset:12800
  s_waitcnt lgkmcnt(0)
  v_smfmac_f32_16x16x64_bf16 v[20:23], v[12:15], v[176:183], v74
  v_smfmac_f32_16x16x64_bf16 v[24:27], v[12:15], v[184:191], v74
  v_smfmac_f32_16x16x64_bf16 v[28:31], v[12:15], a[16:23], v74
  v_smfmac_f32_16x16x64_bf16 v[32:35], v[12:15], a[24:31], v74
  v_add_f32 v20, v20, v22
  v_add_f32 v21, v21, v23
  v_add_f32 v24, v24, v26
  v_cvt_pk_bf16_f32 v22, v20, v24
  s_nop 0
  ds_write_b32 v79, v22 offset:0
  v_add_f32 v25, v25, v27
  v_cvt_pk_bf16_f32 v23, v21, v25
  ds_write_b32 v79, v23 offset:576
  v_add_f32 v28, v28, v30
  v_add_f32 v29, v29, v31
  s_waitcnt lgkmcnt(0)
  s_nop 1
  s_branch Cf1_recok
Cf1_mx:
  s_waitcnt lgkmcnt(0)
  s_barrier
  buffer_load_dwordx4 v[0:3], v76, s[8:11], s58 offen offset:0 sc1
  ds_read_b128 v[20:23], v77 offset:0
  ds_read_b128 v[28:31], v77 offset:256
  buffer_load_dwordx4 v[4:7], v76, s[8:11], s58 offen offset:1024 sc1
  ds_read_b128 v[24:27], v77 offset:128
  ds_read_b128 v[32:35], v77 offset:384
  s_waitcnt vmcnt(1) lgkmcnt(3)
  v_mfma_f32_16x16x32_bf16 v[8:11], v[0:3], v[20:23], 0
  s_waitcnt vmcnt(0) lgkmcnt(1)
  v_mfma_f32_16x16x32_bf16 v[8:11], v[4:7], v[24:27], v[8:11]
  v_mfma_f32_16x16x32_bf16 v[12:15], v[28:31], v[20:23], 0
  s_waitcnt lgkmcnt(0)
  v_mfma_f32_16x16x32_bf16 v[12:15], v[32:35], v[24:27], v[12:15]
  v_add_f32_dpp v8, v10, v8 quad_perm:[2,3,0,1] row_mask:0xf bank_mask:0xf
  v_add_f32_dpp v9, v11, v9 quad_perm:[2,3,0,1] row_mask:0xf bank_mask:0xf
  s_nop 0
  v_mov_b32_dpp v8, v8 quad_perm:[0,1,0,1] row_mask:0xf bank_mask:0xf
  v_mov_b32_dpp v9, v9 quad_perm:[0,1,0,1] row_mask:0xf bank_mask:0xf
  s_nop 1
  v_add_f32_dpp v12, v14, v12 quad_perm:[2,3,0,1] row_mask:0xf bank_mask:0xf
  v_add_f32_dpp v13, v15, v13 quad_perm:[2,3,0,1] row_mask:0xf bank_mask:0xf
  s_nop 0
  v_mov_b32_dpp v12, v12 quad_perm:[0,1,0,1] row_mask:0xf bank_mask:0xf
  v_mov_b32_dpp v13, v13 quad_perm:[0,1,0,1] row_mask:0xf bank_mask:0xf
  v_mul_f32 v12, s69, v12
  ds_write_b32 v78, v8 offset:8708
  v_mul_f32 v13, s69, v13
  ds_write_b32 v78, v9 offset:8772
  s_waitcnt lgkmcnt(0)
  s_barrier
  ds_read_b128 v[36:39], v78 offset:8704
  ds_read_b128 v[40:43], v78 offset:8768
  s_waitcnt lgkmcnt(0)
  s_barrier
  v_max_f32 v16, v36, v37
  v_max3_f32 v16, v16, v38, v39
  v_max3_f32 v16, v16, v40, v41
  v_max3_f32 v16, v16, v42, v43
  v_max3_f32 v16, v16, v12, v13
  v_mov_b32 v17, v16
  s_nop 1
  v_permlane16_swap_b32 v16, v17
  v_max_f32 v16, v16, v17
  v_mov_b32 v17, v16
  s_nop 1
  v_permlane32_swap_b32 v16, v17
  v_max_f32 v16, v16, v17
  v_sub_f32 v36, v36, v16
  v_sub_f32 v37, v37, v16
  v_sub_f32 v38, v38, v16
  v_sub_f32 v39, v39, v16
  v_sub_f32 v40, v40, v16
  v_sub_f32 v41, v41, v16
  v_sub_f32 v42, v42, v16
  v_sub_f32 v43, v43, v16
  v_sub_f32 v12, v12, v16
  v_sub_f32 v13, v13, v16
  v_exp_f32 v36, v36
  v_exp_f32 v37, v37
  v_exp_f32 v38, v38
  v_exp_f32 v39, v39
  v_exp_f32 v40, v40
  v_exp_f32 v41, v41
  v_exp_f32 v42, v42
  v_exp_f32 v43, v43
  v_exp_f32 v12, v12
  v_exp_f32 v13, v13
  v_cvt_pk_bf16_f32 v32, v36, v40
  v_cvt_pk_bf16_f32 v33, v37, v41
  v_cvt_pk_bf16_f32 v34, v38, v42
  v_cvt_pk_bf16_f32 v35, v39, v43
  v_cvt_pk_bf16_f32 v28, v12, v13
  v_cvt_pk_bf16_f32 v31, v12, v13
  v_mov_b32 v29, 0
  v_mov_b32 v30, 0
  v_mov_b32 v68, 0x3f803f80
  v_mov_b32 v69, 0x3f803f80
  v_mov_b32 v70, 0x3f803f80
  v_mov_b32 v71, 0x3f803f80
  s_nop 1
  v_mfma_f32_16x16x32_bf16 v[8:11], v[32:35], v[68:71], 0
  v_mfma_f32_16x16x32_bf16 v[0:3], v[32:35], v[52:55], 0
  v_mfma_f32_16x16x32_bf16 v[4:7], v[32:35], v[56:59], 0
  v_mfma_f32_16x16x16_bf16 v[8:11], v[28:29], v[68:69], v[8:11]
  v_mfma_f32_16x16x16_bf16 v[0:3], v[28:29], v[72:73], v[0:3]
  v_mfma_f32_16x16x16_bf16 v[4:7], v[30:31], v[72:73], v[4:7]
  ds_read_b128 v[68:71], v76 offset:13824
  v_rcp_f32 v10, v8
  v_rcp_f32 v11, v9
  v_mul_f32 v0, v10, v0
  v_mul_f32 v1, v11, v1
  s_nop 0
  v_mul_f32 v4, v10, v4
  v_mul_f32 v5, v11, v5
  v_cvt_pk_bf16_f32 v2, v0, v4
  ds_write_b32 v79, v2 offset:8704
  v_cvt_pk_bf16_f32 v3, v1, v5
  ds_write_b32 v79, v3 offset:9280
  v_mov_b64 v[16:17], 0
  v_mov_b64 v[18:19], 0
  v_mov_b64 v[20:21], 0
  v_mov_b64 v[22:23], 0
  v_mov_b64 v[24:25], 0
  v_mov_b64 v[26:27], 0
  s_branch Cf1_mxok
Cf1_last:
  ds_read_b128 v[4:7], v76 offset:5632
  ds_read_b128 v[12:15], v76 offset:7680
  ds_read_b128 v[60:63], v76 offset:38912
  ds_read_b128 v[64:67], v76 offset:39936
  ds_read_b128 v[44:47], v76 offset:53248
  ds_read_b128 v[48:51], v76 offset:54272
  s_nop 3
  v_mov_b64 v[20:21], 0
  v_mov_b64 v[22:23], 0
  v_mov_b64 v[24:25], 0
  v_mov_b64 v[26:27], 0
  s_waitcnt lgkmcnt(6)
  v_smfmac_f32_16x16x64_bf16 v[28:31], v[0:3], v[36:43], v74
  v_smfmac_f32_16x16x64_bf16 v[20:23], v[0:3], a[32:39], v74
  ds_read_b128 v[36:39], v76 offset:55296
  ds_read_b128 v[40:43], v76 offset:56320
  v_smfmac_f32_16x16x64_bf16 v[24:27], v[0:3], a[40:47], v74
  s_waitcnt lgkmcnt(7)
  v_smfmac_f32_16x16x64_bf16 v[20:23], v[4:7], a[48:55], v74
  buffer_store_dwordx4 v[16:19], v76, s[8:11], s68 offen sc1
  s_waitcnt lgkmcnt(4)
  v_smfmac_f32_16x16x64_bf16 v[24:27], v[4:7], a[56:63], v74
  v_smfmac_f32_16x16x64_bf16 v[28:31], v[4:7], v[192:199], v74
  v_smfmac_f32_16x16x64_bf16 v[32:35], v[4:7], v[200:207], v74
  v_smfmac_f32_16x16x64_bf16 v[32:35], v[0:3], v[60:67], v74
  v_smfmac_f32_16x16x64_bf16 v[20:23], v[8:11], a[64:71], v74
  ds_read_b128 v[60:63], v75 offset:20480
  ds_read_b128 v[64:67], v75 offset:21504
  v_smfmac_f32_16x16x64_bf16 v[24:27], v[8:11], a[72:79], v74
  v_smfmac_f32_16x16x64_bf16 v[28:31], v[8:11], v[208:215], v74
  v_smfmac_f32_16x16x64_bf16 v[20:23], v[12:15], a[80:87], v74
  v_smfmac_f32_16x16x64_bf16 v[24:27], v[12:15], a[88:95], v74
  v_smfmac_f32_16x16x64_bf16 v[28:31], v[12:15], v[224:231], v74
  v_smfmac_f32_16x16x64_bf16 v[32:35], v[12:15], v[232:239], v74
  v_smfmac_f32_16x16x64_bf16 v[32:35], v[8:11], v[216:223], v74
  s_waitcnt vmcnt(1)
  s_barrier
Cf1_lastr:
  ds_read_b128 v[8:11], v76 offset:8704
  ds_read_b128 v[4:7], v76 offset:9728
  ds_read_b128 v[16:19], v76 offset:10752
  ds_read_b128 v[0:3], v76 offset:11776
  ds_read_b128 v[12:15], v76 offset:12800
  s_waitcnt lgkmcnt(1)
  v_max3_u32 v72, v0, v1, v2
  v_max3_u32 v72, v72, v3, v4
  v_max3_u32 v72, v72, v5, v6
  v_max3_u32 v72, v72, v7, v8
  v_max3_u32 v72, v72, v9, v10
  s_waitcnt lgkmcnt(0)
  v_max3_u32 v72, v72, v11, v12
  v_max3_u32 v72, v72, v13, v14
  v_max3_u32 v72, v72, v15, v16
  v_max3_u32 v72, v72, v17, v18
  v_max_u32 v72, v72, v19
  v_cmp_eq_u32 vcc, -1, v72
  s_cbranch_vccnz Cf1_lastp
Cf1_lastg:
  v_smfmac_f32_16x16x64_bf16 v[28:31], v[8:11], v[44:51], v74
  ds_read_b128 v[44:47], v75 offset:22528
  ds_read_b128 v[48:51], v75 offset:23552
  v_smfmac_f32_16x16x64_bf16 v[32:35], v[8:11], v[36:43], v74
  v_smfmac_f32_16x16x64_bf16 v[28:31], v[4:7], v[60:67], v74
  v_smfmac_f32_16x16x64_bf16 v[28:31], v[16:19], v[240:247], v74
  v_smfmac_f32_16x16x64_bf16 v[28:31], v[0:3], a[0:7], v74
  v_smfmac_f32_16x16x64_bf16 v[28:31], v[12:15], a[16:23], v74
  v_smfmac_f32_16x16x64_bf16 v[32:35], v[16:19], v[248:255], v74
  v_smfmac_f32_16x16x64_bf16 v[32:35], v[0:3], a[8:15], v74
  s_waitcnt lgkmcnt(0)
  v_smfmac_f32_16x16x64_bf16 v[32:35], v[12:15], a[24:31], v74
  v_smfmac_f32_16x16x64_bf16 v[32:35], v[4:7], v[44:51], v74
  v_smfmac_f32_16x16x64_bf16 v[20:23], v[8:11], a[96:103], v74
  v_smfmac_f32_16x16x64_bf16 v[20:23], v[4:7], a[112:119], v74
  v_add_f32 v28, v28, v30
  v_add_f32 v32, v32, v34
  v_cvt_pk_bf16_f32 v30, v28, v32
  v_smfmac_f32_16x16x64_bf16 v[20:23], v[16:19], a[128:135], v74
  ds_write_b32 v79, v30 offset:256
  v_add_f32 v29, v29, v31
  v_add_f32 v33, v33, v35
  v_cvt_pk_bf16_f32 v31, v29, v33
  v_smfmac_f32_16x16x64_bf16 v[20:23], v[0:3], a[144:151], v74
  ds_write_b32 v79, v31 offset:832
  v_smfmac_f32_16x16x64_bf16 v[20:23], v[12:15], a[160:167], v74
  v_smfmac_f32_16x16x64_bf16 v[24:27], v[8:11], a[104:111], v74
  v_smfmac_f32_16x16x64_bf16 v[24:27], v[4:7], a[120:127], v74
  v_smfmac_f32_16x16x64_bf16 v[24:27], v[16:19], a[136:143], v74
  s_waitcnt lgkmcnt(0)
  s_barrier
  ds_read_b64 v[52:53], v77 offset:264
  v_add_f32 v20, v20, v22
  v_smfmac_f32_16x16x64_bf16 v[24:27], v[0:3], a[152:159], v74
  v_add_f32 v21, v21, v23
  v_smfmac_f32_16x16x64_bf16 v[24:27], v[12:15], a[168:175], v74
  v_cvt_pk_bf16_f32 v54, v20, v21
  s_add_u32 s68, s68, 655360
  s_nop 3
  v_add_f32 v24, v24, v26
  v_add_f32 v25, v25, v27
  v_cvt_pk_bf16_f32 v55, v24, v25
  s_waitcnt lgkmcnt(0)
  buffer_store_dwordx4 v[52:55], v76, s[8:11], s68 offen sc1
  s_branch Cf1_done
Cf1_lastp:
  s_add_u32 s72, s72, 2
  s_cmp_ge_u32 s72, 131072
  s_cbranch_scc1 Cf1_lastg
  s_barrier
  s_waitcnt vmcnt(0)
  s_barrier
  s_branch Cf1_lastr
Cf1_done:
  s_branch L_cexit
L_w2:
  v_mov_b64 v[20:21], 0
  v_mov_b64 v[22:23], 0
  v_mov_b64 v[24:25], 0
  v_mov_b64 v[26:27], 0
  v_mov_b64 v[28:29], 0
  v_mov_b64 v[30:31], 0
  v_mov_b64 v[32:33], 0
  v_mov_b64 v[34:35], 0
  s_mov_b32 s78, 0x3f803f80
  s_mov_b32 s79, s78
  s_mov_b32 s65, 360448
  s_mov_b32 m0, 15872
  s_lshl_b32 s71, s53, 2
  s_add_u32 s71, s71, 128
  s_movk_i32 s56, 0x1000
  v_lshlrev_b32 v73, 2, v76
  v_mov_b32 v72, 0
  s_mov_b64 s[16:17], s[8:9]
  s_mov_b32 s18, 268435456
  s_mov_b32 s19, 0x20000
  s_getpc_b64 s[20:21]
Cf2_pc:
  s_add_u32 s20, s20, (Cf2_last - Cf2_pc)
  s_addc_u32 s21, s21, 0
  v_mov_b32 v68, 14880
  buffer_load_dwordx4 v[52:55], v76, s[8:11], s59 offen offset:0 sc1
  buffer_load_dwordx4 v[56:59], v76, s[8:11], s59 offen offset:1024 sc1
  ds_read_b128 v[60:63], v76 offset:24576
  ds_read_b128 v[64:67], v76 offset:25600
  ds_read_b128 v[44:47], v76 offset:26624
  ds_read_b128 v[48:51], v76 offset:27648
  ds_read_b128 v[36:39], v76 offset:40960
  ds_read_b128 v[40:43], v76 offset:41984
  ds_read_b128 v[0:3], v76 offset:4608
  ds_read_b128 v[4:7], v76 offset:5632
  ds_read_b128 v[8:11], v76 offset:6656
  ds_read_b128 v[12:15], v76 offset:7680
  s_waitcnt lgkmcnt(0)
  s_cmp_eq_u32 s66, 1
  s_branch Cf2_top2
.p2align 6
Cf2_h2:
  v_lshlrev_b32 v73, 2, v76
  s_nop 3
  buffer_load_dwordx4 v[12:15], v76, s[8:11], s65 offen offset:3072 sc1
  s_nop 15
  s_nop 3
  buffer_load_dwordx4 v[12:15], v76, s[8:11], s65 offen offset:3072 sc1
  s_nop 15
  s_nop 3
  buffer_load_dwordx4 v[12:15], v76, s[8:11], s65 offen offset:3072 sc1
  s_waitcnt vmcnt(5)
  ds_read_b128 v[60:63], v76 offset:24576
  ds_read_b128 v[64:67], v76 offset:25600
  ds_read_b128 v[44:47], v76 offset:26624
  ds_read_b128 v[48:51], v76 offset:27648
  ds_read_b128 v[36:39], v76 offset:40960
  ds_read_b128 v[40:43], v76 offset:41984
  buffer_load_dwordx4 v[52:55], v76, s[8:11], s59 offen offset:0 sc1
  buffer_load_dwordx4 v[56:59], v76, s[8:11], s59 offen offset:1024 sc1
  s_waitcnt vmcnt(4)
  v_max3_u32 v72, v12, v13, v14
  v_max_u32 v72, v72, v15
  ds_write_b128 v76, v[12:15] offset:7680
  v_cmp_eq_u32 vcc, -1, v72
  s_cbranch_vccnz Cf2_h2r
Cf2_h2w:
  s_cmp_eq_u32 s66, 63
  s_waitcnt lgkmcnt(0)
  s_barrier
  ds_read_b128 v[0:3], v76 offset:4608
Cf2_top2:
  v_smfmac_f32_16x16x64_bf16 v[20:23], v[12:15], v[112:119], v74
  s_cbranch_scc1 Cf2_last
  v_smfmac_f32_16x16x64_bf16 v[24:27], v[12:15], v[120:127], v74
  ds_read_b128 v[4:7], v76 offset:5632
  v_smfmac_f32_16x16x64_bf16 v[28:31], v[12:15], v[224:231], v74
  ds_read_b128 v[8:11], v76 offset:6656
  v_smfmac_f32_16x16x64_bf16 v[32:35], v[12:15], v[232:239], v74
  s_waitcnt lgkmcnt(2)
  v_smfmac_f32_16x16x64_bf16 v[24:27], v[0:3], v[44:51], v74
  buffer_load_dwordx4 v[44:47], v76, s[8:11], s58 offen offset:0 sc1
  v_smfmac_f32_16x16x64_bf16 v[20:23], v[0:3], v[60:67], v74
  buffer_load_dwordx4 v[48:51], v76, s[8:11], s58 offen offset:1024 sc1
  ds_read_b128 v[60:63], v76 offset:43008
  v_smfmac_f32_16x16x64_bf16 v[28:31], v[0:3], v[36:43], v74
  ds_read_b128 v[64:67], v76 offset:44032
  s_waitcnt lgkmcnt(3)
  v_smfmac_f32_16x16x64_bf16 v[20:23], v[4:7], v[80:87], v74
  ds_read_b128 v[36:39], v76 offset:57344
  v_smfmac_f32_16x16x64_bf16 v[24:27], v[4:7], v[88:95], v74
  ds_read_b128 v[40:43], v76 offset:58368
  s_waitcnt lgkmcnt(4)
  v_smfmac_f32_16x16x64_bf16 v[28:31], v[4:7], v[192:199], v74
  buffer_store_dwordx4 v[16:19], v76, s[8:11], s68 offen sc1
  s_waitcnt vmcnt(3)
  v_smfmac_f32_16x16x64_bf16 v[32:35], v[4:7], v[200:207], v74
  s_barrier
  s_waitcnt lgkmcnt(2)
  v_smfmac_f32_16x16x64_bf16 v[32:35], v[0:3], v[60:67], v74
  buffer_load_dword v73, s[16:19], s70 offen lds
  ds_read_b128 v[12:15], v76 offset:8704
  v_smfmac_f32_16x16x64_bf16 v[20:23], v[8:11], v[96:103], v74
  ds_read_b128 v[60:63], v76 offset:59392
  ds_read_b128 v[64:67], v76 offset:60416
  v_smfmac_f32_16x16x64_bf16 v[24:27], v[8:11], v[104:111], v74
  ds_read_b128 v[4:7], v76 offset:9728
  v_smfmac_f32_16x16x64_bf16 v[28:31], v[8:11], v[208:215], v74
  v_smfmac_f32_16x16x64_bf16 v[32:35], v[8:11], v[216:223], v74
  s_waitcnt lgkmcnt(3)
  v_smfmac_f32_16x16x64_bf16 v[28:31], v[12:15], v[36:43], v74
  ds_read_b128 v[36:39], v75 offset:8192
  ds_read_b128 v[40:43], v75 offset:9216
  s_waitcnt lgkmcnt(3)
  v_smfmac_f32_16x16x64_bf16 v[32:35], v[12:15], v[60:67], v74
  s_barrier
  ds_read_b128 v[16:19], v76 offset:10752
  v_smfmac_f32_16x16x64_bf16 v[20:23], v[12:15], v[128:135], v74
  ds_read_b128 v[60:63], v75 offset:10240
  ds_read_b128 v[64:67], v75 offset:11264
  v_smfmac_f32_16x16x64_bf16 v[24:27], v[12:15], v[136:143], v74
  ds_read_b128 v[0:3], v76 offset:11776
  s_waitcnt lgkmcnt(6)
  v_smfmac_f32_16x16x64_bf16 v[20:23], v[4:7], v[144:151], v74
  ds_read_b128 v[8:11], v76 offset:12800
  v_smfmac_f32_16x16x64_bf16 v[24:27], v[4:7], v[152:159], v74
  s_waitcnt lgkmcnt(4)
  v_smfmac_f32_16x16x64_bf16 v[20:23], v[16:19], v[36:43], v74
  ds_read_b128 v[36:39], v75 offset:24576
  s_waitcnt lgkmcnt(3)
  v_smfmac_f32_16x16x64_bf16 v[24:27], v[16:19], v[60:67], v74
  ds_read_b128 v[40:43], v75 offset:25600
  s_waitcnt lgkmcnt(3)
  v_smfmac_f32_16x16x64_bf16 v[20:23], v[0:3], v[160:167], v74
  ds_read_b128 v[60:63], v75 offset:26624
  s_waitcnt lgkmcnt(3)
  v_smfmac_f32_16x16x64_bf16 v[20:23], v[8:11], v[176:183], v74
  ds_read_b128 v[64:67], v75 offset:27648
  v_smfmac_f32_16x16x64_bf16 v[24:27], v[0:3], v[168:175], v74
  v_mov_b64 v[70:71], s[78:79]
  v_smfmac_f32_16x16x64_bf16 v[24:27], v[8:11], v[184:191], v74
  s_waitcnt lgkmcnt(2)
  v_add_f32 v20, v20, v22
  v_smfmac_f32_16x16x64_bf16 v[28:31], v[4:7], v[36:43], v74
  ds_read_b128 v[36:39], v68
  s_waitcnt lgkmcnt(1)
  v_add_f32 v21, v21, v23
  v_smfmac_f32_16x16x64_bf16 v[32:35], v[4:7], v[60:67], v74
  ds_read_b128 v[40:43], v68
  v_add_f32 v24, v24, v26
  v_smfmac_f32_16x16x64_bf16 v[28:31], v[16:19], v[240:247], v74
  v_cvt_pk_bf16_f32 v22, v20, v24
  v_smfmac_f32_16x16x64_bf16 v[28:31], v[0:3], a[0:7], v74
  ds_write_b32 v79, v22 offset:0
  v_add_f32 v25, v25, v27
  v_cvt_pk_bf16_f32 v23, v21, v25
  v_smfmac_f32_16x16x64_bf16 v[28:31], v[8:11], a[16:23], v74
  ds_write_b32 v79, v23 offset:576
  v_cmp_u_f32 vcc, v20, v21
  v_smfmac_f32_16x16x64_bf16 v[32:35], v[16:19], v[248:255], v74
  v_mov_b64 v[68:69], s[78:79]
  v_smfmac_f32_16x16x64_bf16 v[32:35], v[0:3], a[8:15], v74
  v_add_f32 v28, v28, v30
  v_add_f32 v29, v29, v31
  v_smfmac_f32_16x16x64_bf16 v[32:35], v[8:11], a[24:31], v74
  s_cbranch_vccnz Cf2_rec
Cf2_recok:
  s_waitcnt lgkmcnt(3)
  v_smfmac_f32_16x16x64_bf16 v[36:39], v[16:19], a[128:135], v74
  s_waitcnt lgkmcnt(0)
  s_barrier
  ds_read_b128 v[60:63], v77
  v_smfmac_f32_16x16x64_bf16 v[40:43], v[16:19], a[136:143], v74
  ds_read_b128 v[64:67], v77 offset:128
  v_add_f32 v32, v32, v34
  v_cvt_pk_bf16_f32 v30, v28, v32
  v_smfmac_f32_16x16x64_bf16 v[36:39], v[0:3], a[144:151], v74
  ds_write_b32 v79, v30 offset:256
  v_add_f32 v33, v33, v35
  v_cvt_pk_bf16_f32 v31, v29, v33
  v_smfmac_f32_16x16x64_bf16 v[40:43], v[0:3], a[152:159], v74
  ds_write_b32 v79, v31 offset:832
  v_xor_b32 v75, 0x8000, v75
  v_smfmac_f32_16x16x64_bf16 v[36:39], v[4:7], a[112:119], v74
  ds_read_b128 v[0:3], v76 offset:4608
  v_mov_b32 v29, 0
  v_smfmac_f32_16x16x64_bf16 v[40:43], v[4:7], a[120:127], v74
  s_waitcnt vmcnt(2) lgkmcnt(3)
  v_mov_b32 v30, 0
  v_mfma_f32_16x16x32_bf16 v[44:47], v[44:47], v[60:63], 0
  ds_read_b128 v[4:7], v76 offset:5632
  s_waitcnt lgkmcnt(2)
  v_mfma_f32_16x16x32_bf16 v[44:47], v[48:51], v[64:67], v[44:47]
  s_barrier
  v_smfmac_f32_16x16x64_bf16 v[36:39], v[8:11], a[160:167], v74
  ds_read_b128 v[20:23], v77 offset:256
  ds_read_b128 v[24:27], v77 offset:384
  v_smfmac_f32_16x16x64_bf16 v[40:43], v[8:11], a[168:175], v74
  ds_read_b128 v[8:11], v76 offset:6656
  v_add_f32_dpp v72, v46, v44 quad_perm:[2,3,0,1] row_mask:0xf bank_mask:0xf
  v_add_f32_dpp v73, v47, v45 quad_perm:[2,3,0,1] row_mask:0xf bank_mask:0xf
  v_smfmac_f32_16x16x64_bf16 v[36:39], v[12:15], a[96:103], v74
  s_waitcnt lgkmcnt(4)
  v_exp_f32_dpp v72, v72 quad_perm:[0,1,0,1] row_mask:0xf bank_mask:0xf
  v_smfmac_f32_16x16x64_bf16 v[40:43], v[12:15], a[104:111], v74
  ds_read_b128 v[12:15], v76 offset:7680
  v_exp_f32_dpp v73, v73 quad_perm:[0,1,0,1] row_mask:0xf bank_mask:0xf
  v_smfmac_f32_16x16x64_bf16 v[36:39], v[0:3], a[32:39], v74
  s_waitcnt lgkmcnt(2)
  v_cvt_pk_bf16_f32 v72, v72, v73
  v_mfma_f32_16x16x32_bf16 v[20:23], v[20:23], v[60:63], 0
  ds_write_b32 v78, v72 offset:520
  v_mov_b64 v[16:17], 0
  v_mfma_f32_16x16x32_bf16 v[20:23], v[24:27], v[64:67], v[20:23]
  ds_read_b128 v[44:47], v75 offset:24576
  v_mov_b64 v[18:19], 0
  v_smfmac_f32_16x16x64_bf16 v[40:43], v[0:3], a[40:47], v74
  ds_read_b128 v[48:51], v75 offset:25600
  s_waitcnt lgkmcnt(4)
  v_smfmac_f32_16x16x64_bf16 v[36:39], v[4:7], a[48:55], v74
  v_add_f32_dpp v24, v22, v20 quad_perm:[2,3,0,1] row_mask:0xf bank_mask:0xf
  v_add_f32_dpp v25, v23, v21 quad_perm:[2,3,0,1] row_mask:0xf bank_mask:0xf
  v_smfmac_f32_16x16x64_bf16 v[36:39], v[8:11], a[64:71], v74
  s_waitcnt lgkmcnt(2)
  s_barrier
  ds_read_b128 v[32:35], v78 offset:512
  v_smfmac_f32_16x16x64_bf16 v[36:39], v[12:15], a[80:87], v74
  ds_read_b128 v[60:63], v75 offset:26624
  v_mul_f32 v24, s69, v24
  v_smfmac_f32_16x16x64_bf16 v[40:43], v[4:7], a[56:63], v74
  ds_read_b128 v[64:67], v75 offset:27648
  v_mul_f32 v25, s69, v25
  v_smfmac_f32_16x16x64_bf16 v[40:43], v[8:11], a[72:79], v74
  v_exp_f32_dpp v24, v24 quad_perm:[0,1,0,1] row_mask:0xf bank_mask:0xf
  v_smfmac_f32_16x16x64_bf16 v[40:43], v[12:15], a[88:95], v74
  s_waitcnt lgkmcnt(2)
  v_exp_f32_dpp v25, v25 quad_perm:[0,1,0,1] row_mask:0xf bank_mask:0xf
  v_mfma_f32_16x16x32_bf16 v[8:11], v[32:35], v[68:71], 0
  v_add_f32 v36, v36, v38
  v_add_f32 v37, v37, v39
  v_mfma_f32_16x16x32_bf16 v[0:3], v[32:35], v[52:55], 0
  v_add_f32 v40, v40, v42
  v_add_f32 v41, v41, v43
  v_mfma_f32_16x16x32_bf16 v[4:7], v[32:35], v[56:59], 0
  v_cvt_pk_bf16_f32 v28, v24, v25
  v_cvt_pk_bf16_f32 v72, v36, v37
  v_cvt_pk_bf16_f32 v73, v40, v41
  v_mfma_f32_16x16x16_bf16 v[8:11], v[28:29], v[68:69], v[8:11]
  v_cvt_pk_bf16_f32 v31, v24, v25
  v_mov_b64 v[20:21], 0
  v_mfma_f32_16x16x16_bf16 v[0:3], v[28:29], v[72:73], v[0:3]
  ds_read_b128 v[68:71], v76 offset:13824
  v_mov_b64 v[22:23], 0
  v_mfma_f32_16x16x16_bf16 v[4:7], v[30:31], v[72:73], v[4:7]
  v_rcp_f32 v10, v8
  v_rcp_f32 v11, v9
  v_mul_f32 v0, v10, v0
  v_mul_f32 v1, v11, v1
  s_nop 0
  v_mul_f32 v4, v10, v4
  v_mul_f32 v5, v11, v5
  v_cvt_pk_bf16_f32 v2, v0, v4
  ds_write_b32 v79, v2 offset:8704
  v_cvt_pk_bf16_f32 v3, v1, v5
  ds_write_b32 v79, v3 offset:9280
  v_max3_f32 v8, v8, v9, v10
  v_max_f32 v8, v8, v11
  v_cmp_le_f32 vcc, 1317011456, v8
  v_mov_b64 v[24:25], 0
  v_mov_b64 v[26:27], 0
  s_cbranch_vccnz Cf2_mx
Cf2_mxok:
  s_waitcnt lgkmcnt(0)
  s_barrier
  ds_read_b128 v[0:3], v78 offset:8704
  ds_read_b128 v[4:7], v78 offset:8768
  ds_read_b128 v[8:11], v78 offset:8832
  ds_read_b128 v[12:15], v78 offset:8896
  s_waitcnt lgkmcnt(3)
  v_smfmac_f32_16x16x64_bf16 v[16:19], v[0:3], v[44:51], v74
  ds_read_b128 v[52:55], v75 offset:40960
  s_waitcnt lgkmcnt(3)
  v_smfmac_f32_16x16x64_bf16 v[16:19], v[4:7], v[60:67], v74
  ds_read_b128 v[56:59], v75 offset:41984
  s_waitcnt lgkmcnt(3)
  v_smfmac_f32_16x16x64_bf16 v[16:19], v[8:11], a[176:183], v74
  ds_read_b128 v[36:39], v75 offset:43008
  s_waitcnt lgkmcnt(3)
  v_smfmac_f32_16x16x64_bf16 v[16:19], v[12:15], a[184:191], v74
  ds_read_b128 v[40:43], v75 offset:44032
  ds_read_b128 v[44:47], v75 offset:57344
  v_smfmac_f32_16x16x64_bf16 v[20:23], v[0:3], a[192:199], v74
  ds_read_b128 v[48:51], v75 offset:58368
  ds_read_b128 v[60:63], v75 offset:59392
  v_smfmac_f32_16x16x64_bf16 v[20:23], v[4:7], a[200:207], v74
  ds_read_b128 v[64:67], v75 offset:60416
  s_waitcnt lgkmcnt(6)
  v_cvt_pk_bf16_f32 v16, v16, v17
  v_cvt_pk_bf16_f32 v17, v18, v19
  v_bfi_b32 v16, 1, s72, v16
  v_smfmac_f32_16x16x64_bf16 v[20:23], v[8:11], v[52:59], v74
  buffer_store_dwordx2 v[16:17], v68, s[8:11], s73 offen
  s_waitcnt lgkmcnt(4)
  v_smfmac_f32_16x16x64_bf16 v[20:23], v[12:15], v[36:43], v74
  ds_read_b128 v[52:55], v75 offset:0
  v_mov_b64 v[32:33], 0
  v_smfmac_f32_16x16x64_bf16 v[24:27], v[0:3], a[208:215], v74
  ds_read_b128 v[56:59], v75 offset:1024
  v_mov_b64 v[34:35], 0
  v_smfmac_f32_16x16x64_bf16 v[24:27], v[4:7], a[216:223], v74
  ds_read_b128 v[36:39], v75 offset:2048
  s_waitcnt lgkmcnt(5)
  v_cvt_pk_bf16_f32 v20, v20, v21
  v_cvt_pk_bf16_f32 v21, v22, v23
  v_bfi_b32 v20, 1, s72, v20
  v_smfmac_f32_16x16x64_bf16 v[24:27], v[8:11], v[44:51], v74
  buffer_store_dwordx2 v[20:21], v68, s[8:11], s74 offen
  s_waitcnt lgkmcnt(3)
  v_smfmac_f32_16x16x64_bf16 v[24:27], v[12:15], v[60:67], v74
  ds_read_b128 v[40:43], v75 offset:3072
  v_mov_b64 v[28:29], 0
  v_smfmac_f32_16x16x64_bf16 v[32:35], v[0:3], a[224:231], v74
  ds_read_b128 v[44:47], v75 offset:4096
  ds_read_b128 v[48:51], v75 offset:5120
  v_smfmac_f32_16x16x64_bf16 v[32:35], v[4:7], a[232:239], v74
  ds_read_b128 v[60:63], v75 offset:6144
  v_cvt_pk_bf16_f32 v24, v24, v25
  v_cvt_pk_bf16_f32 v25, v26, v27
  v_bfi_b32 v24, 1, s72, v24
  v_smfmac_f32_16x16x64_bf16 v[32:35], v[8:11], a[240:247], v74
  buffer_store_dwordx2 v[24:25], v68, s[8:11], s75 offen
  v_mov_b64 v[30:31], 0
  v_smfmac_f32_16x16x64_bf16 v[32:35], v[12:15], a[248:255], v74
  ds_read_b128 v[64:67], v75 offset:7168
  s_waitcnt lgkmcnt(6)
  v_smfmac_f32_16x16x64_bf16 v[28:31], v[0:3], v[52:59], v74
  s_waitcnt lgkmcnt(4)
  v_smfmac_f32_16x16x64_bf16 v[28:31], v[4:7], v[36:43], v74
  s_waitcnt lgkmcnt(2)
  v_cvt_pk_bf16_f32 v32, v32, v33
  v_cvt_pk_bf16_f32 v33, v34, v35
  v_bfi_b32 v32, 1, s72, v32
  v_smfmac_f32_16x16x64_bf16 v[28:31], v[8:11], v[44:51], v74
  buffer_store_dwordx2 v[32:33], v68, s[8:11], s76 offen
  s_waitcnt lgkmcnt(0)
  v_smfmac_f32_16x16x64_bf16 v[28:31], v[12:15], v[60:67], v74
  ds_read_b128 v[0:3], v76 offset:14848
  ds_read_b64 v[16:17], v77 offset:384
  v_mov_b64 v[18:19], v[72:73]
  v_xor_b32 v75, 0x8000, v75
  s_nop 3
  v_cvt_pk_bf16_f32 v28, v28, v29
  v_cvt_pk_bf16_f32 v29, v30, v31
  v_bfi_b32 v28, 1, s72, v28
  buffer_store_dwordx2 v[28:29], v68, s[8:11], s77 offen
  v_mov_b64 v[20:21], 0
  v_mov_b64 v[22:23], 0
  v_mov_b64 v[24:25], 0
  v_mov_b64 v[26:27], 0
  v_mov_b64 v[28:29], 0
  v_mov_b64 v[30:31], 0
  v_mov_b64 v[32:33], 0
  v_mov_b64 v[34:35], 0
  v_mov_b32 v68, 14880
  s_add_u32 s58, s58, 655360
  s_add_u32 s59, s59, 655360
  s_add_u32 s70, s70, 655360
  s_add_u32 s68, s68, 655360
  s_add_u32 s66, s66, 1
  s_xor_b32 s64, s64, 16384
  s_xor_b32 s65, s65, 16384
  s_cmp_eq_u32 s66, 62
  s_cselect_b64 s[16:17], s[20:21], s[16:17]
  s_cselect_b32 s18, (Cf2_done - Cf2_last), s18
  s_cselect_b32 s70, 0, s70
  s_cmp_eq_u32 s66, 63
  s_cselect_b32 s59, 268435456, s59
  s_nop 15
  s_nop 15
  s_nop 1
  buffer_load_dwordx4 v[52:55], v76, s[8:11], s60 offen offset:0 sc1
  buffer_load_dwordx4 v[56:59], v76, s[8:11], s60 offen offset:1024 sc1
  s_nop 15
  s_nop 11
  buffer_load_dwordx4 v[36:39], v76, s[8:11], s60 offen offset:0 sc1
  buffer_load_dwordx4 v[40:43], v76, s[8:11], s60 offen offset:1024 sc1
  s_waitcnt lgkmcnt(0)
  s_waitcnt vmcnt(3)
  v_mfma_f32_16x16x32_bf16 v[4:7], v[0:3], v[52:55], 0
  v_bitop3_b32 v72, v52, v54, s72 bitop3:0x7e
  s_waitcnt vmcnt(2)
  v_mfma_f32_16x16x32_bf16 v[4:7], v[0:3], v[56:59], v[4:7]
  v_bitop3_b32 v73, v56, v58, s72 bitop3:0x7e
  v_bitop3_b32 v72, v72, v73, 1 bitop3:0xa8
  v_cmp_ne_u32 vcc, 0, v72
  s_cbranch_vccnz Cf2_h1r
  s_nop 2
  v_add_f32_dpp v4, v4, v4 row_ror:4 row_mask:0xf bank_mask:0xf
  v_add_f32_dpp v5, v5, v5 row_ror:4 row_mask:0xf bank_mask:0xf
  s_nop 0
  v_add_f32_dpp v4, v4, v4 row_ror:8 row_mask:0xf bank_mask:0xf
  v_add_f32_dpp v5, v5, v5 row_ror:8 row_mask:0xf bank_mask:0xf
  v_cvt_pk_bf16_f32 v4, v4, v5
  buffer_store_dword v4, v69, s[8:11], s62 offen
  s_xor_b32 s62, s62, 16384
  buffer_store_dword v71, v69, s[8:11], s62 offen
  s_xor_b32 s72, s72, 1
  s_branch Cf2_h2
Cf2_h1r:
  s_mov_b64 exec, vcc
  buffer_load_dwordx4 v[52:55], v76, s[8:11], s60 offen offset:0 sc1
  buffer_load_dwordx4 v[56:59], v76, s[8:11], s60 offen offset:1024 sc1
  s_mov_b64 exec, -1
  s_add_u32 s67, s67, 1
  s_waitcnt vmcnt(3)
  v_mfma_f32_16x16x32_bf16 v[4:7], v[0:3], v[36:39], 0
  v_bitop3_b32 v72, v36, v38, s72 bitop3:0x7e
  s_waitcnt vmcnt(2)
  v_mfma_f32_16x16x32_bf16 v[4:7], v[0:3], v[40:43], v[4:7]
  v_bitop3_b32 v73, v40, v42, s72 bitop3:0x7e
  v_bitop3_b32 v72, v72, v73, 1 bitop3:0xa8
  v_cmp_ne_u32 vcc, 0, v72
  s_cbranch_vccz Cf2_h1p
  s_mov_b64 exec, vcc
  buffer_load_dwordx4 v[36:39], v76, s[8:11], s60 offen offset:0 sc1
  buffer_load_dwordx4 v[40:43], v76, s[8:11], s60 offen offset:1024 sc1
  s_mov_b64 exec, -1
  s_add_u32 s67, s67, 1
  s_waitcnt vmcnt(3)
  v_mfma_f32_16x16x32_bf16 v[4:7], v[0:3], v[52:55], 0
  v_bitop3_b32 v72, v52, v54, s72 bitop3:0x7e
  s_waitcnt vmcnt(2)
  v_mfma_f32_16x16x32_bf16 v[4:7], v[0:3], v[56:59], v[4:7]
  v_bitop3_b32 v73, v56, v58, s72 bitop3:0x7e
  v_bitop3_b32 v72, v72, v73, 1 bitop3:0xa8
  v_cmp_ne_u32 vcc, 0, v72
  s_cbranch_vccz Cf2_h1p
Cf2_h1s:
  s_mov_b64 exec, vcc
  buffer_load_dwordx4 v[52:55], v76, s[8:11], s60 offen offset:0 sc1
  buffer_load_dwordx4 v[56:59], v76, s[8:11], s60 offen offset:1024 sc1
  s_mov_b64 exec, -1
  s_add_u32 s67, s67, 1
  s_waitcnt vmcnt(3)
  v_mfma_f32_16x16x32_bf16 v[4:7], v[0:3], v[36:39], 0
  v_bitop3_b32 v72, v36, v38, s72 bitop3:0x7e
  s_waitcnt vmcnt(2)
  v_mfma_f32_16x16x32_bf16 v[4:7], v[0:3], v[40:43], v[4:7]
  v_bitop3_b32 v73, v40, v42, s72 bitop3:0x7e
  v_bitop3_b32 v72, v72, v73, 1 bitop3:0xa8
  v_cmp_ne_u32 vcc, 0, v72
  s_cbranch_vccz Cf2_h1p
  s_mov_b64 exec, vcc
  buffer_load_dwordx4 v[36:39], v76, s[8:11], s60 offen offset:0 sc1
  buffer_load_dwordx4 v[40:43], v76, s[8:11], s60 offen offset:1024 sc1
  s_mov_b64 exec, -1
  s_add_u32 s67, s67, 1
  s_waitcnt vmcnt(3)
  v_mfma_f32_16x16x32_bf16 v[4:7], v[0:3], v[52:55], 0
  v_bitop3_b32 v72, v52, v54, s72 bitop3:0x7e
  s_waitcnt vmcnt(2)
  v_mfma_f32_16x16x32_bf16 v[4:7], v[0:3], v[56:59], v[4:7]
  v_bitop3_b32 v73, v56, v58, s72 bitop3:0x7e
  v_bitop3_b32 v72, v72, v73, 1 bitop3:0xa8
  v_cmp_ne_u32 vcc, 0, v72
  s_cbranch_vccz Cf2_h1p
  s_cmp_lt_u32 s67, 131072
  s_cbranch_scc1 Cf2_h1s
Cf2_h1p:
  s_nop 2
  v_add_f32_dpp v4, v4, v4 row_ror:4 row_mask:0xf bank_mask:0xf
  v_add_f32_dpp v5, v5, v5 row_ror:4 row_mask:0xf bank_mask:0xf
  s_nop 0
  v_add_f32_dpp v4, v4, v4 row_ror:8 row_mask:0xf bank_mask:0xf
  v_add_f32_dpp v5, v5, v5 row_ror:8 row_mask:0xf bank_mask:0xf
  v_cvt_pk_bf16_f32 v4, v4, v5
  buffer_store_dword v4, v69, s[8:11], s62 offen
  s_xor_b32 s62, s62, 16384
  buffer_store_dword v71, v69, s[8:11], s62 offen
  s_xor_b32 s72, s72, 1
  s_branch Cf2_h2
Cf2_h2r:
  s_mov_b64 exec, vcc
  buffer_load_dwordx4 v[12:15], v76, s[8:11], s65 offen offset:3072 sc1
  s_mov_b64 exec, -1
  s_add_u32 s67, s67, 1
  s_waitcnt vmcnt(4)
  v_max3_u32 v72, v12, v13, v14
  v_max_u32 v72, v72, v15
  ds_write_b128 v76, v[12:15] offset:7680
  v_cmp_eq_u32 vcc, -1, v72
  s_cbranch_vccz Cf2_h2w
  s_mov_b64 exec, vcc
  buffer_load_dwordx4 v[12:15], v76, s[8:11], s65 offen offset:3072 sc1
  s_mov_b64 exec, -1
  s_add_u32 s67, s67, 1
  s_waitcnt vmcnt(4)
  v_max3_u32 v72, v12, v13, v14
  v_max_u32 v72, v72, v15
  ds_write_b128 v76, v[12:15] offset:7680
  v_cmp_eq_u32 vcc, -1, v72
  s_cbranch_vccz Cf2_h2w
Cf2_h2s:
  s_mov_b64 exec, vcc
  buffer_load_dwordx4 v[12:15], v76, s[8:11], s65 offen offset:3072 sc1
  s_mov_b64 exec, -1
  s_add_u32 s67, s67, 1
  s_waitcnt vmcnt(2)
  v_max3_u32 v72, v12, v13, v14
  v_max_u32 v72, v72, v15
  ds_write_b128 v76, v[12:15] offset:7680
  v_cmp_eq_u32 vcc, -1, v72
  s_cbranch_vccz Cf2_h2w
  s_mov_b64 exec, vcc
  buffer_load_dwordx4 v[12:15], v76, s[8:11], s65 offen offset:3072 sc1
  s_mov_b64 exec, -1
  s_add_u32 s67, s67, 1
  s_waitcnt vmcnt(2)
  v_max3_u32 v72, v12, v13, v14
  v_max_u32 v72, v72, v15
  ds_write_b128 v76, v[12:15] offset:7680
  v_cmp_eq_u32 vcc, -1, v72
  s_cbranch_vccz Cf2_h2w
  s_mov_b64 exec, vcc
  buffer_load_dwordx4 v[12:15], v76, s[8:11], s65 offen offset:3072 sc1
  s_mov_b64 exec, -1
  s_add_u32 s67, s67, 1
  s_waitcnt vmcnt(2)
  v_max3_u32 v72, v12, v13, v14
  v_max_u32 v72, v72, v15
  ds_write_b128 v76, v[12:15] offset:7680
  v_cmp_eq_u32 vcc, -1, v72
  s_cbranch_vccz Cf2_h2w
  s_cmp_lt_u32 s67, 131072
  s_cbranch_scc1 Cf2_h2s
  s_branch Cf2_h2w
Cf2_rec:
  s_nop 7
  s_waitcnt vmcnt(0) lgkmcnt(0)
  v_max3_u32 v72, v0, v1, v2
  v_max3_u32 v72, v72, v3, v4
  v_max3_u32 v72, v72, v5, v6
  v_max3_u32 v72, v72, v7, v8
  v_max3_u32 v72, v72, v9, v10
  v_max3_u32 v72, v72, v11, v12
  v_max3_u32 v72, v72, v13, v14
  v_max3_u32 v72, v72, v15, v16
  v_max3_u32 v72, v72, v17, v18
  v_max_u32 v72, v72, v19
  v_cmp_eq_u32 vcc, -1, v72
  s_cbranch_vccz Cf2_recok
  s_barrier
Cf2_recp:
  buffer_load_dwordx4 v[0:3], v76, s[8:11], s64 offen offset:0 sc1
  buffer_load_dwordx4 v[4:7], v76, s[8:11], s64 offen offset:1024 sc1
  s_add_u32 s67, s67, 1
  s_cmp_lt_u32 s67, 131072
  s_cselect_b32 s54, -2, -1
  s_waitcnt vmcnt(1)
  v_max3_u32 v72, v0, v1, v2
  s_waitcnt vmcnt(0)
  v_max3_u32 v72, v72, v3, v4
  v_max3_u32 v72, v72, v5, v6
  v_max_u32 v72, v72, v7
  v_cmp_lt_u32 vcc, s54, v72
  s_cbranch_vccnz Cf2_recp
  ds_write_b128 v76, v[0:3] offset:8704
  ds_write_b128 v76, v[4:7] offset:9728
  v_mov_b64 v[20:21], 0
  v_mov_b64 v[22:23], 0
  v_mov_b64 v[24:25], 0
  v_mov_b64 v[26:27], 0
  v_mov_b64 v[28:29], 0
  v_mov_b64 v[30:31], 0
  v_mov_b64 v[32:33], 0
  v_mov_b64 v[34:35], 0
  s_waitcnt lgkmcnt(0)
  s_barrier
  ds_read_b128 v[0:3], v76 offset:4608
  ds_read_b128 v[60:63], v76 offset:24576
  ds_read_b128 v[64:67], v76 offset:25600
  s_waitcnt lgkmcnt(0)
  v_smfmac_f32_16x16x64_bf16 v[20:23], v[0:3], v[60:67], v74
  ds_read_b128 v[60:63], v76 offset:26624
  ds_read_b128 v[64:67], v76 offset:27648
  s_waitcnt lgkmcnt(0)
  v_smfmac_f32_16x16x64_bf16 v[24:27], v[0:3], v[60:67], v74
  ds_read_b128 v[60:63], v76 offset:40960
  ds_read_b128 v[64:67], v76 offset:41984
  s_waitcnt lgkmcnt(0)
  v_smfmac_f32_16x16x64_bf16 v[28:31], v[0:3], v[60:67], v74
  ds_read_b128 v[60:63], v76 offset:43008
  ds_read_b128 v[64:67], v76 offset:44032
  s_waitcnt lgkmcnt(0)
  v_smfmac_f32_16x16x64_bf16 v[32:35], v[0:3], v[60:67], v74
  ds_read_b128 v[4:7], v76 offset:5632
  s_waitcnt lgkmcnt(0)
  v_smfmac_f32_16x16x64_bf16 v[20:23], v[4:7], v[80:87], v74
  v_smfmac_f32_16x16x64_bf16 v[24:27], v[4:7], v[88:95], v74
  v_smfmac_f32_16x16x64_bf16 v[28:31], v[4:7], v[192:199], v74
  v_smfmac_f32_16x16x64_bf16 v[32:35], v[4:7], v[200:207], v74
  ds_read_b128 v[8:11], v76 offset:6656
  s_waitcnt lgkmcnt(0)
  v_smfmac_f32_16x16x64_bf16 v[20:23], v[8:11], v[96:103], v74
  v_smfmac_f32_16x16x64_bf16 v[24:27], v[8:11], v[104:111], v74
  v_smfmac_f32_16x16x64_bf16 v[28:31], v[8:11], v[208:215], v74
  v_smfmac_f32_16x16x64_bf16 v[32:35], v[8:11], v[216:223], v74
  ds_read_b128 v[12:15], v76 offset:7680
  s_waitcnt lgkmcnt(0)
  v_smfmac_f32_16x16x64_bf16 v[20:23], v[12:15], v[112:119], v74
  v_smfmac_f32_16x16x64_bf16 v[24:27], v[12:15], v[120:127], v74
  v_smfmac_f32_16x16x64_bf16 v[28:31], v[12:15], v[224:231], v74
  v_smfmac_f32_16x16x64_bf16 v[32:35], v[12:15], v[232:239], v74
  ds_read_b128 v[12:15], v76 offset:8704
  s_waitcnt lgkmcnt(0)
  v_smfmac_f32_16x16x64_bf16 v[20:23], v[12:15], v[128:135], v74
  v_smfmac_f32_16x16x64_bf16 v[24:27], v[12:15], v[136:143], v74
  ds_read_b128 v[60:63], v76 offset:57344
  ds_read_b128 v[64:67], v76 offset:58368
  s_waitcnt lgkmcnt(0)
  v_smfmac_f32_16x16x64_bf16 v[28:31], v[12:15], v[60:67], v74
  ds_read_b128 v[60:63], v76 offset:59392
  ds_read_b128 v[64:67], v76 offset:60416
  s_waitcnt lgkmcnt(0)
  v_smfmac_f32_16x16x64_bf16 v[32:35], v[12:15], v[60:67], v74
  ds_read_b128 v[4:7], v76 offset:9728
  s_waitcnt lgkmcnt(0)
  v_smfmac_f32_16x16x64_bf16 v[20:23], v[4:7], v[144:151], v74
  v_smfmac_f32_16x16x64_bf16 v[24:27], v[4:7], v[152:159], v74
  ds_read_b128 v[60:63], v75 offset:24576
  ds_read_b128 v[64:67], v75 offset:25600
  s_waitcnt lgkmcnt(0)
  v_smfmac_f32_16x16x64_bf16 v[28:31], v[4:7], v[60:67], v74
  ds_read_b128 v[60:63], v75 offset:26624
  ds_read_b128 v[64:67], v75 offset:27648
  s_waitcnt lgkmcnt(0)
  v_smfmac_f32_16x16x64_bf16 v[32:35], v[4:7], v[60:67], v74
  ds_read_b128 v[16:19], v76 offset:10752
  ds_read_b128 v[60:63], v75 offset:8192
  ds_read_b128 v[64:67], v75 offset:9216
  s_waitcnt lgkmcnt(0)
  v_smfmac_f32_16x16x64_bf16 v[20:23], v[16:19], v[60:67], v74
  ds_read_b128 v[60:63], v75 offset:10240
  ds_read_b128 v[64:67], v75 offset:11264
  s_waitcnt lgkmcnt(0)
  v_smfmac_f32_16x16x64_bf16 v[24:27], v[16:19], v[60:67], v74
  v_smfmac_f32_16x16x64_bf16 v[28:31], v[16:19], v[240:247], v74
  v_smfmac_f32_16x16x64_bf16 v[32:35], v[16:19], v[248:255], v74
  ds_read_b128 v[0:3], v76 offset:11776
  s_waitcnt lgkmcnt(0)
  v_smfmac_f32_16x16x64_bf16 v[20:23], v[0:3], v[160:167], v74
  v_smfmac_f32_16x16x64_bf16 v[24:27], v[0:3], v[168:175], v74
  v_smfmac_f32_16x16x64_bf16 v[28:31], v[0:3], a[0:7], v74
  v_smfmac_f32_16x16x64_bf16 v[32:35], v[0:3], a[8:15], v74
  ds_read_b128 v[8:11], v76 offset:12800
  s_waitcnt lgkmcnt(0)
  v_smfmac_f32_16x16x64_bf16 v[20:23], v[8:11], v[176:183], v74
  v_smfmac_f32_16x16x64_bf16 v[24:27], v[8:11], v[184:191], v74
  v_smfmac_f32_16x16x64_bf16 v[28:31], v[8:11], a[16:23], v74
  v_smfmac_f32_16x16x64_bf16 v[32:35], v[8:11], a[24:31], v74
  v_add_f32 v20, v20, v22
  v_add_f32 v21, v21, v23
  v_add_f32 v24, v24, v26
  v_cvt_pk_bf16_f32 v22, v20, v24
  s_nop 0
  ds_write_b32 v79, v22 offset:0
  v_add_f32 v25, v25, v27
  v_cvt_pk_bf16_f32 v23, v21, v25
  ds_write_b32 v79, v23 offset:576
  v_add_f32 v28, v28, v30
  v_add_f32 v29, v29, v31
  s_waitcnt lgkmcnt(0)
  s_nop 1
  s_branch Cf2_recok
Cf2_mx:
  s_waitcnt lgkmcnt(0)
  s_barrier
  buffer_load_dwordx4 v[0:3], v76, s[8:11], s58 offen offset:0 sc1
  ds_read_b128 v[20:23], v77 offset:0
  ds_read_b128 v[28:31], v77 offset:256
  buffer_load_dwordx4 v[4:7], v76, s[8:11], s58 offen offset:1024 sc1
  ds_read_b128 v[24:27], v77 offset:128
  ds_read_b128 v[32:35], v77 offset:384
  s_waitcnt vmcnt(1) lgkmcnt(3)
  v_mfma_f32_16x16x32_bf16 v[8:11], v[0:3], v[20:23], 0
  s_waitcnt vmcnt(0) lgkmcnt(1)
  v_mfma_f32_16x16x32_bf16 v[8:11], v[4:7], v[24:27], v[8:11]
  v_mfma_f32_16x16x32_bf16 v[12:15], v[28:31], v[20:23], 0
  s_waitcnt lgkmcnt(0)
  v_mfma_f32_16x16x32_bf16 v[12:15], v[32:35], v[24:27], v[12:15]
  v_add_f32_dpp v8, v10, v8 quad_perm:[2,3,0,1] row_mask:0xf bank_mask:0xf
  v_add_f32_dpp v9, v11, v9 quad_perm:[2,3,0,1] row_mask:0xf bank_mask:0xf
  s_nop 0
  v_mov_b32_dpp v8, v8 quad_perm:[0,1,0,1] row_mask:0xf bank_mask:0xf
  v_mov_b32_dpp v9, v9 quad_perm:[0,1,0,1] row_mask:0xf bank_mask:0xf
  s_nop 1
  v_add_f32_dpp v12, v14, v12 quad_perm:[2,3,0,1] row_mask:0xf bank_mask:0xf
  v_add_f32_dpp v13, v15, v13 quad_perm:[2,3,0,1] row_mask:0xf bank_mask:0xf
  s_nop 0
  v_mov_b32_dpp v12, v12 quad_perm:[0,1,0,1] row_mask:0xf bank_mask:0xf
  v_mov_b32_dpp v13, v13 quad_perm:[0,1,0,1] row_mask:0xf bank_mask:0xf
  v_mul_f32 v12, s69, v12
  ds_write_b32 v78, v8 offset:8712
  v_mul_f32 v13, s69, v13
  ds_write_b32 v78, v9 offset:8776
  s_waitcnt lgkmcnt(0)
  s_barrier
  ds_read_b128 v[36:39], v78 offset:8704
  ds_read_b128 v[40:43], v78 offset:8768
  s_waitcnt lgkmcnt(0)
  s_barrier
  v_max_f32 v16, v36, v37
  v_max3_f32 v16, v16, v38, v39
  v_max3_f32 v16, v16, v40, v41
  v_max3_f32 v16, v16, v42, v43
  v_max3_f32 v16, v16, v12, v13
  v_mov_b32 v17, v16
  s_nop 1
  v_permlane16_swap_b32 v16, v17
  v_max_f32 v16, v16, v17
  v_mov_b32 v17, v16
  s_nop 1
  v_permlane32_swap_b32 v16, v17
  v_max_f32 v16, v16, v17
  v_sub_f32 v36, v36, v16
  v_sub_f32 v37, v37, v16
  v_sub_f32 v38, v38, v16
  v_sub_f32 v39, v39, v16
  v_sub_f32 v40, v40, v16
  v_sub_f32 v41, v41, v16
  v_sub_f32 v42, v42, v16
  v_sub_f32 v43, v43, v16
  v_sub_f32 v12, v12, v16
  v_sub_f32 v13, v13, v16
  v_exp_f32 v36, v36
  v_exp_f32 v37, v37
  v_exp_f32 v38, v38
  v_exp_f32 v39, v39
  v_exp_f32 v40, v40
  v_exp_f32 v41, v41
  v_exp_f32 v42, v42
  v_exp_f32 v43, v43
  v_exp_f32 v12, v12
  v_exp_f32 v13, v13
  v_cvt_pk_bf16_f32 v32, v36, v40
  v_cvt_pk_bf16_f32 v33, v37, v41
  v_cvt_pk_bf16_f32 v34, v38, v42
  v_cvt_pk_bf16_f32 v35, v39, v43
  v_cvt_pk_bf16_f32 v28, v12, v13
  v_cvt_pk_bf16_f32 v31, v12, v13
  v_mov_b32 v29, 0
  v_mov_b32 v30, 0
  v_mov_b32 v68, 0x3f803f80
  v_mov_b32 v69, 0x3f803f80
  v_mov_b32 v70, 0x3f803f80
  v_mov_b32 v71, 0x3f803f80
  s_nop 1
  v_mfma_f32_16x16x32_bf16 v[8:11], v[32:35], v[68:71], 0
  v_mfma_f32_16x16x32_bf16 v[0:3], v[32:35], v[52:55], 0
  v_mfma_f32_16x16x32_bf16 v[4:7], v[32:35], v[56:59], 0
  v_mfma_f32_16x16x16_bf16 v[8:11], v[28:29], v[68:69], v[8:11]
  v_mfma_f32_16x16x16_bf16 v[0:3], v[28:29], v[72:73], v[0:3]
  v_mfma_f32_16x16x16_bf16 v[4:7], v[30:31], v[72:73], v[4:7]
  ds_read_b128 v[68:71], v76 offset:13824
  v_rcp_f32 v10, v8
  v_rcp_f32 v11, v9
  v_mul_f32 v0, v10, v0
  v_mul_f32 v1, v11, v1
  s_nop 0
  v_mul_f32 v4, v10, v4
  v_mul_f32 v5, v11, v5
  v_cvt_pk_bf16_f32 v2, v0, v4
  ds_write_b32 v79, v2 offset:8704
  v_cvt_pk_bf16_f32 v3, v1, v5
  ds_write_b32 v79, v3 offset:9280
  v_mov_b64 v[16:17], 0
  v_mov_b64 v[18:19], 0
  v_mov_b64 v[20:21], 0
  v_mov_b64 v[22:23], 0
  v_mov_b64 v[24:25], 0
  v_mov_b64 v[26:27], 0
  s_branch Cf2_mxok
Cf2_last:
  ds_read_b128 v[4:7], v76 offset:5632
  ds_read_b128 v[8:11], v76 offset:6656
  ds_read_b128 v[60:63], v76 offset:43008
  ds_read_b128 v[64:67], v76 offset:44032
  ds_read_b128 v[44:47], v76 offset:57344
  ds_read_b128 v[48:51], v76 offset:58368
  s_nop 3
  v_mov_b64 v[20:21], 0
  v_mov_b64 v[22:23], 0
  v_mov_b64 v[24:25], 0
  v_mov_b64 v[26:27], 0
  s_waitcnt lgkmcnt(6)
  v_smfmac_f32_16x16x64_bf16 v[28:31], v[0:3], v[36:43], v74
  v_smfmac_f32_16x16x64_bf16 v[20:23], v[0:3], a[32:39], v74
  ds_read_b128 v[36:39], v76 offset:59392
  ds_read_b128 v[40:43], v76 offset:60416
  v_smfmac_f32_16x16x64_bf16 v[24:27], v[0:3], a[40:47], v74
  s_waitcnt lgkmcnt(7)
  v_smfmac_f32_16x16x64_bf16 v[20:23], v[4:7], a[48:55], v74
  buffer_store_dwordx4 v[16:19], v76, s[8:11], s68 offen sc1
  s_waitcnt lgkmcnt(4)
  v_smfmac_f32_16x16x64_bf16 v[24:27], v[4:7], a[56:63], v74
  v_smfmac_f32_16x16x64_bf16 v[28:31], v[4:7], v[192:199], v74
  v_smfmac_f32_16x16x64_bf16 v[32:35], v[4:7], v[200:207], v74
  v_smfmac_f32_16x16x64_bf16 v[32:35], v[0:3], v[60:67], v74
  v_smfmac_f32_16x16x64_bf16 v[20:23], v[8:11], a[64:71], v74
  ds_read_b128 v[60:63], v75 offset:24576
  ds_read_b128 v[64:67], v75 offset:25600
  v_smfmac_f32_16x16x64_bf16 v[24:27], v[8:11], a[72:79], v74
  v_smfmac_f32_16x16x64_bf16 v[28:31], v[8:11], v[208:215], v74
  v_smfmac_f32_16x16x64_bf16 v[20:23], v[12:15], a[80:87], v74
  v_smfmac_f32_16x16x64_bf16 v[24:27], v[12:15], a[88:95], v74
  v_smfmac_f32_16x16x64_bf16 v[28:31], v[12:15], v[224:231], v74
  v_smfmac_f32_16x16x64_bf16 v[32:35], v[12:15], v[232:239], v74
  v_smfmac_f32_16x16x64_bf16 v[32:35], v[8:11], v[216:223], v74
  s_waitcnt vmcnt(1)
  s_barrier
Cf2_lastr:
  ds_read_b128 v[12:15], v76 offset:8704
  ds_read_b128 v[4:7], v76 offset:9728
  ds_read_b128 v[16:19], v76 offset:10752
  ds_read_b128 v[0:3], v76 offset:11776
  ds_read_b128 v[8:11], v76 offset:12800
  s_waitcnt lgkmcnt(1)
  v_max3_u32 v72, v0, v1, v2
  v_max3_u32 v72, v72, v3, v4
  v_max3_u32 v72, v72, v5, v6
  s_waitcnt lgkmcnt(0)
  v_max3_u32 v72, v72, v7, v8
  v_max3_u32 v72, v72, v9, v10
  v_max3_u32 v72, v72, v11, v12
  v_max3_u32 v72, v72, v13, v14
  v_max3_u32 v72, v72, v15, v16
  v_max3_u32 v72, v72, v17, v18
  v_max_u32 v72, v72, v19
  v_cmp_eq_u32 vcc, -1, v72
  s_cbranch_vccnz Cf2_lastp
Cf2_lastg:
  v_smfmac_f32_16x16x64_bf16 v[28:31], v[12:15], v[44:51], v74
  ds_read_b128 v[44:47], v75 offset:26624
  ds_read_b128 v[48:51], v75 offset:27648
  v_smfmac_f32_16x16x64_bf16 v[32:35], v[12:15], v[36:43], v74
  v_smfmac_f32_16x16x64_bf16 v[28:31], v[4:7], v[60:67], v74
  v_smfmac_f32_16x16x64_bf16 v[28:31], v[16:19], v[240:247], v74
  v_smfmac_f32_16x16x64_bf16 v[28:31], v[0:3], a[0:7], v74
  v_smfmac_f32_16x16x64_bf16 v[28:31], v[8:11], a[16:23], v74
  v_smfmac_f32_16x16x64_bf16 v[32:35], v[16:19], v[248:255], v74
  v_smfmac_f32_16x16x64_bf16 v[32:35], v[0:3], a[8:15], v74
  s_waitcnt lgkmcnt(0)
  v_smfmac_f32_16x16x64_bf16 v[32:35], v[8:11], a[24:31], v74
  v_smfmac_f32_16x16x64_bf16 v[32:35], v[4:7], v[44:51], v74
  v_smfmac_f32_16x16x64_bf16 v[20:23], v[12:15], a[96:103], v74
  v_smfmac_f32_16x16x64_bf16 v[20:23], v[4:7], a[112:119], v74
  v_add_f32 v28, v28, v30
  v_add_f32 v32, v32, v34
  v_cvt_pk_bf16_f32 v30, v28, v32
  v_smfmac_f32_16x16x64_bf16 v[20:23], v[16:19], a[128:135], v74
  ds_write_b32 v79, v30 offset:256
  v_add_f32 v29, v29, v31
  v_add_f32 v33, v33, v35
  v_cvt_pk_bf16_f32 v31, v29, v33
  v_smfmac_f32_16x16x64_bf16 v[20:23], v[0:3], a[144:151], v74
  ds_write_b32 v79, v31 offset:832
  v_smfmac_f32_16x16x64_bf16 v[20:23], v[8:11], a[160:167], v74
  v_smfmac_f32_16x16x64_bf16 v[24:27], v[12:15], a[104:111], v74
  v_smfmac_f32_16x16x64_bf16 v[24:27], v[4:7], a[120:127], v74
  v_smfmac_f32_16x16x64_bf16 v[24:27], v[16:19], a[136:143], v74
  s_waitcnt lgkmcnt(0)
  s_barrier
  ds_read_b64 v[52:53], v77 offset:384
  v_add_f32 v20, v20, v22
  v_smfmac_f32_16x16x64_bf16 v[24:27], v[0:3], a[152:159], v74
  v_add_f32 v21, v21, v23
  v_smfmac_f32_16x16x64_bf16 v[24:27], v[8:11], a[168:175], v74
  v_cvt_pk_bf16_f32 v54, v20, v21
  s_add_u32 s68, s68, 655360
  s_nop 3
  v_add_f32 v24, v24, v26
  v_add_f32 v25, v25, v27
  v_cvt_pk_bf16_f32 v55, v24, v25
  s_waitcnt lgkmcnt(0)
  buffer_store_dwordx4 v[52:55], v76, s[8:11], s68 offen sc1
  s_branch Cf2_done
Cf2_lastp:
  s_add_u32 s72, s72, 2
  s_cmp_ge_u32 s72, 131072
  s_cbranch_scc1 Cf2_lastg
  s_barrier
  s_waitcnt vmcnt(0)
  s_barrier
  s_branch Cf2_lastr
Cf2_done:
  s_branch L_cexit
L_w3:
  v_mov_b64 v[20:21], 0
  v_mov_b64 v[22:23], 0
  v_mov_b64 v[24:25], 0
  v_mov_b64 v[26:27], 0
  v_mov_b64 v[28:29], 0
  v_mov_b64 v[30:31], 0
  v_mov_b64 v[32:33], 0
  v_mov_b64 v[34:35], 0
  s_mov_b32 s78, 0x3f803f80
  s_mov_b32 s79, s78
  s_mov_b32 s65, 360448
  s_mov_b32 m0, 15872
  s_lshl_b32 s71, s53, 2
  s_add_u32 s71, s71, 128
  s_movk_i32 s56, 0x1000
  v_lshlrev_b32 v73, 2, v76
  v_mov_b32 v72, 0
  s_mov_b64 s[16:17], s[8:9]
  s_mov_b32 s18, 268435456
  s_mov_b32 s19, 0x20000
  s_getpc_b64 s[20:21]
Cf3_pc:
  s_add_u32 s20, s20, (Cf3_last - Cf3_pc)
  s_addc_u32 s21, s21, 0
  v_mov_b32 v68, 14880
  buffer_load_dwordx4 v[52:55], v76, s[8:11], s59 offen offset:0 sc1
  buffer_load_dwordx4 v[56:59], v76, s[8:11], s59 offen offset:1024 sc1
  ds_read_b128 v[60:63], v76 offset:28672
  ds_read_b128 v[64:67], v76 offset:29696
  ds_read_b128 v[44:47], v76 offset:30720
  ds_read_b128 v[48:51], v76 offset:31744
  ds_read_b128 v[36:39], v76 offset:45056
  ds_read_b128 v[40:43], v76 offset:46080
  ds_read_b128 v[0:3], v76 offset:4608
  ds_read_b128 v[4:7], v76 offset:5632
  ds_read_b128 v[8:11], v76 offset:6656
  ds_read_b128 v[12:15], v76 offset:7680
  s_waitcnt lgkmcnt(0)
  s_cmp_eq_u32 s66, 1
  s_branch Cf3_top2
.p2align 6
Cf3_h2:
  v_lshlrev_b32 v73, 2, v76
  s_mov_b32 m0, 8704
  s_add_u32 s55, s65, 4096
  buffer_load_dwordx4 v[4:7], v76, s[8:11], s65 offen offset:1024 sc1
  s_waitcnt vmcnt(6)
  ds_read_b128 v[60:63], v76 offset:28672
  ds_read_b128 v[64:67], v76 offset:29696
  ds_read_b128 v[44:47], v76 offset:30720
  ds_read_b128 v[48:51], v76 offset:31744
  ds_read_b128 v[36:39], v76 offset:45056
  ds_read_b128 v[40:43], v76 offset:46080
  buffer_load_dwordx4 v[52:55], v76, s[8:11], s59 offen offset:0 sc1
  buffer_load_dwordx4 v[56:59], v76, s[8:11], s59 offen offset:1024 sc1
  s_waitcnt vmcnt(7)
  v_max3_u32 v72, v4, v5, v6
  v_max_u32 v72, v72, v7
  ds_write_b128 v76, v[4:7] offset:5632
  v_cmp_eq_u32 vcc, -1, v72
  s_cbranch_vccnz Cf3_h2r
Cf3_h2w:
  buffer_load_dwordx4 v76, s[8:11], s55 offen offset:0 sc1 lds
  buffer_load_dwordx4 v76, s[8:11], s55 offen offset:1024 sc1 lds
  s_cmp_eq_u32 s66, 63
  s_waitcnt lgkmcnt(0)
  s_barrier
  ds_read_b128 v[0:3], v76 offset:4608
Cf3_top2:
  v_smfmac_f32_16x16x64_bf16 v[20:23], v[4:7], v[80:87], v74
  s_cbranch_scc1 Cf3_last
  v_smfmac_f32_16x16x64_bf16 v[24:27], v[4:7], v[88:95], v74
  ds_read_b128 v[8:11], v76 offset:6656
  v_smfmac_f32_16x16x64_bf16 v[28:31], v[4:7], v[192:199], v74
  ds_read_b128 v[12:15], v76 offset:7680
  v_smfmac_f32_16x16x64_bf16 v[32:35], v[4:7], v[200:207], v74
  s_mov_b32 m0, 15872
  s_waitcnt lgkmcnt(2)
  v_smfmac_f32_16x16x64_bf16 v[24:27], v[0:3], v[44:51], v74
  buffer_load_dwordx4 v[44:47], v76, s[8:11], s58 offen offset:0 sc1
  v_smfmac_f32_16x16x64_bf16 v[20:23], v[0:3], v[60:67], v74
  buffer_load_dwordx4 v[48:51], v76, s[8:11], s58 offen offset:1024 sc1
  ds_read_b128 v[60:63], v76 offset:47104
  v_smfmac_f32_16x16x64_bf16 v[28:31], v[0:3], v[36:43], v74
  ds_read_b128 v[64:67], v76 offset:48128
  s_waitcnt lgkmcnt(3)
  v_smfmac_f32_16x16x64_bf16 v[20:23], v[8:11], v[96:103], v74
  ds_read_b128 v[36:39], v76 offset:61440
  v_smfmac_f32_16x16x64_bf16 v[24:27], v[8:11], v[104:111], v74
  ds_read_b128 v[40:43], v76 offset:62464
  s_waitcnt lgkmcnt(4)
  v_smfmac_f32_16x16x64_bf16 v[28:31], v[8:11], v[208:215], v74
  buffer_store_dwordx4 v[16:19], v76, s[8:11], s68 offen sc1
  s_waitcnt vmcnt(3)
  v_smfmac_f32_16x16x64_bf16 v[32:35], v[8:11], v[216:223], v74
  s_barrier
  s_waitcnt lgkmcnt(2)
  v_smfmac_f32_16x16x64_bf16 v[32:35], v[0:3], v[60:67], v74
  buffer_load_dword v73, s[16:19], s70 offen lds
  ds_read_b128 v[4:7], v76 offset:8704
  v_smfmac_f32_16x16x64_bf16 v[20:23], v[12:15], v[112:119], v74
  ds_read_b128 v[60:63], v76 offset:63488
  ds_read_b128 v[64:67], v76 offset:64512
  v_smfmac_f32_16x16x64_bf16 v[24:27], v[12:15], v[120:127], v74
  ds_read_b128 v[8:11], v76 offset:9728
  v_smfmac_f32_16x16x64_bf16 v[28:31], v[12:15], v[224:231], v74
  v_smfmac_f32_16x16x64_bf16 v[32:35], v[12:15], v[232:239], v74
  s_waitcnt lgkmcnt(3)
  v_smfmac_f32_16x16x64_bf16 v[28:31], v[4:7], v[36:43], v74
  ds_read_b128 v[36:39], v75 offset:12288
  ds_read_b128 v[40:43], v75 offset:13312
  s_waitcnt lgkmcnt(3)
  v_smfmac_f32_16x16x64_bf16 v[32:35], v[4:7], v[60:67], v74
  s_barrier
  ds_read_b128 v[16:19], v76 offset:10752
  v_smfmac_f32_16x16x64_bf16 v[20:23], v[4:7], v[128:135], v74
  ds_read_b128 v[60:63], v75 offset:14336
  ds_read_b128 v[64:67], v75 offset:15360
  v_smfmac_f32_16x16x64_bf16 v[24:27], v[4:7], v[136:143], v74
  ds_read_b128 v[0:3], v76 offset:11776
  s_waitcnt lgkmcnt(6)
  v_smfmac_f32_16x16x64_bf16 v[20:23], v[8:11], v[144:151], v74
  ds_read_b128 v[12:15], v76 offset:12800
  v_smfmac_f32_16x16x64_bf16 v[24:27], v[8:11], v[152:159], v74
  s_waitcnt lgkmcnt(4)
  v_smfmac_f32_16x16x64_bf16 v[20:23], v[16:19], v[36:43], v74
  ds_read_b128 v[36:39], v75 offset:28672
  s_waitcnt lgkmcnt(3)
  v_smfmac_f32_16x16x64_bf16 v[24:27], v[16:19], v[60:67], v74
  ds_read_b128 v[40:43], v75 offset:29696
  s_waitcnt lgkmcnt(3)
  v_smfmac_f32_16x16x64_bf16 v[20:23], v[0:3], v[160:167], v74
  ds_read_b128 v[60:63], v75 offset:30720
  s_waitcnt lgkmcnt(3)
  v_smfmac_f32_16x16x64_bf16 v[20:23], v[12:15], v[176:183], v74
  ds_read_b128 v[64:67], v75 offset:31744
  v_smfmac_f32_16x16x64_bf16 v[24:27], v[0:3], v[168:175], v74
  v_mov_b64 v[70:71], s[78:79]
  v_smfmac_f32_16x16x64_bf16 v[24:27], v[12:15], v[184:191], v74
  s_waitcnt lgkmcnt(2)
  v_add_f32 v20, v20, v22
  v_smfmac_f32_16x16x64_bf16 v[28:31], v[8:11], v[36:43], v74
  ds_read_b128 v[36:39], v68
  s_waitcnt lgkmcnt(1)
  v_add_f32 v21, v21, v23
  v_smfmac_f32_16x16x64_bf16 v[32:35], v[8:11], v[60:67], v74
  ds_read_b128 v[40:43], v68
  v_add_f32 v24, v24, v26
  v_smfmac_f32_16x16x64_bf16 v[28:31], v[16:19], v[240:247], v74
  v_cvt_pk_bf16_f32 v22, v20, v24
  v_smfmac_f32_16x16x64_bf16 v[28:31], v[0:3], a[0:7], v74
  ds_write_b32 v79, v22 offset:0
  v_add_f32 v25, v25, v27
  v_cvt_pk_bf16_f32 v23, v21, v25
  v_smfmac_f32_16x16x64_bf16 v[28:31], v[12:15], a[16:23], v74
  ds_write_b32 v79, v23 offset:576
  v_cmp_u_f32 vcc, v20, v21
  v_smfmac_f32_16x16x64_bf16 v[32:35], v[16:19], v[248:255], v74
  v_mov_b64 v[68:69], s[78:79]
  v_smfmac_f32_16x16x64_bf16 v[32:35], v[0:3], a[8:15], v74
  v_add_f32 v28, v28, v30
  v_add_f32 v29, v29, v31
  v_smfmac_f32_16x16x64_bf16 v[32:35], v[12:15], a[24:31], v74
  s_cbranch_vccnz Cf3_rec
Cf3_recok:
  s_waitcnt lgkmcnt(3)
  v_smfmac_f32_16x16x64_bf16 v[36:39], v[16:19], a[128:135], v74
  s_waitcnt lgkmcnt(0)
  s_barrier
  ds_read_b128 v[60:63], v77
  v_smfmac_f32_16x16x64_bf16 v[40:43], v[16:19], a[136:143], v74
  ds_read_b128 v[64:67], v77 offset:128
  v_add_f32 v32, v32, v34
  v_cvt_pk_bf16_f32 v30, v28, v32
  v_smfmac_f32_16x16x64_bf16 v[36:39], v[0:3], a[144:151], v74
  ds_write_b32 v79, v30 offset:256
  v_add_f32 v33, v33, v35
  v_cvt_pk_bf16_f32 v31, v29, v33
  v_smfmac_f32_16x16x64_bf16 v[40:43], v[0:3], a[152:159], v74
  ds_write_b32 v79, v31 offset:832
  v_xor_b32 v75, 0x8000, v75
  v_smfmac_f32_16x16x64_bf16 v[36:39], v[4:7], a[96:103], v74
  ds_read_b128 v[0:3], v76 offset:4608
  v_mov_b32 v29, 0
  v_smfmac_f32_16x16x64_bf16 v[40:43], v[4:7], a[104:111], v74
  s_waitcnt vmcnt(2) lgkmcnt(3)
  v_mov_b32 v30, 0
  v_mfma_f32_16x16x32_bf16 v[44:47], v[44:47], v[60:63], 0
  ds_read_b128 v[4:7], v76 offset:5632
  s_waitcnt lgkmcnt(2)
  v_mfma_f32_16x16x32_bf16 v[44:47], v[48:51], v[64:67], v[44:47]
  s_barrier
  v_smfmac_f32_16x16x64_bf16 v[36:39], v[8:11], a[112:119], v74
  ds_read_b128 v[20:23], v77 offset:256
  ds_read_b128 v[24:27], v77 offset:384
  v_smfmac_f32_16x16x64_bf16 v[40:43], v[8:11], a[120:127], v74
  ds_read_b128 v[8:11], v76 offset:6656
  v_add_f32_dpp v72, v46, v44 quad_perm:[2,3,0,1] row_mask:0xf bank_mask:0xf
  v_add_f32_dpp v73, v47, v45 quad_perm:[2,3,0,1] row_mask:0xf bank_mask:0xf
  v_smfmac_f32_16x16x64_bf16 v[36:39], v[12:15], a[160:167], v74
  s_waitcnt lgkmcnt(4)
  v_exp_f32_dpp v72, v72 quad_perm:[0,1,0,1] row_mask:0xf bank_mask:0xf
  v_smfmac_f32_16x16x64_bf16 v[40:43], v[12:15], a[168:175], v74
  ds_read_b128 v[12:15], v76 offset:7680
  v_exp_f32_dpp v73, v73 quad_perm:[0,1,0,1] row_mask:0xf bank_mask:0xf
  v_smfmac_f32_16x16x64_bf16 v[36:39], v[0:3], a[32:39], v74
  s_waitcnt lgkmcnt(2)
  v_cvt_pk_bf16_f32 v72, v72, v73
  v_mfma_f32_16x16x32_bf16 v[20:23], v[20:23], v[60:63], 0
  ds_write_b32 v78, v72 offset:524
  v_mov_b64 v[16:17], 0
  v_mfma_f32_16x16x32_bf16 v[20:23], v[24:27], v[64:67], v[20:23]
  ds_read_b128 v[44:47], v75 offset:28672
  v_mov_b64 v[18:19], 0
  v_smfmac_f32_16x16x64_bf16 v[40:43], v[0:3], a[40:47], v74
  ds_read_b128 v[48:51], v75 offset:29696
  s_waitcnt lgkmcnt(4)
  v_smfmac_f32_16x16x64_bf16 v[36:39], v[4:7], a[48:55], v74
  v_add_f32_dpp v24, v22, v20 quad_perm:[2,3,0,1] row_mask:0xf bank_mask:0xf
  v_add_f32_dpp v25, v23, v21 quad_perm:[2,3,0,1] row_mask:0xf bank_mask:0xf
  v_smfmac_f32_16x16x64_bf16 v[36:39], v[8:11], a[64:71], v74
  s_waitcnt lgkmcnt(2)
  s_barrier
  ds_read_b128 v[32:35], v78 offset:512
  v_smfmac_f32_16x16x64_bf16 v[36:39], v[12:15], a[80:87], v74
  ds_read_b128 v[60:63], v75 offset:30720
  v_mul_f32 v24, s69, v24
  v_smfmac_f32_16x16x64_bf16 v[40:43], v[4:7], a[56:63], v74
  ds_read_b128 v[64:67], v75 offset:31744
  v_mul_f32 v25, s69, v25
  v_smfmac_f32_16x16x64_bf16 v[40:43], v[8:11], a[72:79], v74
  v_exp_f32_dpp v24, v24 quad_perm:[0,1,0,1] row_mask:0xf bank_mask:0xf
  v_smfmac_f32_16x16x64_bf16 v[40:43], v[12:15], a[88:95], v74
  s_waitcnt lgkmcnt(2)
  v_exp_f32_dpp v25, v25 quad_perm:[0,1,0,1] row_mask:0xf bank_mask:0xf
  v_mfma_f32_16x16x32_bf16 v[8:11], v[32:35], v[68:71], 0
  v_add_f32 v36, v36, v38
  v_add_f32 v37, v37, v39
  v_mfma_f32_16x16x32_bf16 v[0:3], v[32:35], v[52:55], 0
  v_add_f32 v40, v40, v42
  v_add_f32 v41, v41, v43
  v_mfma_f32_16x16x32_bf16 v[4:7], v[32:35], v[56:59], 0
  v_cvt_pk_bf16_f32 v28, v24, v25
  v_cvt_pk_bf16_f32 v72, v36, v37
  v_cvt_pk_bf16_f32 v73, v40, v41
  v_mfma_f32_16x16x16_bf16 v[8:11], v[28:29], v[68:69], v[8:11]
  v_cvt_pk_bf16_f32 v31, v24, v25
  v_mov_b64 v[20:21], 0
  v_mfma_f32_16x16x16_bf16 v[0:3], v[28:29], v[72:73], v[0:3]
  ds_read_b128 v[68:71], v76 offset:13824
  v_mov_b64 v[22:23], 0
  v_mfma_f32_16x16x16_bf16 v[4:7], v[30:31], v[72:73], v[4:7]
  v_rcp_f32 v10, v8
  v_rcp_f32 v11, v9
  v_mul_f32 v0, v10, v0
  v_mul_f32 v1, v11, v1
  s_nop 0
  v_mul_f32 v4, v10, v4
  v_mul_f32 v5, v11, v5
  v_cvt_pk_bf16_f32 v2, v0, v4
  ds_write_b32 v79, v2 offset:8704
  v_cvt_pk_bf16_f32 v3, v1, v5
  ds_write_b32 v79, v3 offset:9280
  v_max3_f32 v8, v8, v9, v10
  v_max_f32 v8, v8, v11
  v_cmp_le_f32 vcc, 1317011456, v8
  v_mov_b64 v[24:25], 0
  v_mov_b64 v[26:27], 0
  s_cbranch_vccnz Cf3_mx
Cf3_mxok:
  s_waitcnt lgkmcnt(0)
  s_barrier
  ds_read_b128 v[0:3], v78 offset:8704
  ds_read_b128 v[4:7], v78 offset:8768
  ds_read_b128 v[8:11], v78 offset:8832
  ds_read_b128 v[12:15], v78 offset:8896
  s_waitcnt lgkmcnt(3)
  v_smfmac_f32_16x16x64_bf16 v[16:19], v[0:3], v[44:51], v74
  ds_read_b128 v[52:55], v75 offset:45056
  s_waitcnt lgkmcnt(3)
  v_smfmac_f32_16x16x64_bf16 v[16:19], v[4:7], v[60:67], v74
  ds_read_b128 v[56:59], v75 offset:46080
  s_waitcnt lgkmcnt(3)
  v_smfmac_f32_16x16x64_bf16 v[16:19], v[8:11], a[176:183], v74
  ds_read_b128 v[36:39], v75 offset:47104
  s_waitcnt lgkmcnt(3)
  v_smfmac_f32_16x16x64_bf16 v[16:19], v[12:15], a[184:191], v74
  ds_read_b128 v[40:43], v75 offset:48128
  ds_read_b128 v[44:47], v75 offset:61440
  v_smfmac_f32_16x16x64_bf16 v[20:23], v[0:3], a[192:199], v74
  ds_read_b128 v[48:51], v75 offset:62464
  ds_read_b128 v[60:63], v75 offset:63488
  v_smfmac_f32_16x16x64_bf16 v[20:23], v[4:7], a[200:207], v74
  ds_read_b128 v[64:67], v75 offset:64512
  s_waitcnt lgkmcnt(6)
  v_cvt_pk_bf16_f32 v16, v16, v17
  v_cvt_pk_bf16_f32 v17, v18, v19
  v_bfi_b32 v16, 1, s72, v16
  v_smfmac_f32_16x16x64_bf16 v[20:23], v[8:11], v[52:59], v74
  buffer_store_dwordx2 v[16:17], v68, s[8:11], s73 offen
  s_waitcnt lgkmcnt(4)
  v_smfmac_f32_16x16x64_bf16 v[20:23], v[12:15], v[36:43], v74
  ds_read_b128 v[52:55], v75 offset:8192
  v_mov_b64 v[32:33], 0
  v_smfmac_f32_16x16x64_bf16 v[24:27], v[0:3], a[208:215], v74
  ds_read_b128 v[56:59], v75 offset:9216
  v_mov_b64 v[34:35], 0
  v_smfmac_f32_16x16x64_bf16 v[24:27], v[4:7], a[216:223], v74
  ds_read_b128 v[36:39], v75 offset:10240
  s_waitcnt lgkmcnt(5)
  v_cvt_pk_bf16_f32 v20, v20, v21
  v_cvt_pk_bf16_f32 v21, v22, v23
  v_bfi_b32 v20, 1, s72, v20
  v_smfmac_f32_16x16x64_bf16 v[24:27], v[8:11], v[44:51], v74
  buffer_store_dwordx2 v[20:21], v68, s[8:11], s74 offen
  s_waitcnt lgkmcnt(3)
  v_smfmac_f32_16x16x64_bf16 v[24:27], v[12:15], v[60:67], v74
  ds_read_b128 v[40:43], v75 offset:11264
  v_mov_b64 v[28:29], 0
  v_smfmac_f32_16x16x64_bf16 v[32:35], v[0:3], a[224:231], v74
  ds_read_b128 v[44:47], v75 offset:12288
  ds_read_b128 v[48:51], v75 offset:13312
  v_smfmac_f32_16x16x64_bf16 v[32:35], v[4:7], a[232:239], v74
  ds_read_b128 v[60:63], v75 offset:14336
  v_cvt_pk_bf16_f32 v24, v24, v25
  v_cvt_pk_bf16_f32 v25, v26, v27
  v_bfi_b32 v24, 1, s72, v24
  v_smfmac_f32_16x16x64_bf16 v[32:35], v[8:11], a[240:247], v74
  buffer_store_dwordx2 v[24:25], v68, s[8:11], s75 offen
  v_mov_b64 v[30:31], 0
  v_smfmac_f32_16x16x64_bf16 v[32:35], v[12:15], a[248:255], v74
  ds_read_b128 v[64:67], v75 offset:15360
  s_waitcnt lgkmcnt(6)
  v_smfmac_f32_16x16x64_bf16 v[28:31], v[0:3], v[52:59], v74
  s_waitcnt lgkmcnt(4)
  v_smfmac_f32_16x16x64_bf16 v[28:31], v[4:7], v[36:43], v74
  s_waitcnt lgkmcnt(2)
  v_cvt_pk_bf16_f32 v32, v32, v33
  v_cvt_pk_bf16_f32 v33, v34, v35
  v_bfi_b32 v32, 1, s72, v32
  v_smfmac_f32_16x16x64_bf16 v[28:31], v[8:11], v[44:51], v74
  buffer_store_dwordx2 v[32:33], v68, s[8:11], s76 offen
  s_waitcnt lgkmcnt(0)
  v_smfmac_f32_16x16x64_bf16 v[28:31], v[12:15], v[60:67], v74
  ds_read_b128 v[52:55], v76 offset:14848
  ds_read_b64 v[16:17], v77 offset:392
  v_mov_b64 v[18:19], v[72:73]
  v_xor_b32 v75, 0x8000, v75
  s_nop 3
  v_cvt_pk_bf16_f32 v28, v28, v29
  v_cvt_pk_bf16_f32 v29, v30, v31
  v_bfi_b32 v28, 1, s72, v28
  buffer_store_dwordx2 v[28:29], v68, s[8:11], s77 offen
  v_mov_b64 v[20:21], 0
  v_mov_b64 v[22:23], 0
  v_mov_b64 v[24:25], 0
  v_mov_b64 v[26:27], 0
  v_mov_b64 v[28:29], 0
  v_mov_b64 v[30:31], 0
  v_mov_b64 v[32:33], 0
  v_mov_b64 v[34:35], 0
  v_mov_b32 v68, 14880
  s_add_u32 s58, s58, 655360
  s_add_u32 s59, s59, 655360
  s_add_u32 s70, s70, 655360
  s_add_u32 s68, s68, 655360
  s_add_u32 s66, s66, 1
  s_xor_b32 s64, s64, 16384
  s_xor_b32 s65, s65, 16384
  s_cmp_eq_u32 s66, 62
  s_cselect_b64 s[16:17], s[20:21], s[16:17]
  s_cselect_b32 s18, (Cf3_done - Cf3_last), s18
  s_cselect_b32 s70, 0, s70
  s_cmp_eq_u32 s66, 63
  s_cselect_b32 s59, 268435456, s59
  s_nop 15
  s_nop 15
  s_nop 15
  s_nop 3
  buffer_load_dwordx4 v[0:3], v76, s[8:11], s60 offen offset:0 sc1
  buffer_load_dwordx4 v[4:7], v76, s[8:11], s60 offen offset:1024 sc1
  buffer_load_dwordx4 v[8:11], v76, s[8:11], s61 offen offset:0 sc1
  buffer_load_dwordx4 v[12:15], v76, s[8:11], s61 offen offset:1024 sc1
  s_nop 15
  s_nop 11
  buffer_load_dwordx4 v[44:47], v76, s[8:11], s60 offen offset:0 sc1
  buffer_load_dwordx4 v[48:51], v76, s[8:11], s60 offen offset:1024 sc1
  buffer_load_dwordx4 v[60:63], v76, s[8:11], s61 offen offset:0 sc1
  buffer_load_dwordx4 v[64:67], v76, s[8:11], s61 offen offset:1024 sc1
  s_waitcnt lgkmcnt(0)
  s_waitcnt vmcnt(7)
  v_mfma_f32_16x16x32_bf16 v[56:59], v[52:55], v[0:3], 0
  v_bitop3_b32 v72, v0, v2, s72 bitop3:0x7e
  s_waitcnt vmcnt(6)
  v_mfma_f32_16x16x32_bf16 v[56:59], v[52:55], v[4:7], v[56:59]
  v_bitop3_b32 v73, v4, v6, s72 bitop3:0x7e
  v_or_b32 v72, v72, v73
  s_waitcnt vmcnt(5)
  v_mfma_f32_16x16x32_bf16 v[36:39], v[52:55], v[8:11], 0
  v_bitop3_b32 v73, v8, v10, s72 bitop3:0x7e
  v_or_b32 v72, v72, v73
  s_waitcnt vmcnt(4)
  v_mfma_f32_16x16x32_bf16 v[36:39], v[52:55], v[12:15], v[36:39]
  v_bitop3_b32 v73, v12, v14, s72 bitop3:0x7e
  v_bitop3_b32 v72, v72, v73, 1 bitop3:0xa8
  v_cmp_ne_u32 vcc, 0, v72
  s_cbranch_vccnz Cf3_h1r
  buffer_load_dwordx4 v[4:7], v76, s[8:11], s65 offen offset:1024 sc1
  v_add_f32_dpp v56, v56, v56 row_ror:4 row_mask:0xf bank_mask:0xf
  v_add_f32_dpp v57, v57, v57 row_ror:4 row_mask:0xf bank_mask:0xf
  v_add_f32_dpp v36, v36, v36 row_ror:4 row_mask:0xf bank_mask:0xf
  v_add_f32_dpp v37, v37, v37 row_ror:4 row_mask:0xf bank_mask:0xf
  v_add_f32_dpp v56, v56, v56 row_ror:8 row_mask:0xf bank_mask:0xf
  v_add_f32_dpp v57, v57, v57 row_ror:8 row_mask:0xf bank_mask:0xf
  v_add_f32_dpp v36, v36, v36 row_ror:8 row_mask:0xf bank_mask:0xf
  v_add_f32_dpp v37, v37, v37 row_ror:8 row_mask:0xf bank_mask:0xf
  v_cvt_pk_bf16_f32 v56, v56, v57
  buffer_store_dword v56, v69, s[8:11], s62 offen
  v_cvt_pk_bf16_f32 v36, v36, v37
  buffer_store_dword v36, v70, s[8:11], s63 offen
  s_xor_b32 s62, s62, 16384
  buffer_store_dword v71, v69, s[8:11], s62 offen
  s_xor_b32 s63, s63, 16384
  buffer_store_dword v71, v70, s[8:11], s63 offen
  s_xor_b32 s72, s72, 1
  s_branch Cf3_h2
Cf3_h1r:
  s_mov_b64 exec, vcc
  buffer_load_dwordx4 v[0:3], v76, s[8:11], s60 offen offset:0 sc1
  buffer_load_dwordx4 v[4:7], v76, s[8:11], s60 offen offset:1024 sc1
  buffer_load_dwordx4 v[8:11], v76, s[8:11], s61 offen offset:0 sc1
  buffer_load_dwordx4 v[12:15], v76, s[8:11], s61 offen offset:1024 sc1
  s_mov_b64 exec, -1
  s_add_u32 s67, s67, 1
  s_waitcnt vmcnt(7)
  v_mfma_f32_16x16x32_bf16 v[56:59], v[52:55], v[44:47], 0
  v_bitop3_b32 v72, v44, v46, s72 bitop3:0x7e
  s_waitcnt vmcnt(6)
  v_mfma_f32_16x16x32_bf16 v[56:59], v[52:55], v[48:51], v[56:59]
  v_bitop3_b32 v73, v48, v50, s72 bitop3:0x7e
  v_or_b32 v72, v72, v73
  s_waitcnt vmcnt(5)
  v_mfma_f32_16x16x32_bf16 v[36:39], v[52:55], v[60:63], 0
  v_bitop3_b32 v73, v60, v62, s72 bitop3:0x7e
  v_or_b32 v72, v72, v73
  s_waitcnt vmcnt(4)
  v_mfma_f32_16x16x32_bf16 v[36:39], v[52:55], v[64:67], v[36:39]
  v_bitop3_b32 v73, v64, v66, s72 bitop3:0x7e
  v_bitop3_b32 v72, v72, v73, 1 bitop3:0xa8
  v_cmp_ne_u32 vcc, 0, v72
  s_cbranch_vccz Cf3_h1p
  s_mov_b64 exec, vcc
  buffer_load_dwordx4 v[44:47], v76, s[8:11], s60 offen offset:0 sc1
  buffer_load_dwordx4 v[48:51], v76, s[8:11], s60 offen offset:1024 sc1
  buffer_load_dwordx4 v[60:63], v76, s[8:11], s61 offen offset:0 sc1
  buffer_load_dwordx4 v[64:67], v76, s[8:11], s61 offen offset:1024 sc1
  s_mov_b64 exec, -1
  s_add_u32 s67, s67, 1
  s_waitcnt vmcnt(7)
  v_mfma_f32_16x16x32_bf16 v[56:59], v[52:55], v[0:3], 0
  v_bitop3_b32 v72, v0, v2, s72 bitop3:0x7e
  s_waitcnt vmcnt(6)
  v_mfma_f32_16x16x32_bf16 v[56:59], v[52:55], v[4:7], v[56:59]
  v_bitop3_b32 v73, v4, v6, s72 bitop3:0x7e
  v_or_b32 v72, v72, v73
  s_waitcnt vmcnt(5)
  v_mfma_f32_16x16x32_bf16 v[36:39], v[52:55], v[8:11], 0
  v_bitop3_b32 v73, v8, v10, s72 bitop3:0x7e
  v_or_b32 v72, v72, v73
  s_waitcnt vmcnt(4)
  v_mfma_f32_16x16x32_bf16 v[36:39], v[52:55], v[12:15], v[36:39]
  v_bitop3_b32 v73, v12, v14, s72 bitop3:0x7e
  v_bitop3_b32 v72, v72, v73, 1 bitop3:0xa8
  v_cmp_ne_u32 vcc, 0, v72
  s_cbranch_vccz Cf3_h1p
Cf3_h1s:
  s_mov_b64 exec, vcc
  buffer_load_dwordx4 v[0:3], v76, s[8:11], s60 offen offset:0 sc1
  buffer_load_dwordx4 v[4:7], v76, s[8:11], s60 offen offset:1024 sc1
  buffer_load_dwordx4 v[8:11], v76, s[8:11], s61 offen offset:0 sc1
  buffer_load_dwordx4 v[12:15], v76, s[8:11], s61 offen offset:1024 sc1
  s_mov_b64 exec, -1
  s_add_u32 s67, s67, 1
  s_waitcnt vmcnt(7)
  v_mfma_f32_16x16x32_bf16 v[56:59], v[52:55], v[44:47], 0
  v_bitop3_b32 v72, v44, v46, s72 bitop3:0x7e
  s_waitcnt vmcnt(6)
  v_mfma_f32_16x16x32_bf16 v[56:59], v[52:55], v[48:51], v[56:59]
  v_bitop3_b32 v73, v48, v50, s72 bitop3:0x7e
  v_or_b32 v72, v72, v73
  s_waitcnt vmcnt(5)
  v_mfma_f32_16x16x32_bf16 v[36:39], v[52:55], v[60:63], 0
  v_bitop3_b32 v73, v60, v62, s72 bitop3:0x7e
  v_or_b32 v72, v72, v73
  s_waitcnt vmcnt(4)
  v_mfma_f32_16x16x32_bf16 v[36:39], v[52:55], v[64:67], v[36:39]
  v_bitop3_b32 v73, v64, v66, s72 bitop3:0x7e
  v_bitop3_b32 v72, v72, v73, 1 bitop3:0xa8
  v_cmp_ne_u32 vcc, 0, v72
  s_cbranch_vccz Cf3_h1p
  s_mov_b64 exec, vcc
  buffer_load_dwordx4 v[44:47], v76, s[8:11], s60 offen offset:0 sc1
  buffer_load_dwordx4 v[48:51], v76, s[8:11], s60 offen offset:1024 sc1
  buffer_load_dwordx4 v[60:63], v76, s[8:11], s61 offen offset:0 sc1
  buffer_load_dwordx4 v[64:67], v76, s[8:11], s61 offen offset:1024 sc1
  s_mov_b64 exec, -1
  s_add_u32 s67, s67, 1
  s_waitcnt vmcnt(7)
  v_mfma_f32_16x16x32_bf16 v[56:59], v[52:55], v[0:3], 0
  v_bitop3_b32 v72, v0, v2, s72 bitop3:0x7e
  s_waitcnt vmcnt(6)
  v_mfma_f32_16x16x32_bf16 v[56:59], v[52:55], v[4:7], v[56:59]
  v_bitop3_b32 v73, v4, v6, s72 bitop3:0x7e
  v_or_b32 v72, v72, v73
  s_waitcnt vmcnt(5)
  v_mfma_f32_16x16x32_bf16 v[36:39], v[52:55], v[8:11], 0
  v_bitop3_b32 v73, v8, v10, s72 bitop3:0x7e
  v_or_b32 v72, v72, v73
  s_waitcnt vmcnt(4)
  v_mfma_f32_16x16x32_bf16 v[36:39], v[52:55], v[12:15], v[36:39]
  v_bitop3_b32 v73, v12, v14, s72 bitop3:0x7e
  v_bitop3_b32 v72, v72, v73, 1 bitop3:0xa8
  v_cmp_ne_u32 vcc, 0, v72
  s_cbranch_vccz Cf3_h1p
  s_cmp_lt_u32 s67, 131072
  s_cbranch_scc1 Cf3_h1s
Cf3_h1p:
  s_nop 2
  buffer_load_dwordx4 v[4:7], v76, s[8:11], s65 offen offset:1024 sc1
  v_add_f32_dpp v56, v56, v56 row_ror:4 row_mask:0xf bank_mask:0xf
  v_add_f32_dpp v57, v57, v57 row_ror:4 row_mask:0xf bank_mask:0xf
  v_add_f32_dpp v36, v36, v36 row_ror:4 row_mask:0xf bank_mask:0xf
  v_add_f32_dpp v37, v37, v37 row_ror:4 row_mask:0xf bank_mask:0xf
  v_add_f32_dpp v56, v56, v56 row_ror:8 row_mask:0xf bank_mask:0xf
  v_add_f32_dpp v57, v57, v57 row_ror:8 row_mask:0xf bank_mask:0xf
  v_add_f32_dpp v36, v36, v36 row_ror:8 row_mask:0xf bank_mask:0xf
  v_add_f32_dpp v37, v37, v37 row_ror:8 row_mask:0xf bank_mask:0xf
  v_cvt_pk_bf16_f32 v56, v56, v57
  buffer_store_dword v56, v69, s[8:11], s62 offen
  v_cvt_pk_bf16_f32 v36, v36, v37
  buffer_store_dword v36, v70, s[8:11], s63 offen
  s_xor_b32 s62, s62, 16384
  buffer_store_dword v71, v69, s[8:11], s62 offen
  s_xor_b32 s63, s63, 16384
  buffer_store_dword v71, v70, s[8:11], s63 offen
  s_xor_b32 s72, s72, 1
  s_branch Cf3_h2
Cf3_h2r:
  s_mov_b64 exec, vcc
  buffer_load_dwordx4 v[4:7], v76, s[8:11], s65 offen offset:1024 sc1
  s_mov_b64 exec, -1
  s_add_u32 s67, s67, 1
  s_waitcnt vmcnt(3)
  v_max3_u32 v72, v4, v5, v6
  v_max_u32 v72, v72, v7
  ds_write_b128 v76, v[4:7] offset:5632
  v_cmp_eq_u32 vcc, -1, v72
  s_cbranch_vccz Cf3_h2w
Cf3_h2s:
  s_mov_b64 exec, vcc
  buffer_load_dwordx4 v[4:7], v76, s[8:11], s65 offen offset:1024 sc1
  s_mov_b64 exec, -1
  s_add_u32 s67, s67, 1
  s_waitcnt vmcnt(1)
  v_max3_u32 v72, v4, v5, v6
  v_max_u32 v72, v72, v7
  ds_write_b128 v76, v[4:7] offset:5632
  v_cmp_eq_u32 vcc, -1, v72
  s_cbranch_vccz Cf3_h2w
  s_mov_b64 exec, vcc
  buffer_load_dwordx4 v[4:7], v76, s[8:11], s65 offen offset:1024 sc1
  s_mov_b64 exec, -1
  s_add_u32 s67, s67, 1
  s_waitcnt vmcnt(1)
  v_max3_u32 v72, v4, v5, v6
  v_max_u32 v72, v72, v7
  ds_write_b128 v76, v[4:7] offset:5632
  v_cmp_eq_u32 vcc, -1, v72
  s_cbranch_vccz Cf3_h2w
  s_mov_b64 exec, vcc
  buffer_load_dwordx4 v[4:7], v76, s[8:11], s65 offen offset:1024 sc1
  s_mov_b64 exec, -1
  s_add_u32 s67, s67, 1
  s_waitcnt vmcnt(1)
  v_max3_u32 v72, v4, v5, v6
  v_max_u32 v72, v72, v7
  ds_write_b128 v76, v[4:7] offset:5632
  v_cmp_eq_u32 vcc, -1, v72
  s_cbranch_vccz Cf3_h2w
  s_cmp_lt_u32 s67, 131072
  s_cbranch_scc1 Cf3_h2s
  s_branch Cf3_h2w
Cf3_rec:
  s_nop 7
  s_waitcnt vmcnt(0) lgkmcnt(0)
  v_max3_u32 v72, v0, v1, v2
  v_max3_u32 v72, v72, v3, v4
  v_max3_u32 v72, v72, v5, v6
  v_max3_u32 v72, v72, v7, v8
  v_max3_u32 v72, v72, v9, v10
  v_max3_u32 v72, v72, v11, v12
  v_max3_u32 v72, v72, v13, v14
  v_max3_u32 v72, v72, v15, v16
  v_max3_u32 v72, v72, v17, v18
  v_max_u32 v72, v72, v19
  v_cmp_eq_u32 vcc, -1, v72
  s_cbranch_vccz Cf3_recok
  s_barrier
Cf3_recp:
  buffer_load_dwordx4 v[0:3], v76, s[8:11], s64 offen offset:0 sc1
  buffer_load_dwordx4 v[4:7], v76, s[8:11], s64 offen offset:1024 sc1
  buffer_load_dwordx4 v[8:11], v76, s[8:11], s64 offen offset:2048 sc1
  s_add_u32 s67, s67, 1
  s_cmp_lt_u32 s67, 131072
  s_cselect_b32 s54, -2, -1
  s_waitcnt vmcnt(2)
  v_max3_u32 v72, v0, v1, v2
  s_waitcnt vmcnt(1)
  v_max3_u32 v72, v72, v3, v4
  v_max3_u32 v72, v72, v5, v6
  s_waitcnt vmcnt(0)
  v_max3_u32 v72, v72, v7, v8
  v_max3_u32 v72, v72, v9, v10
  v_max_u32 v72, v72, v11
  v_cmp_lt_u32 vcc, s54, v72
  s_cbranch_vccnz Cf3_recp
  ds_write_b128 v76, v[0:3] offset:10752
  ds_write_b128 v76, v[4:7] offset:11776
  ds_write_b128 v76, v[8:11] offset:12800
  v_mov_b64 v[20:21], 0
  v_mov_b64 v[22:23], 0
  v_mov_b64 v[24:25], 0
  v_mov_b64 v[26:27], 0
  v_mov_b64 v[28:29], 0
  v_mov_b64 v[30:31], 0
  v_mov_b64 v[32:33], 0
  v_mov_b64 v[34:35], 0
  s_waitcnt lgkmcnt(0)
  s_barrier
  ds_read_b128 v[0:3], v76 offset:4608
  ds_read_b128 v[60:63], v76 offset:28672
  ds_read_b128 v[64:67], v76 offset:29696
  s_waitcnt lgkmcnt(0)
  v_smfmac_f32_16x16x64_bf16 v[20:23], v[0:3], v[60:67], v74
  ds_read_b128 v[60:63], v76 offset:30720
  ds_read_b128 v[64:67], v76 offset:31744
  s_waitcnt lgkmcnt(0)
  v_smfmac_f32_16x16x64_bf16 v[24:27], v[0:3], v[60:67], v74
  ds_read_b128 v[60:63], v76 offset:45056
  ds_read_b128 v[64:67], v76 offset:46080
  s_waitcnt lgkmcnt(0)
  v_smfmac_f32_16x16x64_bf16 v[28:31], v[0:3], v[60:67], v74
  ds_read_b128 v[60:63], v76 offset:47104
  ds_read_b128 v[64:67], v76 offset:48128
  s_waitcnt lgkmcnt(0)
  v_smfmac_f32_16x16x64_bf16 v[32:35], v[0:3], v[60:67], v74
  ds_read_b128 v[4:7], v76 offset:5632
  s_waitcnt lgkmcnt(0)
  v_smfmac_f32_16x16x64_bf16 v[20:23], v[4:7], v[80:87], v74
  v_smfmac_f32_16x16x64_bf16 v[24:27], v[4:7], v[88:95], v74
  v_smfmac_f32_16x16x64_bf16 v[28:31], v[4:7], v[192:199], v74
  v_smfmac_f32_16x16x64_bf16 v[32:35], v[4:7], v[200:207], v74
  ds_read_b128 v[8:11], v76 offset:6656
  s_waitcnt lgkmcnt(0)
  v_smfmac_f32_16x16x64_bf16 v[20:23], v[8:11], v[96:103], v74
  v_smfmac_f32_16x16x64_bf16 v[24:27], v[8:11], v[104:111], v74
  v_smfmac_f32_16x16x64_bf16 v[28:31], v[8:11], v[208:215], v74
  v_smfmac_f32_16x16x64_bf16 v[32:35], v[8:11], v[216:223], v74
  ds_read_b128 v[12:15], v76 offset:7680
  s_waitcnt lgkmcnt(0)
  v_smfmac_f32_16x16x64_bf16 v[20:23], v[12:15], v[112:119], v74
  v_smfmac_f32_16x16x64_bf16 v[24:27], v[12:15], v[120:127], v74
  v_smfmac_f32_16x16x64_bf16 v[28:31], v[12:15], v[224:231], v74
  v_smfmac_f32_16x16x64_bf16 v[32:35], v[12:15], v[232:239], v74
  ds_read_b128 v[4:7], v76 offset:8704
  s_waitcnt lgkmcnt(0)
  v_smfmac_f32_16x16x64_bf16 v[20:23], v[4:7], v[128:135], v74
  v_smfmac_f32_16x16x64_bf16 v[24:27], v[4:7], v[136:143], v74
  ds_read_b128 v[60:63], v76 offset:61440
  ds_read_b128 v[64:67], v76 offset:62464
  s_waitcnt lgkmcnt(0)
  v_smfmac_f32_16x16x64_bf16 v[28:31], v[4:7], v[60:67], v74
  ds_read_b128 v[60:63], v76 offset:63488
  ds_read_b128 v[64:67], v76 offset:64512
  s_waitcnt lgkmcnt(0)
  v_smfmac_f32_16x16x64_bf16 v[32:35], v[4:7], v[60:67], v74
  ds_read_b128 v[8:11], v76 offset:9728
  s_waitcnt lgkmcnt(0)
  v_smfmac_f32_16x16x64_bf16 v[20:23], v[8:11], v[144:151], v74
  v_smfmac_f32_16x16x64_bf16 v[24:27], v[8:11], v[152:159], v74
  ds_read_b128 v[60:63], v75 offset:28672
  ds_read_b128 v[64:67], v75 offset:29696
  s_waitcnt lgkmcnt(0)
  v_smfmac_f32_16x16x64_bf16 v[28:31], v[8:11], v[60:67], v74
  ds_read_b128 v[60:63], v75 offset:30720
  ds_read_b128 v[64:67], v75 offset:31744
  s_waitcnt lgkmcnt(0)
  v_smfmac_f32_16x16x64_bf16 v[32:35], v[8:11], v[60:67], v74
  ds_read_b128 v[16:19], v76 offset:10752
  ds_read_b128 v[60:63], v75 offset:12288
  ds_read_b128 v[64:67], v75 offset:13312
  s_waitcnt lgkmcnt(0)
  v_smfmac_f32_16x16x64_bf16 v[20:23], v[16:19], v[60:67], v74
  ds_read_b128 v[60:63], v75 offset:14336
  ds_read_b128 v[64:67], v75 offset:15360
  s_waitcnt lgkmcnt(0)
  v_smfmac_f32_16x16x64_bf16 v[24:27], v[16:19], v[60:67], v74
  v_smfmac_f32_16x16x64_bf16 v[28:31], v[16:19], v[240:247], v74
  v_smfmac_f32_16x16x64_bf16 v[32:35], v[16:19], v[248:255], v74
  ds_read_b128 v[0:3], v76 offset:11776
  s_waitcnt lgkmcnt(0)
  v_smfmac_f32_16x16x64_bf16 v[20:23], v[0:3], v[160:167], v74
  v_smfmac_f32_16x16x64_bf16 v[24:27], v[0:3], v[168:175], v74
  v_smfmac_f32_16x16x64_bf16 v[28:31], v[0:3], a[0:7], v74
  v_smfmac_f32_16x16x64_bf16 v[32:35], v[0:3], a[8:15], v74
  ds_read_b128 v[12:15], v76 offset:12800
  s_waitcnt lgkmcnt(0)
  v_smfmac_f32_16x16x64_bf16 v[20:23], v[12:15], v[176:183], v74
  v_smfmac_f32_16x16x64_bf16 v[24:27], v[12:15], v[184:191], v74
  v_smfmac_f32_16x16x64_bf16 v[28:31], v[12:15], a[16:23], v74
  v_smfmac_f32_16x16x64_bf16 v[32:35], v[12:15], a[24:31], v74
  v_add_f32 v20, v20, v22
  v_add_f32 v21, v21, v23
  v_add_f32 v24, v24, v26
  v_cvt_pk_bf16_f32 v22, v20, v24
  s_nop 0
  ds_write_b32 v79, v22 offset:0
  v_add_f32 v25, v25, v27
  v_cvt_pk_bf16_f32 v23, v21, v25
  ds_write_b32 v79, v23 offset:576
  v_add_f32 v28, v28, v30
  v_add_f32 v29, v29, v31
  s_waitcnt lgkmcnt(0)
  s_nop 1
  s_branch Cf3_recok
Cf3_mx:
  s_waitcnt lgkmcnt(0)
  s_barrier
  buffer_load_dwordx4 v[0:3], v76, s[8:11], s58 offen offset:0 sc1
  ds_read_b128 v[20:23], v77 offset:0
  ds_read_b128 v[28:31], v77 offset:256
  buffer_load_dwordx4 v[4:7], v76, s[8:11], s58 offen offset:1024 sc1
  ds_read_b128 v[24:27], v77 offset:128
  ds_read_b128 v[32:35], v77 offset:384
  s_waitcnt vmcnt(1) lgkmcnt(3)
  v_mfma_f32_16x16x32_bf16 v[8:11], v[0:3], v[20:23], 0
  s_waitcnt vmcnt(0) lgkmcnt(1)
  v_mfma_f32_16x16x32_bf16 v[8:11], v[4:7], v[24:27], v[8:11]
  v_mfma_f32_16x16x32_bf16 v[12:15], v[28:31], v[20:23], 0
  s_waitcnt lgkmcnt(0)
  v_mfma_f32_16x16x32_bf16 v[12:15], v[32:35], v[24:27], v[12:15]
  v_add_f32_dpp v8, v10, v8 quad_perm:[2,3,0,1] row_mask:0xf bank_mask:0xf
  v_add_f32_dpp v9, v11, v9 quad_perm:[2,3,0,1] row_mask:0xf bank_mask:0xf
  s_nop 0
  v_mov_b32_dpp v8, v8 quad_perm:[0,1,0,1] row_mask:0xf bank_mask:0xf
  v_mov_b32_dpp v9, v9 quad_perm:[0,1,0,1] row_mask:0xf bank_mask:0xf
  s_nop 1
  v_add_f32_dpp v12, v14, v12 quad_perm:[2,3,0,1] row_mask:0xf bank_mask:0xf
  v_add_f32_dpp v13, v15, v13 quad_perm:[2,3,0,1] row_mask:0xf bank_mask:0xf
  s_nop 0
  v_mov_b32_dpp v12, v12 quad_perm:[0,1,0,1] row_mask:0xf bank_mask:0xf
  v_mov_b32_dpp v13, v13 quad_perm:[0,1,0,1] row_mask:0xf bank_mask:0xf
  v_mul_f32 v12, s69, v12
  ds_write_b32 v78, v8 offset:8716
  v_mul_f32 v13, s69, v13
  ds_write_b32 v78, v9 offset:8780
  s_waitcnt lgkmcnt(0)
  s_barrier
  ds_read_b128 v[36:39], v78 offset:8704
  ds_read_b128 v[40:43], v78 offset:8768
  s_waitcnt lgkmcnt(0)
  s_barrier
  v_max_f32 v16, v36, v37
  v_max3_f32 v16, v16, v38, v39
  v_max3_f32 v16, v16, v40, v41
  v_max3_f32 v16, v16, v42, v43
  v_max3_f32 v16, v16, v12, v13
  v_mov_b32 v17, v16
  s_nop 1
  v_permlane16_swap_b32 v16, v17
  v_max_f32 v16, v16, v17
  v_mov_b32 v17, v16
  s_nop 1
  v_permlane32_swap_b32 v16, v17
  v_max_f32 v16, v16, v17
  v_sub_f32 v36, v36, v16
  v_sub_f32 v37, v37, v16
  v_sub_f32 v38, v38, v16
  v_sub_f32 v39, v39, v16
  v_sub_f32 v40, v40, v16
  v_sub_f32 v41, v41, v16
  v_sub_f32 v42, v42, v16
  v_sub_f32 v43, v43, v16
  v_sub_f32 v12, v12, v16
  v_sub_f32 v13, v13, v16
  v_exp_f32 v36, v36
  v_exp_f32 v37, v37
  v_exp_f32 v38, v38
  v_exp_f32 v39, v39
  v_exp_f32 v40, v40
  v_exp_f32 v41, v41
  v_exp_f32 v42, v42
  v_exp_f32 v43, v43
  v_exp_f32 v12, v12
  v_exp_f32 v13, v13
  v_cvt_pk_bf16_f32 v32, v36, v40
  v_cvt_pk_bf16_f32 v33, v37, v41
  v_cvt_pk_bf16_f32 v34, v38, v42
  v_cvt_pk_bf16_f32 v35, v39, v43
  v_cvt_pk_bf16_f32 v28, v12, v13
  v_cvt_pk_bf16_f32 v31, v12, v13
  v_mov_b32 v29, 0
  v_mov_b32 v30, 0
  v_mov_b32 v68, 0x3f803f80
  v_mov_b32 v69, 0x3f803f80
  v_mov_b32 v70, 0x3f803f80
  v_mov_b32 v71, 0x3f803f80
  s_nop 1
  v_mfma_f32_16x16x32_bf16 v[8:11], v[32:35], v[68:71], 0
  v_mfma_f32_16x16x32_bf16 v[0:3], v[32:35], v[52:55], 0
  v_mfma_f32_16x16x32_bf16 v[4:7], v[32:35], v[56:59], 0
  v_mfma_f32_16x16x16_bf16 v[8:11], v[28:29], v[68:69], v[8:11]
  v_mfma_f32_16x16x16_bf16 v[0:3], v[28:29], v[72:73], v[0:3]
  v_mfma_f32_16x16x16_bf16 v[4:7], v[30:31], v[72:73], v[4:7]
  ds_read_b128 v[68:71], v76 offset:13824
  v_rcp_f32 v10, v8
  v_rcp_f32 v11, v9
  v_mul_f32 v0, v10, v0
  v_mul_f32 v1, v11, v1
  s_nop 0
  v_mul_f32 v4, v10, v4
  v_mul_f32 v5, v11, v5
  v_cvt_pk_bf16_f32 v2, v0, v4
  ds_write_b32 v79, v2 offset:8704
  v_cvt_pk_bf16_f32 v3, v1, v5
  ds_write_b32 v79, v3 offset:9280
  v_mov_b64 v[16:17], 0
  v_mov_b64 v[18:19], 0
  v_mov_b64 v[20:21], 0
  v_mov_b64 v[22:23], 0
  v_mov_b64 v[24:25], 0
  v_mov_b64 v[26:27], 0
  s_branch Cf3_mxok
Cf3_last:
  ds_read_b128 v[8:11], v76 offset:6656
  ds_read_b128 v[12:15], v76 offset:7680
  ds_read_b128 v[60:63], v76 offset:47104
  ds_read_b128 v[64:67], v76 offset:48128
  ds_read_b128 v[44:47], v76 offset:61440
  ds_read_b128 v[48:51], v76 offset:62464
  s_nop 3
  v_mov_b64 v[20:21], 0
  v_mov_b64 v[22:23], 0
  v_mov_b64 v[24:25], 0
  v_mov_b64 v[26:27], 0
  s_waitcnt lgkmcnt(6)
  v_smfmac_f32_16x16x64_bf16 v[28:31], v[0:3], v[36:43], v74
  v_smfmac_f32_16x16x64_bf16 v[20:23], v[0:3], a[32:39], v74
  ds_read_b128 v[36:39], v76 offset:63488
  ds_read_b128 v[40:43], v76 offset:64512
  v_smfmac_f32_16x16x64_bf16 v[24:27], v[0:3], a[40:47], v74
  v_smfmac_f32_16x16x64_bf16 v[20:23], v[4:7], a[48:55], v74
  buffer_store_dwordx4 v[16:19], v76, s[8:11], s68 offen sc1
  s_waitcnt lgkmcnt(4)
  v_smfmac_f32_16x16x64_bf16 v[24:27], v[4:7], a[56:63], v74
  v_smfmac_f32_16x16x64_bf16 v[28:31], v[4:7], v[192:199], v74
  v_smfmac_f32_16x16x64_bf16 v[32:35], v[4:7], v[200:207], v74
  v_smfmac_f32_16x16x64_bf16 v[32:35], v[0:3], v[60:67], v74
  v_smfmac_f32_16x16x64_bf16 v[20:23], v[8:11], a[64:71], v74
  ds_read_b128 v[60:63], v75 offset:28672
  ds_read_b128 v[64:67], v75 offset:29696
  v_smfmac_f32_16x16x64_bf16 v[24:27], v[8:11], a[72:79], v74
  v_smfmac_f32_16x16x64_bf16 v[28:31], v[8:11], v[208:215], v74
  v_smfmac_f32_16x16x64_bf16 v[20:23], v[12:15], a[80:87], v74
  v_smfmac_f32_16x16x64_bf16 v[24:27], v[12:15], a[88:95], v74
  v_smfmac_f32_16x16x64_bf16 v[28:31], v[12:15], v[224:231], v74
  v_smfmac_f32_16x16x64_bf16 v[32:35], v[12:15], v[232:239], v74
  v_smfmac_f32_16x16x64_bf16 v[32:35], v[8:11], v[216:223], v74
  s_waitcnt vmcnt(1)
  s_barrier
Cf3_lastr:
  ds_read_b128 v[4:7], v76 offset:8704
  ds_read_b128 v[8:11], v76 offset:9728
  ds_read_b128 v[16:19], v76 offset:10752
  ds_read_b128 v[0:3], v76 offset:11776
  ds_read_b128 v[12:15], v76 offset:12800
  s_waitcnt lgkmcnt(1)
  v_max3_u32 v72, v0, v1, v2
  v_max3_u32 v72, v72, v3, v4
  v_max3_u32 v72, v72, v5, v6
  v_max3_u32 v72, v72, v7, v8
  v_max3_u32 v72, v72, v9, v10
  s_waitcnt lgkmcnt(0)
  v_max3_u32 v72, v72, v11, v12
  v_max3_u32 v72, v72, v13, v14
  v_max3_u32 v72, v72, v15, v16
  v_max3_u32 v72, v72, v17, v18
  v_max_u32 v72, v72, v19
  v_cmp_eq_u32 vcc, -1, v72
  s_cbranch_vccnz Cf3_lastp
Cf3_lastg:
  v_smfmac_f32_16x16x64_bf16 v[28:31], v[4:7], v[44:51], v74
  ds_read_b128 v[44:47], v75 offset:30720
  ds_read_b128 v[48:51], v75 offset:31744
  v_smfmac_f32_16x16x64_bf16 v[32:35], v[4:7], v[36:43], v74
  v_smfmac_f32_16x16x64_bf16 v[28:31], v[8:11], v[60:67], v74
  v_smfmac_f32_16x16x64_bf16 v[28:31], v[16:19], v[240:247], v74
  v_smfmac_f32_16x16x64_bf16 v[28:31], v[0:3], a[0:7], v74
  v_smfmac_f32_16x16x64_bf16 v[28:31], v[12:15], a[16:23], v74
  v_smfmac_f32_16x16x64_bf16 v[32:35], v[16:19], v[248:255], v74
  v_smfmac_f32_16x16x64_bf16 v[32:35], v[0:3], a[8:15], v74
  s_waitcnt lgkmcnt(0)
  v_smfmac_f32_16x16x64_bf16 v[32:35], v[12:15], a[24:31], v74
  v_smfmac_f32_16x16x64_bf16 v[32:35], v[8:11], v[44:51], v74
  v_smfmac_f32_16x16x64_bf16 v[20:23], v[4:7], a[96:103], v74
  v_smfmac_f32_16x16x64_bf16 v[20:23], v[8:11], a[112:119], v74
  v_add_f32 v28, v28, v30
  v_add_f32 v32, v32, v34
  v_cvt_pk_bf16_f32 v30, v28, v32
  v_smfmac_f32_16x16x64_bf16 v[20:23], v[16:19], a[128:135], v74
  ds_write_b32 v79, v30 offset:256
  v_add_f32 v29, v29, v31
  v_add_f32 v33, v33, v35
  v_cvt_pk_bf16_f32 v31, v29, v33
  v_smfmac_f32_16x16x64_bf16 v[20:23], v[0:3], a[144:151], v74
  ds_write_b32 v79, v31 offset:832
  v_smfmac_f32_16x16x64_bf16 v[20:23], v[12:15], a[160:167], v74
  v_smfmac_f32_16x16x64_bf16 v[24:27], v[4:7], a[104:111], v74
  v_smfmac_f32_16x16x64_bf16 v[24:27], v[8:11], a[120:127], v74
  v_smfmac_f32_16x16x64_bf16 v[24:27], v[16:19], a[136:143], v74
  s_waitcnt lgkmcnt(0)
  s_barrier
  ds_read_b64 v[52:53], v77 offset:392
  v_add_f32 v20, v20, v22
  v_smfmac_f32_16x16x64_bf16 v[24:27], v[0:3], a[152:159], v74
  v_add_f32 v21, v21, v23
  v_smfmac_f32_16x16x64_bf16 v[24:27], v[12:15], a[168:175], v74
  v_cvt_pk_bf16_f32 v54, v20, v21
  s_add_u32 s68, s68, 655360
  s_nop 3
  v_add_f32 v24, v24, v26
  v_add_f32 v25, v25, v27
  v_cvt_pk_bf16_f32 v55, v24, v25
  s_waitcnt lgkmcnt(0)
  buffer_store_dwordx4 v[52:55], v76, s[8:11], s68 offen sc1
  s_branch Cf3_done
Cf3_lastp:
  s_add_u32 s72, s72, 2
  s_cmp_ge_u32 s72, 131072
  s_cbranch_scc1 Cf3_lastg
  s_barrier
  buffer_load_dwordx4 v76, s[8:11], s55 offen offset:0 sc1 lds
  buffer_load_dwordx4 v76, s[8:11], s55 offen offset:1024 sc1 lds
  s_waitcnt vmcnt(0)
  s_barrier
  s_branch Cf3_lastr
Cf3_done:
  s_branch L_cexit
L_w4:
  v_mov_b64 v[20:21], 0
  v_mov_b64 v[22:23], 0
  v_mov_b64 v[24:25], 0
  v_mov_b64 v[26:27], 0
  v_mov_b64 v[28:29], 0
  v_mov_b64 v[30:31], 0
  v_mov_b64 v[32:33], 0
  v_mov_b64 v[34:35], 0
  s_mov_b32 s78, 0x3f803f80
  s_mov_b32 s79, s78
  s_mov_b32 s65, 360448
  s_mov_b32 m0, 16128
  s_lshl_b32 s71, s53, 2
  s_add_u32 s71, s71, 128
  s_movk_i32 s56, 0x1000
  v_lshlrev_b32 v73, 2, v76
  v_mov_b32 v72, 0
  s_mov_b64 s[16:17], s[8:9]
  s_mov_b32 s18, 268435456
  s_mov_b32 s19, 0x20000
  s_getpc_b64 s[20:21]
Cs0_pc:
  s_add_u32 s20, s20, (Cs0_last - Cs0_pc)
  s_addc_u32 s21, s21, 0
  v_mov_b32 v68, 14880
  buffer_load_dwordx4 v[52:55], v76, s[8:11], s59 offen offset:0 sc1
  buffer_load_dwordx4 v[56:59], v76, s[8:11], s59 offen offset:1024 sc1
  ds_read_b128 v[60:63], v76 offset:16384
  ds_read_b128 v[64:67], v76 offset:17408
  ds_read_b128 v[44:47], v76 offset:18432
  ds_read_b128 v[48:51], v76 offset:19456
  ds_read_b128 v[36:39], v76 offset:32768
  ds_read_b128 v[40:43], v76 offset:33792
  ds_read_b128 v[0:3], v76 offset:4608
  ds_read_b128 v[4:7], v76 offset:5632
  ds_read_b128 v[8:11], v76 offset:6656
  ds_read_b128 v[12:15], v76 offset:7680
  s_waitcnt lgkmcnt(0)
  s_mov_b32 m0, 0
  s_mov_b32 s55, 268435456
  s_cmp_eq_u32 s66, 1
  s_branch Cs0_top2
.p2align 6
Cs0_h2:
  v_lshlrev_b32 v73, 2, v76
  s_mov_b32 m0, 10752
  s_add_u32 s55, s65, 6144
  s_cmp_eq_u32 s66, 12
  s_cselect_b32 s56, s71, 0x1000
  ds_read_b32 v72, v76 offset:16128
  s_cmp_eq_u32 s66, 13
  s_cselect_b32 s54, 0x700, 0
  s_waitcnt lgkmcnt(0)
  v_readfirstlane_b32 s57, v72
  s_nop 0
  s_cmp_lt_u32 s57, s54
  s_cbranch_scc1 Cs0_kv3
Cs0_kvb:
  s_nop 1
  buffer_load_dwordx4 v[0:3], v76, s[8:11], s65 offen offset:0 sc1
  s_nop 15
  s_nop 3
  buffer_load_dwordx4 v[0:3], v76, s[8:11], s65 offen offset:0 sc1
  s_nop 15
  s_nop 3
  buffer_load_dwordx4 v[0:3], v76, s[8:11], s65 offen offset:0 sc1
  s_waitcnt vmcnt(5)
  ds_read_b128 v[60:63], v76 offset:16384
  ds_read_b128 v[64:67], v76 offset:17408
  ds_read_b128 v[44:47], v76 offset:18432
  ds_read_b128 v[48:51], v76 offset:19456
  ds_read_b128 v[36:39], v76 offset:32768
  ds_read_b128 v[40:43], v76 offset:33792
  buffer_load_dwordx4 v[52:55], v76, s[8:11], s59 offen offset:0 sc1
  buffer_load_dwordx4 v[56:59], v76, s[8:11], s59 offen offset:1024 sc1
  s_waitcnt vmcnt(4)
  v_max3_u32 v72, v0, v1, v2
  v_max_u32 v72, v72, v3
  ds_write_b128 v76, v[0:3] offset:4608
  v_cmp_eq_u32 vcc, -1, v72
  s_cbranch_vccnz Cs0_h2r
Cs0_h2w:
  s_cmp_eq_u32 s66, 63
  s_waitcnt lgkmcnt(0)
  s_barrier
  ds_read_b128 v[4:7], v76 offset:5632
  buffer_load_dwordx4 v76, s[8:11], s55 offen offset:0 sc1 lds
  buffer_load_dwordx4 v76, s[8:11], s55 offen offset:1024 sc1 lds
Cs0_top2:
  v_smfmac_f32_16x16x64_bf16 v[24:27], v[0:3], v[44:51], v74
  s_cbranch_scc1 Cs0_last
  v_smfmac_f32_16x16x64_bf16 v[20:23], v[0:3], v[60:67], v74
  ds_read_b128 v[60:63], v76 offset:34816
  ds_read_b128 v[64:67], v76 offset:35840
  v_smfmac_f32_16x16x64_bf16 v[28:31], v[0:3], v[36:43], v74
  buffer_load_dwordx4 v76, s[8:11], s55 offen offset:2048 sc1 lds
  s_waitcnt lgkmcnt(2)
  v_smfmac_f32_16x16x64_bf16 v[20:23], v[4:7], v[80:87], v74
  buffer_load_dwordx4 v[44:47], v76, s[8:11], s58 offen offset:0 sc1
  ds_read_b128 v[8:11], v76 offset:6656
  v_smfmac_f32_16x16x64_bf16 v[24:27], v[4:7], v[88:95], v74
  buffer_load_dwordx4 v[48:51], v76, s[8:11], s58 offen offset:1024 sc1
  s_mov_b32 m0, 16128
  v_smfmac_f32_16x16x64_bf16 v[28:31], v[4:7], v[192:199], v74
  ds_read_b128 v[12:15], v76 offset:7680
  v_smfmac_f32_16x16x64_bf16 v[32:35], v[4:7], v[200:207], v74
  ds_read_b128 v[36:39], v76 offset:49152
  s_waitcnt lgkmcnt(3)
  v_smfmac_f32_16x16x64_bf16 v[32:35], v[0:3], v[60:67], v74
  ds_read_b128 v[40:43], v76 offset:50176
  s_waitcnt lgkmcnt(3)
  v_smfmac_f32_16x16x64_bf16 v[20:23], v[8:11], v[96:103], v74
  buffer_store_dwordx4 v[16:19], v76, s[8:11], s68 offen sc1
  v_smfmac_f32_16x16x64_bf16 v[24:27], v[8:11], v[104:111], v74
  s_waitcnt vmcnt(6)
  ds_read_b128 v[60:63], v76 offset:51200
  v_smfmac_f32_16x16x64_bf16 v[28:31], v[8:11], v[208:215], v74
  s_barrier
  v_smfmac_f32_16x16x64_bf16 v[32:35], v[8:11], v[216:223], v74
  buffer_load_dword v73, s[16:19], s70 offen lds
  ds_read_b128 v[4:7], v76 offset:8704
  s_waitcnt lgkmcnt(4)
  v_smfmac_f32_16x16x64_bf16 v[20:23], v[12:15], v[112:119], v74
  ds_read_b128 v[64:67], v76 offset:52224
  v_smfmac_f32_16x16x64_bf16 v[24:27], v[12:15], v[120:127], v74
  ds_read_b128 v[0:3], v76 offset:9728
  v_smfmac_f32_16x16x64_bf16 v[28:31], v[12:15], v[224:231], v74
  buffer_load_dword off, s[12:15], s56 sc1 lds
  v_smfmac_f32_16x16x64_bf16 v[32:35], v[12:15], v[232:239], v74
  s_waitcnt lgkmcnt(2)
  v_smfmac_f32_16x16x64_bf16 v[28:31], v[4:7], v[36:43], v74
  s_waitcnt vmcnt(5)
  ds_read_b128 v[36:39], v75 offset:0
  ds_read_b128 v[40:43], v75 offset:1024
  s_waitcnt lgkmcnt(3)
  v_smfmac_f32_16x16x64_bf16 v[32:35], v[4:7], v[60:67], v74
  s_barrier
  ds_read_b128 v[16:19], v76 offset:10752
  v_smfmac_f32_16x16x64_bf16 v[20:23], v[4:7], v[128:135], v74
  ds_read_b128 v[60:63], v75 offset:2048
  ds_read_b128 v[64:67], v75 offset:3072
  v_smfmac_f32_16x16x64_bf16 v[24:27], v[4:7], v[136:143], v74
  ds_read_b128 v[8:11], v76 offset:11776
  s_waitcnt lgkmcnt(6)
  v_smfmac_f32_16x16x64_bf16 v[20:23], v[0:3], v[144:151], v74
  ds_read_b128 v[12:15], v76 offset:12800
  v_smfmac_f32_16x16x64_bf16 v[24:27], v[0:3], v[152:159], v74
  s_waitcnt lgkmcnt(4)
  v_smfmac_f32_16x16x64_bf16 v[20:23], v[16:19], v[36:43], v74
  ds_read_b128 v[36:39], v75 offset:16384
  s_waitcnt lgkmcnt(3)
  v_smfmac_f32_16x16x64_bf16 v[24:27], v[16:19], v[60:67], v74
  ds_read_b128 v[40:43], v75 offset:17408
  s_waitcnt lgkmcnt(3)
  v_smfmac_f32_16x16x64_bf16 v[20:23], v[8:11], v[160:167], v74
  ds_read_b128 v[60:63], v75 offset:18432
  s_waitcnt lgkmcnt(3)
  v_smfmac_f32_16x16x64_bf16 v[20:23], v[12:15], v[176:183], v74
  ds_read_b128 v[64:67], v75 offset:19456
  v_smfmac_f32_16x16x64_bf16 v[24:27], v[8:11], v[168:175], v74
  v_mov_b64 v[70:71], s[78:79]
  v_smfmac_f32_16x16x64_bf16 v[24:27], v[12:15], v[184:191], v74
  s_waitcnt lgkmcnt(2)
  v_add_f32 v20, v20, v22
  v_smfmac_f32_16x16x64_bf16 v[28:31], v[0:3], v[36:43], v74
  ds_read_b128 v[36:39], v68
  s_waitcnt lgkmcnt(1)
  v_add_f32 v21, v21, v23
  v_smfmac_f32_16x16x64_bf16 v[32:35], v[0:3], v[60:67], v74
  ds_read_b128 v[40:43], v68
  v_add_f32 v24, v24, v26
  v_smfmac_f32_16x16x64_bf16 v[28:31], v[16:19], v[240:247], v74
  v_cvt_pk_bf16_f32 v22, v20, v24
  v_smfmac_f32_16x16x64_bf16 v[28:31], v[8:11], a[0:7], v74
  ds_write_b32 v79, v22 offset:0
  v_add_f32 v25, v25, v27
  v_cvt_pk_bf16_f32 v23, v21, v25
  v_smfmac_f32_16x16x64_bf16 v[28:31], v[12:15], a[16:23], v74
  ds_write_b32 v79, v23 offset:576
  v_cmp_u_f32 vcc, v20, v21
  v_smfmac_f32_16x16x64_bf16 v[32:35], v[16:19], v[248:255], v74
  v_mov_b64 v[68:69], s[78:79]
  v_smfmac_f32_16x16x64_bf16 v[32:35], v[8:11], a[8:15], v74
  v_add_f32 v28, v28, v30
  v_add_f32 v29, v29, v31
  v_smfmac_f32_16x16x64_bf16 v[32:35], v[12:15], a[24:31], v74
  s_cbranch_vccnz Cs0_rec
Cs0_recok:
  s_waitcnt lgkmcnt(3)
  v_smfmac_f32_16x16x64_bf16 v[36:39], v[16:19], a[128:135], v74
  s_waitcnt lgkmcnt(0)
  s_barrier
  ds_read_b128 v[60:63], v77
  v_smfmac_f32_16x16x64_bf16 v[40:43], v[16:19], a[136:143], v74
  ds_read_b128 v[64:67], v77 offset:128
  v_add_f32 v32, v32, v34
  v_cvt_pk_bf16_f32 v30, v28, v32
  v_smfmac_f32_16x16x64_bf16 v[36:39], v[0:3], a[112:119], v74
  ds_write_b32 v79, v30 offset:256
  v_add_f32 v33, v33, v35
  v_cvt_pk_bf16_f32 v31, v29, v33
  v_smfmac_f32_16x16x64_bf16 v[40:43], v[0:3], a[120:127], v74
  ds_write_b32 v79, v31 offset:832
  v_xor_b32 v75, 0x8000, v75
  v_smfmac_f32_16x16x64_bf16 v[36:39], v[4:7], a[96:103], v74
  ds_read_b128 v[0:3], v76 offset:4608
  v_mov_b32 v29, 0
  v_smfmac_f32_16x16x64_bf16 v[40:43], v[4:7], a[104:111], v74
  s_waitcnt vmcnt(3) lgkmcnt(3)
  v_mov_b32 v30, 0
  v_mfma_f32_16x16x32_bf16 v[44:47], v[44:47], v[60:63], 0
  ds_read_b128 v[4:7], v76 offset:5632
  s_waitcnt lgkmcnt(2)
  v_mfma_f32_16x16x32_bf16 v[44:47], v[48:51], v[64:67], v[44:47]
  s_barrier
  v_smfmac_f32_16x16x64_bf16 v[36:39], v[8:11], a[144:151], v74
  ds_read_b128 v[20:23], v77 offset:256
  ds_read_b128 v[24:27], v77 offset:384
  v_smfmac_f32_16x16x64_bf16 v[40:43], v[8:11], a[152:159], v74
  ds_read_b128 v[8:11], v76 offset:6656
  v_add_f32_dpp v72, v46, v44 quad_perm:[2,3,0,1] row_mask:0xf bank_mask:0xf
  v_add_f32_dpp v73, v47, v45 quad_perm:[2,3,0,1] row_mask:0xf bank_mask:0xf
  v_smfmac_f32_16x16x64_bf16 v[36:39], v[12:15], a[160:167], v74
  s_waitcnt lgkmcnt(4)
  v_exp_f32_dpp v72, v72 quad_perm:[0,1,0,1] row_mask:0xf bank_mask:0xf
  v_smfmac_f32_16x16x64_bf16 v[40:43], v[12:15], a[168:175], v74
  ds_read_b128 v[12:15], v76 offset:7680
  v_exp_f32_dpp v73, v73 quad_perm:[0,1,0,1] row_mask:0xf bank_mask:0xf
  v_smfmac_f32_16x16x64_bf16 v[36:39], v[0:3], a[32:39], v74
  s_waitcnt lgkmcnt(2)
  v_cvt_pk_bf16_f32 v72, v72, v73
  v_mfma_f32_16x16x32_bf16 v[20:23], v[20:23], v[60:63], 0
  ds_write_b32 v78, v72 offset:512
  v_mov_b64 v[16:17], 0
  v_mfma_f32_16x16x32_bf16 v[20:23], v[24:27], v[64:67], v[20:23]
  ds_read_b128 v[44:47], v75 offset:16384
  v_mov_b64 v[18:19], 0
  v_smfmac_f32_16x16x64_bf16 v[40:43], v[0:3], a[40:47], v74
  ds_read_b128 v[48:51], v75 offset:17408
  s_waitcnt lgkmcnt(4)
  v_smfmac_f32_16x16x64_bf16 v[36:39], v[4:7], a[48:55], v74
  v_add_f32_dpp v24, v22, v20 quad_perm:[2,3,0,1] row_mask:0xf bank_mask:0xf
  v_add_f32_dpp v25, v23, v21 quad_perm:[2,3,0,1] row_mask:0xf bank_mask:0xf
  v_smfmac_f32_16x16x64_bf16 v[36:39], v[8:11], a[64:71], v74
  s_waitcnt lgkmcnt(2)
  s_barrier
  ds_read_b128 v[32:35], v78 offset:512
  v_smfmac_f32_16x16x64_bf16 v[36:39], v[12:15], a[80:87], v74
  ds_read_b128 v[60:63], v75 offset:18432
  v_mul_f32 v24, s69, v24
  v_smfmac_f32_16x16x64_bf16 v[40:43], v[4:7], a[56:63], v74
  ds_read_b128 v[64:67], v75 offset:19456
  v_mul_f32 v25, s69, v25
  v_smfmac_f32_16x16x64_bf16 v[40:43], v[8:11], a[72:79], v74
  v_exp_f32_dpp v24, v24 quad_perm:[0,1,0,1] row_mask:0xf bank_mask:0xf
  v_smfmac_f32_16x16x64_bf16 v[40:43], v[12:15], a[88:95], v74
  s_waitcnt lgkmcnt(2)
  v_exp_f32_dpp v25, v25 quad_perm:[0,1,0,1] row_mask:0xf bank_mask:0xf
  v_mfma_f32_16x16x32_bf16 v[8:11], v[32:35], v[68:71], 0
  v_add_f32 v36, v36, v38
  v_add_f32 v37, v37, v39
  v_mfma_f32_16x16x32_bf16 v[0:3], v[32:35], v[52:55], 0
  v_add_f32 v40, v40, v42
  v_add_f32 v41, v41, v43
  v_mfma_f32_16x16x32_bf16 v[4:7], v[32:35], v[56:59], 0
  v_cvt_pk_bf16_f32 v28, v24, v25
  v_cvt_pk_bf16_f32 v72, v36, v37
  v_cvt_pk_bf16_f32 v73, v40, v41
  v_mfma_f32_16x16x16_bf16 v[8:11], v[28:29], v[68:69], v[8:11]
  v_cvt_pk_bf16_f32 v31, v24, v25
  v_mov_b64 v[20:21], 0
  v_mfma_f32_16x16x16_bf16 v[0:3], v[28:29], v[72:73], v[0:3]
  ds_read_b128 v[68:71], v76 offset:13824
  v_mov_b64 v[22:23], 0
  v_mfma_f32_16x16x16_bf16 v[4:7], v[30:31], v[72:73], v[4:7]
  v_rcp_f32 v10, v8
  v_rcp_f32 v11, v9
  v_mul_f32 v0, v10, v0
  v_mul_f32 v1, v11, v1
  s_nop 0
  v_mul_f32 v4, v10, v4
  v_mul_f32 v5, v11, v5
  v_cvt_pk_bf16_f32 v2, v0, v4
  ds_write_b32 v79, v2 offset:8704
  v_cvt_pk_bf16_f32 v3, v1, v5
  ds_write_b32 v79, v3 offset:9280
  v_max3_f32 v8, v8, v9, v10
  v_max_f32 v8, v8, v11
  v_cmp_le_f32 vcc, 1317011456, v8
  v_mov_b64 v[24:25], 0
  v_mov_b64 v[26:27], 0
  s_cbranch_vccnz Cs0_mx
Cs0_mxok:
  s_waitcnt lgkmcnt(0)
  s_barrier
  ds_read_b128 v[0:3], v78 offset:8704
  ds_read_b128 v[4:7], v78 offset:8768
  ds_read_b128 v[8:11], v78 offset:8832
  ds_read_b128 v[12:15], v78 offset:8896
  s_waitcnt lgkmcnt(3)
  v_smfmac_f32_16x16x64_bf16 v[16:19], v[0:3], v[44:51], v74
  ds_read_b128 v[52:55], v75 offset:32768
  s_waitcnt lgkmcnt(3)
  v_smfmac_f32_16x16x64_bf16 v[16:19], v[4:7], v[60:67], v74
  ds_read_b128 v[56:59], v75 offset:33792
  s_waitcnt lgkmcnt(3)
  v_smfmac_f32_16x16x64_bf16 v[16:19], v[8:11], a[176:183], v74
  ds_read_b128 v[36:39], v75 offset:34816
  s_waitcnt lgkmcnt(3)
  v_smfmac_f32_16x16x64_bf16 v[16:19], v[12:15], a[184:191], v74
  ds_read_b128 v[40:43], v75 offset:35840
  ds_read_b128 v[44:47], v75 offset:49152
  v_smfmac_f32_16x16x64_bf16 v[20:23], v[0:3], a[192:199], v74
  ds_read_b128 v[48:51], v75 offset:50176
  ds_read_b128 v[60:63], v75 offset:51200
  v_smfmac_f32_16x16x64_bf16 v[20:23], v[4:7], a[200:207], v74
  ds_read_b128 v[64:67], v75 offset:52224
  s_waitcnt lgkmcnt(6)
  v_cvt_pk_bf16_f32 v16, v16, v17
  v_cvt_pk_bf16_f32 v17, v18, v19
  v_bfi_b32 v16, 1, s72, v16
  v_smfmac_f32_16x16x64_bf16 v[20:23], v[8:11], v[52:59], v74
  buffer_store_dwordx2 v[16:17], v68, s[8:11], s73 offen sc1
  s_waitcnt lgkmcnt(4)
  v_smfmac_f32_16x16x64_bf16 v[20:23], v[12:15], v[36:43], v74
  v_mov_b64 v[32:33], 0
  v_smfmac_f32_16x16x64_bf16 v[24:27], v[0:3], a[208:215], v74
  v_mov_b64 v[34:35], 0
  v_smfmac_f32_16x16x64_bf16 v[24:27], v[4:7], a[216:223], v74
  s_waitcnt lgkmcnt(2)
  v_cvt_pk_bf16_f32 v20, v20, v21
  v_cvt_pk_bf16_f32 v21, v22, v23
  v_bfi_b32 v20, 1, s72, v20
  v_smfmac_f32_16x16x64_bf16 v[24:27], v[8:11], v[44:51], v74
  buffer_store_dwordx2 v[20:21], v68, s[8:11], s74 offen sc1
  s_waitcnt lgkmcnt(0)
  v_smfmac_f32_16x16x64_bf16 v[24:27], v[12:15], v[60:67], v74
  v_smfmac_f32_16x16x64_bf16 v[32:35], v[0:3], a[224:231], v74
  v_smfmac_f32_16x16x64_bf16 v[32:35], v[4:7], a[232:239], v74
  v_cvt_pk_bf16_f32 v24, v24, v25
  v_cvt_pk_bf16_f32 v25, v26, v27
  v_bfi_b32 v24, 1, s72, v24
  v_smfmac_f32_16x16x64_bf16 v[32:35], v[8:11], a[240:247], v74
  s_nop 1
  buffer_store_dwordx2 v[24:25], v68, s[8:11], s75 offen sc1
  v_smfmac_f32_16x16x64_bf16 v[32:35], v[12:15], a[248:255], v74
  ds_read_b128 v[0:3], v76 offset:14848
  ds_read_b64 v[16:17], v77 offset:256
  v_mov_b64 v[18:19], v[72:73]
  v_xor_b32 v75, 0x8000, v75
  s_nop 3
  v_cvt_pk_bf16_f32 v32, v32, v33
  v_cvt_pk_bf16_f32 v33, v34, v35
  v_bfi_b32 v32, 1, s72, v32
  buffer_store_dwordx2 v[32:33], v68, s[8:11], s76 offen sc1
  v_mov_b64 v[20:21], 0
  v_mov_b64 v[22:23], 0
  v_mov_b64 v[24:25], 0
  v_mov_b64 v[26:27], 0
  v_mov_b64 v[28:29], 0
  v_mov_b64 v[30:31], 0
  v_mov_b64 v[32:33], 0
  v_mov_b64 v[34:35], 0
  v_mov_b32 v68, 14880
  s_add_u32 s58, s58, 655360
  s_add_u32 s59, s59, 655360
  s_add_u32 s70, s70, 655360
  s_add_u32 s68, s68, 655360
  s_add_u32 s66, s66, 1
  s_xor_b32 s64, s64, 16384
  s_xor_b32 s65, s65, 16384
  s_cmp_eq_u32 s66, 62
  s_cselect_b64 s[16:17], s[20:21], s[16:17]
  s_cselect_b32 s18, (Cs0_done - Cs0_last), s18
  s_cselect_b32 s70, 0, s70
  s_cmp_eq_u32 s66, 63
  s_cselect_b32 s59, 268435456, s59
  s_nop 13
  buffer_load_dwordx4 v[52:55], v76, s[8:11], s60 offen offset:0 sc1
  buffer_load_dwordx4 v[56:59], v76, s[8:11], s60 offen offset:1024 sc1
  s_nop 15
  s_nop 11
  buffer_load_dwordx4 v[36:39], v76, s[8:11], s60 offen offset:0 sc1
  buffer_load_dwordx4 v[40:43], v76, s[8:11], s60 offen offset:1024 sc1
  s_waitcnt lgkmcnt(0)
  s_waitcnt vmcnt(3)
  v_mfma_f32_16x16x32_bf16 v[4:7], v[0:3], v[52:55], 0
  v_bitop3_b32 v72, v52, v54, s72 bitop3:0x7e
  s_waitcnt vmcnt(2)
  v_mfma_f32_16x16x32_bf16 v[4:7], v[0:3], v[56:59], v[4:7]
  v_bitop3_b32 v73, v56, v58, s72 bitop3:0x7e
  v_bitop3_b32 v72, v72, v73, 1 bitop3:0xa8
  v_cmp_ne_u32 vcc, 0, v72
  s_cbranch_vccnz Cs0_h1r
  s_nop 2
  v_add_f32_dpp v4, v4, v4 row_ror:4 row_mask:0xf bank_mask:0xf
  v_add_f32_dpp v5, v5, v5 row_ror:4 row_mask:0xf bank_mask:0xf
  s_nop 0
  v_add_f32_dpp v4, v4, v4 row_ror:8 row_mask:0xf bank_mask:0xf
  v_add_f32_dpp v5, v5, v5 row_ror:8 row_mask:0xf bank_mask:0xf
  v_cvt_pk_bf16_f32 v4, v4, v5
  buffer_store_dword v4, v69, s[8:11], s62 offen sc1
  s_xor_b32 s62, s62, 16384
  buffer_store_dword v71, v69, s[8:11], s62 offen sc1
  s_xor_b32 s72, s72, 1
  s_branch Cs0_h2
Cs0_h1r:
  s_mov_b64 exec, vcc
  buffer_load_dwordx4 v[52:55], v76, s[8:11], s60 offen offset:0 sc1
  buffer_load_dwordx4 v[56:59], v76, s[8:11], s60 offen offset:1024 sc1
  s_mov_b64 exec, -1
  s_add_u32 s67, s67, 1
  s_waitcnt vmcnt(3)
  v_mfma_f32_16x16x32_bf16 v[4:7], v[0:3], v[36:39], 0
  v_bitop3_b32 v72, v36, v38, s72 bitop3:0x7e
  s_waitcnt vmcnt(2)
  v_mfma_f32_16x16x32_bf16 v[4:7], v[0:3], v[40:43], v[4:7]
  v_bitop3_b32 v73, v40, v42, s72 bitop3:0x7e
  v_bitop3_b32 v72, v72, v73, 1 bitop3:0xa8
  v_cmp_ne_u32 vcc, 0, v72
  s_cbranch_vccz Cs0_h1p
  s_mov_b64 exec, vcc
  buffer_load_dwordx4 v[36:39], v76, s[8:11], s60 offen offset:0 sc1
  buffer_load_dwordx4 v[40:43], v76, s[8:11], s60 offen offset:1024 sc1
  s_mov_b64 exec, -1
  s_add_u32 s67, s67, 1
  s_waitcnt vmcnt(3)
  v_mfma_f32_16x16x32_bf16 v[4:7], v[0:3], v[52:55], 0
  v_bitop3_b32 v72, v52, v54, s72 bitop3:0x7e
  s_waitcnt vmcnt(2)
  v_mfma_f32_16x16x32_bf16 v[4:7], v[0:3], v[56:59], v[4:7]
  v_bitop3_b32 v73, v56, v58, s72 bitop3:0x7e
  v_bitop3_b32 v72, v72, v73, 1 bitop3:0xa8
  v_cmp_ne_u32 vcc, 0, v72
  s_cbranch_vccz Cs0_h1p
Cs0_h1s:
  s_mov_b64 exec, vcc
  buffer_load_dwordx4 v[52:55], v76, s[8:11], s60 offen offset:0 sc1
  buffer_load_dwordx4 v[56:59], v76, s[8:11], s60 offen offset:1024 sc1
  s_mov_b64 exec, -1
  s_add_u32 s67, s67, 1
  s_waitcnt vmcnt(3)
  v_mfma_f32_16x16x32_bf16 v[4:7], v[0:3], v[36:39], 0
  v_bitop3_b32 v72, v36, v38, s72 bitop3:0x7e
  s_waitcnt vmcnt(2)
  v_mfma_f32_16x16x32_bf16 v[4:7], v[0:3], v[40:43], v[4:7]
  v_bitop3_b32 v73, v40, v42, s72 bitop3:0x7e
  v_bitop3_b32 v72, v72, v73, 1 bitop3:0xa8
  v_cmp_ne_u32 vcc, 0, v72
  s_cbranch_vccz Cs0_h1p
  s_mov_b64 exec, vcc
  buffer_load_dwordx4 v[36:39], v76, s[8:11], s60 offen offset:0 sc1
  buffer_load_dwordx4 v[40:43], v76, s[8:11], s60 offen offset:1024 sc1
  s_mov_b64 exec, -1
  s_add_u32 s67, s67, 1
  s_waitcnt vmcnt(3)
  v_mfma_f32_16x16x32_bf16 v[4:7], v[0:3], v[52:55], 0
  v_bitop3_b32 v72, v52, v54, s72 bitop3:0x7e
  s_waitcnt vmcnt(2)
  v_mfma_f32_16x16x32_bf16 v[4:7], v[0:3], v[56:59], v[4:7]
  v_bitop3_b32 v73, v56, v58, s72 bitop3:0x7e
  v_bitop3_b32 v72, v72, v73, 1 bitop3:0xa8
  v_cmp_ne_u32 vcc, 0, v72
  s_cbranch_vccz Cs0_h1p
  s_cmp_lt_u32 s67, 131072
  s_cbranch_scc1 Cs0_h1s
Cs0_h1p:
  s_nop 2
  v_add_f32_dpp v4, v4, v4 row_ror:4 row_mask:0xf bank_mask:0xf
  v_add_f32_dpp v5, v5, v5 row_ror:4 row_mask:0xf bank_mask:0xf
  s_nop 0
  v_add_f32_dpp v4, v4, v4 row_ror:8 row_mask:0xf bank_mask:0xf
  v_add_f32_dpp v5, v5, v5 row_ror:8 row_mask:0xf bank_mask:0xf
  v_cvt_pk_bf16_f32 v4, v4, v5
  buffer_store_dword v4, v69, s[8:11], s62 offen sc1
  s_xor_b32 s62, s62, 16384
  buffer_store_dword v71, v69, s[8:11], s62 offen sc1
  s_xor_b32 s72, s72, 1
  s_branch Cs0_h2
Cs0_h2r:
  s_mov_b64 exec, vcc
  buffer_load_dwordx4 v[0:3], v76, s[8:11], s65 offen offset:0 sc1
  s_mov_b64 exec, -1
  s_add_u32 s67, s67, 1
  s_waitcnt vmcnt(4)
  v_max3_u32 v72, v0, v1, v2
  v_max_u32 v72, v72, v3
  ds_write_b128 v76, v[0:3] offset:4608
  v_cmp_eq_u32 vcc, -1, v72
  s_cbranch_vccz Cs0_h2w
  s_mov_b64 exec, vcc
  buffer_load_dwordx4 v[0:3], v76, s[8:11], s65 offen offset:0 sc1
  s_mov_b64 exec, -1
  s_add_u32 s67, s67, 1
  s_waitcnt vmcnt(4)
  v_max3_u32 v72, v0, v1, v2
  v_max_u32 v72, v72, v3
  ds_write_b128 v76, v[0:3] offset:4608
  v_cmp_eq_u32 vcc, -1, v72
  s_cbranch_vccz Cs0_h2w
Cs0_h2s:
  s_mov_b64 exec, vcc
  buffer_load_dwordx4 v[0:3], v76, s[8:11], s65 offen offset:0 sc1
  s_mov_b64 exec, -1
  s_add_u32 s67, s67, 1
  s_waitcnt vmcnt(2)
  v_max3_u32 v72, v0, v1, v2
  v_max_u32 v72, v72, v3
  ds_write_b128 v76, v[0:3] offset:4608
  v_cmp_eq_u32 vcc, -1, v72
  s_cbranch_vccz Cs0_h2w
  s_mov_b64 exec, vcc
  buffer_load_dwordx4 v[0:3], v76, s[8:11], s65 offen offset:0 sc1
  s_mov_b64 exec, -1
  s_add_u32 s67, s67, 1
  s_waitcnt vmcnt(2)
  v_max3_u32 v72, v0, v1, v2
  v_max_u32 v72, v72, v3
  ds_write_b128 v76, v[0:3] offset:4608
  v_cmp_eq_u32 vcc, -1, v72
  s_cbranch_vccz Cs0_h2w
  s_mov_b64 exec, vcc
  buffer_load_dwordx4 v[0:3], v76, s[8:11], s65 offen offset:0 sc1
  s_mov_b64 exec, -1
  s_add_u32 s67, s67, 1
  s_waitcnt vmcnt(2)
  v_max3_u32 v72, v0, v1, v2
  v_max_u32 v72, v72, v3
  ds_write_b128 v76, v[0:3] offset:4608
  v_cmp_eq_u32 vcc, -1, v72
  s_cbranch_vccz Cs0_h2w
  s_cmp_lt_u32 s67, 131072
  s_cbranch_scc1 Cs0_h2s
  s_branch Cs0_h2w
Cs0_rec:
  s_nop 7
  s_waitcnt vmcnt(0) lgkmcnt(0)
  v_max3_u32 v72, v0, v1, v2
  v_max3_u32 v72, v72, v3, v4
  v_max3_u32 v72, v72, v5, v6
  v_max3_u32 v72, v72, v7, v8
  v_max3_u32 v72, v72, v9, v10
  v_max3_u32 v72, v72, v11, v12
  v_max3_u32 v72, v72, v13, v14
  v_max3_u32 v72, v72, v15, v16
  v_max3_u32 v72, v72, v17, v18
  v_max_u32 v72, v72, v19
  v_cmp_eq_u32 vcc, -1, v72
  s_cbranch_vccz Cs0_recok
  s_barrier
  v_mov_b64 v[20:21], 0
  v_mov_b64 v[22:23], 0
  v_mov_b64 v[24:25], 0
  v_mov_b64 v[26:27], 0
  v_mov_b64 v[28:29], 0
  v_mov_b64 v[30:31], 0
  v_mov_b64 v[32:33], 0
  v_mov_b64 v[34:35], 0
  s_waitcnt lgkmcnt(0)
  s_barrier
  ds_read_b128 v[0:3], v76 offset:4608
  ds_read_b128 v[60:63], v76 offset:16384
  ds_read_b128 v[64:67], v76 offset:17408
  s_waitcnt lgkmcnt(0)
  v_smfmac_f32_16x16x64_bf16 v[20:23], v[0:3], v[60:67], v74
  ds_read_b128 v[60:63], v76 offset:18432
  ds_read_b128 v[64:67], v76 offset:19456
  s_waitcnt lgkmcnt(0)
  v_smfmac_f32_16x16x64_bf16 v[24:27], v[0:3], v[60:67], v74
  ds_read_b128 v[60:63], v76 offset:32768
  ds_read_b128 v[64:67], v76 offset:33792
  s_waitcnt lgkmcnt(0)
  v_smfmac_f32_16x16x64_bf16 v[28:31], v[0:3], v[60:67], v74
  ds_read_b128 v[60:63], v76 offset:34816
  ds_read_b128 v[64:67], v76 offset:35840
  s_waitcnt lgkmcnt(0)
  v_smfmac_f32_16x16x64_bf16 v[32:35], v[0:3], v[60:67], v74
  ds_read_b128 v[4:7], v76 offset:5632
  s_waitcnt lgkmcnt(0)
  v_smfmac_f32_16x16x64_bf16 v[20:23], v[4:7], v[80:87], v74
  v_smfmac_f32_16x16x64_bf16 v[24:27], v[4:7], v[88:95], v74
  v_smfmac_f32_16x16x64_bf16 v[28:31], v[4:7], v[192:199], v74
  v_smfmac_f32_16x16x64_bf16 v[32:35], v[4:7], v[200:207], v74
  ds_read_b128 v[8:11], v76 offset:6656
  s_waitcnt lgkmcnt(0)
  v_smfmac_f32_16x16x64_bf16 v[20:23], v[8:11], v[96:103], v74
  v_smfmac_f32_16x16x64_bf16 v[24:27], v[8:11], v[104:111], v74
  v_smfmac_f32_16x16x64_bf16 v[28:31], v[8:11], v[208:215], v74
  v_smfmac_f32_16x16x64_bf16 v[32:35], v[8:11], v[216:223], v74
  ds_read_b128 v[12:15], v76 offset:7680
  s_waitcnt lgkmcnt(0)
  v_smfmac_f32_16x16x64_bf16 v[20:23], v[12:15], v[112:119], v74
  v_smfmac_f32_16x16x64_bf16 v[24:27], v[12:15], v[120:127], v74
  v_smfmac_f32_16x16x64_bf16 v[28:31], v[12:15], v[224:231], v74
  v_smfmac_f32_16x16x64_bf16 v[32:35], v[12:15], v[232:239], v74
  ds_read_b128 v[4:7], v76 offset:8704
  s_waitcnt lgkmcnt(0)
  v_smfmac_f32_16x16x64_bf16 v[20:23], v[4:7], v[128:135], v74
  v_smfmac_f32_16x16x64_bf16 v[24:27], v[4:7], v[136:143], v74
  ds_read_b128 v[60:63], v76 offset:49152
  ds_read_b128 v[64:67], v76 offset:50176
  s_waitcnt lgkmcnt(0)
  v_smfmac_f32_16x16x64_bf16 v[28:31], v[4:7], v[60:67], v74
  ds_read_b128 v[60:63], v76 offset:51200
  ds_read_b128 v[64:67], v76 offset:52224
  s_waitcnt lgkmcnt(0)
  v_smfmac_f32_16x16x64_bf16 v[32:35], v[4:7], v[60:67], v74
  ds_read_b128 v[0:3], v76 offset:9728
  s_waitcnt lgkmcnt(0)
  v_smfmac_f32_16x16x64_bf16 v[20:23], v[0:3], v[144:151], v74
  v_smfmac_f32_16x16x64_bf16 v[24:27], v[0:3], v[152:159], v74
  ds_read_b128 v[60:63], v75 offset:16384
  ds_read_b128 v[64:67], v75 offset:17408
  s_waitcnt lgkmcnt(0)
  v_smfmac_f32_16x16x64_bf16 v[28:31], v[0:3], v[60:67], v74
  ds_read_b128 v[60:63], v75 offset:18432
  ds_read_b128 v[64:67], v75 offset:19456
  s_waitcnt lgkmcnt(0)
  v_smfmac_f32_16x16x64_bf16 v[32:35], v[0:3], v[60:67], v74
  ds_read_b128 v[16:19], v76 offset:10752
  ds_read_b128 v[60:63], v75 offset:0
  ds_read_b128 v[64:67], v75 offset:1024
  s_waitcnt lgkmcnt(0)
  v_smfmac_f32_16x16x64_bf16 v[20:23], v[16:19], v[60:67], v74
  ds_read_b128 v[60:63], v75 offset:2048
  ds_read_b128 v[64:67], v75 offset:3072
  s_waitcnt lgkmcnt(0)
  v_smfmac_f32_16x16x64_bf16 v[24:27], v[16:19], v[60:67], v74
  v_smfmac_f32_16x16x64_bf16 v[28:31], v[16:19], v[240:247], v74
  v_smfmac_f32_16x16x64_bf16 v[32:35], v[16:19], v[248:255], v74
  ds_read_b128 v[8:11], v76 offset:11776
  s_waitcnt lgkmcnt(0)
  v_smfmac_f32_16x16x64_bf16 v[20:23], v[8:11], v[160:167], v74
  v_smfmac_f32_16x16x64_bf16 v[24:27], v[8:11], v[168:175], v74
  v_smfmac_f32_16x16x64_bf16 v[28:31], v[8:11], a[0:7], v74
  v_smfmac_f32_16x16x64_bf16 v[32:35], v[8:11], a[8:15], v74
  ds_read_b128 v[12:15], v76 offset:12800
  s_waitcnt lgkmcnt(0)
  v_smfmac_f32_16x16x64_bf16 v[20:23], v[12:15], v[176:183], v74
  v_smfmac_f32_16x16x64_bf16 v[24:27], v[12:15], v[184:191], v74
  v_smfmac_f32_16x16x64_bf16 v[28:31], v[12:15], a[16:23], v74
  v_smfmac_f32_16x16x64_bf16 v[32:35], v[12:15], a[24:31], v74
  v_add_f32 v20, v20, v22
  v_add_f32 v21, v21, v23
  v_add_f32 v24, v24, v26
  v_cvt_pk_bf16_f32 v22, v20, v24
  s_nop 0
  ds_write_b32 v79, v22 offset:0
  v_add_f32 v25, v25, v27
  v_cvt_pk_bf16_f32 v23, v21, v25
  ds_write_b32 v79, v23 offset:576
  v_add_f32 v28, v28, v30
  v_add_f32 v29, v29, v31
  s_waitcnt lgkmcnt(0)
  s_nop 1
  s_branch Cs0_recok
Cs0_mx:
  s_waitcnt lgkmcnt(0)
  s_barrier
  buffer_load_dwordx4 v[0:3], v76, s[8:11], s58 offen offset:0 sc1
  ds_read_b128 v[20:23], v77 offset:0
  ds_read_b128 v[28:31], v77 offset:256
  buffer_load_dwordx4 v[4:7], v76, s[8:11], s58 offen offset:1024 sc1
  ds_read_b128 v[24:27], v77 offset:128
  ds_read_b128 v[32:35], v77 offset:384
  s_waitcnt vmcnt(1) lgkmcnt(3)
  v_mfma_f32_16x16x32_bf16 v[8:11], v[0:3], v[20:23], 0
  s_waitcnt vmcnt(0) lgkmcnt(1)
  v_mfma_f32_16x16x32_bf16 v[8:11], v[4:7], v[24:27], v[8:11]
  v_mfma_f32_16x16x32_bf16 v[12:15], v[28:31], v[20:23], 0
  s_waitcnt lgkmcnt(0)
  v_mfma_f32_16x16x32_bf16 v[12:15], v[32:35], v[24:27], v[12:15]
  v_add_f32_dpp v8, v10, v8 quad_perm:[2,3,0,1] row_mask:0xf bank_mask:0xf
  v_add_f32_dpp v9, v11, v9 quad_perm:[2,3,0,1] row_mask:0xf bank_mask:0xf
  s_nop 0
  v_mov_b32_dpp v8, v8 quad_perm:[0,1,0,1] row_mask:0xf bank_mask:0xf
  v_mov_b32_dpp v9, v9 quad_perm:[0,1,0,1] row_mask:0xf bank_mask:0xf
  s_nop 1
  v_add_f32_dpp v12, v14, v12 quad_perm:[2,3,0,1] row_mask:0xf bank_mask:0xf
  v_add_f32_dpp v13, v15, v13 quad_perm:[2,3,0,1] row_mask:0xf bank_mask:0xf
  s_nop 0
  v_mov_b32_dpp v12, v12 quad_perm:[0,1,0,1] row_mask:0xf bank_mask:0xf
  v_mov_b32_dpp v13, v13 quad_perm:[0,1,0,1] row_mask:0xf bank_mask:0xf
  v_mul_f32 v12, s69, v12
  ds_write_b32 v78, v8 offset:8704
  v_mul_f32 v13, s69, v13
  ds_write_b32 v78, v9 offset:8768
  s_waitcnt lgkmcnt(0)
  s_barrier
  ds_read_b128 v[36:39], v78 offset:8704
  ds_read_b128 v[40:43], v78 offset:8768
  s_waitcnt lgkmcnt(0)
  s_barrier
  v_max_f32 v16, v36, v37
  v_max3_f32 v16, v16, v38, v39
  v_max3_f32 v16, v16, v40, v41
  v_max3_f32 v16, v16, v42, v43
  v_max3_f32 v16, v16, v12, v13
  v_mov_b32 v17, v16
  s_nop 1
  v_permlane16_swap_b32 v16, v17
  v_max_f32 v16, v16, v17
  v_mov_b32 v17, v16
  s_nop 1
  v_permlane32_swap_b32 v16, v17
  v_max_f32 v16, v16, v17
  v_sub_f32 v36, v36, v16
  v_sub_f32 v37, v37, v16
  v_sub_f32 v38, v38, v16
  v_sub_f32 v39, v39, v16
  v_sub_f32 v40, v40, v16
  v_sub_f32 v41, v41, v16
  v_sub_f32 v42, v42, v16
  v_sub_f32 v43, v43, v16
  v_sub_f32 v12, v12, v16
  v_sub_f32 v13, v13, v16
  v_exp_f32 v36, v36
  v_exp_f32 v37, v37
  v_exp_f32 v38, v38
  v_exp_f32 v39, v39
  v_exp_f32 v40, v40
  v_exp_f32 v41, v41
  v_exp_f32 v42, v42
  v_exp_f32 v43, v43
  v_exp_f32 v12, v12
  v_exp_f32 v13, v13
  v_cvt_pk_bf16_f32 v32, v36, v40
  v_cvt_pk_bf16_f32 v33, v37, v41
  v_cvt_pk_bf16_f32 v34, v38, v42
  v_cvt_pk_bf16_f32 v35, v39, v43
  v_cvt_pk_bf16_f32 v28, v12, v13
  v_cvt_pk_bf16_f32 v31, v12, v13
  v_mov_b32 v29, 0
  v_mov_b32 v30, 0
  v_mov_b32 v68, 0x3f803f80
  v_mov_b32 v69, 0x3f803f80
  v_mov_b32 v70, 0x3f803f80
  v_mov_b32 v71, 0x3f803f80
  s_nop 1
  v_mfma_f32_16x16x32_bf16 v[8:11], v[32:35], v[68:71], 0
  v_mfma_f32_16x16x32_bf16 v[0:3], v[32:35], v[52:55], 0
  v_mfma_f32_16x16x32_bf16 v[4:7], v[32:35], v[56:59], 0
  v_mfma_f32_16x16x16_bf16 v[8:11], v[28:29], v[68:69], v[8:11]
  v_mfma_f32_16x16x16_bf16 v[0:3], v[28:29], v[72:73], v[0:3]
  v_mfma_f32_16x16x16_bf16 v[4:7], v[30:31], v[72:73], v[4:7]
  ds_read_b128 v[68:71], v76 offset:13824
  v_rcp_f32 v10, v8
  v_rcp_f32 v11, v9
  v_mul_f32 v0, v10, v0
  v_mul_f32 v1, v11, v1
  s_nop 0
  v_mul_f32 v4, v10, v4
  v_mul_f32 v5, v11, v5
  v_cvt_pk_bf16_f32 v2, v0, v4
  ds_write_b32 v79, v2 offset:8704
  v_cvt_pk_bf16_f32 v3, v1, v5
  ds_write_b32 v79, v3 offset:9280
  v_mov_b64 v[16:17], 0
  v_mov_b64 v[18:19], 0
  v_mov_b64 v[20:21], 0
  v_mov_b64 v[22:23], 0
  v_mov_b64 v[24:25], 0
  v_mov_b64 v[26:27], 0
  s_branch Cs0_mxok
Cs0_kv3:
  s_waitcnt lgkmcnt(0)
  s_cmp_ge_u32 s57, 0x700
  s_cbranch_scc1 Cs0_kvb
  s_load_dword s57, s[12:13], s71 glc
  s_add_u32 s67, s67, 1
  s_cmp_lt_u32 s67, 131072
  s_cbranch_scc1 Cs0_kv3
  s_waitcnt lgkmcnt(0)
  s_branch Cs0_kvb
Cs0_last:
  buffer_load_dwordx4 v76, s[8:11], s55 offen offset:2048 sc1 lds
  ds_read_b128 v[8:11], v76 offset:6656
  ds_read_b128 v[12:15], v76 offset:7680
  ds_read_b128 v[60:63], v76 offset:34816
  ds_read_b128 v[64:67], v76 offset:35840
  ds_read_b128 v[44:47], v76 offset:49152
  ds_read_b128 v[48:51], v76 offset:50176
  s_nop 3
  v_mov_b64 v[20:21], 0
  v_mov_b64 v[22:23], 0
  v_mov_b64 v[24:25], 0
  v_mov_b64 v[26:27], 0
  v_smfmac_f32_16x16x64_bf16 v[28:31], v[0:3], v[36:43], v74
  s_waitcnt lgkmcnt(6)
  v_smfmac_f32_16x16x64_bf16 v[20:23], v[0:3], a[32:39], v74
  ds_read_b128 v[36:39], v76 offset:51200
  ds_read_b128 v[40:43], v76 offset:52224
  v_smfmac_f32_16x16x64_bf16 v[24:27], v[0:3], a[40:47], v74
  v_smfmac_f32_16x16x64_bf16 v[20:23], v[4:7], a[48:55], v74
  buffer_store_dwordx4 v[16:19], v76, s[8:11], s68 offen sc1
  s_waitcnt lgkmcnt(4)
  v_smfmac_f32_16x16x64_bf16 v[24:27], v[4:7], a[56:63], v74
  v_smfmac_f32_16x16x64_bf16 v[28:31], v[4:7], v[192:199], v74
  v_smfmac_f32_16x16x64_bf16 v[32:35], v[4:7], v[200:207], v74
  v_smfmac_f32_16x16x64_bf16 v[32:35], v[0:3], v[60:67], v74
  v_smfmac_f32_16x16x64_bf16 v[20:23], v[8:11], a[64:71], v74
  ds_read_b128 v[60:63], v75 offset:16384
  ds_read_b128 v[64:67], v75 offset:17408
  v_smfmac_f32_16x16x64_bf16 v[24:27], v[8:11], a[72:79], v74
  v_smfmac_f32_16x16x64_bf16 v[28:31], v[8:11], v[208:215], v74
  v_smfmac_f32_16x16x64_bf16 v[20:23], v[12:15], a[80:87], v74
  v_smfmac_f32_16x16x64_bf16 v[24:27], v[12:15], a[88:95], v74
  v_smfmac_f32_16x16x64_bf16 v[28:31], v[12:15], v[224:231], v74
  v_smfmac_f32_16x16x64_bf16 v[32:35], v[12:15], v[232:239], v74
  v_smfmac_f32_16x16x64_bf16 v[32:35], v[8:11], v[216:223], v74
  s_waitcnt vmcnt(4)
  s_waitcnt vmcnt(1)
  s_barrier
Cs0_lastr:
  ds_read_b128 v[4:7], v76 offset:8704
  ds_read_b128 v[0:3], v76 offset:9728
  ds_read_b128 v[16:19], v76 offset:10752
  ds_read_b128 v[8:11], v76 offset:11776
  ds_read_b128 v[12:15], v76 offset:12800
  s_waitcnt lgkmcnt(3)
  v_max3_u32 v72, v0, v1, v2
  v_max3_u32 v72, v72, v3, v4
  v_max3_u32 v72, v72, v5, v6
  s_waitcnt lgkmcnt(1)
  v_max3_u32 v72, v72, v7, v8
  v_max3_u32 v72, v72, v9, v10
  s_waitcnt lgkmcnt(0)
  v_max3_u32 v72, v72, v11, v12
  v_max3_u32 v72, v72, v13, v14
  v_max3_u32 v72, v72, v15, v16
  v_max3_u32 v72, v72, v17, v18
  v_max_u32 v72, v72, v19
  v_cmp_eq_u32 vcc, -1, v72
  s_cbranch_vccnz Cs0_lastp
Cs0_lastg:
  v_smfmac_f32_16x16x64_bf16 v[28:31], v[4:7], v[44:51], v74
  ds_read_b128 v[44:47], v75 offset:18432
  ds_read_b128 v[48:51], v75 offset:19456
  v_smfmac_f32_16x16x64_bf16 v[32:35], v[4:7], v[36:43], v74
  v_smfmac_f32_16x16x64_bf16 v[28:31], v[0:3], v[60:67], v74
  v_smfmac_f32_16x16x64_bf16 v[28:31], v[16:19], v[240:247], v74
  v_smfmac_f32_16x16x64_bf16 v[28:31], v[8:11], a[0:7], v74
  v_smfmac_f32_16x16x64_bf16 v[28:31], v[12:15], a[16:23], v74
  v_smfmac_f32_16x16x64_bf16 v[32:35], v[16:19], v[248:255], v74
  v_smfmac_f32_16x16x64_bf16 v[32:35], v[8:11], a[8:15], v74
  s_waitcnt lgkmcnt(0)
  v_smfmac_f32_16x16x64_bf16 v[32:35], v[12:15], a[24:31], v74
  v_smfmac_f32_16x16x64_bf16 v[32:35], v[0:3], v[44:51], v74
  v_smfmac_f32_16x16x64_bf16 v[20:23], v[4:7], a[96:103], v74
  v_smfmac_f32_16x16x64_bf16 v[20:23], v[0:3], a[112:119], v74
  v_add_f32 v28, v28, v30
  v_add_f32 v32, v32, v34
  v_cvt_pk_bf16_f32 v30, v28, v32
  v_smfmac_f32_16x16x64_bf16 v[20:23], v[16:19], a[128:135], v74
  ds_write_b32 v79, v30 offset:256
  v_add_f32 v29, v29, v31
  v_add_f32 v33, v33, v35
  v_cvt_pk_bf16_f32 v31, v29, v33
  v_smfmac_f32_16x16x64_bf16 v[20:23], v[8:11], a[144:151], v74
  ds_write_b32 v79, v31 offset:832
  v_smfmac_f32_16x16x64_bf16 v[20:23], v[12:15], a[160:167], v74
  v_smfmac_f32_16x16x64_bf16 v[24:27], v[4:7], a[104:111], v74
  v_smfmac_f32_16x16x64_bf16 v[24:27], v[0:3], a[120:127], v74
  v_smfmac_f32_16x16x64_bf16 v[24:27], v[16:19], a[136:143], v74
  s_waitcnt lgkmcnt(0)
  s_barrier
  ds_read_b64 v[52:53], v77 offset:256
  v_add_f32 v20, v20, v22
  v_smfmac_f32_16x16x64_bf16 v[24:27], v[8:11], a[152:159], v74
  v_add_f32 v21, v21, v23
  v_smfmac_f32_16x16x64_bf16 v[24:27], v[12:15], a[168:175], v74
  v_cvt_pk_bf16_f32 v54, v20, v21
  s_add_u32 s68, s68, 655360
  s_nop 3
  v_add_f32 v24, v24, v26
  v_add_f32 v25, v25, v27
  v_cvt_pk_bf16_f32 v55, v24, v25
  s_waitcnt lgkmcnt(0)
  buffer_store_dwordx4 v[52:55], v76, s[8:11], s68 offen sc1
  s_branch Cs0_done
Cs0_lastp:
  s_add_u32 s72, s72, 2
  s_cmp_ge_u32 s72, 131072
  s_cbranch_scc1 Cs0_lastg
  s_barrier
  buffer_load_dwordx4 v76, s[8:11], s55 offen offset:0 sc1 lds
  buffer_load_dwordx4 v76, s[8:11], s55 offen offset:1024 sc1 lds
  buffer_load_dwordx4 v76, s[8:11], s55 offen offset:2048 sc1 lds
  s_waitcnt vmcnt(0)
  s_barrier
  s_branch Cs0_lastr
Cs0_done:
  s_branch L_cexit
L_w5:
  v_mov_b64 v[20:21], 0
  v_mov_b64 v[22:23], 0
  v_mov_b64 v[24:25], 0
  v_mov_b64 v[26:27], 0
  v_mov_b64 v[28:29], 0
  v_mov_b64 v[30:31], 0
  v_mov_b64 v[32:33], 0
  v_mov_b64 v[34:35], 0
  s_mov_b32 s78, 0x3f803f80
  s_mov_b32 s79, s78
  s_mov_b32 s65, 360448
  s_mov_b32 m0, 15872
  s_lshl_b32 s71, s53, 2
  s_add_u32 s71, s71, 128
  s_movk_i32 s56, 0x1000
  v_lshlrev_b32 v73, 2, v76
  v_mov_b32 v72, 0
  s_mov_b64 s[16:17], s[8:9]
  s_mov_b32 s18, 268435456
  s_mov_b32 s19, 0x20000
  s_getpc_b64 s[20:21]
Cs1_pc:
  s_add_u32 s20, s20, (Cs1_last - Cs1_pc)
  s_addc_u32 s21, s21, 0
  v_mov_b32 v68, 14880
  buffer_load_dwordx4 v[52:55], v76, s[8:11], s59 offen offset:0 sc1
  buffer_load_dwordx4 v[56:59], v76, s[8:11], s59 offen offset:1024 sc1
  ds_read_b128 v[60:63], v76 offset:20480
  ds_read_b128 v[64:67], v76 offset:21504
  ds_read_b128 v[44:47], v76 offset:22528
  ds_read_b128 v[48:51], v76 offset:23552
  ds_read_b128 v[36:39], v76 offset:36864
  ds_read_b128 v[40:43], v76 offset:37888
  ds_read_b128 v[0:3], v76 offset:4608
  ds_read_b128 v[4:7], v76 offset:5632
  ds_read_b128 v[8:11], v76 offset:6656
  ds_read_b128 v[12:15], v76 offset:7680
  s_waitcnt lgkmcnt(0)
  s_cmp_eq_u32 s66, 1
  s_branch Cs1_top2
.p2align 6
Cs1_h2:
  v_lshlrev_b32 v73, 2, v76
  s_nop 15
  s_nop 3
  buffer_load_dwordx4 v[8:11], v76, s[8:11], s65 offen offset:2048 sc1
  s_nop 15
  s_nop 3
  buffer_load_dwordx4 v[8:11], v76, s[8:11], s65 offen offset:2048 sc1
  s_nop 15
  s_nop 3
  buffer_load_dwordx4 v[8:11], v76, s[8:11], s65 offen offset:2048 sc1
  s_waitcnt vmcnt(5)
  ds_read_b128 v[60:63], v76 offset:20480
  ds_read_b128 v[64:67], v76 offset:21504
  ds_read_b128 v[44:47], v76 offset:22528
  ds_read_b128 v[48:51], v76 offset:23552
  ds_read_b128 v[36:39], v76 offset:36864
  ds_read_b128 v[40:43], v76 offset:37888
  buffer_load_dwordx4 v[52:55], v76, s[8:11], s59 offen offset:0 sc1
  buffer_load_dwordx4 v[56:59], v76, s[8:11], s59 offen offset:1024 sc1
  s_waitcnt vmcnt(4)
  v_max3_u32 v72, v8, v9, v10
  v_max_u32 v72, v72, v11
  ds_write_b128 v76, v[8:11] offset:6656
  v_cmp_eq_u32 vcc, -1, v72
  s_cbranch_vccnz Cs1_h2r
Cs1_h2w:
  s_cmp_eq_u32 s66, 63
  s_waitcnt lgkmcnt(0)
  s_barrier
  ds_read_b128 v[0:3], v76 offset:4608
Cs1_top2:
  v_smfmac_f32_16x16x64_bf16 v[20:23], v[8:11], v[96:103], v74
  s_cbranch_scc1 Cs1_last
  v_smfmac_f32_16x16x64_bf16 v[24:27], v[8:11], v[104:111], v74
  ds_read_b128 v[4:7], v76 offset:5632
  v_smfmac_f32_16x16x64_bf16 v[28:31], v[8:11], v[208:215], v74
  ds_read_b128 v[12:15], v76 offset:7680
  v_smfmac_f32_16x16x64_bf16 v[32:35], v[8:11], v[216:223], v74
  s_waitcnt lgkmcnt(2)
  v_smfmac_f32_16x16x64_bf16 v[24:27], v[0:3], v[44:51], v74
  buffer_load_dwordx4 v[44:47], v76, s[8:11], s58 offen offset:0 sc1
  v_smfmac_f32_16x16x64_bf16 v[20:23], v[0:3], v[60:67], v74
  buffer_load_dwordx4 v[48:51], v76, s[8:11], s58 offen offset:1024 sc1
  ds_read_b128 v[60:63], v76 offset:38912
  v_smfmac_f32_16x16x64_bf16 v[28:31], v[0:3], v[36:43], v74
  ds_read_b128 v[64:67], v76 offset:39936
  s_waitcnt lgkmcnt(3)
  v_smfmac_f32_16x16x64_bf16 v[20:23], v[4:7], v[80:87], v74
  ds_read_b128 v[36:39], v76 offset:53248
  v_smfmac_f32_16x16x64_bf16 v[24:27], v[4:7], v[88:95], v74
  ds_read_b128 v[40:43], v76 offset:54272
  s_waitcnt lgkmcnt(4)
  v_smfmac_f32_16x16x64_bf16 v[28:31], v[4:7], v[192:199], v74
  buffer_store_dwordx4 v[16:19], v76, s[8:11], s68 offen sc1
  s_waitcnt vmcnt(3)
  v_smfmac_f32_16x16x64_bf16 v[32:35], v[4:7], v[200:207], v74
  s_barrier
  s_waitcnt lgkmcnt(2)
  v_smfmac_f32_16x16x64_bf16 v[32:35], v[0:3], v[60:67], v74
  buffer_load_dword v73, s[16:19], s70 offen lds
  ds_read_b128 v[8:11], v76 offset:8704
  v_smfmac_f32_16x16x64_bf16 v[20:23], v[12:15], v[112:119], v74
  ds_read_b128 v[60:63], v76 offset:55296
  ds_read_b128 v[64:67], v76 offset:56320
  v_smfmac_f32_16x16x64_bf16 v[24:27], v[12:15], v[120:127], v74
  ds_read_b128 v[4:7], v76 offset:9728
  v_smfmac_f32_16x16x64_bf16 v[28:31], v[12:15], v[224:231], v74
  v_smfmac_f32_16x16x64_bf16 v[32:35], v[12:15], v[232:239], v74
  s_waitcnt lgkmcnt(3)
  v_smfmac_f32_16x16x64_bf16 v[28:31], v[8:11], v[36:43], v74
  ds_read_b128 v[36:39], v75 offset:4096
  ds_read_b128 v[40:43], v75 offset:5120
  s_waitcnt lgkmcnt(3)
  v_smfmac_f32_16x16x64_bf16 v[32:35], v[8:11], v[60:67], v74
  s_barrier
  ds_read_b128 v[16:19], v76 offset:10752
  v_smfmac_f32_16x16x64_bf16 v[20:23], v[8:11], v[128:135], v74
  ds_read_b128 v[60:63], v75 offset:6144
  ds_read_b128 v[64:67], v75 offset:7168
  v_smfmac_f32_16x16x64_bf16 v[24:27], v[8:11], v[136:143], v74
  ds_read_b128 v[0:3], v76 offset:11776
  s_waitcnt lgkmcnt(6)
  v_smfmac_f32_16x16x64_bf16 v[20:23], v[4:7], v[144:151], v74
  ds_read_b128 v[12:15], v76 offset:12800
  v_smfmac_f32_16x16x64_bf16 v[24:27], v[4:7], v[152:159], v74
  s_waitcnt lgkmcnt(4)
  v_smfmac_f32_16x16x64_bf16 v[20:23], v[16:19], v[36:43], v74
  ds_read_b128 v[36:39], v75 offset:20480
  s_waitcnt lgkmcnt(3)
  v_smfmac_f32_16x16x64_bf16 v[24:27], v[16:19], v[60:67], v74
  ds_read_b128 v[40:43], v75 offset:21504
  s_waitcnt lgkmcnt(3)
  v_smfmac_f32_16x16x64_bf16 v[20:23], v[0:3], v[160:167], v74
  ds_read_b128 v[60:63], v75 offset:22528
  s_waitcnt lgkmcnt(3)
  v_smfmac_f32_16x16x64_bf16 v[20:23], v[12:15], v[176:183], v74
  ds_read_b128 v[64:67], v75 offset:23552
  v_smfmac_f32_16x16x64_bf16 v[24:27], v[0:3], v[168:175], v74
  v_mov_b64 v[70:71], s[78:79]
  v_smfmac_f32_16x16x64_bf16 v[24:27], v[12:15], v[184:191], v74
  s_waitcnt lgkmcnt(2)
  v_add_f32 v20, v20, v22
  v_smfmac_f32_16x16x64_bf16 v[28:31], v[4:7], v[36:43], v74
  ds_read_b128 v[36:39], v68
  s_waitcnt lgkmcnt(1)
  v_add_f32 v21, v21, v23
  v_smfmac_f32_16x16x64_bf16 v[32:35], v[4:7], v[60:67], v74
  ds_read_b128 v[40:43], v68
  v_add_f32 v24, v24, v26
  v_smfmac_f32_16x16x64_bf16 v[28:31], v[16:19], v[240:247], v74
  v_cvt_pk_bf16_f32 v22, v20, v24
  v_smfmac_f32_16x16x64_bf16 v[28:31], v[0:3], a[0:7], v74
  ds_write_b32 v79, v22 offset:0
  v_add_f32 v25, v25, v27
  v_cvt_pk_bf16_f32 v23, v21, v25
  v_smfmac_f32_16x16x64_bf16 v[28:31], v[12:15], a[16:23], v74
  ds_write_b32 v79, v23 offset:576
  v_cmp_u_f32 vcc, v20, v21
  v_smfmac_f32_16x16x64_bf16 v[32:35], v[16:19], v[248:255], v74
  v_mov_b64 v[68:69], s[78:79]
  v_smfmac_f32_16x16x64_bf16 v[32:35], v[0:3], a[8:15], v74
  v_add_f32 v28, v28, v30
  v_add_f32 v29, v29, v31
  v_smfmac_f32_16x16x64_bf16 v[32:35], v[12:15], a[24:31], v74
  s_cbranch_vccnz Cs1_rec
Cs1_recok:
  s_waitcnt lgkmcnt(3)
  v_smfmac_f32_16x16x64_bf16 v[36:39], v[16:19], a[128:135], v74
  s_waitcnt lgkmcnt(0)
  s_barrier
  ds_read_b128 v[60:63], v77
  v_smfmac_f32_16x16x64_bf16 v[40:43], v[16:19], a[136:143], v74
  ds_read_b128 v[64:67], v77 offset:128
  v_add_f32 v32, v32, v34
  v_cvt_pk_bf16_f32 v30, v28, v32
  v_smfmac_f32_16x16x64_bf16 v[36:39], v[0:3], a[144:151], v74
  ds_write_b32 v79, v30 offset:256
  v_add_f32 v33, v33, v35
  v_cvt_pk_bf16_f32 v31, v29, v33
  v_smfmac_f32_16x16x64_bf16 v[40:43], v[0:3], a[152:159], v74
  ds_write_b32 v79, v31 offset:832
  v_xor_b32 v75, 0x8000, v75
  v_smfmac_f32_16x16x64_bf16 v[36:39], v[4:7], a[112:119], v74
  ds_read_b128 v[0:3], v76 offset:4608
  v_mov_b32 v29, 0
  v_smfmac_f32_16x16x64_bf16 v[40:43], v[4:7], a[120:127], v74
  s_waitcnt vmcnt(2) lgkmcnt(3)
  v_mov_b32 v30, 0
  v_mfma_f32_16x16x32_bf16 v[44:47], v[44:47], v[60:63], 0
  ds_read_b128 v[4:7], v76 offset:5632
  s_waitcnt lgkmcnt(2)
  v_mfma_f32_16x16x32_bf16 v[44:47], v[48:51], v[64:67], v[44:47]
  s_barrier
  v_smfmac_f32_16x16x64_bf16 v[36:39], v[8:11], a[96:103], v74
  ds_read_b128 v[20:23], v77 offset:256
  ds_read_b128 v[24:27], v77 offset:384
  v_smfmac_f32_16x16x64_bf16 v[40:43], v[8:11], a[104:111], v74
  ds_read_b128 v[8:11], v76 offset:6656
  v_add_f32_dpp v72, v46, v44 quad_perm:[2,3,0,1] row_mask:0xf bank_mask:0xf
  v_add_f32_dpp v73, v47, v45 quad_perm:[2,3,0,1] row_mask:0xf bank_mask:0xf
  v_smfmac_f32_16x16x64_bf16 v[36:39], v[12:15], a[160:167], v74
  s_waitcnt lgkmcnt(4)
  v_exp_f32_dpp v72, v72 quad_perm:[0,1,0,1] row_mask:0xf bank_mask:0xf
  v_smfmac_f32_16x16x64_bf16 v[40:43], v[12:15], a[168:175], v74
  ds_read_b128 v[12:15], v76 offset:7680
  v_exp_f32_dpp v73, v73 quad_perm:[0,1,0,1] row_mask:0xf bank_mask:0xf
  v_smfmac_f32_16x16x64_bf16 v[36:39], v[0:3], a[32:39], v74
  s_waitcnt lgkmcnt(2)
  v_cvt_pk_bf16_f32 v72, v72, v73
  v_mfma_f32_16x16x32_bf16 v[20:23], v[20:23], v[60:63], 0
  ds_write_b32 v78, v72 offset:516
  v_mov_b64 v[16:17], 0
  v_mfma_f32_16x16x32_bf16 v[20:23], v[24:27], v[64:67], v[20:23]
  ds_read_b128 v[44:47], v75 offset:20480
  v_mov_b64 v[18:19], 0
  v_smfmac_f32_16x16x64_bf16 v[40:43], v[0:3], a[40:47], v74
  ds_read_b128 v[48:51], v75 offset:21504
  s_waitcnt lgkmcnt(4)
  v_smfmac_f32_16x16x64_bf16 v[36:39], v[4:7], a[48:55], v74
  v_add_f32_dpp v24, v22, v20 quad_perm:[2,3,0,1] row_mask:0xf bank_mask:0xf
  v_add_f32_dpp v25, v23, v21 quad_perm:[2,3,0,1] row_mask:0xf bank_mask:0xf
  v_smfmac_f32_16x16x64_bf16 v[36:39], v[8:11], a[64:71], v74
  s_waitcnt lgkmcnt(2)
  s_barrier
  ds_read_b128 v[32:35], v78 offset:512
  v_smfmac_f32_16x16x64_bf16 v[36:39], v[12:15], a[80:87], v74
  ds_read_b128 v[60:63], v75 offset:22528
  v_mul_f32 v24, s69, v24
  v_smfmac_f32_16x16x64_bf16 v[40:43], v[4:7], a[56:63], v74
  ds_read_b128 v[64:67], v75 offset:23552
  v_mul_f32 v25, s69, v25
  v_smfmac_f32_16x16x64_bf16 v[40:43], v[8:11], a[72:79], v74
  v_exp_f32_dpp v24, v24 quad_perm:[0,1,0,1] row_mask:0xf bank_mask:0xf
  v_smfmac_f32_16x16x64_bf16 v[40:43], v[12:15], a[88:95], v74
  s_waitcnt lgkmcnt(2)
  v_exp_f32_dpp v25, v25 quad_perm:[0,1,0,1] row_mask:0xf bank_mask:0xf
  v_mfma_f32_16x16x32_bf16 v[8:11], v[32:35], v[68:71], 0
  v_add_f32 v36, v36, v38
  v_add_f32 v37, v37, v39
  v_mfma_f32_16x16x32_bf16 v[0:3], v[32:35], v[52:55], 0
  v_add_f32 v40, v40, v42
  v_add_f32 v41, v41, v43
  v_mfma_f32_16x16x32_bf16 v[4:7], v[32:35], v[56:59], 0
  v_cvt_pk_bf16_f32 v28, v24, v25
  v_cvt_pk_bf16_f32 v72, v36, v37
  v_cvt_pk_bf16_f32 v73, v40, v41
  v_mfma_f32_16x16x16_bf16 v[8:11], v[28:29], v[68:69], v[8:11]
  v_cvt_pk_bf16_f32 v31, v24, v25
  v_mov_b64 v[20:21], 0
  v_mfma_f32_16x16x16_bf16 v[0:3], v[28:29], v[72:73], v[0:3]
  ds_read_b128 v[68:71], v76 offset:13824
  v_mov_b64 v[22:23], 0
  v_mfma_f32_16x16x16_bf16 v[4:7], v[30:31], v[72:73], v[4:7]
  v_rcp_f32 v10, v8
  v_rcp_f32 v11, v9
  v_mul_f32 v0, v10, v0
  v_mul_f32 v1, v11, v1
  s_nop 0
  v_mul_f32 v4, v10, v4
  v_mul_f32 v5, v11, v5
  v_cvt_pk_bf16_f32 v2, v0, v4
  ds_write_b32 v79, v2 offset:8704
  v_cvt_pk_bf16_f32 v3, v1, v5
  ds_write_b32 v79, v3 offset:9280
  v_max3_f32 v8, v8, v9, v10
  v_max_f32 v8, v8, v11
  v_cmp_le_f32 vcc, 1317011456, v8
  v_mov_b64 v[24:25], 0
  v_mov_b64 v[26:27], 0
  s_cbranch_vccnz Cs1_mx
Cs1_mxok:
  s_waitcnt lgkmcnt(0)
  s_barrier
  ds_read_b128 v[0:3], v78 offset:8704
  ds_read_b128 v[4:7], v78 offset:8768
  ds_read_b128 v[8:11], v78 offset:8832
  ds_read_b128 v[12:15], v78 offset:8896
  s_waitcnt lgkmcnt(3)
  v_smfmac_f32_16x16x64_bf16 v[16:19], v[0:3], v[44:51], v74
  ds_read_b128 v[52:55], v75 offset:36864
  s_waitcnt lgkmcnt(3)
  v_smfmac_f32_16x16x64_bf16 v[16:19], v[4:7], v[60:67], v74
  ds_read_b128 v[56:59], v75 offset:37888
  s_waitcnt lgkmcnt(3)
  v_smfmac_f32_16x16x64_bf16 v[16:19], v[8:11], a[176:183], v74
  ds_read_b128 v[36:39], v75 offset:38912
  s_waitcnt lgkmcnt(3)
  v_smfmac_f32_16x16x64_bf16 v[16:19], v[12:15], a[184:191], v74
  ds_read_b128 v[40:43], v75 offset:39936
  ds_read_b128 v[44:47], v75 offset:53248
  v_smfmac_f32_16x16x64_bf16 v[20:23], v[0:3], a[192:199], v74
  ds_read_b128 v[48:51], v75 offset:54272
  ds_read_b128 v[60:63], v75 offset:55296
  v_smfmac_f32_16x16x64_bf16 v[20:23], v[4:7], a[200:207], v74
  ds_read_b128 v[64:67], v75 offset:56320
  s_waitcnt lgkmcnt(6)
  v_cvt_pk_bf16_f32 v16, v16, v17
  v_cvt_pk_bf16_f32 v17, v18, v19
  v_bfi_b32 v16, 1, s72, v16
  v_smfmac_f32_16x16x64_bf16 v[20:23], v[8:11], v[52:59], v74
  buffer_store_dwordx2 v[16:17], v68, s[8:11], s73 offen sc1
  s_waitcnt lgkmcnt(4)
  v_smfmac_f32_16x16x64_bf16 v[20:23], v[12:15], v[36:43], v74
  v_mov_b64 v[32:33], 0
  v_smfmac_f32_16x16x64_bf16 v[24:27], v[0:3], a[208:215], v74
  v_mov_b64 v[34:35], 0
  v_smfmac_f32_16x16x64_bf16 v[24:27], v[4:7], a[216:223], v74
  s_waitcnt lgkmcnt(2)
  v_cvt_pk_bf16_f32 v20, v20, v21
  v_cvt_pk_bf16_f32 v21, v22, v23
  v_bfi_b32 v20, 1, s72, v20
  v_smfmac_f32_16x16x64_bf16 v[24:27], v[8:11], v[44:51], v74
  buffer_store_dwordx2 v[20:21], v68, s[8:11], s74 offen sc1
  s_waitcnt lgkmcnt(0)
  v_smfmac_f32_16x16x64_bf16 v[24:27], v[12:15], v[60:67], v74
  v_smfmac_f32_16x16x64_bf16 v[32:35], v[0:3], a[224:231], v74
  v_smfmac_f32_16x16x64_bf16 v[32:35], v[4:7], a[232:239], v74
  v_cvt_pk_bf16_f32 v24, v24, v25
  v_cvt_pk_bf16_f32 v25, v26, v27
  v_bfi_b32 v24, 1, s72, v24
  v_smfmac_f32_16x16x64_bf16 v[32:35], v[8:11], a[240:247], v74
  s_nop 1
  buffer_store_dwordx2 v[24:25], v68, s[8:11], s75 offen sc1
  v_smfmac_f32_16x16x64_bf16 v[32:35], v[12:15], a[248:255], v74
  ds_read_b128 v[0:3], v76 offset:14848
  ds_read_b64 v[16:17], v77 offset:264
  v_mov_b64 v[18:19], v[72:73]
  v_xor_b32 v75, 0x8000, v75
  s_nop 3
  v_cvt_pk_bf16_f32 v32, v32, v33
  v_cvt_pk_bf16_f32 v33, v34, v35
  v_bfi_b32 v32, 1, s72, v32
  buffer_store_dwordx2 v[32:33], v68, s[8:11], s76 offen sc1
  v_mov_b64 v[20:21], 0
  v_mov_b64 v[22:23], 0
  v_mov_b64 v[24:25], 0
  v_mov_b64 v[26:27], 0
  v_mov_b64 v[28:29], 0
  v_mov_b64 v[30:31], 0
  v_mov_b64 v[32:33], 0
  v_mov_b64 v[34:35], 0
  v_mov_b32 v68, 14880
  s_add_u32 s58, s58, 655360
  s_add_u32 s59, s59, 655360
  s_add_u32 s70, s70, 655360
  s_add_u32 s68, s68, 655360
  s_add_u32 s66, s66, 1
  s_xor_b32 s64, s64, 16384
  s_xor_b32 s65, s65, 16384
  s_cmp_eq_u32 s66, 62
  s_cselect_b64 s[16:17], s[20:21], s[16:17]
  s_cselect_b32 s18, (Cs1_done - Cs1_last), s18
  s_cselect_b32 s70, 0, s70
  s_cmp_eq_u32 s66, 63
  s_cselect_b32 s59, 268435456, s59
  s_nop 15
  s_nop 15
  s_nop 1
  buffer_load_dwordx4 v[52:55], v76, s[8:11], s60 offen offset:0 sc1
  buffer_load_dwordx4 v[56:59], v76, s[8:11], s60 offen offset:1024 sc1
  s_nop 15
  s_nop 11
  buffer_load_dwordx4 v[36:39], v76, s[8:11], s60 offen offset:0 sc1
  buffer_load_dwordx4 v[40:43], v76, s[8:11], s60 offen offset:1024 sc1
  s_waitcnt lgkmcnt(0)
  s_waitcnt vmcnt(3)
  v_mfma_f32_16x16x32_bf16 v[4:7], v[0:3], v[52:55], 0
  v_bitop3_b32 v72, v52, v54, s72 bitop3:0x7e
  s_waitcnt vmcnt(2)
  v_mfma_f32_16x16x32_bf16 v[4:7], v[0:3], v[56:59], v[4:7]
  v_bitop3_b32 v73, v56, v58, s72 bitop3:0x7e
  v_bitop3_b32 v72, v72, v73, 1 bitop3:0xa8
  v_cmp_ne_u32 vcc, 0, v72
  s_cbranch_vccnz Cs1_h1r
  s_nop 2
  v_add_f32_dpp v4, v4, v4 row_ror:4 row_mask:0xf bank_mask:0xf
  v_add_f32_dpp v5, v5, v5 row_ror:4 row_mask:0xf bank_mask:0xf
  s_nop 0
  v_add_f32_dpp v4, v4, v4 row_ror:8 row_mask:0xf bank_mask:0xf
  v_add_f32_dpp v5, v5, v5 row_ror:8 row_mask:0xf bank_mask:0xf
  v_cvt_pk_bf16_f32 v4, v4, v5
  buffer_store_dword v4, v69, s[8:11], s62 offen sc1
  s_xor_b32 s62, s62, 16384
  buffer_store_dword v71, v69, s[8:11], s62 offen sc1
  s_xor_b32 s72, s72, 1
  s_branch Cs1_h2
Cs1_h1r:
  s_mov_b64 exec, vcc
  buffer_load_dwordx4 v[52:55], v76, s[8:11], s60 offen offset:0 sc1
  buffer_load_dwordx4 v[56:59], v76, s[8:11], s60 offen offset:1024 sc1
  s_mov_b64 exec, -1
  s_add_u32 s67, s67, 1
  s_waitcnt vmcnt(3)
  v_mfma_f32_16x16x32_bf16 v[4:7], v[0:3], v[36:39], 0
  v_bitop3_b32 v72, v36, v38, s72 bitop3:0x7e
  s_waitcnt vmcnt(2)
  v_mfma_f32_16x16x32_bf16 v[4:7], v[0:3], v[40:43], v[4:7]
  v_bitop3_b32 v73, v40, v42, s72 bitop3:0x7e
  v_bitop3_b32 v72, v72, v73, 1 bitop3:0xa8
  v_cmp_ne_u32 vcc, 0, v72
  s_cbranch_vccz Cs1_h1p
  s_mov_b64 exec, vcc
  buffer_load_dwordx4 v[36:39], v76, s[8:11], s60 offen offset:0 sc1
  buffer_load_dwordx4 v[40:43], v76, s[8:11], s60 offen offset:1024 sc1
  s_mov_b64 exec, -1
  s_add_u32 s67, s67, 1
  s_waitcnt vmcnt(3)
  v_mfma_f32_16x16x32_bf16 v[4:7], v[0:3], v[52:55], 0
  v_bitop3_b32 v72, v52, v54, s72 bitop3:0x7e
  s_waitcnt vmcnt(2)
  v_mfma_f32_16x16x32_bf16 v[4:7], v[0:3], v[56:59], v[4:7]
  v_bitop3_b32 v73, v56, v58, s72 bitop3:0x7e
  v_bitop3_b32 v72, v72, v73, 1 bitop3:0xa8
  v_cmp_ne_u32 vcc, 0, v72
  s_cbranch_vccz Cs1_h1p
Cs1_h1s:
  s_mov_b64 exec, vcc
  buffer_load_dwordx4 v[52:55], v76, s[8:11], s60 offen offset:0 sc1
  buffer_load_dwordx4 v[56:59], v76, s[8:11], s60 offen offset:1024 sc1
  s_mov_b64 exec, -1
  s_add_u32 s67, s67, 1
  s_waitcnt vmcnt(3)
  v_mfma_f32_16x16x32_bf16 v[4:7], v[0:3], v[36:39], 0
  v_bitop3_b32 v72, v36, v38, s72 bitop3:0x7e
  s_waitcnt vmcnt(2)
  v_mfma_f32_16x16x32_bf16 v[4:7], v[0:3], v[40:43], v[4:7]
  v_bitop3_b32 v73, v40, v42, s72 bitop3:0x7e
  v_bitop3_b32 v72, v72, v73, 1 bitop3:0xa8
  v_cmp_ne_u32 vcc, 0, v72
  s_cbranch_vccz Cs1_h1p
  s_mov_b64 exec, vcc
  buffer_load_dwordx4 v[36:39], v76, s[8:11], s60 offen offset:0 sc1
  buffer_load_dwordx4 v[40:43], v76, s[8:11], s60 offen offset:1024 sc1
  s_mov_b64 exec, -1
  s_add_u32 s67, s67, 1
  s_waitcnt vmcnt(3)
  v_mfma_f32_16x16x32_bf16 v[4:7], v[0:3], v[52:55], 0
  v_bitop3_b32 v72, v52, v54, s72 bitop3:0x7e
  s_waitcnt vmcnt(2)
  v_mfma_f32_16x16x32_bf16 v[4:7], v[0:3], v[56:59], v[4:7]
  v_bitop3_b32 v73, v56, v58, s72 bitop3:0x7e
  v_bitop3_b32 v72, v72, v73, 1 bitop3:0xa8
  v_cmp_ne_u32 vcc, 0, v72
  s_cbranch_vccz Cs1_h1p
  s_cmp_lt_u32 s67, 131072
  s_cbranch_scc1 Cs1_h1s
Cs1_h1p:
  s_nop 2
  v_add_f32_dpp v4, v4, v4 row_ror:4 row_mask:0xf bank_mask:0xf
  v_add_f32_dpp v5, v5, v5 row_ror:4 row_mask:0xf bank_mask:0xf
  s_nop 0
  v_add_f32_dpp v4, v4, v4 row_ror:8 row_mask:0xf bank_mask:0xf
  v_add_f32_dpp v5, v5, v5 row_ror:8 row_mask:0xf bank_mask:0xf
  v_cvt_pk_bf16_f32 v4, v4, v5
  buffer_store_dword v4, v69, s[8:11], s62 offen sc1
  s_xor_b32 s62, s62, 16384
  buffer_store_dword v71, v69, s[8:11], s62 offen sc1
  s_xor_b32 s72, s72, 1
  s_branch Cs1_h2
Cs1_h2r:
  s_mov_b64 exec, vcc
  buffer_load_dwordx4 v[8:11], v76, s[8:11], s65 offen offset:2048 sc1
  s_mov_b64 exec, -1
  s_add_u32 s67, s67, 1
  s_waitcnt vmcnt(4)
  v_max3_u32 v72, v8, v9, v10
  v_max_u32 v72, v72, v11
  ds_write_b128 v76, v[8:11] offset:6656
  v_cmp_eq_u32 vcc, -1, v72
  s_cbranch_vccz Cs1_h2w
  s_mov_b64 exec, vcc
  buffer_load_dwordx4 v[8:11], v76, s[8:11], s65 offen offset:2048 sc1
  s_mov_b64 exec, -1
  s_add_u32 s67, s67, 1
  s_waitcnt vmcnt(4)
  v_max3_u32 v72, v8, v9, v10
  v_max_u32 v72, v72, v11
  ds_write_b128 v76, v[8:11] offset:6656
  v_cmp_eq_u32 vcc, -1, v72
  s_cbranch_vccz Cs1_h2w
Cs1_h2s:
  s_mov_b64 exec, vcc
  buffer_load_dwordx4 v[8:11], v76, s[8:11], s65 offen offset:2048 sc1
  s_mov_b64 exec, -1
  s_add_u32 s67, s67, 1
  s_waitcnt vmcnt(2)
  v_max3_u32 v72, v8, v9, v10
  v_max_u32 v72, v72, v11
  ds_write_b128 v76, v[8:11] offset:6656
  v_cmp_eq_u32 vcc, -1, v72
  s_cbranch_vccz Cs1_h2w
  s_mov_b64 exec, vcc
  buffer_load_dwordx4 v[8:11], v76, s[8:11], s65 offen offset:2048 sc1
  s_mov_b64 exec, -1
  s_add_u32 s67, s67, 1
  s_waitcnt vmcnt(2)
  v_max3_u32 v72, v8, v9, v10
  v_max_u32 v72, v72, v11
  ds_write_b128 v76, v[8:11] offset:6656
  v_cmp_eq_u32 vcc, -1, v72
  s_cbranch_vccz Cs1_h2w
  s_mov_b64 exec, vcc
  buffer_load_dwordx4 v[8:11], v76, s[8:11], s65 offen offset:2048 sc1
  s_mov_b64 exec, -1
  s_add_u32 s67, s67, 1
  s_waitcnt vmcnt(2)
  v_max3_u32 v72, v8, v9, v10
  v_max_u32 v72, v72, v11
  ds_write_b128 v76, v[8:11] offset:6656
  v_cmp_eq_u32 vcc, -1, v72
  s_cbranch_vccz Cs1_h2w
  s_cmp_lt_u32 s67, 131072
  s_cbranch_scc1 Cs1_h2s
  s_branch Cs1_h2w
Cs1_rec:
  s_nop 7
  s_waitcnt vmcnt(0) lgkmcnt(0)
  v_max3_u32 v72, v0, v1, v2
  v_max3_u32 v72, v72, v3, v4
  v_max3_u32 v72, v72, v5, v6
  v_max3_u32 v72, v72, v7, v8
  v_max3_u32 v72, v72, v9, v10
  v_max3_u32 v72, v72, v11, v12
  v_max3_u32 v72, v72, v13, v14
  v_max3_u32 v72, v72, v15, v16
  v_max3_u32 v72, v72, v17, v18
  v_max_u32 v72, v72, v19
  v_cmp_eq_u32 vcc, -1, v72
  s_cbranch_vccz Cs1_recok
  s_barrier
  v_mov_b64 v[20:21], 0
  v_mov_b64 v[22:23], 0
  v_mov_b64 v[24:25], 0
  v_mov_b64 v[26:27], 0
  v_mov_b64 v[28:29], 0
  v_mov_b64 v[30:31], 0
  v_mov_b64 v[32:33], 0
  v_mov_b64 v[34:35], 0
  s_waitcnt lgkmcnt(0)
  s_barrier
  ds_read_b128 v[0:3], v76 offset:4608
  ds_read_b128 v[60:63], v76 offset:20480
  ds_read_b128 v[64:67], v76 offset:21504
  s_waitcnt lgkmcnt(0)
  v_smfmac_f32_16x16x64_bf16 v[20:23], v[0:3], v[60:67], v74
  ds_read_b128 v[60:63], v76 offset:22528
  ds_read_b128 v[64:67], v76 offset:23552
  s_waitcnt lgkmcnt(0)
  v_smfmac_f32_16x16x64_bf16 v[24:27], v[0:3], v[60:67], v74
  ds_read_b128 v[60:63], v76 offset:36864
  ds_read_b128 v[64:67], v76 offset:37888
  s_waitcnt lgkmcnt(0)
  v_smfmac_f32_16x16x64_bf16 v[28:31], v[0:3], v[60:67], v74
  ds_read_b128 v[60:63], v76 offset:38912
  ds_read_b128 v[64:67], v76 offset:39936
  s_waitcnt lgkmcnt(0)
  v_smfmac_f32_16x16x64_bf16 v[32:35], v[0:3], v[60:67], v74
  ds_read_b128 v[4:7], v76 offset:5632
  s_waitcnt lgkmcnt(0)
  v_smfmac_f32_16x16x64_bf16 v[20:23], v[4:7], v[80:87], v74
  v_smfmac_f32_16x16x64_bf16 v[24:27], v[4:7], v[88:95], v74
  v_smfmac_f32_16x16x64_bf16 v[28:31], v[4:7], v[192:199], v74
  v_smfmac_f32_16x16x64_bf16 v[32:35], v[4:7], v[200:207], v74
  ds_read_b128 v[8:11], v76 offset:6656
  s_waitcnt lgkmcnt(0)
  v_smfmac_f32_16x16x64_bf16 v[20:23], v[8:11], v[96:103], v74
  v_smfmac_f32_16x16x64_bf16 v[24:27], v[8:11], v[104:111], v74
  v_smfmac_f32_16x16x64_bf16 v[28:31], v[8:11], v[208:215], v74
  v_smfmac_f32_16x16x64_bf16 v[32:35], v[8:11], v[216:223], v74
  ds_read_b128 v[12:15], v76 offset:7680
  s_waitcnt lgkmcnt(0)
  v_smfmac_f32_16x16x64_bf16 v[20:23], v[12:15], v[112:119], v74
  v_smfmac_f32_16x16x64_bf16 v[24:27], v[12:15], v[120:127], v74
  v_smfmac_f32_16x16x64_bf16 v[28:31], v[12:15], v[224:231], v74
  v_smfmac_f32_16x16x64_bf16 v[32:35], v[12:15], v[232:239], v74
  ds_read_b128 v[8:11], v76 offset:8704
  s_waitcnt lgkmcnt(0)
  v_smfmac_f32_16x16x64_bf16 v[20:23], v[8:11], v[128:135], v74
  v_smfmac_f32_16x16x64_bf16 v[24:27], v[8:11], v[136:143], v74
  ds_read_b128 v[60:63], v76 offset:53248
  ds_read_b128 v[64:67], v76 offset:54272
  s_waitcnt lgkmcnt(0)
  v_smfmac_f32_16x16x64_bf16 v[28:31], v[8:11], v[60:67], v74
  ds_read_b128 v[60:63], v76 offset:55296
  ds_read_b128 v[64:67], v76 offset:56320
  s_waitcnt lgkmcnt(0)
  v_smfmac_f32_16x16x64_bf16 v[32:35], v[8:11], v[60:67], v74
  ds_read_b128 v[4:7], v76 offset:9728
  s_waitcnt lgkmcnt(0)
  v_smfmac_f32_16x16x64_bf16 v[20:23], v[4:7], v[144:151], v74
  v_smfmac_f32_16x16x64_bf16 v[24:27], v[4:7], v[152:159], v74
  ds_read_b128 v[60:63], v75 offset:20480
  ds_read_b128 v[64:67], v75 offset:21504
  s_waitcnt lgkmcnt(0)
  v_smfmac_f32_16x16x64_bf16 v[28:31], v[4:7], v[60:67], v74
  ds_read_b128 v[60:63], v75 offset:22528
  ds_read_b128 v[64:67], v75 offset:23552
  s_waitcnt lgkmcnt(0)
  v_smfmac_f32_16x16x64_bf16 v[32:35], v[4:7], v[60:67], v74
  ds_read_b128 v[16:19], v76 offset:10752
  ds_read_b128 v[60:63], v75 offset:4096
  ds_read_b128 v[64:67], v75 offset:5120
  s_waitcnt lgkmcnt(0)
  v_smfmac_f32_16x16x64_bf16 v[20:23], v[16:19], v[60:67], v74
  ds_read_b128 v[60:63], v75 offset:6144
  ds_read_b128 v[64:67], v75 offset:7168
  s_waitcnt lgkmcnt(0)
  v_smfmac_f32_16x16x64_bf16 v[24:27], v[16:19], v[60:67], v74
  v_smfmac_f32_16x16x64_bf16 v[28:31], v[16:19], v[240:247], v74
  v_smfmac_f32_16x16x64_bf16 v[32:35], v[16:19], v[248:255], v74
  ds_read_b128 v[0:3], v76 offset:11776
  s_waitcnt lgkmcnt(0)
  v_smfmac_f32_16x16x64_bf16 v[20:23], v[0:3], v[160:167], v74
  v_smfmac_f32_16x16x64_bf16 v[24:27], v[0:3], v[168:175], v74
  v_smfmac_f32_16x16x64_bf16 v[28:31], v[0:3], a[0:7], v74
  v_smfmac_f32_16x16x64_bf16 v[32:35], v[0:3], a[8:15], v74
  ds_read_b128 v[12:15], v76 offset:12800
  s_waitcnt lgkmcnt(0)
  v_smfmac_f32_16x16x64_bf16 v[20:23], v[12:15], v[176:183], v74
  v_smfmac_f32_16x16x64_bf16 v[24:27], v[12:15], v[184:191], v74
  v_smfmac_f32_16x16x64_bf16 v[28:31], v[12:15], a[16:23], v74
  v_smfmac_f32_16x16x64_bf16 v[32:35], v[12:15], a[24:31], v74
  v_add_f32 v20, v20, v22
  v_add_f32 v21, v21, v23
  v_add_f32 v24, v24, v26
  v_cvt_pk_bf16_f32 v22, v20, v24
  s_nop 0
  ds_write_b32 v79, v22 offset:0
  v_add_f32 v25, v25, v27
  v_cvt_pk_bf16_f32 v23, v21, v25
  ds_write_b32 v79, v23 offset:576
  v_add_f32 v28, v28, v30
  v_add_f32 v29, v29, v31
  s_waitcnt lgkmcnt(0)
  s_nop 1
  s_branch Cs1_recok
Cs1_mx:
  s_waitcnt lgkmcnt(0)
  s_barrier
  buffer_load_dwordx4 v[0:3], v76, s[8:11], s58 offen offset:0 sc1
  ds_read_b128 v[20:23], v77 offset:0
  ds_read_b128 v[28:31], v77 offset:256
  buffer_load_dwordx4 v[4:7], v76, s[8:11], s58 offen offset:1024 sc1
  ds_read_b128 v[24:27], v77 offset:128
  ds_read_b128 v[32:35], v77 offset:384
  s_waitcnt vmcnt(1) lgkmcnt(3)
  v_mfma_f32_16x16x32_bf16 v[8:11], v[0:3], v[20:23], 0
  s_waitcnt vmcnt(0) lgkmcnt(1)
  v_mfma_f32_16x16x32_bf16 v[8:11], v[4:7], v[24:27], v[8:11]
  v_mfma_f32_16x16x32_bf16 v[12:15], v[28:31], v[20:23], 0
  s_waitcnt lgkmcnt(0)
  v_mfma_f32_16x16x32_bf16 v[12:15], v[32:35], v[24:27], v[12:15]
  v_add_f32_dpp v8, v10, v8 quad_perm:[2,3,0,1] row_mask:0xf bank_mask:0xf
  v_add_f32_dpp v9, v11, v9 quad_perm:[2,3,0,1] row_mask:0xf bank_mask:0xf
  s_nop 0
  v_mov_b32_dpp v8, v8 quad_perm:[0,1,0,1] row_mask:0xf bank_mask:0xf
  v_mov_b32_dpp v9, v9 quad_perm:[0,1,0,1] row_mask:0xf bank_mask:0xf
  s_nop 1
  v_add_f32_dpp v12, v14, v12 quad_perm:[2,3,0,1] row_mask:0xf bank_mask:0xf
  v_add_f32_dpp v13, v15, v13 quad_perm:[2,3,0,1] row_mask:0xf bank_mask:0xf
  s_nop 0
  v_mov_b32_dpp v12, v12 quad_perm:[0,1,0,1] row_mask:0xf bank_mask:0xf
  v_mov_b32_dpp v13, v13 quad_perm:[0,1,0,1] row_mask:0xf bank_mask:0xf
  v_mul_f32 v12, s69, v12
  ds_write_b32 v78, v8 offset:8708
  v_mul_f32 v13, s69, v13
  ds_write_b32 v78, v9 offset:8772
  s_waitcnt lgkmcnt(0)
  s_barrier
  ds_read_b128 v[36:39], v78 offset:8704
  ds_read_b128 v[40:43], v78 offset:8768
  s_waitcnt lgkmcnt(0)
  s_barrier
  v_max_f32 v16, v36, v37
  v_max3_f32 v16, v16, v38, v39
  v_max3_f32 v16, v16, v40, v41
  v_max3_f32 v16, v16, v42, v43
  v_max3_f32 v16, v16, v12, v13
  v_mov_b32 v17, v16
  s_nop 1
  v_permlane16_swap_b32 v16, v17
  v_max_f32 v16, v16, v17
  v_mov_b32 v17, v16
  s_nop 1
  v_permlane32_swap_b32 v16, v17
  v_max_f32 v16, v16, v17
  v_sub_f32 v36, v36, v16
  v_sub_f32 v37, v37, v16
  v_sub_f32 v38, v38, v16
  v_sub_f32 v39, v39, v16
  v_sub_f32 v40, v40, v16
  v_sub_f32 v41, v41, v16
  v_sub_f32 v42, v42, v16
  v_sub_f32 v43, v43, v16
  v_sub_f32 v12, v12, v16
  v_sub_f32 v13, v13, v16
  v_exp_f32 v36, v36
  v_exp_f32 v37, v37
  v_exp_f32 v38, v38
  v_exp_f32 v39, v39
  v_exp_f32 v40, v40
  v_exp_f32 v41, v41
  v_exp_f32 v42, v42
  v_exp_f32 v43, v43
  v_exp_f32 v12, v12
  v_exp_f32 v13, v13
  v_cvt_pk_bf16_f32 v32, v36, v40
  v_cvt_pk_bf16_f32 v33, v37, v41
  v_cvt_pk_bf16_f32 v34, v38, v42
  v_cvt_pk_bf16_f32 v35, v39, v43
  v_cvt_pk_bf16_f32 v28, v12, v13
  v_cvt_pk_bf16_f32 v31, v12, v13
  v_mov_b32 v29, 0
  v_mov_b32 v30, 0
  v_mov_b32 v68, 0x3f803f80
  v_mov_b32 v69, 0x3f803f80
  v_mov_b32 v70, 0x3f803f80
  v_mov_b32 v71, 0x3f803f80
  s_nop 1
  v_mfma_f32_16x16x32_bf16 v[8:11], v[32:35], v[68:71], 0
  v_mfma_f32_16x16x32_bf16 v[0:3], v[32:35], v[52:55], 0
  v_mfma_f32_16x16x32_bf16 v[4:7], v[32:35], v[56:59], 0
  v_mfma_f32_16x16x16_bf16 v[8:11], v[28:29], v[68:69], v[8:11]
  v_mfma_f32_16x16x16_bf16 v[0:3], v[28:29], v[72:73], v[0:3]
  v_mfma_f32_16x16x16_bf16 v[4:7], v[30:31], v[72:73], v[4:7]
  ds_read_b128 v[68:71], v76 offset:13824
  v_rcp_f32 v10, v8
  v_rcp_f32 v11, v9
  v_mul_f32 v0, v10, v0
  v_mul_f32 v1, v11, v1
  s_nop 0
  v_mul_f32 v4, v10, v4
  v_mul_f32 v5, v11, v5
  v_cvt_pk_bf16_f32 v2, v0, v4
  ds_write_b32 v79, v2 offset:8704
  v_cvt_pk_bf16_f32 v3, v1, v5
  ds_write_b32 v79, v3 offset:9280
  v_mov_b64 v[16:17], 0
  v_mov_b64 v[18:19], 0
  v_mov_b64 v[20:21], 0
  v_mov_b64 v[22:23], 0
  v_mov_b64 v[24:25], 0
  v_mov_b64 v[26:27], 0
  s_branch Cs1_mxok
Cs1_last:
  ds_read_b128 v[4:7], v76 offset:5632
  ds_read_b128 v[12:15], v76 offset:7680
  ds_read_b128 v[60:63], v76 offset:38912
  ds_read_b128 v[64:67], v76 offset:39936
  ds_read_b128 v[44:47], v76 offset:53248
  ds_read_b128 v[48:51], v76 offset:54272
  s_nop 3
  v_mov_b64 v[20:21], 0
  v_mov_b64 v[22:23], 0
  v_mov_b64 v[24:25], 0
  v_mov_b64 v[26:27], 0
  s_waitcnt lgkmcnt(6)
  v_smfmac_f32_16x16x64_bf16 v[28:31], v[0:3], v[36:43], v74
  v_smfmac_f32_16x16x64_bf16 v[20:23], v[0:3], a[32:39], v74
  ds_read_b128 v[36:39], v76 offset:55296
  ds_read_b128 v[40:43], v76 offset:56320
  v_smfmac_f32_16x16x64_bf16 v[24:27], v[0:3], a[40:47], v74
  s_waitcnt lgkmcnt(7)
  v_smfmac_f32_16x16x64_bf16 v[20:23], v[4:7], a[48:55], v74
  buffer_store_dwordx4 v[16:19], v76, s[8:11], s68 offen sc1
  s_waitcnt lgkmcnt(4)
  v_smfmac_f32_16x16x64_bf16 v[24:27], v[4:7], a[56:63], v74
  v_smfmac_f32_16x16x64_bf16 v[28:31], v[4:7], v[192:199], v74
  v_smfmac_f32_16x16x64_bf16 v[32:35], v[4:7], v[200:207], v74
  v_smfmac_f32_16x16x64_bf16 v[32:35], v[0:3], v[60:67], v74
  v_smfmac_f32_16x16x64_bf16 v[20:23], v[8:11], a[64:71], v74
  ds_read_b128 v[60:63], v75 offset:20480
  ds_read_b128 v[64:67], v75 offset:21504
  v_smfmac_f32_16x16x64_bf16 v[24:27], v[8:11], a[72:79], v74
  v_smfmac_f32_16x16x64_bf16 v[28:31], v[8:11], v[208:215], v74
  v_smfmac_f32_16x16x64_bf16 v[20:23], v[12:15], a[80:87], v74
  v_smfmac_f32_16x16x64_bf16 v[24:27], v[12:15], a[88:95], v74
  v_smfmac_f32_16x16x64_bf16 v[28:31], v[12:15], v[224:231], v74
  v_smfmac_f32_16x16x64_bf16 v[32:35], v[12:15], v[232:239], v74
  v_smfmac_f32_16x16x64_bf16 v[32:35], v[8:11], v[216:223], v74
  s_waitcnt vmcnt(1)
  s_barrier
Cs1_lastr:
  ds_read_b128 v[8:11], v76 offset:8704
  ds_read_b128 v[4:7], v76 offset:9728
  ds_read_b128 v[16:19], v76 offset:10752
  ds_read_b128 v[0:3], v76 offset:11776
  ds_read_b128 v[12:15], v76 offset:12800
  s_waitcnt lgkmcnt(1)
  v_max3_u32 v72, v0, v1, v2
  v_max3_u32 v72, v72, v3, v4
  v_max3_u32 v72, v72, v5, v6
  v_max3_u32 v72, v72, v7, v8
  v_max3_u32 v72, v72, v9, v10
  s_waitcnt lgkmcnt(0)
  v_max3_u32 v72, v72, v11, v12
  v_max3_u32 v72, v72, v13, v14
  v_max3_u32 v72, v72, v15, v16
  v_max3_u32 v72, v72, v17, v18
  v_max_u32 v72, v72, v19
  v_cmp_eq_u32 vcc, -1, v72
  s_cbranch_vccnz Cs1_lastp
Cs1_lastg:
  v_smfmac_f32_16x16x64_bf16 v[28:31], v[8:11], v[44:51], v74
  ds_read_b128 v[44:47], v75 offset:22528
  ds_read_b128 v[48:51], v75 offset:23552
  v_smfmac_f32_16x16x64_bf16 v[32:35], v[8:11], v[36:43], v74
  v_smfmac_f32_16x16x64_bf16 v[28:31], v[4:7], v[60:67], v74
  v_smfmac_f32_16x16x64_bf16 v[28:31], v[16:19], v[240:247], v74
  v_smfmac_f32_16x16x64_bf16 v[28:31], v[0:3], a[0:7], v74
  v_smfmac_f32_16x16x64_bf16 v[28:31], v[12:15], a[16:23], v74
  v_smfmac_f32_16x16x64_bf16 v[32:35], v[16:19], v[248:255], v74
  v_smfmac_f32_16x16x64_bf16 v[32:35], v[0:3], a[8:15], v74
  s_waitcnt lgkmcnt(0)
  v_smfmac_f32_16x16x64_bf16 v[32:35], v[12:15], a[24:31], v74
  v_smfmac_f32_16x16x64_bf16 v[32:35], v[4:7], v[44:51], v74
  v_smfmac_f32_16x16x64_bf16 v[20:23], v[8:11], a[96:103], v74
  v_smfmac_f32_16x16x64_bf16 v[20:23], v[4:7], a[112:119], v74
  v_add_f32 v28, v28, v30
  v_add_f32 v32, v32, v34
  v_cvt_pk_bf16_f32 v30, v28, v32
  v_smfmac_f32_16x16x64_bf16 v[20:23], v[16:19], a[128:135], v74
  ds_write_b32 v79, v30 offset:256
  v_add_f32 v29, v29, v31
  v_add_f32 v33, v33, v35
  v_cvt_pk_bf16_f32 v31, v29, v33
  v_smfmac_f32_16x16x64_bf16 v[20:23], v[0:3], a[144:151], v74
  ds_write_b32 v79, v31 offset:832
  v_smfmac_f32_16x16x64_bf16 v[20:23], v[12:15], a[160:167], v74
  v_smfmac_f32_16x16x64_bf16 v[24:27], v[8:11], a[104:111], v74
  v_smfmac_f32_16x16x64_bf16 v[24:27], v[4:7], a[120:127], v74
  v_smfmac_f32_16x16x64_bf16 v[24:27], v[16:19], a[136:143], v74
  s_waitcnt lgkmcnt(0)
  s_barrier
  ds_read_b64 v[52:53], v77 offset:264
  v_add_f32 v20, v20, v22
  v_smfmac_f32_16x16x64_bf16 v[24:27], v[0:3], a[152:159], v74
  v_add_f32 v21, v21, v23
  v_smfmac_f32_16x16x64_bf16 v[24:27], v[12:15], a[168:175], v74
  v_cvt_pk_bf16_f32 v54, v20, v21
  s_add_u32 s68, s68, 655360
  s_nop 3
  v_add_f32 v24, v24, v26
  v_add_f32 v25, v25, v27
  v_cvt_pk_bf16_f32 v55, v24, v25
  s_waitcnt lgkmcnt(0)
  buffer_store_dwordx4 v[52:55], v76, s[8:11], s68 offen sc1
  s_branch Cs1_done
Cs1_lastp:
  s_add_u32 s72, s72, 2
  s_cmp_ge_u32 s72, 131072
  s_cbranch_scc1 Cs1_lastg
  s_barrier
  s_waitcnt vmcnt(0)
  s_barrier
  s_branch Cs1_lastr
Cs1_done:
  s_branch L_cexit
L_w6:
  v_mov_b64 v[20:21], 0
  v_mov_b64 v[22:23], 0
  v_mov_b64 v[24:25], 0
  v_mov_b64 v[26:27], 0
  v_mov_b64 v[28:29], 0
  v_mov_b64 v[30:31], 0
  v_mov_b64 v[32:33], 0
  v_mov_b64 v[34:35], 0
  s_mov_b32 s78, 0x3f803f80
  s_mov_b32 s79, s78
  s_mov_b32 s65, 360448
  s_mov_b32 m0, 15872
  s_lshl_b32 s71, s53, 2
  s_add_u32 s71, s71, 128
  s_movk_i32 s56, 0x1000
  v_lshlrev_b32 v73, 2, v76
  v_mov_b32 v72, 0
  s_mov_b64 s[16:17], s[8:9]
  s_mov_b32 s18, 268435456
  s_mov_b32 s19, 0x20000
  s_getpc_b64 s[20:21]
Cs2_pc:
  s_add_u32 s20, s20, (Cs2_last - Cs2_pc)
  s_addc_u32 s21, s21, 0
  v_mov_b32 v68, 14880
  buffer_load_dwordx4 v[52:55], v76, s[8:11], s59 offen offset:0 sc1
  buffer_load_dwordx4 v[56:59], v76, s[8:11], s59 offen offset:1024 sc1
  ds_read_b128 v[60:63], v76 offset:24576
  ds_read_b128 v[64:67], v76 offset:25600
  ds_read_b128 v[44:47], v76 offset:26624
  ds_read_b128 v[48:51], v76 offset:27648
  ds_read_b128 v[36:39], v76 offset:40960
  ds_read_b128 v[40:43], v76 offset:41984
  ds_read_b128 v[0:3], v76 offset:4608
  ds_read_b128 v[4:7], v76 offset:5632
  ds_read_b128 v[8:11], v76 offset:6656
  ds_read_b128 v[12:15], v76 offset:7680
  s_waitcnt lgkmcnt(0)
  s_cmp_eq_u32 s66, 1
  s_branch Cs2_top2
.p2align 6
Cs2_h2:
  v_lshlrev_b32 v73, 2, v76
  s_nop 3
  buffer_load_dwordx4 v[12:15], v76, s[8:11], s65 offen offset:3072 sc1
  s_nop 15
  s_nop 3
  buffer_load_dwordx4 v[12:15], v76, s[8:11], s65 offen offset:3072 sc1
  s_nop 15
  s_nop 3
  buffer_load_dwordx4 v[12:15], v76, s[8:11], s65 offen offset:3072 sc1
  s_waitcnt vmcnt(5)
  ds_read_b128 v[60:63], v76 offset:24576
  ds_read_b128 v[64:67], v76 offset:25600
  ds_read_b128 v[44:47], v76 offset:26624
  ds_read_b128 v[48:51], v76 offset:27648
  ds_read_b128 v[36:39], v76 offset:40960
  ds_read_b128 v[40:43], v76 offset:41984
  buffer_load_dwordx4 v[52:55], v76, s[8:11], s59 offen offset:0 sc1
  buffer_load_dwordx4 v[56:59], v76, s[8:11], s59 offen offset:1024 sc1
  s_waitcnt vmcnt(4)
  v_max3_u32 v72, v12, v13, v14
  v_max_u32 v72, v72, v15
  ds_write_b128 v76, v[12:15] offset:7680
  v_cmp_eq_u32 vcc, -1, v72
  s_cbranch_vccnz Cs2_h2r
Cs2_h2w:
  s_cmp_eq_u32 s66, 63
  s_waitcnt lgkmcnt(0)
  s_barrier
  ds_read_b128 v[0:3], v76 offset:4608
Cs2_top2:
  v_smfmac_f32_16x16x64_bf16 v[20:23], v[12:15], v[112:119], v74
  s_cbranch_scc1 Cs2_last
  v_smfmac_f32_16x16x64_bf16 v[24:27], v[12:15], v[120:127], v74
  ds_read_b128 v[4:7], v76 offset:5632
  v_smfmac_f32_16x16x64_bf16 v[28:31], v[12:15], v[224:231], v74
  ds_read_b128 v[8:11], v76 offset:6656
  v_smfmac_f32_16x16x64_bf16 v[32:35], v[12:15], v[232:239], v74
  s_waitcnt lgkmcnt(2)
  v_smfmac_f32_16x16x64_bf16 v[24:27], v[0:3], v[44:51], v74
  buffer_load_dwordx4 v[44:47], v76, s[8:11], s58 offen offset:0 sc1
  v_smfmac_f32_16x16x64_bf16 v[20:23], v[0:3], v[60:67], v74
  buffer_load_dwordx4 v[48:51], v76, s[8:11], s58 offen offset:1024 sc1
  ds_read_b128 v[60:63], v76 offset:43008
  v_smfmac_f32_16x16x64_bf16 v[28:31], v[0:3], v[36:43], v74
  ds_read_b128 v[64:67], v76 offset:44032
  s_waitcnt lgkmcnt(3)
  v_smfmac_f32_16x16x64_bf16 v[20:23], v[4:7], v[80:87], v74
  ds_read_b128 v[36:39], v76 offset:57344
  v_smfmac_f32_16x16x64_bf16 v[24:27], v[4:7], v[88:95], v74
  ds_read_b128 v[40:43], v76 offset:58368
  s_waitcnt lgkmcnt(4)
  v_smfmac_f32_16x16x64_bf16 v[28:31], v[4:7], v[192:199], v74
  buffer_store_dwordx4 v[16:19], v76, s[8:11], s68 offen sc1
  s_waitcnt vmcnt(3)
  v_smfmac_f32_16x16x64_bf16 v[32:35], v[4:7], v[200:207], v74
  s_barrier
  s_waitcnt lgkmcnt(2)
  v_smfmac_f32_16x16x64_bf16 v[32:35], v[0:3], v[60:67], v74
  buffer_load_dword v73, s[16:19], s70 offen lds
  ds_read_b128 v[12:15], v76 offset:8704
  v_smfmac_f32_16x16x64_bf16 v[20:23], v[8:11], v[96:103], v74
  ds_read_b128 v[60:63], v76 offset:59392
  ds_read_b128 v[64:67], v76 offset:60416
  v_smfmac_f32_16x16x64_bf16 v[24:27], v[8:11], v[104:111], v74
  ds_read_b128 v[4:7], v76 offset:9728
  v_smfmac_f32_16x16x64_bf16 v[28:31], v[8:11], v[208:215], v74
  v_smfmac_f32_16x16x64_bf16 v[32:35], v[8:11], v[216:223], v74
  s_waitcnt lgkmcnt(3)
  v_smfmac_f32_16x16x64_bf16 v[28:31], v[12:15], v[36:43], v74
  ds_read_b128 v[36:39], v75 offset:8192
  ds_read_b128 v[40:43], v75 offset:9216
  s_waitcnt lgkmcnt(3)
  v_smfmac_f32_16x16x64_bf16 v[32:35], v[12:15], v[60:67], v74
  s_barrier
  ds_read_b128 v[16:19], v76 offset:10752
  v_smfmac_f32_16x16x64_bf16 v[20:23], v[12:15], v[128:135], v74
  ds_read_b128 v[60:63], v75 offset:10240
  ds_read_b128 v[64:67], v75 offset:11264
  v_smfmac_f32_16x16x64_bf16 v[24:27], v[12:15], v[136:143], v74
  ds_read_b128 v[0:3], v76 offset:11776
  s_waitcnt lgkmcnt(6)
  v_smfmac_f32_16x16x64_bf16 v[20:23], v[4:7], v[144:151], v74
  ds_read_b128 v[8:11], v76 offset:12800
  v_smfmac_f32_16x16x64_bf16 v[24:27], v[4:7], v[152:159], v74
  s_waitcnt lgkmcnt(4)
  v_smfmac_f32_16x16x64_bf16 v[20:23], v[16:19], v[36:43], v74
  ds_read_b128 v[36:39], v75 offset:24576
  s_waitcnt lgkmcnt(3)
  v_smfmac_f32_16x16x64_bf16 v[24:27], v[16:19], v[60:67], v74
  ds_read_b128 v[40:43], v75 offset:25600
  s_waitcnt lgkmcnt(3)
  v_smfmac_f32_16x16x64_bf16 v[20:23], v[0:3], v[160:167], v74
  ds_read_b128 v[60:63], v75 offset:26624
  s_waitcnt lgkmcnt(3)
  v_smfmac_f32_16x16x64_bf16 v[20:23], v[8:11], v[176:183], v74
  ds_read_b128 v[64:67], v75 offset:27648
  v_smfmac_f32_16x16x64_bf16 v[24:27], v[0:3], v[168:175], v74
  v_mov_b64 v[70:71], s[78:79]
  v_smfmac_f32_16x16x64_bf16 v[24:27], v[8:11], v[184:191], v74
  s_waitcnt lgkmcnt(2)
  v_add_f32 v20, v20, v22
  v_smfmac_f32_16x16x64_bf16 v[28:31], v[4:7], v[36:43], v74
  ds_read_b128 v[36:39], v68
  s_waitcnt lgkmcnt(1)
  v_add_f32 v21, v21, v23
  v_smfmac_f32_16x16x64_bf16 v[32:35], v[4:7], v[60:67], v74
  ds_read_b128 v[40:43], v68
  v_add_f32 v24, v24, v26
  v_smfmac_f32_16x16x64_bf16 v[28:31], v[16:19], v[240:247], v74
  v_cvt_pk_bf16_f32 v22, v20, v24
  v_smfmac_f32_16x16x64_bf16 v[28:31], v[0:3], a[0:7], v74
  ds_write_b32 v79, v22 offset:0
  v_add_f32 v25, v25, v27
  v_cvt_pk_bf16_f32 v23, v21, v25
  v_smfmac_f32_16x16x64_bf16 v[28:31], v[8:11], a[16:23], v74
  ds_write_b32 v79, v23 offset:576
  v_cmp_u_f32 vcc, v20, v21
  v_smfmac_f32_16x16x64_bf16 v[32:35], v[16:19], v[248:255], v74
  v_mov_b64 v[68:69], s[78:79]
  v_smfmac_f32_16x16x64_bf16 v[32:35], v[0:3], a[8:15], v74
  v_add_f32 v28, v28, v30
  v_add_f32 v29, v29, v31
  v_smfmac_f32_16x16x64_bf16 v[32:35], v[8:11], a[24:31], v74
  s_cbranch_vccnz Cs2_rec
Cs2_recok:
  s_waitcnt lgkmcnt(3)
  v_smfmac_f32_16x16x64_bf16 v[36:39], v[16:19], a[128:135], v74
  s_waitcnt lgkmcnt(0)
  s_barrier
  ds_read_b128 v[60:63], v77
  v_smfmac_f32_16x16x64_bf16 v[40:43], v[16:19], a[136:143], v74
  ds_read_b128 v[64:67], v77 offset:128
  v_add_f32 v32, v32, v34
  v_cvt_pk_bf16_f32 v30, v28, v32
  v_smfmac_f32_16x16x64_bf16 v[36:39], v[0:3], a[144:151], v74
  ds_write_b32 v79, v30 offset:256
  v_add_f32 v33, v33, v35
  v_cvt_pk_bf16_f32 v31, v29, v33
  v_smfmac_f32_16x16x64_bf16 v[40:43], v[0:3], a[152:159], v74
  ds_write_b32 v79, v31 offset:832
  v_xor_b32 v75, 0x8000, v75
  v_smfmac_f32_16x16x64_bf16 v[36:39], v[4:7], a[112:119], v74
  ds_read_b128 v[0:3], v76 offset:4608
  v_mov_b32 v29, 0
  v_smfmac_f32_16x16x64_bf16 v[40:43], v[4:7], a[120:127], v74
  s_waitcnt vmcnt(2) lgkmcnt(3)
  v_mov_b32 v30, 0
  v_mfma_f32_16x16x32_bf16 v[44:47], v[44:47], v[60:63], 0
  ds_read_b128 v[4:7], v76 offset:5632
  s_waitcnt lgkmcnt(2)
  v_mfma_f32_16x16x32_bf16 v[44:47], v[48:51], v[64:67], v[44:47]
  s_barrier
  v_smfmac_f32_16x16x64_bf16 v[36:39], v[8:11], a[160:167], v74
  ds_read_b128 v[20:23], v77 offset:256
  ds_read_b128 v[24:27], v77 offset:384
  v_smfmac_f32_16x16x64_bf16 v[40:43], v[8:11], a[168:175], v74
  ds_read_b128 v[8:11], v76 offset:6656
  v_add_f32_dpp v72, v46, v44 quad_perm:[2,3,0,1] row_mask:0xf bank_mask:0xf
  v_add_f32_dpp v73, v47, v45 quad_perm:[2,3,0,1] row_mask:0xf bank_mask:0xf
  v_smfmac_f32_16x16x64_bf16 v[36:39], v[12:15], a[96:103], v74
  s_waitcnt lgkmcnt(4)
  v_exp_f32_dpp v72, v72 quad_perm:[0,1,0,1] row_mask:0xf bank_mask:0xf
  v_smfmac_f32_16x16x64_bf16 v[40:43], v[12:15], a[104:111], v74
  ds_read_b128 v[12:15], v76 offset:7680
  v_exp_f32_dpp v73, v73 quad_perm:[0,1,0,1] row_mask:0xf bank_mask:0xf
  v_smfmac_f32_16x16x64_bf16 v[36:39], v[0:3], a[32:39], v74
  s_waitcnt lgkmcnt(2)
  v_cvt_pk_bf16_f32 v72, v72, v73
  v_mfma_f32_16x16x32_bf16 v[20:23], v[20:23], v[60:63], 0
  ds_write_b32 v78, v72 offset:520
  v_mov_b64 v[16:17], 0
  v_mfma_f32_16x16x32_bf16 v[20:23], v[24:27], v[64:67], v[20:23]
  ds_read_b128 v[44:47], v75 offset:24576
  v_mov_b64 v[18:19], 0
  v_smfmac_f32_16x16x64_bf16 v[40:43], v[0:3], a[40:47], v74
  ds_read_b128 v[48:51], v75 offset:25600
  s_waitcnt lgkmcnt(4)
  v_smfmac_f32_16x16x64_bf16 v[36:39], v[4:7], a[48:55], v74
  v_add_f32_dpp v24, v22, v20 quad_perm:[2,3,0,1] row_mask:0xf bank_mask:0xf
  v_add_f32_dpp v25, v23, v21 quad_perm:[2,3,0,1] row_mask:0xf bank_mask:0xf
  v_smfmac_f32_16x16x64_bf16 v[36:39], v[8:11], a[64:71], v74
  s_waitcnt lgkmcnt(2)
  s_barrier
  ds_read_b128 v[32:35], v78 offset:512
  v_smfmac_f32_16x16x64_bf16 v[36:39], v[12:15], a[80:87], v74
  ds_read_b128 v[60:63], v75 offset:26624
  v_mul_f32 v24, s69, v24
  v_smfmac_f32_16x16x64_bf16 v[40:43], v[4:7], a[56:63], v74
  ds_read_b128 v[64:67], v75 offset:27648
  v_mul_f32 v25, s69, v25
  v_smfmac_f32_16x16x64_bf16 v[40:43], v[8:11], a[72:79], v74
  v_exp_f32_dpp v24, v24 quad_perm:[0,1,0,1] row_mask:0xf bank_mask:0xf
  v_smfmac_f32_16x16x64_bf16 v[40:43], v[12:15], a[88:95], v74
  s_waitcnt lgkmcnt(2)
  v_exp_f32_dpp v25, v25 quad_perm:[0,1,0,1] row_mask:0xf bank_mask:0xf
  v_mfma_f32_16x16x32_bf16 v[8:11], v[32:35], v[68:71], 0
  v_add_f32 v36, v36, v38
  v_add_f32 v37, v37, v39
  v_mfma_f32_16x16x32_bf16 v[0:3], v[32:35], v[52:55], 0
  v_add_f32 v40, v40, v42
  v_add_f32 v41, v41, v43
  v_mfma_f32_16x16x32_bf16 v[4:7], v[32:35], v[56:59], 0
  v_cvt_pk_bf16_f32 v28, v24, v25
  v_cvt_pk_bf16_f32 v72, v36, v37
  v_cvt_pk_bf16_f32 v73, v40, v41
  v_mfma_f32_16x16x16_bf16 v[8:11], v[28:29], v[68:69], v[8:11]
  v_cvt_pk_bf16_f32 v31, v24, v25
  v_mov_b64 v[20:21], 0
  v_mfma_f32_16x16x16_bf16 v[0:3], v[28:29], v[72:73], v[0:3]
  ds_read_b128 v[68:71], v76 offset:13824
  v_mov_b64 v[22:23], 0
  v_mfma_f32_16x16x16_bf16 v[4:7], v[30:31], v[72:73], v[4:7]
  v_rcp_f32 v10, v8
  v_rcp_f32 v11, v9
  v_mul_f32 v0, v10, v0
  v_mul_f32 v1, v11, v1
  s_nop 0
  v_mul_f32 v4, v10, v4
  v_mul_f32 v5, v11, v5
  v_cvt_pk_bf16_f32 v2, v0, v4
  ds_write_b32 v79, v2 offset:8704
  v_cvt_pk_bf16_f32 v3, v1, v5
  ds_write_b32 v79, v3 offset:9280
  v_max3_f32 v8, v8, v9, v10
  v_max_f32 v8, v8, v11
  v_cmp_le_f32 vcc, 1317011456, v8
  v_mov_b64 v[24:25], 0
  v_mov_b64 v[26:27], 0
  s_cbranch_vccnz Cs2_mx
Cs2_mxok:
  s_waitcnt lgkmcnt(0)
  s_barrier
  ds_read_b128 v[0:3], v78 offset:8704
  ds_read_b128 v[4:7], v78 offset:8768
  ds_read_b128 v[8:11], v78 offset:8832
  ds_read_b128 v[12:15], v78 offset:8896
  s_waitcnt lgkmcnt(3)
  v_smfmac_f32_16x16x64_bf16 v[16:19], v[0:3], v[44:51], v74
  ds_read_b128 v[52:55], v75 offset:40960
  s_waitcnt lgkmcnt(3)
  v_smfmac_f32_16x16x64_bf16 v[16:19], v[4:7], v[60:67], v74
  ds_read_b128 v[56:59], v75 offset:41984
  s_waitcnt lgkmcnt(3)
  v_smfmac_f32_16x16x64_bf16 v[16:19], v[8:11], a[176:183], v74
  ds_read_b128 v[36:39], v75 offset:43008
  s_waitcnt lgkmcnt(3)
  v_smfmac_f32_16x16x64_bf16 v[16:19], v[12:15], a[184:191], v74
  ds_read_b128 v[40:43], v75 offset:44032
  ds_read_b128 v[44:47], v75 offset:57344
  v_smfmac_f32_16x16x64_bf16 v[20:23], v[0:3], a[192:199], v74
  ds_read_b128 v[48:51], v75 offset:58368
  ds_read_b128 v[60:63], v75 offset:59392
  v_smfmac_f32_16x16x64_bf16 v[20:23], v[4:7], a[200:207], v74
  ds_read_b128 v[64:67], v75 offset:60416
  s_waitcnt lgkmcnt(6)
  v_cvt_pk_bf16_f32 v16, v16, v17
  v_cvt_pk_bf16_f32 v17, v18, v19
  v_bfi_b32 v16, 1, s72, v16
  v_smfmac_f32_16x16x64_bf16 v[20:23], v[8:11], v[52:59], v74
  buffer_store_dwordx2 v[16:17], v68, s[8:11], s73 offen sc1
  s_waitcnt lgkmcnt(4)
  v_smfmac_f32_16x16x64_bf16 v[20:23], v[12:15], v[36:43], v74
  ds_read_b128 v[52:55], v75 offset:0
  v_mov_b64 v[32:33], 0
  v_smfmac_f32_16x16x64_bf16 v[24:27], v[0:3], a[208:215], v74
  ds_read_b128 v[56:59], v75 offset:1024
  v_mov_b64 v[34:35], 0
  v_smfmac_f32_16x16x64_bf16 v[24:27], v[4:7], a[216:223], v74
  ds_read_b128 v[36:39], v75 offset:2048
  s_waitcnt lgkmcnt(5)
  v_cvt_pk_bf16_f32 v20, v20, v21
  v_cvt_pk_bf16_f32 v21, v22, v23
  v_bfi_b32 v20, 1, s72, v20
  v_smfmac_f32_16x16x64_bf16 v[24:27], v[8:11], v[44:51], v74
  buffer_store_dwordx2 v[20:21], v68, s[8:11], s74 offen sc1
  s_waitcnt lgkmcnt(3)
  v_smfmac_f32_16x16x64_bf16 v[24:27], v[12:15], v[60:67], v74
  ds_read_b128 v[40:43], v75 offset:3072
  v_mov_b64 v[28:29], 0
  v_smfmac_f32_16x16x64_bf16 v[32:35], v[0:3], a[224:231], v74
  ds_read_b128 v[44:47], v75 offset:4096
  ds_read_b128 v[48:51], v75 offset:5120
  v_smfmac_f32_16x16x64_bf16 v[32:35], v[4:7], a[232:239], v74
  ds_read_b128 v[60:63], v75 offset:6144
  v_cvt_pk_bf16_f32 v24, v24, v25
  v_cvt_pk_bf16_f32 v25, v26, v27
  v_bfi_b32 v24, 1, s72, v24
  v_smfmac_f32_16x16x64_bf16 v[32:35], v[8:11], a[240:247], v74
  buffer_store_dwordx2 v[24:25], v68, s[8:11], s75 offen sc1
  v_mov_b64 v[30:31], 0
  v_smfmac_f32_16x16x64_bf16 v[32:35], v[12:15], a[248:255], v74
  ds_read_b128 v[64:67], v75 offset:7168
  s_waitcnt lgkmcnt(6)
  v_smfmac_f32_16x16x64_bf16 v[28:31], v[0:3], v[52:59], v74
  s_waitcnt lgkmcnt(4)
  v_smfmac_f32_16x16x64_bf16 v[28:31], v[4:7], v[36:43], v74
  s_waitcnt lgkmcnt(2)
  v_cvt_pk_bf16_f32 v32, v32, v33
  v_cvt_pk_bf16_f32 v33, v34, v35
  v_bfi_b32 v32, 1, s72, v32
  v_smfmac_f32_16x16x64_bf16 v[28:31], v[8:11], v[44:51], v74
  buffer_store_dwordx2 v[32:33], v68, s[8:11], s76 offen sc1
  s_waitcnt lgkmcnt(0)
  v_smfmac_f32_16x16x64_bf16 v[28:31], v[12:15], v[60:67], v74
  ds_read_b128 v[0:3], v76 offset:14848
  ds_read_b64 v[16:17], v77 offset:384
  v_mov_b64 v[18:19], v[72:73]
  v_xor_b32 v75, 0x8000, v75
  s_nop 3
  v_cvt_pk_bf16_f32 v28, v28, v29
  v_cvt_pk_bf16_f32 v29, v30, v31
  v_bfi_b32 v28, 1, s72, v28
  buffer_store_dwordx2 v[28:29], v68, s[8:11], s77 offen sc1
  v_mov_b64 v[20:21], 0
  v_mov_b64 v[22:23], 0
  v_mov_b64 v[24:25], 0
  v_mov_b64 v[26:27], 0
  v_mov_b64 v[28:29], 0
  v_mov_b64 v[30:31], 0
  v_mov_b64 v[32:33], 0
  v_mov_b64 v[34:35], 0
  v_mov_b32 v68, 14880
  s_add_u32 s58, s58, 655360
  s_add_u32 s59, s59, 655360
  s_add_u32 s70, s70, 655360
  s_add_u32 s68, s68, 655360
  s_add_u32 s66, s66, 1
  s_xor_b32 s64, s64, 16384
  s_xor_b32 s65, s65, 16384
  s_cmp_eq_u32 s66, 62
  s_cselect_b64 s[16:17], s[20:21], s[16:17]
  s_cselect_b32 s18, (Cs2_done - Cs2_last), s18
  s_cselect_b32 s70, 0, s70
  s_cmp_eq_u32 s66, 63
  s_cselect_b32 s59, 268435456, s59
  s_nop 15
  s_nop 15
  s_nop 1
  buffer_load_dwordx4 v[52:55], v76, s[8:11], s60 offen offset:0 sc1
  buffer_load_dwordx4 v[56:59], v76, s[8:11], s60 offen offset:1024 sc1
  s_nop 15
  s_nop 11
  buffer_load_dwordx4 v[36:39], v76, s[8:11], s60 offen offset:0 sc1
  buffer_load_dwordx4 v[40:43], v76, s[8:11], s60 offen offset:1024 sc1
  s_waitcnt lgkmcnt(0)
  s_waitcnt vmcnt(3)
  v_mfma_f32_16x16x32_bf16 v[4:7], v[0:3], v[52:55], 0
  v_bitop3_b32 v72, v52, v54, s72 bitop3:0x7e
  s_waitcnt vmcnt(2)
  v_mfma_f32_16x16x32_bf16 v[4:7], v[0:3], v[56:59], v[4:7]
  v_bitop3_b32 v73, v56, v58, s72 bitop3:0x7e
  v_bitop3_b32 v72, v72, v73, 1 bitop3:0xa8
  v_cmp_ne_u32 vcc, 0, v72
  s_cbranch_vccnz Cs2_h1r
  s_nop 2
  v_add_f32_dpp v4, v4, v4 row_ror:4 row_mask:0xf bank_mask:0xf
  v_add_f32_dpp v5, v5, v5 row_ror:4 row_mask:0xf bank_mask:0xf
  s_nop 0
  v_add_f32_dpp v4, v4, v4 row_ror:8 row_mask:0xf bank_mask:0xf
  v_add_f32_dpp v5, v5, v5 row_ror:8 row_mask:0xf bank_mask:0xf
  v_cvt_pk_bf16_f32 v4, v4, v5
  buffer_store_dword v4, v69, s[8:11], s62 offen sc1
  s_xor_b32 s62, s62, 16384
  buffer_store_dword v71, v69, s[8:11], s62 offen sc1
  s_xor_b32 s72, s72, 1
  s_branch Cs2_h2
Cs2_h1r:
  s_mov_b64 exec, vcc
  buffer_load_dwordx4 v[52:55], v76, s[8:11], s60 offen offset:0 sc1
  buffer_load_dwordx4 v[56:59], v76, s[8:11], s60 offen offset:1024 sc1
  s_mov_b64 exec, -1
  s_add_u32 s67, s67, 1
  s_waitcnt vmcnt(3)
  v_mfma_f32_16x16x32_bf16 v[4:7], v[0:3], v[36:39], 0
  v_bitop3_b32 v72, v36, v38, s72 bitop3:0x7e
  s_waitcnt vmcnt(2)
  v_mfma_f32_16x16x32_bf16 v[4:7], v[0:3], v[40:43], v[4:7]
  v_bitop3_b32 v73, v40, v42, s72 bitop3:0x7e
  v_bitop3_b32 v72, v72, v73, 1 bitop3:0xa8
  v_cmp_ne_u32 vcc, 0, v72
  s_cbranch_vccz Cs2_h1p
  s_mov_b64 exec, vcc
  buffer_load_dwordx4 v[36:39], v76, s[8:11], s60 offen offset:0 sc1
  buffer_load_dwordx4 v[40:43], v76, s[8:11], s60 offen offset:1024 sc1
  s_mov_b64 exec, -1
  s_add_u32 s67, s67, 1
  s_waitcnt vmcnt(3)
  v_mfma_f32_16x16x32_bf16 v[4:7], v[0:3], v[52:55], 0
  v_bitop3_b32 v72, v52, v54, s72 bitop3:0x7e
  s_waitcnt vmcnt(2)
  v_mfma_f32_16x16x32_bf16 v[4:7], v[0:3], v[56:59], v[4:7]
  v_bitop3_b32 v73, v56, v58, s72 bitop3:0x7e
  v_bitop3_b32 v72, v72, v73, 1 bitop3:0xa8
  v_cmp_ne_u32 vcc, 0, v72
  s_cbranch_vccz Cs2_h1p
Cs2_h1s:
  s_mov_b64 exec, vcc
  buffer_load_dwordx4 v[52:55], v76, s[8:11], s60 offen offset:0 sc1
  buffer_load_dwordx4 v[56:59], v76, s[8:11], s60 offen offset:1024 sc1
  s_mov_b64 exec, -1
  s_add_u32 s67, s67, 1
  s_waitcnt vmcnt(3)
  v_mfma_f32_16x16x32_bf16 v[4:7], v[0:3], v[36:39], 0
  v_bitop3_b32 v72, v36, v38, s72 bitop3:0x7e
  s_waitcnt vmcnt(2)
  v_mfma_f32_16x16x32_bf16 v[4:7], v[0:3], v[40:43], v[4:7]
  v_bitop3_b32 v73, v40, v42, s72 bitop3:0x7e
  v_bitop3_b32 v72, v72, v73, 1 bitop3:0xa8
  v_cmp_ne_u32 vcc, 0, v72
  s_cbranch_vccz Cs2_h1p
  s_mov_b64 exec, vcc
  buffer_load_dwordx4 v[36:39], v76, s[8:11], s60 offen offset:0 sc1
  buffer_load_dwordx4 v[40:43], v76, s[8:11], s60 offen offset:1024 sc1
  s_mov_b64 exec, -1
  s_add_u32 s67, s67, 1
  s_waitcnt vmcnt(3)
  v_mfma_f32_16x16x32_bf16 v[4:7], v[0:3], v[52:55], 0
  v_bitop3_b32 v72, v52, v54, s72 bitop3:0x7e
  s_waitcnt vmcnt(2)
  v_mfma_f32_16x16x32_bf16 v[4:7], v[0:3], v[56:59], v[4:7]
  v_bitop3_b32 v73, v56, v58, s72 bitop3:0x7e
  v_bitop3_b32 v72, v72, v73, 1 bitop3:0xa8
  v_cmp_ne_u32 vcc, 0, v72
  s_cbranch_vccz Cs2_h1p
  s_cmp_lt_u32 s67, 131072
  s_cbranch_scc1 Cs2_h1s
Cs2_h1p:
  s_nop 2
  v_add_f32_dpp v4, v4, v4 row_ror:4 row_mask:0xf bank_mask:0xf
  v_add_f32_dpp v5, v5, v5 row_ror:4 row_mask:0xf bank_mask:0xf
  s_nop 0
  v_add_f32_dpp v4, v4, v4 row_ror:8 row_mask:0xf bank_mask:0xf
  v_add_f32_dpp v5, v5, v5 row_ror:8 row_mask:0xf bank_mask:0xf
  v_cvt_pk_bf16_f32 v4, v4, v5
  buffer_store_dword v4, v69, s[8:11], s62 offen sc1
  s_xor_b32 s62, s62, 16384
  buffer_store_dword v71, v69, s[8:11], s62 offen sc1
  s_xor_b32 s72, s72, 1
  s_branch Cs2_h2
Cs2_h2r:
  s_mov_b64 exec, vcc
  buffer_load_dwordx4 v[12:15], v76, s[8:11], s65 offen offset:3072 sc1
  s_mov_b64 exec, -1
  s_add_u32 s67, s67, 1
  s_waitcnt vmcnt(4)
  v_max3_u32 v72, v12, v13, v14
  v_max_u32 v72, v72, v15
  ds_write_b128 v76, v[12:15] offset:7680
  v_cmp_eq_u32 vcc, -1, v72
  s_cbranch_vccz Cs2_h2w
  s_mov_b64 exec, vcc
  buffer_load_dwordx4 v[12:15], v76, s[8:11], s65 offen offset:3072 sc1
  s_mov_b64 exec, -1
  s_add_u32 s67, s67, 1
  s_waitcnt vmcnt(4)
  v_max3_u32 v72, v12, v13, v14
  v_max_u32 v72, v72, v15
  ds_write_b128 v76, v[12:15] offset:7680
  v_cmp_eq_u32 vcc, -1, v72
  s_cbranch_vccz Cs2_h2w
Cs2_h2s:
  s_mov_b64 exec, vcc
  buffer_load_dwordx4 v[12:15], v76, s[8:11], s65 offen offset:3072 sc1
  s_mov_b64 exec, -1
  s_add_u32 s67, s67, 1
  s_waitcnt vmcnt(2)
  v_max3_u32 v72, v12, v13, v14
  v_max_u32 v72, v72, v15
  ds_write_b128 v76, v[12:15] offset:7680
  v_cmp_eq_u32 vcc, -1, v72
  s_cbranch_vccz Cs2_h2w
  s_mov_b64 exec, vcc
  buffer_load_dwordx4 v[12:15], v76, s[8:11], s65 offen offset:3072 sc1
  s_mov_b64 exec, -1
  s_add_u32 s67, s67, 1
  s_waitcnt vmcnt(2)
  v_max3_u32 v72, v12, v13, v14
  v_max_u32 v72, v72, v15
  ds_write_b128 v76, v[12:15] offset:7680
  v_cmp_eq_u32 vcc, -1, v72
  s_cbranch_vccz Cs2_h2w
  s_mov_b64 exec, vcc
  buffer_load_dwordx4 v[12:15], v76, s[8:11], s65 offen offset:3072 sc1
  s_mov_b64 exec, -1
  s_add_u32 s67, s67, 1
  s_waitcnt vmcnt(2)
  v_max3_u32 v72, v12, v13, v14
  v_max_u32 v72, v72, v15
  ds_write_b128 v76, v[12:15] offset:7680
  v_cmp_eq_u32 vcc, -1, v72
  s_cbranch_vccz Cs2_h2w
  s_cmp_lt_u32 s67, 131072
  s_cbranch_scc1 Cs2_h2s
  s_branch Cs2_h2w
Cs2_rec:
  s_nop 7
  s_waitcnt vmcnt(0) lgkmcnt(0)
  v_max3_u32 v72, v0, v1, v2
  v_max3_u32 v72, v72, v3, v4
  v_max3_u32 v72, v72, v5, v6
  v_max3_u32 v72, v72, v7, v8
  v_max3_u32 v72, v72, v9, v10
  v_max3_u32 v72, v72, v11, v12
  v_max3_u32 v72, v72, v13, v14
  v_max3_u32 v72, v72, v15, v16
  v_max3_u32 v72, v72, v17, v18
  v_max_u32 v72, v72, v19
  v_cmp_eq_u32 vcc, -1, v72
  s_cbranch_vccz Cs2_recok
  s_barrier
Cs2_recp:
  buffer_load_dwordx4 v[0:3], v76, s[8:11], s64 offen offset:0 sc1
  buffer_load_dwordx4 v[4:7], v76, s[8:11], s64 offen offset:1024 sc1
  s_add_u32 s67, s67, 1
  s_cmp_lt_u32 s67, 131072
  s_cselect_b32 s54, -2, -1
  s_waitcnt vmcnt(1)
  v_max3_u32 v72, v0, v1, v2
  s_waitcnt vmcnt(0)
  v_max3_u32 v72, v72, v3, v4
  v_max3_u32 v72, v72, v5, v6
  v_max_u32 v72, v72, v7
  v_cmp_lt_u32 vcc, s54, v72
  s_cbranch_vccnz Cs2_recp
  ds_write_b128 v76, v[0:3] offset:8704
  ds_write_b128 v76, v[4:7] offset:9728
  v_mov_b64 v[20:21], 0
  v_mov_b64 v[22:23], 0
  v_mov_b64 v[24:25], 0
  v_mov_b64 v[26:27], 0
  v_mov_b64 v[28:29], 0
  v_mov_b64 v[30:31], 0
  v_mov_b64 v[32:33], 0
  v_mov_b64 v[34:35], 0
  s_waitcnt lgkmcnt(0)
  s_barrier
  ds_read_b128 v[0:3], v76 offset:4608
  ds_read_b128 v[60:63], v76 offset:24576
  ds_read_b128 v[64:67], v76 offset:25600
  s_waitcnt lgkmcnt(0)
  v_smfmac_f32_16x16x64_bf16 v[20:23], v[0:3], v[60:67], v74
  ds_read_b128 v[60:63], v76 offset:26624
  ds_read_b128 v[64:67], v76 offset:27648
  s_waitcnt lgkmcnt(0)
  v_smfmac_f32_16x16x64_bf16 v[24:27], v[0:3], v[60:67], v74
  ds_read_b128 v[60:63], v76 offset:40960
  ds_read_b128 v[64:67], v76 offset:41984
  s_waitcnt lgkmcnt(0)
  v_smfmac_f32_16x16x64_bf16 v[28:31], v[0:3], v[60:67], v74
  ds_read_b128 v[60:63], v76 offset:43008
  ds_read_b128 v[64:67], v76 offset:44032
  s_waitcnt lgkmcnt(0)
  v_smfmac_f32_16x16x64_bf16 v[32:35], v[0:3], v[60:67], v74
  ds_read_b128 v[4:7], v76 offset:5632
  s_waitcnt lgkmcnt(0)
  v_smfmac_f32_16x16x64_bf16 v[20:23], v[4:7], v[80:87], v74
  v_smfmac_f32_16x16x64_bf16 v[24:27], v[4:7], v[88:95], v74
  v_smfmac_f32_16x16x64_bf16 v[28:31], v[4:7], v[192:199], v74
  v_smfmac_f32_16x16x64_bf16 v[32:35], v[4:7], v[200:207], v74
  ds_read_b128 v[8:11], v76 offset:6656
  s_waitcnt lgkmcnt(0)
  v_smfmac_f32_16x16x64_bf16 v[20:23], v[8:11], v[96:103], v74
  v_smfmac_f32_16x16x64_bf16 v[24:27], v[8:11], v[104:111], v74
  v_smfmac_f32_16x16x64_bf16 v[28:31], v[8:11], v[208:215], v74
  v_smfmac_f32_16x16x64_bf16 v[32:35], v[8:11], v[216:223], v74
  ds_read_b128 v[12:15], v76 offset:7680
  s_waitcnt lgkmcnt(0)
  v_smfmac_f32_16x16x64_bf16 v[20:23], v[12:15], v[112:119], v74
  v_smfmac_f32_16x16x64_bf16 v[24:27], v[12:15], v[120:127], v74
  v_smfmac_f32_16x16x64_bf16 v[28:31], v[12:15], v[224:231], v74
  v_smfmac_f32_16x16x64_bf16 v[32:35], v[12:15], v[232:239], v74
  ds_read_b128 v[12:15], v76 offset:8704
  s_waitcnt lgkmcnt(0)
  v_smfmac_f32_16x16x64_bf16 v[20:23], v[12:15], v[128:135], v74
  v_smfmac_f32_16x16x64_bf16 v[24:27], v[12:15], v[136:143], v74
  ds_read_b128 v[60:63], v76 offset:57344
  ds_read_b128 v[64:67], v76 offset:58368
  s_waitcnt lgkmcnt(0)
  v_smfmac_f32_16x16x64_bf16 v[28:31], v[12:15], v[60:67], v74
  ds_read_b128 v[60:63], v76 offset:59392
  ds_read_b128 v[64:67], v76 offset:60416
  s_waitcnt lgkmcnt(0)
  v_smfmac_f32_16x16x64_bf16 v[32:35], v[12:15], v[60:67], v74
  ds_read_b128 v[4:7], v76 offset:9728
  s_waitcnt lgkmcnt(0)
  v_smfmac_f32_16x16x64_bf16 v[20:23], v[4:7], v[144:151], v74
  v_smfmac_f32_16x16x64_bf16 v[24:27], v[4:7], v[152:159], v74
  ds_read_b128 v[60:63], v75 offset:24576
  ds_read_b128 v[64:67], v75 offset:25600
  s_waitcnt lgkmcnt(0)
  v_smfmac_f32_16x16x64_bf16 v[28:31], v[4:7], v[60:67], v74
  ds_read_b128 v[60:63], v75 offset:26624
  ds_read_b128 v[64:67], v75 offset:27648
  s_waitcnt lgkmcnt(0)
  v_smfmac_f32_16x16x64_bf16 v[32:35], v[4:7], v[60:67], v74
  ds_read_b128 v[16:19], v76 offset:10752
  ds_read_b128 v[60:63], v75 offset:8192
  ds_read_b128 v[64:67], v75 offset:9216
  s_waitcnt lgkmcnt(0)
  v_smfmac_f32_16x16x64_bf16 v[20:23], v[16:19], v[60:67], v74
  ds_read_b128 v[60:63], v75 offset:10240
  ds_read_b128 v[64:67], v75 offset:11264
  s_waitcnt lgkmcnt(0)
  v_smfmac_f32_16x16x64_bf16 v[24:27], v[16:19], v[60:67], v74
  v_smfmac_f32_16x16x64_bf16 v[28:31], v[16:19], v[240:247], v74
  v_smfmac_f32_16x16x64_bf16 v[32:35], v[16:19], v[248:255], v74
  ds_read_b128 v[0:3], v76 offset:11776
  s_waitcnt lgkmcnt(0)
  v_smfmac_f32_16x16x64_bf16 v[20:23], v[0:3], v[160:167], v74
  v_smfmac_f32_16x16x64_bf16 v[24:27], v[0:3], v[168:175], v74
  v_smfmac_f32_16x16x64_bf16 v[28:31], v[0:3], a[0:7], v74
  v_smfmac_f32_16x16x64_bf16 v[32:35], v[0:3], a[8:15], v74
  ds_read_b128 v[8:11], v76 offset:12800
  s_waitcnt lgkmcnt(0)
  v_smfmac_f32_16x16x64_bf16 v[20:23], v[8:11], v[176:183], v74
  v_smfmac_f32_16x16x64_bf16 v[24:27], v[8:11], v[184:191], v74
  v_smfmac_f32_16x16x64_bf16 v[28:31], v[8:11], a[16:23], v74
  v_smfmac_f32_16x16x64_bf16 v[32:35], v[8:11], a[24:31], v74
  v_add_f32 v20, v20, v22
  v_add_f32 v21, v21, v23
  v_add_f32 v24, v24, v26
  v_cvt_pk_bf16_f32 v22, v20, v24
  s_nop 0
  ds_write_b32 v79, v22 offset:0
  v_add_f32 v25, v25, v27
  v_cvt_pk_bf16_f32 v23, v21, v25
  ds_write_b32 v79, v23 offset:576
  v_add_f32 v28, v28, v30
  v_add_f32 v29, v29, v31
  s_waitcnt lgkmcnt(0)
  s_nop 1
  s_branch Cs2_recok
Cs2_mx:
  s_waitcnt lgkmcnt(0)
  s_barrier
  buffer_load_dwordx4 v[0:3], v76, s[8:11], s58 offen offset:0 sc1
  ds_read_b128 v[20:23], v77 offset:0
  ds_read_b128 v[28:31], v77 offset:256
  buffer_load_dwordx4 v[4:7], v76, s[8:11], s58 offen offset:1024 sc1
  ds_read_b128 v[24:27], v77 offset:128
  ds_read_b128 v[32:35], v77 offset:384
  s_waitcnt vmcnt(1) lgkmcnt(3)
  v_mfma_f32_16x16x32_bf16 v[8:11], v[0:3], v[20:23], 0
  s_waitcnt vmcnt(0) lgkmcnt(1)
  v_mfma_f32_16x16x32_bf16 v[8:11], v[4:7], v[24:27], v[8:11]
  v_mfma_f32_16x16x32_bf16 v[12:15], v[28:31], v[20:23], 0
  s_waitcnt lgkmcnt(0)
  v_mfma_f32_16x16x32_bf16 v[12:15], v[32:35], v[24:27], v[12:15]
  v_add_f32_dpp v8, v10, v8 quad_perm:[2,3,0,1] row_mask:0xf bank_mask:0xf
  v_add_f32_dpp v9, v11, v9 quad_perm:[2,3,0,1] row_mask:0xf bank_mask:0xf
  s_nop 0
  v_mov_b32_dpp v8, v8 quad_perm:[0,1,0,1] row_mask:0xf bank_mask:0xf
  v_mov_b32_dpp v9, v9 quad_perm:[0,1,0,1] row_mask:0xf bank_mask:0xf
  s_nop 1
  v_add_f32_dpp v12, v14, v12 quad_perm:[2,3,0,1] row_mask:0xf bank_mask:0xf
  v_add_f32_dpp v13, v15, v13 quad_perm:[2,3,0,1] row_mask:0xf bank_mask:0xf
  s_nop 0
  v_mov_b32_dpp v12, v12 quad_perm:[0,1,0,1] row_mask:0xf bank_mask:0xf
  v_mov_b32_dpp v13, v13 quad_perm:[0,1,0,1] row_mask:0xf bank_mask:0xf
  v_mul_f32 v12, s69, v12
  ds_write_b32 v78, v8 offset:8712
  v_mul_f32 v13, s69, v13
  ds_write_b32 v78, v9 offset:8776
  s_waitcnt lgkmcnt(0)
  s_barrier
  ds_read_b128 v[36:39], v78 offset:8704
  ds_read_b128 v[40:43], v78 offset:8768
  s_waitcnt lgkmcnt(0)
  s_barrier
  v_max_f32 v16, v36, v37
  v_max3_f32 v16, v16, v38, v39
  v_max3_f32 v16, v16, v40, v41
  v_max3_f32 v16, v16, v42, v43
  v_max3_f32 v16, v16, v12, v13
  v_mov_b32 v17, v16
  s_nop 1
  v_permlane16_swap_b32 v16, v17
  v_max_f32 v16, v16, v17
  v_mov_b32 v17, v16
  s_nop 1
  v_permlane32_swap_b32 v16, v17
  v_max_f32 v16, v16, v17
  v_sub_f32 v36, v36, v16
  v_sub_f32 v37, v37, v16
  v_sub_f32 v38, v38, v16
  v_sub_f32 v39, v39, v16
  v_sub_f32 v40, v40, v16
  v_sub_f32 v41, v41, v16
  v_sub_f32 v42, v42, v16
  v_sub_f32 v43, v43, v16
  v_sub_f32 v12, v12, v16
  v_sub_f32 v13, v13, v16
  v_exp_f32 v36, v36
  v_exp_f32 v37, v37
  v_exp_f32 v38, v38
  v_exp_f32 v39, v39
  v_exp_f32 v40, v40
  v_exp_f32 v41, v41
  v_exp_f32 v42, v42
  v_exp_f32 v43, v43
  v_exp_f32 v12, v12
  v_exp_f32 v13, v13
  v_cvt_pk_bf16_f32 v32, v36, v40
  v_cvt_pk_bf16_f32 v33, v37, v41
  v_cvt_pk_bf16_f32 v34, v38, v42
  v_cvt_pk_bf16_f32 v35, v39, v43
  v_cvt_pk_bf16_f32 v28, v12, v13
  v_cvt_pk_bf16_f32 v31, v12, v13
  v_mov_b32 v29, 0
  v_mov_b32 v30, 0
  v_mov_b32 v68, 0x3f803f80
  v_mov_b32 v69, 0x3f803f80
  v_mov_b32 v70, 0x3f803f80
  v_mov_b32 v71, 0x3f803f80
  s_nop 1
  v_mfma_f32_16x16x32_bf16 v[8:11], v[32:35], v[68:71], 0
  v_mfma_f32_16x16x32_bf16 v[0:3], v[32:35], v[52:55], 0
  v_mfma_f32_16x16x32_bf16 v[4:7], v[32:35], v[56:59], 0
  v_mfma_f32_16x16x16_bf16 v[8:11], v[28:29], v[68:69], v[8:11]
  v_mfma_f32_16x16x16_bf16 v[0:3], v[28:29], v[72:73], v[0:3]
  v_mfma_f32_16x16x16_bf16 v[4:7], v[30:31], v[72:73], v[4:7]
  ds_read_b128 v[68:71], v76 offset:13824
  v_rcp_f32 v10, v8
  v_rcp_f32 v11, v9
  v_mul_f32 v0, v10, v0
  v_mul_f32 v1, v11, v1
  s_nop 0
  v_mul_f32 v4, v10, v4
  v_mul_f32 v5, v11, v5
  v_cvt_pk_bf16_f32 v2, v0, v4
  ds_write_b32 v79, v2 offset:8704
  v_cvt_pk_bf16_f32 v3, v1, v5
  ds_write_b32 v79, v3 offset:9280
  v_mov_b64 v[16:17], 0
  v_mov_b64 v[18:19], 0
  v_mov_b64 v[20:21], 0
  v_mov_b64 v[22:23], 0
  v_mov_b64 v[24:25], 0
  v_mov_b64 v[26:27], 0
  s_branch Cs2_mxok
Cs2_last:
  ds_read_b128 v[4:7], v76 offset:5632
  ds_read_b128 v[8:11], v76 offset:6656
  ds_read_b128 v[60:63], v76 offset:43008
  ds_read_b128 v[64:67], v76 offset:44032
  ds_read_b128 v[44:47], v76 offset:57344
  ds_read_b128 v[48:51], v76 offset:58368
  s_nop 3
  v_mov_b64 v[20:21], 0
  v_mov_b64 v[22:23], 0
  v_mov_b64 v[24:25], 0
  v_mov_b64 v[26:27], 0
  s_waitcnt lgkmcnt(6)
  v_smfmac_f32_16x16x64_bf16 v[28:31], v[0:3], v[36:43], v74
  v_smfmac_f32_16x16x64_bf16 v[20:23], v[0:3], a[32:39], v74
  ds_read_b128 v[36:39], v76 offset:59392
  ds_read_b128 v[40:43], v76 offset:60416
  v_smfmac_f32_16x16x64_bf16 v[24:27], v[0:3], a[40:47], v74
  s_waitcnt lgkmcnt(7)
  v_smfmac_f32_16x16x64_bf16 v[20:23], v[4:7], a[48:55], v74
  buffer_store_dwordx4 v[16:19], v76, s[8:11], s68 offen sc1
  s_waitcnt lgkmcnt(4)
  v_smfmac_f32_16x16x64_bf16 v[24:27], v[4:7], a[56:63], v74
  v_smfmac_f32_16x16x64_bf16 v[28:31], v[4:7], v[192:199], v74
  v_smfmac_f32_16x16x64_bf16 v[32:35], v[4:7], v[200:207], v74
  v_smfmac_f32_16x16x64_bf16 v[32:35], v[0:3], v[60:67], v74
  v_smfmac_f32_16x16x64_bf16 v[20:23], v[8:11], a[64:71], v74
  ds_read_b128 v[60:63], v75 offset:24576
  ds_read_b128 v[64:67], v75 offset:25600
  v_smfmac_f32_16x16x64_bf16 v[24:27], v[8:11], a[72:79], v74
  v_smfmac_f32_16x16x64_bf16 v[28:31], v[8:11], v[208:215], v74
  v_smfmac_f32_16x16x64_bf16 v[20:23], v[12:15], a[80:87], v74
  v_smfmac_f32_16x16x64_bf16 v[24:27], v[12:15], a[88:95], v74
  v_smfmac_f32_16x16x64_bf16 v[28:31], v[12:15], v[224:231], v74
  v_smfmac_f32_16x16x64_bf16 v[32:35], v[12:15], v[232:239], v74
  v_smfmac_f32_16x16x64_bf16 v[32:35], v[8:11], v[216:223], v74
  s_waitcnt vmcnt(1)
  s_barrier
Cs2_lastr:
  ds_read_b128 v[12:15], v76 offset:8704
  ds_read_b128 v[4:7], v76 offset:9728
  ds_read_b128 v[16:19], v76 offset:10752
  ds_read_b128 v[0:3], v76 offset:11776
  ds_read_b128 v[8:11], v76 offset:12800
  s_waitcnt lgkmcnt(1)
  v_max3_u32 v72, v0, v1, v2
  v_max3_u32 v72, v72, v3, v4
  v_max3_u32 v72, v72, v5, v6
  s_waitcnt lgkmcnt(0)
  v_max3_u32 v72, v72, v7, v8
  v_max3_u32 v72, v72, v9, v10
  v_max3_u32 v72, v72, v11, v12
  v_max3_u32 v72, v72, v13, v14
  v_max3_u32 v72, v72, v15, v16
  v_max3_u32 v72, v72, v17, v18
  v_max_u32 v72, v72, v19
  v_cmp_eq_u32 vcc, -1, v72
  s_cbranch_vccnz Cs2_lastp
Cs2_lastg:
  v_smfmac_f32_16x16x64_bf16 v[28:31], v[12:15], v[44:51], v74
  ds_read_b128 v[44:47], v75 offset:26624
  ds_read_b128 v[48:51], v75 offset:27648
  v_smfmac_f32_16x16x64_bf16 v[32:35], v[12:15], v[36:43], v74
  v_smfmac_f32_16x16x64_bf16 v[28:31], v[4:7], v[60:67], v74
  v_smfmac_f32_16x16x64_bf16 v[28:31], v[16:19], v[240:247], v74
  v_smfmac_f32_16x16x64_bf16 v[28:31], v[0:3], a[0:7], v74
  v_smfmac_f32_16x16x64_bf16 v[28:31], v[8:11], a[16:23], v74
  v_smfmac_f32_16x16x64_bf16 v[32:35], v[16:19], v[248:255], v74
  v_smfmac_f32_16x16x64_bf16 v[32:35], v[0:3], a[8:15], v74
  s_waitcnt lgkmcnt(0)
  v_smfmac_f32_16x16x64_bf16 v[32:35], v[8:11], a[24:31], v74
  v_smfmac_f32_16x16x64_bf16 v[32:35], v[4:7], v[44:51], v74
  v_smfmac_f32_16x16x64_bf16 v[20:23], v[12:15], a[96:103], v74
  v_smfmac_f32_16x16x64_bf16 v[20:23], v[4:7], a[112:119], v74
  v_add_f32 v28, v28, v30
  v_add_f32 v32, v32, v34
  v_cvt_pk_bf16_f32 v30, v28, v32
  v_smfmac_f32_16x16x64_bf16 v[20:23], v[16:19], a[128:135], v74
  ds_write_b32 v79, v30 offset:256
  v_add_f32 v29, v29, v31
  v_add_f32 v33, v33, v35
  v_cvt_pk_bf16_f32 v31, v29, v33
  v_smfmac_f32_16x16x64_bf16 v[20:23], v[0:3], a[144:151], v74
  ds_write_b32 v79, v31 offset:832
  v_smfmac_f32_16x16x64_bf16 v[20:23], v[8:11], a[160:167], v74
  v_smfmac_f32_16x16x64_bf16 v[24:27], v[12:15], a[104:111], v74
  v_smfmac_f32_16x16x64_bf16 v[24:27], v[4:7], a[120:127], v74
  v_smfmac_f32_16x16x64_bf16 v[24:27], v[16:19], a[136:143], v74
  s_waitcnt lgkmcnt(0)
  s_barrier
  ds_read_b64 v[52:53], v77 offset:384
  v_add_f32 v20, v20, v22
  v_smfmac_f32_16x16x64_bf16 v[24:27], v[0:3], a[152:159], v74
  v_add_f32 v21, v21, v23
  v_smfmac_f32_16x16x64_bf16 v[24:27], v[8:11], a[168:175], v74
  v_cvt_pk_bf16_f32 v54, v20, v21
  s_add_u32 s68, s68, 655360
  s_nop 3
  v_add_f32 v24, v24, v26
  v_add_f32 v25, v25, v27
  v_cvt_pk_bf16_f32 v55, v24, v25
  s_waitcnt lgkmcnt(0)
  buffer_store_dwordx4 v[52:55], v76, s[8:11], s68 offen sc1
  s_branch Cs2_done
Cs2_lastp:
  s_add_u32 s72, s72, 2
  s_cmp_ge_u32 s72, 131072
  s_cbranch_scc1 Cs2_lastg
  s_barrier
  s_waitcnt vmcnt(0)
  s_barrier
  s_branch Cs2_lastr
Cs2_done:
  s_branch L_cexit
L_w7:
  v_mov_b64 v[20:21], 0
  v_mov_b64 v[22:23], 0
  v_mov_b64 v[24:25], 0
  v_mov_b64 v[26:27], 0
  v_mov_b64 v[28:29], 0
  v_mov_b64 v[30:31], 0
  v_mov_b64 v[32:33], 0
  v_mov_b64 v[34:35], 0
  s_mov_b32 s78, 0x3f803f80
  s_mov_b32 s79, s78
  s_mov_b32 s65, 360448
  s_mov_b32 m0, 15872
  s_lshl_b32 s71, s53, 2
  s_add_u32 s71, s71, 128
  s_movk_i32 s56, 0x1000
  v_lshlrev_b32 v73, 2, v76
  v_mov_b32 v72, 0
  s_mov_b64 s[16:17], s[8:9]
  s_mov_b32 s18, 268435456
  s_mov_b32 s19, 0x20000
  s_getpc_b64 s[20:21]
Cs3_pc:
  s_add_u32 s20, s20, (Cs3_last - Cs3_pc)
  s_addc_u32 s21, s21, 0
  v_mov_b32 v68, 14880
  buffer_load_dwordx4 v[52:55], v76, s[8:11], s59 offen offset:0 sc1
  buffer_load_dwordx4 v[56:59], v76, s[8:11], s59 offen offset:1024 sc1
  ds_read_b128 v[60:63], v76 offset:28672
  ds_read_b128 v[64:67], v76 offset:29696
  ds_read_b128 v[44:47], v76 offset:30720
  ds_read_b128 v[48:51], v76 offset:31744
  ds_read_b128 v[36:39], v76 offset:45056
  ds_read_b128 v[40:43], v76 offset:46080
  ds_read_b128 v[0:3], v76 offset:4608
  ds_read_b128 v[4:7], v76 offset:5632
  ds_read_b128 v[8:11], v76 offset:6656
  ds_read_b128 v[12:15], v76 offset:7680
  s_waitcnt lgkmcnt(0)
  s_cmp_eq_u32 s66, 1
  s_branch Cs3_top2
.p2align 6
Cs3_h2:
  v_lshlrev_b32 v73, 2, v76
  s_mov_b32 m0, 8704
  s_add_u32 s55, s65, 4096
  buffer_load_dwordx4 v[4:7], v76, s[8:11], s65 offen offset:1024 sc1
  s_waitcnt vmcnt(6)
  ds_read_b128 v[60:63], v76 offset:28672
  ds_read_b128 v[64:67], v76 offset:29696
  ds_read_b128 v[44:47], v76 offset:30720
  ds_read_b128 v[48:51], v76 offset:31744
  ds_read_b128 v[36:39], v76 offset:45056
  ds_read_b128 v[40:43], v76 offset:46080
  buffer_load_dwordx4 v[52:55], v76, s[8:11], s59 offen offset:0 sc1
  buffer_load_dwordx4 v[56:59], v76, s[8:11], s59 offen offset:1024 sc1
  s_waitcnt vmcnt(7)
  v_max3_u32 v72, v4, v5, v6
  v_max_u32 v72, v72, v7
  ds_write_b128 v76, v[4:7] offset:5632
  v_cmp_eq_u32 vcc, -1, v72
  s_cbranch_vccnz Cs3_h2r
Cs3_h2w:
  buffer_load_dwordx4 v76, s[8:11], s55 offen offset:0 sc1 lds
  buffer_load_dwordx4 v76, s[8:11], s55 offen offset:1024 sc1 lds
  s_cmp_eq_u32 s66, 63
  s_waitcnt lgkmcnt(0)
  s_barrier
  ds_read_b128 v[0:3], v76 offset:4608
Cs3_top2:
  v_smfmac_f32_16x16x64_bf16 v[20:23], v[4:7], v[80:87], v74
  s_cbranch_scc1 Cs3_last
  v_smfmac_f32_16x16x64_bf16 v[24:27], v[4:7], v[88:95], v74
  ds_read_b128 v[8:11], v76 offset:6656
  v_smfmac_f32_16x16x64_bf16 v[28:31], v[4:7], v[192:199], v74
  ds_read_b128 v[12:15], v76 offset:7680
  v_smfmac_f32_16x16x64_bf16 v[32:35], v[4:7], v[200:207], v74
  s_mov_b32 m0, 15872
  s_waitcnt lgkmcnt(2)
  v_smfmac_f32_16x16x64_bf16 v[24:27], v[0:3], v[44:51], v74
  buffer_load_dwordx4 v[44:47], v76, s[8:11], s58 offen offset:0 sc1
  v_smfmac_f32_16x16x64_bf16 v[20:23], v[0:3], v[60:67], v74
  buffer_load_dwordx4 v[48:51], v76, s[8:11], s58 offen offset:1024 sc1
  ds_read_b128 v[60:63], v76 offset:47104
  v_smfmac_f32_16x16x64_bf16 v[28:31], v[0:3], v[36:43], v74
  ds_read_b128 v[64:67], v76 offset:48128
  s_waitcnt lgkmcnt(3)
  v_smfmac_f32_16x16x64_bf16 v[20:23], v[8:11], v[96:103], v74
  ds_read_b128 v[36:39], v76 offset:61440
  v_smfmac_f32_16x16x64_bf16 v[24:27], v[8:11], v[104:111], v74
  ds_read_b128 v[40:43], v76 offset:62464
  s_waitcnt lgkmcnt(4)
  v_smfmac_f32_16x16x64_bf16 v[28:31], v[8:11], v[208:215], v74
  buffer_store_dwordx4 v[16:19], v76, s[8:11], s68 offen sc1
  s_waitcnt vmcnt(3)
  v_smfmac_f32_16x16x64_bf16 v[32:35], v[8:11], v[216:223], v74
  s_barrier
  s_waitcnt lgkmcnt(2)
  v_smfmac_f32_16x16x64_bf16 v[32:35], v[0:3], v[60:67], v74
  buffer_load_dword v73, s[16:19], s70 offen lds
  ds_read_b128 v[4:7], v76 offset:8704
  v_smfmac_f32_16x16x64_bf16 v[20:23], v[12:15], v[112:119], v74
  ds_read_b128 v[60:63], v76 offset:63488
  ds_read_b128 v[64:67], v76 offset:64512
  v_smfmac_f32_16x16x64_bf16 v[24:27], v[12:15], v[120:127], v74
  ds_read_b128 v[8:11], v76 offset:9728
  v_smfmac_f32_16x16x64_bf16 v[28:31], v[12:15], v[224:231], v74
  v_smfmac_f32_16x16x64_bf16 v[32:35], v[12:15], v[232:239], v74
  s_waitcnt lgkmcnt(3)
  v_smfmac_f32_16x16x64_bf16 v[28:31], v[4:7], v[36:43], v74
  ds_read_b128 v[36:39], v75 offset:12288
  ds_read_b128 v[40:43], v75 offset:13312
  s_waitcnt lgkmcnt(3)
  v_smfmac_f32_16x16x64_bf16 v[32:35], v[4:7], v[60:67], v74
  s_barrier
  ds_read_b128 v[16:19], v76 offset:10752
  v_smfmac_f32_16x16x64_bf16 v[20:23], v[4:7], v[128:135], v74
  ds_read_b128 v[60:63], v75 offset:14336
  ds_read_b128 v[64:67], v75 offset:15360
  v_smfmac_f32_16x16x64_bf16 v[24:27], v[4:7], v[136:143], v74
  ds_read_b128 v[0:3], v76 offset:11776
  s_waitcnt lgkmcnt(6)
  v_smfmac_f32_16x16x64_bf16 v[20:23], v[8:11], v[144:151], v74
  ds_read_b128 v[12:15], v76 offset:12800
  v_smfmac_f32_16x16x64_bf16 v[24:27], v[8:11], v[152:159], v74
  s_waitcnt lgkmcnt(4)
  v_smfmac_f32_16x16x64_bf16 v[20:23], v[16:19], v[36:43], v74
  ds_read_b128 v[36:39], v75 offset:28672
  s_waitcnt lgkmcnt(3)
  v_smfmac_f32_16x16x64_bf16 v[24:27], v[16:19], v[60:67], v74
  ds_read_b128 v[40:43], v75 offset:29696
  s_waitcnt lgkmcnt(3)
  v_smfmac_f32_16x16x64_bf16 v[20:23], v[0:3], v[160:167], v74
  ds_read_b128 v[60:63], v75 offset:30720
  s_waitcnt lgkmcnt(3)
  v_smfmac_f32_16x16x64_bf16 v[20:23], v[12:15], v[176:183], v74
  ds_read_b128 v[64:67], v75 offset:31744
  v_smfmac_f32_16x16x64_bf16 v[24:27], v[0:3], v[168:175], v74
  v_mov_b64 v[70:71], s[78:79]
  v_smfmac_f32_16x16x64_bf16 v[24:27], v[12:15], v[184:191], v74
  s_waitcnt lgkmcnt(2)
  v_add_f32 v20, v20, v22
  v_smfmac_f32_16x16x64_bf16 v[28:31], v[8:11], v[36:43], v74
  ds_read_b128 v[36:39], v68
  s_waitcnt lgkmcnt(1)
  v_add_f32 v21, v21, v23
  v_smfmac_f32_16x16x64_bf16 v[32:35], v[8:11], v[60:67], v74
  ds_read_b128 v[40:43], v68
  v_add_f32 v24, v24, v26
  v_smfmac_f32_16x16x64_bf16 v[28:31], v[16:19], v[240:247], v74
  v_cvt_pk_bf16_f32 v22, v20, v24
  v_smfmac_f32_16x16x64_bf16 v[28:31], v[0:3], a[0:7], v74
  ds_write_b32 v79, v22 offset:0
  v_add_f32 v25, v25, v27
  v_cvt_pk_bf16_f32 v23, v21, v25
  v_smfmac_f32_16x16x64_bf16 v[28:31], v[12:15], a[16:23], v74
  ds_write_b32 v79, v23 offset:576
  v_cmp_u_f32 vcc, v20, v21
  v_smfmac_f32_16x16x64_bf16 v[32:35], v[16:19], v[248:255], v74
  v_mov_b64 v[68:69], s[78:79]
  v_smfmac_f32_16x16x64_bf16 v[32:35], v[0:3], a[8:15], v74
  v_add_f32 v28, v28, v30
  v_add_f32 v29, v29, v31
  v_smfmac_f32_16x16x64_bf16 v[32:35], v[12:15], a[24:31], v74
  s_cbranch_vccnz Cs3_rec
Cs3_recok:
  s_waitcnt lgkmcnt(3)
  v_smfmac_f32_16x16x64_bf16 v[36:39], v[16:19], a[128:135], v74
  s_waitcnt lgkmcnt(0)
  s_barrier
  ds_read_b128 v[60:63], v77
  v_smfmac_f32_16x16x64_bf16 v[40:43], v[16:19], a[136:143], v74
  ds_read_b128 v[64:67], v77 offset:128
  v_add_f32 v32, v32, v34
  v_cvt_pk_bf16_f32 v30, v28, v32
  v_smfmac_f32_16x16x64_bf16 v[36:39], v[0:3], a[144:151], v74
  ds_write_b32 v79, v30 offset:256
  v_add_f32 v33, v33, v35
  v_cvt_pk_bf16_f32 v31, v29, v33
  v_smfmac_f32_16x16x64_bf16 v[40:43], v[0:3], a[152:159], v74
  ds_write_b32 v79, v31 offset:832
  v_xor_b32 v75, 0x8000, v75
  v_smfmac_f32_16x16x64_bf16 v[36:39], v[4:7], a[96:103], v74
  ds_read_b128 v[0:3], v76 offset:4608
  v_mov_b32 v29, 0
  v_smfmac_f32_16x16x64_bf16 v[40:43], v[4:7], a[104:111], v74
  s_waitcnt vmcnt(2) lgkmcnt(3)
  v_mov_b32 v30, 0
  v_mfma_f32_16x16x32_bf16 v[44:47], v[44:47], v[60:63], 0
  ds_read_b128 v[4:7], v76 offset:5632
  s_waitcnt lgkmcnt(2)
  v_mfma_f32_16x16x32_bf16 v[44:47], v[48:51], v[64:67], v[44:47]
  s_barrier
  v_smfmac_f32_16x16x64_bf16 v[36:39], v[8:11], a[112:119], v74
  ds_read_b128 v[20:23], v77 offset:256
  ds_read_b128 v[24:27], v77 offset:384
  v_smfmac_f32_16x16x64_bf16 v[40:43], v[8:11], a[120:127], v74
  ds_read_b128 v[8:11], v76 offset:6656
  v_add_f32_dpp v72, v46, v44 quad_perm:[2,3,0,1] row_mask:0xf bank_mask:0xf
  v_add_f32_dpp v73, v47, v45 quad_perm:[2,3,0,1] row_mask:0xf bank_mask:0xf
  v_smfmac_f32_16x16x64_bf16 v[36:39], v[12:15], a[160:167], v74
  s_waitcnt lgkmcnt(4)
  v_exp_f32_dpp v72, v72 quad_perm:[0,1,0,1] row_mask:0xf bank_mask:0xf
  v_smfmac_f32_16x16x64_bf16 v[40:43], v[12:15], a[168:175], v74
  ds_read_b128 v[12:15], v76 offset:7680
  v_exp_f32_dpp v73, v73 quad_perm:[0,1,0,1] row_mask:0xf bank_mask:0xf
  v_smfmac_f32_16x16x64_bf16 v[36:39], v[0:3], a[32:39], v74
  s_waitcnt lgkmcnt(2)
  v_cvt_pk_bf16_f32 v72, v72, v73
  v_mfma_f32_16x16x32_bf16 v[20:23], v[20:23], v[60:63], 0
  ds_write_b32 v78, v72 offset:524
  v_mov_b64 v[16:17], 0
  v_mfma_f32_16x16x32_bf16 v[20:23], v[24:27], v[64:67], v[20:23]
  ds_read_b128 v[44:47], v75 offset:28672
  v_mov_b64 v[18:19], 0
  v_smfmac_f32_16x16x64_bf16 v[40:43], v[0:3], a[40:47], v74
  ds_read_b128 v[48:51], v75 offset:29696
  s_waitcnt lgkmcnt(4)
  v_smfmac_f32_16x16x64_bf16 v[36:39], v[4:7], a[48:55], v74
  v_add_f32_dpp v24, v22, v20 quad_perm:[2,3,0,1] row_mask:0xf bank_mask:0xf
  v_add_f32_dpp v25, v23, v21 quad_perm:[2,3,0,1] row_mask:0xf bank_mask:0xf
  v_smfmac_f32_16x16x64_bf16 v[36:39], v[8:11], a[64:71], v74
  s_waitcnt lgkmcnt(2)
  s_barrier
  ds_read_b128 v[32:35], v78 offset:512
  v_smfmac_f32_16x16x64_bf16 v[36:39], v[12:15], a[80:87], v74
  ds_read_b128 v[60:63], v75 offset:30720
  v_mul_f32 v24, s69, v24
  v_smfmac_f32_16x16x64_bf16 v[40:43], v[4:7], a[56:63], v74
  ds_read_b128 v[64:67], v75 offset:31744
  v_mul_f32 v25, s69, v25
  v_smfmac_f32_16x16x64_bf16 v[40:43], v[8:11], a[72:79], v74
  v_exp_f32_dpp v24, v24 quad_perm:[0,1,0,1] row_mask:0xf bank_mask:0xf
  v_smfmac_f32_16x16x64_bf16 v[40:43], v[12:15], a[88:95], v74
  s_waitcnt lgkmcnt(2)
  v_exp_f32_dpp v25, v25 quad_perm:[0,1,0,1] row_mask:0xf bank_mask:0xf
  v_mfma_f32_16x16x32_bf16 v[8:11], v[32:35], v[68:71], 0
  v_add_f32 v36, v36, v38
  v_add_f32 v37, v37, v39
  v_mfma_f32_16x16x32_bf16 v[0:3], v[32:35], v[52:55], 0
  v_add_f32 v40, v40, v42
  v_add_f32 v41, v41, v43
  v_mfma_f32_16x16x32_bf16 v[4:7], v[32:35], v[56:59], 0
  v_cvt_pk_bf16_f32 v28, v24, v25
  v_cvt_pk_bf16_f32 v72, v36, v37
  v_cvt_pk_bf16_f32 v73, v40, v41
  v_mfma_f32_16x16x16_bf16 v[8:11], v[28:29], v[68:69], v[8:11]
  v_cvt_pk_bf16_f32 v31, v24, v25
  v_mov_b64 v[20:21], 0
  v_mfma_f32_16x16x16_bf16 v[0:3], v[28:29], v[72:73], v[0:3]
  ds_read_b128 v[68:71], v76 offset:13824
  v_mov_b64 v[22:23], 0
  v_mfma_f32_16x16x16_bf16 v[4:7], v[30:31], v[72:73], v[4:7]
  v_rcp_f32 v10, v8
  v_rcp_f32 v11, v9
  v_mul_f32 v0, v10, v0
  v_mul_f32 v1, v11, v1
  s_nop 0
  v_mul_f32 v4, v10, v4
  v_mul_f32 v5, v11, v5
  v_cvt_pk_bf16_f32 v2, v0, v4
  ds_write_b32 v79, v2 offset:8704
  v_cvt_pk_bf16_f32 v3, v1, v5
  ds_write_b32 v79, v3 offset:9280
  v_max3_f32 v8, v8, v9, v10
  v_max_f32 v8, v8, v11
  v_cmp_le_f32 vcc, 1317011456, v8
  v_mov_b64 v[24:25], 0
  v_mov_b64 v[26:27], 0
  s_cbranch_vccnz Cs3_mx
Cs3_mxok:
  s_waitcnt lgkmcnt(0)
  s_barrier
  ds_read_b128 v[0:3], v78 offset:8704
  ds_read_b128 v[4:7], v78 offset:8768
  ds_read_b128 v[8:11], v78 offset:8832
  ds_read_b128 v[12:15], v78 offset:8896
  s_waitcnt lgkmcnt(3)
  v_smfmac_f32_16x16x64_bf16 v[16:19], v[0:3], v[44:51], v74
  ds_read_b128 v[52:55], v75 offset:45056
  s_waitcnt lgkmcnt(3)
  v_smfmac_f32_16x16x64_bf16 v[16:19], v[4:7], v[60:67], v74
  ds_read_b128 v[56:59], v75 offset:46080
  s_waitcnt lgkmcnt(3)
  v_smfmac_f32_16x16x64_bf16 v[16:19], v[8:11], a[176:183], v74
  ds_read_b128 v[36:39], v75 offset:47104
  s_waitcnt lgkmcnt(3)
  v_smfmac_f32_16x16x64_bf16 v[16:19], v[12:15], a[184:191], v74
  ds_read_b128 v[40:43], v75 offset:48128
  ds_read_b128 v[44:47], v75 offset:61440
  v_smfmac_f32_16x16x64_bf16 v[20:23], v[0:3], a[192:199], v74
  ds_read_b128 v[48:51], v75 offset:62464
  ds_read_b128 v[60:63], v75 offset:63488
  v_smfmac_f32_16x16x64_bf16 v[20:23], v[4:7], a[200:207], v74
  ds_read_b128 v[64:67], v75 offset:64512
  s_waitcnt lgkmcnt(6)
  v_cvt_pk_bf16_f32 v16, v16, v17
  v_cvt_pk_bf16_f32 v17, v18, v19
  v_bfi_b32 v16, 1, s72, v16
  v_smfmac_f32_16x16x64_bf16 v[20:23], v[8:11], v[52:59], v74
  buffer_store_dwordx2 v[16:17], v68, s[8:11], s73 offen sc1
  s_waitcnt lgkmcnt(4)
  v_smfmac_f32_16x16x64_bf16 v[20:23], v[12:15], v[36:43], v74
  ds_read_b128 v[52:55], v75 offset:8192
  v_mov_b64 v[32:33], 0
  v_smfmac_f32_16x16x64_bf16 v[24:27], v[0:3], a[208:215], v74
  ds_read_b128 v[56:59], v75 offset:9216
  v_mov_b64 v[34:35], 0
  v_smfmac_f32_16x16x64_bf16 v[24:27], v[4:7], a[216:223], v74
  ds_read_b128 v[36:39], v75 offset:10240
  s_waitcnt lgkmcnt(5)
  v_cvt_pk_bf16_f32 v20, v20, v21
  v_cvt_pk_bf16_f32 v21, v22, v23
  v_bfi_b32 v20, 1, s72, v20
  v_smfmac_f32_16x16x64_bf16 v[24:27], v[8:11], v[44:51], v74
  buffer_store_dwordx2 v[20:21], v68, s[8:11], s74 offen sc1
  s_waitcnt lgkmcnt(3)
  v_smfmac_f32_16x16x64_bf16 v[24:27], v[12:15], v[60:67], v74
  ds_read_b128 v[40:43], v75 offset:11264
  v_mov_b64 v[28:29], 0
  v_smfmac_f32_16x16x64_bf16 v[32:35], v[0:3], a[224:231], v74
  ds_read_b128 v[44:47], v75 offset:12288
  ds_read_b128 v[48:51], v75 offset:13312
  v_smfmac_f32_16x16x64_bf16 v[32:35], v[4:7], a[232:239], v74
  ds_read_b128 v[60:63], v75 offset:14336
  v_cvt_pk_bf16_f32 v24, v24, v25
  v_cvt_pk_bf16_f32 v25, v26, v27
  v_bfi_b32 v24, 1, s72, v24
  v_smfmac_f32_16x16x64_bf16 v[32:35], v[8:11], a[240:247], v74
  buffer_store_dwordx2 v[24:25], v68, s[8:11], s75 offen sc1
  v_mov_b64 v[30:31], 0
  v_smfmac_f32_16x16x64_bf16 v[32:35], v[12:15], a[248:255], v74
  ds_read_b128 v[64:67], v75 offset:15360
  s_waitcnt lgkmcnt(6)
  v_smfmac_f32_16x16x64_bf16 v[28:31], v[0:3], v[52:59], v74
  s_waitcnt lgkmcnt(4)
  v_smfmac_f32_16x16x64_bf16 v[28:31], v[4:7], v[36:43], v74
  s_waitcnt lgkmcnt(2)
  v_cvt_pk_bf16_f32 v32, v32, v33
  v_cvt_pk_bf16_f32 v33, v34, v35
  v_bfi_b32 v32, 1, s72, v32
  v_smfmac_f32_16x16x64_bf16 v[28:31], v[8:11], v[44:51], v74
  buffer_store_dwordx2 v[32:33], v68, s[8:11], s76 offen sc1
  s_waitcnt lgkmcnt(0)
  v_smfmac_f32_16x16x64_bf16 v[28:31], v[12:15], v[60:67], v74
  ds_read_b128 v[52:55], v76 offset:14848
  ds_read_b64 v[16:17], v77 offset:392
  v_mov_b64 v[18:19], v[72:73]
  v_xor_b32 v75, 0x8000, v75
  s_nop 3
  v_cvt_pk_bf16_f32 v28, v28, v29
  v_cvt_pk_bf16_f32 v29, v30, v31
  v_bfi_b32 v28, 1, s72, v28
  buffer_store_dwordx2 v[28:29], v68, s[8:11], s77 offen sc1
  v_mov_b64 v[20:21], 0
  v_mov_b64 v[22:23], 0
  v_mov_b64 v[24:25], 0
  v_mov_b64 v[26:27], 0
  v_mov_b64 v[28:29], 0
  v_mov_b64 v[30:31], 0
  v_mov_b64 v[32:33], 0
  v_mov_b64 v[34:35], 0
  v_mov_b32 v68, 14880
  s_add_u32 s58, s58, 655360
  s_add_u32 s59, s59, 655360
  s_add_u32 s70, s70, 655360
  s_add_u32 s68, s68, 655360
  s_add_u32 s66, s66, 1
  s_xor_b32 s64, s64, 16384
  s_xor_b32 s65, s65, 16384
  s_cmp_eq_u32 s66, 62
  s_cselect_b64 s[16:17], s[20:21], s[16:17]
  s_cselect_b32 s18, (Cs3_done - Cs3_last), s18
  s_cselect_b32 s70, 0, s70
  s_cmp_eq_u32 s66, 63
  s_cselect_b32 s59, 268435456, s59
  s_nop 15
  s_nop 15
  s_nop 15
  s_nop 3
  buffer_load_dwordx4 v[0:3], v76, s[8:11], s60 offen offset:0 sc1
  buffer_load_dwordx4 v[4:7], v76, s[8:11], s60 offen offset:1024 sc1
  buffer_load_dwordx4 v[8:11], v76, s[8:11], s61 offen offset:0 sc1
  buffer_load_dwordx4 v[12:15], v76, s[8:11], s61 offen offset:1024 sc1
  s_nop 15
  s_nop 11
  buffer_load_dwordx4 v[44:47], v76, s[8:11], s60 offen offset:0 sc1
  buffer_load_dwordx4 v[48:51], v76, s[8:11], s60 offen offset:1024 sc1
  buffer_load_dwordx4 v[60:63], v76, s[8:11], s61 offen offset:0 sc1
  buffer_load_dwordx4 v[64:67], v76, s[8:11], s61 offen offset:1024 sc1
  s_waitcnt lgkmcnt(0)
  s_waitcnt vmcnt(7)
  v_mfma_f32_16x16x32_bf16 v[56:59], v[52:55], v[0:3], 0
  v_bitop3_b32 v72, v0, v2, s72 bitop3:0x7e
  s_waitcnt vmcnt(6)
  v_mfma_f32_16x16x32_bf16 v[56:59], v[52:55], v[4:7], v[56:59]
  v_bitop3_b32 v73, v4, v6, s72 bitop3:0x7e
  v_or_b32 v72, v72, v73
  s_waitcnt vmcnt(5)
  v_mfma_f32_16x16x32_bf16 v[36:39], v[52:55], v[8:11], 0
  v_bitop3_b32 v73, v8, v10, s72 bitop3:0x7e
  v_or_b32 v72, v72, v73
  s_waitcnt vmcnt(4)
  v_mfma_f32_16x16x32_bf16 v[36:39], v[52:55], v[12:15], v[36:39]
  v_bitop3_b32 v73, v12, v14, s72 bitop3:0x7e
  v_bitop3_b32 v72, v72, v73, 1 bitop3:0xa8
  v_cmp_ne_u32 vcc, 0, v72
  s_cbranch_vccnz Cs3_h1r
  buffer_load_dwordx4 v[4:7], v76, s[8:11], s65 offen offset:1024 sc1
  v_add_f32_dpp v56, v56, v56 row_ror:4 row_mask:0xf bank_mask:0xf
  v_add_f32_dpp v57, v57, v57 row_ror:4 row_mask:0xf bank_mask:0xf
  v_add_f32_dpp v36, v36, v36 row_ror:4 row_mask:0xf bank_mask:0xf
  v_add_f32_dpp v37, v37, v37 row_ror:4 row_mask:0xf bank_mask:0xf
  v_add_f32_dpp v56, v56, v56 row_ror:8 row_mask:0xf bank_mask:0xf
  v_add_f32_dpp v57, v57, v57 row_ror:8 row_mask:0xf bank_mask:0xf
  v_add_f32_dpp v36, v36, v36 row_ror:8 row_mask:0xf bank_mask:0xf
  v_add_f32_dpp v37, v37, v37 row_ror:8 row_mask:0xf bank_mask:0xf
  v_cvt_pk_bf16_f32 v56, v56, v57
  buffer_store_dword v56, v69, s[8:11], s62 offen sc1
  v_cvt_pk_bf16_f32 v36, v36, v37
  buffer_store_dword v36, v70, s[8:11], s63 offen sc1
  s_xor_b32 s62, s62, 16384
  buffer_store_dword v71, v69, s[8:11], s62 offen sc1
  s_xor_b32 s63, s63, 16384
  buffer_store_dword v71, v70, s[8:11], s63 offen sc1
  s_xor_b32 s72, s72, 1
  s_branch Cs3_h2
Cs3_h1r:
  s_mov_b64 exec, vcc
  buffer_load_dwordx4 v[0:3], v76, s[8:11], s60 offen offset:0 sc1
  buffer_load_dwordx4 v[4:7], v76, s[8:11], s60 offen offset:1024 sc1
  buffer_load_dwordx4 v[8:11], v76, s[8:11], s61 offen offset:0 sc1
  buffer_load_dwordx4 v[12:15], v76, s[8:11], s61 offen offset:1024 sc1
  s_mov_b64 exec, -1
  s_add_u32 s67, s67, 1
  s_waitcnt vmcnt(7)
  v_mfma_f32_16x16x32_bf16 v[56:59], v[52:55], v[44:47], 0
  v_bitop3_b32 v72, v44, v46, s72 bitop3:0x7e
  s_waitcnt vmcnt(6)
  v_mfma_f32_16x16x32_bf16 v[56:59], v[52:55], v[48:51], v[56:59]
  v_bitop3_b32 v73, v48, v50, s72 bitop3:0x7e
  v_or_b32 v72, v72, v73
  s_waitcnt vmcnt(5)
  v_mfma_f32_16x16x32_bf16 v[36:39], v[52:55], v[60:63], 0
  v_bitop3_b32 v73, v60, v62, s72 bitop3:0x7e
  v_or_b32 v72, v72, v73
  s_waitcnt vmcnt(4)
  v_mfma_f32_16x16x32_bf16 v[36:39], v[52:55], v[64:67], v[36:39]
  v_bitop3_b32 v73, v64, v66, s72 bitop3:0x7e
  v_bitop3_b32 v72, v72, v73, 1 bitop3:0xa8
  v_cmp_ne_u32 vcc, 0, v72
  s_cbranch_vccz Cs3_h1p
  s_mov_b64 exec, vcc
  buffer_load_dwordx4 v[44:47], v76, s[8:11], s60 offen offset:0 sc1
  buffer_load_dwordx4 v[48:51], v76, s[8:11], s60 offen offset:1024 sc1
  buffer_load_dwordx4 v[60:63], v76, s[8:11], s61 offen offset:0 sc1
  buffer_load_dwordx4 v[64:67], v76, s[8:11], s61 offen offset:1024 sc1
  s_mov_b64 exec, -1
  s_add_u32 s67, s67, 1
  s_waitcnt vmcnt(7)
  v_mfma_f32_16x16x32_bf16 v[56:59], v[52:55], v[0:3], 0
  v_bitop3_b32 v72, v0, v2, s72 bitop3:0x7e
  s_waitcnt vmcnt(6)
  v_mfma_f32_16x16x32_bf16 v[56:59], v[52:55], v[4:7], v[56:59]
  v_bitop3_b32 v73, v4, v6, s72 bitop3:0x7e
  v_or_b32 v72, v72, v73
  s_waitcnt vmcnt(5)
  v_mfma_f32_16x16x32_bf16 v[36:39], v[52:55], v[8:11], 0
  v_bitop3_b32 v73, v8, v10, s72 bitop3:0x7e
  v_or_b32 v72, v72, v73
  s_waitcnt vmcnt(4)
  v_mfma_f32_16x16x32_bf16 v[36:39], v[52:55], v[12:15], v[36:39]
  v_bitop3_b32 v73, v12, v14, s72 bitop3:0x7e
  v_bitop3_b32 v72, v72, v73, 1 bitop3:0xa8
  v_cmp_ne_u32 vcc, 0, v72
  s_cbranch_vccz Cs3_h1p
Cs3_h1s:
  s_mov_b64 exec, vcc
  buffer_load_dwordx4 v[0:3], v76, s[8:11], s60 offen offset:0 sc1
  buffer_load_dwordx4 v[4:7], v76, s[8:11], s60 offen offset:1024 sc1
  buffer_load_dwordx4 v[8:11], v76, s[8:11], s61 offen offset:0 sc1
  buffer_load_dwordx4 v[12:15], v76, s[8:11], s61 offen offset:1024 sc1
  s_mov_b64 exec, -1
  s_add_u32 s67, s67, 1
  s_waitcnt vmcnt(7)
  v_mfma_f32_16x16x32_bf16 v[56:59], v[52:55], v[44:47], 0
  v_bitop3_b32 v72, v44, v46, s72 bitop3:0x7e
  s_waitcnt vmcnt(6)
  v_mfma_f32_16x16x32_bf16 v[56:59], v[52:55], v[48:51], v[56:59]
  v_bitop3_b32 v73, v48, v50, s72 bitop3:0x7e
  v_or_b32 v72, v72, v73
  s_waitcnt vmcnt(5)
  v_mfma_f32_16x16x32_bf16 v[36:39], v[52:55], v[60:63], 0
  v_bitop3_b32 v73, v60, v62, s72 bitop3:0x7e
  v_or_b32 v72, v72, v73
  s_waitcnt vmcnt(4)
  v_mfma_f32_16x16x32_bf16 v[36:39], v[52:55], v[64:67], v[36:39]
  v_bitop3_b32 v73, v64, v66, s72 bitop3:0x7e
  v_bitop3_b32 v72, v72, v73, 1 bitop3:0xa8
  v_cmp_ne_u32 vcc, 0, v72
  s_cbranch_vccz Cs3_h1p
  s_mov_b64 exec, vcc
  buffer_load_dwordx4 v[44:47], v76, s[8:11], s60 offen offset:0 sc1
  buffer_load_dwordx4 v[48:51], v76, s[8:11], s60 offen offset:1024 sc1
  buffer_load_dwordx4 v[60:63], v76, s[8:11], s61 offen offset:0 sc1
  buffer_load_dwordx4 v[64:67], v76, s[8:11], s61 offen offset:1024 sc1
  s_mov_b64 exec, -1
  s_add_u32 s67, s67, 1
  s_waitcnt vmcnt(7)
  v_mfma_f32_16x16x32_bf16 v[56:59], v[52:55], v[0:3], 0
  v_bitop3_b32 v72, v0, v2, s72 bitop3:0x7e
  s_waitcnt vmcnt(6)
  v_mfma_f32_16x16x32_bf16 v[56:59], v[52:55], v[4:7], v[56:59]
  v_bitop3_b32 v73, v4, v6, s72 bitop3:0x7e
  v_or_b32 v72, v72, v73
  s_waitcnt vmcnt(5)
  v_mfma_f32_16x16x32_bf16 v[36:39], v[52:55], v[8:11], 0
  v_bitop3_b32 v73, v8, v10, s72 bitop3:0x7e
  v_or_b32 v72, v72, v73
  s_waitcnt vmcnt(4)
  v_mfma_f32_16x16x32_bf16 v[36:39], v[52:55], v[12:15], v[36:39]
  v_bitop3_b32 v73, v12, v14, s72 bitop3:0x7e
  v_bitop3_b32 v72, v72, v73, 1 bitop3:0xa8
  v_cmp_ne_u32 vcc, 0, v72
  s_cbranch_vccz Cs3_h1p
  s_cmp_lt_u32 s67, 131072
  s_cbranch_scc1 Cs3_h1s
Cs3_h1p:
  s_nop 2
  buffer_load_dwordx4 v[4:7], v76, s[8:11], s65 offen offset:1024 sc1
  v_add_f32_dpp v56, v56, v56 row_ror:4 row_mask:0xf bank_mask:0xf
  v_add_f32_dpp v57, v57, v57 row_ror:4 row_mask:0xf bank_mask:0xf
  v_add_f32_dpp v36, v36, v36 row_ror:4 row_mask:0xf bank_mask:0xf
  v_add_f32_dpp v37, v37, v37 row_ror:4 row_mask:0xf bank_mask:0xf
  v_add_f32_dpp v56, v56, v56 row_ror:8 row_mask:0xf bank_mask:0xf
  v_add_f32_dpp v57, v57, v57 row_ror:8 row_mask:0xf bank_mask:0xf
  v_add_f32_dpp v36, v36, v36 row_ror:8 row_mask:0xf bank_mask:0xf
  v_add_f32_dpp v37, v37, v37 row_ror:8 row_mask:0xf bank_mask:0xf
  v_cvt_pk_bf16_f32 v56, v56, v57
  buffer_store_dword v56, v69, s[8:11], s62 offen sc1
  v_cvt_pk_bf16_f32 v36, v36, v37
  buffer_store_dword v36, v70, s[8:11], s63 offen sc1
  s_xor_b32 s62, s62, 16384
  buffer_store_dword v71, v69, s[8:11], s62 offen sc1
  s_xor_b32 s63, s63, 16384
  buffer_store_dword v71, v70, s[8:11], s63 offen sc1
  s_xor_b32 s72, s72, 1
  s_branch Cs3_h2
Cs3_h2r:
  s_mov_b64 exec, vcc
  buffer_load_dwordx4 v[4:7], v76, s[8:11], s65 offen offset:1024 sc1
  s_mov_b64 exec, -1
  s_add_u32 s67, s67, 1
  s_waitcnt vmcnt(3)
  v_max3_u32 v72, v4, v5, v6
  v_max_u32 v72, v72, v7
  ds_write_b128 v76, v[4:7] offset:5632
  v_cmp_eq_u32 vcc, -1, v72
  s_cbranch_vccz Cs3_h2w
Cs3_h2s:
  s_mov_b64 exec, vcc
  buffer_load_dwordx4 v[4:7], v76, s[8:11], s65 offen offset:1024 sc1
  s_mov_b64 exec, -1
  s_add_u32 s67, s67, 1
  s_waitcnt vmcnt(1)
  v_max3_u32 v72, v4, v5, v6
  v_max_u32 v72, v72, v7
  ds_write_b128 v76, v[4:7] offset:5632
  v_cmp_eq_u32 vcc, -1, v72
  s_cbranch_vccz Cs3_h2w
  s_mov_b64 exec, vcc
  buffer_load_dwordx4 v[4:7], v76, s[8:11], s65 offen offset:1024 sc1
  s_mov_b64 exec, -1
  s_add_u32 s67, s67, 1
  s_waitcnt vmcnt(1)
  v_max3_u32 v72, v4, v5, v6
  v_max_u32 v72, v72, v7
  ds_write_b128 v76, v[4:7] offset:5632
  v_cmp_eq_u32 vcc, -1, v72
  s_cbranch_vccz Cs3_h2w
  s_mov_b64 exec, vcc
  buffer_load_dwordx4 v[4:7], v76, s[8:11], s65 offen offset:1024 sc1
  s_mov_b64 exec, -1
  s_add_u32 s67, s67, 1
  s_waitcnt vmcnt(1)
  v_max3_u32 v72, v4, v5, v6
  v_max_u32 v72, v72, v7
  ds_write_b128 v76, v[4:7] offset:5632
  v_cmp_eq_u32 vcc, -1, v72
  s_cbranch_vccz Cs3_h2w
  s_cmp_lt_u32 s67, 131072
  s_cbranch_scc1 Cs3_h2s
  s_branch Cs3_h2w
Cs3_rec:
  s_nop 7
  s_waitcnt vmcnt(0) lgkmcnt(0)
  v_max3_u32 v72, v0, v1, v2
  v_max3_u32 v72, v72, v3, v4
  v_max3_u32 v72, v72, v5, v6
  v_max3_u32 v72, v72, v7, v8
  v_max3_u32 v72, v72, v9, v10
  v_max3_u32 v72, v72, v11, v12
  v_max3_u32 v72, v72, v13, v14
  v_max3_u32 v72, v72, v15, v16
  v_max3_u32 v72, v72, v17, v18
  v_max_u32 v72, v72, v19
  v_cmp_eq_u32 vcc, -1, v72
  s_cbranch_vccz Cs3_recok
  s_barrier
Cs3_recp:
  buffer_load_dwordx4 v[0:3], v76, s[8:11], s64 offen offset:0 sc1
  buffer_load_dwordx4 v[4:7], v76, s[8:11], s64 offen offset:1024 sc1
  buffer_load_dwordx4 v[8:11], v76, s[8:11], s64 offen offset:2048 sc1
  s_add_u32 s67, s67, 1
  s_cmp_lt_u32 s67, 131072
  s_cselect_b32 s54, -2, -1
  s_waitcnt vmcnt(2)
  v_max3_u32 v72, v0, v1, v2
  s_waitcnt vmcnt(1)
  v_max3_u32 v72, v72, v3, v4
  v_max3_u32 v72, v72, v5, v6
  s_waitcnt vmcnt(0)
  v_max3_u32 v72, v72, v7, v8
  v_max3_u32 v72, v72, v9, v10
  v_max_u32 v72, v72, v11
  v_cmp_lt_u32 vcc, s54, v72
  s_cbranch_vccnz Cs3_recp
  ds_write_b128 v76, v[0:3] offset:10752
  ds_write_b128 v76, v[4:7] offset:11776
  ds_write_b128 v76, v[8:11] offset:12800
  v_mov_b64 v[20:21], 0
  v_mov_b64 v[22:23], 0
  v_mov_b64 v[24:25], 0
  v_mov_b64 v[26:27], 0
  v_mov_b64 v[28:29], 0
  v_mov_b64 v[30:31], 0
  v_mov_b64 v[32:33], 0
  v_mov_b64 v[34:35], 0
  s_waitcnt lgkmcnt(0)
  s_barrier
  ds_read_b128 v[0:3], v76 offset:4608
  ds_read_b128 v[60:63], v76 offset:28672
  ds_read_b128 v[64:67], v76 offset:29696
  s_waitcnt lgkmcnt(0)
  v_smfmac_f32_16x16x64_bf16 v[20:23], v[0:3], v[60:67], v74
  ds_read_b128 v[60:63], v76 offset:30720
  ds_read_b128 v[64:67], v76 offset:31744
  s_waitcnt lgkmcnt(0)
  v_smfmac_f32_16x16x64_bf16 v[24:27], v[0:3], v[60:67], v74
  ds_read_b128 v[60:63], v76 offset:45056
  ds_read_b128 v[64:67], v76 offset:46080
  s_waitcnt lgkmcnt(0)
  v_smfmac_f32_16x16x64_bf16 v[28:31], v[0:3], v[60:67], v74
  ds_read_b128 v[60:63], v76 offset:47104
  ds_read_b128 v[64:67], v76 offset:48128
  s_waitcnt lgkmcnt(0)
  v_smfmac_f32_16x16x64_bf16 v[32:35], v[0:3], v[60:67], v74
  ds_read_b128 v[4:7], v76 offset:5632
  s_waitcnt lgkmcnt(0)
  v_smfmac_f32_16x16x64_bf16 v[20:23], v[4:7], v[80:87], v74
  v_smfmac_f32_16x16x64_bf16 v[24:27], v[4:7], v[88:95], v74
  v_smfmac_f32_16x16x64_bf16 v[28:31], v[4:7], v[192:199], v74
  v_smfmac_f32_16x16x64_bf16 v[32:35], v[4:7], v[200:207], v74
  ds_read_b128 v[8:11], v76 offset:6656
  s_waitcnt lgkmcnt(0)
  v_smfmac_f32_16x16x64_bf16 v[20:23], v[8:11], v[96:103], v74
  v_smfmac_f32_16x16x64_bf16 v[24:27], v[8:11], v[104:111], v74
  v_smfmac_f32_16x16x64_bf16 v[28:31], v[8:11], v[208:215], v74
  v_smfmac_f32_16x16x64_bf16 v[32:35], v[8:11], v[216:223], v74
  ds_read_b128 v[12:15], v76 offset:7680
  s_waitcnt lgkmcnt(0)
  v_smfmac_f32_16x16x64_bf16 v[20:23], v[12:15], v[112:119], v74
  v_smfmac_f32_16x16x64_bf16 v[24:27], v[12:15], v[120:127], v74
  v_smfmac_f32_16x16x64_bf16 v[28:31], v[12:15], v[224:231], v74
  v_smfmac_f32_16x16x64_bf16 v[32:35], v[12:15], v[232:239], v74
  ds_read_b128 v[4:7], v76 offset:8704
  s_waitcnt lgkmcnt(0)
  v_smfmac_f32_16x16x64_bf16 v[20:23], v[4:7], v[128:135], v74
  v_smfmac_f32_16x16x64_bf16 v[24:27], v[4:7], v[136:143], v74
  ds_read_b128 v[60:63], v76 offset:61440
  ds_read_b128 v[64:67], v76 offset:62464
  s_waitcnt lgkmcnt(0)
  v_smfmac_f32_16x16x64_bf16 v[28:31], v[4:7], v[60:67], v74
  ds_read_b128 v[60:63], v76 offset:63488
  ds_read_b128 v[64:67], v76 offset:64512
  s_waitcnt lgkmcnt(0)
  v_smfmac_f32_16x16x64_bf16 v[32:35], v[4:7], v[60:67], v74
  ds_read_b128 v[8:11], v76 offset:9728
  s_waitcnt lgkmcnt(0)
  v_smfmac_f32_16x16x64_bf16 v[20:23], v[8:11], v[144:151], v74
  v_smfmac_f32_16x16x64_bf16 v[24:27], v[8:11], v[152:159], v74
  ds_read_b128 v[60:63], v75 offset:28672
  ds_read_b128 v[64:67], v75 offset:29696
  s_waitcnt lgkmcnt(0)
  v_smfmac_f32_16x16x64_bf16 v[28:31], v[8:11], v[60:67], v74
  ds_read_b128 v[60:63], v75 offset:30720
  ds_read_b128 v[64:67], v75 offset:31744
  s_waitcnt lgkmcnt(0)
  v_smfmac_f32_16x16x64_bf16 v[32:35], v[8:11], v[60:67], v74
  ds_read_b128 v[16:19], v76 offset:10752
  ds_read_b128 v[60:63], v75 offset:12288
  ds_read_b128 v[64:67], v75 offset:13312
  s_waitcnt lgkmcnt(0)
  v_smfmac_f32_16x16x64_bf16 v[20:23], v[16:19], v[60:67], v74
  ds_read_b128 v[60:63], v75 offset:14336
  ds_read_b128 v[64:67], v75 offset:15360
  s_waitcnt lgkmcnt(0)
  v_smfmac_f32_16x16x64_bf16 v[24:27], v[16:19], v[60:67], v74
  v_smfmac_f32_16x16x64_bf16 v[28:31], v[16:19], v[240:247], v74
  v_smfmac_f32_16x16x64_bf16 v[32:35], v[16:19], v[248:255], v74
  ds_read_b128 v[0:3], v76 offset:11776
  s_waitcnt lgkmcnt(0)
  v_smfmac_f32_16x16x64_bf16 v[20:23], v[0:3], v[160:167], v74
  v_smfmac_f32_16x16x64_bf16 v[24:27], v[0:3], v[168:175], v74
  v_smfmac_f32_16x16x64_bf16 v[28:31], v[0:3], a[0:7], v74
  v_smfmac_f32_16x16x64_bf16 v[32:35], v[0:3], a[8:15], v74
  ds_read_b128 v[12:15], v76 offset:12800
  s_waitcnt lgkmcnt(0)
  v_smfmac_f32_16x16x64_bf16 v[20:23], v[12:15], v[176:183], v74
  v_smfmac_f32_16x16x64_bf16 v[24:27], v[12:15], v[184:191], v74
  v_smfmac_f32_16x16x64_bf16 v[28:31], v[12:15], a[16:23], v74
  v_smfmac_f32_16x16x64_bf16 v[32:35], v[12:15], a[24:31], v74
  v_add_f32 v20, v20, v22
  v_add_f32 v21, v21, v23
  v_add_f32 v24, v24, v26
  v_cvt_pk_bf16_f32 v22, v20, v24
  s_nop 0
  ds_write_b32 v79, v22 offset:0
  v_add_f32 v25, v25, v27
  v_cvt_pk_bf16_f32 v23, v21, v25
  ds_write_b32 v79, v23 offset:576
  v_add_f32 v28, v28, v30
  v_add_f32 v29, v29, v31
  s_waitcnt lgkmcnt(0)
  s_nop 1
  s_branch Cs3_recok
Cs3_mx:
  s_waitcnt lgkmcnt(0)
  s_barrier
  buffer_load_dwordx4 v[0:3], v76, s[8:11], s58 offen offset:0 sc1
  ds_read_b128 v[20:23], v77 offset:0
  ds_read_b128 v[28:31], v77 offset:256
  buffer_load_dwordx4 v[4:7], v76, s[8:11], s58 offen offset:1024 sc1
  ds_read_b128 v[24:27], v77 offset:128
  ds_read_b128 v[32:35], v77 offset:384
  s_waitcnt vmcnt(1) lgkmcnt(3)
  v_mfma_f32_16x16x32_bf16 v[8:11], v[0:3], v[20:23], 0
  s_waitcnt vmcnt(0) lgkmcnt(1)
  v_mfma_f32_16x16x32_bf16 v[8:11], v[4:7], v[24:27], v[8:11]
  v_mfma_f32_16x16x32_bf16 v[12:15], v[28:31], v[20:23], 0
  s_waitcnt lgkmcnt(0)
  v_mfma_f32_16x16x32_bf16 v[12:15], v[32:35], v[24:27], v[12:15]
  v_add_f32_dpp v8, v10, v8 quad_perm:[2,3,0,1] row_mask:0xf bank_mask:0xf
  v_add_f32_dpp v9, v11, v9 quad_perm:[2,3,0,1] row_mask:0xf bank_mask:0xf
  s_nop 0
  v_mov_b32_dpp v8, v8 quad_perm:[0,1,0,1] row_mask:0xf bank_mask:0xf
  v_mov_b32_dpp v9, v9 quad_perm:[0,1,0,1] row_mask:0xf bank_mask:0xf
  s_nop 1
  v_add_f32_dpp v12, v14, v12 quad_perm:[2,3,0,1] row_mask:0xf bank_mask:0xf
  v_add_f32_dpp v13, v15, v13 quad_perm:[2,3,0,1] row_mask:0xf bank_mask:0xf
  s_nop 0
  v_mov_b32_dpp v12, v12 quad_perm:[0,1,0,1] row_mask:0xf bank_mask:0xf
  v_mov_b32_dpp v13, v13 quad_perm:[0,1,0,1] row_mask:0xf bank_mask:0xf
  v_mul_f32 v12, s69, v12
  ds_write_b32 v78, v8 offset:8716
  v_mul_f32 v13, s69, v13
  ds_write_b32 v78, v9 offset:8780
  s_waitcnt lgkmcnt(0)
  s_barrier
  ds_read_b128 v[36:39], v78 offset:8704
  ds_read_b128 v[40:43], v78 offset:8768
  s_waitcnt lgkmcnt(0)
  s_barrier
  v_max_f32 v16, v36, v37
  v_max3_f32 v16, v16, v38, v39
  v_max3_f32 v16, v16, v40, v41
  v_max3_f32 v16, v16, v42, v43
  v_max3_f32 v16, v16, v12, v13
  v_mov_b32 v17, v16
  s_nop 1
  v_permlane16_swap_b32 v16, v17
  v_max_f32 v16, v16, v17
  v_mov_b32 v17, v16
  s_nop 1
  v_permlane32_swap_b32 v16, v17
  v_max_f32 v16, v16, v17
  v_sub_f32 v36, v36, v16
  v_sub_f32 v37, v37, v16
  v_sub_f32 v38, v38, v16
  v_sub_f32 v39, v39, v16
  v_sub_f32 v40, v40, v16
  v_sub_f32 v41, v41, v16
  v_sub_f32 v42, v42, v16
  v_sub_f32 v43, v43, v16
  v_sub_f32 v12, v12, v16
  v_sub_f32 v13, v13, v16
  v_exp_f32 v36, v36
  v_exp_f32 v37, v37
  v_exp_f32 v38, v38
  v_exp_f32 v39, v39
  v_exp_f32 v40, v40
  v_exp_f32 v41, v41
  v_exp_f32 v42, v42
  v_exp_f32 v43, v43
  v_exp_f32 v12, v12
  v_exp_f32 v13, v13
  v_cvt_pk_bf16_f32 v32, v36, v40
  v_cvt_pk_bf16_f32 v33, v37, v41
  v_cvt_pk_bf16_f32 v34, v38, v42
  v_cvt_pk_bf16_f32 v35, v39, v43
  v_cvt_pk_bf16_f32 v28, v12, v13
  v_cvt_pk_bf16_f32 v31, v12, v13
  v_mov_b32 v29, 0
  v_mov_b32 v30, 0
  v_mov_b32 v68, 0x3f803f80
  v_mov_b32 v69, 0x3f803f80
  v_mov_b32 v70, 0x3f803f80
  v_mov_b32 v71, 0x3f803f80
  s_nop 1
  v_mfma_f32_16x16x32_bf16 v[8:11], v[32:35], v[68:71], 0
  v_mfma_f32_16x16x32_bf16 v[0:3], v[32:35], v[52:55], 0
  v_mfma_f32_16x16x32_bf16 v[4:7], v[32:35], v[56:59], 0
  v_mfma_f32_16x16x16_bf16 v[8:11], v[28:29], v[68:69], v[8:11]
  v_mfma_f32_16x16x16_bf16 v[0:3], v[28:29], v[72:73], v[0:3]
  v_mfma_f32_16x16x16_bf16 v[4:7], v[30:31], v[72:73], v[4:7]
  ds_read_b128 v[68:71], v76 offset:13824
  v_rcp_f32 v10, v8
  v_rcp_f32 v11, v9
  v_mul_f32 v0, v10, v0
  v_mul_f32 v1, v11, v1
  s_nop 0
  v_mul_f32 v4, v10, v4
  v_mul_f32 v5, v11, v5
  v_cvt_pk_bf16_f32 v2, v0, v4
  ds_write_b32 v79, v2 offset:8704
  v_cvt_pk_bf16_f32 v3, v1, v5
  ds_write_b32 v79, v3 offset:9280
  v_mov_b64 v[16:17], 0
  v_mov_b64 v[18:19], 0
  v_mov_b64 v[20:21], 0
  v_mov_b64 v[22:23], 0
  v_mov_b64 v[24:25], 0
  v_mov_b64 v[26:27], 0
  s_branch Cs3_mxok
Cs3_last:
  ds_read_b128 v[8:11], v76 offset:6656
  ds_read_b128 v[12:15], v76 offset:7680
  ds_read_b128 v[60:63], v76 offset:47104
  ds_read_b128 v[64:67], v76 offset:48128
  ds_read_b128 v[44:47], v76 offset:61440
  ds_read_b128 v[48:51], v76 offset:62464
  s_nop 3
  v_mov_b64 v[20:21], 0
  v_mov_b64 v[22:23], 0
  v_mov_b64 v[24:25], 0
  v_mov_b64 v[26:27], 0
  s_waitcnt lgkmcnt(6)
  v_smfmac_f32_16x16x64_bf16 v[28:31], v[0:3], v[36:43], v74
  v_smfmac_f32_16x16x64_bf16 v[20:23], v[0:3], a[32:39], v74
  ds_read_b128 v[36:39], v76 offset:63488
  ds_read_b128 v[40:43], v76 offset:64512
  v_smfmac_f32_16x16x64_bf16 v[24:27], v[0:3], a[40:47], v74
  v_smfmac_f32_16x16x64_bf16 v[20:23], v[4:7], a[48:55], v74
  buffer_store_dwordx4 v[16:19], v76, s[8:11], s68 offen sc1
  s_waitcnt lgkmcnt(4)
  v_smfmac_f32_16x16x64_bf16 v[24:27], v[4:7], a[56:63], v74
  v_smfmac_f32_16x16x64_bf16 v[28:31], v[4:7], v[192:199], v74
  v_smfmac_f32_16x16x64_bf16 v[32:35], v[4:7], v[200:207], v74
  v_smfmac_f32_16x16x64_bf16 v[32:35], v[0:3], v[60:67], v74
  v_smfmac_f32_16x16x64_bf16 v[20:23], v[8:11], a[64:71], v74
  ds_read_b128 v[60:63], v75 offset:28672
  ds_read_b128 v[64:67], v75 offset:29696
  v_smfmac_f32_16x16x64_bf16 v[24:27], v[8:11], a[72:79], v74
  v_smfmac_f32_16x16x64_bf16 v[28:31], v[8:11], v[208:215], v74
  v_smfmac_f32_16x16x64_bf16 v[20:23], v[12:15], a[80:87], v74
  v_smfmac_f32_16x16x64_bf16 v[24:27], v[12:15], a[88:95], v74
  v_smfmac_f32_16x16x64_bf16 v[28:31], v[12:15], v[224:231], v74
  v_smfmac_f32_16x16x64_bf16 v[32:35], v[12:15], v[232:239], v74
  v_smfmac_f32_16x16x64_bf16 v[32:35], v[8:11], v[216:223], v74
  s_waitcnt vmcnt(1)
  s_barrier
Cs3_lastr:
  ds_read_b128 v[4:7], v76 offset:8704
  ds_read_b128 v[8:11], v76 offset:9728
  ds_read_b128 v[16:19], v76 offset:10752
  ds_read_b128 v[0:3], v76 offset:11776
  ds_read_b128 v[12:15], v76 offset:12800
  s_waitcnt lgkmcnt(1)
  v_max3_u32 v72, v0, v1, v2
  v_max3_u32 v72, v72, v3, v4
  v_max3_u32 v72, v72, v5, v6
  v_max3_u32 v72, v72, v7, v8
  v_max3_u32 v72, v72, v9, v10
  s_waitcnt lgkmcnt(0)
  v_max3_u32 v72, v72, v11, v12
  v_max3_u32 v72, v72, v13, v14
  v_max3_u32 v72, v72, v15, v16
  v_max3_u32 v72, v72, v17, v18
  v_max_u32 v72, v72, v19
  v_cmp_eq_u32 vcc, -1, v72
  s_cbranch_vccnz Cs3_lastp
Cs3_lastg:
  v_smfmac_f32_16x16x64_bf16 v[28:31], v[4:7], v[44:51], v74
  ds_read_b128 v[44:47], v75 offset:30720
  ds_read_b128 v[48:51], v75 offset:31744
  v_smfmac_f32_16x16x64_bf16 v[32:35], v[4:7], v[36:43], v74
  v_smfmac_f32_16x16x64_bf16 v[28:31], v[8:11], v[60:67], v74
  v_smfmac_f32_16x16x64_bf16 v[28:31], v[16:19], v[240:247], v74
  v_smfmac_f32_16x16x64_bf16 v[28:31], v[0:3], a[0:7], v74
  v_smfmac_f32_16x16x64_bf16 v[28:31], v[12:15], a[16:23], v74
  v_smfmac_f32_16x16x64_bf16 v[32:35], v[16:19], v[248:255], v74
  v_smfmac_f32_16x16x64_bf16 v[32:35], v[0:3], a[8:15], v74
  s_waitcnt lgkmcnt(0)
  v_smfmac_f32_16x16x64_bf16 v[32:35], v[12:15], a[24:31], v74
  v_smfmac_f32_16x16x64_bf16 v[32:35], v[8:11], v[44:51], v74
  v_smfmac_f32_16x16x64_bf16 v[20:23], v[4:7], a[96:103], v74
  v_smfmac_f32_16x16x64_bf16 v[20:23], v[8:11], a[112:119], v74
  v_add_f32 v28, v28, v30
  v_add_f32 v32, v32, v34
  v_cvt_pk_bf16_f32 v30, v28, v32
  v_smfmac_f32_16x16x64_bf16 v[20:23], v[16:19], a[128:135], v74
  ds_write_b32 v79, v30 offset:256
  v_add_f32 v29, v29, v31
  v_add_f32 v33, v33, v35
  v_cvt_pk_bf16_f32 v31, v29, v33
  v_smfmac_f32_16x16x64_bf16 v[20:23], v[0:3], a[144:151], v74
  ds_write_b32 v79, v31 offset:832
  v_smfmac_f32_16x16x64_bf16 v[20:23], v[12:15], a[160:167], v74
  v_smfmac_f32_16x16x64_bf16 v[24:27], v[4:7], a[104:111], v74
  v_smfmac_f32_16x16x64_bf16 v[24:27], v[8:11], a[120:127], v74
  v_smfmac_f32_16x16x64_bf16 v[24:27], v[16:19], a[136:143], v74
  s_waitcnt lgkmcnt(0)
  s_barrier
  ds_read_b64 v[52:53], v77 offset:392
  v_add_f32 v20, v20, v22
  v_smfmac_f32_16x16x64_bf16 v[24:27], v[0:3], a[152:159], v74
  v_add_f32 v21, v21, v23
  v_smfmac_f32_16x16x64_bf16 v[24:27], v[12:15], a[168:175], v74
  v_cvt_pk_bf16_f32 v54, v20, v21
  s_add_u32 s68, s68, 655360
  s_nop 3
  v_add_f32 v24, v24, v26
  v_add_f32 v25, v25, v27
  v_cvt_pk_bf16_f32 v55, v24, v25
  s_waitcnt lgkmcnt(0)
  buffer_store_dwordx4 v[52:55], v76, s[8:11], s68 offen sc1
  s_branch Cs3_done
Cs3_lastp:
  s_add_u32 s72, s72, 2
  s_cmp_ge_u32 s72, 131072
  s_cbranch_scc1 Cs3_lastg
  s_barrier
  buffer_load_dwordx4 v76, s[8:11], s55 offen offset:0 sc1 lds
  buffer_load_dwordx4 v76, s[8:11], s55 offen offset:1024 sc1 lds
  s_waitcnt vmcnt(0)
  s_barrier
  s_branch Cs3_lastr
Cs3_done:
  s_branch L_cexit
L_conf:
  s_waitcnt vmcnt(0) lgkmcnt(0)
  s_barrier
  s_cmp_eq_u32 s52, 0
  s_cbranch_scc0 L_cf2
  s_mov_b64 exec, 1
  s_lshl_b32 s57, s2, 2
  v_mov_b32 v1, 0
L_cf0:
  s_cmp_eq_u32 s54, -1
  s_cbranch_scc1 L_cf1
  s_mov_b32 s55, s54
  s_lshr_b64 s[54:55], s[54:55], s0
  s_ff0_i32_b32 s56, s54
  s_add_u32 s0, s0, s56
  s_and_b32 s0, s0, 31
  s_lshl_b32 s56, 1, s0
  v_mov_b32 v35, s56
  buffer_atomic_or v35, v1, s[12:15], s57 offen sc0
  s_waitcnt vmcnt(0)
  v_readfirstlane_b32 s54, v35
  s_nop 0
  s_bitcmp1_b32 s54, s0
  s_cbranch_scc1 L_cf0
  v_mov_b32 v35, s0
  s_branch L_cf3
L_cf1:
  v_mov_b32 v35, 1
  buffer_atomic_add v35, v1, s[12:15], 0 offen offset:40 sc0
  s_waitcnt vmcnt(0)
  v_add_u32 v35, 32, v35
L_cf3:
  ds_write_b32 v33, v35
  s_mov_b64 exec, -1
  s_waitcnt lgkmcnt(0)
L_cf2:
  s_barrier
  ds_read_b32 v32, v33
  s_waitcnt lgkmcnt(0)
  v_readfirstlane_b32 s0, v32
  s_mov_b32 s1, 1
  s_cmp_lt_u32 s0, 32
  s_cbranch_scc1 L_role
  s_sub_u32 s53, s0, 32
  s_mov_b32 s57, 0
L_sur:
  s_load_dwordx16 s[60:75], s[12:13], 0 glc
  s_add_u32 s57, s57, 1
  s_waitcnt lgkmcnt(0)
  s_mov_b32 s55, s70
  s_bcnt1_i32_b32 s56, s60
  s_add_u32 s55, s55, s56
  s_bcnt1_i32_b32 s56, s61
  s_add_u32 s55, s55, s56
  s_bcnt1_i32_b32 s56, s62
  s_add_u32 s55, s55, s56
  s_bcnt1_i32_b32 s56, s63
  s_add_u32 s55, s55, s56
  s_bcnt1_i32_b32 s56, s64
  s_add_u32 s55, s55, s56
  s_bcnt1_i32_b32 s56, s65
  s_add_u32 s55, s55, s56
  s_bcnt1_i32_b32 s56, s66
  s_add_u32 s55, s55, s56
  s_bcnt1_i32_b32 s56, s67
  s_add_u32 s55, s55, s56
  s_cmp_ge_u32 s57, 131072
  s_cbranch_scc1 L_end
  s_cmp_lt_u32 s55, 256
  s_cbranch_scc1 L_sur
  s_mov_b32 s2, 0
  s_mov_b32 s54, s60
  s_bcnt0_i32_b32 s56, s54
  s_cmp_lt_u32 s53, s56
  s_cbranch_scc1 L_sur2
  s_sub_u32 s53, s53, s56
  s_mov_b32 s2, 1
  s_mov_b32 s54, s61
  s_bcnt0_i32_b32 s56, s54
  s_cmp_lt_u32 s53, s56
  s_cbranch_scc1 L_sur2
  s_sub_u32 s53, s53, s56
  s_mov_b32 s2, 2
  s_mov_b32 s54, s62
  s_bcnt0_i32_b32 s56, s54
  s_cmp_lt_u32 s53, s56
  s_cbranch_scc1 L_sur2
  s_sub_u32 s53, s53, s56
  s_mov_b32 s2, 3
  s_mov_b32 s54, s63
  s_bcnt0_i32_b32 s56, s54
  s_cmp_lt_u32 s53, s56
  s_cbranch_scc1 L_sur2
  s_sub_u32 s53, s53, s56
  s_mov_b32 s2, 4
  s_mov_b32 s54, s64
  s_bcnt0_i32_b32 s56, s54
  s_cmp_lt_u32 s53, s56
  s_cbranch_scc1 L_sur2
  s_sub_u32 s53, s53, s56
  s_mov_b32 s2, 5
  s_mov_b32 s54, s65
  s_bcnt0_i32_b32 s56, s54
  s_cmp_lt_u32 s53, s56
  s_cbranch_scc1 L_sur2
  s_sub_u32 s53, s53, s56
  s_mov_b32 s2, 6
  s_mov_b32 s54, s66
  s_bcnt0_i32_b32 s56, s54
  s_cmp_lt_u32 s53, s56
  s_cbranch_scc1 L_sur2
  s_sub_u32 s53, s53, s56
  s_mov_b32 s2, 7
  s_mov_b32 s54, s67
  s_bcnt0_i32_b32 s56, s54
  s_cmp_lt_u32 s53, s56
  s_cbranch_scc1 L_sur2
  s_sub_u32 s53, s53, s56
  s_branch L_end
L_sur2:
  s_ff0_i32_b32 s0, s54
  s_bitset1_b32 s54, s0
  s_sub_u32 s53, s53, 1
  s_cbranch_scc0 L_sur2
  s_branch L_role
L_worker:
  s_lshl_b32 s54, s2, 2
  s_lshr_b32 s54, 1412567136, s54
  s_and_b32 s54, s54, 7
  s_lshl_b32 s54, s54, 5
  s_add_u32 s53, s53, s54
  s_getpc_b64 s[80:81]
L_pc_2:
  s_and_b32 s55, s0, 1
  s_lshl_b32 s55, s55, 2
  s_add_u32 s55, s55, s52
  s_lshl_b32 s55, s55, 13
  v_and_b32 v199, 63, v0
  v_lshl_add_u32 v199, v199, 7, s55
  s_sub_u32 s82, s80, (L_pc_2 - L_w0)
  s_subb_u32 s83, s81, 0
  v_min_u32 v198, (L_w4 - L_w0), v199
  global_load_dword v196, v198, s[82:83]
  v_min_u32 v199, (L_end - L_pc_2), v199
  global_load_dword v196, v199, s[80:81]
  v_and_b32 v200, 63, v0
  v_lshlrev_b32 v201, 4, v200
  v_lshrrev_b32 v211, 3, v200
  s_lshl_b32 s54, s52, 3
  v_add_u32 v211, s54, v211
  v_bfe_u32 v212, v211, 1, 3
  v_and_b32 v213, 7, v200
  v_xor_b32 v212, v212, v213
  v_mul_u32_u24 v211, 1152, v211
  v_lshl_add_u32 v202, v212, 4, v211
  s_mul_i32 s67, s52, 9216
  v_and_b32 v211, 31, v200
  v_lshrrev_b32 v212, 3, v211
  v_mul_u32_u24 v212, 9216, v212
  v_and_b32 v213, 7, v211
  v_lshl_add_u32 v212, v213, 7, v212
  v_bfe_u32 v213, v211, 1, 3
  v_lshrrev_b32 v214, 5, v200
  v_xor_b32 v213, v213, v214
  v_lshl_add_u32 v203, v213, 4, v212
  v_xor_b32 v204, 32, v203
  v_xor_b32 v205, 64, v203
  v_xor_b32 v206, 0x60, v203
  v_bfe_u32 v211, v200, 2, 2
  v_lshl_add_u32 v212, v214, 3, v211
  v_lshlrev_b32 v212, 8, v212
  v_xor_b32 v211, s52, v211
  v_lshl_add_u32 v212, v211, 6, v212
  v_bfe_u32 v213, v200, 4, 1
  v_and_b32 v211, 3, v200
  v_lshl_add_u32 v210, v213, 5, v212
  v_lshl_add_u32 v210, v211, 3, v210
  v_lshl_add_u32 v209, v213, 4, v212
  v_and_b32 v213, 1, v211
  v_lshl_add_u32 v209, v213, 3, v209
  v_lshrrev_b32 v213, 1, v211
  v_lshl_add_u32 v209, v213, 5, v209
  s_mov_b32 s65, 0
  s_mul_i32 s58, s53, 9363
  s_lshr_b32 s58, s58, 16
  s_mul_i32 s54, s58, 7
  s_sub_u32 s59, s53, s54
  s_mul_i32 s60, s59, 36864
  s_add_u32 m0, s67, 0
  s_nop 0
  buffer_load_dwordx4 v202, s[4:7], s60 offen offset:0 lds
  s_add_u32 m0, s67, 896
  s_nop 0
  buffer_load_dwordx4 v202, s[4:7], s60 offen offset:128 lds
  s_add_u32 m0, s67, 1792
  s_nop 0
  buffer_load_dwordx4 v202, s[4:7], s60 offen offset:256 lds
  s_add_u32 m0, s67, 2688
  s_nop 0
  buffer_load_dwordx4 v202, s[4:7], s60 offen offset:384 lds
  s_add_u32 m0, s67, 3584
  s_nop 0
  buffer_load_dwordx4 v202, s[4:7], s60 offen offset:512 lds
  s_add_u32 m0, s67, 4480
  s_nop 0
  buffer_load_dwordx4 v202, s[4:7], s60 offen offset:640 lds
  s_add_u32 m0, s67, 5376
  s_nop 0
  buffer_load_dwordx4 v202, s[4:7], s60 offen offset:768 lds
  s_add_u32 m0, s67, 6272
  s_nop 0
  buffer_load_dwordx4 v202, s[4:7], s60 offen offset:896 lds
  s_add_u32 m0, s67, 7168
  s_nop 0
  buffer_load_dwordx4 v202, s[4:7], s60 offen offset:1024 lds
  v_lshrrev_b32 v211, 4, v200
  v_lshlrev_b32 v212, 2, v211
  v_and_b32 v213, 15, v200
  v_xor_b32 v212, v212, v213
  v_lshlrev_b32 v212, 4, v212
  v_lshl_add_u32 v207, v211, 13, v212
  s_lshl_b32 s62, s58, 8
  s_lshl_b32 s54, s52, 15
  s_add_u32 s62, s62, s54
  s_lshl_b32 s61, s52, 10
  s_add_u32 s61, s61, 36864
  s_add_u32 m0, s61, 0
  s_add_u32 s54, s62, 0
  buffer_load_dwordx4 v207, s[20:23], s54 offen lds
  s_add_u32 m0, s61, 4096
  s_add_u32 s54, s62, 131072
  buffer_load_dwordx4 v207, s[20:23], s54 offen lds
  s_add_u32 m0, s61, 8192
  s_add_u32 s54, s62, 262144
  buffer_load_dwordx4 v207, s[20:23], s54 offen lds
  s_add_u32 m0, s61, 12288
  s_add_u32 s54, s62, 393216
  buffer_load_dwordx4 v207, s[20:23], s54 offen lds
  s_add_u32 m0, s61, 16384
  s_add_u32 s54, s62, 0
  buffer_load_dwordx4 v207, s[24:27], s54 offen lds
  s_add_u32 m0, s61, 20480
  s_add_u32 s54, s62, 131072
  buffer_load_dwordx4 v207, s[24:27], s54 offen lds
  s_add_u32 m0, s61, 24576
  s_add_u32 s54, s62, 262144
  buffer_load_dwordx4 v207, s[24:27], s54 offen lds
  s_add_u32 m0, s61, 28672
  s_add_u32 s54, s62, 393216
  buffer_load_dwordx4 v207, s[24:27], s54 offen lds
  s_add_u32 m0, s61, 32768
  s_add_u32 s54, s62, 524288
  buffer_load_dwordx4 v207, s[20:23], s54 offen lds
  s_add_u32 m0, s61, 36864
  s_add_u32 s54, s62, 655360
  buffer_load_dwordx4 v207, s[20:23], s54 offen lds
  s_add_u32 m0, s61, 40960
  s_add_u32 s54, s62, 786432
  buffer_load_dwordx4 v207, s[20:23], s54 offen lds
  s_add_u32 m0, s61, 45056
  s_add_u32 s54, s62, 917504
  buffer_load_dwordx4 v207, s[20:23], s54 offen lds
  s_add_u32 m0, s61, 49152
  s_add_u32 s54, s62, 524288
  buffer_load_dwordx4 v207, s[24:27], s54 offen lds
  s_add_u32 m0, s61, 53248
  s_add_u32 s54, s62, 655360
  buffer_load_dwordx4 v207, s[24:27], s54 offen lds
  s_add_u32 m0, s61, 57344
  s_add_u32 s54, s62, 786432
  buffer_load_dwordx4 v207, s[24:27], s54 offen lds
  s_add_u32 m0, s61, 61440
  s_add_u32 s54, s62, 917504
  buffer_load_dwordx4 v207, s[24:27], s54 offen lds
  s_add_u32 m0, s61, 65536
  s_add_u32 s54, s62, 1048576
  buffer_load_dwordx4 v207, s[20:23], s54 offen lds
  s_add_u32 m0, s61, 69632
  s_add_u32 s54, s62, 1179648
  buffer_load_dwordx4 v207, s[20:23], s54 offen lds
  s_add_u32 m0, s61, 73728
  s_add_u32 s54, s62, 1310720
  buffer_load_dwordx4 v207, s[20:23], s54 offen lds
  s_add_u32 m0, s61, 77824
  s_add_u32 s54, s62, 1441792
  buffer_load_dwordx4 v207, s[20:23], s54 offen lds
  s_add_u32 m0, s61, 81920
  s_add_u32 s54, s62, 1048576
  buffer_load_dwordx4 v207, s[24:27], s54 offen lds
  s_add_u32 m0, s61, 86016
  s_add_u32 s54, s62, 1179648
  buffer_load_dwordx4 v207, s[24:27], s54 offen lds
  s_add_u32 m0, s61, 90112
  s_add_u32 s54, s62, 1310720
  buffer_load_dwordx4 v207, s[24:27], s54 offen lds
  s_add_u32 m0, s61, 94208
  s_add_u32 s54, s62, 1441792
  buffer_load_dwordx4 v207, s[24:27], s54 offen lds
  v_bfe_u32 v211, v200, 3, 2
  v_lshlrev_b32 v216, 11, v211
  v_bfe_u32 v211, v200, 1, 2
  v_lshl_add_u32 v216, v211, 6, v216
  v_lshrrev_b32 v212, 5, v200
  v_lshl_add_u32 v216, v212, 5, v216
  v_and_b32 v211, 1, v200
  v_lshl_add_u32 v216, v211, 4, v216
  v_bfe_u32 v211, v200, 4, 1
  v_lshlrev_b32 v217, 10, v211
  v_lshl_add_u32 v217, v212, 9, v217
  v_and_b32 v211, 15, v200
  v_lshl_add_u32 v217, v211, 4, v217
  s_lshl_b32 s54, s52, 11
  s_add_u32 s54, s54, 8192
  v_add_u32 v217, s54, v217
  s_cmp_eq_u32 s1, 1
  s_cbranch_scc1 W_ver_ok
  v_mov_b32 v33, 163832
  s_cmp_eq_u32 s52, 0
  s_cbranch_scc0 W_ver_b
  s_waitcnt vmcnt(35)
  s_mov_b64 exec, 1
  ds_write_b32 v33, v35
  s_mov_b64 exec, -1
  s_waitcnt lgkmcnt(0)
W_ver_b:
  s_barrier
  ds_read_b32 v32, v33
  s_waitcnt lgkmcnt(0)
  v_readfirstlane_b32 s54, v32
  s_nop 0
  s_bitcmp1_b32 s54, s0
  s_cbranch_scc1 L_conf
W_ver_ok:
  s_waitcnt vmcnt(20) lgkmcnt(0)
  s_barrier
  s_add_u32 m0, s61, 98304
  s_add_u32 s54, s62, 1572864
  buffer_load_dwordx4 v207, s[20:23], s54 offen lds
  s_add_u32 m0, s61, 102400
  s_add_u32 s54, s62, 1703936
  buffer_load_dwordx4 v207, s[20:23], s54 offen lds
  s_add_u32 m0, s61, 106496
  s_add_u32 s54, s62, 1835008
  buffer_load_dwordx4 v207, s[20:23], s54 offen lds
  s_add_u32 m0, s61, 110592
  s_add_u32 s54, s62, 1966080
  buffer_load_dwordx4 v207, s[20:23], s54 offen lds
  v_add_u32 v215, 36864, v209
  ds_read_b64_tr_b16 a[0:1], v215 offset:0
  ds_read_b64_tr_b16 a[2:3], v215 offset:1024
  ds_read_b64_tr_b16 a[4:5], v215 offset:4096
  ds_read_b64_tr_b16 a[6:7], v215 offset:5120
  ds_read_b64_tr_b16 a[8:9], v215 offset:8192
  ds_read_b64_tr_b16 a[10:11], v215 offset:9216
  ds_read_b64_tr_b16 a[12:13], v215 offset:12288
  ds_read_b64_tr_b16 a[14:15], v215 offset:13312
  s_waitcnt vmcnt(20) lgkmcnt(0)
  s_barrier
  s_add_u32 m0, s61, 0
  s_add_u32 s54, s62, 1572864
  buffer_load_dwordx4 v207, s[24:27], s54 offen lds
  s_add_u32 m0, s61, 4096
  s_add_u32 s54, s62, 1703936
  buffer_load_dwordx4 v207, s[24:27], s54 offen lds
  s_add_u32 m0, s61, 8192
  s_add_u32 s54, s62, 1835008
  buffer_load_dwordx4 v207, s[24:27], s54 offen lds
  s_add_u32 m0, s61, 12288
  s_add_u32 s54, s62, 1966080
  buffer_load_dwordx4 v207, s[24:27], s54 offen lds
  v_add_u32 v215, 53248, v210
  ds_read_b64_tr_b16 a[144:145], v215 offset:0
  ds_read_b64_tr_b16 a[146:147], v215 offset:1024
  ds_read_b64_tr_b16 a[148:149], v215 offset:4096
  ds_read_b64_tr_b16 a[150:151], v215 offset:5120
  ds_read_b64_tr_b16 a[152:153], v215 offset:8192
  ds_read_b64_tr_b16 a[154:155], v215 offset:9216
  ds_read_b64_tr_b16 a[156:157], v215 offset:12288
  ds_read_b64_tr_b16 a[158:159], v215 offset:13312
  s_waitcnt vmcnt(20) lgkmcnt(0)
  s_barrier
  s_add_u32 m0, s61, 16384
  s_add_u32 s54, s62, 2097152
  buffer_load_dwordx4 v207, s[20:23], s54 offen lds
  s_add_u32 m0, s61, 20480
  s_add_u32 s54, s62, 2228224
  buffer_load_dwordx4 v207, s[20:23], s54 offen lds
  s_add_u32 m0, s61, 24576
  s_add_u32 s54, s62, 2359296
  buffer_load_dwordx4 v207, s[20:23], s54 offen lds
  s_add_u32 m0, s61, 28672
  s_add_u32 s54, s62, 2490368
  buffer_load_dwordx4 v207, s[20:23], s54 offen lds
  v_add_u32 v215, 69632, v209
  ds_read_b64_tr_b16 a[16:17], v215 offset:0
  ds_read_b64_tr_b16 a[18:19], v215 offset:1024
  ds_read_b64_tr_b16 a[20:21], v215 offset:4096
  ds_read_b64_tr_b16 a[22:23], v215 offset:5120
  ds_read_b64_tr_b16 a[24:25], v215 offset:8192
  ds_read_b64_tr_b16 a[26:27], v215 offset:9216
  ds_read_b64_tr_b16 a[28:29], v215 offset:12288
  ds_read_b64_tr_b16 a[30:31], v215 offset:13312
  s_waitcnt vmcnt(20) lgkmcnt(0)
  s_barrier
  s_add_u32 m0, s61, 32768
  s_add_u32 s54, s62, 2097152
  buffer_load_dwordx4 v207, s[24:27], s54 offen lds
  s_add_u32 m0, s61, 36864
  s_add_u32 s54, s62, 2228224
  buffer_load_dwordx4 v207, s[24:27], s54 offen lds
  s_add_u32 m0, s61, 40960
  s_add_u32 s54, s62, 2359296
  buffer_load_dwordx4 v207, s[24:27], s54 offen lds
  s_add_u32 m0, s61, 45056
  s_add_u32 s54, s62, 2490368
  buffer_load_dwordx4 v207, s[24:27], s54 offen lds
  v_add_u32 v215, 86016, v210
  ds_read_b64_tr_b16 a[160:161], v215 offset:0
  ds_read_b64_tr_b16 a[162:163], v215 offset:1024
  ds_read_b64_tr_b16 a[164:165], v215 offset:4096
  ds_read_b64_tr_b16 a[166:167], v215 offset:5120
  ds_read_b64_tr_b16 a[168:169], v215 offset:8192
  ds_read_b64_tr_b16 a[170:171], v215 offset:9216
  ds_read_b64_tr_b16 a[172:173], v215 offset:12288
  ds_read_b64_tr_b16 a[174:175], v215 offset:13312
  s_waitcnt vmcnt(20) lgkmcnt(0)
  s_barrier
  s_add_u32 m0, s61, 49152
  s_add_u32 s54, s62, 2621440
  buffer_load_dwordx4 v207, s[20:23], s54 offen lds
  s_add_u32 m0, s61, 53248
  s_add_u32 s54, s62, 2752512
  buffer_load_dwordx4 v207, s[20:23], s54 offen lds
  s_add_u32 m0, s61, 57344
  s_add_u32 s54, s62, 2883584
  buffer_load_dwordx4 v207, s[20:23], s54 offen lds
  s_add_u32 m0, s61, 61440
  s_add_u32 s54, s62, 3014656
  buffer_load_dwordx4 v207, s[20:23], s54 offen lds
  v_add_u32 v215, 102400, v209
  ds_read_b64_tr_b16 a[32:33], v215 offset:0
  ds_read_b64_tr_b16 a[34:35], v215 offset:1024
  ds_read_b64_tr_b16 a[36:37], v215 offset:4096
  ds_read_b64_tr_b16 a[38:39], v215 offset:5120
  ds_read_b64_tr_b16 a[40:41], v215 offset:8192
  ds_read_b64_tr_b16 a[42:43], v215 offset:9216
  ds_read_b64_tr_b16 a[44:45], v215 offset:12288
  ds_read_b64_tr_b16 a[46:47], v215 offset:13312
  s_waitcnt vmcnt(20) lgkmcnt(0)
  s_barrier
  s_add_u32 m0, s61, 65536
  s_add_u32 s54, s62, 2621440
  buffer_load_dwordx4 v207, s[24:27], s54 offen lds
  s_add_u32 m0, s61, 69632
  s_add_u32 s54, s62, 2752512
  buffer_load_dwordx4 v207, s[24:27], s54 offen lds
  s_add_u32 m0, s61, 73728
  s_add_u32 s54, s62, 2883584
  buffer_load_dwordx4 v207, s[24:27], s54 offen lds
  s_add_u32 m0, s61, 77824
  s_add_u32 s54, s62, 3014656
  buffer_load_dwordx4 v207, s[24:27], s54 offen lds
  v_add_u32 v215, 118784, v210
  ds_read_b64_tr_b16 a[176:177], v215 offset:0
  ds_read_b64_tr_b16 a[178:179], v215 offset:1024
  ds_read_b64_tr_b16 a[180:181], v215 offset:4096
  ds_read_b64_tr_b16 a[182:183], v215 offset:5120
  ds_read_b64_tr_b16 a[184:185], v215 offset:8192
  ds_read_b64_tr_b16 a[186:187], v215 offset:9216
  ds_read_b64_tr_b16 a[188:189], v215 offset:12288
  ds_read_b64_tr_b16 a[190:191], v215 offset:13312
  s_waitcnt vmcnt(20) lgkmcnt(0)
  s_barrier
  s_add_u32 m0, s61, 81920
  s_add_u32 s54, s62, 3145728
  buffer_load_dwordx4 v207, s[20:23], s54 offen lds
  s_add_u32 m0, s61, 86016
  s_add_u32 s54, s62, 3276800
  buffer_load_dwordx4 v207, s[20:23], s54 offen lds
  s_add_u32 m0, s61, 90112
  s_add_u32 s54, s62, 3407872
  buffer_load_dwordx4 v207, s[20:23], s54 offen lds
  s_add_u32 m0, s61, 94208
  s_add_u32 s54, s62, 3538944
  buffer_load_dwordx4 v207, s[20:23], s54 offen lds
  v_add_u32 v215, 135168, v209
  ds_read_b64_tr_b16 a[48:49], v215 offset:0
  ds_read_b64_tr_b16 a[50:51], v215 offset:1024
  ds_read_b64_tr_b16 a[52:53], v215 offset:4096
  ds_read_b64_tr_b16 a[54:55], v215 offset:5120
  ds_read_b64_tr_b16 a[56:57], v215 offset:8192
  ds_read_b64_tr_b16 a[58:59], v215 offset:9216
  ds_read_b64_tr_b16 a[60:61], v215 offset:12288
  ds_read_b64_tr_b16 a[62:63], v215 offset:13312
  s_waitcnt vmcnt(20) lgkmcnt(0)
  s_barrier
  s_add_u32 m0, s61, 98304
  s_add_u32 s54, s62, 3145728
  buffer_load_dwordx4 v207, s[24:27], s54 offen lds
  s_add_u32 m0, s61, 102400
  s_add_u32 s54, s62, 3276800
  buffer_load_dwordx4 v207, s[24:27], s54 offen lds
  s_add_u32 m0, s61, 106496
  s_add_u32 s54, s62, 3407872
  buffer_load_dwordx4 v207, s[24:27], s54 offen lds
  s_add_u32 m0, s61, 110592
  s_add_u32 s54, s62, 3538944
  buffer_load_dwordx4 v207, s[24:27], s54 offen lds
  v_add_u32 v215, 36864, v210
  ds_read_b64_tr_b16 a[192:193], v215 offset:0
  ds_read_b64_tr_b16 a[194:195], v215 offset:1024
  ds_read_b64_tr_b16 a[196:197], v215 offset:4096
  ds_read_b64_tr_b16 a[198:199], v215 offset:5120
  ds_read_b64_tr_b16 a[200:201], v215 offset:8192
  ds_read_b64_tr_b16 a[202:203], v215 offset:9216
  ds_read_b64_tr_b16 a[204:205], v215 offset:12288
  ds_read_b64_tr_b16 a[206:207], v215 offset:13312
  s_waitcnt vmcnt(20) lgkmcnt(0)
  s_barrier
  s_add_u32 m0, s61, 0
  s_add_u32 s54, s62, 3670016
  buffer_load_dwordx4 v207, s[20:23], s54 offen lds
  s_add_u32 m0, s61, 4096
  s_add_u32 s54, s62, 3801088
  buffer_load_dwordx4 v207, s[20:23], s54 offen lds
  s_add_u32 m0, s61, 8192
  s_add_u32 s54, s62, 3932160
  buffer_load_dwordx4 v207, s[20:23], s54 offen lds
  s_add_u32 m0, s61, 12288
  s_add_u32 s54, s62, 4063232
  buffer_load_dwordx4 v207, s[20:23], s54 offen lds
  v_add_u32 v215, 53248, v209
  ds_read_b64_tr_b16 a[64:65], v215 offset:0
  ds_read_b64_tr_b16 a[66:67], v215 offset:1024
  ds_read_b64_tr_b16 a[68:69], v215 offset:4096
  ds_read_b64_tr_b16 a[70:71], v215 offset:5120
  ds_read_b64_tr_b16 a[72:73], v215 offset:8192
  ds_read_b64_tr_b16 a[74:75], v215 offset:9216
  ds_read_b64_tr_b16 a[76:77], v215 offset:12288
  ds_read_b64_tr_b16 a[78:79], v215 offset:13312
  s_waitcnt vmcnt(20) lgkmcnt(0)
  s_barrier
  s_add_u32 m0, s61, 16384
  s_add_u32 s54, s62, 3670016
  buffer_load_dwordx4 v207, s[24:27], s54 offen lds
  s_add_u32 m0, s61, 20480
  s_add_u32 s54, s62, 3801088
  buffer_load_dwordx4 v207, s[24:27], s54 offen lds
  s_add_u32 m0, s61, 24576
  s_add_u32 s54, s62, 3932160
  buffer_load_dwordx4 v207, s[24:27], s54 offen lds
  s_add_u32 m0, s61, 28672
  s_add_u32 s54, s62, 4063232
  buffer_load_dwordx4 v207, s[24:27], s54 offen lds
  v_add_u32 v215, 69632, v210
  ds_read_b64_tr_b16 a[208:209], v215 offset:0
  ds_read_b64_tr_b16 a[210:211], v215 offset:1024
  ds_read_b64_tr_b16 a[212:213], v215 offset:4096
  ds_read_b64_tr_b16 a[214:215], v215 offset:5120
  ds_read_b64_tr_b16 a[216:217], v215 offset:8192
  ds_read_b64_tr_b16 a[218:219], v215 offset:9216
  ds_read_b64_tr_b16 a[220:221], v215 offset:12288
  ds_read_b64_tr_b16 a[222:223], v215 offset:13312
  s_waitcnt vmcnt(20) lgkmcnt(0)
  s_barrier
  s_add_u32 m0, s61, 32768
  s_add_u32 s54, s62, 4194304
  buffer_load_dwordx4 v207, s[20:23], s54 offen lds
  s_add_u32 m0, s61, 36864
  s_add_u32 s54, s62, 4325376
  buffer_load_dwordx4 v207, s[20:23], s54 offen lds
  s_add_u32 m0, s61, 40960
  s_add_u32 s54, s62, 4456448
  buffer_load_dwordx4 v207, s[20:23], s54 offen lds
  s_add_u32 m0, s61, 45056
  s_add_u32 s54, s62, 4587520
  buffer_load_dwordx4 v207, s[20:23], s54 offen lds
  v_add_u32 v215, 86016, v209
  ds_read_b64_tr_b16 a[80:81], v215 offset:0
  ds_read_b64_tr_b16 a[82:83], v215 offset:1024
  ds_read_b64_tr_b16 a[84:85], v215 offset:4096
  ds_read_b64_tr_b16 a[86:87], v215 offset:5120
  ds_read_b64_tr_b16 a[88:89], v215 offset:8192
  ds_read_b64_tr_b16 a[90:91], v215 offset:9216
  ds_read_b64_tr_b16 a[92:93], v215 offset:12288
  ds_read_b64_tr_b16 a[94:95], v215 offset:13312
  s_waitcnt vmcnt(20) lgkmcnt(0)
  s_barrier
  s_add_u32 m0, s61, 49152
  s_add_u32 s54, s62, 4194304
  buffer_load_dwordx4 v207, s[24:27], s54 offen lds
  s_add_u32 m0, s61, 53248
  s_add_u32 s54, s62, 4325376
  buffer_load_dwordx4 v207, s[24:27], s54 offen lds
  s_add_u32 m0, s61, 57344
  s_add_u32 s54, s62, 4456448
  buffer_load_dwordx4 v207, s[24:27], s54 offen lds
  s_add_u32 m0, s61, 61440
  s_add_u32 s54, s62, 4587520
  buffer_load_dwordx4 v207, s[24:27], s54 offen lds
  s_mul_i32 s54, s53, 21120
  s_lshl_b32 s55, s52, 13
  s_add_u32 s54, s54, s55
  s_cmp_eq_u32 s52, 3
  s_cselect_b32 s54, 0x10000000, s54
  v_lshlrev_b32 v211, 3, v201
  buffer_load_dword v196, v211, s[28:31], s54 offen
  v_add_u32 v215, 102400, v210
  ds_read_b64_tr_b16 a[224:225], v215 offset:0
  ds_read_b64_tr_b16 a[226:227], v215 offset:1024
  ds_read_b64_tr_b16 a[228:229], v215 offset:4096
  ds_read_b64_tr_b16 a[230:231], v215 offset:5120
  ds_read_b64_tr_b16 a[232:233], v215 offset:8192
  ds_read_b64_tr_b16 a[234:235], v215 offset:9216
  ds_read_b64_tr_b16 a[236:237], v215 offset:12288
  ds_read_b64_tr_b16 a[238:239], v215 offset:13312
  s_waitcnt vmcnt(21) lgkmcnt(0)
  s_barrier
  s_lshl_b32 s54, s53, 13
  s_lshr_b32 s55, s53, 6
  s_or_b32 s55, s55, s52
  s_cmp_eq_u32 s55, 0
  s_cselect_b32 s54, s54, 0x10000000
  v_lshlrev_b32 v211, 3, v201
  buffer_load_dword v196, v211, s[16:19], s54 offen
  v_add_u32 v215, 118784, v209
  ds_read_b64_tr_b16 a[96:97], v215 offset:0
  ds_read_b64_tr_b16 a[98:99], v215 offset:1024
  ds_read_b64_tr_b16 a[100:101], v215 offset:4096
  ds_read_b64_tr_b16 a[102:103], v215 offset:5120
  ds_read_b64_tr_b16 a[104:105], v215 offset:8192
  ds_read_b64_tr_b16 a[106:107], v215 offset:9216
  ds_read_b64_tr_b16 a[108:109], v215 offset:12288
  ds_read_b64_tr_b16 a[110:111], v215 offset:13312
  s_waitcnt vmcnt(18) lgkmcnt(0)
  s_barrier
  v_add_u32 v215, 135168, v210
  ds_read_b64_tr_b16 a[240:241], v215 offset:0
  ds_read_b64_tr_b16 a[242:243], v215 offset:1024
  ds_read_b64_tr_b16 a[244:245], v215 offset:4096
  ds_read_b64_tr_b16 a[246:247], v215 offset:5120
  ds_read_b64_tr_b16 a[248:249], v215 offset:8192
  ds_read_b64_tr_b16 a[250:251], v215 offset:9216
  ds_read_b64_tr_b16 a[252:253], v215 offset:12288
  ds_read_b64_tr_b16 a[254:255], v215 offset:13312
  s_waitcnt vmcnt(14) lgkmcnt(0)
  s_barrier
  v_add_u32 v215, 36864, v209
  ds_read_b64_tr_b16 a[112:113], v215 offset:0
  ds_read_b64_tr_b16 a[114:115], v215 offset:1024
  ds_read_b64_tr_b16 a[116:117], v215 offset:4096
  ds_read_b64_tr_b16 a[118:119], v215 offset:5120
  ds_read_b64_tr_b16 a[120:121], v215 offset:8192
  ds_read_b64_tr_b16 a[122:123], v215 offset:9216
  ds_read_b64_tr_b16 a[124:125], v215 offset:12288
  ds_read_b64_tr_b16 a[126:127], v215 offset:13312
  s_waitcnt vmcnt(10) lgkmcnt(0)
  s_barrier
  v_add_u32 v215, 53248, v210
  ds_read_b64_tr_b16 v[224:225], v215 offset:0
  ds_read_b64_tr_b16 v[226:227], v215 offset:1024
  ds_read_b64_tr_b16 v[228:229], v215 offset:4096
  ds_read_b64_tr_b16 v[230:231], v215 offset:5120
  ds_read_b64_tr_b16 v[232:233], v215 offset:8192
  ds_read_b64_tr_b16 v[234:235], v215 offset:9216
  ds_read_b64_tr_b16 v[236:237], v215 offset:12288
  ds_read_b64_tr_b16 v[238:239], v215 offset:13312
  s_waitcnt vmcnt(6) lgkmcnt(0)
  s_barrier
  v_add_u32 v215, 69632, v209
  ds_read_b64_tr_b16 a[128:129], v215 offset:0
  ds_read_b64_tr_b16 a[130:131], v215 offset:1024
  ds_read_b64_tr_b16 a[132:133], v215 offset:4096
  ds_read_b64_tr_b16 a[134:135], v215 offset:5120
  ds_read_b64_tr_b16 a[136:137], v215 offset:8192
  ds_read_b64_tr_b16 a[138:139], v215 offset:9216
  ds_read_b64_tr_b16 a[140:141], v215 offset:12288
  ds_read_b64_tr_b16 a[142:143], v215 offset:13312
  s_waitcnt vmcnt(2) lgkmcnt(0)
  s_barrier
  v_add_u32 v215, 86016, v210
  ds_read_b64_tr_b16 v[240:241], v215 offset:0
  ds_read_b64_tr_b16 v[242:243], v215 offset:1024
  ds_read_b64_tr_b16 v[244:245], v215 offset:4096
  ds_read_b64_tr_b16 v[246:247], v215 offset:5120
  ds_read_b64_tr_b16 v[248:249], v215 offset:8192
  ds_read_b64_tr_b16 v[250:251], v215 offset:9216
  ds_read_b64_tr_b16 v[252:253], v215 offset:12288
  ds_read_b64_tr_b16 v[254:255], v215 offset:13312
  s_waitcnt lgkmcnt(0)
  s_barrier
  s_lshr_b32 s55, s53, 1
  s_and_b32 s56, s53, 1
  s_lshl_b32 s56, s56, 7
  s_lshl_b32 s55, s55, 2
  s_add_u32 s55, s55, s56
  s_add_u32 s55, s55, 356352
  s_cmp_lt_u32 s53, 64
  s_cselect_b32 s71, s55, 268435456
  v_mov_b32 v211, 0
  s_mov_b64 exec, 1
  buffer_store_dword v211, v211, s[8:11], s71 offen sc1
  s_mov_b64 exec, -1
  s_mov_b32 s68, 1040356334
  s_lshl_b32 s69, s52, 9
  s_lshl_b32 s70, s58, 2
  s_add_u32 s70, s70, 128
  s_mul_i32 s66, s58, -12288
  s_lshl_b32 s54, s52, 10
  s_add_u32 s66, s66, s54
  s_add_u32 s66, s66, 524288
  v_mov_b32 v64, -1
  v_mov_b32 v65, -1
  v_mov_b32 v66, -1
  v_mov_b32 v67, -1
  s_cmp_eq_u32 s59, 0
  s_cbranch_scc0 KV_na
  s_mul_i32 s54, s58, 2176
  s_mul_i32 s55, s52, 69632
  s_add_u32 s55, s55, s54
  s_add_u32 s55, s55, 0
  s_add_u32 s54, s54, 278528
  s_lshl_b32 s56, s58, 14
  s_mul_i32 s57, s52, 3072
  s_add_u32 s56, s56, s57
  s_add_u32 s56, s56, 360448
  s_cmp_lt_u32 s58, 2
  s_cselect_b32 s56, s56, 268435456
  s_cmp_eq_u32 s52, 0
  s_cselect_b32 s54, s54, 268435456
  buffer_store_dwordx4 v[64:67], v201, s[8:11], s55 offen offset:0 sc1
  buffer_store_dwordx4 v[64:67], v201, s[8:11], s55 offen offset:1024 sc1
  buffer_store_dwordx4 v[64:67], v201, s[8:11], s54 offen offset:0 sc1
  buffer_store_dwordx4 v[64:67], v201, s[8:11], s54 offen offset:1024 sc1
  buffer_store_dwordx4 v[64:67], v201, s[8:11], s56 offen offset:0 sc1
  buffer_store_dwordx4 v[64:67], v201, s[8:11], s56 offen offset:1024 sc1
  buffer_store_dwordx4 v[64:67], v201, s[8:11], s56 offen offset:2048 sc1
KV_na:
  s_add_u32 s60, s60, 258048
  ds_read_b128 v[32:35], v203 offset:0
  ds_read_b128 v[36:39], v204 offset:0
  ds_read_b128 v[40:43], v205 offset:0
  s_waitcnt lgkmcnt(2)
  v_mfma_f32_32x32x16_bf16 v[0:15], a[0:3], v[32:35], 0
  ds_read_b128 v[44:47], v206 offset:0
  s_add_u32 m0, s67, 36864
  s_nop 0
  buffer_load_dwordx4 v202, s[4:7], s60 offen offset:0 lds
  v_mfma_f32_32x32x16_bf16 v[16:31], v[32:35], a[144:147], 0
  s_waitcnt lgkmcnt(2)
  v_mfma_f32_32x32x16_bf16 v[0:15], a[4:7], v[36:39], v[0:15]
  ds_read_b128 v[32:35], v203 offset:1024
  s_add_u32 m0, s67, 37760
  s_nop 0
  buffer_load_dwordx4 v202, s[4:7], s60 offen offset:128 lds
  v_mfma_f32_32x32x16_bf16 v[16:31], v[36:39], a[148:151], v[16:31]
  s_waitcnt lgkmcnt(2)
  v_mfma_f32_32x32x16_bf16 v[0:15], a[8:11], v[40:43], v[0:15]
  ds_read_b128 v[36:39], v204 offset:1024
  s_add_u32 m0, s67, 38656
  s_nop 0
  buffer_load_dwordx4 v202, s[4:7], s60 offen offset:256 lds
  v_mfma_f32_32x32x16_bf16 v[16:31], v[40:43], a[152:155], v[16:31]
  s_waitcnt lgkmcnt(2)
  v_mfma_f32_32x32x16_bf16 v[0:15], a[12:15], v[44:47], v[0:15]
  ds_read_b128 v[40:43], v205 offset:1024
  s_add_u32 m0, s67, 39552
  s_nop 0
  buffer_load_dwordx4 v202, s[4:7], s60 offen offset:384 lds
  v_mfma_f32_32x32x16_bf16 v[16:31], v[44:47], a[156:159], v[16:31]
  s_waitcnt lgkmcnt(2)
  v_mfma_f32_32x32x16_bf16 v[0:15], a[16:19], v[32:35], v[0:15]
  ds_read_b128 v[44:47], v206 offset:1024
  s_add_u32 m0, s67, 40448
  s_nop 0
  buffer_load_dwordx4 v202, s[4:7], s60 offen offset:512 lds
  v_mfma_f32_32x32x16_bf16 v[16:31], v[32:35], a[160:163], v[16:31]
  s_waitcnt lgkmcnt(2)
  v_mfma_f32_32x32x16_bf16 v[0:15], a[20:23], v[36:39], v[0:15]
  ds_read_b128 v[32:35], v203 offset:2048
  s_add_u32 m0, s67, 41344
  s_nop 0
  buffer_load_dwordx4 v202, s[4:7], s60 offen offset:640 lds
  v_mfma_f32_32x32x16_bf16 v[16:31], v[36:39], a[164:167], v[16:31]
  s_waitcnt lgkmcnt(2)
  v_mfma_f32_32x32x16_bf16 v[0:15], a[24:27], v[40:43], v[0:15]
  ds_read_b128 v[36:39], v204 offset:2048
  s_add_u32 m0, s67, 42240
  s_nop 0
  buffer_load_dwordx4 v202, s[4:7], s60 offen offset:768 lds
  v_mfma_f32_32x32x16_bf16 v[16:31], v[40:43], a[168:171], v[16:31]
  s_waitcnt lgkmcnt(2)
  v_mfma_f32_32x32x16_bf16 v[0:15], a[28:31], v[44:47], v[0:15]
  ds_read_b128 v[40:43], v205 offset:2048
  s_add_u32 m0, s67, 43136
  s_nop 0
  buffer_load_dwordx4 v202, s[4:7], s60 offen offset:896 lds
  v_mfma_f32_32x32x16_bf16 v[16:31], v[44:47], a[172:175], v[16:31]
  s_waitcnt lgkmcnt(2)
  v_mfma_f32_32x32x16_bf16 v[0:15], a[32:35], v[32:35], v[0:15]
  ds_read_b128 v[44:47], v206 offset:2048
  s_add_u32 m0, s67, 44032
  s_nop 0
  buffer_load_dwordx4 v202, s[4:7], s60 offen offset:1024 lds
  v_mfma_f32_32x32x16_bf16 v[16:31], v[32:35], a[176:179], v[16:31]
  s_waitcnt lgkmcnt(2)
  v_mfma_f32_32x32x16_bf16 v[0:15], a[36:39], v[36:39], v[0:15]
  ds_read_b128 v[32:35], v203 offset:3072
  v_mfma_f32_32x32x16_bf16 v[16:31], v[36:39], a[180:183], v[16:31]
  s_waitcnt lgkmcnt(2)
  v_mfma_f32_32x32x16_bf16 v[0:15], a[40:43], v[40:43], v[0:15]
  ds_read_b128 v[36:39], v204 offset:3072
  v_mfma_f32_32x32x16_bf16 v[16:31], v[40:43], a[184:187], v[16:31]
  s_waitcnt lgkmcnt(2)
  v_mfma_f32_32x32x16_bf16 v[0:15], a[44:47], v[44:47], v[0:15]
  ds_read_b128 v[40:43], v205 offset:3072
  v_mfma_f32_32x32x16_bf16 v[16:31], v[44:47], a[188:191], v[16:31]
  s_waitcnt lgkmcnt(2)
  v_mfma_f32_32x32x16_bf16 v[0:15], a[48:51], v[32:35], v[0:15]
  ds_read_b128 v[44:47], v206 offset:3072
  v_mfma_f32_32x32x16_bf16 v[16:31], v[32:35], a[192:195], v[16:31]
  s_waitcnt lgkmcnt(2)
  v_mfma_f32_32x32x16_bf16 v[0:15], a[52:55], v[36:39], v[0:15]
  ds_read_b128 v[32:35], v203 offset:4096
  v_mfma_f32_32x32x16_bf16 v[16:31], v[36:39], a[196:199], v[16:31]
  s_waitcnt lgkmcnt(2)
  v_mfma_f32_32x32x16_bf16 v[0:15], a[56:59], v[40:43], v[0:15]
  ds_read_b128 v[36:39], v204 offset:4096
  v_mfma_f32_32x32x16_bf16 v[16:31], v[40:43], a[200:203], v[16:31]
  s_waitcnt lgkmcnt(2)
  v_mfma_f32_32x32x16_bf16 v[0:15], a[60:63], v[44:47], v[0:15]
  ds_read_b128 v[40:43], v205 offset:4096
  v_mfma_f32_32x32x16_bf16 v[16:31], v[44:47], a[204:207], v[16:31]
  s_waitcnt lgkmcnt(2)
  v_mfma_f32_32x32x16_bf16 v[0:15], a[64:67], v[32:35], v[0:15]
  ds_read_b128 v[44:47], v206 offset:4096
  v_mfma_f32_32x32x16_bf16 v[16:31], v[32:35], a[208:211], v[16:31]
  s_waitcnt lgkmcnt(2)
  v_mfma_f32_32x32x16_bf16 v[0:15], a[68:71], v[36:39], v[0:15]
  ds_read_b128 v[32:35], v203 offset:5120
  v_mfma_f32_32x32x16_bf16 v[16:31], v[36:39], a[212:215], v[16:31]
  s_waitcnt lgkmcnt(2)
  v_mfma_f32_32x32x16_bf16 v[0:15], a[72:75], v[40:43], v[0:15]
  ds_read_b128 v[36:39], v204 offset:5120
  v_mfma_f32_32x32x16_bf16 v[16:31], v[40:43], a[216:219], v[16:31]
  s_waitcnt lgkmcnt(2)
  v_mfma_f32_32x32x16_bf16 v[0:15], a[76:79], v[44:47], v[0:15]
  ds_read_b128 v[40:43], v205 offset:5120
  v_mfma_f32_32x32x16_bf16 v[16:31], v[44:47], a[220:223], v[16:31]
  s_waitcnt lgkmcnt(2)
  v_mfma_f32_32x32x16_bf16 v[0:15], a[80:83], v[32:35], v[0:15]
  ds_read_b128 v[44:47], v206 offset:5120
  v_mfma_f32_32x32x16_bf16 v[16:31], v[32:35], a[224:227], v[16:31]
  s_waitcnt lgkmcnt(2)
  v_mfma_f32_32x32x16_bf16 v[0:15], a[84:87], v[36:39], v[0:15]
  ds_read_b128 v[32:35], v203 offset:6144
  v_mfma_f32_32x32x16_bf16 v[16:31], v[36:39], a[228:231], v[16:31]
  s_waitcnt lgkmcnt(2)
  v_mfma_f32_32x32x16_bf16 v[0:15], a[88:91], v[40:43], v[0:15]
  ds_read_b128 v[36:39], v204 offset:6144
  v_mfma_f32_32x32x16_bf16 v[16:31], v[40:43], a[232:235], v[16:31]
  s_waitcnt lgkmcnt(2)
  v_mfma_f32_32x32x16_bf16 v[0:15], a[92:95], v[44:47], v[0:15]
  ds_read_b128 v[40:43], v205 offset:6144
  v_mfma_f32_32x32x16_bf16 v[16:31], v[44:47], a[236:239], v[16:31]
  s_waitcnt lgkmcnt(2)
  v_mfma_f32_32x32x16_bf16 v[0:15], a[96:99], v[32:35], v[0:15]
  ds_read_b128 v[44:47], v206 offset:6144
  v_mfma_f32_32x32x16_bf16 v[16:31], v[32:35], a[240:243], v[16:31]
  s_waitcnt lgkmcnt(2)
  v_mfma_f32_32x32x16_bf16 v[0:15], a[100:103], v[36:39], v[0:15]
  ds_read_b128 v[32:35], v203 offset:7168
  v_mfma_f32_32x32x16_bf16 v[16:31], v[36:39], a[244:247], v[16:31]
  s_waitcnt lgkmcnt(2)
  v_mfma_f32_32x32x16_bf16 v[0:15], a[104:107], v[40:43], v[0:15]
  ds_read_b128 v[36:39], v204 offset:7168
  v_mfma_f32_32x32x16_bf16 v[16:31], v[40:43], a[248:251], v[16:31]
  s_waitcnt lgkmcnt(2)
  v_mfma_f32_32x32x16_bf16 v[0:15], a[108:111], v[44:47], v[0:15]
  ds_read_b128 v[40:43], v205 offset:7168
  v_mfma_f32_32x32x16_bf16 v[16:31], v[44:47], a[252:255], v[16:31]
  s_waitcnt lgkmcnt(2)
  v_mfma_f32_32x32x16_bf16 v[0:15], a[112:115], v[32:35], v[0:15]
  ds_read_b128 v[44:47], v206 offset:7168
  v_mfma_f32_32x32x16_bf16 v[16:31], v[32:35], v[224:227], v[16:31]
  s_waitcnt lgkmcnt(2)
  v_mfma_f32_32x32x16_bf16 v[0:15], a[116:119], v[36:39], v[0:15]
  ds_read_b128 v[32:35], v203 offset:8192
  v_mfma_f32_32x32x16_bf16 v[16:31], v[36:39], v[228:231], v[16:31]
  s_waitcnt lgkmcnt(2)
  v_mfma_f32_32x32x16_bf16 v[0:15], a[120:123], v[40:43], v[0:15]
  ds_read_b128 v[36:39], v204 offset:8192
  v_mfma_f32_32x32x16_bf16 v[16:31], v[40:43], v[232:235], v[16:31]
  s_waitcnt lgkmcnt(2)
  v_mfma_f32_32x32x16_bf16 v[0:15], a[124:127], v[44:47], v[0:15]
  ds_read_b128 v[40:43], v205 offset:8192
  v_mfma_f32_32x32x16_bf16 v[16:31], v[44:47], v[236:239], v[16:31]
  s_waitcnt lgkmcnt(2)
  v_mfma_f32_32x32x16_bf16 v[0:15], a[128:131], v[32:35], v[0:15]
  ds_read_b128 v[44:47], v206 offset:8192
  v_mfma_f32_32x32x16_bf16 v[16:31], v[32:35], v[240:243], v[16:31]
  s_waitcnt lgkmcnt(2)
  v_mfma_f32_32x32x16_bf16 v[0:15], a[132:135], v[36:39], v[0:15]
  v_mfma_f32_32x32x16_bf16 v[16:31], v[36:39], v[244:247], v[16:31]
  s_waitcnt lgkmcnt(1)
  v_mfma_f32_32x32x16_bf16 v[0:15], a[136:139], v[40:43], v[0:15]
  v_mfma_f32_32x32x16_bf16 v[16:31], v[40:43], v[248:251], v[16:31]
  s_waitcnt lgkmcnt(0)
  v_mfma_f32_32x32x16_bf16 v[0:15], a[140:143], v[44:47], v[0:15]
  v_mfma_f32_32x32x16_bf16 v[16:31], v[44:47], v[252:255], v[16:31]
  s_mul_i32 s64, s59, 655360
  s_lshl_b32 s55, s58, 14
  s_add_u32 s64, s64, s55
  s_add_u32 s64, s64, 1048576
  s_add_u32 s72, s64, s69
  s_add_u32 s73, s64, s66
  s_add_u32 s59, s59, 7
  s_waitcnt vmcnt(0)
  s_barrier
KV_loop:
  s_add_u32 s60, s60, 258048
  ds_read_b128 v[32:35], v203 offset:36864
  ds_read_b128 v[36:39], v204 offset:36864
  ds_read_b128 v[40:43], v205 offset:36864
  s_waitcnt lgkmcnt(2)
  v_mfma_f32_32x32x16_bf16 v[68:83], a[0:3], v[32:35], 0
  ds_read_b128 v[44:47], v206 offset:36864
  s_add_u32 m0, s67, 0
  s_nop 0
  buffer_load_dwordx4 v202, s[4:7], s60 offen offset:0 lds
  v_mfma_f32_32x32x16_bf16 v[84:99], v[32:35], a[144:147], 0
  s_waitcnt lgkmcnt(2)
  v_mfma_f32_32x32x16_bf16 v[68:83], a[4:7], v[36:39], v[68:83]
  ds_read_b128 v[32:35], v203 offset:37888
  s_add_u32 m0, s67, 896
  s_nop 0
  buffer_load_dwordx4 v202, s[4:7], s60 offen offset:128 lds
  v_mfma_f32_32x32x16_bf16 v[84:99], v[36:39], a[148:151], v[84:99]
  s_waitcnt lgkmcnt(2)
  v_mfma_f32_32x32x16_bf16 v[68:83], a[8:11], v[40:43], v[68:83]
  ds_read_b128 v[36:39], v204 offset:37888
  s_add_u32 m0, s67, 1792
  s_nop 0
  buffer_load_dwordx4 v202, s[4:7], s60 offen offset:256 lds
  v_mfma_f32_32x32x16_bf16 v[84:99], v[40:43], a[152:155], v[84:99]
  s_waitcnt lgkmcnt(2)
  v_mfma_f32_32x32x16_bf16 v[68:83], a[12:15], v[44:47], v[68:83]
  ds_read_b128 v[40:43], v205 offset:37888
  s_add_u32 m0, s67, 2688
  s_nop 0
  buffer_load_dwordx4 v202, s[4:7], s60 offen offset:384 lds
  v_mfma_f32_32x32x16_bf16 v[84:99], v[44:47], a[156:159], v[84:99]
  s_waitcnt lgkmcnt(2)
  v_mfma_f32_32x32x16_bf16 v[68:83], a[16:19], v[32:35], v[68:83]
  ds_read_b128 v[44:47], v206 offset:37888
  s_add_u32 m0, s67, 3584
  s_nop 0
  buffer_load_dwordx4 v202, s[4:7], s60 offen offset:512 lds
  v_mfma_f32_32x32x16_bf16 v[84:99], v[32:35], a[160:163], v[84:99]
  s_waitcnt lgkmcnt(2)
  v_mfma_f32_32x32x16_bf16 v[68:83], a[20:23], v[36:39], v[68:83]
  ds_read_b128 v[32:35], v203 offset:38912
  s_add_u32 m0, s67, 4480
  s_nop 0
  buffer_load_dwordx4 v202, s[4:7], s60 offen offset:640 lds
  v_mfma_f32_32x32x16_bf16 v[84:99], v[36:39], a[164:167], v[84:99]
  s_waitcnt lgkmcnt(2)
  v_mfma_f32_32x32x16_bf16 v[68:83], a[24:27], v[40:43], v[68:83]
  ds_read_b128 v[36:39], v204 offset:38912
  s_add_u32 m0, s67, 5376
  s_nop 0
  buffer_load_dwordx4 v202, s[4:7], s60 offen offset:768 lds
  v_mfma_f32_32x32x16_bf16 v[84:99], v[40:43], a[168:171], v[84:99]
  s_waitcnt lgkmcnt(2)
  v_mfma_f32_32x32x16_bf16 v[68:83], a[28:31], v[44:47], v[68:83]
  ds_read_b128 v[40:43], v205 offset:38912
  s_add_u32 m0, s67, 6272
  s_nop 0
  buffer_load_dwordx4 v202, s[4:7], s60 offen offset:896 lds
  v_mfma_f32_32x32x16_bf16 v[84:99], v[44:47], a[172:175], v[84:99]
  s_waitcnt lgkmcnt(2)
  v_mfma_f32_32x32x16_bf16 v[68:83], a[32:35], v[32:35], v[68:83]
  ds_read_b128 v[44:47], v206 offset:38912
  s_add_u32 m0, s67, 7168
  s_nop 0
  buffer_load_dwordx4 v202, s[4:7], s60 offen offset:1024 lds
  v_mfma_f32_32x32x16_bf16 v[84:99], v[32:35], a[176:179], v[84:99]
  s_waitcnt lgkmcnt(2)
  v_mfma_f32_32x32x16_bf16 v[68:83], a[36:39], v[36:39], v[68:83]
  ds_read_b128 v[32:35], v203 offset:39936
  v_mul_f32 v0, s68, v0
  v_mul_f32 v1, s68, v1
  v_mul_f32 v2, s68, v2
  v_mul_f32 v3, s68, v3
  v_mfma_f32_32x32x16_bf16 v[84:99], v[36:39], a[180:183], v[84:99]
  v_mul_f32 v4, s68, v4
  v_mul_f32 v5, s68, v5
  v_mul_f32 v6, s68, v6
  v_mul_f32 v7, s68, v7
  s_waitcnt lgkmcnt(2)
  v_mfma_f32_32x32x16_bf16 v[68:83], a[40:43], v[40:43], v[68:83]
  ds_read_b128 v[36:39], v204 offset:39936
  v_cvt_pk_bf16_f32 v48, v0, v4
  v_cvt_pk_bf16_f32 v49, v1, v5
  v_cvt_pk_bf16_f32 v50, v2, v6
  v_cvt_pk_bf16_f32 v51, v3, v7
  v_mfma_f32_32x32x16_bf16 v[84:99], v[40:43], a[184:187], v[84:99]
  buffer_store_dwordx4 v[48:51], v216, s[8:11], s72 offen offset:0 sc1
  s_waitcnt lgkmcnt(2)
  v_mfma_f32_32x32x16_bf16 v[68:83], a[44:47], v[44:47], v[68:83]
  ds_read_b128 v[40:43], v205 offset:39936
  v_mfma_f32_32x32x16_bf16 v[84:99], v[44:47], a[188:191], v[84:99]
  s_waitcnt lgkmcnt(2)
  v_mfma_f32_32x32x16_bf16 v[68:83], a[48:51], v[32:35], v[68:83]
  ds_read_b128 v[44:47], v206 offset:39936
  v_mul_f32 v8, s68, v8
  v_mul_f32 v9, s68, v9
  v_mul_f32 v10, s68, v10
  v_mul_f32 v11, s68, v11
  v_mfma_f32_32x32x16_bf16 v[84:99], v[32:35], a[192:195], v[84:99]
  v_mul_f32 v12, s68, v12
  v_mul_f32 v13, s68, v13
  v_mul_f32 v14, s68, v14
  v_mul_f32 v15, s68, v15
  s_waitcnt lgkmcnt(2)
  v_mfma_f32_32x32x16_bf16 v[68:83], a[52:55], v[36:39], v[68:83]
  ds_read_b128 v[32:35], v203 offset:40960
  v_cvt_pk_bf16_f32 v52, v8, v12
  v_cvt_pk_bf16_f32 v53, v9, v13
  v_cvt_pk_bf16_f32 v54, v10, v14
  v_cvt_pk_bf16_f32 v55, v11, v15
  v_mfma_f32_32x32x16_bf16 v[84:99], v[36:39], a[196:199], v[84:99]
  buffer_store_dwordx4 v[52:55], v216, s[8:11], s72 offen offset:256 sc1
  s_waitcnt lgkmcnt(2)
  v_mfma_f32_32x32x16_bf16 v[68:83], a[56:59], v[40:43], v[68:83]
  ds_read_b128 v[36:39], v204 offset:40960
  v_mfma_f32_32x32x16_bf16 v[84:99], v[40:43], a[200:203], v[84:99]
  s_waitcnt lgkmcnt(2)
  v_mfma_f32_32x32x16_bf16 v[68:83], a[60:63], v[44:47], v[68:83]
  ds_read_b128 v[40:43], v205 offset:40960
  v_cvt_pk_bf16_f32 v56, v16, v17
  v_cvt_pk_bf16_f32 v57, v20, v21
  v_cvt_pk_bf16_f32 v58, v24, v25
  v_cvt_pk_bf16_f32 v59, v28, v29
  v_mfma_f32_32x32x16_bf16 v[84:99], v[44:47], a[204:207], v[84:99]
  buffer_store_dwordx4 v[56:59], v217, s[8:11], s64 offen offset:0 sc1
  s_waitcnt lgkmcnt(2)
  v_mfma_f32_32x32x16_bf16 v[68:83], a[64:67], v[32:35], v[68:83]
  ds_read_b128 v[44:47], v206 offset:40960
  v_mfma_f32_32x32x16_bf16 v[84:99], v[32:35], a[208:211], v[84:99]
  s_waitcnt lgkmcnt(2)
  v_mfma_f32_32x32x16_bf16 v[68:83], a[68:71], v[36:39], v[68:83]
  ds_read_b128 v[32:35], v203 offset:41984
  v_cvt_pk_bf16_f32 v60, v18, v19
  v_cvt_pk_bf16_f32 v61, v22, v23
  v_cvt_pk_bf16_f32 v62, v26, v27
  v_cvt_pk_bf16_f32 v63, v30, v31
  v_mfma_f32_32x32x16_bf16 v[84:99], v[36:39], a[212:215], v[84:99]
  buffer_store_dwordx4 v[60:63], v217, s[8:11], s64 offen offset:256 sc1
  s_waitcnt lgkmcnt(2)
  v_mfma_f32_32x32x16_bf16 v[68:83], a[72:75], v[40:43], v[68:83]
  ds_read_b128 v[36:39], v204 offset:41984
  v_mfma_f32_32x32x16_bf16 v[84:99], v[40:43], a[216:219], v[84:99]
  s_waitcnt lgkmcnt(2)
  v_mfma_f32_32x32x16_bf16 v[68:83], a[76:79], v[44:47], v[68:83]
  ds_read_b128 v[40:43], v205 offset:41984
  buffer_store_dwordx4 v[64:67], v201, s[8:11], s73 offen sc1
  v_mfma_f32_32x32x16_bf16 v[84:99], v[44:47], a[220:223], v[84:99]
  s_waitcnt lgkmcnt(2)
  v_mfma_f32_32x32x16_bf16 v[68:83], a[80:83], v[32:35], v[68:83]
  ds_read_b128 v[44:47], v206 offset:41984
  v_mfma_f32_32x32x16_bf16 v[84:99], v[32:35], a[224:227], v[84:99]
  s_waitcnt lgkmcnt(2)
  v_mfma_f32_32x32x16_bf16 v[68:83], a[84:87], v[36:39], v[68:83]
  ds_read_b128 v[32:35], v203 offset:43008
  v_mfma_f32_32x32x16_bf16 v[84:99], v[36:39], a[228:231], v[84:99]
  s_waitcnt lgkmcnt(2)
  v_mfma_f32_32x32x16_bf16 v[68:83], a[88:91], v[40:43], v[68:83]
  ds_read_b128 v[36:39], v204 offset:43008
  v_mfma_f32_32x32x16_bf16 v[84:99], v[40:43], a[232:235], v[84:99]
  s_waitcnt lgkmcnt(2)
  v_mfma_f32_32x32x16_bf16 v[68:83], a[92:95], v[44:47], v[68:83]
  ds_read_b128 v[40:43], v205 offset:43008
  v_mfma_f32_32x32x16_bf16 v[84:99], v[44:47], a[236:239], v[84:99]
  s_waitcnt lgkmcnt(2)
  v_mfma_f32_32x32x16_bf16 v[68:83], a[96:99], v[32:35], v[68:83]
  ds_read_b128 v[44:47], v206 offset:43008
  v_mfma_f32_32x32x16_bf16 v[84:99], v[32:35], a[240:243], v[84:99]
  s_waitcnt lgkmcnt(2)
  v_mfma_f32_32x32x16_bf16 v[68:83], a[100:103], v[36:39], v[68:83]
  ds_read_b128 v[32:35], v203 offset:44032
  v_mfma_f32_32x32x16_bf16 v[84:99], v[36:39], a[244:247], v[84:99]
  s_waitcnt lgkmcnt(2)
  v_mfma_f32_32x32x16_bf16 v[68:83], a[104:107], v[40:43], v[68:83]
  ds_read_b128 v[36:39], v204 offset:44032
  v_mfma_f32_32x32x16_bf16 v[84:99], v[40:43], a[248:251], v[84:99]
  s_waitcnt lgkmcnt(2)
  v_mfma_f32_32x32x16_bf16 v[68:83], a[108:111], v[44:47], v[68:83]
  ds_read_b128 v[40:43], v205 offset:44032
  v_mfma_f32_32x32x16_bf16 v[84:99], v[44:47], a[252:255], v[84:99]
  s_waitcnt lgkmcnt(2)
  v_mfma_f32_32x32x16_bf16 v[68:83], a[112:115], v[32:35], v[68:83]
  ds_read_b128 v[44:47], v206 offset:44032
  v_mfma_f32_32x32x16_bf16 v[84:99], v[32:35], v[224:227], v[84:99]
  s_waitcnt lgkmcnt(2)
  v_mfma_f32_32x32x16_bf16 v[68:83], a[116:119], v[36:39], v[68:83]
  ds_read_b128 v[32:35], v203 offset:45056
  v_mfma_f32_32x32x16_bf16 v[84:99], v[36:39], v[228:231], v[84:99]
  s_waitcnt lgkmcnt(2)
  v_mfma_f32_32x32x16_bf16 v[68:83], a[120:123], v[40:43], v[68:83]
  ds_read_b128 v[36:39], v204 offset:45056
  v_mfma_f32_32x32x16_bf16 v[84:99], v[40:43], v[232:235], v[84:99]
  s_waitcnt lgkmcnt(2)
  v_mfma_f32_32x32x16_bf16 v[68:83], a[124:127], v[44:47], v[68:83]
  ds_read_b128 v[40:43], v205 offset:45056
  v_mfma_f32_32x32x16_bf16 v[84:99], v[44:47], v[236:239], v[84:99]
  s_waitcnt lgkmcnt(2)
  v_mfma_f32_32x32x16_bf16 v[68:83], a[128:131], v[32:35], v[68:83]
  ds_read_b128 v[44:47], v206 offset:45056
  v_mfma_f32_32x32x16_bf16 v[84:99], v[32:35], v[240:243], v[84:99]
  s_waitcnt lgkmcnt(2)
  v_mfma_f32_32x32x16_bf16 v[68:83], a[132:135], v[36:39], v[68:83]
  v_mfma_f32_32x32x16_bf16 v[84:99], v[36:39], v[244:247], v[84:99]
  s_waitcnt lgkmcnt(1)
  v_mfma_f32_32x32x16_bf16 v[68:83], a[136:139], v[40:43], v[68:83]
  v_mfma_f32_32x32x16_bf16 v[84:99], v[40:43], v[248:251], v[84:99]
  s_waitcnt lgkmcnt(0)
  v_mfma_f32_32x32x16_bf16 v[68:83], a[140:143], v[44:47], v[68:83]
  v_mfma_f32_32x32x16_bf16 v[84:99], v[44:47], v[252:255], v[84:99]
  s_mul_i32 s64, s59, 655360
  s_lshl_b32 s55, s58, 14
  s_add_u32 s64, s64, s55
  s_add_u32 s64, s64, 1048576
  s_add_u32 s72, s64, s69
  s_add_u32 s73, s64, s66
  s_add_u32 s59, s59, 7
  s_cmp_ge_u32 s59, 64
  s_cbranch_scc1 KV_done1
  s_waitcnt vmcnt(5)
  s_barrier
  s_add_u32 s60, s60, 258048
  ds_read_b128 v[32:35], v203 offset:0
  ds_read_b128 v[36:39], v204 offset:0
  ds_read_b128 v[40:43], v205 offset:0
  s_waitcnt lgkmcnt(2)
  v_mfma_f32_32x32x16_bf16 v[0:15], a[0:3], v[32:35], 0
  ds_read_b128 v[44:47], v206 offset:0
  s_add_u32 m0, s67, 36864
  s_nop 0
  buffer_load_dwordx4 v202, s[4:7], s60 offen offset:0 lds
  v_mfma_f32_32x32x16_bf16 v[16:31], v[32:35], a[144:147], 0
  s_waitcnt lgkmcnt(2)
  v_mfma_f32_32x32x16_bf16 v[0:15], a[4:7], v[36:39], v[0:15]
  ds_read_b128 v[32:35], v203 offset:1024
  s_add_u32 m0, s67, 37760
  s_nop 0
  buffer_load_dwordx4 v202, s[4:7], s60 offen offset:128 lds
  v_mfma_f32_32x32x16_bf16 v[16:31], v[36:39], a[148:151], v[16:31]
  s_waitcnt lgkmcnt(2)
  v_mfma_f32_32x32x16_bf16 v[0:15], a[8:11], v[40:43], v[0:15]
  ds_read_b128 v[36:39], v204 offset:1024
  s_add_u32 m0, s67, 38656
  s_nop 0
  buffer_load_dwordx4 v202, s[4:7], s60 offen offset:256 lds
  v_mfma_f32_32x32x16_bf16 v[16:31], v[40:43], a[152:155], v[16:31]
  s_waitcnt lgkmcnt(2)
  v_mfma_f32_32x32x16_bf16 v[0:15], a[12:15], v[44:47], v[0:15]
  ds_read_b128 v[40:43], v205 offset:1024
  s_add_u32 m0, s67, 39552
  s_nop 0
  buffer_load_dwordx4 v202, s[4:7], s60 offen offset:384 lds
  v_mfma_f32_32x32x16_bf16 v[16:31], v[44:47], a[156:159], v[16:31]
  s_waitcnt lgkmcnt(2)
  v_mfma_f32_32x32x16_bf16 v[0:15], a[16:19], v[32:35], v[0:15]
  ds_read_b128 v[44:47], v206 offset:1024
  s_add_u32 m0, s67, 40448
  s_nop 0
  buffer_load_dwordx4 v202, s[4:7], s60 offen offset:512 lds
  v_mfma_f32_32x32x16_bf16 v[16:31], v[32:35], a[160:163], v[16:31]
  s_waitcnt lgkmcnt(2)
  v_mfma_f32_32x32x16_bf16 v[0:15], a[20:23], v[36:39], v[0:15]
  ds_read_b128 v[32:35], v203 offset:2048
  s_add_u32 m0, s67, 41344
  s_nop 0
  buffer_load_dwordx4 v202, s[4:7], s60 offen offset:640 lds
  v_mfma_f32_32x32x16_bf16 v[16:31], v[36:39], a[164:167], v[16:31]
  s_waitcnt lgkmcnt(2)
  v_mfma_f32_32x32x16_bf16 v[0:15], a[24:27], v[40:43], v[0:15]
  ds_read_b128 v[36:39], v204 offset:2048
  s_add_u32 m0, s67, 42240
  s_nop 0
  buffer_load_dwordx4 v202, s[4:7], s60 offen offset:768 lds
  v_mfma_f32_32x32x16_bf16 v[16:31], v[40:43], a[168:171], v[16:31]
  s_waitcnt lgkmcnt(2)
  v_mfma_f32_32x32x16_bf16 v[0:15], a[28:31], v[44:47], v[0:15]
  ds_read_b128 v[40:43], v205 offset:2048
  s_add_u32 m0, s67, 43136
  s_nop 0
  buffer_load_dwordx4 v202, s[4:7], s60 offen offset:896 lds
  v_mfma_f32_32x32x16_bf16 v[16:31], v[44:47], a[172:175], v[16:31]
  s_waitcnt lgkmcnt(2)
  v_mfma_f32_32x32x16_bf16 v[0:15], a[32:35], v[32:35], v[0:15]
  ds_read_b128 v[44:47], v206 offset:2048
  s_add_u32 m0, s67, 44032
  s_nop 0
  buffer_load_dwordx4 v202, s[4:7], s60 offen offset:1024 lds
  v_mfma_f32_32x32x16_bf16 v[16:31], v[32:35], a[176:179], v[16:31]
  s_waitcnt lgkmcnt(2)
  v_mfma_f32_32x32x16_bf16 v[0:15], a[36:39], v[36:39], v[0:15]
  ds_read_b128 v[32:35], v203 offset:3072
  v_mul_f32 v68, s68, v68
  v_mul_f32 v69, s68, v69
  v_mul_f32 v70, s68, v70
  v_mul_f32 v71, s68, v71
  v_mfma_f32_32x32x16_bf16 v[16:31], v[36:39], a[180:183], v[16:31]
  v_mul_f32 v72, s68, v72
  v_mul_f32 v73, s68, v73
  v_mul_f32 v74, s68, v74
  v_mul_f32 v75, s68, v75
  s_waitcnt lgkmcnt(2)
  v_mfma_f32_32x32x16_bf16 v[0:15], a[40:43], v[40:43], v[0:15]
  ds_read_b128 v[36:39], v204 offset:3072
  v_cvt_pk_bf16_f32 v48, v68, v72
  v_cvt_pk_bf16_f32 v49, v69, v73
  v_cvt_pk_bf16_f32 v50, v70, v74
  v_cvt_pk_bf16_f32 v51, v71, v75
  v_mfma_f32_32x32x16_bf16 v[16:31], v[40:43], a[184:187], v[16:31]
  buffer_store_dwordx4 v[48:51], v216, s[8:11], s72 offen offset:0 sc1
  s_waitcnt lgkmcnt(2)
  v_mfma_f32_32x32x16_bf16 v[0:15], a[44:47], v[44:47], v[0:15]
  ds_read_b128 v[40:43], v205 offset:3072
  v_mfma_f32_32x32x16_bf16 v[16:31], v[44:47], a[188:191], v[16:31]
  s_waitcnt lgkmcnt(2)
  v_mfma_f32_32x32x16_bf16 v[0:15], a[48:51], v[32:35], v[0:15]
  ds_read_b128 v[44:47], v206 offset:3072
  v_mul_f32 v76, s68, v76
  v_mul_f32 v77, s68, v77
  v_mul_f32 v78, s68, v78
  v_mul_f32 v79, s68, v79
  v_mfma_f32_32x32x16_bf16 v[16:31], v[32:35], a[192:195], v[16:31]
  v_mul_f32 v80, s68, v80
  v_mul_f32 v81, s68, v81
  v_mul_f32 v82, s68, v82
  v_mul_f32 v83, s68, v83
  s_waitcnt lgkmcnt(2)
  v_mfma_f32_32x32x16_bf16 v[0:15], a[52:55], v[36:39], v[0:15]
  ds_read_b128 v[32:35], v203 offset:4096
  v_cvt_pk_bf16_f32 v52, v76, v80
  v_cvt_pk_bf16_f32 v53, v77, v81
  v_cvt_pk_bf16_f32 v54, v78, v82
  v_cvt_pk_bf16_f32 v55, v79, v83
  v_mfma_f32_32x32x16_bf16 v[16:31], v[36:39], a[196:199], v[16:31]
  buffer_store_dwordx4 v[52:55], v216, s[8:11], s72 offen offset:256 sc1
  s_waitcnt lgkmcnt(2)
  v_mfma_f32_32x32x16_bf16 v[0:15], a[56:59], v[40:43], v[0:15]
  ds_read_b128 v[36:39], v204 offset:4096
  v_mfma_f32_32x32x16_bf16 v[16:31], v[40:43], a[200:203], v[16:31]
  s_waitcnt lgkmcnt(2)
  v_mfma_f32_32x32x16_bf16 v[0:15], a[60:63], v[44:47], v[0:15]
  ds_read_b128 v[40:43], v205 offset:4096
  v_cvt_pk_bf16_f32 v56, v84, v85
  v_cvt_pk_bf16_f32 v57, v88, v89
  v_cvt_pk_bf16_f32 v58, v92, v93
  v_cvt_pk_bf16_f32 v59, v96, v97
  v_mfma_f32_32x32x16_bf16 v[16:31], v[44:47], a[204:207], v[16:31]
  buffer_store_dwordx4 v[56:59], v217, s[8:11], s64 offen offset:0 sc1
  s_waitcnt lgkmcnt(2)
  v_mfma_f32_32x32x16_bf16 v[0:15], a[64:67], v[32:35], v[0:15]
  ds_read_b128 v[44:47], v206 offset:4096
  v_mfma_f32_32x32x16_bf16 v[16:31], v[32:35], a[208:211], v[16:31]
  s_waitcnt lgkmcnt(2)
  v_mfma_f32_32x32x16_bf16 v[0:15], a[68:71], v[36:39], v[0:15]
  ds_read_b128 v[32:35], v203 offset:5120
  v_cvt_pk_bf16_f32 v60, v86, v87
  v_cvt_pk_bf16_f32 v61, v90, v91
  v_cvt_pk_bf16_f32 v62, v94, v95
  v_cvt_pk_bf16_f32 v63, v98, v99
  v_mfma_f32_32x32x16_bf16 v[16:31], v[36:39], a[212:215], v[16:31]
  buffer_store_dwordx4 v[60:63], v217, s[8:11], s64 offen offset:256 sc1
  s_waitcnt lgkmcnt(2)
  v_mfma_f32_32x32x16_bf16 v[0:15], a[72:75], v[40:43], v[0:15]
  ds_read_b128 v[36:39], v204 offset:5120
  v_mfma_f32_32x32x16_bf16 v[16:31], v[40:43], a[216:219], v[16:31]
  s_waitcnt lgkmcnt(2)
  v_mfma_f32_32x32x16_bf16 v[0:15], a[76:79], v[44:47], v[0:15]
  ds_read_b128 v[40:43], v205 offset:5120
  buffer_store_dwordx4 v[64:67], v201, s[8:11], s73 offen sc1
  v_mfma_f32_32x32x16_bf16 v[16:31], v[44:47], a[220:223], v[16:31]
  s_waitcnt lgkmcnt(2)
  v_mfma_f32_32x32x16_bf16 v[0:15], a[80:83], v[32:35], v[0:15]
  ds_read_b128 v[44:47], v206 offset:5120
  v_mfma_f32_32x32x16_bf16 v[16:31], v[32:35], a[224:227], v[16:31]
  s_waitcnt lgkmcnt(2)
  v_mfma_f32_32x32x16_bf16 v[0:15], a[84:87], v[36:39], v[0:15]
  ds_read_b128 v[32:35], v203 offset:6144
  v_mfma_f32_32x32x16_bf16 v[16:31], v[36:39], a[228:231], v[16:31]
  s_waitcnt lgkmcnt(2)
  v_mfma_f32_32x32x16_bf16 v[0:15], a[88:91], v[40:43], v[0:15]
  ds_read_b128 v[36:39], v204 offset:6144
  v_mfma_f32_32x32x16_bf16 v[16:31], v[40:43], a[232:235], v[16:31]
  s_waitcnt lgkmcnt(2)
  v_mfma_f32_32x32x16_bf16 v[0:15], a[92:95], v[44:47], v[0:15]
  ds_read_b128 v[40:43], v205 offset:6144
  v_mfma_f32_32x32x16_bf16 v[16:31], v[44:47], a[236:239], v[16:31]
  s_waitcnt lgkmcnt(2)
  v_mfma_f32_32x32x16_bf16 v[0:15], a[96:99], v[32:35], v[0:15]
  ds_read_b128 v[44:47], v206 offset:6144
  v_mfma_f32_32x32x16_bf16 v[16:31], v[32:35], a[240:243], v[16:31]
  s_waitcnt lgkmcnt(2)
  v_mfma_f32_32x32x16_bf16 v[0:15], a[100:103], v[36:39], v[0:15]
  ds_read_b128 v[32:35], v203 offset:7168
  v_mfma_f32_32x32x16_bf16 v[16:31], v[36:39], a[244:247], v[16:31]
  s_waitcnt lgkmcnt(2)
  v_mfma_f32_32x32x16_bf16 v[0:15], a[104:107], v[40:43], v[0:15]
  ds_read_b128 v[36:39], v204 offset:7168
  v_mfma_f32_32x32x16_bf16 v[16:31], v[40:43], a[248:251], v[16:31]
  s_waitcnt lgkmcnt(2)
  v_mfma_f32_32x32x16_bf16 v[0:15], a[108:111], v[44:47], v[0:15]
  ds_read_b128 v[40:43], v205 offset:7168
  v_mfma_f32_32x32x16_bf16 v[16:31], v[44:47], a[252:255], v[16:31]
  s_waitcnt lgkmcnt(2)
  v_mfma_f32_32x32x16_bf16 v[0:15], a[112:115], v[32:35], v[0:15]
  ds_read_b128 v[44:47], v206 offset:7168
  v_mfma_f32_32x32x16_bf16 v[16:31], v[32:35], v[224:227], v[16:31]
  s_waitcnt lgkmcnt(2)
  v_mfma_f32_32x32x16_bf16 v[0:15], a[116:119], v[36:39], v[0:15]
  ds_read_b128 v[32:35], v203 offset:8192
  v_mfma_f32_32x32x16_bf16 v[16:31], v[36:39], v[228:231], v[16:31]
  s_waitcnt lgkmcnt(2)
  v_mfma_f32_32x32x16_bf16 v[0:15], a[120:123], v[40:43], v[0:15]
  ds_read_b128 v[36:39], v204 offset:8192
  v_mfma_f32_32x32x16_bf16 v[16:31], v[40:43], v[232:235], v[16:31]
  s_waitcnt lgkmcnt(2)
  v_mfma_f32_32x32x16_bf16 v[0:15], a[124:127], v[44:47], v[0:15]
  ds_read_b128 v[40:43], v205 offset:8192
  v_mfma_f32_32x32x16_bf16 v[16:31], v[44:47], v[236:239], v[16:31]
  s_waitcnt lgkmcnt(2)
  v_mfma_f32_32x32x16_bf16 v[0:15], a[128:131], v[32:35], v[0:15]
  ds_read_b128 v[44:47], v206 offset:8192
  v_mfma_f32_32x32x16_bf16 v[16:31], v[32:35], v[240:243], v[16:31]
  s_waitcnt lgkmcnt(2)
  v_mfma_f32_32x32x16_bf16 v[0:15], a[132:135], v[36:39], v[0:15]
  v_mfma_f32_32x32x16_bf16 v[16:31], v[36:39], v[244:247], v[16:31]
  s_waitcnt lgkmcnt(1)
  v_mfma_f32_32x32x16_bf16 v[0:15], a[136:139], v[40:43], v[0:15]
  v_mfma_f32_32x32x16_bf16 v[16:31], v[40:43], v[248:251], v[16:31]
  s_waitcnt lgkmcnt(0)
  v_mfma_f32_32x32x16_bf16 v[0:15], a[140:143], v[44:47], v[0:15]
  v_mfma_f32_32x32x16_bf16 v[16:31], v[44:47], v[252:255], v[16:31]
  s_mul_i32 s64, s59, 655360
  s_lshl_b32 s55, s58, 14
  s_add_u32 s64, s64, s55
  s_add_u32 s64, s64, 1048576
  s_add_u32 s72, s64, s69
  s_add_u32 s73, s64, s66
  s_add_u32 s59, s59, 7
  s_cmp_ge_u32 s59, 64
  s_cbranch_scc1 KV_done0
  s_sub_u32 s54, s59, 21
  s_cmp_lt_u32 s54, 7
  s_cbranch_scc1 KV_early
  s_waitcnt vmcnt(5)
  s_barrier
KV_cont:
  s_branch KV_loop
KV_early:
  s_waitcnt vmcnt(0)
  s_barrier
  s_cmp_eq_u32 s52, 0
  s_cbranch_scc0 KV_sig0
  v_mov_b32 v211, 1
  v_mov_b32 v212, 0
  s_mov_b64 exec, 1
  buffer_atomic_add v211, v212, s[12:15], s70 offen
  s_mov_b64 exec, -1
KV_sig0:
  s_branch KV_cont
KV_done1:
  s_nop 11
  v_mul_f32 v68, s68, v68
  v_mul_f32 v69, s68, v69
  v_mul_f32 v70, s68, v70
  v_mul_f32 v71, s68, v71
  v_mul_f32 v72, s68, v72
  v_mul_f32 v73, s68, v73
  v_mul_f32 v74, s68, v74
  v_mul_f32 v75, s68, v75
  v_cvt_pk_bf16_f32 v48, v68, v72
  v_cvt_pk_bf16_f32 v49, v69, v73
  v_cvt_pk_bf16_f32 v50, v70, v74
  v_cvt_pk_bf16_f32 v51, v71, v75
  buffer_store_dwordx4 v[48:51], v216, s[8:11], s72 offen offset:0 sc1
  v_mul_f32 v76, s68, v76
  v_mul_f32 v77, s68, v77
  v_mul_f32 v78, s68, v78
  v_mul_f32 v79, s68, v79
  v_mul_f32 v80, s68, v80
  v_mul_f32 v81, s68, v81
  v_mul_f32 v82, s68, v82
  v_mul_f32 v83, s68, v83
  v_cvt_pk_bf16_f32 v52, v76, v80
  v_cvt_pk_bf16_f32 v53, v77, v81
  v_cvt_pk_bf16_f32 v54, v78, v82
  v_cvt_pk_bf16_f32 v55, v79, v83
  buffer_store_dwordx4 v[52:55], v216, s[8:11], s72 offen offset:256 sc1
  v_cvt_pk_bf16_f32 v56, v84, v85
  v_cvt_pk_bf16_f32 v57, v88, v89
  v_cvt_pk_bf16_f32 v58, v92, v93
  v_cvt_pk_bf16_f32 v59, v96, v97
  buffer_store_dwordx4 v[56:59], v217, s[8:11], s64 offen offset:0 sc1
  v_cvt_pk_bf16_f32 v60, v86, v87
  v_cvt_pk_bf16_f32 v61, v90, v91
  v_cvt_pk_bf16_f32 v62, v94, v95
  v_cvt_pk_bf16_f32 v63, v98, v99
  buffer_store_dwordx4 v[60:63], v217, s[8:11], s64 offen offset:256 sc1
  buffer_store_dwordx4 v[64:67], v201, s[8:11], s73 offen sc1
  s_branch KV_fin
KV_done0:
  s_nop 11
  v_mul_f32 v0, s68, v0
  v_mul_f32 v1, s68, v1
  v_mul_f32 v2, s68, v2
  v_mul_f32 v3, s68, v3
  v_mul_f32 v4, s68, v4
  v_mul_f32 v5, s68, v5
  v_mul_f32 v6, s68, v6
  v_mul_f32 v7, s68, v7
  v_cvt_pk_bf16_f32 v48, v0, v4
  v_cvt_pk_bf16_f32 v49, v1, v5
  v_cvt_pk_bf16_f32 v50, v2, v6
  v_cvt_pk_bf16_f32 v51, v3, v7
  buffer_store_dwordx4 v[48:51], v216, s[8:11], s72 offen offset:0 sc1
  v_mul_f32 v8, s68, v8
  v_mul_f32 v9, s68, v9
  v_mul_f32 v10, s68, v10
  v_mul_f32 v11, s68, v11
  v_mul_f32 v12, s68, v12
  v_mul_f32 v13, s68, v13
  v_mul_f32 v14, s68, v14
  v_mul_f32 v15, s68, v15
  v_cvt_pk_bf16_f32 v52, v8, v12
  v_cvt_pk_bf16_f32 v53, v9, v13
  v_cvt_pk_bf16_f32 v54, v10, v14
  v_cvt_pk_bf16_f32 v55, v11, v15
  buffer_store_dwordx4 v[52:55], v216, s[8:11], s72 offen offset:256 sc1
  v_cvt_pk_bf16_f32 v56, v16, v17
  v_cvt_pk_bf16_f32 v57, v20, v21
  v_cvt_pk_bf16_f32 v58, v24, v25
  v_cvt_pk_bf16_f32 v59, v28, v29
  buffer_store_dwordx4 v[56:59], v217, s[8:11], s64 offen offset:0 sc1
  v_cvt_pk_bf16_f32 v60, v18, v19
  v_cvt_pk_bf16_f32 v61, v22, v23
  v_cvt_pk_bf16_f32 v62, v26, v27
  v_cvt_pk_bf16_f32 v63, v30, v31
  buffer_store_dwordx4 v[60:63], v217, s[8:11], s64 offen offset:256 sc1
  buffer_store_dwordx4 v[64:67], v201, s[8:11], s73 offen sc1
KV_fin:
  s_waitcnt vmcnt(0)
  s_barrier
  s_cmp_eq_u32 s52, 0
  s_cbranch_scc0 KV_sig
  v_mov_b32 v211, 256
  v_mov_b32 v212, 0
  s_mov_b64 exec, 1
  buffer_atomic_add v211, v212, s[12:15], s70 offen
  s_mov_b64 exec, -1
KV_sig:
  s_cmp_ge_u32 s53, 192
  s_cbranch_scc1 L_exit
  s_cmp_lt_u32 s53, 64
  s_cbranch_scc1 W_h
  s_sub_u32 s54, s53, 64
  s_lshr_b32 s68, s54, 4
  s_and_b32 s69, s54, 15
  s_lshl_b32 s60, s69, 2
  s_sub_u32 s60, s60, 1
  s_max_i32 s60, s60, 0
  s_mul_i32 s60, s60, 36864
  s_add_u32 m0, s67, 0
  s_nop 0
  buffer_load_dwordx4 v202, s[4:7], s60 offen offset:0 lds
  s_add_u32 m0, s67, 896
  s_nop 0
  buffer_load_dwordx4 v202, s[4:7], s60 offen offset:128 lds
  s_add_u32 m0, s67, 1792
  s_nop 0
  buffer_load_dwordx4 v202, s[4:7], s60 offen offset:256 lds
  s_add_u32 m0, s67, 2688
  s_nop 0
  buffer_load_dwordx4 v202, s[4:7], s60 offen offset:384 lds
  s_add_u32 m0, s67, 3584
  s_nop 0
  buffer_load_dwordx4 v202, s[4:7], s60 offen offset:512 lds
  s_add_u32 m0, s67, 4480
  s_nop 0
  buffer_load_dwordx4 v202, s[4:7], s60 offen offset:640 lds
  s_add_u32 m0, s67, 5376
  s_nop 0
  buffer_load_dwordx4 v202, s[4:7], s60 offen offset:768 lds
  s_add_u32 m0, s67, 6272
  s_nop 0
  buffer_load_dwordx4 v202, s[4:7], s60 offen offset:896 lds
  s_add_u32 m0, s67, 7168
  s_nop 0
  buffer_load_dwordx4 v202, s[4:7], s60 offen offset:1024 lds
  v_and_b32 v211, 15, v200
  v_mul_u32_u24 v211, 72, v211
  v_lshrrev_b32 v212, 4, v200
  v_mul_u32_u24 v213, 1152, v212
  v_add_u32 v213, v213, v211
  s_lshl_b32 s54, s54, 2
  s_add_u32 s70, s54, s52
  s_mul_i32 s55, s70, 4608
  buffer_load_dwordx4 v[48:51], v213, s[4:7], s55 offen offset:0
  buffer_load_dwordx4 v[52:55], v213, s[4:7], s55 offen offset:16
  buffer_load_dwordx4 v[56:59], v213, s[4:7], s55 offen offset:32
  buffer_load_dwordx4 v[60:63], v213, s[4:7], s55 offen offset:48
  buffer_load_dwordx2 v[64:65], v213, s[4:7], s55 offen offset:64
  buffer_load_dwordx4 v[68:71], v211, s[44:47], 0 offen offset:0
  buffer_load_dwordx4 v[72:75], v211, s[44:47], 0 offen offset:16
  buffer_load_dwordx4 v[76:79], v211, s[44:47], 0 offen offset:32
  buffer_load_dwordx4 v[80:83], v211, s[44:47], 0 offen offset:48
  buffer_load_dwordx2 v[84:85], v211, s[44:47], 0 offen offset:64
  v_mov_b32 v0, 0
  v_mov_b32 v1, 0x3f803f80
  s_waitcnt vmcnt(9)
  v_lshlrev_b32 v2, 16, v48
  s_waitcnt vmcnt(4)
  v_lshlrev_b32 v3, 16, v68
  v_and_b32 v4, 0xffff0000, v48
  v_and_b32 v5, 0xffff0000, v68
  v_mul_f32 v2, v2, v3
  v_mul_f32 v4, v4, v5
  v_cvt_pk_bf16_f32 v2, v2, v4
  v_lshlrev_b32 v3, 16, v2
  v_and_b32 v4, 0xffff0000, v2
  v_add_f32 v0, v0, v3
  v_add_f32 v0, v0, v4
  v_lshlrev_b32 v2, 16, v49
  v_lshlrev_b32 v3, 16, v69
  v_and_b32 v4, 0xffff0000, v49
  v_and_b32 v5, 0xffff0000, v69
  v_mul_f32 v2, v2, v3
  v_mul_f32 v4, v4, v5
  v_cvt_pk_bf16_f32 v2, v2, v4
  v_lshlrev_b32 v3, 16, v2
  v_and_b32 v4, 0xffff0000, v2
  v_add_f32 v0, v0, v3
  v_add_f32 v0, v0, v4
  v_lshlrev_b32 v2, 16, v50
  v_lshlrev_b32 v3, 16, v70
  v_and_b32 v4, 0xffff0000, v50
  v_and_b32 v5, 0xffff0000, v70
  v_mul_f32 v2, v2, v3
  v_mul_f32 v4, v4, v5
  v_cvt_pk_bf16_f32 v2, v2, v4
  v_lshlrev_b32 v3, 16, v2
  v_and_b32 v4, 0xffff0000, v2
  v_add_f32 v0, v0, v3
  v_add_f32 v0, v0, v4
  v_lshlrev_b32 v2, 16, v51
  v_lshlrev_b32 v3, 16, v71
  v_and_b32 v4, 0xffff0000, v51
  v_and_b32 v5, 0xffff0000, v71
  v_mul_f32 v2, v2, v3
  v_mul_f32 v4, v4, v5
  v_cvt_pk_bf16_f32 v2, v2, v4
  v_lshlrev_b32 v3, 16, v2
  v_and_b32 v4, 0xffff0000, v2
  v_add_f32 v0, v0, v3
  v_add_f32 v0, v0, v4
  v_lshlrev_b32 v2, 16, v52
  s_waitcnt vmcnt(3)
  v_lshlrev_b32 v3, 16, v72
  v_and_b32 v4, 0xffff0000, v52
  v_and_b32 v5, 0xffff0000, v72
  v_mul_f32 v2, v2, v3
  v_mul_f32 v4, v4, v5
  v_cvt_pk_bf16_f32 v2, v2, v4
  v_lshlrev_b32 v3, 16, v2
  v_and_b32 v4, 0xffff0000, v2
  v_add_f32 v0, v0, v3
  v_add_f32 v0, v0, v4
  v_lshlrev_b32 v2, 16, v53
  v_lshlrev_b32 v3, 16, v73
  v_and_b32 v4, 0xffff0000, v53
  v_and_b32 v5, 0xffff0000, v73
  v_mul_f32 v2, v2, v3
  v_mul_f32 v4, v4, v5
  v_cvt_pk_bf16_f32 v2, v2, v4
  v_lshlrev_b32 v3, 16, v2
  v_and_b32 v4, 0xffff0000, v2
  v_add_f32 v0, v0, v3
  v_add_f32 v0, v0, v4
  v_lshlrev_b32 v2, 16, v54
  v_lshlrev_b32 v3, 16, v74
  v_and_b32 v4, 0xffff0000, v54
  v_and_b32 v5, 0xffff0000, v74
  v_mul_f32 v2, v2, v3
  v_mul_f32 v4, v4, v5
  v_cvt_pk_bf16_f32 v2, v2, v4
  v_lshlrev_b32 v3, 16, v2
  v_and_b32 v4, 0xffff0000, v2
  v_add_f32 v0, v0, v3
  v_add_f32 v0, v0, v4
  v_lshlrev_b32 v2, 16, v55
  v_lshlrev_b32 v3, 16, v75
  v_and_b32 v4, 0xffff0000, v55
  v_and_b32 v5, 0xffff0000, v75
  v_mul_f32 v2, v2, v3
  v_mul_f32 v4, v4, v5
  v_cvt_pk_bf16_f32 v2, v2, v4
  v_lshlrev_b32 v3, 16, v2
  v_and_b32 v4, 0xffff0000, v2
  v_add_f32 v0, v0, v3
  v_add_f32 v0, v0, v4
  v_lshlrev_b32 v2, 16, v56
  s_waitcnt vmcnt(2)
  v_lshlrev_b32 v3, 16, v76
  v_and_b32 v4, 0xffff0000, v56
  v_and_b32 v5, 0xffff0000, v76
  v_mul_f32 v2, v2, v3
  v_mul_f32 v4, v4, v5
  v_cvt_pk_bf16_f32 v2, v2, v4
  v_lshlrev_b32 v3, 16, v2
  v_and_b32 v4, 0xffff0000, v2
  v_add_f32 v0, v0, v3
  v_add_f32 v0, v0, v4
  v_lshlrev_b32 v2, 16, v57
  v_lshlrev_b32 v3, 16, v77
  v_and_b32 v4, 0xffff0000, v57
  v_and_b32 v5, 0xffff0000, v77
  v_mul_f32 v2, v2, v3
  v_mul_f32 v4, v4, v5
  v_cvt_pk_bf16_f32 v2, v2, v4
  v_lshlrev_b32 v3, 16, v2
  v_and_b32 v4, 0xffff0000, v2
  v_add_f32 v0, v0, v3
  v_add_f32 v0, v0, v4
  v_lshlrev_b32 v2, 16, v58
  v_lshlrev_b32 v3, 16, v78
  v_and_b32 v4, 0xffff0000, v58
  v_and_b32 v5, 0xffff0000, v78
  v_mul_f32 v2, v2, v3
  v_mul_f32 v4, v4, v5
  v_cvt_pk_bf16_f32 v2, v2, v4
  v_lshlrev_b32 v3, 16, v2
  v_and_b32 v4, 0xffff0000, v2
  v_add_f32 v0, v0, v3
  v_add_f32 v0, v0, v4
  v_lshlrev_b32 v2, 16, v59
  v_lshlrev_b32 v3, 16, v79
  v_and_b32 v4, 0xffff0000, v59
  v_and_b32 v5, 0xffff0000, v79
  v_mul_f32 v2, v2, v3
  v_mul_f32 v4, v4, v5
  v_cvt_pk_bf16_f32 v2, v2, v4
  v_lshlrev_b32 v3, 16, v2
  v_and_b32 v4, 0xffff0000, v2
  v_add_f32 v0, v0, v3
  v_add_f32 v0, v0, v4
  v_lshlrev_b32 v2, 16, v60
  s_waitcnt vmcnt(1)
  v_lshlrev_b32 v3, 16, v80
  v_and_b32 v4, 0xffff0000, v60
  v_and_b32 v5, 0xffff0000, v80
  v_mul_f32 v2, v2, v3
  v_mul_f32 v4, v4, v5
  v_cvt_pk_bf16_f32 v2, v2, v4
  v_lshlrev_b32 v3, 16, v2
  v_and_b32 v4, 0xffff0000, v2
  v_add_f32 v0, v0, v3
  v_add_f32 v0, v0, v4
  v_lshlrev_b32 v2, 16, v61
  v_lshlrev_b32 v3, 16, v81
  v_and_b32 v4, 0xffff0000, v61
  v_and_b32 v5, 0xffff0000, v81
  v_mul_f32 v2, v2, v3
  v_mul_f32 v4, v4, v5
  v_cvt_pk_bf16_f32 v2, v2, v4
  v_lshlrev_b32 v3, 16, v2
  v_and_b32 v4, 0xffff0000, v2
  v_add_f32 v0, v0, v3
  v_add_f32 v0, v0, v4
  v_lshlrev_b32 v2, 16, v62
  v_lshlrev_b32 v3, 16, v82
  v_and_b32 v4, 0xffff0000, v62
  v_and_b32 v5, 0xffff0000, v82
  v_mul_f32 v2, v2, v3
  v_mul_f32 v4, v4, v5
  v_cvt_pk_bf16_f32 v2, v2, v4
  v_lshlrev_b32 v3, 16, v2
  v_and_b32 v4, 0xffff0000, v2
  v_add_f32 v0, v0, v3
  v_add_f32 v0, v0, v4
  v_lshlrev_b32 v2, 16, v63
  v_lshlrev_b32 v3, 16, v83
  v_and_b32 v4, 0xffff0000, v63
  v_and_b32 v5, 0xffff0000, v83
  v_mul_f32 v2, v2, v3
  v_mul_f32 v4, v4, v5
  v_cvt_pk_bf16_f32 v2, v2, v4
  v_lshlrev_b32 v3, 16, v2
  v_and_b32 v4, 0xffff0000, v2
  v_add_f32 v0, v0, v3
  v_add_f32 v0, v0, v4
  v_lshlrev_b32 v2, 16, v64
  s_waitcnt vmcnt(0)
  v_lshlrev_b32 v3, 16, v84
  v_and_b32 v4, 0xffff0000, v64
  v_and_b32 v5, 0xffff0000, v84
  v_mul_f32 v2, v2, v3
  v_mul_f32 v4, v4, v5
  v_cvt_pk_bf16_f32 v2, v2, v4
  v_lshlrev_b32 v3, 16, v2
  v_and_b32 v4, 0xffff0000, v2
  v_add_f32 v0, v0, v3
  v_add_f32 v0, v0, v4
  v_lshlrev_b32 v2, 16, v65
  v_lshlrev_b32 v3, 16, v85
  v_and_b32 v4, 0xffff0000, v65
  v_and_b32 v5, 0xffff0000, v85
  v_mul_f32 v2, v2, v3
  v_mul_f32 v4, v4, v5
  v_cvt_pk_bf16_f32 v2, v2, v4
  v_lshlrev_b32 v3, 16, v2
  v_and_b32 v4, 0xffff0000, v2
  v_add_f32 v0, v0, v3
  v_add_f32 v0, v0, v4
  s_nop 1
  v_add_f32_dpp v0, v0, v0 row_ror:1 row_mask:0xf bank_mask:0xf
  s_nop 1
  v_add_f32_dpp v0, v0, v0 row_ror:2 row_mask:0xf bank_mask:0xf
  s_nop 1
  v_add_f32_dpp v0, v0, v0 row_ror:4 row_mask:0xf bank_mask:0xf
  s_nop 1
  v_add_f32_dpp v0, v0, v0 row_ror:8 row_mask:0xf bank_mask:0xf
  v_cvt_pk_bf16_f32 v0, v0, v0
  v_lshlrev_b32 v0, 16, v0
  v_mul_f32 v0, 3216550459, v0
  v_exp_f32 v0, v0
  s_nop 0
  v_add_f32 v0, 1.0, v0
  v_rcp_f32 v0, v0
  s_nop 0
  v_cvt_pk_bf16_f32 v0, v0, v0
  v_lshlrev_b32 v0, 16, v0
  v_lshlrev_b32 v212, 2, v212
  s_lshl_b32 s55, s70, 4
  s_add_u32 s55, s55, 66060288
  s_mov_b32 exec_lo, 0x00010001
  s_mov_b32 exec_hi, 0x00010001
  buffer_store_dword v0, v212, s[8:11], s55 offen sc1
  s_mov_b64 exec, -1
  v_lshrrev_b32 v211, 4, v200
  v_lshlrev_b32 v212, 2, v211
  v_and_b32 v213, 15, v200
  v_xor_b32 v212, v212, v213
  v_mul_u32_u24 v211, 3456, v211
  v_mov_b32 v2, 0x40000000
  v_add_u32 v213, 0, v212
  v_mul_u32_u24 v214, 57, v213
  v_lshrrev_b32 v214, 9, v214
  v_mul_u32_u24 v214, 1008, v214
  v_lshl_add_u32 v214, v213, 4, v214
  v_add_u32 v214, v214, v211
  v_cmp_lt_u32 vcc, 26, v213
  s_nop 1
  v_cndmask_b32 v207, v214, v2, vcc
  v_add_u32 v213, 16, v212
  v_mul_u32_u24 v214, 57, v213
  v_lshrrev_b32 v214, 9, v214
  v_mul_u32_u24 v214, 1008, v214
  v_lshl_add_u32 v214, v213, 4, v214
  v_add_u32 v214, v214, v211
  v_cmp_lt_u32 vcc, 26, v213
  s_nop 1
  v_cndmask_b32 v208, v214, v2, vcc
  s_mul_i32 s62, s68, 144
  s_mul_i32 s54, s52, 13824
  s_add_u32 s62, s62, s54
  s_waitcnt vmcnt(0)
  s_lshl_b32 s61, s52, 10
  s_add_u32 s61, s61, 36864
  s_add_u32 m0, s61, 0
  s_add_u32 s54, s62, 0
  buffer_load_dwordx4 v207, s[36:39], s54 offen lds
  s_add_u32 m0, s61, 4096
  s_add_u32 s54, s62, 55296
  buffer_load_dwordx4 v207, s[36:39], s54 offen lds
  s_add_u32 m0, s61, 8192
  s_add_u32 s54, s62, 110592
  buffer_load_dwordx4 v207, s[36:39], s54 offen lds
  s_add_u32 m0, s61, 12288
  s_add_u32 s54, s62, 165888
  buffer_load_dwordx4 v207, s[36:39], s54 offen lds
  s_add_u32 m0, s61, 16384
  s_add_u32 s54, s62, 0
  buffer_load_dwordx4 v208, s[36:39], s54 offen lds
  s_add_u32 m0, s61, 20480
  s_add_u32 s54, s62, 55296
  buffer_load_dwordx4 v208, s[36:39], s54 offen lds
  s_add_u32 m0, s61, 24576
  s_add_u32 s54, s62, 110592
  buffer_load_dwordx4 v208, s[36:39], s54 offen lds
  s_add_u32 m0, s61, 28672
  s_add_u32 s54, s62, 165888
  buffer_load_dwordx4 v208, s[36:39], s54 offen lds
  s_add_u32 m0, s61, 32768
  s_add_u32 s54, s62, 221184
  buffer_load_dwordx4 v207, s[36:39], s54 offen lds
  s_add_u32 m0, s61, 36864
  s_add_u32 s54, s62, 276480
  buffer_load_dwordx4 v207, s[36:39], s54 offen lds
  s_add_u32 m0, s61, 40960
  s_add_u32 s54, s62, 331776
  buffer_load_dwordx4 v207, s[36:39], s54 offen lds
  s_add_u32 m0, s61, 45056
  s_add_u32 s54, s62, 387072
  buffer_load_dwordx4 v207, s[36:39], s54 offen lds
  s_add_u32 m0, s61, 49152
  s_add_u32 s54, s62, 221184
  buffer_load_dwordx4 v208, s[36:39], s54 offen lds
  s_add_u32 m0, s61, 53248
  s_add_u32 s54, s62, 276480
  buffer_load_dwordx4 v208, s[36:39], s54 offen lds
  s_add_u32 m0, s61, 57344
  s_add_u32 s54, s62, 331776
  buffer_load_dwordx4 v208, s[36:39], s54 offen lds
  s_add_u32 m0, s61, 61440
  s_add_u32 s54, s62, 387072
  buffer_load_dwordx4 v208, s[36:39], s54 offen lds
  s_add_u32 m0, s61, 65536
  s_add_u32 s54, s62, 442368
  buffer_load_dwordx4 v207, s[36:39], s54 offen lds
  s_add_u32 m0, s61, 69632
  s_add_u32 s54, s62, 497664
  buffer_load_dwordx4 v207, s[36:39], s54 offen lds
  s_add_u32 m0, s61, 73728
  s_add_u32 s54, s62, 552960
  buffer_load_dwordx4 v207, s[36:39], s54 offen lds
  s_add_u32 m0, s61, 77824
  s_add_u32 s54, s62, 608256
  buffer_load_dwordx4 v207, s[36:39], s54 offen lds
  s_add_u32 m0, s61, 81920
  s_add_u32 s54, s62, 442368
  buffer_load_dwordx4 v208, s[36:39], s54 offen lds
  s_add_u32 m0, s61, 86016
  s_add_u32 s54, s62, 497664
  buffer_load_dwordx4 v208, s[36:39], s54 offen lds
  s_add_u32 m0, s61, 90112
  s_add_u32 s54, s62, 552960
  buffer_load_dwordx4 v208, s[36:39], s54 offen lds
  s_add_u32 m0, s61, 94208
  s_add_u32 s54, s62, 608256
  buffer_load_dwordx4 v208, s[36:39], s54 offen lds
  s_waitcnt vmcnt(20) lgkmcnt(0)
  s_barrier
  s_add_u32 m0, s61, 98304
  s_add_u32 s54, s62, 663552
  buffer_load_dwordx4 v207, s[36:39], s54 offen lds
  s_add_u32 m0, s61, 102400
  s_add_u32 s54, s62, 718848
  buffer_load_dwordx4 v207, s[36:39], s54 offen lds
  s_add_u32 m0, s61, 106496
  s_add_u32 s54, s62, 774144
  buffer_load_dwordx4 v207, s[36:39], s54 offen lds
  s_add_u32 m0, s61, 110592
  s_add_u32 s54, s62, 829440
  buffer_load_dwordx4 v207, s[36:39], s54 offen lds
  v_add_u32 v215, 36864, v210
  ds_read_b64_tr_b16 a[0:1], v215 offset:0
  ds_read_b64_tr_b16 a[2:3], v215 offset:1024
  ds_read_b64_tr_b16 a[4:5], v215 offset:4096
  ds_read_b64_tr_b16 a[6:7], v215 offset:5120
  ds_read_b64_tr_b16 a[8:9], v215 offset:8192
  ds_read_b64_tr_b16 a[10:11], v215 offset:9216
  ds_read_b64_tr_b16 a[12:13], v215 offset:12288
  ds_read_b64_tr_b16 a[14:15], v215 offset:13312
  s_waitcnt vmcnt(20) lgkmcnt(0)
  s_barrier
  s_add_u32 m0, s61, 0
  s_add_u32 s54, s62, 663552
  buffer_load_dwordx4 v208, s[36:39], s54 offen lds
  s_add_u32 m0, s61, 4096
  s_add_u32 s54, s62, 718848
  buffer_load_dwordx4 v208, s[36:39], s54 offen lds
  s_add_u32 m0, s61, 8192
  s_add_u32 s54, s62, 774144
  buffer_load_dwordx4 v208, s[36:39], s54 offen lds
  s_add_u32 m0, s61, 12288
  s_add_u32 s54, s62, 829440
  buffer_load_dwordx4 v208, s[36:39], s54 offen lds
  v_add_u32 v215, 53248, v210
  ds_read_b64_tr_b16 a[144:145], v215 offset:0
  ds_read_b64_tr_b16 a[146:147], v215 offset:1024
  ds_read_b64_tr_b16 a[148:149], v215 offset:4096
  ds_read_b64_tr_b16 a[150:151], v215 offset:5120
  ds_read_b64_tr_b16 a[152:153], v215 offset:8192
  ds_read_b64_tr_b16 a[154:155], v215 offset:9216
  ds_read_b64_tr_b16 a[156:157], v215 offset:12288
  ds_read_b64_tr_b16 a[158:159], v215 offset:13312
  s_waitcnt vmcnt(20) lgkmcnt(0)
  s_barrier
  s_add_u32 m0, s61, 16384
  s_add_u32 s54, s62, 884736
  buffer_load_dwordx4 v207, s[36:39], s54 offen lds
  s_add_u32 m0, s61, 20480
  s_add_u32 s54, s62, 940032
  buffer_load_dwordx4 v207, s[36:39], s54 offen lds
  s_add_u32 m0, s61, 24576
  s_add_u32 s54, s62, 995328
  buffer_load_dwordx4 v207, s[36:39], s54 offen lds
  s_add_u32 m0, s61, 28672
  s_add_u32 s54, s62, 1050624
  buffer_load_dwordx4 v207, s[36:39], s54 offen lds
  v_add_u32 v215, 69632, v210
  ds_read_b64_tr_b16 a[16:17], v215 offset:0
  ds_read_b64_tr_b16 a[18:19], v215 offset:1024
  ds_read_b64_tr_b16 a[20:21], v215 offset:4096
  ds_read_b64_tr_b16 a[22:23], v215 offset:5120
  ds_read_b64_tr_b16 a[24:25], v215 offset:8192
  ds_read_b64_tr_b16 a[26:27], v215 offset:9216
  ds_read_b64_tr_b16 a[28:29], v215 offset:12288
  ds_read_b64_tr_b16 a[30:31], v215 offset:13312
  s_waitcnt vmcnt(20) lgkmcnt(0)
  s_barrier
  s_add_u32 m0, s61, 32768
  s_add_u32 s54, s62, 884736
  buffer_load_dwordx4 v208, s[36:39], s54 offen lds
  s_add_u32 m0, s61, 36864
  s_add_u32 s54, s62, 940032
  buffer_load_dwordx4 v208, s[36:39], s54 offen lds
  s_add_u32 m0, s61, 40960
  s_add_u32 s54, s62, 995328
  buffer_load_dwordx4 v208, s[36:39], s54 offen lds
  s_add_u32 m0, s61, 45056
  s_add_u32 s54, s62, 1050624
  buffer_load_dwordx4 v208, s[36:39], s54 offen lds
  v_add_u32 v215, 86016, v210
  ds_read_b64_tr_b16 a[160:161], v215 offset:0
  ds_read_b64_tr_b16 a[162:163], v215 offset:1024
  ds_read_b64_tr_b16 a[164:165], v215 offset:4096
  ds_read_b64_tr_b16 a[166:167], v215 offset:5120
  ds_read_b64_tr_b16 a[168:169], v215 offset:8192
  ds_read_b64_tr_b16 a[170:171], v215 offset:9216
  ds_read_b64_tr_b16 a[172:173], v215 offset:12288
  ds_read_b64_tr_b16 a[174:175], v215 offset:13312
  s_waitcnt vmcnt(20) lgkmcnt(0)
  s_barrier
  s_add_u32 m0, s61, 49152
  s_add_u32 s54, s62, 1105920
  buffer_load_dwordx4 v207, s[36:39], s54 offen lds
  s_add_u32 m0, s61, 53248
  s_add_u32 s54, s62, 1161216
  buffer_load_dwordx4 v207, s[36:39], s54 offen lds
  s_add_u32 m0, s61, 57344
  s_add_u32 s54, s62, 1216512
  buffer_load_dwordx4 v207, s[36:39], s54 offen lds
  s_add_u32 m0, s61, 61440
  s_add_u32 s54, s62, 1271808
  buffer_load_dwordx4 v207, s[36:39], s54 offen lds
  v_add_u32 v215, 102400, v210
  ds_read_b64_tr_b16 a[32:33], v215 offset:0
  ds_read_b64_tr_b16 a[34:35], v215 offset:1024
  ds_read_b64_tr_b16 a[36:37], v215 offset:4096
  ds_read_b64_tr_b16 a[38:39], v215 offset:5120
  ds_read_b64_tr_b16 a[40:41], v215 offset:8192
  ds_read_b64_tr_b16 a[42:43], v215 offset:9216
  ds_read_b64_tr_b16 a[44:45], v215 offset:12288
  ds_read_b64_tr_b16 a[46:47], v215 offset:13312
  s_waitcnt vmcnt(20) lgkmcnt(0)
  s_barrier
  s_add_u32 m0, s61, 65536
  s_add_u32 s54, s62, 1105920
  buffer_load_dwordx4 v208, s[36:39], s54 offen lds
  s_add_u32 m0, s61, 69632
  s_add_u32 s54, s62, 1161216
  buffer_load_dwordx4 v208, s[36:39], s54 offen lds
  s_add_u32 m0, s61, 73728
  s_add_u32 s54, s62, 1216512
  buffer_load_dwordx4 v208, s[36:39], s54 offen lds
  s_add_u32 m0, s61, 77824
  s_add_u32 s54, s62, 1271808
  buffer_load_dwordx4 v208, s[36:39], s54 offen lds
  v_add_u32 v215, 118784, v210
  ds_read_b64_tr_b16 a[176:177], v215 offset:0
  ds_read_b64_tr_b16 a[178:179], v215 offset:1024
  ds_read_b64_tr_b16 a[180:181], v215 offset:4096
  ds_read_b64_tr_b16 a[182:183], v215 offset:5120
  ds_read_b64_tr_b16 a[184:185], v215 offset:8192
  ds_read_b64_tr_b16 a[186:187], v215 offset:9216
  ds_read_b64_tr_b16 a[188:189], v215 offset:12288
  ds_read_b64_tr_b16 a[190:191], v215 offset:13312
  s_waitcnt vmcnt(20) lgkmcnt(0)
  s_barrier
  s_add_u32 m0, s61, 81920
  s_add_u32 s54, s62, 1327104
  buffer_load_dwordx4 v207, s[36:39], s54 offen lds
  s_add_u32 m0, s61, 86016
  s_add_u32 s54, s62, 1382400
  buffer_load_dwordx4 v207, s[36:39], s54 offen lds
  s_add_u32 m0, s61, 90112
  s_add_u32 s54, s62, 1437696
  buffer_load_dwordx4 v207, s[36:39], s54 offen lds
  s_add_u32 m0, s61, 94208
  s_add_u32 s54, s62, 1492992
  buffer_load_dwordx4 v207, s[36:39], s54 offen lds
  v_add_u32 v215, 135168, v210
  ds_read_b64_tr_b16 a[48:49], v215 offset:0
  ds_read_b64_tr_b16 a[50:51], v215 offset:1024
  ds_read_b64_tr_b16 a[52:53], v215 offset:4096
  ds_read_b64_tr_b16 a[54:55], v215 offset:5120
  ds_read_b64_tr_b16 a[56:57], v215 offset:8192
  ds_read_b64_tr_b16 a[58:59], v215 offset:9216
  ds_read_b64_tr_b16 a[60:61], v215 offset:12288
  ds_read_b64_tr_b16 a[62:63], v215 offset:13312
  s_waitcnt vmcnt(20) lgkmcnt(0)
  s_barrier
  s_add_u32 m0, s61, 98304
  s_add_u32 s54, s62, 1327104
  buffer_load_dwordx4 v208, s[36:39], s54 offen lds
  s_add_u32 m0, s61, 102400
  s_add_u32 s54, s62, 1382400
  buffer_load_dwordx4 v208, s[36:39], s54 offen lds
  s_add_u32 m0, s61, 106496
  s_add_u32 s54, s62, 1437696
  buffer_load_dwordx4 v208, s[36:39], s54 offen lds
  s_add_u32 m0, s61, 110592
  s_add_u32 s54, s62, 1492992
  buffer_load_dwordx4 v208, s[36:39], s54 offen lds
  v_add_u32 v215, 36864, v210
  ds_read_b64_tr_b16 a[192:193], v215 offset:0
  ds_read_b64_tr_b16 a[194:195], v215 offset:1024
  ds_read_b64_tr_b16 a[196:197], v215 offset:4096
  ds_read_b64_tr_b16 a[198:199], v215 offset:5120
  ds_read_b64_tr_b16 a[200:201], v215 offset:8192
  ds_read_b64_tr_b16 a[202:203], v215 offset:9216
  ds_read_b64_tr_b16 a[204:205], v215 offset:12288
  ds_read_b64_tr_b16 a[206:207], v215 offset:13312
  s_waitcnt vmcnt(20) lgkmcnt(0)
  s_barrier
  s_add_u32 m0, s61, 0
  s_add_u32 s54, s62, 1548288
  buffer_load_dwordx4 v207, s[36:39], s54 offen lds
  s_add_u32 m0, s61, 4096
  s_add_u32 s54, s62, 1603584
  buffer_load_dwordx4 v207, s[36:39], s54 offen lds
  s_add_u32 m0, s61, 8192
  s_add_u32 s54, s62, 1658880
  buffer_load_dwordx4 v207, s[36:39], s54 offen lds
  s_add_u32 m0, s61, 12288
  s_add_u32 s54, s62, 1714176
  buffer_load_dwordx4 v207, s[36:39], s54 offen lds
  v_add_u32 v215, 53248, v210
  ds_read_b64_tr_b16 a[64:65], v215 offset:0
  ds_read_b64_tr_b16 a[66:67], v215 offset:1024
  ds_read_b64_tr_b16 a[68:69], v215 offset:4096
  ds_read_b64_tr_b16 a[70:71], v215 offset:5120
  ds_read_b64_tr_b16 a[72:73], v215 offset:8192
  ds_read_b64_tr_b16 a[74:75], v215 offset:9216
  ds_read_b64_tr_b16 a[76:77], v215 offset:12288
  ds_read_b64_tr_b16 a[78:79], v215 offset:13312
  s_waitcnt vmcnt(20) lgkmcnt(0)
  s_barrier
  s_add_u32 m0, s61, 16384
  s_add_u32 s54, s62, 1548288
  buffer_load_dwordx4 v208, s[36:39], s54 offen lds
  s_add_u32 m0, s61, 20480
  s_add_u32 s54, s62, 1603584
  buffer_load_dwordx4 v208, s[36:39], s54 offen lds
  s_add_u32 m0, s61, 24576
  s_add_u32 s54, s62, 1658880
  buffer_load_dwordx4 v208, s[36:39], s54 offen lds
  s_add_u32 m0, s61, 28672
  s_add_u32 s54, s62, 1714176
  buffer_load_dwordx4 v208, s[36:39], s54 offen lds
  v_add_u32 v215, 69632, v210
  ds_read_b64_tr_b16 a[208:209], v215 offset:0
  ds_read_b64_tr_b16 a[210:211], v215 offset:1024
  ds_read_b64_tr_b16 a[212:213], v215 offset:4096
  ds_read_b64_tr_b16 a[214:215], v215 offset:5120
  ds_read_b64_tr_b16 a[216:217], v215 offset:8192
  ds_read_b64_tr_b16 a[218:219], v215 offset:9216
  ds_read_b64_tr_b16 a[220:221], v215 offset:12288
  ds_read_b64_tr_b16 a[222:223], v215 offset:13312
  s_waitcnt vmcnt(20) lgkmcnt(0)
  s_barrier
  s_add_u32 m0, s61, 32768
  s_add_u32 s54, s62, 1769472
  buffer_load_dwordx4 v207, s[36:39], s54 offen lds
  s_add_u32 m0, s61, 36864
  s_add_u32 s54, s62, 1824768
  buffer_load_dwordx4 v207, s[36:39], s54 offen lds
  s_add_u32 m0, s61, 40960
  s_add_u32 s54, s62, 1880064
  buffer_load_dwordx4 v207, s[36:39], s54 offen lds
  s_add_u32 m0, s61, 45056
  s_add_u32 s54, s62, 1935360
  buffer_load_dwordx4 v207, s[36:39], s54 offen lds
  v_add_u32 v215, 86016, v210
  ds_read_b64_tr_b16 a[80:81], v215 offset:0
  ds_read_b64_tr_b16 a[82:83], v215 offset:1024
  ds_read_b64_tr_b16 a[84:85], v215 offset:4096
  ds_read_b64_tr_b16 a[86:87], v215 offset:5120
  ds_read_b64_tr_b16 a[88:89], v215 offset:8192
  ds_read_b64_tr_b16 a[90:91], v215 offset:9216
  ds_read_b64_tr_b16 a[92:93], v215 offset:12288
  ds_read_b64_tr_b16 a[94:95], v215 offset:13312
  s_waitcnt vmcnt(20) lgkmcnt(0)
  s_barrier
  s_add_u32 m0, s61, 49152
  s_add_u32 s54, s62, 1769472
  buffer_load_dwordx4 v208, s[36:39], s54 offen lds
  s_add_u32 m0, s61, 53248
  s_add_u32 s54, s62, 1824768
  buffer_load_dwordx4 v208, s[36:39], s54 offen lds
  s_add_u32 m0, s61, 57344
  s_add_u32 s54, s62, 1880064
  buffer_load_dwordx4 v208, s[36:39], s54 offen lds
  s_add_u32 m0, s61, 61440
  s_add_u32 s54, s62, 1935360
  buffer_load_dwordx4 v208, s[36:39], s54 offen lds
  v_add_u32 v215, 102400, v210
  ds_read_b64_tr_b16 a[224:225], v215 offset:0
  ds_read_b64_tr_b16 a[226:227], v215 offset:1024
  ds_read_b64_tr_b16 a[228:229], v215 offset:4096
  ds_read_b64_tr_b16 a[230:231], v215 offset:5120
  ds_read_b64_tr_b16 a[232:233], v215 offset:8192
  ds_read_b64_tr_b16 a[234:235], v215 offset:9216
  ds_read_b64_tr_b16 a[236:237], v215 offset:12288
  ds_read_b64_tr_b16 a[238:239], v215 offset:13312
  s_waitcnt vmcnt(20) lgkmcnt(0)
  s_barrier
  v_add_u32 v215, 118784, v210
  ds_read_b64_tr_b16 a[96:97], v215 offset:0
  ds_read_b64_tr_b16 a[98:99], v215 offset:1024
  ds_read_b64_tr_b16 a[100:101], v215 offset:4096
  ds_read_b64_tr_b16 a[102:103], v215 offset:5120
  ds_read_b64_tr_b16 a[104:105], v215 offset:8192
  ds_read_b64_tr_b16 a[106:107], v215 offset:9216
  ds_read_b64_tr_b16 a[108:109], v215 offset:12288
  ds_read_b64_tr_b16 a[110:111], v215 offset:13312
  s_waitcnt vmcnt(16) lgkmcnt(0)
  s_barrier
  v_add_u32 v215, 135168, v210
  ds_read_b64_tr_b16 a[240:241], v215 offset:0
  ds_read_b64_tr_b16 a[242:243], v215 offset:1024
  ds_read_b64_tr_b16 a[244:245], v215 offset:4096
  ds_read_b64_tr_b16 a[246:247], v215 offset:5120
  ds_read_b64_tr_b16 a[248:249], v215 offset:8192
  ds_read_b64_tr_b16 a[250:251], v215 offset:9216
  ds_read_b64_tr_b16 a[252:253], v215 offset:12288
  ds_read_b64_tr_b16 a[254:255], v215 offset:13312
  s_waitcnt vmcnt(12) lgkmcnt(0)
  s_barrier
  v_add_u32 v215, 36864, v210
  ds_read_b64_tr_b16 a[112:113], v215 offset:0
  ds_read_b64_tr_b16 a[114:115], v215 offset:1024
  ds_read_b64_tr_b16 a[116:117], v215 offset:4096
  ds_read_b64_tr_b16 a[118:119], v215 offset:5120
  ds_read_b64_tr_b16 a[120:121], v215 offset:8192
  ds_read_b64_tr_b16 a[122:123], v215 offset:9216
  ds_read_b64_tr_b16 a[124:125], v215 offset:12288
  ds_read_b64_tr_b16 a[126:127], v215 offset:13312
  s_waitcnt vmcnt(8) lgkmcnt(0)
  s_barrier
  v_add_u32 v215, 53248, v210
  ds_read_b64_tr_b16 v[224:225], v215 offset:0
  ds_read_b64_tr_b16 v[226:227], v215 offset:1024
  ds_read_b64_tr_b16 v[228:229], v215 offset:4096
  ds_read_b64_tr_b16 v[230:231], v215 offset:5120
  ds_read_b64_tr_b16 v[232:233], v215 offset:8192
  ds_read_b64_tr_b16 v[234:235], v215 offset:9216
  ds_read_b64_tr_b16 v[236:237], v215 offset:12288
  ds_read_b64_tr_b16 v[238:239], v215 offset:13312
  s_waitcnt vmcnt(4) lgkmcnt(0)
  s_barrier
  v_add_u32 v215, 69632, v210
  ds_read_b64_tr_b16 a[128:129], v215 offset:0
  ds_read_b64_tr_b16 a[130:131], v215 offset:1024
  ds_read_b64_tr_b16 a[132:133], v215 offset:4096
  ds_read_b64_tr_b16 a[134:135], v215 offset:5120
  ds_read_b64_tr_b16 a[136:137], v215 offset:8192
  ds_read_b64_tr_b16 a[138:139], v215 offset:9216
  ds_read_b64_tr_b16 a[140:141], v215 offset:12288
  ds_read_b64_tr_b16 a[142:143], v215 offset:13312
  s_waitcnt vmcnt(0) lgkmcnt(0)
  s_barrier
  v_add_u32 v215, 86016, v210
  ds_read_b64_tr_b16 v[240:241], v215 offset:0
  ds_read_b64_tr_b16 v[242:243], v215 offset:1024
  ds_read_b64_tr_b16 v[244:245], v215 offset:4096
  ds_read_b64_tr_b16 v[246:247], v215 offset:5120
  ds_read_b64_tr_b16 v[248:249], v215 offset:8192
  ds_read_b64_tr_b16 v[250:251], v215 offset:9216
  ds_read_b64_tr_b16 v[252:253], v215 offset:12288
  ds_read_b64_tr_b16 v[254:255], v215 offset:13312
  s_waitcnt lgkmcnt(0)
  s_barrier
  v_and_b32 v211, 31, v200
  v_mul_u32_u24 v218, 516, v211
  v_lshrrev_b32 v212, 5, v200
  v_lshl_add_u32 v218, v212, 3, v218
  s_lshl_b32 s54, s52, 6
  s_add_u32 s54, s54, 73728
  v_add_u32 v218, s54, v218
  s_lshl_b32 s60, s69, 2
  s_mul_i32 s60, s60, 36864
  ds_read_b128 v[32:35], v203 offset:0
  ds_read_b128 v[36:39], v204 offset:0
  ds_read_b128 v[40:43], v205 offset:0
  s_waitcnt lgkmcnt(2)
  v_mfma_f32_32x32x16_bf16 v[0:15], a[0:3], v[32:35], 0
  ds_read_b128 v[44:47], v206 offset:0
  s_add_u32 m0, s67, 36864
  s_nop 0
  buffer_load_dwordx4 v202, s[4:7], s60 offen offset:0 lds
  v_mfma_f32_32x32x16_bf16 v[16:31], a[144:147], v[32:35], 0
  s_waitcnt lgkmcnt(2)
  v_mfma_f32_32x32x16_bf16 v[0:15], a[4:7], v[36:39], v[0:15]
  ds_read_b128 v[32:35], v203 offset:1024
  s_add_u32 m0, s67, 37760
  s_nop 0
  buffer_load_dwordx4 v202, s[4:7], s60 offen offset:128 lds
  v_mfma_f32_32x32x16_bf16 v[16:31], a[148:151], v[36:39], v[16:31]
  s_waitcnt lgkmcnt(2)
  v_mfma_f32_32x32x16_bf16 v[0:15], a[8:11], v[40:43], v[0:15]
  ds_read_b128 v[36:39], v204 offset:1024
  s_add_u32 m0, s67, 38656
  s_nop 0
  buffer_load_dwordx4 v202, s[4:7], s60 offen offset:256 lds
  v_mfma_f32_32x32x16_bf16 v[16:31], a[152:155], v[40:43], v[16:31]
  s_waitcnt lgkmcnt(2)
  v_mfma_f32_32x32x16_bf16 v[0:15], a[12:15], v[44:47], v[0:15]
  ds_read_b128 v[40:43], v205 offset:1024
  s_add_u32 m0, s67, 39552
  s_nop 0
  buffer_load_dwordx4 v202, s[4:7], s60 offen offset:384 lds
  v_mfma_f32_32x32x16_bf16 v[16:31], a[156:159], v[44:47], v[16:31]
  s_waitcnt lgkmcnt(2)
  v_mfma_f32_32x32x16_bf16 v[0:15], a[16:19], v[32:35], v[0:15]
  ds_read_b128 v[44:47], v206 offset:1024
  s_add_u32 m0, s67, 40448
  s_nop 0
  buffer_load_dwordx4 v202, s[4:7], s60 offen offset:512 lds
  v_mfma_f32_32x32x16_bf16 v[16:31], a[160:163], v[32:35], v[16:31]
  s_waitcnt lgkmcnt(2)
  v_mfma_f32_32x32x16_bf16 v[0:15], a[20:23], v[36:39], v[0:15]
  ds_read_b128 v[32:35], v203 offset:2048
  s_add_u32 m0, s67, 41344
  s_nop 0
  buffer_load_dwordx4 v202, s[4:7], s60 offen offset:640 lds
  v_mfma_f32_32x32x16_bf16 v[16:31], a[164:167], v[36:39], v[16:31]
  s_waitcnt lgkmcnt(2)
  v_mfma_f32_32x32x16_bf16 v[0:15], a[24:27], v[40:43], v[0:15]
  ds_read_b128 v[36:39], v204 offset:2048
  s_add_u32 m0, s67, 42240
  s_nop 0
  buffer_load_dwordx4 v202, s[4:7], s60 offen offset:768 lds
  v_mfma_f32_32x32x16_bf16 v[16:31], a[168:171], v[40:43], v[16:31]
  s_waitcnt lgkmcnt(2)
  v_mfma_f32_32x32x16_bf16 v[0:15], a[28:31], v[44:47], v[0:15]
  ds_read_b128 v[40:43], v205 offset:2048
  s_add_u32 m0, s67, 43136
  s_nop 0
  buffer_load_dwordx4 v202, s[4:7], s60 offen offset:896 lds
  v_mfma_f32_32x32x16_bf16 v[16:31], a[172:175], v[44:47], v[16:31]
  s_waitcnt lgkmcnt(2)
  v_mfma_f32_32x32x16_bf16 v[0:15], a[32:35], v[32:35], v[0:15]
  ds_read_b128 v[44:47], v206 offset:2048
  s_add_u32 m0, s67, 44032
  s_nop 0
  buffer_load_dwordx4 v202, s[4:7], s60 offen offset:1024 lds
  v_mfma_f32_32x32x16_bf16 v[16:31], a[176:179], v[32:35], v[16:31]
  s_waitcnt lgkmcnt(2)
  v_mfma_f32_32x32x16_bf16 v[0:15], a[36:39], v[36:39], v[0:15]
  ds_read_b128 v[32:35], v203 offset:3072
  v_mfma_f32_32x32x16_bf16 v[16:31], a[180:183], v[36:39], v[16:31]
  s_waitcnt lgkmcnt(2)
  v_mfma_f32_32x32x16_bf16 v[0:15], a[40:43], v[40:43], v[0:15]
  ds_read_b128 v[36:39], v204 offset:3072
  v_mfma_f32_32x32x16_bf16 v[16:31], a[184:187], v[40:43], v[16:31]
  s_waitcnt lgkmcnt(2)
  v_mfma_f32_32x32x16_bf16 v[0:15], a[44:47], v[44:47], v[0:15]
  ds_read_b128 v[40:43], v205 offset:3072
  v_mfma_f32_32x32x16_bf16 v[16:31], a[188:191], v[44:47], v[16:31]
  s_waitcnt lgkmcnt(2)
  v_mfma_f32_32x32x16_bf16 v[0:15], a[48:51], v[32:35], v[0:15]
  ds_read_b128 v[44:47], v206 offset:3072
  v_mfma_f32_32x32x16_bf16 v[16:31], a[192:195], v[32:35], v[16:31]
  s_waitcnt lgkmcnt(2)
  v_mfma_f32_32x32x16_bf16 v[0:15], a[52:55], v[36:39], v[0:15]
  ds_read_b128 v[32:35], v203 offset:4096
  v_mfma_f32_32x32x16_bf16 v[16:31], a[196:199], v[36:39], v[16:31]
  s_waitcnt lgkmcnt(2)
  v_mfma_f32_32x32x16_bf16 v[0:15], a[56:59], v[40:43], v[0:15]
  ds_read_b128 v[36:39], v204 offset:4096
  v_mfma_f32_32x32x16_bf16 v[16:31], a[200:203], v[40:43], v[16:31]
  s_waitcnt lgkmcnt(2)
  v_mfma_f32_32x32x16_bf16 v[0:15], a[60:63], v[44:47], v[0:15]
  ds_read_b128 v[40:43], v205 offset:4096
  v_mfma_f32_32x32x16_bf16 v[16:31], a[204:207], v[44:47], v[16:31]
  s_waitcnt lgkmcnt(2)
  v_mfma_f32_32x32x16_bf16 v[0:15], a[64:67], v[32:35], v[0:15]
  ds_read_b128 v[44:47], v206 offset:4096
  v_mfma_f32_32x32x16_bf16 v[16:31], a[208:211], v[32:35], v[16:31]
  s_waitcnt lgkmcnt(2)
  v_mfma_f32_32x32x16_bf16 v[0:15], a[68:71], v[36:39], v[0:15]
  ds_read_b128 v[32:35], v203 offset:5120
  v_mfma_f32_32x32x16_bf16 v[16:31], a[212:215], v[36:39], v[16:31]
  s_waitcnt lgkmcnt(2)
  v_mfma_f32_32x32x16_bf16 v[0:15], a[72:75], v[40:43], v[0:15]
  ds_read_b128 v[36:39], v204 offset:5120
  v_mfma_f32_32x32x16_bf16 v[16:31], a[216:219], v[40:43], v[16:31]
  s_waitcnt lgkmcnt(2)
  v_mfma_f32_32x32x16_bf16 v[0:15], a[76:79], v[44:47], v[0:15]
  ds_read_b128 v[40:43], v205 offset:5120
  v_mfma_f32_32x32x16_bf16 v[16:31], a[220:223], v[44:47], v[16:31]
  s_waitcnt lgkmcnt(2)
  v_mfma_f32_32x32x16_bf16 v[0:15], a[80:83], v[32:35], v[0:15]
  ds_read_b128 v[44:47], v206 offset:5120
  v_mfma_f32_32x32x16_bf16 v[16:31], a[224:227], v[32:35], v[16:31]
  s_waitcnt lgkmcnt(2)
  v_mfma_f32_32x32x16_bf16 v[0:15], a[84:87], v[36:39], v[0:15]
  ds_read_b128 v[32:35], v203 offset:6144
  v_mfma_f32_32x32x16_bf16 v[16:31], a[228:231], v[36:39], v[16:31]
  s_waitcnt lgkmcnt(2)
  v_mfma_f32_32x32x16_bf16 v[0:15], a[88:91], v[40:43], v[0:15]
  ds_read_b128 v[36:39], v204 offset:6144
  v_mfma_f32_32x32x16_bf16 v[16:31], a[232:235], v[40:43], v[16:31]
  s_waitcnt lgkmcnt(2)
  v_mfma_f32_32x32x16_bf16 v[0:15], a[92:95], v[44:47], v[0:15]
  ds_read_b128 v[40:43], v205 offset:6144
  v_mfma_f32_32x32x16_bf16 v[16:31], a[236:239], v[44:47], v[16:31]
  s_waitcnt lgkmcnt(2)
  v_mfma_f32_32x32x16_bf16 v[0:15], a[96:99], v[32:35], v[0:15]
  ds_read_b128 v[44:47], v206 offset:6144
  v_mfma_f32_32x32x16_bf16 v[16:31], a[240:243], v[32:35], v[16:31]
  s_waitcnt lgkmcnt(2)
  v_mfma_f32_32x32x16_bf16 v[0:15], a[100:103], v[36:39], v[0:15]
  ds_read_b128 v[32:35], v203 offset:7168
  v_mfma_f32_32x32x16_bf16 v[16:31], a[244:247], v[36:39], v[16:31]
  s_waitcnt lgkmcnt(2)
  v_mfma_f32_32x32x16_bf16 v[0:15], a[104:107], v[40:43], v[0:15]
  ds_read_b128 v[36:39], v204 offset:7168
  v_mfma_f32_32x32x16_bf16 v[16:31], a[248:251], v[40:43], v[16:31]
  s_waitcnt lgkmcnt(2)
  v_mfma_f32_32x32x16_bf16 v[0:15], a[108:111], v[44:47], v[0:15]
  ds_read_b128 v[40:43], v205 offset:7168
  v_mfma_f32_32x32x16_bf16 v[16:31], a[252:255], v[44:47], v[16:31]
  s_waitcnt lgkmcnt(2)
  v_mfma_f32_32x32x16_bf16 v[0:15], a[112:115], v[32:35], v[0:15]
  ds_read_b128 v[44:47], v206 offset:7168
  v_mfma_f32_32x32x16_bf16 v[16:31], v[224:227], v[32:35], v[16:31]
  s_waitcnt lgkmcnt(2)
  v_mfma_f32_32x32x16_bf16 v[0:15], a[116:119], v[36:39], v[0:15]
  ds_read_b128 v[32:35], v203 offset:8192
  v_mfma_f32_32x32x16_bf16 v[16:31], v[228:231], v[36:39], v[16:31]
  s_waitcnt lgkmcnt(2)
  v_mfma_f32_32x32x16_bf16 v[0:15], a[120:123], v[40:43], v[0:15]
  ds_read_b128 v[36:39], v204 offset:8192
  v_mfma_f32_32x32x16_bf16 v[16:31], v[232:235], v[40:43], v[16:31]
  s_waitcnt lgkmcnt(2)
  v_mfma_f32_32x32x16_bf16 v[0:15], a[124:127], v[44:47], v[0:15]
  ds_read_b128 v[40:43], v205 offset:8192
  v_mfma_f32_32x32x16_bf16 v[16:31], v[236:239], v[44:47], v[16:31]
  s_waitcnt lgkmcnt(2)
  v_mfma_f32_32x32x16_bf16 v[0:15], a[128:131], v[32:35], v[0:15]
  ds_read_b128 v[44:47], v206 offset:8192
  v_mfma_f32_32x32x16_bf16 v[16:31], v[240:243], v[32:35], v[16:31]
  s_waitcnt lgkmcnt(2)
  v_mfma_f32_32x32x16_bf16 v[0:15], a[132:135], v[36:39], v[0:15]
  v_mfma_f32_32x32x16_bf16 v[16:31], v[244:247], v[36:39], v[16:31]
  s_waitcnt lgkmcnt(1)
  v_mfma_f32_32x32x16_bf16 v[0:15], a[136:139], v[40:43], v[0:15]
  v_mfma_f32_32x32x16_bf16 v[16:31], v[248:251], v[40:43], v[16:31]
  s_waitcnt lgkmcnt(0)
  v_mfma_f32_32x32x16_bf16 v[0:15], a[140:143], v[44:47], v[0:15]
  v_mfma_f32_32x32x16_bf16 v[16:31], v[252:255], v[44:47], v[16:31]
  s_add_u32 s60, s60, 36864
  s_nop 2
  v_cvt_pk_bf16_f32 v48, v0, v1
  v_cvt_pk_bf16_f32 v49, v2, v3
  ds_write2_b32 v218, v48, v49 offset0:0 offset1:1
  v_cvt_pk_bf16_f32 v48, v4, v5
  v_cvt_pk_bf16_f32 v49, v6, v7
  ds_write2_b32 v218, v48, v49 offset0:4 offset1:5
  v_cvt_pk_bf16_f32 v48, v8, v9
  v_cvt_pk_bf16_f32 v49, v10, v11
  ds_write2_b32 v218, v48, v49 offset0:8 offset1:9
  v_cvt_pk_bf16_f32 v48, v12, v13
  v_cvt_pk_bf16_f32 v49, v14, v15
  ds_write2_b32 v218, v48, v49 offset0:12 offset1:13
  v_cvt_pk_bf16_f32 v48, v16, v17
  v_cvt_pk_bf16_f32 v49, v18, v19
  ds_write2_b32 v218, v48, v49 offset0:64 offset1:65
  v_cvt_pk_bf16_f32 v48, v20, v21
  v_cvt_pk_bf16_f32 v49, v22, v23
  ds_write2_b32 v218, v48, v49 offset0:68 offset1:69
  v_cvt_pk_bf16_f32 v48, v24, v25
  v_cvt_pk_bf16_f32 v49, v26, v27
  ds_write2_b32 v218, v48, v49 offset0:72 offset1:73
  v_cvt_pk_bf16_f32 v48, v28, v29
  v_cvt_pk_bf16_f32 v49, v30, v31
  ds_write2_b32 v218, v48, v49 offset0:76 offset1:77
  v_add_u32 v218, 16512, v218
  s_waitcnt vmcnt(0) lgkmcnt(0)
  s_barrier
  ds_read_b128 v[32:35], v203 offset:36864
  ds_read_b128 v[36:39], v204 offset:36864
  ds_read_b128 v[40:43], v205 offset:36864
  s_waitcnt lgkmcnt(2)
  v_mfma_f32_32x32x16_bf16 v[0:15], a[0:3], v[32:35], 0
  ds_read_b128 v[44:47], v206 offset:36864
  s_add_u32 m0, s67, 0
  s_nop 0
  buffer_load_dwordx4 v202, s[4:7], s60 offen offset:0 lds
  v_mfma_f32_32x32x16_bf16 v[16:31], a[144:147], v[32:35], 0
  s_waitcnt lgkmcnt(2)
  v_mfma_f32_32x32x16_bf16 v[0:15], a[4:7], v[36:39], v[0:15]
  ds_read_b128 v[32:35], v203 offset:37888
  s_add_u32 m0, s67, 896
  s_nop 0
  buffer_load_dwordx4 v202, s[4:7], s60 offen offset:128 lds
  v_mfma_f32_32x32x16_bf16 v[16:31], a[148:151], v[36:39], v[16:31]
  s_waitcnt lgkmcnt(2)
  v_mfma_f32_32x32x16_bf16 v[0:15], a[8:11], v[40:43], v[0:15]
  ds_read_b128 v[36:39], v204 offset:37888
  s_add_u32 m0, s67, 1792
  s_nop 0
  buffer_load_dwordx4 v202, s[4:7], s60 offen offset:256 lds
  v_mfma_f32_32x32x16_bf16 v[16:31], a[152:155], v[40:43], v[16:31]
  s_waitcnt lgkmcnt(2)
  v_mfma_f32_32x32x16_bf16 v[0:15], a[12:15], v[44:47], v[0:15]
  ds_read_b128 v[40:43], v205 offset:37888
  s_add_u32 m0, s67, 2688
  s_nop 0
  buffer_load_dwordx4 v202, s[4:7], s60 offen offset:384 lds
  v_mfma_f32_32x32x16_bf16 v[16:31], a[156:159], v[44:47], v[16:31]
  s_waitcnt lgkmcnt(2)
  v_mfma_f32_32x32x16_bf16 v[0:15], a[16:19], v[32:35], v[0:15]
  ds_read_b128 v[44:47], v206 offset:37888
  s_add_u32 m0, s67, 3584
  s_nop 0
  buffer_load_dwordx4 v202, s[4:7], s60 offen offset:512 lds
  v_mfma_f32_32x32x16_bf16 v[16:31], a[160:163], v[32:35], v[16:31]
  s_waitcnt lgkmcnt(2)
  v_mfma_f32_32x32x16_bf16 v[0:15], a[20:23], v[36:39], v[0:15]
  ds_read_b128 v[32:35], v203 offset:38912
  s_add_u32 m0, s67, 4480
  s_nop 0
  buffer_load_dwordx4 v202, s[4:7], s60 offen offset:640 lds
  v_mfma_f32_32x32x16_bf16 v[16:31], a[164:167], v[36:39], v[16:31]
  s_waitcnt lgkmcnt(2)
  v_mfma_f32_32x32x16_bf16 v[0:15], a[24:27], v[40:43], v[0:15]
  ds_read_b128 v[36:39], v204 offset:38912
  s_add_u32 m0, s67, 5376
  s_nop 0
  buffer_load_dwordx4 v202, s[4:7], s60 offen offset:768 lds
  v_mfma_f32_32x32x16_bf16 v[16:31], a[168:171], v[40:43], v[16:31]
  s_waitcnt lgkmcnt(2)
  v_mfma_f32_32x32x16_bf16 v[0:15], a[28:31], v[44:47], v[0:15]
  ds_read_b128 v[40:43], v205 offset:38912
  s_add_u32 m0, s67, 6272
  s_nop 0
  buffer_load_dwordx4 v202, s[4:7], s60 offen offset:896 lds
  v_mfma_f32_32x32x16_bf16 v[16:31], a[172:175], v[44:47], v[16:31]
  s_waitcnt lgkmcnt(2)
  v_mfma_f32_32x32x16_bf16 v[0:15], a[32:35], v[32:35], v[0:15]
  ds_read_b128 v[44:47], v206 offset:38912
  s_add_u32 m0, s67, 7168
  s_nop 0
  buffer_load_dwordx4 v202, s[4:7], s60 offen offset:1024 lds
  v_mfma_f32_32x32x16_bf16 v[16:31], a[176:179], v[32:35], v[16:31]
  s_waitcnt lgkmcnt(2)
  v_mfma_f32_32x32x16_bf16 v[0:15], a[36:39], v[36:39], v[0:15]
  ds_read_b128 v[32:35], v203 offset:39936
  v_mfma_f32_32x32x16_bf16 v[16:31], a[180:183], v[36:39], v[16:31]
  s_waitcnt lgkmcnt(2)
  v_mfma_f32_32x32x16_bf16 v[0:15], a[40:43], v[40:43], v[0:15]
  ds_read_b128 v[36:39], v204 offset:39936
  v_mfma_f32_32x32x16_bf16 v[16:31], a[184:187], v[40:43], v[16:31]
  s_waitcnt lgkmcnt(2)
  v_mfma_f32_32x32x16_bf16 v[0:15], a[44:47], v[44:47], v[0:15]
  ds_read_b128 v[40:43], v205 offset:39936
  v_mfma_f32_32x32x16_bf16 v[16:31], a[188:191], v[44:47], v[16:31]
  s_waitcnt lgkmcnt(2)
  v_mfma_f32_32x32x16_bf16 v[0:15], a[48:51], v[32:35], v[0:15]
  ds_read_b128 v[44:47], v206 offset:39936
  v_mfma_f32_32x32x16_bf16 v[16:31], a[192:195], v[32:35], v[16:31]
  s_waitcnt lgkmcnt(2)
  v_mfma_f32_32x32x16_bf16 v[0:15], a[52:55], v[36:39], v[0:15]
  ds_read_b128 v[32:35], v203 offset:40960
  v_mfma_f32_32x32x16_bf16 v[16:31], a[196:199], v[36:39], v[16:31]
  s_waitcnt lgkmcnt(2)
  v_mfma_f32_32x32x16_bf16 v[0:15], a[56:59], v[40:43], v[0:15]
  ds_read_b128 v[36:39], v204 offset:40960
  v_mfma_f32_32x32x16_bf16 v[16:31], a[200:203], v[40:43], v[16:31]
  s_waitcnt lgkmcnt(2)
  v_mfma_f32_32x32x16_bf16 v[0:15], a[60:63], v[44:47], v[0:15]
  ds_read_b128 v[40:43], v205 offset:40960
  v_mfma_f32_32x32x16_bf16 v[16:31], a[204:207], v[44:47], v[16:31]
  s_waitcnt lgkmcnt(2)
  v_mfma_f32_32x32x16_bf16 v[0:15], a[64:67], v[32:35], v[0:15]
  ds_read_b128 v[44:47], v206 offset:40960
  v_mfma_f32_32x32x16_bf16 v[16:31], a[208:211], v[32:35], v[16:31]
  s_waitcnt lgkmcnt(2)
  v_mfma_f32_32x32x16_bf16 v[0:15], a[68:71], v[36:39], v[0:15]
  ds_read_b128 v[32:35], v203 offset:41984
  v_mfma_f32_32x32x16_bf16 v[16:31], a[212:215], v[36:39], v[16:31]
  s_waitcnt lgkmcnt(2)
  v_mfma_f32_32x32x16_bf16 v[0:15], a[72:75], v[40:43], v[0:15]
  ds_read_b128 v[36:39], v204 offset:41984
  v_mfma_f32_32x32x16_bf16 v[16:31], a[216:219], v[40:43], v[16:31]
  s_waitcnt lgkmcnt(2)
  v_mfma_f32_32x32x16_bf16 v[0:15], a[76:79], v[44:47], v[0:15]
  ds_read_b128 v[40:43], v205 offset:41984
  v_mfma_f32_32x32x16_bf16 v[16:31], a[220:223], v[44:47], v[16:31]
  s_waitcnt lgkmcnt(2)
  v_mfma_f32_32x32x16_bf16 v[0:15], a[80:83], v[32:35], v[0:15]
  ds_read_b128 v[44:47], v206 offset:41984
  v_mfma_f32_32x32x16_bf16 v[16:31], a[224:227], v[32:35], v[16:31]
  s_waitcnt lgkmcnt(2)
  v_mfma_f32_32x32x16_bf16 v[0:15], a[84:87], v[36:39], v[0:15]
  ds_read_b128 v[32:35], v203 offset:43008
  v_mfma_f32_32x32x16_bf16 v[16:31], a[228:231], v[36:39], v[16:31]
  s_waitcnt lgkmcnt(2)
  v_mfma_f32_32x32x16_bf16 v[0:15], a[88:91], v[40:43], v[0:15]
  ds_read_b128 v[36:39], v204 offset:43008
  v_mfma_f32_32x32x16_bf16 v[16:31], a[232:235], v[40:43], v[16:31]
  s_waitcnt lgkmcnt(2)
  v_mfma_f32_32x32x16_bf16 v[0:15], a[92:95], v[44:47], v[0:15]
  ds_read_b128 v[40:43], v205 offset:43008
  v_mfma_f32_32x32x16_bf16 v[16:31], a[236:239], v[44:47], v[16:31]
  s_waitcnt lgkmcnt(2)
  v_mfma_f32_32x32x16_bf16 v[0:15], a[96:99], v[32:35], v[0:15]
  ds_read_b128 v[44:47], v206 offset:43008
  v_mfma_f32_32x32x16_bf16 v[16:31], a[240:243], v[32:35], v[16:31]
  s_waitcnt lgkmcnt(2)
  v_mfma_f32_32x32x16_bf16 v[0:15], a[100:103], v[36:39], v[0:15]
  ds_read_b128 v[32:35], v203 offset:44032
  v_mfma_f32_32x32x16_bf16 v[16:31], a[244:247], v[36:39], v[16:31]
  s_waitcnt lgkmcnt(2)
  v_mfma_f32_32x32x16_bf16 v[0:15], a[104:107], v[40:43], v[0:15]
  ds_read_b128 v[36:39], v204 offset:44032
  v_mfma_f32_32x32x16_bf16 v[16:31], a[248:251], v[40:43], v[16:31]
  s_waitcnt lgkmcnt(2)
  v_mfma_f32_32x32x16_bf16 v[0:15], a[108:111], v[44:47], v[0:15]
  ds_read_b128 v[40:43], v205 offset:44032
  v_mfma_f32_32x32x16_bf16 v[16:31], a[252:255], v[44:47], v[16:31]
  s_waitcnt lgkmcnt(2)
  v_mfma_f32_32x32x16_bf16 v[0:15], a[112:115], v[32:35], v[0:15]
  ds_read_b128 v[44:47], v206 offset:44032
  v_mfma_f32_32x32x16_bf16 v[16:31], v[224:227], v[32:35], v[16:31]
  s_waitcnt lgkmcnt(2)
  v_mfma_f32_32x32x16_bf16 v[0:15], a[116:119], v[36:39], v[0:15]
  ds_read_b128 v[32:35], v203 offset:45056
  v_mfma_f32_32x32x16_bf16 v[16:31], v[228:231], v[36:39], v[16:31]
  s_waitcnt lgkmcnt(2)
  v_mfma_f32_32x32x16_bf16 v[0:15], a[120:123], v[40:43], v[0:15]
  ds_read_b128 v[36:39], v204 offset:45056
  v_mfma_f32_32x32x16_bf16 v[16:31], v[232:235], v[40:43], v[16:31]
  s_waitcnt lgkmcnt(2)
  v_mfma_f32_32x32x16_bf16 v[0:15], a[124:127], v[44:47], v[0:15]
  ds_read_b128 v[40:43], v205 offset:45056
  v_mfma_f32_32x32x16_bf16 v[16:31], v[236:239], v[44:47], v[16:31]
  s_waitcnt lgkmcnt(2)
  v_mfma_f32_32x32x16_bf16 v[0:15], a[128:131], v[32:35], v[0:15]
  ds_read_b128 v[44:47], v206 offset:45056
  v_mfma_f32_32x32x16_bf16 v[16:31], v[240:243], v[32:35], v[16:31]
  s_waitcnt lgkmcnt(2)
  v_mfma_f32_32x32x16_bf16 v[0:15], a[132:135], v[36:39], v[0:15]
  v_mfma_f32_32x32x16_bf16 v[16:31], v[244:247], v[36:39], v[16:31]
  s_waitcnt lgkmcnt(1)
  v_mfma_f32_32x32x16_bf16 v[0:15], a[136:139], v[40:43], v[0:15]
  v_mfma_f32_32x32x16_bf16 v[16:31], v[248:251], v[40:43], v[16:31]
  s_waitcnt lgkmcnt(0)
  v_mfma_f32_32x32x16_bf16 v[0:15], a[140:143], v[44:47], v[0:15]
  v_mfma_f32_32x32x16_bf16 v[16:31], v[252:255], v[44:47], v[16:31]
  s_add_u32 s60, s60, 36864
  s_nop 2
  v_cvt_pk_bf16_f32 v48, v0, v1
  v_cvt_pk_bf16_f32 v49, v2, v3
  ds_write2_b32 v218, v48, v49 offset0:0 offset1:1
  v_cvt_pk_bf16_f32 v48, v4, v5
  v_cvt_pk_bf16_f32 v49, v6, v7
  ds_write2_b32 v218, v48, v49 offset0:4 offset1:5
  v_cvt_pk_bf16_f32 v48, v8, v9
  v_cvt_pk_bf16_f32 v49, v10, v11
  ds_write2_b32 v218, v48, v49 offset0:8 offset1:9
  v_cvt_pk_bf16_f32 v48, v12, v13
  v_cvt_pk_bf16_f32 v49, v14, v15
  ds_write2_b32 v218, v48, v49 offset0:12 offset1:13
  v_cvt_pk_bf16_f32 v48, v16, v17
  v_cvt_pk_bf16_f32 v49, v18, v19
  ds_write2_b32 v218, v48, v49 offset0:64 offset1:65
  v_cvt_pk_bf16_f32 v48, v20, v21
  v_cvt_pk_bf16_f32 v49, v22, v23
  ds_write2_b32 v218, v48, v49 offset0:68 offset1:69
  v_cvt_pk_bf16_f32 v48, v24, v25
  v_cvt_pk_bf16_f32 v49, v26, v27
  ds_write2_b32 v218, v48, v49 offset0:72 offset1:73
  v_cvt_pk_bf16_f32 v48, v28, v29
  v_cvt_pk_bf16_f32 v49, v30, v31
  ds_write2_b32 v218, v48, v49 offset0:76 offset1:77
  v_add_u32 v218, 16512, v218
  s_waitcnt vmcnt(0) lgkmcnt(0)
  s_barrier
  ds_read_b128 v[32:35], v203 offset:0
  ds_read_b128 v[36:39], v204 offset:0
  ds_read_b128 v[40:43], v205 offset:0
  s_waitcnt lgkmcnt(2)
  v_mfma_f32_32x32x16_bf16 v[0:15], a[0:3], v[32:35], 0
  ds_read_b128 v[44:47], v206 offset:0
  s_add_u32 m0, s67, 36864
  s_nop 0
  buffer_load_dwordx4 v202, s[4:7], s60 offen offset:0 lds
  v_mfma_f32_32x32x16_bf16 v[16:31], a[144:147], v[32:35], 0
  s_waitcnt lgkmcnt(2)
  v_mfma_f32_32x32x16_bf16 v[0:15], a[4:7], v[36:39], v[0:15]
  ds_read_b128 v[32:35], v203 offset:1024
  s_add_u32 m0, s67, 37760
  s_nop 0
  buffer_load_dwordx4 v202, s[4:7], s60 offen offset:128 lds
  v_mfma_f32_32x32x16_bf16 v[16:31], a[148:151], v[36:39], v[16:31]
  s_waitcnt lgkmcnt(2)
  v_mfma_f32_32x32x16_bf16 v[0:15], a[8:11], v[40:43], v[0:15]
  ds_read_b128 v[36:39], v204 offset:1024
  s_add_u32 m0, s67, 38656
  s_nop 0
  buffer_load_dwordx4 v202, s[4:7], s60 offen offset:256 lds
  v_mfma_f32_32x32x16_bf16 v[16:31], a[152:155], v[40:43], v[16:31]
  s_waitcnt lgkmcnt(2)
  v_mfma_f32_32x32x16_bf16 v[0:15], a[12:15], v[44:47], v[0:15]
  ds_read_b128 v[40:43], v205 offset:1024
  s_add_u32 m0, s67, 39552
  s_nop 0
  buffer_load_dwordx4 v202, s[4:7], s60 offen offset:384 lds
  v_mfma_f32_32x32x16_bf16 v[16:31], a[156:159], v[44:47], v[16:31]
  s_waitcnt lgkmcnt(2)
  v_mfma_f32_32x32x16_bf16 v[0:15], a[16:19], v[32:35], v[0:15]
  ds_read_b128 v[44:47], v206 offset:1024
  s_add_u32 m0, s67, 40448
  s_nop 0
  buffer_load_dwordx4 v202, s[4:7], s60 offen offset:512 lds
  v_mfma_f32_32x32x16_bf16 v[16:31], a[160:163], v[32:35], v[16:31]
  s_waitcnt lgkmcnt(2)
  v_mfma_f32_32x32x16_bf16 v[0:15], a[20:23], v[36:39], v[0:15]
  ds_read_b128 v[32:35], v203 offset:2048
  s_add_u32 m0, s67, 41344
  s_nop 0
  buffer_load_dwordx4 v202, s[4:7], s60 offen offset:640 lds
  v_mfma_f32_32x32x16_bf16 v[16:31], a[164:167], v[36:39], v[16:31]
  s_waitcnt lgkmcnt(2)
  v_mfma_f32_32x32x16_bf16 v[0:15], a[24:27], v[40:43], v[0:15]
  ds_read_b128 v[36:39], v204 offset:2048
  s_add_u32 m0, s67, 42240
  s_nop 0
  buffer_load_dwordx4 v202, s[4:7], s60 offen offset:768 lds
  v_mfma_f32_32x32x16_bf16 v[16:31], a[168:171], v[40:43], v[16:31]
  s_waitcnt lgkmcnt(2)
  v_mfma_f32_32x32x16_bf16 v[0:15], a[28:31], v[44:47], v[0:15]
  ds_read_b128 v[40:43], v205 offset:2048
  s_add_u32 m0, s67, 43136
  s_nop 0
  buffer_load_dwordx4 v202, s[4:7], s60 offen offset:896 lds
  v_mfma_f32_32x32x16_bf16 v[16:31], a[172:175], v[44:47], v[16:31]
  s_waitcnt lgkmcnt(2)
  v_mfma_f32_32x32x16_bf16 v[0:15], a[32:35], v[32:35], v[0:15]
  ds_read_b128 v[44:47], v206 offset:2048
  s_add_u32 m0, s67, 44032
  s_nop 0
  buffer_load_dwordx4 v202, s[4:7], s60 offen offset:1024 lds
  v_mfma_f32_32x32x16_bf16 v[16:31], a[176:179], v[32:35], v[16:31]
  s_waitcnt lgkmcnt(2)
  v_mfma_f32_32x32x16_bf16 v[0:15], a[36:39], v[36:39], v[0:15]
  ds_read_b128 v[32:35], v203 offset:3072
  v_mfma_f32_32x32x16_bf16 v[16:31], a[180:183], v[36:39], v[16:31]
  s_waitcnt lgkmcnt(2)
  v_mfma_f32_32x32x16_bf16 v[0:15], a[40:43], v[40:43], v[0:15]
  ds_read_b128 v[36:39], v204 offset:3072
  v_mfma_f32_32x32x16_bf16 v[16:31], a[184:187], v[40:43], v[16:31]
  s_waitcnt lgkmcnt(2)
  v_mfma_f32_32x32x16_bf16 v[0:15], a[44:47], v[44:47], v[0:15]
  ds_read_b128 v[40:43], v205 offset:3072
  v_mfma_f32_32x32x16_bf16 v[16:31], a[188:191], v[44:47], v[16:31]
  s_waitcnt lgkmcnt(2)
  v_mfma_f32_32x32x16_bf16 v[0:15], a[48:51], v[32:35], v[0:15]
  ds_read_b128 v[44:47], v206 offset:3072
  v_mfma_f32_32x32x16_bf16 v[16:31], a[192:195], v[32:35], v[16:31]
  s_waitcnt lgkmcnt(2)
  v_mfma_f32_32x32x16_bf16 v[0:15], a[52:55], v[36:39], v[0:15]
  ds_read_b128 v[32:35], v203 offset:4096
  v_mfma_f32_32x32x16_bf16 v[16:31], a[196:199], v[36:39], v[16:31]
  s_waitcnt lgkmcnt(2)
  v_mfma_f32_32x32x16_bf16 v[0:15], a[56:59], v[40:43], v[0:15]
  ds_read_b128 v[36:39], v204 offset:4096
  v_mfma_f32_32x32x16_bf16 v[16:31], a[200:203], v[40:43], v[16:31]
  s_waitcnt lgkmcnt(2)
  v_mfma_f32_32x32x16_bf16 v[0:15], a[60:63], v[44:47], v[0:15]
  ds_read_b128 v[40:43], v205 offset:4096
  v_mfma_f32_32x32x16_bf16 v[16:31], a[204:207], v[44:47], v[16:31]
  s_waitcnt lgkmcnt(2)
  v_mfma_f32_32x32x16_bf16 v[0:15], a[64:67], v[32:35], v[0:15]
  ds_read_b128 v[44:47], v206 offset:4096
  v_mfma_f32_32x32x16_bf16 v[16:31], a[208:211], v[32:35], v[16:31]
  s_waitcnt lgkmcnt(2)
  v_mfma_f32_32x32x16_bf16 v[0:15], a[68:71], v[36:39], v[0:15]
  ds_read_b128 v[32:35], v203 offset:5120
  v_mfma_f32_32x32x16_bf16 v[16:31], a[212:215], v[36:39], v[16:31]
  s_waitcnt lgkmcnt(2)
  v_mfma_f32_32x32x16_bf16 v[0:15], a[72:75], v[40:43], v[0:15]
  ds_read_b128 v[36:39], v204 offset:5120
  v_mfma_f32_32x32x16_bf16 v[16:31], a[216:219], v[40:43], v[16:31]
  s_waitcnt lgkmcnt(2)
  v_mfma_f32_32x32x16_bf16 v[0:15], a[76:79], v[44:47], v[0:15]
  ds_read_b128 v[40:43], v205 offset:5120
  v_mfma_f32_32x32x16_bf16 v[16:31], a[220:223], v[44:47], v[16:31]
  s_waitcnt lgkmcnt(2)
  v_mfma_f32_32x32x16_bf16 v[0:15], a[80:83], v[32:35], v[0:15]
  ds_read_b128 v[44:47], v206 offset:5120
  v_mfma_f32_32x32x16_bf16 v[16:31], a[224:227], v[32:35], v[16:31]
  s_waitcnt lgkmcnt(2)
  v_mfma_f32_32x32x16_bf16 v[0:15], a[84:87], v[36:39], v[0:15]
  ds_read_b128 v[32:35], v203 offset:6144
  v_mfma_f32_32x32x16_bf16 v[16:31], a[228:231], v[36:39], v[16:31]
  s_waitcnt lgkmcnt(2)
  v_mfma_f32_32x32x16_bf16 v[0:15], a[88:91], v[40:43], v[0:15]
  ds_read_b128 v[36:39], v204 offset:6144
  v_mfma_f32_32x32x16_bf16 v[16:31], a[232:235], v[40:43], v[16:31]
  s_waitcnt lgkmcnt(2)
  v_mfma_f32_32x32x16_bf16 v[0:15], a[92:95], v[44:47], v[0:15]
  ds_read_b128 v[40:43], v205 offset:6144
  v_mfma_f32_32x32x16_bf16 v[16:31], a[236:239], v[44:47], v[16:31]
  s_waitcnt lgkmcnt(2)
  v_mfma_f32_32x32x16_bf16 v[0:15], a[96:99], v[32:35], v[0:15]
  ds_read_b128 v[44:47], v206 offset:6144
  v_mfma_f32_32x32x16_bf16 v[16:31], a[240:243], v[32:35], v[16:31]
  s_waitcnt lgkmcnt(2)
  v_mfma_f32_32x32x16_bf16 v[0:15], a[100:103], v[36:39], v[0:15]
  ds_read_b128 v[32:35], v203 offset:7168
  v_mfma_f32_32x32x16_bf16 v[16:31], a[244:247], v[36:39], v[16:31]
  s_waitcnt lgkmcnt(2)
  v_mfma_f32_32x32x16_bf16 v[0:15], a[104:107], v[40:43], v[0:15]
  ds_read_b128 v[36:39], v204 offset:7168
  v_mfma_f32_32x32x16_bf16 v[16:31], a[248:251], v[40:43], v[16:31]
  s_waitcnt lgkmcnt(2)
  v_mfma_f32_32x32x16_bf16 v[0:15], a[108:111], v[44:47], v[0:15]
  ds_read_b128 v[40:43], v205 offset:7168
  v_mfma_f32_32x32x16_bf16 v[16:31], a[252:255], v[44:47], v[16:31]
  s_waitcnt lgkmcnt(2)
  v_mfma_f32_32x32x16_bf16 v[0:15], a[112:115], v[32:35], v[0:15]
  ds_read_b128 v[44:47], v206 offset:7168
  v_mfma_f32_32x32x16_bf16 v[16:31], v[224:227], v[32:35], v[16:31]
  s_waitcnt lgkmcnt(2)
  v_mfma_f32_32x32x16_bf16 v[0:15], a[116:119], v[36:39], v[0:15]
  ds_read_b128 v[32:35], v203 offset:8192
  v_mfma_f32_32x32x16_bf16 v[16:31], v[228:231], v[36:39], v[16:31]
  s_waitcnt lgkmcnt(2)
  v_mfma_f32_32x32x16_bf16 v[0:15], a[120:123], v[40:43], v[0:15]
  ds_read_b128 v[36:39], v204 offset:8192
  v_mfma_f32_32x32x16_bf16 v[16:31], v[232:235], v[40:43], v[16:31]
  s_waitcnt lgkmcnt(2)
  v_mfma_f32_32x32x16_bf16 v[0:15], a[124:127], v[44:47], v[0:15]
  ds_read_b128 v[40:43], v205 offset:8192
  v_mfma_f32_32x32x16_bf16 v[16:31], v[236:239], v[44:47], v[16:31]
  s_waitcnt lgkmcnt(2)
  v_mfma_f32_32x32x16_bf16 v[0:15], a[128:131], v[32:35], v[0:15]
  ds_read_b128 v[44:47], v206 offset:8192
  v_mfma_f32_32x32x16_bf16 v[16:31], v[240:243], v[32:35], v[16:31]
  s_waitcnt lgkmcnt(2)
  v_mfma_f32_32x32x16_bf16 v[0:15], a[132:135], v[36:39], v[0:15]
  v_mfma_f32_32x32x16_bf16 v[16:31], v[244:247], v[36:39], v[16:31]
  s_waitcnt lgkmcnt(1)
  v_mfma_f32_32x32x16_bf16 v[0:15], a[136:139], v[40:43], v[0:15]
  v_mfma_f32_32x32x16_bf16 v[16:31], v[248:251], v[40:43], v[16:31]
  s_waitcnt lgkmcnt(0)
  v_mfma_f32_32x32x16_bf16 v[0:15], a[140:143], v[44:47], v[0:15]
  v_mfma_f32_32x32x16_bf16 v[16:31], v[252:255], v[44:47], v[16:31]
  s_add_u32 s60, s60, 36864
  s_nop 2
  v_cvt_pk_bf16_f32 v48, v0, v1
  v_cvt_pk_bf16_f32 v49, v2, v3
  ds_write2_b32 v218, v48, v49 offset0:0 offset1:1
  v_cvt_pk_bf16_f32 v48, v4, v5
  v_cvt_pk_bf16_f32 v49, v6, v7
  ds_write2_b32 v218, v48, v49 offset0:4 offset1:5
  v_cvt_pk_bf16_f32 v48, v8, v9
  v_cvt_pk_bf16_f32 v49, v10, v11
  ds_write2_b32 v218, v48, v49 offset0:8 offset1:9
  v_cvt_pk_bf16_f32 v48, v12, v13
  v_cvt_pk_bf16_f32 v49, v14, v15
  ds_write2_b32 v218, v48, v49 offset0:12 offset1:13
  v_cvt_pk_bf16_f32 v48, v16, v17
  v_cvt_pk_bf16_f32 v49, v18, v19
  ds_write2_b32 v218, v48, v49 offset0:64 offset1:65
  v_cvt_pk_bf16_f32 v48, v20, v21
  v_cvt_pk_bf16_f32 v49, v22, v23
  ds_write2_b32 v218, v48, v49 offset0:68 offset1:69
  v_cvt_pk_bf16_f32 v48, v24, v25
  v_cvt_pk_bf16_f32 v49, v26, v27
  ds_write2_b32 v218, v48, v49 offset0:72 offset1:73
  v_cvt_pk_bf16_f32 v48, v28, v29
  v_cvt_pk_bf16_f32 v49, v30, v31
  ds_write2_b32 v218, v48, v49 offset0:76 offset1:77
  v_add_u32 v218, 16512, v218
  s_waitcnt vmcnt(0) lgkmcnt(0)
  s_barrier
  ds_read_b128 v[32:35], v203 offset:36864
  ds_read_b128 v[36:39], v204 offset:36864
  ds_read_b128 v[40:43], v205 offset:36864
  s_waitcnt lgkmcnt(2)
  v_mfma_f32_32x32x16_bf16 v[0:15], a[0:3], v[32:35], 0
  ds_read_b128 v[44:47], v206 offset:36864
  s_add_u32 m0, s67, 0
  s_nop 0
  buffer_load_dwordx4 v202, s[4:7], s60 offen offset:0 lds
  v_mfma_f32_32x32x16_bf16 v[16:31], a[144:147], v[32:35], 0
  s_waitcnt lgkmcnt(2)
  v_mfma_f32_32x32x16_bf16 v[0:15], a[4:7], v[36:39], v[0:15]
  ds_read_b128 v[32:35], v203 offset:37888
  s_add_u32 m0, s67, 896
  s_nop 0
  buffer_load_dwordx4 v202, s[4:7], s60 offen offset:128 lds
  v_mfma_f32_32x32x16_bf16 v[16:31], a[148:151], v[36:39], v[16:31]
  s_waitcnt lgkmcnt(2)
  v_mfma_f32_32x32x16_bf16 v[0:15], a[8:11], v[40:43], v[0:15]
  ds_read_b128 v[36:39], v204 offset:37888
  s_add_u32 m0, s67, 1792
  s_nop 0
  buffer_load_dwordx4 v202, s[4:7], s60 offen offset:256 lds
  v_mfma_f32_32x32x16_bf16 v[16:31], a[152:155], v[40:43], v[16:31]
  s_waitcnt lgkmcnt(2)
  v_mfma_f32_32x32x16_bf16 v[0:15], a[12:15], v[44:47], v[0:15]
  ds_read_b128 v[40:43], v205 offset:37888
  s_add_u32 m0, s67, 2688
  s_nop 0
  buffer_load_dwordx4 v202, s[4:7], s60 offen offset:384 lds
  v_mfma_f32_32x32x16_bf16 v[16:31], a[156:159], v[44:47], v[16:31]
  s_waitcnt lgkmcnt(2)
  v_mfma_f32_32x32x16_bf16 v[0:15], a[16:19], v[32:35], v[0:15]
  ds_read_b128 v[44:47], v206 offset:37888
  s_add_u32 m0, s67, 3584
  s_nop 0
  buffer_load_dwordx4 v202, s[4:7], s60 offen offset:512 lds
  v_mfma_f32_32x32x16_bf16 v[16:31], a[160:163], v[32:35], v[16:31]
  s_waitcnt lgkmcnt(2)
  v_mfma_f32_32x32x16_bf16 v[0:15], a[20:23], v[36:39], v[0:15]
  ds_read_b128 v[32:35], v203 offset:38912
  s_add_u32 m0, s67, 4480
  s_nop 0
  buffer_load_dwordx4 v202, s[4:7], s60 offen offset:640 lds
  v_mfma_f32_32x32x16_bf16 v[16:31], a[164:167], v[36:39], v[16:31]
  s_waitcnt lgkmcnt(2)
  v_mfma_f32_32x32x16_bf16 v[0:15], a[24:27], v[40:43], v[0:15]
  ds_read_b128 v[36:39], v204 offset:38912
  s_add_u32 m0, s67, 5376
  s_nop 0
  buffer_load_dwordx4 v202, s[4:7], s60 offen offset:768 lds
  v_mfma_f32_32x32x16_bf16 v[16:31], a[168:171], v[40:43], v[16:31]
  s_waitcnt lgkmcnt(2)
  v_mfma_f32_32x32x16_bf16 v[0:15], a[28:31], v[44:47], v[0:15]
  ds_read_b128 v[40:43], v205 offset:38912
  s_add_u32 m0, s67, 6272
  s_nop 0
  buffer_load_dwordx4 v202, s[4:7], s60 offen offset:896 lds
  v_mfma_f32_32x32x16_bf16 v[16:31], a[172:175], v[44:47], v[16:31]
  s_waitcnt lgkmcnt(2)
  v_mfma_f32_32x32x16_bf16 v[0:15], a[32:35], v[32:35], v[0:15]
  ds_read_b128 v[44:47], v206 offset:38912
  s_add_u32 m0, s67, 7168
  s_nop 0
  buffer_load_dwordx4 v202, s[4:7], s60 offen offset:1024 lds
  v_mfma_f32_32x32x16_bf16 v[16:31], a[176:179], v[32:35], v[16:31]
  s_waitcnt lgkmcnt(2)
  v_mfma_f32_32x32x16_bf16 v[0:15], a[36:39], v[36:39], v[0:15]
  ds_read_b128 v[32:35], v203 offset:39936
  v_mfma_f32_32x32x16_bf16 v[16:31], a[180:183], v[36:39], v[16:31]
  s_waitcnt lgkmcnt(2)
  v_mfma_f32_32x32x16_bf16 v[0:15], a[40:43], v[40:43], v[0:15]
  ds_read_b128 v[36:39], v204 offset:39936
  v_mfma_f32_32x32x16_bf16 v[16:31], a[184:187], v[40:43], v[16:31]
  s_waitcnt lgkmcnt(2)
  v_mfma_f32_32x32x16_bf16 v[0:15], a[44:47], v[44:47], v[0:15]
  ds_read_b128 v[40:43], v205 offset:39936
  v_mfma_f32_32x32x16_bf16 v[16:31], a[188:191], v[44:47], v[16:31]
  s_waitcnt lgkmcnt(2)
  v_mfma_f32_32x32x16_bf16 v[0:15], a[48:51], v[32:35], v[0:15]
  ds_read_b128 v[44:47], v206 offset:39936
  v_mfma_f32_32x32x16_bf16 v[16:31], a[192:195], v[32:35], v[16:31]
  s_waitcnt lgkmcnt(2)
  v_mfma_f32_32x32x16_bf16 v[0:15], a[52:55], v[36:39], v[0:15]
  ds_read_b128 v[32:35], v203 offset:40960
  v_mfma_f32_32x32x16_bf16 v[16:31], a[196:199], v[36:39], v[16:31]
  s_waitcnt lgkmcnt(2)
  v_mfma_f32_32x32x16_bf16 v[0:15], a[56:59], v[40:43], v[0:15]
  ds_read_b128 v[36:39], v204 offset:40960
  v_mfma_f32_32x32x16_bf16 v[16:31], a[200:203], v[40:43], v[16:31]
  s_waitcnt lgkmcnt(2)
  v_mfma_f32_32x32x16_bf16 v[0:15], a[60:63], v[44:47], v[0:15]
  ds_read_b128 v[40:43], v205 offset:40960
  v_mfma_f32_32x32x16_bf16 v[16:31], a[204:207], v[44:47], v[16:31]
  s_waitcnt lgkmcnt(2)
  v_mfma_f32_32x32x16_bf16 v[0:15], a[64:67], v[32:35], v[0:15]
  ds_read_b128 v[44:47], v206 offset:40960
  v_mfma_f32_32x32x16_bf16 v[16:31], a[208:211], v[32:35], v[16:31]
  s_waitcnt lgkmcnt(2)
  v_mfma_f32_32x32x16_bf16 v[0:15], a[68:71], v[36:39], v[0:15]
  ds_read_b128 v[32:35], v203 offset:41984
  v_mfma_f32_32x32x16_bf16 v[16:31], a[212:215], v[36:39], v[16:31]
  s_waitcnt lgkmcnt(2)
  v_mfma_f32_32x32x16_bf16 v[0:15], a[72:75], v[40:43], v[0:15]
  ds_read_b128 v[36:39], v204 offset:41984
  v_mfma_f32_32x32x16_bf16 v[16:31], a[216:219], v[40:43], v[16:31]
  s_waitcnt lgkmcnt(2)
  v_mfma_f32_32x32x16_bf16 v[0:15], a[76:79], v[44:47], v[0:15]
  ds_read_b128 v[40:43], v205 offset:41984
  v_mfma_f32_32x32x16_bf16 v[16:31], a[220:223], v[44:47], v[16:31]
  s_waitcnt lgkmcnt(2)
  v_mfma_f32_32x32x16_bf16 v[0:15], a[80:83], v[32:35], v[0:15]
  ds_read_b128 v[44:47], v206 offset:41984
  v_mfma_f32_32x32x16_bf16 v[16:31], a[224:227], v[32:35], v[16:31]
  s_waitcnt lgkmcnt(2)
  v_mfma_f32_32x32x16_bf16 v[0:15], a[84:87], v[36:39], v[0:15]
  ds_read_b128 v[32:35], v203 offset:43008
  v_mfma_f32_32x32x16_bf16 v[16:31], a[228:231], v[36:39], v[16:31]
  s_waitcnt lgkmcnt(2)
  v_mfma_f32_32x32x16_bf16 v[0:15], a[88:91], v[40:43], v[0:15]
  ds_read_b128 v[36:39], v204 offset:43008
  v_mfma_f32_32x32x16_bf16 v[16:31], a[232:235], v[40:43], v[16:31]
  s_waitcnt lgkmcnt(2)
  v_mfma_f32_32x32x16_bf16 v[0:15], a[92:95], v[44:47], v[0:15]
  ds_read_b128 v[40:43], v205 offset:43008
  v_mfma_f32_32x32x16_bf16 v[16:31], a[236:239], v[44:47], v[16:31]
  s_waitcnt lgkmcnt(2)
  v_mfma_f32_32x32x16_bf16 v[0:15], a[96:99], v[32:35], v[0:15]
  ds_read_b128 v[44:47], v206 offset:43008
  v_mfma_f32_32x32x16_bf16 v[16:31], a[240:243], v[32:35], v[16:31]
  s_waitcnt lgkmcnt(2)
  v_mfma_f32_32x32x16_bf16 v[0:15], a[100:103], v[36:39], v[0:15]
  ds_read_b128 v[32:35], v203 offset:44032
  v_mfma_f32_32x32x16_bf16 v[16:31], a[244:247], v[36:39], v[16:31]
  s_waitcnt lgkmcnt(2)
  v_mfma_f32_32x32x16_bf16 v[0:15], a[104:107], v[40:43], v[0:15]
  ds_read_b128 v[36:39], v204 offset:44032
  v_mfma_f32_32x32x16_bf16 v[16:31], a[248:251], v[40:43], v[16:31]
  s_waitcnt lgkmcnt(2)
  v_mfma_f32_32x32x16_bf16 v[0:15], a[108:111], v[44:47], v[0:15]
  ds_read_b128 v[40:43], v205 offset:44032
  v_mfma_f32_32x32x16_bf16 v[16:31], a[252:255], v[44:47], v[16:31]
  s_waitcnt lgkmcnt(2)
  v_mfma_f32_32x32x16_bf16 v[0:15], a[112:115], v[32:35], v[0:15]
  ds_read_b128 v[44:47], v206 offset:44032
  v_mfma_f32_32x32x16_bf16 v[16:31], v[224:227], v[32:35], v[16:31]
  s_waitcnt lgkmcnt(2)
  v_mfma_f32_32x32x16_bf16 v[0:15], a[116:119], v[36:39], v[0:15]
  ds_read_b128 v[32:35], v203 offset:45056
  v_mfma_f32_32x32x16_bf16 v[16:31], v[228:231], v[36:39], v[16:31]
  s_waitcnt lgkmcnt(2)
  v_mfma_f32_32x32x16_bf16 v[0:15], a[120:123], v[40:43], v[0:15]
  ds_read_b128 v[36:39], v204 offset:45056
  v_mfma_f32_32x32x16_bf16 v[16:31], v[232:235], v[40:43], v[16:31]
  s_waitcnt lgkmcnt(2)
  v_mfma_f32_32x32x16_bf16 v[0:15], a[124:127], v[44:47], v[0:15]
  ds_read_b128 v[40:43], v205 offset:45056
  v_mfma_f32_32x32x16_bf16 v[16:31], v[236:239], v[44:47], v[16:31]
  s_waitcnt lgkmcnt(2)
  v_mfma_f32_32x32x16_bf16 v[0:15], a[128:131], v[32:35], v[0:15]
  ds_read_b128 v[44:47], v206 offset:45056
  v_mfma_f32_32x32x16_bf16 v[16:31], v[240:243], v[32:35], v[16:31]
  s_waitcnt lgkmcnt(2)
  v_mfma_f32_32x32x16_bf16 v[0:15], a[132:135], v[36:39], v[0:15]
  v_mfma_f32_32x32x16_bf16 v[16:31], v[244:247], v[36:39], v[16:31]
  s_waitcnt lgkmcnt(1)
  v_mfma_f32_32x32x16_bf16 v[0:15], a[136:139], v[40:43], v[0:15]
  v_mfma_f32_32x32x16_bf16 v[16:31], v[248:251], v[40:43], v[16:31]
  s_waitcnt lgkmcnt(0)
  v_mfma_f32_32x32x16_bf16 v[0:15], a[140:143], v[44:47], v[0:15]
  v_mfma_f32_32x32x16_bf16 v[16:31], v[252:255], v[44:47], v[16:31]
  s_add_u32 s60, s60, 36864
  s_nop 2
  v_cvt_pk_bf16_f32 v48, v0, v1
  v_cvt_pk_bf16_f32 v49, v2, v3
  ds_write2_b32 v218, v48, v49 offset0:0 offset1:1
  v_cvt_pk_bf16_f32 v48, v4, v5
  v_cvt_pk_bf16_f32 v49, v6, v7
  ds_write2_b32 v218, v48, v49 offset0:4 offset1:5
  v_cvt_pk_bf16_f32 v48, v8, v9
  v_cvt_pk_bf16_f32 v49, v10, v11
  ds_write2_b32 v218, v48, v49 offset0:8 offset1:9
  v_cvt_pk_bf16_f32 v48, v12, v13
  v_cvt_pk_bf16_f32 v49, v14, v15
  ds_write2_b32 v218, v48, v49 offset0:12 offset1:13
  v_cvt_pk_bf16_f32 v48, v16, v17
  v_cvt_pk_bf16_f32 v49, v18, v19
  ds_write2_b32 v218, v48, v49 offset0:64 offset1:65
  v_cvt_pk_bf16_f32 v48, v20, v21
  v_cvt_pk_bf16_f32 v49, v22, v23
  ds_write2_b32 v218, v48, v49 offset0:68 offset1:69
  v_cvt_pk_bf16_f32 v48, v24, v25
  v_cvt_pk_bf16_f32 v49, v26, v27
  ds_write2_b32 v218, v48, v49 offset0:72 offset1:73
  v_cvt_pk_bf16_f32 v48, v28, v29
  v_cvt_pk_bf16_f32 v49, v30, v31
  ds_write2_b32 v218, v48, v49 offset0:76 offset1:77
  v_add_u32 v218, 16512, v218
  s_waitcnt vmcnt(0) lgkmcnt(0)
  s_barrier
  ds_read_b128 v[32:35], v203 offset:0
  ds_read_b128 v[36:39], v204 offset:0
  ds_read_b128 v[40:43], v205 offset:0
  s_waitcnt lgkmcnt(2)
  v_mfma_f32_32x32x16_bf16 v[0:15], a[0:3], v[32:35], 0
  ds_read_b128 v[44:47], v206 offset:0
  v_mfma_f32_32x32x16_bf16 v[16:31], a[144:147], v[32:35], 0
  s_waitcnt lgkmcnt(2)
  v_mfma_f32_32x32x16_bf16 v[0:15], a[4:7], v[36:39], v[0:15]
  ds_read_b128 v[32:35], v203 offset:1024
  v_mfma_f32_32x32x16_bf16 v[16:31], a[148:151], v[36:39], v[16:31]
  s_waitcnt lgkmcnt(2)
  v_mfma_f32_32x32x16_bf16 v[0:15], a[8:11], v[40:43], v[0:15]
  ds_read_b128 v[36:39], v204 offset:1024
  v_mfma_f32_32x32x16_bf16 v[16:31], a[152:155], v[40:43], v[16:31]
  s_waitcnt lgkmcnt(2)
  v_mfma_f32_32x32x16_bf16 v[0:15], a[12:15], v[44:47], v[0:15]
  ds_read_b128 v[40:43], v205 offset:1024
  v_mfma_f32_32x32x16_bf16 v[16:31], a[156:159], v[44:47], v[16:31]
  s_waitcnt lgkmcnt(2)
  v_mfma_f32_32x32x16_bf16 v[0:15], a[16:19], v[32:35], v[0:15]
  ds_read_b128 v[44:47], v206 offset:1024
  v_mfma_f32_32x32x16_bf16 v[16:31], a[160:163], v[32:35], v[16:31]
  s_waitcnt lgkmcnt(2)
  v_mfma_f32_32x32x16_bf16 v[0:15], a[20:23], v[36:39], v[0:15]
  ds_read_b128 v[32:35], v203 offset:2048
  v_mfma_f32_32x32x16_bf16 v[16:31], a[164:167], v[36:39], v[16:31]
  s_waitcnt lgkmcnt(2)
  v_mfma_f32_32x32x16_bf16 v[0:15], a[24:27], v[40:43], v[0:15]
  ds_read_b128 v[36:39], v204 offset:2048
  v_mfma_f32_32x32x16_bf16 v[16:31], a[168:171], v[40:43], v[16:31]
  s_waitcnt lgkmcnt(2)
  v_mfma_f32_32x32x16_bf16 v[0:15], a[28:31], v[44:47], v[0:15]
  ds_read_b128 v[40:43], v205 offset:2048
  v_mfma_f32_32x32x16_bf16 v[16:31], a[172:175], v[44:47], v[16:31]
  s_waitcnt lgkmcnt(2)
  v_mfma_f32_32x32x16_bf16 v[0:15], a[32:35], v[32:35], v[0:15]
  ds_read_b128 v[44:47], v206 offset:2048
  v_mfma_f32_32x32x16_bf16 v[16:31], a[176:179], v[32:35], v[16:31]
  s_waitcnt lgkmcnt(2)
  v_mfma_f32_32x32x16_bf16 v[0:15], a[36:39], v[36:39], v[0:15]
  ds_read_b128 v[32:35], v203 offset:3072
  v_mfma_f32_32x32x16_bf16 v[16:31], a[180:183], v[36:39], v[16:31]
  s_waitcnt lgkmcnt(2)
  v_mfma_f32_32x32x16_bf16 v[0:15], a[40:43], v[40:43], v[0:15]
  ds_read_b128 v[36:39], v204 offset:3072
  v_mfma_f32_32x32x16_bf16 v[16:31], a[184:187], v[40:43], v[16:31]
  s_waitcnt lgkmcnt(2)
  v_mfma_f32_32x32x16_bf16 v[0:15], a[44:47], v[44:47], v[0:15]
  ds_read_b128 v[40:43], v205 offset:3072
  v_mfma_f32_32x32x16_bf16 v[16:31], a[188:191], v[44:47], v[16:31]
  s_waitcnt lgkmcnt(2)
  v_mfma_f32_32x32x16_bf16 v[0:15], a[48:51], v[32:35], v[0:15]
  ds_read_b128 v[44:47], v206 offset:3072
  v_mfma_f32_32x32x16_bf16 v[16:31], a[192:195], v[32:35], v[16:31]
  s_waitcnt lgkmcnt(2)
  v_mfma_f32_32x32x16_bf16 v[0:15], a[52:55], v[36:39], v[0:15]
  ds_read_b128 v[32:35], v203 offset:4096
  v_mfma_f32_32x32x16_bf16 v[16:31], a[196:199], v[36:39], v[16:31]
  s_waitcnt lgkmcnt(2)
  v_mfma_f32_32x32x16_bf16 v[0:15], a[56:59], v[40:43], v[0:15]
  ds_read_b128 v[36:39], v204 offset:4096
  v_mfma_f32_32x32x16_bf16 v[16:31], a[200:203], v[40:43], v[16:31]
  s_waitcnt lgkmcnt(2)
  v_mfma_f32_32x32x16_bf16 v[0:15], a[60:63], v[44:47], v[0:15]
  ds_read_b128 v[40:43], v205 offset:4096
  v_mfma_f32_32x32x16_bf16 v[16:31], a[204:207], v[44:47], v[16:31]
  s_waitcnt lgkmcnt(2)
  v_mfma_f32_32x32x16_bf16 v[0:15], a[64:67], v[32:35], v[0:15]
  ds_read_b128 v[44:47], v206 offset:4096
  v_mfma_f32_32x32x16_bf16 v[16:31], a[208:211], v[32:35], v[16:31]
  s_waitcnt lgkmcnt(2)
  v_mfma_f32_32x32x16_bf16 v[0:15], a[68:71], v[36:39], v[0:15]
  ds_read_b128 v[32:35], v203 offset:5120
  v_mfma_f32_32x32x16_bf16 v[16:31], a[212:215], v[36:39], v[16:31]
  s_waitcnt lgkmcnt(2)
  v_mfma_f32_32x32x16_bf16 v[0:15], a[72:75], v[40:43], v[0:15]
  ds_read_b128 v[36:39], v204 offset:5120
  v_mfma_f32_32x32x16_bf16 v[16:31], a[216:219], v[40:43], v[16:31]
  s_waitcnt lgkmcnt(2)
  v_mfma_f32_32x32x16_bf16 v[0:15], a[76:79], v[44:47], v[0:15]
  ds_read_b128 v[40:43], v205 offset:5120
  v_mfma_f32_32x32x16_bf16 v[16:31], a[220:223], v[44:47], v[16:31]
  s_waitcnt lgkmcnt(2)
  v_mfma_f32_32x32x16_bf16 v[0:15], a[80:83], v[32:35], v[0:15]
  ds_read_b128 v[44:47], v206 offset:5120
  v_mfma_f32_32x32x16_bf16 v[16:31], a[224:227], v[32:35], v[16:31]
  s_waitcnt lgkmcnt(2)
  v_mfma_f32_32x32x16_bf16 v[0:15], a[84:87], v[36:39], v[0:15]
  ds_read_b128 v[32:35], v203 offset:6144
  v_mfma_f32_32x32x16_bf16 v[16:31], a[228:231], v[36:39], v[16:31]
  s_waitcnt lgkmcnt(2)
  v_mfma_f32_32x32x16_bf16 v[0:15], a[88:91], v[40:43], v[0:15]
  ds_read_b128 v[36:39], v204 offset:6144
  v_mfma_f32_32x32x16_bf16 v[16:31], a[232:235], v[40:43], v[16:31]
  s_waitcnt lgkmcnt(2)
  v_mfma_f32_32x32x16_bf16 v[0:15], a[92:95], v[44:47], v[0:15]
  ds_read_b128 v[40:43], v205 offset:6144
  v_mfma_f32_32x32x16_bf16 v[16:31], a[236:239], v[44:47], v[16:31]
  s_waitcnt lgkmcnt(2)
  v_mfma_f32_32x32x16_bf16 v[0:15], a[96:99], v[32:35], v[0:15]
  ds_read_b128 v[44:47], v206 offset:6144
  v_mfma_f32_32x32x16_bf16 v[16:31], a[240:243], v[32:35], v[16:31]
  s_waitcnt lgkmcnt(2)
  v_mfma_f32_32x32x16_bf16 v[0:15], a[100:103], v[36:39], v[0:15]
  ds_read_b128 v[32:35], v203 offset:7168
  v_mfma_f32_32x32x16_bf16 v[16:31], a[244:247], v[36:39], v[16:31]
  s_waitcnt lgkmcnt(2)
  v_mfma_f32_32x32x16_bf16 v[0:15], a[104:107], v[40:43], v[0:15]
  ds_read_b128 v[36:39], v204 offset:7168
  v_mfma_f32_32x32x16_bf16 v[16:31], a[248:251], v[40:43], v[16:31]
  s_waitcnt lgkmcnt(2)
  v_mfma_f32_32x32x16_bf16 v[0:15], a[108:111], v[44:47], v[0:15]
  ds_read_b128 v[40:43], v205 offset:7168
  v_mfma_f32_32x32x16_bf16 v[16:31], a[252:255], v[44:47], v[16:31]
  s_waitcnt lgkmcnt(2)
  v_mfma_f32_32x32x16_bf16 v[0:15], a[112:115], v[32:35], v[0:15]
  ds_read_b128 v[44:47], v206 offset:7168
  v_mfma_f32_32x32x16_bf16 v[16:31], v[224:227], v[32:35], v[16:31]
  s_waitcnt lgkmcnt(2)
  v_mfma_f32_32x32x16_bf16 v[0:15], a[116:119], v[36:39], v[0:15]
  ds_read_b128 v[32:35], v203 offset:8192
  v_mfma_f32_32x32x16_bf16 v[16:31], v[228:231], v[36:39], v[16:31]
  s_waitcnt lgkmcnt(2)
  v_mfma_f32_32x32x16_bf16 v[0:15], a[120:123], v[40:43], v[0:15]
  ds_read_b128 v[36:39], v204 offset:8192
  v_mfma_f32_32x32x16_bf16 v[16:31], v[232:235], v[40:43], v[16:31]
  s_waitcnt lgkmcnt(2)
  v_mfma_f32_32x32x16_bf16 v[0:15], a[124:127], v[44:47], v[0:15]
  ds_read_b128 v[40:43], v205 offset:8192
  v_mfma_f32_32x32x16_bf16 v[16:31], v[236:239], v[44:47], v[16:31]
  s_waitcnt lgkmcnt(2)
  v_mfma_f32_32x32x16_bf16 v[0:15], a[128:131], v[32:35], v[0:15]
  ds_read_b128 v[44:47], v206 offset:8192
  v_mfma_f32_32x32x16_bf16 v[16:31], v[240:243], v[32:35], v[16:31]
  s_waitcnt lgkmcnt(2)
  v_mfma_f32_32x32x16_bf16 v[0:15], a[132:135], v[36:39], v[0:15]
  v_mfma_f32_32x32x16_bf16 v[16:31], v[244:247], v[36:39], v[16:31]
  s_waitcnt lgkmcnt(1)
  v_mfma_f32_32x32x16_bf16 v[0:15], a[136:139], v[40:43], v[0:15]
  v_mfma_f32_32x32x16_bf16 v[16:31], v[248:251], v[40:43], v[16:31]
  s_waitcnt lgkmcnt(0)
  v_mfma_f32_32x32x16_bf16 v[0:15], a[140:143], v[44:47], v[0:15]
  v_mfma_f32_32x32x16_bf16 v[16:31], v[252:255], v[44:47], v[16:31]
  s_add_u32 s60, s60, 36864
  s_nop 2
  v_cvt_pk_bf16_f32 v48, v0, v1
  v_cvt_pk_bf16_f32 v49, v2, v3
  ds_write2_b32 v218, v48, v49 offset0:0 offset1:1
  v_cvt_pk_bf16_f32 v48, v4, v5
  v_cvt_pk_bf16_f32 v49, v6, v7
  ds_write2_b32 v218, v48, v49 offset0:4 offset1:5
  v_cvt_pk_bf16_f32 v48, v8, v9
  v_cvt_pk_bf16_f32 v49, v10, v11
  ds_write2_b32 v218, v48, v49 offset0:8 offset1:9
  v_cvt_pk_bf16_f32 v48, v12, v13
  v_cvt_pk_bf16_f32 v49, v14, v15
  ds_write2_b32 v218, v48, v49 offset0:12 offset1:13
  v_cvt_pk_bf16_f32 v48, v16, v17
  v_cvt_pk_bf16_f32 v49, v18, v19
  ds_write2_b32 v218, v48, v49 offset0:64 offset1:65
  v_cvt_pk_bf16_f32 v48, v20, v21
  v_cvt_pk_bf16_f32 v49, v22, v23
  ds_write2_b32 v218, v48, v49 offset0:68 offset1:69
  v_cvt_pk_bf16_f32 v48, v24, v25
  v_cvt_pk_bf16_f32 v49, v26, v27
  ds_write2_b32 v218, v48, v49 offset0:72 offset1:73
  v_cvt_pk_bf16_f32 v48, v28, v29
  v_cvt_pk_bf16_f32 v49, v30, v31
  ds_write2_b32 v218, v48, v49 offset0:76 offset1:77
  v_add_u32 v218, 16512, v218
  s_waitcnt vmcnt(0) lgkmcnt(0)
  s_barrier
  v_mul_u32_u24 v219, 516, v200
  s_mul_i32 s54, s52, 36
  s_add_u32 s55, s54, 83016
  v_add_u32 v219, s55, v219
  v_mul_u32_u24 v220, 1152, v200
  s_mul_i32 s55, s68, 144
  s_add_u32 s54, s54, s55
  s_mul_i32 s55, s69, 147456
  s_add_u32 s64, s54, s55
  s_add_u32 s64, s64, 62914560
  s_lshl_b32 s66, s69, 7
  s_mov_b32 s57, 1051597459
  ds_read_b32 v0, v219 offset:7224
  ds_read_b32 v1, v219 offset:7228
  ds_read_b32 v2, v219 offset:7232
  ds_read_b32 v3, v219 offset:7236
  ds_read_b32 v4, v219 offset:7240
  ds_read_b32 v5, v219 offset:7244
  ds_read_b32 v6, v219 offset:7248
  ds_read_b32 v7, v219 offset:7252
  ds_read_b32 v8, v219 offset:7256
  ds_read_b32 v16, v219 offset:7368
  ds_read_b32 v17, v219 offset:7372
  ds_read_b32 v18, v219 offset:7376
  ds_read_b32 v19, v219 offset:7380
  ds_read_b32 v20, v219 offset:7384
  ds_read_b32 v21, v219 offset:7388
  ds_read_b32 v22, v219 offset:7392
  ds_read_b32 v23, v219 offset:7396
  ds_read_b32 v24, v219 offset:7400
  ds_read_b32 v25, v219 offset:6336
  ds_read_b32 v26, v219 offset:6340
  ds_read_b32 v27, v219 offset:6344
  ds_read_b32 v28, v219 offset:6348
  ds_read_b32 v29, v219 offset:6352
  ds_read_b32 v30, v219 offset:6356
  ds_read_b32 v31, v219 offset:6360
  ds_read_b32 v32, v219 offset:6364
  ds_read_b32 v33, v219 offset:6368
  ds_read_b32 v34, v219 offset:5304
  ds_read_b32 v35, v219 offset:5308
  ds_read_b32 v36, v219 offset:5312
  ds_read_b32 v37, v219 offset:5316
  ds_read_b32 v38, v219 offset:5320
  ds_read_b32 v39, v219 offset:5324
  ds_read_b32 v40, v219 offset:5328
  ds_read_b32 v41, v219 offset:5332
  ds_read_b32 v42, v219 offset:5336
  ds_read_b32 v43, v219 offset:4272
  ds_read_b32 v44, v219 offset:4276
  ds_read_b32 v45, v219 offset:4280
  ds_read_b32 v46, v219 offset:4284
  ds_read_b32 v47, v219 offset:4288
  ds_read_b32 v48, v219 offset:4292
  ds_read_b32 v49, v219 offset:4296
  ds_read_b32 v50, v219 offset:4300
  ds_read_b32 v51, v219 offset:4304
  ds_read_b32 v52, v219 offset:3240
  ds_read_b32 v53, v219 offset:3244
  ds_read_b32 v54, v219 offset:3248
  ds_read_b32 v55, v219 offset:3252
  ds_read_b32 v56, v219 offset:3256
  ds_read_b32 v57, v219 offset:3260
  ds_read_b32 v58, v219 offset:3264
  ds_read_b32 v59, v219 offset:3268
  ds_read_b32 v60, v219 offset:3272
  ds_read_b32 v61, v219 offset:2208
  ds_read_b32 v62, v219 offset:2212
  ds_read_b32 v63, v219 offset:2216
  ds_read_b32 v64, v219 offset:2220
  ds_read_b32 v65, v219 offset:2224
  ds_read_b32 v66, v219 offset:2228
  ds_read_b32 v67, v219 offset:2232
  ds_read_b32 v68, v219 offset:2236
  ds_read_b32 v69, v219 offset:2240
  ds_read_b32 v70, v219 offset:1176
  ds_read_b32 v71, v219 offset:1180
  ds_read_b32 v72, v219 offset:1184
  ds_read_b32 v73, v219 offset:1188
  ds_read_b32 v74, v219 offset:1192
  ds_read_b32 v75, v219 offset:1196
  ds_read_b32 v76, v219 offset:1200
  ds_read_b32 v77, v219 offset:1204
  ds_read_b32 v78, v219 offset:1208
  ds_read_b32 v79, v219 offset:144
  ds_read_b32 v80, v219 offset:148
  ds_read_b32 v81, v219 offset:152
  ds_read_b32 v82, v219 offset:156
  ds_read_b32 v83, v219 offset:160
  ds_read_b32 v84, v219 offset:164
  ds_read_b32 v85, v219 offset:168
  ds_read_b32 v86, v219 offset:172
  ds_read_b32 v87, v219 offset:176
  v_mov_b32 v100, 0
  v_mov_b32 v101, 0
  v_mov_b32 v102, 0
  v_mov_b32 v103, 0
  v_mov_b32 v104, 0
  v_mov_b32 v105, 0
  v_mov_b32 v106, 0
  v_mov_b32 v107, 0
  s_waitcnt lgkmcnt(15)
  v_dot2c_f32_bf16 v100, v0, v16
  v_dot2c_f32_bf16 v101, v0, v25
  v_dot2c_f32_bf16 v102, v0, v34
  v_dot2c_f32_bf16 v103, v0, v43
  v_dot2c_f32_bf16 v104, v0, v52
  v_dot2c_f32_bf16 v105, v0, v61
  v_dot2c_f32_bf16 v106, v0, v70
  s_waitcnt lgkmcnt(8)
  v_dot2c_f32_bf16 v107, v0, v79
  v_dot2c_f32_bf16 v100, v1, v17
  v_dot2c_f32_bf16 v101, v1, v26
  v_dot2c_f32_bf16 v102, v1, v35
  v_dot2c_f32_bf16 v103, v1, v44
  v_dot2c_f32_bf16 v104, v1, v53
  v_dot2c_f32_bf16 v105, v1, v62
  v_dot2c_f32_bf16 v106, v1, v71
  s_waitcnt lgkmcnt(7)
  v_dot2c_f32_bf16 v107, v1, v80
  v_dot2c_f32_bf16 v100, v2, v18
  v_dot2c_f32_bf16 v101, v2, v27
  v_dot2c_f32_bf16 v102, v2, v36
  v_dot2c_f32_bf16 v103, v2, v45
  v_dot2c_f32_bf16 v104, v2, v54
  v_dot2c_f32_bf16 v105, v2, v63
  v_dot2c_f32_bf16 v106, v2, v72
  s_waitcnt lgkmcnt(6)
  v_dot2c_f32_bf16 v107, v2, v81
  v_dot2c_f32_bf16 v100, v3, v19
  v_dot2c_f32_bf16 v101, v3, v28
  v_dot2c_f32_bf16 v102, v3, v37
  v_dot2c_f32_bf16 v103, v3, v46
  v_dot2c_f32_bf16 v104, v3, v55
  v_dot2c_f32_bf16 v105, v3, v64
  v_dot2c_f32_bf16 v106, v3, v73
  s_waitcnt lgkmcnt(5)
  v_dot2c_f32_bf16 v107, v3, v82
  v_dot2c_f32_bf16 v100, v4, v20
  v_dot2c_f32_bf16 v101, v4, v29
  v_dot2c_f32_bf16 v102, v4, v38
  v_dot2c_f32_bf16 v103, v4, v47
  v_dot2c_f32_bf16 v104, v4, v56
  v_dot2c_f32_bf16 v105, v4, v65
  v_dot2c_f32_bf16 v106, v4, v74
  s_waitcnt lgkmcnt(4)
  v_dot2c_f32_bf16 v107, v4, v83
  v_dot2c_f32_bf16 v100, v5, v21
  v_dot2c_f32_bf16 v101, v5, v30
  v_dot2c_f32_bf16 v102, v5, v39
  v_dot2c_f32_bf16 v103, v5, v48
  v_dot2c_f32_bf16 v104, v5, v57
  v_dot2c_f32_bf16 v105, v5, v66
  v_dot2c_f32_bf16 v106, v5, v75
  s_waitcnt lgkmcnt(3)
  v_dot2c_f32_bf16 v107, v5, v84
  v_dot2c_f32_bf16 v100, v6, v22
  v_dot2c_f32_bf16 v101, v6, v31
  v_dot2c_f32_bf16 v102, v6, v40
  v_dot2c_f32_bf16 v103, v6, v49
  v_dot2c_f32_bf16 v104, v6, v58
  v_dot2c_f32_bf16 v105, v6, v67
  v_dot2c_f32_bf16 v106, v6, v76
  s_waitcnt lgkmcnt(2)
  v_dot2c_f32_bf16 v107, v6, v85
  v_dot2c_f32_bf16 v100, v7, v23
  v_dot2c_f32_bf16 v101, v7, v32
  v_dot2c_f32_bf16 v102, v7, v41
  v_dot2c_f32_bf16 v103, v7, v50
  v_dot2c_f32_bf16 v104, v7, v59
  v_dot2c_f32_bf16 v105, v7, v68
  v_dot2c_f32_bf16 v106, v7, v77
  s_waitcnt lgkmcnt(1)
  v_dot2c_f32_bf16 v107, v7, v86
  v_dot2c_f32_bf16 v100, v8, v24
  v_dot2c_f32_bf16 v101, v8, v33
  v_dot2c_f32_bf16 v102, v8, v42
  v_dot2c_f32_bf16 v103, v8, v51
  v_dot2c_f32_bf16 v104, v8, v60
  v_dot2c_f32_bf16 v105, v8, v69
  v_dot2c_f32_bf16 v106, v8, v78
  s_waitcnt lgkmcnt(0)
  v_dot2c_f32_bf16 v107, v8, v87
  ds_read_b32 v16, v219 offset:7512
  ds_read_b32 v17, v219 offset:7516
  ds_read_b32 v18, v219 offset:7520
  ds_read_b32 v19, v219 offset:7524
  ds_read_b32 v20, v219 offset:7528
  ds_read_b32 v21, v219 offset:7532
  ds_read_b32 v22, v219 offset:7536
  ds_read_b32 v23, v219 offset:7540
  ds_read_b32 v24, v219 offset:7544
  ds_read_b32 v25, v219 offset:6480
  ds_read_b32 v26, v219 offset:6484
  ds_read_b32 v27, v219 offset:6488
  ds_read_b32 v28, v219 offset:6492
  ds_read_b32 v29, v219 offset:6496
  ds_read_b32 v30, v219 offset:6500
  ds_read_b32 v31, v219 offset:6504
  ds_read_b32 v32, v219 offset:6508
  ds_read_b32 v33, v219 offset:6512
  ds_read_b32 v34, v219 offset:5448
  ds_read_b32 v35, v219 offset:5452
  ds_read_b32 v36, v219 offset:5456
  ds_read_b32 v37, v219 offset:5460
  ds_read_b32 v38, v219 offset:5464
  ds_read_b32 v39, v219 offset:5468
  ds_read_b32 v40, v219 offset:5472
  ds_read_b32 v41, v219 offset:5476
  ds_read_b32 v42, v219 offset:5480
  ds_read_b32 v43, v219 offset:4416
  ds_read_b32 v44, v219 offset:4420
  ds_read_b32 v45, v219 offset:4424
  ds_read_b32 v46, v219 offset:4428
  ds_read_b32 v47, v219 offset:4432
  ds_read_b32 v48, v219 offset:4436
  ds_read_b32 v49, v219 offset:4440
  ds_read_b32 v50, v219 offset:4444
  ds_read_b32 v51, v219 offset:4448
  ds_read_b32 v52, v219 offset:3384
  ds_read_b32 v53, v219 offset:3388
  ds_read_b32 v54, v219 offset:3392
  ds_read_b32 v55, v219 offset:3396
  ds_read_b32 v56, v219 offset:3400
  ds_read_b32 v57, v219 offset:3404
  ds_read_b32 v58, v219 offset:3408
  ds_read_b32 v59, v219 offset:3412
  ds_read_b32 v60, v219 offset:3416
  ds_read_b32 v61, v219 offset:2352
  ds_read_b32 v62, v219 offset:2356
  ds_read_b32 v63, v219 offset:2360
  ds_read_b32 v64, v219 offset:2364
  ds_read_b32 v65, v219 offset:2368
  ds_read_b32 v66, v219 offset:2372
  ds_read_b32 v67, v219 offset:2376
  ds_read_b32 v68, v219 offset:2380
  ds_read_b32 v69, v219 offset:2384
  ds_read_b32 v70, v219 offset:1320
  ds_read_b32 v71, v219 offset:1324
  ds_read_b32 v72, v219 offset:1328
  ds_read_b32 v73, v219 offset:1332
  ds_read_b32 v74, v219 offset:1336
  ds_read_b32 v75, v219 offset:1340
  ds_read_b32 v76, v219 offset:1344
  ds_read_b32 v77, v219 offset:1348
  ds_read_b32 v78, v219 offset:1352
  ds_read_b32 v79, v219 offset:288
  ds_read_b32 v80, v219 offset:292
  ds_read_b32 v81, v219 offset:296
  ds_read_b32 v82, v219 offset:300
  ds_read_b32 v83, v219 offset:304
  ds_read_b32 v84, v219 offset:308
  ds_read_b32 v85, v219 offset:312
  ds_read_b32 v86, v219 offset:316
  ds_read_b32 v87, v219 offset:320
  v_add_u32 v211, s66, v200
  v_mov_b32 v212, 0xf149f2ca
  v_mul_f32 v100, s57, v100
  v_mul_f32 v101, s57, v101
  v_mul_f32 v102, s57, v102
  v_mul_f32 v103, s57, v103
  v_mul_f32 v104, s57, v104
  v_mul_f32 v105, s57, v105
  v_mul_f32 v106, s57, v106
  v_mul_f32 v107, s57, v107
  v_cmp_gt_u32 vcc, 2, v211
  s_nop 1
  v_cndmask_b32 v101, v101, v212, vcc
  v_cmp_gt_u32 vcc, 4, v211
  s_nop 1
  v_cndmask_b32 v102, v102, v212, vcc
  v_cmp_gt_u32 vcc, 6, v211
  s_nop 1
  v_cndmask_b32 v103, v103, v212, vcc
  v_cmp_gt_u32 vcc, 8, v211
  s_nop 1
  v_cndmask_b32 v104, v104, v212, vcc
  v_cmp_gt_u32 vcc, 10, v211
  s_nop 1
  v_cndmask_b32 v105, v105, v212, vcc
  v_cmp_gt_u32 vcc, 12, v211
  s_nop 1
  v_cndmask_b32 v106, v106, v212, vcc
  v_cmp_gt_u32 vcc, 14, v211
  s_nop 1
  v_cndmask_b32 v107, v107, v212, vcc
  v_max3_f32 v213, v100, v101, v102
  v_max3_f32 v213, v213, v103, v104
  v_max3_f32 v213, v213, v105, v106
  v_max_f32 v213, v213, v107
  v_sub_f32 v100, v100, v213
  v_sub_f32 v101, v101, v213
  v_sub_f32 v102, v102, v213
  v_sub_f32 v103, v103, v213
  v_sub_f32 v104, v104, v213
  v_sub_f32 v105, v105, v213
  v_sub_f32 v106, v106, v213
  v_sub_f32 v107, v107, v213
  v_exp_f32 v100, v100
  v_exp_f32 v101, v101
  v_exp_f32 v102, v102
  v_exp_f32 v103, v103
  v_exp_f32 v104, v104
  v_exp_f32 v105, v105
  v_exp_f32 v106, v106
  v_exp_f32 v107, v107
  v_add_f32 v213, v100, v101
  v_add_f32 v213, v213, v102
  v_add_f32 v213, v213, v103
  v_add_f32 v213, v213, v104
  v_add_f32 v213, v213, v105
  v_add_f32 v213, v213, v106
  v_add_f32 v213, v213, v107
  v_rcp_f32 v213, v213
  v_mov_b32 v214, 0
  v_mul_f32 v100, v213, v100
  v_mul_f32 v101, v213, v101
  v_mul_f32 v102, v213, v102
  v_mul_f32 v103, v213, v103
  v_mul_f32 v104, v213, v104
  v_mul_f32 v105, v213, v105
  v_mul_f32 v106, v213, v106
  v_mul_f32 v107, v213, v107
  v_mov_b32 v112, 0
  v_mov_b32 v113, 0
  v_mov_b32 v114, 0
  v_mov_b32 v115, 0
  v_mov_b32 v116, 0
  v_mov_b32 v117, 0
  v_mov_b32 v118, 0
  v_mov_b32 v119, 0
  v_mov_b32 v120, 0
  v_mov_b32 v121, 0
  v_mov_b32 v122, 0
  v_mov_b32 v123, 0
  v_mov_b32 v124, 0
  v_mov_b32 v125, 0
  v_mov_b32 v126, 0
  v_mov_b32 v127, 0
  v_mov_b32 v128, 0
  v_mov_b32 v129, 0
  v_cvt_pk_bf16_f32 v0, v100, v214
  v_cvt_pk_bf16_f32 v1, v214, v100
  s_waitcnt lgkmcnt(15)
  v_dot2c_f32_bf16 v112, v16, v0
  v_dot2c_f32_bf16 v113, v16, v1
  v_dot2c_f32_bf16 v114, v17, v0
  v_dot2c_f32_bf16 v115, v17, v1
  v_dot2c_f32_bf16 v116, v18, v0
  v_dot2c_f32_bf16 v117, v18, v1
  v_dot2c_f32_bf16 v118, v19, v0
  v_dot2c_f32_bf16 v119, v19, v1
  v_dot2c_f32_bf16 v120, v20, v0
  v_dot2c_f32_bf16 v121, v20, v1
  v_dot2c_f32_bf16 v122, v21, v0
  v_dot2c_f32_bf16 v123, v21, v1
  v_dot2c_f32_bf16 v124, v22, v0
  v_dot2c_f32_bf16 v125, v22, v1
  v_dot2c_f32_bf16 v126, v23, v0
  v_dot2c_f32_bf16 v127, v23, v1
  v_dot2c_f32_bf16 v128, v24, v0
  v_dot2c_f32_bf16 v129, v24, v1
  v_cvt_pk_bf16_f32 v2, v101, v214
  v_cvt_pk_bf16_f32 v3, v214, v101
  v_dot2c_f32_bf16 v112, v25, v2
  v_dot2c_f32_bf16 v113, v25, v3
  v_dot2c_f32_bf16 v114, v26, v2
  v_dot2c_f32_bf16 v115, v26, v3
  v_dot2c_f32_bf16 v116, v27, v2
  v_dot2c_f32_bf16 v117, v27, v3
  v_dot2c_f32_bf16 v118, v28, v2
  v_dot2c_f32_bf16 v119, v28, v3
  v_dot2c_f32_bf16 v120, v29, v2
  v_dot2c_f32_bf16 v121, v29, v3
  v_dot2c_f32_bf16 v122, v30, v2
  v_dot2c_f32_bf16 v123, v30, v3
  v_dot2c_f32_bf16 v124, v31, v2
  v_dot2c_f32_bf16 v125, v31, v3
  v_dot2c_f32_bf16 v126, v32, v2
  v_dot2c_f32_bf16 v127, v32, v3
  v_dot2c_f32_bf16 v128, v33, v2
  v_dot2c_f32_bf16 v129, v33, v3
  v_cvt_pk_bf16_f32 v0, v102, v214
  v_cvt_pk_bf16_f32 v1, v214, v102
  v_dot2c_f32_bf16 v112, v34, v0
  v_dot2c_f32_bf16 v113, v34, v1
  v_dot2c_f32_bf16 v114, v35, v0
  v_dot2c_f32_bf16 v115, v35, v1
  v_dot2c_f32_bf16 v116, v36, v0
  v_dot2c_f32_bf16 v117, v36, v1
  v_dot2c_f32_bf16 v118, v37, v0
  v_dot2c_f32_bf16 v119, v37, v1
  v_dot2c_f32_bf16 v120, v38, v0
  v_dot2c_f32_bf16 v121, v38, v1
  v_dot2c_f32_bf16 v122, v39, v0
  v_dot2c_f32_bf16 v123, v39, v1
  v_dot2c_f32_bf16 v124, v40, v0
  v_dot2c_f32_bf16 v125, v40, v1
  v_dot2c_f32_bf16 v126, v41, v0
  v_dot2c_f32_bf16 v127, v41, v1
  v_dot2c_f32_bf16 v128, v42, v0
  v_dot2c_f32_bf16 v129, v42, v1
  v_cvt_pk_bf16_f32 v2, v103, v214
  v_cvt_pk_bf16_f32 v3, v214, v103
  v_dot2c_f32_bf16 v112, v43, v2
  v_dot2c_f32_bf16 v113, v43, v3
  v_dot2c_f32_bf16 v114, v44, v2
  v_dot2c_f32_bf16 v115, v44, v3
  v_dot2c_f32_bf16 v116, v45, v2
  v_dot2c_f32_bf16 v117, v45, v3
  v_dot2c_f32_bf16 v118, v46, v2
  v_dot2c_f32_bf16 v119, v46, v3
  v_dot2c_f32_bf16 v120, v47, v2
  v_dot2c_f32_bf16 v121, v47, v3
  v_dot2c_f32_bf16 v122, v48, v2
  v_dot2c_f32_bf16 v123, v48, v3
  v_dot2c_f32_bf16 v124, v49, v2
  v_dot2c_f32_bf16 v125, v49, v3
  v_dot2c_f32_bf16 v126, v50, v2
  v_dot2c_f32_bf16 v127, v50, v3
  v_dot2c_f32_bf16 v128, v51, v2
  v_dot2c_f32_bf16 v129, v51, v3
  v_cvt_pk_bf16_f32 v0, v104, v214
  v_cvt_pk_bf16_f32 v1, v214, v104
  v_dot2c_f32_bf16 v112, v52, v0
  v_dot2c_f32_bf16 v113, v52, v1
  v_dot2c_f32_bf16 v114, v53, v0
  v_dot2c_f32_bf16 v115, v53, v1
  v_dot2c_f32_bf16 v116, v54, v0
  v_dot2c_f32_bf16 v117, v54, v1
  v_dot2c_f32_bf16 v118, v55, v0
  v_dot2c_f32_bf16 v119, v55, v1
  v_dot2c_f32_bf16 v120, v56, v0
  v_dot2c_f32_bf16 v121, v56, v1
  v_dot2c_f32_bf16 v122, v57, v0
  v_dot2c_f32_bf16 v123, v57, v1
  v_dot2c_f32_bf16 v124, v58, v0
  v_dot2c_f32_bf16 v125, v58, v1
  v_dot2c_f32_bf16 v126, v59, v0
  v_dot2c_f32_bf16 v127, v59, v1
  v_dot2c_f32_bf16 v128, v60, v0
  v_dot2c_f32_bf16 v129, v60, v1
  v_cvt_pk_bf16_f32 v2, v105, v214
  v_cvt_pk_bf16_f32 v3, v214, v105
  v_dot2c_f32_bf16 v112, v61, v2
  v_dot2c_f32_bf16 v113, v61, v3
  v_dot2c_f32_bf16 v114, v62, v2
  v_dot2c_f32_bf16 v115, v62, v3
  v_dot2c_f32_bf16 v116, v63, v2
  v_dot2c_f32_bf16 v117, v63, v3
  v_dot2c_f32_bf16 v118, v64, v2
  v_dot2c_f32_bf16 v119, v64, v3
  v_dot2c_f32_bf16 v120, v65, v2
  v_dot2c_f32_bf16 v121, v65, v3
  v_dot2c_f32_bf16 v122, v66, v2
  v_dot2c_f32_bf16 v123, v66, v3
  v_dot2c_f32_bf16 v124, v67, v2
  v_dot2c_f32_bf16 v125, v67, v3
  v_dot2c_f32_bf16 v126, v68, v2
  v_dot2c_f32_bf16 v127, v68, v3
  v_dot2c_f32_bf16 v128, v69, v2
  v_dot2c_f32_bf16 v129, v69, v3
  v_cvt_pk_bf16_f32 v0, v106, v214
  v_cvt_pk_bf16_f32 v1, v214, v106
  v_dot2c_f32_bf16 v112, v70, v0
  v_dot2c_f32_bf16 v113, v70, v1
  v_dot2c_f32_bf16 v114, v71, v0
  v_dot2c_f32_bf16 v115, v71, v1
  v_dot2c_f32_bf16 v116, v72, v0
  v_dot2c_f32_bf16 v117, v72, v1
  s_waitcnt lgkmcnt(14)
  v_dot2c_f32_bf16 v118, v73, v0
  v_dot2c_f32_bf16 v119, v73, v1
  s_waitcnt lgkmcnt(13)
  v_dot2c_f32_bf16 v120, v74, v0
  v_dot2c_f32_bf16 v121, v74, v1
  s_waitcnt lgkmcnt(12)
  v_dot2c_f32_bf16 v122, v75, v0
  v_dot2c_f32_bf16 v123, v75, v1
  s_waitcnt lgkmcnt(11)
  v_dot2c_f32_bf16 v124, v76, v0
  v_dot2c_f32_bf16 v125, v76, v1
  s_waitcnt lgkmcnt(10)
  v_dot2c_f32_bf16 v126, v77, v0
  v_dot2c_f32_bf16 v127, v77, v1
  s_waitcnt lgkmcnt(9)
  v_dot2c_f32_bf16 v128, v78, v0
  v_dot2c_f32_bf16 v129, v78, v1
  v_cvt_pk_bf16_f32 v2, v107, v214
  v_cvt_pk_bf16_f32 v3, v214, v107
  s_waitcnt lgkmcnt(8)
  v_dot2c_f32_bf16 v112, v79, v2
  v_dot2c_f32_bf16 v113, v79, v3
  s_waitcnt lgkmcnt(7)
  v_dot2c_f32_bf16 v114, v80, v2
  v_dot2c_f32_bf16 v115, v80, v3
  s_waitcnt lgkmcnt(6)
  v_dot2c_f32_bf16 v116, v81, v2
  v_dot2c_f32_bf16 v117, v81, v3
  s_waitcnt lgkmcnt(5)
  v_dot2c_f32_bf16 v118, v82, v2
  v_dot2c_f32_bf16 v119, v82, v3
  s_waitcnt lgkmcnt(4)
  v_dot2c_f32_bf16 v120, v83, v2
  v_dot2c_f32_bf16 v121, v83, v3
  s_waitcnt lgkmcnt(3)
  v_dot2c_f32_bf16 v122, v84, v2
  v_dot2c_f32_bf16 v123, v84, v3
  s_waitcnt lgkmcnt(2)
  v_dot2c_f32_bf16 v124, v85, v2
  v_dot2c_f32_bf16 v125, v85, v3
  s_waitcnt lgkmcnt(1)
  v_dot2c_f32_bf16 v126, v86, v2
  v_dot2c_f32_bf16 v127, v86, v3
  s_waitcnt lgkmcnt(0)
  v_dot2c_f32_bf16 v128, v87, v2
  v_dot2c_f32_bf16 v129, v87, v3
  v_cvt_pk_bf16_f32 v132, v112, v113
  v_cvt_pk_bf16_f32 v133, v114, v115
  v_cvt_pk_bf16_f32 v134, v116, v117
  v_cvt_pk_bf16_f32 v135, v118, v119
  v_cvt_pk_bf16_f32 v136, v120, v121
  v_cvt_pk_bf16_f32 v137, v122, v123
  v_cvt_pk_bf16_f32 v138, v124, v125
  v_cvt_pk_bf16_f32 v139, v126, v127
  v_cvt_pk_bf16_f32 v140, v128, v129
  buffer_store_dwordx4 v[132:135], v220, s[8:11], s64 offen sc1
  buffer_store_dwordx4 v[136:139], v220, s[8:11], s64 offen offset:16 sc1
  buffer_store_dword v140, v220, s[8:11], s64 offen offset:32 sc1
  v_add_u32 v219, 33024, v219
  s_add_u32 s66, s66, 64
  s_add_u32 s64, s64, 73728
  ds_read_b32 v0, v219 offset:7224
  ds_read_b32 v1, v219 offset:7228
  ds_read_b32 v2, v219 offset:7232
  ds_read_b32 v3, v219 offset:7236
  ds_read_b32 v4, v219 offset:7240
  ds_read_b32 v5, v219 offset:7244
  ds_read_b32 v6, v219 offset:7248
  ds_read_b32 v7, v219 offset:7252
  ds_read_b32 v8, v219 offset:7256
  ds_read_b32 v16, v219 offset:7368
  ds_read_b32 v17, v219 offset:7372
  ds_read_b32 v18, v219 offset:7376
  ds_read_b32 v19, v219 offset:7380
  ds_read_b32 v20, v219 offset:7384
  ds_read_b32 v21, v219 offset:7388
  ds_read_b32 v22, v219 offset:7392
  ds_read_b32 v23, v219 offset:7396
  ds_read_b32 v24, v219 offset:7400
  ds_read_b32 v25, v219 offset:6336
  ds_read_b32 v26, v219 offset:6340
  ds_read_b32 v27, v219 offset:6344
  ds_read_b32 v28, v219 offset:6348
  ds_read_b32 v29, v219 offset:6352
  ds_read_b32 v30, v219 offset:6356
  ds_read_b32 v31, v219 offset:6360
  ds_read_b32 v32, v219 offset:6364
  ds_read_b32 v33, v219 offset:6368
  ds_read_b32 v34, v219 offset:5304
  ds_read_b32 v35, v219 offset:5308
  ds_read_b32 v36, v219 offset:5312
  ds_read_b32 v37, v219 offset:5316
  ds_read_b32 v38, v219 offset:5320
  ds_read_b32 v39, v219 offset:5324
  ds_read_b32 v40, v219 offset:5328
  ds_read_b32 v41, v219 offset:5332
  ds_read_b32 v42, v219 offset:5336
  ds_read_b32 v43, v219 offset:4272
  ds_read_b32 v44, v219 offset:4276
  ds_read_b32 v45, v219 offset:4280
  ds_read_b32 v46, v219 offset:4284
  ds_read_b32 v47, v219 offset:4288
  ds_read_b32 v48, v219 offset:4292
  ds_read_b32 v49, v219 offset:4296
  ds_read_b32 v50, v219 offset:4300
  ds_read_b32 v51, v219 offset:4304
  ds_read_b32 v52, v219 offset:3240
  ds_read_b32 v53, v219 offset:3244
  ds_read_b32 v54, v219 offset:3248
  ds_read_b32 v55, v219 offset:3252
  ds_read_b32 v56, v219 offset:3256
  ds_read_b32 v57, v219 offset:3260
  ds_read_b32 v58, v219 offset:3264
  ds_read_b32 v59, v219 offset:3268
  ds_read_b32 v60, v219 offset:3272
  ds_read_b32 v61, v219 offset:2208
  ds_read_b32 v62, v219 offset:2212
  ds_read_b32 v63, v219 offset:2216
  ds_read_b32 v64, v219 offset:2220
  ds_read_b32 v65, v219 offset:2224
  ds_read_b32 v66, v219 offset:2228
  ds_read_b32 v67, v219 offset:2232
  ds_read_b32 v68, v219 offset:2236
  ds_read_b32 v69, v219 offset:2240
  ds_read_b32 v70, v219 offset:1176
  ds_read_b32 v71, v219 offset:1180
  ds_read_b32 v72, v219 offset:1184
  ds_read_b32 v73, v219 offset:1188
  ds_read_b32 v74, v219 offset:1192
  ds_read_b32 v75, v219 offset:1196
  ds_read_b32 v76, v219 offset:1200
  ds_read_b32 v77, v219 offset:1204
  ds_read_b32 v78, v219 offset:1208
  ds_read_b32 v79, v219 offset:144
  ds_read_b32 v80, v219 offset:148
  ds_read_b32 v81, v219 offset:152
  ds_read_b32 v82, v219 offset:156
  ds_read_b32 v83, v219 offset:160
  ds_read_b32 v84, v219 offset:164
  ds_read_b32 v85, v219 offset:168
  ds_read_b32 v86, v219 offset:172
  ds_read_b32 v87, v219 offset:176
  v_mov_b32 v100, 0
  v_mov_b32 v101, 0
  v_mov_b32 v102, 0
  v_mov_b32 v103, 0
  v_mov_b32 v104, 0
  v_mov_b32 v105, 0
  v_mov_b32 v106, 0
  v_mov_b32 v107, 0
  s_waitcnt lgkmcnt(15)
  v_dot2c_f32_bf16 v100, v0, v16
  v_dot2c_f32_bf16 v101, v0, v25
  v_dot2c_f32_bf16 v102, v0, v34
  v_dot2c_f32_bf16 v103, v0, v43
  v_dot2c_f32_bf16 v104, v0, v52
  v_dot2c_f32_bf16 v105, v0, v61
  v_dot2c_f32_bf16 v106, v0, v70
  s_waitcnt lgkmcnt(8)
  v_dot2c_f32_bf16 v107, v0, v79
  v_dot2c_f32_bf16 v100, v1, v17
  v_dot2c_f32_bf16 v101, v1, v26
  v_dot2c_f32_bf16 v102, v1, v35
  v_dot2c_f32_bf16 v103, v1, v44
  v_dot2c_f32_bf16 v104, v1, v53
  v_dot2c_f32_bf16 v105, v1, v62
  v_dot2c_f32_bf16 v106, v1, v71
  s_waitcnt lgkmcnt(7)
  v_dot2c_f32_bf16 v107, v1, v80
  v_dot2c_f32_bf16 v100, v2, v18
  v_dot2c_f32_bf16 v101, v2, v27
  v_dot2c_f32_bf16 v102, v2, v36
  v_dot2c_f32_bf16 v103, v2, v45
  v_dot2c_f32_bf16 v104, v2, v54
  v_dot2c_f32_bf16 v105, v2, v63
  v_dot2c_f32_bf16 v106, v2, v72
  s_waitcnt lgkmcnt(6)
  v_dot2c_f32_bf16 v107, v2, v81
  v_dot2c_f32_bf16 v100, v3, v19
  v_dot2c_f32_bf16 v101, v3, v28
  v_dot2c_f32_bf16 v102, v3, v37
  v_dot2c_f32_bf16 v103, v3, v46
  v_dot2c_f32_bf16 v104, v3, v55
  v_dot2c_f32_bf16 v105, v3, v64
  v_dot2c_f32_bf16 v106, v3, v73
  s_waitcnt lgkmcnt(5)
  v_dot2c_f32_bf16 v107, v3, v82
  v_dot2c_f32_bf16 v100, v4, v20
  v_dot2c_f32_bf16 v101, v4, v29
  v_dot2c_f32_bf16 v102, v4, v38
  v_dot2c_f32_bf16 v103, v4, v47
  v_dot2c_f32_bf16 v104, v4, v56
  v_dot2c_f32_bf16 v105, v4, v65
  v_dot2c_f32_bf16 v106, v4, v74
  s_waitcnt lgkmcnt(4)
  v_dot2c_f32_bf16 v107, v4, v83
  v_dot2c_f32_bf16 v100, v5, v21
  v_dot2c_f32_bf16 v101, v5, v30
  v_dot2c_f32_bf16 v102, v5, v39
  v_dot2c_f32_bf16 v103, v5, v48
  v_dot2c_f32_bf16 v104, v5, v57
  v_dot2c_f32_bf16 v105, v5, v66
  v_dot2c_f32_bf16 v106, v5, v75
  s_waitcnt lgkmcnt(3)
  v_dot2c_f32_bf16 v107, v5, v84
  v_dot2c_f32_bf16 v100, v6, v22
  v_dot2c_f32_bf16 v101, v6, v31
  v_dot2c_f32_bf16 v102, v6, v40
  v_dot2c_f32_bf16 v103, v6, v49
  v_dot2c_f32_bf16 v104, v6, v58
  v_dot2c_f32_bf16 v105, v6, v67
  v_dot2c_f32_bf16 v106, v6, v76
  s_waitcnt lgkmcnt(2)
  v_dot2c_f32_bf16 v107, v6, v85
  v_dot2c_f32_bf16 v100, v7, v23
  v_dot2c_f32_bf16 v101, v7, v32
  v_dot2c_f32_bf16 v102, v7, v41
  v_dot2c_f32_bf16 v103, v7, v50
  v_dot2c_f32_bf16 v104, v7, v59
  v_dot2c_f32_bf16 v105, v7, v68
  v_dot2c_f32_bf16 v106, v7, v77
  s_waitcnt lgkmcnt(1)
  v_dot2c_f32_bf16 v107, v7, v86
  v_dot2c_f32_bf16 v100, v8, v24
  v_dot2c_f32_bf16 v101, v8, v33
  v_dot2c_f32_bf16 v102, v8, v42
  v_dot2c_f32_bf16 v103, v8, v51
  v_dot2c_f32_bf16 v104, v8, v60
  v_dot2c_f32_bf16 v105, v8, v69
  v_dot2c_f32_bf16 v106, v8, v78
  s_waitcnt lgkmcnt(0)
  v_dot2c_f32_bf16 v107, v8, v87
  ds_read_b32 v16, v219 offset:7512
  ds_read_b32 v17, v219 offset:7516
  ds_read_b32 v18, v219 offset:7520
  ds_read_b32 v19, v219 offset:7524
  ds_read_b32 v20, v219 offset:7528
  ds_read_b32 v21, v219 offset:7532
  ds_read_b32 v22, v219 offset:7536
  ds_read_b32 v23, v219 offset:7540
  ds_read_b32 v24, v219 offset:7544
  ds_read_b32 v25, v219 offset:6480
  ds_read_b32 v26, v219 offset:6484
  ds_read_b32 v27, v219 offset:6488
  ds_read_b32 v28, v219 offset:6492
  ds_read_b32 v29, v219 offset:6496
  ds_read_b32 v30, v219 offset:6500
  ds_read_b32 v31, v219 offset:6504
  ds_read_b32 v32, v219 offset:6508
  ds_read_b32 v33, v219 offset:6512
  ds_read_b32 v34, v219 offset:5448
  ds_read_b32 v35, v219 offset:5452
  ds_read_b32 v36, v219 offset:5456
  ds_read_b32 v37, v219 offset:5460
  ds_read_b32 v38, v219 offset:5464
  ds_read_b32 v39, v219 offset:5468
  ds_read_b32 v40, v219 offset:5472
  ds_read_b32 v41, v219 offset:5476
  ds_read_b32 v42, v219 offset:5480
  ds_read_b32 v43, v219 offset:4416
  ds_read_b32 v44, v219 offset:4420
  ds_read_b32 v45, v219 offset:4424
  ds_read_b32 v46, v219 offset:4428
  ds_read_b32 v47, v219 offset:4432
  ds_read_b32 v48, v219 offset:4436
  ds_read_b32 v49, v219 offset:4440
  ds_read_b32 v50, v219 offset:4444
  ds_read_b32 v51, v219 offset:4448
  ds_read_b32 v52, v219 offset:3384
  ds_read_b32 v53, v219 offset:3388
  ds_read_b32 v54, v219 offset:3392
  ds_read_b32 v55, v219 offset:3396
  ds_read_b32 v56, v219 offset:3400
  ds_read_b32 v57, v219 offset:3404
  ds_read_b32 v58, v219 offset:3408
  ds_read_b32 v59, v219 offset:3412
  ds_read_b32 v60, v219 offset:3416
  ds_read_b32 v61, v219 offset:2352
  ds_read_b32 v62, v219 offset:2356
  ds_read_b32 v63, v219 offset:2360
  ds_read_b32 v64, v219 offset:2364
  ds_read_b32 v65, v219 offset:2368
  ds_read_b32 v66, v219 offset:2372
  ds_read_b32 v67, v219 offset:2376
  ds_read_b32 v68, v219 offset:2380
  ds_read_b32 v69, v219 offset:2384
  ds_read_b32 v70, v219 offset:1320
  ds_read_b32 v71, v219 offset:1324
  ds_read_b32 v72, v219 offset:1328
  ds_read_b32 v73, v219 offset:1332
  ds_read_b32 v74, v219 offset:1336
  ds_read_b32 v75, v219 offset:1340
  ds_read_b32 v76, v219 offset:1344
  ds_read_b32 v77, v219 offset:1348
  ds_read_b32 v78, v219 offset:1352
  ds_read_b32 v79, v219 offset:288
  ds_read_b32 v80, v219 offset:292
  ds_read_b32 v81, v219 offset:296
  ds_read_b32 v82, v219 offset:300
  ds_read_b32 v83, v219 offset:304
  ds_read_b32 v84, v219 offset:308
  ds_read_b32 v85, v219 offset:312
  ds_read_b32 v86, v219 offset:316
  ds_read_b32 v87, v219 offset:320
  v_add_u32 v211, s66, v200
  v_mov_b32 v212, 0xf149f2ca
  v_mul_f32 v100, s57, v100
  v_mul_f32 v101, s57, v101
  v_mul_f32 v102, s57, v102
  v_mul_f32 v103, s57, v103
  v_mul_f32 v104, s57, v104
  v_mul_f32 v105, s57, v105
  v_mul_f32 v106, s57, v106
  v_mul_f32 v107, s57, v107
  v_cmp_gt_u32 vcc, 2, v211
  s_nop 1
  v_cndmask_b32 v101, v101, v212, vcc
  v_cmp_gt_u32 vcc, 4, v211
  s_nop 1
  v_cndmask_b32 v102, v102, v212, vcc
  v_cmp_gt_u32 vcc, 6, v211
  s_nop 1
  v_cndmask_b32 v103, v103, v212, vcc
  v_cmp_gt_u32 vcc, 8, v211
  s_nop 1
  v_cndmask_b32 v104, v104, v212, vcc
  v_cmp_gt_u32 vcc, 10, v211
  s_nop 1
  v_cndmask_b32 v105, v105, v212, vcc
  v_cmp_gt_u32 vcc, 12, v211
  s_nop 1
  v_cndmask_b32 v106, v106, v212, vcc
  v_cmp_gt_u32 vcc, 14, v211
  s_nop 1
  v_cndmask_b32 v107, v107, v212, vcc
  v_max3_f32 v213, v100, v101, v102
  v_max3_f32 v213, v213, v103, v104
  v_max3_f32 v213, v213, v105, v106
  v_max_f32 v213, v213, v107
  v_sub_f32 v100, v100, v213
  v_sub_f32 v101, v101, v213
  v_sub_f32 v102, v102, v213
  v_sub_f32 v103, v103, v213
  v_sub_f32 v104, v104, v213
  v_sub_f32 v105, v105, v213
  v_sub_f32 v106, v106, v213
  v_sub_f32 v107, v107, v213
  v_exp_f32 v100, v100
  v_exp_f32 v101, v101
  v_exp_f32 v102, v102
  v_exp_f32 v103, v103
  v_exp_f32 v104, v104
  v_exp_f32 v105, v105
  v_exp_f32 v106, v106
  v_exp_f32 v107, v107
  v_add_f32 v213, v100, v101
  v_add_f32 v213, v213, v102
  v_add_f32 v213, v213, v103
  v_add_f32 v213, v213, v104
  v_add_f32 v213, v213, v105
  v_add_f32 v213, v213, v106
  v_add_f32 v213, v213, v107
  v_rcp_f32 v213, v213
  v_mov_b32 v214, 0
  v_mul_f32 v100, v213, v100
  v_mul_f32 v101, v213, v101
  v_mul_f32 v102, v213, v102
  v_mul_f32 v103, v213, v103
  v_mul_f32 v104, v213, v104
  v_mul_f32 v105, v213, v105
  v_mul_f32 v106, v213, v106
  v_mul_f32 v107, v213, v107
  v_mov_b32 v112, 0
  v_mov_b32 v113, 0
  v_mov_b32 v114, 0
  v_mov_b32 v115, 0
  v_mov_b32 v116, 0
  v_mov_b32 v117, 0
  v_mov_b32 v118, 0
  v_mov_b32 v119, 0
  v_mov_b32 v120, 0
  v_mov_b32 v121, 0
  v_mov_b32 v122, 0
  v_mov_b32 v123, 0
  v_mov_b32 v124, 0
  v_mov_b32 v125, 0
  v_mov_b32 v126, 0
  v_mov_b32 v127, 0
  v_mov_b32 v128, 0
  v_mov_b32 v129, 0
  v_cvt_pk_bf16_f32 v0, v100, v214
  v_cvt_pk_bf16_f32 v1, v214, v100
  s_waitcnt lgkmcnt(15)
  v_dot2c_f32_bf16 v112, v16, v0
  v_dot2c_f32_bf16 v113, v16, v1
  v_dot2c_f32_bf16 v114, v17, v0
  v_dot2c_f32_bf16 v115, v17, v1
  v_dot2c_f32_bf16 v116, v18, v0
  v_dot2c_f32_bf16 v117, v18, v1
  v_dot2c_f32_bf16 v118, v19, v0
  v_dot2c_f32_bf16 v119, v19, v1
  v_dot2c_f32_bf16 v120, v20, v0
  v_dot2c_f32_bf16 v121, v20, v1
  v_dot2c_f32_bf16 v122, v21, v0
  v_dot2c_f32_bf16 v123, v21, v1
  v_dot2c_f32_bf16 v124, v22, v0
  v_dot2c_f32_bf16 v125, v22, v1
  v_dot2c_f32_bf16 v126, v23, v0
  v_dot2c_f32_bf16 v127, v23, v1
  v_dot2c_f32_bf16 v128, v24, v0
  v_dot2c_f32_bf16 v129, v24, v1
  v_cvt_pk_bf16_f32 v2, v101, v214
  v_cvt_pk_bf16_f32 v3, v214, v101
  v_dot2c_f32_bf16 v112, v25, v2
  v_dot2c_f32_bf16 v113, v25, v3
  v_dot2c_f32_bf16 v114, v26, v2
  v_dot2c_f32_bf16 v115, v26, v3
  v_dot2c_f32_bf16 v116, v27, v2
  v_dot2c_f32_bf16 v117, v27, v3
  v_dot2c_f32_bf16 v118, v28, v2
  v_dot2c_f32_bf16 v119, v28, v3
  v_dot2c_f32_bf16 v120, v29, v2
  v_dot2c_f32_bf16 v121, v29, v3
  v_dot2c_f32_bf16 v122, v30, v2
  v_dot2c_f32_bf16 v123, v30, v3
  v_dot2c_f32_bf16 v124, v31, v2
  v_dot2c_f32_bf16 v125, v31, v3
  v_dot2c_f32_bf16 v126, v32, v2
  v_dot2c_f32_bf16 v127, v32, v3
  v_dot2c_f32_bf16 v128, v33, v2
  v_dot2c_f32_bf16 v129, v33, v3
  v_cvt_pk_bf16_f32 v0, v102, v214
  v_cvt_pk_bf16_f32 v1, v214, v102
  v_dot2c_f32_bf16 v112, v34, v0
  v_dot2c_f32_bf16 v113, v34, v1
  v_dot2c_f32_bf16 v114, v35, v0
  v_dot2c_f32_bf16 v115, v35, v1
  v_dot2c_f32_bf16 v116, v36, v0
  v_dot2c_f32_bf16 v117, v36, v1
  v_dot2c_f32_bf16 v118, v37, v0
  v_dot2c_f32_bf16 v119, v37, v1
  v_dot2c_f32_bf16 v120, v38, v0
  v_dot2c_f32_bf16 v121, v38, v1
  v_dot2c_f32_bf16 v122, v39, v0
  v_dot2c_f32_bf16 v123, v39, v1
  v_dot2c_f32_bf16 v124, v40, v0
  v_dot2c_f32_bf16 v125, v40, v1
  v_dot2c_f32_bf16 v126, v41, v0
  v_dot2c_f32_bf16 v127, v41, v1
  v_dot2c_f32_bf16 v128, v42, v0
  v_dot2c_f32_bf16 v129, v42, v1
  v_cvt_pk_bf16_f32 v2, v103, v214
  v_cvt_pk_bf16_f32 v3, v214, v103
  v_dot2c_f32_bf16 v112, v43, v2
  v_dot2c_f32_bf16 v113, v43, v3
  v_dot2c_f32_bf16 v114, v44, v2
  v_dot2c_f32_bf16 v115, v44, v3
  v_dot2c_f32_bf16 v116, v45, v2
  v_dot2c_f32_bf16 v117, v45, v3
  v_dot2c_f32_bf16 v118, v46, v2
  v_dot2c_f32_bf16 v119, v46, v3
  v_dot2c_f32_bf16 v120, v47, v2
  v_dot2c_f32_bf16 v121, v47, v3
  v_dot2c_f32_bf16 v122, v48, v2
  v_dot2c_f32_bf16 v123, v48, v3
  v_dot2c_f32_bf16 v124, v49, v2
  v_dot2c_f32_bf16 v125, v49, v3
  v_dot2c_f32_bf16 v126, v50, v2
  v_dot2c_f32_bf16 v127, v50, v3
  v_dot2c_f32_bf16 v128, v51, v2
  v_dot2c_f32_bf16 v129, v51, v3
  v_cvt_pk_bf16_f32 v0, v104, v214
  v_cvt_pk_bf16_f32 v1, v214, v104
  v_dot2c_f32_bf16 v112, v52, v0
  v_dot2c_f32_bf16 v113, v52, v1
  v_dot2c_f32_bf16 v114, v53, v0
  v_dot2c_f32_bf16 v115, v53, v1
  v_dot2c_f32_bf16 v116, v54, v0
  v_dot2c_f32_bf16 v117, v54, v1
  v_dot2c_f32_bf16 v118, v55, v0
  v_dot2c_f32_bf16 v119, v55, v1
  v_dot2c_f32_bf16 v120, v56, v0
  v_dot2c_f32_bf16 v121, v56, v1
  v_dot2c_f32_bf16 v122, v57, v0
  v_dot2c_f32_bf16 v123, v57, v1
  v_dot2c_f32_bf16 v124, v58, v0
  v_dot2c_f32_bf16 v125, v58, v1
  v_dot2c_f32_bf16 v126, v59, v0
  v_dot2c_f32_bf16 v127, v59, v1
  v_dot2c_f32_bf16 v128, v60, v0
  v_dot2c_f32_bf16 v129, v60, v1
  v_cvt_pk_bf16_f32 v2, v105, v214
  v_cvt_pk_bf16_f32 v3, v214, v105
  v_dot2c_f32_bf16 v112, v61, v2
  v_dot2c_f32_bf16 v113, v61, v3
  v_dot2c_f32_bf16 v114, v62, v2
  v_dot2c_f32_bf16 v115, v62, v3
  v_dot2c_f32_bf16 v116, v63, v2
  v_dot2c_f32_bf16 v117, v63, v3
  v_dot2c_f32_bf16 v118, v64, v2
  v_dot2c_f32_bf16 v119, v64, v3
  v_dot2c_f32_bf16 v120, v65, v2
  v_dot2c_f32_bf16 v121, v65, v3
  v_dot2c_f32_bf16 v122, v66, v2
  v_dot2c_f32_bf16 v123, v66, v3
  v_dot2c_f32_bf16 v124, v67, v2
  v_dot2c_f32_bf16 v125, v67, v3
  v_dot2c_f32_bf16 v126, v68, v2
  v_dot2c_f32_bf16 v127, v68, v3
  v_dot2c_f32_bf16 v128, v69, v2
  v_dot2c_f32_bf16 v129, v69, v3
  v_cvt_pk_bf16_f32 v0, v106, v214
  v_cvt_pk_bf16_f32 v1, v214, v106
  v_dot2c_f32_bf16 v112, v70, v0
  v_dot2c_f32_bf16 v113, v70, v1
  v_dot2c_f32_bf16 v114, v71, v0
  v_dot2c_f32_bf16 v115, v71, v1
  v_dot2c_f32_bf16 v116, v72, v0
  v_dot2c_f32_bf16 v117, v72, v1
  s_waitcnt lgkmcnt(14)
  v_dot2c_f32_bf16 v118, v73, v0
  v_dot2c_f32_bf16 v119, v73, v1
  s_waitcnt lgkmcnt(13)
  v_dot2c_f32_bf16 v120, v74, v0
  v_dot2c_f32_bf16 v121, v74, v1
  s_waitcnt lgkmcnt(12)
  v_dot2c_f32_bf16 v122, v75, v0
  v_dot2c_f32_bf16 v123, v75, v1
  s_waitcnt lgkmcnt(11)
  v_dot2c_f32_bf16 v124, v76, v0
  v_dot2c_f32_bf16 v125, v76, v1
  s_waitcnt lgkmcnt(10)
  v_dot2c_f32_bf16 v126, v77, v0
  v_dot2c_f32_bf16 v127, v77, v1
  s_waitcnt lgkmcnt(9)
  v_dot2c_f32_bf16 v128, v78, v0
  v_dot2c_f32_bf16 v129, v78, v1
  v_cvt_pk_bf16_f32 v2, v107, v214
  v_cvt_pk_bf16_f32 v3, v214, v107
  s_waitcnt lgkmcnt(8)
  v_dot2c_f32_bf16 v112, v79, v2
  v_dot2c_f32_bf16 v113, v79, v3
  s_waitcnt lgkmcnt(7)
  v_dot2c_f32_bf16 v114, v80, v2
  v_dot2c_f32_bf16 v115, v80, v3
  s_waitcnt lgkmcnt(6)
  v_dot2c_f32_bf16 v116, v81, v2
  v_dot2c_f32_bf16 v117, v81, v3
  s_waitcnt lgkmcnt(5)
  v_dot2c_f32_bf16 v118, v82, v2
  v_dot2c_f32_bf16 v119, v82, v3
  s_waitcnt lgkmcnt(4)
  v_dot2c_f32_bf16 v120, v83, v2
  v_dot2c_f32_bf16 v121, v83, v3
  s_waitcnt lgkmcnt(3)
  v_dot2c_f32_bf16 v122, v84, v2
  v_dot2c_f32_bf16 v123, v84, v3
  s_waitcnt lgkmcnt(2)
  v_dot2c_f32_bf16 v124, v85, v2
  v_dot2c_f32_bf16 v125, v85, v3
  s_waitcnt lgkmcnt(1)
  v_dot2c_f32_bf16 v126, v86, v2
  v_dot2c_f32_bf16 v127, v86, v3
  s_waitcnt lgkmcnt(0)
  v_dot2c_f32_bf16 v128, v87, v2
  v_dot2c_f32_bf16 v129, v87, v3
  v_cvt_pk_bf16_f32 v132, v112, v113
  v_cvt_pk_bf16_f32 v133, v114, v115
  v_cvt_pk_bf16_f32 v134, v116, v117
  v_cvt_pk_bf16_f32 v135, v118, v119
  v_cvt_pk_bf16_f32 v136, v120, v121
  v_cvt_pk_bf16_f32 v137, v122, v123
  v_cvt_pk_bf16_f32 v138, v124, v125
  v_cvt_pk_bf16_f32 v139, v126, v127
  v_cvt_pk_bf16_f32 v140, v128, v129
  buffer_store_dwordx4 v[132:135], v220, s[8:11], s64 offen sc1
  buffer_store_dwordx4 v[136:139], v220, s[8:11], s64 offen offset:16 sc1
  buffer_store_dword v140, v220, s[8:11], s64 offen offset:32 sc1
  s_mov_b32 s56, 36
  s_waitcnt vmcnt(0)
  s_barrier
  s_cmp_eq_u32 s52, 0
  s_cbranch_scc0 A_sig
  v_mov_b32 v211, 1
  v_mov_b32 v212, 0
  s_mov_b64 exec, 1
  buffer_atomic_add v211, v212, s[12:15], s56 offen
  s_mov_b64 exec, -1
A_sig:
  s_and_b32 s54, s53, 31
  s_cmp_lt_u32 s54, 27
  s_cbranch_scc0 L_exit
  s_and_b32 s54, s53, 31
  s_mul_i32 s68, s54, 57
  s_lshr_b32 s68, s68, 9
  s_mul_i32 s56, s68, 9
  s_sub_u32 s70, s54, s56
  s_bfe_u32 s55, s53, 0x10005
  s_mul_i32 s55, s55, 9
  s_add_u32 s70, s70, s55
  s_bfe_u32 s69, s53, 0x10006
  v_lshrrev_b32 v211, 2, v200
  v_mul_u32_u24 v211, 1152, v211
  v_and_b32 v212, 3, v200
  v_lshl_add_u32 v207, v212, 4, v211
  s_lshl_b32 s54, s70, 6
  s_mul_i32 s55, s52, 1179648
  s_add_u32 s62, s54, s55
  s_mul_i32 s55, s52, 184320
  s_add_u32 s63, s54, s55
  s_mul_i32 s61, s52, 40960
  v_bfe_u32 v211, v200, 2, 2
  v_lshlrev_b32 v212, 4, v212
  v_add_u32 v212, s61, v212
  v_lshl_add_u32 v212, v211, 6, v212
  v_lshrrev_b32 v213, 4, v200
  v_lshl_add_u32 v210, v213, 9, v212
  v_lshrrev_b32 v214, 5, v200
  v_lshl_add_u32 v209, v214, 10, v212
  v_and_b32 v214, 1, v213
  v_lshl_add_u32 v209, v214, 8, v209
  s_add_u32 m0, s61, 0
  s_add_u32 s54, s62, 0
  buffer_load_dwordx4 v207, s[28:31], s54 offen lds
  s_add_u32 m0, s61, 1024
  s_add_u32 s54, s62, 18432
  buffer_load_dwordx4 v207, s[28:31], s54 offen lds
  s_add_u32 m0, s61, 2048
  s_add_u32 s54, s62, 36864
  buffer_load_dwordx4 v207, s[28:31], s54 offen lds
  s_add_u32 m0, s61, 3072
  s_add_u32 s54, s62, 55296
  buffer_load_dwordx4 v207, s[28:31], s54 offen lds
  s_add_u32 m0, s61, 4096
  s_add_u32 s54, s62, 73728
  buffer_load_dwordx4 v207, s[28:31], s54 offen lds
  s_add_u32 m0, s61, 5120
  s_add_u32 s54, s62, 92160
  buffer_load_dwordx4 v207, s[28:31], s54 offen lds
  s_add_u32 m0, s61, 6144
  s_add_u32 s54, s62, 110592
  buffer_load_dwordx4 v207, s[28:31], s54 offen lds
  s_add_u32 m0, s61, 7168
  s_add_u32 s54, s62, 129024
  buffer_load_dwordx4 v207, s[28:31], s54 offen lds
  s_add_u32 m0, s61, 8192
  s_add_u32 s54, s62, 147456
  buffer_load_dwordx4 v207, s[28:31], s54 offen lds
  s_add_u32 m0, s61, 9216
  s_add_u32 s54, s62, 165888
  buffer_load_dwordx4 v207, s[28:31], s54 offen lds
  s_add_u32 m0, s61, 10240
  s_add_u32 s54, s62, 184320
  buffer_load_dwordx4 v207, s[28:31], s54 offen lds
  s_add_u32 m0, s61, 11264
  s_add_u32 s54, s62, 202752
  buffer_load_dwordx4 v207, s[28:31], s54 offen lds
  s_add_u32 m0, s61, 12288
  s_add_u32 s54, s62, 221184
  buffer_load_dwordx4 v207, s[28:31], s54 offen lds
  s_add_u32 m0, s61, 13312
  s_add_u32 s54, s62, 239616
  buffer_load_dwordx4 v207, s[28:31], s54 offen lds
  s_add_u32 m0, s61, 14336
  s_add_u32 s54, s62, 258048
  buffer_load_dwordx4 v207, s[28:31], s54 offen lds
  s_add_u32 m0, s61, 15360
  s_add_u32 s54, s62, 276480
  buffer_load_dwordx4 v207, s[28:31], s54 offen lds
  s_add_u32 m0, s61, 16384
  s_add_u32 s54, s62, 294912
  buffer_load_dwordx4 v207, s[28:31], s54 offen lds
  s_add_u32 m0, s61, 17408
  s_add_u32 s54, s62, 313344
  buffer_load_dwordx4 v207, s[28:31], s54 offen lds
  s_add_u32 m0, s61, 18432
  s_add_u32 s54, s62, 331776
  buffer_load_dwordx4 v207, s[28:31], s54 offen lds
  s_add_u32 m0, s61, 19456
  s_add_u32 s54, s62, 350208
  buffer_load_dwordx4 v207, s[28:31], s54 offen lds
  s_add_u32 m0, s61, 20480
  s_add_u32 s54, s62, 368640
  buffer_load_dwordx4 v207, s[28:31], s54 offen lds
  s_add_u32 m0, s61, 21504
  s_add_u32 s54, s62, 387072
  buffer_load_dwordx4 v207, s[28:31], s54 offen lds
  s_add_u32 m0, s61, 22528
  s_add_u32 s54, s62, 405504
  buffer_load_dwordx4 v207, s[28:31], s54 offen lds
  s_add_u32 m0, s61, 23552
  s_add_u32 s54, s62, 423936
  buffer_load_dwordx4 v207, s[28:31], s54 offen lds
  s_add_u32 m0, s61, 24576
  s_add_u32 s54, s62, 442368
  buffer_load_dwordx4 v207, s[28:31], s54 offen lds
  s_add_u32 m0, s61, 25600
  s_add_u32 s54, s62, 460800
  buffer_load_dwordx4 v207, s[28:31], s54 offen lds
  s_add_u32 m0, s61, 26624
  s_add_u32 s54, s62, 479232
  buffer_load_dwordx4 v207, s[28:31], s54 offen lds
  s_add_u32 m0, s61, 27648
  s_add_u32 s54, s62, 497664
  buffer_load_dwordx4 v207, s[28:31], s54 offen lds
  s_add_u32 m0, s61, 28672
  s_add_u32 s54, s62, 516096
  buffer_load_dwordx4 v207, s[28:31], s54 offen lds
  s_add_u32 m0, s61, 29696
  s_add_u32 s54, s62, 534528
  buffer_load_dwordx4 v207, s[28:31], s54 offen lds
  s_add_u32 m0, s61, 30720
  s_add_u32 s54, s62, 552960
  buffer_load_dwordx4 v207, s[28:31], s54 offen lds
  s_add_u32 m0, s61, 31744
  s_add_u32 s54, s62, 571392
  buffer_load_dwordx4 v207, s[28:31], s54 offen lds
  s_add_u32 m0, s61, 32768
  s_add_u32 s54, s62, 589824
  buffer_load_dwordx4 v207, s[28:31], s54 offen lds
  s_add_u32 m0, s61, 33792
  s_add_u32 s54, s62, 608256
  buffer_load_dwordx4 v207, s[28:31], s54 offen lds
  s_add_u32 m0, s61, 34816
  s_add_u32 s54, s62, 626688
  buffer_load_dwordx4 v207, s[28:31], s54 offen lds
  s_add_u32 m0, s61, 35840
  s_add_u32 s54, s62, 645120
  buffer_load_dwordx4 v207, s[28:31], s54 offen lds
  s_add_u32 m0, s61, 36864
  s_add_u32 s54, s62, 663552
  buffer_load_dwordx4 v207, s[28:31], s54 offen lds
  s_add_u32 m0, s61, 37888
  s_add_u32 s54, s62, 681984
  buffer_load_dwordx4 v207, s[28:31], s54 offen lds
  s_waitcnt vmcnt(36) lgkmcnt(0)
  s_add_u32 m0, s61, 38912
  s_add_u32 s54, s62, 700416
  buffer_load_dwordx4 v207, s[28:31], s54 offen lds
  s_add_u32 m0, s61, 39936
  s_add_u32 s54, s62, 718848
  buffer_load_dwordx4 v207, s[28:31], s54 offen lds
  ds_read_b64_tr_b16 a[0:1], v209 offset:0
  ds_read_b64_tr_b16 a[2:3], v209 offset:512
  ds_read_b64_tr_b16 a[4:5], v209 offset:8
  ds_read_b64_tr_b16 a[6:7], v209 offset:520
  s_waitcnt vmcnt(36) lgkmcnt(0)
  s_add_u32 m0, s61, 0
  s_add_u32 s54, s62, 737280
  buffer_load_dwordx4 v207, s[28:31], s54 offen lds
  s_add_u32 m0, s61, 1024
  s_add_u32 s54, s62, 755712
  buffer_load_dwordx4 v207, s[28:31], s54 offen lds
  ds_read_b64_tr_b16 a[8:9], v209 offset:2048
  ds_read_b64_tr_b16 a[10:11], v209 offset:2560
  ds_read_b64_tr_b16 a[12:13], v209 offset:2056
  ds_read_b64_tr_b16 a[14:15], v209 offset:2568
  s_waitcnt vmcnt(36) lgkmcnt(0)
  s_add_u32 m0, s61, 2048
  s_add_u32 s54, s62, 774144
  buffer_load_dwordx4 v207, s[28:31], s54 offen lds
  s_add_u32 m0, s61, 3072
  s_add_u32 s54, s62, 792576
  buffer_load_dwordx4 v207, s[28:31], s54 offen lds
  ds_read_b64_tr_b16 a[16:17], v209 offset:4096
  ds_read_b64_tr_b16 a[18:19], v209 offset:4608
  ds_read_b64_tr_b16 a[20:21], v209 offset:4104
  ds_read_b64_tr_b16 a[22:23], v209 offset:4616
  s_waitcnt vmcnt(36) lgkmcnt(0)
  s_add_u32 m0, s61, 4096
  s_add_u32 s54, s62, 811008
  buffer_load_dwordx4 v207, s[28:31], s54 offen lds
  s_add_u32 m0, s61, 5120
  s_add_u32 s54, s62, 829440
  buffer_load_dwordx4 v207, s[28:31], s54 offen lds
  ds_read_b64_tr_b16 a[24:25], v209 offset:6144
  ds_read_b64_tr_b16 a[26:27], v209 offset:6656
  ds_read_b64_tr_b16 a[28:29], v209 offset:6152
  ds_read_b64_tr_b16 a[30:31], v209 offset:6664
  s_waitcnt vmcnt(36) lgkmcnt(0)
  s_add_u32 m0, s61, 6144
  s_add_u32 s54, s62, 847872
  buffer_load_dwordx4 v207, s[28:31], s54 offen lds
  s_add_u32 m0, s61, 7168
  s_add_u32 s54, s62, 866304
  buffer_load_dwordx4 v207, s[28:31], s54 offen lds
  ds_read_b64_tr_b16 a[32:33], v209 offset:8192
  ds_read_b64_tr_b16 a[34:35], v209 offset:8704
  ds_read_b64_tr_b16 a[36:37], v209 offset:8200
  ds_read_b64_tr_b16 a[38:39], v209 offset:8712
  s_waitcnt vmcnt(36) lgkmcnt(0)
  s_add_u32 m0, s61, 8192
  s_add_u32 s54, s62, 884736
  buffer_load_dwordx4 v207, s[28:31], s54 offen lds
  s_add_u32 m0, s61, 9216
  s_add_u32 s54, s62, 903168
  buffer_load_dwordx4 v207, s[28:31], s54 offen lds
  ds_read_b64_tr_b16 a[40:41], v209 offset:10240
  ds_read_b64_tr_b16 a[42:43], v209 offset:10752
  ds_read_b64_tr_b16 a[44:45], v209 offset:10248
  ds_read_b64_tr_b16 a[46:47], v209 offset:10760
  s_waitcnt vmcnt(36) lgkmcnt(0)
  s_add_u32 m0, s61, 10240
  s_add_u32 s54, s62, 921600
  buffer_load_dwordx4 v207, s[28:31], s54 offen lds
  s_add_u32 m0, s61, 11264
  s_add_u32 s54, s62, 940032
  buffer_load_dwordx4 v207, s[28:31], s54 offen lds
  ds_read_b64_tr_b16 a[48:49], v209 offset:12288
  ds_read_b64_tr_b16 a[50:51], v209 offset:12800
  ds_read_b64_tr_b16 a[52:53], v209 offset:12296
  ds_read_b64_tr_b16 a[54:55], v209 offset:12808
  s_waitcnt vmcnt(36) lgkmcnt(0)
  s_add_u32 m0, s61, 12288
  s_add_u32 s54, s62, 958464
  buffer_load_dwordx4 v207, s[28:31], s54 offen lds
  s_add_u32 m0, s61, 13312
  s_add_u32 s54, s62, 976896
  buffer_load_dwordx4 v207, s[28:31], s54 offen lds
  ds_read_b64_tr_b16 a[56:57], v209 offset:14336
  ds_read_b64_tr_b16 a[58:59], v209 offset:14848
  ds_read_b64_tr_b16 a[60:61], v209 offset:14344
  ds_read_b64_tr_b16 a[62:63], v209 offset:14856
  s_waitcnt vmcnt(36) lgkmcnt(0)
  s_add_u32 m0, s61, 14336
  s_add_u32 s54, s62, 995328
  buffer_load_dwordx4 v207, s[28:31], s54 offen lds
  s_add_u32 m0, s61, 15360
  s_add_u32 s54, s62, 1013760
  buffer_load_dwordx4 v207, s[28:31], s54 offen lds
  ds_read_b64_tr_b16 a[64:65], v209 offset:16384
  ds_read_b64_tr_b16 a[66:67], v209 offset:16896
  ds_read_b64_tr_b16 a[68:69], v209 offset:16392
  ds_read_b64_tr_b16 a[70:71], v209 offset:16904
  s_waitcnt vmcnt(36) lgkmcnt(0)
  s_add_u32 m0, s61, 16384
  s_add_u32 s54, s62, 1032192
  buffer_load_dwordx4 v207, s[28:31], s54 offen lds
  s_add_u32 m0, s61, 17408
  s_add_u32 s54, s62, 1050624
  buffer_load_dwordx4 v207, s[28:31], s54 offen lds
  ds_read_b64_tr_b16 a[72:73], v209 offset:18432
  ds_read_b64_tr_b16 a[74:75], v209 offset:18944
  ds_read_b64_tr_b16 a[76:77], v209 offset:18440
  ds_read_b64_tr_b16 a[78:79], v209 offset:18952
  s_waitcnt vmcnt(36) lgkmcnt(0)
  s_add_u32 m0, s61, 18432
  s_add_u32 s54, s62, 1069056
  buffer_load_dwordx4 v207, s[28:31], s54 offen lds
  s_add_u32 m0, s61, 19456
  s_add_u32 s54, s62, 1087488
  buffer_load_dwordx4 v207, s[28:31], s54 offen lds
  ds_read_b64_tr_b16 a[80:81], v209 offset:20480
  ds_read_b64_tr_b16 a[82:83], v209 offset:20992
  ds_read_b64_tr_b16 a[84:85], v209 offset:20488
  ds_read_b64_tr_b16 a[86:87], v209 offset:21000
  s_waitcnt vmcnt(36) lgkmcnt(0)
  s_add_u32 m0, s61, 20480
  s_add_u32 s54, s62, 1105920
  buffer_load_dwordx4 v207, s[28:31], s54 offen lds
  s_add_u32 m0, s61, 21504
  s_add_u32 s54, s62, 1124352
  buffer_load_dwordx4 v207, s[28:31], s54 offen lds
  ds_read_b64_tr_b16 a[88:89], v209 offset:22528
  ds_read_b64_tr_b16 a[90:91], v209 offset:23040
  ds_read_b64_tr_b16 a[92:93], v209 offset:22536
  ds_read_b64_tr_b16 a[94:95], v209 offset:23048
  s_waitcnt vmcnt(36) lgkmcnt(0)
  s_add_u32 m0, s61, 22528
  s_add_u32 s54, s62, 1142784
  buffer_load_dwordx4 v207, s[28:31], s54 offen lds
  s_add_u32 m0, s61, 23552
  s_add_u32 s54, s62, 1161216
  buffer_load_dwordx4 v207, s[28:31], s54 offen lds
  ds_read_b64_tr_b16 a[96:97], v209 offset:24576
  ds_read_b64_tr_b16 a[98:99], v209 offset:25088
  ds_read_b64_tr_b16 a[100:101], v209 offset:24584
  ds_read_b64_tr_b16 a[102:103], v209 offset:25096
  s_waitcnt vmcnt(36) lgkmcnt(0)
  s_add_u32 m0, s61, 24576
  s_add_u32 s54, s63, 0
  buffer_load_dwordx4 v207, s[40:43], s54 offen lds
  s_add_u32 m0, s61, 25600
  s_add_u32 s54, s63, 18432
  buffer_load_dwordx4 v207, s[40:43], s54 offen lds
  ds_read_b64_tr_b16 a[104:105], v209 offset:26624
  ds_read_b64_tr_b16 a[106:107], v209 offset:27136
  ds_read_b64_tr_b16 a[108:109], v209 offset:26632
  ds_read_b64_tr_b16 a[110:111], v209 offset:27144
  s_waitcnt vmcnt(36) lgkmcnt(0)
  s_add_u32 m0, s61, 26624
  s_add_u32 s54, s63, 36864
  buffer_load_dwordx4 v207, s[40:43], s54 offen lds
  s_add_u32 m0, s61, 27648
  s_add_u32 s54, s63, 55296
  buffer_load_dwordx4 v207, s[40:43], s54 offen lds
  ds_read_b64_tr_b16 a[112:113], v209 offset:28672
  ds_read_b64_tr_b16 a[114:115], v209 offset:29184
  ds_read_b64_tr_b16 a[116:117], v209 offset:28680
  ds_read_b64_tr_b16 a[118:119], v209 offset:29192
  s_waitcnt vmcnt(36) lgkmcnt(0)
  s_add_u32 m0, s61, 28672
  s_add_u32 s54, s63, 73728
  buffer_load_dwordx4 v207, s[40:43], s54 offen lds
  s_add_u32 m0, s61, 29696
  s_add_u32 s54, s63, 92160
  buffer_load_dwordx4 v207, s[40:43], s54 offen lds
  ds_read_b64_tr_b16 a[120:121], v209 offset:30720
  ds_read_b64_tr_b16 a[122:123], v209 offset:31232
  ds_read_b64_tr_b16 a[124:125], v209 offset:30728
  ds_read_b64_tr_b16 a[126:127], v209 offset:31240
  s_waitcnt vmcnt(36) lgkmcnt(0)
  s_add_u32 m0, s61, 30720
  s_add_u32 s54, s63, 110592
  buffer_load_dwordx4 v207, s[40:43], s54 offen lds
  s_add_u32 m0, s61, 31744
  s_add_u32 s54, s63, 129024
  buffer_load_dwordx4 v207, s[40:43], s54 offen lds
  ds_read_b64_tr_b16 a[128:129], v209 offset:32768
  ds_read_b64_tr_b16 a[130:131], v209 offset:33280
  ds_read_b64_tr_b16 a[132:133], v209 offset:32776
  ds_read_b64_tr_b16 a[134:135], v209 offset:33288
  s_waitcnt vmcnt(36) lgkmcnt(0)
  s_add_u32 m0, s61, 32768
  s_add_u32 s54, s63, 147456
  buffer_load_dwordx4 v207, s[40:43], s54 offen lds
  s_add_u32 m0, s61, 33792
  s_add_u32 s54, s63, 165888
  buffer_load_dwordx4 v207, s[40:43], s54 offen lds
  ds_read_b64_tr_b16 a[136:137], v209 offset:34816
  ds_read_b64_tr_b16 a[138:139], v209 offset:35328
  ds_read_b64_tr_b16 a[140:141], v209 offset:34824
  ds_read_b64_tr_b16 a[142:143], v209 offset:35336
  s_waitcnt vmcnt(36) lgkmcnt(0)
  ds_read_b64_tr_b16 a[144:145], v209 offset:36864
  ds_read_b64_tr_b16 a[146:147], v209 offset:37376
  ds_read_b64_tr_b16 a[148:149], v209 offset:36872
  ds_read_b64_tr_b16 a[150:151], v209 offset:37384
  s_waitcnt vmcnt(34) lgkmcnt(0)
  ds_read_b64_tr_b16 a[152:153], v209 offset:38912
  ds_read_b64_tr_b16 a[154:155], v209 offset:39424
  ds_read_b64_tr_b16 a[156:157], v209 offset:38920
  ds_read_b64_tr_b16 a[158:159], v209 offset:39432
  s_waitcnt vmcnt(32) lgkmcnt(0)
  ds_read_b64_tr_b16 a[160:161], v209 offset:0
  ds_read_b64_tr_b16 a[162:163], v209 offset:512
  ds_read_b64_tr_b16 a[164:165], v209 offset:8
  ds_read_b64_tr_b16 a[166:167], v209 offset:520
  s_waitcnt vmcnt(30) lgkmcnt(0)
  ds_read_b64_tr_b16 a[168:169], v209 offset:2048
  ds_read_b64_tr_b16 a[170:171], v209 offset:2560
  ds_read_b64_tr_b16 a[172:173], v209 offset:2056
  ds_read_b64_tr_b16 a[174:175], v209 offset:2568
  s_waitcnt vmcnt(28) lgkmcnt(0)
  ds_read_b64_tr_b16 a[176:177], v209 offset:4096
  ds_read_b64_tr_b16 a[178:179], v209 offset:4608
  ds_read_b64_tr_b16 a[180:181], v209 offset:4104
  ds_read_b64_tr_b16 a[182:183], v209 offset:4616
  s_waitcnt vmcnt(26) lgkmcnt(0)
  ds_read_b64_tr_b16 a[184:185], v209 offset:6144
  ds_read_b64_tr_b16 a[186:187], v209 offset:6656
  ds_read_b64_tr_b16 a[188:189], v209 offset:6152
  ds_read_b64_tr_b16 a[190:191], v209 offset:6664
  s_waitcnt vmcnt(24) lgkmcnt(0)
  ds_read_b64_tr_b16 a[192:193], v209 offset:8192
  ds_read_b64_tr_b16 a[194:195], v209 offset:8704
  ds_read_b64_tr_b16 a[196:197], v209 offset:8200
  ds_read_b64_tr_b16 a[198:199], v209 offset:8712
  s_waitcnt vmcnt(22) lgkmcnt(0)
  ds_read_b64_tr_b16 a[200:201], v209 offset:10240
  ds_read_b64_tr_b16 a[202:203], v209 offset:10752
  ds_read_b64_tr_b16 a[204:205], v209 offset:10248
  ds_read_b64_tr_b16 a[206:207], v209 offset:10760
  s_waitcnt vmcnt(20) lgkmcnt(0)
  ds_read_b64_tr_b16 a[208:209], v209 offset:12288
  ds_read_b64_tr_b16 a[210:211], v209 offset:12800
  ds_read_b64_tr_b16 a[212:213], v209 offset:12296
  ds_read_b64_tr_b16 a[214:215], v209 offset:12808
  s_waitcnt vmcnt(18) lgkmcnt(0)
  ds_read_b64_tr_b16 a[216:217], v209 offset:14336
  ds_read_b64_tr_b16 a[218:219], v209 offset:14848
  ds_read_b64_tr_b16 a[220:221], v209 offset:14344
  ds_read_b64_tr_b16 a[222:223], v209 offset:14856
  s_waitcnt vmcnt(16) lgkmcnt(0)
  ds_read_b64_tr_b16 a[224:225], v209 offset:16384
  ds_read_b64_tr_b16 a[226:227], v209 offset:16896
  ds_read_b64_tr_b16 a[228:229], v209 offset:16392
  ds_read_b64_tr_b16 a[230:231], v209 offset:16904
  s_waitcnt vmcnt(14) lgkmcnt(0)
  ds_read_b64_tr_b16 a[232:233], v209 offset:18432
  ds_read_b64_tr_b16 a[234:235], v209 offset:18944
  ds_read_b64_tr_b16 a[236:237], v209 offset:18440
  ds_read_b64_tr_b16 a[238:239], v209 offset:18952
  s_waitcnt vmcnt(12) lgkmcnt(0)
  ds_read_b64_tr_b16 a[240:241], v209 offset:20480
  ds_read_b64_tr_b16 a[242:243], v209 offset:20992
  ds_read_b64_tr_b16 a[244:245], v209 offset:20488
  ds_read_b64_tr_b16 a[246:247], v209 offset:21000
  s_waitcnt vmcnt(10) lgkmcnt(0)
  ds_read_b64_tr_b16 a[248:249], v209 offset:22528
  ds_read_b64_tr_b16 a[250:251], v209 offset:23040
  ds_read_b64_tr_b16 a[252:253], v209 offset:22536
  ds_read_b64_tr_b16 a[254:255], v209 offset:23048
  s_waitcnt vmcnt(8) lgkmcnt(0)
  ds_read_b64_tr_b16 v[216:217], v210 offset:24576
  ds_read_b64_tr_b16 v[218:219], v210 offset:24832
  ds_read_b64_tr_b16 v[220:221], v210 offset:24584
  ds_read_b64_tr_b16 v[222:223], v210 offset:24840
  s_waitcnt vmcnt(6) lgkmcnt(0)
  ds_read_b64_tr_b16 v[224:225], v210 offset:26624
  ds_read_b64_tr_b16 v[226:227], v210 offset:26880
  ds_read_b64_tr_b16 v[228:229], v210 offset:26632
  ds_read_b64_tr_b16 v[230:231], v210 offset:26888
  s_waitcnt vmcnt(4) lgkmcnt(0)
  ds_read_b64_tr_b16 v[232:233], v210 offset:28672
  ds_read_b64_tr_b16 v[234:235], v210 offset:28928
  ds_read_b64_tr_b16 v[236:237], v210 offset:28680
  ds_read_b64_tr_b16 v[238:239], v210 offset:28936
  s_waitcnt vmcnt(2) lgkmcnt(0)
  ds_read_b64_tr_b16 v[240:241], v210 offset:30720
  ds_read_b64_tr_b16 v[242:243], v210 offset:30976
  ds_read_b64_tr_b16 v[244:245], v210 offset:30728
  ds_read_b64_tr_b16 v[246:247], v210 offset:30984
  s_waitcnt vmcnt(0) lgkmcnt(0)
  ds_read_b64_tr_b16 v[248:249], v210 offset:32768
  ds_read_b64_tr_b16 v[250:251], v210 offset:33024
  ds_read_b64_tr_b16 v[252:253], v210 offset:32776
  ds_read_b64_tr_b16 v[254:255], v210 offset:33032
  v_and_b32 v211, 15, v200
  s_lshl_b32 s54, s69, 4
  v_add_u32 v211, s54, v211
  v_lshl_add_u32 v212, v214, 5, v211
  v_lshlrev_b32 v164, 4, v212
  v_lshrrev_b32 v212, 5, v200
  v_lshl_add_u32 v164, v212, 10, v164
  v_mul_u32_u24 v167, 1152, v211
  v_lshl_add_u32 v167, v213, 4, v167
  v_lshlrev_b32 v166, 2, v211
  v_lshlrev_b32 v208, 2, v200
  s_lshl_b32 s54, s52, 11
  v_add_u32 v168, s54, v201
  s_mov_b32 s59, s68
  s_mov_b32 s56, 128
  s_mov_b32 s57, 36
  s_waitcnt lgkmcnt(0)
  s_cmp_eq_u32 s52, 0
  s_cbranch_scc0 O_p1_d
  s_mov_b32 exec_hi, 0
  s_mov_b32 exec_lo, -1
O_p1:
  buffer_load_dword v211, v208, s[12:15], s56 offen sc1
  s_add_u32 s65, s65, 1
  s_waitcnt vmcnt(0)
  v_cmp_gt_u32 vcc, 0x700, v211
  s_cbranch_vccz O_p1_x
  s_sleep 16
  s_cmp_lt_u32 s65, 131072
  s_cbranch_scc1 O_p1
O_p1_x:
  s_mov_b64 exec, -1
O_p1_d:
  s_barrier
  s_cmp_eq_u32 s52, 0
  s_cbranch_scc0 O_a_d
  s_mov_b32 exec_hi, 0
  s_mov_b32 exec_lo, 1
O_a:
  buffer_load_dword v211, v208, s[12:15], s57 offen sc1
  s_add_u32 s65, s65, 1
  s_waitcnt vmcnt(0)
  v_cmp_gt_u32 vcc, 0x80, v211
  s_cbranch_vccz O_a_x
  s_sleep 16
  s_cmp_lt_u32 s65, 131072
  s_cbranch_scc1 O_a
O_a_x:
  s_mov_b64 exec, -1
O_a_d:
  s_barrier
  s_cmp_ge_u32 s70, 9
  s_cselect_b32 s54, 9, 0
  s_sub_u32 s54, s70, s54
  s_and_b32 s54, s54, 7
  s_lshl_b32 s54, s54, 13
  s_lshl_b32 s55, s69, 8
  s_add_u32 s54, s54, s55
  v_lshrrev_b32 v211, 2, v200
  v_lshl_add_u32 v172, v211, 9, s54
  v_and_b32 v211, 3, v200
  v_lshl_add_u32 v172, v211, 6, v172
  s_mul_i32 s55, s59, 36864
  s_mul_i32 s54, s52, 320
  s_add_u32 s55, s55, s54
  s_add_u32 s55, s55, 62914560
  s_cmp_eq_u32 s52, 3
  s_cselect_b32 s56, 268435456, s55
  buffer_load_dwordx4 v[128:131], v167, s[8:11], s55 offen offset:0 sc1
  buffer_load_dwordx4 v[132:135], v167, s[8:11], s55 offen offset:64 sc1
  buffer_load_dwordx4 v[136:139], v167, s[8:11], s55 offen offset:128 sc1
  buffer_load_dwordx4 v[140:143], v167, s[8:11], s56 offen offset:192 sc1
  buffer_load_dwordx4 v[144:147], v167, s[8:11], s56 offen offset:256 sc1
  s_lshl_b32 s55, s59, 7
  s_add_u32 s55, s55, 66060288
  buffer_load_dword v171, v166, s[8:11], s55 offen sc1
  v_mov_b32 v169, 0
  s_mov_b32 s66, 356352
  s_waitcnt vmcnt(0)
O_loop:
  v_mfma_f32_16x16x32_bf16 v[156:159], v[216:219], v[128:131], 0
  v_mfma_f32_16x16x32_bf16 v[160:163], v[220:223], v[128:131], 0
  v_mfma_f32_16x16x32_bf16 v[156:159], v[224:227], v[132:135], v[156:159]
  v_mfma_f32_16x16x32_bf16 v[160:163], v[228:231], v[132:135], v[160:163]
  v_mfma_f32_16x16x32_bf16 v[156:159], v[232:235], v[136:139], v[156:159]
  v_mfma_f32_16x16x32_bf16 v[160:163], v[236:239], v[136:139], v[160:163]
  v_mfma_f32_16x16x32_bf16 v[156:159], v[240:243], v[140:143], v[156:159]
  v_mfma_f32_16x16x32_bf16 v[160:163], v[244:247], v[140:143], v[160:163]
  v_mfma_f32_16x16x32_bf16 v[156:159], v[248:251], v[144:147], v[156:159]
  v_mfma_f32_16x16x32_bf16 v[160:163], v[252:255], v[144:147], v[160:163]
  s_mul_i32 s64, s59, 36864
  s_lshl_b32 s54, s70, 6
  s_add_u32 s64, s64, s54
  s_add_u32 s71, s59, 2
  s_lshl_b32 s55, s59, 18
  s_lshl_b32 s54, s52, 16
  s_add_u32 s55, s55, s54
  s_add_u32 s63, s55, 46137344
  s_and_b32 s54, s59, 1
  s_lshl_b32 s54, s54, 2
  s_add_u32 s54, s54, s52
  s_lshl_b32 s54, s54, 3
  s_lshl_b64 s[72:73], 0xff, s54
  v_sub_f32 v165, 1.0, v171
  v_cvt_pk_bf16_f32 v165, v165, v165
  v_lshlrev_b32 v165, 16, v165
  v_mul_f32 v156, v171, v156
  v_mul_f32 v157, v171, v157
  v_mul_f32 v158, v171, v158
  v_mul_f32 v159, v171, v159
  v_mul_f32 v160, v171, v160
  v_mul_f32 v161, v171, v161
  v_mul_f32 v162, v171, v162
  v_mul_f32 v163, v171, v163
  s_branch O_pc
O_pl:
  s_sleep 1
  buffer_load_dword v169, v208, s[8:11], s66 offen sc1
  s_add_u32 s65, s65, 1
  s_cmp_ge_u32 s65, 131072
  s_cbranch_scc1 O_ld
  s_waitcnt vmcnt(0)
O_pc:
  v_cmp_gt_u32 vcc, s71, v169
  s_nop 0
  s_and_b64 vcc, vcc, s[72:73]
  s_cbranch_scc1 O_pl
O_ld:
  s_mov_b32 s62, s63
  buffer_load_dword v173, v172, s[8:11], s63 offen sc1
  buffer_load_dwordx4 v[0:3], v164, s[8:11], s62 offen offset:0 sc1
  buffer_load_dwordx4 v[4:7], v164, s[8:11], s62 offen offset:2048 sc1
  s_add_u32 s62, s62, 4096
  buffer_load_dwordx4 v[8:11], v164, s[8:11], s62 offen offset:0 sc1
  buffer_load_dwordx4 v[12:15], v164, s[8:11], s62 offen offset:2048 sc1
  s_add_u32 s62, s62, 4096
  buffer_load_dwordx4 v[16:19], v164, s[8:11], s62 offen offset:0 sc1
  buffer_load_dwordx4 v[20:23], v164, s[8:11], s62 offen offset:2048 sc1
  s_add_u32 s62, s62, 4096
  buffer_load_dwordx4 v[24:27], v164, s[8:11], s62 offen offset:0 sc1
  buffer_load_dwordx4 v[28:31], v164, s[8:11], s62 offen offset:2048 sc1
  s_add_u32 s62, s62, 4096
  buffer_load_dwordx4 v[32:35], v164, s[8:11], s62 offen offset:0 sc1
  buffer_load_dwordx4 v[36:39], v164, s[8:11], s62 offen offset:2048 sc1
  s_add_u32 s62, s62, 4096
  buffer_load_dwordx4 v[40:43], v164, s[8:11], s62 offen offset:0 sc1
  buffer_load_dwordx4 v[44:47], v164, s[8:11], s62 offen offset:2048 sc1
  s_add_u32 s62, s62, 4096
  buffer_load_dwordx4 v[48:51], v164, s[8:11], s62 offen offset:0 sc1
  buffer_load_dwordx4 v[52:55], v164, s[8:11], s62 offen offset:2048 sc1
  s_add_u32 s62, s62, 4096
  buffer_load_dwordx4 v[56:59], v164, s[8:11], s62 offen offset:0 sc1
  buffer_load_dwordx4 v[60:63], v164, s[8:11], s62 offen offset:2048 sc1
  s_add_u32 s62, s62, 4096
  buffer_load_dwordx4 v[64:67], v164, s[8:11], s62 offen offset:0 sc1
  buffer_load_dwordx4 v[68:71], v164, s[8:11], s62 offen offset:2048 sc1
  s_add_u32 s62, s62, 4096
  buffer_load_dwordx4 v[72:75], v164, s[8:11], s62 offen offset:0 sc1
  buffer_load_dwordx4 v[76:79], v164, s[8:11], s62 offen offset:2048 sc1
  s_add_u32 s62, s62, 4096
  buffer_load_dwordx4 v[80:83], v164, s[8:11], s62 offen offset:0 sc1
  buffer_load_dwordx4 v[84:87], v164, s[8:11], s62 offen offset:2048 sc1
  s_add_u32 s62, s62, 4096
  buffer_load_dwordx4 v[88:91], v164, s[8:11], s62 offen offset:0 sc1
  buffer_load_dwordx4 v[92:95], v164, s[8:11], s62 offen offset:2048 sc1
  s_add_u32 s62, s62, 4096
  buffer_load_dwordx4 v[96:99], v164, s[8:11], s62 offen offset:0 sc1
  buffer_load_dwordx4 v[100:103], v164, s[8:11], s62 offen offset:2048 sc1
  s_add_u32 s62, s62, 4096
  buffer_load_dwordx4 v[104:107], v164, s[8:11], s62 offen offset:0 sc1
  buffer_load_dwordx4 v[108:111], v164, s[8:11], s62 offen offset:2048 sc1
  s_add_u32 s62, s62, 4096
  buffer_load_dwordx4 v[112:115], v164, s[8:11], s62 offen offset:0 sc1
  buffer_load_dwordx4 v[116:119], v164, s[8:11], s62 offen offset:2048 sc1
  s_add_u32 s62, s62, 4096
  buffer_load_dwordx4 v[120:123], v164, s[8:11], s62 offen offset:0 sc1
  buffer_load_dwordx4 v[124:127], v164, s[8:11], s62 offen offset:2048 sc1
  s_add_u32 s62, s62, 4096
  s_add_u32 s57, s59, 3
  s_min_u32 s74, s57, 63
  s_mul_i32 s55, s74, 36864
  s_mul_i32 s54, s52, 320
  s_add_u32 s55, s55, s54
  s_add_u32 s55, s55, 62914560
  s_cmp_eq_u32 s52, 3
  s_cselect_b32 s56, 268435456, s55
  buffer_load_dwordx4 v[128:131], v167, s[8:11], s55 offen offset:0 sc1
  buffer_load_dwordx4 v[132:135], v167, s[8:11], s55 offen offset:64 sc1
  buffer_load_dwordx4 v[136:139], v167, s[8:11], s55 offen offset:128 sc1
  buffer_load_dwordx4 v[140:143], v167, s[8:11], s56 offen offset:192 sc1
  buffer_load_dwordx4 v[144:147], v167, s[8:11], s56 offen offset:256 sc1
  s_lshl_b32 s55, s74, 7
  s_add_u32 s55, s55, 66060288
  buffer_load_dword v171, v166, s[8:11], s55 offen sc1
  s_add_u32 s65, s65, 1
  s_cmp_lt_u32 s65, 131072
  s_cselect_b32 s54, -2, -1
  s_waitcnt vmcnt(37)
  v_mfma_f32_16x16x32_bf16 v[148:151], a[0:3], v[0:3], 0
  v_mfma_f32_16x16x32_bf16 v[152:155], a[4:7], v[0:3], 0
  v_max3_u32 v170, v0, v1, v0
  v_max3_u32 v170, v2, v3, v170
  s_waitcnt vmcnt(36)
  v_mfma_f32_16x16x32_bf16 v[148:151], a[8:11], v[4:7], v[148:151]
  v_mfma_f32_16x16x32_bf16 v[152:155], a[12:15], v[4:7], v[152:155]
  v_max3_u32 v170, v4, v5, v170
  v_max3_u32 v170, v6, v7, v170
  s_waitcnt vmcnt(35)
  v_mfma_f32_16x16x32_bf16 v[148:151], a[16:19], v[8:11], v[148:151]
  v_mfma_f32_16x16x32_bf16 v[152:155], a[20:23], v[8:11], v[152:155]
  v_max3_u32 v170, v8, v9, v170
  v_max3_u32 v170, v10, v11, v170
  s_waitcnt vmcnt(34)
  v_mfma_f32_16x16x32_bf16 v[148:151], a[24:27], v[12:15], v[148:151]
  v_mfma_f32_16x16x32_bf16 v[152:155], a[28:31], v[12:15], v[152:155]
  v_max3_u32 v170, v12, v13, v170
  v_max3_u32 v170, v14, v15, v170
  s_waitcnt vmcnt(33)
  v_mfma_f32_16x16x32_bf16 v[148:151], a[32:35], v[16:19], v[148:151]
  v_mfma_f32_16x16x32_bf16 v[152:155], a[36:39], v[16:19], v[152:155]
  v_max3_u32 v170, v16, v17, v170
  v_max3_u32 v170, v18, v19, v170
  s_waitcnt vmcnt(32)
  v_mfma_f32_16x16x32_bf16 v[148:151], a[40:43], v[20:23], v[148:151]
  v_mfma_f32_16x16x32_bf16 v[152:155], a[44:47], v[20:23], v[152:155]
  v_max3_u32 v170, v20, v21, v170
  v_max3_u32 v170, v22, v23, v170
  s_waitcnt vmcnt(31)
  v_mfma_f32_16x16x32_bf16 v[148:151], a[48:51], v[24:27], v[148:151]
  v_mfma_f32_16x16x32_bf16 v[152:155], a[52:55], v[24:27], v[152:155]
  v_max3_u32 v170, v24, v25, v170
  v_max3_u32 v170, v26, v27, v170
  s_waitcnt vmcnt(30)
  v_mfma_f32_16x16x32_bf16 v[148:151], a[56:59], v[28:31], v[148:151]
  v_mfma_f32_16x16x32_bf16 v[152:155], a[60:63], v[28:31], v[152:155]
  v_max3_u32 v170, v28, v29, v170
  v_max3_u32 v170, v30, v31, v170
  s_waitcnt vmcnt(29)
  v_mfma_f32_16x16x32_bf16 v[148:151], a[64:67], v[32:35], v[148:151]
  v_mfma_f32_16x16x32_bf16 v[152:155], a[68:71], v[32:35], v[152:155]
  v_max3_u32 v170, v32, v33, v170
  v_max3_u32 v170, v34, v35, v170
  s_waitcnt vmcnt(28)
  v_mfma_f32_16x16x32_bf16 v[148:151], a[72:75], v[36:39], v[148:151]
  v_mfma_f32_16x16x32_bf16 v[152:155], a[76:79], v[36:39], v[152:155]
  v_max3_u32 v170, v36, v37, v170
  v_max3_u32 v170, v38, v39, v170
  s_waitcnt vmcnt(27)
  v_mfma_f32_16x16x32_bf16 v[148:151], a[80:83], v[40:43], v[148:151]
  v_mfma_f32_16x16x32_bf16 v[152:155], a[84:87], v[40:43], v[152:155]
  v_max3_u32 v170, v40, v41, v170
  v_max3_u32 v170, v42, v43, v170
  s_waitcnt vmcnt(26)
  v_mfma_f32_16x16x32_bf16 v[148:151], a[88:91], v[44:47], v[148:151]
  v_mfma_f32_16x16x32_bf16 v[152:155], a[92:95], v[44:47], v[152:155]
  v_max3_u32 v170, v44, v45, v170
  v_max3_u32 v170, v46, v47, v170
  s_waitcnt vmcnt(25)
  v_mfma_f32_16x16x32_bf16 v[148:151], a[96:99], v[48:51], v[148:151]
  v_mfma_f32_16x16x32_bf16 v[152:155], a[100:103], v[48:51], v[152:155]
  v_max3_u32 v170, v48, v49, v170
  v_max3_u32 v170, v50, v51, v170
  s_waitcnt vmcnt(24)
  v_mfma_f32_16x16x32_bf16 v[148:151], a[104:107], v[52:55], v[148:151]
  v_mfma_f32_16x16x32_bf16 v[152:155], a[108:111], v[52:55], v[152:155]
  v_max3_u32 v170, v52, v53, v170
  v_max3_u32 v170, v54, v55, v170
  s_waitcnt vmcnt(23)
  v_mfma_f32_16x16x32_bf16 v[148:151], a[112:115], v[56:59], v[148:151]
  v_mfma_f32_16x16x32_bf16 v[152:155], a[116:119], v[56:59], v[152:155]
  v_max3_u32 v170, v56, v57, v170
  v_max3_u32 v170, v58, v59, v170
  s_waitcnt vmcnt(22)
  v_mfma_f32_16x16x32_bf16 v[148:151], a[120:123], v[60:63], v[148:151]
  v_mfma_f32_16x16x32_bf16 v[152:155], a[124:127], v[60:63], v[152:155]
  v_max3_u32 v170, v60, v61, v170
  v_max3_u32 v170, v62, v63, v170
  s_waitcnt vmcnt(21)
  v_mfma_f32_16x16x32_bf16 v[148:151], a[128:131], v[64:67], v[148:151]
  v_mfma_f32_16x16x32_bf16 v[152:155], a[132:135], v[64:67], v[152:155]
  v_max3_u32 v170, v64, v65, v170
  v_max3_u32 v170, v66, v67, v170
  s_waitcnt vmcnt(20)
  v_mfma_f32_16x16x32_bf16 v[148:151], a[136:139], v[68:71], v[148:151]
  v_mfma_f32_16x16x32_bf16 v[152:155], a[140:143], v[68:71], v[152:155]
  v_max3_u32 v170, v68, v69, v170
  v_max3_u32 v170, v70, v71, v170
  s_waitcnt vmcnt(19)
  v_mfma_f32_16x16x32_bf16 v[148:151], a[144:147], v[72:75], v[148:151]
  v_mfma_f32_16x16x32_bf16 v[152:155], a[148:151], v[72:75], v[152:155]
  v_max3_u32 v170, v72, v73, v170
  v_max3_u32 v170, v74, v75, v170
  s_waitcnt vmcnt(18)
  v_mfma_f32_16x16x32_bf16 v[148:151], a[152:155], v[76:79], v[148:151]
  v_mfma_f32_16x16x32_bf16 v[152:155], a[156:159], v[76:79], v[152:155]
  v_max3_u32 v170, v76, v77, v170
  v_max3_u32 v170, v78, v79, v170
  s_waitcnt vmcnt(17)
  v_mfma_f32_16x16x32_bf16 v[148:151], a[160:163], v[80:83], v[148:151]
  v_mfma_f32_16x16x32_bf16 v[152:155], a[164:167], v[80:83], v[152:155]
  v_max3_u32 v170, v80, v81, v170
  v_max3_u32 v170, v82, v83, v170
  s_waitcnt vmcnt(16)
  v_mfma_f32_16x16x32_bf16 v[148:151], a[168:171], v[84:87], v[148:151]
  v_mfma_f32_16x16x32_bf16 v[152:155], a[172:175], v[84:87], v[152:155]
  v_max3_u32 v170, v84, v85, v170
  v_max3_u32 v170, v86, v87, v170
  s_waitcnt vmcnt(15)
  v_mfma_f32_16x16x32_bf16 v[148:151], a[176:179], v[88:91], v[148:151]
  v_mfma_f32_16x16x32_bf16 v[152:155], a[180:183], v[88:91], v[152:155]
  v_max3_u32 v170, v88, v89, v170
  v_max3_u32 v170, v90, v91, v170
  s_waitcnt vmcnt(14)
  v_mfma_f32_16x16x32_bf16 v[148:151], a[184:187], v[92:95], v[148:151]
  v_mfma_f32_16x16x32_bf16 v[152:155], a[188:191], v[92:95], v[152:155]
  v_max3_u32 v170, v92, v93, v170
  v_max3_u32 v170, v94, v95, v170
  s_waitcnt vmcnt(13)
  v_mfma_f32_16x16x32_bf16 v[148:151], a[192:195], v[96:99], v[148:151]
  v_mfma_f32_16x16x32_bf16 v[152:155], a[196:199], v[96:99], v[152:155]
  v_max3_u32 v170, v96, v97, v170
  v_max3_u32 v170, v98, v99, v170
  s_waitcnt vmcnt(12)
  v_mfma_f32_16x16x32_bf16 v[148:151], a[200:203], v[100:103], v[148:151]
  v_mfma_f32_16x16x32_bf16 v[152:155], a[204:207], v[100:103], v[152:155]
  v_max3_u32 v170, v100, v101, v170
  v_max3_u32 v170, v102, v103, v170
  s_waitcnt vmcnt(11)
  v_mfma_f32_16x16x32_bf16 v[148:151], a[208:211], v[104:107], v[148:151]
  v_mfma_f32_16x16x32_bf16 v[152:155], a[212:215], v[104:107], v[152:155]
  v_max3_u32 v170, v104, v105, v170
  v_max3_u32 v170, v106, v107, v170
  s_waitcnt vmcnt(10)
  v_mfma_f32_16x16x32_bf16 v[148:151], a[216:219], v[108:111], v[148:151]
  v_mfma_f32_16x16x32_bf16 v[152:155], a[220:223], v[108:111], v[152:155]
  v_max3_u32 v170, v108, v109, v170
  v_max3_u32 v170, v110, v111, v170
  s_waitcnt vmcnt(9)
  v_mfma_f32_16x16x32_bf16 v[148:151], a[224:227], v[112:115], v[148:151]
  v_mfma_f32_16x16x32_bf16 v[152:155], a[228:231], v[112:115], v[152:155]
  v_max3_u32 v170, v112, v113, v170
  v_max3_u32 v170, v114, v115, v170
  s_waitcnt vmcnt(8)
  v_mfma_f32_16x16x32_bf16 v[148:151], a[232:235], v[116:119], v[148:151]
  v_mfma_f32_16x16x32_bf16 v[152:155], a[236:239], v[116:119], v[152:155]
  v_max3_u32 v170, v116, v117, v170
  v_max3_u32 v170, v118, v119, v170
  s_waitcnt vmcnt(7)
  v_mfma_f32_16x16x32_bf16 v[148:151], a[240:243], v[120:123], v[148:151]
  v_mfma_f32_16x16x32_bf16 v[152:155], a[244:247], v[120:123], v[152:155]
  v_max3_u32 v170, v120, v121, v170
  v_max3_u32 v170, v122, v123, v170
  s_waitcnt vmcnt(6)
  v_mfma_f32_16x16x32_bf16 v[148:151], a[248:251], v[124:127], v[148:151]
  v_mfma_f32_16x16x32_bf16 v[152:155], a[252:255], v[124:127], v[152:155]
  v_max3_u32 v170, v124, v125, v170
  v_max3_u32 v170, v126, v127, v170
  v_cmp_lt_u32 vcc, s54, v170
  s_cbranch_vccnz O_ld
  v_fmac_f32 v156, v165, v148
  v_fmac_f32 v157, v165, v149
  v_fmac_f32 v158, v165, v150
  v_fmac_f32 v159, v165, v151
  v_fmac_f32 v160, v165, v152
  v_fmac_f32 v161, v165, v153
  v_fmac_f32 v162, v165, v154
  v_fmac_f32 v163, v165, v155
  ds_write_b128 v168, v[156:159]
  ds_write_b128 v168, v[160:163] offset:1024
  v_xor_b32 v168, 0x2000, v168
  s_mov_b32 s59, s57
  s_waitcnt lgkmcnt(0)
  s_barrier
  s_cmp_eq_u32 s52, 0
  s_cbranch_scc0 O_next
  v_xor_b32 v211, 0x2000, v168
  ds_read_b128 v[0:3], v211 offset:2048
  ds_read_b128 v[4:7], v211 offset:3072
  ds_read_b128 v[8:11], v211 offset:4096
  ds_read_b128 v[12:15], v211 offset:5120
  ds_read_b128 v[16:19], v211 offset:6144
  ds_read_b128 v[20:23], v211 offset:7168
  s_waitcnt lgkmcnt(5)
  v_add_f32 v156, v156, v0
  v_add_f32 v157, v157, v1
  v_add_f32 v158, v158, v2
  v_add_f32 v159, v159, v3
  s_waitcnt lgkmcnt(4)
  v_add_f32 v160, v160, v4
  v_add_f32 v161, v161, v5
  v_add_f32 v162, v162, v6
  v_add_f32 v163, v163, v7
  s_waitcnt lgkmcnt(3)
  v_add_f32 v156, v156, v8
  v_add_f32 v157, v157, v9
  v_add_f32 v158, v158, v10
  v_add_f32 v159, v159, v11
  s_waitcnt lgkmcnt(2)
  v_add_f32 v160, v160, v12
  v_add_f32 v161, v161, v13
  v_add_f32 v162, v162, v14
  v_add_f32 v163, v163, v15
  s_waitcnt lgkmcnt(1)
  v_add_f32 v156, v156, v16
  v_add_f32 v157, v157, v17
  v_add_f32 v158, v158, v18
  v_add_f32 v159, v159, v19
  s_waitcnt lgkmcnt(0)
  v_add_f32 v160, v160, v20
  v_add_f32 v161, v161, v21
  v_add_f32 v162, v162, v22
  v_add_f32 v163, v163, v23
  v_cvt_pk_bf16_f32 v148, v156, v157
  v_cvt_pk_bf16_f32 v149, v158, v159
  v_cvt_pk_bf16_f32 v150, v160, v161
  v_cvt_pk_bf16_f32 v151, v162, v163
  buffer_store_dwordx4 v[148:151], v167, s[48:51], s64 offen
  s_waitcnt vmcnt(1)
  s_branch O_nx2
O_next:
  s_waitcnt vmcnt(0)
O_nx2:
  s_cmp_lt_u32 s59, 64
  s_cbranch_scc1 O_loop
  s_branch L_exit
W_h:
  s_lshr_b32 s58, s53, 1
  s_and_b32 s59, s53, 1
  s_mul_i32 s60, s59, 36864
  s_add_u32 m0, s67, 0
  s_nop 0
  buffer_load_dwordx4 v202, s[4:7], s60 offen offset:0 lds
  s_add_u32 m0, s67, 896
  s_nop 0
  buffer_load_dwordx4 v202, s[4:7], s60 offen offset:128 lds
  s_add_u32 m0, s67, 1792
  s_nop 0
  buffer_load_dwordx4 v202, s[4:7], s60 offen offset:256 lds
  s_add_u32 m0, s67, 2688
  s_nop 0
  buffer_load_dwordx4 v202, s[4:7], s60 offen offset:384 lds
  s_add_u32 m0, s67, 3584
  s_nop 0
  buffer_load_dwordx4 v202, s[4:7], s60 offen offset:512 lds
  s_add_u32 m0, s67, 4480
  s_nop 0
  buffer_load_dwordx4 v202, s[4:7], s60 offen offset:640 lds
  s_add_u32 m0, s67, 5376
  s_nop 0
  buffer_load_dwordx4 v202, s[4:7], s60 offen offset:768 lds
  s_add_u32 m0, s67, 6272
  s_nop 0
  buffer_load_dwordx4 v202, s[4:7], s60 offen offset:896 lds
  s_add_u32 m0, s67, 7168
  s_nop 0
  buffer_load_dwordx4 v202, s[4:7], s60 offen offset:1024 lds
  v_lshrrev_b32 v211, 4, v200
  v_lshlrev_b32 v212, 2, v211
  v_and_b32 v213, 15, v200
  v_xor_b32 v212, v212, v213
  v_lshlrev_b32 v212, 4, v212
  v_lshl_add_u32 v207, v211, 13, v212
  s_lshl_b32 s62, s58, 8
  s_lshl_b32 s54, s52, 15
  s_add_u32 s62, s62, s54
  s_lshl_b32 s61, s52, 10
  s_add_u32 s61, s61, 36864
  s_add_u32 m0, s61, 0
  s_add_u32 s54, s62, 0
  buffer_load_dwordx4 v207, s[16:19], s54 offen lds
  s_add_u32 m0, s61, 4096
  s_add_u32 s54, s62, 131072
  buffer_load_dwordx4 v207, s[16:19], s54 offen lds
  s_add_u32 m0, s61, 8192
  s_add_u32 s54, s62, 262144
  buffer_load_dwordx4 v207, s[16:19], s54 offen lds
  s_add_u32 m0, s61, 12288
  s_add_u32 s54, s62, 393216
  buffer_load_dwordx4 v207, s[16:19], s54 offen lds
  s_add_u32 m0, s61, 16384
  s_add_u32 s54, s62, 524288
  buffer_load_dwordx4 v207, s[16:19], s54 offen lds
  s_add_u32 m0, s61, 20480
  s_add_u32 s54, s62, 655360
  buffer_load_dwordx4 v207, s[16:19], s54 offen lds
  s_add_u32 m0, s61, 24576
  s_add_u32 s54, s62, 786432
  buffer_load_dwordx4 v207, s[16:19], s54 offen lds
  s_add_u32 m0, s61, 28672
  s_add_u32 s54, s62, 917504
  buffer_load_dwordx4 v207, s[16:19], s54 offen lds
  s_add_u32 m0, s61, 32768
  s_add_u32 s54, s62, 1048576
  buffer_load_dwordx4 v207, s[16:19], s54 offen lds
  s_add_u32 m0, s61, 36864
  s_add_u32 s54, s62, 1179648
  buffer_load_dwordx4 v207, s[16:19], s54 offen lds
  s_add_u32 m0, s61, 40960
  s_add_u32 s54, s62, 1310720
  buffer_load_dwordx4 v207, s[16:19], s54 offen lds
  s_add_u32 m0, s61, 45056
  s_add_u32 s54, s62, 1441792
  buffer_load_dwordx4 v207, s[16:19], s54 offen lds
  s_add_u32 m0, s61, 49152
  s_add_u32 s54, s62, 1572864
  buffer_load_dwordx4 v207, s[16:19], s54 offen lds
  s_add_u32 m0, s61, 53248
  s_add_u32 s54, s62, 1703936
  buffer_load_dwordx4 v207, s[16:19], s54 offen lds
  s_add_u32 m0, s61, 57344
  s_add_u32 s54, s62, 1835008
  buffer_load_dwordx4 v207, s[16:19], s54 offen lds
  s_add_u32 m0, s61, 61440
  s_add_u32 s54, s62, 1966080
  buffer_load_dwordx4 v207, s[16:19], s54 offen lds
  s_add_u32 m0, s61, 65536
  s_add_u32 s54, s62, 2097152
  buffer_load_dwordx4 v207, s[16:19], s54 offen lds
  s_add_u32 m0, s61, 69632
  s_add_u32 s54, s62, 2228224
  buffer_load_dwordx4 v207, s[16:19], s54 offen lds
  s_add_u32 m0, s61, 73728
  s_add_u32 s54, s62, 2359296
  buffer_load_dwordx4 v207, s[16:19], s54 offen lds
  s_add_u32 m0, s61, 77824
  s_add_u32 s54, s62, 2490368
  buffer_load_dwordx4 v207, s[16:19], s54 offen lds
  s_add_u32 m0, s61, 81920
  s_add_u32 s54, s62, 2621440
  buffer_load_dwordx4 v207, s[16:19], s54 offen lds
  s_add_u32 m0, s61, 86016
  s_add_u32 s54, s62, 2752512
  buffer_load_dwordx4 v207, s[16:19], s54 offen lds
  s_add_u32 m0, s61, 90112
  s_add_u32 s54, s62, 2883584
  buffer_load_dwordx4 v207, s[16:19], s54 offen lds
  s_add_u32 m0, s61, 94208
  s_add_u32 s54, s62, 3014656
  buffer_load_dwordx4 v207, s[16:19], s54 offen lds
  s_waitcnt vmcnt(20) lgkmcnt(0)
  s_barrier
  s_add_u32 m0, s61, 98304
  s_add_u32 s54, s62, 3145728
  buffer_load_dwordx4 v207, s[16:19], s54 offen lds
  s_add_u32 m0, s61, 102400
  s_add_u32 s54, s62, 3276800
  buffer_load_dwordx4 v207, s[16:19], s54 offen lds
  s_add_u32 m0, s61, 106496
  s_add_u32 s54, s62, 3407872
  buffer_load_dwordx4 v207, s[16:19], s54 offen lds
  s_add_u32 m0, s61, 110592
  s_add_u32 s54, s62, 3538944
  buffer_load_dwordx4 v207, s[16:19], s54 offen lds
  v_add_u32 v215, 36864, v209
  ds_read_b64_tr_b16 a[0:1], v215 offset:0
  ds_read_b64_tr_b16 a[2:3], v215 offset:1024
  ds_read_b64_tr_b16 a[4:5], v215 offset:4096
  ds_read_b64_tr_b16 a[6:7], v215 offset:5120
  ds_read_b64_tr_b16 a[8:9], v215 offset:8192
  ds_read_b64_tr_b16 a[10:11], v215 offset:9216
  ds_read_b64_tr_b16 a[12:13], v215 offset:12288
  ds_read_b64_tr_b16 a[14:15], v215 offset:13312
  s_waitcnt vmcnt(20) lgkmcnt(0)
  s_barrier
  s_add_u32 m0, s61, 0
  s_add_u32 s54, s62, 3670016
  buffer_load_dwordx4 v207, s[16:19], s54 offen lds
  s_add_u32 m0, s61, 4096
  s_add_u32 s54, s62, 3801088
  buffer_load_dwordx4 v207, s[16:19], s54 offen lds
  s_add_u32 m0, s61, 8192
  s_add_u32 s54, s62, 3932160
  buffer_load_dwordx4 v207, s[16:19], s54 offen lds
  s_add_u32 m0, s61, 12288
  s_add_u32 s54, s62, 4063232
  buffer_load_dwordx4 v207, s[16:19], s54 offen lds
  v_add_u32 v215, 53248, v209
  ds_read_b64_tr_b16 a[16:17], v215 offset:0
  ds_read_b64_tr_b16 a[18:19], v215 offset:1024
  ds_read_b64_tr_b16 a[20:21], v215 offset:4096
  ds_read_b64_tr_b16 a[22:23], v215 offset:5120
  ds_read_b64_tr_b16 a[24:25], v215 offset:8192
  ds_read_b64_tr_b16 a[26:27], v215 offset:9216
  ds_read_b64_tr_b16 a[28:29], v215 offset:12288
  ds_read_b64_tr_b16 a[30:31], v215 offset:13312
  s_waitcnt vmcnt(20) lgkmcnt(0)
  s_barrier
  s_add_u32 m0, s61, 16384
  s_add_u32 s54, s62, 4194304
  buffer_load_dwordx4 v207, s[16:19], s54 offen lds
  s_add_u32 m0, s61, 20480
  s_add_u32 s54, s62, 4325376
  buffer_load_dwordx4 v207, s[16:19], s54 offen lds
  s_add_u32 m0, s61, 24576
  s_add_u32 s54, s62, 4456448
  buffer_load_dwordx4 v207, s[16:19], s54 offen lds
  s_add_u32 m0, s61, 28672
  s_add_u32 s54, s62, 4587520
  buffer_load_dwordx4 v207, s[16:19], s54 offen lds
  v_add_u32 v215, 69632, v209
  ds_read_b64_tr_b16 a[32:33], v215 offset:0
  ds_read_b64_tr_b16 a[34:35], v215 offset:1024
  ds_read_b64_tr_b16 a[36:37], v215 offset:4096
  ds_read_b64_tr_b16 a[38:39], v215 offset:5120
  ds_read_b64_tr_b16 a[40:41], v215 offset:8192
  ds_read_b64_tr_b16 a[42:43], v215 offset:9216
  ds_read_b64_tr_b16 a[44:45], v215 offset:12288
  ds_read_b64_tr_b16 a[46:47], v215 offset:13312
  s_waitcnt vmcnt(20) lgkmcnt(0)
  s_barrier
  v_add_u32 v215, 86016, v209
  ds_read_b64_tr_b16 a[48:49], v215 offset:0
  ds_read_b64_tr_b16 a[50:51], v215 offset:1024
  ds_read_b64_tr_b16 a[52:53], v215 offset:4096
  ds_read_b64_tr_b16 a[54:55], v215 offset:5120
  ds_read_b64_tr_b16 a[56:57], v215 offset:8192
  ds_read_b64_tr_b16 a[58:59], v215 offset:9216
  ds_read_b64_tr_b16 a[60:61], v215 offset:12288
  ds_read_b64_tr_b16 a[62:63], v215 offset:13312
  s_waitcnt vmcnt(16) lgkmcnt(0)
  s_barrier
  v_add_u32 v215, 102400, v209
  ds_read_b64_tr_b16 a[64:65], v215 offset:0
  ds_read_b64_tr_b16 a[66:67], v215 offset:1024
  ds_read_b64_tr_b16 a[68:69], v215 offset:4096
  ds_read_b64_tr_b16 a[70:71], v215 offset:5120
  ds_read_b64_tr_b16 a[72:73], v215 offset:8192
  ds_read_b64_tr_b16 a[74:75], v215 offset:9216
  ds_read_b64_tr_b16 a[76:77], v215 offset:12288
  ds_read_b64_tr_b16 a[78:79], v215 offset:13312
  s_waitcnt vmcnt(12) lgkmcnt(0)
  s_barrier
  v_add_u32 v215, 118784, v209
  ds_read_b64_tr_b16 a[80:81], v215 offset:0
  ds_read_b64_tr_b16 a[82:83], v215 offset:1024
  ds_read_b64_tr_b16 a[84:85], v215 offset:4096
  ds_read_b64_tr_b16 a[86:87], v215 offset:5120
  ds_read_b64_tr_b16 a[88:89], v215 offset:8192
  ds_read_b64_tr_b16 a[90:91], v215 offset:9216
  ds_read_b64_tr_b16 a[92:93], v215 offset:12288
  ds_read_b64_tr_b16 a[94:95], v215 offset:13312
  s_waitcnt vmcnt(8) lgkmcnt(0)
  s_barrier
  v_add_u32 v215, 135168, v209
  ds_read_b64_tr_b16 a[96:97], v215 offset:0
  ds_read_b64_tr_b16 a[98:99], v215 offset:1024
  ds_read_b64_tr_b16 a[100:101], v215 offset:4096
  ds_read_b64_tr_b16 a[102:103], v215 offset:5120
  ds_read_b64_tr_b16 a[104:105], v215 offset:8192
  ds_read_b64_tr_b16 a[106:107], v215 offset:9216
  ds_read_b64_tr_b16 a[108:109], v215 offset:12288
  ds_read_b64_tr_b16 a[110:111], v215 offset:13312
  s_waitcnt vmcnt(4) lgkmcnt(0)
  s_barrier
  v_add_u32 v215, 36864, v209
  ds_read_b64_tr_b16 a[112:113], v215 offset:0
  ds_read_b64_tr_b16 a[114:115], v215 offset:1024
  ds_read_b64_tr_b16 a[116:117], v215 offset:4096
  ds_read_b64_tr_b16 a[118:119], v215 offset:5120
  ds_read_b64_tr_b16 a[120:121], v215 offset:8192
  ds_read_b64_tr_b16 a[122:123], v215 offset:9216
  ds_read_b64_tr_b16 a[124:125], v215 offset:12288
  ds_read_b64_tr_b16 a[126:127], v215 offset:13312
  s_waitcnt vmcnt(0) lgkmcnt(0)
  s_barrier
  v_add_u32 v215, 53248, v209
  ds_read_b64_tr_b16 a[128:129], v215 offset:0
  ds_read_b64_tr_b16 a[130:131], v215 offset:1024
  ds_read_b64_tr_b16 a[132:133], v215 offset:4096
  ds_read_b64_tr_b16 a[134:135], v215 offset:5120
  ds_read_b64_tr_b16 a[136:137], v215 offset:8192
  ds_read_b64_tr_b16 a[138:139], v215 offset:9216
  ds_read_b64_tr_b16 a[140:141], v215 offset:12288
  ds_read_b64_tr_b16 a[142:143], v215 offset:13312
  s_waitcnt lgkmcnt(0)
  s_barrier
  v_and_b32 v211, 31, v200
  v_lshrrev_b32 v212, 5, v200
  v_lshlrev_b32 v213, 2, v212
  v_sub_u32 v211, v211, v213
  v_mov_b32 v214, 0xf149f2ca
  v_cmp_gt_i32 vcc, 0, v211
  s_nop 1
  v_cndmask_b32 v48, 0, v214, vcc
  v_cmp_gt_i32 vcc, 1, v211
  s_nop 1
  v_cndmask_b32 v49, 0, v214, vcc
  v_cmp_gt_i32 vcc, 2, v211
  s_nop 1
  v_cndmask_b32 v50, 0, v214, vcc
  v_cmp_gt_i32 vcc, 3, v211
  s_nop 1
  v_cndmask_b32 v51, 0, v214, vcc
  v_cmp_gt_i32 vcc, 8, v211
  s_nop 1
  v_cndmask_b32 v52, 0, v214, vcc
  v_cmp_gt_i32 vcc, 9, v211
  s_nop 1
  v_cndmask_b32 v53, 0, v214, vcc
  v_cmp_gt_i32 vcc, 10, v211
  s_nop 1
  v_cndmask_b32 v54, 0, v214, vcc
  v_cmp_gt_i32 vcc, 11, v211
  s_nop 1
  v_cndmask_b32 v55, 0, v214, vcc
  v_cmp_gt_i32 vcc, 16, v211
  s_nop 1
  v_cndmask_b32 v56, 0, v214, vcc
  v_cmp_gt_i32 vcc, 17, v211
  s_nop 1
  v_cndmask_b32 v57, 0, v214, vcc
  v_cmp_gt_i32 vcc, 18, v211
  s_nop 1
  v_cndmask_b32 v58, 0, v214, vcc
  v_cmp_gt_i32 vcc, 19, v211
  s_nop 1
  v_cndmask_b32 v59, 0, v214, vcc
  v_cmp_gt_i32 vcc, 24, v211
  s_nop 1
  v_cndmask_b32 v60, 0, v214, vcc
  v_cmp_gt_i32 vcc, 25, v211
  s_nop 1
  v_cndmask_b32 v61, 0, v214, vcc
  v_cmp_gt_i32 vcc, 26, v211
  s_nop 1
  v_cndmask_b32 v62, 0, v214, vcc
  v_cmp_gt_i32 vcc, 27, v211
  s_nop 1
  v_cndmask_b32 v63, 0, v214, vcc
  v_and_b32 v218, 0xff, v216
  v_add_u32 v218, 81920, v218
  v_and_b32 v211, 15, v200
  v_lshl_add_u32 v211, v212, 5, v211
  v_lshlrev_b32 v219, 3, v211
  v_bfe_u32 v211, v200, 4, 1
  v_lshl_add_u32 v219, v211, 2, v219
  s_lshl_b32 s54, s52, 9
  s_add_u32 s54, s54, 83968
  v_add_u32 v219, s54, v219
  v_lshl_add_u32 v221, v200, 3, s54
  s_lshr_b32 s54, s52, 1
  s_lshl_b32 s54, s54, 10
  s_and_b32 s55, s52, 1
  s_lshl_b32 s55, s55, 3
  s_add_u32 s54, s54, s55
  s_add_u32 s54, s54, 81920
  v_add_u32 v220, s54, v201
  s_lshl_b32 s54, s52, 11
  s_add_u32 s54, s54, 73728
  v_add_u32 v215, s54, v201
  v_add_u32 v208, 73728, v201
  s_mov_b32 s68, 1040356334
  s_cmp_eq_u32 s52, 0
  s_cselect_b32 s71, s71, 268435456
  s_lshl_b32 s56, s58, 2
  s_add_u32 s56, s56, 128
  v_mov_b32 v176, -1
  v_mov_b32 v177, -1
  v_mov_b32 v178, -1
  v_mov_b32 v179, -1
  s_cmp_eq_u32 s52, 0
  s_cbranch_scc0 AT_p1_d
  s_mov_b32 exec_hi, 0
  s_mov_b32 exec_lo, 1
AT_p1:
  buffer_load_dword v211, v201, s[12:15], s56 offen sc1
  s_add_u32 s65, s65, 1
  s_waitcnt vmcnt(0)
  v_cmp_gt_u32 vcc, 0x700, v211
  s_cbranch_vccz AT_p1_x
  s_sleep 8
  s_cmp_lt_u32 s65, 131072
  s_cbranch_scc1 AT_p1
AT_p1_x:
  s_mov_b64 exec, -1
AT_p1_d:
  s_barrier
  s_mov_b32 s74, s59
  s_mul_i32 s66, s59, 655360
  s_lshl_b32 s55, s58, 14
  s_add_u32 s55, s55, s66
  s_add_u32 s55, s55, 1048576
  s_lshl_b32 s73, s58, 2
  s_add_u32 s73, s73, s52
  s_lshl_b32 s72, s59, 7
  s_add_u32 s72, s72, s73
  s_lshl_b32 s72, s72, 11
  s_add_u32 s72, s72, 46137344
  s_lshl_b32 s73, s73, 10
  s_add_u32 s73, s73, s66
  s_add_u32 s73, s73, 1572864
  s_add_u32 s59, s59, 2
  buffer_load_dwordx4 v[128:131], v216, s[8:11], s55 offen offset:0 sc1
  buffer_load_dwordx4 v[132:135], v216, s[8:11], s55 offen offset:256 sc1
  buffer_load_dwordx4 v[136:139], v216, s[8:11], s55 offen offset:512 sc1
  buffer_load_dwordx4 v[140:143], v216, s[8:11], s55 offen offset:768 sc1
  buffer_load_dwordx4 v[144:147], v216, s[8:11], s55 offen offset:1024 sc1
  buffer_load_dwordx4 v[148:151], v216, s[8:11], s55 offen offset:1280 sc1
  buffer_load_dwordx4 v[152:155], v216, s[8:11], s55 offen offset:1536 sc1
  buffer_load_dwordx4 v[156:159], v216, s[8:11], s55 offen offset:1792 sc1
  buffer_load_dwordx4 v[160:163], v217, s[8:11], s55 offen offset:0 sc1
  buffer_load_dwordx4 v[164:167], v217, s[8:11], s55 offen offset:256 sc1
  s_add_u32 s60, s60, 73728
  ds_read_b128 v[32:35], v203 offset:0
  ds_read_b128 v[36:39], v204 offset:0
  ds_read_b128 v[40:43], v205 offset:0
  s_waitcnt lgkmcnt(2)
  v_mfma_f32_32x32x16_bf16 v[240:255], a[0:3], v[32:35], 0
  ds_read_b128 v[44:47], v206 offset:0
  s_add_u32 m0, s67, 36864
  s_nop 0
  buffer_load_dwordx4 v202, s[4:7], s60 offen offset:0 lds
  s_waitcnt lgkmcnt(2)
  v_mfma_f32_32x32x16_bf16 v[240:255], a[4:7], v[36:39], v[240:255]
  ds_read_b128 v[32:35], v203 offset:1024
  s_waitcnt lgkmcnt(2)
  v_mfma_f32_32x32x16_bf16 v[240:255], a[8:11], v[40:43], v[240:255]
  ds_read_b128 v[36:39], v204 offset:1024
  s_add_u32 m0, s67, 37760
  s_nop 0
  buffer_load_dwordx4 v202, s[4:7], s60 offen offset:128 lds
  s_waitcnt lgkmcnt(2)
  v_mfma_f32_32x32x16_bf16 v[240:255], a[12:15], v[44:47], v[240:255]
  ds_read_b128 v[40:43], v205 offset:1024
  s_waitcnt lgkmcnt(2)
  v_mfma_f32_32x32x16_bf16 v[240:255], a[16:19], v[32:35], v[240:255]
  ds_read_b128 v[44:47], v206 offset:1024
  s_add_u32 m0, s67, 38656
  s_nop 0
  buffer_load_dwordx4 v202, s[4:7], s60 offen offset:256 lds
  s_waitcnt lgkmcnt(2)
  v_mfma_f32_32x32x16_bf16 v[240:255], a[20:23], v[36:39], v[240:255]
  ds_read_b128 v[32:35], v203 offset:2048
  s_waitcnt lgkmcnt(2)
  v_mfma_f32_32x32x16_bf16 v[240:255], a[24:27], v[40:43], v[240:255]
  ds_read_b128 v[36:39], v204 offset:2048
  s_add_u32 m0, s67, 39552
  s_nop 0
  buffer_load_dwordx4 v202, s[4:7], s60 offen offset:384 lds
  s_waitcnt lgkmcnt(2)
  v_mfma_f32_32x32x16_bf16 v[240:255], a[28:31], v[44:47], v[240:255]
  ds_read_b128 v[40:43], v205 offset:2048
  s_waitcnt lgkmcnt(2)
  v_mfma_f32_32x32x16_bf16 v[240:255], a[32:35], v[32:35], v[240:255]
  ds_read_b128 v[44:47], v206 offset:2048
  s_add_u32 m0, s67, 40448
  s_nop 0
  buffer_load_dwordx4 v202, s[4:7], s60 offen offset:512 lds
  s_waitcnt lgkmcnt(2)
  v_mfma_f32_32x32x16_bf16 v[240:255], a[36:39], v[36:39], v[240:255]
  ds_read_b128 v[32:35], v203 offset:3072
  s_waitcnt lgkmcnt(2)
  v_mfma_f32_32x32x16_bf16 v[240:255], a[40:43], v[40:43], v[240:255]
  ds_read_b128 v[36:39], v204 offset:3072
  s_add_u32 m0, s67, 41344
  s_nop 0
  buffer_load_dwordx4 v202, s[4:7], s60 offen offset:640 lds
  s_waitcnt lgkmcnt(2)
  v_mfma_f32_32x32x16_bf16 v[240:255], a[44:47], v[44:47], v[240:255]
  ds_read_b128 v[40:43], v205 offset:3072
  s_waitcnt lgkmcnt(2)
  v_mfma_f32_32x32x16_bf16 v[240:255], a[48:51], v[32:35], v[240:255]
  ds_read_b128 v[44:47], v206 offset:3072
  s_add_u32 m0, s67, 42240
  s_nop 0
  buffer_load_dwordx4 v202, s[4:7], s60 offen offset:768 lds
  s_waitcnt lgkmcnt(2)
  v_mfma_f32_32x32x16_bf16 v[240:255], a[52:55], v[36:39], v[240:255]
  ds_read_b128 v[32:35], v203 offset:4096
  s_waitcnt lgkmcnt(2)
  v_mfma_f32_32x32x16_bf16 v[240:255], a[56:59], v[40:43], v[240:255]
  ds_read_b128 v[36:39], v204 offset:4096
  s_add_u32 m0, s67, 43136
  s_nop 0
  buffer_load_dwordx4 v202, s[4:7], s60 offen offset:896 lds
  s_waitcnt lgkmcnt(2)
  v_mfma_f32_32x32x16_bf16 v[240:255], a[60:63], v[44:47], v[240:255]
  ds_read_b128 v[40:43], v205 offset:4096
  s_waitcnt lgkmcnt(2)
  v_mfma_f32_32x32x16_bf16 v[240:255], a[64:67], v[32:35], v[240:255]
  ds_read_b128 v[44:47], v206 offset:4096
  s_add_u32 m0, s67, 44032
  s_nop 0
  buffer_load_dwordx4 v202, s[4:7], s60 offen offset:1024 lds
  s_waitcnt lgkmcnt(2)
  v_mfma_f32_32x32x16_bf16 v[240:255], a[68:71], v[36:39], v[240:255]
  ds_read_b128 v[32:35], v203 offset:5120
  s_waitcnt lgkmcnt(2)
  v_mfma_f32_32x32x16_bf16 v[240:255], a[72:75], v[40:43], v[240:255]
  ds_read_b128 v[36:39], v204 offset:5120
  buffer_store_dwordx4 v[176:179], v201, s[8:11], s72 offen offset:0 sc1
  s_waitcnt lgkmcnt(2)
  v_mfma_f32_32x32x16_bf16 v[240:255], a[76:79], v[44:47], v[240:255]
  ds_read_b128 v[40:43], v205 offset:5120
  s_waitcnt lgkmcnt(2)
  v_mfma_f32_32x32x16_bf16 v[240:255], a[80:83], v[32:35], v[240:255]
  ds_read_b128 v[44:47], v206 offset:5120
  buffer_store_dwordx4 v[176:179], v201, s[8:11], s72 offen offset:1024 sc1
  s_waitcnt lgkmcnt(2)
  v_mfma_f32_32x32x16_bf16 v[240:255], a[84:87], v[36:39], v[240:255]
  ds_read_b128 v[32:35], v203 offset:6144
  s_waitcnt lgkmcnt(2)
  v_mfma_f32_32x32x16_bf16 v[240:255], a[88:91], v[40:43], v[240:255]
  ds_read_b128 v[36:39], v204 offset:6144
  s_waitcnt lgkmcnt(2)
  v_mfma_f32_32x32x16_bf16 v[240:255], a[92:95], v[44:47], v[240:255]
  ds_read_b128 v[40:43], v205 offset:6144
  s_waitcnt lgkmcnt(2)
  v_mfma_f32_32x32x16_bf16 v[240:255], a[96:99], v[32:35], v[240:255]
  ds_read_b128 v[44:47], v206 offset:6144
  s_waitcnt lgkmcnt(2)
  v_mfma_f32_32x32x16_bf16 v[240:255], a[100:103], v[36:39], v[240:255]
  ds_read_b128 v[32:35], v203 offset:7168
  s_waitcnt lgkmcnt(2)
  v_mfma_f32_32x32x16_bf16 v[240:255], a[104:107], v[40:43], v[240:255]
  ds_read_b128 v[36:39], v204 offset:7168
  s_waitcnt lgkmcnt(2)
  v_mfma_f32_32x32x16_bf16 v[240:255], a[108:111], v[44:47], v[240:255]
  ds_read_b128 v[40:43], v205 offset:7168
  s_waitcnt lgkmcnt(2)
  v_mfma_f32_32x32x16_bf16 v[240:255], a[112:115], v[32:35], v[240:255]
  ds_read_b128 v[44:47], v206 offset:7168
  s_waitcnt lgkmcnt(2)
  v_mfma_f32_32x32x16_bf16 v[240:255], a[116:119], v[36:39], v[240:255]
  ds_read_b128 v[32:35], v203 offset:8192
  s_waitcnt lgkmcnt(2)
  v_mfma_f32_32x32x16_bf16 v[240:255], a[120:123], v[40:43], v[240:255]
  ds_read_b128 v[36:39], v204 offset:8192
  s_waitcnt lgkmcnt(2)
  v_mfma_f32_32x32x16_bf16 v[240:255], a[124:127], v[44:47], v[240:255]
  ds_read_b128 v[40:43], v205 offset:8192
  s_waitcnt lgkmcnt(2)
  v_mfma_f32_32x32x16_bf16 v[240:255], a[128:131], v[32:35], v[240:255]
  ds_read_b128 v[44:47], v206 offset:8192
  s_waitcnt lgkmcnt(2)
  v_mfma_f32_32x32x16_bf16 v[240:255], a[132:135], v[36:39], v[240:255]
  s_waitcnt lgkmcnt(1)
  v_mfma_f32_32x32x16_bf16 v[240:255], a[136:139], v[40:43], v[240:255]
  s_waitcnt lgkmcnt(0)
  v_mfma_f32_32x32x16_bf16 v[240:255], a[140:143], v[44:47], v[240:255]
  s_nop 11
  v_cvt_pk_bf16_f32 v16, v240, v244
  v_cvt_pk_bf16_f32 v17, v241, v245
  v_cvt_pk_bf16_f32 v18, v242, v246
  v_cvt_pk_bf16_f32 v19, v243, v247
  ds_write_b128 v215, v[16:19] offset:0
  v_cvt_pk_bf16_f32 v20, v248, v252
  v_cvt_pk_bf16_f32 v21, v249, v253
  v_cvt_pk_bf16_f32 v22, v250, v254
  v_cvt_pk_bf16_f32 v23, v251, v255
  ds_write_b128 v215, v[20:23] offset:1024
  s_waitcnt lgkmcnt(0)
  s_barrier
  ds_read_b128 v[96:99], v208 offset:0
  ds_read_b128 v[100:103], v208 offset:1024
  ds_read_b128 v[104:107], v208 offset:2048
  ds_read_b128 v[108:111], v208 offset:3072
  ds_read_b128 v[112:115], v208 offset:4096
  ds_read_b128 v[116:119], v208 offset:5120
  ds_read_b128 v[120:123], v208 offset:6144
  ds_read_b128 v[124:127], v208 offset:7168
  s_waitcnt vmcnt(20) lgkmcnt(7)
  v_mfma_f32_32x32x16_bf16 v[64:79], v[128:131], v[96:99], v[48:63]
  s_waitcnt vmcnt(19) lgkmcnt(6)
  v_mfma_f32_32x32x16_bf16 v[64:79], v[132:135], v[100:103], v[64:79]
  s_waitcnt vmcnt(18) lgkmcnt(5)
  v_mfma_f32_32x32x16_bf16 v[64:79], v[136:139], v[104:107], v[64:79]
  s_waitcnt vmcnt(17) lgkmcnt(4)
  v_mfma_f32_32x32x16_bf16 v[64:79], v[140:143], v[108:111], v[64:79]
  s_waitcnt vmcnt(16) lgkmcnt(3)
  v_mfma_f32_32x32x16_bf16 v[64:79], v[144:147], v[112:115], v[64:79]
  s_waitcnt vmcnt(15) lgkmcnt(2)
  v_mfma_f32_32x32x16_bf16 v[64:79], v[148:151], v[116:119], v[64:79]
  s_waitcnt vmcnt(14) lgkmcnt(1)
  v_mfma_f32_32x32x16_bf16 v[64:79], v[152:155], v[120:123], v[64:79]
  s_waitcnt vmcnt(13) lgkmcnt(0)
  v_mfma_f32_32x32x16_bf16 v[64:79], v[156:159], v[124:127], v[64:79]
  s_nop 11
  v_max3_f32 v180, v64, v65, v66
  v_max3_f32 v180, v180, v67, v68
  v_max3_f32 v180, v180, v69, v70
  v_max3_f32 v180, v180, v71, v72
  v_max3_f32 v180, v180, v73, v74
  v_max3_f32 v180, v180, v75, v76
  v_max3_f32 v180, v180, v77, v78
  v_max_f32 v180, v180, v79
  v_mov_b32 v181, v180
  s_nop 1
  v_permlane32_swap_b32 v180, v181
  v_max_f32 v180, v180, v181
  v_sub_f32 v64, v64, v180
  v_sub_f32 v65, v65, v180
  v_sub_f32 v66, v66, v180
  v_sub_f32 v67, v67, v180
  v_sub_f32 v68, v68, v180
  v_sub_f32 v69, v69, v180
  v_sub_f32 v70, v70, v180
  v_sub_f32 v71, v71, v180
  v_sub_f32 v72, v72, v180
  v_sub_f32 v73, v73, v180
  v_sub_f32 v74, v74, v180
  v_sub_f32 v75, v75, v180
  v_sub_f32 v76, v76, v180
  v_sub_f32 v77, v77, v180
  v_sub_f32 v78, v78, v180
  v_sub_f32 v79, v79, v180
  v_exp_f32 v64, v64
  v_exp_f32 v65, v65
  v_exp_f32 v66, v66
  v_exp_f32 v67, v67
  v_exp_f32 v68, v68
  v_exp_f32 v69, v69
  v_exp_f32 v70, v70
  v_exp_f32 v71, v71
  v_exp_f32 v72, v72
  v_exp_f32 v73, v73
  v_exp_f32 v74, v74
  v_exp_f32 v75, v75
  v_exp_f32 v76, v76
  v_exp_f32 v77, v77
  v_exp_f32 v78, v78
  v_exp_f32 v79, v79
  v_cvt_pk_bf16_f32 v20, v64, v65
  v_cvt_pk_bf16_f32 v21, v68, v69
  v_cvt_pk_bf16_f32 v22, v72, v73
  v_cvt_pk_bf16_f32 v23, v76, v77
  v_cvt_pk_bf16_f32 v24, v66, v67
  v_cvt_pk_bf16_f32 v25, v70, v71
  v_cvt_pk_bf16_f32 v26, v74, v75
  v_cvt_pk_bf16_f32 v27, v78, v79
  s_waitcnt vmcnt(12)
  v_mfma_f32_32x32x16_bf16 v[0:15], v[160:163], v[20:23], 0
  v_add_f32 v182, v64, v65
  v_add_f32 v182, v182, v66
  v_add_f32 v182, v182, v67
  v_add_f32 v182, v182, v68
  v_add_f32 v182, v182, v69
  v_add_f32 v182, v182, v70
  v_add_f32 v182, v182, v71
  s_waitcnt vmcnt(11)
  v_mfma_f32_32x32x16_bf16 v[0:15], v[164:167], v[24:27], v[0:15]
  v_add_f32 v182, v182, v72
  v_add_f32 v182, v182, v73
  v_add_f32 v182, v182, v74
  v_add_f32 v182, v182, v75
  v_add_f32 v182, v182, v76
  v_add_f32 v182, v182, v77
  v_add_f32 v182, v182, v78
  v_add_f32 v182, v182, v79
  s_waitcnt vmcnt(0)
  s_barrier
AT_loop:
  s_cmp_ge_u32 s59, 64
  s_cbranch_scc1 AT_l0
  s_mov_b32 s77, s59
  s_mul_i32 s66, s59, 655360
  s_lshl_b32 s55, s58, 14
  s_add_u32 s55, s55, s66
  s_add_u32 s55, s55, 1048576
  s_lshl_b32 s76, s58, 2
  s_add_u32 s76, s76, s52
  s_lshl_b32 s75, s59, 7
  s_add_u32 s75, s75, s76
  s_lshl_b32 s75, s75, 11
  s_add_u32 s75, s75, 46137344
  s_lshl_b32 s76, s76, 10
  s_add_u32 s76, s76, s66
  s_add_u32 s76, s76, 1572864
  s_add_u32 s59, s59, 2
  buffer_load_dwordx4 v[128:131], v216, s[8:11], s55 offen offset:0 sc1
  buffer_load_dwordx4 v[132:135], v216, s[8:11], s55 offen offset:256 sc1
  buffer_load_dwordx4 v[136:139], v216, s[8:11], s55 offen offset:512 sc1
  buffer_load_dwordx4 v[140:143], v216, s[8:11], s55 offen offset:768 sc1
  buffer_load_dwordx4 v[144:147], v216, s[8:11], s55 offen offset:1024 sc1
  buffer_load_dwordx4 v[148:151], v216, s[8:11], s55 offen offset:1280 sc1
  buffer_load_dwordx4 v[152:155], v216, s[8:11], s55 offen offset:1536 sc1
  buffer_load_dwordx4 v[156:159], v216, s[8:11], s55 offen offset:1792 sc1
  buffer_load_dwordx4 v[160:163], v217, s[8:11], s55 offen offset:0 sc1
  buffer_load_dwordx4 v[164:167], v217, s[8:11], s55 offen offset:256 sc1
  s_or_b32 s70, s73, 0xc00
  buffer_load_dword v172, off, s[8:11], s70 sc1
  s_add_u32 s60, s60, 73728
  ds_read_b128 v[32:35], v203 offset:36864
  ds_read_b128 v[36:39], v204 offset:36864
  ds_read_b128 v[40:43], v205 offset:36864
  s_waitcnt lgkmcnt(2)
  v_mfma_f32_32x32x16_bf16 v[240:255], a[0:3], v[32:35], 0
  ds_read_b128 v[44:47], v206 offset:36864
  s_add_u32 m0, s67, 0
  s_nop 0
  buffer_load_dwordx4 v202, s[4:7], s60 offen offset:0 lds
  s_waitcnt lgkmcnt(2)
  v_mfma_f32_32x32x16_bf16 v[240:255], a[4:7], v[36:39], v[240:255]
  ds_read_b128 v[32:35], v203 offset:37888
  s_waitcnt lgkmcnt(2)
  v_mfma_f32_32x32x16_bf16 v[240:255], a[8:11], v[40:43], v[240:255]
  ds_read_b128 v[36:39], v204 offset:37888
  s_add_u32 m0, s67, 896
  s_nop 0
  buffer_load_dwordx4 v202, s[4:7], s60 offen offset:128 lds
  s_waitcnt lgkmcnt(2)
  v_mfma_f32_32x32x16_bf16 v[240:255], a[12:15], v[44:47], v[240:255]
  ds_read_b128 v[40:43], v205 offset:37888
  s_waitcnt lgkmcnt(2)
  v_mfma_f32_32x32x16_bf16 v[240:255], a[16:19], v[32:35], v[240:255]
  ds_read_b128 v[44:47], v206 offset:37888
  s_add_u32 m0, s67, 1792
  s_nop 0
  buffer_load_dwordx4 v202, s[4:7], s60 offen offset:256 lds
  s_waitcnt lgkmcnt(2)
  v_mfma_f32_32x32x16_bf16 v[240:255], a[20:23], v[36:39], v[240:255]
  ds_read_b128 v[32:35], v203 offset:38912
  s_waitcnt lgkmcnt(2)
  v_mfma_f32_32x32x16_bf16 v[240:255], a[24:27], v[40:43], v[240:255]
  ds_read_b128 v[36:39], v204 offset:38912
  s_add_u32 m0, s67, 2688
  s_nop 0
  buffer_load_dwordx4 v202, s[4:7], s60 offen offset:384 lds
  s_waitcnt lgkmcnt(2)
  v_mfma_f32_32x32x16_bf16 v[240:255], a[28:31], v[44:47], v[240:255]
  ds_read_b128 v[40:43], v205 offset:38912
  s_waitcnt lgkmcnt(2)
  v_mfma_f32_32x32x16_bf16 v[240:255], a[32:35], v[32:35], v[240:255]
  ds_read_b128 v[44:47], v206 offset:38912
  s_add_u32 m0, s67, 3584
  s_nop 0
  buffer_load_dwordx4 v202, s[4:7], s60 offen offset:512 lds
  s_waitcnt lgkmcnt(2)
  v_mfma_f32_32x32x16_bf16 v[240:255], a[36:39], v[36:39], v[240:255]
  ds_read_b128 v[32:35], v203 offset:39936
  s_waitcnt lgkmcnt(2)
  v_mfma_f32_32x32x16_bf16 v[240:255], a[40:43], v[40:43], v[240:255]
  ds_read_b128 v[36:39], v204 offset:39936
  s_add_u32 m0, s67, 4480
  s_nop 0
  buffer_load_dwordx4 v202, s[4:7], s60 offen offset:640 lds
  s_waitcnt lgkmcnt(2)
  v_mfma_f32_32x32x16_bf16 v[240:255], a[44:47], v[44:47], v[240:255]
  ds_read_b128 v[40:43], v205 offset:39936
  s_waitcnt lgkmcnt(2)
  v_mfma_f32_32x32x16_bf16 v[240:255], a[48:51], v[32:35], v[240:255]
  ds_read_b128 v[44:47], v206 offset:39936
  s_add_u32 m0, s67, 5376
  s_nop 0
  buffer_load_dwordx4 v202, s[4:7], s60 offen offset:768 lds
  s_waitcnt lgkmcnt(2)
  v_mfma_f32_32x32x16_bf16 v[240:255], a[52:55], v[36:39], v[240:255]
  ds_read_b128 v[32:35], v203 offset:40960
  s_waitcnt lgkmcnt(2)
  v_mfma_f32_32x32x16_bf16 v[240:255], a[56:59], v[40:43], v[240:255]
  ds_read_b128 v[36:39], v204 offset:40960
  s_add_u32 m0, s67, 6272
  s_nop 0
  buffer_load_dwordx4 v202, s[4:7], s60 offen offset:896 lds
  s_waitcnt lgkmcnt(2)
  v_mfma_f32_32x32x16_bf16 v[240:255], a[60:63], v[44:47], v[240:255]
  ds_read_b128 v[40:43], v205 offset:40960
  s_waitcnt lgkmcnt(2)
  v_mfma_f32_32x32x16_bf16 v[240:255], a[64:67], v[32:35], v[240:255]
  ds_read_b128 v[44:47], v206 offset:40960
  s_add_u32 m0, s67, 7168
  s_nop 0
  buffer_load_dwordx4 v202, s[4:7], s60 offen offset:1024 lds
  s_waitcnt lgkmcnt(2)
  v_mfma_f32_32x32x16_bf16 v[240:255], a[68:71], v[36:39], v[240:255]
  ds_read_b128 v[32:35], v203 offset:41984
  s_waitcnt lgkmcnt(2)
  v_mfma_f32_32x32x16_bf16 v[240:255], a[72:75], v[40:43], v[240:255]
  ds_read_b128 v[36:39], v204 offset:41984
  buffer_store_dwordx4 v[176:179], v201, s[8:11], s75 offen offset:0 sc1
  s_waitcnt lgkmcnt(2)
  v_mfma_f32_32x32x16_bf16 v[240:255], a[76:79], v[44:47], v[240:255]
  ds_read_b128 v[40:43], v205 offset:41984
  s_waitcnt lgkmcnt(2)
  v_mfma_f32_32x32x16_bf16 v[240:255], a[80:83], v[32:35], v[240:255]
  ds_read_b128 v[44:47], v206 offset:41984
  buffer_store_dwordx4 v[176:179], v201, s[8:11], s75 offen offset:1024 sc1
  s_waitcnt lgkmcnt(2)
  v_mfma_f32_32x32x16_bf16 v[240:255], a[84:87], v[36:39], v[240:255]
  ds_read_b128 v[32:35], v203 offset:43008
  s_waitcnt lgkmcnt(2)
  v_mfma_f32_32x32x16_bf16 v[240:255], a[88:91], v[40:43], v[240:255]
  ds_read_b128 v[36:39], v204 offset:43008
  s_waitcnt lgkmcnt(2)
  v_mfma_f32_32x32x16_bf16 v[240:255], a[92:95], v[44:47], v[240:255]
  ds_read_b128 v[40:43], v205 offset:43008
  s_waitcnt lgkmcnt(2)
  v_mfma_f32_32x32x16_bf16 v[240:255], a[96:99], v[32:35], v[240:255]
  ds_read_b128 v[44:47], v206 offset:43008
  s_waitcnt lgkmcnt(2)
  v_mfma_f32_32x32x16_bf16 v[240:255], a[100:103], v[36:39], v[240:255]
  ds_read_b128 v[32:35], v203 offset:44032
  s_waitcnt lgkmcnt(2)
  v_mfma_f32_32x32x16_bf16 v[240:255], a[104:107], v[40:43], v[240:255]
  ds_read_b128 v[36:39], v204 offset:44032
  s_waitcnt lgkmcnt(2)
  v_mfma_f32_32x32x16_bf16 v[240:255], a[108:111], v[44:47], v[240:255]
  ds_read_b128 v[40:43], v205 offset:44032
  s_waitcnt lgkmcnt(2)
  v_mfma_f32_32x32x16_bf16 v[240:255], a[112:115], v[32:35], v[240:255]
  ds_read_b128 v[44:47], v206 offset:44032
  s_waitcnt lgkmcnt(2)
  v_mfma_f32_32x32x16_bf16 v[240:255], a[116:119], v[36:39], v[240:255]
  ds_read_b128 v[32:35], v203 offset:45056
  s_waitcnt lgkmcnt(2)
  v_mfma_f32_32x32x16_bf16 v[240:255], a[120:123], v[40:43], v[240:255]
  ds_read_b128 v[36:39], v204 offset:45056
  s_waitcnt lgkmcnt(2)
  v_mfma_f32_32x32x16_bf16 v[240:255], a[124:127], v[44:47], v[240:255]
  ds_read_b128 v[40:43], v205 offset:45056
  s_waitcnt lgkmcnt(2)
  v_mfma_f32_32x32x16_bf16 v[240:255], a[128:131], v[32:35], v[240:255]
  ds_read_b128 v[44:47], v206 offset:45056
  s_waitcnt lgkmcnt(2)
  v_mfma_f32_32x32x16_bf16 v[240:255], a[132:135], v[36:39], v[240:255]
  s_waitcnt lgkmcnt(1)
  v_mfma_f32_32x32x16_bf16 v[240:255], a[136:139], v[40:43], v[240:255]
  s_waitcnt lgkmcnt(0)
  v_mfma_f32_32x32x16_bf16 v[240:255], a[140:143], v[44:47], v[240:255]
  s_nop 11
  v_cvt_pk_bf16_f32 v16, v240, v244
  v_cvt_pk_bf16_f32 v17, v241, v245
  v_cvt_pk_bf16_f32 v18, v242, v246
  v_cvt_pk_bf16_f32 v19, v243, v247
  ds_write_b128 v215, v[16:19] offset:0
  v_cvt_pk_bf16_f32 v20, v248, v252
  v_cvt_pk_bf16_f32 v21, v249, v253
  v_cvt_pk_bf16_f32 v22, v250, v254
  v_cvt_pk_bf16_f32 v23, v251, v255
  ds_write_b128 v215, v[20:23] offset:1024
  s_waitcnt lgkmcnt(0)
  s_barrier
  ds_read_b128 a[144:147], v208 offset:0
  ds_read_b128 a[148:151], v208 offset:1024
  ds_read_b128 a[152:155], v208 offset:2048
  ds_read_b128 a[156:159], v208 offset:3072
  ds_read_b128 a[160:163], v208 offset:4096
  ds_read_b128 a[164:167], v208 offset:5120
  ds_read_b128 a[168:171], v208 offset:6144
  ds_read_b128 a[172:175], v208 offset:7168
  s_waitcnt vmcnt(11)
  v_cmp_eq_u32 vcc, -1, v172
  s_mov_b32 s69, 0
  s_cbranch_vccnz AT_e1
  s_mov_b32 s69, 1
  buffer_load_dwordx4 v[172:175], v201, s[8:11], s73 offen sc1
AT_e1:
  s_waitcnt lgkmcnt(7)
  v_mfma_f32_32x32x16_bf16 v[64:79], v[128:131], a[144:147], v[48:63]
  s_waitcnt lgkmcnt(6)
  v_mfma_f32_32x32x16_bf16 v[64:79], v[132:135], a[148:151], v[64:79]
  s_waitcnt lgkmcnt(5)
  v_mfma_f32_32x32x16_bf16 v[64:79], v[136:139], a[152:155], v[64:79]
  s_waitcnt lgkmcnt(4)
  v_mfma_f32_32x32x16_bf16 v[64:79], v[140:143], a[156:159], v[64:79]
  s_waitcnt lgkmcnt(3)
  v_mfma_f32_32x32x16_bf16 v[64:79], v[144:147], a[160:163], v[64:79]
  s_waitcnt lgkmcnt(2)
  v_mfma_f32_32x32x16_bf16 v[64:79], v[148:151], a[164:167], v[64:79]
  s_waitcnt lgkmcnt(1)
  v_mfma_f32_32x32x16_bf16 v[64:79], v[152:155], a[168:171], v[64:79]
  s_waitcnt lgkmcnt(0)
  v_mfma_f32_32x32x16_bf16 v[64:79], v[156:159], a[172:175], v[64:79]
  s_nop 11
  v_max3_f32 v184, v64, v65, v66
  v_max3_f32 v184, v184, v67, v68
  v_max3_f32 v184, v184, v69, v70
  v_max3_f32 v184, v184, v71, v72
  v_max3_f32 v184, v184, v73, v74
  v_max3_f32 v184, v184, v75, v76
  v_max3_f32 v184, v184, v77, v78
  v_max_f32 v184, v184, v79
  v_mov_b32 v185, v184
  s_nop 1
  v_permlane32_swap_b32 v184, v185
  v_max_f32 v184, v184, v185
  v_sub_f32 v64, v64, v184
  v_sub_f32 v65, v65, v184
  v_sub_f32 v66, v66, v184
  v_sub_f32 v67, v67, v184
  v_sub_f32 v68, v68, v184
  v_sub_f32 v69, v69, v184
  v_sub_f32 v70, v70, v184
  v_sub_f32 v71, v71, v184
  v_sub_f32 v72, v72, v184
  v_sub_f32 v73, v73, v184
  v_sub_f32 v74, v74, v184
  v_sub_f32 v75, v75, v184
  v_sub_f32 v76, v76, v184
  v_sub_f32 v77, v77, v184
  v_sub_f32 v78, v78, v184
  v_sub_f32 v79, v79, v184
  v_exp_f32 v64, v64
  v_exp_f32 v65, v65
  v_exp_f32 v66, v66
  v_exp_f32 v67, v67
  v_exp_f32 v68, v68
  v_exp_f32 v69, v69
  v_exp_f32 v70, v70
  v_exp_f32 v71, v71
  v_exp_f32 v72, v72
  v_exp_f32 v73, v73
  v_exp_f32 v74, v74
  v_exp_f32 v75, v75
  v_exp_f32 v76, v76
  v_exp_f32 v77, v77
  v_exp_f32 v78, v78
  v_exp_f32 v79, v79
  v_cvt_pk_bf16_f32 v20, v64, v65
  v_cvt_pk_bf16_f32 v21, v68, v69
  v_cvt_pk_bf16_f32 v22, v72, v73
  v_cvt_pk_bf16_f32 v23, v76, v77
  v_cvt_pk_bf16_f32 v24, v66, v67
  v_cvt_pk_bf16_f32 v25, v70, v71
  v_cvt_pk_bf16_f32 v26, v74, v75
  v_cvt_pk_bf16_f32 v27, v78, v79
  v_mfma_f32_32x32x16_bf16 v[224:239], v[160:163], v[20:23], 0
  v_add_f32 v186, v64, v65
  v_add_f32 v186, v186, v66
  v_add_f32 v186, v186, v67
  v_add_f32 v186, v186, v68
  v_add_f32 v186, v186, v69
  v_add_f32 v186, v186, v70
  v_add_f32 v186, v186, v71
  v_mfma_f32_32x32x16_bf16 v[224:239], v[164:167], v[24:27], v[224:239]
  v_add_f32 v186, v186, v72
  v_add_f32 v186, v186, v73
  v_add_f32 v186, v186, v74
  v_add_f32 v186, v186, v75
  v_add_f32 v186, v186, v76
  v_add_f32 v186, v186, v77
  v_add_f32 v186, v186, v78
  v_add_f32 v186, v186, v79
AT_l0:
  s_cmp_eq_u32 s69, 1
  s_cbranch_scc1 AT_v0
  s_cmp_ge_u32 s74, 62
  s_cbranch_scc1 AT_k0
  s_branch AT_c0
AT_h0:
  s_sleep 2
AT_c0:
  buffer_load_dword v172, off, s[8:11], s70 sc1
  s_add_u32 s65, s65, 1
  s_cmp_lt_u32 s65, 131072
  s_cselect_b32 s54, -2, -1
  s_waitcnt vmcnt(0)
  v_cmp_lt_u32 vcc, s54, v172
  s_cbranch_vccnz AT_h0
AT_k0:
  buffer_load_dwordx4 v[172:175], v201, s[8:11], s73 offen sc1
AT_v0:
  s_mov_b32 s69, 0
  s_add_u32 s65, s65, 1
  s_cmp_lt_u32 s65, 131072
  s_cselect_b32 s54, -2, -1
  s_waitcnt vmcnt(0)
  ds_write_b64 v220, v[172:173] offset:0
  ds_write_b64 v221, v[174:175] offset:0
  v_max3_u32 v213, v172, v173, v174
  v_max_u32 v213, v213, v175
  v_cmp_lt_u32 vcc, s54, v213
  s_cbranch_vccnz AT_k0
  s_waitcnt lgkmcnt(0)
  s_barrier
  ds_read_b128 v[128:131], v218 offset:0
  ds_read_b128 v[132:135], v218 offset:256
  ds_read_b128 v[136:139], v218 offset:512
  ds_read_b128 v[140:143], v218 offset:768
  ds_read_b128 v[144:147], v218 offset:1024
  ds_read_b128 v[148:151], v218 offset:1280
  ds_read_b128 v[152:155], v218 offset:1536
  ds_read_b128 v[156:159], v218 offset:1792
  ds_read_b32 v168, v219 offset:0
  ds_read_b32 v169, v219 offset:128
  s_waitcnt lgkmcnt(9)
  v_mfma_f32_32x32x16_bf16 v[80:95], v[128:131], v[96:99], 0
  s_waitcnt lgkmcnt(8)
  v_mfma_f32_32x32x16_bf16 v[80:95], v[132:135], v[100:103], v[80:95]
  s_waitcnt lgkmcnt(7)
  v_mfma_f32_32x32x16_bf16 v[80:95], v[136:139], v[104:107], v[80:95]
  s_waitcnt lgkmcnt(6)
  v_mfma_f32_32x32x16_bf16 v[80:95], v[140:143], v[108:111], v[80:95]
  s_waitcnt lgkmcnt(5)
  v_mfma_f32_32x32x16_bf16 v[80:95], v[144:147], v[112:115], v[80:95]
  s_waitcnt lgkmcnt(4)
  v_mfma_f32_32x32x16_bf16 v[80:95], v[148:151], v[116:119], v[80:95]
  s_waitcnt lgkmcnt(3)
  v_mfma_f32_32x32x16_bf16 v[80:95], v[152:155], v[120:123], v[80:95]
  s_waitcnt lgkmcnt(2)
  v_mfma_f32_32x32x16_bf16 v[80:95], v[156:159], v[124:127], v[80:95]
  s_add_u32 s74, s74, 2
  v_mov_b32 v212, s74
  s_nop 9
  v_mul_f32 v80, s68, v80
  v_mul_f32 v81, s68, v81
  v_mul_f32 v82, s68, v82
  v_mul_f32 v83, s68, v83
  v_max3_f32 v84, v180, v80, v81
  v_max3_f32 v84, v84, v82, v83
  v_mov_b32 v85, v84
  s_nop 1
  v_permlane32_swap_b32 v84, v85
  v_max_f32 v84, v84, v85
  v_sub_f32 v86, v180, v84
  v_sub_f32 v80, v80, v84
  v_sub_f32 v81, v81, v84
  v_sub_f32 v82, v82, v84
  v_sub_f32 v83, v83, v84
  v_exp_f32 v86, v86
  v_exp_f32 v80, v80
  v_exp_f32 v81, v81
  v_exp_f32 v82, v82
  v_exp_f32 v83, v83
  v_fma_f32 v182, v182, v86, v80
  v_add_f32 v84, v81, v82
  v_add_f32 v182, v182, v83
  v_add_f32 v182, v182, v84
  v_mov_b32 v183, v182
  s_nop 1
  v_permlane32_swap_b32 v182, v183
  v_add_f32 v182, v182, v183
  v_rcp_f32 v182, v182
  s_nop 0
  v_mul_f32 v86, v86, v182
  v_mul_f32 v80, v182, v80
  v_mul_f32 v81, v182, v81
  v_mul_f32 v82, v182, v82
  v_mul_f32 v83, v182, v83
  v_cvt_pk_bf16_f32 v28, v80, v81
  v_cvt_pk_bf16_f32 v29, v82, v83
  v_mul_f32 v0, v86, v0
  v_mul_f32 v1, v86, v1
  v_mul_f32 v2, v86, v2
  v_mul_f32 v3, v86, v3
  v_mul_f32 v4, v86, v4
  v_mul_f32 v5, v86, v5
  v_mul_f32 v6, v86, v6
  v_mul_f32 v7, v86, v7
  v_mul_f32 v8, v86, v8
  v_mul_f32 v9, v86, v9
  v_mul_f32 v10, v86, v10
  v_mul_f32 v11, v86, v11
  v_mul_f32 v12, v86, v12
  v_mul_f32 v13, v86, v13
  v_mul_f32 v14, v86, v14
  v_mul_f32 v15, v86, v15
  s_waitcnt lgkmcnt(0)
  s_nop 0
  v_mfma_f32_32x32x8_bf16 v[0:15], v[168:169], v[28:29], v[0:15]
  s_nop 11
  v_cvt_pk_bf16_f32 v20, v0, v1
  v_cvt_pk_bf16_f32 v21, v2, v3
  v_cvt_pk_bf16_f32 v22, v4, v5
  v_cvt_pk_bf16_f32 v23, v6, v7
  buffer_store_dwordx4 v[20:23], v201, s[8:11], s72 offen offset:0 sc1
  v_cvt_pk_bf16_f32 v24, v8, v9
  v_cvt_pk_bf16_f32 v25, v10, v11
  v_cvt_pk_bf16_f32 v26, v12, v13
  v_cvt_pk_bf16_f32 v27, v14, v15
  buffer_store_dwordx4 v[24:27], v201, s[8:11], s72 offen offset:1024 sc1
  s_mov_b64 exec, 1
  buffer_store_dword v212, v201, s[8:11], s71 offen sc1
  s_mov_b64 exec, -1
  s_cmp_ge_u32 s74, 64
  s_cbranch_scc1 L_exit
  s_cmp_ge_u32 s59, 64
  s_cbranch_scc1 AT_l1
  s_mov_b32 s74, s59
  s_mul_i32 s66, s59, 655360
  s_lshl_b32 s55, s58, 14
  s_add_u32 s55, s55, s66
  s_add_u32 s55, s55, 1048576
  s_lshl_b32 s73, s58, 2
  s_add_u32 s73, s73, s52
  s_lshl_b32 s72, s59, 7
  s_add_u32 s72, s72, s73
  s_lshl_b32 s72, s72, 11
  s_add_u32 s72, s72, 46137344
  s_lshl_b32 s73, s73, 10
  s_add_u32 s73, s73, s66
  s_add_u32 s73, s73, 1572864
  s_add_u32 s59, s59, 2
  buffer_load_dwordx4 v[128:131], v216, s[8:11], s55 offen offset:0 sc1
  buffer_load_dwordx4 v[132:135], v216, s[8:11], s55 offen offset:256 sc1
  buffer_load_dwordx4 v[136:139], v216, s[8:11], s55 offen offset:512 sc1
  buffer_load_dwordx4 v[140:143], v216, s[8:11], s55 offen offset:768 sc1
  buffer_load_dwordx4 v[144:147], v216, s[8:11], s55 offen offset:1024 sc1
  buffer_load_dwordx4 v[148:151], v216, s[8:11], s55 offen offset:1280 sc1
  buffer_load_dwordx4 v[152:155], v216, s[8:11], s55 offen offset:1536 sc1
  buffer_load_dwordx4 v[156:159], v216, s[8:11], s55 offen offset:1792 sc1
  buffer_load_dwordx4 v[160:163], v217, s[8:11], s55 offen offset:0 sc1
  buffer_load_dwordx4 v[164:167], v217, s[8:11], s55 offen offset:256 sc1
  s_or_b32 s70, s76, 0xc00
  buffer_load_dword v172, off, s[8:11], s70 sc1
  s_add_u32 s60, s60, 73728
  ds_read_b128 v[32:35], v203 offset:0
  ds_read_b128 v[36:39], v204 offset:0
  ds_read_b128 v[40:43], v205 offset:0
  s_waitcnt lgkmcnt(2)
  v_mfma_f32_32x32x16_bf16 v[240:255], a[0:3], v[32:35], 0
  ds_read_b128 v[44:47], v206 offset:0
  s_add_u32 m0, s67, 36864
  s_nop 0
  buffer_load_dwordx4 v202, s[4:7], s60 offen offset:0 lds
  s_waitcnt lgkmcnt(2)
  v_mfma_f32_32x32x16_bf16 v[240:255], a[4:7], v[36:39], v[240:255]
  ds_read_b128 v[32:35], v203 offset:1024
  s_waitcnt lgkmcnt(2)
  v_mfma_f32_32x32x16_bf16 v[240:255], a[8:11], v[40:43], v[240:255]
  ds_read_b128 v[36:39], v204 offset:1024
  s_add_u32 m0, s67, 37760
  s_nop 0
  buffer_load_dwordx4 v202, s[4:7], s60 offen offset:128 lds
  s_waitcnt lgkmcnt(2)
  v_mfma_f32_32x32x16_bf16 v[240:255], a[12:15], v[44:47], v[240:255]
  ds_read_b128 v[40:43], v205 offset:1024
  s_waitcnt lgkmcnt(2)
  v_mfma_f32_32x32x16_bf16 v[240:255], a[16:19], v[32:35], v[240:255]
  ds_read_b128 v[44:47], v206 offset:1024
  s_add_u32 m0, s67, 38656
  s_nop 0
  buffer_load_dwordx4 v202, s[4:7], s60 offen offset:256 lds
  s_waitcnt lgkmcnt(2)
  v_mfma_f32_32x32x16_bf16 v[240:255], a[20:23], v[36:39], v[240:255]
  ds_read_b128 v[32:35], v203 offset:2048
  s_waitcnt lgkmcnt(2)
  v_mfma_f32_32x32x16_bf16 v[240:255], a[24:27], v[40:43], v[240:255]
  ds_read_b128 v[36:39], v204 offset:2048
  s_add_u32 m0, s67, 39552
  s_nop 0
  buffer_load_dwordx4 v202, s[4:7], s60 offen offset:384 lds
  s_waitcnt lgkmcnt(2)
  v_mfma_f32_32x32x16_bf16 v[240:255], a[28:31], v[44:47], v[240:255]
  ds_read_b128 v[40:43], v205 offset:2048
  s_waitcnt lgkmcnt(2)
  v_mfma_f32_32x32x16_bf16 v[240:255], a[32:35], v[32:35], v[240:255]
  ds_read_b128 v[44:47], v206 offset:2048
  s_add_u32 m0, s67, 40448
  s_nop 0
  buffer_load_dwordx4 v202, s[4:7], s60 offen offset:512 lds
  s_waitcnt lgkmcnt(2)
  v_mfma_f32_32x32x16_bf16 v[240:255], a[36:39], v[36:39], v[240:255]
  ds_read_b128 v[32:35], v203 offset:3072
  s_waitcnt lgkmcnt(2)
  v_mfma_f32_32x32x16_bf16 v[240:255], a[40:43], v[40:43], v[240:255]
  ds_read_b128 v[36:39], v204 offset:3072
  s_add_u32 m0, s67, 41344
  s_nop 0
  buffer_load_dwordx4 v202, s[4:7], s60 offen offset:640 lds
  s_waitcnt lgkmcnt(2)
  v_mfma_f32_32x32x16_bf16 v[240:255], a[44:47], v[44:47], v[240:255]
  ds_read_b128 v[40:43], v205 offset:3072
  s_waitcnt lgkmcnt(2)
  v_mfma_f32_32x32x16_bf16 v[240:255], a[48:51], v[32:35], v[240:255]
  ds_read_b128 v[44:47], v206 offset:3072
  s_add_u32 m0, s67, 42240
  s_nop 0
  buffer_load_dwordx4 v202, s[4:7], s60 offen offset:768 lds
  s_waitcnt lgkmcnt(2)
  v_mfma_f32_32x32x16_bf16 v[240:255], a[52:55], v[36:39], v[240:255]
  ds_read_b128 v[32:35], v203 offset:4096
  s_waitcnt lgkmcnt(2)
  v_mfma_f32_32x32x16_bf16 v[240:255], a[56:59], v[40:43], v[240:255]
  ds_read_b128 v[36:39], v204 offset:4096
  s_add_u32 m0, s67, 43136
  s_nop 0
  buffer_load_dwordx4 v202, s[4:7], s60 offen offset:896 lds
  s_waitcnt lgkmcnt(2)
  v_mfma_f32_32x32x16_bf16 v[240:255], a[60:63], v[44:47], v[240:255]
  ds_read_b128 v[40:43], v205 offset:4096
  s_waitcnt lgkmcnt(2)
  v_mfma_f32_32x32x16_bf16 v[240:255], a[64:67], v[32:35], v[240:255]
  ds_read_b128 v[44:47], v206 offset:4096
  s_add_u32 m0, s67, 44032
  s_nop 0
  buffer_load_dwordx4 v202, s[4:7], s60 offen offset:1024 lds
  s_waitcnt lgkmcnt(2)
  v_mfma_f32_32x32x16_bf16 v[240:255], a[68:71], v[36:39], v[240:255]
  ds_read_b128 v[32:35], v203 offset:5120
  s_waitcnt lgkmcnt(2)
  v_mfma_f32_32x32x16_bf16 v[240:255], a[72:75], v[40:43], v[240:255]
  ds_read_b128 v[36:39], v204 offset:5120
  buffer_store_dwordx4 v[176:179], v201, s[8:11], s72 offen offset:0 sc1
  s_waitcnt lgkmcnt(2)
  v_mfma_f32_32x32x16_bf16 v[240:255], a[76:79], v[44:47], v[240:255]
  ds_read_b128 v[40:43], v205 offset:5120
  s_waitcnt lgkmcnt(2)
  v_mfma_f32_32x32x16_bf16 v[240:255], a[80:83], v[32:35], v[240:255]
  ds_read_b128 v[44:47], v206 offset:5120
  buffer_store_dwordx4 v[176:179], v201, s[8:11], s72 offen offset:1024 sc1
  s_waitcnt lgkmcnt(2)
  v_mfma_f32_32x32x16_bf16 v[240:255], a[84:87], v[36:39], v[240:255]
  ds_read_b128 v[32:35], v203 offset:6144
  s_waitcnt lgkmcnt(2)
  v_mfma_f32_32x32x16_bf16 v[240:255], a[88:91], v[40:43], v[240:255]
  ds_read_b128 v[36:39], v204 offset:6144
  s_waitcnt lgkmcnt(2)
  v_mfma_f32_32x32x16_bf16 v[240:255], a[92:95], v[44:47], v[240:255]
  ds_read_b128 v[40:43], v205 offset:6144
  s_waitcnt lgkmcnt(2)
  v_mfma_f32_32x32x16_bf16 v[240:255], a[96:99], v[32:35], v[240:255]
  ds_read_b128 v[44:47], v206 offset:6144
  s_waitcnt lgkmcnt(2)
  v_mfma_f32_32x32x16_bf16 v[240:255], a[100:103], v[36:39], v[240:255]
  ds_read_b128 v[32:35], v203 offset:7168
  s_waitcnt lgkmcnt(2)
  v_mfma_f32_32x32x16_bf16 v[240:255], a[104:107], v[40:43], v[240:255]
  ds_read_b128 v[36:39], v204 offset:7168
  s_waitcnt lgkmcnt(2)
  v_mfma_f32_32x32x16_bf16 v[240:255], a[108:111], v[44:47], v[240:255]
  ds_read_b128 v[40:43], v205 offset:7168
  s_waitcnt lgkmcnt(2)
  v_mfma_f32_32x32x16_bf16 v[240:255], a[112:115], v[32:35], v[240:255]
  ds_read_b128 v[44:47], v206 offset:7168
  s_waitcnt lgkmcnt(2)
  v_mfma_f32_32x32x16_bf16 v[240:255], a[116:119], v[36:39], v[240:255]
  ds_read_b128 v[32:35], v203 offset:8192
  s_waitcnt lgkmcnt(2)
  v_mfma_f32_32x32x16_bf16 v[240:255], a[120:123], v[40:43], v[240:255]
  ds_read_b128 v[36:39], v204 offset:8192
  s_waitcnt lgkmcnt(2)
  v_mfma_f32_32x32x16_bf16 v[240:255], a[124:127], v[44:47], v[240:255]
  ds_read_b128 v[40:43], v205 offset:8192
  s_waitcnt lgkmcnt(2)
  v_mfma_f32_32x32x16_bf16 v[240:255], a[128:131], v[32:35], v[240:255]
  ds_read_b128 v[44:47], v206 offset:8192
  s_waitcnt lgkmcnt(2)
  v_mfma_f32_32x32x16_bf16 v[240:255], a[132:135], v[36:39], v[240:255]
  s_waitcnt lgkmcnt(1)
  v_mfma_f32_32x32x16_bf16 v[240:255], a[136:139], v[40:43], v[240:255]
  s_waitcnt lgkmcnt(0)
  v_mfma_f32_32x32x16_bf16 v[240:255], a[140:143], v[44:47], v[240:255]
  s_nop 11
  v_cvt_pk_bf16_f32 v16, v240, v244
  v_cvt_pk_bf16_f32 v17, v241, v245
  v_cvt_pk_bf16_f32 v18, v242, v246
  v_cvt_pk_bf16_f32 v19, v243, v247
  ds_write_b128 v215, v[16:19] offset:0
  v_cvt_pk_bf16_f32 v20, v248, v252
  v_cvt_pk_bf16_f32 v21, v249, v253
  v_cvt_pk_bf16_f32 v22, v250, v254
  v_cvt_pk_bf16_f32 v23, v251, v255
  ds_write_b128 v215, v[20:23] offset:1024
  s_waitcnt lgkmcnt(0)
  s_barrier
  ds_read_b128 v[96:99], v208 offset:0
  ds_read_b128 v[100:103], v208 offset:1024
  ds_read_b128 v[104:107], v208 offset:2048
  ds_read_b128 v[108:111], v208 offset:3072
  ds_read_b128 v[112:115], v208 offset:4096
  ds_read_b128 v[116:119], v208 offset:5120
  ds_read_b128 v[120:123], v208 offset:6144
  ds_read_b128 v[124:127], v208 offset:7168
  s_waitcnt vmcnt(11)
  v_cmp_eq_u32 vcc, -1, v172
  s_mov_b32 s69, 0
  s_cbranch_vccnz AT_e0
  s_mov_b32 s69, 1
  buffer_load_dwordx4 v[172:175], v201, s[8:11], s76 offen sc1
AT_e0:
  s_waitcnt lgkmcnt(7)
  v_mfma_f32_32x32x16_bf16 v[64:79], v[128:131], v[96:99], v[48:63]
  s_waitcnt lgkmcnt(6)
  v_mfma_f32_32x32x16_bf16 v[64:79], v[132:135], v[100:103], v[64:79]
  s_waitcnt lgkmcnt(5)
  v_mfma_f32_32x32x16_bf16 v[64:79], v[136:139], v[104:107], v[64:79]
  s_waitcnt lgkmcnt(4)
  v_mfma_f32_32x32x16_bf16 v[64:79], v[140:143], v[108:111], v[64:79]
  s_waitcnt lgkmcnt(3)
  v_mfma_f32_32x32x16_bf16 v[64:79], v[144:147], v[112:115], v[64:79]
  s_waitcnt lgkmcnt(2)
  v_mfma_f32_32x32x16_bf16 v[64:79], v[148:151], v[116:119], v[64:79]
  s_waitcnt lgkmcnt(1)
  v_mfma_f32_32x32x16_bf16 v[64:79], v[152:155], v[120:123], v[64:79]
  s_waitcnt lgkmcnt(0)
  v_mfma_f32_32x32x16_bf16 v[64:79], v[156:159], v[124:127], v[64:79]
  s_nop 11
  v_max3_f32 v180, v64, v65, v66
  v_max3_f32 v180, v180, v67, v68
  v_max3_f32 v180, v180, v69, v70
  v_max3_f32 v180, v180, v71, v72
  v_max3_f32 v180, v180, v73, v74
  v_max3_f32 v180, v180, v75, v76
  v_max3_f32 v180, v180, v77, v78
  v_max_f32 v180, v180, v79
  v_mov_b32 v181, v180
  s_nop 1
  v_permlane32_swap_b32 v180, v181
  v_max_f32 v180, v180, v181
  v_sub_f32 v64, v64, v180
  v_sub_f32 v65, v65, v180
  v_sub_f32 v66, v66, v180
  v_sub_f32 v67, v67, v180
  v_sub_f32 v68, v68, v180
  v_sub_f32 v69, v69, v180
  v_sub_f32 v70, v70, v180
  v_sub_f32 v71, v71, v180
  v_sub_f32 v72, v72, v180
  v_sub_f32 v73, v73, v180
  v_sub_f32 v74, v74, v180
  v_sub_f32 v75, v75, v180
  v_sub_f32 v76, v76, v180
  v_sub_f32 v77, v77, v180
  v_sub_f32 v78, v78, v180
  v_sub_f32 v79, v79, v180
  v_exp_f32 v64, v64
  v_exp_f32 v65, v65
  v_exp_f32 v66, v66
  v_exp_f32 v67, v67
  v_exp_f32 v68, v68
  v_exp_f32 v69, v69
  v_exp_f32 v70, v70
  v_exp_f32 v71, v71
  v_exp_f32 v72, v72
  v_exp_f32 v73, v73
  v_exp_f32 v74, v74
  v_exp_f32 v75, v75
  v_exp_f32 v76, v76
  v_exp_f32 v77, v77
  v_exp_f32 v78, v78
  v_exp_f32 v79, v79
  v_cvt_pk_bf16_f32 v20, v64, v65
  v_cvt_pk_bf16_f32 v21, v68, v69
  v_cvt_pk_bf16_f32 v22, v72, v73
  v_cvt_pk_bf16_f32 v23, v76, v77
  v_cvt_pk_bf16_f32 v24, v66, v67
  v_cvt_pk_bf16_f32 v25, v70, v71
  v_cvt_pk_bf16_f32 v26, v74, v75
  v_cvt_pk_bf16_f32 v27, v78, v79
  v_mfma_f32_32x32x16_bf16 v[0:15], v[160:163], v[20:23], 0
  v_add_f32 v182, v64, v65
  v_add_f32 v182, v182, v66
  v_add_f32 v182, v182, v67
  v_add_f32 v182, v182, v68
  v_add_f32 v182, v182, v69
  v_add_f32 v182, v182, v70
  v_add_f32 v182, v182, v71
  v_mfma_f32_32x32x16_bf16 v[0:15], v[164:167], v[24:27], v[0:15]
  v_add_f32 v182, v182, v72
  v_add_f32 v182, v182, v73
  v_add_f32 v182, v182, v74
  v_add_f32 v182, v182, v75
  v_add_f32 v182, v182, v76
  v_add_f32 v182, v182, v77
  v_add_f32 v182, v182, v78
  v_add_f32 v182, v182, v79
AT_l1:
  s_cmp_eq_u32 s69, 1
  s_cbranch_scc1 AT_v1
  s_cmp_ge_u32 s77, 62
  s_cbranch_scc1 AT_k1
  s_branch AT_c1
AT_h1:
  s_sleep 2
AT_c1:
  buffer_load_dword v172, off, s[8:11], s70 sc1
  s_add_u32 s65, s65, 1
  s_cmp_lt_u32 s65, 131072
  s_cselect_b32 s54, -2, -1
  s_waitcnt vmcnt(0)
  v_cmp_lt_u32 vcc, s54, v172
  s_cbranch_vccnz AT_h1
AT_k1:
  buffer_load_dwordx4 v[172:175], v201, s[8:11], s76 offen sc1
AT_v1:
  s_mov_b32 s69, 0
  s_add_u32 s65, s65, 1
  s_cmp_lt_u32 s65, 131072
  s_cselect_b32 s54, -2, -1
  s_waitcnt vmcnt(0)
  ds_write_b64 v220, v[172:173] offset:4096
  ds_write_b64 v221, v[174:175] offset:4096
  v_max3_u32 v213, v172, v173, v174
  v_max_u32 v213, v213, v175
  v_cmp_lt_u32 vcc, s54, v213
  s_cbranch_vccnz AT_k1
  s_waitcnt lgkmcnt(0)
  s_barrier
  ds_read_b128 v[128:131], v218 offset:4096
  ds_read_b128 v[132:135], v218 offset:4352
  ds_read_b128 v[136:139], v218 offset:4608
  ds_read_b128 v[140:143], v218 offset:4864
  ds_read_b128 v[144:147], v218 offset:5120
  ds_read_b128 v[148:151], v218 offset:5376
  ds_read_b128 v[152:155], v218 offset:5632
  ds_read_b128 v[156:159], v218 offset:5888
  ds_read_b32 v168, v219 offset:4096
  ds_read_b32 v169, v219 offset:4224
  s_waitcnt lgkmcnt(9)
  v_mfma_f32_32x32x16_bf16 v[80:95], v[128:131], a[144:147], 0
  s_waitcnt lgkmcnt(8)
  v_mfma_f32_32x32x16_bf16 v[80:95], v[132:135], a[148:151], v[80:95]
  s_waitcnt lgkmcnt(7)
  v_mfma_f32_32x32x16_bf16 v[80:95], v[136:139], a[152:155], v[80:95]
  s_waitcnt lgkmcnt(6)
  v_mfma_f32_32x32x16_bf16 v[80:95], v[140:143], a[156:159], v[80:95]
  s_waitcnt lgkmcnt(5)
  v_mfma_f32_32x32x16_bf16 v[80:95], v[144:147], a[160:163], v[80:95]
  s_waitcnt lgkmcnt(4)
  v_mfma_f32_32x32x16_bf16 v[80:95], v[148:151], a[164:167], v[80:95]
  s_waitcnt lgkmcnt(3)
  v_mfma_f32_32x32x16_bf16 v[80:95], v[152:155], a[168:171], v[80:95]
  s_waitcnt lgkmcnt(2)
  v_mfma_f32_32x32x16_bf16 v[80:95], v[156:159], a[172:175], v[80:95]
  s_add_u32 s77, s77, 2
  v_mov_b32 v212, s77
  s_nop 9
  v_mul_f32 v80, s68, v80
  v_mul_f32 v81, s68, v81
  v_mul_f32 v82, s68, v82
  v_mul_f32 v83, s68, v83
  v_max3_f32 v84, v184, v80, v81
  v_max3_f32 v84, v84, v82, v83
  v_mov_b32 v85, v84
  s_nop 1
  v_permlane32_swap_b32 v84, v85
  v_max_f32 v84, v84, v85
  v_sub_f32 v86, v184, v84
  v_sub_f32 v80, v80, v84
  v_sub_f32 v81, v81, v84
  v_sub_f32 v82, v82, v84
  v_sub_f32 v83, v83, v84
  v_exp_f32 v86, v86
  v_exp_f32 v80, v80
  v_exp_f32 v81, v81
  v_exp_f32 v82, v82
  v_exp_f32 v83, v83
  v_fma_f32 v186, v186, v86, v80
  v_add_f32 v84, v81, v82
  v_add_f32 v186, v186, v83
  v_add_f32 v186, v186, v84
  v_mov_b32 v187, v186
  s_nop 1
  v_permlane32_swap_b32 v186, v187
  v_add_f32 v186, v186, v187
  v_rcp_f32 v186, v186
  s_nop 0
  v_mul_f32 v86, v86, v186
  v_mul_f32 v80, v186, v80
  v_mul_f32 v81, v186, v81
  v_mul_f32 v82, v186, v82
  v_mul_f32 v83, v186, v83
  v_cvt_pk_bf16_f32 v28, v80, v81
  v_cvt_pk_bf16_f32 v29, v82, v83
  v_mul_f32 v224, v86, v224
  v_mul_f32 v225, v86, v225
  v_mul_f32 v226, v86, v226
  v_mul_f32 v227, v86, v227
  v_mul_f32 v228, v86, v228
  v_mul_f32 v229, v86, v229
  v_mul_f32 v230, v86, v230
  v_mul_f32 v231, v86, v231
  v_mul_f32 v232, v86, v232
  v_mul_f32 v233, v86, v233
  v_mul_f32 v234, v86, v234
  v_mul_f32 v235, v86, v235
  v_mul_f32 v236, v86, v236
  v_mul_f32 v237, v86, v237
  v_mul_f32 v238, v86, v238
  v_mul_f32 v239, v86, v239
  s_waitcnt lgkmcnt(0)
  s_nop 0
  v_mfma_f32_32x32x8_bf16 v[224:239], v[168:169], v[28:29], v[224:239]
  s_nop 11
  v_cvt_pk_bf16_f32 v20, v224, v225
  v_cvt_pk_bf16_f32 v21, v226, v227
  v_cvt_pk_bf16_f32 v22, v228, v229
  v_cvt_pk_bf16_f32 v23, v230, v231
  buffer_store_dwordx4 v[20:23], v201, s[8:11], s75 offen offset:0 sc1
  v_cvt_pk_bf16_f32 v24, v232, v233
  v_cvt_pk_bf16_f32 v25, v234, v235
  v_cvt_pk_bf16_f32 v26, v236, v237
  v_cvt_pk_bf16_f32 v27, v238, v239
  buffer_store_dwordx4 v[24:27], v201, s[8:11], s75 offen offset:1024 sc1
  s_mov_b64 exec, 1
  buffer_store_dword v212, v201, s[8:11], s71 offen sc1
  s_mov_b64 exec, -1
  s_cmp_ge_u32 s77, 64
  s_cbranch_scc1 L_exit
  s_branch AT_loop
L_cexit:
L_exit:
L_end:
s_endpgm
.section .rodata,"a"
.p2align 6
.amdhsa_kernel gated_mix__sliding_local_dilated__memory_aug_recurrent_mem_tr__prompt_kernel
  .amdhsa_next_free_vgpr 512
  .amdhsa_next_free_sgpr 102
  .amdhsa_accum_offset 256
  .amdhsa_group_segment_fixed_size 0
  .amdhsa_kernarg_size 112
  .amdhsa_user_sgpr_count 2
  .amdhsa_user_sgpr_kernarg_segment_ptr 1
  .amdhsa_system_sgpr_workgroup_id_x 1
.end_amdhsa_kernel
```

```asm
; @launch grid=(256,1,1) block=(256,1,1) lds=163840
.amdgcn_target "amdgcn-amd-amdhsa--gfx950"
.text
.globl gated_mix__sliding_local_dilated__memory_aug_recurrent_mem_tr__prompt_kernel
.p2align 8
.type gated_mix__sliding_local_dilated__memory_aug_recurrent_mem_tr__prompt_kernel,@function
gated_mix__sliding_local_dilated__memory_aug_recurrent_mem_tr__prompt_kernel:
  s_cmp_ge_u32 s2, 256
  s_cbranch_scc1 L_end
  s_load_dwordx2 s[4:5], s[0:1], 0
  s_load_dwordx2 s[8:9], s[0:1], 104
  s_load_dwordx2 s[12:13], s[0:1], 96
  s_load_dwordx2 s[16:17], s[0:1], 40
  s_load_dwordx2 s[20:21], s[0:1], 48
  s_load_dwordx2 s[24:25], s[0:1], 56
  s_load_dwordx2 s[28:29], s[0:1], 64
  s_load_dwordx2 s[32:33], s[0:1], 32
  s_load_dwordx2 s[36:37], s[0:1], 8
  s_load_dwordx2 s[40:41], s[0:1], 16
  s_load_dwordx2 s[44:45], s[0:1], 80
  s_load_dwordx2 s[48:49], s[0:1], 88
  s_getreg_b32 s54, hwreg(HW_REG_XCC_ID, 0, 3)
  v_lshrrev_b32 v1, 6, v0
  s_nop 0
  v_readfirstlane_b32 s52, v1
  s_mov_b32 s6, 2359296
  s_mov_b32 s7, 0x20000
  s_mov_b32 s10, 268435456
  s_mov_b32 s11, 0x20000
  s_mov_b32 s14, 256
  s_mov_b32 s15, 0x20000
  s_mov_b32 s18, 4718592
  s_mov_b32 s19, 0x20000
  s_mov_b32 s22, 4718592
  s_mov_b32 s23, 0x20000
  s_mov_b32 s26, 4718592
  s_mov_b32 s27, 0x20000
  s_mov_b32 s30, 4718592
  s_mov_b32 s31, 0x20000
  s_mov_b32 s34, 9216
  s_mov_b32 s35, 0x20000
  s_mov_b32 s38, 1990656
  s_mov_b32 s39, 0x20000
  s_mov_b32 s42, 663552
  s_mov_b32 s43, 0x20000
  s_mov_b32 s46, 1152
  s_mov_b32 s47, 0x20000
  s_mov_b32 s50, 2359296
  s_mov_b32 s51, 0x20000
  s_waitcnt lgkmcnt(0)
  s_lshr_b32 s0, s2, 3
  s_mov_b32 s2, s54
  s_mov_b32 s1, 0
  s_lshl_b32 s55, s2, 2
  s_cmp_eq_u32 s52, 0
  s_cselect_b32 s55, s55, 0x1000
  s_lshl_b32 s56, 1, s0
  v_mov_b32 v1, 0
  v_mov_b32 v35, s56
  s_mov_b64 exec, 1
  buffer_atomic_or v35, v1, s[12:15], s55 offen sc0
  s_mov_b64 exec, -1
L_role:
  s_mov_b32 s53, s0
  s_cmp_eq_u32 s2, 0
  s_cbranch_scc0 L_worker
  v_and_b32 v0, 63, v0
  v_and_b32 v1, 15, v0
  v_lshrrev_b32 v2, 4, v0
  v_and_b32 v3, 1, v2
  s_lshl_b32 s54, s52, 1
  v_add_u32 v3, s54, v3
  v_lshlrev_b32 v3, 1, v3
  v_xor_b32 v3, v3, v1
  v_lshlrev_b32 v3, 4, v3
  v_lshl_add_u32 v8, v2, 13, v3
  s_lshl_b32 s78, s53, 8
  s_lshl_b32 s54, s52, 15
  s_add_u32 s78, s78, s54
  s_mul_i32 s79, s53, 147456
  s_lshl_b32 s57, s52, 10
  s_add_u32 s57, s57, 16384
  s_getpc_b64 s[80:81]
L_pc_1:
  s_and_b32 s55, s0, 1
  s_lshl_b32 s55, s55, 2
  s_add_u32 s55, s55, s52
  s_lshl_b32 s55, s55, 10
  v_and_b32 v199, 63, v0
  v_lshl_add_u32 v199, v199, 4, s55
  v_min_u32 v199, (L_w0 - L_pc_1), v199
  global_load_dword v196, v199, s[80:81]
  s_add_u32 m0, s57, 0
  s_add_u32 s54, s78, 0
  buffer_load_dwordx4 v8, s[16:19], s54 offen  lds
  s_add_u32 m0, s57, 4096
  s_add_u32 s54, s78, 131072
  buffer_load_dwordx4 v8, s[16:19], s54 offen  lds
  s_add_u32 m0, s57, 8192
  s_add_u32 s54, s78, 262144
  buffer_load_dwordx4 v8, s[16:19], s54 offen  lds
  s_add_u32 m0, s57, 12288
  s_add_u32 s54, s78, 393216
  buffer_load_dwordx4 v8, s[16:19], s54 offen  lds
  s_add_u32 m0, s57, 16384
  s_add_u32 s54, s78, 524288
  buffer_load_dwordx4 v8, s[16:19], s54 offen  lds
  s_add_u32 m0, s57, 20480
  s_add_u32 s54, s78, 655360
  buffer_load_dwordx4 v8, s[16:19], s54 offen  lds
  s_add_u32 m0, s57, 24576
  s_add_u32 s54, s78, 786432
  buffer_load_dwordx4 v8, s[16:19], s54 offen  lds
  s_add_u32 m0, s57, 28672
  s_add_u32 s54, s78, 917504
  buffer_load_dwordx4 v8, s[16:19], s54 offen  lds
  s_add_u32 m0, s57, 32768
  s_add_u32 s54, s78, 1048576
  buffer_load_dwordx4 v8, s[16:19], s54 offen  lds
  s_add_u32 m0, s57, 36864
  s_add_u32 s54, s78, 1179648
  buffer_load_dwordx4 v8, s[16:19], s54 offen  lds
  s_add_u32 m0, s57, 40960
  s_add_u32 s54, s78, 1310720
  buffer_load_dwordx4 v8, s[16:19], s54 offen  lds
  s_add_u32 m0, s57, 45056
  s_add_u32 s54, s78, 1441792
  buffer_load_dwordx4 v8, s[16:19], s54 offen  lds
  s_add_u32 m0, s57, 49152
  s_add_u32 s54, s78, 1572864
  buffer_load_dwordx4 v8, s[16:19], s54 offen  lds
  s_add_u32 m0, s57, 53248
  s_add_u32 s54, s78, 1703936
  buffer_load_dwordx4 v8, s[16:19], s54 offen  lds
  s_add_u32 m0, s57, 57344
  s_add_u32 s54, s78, 1835008
  buffer_load_dwordx4 v8, s[16:19], s54 offen  lds
  s_add_u32 m0, s57, 61440
  s_add_u32 s54, s78, 1966080
  buffer_load_dwordx4 v8, s[16:19], s54 offen  lds
  s_add_u32 m0, s57, 65536
  s_add_u32 s54, s78, 2097152
  buffer_load_dwordx4 v8, s[16:19], s54 offen  lds
  s_add_u32 m0, s57, 69632
  s_add_u32 s54, s78, 2228224
  buffer_load_dwordx4 v8, s[16:19], s54 offen  lds
  s_add_u32 m0, s57, 73728
  s_add_u32 s54, s78, 2359296
  buffer_load_dwordx4 v8, s[16:19], s54 offen  lds
  s_add_u32 m0, s57, 77824
  s_add_u32 s54, s78, 2490368
  buffer_load_dwordx4 v8, s[16:19], s54 offen  lds
  v_lshlrev_b32 v76, 4, v0
  v_add_u32 v75, 0x10000, v76
  v_lshrrev_b32 v3, 2, v1
  v_and_b32 v4, 1, v1
  v_lshl_add_u32 v3, v3, 1, v4
  v_bfe_u32 v4, v1, 1, 1
  v_mul_u32_u24 v74, 0xaaaa, v4
  v_add_u32 v74, 0x4444, v74
  v_mul_u32_u24 v5, 576, v3
  v_add_u32 v5, 0, v5
  v_lshl_add_u32 v78, v2, 4, v5
  v_lshl_add_u32 v77, v2, 5, v5
  v_lshl_add_u32 v77, v4, 4, v77
  v_mul_u32_u24 v15, 1152, v3
  v_lshl_add_u32 v15, v2, 5, v15
  v_lshl_add_u32 v15, v4, 4, v15
  s_lshl_b32 s54, s52, 8
  buffer_load_dwordx4 v[20:23], v15, s[32:35], s54 offen
  buffer_load_dwordx4 v[24:27], v15, s[32:35], s54 offen offset:128
  buffer_load_dwordx4 v[28:31], v15, s[32:35], 0 offen offset:1024
  v_mul_u32_u24 v79, 1152, v2
  v_lshl_add_u32 v79, v1, 2, v79
  s_lshl_b32 s54, s52, 6
  s_add_u32 s54, s54, 0
  v_add_u32 v79, s54, v79
  v_lshrrev_b32 v5, 3, v0
  v_mul_u32_u24 v68, 2176, v5
  v_and_b32 v5, 7, v0
  v_lshl_add_u32 v68, v5, 3, v68
  v_and_b32 v5, 1, v2
  v_lshlrev_b32 v5, 4, v5
  v_lshl_add_u32 v5, v1, 2, v5
  v_mov_b32 v6, 0x40000000
  v_cmp_lt_u32 vcc, 3, v1
  s_nop 1
  v_cndmask_b32 v5, v5, v6, vcc
  v_lshrrev_b32 v6, 1, v2
  v_lshl_add_u32 v69, v6, 10, v5
  v_lshl_add_u32 v70, v6, 8, v5
  v_mov_b32 v71, -1
  ds_write_b128 v76, v[68:71] offset:13824
  v_and_b32 v5, 3, v1
  v_lshrrev_b32 v6, 2, v1
  v_lshl_add_u32 v5, v5, 2, v6
  v_and_b32 v6, 1, v5
  v_lshlrev_b32 v6, 4, v6
  v_mov_b32 v7, 0x3f80
  v_lshlrev_b32 v6, v6, v7
  v_lshrrev_b32 v5, 1, v5
  v_cmp_eq_u32 vcc, 0, v5
  s_nop 1
  v_cndmask_b32 v40, 0, v6, vcc
  v_cmp_eq_u32 vcc, 1, v5
  s_nop 1
  v_cndmask_b32 v41, 0, v6, vcc
  v_cmp_eq_u32 vcc, 2, v5
  s_nop 1
  v_cndmask_b32 v42, 0, v6, vcc
  v_cmp_eq_u32 vcc, 3, v5
  s_nop 1
  v_cndmask_b32 v43, 0, v6, vcc
  ds_write_b128 v76, v[40:43] offset:14848
  s_and_b32 s54, s52, 1
  s_lshr_b32 s55, s52, 1
  v_lshrrev_b32 v3, 3, v0
  v_and_b32 v4, 1, v3
  v_lshlrev_b32 v4, 4, v4
  v_and_b32 v5, 6, v3
  v_add_u32 v4, v4, v5
  s_lshl_b32 s56, s55, 3
  s_add_u32 s56, s56, s54
  v_add_u32 v4, s56, v4
  v_mul_u32_u24 v4, 1152, v4
  v_and_b32 v5, 2, v3
  v_lshlrev_b32 v5, 1, v5
  v_and_b32 v6, 7, v0
  v_xor_b32 v6, v6, v5
  v_lshl_add_u32 v9, v6, 4, v4
  v_and_b32 v4, 1, v2
  v_lshlrev_b32 v4, 4, v4
  v_and_b32 v5, 2, v2
  v_add_u32 v4, v4, v5
  s_lshl_b32 s56, s55, 2
  s_add_u32 s56, s56, s54
  v_add_u32 v4, s56, v4
  v_mul_u32_u24 v4, 1152, v4
  v_lshlrev_b32 v6, 1, v2
  v_xor_b32 v6, v6, v1
  v_lshl_add_u32 v10, v6, 4, v4
  v_bfe_u32 v17, v1, 2, 1
  v_bfe_u32 v18, v1, 3, 1
  v_and_b32 v19, 1, v2
  v_lshrrev_b32 v72, 1, v2
  v_and_b32 v73, 3, v1
  v_lshl_add_u32 v3, v19, 1, v17
  v_lshl_add_u32 v6, v18, 2, v3
  v_lshl_add_u32 v4, v72, 4, v17
  v_lshl_add_u32 v4, v19, 2, v4
  v_lshl_add_u32 v4, v18, 3, v4
  v_lshlrev_b32 v4, 8, v4
  s_lshl_b32 s54, s52, 6
  v_lshl_add_u32 v5, v73, 3, s54
  v_lshlrev_b32 v7, 5, v6
  v_xor_b32 v5, v5, v7
  v_add_u32 v11, v4, v5
  v_xor_b32 v12, 32, v11
  v_lshl_add_u32 v4, v72, 2, v3
  v_lshlrev_b32 v4, 7, v4
  v_lshl_add_u32 v4, v73, 3, v4
  s_and_b32 s54, s52, 1
  v_xor_b32 v7, s54, v19
  v_lshl_add_u32 v7, v7, 1, v18
  v_lshl_add_u32 v13, v7, 5, v4
  v_lshlrev_b32 v4, 11, v72
  v_lshl_add_u32 v4, v73, 3, v4
  v_lshl_add_u32 v5, v3, 8, v4
  v_lshl_add_u32 v7, v18, 2, s52
  v_xor_b32 v7, v7, v3
  v_lshl_add_u32 v14, v7, 5, v5
  s_lshl_b32 s54, s53, 14
  s_lshl_b32 s55, s52, 11
  s_add_u32 s54, s54, 1048576
  s_add_u32 s58, s54, s55
  s_add_u32 s59, s58, 8192
  s_lshl_b32 s55, s52, 12
  s_add_u32 s70, s54, s55
  s_add_u32 s70, s70, 655360
  s_lshl_b32 s54, s53, 12
  s_lshl_b32 s55, s52, 10
  s_add_u32 s54, s54, s55
  s_add_u32 s68, s54, 917504
  s_lshl_b32 s54, s53, 6
  s_mul_i32 s55, s52, 17408
  s_add_u32 s55, s54, s55
  s_add_u32 s73, s55, 0
  s_add_u32 s74, s55, 69632
  s_add_u32 s75, s55, 139264
  s_add_u32 s76, s55, 208896
  s_and_b32 s56, s52, 1
  s_mul_i32 s55, s56, 17408
  s_add_u32 s55, s54, s55
  s_add_u32 s77, s55, 278528
  s_mul_i32 s54, s52, 69632
  s_mul_i32 s55, s53, 2176
  s_add_u32 s54, s54, s55
  s_add_u32 s60, s54, 0
  s_and_b32 s56, s53, 15
  s_mul_i32 s55, s56, 2176
  s_add_u32 s61, s55, 278528
  s_lshl_b32 s54, s52, 11
  s_add_u32 s64, s54, 360448
  s_mov_b32 s65, 368640
  s_lshl_b32 s55, s53, 5
  s_add_u32 s54, s54, s55
  s_add_u32 s62, s54, 376832
  s_lshr_b32 s54, s56, 3
  s_lshl_b32 s54, s54, 9
  s_and_b32 s55, s56, 7
  s_lshl_b32 s55, s55, 5
  s_add_u32 s54, s54, s55
  s_add_u32 s63, s54, 385024
  s_mov_b32 s66, 0
  s_mov_b32 s67, 0
  s_mov_b32 s72, 0
  s_mov_b32 s69, 1040356334
  s_waitcnt vmcnt(19) lgkmcnt(0)
  s_barrier
  s_add_u32 m0, s57, 81920
  s_add_u32 s54, s78, 2621440
  buffer_load_dwordx4 v8, s[16:19], s54 offen  lds
  s_add_u32 m0, s57, 86016
  s_add_u32 s54, s78, 2752512
  buffer_load_dwordx4 v8, s[16:19], s54 offen  lds
  s_add_u32 m0, s57, 90112
  s_add_u32 s54, s78, 2883584
  buffer_load_dwordx4 v8, s[16:19], s54 offen  lds
  s_add_u32 m0, s57, 94208
  s_add_u32 s54, s78, 3014656
  buffer_load_dwordx4 v8, s[16:19], s54 offen  lds
  v_add_u32 v15, 16384, v11
  v_add_u32 v16, 16384, v12
  ds_read_b64_tr_b16 v[80:81], v15 offset:0
  ds_read_b64_tr_b16 v[82:83], v15 offset:512
  ds_read_b64_tr_b16 v[84:85], v15 offset:8192
  ds_read_b64_tr_b16 v[86:87], v15 offset:8704
  ds_read_b64_tr_b16 v[88:89], v16 offset:0
  ds_read_b64_tr_b16 v[90:91], v16 offset:512
  ds_read_b64_tr_b16 v[92:93], v16 offset:8192
  ds_read_b64_tr_b16 v[94:95], v16 offset:8704
  s_waitcnt vmcnt(19) lgkmcnt(0)
  s_barrier
  s_add_u32 m0, s57, 98304
  s_add_u32 s54, s78, 3670016
  buffer_load_dwordx4 v8, s[16:19], s54 offen  lds
  s_add_u32 m0, s57, 102400
  s_add_u32 s54, s78, 3801088
  buffer_load_dwordx4 v8, s[16:19], s54 offen  lds
  s_add_u32 m0, s57, 106496
  s_add_u32 s54, s78, 3932160
  buffer_load_dwordx4 v8, s[16:19], s54 offen  lds
  s_add_u32 m0, s57, 110592
  s_add_u32 s54, s78, 4063232
  buffer_load_dwordx4 v8, s[16:19], s54 offen  lds
  v_add_u32 v15, 32768, v11
  v_add_u32 v16, 32768, v12
  ds_read_b64_tr_b16 v[96:97], v15 offset:0
  ds_read_b64_tr_b16 v[98:99], v15 offset:512
  ds_read_b64_tr_b16 v[100:101], v15 offset:8192
  ds_read_b64_tr_b16 v[102:103], v15 offset:8704
  ds_read_b64_tr_b16 v[104:105], v16 offset:0
  ds_read_b64_tr_b16 v[106:107], v16 offset:512
  ds_read_b64_tr_b16 v[108:109], v16 offset:8192
  ds_read_b64_tr_b16 v[110:111], v16 offset:8704
  s_waitcnt vmcnt(19) lgkmcnt(0)
  s_barrier
  s_add_u32 m0, s57, 114688
  s_add_u32 s54, s78, 4194304
  buffer_load_dwordx4 v8, s[16:19], s54 offen  lds
  s_add_u32 m0, s57, 118784
  s_add_u32 s54, s78, 4325376
  buffer_load_dwordx4 v8, s[16:19], s54 offen  lds
  s_add_u32 m0, s57, 122880
  s_add_u32 s54, s78, 4456448
  buffer_load_dwordx4 v8, s[16:19], s54 offen  lds
  s_add_u32 m0, s57, 126976
  s_add_u32 s54, s78, 4587520
  buffer_load_dwordx4 v8, s[16:19], s54 offen  lds
  v_add_u32 v15, 49152, v11
  v_add_u32 v16, 49152, v12
  ds_read_b64_tr_b16 v[112:113], v15 offset:0
  ds_read_b64_tr_b16 v[114:115], v15 offset:512
  ds_read_b64_tr_b16 v[116:117], v15 offset:8192
  ds_read_b64_tr_b16 v[118:119], v15 offset:8704
  ds_read_b64_tr_b16 v[120:121], v16 offset:0
  ds_read_b64_tr_b16 v[122:123], v16 offset:512
  ds_read_b64_tr_b16 v[124:125], v16 offset:8192
  ds_read_b64_tr_b16 v[126:127], v16 offset:8704
  s_waitcnt vmcnt(19) lgkmcnt(0)
  s_barrier
  s_add_u32 m0, s57, 131072
  s_add_u32 s54, s78, 1048576
  buffer_load_dwordx4 v8, s[20:23], s54 offen  lds
  s_add_u32 m0, s57, 135168
  s_add_u32 s54, s78, 1179648
  buffer_load_dwordx4 v8, s[20:23], s54 offen  lds
  s_add_u32 m0, s57, 139264
  s_add_u32 s54, s78, 1310720
  buffer_load_dwordx4 v8, s[20:23], s54 offen  lds
  s_add_u32 m0, s57, 143360
  s_add_u32 s54, s78, 1441792
  buffer_load_dwordx4 v8, s[20:23], s54 offen  lds
  v_add_u32 v15, 65536, v11
  v_add_u32 v16, 65536, v12
  ds_read_b64_tr_b16 v[128:129], v15 offset:0
  ds_read_b64_tr_b16 v[130:131], v15 offset:512
  ds_read_b64_tr_b16 v[132:133], v15 offset:8192
  ds_read_b64_tr_b16 v[134:135], v15 offset:8704
  ds_read_b64_tr_b16 v[136:137], v16 offset:0
  ds_read_b64_tr_b16 v[138:139], v16 offset:512
  ds_read_b64_tr_b16 v[140:141], v16 offset:8192
  ds_read_b64_tr_b16 v[142:143], v16 offset:8704
  s_waitcnt vmcnt(19) lgkmcnt(0)
  s_barrier
  s_add_u32 m0, s57, 0
  s_add_u32 s54, s78, 1572864
  buffer_load_dwordx4 v8, s[20:23], s54 offen  lds
  s_add_u32 m0, s57, 4096
  s_add_u32 s54, s78, 1703936
  buffer_load_dwordx4 v8, s[20:23], s54 offen  lds
  s_add_u32 m0, s57, 8192
  s_add_u32 s54, s78, 1835008
  buffer_load_dwordx4 v8, s[20:23], s54 offen  lds
  s_add_u32 m0, s57, 12288
  s_add_u32 s54, s78, 1966080
  buffer_load_dwordx4 v8, s[20:23], s54 offen  lds
  v_add_u32 v15, 81920, v11
  v_add_u32 v16, 81920, v12
  ds_read_b64_tr_b16 v[144:145], v15 offset:0
  ds_read_b64_tr_b16 v[146:147], v15 offset:512
  ds_read_b64_tr_b16 v[148:149], v15 offset:8192
  ds_read_b64_tr_b16 v[150:151], v15 offset:8704
  ds_read_b64_tr_b16 v[152:153], v16 offset:0
  ds_read_b64_tr_b16 v[154:155], v16 offset:512
  ds_read_b64_tr_b16 v[156:157], v16 offset:8192
  ds_read_b64_tr_b16 v[158:159], v16 offset:8704
  s_waitcnt vmcnt(16) lgkmcnt(0)
  s_barrier
  s_add_u32 m0, s57, 16384
  s_add_u32 s54, s78, 3145728
  buffer_load_dwordx4 v8, s[20:23], s54 offen  lds
  s_add_u32 m0, s57, 20480
  s_add_u32 s54, s78, 3276800
  buffer_load_dwordx4 v8, s[20:23], s54 offen  lds
  s_add_u32 m0, s57, 24576
  s_add_u32 s54, s78, 3407872
  buffer_load_dwordx4 v8, s[20:23], s54 offen  lds
  s_add_u32 m0, s57, 28672
  s_add_u32 s54, s78, 3538944
  buffer_load_dwordx4 v8, s[20:23], s54 offen  lds
  v_add_u32 v15, 98304, v11
  v_add_u32 v16, 98304, v12
  ds_read_b64_tr_b16 v[160:161], v15 offset:0
  ds_read_b64_tr_b16 v[162:163], v15 offset:512
  ds_read_b64_tr_b16 v[164:165], v15 offset:8192
  ds_read_b64_tr_b16 v[166:167], v15 offset:8704
  ds_read_b64_tr_b16 v[168:169], v16 offset:0
  ds_read_b64_tr_b16 v[170:171], v16 offset:512
  ds_read_b64_tr_b16 v[172:173], v16 offset:8192
  ds_read_b64_tr_b16 v[174:175], v16 offset:8704
  s_waitcnt vmcnt(16) lgkmcnt(0)
  s_barrier
  s_add_u32 m0, s57, 32768
  s_add_u32 s54, s78, 3670016
  buffer_load_dwordx4 v8, s[20:23], s54 offen  lds
  s_add_u32 m0, s57, 36864
  s_add_u32 s54, s78, 3801088
  buffer_load_dwordx4 v8, s[20:23], s54 offen  lds
  s_add_u32 m0, s57, 40960
  s_add_u32 s54, s78, 3932160
  buffer_load_dwordx4 v8, s[20:23], s54 offen  lds
  s_add_u32 m0, s57, 45056
  s_add_u32 s54, s78, 4063232
  buffer_load_dwordx4 v8, s[20:23], s54 offen  lds
  s_cmp_eq_u32 s1, 1
  s_cbranch_scc1 C_ver_ok
  v_mov_b32 v33, 16320
  s_cmp_eq_u32 s52, 0
  s_cbranch_scc0 C_ver_b
  s_waitcnt vmcnt(52)
  s_mov_b64 exec, 1
  ds_write_b32 v33, v35
  s_mov_b64 exec, -1
  s_waitcnt lgkmcnt(0)
C_ver_b:
  s_barrier
  ds_read_b32 v32, v33
  s_waitcnt lgkmcnt(0)
  v_readfirstlane_b32 s54, v32
  s_nop 0
  s_bitcmp1_b32 s54, s0
  s_cbranch_scc1 L_conf
C_ver_ok:
  v_add_u32 v15, 114688, v11
  v_add_u32 v16, 114688, v12
  ds_read_b64_tr_b16 v[176:177], v15 offset:0
  ds_read_b64_tr_b16 v[178:179], v15 offset:512
  ds_read_b64_tr_b16 v[180:181], v15 offset:8192
  ds_read_b64_tr_b16 v[182:183], v15 offset:8704
  ds_read_b64_tr_b16 v[184:185], v16 offset:0
  ds_read_b64_tr_b16 v[186:187], v16 offset:512
  ds_read_b64_tr_b16 v[188:189], v16 offset:8192
  ds_read_b64_tr_b16 v[190:191], v16 offset:8704
  s_waitcnt vmcnt(16) lgkmcnt(0)
  s_barrier
  s_add_u32 m0, s57, 49152
  s_add_u32 s54, s78, 4194304
  buffer_load_dwordx4 v8, s[20:23], s54 offen  lds
  s_add_u32 m0, s57, 53248
  s_add_u32 s54, s78, 4325376
  buffer_load_dwordx4 v8, s[20:23], s54 offen  lds
  s_add_u32 m0, s57, 57344
  s_add_u32 s54, s78, 4456448
  buffer_load_dwordx4 v8, s[20:23], s54 offen  lds
  s_add_u32 m0, s57, 61440
  s_add_u32 s54, s78, 4587520
  buffer_load_dwordx4 v8, s[20:23], s54 offen  lds
  v_add_u32 v15, 131072, v11
  v_add_u32 v16, 131072, v12
  ds_read_b64_tr_b16 v[192:193], v15 offset:0
  ds_read_b64_tr_b16 v[194:195], v15 offset:512
  ds_read_b64_tr_b16 v[196:197], v15 offset:8192
  ds_read_b64_tr_b16 v[198:199], v15 offset:8704
  ds_read_b64_tr_b16 v[200:201], v16 offset:0
  ds_read_b64_tr_b16 v[202:203], v16 offset:512
  ds_read_b64_tr_b16 v[204:205], v16 offset:8192
  ds_read_b64_tr_b16 v[206:207], v16 offset:8704
  s_waitcnt vmcnt(16) lgkmcnt(0)
  s_barrier
  s_add_u32 m0, s57, 65536
  s_add_u32 s54, s78, 0
  buffer_load_dwordx4 v8, s[24:27], s54 offen  lds
  s_add_u32 m0, s57, 69632
  s_add_u32 s54, s78, 131072
  buffer_load_dwordx4 v8, s[24:27], s54 offen  lds
  s_add_u32 m0, s57, 73728
  s_add_u32 s54, s78, 262144
  buffer_load_dwordx4 v8, s[24:27], s54 offen  lds
  s_add_u32 m0, s57, 77824
  s_add_u32 s54, s78, 393216
  buffer_load_dwordx4 v8, s[24:27], s54 offen  lds
  s_getpc_b64 s[80:81]
  v_lshlrev_b32 v7, 2, v76
  global_load_dword v35, v7, s[80:81] offset:1024
  v_min_u32 v20, -2, v20
  v_min_u32 v21, -2, v21
  v_min_u32 v22, -2, v22
  v_min_u32 v23, -2, v23
  v_min_u32 v24, -2, v24
  v_min_u32 v25, -2, v25
  v_min_u32 v26, -2, v26
  v_min_u32 v27, -2, v27
  v_min_u32 v28, -2, v28
  v_min_u32 v29, -2, v29
  v_min_u32 v30, -2, v30
  v_min_u32 v31, -2, v31
  s_lshl_b32 s54, s52, 11
  v_add_u32 v3, s54, v76
  ds_write_b128 v3, v[20:23] offset:4608
  ds_write_b128 v3, v[24:27] offset:5632
  ds_write_b128 v76, v[28:31] offset:12800
  v_add_u32 v15, 147456, v11
  v_add_u32 v16, 147456, v12
  ds_read_b64_tr_b16 v[208:209], v15 offset:0
  ds_read_b64_tr_b16 v[210:211], v15 offset:512
  ds_read_b64_tr_b16 v[212:213], v15 offset:8192
  ds_read_b64_tr_b16 v[214:215], v15 offset:8704
  ds_read_b64_tr_b16 v[216:217], v16 offset:0
  ds_read_b64_tr_b16 v[218:219], v16 offset:512
  ds_read_b64_tr_b16 v[220:221], v16 offset:8192
  ds_read_b64_tr_b16 v[222:223], v16 offset:8704
  s_waitcnt vmcnt(17) lgkmcnt(0)
  s_barrier
  s_add_u32 m0, s57, 81920
  s_add_u32 s54, s78, 524288
  buffer_load_dwordx4 v8, s[24:27], s54 offen  lds
  s_add_u32 m0, s57, 86016
  s_add_u32 s54, s78, 655360
  buffer_load_dwordx4 v8, s[24:27], s54 offen  lds
  s_add_u32 m0, s57, 90112
  s_add_u32 s54, s78, 786432
  buffer_load_dwordx4 v8, s[24:27], s54 offen  lds
  s_add_u32 m0, s57, 94208
  s_add_u32 s54, s78, 917504
  buffer_load_dwordx4 v8, s[24:27], s54 offen  lds
  v_add_u32 v15, 16384, v11
  v_add_u32 v16, 16384, v12
  ds_read_b64_tr_b16 v[224:225], v15 offset:0
  ds_read_b64_tr_b16 v[226:227], v15 offset:512
  ds_read_b64_tr_b16 v[228:229], v15 offset:8192
  ds_read_b64_tr_b16 v[230:231], v15 offset:8704
  ds_read_b64_tr_b16 v[232:233], v16 offset:0
  ds_read_b64_tr_b16 v[234:235], v16 offset:512
  ds_read_b64_tr_b16 v[236:237], v16 offset:8192
  ds_read_b64_tr_b16 v[238:239], v16 offset:8704
  s_waitcnt vmcnt(17) lgkmcnt(0)
  s_barrier
  s_add_u32 m0, s57, 98304
  s_add_u32 s54, s78, 1048576
  buffer_load_dwordx4 v8, s[24:27], s54 offen  lds
  s_add_u32 m0, s57, 102400
  s_add_u32 s54, s78, 1179648
  buffer_load_dwordx4 v8, s[24:27], s54 offen  lds
  s_add_u32 m0, s57, 106496
  s_add_u32 s54, s78, 1310720
  buffer_load_dwordx4 v8, s[24:27], s54 offen  lds
  s_add_u32 m0, s57, 110592
  s_add_u32 s54, s78, 1441792
  buffer_load_dwordx4 v8, s[24:27], s54 offen  lds
  v_add_u32 v15, 32768, v11
  v_add_u32 v16, 32768, v12
  ds_read_b64_tr_b16 v[240:241], v15 offset:0
  ds_read_b64_tr_b16 v[242:243], v15 offset:512
  ds_read_b64_tr_b16 v[244:245], v15 offset:8192
  ds_read_b64_tr_b16 v[246:247], v15 offset:8704
  ds_read_b64_tr_b16 v[248:249], v16 offset:0
  ds_read_b64_tr_b16 v[250:251], v16 offset:512
  ds_read_b64_tr_b16 v[252:253], v16 offset:8192
  ds_read_b64_tr_b16 v[254:255], v16 offset:8704
  s_waitcnt vmcnt(17) lgkmcnt(0)
  s_barrier
  s_add_u32 m0, s57, 114688
  s_add_u32 s54, s78, 1572864
  buffer_load_dwordx4 v8, s[24:27], s54 offen  lds
  s_add_u32 m0, s57, 118784
  s_add_u32 s54, s78, 1703936
  buffer_load_dwordx4 v8, s[24:27], s54 offen  lds
  s_add_u32 m0, s57, 122880
  s_add_u32 s54, s78, 1835008
  buffer_load_dwordx4 v8, s[24:27], s54 offen  lds
  s_add_u32 m0, s57, 126976
  s_add_u32 s54, s78, 1966080
  buffer_load_dwordx4 v8, s[24:27], s54 offen  lds
  v_add_u32 v15, 49152, v11
  v_add_u32 v16, 49152, v12
  ds_read_b64_tr_b16 a[0:1], v15 offset:0
  ds_read_b64_tr_b16 a[2:3], v15 offset:512
  ds_read_b64_tr_b16 a[4:5], v15 offset:8192
  ds_read_b64_tr_b16 a[6:7], v15 offset:8704
  ds_read_b64_tr_b16 a[8:9], v16 offset:0
  ds_read_b64_tr_b16 a[10:11], v16 offset:512
  ds_read_b64_tr_b16 a[12:13], v16 offset:8192
  ds_read_b64_tr_b16 a[14:15], v16 offset:8704
  s_waitcnt vmcnt(17) lgkmcnt(0)
  s_barrier
  s_add_u32 m0, s57, 131072
  s_add_u32 s54, s78, 2097152
  buffer_load_dwordx4 v8, s[24:27], s54 offen  lds
  s_add_u32 m0, s57, 135168
  s_add_u32 s54, s78, 2228224
  buffer_load_dwordx4 v8, s[24:27], s54 offen  lds
  s_add_u32 m0, s57, 139264
  s_add_u32 s54, s78, 2359296
  buffer_load_dwordx4 v8, s[24:27], s54 offen  lds
  s_add_u32 m0, s57, 143360
  s_add_u32 s54, s78, 2490368
  buffer_load_dwordx4 v8, s[24:27], s54 offen  lds
  v_add_u32 v15, 65536, v11
  v_add_u32 v16, 65536, v12
  ds_read_b64_tr_b16 a[16:17], v15 offset:0
  ds_read_b64_tr_b16 a[18:19], v15 offset:512
  ds_read_b64_tr_b16 a[20:21], v15 offset:8192
  ds_read_b64_tr_b16 a[22:23], v15 offset:8704
  ds_read_b64_tr_b16 a[24:25], v16 offset:0
  ds_read_b64_tr_b16 a[26:27], v16 offset:512
  ds_read_b64_tr_b16 a[28:29], v16 offset:8192
  ds_read_b64_tr_b16 a[30:31], v16 offset:8704
  s_waitcnt vmcnt(17) lgkmcnt(0)
  s_barrier
  s_add_u32 m0, s57, 0
  s_add_u32 s54, s78, 2621440
  buffer_load_dwordx4 v8, s[24:27], s54 offen  lds
  s_add_u32 m0, s57, 4096
  s_add_u32 s54, s78, 2752512
  buffer_load_dwordx4 v8, s[24:27], s54 offen  lds
  s_add_u32 m0, s57, 8192
  s_add_u32 s54, s78, 2883584
  buffer_load_dwordx4 v8, s[24:27], s54 offen  lds
  s_add_u32 m0, s57, 12288
  s_add_u32 s54, s78, 3014656
  buffer_load_dwordx4 v8, s[24:27], s54 offen  lds
  v_add_u32 v15, 81920, v11
  v_add_u32 v16, 81920, v12
  ds_read_b64_tr_b16 a[32:33], v15 offset:0
  ds_read_b64_tr_b16 a[34:35], v15 offset:512
  ds_read_b64_tr_b16 a[36:37], v15 offset:8192
  ds_read_b64_tr_b16 a[38:39], v15 offset:8704
  ds_read_b64_tr_b16 a[40:41], v16 offset:0
  ds_read_b64_tr_b16 a[42:43], v16 offset:512
  ds_read_b64_tr_b16 a[44:45], v16 offset:8192
  ds_read_b64_tr_b16 a[46:47], v16 offset:8704
  s_waitcnt vmcnt(16) lgkmcnt(0)
  s_barrier
  s_add_u32 m0, s57, 16384
  s_add_u32 s54, s78, 3145728
  buffer_load_dwordx4 v8, s[24:27], s54 offen  lds
  s_add_u32 m0, s57, 20480
  s_add_u32 s54, s78, 3276800
  buffer_load_dwordx4 v8, s[24:27], s54 offen  lds
  s_add_u32 m0, s57, 24576
  s_add_u32 s54, s78, 3407872
  buffer_load_dwordx4 v8, s[24:27], s54 offen  lds
  s_add_u32 m0, s57, 28672
  s_add_u32 s54, s78, 3538944
  buffer_load_dwordx4 v8, s[24:27], s54 offen  lds
  s_getpc_b64 s[80:81]
  v_lshlrev_b32 v7, 2, v76
  global_load_dword v35, v7, s[80:81] offset:1024
  v_add_u32 v15, 98304, v11
  v_add_u32 v16, 98304, v12
  ds_read_b64_tr_b16 a[48:49], v15 offset:0
  ds_read_b64_tr_b16 a[50:51], v15 offset:512
  ds_read_b64_tr_b16 a[52:53], v15 offset:8192
  ds_read_b64_tr_b16 a[54:55], v15 offset:8704
  ds_read_b64_tr_b16 a[56:57], v16 offset:0
  ds_read_b64_tr_b16 a[58:59], v16 offset:512
  ds_read_b64_tr_b16 a[60:61], v16 offset:8192
  ds_read_b64_tr_b16 a[62:63], v16 offset:8704
  s_waitcnt vmcnt(17) lgkmcnt(0)
  s_barrier
  s_add_u32 m0, s57, 32768
  s_add_u32 s54, s78, 3670016
  buffer_load_dwordx4 v8, s[24:27], s54 offen  lds
  s_add_u32 m0, s57, 36864
  s_add_u32 s54, s78, 3801088
  buffer_load_dwordx4 v8, s[24:27], s54 offen  lds
  s_add_u32 m0, s57, 40960
  s_add_u32 s54, s78, 3932160
  buffer_load_dwordx4 v8, s[24:27], s54 offen  lds
  s_add_u32 m0, s57, 45056
  s_add_u32 s54, s78, 4063232
  buffer_load_dwordx4 v8, s[24:27], s54 offen  lds
  v_add_u32 v15, 114688, v11
  v_add_u32 v16, 114688, v12
  ds_read_b64_tr_b16 a[64:65], v15 offset:0
  ds_read_b64_tr_b16 a[66:67], v15 offset:512
  ds_read_b64_tr_b16 a[68:69], v15 offset:8192
  ds_read_b64_tr_b16 a[70:71], v15 offset:8704
  ds_read_b64_tr_b16 a[72:73], v16 offset:0
  ds_read_b64_tr_b16 a[74:75], v16 offset:512
  ds_read_b64_tr_b16 a[76:77], v16 offset:8192
  ds_read_b64_tr_b16 a[78:79], v16 offset:8704
  s_waitcnt vmcnt(17) lgkmcnt(0)
  s_barrier
  s_add_u32 m0, s57, 49152
  s_add_u32 s54, s78, 4194304
  buffer_load_dwordx4 v8, s[24:27], s54 offen  lds
  s_add_u32 m0, s57, 53248
  s_add_u32 s54, s78, 4325376
  buffer_load_dwordx4 v8, s[24:27], s54 offen  lds
  s_add_u32 m0, s57, 57344
  s_add_u32 s54, s78, 4456448
  buffer_load_dwordx4 v8, s[24:27], s54 offen  lds
  s_add_u32 m0, s57, 61440
  s_add_u32 s54, s78, 4587520
  buffer_load_dwordx4 v8, s[24:27], s54 offen  lds
  v_add_u32 v15, 131072, v11
  v_add_u32 v16, 131072, v12
  ds_read_b64_tr_b16 a[80:81], v15 offset:0
  ds_read_b64_tr_b16 a[82:83], v15 offset:512
  ds_read_b64_tr_b16 a[84:85], v15 offset:8192
  ds_read_b64_tr_b16 a[86:87], v15 offset:8704
  ds_read_b64_tr_b16 a[88:89], v16 offset:0
  ds_read_b64_tr_b16 a[90:91], v16 offset:512
  ds_read_b64_tr_b16 a[92:93], v16 offset:8192
  ds_read_b64_tr_b16 a[94:95], v16 offset:8704
  s_waitcnt vmcnt(17) lgkmcnt(0)
  s_barrier
  s_add_u32 m0, s57, 65536
  s_add_u32 s54, s79, 73728
  buffer_load_dwordx4 v10, s[28:31], s54 offen  lds
  s_add_u32 m0, s57, 69632
  s_add_u32 s54, s79, 82944
  buffer_load_dwordx4 v10, s[28:31], s54 offen  lds
  s_add_u32 m0, s57, 73728
  s_add_u32 s54, s79, 110592
  buffer_load_dwordx4 v10, s[28:31], s54 offen  lds
  s_add_u32 m0, s57, 77824
  s_add_u32 s54, s79, 119808
  buffer_load_dwordx4 v10, s[28:31], s54 offen  lds
  v_add_u32 v15, 147456, v11
  v_add_u32 v16, 147456, v12
  ds_read_b64_tr_b16 a[96:97], v15 offset:0
  ds_read_b64_tr_b16 a[98:99], v15 offset:512
  ds_read_b64_tr_b16 a[100:101], v15 offset:8192
  ds_read_b64_tr_b16 a[102:103], v15 offset:8704
  ds_read_b64_tr_b16 a[104:105], v16 offset:0
  ds_read_b64_tr_b16 a[106:107], v16 offset:512
  ds_read_b64_tr_b16 a[108:109], v16 offset:8192
  ds_read_b64_tr_b16 a[110:111], v16 offset:8704
  s_waitcnt vmcnt(17) lgkmcnt(0)
  s_barrier
  s_add_u32 m0, s57, 81920
  s_add_u32 s54, s79, 256
  buffer_load_dwordx4 v10, s[28:31], s54 offen  lds
  s_add_u32 m0, s57, 86016
  s_add_u32 s54, s79, 9472
  buffer_load_dwordx4 v10, s[28:31], s54 offen  lds
  s_add_u32 m0, s57, 90112
  s_add_u32 s54, s79, 37120
  buffer_load_dwordx4 v10, s[28:31], s54 offen  lds
  s_add_u32 m0, s57, 94208
  s_add_u32 s54, s79, 46336
  buffer_load_dwordx4 v10, s[28:31], s54 offen  lds
  v_add_u32 v15, 16384, v11
  v_add_u32 v16, 16384, v12
  ds_read_b64_tr_b16 a[112:113], v15 offset:0
  ds_read_b64_tr_b16 a[114:115], v15 offset:512
  ds_read_b64_tr_b16 a[116:117], v15 offset:8192
  ds_read_b64_tr_b16 a[118:119], v15 offset:8704
  ds_read_b64_tr_b16 a[120:121], v16 offset:0
  ds_read_b64_tr_b16 a[122:123], v16 offset:512
  ds_read_b64_tr_b16 a[124:125], v16 offset:8192
  ds_read_b64_tr_b16 a[126:127], v16 offset:8704
  s_waitcnt vmcnt(17) lgkmcnt(0)
  s_barrier
  s_add_u32 m0, s57, 98304
  s_add_u32 s54, s79, 512
  buffer_load_dwordx4 v10, s[28:31], s54 offen  lds
  s_add_u32 m0, s57, 102400
  s_add_u32 s54, s79, 9728
  buffer_load_dwordx4 v10, s[28:31], s54 offen  lds
  s_add_u32 m0, s57, 106496
  s_add_u32 s54, s79, 37376
  buffer_load_dwordx4 v10, s[28:31], s54 offen  lds
  s_add_u32 m0, s57, 110592
  s_add_u32 s54, s79, 46592
  buffer_load_dwordx4 v10, s[28:31], s54 offen  lds
  v_add_u32 v15, 32768, v11
  v_add_u32 v16, 32768, v12
  ds_read_b64_tr_b16 a[128:129], v15 offset:0
  ds_read_b64_tr_b16 a[130:131], v15 offset:512
  ds_read_b64_tr_b16 a[132:133], v15 offset:8192
  ds_read_b64_tr_b16 a[134:135], v15 offset:8704
  ds_read_b64_tr_b16 a[136:137], v16 offset:0
  ds_read_b64_tr_b16 a[138:139], v16 offset:512
  ds_read_b64_tr_b16 a[140:141], v16 offset:8192
  ds_read_b64_tr_b16 a[142:143], v16 offset:8704
  s_waitcnt vmcnt(16) lgkmcnt(0)
  s_barrier
  s_add_u32 m0, s57, 114688
  s_add_u32 s54, s79, 768
  buffer_load_dwordx4 v10, s[28:31], s54 offen  lds
  s_add_u32 m0, s57, 118784
  s_add_u32 s54, s79, 9984
  buffer_load_dwordx4 v10, s[28:31], s54 offen  lds
  s_add_u32 m0, s57, 122880
  s_add_u32 s54, s79, 37632
  buffer_load_dwordx4 v10, s[28:31], s54 offen  lds
  s_add_u32 m0, s57, 126976
  s_add_u32 s54, s79, 46848
  buffer_load_dwordx4 v10, s[28:31], s54 offen  lds
  s_getpc_b64 s[80:81]
  v_lshlrev_b32 v7, 2, v76
  global_load_dword v35, v7, s[80:81] offset:1024
  v_add_u32 v15, 49152, v11
  v_add_u32 v16, 49152, v12
  ds_read_b64_tr_b16 a[144:145], v15 offset:0
  ds_read_b64_tr_b16 a[146:147], v15 offset:512
  ds_read_b64_tr_b16 a[148:149], v15 offset:8192
  ds_read_b64_tr_b16 a[150:151], v15 offset:8704
  ds_read_b64_tr_b16 a[152:153], v16 offset:0
  ds_read_b64_tr_b16 a[154:155], v16 offset:512
  ds_read_b64_tr_b16 a[156:157], v16 offset:8192
  ds_read_b64_tr_b16 a[158:159], v16 offset:8704
  s_waitcnt vmcnt(17) lgkmcnt(0)
  s_barrier
  s_add_u32 m0, s57, 131072
  s_add_u32 s54, s79, 74496
  buffer_load_dwordx4 v10, s[28:31], s54 offen  lds
  s_add_u32 m0, s57, 135168
  s_add_u32 s54, s79, 83712
  buffer_load_dwordx4 v10, s[28:31], s54 offen  lds
  s_add_u32 m0, s57, 139264
  s_add_u32 s54, s79, 111360
  buffer_load_dwordx4 v10, s[28:31], s54 offen  lds
  s_add_u32 m0, s57, 143360
  s_add_u32 s54, s79, 120576
  buffer_load_dwordx4 v10, s[28:31], s54 offen  lds
  v_add_u32 v15, 65536, v11
  v_add_u32 v16, 65536, v12
  ds_read_b64_tr_b16 a[160:161], v15 offset:0
  ds_read_b64_tr_b16 a[162:163], v15 offset:512
  ds_read_b64_tr_b16 a[164:165], v15 offset:8192
  ds_read_b64_tr_b16 a[166:167], v15 offset:8704
  ds_read_b64_tr_b16 a[168:169], v16 offset:0
  ds_read_b64_tr_b16 a[170:171], v16 offset:512
  ds_read_b64_tr_b16 a[172:173], v16 offset:8192
  ds_read_b64_tr_b16 a[174:175], v16 offset:8704
  s_waitcnt vmcnt(17) lgkmcnt(0)
  s_barrier
  s_add_u32 m0, s57, 0
  s_add_u32 s54, s78, 0
  buffer_load_dwordx4 v8, s[20:23], s54 offen  lds
  s_add_u32 m0, s57, 4096
  s_add_u32 s54, s78, 131072
  buffer_load_dwordx4 v8, s[20:23], s54 offen  lds
  s_add_u32 m0, s57, 8192
  s_add_u32 s54, s78, 262144
  buffer_load_dwordx4 v8, s[20:23], s54 offen  lds
  s_add_u32 m0, s57, 12288
  s_add_u32 s54, s78, 393216
  buffer_load_dwordx4 v8, s[20:23], s54 offen  lds
  v_add_u32 v15, 81920, v14
  ds_read_b64_tr_b16 a[176:177], v15 offset:0
  ds_read_b64_tr_b16 a[178:179], v15 offset:1024
  ds_read_b64_tr_b16 a[180:181], v15 offset:4096
  ds_read_b64_tr_b16 a[182:183], v15 offset:5120
  ds_read_b64_tr_b16 a[184:185], v15 offset:8192
  ds_read_b64_tr_b16 a[186:187], v15 offset:9216
  ds_read_b64_tr_b16 a[188:189], v15 offset:12288
  ds_read_b64_tr_b16 a[190:191], v15 offset:13312
  s_waitcnt vmcnt(17) lgkmcnt(0)
  s_barrier
  s_add_u32 m0, s57, 16384
  s_add_u32 s54, s78, 524288
  buffer_load_dwordx4 v8, s[20:23], s54 offen  lds
  s_add_u32 m0, s57, 20480
  s_add_u32 s54, s78, 655360
  buffer_load_dwordx4 v8, s[20:23], s54 offen  lds
  s_add_u32 m0, s57, 24576
  s_add_u32 s54, s78, 786432
  buffer_load_dwordx4 v8, s[20:23], s54 offen  lds
  s_add_u32 m0, s57, 28672
  s_add_u32 s54, s78, 917504
  buffer_load_dwordx4 v8, s[20:23], s54 offen  lds
  v_add_u32 v15, 98304, v14
  ds_read_b64_tr_b16 a[192:193], v15 offset:0
  ds_read_b64_tr_b16 a[194:195], v15 offset:1024
  ds_read_b64_tr_b16 a[196:197], v15 offset:4096
  ds_read_b64_tr_b16 a[198:199], v15 offset:5120
  ds_read_b64_tr_b16 a[200:201], v15 offset:8192
  ds_read_b64_tr_b16 a[202:203], v15 offset:9216
  ds_read_b64_tr_b16 a[204:205], v15 offset:12288
  ds_read_b64_tr_b16 a[206:207], v15 offset:13312
  s_waitcnt vmcnt(17) lgkmcnt(0)
  s_barrier
  s_add_u32 m0, s57, 32768
  s_add_u32 s54, s78, 2097152
  buffer_load_dwordx4 v8, s[20:23], s54 offen  lds
  s_add_u32 m0, s57, 36864
  s_add_u32 s54, s78, 2228224
  buffer_load_dwordx4 v8, s[20:23], s54 offen  lds
  s_add_u32 m0, s57, 40960
  s_add_u32 s54, s78, 2359296
  buffer_load_dwordx4 v8, s[20:23], s54 offen  lds
  s_add_u32 m0, s57, 45056
  s_add_u32 s54, s78, 2490368
  buffer_load_dwordx4 v8, s[20:23], s54 offen  lds
  v_add_u32 v15, 114688, v14
  ds_read_b64_tr_b16 a[208:209], v15 offset:0
  ds_read_b64_tr_b16 a[210:211], v15 offset:1024
  ds_read_b64_tr_b16 a[212:213], v15 offset:4096
  ds_read_b64_tr_b16 a[214:215], v15 offset:5120
  ds_read_b64_tr_b16 a[216:217], v15 offset:8192
  ds_read_b64_tr_b16 a[218:219], v15 offset:9216
  ds_read_b64_tr_b16 a[220:221], v15 offset:12288
  ds_read_b64_tr_b16 a[222:223], v15 offset:13312
  s_waitcnt vmcnt(17) lgkmcnt(0)
  s_barrier
  s_add_u32 m0, s57, 49152
  s_add_u32 s54, s78, 3145728
  buffer_load_dwordx4 v8, s[16:19], s54 offen  lds
  s_add_u32 m0, s57, 53248
  s_add_u32 s54, s78, 3276800
  buffer_load_dwordx4 v8, s[16:19], s54 offen  lds
  s_add_u32 m0, s57, 57344
  s_add_u32 s54, s78, 3407872
  buffer_load_dwordx4 v8, s[16:19], s54 offen  lds
  s_add_u32 m0, s57, 61440
  s_add_u32 s54, s78, 3538944
  buffer_load_dwordx4 v8, s[16:19], s54 offen  lds
  v_add_u32 v15, 131072, v14
  ds_read_b64_tr_b16 a[224:225], v15 offset:0
  ds_read_b64_tr_b16 a[226:227], v15 offset:1024
  ds_read_b64_tr_b16 a[228:229], v15 offset:4096
  ds_read_b64_tr_b16 a[230:231], v15 offset:5120
  ds_read_b64_tr_b16 a[232:233], v15 offset:8192
  ds_read_b64_tr_b16 a[234:235], v15 offset:9216
  ds_read_b64_tr_b16 a[236:237], v15 offset:12288
  ds_read_b64_tr_b16 a[238:239], v15 offset:13312
  s_waitcnt vmcnt(16) lgkmcnt(0)
  s_barrier
  s_add_u32 m0, s57, 65536
  s_add_u32 s54, s78, 2621440
  buffer_load_dwordx4 v8, s[20:23], s54 offen  lds
  s_add_u32 m0, s57, 69632
  s_add_u32 s54, s78, 2752512
  buffer_load_dwordx4 v8, s[20:23], s54 offen  lds
  s_add_u32 m0, s57, 73728
  s_add_u32 s54, s78, 2883584
  buffer_load_dwordx4 v8, s[20:23], s54 offen  lds
  s_add_u32 m0, s57, 77824
  s_add_u32 s54, s78, 3014656
  buffer_load_dwordx4 v8, s[20:23], s54 offen  lds
  v_add_u32 v15, 147456, v14
  ds_read_b64_tr_b16 a[240:241], v15 offset:0
  ds_read_b64_tr_b16 a[242:243], v15 offset:1024
  ds_read_b64_tr_b16 a[244:245], v15 offset:4096
  ds_read_b64_tr_b16 a[246:247], v15 offset:5120
  ds_read_b64_tr_b16 a[248:249], v15 offset:8192
  ds_read_b64_tr_b16 a[250:251], v15 offset:9216
  ds_read_b64_tr_b16 a[252:253], v15 offset:12288
  ds_read_b64_tr_b16 a[254:255], v15 offset:13312
  s_waitcnt vmcnt(16) lgkmcnt(0)
  s_barrier
  s_add_u32 m0, s57, 81920
  s_add_u32 s54, s79, 1024
  buffer_load_dwordx4 v9, s[28:31], s54 offen  lds
  s_add_u32 m0, s57, 86016
  s_add_u32 s54, s79, 37888
  buffer_load_dwordx4 v9, s[28:31], s54 offen  lds
  s_add_u32 m0, s57, 90112
  s_add_u32 s54, s79, 74752
  buffer_load_dwordx4 v9, s[28:31], s54 offen  lds
  s_add_u32 m0, s57, 94208
  s_add_u32 s54, s79, 111616
  buffer_load_dwordx4 v9, s[28:31], s54 offen  lds
  v_add_u32 v15, 16384, v11
  v_add_u32 v16, 16384, v12
  ds_read_b64_tr_b16 v[52:53], v15 offset:0
  ds_read_b64_tr_b16 v[54:55], v15 offset:512
  ds_read_b64_tr_b16 v[56:57], v15 offset:8192
  ds_read_b64_tr_b16 v[58:59], v15 offset:8704
  ds_read_b64_tr_b16 v[60:61], v16 offset:0
  ds_read_b64_tr_b16 v[62:63], v16 offset:512
  ds_read_b64_tr_b16 v[64:65], v16 offset:8192
  ds_read_b64_tr_b16 v[66:67], v16 offset:8704
  s_waitcnt vmcnt(16) lgkmcnt(0)
  s_barrier
  s_lshl_b32 s54, s52, 12
  s_add_u32 s54, s54, 16384
  v_add_u32 v7, s54, v76
  ds_write_b128 v7, v[52:55] offset:0
  ds_write_b128 v7, v[56:59] offset:1024
  ds_write_b128 v7, v[60:63] offset:2048
  ds_write_b128 v7, v[64:67] offset:3072
  s_add_u32 m0, s57, 98304
  s_add_u32 s54, s79, 0
  buffer_load_dwordx4 v10, s[28:31], s54 offen  lds
  s_add_u32 m0, s57, 102400
  s_add_u32 s54, s79, 9216
  buffer_load_dwordx4 v10, s[28:31], s54 offen  lds
  s_add_u32 m0, s57, 106496
  s_add_u32 s54, s79, 36864
  buffer_load_dwordx4 v10, s[28:31], s54 offen  lds
  s_add_u32 m0, s57, 110592
  s_add_u32 s54, s79, 46080
  buffer_load_dwordx4 v10, s[28:31], s54 offen  lds
  v_add_u32 v15, 32768, v11
  v_add_u32 v16, 32768, v12
  ds_read_b64_tr_b16 v[36:37], v15 offset:0
  ds_read_b64_tr_b16 v[38:39], v15 offset:512
  ds_read_b64_tr_b16 v[40:41], v15 offset:8192
  ds_read_b64_tr_b16 v[42:43], v15 offset:8704
  ds_read_b64_tr_b16 v[44:45], v16 offset:0
  ds_read_b64_tr_b16 v[46:47], v16 offset:512
  ds_read_b64_tr_b16 v[48:49], v16 offset:8192
  ds_read_b64_tr_b16 v[50:51], v16 offset:8704
  s_waitcnt vmcnt(16) lgkmcnt(0)
  s_barrier
  s_lshl_b32 s54, s52, 12
  s_add_u32 s54, s54, 32768
  v_add_u32 v7, s54, v76
  ds_write_b128 v7, v[36:39] offset:0
  ds_write_b128 v7, v[40:43] offset:1024
  ds_write_b128 v7, v[44:47] offset:2048
  ds_write_b128 v7, v[48:51] offset:3072
  s_add_u32 m0, s57, 114688
  s_add_u32 s54, s79, 73984
  buffer_load_dwordx4 v10, s[28:31], s54 offen  lds
  s_add_u32 m0, s57, 118784
  s_add_u32 s54, s79, 83200
  buffer_load_dwordx4 v10, s[28:31], s54 offen  lds
  s_add_u32 m0, s57, 122880
  s_add_u32 s54, s79, 110848
  buffer_load_dwordx4 v10, s[28:31], s54 offen  lds
  s_add_u32 m0, s57, 126976
  s_add_u32 s54, s79, 120064
  buffer_load_dwordx4 v10, s[28:31], s54 offen  lds
  v_add_u32 v15, 49152, v11
  v_add_u32 v16, 49152, v12
  ds_read_b64_tr_b16 v[52:53], v15 offset:0
  ds_read_b64_tr_b16 v[54:55], v15 offset:512
  ds_read_b64_tr_b16 v[56:57], v15 offset:8192
  ds_read_b64_tr_b16 v[58:59], v15 offset:8704
  ds_read_b64_tr_b16 v[60:61], v16 offset:0
  ds_read_b64_tr_b16 v[62:63], v16 offset:512
  ds_read_b64_tr_b16 v[64:65], v16 offset:8192
  ds_read_b64_tr_b16 v[66:67], v16 offset:8704
  s_waitcnt vmcnt(16) lgkmcnt(0)
  s_barrier
  s_lshl_b32 s54, s52, 12
  s_add_u32 s54, s54, 49152
  v_add_u32 v7, s54, v76
  ds_write_b128 v7, v[52:55] offset:0
  ds_write_b128 v7, v[56:59] offset:1024
  ds_write_b128 v7, v[60:63] offset:2048
  ds_write_b128 v7, v[64:67] offset:3072
  s_add_u32 m0, s57, 131072
  s_add_u32 s54, s79, 74240
  buffer_load_dwordx4 v10, s[28:31], s54 offen  lds
  s_add_u32 m0, s57, 135168
  s_add_u32 s54, s79, 83456
  buffer_load_dwordx4 v10, s[28:31], s54 offen  lds
  s_add_u32 m0, s57, 139264
  s_add_u32 s54, s79, 111104
  buffer_load_dwordx4 v10, s[28:31], s54 offen  lds
  s_add_u32 m0, s57, 143360
  s_add_u32 s54, s79, 120320
  buffer_load_dwordx4 v10, s[28:31], s54 offen  lds
  v_lshlrev_b32 v7, 3, v76
  s_lshl_b32 s54, s52, 13
  s_add_u32 s54, s54, 360448
  s_bitcmp1_b32 s52, 0
  s_cselect_b64 exec, 0xff, -1
  buffer_load_dword v35, v7, s[8:11], s54 offen sc1
  s_mov_b64 exec, -1
  s_getpc_b64 s[80:81]
C_pc:
  s_mov_b32 s55, (L_w0 - C_pc)
  s_cmp_eq_u32 s52, 1
  s_cselect_b32 s55, (L_w1 - C_pc), s55
  s_cmp_eq_u32 s52, 2
  s_cselect_b32 s55, (L_w2 - C_pc), s55
  s_cmp_eq_u32 s52, 3
  s_cselect_b32 s55, (L_w3 - C_pc), s55
  v_lshl_add_u32 v7, v76, 3, s55
  global_load_dword v35, v7, s[80:81]
  v_add_u32 v15, 65536, v11
  v_add_u32 v16, 65536, v12
  ds_read_b64_tr_b16 v[36:37], v15 offset:0
  ds_read_b64_tr_b16 v[38:39], v15 offset:512
  ds_read_b64_tr_b16 v[40:41], v15 offset:8192
  ds_read_b64_tr_b16 v[42:43], v15 offset:8704
  ds_read_b64_tr_b16 v[44:45], v16 offset:0
  ds_read_b64_tr_b16 v[46:47], v16 offset:512
  ds_read_b64_tr_b16 v[48:49], v16 offset:8192
  ds_read_b64_tr_b16 v[50:51], v16 offset:8704
  s_waitcnt vmcnt(18) lgkmcnt(0)
  s_barrier
  s_lshl_b32 s54, s52, 12
  s_add_u32 s54, s54, 65536
  v_add_u32 v7, s54, v76
  ds_write_b128 v7, v[36:39] offset:0
  ds_write_b128 v7, v[40:43] offset:1024
  ds_write_b128 v7, v[44:47] offset:2048
  ds_write_b128 v7, v[48:51] offset:3072
  v_lshrrev_b32 v20, 2, v76
  buffer_load_dword v21, v20, s[12:15], 0 offen sc1
  v_add_u32 v15, 81920, v11
  v_add_u32 v16, 81920, v12
  ds_read_b64_tr_b16 v[52:53], v15 offset:0
  ds_read_b64_tr_b16 v[54:55], v15 offset:512
  ds_read_b64_tr_b16 v[56:57], v15 offset:8192
  ds_read_b64_tr_b16 v[58:59], v15 offset:8704
  ds_read_b64_tr_b16 v[60:61], v16 offset:0
  ds_read_b64_tr_b16 v[62:63], v16 offset:512
  ds_read_b64_tr_b16 v[64:65], v16 offset:8192
  ds_read_b64_tr_b16 v[66:67], v16 offset:8704
  s_waitcnt vmcnt(15) lgkmcnt(0)
  s_barrier
  s_lshl_b32 s54, s52, 12
  s_add_u32 s54, s54, 81920
  v_add_u32 v7, s54, v76
  ds_write_b128 v7, v[52:55] offset:0
  ds_write_b128 v7, v[56:59] offset:1024
  ds_write_b128 v7, v[60:63] offset:2048
  ds_write_b128 v7, v[64:67] offset:3072
  v_add_u32 v15, 98304, v13
  s_waitcnt lgkmcnt(0)
  ds_read_b64_tr_b16 v[36:37], v15 offset:0
  ds_read_b64_tr_b16 v[38:39], v15 offset:1024
  ds_read_b64_tr_b16 v[40:41], v15 offset:2048
  ds_read_b64_tr_b16 v[42:43], v15 offset:3072
  ds_read_b64_tr_b16 v[44:45], v15 offset:4096
  ds_read_b64_tr_b16 v[46:47], v15 offset:5120
  ds_read_b64_tr_b16 v[48:49], v15 offset:6144
  ds_read_b64_tr_b16 v[50:51], v15 offset:7168
  ds_read_b64_tr_b16 v[52:53], v15 offset:8192
  ds_read_b64_tr_b16 v[54:55], v15 offset:9216
  ds_read_b64_tr_b16 v[56:57], v15 offset:10240
  ds_read_b64_tr_b16 v[58:59], v15 offset:11264
  ds_read_b64_tr_b16 v[60:61], v15 offset:12288
  ds_read_b64_tr_b16 v[62:63], v15 offset:13312
  ds_read_b64_tr_b16 v[64:65], v15 offset:14336
  ds_read_b64_tr_b16 v[66:67], v15 offset:15360
  s_waitcnt vmcnt(11) lgkmcnt(0)
  s_barrier
  s_and_b32 s54, s52, 1
  s_lshl_b32 s54, s54, 13
  s_add_u32 s54, s54, 98304
  v_add_u32 v7, s54, v76
  ds_write_b128 v7, v[36:39] offset:0
  ds_write_b128 v7, v[40:43] offset:1024
  ds_write_b128 v7, v[44:47] offset:2048
  ds_write_b128 v7, v[48:51] offset:3072
  ds_write_b128 v7, v[52:55] offset:4096
  ds_write_b128 v7, v[56:59] offset:5120
  ds_write_b128 v7, v[60:63] offset:6144
  ds_write_b128 v7, v[64:67] offset:7168
  v_add_u32 v15, 114688, v14
  ds_read_b64_tr_b16 v[52:53], v15 offset:0
  ds_read_b64_tr_b16 v[54:55], v15 offset:1024
  ds_read_b64_tr_b16 v[56:57], v15 offset:4096
  ds_read_b64_tr_b16 v[58:59], v15 offset:5120
  ds_read_b64_tr_b16 v[60:61], v15 offset:8192
  ds_read_b64_tr_b16 v[62:63], v15 offset:9216
  ds_read_b64_tr_b16 v[64:65], v15 offset:12288
  ds_read_b64_tr_b16 v[66:67], v15 offset:13312
  s_waitcnt vmcnt(7) lgkmcnt(0)
  s_barrier
  s_lshl_b32 s54, s52, 12
  s_add_u32 s54, s54, 114688
  v_add_u32 v7, s54, v76
  ds_write_b128 v7, v[52:55] offset:0
  ds_write_b128 v7, v[56:59] offset:1024
  ds_write_b128 v7, v[60:63] offset:2048
  ds_write_b128 v7, v[64:67] offset:3072
  v_add_u32 v15, 131072, v14
  ds_read_b64_tr_b16 v[36:37], v15 offset:0
  ds_read_b64_tr_b16 v[38:39], v15 offset:1024
  ds_read_b64_tr_b16 v[40:41], v15 offset:4096
  ds_read_b64_tr_b16 v[42:43], v15 offset:5120
  ds_read_b64_tr_b16 v[44:45], v15 offset:8192
  ds_read_b64_tr_b16 v[46:47], v15 offset:9216
  ds_read_b64_tr_b16 v[48:49], v15 offset:12288
  ds_read_b64_tr_b16 v[50:51], v15 offset:13312
  s_waitcnt vmcnt(3) lgkmcnt(0)
  s_barrier
  s_lshl_b32 s54, s52, 12
  s_add_u32 s54, s54, 131072
  v_add_u32 v7, s54, v76
  ds_write_b128 v7, v[36:39] offset:0
  ds_write_b128 v7, v[40:43] offset:1024
  ds_write_b128 v7, v[44:47] offset:2048
  ds_write_b128 v7, v[48:51] offset:3072
  v_add_u32 v15, 147456, v14
  ds_read_b64_tr_b16 v[52:53], v15 offset:0
  ds_read_b64_tr_b16 v[54:55], v15 offset:1024
  ds_read_b64_tr_b16 v[56:57], v15 offset:4096
  ds_read_b64_tr_b16 v[58:59], v15 offset:5120
  ds_read_b64_tr_b16 v[60:61], v15 offset:8192
  ds_read_b64_tr_b16 v[62:63], v15 offset:9216
  ds_read_b64_tr_b16 v[64:65], v15 offset:12288
  ds_read_b64_tr_b16 v[66:67], v15 offset:13312
  s_waitcnt vmcnt(0) lgkmcnt(0)
  s_barrier
  s_lshl_b32 s54, s52, 12
  s_add_u32 s54, s54, 147456
  v_add_u32 v7, s54, v76
  ds_write_b128 v7, v[52:55] offset:0
  ds_write_b128 v7, v[56:59] offset:1024
  ds_write_b128 v7, v[60:63] offset:2048
  ds_write_b128 v7, v[64:67] offset:3072
  s_waitcnt lgkmcnt(0)
  s_branch C_rd1
C_rd0:
  s_sleep 2
  buffer_load_dword v21, v20, s[12:15], 0 offen sc1
  s_waitcnt vmcnt(0)
C_rd1:
  v_and_b32 v22, 0xff, v21
  v_cmp_gt_u32 vcc, 7, v22
  v_readlane_b32 s56, v21, 0
  s_mov_b32 s3, 1
  s_add_u32 s67, s67, 1
  s_cmp_ge_u32 s67, 131072
  s_cbranch_scc1 C_rd2
  s_cmp_lg_u32 vcc_hi, 0
  s_cbranch_scc1 C_rd0
  s_mov_b32 s3, 0
  s_cmp_eq_u32 s56, -1
  s_cbranch_scc1 C_rd2
  s_mov_b32 s3, 1
  v_readlane_b32 s54, v21, 10
  v_readlane_b32 s55, v21, 0
  s_nop 0
  s_bcnt1_i32_b32 s55, s55
  s_add_u32 s54, s54, s55
  v_readlane_b32 s55, v21, 1
  s_nop 0
  s_bcnt1_i32_b32 s55, s55
  s_add_u32 s54, s54, s55
  v_readlane_b32 s55, v21, 2
  s_nop 0
  s_bcnt1_i32_b32 s55, s55
  s_add_u32 s54, s54, s55
  v_readlane_b32 s55, v21, 3
  s_nop 0
  s_bcnt1_i32_b32 s55, s55
  s_add_u32 s54, s54, s55
  v_readlane_b32 s55, v21, 4
  s_nop 0
  s_bcnt1_i32_b32 s55, s55
  s_add_u32 s54, s54, s55
  v_readlane_b32 s55, v21, 5
  s_nop 0
  s_bcnt1_i32_b32 s55, s55
  s_add_u32 s54, s54, s55
  v_readlane_b32 s55, v21, 6
  s_nop 0
  s_bcnt1_i32_b32 s55, s55
  s_add_u32 s54, s54, s55
  v_readlane_b32 s55, v21, 7
  s_nop 0
  s_bcnt1_i32_b32 s55, s55
  s_add_u32 s54, s54, s55
  s_cmp_lt_u32 s54, 256
  s_cbranch_scc1 C_rd0
C_rd2:
  s_lshl_b32 s54, s3, 2
  s_add_u32 s54, s54, s52
  s_cmp_eq_u32 s54, 1
  s_cbranch_scc1 L_w1
  s_cmp_eq_u32 s54, 2
  s_cbranch_scc1 L_w2
  s_cmp_eq_u32 s54, 3
  s_cbranch_scc1 L_w3
  s_cmp_eq_u32 s54, 4
  s_cbranch_scc1 L_w4
  s_cmp_eq_u32 s54, 5
  s_cbranch_scc1 L_w5
  s_cmp_eq_u32 s54, 6
  s_cbranch_scc1 L_w6
  s_cmp_eq_u32 s54, 7
  s_cbranch_scc1 L_w7
L_w0:
  v_mov_b64 v[20:21], 0
  v_mov_b64 v[22:23], 0
  v_mov_b64 v[24:25], 0
  v_mov_b64 v[26:27], 0
  v_mov_b64 v[28:29], 0
  v_mov_b64 v[30:31], 0
  v_mov_b64 v[32:33], 0
  v_mov_b64 v[34:35], 0
  s_mov_b32 s78, 0x3f803f80
  s_mov_b32 s79, s78
  s_mov_b32 s65, 360448
  s_mov_b32 m0, 16128
  s_lshl_b32 s71, s53, 2
  s_add_u32 s71, s71, 128
  s_movk_i32 s56, 0x1000
  v_lshlrev_b32 v73, 2, v76
  v_mov_b32 v72, 0
  s_mov_b64 s[16:17], s[8:9]
  s_mov_b32 s18, 268435456
  s_mov_b32 s19, 0x20000
  s_getpc_b64 s[20:21]
Cf0_pc:
  s_add_u32 s20, s20, (Cf0_last - Cf0_pc)
  s_addc_u32 s21, s21, 0
  v_mov_b32 v68, 14880
  buffer_load_dwordx4 v[52:55], v76, s[8:11], s59 offen offset:0 sc1
  buffer_load_dwordx4 v[56:59], v76, s[8:11], s59 offen offset:1024 sc1
  ds_read_b128 v[36:39], v76 offset:16384
  ds_read_b128 v[40:43], v76 offset:17408
  ds_read_b128 v[60:63], v76 offset:18432
  ds_read_b128 v[64:67], v76 offset:19456
  ds_read_b128 v[0:3], v76 offset:4608
  ds_read_b128 v[4:7], v76 offset:5632
  ds_read_b128 v[8:11], v76 offset:6656
  ds_read_b128 v[12:15], v76 offset:7680
  s_waitcnt lgkmcnt(0)
  s_cmp_eq_u32 s66, 1
  s_branch Cf0_top2
.p2align 6
Cf0_h2:
  v_lshlrev_b32 v73, 2, v76
  s_mov_b32 m0, 10752
  s_add_u32 s55, s65, 6144
  s_cmp_eq_u32 s66, 12
  s_cselect_b32 s56, s71, 0x1000
  ds_read_b32 v72, v76 offset:16128
  s_cmp_eq_u32 s66, 13
  s_cselect_b32 s54, 0x700, 0
  s_waitcnt lgkmcnt(0)
  v_readfirstlane_b32 s57, v72
  s_nop 0
  s_cmp_lt_u32 s57, s54
  s_cbranch_scc1 Cf0_kv3
Cf0_kvb:
  s_nop 1
  buffer_load_dwordx4 v[0:3], v76, s[8:11], s65 offen offset:0 sc1
  s_nop 15
  s_nop 3
  buffer_load_dwordx4 v[0:3], v76, s[8:11], s65 offen offset:0 sc1
  s_nop 15
  s_nop 3
  buffer_load_dwordx4 v[0:3], v76, s[8:11], s65 offen offset:0 sc1
  s_waitcnt vmcnt(5)
  ds_read_b128 v[36:39], v76 offset:16384
  ds_read_b128 v[40:43], v76 offset:17408
  ds_read_b128 v[60:63], v76 offset:18432
  ds_read_b128 v[64:67], v76 offset:19456
  buffer_load_dwordx4 v[52:55], v76, s[8:11], s59 offen offset:0 sc1
  buffer_load_dwordx4 v[56:59], v76, s[8:11], s59 offen offset:1024 sc1
  s_waitcnt vmcnt(4)
  v_max3_u32 v72, v0, v1, v2
  v_max_u32 v72, v72, v3
  ds_write_b128 v76, v[0:3] offset:4608
  v_cmp_eq_u32 vcc, -1, v72
  s_cbranch_vccnz Cf0_h2r
Cf0_h2w:
  s_cmp_eq_u32 s66, 63
  s_waitcnt lgkmcnt(0)
  s_barrier
  ds_read_b128 v[8:11], v76 offset:6656
  buffer_load_dwordx4 v76, s[8:11], s55 offen offset:0 sc1 lds
Cf0_top2:
  v_smfmac_f32_16x16x64_bf16 v[20:23], v[0:3], v[80:87], v74
  s_cbranch_scc1 Cf0_last
  v_smfmac_f32_16x16x64_bf16 v[28:31], v[0:3], v[36:43], v74
  buffer_load_dwordx4 v[44:47], v76, s[8:11], s58 offen offset:0 sc1
  s_mov_b32 m0, 16128
  v_smfmac_f32_16x16x64_bf16 v[24:27], v[0:3], v[88:95], v74
  buffer_load_dwordx4 v[48:51], v76, s[8:11], s58 offen offset:1024 sc1
  v_smfmac_f32_16x16x64_bf16 v[32:35], v[0:3], v[60:67], v74
  ds_read_b128 v[4:7], v76 offset:5632
  s_waitcnt lgkmcnt(1)
  v_smfmac_f32_16x16x64_bf16 v[20:23], v[8:11], v[112:119], v74
  ds_read_b128 v[12:15], v76 offset:7680
  v_smfmac_f32_16x16x64_bf16 v[24:27], v[8:11], v[120:127], v74
  ds_read_b128 v[36:39], v76 offset:32768
  v_smfmac_f32_16x16x64_bf16 v[28:31], v[8:11], v[208:215], v74
  buffer_store_dwordx4 v[16:19], v76, s[8:11], s68 offen sc1
  ds_read_b128 v[40:43], v76 offset:33792
  v_smfmac_f32_16x16x64_bf16 v[32:35], v[8:11], v[216:223], v74
  ds_read_b128 v[60:63], v76 offset:34816
  s_waitcnt lgkmcnt(4)
  v_smfmac_f32_16x16x64_bf16 v[20:23], v[4:7], v[96:103], v74
  ds_read_b128 v[64:67], v76 offset:35840
  v_smfmac_f32_16x16x64_bf16 v[24:27], v[4:7], v[104:111], v74
  buffer_load_dword v73, s[16:19], s70 offen lds
  s_waitcnt vmcnt(5)
  s_waitcnt lgkmcnt(4)
  v_smfmac_f32_16x16x64_bf16 v[20:23], v[12:15], v[128:135], v74
  s_barrier
  s_waitcnt lgkmcnt(2)
  v_smfmac_f32_16x16x64_bf16 v[28:31], v[4:7], v[36:43], v74
  ds_read_b128 v[0:3], v76 offset:8704
  v_smfmac_f32_16x16x64_bf16 v[24:27], v[12:15], v[136:143], v74
  ds_read_b128 v[36:39], v76 offset:49152
  s_waitcnt lgkmcnt(2)
  v_smfmac_f32_16x16x64_bf16 v[32:35], v[4:7], v[60:67], v74
  ds_read_b128 v[40:43], v76 offset:50176
  v_smfmac_f32_16x16x64_bf16 v[28:31], v[12:15], v[224:231], v74
  ds_read_b128 v[60:63], v76 offset:51200
  v_smfmac_f32_16x16x64_bf16 v[32:35], v[12:15], v[232:239], v74
  ds_read_b128 v[64:67], v76 offset:52224
  s_waitcnt lgkmcnt(4)
  v_smfmac_f32_16x16x64_bf16 v[20:23], v[0:3], v[144:151], v74
  s_waitcnt vmcnt(4)
  ds_read_b128 v[8:11], v76 offset:9728
  s_waitcnt lgkmcnt(3)
  v_smfmac_f32_16x16x64_bf16 v[28:31], v[0:3], v[36:43], v74
  s_barrier
  ds_read_b128 v[4:7], v76 offset:11776
  v_smfmac_f32_16x16x64_bf16 v[24:27], v[0:3], v[152:159], v74
  ds_read_b128 v[36:39], v75 offset:0
  ds_read_b128 v[40:43], v75 offset:1024
  s_waitcnt lgkmcnt(4)
  v_smfmac_f32_16x16x64_bf16 v[32:35], v[0:3], v[60:67], v74
  ds_read_b128 v[16:19], v76 offset:10752
  s_waitcnt lgkmcnt(4)
  v_smfmac_f32_16x16x64_bf16 v[20:23], v[8:11], v[160:167], v74
  ds_read_b128 v[12:15], v76 offset:12800
  v_smfmac_f32_16x16x64_bf16 v[24:27], v[8:11], v[168:175], v74
  ds_read_b128 v[60:63], v75 offset:2048
  ds_read_b128 v[64:67], v75 offset:3072
  s_waitcnt lgkmcnt(6)
  v_smfmac_f32_16x16x64_bf16 v[20:23], v[4:7], v[176:183], v74
  s_waitcnt lgkmcnt(3)
  v_smfmac_f32_16x16x64_bf16 v[20:23], v[16:19], v[36:43], v74
  ds_read_b128 v[36:39], v75 offset:16384
  s_waitcnt lgkmcnt(3)
  v_smfmac_f32_16x16x64_bf16 v[20:23], v[12:15], v[192:199], v74
  ds_read_b128 v[40:43], v75 offset:17408
  s_waitcnt lgkmcnt(2)
  v_smfmac_f32_16x16x64_bf16 v[24:27], v[16:19], v[60:67], v74
  ds_read_b128 v[60:63], v75 offset:18432
  v_smfmac_f32_16x16x64_bf16 v[24:27], v[4:7], v[184:191], v74
  ds_read_b128 v[64:67], v75 offset:19456
  v_add_f32 v20, v20, v22
  v_smfmac_f32_16x16x64_bf16 v[24:27], v[12:15], v[200:207], v74
  buffer_load_dword off, s[12:15], s56 sc1 lds
  v_add_f32 v21, v21, v23
  v_smfmac_f32_16x16x64_bf16 v[28:31], v[16:19], v[240:247], v74
  s_waitcnt lgkmcnt(2)
  v_mov_b64 v[70:71], s[78:79]
  v_smfmac_f32_16x16x64_bf16 v[28:31], v[8:11], v[36:43], v74
  ds_read_b128 v[36:39], v68
  v_add_f32 v24, v24, v26
  v_smfmac_f32_16x16x64_bf16 v[28:31], v[4:7], a[0:7], v74
  ds_read_b128 v[40:43], v68
  v_cvt_pk_bf16_f32 v22, v20, v24
  v_smfmac_f32_16x16x64_bf16 v[28:31], v[12:15], a[16:23], v74
  ds_write_b32 v79, v22 offset:0
  s_waitcnt lgkmcnt(3)
  v_add_f32 v25, v25, v27
  v_cvt_pk_bf16_f32 v23, v21, v25
  v_smfmac_f32_16x16x64_bf16 v[32:35], v[8:11], v[60:67], v74
  ds_write_b32 v79, v23 offset:576
  v_cmp_u_f32 vcc, v20, v21
  v_smfmac_f32_16x16x64_bf16 v[32:35], v[16:19], v[248:255], v74
  v_add_f32 v28, v28, v30
  v_smfmac_f32_16x16x64_bf16 v[32:35], v[4:7], a[8:15], v74
  v_add_f32 v29, v29, v31
  v_smfmac_f32_16x16x64_bf16 v[32:35], v[12:15], a[24:31], v74
  s_cbranch_vccnz Cf0_rec
Cf0_recok:
  s_waitcnt lgkmcnt(3)
  v_smfmac_f32_16x16x64_bf16 v[36:39], v[16:19], a[128:135], v74
  s_waitcnt lgkmcnt(0)
  s_barrier
  ds_read_b128 v[60:63], v77
  v_smfmac_f32_16x16x64_bf16 v[40:43], v[16:19], a[136:143], v74
  ds_read_b128 v[64:67], v77 offset:128
  v_add_f32 v32, v32, v34
  v_cvt_pk_bf16_f32 v30, v28, v32
  v_smfmac_f32_16x16x64_bf16 v[36:39], v[0:3], a[96:103], v74
  ds_write_b32 v79, v30 offset:256
  v_add_f32 v33, v33, v35
  v_cvt_pk_bf16_f32 v31, v29, v33
  v_smfmac_f32_16x16x64_bf16 v[40:43], v[0:3], a[104:111], v74
  ds_write_b32 v79, v31 offset:832
  v_xor_b32 v75, 0x8000, v75
  v_smfmac_f32_16x16x64_bf16 v[36:39], v[4:7], a[144:151], v74
  ds_read_b128 v[0:3], v76 offset:4608
  v_mov_b32 v29, 0
  v_smfmac_f32_16x16x64_bf16 v[40:43], v[4:7], a[152:159], v74
  s_waitcnt vmcnt(3) lgkmcnt(3)
  v_mov_b32 v30, 0
  v_mfma_f32_16x16x32_bf16 v[44:47], v[44:47], v[60:63], 0
  ds_read_b128 v[4:7], v76 offset:5632
  s_waitcnt lgkmcnt(2)
  v_mfma_f32_16x16x32_bf16 v[44:47], v[48:51], v[64:67], v[44:47]
  s_barrier
  v_smfmac_f32_16x16x64_bf16 v[36:39], v[8:11], a[112:119], v74
  ds_read_b128 v[20:23], v77 offset:256
  ds_read_b128 v[24:27], v77 offset:384
  v_smfmac_f32_16x16x64_bf16 v[40:43], v[8:11], a[120:127], v74
  ds_read_b128 v[8:11], v76 offset:6656
  v_add_f32_dpp v72, v46, v44 quad_perm:[2,3,0,1] row_mask:0xf bank_mask:0xf
  v_add_f32_dpp v73, v47, v45 quad_perm:[2,3,0,1] row_mask:0xf bank_mask:0xf
  v_smfmac_f32_16x16x64_bf16 v[36:39], v[12:15], a[160:167], v74
  s_waitcnt lgkmcnt(4)
  v_exp_f32_dpp v72, v72 quad_perm:[0,1,0,1] row_mask:0xf bank_mask:0xf
  v_smfmac_f32_16x16x64_bf16 v[40:43], v[12:15], a[168:175], v74
  ds_read_b128 v[12:15], v76 offset:7680
  v_exp_f32_dpp v73, v73 quad_perm:[0,1,0,1] row_mask:0xf bank_mask:0xf
  v_smfmac_f32_16x16x64_bf16 v[36:39], v[0:3], a[32:39], v74
  s_waitcnt lgkmcnt(2)
  v_cvt_pk_bf16_f32 v72, v72, v73
  v_mfma_f32_16x16x32_bf16 v[20:23], v[20:23], v[60:63], 0
  ds_write_b32 v78, v72 offset:512
  v_mov_b64 v[16:17], 0
  v_mfma_f32_16x16x32_bf16 v[20:23], v[24:27], v[64:67], v[20:23]
  ds_read_b128 v[44:47], v75 offset:16384
  v_mov_b64 v[18:19], 0
  v_smfmac_f32_16x16x64_bf16 v[40:43], v[0:3], a[40:47], v74
  ds_read_b128 v[48:51], v75 offset:17408
  v_mov_b64 v[68:69], s[78:79]
  v_smfmac_f32_16x16x64_bf16 v[36:39], v[4:7], a[48:55], v74
  s_waitcnt lgkmcnt(4)
  v_add_f32_dpp v24, v22, v20 quad_perm:[2,3,0,1] row_mask:0xf bank_mask:0xf
  v_add_f32_dpp v25, v23, v21 quad_perm:[2,3,0,1] row_mask:0xf bank_mask:0xf
  v_smfmac_f32_16x16x64_bf16 v[36:39], v[8:11], a[64:71], v74
  s_waitcnt lgkmcnt(2)
  s_barrier
  ds_read_b128 v[32:35], v78 offset:512
  v_smfmac_f32_16x16x64_bf16 v[36:39], v[12:15], a[80:87], v74
  ds_read_b128 v[60:63], v75 offset:18432
  v_mul_f32 v24, s69, v24
  v_smfmac_f32_16x16x64_bf16 v[40:43], v[4:7], a[56:63], v74
  ds_read_b128 v[64:67], v75 offset:19456
  v_mul_f32 v25, s69, v25
  v_smfmac_f32_16x16x64_bf16 v[40:43], v[8:11], a[72:79], v74
  v_exp_f32_dpp v24, v24 quad_perm:[0,1,0,1] row_mask:0xf bank_mask:0xf
  v_smfmac_f32_16x16x64_bf16 v[40:43], v[12:15], a[88:95], v74
  s_waitcnt lgkmcnt(2)
  v_exp_f32_dpp v25, v25 quad_perm:[0,1,0,1] row_mask:0xf bank_mask:0xf
  v_mfma_f32_16x16x32_bf16 v[8:11], v[32:35], v[68:71], 0
  v_add_f32 v36, v36, v38
  v_add_f32 v37, v37, v39
  v_mfma_f32_16x16x32_bf16 v[0:3], v[32:35], v[52:55], 0
  v_add_f32 v40, v40, v42
  v_add_f32 v41, v41, v43
  v_mfma_f32_16x16x32_bf16 v[4:7], v[32:35], v[56:59], 0
  v_cvt_pk_bf16_f32 v28, v24, v25
  v_cvt_pk_bf16_f32 v72, v36, v37
  v_cvt_pk_bf16_f32 v73, v40, v41
  v_mfma_f32_16x16x16_bf16 v[8:11], v[28:29], v[68:69], v[8:11]
  v_cvt_pk_bf16_f32 v31, v24, v25
  v_mov_b64 v[20:21], 0
  v_mfma_f32_16x16x16_bf16 v[0:3], v[28:29], v[72:73], v[0:3]
  ds_read_b128 v[68:71], v76 offset:13824
  v_mov_b64 v[22:23], 0
  v_mfma_f32_16x16x16_bf16 v[4:7], v[30:31], v[72:73], v[4:7]
  v_rcp_f32 v10, v8
  v_rcp_f32 v11, v9
  v_mul_f32 v0, v10, v0
  v_mul_f32 v1, v11, v1
  s_nop 0
  v_mul_f32 v4, v10, v4
  v_mul_f32 v5, v11, v5
  v_cvt_pk_bf16_f32 v2, v0, v4
  ds_write_b32 v79, v2 offset:8704
  v_cvt_pk_bf16_f32 v3, v1, v5
  ds_write_b32 v79, v3 offset:9280
  v_max3_f32 v8, v8, v9, v10
  v_max_f32 v8, v8, v11
  v_cmp_le_f32 vcc, 1317011456, v8
  v_mov_b64 v[24:25], 0
  v_mov_b64 v[26:27], 0
  s_cbranch_vccnz Cf0_mx
Cf0_mxok:
  s_waitcnt lgkmcnt(0)
  s_barrier
  ds_read_b128 v[0:3], v78 offset:8704
  ds_read_b128 v[4:7], v78 offset:8768
  ds_read_b128 v[8:11], v78 offset:8832
  ds_read_b128 v[12:15], v78 offset:8896
  s_waitcnt lgkmcnt(3)
  v_smfmac_f32_16x16x64_bf16 v[16:19], v[0:3], v[44:51], v74
  ds_read_b128 v[52:55], v75 offset:32768
  s_waitcnt lgkmcnt(3)
  v_smfmac_f32_16x16x64_bf16 v[16:19], v[4:7], v[60:67], v74
  ds_read_b128 v[56:59], v75 offset:33792
  s_waitcnt lgkmcnt(3)
  v_smfmac_f32_16x16x64_bf16 v[16:19], v[8:11], a[176:183], v74
  ds_read_b128 v[36:39], v75 offset:34816
  s_waitcnt lgkmcnt(3)
  v_smfmac_f32_16x16x64_bf16 v[16:19], v[12:15], a[184:191], v74
  ds_read_b128 v[40:43], v75 offset:35840
  ds_read_b128 v[44:47], v75 offset:49152
  v_smfmac_f32_16x16x64_bf16 v[20:23], v[0:3], a[192:199], v74
  ds_read_b128 v[48:51], v75 offset:50176
  ds_read_b128 v[60:63], v75 offset:51200
  v_smfmac_f32_16x16x64_bf16 v[20:23], v[4:7], a[200:207], v74
  ds_read_b128 v[64:67], v75 offset:52224
  s_waitcnt lgkmcnt(6)
  v_cvt_pk_bf16_f32 v16, v16, v17
  v_cvt_pk_bf16_f32 v17, v18, v19
  v_bfi_b32 v16, 1, s72, v16
  v_smfmac_f32_16x16x64_bf16 v[20:23], v[8:11], v[52:59], v74
  buffer_store_dwordx2 v[16:17], v68, s[8:11], s73 offen
  s_waitcnt lgkmcnt(4)
  v_smfmac_f32_16x16x64_bf16 v[20:23], v[12:15], v[36:43], v74
  v_mov_b64 v[32:33], 0
  v_smfmac_f32_16x16x64_bf16 v[24:27], v[0:3], a[208:215], v74
  v_mov_b64 v[34:35], 0
  v_smfmac_f32_16x16x64_bf16 v[24:27], v[4:7], a[216:223], v74
  s_waitcnt lgkmcnt(2)
  v_cvt_pk_bf16_f32 v20, v20, v21
  v_cvt_pk_bf16_f32 v21, v22, v23
  v_bfi_b32 v20, 1, s72, v20
  v_smfmac_f32_16x16x64_bf16 v[24:27], v[8:11], v[44:51], v74
  buffer_store_dwordx2 v[20:21], v68, s[8:11], s74 offen
  s_waitcnt lgkmcnt(0)
  v_smfmac_f32_16x16x64_bf16 v[24:27], v[12:15], v[60:67], v74
  v_smfmac_f32_16x16x64_bf16 v[32:35], v[0:3], a[224:231], v74
  v_smfmac_f32_16x16x64_bf16 v[32:35], v[4:7], a[232:239], v74
  v_cvt_pk_bf16_f32 v24, v24, v25
  v_cvt_pk_bf16_f32 v25, v26, v27
  v_bfi_b32 v24, 1, s72, v24
  v_smfmac_f32_16x16x64_bf16 v[32:35], v[8:11], a[240:247], v74
  s_nop 1
  buffer_store_dwordx2 v[24:25], v68, s[8:11], s75 offen
  v_smfmac_f32_16x16x64_bf16 v[32:35], v[12:15], a[248:255], v74
  ds_read_b128 v[0:3], v76 offset:14848
  ds_read_b64 v[16:17], v77 offset:256
  v_mov_b64 v[18:19], v[72:73]
  v_xor_b32 v75, 0x8000, v75
  s_nop 3
  v_cvt_pk_bf16_f32 v32, v32, v33
  v_cvt_pk_bf16_f32 v33, v34, v35
  v_bfi_b32 v32, 1, s72, v32
  buffer_store_dwordx2 v[32:33], v68, s[8:11], s76 offen
  v_mov_b64 v[20:21], 0
  v_mov_b64 v[22:23], 0
  v_mov_b64 v[24:25], 0
  v_mov_b64 v[26:27], 0
  v_mov_b64 v[28:29], 0
  v_mov_b64 v[30:31], 0
  v_mov_b64 v[32:33], 0
  v_mov_b64 v[34:35], 0
  v_mov_b32 v68, 14880
  s_add_u32 s58, s58, 655360
  s_add_u32 s59, s59, 655360
  s_add_u32 s70, s70, 655360
  s_add_u32 s68, s68, 655360
  s_add_u32 s66, s66, 1
  s_xor_b32 s64, s64, 16384
  s_xor_b32 s65, s65, 16384
  s_cmp_eq_u32 s66, 62
  s_cselect_b64 s[16:17], s[20:21], s[16:17]
  s_cselect_b32 s18, (Cf0_done - Cf0_last), s18
  s_cselect_b32 s70, 0, s70
  s_cmp_eq_u32 s66, 63
  s_cselect_b32 s59, 268435456, s59
  s_cselect_b32 s58, 268435456, s58
  s_nop 13
  buffer_load_dwordx4 v[52:55], v76, s[8:11], s60 offen offset:0 sc1
  buffer_load_dwordx4 v[56:59], v76, s[8:11], s60 offen offset:1024 sc1
  s_waitcnt lgkmcnt(0)
  s_waitcnt vmcnt(1)
  v_mfma_f32_16x16x32_bf16 v[4:7], v[0:3], v[52:55], 0
  v_bitop3_b32 v72, v52, v54, s72 bitop3:0x7e
  s_waitcnt vmcnt(0)
  v_mfma_f32_16x16x32_bf16 v[4:7], v[0:3], v[56:59], v[4:7]
  v_bitop3_b32 v73, v56, v58, s72 bitop3:0x7e
  v_bitop3_b32 v72, v72, v73, 1 bitop3:0xa8
  v_cmp_ne_u32 vcc, 0, v72
  s_nop 0
  s_cmp_eq_u64 vcc, 0
  s_cselect_b32 s54, s62, 268435456
  s_nop 0
  v_add_f32_dpp v4, v4, v4 row_ror:4 row_mask:0xf bank_mask:0xf
  v_add_f32_dpp v5, v5, v5 row_ror:4 row_mask:0xf bank_mask:0xf
  s_nop 0
  v_add_f32_dpp v4, v4, v4 row_ror:8 row_mask:0xf bank_mask:0xf
  v_add_f32_dpp v5, v5, v5 row_ror:8 row_mask:0xf bank_mask:0xf
  v_cvt_pk_bf16_f32 v4, v4, v5
  buffer_store_dword v4, v69, s[8:11], s54 offen
  s_cbranch_vccnz Cf0_h1r
  s_xor_b32 s62, s62, 16384
  buffer_store_dword v71, v69, s[8:11], s62 offen
  s_xor_b32 s72, s72, 1
  s_branch Cf0_h2
Cf0_h1r:
  s_mov_b64 exec, vcc
  buffer_load_dwordx4 v[52:55], v76, s[8:11], s60 offen offset:0 sc1
  buffer_load_dwordx4 v[56:59], v76, s[8:11], s60 offen offset:1024 sc1
  s_mov_b64 exec, -1
  s_add_u32 s67, s67, 1
  s_waitcnt vmcnt(1)
  v_mfma_f32_16x16x32_bf16 v[4:7], v[0:3], v[52:55], 0
  v_bitop3_b32 v72, v52, v54, s72 bitop3:0x7e
  s_waitcnt vmcnt(0)
  v_mfma_f32_16x16x32_bf16 v[4:7], v[0:3], v[56:59], v[4:7]
  v_bitop3_b32 v73, v56, v58, s72 bitop3:0x7e
  v_bitop3_b32 v72, v72, v73, 1 bitop3:0xa8
  v_cmp_ne_u32 vcc, 0, v72
  s_cbranch_vccz Cf0_h1p
Cf0_h1s:
  s_mov_b64 exec, vcc
  buffer_load_dwordx4 v[52:55], v76, s[8:11], s60 offen offset:0 sc1
  buffer_load_dwordx4 v[56:59], v76, s[8:11], s60 offen offset:1024 sc1
  s_mov_b64 exec, -1
  s_add_u32 s67, s67, 1
  s_waitcnt vmcnt(1)
  v_mfma_f32_16x16x32_bf16 v[4:7], v[0:3], v[52:55], 0
  v_bitop3_b32 v72, v52, v54, s72 bitop3:0x7e
  s_waitcnt vmcnt(0)
  v_mfma_f32_16x16x32_bf16 v[4:7], v[0:3], v[56:59], v[4:7]
  v_bitop3_b32 v73, v56, v58, s72 bitop3:0x7e
  v_bitop3_b32 v72, v72, v73, 1 bitop3:0xa8
  v_cmp_ne_u32 vcc, 0, v72
  s_cbranch_vccz Cf0_h1p
  s_cmp_lt_u32 s67, 131072
  s_cbranch_scc1 Cf0_h1s
Cf0_h1p:
  s_nop 2
  v_add_f32_dpp v4, v4, v4 row_ror:4 row_mask:0xf bank_mask:0xf
  v_add_f32_dpp v5, v5, v5 row_ror:4 row_mask:0xf bank_mask:0xf
  s_nop 0
  v_add_f32_dpp v4, v4, v4 row_ror:8 row_mask:0xf bank_mask:0xf
  v_add_f32_dpp v5, v5, v5 row_ror:8 row_mask:0xf bank_mask:0xf
  v_cvt_pk_bf16_f32 v4, v4, v5
  buffer_store_dword v4, v69, s[8:11], s62 offen
  s_xor_b32 s62, s62, 16384
  buffer_store_dword v71, v69, s[8:11], s62 offen
  s_xor_b32 s72, s72, 1
  s_branch Cf0_h2
Cf0_h2r:
  s_mov_b64 exec, vcc
  buffer_load_dwordx4 v[0:3], v76, s[8:11], s65 offen offset:0 sc1
  s_mov_b64 exec, -1
  s_add_u32 s67, s67, 1
  s_waitcnt vmcnt(4)
  v_max3_u32 v72, v0, v1, v2
  v_max_u32 v72, v72, v3
  ds_write_b128 v76, v[0:3] offset:4608
  v_cmp_eq_u32 vcc, -1, v72
  s_cbranch_vccz Cf0_h2w
  s_mov_b64 exec, vcc
  buffer_load_dwordx4 v[0:3], v76, s[8:11], s65 offen offset:0 sc1
  s_mov_b64 exec, -1
  s_add_u32 s67, s67, 1
  s_waitcnt vmcnt(4)
  v_max3_u32 v72, v0, v1, v2
  v_max_u32 v72, v72, v3
  ds_write_b128 v76, v[0:3] offset:4608
  v_cmp_eq_u32 vcc, -1, v72
  s_cbranch_vccz Cf0_h2w
Cf0_h2s:
  s_mov_b64 exec, vcc
  buffer_load_dwordx4 v[0:3], v76, s[8:11], s65 offen offset:0 sc1
  s_mov_b64 exec, -1
  s_add_u32 s67, s67, 1
  s_waitcnt vmcnt(2)
  v_max3_u32 v72, v0, v1, v2
  v_max_u32 v72, v72, v3
  ds_write_b128 v76, v[0:3] offset:4608
  v_cmp_eq_u32 vcc, -1, v72
  s_cbranch_vccz Cf0_h2w
  s_mov_b64 exec, vcc
  buffer_load_dwordx4 v[0:3], v76, s[8:11], s65 offen offset:0 sc1
  s_mov_b64 exec, -1
  s_add_u32 s67, s67, 1
  s_waitcnt vmcnt(2)
  v_max3_u32 v72, v0, v1, v2
  v_max_u32 v72, v72, v3
  ds_write_b128 v76, v[0:3] offset:4608
  v_cmp_eq_u32 vcc, -1, v72
  s_cbranch_vccz Cf0_h2w
  s_mov_b64 exec, vcc
  buffer_load_dwordx4 v[0:3], v76, s[8:11], s65 offen offset:0 sc1
  s_mov_b64 exec, -1
  s_add_u32 s67, s67, 1
  s_waitcnt vmcnt(2)
  v_max3_u32 v72, v0, v1, v2
  v_max_u32 v72, v72, v3
  ds_write_b128 v76, v[0:3] offset:4608
  v_cmp_eq_u32 vcc, -1, v72
  s_cbranch_vccz Cf0_h2w
  s_cmp_lt_u32 s67, 131072
  s_cbranch_scc1 Cf0_h2s
  s_branch Cf0_h2w
Cf0_rec:
  s_nop 7
  s_waitcnt vmcnt(0) lgkmcnt(0)
  v_max3_u32 v72, v0, v1, v2
  v_max3_u32 v72, v72, v3, v4
  v_max3_u32 v72, v72, v5, v6
  v_max3_u32 v72, v72, v7, v8
  v_max3_u32 v72, v72, v9, v10
  v_max3_u32 v72, v72, v11, v12
  v_max3_u32 v72, v72, v13, v14
  v_max3_u32 v72, v72, v15, v16
  v_max3_u32 v72, v72, v17, v18
  v_max_u32 v72, v72, v19
  v_cmp_eq_u32 vcc, -1, v72
  s_cbranch_vccz Cf0_recok
  s_barrier
  v_mov_b64 v[20:21], 0
  v_mov_b64 v[22:23], 0
  v_mov_b64 v[24:25], 0
  v_mov_b64 v[26:27], 0
  v_mov_b64 v[28:29], 0
  v_mov_b64 v[30:31], 0
  v_mov_b64 v[32:33], 0
  v_mov_b64 v[34:35], 0
  s_waitcnt lgkmcnt(0)
  s_barrier
  ds_read_b128 v[0:3], v76 offset:4608
  s_waitcnt lgkmcnt(0)
  v_smfmac_f32_16x16x64_bf16 v[20:23], v[0:3], v[80:87], v74
  v_smfmac_f32_16x16x64_bf16 v[24:27], v[0:3], v[88:95], v74
  ds_read_b128 v[60:63], v76 offset:16384
  ds_read_b128 v[64:67], v76 offset:17408
  s_waitcnt lgkmcnt(0)
  v_smfmac_f32_16x16x64_bf16 v[28:31], v[0:3], v[60:67], v74
  ds_read_b128 v[60:63], v76 offset:18432
  ds_read_b128 v[64:67], v76 offset:19456
  s_waitcnt lgkmcnt(0)
  v_smfmac_f32_16x16x64_bf16 v[32:35], v[0:3], v[60:67], v74
  ds_read_b128 v[4:7], v76 offset:5632
  s_waitcnt lgkmcnt(0)
  v_smfmac_f32_16x16x64_bf16 v[20:23], v[4:7], v[96:103], v74
  v_smfmac_f32_16x16x64_bf16 v[24:27], v[4:7], v[104:111], v74
  ds_read_b128 v[60:63], v76 offset:32768
  ds_read_b128 v[64:67], v76 offset:33792
  s_waitcnt lgkmcnt(0)
  v_smfmac_f32_16x16x64_bf16 v[28:31], v[4:7], v[60:67], v74
  ds_read_b128 v[60:63], v76 offset:34816
  ds_read_b128 v[64:67], v76 offset:35840
  s_waitcnt lgkmcnt(0)
  v_smfmac_f32_16x16x64_bf16 v[32:35], v[4:7], v[60:67], v74
  ds_read_b128 v[8:11], v76 offset:6656
  s_waitcnt lgkmcnt(0)
  v_smfmac_f32_16x16x64_bf16 v[20:23], v[8:11], v[112:119], v74
  v_smfmac_f32_16x16x64_bf16 v[24:27], v[8:11], v[120:127], v74
  v_smfmac_f32_16x16x64_bf16 v[28:31], v[8:11], v[208:215], v74
  v_smfmac_f32_16x16x64_bf16 v[32:35], v[8:11], v[216:223], v74
  ds_read_b128 v[12:15], v76 offset:7680
  s_waitcnt lgkmcnt(0)
  v_smfmac_f32_16x16x64_bf16 v[20:23], v[12:15], v[128:135], v74
  v_smfmac_f32_16x16x64_bf16 v[24:27], v[12:15], v[136:143], v74
  v_smfmac_f32_16x16x64_bf16 v[28:31], v[12:15], v[224:231], v74
  v_smfmac_f32_16x16x64_bf16 v[32:35], v[12:15], v[232:239], v74
  ds_read_b128 v[0:3], v76 offset:8704
  s_waitcnt lgkmcnt(0)
  v_smfmac_f32_16x16x64_bf16 v[20:23], v[0:3], v[144:151], v74
  v_smfmac_f32_16x16x64_bf16 v[24:27], v[0:3], v[152:159], v74
  ds_read_b128 v[60:63], v76 offset:49152
  ds_read_b128 v[64:67], v76 offset:50176
  s_waitcnt lgkmcnt(0)
  v_smfmac_f32_16x16x64_bf16 v[28:31], v[0:3], v[60:67], v74
  ds_read_b128 v[60:63], v76 offset:51200
  ds_read_b128 v[64:67], v76 offset:52224
  s_waitcnt lgkmcnt(0)
  v_smfmac_f32_16x16x64_bf16 v[32:35], v[0:3], v[60:67], v74
  ds_read_b128 v[8:11], v76 offset:9728
  s_waitcnt lgkmcnt(0)
  v_smfmac_f32_16x16x64_bf16 v[20:23], v[8:11], v[160:167], v74
  v_smfmac_f32_16x16x64_bf16 v[24:27], v[8:11], v[168:175], v74
  ds_read_b128 v[60:63], v75 offset:16384
  ds_read_b128 v[64:67], v75 offset:17408
  s_waitcnt lgkmcnt(0)
  v_smfmac_f32_16x16x64_bf16 v[28:31], v[8:11], v[60:67], v74
  ds_read_b128 v[60:63], v75 offset:18432
  ds_read_b128 v[64:67], v75 offset:19456
  s_waitcnt lgkmcnt(0)
  v_smfmac_f32_16x16x64_bf16 v[32:35], v[8:11], v[60:67], v74
  ds_read_b128 v[16:19], v76 offset:10752
  ds_read_b128 v[60:63], v75 offset:0
  ds_read_b128 v[64:67], v75 offset:1024
  s_waitcnt lgkmcnt(0)
  v_smfmac_f32_16x16x64_bf16 v[20:23], v[16:19], v[60:67], v74
  ds_read_b128 v[60:63], v75 offset:2048
  ds_read_b128 v[64:67], v75 offset:3072
  s_waitcnt lgkmcnt(0)
  v_smfmac_f32_16x16x64_bf16 v[24:27], v[16:19], v[60:67], v74
  v_smfmac_f32_16x16x64_bf16 v[28:31], v[16:19], v[240:247], v74
  v_smfmac_f32_16x16x64_bf16 v[32:35], v[16:19], v[248:255], v74
  ds_read_b128 v[4:7], v76 offset:11776
  s_waitcnt lgkmcnt(0)
  v_smfmac_f32_16x16x64_bf16 v[20:23], v[4:7], v[176:183], v74
  v_smfmac_f32_16x16x64_bf16 v[24:27], v[4:7], v[184:191], v74
  v_smfmac_f32_16x16x64_bf16 v[28:31], v[4:7], a[0:7], v74
  v_smfmac_f32_16x16x64_bf16 v[32:35], v[4:7], a[8:15], v74
  ds_read_b128 v[12:15], v76 offset:12800
  s_waitcnt lgkmcnt(0)
  v_smfmac_f32_16x16x64_bf16 v[20:23], v[12:15], v[192:199], v74
  v_smfmac_f32_16x16x64_bf16 v[24:27], v[12:15], v[200:207], v74
  v_smfmac_f32_16x16x64_bf16 v[28:31], v[12:15], a[16:23], v74
  v_smfmac_f32_16x16x64_bf16 v[32:35], v[12:15], a[24:31], v74
  v_add_f32 v20, v20, v22
  v_add_f32 v21, v21, v23
  v_add_f32 v24, v24, v26
  v_cvt_pk_bf16_f32 v22, v20, v24
  s_nop 0
  ds_write_b32 v79, v22 offset:0
  v_add_f32 v25, v25, v27
  v_cvt_pk_bf16_f32 v23, v21, v25
  ds_write_b32 v79, v23 offset:576
  v_add_f32 v28, v28, v30
  v_add_f32 v29, v29, v31
  s_waitcnt lgkmcnt(0)
  s_nop 1
  s_branch Cf0_recok
Cf0_mx:
  s_waitcnt lgkmcnt(0)
  s_barrier
  buffer_load_dwordx4 v[0:3], v76, s[8:11], s58 offen offset:0 sc1
  ds_read_b128 v[20:23], v77 offset:0
  ds_read_b128 v[28:31], v77 offset:256
  buffer_load_dwordx4 v[4:7], v76, s[8:11], s58 offen offset:1024 sc1
  ds_read_b128 v[24:27], v77 offset:128
  ds_read_b128 v[32:35], v77 offset:384
  s_waitcnt vmcnt(1) lgkmcnt(3)
  v_mfma_f32_16x16x32_bf16 v[8:11], v[0:3], v[20:23], 0
  s_waitcnt vmcnt(0) lgkmcnt(1)
  v_mfma_f32_16x16x32_bf16 v[8:11], v[4:7], v[24:27], v[8:11]
  v_mfma_f32_16x16x32_bf16 v[12:15], v[28:31], v[20:23], 0
  s_waitcnt lgkmcnt(0)
  v_mfma_f32_16x16x32_bf16 v[12:15], v[32:35], v[24:27], v[12:15]
  v_add_f32_dpp v8, v10, v8 quad_perm:[2,3,0,1] row_mask:0xf bank_mask:0xf
  v_add_f32_dpp v9, v11, v9 quad_perm:[2,3,0,1] row_mask:0xf bank_mask:0xf
  s_nop 0
  v_mov_b32_dpp v8, v8 quad_perm:[0,1,0,1] row_mask:0xf bank_mask:0xf
  v_mov_b32_dpp v9, v9 quad_perm:[0,1,0,1] row_mask:0xf bank_mask:0xf
  s_nop 1
  v_add_f32_dpp v12, v14, v12 quad_perm:[2,3,0,1] row_mask:0xf bank_mask:0xf
  v_add_f32_dpp v13, v15, v13 quad_perm:[2,3,0,1] row_mask:0xf bank_mask:0xf
  s_nop 0
  v_mov_b32_dpp v12, v12 quad_perm:[0,1,0,1] row_mask:0xf bank_mask:0xf
  v_mov_b32_dpp v13, v13 quad_perm:[0,1,0,1] row_mask:0xf bank_mask:0xf
  v_mul_f32 v12, s69, v12
  ds_write_b32 v78, v8 offset:8704
  v_mul_f32 v13, s69, v13
  ds_write_b32 v78, v9 offset:8768
  s_waitcnt lgkmcnt(0)
  s_barrier
  ds_read_b128 v[36:39], v78 offset:8704
  ds_read_b128 v[40:43], v78 offset:8768
  s_waitcnt lgkmcnt(0)
  s_barrier
  v_max_f32 v16, v36, v37
  v_max3_f32 v16, v16, v38, v39
  v_max3_f32 v16, v16, v40, v41
  v_max3_f32 v16, v16, v42, v43
  v_max3_f32 v16, v16, v12, v13
  v_mov_b32 v17, v16
  s_nop 1
  v_permlane16_swap_b32 v16, v17
  v_max_f32 v16, v16, v17
  v_mov_b32 v17, v16
  s_nop 1
  v_permlane32_swap_b32 v16, v17
  v_max_f32 v16, v16, v17
  v_sub_f32 v36, v36, v16
  v_sub_f32 v37, v37, v16
  v_sub_f32 v38, v38, v16
  v_sub_f32 v39, v39, v16
  v_sub_f32 v40, v40, v16
  v_sub_f32 v41, v41, v16
  v_sub_f32 v42, v42, v16
  v_sub_f32 v43, v43, v16
  v_sub_f32 v12, v12, v16
  v_sub_f32 v13, v13, v16
  v_exp_f32 v36, v36
  v_exp_f32 v37, v37
  v_exp_f32 v38, v38
  v_exp_f32 v39, v39
  v_exp_f32 v40, v40
  v_exp_f32 v41, v41
  v_exp_f32 v42, v42
  v_exp_f32 v43, v43
  v_exp_f32 v12, v12
  v_exp_f32 v13, v13
  v_cvt_pk_bf16_f32 v32, v36, v40
  v_cvt_pk_bf16_f32 v33, v37, v41
  v_cvt_pk_bf16_f32 v34, v38, v42
  v_cvt_pk_bf16_f32 v35, v39, v43
  v_cvt_pk_bf16_f32 v28, v12, v13
  v_cvt_pk_bf16_f32 v31, v12, v13
  v_mov_b32 v29, 0
  v_mov_b32 v30, 0
  v_mov_b32 v68, 0x3f803f80
  v_mov_b32 v69, 0x3f803f80
  v_mov_b32 v70, 0x3f803f80
  v_mov_b32 v71, 0x3f803f80
  s_nop 1
  v_mfma_f32_16x16x32_bf16 v[8:11], v[32:35], v[68:71], 0
  v_mfma_f32_16x16x32_bf16 v[0:3], v[32:35], v[52:55], 0
  v_mfma_f32_16x16x32_bf16 v[4:7], v[32:35], v[56:59], 0
  v_mfma_f32_16x16x16_bf16 v[8:11], v[28:29], v[68:69], v[8:11]
  v_mfma_f32_16x16x16_bf16 v[0:3], v[28:29], v[72:73], v[0:3]
  v_mfma_f32_16x16x16_bf16 v[4:7], v[30:31], v[72:73], v[4:7]
  ds_read_b128 v[68:71], v76 offset:13824
  v_rcp_f32 v10, v8
  v_rcp_f32 v11, v9
  v_mul_f32 v0, v10, v0
  v_mul_f32 v1, v11, v1
  s_nop 0
  v_mul_f32 v4, v10, v4
  v_mul_f32 v5, v11, v5
  v_cvt_pk_bf16_f32 v2, v0, v4
  ds_write_b32 v79, v2 offset:8704
  v_cvt_pk_bf16_f32 v3, v1, v5
  ds_write_b32 v79, v3 offset:9280
  v_mov_b64 v[16:17], 0
  v_mov_b64 v[18:19], 0
  v_mov_b64 v[20:21], 0
  v_mov_b64 v[22:23], 0
  v_mov_b64 v[24:25], 0
  v_mov_b64 v[26:27], 0
  s_branch Cf0_mxok
Cf0_kv3:
  s_waitcnt lgkmcnt(0)
  s_cmp_ge_u32 s57, 0x700
  s_cbranch_scc1 Cf0_kvb
  s_load_dword s57, s[12:13], s71 glc
  s_add_u32 s67, s67, 1
  s_cmp_lt_u32 s67, 131072
  s_cbranch_scc1 Cf0_kv3
  s_waitcnt lgkmcnt(0)
  s_branch Cf0_kvb
Cf0_last:
  ds_read_b128 v[4:7], v76 offset:5632
  ds_read_b128 v[12:15], v76 offset:7680
  ds_read_b128 v[44:47], v76 offset:32768
  ds_read_b128 v[48:51], v76 offset:33792
  s_nop 5
  v_mov_b64 v[20:21], 0
  v_mov_b64 v[22:23], 0
  v_mov_b64 v[24:25], 0
  v_mov_b64 v[26:27], 0
  v_smfmac_f32_16x16x64_bf16 v[28:31], v[0:3], v[36:43], v74
  ds_read_b128 v[36:39], v76 offset:34816
  ds_read_b128 v[40:43], v76 offset:35840
  v_smfmac_f32_16x16x64_bf16 v[32:35], v[0:3], v[60:67], v74
  s_waitcnt lgkmcnt(5)
  v_smfmac_f32_16x16x64_bf16 v[20:23], v[0:3], a[32:39], v74
  ds_read_b128 v[60:63], v76 offset:49152
  ds_read_b128 v[64:67], v76 offset:50176
  v_smfmac_f32_16x16x64_bf16 v[24:27], v[0:3], a[40:47], v74
  s_waitcnt lgkmcnt(4)
  v_smfmac_f32_16x16x64_bf16 v[20:23], v[4:7], a[48:55], v74
  buffer_store_dwordx4 v[16:19], v76, s[8:11], s68 offen sc1
  v_smfmac_f32_16x16x64_bf16 v[24:27], v[4:7], a[56:63], v74
  v_smfmac_f32_16x16x64_bf16 v[28:31], v[4:7], v[44:51], v74
  s_waitcnt lgkmcnt(2)
  v_smfmac_f32_16x16x64_bf16 v[20:23], v[8:11], a[64:71], v74
  ds_read_b128 v[44:47], v76 offset:51200
  ds_read_b128 v[48:51], v76 offset:52224
  v_smfmac_f32_16x16x64_bf16 v[24:27], v[8:11], a[72:79], v74
  v_smfmac_f32_16x16x64_bf16 v[32:35], v[4:7], v[36:43], v74
  v_smfmac_f32_16x16x64_bf16 v[28:31], v[8:11], v[208:215], v74
  ds_read_b128 v[36:39], v75 offset:16384
  ds_read_b128 v[40:43], v75 offset:17408
  v_smfmac_f32_16x16x64_bf16 v[32:35], v[8:11], v[216:223], v74
  v_smfmac_f32_16x16x64_bf16 v[20:23], v[12:15], a[80:87], v74
  v_smfmac_f32_16x16x64_bf16 v[24:27], v[12:15], a[88:95], v74
  v_smfmac_f32_16x16x64_bf16 v[28:31], v[12:15], v[224:231], v74
  v_smfmac_f32_16x16x64_bf16 v[32:35], v[12:15], v[232:239], v74
  s_waitcnt vmcnt(2)
  s_waitcnt vmcnt(1)
  s_barrier
Cf0_lastr:
  ds_read_b128 v[0:3], v76 offset:8704
  ds_read_b128 v[8:11], v76 offset:9728
  ds_read_b128 v[16:19], v76 offset:10752
  ds_read_b128 v[4:7], v76 offset:11776
  ds_read_b128 v[12:15], v76 offset:12800
  s_waitcnt lgkmcnt(4)
  v_max3_u32 v72, v0, v1, v2
  s_waitcnt lgkmcnt(1)
  v_max3_u32 v72, v72, v3, v4
  v_max3_u32 v72, v72, v5, v6
  v_max3_u32 v72, v72, v7, v8
  v_max3_u32 v72, v72, v9, v10
  s_waitcnt lgkmcnt(0)
  v_max3_u32 v72, v72, v11, v12
  v_max3_u32 v72, v72, v13, v14
  v_max3_u32 v72, v72, v15, v16
  v_max3_u32 v72, v72, v17, v18
  v_max_u32 v72, v72, v19
  v_cmp_eq_u32 vcc, -1, v72
  s_cbranch_vccnz Cf0_lastp
Cf0_lastg:
  v_smfmac_f32_16x16x64_bf16 v[28:31], v[0:3], v[60:67], v74
  ds_read_b128 v[60:63], v75 offset:18432
  ds_read_b128 v[64:67], v75 offset:19456
  v_smfmac_f32_16x16x64_bf16 v[32:35], v[0:3], v[44:51], v74
  v_smfmac_f32_16x16x64_bf16 v[28:31], v[8:11], v[36:43], v74
  v_smfmac_f32_16x16x64_bf16 v[28:31], v[16:19], v[240:247], v74
  v_smfmac_f32_16x16x64_bf16 v[28:31], v[4:7], a[0:7], v74
  v_smfmac_f32_16x16x64_bf16 v[28:31], v[12:15], a[16:23], v74
  v_smfmac_f32_16x16x64_bf16 v[32:35], v[16:19], v[248:255], v74
  v_smfmac_f32_16x16x64_bf16 v[32:35], v[4:7], a[8:15], v74
  s_waitcnt lgkmcnt(0)
  v_smfmac_f32_16x16x64_bf16 v[32:35], v[12:15], a[24:31], v74
  v_smfmac_f32_16x16x64_bf16 v[32:35], v[8:11], v[60:67], v74
  v_smfmac_f32_16x16x64_bf16 v[20:23], v[0:3], a[96:103], v74
  v_smfmac_f32_16x16x64_bf16 v[20:23], v[8:11], a[112:119], v74
  v_add_f32 v28, v28, v30
  v_add_f32 v32, v32, v34
  v_cvt_pk_bf16_f32 v30, v28, v32
  v_smfmac_f32_16x16x64_bf16 v[20:23], v[16:19], a[128:135], v74
  ds_write_b32 v79, v30 offset:256
  v_add_f32 v29, v29, v31
  v_add_f32 v33, v33, v35
  v_cvt_pk_bf16_f32 v31, v29, v33
  v_smfmac_f32_16x16x64_bf16 v[20:23], v[4:7], a[144:151], v74
  ds_write_b32 v79, v31 offset:832
  v_smfmac_f32_16x16x64_bf16 v[20:23], v[12:15], a[160:167], v74
  v_smfmac_f32_16x16x64_bf16 v[24:27], v[0:3], a[104:111], v74
  v_smfmac_f32_16x16x64_bf16 v[24:27], v[8:11], a[120:127], v74
  v_smfmac_f32_16x16x64_bf16 v[24:27], v[16:19], a[136:143], v74
  s_waitcnt lgkmcnt(0)
  s_barrier
  ds_read_b64 v[52:53], v77 offset:256
  v_add_f32 v20, v20, v22
  v_smfmac_f32_16x16x64_bf16 v[24:27], v[4:7], a[152:159], v74
  v_add_f32 v21, v21, v23
  v_smfmac_f32_16x16x64_bf16 v[24:27], v[12:15], a[168:175], v74
  v_cvt_pk_bf16_f32 v54, v20, v21
  s_add_u32 s68, s68, 655360
  s_nop 3
  v_add_f32 v24, v24, v26
  v_add_f32 v25, v25, v27
  v_cvt_pk_bf16_f32 v55, v24, v25
  s_waitcnt lgkmcnt(0)
  buffer_store_dwordx4 v[52:55], v76, s[8:11], s68 offen sc1
  s_branch Cf0_done
Cf0_lastp:
  s_add_u32 s72, s72, 2
  s_cmp_ge_u32 s72, 131072
  s_cbranch_scc1 Cf0_lastg
  s_barrier
  buffer_load_dwordx4 v76, s[8:11], s55 offen offset:0 sc1 lds
  s_waitcnt vmcnt(0)
  s_barrier
  s_branch Cf0_lastr
Cf0_done:
  s_branch L_cexit
L_w1:
  v_mov_b64 v[20:21], 0
  v_mov_b64 v[22:23], 0
  v_mov_b64 v[24:25], 0
  v_mov_b64 v[26:27], 0
  v_mov_b64 v[28:29], 0
  v_mov_b64 v[30:31], 0
  v_mov_b64 v[32:33], 0
  v_mov_b64 v[34:35], 0
  s_mov_b32 s78, 0x3f803f80
  s_mov_b32 s79, s78
  s_mov_b32 s65, 360448
  s_mov_b32 m0, 15872
  s_lshl_b32 s71, s53, 2
  s_add_u32 s71, s71, 128
  s_movk_i32 s56, 0x1000
  v_lshlrev_b32 v73, 2, v76
  v_mov_b32 v72, 0
  s_mov_b64 s[16:17], s[8:9]
  s_mov_b32 s18, 268435456
  s_mov_b32 s19, 0x20000
  s_getpc_b64 s[20:21]
Cf1_pc:
  s_add_u32 s20, s20, (Cf1_last - Cf1_pc)
  s_addc_u32 s21, s21, 0
  v_mov_b32 v68, 14880
  buffer_load_dwordx4 v[52:55], v76, s[8:11], s59 offen offset:0 sc1
  buffer_load_dwordx4 v[56:59], v76, s[8:11], s59 offen offset:1024 sc1
  ds_read_b128 v[36:39], v76 offset:20480
  ds_read_b128 v[40:43], v76 offset:21504
  ds_read_b128 v[60:63], v76 offset:22528
  ds_read_b128 v[64:67], v76 offset:23552
  ds_read_b128 v[0:3], v76 offset:4608
  ds_read_b128 v[4:7], v76 offset:5632
  ds_read_b128 v[8:11], v76 offset:6656
  ds_read_b128 v[12:15], v76 offset:7680
  s_waitcnt lgkmcnt(0)
  s_cmp_eq_u32 s66, 1
  s_branch Cf1_top2
.p2align 6
Cf1_h2:
  v_lshlrev_b32 v73, 2, v76
  s_mov_b32 m0, 11776
  s_add_u32 s55, s65, 7168
  s_nop 15
  s_nop 3
  buffer_load_dwordx4 v[8:11], v76, s[8:11], s65 offen offset:2048 sc1
  s_nop 15
  s_nop 3
  buffer_load_dwordx4 v[8:11], v76, s[8:11], s65 offen offset:2048 sc1
  s_nop 15
  s_nop 3
  buffer_load_dwordx4 v[8:11], v76, s[8:11], s65 offen offset:2048 sc1
  s_waitcnt vmcnt(5)
  ds_read_b128 v[36:39], v76 offset:20480
  ds_read_b128 v[40:43], v76 offset:21504
  ds_read_b128 v[60:63], v76 offset:22528
  ds_read_b128 v[64:67], v76 offset:23552
  buffer_load_dwordx4 v[52:55], v76, s[8:11], s59 offen offset:0 sc1
  buffer_load_dwordx4 v[56:59], v76, s[8:11], s59 offen offset:1024 sc1
  s_waitcnt vmcnt(4)
  v_max3_u32 v72, v8, v9, v10
  v_max_u32 v72, v72, v11
  ds_write_b128 v76, v[8:11] offset:6656
  v_cmp_eq_u32 vcc, -1, v72
  s_cbranch_vccnz Cf1_h2r
Cf1_h2w:
  s_cmp_eq_u32 s66, 63
  s_waitcnt lgkmcnt(0)
  s_barrier
  ds_read_b128 v[0:3], v76 offset:4608
  buffer_load_dwordx4 v76, s[8:11], s55 offen offset:0 sc1 lds
Cf1_top2:
  v_smfmac_f32_16x16x64_bf16 v[20:23], v[8:11], v[112:119], v74
  s_cbranch_scc1 Cf1_last
  v_smfmac_f32_16x16x64_bf16 v[24:27], v[8:11], v[120:127], v74
  buffer_load_dwordx4 v[44:47], v76, s[8:11], s58 offen offset:0 sc1
  s_mov_b32 m0, 15872
  v_smfmac_f32_16x16x64_bf16 v[28:31], v[8:11], v[208:215], v74
  buffer_load_dwordx4 v[48:51], v76, s[8:11], s58 offen offset:1024 sc1
  v_smfmac_f32_16x16x64_bf16 v[32:35], v[8:11], v[216:223], v74
  ds_read_b128 v[4:7], v76 offset:5632
  s_waitcnt lgkmcnt(1)
  v_smfmac_f32_16x16x64_bf16 v[20:23], v[0:3], v[80:87], v74
  ds_read_b128 v[12:15], v76 offset:7680
  v_smfmac_f32_16x16x64_bf16 v[28:31], v[0:3], v[36:43], v74
  ds_read_b128 v[36:39], v76 offset:36864
  v_smfmac_f32_16x16x64_bf16 v[24:27], v[0:3], v[88:95], v74
  buffer_store_dwordx4 v[16:19], v76, s[8:11], s68 offen sc1
  ds_read_b128 v[40:43], v76 offset:37888
  v_smfmac_f32_16x16x64_bf16 v[32:35], v[0:3], v[60:67], v74
  ds_read_b128 v[60:63], v76 offset:38912
  s_waitcnt lgkmcnt(4)
  v_smfmac_f32_16x16x64_bf16 v[20:23], v[4:7], v[96:103], v74
  ds_read_b128 v[64:67], v76 offset:39936
  v_smfmac_f32_16x16x64_bf16 v[24:27], v[4:7], v[104:111], v74
  buffer_load_dword v73, s[16:19], s70 offen lds
  s_waitcnt vmcnt(5)
  s_waitcnt lgkmcnt(4)
  v_smfmac_f32_16x16x64_bf16 v[20:23], v[12:15], v[128:135], v74
  s_barrier
  s_waitcnt lgkmcnt(2)
  v_smfmac_f32_16x16x64_bf16 v[28:31], v[4:7], v[36:43], v74
  ds_read_b128 v[8:11], v76 offset:8704
  v_smfmac_f32_16x16x64_bf16 v[24:27], v[12:15], v[136:143], v74
  ds_read_b128 v[36:39], v76 offset:53248
  s_waitcnt lgkmcnt(2)
  v_smfmac_f32_16x16x64_bf16 v[32:35], v[4:7], v[60:67], v74
  ds_read_b128 v[40:43], v76 offset:54272
  v_smfmac_f32_16x16x64_bf16 v[28:31], v[12:15], v[224:231], v74
  ds_read_b128 v[60:63], v76 offset:55296
  v_smfmac_f32_16x16x64_bf16 v[32:35], v[12:15], v[232:239], v74
  ds_read_b128 v[64:67], v76 offset:56320
  s_waitcnt lgkmcnt(4)
  v_smfmac_f32_16x16x64_bf16 v[20:23], v[8:11], v[144:151], v74
  s_waitcnt vmcnt(4)
  ds_read_b128 v[0:3], v76 offset:9728
  s_waitcnt lgkmcnt(3)
  v_smfmac_f32_16x16x64_bf16 v[28:31], v[8:11], v[36:43], v74
  s_barrier
  ds_read_b128 v[4:7], v76 offset:11776
  v_smfmac_f32_16x16x64_bf16 v[24:27], v[8:11], v[152:159], v74
  ds_read_b128 v[36:39], v75 offset:4096
  ds_read_b128 v[40:43], v75 offset:5120
  s_waitcnt lgkmcnt(4)
  v_smfmac_f32_16x16x64_bf16 v[32:35], v[8:11], v[60:67], v74
  ds_read_b128 v[16:19], v76 offset:10752
  s_waitcnt lgkmcnt(4)
  v_smfmac_f32_16x16x64_bf16 v[20:23], v[0:3], v[160:167], v74
  ds_read_b128 v[12:15], v76 offset:12800
  v_smfmac_f32_16x16x64_bf16 v[24:27], v[0:3], v[168:175], v74
  ds_read_b128 v[60:63], v75 offset:6144
  ds_read_b128 v[64:67], v75 offset:7168
  s_waitcnt lgkmcnt(6)
  v_smfmac_f32_16x16x64_bf16 v[20:23], v[4:7], v[176:183], v74
  s_waitcnt lgkmcnt(3)
  v_smfmac_f32_16x16x64_bf16 v[20:23], v[16:19], v[36:43], v74
  ds_read_b128 v[36:39], v75 offset:20480
  s_waitcnt lgkmcnt(3)
  v_smfmac_f32_16x16x64_bf16 v[20:23], v[12:15], v[192:199], v74
  ds_read_b128 v[40:43], v75 offset:21504
  s_waitcnt lgkmcnt(2)
  v_smfmac_f32_16x16x64_bf16 v[24:27], v[16:19], v[60:67], v74
  ds_read_b128 v[60:63], v75 offset:22528
  v_smfmac_f32_16x16x64_bf16 v[24:27], v[4:7], v[184:191], v74
  ds_read_b128 v[64:67], v75 offset:23552
  v_add_f32 v20, v20, v22
  v_smfmac_f32_16x16x64_bf16 v[24:27], v[12:15], v[200:207], v74
  v_add_f32 v21, v21, v23
  v_smfmac_f32_16x16x64_bf16 v[28:31], v[16:19], v[240:247], v74
  s_waitcnt lgkmcnt(2)
  v_mov_b64 v[70:71], s[78:79]
  v_smfmac_f32_16x16x64_bf16 v[28:31], v[0:3], v[36:43], v74
  ds_read_b128 v[36:39], v68
  v_add_f32 v24, v24, v26
  v_smfmac_f32_16x16x64_bf16 v[28:31], v[4:7], a[0:7], v74
  ds_read_b128 v[40:43], v68
  v_cvt_pk_bf16_f32 v22, v20, v24
  v_smfmac_f32_16x16x64_bf16 v[28:31], v[12:15], a[16:23], v74
  ds_write_b32 v79, v22 offset:0
  s_waitcnt lgkmcnt(3)
  v_add_f32 v25, v25, v27
  v_cvt_pk_bf16_f32 v23, v21, v25
  v_smfmac_f32_16x16x64_bf16 v[32:35], v[0:3], v[60:67], v74
  ds_write_b32 v79, v23 offset:576
  v_cmp_u_f32 vcc, v20, v21
  v_smfmac_f32_16x16x64_bf16 v[32:35], v[16:19], v[248:255], v74
  v_add_f32 v28, v28, v30
  v_smfmac_f32_16x16x64_bf16 v[32:35], v[4:7], a[8:15], v74
  v_add_f32 v29, v29, v31
  v_smfmac_f32_16x16x64_bf16 v[32:35], v[12:15], a[24:31], v74
  s_cbranch_vccnz Cf1_rec
Cf1_recok:
  s_waitcnt lgkmcnt(3)
  v_smfmac_f32_16x16x64_bf16 v[36:39], v[16:19], a[128:135], v74
  s_waitcnt lgkmcnt(0)
  s_barrier
  ds_read_b128 v[60:63], v77
  v_smfmac_f32_16x16x64_bf16 v[40:43], v[16:19], a[136:143], v74
  ds_read_b128 v[64:67], v77 offset:128
  v_add_f32 v32, v32, v34
  v_cvt_pk_bf16_f32 v30, v28, v32
  v_smfmac_f32_16x16x64_bf16 v[36:39], v[0:3], a[112:119], v74
  ds_write_b32 v79, v30 offset:256
  v_add_f32 v33, v33, v35
  v_cvt_pk_bf16_f32 v31, v29, v33
  v_smfmac_f32_16x16x64_bf16 v[40:43], v[0:3], a[120:127], v74
  ds_write_b32 v79, v31 offset:832
  v_xor_b32 v75, 0x8000, v75
  v_smfmac_f32_16x16x64_bf16 v[36:39], v[4:7], a[144:151], v74
  ds_read_b128 v[0:3], v76 offset:4608
  v_mov_b32 v29, 0
  v_smfmac_f32_16x16x64_bf16 v[40:43], v[4:7], a[152:159], v74
  s_waitcnt vmcnt(2) lgkmcnt(3)
  v_mov_b32 v30, 0
  v_mfma_f32_16x16x32_bf16 v[44:47], v[44:47], v[60:63], 0
  ds_read_b128 v[4:7], v76 offset:5632
  s_waitcnt lgkmcnt(2)
  v_mfma_f32_16x16x32_bf16 v[44:47], v[48:51], v[64:67], v[44:47]
  s_barrier
  v_smfmac_f32_16x16x64_bf16 v[36:39], v[8:11], a[96:103], v74
  ds_read_b128 v[20:23], v77 offset:256
  ds_read_b128 v[24:27], v77 offset:384
  v_smfmac_f32_16x16x64_bf16 v[40:43], v[8:11], a[104:111], v74
  ds_read_b128 v[8:11], v76 offset:6656
  v_add_f32_dpp v72, v46, v44 quad_perm:[2,3,0,1] row_mask:0xf bank_mask:0xf
  v_add_f32_dpp v73, v47, v45 quad_perm:[2,3,0,1] row_mask:0xf bank_mask:0xf
  v_smfmac_f32_16x16x64_bf16 v[36:39], v[12:15], a[160:167], v74
  s_waitcnt lgkmcnt(4)
  v_exp_f32_dpp v72, v72 quad_perm:[0,1,0,1] row_mask:0xf bank_mask:0xf
  v_smfmac_f32_16x16x64_bf16 v[40:43], v[12:15], a[168:175], v74
  ds_read_b128 v[12:15], v76 offset:7680
  v_exp_f32_dpp v73, v73 quad_perm:[0,1,0,1] row_mask:0xf bank_mask:0xf
  v_smfmac_f32_16x16x64_bf16 v[36:39], v[0:3], a[32:39], v74
  s_waitcnt lgkmcnt(2)
  v_cvt_pk_bf16_f32 v72, v72, v73
  v_mfma_f32_16x16x32_bf16 v[20:23], v[20:23], v[60:63], 0
  ds_write_b32 v78, v72 offset:516
  v_mov_b64 v[16:17], 0
  v_mfma_f32_16x16x32_bf16 v[20:23], v[24:27], v[64:67], v[20:23]
  ds_read_b128 v[44:47], v75 offset:20480
  v_mov_b64 v[18:19], 0
  v_smfmac_f32_16x16x64_bf16 v[40:43], v[0:3], a[40:47], v74
  ds_read_b128 v[48:51], v75 offset:21504
  v_mov_b64 v[68:69], s[78:79]
  v_smfmac_f32_16x16x64_bf16 v[36:39], v[4:7], a[48:55], v74
  s_waitcnt lgkmcnt(4)
  v_add_f32_dpp v24, v22, v20 quad_perm:[2,3,0,1] row_mask:0xf bank_mask:0xf
  v_add_f32_dpp v25, v23, v21 quad_perm:[2,3,0,1] row_mask:0xf bank_mask:0xf
  v_smfmac_f32_16x16x64_bf16 v[36:39], v[8:11], a[64:71], v74
  s_waitcnt lgkmcnt(2)
  s_barrier
  ds_read_b128 v[32:35], v78 offset:512
  v_smfmac_f32_16x16x64_bf16 v[36:39], v[12:15], a[80:87], v74
  ds_read_b128 v[60:63], v75 offset:22528
  v_mul_f32 v24, s69, v24
  v_smfmac_f32_16x16x64_bf16 v[40:43], v[4:7], a[56:63], v74
  ds_read_b128 v[64:67], v75 offset:23552
  v_mul_f32 v25, s69, v25
  v_smfmac_f32_16x16x64_bf16 v[40:43], v[8:11], a[72:79], v74
  v_exp_f32_dpp v24, v24 quad_perm:[0,1,0,1] row_mask:0xf bank_mask:0xf
  v_smfmac_f32_16x16x64_bf16 v[40:43], v[12:15], a[88:95], v74
  s_waitcnt lgkmcnt(2)
  v_exp_f32_dpp v25, v25 quad_perm:[0,1,0,1] row_mask:0xf bank_mask:0xf
  v_mfma_f32_16x16x32_bf16 v[8:11], v[32:35], v[68:71], 0
  v_add_f32 v36, v36, v38
  v_add_f32 v37, v37, v39
  v_mfma_f32_16x16x32_bf16 v[0:3], v[32:35], v[52:55], 0
  v_add_f32 v40, v40, v42
  v_add_f32 v41, v41, v43
  v_mfma_f32_16x16x32_bf16 v[4:7], v[32:35], v[56:59], 0
  v_cvt_pk_bf16_f32 v28, v24, v25
  v_cvt_pk_bf16_f32 v72, v36, v37
  v_cvt_pk_bf16_f32 v73, v40, v41
  v_mfma_f32_16x16x16_bf16 v[8:11], v[28:29], v[68:69], v[8:11]
  v_cvt_pk_bf16_f32 v31, v24, v25
  v_mov_b64 v[20:21], 0
  v_mfma_f32_16x16x16_bf16 v[0:3], v[28:29], v[72:73], v[0:3]
  ds_read_b128 v[68:71], v76 offset:13824
  v_mov_b64 v[22:23], 0
  v_mfma_f32_16x16x16_bf16 v[4:7], v[30:31], v[72:73], v[4:7]
  v_rcp_f32 v10, v8
  v_rcp_f32 v11, v9
  v_mul_f32 v0, v10, v0
  v_mul_f32 v1, v11, v1
  s_nop 0
  v_mul_f32 v4, v10, v4
  v_mul_f32 v5, v11, v5
  v_cvt_pk_bf16_f32 v2, v0, v4
  ds_write_b32 v79, v2 offset:8704
  v_cvt_pk_bf16_f32 v3, v1, v5
  ds_write_b32 v79, v3 offset:9280
  v_max3_f32 v8, v8, v9, v10
  v_max_f32 v8, v8, v11
  v_cmp_le_f32 vcc, 1317011456, v8
  v_mov_b64 v[24:25], 0
  v_mov_b64 v[26:27], 0
  s_cbranch_vccnz Cf1_mx
Cf1_mxok:
  s_waitcnt lgkmcnt(0)
  s_barrier
  ds_read_b128 v[0:3], v78 offset:8704
  ds_read_b128 v[4:7], v78 offset:8768
  ds_read_b128 v[8:11], v78 offset:8832
  ds_read_b128 v[12:15], v78 offset:8896
  s_waitcnt lgkmcnt(3)
  v_smfmac_f32_16x16x64_bf16 v[16:19], v[0:3], v[44:51], v74
  ds_read_b128 v[52:55], v75 offset:36864
  s_waitcnt lgkmcnt(3)
  v_smfmac_f32_16x16x64_bf16 v[16:19], v[4:7], v[60:67], v74
  ds_read_b128 v[56:59], v75 offset:37888
  s_waitcnt lgkmcnt(3)
  v_smfmac_f32_16x16x64_bf16 v[16:19], v[8:11], a[176:183], v74
  ds_read_b128 v[36:39], v75 offset:38912
  s_waitcnt lgkmcnt(3)
  v_smfmac_f32_16x16x64_bf16 v[16:19], v[12:15], a[184:191], v74
  ds_read_b128 v[40:43], v75 offset:39936
  ds_read_b128 v[44:47], v75 offset:53248
  v_smfmac_f32_16x16x64_bf16 v[20:23], v[0:3], a[192:199], v74
  ds_read_b128 v[48:51], v75 offset:54272
  ds_read_b128 v[60:63], v75 offset:55296
  v_smfmac_f32_16x16x64_bf16 v[20:23], v[4:7], a[200:207], v74
  ds_read_b128 v[64:67], v75 offset:56320
  s_waitcnt lgkmcnt(6)
  v_cvt_pk_bf16_f32 v16, v16, v17
  v_cvt_pk_bf16_f32 v17, v18, v19
  v_bfi_b32 v16, 1, s72, v16
  v_smfmac_f32_16x16x64_bf16 v[20:23], v[8:11], v[52:59], v74
  buffer_store_dwordx2 v[16:17], v68, s[8:11], s73 offen
  s_waitcnt lgkmcnt(4)
  v_smfmac_f32_16x16x64_bf16 v[20:23], v[12:15], v[36:43], v74
  v_mov_b64 v[32:33], 0
  v_smfmac_f32_16x16x64_bf16 v[24:27], v[0:3], a[208:215], v74
  v_mov_b64 v[34:35], 0
  v_smfmac_f32_16x16x64_bf16 v[24:27], v[4:7], a[216:223], v74
  s_waitcnt lgkmcnt(2)
  v_cvt_pk_bf16_f32 v20, v20, v21
  v_cvt_pk_bf16_f32 v21, v22, v23
  v_bfi_b32 v20, 1, s72, v20
  v_smfmac_f32_16x16x64_bf16 v[24:27], v[8:11], v[44:51], v74
  buffer_store_dwordx2 v[20:21], v68, s[8:11], s74 offen
  s_waitcnt lgkmcnt(0)
  v_smfmac_f32_16x16x64_bf16 v[24:27], v[12:15], v[60:67], v74
  v_smfmac_f32_16x16x64_bf16 v[32:35], v[0:3], a[224:231], v74
  v_smfmac_f32_16x16x64_bf16 v[32:35], v[4:7], a[232:239], v74
  v_cvt_pk_bf16_f32 v24, v24, v25
  v_cvt_pk_bf16_f32 v25, v26, v27
  v_bfi_b32 v24, 1, s72, v24
  v_smfmac_f32_16x16x64_bf16 v[32:35], v[8:11], a[240:247], v74
  s_nop 1
  buffer_store_dwordx2 v[24:25], v68, s[8:11], s75 offen
  v_smfmac_f32_16x16x64_bf16 v[32:35], v[12:15], a[248:255], v74
  ds_read_b128 v[0:3], v76 offset:14848
  ds_read_b64 v[16:17], v77 offset:264
  v_mov_b64 v[18:19], v[72:73]
  v_xor_b32 v75, 0x8000, v75
  s_nop 3
  v_cvt_pk_bf16_f32 v32, v32, v33
  v_cvt_pk_bf16_f32 v33, v34, v35
  v_bfi_b32 v32, 1, s72, v32
  buffer_store_dwordx2 v[32:33], v68, s[8:11], s76 offen
  v_mov_b64 v[20:21], 0
  v_mov_b64 v[22:23], 0
  v_mov_b64 v[24:25], 0
  v_mov_b64 v[26:27], 0
  v_mov_b64 v[28:29], 0
  v_mov_b64 v[30:31], 0
  v_mov_b64 v[32:33], 0
  v_mov_b64 v[34:35], 0
  v_mov_b32 v68, 14880
  s_add_u32 s58, s58, 655360
  s_add_u32 s59, s59, 655360
  s_add_u32 s70, s70, 655360
  s_add_u32 s68, s68, 655360
  s_add_u32 s66, s66, 1
  s_xor_b32 s64, s64, 16384
  s_xor_b32 s65, s65, 16384
  s_cmp_eq_u32 s66, 62
  s_cselect_b64 s[16:17], s[20:21], s[16:17]
  s_cselect_b32 s18, (Cf1_done - Cf1_last), s18
  s_cselect_b32 s70, 0, s70
  s_cmp_eq_u32 s66, 63
  s_cselect_b32 s59, 268435456, s59
  s_cselect_b32 s58, 268435456, s58
  s_nop 15
  s_nop 13
  buffer_load_dwordx4 v[52:55], v76, s[8:11], s60 offen offset:0 sc1
  buffer_load_dwordx4 v[56:59], v76, s[8:11], s60 offen offset:1024 sc1
  s_waitcnt lgkmcnt(0)
  s_waitcnt vmcnt(1)
  v_mfma_f32_16x16x32_bf16 v[4:7], v[0:3], v[52:55], 0
  v_bitop3_b32 v72, v52, v54, s72 bitop3:0x7e
  s_waitcnt vmcnt(0)
  v_mfma_f32_16x16x32_bf16 v[4:7], v[0:3], v[56:59], v[4:7]
  v_bitop3_b32 v73, v56, v58, s72 bitop3:0x7e
  v_bitop3_b32 v72, v72, v73, 1 bitop3:0xa8
  v_cmp_ne_u32 vcc, 0, v72
  s_nop 0
  s_cmp_eq_u64 vcc, 0
  s_cselect_b32 s54, s62, 268435456
  s_nop 0
  v_add_f32_dpp v4, v4, v4 row_ror:4 row_mask:0xf bank_mask:0xf
  v_add_f32_dpp v5, v5, v5 row_ror:4 row_mask:0xf bank_mask:0xf
  s_nop 0
  v_add_f32_dpp v4, v4, v4 row_ror:8 row_mask:0xf bank_mask:0xf
  v_add_f32_dpp v5, v5, v5 row_ror:8 row_mask:0xf bank_mask:0xf
  v_cvt_pk_bf16_f32 v4, v4, v5
  buffer_store_dword v4, v69, s[8:11], s54 offen
  s_cbranch_vccnz Cf1_h1r
  s_xor_b32 s62, s62, 16384
  buffer_store_dword v71, v69, s[8:11], s62 offen
  s_xor_b32 s72, s72, 1
  s_branch Cf1_h2
Cf1_h1r:
  s_mov_b64 exec, vcc
  buffer_load_dwordx4 v[52:55], v76, s[8:11], s60 offen offset:0 sc1
  buffer_load_dwordx4 v[56:59], v76, s[8:11], s60 offen offset:1024 sc1
  s_mov_b64 exec, -1
  s_add_u32 s67, s67, 1
  s_waitcnt vmcnt(1)
  v_mfma_f32_16x16x32_bf16 v[4:7], v[0:3], v[52:55], 0
  v_bitop3_b32 v72, v52, v54, s72 bitop3:0x7e
  s_waitcnt vmcnt(0)
  v_mfma_f32_16x16x32_bf16 v[4:7], v[0:3], v[56:59], v[4:7]
  v_bitop3_b32 v73, v56, v58, s72 bitop3:0x7e
  v_bitop3_b32 v72, v72, v73, 1 bitop3:0xa8
  v_cmp_ne_u32 vcc, 0, v72
  s_cbranch_vccz Cf1_h1p
Cf1_h1s:
  s_mov_b64 exec, vcc
  buffer_load_dwordx4 v[52:55], v76, s[8:11], s60 offen offset:0 sc1
  buffer_load_dwordx4 v[56:59], v76, s[8:11], s60 offen offset:1024 sc1
  s_mov_b64 exec, -1
  s_add_u32 s67, s67, 1
  s_waitcnt vmcnt(1)
  v_mfma_f32_16x16x32_bf16 v[4:7], v[0:3], v[52:55], 0
  v_bitop3_b32 v72, v52, v54, s72 bitop3:0x7e
  s_waitcnt vmcnt(0)
  v_mfma_f32_16x16x32_bf16 v[4:7], v[0:3], v[56:59], v[4:7]
  v_bitop3_b32 v73, v56, v58, s72 bitop3:0x7e
  v_bitop3_b32 v72, v72, v73, 1 bitop3:0xa8
  v_cmp_ne_u32 vcc, 0, v72
  s_cbranch_vccz Cf1_h1p
  s_cmp_lt_u32 s67, 131072
  s_cbranch_scc1 Cf1_h1s
Cf1_h1p:
  s_nop 2
  v_add_f32_dpp v4, v4, v4 row_ror:4 row_mask:0xf bank_mask:0xf
  v_add_f32_dpp v5, v5, v5 row_ror:4 row_mask:0xf bank_mask:0xf
  s_nop 0
  v_add_f32_dpp v4, v4, v4 row_ror:8 row_mask:0xf bank_mask:0xf
  v_add_f32_dpp v5, v5, v5 row_ror:8 row_mask:0xf bank_mask:0xf
  v_cvt_pk_bf16_f32 v4, v4, v5
  buffer_store_dword v4, v69, s[8:11], s62 offen
  s_xor_b32 s62, s62, 16384
  buffer_store_dword v71, v69, s[8:11], s62 offen
  s_xor_b32 s72, s72, 1
  s_branch Cf1_h2
Cf1_h2r:
  s_mov_b64 exec, vcc
  buffer_load_dwordx4 v[8:11], v76, s[8:11], s65 offen offset:2048 sc1
  s_mov_b64 exec, -1
  s_add_u32 s67, s67, 1
  s_waitcnt vmcnt(4)
  v_max3_u32 v72, v8, v9, v10
  v_max_u32 v72, v72, v11
  ds_write_b128 v76, v[8:11] offset:6656
  v_cmp_eq_u32 vcc, -1, v72
  s_cbranch_vccz Cf1_h2w
  s_mov_b64 exec, vcc
  buffer_load_dwordx4 v[8:11], v76, s[8:11], s65 offen offset:2048 sc1
  s_mov_b64 exec, -1
  s_add_u32 s67, s67, 1
  s_waitcnt vmcnt(4)
  v_max3_u32 v72, v8, v9, v10
  v_max_u32 v72, v72, v11
  ds_write_b128 v76, v[8:11] offset:6656
  v_cmp_eq_u32 vcc, -1, v72
  s_cbranch_vccz Cf1_h2w
Cf1_h2s:
  s_mov_b64 exec, vcc
  buffer_load_dwordx4 v[8:11], v76, s[8:11], s65 offen offset:2048 sc1
  s_mov_b64 exec, -1
  s_add_u32 s67, s67, 1
  s_waitcnt vmcnt(2)
  v_max3_u32 v72, v8, v9, v10
  v_max_u32 v72, v72, v11
  ds_write_b128 v76, v[8:11] offset:6656
  v_cmp_eq_u32 vcc, -1, v72
  s_cbranch_vccz Cf1_h2w
  s_mov_b64 exec, vcc
  buffer_load_dwordx4 v[8:11], v76, s[8:11], s65 offen offset:2048 sc1
  s_mov_b64 exec, -1
  s_add_u32 s67, s67, 1
  s_waitcnt vmcnt(2)
  v_max3_u32 v72, v8, v9, v10
  v_max_u32 v72, v72, v11
  ds_write_b128 v76, v[8:11] offset:6656
  v_cmp_eq_u32 vcc, -1, v72
  s_cbranch_vccz Cf1_h2w
  s_mov_b64 exec, vcc
  buffer_load_dwordx4 v[8:11], v76, s[8:11], s65 offen offset:2048 sc1
  s_mov_b64 exec, -1
  s_add_u32 s67, s67, 1
  s_waitcnt vmcnt(2)
  v_max3_u32 v72, v8, v9, v10
  v_max_u32 v72, v72, v11
  ds_write_b128 v76, v[8:11] offset:6656
  v_cmp_eq_u32 vcc, -1, v72
  s_cbranch_vccz Cf1_h2w
  s_cmp_lt_u32 s67, 131072
  s_cbranch_scc1 Cf1_h2s
  s_branch Cf1_h2w
Cf1_rec:
  s_nop 7
  s_waitcnt vmcnt(0) lgkmcnt(0)
  v_max3_u32 v72, v0, v1, v2
  v_max3_u32 v72, v72, v3, v4
  v_max3_u32 v72, v72, v5, v6
  v_max3_u32 v72, v72, v7, v8
  v_max3_u32 v72, v72, v9, v10
  v_max3_u32 v72, v72, v11, v12
  v_max3_u32 v72, v72, v13, v14
  v_max3_u32 v72, v72, v15, v16
  v_max3_u32 v72, v72, v17, v18
  v_max_u32 v72, v72, v19
  v_cmp_eq_u32 vcc, -1, v72
  s_cbranch_vccz Cf1_recok
  s_barrier
  v_mov_b64 v[20:21], 0
  v_mov_b64 v[22:23], 0
  v_mov_b64 v[24:25], 0
  v_mov_b64 v[26:27], 0
  v_mov_b64 v[28:29], 0
  v_mov_b64 v[30:31], 0
  v_mov_b64 v[32:33], 0
  v_mov_b64 v[34:35], 0
  s_waitcnt lgkmcnt(0)
  s_barrier
  ds_read_b128 v[0:3], v76 offset:4608
  s_waitcnt lgkmcnt(0)
  v_smfmac_f32_16x16x64_bf16 v[20:23], v[0:3], v[80:87], v74
  v_smfmac_f32_16x16x64_bf16 v[24:27], v[0:3], v[88:95], v74
  ds_read_b128 v[60:63], v76 offset:20480
  ds_read_b128 v[64:67], v76 offset:21504
  s_waitcnt lgkmcnt(0)
  v_smfmac_f32_16x16x64_bf16 v[28:31], v[0:3], v[60:67], v74
  ds_read_b128 v[60:63], v76 offset:22528
  ds_read_b128 v[64:67], v76 offset:23552
  s_waitcnt lgkmcnt(0)
  v_smfmac_f32_16x16x64_bf16 v[32:35], v[0:3], v[60:67], v74
  ds_read_b128 v[4:7], v76 offset:5632
  s_waitcnt lgkmcnt(0)
  v_smfmac_f32_16x16x64_bf16 v[20:23], v[4:7], v[96:103], v74
  v_smfmac_f32_16x16x64_bf16 v[24:27], v[4:7], v[104:111], v74
  ds_read_b128 v[60:63], v76 offset:36864
  ds_read_b128 v[64:67], v76 offset:37888
  s_waitcnt lgkmcnt(0)
  v_smfmac_f32_16x16x64_bf16 v[28:31], v[4:7], v[60:67], v74
  ds_read_b128 v[60:63], v76 offset:38912
  ds_read_b128 v[64:67], v76 offset:39936
  s_waitcnt lgkmcnt(0)
  v_smfmac_f32_16x16x64_bf16 v[32:35], v[4:7], v[60:67], v74
  ds_read_b128 v[8:11], v76 offset:6656
  s_waitcnt lgkmcnt(0)
  v_smfmac_f32_16x16x64_bf16 v[20:23], v[8:11], v[112:119], v74
  v_smfmac_f32_16x16x64_bf16 v[24:27], v[8:11], v[120:127], v74
  v_smfmac_f32_16x16x64_bf16 v[28:31], v[8:11], v[208:215], v74
  v_smfmac_f32_16x16x64_bf16 v[32:35], v[8:11], v[216:223], v74
  ds_read_b128 v[12:15], v76 offset:7680
  s_waitcnt lgkmcnt(0)
  v_smfmac_f32_16x16x64_bf16 v[20:23], v[12:15], v[128:135], v74
  v_smfmac_f32_16x16x64_bf16 v[24:27], v[12:15], v[136:143], v74
  v_smfmac_f32_16x16x64_bf16 v[28:31], v[12:15], v[224:231], v74
  v_smfmac_f32_16x16x64_bf16 v[32:35], v[12:15], v[232:239], v74
  ds_read_b128 v[8:11], v76 offset:8704
  s_waitcnt lgkmcnt(0)
  v_smfmac_f32_16x16x64_bf16 v[20:23], v[8:11], v[144:151], v74
  v_smfmac_f32_16x16x64_bf16 v[24:27], v[8:11], v[152:159], v74
  ds_read_b128 v[60:63], v76 offset:53248
  ds_read_b128 v[64:67], v76 offset:54272
  s_waitcnt lgkmcnt(0)
  v_smfmac_f32_16x16x64_bf16 v[28:31], v[8:11], v[60:67], v74
  ds_read_b128 v[60:63], v76 offset:55296
  ds_read_b128 v[64:67], v76 offset:56320
  s_waitcnt lgkmcnt(0)
  v_smfmac_f32_16x16x64_bf16 v[32:35], v[8:11], v[60:67], v74
  ds_read_b128 v[0:3], v76 offset:9728
  s_waitcnt lgkmcnt(0)
  v_smfmac_f32_16x16x64_bf16 v[20:23], v[0:3], v[160:167], v74
  v_smfmac_f32_16x16x64_bf16 v[24:27], v[0:3], v[168:175], v74
  ds_read_b128 v[60:63], v75 offset:20480
  ds_read_b128 v[64:67], v75 offset:21504
  s_waitcnt lgkmcnt(0)
  v_smfmac_f32_16x16x64_bf16 v[28:31], v[0:3], v[60:67], v74
  ds_read_b128 v[60:63], v75 offset:22528
  ds_read_b128 v[64:67], v75 offset:23552
  s_waitcnt lgkmcnt(0)
  v_smfmac_f32_16x16x64_bf16 v[32:35], v[0:3], v[60:67], v74
  ds_read_b128 v[16:19], v76 offset:10752
  ds_read_b128 v[60:63], v75 offset:4096
  ds_read_b128 v[64:67], v75 offset:5120
  s_waitcnt lgkmcnt(0)
  v_smfmac_f32_16x16x64_bf16 v[20:23], v[16:19], v[60:67], v74
  ds_read_b128 v[60:63], v75 offset:6144
  ds_read_b128 v[64:67], v75 offset:7168
  s_waitcnt lgkmcnt(0)
  v_smfmac_f32_16x16x64_bf16 v[24:27], v[16:19], v[60:67], v74
  v_smfmac_f32_16x16x64_bf16 v[28:31], v[16:19], v[240:247], v74
  v_smfmac_f32_16x16x64_bf16 v[32:35], v[16:19], v[248:255], v74
  ds_read_b128 v[4:7], v76 offset:11776
  s_waitcnt lgkmcnt(0)
  v_smfmac_f32_16x16x64_bf16 v[20:23], v[4:7], v[176:183], v74
  v_smfmac_f32_16x16x64_bf16 v[24:27], v[4:7], v[184:191], v74
  v_smfmac_f32_16x16x64_bf16 v[28:31], v[4:7], a[0:7], v74
  v_smfmac_f32_16x16x64_bf16 v[32:35], v[4:7], a[8:15], v74
  ds_read_b128 v[12:15], v76 offset:12800
  s_waitcnt lgkmcnt(0)
  v_smfmac_f32_16x16x64_bf16 v[20:23], v[12:15], v[192:199], v74
  v_smfmac_f32_16x16x64_bf16 v[24:27], v[12:15], v[200:207], v74
  v_smfmac_f32_16x16x64_bf16 v[28:31], v[12:15], a[16:23], v74
  v_smfmac_f32_16x16x64_bf16 v[32:35], v[12:15], a[24:31], v74
  v_add_f32 v20, v20, v22
  v_add_f32 v21, v21, v23
  v_add_f32 v24, v24, v26
  v_cvt_pk_bf16_f32 v22, v20, v24
  s_nop 0
  ds_write_b32 v79, v22 offset:0
  v_add_f32 v25, v25, v27
  v_cvt_pk_bf16_f32 v23, v21, v25
  ds_write_b32 v79, v23 offset:576
  v_add_f32 v28, v28, v30
  v_add_f32 v29, v29, v31
  s_waitcnt lgkmcnt(0)
  s_nop 1
  s_branch Cf1_recok
Cf1_mx:
  s_waitcnt lgkmcnt(0)
  s_barrier
  buffer_load_dwordx4 v[0:3], v76, s[8:11], s58 offen offset:0 sc1
  ds_read_b128 v[20:23], v77 offset:0
  ds_read_b128 v[28:31], v77 offset:256
  buffer_load_dwordx4 v[4:7], v76, s[8:11], s58 offen offset:1024 sc1
  ds_read_b128 v[24:27], v77 offset:128
  ds_read_b128 v[32:35], v77 offset:384
  s_waitcnt vmcnt(1) lgkmcnt(3)
  v_mfma_f32_16x16x32_bf16 v[8:11], v[0:3], v[20:23], 0
  s_waitcnt vmcnt(0) lgkmcnt(1)
  v_mfma_f32_16x16x32_bf16 v[8:11], v[4:7], v[24:27], v[8:11]
  v_mfma_f32_16x16x32_bf16 v[12:15], v[28:31], v[20:23], 0
  s_waitcnt lgkmcnt(0)
  v_mfma_f32_16x16x32_bf16 v[12:15], v[32:35], v[24:27], v[12:15]
  v_add_f32_dpp v8, v10, v8 quad_perm:[2,3,0,1] row_mask:0xf bank_mask:0xf
  v_add_f32_dpp v9, v11, v9 quad_perm:[2,3,0,1] row_mask:0xf bank_mask:0xf
  s_nop 0
  v_mov_b32_dpp v8, v8 quad_perm:[0,1,0,1] row_mask:0xf bank_mask:0xf
  v_mov_b32_dpp v9, v9 quad_perm:[0,1,0,1] row_mask:0xf bank_mask:0xf
  s_nop 1
  v_add_f32_dpp v12, v14, v12 quad_perm:[2,3,0,1] row_mask:0xf bank_mask:0xf
  v_add_f32_dpp v13, v15, v13 quad_perm:[2,3,0,1] row_mask:0xf bank_mask:0xf
  s_nop 0
  v_mov_b32_dpp v12, v12 quad_perm:[0,1,0,1] row_mask:0xf bank_mask:0xf
  v_mov_b32_dpp v13, v13 quad_perm:[0,1,0,1] row_mask:0xf bank_mask:0xf
  v_mul_f32 v12, s69, v12
  ds_write_b32 v78, v8 offset:8708
  v_mul_f32 v13, s69, v13
  ds_write_b32 v78, v9 offset:8772
  s_waitcnt lgkmcnt(0)
  s_barrier
  ds_read_b128 v[36:39], v78 offset:8704
  ds_read_b128 v[40:43], v78 offset:8768
  s_waitcnt lgkmcnt(0)
  s_barrier
  v_max_f32 v16, v36, v37
  v_max3_f32 v16, v16, v38, v39
  v_max3_f32 v16, v16, v40, v41
  v_max3_f32 v16, v16, v42, v43
  v_max3_f32 v16, v16, v12, v13
  v_mov_b32 v17, v16
  s_nop 1
  v_permlane16_swap_b32 v16, v17
  v_max_f32 v16, v16, v17
  v_mov_b32 v17, v16
  s_nop 1
  v_permlane32_swap_b32 v16, v17
  v_max_f32 v16, v16, v17
  v_sub_f32 v36, v36, v16
  v_sub_f32 v37, v37, v16
  v_sub_f32 v38, v38, v16
  v_sub_f32 v39, v39, v16
  v_sub_f32 v40, v40, v16
  v_sub_f32 v41, v41, v16
  v_sub_f32 v42, v42, v16
  v_sub_f32 v43, v43, v16
  v_sub_f32 v12, v12, v16
  v_sub_f32 v13, v13, v16
  v_exp_f32 v36, v36
  v_exp_f32 v37, v37
  v_exp_f32 v38, v38
  v_exp_f32 v39, v39
  v_exp_f32 v40, v40
  v_exp_f32 v41, v41
  v_exp_f32 v42, v42
  v_exp_f32 v43, v43
  v_exp_f32 v12, v12
  v_exp_f32 v13, v13
  v_cvt_pk_bf16_f32 v32, v36, v40
  v_cvt_pk_bf16_f32 v33, v37, v41
  v_cvt_pk_bf16_f32 v34, v38, v42
  v_cvt_pk_bf16_f32 v35, v39, v43
  v_cvt_pk_bf16_f32 v28, v12, v13
  v_cvt_pk_bf16_f32 v31, v12, v13
  v_mov_b32 v29, 0
  v_mov_b32 v30, 0
  v_mov_b32 v68, 0x3f803f80
  v_mov_b32 v69, 0x3f803f80
  v_mov_b32 v70, 0x3f803f80
  v_mov_b32 v71, 0x3f803f80
  s_nop 1
  v_mfma_f32_16x16x32_bf16 v[8:11], v[32:35], v[68:71], 0
  v_mfma_f32_16x16x32_bf16 v[0:3], v[32:35], v[52:55], 0
  v_mfma_f32_16x16x32_bf16 v[4:7], v[32:35], v[56:59], 0
  v_mfma_f32_16x16x16_bf16 v[8:11], v[28:29], v[68:69], v[8:11]
  v_mfma_f32_16x16x16_bf16 v[0:3], v[28:29], v[72:73], v[0:3]
  v_mfma_f32_16x16x16_bf16 v[4:7], v[30:31], v[72:73], v[4:7]
  ds_read_b128 v[68:71], v76 offset:13824
  v_rcp_f32 v10, v8
  v_rcp_f32 v11, v9
  v_mul_f32 v0, v10, v0
  v_mul_f32 v1, v11, v1
  s_nop 0
  v_mul_f32 v4, v10, v4
  v_mul_f32 v5, v11, v5
  v_cvt_pk_bf16_f32 v2, v0, v4
  ds_write_b32 v79, v2 offset:8704
  v_cvt_pk_bf16_f32 v3, v1, v5
  ds_write_b32 v79, v3 offset:9280
  v_mov_b64 v[16:17], 0
  v_mov_b64 v[18:19], 0
  v_mov_b64 v[20:21], 0
  v_mov_b64 v[22:23], 0
  v_mov_b64 v[24:25], 0
  v_mov_b64 v[26:27], 0
  s_branch Cf1_mxok
Cf1_last:
  ds_read_b128 v[4:7], v76 offset:5632
  ds_read_b128 v[12:15], v76 offset:7680
  ds_read_b128 v[44:47], v76 offset:36864
  ds_read_b128 v[48:51], v76 offset:37888
  s_nop 5
  v_mov_b64 v[20:21], 0
  v_mov_b64 v[22:23], 0
  v_mov_b64 v[24:25], 0
  v_mov_b64 v[26:27], 0
  s_waitcnt lgkmcnt(4)
  v_smfmac_f32_16x16x64_bf16 v[28:31], v[0:3], v[36:43], v74
  ds_read_b128 v[36:39], v76 offset:38912
  ds_read_b128 v[40:43], v76 offset:39936
  v_smfmac_f32_16x16x64_bf16 v[32:35], v[0:3], v[60:67], v74
  s_waitcnt lgkmcnt(5)
  v_smfmac_f32_16x16x64_bf16 v[20:23], v[0:3], a[32:39], v74
  ds_read_b128 v[60:63], v76 offset:53248
  ds_read_b128 v[64:67], v76 offset:54272
  v_smfmac_f32_16x16x64_bf16 v[24:27], v[0:3], a[40:47], v74
  s_waitcnt lgkmcnt(4)
  v_smfmac_f32_16x16x64_bf16 v[20:23], v[4:7], a[48:55], v74
  buffer_store_dwordx4 v[16:19], v76, s[8:11], s68 offen sc1
  v_smfmac_f32_16x16x64_bf16 v[24:27], v[4:7], a[56:63], v74
  v_smfmac_f32_16x16x64_bf16 v[28:31], v[4:7], v[44:51], v74
  s_waitcnt lgkmcnt(2)
  v_smfmac_f32_16x16x64_bf16 v[20:23], v[8:11], a[64:71], v74
  ds_read_b128 v[44:47], v76 offset:55296
  ds_read_b128 v[48:51], v76 offset:56320
  v_smfmac_f32_16x16x64_bf16 v[24:27], v[8:11], a[72:79], v74
  v_smfmac_f32_16x16x64_bf16 v[32:35], v[4:7], v[36:43], v74
  v_smfmac_f32_16x16x64_bf16 v[28:31], v[8:11], v[208:215], v74
  ds_read_b128 v[36:39], v75 offset:20480
  ds_read_b128 v[40:43], v75 offset:21504
  v_smfmac_f32_16x16x64_bf16 v[32:35], v[8:11], v[216:223], v74
  v_smfmac_f32_16x16x64_bf16 v[20:23], v[12:15], a[80:87], v74
  v_smfmac_f32_16x16x64_bf16 v[24:27], v[12:15], a[88:95], v74
  v_smfmac_f32_16x16x64_bf16 v[28:31], v[12:15], v[224:231], v74
  v_smfmac_f32_16x16x64_bf16 v[32:35], v[12:15], v[232:239], v74
  s_waitcnt vmcnt(2)
  s_waitcnt vmcnt(1)
  s_barrier
Cf1_lastr:
  ds_read_b128 v[8:11], v76 offset:8704
  ds_read_b128 v[0:3], v76 offset:9728
  ds_read_b128 v[16:19], v76 offset:10752
  ds_read_b128 v[4:7], v76 offset:11776
  ds_read_b128 v[12:15], v76 offset:12800
  s_waitcnt lgkmcnt(3)
  v_max3_u32 v72, v0, v1, v2
  s_waitcnt lgkmcnt(1)
  v_max3_u32 v72, v72, v3, v4
  v_max3_u32 v72, v72, v5, v6
  v_max3_u32 v72, v72, v7, v8
  v_max3_u32 v72, v72, v9, v10
  s_waitcnt lgkmcnt(0)
  v_max3_u32 v72, v72, v11, v12
  v_max3_u32 v72, v72, v13, v14
  v_max3_u32 v72, v72, v15, v16
  v_max3_u32 v72, v72, v17, v18
  v_max_u32 v72, v72, v19
  v_cmp_eq_u32 vcc, -1, v72
  s_cbranch_vccnz Cf1_lastp
Cf1_lastg:
  v_smfmac_f32_16x16x64_bf16 v[28:31], v[8:11], v[60:67], v74
  ds_read_b128 v[60:63], v75 offset:22528
  ds_read_b128 v[64:67], v75 offset:23552
  v_smfmac_f32_16x16x64_bf16 v[32:35], v[8:11], v[44:51], v74
  v_smfmac_f32_16x16x64_bf16 v[28:31], v[0:3], v[36:43], v74
  v_smfmac_f32_16x16x64_bf16 v[28:31], v[16:19], v[240:247], v74
  v_smfmac_f32_16x16x64_bf16 v[28:31], v[4:7], a[0:7], v74
  v_smfmac_f32_16x16x64_bf16 v[28:31], v[12:15], a[16:23], v74
  v_smfmac_f32_16x16x64_bf16 v[32:35], v[16:19], v[248:255], v74
  v_smfmac_f32_16x16x64_bf16 v[32:35], v[4:7], a[8:15], v74
  s_waitcnt lgkmcnt(0)
  v_smfmac_f32_16x16x64_bf16 v[32:35], v[12:15], a[24:31], v74
  v_smfmac_f32_16x16x64_bf16 v[32:35], v[0:3], v[60:67], v74
  v_smfmac_f32_16x16x64_bf16 v[20:23], v[8:11], a[96:103], v74
  v_smfmac_f32_16x16x64_bf16 v[20:23], v[0:3], a[112:119], v74
  v_add_f32 v28, v28, v30
  v_add_f32 v32, v32, v34
  v_cvt_pk_bf16_f32 v30, v28, v32
  v_smfmac_f32_16x16x64_bf16 v[20:23], v[16:19], a[128:135], v74
  ds_write_b32 v79, v30 offset:256
  v_add_f32 v29, v29, v31
  v_add_f32 v33, v33, v35
  v_cvt_pk_bf16_f32 v31, v29, v33
  v_smfmac_f32_16x16x64_bf16 v[20:23], v[4:7], a[144:151], v74
  ds_write_b32 v79, v31 offset:832
  v_smfmac_f32_16x16x64_bf16 v[20:23], v[12:15], a[160:167], v74
  v_smfmac_f32_16x16x64_bf16 v[24:27], v[8:11], a[104:111], v74
  v_smfmac_f32_16x16x64_bf16 v[24:27], v[0:3], a[120:127], v74
  v_smfmac_f32_16x16x64_bf16 v[24:27], v[16:19], a[136:143], v74
  s_waitcnt lgkmcnt(0)
  s_barrier
  ds_read_b64 v[52:53], v77 offset:264
  v_add_f32 v20, v20, v22
  v_smfmac_f32_16x16x64_bf16 v[24:27], v[4:7], a[152:159], v74
  v_add_f32 v21, v21, v23
  v_smfmac_f32_16x16x64_bf16 v[24:27], v[12:15], a[168:175], v74
  v_cvt_pk_bf16_f32 v54, v20, v21
  s_add_u32 s68, s68, 655360
  s_nop 3
  v_add_f32 v24, v24, v26
  v_add_f32 v25, v25, v27
  v_cvt_pk_bf16_f32 v55, v24, v25
  s_waitcnt lgkmcnt(0)
  buffer_store_dwordx4 v[52:55], v76, s[8:11], s68 offen sc1
  s_branch Cf1_done
Cf1_lastp:
  s_add_u32 s72, s72, 2
  s_cmp_ge_u32 s72, 131072
  s_cbranch_scc1 Cf1_lastg
  s_barrier
  buffer_load_dwordx4 v76, s[8:11], s55 offen offset:0 sc1 lds
  s_waitcnt vmcnt(0)
  s_barrier
  s_branch Cf1_lastr
Cf1_done:
  s_branch L_cexit
L_w2:
  v_mov_b64 v[20:21], 0
  v_mov_b64 v[22:23], 0
  v_mov_b64 v[24:25], 0
  v_mov_b64 v[26:27], 0
  v_mov_b64 v[28:29], 0
  v_mov_b64 v[30:31], 0
  v_mov_b64 v[32:33], 0
  v_mov_b64 v[34:35], 0
  s_mov_b32 s78, 0x3f803f80
  s_mov_b32 s79, s78
  s_mov_b32 s65, 360448
  s_mov_b32 m0, 15872
  s_lshl_b32 s71, s53, 2
  s_add_u32 s71, s71, 128
  s_movk_i32 s56, 0x1000
  v_lshlrev_b32 v73, 2, v76
  v_mov_b32 v72, 0
  s_mov_b64 s[16:17], s[8:9]
  s_mov_b32 s18, 268435456
  s_mov_b32 s19, 0x20000
  s_getpc_b64 s[20:21]
Cf2_pc:
  s_add_u32 s20, s20, (Cf2_last - Cf2_pc)
  s_addc_u32 s21, s21, 0
  v_mov_b32 v68, 14880
  buffer_load_dwordx4 v[52:55], v76, s[8:11], s59 offen offset:0 sc1
  buffer_load_dwordx4 v[56:59], v76, s[8:11], s59 offen offset:1024 sc1
  ds_read_b128 v[36:39], v76 offset:24576
  ds_read_b128 v[40:43], v76 offset:25600
  ds_read_b128 v[60:63], v76 offset:26624
  ds_read_b128 v[64:67], v76 offset:27648
  ds_read_b128 v[0:3], v76 offset:4608
  ds_read_b128 v[4:7], v76 offset:5632
  ds_read_b128 v[8:11], v76 offset:6656
  ds_read_b128 v[12:15], v76 offset:7680
  s_waitcnt lgkmcnt(0)
  s_cmp_eq_u32 s66, 1
  s_branch Cf2_top2
.p2align 6
Cf2_h2:
  v_lshlrev_b32 v73, 2, v76
  s_mov_b32 m0, 12800
  s_add_u32 s55, s65, 8192
  s_nop 3
  buffer_load_dwordx4 v[12:15], v76, s[8:11], s65 offen offset:3072 sc1
  s_nop 15
  s_nop 3
  buffer_load_dwordx4 v[12:15], v76, s[8:11], s65 offen offset:3072 sc1
  s_nop 15
  s_nop 3
  buffer_load_dwordx4 v[12:15], v76, s[8:11], s65 offen offset:3072 sc1
  s_waitcnt vmcnt(5)
  ds_read_b128 v[36:39], v76 offset:24576
  ds_read_b128 v[40:43], v76 offset:25600
  ds_read_b128 v[60:63], v76 offset:26624
  ds_read_b128 v[64:67], v76 offset:27648
  buffer_load_dwordx4 v[52:55], v76, s[8:11], s59 offen offset:0 sc1
  buffer_load_dwordx4 v[56:59], v76, s[8:11], s59 offen offset:1024 sc1
  s_waitcnt vmcnt(4)
  v_max3_u32 v72, v12, v13, v14
  v_max_u32 v72, v72, v15
  ds_write_b128 v76, v[12:15] offset:7680
  v_cmp_eq_u32 vcc, -1, v72
  s_cbranch_vccnz Cf2_h2r
Cf2_h2w:
  s_cmp_eq_u32 s66, 63
  s_waitcnt lgkmcnt(0)
  s_barrier
  ds_read_b128 v[0:3], v76 offset:4608
  buffer_load_dwordx4 v76, s[8:11], s55 offen offset:0 sc1 lds
Cf2_top2:
  v_smfmac_f32_16x16x64_bf16 v[20:23], v[12:15], v[128:135], v74
  s_cbranch_scc1 Cf2_last
  v_smfmac_f32_16x16x64_bf16 v[24:27], v[12:15], v[136:143], v74
  buffer_load_dwordx4 v[44:47], v76, s[8:11], s58 offen offset:0 sc1
  s_mov_b32 m0, 15872
  v_smfmac_f32_16x16x64_bf16 v[28:31], v[12:15], v[224:231], v74
  buffer_load_dwordx4 v[48:51], v76, s[8:11], s58 offen offset:1024 sc1
  v_smfmac_f32_16x16x64_bf16 v[32:35], v[12:15], v[232:239], v74
  ds_read_b128 v[4:7], v76 offset:5632
  s_waitcnt lgkmcnt(1)
  v_smfmac_f32_16x16x64_bf16 v[20:23], v[0:3], v[80:87], v74
  ds_read_b128 v[8:11], v76 offset:6656
  v_smfmac_f32_16x16x64_bf16 v[28:31], v[0:3], v[36:43], v74
  ds_read_b128 v[36:39], v76 offset:40960
  v_smfmac_f32_16x16x64_bf16 v[24:27], v[0:3], v[88:95], v74
  buffer_store_dwordx4 v[16:19], v76, s[8:11], s68 offen sc1
  ds_read_b128 v[40:43], v76 offset:41984
  v_smfmac_f32_16x16x64_bf16 v[32:35], v[0:3], v[60:67], v74
  ds_read_b128 v[60:63], v76 offset:43008
  s_waitcnt lgkmcnt(4)
  v_smfmac_f32_16x16x64_bf16 v[20:23], v[4:7], v[96:103], v74
  ds_read_b128 v[64:67], v76 offset:44032
  v_smfmac_f32_16x16x64_bf16 v[24:27], v[4:7], v[104:111], v74
  buffer_load_dword v73, s[16:19], s70 offen lds
  s_waitcnt vmcnt(5)
  s_waitcnt lgkmcnt(4)
  v_smfmac_f32_16x16x64_bf16 v[20:23], v[8:11], v[112:119], v74
  s_barrier
  s_waitcnt lgkmcnt(2)
  v_smfmac_f32_16x16x64_bf16 v[28:31], v[4:7], v[36:43], v74
  ds_read_b128 v[12:15], v76 offset:8704
  v_smfmac_f32_16x16x64_bf16 v[24:27], v[8:11], v[120:127], v74
  ds_read_b128 v[36:39], v76 offset:57344
  s_waitcnt lgkmcnt(2)
  v_smfmac_f32_16x16x64_bf16 v[32:35], v[4:7], v[60:67], v74
  ds_read_b128 v[40:43], v76 offset:58368
  v_smfmac_f32_16x16x64_bf16 v[28:31], v[8:11], v[208:215], v74
  ds_read_b128 v[60:63], v76 offset:59392
  v_smfmac_f32_16x16x64_bf16 v[32:35], v[8:11], v[216:223], v74
  ds_read_b128 v[64:67], v76 offset:60416
  s_waitcnt lgkmcnt(4)
  v_smfmac_f32_16x16x64_bf16 v[20:23], v[12:15], v[144:151], v74
  s_waitcnt vmcnt(4)
  ds_read_b128 v[0:3], v76 offset:9728
  s_waitcnt lgkmcnt(3)
  v_smfmac_f32_16x16x64_bf16 v[28:31], v[12:15], v[36:43], v74
  s_barrier
  ds_read_b128 v[4:7], v76 offset:11776
  v_smfmac_f32_16x16x64_bf16 v[24:27], v[12:15], v[152:159], v74
  ds_read_b128 v[36:39], v75 offset:8192
  ds_read_b128 v[40:43], v75 offset:9216
  s_waitcnt lgkmcnt(4)
  v_smfmac_f32_16x16x64_bf16 v[32:35], v[12:15], v[60:67], v74
  ds_read_b128 v[16:19], v76 offset:10752
  s_waitcnt lgkmcnt(4)
  v_smfmac_f32_16x16x64_bf16 v[20:23], v[0:3], v[160:167], v74
  ds_read_b128 v[8:11], v76 offset:12800
  v_smfmac_f32_16x16x64_bf16 v[24:27], v[0:3], v[168:175], v74
  ds_read_b128 v[60:63], v75 offset:10240
  ds_read_b128 v[64:67], v75 offset:11264
  s_waitcnt lgkmcnt(6)
  v_smfmac_f32_16x16x64_bf16 v[20:23], v[4:7], v[176:183], v74
  s_waitcnt lgkmcnt(3)
  v_smfmac_f32_16x16x64_bf16 v[20:23], v[16:19], v[36:43], v74
  ds_read_b128 v[36:39], v75 offset:24576
  s_waitcnt lgkmcnt(3)
  v_smfmac_f32_16x16x64_bf16 v[20:23], v[8:11], v[192:199], v74
  ds_read_b128 v[40:43], v75 offset:25600
  s_waitcnt lgkmcnt(2)
  v_smfmac_f32_16x16x64_bf16 v[24:27], v[16:19], v[60:67], v74
  ds_read_b128 v[60:63], v75 offset:26624
  v_smfmac_f32_16x16x64_bf16 v[24:27], v[4:7], v[184:191], v74
  ds_read_b128 v[64:67], v75 offset:27648
  v_add_f32 v20, v20, v22
  v_smfmac_f32_16x16x64_bf16 v[24:27], v[8:11], v[200:207], v74
  v_add_f32 v21, v21, v23
  v_smfmac_f32_16x16x64_bf16 v[28:31], v[16:19], v[240:247], v74
  s_waitcnt lgkmcnt(2)
  v_mov_b64 v[70:71], s[78:79]
  v_smfmac_f32_16x16x64_bf16 v[28:31], v[0:3], v[36:43], v74
  ds_read_b128 v[36:39], v68
  v_add_f32 v24, v24, v26
  v_smfmac_f32_16x16x64_bf16 v[28:31], v[4:7], a[0:7], v74
  ds_read_b128 v[40:43], v68
  v_cvt_pk_bf16_f32 v22, v20, v24
  v_smfmac_f32_16x16x64_bf16 v[28:31], v[8:11], a[16:23], v74
  ds_write_b32 v79, v22 offset:0
  s_waitcnt lgkmcnt(3)
  v_add_f32 v25, v25, v27
  v_cvt_pk_bf16_f32 v23, v21, v25
  v_smfmac_f32_16x16x64_bf16 v[32:35], v[0:3], v[60:67], v74
  ds_write_b32 v79, v23 offset:576
  v_cmp_u_f32 vcc, v20, v21
  v_smfmac_f32_16x16x64_bf16 v[32:35], v[16:19], v[248:255], v74
  v_add_f32 v28, v28, v30
  v_smfmac_f32_16x16x64_bf16 v[32:35], v[4:7], a[8:15], v74
  v_add_f32 v29, v29, v31
  v_smfmac_f32_16x16x64_bf16 v[32:35], v[8:11], a[24:31], v74
  s_cbranch_vccnz Cf2_rec
Cf2_recok:
  s_waitcnt lgkmcnt(3)
  v_smfmac_f32_16x16x64_bf16 v[36:39], v[16:19], a[128:135], v74
  s_waitcnt lgkmcnt(0)
  s_barrier
  ds_read_b128 v[60:63], v77
  v_smfmac_f32_16x16x64_bf16 v[40:43], v[16:19], a[136:143], v74
  ds_read_b128 v[64:67], v77 offset:128
  v_add_f32 v32, v32, v34
  v_cvt_pk_bf16_f32 v30, v28, v32
  v_smfmac_f32_16x16x64_bf16 v[36:39], v[0:3], a[112:119], v74
  ds_write_b32 v79, v30 offset:256
  v_add_f32 v33, v33, v35
  v_cvt_pk_bf16_f32 v31, v29, v33
  v_smfmac_f32_16x16x64_bf16 v[40:43], v[0:3], a[120:127], v74
  ds_write_b32 v79, v31 offset:832
  v_xor_b32 v75, 0x8000, v75
  v_smfmac_f32_16x16x64_bf16 v[36:39], v[4:7], a[144:151], v74
  ds_read_b128 v[0:3], v76 offset:4608
  v_mov_b32 v29, 0
  v_smfmac_f32_16x16x64_bf16 v[40:43], v[4:7], a[152:159], v74
  s_waitcnt vmcnt(2) lgkmcnt(3)
  v_mov_b32 v30, 0
  v_mfma_f32_16x16x32_bf16 v[44:47], v[44:47], v[60:63], 0
  ds_read_b128 v[4:7], v76 offset:5632
  s_waitcnt lgkmcnt(2)
  v_mfma_f32_16x16x32_bf16 v[44:47], v[48:51], v[64:67], v[44:47]
  s_barrier
  v_smfmac_f32_16x16x64_bf16 v[36:39], v[8:11], a[160:167], v74
  ds_read_b128 v[20:23], v77 offset:256
  ds_read_b128 v[24:27], v77 offset:384
  v_smfmac_f32_16x16x64_bf16 v[40:43], v[8:11], a[168:175], v74
  ds_read_b128 v[8:11], v76 offset:6656
  v_add_f32_dpp v72, v46, v44 quad_perm:[2,3,0,1] row_mask:0xf bank_mask:0xf
  v_add_f32_dpp v73, v47, v45 quad_perm:[2,3,0,1] row_mask:0xf bank_mask:0xf
  v_smfmac_f32_16x16x64_bf16 v[36:39], v[12:15], a[96:103], v74
  s_waitcnt lgkmcnt(4)
  v_exp_f32_dpp v72, v72 quad_perm:[0,1,0,1] row_mask:0xf bank_mask:0xf
  v_smfmac_f32_16x16x64_bf16 v[40:43], v[12:15], a[104:111], v74
  ds_read_b128 v[12:15], v76 offset:7680
  v_exp_f32_dpp v73, v73 quad_perm:[0,1,0,1] row_mask:0xf bank_mask:0xf
  v_smfmac_f32_16x16x64_bf16 v[36:39], v[0:3], a[32:39], v74
  s_waitcnt lgkmcnt(2)
  v_cvt_pk_bf16_f32 v72, v72, v73
  v_mfma_f32_16x16x32_bf16 v[20:23], v[20:23], v[60:63], 0
  ds_write_b32 v78, v72 offset:520
  v_mov_b64 v[16:17], 0
  v_mfma_f32_16x16x32_bf16 v[20:23], v[24:27], v[64:67], v[20:23]
  ds_read_b128 v[44:47], v75 offset:24576
  v_mov_b64 v[18:19], 0
  v_smfmac_f32_16x16x64_bf16 v[40:43], v[0:3], a[40:47], v74
  ds_read_b128 v[48:51], v75 offset:25600
  v_mov_b64 v[68:69], s[78:79]
  v_smfmac_f32_16x16x64_bf16 v[36:39], v[4:7], a[48:55], v74
  s_waitcnt lgkmcnt(4)
  v_add_f32_dpp v24, v22, v20 quad_perm:[2,3,0,1] row_mask:0xf bank_mask:0xf
  v_add_f32_dpp v25, v23, v21 quad_perm:[2,3,0,1] row_mask:0xf bank_mask:0xf
  v_smfmac_f32_16x16x64_bf16 v[36:39], v[8:11], a[64:71], v74
  s_waitcnt lgkmcnt(2)
  s_barrier
  ds_read_b128 v[32:35], v78 offset:512
  v_smfmac_f32_16x16x64_bf16 v[36:39], v[12:15], a[80:87], v74
  ds_read_b128 v[60:63], v75 offset:26624
  v_mul_f32 v24, s69, v24
  v_smfmac_f32_16x16x64_bf16 v[40:43], v[4:7], a[56:63], v74
  ds_read_b128 v[64:67], v75 offset:27648
  v_mul_f32 v25, s69, v25
  v_smfmac_f32_16x16x64_bf16 v[40:43], v[8:11], a[72:79], v74
  v_exp_f32_dpp v24, v24 quad_perm:[0,1,0,1] row_mask:0xf bank_mask:0xf
  v_smfmac_f32_16x16x64_bf16 v[40:43], v[12:15], a[88:95], v74
  s_waitcnt lgkmcnt(2)
  v_exp_f32_dpp v25, v25 quad_perm:[0,1,0,1] row_mask:0xf bank_mask:0xf
  v_mfma_f32_16x16x32_bf16 v[8:11], v[32:35], v[68:71], 0
  v_add_f32 v36, v36, v38
  v_add_f32 v37, v37, v39
  v_mfma_f32_16x16x32_bf16 v[0:3], v[32:35], v[52:55], 0
  v_add_f32 v40, v40, v42
  v_add_f32 v41, v41, v43
  v_mfma_f32_16x16x32_bf16 v[4:7], v[32:35], v[56:59], 0
  v_cvt_pk_bf16_f32 v28, v24, v25
  v_cvt_pk_bf16_f32 v72, v36, v37
  v_cvt_pk_bf16_f32 v73, v40, v41
  v_mfma_f32_16x16x16_bf16 v[8:11], v[28:29], v[68:69], v[8:11]
  v_cvt_pk_bf16_f32 v31, v24, v25
  v_mov_b64 v[20:21], 0
  v_mfma_f32_16x16x16_bf16 v[0:3], v[28:29], v[72:73], v[0:3]
  ds_read_b128 v[68:71], v76 offset:13824
  v_mov_b64 v[22:23], 0
  v_mfma_f32_16x16x16_bf16 v[4:7], v[30:31], v[72:73], v[4:7]
  v_rcp_f32 v10, v8
  v_rcp_f32 v11, v9
  v_mul_f32 v0, v10, v0
  v_mul_f32 v1, v11, v1
  s_nop 0
  v_mul_f32 v4, v10, v4
  v_mul_f32 v5, v11, v5
  v_cvt_pk_bf16_f32 v2, v0, v4
  ds_write_b32 v79, v2 offset:8704
  v_cvt_pk_bf16_f32 v3, v1, v5
  ds_write_b32 v79, v3 offset:9280
  v_max3_f32 v8, v8, v9, v10
  v_max_f32 v8, v8, v11
  v_cmp_le_f32 vcc, 1317011456, v8
  v_mov_b64 v[24:25], 0
  v_mov_b64 v[26:27], 0
  s_cbranch_vccnz Cf2_mx
Cf2_mxok:
  s_waitcnt lgkmcnt(0)
  s_barrier
  ds_read_b128 v[0:3], v78 offset:8704
  ds_read_b128 v[4:7], v78 offset:8768
  ds_read_b128 v[8:11], v78 offset:8832
  ds_read_b128 v[12:15], v78 offset:8896
  s_waitcnt lgkmcnt(3)
  v_smfmac_f32_16x16x64_bf16 v[16:19], v[0:3], v[44:51], v74
  ds_read_b128 v[52:55], v75 offset:40960
  s_waitcnt lgkmcnt(3)
  v_smfmac_f32_16x16x64_bf16 v[16:19], v[4:7], v[60:67], v74
  ds_read_b128 v[56:59], v75 offset:41984
  s_waitcnt lgkmcnt(3)
  v_smfmac_f32_16x16x64_bf16 v[16:19], v[8:11], a[176:183], v74
  ds_read_b128 v[36:39], v75 offset:43008
  s_waitcnt lgkmcnt(3)
  v_smfmac_f32_16x16x64_bf16 v[16:19], v[12:15], a[184:191], v74
  ds_read_b128 v[40:43], v75 offset:44032
  ds_read_b128 v[44:47], v75 offset:57344
  v_smfmac_f32_16x16x64_bf16 v[20:23], v[0:3], a[192:199], v74
  ds_read_b128 v[48:51], v75 offset:58368
  ds_read_b128 v[60:63], v75 offset:59392
  v_smfmac_f32_16x16x64_bf16 v[20:23], v[4:7], a[200:207], v74
  ds_read_b128 v[64:67], v75 offset:60416
  s_waitcnt lgkmcnt(6)
  v_cvt_pk_bf16_f32 v16, v16, v17
  v_cvt_pk_bf16_f32 v17, v18, v19
  v_bfi_b32 v16, 1, s72, v16
  v_smfmac_f32_16x16x64_bf16 v[20:23], v[8:11], v[52:59], v74
  buffer_store_dwordx2 v[16:17], v68, s[8:11], s73 offen
  s_waitcnt lgkmcnt(4)
  v_smfmac_f32_16x16x64_bf16 v[20:23], v[12:15], v[36:43], v74
  ds_read_b128 v[52:55], v75 offset:0
  v_mov_b64 v[32:33], 0
  v_smfmac_f32_16x16x64_bf16 v[24:27], v[0:3], a[208:215], v74
  ds_read_b128 v[56:59], v75 offset:1024
  v_mov_b64 v[34:35], 0
  v_smfmac_f32_16x16x64_bf16 v[24:27], v[4:7], a[216:223], v74
  ds_read_b128 v[36:39], v75 offset:2048
  s_waitcnt lgkmcnt(5)
  v_cvt_pk_bf16_f32 v20, v20, v21
  v_cvt_pk_bf16_f32 v21, v22, v23
  v_bfi_b32 v20, 1, s72, v20
  v_smfmac_f32_16x16x64_bf16 v[24:27], v[8:11], v[44:51], v74
  buffer_store_dwordx2 v[20:21], v68, s[8:11], s74 offen
  s_waitcnt lgkmcnt(3)
  v_smfmac_f32_16x16x64_bf16 v[24:27], v[12:15], v[60:67], v74
  ds_read_b128 v[40:43], v75 offset:3072
  v_mov_b64 v[28:29], 0
  v_smfmac_f32_16x16x64_bf16 v[32:35], v[0:3], a[224:231], v74
  ds_read_b128 v[44:47], v75 offset:4096
  ds_read_b128 v[48:51], v75 offset:5120
  v_smfmac_f32_16x16x64_bf16 v[32:35], v[4:7], a[232:239], v74
  ds_read_b128 v[60:63], v75 offset:6144
  v_cvt_pk_bf16_f32 v24, v24, v25
  v_cvt_pk_bf16_f32 v25, v26, v27
  v_bfi_b32 v24, 1, s72, v24
  v_smfmac_f32_16x16x64_bf16 v[32:35], v[8:11], a[240:247], v74
  buffer_store_dwordx2 v[24:25], v68, s[8:11], s75 offen
  v_mov_b64 v[30:31], 0
  v_smfmac_f32_16x16x64_bf16 v[32:35], v[12:15], a[248:255], v74
  ds_read_b128 v[64:67], v75 offset:7168
  s_waitcnt lgkmcnt(6)
  v_smfmac_f32_16x16x64_bf16 v[28:31], v[0:3], v[52:59], v74
  s_waitcnt lgkmcnt(4)
  v_smfmac_f32_16x16x64_bf16 v[28:31], v[4:7], v[36:43], v74
  s_waitcnt lgkmcnt(2)
  v_cvt_pk_bf16_f32 v32, v32, v33
  v_cvt_pk_bf16_f32 v33, v34, v35
  v_bfi_b32 v32, 1, s72, v32
  v_smfmac_f32_16x16x64_bf16 v[28:31], v[8:11], v[44:51], v74
  buffer_store_dwordx2 v[32:33], v68, s[8:11], s76 offen
  s_waitcnt lgkmcnt(0)
  v_smfmac_f32_16x16x64_bf16 v[28:31], v[12:15], v[60:67], v74
  ds_read_b128 v[0:3], v76 offset:14848
  ds_read_b64 v[16:17], v77 offset:384
  v_mov_b64 v[18:19], v[72:73]
  v_xor_b32 v75, 0x8000, v75
  s_nop 3
  v_cvt_pk_bf16_f32 v28, v28, v29
  v_cvt_pk_bf16_f32 v29, v30, v31
  v_bfi_b32 v28, 1, s72, v28
  buffer_store_dwordx2 v[28:29], v68, s[8:11], s77 offen
  v_mov_b64 v[20:21], 0
  v_mov_b64 v[22:23], 0
  v_mov_b64 v[24:25], 0
  v_mov_b64 v[26:27], 0
  v_mov_b64 v[28:29], 0
  v_mov_b64 v[30:31], 0
  v_mov_b64 v[32:33], 0
  v_mov_b64 v[34:35], 0
  v_mov_b32 v68, 14880
  s_add_u32 s58, s58, 655360
  s_add_u32 s59, s59, 655360
  s_add_u32 s70, s70, 655360
  s_add_u32 s68, s68, 655360
  s_add_u32 s66, s66, 1
  s_xor_b32 s64, s64, 16384
  s_xor_b32 s65, s65, 16384
  s_cmp_eq_u32 s66, 62
  s_cselect_b64 s[16:17], s[20:21], s[16:17]
  s_cselect_b32 s18, (Cf2_done - Cf2_last), s18
  s_cselect_b32 s70, 0, s70
  s_cmp_eq_u32 s66, 63
  s_cselect_b32 s59, 268435456, s59
  s_cselect_b32 s58, 268435456, s58
  s_nop 15
  s_nop 11
  buffer_load_dwordx4 v[52:55], v76, s[8:11], s60 offen offset:0 sc1
  buffer_load_dwordx4 v[56:59], v76, s[8:11], s60 offen offset:1024 sc1
  s_waitcnt lgkmcnt(0)
  s_waitcnt vmcnt(1)
  v_mfma_f32_16x16x32_bf16 v[4:7], v[0:3], v[52:55], 0
  v_bitop3_b32 v72, v52, v54, s72 bitop3:0x7e
  s_waitcnt vmcnt(0)
  v_mfma_f32_16x16x32_bf16 v[4:7], v[0:3], v[56:59], v[4:7]
  v_bitop3_b32 v73, v56, v58, s72 bitop3:0x7e
  v_bitop3_b32 v72, v72, v73, 1 bitop3:0xa8
  v_cmp_ne_u32 vcc, 0, v72
  s_nop 0
  s_cmp_eq_u64 vcc, 0
  s_cselect_b32 s54, s62, 268435456
  s_nop 0
  v_add_f32_dpp v4, v4, v4 row_ror:4 row_mask:0xf bank_mask:0xf
  v_add_f32_dpp v5, v5, v5 row_ror:4 row_mask:0xf bank_mask:0xf
  s_nop 0
  v_add_f32_dpp v4, v4, v4 row_ror:8 row_mask:0xf bank_mask:0xf
  v_add_f32_dpp v5, v5, v5 row_ror:8 row_mask:0xf bank_mask:0xf
  v_cvt_pk_bf16_f32 v4, v4, v5
  buffer_store_dword v4, v69, s[8:11], s54 offen
  s_cbranch_vccnz Cf2_h1r
  s_xor_b32 s62, s62, 16384
  buffer_store_dword v71, v69, s[8:11], s62 offen
  s_xor_b32 s72, s72, 1
  s_branch Cf2_h2
Cf2_h1r:
  s_mov_b64 exec, vcc
  buffer_load_dwordx4 v[52:55], v76, s[8:11], s60 offen offset:0 sc1
  buffer_load_dwordx4 v[56:59], v76, s[8:11], s60 offen offset:1024 sc1
  s_mov_b64 exec, -1
  s_add_u32 s67, s67, 1
  s_waitcnt vmcnt(1)
  v_mfma_f32_16x16x32_bf16 v[4:7], v[0:3], v[52:55], 0
  v_bitop3_b32 v72, v52, v54, s72 bitop3:0x7e
  s_waitcnt vmcnt(0)
  v_mfma_f32_16x16x32_bf16 v[4:7], v[0:3], v[56:59], v[4:7]
  v_bitop3_b32 v73, v56, v58, s72 bitop3:0x7e
  v_bitop3_b32 v72, v72, v73, 1 bitop3:0xa8
  v_cmp_ne_u32 vcc, 0, v72
  s_cbranch_vccz Cf2_h1p
Cf2_h1s:
  s_mov_b64 exec, vcc
  buffer_load_dwordx4 v[52:55], v76, s[8:11], s60 offen offset:0 sc1
  buffer_load_dwordx4 v[56:59], v76, s[8:11], s60 offen offset:1024 sc1
  s_mov_b64 exec, -1
  s_add_u32 s67, s67, 1
  s_waitcnt vmcnt(1)
  v_mfma_f32_16x16x32_bf16 v[4:7], v[0:3], v[52:55], 0
  v_bitop3_b32 v72, v52, v54, s72 bitop3:0x7e
  s_waitcnt vmcnt(0)
  v_mfma_f32_16x16x32_bf16 v[4:7], v[0:3], v[56:59], v[4:7]
  v_bitop3_b32 v73, v56, v58, s72 bitop3:0x7e
  v_bitop3_b32 v72, v72, v73, 1 bitop3:0xa8
  v_cmp_ne_u32 vcc, 0, v72
  s_cbranch_vccz Cf2_h1p
  s_cmp_lt_u32 s67, 131072
  s_cbranch_scc1 Cf2_h1s
Cf2_h1p:
  s_nop 2
  v_add_f32_dpp v4, v4, v4 row_ror:4 row_mask:0xf bank_mask:0xf
  v_add_f32_dpp v5, v5, v5 row_ror:4 row_mask:0xf bank_mask:0xf
  s_nop 0
  v_add_f32_dpp v4, v4, v4 row_ror:8 row_mask:0xf bank_mask:0xf
  v_add_f32_dpp v5, v5, v5 row_ror:8 row_mask:0xf bank_mask:0xf
  v_cvt_pk_bf16_f32 v4, v4, v5
  buffer_store_dword v4, v69, s[8:11], s62 offen
  s_xor_b32 s62, s62, 16384
  buffer_store_dword v71, v69, s[8:11], s62 offen
  s_xor_b32 s72, s72, 1
  s_branch Cf2_h2
Cf2_h2r:
  s_mov_b64 exec, vcc
  buffer_load_dwordx4 v[12:15], v76, s[8:11], s65 offen offset:3072 sc1
  s_mov_b64 exec, -1
  s_add_u32 s67, s67, 1
  s_waitcnt vmcnt(4)
  v_max3_u32 v72, v12, v13, v14
  v_max_u32 v72, v72, v15
  ds_write_b128 v76, v[12:15] offset:7680
  v_cmp_eq_u32 vcc, -1, v72
  s_cbranch_vccz Cf2_h2w
  s_mov_b64 exec, vcc
  buffer_load_dwordx4 v[12:15], v76, s[8:11], s65 offen offset:3072 sc1
  s_mov_b64 exec, -1
  s_add_u32 s67, s67, 1
  s_waitcnt vmcnt(4)
  v_max3_u32 v72, v12, v13, v14
  v_max_u32 v72, v72, v15
  ds_write_b128 v76, v[12:15] offset:7680
  v_cmp_eq_u32 vcc, -1, v72
  s_cbranch_vccz Cf2_h2w
Cf2_h2s:
  s_mov_b64 exec, vcc
  buffer_load_dwordx4 v[12:15], v76, s[8:11], s65 offen offset:3072 sc1
  s_mov_b64 exec, -1
  s_add_u32 s67, s67, 1
  s_waitcnt vmcnt(2)
  v_max3_u32 v72, v12, v13, v14
  v_max_u32 v72, v72, v15
  ds_write_b128 v76, v[12:15] offset:7680
  v_cmp_eq_u32 vcc, -1, v72
  s_cbranch_vccz Cf2_h2w
  s_mov_b64 exec, vcc
  buffer_load_dwordx4 v[12:15], v76, s[8:11], s65 offen offset:3072 sc1
  s_mov_b64 exec, -1
  s_add_u32 s67, s67, 1
  s_waitcnt vmcnt(2)
  v_max3_u32 v72, v12, v13, v14
  v_max_u32 v72, v72, v15
  ds_write_b128 v76, v[12:15] offset:7680
  v_cmp_eq_u32 vcc, -1, v72
  s_cbranch_vccz Cf2_h2w
  s_mov_b64 exec, vcc
  buffer_load_dwordx4 v[12:15], v76, s[8:11], s65 offen offset:3072 sc1
  s_mov_b64 exec, -1
  s_add_u32 s67, s67, 1
  s_waitcnt vmcnt(2)
  v_max3_u32 v72, v12, v13, v14
  v_max_u32 v72, v72, v15
  ds_write_b128 v76, v[12:15] offset:7680
  v_cmp_eq_u32 vcc, -1, v72
  s_cbranch_vccz Cf2_h2w
  s_cmp_lt_u32 s67, 131072
  s_cbranch_scc1 Cf2_h2s
  s_branch Cf2_h2w
Cf2_rec:
  s_nop 7
  s_waitcnt vmcnt(0) lgkmcnt(0)
  v_max3_u32 v72, v0, v1, v2
  v_max3_u32 v72, v72, v3, v4
  v_max3_u32 v72, v72, v5, v6
  v_max3_u32 v72, v72, v7, v8
  v_max3_u32 v72, v72, v9, v10
  v_max3_u32 v72, v72, v11, v12
  v_max3_u32 v72, v72, v13, v14
  v_max3_u32 v72, v72, v15, v16
  v_max3_u32 v72, v72, v17, v18
  v_max_u32 v72, v72, v19
  v_cmp_eq_u32 vcc, -1, v72
  s_cbranch_vccz Cf2_recok
  s_barrier
Cf2_recp:
  buffer_load_dwordx4 v[0:3], v76, s[8:11], s64 offen offset:0 sc1
  buffer_load_dwordx4 v[4:7], v76, s[8:11], s64 offen offset:1024 sc1
  s_add_u32 s67, s67, 1
  s_cmp_lt_u32 s67, 131072
  s_cselect_b32 s54, -2, -1
  s_waitcnt vmcnt(1)
  v_max3_u32 v72, v0, v1, v2
  s_waitcnt vmcnt(0)
  v_max3_u32 v72, v72, v3, v4
  v_max3_u32 v72, v72, v5, v6
  v_max_u32 v72, v72, v7
  v_cmp_lt_u32 vcc, s54, v72
  s_cbranch_vccnz Cf2_recp
  ds_write_b128 v76, v[0:3] offset:8704
  ds_write_b128 v76, v[4:7] offset:9728
  v_mov_b64 v[20:21], 0
  v_mov_b64 v[22:23], 0
  v_mov_b64 v[24:25], 0
  v_mov_b64 v[26:27], 0
  v_mov_b64 v[28:29], 0
  v_mov_b64 v[30:31], 0
  v_mov_b64 v[32:33], 0
  v_mov_b64 v[34:35], 0
  s_waitcnt lgkmcnt(0)
  s_barrier
  ds_read_b128 v[0:3], v76 offset:4608
  s_waitcnt lgkmcnt(0)
  v_smfmac_f32_16x16x64_bf16 v[20:23], v[0:3], v[80:87], v74
  v_smfmac_f32_16x16x64_bf16 v[24:27], v[0:3], v[88:95], v74
  ds_read_b128 v[60:63], v76 offset:24576
  ds_read_b128 v[64:67], v76 offset:25600
  s_waitcnt lgkmcnt(0)
  v_smfmac_f32_16x16x64_bf16 v[28:31], v[0:3], v[60:67], v74
  ds_read_b128 v[60:63], v76 offset:26624
  ds_read_b128 v[64:67], v76 offset:27648
  s_waitcnt lgkmcnt(0)
  v_smfmac_f32_16x16x64_bf16 v[32:35], v[0:3], v[60:67], v74
  ds_read_b128 v[4:7], v76 offset:5632
  s_waitcnt lgkmcnt(0)
  v_smfmac_f32_16x16x64_bf16 v[20:23], v[4:7], v[96:103], v74
  v_smfmac_f32_16x16x64_bf16 v[24:27], v[4:7], v[104:111], v74
  ds_read_b128 v[60:63], v76 offset:40960
  ds_read_b128 v[64:67], v76 offset:41984
  s_waitcnt lgkmcnt(0)
  v_smfmac_f32_16x16x64_bf16 v[28:31], v[4:7], v[60:67], v74
  ds_read_b128 v[60:63], v76 offset:43008
  ds_read_b128 v[64:67], v76 offset:44032
  s_waitcnt lgkmcnt(0)
  v_smfmac_f32_16x16x64_bf16 v[32:35], v[4:7], v[60:67], v74
  ds_read_b128 v[8:11], v76 offset:6656
  s_waitcnt lgkmcnt(0)
  v_smfmac_f32_16x16x64_bf16 v[20:23], v[8:11], v[112:119], v74
  v_smfmac_f32_16x16x64_bf16 v[24:27], v[8:11], v[120:127], v74
  v_smfmac_f32_16x16x64_bf16 v[28:31], v[8:11], v[208:215], v74
  v_smfmac_f32_16x16x64_bf16 v[32:35], v[8:11], v[216:223], v74
  ds_read_b128 v[12:15], v76 offset:7680
  s_waitcnt lgkmcnt(0)
  v_smfmac_f32_16x16x64_bf16 v[20:23], v[12:15], v[128:135], v74
  v_smfmac_f32_16x16x64_bf16 v[24:27], v[12:15], v[136:143], v74
  v_smfmac_f32_16x16x64_bf16 v[28:31], v[12:15], v[224:231], v74
  v_smfmac_f32_16x16x64_bf16 v[32:35], v[12:15], v[232:239], v74
  ds_read_b128 v[12:15], v76 offset:8704
  s_waitcnt lgkmcnt(0)
  v_smfmac_f32_16x16x64_bf16 v[20:23], v[12:15], v[144:151], v74
  v_smfmac_f32_16x16x64_bf16 v[24:27], v[12:15], v[152:159], v74
  ds_read_b128 v[60:63], v76 offset:57344
  ds_read_b128 v[64:67], v76 offset:58368
  s_waitcnt lgkmcnt(0)
  v_smfmac_f32_16x16x64_bf16 v[28:31], v[12:15], v[60:67], v74
  ds_read_b128 v[60:63], v76 offset:59392
  ds_read_b128 v[64:67], v76 offset:60416
  s_waitcnt lgkmcnt(0)
  v_smfmac_f32_16x16x64_bf16 v[32:35], v[12:15], v[60:67], v74
  ds_read_b128 v[0:3], v76 offset:9728
  s_waitcnt lgkmcnt(0)
  v_smfmac_f32_16x16x64_bf16 v[20:23], v[0:3], v[160:167], v74
  v_smfmac_f32_16x16x64_bf16 v[24:27], v[0:3], v[168:175], v74
  ds_read_b128 v[60:63], v75 offset:24576
  ds_read_b128 v[64:67], v75 offset:25600
  s_waitcnt lgkmcnt(0)
  v_smfmac_f32_16x16x64_bf16 v[28:31], v[0:3], v[60:67], v74
  ds_read_b128 v[60:63], v75 offset:26624
  ds_read_b128 v[64:67], v75 offset:27648
  s_waitcnt lgkmcnt(0)
  v_smfmac_f32_16x16x64_bf16 v[32:35], v[0:3], v[60:67], v74
  ds_read_b128 v[16:19], v76 offset:10752
  ds_read_b128 v[60:63], v75 offset:8192
  ds_read_b128 v[64:67], v75 offset:9216
  s_waitcnt lgkmcnt(0)
  v_smfmac_f32_16x16x64_bf16 v[20:23], v[16:19], v[60:67], v74
  ds_read_b128 v[60:63], v75 offset:10240
  ds_read_b128 v[64:67], v75 offset:11264
  s_waitcnt lgkmcnt(0)
  v_smfmac_f32_16x16x64_bf16 v[24:27], v[16:19], v[60:67], v74
  v_smfmac_f32_16x16x64_bf16 v[28:31], v[16:19], v[240:247], v74
  v_smfmac_f32_16x16x64_bf16 v[32:35], v[16:19], v[248:255], v74
  ds_read_b128 v[4:7], v76 offset:11776
  s_waitcnt lgkmcnt(0)
  v_smfmac_f32_16x16x64_bf16 v[20:23], v[4:7], v[176:183], v74
  v_smfmac_f32_16x16x64_bf16 v[24:27], v[4:7], v[184:191], v74
  v_smfmac_f32_16x16x64_bf16 v[28:31], v[4:7], a[0:7], v74
  v_smfmac_f32_16x16x64_bf16 v[32:35], v[4:7], a[8:15], v74
  ds_read_b128 v[8:11], v76 offset:12800
  s_waitcnt lgkmcnt(0)
  v_smfmac_f32_16x16x64_bf16 v[20:23], v[8:11], v[192:199], v74
  v_smfmac_f32_16x16x64_bf16 v[24:27], v[8:11], v[200:207], v74
  v_smfmac_f32_16x16x64_bf16 v[28:31], v[8:11], a[16:23], v74
  v_smfmac_f32_16x16x64_bf16 v[32:35], v[8:11], a[24:31], v74
  v_add_f32 v20, v20, v22
  v_add_f32 v21, v21, v23
  v_add_f32 v24, v24, v26
  v_cvt_pk_bf16_f32 v22, v20, v24
  s_nop 0
  ds_write_b32 v79, v22 offset:0
  v_add_f32 v25, v25, v27
  v_cvt_pk_bf16_f32 v23, v21, v25
  ds_write_b32 v79, v23 offset:576
  v_add_f32 v28, v28, v30
  v_add_f32 v29, v29, v31
  s_waitcnt lgkmcnt(0)
  s_nop 1
  s_branch Cf2_recok
Cf2_mx:
  s_waitcnt lgkmcnt(0)
  s_barrier
  buffer_load_dwordx4 v[0:3], v76, s[8:11], s58 offen offset:0 sc1
  ds_read_b128 v[20:23], v77 offset:0
  ds_read_b128 v[28:31], v77 offset:256
  buffer_load_dwordx4 v[4:7], v76, s[8:11], s58 offen offset:1024 sc1
  ds_read_b128 v[24:27], v77 offset:128
  ds_read_b128 v[32:35], v77 offset:384
  s_waitcnt vmcnt(1) lgkmcnt(3)
  v_mfma_f32_16x16x32_bf16 v[8:11], v[0:3], v[20:23], 0
  s_waitcnt vmcnt(0) lgkmcnt(1)
  v_mfma_f32_16x16x32_bf16 v[8:11], v[4:7], v[24:27], v[8:11]
  v_mfma_f32_16x16x32_bf16 v[12:15], v[28:31], v[20:23], 0
  s_waitcnt lgkmcnt(0)
  v_mfma_f32_16x16x32_bf16 v[12:15], v[32:35], v[24:27], v[12:15]
  v_add_f32_dpp v8, v10, v8 quad_perm:[2,3,0,1] row_mask:0xf bank_mask:0xf
  v_add_f32_dpp v9, v11, v9 quad_perm:[2,3,0,1] row_mask:0xf bank_mask:0xf
  s_nop 0
  v_mov_b32_dpp v8, v8 quad_perm:[0,1,0,1] row_mask:0xf bank_mask:0xf
  v_mov_b32_dpp v9, v9 quad_perm:[0,1,0,1] row_mask:0xf bank_mask:0xf
  s_nop 1
  v_add_f32_dpp v12, v14, v12 quad_perm:[2,3,0,1] row_mask:0xf bank_mask:0xf
  v_add_f32_dpp v13, v15, v13 quad_perm:[2,3,0,1] row_mask:0xf bank_mask:0xf
  s_nop 0
  v_mov_b32_dpp v12, v12 quad_perm:[0,1,0,1] row_mask:0xf bank_mask:0xf
  v_mov_b32_dpp v13, v13 quad_perm:[0,1,0,1] row_mask:0xf bank_mask:0xf
  v_mul_f32 v12, s69, v12
  ds_write_b32 v78, v8 offset:8712
  v_mul_f32 v13, s69, v13
  ds_write_b32 v78, v9 offset:8776
  s_waitcnt lgkmcnt(0)
  s_barrier
  ds_read_b128 v[36:39], v78 offset:8704
  ds_read_b128 v[40:43], v78 offset:8768
  s_waitcnt lgkmcnt(0)
  s_barrier
  v_max_f32 v16, v36, v37
  v_max3_f32 v16, v16, v38, v39
  v_max3_f32 v16, v16, v40, v41
  v_max3_f32 v16, v16, v42, v43
  v_max3_f32 v16, v16, v12, v13
  v_mov_b32 v17, v16
  s_nop 1
  v_permlane16_swap_b32 v16, v17
  v_max_f32 v16, v16, v17
  v_mov_b32 v17, v16
  s_nop 1
  v_permlane32_swap_b32 v16, v17
  v_max_f32 v16, v16, v17
  v_sub_f32 v36, v36, v16
  v_sub_f32 v37, v37, v16
  v_sub_f32 v38, v38, v16
  v_sub_f32 v39, v39, v16
  v_sub_f32 v40, v40, v16
  v_sub_f32 v41, v41, v16
  v_sub_f32 v42, v42, v16
  v_sub_f32 v43, v43, v16
  v_sub_f32 v12, v12, v16
  v_sub_f32 v13, v13, v16
  v_exp_f32 v36, v36
  v_exp_f32 v37, v37
  v_exp_f32 v38, v38
  v_exp_f32 v39, v39
  v_exp_f32 v40, v40
  v_exp_f32 v41, v41
  v_exp_f32 v42, v42
  v_exp_f32 v43, v43
  v_exp_f32 v12, v12
  v_exp_f32 v13, v13
  v_cvt_pk_bf16_f32 v32, v36, v40
  v_cvt_pk_bf16_f32 v33, v37, v41
  v_cvt_pk_bf16_f32 v34, v38, v42
  v_cvt_pk_bf16_f32 v35, v39, v43
  v_cvt_pk_bf16_f32 v28, v12, v13
  v_cvt_pk_bf16_f32 v31, v12, v13
  v_mov_b32 v29, 0
  v_mov_b32 v30, 0
  v_mov_b32 v68, 0x3f803f80
  v_mov_b32 v69, 0x3f803f80
  v_mov_b32 v70, 0x3f803f80
  v_mov_b32 v71, 0x3f803f80
  s_nop 1
  v_mfma_f32_16x16x32_bf16 v[8:11], v[32:35], v[68:71], 0
  v_mfma_f32_16x16x32_bf16 v[0:3], v[32:35], v[52:55], 0
  v_mfma_f32_16x16x32_bf16 v[4:7], v[32:35], v[56:59], 0
  v_mfma_f32_16x16x16_bf16 v[8:11], v[28:29], v[68:69], v[8:11]
  v_mfma_f32_16x16x16_bf16 v[0:3], v[28:29], v[72:73], v[0:3]
  v_mfma_f32_16x16x16_bf16 v[4:7], v[30:31], v[72:73], v[4:7]
  ds_read_b128 v[68:71], v76 offset:13824
  v_rcp_f32 v10, v8
  v_rcp_f32 v11, v9
  v_mul_f32 v0, v10, v0
  v_mul_f32 v1, v11, v1
  s_nop 0
  v_mul_f32 v4, v10, v4
  v_mul_f32 v5, v11, v5
  v_cvt_pk_bf16_f32 v2, v0, v4
  ds_write_b32 v79, v2 offset:8704
  v_cvt_pk_bf16_f32 v3, v1, v5
  ds_write_b32 v79, v3 offset:9280
  v_mov_b64 v[16:17], 0
  v_mov_b64 v[18:19], 0
  v_mov_b64 v[20:21], 0
  v_mov_b64 v[22:23], 0
  v_mov_b64 v[24:25], 0
  v_mov_b64 v[26:27], 0
  s_branch Cf2_mxok
Cf2_last:
  ds_read_b128 v[4:7], v76 offset:5632
  ds_read_b128 v[8:11], v76 offset:6656
  ds_read_b128 v[44:47], v76 offset:40960
  ds_read_b128 v[48:51], v76 offset:41984
  s_nop 5
  v_mov_b64 v[20:21], 0
  v_mov_b64 v[22:23], 0
  v_mov_b64 v[24:25], 0
  v_mov_b64 v[26:27], 0
  s_waitcnt lgkmcnt(4)
  v_smfmac_f32_16x16x64_bf16 v[28:31], v[0:3], v[36:43], v74
  ds_read_b128 v[36:39], v76 offset:43008
  ds_read_b128 v[40:43], v76 offset:44032
  v_smfmac_f32_16x16x64_bf16 v[32:35], v[0:3], v[60:67], v74
  s_waitcnt lgkmcnt(5)
  v_smfmac_f32_16x16x64_bf16 v[20:23], v[0:3], a[32:39], v74
  ds_read_b128 v[60:63], v76 offset:57344
  ds_read_b128 v[64:67], v76 offset:58368
  v_smfmac_f32_16x16x64_bf16 v[24:27], v[0:3], a[40:47], v74
  s_waitcnt lgkmcnt(4)
  v_smfmac_f32_16x16x64_bf16 v[20:23], v[4:7], a[48:55], v74
  buffer_store_dwordx4 v[16:19], v76, s[8:11], s68 offen sc1
  v_smfmac_f32_16x16x64_bf16 v[24:27], v[4:7], a[56:63], v74
  v_smfmac_f32_16x16x64_bf16 v[28:31], v[4:7], v[44:51], v74
  s_waitcnt lgkmcnt(2)
  v_smfmac_f32_16x16x64_bf16 v[20:23], v[8:11], a[64:71], v74
  ds_read_b128 v[44:47], v76 offset:59392
  ds_read_b128 v[48:51], v76 offset:60416
  v_smfmac_f32_16x16x64_bf16 v[24:27], v[8:11], a[72:79], v74
  v_smfmac_f32_16x16x64_bf16 v[32:35], v[4:7], v[36:43], v74
  v_smfmac_f32_16x16x64_bf16 v[28:31], v[8:11], v[208:215], v74
  ds_read_b128 v[36:39], v75 offset:24576
  ds_read_b128 v[40:43], v75 offset:25600
  v_smfmac_f32_16x16x64_bf16 v[32:35], v[8:11], v[216:223], v74
  v_smfmac_f32_16x16x64_bf16 v[20:23], v[12:15], a[80:87], v74
  v_smfmac_f32_16x16x64_bf16 v[24:27], v[12:15], a[88:95], v74
  v_smfmac_f32_16x16x64_bf16 v[28:31], v[12:15], v[224:231], v74
  v_smfmac_f32_16x16x64_bf16 v[32:35], v[12:15], v[232:239], v74
  s_waitcnt vmcnt(2)
  s_waitcnt vmcnt(1)
  s_barrier
Cf2_lastr:
  ds_read_b128 v[12:15], v76 offset:8704
  ds_read_b128 v[0:3], v76 offset:9728
  ds_read_b128 v[16:19], v76 offset:10752
  ds_read_b128 v[4:7], v76 offset:11776
  ds_read_b128 v[8:11], v76 offset:12800
  s_waitcnt lgkmcnt(3)
  v_max3_u32 v72, v0, v1, v2
  s_waitcnt lgkmcnt(1)
  v_max3_u32 v72, v72, v3, v4
  v_max3_u32 v72, v72, v5, v6
  s_waitcnt lgkmcnt(0)
  v_max3_u32 v72, v72, v7, v8
  v_max3_u32 v72, v72, v9, v10
  v_max3_u32 v72, v72, v11, v12
  v_max3_u32 v72, v72, v13, v14
  v_max3_u32 v72, v72, v15, v16
  v_max3_u32 v72, v72, v17, v18
  v_max_u32 v72, v72, v19
  v_cmp_eq_u32 vcc, -1, v72
  s_cbranch_vccnz Cf2_lastp
Cf2_lastg:
  v_smfmac_f32_16x16x64_bf16 v[28:31], v[12:15], v[60:67], v74
  ds_read_b128 v[60:63], v75 offset:26624
  ds_read_b128 v[64:67], v75 offset:27648
  v_smfmac_f32_16x16x64_bf16 v[32:35], v[12:15], v[44:51], v74
  v_smfmac_f32_16x16x64_bf16 v[28:31], v[0:3], v[36:43], v74
  v_smfmac_f32_16x16x64_bf16 v[28:31], v[16:19], v[240:247], v74
  v_smfmac_f32_16x16x64_bf16 v[28:31], v[4:7], a[0:7], v74
  v_smfmac_f32_16x16x64_bf16 v[28:31], v[8:11], a[16:23], v74
  v_smfmac_f32_16x16x64_bf16 v[32:35], v[16:19], v[248:255], v74
  v_smfmac_f32_16x16x64_bf16 v[32:35], v[4:7], a[8:15], v74
  s_waitcnt lgkmcnt(0)
  v_smfmac_f32_16x16x64_bf16 v[32:35], v[8:11], a[24:31], v74
  v_smfmac_f32_16x16x64_bf16 v[32:35], v[0:3], v[60:67], v74
  v_smfmac_f32_16x16x64_bf16 v[20:23], v[12:15], a[96:103], v74
  v_smfmac_f32_16x16x64_bf16 v[20:23], v[0:3], a[112:119], v74
  v_add_f32 v28, v28, v30
  v_add_f32 v32, v32, v34
  v_cvt_pk_bf16_f32 v30, v28, v32
  v_smfmac_f32_16x16x64_bf16 v[20:23], v[16:19], a[128:135], v74
  ds_write_b32 v79, v30 offset:256
  v_add_f32 v29, v29, v31
  v_add_f32 v33, v33, v35
  v_cvt_pk_bf16_f32 v31, v29, v33
  v_smfmac_f32_16x16x64_bf16 v[20:23], v[4:7], a[144:151], v74
  ds_write_b32 v79, v31 offset:832
  v_smfmac_f32_16x16x64_bf16 v[20:23], v[8:11], a[160:167], v74
  v_smfmac_f32_16x16x64_bf16 v[24:27], v[12:15], a[104:111], v74
  v_smfmac_f32_16x16x64_bf16 v[24:27], v[0:3], a[120:127], v74
  v_smfmac_f32_16x16x64_bf16 v[24:27], v[16:19], a[136:143], v74
  s_waitcnt lgkmcnt(0)
  s_barrier
  ds_read_b64 v[52:53], v77 offset:384
  v_add_f32 v20, v20, v22
  v_smfmac_f32_16x16x64_bf16 v[24:27], v[4:7], a[152:159], v74
  v_add_f32 v21, v21, v23
  v_smfmac_f32_16x16x64_bf16 v[24:27], v[8:11], a[168:175], v74
  v_cvt_pk_bf16_f32 v54, v20, v21
  s_add_u32 s68, s68, 655360
  s_nop 3
  v_add_f32 v24, v24, v26
  v_add_f32 v25, v25, v27
  v_cvt_pk_bf16_f32 v55, v24, v25
  s_waitcnt lgkmcnt(0)
  buffer_store_dwordx4 v[52:55], v76, s[8:11], s68 offen sc1
  s_branch Cf2_done
Cf2_lastp:
  s_add_u32 s72, s72, 2
  s_cmp_ge_u32 s72, 131072
  s_cbranch_scc1 Cf2_lastg
  s_barrier
  buffer_load_dwordx4 v76, s[8:11], s55 offen offset:0 sc1 lds
  s_waitcnt vmcnt(0)
  s_barrier
  s_branch Cf2_lastr
Cf2_done:
  s_branch L_cexit
L_w3:
  v_mov_b64 v[20:21], 0
  v_mov_b64 v[22:23], 0
  v_mov_b64 v[24:25], 0
  v_mov_b64 v[26:27], 0
  v_mov_b64 v[28:29], 0
  v_mov_b64 v[30:31], 0
  v_mov_b64 v[32:33], 0
  v_mov_b64 v[34:35], 0
  s_mov_b32 s78, 0x3f803f80
  s_mov_b32 s79, s78
  s_mov_b32 s65, 360448
  s_mov_b32 m0, 15872
  s_lshl_b32 s71, s53, 2
  s_add_u32 s71, s71, 128
  s_movk_i32 s56, 0x1000
  v_lshlrev_b32 v73, 2, v76
  v_mov_b32 v72, 0
  s_mov_b64 s[16:17], s[8:9]
  s_mov_b32 s18, 268435456
  s_mov_b32 s19, 0x20000
  s_getpc_b64 s[20:21]
Cf3_pc:
  s_add_u32 s20, s20, (Cf3_last - Cf3_pc)
  s_addc_u32 s21, s21, 0
  v_mov_b32 v68, 14880
  buffer_load_dwordx4 v[52:55], v76, s[8:11], s59 offen offset:0 sc1
  buffer_load_dwordx4 v[56:59], v76, s[8:11], s59 offen offset:1024 sc1
  ds_read_b128 v[36:39], v76 offset:45056
  ds_read_b128 v[40:43], v76 offset:46080
  ds_read_b128 v[60:63], v76 offset:47104
  ds_read_b128 v[64:67], v76 offset:48128
  ds_read_b128 v[0:3], v76 offset:4608
  ds_read_b128 v[4:7], v76 offset:5632
  ds_read_b128 v[8:11], v76 offset:6656
  ds_read_b128 v[12:15], v76 offset:7680
  s_waitcnt lgkmcnt(0)
  s_cmp_eq_u32 s66, 1
  s_branch Cf3_top2
.p2align 6
Cf3_h2:
  v_lshlrev_b32 v73, 2, v76
  s_mov_b32 m0, 8704
  s_add_u32 s55, s65, 4096
  buffer_load_dwordx4 v[4:7], v76, s[8:11], s65 offen offset:1024 sc1
  s_waitcnt vmcnt(6)
  ds_read_b128 v[36:39], v76 offset:45056
  ds_read_b128 v[40:43], v76 offset:46080
  ds_read_b128 v[60:63], v76 offset:47104
  ds_read_b128 v[64:67], v76 offset:48128
  buffer_load_dwordx4 v[52:55], v76, s[8:11], s59 offen offset:0 sc1
  buffer_load_dwordx4 v[56:59], v76, s[8:11], s59 offen offset:1024 sc1
  s_waitcnt vmcnt(7)
  v_max3_u32 v72, v4, v5, v6
  v_max_u32 v72, v72, v7
  ds_write_b128 v76, v[4:7] offset:5632
  v_cmp_eq_u32 vcc, -1, v72
  s_cbranch_vccnz Cf3_h2r
Cf3_h2w:
  buffer_load_dwordx4 v76, s[8:11], s55 offen offset:0 sc1 lds
  buffer_load_dwordx4 v76, s[8:11], s55 offen offset:1024 sc1 lds
  s_cmp_eq_u32 s66, 63
  s_waitcnt lgkmcnt(0)
  s_barrier
  ds_read_b128 v[8:11], v76 offset:6656
Cf3_top2:
  v_smfmac_f32_16x16x64_bf16 v[20:23], v[4:7], v[96:103], v74
  s_cbranch_scc1 Cf3_last
  v_smfmac_f32_16x16x64_bf16 v[28:31], v[4:7], v[36:43], v74
  buffer_load_dwordx4 v[44:47], v76, s[8:11], s58 offen offset:0 sc1
  s_mov_b32 m0, 15872
  v_smfmac_f32_16x16x64_bf16 v[24:27], v[4:7], v[104:111], v74
  buffer_load_dwordx4 v[48:51], v76, s[8:11], s58 offen offset:1024 sc1
  v_smfmac_f32_16x16x64_bf16 v[32:35], v[4:7], v[60:67], v74
  ds_read_b128 v[0:3], v76 offset:4608
  s_waitcnt lgkmcnt(1)
  v_smfmac_f32_16x16x64_bf16 v[20:23], v[8:11], v[112:119], v74
  ds_read_b128 v[12:15], v76 offset:7680
  v_smfmac_f32_16x16x64_bf16 v[24:27], v[8:11], v[120:127], v74
  ds_read_b128 v[36:39], v76 offset:28672
  v_smfmac_f32_16x16x64_bf16 v[28:31], v[8:11], v[208:215], v74
  buffer_store_dwordx4 v[16:19], v76, s[8:11], s68 offen sc1
  ds_read_b128 v[40:43], v76 offset:29696
  v_smfmac_f32_16x16x64_bf16 v[32:35], v[8:11], v[216:223], v74
  ds_read_b128 v[60:63], v76 offset:30720
  s_waitcnt lgkmcnt(4)
  v_smfmac_f32_16x16x64_bf16 v[20:23], v[0:3], v[80:87], v74
  ds_read_b128 v[64:67], v76 offset:31744
  v_smfmac_f32_16x16x64_bf16 v[24:27], v[0:3], v[88:95], v74
  buffer_load_dword v73, s[16:19], s70 offen lds
  s_waitcnt vmcnt(4)
  s_waitcnt lgkmcnt(4)
  v_smfmac_f32_16x16x64_bf16 v[20:23], v[12:15], v[128:135], v74
  s_barrier
  s_waitcnt lgkmcnt(2)
  v_smfmac_f32_16x16x64_bf16 v[28:31], v[0:3], v[36:43], v74
  ds_read_b128 v[4:7], v76 offset:8704
  v_smfmac_f32_16x16x64_bf16 v[24:27], v[12:15], v[136:143], v74
  ds_read_b128 v[36:39], v76 offset:61440
  s_waitcnt lgkmcnt(2)
  v_smfmac_f32_16x16x64_bf16 v[32:35], v[0:3], v[60:67], v74
  ds_read_b128 v[40:43], v76 offset:62464
  v_smfmac_f32_16x16x64_bf16 v[28:31], v[12:15], v[224:231], v74
  ds_read_b128 v[60:63], v76 offset:63488
  v_smfmac_f32_16x16x64_bf16 v[32:35], v[12:15], v[232:239], v74
  ds_read_b128 v[64:67], v76 offset:64512
  s_waitcnt lgkmcnt(4)
  v_smfmac_f32_16x16x64_bf16 v[20:23], v[4:7], v[144:151], v74
  ds_read_b128 v[8:11], v76 offset:9728
  s_waitcnt lgkmcnt(3)
  v_smfmac_f32_16x16x64_bf16 v[28:31], v[4:7], v[36:43], v74
  s_barrier
  ds_read_b128 v[0:3], v76 offset:11776
  v_smfmac_f32_16x16x64_bf16 v[24:27], v[4:7], v[152:159], v74
  ds_read_b128 v[36:39], v75 offset:12288
  ds_read_b128 v[40:43], v75 offset:13312
  s_waitcnt lgkmcnt(4)
  v_smfmac_f32_16x16x64_bf16 v[32:35], v[4:7], v[60:67], v74
  ds_read_b128 v[16:19], v76 offset:10752
  s_waitcnt lgkmcnt(4)
  v_smfmac_f32_16x16x64_bf16 v[20:23], v[8:11], v[160:167], v74
  ds_read_b128 v[12:15], v76 offset:12800
  v_smfmac_f32_16x16x64_bf16 v[24:27], v[8:11], v[168:175], v74
  ds_read_b128 v[60:63], v75 offset:14336
  ds_read_b128 v[64:67], v75 offset:15360
  s_waitcnt lgkmcnt(6)
  v_smfmac_f32_16x16x64_bf16 v[20:23], v[0:3], v[176:183], v74
  s_waitcnt lgkmcnt(3)
  v_smfmac_f32_16x16x64_bf16 v[20:23], v[16:19], v[36:43], v74
  ds_read_b128 v[36:39], v75 offset:28672
  s_waitcnt lgkmcnt(3)
  v_smfmac_f32_16x16x64_bf16 v[20:23], v[12:15], v[192:199], v74
  ds_read_b128 v[40:43], v75 offset:29696
  s_waitcnt lgkmcnt(2)
  v_smfmac_f32_16x16x64_bf16 v[24:27], v[16:19], v[60:67], v74
  ds_read_b128 v[60:63], v75 offset:30720
  v_smfmac_f32_16x16x64_bf16 v[24:27], v[0:3], v[184:191], v74
  ds_read_b128 v[64:67], v75 offset:31744
  v_add_f32 v20, v20, v22
  v_smfmac_f32_16x16x64_bf16 v[24:27], v[12:15], v[200:207], v74
  v_add_f32 v21, v21, v23
  v_smfmac_f32_16x16x64_bf16 v[28:31], v[16:19], v[240:247], v74
  s_waitcnt lgkmcnt(2)
  v_mov_b64 v[70:71], s[78:79]
  v_smfmac_f32_16x16x64_bf16 v[28:31], v[8:11], v[36:43], v74
  ds_read_b128 v[36:39], v68
  v_add_f32 v24, v24, v26
  v_smfmac_f32_16x16x64_bf16 v[28:31], v[0:3], a[0:7], v74
  ds_read_b128 v[40:43], v68
  v_cvt_pk_bf16_f32 v22, v20, v24
  v_smfmac_f32_16x16x64_bf16 v[28:31], v[12:15], a[16:23], v74
  ds_write_b32 v79, v22 offset:0
  s_waitcnt lgkmcnt(3)
  v_add_f32 v25, v25, v27
  v_cvt_pk_bf16_f32 v23, v21, v25
  v_smfmac_f32_16x16x64_bf16 v[32:35], v[8:11], v[60:67], v74
  ds_write_b32 v79, v23 offset:576
  v_cmp_u_f32 vcc, v20, v21
  v_smfmac_f32_16x16x64_bf16 v[32:35], v[16:19], v[248:255], v74
  v_add_f32 v28, v28, v30
  v_smfmac_f32_16x16x64_bf16 v[32:35], v[0:3], a[8:15], v74
  v_add_f32 v29, v29, v31
  v_smfmac_f32_16x16x64_bf16 v[32:35], v[12:15], a[24:31], v74
  s_cbranch_vccnz Cf3_rec
Cf3_recok:
  s_waitcnt lgkmcnt(3)
  v_smfmac_f32_16x16x64_bf16 v[36:39], v[16:19], a[128:135], v74
  s_waitcnt lgkmcnt(0)
  s_barrier
  ds_read_b128 v[60:63], v77
  v_smfmac_f32_16x16x64_bf16 v[40:43], v[16:19], a[136:143], v74
  ds_read_b128 v[64:67], v77 offset:128
  v_add_f32 v32, v32, v34
  v_cvt_pk_bf16_f32 v30, v28, v32
  v_smfmac_f32_16x16x64_bf16 v[36:39], v[0:3], a[144:151], v74
  ds_write_b32 v79, v30 offset:256
  v_add_f32 v33, v33, v35
  v_cvt_pk_bf16_f32 v31, v29, v33
  v_smfmac_f32_16x16x64_bf16 v[40:43], v[0:3], a[152:159], v74
  ds_write_b32 v79, v31 offset:832
  v_xor_b32 v75, 0x8000, v75
  v_smfmac_f32_16x16x64_bf16 v[36:39], v[4:7], a[96:103], v74
  ds_read_b128 v[0:3], v76 offset:4608
  v_mov_b32 v29, 0
  v_smfmac_f32_16x16x64_bf16 v[40:43], v[4:7], a[104:111], v74
  s_waitcnt vmcnt(2) lgkmcnt(3)
  v_mov_b32 v30, 0
  v_mfma_f32_16x16x32_bf16 v[44:47], v[44:47], v[60:63], 0
  ds_read_b128 v[4:7], v76 offset:5632
  s_waitcnt lgkmcnt(2)
  v_mfma_f32_16x16x32_bf16 v[44:47], v[48:51], v[64:67], v[44:47]
  s_barrier
  v_smfmac_f32_16x16x64_bf16 v[36:39], v[8:11], a[112:119], v74
  ds_read_b128 v[20:23], v77 offset:256
  ds_read_b128 v[24:27], v77 offset:384
  v_smfmac_f32_16x16x64_bf16 v[40:43], v[8:11], a[120:127], v74
  ds_read_b128 v[8:11], v76 offset:6656
  v_add_f32_dpp v72, v46, v44 quad_perm:[2,3,0,1] row_mask:0xf bank_mask:0xf
  v_add_f32_dpp v73, v47, v45 quad_perm:[2,3,0,1] row_mask:0xf bank_mask:0xf
  v_smfmac_f32_16x16x64_bf16 v[36:39], v[12:15], a[160:167], v74
  s_waitcnt lgkmcnt(4)
  v_exp_f32_dpp v72, v72 quad_perm:[0,1,0,1] row_mask:0xf bank_mask:0xf
  v_smfmac_f32_16x16x64_bf16 v[40:43], v[12:15], a[168:175], v74
  ds_read_b128 v[12:15], v76 offset:7680
  v_exp_f32_dpp v73, v73 quad_perm:[0,1,0,1] row_mask:0xf bank_mask:0xf
  v_smfmac_f32_16x16x64_bf16 v[36:39], v[0:3], a[32:39], v74
  s_waitcnt lgkmcnt(2)
  v_cvt_pk_bf16_f32 v72, v72, v73
  v_mfma_f32_16x16x32_bf16 v[20:23], v[20:23], v[60:63], 0
  ds_write_b32 v78, v72 offset:524
  v_mov_b64 v[16:17], 0
  v_mfma_f32_16x16x32_bf16 v[20:23], v[24:27], v[64:67], v[20:23]
  ds_read_b128 v[44:47], v75 offset:28672
  v_mov_b64 v[18:19], 0
  v_smfmac_f32_16x16x64_bf16 v[40:43], v[0:3], a[40:47], v74
  ds_read_b128 v[48:51], v75 offset:29696
  v_mov_b64 v[68:69], s[78:79]
  v_smfmac_f32_16x16x64_bf16 v[36:39], v[4:7], a[48:55], v74
  s_waitcnt lgkmcnt(4)
  v_add_f32_dpp v24, v22, v20 quad_perm:[2,3,0,1] row_mask:0xf bank_mask:0xf
  v_add_f32_dpp v25, v23, v21 quad_perm:[2,3,0,1] row_mask:0xf bank_mask:0xf
  v_smfmac_f32_16x16x64_bf16 v[36:39], v[8:11], a[64:71], v74
  s_waitcnt lgkmcnt(2)
  s_barrier
  ds_read_b128 v[32:35], v78 offset:512
  v_smfmac_f32_16x16x64_bf16 v[36:39], v[12:15], a[80:87], v74
  ds_read_b128 v[60:63], v75 offset:30720
  v_mul_f32 v24, s69, v24
  v_smfmac_f32_16x16x64_bf16 v[40:43], v[4:7], a[56:63], v74
  ds_read_b128 v[64:67], v75 offset:31744
  v_mul_f32 v25, s69, v25
  v_smfmac_f32_16x16x64_bf16 v[40:43], v[8:11], a[72:79], v74
  v_exp_f32_dpp v24, v24 quad_perm:[0,1,0,1] row_mask:0xf bank_mask:0xf
  v_smfmac_f32_16x16x64_bf16 v[40:43], v[12:15], a[88:95], v74
  s_waitcnt lgkmcnt(2)
  v_exp_f32_dpp v25, v25 quad_perm:[0,1,0,1] row_mask:0xf bank_mask:0xf
  v_mfma_f32_16x16x32_bf16 v[8:11], v[32:35], v[68:71], 0
  v_add_f32 v36, v36, v38
  v_add_f32 v37, v37, v39
  v_mfma_f32_16x16x32_bf16 v[0:3], v[32:35], v[52:55], 0
  v_add_f32 v40, v40, v42
  v_add_f32 v41, v41, v43
  v_mfma_f32_16x16x32_bf16 v[4:7], v[32:35], v[56:59], 0
  v_cvt_pk_bf16_f32 v28, v24, v25
  v_cvt_pk_bf16_f32 v72, v36, v37
  v_cvt_pk_bf16_f32 v73, v40, v41
  v_mfma_f32_16x16x16_bf16 v[8:11], v[28:29], v[68:69], v[8:11]
  v_cvt_pk_bf16_f32 v31, v24, v25
  v_mov_b64 v[20:21], 0
  v_mfma_f32_16x16x16_bf16 v[0:3], v[28:29], v[72:73], v[0:3]
  ds_read_b128 v[68:71], v76 offset:13824
  v_mov_b64 v[22:23], 0
  v_mfma_f32_16x16x16_bf16 v[4:7], v[30:31], v[72:73], v[4:7]
  v_rcp_f32 v10, v8
  v_rcp_f32 v11, v9
  v_mul_f32 v0, v10, v0
  v_mul_f32 v1, v11, v1
  s_nop 0
  v_mul_f32 v4, v10, v4
  v_mul_f32 v5, v11, v5
  v_cvt_pk_bf16_f32 v2, v0, v4
  ds_write_b32 v79, v2 offset:8704
  v_cvt_pk_bf16_f32 v3, v1, v5
  ds_write_b32 v79, v3 offset:9280
  v_max3_f32 v8, v8, v9, v10
  v_max_f32 v8, v8, v11
  v_cmp_le_f32 vcc, 1317011456, v8
  v_mov_b64 v[24:25], 0
  v_mov_b64 v[26:27], 0
  s_cbranch_vccnz Cf3_mx
Cf3_mxok:
  s_waitcnt lgkmcnt(0)
  s_barrier
  ds_read_b128 v[0:3], v78 offset:8704
  ds_read_b128 v[4:7], v78 offset:8768
  ds_read_b128 v[8:11], v78 offset:8832
  ds_read_b128 v[12:15], v78 offset:8896
  s_waitcnt lgkmcnt(3)
  v_smfmac_f32_16x16x64_bf16 v[16:19], v[0:3], v[44:51], v74
  ds_read_b128 v[52:55], v75 offset:45056
  s_waitcnt lgkmcnt(3)
  v_smfmac_f32_16x16x64_bf16 v[16:19], v[4:7], v[60:67], v74
  ds_read_b128 v[56:59], v75 offset:46080
  s_waitcnt lgkmcnt(3)
  v_smfmac_f32_16x16x64_bf16 v[16:19], v[8:11], a[176:183], v74
  ds_read_b128 v[36:39], v75 offset:47104
  s_waitcnt lgkmcnt(3)
  v_smfmac_f32_16x16x64_bf16 v[16:19], v[12:15], a[184:191], v74
  ds_read_b128 v[40:43], v75 offset:48128
  ds_read_b128 v[44:47], v75 offset:61440
  v_smfmac_f32_16x16x64_bf16 v[20:23], v[0:3], a[192:199], v74
  ds_read_b128 v[48:51], v75 offset:62464
  ds_read_b128 v[60:63], v75 offset:63488
  v_smfmac_f32_16x16x64_bf16 v[20:23], v[4:7], a[200:207], v74
  ds_read_b128 v[64:67], v75 offset:64512
  s_waitcnt lgkmcnt(6)
  v_cvt_pk_bf16_f32 v16, v16, v17
  v_cvt_pk_bf16_f32 v17, v18, v19
  v_bfi_b32 v16, 1, s72, v16
  v_smfmac_f32_16x16x64_bf16 v[20:23], v[8:11], v[52:59], v74
  buffer_store_dwordx2 v[16:17], v68, s[8:11], s73 offen
  s_waitcnt lgkmcnt(4)
  v_smfmac_f32_16x16x64_bf16 v[20:23], v[12:15], v[36:43], v74
  ds_read_b128 v[52:55], v75 offset:8192
  v_mov_b64 v[32:33], 0
  v_smfmac_f32_16x16x64_bf16 v[24:27], v[0:3], a[208:215], v74
  ds_read_b128 v[56:59], v75 offset:9216
  v_mov_b64 v[34:35], 0
  v_smfmac_f32_16x16x64_bf16 v[24:27], v[4:7], a[216:223], v74
  ds_read_b128 v[36:39], v75 offset:10240
  s_waitcnt lgkmcnt(5)
  v_cvt_pk_bf16_f32 v20, v20, v21
  v_cvt_pk_bf16_f32 v21, v22, v23
  v_bfi_b32 v20, 1, s72, v20
  v_smfmac_f32_16x16x64_bf16 v[24:27], v[8:11], v[44:51], v74
  buffer_store_dwordx2 v[20:21], v68, s[8:11], s74 offen
  s_waitcnt lgkmcnt(3)
  v_smfmac_f32_16x16x64_bf16 v[24:27], v[12:15], v[60:67], v74
  ds_read_b128 v[40:43], v75 offset:11264
  v_mov_b64 v[28:29], 0
  v_smfmac_f32_16x16x64_bf16 v[32:35], v[0:3], a[224:231], v74
  ds_read_b128 v[44:47], v75 offset:12288
  ds_read_b128 v[48:51], v75 offset:13312
  v_smfmac_f32_16x16x64_bf16 v[32:35], v[4:7], a[232:239], v74
  ds_read_b128 v[60:63], v75 offset:14336
  v_cvt_pk_bf16_f32 v24, v24, v25
  v_cvt_pk_bf16_f32 v25, v26, v27
  v_bfi_b32 v24, 1, s72, v24
  v_smfmac_f32_16x16x64_bf16 v[32:35], v[8:11], a[240:247], v74
  buffer_store_dwordx2 v[24:25], v68, s[8:11], s75 offen
  v_mov_b64 v[30:31], 0
  v_smfmac_f32_16x16x64_bf16 v[32:35], v[12:15], a[248:255], v74
  ds_read_b128 v[64:67], v75 offset:15360
  s_waitcnt lgkmcnt(6)
  v_smfmac_f32_16x16x64_bf16 v[28:31], v[0:3], v[52:59], v74
  s_waitcnt lgkmcnt(4)
  v_smfmac_f32_16x16x64_bf16 v[28:31], v[4:7], v[36:43], v74
  s_waitcnt lgkmcnt(2)
  v_cvt_pk_bf16_f32 v32, v32, v33
  v_cvt_pk_bf16_f32 v33, v34, v35
  v_bfi_b32 v32, 1, s72, v32
  v_smfmac_f32_16x16x64_bf16 v[28:31], v[8:11], v[44:51], v74
  buffer_store_dwordx2 v[32:33], v68, s[8:11], s76 offen
  s_waitcnt lgkmcnt(0)
  v_smfmac_f32_16x16x64_bf16 v[28:31], v[12:15], v[60:67], v74
  ds_read_b128 v[52:55], v76 offset:14848
  ds_read_b64 v[16:17], v77 offset:392
  v_mov_b64 v[18:19], v[72:73]
  v_xor_b32 v75, 0x8000, v75
  s_nop 3
  v_cvt_pk_bf16_f32 v28, v28, v29
  v_cvt_pk_bf16_f32 v29, v30, v31
  v_bfi_b32 v28, 1, s72, v28
  buffer_store_dwordx2 v[28:29], v68, s[8:11], s77 offen
  v_mov_b64 v[20:21], 0
  v_mov_b64 v[22:23], 0
  v_mov_b64 v[24:25], 0
  v_mov_b64 v[26:27], 0
  v_mov_b64 v[28:29], 0
  v_mov_b64 v[30:31], 0
  v_mov_b64 v[32:33], 0
  v_mov_b64 v[34:35], 0
  v_mov_b32 v68, 14880
  s_add_u32 s58, s58, 655360
  s_add_u32 s59, s59, 655360
  s_add_u32 s70, s70, 655360
  s_add_u32 s68, s68, 655360
  s_add_u32 s66, s66, 1
  s_xor_b32 s64, s64, 16384
  s_xor_b32 s65, s65, 16384
  s_cmp_eq_u32 s66, 62
  s_cselect_b64 s[16:17], s[20:21], s[16:17]
  s_cselect_b32 s18, (Cf3_done - Cf3_last), s18
  s_cselect_b32 s70, 0, s70
  s_cmp_eq_u32 s66, 63
  s_cselect_b32 s59, 268435456, s59
  s_cselect_b32 s58, 268435456, s58
  s_nop 15
  s_nop 15
  s_nop 11
  buffer_load_dwordx4 v[0:3], v76, s[8:11], s60 offen offset:0 sc1
  buffer_load_dwordx4 v[4:7], v76, s[8:11], s60 offen offset:1024 sc1
  buffer_load_dwordx4 v[8:11], v76, s[8:11], s61 offen offset:0 sc1
  buffer_load_dwordx4 v[12:15], v76, s[8:11], s61 offen offset:1024 sc1
  s_waitcnt lgkmcnt(0)
  s_waitcnt vmcnt(3)
  v_mfma_f32_16x16x32_bf16 v[56:59], v[52:55], v[0:3], 0
  v_bitop3_b32 v72, v0, v2, s72 bitop3:0x7e
  s_waitcnt vmcnt(2)
  v_mfma_f32_16x16x32_bf16 v[56:59], v[52:55], v[4:7], v[56:59]
  v_bitop3_b32 v73, v4, v6, s72 bitop3:0x7e
  v_or_b32 v72, v72, v73
  s_waitcnt vmcnt(1)
  v_mfma_f32_16x16x32_bf16 v[36:39], v[52:55], v[8:11], 0
  v_bitop3_b32 v73, v8, v10, s72 bitop3:0x7e
  v_or_b32 v72, v72, v73
  s_waitcnt vmcnt(0)
  v_mfma_f32_16x16x32_bf16 v[36:39], v[52:55], v[12:15], v[36:39]
  v_bitop3_b32 v73, v12, v14, s72 bitop3:0x7e
  v_bitop3_b32 v72, v72, v73, 1 bitop3:0xa8
  v_cmp_ne_u32 vcc, 0, v72
  s_cbranch_vccnz Cf3_h1r
  buffer_load_dwordx4 v[4:7], v76, s[8:11], s65 offen offset:1024 sc1
  v_add_f32_dpp v56, v56, v56 row_ror:4 row_mask:0xf bank_mask:0xf
  v_add_f32_dpp v57, v57, v57 row_ror:4 row_mask:0xf bank_mask:0xf
  v_add_f32_dpp v36, v36, v36 row_ror:4 row_mask:0xf bank_mask:0xf
  v_add_f32_dpp v37, v37, v37 row_ror:4 row_mask:0xf bank_mask:0xf
  v_add_f32_dpp v56, v56, v56 row_ror:8 row_mask:0xf bank_mask:0xf
  v_add_f32_dpp v57, v57, v57 row_ror:8 row_mask:0xf bank_mask:0xf
  v_add_f32_dpp v36, v36, v36 row_ror:8 row_mask:0xf bank_mask:0xf
  v_add_f32_dpp v37, v37, v37 row_ror:8 row_mask:0xf bank_mask:0xf
  v_cvt_pk_bf16_f32 v56, v56, v57
  buffer_store_dword v56, v69, s[8:11], s62 offen
  v_cvt_pk_bf16_f32 v36, v36, v37
  buffer_store_dword v36, v70, s[8:11], s63 offen
  s_xor_b32 s62, s62, 16384
  buffer_store_dword v71, v69, s[8:11], s62 offen
  s_xor_b32 s63, s63, 16384
  buffer_store_dword v71, v70, s[8:11], s63 offen
  s_xor_b32 s72, s72, 1
  s_branch Cf3_h2
Cf3_h1r:
  s_mov_b64 exec, vcc
  buffer_load_dwordx4 v[0:3], v76, s[8:11], s60 offen offset:0 sc1
  buffer_load_dwordx4 v[4:7], v76, s[8:11], s60 offen offset:1024 sc1
  buffer_load_dwordx4 v[8:11], v76, s[8:11], s61 offen offset:0 sc1
  buffer_load_dwordx4 v[12:15], v76, s[8:11], s61 offen offset:1024 sc1
  s_mov_b64 exec, -1
  s_add_u32 s67, s67, 1
  s_waitcnt vmcnt(3)
  v_mfma_f32_16x16x32_bf16 v[56:59], v[52:55], v[0:3], 0
  v_bitop3_b32 v72, v0, v2, s72 bitop3:0x7e
  s_waitcnt vmcnt(2)
  v_mfma_f32_16x16x32_bf16 v[56:59], v[52:55], v[4:7], v[56:59]
  v_bitop3_b32 v73, v4, v6, s72 bitop3:0x7e
  v_or_b32 v72, v72, v73
  s_waitcnt vmcnt(1)
  v_mfma_f32_16x16x32_bf16 v[36:39], v[52:55], v[8:11], 0
  v_bitop3_b32 v73, v8, v10, s72 bitop3:0x7e
  v_or_b32 v72, v72, v73
  s_waitcnt vmcnt(0)
  v_mfma_f32_16x16x32_bf16 v[36:39], v[52:55], v[12:15], v[36:39]
  v_bitop3_b32 v73, v12, v14, s72 bitop3:0x7e
  v_bitop3_b32 v72, v72, v73, 1 bitop3:0xa8
  v_cmp_ne_u32 vcc, 0, v72
  s_cbranch_vccz Cf3_h1p
Cf3_h1s:
  s_mov_b64 exec, vcc
  buffer_load_dwordx4 v[0:3], v76, s[8:11], s60 offen offset:0 sc1
  buffer_load_dwordx4 v[4:7], v76, s[8:11], s60 offen offset:1024 sc1
  buffer_load_dwordx4 v[8:11], v76, s[8:11], s61 offen offset:0 sc1
  buffer_load_dwordx4 v[12:15], v76, s[8:11], s61 offen offset:1024 sc1
  s_mov_b64 exec, -1
  s_add_u32 s67, s67, 1
  s_waitcnt vmcnt(3)
  v_mfma_f32_16x16x32_bf16 v[56:59], v[52:55], v[0:3], 0
  v_bitop3_b32 v72, v0, v2, s72 bitop3:0x7e
  s_waitcnt vmcnt(2)
  v_mfma_f32_16x16x32_bf16 v[56:59], v[52:55], v[4:7], v[56:59]
  v_bitop3_b32 v73, v4, v6, s72 bitop3:0x7e
  v_or_b32 v72, v72, v73
  s_waitcnt vmcnt(1)
  v_mfma_f32_16x16x32_bf16 v[36:39], v[52:55], v[8:11], 0
  v_bitop3_b32 v73, v8, v10, s72 bitop3:0x7e
  v_or_b32 v72, v72, v73
  s_waitcnt vmcnt(0)
  v_mfma_f32_16x16x32_bf16 v[36:39], v[52:55], v[12:15], v[36:39]
  v_bitop3_b32 v73, v12, v14, s72 bitop3:0x7e
  v_bitop3_b32 v72, v72, v73, 1 bitop3:0xa8
  v_cmp_ne_u32 vcc, 0, v72
  s_cbranch_vccz Cf3_h1p
  s_cmp_lt_u32 s67, 131072
  s_cbranch_scc1 Cf3_h1s
Cf3_h1p:
  s_nop 2
  buffer_load_dwordx4 v[4:7], v76, s[8:11], s65 offen offset:1024 sc1
  v_add_f32_dpp v56, v56, v56 row_ror:4 row_mask:0xf bank_mask:0xf
  v_add_f32_dpp v57, v57, v57 row_ror:4 row_mask:0xf bank_mask:0xf
  v_add_f32_dpp v36, v36, v36 row_ror:4 row_mask:0xf bank_mask:0xf
  v_add_f32_dpp v37, v37, v37 row_ror:4 row_mask:0xf bank_mask:0xf
  v_add_f32_dpp v56, v56, v56 row_ror:8 row_mask:0xf bank_mask:0xf
  v_add_f32_dpp v57, v57, v57 row_ror:8 row_mask:0xf bank_mask:0xf
  v_add_f32_dpp v36, v36, v36 row_ror:8 row_mask:0xf bank_mask:0xf
  v_add_f32_dpp v37, v37, v37 row_ror:8 row_mask:0xf bank_mask:0xf
  v_cvt_pk_bf16_f32 v56, v56, v57
  buffer_store_dword v56, v69, s[8:11], s62 offen
  v_cvt_pk_bf16_f32 v36, v36, v37
  buffer_store_dword v36, v70, s[8:11], s63 offen
  s_xor_b32 s62, s62, 16384
  buffer_store_dword v71, v69, s[8:11], s62 offen
  s_xor_b32 s63, s63, 16384
  buffer_store_dword v71, v70, s[8:11], s63 offen
  s_xor_b32 s72, s72, 1
  s_branch Cf3_h2
Cf3_h2r:
  s_mov_b64 exec, vcc
  buffer_load_dwordx4 v[4:7], v76, s[8:11], s65 offen offset:1024 sc1
  s_mov_b64 exec, -1
  s_add_u32 s67, s67, 1
  s_waitcnt vmcnt(3)
  v_max3_u32 v72, v4, v5, v6
  v_max_u32 v72, v72, v7
  ds_write_b128 v76, v[4:7] offset:5632
  v_cmp_eq_u32 vcc, -1, v72
  s_cbranch_vccz Cf3_h2w
Cf3_h2s:
  s_mov_b64 exec, vcc
  buffer_load_dwordx4 v[4:7], v76, s[8:11], s65 offen offset:1024 sc1
  s_mov_b64 exec, -1
  s_add_u32 s67, s67, 1
  s_waitcnt vmcnt(1)
  v_max3_u32 v72, v4, v5, v6
  v_max_u32 v72, v72, v7
  ds_write_b128 v76, v[4:7] offset:5632
  v_cmp_eq_u32 vcc, -1, v72
  s_cbranch_vccz Cf3_h2w
  s_mov_b64 exec, vcc
  buffer_load_dwordx4 v[4:7], v76, s[8:11], s65 offen offset:1024 sc1
  s_mov_b64 exec, -1
  s_add_u32 s67, s67, 1
  s_waitcnt vmcnt(1)
  v_max3_u32 v72, v4, v5, v6
  v_max_u32 v72, v72, v7
  ds_write_b128 v76, v[4:7] offset:5632
  v_cmp_eq_u32 vcc, -1, v72
  s_cbranch_vccz Cf3_h2w
  s_mov_b64 exec, vcc
  buffer_load_dwordx4 v[4:7], v76, s[8:11], s65 offen offset:1024 sc1
  s_mov_b64 exec, -1
  s_add_u32 s67, s67, 1
  s_waitcnt vmcnt(1)
  v_max3_u32 v72, v4, v5, v6
  v_max_u32 v72, v72, v7
  ds_write_b128 v76, v[4:7] offset:5632
  v_cmp_eq_u32 vcc, -1, v72
  s_cbranch_vccz Cf3_h2w
  s_cmp_lt_u32 s67, 131072
  s_cbranch_scc1 Cf3_h2s
  s_branch Cf3_h2w
Cf3_rec:
  s_nop 7
  s_waitcnt vmcnt(0) lgkmcnt(0)
  v_max3_u32 v72, v0, v1, v2
  v_max3_u32 v72, v72, v3, v4
  v_max3_u32 v72, v72, v5, v6
  v_max3_u32 v72, v72, v7, v8
  v_max3_u32 v72, v72, v9, v10
  v_max3_u32 v72, v72, v11, v12
  v_max3_u32 v72, v72, v13, v14
  v_max3_u32 v72, v72, v15, v16
  v_max3_u32 v72, v72, v17, v18
  v_max_u32 v72, v72, v19
  v_cmp_eq_u32 vcc, -1, v72
  s_cbranch_vccz Cf3_recok
  s_barrier
Cf3_recp:
  buffer_load_dwordx4 v[0:3], v76, s[8:11], s64 offen offset:0 sc1
  buffer_load_dwordx4 v[4:7], v76, s[8:11], s64 offen offset:1024 sc1
  buffer_load_dwordx4 v[8:11], v76, s[8:11], s64 offen offset:2048 sc1
  s_add_u32 s67, s67, 1
  s_cmp_lt_u32 s67, 131072
  s_cselect_b32 s54, -2, -1
  s_waitcnt vmcnt(2)
  v_max3_u32 v72, v0, v1, v2
  s_waitcnt vmcnt(1)
  v_max3_u32 v72, v72, v3, v4
  v_max3_u32 v72, v72, v5, v6
  s_waitcnt vmcnt(0)
  v_max3_u32 v72, v72, v7, v8
  v_max3_u32 v72, v72, v9, v10
  v_max_u32 v72, v72, v11
  v_cmp_lt_u32 vcc, s54, v72
  s_cbranch_vccnz Cf3_recp
  ds_write_b128 v76, v[0:3] offset:10752
  ds_write_b128 v76, v[4:7] offset:11776
  ds_write_b128 v76, v[8:11] offset:12800
  v_mov_b64 v[20:21], 0
  v_mov_b64 v[22:23], 0
  v_mov_b64 v[24:25], 0
  v_mov_b64 v[26:27], 0
  v_mov_b64 v[28:29], 0
  v_mov_b64 v[30:31], 0
  v_mov_b64 v[32:33], 0
  v_mov_b64 v[34:35], 0
  s_waitcnt lgkmcnt(0)
  s_barrier
  ds_read_b128 v[0:3], v76 offset:4608
  s_waitcnt lgkmcnt(0)
  v_smfmac_f32_16x16x64_bf16 v[20:23], v[0:3], v[80:87], v74
  v_smfmac_f32_16x16x64_bf16 v[24:27], v[0:3], v[88:95], v74
  ds_read_b128 v[60:63], v76 offset:28672
  ds_read_b128 v[64:67], v76 offset:29696
  s_waitcnt lgkmcnt(0)
  v_smfmac_f32_16x16x64_bf16 v[28:31], v[0:3], v[60:67], v74
  ds_read_b128 v[60:63], v76 offset:30720
  ds_read_b128 v[64:67], v76 offset:31744
  s_waitcnt lgkmcnt(0)
  v_smfmac_f32_16x16x64_bf16 v[32:35], v[0:3], v[60:67], v74
  ds_read_b128 v[4:7], v76 offset:5632
  s_waitcnt lgkmcnt(0)
  v_smfmac_f32_16x16x64_bf16 v[20:23], v[4:7], v[96:103], v74
  v_smfmac_f32_16x16x64_bf16 v[24:27], v[4:7], v[104:111], v74
  ds_read_b128 v[60:63], v76 offset:45056
  ds_read_b128 v[64:67], v76 offset:46080
  s_waitcnt lgkmcnt(0)
  v_smfmac_f32_16x16x64_bf16 v[28:31], v[4:7], v[60:67], v74
  ds_read_b128 v[60:63], v76 offset:47104
  ds_read_b128 v[64:67], v76 offset:48128
  s_waitcnt lgkmcnt(0)
  v_smfmac_f32_16x16x64_bf16 v[32:35], v[4:7], v[60:67], v74
  ds_read_b128 v[8:11], v76 offset:6656
  s_waitcnt lgkmcnt(0)
  v_smfmac_f32_16x16x64_bf16 v[20:23], v[8:11], v[112:119], v74
  v_smfmac_f32_16x16x64_bf16 v[24:27], v[8:11], v[120:127], v74
  v_smfmac_f32_16x16x64_bf16 v[28:31], v[8:11], v[208:215], v74
  v_smfmac_f32_16x16x64_bf16 v[32:35], v[8:11], v[216:223], v74
  ds_read_b128 v[12:15], v76 offset:7680
  s_waitcnt lgkmcnt(0)
  v_smfmac_f32_16x16x64_bf16 v[20:23], v[12:15], v[128:135], v74
  v_smfmac_f32_16x16x64_bf16 v[24:27], v[12:15], v[136:143], v74
  v_smfmac_f32_16x16x64_bf16 v[28:31], v[12:15], v[224:231], v74
  v_smfmac_f32_16x16x64_bf16 v[32:35], v[12:15], v[232:239], v74
  ds_read_b128 v[4:7], v76 offset:8704
  s_waitcnt lgkmcnt(0)
  v_smfmac_f32_16x16x64_bf16 v[20:23], v[4:7], v[144:151], v74
  v_smfmac_f32_16x16x64_bf16 v[24:27], v[4:7], v[152:159], v74
  ds_read_b128 v[60:63], v76 offset:61440
  ds_read_b128 v[64:67], v76 offset:62464
  s_waitcnt lgkmcnt(0)
  v_smfmac_f32_16x16x64_bf16 v[28:31], v[4:7], v[60:67], v74
  ds_read_b128 v[60:63], v76 offset:63488
  ds_read_b128 v[64:67], v76 offset:64512
  s_waitcnt lgkmcnt(0)
  v_smfmac_f32_16x16x64_bf16 v[32:35], v[4:7], v[60:67], v74
  ds_read_b128 v[8:11], v76 offset:9728
  s_waitcnt lgkmcnt(0)
  v_smfmac_f32_16x16x64_bf16 v[20:23], v[8:11], v[160:167], v74
  v_smfmac_f32_16x16x64_bf16 v[24:27], v[8:11], v[168:175], v74
  ds_read_b128 v[60:63], v75 offset:28672
  ds_read_b128 v[64:67], v75 offset:29696
  s_waitcnt lgkmcnt(0)
  v_smfmac_f32_16x16x64_bf16 v[28:31], v[8:11], v[60:67], v74
  ds_read_b128 v[60:63], v75 offset:30720
  ds_read_b128 v[64:67], v75 offset:31744
  s_waitcnt lgkmcnt(0)
  v_smfmac_f32_16x16x64_bf16 v[32:35], v[8:11], v[60:67], v74
  ds_read_b128 v[16:19], v76 offset:10752
  ds_read_b128 v[60:63], v75 offset:12288
  ds_read_b128 v[64:67], v75 offset:13312
  s_waitcnt lgkmcnt(0)
  v_smfmac_f32_16x16x64_bf16 v[20:23], v[16:19], v[60:67], v74
  ds_read_b128 v[60:63], v75 offset:14336
  ds_read_b128 v[64:67], v75 offset:15360
  s_waitcnt lgkmcnt(0)
  v_smfmac_f32_16x16x64_bf16 v[24:27], v[16:19], v[60:67], v74
  v_smfmac_f32_16x16x64_bf16 v[28:31], v[16:19], v[240:247], v74
  v_smfmac_f32_16x16x64_bf16 v[32:35], v[16:19], v[248:255], v74
  ds_read_b128 v[0:3], v76 offset:11776
  s_waitcnt lgkmcnt(0)
  v_smfmac_f32_16x16x64_bf16 v[20:23], v[0:3], v[176:183], v74
  v_smfmac_f32_16x16x64_bf16 v[24:27], v[0:3], v[184:191], v74
  v_smfmac_f32_16x16x64_bf16 v[28:31], v[0:3], a[0:7], v74
  v_smfmac_f32_16x16x64_bf16 v[32:35], v[0:3], a[8:15], v74
  ds_read_b128 v[12:15], v76 offset:12800
  s_waitcnt lgkmcnt(0)
  v_smfmac_f32_16x16x64_bf16 v[20:23], v[12:15], v[192:199], v74
  v_smfmac_f32_16x16x64_bf16 v[24:27], v[12:15], v[200:207], v74
  v_smfmac_f32_16x16x64_bf16 v[28:31], v[12:15], a[16:23], v74
  v_smfmac_f32_16x16x64_bf16 v[32:35], v[12:15], a[24:31], v74
  v_add_f32 v20, v20, v22
  v_add_f32 v21, v21, v23
  v_add_f32 v24, v24, v26
  v_cvt_pk_bf16_f32 v22, v20, v24
  s_nop 0
  ds_write_b32 v79, v22 offset:0
  v_add_f32 v25, v25, v27
  v_cvt_pk_bf16_f32 v23, v21, v25
  ds_write_b32 v79, v23 offset:576
  v_add_f32 v28, v28, v30
  v_add_f32 v29, v29, v31
  s_waitcnt lgkmcnt(0)
  s_nop 1
  s_branch Cf3_recok
Cf3_mx:
  s_waitcnt lgkmcnt(0)
  s_barrier
  buffer_load_dwordx4 v[0:3], v76, s[8:11], s58 offen offset:0 sc1
  ds_read_b128 v[20:23], v77 offset:0
  ds_read_b128 v[28:31], v77 offset:256
  buffer_load_dwordx4 v[4:7], v76, s[8:11], s58 offen offset:1024 sc1
  ds_read_b128 v[24:27], v77 offset:128
  ds_read_b128 v[32:35], v77 offset:384
  s_waitcnt vmcnt(1) lgkmcnt(3)
  v_mfma_f32_16x16x32_bf16 v[8:11], v[0:3], v[20:23], 0
  s_waitcnt vmcnt(0) lgkmcnt(1)
  v_mfma_f32_16x16x32_bf16 v[8:11], v[4:7], v[24:27], v[8:11]
  v_mfma_f32_16x16x32_bf16 v[12:15], v[28:31], v[20:23], 0
  s_waitcnt lgkmcnt(0)
  v_mfma_f32_16x16x32_bf16 v[12:15], v[32:35], v[24:27], v[12:15]
  v_add_f32_dpp v8, v10, v8 quad_perm:[2,3,0,1] row_mask:0xf bank_mask:0xf
  v_add_f32_dpp v9, v11, v9 quad_perm:[2,3,0,1] row_mask:0xf bank_mask:0xf
  s_nop 0
  v_mov_b32_dpp v8, v8 quad_perm:[0,1,0,1] row_mask:0xf bank_mask:0xf
  v_mov_b32_dpp v9, v9 quad_perm:[0,1,0,1] row_mask:0xf bank_mask:0xf
  s_nop 1
  v_add_f32_dpp v12, v14, v12 quad_perm:[2,3,0,1] row_mask:0xf bank_mask:0xf
  v_add_f32_dpp v13, v15, v13 quad_perm:[2,3,0,1] row_mask:0xf bank_mask:0xf
  s_nop 0
  v_mov_b32_dpp v12, v12 quad_perm:[0,1,0,1] row_mask:0xf bank_mask:0xf
  v_mov_b32_dpp v13, v13 quad_perm:[0,1,0,1] row_mask:0xf bank_mask:0xf
  v_mul_f32 v12, s69, v12
  ds_write_b32 v78, v8 offset:8716
  v_mul_f32 v13, s69, v13
  ds_write_b32 v78, v9 offset:8780
  s_waitcnt lgkmcnt(0)
  s_barrier
  ds_read_b128 v[36:39], v78 offset:8704
  ds_read_b128 v[40:43], v78 offset:8768
  s_waitcnt lgkmcnt(0)
  s_barrier
  v_max_f32 v16, v36, v37
  v_max3_f32 v16, v16, v38, v39
  v_max3_f32 v16, v16, v40, v41
  v_max3_f32 v16, v16, v42, v43
  v_max3_f32 v16, v16, v12, v13
  v_mov_b32 v17, v16
  s_nop 1
  v_permlane16_swap_b32 v16, v17
  v_max_f32 v16, v16, v17
  v_mov_b32 v17, v16
  s_nop 1
  v_permlane32_swap_b32 v16, v17
  v_max_f32 v16, v16, v17
  v_sub_f32 v36, v36, v16
  v_sub_f32 v37, v37, v16
  v_sub_f32 v38, v38, v16
  v_sub_f32 v39, v39, v16
  v_sub_f32 v40, v40, v16
  v_sub_f32 v41, v41, v16
  v_sub_f32 v42, v42, v16
  v_sub_f32 v43, v43, v16
  v_sub_f32 v12, v12, v16
  v_sub_f32 v13, v13, v16
  v_exp_f32 v36, v36
  v_exp_f32 v37, v37
  v_exp_f32 v38, v38
  v_exp_f32 v39, v39
  v_exp_f32 v40, v40
  v_exp_f32 v41, v41
  v_exp_f32 v42, v42
  v_exp_f32 v43, v43
  v_exp_f32 v12, v12
  v_exp_f32 v13, v13
  v_cvt_pk_bf16_f32 v32, v36, v40
  v_cvt_pk_bf16_f32 v33, v37, v41
  v_cvt_pk_bf16_f32 v34, v38, v42
  v_cvt_pk_bf16_f32 v35, v39, v43
  v_cvt_pk_bf16_f32 v28, v12, v13
  v_cvt_pk_bf16_f32 v31, v12, v13
  v_mov_b32 v29, 0
  v_mov_b32 v30, 0
  v_mov_b32 v68, 0x3f803f80
  v_mov_b32 v69, 0x3f803f80
  v_mov_b32 v70, 0x3f803f80
  v_mov_b32 v71, 0x3f803f80
  s_nop 1
  v_mfma_f32_16x16x32_bf16 v[8:11], v[32:35], v[68:71], 0
  v_mfma_f32_16x16x32_bf16 v[0:3], v[32:35], v[52:55], 0
  v_mfma_f32_16x16x32_bf16 v[4:7], v[32:35], v[56:59], 0
  v_mfma_f32_16x16x16_bf16 v[8:11], v[28:29], v[68:69], v[8:11]
  v_mfma_f32_16x16x16_bf16 v[0:3], v[28:29], v[72:73], v[0:3]
  v_mfma_f32_16x16x16_bf16 v[4:7], v[30:31], v[72:73], v[4:7]
  ds_read_b128 v[68:71], v76 offset:13824
  v_rcp_f32 v10, v8
  v_rcp_f32 v11, v9
  v_mul_f32 v0, v10, v0
  v_mul_f32 v1, v11, v1
  s_nop 0
  v_mul_f32 v4, v10, v4
  v_mul_f32 v5, v11, v5
  v_cvt_pk_bf16_f32 v2, v0, v4
  ds_write_b32 v79, v2 offset:8704
  v_cvt_pk_bf16_f32 v3, v1, v5
  ds_write_b32 v79, v3 offset:9280
  v_mov_b64 v[16:17], 0
  v_mov_b64 v[18:19], 0
  v_mov_b64 v[20:21], 0
  v_mov_b64 v[22:23], 0
  v_mov_b64 v[24:25], 0
  v_mov_b64 v[26:27], 0
  s_branch Cf3_mxok
Cf3_last:
  ds_read_b128 v[0:3], v76 offset:4608
  ds_read_b128 v[12:15], v76 offset:7680
  ds_read_b128 v[44:47], v76 offset:28672
  ds_read_b128 v[48:51], v76 offset:29696
  s_nop 5
  v_mov_b64 v[20:21], 0
  v_mov_b64 v[22:23], 0
  v_mov_b64 v[24:25], 0
  v_mov_b64 v[26:27], 0
  v_smfmac_f32_16x16x64_bf16 v[28:31], v[4:7], v[36:43], v74
  ds_read_b128 v[36:39], v76 offset:30720
  ds_read_b128 v[40:43], v76 offset:31744
  v_smfmac_f32_16x16x64_bf16 v[32:35], v[4:7], v[60:67], v74
  s_waitcnt lgkmcnt(5)
  v_smfmac_f32_16x16x64_bf16 v[20:23], v[0:3], a[32:39], v74
  ds_read_b128 v[60:63], v76 offset:61440
  ds_read_b128 v[64:67], v76 offset:62464
  v_smfmac_f32_16x16x64_bf16 v[24:27], v[0:3], a[40:47], v74
  s_waitcnt lgkmcnt(4)
  v_smfmac_f32_16x16x64_bf16 v[20:23], v[4:7], a[48:55], v74
  buffer_store_dwordx4 v[16:19], v76, s[8:11], s68 offen sc1
  v_smfmac_f32_16x16x64_bf16 v[24:27], v[4:7], a[56:63], v74
  v_smfmac_f32_16x16x64_bf16 v[28:31], v[0:3], v[44:51], v74
  s_waitcnt lgkmcnt(2)
  v_smfmac_f32_16x16x64_bf16 v[20:23], v[8:11], a[64:71], v74
  ds_read_b128 v[44:47], v76 offset:63488
  ds_read_b128 v[48:51], v76 offset:64512
  v_smfmac_f32_16x16x64_bf16 v[24:27], v[8:11], a[72:79], v74
  v_smfmac_f32_16x16x64_bf16 v[32:35], v[0:3], v[36:43], v74
  v_smfmac_f32_16x16x64_bf16 v[28:31], v[8:11], v[208:215], v74
  ds_read_b128 v[36:39], v75 offset:28672
  ds_read_b128 v[40:43], v75 offset:29696
  v_smfmac_f32_16x16x64_bf16 v[32:35], v[8:11], v[216:223], v74
  v_smfmac_f32_16x16x64_bf16 v[20:23], v[12:15], a[80:87], v74
  v_smfmac_f32_16x16x64_bf16 v[24:27], v[12:15], a[88:95], v74
  v_smfmac_f32_16x16x64_bf16 v[28:31], v[12:15], v[224:231], v74
  v_smfmac_f32_16x16x64_bf16 v[32:35], v[12:15], v[232:239], v74
  s_waitcnt vmcnt(1)
  s_barrier
Cf3_lastr:
  ds_read_b128 v[4:7], v76 offset:8704
  ds_read_b128 v[8:11], v76 offset:9728
  ds_read_b128 v[16:19], v76 offset:10752
  ds_read_b128 v[0:3], v76 offset:11776
  ds_read_b128 v[12:15], v76 offset:12800
  s_waitcnt lgkmcnt(1)
  v_max3_u32 v72, v0, v1, v2
  v_max3_u32 v72, v72, v3, v4
  v_max3_u32 v72, v72, v5, v6
  v_max3_u32 v72, v72, v7, v8
  v_max3_u32 v72, v72, v9, v10
  s_waitcnt lgkmcnt(0)
  v_max3_u32 v72, v72, v11, v12
  v_max3_u32 v72, v72, v13, v14
  v_max3_u32 v72, v72, v15, v16
  v_max3_u32 v72, v72, v17, v18
  v_max_u32 v72, v72, v19
  v_cmp_eq_u32 vcc, -1, v72
  s_cbranch_vccnz Cf3_lastp
Cf3_lastg:
  v_smfmac_f32_16x16x64_bf16 v[28:31], v[4:7], v[60:67], v74
  ds_read_b128 v[60:63], v75 offset:30720
  ds_read_b128 v[64:67], v75 offset:31744
  v_smfmac_f32_16x16x64_bf16 v[32:35], v[4:7], v[44:51], v74
  v_smfmac_f32_16x16x64_bf16 v[28:31], v[8:11], v[36:43], v74
  v_smfmac_f32_16x16x64_bf16 v[28:31], v[16:19], v[240:247], v74
  v_smfmac_f32_16x16x64_bf16 v[28:31], v[0:3], a[0:7], v74
  v_smfmac_f32_16x16x64_bf16 v[28:31], v[12:15], a[16:23], v74
  v_smfmac_f32_16x16x64_bf16 v[32:35], v[16:19], v[248:255], v74
  v_smfmac_f32_16x16x64_bf16 v[32:35], v[0:3], a[8:15], v74
  s_waitcnt lgkmcnt(0)
  v_smfmac_f32_16x16x64_bf16 v[32:35], v[12:15], a[24:31], v74
  v_smfmac_f32_16x16x64_bf16 v[32:35], v[8:11], v[60:67], v74
  v_smfmac_f32_16x16x64_bf16 v[20:23], v[4:7], a[96:103], v74
  v_smfmac_f32_16x16x64_bf16 v[20:23], v[8:11], a[112:119], v74
  v_add_f32 v28, v28, v30
  v_add_f32 v32, v32, v34
  v_cvt_pk_bf16_f32 v30, v28, v32
  v_smfmac_f32_16x16x64_bf16 v[20:23], v[16:19], a[128:135], v74
  ds_write_b32 v79, v30 offset:256
  v_add_f32 v29, v29, v31
  v_add_f32 v33, v33, v35
  v_cvt_pk_bf16_f32 v31, v29, v33
  v_smfmac_f32_16x16x64_bf16 v[20:23], v[0:3], a[144:151], v74
  ds_write_b32 v79, v31 offset:832
  v_smfmac_f32_16x16x64_bf16 v[20:23], v[12:15], a[160:167], v74
  v_smfmac_f32_16x16x64_bf16 v[24:27], v[4:7], a[104:111], v74
  v_smfmac_f32_16x16x64_bf16 v[24:27], v[8:11], a[120:127], v74
  v_smfmac_f32_16x16x64_bf16 v[24:27], v[16:19], a[136:143], v74
  s_waitcnt lgkmcnt(0)
  s_barrier
  ds_read_b64 v[52:53], v77 offset:392
  v_add_f32 v20, v20, v22
  v_smfmac_f32_16x16x64_bf16 v[24:27], v[0:3], a[152:159], v74
  v_add_f32 v21, v21, v23
  v_smfmac_f32_16x16x64_bf16 v[24:27], v[12:15], a[168:175], v74
  v_cvt_pk_bf16_f32 v54, v20, v21
  s_add_u32 s68, s68, 655360
  s_nop 3
  v_add_f32 v24, v24, v26
  v_add_f32 v25, v25, v27
  v_cvt_pk_bf16_f32 v55, v24, v25
  s_waitcnt lgkmcnt(0)
  buffer_store_dwordx4 v[52:55], v76, s[8:11], s68 offen sc1
  s_branch Cf3_done
Cf3_lastp:
  s_add_u32 s72, s72, 2
  s_cmp_ge_u32 s72, 131072
  s_cbranch_scc1 Cf3_lastg
  s_barrier
  buffer_load_dwordx4 v76, s[8:11], s55 offen offset:0 sc1 lds
  buffer_load_dwordx4 v76, s[8:11], s55 offen offset:1024 sc1 lds
  s_waitcnt vmcnt(0)
  s_barrier
  s_branch Cf3_lastr
Cf3_done:
  s_branch L_cexit
L_w4:
  v_mov_b64 v[20:21], 0
  v_mov_b64 v[22:23], 0
  v_mov_b64 v[24:25], 0
  v_mov_b64 v[26:27], 0
  v_mov_b64 v[28:29], 0
  v_mov_b64 v[30:31], 0
  v_mov_b64 v[32:33], 0
  v_mov_b64 v[34:35], 0
  s_mov_b32 s78, 0x3f803f80
  s_mov_b32 s79, s78
  s_mov_b32 s65, 360448
  s_mov_b32 m0, 16128
  s_lshl_b32 s71, s53, 2
  s_add_u32 s71, s71, 128
  s_movk_i32 s56, 0x1000
  v_lshlrev_b32 v73, 2, v76
  v_mov_b32 v72, 0
  s_mov_b64 s[16:17], s[8:9]
  s_mov_b32 s18, 268435456
  s_mov_b32 s19, 0x20000
  s_getpc_b64 s[20:21]
Cs0_pc:
  s_add_u32 s20, s20, (Cs0_last - Cs0_pc)
  s_addc_u32 s21, s21, 0
  v_mov_b32 v68, 14880
  buffer_load_dwordx4 v[52:55], v76, s[8:11], s59 offen offset:0 sc1
  buffer_load_dwordx4 v[56:59], v76, s[8:11], s59 offen offset:1024 sc1
  ds_read_b128 v[36:39], v76 offset:16384
  ds_read_b128 v[40:43], v76 offset:17408
  ds_read_b128 v[60:63], v76 offset:18432
  ds_read_b128 v[64:67], v76 offset:19456
  ds_read_b128 v[0:3], v76 offset:4608
  ds_read_b128 v[4:7], v76 offset:5632
  ds_read_b128 v[8:11], v76 offset:6656
  ds_read_b128 v[12:15], v76 offset:7680
  s_waitcnt lgkmcnt(0)
  s_cmp_eq_u32 s66, 1
  s_branch Cs0_top2
.p2align 6
Cs0_h2:
  v_lshlrev_b32 v73, 2, v76
  s_mov_b32 m0, 10752
  s_add_u32 s55, s65, 6144
  s_cmp_eq_u32 s66, 12
  s_cselect_b32 s56, s71, 0x1000
  ds_read_b32 v72, v76 offset:16128
  s_cmp_eq_u32 s66, 13
  s_cselect_b32 s54, 0x700, 0
  s_waitcnt lgkmcnt(0)
  v_readfirstlane_b32 s57, v72
  s_nop 0
  s_cmp_lt_u32 s57, s54
  s_cbranch_scc1 Cs0_kv3
Cs0_kvb:
  s_nop 1
  buffer_load_dwordx4 v[0:3], v76, s[8:11], s65 offen offset:0 sc1
  s_nop 15
  s_nop 3
  buffer_load_dwordx4 v[0:3], v76, s[8:11], s65 offen offset:0 sc1
  s_nop 15
  s_nop 3
  buffer_load_dwordx4 v[0:3], v76, s[8:11], s65 offen offset:0 sc1
  s_waitcnt vmcnt(5)
  ds_read_b128 v[36:39], v76 offset:16384
  ds_read_b128 v[40:43], v76 offset:17408
  ds_read_b128 v[60:63], v76 offset:18432
  ds_read_b128 v[64:67], v76 offset:19456
  buffer_load_dwordx4 v[52:55], v76, s[8:11], s59 offen offset:0 sc1
  buffer_load_dwordx4 v[56:59], v76, s[8:11], s59 offen offset:1024 sc1
  s_waitcnt vmcnt(4)
  v_max3_u32 v72, v0, v1, v2
  v_max_u32 v72, v72, v3
  ds_write_b128 v76, v[0:3] offset:4608
  v_cmp_eq_u32 vcc, -1, v72
  s_cbranch_vccnz Cs0_h2r
Cs0_h2w:
  s_cmp_eq_u32 s66, 63
  s_waitcnt lgkmcnt(0)
  s_barrier
  ds_read_b128 v[8:11], v76 offset:6656
  buffer_load_dwordx4 v76, s[8:11], s55 offen offset:0 sc1 lds
Cs0_top2:
  v_smfmac_f32_16x16x64_bf16 v[20:23], v[0:3], v[80:87], v74
  s_cbranch_scc1 Cs0_last
  v_smfmac_f32_16x16x64_bf16 v[28:31], v[0:3], v[36:43], v74
  buffer_load_dwordx4 v[44:47], v76, s[8:11], s58 offen offset:0 sc1
  s_mov_b32 m0, 16128
  v_smfmac_f32_16x16x64_bf16 v[24:27], v[0:3], v[88:95], v74
  buffer_load_dwordx4 v[48:51], v76, s[8:11], s58 offen offset:1024 sc1
  v_smfmac_f32_16x16x64_bf16 v[32:35], v[0:3], v[60:67], v74
  ds_read_b128 v[4:7], v76 offset:5632
  s_waitcnt lgkmcnt(1)
  v_smfmac_f32_16x16x64_bf16 v[20:23], v[8:11], v[112:119], v74
  ds_read_b128 v[12:15], v76 offset:7680
  v_smfmac_f32_16x16x64_bf16 v[24:27], v[8:11], v[120:127], v74
  ds_read_b128 v[36:39], v76 offset:32768
  v_smfmac_f32_16x16x64_bf16 v[28:31], v[8:11], v[208:215], v74
  buffer_store_dwordx4 v[16:19], v76, s[8:11], s68 offen sc1
  ds_read_b128 v[40:43], v76 offset:33792
  v_smfmac_f32_16x16x64_bf16 v[32:35], v[8:11], v[216:223], v74
  ds_read_b128 v[60:63], v76 offset:34816
  s_waitcnt lgkmcnt(4)
  v_smfmac_f32_16x16x64_bf16 v[20:23], v[4:7], v[96:103], v74
  ds_read_b128 v[64:67], v76 offset:35840
  v_smfmac_f32_16x16x64_bf16 v[24:27], v[4:7], v[104:111], v74
  buffer_load_dword v73, s[16:19], s70 offen lds
  s_waitcnt vmcnt(5)
  s_waitcnt lgkmcnt(4)
  v_smfmac_f32_16x16x64_bf16 v[20:23], v[12:15], v[128:135], v74
  s_barrier
  s_waitcnt lgkmcnt(2)
  v_smfmac_f32_16x16x64_bf16 v[28:31], v[4:7], v[36:43], v74
  ds_read_b128 v[0:3], v76 offset:8704
  v_smfmac_f32_16x16x64_bf16 v[24:27], v[12:15], v[136:143], v74
  ds_read_b128 v[36:39], v76 offset:49152
  s_waitcnt lgkmcnt(2)
  v_smfmac_f32_16x16x64_bf16 v[32:35], v[4:7], v[60:67], v74
  ds_read_b128 v[40:43], v76 offset:50176
  v_smfmac_f32_16x16x64_bf16 v[28:31], v[12:15], v[224:231], v74
  ds_read_b128 v[60:63], v76 offset:51200
  v_smfmac_f32_16x16x64_bf16 v[32:35], v[12:15], v[232:239], v74
  ds_read_b128 v[64:67], v76 offset:52224
  s_waitcnt lgkmcnt(4)
  v_smfmac_f32_16x16x64_bf16 v[20:23], v[0:3], v[144:151], v74
  s_waitcnt vmcnt(4)
  ds_read_b128 v[8:11], v76 offset:9728
  s_waitcnt lgkmcnt(3)
  v_smfmac_f32_16x16x64_bf16 v[28:31], v[0:3], v[36:43], v74
  s_barrier
  ds_read_b128 v[4:7], v76 offset:11776
  v_smfmac_f32_16x16x64_bf16 v[24:27], v[0:3], v[152:159], v74
  ds_read_b128 v[36:39], v75 offset:0
  ds_read_b128 v[40:43], v75 offset:1024
  s_waitcnt lgkmcnt(4)
  v_smfmac_f32_16x16x64_bf16 v[32:35], v[0:3], v[60:67], v74
  ds_read_b128 v[16:19], v76 offset:10752
  s_waitcnt lgkmcnt(4)
  v_smfmac_f32_16x16x64_bf16 v[20:23], v[8:11], v[160:167], v74
  ds_read_b128 v[12:15], v76 offset:12800
  v_smfmac_f32_16x16x64_bf16 v[24:27], v[8:11], v[168:175], v74
  ds_read_b128 v[60:63], v75 offset:2048
  ds_read_b128 v[64:67], v75 offset:3072
  s_waitcnt lgkmcnt(6)
  v_smfmac_f32_16x16x64_bf16 v[20:23], v[4:7], v[176:183], v74
  s_waitcnt lgkmcnt(3)
  v_smfmac_f32_16x16x64_bf16 v[20:23], v[16:19], v[36:43], v74
  ds_read_b128 v[36:39], v75 offset:16384
  s_waitcnt lgkmcnt(3)
  v_smfmac_f32_16x16x64_bf16 v[20:23], v[12:15], v[192:199], v74
  ds_read_b128 v[40:43], v75 offset:17408
  s_waitcnt lgkmcnt(2)
  v_smfmac_f32_16x16x64_bf16 v[24:27], v[16:19], v[60:67], v74
  ds_read_b128 v[60:63], v75 offset:18432
  v_smfmac_f32_16x16x64_bf16 v[24:27], v[4:7], v[184:191], v74
  ds_read_b128 v[64:67], v75 offset:19456
  v_add_f32 v20, v20, v22
  v_smfmac_f32_16x16x64_bf16 v[24:27], v[12:15], v[200:207], v74
  buffer_load_dword off, s[12:15], s56 sc1 lds
  v_add_f32 v21, v21, v23
  v_smfmac_f32_16x16x64_bf16 v[28:31], v[16:19], v[240:247], v74
  s_waitcnt lgkmcnt(2)
  v_mov_b64 v[70:71], s[78:79]
  v_smfmac_f32_16x16x64_bf16 v[28:31], v[8:11], v[36:43], v74
  ds_read_b128 v[36:39], v68
  v_add_f32 v24, v24, v26
  v_smfmac_f32_16x16x64_bf16 v[28:31], v[4:7], a[0:7], v74
  ds_read_b128 v[40:43], v68
  v_cvt_pk_bf16_f32 v22, v20, v24
  v_smfmac_f32_16x16x64_bf16 v[28:31], v[12:15], a[16:23], v74
  ds_write_b32 v79, v22 offset:0
  s_waitcnt lgkmcnt(3)
  v_add_f32 v25, v25, v27
  v_cvt_pk_bf16_f32 v23, v21, v25
  v_smfmac_f32_16x16x64_bf16 v[32:35], v[8:11], v[60:67], v74
  ds_write_b32 v79, v23 offset:576
  v_cmp_u_f32 vcc, v20, v21
  v_smfmac_f32_16x16x64_bf16 v[32:35], v[16:19], v[248:255], v74
  v_add_f32 v28, v28, v30
  v_smfmac_f32_16x16x64_bf16 v[32:35], v[4:7], a[8:15], v74
  v_add_f32 v29, v29, v31
  v_smfmac_f32_16x16x64_bf16 v[32:35], v[12:15], a[24:31], v74
  s_cbranch_vccnz Cs0_rec
Cs0_recok:
  s_waitcnt lgkmcnt(3)
  v_smfmac_f32_16x16x64_bf16 v[36:39], v[16:19], a[128:135], v74
  s_waitcnt lgkmcnt(0)
  s_barrier
  ds_read_b128 v[60:63], v77
  v_smfmac_f32_16x16x64_bf16 v[40:43], v[16:19], a[136:143], v74
  ds_read_b128 v[64:67], v77 offset:128
  v_add_f32 v32, v32, v34
  v_cvt_pk_bf16_f32 v30, v28, v32
  v_smfmac_f32_16x16x64_bf16 v[36:39], v[0:3], a[96:103], v74
  ds_write_b32 v79, v30 offset:256
  v_add_f32 v33, v33, v35
  v_cvt_pk_bf16_f32 v31, v29, v33
  v_smfmac_f32_16x16x64_bf16 v[40:43], v[0:3], a[104:111], v74
  ds_write_b32 v79, v31 offset:832
  v_xor_b32 v75, 0x8000, v75
  v_smfmac_f32_16x16x64_bf16 v[36:39], v[4:7], a[144:151], v74
  ds_read_b128 v[0:3], v76 offset:4608
  v_mov_b32 v29, 0
  v_smfmac_f32_16x16x64_bf16 v[40:43], v[4:7], a[152:159], v74
  s_waitcnt vmcnt(3) lgkmcnt(3)
  v_mov_b32 v30, 0
  v_mfma_f32_16x16x32_bf16 v[44:47], v[44:47], v[60:63], 0
  ds_read_b128 v[4:7], v76 offset:5632
  s_waitcnt lgkmcnt(2)
  v_mfma_f32_16x16x32_bf16 v[44:47], v[48:51], v[64:67], v[44:47]
  s_barrier
  v_smfmac_f32_16x16x64_bf16 v[36:39], v[8:11], a[112:119], v74
  ds_read_b128 v[20:23], v77 offset:256
  ds_read_b128 v[24:27], v77 offset:384
  v_smfmac_f32_16x16x64_bf16 v[40:43], v[8:11], a[120:127], v74
  ds_read_b128 v[8:11], v76 offset:6656
  v_add_f32_dpp v72, v46, v44 quad_perm:[2,3,0,1] row_mask:0xf bank_mask:0xf
  v_add_f32_dpp v73, v47, v45 quad_perm:[2,3,0,1] row_mask:0xf bank_mask:0xf
  v_smfmac_f32_16x16x64_bf16 v[36:39], v[12:15], a[160:167], v74
  s_waitcnt lgkmcnt(4)
  v_exp_f32_dpp v72, v72 quad_perm:[0,1,0,1] row_mask:0xf bank_mask:0xf
  v_smfmac_f32_16x16x64_bf16 v[40:43], v[12:15], a[168:175], v74
  ds_read_b128 v[12:15], v76 offset:7680
  v_exp_f32_dpp v73, v73 quad_perm:[0,1,0,1] row_mask:0xf bank_mask:0xf
  v_smfmac_f32_16x16x64_bf16 v[36:39], v[0:3], a[32:39], v74
  s_waitcnt lgkmcnt(2)
  v_cvt_pk_bf16_f32 v72, v72, v73
  v_mfma_f32_16x16x32_bf16 v[20:23], v[20:23], v[60:63], 0
  ds_write_b32 v78, v72 offset:512
  v_mov_b64 v[16:17], 0
  v_mfma_f32_16x16x32_bf16 v[20:23], v[24:27], v[64:67], v[20:23]
  ds_read_b128 v[44:47], v75 offset:16384
  v_mov_b64 v[18:19], 0
  v_smfmac_f32_16x16x64_bf16 v[40:43], v[0:3], a[40:47], v74
  ds_read_b128 v[48:51], v75 offset:17408
  v_mov_b64 v[68:69], s[78:79]
  v_smfmac_f32_16x16x64_bf16 v[36:39], v[4:7], a[48:55], v74
  s_waitcnt lgkmcnt(4)
  v_add_f32_dpp v24, v22, v20 quad_perm:[2,3,0,1] row_mask:0xf bank_mask:0xf
  v_add_f32_dpp v25, v23, v21 quad_perm:[2,3,0,1] row_mask:0xf bank_mask:0xf
  v_smfmac_f32_16x16x64_bf16 v[36:39], v[8:11], a[64:71], v74
  s_waitcnt lgkmcnt(2)
  s_barrier
  ds_read_b128 v[32:35], v78 offset:512
  v_smfmac_f32_16x16x64_bf16 v[36:39], v[12:15], a[80:87], v74
  ds_read_b128 v[60:63], v75 offset:18432
  v_mul_f32 v24, s69, v24
  v_smfmac_f32_16x16x64_bf16 v[40:43], v[4:7], a[56:63], v74
  ds_read_b128 v[64:67], v75 offset:19456
  v_mul_f32 v25, s69, v25
  v_smfmac_f32_16x16x64_bf16 v[40:43], v[8:11], a[72:79], v74
  v_exp_f32_dpp v24, v24 quad_perm:[0,1,0,1] row_mask:0xf bank_mask:0xf
  v_smfmac_f32_16x16x64_bf16 v[40:43], v[12:15], a[88:95], v74
  s_waitcnt lgkmcnt(2)
  v_exp_f32_dpp v25, v25 quad_perm:[0,1,0,1] row_mask:0xf bank_mask:0xf
  v_mfma_f32_16x16x32_bf16 v[8:11], v[32:35], v[68:71], 0
  v_add_f32 v36, v36, v38
  v_add_f32 v37, v37, v39
  v_mfma_f32_16x16x32_bf16 v[0:3], v[32:35], v[52:55], 0
  v_add_f32 v40, v40, v42
  v_add_f32 v41, v41, v43
  v_mfma_f32_16x16x32_bf16 v[4:7], v[32:35], v[56:59], 0
  v_cvt_pk_bf16_f32 v28, v24, v25
  v_cvt_pk_bf16_f32 v72, v36, v37
  v_cvt_pk_bf16_f32 v73, v40, v41
  v_mfma_f32_16x16x16_bf16 v[8:11], v[28:29], v[68:69], v[8:11]
  v_cvt_pk_bf16_f32 v31, v24, v25
  v_mov_b64 v[20:21], 0
  v_mfma_f32_16x16x16_bf16 v[0:3], v[28:29], v[72:73], v[0:3]
  ds_read_b128 v[68:71], v76 offset:13824
  v_mov_b64 v[22:23], 0
  v_mfma_f32_16x16x16_bf16 v[4:7], v[30:31], v[72:73], v[4:7]
  v_rcp_f32 v10, v8
  v_rcp_f32 v11, v9
  v_mul_f32 v0, v10, v0
  v_mul_f32 v1, v11, v1
  s_nop 0
  v_mul_f32 v4, v10, v4
  v_mul_f32 v5, v11, v5
  v_cvt_pk_bf16_f32 v2, v0, v4
  ds_write_b32 v79, v2 offset:8704
  v_cvt_pk_bf16_f32 v3, v1, v5
  ds_write_b32 v79, v3 offset:9280
  v_max3_f32 v8, v8, v9, v10
  v_max_f32 v8, v8, v11
  v_cmp_le_f32 vcc, 1317011456, v8
  v_mov_b64 v[24:25], 0
  v_mov_b64 v[26:27], 0
  s_cbranch_vccnz Cs0_mx
Cs0_mxok:
  s_waitcnt lgkmcnt(0)
  s_barrier
  ds_read_b128 v[0:3], v78 offset:8704
  ds_read_b128 v[4:7], v78 offset:8768
  ds_read_b128 v[8:11], v78 offset:8832
  ds_read_b128 v[12:15], v78 offset:8896
  s_waitcnt lgkmcnt(3)
  v_smfmac_f32_16x16x64_bf16 v[16:19], v[0:3], v[44:51], v74
  ds_read_b128 v[52:55], v75 offset:32768
  s_waitcnt lgkmcnt(3)
  v_smfmac_f32_16x16x64_bf16 v[16:19], v[4:7], v[60:67], v74
  ds_read_b128 v[56:59], v75 offset:33792
  s_waitcnt lgkmcnt(3)
  v_smfmac_f32_16x16x64_bf16 v[16:19], v[8:11], a[176:183], v74
  ds_read_b128 v[36:39], v75 offset:34816
  s_waitcnt lgkmcnt(3)
  v_smfmac_f32_16x16x64_bf16 v[16:19], v[12:15], a[184:191], v74
  ds_read_b128 v[40:43], v75 offset:35840
  ds_read_b128 v[44:47], v75 offset:49152
  v_smfmac_f32_16x16x64_bf16 v[20:23], v[0:3], a[192:199], v74
  ds_read_b128 v[48:51], v75 offset:50176
  ds_read_b128 v[60:63], v75 offset:51200
  v_smfmac_f32_16x16x64_bf16 v[20:23], v[4:7], a[200:207], v74
  ds_read_b128 v[64:67], v75 offset:52224
  s_waitcnt lgkmcnt(6)
  v_cvt_pk_bf16_f32 v16, v16, v17
  v_cvt_pk_bf16_f32 v17, v18, v19
  v_bfi_b32 v16, 1, s72, v16
  v_smfmac_f32_16x16x64_bf16 v[20:23], v[8:11], v[52:59], v74
  buffer_store_dwordx2 v[16:17], v68, s[8:11], s73 offen sc1
  s_waitcnt lgkmcnt(4)
  v_smfmac_f32_16x16x64_bf16 v[20:23], v[12:15], v[36:43], v74
  v_mov_b64 v[32:33], 0
  v_smfmac_f32_16x16x64_bf16 v[24:27], v[0:3], a[208:215], v74
  v_mov_b64 v[34:35], 0
  v_smfmac_f32_16x16x64_bf16 v[24:27], v[4:7], a[216:223], v74
  s_waitcnt lgkmcnt(2)
  v_cvt_pk_bf16_f32 v20, v20, v21
  v_cvt_pk_bf16_f32 v21, v22, v23
  v_bfi_b32 v20, 1, s72, v20
  v_smfmac_f32_16x16x64_bf16 v[24:27], v[8:11], v[44:51], v74
  buffer_store_dwordx2 v[20:21], v68, s[8:11], s74 offen sc1
  s_waitcnt lgkmcnt(0)
  v_smfmac_f32_16x16x64_bf16 v[24:27], v[12:15], v[60:67], v74
  v_smfmac_f32_16x16x64_bf16 v[32:35], v[0:3], a[224:231], v74
  v_smfmac_f32_16x16x64_bf16 v[32:35], v[4:7], a[232:239], v74
  v_cvt_pk_bf16_f32 v24, v24, v25
  v_cvt_pk_bf16_f32 v25, v26, v27
  v_bfi_b32 v24, 1, s72, v24
  v_smfmac_f32_16x16x64_bf16 v[32:35], v[8:11], a[240:247], v74
  s_nop 1
  buffer_store_dwordx2 v[24:25], v68, s[8:11], s75 offen sc1
  v_smfmac_f32_16x16x64_bf16 v[32:35], v[12:15], a[248:255], v74
  ds_read_b128 v[0:3], v76 offset:14848
  ds_read_b64 v[16:17], v77 offset:256
  v_mov_b64 v[18:19], v[72:73]
  v_xor_b32 v75, 0x8000, v75
  s_nop 3
  v_cvt_pk_bf16_f32 v32, v32, v33
  v_cvt_pk_bf16_f32 v33, v34, v35
  v_bfi_b32 v32, 1, s72, v32
  buffer_store_dwordx2 v[32:33], v68, s[8:11], s76 offen sc1
  v_mov_b64 v[20:21], 0
  v_mov_b64 v[22:23], 0
  v_mov_b64 v[24:25], 0
  v_mov_b64 v[26:27], 0
  v_mov_b64 v[28:29], 0
  v_mov_b64 v[30:31], 0
  v_mov_b64 v[32:33], 0
  v_mov_b64 v[34:35], 0
  v_mov_b32 v68, 14880
  s_add_u32 s58, s58, 655360
  s_add_u32 s59, s59, 655360
  s_add_u32 s70, s70, 655360
  s_add_u32 s68, s68, 655360
  s_add_u32 s66, s66, 1
  s_xor_b32 s64, s64, 16384
  s_xor_b32 s65, s65, 16384
  s_cmp_eq_u32 s66, 62
  s_cselect_b64 s[16:17], s[20:21], s[16:17]
  s_cselect_b32 s18, (Cs0_done - Cs0_last), s18
  s_cselect_b32 s70, 0, s70
  s_cmp_eq_u32 s66, 63
  s_cselect_b32 s59, 268435456, s59
  s_cselect_b32 s58, 268435456, s58
  s_nop 13
  buffer_load_dwordx4 v[52:55], v76, s[8:11], s60 offen offset:0 sc1
  buffer_load_dwordx4 v[56:59], v76, s[8:11], s60 offen offset:1024 sc1
  s_waitcnt lgkmcnt(0)
  s_waitcnt vmcnt(1)
  v_mfma_f32_16x16x32_bf16 v[4:7], v[0:3], v[52:55], 0
  v_bitop3_b32 v72, v52, v54, s72 bitop3:0x7e
  s_waitcnt vmcnt(0)
  v_mfma_f32_16x16x32_bf16 v[4:7], v[0:3], v[56:59], v[4:7]
  v_bitop3_b32 v73, v56, v58, s72 bitop3:0x7e
  v_bitop3_b32 v72, v72, v73, 1 bitop3:0xa8
  v_cmp_ne_u32 vcc, 0, v72
  s_nop 0
  s_cmp_eq_u64 vcc, 0
  s_cselect_b32 s54, s62, 268435456
  s_nop 0
  v_add_f32_dpp v4, v4, v4 row_ror:4 row_mask:0xf bank_mask:0xf
  v_add_f32_dpp v5, v5, v5 row_ror:4 row_mask:0xf bank_mask:0xf
  s_nop 0
  v_add_f32_dpp v4, v4, v4 row_ror:8 row_mask:0xf bank_mask:0xf
  v_add_f32_dpp v5, v5, v5 row_ror:8 row_mask:0xf bank_mask:0xf
  v_cvt_pk_bf16_f32 v4, v4, v5
  buffer_store_dword v4, v69, s[8:11], s54 offen sc1
  s_cbranch_vccnz Cs0_h1r
  s_xor_b32 s62, s62, 16384
  buffer_store_dword v71, v69, s[8:11], s62 offen sc1
  s_xor_b32 s72, s72, 1
  s_branch Cs0_h2
Cs0_h1r:
  s_mov_b64 exec, vcc
  buffer_load_dwordx4 v[52:55], v76, s[8:11], s60 offen offset:0 sc1
  buffer_load_dwordx4 v[56:59], v76, s[8:11], s60 offen offset:1024 sc1
  s_mov_b64 exec, -1
  s_add_u32 s67, s67, 1
  s_waitcnt vmcnt(1)
  v_mfma_f32_16x16x32_bf16 v[4:7], v[0:3], v[52:55], 0
  v_bitop3_b32 v72, v52, v54, s72 bitop3:0x7e
  s_waitcnt vmcnt(0)
  v_mfma_f32_16x16x32_bf16 v[4:7], v[0:3], v[56:59], v[4:7]
  v_bitop3_b32 v73, v56, v58, s72 bitop3:0x7e
  v_bitop3_b32 v72, v72, v73, 1 bitop3:0xa8
  v_cmp_ne_u32 vcc, 0, v72
  s_cbranch_vccz Cs0_h1p
Cs0_h1s:
  s_mov_b64 exec, vcc
  buffer_load_dwordx4 v[52:55], v76, s[8:11], s60 offen offset:0 sc1
  buffer_load_dwordx4 v[56:59], v76, s[8:11], s60 offen offset:1024 sc1
  s_mov_b64 exec, -1
  s_add_u32 s67, s67, 1
  s_waitcnt vmcnt(1)
  v_mfma_f32_16x16x32_bf16 v[4:7], v[0:3], v[52:55], 0
  v_bitop3_b32 v72, v52, v54, s72 bitop3:0x7e
  s_waitcnt vmcnt(0)
  v_mfma_f32_16x16x32_bf16 v[4:7], v[0:3], v[56:59], v[4:7]
  v_bitop3_b32 v73, v56, v58, s72 bitop3:0x7e
  v_bitop3_b32 v72, v72, v73, 1 bitop3:0xa8
  v_cmp_ne_u32 vcc, 0, v72
  s_cbranch_vccz Cs0_h1p
  s_cmp_lt_u32 s67, 131072
  s_cbranch_scc1 Cs0_h1s
Cs0_h1p:
  s_nop 2
  v_add_f32_dpp v4, v4, v4 row_ror:4 row_mask:0xf bank_mask:0xf
  v_add_f32_dpp v5, v5, v5 row_ror:4 row_mask:0xf bank_mask:0xf
  s_nop 0
  v_add_f32_dpp v4, v4, v4 row_ror:8 row_mask:0xf bank_mask:0xf
  v_add_f32_dpp v5, v5, v5 row_ror:8 row_mask:0xf bank_mask:0xf
  v_cvt_pk_bf16_f32 v4, v4, v5
  buffer_store_dword v4, v69, s[8:11], s62 offen sc1
  s_xor_b32 s62, s62, 16384
  buffer_store_dword v71, v69, s[8:11], s62 offen sc1
  s_xor_b32 s72, s72, 1
  s_branch Cs0_h2
Cs0_h2r:
  s_mov_b64 exec, vcc
  buffer_load_dwordx4 v[0:3], v76, s[8:11], s65 offen offset:0 sc1
  s_mov_b64 exec, -1
  s_add_u32 s67, s67, 1
  s_waitcnt vmcnt(4)
  v_max3_u32 v72, v0, v1, v2
  v_max_u32 v72, v72, v3
  ds_write_b128 v76, v[0:3] offset:4608
  v_cmp_eq_u32 vcc, -1, v72
  s_cbranch_vccz Cs0_h2w
  s_mov_b64 exec, vcc
  buffer_load_dwordx4 v[0:3], v76, s[8:11], s65 offen offset:0 sc1
  s_mov_b64 exec, -1
  s_add_u32 s67, s67, 1
  s_waitcnt vmcnt(4)
  v_max3_u32 v72, v0, v1, v2
  v_max_u32 v72, v72, v3
  ds_write_b128 v76, v[0:3] offset:4608
  v_cmp_eq_u32 vcc, -1, v72
  s_cbranch_vccz Cs0_h2w
Cs0_h2s:
  s_mov_b64 exec, vcc
  buffer_load_dwordx4 v[0:3], v76, s[8:11], s65 offen offset:0 sc1
  s_mov_b64 exec, -1
  s_add_u32 s67, s67, 1
  s_waitcnt vmcnt(2)
  v_max3_u32 v72, v0, v1, v2
  v_max_u32 v72, v72, v3
  ds_write_b128 v76, v[0:3] offset:4608
  v_cmp_eq_u32 vcc, -1, v72
  s_cbranch_vccz Cs0_h2w
  s_mov_b64 exec, vcc
  buffer_load_dwordx4 v[0:3], v76, s[8:11], s65 offen offset:0 sc1
  s_mov_b64 exec, -1
  s_add_u32 s67, s67, 1
  s_waitcnt vmcnt(2)
  v_max3_u32 v72, v0, v1, v2
  v_max_u32 v72, v72, v3
  ds_write_b128 v76, v[0:3] offset:4608
  v_cmp_eq_u32 vcc, -1, v72
  s_cbranch_vccz Cs0_h2w
  s_mov_b64 exec, vcc
  buffer_load_dwordx4 v[0:3], v76, s[8:11], s65 offen offset:0 sc1
  s_mov_b64 exec, -1
  s_add_u32 s67, s67, 1
  s_waitcnt vmcnt(2)
  v_max3_u32 v72, v0, v1, v2
  v_max_u32 v72, v72, v3
  ds_write_b128 v76, v[0:3] offset:4608
  v_cmp_eq_u32 vcc, -1, v72
  s_cbranch_vccz Cs0_h2w
  s_cmp_lt_u32 s67, 131072
  s_cbranch_scc1 Cs0_h2s
  s_branch Cs0_h2w
Cs0_rec:
  s_nop 7
  s_waitcnt vmcnt(0) lgkmcnt(0)
  v_max3_u32 v72, v0, v1, v2
  v_max3_u32 v72, v72, v3, v4
  v_max3_u32 v72, v72, v5, v6
  v_max3_u32 v72, v72, v7, v8
  v_max3_u32 v72, v72, v9, v10
  v_max3_u32 v72, v72, v11, v12
  v_max3_u32 v72, v72, v13, v14
  v_max3_u32 v72, v72, v15, v16
  v_max3_u32 v72, v72, v17, v18
  v_max_u32 v72, v72, v19
  v_cmp_eq_u32 vcc, -1, v72
  s_cbranch_vccz Cs0_recok
  s_barrier
  v_mov_b64 v[20:21], 0
  v_mov_b64 v[22:23], 0
  v_mov_b64 v[24:25], 0
  v_mov_b64 v[26:27], 0
  v_mov_b64 v[28:29], 0
  v_mov_b64 v[30:31], 0
  v_mov_b64 v[32:33], 0
  v_mov_b64 v[34:35], 0
  s_waitcnt lgkmcnt(0)
  s_barrier
  ds_read_b128 v[0:3], v76 offset:4608
  s_waitcnt lgkmcnt(0)
  v_smfmac_f32_16x16x64_bf16 v[20:23], v[0:3], v[80:87], v74
  v_smfmac_f32_16x16x64_bf16 v[24:27], v[0:3], v[88:95], v74
  ds_read_b128 v[60:63], v76 offset:16384
  ds_read_b128 v[64:67], v76 offset:17408
  s_waitcnt lgkmcnt(0)
  v_smfmac_f32_16x16x64_bf16 v[28:31], v[0:3], v[60:67], v74
  ds_read_b128 v[60:63], v76 offset:18432
  ds_read_b128 v[64:67], v76 offset:19456
  s_waitcnt lgkmcnt(0)
  v_smfmac_f32_16x16x64_bf16 v[32:35], v[0:3], v[60:67], v74
  ds_read_b128 v[4:7], v76 offset:5632
  s_waitcnt lgkmcnt(0)
  v_smfmac_f32_16x16x64_bf16 v[20:23], v[4:7], v[96:103], v74
  v_smfmac_f32_16x16x64_bf16 v[24:27], v[4:7], v[104:111], v74
  ds_read_b128 v[60:63], v76 offset:32768
  ds_read_b128 v[64:67], v76 offset:33792
  s_waitcnt lgkmcnt(0)
  v_smfmac_f32_16x16x64_bf16 v[28:31], v[4:7], v[60:67], v74
  ds_read_b128 v[60:63], v76 offset:34816
  ds_read_b128 v[64:67], v76 offset:35840
  s_waitcnt lgkmcnt(0)
  v_smfmac_f32_16x16x64_bf16 v[32:35], v[4:7], v[60:67], v74
  ds_read_b128 v[8:11], v76 offset:6656
  s_waitcnt lgkmcnt(0)
  v_smfmac_f32_16x16x64_bf16 v[20:23], v[8:11], v[112:119], v74
  v_smfmac_f32_16x16x64_bf16 v[24:27], v[8:11], v[120:127], v74
  v_smfmac_f32_16x16x64_bf16 v[28:31], v[8:11], v[208:215], v74
  v_smfmac_f32_16x16x64_bf16 v[32:35], v[8:11], v[216:223], v74
  ds_read_b128 v[12:15], v76 offset:7680
  s_waitcnt lgkmcnt(0)
  v_smfmac_f32_16x16x64_bf16 v[20:23], v[12:15], v[128:135], v74
  v_smfmac_f32_16x16x64_bf16 v[24:27], v[12:15], v[136:143], v74
  v_smfmac_f32_16x16x64_bf16 v[28:31], v[12:15], v[224:231], v74
  v_smfmac_f32_16x16x64_bf16 v[32:35], v[12:15], v[232:239], v74
  ds_read_b128 v[0:3], v76 offset:8704
  s_waitcnt lgkmcnt(0)
  v_smfmac_f32_16x16x64_bf16 v[20:23], v[0:3], v[144:151], v74
  v_smfmac_f32_16x16x64_bf16 v[24:27], v[0:3], v[152:159], v74
  ds_read_b128 v[60:63], v76 offset:49152
  ds_read_b128 v[64:67], v76 offset:50176
  s_waitcnt lgkmcnt(0)
  v_smfmac_f32_16x16x64_bf16 v[28:31], v[0:3], v[60:67], v74
  ds_read_b128 v[60:63], v76 offset:51200
  ds_read_b128 v[64:67], v76 offset:52224
  s_waitcnt lgkmcnt(0)
  v_smfmac_f32_16x16x64_bf16 v[32:35], v[0:3], v[60:67], v74
  ds_read_b128 v[8:11], v76 offset:9728
  s_waitcnt lgkmcnt(0)
  v_smfmac_f32_16x16x64_bf16 v[20:23], v[8:11], v[160:167], v74
  v_smfmac_f32_16x16x64_bf16 v[24:27], v[8:11], v[168:175], v74
  ds_read_b128 v[60:63], v75 offset:16384
  ds_read_b128 v[64:67], v75 offset:17408
  s_waitcnt lgkmcnt(0)
  v_smfmac_f32_16x16x64_bf16 v[28:31], v[8:11], v[60:67], v74
  ds_read_b128 v[60:63], v75 offset:18432
  ds_read_b128 v[64:67], v75 offset:19456
  s_waitcnt lgkmcnt(0)
  v_smfmac_f32_16x16x64_bf16 v[32:35], v[8:11], v[60:67], v74
  ds_read_b128 v[16:19], v76 offset:10752
  ds_read_b128 v[60:63], v75 offset:0
  ds_read_b128 v[64:67], v75 offset:1024
  s_waitcnt lgkmcnt(0)
  v_smfmac_f32_16x16x64_bf16 v[20:23], v[16:19], v[60:67], v74
  ds_read_b128 v[60:63], v75 offset:2048
  ds_read_b128 v[64:67], v75 offset:3072
  s_waitcnt lgkmcnt(0)
  v_smfmac_f32_16x16x64_bf16 v[24:27], v[16:19], v[60:67], v74
  v_smfmac_f32_16x16x64_bf16 v[28:31], v[16:19], v[240:247], v74
  v_smfmac_f32_16x16x64_bf16 v[32:35], v[16:19], v[248:255], v74
  ds_read_b128 v[4:7], v76 offset:11776
  s_waitcnt lgkmcnt(0)
  v_smfmac_f32_16x16x64_bf16 v[20:23], v[4:7], v[176:183], v74
  v_smfmac_f32_16x16x64_bf16 v[24:27], v[4:7], v[184:191], v74
  v_smfmac_f32_16x16x64_bf16 v[28:31], v[4:7], a[0:7], v74
  v_smfmac_f32_16x16x64_bf16 v[32:35], v[4:7], a[8:15], v74
  ds_read_b128 v[12:15], v76 offset:12800
  s_waitcnt lgkmcnt(0)
  v_smfmac_f32_16x16x64_bf16 v[20:23], v[12:15], v[192:199], v74
  v_smfmac_f32_16x16x64_bf16 v[24:27], v[12:15], v[200:207], v74
  v_smfmac_f32_16x16x64_bf16 v[28:31], v[12:15], a[16:23], v74
  v_smfmac_f32_16x16x64_bf16 v[32:35], v[12:15], a[24:31], v74
  v_add_f32 v20, v20, v22
  v_add_f32 v21, v21, v23
  v_add_f32 v24, v24, v26
  v_cvt_pk_bf16_f32 v22, v20, v24
  s_nop 0
  ds_write_b32 v79, v22 offset:0
  v_add_f32 v25, v25, v27
  v_cvt_pk_bf16_f32 v23, v21, v25
  ds_write_b32 v79, v23 offset:576
  v_add_f32 v28, v28, v30
  v_add_f32 v29, v29, v31
  s_waitcnt lgkmcnt(0)
  s_nop 1
  s_branch Cs0_recok
Cs0_mx:
  s_waitcnt lgkmcnt(0)
  s_barrier
  buffer_load_dwordx4 v[0:3], v76, s[8:11], s58 offen offset:0 sc1
  ds_read_b128 v[20:23], v77 offset:0
  ds_read_b128 v[28:31], v77 offset:256
  buffer_load_dwordx4 v[4:7], v76, s[8:11], s58 offen offset:1024 sc1
  ds_read_b128 v[24:27], v77 offset:128
  ds_read_b128 v[32:35], v77 offset:384
  s_waitcnt vmcnt(1) lgkmcnt(3)
  v_mfma_f32_16x16x32_bf16 v[8:11], v[0:3], v[20:23], 0
  s_waitcnt vmcnt(0) lgkmcnt(1)
  v_mfma_f32_16x16x32_bf16 v[8:11], v[4:7], v[24:27], v[8:11]
  v_mfma_f32_16x16x32_bf16 v[12:15], v[28:31], v[20:23], 0
  s_waitcnt lgkmcnt(0)
  v_mfma_f32_16x16x32_bf16 v[12:15], v[32:35], v[24:27], v[12:15]
  v_add_f32_dpp v8, v10, v8 quad_perm:[2,3,0,1] row_mask:0xf bank_mask:0xf
  v_add_f32_dpp v9, v11, v9 quad_perm:[2,3,0,1] row_mask:0xf bank_mask:0xf
  s_nop 0
  v_mov_b32_dpp v8, v8 quad_perm:[0,1,0,1] row_mask:0xf bank_mask:0xf
  v_mov_b32_dpp v9, v9 quad_perm:[0,1,0,1] row_mask:0xf bank_mask:0xf
  s_nop 1
  v_add_f32_dpp v12, v14, v12 quad_perm:[2,3,0,1] row_mask:0xf bank_mask:0xf
  v_add_f32_dpp v13, v15, v13 quad_perm:[2,3,0,1] row_mask:0xf bank_mask:0xf
  s_nop 0
  v_mov_b32_dpp v12, v12 quad_perm:[0,1,0,1] row_mask:0xf bank_mask:0xf
  v_mov_b32_dpp v13, v13 quad_perm:[0,1,0,1] row_mask:0xf bank_mask:0xf
  v_mul_f32 v12, s69, v12
  ds_write_b32 v78, v8 offset:8704
  v_mul_f32 v13, s69, v13
  ds_write_b32 v78, v9 offset:8768
  s_waitcnt lgkmcnt(0)
  s_barrier
  ds_read_b128 v[36:39], v78 offset:8704
  ds_read_b128 v[40:43], v78 offset:8768
  s_waitcnt lgkmcnt(0)
  s_barrier
  v_max_f32 v16, v36, v37
  v_max3_f32 v16, v16, v38, v39
  v_max3_f32 v16, v16, v40, v41
  v_max3_f32 v16, v16, v42, v43
  v_max3_f32 v16, v16, v12, v13
  v_mov_b32 v17, v16
  s_nop 1
  v_permlane16_swap_b32 v16, v17
  v_max_f32 v16, v16, v17
  v_mov_b32 v17, v16
  s_nop 1
  v_permlane32_swap_b32 v16, v17
  v_max_f32 v16, v16, v17
  v_sub_f32 v36, v36, v16
  v_sub_f32 v37, v37, v16
  v_sub_f32 v38, v38, v16
  v_sub_f32 v39, v39, v16
  v_sub_f32 v40, v40, v16
  v_sub_f32 v41, v41, v16
  v_sub_f32 v42, v42, v16
  v_sub_f32 v43, v43, v16
  v_sub_f32 v12, v12, v16
  v_sub_f32 v13, v13, v16
  v_exp_f32 v36, v36
  v_exp_f32 v37, v37
  v_exp_f32 v38, v38
  v_exp_f32 v39, v39
  v_exp_f32 v40, v40
  v_exp_f32 v41, v41
  v_exp_f32 v42, v42
  v_exp_f32 v43, v43
  v_exp_f32 v12, v12
  v_exp_f32 v13, v13
  v_cvt_pk_bf16_f32 v32, v36, v40
  v_cvt_pk_bf16_f32 v33, v37, v41
  v_cvt_pk_bf16_f32 v34, v38, v42
  v_cvt_pk_bf16_f32 v35, v39, v43
  v_cvt_pk_bf16_f32 v28, v12, v13
  v_cvt_pk_bf16_f32 v31, v12, v13
  v_mov_b32 v29, 0
  v_mov_b32 v30, 0
  v_mov_b32 v68, 0x3f803f80
  v_mov_b32 v69, 0x3f803f80
  v_mov_b32 v70, 0x3f803f80
  v_mov_b32 v71, 0x3f803f80
  s_nop 1
  v_mfma_f32_16x16x32_bf16 v[8:11], v[32:35], v[68:71], 0
  v_mfma_f32_16x16x32_bf16 v[0:3], v[32:35], v[52:55], 0
  v_mfma_f32_16x16x32_bf16 v[4:7], v[32:35], v[56:59], 0
  v_mfma_f32_16x16x16_bf16 v[8:11], v[28:29], v[68:69], v[8:11]
  v_mfma_f32_16x16x16_bf16 v[0:3], v[28:29], v[72:73], v[0:3]
  v_mfma_f32_16x16x16_bf16 v[4:7], v[30:31], v[72:73], v[4:7]
  ds_read_b128 v[68:71], v76 offset:13824
  v_rcp_f32 v10, v8
  v_rcp_f32 v11, v9
  v_mul_f32 v0, v10, v0
  v_mul_f32 v1, v11, v1
  s_nop 0
  v_mul_f32 v4, v10, v4
  v_mul_f32 v5, v11, v5
  v_cvt_pk_bf16_f32 v2, v0, v4
  ds_write_b32 v79, v2 offset:8704
  v_cvt_pk_bf16_f32 v3, v1, v5
  ds_write_b32 v79, v3 offset:9280
  v_mov_b64 v[16:17], 0
  v_mov_b64 v[18:19], 0
  v_mov_b64 v[20:21], 0
  v_mov_b64 v[22:23], 0
  v_mov_b64 v[24:25], 0
  v_mov_b64 v[26:27], 0
  s_branch Cs0_mxok
Cs0_kv3:
  s_waitcnt lgkmcnt(0)
  s_cmp_ge_u32 s57, 0x700
  s_cbranch_scc1 Cs0_kvb
  s_load_dword s57, s[12:13], s71 glc
  s_add_u32 s67, s67, 1
  s_cmp_lt_u32 s67, 131072
  s_cbranch_scc1 Cs0_kv3
  s_waitcnt lgkmcnt(0)
  s_branch Cs0_kvb
Cs0_last:
  ds_read_b128 v[4:7], v76 offset:5632
  ds_read_b128 v[12:15], v76 offset:7680
  ds_read_b128 v[44:47], v76 offset:32768
  ds_read_b128 v[48:51], v76 offset:33792
  s_nop 5
  v_mov_b64 v[20:21], 0
  v_mov_b64 v[22:23], 0
  v_mov_b64 v[24:25], 0
  v_mov_b64 v[26:27], 0
  v_smfmac_f32_16x16x64_bf16 v[28:31], v[0:3], v[36:43], v74
  ds_read_b128 v[36:39], v76 offset:34816
  ds_read_b128 v[40:43], v76 offset:35840
  v_smfmac_f32_16x16x64_bf16 v[32:35], v[0:3], v[60:67], v74
  s_waitcnt lgkmcnt(5)
  v_smfmac_f32_16x16x64_bf16 v[20:23], v[0:3], a[32:39], v74
  ds_read_b128 v[60:63], v76 offset:49152
  ds_read_b128 v[64:67], v76 offset:50176
  v_smfmac_f32_16x16x64_bf16 v[24:27], v[0:3], a[40:47], v74
  s_waitcnt lgkmcnt(4)
  v_smfmac_f32_16x16x64_bf16 v[20:23], v[4:7], a[48:55], v74
  buffer_store_dwordx4 v[16:19], v76, s[8:11], s68 offen sc1
  v_smfmac_f32_16x16x64_bf16 v[24:27], v[4:7], a[56:63], v74
  v_smfmac_f32_16x16x64_bf16 v[28:31], v[4:7], v[44:51], v74
  s_waitcnt lgkmcnt(2)
  v_smfmac_f32_16x16x64_bf16 v[20:23], v[8:11], a[64:71], v74
  ds_read_b128 v[44:47], v76 offset:51200
  ds_read_b128 v[48:51], v76 offset:52224
  v_smfmac_f32_16x16x64_bf16 v[24:27], v[8:11], a[72:79], v74
  v_smfmac_f32_16x16x64_bf16 v[32:35], v[4:7], v[36:43], v74
  v_smfmac_f32_16x16x64_bf16 v[28:31], v[8:11], v[208:215], v74
  ds_read_b128 v[36:39], v75 offset:16384
  ds_read_b128 v[40:43], v75 offset:17408
  v_smfmac_f32_16x16x64_bf16 v[32:35], v[8:11], v[216:223], v74
  v_smfmac_f32_16x16x64_bf16 v[20:23], v[12:15], a[80:87], v74
  v_smfmac_f32_16x16x64_bf16 v[24:27], v[12:15], a[88:95], v74
  v_smfmac_f32_16x16x64_bf16 v[28:31], v[12:15], v[224:231], v74
  v_smfmac_f32_16x16x64_bf16 v[32:35], v[12:15], v[232:239], v74
  s_waitcnt vmcnt(2)
  s_waitcnt vmcnt(1)
  s_barrier
Cs0_lastr:
  ds_read_b128 v[0:3], v76 offset:8704
  ds_read_b128 v[8:11], v76 offset:9728
  ds_read_b128 v[16:19], v76 offset:10752
  ds_read_b128 v[4:7], v76 offset:11776
  ds_read_b128 v[12:15], v76 offset:12800
  s_waitcnt lgkmcnt(4)
  v_max3_u32 v72, v0, v1, v2
  s_waitcnt lgkmcnt(1)
  v_max3_u32 v72, v72, v3, v4
  v_max3_u32 v72, v72, v5, v6
  v_max3_u32 v72, v72, v7, v8
  v_max3_u32 v72, v72, v9, v10
  s_waitcnt lgkmcnt(0)
  v_max3_u32 v72, v72, v11, v12
  v_max3_u32 v72, v72, v13, v14
  v_max3_u32 v72, v72, v15, v16
  v_max3_u32 v72, v72, v17, v18
  v_max_u32 v72, v72, v19
  v_cmp_eq_u32 vcc, -1, v72
  s_cbranch_vccnz Cs0_lastp
Cs0_lastg:
  v_smfmac_f32_16x16x64_bf16 v[28:31], v[0:3], v[60:67], v74
  ds_read_b128 v[60:63], v75 offset:18432
  ds_read_b128 v[64:67], v75 offset:19456
  v_smfmac_f32_16x16x64_bf16 v[32:35], v[0:3], v[44:51], v74
  v_smfmac_f32_16x16x64_bf16 v[28:31], v[8:11], v[36:43], v74
  v_smfmac_f32_16x16x64_bf16 v[28:31], v[16:19], v[240:247], v74
  v_smfmac_f32_16x16x64_bf16 v[28:31], v[4:7], a[0:7], v74
  v_smfmac_f32_16x16x64_bf16 v[28:31], v[12:15], a[16:23], v74
  v_smfmac_f32_16x16x64_bf16 v[32:35], v[16:19], v[248:255], v74
  v_smfmac_f32_16x16x64_bf16 v[32:35], v[4:7], a[8:15], v74
  s_waitcnt lgkmcnt(0)
  v_smfmac_f32_16x16x64_bf16 v[32:35], v[12:15], a[24:31], v74
  v_smfmac_f32_16x16x64_bf16 v[32:35], v[8:11], v[60:67], v74
  v_smfmac_f32_16x16x64_bf16 v[20:23], v[0:3], a[96:103], v74
  v_smfmac_f32_16x16x64_bf16 v[20:23], v[8:11], a[112:119], v74
  v_add_f32 v28, v28, v30
  v_add_f32 v32, v32, v34
  v_cvt_pk_bf16_f32 v30, v28, v32
  v_smfmac_f32_16x16x64_bf16 v[20:23], v[16:19], a[128:135], v74
  ds_write_b32 v79, v30 offset:256
  v_add_f32 v29, v29, v31
  v_add_f32 v33, v33, v35
  v_cvt_pk_bf16_f32 v31, v29, v33
  v_smfmac_f32_16x16x64_bf16 v[20:23], v[4:7], a[144:151], v74
  ds_write_b32 v79, v31 offset:832
  v_smfmac_f32_16x16x64_bf16 v[20:23], v[12:15], a[160:167], v74
  v_smfmac_f32_16x16x64_bf16 v[24:27], v[0:3], a[104:111], v74
  v_smfmac_f32_16x16x64_bf16 v[24:27], v[8:11], a[120:127], v74
  v_smfmac_f32_16x16x64_bf16 v[24:27], v[16:19], a[136:143], v74
  s_waitcnt lgkmcnt(0)
  s_barrier
  ds_read_b64 v[52:53], v77 offset:256
  v_add_f32 v20, v20, v22
  v_smfmac_f32_16x16x64_bf16 v[24:27], v[4:7], a[152:159], v74
  v_add_f32 v21, v21, v23
  v_smfmac_f32_16x16x64_bf16 v[24:27], v[12:15], a[168:175], v74
  v_cvt_pk_bf16_f32 v54, v20, v21
  s_add_u32 s68, s68, 655360
  s_nop 3
  v_add_f32 v24, v24, v26
  v_add_f32 v25, v25, v27
  v_cvt_pk_bf16_f32 v55, v24, v25
  s_waitcnt lgkmcnt(0)
  buffer_store_dwordx4 v[52:55], v76, s[8:11], s68 offen sc1
  s_branch Cs0_done
Cs0_lastp:
  s_add_u32 s72, s72, 2
  s_cmp_ge_u32 s72, 131072
  s_cbranch_scc1 Cs0_lastg
  s_barrier
  buffer_load_dwordx4 v76, s[8:11], s55 offen offset:0 sc1 lds
  s_waitcnt vmcnt(0)
  s_barrier
  s_branch Cs0_lastr
Cs0_done:
  s_branch L_cexit
L_w5:
  v_mov_b64 v[20:21], 0
  v_mov_b64 v[22:23], 0
  v_mov_b64 v[24:25], 0
  v_mov_b64 v[26:27], 0
  v_mov_b64 v[28:29], 0
  v_mov_b64 v[30:31], 0
  v_mov_b64 v[32:33], 0
  v_mov_b64 v[34:35], 0
  s_mov_b32 s78, 0x3f803f80
  s_mov_b32 s79, s78
  s_mov_b32 s65, 360448
  s_mov_b32 m0, 15872
  s_lshl_b32 s71, s53, 2
  s_add_u32 s71, s71, 128
  s_movk_i32 s56, 0x1000
  v_lshlrev_b32 v73, 2, v76
  v_mov_b32 v72, 0
  s_mov_b64 s[16:17], s[8:9]
  s_mov_b32 s18, 268435456
  s_mov_b32 s19, 0x20000
  s_getpc_b64 s[20:21]
Cs1_pc:
  s_add_u32 s20, s20, (Cs1_last - Cs1_pc)
  s_addc_u32 s21, s21, 0
  v_mov_b32 v68, 14880
  buffer_load_dwordx4 v[52:55], v76, s[8:11], s59 offen offset:0 sc1
  buffer_load_dwordx4 v[56:59], v76, s[8:11], s59 offen offset:1024 sc1
  ds_read_b128 v[36:39], v76 offset:20480
  ds_read_b128 v[40:43], v76 offset:21504
  ds_read_b128 v[60:63], v76 offset:22528
  ds_read_b128 v[64:67], v76 offset:23552
  ds_read_b128 v[0:3], v76 offset:4608
  ds_read_b128 v[4:7], v76 offset:5632
  ds_read_b128 v[8:11], v76 offset:6656
  ds_read_b128 v[12:15], v76 offset:7680
  s_waitcnt lgkmcnt(0)
  s_cmp_eq_u32 s66, 1
  s_branch Cs1_top2
.p2align 6
Cs1_h2:
  v_lshlrev_b32 v73, 2, v76
  s_mov_b32 m0, 11776
  s_add_u32 s55, s65, 7168
  s_nop 15
  s_nop 3
  buffer_load_dwordx4 v[8:11], v76, s[8:11], s65 offen offset:2048 sc1
  s_nop 15
  s_nop 3
  buffer_load_dwordx4 v[8:11], v76, s[8:11], s65 offen offset:2048 sc1
  s_nop 15
  s_nop 3
  buffer_load_dwordx4 v[8:11], v76, s[8:11], s65 offen offset:2048 sc1
  s_waitcnt vmcnt(5)
  ds_read_b128 v[36:39], v76 offset:20480
  ds_read_b128 v[40:43], v76 offset:21504
  ds_read_b128 v[60:63], v76 offset:22528
  ds_read_b128 v[64:67], v76 offset:23552
  buffer_load_dwordx4 v[52:55], v76, s[8:11], s59 offen offset:0 sc1
  buffer_load_dwordx4 v[56:59], v76, s[8:11], s59 offen offset:1024 sc1
  s_waitcnt vmcnt(4)
  v_max3_u32 v72, v8, v9, v10
  v_max_u32 v72, v72, v11
  ds_write_b128 v76, v[8:11] offset:6656
  v_cmp_eq_u32 vcc, -1, v72
  s_cbranch_vccnz Cs1_h2r
Cs1_h2w:
  s_cmp_eq_u32 s66, 63
  s_waitcnt lgkmcnt(0)
  s_barrier
  ds_read_b128 v[0:3], v76 offset:4608
  buffer_load_dwordx4 v76, s[8:11], s55 offen offset:0 sc1 lds
Cs1_top2:
  v_smfmac_f32_16x16x64_bf16 v[20:23], v[8:11], v[112:119], v74
  s_cbranch_scc1 Cs1_last
  v_smfmac_f32_16x16x64_bf16 v[24:27], v[8:11], v[120:127], v74
  buffer_load_dwordx4 v[44:47], v76, s[8:11], s58 offen offset:0 sc1
  s_mov_b32 m0, 15872
  v_smfmac_f32_16x16x64_bf16 v[28:31], v[8:11], v[208:215], v74
  buffer_load_dwordx4 v[48:51], v76, s[8:11], s58 offen offset:1024 sc1
  v_smfmac_f32_16x16x64_bf16 v[32:35], v[8:11], v[216:223], v74
  ds_read_b128 v[4:7], v76 offset:5632
  s_waitcnt lgkmcnt(1)
  v_smfmac_f32_16x16x64_bf16 v[20:23], v[0:3], v[80:87], v74
  ds_read_b128 v[12:15], v76 offset:7680
  v_smfmac_f32_16x16x64_bf16 v[28:31], v[0:3], v[36:43], v74
  ds_read_b128 v[36:39], v76 offset:36864
  v_smfmac_f32_16x16x64_bf16 v[24:27], v[0:3], v[88:95], v74
  buffer_store_dwordx4 v[16:19], v76, s[8:11], s68 offen sc1
  ds_read_b128 v[40:43], v76 offset:37888
  v_smfmac_f32_16x16x64_bf16 v[32:35], v[0:3], v[60:67], v74
  ds_read_b128 v[60:63], v76 offset:38912
  s_waitcnt lgkmcnt(4)
  v_smfmac_f32_16x16x64_bf16 v[20:23], v[4:7], v[96:103], v74
  ds_read_b128 v[64:67], v76 offset:39936
  v_smfmac_f32_16x16x64_bf16 v[24:27], v[4:7], v[104:111], v74
  buffer_load_dword v73, s[16:19], s70 offen lds
  s_waitcnt vmcnt(5)
  s_waitcnt lgkmcnt(4)
  v_smfmac_f32_16x16x64_bf16 v[20:23], v[12:15], v[128:135], v74
  s_barrier
  s_waitcnt lgkmcnt(2)
  v_smfmac_f32_16x16x64_bf16 v[28:31], v[4:7], v[36:43], v74
  ds_read_b128 v[8:11], v76 offset:8704
  v_smfmac_f32_16x16x64_bf16 v[24:27], v[12:15], v[136:143], v74
  ds_read_b128 v[36:39], v76 offset:53248
  s_waitcnt lgkmcnt(2)
  v_smfmac_f32_16x16x64_bf16 v[32:35], v[4:7], v[60:67], v74
  ds_read_b128 v[40:43], v76 offset:54272
  v_smfmac_f32_16x16x64_bf16 v[28:31], v[12:15], v[224:231], v74
  ds_read_b128 v[60:63], v76 offset:55296
  v_smfmac_f32_16x16x64_bf16 v[32:35], v[12:15], v[232:239], v74
  ds_read_b128 v[64:67], v76 offset:56320
  s_waitcnt lgkmcnt(4)
  v_smfmac_f32_16x16x64_bf16 v[20:23], v[8:11], v[144:151], v74
  s_waitcnt vmcnt(4)
  ds_read_b128 v[0:3], v76 offset:9728
  s_waitcnt lgkmcnt(3)
  v_smfmac_f32_16x16x64_bf16 v[28:31], v[8:11], v[36:43], v74
  s_barrier
  ds_read_b128 v[4:7], v76 offset:11776
  v_smfmac_f32_16x16x64_bf16 v[24:27], v[8:11], v[152:159], v74
  ds_read_b128 v[36:39], v75 offset:4096
  ds_read_b128 v[40:43], v75 offset:5120
  s_waitcnt lgkmcnt(4)
  v_smfmac_f32_16x16x64_bf16 v[32:35], v[8:11], v[60:67], v74
  ds_read_b128 v[16:19], v76 offset:10752
  s_waitcnt lgkmcnt(4)
  v_smfmac_f32_16x16x64_bf16 v[20:23], v[0:3], v[160:167], v74
  ds_read_b128 v[12:15], v76 offset:12800
  v_smfmac_f32_16x16x64_bf16 v[24:27], v[0:3], v[168:175], v74
  ds_read_b128 v[60:63], v75 offset:6144
  ds_read_b128 v[64:67], v75 offset:7168
  s_waitcnt lgkmcnt(6)
  v_smfmac_f32_16x16x64_bf16 v[20:23], v[4:7], v[176:183], v74
  s_waitcnt lgkmcnt(3)
  v_smfmac_f32_16x16x64_bf16 v[20:23], v[16:19], v[36:43], v74
  ds_read_b128 v[36:39], v75 offset:20480
  s_waitcnt lgkmcnt(3)
  v_smfmac_f32_16x16x64_bf16 v[20:23], v[12:15], v[192:199], v74
  ds_read_b128 v[40:43], v75 offset:21504
  s_waitcnt lgkmcnt(2)
  v_smfmac_f32_16x16x64_bf16 v[24:27], v[16:19], v[60:67], v74
  ds_read_b128 v[60:63], v75 offset:22528
  v_smfmac_f32_16x16x64_bf16 v[24:27], v[4:7], v[184:191], v74
  ds_read_b128 v[64:67], v75 offset:23552
  v_add_f32 v20, v20, v22
  v_smfmac_f32_16x16x64_bf16 v[24:27], v[12:15], v[200:207], v74
  v_add_f32 v21, v21, v23
  v_smfmac_f32_16x16x64_bf16 v[28:31], v[16:19], v[240:247], v74
  s_waitcnt lgkmcnt(2)
  v_mov_b64 v[70:71], s[78:79]
  v_smfmac_f32_16x16x64_bf16 v[28:31], v[0:3], v[36:43], v74
  ds_read_b128 v[36:39], v68
  v_add_f32 v24, v24, v26
  v_smfmac_f32_16x16x64_bf16 v[28:31], v[4:7], a[0:7], v74
  ds_read_b128 v[40:43], v68
  v_cvt_pk_bf16_f32 v22, v20, v24
  v_smfmac_f32_16x16x64_bf16 v[28:31], v[12:15], a[16:23], v74
  ds_write_b32 v79, v22 offset:0
  s_waitcnt lgkmcnt(3)
  v_add_f32 v25, v25, v27
  v_cvt_pk_bf16_f32 v23, v21, v25
  v_smfmac_f32_16x16x64_bf16 v[32:35], v[0:3], v[60:67], v74
  ds_write_b32 v79, v23 offset:576
  v_cmp_u_f32 vcc, v20, v21
  v_smfmac_f32_16x16x64_bf16 v[32:35], v[16:19], v[248:255], v74
  v_add_f32 v28, v28, v30
  v_smfmac_f32_16x16x64_bf16 v[32:35], v[4:7], a[8:15], v74
  v_add_f32 v29, v29, v31
  v_smfmac_f32_16x16x64_bf16 v[32:35], v[12:15], a[24:31], v74
  s_cbranch_vccnz Cs1_rec
Cs1_recok:
  s_waitcnt lgkmcnt(3)
  v_smfmac_f32_16x16x64_bf16 v[36:39], v[16:19], a[128:135], v74
  s_waitcnt lgkmcnt(0)
  s_barrier
  ds_read_b128 v[60:63], v77
  v_smfmac_f32_16x16x64_bf16 v[40:43], v[16:19], a[136:143], v74
  ds_read_b128 v[64:67], v77 offset:128
  v_add_f32 v32, v32, v34
  v_cvt_pk_bf16_f32 v30, v28, v32
  v_smfmac_f32_16x16x64_bf16 v[36:39], v[0:3], a[112:119], v74
  ds_write_b32 v79, v30 offset:256
  v_add_f32 v33, v33, v35
  v_cvt_pk_bf16_f32 v31, v29, v33
  v_smfmac_f32_16x16x64_bf16 v[40:43], v[0:3], a[120:127], v74
  ds_write_b32 v79, v31 offset:832
  v_xor_b32 v75, 0x8000, v75
  v_smfmac_f32_16x16x64_bf16 v[36:39], v[4:7], a[144:151], v74
  ds_read_b128 v[0:3], v76 offset:4608
  v_mov_b32 v29, 0
  v_smfmac_f32_16x16x64_bf16 v[40:43], v[4:7], a[152:159], v74
  s_waitcnt vmcnt(2) lgkmcnt(3)
  v_mov_b32 v30, 0
  v_mfma_f32_16x16x32_bf16 v[44:47], v[44:47], v[60:63], 0
  ds_read_b128 v[4:7], v76 offset:5632
  s_waitcnt lgkmcnt(2)
  v_mfma_f32_16x16x32_bf16 v[44:47], v[48:51], v[64:67], v[44:47]
  s_barrier
  v_smfmac_f32_16x16x64_bf16 v[36:39], v[8:11], a[96:103], v74
  ds_read_b128 v[20:23], v77 offset:256
  ds_read_b128 v[24:27], v77 offset:384
  v_smfmac_f32_16x16x64_bf16 v[40:43], v[8:11], a[104:111], v74
  ds_read_b128 v[8:11], v76 offset:6656
  v_add_f32_dpp v72, v46, v44 quad_perm:[2,3,0,1] row_mask:0xf bank_mask:0xf
  v_add_f32_dpp v73, v47, v45 quad_perm:[2,3,0,1] row_mask:0xf bank_mask:0xf
  v_smfmac_f32_16x16x64_bf16 v[36:39], v[12:15], a[160:167], v74
  s_waitcnt lgkmcnt(4)
  v_exp_f32_dpp v72, v72 quad_perm:[0,1,0,1] row_mask:0xf bank_mask:0xf
  v_smfmac_f32_16x16x64_bf16 v[40:43], v[12:15], a[168:175], v74
  ds_read_b128 v[12:15], v76 offset:7680
  v_exp_f32_dpp v73, v73 quad_perm:[0,1,0,1] row_mask:0xf bank_mask:0xf
  v_smfmac_f32_16x16x64_bf16 v[36:39], v[0:3], a[32:39], v74
  s_waitcnt lgkmcnt(2)
  v_cvt_pk_bf16_f32 v72, v72, v73
  v_mfma_f32_16x16x32_bf16 v[20:23], v[20:23], v[60:63], 0
  ds_write_b32 v78, v72 offset:516
  v_mov_b64 v[16:17], 0
  v_mfma_f32_16x16x32_bf16 v[20:23], v[24:27], v[64:67], v[20:23]
  ds_read_b128 v[44:47], v75 offset:20480
  v_mov_b64 v[18:19], 0
  v_smfmac_f32_16x16x64_bf16 v[40:43], v[0:3], a[40:47], v74
  ds_read_b128 v[48:51], v75 offset:21504
  v_mov_b64 v[68:69], s[78:79]
  v_smfmac_f32_16x16x64_bf16 v[36:39], v[4:7], a[48:55], v74
  s_waitcnt lgkmcnt(4)
  v_add_f32_dpp v24, v22, v20 quad_perm:[2,3,0,1] row_mask:0xf bank_mask:0xf
  v_add_f32_dpp v25, v23, v21 quad_perm:[2,3,0,1] row_mask:0xf bank_mask:0xf
  v_smfmac_f32_16x16x64_bf16 v[36:39], v[8:11], a[64:71], v74
  s_waitcnt lgkmcnt(2)
  s_barrier
  ds_read_b128 v[32:35], v78 offset:512
  v_smfmac_f32_16x16x64_bf16 v[36:39], v[12:15], a[80:87], v74
  ds_read_b128 v[60:63], v75 offset:22528
  v_mul_f32 v24, s69, v24
  v_smfmac_f32_16x16x64_bf16 v[40:43], v[4:7], a[56:63], v74
  ds_read_b128 v[64:67], v75 offset:23552
  v_mul_f32 v25, s69, v25
  v_smfmac_f32_16x16x64_bf16 v[40:43], v[8:11], a[72:79], v74
  v_exp_f32_dpp v24, v24 quad_perm:[0,1,0,1] row_mask:0xf bank_mask:0xf
  v_smfmac_f32_16x16x64_bf16 v[40:43], v[12:15], a[88:95], v74
  s_waitcnt lgkmcnt(2)
  v_exp_f32_dpp v25, v25 quad_perm:[0,1,0,1] row_mask:0xf bank_mask:0xf
  v_mfma_f32_16x16x32_bf16 v[8:11], v[32:35], v[68:71], 0
  v_add_f32 v36, v36, v38
  v_add_f32 v37, v37, v39
  v_mfma_f32_16x16x32_bf16 v[0:3], v[32:35], v[52:55], 0
  v_add_f32 v40, v40, v42
  v_add_f32 v41, v41, v43
  v_mfma_f32_16x16x32_bf16 v[4:7], v[32:35], v[56:59], 0
  v_cvt_pk_bf16_f32 v28, v24, v25
  v_cvt_pk_bf16_f32 v72, v36, v37
  v_cvt_pk_bf16_f32 v73, v40, v41
  v_mfma_f32_16x16x16_bf16 v[8:11], v[28:29], v[68:69], v[8:11]
  v_cvt_pk_bf16_f32 v31, v24, v25
  v_mov_b64 v[20:21], 0
  v_mfma_f32_16x16x16_bf16 v[0:3], v[28:29], v[72:73], v[0:3]
  ds_read_b128 v[68:71], v76 offset:13824
  v_mov_b64 v[22:23], 0
  v_mfma_f32_16x16x16_bf16 v[4:7], v[30:31], v[72:73], v[4:7]
  v_rcp_f32 v10, v8
  v_rcp_f32 v11, v9
  v_mul_f32 v0, v10, v0
  v_mul_f32 v1, v11, v1
  s_nop 0
  v_mul_f32 v4, v10, v4
  v_mul_f32 v5, v11, v5
  v_cvt_pk_bf16_f32 v2, v0, v4
  ds_write_b32 v79, v2 offset:8704
  v_cvt_pk_bf16_f32 v3, v1, v5
  ds_write_b32 v79, v3 offset:9280
  v_max3_f32 v8, v8, v9, v10
  v_max_f32 v8, v8, v11
  v_cmp_le_f32 vcc, 1317011456, v8
  v_mov_b64 v[24:25], 0
  v_mov_b64 v[26:27], 0
  s_cbranch_vccnz Cs1_mx
Cs1_mxok:
  s_waitcnt lgkmcnt(0)
  s_barrier
  ds_read_b128 v[0:3], v78 offset:8704
  ds_read_b128 v[4:7], v78 offset:8768
  ds_read_b128 v[8:11], v78 offset:8832
  ds_read_b128 v[12:15], v78 offset:8896
  s_waitcnt lgkmcnt(3)
  v_smfmac_f32_16x16x64_bf16 v[16:19], v[0:3], v[44:51], v74
  ds_read_b128 v[52:55], v75 offset:36864
  s_waitcnt lgkmcnt(3)
  v_smfmac_f32_16x16x64_bf16 v[16:19], v[4:7], v[60:67], v74
  ds_read_b128 v[56:59], v75 offset:37888
  s_waitcnt lgkmcnt(3)
  v_smfmac_f32_16x16x64_bf16 v[16:19], v[8:11], a[176:183], v74
  ds_read_b128 v[36:39], v75 offset:38912
  s_waitcnt lgkmcnt(3)
  v_smfmac_f32_16x16x64_bf16 v[16:19], v[12:15], a[184:191], v74
  ds_read_b128 v[40:43], v75 offset:39936
  ds_read_b128 v[44:47], v75 offset:53248
  v_smfmac_f32_16x16x64_bf16 v[20:23], v[0:3], a[192:199], v74
  ds_read_b128 v[48:51], v75 offset:54272
  ds_read_b128 v[60:63], v75 offset:55296
  v_smfmac_f32_16x16x64_bf16 v[20:23], v[4:7], a[200:207], v74
  ds_read_b128 v[64:67], v75 offset:56320
  s_waitcnt lgkmcnt(6)
  v_cvt_pk_bf16_f32 v16, v16, v17
  v_cvt_pk_bf16_f32 v17, v18, v19
  v_bfi_b32 v16, 1, s72, v16
  v_smfmac_f32_16x16x64_bf16 v[20:23], v[8:11], v[52:59], v74
  buffer_store_dwordx2 v[16:17], v68, s[8:11], s73 offen sc1
  s_waitcnt lgkmcnt(4)
  v_smfmac_f32_16x16x64_bf16 v[20:23], v[12:15], v[36:43], v74
  v_mov_b64 v[32:33], 0
  v_smfmac_f32_16x16x64_bf16 v[24:27], v[0:3], a[208:215], v74
  v_mov_b64 v[34:35], 0
  v_smfmac_f32_16x16x64_bf16 v[24:27], v[4:7], a[216:223], v74
  s_waitcnt lgkmcnt(2)
  v_cvt_pk_bf16_f32 v20, v20, v21
  v_cvt_pk_bf16_f32 v21, v22, v23
  v_bfi_b32 v20, 1, s72, v20
  v_smfmac_f32_16x16x64_bf16 v[24:27], v[8:11], v[44:51], v74
  buffer_store_dwordx2 v[20:21], v68, s[8:11], s74 offen sc1
  s_waitcnt lgkmcnt(0)
  v_smfmac_f32_16x16x64_bf16 v[24:27], v[12:15], v[60:67], v74
  v_smfmac_f32_16x16x64_bf16 v[32:35], v[0:3], a[224:231], v74
  v_smfmac_f32_16x16x64_bf16 v[32:35], v[4:7], a[232:239], v74
  v_cvt_pk_bf16_f32 v24, v24, v25
  v_cvt_pk_bf16_f32 v25, v26, v27
  v_bfi_b32 v24, 1, s72, v24
  v_smfmac_f32_16x16x64_bf16 v[32:35], v[8:11], a[240:247], v74
  s_nop 1
  buffer_store_dwordx2 v[24:25], v68, s[8:11], s75 offen sc1
  v_smfmac_f32_16x16x64_bf16 v[32:35], v[12:15], a[248:255], v74
  ds_read_b128 v[0:3], v76 offset:14848
  ds_read_b64 v[16:17], v77 offset:264
  v_mov_b64 v[18:19], v[72:73]
  v_xor_b32 v75, 0x8000, v75
  s_nop 3
  v_cvt_pk_bf16_f32 v32, v32, v33
  v_cvt_pk_bf16_f32 v33, v34, v35
  v_bfi_b32 v32, 1, s72, v32
  buffer_store_dwordx2 v[32:33], v68, s[8:11], s76 offen sc1
  v_mov_b64 v[20:21], 0
  v_mov_b64 v[22:23], 0
  v_mov_b64 v[24:25], 0
  v_mov_b64 v[26:27], 0
  v_mov_b64 v[28:29], 0
  v_mov_b64 v[30:31], 0
  v_mov_b64 v[32:33], 0
  v_mov_b64 v[34:35], 0
  v_mov_b32 v68, 14880
  s_add_u32 s58, s58, 655360
  s_add_u32 s59, s59, 655360
  s_add_u32 s70, s70, 655360
  s_add_u32 s68, s68, 655360
  s_add_u32 s66, s66, 1
  s_xor_b32 s64, s64, 16384
  s_xor_b32 s65, s65, 16384
  s_cmp_eq_u32 s66, 62
  s_cselect_b64 s[16:17], s[20:21], s[16:17]
  s_cselect_b32 s18, (Cs1_done - Cs1_last), s18
  s_cselect_b32 s70, 0, s70
  s_cmp_eq_u32 s66, 63
  s_cselect_b32 s59, 268435456, s59
  s_cselect_b32 s58, 268435456, s58
  s_nop 15
  s_nop 13
  buffer_load_dwordx4 v[52:55], v76, s[8:11], s60 offen offset:0 sc1
  buffer_load_dwordx4 v[56:59], v76, s[8:11], s60 offen offset:1024 sc1
  s_waitcnt lgkmcnt(0)
  s_waitcnt vmcnt(1)
  v_mfma_f32_16x16x32_bf16 v[4:7], v[0:3], v[52:55], 0
  v_bitop3_b32 v72, v52, v54, s72 bitop3:0x7e
  s_waitcnt vmcnt(0)
  v_mfma_f32_16x16x32_bf16 v[4:7], v[0:3], v[56:59], v[4:7]
  v_bitop3_b32 v73, v56, v58, s72 bitop3:0x7e
  v_bitop3_b32 v72, v72, v73, 1 bitop3:0xa8
  v_cmp_ne_u32 vcc, 0, v72
  s_nop 0
  s_cmp_eq_u64 vcc, 0
  s_cselect_b32 s54, s62, 268435456
  s_nop 0
  v_add_f32_dpp v4, v4, v4 row_ror:4 row_mask:0xf bank_mask:0xf
  v_add_f32_dpp v5, v5, v5 row_ror:4 row_mask:0xf bank_mask:0xf
  s_nop 0
  v_add_f32_dpp v4, v4, v4 row_ror:8 row_mask:0xf bank_mask:0xf
  v_add_f32_dpp v5, v5, v5 row_ror:8 row_mask:0xf bank_mask:0xf
  v_cvt_pk_bf16_f32 v4, v4, v5
  buffer_store_dword v4, v69, s[8:11], s54 offen sc1
  s_cbranch_vccnz Cs1_h1r
  s_xor_b32 s62, s62, 16384
  buffer_store_dword v71, v69, s[8:11], s62 offen sc1
  s_xor_b32 s72, s72, 1
  s_branch Cs1_h2
Cs1_h1r:
  s_mov_b64 exec, vcc
  buffer_load_dwordx4 v[52:55], v76, s[8:11], s60 offen offset:0 sc1
  buffer_load_dwordx4 v[56:59], v76, s[8:11], s60 offen offset:1024 sc1
  s_mov_b64 exec, -1
  s_add_u32 s67, s67, 1
  s_waitcnt vmcnt(1)
  v_mfma_f32_16x16x32_bf16 v[4:7], v[0:3], v[52:55], 0
  v_bitop3_b32 v72, v52, v54, s72 bitop3:0x7e
  s_waitcnt vmcnt(0)
  v_mfma_f32_16x16x32_bf16 v[4:7], v[0:3], v[56:59], v[4:7]
  v_bitop3_b32 v73, v56, v58, s72 bitop3:0x7e
  v_bitop3_b32 v72, v72, v73, 1 bitop3:0xa8
  v_cmp_ne_u32 vcc, 0, v72
  s_cbranch_vccz Cs1_h1p
Cs1_h1s:
  s_mov_b64 exec, vcc
  buffer_load_dwordx4 v[52:55], v76, s[8:11], s60 offen offset:0 sc1
  buffer_load_dwordx4 v[56:59], v76, s[8:11], s60 offen offset:1024 sc1
  s_mov_b64 exec, -1
  s_add_u32 s67, s67, 1
  s_waitcnt vmcnt(1)
  v_mfma_f32_16x16x32_bf16 v[4:7], v[0:3], v[52:55], 0
  v_bitop3_b32 v72, v52, v54, s72 bitop3:0x7e
  s_waitcnt vmcnt(0)
  v_mfma_f32_16x16x32_bf16 v[4:7], v[0:3], v[56:59], v[4:7]
  v_bitop3_b32 v73, v56, v58, s72 bitop3:0x7e
  v_bitop3_b32 v72, v72, v73, 1 bitop3:0xa8
  v_cmp_ne_u32 vcc, 0, v72
  s_cbranch_vccz Cs1_h1p
  s_cmp_lt_u32 s67, 131072
  s_cbranch_scc1 Cs1_h1s
Cs1_h1p:
  s_nop 2
  v_add_f32_dpp v4, v4, v4 row_ror:4 row_mask:0xf bank_mask:0xf
  v_add_f32_dpp v5, v5, v5 row_ror:4 row_mask:0xf bank_mask:0xf
  s_nop 0
  v_add_f32_dpp v4, v4, v4 row_ror:8 row_mask:0xf bank_mask:0xf
  v_add_f32_dpp v5, v5, v5 row_ror:8 row_mask:0xf bank_mask:0xf
  v_cvt_pk_bf16_f32 v4, v4, v5
  buffer_store_dword v4, v69, s[8:11], s62 offen sc1
  s_xor_b32 s62, s62, 16384
  buffer_store_dword v71, v69, s[8:11], s62 offen sc1
  s_xor_b32 s72, s72, 1
  s_branch Cs1_h2
Cs1_h2r:
  s_mov_b64 exec, vcc
  buffer_load_dwordx4 v[8:11], v76, s[8:11], s65 offen offset:2048 sc1
  s_mov_b64 exec, -1
  s_add_u32 s67, s67, 1
  s_waitcnt vmcnt(4)
  v_max3_u32 v72, v8, v9, v10
  v_max_u32 v72, v72, v11
  ds_write_b128 v76, v[8:11] offset:6656
  v_cmp_eq_u32 vcc, -1, v72
  s_cbranch_vccz Cs1_h2w
  s_mov_b64 exec, vcc
  buffer_load_dwordx4 v[8:11], v76, s[8:11], s65 offen offset:2048 sc1
  s_mov_b64 exec, -1
  s_add_u32 s67, s67, 1
  s_waitcnt vmcnt(4)
  v_max3_u32 v72, v8, v9, v10
  v_max_u32 v72, v72, v11
  ds_write_b128 v76, v[8:11] offset:6656
  v_cmp_eq_u32 vcc, -1, v72
  s_cbranch_vccz Cs1_h2w
Cs1_h2s:
  s_mov_b64 exec, vcc
  buffer_load_dwordx4 v[8:11], v76, s[8:11], s65 offen offset:2048 sc1
  s_mov_b64 exec, -1
  s_add_u32 s67, s67, 1
  s_waitcnt vmcnt(2)
  v_max3_u32 v72, v8, v9, v10
  v_max_u32 v72, v72, v11
  ds_write_b128 v76, v[8:11] offset:6656
  v_cmp_eq_u32 vcc, -1, v72
  s_cbranch_vccz Cs1_h2w
  s_mov_b64 exec, vcc
  buffer_load_dwordx4 v[8:11], v76, s[8:11], s65 offen offset:2048 sc1
  s_mov_b64 exec, -1
  s_add_u32 s67, s67, 1
  s_waitcnt vmcnt(2)
  v_max3_u32 v72, v8, v9, v10
  v_max_u32 v72, v72, v11
  ds_write_b128 v76, v[8:11] offset:6656
  v_cmp_eq_u32 vcc, -1, v72
  s_cbranch_vccz Cs1_h2w
  s_mov_b64 exec, vcc
  buffer_load_dwordx4 v[8:11], v76, s[8:11], s65 offen offset:2048 sc1
  s_mov_b64 exec, -1
  s_add_u32 s67, s67, 1
  s_waitcnt vmcnt(2)
  v_max3_u32 v72, v8, v9, v10
  v_max_u32 v72, v72, v11
  ds_write_b128 v76, v[8:11] offset:6656
  v_cmp_eq_u32 vcc, -1, v72
  s_cbranch_vccz Cs1_h2w
  s_cmp_lt_u32 s67, 131072
  s_cbranch_scc1 Cs1_h2s
  s_branch Cs1_h2w
Cs1_rec:
  s_nop 7
  s_waitcnt vmcnt(0) lgkmcnt(0)
  v_max3_u32 v72, v0, v1, v2
  v_max3_u32 v72, v72, v3, v4
  v_max3_u32 v72, v72, v5, v6
  v_max3_u32 v72, v72, v7, v8
  v_max3_u32 v72, v72, v9, v10
  v_max3_u32 v72, v72, v11, v12
  v_max3_u32 v72, v72, v13, v14
  v_max3_u32 v72, v72, v15, v16
  v_max3_u32 v72, v72, v17, v18
  v_max_u32 v72, v72, v19
  v_cmp_eq_u32 vcc, -1, v72
  s_cbranch_vccz Cs1_recok
  s_barrier
  v_mov_b64 v[20:21], 0
  v_mov_b64 v[22:23], 0
  v_mov_b64 v[24:25], 0
  v_mov_b64 v[26:27], 0
  v_mov_b64 v[28:29], 0
  v_mov_b64 v[30:31], 0
  v_mov_b64 v[32:33], 0
  v_mov_b64 v[34:35], 0
  s_waitcnt lgkmcnt(0)
  s_barrier
  ds_read_b128 v[0:3], v76 offset:4608
  s_waitcnt lgkmcnt(0)
  v_smfmac_f32_16x16x64_bf16 v[20:23], v[0:3], v[80:87], v74
  v_smfmac_f32_16x16x64_bf16 v[24:27], v[0:3], v[88:95], v74
  ds_read_b128 v[60:63], v76 offset:20480
  ds_read_b128 v[64:67], v76 offset:21504
  s_waitcnt lgkmcnt(0)
  v_smfmac_f32_16x16x64_bf16 v[28:31], v[0:3], v[60:67], v74
  ds_read_b128 v[60:63], v76 offset:22528
  ds_read_b128 v[64:67], v76 offset:23552
  s_waitcnt lgkmcnt(0)
  v_smfmac_f32_16x16x64_bf16 v[32:35], v[0:3], v[60:67], v74
  ds_read_b128 v[4:7], v76 offset:5632
  s_waitcnt lgkmcnt(0)
  v_smfmac_f32_16x16x64_bf16 v[20:23], v[4:7], v[96:103], v74
  v_smfmac_f32_16x16x64_bf16 v[24:27], v[4:7], v[104:111], v74
  ds_read_b128 v[60:63], v76 offset:36864
  ds_read_b128 v[64:67], v76 offset:37888
  s_waitcnt lgkmcnt(0)
  v_smfmac_f32_16x16x64_bf16 v[28:31], v[4:7], v[60:67], v74
  ds_read_b128 v[60:63], v76 offset:38912
  ds_read_b128 v[64:67], v76 offset:39936
  s_waitcnt lgkmcnt(0)
  v_smfmac_f32_16x16x64_bf16 v[32:35], v[4:7], v[60:67], v74
  ds_read_b128 v[8:11], v76 offset:6656
  s_waitcnt lgkmcnt(0)
  v_smfmac_f32_16x16x64_bf16 v[20:23], v[8:11], v[112:119], v74
  v_smfmac_f32_16x16x64_bf16 v[24:27], v[8:11], v[120:127], v74
  v_smfmac_f32_16x16x64_bf16 v[28:31], v[8:11], v[208:215], v74
  v_smfmac_f32_16x16x64_bf16 v[32:35], v[8:11], v[216:223], v74
  ds_read_b128 v[12:15], v76 offset:7680
  s_waitcnt lgkmcnt(0)
  v_smfmac_f32_16x16x64_bf16 v[20:23], v[12:15], v[128:135], v74
  v_smfmac_f32_16x16x64_bf16 v[24:27], v[12:15], v[136:143], v74
  v_smfmac_f32_16x16x64_bf16 v[28:31], v[12:15], v[224:231], v74
  v_smfmac_f32_16x16x64_bf16 v[32:35], v[12:15], v[232:239], v74
  ds_read_b128 v[8:11], v76 offset:8704
  s_waitcnt lgkmcnt(0)
  v_smfmac_f32_16x16x64_bf16 v[20:23], v[8:11], v[144:151], v74
  v_smfmac_f32_16x16x64_bf16 v[24:27], v[8:11], v[152:159], v74
  ds_read_b128 v[60:63], v76 offset:53248
  ds_read_b128 v[64:67], v76 offset:54272
  s_waitcnt lgkmcnt(0)
  v_smfmac_f32_16x16x64_bf16 v[28:31], v[8:11], v[60:67], v74
  ds_read_b128 v[60:63], v76 offset:55296
  ds_read_b128 v[64:67], v76 offset:56320
  s_waitcnt lgkmcnt(0)
  v_smfmac_f32_16x16x64_bf16 v[32:35], v[8:11], v[60:67], v74
  ds_read_b128 v[0:3], v76 offset:9728
  s_waitcnt lgkmcnt(0)
  v_smfmac_f32_16x16x64_bf16 v[20:23], v[0:3], v[160:167], v74
  v_smfmac_f32_16x16x64_bf16 v[24:27], v[0:3], v[168:175], v74
  ds_read_b128 v[60:63], v75 offset:20480
  ds_read_b128 v[64:67], v75 offset:21504
  s_waitcnt lgkmcnt(0)
  v_smfmac_f32_16x16x64_bf16 v[28:31], v[0:3], v[60:67], v74
  ds_read_b128 v[60:63], v75 offset:22528
  ds_read_b128 v[64:67], v75 offset:23552
  s_waitcnt lgkmcnt(0)
  v_smfmac_f32_16x16x64_bf16 v[32:35], v[0:3], v[60:67], v74
  ds_read_b128 v[16:19], v76 offset:10752
  ds_read_b128 v[60:63], v75 offset:4096
  ds_read_b128 v[64:67], v75 offset:5120
  s_waitcnt lgkmcnt(0)
  v_smfmac_f32_16x16x64_bf16 v[20:23], v[16:19], v[60:67], v74
  ds_read_b128 v[60:63], v75 offset:6144
  ds_read_b128 v[64:67], v75 offset:7168
  s_waitcnt lgkmcnt(0)
  v_smfmac_f32_16x16x64_bf16 v[24:27], v[16:19], v[60:67], v74
  v_smfmac_f32_16x16x64_bf16 v[28:31], v[16:19], v[240:247], v74
  v_smfmac_f32_16x16x64_bf16 v[32:35], v[16:19], v[248:255], v74
  ds_read_b128 v[4:7], v76 offset:11776
  s_waitcnt lgkmcnt(0)
  v_smfmac_f32_16x16x64_bf16 v[20:23], v[4:7], v[176:183], v74
  v_smfmac_f32_16x16x64_bf16 v[24:27], v[4:7], v[184:191], v74
  v_smfmac_f32_16x16x64_bf16 v[28:31], v[4:7], a[0:7], v74
  v_smfmac_f32_16x16x64_bf16 v[32:35], v[4:7], a[8:15], v74
  ds_read_b128 v[12:15], v76 offset:12800
  s_waitcnt lgkmcnt(0)
  v_smfmac_f32_16x16x64_bf16 v[20:23], v[12:15], v[192:199], v74
  v_smfmac_f32_16x16x64_bf16 v[24:27], v[12:15], v[200:207], v74
  v_smfmac_f32_16x16x64_bf16 v[28:31], v[12:15], a[16:23], v74
  v_smfmac_f32_16x16x64_bf16 v[32:35], v[12:15], a[24:31], v74
  v_add_f32 v20, v20, v22
  v_add_f32 v21, v21, v23
  v_add_f32 v24, v24, v26
  v_cvt_pk_bf16_f32 v22, v20, v24
  s_nop 0
  ds_write_b32 v79, v22 offset:0
  v_add_f32 v25, v25, v27
  v_cvt_pk_bf16_f32 v23, v21, v25
  ds_write_b32 v79, v23 offset:576
  v_add_f32 v28, v28, v30
  v_add_f32 v29, v29, v31
  s_waitcnt lgkmcnt(0)
  s_nop 1
  s_branch Cs1_recok
Cs1_mx:
  s_waitcnt lgkmcnt(0)
  s_barrier
  buffer_load_dwordx4 v[0:3], v76, s[8:11], s58 offen offset:0 sc1
  ds_read_b128 v[20:23], v77 offset:0
  ds_read_b128 v[28:31], v77 offset:256
  buffer_load_dwordx4 v[4:7], v76, s[8:11], s58 offen offset:1024 sc1
  ds_read_b128 v[24:27], v77 offset:128
  ds_read_b128 v[32:35], v77 offset:384
  s_waitcnt vmcnt(1) lgkmcnt(3)
  v_mfma_f32_16x16x32_bf16 v[8:11], v[0:3], v[20:23], 0
  s_waitcnt vmcnt(0) lgkmcnt(1)
  v_mfma_f32_16x16x32_bf16 v[8:11], v[4:7], v[24:27], v[8:11]
  v_mfma_f32_16x16x32_bf16 v[12:15], v[28:31], v[20:23], 0
  s_waitcnt lgkmcnt(0)
  v_mfma_f32_16x16x32_bf16 v[12:15], v[32:35], v[24:27], v[12:15]
  v_add_f32_dpp v8, v10, v8 quad_perm:[2,3,0,1] row_mask:0xf bank_mask:0xf
  v_add_f32_dpp v9, v11, v9 quad_perm:[2,3,0,1] row_mask:0xf bank_mask:0xf
  s_nop 0
  v_mov_b32_dpp v8, v8 quad_perm:[0,1,0,1] row_mask:0xf bank_mask:0xf
  v_mov_b32_dpp v9, v9 quad_perm:[0,1,0,1] row_mask:0xf bank_mask:0xf
  s_nop 1
  v_add_f32_dpp v12, v14, v12 quad_perm:[2,3,0,1] row_mask:0xf bank_mask:0xf
  v_add_f32_dpp v13, v15, v13 quad_perm:[2,3,0,1] row_mask:0xf bank_mask:0xf
  s_nop 0
  v_mov_b32_dpp v12, v12 quad_perm:[0,1,0,1] row_mask:0xf bank_mask:0xf
  v_mov_b32_dpp v13, v13 quad_perm:[0,1,0,1] row_mask:0xf bank_mask:0xf
  v_mul_f32 v12, s69, v12
  ds_write_b32 v78, v8 offset:8708
  v_mul_f32 v13, s69, v13
  ds_write_b32 v78, v9 offset:8772
  s_waitcnt lgkmcnt(0)
  s_barrier
  ds_read_b128 v[36:39], v78 offset:8704
  ds_read_b128 v[40:43], v78 offset:8768
  s_waitcnt lgkmcnt(0)
  s_barrier
  v_max_f32 v16, v36, v37
  v_max3_f32 v16, v16, v38, v39
  v_max3_f32 v16, v16, v40, v41
  v_max3_f32 v16, v16, v42, v43
  v_max3_f32 v16, v16, v12, v13
  v_mov_b32 v17, v16
  s_nop 1
  v_permlane16_swap_b32 v16, v17
  v_max_f32 v16, v16, v17
  v_mov_b32 v17, v16
  s_nop 1
  v_permlane32_swap_b32 v16, v17
  v_max_f32 v16, v16, v17
  v_sub_f32 v36, v36, v16
  v_sub_f32 v37, v37, v16
  v_sub_f32 v38, v38, v16
  v_sub_f32 v39, v39, v16
  v_sub_f32 v40, v40, v16
  v_sub_f32 v41, v41, v16
  v_sub_f32 v42, v42, v16
  v_sub_f32 v43, v43, v16
  v_sub_f32 v12, v12, v16
  v_sub_f32 v13, v13, v16
  v_exp_f32 v36, v36
  v_exp_f32 v37, v37
  v_exp_f32 v38, v38
  v_exp_f32 v39, v39
  v_exp_f32 v40, v40
  v_exp_f32 v41, v41
  v_exp_f32 v42, v42
  v_exp_f32 v43, v43
  v_exp_f32 v12, v12
  v_exp_f32 v13, v13
  v_cvt_pk_bf16_f32 v32, v36, v40
  v_cvt_pk_bf16_f32 v33, v37, v41
  v_cvt_pk_bf16_f32 v34, v38, v42
  v_cvt_pk_bf16_f32 v35, v39, v43
  v_cvt_pk_bf16_f32 v28, v12, v13
  v_cvt_pk_bf16_f32 v31, v12, v13
  v_mov_b32 v29, 0
  v_mov_b32 v30, 0
  v_mov_b32 v68, 0x3f803f80
  v_mov_b32 v69, 0x3f803f80
  v_mov_b32 v70, 0x3f803f80
  v_mov_b32 v71, 0x3f803f80
  s_nop 1
  v_mfma_f32_16x16x32_bf16 v[8:11], v[32:35], v[68:71], 0
  v_mfma_f32_16x16x32_bf16 v[0:3], v[32:35], v[52:55], 0
  v_mfma_f32_16x16x32_bf16 v[4:7], v[32:35], v[56:59], 0
  v_mfma_f32_16x16x16_bf16 v[8:11], v[28:29], v[68:69], v[8:11]
  v_mfma_f32_16x16x16_bf16 v[0:3], v[28:29], v[72:73], v[0:3]
  v_mfma_f32_16x16x16_bf16 v[4:7], v[30:31], v[72:73], v[4:7]
  ds_read_b128 v[68:71], v76 offset:13824
  v_rcp_f32 v10, v8
  v_rcp_f32 v11, v9
  v_mul_f32 v0, v10, v0
  v_mul_f32 v1, v11, v1
  s_nop 0
  v_mul_f32 v4, v10, v4
  v_mul_f32 v5, v11, v5
  v_cvt_pk_bf16_f32 v2, v0, v4
  ds_write_b32 v79, v2 offset:8704
  v_cvt_pk_bf16_f32 v3, v1, v5
  ds_write_b32 v79, v3 offset:9280
  v_mov_b64 v[16:17], 0
  v_mov_b64 v[18:19], 0
  v_mov_b64 v[20:21], 0
  v_mov_b64 v[22:23], 0
  v_mov_b64 v[24:25], 0
  v_mov_b64 v[26:27], 0
  s_branch Cs1_mxok
Cs1_last:
  ds_read_b128 v[4:7], v76 offset:5632
  ds_read_b128 v[12:15], v76 offset:7680
  ds_read_b128 v[44:47], v76 offset:36864
  ds_read_b128 v[48:51], v76 offset:37888
  s_nop 5
  v_mov_b64 v[20:21], 0
  v_mov_b64 v[22:23], 0
  v_mov_b64 v[24:25], 0
  v_mov_b64 v[26:27], 0
  s_waitcnt lgkmcnt(4)
  v_smfmac_f32_16x16x64_bf16 v[28:31], v[0:3], v[36:43], v74
  ds_read_b128 v[36:39], v76 offset:38912
  ds_read_b128 v[40:43], v76 offset:39936
  v_smfmac_f32_16x16x64_bf16 v[32:35], v[0:3], v[60:67], v74
  s_waitcnt lgkmcnt(5)
  v_smfmac_f32_16x16x64_bf16 v[20:23], v[0:3], a[32:39], v74
  ds_read_b128 v[60:63], v76 offset:53248
  ds_read_b128 v[64:67], v76 offset:54272
  v_smfmac_f32_16x16x64_bf16 v[24:27], v[0:3], a[40:47], v74
  s_waitcnt lgkmcnt(4)
  v_smfmac_f32_16x16x64_bf16 v[20:23], v[4:7], a[48:55], v74
  buffer_store_dwordx4 v[16:19], v76, s[8:11], s68 offen sc1
  v_smfmac_f32_16x16x64_bf16 v[24:27], v[4:7], a[56:63], v74
  v_smfmac_f32_16x16x64_bf16 v[28:31], v[4:7], v[44:51], v74
  s_waitcnt lgkmcnt(2)
  v_smfmac_f32_16x16x64_bf16 v[20:23], v[8:11], a[64:71], v74
  ds_read_b128 v[44:47], v76 offset:55296
  ds_read_b128 v[48:51], v76 offset:56320
  v_smfmac_f32_16x16x64_bf16 v[24:27], v[8:11], a[72:79], v74
  v_smfmac_f32_16x16x64_bf16 v[32:35], v[4:7], v[36:43], v74
  v_smfmac_f32_16x16x64_bf16 v[28:31], v[8:11], v[208:215], v74
  ds_read_b128 v[36:39], v75 offset:20480
  ds_read_b128 v[40:43], v75 offset:21504
  v_smfmac_f32_16x16x64_bf16 v[32:35], v[8:11], v[216:223], v74
  v_smfmac_f32_16x16x64_bf16 v[20:23], v[12:15], a[80:87], v74
  v_smfmac_f32_16x16x64_bf16 v[24:27], v[12:15], a[88:95], v74
  v_smfmac_f32_16x16x64_bf16 v[28:31], v[12:15], v[224:231], v74
  v_smfmac_f32_16x16x64_bf16 v[32:35], v[12:15], v[232:239], v74
  s_waitcnt vmcnt(2)
  s_waitcnt vmcnt(1)
  s_barrier
Cs1_lastr:
  ds_read_b128 v[8:11], v76 offset:8704
  ds_read_b128 v[0:3], v76 offset:9728
  ds_read_b128 v[16:19], v76 offset:10752
  ds_read_b128 v[4:7], v76 offset:11776
  ds_read_b128 v[12:15], v76 offset:12800
  s_waitcnt lgkmcnt(3)
  v_max3_u32 v72, v0, v1, v2
  s_waitcnt lgkmcnt(1)
  v_max3_u32 v72, v72, v3, v4
  v_max3_u32 v72, v72, v5, v6
  v_max3_u32 v72, v72, v7, v8
  v_max3_u32 v72, v72, v9, v10
  s_waitcnt lgkmcnt(0)
  v_max3_u32 v72, v72, v11, v12
  v_max3_u32 v72, v72, v13, v14
  v_max3_u32 v72, v72, v15, v16
  v_max3_u32 v72, v72, v17, v18
  v_max_u32 v72, v72, v19
  v_cmp_eq_u32 vcc, -1, v72
  s_cbranch_vccnz Cs1_lastp
Cs1_lastg:
  v_smfmac_f32_16x16x64_bf16 v[28:31], v[8:11], v[60:67], v74
  ds_read_b128 v[60:63], v75 offset:22528
  ds_read_b128 v[64:67], v75 offset:23552
  v_smfmac_f32_16x16x64_bf16 v[32:35], v[8:11], v[44:51], v74
  v_smfmac_f32_16x16x64_bf16 v[28:31], v[0:3], v[36:43], v74
  v_smfmac_f32_16x16x64_bf16 v[28:31], v[16:19], v[240:247], v74
  v_smfmac_f32_16x16x64_bf16 v[28:31], v[4:7], a[0:7], v74
  v_smfmac_f32_16x16x64_bf16 v[28:31], v[12:15], a[16:23], v74
  v_smfmac_f32_16x16x64_bf16 v[32:35], v[16:19], v[248:255], v74
  v_smfmac_f32_16x16x64_bf16 v[32:35], v[4:7], a[8:15], v74
  s_waitcnt lgkmcnt(0)
  v_smfmac_f32_16x16x64_bf16 v[32:35], v[12:15], a[24:31], v74
  v_smfmac_f32_16x16x64_bf16 v[32:35], v[0:3], v[60:67], v74
  v_smfmac_f32_16x16x64_bf16 v[20:23], v[8:11], a[96:103], v74
  v_smfmac_f32_16x16x64_bf16 v[20:23], v[0:3], a[112:119], v74
  v_add_f32 v28, v28, v30
  v_add_f32 v32, v32, v34
  v_cvt_pk_bf16_f32 v30, v28, v32
  v_smfmac_f32_16x16x64_bf16 v[20:23], v[16:19], a[128:135], v74
  ds_write_b32 v79, v30 offset:256
  v_add_f32 v29, v29, v31
  v_add_f32 v33, v33, v35
  v_cvt_pk_bf16_f32 v31, v29, v33
  v_smfmac_f32_16x16x64_bf16 v[20:23], v[4:7], a[144:151], v74
  ds_write_b32 v79, v31 offset:832
  v_smfmac_f32_16x16x64_bf16 v[20:23], v[12:15], a[160:167], v74
  v_smfmac_f32_16x16x64_bf16 v[24:27], v[8:11], a[104:111], v74
  v_smfmac_f32_16x16x64_bf16 v[24:27], v[0:3], a[120:127], v74
  v_smfmac_f32_16x16x64_bf16 v[24:27], v[16:19], a[136:143], v74
  s_waitcnt lgkmcnt(0)
  s_barrier
  ds_read_b64 v[52:53], v77 offset:264
  v_add_f32 v20, v20, v22
  v_smfmac_f32_16x16x64_bf16 v[24:27], v[4:7], a[152:159], v74
  v_add_f32 v21, v21, v23
  v_smfmac_f32_16x16x64_bf16 v[24:27], v[12:15], a[168:175], v74
  v_cvt_pk_bf16_f32 v54, v20, v21
  s_add_u32 s68, s68, 655360
  s_nop 3
  v_add_f32 v24, v24, v26
  v_add_f32 v25, v25, v27
  v_cvt_pk_bf16_f32 v55, v24, v25
  s_waitcnt lgkmcnt(0)
  buffer_store_dwordx4 v[52:55], v76, s[8:11], s68 offen sc1
  s_branch Cs1_done
Cs1_lastp:
  s_add_u32 s72, s72, 2
  s_cmp_ge_u32 s72, 131072
  s_cbranch_scc1 Cs1_lastg
  s_barrier
  buffer_load_dwordx4 v76, s[8:11], s55 offen offset:0 sc1 lds
  s_waitcnt vmcnt(0)
  s_barrier
  s_branch Cs1_lastr
Cs1_done:
  s_branch L_cexit
L_w6:
  v_mov_b64 v[20:21], 0
  v_mov_b64 v[22:23], 0
  v_mov_b64 v[24:25], 0
  v_mov_b64 v[26:27], 0
  v_mov_b64 v[28:29], 0
  v_mov_b64 v[30:31], 0
  v_mov_b64 v[32:33], 0
  v_mov_b64 v[34:35], 0
  s_mov_b32 s78, 0x3f803f80
  s_mov_b32 s79, s78
  s_mov_b32 s65, 360448
  s_mov_b32 m0, 15872
  s_lshl_b32 s71, s53, 2
  s_add_u32 s71, s71, 128
  s_movk_i32 s56, 0x1000
  v_lshlrev_b32 v73, 2, v76
  v_mov_b32 v72, 0
  s_mov_b64 s[16:17], s[8:9]
  s_mov_b32 s18, 268435456
  s_mov_b32 s19, 0x20000
  s_getpc_b64 s[20:21]
Cs2_pc:
  s_add_u32 s20, s20, (Cs2_last - Cs2_pc)
  s_addc_u32 s21, s21, 0
  v_mov_b32 v68, 14880
  buffer_load_dwordx4 v[52:55], v76, s[8:11], s59 offen offset:0 sc1
  buffer_load_dwordx4 v[56:59], v76, s[8:11], s59 offen offset:1024 sc1
  ds_read_b128 v[36:39], v76 offset:24576
  ds_read_b128 v[40:43], v76 offset:25600
  ds_read_b128 v[60:63], v76 offset:26624
  ds_read_b128 v[64:67], v76 offset:27648
  ds_read_b128 v[0:3], v76 offset:4608
  ds_read_b128 v[4:7], v76 offset:5632
  ds_read_b128 v[8:11], v76 offset:6656
  ds_read_b128 v[12:15], v76 offset:7680
  s_waitcnt lgkmcnt(0)
  s_cmp_eq_u32 s66, 1
  s_branch Cs2_top2
.p2align 6
Cs2_h2:
  v_lshlrev_b32 v73, 2, v76
  s_mov_b32 m0, 12800
  s_add_u32 s55, s65, 8192
  s_nop 3
  buffer_load_dwordx4 v[12:15], v76, s[8:11], s65 offen offset:3072 sc1
  s_nop 15
  s_nop 3
  buffer_load_dwordx4 v[12:15], v76, s[8:11], s65 offen offset:3072 sc1
  s_nop 15
  s_nop 3
  buffer_load_dwordx4 v[12:15], v76, s[8:11], s65 offen offset:3072 sc1
  s_waitcnt vmcnt(5)
  ds_read_b128 v[36:39], v76 offset:24576
  ds_read_b128 v[40:43], v76 offset:25600
  ds_read_b128 v[60:63], v76 offset:26624
  ds_read_b128 v[64:67], v76 offset:27648
  buffer_load_dwordx4 v[52:55], v76, s[8:11], s59 offen offset:0 sc1
  buffer_load_dwordx4 v[56:59], v76, s[8:11], s59 offen offset:1024 sc1
  s_waitcnt vmcnt(4)
  v_max3_u32 v72, v12, v13, v14
  v_max_u32 v72, v72, v15
  ds_write_b128 v76, v[12:15] offset:7680
  v_cmp_eq_u32 vcc, -1, v72
  s_cbranch_vccnz Cs2_h2r
Cs2_h2w:
  s_cmp_eq_u32 s66, 63
  s_waitcnt lgkmcnt(0)
  s_barrier
  ds_read_b128 v[0:3], v76 offset:4608
  buffer_load_dwordx4 v76, s[8:11], s55 offen offset:0 sc1 lds
Cs2_top2:
  v_smfmac_f32_16x16x64_bf16 v[20:23], v[12:15], v[128:135], v74
  s_cbranch_scc1 Cs2_last
  v_smfmac_f32_16x16x64_bf16 v[24:27], v[12:15], v[136:143], v74
  buffer_load_dwordx4 v[44:47], v76, s[8:11], s58 offen offset:0 sc1
  s_mov_b32 m0, 15872
  v_smfmac_f32_16x16x64_bf16 v[28:31], v[12:15], v[224:231], v74
  buffer_load_dwordx4 v[48:51], v76, s[8:11], s58 offen offset:1024 sc1
  v_smfmac_f32_16x16x64_bf16 v[32:35], v[12:15], v[232:239], v74
  ds_read_b128 v[4:7], v76 offset:5632
  s_waitcnt lgkmcnt(1)
  v_smfmac_f32_16x16x64_bf16 v[20:23], v[0:3], v[80:87], v74
  ds_read_b128 v[8:11], v76 offset:6656
  v_smfmac_f32_16x16x64_bf16 v[28:31], v[0:3], v[36:43], v74
  ds_read_b128 v[36:39], v76 offset:40960
  v_smfmac_f32_16x16x64_bf16 v[24:27], v[0:3], v[88:95], v74
  buffer_store_dwordx4 v[16:19], v76, s[8:11], s68 offen sc1
  ds_read_b128 v[40:43], v76 offset:41984
  v_smfmac_f32_16x16x64_bf16 v[32:35], v[0:3], v[60:67], v74
  ds_read_b128 v[60:63], v76 offset:43008
  s_waitcnt lgkmcnt(4)
  v_smfmac_f32_16x16x64_bf16 v[20:23], v[4:7], v[96:103], v74
  ds_read_b128 v[64:67], v76 offset:44032
  v_smfmac_f32_16x16x64_bf16 v[24:27], v[4:7], v[104:111], v74
  buffer_load_dword v73, s[16:19], s70 offen lds
  s_waitcnt vmcnt(5)
  s_waitcnt lgkmcnt(4)
  v_smfmac_f32_16x16x64_bf16 v[20:23], v[8:11], v[112:119], v74
  s_barrier
  s_waitcnt lgkmcnt(2)
  v_smfmac_f32_16x16x64_bf16 v[28:31], v[4:7], v[36:43], v74
  ds_read_b128 v[12:15], v76 offset:8704
  v_smfmac_f32_16x16x64_bf16 v[24:27], v[8:11], v[120:127], v74
  ds_read_b128 v[36:39], v76 offset:57344
  s_waitcnt lgkmcnt(2)
  v_smfmac_f32_16x16x64_bf16 v[32:35], v[4:7], v[60:67], v74
  ds_read_b128 v[40:43], v76 offset:58368
  v_smfmac_f32_16x16x64_bf16 v[28:31], v[8:11], v[208:215], v74
  ds_read_b128 v[60:63], v76 offset:59392
  v_smfmac_f32_16x16x64_bf16 v[32:35], v[8:11], v[216:223], v74
  ds_read_b128 v[64:67], v76 offset:60416
  s_waitcnt lgkmcnt(4)
  v_smfmac_f32_16x16x64_bf16 v[20:23], v[12:15], v[144:151], v74
  s_waitcnt vmcnt(4)
  ds_read_b128 v[0:3], v76 offset:9728
  s_waitcnt lgkmcnt(3)
  v_smfmac_f32_16x16x64_bf16 v[28:31], v[12:15], v[36:43], v74
  s_barrier
  ds_read_b128 v[4:7], v76 offset:11776
  v_smfmac_f32_16x16x64_bf16 v[24:27], v[12:15], v[152:159], v74
  ds_read_b128 v[36:39], v75 offset:8192
  ds_read_b128 v[40:43], v75 offset:9216
  s_waitcnt lgkmcnt(4)
  v_smfmac_f32_16x16x64_bf16 v[32:35], v[12:15], v[60:67], v74
  ds_read_b128 v[16:19], v76 offset:10752
  s_waitcnt lgkmcnt(4)
  v_smfmac_f32_16x16x64_bf16 v[20:23], v[0:3], v[160:167], v74
  ds_read_b128 v[8:11], v76 offset:12800
  v_smfmac_f32_16x16x64_bf16 v[24:27], v[0:3], v[168:175], v74
  ds_read_b128 v[60:63], v75 offset:10240
  ds_read_b128 v[64:67], v75 offset:11264
  s_waitcnt lgkmcnt(6)
  v_smfmac_f32_16x16x64_bf16 v[20:23], v[4:7], v[176:183], v74
  s_waitcnt lgkmcnt(3)
  v_smfmac_f32_16x16x64_bf16 v[20:23], v[16:19], v[36:43], v74
  ds_read_b128 v[36:39], v75 offset:24576
  s_waitcnt lgkmcnt(3)
  v_smfmac_f32_16x16x64_bf16 v[20:23], v[8:11], v[192:199], v74
  ds_read_b128 v[40:43], v75 offset:25600
  s_waitcnt lgkmcnt(2)
  v_smfmac_f32_16x16x64_bf16 v[24:27], v[16:19], v[60:67], v74
  ds_read_b128 v[60:63], v75 offset:26624
  v_smfmac_f32_16x16x64_bf16 v[24:27], v[4:7], v[184:191], v74
  ds_read_b128 v[64:67], v75 offset:27648
  v_add_f32 v20, v20, v22
  v_smfmac_f32_16x16x64_bf16 v[24:27], v[8:11], v[200:207], v74
  v_add_f32 v21, v21, v23
  v_smfmac_f32_16x16x64_bf16 v[28:31], v[16:19], v[240:247], v74
  s_waitcnt lgkmcnt(2)
  v_mov_b64 v[70:71], s[78:79]
  v_smfmac_f32_16x16x64_bf16 v[28:31], v[0:3], v[36:43], v74
  ds_read_b128 v[36:39], v68
  v_add_f32 v24, v24, v26
  v_smfmac_f32_16x16x64_bf16 v[28:31], v[4:7], a[0:7], v74
  ds_read_b128 v[40:43], v68
  v_cvt_pk_bf16_f32 v22, v20, v24
  v_smfmac_f32_16x16x64_bf16 v[28:31], v[8:11], a[16:23], v74
  ds_write_b32 v79, v22 offset:0
  s_waitcnt lgkmcnt(3)
  v_add_f32 v25, v25, v27
  v_cvt_pk_bf16_f32 v23, v21, v25
  v_smfmac_f32_16x16x64_bf16 v[32:35], v[0:3], v[60:67], v74
  ds_write_b32 v79, v23 offset:576
  v_cmp_u_f32 vcc, v20, v21
  v_smfmac_f32_16x16x64_bf16 v[32:35], v[16:19], v[248:255], v74
  v_add_f32 v28, v28, v30
  v_smfmac_f32_16x16x64_bf16 v[32:35], v[4:7], a[8:15], v74
  v_add_f32 v29, v29, v31
  v_smfmac_f32_16x16x64_bf16 v[32:35], v[8:11], a[24:31], v74
  s_cbranch_vccnz Cs2_rec
Cs2_recok:
  s_waitcnt lgkmcnt(3)
  v_smfmac_f32_16x16x64_bf16 v[36:39], v[16:19], a[128:135], v74
  s_waitcnt lgkmcnt(0)
  s_barrier
  ds_read_b128 v[60:63], v77
  v_smfmac_f32_16x16x64_bf16 v[40:43], v[16:19], a[136:143], v74
  ds_read_b128 v[64:67], v77 offset:128
  v_add_f32 v32, v32, v34
  v_cvt_pk_bf16_f32 v30, v28, v32
  v_smfmac_f32_16x16x64_bf16 v[36:39], v[0:3], a[112:119], v74
  ds_write_b32 v79, v30 offset:256
  v_add_f32 v33, v33, v35
  v_cvt_pk_bf16_f32 v31, v29, v33
  v_smfmac_f32_16x16x64_bf16 v[40:43], v[0:3], a[120:127], v74
  ds_write_b32 v79, v31 offset:832
  v_xor_b32 v75, 0x8000, v75
  v_smfmac_f32_16x16x64_bf16 v[36:39], v[4:7], a[144:151], v74
  ds_read_b128 v[0:3], v76 offset:4608
  v_mov_b32 v29, 0
  v_smfmac_f32_16x16x64_bf16 v[40:43], v[4:7], a[152:159], v74
  s_waitcnt vmcnt(2) lgkmcnt(3)
  v_mov_b32 v30, 0
  v_mfma_f32_16x16x32_bf16 v[44:47], v[44:47], v[60:63], 0
  ds_read_b128 v[4:7], v76 offset:5632
  s_waitcnt lgkmcnt(2)
  v_mfma_f32_16x16x32_bf16 v[44:47], v[48:51], v[64:67], v[44:47]
  s_barrier
  v_smfmac_f32_16x16x64_bf16 v[36:39], v[8:11], a[160:167], v74
  ds_read_b128 v[20:23], v77 offset:256
  ds_read_b128 v[24:27], v77 offset:384
  v_smfmac_f32_16x16x64_bf16 v[40:43], v[8:11], a[168:175], v74
  ds_read_b128 v[8:11], v76 offset:6656
  v_add_f32_dpp v72, v46, v44 quad_perm:[2,3,0,1] row_mask:0xf bank_mask:0xf
  v_add_f32_dpp v73, v47, v45 quad_perm:[2,3,0,1] row_mask:0xf bank_mask:0xf
  v_smfmac_f32_16x16x64_bf16 v[36:39], v[12:15], a[96:103], v74
  s_waitcnt lgkmcnt(4)
  v_exp_f32_dpp v72, v72 quad_perm:[0,1,0,1] row_mask:0xf bank_mask:0xf
  v_smfmac_f32_16x16x64_bf16 v[40:43], v[12:15], a[104:111], v74
  ds_read_b128 v[12:15], v76 offset:7680
  v_exp_f32_dpp v73, v73 quad_perm:[0,1,0,1] row_mask:0xf bank_mask:0xf
  v_smfmac_f32_16x16x64_bf16 v[36:39], v[0:3], a[32:39], v74
  s_waitcnt lgkmcnt(2)
  v_cvt_pk_bf16_f32 v72, v72, v73
  v_mfma_f32_16x16x32_bf16 v[20:23], v[20:23], v[60:63], 0
  ds_write_b32 v78, v72 offset:520
  v_mov_b64 v[16:17], 0
  v_mfma_f32_16x16x32_bf16 v[20:23], v[24:27], v[64:67], v[20:23]
  ds_read_b128 v[44:47], v75 offset:24576
  v_mov_b64 v[18:19], 0
  v_smfmac_f32_16x16x64_bf16 v[40:43], v[0:3], a[40:47], v74
  ds_read_b128 v[48:51], v75 offset:25600
  v_mov_b64 v[68:69], s[78:79]
  v_smfmac_f32_16x16x64_bf16 v[36:39], v[4:7], a[48:55], v74
  s_waitcnt lgkmcnt(4)
  v_add_f32_dpp v24, v22, v20 quad_perm:[2,3,0,1] row_mask:0xf bank_mask:0xf
  v_add_f32_dpp v25, v23, v21 quad_perm:[2,3,0,1] row_mask:0xf bank_mask:0xf
  v_smfmac_f32_16x16x64_bf16 v[36:39], v[8:11], a[64:71], v74
  s_waitcnt lgkmcnt(2)
  s_barrier
  ds_read_b128 v[32:35], v78 offset:512
  v_smfmac_f32_16x16x64_bf16 v[36:39], v[12:15], a[80:87], v74
  ds_read_b128 v[60:63], v75 offset:26624
  v_mul_f32 v24, s69, v24
  v_smfmac_f32_16x16x64_bf16 v[40:43], v[4:7], a[56:63], v74
  ds_read_b128 v[64:67], v75 offset:27648
  v_mul_f32 v25, s69, v25
  v_smfmac_f32_16x16x64_bf16 v[40:43], v[8:11], a[72:79], v74
  v_exp_f32_dpp v24, v24 quad_perm:[0,1,0,1] row_mask:0xf bank_mask:0xf
  v_smfmac_f32_16x16x64_bf16 v[40:43], v[12:15], a[88:95], v74
  s_waitcnt lgkmcnt(2)
  v_exp_f32_dpp v25, v25 quad_perm:[0,1,0,1] row_mask:0xf bank_mask:0xf
  v_mfma_f32_16x16x32_bf16 v[8:11], v[32:35], v[68:71], 0
  v_add_f32 v36, v36, v38
  v_add_f32 v37, v37, v39
  v_mfma_f32_16x16x32_bf16 v[0:3], v[32:35], v[52:55], 0
  v_add_f32 v40, v40, v42
  v_add_f32 v41, v41, v43
  v_mfma_f32_16x16x32_bf16 v[4:7], v[32:35], v[56:59], 0
  v_cvt_pk_bf16_f32 v28, v24, v25
  v_cvt_pk_bf16_f32 v72, v36, v37
  v_cvt_pk_bf16_f32 v73, v40, v41
  v_mfma_f32_16x16x16_bf16 v[8:11], v[28:29], v[68:69], v[8:11]
  v_cvt_pk_bf16_f32 v31, v24, v25
  v_mov_b64 v[20:21], 0
  v_mfma_f32_16x16x16_bf16 v[0:3], v[28:29], v[72:73], v[0:3]
  ds_read_b128 v[68:71], v76 offset:13824
  v_mov_b64 v[22:23], 0
  v_mfma_f32_16x16x16_bf16 v[4:7], v[30:31], v[72:73], v[4:7]
  v_rcp_f32 v10, v8
  v_rcp_f32 v11, v9
  v_mul_f32 v0, v10, v0
  v_mul_f32 v1, v11, v1
  s_nop 0
  v_mul_f32 v4, v10, v4
  v_mul_f32 v5, v11, v5
  v_cvt_pk_bf16_f32 v2, v0, v4
  ds_write_b32 v79, v2 offset:8704
  v_cvt_pk_bf16_f32 v3, v1, v5
  ds_write_b32 v79, v3 offset:9280
  v_max3_f32 v8, v8, v9, v10
  v_max_f32 v8, v8, v11
  v_cmp_le_f32 vcc, 1317011456, v8
  v_mov_b64 v[24:25], 0
  v_mov_b64 v[26:27], 0
  s_cbranch_vccnz Cs2_mx
Cs2_mxok:
  s_waitcnt lgkmcnt(0)
  s_barrier
  ds_read_b128 v[0:3], v78 offset:8704
  ds_read_b128 v[4:7], v78 offset:8768
  ds_read_b128 v[8:11], v78 offset:8832
  ds_read_b128 v[12:15], v78 offset:8896
  s_waitcnt lgkmcnt(3)
  v_smfmac_f32_16x16x64_bf16 v[16:19], v[0:3], v[44:51], v74
  ds_read_b128 v[52:55], v75 offset:40960
  s_waitcnt lgkmcnt(3)
  v_smfmac_f32_16x16x64_bf16 v[16:19], v[4:7], v[60:67], v74
  ds_read_b128 v[56:59], v75 offset:41984
  s_waitcnt lgkmcnt(3)
  v_smfmac_f32_16x16x64_bf16 v[16:19], v[8:11], a[176:183], v74
  ds_read_b128 v[36:39], v75 offset:43008
  s_waitcnt lgkmcnt(3)
  v_smfmac_f32_16x16x64_bf16 v[16:19], v[12:15], a[184:191], v74
  ds_read_b128 v[40:43], v75 offset:44032
  ds_read_b128 v[44:47], v75 offset:57344
  v_smfmac_f32_16x16x64_bf16 v[20:23], v[0:3], a[192:199], v74
  ds_read_b128 v[48:51], v75 offset:58368
  ds_read_b128 v[60:63], v75 offset:59392
  v_smfmac_f32_16x16x64_bf16 v[20:23], v[4:7], a[200:207], v74
  ds_read_b128 v[64:67], v75 offset:60416
  s_waitcnt lgkmcnt(6)
  v_cvt_pk_bf16_f32 v16, v16, v17
  v_cvt_pk_bf16_f32 v17, v18, v19
  v_bfi_b32 v16, 1, s72, v16
  v_smfmac_f32_16x16x64_bf16 v[20:23], v[8:11], v[52:59], v74
  buffer_store_dwordx2 v[16:17], v68, s[8:11], s73 offen sc1
  s_waitcnt lgkmcnt(4)
  v_smfmac_f32_16x16x64_bf16 v[20:23], v[12:15], v[36:43], v74
  ds_read_b128 v[52:55], v75 offset:0
  v_mov_b64 v[32:33], 0
  v_smfmac_f32_16x16x64_bf16 v[24:27], v[0:3], a[208:215], v74
  ds_read_b128 v[56:59], v75 offset:1024
  v_mov_b64 v[34:35], 0
  v_smfmac_f32_16x16x64_bf16 v[24:27], v[4:7], a[216:223], v74
  ds_read_b128 v[36:39], v75 offset:2048
  s_waitcnt lgkmcnt(5)
  v_cvt_pk_bf16_f32 v20, v20, v21
  v_cvt_pk_bf16_f32 v21, v22, v23
  v_bfi_b32 v20, 1, s72, v20
  v_smfmac_f32_16x16x64_bf16 v[24:27], v[8:11], v[44:51], v74
  buffer_store_dwordx2 v[20:21], v68, s[8:11], s74 offen sc1
  s_waitcnt lgkmcnt(3)
  v_smfmac_f32_16x16x64_bf16 v[24:27], v[12:15], v[60:67], v74
  ds_read_b128 v[40:43], v75 offset:3072
  v_mov_b64 v[28:29], 0
  v_smfmac_f32_16x16x64_bf16 v[32:35], v[0:3], a[224:231], v74
  ds_read_b128 v[44:47], v75 offset:4096
  ds_read_b128 v[48:51], v75 offset:5120
  v_smfmac_f32_16x16x64_bf16 v[32:35], v[4:7], a[232:239], v74
  ds_read_b128 v[60:63], v75 offset:6144
  v_cvt_pk_bf16_f32 v24, v24, v25
  v_cvt_pk_bf16_f32 v25, v26, v27
  v_bfi_b32 v24, 1, s72, v24
  v_smfmac_f32_16x16x64_bf16 v[32:35], v[8:11], a[240:247], v74
  buffer_store_dwordx2 v[24:25], v68, s[8:11], s75 offen sc1
  v_mov_b64 v[30:31], 0
  v_smfmac_f32_16x16x64_bf16 v[32:35], v[12:15], a[248:255], v74
  ds_read_b128 v[64:67], v75 offset:7168
  s_waitcnt lgkmcnt(6)
  v_smfmac_f32_16x16x64_bf16 v[28:31], v[0:3], v[52:59], v74
  s_waitcnt lgkmcnt(4)
  v_smfmac_f32_16x16x64_bf16 v[28:31], v[4:7], v[36:43], v74
  s_waitcnt lgkmcnt(2)
  v_cvt_pk_bf16_f32 v32, v32, v33
  v_cvt_pk_bf16_f32 v33, v34, v35
  v_bfi_b32 v32, 1, s72, v32
  v_smfmac_f32_16x16x64_bf16 v[28:31], v[8:11], v[44:51], v74
  buffer_store_dwordx2 v[32:33], v68, s[8:11], s76 offen sc1
  s_waitcnt lgkmcnt(0)
  v_smfmac_f32_16x16x64_bf16 v[28:31], v[12:15], v[60:67], v74
  ds_read_b128 v[0:3], v76 offset:14848
  ds_read_b64 v[16:17], v77 offset:384
  v_mov_b64 v[18:19], v[72:73]
  v_xor_b32 v75, 0x8000, v75
  s_nop 3
  v_cvt_pk_bf16_f32 v28, v28, v29
  v_cvt_pk_bf16_f32 v29, v30, v31
  v_bfi_b32 v28, 1, s72, v28
  buffer_store_dwordx2 v[28:29], v68, s[8:11], s77 offen sc1
  v_mov_b64 v[20:21], 0
  v_mov_b64 v[22:23], 0
  v_mov_b64 v[24:25], 0
  v_mov_b64 v[26:27], 0
  v_mov_b64 v[28:29], 0
  v_mov_b64 v[30:31], 0
  v_mov_b64 v[32:33], 0
  v_mov_b64 v[34:35], 0
  v_mov_b32 v68, 14880
  s_add_u32 s58, s58, 655360
  s_add_u32 s59, s59, 655360
  s_add_u32 s70, s70, 655360
  s_add_u32 s68, s68, 655360
  s_add_u32 s66, s66, 1
  s_xor_b32 s64, s64, 16384
  s_xor_b32 s65, s65, 16384
  s_cmp_eq_u32 s66, 62
  s_cselect_b64 s[16:17], s[20:21], s[16:17]
  s_cselect_b32 s18, (Cs2_done - Cs2_last), s18
  s_cselect_b32 s70, 0, s70
  s_cmp_eq_u32 s66, 63
  s_cselect_b32 s59, 268435456, s59
  s_cselect_b32 s58, 268435456, s58
  s_nop 15
  s_nop 11
  buffer_load_dwordx4 v[52:55], v76, s[8:11], s60 offen offset:0 sc1
  buffer_load_dwordx4 v[56:59], v76, s[8:11], s60 offen offset:1024 sc1
  s_waitcnt lgkmcnt(0)
  s_waitcnt vmcnt(1)
  v_mfma_f32_16x16x32_bf16 v[4:7], v[0:3], v[52:55], 0
  v_bitop3_b32 v72, v52, v54, s72 bitop3:0x7e
  s_waitcnt vmcnt(0)
  v_mfma_f32_16x16x32_bf16 v[4:7], v[0:3], v[56:59], v[4:7]
  v_bitop3_b32 v73, v56, v58, s72 bitop3:0x7e
  v_bitop3_b32 v72, v72, v73, 1 bitop3:0xa8
  v_cmp_ne_u32 vcc, 0, v72
  s_nop 0
  s_cmp_eq_u64 vcc, 0
  s_cselect_b32 s54, s62, 268435456
  s_nop 0
  v_add_f32_dpp v4, v4, v4 row_ror:4 row_mask:0xf bank_mask:0xf
  v_add_f32_dpp v5, v5, v5 row_ror:4 row_mask:0xf bank_mask:0xf
  s_nop 0
  v_add_f32_dpp v4, v4, v4 row_ror:8 row_mask:0xf bank_mask:0xf
  v_add_f32_dpp v5, v5, v5 row_ror:8 row_mask:0xf bank_mask:0xf
  v_cvt_pk_bf16_f32 v4, v4, v5
  buffer_store_dword v4, v69, s[8:11], s54 offen sc1
  s_cbranch_vccnz Cs2_h1r
  s_xor_b32 s62, s62, 16384
  buffer_store_dword v71, v69, s[8:11], s62 offen sc1
  s_xor_b32 s72, s72, 1
  s_branch Cs2_h2
Cs2_h1r:
  s_mov_b64 exec, vcc
  buffer_load_dwordx4 v[52:55], v76, s[8:11], s60 offen offset:0 sc1
  buffer_load_dwordx4 v[56:59], v76, s[8:11], s60 offen offset:1024 sc1
  s_mov_b64 exec, -1
  s_add_u32 s67, s67, 1
  s_waitcnt vmcnt(1)
  v_mfma_f32_16x16x32_bf16 v[4:7], v[0:3], v[52:55], 0
  v_bitop3_b32 v72, v52, v54, s72 bitop3:0x7e
  s_waitcnt vmcnt(0)
  v_mfma_f32_16x16x32_bf16 v[4:7], v[0:3], v[56:59], v[4:7]
  v_bitop3_b32 v73, v56, v58, s72 bitop3:0x7e
  v_bitop3_b32 v72, v72, v73, 1 bitop3:0xa8
  v_cmp_ne_u32 vcc, 0, v72
  s_cbranch_vccz Cs2_h1p
Cs2_h1s:
  s_mov_b64 exec, vcc
  buffer_load_dwordx4 v[52:55], v76, s[8:11], s60 offen offset:0 sc1
  buffer_load_dwordx4 v[56:59], v76, s[8:11], s60 offen offset:1024 sc1
  s_mov_b64 exec, -1
  s_add_u32 s67, s67, 1
  s_waitcnt vmcnt(1)
  v_mfma_f32_16x16x32_bf16 v[4:7], v[0:3], v[52:55], 0
  v_bitop3_b32 v72, v52, v54, s72 bitop3:0x7e
  s_waitcnt vmcnt(0)
  v_mfma_f32_16x16x32_bf16 v[4:7], v[0:3], v[56:59], v[4:7]
  v_bitop3_b32 v73, v56, v58, s72 bitop3:0x7e
  v_bitop3_b32 v72, v72, v73, 1 bitop3:0xa8
  v_cmp_ne_u32 vcc, 0, v72
  s_cbranch_vccz Cs2_h1p
  s_cmp_lt_u32 s67, 131072
  s_cbranch_scc1 Cs2_h1s
Cs2_h1p:
  s_nop 2
  v_add_f32_dpp v4, v4, v4 row_ror:4 row_mask:0xf bank_mask:0xf
  v_add_f32_dpp v5, v5, v5 row_ror:4 row_mask:0xf bank_mask:0xf
  s_nop 0
  v_add_f32_dpp v4, v4, v4 row_ror:8 row_mask:0xf bank_mask:0xf
  v_add_f32_dpp v5, v5, v5 row_ror:8 row_mask:0xf bank_mask:0xf
  v_cvt_pk_bf16_f32 v4, v4, v5
  buffer_store_dword v4, v69, s[8:11], s62 offen sc1
  s_xor_b32 s62, s62, 16384
  buffer_store_dword v71, v69, s[8:11], s62 offen sc1
  s_xor_b32 s72, s72, 1
  s_branch Cs2_h2
Cs2_h2r:
  s_mov_b64 exec, vcc
  buffer_load_dwordx4 v[12:15], v76, s[8:11], s65 offen offset:3072 sc1
  s_mov_b64 exec, -1
  s_add_u32 s67, s67, 1
  s_waitcnt vmcnt(4)
  v_max3_u32 v72, v12, v13, v14
  v_max_u32 v72, v72, v15
  ds_write_b128 v76, v[12:15] offset:7680
  v_cmp_eq_u32 vcc, -1, v72
  s_cbranch_vccz Cs2_h2w
  s_mov_b64 exec, vcc
  buffer_load_dwordx4 v[12:15], v76, s[8:11], s65 offen offset:3072 sc1
  s_mov_b64 exec, -1
  s_add_u32 s67, s67, 1
  s_waitcnt vmcnt(4)
  v_max3_u32 v72, v12, v13, v14
  v_max_u32 v72, v72, v15
  ds_write_b128 v76, v[12:15] offset:7680
  v_cmp_eq_u32 vcc, -1, v72
  s_cbranch_vccz Cs2_h2w
Cs2_h2s:
  s_mov_b64 exec, vcc
  buffer_load_dwordx4 v[12:15], v76, s[8:11], s65 offen offset:3072 sc1
  s_mov_b64 exec, -1
  s_add_u32 s67, s67, 1
  s_waitcnt vmcnt(2)
  v_max3_u32 v72, v12, v13, v14
  v_max_u32 v72, v72, v15
  ds_write_b128 v76, v[12:15] offset:7680
  v_cmp_eq_u32 vcc, -1, v72
  s_cbranch_vccz Cs2_h2w
  s_mov_b64 exec, vcc
  buffer_load_dwordx4 v[12:15], v76, s[8:11], s65 offen offset:3072 sc1
  s_mov_b64 exec, -1
  s_add_u32 s67, s67, 1
  s_waitcnt vmcnt(2)
  v_max3_u32 v72, v12, v13, v14
  v_max_u32 v72, v72, v15
  ds_write_b128 v76, v[12:15] offset:7680
  v_cmp_eq_u32 vcc, -1, v72
  s_cbranch_vccz Cs2_h2w
  s_mov_b64 exec, vcc
  buffer_load_dwordx4 v[12:15], v76, s[8:11], s65 offen offset:3072 sc1
  s_mov_b64 exec, -1
  s_add_u32 s67, s67, 1
  s_waitcnt vmcnt(2)
  v_max3_u32 v72, v12, v13, v14
  v_max_u32 v72, v72, v15
  ds_write_b128 v76, v[12:15] offset:7680
  v_cmp_eq_u32 vcc, -1, v72
  s_cbranch_vccz Cs2_h2w
  s_cmp_lt_u32 s67, 131072
  s_cbranch_scc1 Cs2_h2s
  s_branch Cs2_h2w
Cs2_rec:
  s_nop 7
  s_waitcnt vmcnt(0) lgkmcnt(0)
  v_max3_u32 v72, v0, v1, v2
  v_max3_u32 v72, v72, v3, v4
  v_max3_u32 v72, v72, v5, v6
  v_max3_u32 v72, v72, v7, v8
  v_max3_u32 v72, v72, v9, v10
  v_max3_u32 v72, v72, v11, v12
  v_max3_u32 v72, v72, v13, v14
  v_max3_u32 v72, v72, v15, v16
  v_max3_u32 v72, v72, v17, v18
  v_max_u32 v72, v72, v19
  v_cmp_eq_u32 vcc, -1, v72
  s_cbranch_vccz Cs2_recok
  s_barrier
Cs2_recp:
  buffer_load_dwordx4 v[0:3], v76, s[8:11], s64 offen offset:0 sc1
  buffer_load_dwordx4 v[4:7], v76, s[8:11], s64 offen offset:1024 sc1
  s_add_u32 s67, s67, 1
  s_cmp_lt_u32 s67, 131072
  s_cselect_b32 s54, -2, -1
  s_waitcnt vmcnt(1)
  v_max3_u32 v72, v0, v1, v2
  s_waitcnt vmcnt(0)
  v_max3_u32 v72, v72, v3, v4
  v_max3_u32 v72, v72, v5, v6
  v_max_u32 v72, v72, v7
  v_cmp_lt_u32 vcc, s54, v72
  s_cbranch_vccnz Cs2_recp
  ds_write_b128 v76, v[0:3] offset:8704
  ds_write_b128 v76, v[4:7] offset:9728
  v_mov_b64 v[20:21], 0
  v_mov_b64 v[22:23], 0
  v_mov_b64 v[24:25], 0
  v_mov_b64 v[26:27], 0
  v_mov_b64 v[28:29], 0
  v_mov_b64 v[30:31], 0
  v_mov_b64 v[32:33], 0
  v_mov_b64 v[34:35], 0
  s_waitcnt lgkmcnt(0)
  s_barrier
  ds_read_b128 v[0:3], v76 offset:4608
  s_waitcnt lgkmcnt(0)
  v_smfmac_f32_16x16x64_bf16 v[20:23], v[0:3], v[80:87], v74
  v_smfmac_f32_16x16x64_bf16 v[24:27], v[0:3], v[88:95], v74
  ds_read_b128 v[60:63], v76 offset:24576
  ds_read_b128 v[64:67], v76 offset:25600
  s_waitcnt lgkmcnt(0)
  v_smfmac_f32_16x16x64_bf16 v[28:31], v[0:3], v[60:67], v74
  ds_read_b128 v[60:63], v76 offset:26624
  ds_read_b128 v[64:67], v76 offset:27648
  s_waitcnt lgkmcnt(0)
  v_smfmac_f32_16x16x64_bf16 v[32:35], v[0:3], v[60:67], v74
  ds_read_b128 v[4:7], v76 offset:5632
  s_waitcnt lgkmcnt(0)
  v_smfmac_f32_16x16x64_bf16 v[20:23], v[4:7], v[96:103], v74
  v_smfmac_f32_16x16x64_bf16 v[24:27], v[4:7], v[104:111], v74
  ds_read_b128 v[60:63], v76 offset:40960
  ds_read_b128 v[64:67], v76 offset:41984
  s_waitcnt lgkmcnt(0)
  v_smfmac_f32_16x16x64_bf16 v[28:31], v[4:7], v[60:67], v74
  ds_read_b128 v[60:63], v76 offset:43008
  ds_read_b128 v[64:67], v76 offset:44032
  s_waitcnt lgkmcnt(0)
  v_smfmac_f32_16x16x64_bf16 v[32:35], v[4:7], v[60:67], v74
  ds_read_b128 v[8:11], v76 offset:6656
  s_waitcnt lgkmcnt(0)
  v_smfmac_f32_16x16x64_bf16 v[20:23], v[8:11], v[112:119], v74
  v_smfmac_f32_16x16x64_bf16 v[24:27], v[8:11], v[120:127], v74
  v_smfmac_f32_16x16x64_bf16 v[28:31], v[8:11], v[208:215], v74
  v_smfmac_f32_16x16x64_bf16 v[32:35], v[8:11], v[216:223], v74
  ds_read_b128 v[12:15], v76 offset:7680
  s_waitcnt lgkmcnt(0)
  v_smfmac_f32_16x16x64_bf16 v[20:23], v[12:15], v[128:135], v74
  v_smfmac_f32_16x16x64_bf16 v[24:27], v[12:15], v[136:143], v74
  v_smfmac_f32_16x16x64_bf16 v[28:31], v[12:15], v[224:231], v74
  v_smfmac_f32_16x16x64_bf16 v[32:35], v[12:15], v[232:239], v74
  ds_read_b128 v[12:15], v76 offset:8704
  s_waitcnt lgkmcnt(0)
  v_smfmac_f32_16x16x64_bf16 v[20:23], v[12:15], v[144:151], v74
  v_smfmac_f32_16x16x64_bf16 v[24:27], v[12:15], v[152:159], v74
  ds_read_b128 v[60:63], v76 offset:57344
  ds_read_b128 v[64:67], v76 offset:58368
  s_waitcnt lgkmcnt(0)
  v_smfmac_f32_16x16x64_bf16 v[28:31], v[12:15], v[60:67], v74
  ds_read_b128 v[60:63], v76 offset:59392
  ds_read_b128 v[64:67], v76 offset:60416
  s_waitcnt lgkmcnt(0)
  v_smfmac_f32_16x16x64_bf16 v[32:35], v[12:15], v[60:67], v74
  ds_read_b128 v[0:3], v76 offset:9728
  s_waitcnt lgkmcnt(0)
  v_smfmac_f32_16x16x64_bf16 v[20:23], v[0:3], v[160:167], v74
  v_smfmac_f32_16x16x64_bf16 v[24:27], v[0:3], v[168:175], v74
  ds_read_b128 v[60:63], v75 offset:24576
  ds_read_b128 v[64:67], v75 offset:25600
  s_waitcnt lgkmcnt(0)
  v_smfmac_f32_16x16x64_bf16 v[28:31], v[0:3], v[60:67], v74
  ds_read_b128 v[60:63], v75 offset:26624
  ds_read_b128 v[64:67], v75 offset:27648
  s_waitcnt lgkmcnt(0)
  v_smfmac_f32_16x16x64_bf16 v[32:35], v[0:3], v[60:67], v74
  ds_read_b128 v[16:19], v76 offset:10752
  ds_read_b128 v[60:63], v75 offset:8192
  ds_read_b128 v[64:67], v75 offset:9216
  s_waitcnt lgkmcnt(0)
  v_smfmac_f32_16x16x64_bf16 v[20:23], v[16:19], v[60:67], v74
  ds_read_b128 v[60:63], v75 offset:10240
  ds_read_b128 v[64:67], v75 offset:11264
  s_waitcnt lgkmcnt(0)
  v_smfmac_f32_16x16x64_bf16 v[24:27], v[16:19], v[60:67], v74
  v_smfmac_f32_16x16x64_bf16 v[28:31], v[16:19], v[240:247], v74
  v_smfmac_f32_16x16x64_bf16 v[32:35], v[16:19], v[248:255], v74
  ds_read_b128 v[4:7], v76 offset:11776
  s_waitcnt lgkmcnt(0)
  v_smfmac_f32_16x16x64_bf16 v[20:23], v[4:7], v[176:183], v74
  v_smfmac_f32_16x16x64_bf16 v[24:27], v[4:7], v[184:191], v74
  v_smfmac_f32_16x16x64_bf16 v[28:31], v[4:7], a[0:7], v74
  v_smfmac_f32_16x16x64_bf16 v[32:35], v[4:7], a[8:15], v74
  ds_read_b128 v[8:11], v76 offset:12800
  s_waitcnt lgkmcnt(0)
  v_smfmac_f32_16x16x64_bf16 v[20:23], v[8:11], v[192:199], v74
  v_smfmac_f32_16x16x64_bf16 v[24:27], v[8:11], v[200:207], v74
  v_smfmac_f32_16x16x64_bf16 v[28:31], v[8:11], a[16:23], v74
  v_smfmac_f32_16x16x64_bf16 v[32:35], v[8:11], a[24:31], v74
  v_add_f32 v20, v20, v22
  v_add_f32 v21, v21, v23
  v_add_f32 v24, v24, v26
  v_cvt_pk_bf16_f32 v22, v20, v24
  s_nop 0
  ds_write_b32 v79, v22 offset:0
  v_add_f32 v25, v25, v27
  v_cvt_pk_bf16_f32 v23, v21, v25
  ds_write_b32 v79, v23 offset:576
  v_add_f32 v28, v28, v30
  v_add_f32 v29, v29, v31
  s_waitcnt lgkmcnt(0)
  s_nop 1
  s_branch Cs2_recok
Cs2_mx:
  s_waitcnt lgkmcnt(0)
  s_barrier
  buffer_load_dwordx4 v[0:3], v76, s[8:11], s58 offen offset:0 sc1
  ds_read_b128 v[20:23], v77 offset:0
  ds_read_b128 v[28:31], v77 offset:256
  buffer_load_dwordx4 v[4:7], v76, s[8:11], s58 offen offset:1024 sc1
  ds_read_b128 v[24:27], v77 offset:128
  ds_read_b128 v[32:35], v77 offset:384
  s_waitcnt vmcnt(1) lgkmcnt(3)
  v_mfma_f32_16x16x32_bf16 v[8:11], v[0:3], v[20:23], 0
  s_waitcnt vmcnt(0) lgkmcnt(1)
  v_mfma_f32_16x16x32_bf16 v[8:11], v[4:7], v[24:27], v[8:11]
  v_mfma_f32_16x16x32_bf16 v[12:15], v[28:31], v[20:23], 0
  s_waitcnt lgkmcnt(0)
  v_mfma_f32_16x16x32_bf16 v[12:15], v[32:35], v[24:27], v[12:15]
  v_add_f32_dpp v8, v10, v8 quad_perm:[2,3,0,1] row_mask:0xf bank_mask:0xf
  v_add_f32_dpp v9, v11, v9 quad_perm:[2,3,0,1] row_mask:0xf bank_mask:0xf
  s_nop 0
  v_mov_b32_dpp v8, v8 quad_perm:[0,1,0,1] row_mask:0xf bank_mask:0xf
  v_mov_b32_dpp v9, v9 quad_perm:[0,1,0,1] row_mask:0xf bank_mask:0xf
  s_nop 1
  v_add_f32_dpp v12, v14, v12 quad_perm:[2,3,0,1] row_mask:0xf bank_mask:0xf
  v_add_f32_dpp v13, v15, v13 quad_perm:[2,3,0,1] row_mask:0xf bank_mask:0xf
  s_nop 0
  v_mov_b32_dpp v12, v12 quad_perm:[0,1,0,1] row_mask:0xf bank_mask:0xf
  v_mov_b32_dpp v13, v13 quad_perm:[0,1,0,1] row_mask:0xf bank_mask:0xf
  v_mul_f32 v12, s69, v12
  ds_write_b32 v78, v8 offset:8712
  v_mul_f32 v13, s69, v13
  ds_write_b32 v78, v9 offset:8776
  s_waitcnt lgkmcnt(0)
  s_barrier
  ds_read_b128 v[36:39], v78 offset:8704
  ds_read_b128 v[40:43], v78 offset:8768
  s_waitcnt lgkmcnt(0)
  s_barrier
  v_max_f32 v16, v36, v37
  v_max3_f32 v16, v16, v38, v39
  v_max3_f32 v16, v16, v40, v41
  v_max3_f32 v16, v16, v42, v43
  v_max3_f32 v16, v16, v12, v13
  v_mov_b32 v17, v16
  s_nop 1
  v_permlane16_swap_b32 v16, v17
  v_max_f32 v16, v16, v17
  v_mov_b32 v17, v16
  s_nop 1
  v_permlane32_swap_b32 v16, v17
  v_max_f32 v16, v16, v17
  v_sub_f32 v36, v36, v16
  v_sub_f32 v37, v37, v16
  v_sub_f32 v38, v38, v16
  v_sub_f32 v39, v39, v16
  v_sub_f32 v40, v40, v16
  v_sub_f32 v41, v41, v16
  v_sub_f32 v42, v42, v16
  v_sub_f32 v43, v43, v16
  v_sub_f32 v12, v12, v16
  v_sub_f32 v13, v13, v16
  v_exp_f32 v36, v36
  v_exp_f32 v37, v37
  v_exp_f32 v38, v38
  v_exp_f32 v39, v39
  v_exp_f32 v40, v40
  v_exp_f32 v41, v41
  v_exp_f32 v42, v42
  v_exp_f32 v43, v43
  v_exp_f32 v12, v12
  v_exp_f32 v13, v13
  v_cvt_pk_bf16_f32 v32, v36, v40
  v_cvt_pk_bf16_f32 v33, v37, v41
  v_cvt_pk_bf16_f32 v34, v38, v42
  v_cvt_pk_bf16_f32 v35, v39, v43
  v_cvt_pk_bf16_f32 v28, v12, v13
  v_cvt_pk_bf16_f32 v31, v12, v13
  v_mov_b32 v29, 0
  v_mov_b32 v30, 0
  v_mov_b32 v68, 0x3f803f80
  v_mov_b32 v69, 0x3f803f80
  v_mov_b32 v70, 0x3f803f80
  v_mov_b32 v71, 0x3f803f80
  s_nop 1
  v_mfma_f32_16x16x32_bf16 v[8:11], v[32:35], v[68:71], 0
  v_mfma_f32_16x16x32_bf16 v[0:3], v[32:35], v[52:55], 0
  v_mfma_f32_16x16x32_bf16 v[4:7], v[32:35], v[56:59], 0
  v_mfma_f32_16x16x16_bf16 v[8:11], v[28:29], v[68:69], v[8:11]
  v_mfma_f32_16x16x16_bf16 v[0:3], v[28:29], v[72:73], v[0:3]
  v_mfma_f32_16x16x16_bf16 v[4:7], v[30:31], v[72:73], v[4:7]
  ds_read_b128 v[68:71], v76 offset:13824
  v_rcp_f32 v10, v8
  v_rcp_f32 v11, v9
  v_mul_f32 v0, v10, v0
  v_mul_f32 v1, v11, v1
  s_nop 0
  v_mul_f32 v4, v10, v4
  v_mul_f32 v5, v11, v5
  v_cvt_pk_bf16_f32 v2, v0, v4
  ds_write_b32 v79, v2 offset:8704
  v_cvt_pk_bf16_f32 v3, v1, v5
  ds_write_b32 v79, v3 offset:9280
  v_mov_b64 v[16:17], 0
  v_mov_b64 v[18:19], 0
  v_mov_b64 v[20:21], 0
  v_mov_b64 v[22:23], 0
  v_mov_b64 v[24:25], 0
  v_mov_b64 v[26:27], 0
  s_branch Cs2_mxok
Cs2_last:
  ds_read_b128 v[4:7], v76 offset:5632
  ds_read_b128 v[8:11], v76 offset:6656
  ds_read_b128 v[44:47], v76 offset:40960
  ds_read_b128 v[48:51], v76 offset:41984
  s_nop 5
  v_mov_b64 v[20:21], 0
  v_mov_b64 v[22:23], 0
  v_mov_b64 v[24:25], 0
  v_mov_b64 v[26:27], 0
  s_waitcnt lgkmcnt(4)
  v_smfmac_f32_16x16x64_bf16 v[28:31], v[0:3], v[36:43], v74
  ds_read_b128 v[36:39], v76 offset:43008
  ds_read_b128 v[40:43], v76 offset:44032
  v_smfmac_f32_16x16x64_bf16 v[32:35], v[0:3], v[60:67], v74
  s_waitcnt lgkmcnt(5)
  v_smfmac_f32_16x16x64_bf16 v[20:23], v[0:3], a[32:39], v74
  ds_read_b128 v[60:63], v76 offset:57344
  ds_read_b128 v[64:67], v76 offset:58368
  v_smfmac_f32_16x16x64_bf16 v[24:27], v[0:3], a[40:47], v74
  s_waitcnt lgkmcnt(4)
  v_smfmac_f32_16x16x64_bf16 v[20:23], v[4:7], a[48:55], v74
  buffer_store_dwordx4 v[16:19], v76, s[8:11], s68 offen sc1
  v_smfmac_f32_16x16x64_bf16 v[24:27], v[4:7], a[56:63], v74
  v_smfmac_f32_16x16x64_bf16 v[28:31], v[4:7], v[44:51], v74
  s_waitcnt lgkmcnt(2)
  v_smfmac_f32_16x16x64_bf16 v[20:23], v[8:11], a[64:71], v74
  ds_read_b128 v[44:47], v76 offset:59392
  ds_read_b128 v[48:51], v76 offset:60416
  v_smfmac_f32_16x16x64_bf16 v[24:27], v[8:11], a[72:79], v74
  v_smfmac_f32_16x16x64_bf16 v[32:35], v[4:7], v[36:43], v74
  v_smfmac_f32_16x16x64_bf16 v[28:31], v[8:11], v[208:215], v74
  ds_read_b128 v[36:39], v75 offset:24576
  ds_read_b128 v[40:43], v75 offset:25600
  v_smfmac_f32_16x16x64_bf16 v[32:35], v[8:11], v[216:223], v74
  v_smfmac_f32_16x16x64_bf16 v[20:23], v[12:15], a[80:87], v74
  v_smfmac_f32_16x16x64_bf16 v[24:27], v[12:15], a[88:95], v74
  v_smfmac_f32_16x16x64_bf16 v[28:31], v[12:15], v[224:231], v74
  v_smfmac_f32_16x16x64_bf16 v[32:35], v[12:15], v[232:239], v74
  s_waitcnt vmcnt(2)
  s_waitcnt vmcnt(1)
  s_barrier
Cs2_lastr:
  ds_read_b128 v[12:15], v76 offset:8704
  ds_read_b128 v[0:3], v76 offset:9728
  ds_read_b128 v[16:19], v76 offset:10752
  ds_read_b128 v[4:7], v76 offset:11776
  ds_read_b128 v[8:11], v76 offset:12800
  s_waitcnt lgkmcnt(3)
  v_max3_u32 v72, v0, v1, v2
  s_waitcnt lgkmcnt(1)
  v_max3_u32 v72, v72, v3, v4
  v_max3_u32 v72, v72, v5, v6
  s_waitcnt lgkmcnt(0)
  v_max3_u32 v72, v72, v7, v8
  v_max3_u32 v72, v72, v9, v10
  v_max3_u32 v72, v72, v11, v12
  v_max3_u32 v72, v72, v13, v14
  v_max3_u32 v72, v72, v15, v16
  v_max3_u32 v72, v72, v17, v18
  v_max_u32 v72, v72, v19
  v_cmp_eq_u32 vcc, -1, v72
  s_cbranch_vccnz Cs2_lastp
Cs2_lastg:
  v_smfmac_f32_16x16x64_bf16 v[28:31], v[12:15], v[60:67], v74
  ds_read_b128 v[60:63], v75 offset:26624
  ds_read_b128 v[64:67], v75 offset:27648
  v_smfmac_f32_16x16x64_bf16 v[32:35], v[12:15], v[44:51], v74
  v_smfmac_f32_16x16x64_bf16 v[28:31], v[0:3], v[36:43], v74
  v_smfmac_f32_16x16x64_bf16 v[28:31], v[16:19], v[240:247], v74
  v_smfmac_f32_16x16x64_bf16 v[28:31], v[4:7], a[0:7], v74
  v_smfmac_f32_16x16x64_bf16 v[28:31], v[8:11], a[16:23], v74
  v_smfmac_f32_16x16x64_bf16 v[32:35], v[16:19], v[248:255], v74
  v_smfmac_f32_16x16x64_bf16 v[32:35], v[4:7], a[8:15], v74
  s_waitcnt lgkmcnt(0)
  v_smfmac_f32_16x16x64_bf16 v[32:35], v[8:11], a[24:31], v74
  v_smfmac_f32_16x16x64_bf16 v[32:35], v[0:3], v[60:67], v74
  v_smfmac_f32_16x16x64_bf16 v[20:23], v[12:15], a[96:103], v74
  v_smfmac_f32_16x16x64_bf16 v[20:23], v[0:3], a[112:119], v74
  v_add_f32 v28, v28, v30
  v_add_f32 v32, v32, v34
  v_cvt_pk_bf16_f32 v30, v28, v32
  v_smfmac_f32_16x16x64_bf16 v[20:23], v[16:19], a[128:135], v74
  ds_write_b32 v79, v30 offset:256
  v_add_f32 v29, v29, v31
  v_add_f32 v33, v33, v35
  v_cvt_pk_bf16_f32 v31, v29, v33
  v_smfmac_f32_16x16x64_bf16 v[20:23], v[4:7], a[144:151], v74
  ds_write_b32 v79, v31 offset:832
  v_smfmac_f32_16x16x64_bf16 v[20:23], v[8:11], a[160:167], v74
  v_smfmac_f32_16x16x64_bf16 v[24:27], v[12:15], a[104:111], v74
  v_smfmac_f32_16x16x64_bf16 v[24:27], v[0:3], a[120:127], v74
  v_smfmac_f32_16x16x64_bf16 v[24:27], v[16:19], a[136:143], v74
  s_waitcnt lgkmcnt(0)
  s_barrier
  ds_read_b64 v[52:53], v77 offset:384
  v_add_f32 v20, v20, v22
  v_smfmac_f32_16x16x64_bf16 v[24:27], v[4:7], a[152:159], v74
  v_add_f32 v21, v21, v23
  v_smfmac_f32_16x16x64_bf16 v[24:27], v[8:11], a[168:175], v74
  v_cvt_pk_bf16_f32 v54, v20, v21
  s_add_u32 s68, s68, 655360
  s_nop 3
  v_add_f32 v24, v24, v26
  v_add_f32 v25, v25, v27
  v_cvt_pk_bf16_f32 v55, v24, v25
  s_waitcnt lgkmcnt(0)
  buffer_store_dwordx4 v[52:55], v76, s[8:11], s68 offen sc1
  s_branch Cs2_done
Cs2_lastp:
  s_add_u32 s72, s72, 2
  s_cmp_ge_u32 s72, 131072
  s_cbranch_scc1 Cs2_lastg
  s_barrier
  buffer_load_dwordx4 v76, s[8:11], s55 offen offset:0 sc1 lds
  s_waitcnt vmcnt(0)
  s_barrier
  s_branch Cs2_lastr
Cs2_done:
  s_branch L_cexit
L_w7:
  v_mov_b64 v[20:21], 0
  v_mov_b64 v[22:23], 0
  v_mov_b64 v[24:25], 0
  v_mov_b64 v[26:27], 0
  v_mov_b64 v[28:29], 0
  v_mov_b64 v[30:31], 0
  v_mov_b64 v[32:33], 0
  v_mov_b64 v[34:35], 0
  s_mov_b32 s78, 0x3f803f80
  s_mov_b32 s79, s78
  s_mov_b32 s65, 360448
  s_mov_b32 m0, 15872
  s_lshl_b32 s71, s53, 2
  s_add_u32 s71, s71, 128
  s_movk_i32 s56, 0x1000
  v_lshlrev_b32 v73, 2, v76
  v_mov_b32 v72, 0
  s_mov_b64 s[16:17], s[8:9]
  s_mov_b32 s18, 268435456
  s_mov_b32 s19, 0x20000
  s_getpc_b64 s[20:21]
Cs3_pc:
  s_add_u32 s20, s20, (Cs3_last - Cs3_pc)
  s_addc_u32 s21, s21, 0
  v_mov_b32 v68, 14880
  buffer_load_dwordx4 v[52:55], v76, s[8:11], s59 offen offset:0 sc1
  buffer_load_dwordx4 v[56:59], v76, s[8:11], s59 offen offset:1024 sc1
  ds_read_b128 v[36:39], v76 offset:45056
  ds_read_b128 v[40:43], v76 offset:46080
  ds_read_b128 v[60:63], v76 offset:47104
  ds_read_b128 v[64:67], v76 offset:48128
  ds_read_b128 v[0:3], v76 offset:4608
  ds_read_b128 v[4:7], v76 offset:5632
  ds_read_b128 v[8:11], v76 offset:6656
  ds_read_b128 v[12:15], v76 offset:7680
  s_waitcnt lgkmcnt(0)
  s_cmp_eq_u32 s66, 1
  s_branch Cs3_top2
.p2align 6
Cs3_h2:
  v_lshlrev_b32 v73, 2, v76
  s_mov_b32 m0, 8704
  s_add_u32 s55, s65, 4096
  buffer_load_dwordx4 v[4:7], v76, s[8:11], s65 offen offset:1024 sc1
  s_waitcnt vmcnt(6)
  ds_read_b128 v[36:39], v76 offset:45056
  ds_read_b128 v[40:43], v76 offset:46080
  ds_read_b128 v[60:63], v76 offset:47104
  ds_read_b128 v[64:67], v76 offset:48128
  buffer_load_dwordx4 v[52:55], v76, s[8:11], s59 offen offset:0 sc1
  buffer_load_dwordx4 v[56:59], v76, s[8:11], s59 offen offset:1024 sc1
  s_waitcnt vmcnt(7)
  v_max3_u32 v72, v4, v5, v6
  v_max_u32 v72, v72, v7
  ds_write_b128 v76, v[4:7] offset:5632
  v_cmp_eq_u32 vcc, -1, v72
  s_cbranch_vccnz Cs3_h2r
Cs3_h2w:
  buffer_load_dwordx4 v76, s[8:11], s55 offen offset:0 sc1 lds
  buffer_load_dwordx4 v76, s[8:11], s55 offen offset:1024 sc1 lds
  s_cmp_eq_u32 s66, 63
  s_waitcnt lgkmcnt(0)
  s_barrier
  ds_read_b128 v[8:11], v76 offset:6656
Cs3_top2:
  v_smfmac_f32_16x16x64_bf16 v[20:23], v[4:7], v[96:103], v74
  s_cbranch_scc1 Cs3_last
  v_smfmac_f32_16x16x64_bf16 v[28:31], v[4:7], v[36:43], v74
  buffer_load_dwordx4 v[44:47], v76, s[8:11], s58 offen offset:0 sc1
  s_mov_b32 m0, 15872
  v_smfmac_f32_16x16x64_bf16 v[24:27], v[4:7], v[104:111], v74
  buffer_load_dwordx4 v[48:51], v76, s[8:11], s58 offen offset:1024 sc1
  v_smfmac_f32_16x16x64_bf16 v[32:35], v[4:7], v[60:67], v74
  ds_read_b128 v[0:3], v76 offset:4608
  s_waitcnt lgkmcnt(1)
  v_smfmac_f32_16x16x64_bf16 v[20:23], v[8:11], v[112:119], v74
  ds_read_b128 v[12:15], v76 offset:7680
  v_smfmac_f32_16x16x64_bf16 v[24:27], v[8:11], v[120:127], v74
  ds_read_b128 v[36:39], v76 offset:28672
  v_smfmac_f32_16x16x64_bf16 v[28:31], v[8:11], v[208:215], v74
  buffer_store_dwordx4 v[16:19], v76, s[8:11], s68 offen sc1
  ds_read_b128 v[40:43], v76 offset:29696
  v_smfmac_f32_16x16x64_bf16 v[32:35], v[8:11], v[216:223], v74
  ds_read_b128 v[60:63], v76 offset:30720
  s_waitcnt lgkmcnt(4)
  v_smfmac_f32_16x16x64_bf16 v[20:23], v[0:3], v[80:87], v74
  ds_read_b128 v[64:67], v76 offset:31744
  v_smfmac_f32_16x16x64_bf16 v[24:27], v[0:3], v[88:95], v74
  buffer_load_dword v73, s[16:19], s70 offen lds
  s_waitcnt vmcnt(4)
  s_waitcnt lgkmcnt(4)
  v_smfmac_f32_16x16x64_bf16 v[20:23], v[12:15], v[128:135], v74
  s_barrier
  s_waitcnt lgkmcnt(2)
  v_smfmac_f32_16x16x64_bf16 v[28:31], v[0:3], v[36:43], v74
  ds_read_b128 v[4:7], v76 offset:8704
  v_smfmac_f32_16x16x64_bf16 v[24:27], v[12:15], v[136:143], v74
  ds_read_b128 v[36:39], v76 offset:61440
  s_waitcnt lgkmcnt(2)
  v_smfmac_f32_16x16x64_bf16 v[32:35], v[0:3], v[60:67], v74
  ds_read_b128 v[40:43], v76 offset:62464
  v_smfmac_f32_16x16x64_bf16 v[28:31], v[12:15], v[224:231], v74
  ds_read_b128 v[60:63], v76 offset:63488
  v_smfmac_f32_16x16x64_bf16 v[32:35], v[12:15], v[232:239], v74
  ds_read_b128 v[64:67], v76 offset:64512
  s_waitcnt lgkmcnt(4)
  v_smfmac_f32_16x16x64_bf16 v[20:23], v[4:7], v[144:151], v74
  ds_read_b128 v[8:11], v76 offset:9728
  s_waitcnt lgkmcnt(3)
  v_smfmac_f32_16x16x64_bf16 v[28:31], v[4:7], v[36:43], v74
  s_barrier
  ds_read_b128 v[0:3], v76 offset:11776
  v_smfmac_f32_16x16x64_bf16 v[24:27], v[4:7], v[152:159], v74
  ds_read_b128 v[36:39], v75 offset:12288
  ds_read_b128 v[40:43], v75 offset:13312
  s_waitcnt lgkmcnt(4)
  v_smfmac_f32_16x16x64_bf16 v[32:35], v[4:7], v[60:67], v74
  ds_read_b128 v[16:19], v76 offset:10752
  s_waitcnt lgkmcnt(4)
  v_smfmac_f32_16x16x64_bf16 v[20:23], v[8:11], v[160:167], v74
  ds_read_b128 v[12:15], v76 offset:12800
  v_smfmac_f32_16x16x64_bf16 v[24:27], v[8:11], v[168:175], v74
  ds_read_b128 v[60:63], v75 offset:14336
  ds_read_b128 v[64:67], v75 offset:15360
  s_waitcnt lgkmcnt(6)
  v_smfmac_f32_16x16x64_bf16 v[20:23], v[0:3], v[176:183], v74
  s_waitcnt lgkmcnt(3)
  v_smfmac_f32_16x16x64_bf16 v[20:23], v[16:19], v[36:43], v74
  ds_read_b128 v[36:39], v75 offset:28672
  s_waitcnt lgkmcnt(3)
  v_smfmac_f32_16x16x64_bf16 v[20:23], v[12:15], v[192:199], v74
  ds_read_b128 v[40:43], v75 offset:29696
  s_waitcnt lgkmcnt(2)
  v_smfmac_f32_16x16x64_bf16 v[24:27], v[16:19], v[60:67], v74
  ds_read_b128 v[60:63], v75 offset:30720
  v_smfmac_f32_16x16x64_bf16 v[24:27], v[0:3], v[184:191], v74
  ds_read_b128 v[64:67], v75 offset:31744
  v_add_f32 v20, v20, v22
  v_smfmac_f32_16x16x64_bf16 v[24:27], v[12:15], v[200:207], v74
  v_add_f32 v21, v21, v23
  v_smfmac_f32_16x16x64_bf16 v[28:31], v[16:19], v[240:247], v74
  s_waitcnt lgkmcnt(2)
  v_mov_b64 v[70:71], s[78:79]
  v_smfmac_f32_16x16x64_bf16 v[28:31], v[8:11], v[36:43], v74
  ds_read_b128 v[36:39], v68
  v_add_f32 v24, v24, v26
  v_smfmac_f32_16x16x64_bf16 v[28:31], v[0:3], a[0:7], v74
  ds_read_b128 v[40:43], v68
  v_cvt_pk_bf16_f32 v22, v20, v24
  v_smfmac_f32_16x16x64_bf16 v[28:31], v[12:15], a[16:23], v74
  ds_write_b32 v79, v22 offset:0
  s_waitcnt lgkmcnt(3)
  v_add_f32 v25, v25, v27
  v_cvt_pk_bf16_f32 v23, v21, v25
  v_smfmac_f32_16x16x64_bf16 v[32:35], v[8:11], v[60:67], v74
  ds_write_b32 v79, v23 offset:576
  v_cmp_u_f32 vcc, v20, v21
  v_smfmac_f32_16x16x64_bf16 v[32:35], v[16:19], v[248:255], v74
  v_add_f32 v28, v28, v30
  v_smfmac_f32_16x16x64_bf16 v[32:35], v[0:3], a[8:15], v74
  v_add_f32 v29, v29, v31
  v_smfmac_f32_16x16x64_bf16 v[32:35], v[12:15], a[24:31], v74
  s_cbranch_vccnz Cs3_rec
Cs3_recok:
  s_waitcnt lgkmcnt(3)
  v_smfmac_f32_16x16x64_bf16 v[36:39], v[16:19], a[128:135], v74
  s_waitcnt lgkmcnt(0)
  s_barrier
  ds_read_b128 v[60:63], v77
  v_smfmac_f32_16x16x64_bf16 v[40:43], v[16:19], a[136:143], v74
  ds_read_b128 v[64:67], v77 offset:128
  v_add_f32 v32, v32, v34
  v_cvt_pk_bf16_f32 v30, v28, v32
  v_smfmac_f32_16x16x64_bf16 v[36:39], v[0:3], a[144:151], v74
  ds_write_b32 v79, v30 offset:256
  v_add_f32 v33, v33, v35
  v_cvt_pk_bf16_f32 v31, v29, v33
  v_smfmac_f32_16x16x64_bf16 v[40:43], v[0:3], a[152:159], v74
  ds_write_b32 v79, v31 offset:832
  v_xor_b32 v75, 0x8000, v75
  v_smfmac_f32_16x16x64_bf16 v[36:39], v[4:7], a[96:103], v74
  ds_read_b128 v[0:3], v76 offset:4608
  v_mov_b32 v29, 0
  v_smfmac_f32_16x16x64_bf16 v[40:43], v[4:7], a[104:111], v74
  s_waitcnt vmcnt(2) lgkmcnt(3)
  v_mov_b32 v30, 0
  v_mfma_f32_16x16x32_bf16 v[44:47], v[44:47], v[60:63], 0
  ds_read_b128 v[4:7], v76 offset:5632
  s_waitcnt lgkmcnt(2)
  v_mfma_f32_16x16x32_bf16 v[44:47], v[48:51], v[64:67], v[44:47]
  s_barrier
  v_smfmac_f32_16x16x64_bf16 v[36:39], v[8:11], a[112:119], v74
  ds_read_b128 v[20:23], v77 offset:256
  ds_read_b128 v[24:27], v77 offset:384
  v_smfmac_f32_16x16x64_bf16 v[40:43], v[8:11], a[120:127], v74
  ds_read_b128 v[8:11], v76 offset:6656
  v_add_f32_dpp v72, v46, v44 quad_perm:[2,3,0,1] row_mask:0xf bank_mask:0xf
  v_add_f32_dpp v73, v47, v45 quad_perm:[2,3,0,1] row_mask:0xf bank_mask:0xf
  v_smfmac_f32_16x16x64_bf16 v[36:39], v[12:15], a[160:167], v74
  s_waitcnt lgkmcnt(4)
  v_exp_f32_dpp v72, v72 quad_perm:[0,1,0,1] row_mask:0xf bank_mask:0xf
  v_smfmac_f32_16x16x64_bf16 v[40:43], v[12:15], a[168:175], v74
  ds_read_b128 v[12:15], v76 offset:7680
  v_exp_f32_dpp v73, v73 quad_perm:[0,1,0,1] row_mask:0xf bank_mask:0xf
  v_smfmac_f32_16x16x64_bf16 v[36:39], v[0:3], a[32:39], v74
  s_waitcnt lgkmcnt(2)
  v_cvt_pk_bf16_f32 v72, v72, v73
  v_mfma_f32_16x16x32_bf16 v[20:23], v[20:23], v[60:63], 0
  ds_write_b32 v78, v72 offset:524
  v_mov_b64 v[16:17], 0
  v_mfma_f32_16x16x32_bf16 v[20:23], v[24:27], v[64:67], v[20:23]
  ds_read_b128 v[44:47], v75 offset:28672
  v_mov_b64 v[18:19], 0
  v_smfmac_f32_16x16x64_bf16 v[40:43], v[0:3], a[40:47], v74
  ds_read_b128 v[48:51], v75 offset:29696
  v_mov_b64 v[68:69], s[78:79]
  v_smfmac_f32_16x16x64_bf16 v[36:39], v[4:7], a[48:55], v74
  s_waitcnt lgkmcnt(4)
  v_add_f32_dpp v24, v22, v20 quad_perm:[2,3,0,1] row_mask:0xf bank_mask:0xf
  v_add_f32_dpp v25, v23, v21 quad_perm:[2,3,0,1] row_mask:0xf bank_mask:0xf
  v_smfmac_f32_16x16x64_bf16 v[36:39], v[8:11], a[64:71], v74
  s_waitcnt lgkmcnt(2)
  s_barrier
  ds_read_b128 v[32:35], v78 offset:512
  v_smfmac_f32_16x16x64_bf16 v[36:39], v[12:15], a[80:87], v74
  ds_read_b128 v[60:63], v75 offset:30720
  v_mul_f32 v24, s69, v24
  v_smfmac_f32_16x16x64_bf16 v[40:43], v[4:7], a[56:63], v74
  ds_read_b128 v[64:67], v75 offset:31744
  v_mul_f32 v25, s69, v25
  v_smfmac_f32_16x16x64_bf16 v[40:43], v[8:11], a[72:79], v74
  v_exp_f32_dpp v24, v24 quad_perm:[0,1,0,1] row_mask:0xf bank_mask:0xf
  v_smfmac_f32_16x16x64_bf16 v[40:43], v[12:15], a[88:95], v74
  s_waitcnt lgkmcnt(2)
  v_exp_f32_dpp v25, v25 quad_perm:[0,1,0,1] row_mask:0xf bank_mask:0xf
  v_mfma_f32_16x16x32_bf16 v[8:11], v[32:35], v[68:71], 0
  v_add_f32 v36, v36, v38
  v_add_f32 v37, v37, v39
  v_mfma_f32_16x16x32_bf16 v[0:3], v[32:35], v[52:55], 0
  v_add_f32 v40, v40, v42
  v_add_f32 v41, v41, v43
  v_mfma_f32_16x16x32_bf16 v[4:7], v[32:35], v[56:59], 0
  v_cvt_pk_bf16_f32 v28, v24, v25
  v_cvt_pk_bf16_f32 v72, v36, v37
  v_cvt_pk_bf16_f32 v73, v40, v41
  v_mfma_f32_16x16x16_bf16 v[8:11], v[28:29], v[68:69], v[8:11]
  v_cvt_pk_bf16_f32 v31, v24, v25
  v_mov_b64 v[20:21], 0
  v_mfma_f32_16x16x16_bf16 v[0:3], v[28:29], v[72:73], v[0:3]
  ds_read_b128 v[68:71], v76 offset:13824
  v_mov_b64 v[22:23], 0
  v_mfma_f32_16x16x16_bf16 v[4:7], v[30:31], v[72:73], v[4:7]
  v_rcp_f32 v10, v8
  v_rcp_f32 v11, v9
  v_mul_f32 v0, v10, v0
  v_mul_f32 v1, v11, v1
  s_nop 0
  v_mul_f32 v4, v10, v4
  v_mul_f32 v5, v11, v5
  v_cvt_pk_bf16_f32 v2, v0, v4
  ds_write_b32 v79, v2 offset:8704
  v_cvt_pk_bf16_f32 v3, v1, v5
  ds_write_b32 v79, v3 offset:9280
  v_max3_f32 v8, v8, v9, v10
  v_max_f32 v8, v8, v11
  v_cmp_le_f32 vcc, 1317011456, v8
  v_mov_b64 v[24:25], 0
  v_mov_b64 v[26:27], 0
  s_cbranch_vccnz Cs3_mx
Cs3_mxok:
  s_waitcnt lgkmcnt(0)
  s_barrier
  ds_read_b128 v[0:3], v78 offset:8704
  ds_read_b128 v[4:7], v78 offset:8768
  ds_read_b128 v[8:11], v78 offset:8832
  ds_read_b128 v[12:15], v78 offset:8896
  s_waitcnt lgkmcnt(3)
  v_smfmac_f32_16x16x64_bf16 v[16:19], v[0:3], v[44:51], v74
  ds_read_b128 v[52:55], v75 offset:45056
  s_waitcnt lgkmcnt(3)
  v_smfmac_f32_16x16x64_bf16 v[16:19], v[4:7], v[60:67], v74
  ds_read_b128 v[56:59], v75 offset:46080
  s_waitcnt lgkmcnt(3)
  v_smfmac_f32_16x16x64_bf16 v[16:19], v[8:11], a[176:183], v74
  ds_read_b128 v[36:39], v75 offset:47104
  s_waitcnt lgkmcnt(3)
  v_smfmac_f32_16x16x64_bf16 v[16:19], v[12:15], a[184:191], v74
  ds_read_b128 v[40:43], v75 offset:48128
  ds_read_b128 v[44:47], v75 offset:61440
  v_smfmac_f32_16x16x64_bf16 v[20:23], v[0:3], a[192:199], v74
  ds_read_b128 v[48:51], v75 offset:62464
  ds_read_b128 v[60:63], v75 offset:63488
  v_smfmac_f32_16x16x64_bf16 v[20:23], v[4:7], a[200:207], v74
  ds_read_b128 v[64:67], v75 offset:64512
  s_waitcnt lgkmcnt(6)
  v_cvt_pk_bf16_f32 v16, v16, v17
  v_cvt_pk_bf16_f32 v17, v18, v19
  v_bfi_b32 v16, 1, s72, v16
  v_smfmac_f32_16x16x64_bf16 v[20:23], v[8:11], v[52:59], v74
  buffer_store_dwordx2 v[16:17], v68, s[8:11], s73 offen sc1
  s_waitcnt lgkmcnt(4)
  v_smfmac_f32_16x16x64_bf16 v[20:23], v[12:15], v[36:43], v74
  ds_read_b128 v[52:55], v75 offset:8192
  v_mov_b64 v[32:33], 0
  v_smfmac_f32_16x16x64_bf16 v[24:27], v[0:3], a[208:215], v74
  ds_read_b128 v[56:59], v75 offset:9216
  v_mov_b64 v[34:35], 0
  v_smfmac_f32_16x16x64_bf16 v[24:27], v[4:7], a[216:223], v74
  ds_read_b128 v[36:39], v75 offset:10240
  s_waitcnt lgkmcnt(5)
  v_cvt_pk_bf16_f32 v20, v20, v21
  v_cvt_pk_bf16_f32 v21, v22, v23
  v_bfi_b32 v20, 1, s72, v20
  v_smfmac_f32_16x16x64_bf16 v[24:27], v[8:11], v[44:51], v74
  buffer_store_dwordx2 v[20:21], v68, s[8:11], s74 offen sc1
  s_waitcnt lgkmcnt(3)
  v_smfmac_f32_16x16x64_bf16 v[24:27], v[12:15], v[60:67], v74
  ds_read_b128 v[40:43], v75 offset:11264
  v_mov_b64 v[28:29], 0
  v_smfmac_f32_16x16x64_bf16 v[32:35], v[0:3], a[224:231], v74
  ds_read_b128 v[44:47], v75 offset:12288
  ds_read_b128 v[48:51], v75 offset:13312
  v_smfmac_f32_16x16x64_bf16 v[32:35], v[4:7], a[232:239], v74
  ds_read_b128 v[60:63], v75 offset:14336
  v_cvt_pk_bf16_f32 v24, v24, v25
  v_cvt_pk_bf16_f32 v25, v26, v27
  v_bfi_b32 v24, 1, s72, v24
  v_smfmac_f32_16x16x64_bf16 v[32:35], v[8:11], a[240:247], v74
  buffer_store_dwordx2 v[24:25], v68, s[8:11], s75 offen sc1
  v_mov_b64 v[30:31], 0
  v_smfmac_f32_16x16x64_bf16 v[32:35], v[12:15], a[248:255], v74
  ds_read_b128 v[64:67], v75 offset:15360
  s_waitcnt lgkmcnt(6)
  v_smfmac_f32_16x16x64_bf16 v[28:31], v[0:3], v[52:59], v74
  s_waitcnt lgkmcnt(4)
  v_smfmac_f32_16x16x64_bf16 v[28:31], v[4:7], v[36:43], v74
  s_waitcnt lgkmcnt(2)
  v_cvt_pk_bf16_f32 v32, v32, v33
  v_cvt_pk_bf16_f32 v33, v34, v35
  v_bfi_b32 v32, 1, s72, v32
  v_smfmac_f32_16x16x64_bf16 v[28:31], v[8:11], v[44:51], v74
  buffer_store_dwordx2 v[32:33], v68, s[8:11], s76 offen sc1
  s_waitcnt lgkmcnt(0)
  v_smfmac_f32_16x16x64_bf16 v[28:31], v[12:15], v[60:67], v74
  ds_read_b128 v[52:55], v76 offset:14848
  ds_read_b64 v[16:17], v77 offset:392
  v_mov_b64 v[18:19], v[72:73]
  v_xor_b32 v75, 0x8000, v75
  s_nop 3
  v_cvt_pk_bf16_f32 v28, v28, v29
  v_cvt_pk_bf16_f32 v29, v30, v31
  v_bfi_b32 v28, 1, s72, v28
  buffer_store_dwordx2 v[28:29], v68, s[8:11], s77 offen sc1
  v_mov_b64 v[20:21], 0
  v_mov_b64 v[22:23], 0
  v_mov_b64 v[24:25], 0
  v_mov_b64 v[26:27], 0
  v_mov_b64 v[28:29], 0
  v_mov_b64 v[30:31], 0
  v_mov_b64 v[32:33], 0
  v_mov_b64 v[34:35], 0
  v_mov_b32 v68, 14880
  s_add_u32 s58, s58, 655360
  s_add_u32 s59, s59, 655360
  s_add_u32 s70, s70, 655360
  s_add_u32 s68, s68, 655360
  s_add_u32 s66, s66, 1
  s_xor_b32 s64, s64, 16384
  s_xor_b32 s65, s65, 16384
  s_cmp_eq_u32 s66, 62
  s_cselect_b64 s[16:17], s[20:21], s[16:17]
  s_cselect_b32 s18, (Cs3_done - Cs3_last), s18
  s_cselect_b32 s70, 0, s70
  s_cmp_eq_u32 s66, 63
  s_cselect_b32 s59, 268435456, s59
  s_cselect_b32 s58, 268435456, s58
  s_nop 15
  s_nop 15
  s_nop 11
  buffer_load_dwordx4 v[0:3], v76, s[8:11], s60 offen offset:0 sc1
  buffer_load_dwordx4 v[4:7], v76, s[8:11], s60 offen offset:1024 sc1
  buffer_load_dwordx4 v[8:11], v76, s[8:11], s61 offen offset:0 sc1
  buffer_load_dwordx4 v[12:15], v76, s[8:11], s61 offen offset:1024 sc1
  s_waitcnt lgkmcnt(0)
  s_waitcnt vmcnt(3)
  v_mfma_f32_16x16x32_bf16 v[56:59], v[52:55], v[0:3], 0
  v_bitop3_b32 v72, v0, v2, s72 bitop3:0x7e
  s_waitcnt vmcnt(2)
  v_mfma_f32_16x16x32_bf16 v[56:59], v[52:55], v[4:7], v[56:59]
  v_bitop3_b32 v73, v4, v6, s72 bitop3:0x7e
  v_or_b32 v72, v72, v73
  s_waitcnt vmcnt(1)
  v_mfma_f32_16x16x32_bf16 v[36:39], v[52:55], v[8:11], 0
  v_bitop3_b32 v73, v8, v10, s72 bitop3:0x7e
  v_or_b32 v72, v72, v73
  s_waitcnt vmcnt(0)
  v_mfma_f32_16x16x32_bf16 v[36:39], v[52:55], v[12:15], v[36:39]
  v_bitop3_b32 v73, v12, v14, s72 bitop3:0x7e
  v_bitop3_b32 v72, v72, v73, 1 bitop3:0xa8
  v_cmp_ne_u32 vcc, 0, v72
  s_cbranch_vccnz Cs3_h1r
  buffer_load_dwordx4 v[4:7], v76, s[8:11], s65 offen offset:1024 sc1
  v_add_f32_dpp v56, v56, v56 row_ror:4 row_mask:0xf bank_mask:0xf
  v_add_f32_dpp v57, v57, v57 row_ror:4 row_mask:0xf bank_mask:0xf
  v_add_f32_dpp v36, v36, v36 row_ror:4 row_mask:0xf bank_mask:0xf
  v_add_f32_dpp v37, v37, v37 row_ror:4 row_mask:0xf bank_mask:0xf
  v_add_f32_dpp v56, v56, v56 row_ror:8 row_mask:0xf bank_mask:0xf
  v_add_f32_dpp v57, v57, v57 row_ror:8 row_mask:0xf bank_mask:0xf
  v_add_f32_dpp v36, v36, v36 row_ror:8 row_mask:0xf bank_mask:0xf
  v_add_f32_dpp v37, v37, v37 row_ror:8 row_mask:0xf bank_mask:0xf
  v_cvt_pk_bf16_f32 v56, v56, v57
  buffer_store_dword v56, v69, s[8:11], s62 offen sc1
  v_cvt_pk_bf16_f32 v36, v36, v37
  buffer_store_dword v36, v70, s[8:11], s63 offen sc1
  s_xor_b32 s62, s62, 16384
  buffer_store_dword v71, v69, s[8:11], s62 offen sc1
  s_xor_b32 s63, s63, 16384
  buffer_store_dword v71, v70, s[8:11], s63 offen sc1
  s_xor_b32 s72, s72, 1
  s_branch Cs3_h2
Cs3_h1r:
  s_mov_b64 exec, vcc
  buffer_load_dwordx4 v[0:3], v76, s[8:11], s60 offen offset:0 sc1
  buffer_load_dwordx4 v[4:7], v76, s[8:11], s60 offen offset:1024 sc1
  buffer_load_dwordx4 v[8:11], v76, s[8:11], s61 offen offset:0 sc1
  buffer_load_dwordx4 v[12:15], v76, s[8:11], s61 offen offset:1024 sc1
  s_mov_b64 exec, -1
  s_add_u32 s67, s67, 1
  s_waitcnt vmcnt(3)
  v_mfma_f32_16x16x32_bf16 v[56:59], v[52:55], v[0:3], 0
  v_bitop3_b32 v72, v0, v2, s72 bitop3:0x7e
  s_waitcnt vmcnt(2)
  v_mfma_f32_16x16x32_bf16 v[56:59], v[52:55], v[4:7], v[56:59]
  v_bitop3_b32 v73, v4, v6, s72 bitop3:0x7e
  v_or_b32 v72, v72, v73
  s_waitcnt vmcnt(1)
  v_mfma_f32_16x16x32_bf16 v[36:39], v[52:55], v[8:11], 0
  v_bitop3_b32 v73, v8, v10, s72 bitop3:0x7e
  v_or_b32 v72, v72, v73
  s_waitcnt vmcnt(0)
  v_mfma_f32_16x16x32_bf16 v[36:39], v[52:55], v[12:15], v[36:39]
  v_bitop3_b32 v73, v12, v14, s72 bitop3:0x7e
  v_bitop3_b32 v72, v72, v73, 1 bitop3:0xa8
  v_cmp_ne_u32 vcc, 0, v72
  s_cbranch_vccz Cs3_h1p
Cs3_h1s:
  s_mov_b64 exec, vcc
  buffer_load_dwordx4 v[0:3], v76, s[8:11], s60 offen offset:0 sc1
  buffer_load_dwordx4 v[4:7], v76, s[8:11], s60 offen offset:1024 sc1
  buffer_load_dwordx4 v[8:11], v76, s[8:11], s61 offen offset:0 sc1
  buffer_load_dwordx4 v[12:15], v76, s[8:11], s61 offen offset:1024 sc1
  s_mov_b64 exec, -1
  s_add_u32 s67, s67, 1
  s_waitcnt vmcnt(3)
  v_mfma_f32_16x16x32_bf16 v[56:59], v[52:55], v[0:3], 0
  v_bitop3_b32 v72, v0, v2, s72 bitop3:0x7e
  s_waitcnt vmcnt(2)
  v_mfma_f32_16x16x32_bf16 v[56:59], v[52:55], v[4:7], v[56:59]
  v_bitop3_b32 v73, v4, v6, s72 bitop3:0x7e
  v_or_b32 v72, v72, v73
  s_waitcnt vmcnt(1)
  v_mfma_f32_16x16x32_bf16 v[36:39], v[52:55], v[8:11], 0
  v_bitop3_b32 v73, v8, v10, s72 bitop3:0x7e
  v_or_b32 v72, v72, v73
  s_waitcnt vmcnt(0)
  v_mfma_f32_16x16x32_bf16 v[36:39], v[52:55], v[12:15], v[36:39]
  v_bitop3_b32 v73, v12, v14, s72 bitop3:0x7e
  v_bitop3_b32 v72, v72, v73, 1 bitop3:0xa8
  v_cmp_ne_u32 vcc, 0, v72
  s_cbranch_vccz Cs3_h1p
  s_cmp_lt_u32 s67, 131072
  s_cbranch_scc1 Cs3_h1s
Cs3_h1p:
  s_nop 2
  buffer_load_dwordx4 v[4:7], v76, s[8:11], s65 offen offset:1024 sc1
  v_add_f32_dpp v56, v56, v56 row_ror:4 row_mask:0xf bank_mask:0xf
  v_add_f32_dpp v57, v57, v57 row_ror:4 row_mask:0xf bank_mask:0xf
  v_add_f32_dpp v36, v36, v36 row_ror:4 row_mask:0xf bank_mask:0xf
  v_add_f32_dpp v37, v37, v37 row_ror:4 row_mask:0xf bank_mask:0xf
  v_add_f32_dpp v56, v56, v56 row_ror:8 row_mask:0xf bank_mask:0xf
  v_add_f32_dpp v57, v57, v57 row_ror:8 row_mask:0xf bank_mask:0xf
  v_add_f32_dpp v36, v36, v36 row_ror:8 row_mask:0xf bank_mask:0xf
  v_add_f32_dpp v37, v37, v37 row_ror:8 row_mask:0xf bank_mask:0xf
  v_cvt_pk_bf16_f32 v56, v56, v57
  buffer_store_dword v56, v69, s[8:11], s62 offen sc1
  v_cvt_pk_bf16_f32 v36, v36, v37
  buffer_store_dword v36, v70, s[8:11], s63 offen sc1
  s_xor_b32 s62, s62, 16384
  buffer_store_dword v71, v69, s[8:11], s62 offen sc1
  s_xor_b32 s63, s63, 16384
  buffer_store_dword v71, v70, s[8:11], s63 offen sc1
  s_xor_b32 s72, s72, 1
  s_branch Cs3_h2
Cs3_h2r:
  s_mov_b64 exec, vcc
  buffer_load_dwordx4 v[4:7], v76, s[8:11], s65 offen offset:1024 sc1
  s_mov_b64 exec, -1
  s_add_u32 s67, s67, 1
  s_waitcnt vmcnt(3)
  v_max3_u32 v72, v4, v5, v6
  v_max_u32 v72, v72, v7
  ds_write_b128 v76, v[4:7] offset:5632
  v_cmp_eq_u32 vcc, -1, v72
  s_cbranch_vccz Cs3_h2w
Cs3_h2s:
  s_mov_b64 exec, vcc
  buffer_load_dwordx4 v[4:7], v76, s[8:11], s65 offen offset:1024 sc1
  s_mov_b64 exec, -1
  s_add_u32 s67, s67, 1
  s_waitcnt vmcnt(1)
  v_max3_u32 v72, v4, v5, v6
  v_max_u32 v72, v72, v7
  ds_write_b128 v76, v[4:7] offset:5632
  v_cmp_eq_u32 vcc, -1, v72
  s_cbranch_vccz Cs3_h2w
  s_mov_b64 exec, vcc
  buffer_load_dwordx4 v[4:7], v76, s[8:11], s65 offen offset:1024 sc1
  s_mov_b64 exec, -1
  s_add_u32 s67, s67, 1
  s_waitcnt vmcnt(1)
  v_max3_u32 v72, v4, v5, v6
  v_max_u32 v72, v72, v7
  ds_write_b128 v76, v[4:7] offset:5632
  v_cmp_eq_u32 vcc, -1, v72
  s_cbranch_vccz Cs3_h2w
  s_mov_b64 exec, vcc
  buffer_load_dwordx4 v[4:7], v76, s[8:11], s65 offen offset:1024 sc1
  s_mov_b64 exec, -1
  s_add_u32 s67, s67, 1
  s_waitcnt vmcnt(1)
  v_max3_u32 v72, v4, v5, v6
  v_max_u32 v72, v72, v7
  ds_write_b128 v76, v[4:7] offset:5632
  v_cmp_eq_u32 vcc, -1, v72
  s_cbranch_vccz Cs3_h2w
  s_cmp_lt_u32 s67, 131072
  s_cbranch_scc1 Cs3_h2s
  s_branch Cs3_h2w
Cs3_rec:
  s_nop 7
  s_waitcnt vmcnt(0) lgkmcnt(0)
  v_max3_u32 v72, v0, v1, v2
  v_max3_u32 v72, v72, v3, v4
  v_max3_u32 v72, v72, v5, v6
  v_max3_u32 v72, v72, v7, v8
  v_max3_u32 v72, v72, v9, v10
  v_max3_u32 v72, v72, v11, v12
  v_max3_u32 v72, v72, v13, v14
  v_max3_u32 v72, v72, v15, v16
  v_max3_u32 v72, v72, v17, v18
  v_max_u32 v72, v72, v19
  v_cmp_eq_u32 vcc, -1, v72
  s_cbranch_vccz Cs3_recok
  s_barrier
Cs3_recp:
  buffer_load_dwordx4 v[0:3], v76, s[8:11], s64 offen offset:0 sc1
  buffer_load_dwordx4 v[4:7], v76, s[8:11], s64 offen offset:1024 sc1
  buffer_load_dwordx4 v[8:11], v76, s[8:11], s64 offen offset:2048 sc1
  s_add_u32 s67, s67, 1
  s_cmp_lt_u32 s67, 131072
  s_cselect_b32 s54, -2, -1
  s_waitcnt vmcnt(2)
  v_max3_u32 v72, v0, v1, v2
  s_waitcnt vmcnt(1)
  v_max3_u32 v72, v72, v3, v4
  v_max3_u32 v72, v72, v5, v6
  s_waitcnt vmcnt(0)
  v_max3_u32 v72, v72, v7, v8
  v_max3_u32 v72, v72, v9, v10
  v_max_u32 v72, v72, v11
  v_cmp_lt_u32 vcc, s54, v72
  s_cbranch_vccnz Cs3_recp
  ds_write_b128 v76, v[0:3] offset:10752
  ds_write_b128 v76, v[4:7] offset:11776
  ds_write_b128 v76, v[8:11] offset:12800
  v_mov_b64 v[20:21], 0
  v_mov_b64 v[22:23], 0
  v_mov_b64 v[24:25], 0
  v_mov_b64 v[26:27], 0
  v_mov_b64 v[28:29], 0
  v_mov_b64 v[30:31], 0
  v_mov_b64 v[32:33], 0
  v_mov_b64 v[34:35], 0
  s_waitcnt lgkmcnt(0)
  s_barrier
  ds_read_b128 v[0:3], v76 offset:4608
  s_waitcnt lgkmcnt(0)
  v_smfmac_f32_16x16x64_bf16 v[20:23], v[0:3], v[80:87], v74
  v_smfmac_f32_16x16x64_bf16 v[24:27], v[0:3], v[88:95], v74
  ds_read_b128 v[60:63], v76 offset:28672
  ds_read_b128 v[64:67], v76 offset:29696
  s_waitcnt lgkmcnt(0)
  v_smfmac_f32_16x16x64_bf16 v[28:31], v[0:3], v[60:67], v74
  ds_read_b128 v[60:63], v76 offset:30720
  ds_read_b128 v[64:67], v76 offset:31744
  s_waitcnt lgkmcnt(0)
  v_smfmac_f32_16x16x64_bf16 v[32:35], v[0:3], v[60:67], v74
  ds_read_b128 v[4:7], v76 offset:5632
  s_waitcnt lgkmcnt(0)
  v_smfmac_f32_16x16x64_bf16 v[20:23], v[4:7], v[96:103], v74
  v_smfmac_f32_16x16x64_bf16 v[24:27], v[4:7], v[104:111], v74
  ds_read_b128 v[60:63], v76 offset:45056
  ds_read_b128 v[64:67], v76 offset:46080
  s_waitcnt lgkmcnt(0)
  v_smfmac_f32_16x16x64_bf16 v[28:31], v[4:7], v[60:67], v74
  ds_read_b128 v[60:63], v76 offset:47104
  ds_read_b128 v[64:67], v76 offset:48128
  s_waitcnt lgkmcnt(0)
  v_smfmac_f32_16x16x64_bf16 v[32:35], v[4:7], v[60:67], v74
  ds_read_b128 v[8:11], v76 offset:6656
  s_waitcnt lgkmcnt(0)
  v_smfmac_f32_16x16x64_bf16 v[20:23], v[8:11], v[112:119], v74
  v_smfmac_f32_16x16x64_bf16 v[24:27], v[8:11], v[120:127], v74
  v_smfmac_f32_16x16x64_bf16 v[28:31], v[8:11], v[208:215], v74
  v_smfmac_f32_16x16x64_bf16 v[32:35], v[8:11], v[216:223], v74
  ds_read_b128 v[12:15], v76 offset:7680
  s_waitcnt lgkmcnt(0)
  v_smfmac_f32_16x16x64_bf16 v[20:23], v[12:15], v[128:135], v74
  v_smfmac_f32_16x16x64_bf16 v[24:27], v[12:15], v[136:143], v74
  v_smfmac_f32_16x16x64_bf16 v[28:31], v[12:15], v[224:231], v74
  v_smfmac_f32_16x16x64_bf16 v[32:35], v[12:15], v[232:239], v74
  ds_read_b128 v[4:7], v76 offset:8704
  s_waitcnt lgkmcnt(0)
  v_smfmac_f32_16x16x64_bf16 v[20:23], v[4:7], v[144:151], v74
  v_smfmac_f32_16x16x64_bf16 v[24:27], v[4:7], v[152:159], v74
  ds_read_b128 v[60:63], v76 offset:61440
  ds_read_b128 v[64:67], v76 offset:62464
  s_waitcnt lgkmcnt(0)
  v_smfmac_f32_16x16x64_bf16 v[28:31], v[4:7], v[60:67], v74
  ds_read_b128 v[60:63], v76 offset:63488
  ds_read_b128 v[64:67], v76 offset:64512
  s_waitcnt lgkmcnt(0)
  v_smfmac_f32_16x16x64_bf16 v[32:35], v[4:7], v[60:67], v74
  ds_read_b128 v[8:11], v76 offset:9728
  s_waitcnt lgkmcnt(0)
  v_smfmac_f32_16x16x64_bf16 v[20:23], v[8:11], v[160:167], v74
  v_smfmac_f32_16x16x64_bf16 v[24:27], v[8:11], v[168:175], v74
  ds_read_b128 v[60:63], v75 offset:28672
  ds_read_b128 v[64:67], v75 offset:29696
  s_waitcnt lgkmcnt(0)
  v_smfmac_f32_16x16x64_bf16 v[28:31], v[8:11], v[60:67], v74
  ds_read_b128 v[60:63], v75 offset:30720
  ds_read_b128 v[64:67], v75 offset:31744
  s_waitcnt lgkmcnt(0)
  v_smfmac_f32_16x16x64_bf16 v[32:35], v[8:11], v[60:67], v74
  ds_read_b128 v[16:19], v76 offset:10752
  ds_read_b128 v[60:63], v75 offset:12288
  ds_read_b128 v[64:67], v75 offset:13312
  s_waitcnt lgkmcnt(0)
  v_smfmac_f32_16x16x64_bf16 v[20:23], v[16:19], v[60:67], v74
  ds_read_b128 v[60:63], v75 offset:14336
  ds_read_b128 v[64:67], v75 offset:15360
  s_waitcnt lgkmcnt(0)
  v_smfmac_f32_16x16x64_bf16 v[24:27], v[16:19], v[60:67], v74
  v_smfmac_f32_16x16x64_bf16 v[28:31], v[16:19], v[240:247], v74
  v_smfmac_f32_16x16x64_bf16 v[32:35], v[16:19], v[248:255], v74
  ds_read_b128 v[0:3], v76 offset:11776
  s_waitcnt lgkmcnt(0)
  v_smfmac_f32_16x16x64_bf16 v[20:23], v[0:3], v[176:183], v74
  v_smfmac_f32_16x16x64_bf16 v[24:27], v[0:3], v[184:191], v74
  v_smfmac_f32_16x16x64_bf16 v[28:31], v[0:3], a[0:7], v74
  v_smfmac_f32_16x16x64_bf16 v[32:35], v[0:3], a[8:15], v74
  ds_read_b128 v[12:15], v76 offset:12800
  s_waitcnt lgkmcnt(0)
  v_smfmac_f32_16x16x64_bf16 v[20:23], v[12:15], v[192:199], v74
  v_smfmac_f32_16x16x64_bf16 v[24:27], v[12:15], v[200:207], v74
  v_smfmac_f32_16x16x64_bf16 v[28:31], v[12:15], a[16:23], v74
  v_smfmac_f32_16x16x64_bf16 v[32:35], v[12:15], a[24:31], v74
  v_add_f32 v20, v20, v22
  v_add_f32 v21, v21, v23
  v_add_f32 v24, v24, v26
  v_cvt_pk_bf16_f32 v22, v20, v24
  s_nop 0
  ds_write_b32 v79, v22 offset:0
  v_add_f32 v25, v25, v27
  v_cvt_pk_bf16_f32 v23, v21, v25
  ds_write_b32 v79, v23 offset:576
  v_add_f32 v28, v28, v30
  v_add_f32 v29, v29, v31
  s_waitcnt lgkmcnt(0)
  s_nop 1
  s_branch Cs3_recok
Cs3_mx:
  s_waitcnt lgkmcnt(0)
  s_barrier
  buffer_load_dwordx4 v[0:3], v76, s[8:11], s58 offen offset:0 sc1
  ds_read_b128 v[20:23], v77 offset:0
  ds_read_b128 v[28:31], v77 offset:256
  buffer_load_dwordx4 v[4:7], v76, s[8:11], s58 offen offset:1024 sc1
  ds_read_b128 v[24:27], v77 offset:128
  ds_read_b128 v[32:35], v77 offset:384
  s_waitcnt vmcnt(1) lgkmcnt(3)
  v_mfma_f32_16x16x32_bf16 v[8:11], v[0:3], v[20:23], 0
  s_waitcnt vmcnt(0) lgkmcnt(1)
  v_mfma_f32_16x16x32_bf16 v[8:11], v[4:7], v[24:27], v[8:11]
  v_mfma_f32_16x16x32_bf16 v[12:15], v[28:31], v[20:23], 0
  s_waitcnt lgkmcnt(0)
  v_mfma_f32_16x16x32_bf16 v[12:15], v[32:35], v[24:27], v[12:15]
  v_add_f32_dpp v8, v10, v8 quad_perm:[2,3,0,1] row_mask:0xf bank_mask:0xf
  v_add_f32_dpp v9, v11, v9 quad_perm:[2,3,0,1] row_mask:0xf bank_mask:0xf
  s_nop 0
  v_mov_b32_dpp v8, v8 quad_perm:[0,1,0,1] row_mask:0xf bank_mask:0xf
  v_mov_b32_dpp v9, v9 quad_perm:[0,1,0,1] row_mask:0xf bank_mask:0xf
  s_nop 1
  v_add_f32_dpp v12, v14, v12 quad_perm:[2,3,0,1] row_mask:0xf bank_mask:0xf
  v_add_f32_dpp v13, v15, v13 quad_perm:[2,3,0,1] row_mask:0xf bank_mask:0xf
  s_nop 0
  v_mov_b32_dpp v12, v12 quad_perm:[0,1,0,1] row_mask:0xf bank_mask:0xf
  v_mov_b32_dpp v13, v13 quad_perm:[0,1,0,1] row_mask:0xf bank_mask:0xf
  v_mul_f32 v12, s69, v12
  ds_write_b32 v78, v8 offset:8716
  v_mul_f32 v13, s69, v13
  ds_write_b32 v78, v9 offset:8780
  s_waitcnt lgkmcnt(0)
  s_barrier
  ds_read_b128 v[36:39], v78 offset:8704
  ds_read_b128 v[40:43], v78 offset:8768
  s_waitcnt lgkmcnt(0)
  s_barrier
  v_max_f32 v16, v36, v37
  v_max3_f32 v16, v16, v38, v39
  v_max3_f32 v16, v16, v40, v41
  v_max3_f32 v16, v16, v42, v43
  v_max3_f32 v16, v16, v12, v13
  v_mov_b32 v17, v16
  s_nop 1
  v_permlane16_swap_b32 v16, v17
  v_max_f32 v16, v16, v17
  v_mov_b32 v17, v16
  s_nop 1
  v_permlane32_swap_b32 v16, v17
  v_max_f32 v16, v16, v17
  v_sub_f32 v36, v36, v16
  v_sub_f32 v37, v37, v16
  v_sub_f32 v38, v38, v16
  v_sub_f32 v39, v39, v16
  v_sub_f32 v40, v40, v16
  v_sub_f32 v41, v41, v16
  v_sub_f32 v42, v42, v16
  v_sub_f32 v43, v43, v16
  v_sub_f32 v12, v12, v16
  v_sub_f32 v13, v13, v16
  v_exp_f32 v36, v36
  v_exp_f32 v37, v37
  v_exp_f32 v38, v38
  v_exp_f32 v39, v39
  v_exp_f32 v40, v40
  v_exp_f32 v41, v41
  v_exp_f32 v42, v42
  v_exp_f32 v43, v43
  v_exp_f32 v12, v12
  v_exp_f32 v13, v13
  v_cvt_pk_bf16_f32 v32, v36, v40
  v_cvt_pk_bf16_f32 v33, v37, v41
  v_cvt_pk_bf16_f32 v34, v38, v42
  v_cvt_pk_bf16_f32 v35, v39, v43
  v_cvt_pk_bf16_f32 v28, v12, v13
  v_cvt_pk_bf16_f32 v31, v12, v13
  v_mov_b32 v29, 0
  v_mov_b32 v30, 0
  v_mov_b32 v68, 0x3f803f80
  v_mov_b32 v69, 0x3f803f80
  v_mov_b32 v70, 0x3f803f80
  v_mov_b32 v71, 0x3f803f80
  s_nop 1
  v_mfma_f32_16x16x32_bf16 v[8:11], v[32:35], v[68:71], 0
  v_mfma_f32_16x16x32_bf16 v[0:3], v[32:35], v[52:55], 0
  v_mfma_f32_16x16x32_bf16 v[4:7], v[32:35], v[56:59], 0
  v_mfma_f32_16x16x16_bf16 v[8:11], v[28:29], v[68:69], v[8:11]
  v_mfma_f32_16x16x16_bf16 v[0:3], v[28:29], v[72:73], v[0:3]
  v_mfma_f32_16x16x16_bf16 v[4:7], v[30:31], v[72:73], v[4:7]
  ds_read_b128 v[68:71], v76 offset:13824
  v_rcp_f32 v10, v8
  v_rcp_f32 v11, v9
  v_mul_f32 v0, v10, v0
  v_mul_f32 v1, v11, v1
  s_nop 0
  v_mul_f32 v4, v10, v4
  v_mul_f32 v5, v11, v5
  v_cvt_pk_bf16_f32 v2, v0, v4
  ds_write_b32 v79, v2 offset:8704
  v_cvt_pk_bf16_f32 v3, v1, v5
  ds_write_b32 v79, v3 offset:9280
  v_mov_b64 v[16:17], 0
  v_mov_b64 v[18:19], 0
  v_mov_b64 v[20:21], 0
  v_mov_b64 v[22:23], 0
  v_mov_b64 v[24:25], 0
  v_mov_b64 v[26:27], 0
  s_branch Cs3_mxok
Cs3_last:
  ds_read_b128 v[0:3], v76 offset:4608
  ds_read_b128 v[12:15], v76 offset:7680
  ds_read_b128 v[44:47], v76 offset:28672
  ds_read_b128 v[48:51], v76 offset:29696
  s_nop 5
  v_mov_b64 v[20:21], 0
  v_mov_b64 v[22:23], 0
  v_mov_b64 v[24:25], 0
  v_mov_b64 v[26:27], 0
  v_smfmac_f32_16x16x64_bf16 v[28:31], v[4:7], v[36:43], v74
  ds_read_b128 v[36:39], v76 offset:30720
  ds_read_b128 v[40:43], v76 offset:31744
  v_smfmac_f32_16x16x64_bf16 v[32:35], v[4:7], v[60:67], v74
  s_waitcnt lgkmcnt(5)
  v_smfmac_f32_16x16x64_bf16 v[20:23], v[0:3], a[32:39], v74
  ds_read_b128 v[60:63], v76 offset:61440
  ds_read_b128 v[64:67], v76 offset:62464
  v_smfmac_f32_16x16x64_bf16 v[24:27], v[0:3], a[40:47], v74
  s_waitcnt lgkmcnt(4)
  v_smfmac_f32_16x16x64_bf16 v[20:23], v[4:7], a[48:55], v74
  buffer_store_dwordx4 v[16:19], v76, s[8:11], s68 offen sc1
  v_smfmac_f32_16x16x64_bf16 v[24:27], v[4:7], a[56:63], v74
  v_smfmac_f32_16x16x64_bf16 v[28:31], v[0:3], v[44:51], v74
  s_waitcnt lgkmcnt(2)
  v_smfmac_f32_16x16x64_bf16 v[20:23], v[8:11], a[64:71], v74
  ds_read_b128 v[44:47], v76 offset:63488
  ds_read_b128 v[48:51], v76 offset:64512
  v_smfmac_f32_16x16x64_bf16 v[24:27], v[8:11], a[72:79], v74
  v_smfmac_f32_16x16x64_bf16 v[32:35], v[0:3], v[36:43], v74
  v_smfmac_f32_16x16x64_bf16 v[28:31], v[8:11], v[208:215], v74
  ds_read_b128 v[36:39], v75 offset:28672
  ds_read_b128 v[40:43], v75 offset:29696
  v_smfmac_f32_16x16x64_bf16 v[32:35], v[8:11], v[216:223], v74
  v_smfmac_f32_16x16x64_bf16 v[20:23], v[12:15], a[80:87], v74
  v_smfmac_f32_16x16x64_bf16 v[24:27], v[12:15], a[88:95], v74
  v_smfmac_f32_16x16x64_bf16 v[28:31], v[12:15], v[224:231], v74
  v_smfmac_f32_16x16x64_bf16 v[32:35], v[12:15], v[232:239], v74
  s_waitcnt vmcnt(1)
  s_barrier
Cs3_lastr:
  ds_read_b128 v[4:7], v76 offset:8704
  ds_read_b128 v[8:11], v76 offset:9728
  ds_read_b128 v[16:19], v76 offset:10752
  ds_read_b128 v[0:3], v76 offset:11776
  ds_read_b128 v[12:15], v76 offset:12800
  s_waitcnt lgkmcnt(1)
  v_max3_u32 v72, v0, v1, v2
  v_max3_u32 v72, v72, v3, v4
  v_max3_u32 v72, v72, v5, v6
  v_max3_u32 v72, v72, v7, v8
  v_max3_u32 v72, v72, v9, v10
  s_waitcnt lgkmcnt(0)
  v_max3_u32 v72, v72, v11, v12
  v_max3_u32 v72, v72, v13, v14
  v_max3_u32 v72, v72, v15, v16
  v_max3_u32 v72, v72, v17, v18
  v_max_u32 v72, v72, v19
  v_cmp_eq_u32 vcc, -1, v72
  s_cbranch_vccnz Cs3_lastp
Cs3_lastg:
  v_smfmac_f32_16x16x64_bf16 v[28:31], v[4:7], v[60:67], v74
  ds_read_b128 v[60:63], v75 offset:30720
  ds_read_b128 v[64:67], v75 offset:31744
  v_smfmac_f32_16x16x64_bf16 v[32:35], v[4:7], v[44:51], v74
  v_smfmac_f32_16x16x64_bf16 v[28:31], v[8:11], v[36:43], v74
  v_smfmac_f32_16x16x64_bf16 v[28:31], v[16:19], v[240:247], v74
  v_smfmac_f32_16x16x64_bf16 v[28:31], v[0:3], a[0:7], v74
  v_smfmac_f32_16x16x64_bf16 v[28:31], v[12:15], a[16:23], v74
  v_smfmac_f32_16x16x64_bf16 v[32:35], v[16:19], v[248:255], v74
  v_smfmac_f32_16x16x64_bf16 v[32:35], v[0:3], a[8:15], v74
  s_waitcnt lgkmcnt(0)
  v_smfmac_f32_16x16x64_bf16 v[32:35], v[12:15], a[24:31], v74
  v_smfmac_f32_16x16x64_bf16 v[32:35], v[8:11], v[60:67], v74
  v_smfmac_f32_16x16x64_bf16 v[20:23], v[4:7], a[96:103], v74
  v_smfmac_f32_16x16x64_bf16 v[20:23], v[8:11], a[112:119], v74
  v_add_f32 v28, v28, v30
  v_add_f32 v32, v32, v34
  v_cvt_pk_bf16_f32 v30, v28, v32
  v_smfmac_f32_16x16x64_bf16 v[20:23], v[16:19], a[128:135], v74
  ds_write_b32 v79, v30 offset:256
  v_add_f32 v29, v29, v31
  v_add_f32 v33, v33, v35
  v_cvt_pk_bf16_f32 v31, v29, v33
  v_smfmac_f32_16x16x64_bf16 v[20:23], v[0:3], a[144:151], v74
  ds_write_b32 v79, v31 offset:832
  v_smfmac_f32_16x16x64_bf16 v[20:23], v[12:15], a[160:167], v74
  v_smfmac_f32_16x16x64_bf16 v[24:27], v[4:7], a[104:111], v74
  v_smfmac_f32_16x16x64_bf16 v[24:27], v[8:11], a[120:127], v74
  v_smfmac_f32_16x16x64_bf16 v[24:27], v[16:19], a[136:143], v74
  s_waitcnt lgkmcnt(0)
  s_barrier
  ds_read_b64 v[52:53], v77 offset:392
  v_add_f32 v20, v20, v22
  v_smfmac_f32_16x16x64_bf16 v[24:27], v[0:3], a[152:159], v74
  v_add_f32 v21, v21, v23
  v_smfmac_f32_16x16x64_bf16 v[24:27], v[12:15], a[168:175], v74
  v_cvt_pk_bf16_f32 v54, v20, v21
  s_add_u32 s68, s68, 655360
  s_nop 3
  v_add_f32 v24, v24, v26
  v_add_f32 v25, v25, v27
  v_cvt_pk_bf16_f32 v55, v24, v25
  s_waitcnt lgkmcnt(0)
  buffer_store_dwordx4 v[52:55], v76, s[8:11], s68 offen sc1
  s_branch Cs3_done
Cs3_lastp:
  s_add_u32 s72, s72, 2
  s_cmp_ge_u32 s72, 131072
  s_cbranch_scc1 Cs3_lastg
  s_barrier
  buffer_load_dwordx4 v76, s[8:11], s55 offen offset:0 sc1 lds
  buffer_load_dwordx4 v76, s[8:11], s55 offen offset:1024 sc1 lds
  s_waitcnt vmcnt(0)
  s_barrier
  s_branch Cs3_lastr
Cs3_done:
  s_branch L_cexit
L_conf:
  s_waitcnt vmcnt(0) lgkmcnt(0)
  s_barrier
  s_cmp_eq_u32 s52, 0
  s_cbranch_scc0 L_cf2
  s_mov_b64 exec, 1
  s_lshl_b32 s57, s2, 2
  v_mov_b32 v1, 0
L_cf0:
  s_cmp_eq_u32 s54, -1
  s_cbranch_scc1 L_cf1
  s_mov_b32 s55, s54
  s_lshr_b64 s[54:55], s[54:55], s0
  s_ff0_i32_b32 s56, s54
  s_add_u32 s0, s0, s56
  s_and_b32 s0, s0, 31
  s_lshl_b32 s56, 1, s0
  v_mov_b32 v35, s56
  buffer_atomic_or v35, v1, s[12:15], s57 offen sc0
  s_waitcnt vmcnt(0)
  v_readfirstlane_b32 s54, v35
  s_nop 0
  s_bitcmp1_b32 s54, s0
  s_cbranch_scc1 L_cf0
  v_mov_b32 v35, s0
  s_branch L_cf3
L_cf1:
  v_mov_b32 v35, 1
  buffer_atomic_add v35, v1, s[12:15], 0 offen offset:40 sc0
  s_waitcnt vmcnt(0)
  v_add_u32 v35, 32, v35
L_cf3:
  ds_write_b32 v33, v35
  s_mov_b64 exec, -1
  s_waitcnt lgkmcnt(0)
L_cf2:
  s_barrier
  ds_read_b32 v32, v33
  s_waitcnt lgkmcnt(0)
  v_readfirstlane_b32 s0, v32
  s_mov_b32 s1, 1
  s_cmp_lt_u32 s0, 32
  s_cbranch_scc1 L_role
  s_sub_u32 s53, s0, 32
  s_mov_b32 s57, 0
L_sur:
  s_load_dwordx16 s[60:75], s[12:13], 0 glc
  s_add_u32 s57, s57, 1
  s_waitcnt lgkmcnt(0)
  s_mov_b32 s55, s70
  s_bcnt1_i32_b32 s56, s60
  s_add_u32 s55, s55, s56
  s_bcnt1_i32_b32 s56, s61
  s_add_u32 s55, s55, s56
  s_bcnt1_i32_b32 s56, s62
  s_add_u32 s55, s55, s56
  s_bcnt1_i32_b32 s56, s63
  s_add_u32 s55, s55, s56
  s_bcnt1_i32_b32 s56, s64
  s_add_u32 s55, s55, s56
  s_bcnt1_i32_b32 s56, s65
  s_add_u32 s55, s55, s56
  s_bcnt1_i32_b32 s56, s66
  s_add_u32 s55, s55, s56
  s_bcnt1_i32_b32 s56, s67
  s_add_u32 s55, s55, s56
  s_cmp_ge_u32 s57, 131072
  s_cbranch_scc1 L_end
  s_cmp_lt_u32 s55, 256
  s_cbranch_scc1 L_sur
  s_mov_b32 s2, 0
  s_mov_b32 s54, s60
  s_bcnt0_i32_b32 s56, s54
  s_cmp_lt_u32 s53, s56
  s_cbranch_scc1 L_sur2
  s_sub_u32 s53, s53, s56
  s_mov_b32 s2, 1
  s_mov_b32 s54, s61
  s_bcnt0_i32_b32 s56, s54
  s_cmp_lt_u32 s53, s56
  s_cbranch_scc1 L_sur2
  s_sub_u32 s53, s53, s56
  s_mov_b32 s2, 2
  s_mov_b32 s54, s62
  s_bcnt0_i32_b32 s56, s54
  s_cmp_lt_u32 s53, s56
  s_cbranch_scc1 L_sur2
  s_sub_u32 s53, s53, s56
  s_mov_b32 s2, 3
  s_mov_b32 s54, s63
  s_bcnt0_i32_b32 s56, s54
  s_cmp_lt_u32 s53, s56
  s_cbranch_scc1 L_sur2
  s_sub_u32 s53, s53, s56
  s_mov_b32 s2, 4
  s_mov_b32 s54, s64
  s_bcnt0_i32_b32 s56, s54
  s_cmp_lt_u32 s53, s56
  s_cbranch_scc1 L_sur2
  s_sub_u32 s53, s53, s56
  s_mov_b32 s2, 5
  s_mov_b32 s54, s65
  s_bcnt0_i32_b32 s56, s54
  s_cmp_lt_u32 s53, s56
  s_cbranch_scc1 L_sur2
  s_sub_u32 s53, s53, s56
  s_mov_b32 s2, 6
  s_mov_b32 s54, s66
  s_bcnt0_i32_b32 s56, s54
  s_cmp_lt_u32 s53, s56
  s_cbranch_scc1 L_sur2
  s_sub_u32 s53, s53, s56
  s_mov_b32 s2, 7
  s_mov_b32 s54, s67
  s_bcnt0_i32_b32 s56, s54
  s_cmp_lt_u32 s53, s56
  s_cbranch_scc1 L_sur2
  s_sub_u32 s53, s53, s56
  s_branch L_end
L_sur2:
  s_ff0_i32_b32 s0, s54
  s_bitset1_b32 s54, s0
  s_sub_u32 s53, s53, 1
  s_cbranch_scc0 L_sur2
  s_branch L_role
L_worker:
  s_lshl_b32 s54, s2, 2
  s_lshr_b32 s54, 1412567136, s54
  s_and_b32 s54, s54, 7
  s_lshl_b32 s54, s54, 5
  s_add_u32 s53, s53, s54
  s_getpc_b64 s[80:81]
L_pc_2:
  s_and_b32 s55, s0, 1
  s_lshl_b32 s55, s55, 2
  s_add_u32 s55, s55, s52
  s_lshl_b32 s55, s55, 13
  v_and_b32 v199, 63, v0
  v_lshl_add_u32 v199, v199, 7, s55
  s_sub_u32 s82, s80, (L_pc_2 - L_w0)
  s_subb_u32 s83, s81, 0
  v_min_u32 v198, (L_w4 - L_w0), v199
  global_load_dword v196, v198, s[82:83]
  v_min_u32 v199, (L_end - L_pc_2), v199
  global_load_dword v196, v199, s[80:81]
  v_and_b32 v200, 63, v0
  v_lshlrev_b32 v201, 4, v200
  v_lshrrev_b32 v211, 3, v200
  s_lshl_b32 s54, s52, 3
  v_add_u32 v211, s54, v211
  v_bfe_u32 v212, v211, 1, 3
  v_and_b32 v213, 7, v200
  v_xor_b32 v212, v212, v213
  v_mul_u32_u24 v211, 1152, v211
  v_lshl_add_u32 v202, v212, 4, v211
  s_mul_i32 s67, s52, 9216
  v_and_b32 v211, 31, v200
  v_lshrrev_b32 v212, 3, v211
  v_mul_u32_u24 v212, 9216, v212
  v_and_b32 v213, 7, v211
  v_lshl_add_u32 v212, v213, 7, v212
  v_bfe_u32 v213, v211, 1, 3
  v_lshrrev_b32 v214, 5, v200
  v_xor_b32 v213, v213, v214
  v_lshl_add_u32 v203, v213, 4, v212
  v_xor_b32 v204, 32, v203
  v_xor_b32 v205, 64, v203
  v_xor_b32 v206, 0x60, v203
  v_bfe_u32 v211, v200, 2, 2
  v_lshl_add_u32 v212, v214, 3, v211
  v_lshlrev_b32 v212, 8, v212
  v_xor_b32 v211, s52, v211
  v_lshl_add_u32 v212, v211, 6, v212
  v_bfe_u32 v213, v200, 4, 1
  v_and_b32 v211, 3, v200
  v_lshl_add_u32 v210, v213, 5, v212
  v_lshl_add_u32 v210, v211, 3, v210
  v_lshl_add_u32 v209, v213, 4, v212
  v_and_b32 v213, 1, v211
  v_lshl_add_u32 v209, v213, 3, v209
  v_lshrrev_b32 v213, 1, v211
  v_lshl_add_u32 v209, v213, 5, v209
  s_mov_b32 s65, 0
  s_mul_i32 s58, s53, 9363
  s_lshr_b32 s58, s58, 16
  s_mul_i32 s54, s58, 7
  s_sub_u32 s59, s53, s54
  s_mul_i32 s60, s59, 36864
  s_add_u32 m0, s67, 0
  s_nop 0
  buffer_load_dwordx4 v202, s[4:7], s60 offen offset:0 lds
  s_add_u32 m0, s67, 896
  s_nop 0
  buffer_load_dwordx4 v202, s[4:7], s60 offen offset:128 lds
  s_add_u32 m0, s67, 1792
  s_nop 0
  buffer_load_dwordx4 v202, s[4:7], s60 offen offset:256 lds
  s_add_u32 m0, s67, 2688
  s_nop 0
  buffer_load_dwordx4 v202, s[4:7], s60 offen offset:384 lds
  s_add_u32 m0, s67, 3584
  s_nop 0
  buffer_load_dwordx4 v202, s[4:7], s60 offen offset:512 lds
  s_add_u32 m0, s67, 4480
  s_nop 0
  buffer_load_dwordx4 v202, s[4:7], s60 offen offset:640 lds
  s_add_u32 m0, s67, 5376
  s_nop 0
  buffer_load_dwordx4 v202, s[4:7], s60 offen offset:768 lds
  s_add_u32 m0, s67, 6272
  s_nop 0
  buffer_load_dwordx4 v202, s[4:7], s60 offen offset:896 lds
  s_add_u32 m0, s67, 7168
  s_nop 0
  buffer_load_dwordx4 v202, s[4:7], s60 offen offset:1024 lds
  v_lshrrev_b32 v211, 4, v200
  v_lshlrev_b32 v212, 2, v211
  v_and_b32 v213, 15, v200
  v_xor_b32 v212, v212, v213
  v_lshlrev_b32 v212, 4, v212
  v_lshl_add_u32 v207, v211, 13, v212
  s_lshl_b32 s62, s58, 8
  s_lshl_b32 s54, s52, 15
  s_add_u32 s62, s62, s54
  s_lshl_b32 s61, s52, 10
  s_add_u32 s61, s61, 36864
  s_add_u32 m0, s61, 0
  s_add_u32 s54, s62, 0
  buffer_load_dwordx4 v207, s[20:23], s54 offen lds
  s_add_u32 m0, s61, 4096
  s_add_u32 s54, s62, 131072
  buffer_load_dwordx4 v207, s[20:23], s54 offen lds
  s_add_u32 m0, s61, 8192
  s_add_u32 s54, s62, 262144
  buffer_load_dwordx4 v207, s[20:23], s54 offen lds
  s_add_u32 m0, s61, 12288
  s_add_u32 s54, s62, 393216
  buffer_load_dwordx4 v207, s[20:23], s54 offen lds
  s_add_u32 m0, s61, 16384
  s_add_u32 s54, s62, 0
  buffer_load_dwordx4 v207, s[24:27], s54 offen lds
  s_add_u32 m0, s61, 20480
  s_add_u32 s54, s62, 131072
  buffer_load_dwordx4 v207, s[24:27], s54 offen lds
  s_add_u32 m0, s61, 24576
  s_add_u32 s54, s62, 262144
  buffer_load_dwordx4 v207, s[24:27], s54 offen lds
  s_add_u32 m0, s61, 28672
  s_add_u32 s54, s62, 393216
  buffer_load_dwordx4 v207, s[24:27], s54 offen lds
  s_add_u32 m0, s61, 32768
  s_add_u32 s54, s62, 524288
  buffer_load_dwordx4 v207, s[20:23], s54 offen lds
  s_add_u32 m0, s61, 36864
  s_add_u32 s54, s62, 655360
  buffer_load_dwordx4 v207, s[20:23], s54 offen lds
  s_add_u32 m0, s61, 40960
  s_add_u32 s54, s62, 786432
  buffer_load_dwordx4 v207, s[20:23], s54 offen lds
  s_add_u32 m0, s61, 45056
  s_add_u32 s54, s62, 917504
  buffer_load_dwordx4 v207, s[20:23], s54 offen lds
  s_add_u32 m0, s61, 49152
  s_add_u32 s54, s62, 524288
  buffer_load_dwordx4 v207, s[24:27], s54 offen lds
  s_add_u32 m0, s61, 53248
  s_add_u32 s54, s62, 655360
  buffer_load_dwordx4 v207, s[24:27], s54 offen lds
  s_add_u32 m0, s61, 57344
  s_add_u32 s54, s62, 786432
  buffer_load_dwordx4 v207, s[24:27], s54 offen lds
  s_add_u32 m0, s61, 61440
  s_add_u32 s54, s62, 917504
  buffer_load_dwordx4 v207, s[24:27], s54 offen lds
  s_add_u32 m0, s61, 65536
  s_add_u32 s54, s62, 1048576
  buffer_load_dwordx4 v207, s[20:23], s54 offen lds
  s_add_u32 m0, s61, 69632
  s_add_u32 s54, s62, 1179648
  buffer_load_dwordx4 v207, s[20:23], s54 offen lds
  s_add_u32 m0, s61, 73728
  s_add_u32 s54, s62, 1310720
  buffer_load_dwordx4 v207, s[20:23], s54 offen lds
  s_add_u32 m0, s61, 77824
  s_add_u32 s54, s62, 1441792
  buffer_load_dwordx4 v207, s[20:23], s54 offen lds
  s_add_u32 m0, s61, 81920
  s_add_u32 s54, s62, 1048576
  buffer_load_dwordx4 v207, s[24:27], s54 offen lds
  s_add_u32 m0, s61, 86016
  s_add_u32 s54, s62, 1179648
  buffer_load_dwordx4 v207, s[24:27], s54 offen lds
  s_add_u32 m0, s61, 90112
  s_add_u32 s54, s62, 1310720
  buffer_load_dwordx4 v207, s[24:27], s54 offen lds
  s_add_u32 m0, s61, 94208
  s_add_u32 s54, s62, 1441792
  buffer_load_dwordx4 v207, s[24:27], s54 offen lds
  v_bfe_u32 v211, v200, 3, 2
  v_lshlrev_b32 v216, 11, v211
  v_bfe_u32 v211, v200, 1, 2
  v_lshl_add_u32 v216, v211, 6, v216
  v_lshrrev_b32 v212, 5, v200
  v_lshl_add_u32 v216, v212, 5, v216
  v_and_b32 v211, 1, v200
  v_lshl_add_u32 v216, v211, 4, v216
  v_bfe_u32 v211, v200, 4, 1
  v_lshlrev_b32 v217, 10, v211
  v_lshl_add_u32 v217, v212, 9, v217
  v_and_b32 v211, 15, v200
  v_lshl_add_u32 v217, v211, 4, v217
  s_lshl_b32 s54, s52, 11
  s_add_u32 s54, s54, 8192
  v_add_u32 v217, s54, v217
  s_cmp_eq_u32 s1, 1
  s_cbranch_scc1 W_ver_ok
  v_mov_b32 v33, 163832
  s_cmp_eq_u32 s52, 0
  s_cbranch_scc0 W_ver_b
  s_waitcnt vmcnt(35)
  s_mov_b64 exec, 1
  ds_write_b32 v33, v35
  s_mov_b64 exec, -1
  s_waitcnt lgkmcnt(0)
W_ver_b:
  s_barrier
  ds_read_b32 v32, v33
  s_waitcnt lgkmcnt(0)
  v_readfirstlane_b32 s54, v32
  s_nop 0
  s_bitcmp1_b32 s54, s0
  s_cbranch_scc1 L_conf
W_ver_ok:
  s_waitcnt vmcnt(20) lgkmcnt(0)
  s_barrier
  s_add_u32 m0, s61, 98304
  s_add_u32 s54, s62, 1572864
  buffer_load_dwordx4 v207, s[20:23], s54 offen lds
  s_add_u32 m0, s61, 102400
  s_add_u32 s54, s62, 1703936
  buffer_load_dwordx4 v207, s[20:23], s54 offen lds
  s_add_u32 m0, s61, 106496
  s_add_u32 s54, s62, 1835008
  buffer_load_dwordx4 v207, s[20:23], s54 offen lds
  s_add_u32 m0, s61, 110592
  s_add_u32 s54, s62, 1966080
  buffer_load_dwordx4 v207, s[20:23], s54 offen lds
  v_add_u32 v215, 36864, v209
  ds_read_b64_tr_b16 a[0:1], v215 offset:0
  ds_read_b64_tr_b16 a[2:3], v215 offset:1024
  ds_read_b64_tr_b16 a[4:5], v215 offset:4096
  ds_read_b64_tr_b16 a[6:7], v215 offset:5120
  ds_read_b64_tr_b16 a[8:9], v215 offset:8192
  ds_read_b64_tr_b16 a[10:11], v215 offset:9216
  ds_read_b64_tr_b16 a[12:13], v215 offset:12288
  ds_read_b64_tr_b16 a[14:15], v215 offset:13312
  s_waitcnt vmcnt(20) lgkmcnt(0)
  s_barrier
  s_add_u32 m0, s61, 0
  s_add_u32 s54, s62, 1572864
  buffer_load_dwordx4 v207, s[24:27], s54 offen lds
  s_add_u32 m0, s61, 4096
  s_add_u32 s54, s62, 1703936
  buffer_load_dwordx4 v207, s[24:27], s54 offen lds
  s_add_u32 m0, s61, 8192
  s_add_u32 s54, s62, 1835008
  buffer_load_dwordx4 v207, s[24:27], s54 offen lds
  s_add_u32 m0, s61, 12288
  s_add_u32 s54, s62, 1966080
  buffer_load_dwordx4 v207, s[24:27], s54 offen lds
  v_add_u32 v215, 53248, v210
  ds_read_b64_tr_b16 a[144:145], v215 offset:0
  ds_read_b64_tr_b16 a[146:147], v215 offset:1024
  ds_read_b64_tr_b16 a[148:149], v215 offset:4096
  ds_read_b64_tr_b16 a[150:151], v215 offset:5120
  ds_read_b64_tr_b16 a[152:153], v215 offset:8192
  ds_read_b64_tr_b16 a[154:155], v215 offset:9216
  ds_read_b64_tr_b16 a[156:157], v215 offset:12288
  ds_read_b64_tr_b16 a[158:159], v215 offset:13312
  s_waitcnt vmcnt(20) lgkmcnt(0)
  s_barrier
  s_add_u32 m0, s61, 16384
  s_add_u32 s54, s62, 2097152
  buffer_load_dwordx4 v207, s[20:23], s54 offen lds
  s_add_u32 m0, s61, 20480
  s_add_u32 s54, s62, 2228224
  buffer_load_dwordx4 v207, s[20:23], s54 offen lds
  s_add_u32 m0, s61, 24576
  s_add_u32 s54, s62, 2359296
  buffer_load_dwordx4 v207, s[20:23], s54 offen lds
  s_add_u32 m0, s61, 28672
  s_add_u32 s54, s62, 2490368
  buffer_load_dwordx4 v207, s[20:23], s54 offen lds
  v_add_u32 v215, 69632, v209
  ds_read_b64_tr_b16 a[16:17], v215 offset:0
  ds_read_b64_tr_b16 a[18:19], v215 offset:1024
  ds_read_b64_tr_b16 a[20:21], v215 offset:4096
  ds_read_b64_tr_b16 a[22:23], v215 offset:5120
  ds_read_b64_tr_b16 a[24:25], v215 offset:8192
  ds_read_b64_tr_b16 a[26:27], v215 offset:9216
  ds_read_b64_tr_b16 a[28:29], v215 offset:12288
  ds_read_b64_tr_b16 a[30:31], v215 offset:13312
  s_waitcnt vmcnt(20) lgkmcnt(0)
  s_barrier
  s_add_u32 m0, s61, 32768
  s_add_u32 s54, s62, 2097152
  buffer_load_dwordx4 v207, s[24:27], s54 offen lds
  s_add_u32 m0, s61, 36864
  s_add_u32 s54, s62, 2228224
  buffer_load_dwordx4 v207, s[24:27], s54 offen lds
  s_add_u32 m0, s61, 40960
  s_add_u32 s54, s62, 2359296
  buffer_load_dwordx4 v207, s[24:27], s54 offen lds
  s_add_u32 m0, s61, 45056
  s_add_u32 s54, s62, 2490368
  buffer_load_dwordx4 v207, s[24:27], s54 offen lds
  v_add_u32 v215, 86016, v210
  ds_read_b64_tr_b16 a[160:161], v215 offset:0
  ds_read_b64_tr_b16 a[162:163], v215 offset:1024
  ds_read_b64_tr_b16 a[164:165], v215 offset:4096
  ds_read_b64_tr_b16 a[166:167], v215 offset:5120
  ds_read_b64_tr_b16 a[168:169], v215 offset:8192
  ds_read_b64_tr_b16 a[170:171], v215 offset:9216
  ds_read_b64_tr_b16 a[172:173], v215 offset:12288
  ds_read_b64_tr_b16 a[174:175], v215 offset:13312
  s_waitcnt vmcnt(20) lgkmcnt(0)
  s_barrier
  s_add_u32 m0, s61, 49152
  s_add_u32 s54, s62, 2621440
  buffer_load_dwordx4 v207, s[20:23], s54 offen lds
  s_add_u32 m0, s61, 53248
  s_add_u32 s54, s62, 2752512
  buffer_load_dwordx4 v207, s[20:23], s54 offen lds
  s_add_u32 m0, s61, 57344
  s_add_u32 s54, s62, 2883584
  buffer_load_dwordx4 v207, s[20:23], s54 offen lds
  s_add_u32 m0, s61, 61440
  s_add_u32 s54, s62, 3014656
  buffer_load_dwordx4 v207, s[20:23], s54 offen lds
  v_add_u32 v215, 102400, v209
  ds_read_b64_tr_b16 a[32:33], v215 offset:0
  ds_read_b64_tr_b16 a[34:35], v215 offset:1024
  ds_read_b64_tr_b16 a[36:37], v215 offset:4096
  ds_read_b64_tr_b16 a[38:39], v215 offset:5120
  ds_read_b64_tr_b16 a[40:41], v215 offset:8192
  ds_read_b64_tr_b16 a[42:43], v215 offset:9216
  ds_read_b64_tr_b16 a[44:45], v215 offset:12288
  ds_read_b64_tr_b16 a[46:47], v215 offset:13312
  s_waitcnt vmcnt(20) lgkmcnt(0)
  s_barrier
  s_add_u32 m0, s61, 65536
  s_add_u32 s54, s62, 2621440
  buffer_load_dwordx4 v207, s[24:27], s54 offen lds
  s_add_u32 m0, s61, 69632
  s_add_u32 s54, s62, 2752512
  buffer_load_dwordx4 v207, s[24:27], s54 offen lds
  s_add_u32 m0, s61, 73728
  s_add_u32 s54, s62, 2883584
  buffer_load_dwordx4 v207, s[24:27], s54 offen lds
  s_add_u32 m0, s61, 77824
  s_add_u32 s54, s62, 3014656
  buffer_load_dwordx4 v207, s[24:27], s54 offen lds
  v_add_u32 v215, 118784, v210
  ds_read_b64_tr_b16 a[176:177], v215 offset:0
  ds_read_b64_tr_b16 a[178:179], v215 offset:1024
  ds_read_b64_tr_b16 a[180:181], v215 offset:4096
  ds_read_b64_tr_b16 a[182:183], v215 offset:5120
  ds_read_b64_tr_b16 a[184:185], v215 offset:8192
  ds_read_b64_tr_b16 a[186:187], v215 offset:9216
  ds_read_b64_tr_b16 a[188:189], v215 offset:12288
  ds_read_b64_tr_b16 a[190:191], v215 offset:13312
  s_waitcnt vmcnt(20) lgkmcnt(0)
  s_barrier
  s_add_u32 m0, s61, 81920
  s_add_u32 s54, s62, 3145728
  buffer_load_dwordx4 v207, s[20:23], s54 offen lds
  s_add_u32 m0, s61, 86016
  s_add_u32 s54, s62, 3276800
  buffer_load_dwordx4 v207, s[20:23], s54 offen lds
  s_add_u32 m0, s61, 90112
  s_add_u32 s54, s62, 3407872
  buffer_load_dwordx4 v207, s[20:23], s54 offen lds
  s_add_u32 m0, s61, 94208
  s_add_u32 s54, s62, 3538944
  buffer_load_dwordx4 v207, s[20:23], s54 offen lds
  v_add_u32 v215, 135168, v209
  ds_read_b64_tr_b16 a[48:49], v215 offset:0
  ds_read_b64_tr_b16 a[50:51], v215 offset:1024
  ds_read_b64_tr_b16 a[52:53], v215 offset:4096
  ds_read_b64_tr_b16 a[54:55], v215 offset:5120
  ds_read_b64_tr_b16 a[56:57], v215 offset:8192
  ds_read_b64_tr_b16 a[58:59], v215 offset:9216
  ds_read_b64_tr_b16 a[60:61], v215 offset:12288
  ds_read_b64_tr_b16 a[62:63], v215 offset:13312
  s_waitcnt vmcnt(20) lgkmcnt(0)
  s_barrier
  s_add_u32 m0, s61, 98304
  s_add_u32 s54, s62, 3145728
  buffer_load_dwordx4 v207, s[24:27], s54 offen lds
  s_add_u32 m0, s61, 102400
  s_add_u32 s54, s62, 3276800
  buffer_load_dwordx4 v207, s[24:27], s54 offen lds
  s_add_u32 m0, s61, 106496
  s_add_u32 s54, s62, 3407872
  buffer_load_dwordx4 v207, s[24:27], s54 offen lds
  s_add_u32 m0, s61, 110592
  s_add_u32 s54, s62, 3538944
  buffer_load_dwordx4 v207, s[24:27], s54 offen lds
  v_add_u32 v215, 36864, v210
  ds_read_b64_tr_b16 a[192:193], v215 offset:0
  ds_read_b64_tr_b16 a[194:195], v215 offset:1024
  ds_read_b64_tr_b16 a[196:197], v215 offset:4096
  ds_read_b64_tr_b16 a[198:199], v215 offset:5120
  ds_read_b64_tr_b16 a[200:201], v215 offset:8192
  ds_read_b64_tr_b16 a[202:203], v215 offset:9216
  ds_read_b64_tr_b16 a[204:205], v215 offset:12288
  ds_read_b64_tr_b16 a[206:207], v215 offset:13312
  s_waitcnt vmcnt(20) lgkmcnt(0)
  s_barrier
  s_add_u32 m0, s61, 0
  s_add_u32 s54, s62, 3670016
  buffer_load_dwordx4 v207, s[20:23], s54 offen lds
  s_add_u32 m0, s61, 4096
  s_add_u32 s54, s62, 3801088
  buffer_load_dwordx4 v207, s[20:23], s54 offen lds
  s_add_u32 m0, s61, 8192
  s_add_u32 s54, s62, 3932160
  buffer_load_dwordx4 v207, s[20:23], s54 offen lds
  s_add_u32 m0, s61, 12288
  s_add_u32 s54, s62, 4063232
  buffer_load_dwordx4 v207, s[20:23], s54 offen lds
  v_add_u32 v215, 53248, v209
  ds_read_b64_tr_b16 a[64:65], v215 offset:0
  ds_read_b64_tr_b16 a[66:67], v215 offset:1024
  ds_read_b64_tr_b16 a[68:69], v215 offset:4096
  ds_read_b64_tr_b16 a[70:71], v215 offset:5120
  ds_read_b64_tr_b16 a[72:73], v215 offset:8192
  ds_read_b64_tr_b16 a[74:75], v215 offset:9216
  ds_read_b64_tr_b16 a[76:77], v215 offset:12288
  ds_read_b64_tr_b16 a[78:79], v215 offset:13312
  s_waitcnt vmcnt(20) lgkmcnt(0)
  s_barrier
  s_add_u32 m0, s61, 16384
  s_add_u32 s54, s62, 3670016
  buffer_load_dwordx4 v207, s[24:27], s54 offen lds
  s_add_u32 m0, s61, 20480
  s_add_u32 s54, s62, 3801088
  buffer_load_dwordx4 v207, s[24:27], s54 offen lds
  s_add_u32 m0, s61, 24576
  s_add_u32 s54, s62, 3932160
  buffer_load_dwordx4 v207, s[24:27], s54 offen lds
  s_add_u32 m0, s61, 28672
  s_add_u32 s54, s62, 4063232
  buffer_load_dwordx4 v207, s[24:27], s54 offen lds
  v_add_u32 v215, 69632, v210
  ds_read_b64_tr_b16 a[208:209], v215 offset:0
  ds_read_b64_tr_b16 a[210:211], v215 offset:1024
  ds_read_b64_tr_b16 a[212:213], v215 offset:4096
  ds_read_b64_tr_b16 a[214:215], v215 offset:5120
  ds_read_b64_tr_b16 a[216:217], v215 offset:8192
  ds_read_b64_tr_b16 a[218:219], v215 offset:9216
  ds_read_b64_tr_b16 a[220:221], v215 offset:12288
  ds_read_b64_tr_b16 a[222:223], v215 offset:13312
  s_waitcnt vmcnt(20) lgkmcnt(0)
  s_barrier
  s_add_u32 m0, s61, 32768
  s_add_u32 s54, s62, 4194304
  buffer_load_dwordx4 v207, s[20:23], s54 offen lds
  s_add_u32 m0, s61, 36864
  s_add_u32 s54, s62, 4325376
  buffer_load_dwordx4 v207, s[20:23], s54 offen lds
  s_add_u32 m0, s61, 40960
  s_add_u32 s54, s62, 4456448
  buffer_load_dwordx4 v207, s[20:23], s54 offen lds
  s_add_u32 m0, s61, 45056
  s_add_u32 s54, s62, 4587520
  buffer_load_dwordx4 v207, s[20:23], s54 offen lds
  v_add_u32 v215, 86016, v209
  ds_read_b64_tr_b16 a[80:81], v215 offset:0
  ds_read_b64_tr_b16 a[82:83], v215 offset:1024
  ds_read_b64_tr_b16 a[84:85], v215 offset:4096
  ds_read_b64_tr_b16 a[86:87], v215 offset:5120
  ds_read_b64_tr_b16 a[88:89], v215 offset:8192
  ds_read_b64_tr_b16 a[90:91], v215 offset:9216
  ds_read_b64_tr_b16 a[92:93], v215 offset:12288
  ds_read_b64_tr_b16 a[94:95], v215 offset:13312
  s_waitcnt vmcnt(20) lgkmcnt(0)
  s_barrier
  s_add_u32 m0, s61, 49152
  s_add_u32 s54, s62, 4194304
  buffer_load_dwordx4 v207, s[24:27], s54 offen lds
  s_add_u32 m0, s61, 53248
  s_add_u32 s54, s62, 4325376
  buffer_load_dwordx4 v207, s[24:27], s54 offen lds
  s_add_u32 m0, s61, 57344
  s_add_u32 s54, s62, 4456448
  buffer_load_dwordx4 v207, s[24:27], s54 offen lds
  s_add_u32 m0, s61, 61440
  s_add_u32 s54, s62, 4587520
  buffer_load_dwordx4 v207, s[24:27], s54 offen lds
  s_mul_i32 s54, s53, 21120
  s_lshl_b32 s55, s52, 13
  s_add_u32 s54, s54, s55
  s_cmp_eq_u32 s52, 3
  s_cselect_b32 s54, 0x10000000, s54
  v_lshlrev_b32 v211, 3, v201
  buffer_load_dword v196, v211, s[28:31], s54 offen
  v_add_u32 v215, 102400, v210
  ds_read_b64_tr_b16 a[224:225], v215 offset:0
  ds_read_b64_tr_b16 a[226:227], v215 offset:1024
  ds_read_b64_tr_b16 a[228:229], v215 offset:4096
  ds_read_b64_tr_b16 a[230:231], v215 offset:5120
  ds_read_b64_tr_b16 a[232:233], v215 offset:8192
  ds_read_b64_tr_b16 a[234:235], v215 offset:9216
  ds_read_b64_tr_b16 a[236:237], v215 offset:12288
  ds_read_b64_tr_b16 a[238:239], v215 offset:13312
  s_waitcnt vmcnt(21) lgkmcnt(0)
  s_barrier
  s_lshl_b32 s54, s53, 13
  s_lshr_b32 s55, s53, 6
  s_or_b32 s55, s55, s52
  s_cmp_eq_u32 s55, 0
  s_cselect_b32 s54, s54, 0x10000000
  v_lshlrev_b32 v211, 3, v201
  buffer_load_dword v196, v211, s[16:19], s54 offen
  v_add_u32 v215, 118784, v209
  ds_read_b64_tr_b16 a[96:97], v215 offset:0
  ds_read_b64_tr_b16 a[98:99], v215 offset:1024
  ds_read_b64_tr_b16 a[100:101], v215 offset:4096
  ds_read_b64_tr_b16 a[102:103], v215 offset:5120
  ds_read_b64_tr_b16 a[104:105], v215 offset:8192
  ds_read_b64_tr_b16 a[106:107], v215 offset:9216
  ds_read_b64_tr_b16 a[108:109], v215 offset:12288
  ds_read_b64_tr_b16 a[110:111], v215 offset:13312
  s_waitcnt vmcnt(18) lgkmcnt(0)
  s_barrier
  v_add_u32 v215, 135168, v210
  ds_read_b64_tr_b16 a[240:241], v215 offset:0
  ds_read_b64_tr_b16 a[242:243], v215 offset:1024
  ds_read_b64_tr_b16 a[244:245], v215 offset:4096
  ds_read_b64_tr_b16 a[246:247], v215 offset:5120
  ds_read_b64_tr_b16 a[248:249], v215 offset:8192
  ds_read_b64_tr_b16 a[250:251], v215 offset:9216
  ds_read_b64_tr_b16 a[252:253], v215 offset:12288
  ds_read_b64_tr_b16 a[254:255], v215 offset:13312
  s_waitcnt vmcnt(14) lgkmcnt(0)
  s_barrier
  v_add_u32 v215, 36864, v209
  ds_read_b64_tr_b16 a[112:113], v215 offset:0
  ds_read_b64_tr_b16 a[114:115], v215 offset:1024
  ds_read_b64_tr_b16 a[116:117], v215 offset:4096
  ds_read_b64_tr_b16 a[118:119], v215 offset:5120
  ds_read_b64_tr_b16 a[120:121], v215 offset:8192
  ds_read_b64_tr_b16 a[122:123], v215 offset:9216
  ds_read_b64_tr_b16 a[124:125], v215 offset:12288
  ds_read_b64_tr_b16 a[126:127], v215 offset:13312
  s_waitcnt vmcnt(10) lgkmcnt(0)
  s_barrier
  v_add_u32 v215, 53248, v210
  ds_read_b64_tr_b16 v[224:225], v215 offset:0
  ds_read_b64_tr_b16 v[226:227], v215 offset:1024
  ds_read_b64_tr_b16 v[228:229], v215 offset:4096
  ds_read_b64_tr_b16 v[230:231], v215 offset:5120
  ds_read_b64_tr_b16 v[232:233], v215 offset:8192
  ds_read_b64_tr_b16 v[234:235], v215 offset:9216
  ds_read_b64_tr_b16 v[236:237], v215 offset:12288
  ds_read_b64_tr_b16 v[238:239], v215 offset:13312
  s_waitcnt vmcnt(6) lgkmcnt(0)
  s_barrier
  v_add_u32 v215, 69632, v209
  ds_read_b64_tr_b16 a[128:129], v215 offset:0
  ds_read_b64_tr_b16 a[130:131], v215 offset:1024
  ds_read_b64_tr_b16 a[132:133], v215 offset:4096
  ds_read_b64_tr_b16 a[134:135], v215 offset:5120
  ds_read_b64_tr_b16 a[136:137], v215 offset:8192
  ds_read_b64_tr_b16 a[138:139], v215 offset:9216
  ds_read_b64_tr_b16 a[140:141], v215 offset:12288
  ds_read_b64_tr_b16 a[142:143], v215 offset:13312
  s_waitcnt vmcnt(2) lgkmcnt(0)
  s_barrier
  v_add_u32 v215, 86016, v210
  ds_read_b64_tr_b16 v[240:241], v215 offset:0
  ds_read_b64_tr_b16 v[242:243], v215 offset:1024
  ds_read_b64_tr_b16 v[244:245], v215 offset:4096
  ds_read_b64_tr_b16 v[246:247], v215 offset:5120
  ds_read_b64_tr_b16 v[248:249], v215 offset:8192
  ds_read_b64_tr_b16 v[250:251], v215 offset:9216
  ds_read_b64_tr_b16 v[252:253], v215 offset:12288
  ds_read_b64_tr_b16 v[254:255], v215 offset:13312
  s_waitcnt lgkmcnt(0)
  s_barrier
  s_lshr_b32 s55, s53, 1
  s_and_b32 s56, s53, 1
  s_lshl_b32 s56, s56, 7
  s_lshl_b32 s55, s55, 2
  s_add_u32 s55, s55, s56
  s_add_u32 s55, s55, 356352
  s_cmp_lt_u32 s53, 64
  s_cselect_b32 s71, s55, 268435456
  v_mov_b32 v211, 0
  s_mov_b64 exec, 1
  buffer_store_dword v211, v211, s[8:11], s71 offen sc1
  s_mov_b64 exec, -1
  s_mov_b32 s68, 1040356334
  s_lshl_b32 s69, s52, 9
  s_lshl_b32 s70, s58, 2
  s_add_u32 s70, s70, 128
  s_mul_i32 s66, s58, -12288
  s_lshl_b32 s54, s52, 10
  s_add_u32 s66, s66, s54
  s_add_u32 s66, s66, 524288
  v_mov_b32 v64, -1
  v_mov_b32 v65, -1
  v_mov_b32 v66, -1
  v_mov_b32 v67, -1
  s_cmp_eq_u32 s59, 0
  s_cbranch_scc0 KV_na
  s_mul_i32 s54, s58, 2176
  s_mul_i32 s55, s52, 69632
  s_add_u32 s55, s55, s54
  s_add_u32 s55, s55, 0
  s_add_u32 s54, s54, 278528
  s_lshl_b32 s56, s58, 14
  s_mul_i32 s57, s52, 3072
  s_add_u32 s56, s56, s57
  s_add_u32 s56, s56, 360448
  s_cmp_lt_u32 s58, 2
  s_cselect_b32 s56, s56, 268435456
  s_cmp_eq_u32 s52, 0
  s_cselect_b32 s54, s54, 268435456
  buffer_store_dwordx4 v[64:67], v201, s[8:11], s55 offen offset:0 sc1
  buffer_store_dwordx4 v[64:67], v201, s[8:11], s55 offen offset:1024 sc1
  buffer_store_dwordx4 v[64:67], v201, s[8:11], s54 offen offset:0 sc1
  buffer_store_dwordx4 v[64:67], v201, s[8:11], s54 offen offset:1024 sc1
  buffer_store_dwordx4 v[64:67], v201, s[8:11], s56 offen offset:0 sc1
  buffer_store_dwordx4 v[64:67], v201, s[8:11], s56 offen offset:1024 sc1
  buffer_store_dwordx4 v[64:67], v201, s[8:11], s56 offen offset:2048 sc1
KV_na:
  s_add_u32 s60, s60, 258048
  ds_read_b128 v[32:35], v203 offset:0
  ds_read_b128 v[36:39], v204 offset:0
  ds_read_b128 v[40:43], v205 offset:0
  s_waitcnt lgkmcnt(2)
  v_mfma_f32_32x32x16_bf16 v[0:15], a[0:3], v[32:35], 0
  ds_read_b128 v[44:47], v206 offset:0
  s_add_u32 m0, s67, 36864
  s_nop 0
  buffer_load_dwordx4 v202, s[4:7], s60 offen offset:0 lds
  v_mfma_f32_32x32x16_bf16 v[16:31], v[32:35], a[144:147], 0
  s_waitcnt lgkmcnt(2)
  v_mfma_f32_32x32x16_bf16 v[0:15], a[4:7], v[36:39], v[0:15]
  ds_read_b128 v[32:35], v203 offset:1024
  s_add_u32 m0, s67, 37760
  s_nop 0
  buffer_load_dwordx4 v202, s[4:7], s60 offen offset:128 lds
  v_mfma_f32_32x32x16_bf16 v[16:31], v[36:39], a[148:151], v[16:31]
  s_waitcnt lgkmcnt(2)
  v_mfma_f32_32x32x16_bf16 v[0:15], a[8:11], v[40:43], v[0:15]
  ds_read_b128 v[36:39], v204 offset:1024
  s_add_u32 m0, s67, 38656
  s_nop 0
  buffer_load_dwordx4 v202, s[4:7], s60 offen offset:256 lds
  v_mfma_f32_32x32x16_bf16 v[16:31], v[40:43], a[152:155], v[16:31]
  s_waitcnt lgkmcnt(2)
  v_mfma_f32_32x32x16_bf16 v[0:15], a[12:15], v[44:47], v[0:15]
  ds_read_b128 v[40:43], v205 offset:1024
  s_add_u32 m0, s67, 39552
  s_nop 0
  buffer_load_dwordx4 v202, s[4:7], s60 offen offset:384 lds
  v_mfma_f32_32x32x16_bf16 v[16:31], v[44:47], a[156:159], v[16:31]
  s_waitcnt lgkmcnt(2)
  v_mfma_f32_32x32x16_bf16 v[0:15], a[16:19], v[32:35], v[0:15]
  ds_read_b128 v[44:47], v206 offset:1024
  s_add_u32 m0, s67, 40448
  s_nop 0
  buffer_load_dwordx4 v202, s[4:7], s60 offen offset:512 lds
  v_mfma_f32_32x32x16_bf16 v[16:31], v[32:35], a[160:163], v[16:31]
  s_waitcnt lgkmcnt(2)
  v_mfma_f32_32x32x16_bf16 v[0:15], a[20:23], v[36:39], v[0:15]
  ds_read_b128 v[32:35], v203 offset:2048
  s_add_u32 m0, s67, 41344
  s_nop 0
  buffer_load_dwordx4 v202, s[4:7], s60 offen offset:640 lds
  v_mfma_f32_32x32x16_bf16 v[16:31], v[36:39], a[164:167], v[16:31]
  s_waitcnt lgkmcnt(2)
  v_mfma_f32_32x32x16_bf16 v[0:15], a[24:27], v[40:43], v[0:15]
  ds_read_b128 v[36:39], v204 offset:2048
  s_add_u32 m0, s67, 42240
  s_nop 0
  buffer_load_dwordx4 v202, s[4:7], s60 offen offset:768 lds
  v_mfma_f32_32x32x16_bf16 v[16:31], v[40:43], a[168:171], v[16:31]
  s_waitcnt lgkmcnt(2)
  v_mfma_f32_32x32x16_bf16 v[0:15], a[28:31], v[44:47], v[0:15]
  ds_read_b128 v[40:43], v205 offset:2048
  s_add_u32 m0, s67, 43136
  s_nop 0
  buffer_load_dwordx4 v202, s[4:7], s60 offen offset:896 lds
  v_mfma_f32_32x32x16_bf16 v[16:31], v[44:47], a[172:175], v[16:31]
  s_waitcnt lgkmcnt(2)
  v_mfma_f32_32x32x16_bf16 v[0:15], a[32:35], v[32:35], v[0:15]
  ds_read_b128 v[44:47], v206 offset:2048
  s_add_u32 m0, s67, 44032
  s_nop 0
  buffer_load_dwordx4 v202, s[4:7], s60 offen offset:1024 lds
  v_mfma_f32_32x32x16_bf16 v[16:31], v[32:35], a[176:179], v[16:31]
  s_waitcnt lgkmcnt(2)
  v_mfma_f32_32x32x16_bf16 v[0:15], a[36:39], v[36:39], v[0:15]
  ds_read_b128 v[32:35], v203 offset:3072
  v_mfma_f32_32x32x16_bf16 v[16:31], v[36:39], a[180:183], v[16:31]
  s_waitcnt lgkmcnt(2)
  v_mfma_f32_32x32x16_bf16 v[0:15], a[40:43], v[40:43], v[0:15]
  ds_read_b128 v[36:39], v204 offset:3072
  v_mfma_f32_32x32x16_bf16 v[16:31], v[40:43], a[184:187], v[16:31]
  s_waitcnt lgkmcnt(2)
  v_mfma_f32_32x32x16_bf16 v[0:15], a[44:47], v[44:47], v[0:15]
  ds_read_b128 v[40:43], v205 offset:3072
  v_mfma_f32_32x32x16_bf16 v[16:31], v[44:47], a[188:191], v[16:31]
  s_waitcnt lgkmcnt(2)
  v_mfma_f32_32x32x16_bf16 v[0:15], a[48:51], v[32:35], v[0:15]
  ds_read_b128 v[44:47], v206 offset:3072
  v_mfma_f32_32x32x16_bf16 v[16:31], v[32:35], a[192:195], v[16:31]
  s_waitcnt lgkmcnt(2)
  v_mfma_f32_32x32x16_bf16 v[0:15], a[52:55], v[36:39], v[0:15]
  ds_read_b128 v[32:35], v203 offset:4096
  v_mfma_f32_32x32x16_bf16 v[16:31], v[36:39], a[196:199], v[16:31]
  s_waitcnt lgkmcnt(2)
  v_mfma_f32_32x32x16_bf16 v[0:15], a[56:59], v[40:43], v[0:15]
  ds_read_b128 v[36:39], v204 offset:4096
  v_mfma_f32_32x32x16_bf16 v[16:31], v[40:43], a[200:203], v[16:31]
  s_waitcnt lgkmcnt(2)
  v_mfma_f32_32x32x16_bf16 v[0:15], a[60:63], v[44:47], v[0:15]
  ds_read_b128 v[40:43], v205 offset:4096
  v_mfma_f32_32x32x16_bf16 v[16:31], v[44:47], a[204:207], v[16:31]
  s_waitcnt lgkmcnt(2)
  v_mfma_f32_32x32x16_bf16 v[0:15], a[64:67], v[32:35], v[0:15]
  ds_read_b128 v[44:47], v206 offset:4096
  v_mfma_f32_32x32x16_bf16 v[16:31], v[32:35], a[208:211], v[16:31]
  s_waitcnt lgkmcnt(2)
  v_mfma_f32_32x32x16_bf16 v[0:15], a[68:71], v[36:39], v[0:15]
  ds_read_b128 v[32:35], v203 offset:5120
  v_mfma_f32_32x32x16_bf16 v[16:31], v[36:39], a[212:215], v[16:31]
  s_waitcnt lgkmcnt(2)
  v_mfma_f32_32x32x16_bf16 v[0:15], a[72:75], v[40:43], v[0:15]
  ds_read_b128 v[36:39], v204 offset:5120
  v_mfma_f32_32x32x16_bf16 v[16:31], v[40:43], a[216:219], v[16:31]
  s_waitcnt lgkmcnt(2)
  v_mfma_f32_32x32x16_bf16 v[0:15], a[76:79], v[44:47], v[0:15]
  ds_read_b128 v[40:43], v205 offset:5120
  v_mfma_f32_32x32x16_bf16 v[16:31], v[44:47], a[220:223], v[16:31]
  s_waitcnt lgkmcnt(2)
  v_mfma_f32_32x32x16_bf16 v[0:15], a[80:83], v[32:35], v[0:15]
  ds_read_b128 v[44:47], v206 offset:5120
  v_mfma_f32_32x32x16_bf16 v[16:31], v[32:35], a[224:227], v[16:31]
  s_waitcnt lgkmcnt(2)
  v_mfma_f32_32x32x16_bf16 v[0:15], a[84:87], v[36:39], v[0:15]
  ds_read_b128 v[32:35], v203 offset:6144
  v_mfma_f32_32x32x16_bf16 v[16:31], v[36:39], a[228:231], v[16:31]
  s_waitcnt lgkmcnt(2)
  v_mfma_f32_32x32x16_bf16 v[0:15], a[88:91], v[40:43], v[0:15]
  ds_read_b128 v[36:39], v204 offset:6144
  v_mfma_f32_32x32x16_bf16 v[16:31], v[40:43], a[232:235], v[16:31]
  s_waitcnt lgkmcnt(2)
  v_mfma_f32_32x32x16_bf16 v[0:15], a[92:95], v[44:47], v[0:15]
  ds_read_b128 v[40:43], v205 offset:6144
  v_mfma_f32_32x32x16_bf16 v[16:31], v[44:47], a[236:239], v[16:31]
  s_waitcnt lgkmcnt(2)
  v_mfma_f32_32x32x16_bf16 v[0:15], a[96:99], v[32:35], v[0:15]
  ds_read_b128 v[44:47], v206 offset:6144
  v_mfma_f32_32x32x16_bf16 v[16:31], v[32:35], a[240:243], v[16:31]
  s_waitcnt lgkmcnt(2)
  v_mfma_f32_32x32x16_bf16 v[0:15], a[100:103], v[36:39], v[0:15]
  ds_read_b128 v[32:35], v203 offset:7168
  v_mfma_f32_32x32x16_bf16 v[16:31], v[36:39], a[244:247], v[16:31]
  s_waitcnt lgkmcnt(2)
  v_mfma_f32_32x32x16_bf16 v[0:15], a[104:107], v[40:43], v[0:15]
  ds_read_b128 v[36:39], v204 offset:7168
  v_mfma_f32_32x32x16_bf16 v[16:31], v[40:43], a[248:251], v[16:31]
  s_waitcnt lgkmcnt(2)
  v_mfma_f32_32x32x16_bf16 v[0:15], a[108:111], v[44:47], v[0:15]
  ds_read_b128 v[40:43], v205 offset:7168
  v_mfma_f32_32x32x16_bf16 v[16:31], v[44:47], a[252:255], v[16:31]
  s_waitcnt lgkmcnt(2)
  v_mfma_f32_32x32x16_bf16 v[0:15], a[112:115], v[32:35], v[0:15]
  ds_read_b128 v[44:47], v206 offset:7168
  v_mfma_f32_32x32x16_bf16 v[16:31], v[32:35], v[224:227], v[16:31]
  s_waitcnt lgkmcnt(2)
  v_mfma_f32_32x32x16_bf16 v[0:15], a[116:119], v[36:39], v[0:15]
  ds_read_b128 v[32:35], v203 offset:8192
  v_mfma_f32_32x32x16_bf16 v[16:31], v[36:39], v[228:231], v[16:31]
  s_waitcnt lgkmcnt(2)
  v_mfma_f32_32x32x16_bf16 v[0:15], a[120:123], v[40:43], v[0:15]
  ds_read_b128 v[36:39], v204 offset:8192
  v_mfma_f32_32x32x16_bf16 v[16:31], v[40:43], v[232:235], v[16:31]
  s_waitcnt lgkmcnt(2)
  v_mfma_f32_32x32x16_bf16 v[0:15], a[124:127], v[44:47], v[0:15]
  ds_read_b128 v[40:43], v205 offset:8192
  v_mfma_f32_32x32x16_bf16 v[16:31], v[44:47], v[236:239], v[16:31]
  s_waitcnt lgkmcnt(2)
  v_mfma_f32_32x32x16_bf16 v[0:15], a[128:131], v[32:35], v[0:15]
  ds_read_b128 v[44:47], v206 offset:8192
  v_mfma_f32_32x32x16_bf16 v[16:31], v[32:35], v[240:243], v[16:31]
  s_waitcnt lgkmcnt(2)
  v_mfma_f32_32x32x16_bf16 v[0:15], a[132:135], v[36:39], v[0:15]
  v_mfma_f32_32x32x16_bf16 v[16:31], v[36:39], v[244:247], v[16:31]
  s_waitcnt lgkmcnt(1)
  v_mfma_f32_32x32x16_bf16 v[0:15], a[136:139], v[40:43], v[0:15]
  v_mfma_f32_32x32x16_bf16 v[16:31], v[40:43], v[248:251], v[16:31]
  s_waitcnt lgkmcnt(0)
  v_mfma_f32_32x32x16_bf16 v[0:15], a[140:143], v[44:47], v[0:15]
  v_mfma_f32_32x32x16_bf16 v[16:31], v[44:47], v[252:255], v[16:31]
  s_mul_i32 s64, s59, 655360
  s_lshl_b32 s55, s58, 14
  s_add_u32 s64, s64, s55
  s_add_u32 s64, s64, 1048576
  s_add_u32 s72, s64, s69
  s_add_u32 s73, s64, s66
  s_add_u32 s59, s59, 7
  s_waitcnt vmcnt(0)
  s_barrier
KV_loop:
  s_add_u32 s60, s60, 258048
  ds_read_b128 v[32:35], v203 offset:36864
  ds_read_b128 v[36:39], v204 offset:36864
  ds_read_b128 v[40:43], v205 offset:36864
  s_waitcnt lgkmcnt(2)
  v_mfma_f32_32x32x16_bf16 v[68:83], a[0:3], v[32:35], 0
  ds_read_b128 v[44:47], v206 offset:36864
  s_add_u32 m0, s67, 0
  s_nop 0
  buffer_load_dwordx4 v202, s[4:7], s60 offen offset:0 lds
  v_mfma_f32_32x32x16_bf16 v[84:99], v[32:35], a[144:147], 0
  s_waitcnt lgkmcnt(2)
  v_mfma_f32_32x32x16_bf16 v[68:83], a[4:7], v[36:39], v[68:83]
  ds_read_b128 v[32:35], v203 offset:37888
  s_add_u32 m0, s67, 896
  s_nop 0
  buffer_load_dwordx4 v202, s[4:7], s60 offen offset:128 lds
  v_mfma_f32_32x32x16_bf16 v[84:99], v[36:39], a[148:151], v[84:99]
  s_waitcnt lgkmcnt(2)
  v_mfma_f32_32x32x16_bf16 v[68:83], a[8:11], v[40:43], v[68:83]
  ds_read_b128 v[36:39], v204 offset:37888
  s_add_u32 m0, s67, 1792
  s_nop 0
  buffer_load_dwordx4 v202, s[4:7], s60 offen offset:256 lds
  v_mfma_f32_32x32x16_bf16 v[84:99], v[40:43], a[152:155], v[84:99]
  s_waitcnt lgkmcnt(2)
  v_mfma_f32_32x32x16_bf16 v[68:83], a[12:15], v[44:47], v[68:83]
  ds_read_b128 v[40:43], v205 offset:37888
  s_add_u32 m0, s67, 2688
  s_nop 0
  buffer_load_dwordx4 v202, s[4:7], s60 offen offset:384 lds
  v_mfma_f32_32x32x16_bf16 v[84:99], v[44:47], a[156:159], v[84:99]
  s_waitcnt lgkmcnt(2)
  v_mfma_f32_32x32x16_bf16 v[68:83], a[16:19], v[32:35], v[68:83]
  ds_read_b128 v[44:47], v206 offset:37888
  s_add_u32 m0, s67, 3584
  s_nop 0
  buffer_load_dwordx4 v202, s[4:7], s60 offen offset:512 lds
  v_mfma_f32_32x32x16_bf16 v[84:99], v[32:35], a[160:163], v[84:99]
  s_waitcnt lgkmcnt(2)
  v_mfma_f32_32x32x16_bf16 v[68:83], a[20:23], v[36:39], v[68:83]
  ds_read_b128 v[32:35], v203 offset:38912
  s_add_u32 m0, s67, 4480
  s_nop 0
  buffer_load_dwordx4 v202, s[4:7], s60 offen offset:640 lds
  v_mfma_f32_32x32x16_bf16 v[84:99], v[36:39], a[164:167], v[84:99]
  s_waitcnt lgkmcnt(2)
  v_mfma_f32_32x32x16_bf16 v[68:83], a[24:27], v[40:43], v[68:83]
  ds_read_b128 v[36:39], v204 offset:38912
  s_add_u32 m0, s67, 5376
  s_nop 0
  buffer_load_dwordx4 v202, s[4:7], s60 offen offset:768 lds
  v_mfma_f32_32x32x16_bf16 v[84:99], v[40:43], a[168:171], v[84:99]
  s_waitcnt lgkmcnt(2)
  v_mfma_f32_32x32x16_bf16 v[68:83], a[28:31], v[44:47], v[68:83]
  ds_read_b128 v[40:43], v205 offset:38912
  s_add_u32 m0, s67, 6272
  s_nop 0
  buffer_load_dwordx4 v202, s[4:7], s60 offen offset:896 lds
  v_mfma_f32_32x32x16_bf16 v[84:99], v[44:47], a[172:175], v[84:99]
  s_waitcnt lgkmcnt(2)
  v_mfma_f32_32x32x16_bf16 v[68:83], a[32:35], v[32:35], v[68:83]
  ds_read_b128 v[44:47], v206 offset:38912
  s_add_u32 m0, s67, 7168
  s_nop 0
  buffer_load_dwordx4 v202, s[4:7], s60 offen offset:1024 lds
  v_mfma_f32_32x32x16_bf16 v[84:99], v[32:35], a[176:179], v[84:99]
  s_waitcnt lgkmcnt(2)
  v_mfma_f32_32x32x16_bf16 v[68:83], a[36:39], v[36:39], v[68:83]
  ds_read_b128 v[32:35], v203 offset:39936
  v_mul_f32 v0, s68, v0
  v_mul_f32 v1, s68, v1
  v_mul_f32 v2, s68, v2
  v_mul_f32 v3, s68, v3
  v_mfma_f32_32x32x16_bf16 v[84:99], v[36:39], a[180:183], v[84:99]
  v_mul_f32 v4, s68, v4
  v_mul_f32 v5, s68, v5
  v_mul_f32 v6, s68, v6
  v_mul_f32 v7, s68, v7
  s_waitcnt lgkmcnt(2)
  v_mfma_f32_32x32x16_bf16 v[68:83], a[40:43], v[40:43], v[68:83]
  ds_read_b128 v[36:39], v204 offset:39936
  v_cvt_pk_bf16_f32 v48, v0, v4
  v_cvt_pk_bf16_f32 v49, v1, v5
  v_cvt_pk_bf16_f32 v50, v2, v6
  v_cvt_pk_bf16_f32 v51, v3, v7
  v_mfma_f32_32x32x16_bf16 v[84:99], v[40:43], a[184:187], v[84:99]
  buffer_store_dwordx4 v[48:51], v216, s[8:11], s72 offen offset:0 sc1
  s_waitcnt lgkmcnt(2)
  v_mfma_f32_32x32x16_bf16 v[68:83], a[44:47], v[44:47], v[68:83]
  ds_read_b128 v[40:43], v205 offset:39936
  v_mfma_f32_32x32x16_bf16 v[84:99], v[44:47], a[188:191], v[84:99]
  s_waitcnt lgkmcnt(2)
  v_mfma_f32_32x32x16_bf16 v[68:83], a[48:51], v[32:35], v[68:83]
  ds_read_b128 v[44:47], v206 offset:39936
  v_mul_f32 v8, s68, v8
  v_mul_f32 v9, s68, v9
  v_mul_f32 v10, s68, v10
  v_mul_f32 v11, s68, v11
  v_mfma_f32_32x32x16_bf16 v[84:99], v[32:35], a[192:195], v[84:99]
  v_mul_f32 v12, s68, v12
  v_mul_f32 v13, s68, v13
  v_mul_f32 v14, s68, v14
  v_mul_f32 v15, s68, v15
  s_waitcnt lgkmcnt(2)
  v_mfma_f32_32x32x16_bf16 v[68:83], a[52:55], v[36:39], v[68:83]
  ds_read_b128 v[32:35], v203 offset:40960
  v_cvt_pk_bf16_f32 v52, v8, v12
  v_cvt_pk_bf16_f32 v53, v9, v13
  v_cvt_pk_bf16_f32 v54, v10, v14
  v_cvt_pk_bf16_f32 v55, v11, v15
  v_mfma_f32_32x32x16_bf16 v[84:99], v[36:39], a[196:199], v[84:99]
  buffer_store_dwordx4 v[52:55], v216, s[8:11], s72 offen offset:256 sc1
  s_waitcnt lgkmcnt(2)
  v_mfma_f32_32x32x16_bf16 v[68:83], a[56:59], v[40:43], v[68:83]
  ds_read_b128 v[36:39], v204 offset:40960
  v_mfma_f32_32x32x16_bf16 v[84:99], v[40:43], a[200:203], v[84:99]
  s_waitcnt lgkmcnt(2)
  v_mfma_f32_32x32x16_bf16 v[68:83], a[60:63], v[44:47], v[68:83]
  ds_read_b128 v[40:43], v205 offset:40960
  v_cvt_pk_bf16_f32 v56, v16, v17
  v_cvt_pk_bf16_f32 v57, v20, v21
  v_cvt_pk_bf16_f32 v58, v24, v25
  v_cvt_pk_bf16_f32 v59, v28, v29
  v_mfma_f32_32x32x16_bf16 v[84:99], v[44:47], a[204:207], v[84:99]
  buffer_store_dwordx4 v[56:59], v217, s[8:11], s64 offen offset:0 sc1
  s_waitcnt lgkmcnt(2)
  v_mfma_f32_32x32x16_bf16 v[68:83], a[64:67], v[32:35], v[68:83]
  ds_read_b128 v[44:47], v206 offset:40960
  v_mfma_f32_32x32x16_bf16 v[84:99], v[32:35], a[208:211], v[84:99]
  s_waitcnt lgkmcnt(2)
  v_mfma_f32_32x32x16_bf16 v[68:83], a[68:71], v[36:39], v[68:83]
  ds_read_b128 v[32:35], v203 offset:41984
  v_cvt_pk_bf16_f32 v60, v18, v19
  v_cvt_pk_bf16_f32 v61, v22, v23
  v_cvt_pk_bf16_f32 v62, v26, v27
  v_cvt_pk_bf16_f32 v63, v30, v31
  v_mfma_f32_32x32x16_bf16 v[84:99], v[36:39], a[212:215], v[84:99]
  buffer_store_dwordx4 v[60:63], v217, s[8:11], s64 offen offset:256 sc1
  s_waitcnt lgkmcnt(2)
  v_mfma_f32_32x32x16_bf16 v[68:83], a[72:75], v[40:43], v[68:83]
  ds_read_b128 v[36:39], v204 offset:41984
  v_mfma_f32_32x32x16_bf16 v[84:99], v[40:43], a[216:219], v[84:99]
  s_waitcnt lgkmcnt(2)
  v_mfma_f32_32x32x16_bf16 v[68:83], a[76:79], v[44:47], v[68:83]
  ds_read_b128 v[40:43], v205 offset:41984
  buffer_store_dwordx4 v[64:67], v201, s[8:11], s73 offen sc1
  v_mfma_f32_32x32x16_bf16 v[84:99], v[44:47], a[220:223], v[84:99]
  s_waitcnt lgkmcnt(2)
  v_mfma_f32_32x32x16_bf16 v[68:83], a[80:83], v[32:35], v[68:83]
  ds_read_b128 v[44:47], v206 offset:41984
  v_mfma_f32_32x32x16_bf16 v[84:99], v[32:35], a[224:227], v[84:99]
  s_waitcnt lgkmcnt(2)
  v_mfma_f32_32x32x16_bf16 v[68:83], a[84:87], v[36:39], v[68:83]
  ds_read_b128 v[32:35], v203 offset:43008
  v_mfma_f32_32x32x16_bf16 v[84:99], v[36:39], a[228:231], v[84:99]
  s_waitcnt lgkmcnt(2)
  v_mfma_f32_32x32x16_bf16 v[68:83], a[88:91], v[40:43], v[68:83]
  ds_read_b128 v[36:39], v204 offset:43008
  v_mfma_f32_32x32x16_bf16 v[84:99], v[40:43], a[232:235], v[84:99]
  s_waitcnt lgkmcnt(2)
  v_mfma_f32_32x32x16_bf16 v[68:83], a[92:95], v[44:47], v[68:83]
  ds_read_b128 v[40:43], v205 offset:43008
  v_mfma_f32_32x32x16_bf16 v[84:99], v[44:47], a[236:239], v[84:99]
  s_waitcnt lgkmcnt(2)
  v_mfma_f32_32x32x16_bf16 v[68:83], a[96:99], v[32:35], v[68:83]
  ds_read_b128 v[44:47], v206 offset:43008
  v_mfma_f32_32x32x16_bf16 v[84:99], v[32:35], a[240:243], v[84:99]
  s_waitcnt lgkmcnt(2)
  v_mfma_f32_32x32x16_bf16 v[68:83], a[100:103], v[36:39], v[68:83]
  ds_read_b128 v[32:35], v203 offset:44032
  v_mfma_f32_32x32x16_bf16 v[84:99], v[36:39], a[244:247], v[84:99]
  s_waitcnt lgkmcnt(2)
  v_mfma_f32_32x32x16_bf16 v[68:83], a[104:107], v[40:43], v[68:83]
  ds_read_b128 v[36:39], v204 offset:44032
  v_mfma_f32_32x32x16_bf16 v[84:99], v[40:43], a[248:251], v[84:99]
  s_waitcnt lgkmcnt(2)
  v_mfma_f32_32x32x16_bf16 v[68:83], a[108:111], v[44:47], v[68:83]
  ds_read_b128 v[40:43], v205 offset:44032
  v_mfma_f32_32x32x16_bf16 v[84:99], v[44:47], a[252:255], v[84:99]
  s_waitcnt lgkmcnt(2)
  v_mfma_f32_32x32x16_bf16 v[68:83], a[112:115], v[32:35], v[68:83]
  ds_read_b128 v[44:47], v206 offset:44032
  v_mfma_f32_32x32x16_bf16 v[84:99], v[32:35], v[224:227], v[84:99]
  s_waitcnt lgkmcnt(2)
  v_mfma_f32_32x32x16_bf16 v[68:83], a[116:119], v[36:39], v[68:83]
  ds_read_b128 v[32:35], v203 offset:45056
  v_mfma_f32_32x32x16_bf16 v[84:99], v[36:39], v[228:231], v[84:99]
  s_waitcnt lgkmcnt(2)
  v_mfma_f32_32x32x16_bf16 v[68:83], a[120:123], v[40:43], v[68:83]
  ds_read_b128 v[36:39], v204 offset:45056
  v_mfma_f32_32x32x16_bf16 v[84:99], v[40:43], v[232:235], v[84:99]
  s_waitcnt lgkmcnt(2)
  v_mfma_f32_32x32x16_bf16 v[68:83], a[124:127], v[44:47], v[68:83]
  ds_read_b128 v[40:43], v205 offset:45056
  v_mfma_f32_32x32x16_bf16 v[84:99], v[44:47], v[236:239], v[84:99]
  s_waitcnt lgkmcnt(2)
  v_mfma_f32_32x32x16_bf16 v[68:83], a[128:131], v[32:35], v[68:83]
  ds_read_b128 v[44:47], v206 offset:45056
  v_mfma_f32_32x32x16_bf16 v[84:99], v[32:35], v[240:243], v[84:99]
  s_waitcnt lgkmcnt(2)
  v_mfma_f32_32x32x16_bf16 v[68:83], a[132:135], v[36:39], v[68:83]
  v_mfma_f32_32x32x16_bf16 v[84:99], v[36:39], v[244:247], v[84:99]
  s_waitcnt lgkmcnt(1)
  v_mfma_f32_32x32x16_bf16 v[68:83], a[136:139], v[40:43], v[68:83]
  v_mfma_f32_32x32x16_bf16 v[84:99], v[40:43], v[248:251], v[84:99]
  s_waitcnt lgkmcnt(0)
  v_mfma_f32_32x32x16_bf16 v[68:83], a[140:143], v[44:47], v[68:83]
  v_mfma_f32_32x32x16_bf16 v[84:99], v[44:47], v[252:255], v[84:99]
  s_mul_i32 s64, s59, 655360
  s_lshl_b32 s55, s58, 14
  s_add_u32 s64, s64, s55
  s_add_u32 s64, s64, 1048576
  s_add_u32 s72, s64, s69
  s_add_u32 s73, s64, s66
  s_add_u32 s59, s59, 7
  s_cmp_ge_u32 s59, 64
  s_cbranch_scc1 KV_done1
  s_waitcnt vmcnt(5)
  s_barrier
  s_add_u32 s60, s60, 258048
  ds_read_b128 v[32:35], v203 offset:0
  ds_read_b128 v[36:39], v204 offset:0
  ds_read_b128 v[40:43], v205 offset:0
  s_waitcnt lgkmcnt(2)
  v_mfma_f32_32x32x16_bf16 v[0:15], a[0:3], v[32:35], 0
  ds_read_b128 v[44:47], v206 offset:0
  s_add_u32 m0, s67, 36864
  s_nop 0
  buffer_load_dwordx4 v202, s[4:7], s60 offen offset:0 lds
  v_mfma_f32_32x32x16_bf16 v[16:31], v[32:35], a[144:147], 0
  s_waitcnt lgkmcnt(2)
  v_mfma_f32_32x32x16_bf16 v[0:15], a[4:7], v[36:39], v[0:15]
  ds_read_b128 v[32:35], v203 offset:1024
  s_add_u32 m0, s67, 37760
  s_nop 0
  buffer_load_dwordx4 v202, s[4:7], s60 offen offset:128 lds
  v_mfma_f32_32x32x16_bf16 v[16:31], v[36:39], a[148:151], v[16:31]
  s_waitcnt lgkmcnt(2)
  v_mfma_f32_32x32x16_bf16 v[0:15], a[8:11], v[40:43], v[0:15]
  ds_read_b128 v[36:39], v204 offset:1024
  s_add_u32 m0, s67, 38656
  s_nop 0
  buffer_load_dwordx4 v202, s[4:7], s60 offen offset:256 lds
  v_mfma_f32_32x32x16_bf16 v[16:31], v[40:43], a[152:155], v[16:31]
  s_waitcnt lgkmcnt(2)
  v_mfma_f32_32x32x16_bf16 v[0:15], a[12:15], v[44:47], v[0:15]
  ds_read_b128 v[40:43], v205 offset:1024
  s_add_u32 m0, s67, 39552
  s_nop 0
  buffer_load_dwordx4 v202, s[4:7], s60 offen offset:384 lds
  v_mfma_f32_32x32x16_bf16 v[16:31], v[44:47], a[156:159], v[16:31]
  s_waitcnt lgkmcnt(2)
  v_mfma_f32_32x32x16_bf16 v[0:15], a[16:19], v[32:35], v[0:15]
  ds_read_b128 v[44:47], v206 offset:1024
  s_add_u32 m0, s67, 40448
  s_nop 0
  buffer_load_dwordx4 v202, s[4:7], s60 offen offset:512 lds
  v_mfma_f32_32x32x16_bf16 v[16:31], v[32:35], a[160:163], v[16:31]
  s_waitcnt lgkmcnt(2)
  v_mfma_f32_32x32x16_bf16 v[0:15], a[20:23], v[36:39], v[0:15]
  ds_read_b128 v[32:35], v203 offset:2048
  s_add_u32 m0, s67, 41344
  s_nop 0
  buffer_load_dwordx4 v202, s[4:7], s60 offen offset:640 lds
  v_mfma_f32_32x32x16_bf16 v[16:31], v[36:39], a[164:167], v[16:31]
  s_waitcnt lgkmcnt(2)
  v_mfma_f32_32x32x16_bf16 v[0:15], a[24:27], v[40:43], v[0:15]
  ds_read_b128 v[36:39], v204 offset:2048
  s_add_u32 m0, s67, 42240
  s_nop 0
  buffer_load_dwordx4 v202, s[4:7], s60 offen offset:768 lds
  v_mfma_f32_32x32x16_bf16 v[16:31], v[40:43], a[168:171], v[16:31]
  s_waitcnt lgkmcnt(2)
  v_mfma_f32_32x32x16_bf16 v[0:15], a[28:31], v[44:47], v[0:15]
  ds_read_b128 v[40:43], v205 offset:2048
  s_add_u32 m0, s67, 43136
  s_nop 0
  buffer_load_dwordx4 v202, s[4:7], s60 offen offset:896 lds
  v_mfma_f32_32x32x16_bf16 v[16:31], v[44:47], a[172:175], v[16:31]
  s_waitcnt lgkmcnt(2)
  v_mfma_f32_32x32x16_bf16 v[0:15], a[32:35], v[32:35], v[0:15]
  ds_read_b128 v[44:47], v206 offset:2048
  s_add_u32 m0, s67, 44032
  s_nop 0
  buffer_load_dwordx4 v202, s[4:7], s60 offen offset:1024 lds
  v_mfma_f32_32x32x16_bf16 v[16:31], v[32:35], a[176:179], v[16:31]
  s_waitcnt lgkmcnt(2)
  v_mfma_f32_32x32x16_bf16 v[0:15], a[36:39], v[36:39], v[0:15]
  ds_read_b128 v[32:35], v203 offset:3072
  v_mul_f32 v68, s68, v68
  v_mul_f32 v69, s68, v69
  v_mul_f32 v70, s68, v70
  v_mul_f32 v71, s68, v71
  v_mfma_f32_32x32x16_bf16 v[16:31], v[36:39], a[180:183], v[16:31]
  v_mul_f32 v72, s68, v72
  v_mul_f32 v73, s68, v73
  v_mul_f32 v74, s68, v74
  v_mul_f32 v75, s68, v75
  s_waitcnt lgkmcnt(2)
  v_mfma_f32_32x32x16_bf16 v[0:15], a[40:43], v[40:43], v[0:15]
  ds_read_b128 v[36:39], v204 offset:3072
  v_cvt_pk_bf16_f32 v48, v68, v72
  v_cvt_pk_bf16_f32 v49, v69, v73
  v_cvt_pk_bf16_f32 v50, v70, v74
  v_cvt_pk_bf16_f32 v51, v71, v75
  v_mfma_f32_32x32x16_bf16 v[16:31], v[40:43], a[184:187], v[16:31]
  buffer_store_dwordx4 v[48:51], v216, s[8:11], s72 offen offset:0 sc1
  s_waitcnt lgkmcnt(2)
  v_mfma_f32_32x32x16_bf16 v[0:15], a[44:47], v[44:47], v[0:15]
  ds_read_b128 v[40:43], v205 offset:3072
  v_mfma_f32_32x32x16_bf16 v[16:31], v[44:47], a[188:191], v[16:31]
  s_waitcnt lgkmcnt(2)
  v_mfma_f32_32x32x16_bf16 v[0:15], a[48:51], v[32:35], v[0:15]
  ds_read_b128 v[44:47], v206 offset:3072
  v_mul_f32 v76, s68, v76
  v_mul_f32 v77, s68, v77
  v_mul_f32 v78, s68, v78
  v_mul_f32 v79, s68, v79
  v_mfma_f32_32x32x16_bf16 v[16:31], v[32:35], a[192:195], v[16:31]
  v_mul_f32 v80, s68, v80
  v_mul_f32 v81, s68, v81
  v_mul_f32 v82, s68, v82
  v_mul_f32 v83, s68, v83
  s_waitcnt lgkmcnt(2)
  v_mfma_f32_32x32x16_bf16 v[0:15], a[52:55], v[36:39], v[0:15]
  ds_read_b128 v[32:35], v203 offset:4096
  v_cvt_pk_bf16_f32 v52, v76, v80
  v_cvt_pk_bf16_f32 v53, v77, v81
  v_cvt_pk_bf16_f32 v54, v78, v82
  v_cvt_pk_bf16_f32 v55, v79, v83
  v_mfma_f32_32x32x16_bf16 v[16:31], v[36:39], a[196:199], v[16:31]
  buffer_store_dwordx4 v[52:55], v216, s[8:11], s72 offen offset:256 sc1
  s_waitcnt lgkmcnt(2)
  v_mfma_f32_32x32x16_bf16 v[0:15], a[56:59], v[40:43], v[0:15]
  ds_read_b128 v[36:39], v204 offset:4096
  v_mfma_f32_32x32x16_bf16 v[16:31], v[40:43], a[200:203], v[16:31]
  s_waitcnt lgkmcnt(2)
  v_mfma_f32_32x32x16_bf16 v[0:15], a[60:63], v[44:47], v[0:15]
  ds_read_b128 v[40:43], v205 offset:4096
  v_cvt_pk_bf16_f32 v56, v84, v85
  v_cvt_pk_bf16_f32 v57, v88, v89
  v_cvt_pk_bf16_f32 v58, v92, v93
  v_cvt_pk_bf16_f32 v59, v96, v97
  v_mfma_f32_32x32x16_bf16 v[16:31], v[44:47], a[204:207], v[16:31]
  buffer_store_dwordx4 v[56:59], v217, s[8:11], s64 offen offset:0 sc1
  s_waitcnt lgkmcnt(2)
  v_mfma_f32_32x32x16_bf16 v[0:15], a[64:67], v[32:35], v[0:15]
  ds_read_b128 v[44:47], v206 offset:4096
  v_mfma_f32_32x32x16_bf16 v[16:31], v[32:35], a[208:211], v[16:31]
  s_waitcnt lgkmcnt(2)
  v_mfma_f32_32x32x16_bf16 v[0:15], a[68:71], v[36:39], v[0:15]
  ds_read_b128 v[32:35], v203 offset:5120
  v_cvt_pk_bf16_f32 v60, v86, v87
  v_cvt_pk_bf16_f32 v61, v90, v91
  v_cvt_pk_bf16_f32 v62, v94, v95
  v_cvt_pk_bf16_f32 v63, v98, v99
  v_mfma_f32_32x32x16_bf16 v[16:31], v[36:39], a[212:215], v[16:31]
  buffer_store_dwordx4 v[60:63], v217, s[8:11], s64 offen offset:256 sc1
  s_waitcnt lgkmcnt(2)
  v_mfma_f32_32x32x16_bf16 v[0:15], a[72:75], v[40:43], v[0:15]
  ds_read_b128 v[36:39], v204 offset:5120
  v_mfma_f32_32x32x16_bf16 v[16:31], v[40:43], a[216:219], v[16:31]
  s_waitcnt lgkmcnt(2)
  v_mfma_f32_32x32x16_bf16 v[0:15], a[76:79], v[44:47], v[0:15]
  ds_read_b128 v[40:43], v205 offset:5120
  buffer_store_dwordx4 v[64:67], v201, s[8:11], s73 offen sc1
  v_mfma_f32_32x32x16_bf16 v[16:31], v[44:47], a[220:223], v[16:31]
  s_waitcnt lgkmcnt(2)
  v_mfma_f32_32x32x16_bf16 v[0:15], a[80:83], v[32:35], v[0:15]
  ds_read_b128 v[44:47], v206 offset:5120
  v_mfma_f32_32x32x16_bf16 v[16:31], v[32:35], a[224:227], v[16:31]
  s_waitcnt lgkmcnt(2)
  v_mfma_f32_32x32x16_bf16 v[0:15], a[84:87], v[36:39], v[0:15]
  ds_read_b128 v[32:35], v203 offset:6144
  v_mfma_f32_32x32x16_bf16 v[16:31], v[36:39], a[228:231], v[16:31]
  s_waitcnt lgkmcnt(2)
  v_mfma_f32_32x32x16_bf16 v[0:15], a[88:91], v[40:43], v[0:15]
  ds_read_b128 v[36:39], v204 offset:6144
  v_mfma_f32_32x32x16_bf16 v[16:31], v[40:43], a[232:235], v[16:31]
  s_waitcnt lgkmcnt(2)
  v_mfma_f32_32x32x16_bf16 v[0:15], a[92:95], v[44:47], v[0:15]
  ds_read_b128 v[40:43], v205 offset:6144
  v_mfma_f32_32x32x16_bf16 v[16:31], v[44:47], a[236:239], v[16:31]
  s_waitcnt lgkmcnt(2)
  v_mfma_f32_32x32x16_bf16 v[0:15], a[96:99], v[32:35], v[0:15]
  ds_read_b128 v[44:47], v206 offset:6144
  v_mfma_f32_32x32x16_bf16 v[16:31], v[32:35], a[240:243], v[16:31]
  s_waitcnt lgkmcnt(2)
  v_mfma_f32_32x32x16_bf16 v[0:15], a[100:103], v[36:39], v[0:15]
  ds_read_b128 v[32:35], v203 offset:7168
  v_mfma_f32_32x32x16_bf16 v[16:31], v[36:39], a[244:247], v[16:31]
  s_waitcnt lgkmcnt(2)
  v_mfma_f32_32x32x16_bf16 v[0:15], a[104:107], v[40:43], v[0:15]
  ds_read_b128 v[36:39], v204 offset:7168
  v_mfma_f32_32x32x16_bf16 v[16:31], v[40:43], a[248:251], v[16:31]
  s_waitcnt lgkmcnt(2)
  v_mfma_f32_32x32x16_bf16 v[0:15], a[108:111], v[44:47], v[0:15]
  ds_read_b128 v[40:43], v205 offset:7168
  v_mfma_f32_32x32x16_bf16 v[16:31], v[44:47], a[252:255], v[16:31]
  s_waitcnt lgkmcnt(2)
  v_mfma_f32_32x32x16_bf16 v[0:15], a[112:115], v[32:35], v[0:15]
  ds_read_b128 v[44:47], v206 offset:7168
  v_mfma_f32_32x32x16_bf16 v[16:31], v[32:35], v[224:227], v[16:31]
  s_waitcnt lgkmcnt(2)
  v_mfma_f32_32x32x16_bf16 v[0:15], a[116:119], v[36:39], v[0:15]
  ds_read_b128 v[32:35], v203 offset:8192
  v_mfma_f32_32x32x16_bf16 v[16:31], v[36:39], v[228:231], v[16:31]
  s_waitcnt lgkmcnt(2)
  v_mfma_f32_32x32x16_bf16 v[0:15], a[120:123], v[40:43], v[0:15]
  ds_read_b128 v[36:39], v204 offset:8192
  v_mfma_f32_32x32x16_bf16 v[16:31], v[40:43], v[232:235], v[16:31]
  s_waitcnt lgkmcnt(2)
  v_mfma_f32_32x32x16_bf16 v[0:15], a[124:127], v[44:47], v[0:15]
  ds_read_b128 v[40:43], v205 offset:8192
  v_mfma_f32_32x32x16_bf16 v[16:31], v[44:47], v[236:239], v[16:31]
  s_waitcnt lgkmcnt(2)
  v_mfma_f32_32x32x16_bf16 v[0:15], a[128:131], v[32:35], v[0:15]
  ds_read_b128 v[44:47], v206 offset:8192
  v_mfma_f32_32x32x16_bf16 v[16:31], v[32:35], v[240:243], v[16:31]
  s_waitcnt lgkmcnt(2)
  v_mfma_f32_32x32x16_bf16 v[0:15], a[132:135], v[36:39], v[0:15]
  v_mfma_f32_32x32x16_bf16 v[16:31], v[36:39], v[244:247], v[16:31]
  s_waitcnt lgkmcnt(1)
  v_mfma_f32_32x32x16_bf16 v[0:15], a[136:139], v[40:43], v[0:15]
  v_mfma_f32_32x32x16_bf16 v[16:31], v[40:43], v[248:251], v[16:31]
  s_waitcnt lgkmcnt(0)
  v_mfma_f32_32x32x16_bf16 v[0:15], a[140:143], v[44:47], v[0:15]
  v_mfma_f32_32x32x16_bf16 v[16:31], v[44:47], v[252:255], v[16:31]
  s_mul_i32 s64, s59, 655360
  s_lshl_b32 s55, s58, 14
  s_add_u32 s64, s64, s55
  s_add_u32 s64, s64, 1048576
  s_add_u32 s72, s64, s69
  s_add_u32 s73, s64, s66
  s_add_u32 s59, s59, 7
  s_cmp_ge_u32 s59, 64
  s_cbranch_scc1 KV_done0
  s_sub_u32 s54, s59, 21
  s_cmp_lt_u32 s54, 7
  s_cbranch_scc1 KV_early
  s_waitcnt vmcnt(5)
  s_barrier
KV_cont:
  s_branch KV_loop
KV_early:
  s_waitcnt vmcnt(0)
  s_barrier
  s_cmp_eq_u32 s52, 0
  s_cbranch_scc0 KV_sig0
  v_mov_b32 v211, 1
  v_mov_b32 v212, 0
  s_mov_b64 exec, 1
  buffer_atomic_add v211, v212, s[12:15], s70 offen
  s_mov_b64 exec, -1
KV_sig0:
  s_branch KV_cont
KV_done1:
  s_nop 11
  v_mul_f32 v68, s68, v68
  v_mul_f32 v69, s68, v69
  v_mul_f32 v70, s68, v70
  v_mul_f32 v71, s68, v71
  v_mul_f32 v72, s68, v72
  v_mul_f32 v73, s68, v73
  v_mul_f32 v74, s68, v74
  v_mul_f32 v75, s68, v75
  v_cvt_pk_bf16_f32 v48, v68, v72
  v_cvt_pk_bf16_f32 v49, v69, v73
  v_cvt_pk_bf16_f32 v50, v70, v74
  v_cvt_pk_bf16_f32 v51, v71, v75
  buffer_store_dwordx4 v[48:51], v216, s[8:11], s72 offen offset:0 sc1
  v_mul_f32 v76, s68, v76
  v_mul_f32 v77, s68, v77
  v_mul_f32 v78, s68, v78
  v_mul_f32 v79, s68, v79
  v_mul_f32 v80, s68, v80
  v_mul_f32 v81, s68, v81
  v_mul_f32 v82, s68, v82
  v_mul_f32 v83, s68, v83
  v_cvt_pk_bf16_f32 v52, v76, v80
  v_cvt_pk_bf16_f32 v53, v77, v81
  v_cvt_pk_bf16_f32 v54, v78, v82
  v_cvt_pk_bf16_f32 v55, v79, v83
  buffer_store_dwordx4 v[52:55], v216, s[8:11], s72 offen offset:256 sc1
  v_cvt_pk_bf16_f32 v56, v84, v85
  v_cvt_pk_bf16_f32 v57, v88, v89
  v_cvt_pk_bf16_f32 v58, v92, v93
  v_cvt_pk_bf16_f32 v59, v96, v97
  buffer_store_dwordx4 v[56:59], v217, s[8:11], s64 offen offset:0 sc1
  v_cvt_pk_bf16_f32 v60, v86, v87
  v_cvt_pk_bf16_f32 v61, v90, v91
  v_cvt_pk_bf16_f32 v62, v94, v95
  v_cvt_pk_bf16_f32 v63, v98, v99
  buffer_store_dwordx4 v[60:63], v217, s[8:11], s64 offen offset:256 sc1
  buffer_store_dwordx4 v[64:67], v201, s[8:11], s73 offen sc1
  s_branch KV_fin
KV_done0:
  s_nop 11
  v_mul_f32 v0, s68, v0
  v_mul_f32 v1, s68, v1
  v_mul_f32 v2, s68, v2
  v_mul_f32 v3, s68, v3
  v_mul_f32 v4, s68, v4
  v_mul_f32 v5, s68, v5
  v_mul_f32 v6, s68, v6
  v_mul_f32 v7, s68, v7
  v_cvt_pk_bf16_f32 v48, v0, v4
  v_cvt_pk_bf16_f32 v49, v1, v5
  v_cvt_pk_bf16_f32 v50, v2, v6
  v_cvt_pk_bf16_f32 v51, v3, v7
  buffer_store_dwordx4 v[48:51], v216, s[8:11], s72 offen offset:0 sc1
  v_mul_f32 v8, s68, v8
  v_mul_f32 v9, s68, v9
  v_mul_f32 v10, s68, v10
  v_mul_f32 v11, s68, v11
  v_mul_f32 v12, s68, v12
  v_mul_f32 v13, s68, v13
  v_mul_f32 v14, s68, v14
  v_mul_f32 v15, s68, v15
  v_cvt_pk_bf16_f32 v52, v8, v12
  v_cvt_pk_bf16_f32 v53, v9, v13
  v_cvt_pk_bf16_f32 v54, v10, v14
  v_cvt_pk_bf16_f32 v55, v11, v15
  buffer_store_dwordx4 v[52:55], v216, s[8:11], s72 offen offset:256 sc1
  v_cvt_pk_bf16_f32 v56, v16, v17
  v_cvt_pk_bf16_f32 v57, v20, v21
  v_cvt_pk_bf16_f32 v58, v24, v25
  v_cvt_pk_bf16_f32 v59, v28, v29
  buffer_store_dwordx4 v[56:59], v217, s[8:11], s64 offen offset:0 sc1
  v_cvt_pk_bf16_f32 v60, v18, v19
  v_cvt_pk_bf16_f32 v61, v22, v23
  v_cvt_pk_bf16_f32 v62, v26, v27
  v_cvt_pk_bf16_f32 v63, v30, v31
  buffer_store_dwordx4 v[60:63], v217, s[8:11], s64 offen offset:256 sc1
  buffer_store_dwordx4 v[64:67], v201, s[8:11], s73 offen sc1
KV_fin:
  s_waitcnt vmcnt(0)
  s_barrier
  s_cmp_eq_u32 s52, 0
  s_cbranch_scc0 KV_sig
  v_mov_b32 v211, 256
  v_mov_b32 v212, 0
  s_mov_b64 exec, 1
  buffer_atomic_add v211, v212, s[12:15], s70 offen
  s_mov_b64 exec, -1
KV_sig:
  s_cmp_ge_u32 s53, 192
  s_cbranch_scc1 L_exit
  s_cmp_lt_u32 s53, 64
  s_cbranch_scc1 W_h
  s_sub_u32 s54, s53, 64
  s_lshr_b32 s68, s54, 4
  s_and_b32 s69, s54, 15
  s_lshl_b32 s60, s69, 2
  s_sub_u32 s60, s60, 1
  s_max_i32 s60, s60, 0
  s_mul_i32 s60, s60, 36864
  s_add_u32 m0, s67, 0
  s_nop 0
  buffer_load_dwordx4 v202, s[4:7], s60 offen offset:0 lds
  s_add_u32 m0, s67, 896
  s_nop 0
  buffer_load_dwordx4 v202, s[4:7], s60 offen offset:128 lds
  s_add_u32 m0, s67, 1792
  s_nop 0
  buffer_load_dwordx4 v202, s[4:7], s60 offen offset:256 lds
  s_add_u32 m0, s67, 2688
  s_nop 0
  buffer_load_dwordx4 v202, s[4:7], s60 offen offset:384 lds
  s_add_u32 m0, s67, 3584
  s_nop 0
  buffer_load_dwordx4 v202, s[4:7], s60 offen offset:512 lds
  s_add_u32 m0, s67, 4480
  s_nop 0
  buffer_load_dwordx4 v202, s[4:7], s60 offen offset:640 lds
  s_add_u32 m0, s67, 5376
  s_nop 0
  buffer_load_dwordx4 v202, s[4:7], s60 offen offset:768 lds
  s_add_u32 m0, s67, 6272
  s_nop 0
  buffer_load_dwordx4 v202, s[4:7], s60 offen offset:896 lds
  s_add_u32 m0, s67, 7168
  s_nop 0
  buffer_load_dwordx4 v202, s[4:7], s60 offen offset:1024 lds
  v_and_b32 v211, 15, v200
  v_mul_u32_u24 v211, 72, v211
  v_lshrrev_b32 v212, 4, v200
  v_mul_u32_u24 v213, 1152, v212
  v_add_u32 v213, v213, v211
  s_lshl_b32 s54, s54, 2
  s_add_u32 s70, s54, s52
  s_mul_i32 s55, s70, 4608
  buffer_load_dwordx4 v[48:51], v213, s[4:7], s55 offen offset:0
  buffer_load_dwordx4 v[52:55], v213, s[4:7], s55 offen offset:16
  buffer_load_dwordx4 v[56:59], v213, s[4:7], s55 offen offset:32
  buffer_load_dwordx4 v[60:63], v213, s[4:7], s55 offen offset:48
  buffer_load_dwordx2 v[64:65], v213, s[4:7], s55 offen offset:64
  buffer_load_dwordx4 v[68:71], v211, s[44:47], 0 offen offset:0
  buffer_load_dwordx4 v[72:75], v211, s[44:47], 0 offen offset:16
  buffer_load_dwordx4 v[76:79], v211, s[44:47], 0 offen offset:32
  buffer_load_dwordx4 v[80:83], v211, s[44:47], 0 offen offset:48
  buffer_load_dwordx2 v[84:85], v211, s[44:47], 0 offen offset:64
  v_mov_b32 v0, 0
  v_mov_b32 v1, 0x3f803f80
  s_waitcnt vmcnt(9)
  v_lshlrev_b32 v2, 16, v48
  s_waitcnt vmcnt(4)
  v_lshlrev_b32 v3, 16, v68
  v_and_b32 v4, 0xffff0000, v48
  v_and_b32 v5, 0xffff0000, v68
  v_mul_f32 v2, v2, v3
  v_mul_f32 v4, v4, v5
  v_cvt_pk_bf16_f32 v2, v2, v4
  v_lshlrev_b32 v3, 16, v2
  v_and_b32 v4, 0xffff0000, v2
  v_add_f32 v0, v0, v3
  v_add_f32 v0, v0, v4
  v_lshlrev_b32 v2, 16, v49
  v_lshlrev_b32 v3, 16, v69
  v_and_b32 v4, 0xffff0000, v49
  v_and_b32 v5, 0xffff0000, v69
  v_mul_f32 v2, v2, v3
  v_mul_f32 v4, v4, v5
  v_cvt_pk_bf16_f32 v2, v2, v4
  v_lshlrev_b32 v3, 16, v2
  v_and_b32 v4, 0xffff0000, v2
  v_add_f32 v0, v0, v3
  v_add_f32 v0, v0, v4
  v_lshlrev_b32 v2, 16, v50
  v_lshlrev_b32 v3, 16, v70
  v_and_b32 v4, 0xffff0000, v50
  v_and_b32 v5, 0xffff0000, v70
  v_mul_f32 v2, v2, v3
  v_mul_f32 v4, v4, v5
  v_cvt_pk_bf16_f32 v2, v2, v4
  v_lshlrev_b32 v3, 16, v2
  v_and_b32 v4, 0xffff0000, v2
  v_add_f32 v0, v0, v3
  v_add_f32 v0, v0, v4
  v_lshlrev_b32 v2, 16, v51
  v_lshlrev_b32 v3, 16, v71
  v_and_b32 v4, 0xffff0000, v51
  v_and_b32 v5, 0xffff0000, v71
  v_mul_f32 v2, v2, v3
  v_mul_f32 v4, v4, v5
  v_cvt_pk_bf16_f32 v2, v2, v4
  v_lshlrev_b32 v3, 16, v2
  v_and_b32 v4, 0xffff0000, v2
  v_add_f32 v0, v0, v3
  v_add_f32 v0, v0, v4
  v_lshlrev_b32 v2, 16, v52
  s_waitcnt vmcnt(3)
  v_lshlrev_b32 v3, 16, v72
  v_and_b32 v4, 0xffff0000, v52
  v_and_b32 v5, 0xffff0000, v72
  v_mul_f32 v2, v2, v3
  v_mul_f32 v4, v4, v5
  v_cvt_pk_bf16_f32 v2, v2, v4
  v_lshlrev_b32 v3, 16, v2
  v_and_b32 v4, 0xffff0000, v2
  v_add_f32 v0, v0, v3
  v_add_f32 v0, v0, v4
  v_lshlrev_b32 v2, 16, v53
  v_lshlrev_b32 v3, 16, v73
  v_and_b32 v4, 0xffff0000, v53
  v_and_b32 v5, 0xffff0000, v73
  v_mul_f32 v2, v2, v3
  v_mul_f32 v4, v4, v5
  v_cvt_pk_bf16_f32 v2, v2, v4
  v_lshlrev_b32 v3, 16, v2
  v_and_b32 v4, 0xffff0000, v2
  v_add_f32 v0, v0, v3
  v_add_f32 v0, v0, v4
  v_lshlrev_b32 v2, 16, v54
  v_lshlrev_b32 v3, 16, v74
  v_and_b32 v4, 0xffff0000, v54
  v_and_b32 v5, 0xffff0000, v74
  v_mul_f32 v2, v2, v3
  v_mul_f32 v4, v4, v5
  v_cvt_pk_bf16_f32 v2, v2, v4
  v_lshlrev_b32 v3, 16, v2
  v_and_b32 v4, 0xffff0000, v2
  v_add_f32 v0, v0, v3
  v_add_f32 v0, v0, v4
  v_lshlrev_b32 v2, 16, v55
  v_lshlrev_b32 v3, 16, v75
  v_and_b32 v4, 0xffff0000, v55
  v_and_b32 v5, 0xffff0000, v75
  v_mul_f32 v2, v2, v3
  v_mul_f32 v4, v4, v5
  v_cvt_pk_bf16_f32 v2, v2, v4
  v_lshlrev_b32 v3, 16, v2
  v_and_b32 v4, 0xffff0000, v2
  v_add_f32 v0, v0, v3
  v_add_f32 v0, v0, v4
  v_lshlrev_b32 v2, 16, v56
  s_waitcnt vmcnt(2)
  v_lshlrev_b32 v3, 16, v76
  v_and_b32 v4, 0xffff0000, v56
  v_and_b32 v5, 0xffff0000, v76
  v_mul_f32 v2, v2, v3
  v_mul_f32 v4, v4, v5
  v_cvt_pk_bf16_f32 v2, v2, v4
  v_lshlrev_b32 v3, 16, v2
  v_and_b32 v4, 0xffff0000, v2
  v_add_f32 v0, v0, v3
  v_add_f32 v0, v0, v4
  v_lshlrev_b32 v2, 16, v57
  v_lshlrev_b32 v3, 16, v77
  v_and_b32 v4, 0xffff0000, v57
  v_and_b32 v5, 0xffff0000, v77
  v_mul_f32 v2, v2, v3
  v_mul_f32 v4, v4, v5
  v_cvt_pk_bf16_f32 v2, v2, v4
  v_lshlrev_b32 v3, 16, v2
  v_and_b32 v4, 0xffff0000, v2
  v_add_f32 v0, v0, v3
  v_add_f32 v0, v0, v4
  v_lshlrev_b32 v2, 16, v58
  v_lshlrev_b32 v3, 16, v78
  v_and_b32 v4, 0xffff0000, v58
  v_and_b32 v5, 0xffff0000, v78
  v_mul_f32 v2, v2, v3
  v_mul_f32 v4, v4, v5
  v_cvt_pk_bf16_f32 v2, v2, v4
  v_lshlrev_b32 v3, 16, v2
  v_and_b32 v4, 0xffff0000, v2
  v_add_f32 v0, v0, v3
  v_add_f32 v0, v0, v4
  v_lshlrev_b32 v2, 16, v59
  v_lshlrev_b32 v3, 16, v79
  v_and_b32 v4, 0xffff0000, v59
  v_and_b32 v5, 0xffff0000, v79
  v_mul_f32 v2, v2, v3
  v_mul_f32 v4, v4, v5
  v_cvt_pk_bf16_f32 v2, v2, v4
  v_lshlrev_b32 v3, 16, v2
  v_and_b32 v4, 0xffff0000, v2
  v_add_f32 v0, v0, v3
  v_add_f32 v0, v0, v4
  v_lshlrev_b32 v2, 16, v60
  s_waitcnt vmcnt(1)
  v_lshlrev_b32 v3, 16, v80
  v_and_b32 v4, 0xffff0000, v60
  v_and_b32 v5, 0xffff0000, v80
  v_mul_f32 v2, v2, v3
  v_mul_f32 v4, v4, v5
  v_cvt_pk_bf16_f32 v2, v2, v4
  v_lshlrev_b32 v3, 16, v2
  v_and_b32 v4, 0xffff0000, v2
  v_add_f32 v0, v0, v3
  v_add_f32 v0, v0, v4
  v_lshlrev_b32 v2, 16, v61
  v_lshlrev_b32 v3, 16, v81
  v_and_b32 v4, 0xffff0000, v61
  v_and_b32 v5, 0xffff0000, v81
  v_mul_f32 v2, v2, v3
  v_mul_f32 v4, v4, v5
  v_cvt_pk_bf16_f32 v2, v2, v4
  v_lshlrev_b32 v3, 16, v2
  v_and_b32 v4, 0xffff0000, v2
  v_add_f32 v0, v0, v3
  v_add_f32 v0, v0, v4
  v_lshlrev_b32 v2, 16, v62
  v_lshlrev_b32 v3, 16, v82
  v_and_b32 v4, 0xffff0000, v62
  v_and_b32 v5, 0xffff0000, v82
  v_mul_f32 v2, v2, v3
  v_mul_f32 v4, v4, v5
  v_cvt_pk_bf16_f32 v2, v2, v4
  v_lshlrev_b32 v3, 16, v2
  v_and_b32 v4, 0xffff0000, v2
  v_add_f32 v0, v0, v3
  v_add_f32 v0, v0, v4
  v_lshlrev_b32 v2, 16, v63
  v_lshlrev_b32 v3, 16, v83
  v_and_b32 v4, 0xffff0000, v63
  v_and_b32 v5, 0xffff0000, v83
  v_mul_f32 v2, v2, v3
  v_mul_f32 v4, v4, v5
  v_cvt_pk_bf16_f32 v2, v2, v4
  v_lshlrev_b32 v3, 16, v2
  v_and_b32 v4, 0xffff0000, v2
  v_add_f32 v0, v0, v3
  v_add_f32 v0, v0, v4
  v_lshlrev_b32 v2, 16, v64
  s_waitcnt vmcnt(0)
  v_lshlrev_b32 v3, 16, v84
  v_and_b32 v4, 0xffff0000, v64
  v_and_b32 v5, 0xffff0000, v84
  v_mul_f32 v2, v2, v3
  v_mul_f32 v4, v4, v5
  v_cvt_pk_bf16_f32 v2, v2, v4
  v_lshlrev_b32 v3, 16, v2
  v_and_b32 v4, 0xffff0000, v2
  v_add_f32 v0, v0, v3
  v_add_f32 v0, v0, v4
  v_lshlrev_b32 v2, 16, v65
  v_lshlrev_b32 v3, 16, v85
  v_and_b32 v4, 0xffff0000, v65
  v_and_b32 v5, 0xffff0000, v85
  v_mul_f32 v2, v2, v3
  v_mul_f32 v4, v4, v5
  v_cvt_pk_bf16_f32 v2, v2, v4
  v_lshlrev_b32 v3, 16, v2
  v_and_b32 v4, 0xffff0000, v2
  v_add_f32 v0, v0, v3
  v_add_f32 v0, v0, v4
  s_nop 1
  v_add_f32_dpp v0, v0, v0 row_ror:1 row_mask:0xf bank_mask:0xf
  s_nop 1
  v_add_f32_dpp v0, v0, v0 row_ror:2 row_mask:0xf bank_mask:0xf
  s_nop 1
  v_add_f32_dpp v0, v0, v0 row_ror:4 row_mask:0xf bank_mask:0xf
  s_nop 1
  v_add_f32_dpp v0, v0, v0 row_ror:8 row_mask:0xf bank_mask:0xf
  v_cvt_pk_bf16_f32 v0, v0, v0
  v_lshlrev_b32 v0, 16, v0
  v_mul_f32 v0, 3216550459, v0
  v_exp_f32 v0, v0
  s_nop 0
  v_add_f32 v0, 1.0, v0
  v_rcp_f32 v0, v0
  s_nop 0
  v_cvt_pk_bf16_f32 v0, v0, v0
  v_lshlrev_b32 v0, 16, v0
  v_lshlrev_b32 v212, 2, v212
  s_lshl_b32 s55, s70, 4
  s_add_u32 s55, s55, 66060288
  s_mov_b32 exec_lo, 0x00010001
  s_mov_b32 exec_hi, 0x00010001
  buffer_store_dword v0, v212, s[8:11], s55 offen sc1
  s_mov_b64 exec, -1
  v_lshrrev_b32 v211, 4, v200
  v_lshlrev_b32 v212, 2, v211
  v_and_b32 v213, 15, v200
  v_xor_b32 v212, v212, v213
  v_mul_u32_u24 v211, 3456, v211
  v_mov_b32 v2, 0x40000000
  v_add_u32 v213, 0, v212
  v_mul_u32_u24 v214, 57, v213
  v_lshrrev_b32 v214, 9, v214
  v_mul_u32_u24 v214, 1008, v214
  v_lshl_add_u32 v214, v213, 4, v214
  v_add_u32 v214, v214, v211
  v_cmp_lt_u32 vcc, 26, v213
  s_nop 1
  v_cndmask_b32 v207, v214, v2, vcc
  v_add_u32 v213, 16, v212
  v_mul_u32_u24 v214, 57, v213
  v_lshrrev_b32 v214, 9, v214
  v_mul_u32_u24 v214, 1008, v214
  v_lshl_add_u32 v214, v213, 4, v214
  v_add_u32 v214, v214, v211
  v_cmp_lt_u32 vcc, 26, v213
  s_nop 1
  v_cndmask_b32 v208, v214, v2, vcc
  s_mul_i32 s62, s68, 144
  s_mul_i32 s54, s52, 13824
  s_add_u32 s62, s62, s54
  s_waitcnt vmcnt(0)
  s_lshl_b32 s61, s52, 10
  s_add_u32 s61, s61, 36864
  s_add_u32 m0, s61, 0
  s_add_u32 s54, s62, 0
  buffer_load_dwordx4 v207, s[36:39], s54 offen lds
  s_add_u32 m0, s61, 4096
  s_add_u32 s54, s62, 55296
  buffer_load_dwordx4 v207, s[36:39], s54 offen lds
  s_add_u32 m0, s61, 8192
  s_add_u32 s54, s62, 110592
  buffer_load_dwordx4 v207, s[36:39], s54 offen lds
  s_add_u32 m0, s61, 12288
  s_add_u32 s54, s62, 165888
  buffer_load_dwordx4 v207, s[36:39], s54 offen lds
  s_add_u32 m0, s61, 16384
  s_add_u32 s54, s62, 0
  buffer_load_dwordx4 v208, s[36:39], s54 offen lds
  s_add_u32 m0, s61, 20480
  s_add_u32 s54, s62, 55296
  buffer_load_dwordx4 v208, s[36:39], s54 offen lds
  s_add_u32 m0, s61, 24576
  s_add_u32 s54, s62, 110592
  buffer_load_dwordx4 v208, s[36:39], s54 offen lds
  s_add_u32 m0, s61, 28672
  s_add_u32 s54, s62, 165888
  buffer_load_dwordx4 v208, s[36:39], s54 offen lds
  s_add_u32 m0, s61, 32768
  s_add_u32 s54, s62, 221184
  buffer_load_dwordx4 v207, s[36:39], s54 offen lds
  s_add_u32 m0, s61, 36864
  s_add_u32 s54, s62, 276480
  buffer_load_dwordx4 v207, s[36:39], s54 offen lds
  s_add_u32 m0, s61, 40960
  s_add_u32 s54, s62, 331776
  buffer_load_dwordx4 v207, s[36:39], s54 offen lds
  s_add_u32 m0, s61, 45056
  s_add_u32 s54, s62, 387072
  buffer_load_dwordx4 v207, s[36:39], s54 offen lds
  s_add_u32 m0, s61, 49152
  s_add_u32 s54, s62, 221184
  buffer_load_dwordx4 v208, s[36:39], s54 offen lds
  s_add_u32 m0, s61, 53248
  s_add_u32 s54, s62, 276480
  buffer_load_dwordx4 v208, s[36:39], s54 offen lds
  s_add_u32 m0, s61, 57344
  s_add_u32 s54, s62, 331776
  buffer_load_dwordx4 v208, s[36:39], s54 offen lds
  s_add_u32 m0, s61, 61440
  s_add_u32 s54, s62, 387072
  buffer_load_dwordx4 v208, s[36:39], s54 offen lds
  s_add_u32 m0, s61, 65536
  s_add_u32 s54, s62, 442368
  buffer_load_dwordx4 v207, s[36:39], s54 offen lds
  s_add_u32 m0, s61, 69632
  s_add_u32 s54, s62, 497664
  buffer_load_dwordx4 v207, s[36:39], s54 offen lds
  s_add_u32 m0, s61, 73728
  s_add_u32 s54, s62, 552960
  buffer_load_dwordx4 v207, s[36:39], s54 offen lds
  s_add_u32 m0, s61, 77824
  s_add_u32 s54, s62, 608256
  buffer_load_dwordx4 v207, s[36:39], s54 offen lds
  s_add_u32 m0, s61, 81920
  s_add_u32 s54, s62, 442368
  buffer_load_dwordx4 v208, s[36:39], s54 offen lds
  s_add_u32 m0, s61, 86016
  s_add_u32 s54, s62, 497664
  buffer_load_dwordx4 v208, s[36:39], s54 offen lds
  s_add_u32 m0, s61, 90112
  s_add_u32 s54, s62, 552960
  buffer_load_dwordx4 v208, s[36:39], s54 offen lds
  s_add_u32 m0, s61, 94208
  s_add_u32 s54, s62, 608256
  buffer_load_dwordx4 v208, s[36:39], s54 offen lds
  s_waitcnt vmcnt(20) lgkmcnt(0)
  s_barrier
  s_add_u32 m0, s61, 98304
  s_add_u32 s54, s62, 663552
  buffer_load_dwordx4 v207, s[36:39], s54 offen lds
  s_add_u32 m0, s61, 102400
  s_add_u32 s54, s62, 718848
  buffer_load_dwordx4 v207, s[36:39], s54 offen lds
  s_add_u32 m0, s61, 106496
  s_add_u32 s54, s62, 774144
  buffer_load_dwordx4 v207, s[36:39], s54 offen lds
  s_add_u32 m0, s61, 110592
  s_add_u32 s54, s62, 829440
  buffer_load_dwordx4 v207, s[36:39], s54 offen lds
  v_add_u32 v215, 36864, v210
  ds_read_b64_tr_b16 a[0:1], v215 offset:0
  ds_read_b64_tr_b16 a[2:3], v215 offset:1024
  ds_read_b64_tr_b16 a[4:5], v215 offset:4096
  ds_read_b64_tr_b16 a[6:7], v215 offset:5120
  ds_read_b64_tr_b16 a[8:9], v215 offset:8192
  ds_read_b64_tr_b16 a[10:11], v215 offset:9216
  ds_read_b64_tr_b16 a[12:13], v215 offset:12288
  ds_read_b64_tr_b16 a[14:15], v215 offset:13312
  s_waitcnt vmcnt(20) lgkmcnt(0)
  s_barrier
  s_add_u32 m0, s61, 0
  s_add_u32 s54, s62, 663552
  buffer_load_dwordx4 v208, s[36:39], s54 offen lds
  s_add_u32 m0, s61, 4096
  s_add_u32 s54, s62, 718848
  buffer_load_dwordx4 v208, s[36:39], s54 offen lds
  s_add_u32 m0, s61, 8192
  s_add_u32 s54, s62, 774144
  buffer_load_dwordx4 v208, s[36:39], s54 offen lds
  s_add_u32 m0, s61, 12288
  s_add_u32 s54, s62, 829440
  buffer_load_dwordx4 v208, s[36:39], s54 offen lds
  v_add_u32 v215, 53248, v210
  ds_read_b64_tr_b16 a[144:145], v215 offset:0
  ds_read_b64_tr_b16 a[146:147], v215 offset:1024
  ds_read_b64_tr_b16 a[148:149], v215 offset:4096
  ds_read_b64_tr_b16 a[150:151], v215 offset:5120
  ds_read_b64_tr_b16 a[152:153], v215 offset:8192
  ds_read_b64_tr_b16 a[154:155], v215 offset:9216
  ds_read_b64_tr_b16 a[156:157], v215 offset:12288
  ds_read_b64_tr_b16 a[158:159], v215 offset:13312
  s_waitcnt vmcnt(20) lgkmcnt(0)
  s_barrier
  s_add_u32 m0, s61, 16384
  s_add_u32 s54, s62, 884736
  buffer_load_dwordx4 v207, s[36:39], s54 offen lds
  s_add_u32 m0, s61, 20480
  s_add_u32 s54, s62, 940032
  buffer_load_dwordx4 v207, s[36:39], s54 offen lds
  s_add_u32 m0, s61, 24576
  s_add_u32 s54, s62, 995328
  buffer_load_dwordx4 v207, s[36:39], s54 offen lds
  s_add_u32 m0, s61, 28672
  s_add_u32 s54, s62, 1050624
  buffer_load_dwordx4 v207, s[36:39], s54 offen lds
  v_add_u32 v215, 69632, v210
  ds_read_b64_tr_b16 a[16:17], v215 offset:0
  ds_read_b64_tr_b16 a[18:19], v215 offset:1024
  ds_read_b64_tr_b16 a[20:21], v215 offset:4096
  ds_read_b64_tr_b16 a[22:23], v215 offset:5120
  ds_read_b64_tr_b16 a[24:25], v215 offset:8192
  ds_read_b64_tr_b16 a[26:27], v215 offset:9216
  ds_read_b64_tr_b16 a[28:29], v215 offset:12288
  ds_read_b64_tr_b16 a[30:31], v215 offset:13312
  s_waitcnt vmcnt(20) lgkmcnt(0)
  s_barrier
  s_add_u32 m0, s61, 32768
  s_add_u32 s54, s62, 884736
  buffer_load_dwordx4 v208, s[36:39], s54 offen lds
  s_add_u32 m0, s61, 36864
  s_add_u32 s54, s62, 940032
  buffer_load_dwordx4 v208, s[36:39], s54 offen lds
  s_add_u32 m0, s61, 40960
  s_add_u32 s54, s62, 995328
  buffer_load_dwordx4 v208, s[36:39], s54 offen lds
  s_add_u32 m0, s61, 45056
  s_add_u32 s54, s62, 1050624
  buffer_load_dwordx4 v208, s[36:39], s54 offen lds
  v_add_u32 v215, 86016, v210
  ds_read_b64_tr_b16 a[160:161], v215 offset:0
  ds_read_b64_tr_b16 a[162:163], v215 offset:1024
  ds_read_b64_tr_b16 a[164:165], v215 offset:4096
  ds_read_b64_tr_b16 a[166:167], v215 offset:5120
  ds_read_b64_tr_b16 a[168:169], v215 offset:8192
  ds_read_b64_tr_b16 a[170:171], v215 offset:9216
  ds_read_b64_tr_b16 a[172:173], v215 offset:12288
  ds_read_b64_tr_b16 a[174:175], v215 offset:13312
  s_waitcnt vmcnt(20) lgkmcnt(0)
  s_barrier
  s_add_u32 m0, s61, 49152
  s_add_u32 s54, s62, 1105920
  buffer_load_dwordx4 v207, s[36:39], s54 offen lds
  s_add_u32 m0, s61, 53248
  s_add_u32 s54, s62, 1161216
  buffer_load_dwordx4 v207, s[36:39], s54 offen lds
  s_add_u32 m0, s61, 57344
  s_add_u32 s54, s62, 1216512
  buffer_load_dwordx4 v207, s[36:39], s54 offen lds
  s_add_u32 m0, s61, 61440
  s_add_u32 s54, s62, 1271808
  buffer_load_dwordx4 v207, s[36:39], s54 offen lds
  v_add_u32 v215, 102400, v210
  ds_read_b64_tr_b16 a[32:33], v215 offset:0
  ds_read_b64_tr_b16 a[34:35], v215 offset:1024
  ds_read_b64_tr_b16 a[36:37], v215 offset:4096
  ds_read_b64_tr_b16 a[38:39], v215 offset:5120
  ds_read_b64_tr_b16 a[40:41], v215 offset:8192
  ds_read_b64_tr_b16 a[42:43], v215 offset:9216
  ds_read_b64_tr_b16 a[44:45], v215 offset:12288
  ds_read_b64_tr_b16 a[46:47], v215 offset:13312
  s_waitcnt vmcnt(20) lgkmcnt(0)
  s_barrier
  s_add_u32 m0, s61, 65536
  s_add_u32 s54, s62, 1105920
  buffer_load_dwordx4 v208, s[36:39], s54 offen lds
  s_add_u32 m0, s61, 69632
  s_add_u32 s54, s62, 1161216
  buffer_load_dwordx4 v208, s[36:39], s54 offen lds
  s_add_u32 m0, s61, 73728
  s_add_u32 s54, s62, 1216512
  buffer_load_dwordx4 v208, s[36:39], s54 offen lds
  s_add_u32 m0, s61, 77824
  s_add_u32 s54, s62, 1271808
  buffer_load_dwordx4 v208, s[36:39], s54 offen lds
  v_add_u32 v215, 118784, v210
  ds_read_b64_tr_b16 a[176:177], v215 offset:0
  ds_read_b64_tr_b16 a[178:179], v215 offset:1024
  ds_read_b64_tr_b16 a[180:181], v215 offset:4096
  ds_read_b64_tr_b16 a[182:183], v215 offset:5120
  ds_read_b64_tr_b16 a[184:185], v215 offset:8192
  ds_read_b64_tr_b16 a[186:187], v215 offset:9216
  ds_read_b64_tr_b16 a[188:189], v215 offset:12288
  ds_read_b64_tr_b16 a[190:191], v215 offset:13312
  s_waitcnt vmcnt(20) lgkmcnt(0)
  s_barrier
  s_add_u32 m0, s61, 81920
  s_add_u32 s54, s62, 1327104
  buffer_load_dwordx4 v207, s[36:39], s54 offen lds
  s_add_u32 m0, s61, 86016
  s_add_u32 s54, s62, 1382400
  buffer_load_dwordx4 v207, s[36:39], s54 offen lds
  s_add_u32 m0, s61, 90112
  s_add_u32 s54, s62, 1437696
  buffer_load_dwordx4 v207, s[36:39], s54 offen lds
  s_add_u32 m0, s61, 94208
  s_add_u32 s54, s62, 1492992
  buffer_load_dwordx4 v207, s[36:39], s54 offen lds
  v_add_u32 v215, 135168, v210
  ds_read_b64_tr_b16 a[48:49], v215 offset:0
  ds_read_b64_tr_b16 a[50:51], v215 offset:1024
  ds_read_b64_tr_b16 a[52:53], v215 offset:4096
  ds_read_b64_tr_b16 a[54:55], v215 offset:5120
  ds_read_b64_tr_b16 a[56:57], v215 offset:8192
  ds_read_b64_tr_b16 a[58:59], v215 offset:9216
  ds_read_b64_tr_b16 a[60:61], v215 offset:12288
  ds_read_b64_tr_b16 a[62:63], v215 offset:13312
  s_waitcnt vmcnt(20) lgkmcnt(0)
  s_barrier
  s_add_u32 m0, s61, 98304
  s_add_u32 s54, s62, 1327104
  buffer_load_dwordx4 v208, s[36:39], s54 offen lds
  s_add_u32 m0, s61, 102400
  s_add_u32 s54, s62, 1382400
  buffer_load_dwordx4 v208, s[36:39], s54 offen lds
  s_add_u32 m0, s61, 106496
  s_add_u32 s54, s62, 1437696
  buffer_load_dwordx4 v208, s[36:39], s54 offen lds
  s_add_u32 m0, s61, 110592
  s_add_u32 s54, s62, 1492992
  buffer_load_dwordx4 v208, s[36:39], s54 offen lds
  v_add_u32 v215, 36864, v210
  ds_read_b64_tr_b16 a[192:193], v215 offset:0
  ds_read_b64_tr_b16 a[194:195], v215 offset:1024
  ds_read_b64_tr_b16 a[196:197], v215 offset:4096
  ds_read_b64_tr_b16 a[198:199], v215 offset:5120
  ds_read_b64_tr_b16 a[200:201], v215 offset:8192
  ds_read_b64_tr_b16 a[202:203], v215 offset:9216
  ds_read_b64_tr_b16 a[204:205], v215 offset:12288
  ds_read_b64_tr_b16 a[206:207], v215 offset:13312
  s_waitcnt vmcnt(20) lgkmcnt(0)
  s_barrier
  s_add_u32 m0, s61, 0
  s_add_u32 s54, s62, 1548288
  buffer_load_dwordx4 v207, s[36:39], s54 offen lds
  s_add_u32 m0, s61, 4096
  s_add_u32 s54, s62, 1603584
  buffer_load_dwordx4 v207, s[36:39], s54 offen lds
  s_add_u32 m0, s61, 8192
  s_add_u32 s54, s62, 1658880
  buffer_load_dwordx4 v207, s[36:39], s54 offen lds
  s_add_u32 m0, s61, 12288
  s_add_u32 s54, s62, 1714176
  buffer_load_dwordx4 v207, s[36:39], s54 offen lds
  v_add_u32 v215, 53248, v210
  ds_read_b64_tr_b16 a[64:65], v215 offset:0
  ds_read_b64_tr_b16 a[66:67], v215 offset:1024
  ds_read_b64_tr_b16 a[68:69], v215 offset:4096
  ds_read_b64_tr_b16 a[70:71], v215 offset:5120
  ds_read_b64_tr_b16 a[72:73], v215 offset:8192
  ds_read_b64_tr_b16 a[74:75], v215 offset:9216
  ds_read_b64_tr_b16 a[76:77], v215 offset:12288
  ds_read_b64_tr_b16 a[78:79], v215 offset:13312
  s_waitcnt vmcnt(20) lgkmcnt(0)
  s_barrier
  s_add_u32 m0, s61, 16384
  s_add_u32 s54, s62, 1548288
  buffer_load_dwordx4 v208, s[36:39], s54 offen lds
  s_add_u32 m0, s61, 20480
  s_add_u32 s54, s62, 1603584
  buffer_load_dwordx4 v208, s[36:39], s54 offen lds
  s_add_u32 m0, s61, 24576
  s_add_u32 s54, s62, 1658880
  buffer_load_dwordx4 v208, s[36:39], s54 offen lds
  s_add_u32 m0, s61, 28672
  s_add_u32 s54, s62, 1714176
  buffer_load_dwordx4 v208, s[36:39], s54 offen lds
  v_add_u32 v215, 69632, v210
  ds_read_b64_tr_b16 a[208:209], v215 offset:0
  ds_read_b64_tr_b16 a[210:211], v215 offset:1024
  ds_read_b64_tr_b16 a[212:213], v215 offset:4096
  ds_read_b64_tr_b16 a[214:215], v215 offset:5120
  ds_read_b64_tr_b16 a[216:217], v215 offset:8192
  ds_read_b64_tr_b16 a[218:219], v215 offset:9216
  ds_read_b64_tr_b16 a[220:221], v215 offset:12288
  ds_read_b64_tr_b16 a[222:223], v215 offset:13312
  s_waitcnt vmcnt(20) lgkmcnt(0)
  s_barrier
  s_add_u32 m0, s61, 32768
  s_add_u32 s54, s62, 1769472
  buffer_load_dwordx4 v207, s[36:39], s54 offen lds
  s_add_u32 m0, s61, 36864
  s_add_u32 s54, s62, 1824768
  buffer_load_dwordx4 v207, s[36:39], s54 offen lds
  s_add_u32 m0, s61, 40960
  s_add_u32 s54, s62, 1880064
  buffer_load_dwordx4 v207, s[36:39], s54 offen lds
  s_add_u32 m0, s61, 45056
  s_add_u32 s54, s62, 1935360
  buffer_load_dwordx4 v207, s[36:39], s54 offen lds
  v_add_u32 v215, 86016, v210
  ds_read_b64_tr_b16 a[80:81], v215 offset:0
  ds_read_b64_tr_b16 a[82:83], v215 offset:1024
  ds_read_b64_tr_b16 a[84:85], v215 offset:4096
  ds_read_b64_tr_b16 a[86:87], v215 offset:5120
  ds_read_b64_tr_b16 a[88:89], v215 offset:8192
  ds_read_b64_tr_b16 a[90:91], v215 offset:9216
  ds_read_b64_tr_b16 a[92:93], v215 offset:12288
  ds_read_b64_tr_b16 a[94:95], v215 offset:13312
  s_waitcnt vmcnt(20) lgkmcnt(0)
  s_barrier
  s_add_u32 m0, s61, 49152
  s_add_u32 s54, s62, 1769472
  buffer_load_dwordx4 v208, s[36:39], s54 offen lds
  s_add_u32 m0, s61, 53248
  s_add_u32 s54, s62, 1824768
  buffer_load_dwordx4 v208, s[36:39], s54 offen lds
  s_add_u32 m0, s61, 57344
  s_add_u32 s54, s62, 1880064
  buffer_load_dwordx4 v208, s[36:39], s54 offen lds
  s_add_u32 m0, s61, 61440
  s_add_u32 s54, s62, 1935360
  buffer_load_dwordx4 v208, s[36:39], s54 offen lds
  v_add_u32 v215, 102400, v210
  ds_read_b64_tr_b16 a[224:225], v215 offset:0
  ds_read_b64_tr_b16 a[226:227], v215 offset:1024
  ds_read_b64_tr_b16 a[228:229], v215 offset:4096
  ds_read_b64_tr_b16 a[230:231], v215 offset:5120
  ds_read_b64_tr_b16 a[232:233], v215 offset:8192
  ds_read_b64_tr_b16 a[234:235], v215 offset:9216
  ds_read_b64_tr_b16 a[236:237], v215 offset:12288
  ds_read_b64_tr_b16 a[238:239], v215 offset:13312
  s_waitcnt vmcnt(20) lgkmcnt(0)
  s_barrier
  v_add_u32 v215, 118784, v210
  ds_read_b64_tr_b16 a[96:97], v215 offset:0
  ds_read_b64_tr_b16 a[98:99], v215 offset:1024
  ds_read_b64_tr_b16 a[100:101], v215 offset:4096
  ds_read_b64_tr_b16 a[102:103], v215 offset:5120
  ds_read_b64_tr_b16 a[104:105], v215 offset:8192
  ds_read_b64_tr_b16 a[106:107], v215 offset:9216
  ds_read_b64_tr_b16 a[108:109], v215 offset:12288
  ds_read_b64_tr_b16 a[110:111], v215 offset:13312
  s_waitcnt vmcnt(16) lgkmcnt(0)
  s_barrier
  v_add_u32 v215, 135168, v210
  ds_read_b64_tr_b16 a[240:241], v215 offset:0
  ds_read_b64_tr_b16 a[242:243], v215 offset:1024
  ds_read_b64_tr_b16 a[244:245], v215 offset:4096
  ds_read_b64_tr_b16 a[246:247], v215 offset:5120
  ds_read_b64_tr_b16 a[248:249], v215 offset:8192
  ds_read_b64_tr_b16 a[250:251], v215 offset:9216
  ds_read_b64_tr_b16 a[252:253], v215 offset:12288
  ds_read_b64_tr_b16 a[254:255], v215 offset:13312
  s_waitcnt vmcnt(12) lgkmcnt(0)
  s_barrier
  v_add_u32 v215, 36864, v210
  ds_read_b64_tr_b16 a[112:113], v215 offset:0
  ds_read_b64_tr_b16 a[114:115], v215 offset:1024
  ds_read_b64_tr_b16 a[116:117], v215 offset:4096
  ds_read_b64_tr_b16 a[118:119], v215 offset:5120
  ds_read_b64_tr_b16 a[120:121], v215 offset:8192
  ds_read_b64_tr_b16 a[122:123], v215 offset:9216
  ds_read_b64_tr_b16 a[124:125], v215 offset:12288
  ds_read_b64_tr_b16 a[126:127], v215 offset:13312
  s_waitcnt vmcnt(8) lgkmcnt(0)
  s_barrier
  v_add_u32 v215, 53248, v210
  ds_read_b64_tr_b16 v[224:225], v215 offset:0
  ds_read_b64_tr_b16 v[226:227], v215 offset:1024
  ds_read_b64_tr_b16 v[228:229], v215 offset:4096
  ds_read_b64_tr_b16 v[230:231], v215 offset:5120
  ds_read_b64_tr_b16 v[232:233], v215 offset:8192
  ds_read_b64_tr_b16 v[234:235], v215 offset:9216
  ds_read_b64_tr_b16 v[236:237], v215 offset:12288
  ds_read_b64_tr_b16 v[238:239], v215 offset:13312
  s_waitcnt vmcnt(4) lgkmcnt(0)
  s_barrier
  v_add_u32 v215, 69632, v210
  ds_read_b64_tr_b16 a[128:129], v215 offset:0
  ds_read_b64_tr_b16 a[130:131], v215 offset:1024
  ds_read_b64_tr_b16 a[132:133], v215 offset:4096
  ds_read_b64_tr_b16 a[134:135], v215 offset:5120
  ds_read_b64_tr_b16 a[136:137], v215 offset:8192
  ds_read_b64_tr_b16 a[138:139], v215 offset:9216
  ds_read_b64_tr_b16 a[140:141], v215 offset:12288
  ds_read_b64_tr_b16 a[142:143], v215 offset:13312
  s_waitcnt vmcnt(0) lgkmcnt(0)
  s_barrier
  v_add_u32 v215, 86016, v210
  ds_read_b64_tr_b16 v[240:241], v215 offset:0
  ds_read_b64_tr_b16 v[242:243], v215 offset:1024
  ds_read_b64_tr_b16 v[244:245], v215 offset:4096
  ds_read_b64_tr_b16 v[246:247], v215 offset:5120
  ds_read_b64_tr_b16 v[248:249], v215 offset:8192
  ds_read_b64_tr_b16 v[250:251], v215 offset:9216
  ds_read_b64_tr_b16 v[252:253], v215 offset:12288
  ds_read_b64_tr_b16 v[254:255], v215 offset:13312
  s_waitcnt lgkmcnt(0)
  s_barrier
  v_and_b32 v211, 31, v200
  v_mul_u32_u24 v218, 516, v211
  v_lshrrev_b32 v212, 5, v200
  v_lshl_add_u32 v218, v212, 3, v218
  s_lshl_b32 s54, s52, 6
  s_add_u32 s54, s54, 73728
  v_add_u32 v218, s54, v218
  s_lshl_b32 s60, s69, 2
  s_mul_i32 s60, s60, 36864
  ds_read_b128 v[32:35], v203 offset:0
  ds_read_b128 v[36:39], v204 offset:0
  ds_read_b128 v[40:43], v205 offset:0
  s_waitcnt lgkmcnt(2)
  v_mfma_f32_32x32x16_bf16 v[0:15], a[0:3], v[32:35], 0
  ds_read_b128 v[44:47], v206 offset:0
  s_add_u32 m0, s67, 36864
  s_nop 0
  buffer_load_dwordx4 v202, s[4:7], s60 offen offset:0 lds
  v_mfma_f32_32x32x16_bf16 v[16:31], a[144:147], v[32:35], 0
  s_waitcnt lgkmcnt(2)
  v_mfma_f32_32x32x16_bf16 v[0:15], a[4:7], v[36:39], v[0:15]
  ds_read_b128 v[32:35], v203 offset:1024
  s_add_u32 m0, s67, 37760
  s_nop 0
  buffer_load_dwordx4 v202, s[4:7], s60 offen offset:128 lds
  v_mfma_f32_32x32x16_bf16 v[16:31], a[148:151], v[36:39], v[16:31]
  s_waitcnt lgkmcnt(2)
  v_mfma_f32_32x32x16_bf16 v[0:15], a[8:11], v[40:43], v[0:15]
  ds_read_b128 v[36:39], v204 offset:1024
  s_add_u32 m0, s67, 38656
  s_nop 0
  buffer_load_dwordx4 v202, s[4:7], s60 offen offset:256 lds
  v_mfma_f32_32x32x16_bf16 v[16:31], a[152:155], v[40:43], v[16:31]
  s_waitcnt lgkmcnt(2)
  v_mfma_f32_32x32x16_bf16 v[0:15], a[12:15], v[44:47], v[0:15]
  ds_read_b128 v[40:43], v205 offset:1024
  s_add_u32 m0, s67, 39552
  s_nop 0
  buffer_load_dwordx4 v202, s[4:7], s60 offen offset:384 lds
  v_mfma_f32_32x32x16_bf16 v[16:31], a[156:159], v[44:47], v[16:31]
  s_waitcnt lgkmcnt(2)
  v_mfma_f32_32x32x16_bf16 v[0:15], a[16:19], v[32:35], v[0:15]
  ds_read_b128 v[44:47], v206 offset:1024
  s_add_u32 m0, s67, 40448
  s_nop 0
  buffer_load_dwordx4 v202, s[4:7], s60 offen offset:512 lds
  v_mfma_f32_32x32x16_bf16 v[16:31], a[160:163], v[32:35], v[16:31]
  s_waitcnt lgkmcnt(2)
  v_mfma_f32_32x32x16_bf16 v[0:15], a[20:23], v[36:39], v[0:15]
  ds_read_b128 v[32:35], v203 offset:2048
  s_add_u32 m0, s67, 41344
  s_nop 0
  buffer_load_dwordx4 v202, s[4:7], s60 offen offset:640 lds
  v_mfma_f32_32x32x16_bf16 v[16:31], a[164:167], v[36:39], v[16:31]
  s_waitcnt lgkmcnt(2)
  v_mfma_f32_32x32x16_bf16 v[0:15], a[24:27], v[40:43], v[0:15]
  ds_read_b128 v[36:39], v204 offset:2048
  s_add_u32 m0, s67, 42240
  s_nop 0
  buffer_load_dwordx4 v202, s[4:7], s60 offen offset:768 lds
  v_mfma_f32_32x32x16_bf16 v[16:31], a[168:171], v[40:43], v[16:31]
  s_waitcnt lgkmcnt(2)
  v_mfma_f32_32x32x16_bf16 v[0:15], a[28:31], v[44:47], v[0:15]
  ds_read_b128 v[40:43], v205 offset:2048
  s_add_u32 m0, s67, 43136
  s_nop 0
  buffer_load_dwordx4 v202, s[4:7], s60 offen offset:896 lds
  v_mfma_f32_32x32x16_bf16 v[16:31], a[172:175], v[44:47], v[16:31]
  s_waitcnt lgkmcnt(2)
  v_mfma_f32_32x32x16_bf16 v[0:15], a[32:35], v[32:35], v[0:15]
  ds_read_b128 v[44:47], v206 offset:2048
  s_add_u32 m0, s67, 44032
  s_nop 0
  buffer_load_dwordx4 v202, s[4:7], s60 offen offset:1024 lds
  v_mfma_f32_32x32x16_bf16 v[16:31], a[176:179], v[32:35], v[16:31]
  s_waitcnt lgkmcnt(2)
  v_mfma_f32_32x32x16_bf16 v[0:15], a[36:39], v[36:39], v[0:15]
  ds_read_b128 v[32:35], v203 offset:3072
  v_mfma_f32_32x32x16_bf16 v[16:31], a[180:183], v[36:39], v[16:31]
  s_waitcnt lgkmcnt(2)
  v_mfma_f32_32x32x16_bf16 v[0:15], a[40:43], v[40:43], v[0:15]
  ds_read_b128 v[36:39], v204 offset:3072
  v_mfma_f32_32x32x16_bf16 v[16:31], a[184:187], v[40:43], v[16:31]
  s_waitcnt lgkmcnt(2)
  v_mfma_f32_32x32x16_bf16 v[0:15], a[44:47], v[44:47], v[0:15]
  ds_read_b128 v[40:43], v205 offset:3072
  v_mfma_f32_32x32x16_bf16 v[16:31], a[188:191], v[44:47], v[16:31]
  s_waitcnt lgkmcnt(2)
  v_mfma_f32_32x32x16_bf16 v[0:15], a[48:51], v[32:35], v[0:15]
  ds_read_b128 v[44:47], v206 offset:3072
  v_mfma_f32_32x32x16_bf16 v[16:31], a[192:195], v[32:35], v[16:31]
  s_waitcnt lgkmcnt(2)
  v_mfma_f32_32x32x16_bf16 v[0:15], a[52:55], v[36:39], v[0:15]
  ds_read_b128 v[32:35], v203 offset:4096
  v_mfma_f32_32x32x16_bf16 v[16:31], a[196:199], v[36:39], v[16:31]
  s_waitcnt lgkmcnt(2)
  v_mfma_f32_32x32x16_bf16 v[0:15], a[56:59], v[40:43], v[0:15]
  ds_read_b128 v[36:39], v204 offset:4096
  v_mfma_f32_32x32x16_bf16 v[16:31], a[200:203], v[40:43], v[16:31]
  s_waitcnt lgkmcnt(2)
  v_mfma_f32_32x32x16_bf16 v[0:15], a[60:63], v[44:47], v[0:15]
  ds_read_b128 v[40:43], v205 offset:4096
  v_mfma_f32_32x32x16_bf16 v[16:31], a[204:207], v[44:47], v[16:31]
  s_waitcnt lgkmcnt(2)
  v_mfma_f32_32x32x16_bf16 v[0:15], a[64:67], v[32:35], v[0:15]
  ds_read_b128 v[44:47], v206 offset:4096
  v_mfma_f32_32x32x16_bf16 v[16:31], a[208:211], v[32:35], v[16:31]
  s_waitcnt lgkmcnt(2)
  v_mfma_f32_32x32x16_bf16 v[0:15], a[68:71], v[36:39], v[0:15]
  ds_read_b128 v[32:35], v203 offset:5120
  v_mfma_f32_32x32x16_bf16 v[16:31], a[212:215], v[36:39], v[16:31]
  s_waitcnt lgkmcnt(2)
  v_mfma_f32_32x32x16_bf16 v[0:15], a[72:75], v[40:43], v[0:15]
  ds_read_b128 v[36:39], v204 offset:5120
  v_mfma_f32_32x32x16_bf16 v[16:31], a[216:219], v[40:43], v[16:31]
  s_waitcnt lgkmcnt(2)
  v_mfma_f32_32x32x16_bf16 v[0:15], a[76:79], v[44:47], v[0:15]
  ds_read_b128 v[40:43], v205 offset:5120
  v_mfma_f32_32x32x16_bf16 v[16:31], a[220:223], v[44:47], v[16:31]
  s_waitcnt lgkmcnt(2)
  v_mfma_f32_32x32x16_bf16 v[0:15], a[80:83], v[32:35], v[0:15]
  ds_read_b128 v[44:47], v206 offset:5120
  v_mfma_f32_32x32x16_bf16 v[16:31], a[224:227], v[32:35], v[16:31]
  s_waitcnt lgkmcnt(2)
  v_mfma_f32_32x32x16_bf16 v[0:15], a[84:87], v[36:39], v[0:15]
  ds_read_b128 v[32:35], v203 offset:6144
  v_mfma_f32_32x32x16_bf16 v[16:31], a[228:231], v[36:39], v[16:31]
  s_waitcnt lgkmcnt(2)
  v_mfma_f32_32x32x16_bf16 v[0:15], a[88:91], v[40:43], v[0:15]
  ds_read_b128 v[36:39], v204 offset:6144
  v_mfma_f32_32x32x16_bf16 v[16:31], a[232:235], v[40:43], v[16:31]
  s_waitcnt lgkmcnt(2)
  v_mfma_f32_32x32x16_bf16 v[0:15], a[92:95], v[44:47], v[0:15]
  ds_read_b128 v[40:43], v205 offset:6144
  v_mfma_f32_32x32x16_bf16 v[16:31], a[236:239], v[44:47], v[16:31]
  s_waitcnt lgkmcnt(2)
  v_mfma_f32_32x32x16_bf16 v[0:15], a[96:99], v[32:35], v[0:15]
  ds_read_b128 v[44:47], v206 offset:6144
  v_mfma_f32_32x32x16_bf16 v[16:31], a[240:243], v[32:35], v[16:31]
  s_waitcnt lgkmcnt(2)
  v_mfma_f32_32x32x16_bf16 v[0:15], a[100:103], v[36:39], v[0:15]
  ds_read_b128 v[32:35], v203 offset:7168
  v_mfma_f32_32x32x16_bf16 v[16:31], a[244:247], v[36:39], v[16:31]
  s_waitcnt lgkmcnt(2)
  v_mfma_f32_32x32x16_bf16 v[0:15], a[104:107], v[40:43], v[0:15]
  ds_read_b128 v[36:39], v204 offset:7168
  v_mfma_f32_32x32x16_bf16 v[16:31], a[248:251], v[40:43], v[16:31]
  s_waitcnt lgkmcnt(2)
  v_mfma_f32_32x32x16_bf16 v[0:15], a[108:111], v[44:47], v[0:15]
  ds_read_b128 v[40:43], v205 offset:7168
  v_mfma_f32_32x32x16_bf16 v[16:31], a[252:255], v[44:47], v[16:31]
  s_waitcnt lgkmcnt(2)
  v_mfma_f32_32x32x16_bf16 v[0:15], a[112:115], v[32:35], v[0:15]
  ds_read_b128 v[44:47], v206 offset:7168
  v_mfma_f32_32x32x16_bf16 v[16:31], v[224:227], v[32:35], v[16:31]
  s_waitcnt lgkmcnt(2)
  v_mfma_f32_32x32x16_bf16 v[0:15], a[116:119], v[36:39], v[0:15]
  ds_read_b128 v[32:35], v203 offset:8192
  v_mfma_f32_32x32x16_bf16 v[16:31], v[228:231], v[36:39], v[16:31]
  s_waitcnt lgkmcnt(2)
  v_mfma_f32_32x32x16_bf16 v[0:15], a[120:123], v[40:43], v[0:15]
  ds_read_b128 v[36:39], v204 offset:8192
  v_mfma_f32_32x32x16_bf16 v[16:31], v[232:235], v[40:43], v[16:31]
  s_waitcnt lgkmcnt(2)
  v_mfma_f32_32x32x16_bf16 v[0:15], a[124:127], v[44:47], v[0:15]
  ds_read_b128 v[40:43], v205 offset:8192
  v_mfma_f32_32x32x16_bf16 v[16:31], v[236:239], v[44:47], v[16:31]
  s_waitcnt lgkmcnt(2)
  v_mfma_f32_32x32x16_bf16 v[0:15], a[128:131], v[32:35], v[0:15]
  ds_read_b128 v[44:47], v206 offset:8192
  v_mfma_f32_32x32x16_bf16 v[16:31], v[240:243], v[32:35], v[16:31]
  s_waitcnt lgkmcnt(2)
  v_mfma_f32_32x32x16_bf16 v[0:15], a[132:135], v[36:39], v[0:15]
  v_mfma_f32_32x32x16_bf16 v[16:31], v[244:247], v[36:39], v[16:31]
  s_waitcnt lgkmcnt(1)
  v_mfma_f32_32x32x16_bf16 v[0:15], a[136:139], v[40:43], v[0:15]
  v_mfma_f32_32x32x16_bf16 v[16:31], v[248:251], v[40:43], v[16:31]
  s_waitcnt lgkmcnt(0)
  v_mfma_f32_32x32x16_bf16 v[0:15], a[140:143], v[44:47], v[0:15]
  v_mfma_f32_32x32x16_bf16 v[16:31], v[252:255], v[44:47], v[16:31]
  s_add_u32 s60, s60, 36864
  s_nop 2
  v_cvt_pk_bf16_f32 v48, v0, v1
  v_cvt_pk_bf16_f32 v49, v2, v3
  ds_write2_b32 v218, v48, v49 offset0:0 offset1:1
  v_cvt_pk_bf16_f32 v48, v4, v5
  v_cvt_pk_bf16_f32 v49, v6, v7
  ds_write2_b32 v218, v48, v49 offset0:4 offset1:5
  v_cvt_pk_bf16_f32 v48, v8, v9
  v_cvt_pk_bf16_f32 v49, v10, v11
  ds_write2_b32 v218, v48, v49 offset0:8 offset1:9
  v_cvt_pk_bf16_f32 v48, v12, v13
  v_cvt_pk_bf16_f32 v49, v14, v15
  ds_write2_b32 v218, v48, v49 offset0:12 offset1:13
  v_cvt_pk_bf16_f32 v48, v16, v17
  v_cvt_pk_bf16_f32 v49, v18, v19
  ds_write2_b32 v218, v48, v49 offset0:64 offset1:65
  v_cvt_pk_bf16_f32 v48, v20, v21
  v_cvt_pk_bf16_f32 v49, v22, v23
  ds_write2_b32 v218, v48, v49 offset0:68 offset1:69
  v_cvt_pk_bf16_f32 v48, v24, v25
  v_cvt_pk_bf16_f32 v49, v26, v27
  ds_write2_b32 v218, v48, v49 offset0:72 offset1:73
  v_cvt_pk_bf16_f32 v48, v28, v29
  v_cvt_pk_bf16_f32 v49, v30, v31
  ds_write2_b32 v218, v48, v49 offset0:76 offset1:77
  v_add_u32 v218, 16512, v218
  s_waitcnt vmcnt(0) lgkmcnt(0)
  s_barrier
  ds_read_b128 v[32:35], v203 offset:36864
  ds_read_b128 v[36:39], v204 offset:36864
  ds_read_b128 v[40:43], v205 offset:36864
  s_waitcnt lgkmcnt(2)
  v_mfma_f32_32x32x16_bf16 v[0:15], a[0:3], v[32:35], 0
  ds_read_b128 v[44:47], v206 offset:36864
  s_add_u32 m0, s67, 0
  s_nop 0
  buffer_load_dwordx4 v202, s[4:7], s60 offen offset:0 lds
  v_mfma_f32_32x32x16_bf16 v[16:31], a[144:147], v[32:35], 0
  s_waitcnt lgkmcnt(2)
  v_mfma_f32_32x32x16_bf16 v[0:15], a[4:7], v[36:39], v[0:15]
  ds_read_b128 v[32:35], v203 offset:37888
  s_add_u32 m0, s67, 896
  s_nop 0
  buffer_load_dwordx4 v202, s[4:7], s60 offen offset:128 lds
  v_mfma_f32_32x32x16_bf16 v[16:31], a[148:151], v[36:39], v[16:31]
  s_waitcnt lgkmcnt(2)
  v_mfma_f32_32x32x16_bf16 v[0:15], a[8:11], v[40:43], v[0:15]
  ds_read_b128 v[36:39], v204 offset:37888
  s_add_u32 m0, s67, 1792
  s_nop 0
  buffer_load_dwordx4 v202, s[4:7], s60 offen offset:256 lds
  v_mfma_f32_32x32x16_bf16 v[16:31], a[152:155], v[40:43], v[16:31]
  s_waitcnt lgkmcnt(2)
  v_mfma_f32_32x32x16_bf16 v[0:15], a[12:15], v[44:47], v[0:15]
  ds_read_b128 v[40:43], v205 offset:37888
  s_add_u32 m0, s67, 2688
  s_nop 0
  buffer_load_dwordx4 v202, s[4:7], s60 offen offset:384 lds
  v_mfma_f32_32x32x16_bf16 v[16:31], a[156:159], v[44:47], v[16:31]
  s_waitcnt lgkmcnt(2)
  v_mfma_f32_32x32x16_bf16 v[0:15], a[16:19], v[32:35], v[0:15]
  ds_read_b128 v[44:47], v206 offset:37888
  s_add_u32 m0, s67, 3584
  s_nop 0
  buffer_load_dwordx4 v202, s[4:7], s60 offen offset:512 lds
  v_mfma_f32_32x32x16_bf16 v[16:31], a[160:163], v[32:35], v[16:31]
  s_waitcnt lgkmcnt(2)
  v_mfma_f32_32x32x16_bf16 v[0:15], a[20:23], v[36:39], v[0:15]
  ds_read_b128 v[32:35], v203 offset:38912
  s_add_u32 m0, s67, 4480
  s_nop 0
  buffer_load_dwordx4 v202, s[4:7], s60 offen offset:640 lds
  v_mfma_f32_32x32x16_bf16 v[16:31], a[164:167], v[36:39], v[16:31]
  s_waitcnt lgkmcnt(2)
  v_mfma_f32_32x32x16_bf16 v[0:15], a[24:27], v[40:43], v[0:15]
  ds_read_b128 v[36:39], v204 offset:38912
  s_add_u32 m0, s67, 5376
  s_nop 0
  buffer_load_dwordx4 v202, s[4:7], s60 offen offset:768 lds
  v_mfma_f32_32x32x16_bf16 v[16:31], a[168:171], v[40:43], v[16:31]
  s_waitcnt lgkmcnt(2)
  v_mfma_f32_32x32x16_bf16 v[0:15], a[28:31], v[44:47], v[0:15]
  ds_read_b128 v[40:43], v205 offset:38912
  s_add_u32 m0, s67, 6272
  s_nop 0
  buffer_load_dwordx4 v202, s[4:7], s60 offen offset:896 lds
  v_mfma_f32_32x32x16_bf16 v[16:31], a[172:175], v[44:47], v[16:31]
  s_waitcnt lgkmcnt(2)
  v_mfma_f32_32x32x16_bf16 v[0:15], a[32:35], v[32:35], v[0:15]
  ds_read_b128 v[44:47], v206 offset:38912
  s_add_u32 m0, s67, 7168
  s_nop 0
  buffer_load_dwordx4 v202, s[4:7], s60 offen offset:1024 lds
  v_mfma_f32_32x32x16_bf16 v[16:31], a[176:179], v[32:35], v[16:31]
  s_waitcnt lgkmcnt(2)
  v_mfma_f32_32x32x16_bf16 v[0:15], a[36:39], v[36:39], v[0:15]
  ds_read_b128 v[32:35], v203 offset:39936
  v_mfma_f32_32x32x16_bf16 v[16:31], a[180:183], v[36:39], v[16:31]
  s_waitcnt lgkmcnt(2)
  v_mfma_f32_32x32x16_bf16 v[0:15], a[40:43], v[40:43], v[0:15]
  ds_read_b128 v[36:39], v204 offset:39936
  v_mfma_f32_32x32x16_bf16 v[16:31], a[184:187], v[40:43], v[16:31]
  s_waitcnt lgkmcnt(2)
  v_mfma_f32_32x32x16_bf16 v[0:15], a[44:47], v[44:47], v[0:15]
  ds_read_b128 v[40:43], v205 offset:39936
  v_mfma_f32_32x32x16_bf16 v[16:31], a[188:191], v[44:47], v[16:31]
  s_waitcnt lgkmcnt(2)
  v_mfma_f32_32x32x16_bf16 v[0:15], a[48:51], v[32:35], v[0:15]
  ds_read_b128 v[44:47], v206 offset:39936
  v_mfma_f32_32x32x16_bf16 v[16:31], a[192:195], v[32:35], v[16:31]
  s_waitcnt lgkmcnt(2)
  v_mfma_f32_32x32x16_bf16 v[0:15], a[52:55], v[36:39], v[0:15]
  ds_read_b128 v[32:35], v203 offset:40960
  v_mfma_f32_32x32x16_bf16 v[16:31], a[196:199], v[36:39], v[16:31]
  s_waitcnt lgkmcnt(2)
  v_mfma_f32_32x32x16_bf16 v[0:15], a[56:59], v[40:43], v[0:15]
  ds_read_b128 v[36:39], v204 offset:40960
  v_mfma_f32_32x32x16_bf16 v[16:31], a[200:203], v[40:43], v[16:31]
  s_waitcnt lgkmcnt(2)
  v_mfma_f32_32x32x16_bf16 v[0:15], a[60:63], v[44:47], v[0:15]
  ds_read_b128 v[40:43], v205 offset:40960
  v_mfma_f32_32x32x16_bf16 v[16:31], a[204:207], v[44:47], v[16:31]
  s_waitcnt lgkmcnt(2)
  v_mfma_f32_32x32x16_bf16 v[0:15], a[64:67], v[32:35], v[0:15]
  ds_read_b128 v[44:47], v206 offset:40960
  v_mfma_f32_32x32x16_bf16 v[16:31], a[208:211], v[32:35], v[16:31]
  s_waitcnt lgkmcnt(2)
  v_mfma_f32_32x32x16_bf16 v[0:15], a[68:71], v[36:39], v[0:15]
  ds_read_b128 v[32:35], v203 offset:41984
  v_mfma_f32_32x32x16_bf16 v[16:31], a[212:215], v[36:39], v[16:31]
  s_waitcnt lgkmcnt(2)
  v_mfma_f32_32x32x16_bf16 v[0:15], a[72:75], v[40:43], v[0:15]
  ds_read_b128 v[36:39], v204 offset:41984
  v_mfma_f32_32x32x16_bf16 v[16:31], a[216:219], v[40:43], v[16:31]
  s_waitcnt lgkmcnt(2)
  v_mfma_f32_32x32x16_bf16 v[0:15], a[76:79], v[44:47], v[0:15]
  ds_read_b128 v[40:43], v205 offset:41984
  v_mfma_f32_32x32x16_bf16 v[16:31], a[220:223], v[44:47], v[16:31]
  s_waitcnt lgkmcnt(2)
  v_mfma_f32_32x32x16_bf16 v[0:15], a[80:83], v[32:35], v[0:15]
  ds_read_b128 v[44:47], v206 offset:41984
  v_mfma_f32_32x32x16_bf16 v[16:31], a[224:227], v[32:35], v[16:31]
  s_waitcnt lgkmcnt(2)
  v_mfma_f32_32x32x16_bf16 v[0:15], a[84:87], v[36:39], v[0:15]
  ds_read_b128 v[32:35], v203 offset:43008
  v_mfma_f32_32x32x16_bf16 v[16:31], a[228:231], v[36:39], v[16:31]
  s_waitcnt lgkmcnt(2)
  v_mfma_f32_32x32x16_bf16 v[0:15], a[88:91], v[40:43], v[0:15]
  ds_read_b128 v[36:39], v204 offset:43008
  v_mfma_f32_32x32x16_bf16 v[16:31], a[232:235], v[40:43], v[16:31]
  s_waitcnt lgkmcnt(2)
  v_mfma_f32_32x32x16_bf16 v[0:15], a[92:95], v[44:47], v[0:15]
  ds_read_b128 v[40:43], v205 offset:43008
  v_mfma_f32_32x32x16_bf16 v[16:31], a[236:239], v[44:47], v[16:31]
  s_waitcnt lgkmcnt(2)
  v_mfma_f32_32x32x16_bf16 v[0:15], a[96:99], v[32:35], v[0:15]
  ds_read_b128 v[44:47], v206 offset:43008
  v_mfma_f32_32x32x16_bf16 v[16:31], a[240:243], v[32:35], v[16:31]
  s_waitcnt lgkmcnt(2)
  v_mfma_f32_32x32x16_bf16 v[0:15], a[100:103], v[36:39], v[0:15]
  ds_read_b128 v[32:35], v203 offset:44032
  v_mfma_f32_32x32x16_bf16 v[16:31], a[244:247], v[36:39], v[16:31]
  s_waitcnt lgkmcnt(2)
  v_mfma_f32_32x32x16_bf16 v[0:15], a[104:107], v[40:43], v[0:15]
  ds_read_b128 v[36:39], v204 offset:44032
  v_mfma_f32_32x32x16_bf16 v[16:31], a[248:251], v[40:43], v[16:31]
  s_waitcnt lgkmcnt(2)
  v_mfma_f32_32x32x16_bf16 v[0:15], a[108:111], v[44:47], v[0:15]
  ds_read_b128 v[40:43], v205 offset:44032
  v_mfma_f32_32x32x16_bf16 v[16:31], a[252:255], v[44:47], v[16:31]
  s_waitcnt lgkmcnt(2)
  v_mfma_f32_32x32x16_bf16 v[0:15], a[112:115], v[32:35], v[0:15]
  ds_read_b128 v[44:47], v206 offset:44032
  v_mfma_f32_32x32x16_bf16 v[16:31], v[224:227], v[32:35], v[16:31]
  s_waitcnt lgkmcnt(2)
  v_mfma_f32_32x32x16_bf16 v[0:15], a[116:119], v[36:39], v[0:15]
  ds_read_b128 v[32:35], v203 offset:45056
  v_mfma_f32_32x32x16_bf16 v[16:31], v[228:231], v[36:39], v[16:31]
  s_waitcnt lgkmcnt(2)
  v_mfma_f32_32x32x16_bf16 v[0:15], a[120:123], v[40:43], v[0:15]
  ds_read_b128 v[36:39], v204 offset:45056
  v_mfma_f32_32x32x16_bf16 v[16:31], v[232:235], v[40:43], v[16:31]
  s_waitcnt lgkmcnt(2)
  v_mfma_f32_32x32x16_bf16 v[0:15], a[124:127], v[44:47], v[0:15]
  ds_read_b128 v[40:43], v205 offset:45056
  v_mfma_f32_32x32x16_bf16 v[16:31], v[236:239], v[44:47], v[16:31]
  s_waitcnt lgkmcnt(2)
  v_mfma_f32_32x32x16_bf16 v[0:15], a[128:131], v[32:35], v[0:15]
  ds_read_b128 v[44:47], v206 offset:45056
  v_mfma_f32_32x32x16_bf16 v[16:31], v[240:243], v[32:35], v[16:31]
  s_waitcnt lgkmcnt(2)
  v_mfma_f32_32x32x16_bf16 v[0:15], a[132:135], v[36:39], v[0:15]
  v_mfma_f32_32x32x16_bf16 v[16:31], v[244:247], v[36:39], v[16:31]
  s_waitcnt lgkmcnt(1)
  v_mfma_f32_32x32x16_bf16 v[0:15], a[136:139], v[40:43], v[0:15]
  v_mfma_f32_32x32x16_bf16 v[16:31], v[248:251], v[40:43], v[16:31]
  s_waitcnt lgkmcnt(0)
  v_mfma_f32_32x32x16_bf16 v[0:15], a[140:143], v[44:47], v[0:15]
  v_mfma_f32_32x32x16_bf16 v[16:31], v[252:255], v[44:47], v[16:31]
  s_add_u32 s60, s60, 36864
  s_nop 2
  v_cvt_pk_bf16_f32 v48, v0, v1
  v_cvt_pk_bf16_f32 v49, v2, v3
  ds_write2_b32 v218, v48, v49 offset0:0 offset1:1
  v_cvt_pk_bf16_f32 v48, v4, v5
  v_cvt_pk_bf16_f32 v49, v6, v7
  ds_write2_b32 v218, v48, v49 offset0:4 offset1:5
  v_cvt_pk_bf16_f32 v48, v8, v9
  v_cvt_pk_bf16_f32 v49, v10, v11
  ds_write2_b32 v218, v48, v49 offset0:8 offset1:9
  v_cvt_pk_bf16_f32 v48, v12, v13
  v_cvt_pk_bf16_f32 v49, v14, v15
  ds_write2_b32 v218, v48, v49 offset0:12 offset1:13
  v_cvt_pk_bf16_f32 v48, v16, v17
  v_cvt_pk_bf16_f32 v49, v18, v19
  ds_write2_b32 v218, v48, v49 offset0:64 offset1:65
  v_cvt_pk_bf16_f32 v48, v20, v21
  v_cvt_pk_bf16_f32 v49, v22, v23
  ds_write2_b32 v218, v48, v49 offset0:68 offset1:69
  v_cvt_pk_bf16_f32 v48, v24, v25
  v_cvt_pk_bf16_f32 v49, v26, v27
  ds_write2_b32 v218, v48, v49 offset0:72 offset1:73
  v_cvt_pk_bf16_f32 v48, v28, v29
  v_cvt_pk_bf16_f32 v49, v30, v31
  ds_write2_b32 v218, v48, v49 offset0:76 offset1:77
  v_add_u32 v218, 16512, v218
  s_waitcnt vmcnt(0) lgkmcnt(0)
  s_barrier
  ds_read_b128 v[32:35], v203 offset:0
  ds_read_b128 v[36:39], v204 offset:0
  ds_read_b128 v[40:43], v205 offset:0
  s_waitcnt lgkmcnt(2)
  v_mfma_f32_32x32x16_bf16 v[0:15], a[0:3], v[32:35], 0
  ds_read_b128 v[44:47], v206 offset:0
  s_add_u32 m0, s67, 36864
  s_nop 0
  buffer_load_dwordx4 v202, s[4:7], s60 offen offset:0 lds
  v_mfma_f32_32x32x16_bf16 v[16:31], a[144:147], v[32:35], 0
  s_waitcnt lgkmcnt(2)
  v_mfma_f32_32x32x16_bf16 v[0:15], a[4:7], v[36:39], v[0:15]
  ds_read_b128 v[32:35], v203 offset:1024
  s_add_u32 m0, s67, 37760
  s_nop 0
  buffer_load_dwordx4 v202, s[4:7], s60 offen offset:128 lds
  v_mfma_f32_32x32x16_bf16 v[16:31], a[148:151], v[36:39], v[16:31]
  s_waitcnt lgkmcnt(2)
  v_mfma_f32_32x32x16_bf16 v[0:15], a[8:11], v[40:43], v[0:15]
  ds_read_b128 v[36:39], v204 offset:1024
  s_add_u32 m0, s67, 38656
  s_nop 0
  buffer_load_dwordx4 v202, s[4:7], s60 offen offset:256 lds
  v_mfma_f32_32x32x16_bf16 v[16:31], a[152:155], v[40:43], v[16:31]
  s_waitcnt lgkmcnt(2)
  v_mfma_f32_32x32x16_bf16 v[0:15], a[12:15], v[44:47], v[0:15]
  ds_read_b128 v[40:43], v205 offset:1024
  s_add_u32 m0, s67, 39552
  s_nop 0
  buffer_load_dwordx4 v202, s[4:7], s60 offen offset:384 lds
  v_mfma_f32_32x32x16_bf16 v[16:31], a[156:159], v[44:47], v[16:31]
  s_waitcnt lgkmcnt(2)
  v_mfma_f32_32x32x16_bf16 v[0:15], a[16:19], v[32:35], v[0:15]
  ds_read_b128 v[44:47], v206 offset:1024
  s_add_u32 m0, s67, 40448
  s_nop 0
  buffer_load_dwordx4 v202, s[4:7], s60 offen offset:512 lds
  v_mfma_f32_32x32x16_bf16 v[16:31], a[160:163], v[32:35], v[16:31]
  s_waitcnt lgkmcnt(2)
  v_mfma_f32_32x32x16_bf16 v[0:15], a[20:23], v[36:39], v[0:15]
  ds_read_b128 v[32:35], v203 offset:2048
  s_add_u32 m0, s67, 41344
  s_nop 0
  buffer_load_dwordx4 v202, s[4:7], s60 offen offset:640 lds
  v_mfma_f32_32x32x16_bf16 v[16:31], a[164:167], v[36:39], v[16:31]
  s_waitcnt lgkmcnt(2)
  v_mfma_f32_32x32x16_bf16 v[0:15], a[24:27], v[40:43], v[0:15]
  ds_read_b128 v[36:39], v204 offset:2048
  s_add_u32 m0, s67, 42240
  s_nop 0
  buffer_load_dwordx4 v202, s[4:7], s60 offen offset:768 lds
  v_mfma_f32_32x32x16_bf16 v[16:31], a[168:171], v[40:43], v[16:31]
  s_waitcnt lgkmcnt(2)
  v_mfma_f32_32x32x16_bf16 v[0:15], a[28:31], v[44:47], v[0:15]
  ds_read_b128 v[40:43], v205 offset:2048
  s_add_u32 m0, s67, 43136
  s_nop 0
  buffer_load_dwordx4 v202, s[4:7], s60 offen offset:896 lds
  v_mfma_f32_32x32x16_bf16 v[16:31], a[172:175], v[44:47], v[16:31]
  s_waitcnt lgkmcnt(2)
  v_mfma_f32_32x32x16_bf16 v[0:15], a[32:35], v[32:35], v[0:15]
  ds_read_b128 v[44:47], v206 offset:2048
  s_add_u32 m0, s67, 44032
  s_nop 0
  buffer_load_dwordx4 v202, s[4:7], s60 offen offset:1024 lds
  v_mfma_f32_32x32x16_bf16 v[16:31], a[176:179], v[32:35], v[16:31]
  s_waitcnt lgkmcnt(2)
  v_mfma_f32_32x32x16_bf16 v[0:15], a[36:39], v[36:39], v[0:15]
  ds_read_b128 v[32:35], v203 offset:3072
  v_mfma_f32_32x32x16_bf16 v[16:31], a[180:183], v[36:39], v[16:31]
  s_waitcnt lgkmcnt(2)
  v_mfma_f32_32x32x16_bf16 v[0:15], a[40:43], v[40:43], v[0:15]
  ds_read_b128 v[36:39], v204 offset:3072
  v_mfma_f32_32x32x16_bf16 v[16:31], a[184:187], v[40:43], v[16:31]
  s_waitcnt lgkmcnt(2)
  v_mfma_f32_32x32x16_bf16 v[0:15], a[44:47], v[44:47], v[0:15]
  ds_read_b128 v[40:43], v205 offset:3072
  v_mfma_f32_32x32x16_bf16 v[16:31], a[188:191], v[44:47], v[16:31]
  s_waitcnt lgkmcnt(2)
  v_mfma_f32_32x32x16_bf16 v[0:15], a[48:51], v[32:35], v[0:15]
  ds_read_b128 v[44:47], v206 offset:3072
  v_mfma_f32_32x32x16_bf16 v[16:31], a[192:195], v[32:35], v[16:31]
  s_waitcnt lgkmcnt(2)
  v_mfma_f32_32x32x16_bf16 v[0:15], a[52:55], v[36:39], v[0:15]
  ds_read_b128 v[32:35], v203 offset:4096
  v_mfma_f32_32x32x16_bf16 v[16:31], a[196:199], v[36:39], v[16:31]
  s_waitcnt lgkmcnt(2)
  v_mfma_f32_32x32x16_bf16 v[0:15], a[56:59], v[40:43], v[0:15]
  ds_read_b128 v[36:39], v204 offset:4096
  v_mfma_f32_32x32x16_bf16 v[16:31], a[200:203], v[40:43], v[16:31]
  s_waitcnt lgkmcnt(2)
  v_mfma_f32_32x32x16_bf16 v[0:15], a[60:63], v[44:47], v[0:15]
  ds_read_b128 v[40:43], v205 offset:4096
  v_mfma_f32_32x32x16_bf16 v[16:31], a[204:207], v[44:47], v[16:31]
  s_waitcnt lgkmcnt(2)
  v_mfma_f32_32x32x16_bf16 v[0:15], a[64:67], v[32:35], v[0:15]
  ds_read_b128 v[44:47], v206 offset:4096
  v_mfma_f32_32x32x16_bf16 v[16:31], a[208:211], v[32:35], v[16:31]
  s_waitcnt lgkmcnt(2)
  v_mfma_f32_32x32x16_bf16 v[0:15], a[68:71], v[36:39], v[0:15]
  ds_read_b128 v[32:35], v203 offset:5120
  v_mfma_f32_32x32x16_bf16 v[16:31], a[212:215], v[36:39], v[16:31]
  s_waitcnt lgkmcnt(2)
  v_mfma_f32_32x32x16_bf16 v[0:15], a[72:75], v[40:43], v[0:15]
  ds_read_b128 v[36:39], v204 offset:5120
  v_mfma_f32_32x32x16_bf16 v[16:31], a[216:219], v[40:43], v[16:31]
  s_waitcnt lgkmcnt(2)
  v_mfma_f32_32x32x16_bf16 v[0:15], a[76:79], v[44:47], v[0:15]
  ds_read_b128 v[40:43], v205 offset:5120
  v_mfma_f32_32x32x16_bf16 v[16:31], a[220:223], v[44:47], v[16:31]
  s_waitcnt lgkmcnt(2)
  v_mfma_f32_32x32x16_bf16 v[0:15], a[80:83], v[32:35], v[0:15]
  ds_read_b128 v[44:47], v206 offset:5120
  v_mfma_f32_32x32x16_bf16 v[16:31], a[224:227], v[32:35], v[16:31]
  s_waitcnt lgkmcnt(2)
  v_mfma_f32_32x32x16_bf16 v[0:15], a[84:87], v[36:39], v[0:15]
  ds_read_b128 v[32:35], v203 offset:6144
  v_mfma_f32_32x32x16_bf16 v[16:31], a[228:231], v[36:39], v[16:31]
  s_waitcnt lgkmcnt(2)
  v_mfma_f32_32x32x16_bf16 v[0:15], a[88:91], v[40:43], v[0:15]
  ds_read_b128 v[36:39], v204 offset:6144
  v_mfma_f32_32x32x16_bf16 v[16:31], a[232:235], v[40:43], v[16:31]
  s_waitcnt lgkmcnt(2)
  v_mfma_f32_32x32x16_bf16 v[0:15], a[92:95], v[44:47], v[0:15]
  ds_read_b128 v[40:43], v205 offset:6144
  v_mfma_f32_32x32x16_bf16 v[16:31], a[236:239], v[44:47], v[16:31]
  s_waitcnt lgkmcnt(2)
  v_mfma_f32_32x32x16_bf16 v[0:15], a[96:99], v[32:35], v[0:15]
  ds_read_b128 v[44:47], v206 offset:6144
  v_mfma_f32_32x32x16_bf16 v[16:31], a[240:243], v[32:35], v[16:31]
  s_waitcnt lgkmcnt(2)
  v_mfma_f32_32x32x16_bf16 v[0:15], a[100:103], v[36:39], v[0:15]
  ds_read_b128 v[32:35], v203 offset:7168
  v_mfma_f32_32x32x16_bf16 v[16:31], a[244:247], v[36:39], v[16:31]
  s_waitcnt lgkmcnt(2)
  v_mfma_f32_32x32x16_bf16 v[0:15], a[104:107], v[40:43], v[0:15]
  ds_read_b128 v[36:39], v204 offset:7168
  v_mfma_f32_32x32x16_bf16 v[16:31], a[248:251], v[40:43], v[16:31]
  s_waitcnt lgkmcnt(2)
  v_mfma_f32_32x32x16_bf16 v[0:15], a[108:111], v[44:47], v[0:15]
  ds_read_b128 v[40:43], v205 offset:7168
  v_mfma_f32_32x32x16_bf16 v[16:31], a[252:255], v[44:47], v[16:31]
  s_waitcnt lgkmcnt(2)
  v_mfma_f32_32x32x16_bf16 v[0:15], a[112:115], v[32:35], v[0:15]
  ds_read_b128 v[44:47], v206 offset:7168
  v_mfma_f32_32x32x16_bf16 v[16:31], v[224:227], v[32:35], v[16:31]
  s_waitcnt lgkmcnt(2)
  v_mfma_f32_32x32x16_bf16 v[0:15], a[116:119], v[36:39], v[0:15]
  ds_read_b128 v[32:35], v203 offset:8192
  v_mfma_f32_32x32x16_bf16 v[16:31], v[228:231], v[36:39], v[16:31]
  s_waitcnt lgkmcnt(2)
  v_mfma_f32_32x32x16_bf16 v[0:15], a[120:123], v[40:43], v[0:15]
  ds_read_b128 v[36:39], v204 offset:8192
  v_mfma_f32_32x32x16_bf16 v[16:31], v[232:235], v[40:43], v[16:31]
  s_waitcnt lgkmcnt(2)
  v_mfma_f32_32x32x16_bf16 v[0:15], a[124:127], v[44:47], v[0:15]
  ds_read_b128 v[40:43], v205 offset:8192
  v_mfma_f32_32x32x16_bf16 v[16:31], v[236:239], v[44:47], v[16:31]
  s_waitcnt lgkmcnt(2)
  v_mfma_f32_32x32x16_bf16 v[0:15], a[128:131], v[32:35], v[0:15]
  ds_read_b128 v[44:47], v206 offset:8192
  v_mfma_f32_32x32x16_bf16 v[16:31], v[240:243], v[32:35], v[16:31]
  s_waitcnt lgkmcnt(2)
  v_mfma_f32_32x32x16_bf16 v[0:15], a[132:135], v[36:39], v[0:15]
  v_mfma_f32_32x32x16_bf16 v[16:31], v[244:247], v[36:39], v[16:31]
  s_waitcnt lgkmcnt(1)
  v_mfma_f32_32x32x16_bf16 v[0:15], a[136:139], v[40:43], v[0:15]
  v_mfma_f32_32x32x16_bf16 v[16:31], v[248:251], v[40:43], v[16:31]
  s_waitcnt lgkmcnt(0)
  v_mfma_f32_32x32x16_bf16 v[0:15], a[140:143], v[44:47], v[0:15]
  v_mfma_f32_32x32x16_bf16 v[16:31], v[252:255], v[44:47], v[16:31]
  s_add_u32 s60, s60, 36864
  s_nop 2
  v_cvt_pk_bf16_f32 v48, v0, v1
  v_cvt_pk_bf16_f32 v49, v2, v3
  ds_write2_b32 v218, v48, v49 offset0:0 offset1:1
  v_cvt_pk_bf16_f32 v48, v4, v5
  v_cvt_pk_bf16_f32 v49, v6, v7
  ds_write2_b32 v218, v48, v49 offset0:4 offset1:5
  v_cvt_pk_bf16_f32 v48, v8, v9
  v_cvt_pk_bf16_f32 v49, v10, v11
  ds_write2_b32 v218, v48, v49 offset0:8 offset1:9
  v_cvt_pk_bf16_f32 v48, v12, v13
  v_cvt_pk_bf16_f32 v49, v14, v15
  ds_write2_b32 v218, v48, v49 offset0:12 offset1:13
  v_cvt_pk_bf16_f32 v48, v16, v17
  v_cvt_pk_bf16_f32 v49, v18, v19
  ds_write2_b32 v218, v48, v49 offset0:64 offset1:65
  v_cvt_pk_bf16_f32 v48, v20, v21
  v_cvt_pk_bf16_f32 v49, v22, v23
  ds_write2_b32 v218, v48, v49 offset0:68 offset1:69
  v_cvt_pk_bf16_f32 v48, v24, v25
  v_cvt_pk_bf16_f32 v49, v26, v27
  ds_write2_b32 v218, v48, v49 offset0:72 offset1:73
  v_cvt_pk_bf16_f32 v48, v28, v29
  v_cvt_pk_bf16_f32 v49, v30, v31
  ds_write2_b32 v218, v48, v49 offset0:76 offset1:77
  v_add_u32 v218, 16512, v218
  s_waitcnt vmcnt(0) lgkmcnt(0)
  s_barrier
  ds_read_b128 v[32:35], v203 offset:36864
  ds_read_b128 v[36:39], v204 offset:36864
  ds_read_b128 v[40:43], v205 offset:36864
  s_waitcnt lgkmcnt(2)
  v_mfma_f32_32x32x16_bf16 v[0:15], a[0:3], v[32:35], 0
  ds_read_b128 v[44:47], v206 offset:36864
  s_add_u32 m0, s67, 0
  s_nop 0
  buffer_load_dwordx4 v202, s[4:7], s60 offen offset:0 lds
  v_mfma_f32_32x32x16_bf16 v[16:31], a[144:147], v[32:35], 0
  s_waitcnt lgkmcnt(2)
  v_mfma_f32_32x32x16_bf16 v[0:15], a[4:7], v[36:39], v[0:15]
  ds_read_b128 v[32:35], v203 offset:37888
  s_add_u32 m0, s67, 896
  s_nop 0
  buffer_load_dwordx4 v202, s[4:7], s60 offen offset:128 lds
  v_mfma_f32_32x32x16_bf16 v[16:31], a[148:151], v[36:39], v[16:31]
  s_waitcnt lgkmcnt(2)
  v_mfma_f32_32x32x16_bf16 v[0:15], a[8:11], v[40:43], v[0:15]
  ds_read_b128 v[36:39], v204 offset:37888
  s_add_u32 m0, s67, 1792
  s_nop 0
  buffer_load_dwordx4 v202, s[4:7], s60 offen offset:256 lds
  v_mfma_f32_32x32x16_bf16 v[16:31], a[152:155], v[40:43], v[16:31]
  s_waitcnt lgkmcnt(2)
  v_mfma_f32_32x32x16_bf16 v[0:15], a[12:15], v[44:47], v[0:15]
  ds_read_b128 v[40:43], v205 offset:37888
  s_add_u32 m0, s67, 2688
  s_nop 0
  buffer_load_dwordx4 v202, s[4:7], s60 offen offset:384 lds
  v_mfma_f32_32x32x16_bf16 v[16:31], a[156:159], v[44:47], v[16:31]
  s_waitcnt lgkmcnt(2)
  v_mfma_f32_32x32x16_bf16 v[0:15], a[16:19], v[32:35], v[0:15]
  ds_read_b128 v[44:47], v206 offset:37888
  s_add_u32 m0, s67, 3584
  s_nop 0
  buffer_load_dwordx4 v202, s[4:7], s60 offen offset:512 lds
  v_mfma_f32_32x32x16_bf16 v[16:31], a[160:163], v[32:35], v[16:31]
  s_waitcnt lgkmcnt(2)
  v_mfma_f32_32x32x16_bf16 v[0:15], a[20:23], v[36:39], v[0:15]
  ds_read_b128 v[32:35], v203 offset:38912
  s_add_u32 m0, s67, 4480
  s_nop 0
  buffer_load_dwordx4 v202, s[4:7], s60 offen offset:640 lds
  v_mfma_f32_32x32x16_bf16 v[16:31], a[164:167], v[36:39], v[16:31]
  s_waitcnt lgkmcnt(2)
  v_mfma_f32_32x32x16_bf16 v[0:15], a[24:27], v[40:43], v[0:15]
  ds_read_b128 v[36:39], v204 offset:38912
  s_add_u32 m0, s67, 5376
  s_nop 0
  buffer_load_dwordx4 v202, s[4:7], s60 offen offset:768 lds
  v_mfma_f32_32x32x16_bf16 v[16:31], a[168:171], v[40:43], v[16:31]
  s_waitcnt lgkmcnt(2)
  v_mfma_f32_32x32x16_bf16 v[0:15], a[28:31], v[44:47], v[0:15]
  ds_read_b128 v[40:43], v205 offset:38912
  s_add_u32 m0, s67, 6272
  s_nop 0
  buffer_load_dwordx4 v202, s[4:7], s60 offen offset:896 lds
  v_mfma_f32_32x32x16_bf16 v[16:31], a[172:175], v[44:47], v[16:31]
  s_waitcnt lgkmcnt(2)
  v_mfma_f32_32x32x16_bf16 v[0:15], a[32:35], v[32:35], v[0:15]
  ds_read_b128 v[44:47], v206 offset:38912
  s_add_u32 m0, s67, 7168
  s_nop 0
  buffer_load_dwordx4 v202, s[4:7], s60 offen offset:1024 lds
  v_mfma_f32_32x32x16_bf16 v[16:31], a[176:179], v[32:35], v[16:31]
  s_waitcnt lgkmcnt(2)
  v_mfma_f32_32x32x16_bf16 v[0:15], a[36:39], v[36:39], v[0:15]
  ds_read_b128 v[32:35], v203 offset:39936
  v_mfma_f32_32x32x16_bf16 v[16:31], a[180:183], v[36:39], v[16:31]
  s_waitcnt lgkmcnt(2)
  v_mfma_f32_32x32x16_bf16 v[0:15], a[40:43], v[40:43], v[0:15]
  ds_read_b128 v[36:39], v204 offset:39936
  v_mfma_f32_32x32x16_bf16 v[16:31], a[184:187], v[40:43], v[16:31]
  s_waitcnt lgkmcnt(2)
  v_mfma_f32_32x32x16_bf16 v[0:15], a[44:47], v[44:47], v[0:15]
  ds_read_b128 v[40:43], v205 offset:39936
  v_mfma_f32_32x32x16_bf16 v[16:31], a[188:191], v[44:47], v[16:31]
  s_waitcnt lgkmcnt(2)
  v_mfma_f32_32x32x16_bf16 v[0:15], a[48:51], v[32:35], v[0:15]
  ds_read_b128 v[44:47], v206 offset:39936
  v_mfma_f32_32x32x16_bf16 v[16:31], a[192:195], v[32:35], v[16:31]
  s_waitcnt lgkmcnt(2)
  v_mfma_f32_32x32x16_bf16 v[0:15], a[52:55], v[36:39], v[0:15]
  ds_read_b128 v[32:35], v203 offset:40960
  v_mfma_f32_32x32x16_bf16 v[16:31], a[196:199], v[36:39], v[16:31]
  s_waitcnt lgkmcnt(2)
  v_mfma_f32_32x32x16_bf16 v[0:15], a[56:59], v[40:43], v[0:15]
  ds_read_b128 v[36:39], v204 offset:40960
  v_mfma_f32_32x32x16_bf16 v[16:31], a[200:203], v[40:43], v[16:31]
  s_waitcnt lgkmcnt(2)
  v_mfma_f32_32x32x16_bf16 v[0:15], a[60:63], v[44:47], v[0:15]
  ds_read_b128 v[40:43], v205 offset:40960
  v_mfma_f32_32x32x16_bf16 v[16:31], a[204:207], v[44:47], v[16:31]
  s_waitcnt lgkmcnt(2)
  v_mfma_f32_32x32x16_bf16 v[0:15], a[64:67], v[32:35], v[0:15]
  ds_read_b128 v[44:47], v206 offset:40960
  v_mfma_f32_32x32x16_bf16 v[16:31], a[208:211], v[32:35], v[16:31]
  s_waitcnt lgkmcnt(2)
  v_mfma_f32_32x32x16_bf16 v[0:15], a[68:71], v[36:39], v[0:15]
  ds_read_b128 v[32:35], v203 offset:41984
  v_mfma_f32_32x32x16_bf16 v[16:31], a[212:215], v[36:39], v[16:31]
  s_waitcnt lgkmcnt(2)
  v_mfma_f32_32x32x16_bf16 v[0:15], a[72:75], v[40:43], v[0:15]
  ds_read_b128 v[36:39], v204 offset:41984
  v_mfma_f32_32x32x16_bf16 v[16:31], a[216:219], v[40:43], v[16:31]
  s_waitcnt lgkmcnt(2)
  v_mfma_f32_32x32x16_bf16 v[0:15], a[76:79], v[44:47], v[0:15]
  ds_read_b128 v[40:43], v205 offset:41984
  v_mfma_f32_32x32x16_bf16 v[16:31], a[220:223], v[44:47], v[16:31]
  s_waitcnt lgkmcnt(2)
  v_mfma_f32_32x32x16_bf16 v[0:15], a[80:83], v[32:35], v[0:15]
  ds_read_b128 v[44:47], v206 offset:41984
  v_mfma_f32_32x32x16_bf16 v[16:31], a[224:227], v[32:35], v[16:31]
  s_waitcnt lgkmcnt(2)
  v_mfma_f32_32x32x16_bf16 v[0:15], a[84:87], v[36:39], v[0:15]
  ds_read_b128 v[32:35], v203 offset:43008
  v_mfma_f32_32x32x16_bf16 v[16:31], a[228:231], v[36:39], v[16:31]
  s_waitcnt lgkmcnt(2)
  v_mfma_f32_32x32x16_bf16 v[0:15], a[88:91], v[40:43], v[0:15]
  ds_read_b128 v[36:39], v204 offset:43008
  v_mfma_f32_32x32x16_bf16 v[16:31], a[232:235], v[40:43], v[16:31]
  s_waitcnt lgkmcnt(2)
  v_mfma_f32_32x32x16_bf16 v[0:15], a[92:95], v[44:47], v[0:15]
  ds_read_b128 v[40:43], v205 offset:43008
  v_mfma_f32_32x32x16_bf16 v[16:31], a[236:239], v[44:47], v[16:31]
  s_waitcnt lgkmcnt(2)
  v_mfma_f32_32x32x16_bf16 v[0:15], a[96:99], v[32:35], v[0:15]
  ds_read_b128 v[44:47], v206 offset:43008
  v_mfma_f32_32x32x16_bf16 v[16:31], a[240:243], v[32:35], v[16:31]
  s_waitcnt lgkmcnt(2)
  v_mfma_f32_32x32x16_bf16 v[0:15], a[100:103], v[36:39], v[0:15]
  ds_read_b128 v[32:35], v203 offset:44032
  v_mfma_f32_32x32x16_bf16 v[16:31], a[244:247], v[36:39], v[16:31]
  s_waitcnt lgkmcnt(2)
  v_mfma_f32_32x32x16_bf16 v[0:15], a[104:107], v[40:43], v[0:15]
  ds_read_b128 v[36:39], v204 offset:44032
  v_mfma_f32_32x32x16_bf16 v[16:31], a[248:251], v[40:43], v[16:31]
  s_waitcnt lgkmcnt(2)
  v_mfma_f32_32x32x16_bf16 v[0:15], a[108:111], v[44:47], v[0:15]
  ds_read_b128 v[40:43], v205 offset:44032
  v_mfma_f32_32x32x16_bf16 v[16:31], a[252:255], v[44:47], v[16:31]
  s_waitcnt lgkmcnt(2)
  v_mfma_f32_32x32x16_bf16 v[0:15], a[112:115], v[32:35], v[0:15]
  ds_read_b128 v[44:47], v206 offset:44032
  v_mfma_f32_32x32x16_bf16 v[16:31], v[224:227], v[32:35], v[16:31]
  s_waitcnt lgkmcnt(2)
  v_mfma_f32_32x32x16_bf16 v[0:15], a[116:119], v[36:39], v[0:15]
  ds_read_b128 v[32:35], v203 offset:45056
  v_mfma_f32_32x32x16_bf16 v[16:31], v[228:231], v[36:39], v[16:31]
  s_waitcnt lgkmcnt(2)
  v_mfma_f32_32x32x16_bf16 v[0:15], a[120:123], v[40:43], v[0:15]
  ds_read_b128 v[36:39], v204 offset:45056
  v_mfma_f32_32x32x16_bf16 v[16:31], v[232:235], v[40:43], v[16:31]
  s_waitcnt lgkmcnt(2)
  v_mfma_f32_32x32x16_bf16 v[0:15], a[124:127], v[44:47], v[0:15]
  ds_read_b128 v[40:43], v205 offset:45056
  v_mfma_f32_32x32x16_bf16 v[16:31], v[236:239], v[44:47], v[16:31]
  s_waitcnt lgkmcnt(2)
  v_mfma_f32_32x32x16_bf16 v[0:15], a[128:131], v[32:35], v[0:15]
  ds_read_b128 v[44:47], v206 offset:45056
  v_mfma_f32_32x32x16_bf16 v[16:31], v[240:243], v[32:35], v[16:31]
  s_waitcnt lgkmcnt(2)
  v_mfma_f32_32x32x16_bf16 v[0:15], a[132:135], v[36:39], v[0:15]
  v_mfma_f32_32x32x16_bf16 v[16:31], v[244:247], v[36:39], v[16:31]
  s_waitcnt lgkmcnt(1)
  v_mfma_f32_32x32x16_bf16 v[0:15], a[136:139], v[40:43], v[0:15]
  v_mfma_f32_32x32x16_bf16 v[16:31], v[248:251], v[40:43], v[16:31]
  s_waitcnt lgkmcnt(0)
  v_mfma_f32_32x32x16_bf16 v[0:15], a[140:143], v[44:47], v[0:15]
  v_mfma_f32_32x32x16_bf16 v[16:31], v[252:255], v[44:47], v[16:31]
  s_add_u32 s60, s60, 36864
  s_nop 2
  v_cvt_pk_bf16_f32 v48, v0, v1
  v_cvt_pk_bf16_f32 v49, v2, v3
  ds_write2_b32 v218, v48, v49 offset0:0 offset1:1
  v_cvt_pk_bf16_f32 v48, v4, v5
  v_cvt_pk_bf16_f32 v49, v6, v7
  ds_write2_b32 v218, v48, v49 offset0:4 offset1:5
  v_cvt_pk_bf16_f32 v48, v8, v9
  v_cvt_pk_bf16_f32 v49, v10, v11
  ds_write2_b32 v218, v48, v49 offset0:8 offset1:9
  v_cvt_pk_bf16_f32 v48, v12, v13
  v_cvt_pk_bf16_f32 v49, v14, v15
  ds_write2_b32 v218, v48, v49 offset0:12 offset1:13
  v_cvt_pk_bf16_f32 v48, v16, v17
  v_cvt_pk_bf16_f32 v49, v18, v19
  ds_write2_b32 v218, v48, v49 offset0:64 offset1:65
  v_cvt_pk_bf16_f32 v48, v20, v21
  v_cvt_pk_bf16_f32 v49, v22, v23
  ds_write2_b32 v218, v48, v49 offset0:68 offset1:69
  v_cvt_pk_bf16_f32 v48, v24, v25
  v_cvt_pk_bf16_f32 v49, v26, v27
  ds_write2_b32 v218, v48, v49 offset0:72 offset1:73
  v_cvt_pk_bf16_f32 v48, v28, v29
  v_cvt_pk_bf16_f32 v49, v30, v31
  ds_write2_b32 v218, v48, v49 offset0:76 offset1:77
  v_add_u32 v218, 16512, v218
  s_waitcnt vmcnt(0) lgkmcnt(0)
  s_barrier
  ds_read_b128 v[32:35], v203 offset:0
  ds_read_b128 v[36:39], v204 offset:0
  ds_read_b128 v[40:43], v205 offset:0
  s_waitcnt lgkmcnt(2)
  v_mfma_f32_32x32x16_bf16 v[0:15], a[0:3], v[32:35], 0
  ds_read_b128 v[44:47], v206 offset:0
  v_mfma_f32_32x32x16_bf16 v[16:31], a[144:147], v[32:35], 0
  s_waitcnt lgkmcnt(2)
  v_mfma_f32_32x32x16_bf16 v[0:15], a[4:7], v[36:39], v[0:15]
  ds_read_b128 v[32:35], v203 offset:1024
  v_mfma_f32_32x32x16_bf16 v[16:31], a[148:151], v[36:39], v[16:31]
  s_waitcnt lgkmcnt(2)
  v_mfma_f32_32x32x16_bf16 v[0:15], a[8:11], v[40:43], v[0:15]
  ds_read_b128 v[36:39], v204 offset:1024
  v_mfma_f32_32x32x16_bf16 v[16:31], a[152:155], v[40:43], v[16:31]
  s_waitcnt lgkmcnt(2)
  v_mfma_f32_32x32x16_bf16 v[0:15], a[12:15], v[44:47], v[0:15]
  ds_read_b128 v[40:43], v205 offset:1024
  v_mfma_f32_32x32x16_bf16 v[16:31], a[156:159], v[44:47], v[16:31]
  s_waitcnt lgkmcnt(2)
  v_mfma_f32_32x32x16_bf16 v[0:15], a[16:19], v[32:35], v[0:15]
  ds_read_b128 v[44:47], v206 offset:1024
  v_mfma_f32_32x32x16_bf16 v[16:31], a[160:163], v[32:35], v[16:31]
  s_waitcnt lgkmcnt(2)
  v_mfma_f32_32x32x16_bf16 v[0:15], a[20:23], v[36:39], v[0:15]
  ds_read_b128 v[32:35], v203 offset:2048
  v_mfma_f32_32x32x16_bf16 v[16:31], a[164:167], v[36:39], v[16:31]
  s_waitcnt lgkmcnt(2)
  v_mfma_f32_32x32x16_bf16 v[0:15], a[24:27], v[40:43], v[0:15]
  ds_read_b128 v[36:39], v204 offset:2048
  v_mfma_f32_32x32x16_bf16 v[16:31], a[168:171], v[40:43], v[16:31]
  s_waitcnt lgkmcnt(2)
  v_mfma_f32_32x32x16_bf16 v[0:15], a[28:31], v[44:47], v[0:15]
  ds_read_b128 v[40:43], v205 offset:2048
  v_mfma_f32_32x32x16_bf16 v[16:31], a[172:175], v[44:47], v[16:31]
  s_waitcnt lgkmcnt(2)
  v_mfma_f32_32x32x16_bf16 v[0:15], a[32:35], v[32:35], v[0:15]
  ds_read_b128 v[44:47], v206 offset:2048
  v_mfma_f32_32x32x16_bf16 v[16:31], a[176:179], v[32:35], v[16:31]
  s_waitcnt lgkmcnt(2)
  v_mfma_f32_32x32x16_bf16 v[0:15], a[36:39], v[36:39], v[0:15]
  ds_read_b128 v[32:35], v203 offset:3072
  v_mfma_f32_32x32x16_bf16 v[16:31], a[180:183], v[36:39], v[16:31]
  s_waitcnt lgkmcnt(2)
  v_mfma_f32_32x32x16_bf16 v[0:15], a[40:43], v[40:43], v[0:15]
  ds_read_b128 v[36:39], v204 offset:3072
  v_mfma_f32_32x32x16_bf16 v[16:31], a[184:187], v[40:43], v[16:31]
  s_waitcnt lgkmcnt(2)
  v_mfma_f32_32x32x16_bf16 v[0:15], a[44:47], v[44:47], v[0:15]
  ds_read_b128 v[40:43], v205 offset:3072
  v_mfma_f32_32x32x16_bf16 v[16:31], a[188:191], v[44:47], v[16:31]
  s_waitcnt lgkmcnt(2)
  v_mfma_f32_32x32x16_bf16 v[0:15], a[48:51], v[32:35], v[0:15]
  ds_read_b128 v[44:47], v206 offset:3072
  v_mfma_f32_32x32x16_bf16 v[16:31], a[192:195], v[32:35], v[16:31]
  s_waitcnt lgkmcnt(2)
  v_mfma_f32_32x32x16_bf16 v[0:15], a[52:55], v[36:39], v[0:15]
  ds_read_b128 v[32:35], v203 offset:4096
  v_mfma_f32_32x32x16_bf16 v[16:31], a[196:199], v[36:39], v[16:31]
  s_waitcnt lgkmcnt(2)
  v_mfma_f32_32x32x16_bf16 v[0:15], a[56:59], v[40:43], v[0:15]
  ds_read_b128 v[36:39], v204 offset:4096
  v_mfma_f32_32x32x16_bf16 v[16:31], a[200:203], v[40:43], v[16:31]
  s_waitcnt lgkmcnt(2)
  v_mfma_f32_32x32x16_bf16 v[0:15], a[60:63], v[44:47], v[0:15]
  ds_read_b128 v[40:43], v205 offset:4096
  v_mfma_f32_32x32x16_bf16 v[16:31], a[204:207], v[44:47], v[16:31]
  s_waitcnt lgkmcnt(2)
  v_mfma_f32_32x32x16_bf16 v[0:15], a[64:67], v[32:35], v[0:15]
  ds_read_b128 v[44:47], v206 offset:4096
  v_mfma_f32_32x32x16_bf16 v[16:31], a[208:211], v[32:35], v[16:31]
  s_waitcnt lgkmcnt(2)
  v_mfma_f32_32x32x16_bf16 v[0:15], a[68:71], v[36:39], v[0:15]
  ds_read_b128 v[32:35], v203 offset:5120
  v_mfma_f32_32x32x16_bf16 v[16:31], a[212:215], v[36:39], v[16:31]
  s_waitcnt lgkmcnt(2)
  v_mfma_f32_32x32x16_bf16 v[0:15], a[72:75], v[40:43], v[0:15]
  ds_read_b128 v[36:39], v204 offset:5120
  v_mfma_f32_32x32x16_bf16 v[16:31], a[216:219], v[40:43], v[16:31]
  s_waitcnt lgkmcnt(2)
  v_mfma_f32_32x32x16_bf16 v[0:15], a[76:79], v[44:47], v[0:15]
  ds_read_b128 v[40:43], v205 offset:5120
  v_mfma_f32_32x32x16_bf16 v[16:31], a[220:223], v[44:47], v[16:31]
  s_waitcnt lgkmcnt(2)
  v_mfma_f32_32x32x16_bf16 v[0:15], a[80:83], v[32:35], v[0:15]
  ds_read_b128 v[44:47], v206 offset:5120
  v_mfma_f32_32x32x16_bf16 v[16:31], a[224:227], v[32:35], v[16:31]
  s_waitcnt lgkmcnt(2)
  v_mfma_f32_32x32x16_bf16 v[0:15], a[84:87], v[36:39], v[0:15]
  ds_read_b128 v[32:35], v203 offset:6144
  v_mfma_f32_32x32x16_bf16 v[16:31], a[228:231], v[36:39], v[16:31]
  s_waitcnt lgkmcnt(2)
  v_mfma_f32_32x32x16_bf16 v[0:15], a[88:91], v[40:43], v[0:15]
  ds_read_b128 v[36:39], v204 offset:6144
  v_mfma_f32_32x32x16_bf16 v[16:31], a[232:235], v[40:43], v[16:31]
  s_waitcnt lgkmcnt(2)
  v_mfma_f32_32x32x16_bf16 v[0:15], a[92:95], v[44:47], v[0:15]
  ds_read_b128 v[40:43], v205 offset:6144
  v_mfma_f32_32x32x16_bf16 v[16:31], a[236:239], v[44:47], v[16:31]
  s_waitcnt lgkmcnt(2)
  v_mfma_f32_32x32x16_bf16 v[0:15], a[96:99], v[32:35], v[0:15]
  ds_read_b128 v[44:47], v206 offset:6144
  v_mfma_f32_32x32x16_bf16 v[16:31], a[240:243], v[32:35], v[16:31]
  s_waitcnt lgkmcnt(2)
  v_mfma_f32_32x32x16_bf16 v[0:15], a[100:103], v[36:39], v[0:15]
  ds_read_b128 v[32:35], v203 offset:7168
  v_mfma_f32_32x32x16_bf16 v[16:31], a[244:247], v[36:39], v[16:31]
  s_waitcnt lgkmcnt(2)
  v_mfma_f32_32x32x16_bf16 v[0:15], a[104:107], v[40:43], v[0:15]
  ds_read_b128 v[36:39], v204 offset:7168
  v_mfma_f32_32x32x16_bf16 v[16:31], a[248:251], v[40:43], v[16:31]
  s_waitcnt lgkmcnt(2)
  v_mfma_f32_32x32x16_bf16 v[0:15], a[108:111], v[44:47], v[0:15]
  ds_read_b128 v[40:43], v205 offset:7168
  v_mfma_f32_32x32x16_bf16 v[16:31], a[252:255], v[44:47], v[16:31]
  s_waitcnt lgkmcnt(2)
  v_mfma_f32_32x32x16_bf16 v[0:15], a[112:115], v[32:35], v[0:15]
  ds_read_b128 v[44:47], v206 offset:7168
  v_mfma_f32_32x32x16_bf16 v[16:31], v[224:227], v[32:35], v[16:31]
  s_waitcnt lgkmcnt(2)
  v_mfma_f32_32x32x16_bf16 v[0:15], a[116:119], v[36:39], v[0:15]
  ds_read_b128 v[32:35], v203 offset:8192
  v_mfma_f32_32x32x16_bf16 v[16:31], v[228:231], v[36:39], v[16:31]
  s_waitcnt lgkmcnt(2)
  v_mfma_f32_32x32x16_bf16 v[0:15], a[120:123], v[40:43], v[0:15]
  ds_read_b128 v[36:39], v204 offset:8192
  v_mfma_f32_32x32x16_bf16 v[16:31], v[232:235], v[40:43], v[16:31]
  s_waitcnt lgkmcnt(2)
  v_mfma_f32_32x32x16_bf16 v[0:15], a[124:127], v[44:47], v[0:15]
  ds_read_b128 v[40:43], v205 offset:8192
  v_mfma_f32_32x32x16_bf16 v[16:31], v[236:239], v[44:47], v[16:31]
  s_waitcnt lgkmcnt(2)
  v_mfma_f32_32x32x16_bf16 v[0:15], a[128:131], v[32:35], v[0:15]
  ds_read_b128 v[44:47], v206 offset:8192
  v_mfma_f32_32x32x16_bf16 v[16:31], v[240:243], v[32:35], v[16:31]
  s_waitcnt lgkmcnt(2)
  v_mfma_f32_32x32x16_bf16 v[0:15], a[132:135], v[36:39], v[0:15]
  v_mfma_f32_32x32x16_bf16 v[16:31], v[244:247], v[36:39], v[16:31]
  s_waitcnt lgkmcnt(1)
  v_mfma_f32_32x32x16_bf16 v[0:15], a[136:139], v[40:43], v[0:15]
  v_mfma_f32_32x32x16_bf16 v[16:31], v[248:251], v[40:43], v[16:31]
  s_waitcnt lgkmcnt(0)
  v_mfma_f32_32x32x16_bf16 v[0:15], a[140:143], v[44:47], v[0:15]
  v_mfma_f32_32x32x16_bf16 v[16:31], v[252:255], v[44:47], v[16:31]
  s_add_u32 s60, s60, 36864
  s_nop 2
  v_cvt_pk_bf16_f32 v48, v0, v1
  v_cvt_pk_bf16_f32 v49, v2, v3
  ds_write2_b32 v218, v48, v49 offset0:0 offset1:1
  v_cvt_pk_bf16_f32 v48, v4, v5
  v_cvt_pk_bf16_f32 v49, v6, v7
  ds_write2_b32 v218, v48, v49 offset0:4 offset1:5
  v_cvt_pk_bf16_f32 v48, v8, v9
  v_cvt_pk_bf16_f32 v49, v10, v11
  ds_write2_b32 v218, v48, v49 offset0:8 offset1:9
  v_cvt_pk_bf16_f32 v48, v12, v13
  v_cvt_pk_bf16_f32 v49, v14, v15
  ds_write2_b32 v218, v48, v49 offset0:12 offset1:13
  v_cvt_pk_bf16_f32 v48, v16, v17
  v_cvt_pk_bf16_f32 v49, v18, v19
  ds_write2_b32 v218, v48, v49 offset0:64 offset1:65
  v_cvt_pk_bf16_f32 v48, v20, v21
  v_cvt_pk_bf16_f32 v49, v22, v23
  ds_write2_b32 v218, v48, v49 offset0:68 offset1:69
  v_cvt_pk_bf16_f32 v48, v24, v25
  v_cvt_pk_bf16_f32 v49, v26, v27
  ds_write2_b32 v218, v48, v49 offset0:72 offset1:73
  v_cvt_pk_bf16_f32 v48, v28, v29
  v_cvt_pk_bf16_f32 v49, v30, v31
  ds_write2_b32 v218, v48, v49 offset0:76 offset1:77
  v_add_u32 v218, 16512, v218
  s_waitcnt vmcnt(0) lgkmcnt(0)
  s_barrier
  v_mul_u32_u24 v219, 516, v200
  s_mul_i32 s54, s52, 36
  s_add_u32 s55, s54, 83016
  v_add_u32 v219, s55, v219
  v_mul_u32_u24 v220, 1152, v200
  s_mul_i32 s55, s68, 144
  s_add_u32 s54, s54, s55
  s_mul_i32 s55, s69, 147456
  s_add_u32 s64, s54, s55
  s_add_u32 s64, s64, 62914560
  s_lshl_b32 s66, s69, 7
  s_mov_b32 s57, 1051597459
  ds_read_b32 v0, v219 offset:7224
  ds_read_b32 v1, v219 offset:7228
  ds_read_b32 v2, v219 offset:7232
  ds_read_b32 v3, v219 offset:7236
  ds_read_b32 v4, v219 offset:7240
  ds_read_b32 v5, v219 offset:7244
  ds_read_b32 v6, v219 offset:7248
  ds_read_b32 v7, v219 offset:7252
  ds_read_b32 v8, v219 offset:7256
  ds_read_b32 v16, v219 offset:7368
  ds_read_b32 v17, v219 offset:7372
  ds_read_b32 v18, v219 offset:7376
  ds_read_b32 v19, v219 offset:7380
  ds_read_b32 v20, v219 offset:7384
  ds_read_b32 v21, v219 offset:7388
  ds_read_b32 v22, v219 offset:7392
  ds_read_b32 v23, v219 offset:7396
  ds_read_b32 v24, v219 offset:7400
  ds_read_b32 v25, v219 offset:6336
  ds_read_b32 v26, v219 offset:6340
  ds_read_b32 v27, v219 offset:6344
  ds_read_b32 v28, v219 offset:6348
  ds_read_b32 v29, v219 offset:6352
  ds_read_b32 v30, v219 offset:6356
  ds_read_b32 v31, v219 offset:6360
  ds_read_b32 v32, v219 offset:6364
  ds_read_b32 v33, v219 offset:6368
  ds_read_b32 v34, v219 offset:5304
  ds_read_b32 v35, v219 offset:5308
  ds_read_b32 v36, v219 offset:5312
  ds_read_b32 v37, v219 offset:5316
  ds_read_b32 v38, v219 offset:5320
  ds_read_b32 v39, v219 offset:5324
  ds_read_b32 v40, v219 offset:5328
  ds_read_b32 v41, v219 offset:5332
  ds_read_b32 v42, v219 offset:5336
  ds_read_b32 v43, v219 offset:4272
  ds_read_b32 v44, v219 offset:4276
  ds_read_b32 v45, v219 offset:4280
  ds_read_b32 v46, v219 offset:4284
  ds_read_b32 v47, v219 offset:4288
  ds_read_b32 v48, v219 offset:4292
  ds_read_b32 v49, v219 offset:4296
  ds_read_b32 v50, v219 offset:4300
  ds_read_b32 v51, v219 offset:4304
  ds_read_b32 v52, v219 offset:3240
  ds_read_b32 v53, v219 offset:3244
  ds_read_b32 v54, v219 offset:3248
  ds_read_b32 v55, v219 offset:3252
  ds_read_b32 v56, v219 offset:3256
  ds_read_b32 v57, v219 offset:3260
  ds_read_b32 v58, v219 offset:3264
  ds_read_b32 v59, v219 offset:3268
  ds_read_b32 v60, v219 offset:3272
  ds_read_b32 v61, v219 offset:2208
  ds_read_b32 v62, v219 offset:2212
  ds_read_b32 v63, v219 offset:2216
  ds_read_b32 v64, v219 offset:2220
  ds_read_b32 v65, v219 offset:2224
  ds_read_b32 v66, v219 offset:2228
  ds_read_b32 v67, v219 offset:2232
  ds_read_b32 v68, v219 offset:2236
  ds_read_b32 v69, v219 offset:2240
  ds_read_b32 v70, v219 offset:1176
  ds_read_b32 v71, v219 offset:1180
  ds_read_b32 v72, v219 offset:1184
  ds_read_b32 v73, v219 offset:1188
  ds_read_b32 v74, v219 offset:1192
  ds_read_b32 v75, v219 offset:1196
  ds_read_b32 v76, v219 offset:1200
  ds_read_b32 v77, v219 offset:1204
  ds_read_b32 v78, v219 offset:1208
  ds_read_b32 v79, v219 offset:144
  ds_read_b32 v80, v219 offset:148
  ds_read_b32 v81, v219 offset:152
  ds_read_b32 v82, v219 offset:156
  ds_read_b32 v83, v219 offset:160
  ds_read_b32 v84, v219 offset:164
  ds_read_b32 v85, v219 offset:168
  ds_read_b32 v86, v219 offset:172
  ds_read_b32 v87, v219 offset:176
  v_mov_b32 v100, 0
  v_mov_b32 v101, 0
  v_mov_b32 v102, 0
  v_mov_b32 v103, 0
  v_mov_b32 v104, 0
  v_mov_b32 v105, 0
  v_mov_b32 v106, 0
  v_mov_b32 v107, 0
  s_waitcnt lgkmcnt(15)
  v_dot2c_f32_bf16 v100, v0, v16
  v_dot2c_f32_bf16 v101, v0, v25
  v_dot2c_f32_bf16 v102, v0, v34
  v_dot2c_f32_bf16 v103, v0, v43
  v_dot2c_f32_bf16 v104, v0, v52
  v_dot2c_f32_bf16 v105, v0, v61
  v_dot2c_f32_bf16 v106, v0, v70
  s_waitcnt lgkmcnt(8)
  v_dot2c_f32_bf16 v107, v0, v79
  v_dot2c_f32_bf16 v100, v1, v17
  v_dot2c_f32_bf16 v101, v1, v26
  v_dot2c_f32_bf16 v102, v1, v35
  v_dot2c_f32_bf16 v103, v1, v44
  v_dot2c_f32_bf16 v104, v1, v53
  v_dot2c_f32_bf16 v105, v1, v62
  v_dot2c_f32_bf16 v106, v1, v71
  s_waitcnt lgkmcnt(7)
  v_dot2c_f32_bf16 v107, v1, v80
  v_dot2c_f32_bf16 v100, v2, v18
  v_dot2c_f32_bf16 v101, v2, v27
  v_dot2c_f32_bf16 v102, v2, v36
  v_dot2c_f32_bf16 v103, v2, v45
  v_dot2c_f32_bf16 v104, v2, v54
  v_dot2c_f32_bf16 v105, v2, v63
  v_dot2c_f32_bf16 v106, v2, v72
  s_waitcnt lgkmcnt(6)
  v_dot2c_f32_bf16 v107, v2, v81
  v_dot2c_f32_bf16 v100, v3, v19
  v_dot2c_f32_bf16 v101, v3, v28
  v_dot2c_f32_bf16 v102, v3, v37
  v_dot2c_f32_bf16 v103, v3, v46
  v_dot2c_f32_bf16 v104, v3, v55
  v_dot2c_f32_bf16 v105, v3, v64
  v_dot2c_f32_bf16 v106, v3, v73
  s_waitcnt lgkmcnt(5)
  v_dot2c_f32_bf16 v107, v3, v82
  v_dot2c_f32_bf16 v100, v4, v20
  v_dot2c_f32_bf16 v101, v4, v29
  v_dot2c_f32_bf16 v102, v4, v38
  v_dot2c_f32_bf16 v103, v4, v47
  v_dot2c_f32_bf16 v104, v4, v56
  v_dot2c_f32_bf16 v105, v4, v65
  v_dot2c_f32_bf16 v106, v4, v74
  s_waitcnt lgkmcnt(4)
  v_dot2c_f32_bf16 v107, v4, v83
  v_dot2c_f32_bf16 v100, v5, v21
  v_dot2c_f32_bf16 v101, v5, v30
  v_dot2c_f32_bf16 v102, v5, v39
  v_dot2c_f32_bf16 v103, v5, v48
  v_dot2c_f32_bf16 v104, v5, v57
  v_dot2c_f32_bf16 v105, v5, v66
  v_dot2c_f32_bf16 v106, v5, v75
  s_waitcnt lgkmcnt(3)
  v_dot2c_f32_bf16 v107, v5, v84
  v_dot2c_f32_bf16 v100, v6, v22
  v_dot2c_f32_bf16 v101, v6, v31
  v_dot2c_f32_bf16 v102, v6, v40
  v_dot2c_f32_bf16 v103, v6, v49
  v_dot2c_f32_bf16 v104, v6, v58
  v_dot2c_f32_bf16 v105, v6, v67
  v_dot2c_f32_bf16 v106, v6, v76
  s_waitcnt lgkmcnt(2)
  v_dot2c_f32_bf16 v107, v6, v85
  v_dot2c_f32_bf16 v100, v7, v23
  v_dot2c_f32_bf16 v101, v7, v32
  v_dot2c_f32_bf16 v102, v7, v41
  v_dot2c_f32_bf16 v103, v7, v50
  v_dot2c_f32_bf16 v104, v7, v59
  v_dot2c_f32_bf16 v105, v7, v68
  v_dot2c_f32_bf16 v106, v7, v77
  s_waitcnt lgkmcnt(1)
  v_dot2c_f32_bf16 v107, v7, v86
  v_dot2c_f32_bf16 v100, v8, v24
  v_dot2c_f32_bf16 v101, v8, v33
  v_dot2c_f32_bf16 v102, v8, v42
  v_dot2c_f32_bf16 v103, v8, v51
  v_dot2c_f32_bf16 v104, v8, v60
  v_dot2c_f32_bf16 v105, v8, v69
  v_dot2c_f32_bf16 v106, v8, v78
  s_waitcnt lgkmcnt(0)
  v_dot2c_f32_bf16 v107, v8, v87
  ds_read_b32 v16, v219 offset:7512
  ds_read_b32 v17, v219 offset:7516
  ds_read_b32 v18, v219 offset:7520
  ds_read_b32 v19, v219 offset:7524
  ds_read_b32 v20, v219 offset:7528
  ds_read_b32 v21, v219 offset:7532
  ds_read_b32 v22, v219 offset:7536
  ds_read_b32 v23, v219 offset:7540
  ds_read_b32 v24, v219 offset:7544
  ds_read_b32 v25, v219 offset:6480
  ds_read_b32 v26, v219 offset:6484
  ds_read_b32 v27, v219 offset:6488
  ds_read_b32 v28, v219 offset:6492
  ds_read_b32 v29, v219 offset:6496
  ds_read_b32 v30, v219 offset:6500
  ds_read_b32 v31, v219 offset:6504
  ds_read_b32 v32, v219 offset:6508
  ds_read_b32 v33, v219 offset:6512
  ds_read_b32 v34, v219 offset:5448
  ds_read_b32 v35, v219 offset:5452
  ds_read_b32 v36, v219 offset:5456
  ds_read_b32 v37, v219 offset:5460
  ds_read_b32 v38, v219 offset:5464
  ds_read_b32 v39, v219 offset:5468
  ds_read_b32 v40, v219 offset:5472
  ds_read_b32 v41, v219 offset:5476
  ds_read_b32 v42, v219 offset:5480
  ds_read_b32 v43, v219 offset:4416
  ds_read_b32 v44, v219 offset:4420
  ds_read_b32 v45, v219 offset:4424
  ds_read_b32 v46, v219 offset:4428
  ds_read_b32 v47, v219 offset:4432
  ds_read_b32 v48, v219 offset:4436
  ds_read_b32 v49, v219 offset:4440
  ds_read_b32 v50, v219 offset:4444
  ds_read_b32 v51, v219 offset:4448
  ds_read_b32 v52, v219 offset:3384
  ds_read_b32 v53, v219 offset:3388
  ds_read_b32 v54, v219 offset:3392
  ds_read_b32 v55, v219 offset:3396
  ds_read_b32 v56, v219 offset:3400
  ds_read_b32 v57, v219 offset:3404
  ds_read_b32 v58, v219 offset:3408
  ds_read_b32 v59, v219 offset:3412
  ds_read_b32 v60, v219 offset:3416
  ds_read_b32 v61, v219 offset:2352
  ds_read_b32 v62, v219 offset:2356
  ds_read_b32 v63, v219 offset:2360
  ds_read_b32 v64, v219 offset:2364
  ds_read_b32 v65, v219 offset:2368
  ds_read_b32 v66, v219 offset:2372
  ds_read_b32 v67, v219 offset:2376
  ds_read_b32 v68, v219 offset:2380
  ds_read_b32 v69, v219 offset:2384
  ds_read_b32 v70, v219 offset:1320
  ds_read_b32 v71, v219 offset:1324
  ds_read_b32 v72, v219 offset:1328
  ds_read_b32 v73, v219 offset:1332
  ds_read_b32 v74, v219 offset:1336
  ds_read_b32 v75, v219 offset:1340
  ds_read_b32 v76, v219 offset:1344
  ds_read_b32 v77, v219 offset:1348
  ds_read_b32 v78, v219 offset:1352
  ds_read_b32 v79, v219 offset:288
  ds_read_b32 v80, v219 offset:292
  ds_read_b32 v81, v219 offset:296
  ds_read_b32 v82, v219 offset:300
  ds_read_b32 v83, v219 offset:304
  ds_read_b32 v84, v219 offset:308
  ds_read_b32 v85, v219 offset:312
  ds_read_b32 v86, v219 offset:316
  ds_read_b32 v87, v219 offset:320
  v_add_u32 v211, s66, v200
  v_mov_b32 v212, 0xf149f2ca
  v_mul_f32 v100, s57, v100
  v_mul_f32 v101, s57, v101
  v_mul_f32 v102, s57, v102
  v_mul_f32 v103, s57, v103
  v_mul_f32 v104, s57, v104
  v_mul_f32 v105, s57, v105
  v_mul_f32 v106, s57, v106
  v_mul_f32 v107, s57, v107
  v_cmp_gt_u32 vcc, 2, v211
  s_nop 1
  v_cndmask_b32 v101, v101, v212, vcc
  v_cmp_gt_u32 vcc, 4, v211
  s_nop 1
  v_cndmask_b32 v102, v102, v212, vcc
  v_cmp_gt_u32 vcc, 6, v211
  s_nop 1
  v_cndmask_b32 v103, v103, v212, vcc
  v_cmp_gt_u32 vcc, 8, v211
  s_nop 1
  v_cndmask_b32 v104, v104, v212, vcc
  v_cmp_gt_u32 vcc, 10, v211
  s_nop 1
  v_cndmask_b32 v105, v105, v212, vcc
  v_cmp_gt_u32 vcc, 12, v211
  s_nop 1
  v_cndmask_b32 v106, v106, v212, vcc
  v_cmp_gt_u32 vcc, 14, v211
  s_nop 1
  v_cndmask_b32 v107, v107, v212, vcc
  v_max3_f32 v213, v100, v101, v102
  v_max3_f32 v213, v213, v103, v104
  v_max3_f32 v213, v213, v105, v106
  v_max_f32 v213, v213, v107
  v_sub_f32 v100, v100, v213
  v_sub_f32 v101, v101, v213
  v_sub_f32 v102, v102, v213
  v_sub_f32 v103, v103, v213
  v_sub_f32 v104, v104, v213
  v_sub_f32 v105, v105, v213
  v_sub_f32 v106, v106, v213
  v_sub_f32 v107, v107, v213
  v_exp_f32 v100, v100
  v_exp_f32 v101, v101
  v_exp_f32 v102, v102
  v_exp_f32 v103, v103
  v_exp_f32 v104, v104
  v_exp_f32 v105, v105
  v_exp_f32 v106, v106
  v_exp_f32 v107, v107
  v_add_f32 v213, v100, v101
  v_add_f32 v213, v213, v102
  v_add_f32 v213, v213, v103
  v_add_f32 v213, v213, v104
  v_add_f32 v213, v213, v105
  v_add_f32 v213, v213, v106
  v_add_f32 v213, v213, v107
  v_rcp_f32 v213, v213
  v_mov_b32 v214, 0
  v_mul_f32 v100, v213, v100
  v_mul_f32 v101, v213, v101
  v_mul_f32 v102, v213, v102
  v_mul_f32 v103, v213, v103
  v_mul_f32 v104, v213, v104
  v_mul_f32 v105, v213, v105
  v_mul_f32 v106, v213, v106
  v_mul_f32 v107, v213, v107
  v_mov_b32 v112, 0
  v_mov_b32 v113, 0
  v_mov_b32 v114, 0
  v_mov_b32 v115, 0
  v_mov_b32 v116, 0
  v_mov_b32 v117, 0
  v_mov_b32 v118, 0
  v_mov_b32 v119, 0
  v_mov_b32 v120, 0
  v_mov_b32 v121, 0
  v_mov_b32 v122, 0
  v_mov_b32 v123, 0
  v_mov_b32 v124, 0
  v_mov_b32 v125, 0
  v_mov_b32 v126, 0
  v_mov_b32 v127, 0
  v_mov_b32 v128, 0
  v_mov_b32 v129, 0
  v_cvt_pk_bf16_f32 v0, v100, v214
  v_cvt_pk_bf16_f32 v1, v214, v100
  s_waitcnt lgkmcnt(15)
  v_dot2c_f32_bf16 v112, v16, v0
  v_dot2c_f32_bf16 v113, v16, v1
  v_dot2c_f32_bf16 v114, v17, v0
  v_dot2c_f32_bf16 v115, v17, v1
  v_dot2c_f32_bf16 v116, v18, v0
  v_dot2c_f32_bf16 v117, v18, v1
  v_dot2c_f32_bf16 v118, v19, v0
  v_dot2c_f32_bf16 v119, v19, v1
  v_dot2c_f32_bf16 v120, v20, v0
  v_dot2c_f32_bf16 v121, v20, v1
  v_dot2c_f32_bf16 v122, v21, v0
  v_dot2c_f32_bf16 v123, v21, v1
  v_dot2c_f32_bf16 v124, v22, v0
  v_dot2c_f32_bf16 v125, v22, v1
  v_dot2c_f32_bf16 v126, v23, v0
  v_dot2c_f32_bf16 v127, v23, v1
  v_dot2c_f32_bf16 v128, v24, v0
  v_dot2c_f32_bf16 v129, v24, v1
  v_cvt_pk_bf16_f32 v2, v101, v214
  v_cvt_pk_bf16_f32 v3, v214, v101
  v_dot2c_f32_bf16 v112, v25, v2
  v_dot2c_f32_bf16 v113, v25, v3
  v_dot2c_f32_bf16 v114, v26, v2
  v_dot2c_f32_bf16 v115, v26, v3
  v_dot2c_f32_bf16 v116, v27, v2
  v_dot2c_f32_bf16 v117, v27, v3
  v_dot2c_f32_bf16 v118, v28, v2
  v_dot2c_f32_bf16 v119, v28, v3
  v_dot2c_f32_bf16 v120, v29, v2
  v_dot2c_f32_bf16 v121, v29, v3
  v_dot2c_f32_bf16 v122, v30, v2
  v_dot2c_f32_bf16 v123, v30, v3
  v_dot2c_f32_bf16 v124, v31, v2
  v_dot2c_f32_bf16 v125, v31, v3
  v_dot2c_f32_bf16 v126, v32, v2
  v_dot2c_f32_bf16 v127, v32, v3
  v_dot2c_f32_bf16 v128, v33, v2
  v_dot2c_f32_bf16 v129, v33, v3
  v_cvt_pk_bf16_f32 v0, v102, v214
  v_cvt_pk_bf16_f32 v1, v214, v102
  v_dot2c_f32_bf16 v112, v34, v0
  v_dot2c_f32_bf16 v113, v34, v1
  v_dot2c_f32_bf16 v114, v35, v0
  v_dot2c_f32_bf16 v115, v35, v1
  v_dot2c_f32_bf16 v116, v36, v0
  v_dot2c_f32_bf16 v117, v36, v1
  v_dot2c_f32_bf16 v118, v37, v0
  v_dot2c_f32_bf16 v119, v37, v1
  v_dot2c_f32_bf16 v120, v38, v0
  v_dot2c_f32_bf16 v121, v38, v1
  v_dot2c_f32_bf16 v122, v39, v0
  v_dot2c_f32_bf16 v123, v39, v1
  v_dot2c_f32_bf16 v124, v40, v0
  v_dot2c_f32_bf16 v125, v40, v1
  v_dot2c_f32_bf16 v126, v41, v0
  v_dot2c_f32_bf16 v127, v41, v1
  v_dot2c_f32_bf16 v128, v42, v0
  v_dot2c_f32_bf16 v129, v42, v1
  v_cvt_pk_bf16_f32 v2, v103, v214
  v_cvt_pk_bf16_f32 v3, v214, v103
  v_dot2c_f32_bf16 v112, v43, v2
  v_dot2c_f32_bf16 v113, v43, v3
  v_dot2c_f32_bf16 v114, v44, v2
  v_dot2c_f32_bf16 v115, v44, v3
  v_dot2c_f32_bf16 v116, v45, v2
  v_dot2c_f32_bf16 v117, v45, v3
  v_dot2c_f32_bf16 v118, v46, v2
  v_dot2c_f32_bf16 v119, v46, v3
  v_dot2c_f32_bf16 v120, v47, v2
  v_dot2c_f32_bf16 v121, v47, v3
  v_dot2c_f32_bf16 v122, v48, v2
  v_dot2c_f32_bf16 v123, v48, v3
  v_dot2c_f32_bf16 v124, v49, v2
  v_dot2c_f32_bf16 v125, v49, v3
  v_dot2c_f32_bf16 v126, v50, v2
  v_dot2c_f32_bf16 v127, v50, v3
  v_dot2c_f32_bf16 v128, v51, v2
  v_dot2c_f32_bf16 v129, v51, v3
  v_cvt_pk_bf16_f32 v0, v104, v214
  v_cvt_pk_bf16_f32 v1, v214, v104
  v_dot2c_f32_bf16 v112, v52, v0
  v_dot2c_f32_bf16 v113, v52, v1
  v_dot2c_f32_bf16 v114, v53, v0
  v_dot2c_f32_bf16 v115, v53, v1
  v_dot2c_f32_bf16 v116, v54, v0
  v_dot2c_f32_bf16 v117, v54, v1
  v_dot2c_f32_bf16 v118, v55, v0
  v_dot2c_f32_bf16 v119, v55, v1
  v_dot2c_f32_bf16 v120, v56, v0
  v_dot2c_f32_bf16 v121, v56, v1
  v_dot2c_f32_bf16 v122, v57, v0
  v_dot2c_f32_bf16 v123, v57, v1
  v_dot2c_f32_bf16 v124, v58, v0
  v_dot2c_f32_bf16 v125, v58, v1
  v_dot2c_f32_bf16 v126, v59, v0
  v_dot2c_f32_bf16 v127, v59, v1
  v_dot2c_f32_bf16 v128, v60, v0
  v_dot2c_f32_bf16 v129, v60, v1
  v_cvt_pk_bf16_f32 v2, v105, v214
  v_cvt_pk_bf16_f32 v3, v214, v105
  v_dot2c_f32_bf16 v112, v61, v2
  v_dot2c_f32_bf16 v113, v61, v3
  v_dot2c_f32_bf16 v114, v62, v2
  v_dot2c_f32_bf16 v115, v62, v3
  v_dot2c_f32_bf16 v116, v63, v2
  v_dot2c_f32_bf16 v117, v63, v3
  v_dot2c_f32_bf16 v118, v64, v2
  v_dot2c_f32_bf16 v119, v64, v3
  v_dot2c_f32_bf16 v120, v65, v2
  v_dot2c_f32_bf16 v121, v65, v3
  v_dot2c_f32_bf16 v122, v66, v2
  v_dot2c_f32_bf16 v123, v66, v3
  v_dot2c_f32_bf16 v124, v67, v2
  v_dot2c_f32_bf16 v125, v67, v3
  v_dot2c_f32_bf16 v126, v68, v2
  v_dot2c_f32_bf16 v127, v68, v3
  v_dot2c_f32_bf16 v128, v69, v2
  v_dot2c_f32_bf16 v129, v69, v3
  v_cvt_pk_bf16_f32 v0, v106, v214
  v_cvt_pk_bf16_f32 v1, v214, v106
  v_dot2c_f32_bf16 v112, v70, v0
  v_dot2c_f32_bf16 v113, v70, v1
  v_dot2c_f32_bf16 v114, v71, v0
  v_dot2c_f32_bf16 v115, v71, v1
  v_dot2c_f32_bf16 v116, v72, v0
  v_dot2c_f32_bf16 v117, v72, v1
  s_waitcnt lgkmcnt(14)
  v_dot2c_f32_bf16 v118, v73, v0
  v_dot2c_f32_bf16 v119, v73, v1
  s_waitcnt lgkmcnt(13)
  v_dot2c_f32_bf16 v120, v74, v0
  v_dot2c_f32_bf16 v121, v74, v1
  s_waitcnt lgkmcnt(12)
  v_dot2c_f32_bf16 v122, v75, v0
  v_dot2c_f32_bf16 v123, v75, v1
  s_waitcnt lgkmcnt(11)
  v_dot2c_f32_bf16 v124, v76, v0
  v_dot2c_f32_bf16 v125, v76, v1
  s_waitcnt lgkmcnt(10)
  v_dot2c_f32_bf16 v126, v77, v0
  v_dot2c_f32_bf16 v127, v77, v1
  s_waitcnt lgkmcnt(9)
  v_dot2c_f32_bf16 v128, v78, v0
  v_dot2c_f32_bf16 v129, v78, v1
  v_cvt_pk_bf16_f32 v2, v107, v214
  v_cvt_pk_bf16_f32 v3, v214, v107
  s_waitcnt lgkmcnt(8)
  v_dot2c_f32_bf16 v112, v79, v2
  v_dot2c_f32_bf16 v113, v79, v3
  s_waitcnt lgkmcnt(7)
  v_dot2c_f32_bf16 v114, v80, v2
  v_dot2c_f32_bf16 v115, v80, v3
  s_waitcnt lgkmcnt(6)
  v_dot2c_f32_bf16 v116, v81, v2
  v_dot2c_f32_bf16 v117, v81, v3
  s_waitcnt lgkmcnt(5)
  v_dot2c_f32_bf16 v118, v82, v2
  v_dot2c_f32_bf16 v119, v82, v3
  s_waitcnt lgkmcnt(4)
  v_dot2c_f32_bf16 v120, v83, v2
  v_dot2c_f32_bf16 v121, v83, v3
  s_waitcnt lgkmcnt(3)
  v_dot2c_f32_bf16 v122, v84, v2
  v_dot2c_f32_bf16 v123, v84, v3
  s_waitcnt lgkmcnt(2)
  v_dot2c_f32_bf16 v124, v85, v2
  v_dot2c_f32_bf16 v125, v85, v3
  s_waitcnt lgkmcnt(1)
  v_dot2c_f32_bf16 v126, v86, v2
  v_dot2c_f32_bf16 v127, v86, v3
  s_waitcnt lgkmcnt(0)
  v_dot2c_f32_bf16 v128, v87, v2
  v_dot2c_f32_bf16 v129, v87, v3
  v_cvt_pk_bf16_f32 v132, v112, v113
  v_cvt_pk_bf16_f32 v133, v114, v115
  v_cvt_pk_bf16_f32 v134, v116, v117
  v_cvt_pk_bf16_f32 v135, v118, v119
  v_cvt_pk_bf16_f32 v136, v120, v121
  v_cvt_pk_bf16_f32 v137, v122, v123
  v_cvt_pk_bf16_f32 v138, v124, v125
  v_cvt_pk_bf16_f32 v139, v126, v127
  v_cvt_pk_bf16_f32 v140, v128, v129
  buffer_store_dwordx4 v[132:135], v220, s[8:11], s64 offen sc1
  buffer_store_dwordx4 v[136:139], v220, s[8:11], s64 offen offset:16 sc1
  buffer_store_dword v140, v220, s[8:11], s64 offen offset:32 sc1
  v_add_u32 v219, 33024, v219
  s_add_u32 s66, s66, 64
  s_add_u32 s64, s64, 73728
  ds_read_b32 v0, v219 offset:7224
  ds_read_b32 v1, v219 offset:7228
  ds_read_b32 v2, v219 offset:7232
  ds_read_b32 v3, v219 offset:7236
  ds_read_b32 v4, v219 offset:7240
  ds_read_b32 v5, v219 offset:7244
  ds_read_b32 v6, v219 offset:7248
  ds_read_b32 v7, v219 offset:7252
  ds_read_b32 v8, v219 offset:7256
  ds_read_b32 v16, v219 offset:7368
  ds_read_b32 v17, v219 offset:7372
  ds_read_b32 v18, v219 offset:7376
  ds_read_b32 v19, v219 offset:7380
  ds_read_b32 v20, v219 offset:7384
  ds_read_b32 v21, v219 offset:7388
  ds_read_b32 v22, v219 offset:7392
  ds_read_b32 v23, v219 offset:7396
  ds_read_b32 v24, v219 offset:7400
  ds_read_b32 v25, v219 offset:6336
  ds_read_b32 v26, v219 offset:6340
  ds_read_b32 v27, v219 offset:6344
  ds_read_b32 v28, v219 offset:6348
  ds_read_b32 v29, v219 offset:6352
  ds_read_b32 v30, v219 offset:6356
  ds_read_b32 v31, v219 offset:6360
  ds_read_b32 v32, v219 offset:6364
  ds_read_b32 v33, v219 offset:6368
  ds_read_b32 v34, v219 offset:5304
  ds_read_b32 v35, v219 offset:5308
  ds_read_b32 v36, v219 offset:5312
  ds_read_b32 v37, v219 offset:5316
  ds_read_b32 v38, v219 offset:5320
  ds_read_b32 v39, v219 offset:5324
  ds_read_b32 v40, v219 offset:5328
  ds_read_b32 v41, v219 offset:5332
  ds_read_b32 v42, v219 offset:5336
  ds_read_b32 v43, v219 offset:4272
  ds_read_b32 v44, v219 offset:4276
  ds_read_b32 v45, v219 offset:4280
  ds_read_b32 v46, v219 offset:4284
  ds_read_b32 v47, v219 offset:4288
  ds_read_b32 v48, v219 offset:4292
  ds_read_b32 v49, v219 offset:4296
  ds_read_b32 v50, v219 offset:4300
  ds_read_b32 v51, v219 offset:4304
  ds_read_b32 v52, v219 offset:3240
  ds_read_b32 v53, v219 offset:3244
  ds_read_b32 v54, v219 offset:3248
  ds_read_b32 v55, v219 offset:3252
  ds_read_b32 v56, v219 offset:3256
  ds_read_b32 v57, v219 offset:3260
  ds_read_b32 v58, v219 offset:3264
  ds_read_b32 v59, v219 offset:3268
  ds_read_b32 v60, v219 offset:3272
  ds_read_b32 v61, v219 offset:2208
  ds_read_b32 v62, v219 offset:2212
  ds_read_b32 v63, v219 offset:2216
  ds_read_b32 v64, v219 offset:2220
  ds_read_b32 v65, v219 offset:2224
  ds_read_b32 v66, v219 offset:2228
  ds_read_b32 v67, v219 offset:2232
  ds_read_b32 v68, v219 offset:2236
  ds_read_b32 v69, v219 offset:2240
  ds_read_b32 v70, v219 offset:1176
  ds_read_b32 v71, v219 offset:1180
  ds_read_b32 v72, v219 offset:1184
  ds_read_b32 v73, v219 offset:1188
  ds_read_b32 v74, v219 offset:1192
  ds_read_b32 v75, v219 offset:1196
  ds_read_b32 v76, v219 offset:1200
  ds_read_b32 v77, v219 offset:1204
  ds_read_b32 v78, v219 offset:1208
  ds_read_b32 v79, v219 offset:144
  ds_read_b32 v80, v219 offset:148
  ds_read_b32 v81, v219 offset:152
  ds_read_b32 v82, v219 offset:156
  ds_read_b32 v83, v219 offset:160
  ds_read_b32 v84, v219 offset:164
  ds_read_b32 v85, v219 offset:168
  ds_read_b32 v86, v219 offset:172
  ds_read_b32 v87, v219 offset:176
  v_mov_b32 v100, 0
  v_mov_b32 v101, 0
  v_mov_b32 v102, 0
  v_mov_b32 v103, 0
  v_mov_b32 v104, 0
  v_mov_b32 v105, 0
  v_mov_b32 v106, 0
  v_mov_b32 v107, 0
  s_waitcnt lgkmcnt(15)
  v_dot2c_f32_bf16 v100, v0, v16
  v_dot2c_f32_bf16 v101, v0, v25
  v_dot2c_f32_bf16 v102, v0, v34
  v_dot2c_f32_bf16 v103, v0, v43
  v_dot2c_f32_bf16 v104, v0, v52
  v_dot2c_f32_bf16 v105, v0, v61
  v_dot2c_f32_bf16 v106, v0, v70
  s_waitcnt lgkmcnt(8)
  v_dot2c_f32_bf16 v107, v0, v79
  v_dot2c_f32_bf16 v100, v1, v17
  v_dot2c_f32_bf16 v101, v1, v26
  v_dot2c_f32_bf16 v102, v1, v35
  v_dot2c_f32_bf16 v103, v1, v44
  v_dot2c_f32_bf16 v104, v1, v53
  v_dot2c_f32_bf16 v105, v1, v62
  v_dot2c_f32_bf16 v106, v1, v71
  s_waitcnt lgkmcnt(7)
  v_dot2c_f32_bf16 v107, v1, v80
  v_dot2c_f32_bf16 v100, v2, v18
  v_dot2c_f32_bf16 v101, v2, v27
  v_dot2c_f32_bf16 v102, v2, v36
  v_dot2c_f32_bf16 v103, v2, v45
  v_dot2c_f32_bf16 v104, v2, v54
  v_dot2c_f32_bf16 v105, v2, v63
  v_dot2c_f32_bf16 v106, v2, v72
  s_waitcnt lgkmcnt(6)
  v_dot2c_f32_bf16 v107, v2, v81
  v_dot2c_f32_bf16 v100, v3, v19
  v_dot2c_f32_bf16 v101, v3, v28
  v_dot2c_f32_bf16 v102, v3, v37
  v_dot2c_f32_bf16 v103, v3, v46
  v_dot2c_f32_bf16 v104, v3, v55
  v_dot2c_f32_bf16 v105, v3, v64
  v_dot2c_f32_bf16 v106, v3, v73
  s_waitcnt lgkmcnt(5)
  v_dot2c_f32_bf16 v107, v3, v82
  v_dot2c_f32_bf16 v100, v4, v20
  v_dot2c_f32_bf16 v101, v4, v29
  v_dot2c_f32_bf16 v102, v4, v38
  v_dot2c_f32_bf16 v103, v4, v47
  v_dot2c_f32_bf16 v104, v4, v56
  v_dot2c_f32_bf16 v105, v4, v65
  v_dot2c_f32_bf16 v106, v4, v74
  s_waitcnt lgkmcnt(4)
  v_dot2c_f32_bf16 v107, v4, v83
  v_dot2c_f32_bf16 v100, v5, v21
  v_dot2c_f32_bf16 v101, v5, v30
  v_dot2c_f32_bf16 v102, v5, v39
  v_dot2c_f32_bf16 v103, v5, v48
  v_dot2c_f32_bf16 v104, v5, v57
  v_dot2c_f32_bf16 v105, v5, v66
  v_dot2c_f32_bf16 v106, v5, v75
  s_waitcnt lgkmcnt(3)
  v_dot2c_f32_bf16 v107, v5, v84
  v_dot2c_f32_bf16 v100, v6, v22
  v_dot2c_f32_bf16 v101, v6, v31
  v_dot2c_f32_bf16 v102, v6, v40
  v_dot2c_f32_bf16 v103, v6, v49
  v_dot2c_f32_bf16 v104, v6, v58
  v_dot2c_f32_bf16 v105, v6, v67
  v_dot2c_f32_bf16 v106, v6, v76
  s_waitcnt lgkmcnt(2)
  v_dot2c_f32_bf16 v107, v6, v85
  v_dot2c_f32_bf16 v100, v7, v23
  v_dot2c_f32_bf16 v101, v7, v32
  v_dot2c_f32_bf16 v102, v7, v41
  v_dot2c_f32_bf16 v103, v7, v50
  v_dot2c_f32_bf16 v104, v7, v59
  v_dot2c_f32_bf16 v105, v7, v68
  v_dot2c_f32_bf16 v106, v7, v77
  s_waitcnt lgkmcnt(1)
  v_dot2c_f32_bf16 v107, v7, v86
  v_dot2c_f32_bf16 v100, v8, v24
  v_dot2c_f32_bf16 v101, v8, v33
  v_dot2c_f32_bf16 v102, v8, v42
  v_dot2c_f32_bf16 v103, v8, v51
  v_dot2c_f32_bf16 v104, v8, v60
  v_dot2c_f32_bf16 v105, v8, v69
  v_dot2c_f32_bf16 v106, v8, v78
  s_waitcnt lgkmcnt(0)
  v_dot2c_f32_bf16 v107, v8, v87
  ds_read_b32 v16, v219 offset:7512
  ds_read_b32 v17, v219 offset:7516
  ds_read_b32 v18, v219 offset:7520
  ds_read_b32 v19, v219 offset:7524
  ds_read_b32 v20, v219 offset:7528
  ds_read_b32 v21, v219 offset:7532
  ds_read_b32 v22, v219 offset:7536
  ds_read_b32 v23, v219 offset:7540
  ds_read_b32 v24, v219 offset:7544
  ds_read_b32 v25, v219 offset:6480
  ds_read_b32 v26, v219 offset:6484
  ds_read_b32 v27, v219 offset:6488
  ds_read_b32 v28, v219 offset:6492
  ds_read_b32 v29, v219 offset:6496
  ds_read_b32 v30, v219 offset:6500
  ds_read_b32 v31, v219 offset:6504
  ds_read_b32 v32, v219 offset:6508
  ds_read_b32 v33, v219 offset:6512
  ds_read_b32 v34, v219 offset:5448
  ds_read_b32 v35, v219 offset:5452
  ds_read_b32 v36, v219 offset:5456
  ds_read_b32 v37, v219 offset:5460
  ds_read_b32 v38, v219 offset:5464
  ds_read_b32 v39, v219 offset:5468
  ds_read_b32 v40, v219 offset:5472
  ds_read_b32 v41, v219 offset:5476
  ds_read_b32 v42, v219 offset:5480
  ds_read_b32 v43, v219 offset:4416
  ds_read_b32 v44, v219 offset:4420
  ds_read_b32 v45, v219 offset:4424
  ds_read_b32 v46, v219 offset:4428
  ds_read_b32 v47, v219 offset:4432
  ds_read_b32 v48, v219 offset:4436
  ds_read_b32 v49, v219 offset:4440
  ds_read_b32 v50, v219 offset:4444
  ds_read_b32 v51, v219 offset:4448
  ds_read_b32 v52, v219 offset:3384
  ds_read_b32 v53, v219 offset:3388
  ds_read_b32 v54, v219 offset:3392
  ds_read_b32 v55, v219 offset:3396
  ds_read_b32 v56, v219 offset:3400
  ds_read_b32 v57, v219 offset:3404
  ds_read_b32 v58, v219 offset:3408
  ds_read_b32 v59, v219 offset:3412
  ds_read_b32 v60, v219 offset:3416
  ds_read_b32 v61, v219 offset:2352
  ds_read_b32 v62, v219 offset:2356
  ds_read_b32 v63, v219 offset:2360
  ds_read_b32 v64, v219 offset:2364
  ds_read_b32 v65, v219 offset:2368
  ds_read_b32 v66, v219 offset:2372
  ds_read_b32 v67, v219 offset:2376
  ds_read_b32 v68, v219 offset:2380
  ds_read_b32 v69, v219 offset:2384
  ds_read_b32 v70, v219 offset:1320
  ds_read_b32 v71, v219 offset:1324
  ds_read_b32 v72, v219 offset:1328
  ds_read_b32 v73, v219 offset:1332
  ds_read_b32 v74, v219 offset:1336
  ds_read_b32 v75, v219 offset:1340
  ds_read_b32 v76, v219 offset:1344
  ds_read_b32 v77, v219 offset:1348
  ds_read_b32 v78, v219 offset:1352
  ds_read_b32 v79, v219 offset:288
  ds_read_b32 v80, v219 offset:292
  ds_read_b32 v81, v219 offset:296
  ds_read_b32 v82, v219 offset:300
  ds_read_b32 v83, v219 offset:304
  ds_read_b32 v84, v219 offset:308
  ds_read_b32 v85, v219 offset:312
  ds_read_b32 v86, v219 offset:316
  ds_read_b32 v87, v219 offset:320
  v_add_u32 v211, s66, v200
  v_mov_b32 v212, 0xf149f2ca
  v_mul_f32 v100, s57, v100
  v_mul_f32 v101, s57, v101
  v_mul_f32 v102, s57, v102
  v_mul_f32 v103, s57, v103
  v_mul_f32 v104, s57, v104
  v_mul_f32 v105, s57, v105
  v_mul_f32 v106, s57, v106
  v_mul_f32 v107, s57, v107
  v_cmp_gt_u32 vcc, 2, v211
  s_nop 1
  v_cndmask_b32 v101, v101, v212, vcc
  v_cmp_gt_u32 vcc, 4, v211
  s_nop 1
  v_cndmask_b32 v102, v102, v212, vcc
  v_cmp_gt_u32 vcc, 6, v211
  s_nop 1
  v_cndmask_b32 v103, v103, v212, vcc
  v_cmp_gt_u32 vcc, 8, v211
  s_nop 1
  v_cndmask_b32 v104, v104, v212, vcc
  v_cmp_gt_u32 vcc, 10, v211
  s_nop 1
  v_cndmask_b32 v105, v105, v212, vcc
  v_cmp_gt_u32 vcc, 12, v211
  s_nop 1
  v_cndmask_b32 v106, v106, v212, vcc
  v_cmp_gt_u32 vcc, 14, v211
  s_nop 1
  v_cndmask_b32 v107, v107, v212, vcc
  v_max3_f32 v213, v100, v101, v102
  v_max3_f32 v213, v213, v103, v104
  v_max3_f32 v213, v213, v105, v106
  v_max_f32 v213, v213, v107
  v_sub_f32 v100, v100, v213
  v_sub_f32 v101, v101, v213
  v_sub_f32 v102, v102, v213
  v_sub_f32 v103, v103, v213
  v_sub_f32 v104, v104, v213
  v_sub_f32 v105, v105, v213
  v_sub_f32 v106, v106, v213
  v_sub_f32 v107, v107, v213
  v_exp_f32 v100, v100
  v_exp_f32 v101, v101
  v_exp_f32 v102, v102
  v_exp_f32 v103, v103
  v_exp_f32 v104, v104
  v_exp_f32 v105, v105
  v_exp_f32 v106, v106
  v_exp_f32 v107, v107
  v_add_f32 v213, v100, v101
  v_add_f32 v213, v213, v102
  v_add_f32 v213, v213, v103
  v_add_f32 v213, v213, v104
  v_add_f32 v213, v213, v105
  v_add_f32 v213, v213, v106
  v_add_f32 v213, v213, v107
  v_rcp_f32 v213, v213
  v_mov_b32 v214, 0
  v_mul_f32 v100, v213, v100
  v_mul_f32 v101, v213, v101
  v_mul_f32 v102, v213, v102
  v_mul_f32 v103, v213, v103
  v_mul_f32 v104, v213, v104
  v_mul_f32 v105, v213, v105
  v_mul_f32 v106, v213, v106
  v_mul_f32 v107, v213, v107
  v_mov_b32 v112, 0
  v_mov_b32 v113, 0
  v_mov_b32 v114, 0
  v_mov_b32 v115, 0
  v_mov_b32 v116, 0
  v_mov_b32 v117, 0
  v_mov_b32 v118, 0
  v_mov_b32 v119, 0
  v_mov_b32 v120, 0
  v_mov_b32 v121, 0
  v_mov_b32 v122, 0
  v_mov_b32 v123, 0
  v_mov_b32 v124, 0
  v_mov_b32 v125, 0
  v_mov_b32 v126, 0
  v_mov_b32 v127, 0
  v_mov_b32 v128, 0
  v_mov_b32 v129, 0
  v_cvt_pk_bf16_f32 v0, v100, v214
  v_cvt_pk_bf16_f32 v1, v214, v100
  s_waitcnt lgkmcnt(15)
  v_dot2c_f32_bf16 v112, v16, v0
  v_dot2c_f32_bf16 v113, v16, v1
  v_dot2c_f32_bf16 v114, v17, v0
  v_dot2c_f32_bf16 v115, v17, v1
  v_dot2c_f32_bf16 v116, v18, v0
  v_dot2c_f32_bf16 v117, v18, v1
  v_dot2c_f32_bf16 v118, v19, v0
  v_dot2c_f32_bf16 v119, v19, v1
  v_dot2c_f32_bf16 v120, v20, v0
  v_dot2c_f32_bf16 v121, v20, v1
  v_dot2c_f32_bf16 v122, v21, v0
  v_dot2c_f32_bf16 v123, v21, v1
  v_dot2c_f32_bf16 v124, v22, v0
  v_dot2c_f32_bf16 v125, v22, v1
  v_dot2c_f32_bf16 v126, v23, v0
  v_dot2c_f32_bf16 v127, v23, v1
  v_dot2c_f32_bf16 v128, v24, v0
  v_dot2c_f32_bf16 v129, v24, v1
  v_cvt_pk_bf16_f32 v2, v101, v214
  v_cvt_pk_bf16_f32 v3, v214, v101
  v_dot2c_f32_bf16 v112, v25, v2
  v_dot2c_f32_bf16 v113, v25, v3
  v_dot2c_f32_bf16 v114, v26, v2
  v_dot2c_f32_bf16 v115, v26, v3
  v_dot2c_f32_bf16 v116, v27, v2
  v_dot2c_f32_bf16 v117, v27, v3
  v_dot2c_f32_bf16 v118, v28, v2
  v_dot2c_f32_bf16 v119, v28, v3
  v_dot2c_f32_bf16 v120, v29, v2
  v_dot2c_f32_bf16 v121, v29, v3
  v_dot2c_f32_bf16 v122, v30, v2
  v_dot2c_f32_bf16 v123, v30, v3
  v_dot2c_f32_bf16 v124, v31, v2
  v_dot2c_f32_bf16 v125, v31, v3
  v_dot2c_f32_bf16 v126, v32, v2
  v_dot2c_f32_bf16 v127, v32, v3
  v_dot2c_f32_bf16 v128, v33, v2
  v_dot2c_f32_bf16 v129, v33, v3
  v_cvt_pk_bf16_f32 v0, v102, v214
  v_cvt_pk_bf16_f32 v1, v214, v102
  v_dot2c_f32_bf16 v112, v34, v0
  v_dot2c_f32_bf16 v113, v34, v1
  v_dot2c_f32_bf16 v114, v35, v0
  v_dot2c_f32_bf16 v115, v35, v1
  v_dot2c_f32_bf16 v116, v36, v0
  v_dot2c_f32_bf16 v117, v36, v1
  v_dot2c_f32_bf16 v118, v37, v0
  v_dot2c_f32_bf16 v119, v37, v1
  v_dot2c_f32_bf16 v120, v38, v0
  v_dot2c_f32_bf16 v121, v38, v1
  v_dot2c_f32_bf16 v122, v39, v0
  v_dot2c_f32_bf16 v123, v39, v1
  v_dot2c_f32_bf16 v124, v40, v0
  v_dot2c_f32_bf16 v125, v40, v1
  v_dot2c_f32_bf16 v126, v41, v0
  v_dot2c_f32_bf16 v127, v41, v1
  v_dot2c_f32_bf16 v128, v42, v0
  v_dot2c_f32_bf16 v129, v42, v1
  v_cvt_pk_bf16_f32 v2, v103, v214
  v_cvt_pk_bf16_f32 v3, v214, v103
  v_dot2c_f32_bf16 v112, v43, v2
  v_dot2c_f32_bf16 v113, v43, v3
  v_dot2c_f32_bf16 v114, v44, v2
  v_dot2c_f32_bf16 v115, v44, v3
  v_dot2c_f32_bf16 v116, v45, v2
  v_dot2c_f32_bf16 v117, v45, v3
  v_dot2c_f32_bf16 v118, v46, v2
  v_dot2c_f32_bf16 v119, v46, v3
  v_dot2c_f32_bf16 v120, v47, v2
  v_dot2c_f32_bf16 v121, v47, v3
  v_dot2c_f32_bf16 v122, v48, v2
  v_dot2c_f32_bf16 v123, v48, v3
  v_dot2c_f32_bf16 v124, v49, v2
  v_dot2c_f32_bf16 v125, v49, v3
  v_dot2c_f32_bf16 v126, v50, v2
  v_dot2c_f32_bf16 v127, v50, v3
  v_dot2c_f32_bf16 v128, v51, v2
  v_dot2c_f32_bf16 v129, v51, v3
  v_cvt_pk_bf16_f32 v0, v104, v214
  v_cvt_pk_bf16_f32 v1, v214, v104
  v_dot2c_f32_bf16 v112, v52, v0
  v_dot2c_f32_bf16 v113, v52, v1
  v_dot2c_f32_bf16 v114, v53, v0
  v_dot2c_f32_bf16 v115, v53, v1
  v_dot2c_f32_bf16 v116, v54, v0
  v_dot2c_f32_bf16 v117, v54, v1
  v_dot2c_f32_bf16 v118, v55, v0
  v_dot2c_f32_bf16 v119, v55, v1
  v_dot2c_f32_bf16 v120, v56, v0
  v_dot2c_f32_bf16 v121, v56, v1
  v_dot2c_f32_bf16 v122, v57, v0
  v_dot2c_f32_bf16 v123, v57, v1
  v_dot2c_f32_bf16 v124, v58, v0
  v_dot2c_f32_bf16 v125, v58, v1
  v_dot2c_f32_bf16 v126, v59, v0
  v_dot2c_f32_bf16 v127, v59, v1
  v_dot2c_f32_bf16 v128, v60, v0
  v_dot2c_f32_bf16 v129, v60, v1
  v_cvt_pk_bf16_f32 v2, v105, v214
  v_cvt_pk_bf16_f32 v3, v214, v105
  v_dot2c_f32_bf16 v112, v61, v2
  v_dot2c_f32_bf16 v113, v61, v3
  v_dot2c_f32_bf16 v114, v62, v2
  v_dot2c_f32_bf16 v115, v62, v3
  v_dot2c_f32_bf16 v116, v63, v2
  v_dot2c_f32_bf16 v117, v63, v3
  v_dot2c_f32_bf16 v118, v64, v2
  v_dot2c_f32_bf16 v119, v64, v3
  v_dot2c_f32_bf16 v120, v65, v2
  v_dot2c_f32_bf16 v121, v65, v3
  v_dot2c_f32_bf16 v122, v66, v2
  v_dot2c_f32_bf16 v123, v66, v3
  v_dot2c_f32_bf16 v124, v67, v2
  v_dot2c_f32_bf16 v125, v67, v3
  v_dot2c_f32_bf16 v126, v68, v2
  v_dot2c_f32_bf16 v127, v68, v3
  v_dot2c_f32_bf16 v128, v69, v2
  v_dot2c_f32_bf16 v129, v69, v3
  v_cvt_pk_bf16_f32 v0, v106, v214
  v_cvt_pk_bf16_f32 v1, v214, v106
  v_dot2c_f32_bf16 v112, v70, v0
  v_dot2c_f32_bf16 v113, v70, v1
  v_dot2c_f32_bf16 v114, v71, v0
  v_dot2c_f32_bf16 v115, v71, v1
  v_dot2c_f32_bf16 v116, v72, v0
  v_dot2c_f32_bf16 v117, v72, v1
  s_waitcnt lgkmcnt(14)
  v_dot2c_f32_bf16 v118, v73, v0
  v_dot2c_f32_bf16 v119, v73, v1
  s_waitcnt lgkmcnt(13)
  v_dot2c_f32_bf16 v120, v74, v0
  v_dot2c_f32_bf16 v121, v74, v1
  s_waitcnt lgkmcnt(12)
  v_dot2c_f32_bf16 v122, v75, v0
  v_dot2c_f32_bf16 v123, v75, v1
  s_waitcnt lgkmcnt(11)
  v_dot2c_f32_bf16 v124, v76, v0
  v_dot2c_f32_bf16 v125, v76, v1
  s_waitcnt lgkmcnt(10)
  v_dot2c_f32_bf16 v126, v77, v0
  v_dot2c_f32_bf16 v127, v77, v1
  s_waitcnt lgkmcnt(9)
  v_dot2c_f32_bf16 v128, v78, v0
  v_dot2c_f32_bf16 v129, v78, v1
  v_cvt_pk_bf16_f32 v2, v107, v214
  v_cvt_pk_bf16_f32 v3, v214, v107
  s_waitcnt lgkmcnt(8)
  v_dot2c_f32_bf16 v112, v79, v2
  v_dot2c_f32_bf16 v113, v79, v3
  s_waitcnt lgkmcnt(7)
  v_dot2c_f32_bf16 v114, v80, v2
  v_dot2c_f32_bf16 v115, v80, v3
  s_waitcnt lgkmcnt(6)
  v_dot2c_f32_bf16 v116, v81, v2
  v_dot2c_f32_bf16 v117, v81, v3
  s_waitcnt lgkmcnt(5)
  v_dot2c_f32_bf16 v118, v82, v2
  v_dot2c_f32_bf16 v119, v82, v3
  s_waitcnt lgkmcnt(4)
  v_dot2c_f32_bf16 v120, v83, v2
  v_dot2c_f32_bf16 v121, v83, v3
  s_waitcnt lgkmcnt(3)
  v_dot2c_f32_bf16 v122, v84, v2
  v_dot2c_f32_bf16 v123, v84, v3
  s_waitcnt lgkmcnt(2)
  v_dot2c_f32_bf16 v124, v85, v2
  v_dot2c_f32_bf16 v125, v85, v3
  s_waitcnt lgkmcnt(1)
  v_dot2c_f32_bf16 v126, v86, v2
  v_dot2c_f32_bf16 v127, v86, v3
  s_waitcnt lgkmcnt(0)
  v_dot2c_f32_bf16 v128, v87, v2
  v_dot2c_f32_bf16 v129, v87, v3
  v_cvt_pk_bf16_f32 v132, v112, v113
  v_cvt_pk_bf16_f32 v133, v114, v115
  v_cvt_pk_bf16_f32 v134, v116, v117
  v_cvt_pk_bf16_f32 v135, v118, v119
  v_cvt_pk_bf16_f32 v136, v120, v121
  v_cvt_pk_bf16_f32 v137, v122, v123
  v_cvt_pk_bf16_f32 v138, v124, v125
  v_cvt_pk_bf16_f32 v139, v126, v127
  v_cvt_pk_bf16_f32 v140, v128, v129
  buffer_store_dwordx4 v[132:135], v220, s[8:11], s64 offen sc1
  buffer_store_dwordx4 v[136:139], v220, s[8:11], s64 offen offset:16 sc1
  buffer_store_dword v140, v220, s[8:11], s64 offen offset:32 sc1
  s_mov_b32 s56, 36
  s_waitcnt vmcnt(0)
  s_barrier
  s_cmp_eq_u32 s52, 0
  s_cbranch_scc0 A_sig
  v_mov_b32 v211, 1
  v_mov_b32 v212, 0
  s_mov_b64 exec, 1
  buffer_atomic_add v211, v212, s[12:15], s56 offen
  s_mov_b64 exec, -1
A_sig:
  s_and_b32 s54, s53, 31
  s_cmp_lt_u32 s54, 27
  s_cbranch_scc0 L_exit
  s_and_b32 s54, s53, 31
  s_mul_i32 s68, s54, 57
  s_lshr_b32 s68, s68, 9
  s_mul_i32 s56, s68, 9
  s_sub_u32 s70, s54, s56
  s_bfe_u32 s55, s53, 0x10005
  s_mul_i32 s55, s55, 9
  s_add_u32 s70, s70, s55
  s_bfe_u32 s69, s53, 0x10006
  v_lshrrev_b32 v211, 2, v200
  v_mul_u32_u24 v211, 1152, v211
  v_and_b32 v212, 3, v200
  v_lshl_add_u32 v207, v212, 4, v211
  s_lshl_b32 s54, s70, 6
  s_mul_i32 s55, s52, 1179648
  s_add_u32 s62, s54, s55
  s_mul_i32 s55, s52, 184320
  s_add_u32 s63, s54, s55
  s_mul_i32 s61, s52, 40960
  v_bfe_u32 v211, v200, 2, 2
  v_lshlrev_b32 v212, 4, v212
  v_add_u32 v212, s61, v212
  v_lshl_add_u32 v212, v211, 6, v212
  v_lshrrev_b32 v213, 4, v200
  v_lshl_add_u32 v210, v213, 9, v212
  v_lshrrev_b32 v214, 5, v200
  v_lshl_add_u32 v209, v214, 10, v212
  v_and_b32 v214, 1, v213
  v_lshl_add_u32 v209, v214, 8, v209
  s_add_u32 m0, s61, 0
  s_add_u32 s54, s62, 0
  buffer_load_dwordx4 v207, s[28:31], s54 offen lds
  s_add_u32 m0, s61, 1024
  s_add_u32 s54, s62, 18432
  buffer_load_dwordx4 v207, s[28:31], s54 offen lds
  s_add_u32 m0, s61, 2048
  s_add_u32 s54, s62, 36864
  buffer_load_dwordx4 v207, s[28:31], s54 offen lds
  s_add_u32 m0, s61, 3072
  s_add_u32 s54, s62, 55296
  buffer_load_dwordx4 v207, s[28:31], s54 offen lds
  s_add_u32 m0, s61, 4096
  s_add_u32 s54, s62, 73728
  buffer_load_dwordx4 v207, s[28:31], s54 offen lds
  s_add_u32 m0, s61, 5120
  s_add_u32 s54, s62, 92160
  buffer_load_dwordx4 v207, s[28:31], s54 offen lds
  s_add_u32 m0, s61, 6144
  s_add_u32 s54, s62, 110592
  buffer_load_dwordx4 v207, s[28:31], s54 offen lds
  s_add_u32 m0, s61, 7168
  s_add_u32 s54, s62, 129024
  buffer_load_dwordx4 v207, s[28:31], s54 offen lds
  s_add_u32 m0, s61, 8192
  s_add_u32 s54, s62, 147456
  buffer_load_dwordx4 v207, s[28:31], s54 offen lds
  s_add_u32 m0, s61, 9216
  s_add_u32 s54, s62, 165888
  buffer_load_dwordx4 v207, s[28:31], s54 offen lds
  s_add_u32 m0, s61, 10240
  s_add_u32 s54, s62, 184320
  buffer_load_dwordx4 v207, s[28:31], s54 offen lds
  s_add_u32 m0, s61, 11264
  s_add_u32 s54, s62, 202752
  buffer_load_dwordx4 v207, s[28:31], s54 offen lds
  s_add_u32 m0, s61, 12288
  s_add_u32 s54, s62, 221184
  buffer_load_dwordx4 v207, s[28:31], s54 offen lds
  s_add_u32 m0, s61, 13312
  s_add_u32 s54, s62, 239616
  buffer_load_dwordx4 v207, s[28:31], s54 offen lds
  s_add_u32 m0, s61, 14336
  s_add_u32 s54, s62, 258048
  buffer_load_dwordx4 v207, s[28:31], s54 offen lds
  s_add_u32 m0, s61, 15360
  s_add_u32 s54, s62, 276480
  buffer_load_dwordx4 v207, s[28:31], s54 offen lds
  s_add_u32 m0, s61, 16384
  s_add_u32 s54, s62, 294912
  buffer_load_dwordx4 v207, s[28:31], s54 offen lds
  s_add_u32 m0, s61, 17408
  s_add_u32 s54, s62, 313344
  buffer_load_dwordx4 v207, s[28:31], s54 offen lds
  s_add_u32 m0, s61, 18432
  s_add_u32 s54, s62, 331776
  buffer_load_dwordx4 v207, s[28:31], s54 offen lds
  s_add_u32 m0, s61, 19456
  s_add_u32 s54, s62, 350208
  buffer_load_dwordx4 v207, s[28:31], s54 offen lds
  s_add_u32 m0, s61, 20480
  s_add_u32 s54, s62, 368640
  buffer_load_dwordx4 v207, s[28:31], s54 offen lds
  s_add_u32 m0, s61, 21504
  s_add_u32 s54, s62, 387072
  buffer_load_dwordx4 v207, s[28:31], s54 offen lds
  s_add_u32 m0, s61, 22528
  s_add_u32 s54, s62, 405504
  buffer_load_dwordx4 v207, s[28:31], s54 offen lds
  s_add_u32 m0, s61, 23552
  s_add_u32 s54, s62, 423936
  buffer_load_dwordx4 v207, s[28:31], s54 offen lds
  s_add_u32 m0, s61, 24576
  s_add_u32 s54, s62, 442368
  buffer_load_dwordx4 v207, s[28:31], s54 offen lds
  s_add_u32 m0, s61, 25600
  s_add_u32 s54, s62, 460800
  buffer_load_dwordx4 v207, s[28:31], s54 offen lds
  s_add_u32 m0, s61, 26624
  s_add_u32 s54, s62, 479232
  buffer_load_dwordx4 v207, s[28:31], s54 offen lds
  s_add_u32 m0, s61, 27648
  s_add_u32 s54, s62, 497664
  buffer_load_dwordx4 v207, s[28:31], s54 offen lds
  s_add_u32 m0, s61, 28672
  s_add_u32 s54, s62, 516096
  buffer_load_dwordx4 v207, s[28:31], s54 offen lds
  s_add_u32 m0, s61, 29696
  s_add_u32 s54, s62, 534528
  buffer_load_dwordx4 v207, s[28:31], s54 offen lds
  s_add_u32 m0, s61, 30720
  s_add_u32 s54, s62, 552960
  buffer_load_dwordx4 v207, s[28:31], s54 offen lds
  s_add_u32 m0, s61, 31744
  s_add_u32 s54, s62, 571392
  buffer_load_dwordx4 v207, s[28:31], s54 offen lds
  s_add_u32 m0, s61, 32768
  s_add_u32 s54, s62, 589824
  buffer_load_dwordx4 v207, s[28:31], s54 offen lds
  s_add_u32 m0, s61, 33792
  s_add_u32 s54, s62, 608256
  buffer_load_dwordx4 v207, s[28:31], s54 offen lds
  s_add_u32 m0, s61, 34816
  s_add_u32 s54, s62, 626688
  buffer_load_dwordx4 v207, s[28:31], s54 offen lds
  s_add_u32 m0, s61, 35840
  s_add_u32 s54, s62, 645120
  buffer_load_dwordx4 v207, s[28:31], s54 offen lds
  s_add_u32 m0, s61, 36864
  s_add_u32 s54, s62, 663552
  buffer_load_dwordx4 v207, s[28:31], s54 offen lds
  s_add_u32 m0, s61, 37888
  s_add_u32 s54, s62, 681984
  buffer_load_dwordx4 v207, s[28:31], s54 offen lds
  s_waitcnt vmcnt(36) lgkmcnt(0)
  s_add_u32 m0, s61, 38912
  s_add_u32 s54, s62, 700416
  buffer_load_dwordx4 v207, s[28:31], s54 offen lds
  s_add_u32 m0, s61, 39936
  s_add_u32 s54, s62, 718848
  buffer_load_dwordx4 v207, s[28:31], s54 offen lds
  ds_read_b64_tr_b16 a[0:1], v209 offset:0
  ds_read_b64_tr_b16 a[2:3], v209 offset:512
  ds_read_b64_tr_b16 a[4:5], v209 offset:8
  ds_read_b64_tr_b16 a[6:7], v209 offset:520
  s_waitcnt vmcnt(36) lgkmcnt(0)
  s_add_u32 m0, s61, 0
  s_add_u32 s54, s62, 737280
  buffer_load_dwordx4 v207, s[28:31], s54 offen lds
  s_add_u32 m0, s61, 1024
  s_add_u32 s54, s62, 755712
  buffer_load_dwordx4 v207, s[28:31], s54 offen lds
  ds_read_b64_tr_b16 a[8:9], v209 offset:2048
  ds_read_b64_tr_b16 a[10:11], v209 offset:2560
  ds_read_b64_tr_b16 a[12:13], v209 offset:2056
  ds_read_b64_tr_b16 a[14:15], v209 offset:2568
  s_waitcnt vmcnt(36) lgkmcnt(0)
  s_add_u32 m0, s61, 2048
  s_add_u32 s54, s62, 774144
  buffer_load_dwordx4 v207, s[28:31], s54 offen lds
  s_add_u32 m0, s61, 3072
  s_add_u32 s54, s62, 792576
  buffer_load_dwordx4 v207, s[28:31], s54 offen lds
  ds_read_b64_tr_b16 a[16:17], v209 offset:4096
  ds_read_b64_tr_b16 a[18:19], v209 offset:4608
  ds_read_b64_tr_b16 a[20:21], v209 offset:4104
  ds_read_b64_tr_b16 a[22:23], v209 offset:4616
  s_waitcnt vmcnt(36) lgkmcnt(0)
  s_add_u32 m0, s61, 4096
  s_add_u32 s54, s62, 811008
  buffer_load_dwordx4 v207, s[28:31], s54 offen lds
  s_add_u32 m0, s61, 5120
  s_add_u32 s54, s62, 829440
  buffer_load_dwordx4 v207, s[28:31], s54 offen lds
  ds_read_b64_tr_b16 a[24:25], v209 offset:6144
  ds_read_b64_tr_b16 a[26:27], v209 offset:6656
  ds_read_b64_tr_b16 a[28:29], v209 offset:6152
  ds_read_b64_tr_b16 a[30:31], v209 offset:6664
  s_waitcnt vmcnt(36) lgkmcnt(0)
  s_add_u32 m0, s61, 6144
  s_add_u32 s54, s62, 847872
  buffer_load_dwordx4 v207, s[28:31], s54 offen lds
  s_add_u32 m0, s61, 7168
  s_add_u32 s54, s62, 866304
  buffer_load_dwordx4 v207, s[28:31], s54 offen lds
  ds_read_b64_tr_b16 a[32:33], v209 offset:8192
  ds_read_b64_tr_b16 a[34:35], v209 offset:8704
  ds_read_b64_tr_b16 a[36:37], v209 offset:8200
  ds_read_b64_tr_b16 a[38:39], v209 offset:8712
  s_waitcnt vmcnt(36) lgkmcnt(0)
  s_add_u32 m0, s61, 8192
  s_add_u32 s54, s62, 884736
  buffer_load_dwordx4 v207, s[28:31], s54 offen lds
  s_add_u32 m0, s61, 9216
  s_add_u32 s54, s62, 903168
  buffer_load_dwordx4 v207, s[28:31], s54 offen lds
  ds_read_b64_tr_b16 a[40:41], v209 offset:10240
  ds_read_b64_tr_b16 a[42:43], v209 offset:10752
  ds_read_b64_tr_b16 a[44:45], v209 offset:10248
  ds_read_b64_tr_b16 a[46:47], v209 offset:10760
  s_waitcnt vmcnt(36) lgkmcnt(0)
  s_add_u32 m0, s61, 10240
  s_add_u32 s54, s62, 921600
  buffer_load_dwordx4 v207, s[28:31], s54 offen lds
  s_add_u32 m0, s61, 11264
  s_add_u32 s54, s62, 940032
  buffer_load_dwordx4 v207, s[28:31], s54 offen lds
  ds_read_b64_tr_b16 a[48:49], v209 offset:12288
  ds_read_b64_tr_b16 a[50:51], v209 offset:12800
  ds_read_b64_tr_b16 a[52:53], v209 offset:12296
  ds_read_b64_tr_b16 a[54:55], v209 offset:12808
  s_waitcnt vmcnt(36) lgkmcnt(0)
  s_add_u32 m0, s61, 12288
  s_add_u32 s54, s62, 958464
  buffer_load_dwordx4 v207, s[28:31], s54 offen lds
  s_add_u32 m0, s61, 13312
  s_add_u32 s54, s62, 976896
  buffer_load_dwordx4 v207, s[28:31], s54 offen lds
  ds_read_b64_tr_b16 a[56:57], v209 offset:14336
  ds_read_b64_tr_b16 a[58:59], v209 offset:14848
  ds_read_b64_tr_b16 a[60:61], v209 offset:14344
  ds_read_b64_tr_b16 a[62:63], v209 offset:14856
  s_waitcnt vmcnt(36) lgkmcnt(0)
  s_add_u32 m0, s61, 14336
  s_add_u32 s54, s62, 995328
  buffer_load_dwordx4 v207, s[28:31], s54 offen lds
  s_add_u32 m0, s61, 15360
  s_add_u32 s54, s62, 1013760
  buffer_load_dwordx4 v207, s[28:31], s54 offen lds
  ds_read_b64_tr_b16 a[64:65], v209 offset:16384
  ds_read_b64_tr_b16 a[66:67], v209 offset:16896
  ds_read_b64_tr_b16 a[68:69], v209 offset:16392
  ds_read_b64_tr_b16 a[70:71], v209 offset:16904
  s_waitcnt vmcnt(36) lgkmcnt(0)
  s_add_u32 m0, s61, 16384
  s_add_u32 s54, s62, 1032192
  buffer_load_dwordx4 v207, s[28:31], s54 offen lds
  s_add_u32 m0, s61, 17408
  s_add_u32 s54, s62, 1050624
  buffer_load_dwordx4 v207, s[28:31], s54 offen lds
  ds_read_b64_tr_b16 a[72:73], v209 offset:18432
  ds_read_b64_tr_b16 a[74:75], v209 offset:18944
  ds_read_b64_tr_b16 a[76:77], v209 offset:18440
  ds_read_b64_tr_b16 a[78:79], v209 offset:18952
  s_waitcnt vmcnt(36) lgkmcnt(0)
  s_add_u32 m0, s61, 18432
  s_add_u32 s54, s62, 1069056
  buffer_load_dwordx4 v207, s[28:31], s54 offen lds
  s_add_u32 m0, s61, 19456
  s_add_u32 s54, s62, 1087488
  buffer_load_dwordx4 v207, s[28:31], s54 offen lds
  ds_read_b64_tr_b16 a[80:81], v209 offset:20480
  ds_read_b64_tr_b16 a[82:83], v209 offset:20992
  ds_read_b64_tr_b16 a[84:85], v209 offset:20488
  ds_read_b64_tr_b16 a[86:87], v209 offset:21000
  s_waitcnt vmcnt(36) lgkmcnt(0)
  s_add_u32 m0, s61, 20480
  s_add_u32 s54, s62, 1105920
  buffer_load_dwordx4 v207, s[28:31], s54 offen lds
  s_add_u32 m0, s61, 21504
  s_add_u32 s54, s62, 1124352
  buffer_load_dwordx4 v207, s[28:31], s54 offen lds
  ds_read_b64_tr_b16 a[88:89], v209 offset:22528
  ds_read_b64_tr_b16 a[90:91], v209 offset:23040
  ds_read_b64_tr_b16 a[92:93], v209 offset:22536
  ds_read_b64_tr_b16 a[94:95], v209 offset:23048
  s_waitcnt vmcnt(36) lgkmcnt(0)
  s_add_u32 m0, s61, 22528
  s_add_u32 s54, s62, 1142784
  buffer_load_dwordx4 v207, s[28:31], s54 offen lds
  s_add_u32 m0, s61, 23552
  s_add_u32 s54, s62, 1161216
  buffer_load_dwordx4 v207, s[28:31], s54 offen lds
  ds_read_b64_tr_b16 a[96:97], v209 offset:24576
  ds_read_b64_tr_b16 a[98:99], v209 offset:25088
  ds_read_b64_tr_b16 a[100:101], v209 offset:24584
  ds_read_b64_tr_b16 a[102:103], v209 offset:25096
  s_waitcnt vmcnt(36) lgkmcnt(0)
  s_add_u32 m0, s61, 24576
  s_add_u32 s54, s63, 0
  buffer_load_dwordx4 v207, s[40:43], s54 offen lds
  s_add_u32 m0, s61, 25600
  s_add_u32 s54, s63, 18432
  buffer_load_dwordx4 v207, s[40:43], s54 offen lds
  ds_read_b64_tr_b16 a[104:105], v209 offset:26624
  ds_read_b64_tr_b16 a[106:107], v209 offset:27136
  ds_read_b64_tr_b16 a[108:109], v209 offset:26632
  ds_read_b64_tr_b16 a[110:111], v209 offset:27144
  s_waitcnt vmcnt(36) lgkmcnt(0)
  s_add_u32 m0, s61, 26624
  s_add_u32 s54, s63, 36864
  buffer_load_dwordx4 v207, s[40:43], s54 offen lds
  s_add_u32 m0, s61, 27648
  s_add_u32 s54, s63, 55296
  buffer_load_dwordx4 v207, s[40:43], s54 offen lds
  ds_read_b64_tr_b16 a[112:113], v209 offset:28672
  ds_read_b64_tr_b16 a[114:115], v209 offset:29184
  ds_read_b64_tr_b16 a[116:117], v209 offset:28680
  ds_read_b64_tr_b16 a[118:119], v209 offset:29192
  s_waitcnt vmcnt(36) lgkmcnt(0)
  s_add_u32 m0, s61, 28672
  s_add_u32 s54, s63, 73728
  buffer_load_dwordx4 v207, s[40:43], s54 offen lds
  s_add_u32 m0, s61, 29696
  s_add_u32 s54, s63, 92160
  buffer_load_dwordx4 v207, s[40:43], s54 offen lds
  ds_read_b64_tr_b16 a[120:121], v209 offset:30720
  ds_read_b64_tr_b16 a[122:123], v209 offset:31232
  ds_read_b64_tr_b16 a[124:125], v209 offset:30728
  ds_read_b64_tr_b16 a[126:127], v209 offset:31240
  s_waitcnt vmcnt(36) lgkmcnt(0)
  s_add_u32 m0, s61, 30720
  s_add_u32 s54, s63, 110592
  buffer_load_dwordx4 v207, s[40:43], s54 offen lds
  s_add_u32 m0, s61, 31744
  s_add_u32 s54, s63, 129024
  buffer_load_dwordx4 v207, s[40:43], s54 offen lds
  ds_read_b64_tr_b16 a[128:129], v209 offset:32768
  ds_read_b64_tr_b16 a[130:131], v209 offset:33280
  ds_read_b64_tr_b16 a[132:133], v209 offset:32776
  ds_read_b64_tr_b16 a[134:135], v209 offset:33288
  s_waitcnt vmcnt(36) lgkmcnt(0)
  s_add_u32 m0, s61, 32768
  s_add_u32 s54, s63, 147456
  buffer_load_dwordx4 v207, s[40:43], s54 offen lds
  s_add_u32 m0, s61, 33792
  s_add_u32 s54, s63, 165888
  buffer_load_dwordx4 v207, s[40:43], s54 offen lds
  ds_read_b64_tr_b16 a[136:137], v209 offset:34816
  ds_read_b64_tr_b16 a[138:139], v209 offset:35328
  ds_read_b64_tr_b16 a[140:141], v209 offset:34824
  ds_read_b64_tr_b16 a[142:143], v209 offset:35336
  s_waitcnt vmcnt(36) lgkmcnt(0)
  ds_read_b64_tr_b16 a[144:145], v209 offset:36864
  ds_read_b64_tr_b16 a[146:147], v209 offset:37376
  ds_read_b64_tr_b16 a[148:149], v209 offset:36872
  ds_read_b64_tr_b16 a[150:151], v209 offset:37384
  s_waitcnt vmcnt(34) lgkmcnt(0)
  ds_read_b64_tr_b16 a[152:153], v209 offset:38912
  ds_read_b64_tr_b16 a[154:155], v209 offset:39424
  ds_read_b64_tr_b16 a[156:157], v209 offset:38920
  ds_read_b64_tr_b16 a[158:159], v209 offset:39432
  s_waitcnt vmcnt(32) lgkmcnt(0)
  ds_read_b64_tr_b16 a[160:161], v209 offset:0
  ds_read_b64_tr_b16 a[162:163], v209 offset:512
  ds_read_b64_tr_b16 a[164:165], v209 offset:8
  ds_read_b64_tr_b16 a[166:167], v209 offset:520
  s_waitcnt vmcnt(30) lgkmcnt(0)
  ds_read_b64_tr_b16 a[168:169], v209 offset:2048
  ds_read_b64_tr_b16 a[170:171], v209 offset:2560
  ds_read_b64_tr_b16 a[172:173], v209 offset:2056
  ds_read_b64_tr_b16 a[174:175], v209 offset:2568
  s_waitcnt vmcnt(28) lgkmcnt(0)
  ds_read_b64_tr_b16 a[176:177], v209 offset:4096
  ds_read_b64_tr_b16 a[178:179], v209 offset:4608
  ds_read_b64_tr_b16 a[180:181], v209 offset:4104
  ds_read_b64_tr_b16 a[182:183], v209 offset:4616
  s_waitcnt vmcnt(26) lgkmcnt(0)
  ds_read_b64_tr_b16 a[184:185], v209 offset:6144
  ds_read_b64_tr_b16 a[186:187], v209 offset:6656
  ds_read_b64_tr_b16 a[188:189], v209 offset:6152
  ds_read_b64_tr_b16 a[190:191], v209 offset:6664
  s_waitcnt vmcnt(24) lgkmcnt(0)
  ds_read_b64_tr_b16 a[192:193], v209 offset:8192
  ds_read_b64_tr_b16 a[194:195], v209 offset:8704
  ds_read_b64_tr_b16 a[196:197], v209 offset:8200
  ds_read_b64_tr_b16 a[198:199], v209 offset:8712
  s_waitcnt vmcnt(22) lgkmcnt(0)
  ds_read_b64_tr_b16 a[200:201], v209 offset:10240
  ds_read_b64_tr_b16 a[202:203], v209 offset:10752
  ds_read_b64_tr_b16 a[204:205], v209 offset:10248
  ds_read_b64_tr_b16 a[206:207], v209 offset:10760
  s_waitcnt vmcnt(20) lgkmcnt(0)
  ds_read_b64_tr_b16 a[208:209], v209 offset:12288
  ds_read_b64_tr_b16 a[210:211], v209 offset:12800
  ds_read_b64_tr_b16 a[212:213], v209 offset:12296
  ds_read_b64_tr_b16 a[214:215], v209 offset:12808
  s_waitcnt vmcnt(18) lgkmcnt(0)
  ds_read_b64_tr_b16 a[216:217], v209 offset:14336
  ds_read_b64_tr_b16 a[218:219], v209 offset:14848
  ds_read_b64_tr_b16 a[220:221], v209 offset:14344
  ds_read_b64_tr_b16 a[222:223], v209 offset:14856
  s_waitcnt vmcnt(16) lgkmcnt(0)
  ds_read_b64_tr_b16 a[224:225], v209 offset:16384
  ds_read_b64_tr_b16 a[226:227], v209 offset:16896
  ds_read_b64_tr_b16 a[228:229], v209 offset:16392
  ds_read_b64_tr_b16 a[230:231], v209 offset:16904
  s_waitcnt vmcnt(14) lgkmcnt(0)
  ds_read_b64_tr_b16 a[232:233], v209 offset:18432
  ds_read_b64_tr_b16 a[234:235], v209 offset:18944
  ds_read_b64_tr_b16 a[236:237], v209 offset:18440
  ds_read_b64_tr_b16 a[238:239], v209 offset:18952
  s_waitcnt vmcnt(12) lgkmcnt(0)
  ds_read_b64_tr_b16 a[240:241], v209 offset:20480
  ds_read_b64_tr_b16 a[242:243], v209 offset:20992
  ds_read_b64_tr_b16 a[244:245], v209 offset:20488
  ds_read_b64_tr_b16 a[246:247], v209 offset:21000
  s_waitcnt vmcnt(10) lgkmcnt(0)
  ds_read_b64_tr_b16 a[248:249], v209 offset:22528
  ds_read_b64_tr_b16 a[250:251], v209 offset:23040
  ds_read_b64_tr_b16 a[252:253], v209 offset:22536
  ds_read_b64_tr_b16 a[254:255], v209 offset:23048
  s_waitcnt vmcnt(8) lgkmcnt(0)
  ds_read_b64_tr_b16 v[216:217], v210 offset:24576
  ds_read_b64_tr_b16 v[218:219], v210 offset:24832
  ds_read_b64_tr_b16 v[220:221], v210 offset:24584
  ds_read_b64_tr_b16 v[222:223], v210 offset:24840
  s_waitcnt vmcnt(6) lgkmcnt(0)
  ds_read_b64_tr_b16 v[224:225], v210 offset:26624
  ds_read_b64_tr_b16 v[226:227], v210 offset:26880
  ds_read_b64_tr_b16 v[228:229], v210 offset:26632
  ds_read_b64_tr_b16 v[230:231], v210 offset:26888
  s_waitcnt vmcnt(4) lgkmcnt(0)
  ds_read_b64_tr_b16 v[232:233], v210 offset:28672
  ds_read_b64_tr_b16 v[234:235], v210 offset:28928
  ds_read_b64_tr_b16 v[236:237], v210 offset:28680
  ds_read_b64_tr_b16 v[238:239], v210 offset:28936
  s_waitcnt vmcnt(2) lgkmcnt(0)
  ds_read_b64_tr_b16 v[240:241], v210 offset:30720
  ds_read_b64_tr_b16 v[242:243], v210 offset:30976
  ds_read_b64_tr_b16 v[244:245], v210 offset:30728
  ds_read_b64_tr_b16 v[246:247], v210 offset:30984
  s_waitcnt vmcnt(0) lgkmcnt(0)
  ds_read_b64_tr_b16 v[248:249], v210 offset:32768
  ds_read_b64_tr_b16 v[250:251], v210 offset:33024
  ds_read_b64_tr_b16 v[252:253], v210 offset:32776
  ds_read_b64_tr_b16 v[254:255], v210 offset:33032
  v_and_b32 v211, 15, v200
  s_lshl_b32 s54, s69, 4
  v_add_u32 v211, s54, v211
  v_lshl_add_u32 v212, v214, 5, v211
  v_lshlrev_b32 v164, 4, v212
  v_lshrrev_b32 v212, 5, v200
  v_lshl_add_u32 v164, v212, 10, v164
  v_mul_u32_u24 v167, 1152, v211
  v_lshl_add_u32 v167, v213, 4, v167
  v_lshlrev_b32 v166, 2, v211
  v_lshlrev_b32 v208, 2, v200
  s_lshl_b32 s54, s52, 11
  v_add_u32 v168, s54, v201
  s_mov_b32 s59, s68
  s_mov_b32 s56, 128
  s_mov_b32 s57, 36
  s_waitcnt lgkmcnt(0)
  s_cmp_eq_u32 s52, 0
  s_cbranch_scc0 O_p1_d
  s_mov_b32 exec_hi, 0
  s_mov_b32 exec_lo, -1
O_p1:
  buffer_load_dword v211, v208, s[12:15], s56 offen sc1
  s_add_u32 s65, s65, 1
  s_waitcnt vmcnt(0)
  v_cmp_gt_u32 vcc, 0x700, v211
  s_cbranch_vccz O_p1_x
  s_sleep 16
  s_cmp_lt_u32 s65, 131072
  s_cbranch_scc1 O_p1
O_p1_x:
  s_mov_b64 exec, -1
O_p1_d:
  s_barrier
  s_cmp_eq_u32 s52, 0
  s_cbranch_scc0 O_a_d
  s_mov_b32 exec_hi, 0
  s_mov_b32 exec_lo, 1
O_a:
  buffer_load_dword v211, v208, s[12:15], s57 offen sc1
  s_add_u32 s65, s65, 1
  s_waitcnt vmcnt(0)
  v_cmp_gt_u32 vcc, 0x80, v211
  s_cbranch_vccz O_a_x
  s_sleep 16
  s_cmp_lt_u32 s65, 131072
  s_cbranch_scc1 O_a
O_a_x:
  s_mov_b64 exec, -1
O_a_d:
  s_barrier
  s_cmp_ge_u32 s70, 9
  s_cselect_b32 s54, 9, 0
  s_sub_u32 s54, s70, s54
  s_and_b32 s54, s54, 7
  s_lshl_b32 s54, s54, 13
  s_lshl_b32 s55, s69, 8
  s_add_u32 s54, s54, s55
  v_lshrrev_b32 v211, 2, v200
  v_lshl_add_u32 v172, v211, 9, s54
  v_and_b32 v211, 3, v200
  v_lshl_add_u32 v172, v211, 6, v172
  s_mul_i32 s55, s59, 36864
  s_mul_i32 s54, s52, 320
  s_add_u32 s55, s55, s54
  s_add_u32 s55, s55, 62914560
  s_cmp_eq_u32 s52, 3
  s_cselect_b32 s56, 268435456, s55
  buffer_load_dwordx4 v[128:131], v167, s[8:11], s55 offen offset:0 sc1
  buffer_load_dwordx4 v[132:135], v167, s[8:11], s55 offen offset:64 sc1
  buffer_load_dwordx4 v[136:139], v167, s[8:11], s55 offen offset:128 sc1
  buffer_load_dwordx4 v[140:143], v167, s[8:11], s56 offen offset:192 sc1
  buffer_load_dwordx4 v[144:147], v167, s[8:11], s56 offen offset:256 sc1
  s_lshl_b32 s55, s59, 7
  s_add_u32 s55, s55, 66060288
  buffer_load_dword v171, v166, s[8:11], s55 offen sc1
  v_mov_b32 v169, 0
  s_mov_b32 s66, 356352
  s_waitcnt vmcnt(0)
O_loop:
  v_mfma_f32_16x16x32_bf16 v[156:159], v[216:219], v[128:131], 0
  v_mfma_f32_16x16x32_bf16 v[160:163], v[220:223], v[128:131], 0
  v_mfma_f32_16x16x32_bf16 v[156:159], v[224:227], v[132:135], v[156:159]
  v_mfma_f32_16x16x32_bf16 v[160:163], v[228:231], v[132:135], v[160:163]
  v_mfma_f32_16x16x32_bf16 v[156:159], v[232:235], v[136:139], v[156:159]
  v_mfma_f32_16x16x32_bf16 v[160:163], v[236:239], v[136:139], v[160:163]
  v_mfma_f32_16x16x32_bf16 v[156:159], v[240:243], v[140:143], v[156:159]
  v_mfma_f32_16x16x32_bf16 v[160:163], v[244:247], v[140:143], v[160:163]
  v_mfma_f32_16x16x32_bf16 v[156:159], v[248:251], v[144:147], v[156:159]
  v_mfma_f32_16x16x32_bf16 v[160:163], v[252:255], v[144:147], v[160:163]
  s_mul_i32 s64, s59, 36864
  s_lshl_b32 s54, s70, 6
  s_add_u32 s64, s64, s54
  s_add_u32 s71, s59, 2
  s_lshl_b32 s55, s59, 18
  s_lshl_b32 s54, s52, 16
  s_add_u32 s55, s55, s54
  s_add_u32 s63, s55, 46137344
  s_and_b32 s54, s59, 1
  s_lshl_b32 s54, s54, 2
  s_add_u32 s54, s54, s52
  s_lshl_b32 s54, s54, 3
  s_lshl_b64 s[72:73], 0xff, s54
  v_sub_f32 v165, 1.0, v171
  v_cvt_pk_bf16_f32 v165, v165, v165
  v_lshlrev_b32 v165, 16, v165
  v_mul_f32 v156, v171, v156
  v_mul_f32 v157, v171, v157
  v_mul_f32 v158, v171, v158
  v_mul_f32 v159, v171, v159
  v_mul_f32 v160, v171, v160
  v_mul_f32 v161, v171, v161
  v_mul_f32 v162, v171, v162
  v_mul_f32 v163, v171, v163
  s_branch O_pc
O_pl:
  s_sleep 1
  buffer_load_dword v169, v208, s[8:11], s66 offen sc1
  s_add_u32 s65, s65, 1
  s_cmp_ge_u32 s65, 131072
  s_cbranch_scc1 O_ld
  s_waitcnt vmcnt(0)
O_pc:
  v_cmp_gt_u32 vcc, s71, v169
  s_nop 0
  s_and_b64 vcc, vcc, s[72:73]
  s_cbranch_scc1 O_pl
O_ld:
  s_mov_b32 s62, s63
  buffer_load_dword v173, v172, s[8:11], s63 offen sc1
  buffer_load_dwordx4 v[0:3], v164, s[8:11], s62 offen offset:0 sc1
  buffer_load_dwordx4 v[4:7], v164, s[8:11], s62 offen offset:2048 sc1
  s_add_u32 s62, s62, 4096
  buffer_load_dwordx4 v[8:11], v164, s[8:11], s62 offen offset:0 sc1
  buffer_load_dwordx4 v[12:15], v164, s[8:11], s62 offen offset:2048 sc1
  s_add_u32 s62, s62, 4096
  buffer_load_dwordx4 v[16:19], v164, s[8:11], s62 offen offset:0 sc1
  buffer_load_dwordx4 v[20:23], v164, s[8:11], s62 offen offset:2048 sc1
  s_add_u32 s62, s62, 4096
  buffer_load_dwordx4 v[24:27], v164, s[8:11], s62 offen offset:0 sc1
  buffer_load_dwordx4 v[28:31], v164, s[8:11], s62 offen offset:2048 sc1
  s_add_u32 s62, s62, 4096
  buffer_load_dwordx4 v[32:35], v164, s[8:11], s62 offen offset:0 sc1
  buffer_load_dwordx4 v[36:39], v164, s[8:11], s62 offen offset:2048 sc1
  s_add_u32 s62, s62, 4096
  buffer_load_dwordx4 v[40:43], v164, s[8:11], s62 offen offset:0 sc1
  buffer_load_dwordx4 v[44:47], v164, s[8:11], s62 offen offset:2048 sc1
  s_add_u32 s62, s62, 4096
  buffer_load_dwordx4 v[48:51], v164, s[8:11], s62 offen offset:0 sc1
  buffer_load_dwordx4 v[52:55], v164, s[8:11], s62 offen offset:2048 sc1
  s_add_u32 s62, s62, 4096
  buffer_load_dwordx4 v[56:59], v164, s[8:11], s62 offen offset:0 sc1
  buffer_load_dwordx4 v[60:63], v164, s[8:11], s62 offen offset:2048 sc1
  s_add_u32 s62, s62, 4096
  buffer_load_dwordx4 v[64:67], v164, s[8:11], s62 offen offset:0 sc1
  buffer_load_dwordx4 v[68:71], v164, s[8:11], s62 offen offset:2048 sc1
  s_add_u32 s62, s62, 4096
  buffer_load_dwordx4 v[72:75], v164, s[8:11], s62 offen offset:0 sc1
  buffer_load_dwordx4 v[76:79], v164, s[8:11], s62 offen offset:2048 sc1
  s_add_u32 s62, s62, 4096
  buffer_load_dwordx4 v[80:83], v164, s[8:11], s62 offen offset:0 sc1
  buffer_load_dwordx4 v[84:87], v164, s[8:11], s62 offen offset:2048 sc1
  s_add_u32 s62, s62, 4096
  buffer_load_dwordx4 v[88:91], v164, s[8:11], s62 offen offset:0 sc1
  buffer_load_dwordx4 v[92:95], v164, s[8:11], s62 offen offset:2048 sc1
  s_add_u32 s62, s62, 4096
  buffer_load_dwordx4 v[96:99], v164, s[8:11], s62 offen offset:0 sc1
  buffer_load_dwordx4 v[100:103], v164, s[8:11], s62 offen offset:2048 sc1
  s_add_u32 s62, s62, 4096
  buffer_load_dwordx4 v[104:107], v164, s[8:11], s62 offen offset:0 sc1
  buffer_load_dwordx4 v[108:111], v164, s[8:11], s62 offen offset:2048 sc1
  s_add_u32 s62, s62, 4096
  buffer_load_dwordx4 v[112:115], v164, s[8:11], s62 offen offset:0 sc1
  buffer_load_dwordx4 v[116:119], v164, s[8:11], s62 offen offset:2048 sc1
  s_add_u32 s62, s62, 4096
  buffer_load_dwordx4 v[120:123], v164, s[8:11], s62 offen offset:0 sc1
  buffer_load_dwordx4 v[124:127], v164, s[8:11], s62 offen offset:2048 sc1
  s_add_u32 s62, s62, 4096
  s_add_u32 s57, s59, 3
  s_min_u32 s74, s57, 63
  s_mul_i32 s55, s74, 36864
  s_mul_i32 s54, s52, 320
  s_add_u32 s55, s55, s54
  s_add_u32 s55, s55, 62914560
  s_cmp_eq_u32 s52, 3
  s_cselect_b32 s56, 268435456, s55
  buffer_load_dwordx4 v[128:131], v167, s[8:11], s55 offen offset:0 sc1
  buffer_load_dwordx4 v[132:135], v167, s[8:11], s55 offen offset:64 sc1
  buffer_load_dwordx4 v[136:139], v167, s[8:11], s55 offen offset:128 sc1
  buffer_load_dwordx4 v[140:143], v167, s[8:11], s56 offen offset:192 sc1
  buffer_load_dwordx4 v[144:147], v167, s[8:11], s56 offen offset:256 sc1
  s_lshl_b32 s55, s74, 7
  s_add_u32 s55, s55, 66060288
  buffer_load_dword v171, v166, s[8:11], s55 offen sc1
  s_add_u32 s65, s65, 1
  s_cmp_lt_u32 s65, 131072
  s_cselect_b32 s54, -2, -1
  s_waitcnt vmcnt(37)
  v_mfma_f32_16x16x32_bf16 v[148:151], a[0:3], v[0:3], 0
  v_mfma_f32_16x16x32_bf16 v[152:155], a[4:7], v[0:3], 0
  v_max3_u32 v170, v0, v1, v0
  v_max3_u32 v170, v2, v3, v170
  s_waitcnt vmcnt(36)
  v_mfma_f32_16x16x32_bf16 v[148:151], a[8:11], v[4:7], v[148:151]
  v_mfma_f32_16x16x32_bf16 v[152:155], a[12:15], v[4:7], v[152:155]
  v_max3_u32 v170, v4, v5, v170
  v_max3_u32 v170, v6, v7, v170
  s_waitcnt vmcnt(35)
  v_mfma_f32_16x16x32_bf16 v[148:151], a[16:19], v[8:11], v[148:151]
  v_mfma_f32_16x16x32_bf16 v[152:155], a[20:23], v[8:11], v[152:155]
  v_max3_u32 v170, v8, v9, v170
  v_max3_u32 v170, v10, v11, v170
  s_waitcnt vmcnt(34)
  v_mfma_f32_16x16x32_bf16 v[148:151], a[24:27], v[12:15], v[148:151]
  v_mfma_f32_16x16x32_bf16 v[152:155], a[28:31], v[12:15], v[152:155]
  v_max3_u32 v170, v12, v13, v170
  v_max3_u32 v170, v14, v15, v170
  s_waitcnt vmcnt(33)
  v_mfma_f32_16x16x32_bf16 v[148:151], a[32:35], v[16:19], v[148:151]
  v_mfma_f32_16x16x32_bf16 v[152:155], a[36:39], v[16:19], v[152:155]
  v_max3_u32 v170, v16, v17, v170
  v_max3_u32 v170, v18, v19, v170
  s_waitcnt vmcnt(32)
  v_mfma_f32_16x16x32_bf16 v[148:151], a[40:43], v[20:23], v[148:151]
  v_mfma_f32_16x16x32_bf16 v[152:155], a[44:47], v[20:23], v[152:155]
  v_max3_u32 v170, v20, v21, v170
  v_max3_u32 v170, v22, v23, v170
  s_waitcnt vmcnt(31)
  v_mfma_f32_16x16x32_bf16 v[148:151], a[48:51], v[24:27], v[148:151]
  v_mfma_f32_16x16x32_bf16 v[152:155], a[52:55], v[24:27], v[152:155]
  v_max3_u32 v170, v24, v25, v170
  v_max3_u32 v170, v26, v27, v170
  s_waitcnt vmcnt(30)
  v_mfma_f32_16x16x32_bf16 v[148:151], a[56:59], v[28:31], v[148:151]
  v_mfma_f32_16x16x32_bf16 v[152:155], a[60:63], v[28:31], v[152:155]
  v_max3_u32 v170, v28, v29, v170
  v_max3_u32 v170, v30, v31, v170
  s_waitcnt vmcnt(29)
  v_mfma_f32_16x16x32_bf16 v[148:151], a[64:67], v[32:35], v[148:151]
  v_mfma_f32_16x16x32_bf16 v[152:155], a[68:71], v[32:35], v[152:155]
  v_max3_u32 v170, v32, v33, v170
  v_max3_u32 v170, v34, v35, v170
  s_waitcnt vmcnt(28)
  v_mfma_f32_16x16x32_bf16 v[148:151], a[72:75], v[36:39], v[148:151]
  v_mfma_f32_16x16x32_bf16 v[152:155], a[76:79], v[36:39], v[152:155]
  v_max3_u32 v170, v36, v37, v170
  v_max3_u32 v170, v38, v39, v170
  s_waitcnt vmcnt(27)
  v_mfma_f32_16x16x32_bf16 v[148:151], a[80:83], v[40:43], v[148:151]
  v_mfma_f32_16x16x32_bf16 v[152:155], a[84:87], v[40:43], v[152:155]
  v_max3_u32 v170, v40, v41, v170
  v_max3_u32 v170, v42, v43, v170
  s_waitcnt vmcnt(26)
  v_mfma_f32_16x16x32_bf16 v[148:151], a[88:91], v[44:47], v[148:151]
  v_mfma_f32_16x16x32_bf16 v[152:155], a[92:95], v[44:47], v[152:155]
  v_max3_u32 v170, v44, v45, v170
  v_max3_u32 v170, v46, v47, v170
  s_waitcnt vmcnt(25)
  v_mfma_f32_16x16x32_bf16 v[148:151], a[96:99], v[48:51], v[148:151]
  v_mfma_f32_16x16x32_bf16 v[152:155], a[100:103], v[48:51], v[152:155]
  v_max3_u32 v170, v48, v49, v170
  v_max3_u32 v170, v50, v51, v170
  s_waitcnt vmcnt(24)
  v_mfma_f32_16x16x32_bf16 v[148:151], a[104:107], v[52:55], v[148:151]
  v_mfma_f32_16x16x32_bf16 v[152:155], a[108:111], v[52:55], v[152:155]
  v_max3_u32 v170, v52, v53, v170
  v_max3_u32 v170, v54, v55, v170
  s_waitcnt vmcnt(23)
  v_mfma_f32_16x16x32_bf16 v[148:151], a[112:115], v[56:59], v[148:151]
  v_mfma_f32_16x16x32_bf16 v[152:155], a[116:119], v[56:59], v[152:155]
  v_max3_u32 v170, v56, v57, v170
  v_max3_u32 v170, v58, v59, v170
  s_waitcnt vmcnt(22)
  v_mfma_f32_16x16x32_bf16 v[148:151], a[120:123], v[60:63], v[148:151]
  v_mfma_f32_16x16x32_bf16 v[152:155], a[124:127], v[60:63], v[152:155]
  v_max3_u32 v170, v60, v61, v170
  v_max3_u32 v170, v62, v63, v170
  s_waitcnt vmcnt(21)
  v_mfma_f32_16x16x32_bf16 v[148:151], a[128:131], v[64:67], v[148:151]
  v_mfma_f32_16x16x32_bf16 v[152:155], a[132:135], v[64:67], v[152:155]
  v_max3_u32 v170, v64, v65, v170
  v_max3_u32 v170, v66, v67, v170
  s_waitcnt vmcnt(20)
  v_mfma_f32_16x16x32_bf16 v[148:151], a[136:139], v[68:71], v[148:151]
  v_mfma_f32_16x16x32_bf16 v[152:155], a[140:143], v[68:71], v[152:155]
  v_max3_u32 v170, v68, v69, v170
  v_max3_u32 v170, v70, v71, v170
  s_waitcnt vmcnt(19)
  v_mfma_f32_16x16x32_bf16 v[148:151], a[144:147], v[72:75], v[148:151]
  v_mfma_f32_16x16x32_bf16 v[152:155], a[148:151], v[72:75], v[152:155]
  v_max3_u32 v170, v72, v73, v170
  v_max3_u32 v170, v74, v75, v170
  s_waitcnt vmcnt(18)
  v_mfma_f32_16x16x32_bf16 v[148:151], a[152:155], v[76:79], v[148:151]
  v_mfma_f32_16x16x32_bf16 v[152:155], a[156:159], v[76:79], v[152:155]
  v_max3_u32 v170, v76, v77, v170
  v_max3_u32 v170, v78, v79, v170
  s_waitcnt vmcnt(17)
  v_mfma_f32_16x16x32_bf16 v[148:151], a[160:163], v[80:83], v[148:151]
  v_mfma_f32_16x16x32_bf16 v[152:155], a[164:167], v[80:83], v[152:155]
  v_max3_u32 v170, v80, v81, v170
  v_max3_u32 v170, v82, v83, v170
  s_waitcnt vmcnt(16)
  v_mfma_f32_16x16x32_bf16 v[148:151], a[168:171], v[84:87], v[148:151]
  v_mfma_f32_16x16x32_bf16 v[152:155], a[172:175], v[84:87], v[152:155]
  v_max3_u32 v170, v84, v85, v170
  v_max3_u32 v170, v86, v87, v170
  s_waitcnt vmcnt(15)
  v_mfma_f32_16x16x32_bf16 v[148:151], a[176:179], v[88:91], v[148:151]
  v_mfma_f32_16x16x32_bf16 v[152:155], a[180:183], v[88:91], v[152:155]
  v_max3_u32 v170, v88, v89, v170
  v_max3_u32 v170, v90, v91, v170
  s_waitcnt vmcnt(14)
  v_mfma_f32_16x16x32_bf16 v[148:151], a[184:187], v[92:95], v[148:151]
  v_mfma_f32_16x16x32_bf16 v[152:155], a[188:191], v[92:95], v[152:155]
  v_max3_u32 v170, v92, v93, v170
  v_max3_u32 v170, v94, v95, v170
  s_waitcnt vmcnt(13)
  v_mfma_f32_16x16x32_bf16 v[148:151], a[192:195], v[96:99], v[148:151]
  v_mfma_f32_16x16x32_bf16 v[152:155], a[196:199], v[96:99], v[152:155]
  v_max3_u32 v170, v96, v97, v170
  v_max3_u32 v170, v98, v99, v170
  s_waitcnt vmcnt(12)
  v_mfma_f32_16x16x32_bf16 v[148:151], a[200:203], v[100:103], v[148:151]
  v_mfma_f32_16x16x32_bf16 v[152:155], a[204:207], v[100:103], v[152:155]
  v_max3_u32 v170, v100, v101, v170
  v_max3_u32 v170, v102, v103, v170
  s_waitcnt vmcnt(11)
  v_mfma_f32_16x16x32_bf16 v[148:151], a[208:211], v[104:107], v[148:151]
  v_mfma_f32_16x16x32_bf16 v[152:155], a[212:215], v[104:107], v[152:155]
  v_max3_u32 v170, v104, v105, v170
  v_max3_u32 v170, v106, v107, v170
  s_waitcnt vmcnt(10)
  v_mfma_f32_16x16x32_bf16 v[148:151], a[216:219], v[108:111], v[148:151]
  v_mfma_f32_16x16x32_bf16 v[152:155], a[220:223], v[108:111], v[152:155]
  v_max3_u32 v170, v108, v109, v170
  v_max3_u32 v170, v110, v111, v170
  s_waitcnt vmcnt(9)
  v_mfma_f32_16x16x32_bf16 v[148:151], a[224:227], v[112:115], v[148:151]
  v_mfma_f32_16x16x32_bf16 v[152:155], a[228:231], v[112:115], v[152:155]
  v_max3_u32 v170, v112, v113, v170
  v_max3_u32 v170, v114, v115, v170
  s_waitcnt vmcnt(8)
  v_mfma_f32_16x16x32_bf16 v[148:151], a[232:235], v[116:119], v[148:151]
  v_mfma_f32_16x16x32_bf16 v[152:155], a[236:239], v[116:119], v[152:155]
  v_max3_u32 v170, v116, v117, v170
  v_max3_u32 v170, v118, v119, v170
  s_waitcnt vmcnt(7)
  v_mfma_f32_16x16x32_bf16 v[148:151], a[240:243], v[120:123], v[148:151]
  v_mfma_f32_16x16x32_bf16 v[152:155], a[244:247], v[120:123], v[152:155]
  v_max3_u32 v170, v120, v121, v170
  v_max3_u32 v170, v122, v123, v170
  s_waitcnt vmcnt(6)
  v_mfma_f32_16x16x32_bf16 v[148:151], a[248:251], v[124:127], v[148:151]
  v_mfma_f32_16x16x32_bf16 v[152:155], a[252:255], v[124:127], v[152:155]
  v_max3_u32 v170, v124, v125, v170
  v_max3_u32 v170, v126, v127, v170
  v_cmp_lt_u32 vcc, s54, v170
  s_cbranch_vccnz O_ld
  v_fmac_f32 v156, v165, v148
  v_fmac_f32 v157, v165, v149
  v_fmac_f32 v158, v165, v150
  v_fmac_f32 v159, v165, v151
  v_fmac_f32 v160, v165, v152
  v_fmac_f32 v161, v165, v153
  v_fmac_f32 v162, v165, v154
  v_fmac_f32 v163, v165, v155
  ds_write_b128 v168, v[156:159]
  ds_write_b128 v168, v[160:163] offset:1024
  v_xor_b32 v168, 0x2000, v168
  s_mov_b32 s59, s57
  s_waitcnt lgkmcnt(0)
  s_barrier
  s_cmp_eq_u32 s52, 0
  s_cbranch_scc0 O_next
  v_xor_b32 v211, 0x2000, v168
  ds_read_b128 v[0:3], v211 offset:2048
  ds_read_b128 v[4:7], v211 offset:3072
  ds_read_b128 v[8:11], v211 offset:4096
  ds_read_b128 v[12:15], v211 offset:5120
  ds_read_b128 v[16:19], v211 offset:6144
  ds_read_b128 v[20:23], v211 offset:7168
  s_waitcnt lgkmcnt(5)
  v_add_f32 v156, v156, v0
  v_add_f32 v157, v157, v1
  v_add_f32 v158, v158, v2
  v_add_f32 v159, v159, v3
  s_waitcnt lgkmcnt(4)
  v_add_f32 v160, v160, v4
  v_add_f32 v161, v161, v5
  v_add_f32 v162, v162, v6
  v_add_f32 v163, v163, v7
  s_waitcnt lgkmcnt(3)
  v_add_f32 v156, v156, v8
  v_add_f32 v157, v157, v9
  v_add_f32 v158, v158, v10
  v_add_f32 v159, v159, v11
  s_waitcnt lgkmcnt(2)
  v_add_f32 v160, v160, v12
  v_add_f32 v161, v161, v13
  v_add_f32 v162, v162, v14
  v_add_f32 v163, v163, v15
  s_waitcnt lgkmcnt(1)
  v_add_f32 v156, v156, v16
  v_add_f32 v157, v157, v17
  v_add_f32 v158, v158, v18
  v_add_f32 v159, v159, v19
  s_waitcnt lgkmcnt(0)
  v_add_f32 v160, v160, v20
  v_add_f32 v161, v161, v21
  v_add_f32 v162, v162, v22
  v_add_f32 v163, v163, v23
  v_cvt_pk_bf16_f32 v148, v156, v157
  v_cvt_pk_bf16_f32 v149, v158, v159
  v_cvt_pk_bf16_f32 v150, v160, v161
  v_cvt_pk_bf16_f32 v151, v162, v163
  buffer_store_dwordx4 v[148:151], v167, s[48:51], s64 offen
  s_waitcnt vmcnt(1)
  s_branch O_nx2
O_next:
  s_waitcnt vmcnt(0)
O_nx2:
  s_cmp_lt_u32 s59, 64
  s_cbranch_scc1 O_loop
  s_branch L_exit
W_h:
  s_lshr_b32 s58, s53, 1
  s_and_b32 s59, s53, 1
  s_mul_i32 s60, s59, 36864
  s_add_u32 m0, s67, 0
  s_nop 0
  buffer_load_dwordx4 v202, s[4:7], s60 offen offset:0 lds
  s_add_u32 m0, s67, 896
  s_nop 0
  buffer_load_dwordx4 v202, s[4:7], s60 offen offset:128 lds
  s_add_u32 m0, s67, 1792
  s_nop 0
  buffer_load_dwordx4 v202, s[4:7], s60 offen offset:256 lds
  s_add_u32 m0, s67, 2688
  s_nop 0
  buffer_load_dwordx4 v202, s[4:7], s60 offen offset:384 lds
  s_add_u32 m0, s67, 3584
  s_nop 0
  buffer_load_dwordx4 v202, s[4:7], s60 offen offset:512 lds
  s_add_u32 m0, s67, 4480
  s_nop 0
  buffer_load_dwordx4 v202, s[4:7], s60 offen offset:640 lds
  s_add_u32 m0, s67, 5376
  s_nop 0
  buffer_load_dwordx4 v202, s[4:7], s60 offen offset:768 lds
  s_add_u32 m0, s67, 6272
  s_nop 0
  buffer_load_dwordx4 v202, s[4:7], s60 offen offset:896 lds
  s_add_u32 m0, s67, 7168
  s_nop 0
  buffer_load_dwordx4 v202, s[4:7], s60 offen offset:1024 lds
  v_lshrrev_b32 v211, 4, v200
  v_lshlrev_b32 v212, 2, v211
  v_and_b32 v213, 15, v200
  v_xor_b32 v212, v212, v213
  v_lshlrev_b32 v212, 4, v212
  v_lshl_add_u32 v207, v211, 13, v212
  s_lshl_b32 s62, s58, 8
  s_lshl_b32 s54, s52, 15
  s_add_u32 s62, s62, s54
  s_lshl_b32 s61, s52, 10
  s_add_u32 s61, s61, 36864
  s_add_u32 m0, s61, 0
  s_add_u32 s54, s62, 0
  buffer_load_dwordx4 v207, s[16:19], s54 offen lds
  s_add_u32 m0, s61, 4096
  s_add_u32 s54, s62, 131072
  buffer_load_dwordx4 v207, s[16:19], s54 offen lds
  s_add_u32 m0, s61, 8192
  s_add_u32 s54, s62, 262144
  buffer_load_dwordx4 v207, s[16:19], s54 offen lds
  s_add_u32 m0, s61, 12288
  s_add_u32 s54, s62, 393216
  buffer_load_dwordx4 v207, s[16:19], s54 offen lds
  s_add_u32 m0, s61, 16384
  s_add_u32 s54, s62, 524288
  buffer_load_dwordx4 v207, s[16:19], s54 offen lds
  s_add_u32 m0, s61, 20480
  s_add_u32 s54, s62, 655360
  buffer_load_dwordx4 v207, s[16:19], s54 offen lds
  s_add_u32 m0, s61, 24576
  s_add_u32 s54, s62, 786432
  buffer_load_dwordx4 v207, s[16:19], s54 offen lds
  s_add_u32 m0, s61, 28672
  s_add_u32 s54, s62, 917504
  buffer_load_dwordx4 v207, s[16:19], s54 offen lds
  s_add_u32 m0, s61, 32768
  s_add_u32 s54, s62, 1048576
  buffer_load_dwordx4 v207, s[16:19], s54 offen lds
  s_add_u32 m0, s61, 36864
  s_add_u32 s54, s62, 1179648
  buffer_load_dwordx4 v207, s[16:19], s54 offen lds
  s_add_u32 m0, s61, 40960
  s_add_u32 s54, s62, 1310720
  buffer_load_dwordx4 v207, s[16:19], s54 offen lds
  s_add_u32 m0, s61, 45056
  s_add_u32 s54, s62, 1441792
  buffer_load_dwordx4 v207, s[16:19], s54 offen lds
  s_add_u32 m0, s61, 49152
  s_add_u32 s54, s62, 1572864
  buffer_load_dwordx4 v207, s[16:19], s54 offen lds
  s_add_u32 m0, s61, 53248
  s_add_u32 s54, s62, 1703936
  buffer_load_dwordx4 v207, s[16:19], s54 offen lds
  s_add_u32 m0, s61, 57344
  s_add_u32 s54, s62, 1835008
  buffer_load_dwordx4 v207, s[16:19], s54 offen lds
  s_add_u32 m0, s61, 61440
  s_add_u32 s54, s62, 1966080
  buffer_load_dwordx4 v207, s[16:19], s54 offen lds
  s_add_u32 m0, s61, 65536
  s_add_u32 s54, s62, 2097152
  buffer_load_dwordx4 v207, s[16:19], s54 offen lds
  s_add_u32 m0, s61, 69632
  s_add_u32 s54, s62, 2228224
  buffer_load_dwordx4 v207, s[16:19], s54 offen lds
  s_add_u32 m0, s61, 73728
  s_add_u32 s54, s62, 2359296
  buffer_load_dwordx4 v207, s[16:19], s54 offen lds
  s_add_u32 m0, s61, 77824
  s_add_u32 s54, s62, 2490368
  buffer_load_dwordx4 v207, s[16:19], s54 offen lds
  s_add_u32 m0, s61, 81920
  s_add_u32 s54, s62, 2621440
  buffer_load_dwordx4 v207, s[16:19], s54 offen lds
  s_add_u32 m0, s61, 86016
  s_add_u32 s54, s62, 2752512
  buffer_load_dwordx4 v207, s[16:19], s54 offen lds
  s_add_u32 m0, s61, 90112
  s_add_u32 s54, s62, 2883584
  buffer_load_dwordx4 v207, s[16:19], s54 offen lds
  s_add_u32 m0, s61, 94208
  s_add_u32 s54, s62, 3014656
  buffer_load_dwordx4 v207, s[16:19], s54 offen lds
  s_waitcnt vmcnt(20) lgkmcnt(0)
  s_barrier
  s_add_u32 m0, s61, 98304
  s_add_u32 s54, s62, 3145728
  buffer_load_dwordx4 v207, s[16:19], s54 offen lds
  s_add_u32 m0, s61, 102400
  s_add_u32 s54, s62, 3276800
  buffer_load_dwordx4 v207, s[16:19], s54 offen lds
  s_add_u32 m0, s61, 106496
  s_add_u32 s54, s62, 3407872
  buffer_load_dwordx4 v207, s[16:19], s54 offen lds
  s_add_u32 m0, s61, 110592
  s_add_u32 s54, s62, 3538944
  buffer_load_dwordx4 v207, s[16:19], s54 offen lds
  v_add_u32 v215, 36864, v209
  ds_read_b64_tr_b16 a[0:1], v215 offset:0
  ds_read_b64_tr_b16 a[2:3], v215 offset:1024
  ds_read_b64_tr_b16 a[4:5], v215 offset:4096
  ds_read_b64_tr_b16 a[6:7], v215 offset:5120
  ds_read_b64_tr_b16 a[8:9], v215 offset:8192
  ds_read_b64_tr_b16 a[10:11], v215 offset:9216
  ds_read_b64_tr_b16 a[12:13], v215 offset:12288
  ds_read_b64_tr_b16 a[14:15], v215 offset:13312
  s_waitcnt vmcnt(20) lgkmcnt(0)
  s_barrier
  s_add_u32 m0, s61, 0
  s_add_u32 s54, s62, 3670016
  buffer_load_dwordx4 v207, s[16:19], s54 offen lds
  s_add_u32 m0, s61, 4096
  s_add_u32 s54, s62, 3801088
  buffer_load_dwordx4 v207, s[16:19], s54 offen lds
  s_add_u32 m0, s61, 8192
  s_add_u32 s54, s62, 3932160
  buffer_load_dwordx4 v207, s[16:19], s54 offen lds
  s_add_u32 m0, s61, 12288
  s_add_u32 s54, s62, 4063232
  buffer_load_dwordx4 v207, s[16:19], s54 offen lds
  v_add_u32 v215, 53248, v209
  ds_read_b64_tr_b16 a[16:17], v215 offset:0
  ds_read_b64_tr_b16 a[18:19], v215 offset:1024
  ds_read_b64_tr_b16 a[20:21], v215 offset:4096
  ds_read_b64_tr_b16 a[22:23], v215 offset:5120
  ds_read_b64_tr_b16 a[24:25], v215 offset:8192
  ds_read_b64_tr_b16 a[26:27], v215 offset:9216
  ds_read_b64_tr_b16 a[28:29], v215 offset:12288
  ds_read_b64_tr_b16 a[30:31], v215 offset:13312
  s_waitcnt vmcnt(20) lgkmcnt(0)
  s_barrier
  s_add_u32 m0, s61, 16384
  s_add_u32 s54, s62, 4194304
  buffer_load_dwordx4 v207, s[16:19], s54 offen lds
  s_add_u32 m0, s61, 20480
  s_add_u32 s54, s62, 4325376
  buffer_load_dwordx4 v207, s[16:19], s54 offen lds
  s_add_u32 m0, s61, 24576
  s_add_u32 s54, s62, 4456448
  buffer_load_dwordx4 v207, s[16:19], s54 offen lds
  s_add_u32 m0, s61, 28672
  s_add_u32 s54, s62, 4587520
  buffer_load_dwordx4 v207, s[16:19], s54 offen lds
  v_add_u32 v215, 69632, v209
  ds_read_b64_tr_b16 a[32:33], v215 offset:0
  ds_read_b64_tr_b16 a[34:35], v215 offset:1024
  ds_read_b64_tr_b16 a[36:37], v215 offset:4096
  ds_read_b64_tr_b16 a[38:39], v215 offset:5120
  ds_read_b64_tr_b16 a[40:41], v215 offset:8192
  ds_read_b64_tr_b16 a[42:43], v215 offset:9216
  ds_read_b64_tr_b16 a[44:45], v215 offset:12288
  ds_read_b64_tr_b16 a[46:47], v215 offset:13312
  s_waitcnt vmcnt(20) lgkmcnt(0)
  s_barrier
  v_add_u32 v215, 86016, v209
  ds_read_b64_tr_b16 a[48:49], v215 offset:0
  ds_read_b64_tr_b16 a[50:51], v215 offset:1024
  ds_read_b64_tr_b16 a[52:53], v215 offset:4096
  ds_read_b64_tr_b16 a[54:55], v215 offset:5120
  ds_read_b64_tr_b16 a[56:57], v215 offset:8192
  ds_read_b64_tr_b16 a[58:59], v215 offset:9216
  ds_read_b64_tr_b16 a[60:61], v215 offset:12288
  ds_read_b64_tr_b16 a[62:63], v215 offset:13312
  s_waitcnt vmcnt(16) lgkmcnt(0)
  s_barrier
  v_add_u32 v215, 102400, v209
  ds_read_b64_tr_b16 a[64:65], v215 offset:0
  ds_read_b64_tr_b16 a[66:67], v215 offset:1024
  ds_read_b64_tr_b16 a[68:69], v215 offset:4096
  ds_read_b64_tr_b16 a[70:71], v215 offset:5120
  ds_read_b64_tr_b16 a[72:73], v215 offset:8192
  ds_read_b64_tr_b16 a[74:75], v215 offset:9216
  ds_read_b64_tr_b16 a[76:77], v215 offset:12288
  ds_read_b64_tr_b16 a[78:79], v215 offset:13312
  s_waitcnt vmcnt(12) lgkmcnt(0)
  s_barrier
  v_add_u32 v215, 118784, v209
  ds_read_b64_tr_b16 a[80:81], v215 offset:0
  ds_read_b64_tr_b16 a[82:83], v215 offset:1024
  ds_read_b64_tr_b16 a[84:85], v215 offset:4096
  ds_read_b64_tr_b16 a[86:87], v215 offset:5120
  ds_read_b64_tr_b16 a[88:89], v215 offset:8192
  ds_read_b64_tr_b16 a[90:91], v215 offset:9216
  ds_read_b64_tr_b16 a[92:93], v215 offset:12288
  ds_read_b64_tr_b16 a[94:95], v215 offset:13312
  s_waitcnt vmcnt(8) lgkmcnt(0)
  s_barrier
  v_add_u32 v215, 135168, v209
  ds_read_b64_tr_b16 a[96:97], v215 offset:0
  ds_read_b64_tr_b16 a[98:99], v215 offset:1024
  ds_read_b64_tr_b16 a[100:101], v215 offset:4096
  ds_read_b64_tr_b16 a[102:103], v215 offset:5120
  ds_read_b64_tr_b16 a[104:105], v215 offset:8192
  ds_read_b64_tr_b16 a[106:107], v215 offset:9216
  ds_read_b64_tr_b16 a[108:109], v215 offset:12288
  ds_read_b64_tr_b16 a[110:111], v215 offset:13312
  s_waitcnt vmcnt(4) lgkmcnt(0)
  s_barrier
  v_add_u32 v215, 36864, v209
  ds_read_b64_tr_b16 a[112:113], v215 offset:0
  ds_read_b64_tr_b16 a[114:115], v215 offset:1024
  ds_read_b64_tr_b16 a[116:117], v215 offset:4096
  ds_read_b64_tr_b16 a[118:119], v215 offset:5120
  ds_read_b64_tr_b16 a[120:121], v215 offset:8192
  ds_read_b64_tr_b16 a[122:123], v215 offset:9216
  ds_read_b64_tr_b16 a[124:125], v215 offset:12288
  ds_read_b64_tr_b16 a[126:127], v215 offset:13312
  s_waitcnt vmcnt(0) lgkmcnt(0)
  s_barrier
  v_add_u32 v215, 53248, v209
  ds_read_b64_tr_b16 a[128:129], v215 offset:0
  ds_read_b64_tr_b16 a[130:131], v215 offset:1024
  ds_read_b64_tr_b16 a[132:133], v215 offset:4096
  ds_read_b64_tr_b16 a[134:135], v215 offset:5120
  ds_read_b64_tr_b16 a[136:137], v215 offset:8192
  ds_read_b64_tr_b16 a[138:139], v215 offset:9216
  ds_read_b64_tr_b16 a[140:141], v215 offset:12288
  ds_read_b64_tr_b16 a[142:143], v215 offset:13312
  s_waitcnt lgkmcnt(0)
  s_barrier
  v_and_b32 v211, 31, v200
  v_lshrrev_b32 v212, 5, v200
  v_lshlrev_b32 v213, 2, v212
  v_sub_u32 v211, v211, v213
  v_mov_b32 v214, 0xf149f2ca
  v_cmp_gt_i32 vcc, 0, v211
  s_nop 1
  v_cndmask_b32 v48, 0, v214, vcc
  v_cmp_gt_i32 vcc, 1, v211
  s_nop 1
  v_cndmask_b32 v49, 0, v214, vcc
  v_cmp_gt_i32 vcc, 2, v211
  s_nop 1
  v_cndmask_b32 v50, 0, v214, vcc
  v_cmp_gt_i32 vcc, 3, v211
  s_nop 1
  v_cndmask_b32 v51, 0, v214, vcc
  v_cmp_gt_i32 vcc, 8, v211
  s_nop 1
  v_cndmask_b32 v52, 0, v214, vcc
  v_cmp_gt_i32 vcc, 9, v211
  s_nop 1
  v_cndmask_b32 v53, 0, v214, vcc
  v_cmp_gt_i32 vcc, 10, v211
  s_nop 1
  v_cndmask_b32 v54, 0, v214, vcc
  v_cmp_gt_i32 vcc, 11, v211
  s_nop 1
  v_cndmask_b32 v55, 0, v214, vcc
  v_cmp_gt_i32 vcc, 16, v211
  s_nop 1
  v_cndmask_b32 v56, 0, v214, vcc
  v_cmp_gt_i32 vcc, 17, v211
  s_nop 1
  v_cndmask_b32 v57, 0, v214, vcc
  v_cmp_gt_i32 vcc, 18, v211
  s_nop 1
  v_cndmask_b32 v58, 0, v214, vcc
  v_cmp_gt_i32 vcc, 19, v211
  s_nop 1
  v_cndmask_b32 v59, 0, v214, vcc
  v_cmp_gt_i32 vcc, 24, v211
  s_nop 1
  v_cndmask_b32 v60, 0, v214, vcc
  v_cmp_gt_i32 vcc, 25, v211
  s_nop 1
  v_cndmask_b32 v61, 0, v214, vcc
  v_cmp_gt_i32 vcc, 26, v211
  s_nop 1
  v_cndmask_b32 v62, 0, v214, vcc
  v_cmp_gt_i32 vcc, 27, v211
  s_nop 1
  v_cndmask_b32 v63, 0, v214, vcc
  v_and_b32 v218, 0xff, v216
  v_add_u32 v218, 81920, v218
  v_and_b32 v211, 15, v200
  v_lshl_add_u32 v211, v212, 5, v211
  v_lshlrev_b32 v219, 3, v211
  v_bfe_u32 v211, v200, 4, 1
  v_lshl_add_u32 v219, v211, 2, v219
  s_lshl_b32 s54, s52, 9
  s_add_u32 s54, s54, 83968
  v_add_u32 v219, s54, v219
  v_lshl_add_u32 v221, v200, 3, s54
  s_lshr_b32 s54, s52, 1
  s_lshl_b32 s54, s54, 10
  s_and_b32 s55, s52, 1
  s_lshl_b32 s55, s55, 3
  s_add_u32 s54, s54, s55
  s_add_u32 s54, s54, 81920
  v_add_u32 v220, s54, v201
  s_lshl_b32 s54, s52, 11
  s_add_u32 s54, s54, 73728
  v_add_u32 v215, s54, v201
  v_add_u32 v208, 73728, v201
  s_mov_b32 s68, 1040356334
  s_cmp_eq_u32 s52, 0
  s_cselect_b32 s71, s71, 268435456
  s_lshl_b32 s56, s58, 2
  s_add_u32 s56, s56, 128
  v_mov_b32 v176, -1
  v_mov_b32 v177, -1
  v_mov_b32 v178, -1
  v_mov_b32 v179, -1
  s_cmp_eq_u32 s52, 0
  s_cbranch_scc0 AT_p1_d
  s_mov_b32 exec_hi, 0
  s_mov_b32 exec_lo, 1
AT_p1:
  buffer_load_dword v211, v201, s[12:15], s56 offen sc1
  s_add_u32 s65, s65, 1
  s_waitcnt vmcnt(0)
  v_cmp_gt_u32 vcc, 0x700, v211
  s_cbranch_vccz AT_p1_x
  s_sleep 8
  s_cmp_lt_u32 s65, 131072
  s_cbranch_scc1 AT_p1
AT_p1_x:
  s_mov_b64 exec, -1
AT_p1_d:
  s_barrier
  s_mov_b32 s74, s59
  s_mul_i32 s66, s59, 655360
  s_lshl_b32 s55, s58, 14
  s_add_u32 s55, s55, s66
  s_add_u32 s55, s55, 1048576
  s_lshl_b32 s73, s58, 2
  s_add_u32 s73, s73, s52
  s_lshl_b32 s72, s59, 7
  s_add_u32 s72, s72, s73
  s_lshl_b32 s72, s72, 11
  s_add_u32 s72, s72, 46137344
  s_lshl_b32 s73, s73, 10
  s_add_u32 s73, s73, s66
  s_add_u32 s73, s73, 1572864
  s_add_u32 s59, s59, 2
  buffer_load_dwordx4 v[128:131], v216, s[8:11], s55 offen offset:0 sc1
  buffer_load_dwordx4 v[132:135], v216, s[8:11], s55 offen offset:256 sc1
  buffer_load_dwordx4 v[136:139], v216, s[8:11], s55 offen offset:512 sc1
  buffer_load_dwordx4 v[140:143], v216, s[8:11], s55 offen offset:768 sc1
  buffer_load_dwordx4 v[144:147], v216, s[8:11], s55 offen offset:1024 sc1
  buffer_load_dwordx4 v[148:151], v216, s[8:11], s55 offen offset:1280 sc1
  buffer_load_dwordx4 v[152:155], v216, s[8:11], s55 offen offset:1536 sc1
  buffer_load_dwordx4 v[156:159], v216, s[8:11], s55 offen offset:1792 sc1
  buffer_load_dwordx4 v[160:163], v217, s[8:11], s55 offen offset:0 sc1
  buffer_load_dwordx4 v[164:167], v217, s[8:11], s55 offen offset:256 sc1
  s_add_u32 s60, s60, 73728
  ds_read_b128 v[32:35], v203 offset:0
  ds_read_b128 v[36:39], v204 offset:0
  ds_read_b128 v[40:43], v205 offset:0
  s_waitcnt lgkmcnt(2)
  v_mfma_f32_32x32x16_bf16 v[240:255], a[0:3], v[32:35], 0
  ds_read_b128 v[44:47], v206 offset:0
  s_add_u32 m0, s67, 36864
  s_nop 0
  buffer_load_dwordx4 v202, s[4:7], s60 offen offset:0 lds
  s_waitcnt lgkmcnt(2)
  v_mfma_f32_32x32x16_bf16 v[240:255], a[4:7], v[36:39], v[240:255]
  ds_read_b128 v[32:35], v203 offset:1024
  s_waitcnt lgkmcnt(2)
  v_mfma_f32_32x32x16_bf16 v[240:255], a[8:11], v[40:43], v[240:255]
  ds_read_b128 v[36:39], v204 offset:1024
  s_add_u32 m0, s67, 37760
  s_nop 0
  buffer_load_dwordx4 v202, s[4:7], s60 offen offset:128 lds
  s_waitcnt lgkmcnt(2)
  v_mfma_f32_32x32x16_bf16 v[240:255], a[12:15], v[44:47], v[240:255]
  ds_read_b128 v[40:43], v205 offset:1024
  s_waitcnt lgkmcnt(2)
  v_mfma_f32_32x32x16_bf16 v[240:255], a[16:19], v[32:35], v[240:255]
  ds_read_b128 v[44:47], v206 offset:1024
  s_add_u32 m0, s67, 38656
  s_nop 0
  buffer_load_dwordx4 v202, s[4:7], s60 offen offset:256 lds
  s_waitcnt lgkmcnt(2)
  v_mfma_f32_32x32x16_bf16 v[240:255], a[20:23], v[36:39], v[240:255]
  ds_read_b128 v[32:35], v203 offset:2048
  s_waitcnt lgkmcnt(2)
  v_mfma_f32_32x32x16_bf16 v[240:255], a[24:27], v[40:43], v[240:255]
  ds_read_b128 v[36:39], v204 offset:2048
  s_add_u32 m0, s67, 39552
  s_nop 0
  buffer_load_dwordx4 v202, s[4:7], s60 offen offset:384 lds
  s_waitcnt lgkmcnt(2)
  v_mfma_f32_32x32x16_bf16 v[240:255], a[28:31], v[44:47], v[240:255]
  ds_read_b128 v[40:43], v205 offset:2048
  s_waitcnt lgkmcnt(2)
  v_mfma_f32_32x32x16_bf16 v[240:255], a[32:35], v[32:35], v[240:255]
  ds_read_b128 v[44:47], v206 offset:2048
  s_add_u32 m0, s67, 40448
  s_nop 0
  buffer_load_dwordx4 v202, s[4:7], s60 offen offset:512 lds
  s_waitcnt lgkmcnt(2)
  v_mfma_f32_32x32x16_bf16 v[240:255], a[36:39], v[36:39], v[240:255]
  ds_read_b128 v[32:35], v203 offset:3072
  s_waitcnt lgkmcnt(2)
  v_mfma_f32_32x32x16_bf16 v[240:255], a[40:43], v[40:43], v[240:255]
  ds_read_b128 v[36:39], v204 offset:3072
  s_add_u32 m0, s67, 41344
  s_nop 0
  buffer_load_dwordx4 v202, s[4:7], s60 offen offset:640 lds
  s_waitcnt lgkmcnt(2)
  v_mfma_f32_32x32x16_bf16 v[240:255], a[44:47], v[44:47], v[240:255]
  ds_read_b128 v[40:43], v205 offset:3072
  s_waitcnt lgkmcnt(2)
  v_mfma_f32_32x32x16_bf16 v[240:255], a[48:51], v[32:35], v[240:255]
  ds_read_b128 v[44:47], v206 offset:3072
  s_add_u32 m0, s67, 42240
  s_nop 0
  buffer_load_dwordx4 v202, s[4:7], s60 offen offset:768 lds
  s_waitcnt lgkmcnt(2)
  v_mfma_f32_32x32x16_bf16 v[240:255], a[52:55], v[36:39], v[240:255]
  ds_read_b128 v[32:35], v203 offset:4096
  s_waitcnt lgkmcnt(2)
  v_mfma_f32_32x32x16_bf16 v[240:255], a[56:59], v[40:43], v[240:255]
  ds_read_b128 v[36:39], v204 offset:4096
  s_add_u32 m0, s67, 43136
  s_nop 0
  buffer_load_dwordx4 v202, s[4:7], s60 offen offset:896 lds
  s_waitcnt lgkmcnt(2)
  v_mfma_f32_32x32x16_bf16 v[240:255], a[60:63], v[44:47], v[240:255]
  ds_read_b128 v[40:43], v205 offset:4096
  s_waitcnt lgkmcnt(2)
  v_mfma_f32_32x32x16_bf16 v[240:255], a[64:67], v[32:35], v[240:255]
  ds_read_b128 v[44:47], v206 offset:4096
  s_add_u32 m0, s67, 44032
  s_nop 0
  buffer_load_dwordx4 v202, s[4:7], s60 offen offset:1024 lds
  s_waitcnt lgkmcnt(2)
  v_mfma_f32_32x32x16_bf16 v[240:255], a[68:71], v[36:39], v[240:255]
  ds_read_b128 v[32:35], v203 offset:5120
  s_waitcnt lgkmcnt(2)
  v_mfma_f32_32x32x16_bf16 v[240:255], a[72:75], v[40:43], v[240:255]
  ds_read_b128 v[36:39], v204 offset:5120
  buffer_store_dwordx4 v[176:179], v201, s[8:11], s72 offen offset:0 sc1
  s_waitcnt lgkmcnt(2)
  v_mfma_f32_32x32x16_bf16 v[240:255], a[76:79], v[44:47], v[240:255]
  ds_read_b128 v[40:43], v205 offset:5120
  s_waitcnt lgkmcnt(2)
  v_mfma_f32_32x32x16_bf16 v[240:255], a[80:83], v[32:35], v[240:255]
  ds_read_b128 v[44:47], v206 offset:5120
  buffer_store_dwordx4 v[176:179], v201, s[8:11], s72 offen offset:1024 sc1
  s_waitcnt lgkmcnt(2)
  v_mfma_f32_32x32x16_bf16 v[240:255], a[84:87], v[36:39], v[240:255]
  ds_read_b128 v[32:35], v203 offset:6144
  s_waitcnt lgkmcnt(2)
  v_mfma_f32_32x32x16_bf16 v[240:255], a[88:91], v[40:43], v[240:255]
  ds_read_b128 v[36:39], v204 offset:6144
  s_waitcnt lgkmcnt(2)
  v_mfma_f32_32x32x16_bf16 v[240:255], a[92:95], v[44:47], v[240:255]
  ds_read_b128 v[40:43], v205 offset:6144
  s_waitcnt lgkmcnt(2)
  v_mfma_f32_32x32x16_bf16 v[240:255], a[96:99], v[32:35], v[240:255]
  ds_read_b128 v[44:47], v206 offset:6144
  s_waitcnt lgkmcnt(2)
  v_mfma_f32_32x32x16_bf16 v[240:255], a[100:103], v[36:39], v[240:255]
  ds_read_b128 v[32:35], v203 offset:7168
  s_waitcnt lgkmcnt(2)
  v_mfma_f32_32x32x16_bf16 v[240:255], a[104:107], v[40:43], v[240:255]
  ds_read_b128 v[36:39], v204 offset:7168
  s_waitcnt lgkmcnt(2)
  v_mfma_f32_32x32x16_bf16 v[240:255], a[108:111], v[44:47], v[240:255]
  ds_read_b128 v[40:43], v205 offset:7168
  s_waitcnt lgkmcnt(2)
  v_mfma_f32_32x32x16_bf16 v[240:255], a[112:115], v[32:35], v[240:255]
  ds_read_b128 v[44:47], v206 offset:7168
  s_waitcnt lgkmcnt(2)
  v_mfma_f32_32x32x16_bf16 v[240:255], a[116:119], v[36:39], v[240:255]
  ds_read_b128 v[32:35], v203 offset:8192
  s_waitcnt lgkmcnt(2)
  v_mfma_f32_32x32x16_bf16 v[240:255], a[120:123], v[40:43], v[240:255]
  ds_read_b128 v[36:39], v204 offset:8192
  s_waitcnt lgkmcnt(2)
  v_mfma_f32_32x32x16_bf16 v[240:255], a[124:127], v[44:47], v[240:255]
  ds_read_b128 v[40:43], v205 offset:8192
  s_waitcnt lgkmcnt(2)
  v_mfma_f32_32x32x16_bf16 v[240:255], a[128:131], v[32:35], v[240:255]
  ds_read_b128 v[44:47], v206 offset:8192
  s_waitcnt lgkmcnt(2)
  v_mfma_f32_32x32x16_bf16 v[240:255], a[132:135], v[36:39], v[240:255]
  s_waitcnt lgkmcnt(1)
  v_mfma_f32_32x32x16_bf16 v[240:255], a[136:139], v[40:43], v[240:255]
  s_waitcnt lgkmcnt(0)
  v_mfma_f32_32x32x16_bf16 v[240:255], a[140:143], v[44:47], v[240:255]
  s_nop 11
  v_cvt_pk_bf16_f32 v16, v240, v244
  v_cvt_pk_bf16_f32 v17, v241, v245
  v_cvt_pk_bf16_f32 v18, v242, v246
  v_cvt_pk_bf16_f32 v19, v243, v247
  ds_write_b128 v215, v[16:19] offset:0
  v_cvt_pk_bf16_f32 v20, v248, v252
  v_cvt_pk_bf16_f32 v21, v249, v253
  v_cvt_pk_bf16_f32 v22, v250, v254
  v_cvt_pk_bf16_f32 v23, v251, v255
  ds_write_b128 v215, v[20:23] offset:1024
  s_waitcnt lgkmcnt(0)
  s_barrier
  ds_read_b128 v[96:99], v208 offset:0
  ds_read_b128 v[100:103], v208 offset:1024
  ds_read_b128 v[104:107], v208 offset:2048
  ds_read_b128 v[108:111], v208 offset:3072
  ds_read_b128 v[112:115], v208 offset:4096
  ds_read_b128 v[116:119], v208 offset:5120
  ds_read_b128 v[120:123], v208 offset:6144
  ds_read_b128 v[124:127], v208 offset:7168
  s_waitcnt vmcnt(20) lgkmcnt(7)
  v_mfma_f32_32x32x16_bf16 v[64:79], v[128:131], v[96:99], v[48:63]
  s_waitcnt vmcnt(19) lgkmcnt(6)
  v_mfma_f32_32x32x16_bf16 v[64:79], v[132:135], v[100:103], v[64:79]
  s_waitcnt vmcnt(18) lgkmcnt(5)
  v_mfma_f32_32x32x16_bf16 v[64:79], v[136:139], v[104:107], v[64:79]
  s_waitcnt vmcnt(17) lgkmcnt(4)
  v_mfma_f32_32x32x16_bf16 v[64:79], v[140:143], v[108:111], v[64:79]
  s_waitcnt vmcnt(16) lgkmcnt(3)
  v_mfma_f32_32x32x16_bf16 v[64:79], v[144:147], v[112:115], v[64:79]
  s_waitcnt vmcnt(15) lgkmcnt(2)
  v_mfma_f32_32x32x16_bf16 v[64:79], v[148:151], v[116:119], v[64:79]
  s_waitcnt vmcnt(14) lgkmcnt(1)
  v_mfma_f32_32x32x16_bf16 v[64:79], v[152:155], v[120:123], v[64:79]
  s_waitcnt vmcnt(13) lgkmcnt(0)
  v_mfma_f32_32x32x16_bf16 v[64:79], v[156:159], v[124:127], v[64:79]
  s_nop 11
  v_max3_f32 v180, v64, v65, v66
  v_max3_f32 v180, v180, v67, v68
  v_max3_f32 v180, v180, v69, v70
  v_max3_f32 v180, v180, v71, v72
  v_max3_f32 v180, v180, v73, v74
  v_max3_f32 v180, v180, v75, v76
  v_max3_f32 v180, v180, v77, v78
  v_max_f32 v180, v180, v79
  v_mov_b32 v181, v180
  s_nop 1
  v_permlane32_swap_b32 v180, v181
  v_max_f32 v180, v180, v181
  v_sub_f32 v64, v64, v180
  v_sub_f32 v65, v65, v180
  v_sub_f32 v66, v66, v180
  v_sub_f32 v67, v67, v180
  v_sub_f32 v68, v68, v180
  v_sub_f32 v69, v69, v180
  v_sub_f32 v70, v70, v180
  v_sub_f32 v71, v71, v180
  v_sub_f32 v72, v72, v180
  v_sub_f32 v73, v73, v180
  v_sub_f32 v74, v74, v180
  v_sub_f32 v75, v75, v180
  v_sub_f32 v76, v76, v180
  v_sub_f32 v77, v77, v180
  v_sub_f32 v78, v78, v180
  v_sub_f32 v79, v79, v180
  v_exp_f32 v64, v64
  v_exp_f32 v65, v65
  v_exp_f32 v66, v66
  v_exp_f32 v67, v67
  v_exp_f32 v68, v68
  v_exp_f32 v69, v69
  v_exp_f32 v70, v70
  v_exp_f32 v71, v71
  v_exp_f32 v72, v72
  v_exp_f32 v73, v73
  v_exp_f32 v74, v74
  v_exp_f32 v75, v75
  v_exp_f32 v76, v76
  v_exp_f32 v77, v77
  v_exp_f32 v78, v78
  v_exp_f32 v79, v79
  v_cvt_pk_bf16_f32 v20, v64, v65
  v_cvt_pk_bf16_f32 v21, v68, v69
  v_cvt_pk_bf16_f32 v22, v72, v73
  v_cvt_pk_bf16_f32 v23, v76, v77
  v_cvt_pk_bf16_f32 v24, v66, v67
  v_cvt_pk_bf16_f32 v25, v70, v71
  v_cvt_pk_bf16_f32 v26, v74, v75
  v_cvt_pk_bf16_f32 v27, v78, v79
  s_waitcnt vmcnt(12)
  v_mfma_f32_32x32x16_bf16 v[0:15], v[160:163], v[20:23], 0
  v_add_f32 v182, v64, v65
  v_add_f32 v182, v182, v66
  v_add_f32 v182, v182, v67
  v_add_f32 v182, v182, v68
  v_add_f32 v182, v182, v69
  v_add_f32 v182, v182, v70
  v_add_f32 v182, v182, v71
  s_waitcnt vmcnt(11)
  v_mfma_f32_32x32x16_bf16 v[0:15], v[164:167], v[24:27], v[0:15]
  v_add_f32 v182, v182, v72
  v_add_f32 v182, v182, v73
  v_add_f32 v182, v182, v74
  v_add_f32 v182, v182, v75
  v_add_f32 v182, v182, v76
  v_add_f32 v182, v182, v77
  v_add_f32 v182, v182, v78
  v_add_f32 v182, v182, v79
  s_waitcnt vmcnt(0)
  s_barrier
AT_loop:
  s_cmp_ge_u32 s59, 64
  s_cbranch_scc1 AT_l0
  s_mov_b32 s77, s59
  s_mul_i32 s66, s59, 655360
  s_lshl_b32 s55, s58, 14
  s_add_u32 s55, s55, s66
  s_add_u32 s55, s55, 1048576
  s_lshl_b32 s76, s58, 2
  s_add_u32 s76, s76, s52
  s_lshl_b32 s75, s59, 7
  s_add_u32 s75, s75, s76
  s_lshl_b32 s75, s75, 11
  s_add_u32 s75, s75, 46137344
  s_lshl_b32 s76, s76, 10
  s_add_u32 s76, s76, s66
  s_add_u32 s76, s76, 1572864
  s_add_u32 s59, s59, 2
  buffer_load_dwordx4 v[128:131], v216, s[8:11], s55 offen offset:0 sc1
  buffer_load_dwordx4 v[132:135], v216, s[8:11], s55 offen offset:256 sc1
  buffer_load_dwordx4 v[136:139], v216, s[8:11], s55 offen offset:512 sc1
  buffer_load_dwordx4 v[140:143], v216, s[8:11], s55 offen offset:768 sc1
  buffer_load_dwordx4 v[144:147], v216, s[8:11], s55 offen offset:1024 sc1
  buffer_load_dwordx4 v[148:151], v216, s[8:11], s55 offen offset:1280 sc1
  buffer_load_dwordx4 v[152:155], v216, s[8:11], s55 offen offset:1536 sc1
  buffer_load_dwordx4 v[156:159], v216, s[8:11], s55 offen offset:1792 sc1
  buffer_load_dwordx4 v[160:163], v217, s[8:11], s55 offen offset:0 sc1
  buffer_load_dwordx4 v[164:167], v217, s[8:11], s55 offen offset:256 sc1
  s_or_b32 s70, s73, 0xc00
  buffer_load_dword v172, off, s[8:11], s70 sc1
  s_add_u32 s60, s60, 73728
  ds_read_b128 v[32:35], v203 offset:36864
  ds_read_b128 v[36:39], v204 offset:36864
  ds_read_b128 v[40:43], v205 offset:36864
  s_waitcnt lgkmcnt(2)
  v_mfma_f32_32x32x16_bf16 v[240:255], a[0:3], v[32:35], 0
  ds_read_b128 v[44:47], v206 offset:36864
  s_add_u32 m0, s67, 0
  s_nop 0
  buffer_load_dwordx4 v202, s[4:7], s60 offen offset:0 lds
  s_waitcnt lgkmcnt(2)
  v_mfma_f32_32x32x16_bf16 v[240:255], a[4:7], v[36:39], v[240:255]
  ds_read_b128 v[32:35], v203 offset:37888
  s_waitcnt lgkmcnt(2)
  v_mfma_f32_32x32x16_bf16 v[240:255], a[8:11], v[40:43], v[240:255]
  ds_read_b128 v[36:39], v204 offset:37888
  s_add_u32 m0, s67, 896
  s_nop 0
  buffer_load_dwordx4 v202, s[4:7], s60 offen offset:128 lds
  s_waitcnt lgkmcnt(2)
  v_mfma_f32_32x32x16_bf16 v[240:255], a[12:15], v[44:47], v[240:255]
  ds_read_b128 v[40:43], v205 offset:37888
  s_waitcnt lgkmcnt(2)
  v_mfma_f32_32x32x16_bf16 v[240:255], a[16:19], v[32:35], v[240:255]
  ds_read_b128 v[44:47], v206 offset:37888
  s_add_u32 m0, s67, 1792
  s_nop 0
  buffer_load_dwordx4 v202, s[4:7], s60 offen offset:256 lds
  s_waitcnt lgkmcnt(2)
  v_mfma_f32_32x32x16_bf16 v[240:255], a[20:23], v[36:39], v[240:255]
  ds_read_b128 v[32:35], v203 offset:38912
  s_waitcnt lgkmcnt(2)
  v_mfma_f32_32x32x16_bf16 v[240:255], a[24:27], v[40:43], v[240:255]
  ds_read_b128 v[36:39], v204 offset:38912
  s_add_u32 m0, s67, 2688
  s_nop 0
  buffer_load_dwordx4 v202, s[4:7], s60 offen offset:384 lds
  s_waitcnt lgkmcnt(2)
  v_mfma_f32_32x32x16_bf16 v[240:255], a[28:31], v[44:47], v[240:255]
  ds_read_b128 v[40:43], v205 offset:38912
  s_waitcnt lgkmcnt(2)
  v_mfma_f32_32x32x16_bf16 v[240:255], a[32:35], v[32:35], v[240:255]
  ds_read_b128 v[44:47], v206 offset:38912
  s_add_u32 m0, s67, 3584
  s_nop 0
  buffer_load_dwordx4 v202, s[4:7], s60 offen offset:512 lds
  s_waitcnt lgkmcnt(2)
  v_mfma_f32_32x32x16_bf16 v[240:255], a[36:39], v[36:39], v[240:255]
  ds_read_b128 v[32:35], v203 offset:39936
  s_waitcnt lgkmcnt(2)
  v_mfma_f32_32x32x16_bf16 v[240:255], a[40:43], v[40:43], v[240:255]
  ds_read_b128 v[36:39], v204 offset:39936
  s_add_u32 m0, s67, 4480
  s_nop 0
  buffer_load_dwordx4 v202, s[4:7], s60 offen offset:640 lds
  s_waitcnt lgkmcnt(2)
  v_mfma_f32_32x32x16_bf16 v[240:255], a[44:47], v[44:47], v[240:255]
  ds_read_b128 v[40:43], v205 offset:39936
  s_waitcnt lgkmcnt(2)
  v_mfma_f32_32x32x16_bf16 v[240:255], a[48:51], v[32:35], v[240:255]
  ds_read_b128 v[44:47], v206 offset:39936
  s_add_u32 m0, s67, 5376
  s_nop 0
  buffer_load_dwordx4 v202, s[4:7], s60 offen offset:768 lds
  s_waitcnt lgkmcnt(2)
  v_mfma_f32_32x32x16_bf16 v[240:255], a[52:55], v[36:39], v[240:255]
  ds_read_b128 v[32:35], v203 offset:40960
  s_waitcnt lgkmcnt(2)
  v_mfma_f32_32x32x16_bf16 v[240:255], a[56:59], v[40:43], v[240:255]
  ds_read_b128 v[36:39], v204 offset:40960
  s_add_u32 m0, s67, 6272
  s_nop 0
  buffer_load_dwordx4 v202, s[4:7], s60 offen offset:896 lds
  s_waitcnt lgkmcnt(2)
  v_mfma_f32_32x32x16_bf16 v[240:255], a[60:63], v[44:47], v[240:255]
  ds_read_b128 v[40:43], v205 offset:40960
  s_waitcnt lgkmcnt(2)
  v_mfma_f32_32x32x16_bf16 v[240:255], a[64:67], v[32:35], v[240:255]
  ds_read_b128 v[44:47], v206 offset:40960
  s_add_u32 m0, s67, 7168
  s_nop 0
  buffer_load_dwordx4 v202, s[4:7], s60 offen offset:1024 lds
  s_waitcnt lgkmcnt(2)
  v_mfma_f32_32x32x16_bf16 v[240:255], a[68:71], v[36:39], v[240:255]
  ds_read_b128 v[32:35], v203 offset:41984
  s_waitcnt lgkmcnt(2)
  v_mfma_f32_32x32x16_bf16 v[240:255], a[72:75], v[40:43], v[240:255]
  ds_read_b128 v[36:39], v204 offset:41984
  buffer_store_dwordx4 v[176:179], v201, s[8:11], s75 offen offset:0 sc1
  s_waitcnt lgkmcnt(2)
  v_mfma_f32_32x32x16_bf16 v[240:255], a[76:79], v[44:47], v[240:255]
  ds_read_b128 v[40:43], v205 offset:41984
  s_waitcnt lgkmcnt(2)
  v_mfma_f32_32x32x16_bf16 v[240:255], a[80:83], v[32:35], v[240:255]
  ds_read_b128 v[44:47], v206 offset:41984
  buffer_store_dwordx4 v[176:179], v201, s[8:11], s75 offen offset:1024 sc1
  s_waitcnt lgkmcnt(2)
  v_mfma_f32_32x32x16_bf16 v[240:255], a[84:87], v[36:39], v[240:255]
  ds_read_b128 v[32:35], v203 offset:43008
  s_waitcnt lgkmcnt(2)
  v_mfma_f32_32x32x16_bf16 v[240:255], a[88:91], v[40:43], v[240:255]
  ds_read_b128 v[36:39], v204 offset:43008
  s_waitcnt lgkmcnt(2)
  v_mfma_f32_32x32x16_bf16 v[240:255], a[92:95], v[44:47], v[240:255]
  ds_read_b128 v[40:43], v205 offset:43008
  s_waitcnt lgkmcnt(2)
  v_mfma_f32_32x32x16_bf16 v[240:255], a[96:99], v[32:35], v[240:255]
  ds_read_b128 v[44:47], v206 offset:43008
  s_waitcnt lgkmcnt(2)
  v_mfma_f32_32x32x16_bf16 v[240:255], a[100:103], v[36:39], v[240:255]
  ds_read_b128 v[32:35], v203 offset:44032
  s_waitcnt lgkmcnt(2)
  v_mfma_f32_32x32x16_bf16 v[240:255], a[104:107], v[40:43], v[240:255]
  ds_read_b128 v[36:39], v204 offset:44032
  s_waitcnt lgkmcnt(2)
  v_mfma_f32_32x32x16_bf16 v[240:255], a[108:111], v[44:47], v[240:255]
  ds_read_b128 v[40:43], v205 offset:44032
  s_waitcnt lgkmcnt(2)
  v_mfma_f32_32x32x16_bf16 v[240:255], a[112:115], v[32:35], v[240:255]
  ds_read_b128 v[44:47], v206 offset:44032
  s_waitcnt lgkmcnt(2)
  v_mfma_f32_32x32x16_bf16 v[240:255], a[116:119], v[36:39], v[240:255]
  ds_read_b128 v[32:35], v203 offset:45056
  s_waitcnt lgkmcnt(2)
  v_mfma_f32_32x32x16_bf16 v[240:255], a[120:123], v[40:43], v[240:255]
  ds_read_b128 v[36:39], v204 offset:45056
  s_waitcnt lgkmcnt(2)
  v_mfma_f32_32x32x16_bf16 v[240:255], a[124:127], v[44:47], v[240:255]
  ds_read_b128 v[40:43], v205 offset:45056
  s_waitcnt lgkmcnt(2)
  v_mfma_f32_32x32x16_bf16 v[240:255], a[128:131], v[32:35], v[240:255]
  ds_read_b128 v[44:47], v206 offset:45056
  s_waitcnt lgkmcnt(2)
  v_mfma_f32_32x32x16_bf16 v[240:255], a[132:135], v[36:39], v[240:255]
  s_waitcnt lgkmcnt(1)
  v_mfma_f32_32x32x16_bf16 v[240:255], a[136:139], v[40:43], v[240:255]
  s_waitcnt lgkmcnt(0)
  v_mfma_f32_32x32x16_bf16 v[240:255], a[140:143], v[44:47], v[240:255]
  s_nop 11
  v_cvt_pk_bf16_f32 v16, v240, v244
  v_cvt_pk_bf16_f32 v17, v241, v245
  v_cvt_pk_bf16_f32 v18, v242, v246
  v_cvt_pk_bf16_f32 v19, v243, v247
  ds_write_b128 v215, v[16:19] offset:0
  v_cvt_pk_bf16_f32 v20, v248, v252
  v_cvt_pk_bf16_f32 v21, v249, v253
  v_cvt_pk_bf16_f32 v22, v250, v254
  v_cvt_pk_bf16_f32 v23, v251, v255
  ds_write_b128 v215, v[20:23] offset:1024
  s_waitcnt lgkmcnt(0)
  s_barrier
  ds_read_b128 a[144:147], v208 offset:0
  ds_read_b128 a[148:151], v208 offset:1024
  ds_read_b128 a[152:155], v208 offset:2048
  ds_read_b128 a[156:159], v208 offset:3072
  ds_read_b128 a[160:163], v208 offset:4096
  ds_read_b128 a[164:167], v208 offset:5120
  ds_read_b128 a[168:171], v208 offset:6144
  ds_read_b128 a[172:175], v208 offset:7168
  s_waitcnt vmcnt(11)
  v_cmp_eq_u32 vcc, -1, v172
  s_mov_b32 s69, 0
  s_cbranch_vccnz AT_e1
  s_mov_b32 s69, 1
  buffer_load_dwordx4 v[172:175], v201, s[8:11], s73 offen sc1
AT_e1:
  s_waitcnt lgkmcnt(7)
  v_mfma_f32_32x32x16_bf16 v[64:79], v[128:131], a[144:147], v[48:63]
  s_waitcnt lgkmcnt(6)
  v_mfma_f32_32x32x16_bf16 v[64:79], v[132:135], a[148:151], v[64:79]
  s_waitcnt lgkmcnt(5)
  v_mfma_f32_32x32x16_bf16 v[64:79], v[136:139], a[152:155], v[64:79]
  s_waitcnt lgkmcnt(4)
  v_mfma_f32_32x32x16_bf16 v[64:79], v[140:143], a[156:159], v[64:79]
  s_waitcnt lgkmcnt(3)
  v_mfma_f32_32x32x16_bf16 v[64:79], v[144:147], a[160:163], v[64:79]
  s_waitcnt lgkmcnt(2)
  v_mfma_f32_32x32x16_bf16 v[64:79], v[148:151], a[164:167], v[64:79]
  s_waitcnt lgkmcnt(1)
  v_mfma_f32_32x32x16_bf16 v[64:79], v[152:155], a[168:171], v[64:79]
  s_waitcnt lgkmcnt(0)
  v_mfma_f32_32x32x16_bf16 v[64:79], v[156:159], a[172:175], v[64:79]
  s_nop 11
  v_max3_f32 v184, v64, v65, v66
  v_max3_f32 v184, v184, v67, v68
  v_max3_f32 v184, v184, v69, v70
  v_max3_f32 v184, v184, v71, v72
  v_max3_f32 v184, v184, v73, v74
  v_max3_f32 v184, v184, v75, v76
  v_max3_f32 v184, v184, v77, v78
  v_max_f32 v184, v184, v79
  v_mov_b32 v185, v184
  s_nop 1
  v_permlane32_swap_b32 v184, v185
  v_max_f32 v184, v184, v185
  v_sub_f32 v64, v64, v184
  v_sub_f32 v65, v65, v184
  v_sub_f32 v66, v66, v184
  v_sub_f32 v67, v67, v184
  v_sub_f32 v68, v68, v184
  v_sub_f32 v69, v69, v184
  v_sub_f32 v70, v70, v184
  v_sub_f32 v71, v71, v184
  v_sub_f32 v72, v72, v184
  v_sub_f32 v73, v73, v184
  v_sub_f32 v74, v74, v184
  v_sub_f32 v75, v75, v184
  v_sub_f32 v76, v76, v184
  v_sub_f32 v77, v77, v184
  v_sub_f32 v78, v78, v184
  v_sub_f32 v79, v79, v184
  v_exp_f32 v64, v64
  v_exp_f32 v65, v65
  v_exp_f32 v66, v66
  v_exp_f32 v67, v67
  v_exp_f32 v68, v68
  v_exp_f32 v69, v69
  v_exp_f32 v70, v70
  v_exp_f32 v71, v71
  v_exp_f32 v72, v72
  v_exp_f32 v73, v73
  v_exp_f32 v74, v74
  v_exp_f32 v75, v75
  v_exp_f32 v76, v76
  v_exp_f32 v77, v77
  v_exp_f32 v78, v78
  v_exp_f32 v79, v79
  v_cvt_pk_bf16_f32 v20, v64, v65
  v_cvt_pk_bf16_f32 v21, v68, v69
  v_cvt_pk_bf16_f32 v22, v72, v73
  v_cvt_pk_bf16_f32 v23, v76, v77
  v_cvt_pk_bf16_f32 v24, v66, v67
  v_cvt_pk_bf16_f32 v25, v70, v71
  v_cvt_pk_bf16_f32 v26, v74, v75
  v_cvt_pk_bf16_f32 v27, v78, v79
  v_mfma_f32_32x32x16_bf16 v[224:239], v[160:163], v[20:23], 0
  v_add_f32 v186, v64, v65
  v_add_f32 v186, v186, v66
  v_add_f32 v186, v186, v67
  v_add_f32 v186, v186, v68
  v_add_f32 v186, v186, v69
  v_add_f32 v186, v186, v70
  v_add_f32 v186, v186, v71
  v_mfma_f32_32x32x16_bf16 v[224:239], v[164:167], v[24:27], v[224:239]
  v_add_f32 v186, v186, v72
  v_add_f32 v186, v186, v73
  v_add_f32 v186, v186, v74
  v_add_f32 v186, v186, v75
  v_add_f32 v186, v186, v76
  v_add_f32 v186, v186, v77
  v_add_f32 v186, v186, v78
  v_add_f32 v186, v186, v79
AT_l0:
  s_cmp_eq_u32 s69, 1
  s_cbranch_scc1 AT_v0
  s_cmp_ge_u32 s74, 62
  s_cbranch_scc1 AT_k0
  s_branch AT_c0
AT_h0:
  s_sleep 2
AT_c0:
  buffer_load_dword v172, off, s[8:11], s70 sc1
  s_add_u32 s65, s65, 1
  s_cmp_lt_u32 s65, 131072
  s_cselect_b32 s54, -2, -1
  s_waitcnt vmcnt(0)
  v_cmp_lt_u32 vcc, s54, v172
  s_cbranch_vccnz AT_h0
AT_k0:
  buffer_load_dwordx4 v[172:175], v201, s[8:11], s73 offen sc1
AT_v0:
  s_mov_b32 s69, 0
  s_add_u32 s65, s65, 1
  s_cmp_lt_u32 s65, 131072
  s_cselect_b32 s54, -2, -1
  s_waitcnt vmcnt(0)
  ds_write_b64 v220, v[172:173] offset:0
  ds_write_b64 v221, v[174:175] offset:0
  v_max3_u32 v213, v172, v173, v174
  v_max_u32 v213, v213, v175
  v_cmp_lt_u32 vcc, s54, v213
  s_cbranch_vccnz AT_k0
  s_waitcnt lgkmcnt(0)
  s_barrier
  ds_read_b128 v[128:131], v218 offset:0
  ds_read_b128 v[132:135], v218 offset:256
  ds_read_b128 v[136:139], v218 offset:512
  ds_read_b128 v[140:143], v218 offset:768
  ds_read_b128 v[144:147], v218 offset:1024
  ds_read_b128 v[148:151], v218 offset:1280
  ds_read_b128 v[152:155], v218 offset:1536
  ds_read_b128 v[156:159], v218 offset:1792
  ds_read_b32 v168, v219 offset:0
  ds_read_b32 v169, v219 offset:128
  s_waitcnt lgkmcnt(9)
  v_mfma_f32_32x32x16_bf16 v[80:95], v[128:131], v[96:99], 0
  s_waitcnt lgkmcnt(8)
  v_mfma_f32_32x32x16_bf16 v[80:95], v[132:135], v[100:103], v[80:95]
  s_waitcnt lgkmcnt(7)
  v_mfma_f32_32x32x16_bf16 v[80:95], v[136:139], v[104:107], v[80:95]
  s_waitcnt lgkmcnt(6)
  v_mfma_f32_32x32x16_bf16 v[80:95], v[140:143], v[108:111], v[80:95]
  s_waitcnt lgkmcnt(5)
  v_mfma_f32_32x32x16_bf16 v[80:95], v[144:147], v[112:115], v[80:95]
  s_waitcnt lgkmcnt(4)
  v_mfma_f32_32x32x16_bf16 v[80:95], v[148:151], v[116:119], v[80:95]
  s_waitcnt lgkmcnt(3)
  v_mfma_f32_32x32x16_bf16 v[80:95], v[152:155], v[120:123], v[80:95]
  s_waitcnt lgkmcnt(2)
  v_mfma_f32_32x32x16_bf16 v[80:95], v[156:159], v[124:127], v[80:95]
  s_add_u32 s74, s74, 2
  v_mov_b32 v212, s74
  s_nop 9
  v_mul_f32 v80, s68, v80
  v_mul_f32 v81, s68, v81
  v_mul_f32 v82, s68, v82
  v_mul_f32 v83, s68, v83
  v_max3_f32 v84, v180, v80, v81
  v_max3_f32 v84, v84, v82, v83
  v_mov_b32 v85, v84
  s_nop 1
  v_permlane32_swap_b32 v84, v85
  v_max_f32 v84, v84, v85
  v_sub_f32 v86, v180, v84
  v_sub_f32 v80, v80, v84
  v_sub_f32 v81, v81, v84
  v_sub_f32 v82, v82, v84
  v_sub_f32 v83, v83, v84
  v_exp_f32 v86, v86
  v_exp_f32 v80, v80
  v_exp_f32 v81, v81
  v_exp_f32 v82, v82
  v_exp_f32 v83, v83
  v_fma_f32 v182, v182, v86, v80
  v_add_f32 v84, v81, v82
  v_add_f32 v182, v182, v83
  v_add_f32 v182, v182, v84
  v_mov_b32 v183, v182
  s_nop 1
  v_permlane32_swap_b32 v182, v183
  v_add_f32 v182, v182, v183
  v_rcp_f32 v182, v182
  s_nop 0
  v_mul_f32 v86, v86, v182
  v_mul_f32 v80, v182, v80
  v_mul_f32 v81, v182, v81
  v_mul_f32 v82, v182, v82
  v_mul_f32 v83, v182, v83
  v_cvt_pk_bf16_f32 v28, v80, v81
  v_cvt_pk_bf16_f32 v29, v82, v83
  v_mul_f32 v0, v86, v0
  v_mul_f32 v1, v86, v1
  v_mul_f32 v2, v86, v2
  v_mul_f32 v3, v86, v3
  v_mul_f32 v4, v86, v4
  v_mul_f32 v5, v86, v5
  v_mul_f32 v6, v86, v6
  v_mul_f32 v7, v86, v7
  v_mul_f32 v8, v86, v8
  v_mul_f32 v9, v86, v9
  v_mul_f32 v10, v86, v10
  v_mul_f32 v11, v86, v11
  v_mul_f32 v12, v86, v12
  v_mul_f32 v13, v86, v13
  v_mul_f32 v14, v86, v14
  v_mul_f32 v15, v86, v15
  s_waitcnt lgkmcnt(0)
  s_nop 0
  v_mfma_f32_32x32x8_bf16 v[0:15], v[168:169], v[28:29], v[0:15]
  s_nop 11
  v_cvt_pk_bf16_f32 v20, v0, v1
  v_cvt_pk_bf16_f32 v21, v2, v3
  v_cvt_pk_bf16_f32 v22, v4, v5
  v_cvt_pk_bf16_f32 v23, v6, v7
  buffer_store_dwordx4 v[20:23], v201, s[8:11], s72 offen offset:0 sc1
  v_cvt_pk_bf16_f32 v24, v8, v9
  v_cvt_pk_bf16_f32 v25, v10, v11
  v_cvt_pk_bf16_f32 v26, v12, v13
  v_cvt_pk_bf16_f32 v27, v14, v15
  buffer_store_dwordx4 v[24:27], v201, s[8:11], s72 offen offset:1024 sc1
  s_mov_b64 exec, 1
  buffer_store_dword v212, v201, s[8:11], s71 offen sc1
  s_mov_b64 exec, -1
  s_cmp_ge_u32 s74, 64
  s_cbranch_scc1 L_exit
  s_cmp_ge_u32 s59, 64
  s_cbranch_scc1 AT_l1
  s_mov_b32 s74, s59
  s_mul_i32 s66, s59, 655360
  s_lshl_b32 s55, s58, 14
  s_add_u32 s55, s55, s66
  s_add_u32 s55, s55, 1048576
  s_lshl_b32 s73, s58, 2
  s_add_u32 s73, s73, s52
  s_lshl_b32 s72, s59, 7
  s_add_u32 s72, s72, s73
  s_lshl_b32 s72, s72, 11
  s_add_u32 s72, s72, 46137344
  s_lshl_b32 s73, s73, 10
  s_add_u32 s73, s73, s66
  s_add_u32 s73, s73, 1572864
  s_add_u32 s59, s59, 2
  buffer_load_dwordx4 v[128:131], v216, s[8:11], s55 offen offset:0 sc1
  buffer_load_dwordx4 v[132:135], v216, s[8:11], s55 offen offset:256 sc1
  buffer_load_dwordx4 v[136:139], v216, s[8:11], s55 offen offset:512 sc1
  buffer_load_dwordx4 v[140:143], v216, s[8:11], s55 offen offset:768 sc1
  buffer_load_dwordx4 v[144:147], v216, s[8:11], s55 offen offset:1024 sc1
  buffer_load_dwordx4 v[148:151], v216, s[8:11], s55 offen offset:1280 sc1
  buffer_load_dwordx4 v[152:155], v216, s[8:11], s55 offen offset:1536 sc1
  buffer_load_dwordx4 v[156:159], v216, s[8:11], s55 offen offset:1792 sc1
  buffer_load_dwordx4 v[160:163], v217, s[8:11], s55 offen offset:0 sc1
  buffer_load_dwordx4 v[164:167], v217, s[8:11], s55 offen offset:256 sc1
  s_or_b32 s70, s76, 0xc00
  buffer_load_dword v172, off, s[8:11], s70 sc1
  s_add_u32 s60, s60, 73728
  ds_read_b128 v[32:35], v203 offset:0
  ds_read_b128 v[36:39], v204 offset:0
  ds_read_b128 v[40:43], v205 offset:0
  s_waitcnt lgkmcnt(2)
  v_mfma_f32_32x32x16_bf16 v[240:255], a[0:3], v[32:35], 0
  ds_read_b128 v[44:47], v206 offset:0
  s_add_u32 m0, s67, 36864
  s_nop 0
  buffer_load_dwordx4 v202, s[4:7], s60 offen offset:0 lds
  s_waitcnt lgkmcnt(2)
  v_mfma_f32_32x32x16_bf16 v[240:255], a[4:7], v[36:39], v[240:255]
  ds_read_b128 v[32:35], v203 offset:1024
  s_waitcnt lgkmcnt(2)
  v_mfma_f32_32x32x16_bf16 v[240:255], a[8:11], v[40:43], v[240:255]
  ds_read_b128 v[36:39], v204 offset:1024
  s_add_u32 m0, s67, 37760
  s_nop 0
  buffer_load_dwordx4 v202, s[4:7], s60 offen offset:128 lds
  s_waitcnt lgkmcnt(2)
  v_mfma_f32_32x32x16_bf16 v[240:255], a[12:15], v[44:47], v[240:255]
  ds_read_b128 v[40:43], v205 offset:1024
  s_waitcnt lgkmcnt(2)
  v_mfma_f32_32x32x16_bf16 v[240:255], a[16:19], v[32:35], v[240:255]
  ds_read_b128 v[44:47], v206 offset:1024
  s_add_u32 m0, s67, 38656
  s_nop 0
  buffer_load_dwordx4 v202, s[4:7], s60 offen offset:256 lds
  s_waitcnt lgkmcnt(2)
  v_mfma_f32_32x32x16_bf16 v[240:255], a[20:23], v[36:39], v[240:255]
  ds_read_b128 v[32:35], v203 offset:2048
  s_waitcnt lgkmcnt(2)
  v_mfma_f32_32x32x16_bf16 v[240:255], a[24:27], v[40:43], v[240:255]
  ds_read_b128 v[36:39], v204 offset:2048
  s_add_u32 m0, s67, 39552
  s_nop 0
  buffer_load_dwordx4 v202, s[4:7], s60 offen offset:384 lds
  s_waitcnt lgkmcnt(2)
  v_mfma_f32_32x32x16_bf16 v[240:255], a[28:31], v[44:47], v[240:255]
  ds_read_b128 v[40:43], v205 offset:2048
  s_waitcnt lgkmcnt(2)
  v_mfma_f32_32x32x16_bf16 v[240:255], a[32:35], v[32:35], v[240:255]
  ds_read_b128 v[44:47], v206 offset:2048
  s_add_u32 m0, s67, 40448
  s_nop 0
  buffer_load_dwordx4 v202, s[4:7], s60 offen offset:512 lds
  s_waitcnt lgkmcnt(2)
  v_mfma_f32_32x32x16_bf16 v[240:255], a[36:39], v[36:39], v[240:255]
  ds_read_b128 v[32:35], v203 offset:3072
  s_waitcnt lgkmcnt(2)
  v_mfma_f32_32x32x16_bf16 v[240:255], a[40:43], v[40:43], v[240:255]
  ds_read_b128 v[36:39], v204 offset:3072
  s_add_u32 m0, s67, 41344
  s_nop 0
  buffer_load_dwordx4 v202, s[4:7], s60 offen offset:640 lds
  s_waitcnt lgkmcnt(2)
  v_mfma_f32_32x32x16_bf16 v[240:255], a[44:47], v[44:47], v[240:255]
  ds_read_b128 v[40:43], v205 offset:3072
  s_waitcnt lgkmcnt(2)
  v_mfma_f32_32x32x16_bf16 v[240:255], a[48:51], v[32:35], v[240:255]
  ds_read_b128 v[44:47], v206 offset:3072
  s_add_u32 m0, s67, 42240
  s_nop 0
  buffer_load_dwordx4 v202, s[4:7], s60 offen offset:768 lds
  s_waitcnt lgkmcnt(2)
  v_mfma_f32_32x32x16_bf16 v[240:255], a[52:55], v[36:39], v[240:255]
  ds_read_b128 v[32:35], v203 offset:4096
  s_waitcnt lgkmcnt(2)
  v_mfma_f32_32x32x16_bf16 v[240:255], a[56:59], v[40:43], v[240:255]
  ds_read_b128 v[36:39], v204 offset:4096
  s_add_u32 m0, s67, 43136
  s_nop 0
  buffer_load_dwordx4 v202, s[4:7], s60 offen offset:896 lds
  s_waitcnt lgkmcnt(2)
  v_mfma_f32_32x32x16_bf16 v[240:255], a[60:63], v[44:47], v[240:255]
  ds_read_b128 v[40:43], v205 offset:4096
  s_waitcnt lgkmcnt(2)
  v_mfma_f32_32x32x16_bf16 v[240:255], a[64:67], v[32:35], v[240:255]
  ds_read_b128 v[44:47], v206 offset:4096
  s_add_u32 m0, s67, 44032
  s_nop 0
  buffer_load_dwordx4 v202, s[4:7], s60 offen offset:1024 lds
  s_waitcnt lgkmcnt(2)
  v_mfma_f32_32x32x16_bf16 v[240:255], a[68:71], v[36:39], v[240:255]
  ds_read_b128 v[32:35], v203 offset:5120
  s_waitcnt lgkmcnt(2)
  v_mfma_f32_32x32x16_bf16 v[240:255], a[72:75], v[40:43], v[240:255]
  ds_read_b128 v[36:39], v204 offset:5120
  buffer_store_dwordx4 v[176:179], v201, s[8:11], s72 offen offset:0 sc1
  s_waitcnt lgkmcnt(2)
  v_mfma_f32_32x32x16_bf16 v[240:255], a[76:79], v[44:47], v[240:255]
  ds_read_b128 v[40:43], v205 offset:5120
  s_waitcnt lgkmcnt(2)
  v_mfma_f32_32x32x16_bf16 v[240:255], a[80:83], v[32:35], v[240:255]
  ds_read_b128 v[44:47], v206 offset:5120
  buffer_store_dwordx4 v[176:179], v201, s[8:11], s72 offen offset:1024 sc1
  s_waitcnt lgkmcnt(2)
  v_mfma_f32_32x32x16_bf16 v[240:255], a[84:87], v[36:39], v[240:255]
  ds_read_b128 v[32:35], v203 offset:6144
  s_waitcnt lgkmcnt(2)
  v_mfma_f32_32x32x16_bf16 v[240:255], a[88:91], v[40:43], v[240:255]
  ds_read_b128 v[36:39], v204 offset:6144
  s_waitcnt lgkmcnt(2)
  v_mfma_f32_32x32x16_bf16 v[240:255], a[92:95], v[44:47], v[240:255]
  ds_read_b128 v[40:43], v205 offset:6144
  s_waitcnt lgkmcnt(2)
  v_mfma_f32_32x32x16_bf16 v[240:255], a[96:99], v[32:35], v[240:255]
  ds_read_b128 v[44:47], v206 offset:6144
  s_waitcnt lgkmcnt(2)
  v_mfma_f32_32x32x16_bf16 v[240:255], a[100:103], v[36:39], v[240:255]
  ds_read_b128 v[32:35], v203 offset:7168
  s_waitcnt lgkmcnt(2)
  v_mfma_f32_32x32x16_bf16 v[240:255], a[104:107], v[40:43], v[240:255]
  ds_read_b128 v[36:39], v204 offset:7168
  s_waitcnt lgkmcnt(2)
  v_mfma_f32_32x32x16_bf16 v[240:255], a[108:111], v[44:47], v[240:255]
  ds_read_b128 v[40:43], v205 offset:7168
  s_waitcnt lgkmcnt(2)
  v_mfma_f32_32x32x16_bf16 v[240:255], a[112:115], v[32:35], v[240:255]
  ds_read_b128 v[44:47], v206 offset:7168
  s_waitcnt lgkmcnt(2)
  v_mfma_f32_32x32x16_bf16 v[240:255], a[116:119], v[36:39], v[240:255]
  ds_read_b128 v[32:35], v203 offset:8192
  s_waitcnt lgkmcnt(2)
  v_mfma_f32_32x32x16_bf16 v[240:255], a[120:123], v[40:43], v[240:255]
  ds_read_b128 v[36:39], v204 offset:8192
  s_waitcnt lgkmcnt(2)
  v_mfma_f32_32x32x16_bf16 v[240:255], a[124:127], v[44:47], v[240:255]
  ds_read_b128 v[40:43], v205 offset:8192
  s_waitcnt lgkmcnt(2)
  v_mfma_f32_32x32x16_bf16 v[240:255], a[128:131], v[32:35], v[240:255]
  ds_read_b128 v[44:47], v206 offset:8192
  s_waitcnt lgkmcnt(2)
  v_mfma_f32_32x32x16_bf16 v[240:255], a[132:135], v[36:39], v[240:255]
  s_waitcnt lgkmcnt(1)
  v_mfma_f32_32x32x16_bf16 v[240:255], a[136:139], v[40:43], v[240:255]
  s_waitcnt lgkmcnt(0)
  v_mfma_f32_32x32x16_bf16 v[240:255], a[140:143], v[44:47], v[240:255]
  s_nop 11
  v_cvt_pk_bf16_f32 v16, v240, v244
  v_cvt_pk_bf16_f32 v17, v241, v245
  v_cvt_pk_bf16_f32 v18, v242, v246
  v_cvt_pk_bf16_f32 v19, v243, v247
  ds_write_b128 v215, v[16:19] offset:0
  v_cvt_pk_bf16_f32 v20, v248, v252
  v_cvt_pk_bf16_f32 v21, v249, v253
  v_cvt_pk_bf16_f32 v22, v250, v254
  v_cvt_pk_bf16_f32 v23, v251, v255
  ds_write_b128 v215, v[20:23] offset:1024
  s_waitcnt lgkmcnt(0)
  s_barrier
  ds_read_b128 v[96:99], v208 offset:0
  ds_read_b128 v[100:103], v208 offset:1024
  ds_read_b128 v[104:107], v208 offset:2048
  ds_read_b128 v[108:111], v208 offset:3072
  ds_read_b128 v[112:115], v208 offset:4096
  ds_read_b128 v[116:119], v208 offset:5120
  ds_read_b128 v[120:123], v208 offset:6144
  ds_read_b128 v[124:127], v208 offset:7168
  s_waitcnt vmcnt(11)
  v_cmp_eq_u32 vcc, -1, v172
  s_mov_b32 s69, 0
  s_cbranch_vccnz AT_e0
  s_mov_b32 s69, 1
  buffer_load_dwordx4 v[172:175], v201, s[8:11], s76 offen sc1
AT_e0:
  s_waitcnt lgkmcnt(7)
  v_mfma_f32_32x32x16_bf16 v[64:79], v[128:131], v[96:99], v[48:63]
  s_waitcnt lgkmcnt(6)
  v_mfma_f32_32x32x16_bf16 v[64:79], v[132:135], v[100:103], v[64:79]
  s_waitcnt lgkmcnt(5)
  v_mfma_f32_32x32x16_bf16 v[64:79], v[136:139], v[104:107], v[64:79]
  s_waitcnt lgkmcnt(4)
  v_mfma_f32_32x32x16_bf16 v[64:79], v[140:143], v[108:111], v[64:79]
  s_waitcnt lgkmcnt(3)
  v_mfma_f32_32x32x16_bf16 v[64:79], v[144:147], v[112:115], v[64:79]
  s_waitcnt lgkmcnt(2)
  v_mfma_f32_32x32x16_bf16 v[64:79], v[148:151], v[116:119], v[64:79]
  s_waitcnt lgkmcnt(1)
  v_mfma_f32_32x32x16_bf16 v[64:79], v[152:155], v[120:123], v[64:79]
  s_waitcnt lgkmcnt(0)
  v_mfma_f32_32x32x16_bf16 v[64:79], v[156:159], v[124:127], v[64:79]
  s_nop 11
  v_max3_f32 v180, v64, v65, v66
  v_max3_f32 v180, v180, v67, v68
  v_max3_f32 v180, v180, v69, v70
  v_max3_f32 v180, v180, v71, v72
  v_max3_f32 v180, v180, v73, v74
  v_max3_f32 v180, v180, v75, v76
  v_max3_f32 v180, v180, v77, v78
  v_max_f32 v180, v180, v79
  v_mov_b32 v181, v180
  s_nop 1
  v_permlane32_swap_b32 v180, v181
  v_max_f32 v180, v180, v181
  v_sub_f32 v64, v64, v180
  v_sub_f32 v65, v65, v180
  v_sub_f32 v66, v66, v180
  v_sub_f32 v67, v67, v180
  v_sub_f32 v68, v68, v180
  v_sub_f32 v69, v69, v180
  v_sub_f32 v70, v70, v180
  v_sub_f32 v71, v71, v180
  v_sub_f32 v72, v72, v180
  v_sub_f32 v73, v73, v180
  v_sub_f32 v74, v74, v180
  v_sub_f32 v75, v75, v180
  v_sub_f32 v76, v76, v180
  v_sub_f32 v77, v77, v180
  v_sub_f32 v78, v78, v180
  v_sub_f32 v79, v79, v180
  v_exp_f32 v64, v64
  v_exp_f32 v65, v65
  v_exp_f32 v66, v66
  v_exp_f32 v67, v67
  v_exp_f32 v68, v68
  v_exp_f32 v69, v69
  v_exp_f32 v70, v70
  v_exp_f32 v71, v71
  v_exp_f32 v72, v72
  v_exp_f32 v73, v73
  v_exp_f32 v74, v74
  v_exp_f32 v75, v75
  v_exp_f32 v76, v76
  v_exp_f32 v77, v77
  v_exp_f32 v78, v78
  v_exp_f32 v79, v79
  v_cvt_pk_bf16_f32 v20, v64, v65
  v_cvt_pk_bf16_f32 v21, v68, v69
  v_cvt_pk_bf16_f32 v22, v72, v73
  v_cvt_pk_bf16_f32 v23, v76, v77
  v_cvt_pk_bf16_f32 v24, v66, v67
  v_cvt_pk_bf16_f32 v25, v70, v71
  v_cvt_pk_bf16_f32 v26, v74, v75
  v_cvt_pk_bf16_f32 v27, v78, v79
  v_mfma_f32_32x32x16_bf16 v[0:15], v[160:163], v[20:23], 0
  v_add_f32 v182, v64, v65
  v_add_f32 v182, v182, v66
  v_add_f32 v182, v182, v67
  v_add_f32 v182, v182, v68
  v_add_f32 v182, v182, v69
  v_add_f32 v182, v182, v70
  v_add_f32 v182, v182, v71
  v_mfma_f32_32x32x16_bf16 v[0:15], v[164:167], v[24:27], v[0:15]
  v_add_f32 v182, v182, v72
  v_add_f32 v182, v182, v73
  v_add_f32 v182, v182, v74
  v_add_f32 v182, v182, v75
  v_add_f32 v182, v182, v76
  v_add_f32 v182, v182, v77
  v_add_f32 v182, v182, v78
  v_add_f32 v182, v182, v79
AT_l1:
  s_cmp_eq_u32 s69, 1
  s_cbranch_scc1 AT_v1
  s_cmp_ge_u32 s77, 62
  s_cbranch_scc1 AT_k1
  s_branch AT_c1
AT_h1:
  s_sleep 2
AT_c1:
  buffer_load_dword v172, off, s[8:11], s70 sc1
  s_add_u32 s65, s65, 1
  s_cmp_lt_u32 s65, 131072
  s_cselect_b32 s54, -2, -1
  s_waitcnt vmcnt(0)
  v_cmp_lt_u32 vcc, s54, v172
  s_cbranch_vccnz AT_h1
AT_k1:
  buffer_load_dwordx4 v[172:175], v201, s[8:11], s76 offen sc1
AT_v1:
  s_mov_b32 s69, 0
  s_add_u32 s65, s65, 1
  s_cmp_lt_u32 s65, 131072
  s_cselect_b32 s54, -2, -1
  s_waitcnt vmcnt(0)
  ds_write_b64 v220, v[172:173] offset:4096
  ds_write_b64 v221, v[174:175] offset:4096
  v_max3_u32 v213, v172, v173, v174
  v_max_u32 v213, v213, v175
  v_cmp_lt_u32 vcc, s54, v213
  s_cbranch_vccnz AT_k1
  s_waitcnt lgkmcnt(0)
  s_barrier
  ds_read_b128 v[128:131], v218 offset:4096
  ds_read_b128 v[132:135], v218 offset:4352
  ds_read_b128 v[136:139], v218 offset:4608
  ds_read_b128 v[140:143], v218 offset:4864
  ds_read_b128 v[144:147], v218 offset:5120
  ds_read_b128 v[148:151], v218 offset:5376
  ds_read_b128 v[152:155], v218 offset:5632
  ds_read_b128 v[156:159], v218 offset:5888
  ds_read_b32 v168, v219 offset:4096
  ds_read_b32 v169, v219 offset:4224
  s_waitcnt lgkmcnt(9)
  v_mfma_f32_32x32x16_bf16 v[80:95], v[128:131], a[144:147], 0
  s_waitcnt lgkmcnt(8)
  v_mfma_f32_32x32x16_bf16 v[80:95], v[132:135], a[148:151], v[80:95]
  s_waitcnt lgkmcnt(7)
  v_mfma_f32_32x32x16_bf16 v[80:95], v[136:139], a[152:155], v[80:95]
  s_waitcnt lgkmcnt(6)
  v_mfma_f32_32x32x16_bf16 v[80:95], v[140:143], a[156:159], v[80:95]
  s_waitcnt lgkmcnt(5)
  v_mfma_f32_32x32x16_bf16 v[80:95], v[144:147], a[160:163], v[80:95]
  s_waitcnt lgkmcnt(4)
  v_mfma_f32_32x32x16_bf16 v[80:95], v[148:151], a[164:167], v[80:95]
  s_waitcnt lgkmcnt(3)
  v_mfma_f32_32x32x16_bf16 v[80:95], v[152:155], a[168:171], v[80:95]
  s_waitcnt lgkmcnt(2)
  v_mfma_f32_32x32x16_bf16 v[80:95], v[156:159], a[172:175], v[80:95]
  s_add_u32 s77, s77, 2
  v_mov_b32 v212, s77
  s_nop 9
  v_mul_f32 v80, s68, v80
  v_mul_f32 v81, s68, v81
  v_mul_f32 v82, s68, v82
  v_mul_f32 v83, s68, v83
  v_max3_f32 v84, v184, v80, v81
  v_max3_f32 v84, v84, v82, v83
  v_mov_b32 v85, v84
  s_nop 1
  v_permlane32_swap_b32 v84, v85
  v_max_f32 v84, v84, v85
  v_sub_f32 v86, v184, v84
  v_sub_f32 v80, v80, v84
  v_sub_f32 v81, v81, v84
  v_sub_f32 v82, v82, v84
  v_sub_f32 v83, v83, v84
  v_exp_f32 v86, v86
  v_exp_f32 v80, v80
  v_exp_f32 v81, v81
  v_exp_f32 v82, v82
  v_exp_f32 v83, v83
  v_fma_f32 v186, v186, v86, v80
  v_add_f32 v84, v81, v82
  v_add_f32 v186, v186, v83
  v_add_f32 v186, v186, v84
  v_mov_b32 v187, v186
  s_nop 1
  v_permlane32_swap_b32 v186, v187
  v_add_f32 v186, v186, v187
  v_rcp_f32 v186, v186
  s_nop 0
  v_mul_f32 v86, v86, v186
  v_mul_f32 v80, v186, v80
  v_mul_f32 v81, v186, v81
  v_mul_f32 v82, v186, v82
  v_mul_f32 v83, v186, v83
  v_cvt_pk_bf16_f32 v28, v80, v81
  v_cvt_pk_bf16_f32 v29, v82, v83
  v_mul_f32 v224, v86, v224
  v_mul_f32 v225, v86, v225
  v_mul_f32 v226, v86, v226
  v_mul_f32 v227, v86, v227
  v_mul_f32 v228, v86, v228
  v_mul_f32 v229, v86, v229
  v_mul_f32 v230, v86, v230
  v_mul_f32 v231, v86, v231
  v_mul_f32 v232, v86, v232
  v_mul_f32 v233, v86, v233
  v_mul_f32 v234, v86, v234
  v_mul_f32 v235, v86, v235
  v_mul_f32 v236, v86, v236
  v_mul_f32 v237, v86, v237
  v_mul_f32 v238, v86, v238
  v_mul_f32 v239, v86, v239
  s_waitcnt lgkmcnt(0)
  s_nop 0
  v_mfma_f32_32x32x8_bf16 v[224:239], v[168:169], v[28:29], v[224:239]
  s_nop 11
  v_cvt_pk_bf16_f32 v20, v224, v225
  v_cvt_pk_bf16_f32 v21, v226, v227
  v_cvt_pk_bf16_f32 v22, v228, v229
  v_cvt_pk_bf16_f32 v23, v230, v231
  buffer_store_dwordx4 v[20:23], v201, s[8:11], s75 offen offset:0 sc1
  v_cvt_pk_bf16_f32 v24, v232, v233
  v_cvt_pk_bf16_f32 v25, v234, v235
  v_cvt_pk_bf16_f32 v26, v236, v237
  v_cvt_pk_bf16_f32 v27, v238, v239
  buffer_store_dwordx4 v[24:27], v201, s[8:11], s75 offen offset:1024 sc1
  s_mov_b64 exec, 1
  buffer_store_dword v212, v201, s[8:11], s71 offen sc1
  s_mov_b64 exec, -1
  s_cmp_ge_u32 s77, 64
  s_cbranch_scc1 L_exit
  s_branch AT_loop
L_cexit:
L_exit:
L_end:
s_endpgm
.section .rodata,"a"
.p2align 6
.amdhsa_kernel gated_mix__sliding_local_dilated__memory_aug_recurrent_mem_tr__prompt_kernel
  .amdhsa_next_free_vgpr 512
  .amdhsa_next_free_sgpr 102
  .amdhsa_accum_offset 256
  .amdhsa_group_segment_fixed_size 0
  .amdhsa_kernarg_size 112
  .amdhsa_user_sgpr_count 2
  .amdhsa_user_sgpr_kernarg_segment_ptr 1
  .amdhsa_system_sgpr_workgroup_id_x 1
.end_amdhsa_kernel
```

```asm
; @launch grid=(256,1,1) block=(256,1,1) lds=163840
.amdgcn_target "amdgcn-amd-amdhsa--gfx950"
.text
.globl gated_mix__sliding_local_dilated__memory_aug_recurrent_mem_tr__prompt_kernel
.p2align 8
.type gated_mix__sliding_local_dilated__memory_aug_recurrent_mem_tr__prompt_kernel,@function
gated_mix__sliding_local_dilated__memory_aug_recurrent_mem_tr__prompt_kernel:
  s_cmp_ge_u32 s2, 256
  s_cbranch_scc1 L_end
  s_load_dwordx2 s[4:5], s[0:1], 0
  s_load_dwordx2 s[8:9], s[0:1], 104
  s_load_dwordx2 s[12:13], s[0:1], 96
  s_load_dwordx2 s[16:17], s[0:1], 40
  s_load_dwordx2 s[20:21], s[0:1], 48
  s_load_dwordx2 s[24:25], s[0:1], 56
  s_load_dwordx2 s[28:29], s[0:1], 64
  s_load_dwordx2 s[32:33], s[0:1], 32
  s_load_dwordx2 s[36:37], s[0:1], 8
  s_load_dwordx2 s[40:41], s[0:1], 16
  s_load_dwordx2 s[44:45], s[0:1], 80
  s_load_dwordx2 s[48:49], s[0:1], 88
  s_getreg_b32 s54, hwreg(HW_REG_XCC_ID, 0, 3)
  v_lshrrev_b32 v1, 6, v0
  s_nop 0
  v_readfirstlane_b32 s52, v1
  s_mov_b32 s6, 2359296
  s_mov_b32 s7, 0x20000
  s_mov_b32 s10, 268435456
  s_mov_b32 s11, 0x20000
  s_mov_b32 s14, 256
  s_mov_b32 s15, 0x20000
  s_mov_b32 s18, 4718592
  s_mov_b32 s19, 0x20000
  s_mov_b32 s22, 4718592
  s_mov_b32 s23, 0x20000
  s_mov_b32 s26, 4718592
  s_mov_b32 s27, 0x20000
  s_mov_b32 s30, 4718592
  s_mov_b32 s31, 0x20000
  s_mov_b32 s34, 9216
  s_mov_b32 s35, 0x20000
  s_mov_b32 s38, 1990656
  s_mov_b32 s39, 0x20000
  s_mov_b32 s42, 663552
  s_mov_b32 s43, 0x20000
  s_mov_b32 s46, 1152
  s_mov_b32 s47, 0x20000
  s_mov_b32 s50, 2359296
  s_mov_b32 s51, 0x20000
  s_waitcnt lgkmcnt(0)
  s_lshr_b32 s0, s2, 3
  s_mov_b32 s2, s54
  s_mov_b32 s1, 0
  s_lshl_b32 s55, s2, 2
  s_cmp_eq_u32 s52, 0
  s_cselect_b32 s55, s55, 0x1000
  s_lshl_b32 s56, 1, s0
  v_mov_b32 v1, 0
  v_mov_b32 v35, s56
  s_mov_b64 exec, 1
  buffer_atomic_or v35, v1, s[12:15], s55 offen sc0
  s_mov_b64 exec, -1
L_role:
  s_mov_b32 s53, s0
  s_cmp_eq_u32 s2, 0
  s_cbranch_scc0 L_worker
  v_and_b32 v0, 63, v0
  v_and_b32 v1, 15, v0
  v_lshrrev_b32 v2, 4, v0
  v_and_b32 v3, 1, v2
  s_lshl_b32 s54, s52, 1
  v_add_u32 v3, s54, v3
  v_lshlrev_b32 v3, 1, v3
  v_xor_b32 v3, v3, v1
  v_lshlrev_b32 v3, 4, v3
  v_lshl_add_u32 v8, v2, 13, v3
  s_lshl_b32 s78, s53, 8
  s_lshl_b32 s54, s52, 15
  s_add_u32 s78, s78, s54
  s_mul_i32 s79, s53, 147456
  s_lshl_b32 s57, s52, 10
  s_add_u32 s57, s57, 16384
  s_getpc_b64 s[80:81]
L_pc_1:
  s_and_b32 s55, s0, 1
  s_lshl_b32 s55, s55, 2
  s_add_u32 s55, s55, s52
  s_lshl_b32 s55, s55, 10
  v_and_b32 v199, 63, v0
  v_lshl_add_u32 v199, v199, 4, s55
  v_min_u32 v199, (L_w0 - L_pc_1), v199
  global_load_dword v196, v199, s[80:81]
  s_add_u32 m0, s57, 0
  s_add_u32 s54, s78, 0
  buffer_load_dwordx4 v8, s[16:19], s54 offen  lds
  s_add_u32 m0, s57, 4096
  s_add_u32 s54, s78, 131072
  buffer_load_dwordx4 v8, s[16:19], s54 offen  lds
  s_add_u32 m0, s57, 8192
  s_add_u32 s54, s78, 262144
  buffer_load_dwordx4 v8, s[16:19], s54 offen  lds
  s_add_u32 m0, s57, 12288
  s_add_u32 s54, s78, 393216
  buffer_load_dwordx4 v8, s[16:19], s54 offen  lds
  s_add_u32 m0, s57, 16384
  s_add_u32 s54, s78, 524288
  buffer_load_dwordx4 v8, s[16:19], s54 offen  lds
  s_add_u32 m0, s57, 20480
  s_add_u32 s54, s78, 655360
  buffer_load_dwordx4 v8, s[16:19], s54 offen  lds
  s_add_u32 m0, s57, 24576
  s_add_u32 s54, s78, 786432
  buffer_load_dwordx4 v8, s[16:19], s54 offen  lds
  s_add_u32 m0, s57, 28672
  s_add_u32 s54, s78, 917504
  buffer_load_dwordx4 v8, s[16:19], s54 offen  lds
  s_add_u32 m0, s57, 32768
  s_add_u32 s54, s78, 1048576
  buffer_load_dwordx4 v8, s[16:19], s54 offen  lds
  s_add_u32 m0, s57, 36864
  s_add_u32 s54, s78, 1179648
  buffer_load_dwordx4 v8, s[16:19], s54 offen  lds
  s_add_u32 m0, s57, 40960
  s_add_u32 s54, s78, 1310720
  buffer_load_dwordx4 v8, s[16:19], s54 offen  lds
  s_add_u32 m0, s57, 45056
  s_add_u32 s54, s78, 1441792
  buffer_load_dwordx4 v8, s[16:19], s54 offen  lds
  s_add_u32 m0, s57, 49152
  s_add_u32 s54, s78, 1572864
  buffer_load_dwordx4 v8, s[16:19], s54 offen  lds
  s_add_u32 m0, s57, 53248
  s_add_u32 s54, s78, 1703936
  buffer_load_dwordx4 v8, s[16:19], s54 offen  lds
  s_add_u32 m0, s57, 57344
  s_add_u32 s54, s78, 1835008
  buffer_load_dwordx4 v8, s[16:19], s54 offen  lds
  s_add_u32 m0, s57, 61440
  s_add_u32 s54, s78, 1966080
  buffer_load_dwordx4 v8, s[16:19], s54 offen  lds
  s_add_u32 m0, s57, 65536
  s_add_u32 s54, s78, 2097152
  buffer_load_dwordx4 v8, s[16:19], s54 offen  lds
  s_add_u32 m0, s57, 69632
  s_add_u32 s54, s78, 2228224
  buffer_load_dwordx4 v8, s[16:19], s54 offen  lds
  s_add_u32 m0, s57, 73728
  s_add_u32 s54, s78, 2359296
  buffer_load_dwordx4 v8, s[16:19], s54 offen  lds
  s_add_u32 m0, s57, 77824
  s_add_u32 s54, s78, 2490368
  buffer_load_dwordx4 v8, s[16:19], s54 offen  lds
  v_lshlrev_b32 v76, 4, v0
  v_add_u32 v75, 0x10000, v76
  v_lshrrev_b32 v3, 2, v1
  v_and_b32 v4, 1, v1
  v_lshl_add_u32 v3, v3, 1, v4
  v_bfe_u32 v4, v1, 1, 1
  v_mul_u32_u24 v74, 0xaaaa, v4
  v_add_u32 v74, 0x4444, v74
  v_mul_u32_u24 v5, 576, v3
  v_add_u32 v5, 0, v5
  v_lshl_add_u32 v78, v2, 4, v5
  v_lshl_add_u32 v77, v2, 5, v5
  v_lshl_add_u32 v77, v4, 4, v77
  v_mul_u32_u24 v15, 1152, v3
  v_lshl_add_u32 v15, v2, 5, v15
  v_lshl_add_u32 v15, v4, 4, v15
  s_lshl_b32 s54, s52, 8
  buffer_load_dwordx4 v[20:23], v15, s[32:35], s54 offen
  buffer_load_dwordx4 v[24:27], v15, s[32:35], s54 offen offset:128
  buffer_load_dwordx4 v[28:31], v15, s[32:35], 0 offen offset:1024
  v_mul_u32_u24 v79, 1152, v2
  v_lshl_add_u32 v79, v1, 2, v79
  s_lshl_b32 s54, s52, 6
  s_add_u32 s54, s54, 0
  v_add_u32 v79, s54, v79
  v_lshrrev_b32 v5, 3, v0
  v_mul_u32_u24 v68, 2176, v5
  v_and_b32 v5, 7, v0
  v_lshl_add_u32 v68, v5, 3, v68
  v_lshrrev_b32 v6, 3, v0
  s_lshr_b32 s54, s53, 2
  v_add_u32 v68, s54, v6
  v_and_b32 v68, 7, v68
  v_xor_b32 v68, v68, v6
  v_lshlrev_b32 v68, 8, v68
  v_lshl_add_u32 v68, v6, 12, v68
  v_lshl_add_u32 v68, v5, 3, v68
  s_and_b32 s54, s53, 3
  s_lshl_b32 s54, s54, 6
  v_add_u32 v68, s54, v68
  v_and_b32 v5, 1, v2
  v_lshlrev_b32 v5, 4, v5
  v_lshl_add_u32 v5, v1, 2, v5
  v_mov_b32 v6, 0x40000000
  v_cmp_lt_u32 vcc, 3, v1
  s_nop 1
  v_cndmask_b32 v5, v5, v6, vcc
  v_lshrrev_b32 v6, 1, v2
  v_lshl_add_u32 v69, v6, 10, v5
  v_lshl_add_u32 v70, v6, 8, v5
  v_mov_b32 v71, -1
  ds_write_b128 v76, v[68:71] offset:13824
  v_and_b32 v5, 3, v1
  v_lshrrev_b32 v6, 2, v1
  v_lshl_add_u32 v5, v5, 2, v6
  v_and_b32 v6, 1, v5
  v_lshlrev_b32 v6, 4, v6
  v_mov_b32 v7, 0x3f80
  v_lshlrev_b32 v6, v6, v7
  v_lshrrev_b32 v5, 1, v5
  v_cmp_eq_u32 vcc, 0, v5
  s_nop 1
  v_cndmask_b32 v40, 0, v6, vcc
  v_cmp_eq_u32 vcc, 1, v5
  s_nop 1
  v_cndmask_b32 v41, 0, v6, vcc
  v_cmp_eq_u32 vcc, 2, v5
  s_nop 1
  v_cndmask_b32 v42, 0, v6, vcc
  v_cmp_eq_u32 vcc, 3, v5
  s_nop 1
  v_cndmask_b32 v43, 0, v6, vcc
  ds_write_b128 v76, v[40:43] offset:14848
  s_and_b32 s54, s52, 1
  s_lshr_b32 s55, s52, 1
  v_lshrrev_b32 v3, 3, v0
  v_and_b32 v4, 1, v3
  v_lshlrev_b32 v4, 4, v4
  v_and_b32 v5, 6, v3
  v_add_u32 v4, v4, v5
  s_lshl_b32 s56, s55, 3
  s_add_u32 s56, s56, s54
  v_add_u32 v4, s56, v4
  v_mul_u32_u24 v4, 1152, v4
  v_and_b32 v5, 2, v3
  v_lshlrev_b32 v5, 1, v5
  v_and_b32 v6, 7, v0
  v_xor_b32 v6, v6, v5
  v_lshl_add_u32 v9, v6, 4, v4
  v_and_b32 v4, 1, v2
  v_lshlrev_b32 v4, 4, v4
  v_and_b32 v5, 2, v2
  v_add_u32 v4, v4, v5
  s_lshl_b32 s56, s55, 2
  s_add_u32 s56, s56, s54
  v_add_u32 v4, s56, v4
  v_mul_u32_u24 v4, 1152, v4
  v_lshlrev_b32 v6, 1, v2
  v_xor_b32 v6, v6, v1
  v_lshl_add_u32 v10, v6, 4, v4
  v_bfe_u32 v17, v1, 2, 1
  v_bfe_u32 v18, v1, 3, 1
  v_and_b32 v19, 1, v2
  v_lshrrev_b32 v72, 1, v2
  v_and_b32 v73, 3, v1
  v_lshl_add_u32 v3, v19, 1, v17
  v_lshl_add_u32 v6, v18, 2, v3
  v_lshl_add_u32 v4, v72, 4, v17
  v_lshl_add_u32 v4, v19, 2, v4
  v_lshl_add_u32 v4, v18, 3, v4
  v_lshlrev_b32 v4, 8, v4
  s_lshl_b32 s54, s52, 6
  v_lshl_add_u32 v5, v73, 3, s54
  v_lshlrev_b32 v7, 5, v6
  v_xor_b32 v5, v5, v7
  v_add_u32 v11, v4, v5
  v_xor_b32 v12, 32, v11
  v_lshl_add_u32 v4, v72, 2, v3
  v_lshlrev_b32 v4, 7, v4
  v_lshl_add_u32 v4, v73, 3, v4
  s_and_b32 s54, s52, 1
  v_xor_b32 v7, s54, v19
  v_lshl_add_u32 v7, v7, 1, v18
  v_lshl_add_u32 v13, v7, 5, v4
  v_lshlrev_b32 v4, 11, v72
  v_lshl_add_u32 v4, v73, 3, v4
  v_lshl_add_u32 v5, v3, 8, v4
  v_lshl_add_u32 v7, v18, 2, s52
  v_xor_b32 v7, v7, v3
  v_lshl_add_u32 v14, v7, 5, v5
  s_lshl_b32 s54, s53, 14
  s_lshl_b32 s55, s52, 11
  s_add_u32 s54, s54, 1048576
  s_add_u32 s58, s54, s55
  s_add_u32 s59, s58, 8192
  s_lshl_b32 s55, s52, 12
  s_add_u32 s70, s54, s55
  s_add_u32 s70, s70, 655360
  s_lshl_b32 s54, s53, 12
  s_lshl_b32 s55, s52, 10
  s_add_u32 s54, s54, s55
  s_add_u32 s68, s54, 917504
  s_lshl_b32 s54, s53, 6
  s_mul_i32 s55, s52, 17408
  s_add_u32 s55, s54, s55
  s_add_u32 s73, s55, 0
  s_add_u32 s74, s55, 69632
  s_add_u32 s75, s55, 139264
  s_add_u32 s76, s55, 208896
  s_and_b32 s56, s52, 1
  s_mul_i32 s55, s56, 17408
  s_add_u32 s55, s54, s55
  s_add_u32 s77, s55, 278528
  s_mul_i32 s54, s52, 69632
  s_mul_i32 s55, s53, 2176
  s_add_u32 s54, s54, s55
  s_add_u32 s60, s54, 0
  s_and_b32 s56, s53, 15
  s_mul_i32 s55, s56, 2176
  s_add_u32 s61, s55, 278528
  s_lshr_b32 s54, s52, 1
  s_lshl_b32 s54, s54, 15
  s_and_b32 s55, s52, 1
  s_lshl_b32 s55, s55, 11
  s_add_u32 s54, s54, s55
  s_add_u32 s73, s54, 0
  s_add_u32 s74, s54, 65536
  s_add_u32 s75, s54, 131072
  s_add_u32 s76, s54, 196608
  s_add_u32 s77, s55, 262144
  s_and_b32 s54, s53, 7
  s_lshl_b32 s54, s54, 12
  s_bfe_u32 s55, s53, 0x10003
  s_lshl_b32 s55, s55, 11
  s_add_u32 s54, s54, s55
  s_add_u32 s61, s54, 262144
  s_lshr_b32 s55, s53, 4
  s_lshl_b32 s55, s55, 15
  s_add_u32 s54, s54, s55
  s_lshl_b32 s55, s52, 16
  s_add_u32 s54, s54, s55
  s_add_u32 s60, s54, 0
  s_lshl_b32 s54, s52, 11
  s_add_u32 s64, s54, 360448
  s_mov_b32 s65, 368640
  s_lshl_b32 s55, s53, 5
  s_add_u32 s54, s54, s55
  s_add_u32 s62, s54, 376832
  s_lshr_b32 s54, s56, 3
  s_lshl_b32 s54, s54, 9
  s_and_b32 s55, s56, 7
  s_lshl_b32 s55, s55, 5
  s_add_u32 s54, s54, s55
  s_add_u32 s63, s54, 385024
  s_mov_b32 s66, 0
  s_mov_b32 s67, 0
  s_mov_b32 s72, 0
  s_mov_b32 s69, 1040356334
  s_waitcnt vmcnt(19) lgkmcnt(0)
  s_barrier
  s_add_u32 m0, s57, 81920
  s_add_u32 s54, s78, 2621440
  buffer_load_dwordx4 v8, s[16:19], s54 offen  lds
  s_add_u32 m0, s57, 86016
  s_add_u32 s54, s78, 2752512
  buffer_load_dwordx4 v8, s[16:19], s54 offen  lds
  s_add_u32 m0, s57, 90112
  s_add_u32 s54, s78, 2883584
  buffer_load_dwordx4 v8, s[16:19], s54 offen  lds
  s_add_u32 m0, s57, 94208
  s_add_u32 s54, s78, 3014656
  buffer_load_dwordx4 v8, s[16:19], s54 offen  lds
  v_add_u32 v15, 16384, v11
  v_add_u32 v16, 16384, v12
  ds_read_b64_tr_b16 v[80:81], v15 offset:0
  ds_read_b64_tr_b16 v[82:83], v15 offset:512
  ds_read_b64_tr_b16 v[84:85], v15 offset:8192
  ds_read_b64_tr_b16 v[86:87], v15 offset:8704
  ds_read_b64_tr_b16 v[88:89], v16 offset:0
  ds_read_b64_tr_b16 v[90:91], v16 offset:512
  ds_read_b64_tr_b16 v[92:93], v16 offset:8192
  ds_read_b64_tr_b16 v[94:95], v16 offset:8704
  s_waitcnt vmcnt(19) lgkmcnt(0)
  s_barrier
  s_add_u32 m0, s57, 98304
  s_add_u32 s54, s78, 3670016
  buffer_load_dwordx4 v8, s[16:19], s54 offen  lds
  s_add_u32 m0, s57, 102400
  s_add_u32 s54, s78, 3801088
  buffer_load_dwordx4 v8, s[16:19], s54 offen  lds
  s_add_u32 m0, s57, 106496
  s_add_u32 s54, s78, 3932160
  buffer_load_dwordx4 v8, s[16:19], s54 offen  lds
  s_add_u32 m0, s57, 110592
  s_add_u32 s54, s78, 4063232
  buffer_load_dwordx4 v8, s[16:19], s54 offen  lds
  v_add_u32 v15, 32768, v11
  v_add_u32 v16, 32768, v12
  ds_read_b64_tr_b16 v[96:97], v15 offset:0
  ds_read_b64_tr_b16 v[98:99], v15 offset:512
  ds_read_b64_tr_b16 v[100:101], v15 offset:8192
  ds_read_b64_tr_b16 v[102:103], v15 offset:8704
  ds_read_b64_tr_b16 v[104:105], v16 offset:0
  ds_read_b64_tr_b16 v[106:107], v16 offset:512
  ds_read_b64_tr_b16 v[108:109], v16 offset:8192
  ds_read_b64_tr_b16 v[110:111], v16 offset:8704
  s_waitcnt vmcnt(19) lgkmcnt(0)
  s_barrier
  s_add_u32 m0, s57, 114688
  s_add_u32 s54, s78, 4194304
  buffer_load_dwordx4 v8, s[16:19], s54 offen  lds
  s_add_u32 m0, s57, 118784
  s_add_u32 s54, s78, 4325376
  buffer_load_dwordx4 v8, s[16:19], s54 offen  lds
  s_add_u32 m0, s57, 122880
  s_add_u32 s54, s78, 4456448
  buffer_load_dwordx4 v8, s[16:19], s54 offen  lds
  s_add_u32 m0, s57, 126976
  s_add_u32 s54, s78, 4587520
  buffer_load_dwordx4 v8, s[16:19], s54 offen  lds
  v_add_u32 v15, 49152, v11
  v_add_u32 v16, 49152, v12
  ds_read_b64_tr_b16 v[112:113], v15 offset:0
  ds_read_b64_tr_b16 v[114:115], v15 offset:512
  ds_read_b64_tr_b16 v[116:117], v15 offset:8192
  ds_read_b64_tr_b16 v[118:119], v15 offset:8704
  ds_read_b64_tr_b16 v[120:121], v16 offset:0
  ds_read_b64_tr_b16 v[122:123], v16 offset:512
  ds_read_b64_tr_b16 v[124:125], v16 offset:8192
  ds_read_b64_tr_b16 v[126:127], v16 offset:8704
  s_waitcnt vmcnt(19) lgkmcnt(0)
  s_barrier
  s_add_u32 m0, s57, 131072
  s_add_u32 s54, s78, 1048576
  buffer_load_dwordx4 v8, s[20:23], s54 offen  lds
  s_add_u32 m0, s57, 135168
  s_add_u32 s54, s78, 1179648
  buffer_load_dwordx4 v8, s[20:23], s54 offen  lds
  s_add_u32 m0, s57, 139264
  s_add_u32 s54, s78, 1310720
  buffer_load_dwordx4 v8, s[20:23], s54 offen  lds
  s_add_u32 m0, s57, 143360
  s_add_u32 s54, s78, 1441792
  buffer_load_dwordx4 v8, s[20:23], s54 offen  lds
  v_add_u32 v15, 65536, v11
  v_add_u32 v16, 65536, v12
  ds_read_b64_tr_b16 v[128:129], v15 offset:0
  ds_read_b64_tr_b16 v[130:131], v15 offset:512
  ds_read_b64_tr_b16 v[132:133], v15 offset:8192
  ds_read_b64_tr_b16 v[134:135], v15 offset:8704
  ds_read_b64_tr_b16 v[136:137], v16 offset:0
  ds_read_b64_tr_b16 v[138:139], v16 offset:512
  ds_read_b64_tr_b16 v[140:141], v16 offset:8192
  ds_read_b64_tr_b16 v[142:143], v16 offset:8704
  s_waitcnt vmcnt(19) lgkmcnt(0)
  s_barrier
  s_add_u32 m0, s57, 0
  s_add_u32 s54, s78, 1572864
  buffer_load_dwordx4 v8, s[20:23], s54 offen  lds
  s_add_u32 m0, s57, 4096
  s_add_u32 s54, s78, 1703936
  buffer_load_dwordx4 v8, s[20:23], s54 offen  lds
  s_add_u32 m0, s57, 8192
  s_add_u32 s54, s78, 1835008
  buffer_load_dwordx4 v8, s[20:23], s54 offen  lds
  s_add_u32 m0, s57, 12288
  s_add_u32 s54, s78, 1966080
  buffer_load_dwordx4 v8, s[20:23], s54 offen  lds
  v_add_u32 v15, 81920, v11
  v_add_u32 v16, 81920, v12
  ds_read_b64_tr_b16 v[144:145], v15 offset:0
  ds_read_b64_tr_b16 v[146:147], v15 offset:512
  ds_read_b64_tr_b16 v[148:149], v15 offset:8192
  ds_read_b64_tr_b16 v[150:151], v15 offset:8704
  ds_read_b64_tr_b16 v[152:153], v16 offset:0
  ds_read_b64_tr_b16 v[154:155], v16 offset:512
  ds_read_b64_tr_b16 v[156:157], v16 offset:8192
  ds_read_b64_tr_b16 v[158:159], v16 offset:8704
  s_waitcnt vmcnt(16) lgkmcnt(0)
  s_barrier
  s_add_u32 m0, s57, 16384
  s_add_u32 s54, s78, 3145728
  buffer_load_dwordx4 v8, s[20:23], s54 offen  lds
  s_add_u32 m0, s57, 20480
  s_add_u32 s54, s78, 3276800
  buffer_load_dwordx4 v8, s[20:23], s54 offen  lds
  s_add_u32 m0, s57, 24576
  s_add_u32 s54, s78, 3407872
  buffer_load_dwordx4 v8, s[20:23], s54 offen  lds
  s_add_u32 m0, s57, 28672
  s_add_u32 s54, s78, 3538944
  buffer_load_dwordx4 v8, s[20:23], s54 offen  lds
  v_add_u32 v15, 98304, v11
  v_add_u32 v16, 98304, v12
  ds_read_b64_tr_b16 v[160:161], v15 offset:0
  ds_read_b64_tr_b16 v[162:163], v15 offset:512
  ds_read_b64_tr_b16 v[164:165], v15 offset:8192
  ds_read_b64_tr_b16 v[166:167], v15 offset:8704
  ds_read_b64_tr_b16 v[168:169], v16 offset:0
  ds_read_b64_tr_b16 v[170:171], v16 offset:512
  ds_read_b64_tr_b16 v[172:173], v16 offset:8192
  ds_read_b64_tr_b16 v[174:175], v16 offset:8704
  s_waitcnt vmcnt(16) lgkmcnt(0)
  s_barrier
  s_add_u32 m0, s57, 32768
  s_add_u32 s54, s78, 3670016
  buffer_load_dwordx4 v8, s[20:23], s54 offen  lds
  s_add_u32 m0, s57, 36864
  s_add_u32 s54, s78, 3801088
  buffer_load_dwordx4 v8, s[20:23], s54 offen  lds
  s_add_u32 m0, s57, 40960
  s_add_u32 s54, s78, 3932160
  buffer_load_dwordx4 v8, s[20:23], s54 offen  lds
  s_add_u32 m0, s57, 45056
  s_add_u32 s54, s78, 4063232
  buffer_load_dwordx4 v8, s[20:23], s54 offen  lds
  s_cmp_eq_u32 s1, 1
  s_cbranch_scc1 C_ver_ok
  v_mov_b32 v33, 16320
  s_cmp_eq_u32 s52, 0
  s_cbranch_scc0 C_ver_b
  s_waitcnt vmcnt(52)
  s_mov_b64 exec, 1
  ds_write_b32 v33, v35
  s_mov_b64 exec, -1
  s_waitcnt lgkmcnt(0)
C_ver_b:
  s_barrier
  ds_read_b32 v32, v33
  s_waitcnt lgkmcnt(0)
  v_readfirstlane_b32 s54, v32
  s_nop 0
  s_bitcmp1_b32 s54, s0
  s_cbranch_scc1 L_conf
C_ver_ok:
  v_add_u32 v15, 114688, v11
  v_add_u32 v16, 114688, v12
  ds_read_b64_tr_b16 v[176:177], v15 offset:0
  ds_read_b64_tr_b16 v[178:179], v15 offset:512
  ds_read_b64_tr_b16 v[180:181], v15 offset:8192
  ds_read_b64_tr_b16 v[182:183], v15 offset:8704
  ds_read_b64_tr_b16 v[184:185], v16 offset:0
  ds_read_b64_tr_b16 v[186:187], v16 offset:512
  ds_read_b64_tr_b16 v[188:189], v16 offset:8192
  ds_read_b64_tr_b16 v[190:191], v16 offset:8704
  s_waitcnt vmcnt(16) lgkmcnt(0)
  s_barrier
  s_add_u32 m0, s57, 49152
  s_add_u32 s54, s78, 4194304
  buffer_load_dwordx4 v8, s[20:23], s54 offen  lds
  s_add_u32 m0, s57, 53248
  s_add_u32 s54, s78, 4325376
  buffer_load_dwordx4 v8, s[20:23], s54 offen  lds
  s_add_u32 m0, s57, 57344
  s_add_u32 s54, s78, 4456448
  buffer_load_dwordx4 v8, s[20:23], s54 offen  lds
  s_add_u32 m0, s57, 61440
  s_add_u32 s54, s78, 4587520
  buffer_load_dwordx4 v8, s[20:23], s54 offen  lds
  v_add_u32 v15, 131072, v11
  v_add_u32 v16, 131072, v12
  ds_read_b64_tr_b16 v[192:193], v15 offset:0
  ds_read_b64_tr_b16 v[194:195], v15 offset:512
  ds_read_b64_tr_b16 v[196:197], v15 offset:8192
  ds_read_b64_tr_b16 v[198:199], v15 offset:8704
  ds_read_b64_tr_b16 v[200:201], v16 offset:0
  ds_read_b64_tr_b16 v[202:203], v16 offset:512
  ds_read_b64_tr_b16 v[204:205], v16 offset:8192
  ds_read_b64_tr_b16 v[206:207], v16 offset:8704
  s_waitcnt vmcnt(16) lgkmcnt(0)
  s_barrier
  s_add_u32 m0, s57, 65536
  s_add_u32 s54, s78, 0
  buffer_load_dwordx4 v8, s[24:27], s54 offen  lds
  s_add_u32 m0, s57, 69632
  s_add_u32 s54, s78, 131072
  buffer_load_dwordx4 v8, s[24:27], s54 offen  lds
  s_add_u32 m0, s57, 73728
  s_add_u32 s54, s78, 262144
  buffer_load_dwordx4 v8, s[24:27], s54 offen  lds
  s_add_u32 m0, s57, 77824
  s_add_u32 s54, s78, 393216
  buffer_load_dwordx4 v8, s[24:27], s54 offen  lds
  s_getpc_b64 s[80:81]
  v_lshlrev_b32 v7, 2, v76
  global_load_dword v35, v7, s[80:81] offset:1024
  v_min_u32 v20, -2, v20
  v_min_u32 v21, -2, v21
  v_min_u32 v22, -2, v22
  v_min_u32 v23, -2, v23
  v_min_u32 v24, -2, v24
  v_min_u32 v25, -2, v25
  v_min_u32 v26, -2, v26
  v_min_u32 v27, -2, v27
  v_min_u32 v28, -2, v28
  v_min_u32 v29, -2, v29
  v_min_u32 v30, -2, v30
  v_min_u32 v31, -2, v31
  s_lshl_b32 s54, s52, 11
  v_add_u32 v3, s54, v76
  ds_write_b128 v3, v[20:23] offset:4608
  ds_write_b128 v3, v[24:27] offset:5632
  ds_write_b128 v76, v[28:31] offset:12800
  v_add_u32 v15, 147456, v11
  v_add_u32 v16, 147456, v12
  ds_read_b64_tr_b16 v[208:209], v15 offset:0
  ds_read_b64_tr_b16 v[210:211], v15 offset:512
  ds_read_b64_tr_b16 v[212:213], v15 offset:8192
  ds_read_b64_tr_b16 v[214:215], v15 offset:8704
  ds_read_b64_tr_b16 v[216:217], v16 offset:0
  ds_read_b64_tr_b16 v[218:219], v16 offset:512
  ds_read_b64_tr_b16 v[220:221], v16 offset:8192
  ds_read_b64_tr_b16 v[222:223], v16 offset:8704
  s_waitcnt vmcnt(17) lgkmcnt(0)
  s_barrier
  s_add_u32 m0, s57, 81920
  s_add_u32 s54, s78, 524288
  buffer_load_dwordx4 v8, s[24:27], s54 offen  lds
  s_add_u32 m0, s57, 86016
  s_add_u32 s54, s78, 655360
  buffer_load_dwordx4 v8, s[24:27], s54 offen  lds
  s_add_u32 m0, s57, 90112
  s_add_u32 s54, s78, 786432
  buffer_load_dwordx4 v8, s[24:27], s54 offen  lds
  s_add_u32 m0, s57, 94208
  s_add_u32 s54, s78, 917504
  buffer_load_dwordx4 v8, s[24:27], s54 offen  lds
  v_add_u32 v15, 16384, v11
  v_add_u32 v16, 16384, v12
  ds_read_b64_tr_b16 v[224:225], v15 offset:0
  ds_read_b64_tr_b16 v[226:227], v15 offset:512
  ds_read_b64_tr_b16 v[228:229], v15 offset:8192
  ds_read_b64_tr_b16 v[230:231], v15 offset:8704
  ds_read_b64_tr_b16 v[232:233], v16 offset:0
  ds_read_b64_tr_b16 v[234:235], v16 offset:512
  ds_read_b64_tr_b16 v[236:237], v16 offset:8192
  ds_read_b64_tr_b16 v[238:239], v16 offset:8704
  s_waitcnt vmcnt(17) lgkmcnt(0)
  s_barrier
  s_add_u32 m0, s57, 98304
  s_add_u32 s54, s78, 1048576
  buffer_load_dwordx4 v8, s[24:27], s54 offen  lds
  s_add_u32 m0, s57, 102400
  s_add_u32 s54, s78, 1179648
  buffer_load_dwordx4 v8, s[24:27], s54 offen  lds
  s_add_u32 m0, s57, 106496
  s_add_u32 s54, s78, 1310720
  buffer_load_dwordx4 v8, s[24:27], s54 offen  lds
  s_add_u32 m0, s57, 110592
  s_add_u32 s54, s78, 1441792
  buffer_load_dwordx4 v8, s[24:27], s54 offen  lds
  v_add_u32 v15, 32768, v11
  v_add_u32 v16, 32768, v12
  ds_read_b64_tr_b16 v[240:241], v15 offset:0
  ds_read_b64_tr_b16 v[242:243], v15 offset:512
  ds_read_b64_tr_b16 v[244:245], v15 offset:8192
  ds_read_b64_tr_b16 v[246:247], v15 offset:8704
  ds_read_b64_tr_b16 v[248:249], v16 offset:0
  ds_read_b64_tr_b16 v[250:251], v16 offset:512
  ds_read_b64_tr_b16 v[252:253], v16 offset:8192
  ds_read_b64_tr_b16 v[254:255], v16 offset:8704
  s_waitcnt vmcnt(17) lgkmcnt(0)
  s_barrier
  s_add_u32 m0, s57, 114688
  s_add_u32 s54, s78, 1572864
  buffer_load_dwordx4 v8, s[24:27], s54 offen  lds
  s_add_u32 m0, s57, 118784
  s_add_u32 s54, s78, 1703936
  buffer_load_dwordx4 v8, s[24:27], s54 offen  lds
  s_add_u32 m0, s57, 122880
  s_add_u32 s54, s78, 1835008
  buffer_load_dwordx4 v8, s[24:27], s54 offen  lds
  s_add_u32 m0, s57, 126976
  s_add_u32 s54, s78, 1966080
  buffer_load_dwordx4 v8, s[24:27], s54 offen  lds
  v_add_u32 v15, 49152, v11
  v_add_u32 v16, 49152, v12
  ds_read_b64_tr_b16 a[0:1], v15 offset:0
  ds_read_b64_tr_b16 a[2:3], v15 offset:512
  ds_read_b64_tr_b16 a[4:5], v15 offset:8192
  ds_read_b64_tr_b16 a[6:7], v15 offset:8704
  ds_read_b64_tr_b16 a[8:9], v16 offset:0
  ds_read_b64_tr_b16 a[10:11], v16 offset:512
  ds_read_b64_tr_b16 a[12:13], v16 offset:8192
  ds_read_b64_tr_b16 a[14:15], v16 offset:8704
  s_waitcnt vmcnt(17) lgkmcnt(0)
  s_barrier
  s_add_u32 m0, s57, 131072
  s_add_u32 s54, s78, 2097152
  buffer_load_dwordx4 v8, s[24:27], s54 offen  lds
  s_add_u32 m0, s57, 135168
  s_add_u32 s54, s78, 2228224
  buffer_load_dwordx4 v8, s[24:27], s54 offen  lds
  s_add_u32 m0, s57, 139264
  s_add_u32 s54, s78, 2359296
  buffer_load_dwordx4 v8, s[24:27], s54 offen  lds
  s_add_u32 m0, s57, 143360
  s_add_u32 s54, s78, 2490368
  buffer_load_dwordx4 v8, s[24:27], s54 offen  lds
  v_add_u32 v15, 65536, v11
  v_add_u32 v16, 65536, v12
  ds_read_b64_tr_b16 a[16:17], v15 offset:0
  ds_read_b64_tr_b16 a[18:19], v15 offset:512
  ds_read_b64_tr_b16 a[20:21], v15 offset:8192
  ds_read_b64_tr_b16 a[22:23], v15 offset:8704
  ds_read_b64_tr_b16 a[24:25], v16 offset:0
  ds_read_b64_tr_b16 a[26:27], v16 offset:512
  ds_read_b64_tr_b16 a[28:29], v16 offset:8192
  ds_read_b64_tr_b16 a[30:31], v16 offset:8704
  s_waitcnt vmcnt(17) lgkmcnt(0)
  s_barrier
  s_add_u32 m0, s57, 0
  s_add_u32 s54, s78, 2621440
  buffer_load_dwordx4 v8, s[24:27], s54 offen  lds
  s_add_u32 m0, s57, 4096
  s_add_u32 s54, s78, 2752512
  buffer_load_dwordx4 v8, s[24:27], s54 offen  lds
  s_add_u32 m0, s57, 8192
  s_add_u32 s54, s78, 2883584
  buffer_load_dwordx4 v8, s[24:27], s54 offen  lds
  s_add_u32 m0, s57, 12288
  s_add_u32 s54, s78, 3014656
  buffer_load_dwordx4 v8, s[24:27], s54 offen  lds
  v_add_u32 v15, 81920, v11
  v_add_u32 v16, 81920, v12
  ds_read_b64_tr_b16 a[32:33], v15 offset:0
  ds_read_b64_tr_b16 a[34:35], v15 offset:512
  ds_read_b64_tr_b16 a[36:37], v15 offset:8192
  ds_read_b64_tr_b16 a[38:39], v15 offset:8704
  ds_read_b64_tr_b16 a[40:41], v16 offset:0
  ds_read_b64_tr_b16 a[42:43], v16 offset:512
  ds_read_b64_tr_b16 a[44:45], v16 offset:8192
  ds_read_b64_tr_b16 a[46:47], v16 offset:8704
  s_waitcnt vmcnt(16) lgkmcnt(0)
  s_barrier
  s_add_u32 m0, s57, 16384
  s_add_u32 s54, s78, 3145728
  buffer_load_dwordx4 v8, s[24:27], s54 offen  lds
  s_add_u32 m0, s57, 20480
  s_add_u32 s54, s78, 3276800
  buffer_load_dwordx4 v8, s[24:27], s54 offen  lds
  s_add_u32 m0, s57, 24576
  s_add_u32 s54, s78, 3407872
  buffer_load_dwordx4 v8, s[24:27], s54 offen  lds
  s_add_u32 m0, s57, 28672
  s_add_u32 s54, s78, 3538944
  buffer_load_dwordx4 v8, s[24:27], s54 offen  lds
  s_getpc_b64 s[80:81]
  v_lshlrev_b32 v7, 2, v76
  global_load_dword v35, v7, s[80:81] offset:1024
  v_add_u32 v15, 98304, v11
  v_add_u32 v16, 98304, v12
  ds_read_b64_tr_b16 a[48:49], v15 offset:0
  ds_read_b64_tr_b16 a[50:51], v15 offset:512
  ds_read_b64_tr_b16 a[52:53], v15 offset:8192
  ds_read_b64_tr_b16 a[54:55], v15 offset:8704
  ds_read_b64_tr_b16 a[56:57], v16 offset:0
  ds_read_b64_tr_b16 a[58:59], v16 offset:512
  ds_read_b64_tr_b16 a[60:61], v16 offset:8192
  ds_read_b64_tr_b16 a[62:63], v16 offset:8704
  s_waitcnt vmcnt(17) lgkmcnt(0)
  s_barrier
  s_add_u32 m0, s57, 32768
  s_add_u32 s54, s78, 3670016
  buffer_load_dwordx4 v8, s[24:27], s54 offen  lds
  s_add_u32 m0, s57, 36864
  s_add_u32 s54, s78, 3801088
  buffer_load_dwordx4 v8, s[24:27], s54 offen  lds
  s_add_u32 m0, s57, 40960
  s_add_u32 s54, s78, 3932160
  buffer_load_dwordx4 v8, s[24:27], s54 offen  lds
  s_add_u32 m0, s57, 45056
  s_add_u32 s54, s78, 4063232
  buffer_load_dwordx4 v8, s[24:27], s54 offen  lds
  v_add_u32 v15, 114688, v11
  v_add_u32 v16, 114688, v12
  ds_read_b64_tr_b16 a[64:65], v15 offset:0
  ds_read_b64_tr_b16 a[66:67], v15 offset:512
  ds_read_b64_tr_b16 a[68:69], v15 offset:8192
  ds_read_b64_tr_b16 a[70:71], v15 offset:8704
  ds_read_b64_tr_b16 a[72:73], v16 offset:0
  ds_read_b64_tr_b16 a[74:75], v16 offset:512
  ds_read_b64_tr_b16 a[76:77], v16 offset:8192
  ds_read_b64_tr_b16 a[78:79], v16 offset:8704
  s_waitcnt vmcnt(17) lgkmcnt(0)
  s_barrier
  s_add_u32 m0, s57, 49152
  s_add_u32 s54, s78, 4194304
  buffer_load_dwordx4 v8, s[24:27], s54 offen  lds
  s_add_u32 m0, s57, 53248
  s_add_u32 s54, s78, 4325376
  buffer_load_dwordx4 v8, s[24:27], s54 offen  lds
  s_add_u32 m0, s57, 57344
  s_add_u32 s54, s78, 4456448
  buffer_load_dwordx4 v8, s[24:27], s54 offen  lds
  s_add_u32 m0, s57, 61440
  s_add_u32 s54, s78, 4587520
  buffer_load_dwordx4 v8, s[24:27], s54 offen  lds
  v_add_u32 v15, 131072, v11
  v_add_u32 v16, 131072, v12
  ds_read_b64_tr_b16 a[80:81], v15 offset:0
  ds_read_b64_tr_b16 a[82:83], v15 offset:512
  ds_read_b64_tr_b16 a[84:85], v15 offset:8192
  ds_read_b64_tr_b16 a[86:87], v15 offset:8704
  ds_read_b64_tr_b16 a[88:89], v16 offset:0
  ds_read_b64_tr_b16 a[90:91], v16 offset:512
  ds_read_b64_tr_b16 a[92:93], v16 offset:8192
  ds_read_b64_tr_b16 a[94:95], v16 offset:8704
  s_waitcnt vmcnt(17) lgkmcnt(0)
  s_barrier
  s_add_u32 m0, s57, 65536
  s_add_u32 s54, s79, 73728
  buffer_load_dwordx4 v10, s[28:31], s54 offen  lds
  s_add_u32 m0, s57, 69632
  s_add_u32 s54, s79, 82944
  buffer_load_dwordx4 v10, s[28:31], s54 offen  lds
  s_add_u32 m0, s57, 73728
  s_add_u32 s54, s79, 110592
  buffer_load_dwordx4 v10, s[28:31], s54 offen  lds
  s_add_u32 m0, s57, 77824
  s_add_u32 s54, s79, 119808
  buffer_load_dwordx4 v10, s[28:31], s54 offen  lds
  v_add_u32 v15, 147456, v11
  v_add_u32 v16, 147456, v12
  ds_read_b64_tr_b16 a[96:97], v15 offset:0
  ds_read_b64_tr_b16 a[98:99], v15 offset:512
  ds_read_b64_tr_b16 a[100:101], v15 offset:8192
  ds_read_b64_tr_b16 a[102:103], v15 offset:8704
  ds_read_b64_tr_b16 a[104:105], v16 offset:0
  ds_read_b64_tr_b16 a[106:107], v16 offset:512
  ds_read_b64_tr_b16 a[108:109], v16 offset:8192
  ds_read_b64_tr_b16 a[110:111], v16 offset:8704
  s_waitcnt vmcnt(17) lgkmcnt(0)
  s_barrier
  s_add_u32 m0, s57, 81920
  s_add_u32 s54, s79, 256
  buffer_load_dwordx4 v10, s[28:31], s54 offen  lds
  s_add_u32 m0, s57, 86016
  s_add_u32 s54, s79, 9472
  buffer_load_dwordx4 v10, s[28:31], s54 offen  lds
  s_add_u32 m0, s57, 90112
  s_add_u32 s54, s79, 37120
  buffer_load_dwordx4 v10, s[28:31], s54 offen  lds
  s_add_u32 m0, s57, 94208
  s_add_u32 s54, s79, 46336
  buffer_load_dwordx4 v10, s[28:31], s54 offen  lds
  v_add_u32 v15, 16384, v11
  v_add_u32 v16, 16384, v12
  ds_read_b64_tr_b16 a[112:113], v15 offset:0
  ds_read_b64_tr_b16 a[114:115], v15 offset:512
  ds_read_b64_tr_b16 a[116:117], v15 offset:8192
  ds_read_b64_tr_b16 a[118:119], v15 offset:8704
  ds_read_b64_tr_b16 a[120:121], v16 offset:0
  ds_read_b64_tr_b16 a[122:123], v16 offset:512
  ds_read_b64_tr_b16 a[124:125], v16 offset:8192
  ds_read_b64_tr_b16 a[126:127], v16 offset:8704
  s_waitcnt vmcnt(17) lgkmcnt(0)
  s_barrier
  s_add_u32 m0, s57, 98304
  s_add_u32 s54, s79, 512
  buffer_load_dwordx4 v10, s[28:31], s54 offen  lds
  s_add_u32 m0, s57, 102400
  s_add_u32 s54, s79, 9728
  buffer_load_dwordx4 v10, s[28:31], s54 offen  lds
  s_add_u32 m0, s57, 106496
  s_add_u32 s54, s79, 37376
  buffer_load_dwordx4 v10, s[28:31], s54 offen  lds
  s_add_u32 m0, s57, 110592
  s_add_u32 s54, s79, 46592
  buffer_load_dwordx4 v10, s[28:31], s54 offen  lds
  v_add_u32 v15, 32768, v11
  v_add_u32 v16, 32768, v12
  ds_read_b64_tr_b16 a[128:129], v15 offset:0
  ds_read_b64_tr_b16 a[130:131], v15 offset:512
  ds_read_b64_tr_b16 a[132:133], v15 offset:8192
  ds_read_b64_tr_b16 a[134:135], v15 offset:8704
  ds_read_b64_tr_b16 a[136:137], v16 offset:0
  ds_read_b64_tr_b16 a[138:139], v16 offset:512
  ds_read_b64_tr_b16 a[140:141], v16 offset:8192
  ds_read_b64_tr_b16 a[142:143], v16 offset:8704
  s_waitcnt vmcnt(16) lgkmcnt(0)
  s_barrier
  s_add_u32 m0, s57, 114688
  s_add_u32 s54, s79, 768
  buffer_load_dwordx4 v10, s[28:31], s54 offen  lds
  s_add_u32 m0, s57, 118784
  s_add_u32 s54, s79, 9984
  buffer_load_dwordx4 v10, s[28:31], s54 offen  lds
  s_add_u32 m0, s57, 122880
  s_add_u32 s54, s79, 37632
  buffer_load_dwordx4 v10, s[28:31], s54 offen  lds
  s_add_u32 m0, s57, 126976
  s_add_u32 s54, s79, 46848
  buffer_load_dwordx4 v10, s[28:31], s54 offen  lds
  s_getpc_b64 s[80:81]
  v_lshlrev_b32 v7, 2, v76
  global_load_dword v35, v7, s[80:81] offset:1024
  v_add_u32 v15, 49152, v11
  v_add_u32 v16, 49152, v12
  ds_read_b64_tr_b16 a[144:145], v15 offset:0
  ds_read_b64_tr_b16 a[146:147], v15 offset:512
  ds_read_b64_tr_b16 a[148:149], v15 offset:8192
  ds_read_b64_tr_b16 a[150:151], v15 offset:8704
  ds_read_b64_tr_b16 a[152:153], v16 offset:0
  ds_read_b64_tr_b16 a[154:155], v16 offset:512
  ds_read_b64_tr_b16 a[156:157], v16 offset:8192
  ds_read_b64_tr_b16 a[158:159], v16 offset:8704
  s_waitcnt vmcnt(17) lgkmcnt(0)
  s_barrier
  s_add_u32 m0, s57, 131072
  s_add_u32 s54, s79, 74496
  buffer_load_dwordx4 v10, s[28:31], s54 offen  lds
  s_add_u32 m0, s57, 135168
  s_add_u32 s54, s79, 83712
  buffer_load_dwordx4 v10, s[28:31], s54 offen  lds
  s_add_u32 m0, s57, 139264
  s_add_u32 s54, s79, 111360
  buffer_load_dwordx4 v10, s[28:31], s54 offen  lds
  s_add_u32 m0, s57, 143360
  s_add_u32 s54, s79, 120576
  buffer_load_dwordx4 v10, s[28:31], s54 offen  lds
  v_add_u32 v15, 65536, v11
  v_add_u32 v16, 65536, v12
  ds_read_b64_tr_b16 a[160:161], v15 offset:0
  ds_read_b64_tr_b16 a[162:163], v15 offset:512
  ds_read_b64_tr_b16 a[164:165], v15 offset:8192
  ds_read_b64_tr_b16 a[166:167], v15 offset:8704
  ds_read_b64_tr_b16 a[168:169], v16 offset:0
  ds_read_b64_tr_b16 a[170:171], v16 offset:512
  ds_read_b64_tr_b16 a[172:173], v16 offset:8192
  ds_read_b64_tr_b16 a[174:175], v16 offset:8704
  s_waitcnt vmcnt(17) lgkmcnt(0)
  s_barrier
  s_add_u32 m0, s57, 0
  s_add_u32 s54, s78, 0
  buffer_load_dwordx4 v8, s[20:23], s54 offen  lds
  s_add_u32 m0, s57, 4096
  s_add_u32 s54, s78, 131072
  buffer_load_dwordx4 v8, s[20:23], s54 offen  lds
  s_add_u32 m0, s57, 8192
  s_add_u32 s54, s78, 262144
  buffer_load_dwordx4 v8, s[20:23], s54 offen  lds
  s_add_u32 m0, s57, 12288
  s_add_u32 s54, s78, 393216
  buffer_load_dwordx4 v8, s[20:23], s54 offen  lds
  v_add_u32 v15, 81920, v14
  ds_read_b64_tr_b16 a[176:177], v15 offset:0
  ds_read_b64_tr_b16 a[178:179], v15 offset:1024
  ds_read_b64_tr_b16 a[180:181], v15 offset:4096
  ds_read_b64_tr_b16 a[182:183], v15 offset:5120
  ds_read_b64_tr_b16 a[184:185], v15 offset:8192
  ds_read_b64_tr_b16 a[186:187], v15 offset:9216
  ds_read_b64_tr_b16 a[188:189], v15 offset:12288
  ds_read_b64_tr_b16 a[190:191], v15 offset:13312
  s_waitcnt vmcnt(17) lgkmcnt(0)
  s_barrier
  s_add_u32 m0, s57, 16384
  s_add_u32 s54, s78, 524288
  buffer_load_dwordx4 v8, s[20:23], s54 offen  lds
  s_add_u32 m0, s57, 20480
  s_add_u32 s54, s78, 655360
  buffer_load_dwordx4 v8, s[20:23], s54 offen  lds
  s_add_u32 m0, s57, 24576
  s_add_u32 s54, s78, 786432
  buffer_load_dwordx4 v8, s[20:23], s54 offen  lds
  s_add_u32 m0, s57, 28672
  s_add_u32 s54, s78, 917504
  buffer_load_dwordx4 v8, s[20:23], s54 offen  lds
  v_add_u32 v15, 98304, v14
  ds_read_b64_tr_b16 a[192:193], v15 offset:0
  ds_read_b64_tr_b16 a[194:195], v15 offset:1024
  ds_read_b64_tr_b16 a[196:197], v15 offset:4096
  ds_read_b64_tr_b16 a[198:199], v15 offset:5120
  ds_read_b64_tr_b16 a[200:201], v15 offset:8192
  ds_read_b64_tr_b16 a[202:203], v15 offset:9216
  ds_read_b64_tr_b16 a[204:205], v15 offset:12288
  ds_read_b64_tr_b16 a[206:207], v15 offset:13312
  s_waitcnt vmcnt(17) lgkmcnt(0)
  s_barrier
  s_add_u32 m0, s57, 32768
  s_add_u32 s54, s78, 2097152
  buffer_load_dwordx4 v8, s[20:23], s54 offen  lds
  s_add_u32 m0, s57, 36864
  s_add_u32 s54, s78, 2228224
  buffer_load_dwordx4 v8, s[20:23], s54 offen  lds
  s_add_u32 m0, s57, 40960
  s_add_u32 s54, s78, 2359296
  buffer_load_dwordx4 v8, s[20:23], s54 offen  lds
  s_add_u32 m0, s57, 45056
  s_add_u32 s54, s78, 2490368
  buffer_load_dwordx4 v8, s[20:23], s54 offen  lds
  v_add_u32 v15, 114688, v14
  ds_read_b64_tr_b16 a[208:209], v15 offset:0
  ds_read_b64_tr_b16 a[210:211], v15 offset:1024
  ds_read_b64_tr_b16 a[212:213], v15 offset:4096
  ds_read_b64_tr_b16 a[214:215], v15 offset:5120
  ds_read_b64_tr_b16 a[216:217], v15 offset:8192
  ds_read_b64_tr_b16 a[218:219], v15 offset:9216
  ds_read_b64_tr_b16 a[220:221], v15 offset:12288
  ds_read_b64_tr_b16 a[222:223], v15 offset:13312
  s_waitcnt vmcnt(17) lgkmcnt(0)
  s_barrier
  s_add_u32 m0, s57, 49152
  s_add_u32 s54, s78, 3145728
  buffer_load_dwordx4 v8, s[16:19], s54 offen  lds
  s_add_u32 m0, s57, 53248
  s_add_u32 s54, s78, 3276800
  buffer_load_dwordx4 v8, s[16:19], s54 offen  lds
  s_add_u32 m0, s57, 57344
  s_add_u32 s54, s78, 3407872
  buffer_load_dwordx4 v8, s[16:19], s54 offen  lds
  s_add_u32 m0, s57, 61440
  s_add_u32 s54, s78, 3538944
  buffer_load_dwordx4 v8, s[16:19], s54 offen  lds
  v_add_u32 v15, 131072, v14
  ds_read_b64_tr_b16 a[224:225], v15 offset:0
  ds_read_b64_tr_b16 a[226:227], v15 offset:1024
  ds_read_b64_tr_b16 a[228:229], v15 offset:4096
  ds_read_b64_tr_b16 a[230:231], v15 offset:5120
  ds_read_b64_tr_b16 a[232:233], v15 offset:8192
  ds_read_b64_tr_b16 a[234:235], v15 offset:9216
  ds_read_b64_tr_b16 a[236:237], v15 offset:12288
  ds_read_b64_tr_b16 a[238:239], v15 offset:13312
  s_waitcnt vmcnt(16) lgkmcnt(0)
  s_barrier
  s_add_u32 m0, s57, 65536
  s_add_u32 s54, s78, 2621440
  buffer_load_dwordx4 v8, s[20:23], s54 offen  lds
  s_add_u32 m0, s57, 69632
  s_add_u32 s54, s78, 2752512
  buffer_load_dwordx4 v8, s[20:23], s54 offen  lds
  s_add_u32 m0, s57, 73728
  s_add_u32 s54, s78, 2883584
  buffer_load_dwordx4 v8, s[20:23], s54 offen  lds
  s_add_u32 m0, s57, 77824
  s_add_u32 s54, s78, 3014656
  buffer_load_dwordx4 v8, s[20:23], s54 offen  lds
  v_add_u32 v15, 147456, v14
  ds_read_b64_tr_b16 a[240:241], v15 offset:0
  ds_read_b64_tr_b16 a[242:243], v15 offset:1024
  ds_read_b64_tr_b16 a[244:245], v15 offset:4096
  ds_read_b64_tr_b16 a[246:247], v15 offset:5120
  ds_read_b64_tr_b16 a[248:249], v15 offset:8192
  ds_read_b64_tr_b16 a[250:251], v15 offset:9216
  ds_read_b64_tr_b16 a[252:253], v15 offset:12288
  ds_read_b64_tr_b16 a[254:255], v15 offset:13312
  s_waitcnt vmcnt(16) lgkmcnt(0)
  s_barrier
  s_add_u32 m0, s57, 81920
  s_add_u32 s54, s79, 1024
  buffer_load_dwordx4 v9, s[28:31], s54 offen  lds
  s_add_u32 m0, s57, 86016
  s_add_u32 s54, s79, 37888
  buffer_load_dwordx4 v9, s[28:31], s54 offen  lds
  s_add_u32 m0, s57, 90112
  s_add_u32 s54, s79, 74752
  buffer_load_dwordx4 v9, s[28:31], s54 offen  lds
  s_add_u32 m0, s57, 94208
  s_add_u32 s54, s79, 111616
  buffer_load_dwordx4 v9, s[28:31], s54 offen  lds
  v_add_u32 v15, 16384, v11
  v_add_u32 v16, 16384, v12
  ds_read_b64_tr_b16 v[52:53], v15 offset:0
  ds_read_b64_tr_b16 v[54:55], v15 offset:512
  ds_read_b64_tr_b16 v[56:57], v15 offset:8192
  ds_read_b64_tr_b16 v[58:59], v15 offset:8704
  ds_read_b64_tr_b16 v[60:61], v16 offset:0
  ds_read_b64_tr_b16 v[62:63], v16 offset:512
  ds_read_b64_tr_b16 v[64:65], v16 offset:8192
  ds_read_b64_tr_b16 v[66:67], v16 offset:8704
  s_waitcnt vmcnt(16) lgkmcnt(0)
  s_barrier
  s_lshl_b32 s54, s52, 12
  s_add_u32 s54, s54, 16384
  v_add_u32 v7, s54, v76
  ds_write_b128 v7, v[52:55] offset:0
  ds_write_b128 v7, v[56:59] offset:1024
  ds_write_b128 v7, v[60:63] offset:2048
  ds_write_b128 v7, v[64:67] offset:3072
  s_add_u32 m0, s57, 98304
  s_add_u32 s54, s79, 0
  buffer_load_dwordx4 v10, s[28:31], s54 offen  lds
  s_add_u32 m0, s57, 102400
  s_add_u32 s54, s79, 9216
  buffer_load_dwordx4 v10, s[28:31], s54 offen  lds
  s_add_u32 m0, s57, 106496
  s_add_u32 s54, s79, 36864
  buffer_load_dwordx4 v10, s[28:31], s54 offen  lds
  s_add_u32 m0, s57, 110592
  s_add_u32 s54, s79, 46080
  buffer_load_dwordx4 v10, s[28:31], s54 offen  lds
  v_add_u32 v15, 32768, v11
  v_add_u32 v16, 32768, v12
  ds_read_b64_tr_b16 v[36:37], v15 offset:0
  ds_read_b64_tr_b16 v[38:39], v15 offset:512
  ds_read_b64_tr_b16 v[40:41], v15 offset:8192
  ds_read_b64_tr_b16 v[42:43], v15 offset:8704
  ds_read_b64_tr_b16 v[44:45], v16 offset:0
  ds_read_b64_tr_b16 v[46:47], v16 offset:512
  ds_read_b64_tr_b16 v[48:49], v16 offset:8192
  ds_read_b64_tr_b16 v[50:51], v16 offset:8704
  s_waitcnt vmcnt(16) lgkmcnt(0)
  s_barrier
  s_lshl_b32 s54, s52, 12
  s_add_u32 s54, s54, 32768
  v_add_u32 v7, s54, v76
  ds_write_b128 v7, v[36:39] offset:0
  ds_write_b128 v7, v[40:43] offset:1024
  ds_write_b128 v7, v[44:47] offset:2048
  ds_write_b128 v7, v[48:51] offset:3072
  s_add_u32 m0, s57, 114688
  s_add_u32 s54, s79, 73984
  buffer_load_dwordx4 v10, s[28:31], s54 offen  lds
  s_add_u32 m0, s57, 118784
  s_add_u32 s54, s79, 83200
  buffer_load_dwordx4 v10, s[28:31], s54 offen  lds
  s_add_u32 m0, s57, 122880
  s_add_u32 s54, s79, 110848
  buffer_load_dwordx4 v10, s[28:31], s54 offen  lds
  s_add_u32 m0, s57, 126976
  s_add_u32 s54, s79, 120064
  buffer_load_dwordx4 v10, s[28:31], s54 offen  lds
  v_add_u32 v15, 49152, v11
  v_add_u32 v16, 49152, v12
  ds_read_b64_tr_b16 v[52:53], v15 offset:0
  ds_read_b64_tr_b16 v[54:55], v15 offset:512
  ds_read_b64_tr_b16 v[56:57], v15 offset:8192
  ds_read_b64_tr_b16 v[58:59], v15 offset:8704
  ds_read_b64_tr_b16 v[60:61], v16 offset:0
  ds_read_b64_tr_b16 v[62:63], v16 offset:512
  ds_read_b64_tr_b16 v[64:65], v16 offset:8192
  ds_read_b64_tr_b16 v[66:67], v16 offset:8704
  s_waitcnt vmcnt(16) lgkmcnt(0)
  s_barrier
  s_lshl_b32 s54, s52, 12
  s_add_u32 s54, s54, 49152
  v_add_u32 v7, s54, v76
  ds_write_b128 v7, v[52:55] offset:0
  ds_write_b128 v7, v[56:59] offset:1024
  ds_write_b128 v7, v[60:63] offset:2048
  ds_write_b128 v7, v[64:67] offset:3072
  s_add_u32 m0, s57, 131072
  s_add_u32 s54, s79, 74240
  buffer_load_dwordx4 v10, s[28:31], s54 offen  lds
  s_add_u32 m0, s57, 135168
  s_add_u32 s54, s79, 83456
  buffer_load_dwordx4 v10, s[28:31], s54 offen  lds
  s_add_u32 m0, s57, 139264
  s_add_u32 s54, s79, 111104
  buffer_load_dwordx4 v10, s[28:31], s54 offen  lds
  s_add_u32 m0, s57, 143360
  s_add_u32 s54, s79, 120320
  buffer_load_dwordx4 v10, s[28:31], s54 offen  lds
  v_lshlrev_b32 v7, 3, v76
  s_lshl_b32 s54, s52, 13
  s_add_u32 s54, s54, 360448
  s_bitcmp1_b32 s52, 0
  s_cselect_b64 exec, 0xff, -1
  buffer_load_dword v35, v7, s[8:11], s54 offen sc1
  s_mov_b64 exec, -1
  s_getpc_b64 s[80:81]
C_pc:
  s_mov_b32 s55, (L_w0 - C_pc)
  s_cmp_eq_u32 s52, 1
  s_cselect_b32 s55, (L_w1 - C_pc), s55
  s_cmp_eq_u32 s52, 2
  s_cselect_b32 s55, (L_w2 - C_pc), s55
  s_cmp_eq_u32 s52, 3
  s_cselect_b32 s55, (L_w3 - C_pc), s55
  v_lshl_add_u32 v7, v76, 3, s55
  global_load_dword v35, v7, s[80:81]
  v_add_u32 v15, 65536, v11
  v_add_u32 v16, 65536, v12
  ds_read_b64_tr_b16 v[36:37], v15 offset:0
  ds_read_b64_tr_b16 v[38:39], v15 offset:512
  ds_read_b64_tr_b16 v[40:41], v15 offset:8192
  ds_read_b64_tr_b16 v[42:43], v15 offset:8704
  ds_read_b64_tr_b16 v[44:45], v16 offset:0
  ds_read_b64_tr_b16 v[46:47], v16 offset:512
  ds_read_b64_tr_b16 v[48:49], v16 offset:8192
  ds_read_b64_tr_b16 v[50:51], v16 offset:8704
  s_waitcnt vmcnt(18) lgkmcnt(0)
  s_barrier
  s_lshl_b32 s54, s52, 12
  s_add_u32 s54, s54, 65536
  v_add_u32 v7, s54, v76
  ds_write_b128 v7, v[36:39] offset:0
  ds_write_b128 v7, v[40:43] offset:1024
  ds_write_b128 v7, v[44:47] offset:2048
  ds_write_b128 v7, v[48:51] offset:3072
  v_lshrrev_b32 v20, 2, v76
  buffer_load_dword v21, v20, s[12:15], 0 offen sc1
  v_add_u32 v15, 81920, v11
  v_add_u32 v16, 81920, v12
  ds_read_b64_tr_b16 v[52:53], v15 offset:0
  ds_read_b64_tr_b16 v[54:55], v15 offset:512
  ds_read_b64_tr_b16 v[56:57], v15 offset:8192
  ds_read_b64_tr_b16 v[58:59], v15 offset:8704
  ds_read_b64_tr_b16 v[60:61], v16 offset:0
  ds_read_b64_tr_b16 v[62:63], v16 offset:512
  ds_read_b64_tr_b16 v[64:65], v16 offset:8192
  ds_read_b64_tr_b16 v[66:67], v16 offset:8704
  s_waitcnt vmcnt(15) lgkmcnt(0)
  s_barrier
  s_lshl_b32 s54, s52, 12
  s_add_u32 s54, s54, 81920
  v_add_u32 v7, s54, v76
  ds_write_b128 v7, v[52:55] offset:0
  ds_write_b128 v7, v[56:59] offset:1024
  ds_write_b128 v7, v[60:63] offset:2048
  ds_write_b128 v7, v[64:67] offset:3072
  v_add_u32 v15, 98304, v13
  s_waitcnt lgkmcnt(0)
  ds_read_b64_tr_b16 v[36:37], v15 offset:0
  ds_read_b64_tr_b16 v[38:39], v15 offset:1024
  ds_read_b64_tr_b16 v[40:41], v15 offset:2048
  ds_read_b64_tr_b16 v[42:43], v15 offset:3072
  ds_read_b64_tr_b16 v[44:45], v15 offset:4096
  ds_read_b64_tr_b16 v[46:47], v15 offset:5120
  ds_read_b64_tr_b16 v[48:49], v15 offset:6144
  ds_read_b64_tr_b16 v[50:51], v15 offset:7168
  ds_read_b64_tr_b16 v[52:53], v15 offset:8192
  ds_read_b64_tr_b16 v[54:55], v15 offset:9216
  ds_read_b64_tr_b16 v[56:57], v15 offset:10240
  ds_read_b64_tr_b16 v[58:59], v15 offset:11264
  ds_read_b64_tr_b16 v[60:61], v15 offset:12288
  ds_read_b64_tr_b16 v[62:63], v15 offset:13312
  ds_read_b64_tr_b16 v[64:65], v15 offset:14336
  ds_read_b64_tr_b16 v[66:67], v15 offset:15360
  s_waitcnt vmcnt(11) lgkmcnt(0)
  s_barrier
  s_and_b32 s54, s52, 1
  s_lshl_b32 s54, s54, 13
  s_add_u32 s54, s54, 98304
  v_add_u32 v7, s54, v76
  ds_write_b128 v7, v[36:39] offset:0
  ds_write_b128 v7, v[40:43] offset:1024
  ds_write_b128 v7, v[44:47] offset:2048
  ds_write_b128 v7, v[48:51] offset:3072
  ds_write_b128 v7, v[52:55] offset:4096
  ds_write_b128 v7, v[56:59] offset:5120
  ds_write_b128 v7, v[60:63] offset:6144
  ds_write_b128 v7, v[64:67] offset:7168
  v_add_u32 v15, 114688, v14
  ds_read_b64_tr_b16 v[52:53], v15 offset:0
  ds_read_b64_tr_b16 v[54:55], v15 offset:1024
  ds_read_b64_tr_b16 v[56:57], v15 offset:4096
  ds_read_b64_tr_b16 v[58:59], v15 offset:5120
  ds_read_b64_tr_b16 v[60:61], v15 offset:8192
  ds_read_b64_tr_b16 v[62:63], v15 offset:9216
  ds_read_b64_tr_b16 v[64:65], v15 offset:12288
  ds_read_b64_tr_b16 v[66:67], v15 offset:13312
  s_waitcnt vmcnt(7) lgkmcnt(0)
  s_barrier
  s_lshl_b32 s54, s52, 12
  s_add_u32 s54, s54, 114688
  v_add_u32 v7, s54, v76
  ds_write_b128 v7, v[52:55] offset:0
  ds_write_b128 v7, v[56:59] offset:1024
  ds_write_b128 v7, v[60:63] offset:2048
  ds_write_b128 v7, v[64:67] offset:3072
  v_add_u32 v15, 131072, v14
  ds_read_b64_tr_b16 v[36:37], v15 offset:0
  ds_read_b64_tr_b16 v[38:39], v15 offset:1024
  ds_read_b64_tr_b16 v[40:41], v15 offset:4096
  ds_read_b64_tr_b16 v[42:43], v15 offset:5120
  ds_read_b64_tr_b16 v[44:45], v15 offset:8192
  ds_read_b64_tr_b16 v[46:47], v15 offset:9216
  ds_read_b64_tr_b16 v[48:49], v15 offset:12288
  ds_read_b64_tr_b16 v[50:51], v15 offset:13312
  s_waitcnt vmcnt(3) lgkmcnt(0)
  s_barrier
  s_lshl_b32 s54, s52, 12
  s_add_u32 s54, s54, 131072
  v_add_u32 v7, s54, v76
  ds_write_b128 v7, v[36:39] offset:0
  ds_write_b128 v7, v[40:43] offset:1024
  ds_write_b128 v7, v[44:47] offset:2048
  ds_write_b128 v7, v[48:51] offset:3072
  v_add_u32 v15, 147456, v14
  ds_read_b64_tr_b16 v[52:53], v15 offset:0
  ds_read_b64_tr_b16 v[54:55], v15 offset:1024
  ds_read_b64_tr_b16 v[56:57], v15 offset:4096
  ds_read_b64_tr_b16 v[58:59], v15 offset:5120
  ds_read_b64_tr_b16 v[60:61], v15 offset:8192
  ds_read_b64_tr_b16 v[62:63], v15 offset:9216
  ds_read_b64_tr_b16 v[64:65], v15 offset:12288
  ds_read_b64_tr_b16 v[66:67], v15 offset:13312
  s_waitcnt vmcnt(0) lgkmcnt(0)
  s_barrier
  s_lshl_b32 s54, s52, 12
  s_add_u32 s54, s54, 147456
  v_add_u32 v7, s54, v76
  ds_write_b128 v7, v[52:55] offset:0
  ds_write_b128 v7, v[56:59] offset:1024
  ds_write_b128 v7, v[60:63] offset:2048
  ds_write_b128 v7, v[64:67] offset:3072
  s_waitcnt lgkmcnt(0)
  s_branch C_rd1
C_rd0:
  s_sleep 2
  buffer_load_dword v21, v20, s[12:15], 0 offen sc1
  s_waitcnt vmcnt(0)
C_rd1:
  v_and_b32 v22, 0xff, v21
  v_cmp_gt_u32 vcc, 7, v22
  v_readlane_b32 s56, v21, 0
  s_mov_b32 s3, 1
  s_add_u32 s67, s67, 1
  s_cmp_ge_u32 s67, 131072
  s_cbranch_scc1 C_rd2
  s_cmp_lg_u32 vcc_hi, 0
  s_cbranch_scc1 C_rd0
  s_mov_b32 s3, 0
  s_cmp_eq_u32 s56, -1
  s_cbranch_scc1 C_rd2
  s_mov_b32 s3, 1
  v_readlane_b32 s54, v21, 10
  v_readlane_b32 s55, v21, 0
  s_nop 0
  s_bcnt1_i32_b32 s55, s55
  s_add_u32 s54, s54, s55
  v_readlane_b32 s55, v21, 1
  s_nop 0
  s_bcnt1_i32_b32 s55, s55
  s_add_u32 s54, s54, s55
  v_readlane_b32 s55, v21, 2
  s_nop 0
  s_bcnt1_i32_b32 s55, s55
  s_add_u32 s54, s54, s55
  v_readlane_b32 s55, v21, 3
  s_nop 0
  s_bcnt1_i32_b32 s55, s55
  s_add_u32 s54, s54, s55
  v_readlane_b32 s55, v21, 4
  s_nop 0
  s_bcnt1_i32_b32 s55, s55
  s_add_u32 s54, s54, s55
  v_readlane_b32 s55, v21, 5
  s_nop 0
  s_bcnt1_i32_b32 s55, s55
  s_add_u32 s54, s54, s55
  v_readlane_b32 s55, v21, 6
  s_nop 0
  s_bcnt1_i32_b32 s55, s55
  s_add_u32 s54, s54, s55
  v_readlane_b32 s55, v21, 7
  s_nop 0
  s_bcnt1_i32_b32 s55, s55
  s_add_u32 s54, s54, s55
  s_cmp_lt_u32 s54, 256
  s_cbranch_scc1 C_rd0
C_rd2:
  s_lshl_b32 s54, s3, 2
  s_add_u32 s54, s54, s52
  s_cmp_eq_u32 s54, 1
  s_cbranch_scc1 L_w1
  s_cmp_eq_u32 s54, 2
  s_cbranch_scc1 L_w2
  s_cmp_eq_u32 s54, 3
  s_cbranch_scc1 L_w3
  s_cmp_eq_u32 s54, 4
  s_cbranch_scc1 L_w4
  s_cmp_eq_u32 s54, 5
  s_cbranch_scc1 L_w5
  s_cmp_eq_u32 s54, 6
  s_cbranch_scc1 L_w6
  s_cmp_eq_u32 s54, 7
  s_cbranch_scc1 L_w7
L_w0:
  v_mov_b64 v[20:21], 0
  v_mov_b64 v[22:23], 0
  v_mov_b64 v[24:25], 0
  v_mov_b64 v[26:27], 0
  v_mov_b64 v[28:29], 0
  v_mov_b64 v[30:31], 0
  v_mov_b64 v[32:33], 0
  v_mov_b64 v[34:35], 0
  s_mov_b32 s78, 0x3f803f80
  s_mov_b32 s79, s78
  s_mov_b32 s65, 360448
  s_mov_b32 m0, 16128
  s_lshl_b32 s71, s53, 2
  s_add_u32 s71, s71, 128
  s_movk_i32 s56, 0x1000
  v_lshlrev_b32 v73, 2, v76
  v_mov_b32 v72, 0
  s_mov_b64 s[16:17], s[8:9]
  s_mov_b32 s18, 268435456
  s_mov_b32 s19, 0x20000
  s_getpc_b64 s[20:21]
Cf0_pc:
  s_add_u32 s20, s20, (Cf0_last - Cf0_pc)
  s_addc_u32 s21, s21, 0
  v_mov_b32 v68, 14880
  buffer_load_dwordx4 v[52:55], v76, s[8:11], s59 offen offset:0 sc1
  buffer_load_dwordx4 v[56:59], v76, s[8:11], s59 offen offset:1024 sc1
  ds_read_b128 v[36:39], v76 offset:16384
  ds_read_b128 v[40:43], v76 offset:17408
  ds_read_b128 v[60:63], v76 offset:18432
  ds_read_b128 v[64:67], v76 offset:19456
  ds_read_b128 v[0:3], v76 offset:4608
  ds_read_b128 v[4:7], v76 offset:5632
  ds_read_b128 v[8:11], v76 offset:6656
  ds_read_b128 v[12:15], v76 offset:7680
  s_waitcnt lgkmcnt(0)
  s_cmp_eq_u32 s66, 1
  s_branch Cf0_top2
.p2align 6
Cf0_h2:
  v_lshlrev_b32 v73, 2, v76
  s_mov_b32 m0, 10752
  s_add_u32 s55, s65, 6144
  s_cmp_eq_u32 s66, 12
  s_cselect_b32 s56, s71, 0x1000
  ds_read_b32 v72, v76 offset:16128
  s_cmp_eq_u32 s66, 13
  s_cselect_b32 s54, 0x700, 0
  s_waitcnt lgkmcnt(0)
  v_readfirstlane_b32 s57, v72
  s_nop 0
  s_cmp_lt_u32 s57, s54
  s_cbranch_scc1 Cf0_kv3
Cf0_kvb:
  s_nop 1
  buffer_load_dwordx4 v[0:3], v76, s[8:11], s65 offen offset:0 sc1
  s_nop 15
  s_nop 3
  buffer_load_dwordx4 v[0:3], v76, s[8:11], s65 offen offset:0 sc1
  s_nop 15
  s_nop 3
  buffer_load_dwordx4 v[0:3], v76, s[8:11], s65 offen offset:0 sc1
  s_waitcnt vmcnt(5)
  ds_read_b128 v[36:39], v76 offset:16384
  ds_read_b128 v[40:43], v76 offset:17408
  ds_read_b128 v[60:63], v76 offset:18432
  ds_read_b128 v[64:67], v76 offset:19456
  buffer_load_dwordx4 v[52:55], v76, s[8:11], s59 offen offset:0 sc1
  buffer_load_dwordx4 v[56:59], v76, s[8:11], s59 offen offset:1024 sc1
  s_waitcnt vmcnt(4)
  v_max3_u32 v72, v0, v1, v2
  v_max_u32 v72, v72, v3
  ds_write_b128 v76, v[0:3] offset:4608
  v_cmp_eq_u32 vcc, -1, v72
  s_cbranch_vccnz Cf0_h2r
Cf0_h2w:
  s_cmp_eq_u32 s66, 63
  s_waitcnt lgkmcnt(0)
  s_barrier
  ds_read_b128 v[8:11], v76 offset:6656
  buffer_load_dwordx4 v76, s[8:11], s55 offen offset:0 sc1 lds
Cf0_top2:
  v_smfmac_f32_16x16x64_bf16 v[20:23], v[0:3], v[80:87], v74
  s_cbranch_scc1 Cf0_last
  v_smfmac_f32_16x16x64_bf16 v[28:31], v[0:3], v[36:43], v74
  buffer_load_dwordx4 v[44:47], v76, s[8:11], s58 offen offset:0 sc1
  s_mov_b32 m0, 16128
  v_smfmac_f32_16x16x64_bf16 v[24:27], v[0:3], v[88:95], v74
  buffer_load_dwordx4 v[48:51], v76, s[8:11], s58 offen offset:1024 sc1
  v_smfmac_f32_16x16x64_bf16 v[32:35], v[0:3], v[60:67], v74
  ds_read_b128 v[4:7], v76 offset:5632
  s_waitcnt lgkmcnt(1)
  v_smfmac_f32_16x16x64_bf16 v[20:23], v[8:11], v[112:119], v74
  ds_read_b128 v[12:15], v76 offset:7680
  v_smfmac_f32_16x16x64_bf16 v[24:27], v[8:11], v[120:127], v74
  ds_read_b128 v[36:39], v76 offset:32768
  v_smfmac_f32_16x16x64_bf16 v[28:31], v[8:11], v[208:215], v74
  buffer_store_dwordx4 v[16:19], v76, s[8:11], s68 offen sc1
  ds_read_b128 v[40:43], v76 offset:33792
  v_smfmac_f32_16x16x64_bf16 v[32:35], v[8:11], v[216:223], v74
  ds_read_b128 v[60:63], v76 offset:34816
  s_waitcnt lgkmcnt(4)
  v_smfmac_f32_16x16x64_bf16 v[20:23], v[4:7], v[96:103], v74
  ds_read_b128 v[64:67], v76 offset:35840
  v_smfmac_f32_16x16x64_bf16 v[24:27], v[4:7], v[104:111], v74
  buffer_load_dword v73, s[16:19], s70 offen lds
  s_waitcnt vmcnt(5)
  s_waitcnt lgkmcnt(4)
  v_smfmac_f32_16x16x64_bf16 v[20:23], v[12:15], v[128:135], v74
  s_barrier
  s_waitcnt lgkmcnt(2)
  v_smfmac_f32_16x16x64_bf16 v[28:31], v[4:7], v[36:43], v74
  ds_read_b128 v[0:3], v76 offset:8704
  v_smfmac_f32_16x16x64_bf16 v[24:27], v[12:15], v[136:143], v74
  ds_read_b128 v[36:39], v76 offset:49152
  s_waitcnt lgkmcnt(2)
  v_smfmac_f32_16x16x64_bf16 v[32:35], v[4:7], v[60:67], v74
  ds_read_b128 v[40:43], v76 offset:50176
  v_smfmac_f32_16x16x64_bf16 v[28:31], v[12:15], v[224:231], v74
  ds_read_b128 v[60:63], v76 offset:51200
  v_smfmac_f32_16x16x64_bf16 v[32:35], v[12:15], v[232:239], v74
  ds_read_b128 v[64:67], v76 offset:52224
  s_waitcnt lgkmcnt(4)
  v_smfmac_f32_16x16x64_bf16 v[20:23], v[0:3], v[144:151], v74
  s_waitcnt vmcnt(4)
  ds_read_b128 v[8:11], v76 offset:9728
  s_waitcnt lgkmcnt(3)
  v_smfmac_f32_16x16x64_bf16 v[28:31], v[0:3], v[36:43], v74
  s_barrier
  ds_read_b128 v[4:7], v76 offset:11776
  v_smfmac_f32_16x16x64_bf16 v[24:27], v[0:3], v[152:159], v74
  ds_read_b128 v[36:39], v75 offset:0
  ds_read_b128 v[40:43], v75 offset:1024
  s_waitcnt lgkmcnt(4)
  v_smfmac_f32_16x16x64_bf16 v[32:35], v[0:3], v[60:67], v74
  ds_read_b128 v[16:19], v76 offset:10752
  s_waitcnt lgkmcnt(4)
  v_smfmac_f32_16x16x64_bf16 v[20:23], v[8:11], v[160:167], v74
  ds_read_b128 v[12:15], v76 offset:12800
  v_smfmac_f32_16x16x64_bf16 v[24:27], v[8:11], v[168:175], v74
  ds_read_b128 v[60:63], v75 offset:2048
  ds_read_b128 v[64:67], v75 offset:3072
  s_waitcnt lgkmcnt(6)
  v_smfmac_f32_16x16x64_bf16 v[20:23], v[4:7], v[176:183], v74
  s_waitcnt lgkmcnt(3)
  v_smfmac_f32_16x16x64_bf16 v[20:23], v[16:19], v[36:43], v74
  ds_read_b128 v[36:39], v75 offset:16384
  s_waitcnt lgkmcnt(3)
  v_smfmac_f32_16x16x64_bf16 v[20:23], v[12:15], v[192:199], v74
  ds_read_b128 v[40:43], v75 offset:17408
  s_waitcnt lgkmcnt(2)
  v_smfmac_f32_16x16x64_bf16 v[24:27], v[16:19], v[60:67], v74
  ds_read_b128 v[60:63], v75 offset:18432
  v_smfmac_f32_16x16x64_bf16 v[24:27], v[4:7], v[184:191], v74
  ds_read_b128 v[64:67], v75 offset:19456
  v_add_f32 v20, v20, v22
  v_smfmac_f32_16x16x64_bf16 v[24:27], v[12:15], v[200:207], v74
  buffer_load_dword off, s[12:15], s56 sc1 lds
  v_add_f32 v21, v21, v23
  v_smfmac_f32_16x16x64_bf16 v[28:31], v[16:19], v[240:247], v74
  s_waitcnt lgkmcnt(2)
  v_mov_b64 v[70:71], s[78:79]
  v_smfmac_f32_16x16x64_bf16 v[28:31], v[8:11], v[36:43], v74
  ds_read_b128 v[36:39], v68
  v_add_f32 v24, v24, v26
  v_smfmac_f32_16x16x64_bf16 v[28:31], v[4:7], a[0:7], v74
  ds_read_b128 v[40:43], v68
  v_cvt_pk_bf16_f32 v22, v20, v24
  v_smfmac_f32_16x16x64_bf16 v[28:31], v[12:15], a[16:23], v74
  ds_write_b32 v79, v22 offset:0
  s_waitcnt lgkmcnt(3)
  v_add_f32 v25, v25, v27
  v_cvt_pk_bf16_f32 v23, v21, v25
  v_smfmac_f32_16x16x64_bf16 v[32:35], v[8:11], v[60:67], v74
  ds_write_b32 v79, v23 offset:576
  v_cmp_u_f32 vcc, v20, v21
  v_smfmac_f32_16x16x64_bf16 v[32:35], v[16:19], v[248:255], v74
  v_add_f32 v28, v28, v30
  v_smfmac_f32_16x16x64_bf16 v[32:35], v[4:7], a[8:15], v74
  v_add_f32 v29, v29, v31
  v_smfmac_f32_16x16x64_bf16 v[32:35], v[12:15], a[24:31], v74
  s_cbranch_vccnz Cf0_rec
Cf0_recok:
  s_waitcnt lgkmcnt(3)
  v_smfmac_f32_16x16x64_bf16 v[36:39], v[16:19], a[128:135], v74
  s_waitcnt lgkmcnt(0)
  s_barrier
  ds_read_b128 v[60:63], v77
  v_smfmac_f32_16x16x64_bf16 v[40:43], v[16:19], a[136:143], v74
  ds_read_b128 v[64:67], v77 offset:128
  v_add_f32 v32, v32, v34
  v_cvt_pk_bf16_f32 v30, v28, v32
  v_smfmac_f32_16x16x64_bf16 v[36:39], v[0:3], a[96:103], v74
  ds_write_b32 v79, v30 offset:256
  v_add_f32 v33, v33, v35
  v_cvt_pk_bf16_f32 v31, v29, v33
  v_smfmac_f32_16x16x64_bf16 v[40:43], v[0:3], a[104:111], v74
  ds_write_b32 v79, v31 offset:832
  v_xor_b32 v75, 0x8000, v75
  v_smfmac_f32_16x16x64_bf16 v[36:39], v[4:7], a[144:151], v74
  ds_read_b128 v[0:3], v76 offset:4608
  v_mov_b32 v29, 0
  v_smfmac_f32_16x16x64_bf16 v[40:43], v[4:7], a[152:159], v74
  s_waitcnt vmcnt(3) lgkmcnt(3)
  v_mov_b32 v30, 0
  v_mfma_f32_16x16x32_bf16 v[44:47], v[44:47], v[60:63], 0
  ds_read_b128 v[4:7], v76 offset:5632
  s_waitcnt lgkmcnt(2)
  v_mfma_f32_16x16x32_bf16 v[44:47], v[48:51], v[64:67], v[44:47]
  s_barrier
  v_smfmac_f32_16x16x64_bf16 v[36:39], v[8:11], a[112:119], v74
  ds_read_b128 v[20:23], v77 offset:256
  ds_read_b128 v[24:27], v77 offset:384
  v_smfmac_f32_16x16x64_bf16 v[40:43], v[8:11], a[120:127], v74
  ds_read_b128 v[8:11], v76 offset:6656
  v_add_f32_dpp v72, v46, v44 quad_perm:[2,3,0,1] row_mask:0xf bank_mask:0xf
  v_add_f32_dpp v73, v47, v45 quad_perm:[2,3,0,1] row_mask:0xf bank_mask:0xf
  v_smfmac_f32_16x16x64_bf16 v[36:39], v[12:15], a[160:167], v74
  s_waitcnt lgkmcnt(4)
  v_exp_f32_dpp v72, v72 quad_perm:[0,1,0,1] row_mask:0xf bank_mask:0xf
  v_smfmac_f32_16x16x64_bf16 v[40:43], v[12:15], a[168:175], v74
  ds_read_b128 v[12:15], v76 offset:7680
  v_exp_f32_dpp v73, v73 quad_perm:[0,1,0,1] row_mask:0xf bank_mask:0xf
  v_smfmac_f32_16x16x64_bf16 v[36:39], v[0:3], a[32:39], v74
  s_waitcnt lgkmcnt(2)
  v_cvt_pk_bf16_f32 v72, v72, v73
  v_mfma_f32_16x16x32_bf16 v[20:23], v[20:23], v[60:63], 0
  ds_write_b32 v78, v72 offset:512
  v_mov_b64 v[16:17], 0
  v_mfma_f32_16x16x32_bf16 v[20:23], v[24:27], v[64:67], v[20:23]
  ds_read_b128 v[44:47], v75 offset:16384
  v_mov_b64 v[18:19], 0
  v_smfmac_f32_16x16x64_bf16 v[40:43], v[0:3], a[40:47], v74
  ds_read_b128 v[48:51], v75 offset:17408
  v_mov_b64 v[68:69], s[78:79]
  v_smfmac_f32_16x16x64_bf16 v[36:39], v[4:7], a[48:55], v74
  s_waitcnt lgkmcnt(4)
  v_add_f32_dpp v24, v22, v20 quad_perm:[2,3,0,1] row_mask:0xf bank_mask:0xf
  v_add_f32_dpp v25, v23, v21 quad_perm:[2,3,0,1] row_mask:0xf bank_mask:0xf
  v_smfmac_f32_16x16x64_bf16 v[36:39], v[8:11], a[64:71], v74
  s_waitcnt lgkmcnt(2)
  s_barrier
  ds_read_b128 v[32:35], v78 offset:512
  v_smfmac_f32_16x16x64_bf16 v[36:39], v[12:15], a[80:87], v74
  ds_read_b128 v[60:63], v75 offset:18432
  v_mul_f32 v24, s69, v24
  v_smfmac_f32_16x16x64_bf16 v[40:43], v[4:7], a[56:63], v74
  ds_read_b128 v[64:67], v75 offset:19456
  v_mul_f32 v25, s69, v25
  v_smfmac_f32_16x16x64_bf16 v[40:43], v[8:11], a[72:79], v74
  v_exp_f32_dpp v24, v24 quad_perm:[0,1,0,1] row_mask:0xf bank_mask:0xf
  v_smfmac_f32_16x16x64_bf16 v[40:43], v[12:15], a[88:95], v74
  s_waitcnt lgkmcnt(2)
  v_exp_f32_dpp v25, v25 quad_perm:[0,1,0,1] row_mask:0xf bank_mask:0xf
  v_mfma_f32_16x16x32_bf16 v[8:11], v[32:35], v[68:71], 0
  v_add_f32 v36, v36, v38
  v_add_f32 v37, v37, v39
  v_mfma_f32_16x16x32_bf16 v[0:3], v[32:35], v[52:55], 0
  v_add_f32 v40, v40, v42
  v_add_f32 v41, v41, v43
  v_mfma_f32_16x16x32_bf16 v[4:7], v[32:35], v[56:59], 0
  v_cvt_pk_bf16_f32 v28, v24, v25
  v_cvt_pk_bf16_f32 v72, v36, v37
  v_cvt_pk_bf16_f32 v73, v40, v41
  v_mfma_f32_16x16x16_bf16 v[8:11], v[28:29], v[68:69], v[8:11]
  v_cvt_pk_bf16_f32 v31, v24, v25
  v_mov_b64 v[20:21], 0
  v_mfma_f32_16x16x16_bf16 v[0:3], v[28:29], v[72:73], v[0:3]
  ds_read_b128 v[68:71], v76 offset:13824
  v_mov_b64 v[22:23], 0
  v_mfma_f32_16x16x16_bf16 v[4:7], v[30:31], v[72:73], v[4:7]
  v_rcp_f32 v10, v8
  v_rcp_f32 v11, v9
  v_mul_f32 v0, v10, v0
  v_mul_f32 v1, v11, v1
  s_nop 0
  v_mul_f32 v4, v10, v4
  v_mul_f32 v5, v11, v5
  v_cvt_pk_bf16_f32 v2, v0, v4
  ds_write_b32 v79, v2 offset:8704
  v_cvt_pk_bf16_f32 v3, v1, v5
  ds_write_b32 v79, v3 offset:9280
  v_max3_f32 v8, v8, v9, v10
  v_max_f32 v8, v8, v11
  v_cmp_le_f32 vcc, 1317011456, v8
  v_mov_b64 v[24:25], 0
  v_mov_b64 v[26:27], 0
  s_cbranch_vccnz Cf0_mx
Cf0_mxok:
  s_waitcnt lgkmcnt(0)
  s_barrier
  ds_read_b128 v[0:3], v78 offset:8704
  ds_read_b128 v[4:7], v78 offset:8768
  ds_read_b128 v[8:11], v78 offset:8832
  ds_read_b128 v[12:15], v78 offset:8896
  s_waitcnt lgkmcnt(3)
  v_smfmac_f32_16x16x64_bf16 v[16:19], v[0:3], v[44:51], v74
  ds_read_b128 v[52:55], v75 offset:32768
  s_waitcnt lgkmcnt(3)
  v_smfmac_f32_16x16x64_bf16 v[16:19], v[4:7], v[60:67], v74
  ds_read_b128 v[56:59], v75 offset:33792
  s_waitcnt lgkmcnt(3)
  v_smfmac_f32_16x16x64_bf16 v[16:19], v[8:11], a[176:183], v74
  ds_read_b128 v[36:39], v75 offset:34816
  s_waitcnt lgkmcnt(3)
  v_smfmac_f32_16x16x64_bf16 v[16:19], v[12:15], a[184:191], v74
  ds_read_b128 v[40:43], v75 offset:35840
  ds_read_b128 v[44:47], v75 offset:49152
  v_smfmac_f32_16x16x64_bf16 v[20:23], v[0:3], a[192:199], v74
  ds_read_b128 v[48:51], v75 offset:50176
  ds_read_b128 v[60:63], v75 offset:51200
  v_smfmac_f32_16x16x64_bf16 v[20:23], v[4:7], a[200:207], v74
  ds_read_b128 v[64:67], v75 offset:52224
  s_waitcnt lgkmcnt(6)
  v_cvt_pk_bf16_f32 v16, v16, v17
  v_cvt_pk_bf16_f32 v17, v18, v19
  v_bfi_b32 v16, 1, s72, v16
  v_smfmac_f32_16x16x64_bf16 v[20:23], v[8:11], v[52:59], v74
  buffer_store_dwordx2 v[16:17], v68, s[8:11], s73 offen
  s_waitcnt lgkmcnt(4)
  v_smfmac_f32_16x16x64_bf16 v[20:23], v[12:15], v[36:43], v74
  v_mov_b64 v[32:33], 0
  v_smfmac_f32_16x16x64_bf16 v[24:27], v[0:3], a[208:215], v74
  v_mov_b64 v[34:35], 0
  v_smfmac_f32_16x16x64_bf16 v[24:27], v[4:7], a[216:223], v74
  s_waitcnt lgkmcnt(2)
  v_cvt_pk_bf16_f32 v20, v20, v21
  v_cvt_pk_bf16_f32 v21, v22, v23
  v_bfi_b32 v20, 1, s72, v20
  v_smfmac_f32_16x16x64_bf16 v[24:27], v[8:11], v[44:51], v74
  buffer_store_dwordx2 v[20:21], v68, s[8:11], s74 offen
  s_waitcnt lgkmcnt(0)
  v_smfmac_f32_16x16x64_bf16 v[24:27], v[12:15], v[60:67], v74
  v_smfmac_f32_16x16x64_bf16 v[32:35], v[0:3], a[224:231], v74
  v_smfmac_f32_16x16x64_bf16 v[32:35], v[4:7], a[232:239], v74
  v_cvt_pk_bf16_f32 v24, v24, v25
  v_cvt_pk_bf16_f32 v25, v26, v27
  v_bfi_b32 v24, 1, s72, v24
  v_smfmac_f32_16x16x64_bf16 v[32:35], v[8:11], a[240:247], v74
  buffer_store_dwordx2 v[24:25], v68, s[8:11], s75 offen
  v_smfmac_f32_16x16x64_bf16 v[32:35], v[12:15], a[248:255], v74
  ds_read_b128 v[0:3], v76 offset:14848
  ds_read_b64 v[16:17], v77 offset:256
  v_mov_b64 v[18:19], v[72:73]
  v_xor_b32 v75, 0x8000, v75
  s_nop 3
  v_cvt_pk_bf16_f32 v32, v32, v33
  v_cvt_pk_bf16_f32 v33, v34, v35
  v_bfi_b32 v32, 1, s72, v32
  buffer_store_dwordx2 v[32:33], v68, s[8:11], s76 offen
  v_mov_b64 v[20:21], 0
  v_mov_b64 v[22:23], 0
  v_mov_b64 v[24:25], 0
  v_mov_b64 v[26:27], 0
  v_mov_b64 v[28:29], 0
  v_mov_b64 v[30:31], 0
  v_mov_b64 v[32:33], 0
  v_mov_b64 v[34:35], 0
  v_mov_b32 v68, 14880
  s_add_u32 s58, s58, 655360
  s_add_u32 s59, s59, 655360
  s_add_u32 s70, s70, 655360
  s_add_u32 s68, s68, 655360
  s_add_u32 s66, s66, 1
  s_xor_b32 s64, s64, 16384
  s_xor_b32 s65, s65, 16384
  s_cmp_eq_u32 s66, 62
  s_cselect_b64 s[16:17], s[20:21], s[16:17]
  s_cselect_b32 s18, (Cf0_done - Cf0_last), s18
  s_cselect_b32 s70, 0, s70
  s_cmp_eq_u32 s66, 63
  s_cselect_b32 s59, 268435456, s59
  s_cselect_b32 s58, 268435456, s58
  s_nop 13
  buffer_load_dwordx4 v[52:55], v76, s[8:11], s60 offen offset:0 sc1
  buffer_load_dwordx4 v[56:59], v76, s[8:11], s60 offen offset:1024 sc1
  s_waitcnt lgkmcnt(0)
  s_waitcnt vmcnt(1)
  v_mfma_f32_16x16x32_bf16 v[4:7], v[0:3], v[52:55], 0
  v_bitop3_b32 v72, v52, v54, s72 bitop3:0x7e
  s_waitcnt vmcnt(0)
  v_mfma_f32_16x16x32_bf16 v[4:7], v[0:3], v[56:59], v[4:7]
  v_bitop3_b32 v73, v56, v58, s72 bitop3:0x7e
  v_bitop3_b32 v72, v72, v73, 1 bitop3:0xa8
  v_cmp_ne_u32 vcc, 0, v72
  s_nop 0
  s_cmp_eq_u64 vcc, 0
  s_cselect_b32 s54, s62, 268435456
  s_nop 0
  v_add_f32_dpp v4, v4, v4 row_ror:4 row_mask:0xf bank_mask:0xf
  v_add_f32_dpp v5, v5, v5 row_ror:4 row_mask:0xf bank_mask:0xf
  s_nop 0
  v_add_f32_dpp v4, v4, v4 row_ror:8 row_mask:0xf bank_mask:0xf
  v_add_f32_dpp v5, v5, v5 row_ror:8 row_mask:0xf bank_mask:0xf
  v_cvt_pk_bf16_f32 v4, v4, v5
  buffer_store_dword v4, v69, s[8:11], s54 offen
  s_cbranch_vccnz Cf0_h1r
  s_xor_b32 s62, s62, 16384
  buffer_store_dword v71, v69, s[8:11], s62 offen
  s_xor_b32 s72, s72, 1
  s_branch Cf0_h2
Cf0_h1r:
  s_mov_b64 exec, vcc
  buffer_load_dwordx4 v[52:55], v76, s[8:11], s60 offen offset:0 sc1
  buffer_load_dwordx4 v[56:59], v76, s[8:11], s60 offen offset:1024 sc1
  s_mov_b64 exec, -1
  s_add_u32 s67, s67, 1
  s_waitcnt vmcnt(1)
  v_mfma_f32_16x16x32_bf16 v[4:7], v[0:3], v[52:55], 0
  v_bitop3_b32 v72, v52, v54, s72 bitop3:0x7e
  s_waitcnt vmcnt(0)
  v_mfma_f32_16x16x32_bf16 v[4:7], v[0:3], v[56:59], v[4:7]
  v_bitop3_b32 v73, v56, v58, s72 bitop3:0x7e
  v_bitop3_b32 v72, v72, v73, 1 bitop3:0xa8
  v_cmp_ne_u32 vcc, 0, v72
  s_cbranch_vccz Cf0_h1p
Cf0_h1s:
  s_mov_b64 exec, vcc
  buffer_load_dwordx4 v[52:55], v76, s[8:11], s60 offen offset:0 sc1
  buffer_load_dwordx4 v[56:59], v76, s[8:11], s60 offen offset:1024 sc1
  s_mov_b64 exec, -1
  s_add_u32 s67, s67, 1
  s_waitcnt vmcnt(1)
  v_mfma_f32_16x16x32_bf16 v[4:7], v[0:3], v[52:55], 0
  v_bitop3_b32 v72, v52, v54, s72 bitop3:0x7e
  s_waitcnt vmcnt(0)
  v_mfma_f32_16x16x32_bf16 v[4:7], v[0:3], v[56:59], v[4:7]
  v_bitop3_b32 v73, v56, v58, s72 bitop3:0x7e
  v_bitop3_b32 v72, v72, v73, 1 bitop3:0xa8
  v_cmp_ne_u32 vcc, 0, v72
  s_cbranch_vccz Cf0_h1p
  s_cmp_lt_u32 s67, 131072
  s_cbranch_scc1 Cf0_h1s
Cf0_h1p:
  s_nop 2
  v_add_f32_dpp v4, v4, v4 row_ror:4 row_mask:0xf bank_mask:0xf
  v_add_f32_dpp v5, v5, v5 row_ror:4 row_mask:0xf bank_mask:0xf
  s_nop 0
  v_add_f32_dpp v4, v4, v4 row_ror:8 row_mask:0xf bank_mask:0xf
  v_add_f32_dpp v5, v5, v5 row_ror:8 row_mask:0xf bank_mask:0xf
  v_cvt_pk_bf16_f32 v4, v4, v5
  buffer_store_dword v4, v69, s[8:11], s62 offen
  s_xor_b32 s62, s62, 16384
  buffer_store_dword v71, v69, s[8:11], s62 offen
  s_xor_b32 s72, s72, 1
  s_branch Cf0_h2
Cf0_h2r:
  s_mov_b64 exec, vcc
  buffer_load_dwordx4 v[0:3], v76, s[8:11], s65 offen offset:0 sc1
  s_mov_b64 exec, -1
  s_add_u32 s67, s67, 1
  s_waitcnt vmcnt(4)
  v_max3_u32 v72, v0, v1, v2
  v_max_u32 v72, v72, v3
  ds_write_b128 v76, v[0:3] offset:4608
  v_cmp_eq_u32 vcc, -1, v72
  s_cbranch_vccz Cf0_h2w
  s_mov_b64 exec, vcc
  buffer_load_dwordx4 v[0:3], v76, s[8:11], s65 offen offset:0 sc1
  s_mov_b64 exec, -1
  s_add_u32 s67, s67, 1
  s_waitcnt vmcnt(4)
  v_max3_u32 v72, v0, v1, v2
  v_max_u32 v72, v72, v3
  ds_write_b128 v76, v[0:3] offset:4608
  v_cmp_eq_u32 vcc, -1, v72
  s_cbranch_vccz Cf0_h2w
Cf0_h2s:
  s_mov_b64 exec, vcc
  buffer_load_dwordx4 v[0:3], v76, s[8:11], s65 offen offset:0 sc1
  s_mov_b64 exec, -1
  s_add_u32 s67, s67, 1
  s_waitcnt vmcnt(2)
  v_max3_u32 v72, v0, v1, v2
  v_max_u32 v72, v72, v3
  ds_write_b128 v76, v[0:3] offset:4608
  v_cmp_eq_u32 vcc, -1, v72
  s_cbranch_vccz Cf0_h2w
  s_mov_b64 exec, vcc
  buffer_load_dwordx4 v[0:3], v76, s[8:11], s65 offen offset:0 sc1
  s_mov_b64 exec, -1
  s_add_u32 s67, s67, 1
  s_waitcnt vmcnt(2)
  v_max3_u32 v72, v0, v1, v2
  v_max_u32 v72, v72, v3
  ds_write_b128 v76, v[0:3] offset:4608
  v_cmp_eq_u32 vcc, -1, v72
  s_cbranch_vccz Cf0_h2w
  s_mov_b64 exec, vcc
  buffer_load_dwordx4 v[0:3], v76, s[8:11], s65 offen offset:0 sc1
  s_mov_b64 exec, -1
  s_add_u32 s67, s67, 1
  s_waitcnt vmcnt(2)
  v_max3_u32 v72, v0, v1, v2
  v_max_u32 v72, v72, v3
  ds_write_b128 v76, v[0:3] offset:4608
  v_cmp_eq_u32 vcc, -1, v72
  s_cbranch_vccz Cf0_h2w
  s_cmp_lt_u32 s67, 131072
  s_cbranch_scc1 Cf0_h2s
  s_branch Cf0_h2w
Cf0_rec:
  s_nop 7
  s_waitcnt vmcnt(0) lgkmcnt(0)
  v_max3_u32 v72, v0, v1, v2
  v_max3_u32 v72, v72, v3, v4
  v_max3_u32 v72, v72, v5, v6
  v_max3_u32 v72, v72, v7, v8
  v_max3_u32 v72, v72, v9, v10
  v_max3_u32 v72, v72, v11, v12
  v_max3_u32 v72, v72, v13, v14
  v_max3_u32 v72, v72, v15, v16
  v_max3_u32 v72, v72, v17, v18
  v_max_u32 v72, v72, v19
  v_cmp_eq_u32 vcc, -1, v72
  s_cbranch_vccz Cf0_recok
  s_barrier
  v_mov_b64 v[20:21], 0
  v_mov_b64 v[22:23], 0
  v_mov_b64 v[24:25], 0
  v_mov_b64 v[26:27], 0
  v_mov_b64 v[28:29], 0
  v_mov_b64 v[30:31], 0
  v_mov_b64 v[32:33], 0
  v_mov_b64 v[34:35], 0
  s_waitcnt lgkmcnt(0)
  s_barrier
  ds_read_b128 v[0:3], v76 offset:4608
  s_waitcnt lgkmcnt(0)
  v_smfmac_f32_16x16x64_bf16 v[20:23], v[0:3], v[80:87], v74
  v_smfmac_f32_16x16x64_bf16 v[24:27], v[0:3], v[88:95], v74
  ds_read_b128 v[60:63], v76 offset:16384
  ds_read_b128 v[64:67], v76 offset:17408
  s_waitcnt lgkmcnt(0)
  v_smfmac_f32_16x16x64_bf16 v[28:31], v[0:3], v[60:67], v74
  ds_read_b128 v[60:63], v76 offset:18432
  ds_read_b128 v[64:67], v76 offset:19456
  s_waitcnt lgkmcnt(0)
  v_smfmac_f32_16x16x64_bf16 v[32:35], v[0:3], v[60:67], v74
  ds_read_b128 v[4:7], v76 offset:5632
  s_waitcnt lgkmcnt(0)
  v_smfmac_f32_16x16x64_bf16 v[20:23], v[4:7], v[96:103], v74
  v_smfmac_f32_16x16x64_bf16 v[24:27], v[4:7], v[104:111], v74
  ds_read_b128 v[60:63], v76 offset:32768
  ds_read_b128 v[64:67], v76 offset:33792
  s_waitcnt lgkmcnt(0)
  v_smfmac_f32_16x16x64_bf16 v[28:31], v[4:7], v[60:67], v74
  ds_read_b128 v[60:63], v76 offset:34816
  ds_read_b128 v[64:67], v76 offset:35840
  s_waitcnt lgkmcnt(0)
  v_smfmac_f32_16x16x64_bf16 v[32:35], v[4:7], v[60:67], v74
  ds_read_b128 v[8:11], v76 offset:6656
  s_waitcnt lgkmcnt(0)
  v_smfmac_f32_16x16x64_bf16 v[20:23], v[8:11], v[112:119], v74
  v_smfmac_f32_16x16x64_bf16 v[24:27], v[8:11], v[120:127], v74
  v_smfmac_f32_16x16x64_bf16 v[28:31], v[8:11], v[208:215], v74
  v_smfmac_f32_16x16x64_bf16 v[32:35], v[8:11], v[216:223], v74
  ds_read_b128 v[12:15], v76 offset:7680
  s_waitcnt lgkmcnt(0)
  v_smfmac_f32_16x16x64_bf16 v[20:23], v[12:15], v[128:135], v74
  v_smfmac_f32_16x16x64_bf16 v[24:27], v[12:15], v[136:143], v74
  v_smfmac_f32_16x16x64_bf16 v[28:31], v[12:15], v[224:231], v74
  v_smfmac_f32_16x16x64_bf16 v[32:35], v[12:15], v[232:239], v74
  ds_read_b128 v[0:3], v76 offset:8704
  s_waitcnt lgkmcnt(0)
  v_smfmac_f32_16x16x64_bf16 v[20:23], v[0:3], v[144:151], v74
  v_smfmac_f32_16x16x64_bf16 v[24:27], v[0:3], v[152:159], v74
  ds_read_b128 v[60:63], v76 offset:49152
  ds_read_b128 v[64:67], v76 offset:50176
  s_waitcnt lgkmcnt(0)
  v_smfmac_f32_16x16x64_bf16 v[28:31], v[0:3], v[60:67], v74
  ds_read_b128 v[60:63], v76 offset:51200
  ds_read_b128 v[64:67], v76 offset:52224
  s_waitcnt lgkmcnt(0)
  v_smfmac_f32_16x16x64_bf16 v[32:35], v[0:3], v[60:67], v74
  ds_read_b128 v[8:11], v76 offset:9728
  s_waitcnt lgkmcnt(0)
  v_smfmac_f32_16x16x64_bf16 v[20:23], v[8:11], v[160:167], v74
  v_smfmac_f32_16x16x64_bf16 v[24:27], v[8:11], v[168:175], v74
  ds_read_b128 v[60:63], v75 offset:16384
  ds_read_b128 v[64:67], v75 offset:17408
  s_waitcnt lgkmcnt(0)
  v_smfmac_f32_16x16x64_bf16 v[28:31], v[8:11], v[60:67], v74
  ds_read_b128 v[60:63], v75 offset:18432
  ds_read_b128 v[64:67], v75 offset:19456
  s_waitcnt lgkmcnt(0)
  v_smfmac_f32_16x16x64_bf16 v[32:35], v[8:11], v[60:67], v74
  ds_read_b128 v[16:19], v76 offset:10752
  ds_read_b128 v[60:63], v75 offset:0
  ds_read_b128 v[64:67], v75 offset:1024
  s_waitcnt lgkmcnt(0)
  v_smfmac_f32_16x16x64_bf16 v[20:23], v[16:19], v[60:67], v74
  ds_read_b128 v[60:63], v75 offset:2048
  ds_read_b128 v[64:67], v75 offset:3072
  s_waitcnt lgkmcnt(0)
  v_smfmac_f32_16x16x64_bf16 v[24:27], v[16:19], v[60:67], v74
  v_smfmac_f32_16x16x64_bf16 v[28:31], v[16:19], v[240:247], v74
  v_smfmac_f32_16x16x64_bf16 v[32:35], v[16:19], v[248:255], v74
  ds_read_b128 v[4:7], v76 offset:11776
  s_waitcnt lgkmcnt(0)
  v_smfmac_f32_16x16x64_bf16 v[20:23], v[4:7], v[176:183], v74
  v_smfmac_f32_16x16x64_bf16 v[24:27], v[4:7], v[184:191], v74
  v_smfmac_f32_16x16x64_bf16 v[28:31], v[4:7], a[0:7], v74
  v_smfmac_f32_16x16x64_bf16 v[32:35], v[4:7], a[8:15], v74
  ds_read_b128 v[12:15], v76 offset:12800
  s_waitcnt lgkmcnt(0)
  v_smfmac_f32_16x16x64_bf16 v[20:23], v[12:15], v[192:199], v74
  v_smfmac_f32_16x16x64_bf16 v[24:27], v[12:15], v[200:207], v74
  v_smfmac_f32_16x16x64_bf16 v[28:31], v[12:15], a[16:23], v74
  v_smfmac_f32_16x16x64_bf16 v[32:35], v[12:15], a[24:31], v74
  v_add_f32 v20, v20, v22
  v_add_f32 v21, v21, v23
  v_add_f32 v24, v24, v26
  v_cvt_pk_bf16_f32 v22, v20, v24
  ds_write_b32 v79, v22 offset:0
  v_add_f32 v25, v25, v27
  v_cvt_pk_bf16_f32 v23, v21, v25
  ds_write_b32 v79, v23 offset:576
  v_add_f32 v28, v28, v30
  v_add_f32 v29, v29, v31
  s_waitcnt lgkmcnt(0)
  s_nop 1
  s_branch Cf0_recok
Cf0_mx:
  s_waitcnt lgkmcnt(0)
  s_barrier
  buffer_load_dwordx4 v[0:3], v76, s[8:11], s58 offen offset:0 sc1
  ds_read_b128 v[20:23], v77 offset:0
  ds_read_b128 v[28:31], v77 offset:256
  buffer_load_dwordx4 v[4:7], v76, s[8:11], s58 offen offset:1024 sc1
  ds_read_b128 v[24:27], v77 offset:128
  ds_read_b128 v[32:35], v77 offset:384
  s_waitcnt vmcnt(1) lgkmcnt(3)
  v_mfma_f32_16x16x32_bf16 v[8:11], v[0:3], v[20:23], 0
  s_waitcnt vmcnt(0) lgkmcnt(1)
  v_mfma_f32_16x16x32_bf16 v[8:11], v[4:7], v[24:27], v[8:11]
  v_mfma_f32_16x16x32_bf16 v[12:15], v[28:31], v[20:23], 0
  s_waitcnt lgkmcnt(0)
  v_mfma_f32_16x16x32_bf16 v[12:15], v[32:35], v[24:27], v[12:15]
  v_add_f32_dpp v8, v10, v8 quad_perm:[2,3,0,1] row_mask:0xf bank_mask:0xf
  v_add_f32_dpp v9, v11, v9 quad_perm:[2,3,0,1] row_mask:0xf bank_mask:0xf
  s_nop 0
  v_mov_b32_dpp v8, v8 quad_perm:[0,1,0,1] row_mask:0xf bank_mask:0xf
  v_mov_b32_dpp v9, v9 quad_perm:[0,1,0,1] row_mask:0xf bank_mask:0xf
  s_nop 1
  v_add_f32_dpp v12, v14, v12 quad_perm:[2,3,0,1] row_mask:0xf bank_mask:0xf
  v_add_f32_dpp v13, v15, v13 quad_perm:[2,3,0,1] row_mask:0xf bank_mask:0xf
  s_nop 0
  v_mov_b32_dpp v12, v12 quad_perm:[0,1,0,1] row_mask:0xf bank_mask:0xf
  v_mov_b32_dpp v13, v13 quad_perm:[0,1,0,1] row_mask:0xf bank_mask:0xf
  v_mul_f32 v12, s69, v12
  ds_write_b32 v78, v8 offset:8704
  v_mul_f32 v13, s69, v13
  ds_write_b32 v78, v9 offset:8768
  s_waitcnt lgkmcnt(0)
  s_barrier
  ds_read_b128 v[36:39], v78 offset:8704
  ds_read_b128 v[40:43], v78 offset:8768
  s_waitcnt lgkmcnt(0)
  s_barrier
  v_max_f32 v16, v36, v37
  v_max3_f32 v16, v16, v38, v39
  v_max3_f32 v16, v16, v40, v41
  v_max3_f32 v16, v16, v42, v43
  v_max3_f32 v16, v16, v12, v13
  v_mov_b32 v17, v16
  s_nop 1
  v_permlane16_swap_b32 v16, v17
  v_max_f32 v16, v16, v17
  v_mov_b32 v17, v16
  s_nop 1
  v_permlane32_swap_b32 v16, v17
  v_max_f32 v16, v16, v17
  v_sub_f32 v36, v36, v16
  v_sub_f32 v37, v37, v16
  v_sub_f32 v38, v38, v16
  v_sub_f32 v39, v39, v16
  v_sub_f32 v40, v40, v16
  v_sub_f32 v41, v41, v16
  v_sub_f32 v42, v42, v16
  v_sub_f32 v43, v43, v16
  v_sub_f32 v12, v12, v16
  v_sub_f32 v13, v13, v16
  v_exp_f32 v36, v36
  v_exp_f32 v37, v37
  v_exp_f32 v38, v38
  v_exp_f32 v39, v39
  v_exp_f32 v40, v40
  v_exp_f32 v41, v41
  v_exp_f32 v42, v42
  v_exp_f32 v43, v43
  v_exp_f32 v12, v12
  v_exp_f32 v13, v13
  v_cvt_pk_bf16_f32 v32, v36, v40
  v_cvt_pk_bf16_f32 v33, v37, v41
  v_cvt_pk_bf16_f32 v34, v38, v42
  v_cvt_pk_bf16_f32 v35, v39, v43
  v_cvt_pk_bf16_f32 v28, v12, v13
  v_cvt_pk_bf16_f32 v31, v12, v13
  v_mov_b32 v29, 0
  v_mov_b32 v30, 0
  v_mov_b32 v68, 0x3f803f80
  v_mov_b32 v69, 0x3f803f80
  v_mov_b32 v70, 0x3f803f80
  v_mov_b32 v71, 0x3f803f80
  s_nop 1
  v_mfma_f32_16x16x32_bf16 v[8:11], v[32:35], v[68:71], 0
  v_mfma_f32_16x16x32_bf16 v[0:3], v[32:35], v[52:55], 0
  v_mfma_f32_16x16x32_bf16 v[4:7], v[32:35], v[56:59], 0
  v_mfma_f32_16x16x16_bf16 v[8:11], v[28:29], v[68:69], v[8:11]
  v_mfma_f32_16x16x16_bf16 v[0:3], v[28:29], v[72:73], v[0:3]
  v_mfma_f32_16x16x16_bf16 v[4:7], v[30:31], v[72:73], v[4:7]
  ds_read_b128 v[68:71], v76 offset:13824
  v_rcp_f32 v10, v8
  v_rcp_f32 v11, v9
  v_mul_f32 v0, v10, v0
  v_mul_f32 v1, v11, v1
  s_nop 0
  v_mul_f32 v4, v10, v4
  v_mul_f32 v5, v11, v5
  v_cvt_pk_bf16_f32 v2, v0, v4
  ds_write_b32 v79, v2 offset:8704
  v_cvt_pk_bf16_f32 v3, v1, v5
  ds_write_b32 v79, v3 offset:9280
  v_mov_b64 v[16:17], 0
  v_mov_b64 v[18:19], 0
  v_mov_b64 v[20:21], 0
  v_mov_b64 v[22:23], 0
  v_mov_b64 v[24:25], 0
  v_mov_b64 v[26:27], 0
  s_branch Cf0_mxok
Cf0_kv3:
  s_waitcnt lgkmcnt(0)
  s_cmp_ge_u32 s57, 0x700
  s_cbranch_scc1 Cf0_kvb
  s_load_dword s57, s[12:13], s71 glc
  s_add_u32 s67, s67, 1
  s_cmp_lt_u32 s67, 131072
  s_cbranch_scc1 Cf0_kv3
  s_waitcnt lgkmcnt(0)
  s_branch Cf0_kvb
Cf0_last:
  ds_read_b128 v[4:7], v76 offset:5632
  ds_read_b128 v[12:15], v76 offset:7680
  ds_read_b128 v[44:47], v76 offset:32768
  ds_read_b128 v[48:51], v76 offset:33792
  s_nop 5
  v_mov_b64 v[20:21], 0
  v_mov_b64 v[22:23], 0
  v_mov_b64 v[24:25], 0
  v_mov_b64 v[26:27], 0
  v_smfmac_f32_16x16x64_bf16 v[28:31], v[0:3], v[36:43], v74
  ds_read_b128 v[36:39], v76 offset:34816
  ds_read_b128 v[40:43], v76 offset:35840
  v_smfmac_f32_16x16x64_bf16 v[32:35], v[0:3], v[60:67], v74
  s_waitcnt lgkmcnt(5)
  v_smfmac_f32_16x16x64_bf16 v[20:23], v[0:3], a[32:39], v74
  ds_read_b128 v[60:63], v76 offset:49152
  ds_read_b128 v[64:67], v76 offset:50176
  v_smfmac_f32_16x16x64_bf16 v[24:27], v[0:3], a[40:47], v74
  s_waitcnt lgkmcnt(4)
  v_smfmac_f32_16x16x64_bf16 v[20:23], v[4:7], a[48:55], v74
  buffer_store_dwordx4 v[16:19], v76, s[8:11], s68 offen sc1
  v_smfmac_f32_16x16x64_bf16 v[24:27], v[4:7], a[56:63], v74
  v_smfmac_f32_16x16x64_bf16 v[28:31], v[4:7], v[44:51], v74
  s_waitcnt lgkmcnt(2)
  v_smfmac_f32_16x16x64_bf16 v[20:23], v[8:11], a[64:71], v74
  ds_read_b128 v[44:47], v76 offset:51200
  ds_read_b128 v[48:51], v76 offset:52224
  v_smfmac_f32_16x16x64_bf16 v[24:27], v[8:11], a[72:79], v74
  v_smfmac_f32_16x16x64_bf16 v[32:35], v[4:7], v[36:43], v74
  v_smfmac_f32_16x16x64_bf16 v[28:31], v[8:11], v[208:215], v74
  ds_read_b128 v[36:39], v75 offset:16384
  ds_read_b128 v[40:43], v75 offset:17408
  v_smfmac_f32_16x16x64_bf16 v[32:35], v[8:11], v[216:223], v74
  v_smfmac_f32_16x16x64_bf16 v[20:23], v[12:15], a[80:87], v74
  v_smfmac_f32_16x16x64_bf16 v[24:27], v[12:15], a[88:95], v74
  v_smfmac_f32_16x16x64_bf16 v[28:31], v[12:15], v[224:231], v74
  v_smfmac_f32_16x16x64_bf16 v[32:35], v[12:15], v[232:239], v74
  s_waitcnt vmcnt(2)
  s_waitcnt vmcnt(1)
  s_barrier
Cf0_lastr:
  ds_read_b128 v[0:3], v76 offset:8704
  ds_read_b128 v[8:11], v76 offset:9728
  ds_read_b128 v[16:19], v76 offset:10752
  ds_read_b128 v[4:7], v76 offset:11776
  ds_read_b128 v[12:15], v76 offset:12800
  s_waitcnt lgkmcnt(4)
  v_max3_u32 v72, v0, v1, v2
  s_waitcnt lgkmcnt(1)
  v_max3_u32 v72, v72, v3, v4
  v_max3_u32 v72, v72, v5, v6
  v_max3_u32 v72, v72, v7, v8
  v_max3_u32 v72, v72, v9, v10
  s_waitcnt lgkmcnt(0)
  v_max3_u32 v72, v72, v11, v12
  v_max3_u32 v72, v72, v13, v14
  v_max3_u32 v72, v72, v15, v16
  v_max3_u32 v72, v72, v17, v18
  v_max_u32 v72, v72, v19
  v_cmp_eq_u32 vcc, -1, v72
  s_cbranch_vccnz Cf0_lastp
Cf0_lastg:
  v_smfmac_f32_16x16x64_bf16 v[28:31], v[0:3], v[60:67], v74
  ds_read_b128 v[60:63], v75 offset:18432
  ds_read_b128 v[64:67], v75 offset:19456
  v_smfmac_f32_16x16x64_bf16 v[32:35], v[0:3], v[44:51], v74
  v_smfmac_f32_16x16x64_bf16 v[28:31], v[8:11], v[36:43], v74
  v_smfmac_f32_16x16x64_bf16 v[28:31], v[16:19], v[240:247], v74
  v_smfmac_f32_16x16x64_bf16 v[28:31], v[4:7], a[0:7], v74
  v_smfmac_f32_16x16x64_bf16 v[28:31], v[12:15], a[16:23], v74
  v_smfmac_f32_16x16x64_bf16 v[32:35], v[16:19], v[248:255], v74
  v_smfmac_f32_16x16x64_bf16 v[32:35], v[4:7], a[8:15], v74
  s_waitcnt lgkmcnt(0)
  v_smfmac_f32_16x16x64_bf16 v[32:35], v[12:15], a[24:31], v74
  v_smfmac_f32_16x16x64_bf16 v[32:35], v[8:11], v[60:67], v74
  v_smfmac_f32_16x16x64_bf16 v[20:23], v[0:3], a[96:103], v74
  v_smfmac_f32_16x16x64_bf16 v[20:23], v[8:11], a[112:119], v74
  v_add_f32 v28, v28, v30
  v_add_f32 v32, v32, v34
  v_cvt_pk_bf16_f32 v30, v28, v32
  v_smfmac_f32_16x16x64_bf16 v[20:23], v[16:19], a[128:135], v74
  ds_write_b32 v79, v30 offset:256
  v_add_f32 v29, v29, v31
  v_add_f32 v33, v33, v35
  v_cvt_pk_bf16_f32 v31, v29, v33
  v_smfmac_f32_16x16x64_bf16 v[20:23], v[4:7], a[144:151], v74
  ds_write_b32 v79, v31 offset:832
  v_smfmac_f32_16x16x64_bf16 v[20:23], v[12:15], a[160:167], v74
  v_smfmac_f32_16x16x64_bf16 v[24:27], v[0:3], a[104:111], v74
  v_smfmac_f32_16x16x64_bf16 v[24:27], v[8:11], a[120:127], v74
  v_smfmac_f32_16x16x64_bf16 v[24:27], v[16:19], a[136:143], v74
  s_waitcnt lgkmcnt(0)
  s_barrier
  ds_read_b64 v[52:53], v77 offset:256
  v_add_f32 v20, v20, v22
  v_smfmac_f32_16x16x64_bf16 v[24:27], v[4:7], a[152:159], v74
  v_add_f32 v21, v21, v23
  v_smfmac_f32_16x16x64_bf16 v[24:27], v[12:15], a[168:175], v74
  v_cvt_pk_bf16_f32 v54, v20, v21
  s_add_u32 s68, s68, 655360
  s_nop 3
  v_add_f32 v24, v24, v26
  v_add_f32 v25, v25, v27
  v_cvt_pk_bf16_f32 v55, v24, v25
  s_waitcnt lgkmcnt(0)
  buffer_store_dwordx4 v[52:55], v76, s[8:11], s68 offen sc1
  s_branch Cf0_done
Cf0_lastp:
  s_add_u32 s72, s72, 2
  s_cmp_ge_u32 s72, 131072
  s_cbranch_scc1 Cf0_lastg
  s_barrier
  buffer_load_dwordx4 v76, s[8:11], s55 offen offset:0 sc1 lds
  s_waitcnt vmcnt(0)
  s_barrier
  s_branch Cf0_lastr
Cf0_done:
  s_branch L_cexit
L_w1:
  v_mov_b64 v[20:21], 0
  v_mov_b64 v[22:23], 0
  v_mov_b64 v[24:25], 0
  v_mov_b64 v[26:27], 0
  v_mov_b64 v[28:29], 0
  v_mov_b64 v[30:31], 0
  v_mov_b64 v[32:33], 0
  v_mov_b64 v[34:35], 0
  s_mov_b32 s78, 0x3f803f80
  s_mov_b32 s79, s78
  s_mov_b32 s65, 360448
  s_mov_b32 m0, 15872
  s_lshl_b32 s71, s53, 2
  s_add_u32 s71, s71, 128
  s_movk_i32 s56, 0x1000
  v_lshlrev_b32 v73, 2, v76
  v_mov_b32 v72, 0
  s_mov_b64 s[16:17], s[8:9]
  s_mov_b32 s18, 268435456
  s_mov_b32 s19, 0x20000
  s_getpc_b64 s[20:21]
Cf1_pc:
  s_add_u32 s20, s20, (Cf1_last - Cf1_pc)
  s_addc_u32 s21, s21, 0
  v_mov_b32 v68, 14880
  buffer_load_dwordx4 v[52:55], v76, s[8:11], s59 offen offset:0 sc1
  buffer_load_dwordx4 v[56:59], v76, s[8:11], s59 offen offset:1024 sc1
  ds_read_b128 v[36:39], v76 offset:20480
  ds_read_b128 v[40:43], v76 offset:21504
  ds_read_b128 v[60:63], v76 offset:22528
  ds_read_b128 v[64:67], v76 offset:23552
  ds_read_b128 v[0:3], v76 offset:4608
  ds_read_b128 v[4:7], v76 offset:5632
  ds_read_b128 v[8:11], v76 offset:6656
  ds_read_b128 v[12:15], v76 offset:7680
  s_waitcnt lgkmcnt(0)
  s_cmp_eq_u32 s66, 1
  s_branch Cf1_top2
.p2align 6
Cf1_h2:
  v_lshlrev_b32 v73, 2, v76
  s_mov_b32 m0, 11776
  s_add_u32 s55, s65, 7168
  s_nop 15
  s_nop 3
  buffer_load_dwordx4 v[8:11], v76, s[8:11], s65 offen offset:2048 sc1
  s_nop 15
  s_nop 3
  buffer_load_dwordx4 v[8:11], v76, s[8:11], s65 offen offset:2048 sc1
  s_nop 15
  s_nop 3
  buffer_load_dwordx4 v[8:11], v76, s[8:11], s65 offen offset:2048 sc1
  s_waitcnt vmcnt(5)
  ds_read_b128 v[36:39], v76 offset:20480
  ds_read_b128 v[40:43], v76 offset:21504
  ds_read_b128 v[60:63], v76 offset:22528
  ds_read_b128 v[64:67], v76 offset:23552
  buffer_load_dwordx4 v[52:55], v76, s[8:11], s59 offen offset:0 sc1
  buffer_load_dwordx4 v[56:59], v76, s[8:11], s59 offen offset:1024 sc1
  s_waitcnt vmcnt(4)
  v_max3_u32 v72, v8, v9, v10
  v_max_u32 v72, v72, v11
  ds_write_b128 v76, v[8:11] offset:6656
  v_cmp_eq_u32 vcc, -1, v72
  s_cbranch_vccnz Cf1_h2r
Cf1_h2w:
  s_cmp_eq_u32 s66, 63
  s_waitcnt lgkmcnt(0)
  s_barrier
  ds_read_b128 v[0:3], v76 offset:4608
  buffer_load_dwordx4 v76, s[8:11], s55 offen offset:0 sc1 lds
Cf1_top2:
  v_smfmac_f32_16x16x64_bf16 v[20:23], v[8:11], v[112:119], v74
  s_cbranch_scc1 Cf1_last
  v_smfmac_f32_16x16x64_bf16 v[24:27], v[8:11], v[120:127], v74
  buffer_load_dwordx4 v[44:47], v76, s[8:11], s58 offen offset:0 sc1
  s_mov_b32 m0, 15872
  v_smfmac_f32_16x16x64_bf16 v[28:31], v[8:11], v[208:215], v74
  buffer_load_dwordx4 v[48:51], v76, s[8:11], s58 offen offset:1024 sc1
  v_smfmac_f32_16x16x64_bf16 v[32:35], v[8:11], v[216:223], v74
  ds_read_b128 v[4:7], v76 offset:5632
  s_waitcnt lgkmcnt(1)
  v_smfmac_f32_16x16x64_bf16 v[20:23], v[0:3], v[80:87], v74
  ds_read_b128 v[12:15], v76 offset:7680
  v_smfmac_f32_16x16x64_bf16 v[28:31], v[0:3], v[36:43], v74
  ds_read_b128 v[36:39], v76 offset:36864
  v_smfmac_f32_16x16x64_bf16 v[24:27], v[0:3], v[88:95], v74
  buffer_store_dwordx4 v[16:19], v76, s[8:11], s68 offen sc1
  ds_read_b128 v[40:43], v76 offset:37888
  v_smfmac_f32_16x16x64_bf16 v[32:35], v[0:3], v[60:67], v74
  ds_read_b128 v[60:63], v76 offset:38912
  s_waitcnt lgkmcnt(4)
  v_smfmac_f32_16x16x64_bf16 v[20:23], v[4:7], v[96:103], v74
  ds_read_b128 v[64:67], v76 offset:39936
  v_smfmac_f32_16x16x64_bf16 v[24:27], v[4:7], v[104:111], v74
  buffer_load_dword v73, s[16:19], s70 offen lds
  s_waitcnt vmcnt(5)
  s_waitcnt lgkmcnt(4)
  v_smfmac_f32_16x16x64_bf16 v[20:23], v[12:15], v[128:135], v74
  s_barrier
  s_waitcnt lgkmcnt(2)
  v_smfmac_f32_16x16x64_bf16 v[28:31], v[4:7], v[36:43], v74
  ds_read_b128 v[8:11], v76 offset:8704
  v_smfmac_f32_16x16x64_bf16 v[24:27], v[12:15], v[136:143], v74
  ds_read_b128 v[36:39], v76 offset:53248
  s_waitcnt lgkmcnt(2)
  v_smfmac_f32_16x16x64_bf16 v[32:35], v[4:7], v[60:67], v74
  ds_read_b128 v[40:43], v76 offset:54272
  v_smfmac_f32_16x16x64_bf16 v[28:31], v[12:15], v[224:231], v74
  ds_read_b128 v[60:63], v76 offset:55296
  v_smfmac_f32_16x16x64_bf16 v[32:35], v[12:15], v[232:239], v74
  ds_read_b128 v[64:67], v76 offset:56320
  s_waitcnt lgkmcnt(4)
  v_smfmac_f32_16x16x64_bf16 v[20:23], v[8:11], v[144:151], v74
  s_waitcnt vmcnt(4)
  ds_read_b128 v[0:3], v76 offset:9728
  s_waitcnt lgkmcnt(3)
  v_smfmac_f32_16x16x64_bf16 v[28:31], v[8:11], v[36:43], v74
  s_barrier
  ds_read_b128 v[4:7], v76 offset:11776
  v_smfmac_f32_16x16x64_bf16 v[24:27], v[8:11], v[152:159], v74
  ds_read_b128 v[36:39], v75 offset:4096
  ds_read_b128 v[40:43], v75 offset:5120
  s_waitcnt lgkmcnt(4)
  v_smfmac_f32_16x16x64_bf16 v[32:35], v[8:11], v[60:67], v74
  ds_read_b128 v[16:19], v76 offset:10752
  s_waitcnt lgkmcnt(4)
  v_smfmac_f32_16x16x64_bf16 v[20:23], v[0:3], v[160:167], v74
  ds_read_b128 v[12:15], v76 offset:12800
  v_smfmac_f32_16x16x64_bf16 v[24:27], v[0:3], v[168:175], v74
  ds_read_b128 v[60:63], v75 offset:6144
  ds_read_b128 v[64:67], v75 offset:7168
  s_waitcnt lgkmcnt(6)
  v_smfmac_f32_16x16x64_bf16 v[20:23], v[4:7], v[176:183], v74
  s_waitcnt lgkmcnt(3)
  v_smfmac_f32_16x16x64_bf16 v[20:23], v[16:19], v[36:43], v74
  ds_read_b128 v[36:39], v75 offset:20480
  s_waitcnt lgkmcnt(3)
  v_smfmac_f32_16x16x64_bf16 v[20:23], v[12:15], v[192:199], v74
  ds_read_b128 v[40:43], v75 offset:21504
  s_waitcnt lgkmcnt(2)
  v_smfmac_f32_16x16x64_bf16 v[24:27], v[16:19], v[60:67], v74
  ds_read_b128 v[60:63], v75 offset:22528
  v_smfmac_f32_16x16x64_bf16 v[24:27], v[4:7], v[184:191], v74
  ds_read_b128 v[64:67], v75 offset:23552
  v_add_f32 v20, v20, v22
  v_smfmac_f32_16x16x64_bf16 v[24:27], v[12:15], v[200:207], v74
  v_add_f32 v21, v21, v23
  v_smfmac_f32_16x16x64_bf16 v[28:31], v[16:19], v[240:247], v74
  s_waitcnt lgkmcnt(2)
  v_mov_b64 v[70:71], s[78:79]
  v_smfmac_f32_16x16x64_bf16 v[28:31], v[0:3], v[36:43], v74
  ds_read_b128 v[36:39], v68
  v_add_f32 v24, v24, v26
  v_smfmac_f32_16x16x64_bf16 v[28:31], v[4:7], a[0:7], v74
  ds_read_b128 v[40:43], v68
  v_cvt_pk_bf16_f32 v22, v20, v24
  v_smfmac_f32_16x16x64_bf16 v[28:31], v[12:15], a[16:23], v74
  ds_write_b32 v79, v22 offset:0
  s_waitcnt lgkmcnt(3)
  v_add_f32 v25, v25, v27
  v_cvt_pk_bf16_f32 v23, v21, v25
  v_smfmac_f32_16x16x64_bf16 v[32:35], v[0:3], v[60:67], v74
  ds_write_b32 v79, v23 offset:576
  v_cmp_u_f32 vcc, v20, v21
  v_smfmac_f32_16x16x64_bf16 v[32:35], v[16:19], v[248:255], v74
  v_add_f32 v28, v28, v30
  v_smfmac_f32_16x16x64_bf16 v[32:35], v[4:7], a[8:15], v74
  v_add_f32 v29, v29, v31
  v_smfmac_f32_16x16x64_bf16 v[32:35], v[12:15], a[24:31], v74
  s_cbranch_vccnz Cf1_rec
Cf1_recok:
  s_waitcnt lgkmcnt(3)
  v_smfmac_f32_16x16x64_bf16 v[36:39], v[16:19], a[128:135], v74
  s_waitcnt lgkmcnt(0)
  s_barrier
  ds_read_b128 v[60:63], v77
  v_smfmac_f32_16x16x64_bf16 v[40:43], v[16:19], a[136:143], v74
  ds_read_b128 v[64:67], v77 offset:128
  v_add_f32 v32, v32, v34
  v_cvt_pk_bf16_f32 v30, v28, v32
  v_smfmac_f32_16x16x64_bf16 v[36:39], v[0:3], a[112:119], v74
  ds_write_b32 v79, v30 offset:256
  v_add_f32 v33, v33, v35
  v_cvt_pk_bf16_f32 v31, v29, v33
  v_smfmac_f32_16x16x64_bf16 v[40:43], v[0:3], a[120:127], v74
  ds_write_b32 v79, v31 offset:832
  v_xor_b32 v75, 0x8000, v75
  v_smfmac_f32_16x16x64_bf16 v[36:39], v[4:7], a[144:151], v74
  ds_read_b128 v[0:3], v76 offset:4608
  v_mov_b32 v29, 0
  v_smfmac_f32_16x16x64_bf16 v[40:43], v[4:7], a[152:159], v74
  s_waitcnt vmcnt(2) lgkmcnt(3)
  v_mov_b32 v30, 0
  v_mfma_f32_16x16x32_bf16 v[44:47], v[44:47], v[60:63], 0
  ds_read_b128 v[4:7], v76 offset:5632
  s_waitcnt lgkmcnt(2)
  v_mfma_f32_16x16x32_bf16 v[44:47], v[48:51], v[64:67], v[44:47]
  s_barrier
  v_smfmac_f32_16x16x64_bf16 v[36:39], v[8:11], a[96:103], v74
  ds_read_b128 v[20:23], v77 offset:256
  ds_read_b128 v[24:27], v77 offset:384
  v_smfmac_f32_16x16x64_bf16 v[40:43], v[8:11], a[104:111], v74
  ds_read_b128 v[8:11], v76 offset:6656
  v_add_f32_dpp v72, v46, v44 quad_perm:[2,3,0,1] row_mask:0xf bank_mask:0xf
  v_add_f32_dpp v73, v47, v45 quad_perm:[2,3,0,1] row_mask:0xf bank_mask:0xf
  v_smfmac_f32_16x16x64_bf16 v[36:39], v[12:15], a[160:167], v74
  s_waitcnt lgkmcnt(4)
  v_exp_f32_dpp v72, v72 quad_perm:[0,1,0,1] row_mask:0xf bank_mask:0xf
  v_smfmac_f32_16x16x64_bf16 v[40:43], v[12:15], a[168:175], v74
  ds_read_b128 v[12:15], v76 offset:7680
  v_exp_f32_dpp v73, v73 quad_perm:[0,1,0,1] row_mask:0xf bank_mask:0xf
  v_smfmac_f32_16x16x64_bf16 v[36:39], v[0:3], a[32:39], v74
  s_waitcnt lgkmcnt(2)
  v_cvt_pk_bf16_f32 v72, v72, v73
  v_mfma_f32_16x16x32_bf16 v[20:23], v[20:23], v[60:63], 0
  ds_write_b32 v78, v72 offset:516
  v_mov_b64 v[16:17], 0
  v_mfma_f32_16x16x32_bf16 v[20:23], v[24:27], v[64:67], v[20:23]
  ds_read_b128 v[44:47], v75 offset:20480
  v_mov_b64 v[18:19], 0
  v_smfmac_f32_16x16x64_bf16 v[40:43], v[0:3], a[40:47], v74
  ds_read_b128 v[48:51], v75 offset:21504
  v_mov_b64 v[68:69], s[78:79]
  v_smfmac_f32_16x16x64_bf16 v[36:39], v[4:7], a[48:55], v74
  s_waitcnt lgkmcnt(4)
  v_add_f32_dpp v24, v22, v20 quad_perm:[2,3,0,1] row_mask:0xf bank_mask:0xf
  v_add_f32_dpp v25, v23, v21 quad_perm:[2,3,0,1] row_mask:0xf bank_mask:0xf
  v_smfmac_f32_16x16x64_bf16 v[36:39], v[8:11], a[64:71], v74
  s_waitcnt lgkmcnt(2)
  s_barrier
  ds_read_b128 v[32:35], v78 offset:512
  v_smfmac_f32_16x16x64_bf16 v[36:39], v[12:15], a[80:87], v74
  ds_read_b128 v[60:63], v75 offset:22528
  v_mul_f32 v24, s69, v24
  v_smfmac_f32_16x16x64_bf16 v[40:43], v[4:7], a[56:63], v74
  ds_read_b128 v[64:67], v75 offset:23552
  v_mul_f32 v25, s69, v25
  v_smfmac_f32_16x16x64_bf16 v[40:43], v[8:11], a[72:79], v74
  v_exp_f32_dpp v24, v24 quad_perm:[0,1,0,1] row_mask:0xf bank_mask:0xf
  v_smfmac_f32_16x16x64_bf16 v[40:43], v[12:15], a[88:95], v74
  s_waitcnt lgkmcnt(2)
  v_exp_f32_dpp v25, v25 quad_perm:[0,1,0,1] row_mask:0xf bank_mask:0xf
  v_mfma_f32_16x16x32_bf16 v[8:11], v[32:35], v[68:71], 0
  v_add_f32 v36, v36, v38
  v_add_f32 v37, v37, v39
  v_mfma_f32_16x16x32_bf16 v[0:3], v[32:35], v[52:55], 0
  v_add_f32 v40, v40, v42
  v_add_f32 v41, v41, v43
  v_mfma_f32_16x16x32_bf16 v[4:7], v[32:35], v[56:59], 0
  v_cvt_pk_bf16_f32 v28, v24, v25
  v_cvt_pk_bf16_f32 v72, v36, v37
  v_cvt_pk_bf16_f32 v73, v40, v41
  v_mfma_f32_16x16x16_bf16 v[8:11], v[28:29], v[68:69], v[8:11]
  v_cvt_pk_bf16_f32 v31, v24, v25
  v_mov_b64 v[20:21], 0
  v_mfma_f32_16x16x16_bf16 v[0:3], v[28:29], v[72:73], v[0:3]
  ds_read_b128 v[68:71], v76 offset:13824
  v_mov_b64 v[22:23], 0
  v_mfma_f32_16x16x16_bf16 v[4:7], v[30:31], v[72:73], v[4:7]
  v_rcp_f32 v10, v8
  v_rcp_f32 v11, v9
  v_mul_f32 v0, v10, v0
  v_mul_f32 v1, v11, v1
  s_nop 0
  v_mul_f32 v4, v10, v4
  v_mul_f32 v5, v11, v5
  v_cvt_pk_bf16_f32 v2, v0, v4
  ds_write_b32 v79, v2 offset:8704
  v_cvt_pk_bf16_f32 v3, v1, v5
  ds_write_b32 v79, v3 offset:9280
  v_max3_f32 v8, v8, v9, v10
  v_max_f32 v8, v8, v11
  v_cmp_le_f32 vcc, 1317011456, v8
  v_mov_b64 v[24:25], 0
  v_mov_b64 v[26:27], 0
  s_cbranch_vccnz Cf1_mx
Cf1_mxok:
  s_waitcnt lgkmcnt(0)
  s_barrier
  ds_read_b128 v[0:3], v78 offset:8704
  ds_read_b128 v[4:7], v78 offset:8768
  ds_read_b128 v[8:11], v78 offset:8832
  ds_read_b128 v[12:15], v78 offset:8896
  s_waitcnt lgkmcnt(3)
  v_smfmac_f32_16x16x64_bf16 v[16:19], v[0:3], v[44:51], v74
  ds_read_b128 v[52:55], v75 offset:36864
  s_waitcnt lgkmcnt(3)
  v_smfmac_f32_16x16x64_bf16 v[16:19], v[4:7], v[60:67], v74
  ds_read_b128 v[56:59], v75 offset:37888
  s_waitcnt lgkmcnt(3)
  v_smfmac_f32_16x16x64_bf16 v[16:19], v[8:11], a[176:183], v74
  ds_read_b128 v[36:39], v75 offset:38912
  s_waitcnt lgkmcnt(3)
  v_smfmac_f32_16x16x64_bf16 v[16:19], v[12:15], a[184:191], v74
  ds_read_b128 v[40:43], v75 offset:39936
  ds_read_b128 v[44:47], v75 offset:53248
  v_smfmac_f32_16x16x64_bf16 v[20:23], v[0:3], a[192:199], v74
  ds_read_b128 v[48:51], v75 offset:54272
  ds_read_b128 v[60:63], v75 offset:55296
  v_smfmac_f32_16x16x64_bf16 v[20:23], v[4:7], a[200:207], v74
  ds_read_b128 v[64:67], v75 offset:56320
  s_waitcnt lgkmcnt(6)
  v_cvt_pk_bf16_f32 v16, v16, v17
  v_cvt_pk_bf16_f32 v17, v18, v19
  v_bfi_b32 v16, 1, s72, v16
  v_smfmac_f32_16x16x64_bf16 v[20:23], v[8:11], v[52:59], v74
  buffer_store_dwordx2 v[16:17], v68, s[8:11], s73 offen
  s_waitcnt lgkmcnt(4)
  v_smfmac_f32_16x16x64_bf16 v[20:23], v[12:15], v[36:43], v74
  v_mov_b64 v[32:33], 0
  v_smfmac_f32_16x16x64_bf16 v[24:27], v[0:3], a[208:215], v74
  v_mov_b64 v[34:35], 0
  v_smfmac_f32_16x16x64_bf16 v[24:27], v[4:7], a[216:223], v74
  s_waitcnt lgkmcnt(2)
  v_cvt_pk_bf16_f32 v20, v20, v21
  v_cvt_pk_bf16_f32 v21, v22, v23
  v_bfi_b32 v20, 1, s72, v20
  v_smfmac_f32_16x16x64_bf16 v[24:27], v[8:11], v[44:51], v74
  buffer_store_dwordx2 v[20:21], v68, s[8:11], s74 offen
  s_waitcnt lgkmcnt(0)
  v_smfmac_f32_16x16x64_bf16 v[24:27], v[12:15], v[60:67], v74
  v_smfmac_f32_16x16x64_bf16 v[32:35], v[0:3], a[224:231], v74
  v_smfmac_f32_16x16x64_bf16 v[32:35], v[4:7], a[232:239], v74
  v_cvt_pk_bf16_f32 v24, v24, v25
  v_cvt_pk_bf16_f32 v25, v26, v27
  v_bfi_b32 v24, 1, s72, v24
  v_smfmac_f32_16x16x64_bf16 v[32:35], v[8:11], a[240:247], v74
  buffer_store_dwordx2 v[24:25], v68, s[8:11], s75 offen
  v_smfmac_f32_16x16x64_bf16 v[32:35], v[12:15], a[248:255], v74
  ds_read_b128 v[0:3], v76 offset:14848
  ds_read_b64 v[16:17], v77 offset:264
  v_mov_b64 v[18:19], v[72:73]
  v_xor_b32 v75, 0x8000, v75
  s_nop 3
  v_cvt_pk_bf16_f32 v32, v32, v33
  v_cvt_pk_bf16_f32 v33, v34, v35
  v_bfi_b32 v32, 1, s72, v32
  buffer_store_dwordx2 v[32:33], v68, s[8:11], s76 offen
  v_mov_b64 v[20:21], 0
  v_mov_b64 v[22:23], 0
  v_mov_b64 v[24:25], 0
  v_mov_b64 v[26:27], 0
  v_mov_b64 v[28:29], 0
  v_mov_b64 v[30:31], 0
  v_mov_b64 v[32:33], 0
  v_mov_b64 v[34:35], 0
  v_mov_b32 v68, 14880
  s_add_u32 s58, s58, 655360
  s_add_u32 s59, s59, 655360
  s_add_u32 s70, s70, 655360
  s_add_u32 s68, s68, 655360
  s_add_u32 s66, s66, 1
  s_xor_b32 s64, s64, 16384
  s_xor_b32 s65, s65, 16384
  s_cmp_eq_u32 s66, 62
  s_cselect_b64 s[16:17], s[20:21], s[16:17]
  s_cselect_b32 s18, (Cf1_done - Cf1_last), s18
  s_cselect_b32 s70, 0, s70
  s_cmp_eq_u32 s66, 63
  s_cselect_b32 s59, 268435456, s59
  s_cselect_b32 s58, 268435456, s58
  s_nop 15
  s_nop 13
  buffer_load_dwordx4 v[52:55], v76, s[8:11], s60 offen offset:0 sc1
  buffer_load_dwordx4 v[56:59], v76, s[8:11], s60 offen offset:1024 sc1
  s_waitcnt lgkmcnt(0)
  s_waitcnt vmcnt(1)
  v_mfma_f32_16x16x32_bf16 v[4:7], v[0:3], v[52:55], 0
  v_bitop3_b32 v72, v52, v54, s72 bitop3:0x7e
  s_waitcnt vmcnt(0)
  v_mfma_f32_16x16x32_bf16 v[4:7], v[0:3], v[56:59], v[4:7]
  v_bitop3_b32 v73, v56, v58, s72 bitop3:0x7e
  v_bitop3_b32 v72, v72, v73, 1 bitop3:0xa8
  v_cmp_ne_u32 vcc, 0, v72
  s_nop 0
  s_cmp_eq_u64 vcc, 0
  s_cselect_b32 s54, s62, 268435456
  s_nop 0
  v_add_f32_dpp v4, v4, v4 row_ror:4 row_mask:0xf bank_mask:0xf
  v_add_f32_dpp v5, v5, v5 row_ror:4 row_mask:0xf bank_mask:0xf
  s_nop 0
  v_add_f32_dpp v4, v4, v4 row_ror:8 row_mask:0xf bank_mask:0xf
  v_add_f32_dpp v5, v5, v5 row_ror:8 row_mask:0xf bank_mask:0xf
  v_cvt_pk_bf16_f32 v4, v4, v5
  buffer_store_dword v4, v69, s[8:11], s54 offen
  s_cbranch_vccnz Cf1_h1r
  s_xor_b32 s62, s62, 16384
  buffer_store_dword v71, v69, s[8:11], s62 offen
  s_xor_b32 s72, s72, 1
  s_branch Cf1_h2
Cf1_h1r:
  s_mov_b64 exec, vcc
  buffer_load_dwordx4 v[52:55], v76, s[8:11], s60 offen offset:0 sc1
  buffer_load_dwordx4 v[56:59], v76, s[8:11], s60 offen offset:1024 sc1
  s_mov_b64 exec, -1
  s_add_u32 s67, s67, 1
  s_waitcnt vmcnt(1)
  v_mfma_f32_16x16x32_bf16 v[4:7], v[0:3], v[52:55], 0
  v_bitop3_b32 v72, v52, v54, s72 bitop3:0x7e
  s_waitcnt vmcnt(0)
  v_mfma_f32_16x16x32_bf16 v[4:7], v[0:3], v[56:59], v[4:7]
  v_bitop3_b32 v73, v56, v58, s72 bitop3:0x7e
  v_bitop3_b32 v72, v72, v73, 1 bitop3:0xa8
  v_cmp_ne_u32 vcc, 0, v72
  s_cbranch_vccz Cf1_h1p
Cf1_h1s:
  s_mov_b64 exec, vcc
  buffer_load_dwordx4 v[52:55], v76, s[8:11], s60 offen offset:0 sc1
  buffer_load_dwordx4 v[56:59], v76, s[8:11], s60 offen offset:1024 sc1
  s_mov_b64 exec, -1
  s_add_u32 s67, s67, 1
  s_waitcnt vmcnt(1)
  v_mfma_f32_16x16x32_bf16 v[4:7], v[0:3], v[52:55], 0
  v_bitop3_b32 v72, v52, v54, s72 bitop3:0x7e
  s_waitcnt vmcnt(0)
  v_mfma_f32_16x16x32_bf16 v[4:7], v[0:3], v[56:59], v[4:7]
  v_bitop3_b32 v73, v56, v58, s72 bitop3:0x7e
  v_bitop3_b32 v72, v72, v73, 1 bitop3:0xa8
  v_cmp_ne_u32 vcc, 0, v72
  s_cbranch_vccz Cf1_h1p
  s_cmp_lt_u32 s67, 131072
  s_cbranch_scc1 Cf1_h1s
Cf1_h1p:
  s_nop 2
  v_add_f32_dpp v4, v4, v4 row_ror:4 row_mask:0xf bank_mask:0xf
  v_add_f32_dpp v5, v5, v5 row_ror:4 row_mask:0xf bank_mask:0xf
  s_nop 0
  v_add_f32_dpp v4, v4, v4 row_ror:8 row_mask:0xf bank_mask:0xf
  v_add_f32_dpp v5, v5, v5 row_ror:8 row_mask:0xf bank_mask:0xf
  v_cvt_pk_bf16_f32 v4, v4, v5
  buffer_store_dword v4, v69, s[8:11], s62 offen
  s_xor_b32 s62, s62, 16384
  buffer_store_dword v71, v69, s[8:11], s62 offen
  s_xor_b32 s72, s72, 1
  s_branch Cf1_h2
Cf1_h2r:
  s_mov_b64 exec, vcc
  buffer_load_dwordx4 v[8:11], v76, s[8:11], s65 offen offset:2048 sc1
  s_mov_b64 exec, -1
  s_add_u32 s67, s67, 1
  s_waitcnt vmcnt(4)
  v_max3_u32 v72, v8, v9, v10
  v_max_u32 v72, v72, v11
  ds_write_b128 v76, v[8:11] offset:6656
  v_cmp_eq_u32 vcc, -1, v72
  s_cbranch_vccz Cf1_h2w
  s_mov_b64 exec, vcc
  buffer_load_dwordx4 v[8:11], v76, s[8:11], s65 offen offset:2048 sc1
  s_mov_b64 exec, -1
  s_add_u32 s67, s67, 1
  s_waitcnt vmcnt(4)
  v_max3_u32 v72, v8, v9, v10
  v_max_u32 v72, v72, v11
  ds_write_b128 v76, v[8:11] offset:6656
  v_cmp_eq_u32 vcc, -1, v72
  s_cbranch_vccz Cf1_h2w
Cf1_h2s:
  s_mov_b64 exec, vcc
  buffer_load_dwordx4 v[8:11], v76, s[8:11], s65 offen offset:2048 sc1
  s_mov_b64 exec, -1
  s_add_u32 s67, s67, 1
  s_waitcnt vmcnt(2)
  v_max3_u32 v72, v8, v9, v10
  v_max_u32 v72, v72, v11
  ds_write_b128 v76, v[8:11] offset:6656
  v_cmp_eq_u32 vcc, -1, v72
  s_cbranch_vccz Cf1_h2w
  s_mov_b64 exec, vcc
  buffer_load_dwordx4 v[8:11], v76, s[8:11], s65 offen offset:2048 sc1
  s_mov_b64 exec, -1
  s_add_u32 s67, s67, 1
  s_waitcnt vmcnt(2)
  v_max3_u32 v72, v8, v9, v10
  v_max_u32 v72, v72, v11
  ds_write_b128 v76, v[8:11] offset:6656
  v_cmp_eq_u32 vcc, -1, v72
  s_cbranch_vccz Cf1_h2w
  s_mov_b64 exec, vcc
  buffer_load_dwordx4 v[8:11], v76, s[8:11], s65 offen offset:2048 sc1
  s_mov_b64 exec, -1
  s_add_u32 s67, s67, 1
  s_waitcnt vmcnt(2)
  v_max3_u32 v72, v8, v9, v10
  v_max_u32 v72, v72, v11
  ds_write_b128 v76, v[8:11] offset:6656
  v_cmp_eq_u32 vcc, -1, v72
  s_cbranch_vccz Cf1_h2w
  s_cmp_lt_u32 s67, 131072
  s_cbranch_scc1 Cf1_h2s
  s_branch Cf1_h2w
Cf1_rec:
  s_nop 7
  s_waitcnt vmcnt(0) lgkmcnt(0)
  v_max3_u32 v72, v0, v1, v2
  v_max3_u32 v72, v72, v3, v4
  v_max3_u32 v72, v72, v5, v6
  v_max3_u32 v72, v72, v7, v8
  v_max3_u32 v72, v72, v9, v10
  v_max3_u32 v72, v72, v11, v12
  v_max3_u32 v72, v72, v13, v14
  v_max3_u32 v72, v72, v15, v16
  v_max3_u32 v72, v72, v17, v18
  v_max_u32 v72, v72, v19
  v_cmp_eq_u32 vcc, -1, v72
  s_cbranch_vccz Cf1_recok
  s_barrier
  v_mov_b64 v[20:21], 0
  v_mov_b64 v[22:23], 0
  v_mov_b64 v[24:25], 0
  v_mov_b64 v[26:27], 0
  v_mov_b64 v[28:29], 0
  v_mov_b64 v[30:31], 0
  v_mov_b64 v[32:33], 0
  v_mov_b64 v[34:35], 0
  s_waitcnt lgkmcnt(0)
  s_barrier
  ds_read_b128 v[0:3], v76 offset:4608
  s_waitcnt lgkmcnt(0)
  v_smfmac_f32_16x16x64_bf16 v[20:23], v[0:3], v[80:87], v74
  v_smfmac_f32_16x16x64_bf16 v[24:27], v[0:3], v[88:95], v74
  ds_read_b128 v[60:63], v76 offset:20480
  ds_read_b128 v[64:67], v76 offset:21504
  s_waitcnt lgkmcnt(0)
  v_smfmac_f32_16x16x64_bf16 v[28:31], v[0:3], v[60:67], v74
  ds_read_b128 v[60:63], v76 offset:22528
  ds_read_b128 v[64:67], v76 offset:23552
  s_waitcnt lgkmcnt(0)
  v_smfmac_f32_16x16x64_bf16 v[32:35], v[0:3], v[60:67], v74
  ds_read_b128 v[4:7], v76 offset:5632
  s_waitcnt lgkmcnt(0)
  v_smfmac_f32_16x16x64_bf16 v[20:23], v[4:7], v[96:103], v74
  v_smfmac_f32_16x16x64_bf16 v[24:27], v[4:7], v[104:111], v74
  ds_read_b128 v[60:63], v76 offset:36864
  ds_read_b128 v[64:67], v76 offset:37888
  s_waitcnt lgkmcnt(0)
  v_smfmac_f32_16x16x64_bf16 v[28:31], v[4:7], v[60:67], v74
  ds_read_b128 v[60:63], v76 offset:38912
  ds_read_b128 v[64:67], v76 offset:39936
  s_waitcnt lgkmcnt(0)
  v_smfmac_f32_16x16x64_bf16 v[32:35], v[4:7], v[60:67], v74
  ds_read_b128 v[8:11], v76 offset:6656
  s_waitcnt lgkmcnt(0)
  v_smfmac_f32_16x16x64_bf16 v[20:23], v[8:11], v[112:119], v74
  v_smfmac_f32_16x16x64_bf16 v[24:27], v[8:11], v[120:127], v74
  v_smfmac_f32_16x16x64_bf16 v[28:31], v[8:11], v[208:215], v74
  v_smfmac_f32_16x16x64_bf16 v[32:35], v[8:11], v[216:223], v74
  ds_read_b128 v[12:15], v76 offset:7680
  s_waitcnt lgkmcnt(0)
  v_smfmac_f32_16x16x64_bf16 v[20:23], v[12:15], v[128:135], v74
  v_smfmac_f32_16x16x64_bf16 v[24:27], v[12:15], v[136:143], v74
  v_smfmac_f32_16x16x64_bf16 v[28:31], v[12:15], v[224:231], v74
  v_smfmac_f32_16x16x64_bf16 v[32:35], v[12:15], v[232:239], v74
  ds_read_b128 v[8:11], v76 offset:8704
  s_waitcnt lgkmcnt(0)
  v_smfmac_f32_16x16x64_bf16 v[20:23], v[8:11], v[144:151], v74
  v_smfmac_f32_16x16x64_bf16 v[24:27], v[8:11], v[152:159], v74
  ds_read_b128 v[60:63], v76 offset:53248
  ds_read_b128 v[64:67], v76 offset:54272
  s_waitcnt lgkmcnt(0)
  v_smfmac_f32_16x16x64_bf16 v[28:31], v[8:11], v[60:67], v74
  ds_read_b128 v[60:63], v76 offset:55296
  ds_read_b128 v[64:67], v76 offset:56320
  s_waitcnt lgkmcnt(0)
  v_smfmac_f32_16x16x64_bf16 v[32:35], v[8:11], v[60:67], v74
  ds_read_b128 v[0:3], v76 offset:9728
  s_waitcnt lgkmcnt(0)
  v_smfmac_f32_16x16x64_bf16 v[20:23], v[0:3], v[160:167], v74
  v_smfmac_f32_16x16x64_bf16 v[24:27], v[0:3], v[168:175], v74
  ds_read_b128 v[60:63], v75 offset:20480
  ds_read_b128 v[64:67], v75 offset:21504
  s_waitcnt lgkmcnt(0)
  v_smfmac_f32_16x16x64_bf16 v[28:31], v[0:3], v[60:67], v74
  ds_read_b128 v[60:63], v75 offset:22528
  ds_read_b128 v[64:67], v75 offset:23552
  s_waitcnt lgkmcnt(0)
  v_smfmac_f32_16x16x64_bf16 v[32:35], v[0:3], v[60:67], v74
  ds_read_b128 v[16:19], v76 offset:10752
  ds_read_b128 v[60:63], v75 offset:4096
  ds_read_b128 v[64:67], v75 offset:5120
  s_waitcnt lgkmcnt(0)
  v_smfmac_f32_16x16x64_bf16 v[20:23], v[16:19], v[60:67], v74
  ds_read_b128 v[60:63], v75 offset:6144
  ds_read_b128 v[64:67], v75 offset:7168
  s_waitcnt lgkmcnt(0)
  v_smfmac_f32_16x16x64_bf16 v[24:27], v[16:19], v[60:67], v74
  v_smfmac_f32_16x16x64_bf16 v[28:31], v[16:19], v[240:247], v74
  v_smfmac_f32_16x16x64_bf16 v[32:35], v[16:19], v[248:255], v74
  ds_read_b128 v[4:7], v76 offset:11776
  s_waitcnt lgkmcnt(0)
  v_smfmac_f32_16x16x64_bf16 v[20:23], v[4:7], v[176:183], v74
  v_smfmac_f32_16x16x64_bf16 v[24:27], v[4:7], v[184:191], v74
  v_smfmac_f32_16x16x64_bf16 v[28:31], v[4:7], a[0:7], v74
  v_smfmac_f32_16x16x64_bf16 v[32:35], v[4:7], a[8:15], v74
  ds_read_b128 v[12:15], v76 offset:12800
  s_waitcnt lgkmcnt(0)
  v_smfmac_f32_16x16x64_bf16 v[20:23], v[12:15], v[192:199], v74
  v_smfmac_f32_16x16x64_bf16 v[24:27], v[12:15], v[200:207], v74
  v_smfmac_f32_16x16x64_bf16 v[28:31], v[12:15], a[16:23], v74
  v_smfmac_f32_16x16x64_bf16 v[32:35], v[12:15], a[24:31], v74
  v_add_f32 v20, v20, v22
  v_add_f32 v21, v21, v23
  v_add_f32 v24, v24, v26
  v_cvt_pk_bf16_f32 v22, v20, v24
  ds_write_b32 v79, v22 offset:0
  v_add_f32 v25, v25, v27
  v_cvt_pk_bf16_f32 v23, v21, v25
  ds_write_b32 v79, v23 offset:576
  v_add_f32 v28, v28, v30
  v_add_f32 v29, v29, v31
  s_waitcnt lgkmcnt(0)
  s_nop 1
  s_branch Cf1_recok
Cf1_mx:
  s_waitcnt lgkmcnt(0)
  s_barrier
  buffer_load_dwordx4 v[0:3], v76, s[8:11], s58 offen offset:0 sc1
  ds_read_b128 v[20:23], v77 offset:0
  ds_read_b128 v[28:31], v77 offset:256
  buffer_load_dwordx4 v[4:7], v76, s[8:11], s58 offen offset:1024 sc1
  ds_read_b128 v[24:27], v77 offset:128
  ds_read_b128 v[32:35], v77 offset:384
  s_waitcnt vmcnt(1) lgkmcnt(3)
  v_mfma_f32_16x16x32_bf16 v[8:11], v[0:3], v[20:23], 0
  s_waitcnt vmcnt(0) lgkmcnt(1)
  v_mfma_f32_16x16x32_bf16 v[8:11], v[4:7], v[24:27], v[8:11]
  v_mfma_f32_16x16x32_bf16 v[12:15], v[28:31], v[20:23], 0
  s_waitcnt lgkmcnt(0)
  v_mfma_f32_16x16x32_bf16 v[12:15], v[32:35], v[24:27], v[12:15]
  v_add_f32_dpp v8, v10, v8 quad_perm:[2,3,0,1] row_mask:0xf bank_mask:0xf
  v_add_f32_dpp v9, v11, v9 quad_perm:[2,3,0,1] row_mask:0xf bank_mask:0xf
  s_nop 0
  v_mov_b32_dpp v8, v8 quad_perm:[0,1,0,1] row_mask:0xf bank_mask:0xf
  v_mov_b32_dpp v9, v9 quad_perm:[0,1,0,1] row_mask:0xf bank_mask:0xf
  s_nop 1
  v_add_f32_dpp v12, v14, v12 quad_perm:[2,3,0,1] row_mask:0xf bank_mask:0xf
  v_add_f32_dpp v13, v15, v13 quad_perm:[2,3,0,1] row_mask:0xf bank_mask:0xf
  s_nop 0
  v_mov_b32_dpp v12, v12 quad_perm:[0,1,0,1] row_mask:0xf bank_mask:0xf
  v_mov_b32_dpp v13, v13 quad_perm:[0,1,0,1] row_mask:0xf bank_mask:0xf
  v_mul_f32 v12, s69, v12
  ds_write_b32 v78, v8 offset:8708
  v_mul_f32 v13, s69, v13
  ds_write_b32 v78, v9 offset:8772
  s_waitcnt lgkmcnt(0)
  s_barrier
  ds_read_b128 v[36:39], v78 offset:8704
  ds_read_b128 v[40:43], v78 offset:8768
  s_waitcnt lgkmcnt(0)
  s_barrier
  v_max_f32 v16, v36, v37
  v_max3_f32 v16, v16, v38, v39
  v_max3_f32 v16, v16, v40, v41
  v_max3_f32 v16, v16, v42, v43
  v_max3_f32 v16, v16, v12, v13
  v_mov_b32 v17, v16
  s_nop 1
  v_permlane16_swap_b32 v16, v17
  v_max_f32 v16, v16, v17
  v_mov_b32 v17, v16
  s_nop 1
  v_permlane32_swap_b32 v16, v17
  v_max_f32 v16, v16, v17
  v_sub_f32 v36, v36, v16
  v_sub_f32 v37, v37, v16
  v_sub_f32 v38, v38, v16
  v_sub_f32 v39, v39, v16
  v_sub_f32 v40, v40, v16
  v_sub_f32 v41, v41, v16
  v_sub_f32 v42, v42, v16
  v_sub_f32 v43, v43, v16
  v_sub_f32 v12, v12, v16
  v_sub_f32 v13, v13, v16
  v_exp_f32 v36, v36
  v_exp_f32 v37, v37
  v_exp_f32 v38, v38
  v_exp_f32 v39, v39
  v_exp_f32 v40, v40
  v_exp_f32 v41, v41
  v_exp_f32 v42, v42
  v_exp_f32 v43, v43
  v_exp_f32 v12, v12
  v_exp_f32 v13, v13
  v_cvt_pk_bf16_f32 v32, v36, v40
  v_cvt_pk_bf16_f32 v33, v37, v41
  v_cvt_pk_bf16_f32 v34, v38, v42
  v_cvt_pk_bf16_f32 v35, v39, v43
  v_cvt_pk_bf16_f32 v28, v12, v13
  v_cvt_pk_bf16_f32 v31, v12, v13
  v_mov_b32 v29, 0
  v_mov_b32 v30, 0
  v_mov_b32 v68, 0x3f803f80
  v_mov_b32 v69, 0x3f803f80
  v_mov_b32 v70, 0x3f803f80
  v_mov_b32 v71, 0x3f803f80
  s_nop 1
  v_mfma_f32_16x16x32_bf16 v[8:11], v[32:35], v[68:71], 0
  v_mfma_f32_16x16x32_bf16 v[0:3], v[32:35], v[52:55], 0
  v_mfma_f32_16x16x32_bf16 v[4:7], v[32:35], v[56:59], 0
  v_mfma_f32_16x16x16_bf16 v[8:11], v[28:29], v[68:69], v[8:11]
  v_mfma_f32_16x16x16_bf16 v[0:3], v[28:29], v[72:73], v[0:3]
  v_mfma_f32_16x16x16_bf16 v[4:7], v[30:31], v[72:73], v[4:7]
  ds_read_b128 v[68:71], v76 offset:13824
  v_rcp_f32 v10, v8
  v_rcp_f32 v11, v9
  v_mul_f32 v0, v10, v0
  v_mul_f32 v1, v11, v1
  s_nop 0
  v_mul_f32 v4, v10, v4
  v_mul_f32 v5, v11, v5
  v_cvt_pk_bf16_f32 v2, v0, v4
  ds_write_b32 v79, v2 offset:8704
  v_cvt_pk_bf16_f32 v3, v1, v5
  ds_write_b32 v79, v3 offset:9280
  v_mov_b64 v[16:17], 0
  v_mov_b64 v[18:19], 0
  v_mov_b64 v[20:21], 0
  v_mov_b64 v[22:23], 0
  v_mov_b64 v[24:25], 0
  v_mov_b64 v[26:27], 0
  s_branch Cf1_mxok
Cf1_last:
  ds_read_b128 v[4:7], v76 offset:5632
  ds_read_b128 v[12:15], v76 offset:7680
  ds_read_b128 v[44:47], v76 offset:36864
  ds_read_b128 v[48:51], v76 offset:37888
  s_nop 5
  v_mov_b64 v[20:21], 0
  v_mov_b64 v[22:23], 0
  v_mov_b64 v[24:25], 0
  v_mov_b64 v[26:27], 0
  s_waitcnt lgkmcnt(4)
  v_smfmac_f32_16x16x64_bf16 v[28:31], v[0:3], v[36:43], v74
  ds_read_b128 v[36:39], v76 offset:38912
  ds_read_b128 v[40:43], v76 offset:39936
  v_smfmac_f32_16x16x64_bf16 v[32:35], v[0:3], v[60:67], v74
  s_waitcnt lgkmcnt(5)
  v_smfmac_f32_16x16x64_bf16 v[20:23], v[0:3], a[32:39], v74
  ds_read_b128 v[60:63], v76 offset:53248
  ds_read_b128 v[64:67], v76 offset:54272
  v_smfmac_f32_16x16x64_bf16 v[24:27], v[0:3], a[40:47], v74
  s_waitcnt lgkmcnt(4)
  v_smfmac_f32_16x16x64_bf16 v[20:23], v[4:7], a[48:55], v74
  buffer_store_dwordx4 v[16:19], v76, s[8:11], s68 offen sc1
  v_smfmac_f32_16x16x64_bf16 v[24:27], v[4:7], a[56:63], v74
  v_smfmac_f32_16x16x64_bf16 v[28:31], v[4:7], v[44:51], v74
  s_waitcnt lgkmcnt(2)
  v_smfmac_f32_16x16x64_bf16 v[20:23], v[8:11], a[64:71], v74
  ds_read_b128 v[44:47], v76 offset:55296
  ds_read_b128 v[48:51], v76 offset:56320
  v_smfmac_f32_16x16x64_bf16 v[24:27], v[8:11], a[72:79], v74
  v_smfmac_f32_16x16x64_bf16 v[32:35], v[4:7], v[36:43], v74
  v_smfmac_f32_16x16x64_bf16 v[28:31], v[8:11], v[208:215], v74
  ds_read_b128 v[36:39], v75 offset:20480
  ds_read_b128 v[40:43], v75 offset:21504
  v_smfmac_f32_16x16x64_bf16 v[32:35], v[8:11], v[216:223], v74
  v_smfmac_f32_16x16x64_bf16 v[20:23], v[12:15], a[80:87], v74
  v_smfmac_f32_16x16x64_bf16 v[24:27], v[12:15], a[88:95], v74
  v_smfmac_f32_16x16x64_bf16 v[28:31], v[12:15], v[224:231], v74
  v_smfmac_f32_16x16x64_bf16 v[32:35], v[12:15], v[232:239], v74
  s_waitcnt vmcnt(2)
  s_waitcnt vmcnt(1)
  s_barrier
Cf1_lastr:
  ds_read_b128 v[8:11], v76 offset:8704
  ds_read_b128 v[0:3], v76 offset:9728
  ds_read_b128 v[16:19], v76 offset:10752
  ds_read_b128 v[4:7], v76 offset:11776
  ds_read_b128 v[12:15], v76 offset:12800
  s_waitcnt lgkmcnt(3)
  v_max3_u32 v72, v0, v1, v2
  s_waitcnt lgkmcnt(1)
  v_max3_u32 v72, v72, v3, v4
  v_max3_u32 v72, v72, v5, v6
  v_max3_u32 v72, v72, v7, v8
  v_max3_u32 v72, v72, v9, v10
  s_waitcnt lgkmcnt(0)
  v_max3_u32 v72, v72, v11, v12
  v_max3_u32 v72, v72, v13, v14
  v_max3_u32 v72, v72, v15, v16
  v_max3_u32 v72, v72, v17, v18
  v_max_u32 v72, v72, v19
  v_cmp_eq_u32 vcc, -1, v72
  s_cbranch_vccnz Cf1_lastp
Cf1_lastg:
  v_smfmac_f32_16x16x64_bf16 v[28:31], v[8:11], v[60:67], v74
  ds_read_b128 v[60:63], v75 offset:22528
  ds_read_b128 v[64:67], v75 offset:23552
  v_smfmac_f32_16x16x64_bf16 v[32:35], v[8:11], v[44:51], v74
  v_smfmac_f32_16x16x64_bf16 v[28:31], v[0:3], v[36:43], v74
  v_smfmac_f32_16x16x64_bf16 v[28:31], v[16:19], v[240:247], v74
  v_smfmac_f32_16x16x64_bf16 v[28:31], v[4:7], a[0:7], v74
  v_smfmac_f32_16x16x64_bf16 v[28:31], v[12:15], a[16:23], v74
  v_smfmac_f32_16x16x64_bf16 v[32:35], v[16:19], v[248:255], v74
  v_smfmac_f32_16x16x64_bf16 v[32:35], v[4:7], a[8:15], v74
  s_waitcnt lgkmcnt(0)
  v_smfmac_f32_16x16x64_bf16 v[32:35], v[12:15], a[24:31], v74
  v_smfmac_f32_16x16x64_bf16 v[32:35], v[0:3], v[60:67], v74
  v_smfmac_f32_16x16x64_bf16 v[20:23], v[8:11], a[96:103], v74
  v_smfmac_f32_16x16x64_bf16 v[20:23], v[0:3], a[112:119], v74
  v_add_f32 v28, v28, v30
  v_add_f32 v32, v32, v34
  v_cvt_pk_bf16_f32 v30, v28, v32
  v_smfmac_f32_16x16x64_bf16 v[20:23], v[16:19], a[128:135], v74
  ds_write_b32 v79, v30 offset:256
  v_add_f32 v29, v29, v31
  v_add_f32 v33, v33, v35
  v_cvt_pk_bf16_f32 v31, v29, v33
  v_smfmac_f32_16x16x64_bf16 v[20:23], v[4:7], a[144:151], v74
  ds_write_b32 v79, v31 offset:832
  v_smfmac_f32_16x16x64_bf16 v[20:23], v[12:15], a[160:167], v74
  v_smfmac_f32_16x16x64_bf16 v[24:27], v[8:11], a[104:111], v74
  v_smfmac_f32_16x16x64_bf16 v[24:27], v[0:3], a[120:127], v74
  v_smfmac_f32_16x16x64_bf16 v[24:27], v[16:19], a[136:143], v74
  s_waitcnt lgkmcnt(0)
  s_barrier
  ds_read_b64 v[52:53], v77 offset:264
  v_add_f32 v20, v20, v22
  v_smfmac_f32_16x16x64_bf16 v[24:27], v[4:7], a[152:159], v74
  v_add_f32 v21, v21, v23
  v_smfmac_f32_16x16x64_bf16 v[24:27], v[12:15], a[168:175], v74
  v_cvt_pk_bf16_f32 v54, v20, v21
  s_add_u32 s68, s68, 655360
  s_nop 3
  v_add_f32 v24, v24, v26
  v_add_f32 v25, v25, v27
  v_cvt_pk_bf16_f32 v55, v24, v25
  s_waitcnt lgkmcnt(0)
  buffer_store_dwordx4 v[52:55], v76, s[8:11], s68 offen sc1
  s_branch Cf1_done
Cf1_lastp:
  s_add_u32 s72, s72, 2
  s_cmp_ge_u32 s72, 131072
  s_cbranch_scc1 Cf1_lastg
  s_barrier
  buffer_load_dwordx4 v76, s[8:11], s55 offen offset:0 sc1 lds
  s_waitcnt vmcnt(0)
  s_barrier
  s_branch Cf1_lastr
Cf1_done:
  s_branch L_cexit
L_w2:
  v_mov_b64 v[20:21], 0
  v_mov_b64 v[22:23], 0
  v_mov_b64 v[24:25], 0
  v_mov_b64 v[26:27], 0
  v_mov_b64 v[28:29], 0
  v_mov_b64 v[30:31], 0
  v_mov_b64 v[32:33], 0
  v_mov_b64 v[34:35], 0
  s_mov_b32 s78, 0x3f803f80
  s_mov_b32 s79, s78
  s_mov_b32 s65, 360448
  s_mov_b32 m0, 15872
  s_lshl_b32 s71, s53, 2
  s_add_u32 s71, s71, 128
  s_movk_i32 s56, 0x1000
  v_lshlrev_b32 v73, 2, v76
  v_mov_b32 v72, 0
  s_mov_b64 s[16:17], s[8:9]
  s_mov_b32 s18, 268435456
  s_mov_b32 s19, 0x20000
  s_getpc_b64 s[20:21]
Cf2_pc:
  s_add_u32 s20, s20, (Cf2_last - Cf2_pc)
  s_addc_u32 s21, s21, 0
  v_mov_b32 v68, 14880
  buffer_load_dwordx4 v[52:55], v76, s[8:11], s59 offen offset:0 sc1
  buffer_load_dwordx4 v[56:59], v76, s[8:11], s59 offen offset:1024 sc1
  ds_read_b128 v[36:39], v76 offset:24576
  ds_read_b128 v[40:43], v76 offset:25600
  ds_read_b128 v[60:63], v76 offset:26624
  ds_read_b128 v[64:67], v76 offset:27648
  ds_read_b128 v[0:3], v76 offset:4608
  ds_read_b128 v[4:7], v76 offset:5632
  ds_read_b128 v[8:11], v76 offset:6656
  ds_read_b128 v[12:15], v76 offset:7680
  s_waitcnt lgkmcnt(0)
  s_cmp_eq_u32 s66, 1
  s_branch Cf2_top2
.p2align 6
Cf2_h2:
  v_lshlrev_b32 v73, 2, v76
  s_mov_b32 m0, 12800
  s_add_u32 s55, s65, 8192
  s_nop 3
  buffer_load_dwordx4 v[12:15], v76, s[8:11], s65 offen offset:3072 sc1
  s_nop 15
  s_nop 3
  buffer_load_dwordx4 v[12:15], v76, s[8:11], s65 offen offset:3072 sc1
  s_nop 15
  s_nop 3
  buffer_load_dwordx4 v[12:15], v76, s[8:11], s65 offen offset:3072 sc1
  s_waitcnt vmcnt(5)
  ds_read_b128 v[36:39], v76 offset:24576
  ds_read_b128 v[40:43], v76 offset:25600
  ds_read_b128 v[60:63], v76 offset:26624
  ds_read_b128 v[64:67], v76 offset:27648
  buffer_load_dwordx4 v[52:55], v76, s[8:11], s59 offen offset:0 sc1
  buffer_load_dwordx4 v[56:59], v76, s[8:11], s59 offen offset:1024 sc1
  s_waitcnt vmcnt(4)
  v_max3_u32 v72, v12, v13, v14
  v_max_u32 v72, v72, v15
  ds_write_b128 v76, v[12:15] offset:7680
  v_cmp_eq_u32 vcc, -1, v72
  s_cbranch_vccnz Cf2_h2r
Cf2_h2w:
  s_cmp_eq_u32 s66, 63
  s_waitcnt lgkmcnt(0)
  s_barrier
  ds_read_b128 v[0:3], v76 offset:4608
  buffer_load_dwordx4 v76, s[8:11], s55 offen offset:0 sc1 lds
Cf2_top2:
  v_smfmac_f32_16x16x64_bf16 v[20:23], v[12:15], v[128:135], v74
  s_cbranch_scc1 Cf2_last
  v_smfmac_f32_16x16x64_bf16 v[24:27], v[12:15], v[136:143], v74
  buffer_load_dwordx4 v[44:47], v76, s[8:11], s58 offen offset:0 sc1
  s_mov_b32 m0, 15872
  v_smfmac_f32_16x16x64_bf16 v[28:31], v[12:15], v[224:231], v74
  buffer_load_dwordx4 v[48:51], v76, s[8:11], s58 offen offset:1024 sc1
  v_smfmac_f32_16x16x64_bf16 v[32:35], v[12:15], v[232:239], v74
  ds_read_b128 v[4:7], v76 offset:5632
  s_waitcnt lgkmcnt(1)
  v_smfmac_f32_16x16x64_bf16 v[20:23], v[0:3], v[80:87], v74
  ds_read_b128 v[8:11], v76 offset:6656
  v_smfmac_f32_16x16x64_bf16 v[28:31], v[0:3], v[36:43], v74
  ds_read_b128 v[36:39], v76 offset:40960
  v_smfmac_f32_16x16x64_bf16 v[24:27], v[0:3], v[88:95], v74
  buffer_store_dwordx4 v[16:19], v76, s[8:11], s68 offen sc1
  ds_read_b128 v[40:43], v76 offset:41984
  v_smfmac_f32_16x16x64_bf16 v[32:35], v[0:3], v[60:67], v74
  ds_read_b128 v[60:63], v76 offset:43008
  s_waitcnt lgkmcnt(4)
  v_smfmac_f32_16x16x64_bf16 v[20:23], v[4:7], v[96:103], v74
  ds_read_b128 v[64:67], v76 offset:44032
  v_smfmac_f32_16x16x64_bf16 v[24:27], v[4:7], v[104:111], v74
  buffer_load_dword v73, s[16:19], s70 offen lds
  s_waitcnt vmcnt(5)
  s_waitcnt lgkmcnt(4)
  v_smfmac_f32_16x16x64_bf16 v[20:23], v[8:11], v[112:119], v74
  s_barrier
  s_waitcnt lgkmcnt(2)
  v_smfmac_f32_16x16x64_bf16 v[28:31], v[4:7], v[36:43], v74
  ds_read_b128 v[12:15], v76 offset:8704
  v_smfmac_f32_16x16x64_bf16 v[24:27], v[8:11], v[120:127], v74
  ds_read_b128 v[36:39], v76 offset:57344
  s_waitcnt lgkmcnt(2)
  v_smfmac_f32_16x16x64_bf16 v[32:35], v[4:7], v[60:67], v74
  ds_read_b128 v[40:43], v76 offset:58368
  v_smfmac_f32_16x16x64_bf16 v[28:31], v[8:11], v[208:215], v74
  ds_read_b128 v[60:63], v76 offset:59392
  v_smfmac_f32_16x16x64_bf16 v[32:35], v[8:11], v[216:223], v74
  ds_read_b128 v[64:67], v76 offset:60416
  s_waitcnt lgkmcnt(4)
  v_smfmac_f32_16x16x64_bf16 v[20:23], v[12:15], v[144:151], v74
  s_waitcnt vmcnt(4)
  ds_read_b128 v[0:3], v76 offset:9728
  s_waitcnt lgkmcnt(3)
  v_smfmac_f32_16x16x64_bf16 v[28:31], v[12:15], v[36:43], v74
  s_barrier
  ds_read_b128 v[4:7], v76 offset:11776
  v_smfmac_f32_16x16x64_bf16 v[24:27], v[12:15], v[152:159], v74
  ds_read_b128 v[36:39], v75 offset:8192
  ds_read_b128 v[40:43], v75 offset:9216
  s_waitcnt lgkmcnt(4)
  v_smfmac_f32_16x16x64_bf16 v[32:35], v[12:15], v[60:67], v74
  ds_read_b128 v[16:19], v76 offset:10752
  s_waitcnt lgkmcnt(4)
  v_smfmac_f32_16x16x64_bf16 v[20:23], v[0:3], v[160:167], v74
  ds_read_b128 v[8:11], v76 offset:12800
  v_smfmac_f32_16x16x64_bf16 v[24:27], v[0:3], v[168:175], v74
  ds_read_b128 v[60:63], v75 offset:10240
  ds_read_b128 v[64:67], v75 offset:11264
  s_waitcnt lgkmcnt(6)
  v_smfmac_f32_16x16x64_bf16 v[20:23], v[4:7], v[176:183], v74
  s_waitcnt lgkmcnt(3)
  v_smfmac_f32_16x16x64_bf16 v[20:23], v[16:19], v[36:43], v74
  ds_read_b128 v[36:39], v75 offset:24576
  s_waitcnt lgkmcnt(3)
  v_smfmac_f32_16x16x64_bf16 v[20:23], v[8:11], v[192:199], v74
  ds_read_b128 v[40:43], v75 offset:25600
  s_waitcnt lgkmcnt(2)
  v_smfmac_f32_16x16x64_bf16 v[24:27], v[16:19], v[60:67], v74
  ds_read_b128 v[60:63], v75 offset:26624
  v_smfmac_f32_16x16x64_bf16 v[24:27], v[4:7], v[184:191], v74
  ds_read_b128 v[64:67], v75 offset:27648
  v_add_f32 v20, v20, v22
  v_smfmac_f32_16x16x64_bf16 v[24:27], v[8:11], v[200:207], v74
  v_add_f32 v21, v21, v23
  v_smfmac_f32_16x16x64_bf16 v[28:31], v[16:19], v[240:247], v74
  s_waitcnt lgkmcnt(2)
  v_mov_b64 v[70:71], s[78:79]
  v_smfmac_f32_16x16x64_bf16 v[28:31], v[0:3], v[36:43], v74
  ds_read_b128 v[36:39], v68
  v_add_f32 v24, v24, v26
  v_smfmac_f32_16x16x64_bf16 v[28:31], v[4:7], a[0:7], v74
  ds_read_b128 v[40:43], v68
  v_cvt_pk_bf16_f32 v22, v20, v24
  v_smfmac_f32_16x16x64_bf16 v[28:31], v[8:11], a[16:23], v74
  ds_write_b32 v79, v22 offset:0
  s_waitcnt lgkmcnt(3)
  v_add_f32 v25, v25, v27
  v_cvt_pk_bf16_f32 v23, v21, v25
  v_smfmac_f32_16x16x64_bf16 v[32:35], v[0:3], v[60:67], v74
  ds_write_b32 v79, v23 offset:576
  v_cmp_u_f32 vcc, v20, v21
  v_smfmac_f32_16x16x64_bf16 v[32:35], v[16:19], v[248:255], v74
  v_add_f32 v28, v28, v30
  v_smfmac_f32_16x16x64_bf16 v[32:35], v[4:7], a[8:15], v74
  v_add_f32 v29, v29, v31
  v_smfmac_f32_16x16x64_bf16 v[32:35], v[8:11], a[24:31], v74
  s_cbranch_vccnz Cf2_rec
Cf2_recok:
  s_waitcnt lgkmcnt(3)
  v_smfmac_f32_16x16x64_bf16 v[36:39], v[16:19], a[128:135], v74
  s_waitcnt lgkmcnt(0)
  s_barrier
  ds_read_b128 v[60:63], v77
  v_smfmac_f32_16x16x64_bf16 v[40:43], v[16:19], a[136:143], v74
  ds_read_b128 v[64:67], v77 offset:128
  v_add_f32 v32, v32, v34
  v_cvt_pk_bf16_f32 v30, v28, v32
  v_smfmac_f32_16x16x64_bf16 v[36:39], v[0:3], a[112:119], v74
  ds_write_b32 v79, v30 offset:256
  v_add_f32 v33, v33, v35
  v_cvt_pk_bf16_f32 v31, v29, v33
  v_smfmac_f32_16x16x64_bf16 v[40:43], v[0:3], a[120:127], v74
  ds_write_b32 v79, v31 offset:832
  v_xor_b32 v75, 0x8000, v75
  v_smfmac_f32_16x16x64_bf16 v[36:39], v[4:7], a[144:151], v74
  ds_read_b128 v[0:3], v76 offset:4608
  v_mov_b32 v29, 0
  v_smfmac_f32_16x16x64_bf16 v[40:43], v[4:7], a[152:159], v74
  s_waitcnt vmcnt(2) lgkmcnt(3)
  v_mov_b32 v30, 0
  v_mfma_f32_16x16x32_bf16 v[44:47], v[44:47], v[60:63], 0
  ds_read_b128 v[4:7], v76 offset:5632
  s_waitcnt lgkmcnt(2)
  v_mfma_f32_16x16x32_bf16 v[44:47], v[48:51], v[64:67], v[44:47]
  s_barrier
  v_smfmac_f32_16x16x64_bf16 v[36:39], v[8:11], a[160:167], v74
  ds_read_b128 v[20:23], v77 offset:256
  ds_read_b128 v[24:27], v77 offset:384
  v_smfmac_f32_16x16x64_bf16 v[40:43], v[8:11], a[168:175], v74
  ds_read_b128 v[8:11], v76 offset:6656
  v_add_f32_dpp v72, v46, v44 quad_perm:[2,3,0,1] row_mask:0xf bank_mask:0xf
  v_add_f32_dpp v73, v47, v45 quad_perm:[2,3,0,1] row_mask:0xf bank_mask:0xf
  v_smfmac_f32_16x16x64_bf16 v[36:39], v[12:15], a[96:103], v74
  s_waitcnt lgkmcnt(4)
  v_exp_f32_dpp v72, v72 quad_perm:[0,1,0,1] row_mask:0xf bank_mask:0xf
  v_smfmac_f32_16x16x64_bf16 v[40:43], v[12:15], a[104:111], v74
  ds_read_b128 v[12:15], v76 offset:7680
  v_exp_f32_dpp v73, v73 quad_perm:[0,1,0,1] row_mask:0xf bank_mask:0xf
  v_smfmac_f32_16x16x64_bf16 v[36:39], v[0:3], a[32:39], v74
  s_waitcnt lgkmcnt(2)
  v_cvt_pk_bf16_f32 v72, v72, v73
  v_mfma_f32_16x16x32_bf16 v[20:23], v[20:23], v[60:63], 0
  ds_write_b32 v78, v72 offset:520
  v_mov_b64 v[16:17], 0
  v_mfma_f32_16x16x32_bf16 v[20:23], v[24:27], v[64:67], v[20:23]
  ds_read_b128 v[44:47], v75 offset:24576
  v_mov_b64 v[18:19], 0
  v_smfmac_f32_16x16x64_bf16 v[40:43], v[0:3], a[40:47], v74
  ds_read_b128 v[48:51], v75 offset:25600
  v_mov_b64 v[68:69], s[78:79]
  v_smfmac_f32_16x16x64_bf16 v[36:39], v[4:7], a[48:55], v74
  s_waitcnt lgkmcnt(4)
  v_add_f32_dpp v24, v22, v20 quad_perm:[2,3,0,1] row_mask:0xf bank_mask:0xf
  v_add_f32_dpp v25, v23, v21 quad_perm:[2,3,0,1] row_mask:0xf bank_mask:0xf
  v_smfmac_f32_16x16x64_bf16 v[36:39], v[8:11], a[64:71], v74
  s_waitcnt lgkmcnt(2)
  s_barrier
  ds_read_b128 v[32:35], v78 offset:512
  v_smfmac_f32_16x16x64_bf16 v[36:39], v[12:15], a[80:87], v74
  ds_read_b128 v[60:63], v75 offset:26624
  v_mul_f32 v24, s69, v24
  v_smfmac_f32_16x16x64_bf16 v[40:43], v[4:7], a[56:63], v74
  ds_read_b128 v[64:67], v75 offset:27648
  v_mul_f32 v25, s69, v25
  v_smfmac_f32_16x16x64_bf16 v[40:43], v[8:11], a[72:79], v74
  v_exp_f32_dpp v24, v24 quad_perm:[0,1,0,1] row_mask:0xf bank_mask:0xf
  v_smfmac_f32_16x16x64_bf16 v[40:43], v[12:15], a[88:95], v74
  s_waitcnt lgkmcnt(2)
  v_exp_f32_dpp v25, v25 quad_perm:[0,1,0,1] row_mask:0xf bank_mask:0xf
  v_mfma_f32_16x16x32_bf16 v[8:11], v[32:35], v[68:71], 0
  v_add_f32 v36, v36, v38
  v_add_f32 v37, v37, v39
  v_mfma_f32_16x16x32_bf16 v[0:3], v[32:35], v[52:55], 0
  v_add_f32 v40, v40, v42
  v_add_f32 v41, v41, v43
  v_mfma_f32_16x16x32_bf16 v[4:7], v[32:35], v[56:59], 0
  v_cvt_pk_bf16_f32 v28, v24, v25
  v_cvt_pk_bf16_f32 v72, v36, v37
  v_cvt_pk_bf16_f32 v73, v40, v41
  v_mfma_f32_16x16x16_bf16 v[8:11], v[28:29], v[68:69], v[8:11]
  v_cvt_pk_bf16_f32 v31, v24, v25
  v_mov_b64 v[20:21], 0
  v_mfma_f32_16x16x16_bf16 v[0:3], v[28:29], v[72:73], v[0:3]
  ds_read_b128 v[68:71], v76 offset:13824
  v_mov_b64 v[22:23], 0
  v_mfma_f32_16x16x16_bf16 v[4:7], v[30:31], v[72:73], v[4:7]
  v_rcp_f32 v10, v8
  v_rcp_f32 v11, v9
  v_mul_f32 v0, v10, v0
  v_mul_f32 v1, v11, v1
  s_nop 0
  v_mul_f32 v4, v10, v4
  v_mul_f32 v5, v11, v5
  v_cvt_pk_bf16_f32 v2, v0, v4
  ds_write_b32 v79, v2 offset:8704
  v_cvt_pk_bf16_f32 v3, v1, v5
  ds_write_b32 v79, v3 offset:9280
  v_max3_f32 v8, v8, v9, v10
  v_max_f32 v8, v8, v11
  v_cmp_le_f32 vcc, 1317011456, v8
  v_mov_b64 v[24:25], 0
  v_mov_b64 v[26:27], 0
  s_cbranch_vccnz Cf2_mx
Cf2_mxok:
  s_waitcnt lgkmcnt(0)
  s_barrier
  ds_read_b128 v[0:3], v78 offset:8704
  ds_read_b128 v[4:7], v78 offset:8768
  ds_read_b128 v[8:11], v78 offset:8832
  ds_read_b128 v[12:15], v78 offset:8896
  s_waitcnt lgkmcnt(3)
  v_smfmac_f32_16x16x64_bf16 v[16:19], v[0:3], v[44:51], v74
  ds_read_b128 v[52:55], v75 offset:40960
  s_waitcnt lgkmcnt(3)
  v_smfmac_f32_16x16x64_bf16 v[16:19], v[4:7], v[60:67], v74
  ds_read_b128 v[56:59], v75 offset:41984
  s_waitcnt lgkmcnt(3)
  v_smfmac_f32_16x16x64_bf16 v[16:19], v[8:11], a[176:183], v74
  ds_read_b128 v[36:39], v75 offset:43008
  s_waitcnt lgkmcnt(3)
  v_smfmac_f32_16x16x64_bf16 v[16:19], v[12:15], a[184:191], v74
  ds_read_b128 v[40:43], v75 offset:44032
  ds_read_b128 v[44:47], v75 offset:57344
  v_smfmac_f32_16x16x64_bf16 v[20:23], v[0:3], a[192:199], v74
  ds_read_b128 v[48:51], v75 offset:58368
  ds_read_b128 v[60:63], v75 offset:59392
  v_smfmac_f32_16x16x64_bf16 v[20:23], v[4:7], a[200:207], v74
  ds_read_b128 v[64:67], v75 offset:60416
  s_waitcnt lgkmcnt(6)
  v_cvt_pk_bf16_f32 v16, v16, v17
  v_cvt_pk_bf16_f32 v17, v18, v19
  v_bfi_b32 v16, 1, s72, v16
  v_smfmac_f32_16x16x64_bf16 v[20:23], v[8:11], v[52:59], v74
  buffer_store_dwordx2 v[16:17], v68, s[8:11], s73 offen
  s_waitcnt lgkmcnt(4)
  v_smfmac_f32_16x16x64_bf16 v[20:23], v[12:15], v[36:43], v74
  ds_read_b128 v[52:55], v75 offset:0
  v_mov_b64 v[32:33], 0
  v_smfmac_f32_16x16x64_bf16 v[24:27], v[0:3], a[208:215], v74
  ds_read_b128 v[56:59], v75 offset:1024
  v_mov_b64 v[34:35], 0
  v_smfmac_f32_16x16x64_bf16 v[24:27], v[4:7], a[216:223], v74
  ds_read_b128 v[36:39], v75 offset:2048
  s_waitcnt lgkmcnt(5)
  v_cvt_pk_bf16_f32 v20, v20, v21
  v_cvt_pk_bf16_f32 v21, v22, v23
  v_bfi_b32 v20, 1, s72, v20
  v_smfmac_f32_16x16x64_bf16 v[24:27], v[8:11], v[44:51], v74
  buffer_store_dwordx2 v[20:21], v68, s[8:11], s74 offen
  s_waitcnt lgkmcnt(3)
  v_smfmac_f32_16x16x64_bf16 v[24:27], v[12:15], v[60:67], v74
  ds_read_b128 v[40:43], v75 offset:3072
  v_mov_b64 v[28:29], 0
  v_smfmac_f32_16x16x64_bf16 v[32:35], v[0:3], a[224:231], v74
  ds_read_b128 v[44:47], v75 offset:4096
  ds_read_b128 v[48:51], v75 offset:5120
  v_smfmac_f32_16x16x64_bf16 v[32:35], v[4:7], a[232:239], v74
  ds_read_b128 v[60:63], v75 offset:6144
  v_cvt_pk_bf16_f32 v24, v24, v25
  v_cvt_pk_bf16_f32 v25, v26, v27
  v_bfi_b32 v24, 1, s72, v24
  v_smfmac_f32_16x16x64_bf16 v[32:35], v[8:11], a[240:247], v74
  buffer_store_dwordx2 v[24:25], v68, s[8:11], s75 offen
  v_mov_b64 v[30:31], 0
  v_smfmac_f32_16x16x64_bf16 v[32:35], v[12:15], a[248:255], v74
  ds_read_b128 v[64:67], v75 offset:7168
  s_waitcnt lgkmcnt(6)
  v_smfmac_f32_16x16x64_bf16 v[28:31], v[0:3], v[52:59], v74
  s_waitcnt lgkmcnt(4)
  v_smfmac_f32_16x16x64_bf16 v[28:31], v[4:7], v[36:43], v74
  s_waitcnt lgkmcnt(2)
  v_cvt_pk_bf16_f32 v32, v32, v33
  v_cvt_pk_bf16_f32 v33, v34, v35
  v_bfi_b32 v32, 1, s72, v32
  v_smfmac_f32_16x16x64_bf16 v[28:31], v[8:11], v[44:51], v74
  buffer_store_dwordx2 v[32:33], v68, s[8:11], s76 offen
  s_waitcnt lgkmcnt(0)
  v_smfmac_f32_16x16x64_bf16 v[28:31], v[12:15], v[60:67], v74
  ds_read_b128 v[0:3], v76 offset:14848
  ds_read_b64 v[16:17], v77 offset:384
  v_mov_b64 v[18:19], v[72:73]
  v_xor_b32 v75, 0x8000, v75
  s_nop 3
  v_cvt_pk_bf16_f32 v28, v28, v29
  v_cvt_pk_bf16_f32 v29, v30, v31
  v_bfi_b32 v28, 1, s72, v28
  buffer_store_dwordx2 v[28:29], v68, s[8:11], s77 offen
  v_mov_b64 v[20:21], 0
  v_mov_b64 v[22:23], 0
  v_mov_b64 v[24:25], 0
  v_mov_b64 v[26:27], 0
  v_mov_b64 v[28:29], 0
  v_mov_b64 v[30:31], 0
  v_mov_b64 v[32:33], 0
  v_mov_b64 v[34:35], 0
  v_mov_b32 v68, 14880
  s_add_u32 s58, s58, 655360
  s_add_u32 s59, s59, 655360
  s_add_u32 s70, s70, 655360
  s_add_u32 s68, s68, 655360
  s_add_u32 s66, s66, 1
  s_xor_b32 s64, s64, 16384
  s_xor_b32 s65, s65, 16384
  s_cmp_eq_u32 s66, 62
  s_cselect_b64 s[16:17], s[20:21], s[16:17]
  s_cselect_b32 s18, (Cf2_done - Cf2_last), s18
  s_cselect_b32 s70, 0, s70
  s_cmp_eq_u32 s66, 63
  s_cselect_b32 s59, 268435456, s59
  s_cselect_b32 s58, 268435456, s58
  s_nop 15
  s_nop 11
  buffer_load_dwordx4 v[52:55], v76, s[8:11], s60 offen offset:0 sc1
  buffer_load_dwordx4 v[56:59], v76, s[8:11], s60 offen offset:1024 sc1
  s_waitcnt lgkmcnt(0)
  s_waitcnt vmcnt(1)
  v_mfma_f32_16x16x32_bf16 v[4:7], v[0:3], v[52:55], 0
  v_bitop3_b32 v72, v52, v54, s72 bitop3:0x7e
  s_waitcnt vmcnt(0)
  v_mfma_f32_16x16x32_bf16 v[4:7], v[0:3], v[56:59], v[4:7]
  v_bitop3_b32 v73, v56, v58, s72 bitop3:0x7e
  v_bitop3_b32 v72, v72, v73, 1 bitop3:0xa8
  v_cmp_ne_u32 vcc, 0, v72
  s_nop 0
  s_cmp_eq_u64 vcc, 0
  s_cselect_b32 s54, s62, 268435456
  s_nop 0
  v_add_f32_dpp v4, v4, v4 row_ror:4 row_mask:0xf bank_mask:0xf
  v_add_f32_dpp v5, v5, v5 row_ror:4 row_mask:0xf bank_mask:0xf
  s_nop 0
  v_add_f32_dpp v4, v4, v4 row_ror:8 row_mask:0xf bank_mask:0xf
  v_add_f32_dpp v5, v5, v5 row_ror:8 row_mask:0xf bank_mask:0xf
  v_cvt_pk_bf16_f32 v4, v4, v5
  buffer_store_dword v4, v69, s[8:11], s54 offen
  s_cbranch_vccnz Cf2_h1r
  s_xor_b32 s62, s62, 16384
  buffer_store_dword v71, v69, s[8:11], s62 offen
  s_xor_b32 s72, s72, 1
  s_branch Cf2_h2
Cf2_h1r:
  s_mov_b64 exec, vcc
  buffer_load_dwordx4 v[52:55], v76, s[8:11], s60 offen offset:0 sc1
  buffer_load_dwordx4 v[56:59], v76, s[8:11], s60 offen offset:1024 sc1
  s_mov_b64 exec, -1
  s_add_u32 s67, s67, 1
  s_waitcnt vmcnt(1)
  v_mfma_f32_16x16x32_bf16 v[4:7], v[0:3], v[52:55], 0
  v_bitop3_b32 v72, v52, v54, s72 bitop3:0x7e
  s_waitcnt vmcnt(0)
  v_mfma_f32_16x16x32_bf16 v[4:7], v[0:3], v[56:59], v[4:7]
  v_bitop3_b32 v73, v56, v58, s72 bitop3:0x7e
  v_bitop3_b32 v72, v72, v73, 1 bitop3:0xa8
  v_cmp_ne_u32 vcc, 0, v72
  s_cbranch_vccz Cf2_h1p
Cf2_h1s:
  s_mov_b64 exec, vcc
  buffer_load_dwordx4 v[52:55], v76, s[8:11], s60 offen offset:0 sc1
  buffer_load_dwordx4 v[56:59], v76, s[8:11], s60 offen offset:1024 sc1
  s_mov_b64 exec, -1
  s_add_u32 s67, s67, 1
  s_waitcnt vmcnt(1)
  v_mfma_f32_16x16x32_bf16 v[4:7], v[0:3], v[52:55], 0
  v_bitop3_b32 v72, v52, v54, s72 bitop3:0x7e
  s_waitcnt vmcnt(0)
  v_mfma_f32_16x16x32_bf16 v[4:7], v[0:3], v[56:59], v[4:7]
  v_bitop3_b32 v73, v56, v58, s72 bitop3:0x7e
  v_bitop3_b32 v72, v72, v73, 1 bitop3:0xa8
  v_cmp_ne_u32 vcc, 0, v72
  s_cbranch_vccz Cf2_h1p
  s_cmp_lt_u32 s67, 131072
  s_cbranch_scc1 Cf2_h1s
Cf2_h1p:
  s_nop 2
  v_add_f32_dpp v4, v4, v4 row_ror:4 row_mask:0xf bank_mask:0xf
  v_add_f32_dpp v5, v5, v5 row_ror:4 row_mask:0xf bank_mask:0xf
  s_nop 0
  v_add_f32_dpp v4, v4, v4 row_ror:8 row_mask:0xf bank_mask:0xf
  v_add_f32_dpp v5, v5, v5 row_ror:8 row_mask:0xf bank_mask:0xf
  v_cvt_pk_bf16_f32 v4, v4, v5
  buffer_store_dword v4, v69, s[8:11], s62 offen
  s_xor_b32 s62, s62, 16384
  buffer_store_dword v71, v69, s[8:11], s62 offen
  s_xor_b32 s72, s72, 1
  s_branch Cf2_h2
Cf2_h2r:
  s_mov_b64 exec, vcc
  buffer_load_dwordx4 v[12:15], v76, s[8:11], s65 offen offset:3072 sc1
  s_mov_b64 exec, -1
  s_add_u32 s67, s67, 1
  s_waitcnt vmcnt(4)
  v_max3_u32 v72, v12, v13, v14
  v_max_u32 v72, v72, v15
  ds_write_b128 v76, v[12:15] offset:7680
  v_cmp_eq_u32 vcc, -1, v72
  s_cbranch_vccz Cf2_h2w
  s_mov_b64 exec, vcc
  buffer_load_dwordx4 v[12:15], v76, s[8:11], s65 offen offset:3072 sc1
  s_mov_b64 exec, -1
  s_add_u32 s67, s67, 1
  s_waitcnt vmcnt(4)
  v_max3_u32 v72, v12, v13, v14
  v_max_u32 v72, v72, v15
  ds_write_b128 v76, v[12:15] offset:7680
  v_cmp_eq_u32 vcc, -1, v72
  s_cbranch_vccz Cf2_h2w
Cf2_h2s:
  s_mov_b64 exec, vcc
  buffer_load_dwordx4 v[12:15], v76, s[8:11], s65 offen offset:3072 sc1
  s_mov_b64 exec, -1
  s_add_u32 s67, s67, 1
  s_waitcnt vmcnt(2)
  v_max3_u32 v72, v12, v13, v14
  v_max_u32 v72, v72, v15
  ds_write_b128 v76, v[12:15] offset:7680
  v_cmp_eq_u32 vcc, -1, v72
  s_cbranch_vccz Cf2_h2w
  s_mov_b64 exec, vcc
  buffer_load_dwordx4 v[12:15], v76, s[8:11], s65 offen offset:3072 sc1
  s_mov_b64 exec, -1
  s_add_u32 s67, s67, 1
  s_waitcnt vmcnt(2)
  v_max3_u32 v72, v12, v13, v14
  v_max_u32 v72, v72, v15
  ds_write_b128 v76, v[12:15] offset:7680
  v_cmp_eq_u32 vcc, -1, v72
  s_cbranch_vccz Cf2_h2w
  s_mov_b64 exec, vcc
  buffer_load_dwordx4 v[12:15], v76, s[8:11], s65 offen offset:3072 sc1
  s_mov_b64 exec, -1
  s_add_u32 s67, s67, 1
  s_waitcnt vmcnt(2)
  v_max3_u32 v72, v12, v13, v14
  v_max_u32 v72, v72, v15
  ds_write_b128 v76, v[12:15] offset:7680
  v_cmp_eq_u32 vcc, -1, v72
  s_cbranch_vccz Cf2_h2w
  s_cmp_lt_u32 s67, 131072
  s_cbranch_scc1 Cf2_h2s
  s_branch Cf2_h2w
Cf2_rec:
  s_nop 7
  s_waitcnt vmcnt(0) lgkmcnt(0)
  v_max3_u32 v72, v0, v1, v2
  v_max3_u32 v72, v72, v3, v4
  v_max3_u32 v72, v72, v5, v6
  v_max3_u32 v72, v72, v7, v8
  v_max3_u32 v72, v72, v9, v10
  v_max3_u32 v72, v72, v11, v12
  v_max3_u32 v72, v72, v13, v14
  v_max3_u32 v72, v72, v15, v16
  v_max3_u32 v72, v72, v17, v18
  v_max_u32 v72, v72, v19
  v_cmp_eq_u32 vcc, -1, v72
  s_cbranch_vccz Cf2_recok
  s_barrier
Cf2_recp:
  buffer_load_dwordx4 v[0:3], v76, s[8:11], s64 offen offset:0 sc1
  buffer_load_dwordx4 v[4:7], v76, s[8:11], s64 offen offset:1024 sc1
  s_add_u32 s67, s67, 1
  s_cmp_lt_u32 s67, 131072
  s_cselect_b32 s54, -2, -1
  s_waitcnt vmcnt(1)
  v_max3_u32 v72, v0, v1, v2
  s_waitcnt vmcnt(0)
  v_max3_u32 v72, v72, v3, v4
  v_max3_u32 v72, v72, v5, v6
  v_max_u32 v72, v72, v7
  v_cmp_lt_u32 vcc, s54, v72
  s_cbranch_vccnz Cf2_recp
  ds_write_b128 v76, v[0:3] offset:8704
  ds_write_b128 v76, v[4:7] offset:9728
  v_mov_b64 v[20:21], 0
  v_mov_b64 v[22:23], 0
  v_mov_b64 v[24:25], 0
  v_mov_b64 v[26:27], 0
  v_mov_b64 v[28:29], 0
  v_mov_b64 v[30:31], 0
  v_mov_b64 v[32:33], 0
  v_mov_b64 v[34:35], 0
  s_waitcnt lgkmcnt(0)
  s_barrier
  ds_read_b128 v[0:3], v76 offset:4608
  s_waitcnt lgkmcnt(0)
  v_smfmac_f32_16x16x64_bf16 v[20:23], v[0:3], v[80:87], v74
  v_smfmac_f32_16x16x64_bf16 v[24:27], v[0:3], v[88:95], v74
  ds_read_b128 v[60:63], v76 offset:24576
  ds_read_b128 v[64:67], v76 offset:25600
  s_waitcnt lgkmcnt(0)
  v_smfmac_f32_16x16x64_bf16 v[28:31], v[0:3], v[60:67], v74
  ds_read_b128 v[60:63], v76 offset:26624
  ds_read_b128 v[64:67], v76 offset:27648
  s_waitcnt lgkmcnt(0)
  v_smfmac_f32_16x16x64_bf16 v[32:35], v[0:3], v[60:67], v74
  ds_read_b128 v[4:7], v76 offset:5632
  s_waitcnt lgkmcnt(0)
  v_smfmac_f32_16x16x64_bf16 v[20:23], v[4:7], v[96:103], v74
  v_smfmac_f32_16x16x64_bf16 v[24:27], v[4:7], v[104:111], v74
  ds_read_b128 v[60:63], v76 offset:40960
  ds_read_b128 v[64:67], v76 offset:41984
  s_waitcnt lgkmcnt(0)
  v_smfmac_f32_16x16x64_bf16 v[28:31], v[4:7], v[60:67], v74
  ds_read_b128 v[60:63], v76 offset:43008
  ds_read_b128 v[64:67], v76 offset:44032
  s_waitcnt lgkmcnt(0)
  v_smfmac_f32_16x16x64_bf16 v[32:35], v[4:7], v[60:67], v74
  ds_read_b128 v[8:11], v76 offset:6656
  s_waitcnt lgkmcnt(0)
  v_smfmac_f32_16x16x64_bf16 v[20:23], v[8:11], v[112:119], v74
  v_smfmac_f32_16x16x64_bf16 v[24:27], v[8:11], v[120:127], v74
  v_smfmac_f32_16x16x64_bf16 v[28:31], v[8:11], v[208:215], v74
  v_smfmac_f32_16x16x64_bf16 v[32:35], v[8:11], v[216:223], v74
  ds_read_b128 v[12:15], v76 offset:7680
  s_waitcnt lgkmcnt(0)
  v_smfmac_f32_16x16x64_bf16 v[20:23], v[12:15], v[128:135], v74
  v_smfmac_f32_16x16x64_bf16 v[24:27], v[12:15], v[136:143], v74
  v_smfmac_f32_16x16x64_bf16 v[28:31], v[12:15], v[224:231], v74
  v_smfmac_f32_16x16x64_bf16 v[32:35], v[12:15], v[232:239], v74
  ds_read_b128 v[12:15], v76 offset:8704
  s_waitcnt lgkmcnt(0)
  v_smfmac_f32_16x16x64_bf16 v[20:23], v[12:15], v[144:151], v74
  v_smfmac_f32_16x16x64_bf16 v[24:27], v[12:15], v[152:159], v74
  ds_read_b128 v[60:63], v76 offset:57344
  ds_read_b128 v[64:67], v76 offset:58368
  s_waitcnt lgkmcnt(0)
  v_smfmac_f32_16x16x64_bf16 v[28:31], v[12:15], v[60:67], v74
  ds_read_b128 v[60:63], v76 offset:59392
  ds_read_b128 v[64:67], v76 offset:60416
  s_waitcnt lgkmcnt(0)
  v_smfmac_f32_16x16x64_bf16 v[32:35], v[12:15], v[60:67], v74
  ds_read_b128 v[0:3], v76 offset:9728
  s_waitcnt lgkmcnt(0)
  v_smfmac_f32_16x16x64_bf16 v[20:23], v[0:3], v[160:167], v74
  v_smfmac_f32_16x16x64_bf16 v[24:27], v[0:3], v[168:175], v74
  ds_read_b128 v[60:63], v75 offset:24576
  ds_read_b128 v[64:67], v75 offset:25600
  s_waitcnt lgkmcnt(0)
  v_smfmac_f32_16x16x64_bf16 v[28:31], v[0:3], v[60:67], v74
  ds_read_b128 v[60:63], v75 offset:26624
  ds_read_b128 v[64:67], v75 offset:27648
  s_waitcnt lgkmcnt(0)
  v_smfmac_f32_16x16x64_bf16 v[32:35], v[0:3], v[60:67], v74
  ds_read_b128 v[16:19], v76 offset:10752
  ds_read_b128 v[60:63], v75 offset:8192
  ds_read_b128 v[64:67], v75 offset:9216
  s_waitcnt lgkmcnt(0)
  v_smfmac_f32_16x16x64_bf16 v[20:23], v[16:19], v[60:67], v74
  ds_read_b128 v[60:63], v75 offset:10240
  ds_read_b128 v[64:67], v75 offset:11264
  s_waitcnt lgkmcnt(0)
  v_smfmac_f32_16x16x64_bf16 v[24:27], v[16:19], v[60:67], v74
  v_smfmac_f32_16x16x64_bf16 v[28:31], v[16:19], v[240:247], v74
  v_smfmac_f32_16x16x64_bf16 v[32:35], v[16:19], v[248:255], v74
  ds_read_b128 v[4:7], v76 offset:11776
  s_waitcnt lgkmcnt(0)
  v_smfmac_f32_16x16x64_bf16 v[20:23], v[4:7], v[176:183], v74
  v_smfmac_f32_16x16x64_bf16 v[24:27], v[4:7], v[184:191], v74
  v_smfmac_f32_16x16x64_bf16 v[28:31], v[4:7], a[0:7], v74
  v_smfmac_f32_16x16x64_bf16 v[32:35], v[4:7], a[8:15], v74
  ds_read_b128 v[8:11], v76 offset:12800
  s_waitcnt lgkmcnt(0)
  v_smfmac_f32_16x16x64_bf16 v[20:23], v[8:11], v[192:199], v74
  v_smfmac_f32_16x16x64_bf16 v[24:27], v[8:11], v[200:207], v74
  v_smfmac_f32_16x16x64_bf16 v[28:31], v[8:11], a[16:23], v74
  v_smfmac_f32_16x16x64_bf16 v[32:35], v[8:11], a[24:31], v74
  v_add_f32 v20, v20, v22
  v_add_f32 v21, v21, v23
  v_add_f32 v24, v24, v26
  v_cvt_pk_bf16_f32 v22, v20, v24
  ds_write_b32 v79, v22 offset:0
  v_add_f32 v25, v25, v27
  v_cvt_pk_bf16_f32 v23, v21, v25
  ds_write_b32 v79, v23 offset:576
  v_add_f32 v28, v28, v30
  v_add_f32 v29, v29, v31
  s_waitcnt lgkmcnt(0)
  s_nop 1
  s_branch Cf2_recok
Cf2_mx:
  s_waitcnt lgkmcnt(0)
  s_barrier
  buffer_load_dwordx4 v[0:3], v76, s[8:11], s58 offen offset:0 sc1
  ds_read_b128 v[20:23], v77 offset:0
  ds_read_b128 v[28:31], v77 offset:256
  buffer_load_dwordx4 v[4:7], v76, s[8:11], s58 offen offset:1024 sc1
  ds_read_b128 v[24:27], v77 offset:128
  ds_read_b128 v[32:35], v77 offset:384
  s_waitcnt vmcnt(1) lgkmcnt(3)
  v_mfma_f32_16x16x32_bf16 v[8:11], v[0:3], v[20:23], 0
  s_waitcnt vmcnt(0) lgkmcnt(1)
  v_mfma_f32_16x16x32_bf16 v[8:11], v[4:7], v[24:27], v[8:11]
  v_mfma_f32_16x16x32_bf16 v[12:15], v[28:31], v[20:23], 0
  s_waitcnt lgkmcnt(0)
  v_mfma_f32_16x16x32_bf16 v[12:15], v[32:35], v[24:27], v[12:15]
  v_add_f32_dpp v8, v10, v8 quad_perm:[2,3,0,1] row_mask:0xf bank_mask:0xf
  v_add_f32_dpp v9, v11, v9 quad_perm:[2,3,0,1] row_mask:0xf bank_mask:0xf
  s_nop 0
  v_mov_b32_dpp v8, v8 quad_perm:[0,1,0,1] row_mask:0xf bank_mask:0xf
  v_mov_b32_dpp v9, v9 quad_perm:[0,1,0,1] row_mask:0xf bank_mask:0xf
  s_nop 1
  v_add_f32_dpp v12, v14, v12 quad_perm:[2,3,0,1] row_mask:0xf bank_mask:0xf
  v_add_f32_dpp v13, v15, v13 quad_perm:[2,3,0,1] row_mask:0xf bank_mask:0xf
  s_nop 0
  v_mov_b32_dpp v12, v12 quad_perm:[0,1,0,1] row_mask:0xf bank_mask:0xf
  v_mov_b32_dpp v13, v13 quad_perm:[0,1,0,1] row_mask:0xf bank_mask:0xf
  v_mul_f32 v12, s69, v12
  ds_write_b32 v78, v8 offset:8712
  v_mul_f32 v13, s69, v13
  ds_write_b32 v78, v9 offset:8776
  s_waitcnt lgkmcnt(0)
  s_barrier
  ds_read_b128 v[36:39], v78 offset:8704
  ds_read_b128 v[40:43], v78 offset:8768
  s_waitcnt lgkmcnt(0)
  s_barrier
  v_max_f32 v16, v36, v37
  v_max3_f32 v16, v16, v38, v39
  v_max3_f32 v16, v16, v40, v41
  v_max3_f32 v16, v16, v42, v43
  v_max3_f32 v16, v16, v12, v13
  v_mov_b32 v17, v16
  s_nop 1
  v_permlane16_swap_b32 v16, v17
  v_max_f32 v16, v16, v17
  v_mov_b32 v17, v16
  s_nop 1
  v_permlane32_swap_b32 v16, v17
  v_max_f32 v16, v16, v17
  v_sub_f32 v36, v36, v16
  v_sub_f32 v37, v37, v16
  v_sub_f32 v38, v38, v16
  v_sub_f32 v39, v39, v16
  v_sub_f32 v40, v40, v16
  v_sub_f32 v41, v41, v16
  v_sub_f32 v42, v42, v16
  v_sub_f32 v43, v43, v16
  v_sub_f32 v12, v12, v16
  v_sub_f32 v13, v13, v16
  v_exp_f32 v36, v36
  v_exp_f32 v37, v37
  v_exp_f32 v38, v38
  v_exp_f32 v39, v39
  v_exp_f32 v40, v40
  v_exp_f32 v41, v41
  v_exp_f32 v42, v42
  v_exp_f32 v43, v43
  v_exp_f32 v12, v12
  v_exp_f32 v13, v13
  v_cvt_pk_bf16_f32 v32, v36, v40
  v_cvt_pk_bf16_f32 v33, v37, v41
  v_cvt_pk_bf16_f32 v34, v38, v42
  v_cvt_pk_bf16_f32 v35, v39, v43
  v_cvt_pk_bf16_f32 v28, v12, v13
  v_cvt_pk_bf16_f32 v31, v12, v13
  v_mov_b32 v29, 0
  v_mov_b32 v30, 0
  v_mov_b32 v68, 0x3f803f80
  v_mov_b32 v69, 0x3f803f80
  v_mov_b32 v70, 0x3f803f80
  v_mov_b32 v71, 0x3f803f80
  s_nop 1
  v_mfma_f32_16x16x32_bf16 v[8:11], v[32:35], v[68:71], 0
  v_mfma_f32_16x16x32_bf16 v[0:3], v[32:35], v[52:55], 0
  v_mfma_f32_16x16x32_bf16 v[4:7], v[32:35], v[56:59], 0
  v_mfma_f32_16x16x16_bf16 v[8:11], v[28:29], v[68:69], v[8:11]
  v_mfma_f32_16x16x16_bf16 v[0:3], v[28:29], v[72:73], v[0:3]
  v_mfma_f32_16x16x16_bf16 v[4:7], v[30:31], v[72:73], v[4:7]
  ds_read_b128 v[68:71], v76 offset:13824
  v_rcp_f32 v10, v8
  v_rcp_f32 v11, v9
  v_mul_f32 v0, v10, v0
  v_mul_f32 v1, v11, v1
  s_nop 0
  v_mul_f32 v4, v10, v4
  v_mul_f32 v5, v11, v5
  v_cvt_pk_bf16_f32 v2, v0, v4
  ds_write_b32 v79, v2 offset:8704
  v_cvt_pk_bf16_f32 v3, v1, v5
  ds_write_b32 v79, v3 offset:9280
  v_mov_b64 v[16:17], 0
  v_mov_b64 v[18:19], 0
  v_mov_b64 v[20:21], 0
  v_mov_b64 v[22:23], 0
  v_mov_b64 v[24:25], 0
  v_mov_b64 v[26:27], 0
  s_branch Cf2_mxok
Cf2_last:
  ds_read_b128 v[4:7], v76 offset:5632
  ds_read_b128 v[8:11], v76 offset:6656
  ds_read_b128 v[44:47], v76 offset:40960
  ds_read_b128 v[48:51], v76 offset:41984
  s_nop 5
  v_mov_b64 v[20:21], 0
  v_mov_b64 v[22:23], 0
  v_mov_b64 v[24:25], 0
  v_mov_b64 v[26:27], 0
  s_waitcnt lgkmcnt(4)
  v_smfmac_f32_16x16x64_bf16 v[28:31], v[0:3], v[36:43], v74
  ds_read_b128 v[36:39], v76 offset:43008
  ds_read_b128 v[40:43], v76 offset:44032
  v_smfmac_f32_16x16x64_bf16 v[32:35], v[0:3], v[60:67], v74
  s_waitcnt lgkmcnt(5)
  v_smfmac_f32_16x16x64_bf16 v[20:23], v[0:3], a[32:39], v74
  ds_read_b128 v[60:63], v76 offset:57344
  ds_read_b128 v[64:67], v76 offset:58368
  v_smfmac_f32_16x16x64_bf16 v[24:27], v[0:3], a[40:47], v74
  s_waitcnt lgkmcnt(4)
  v_smfmac_f32_16x16x64_bf16 v[20:23], v[4:7], a[48:55], v74
  buffer_store_dwordx4 v[16:19], v76, s[8:11], s68 offen sc1
  v_smfmac_f32_16x16x64_bf16 v[24:27], v[4:7], a[56:63], v74
  v_smfmac_f32_16x16x64_bf16 v[28:31], v[4:7], v[44:51], v74
  s_waitcnt lgkmcnt(2)
  v_smfmac_f32_16x16x64_bf16 v[20:23], v[8:11], a[64:71], v74
  ds_read_b128 v[44:47], v76 offset:59392
  ds_read_b128 v[48:51], v76 offset:60416
  v_smfmac_f32_16x16x64_bf16 v[24:27], v[8:11], a[72:79], v74
  v_smfmac_f32_16x16x64_bf16 v[32:35], v[4:7], v[36:43], v74
  v_smfmac_f32_16x16x64_bf16 v[28:31], v[8:11], v[208:215], v74
  ds_read_b128 v[36:39], v75 offset:24576
  ds_read_b128 v[40:43], v75 offset:25600
  v_smfmac_f32_16x16x64_bf16 v[32:35], v[8:11], v[216:223], v74
  v_smfmac_f32_16x16x64_bf16 v[20:23], v[12:15], a[80:87], v74
  v_smfmac_f32_16x16x64_bf16 v[24:27], v[12:15], a[88:95], v74
  v_smfmac_f32_16x16x64_bf16 v[28:31], v[12:15], v[224:231], v74
  v_smfmac_f32_16x16x64_bf16 v[32:35], v[12:15], v[232:239], v74
  s_waitcnt vmcnt(2)
  s_waitcnt vmcnt(1)
  s_barrier
Cf2_lastr:
  ds_read_b128 v[12:15], v76 offset:8704
  ds_read_b128 v[0:3], v76 offset:9728
  ds_read_b128 v[16:19], v76 offset:10752
  ds_read_b128 v[4:7], v76 offset:11776
  ds_read_b128 v[8:11], v76 offset:12800
  s_waitcnt lgkmcnt(3)
  v_max3_u32 v72, v0, v1, v2
  s_waitcnt lgkmcnt(1)
  v_max3_u32 v72, v72, v3, v4
  v_max3_u32 v72, v72, v5, v6
  s_waitcnt lgkmcnt(0)
  v_max3_u32 v72, v72, v7, v8
  v_max3_u32 v72, v72, v9, v10
  v_max3_u32 v72, v72, v11, v12
  v_max3_u32 v72, v72, v13, v14
  v_max3_u32 v72, v72, v15, v16
  v_max3_u32 v72, v72, v17, v18
  v_max_u32 v72, v72, v19
  v_cmp_eq_u32 vcc, -1, v72
  s_cbranch_vccnz Cf2_lastp
Cf2_lastg:
  v_smfmac_f32_16x16x64_bf16 v[28:31], v[12:15], v[60:67], v74
  ds_read_b128 v[60:63], v75 offset:26624
  ds_read_b128 v[64:67], v75 offset:27648
  v_smfmac_f32_16x16x64_bf16 v[32:35], v[12:15], v[44:51], v74
  v_smfmac_f32_16x16x64_bf16 v[28:31], v[0:3], v[36:43], v74
  v_smfmac_f32_16x16x64_bf16 v[28:31], v[16:19], v[240:247], v74
  v_smfmac_f32_16x16x64_bf16 v[28:31], v[4:7], a[0:7], v74
  v_smfmac_f32_16x16x64_bf16 v[28:31], v[8:11], a[16:23], v74
  v_smfmac_f32_16x16x64_bf16 v[32:35], v[16:19], v[248:255], v74
  v_smfmac_f32_16x16x64_bf16 v[32:35], v[4:7], a[8:15], v74
  s_waitcnt lgkmcnt(0)
  v_smfmac_f32_16x16x64_bf16 v[32:35], v[8:11], a[24:31], v74
  v_smfmac_f32_16x16x64_bf16 v[32:35], v[0:3], v[60:67], v74
  v_smfmac_f32_16x16x64_bf16 v[20:23], v[12:15], a[96:103], v74
  v_smfmac_f32_16x16x64_bf16 v[20:23], v[0:3], a[112:119], v74
  v_add_f32 v28, v28, v30
  v_add_f32 v32, v32, v34
  v_cvt_pk_bf16_f32 v30, v28, v32
  v_smfmac_f32_16x16x64_bf16 v[20:23], v[16:19], a[128:135], v74
  ds_write_b32 v79, v30 offset:256
  v_add_f32 v29, v29, v31
  v_add_f32 v33, v33, v35
  v_cvt_pk_bf16_f32 v31, v29, v33
  v_smfmac_f32_16x16x64_bf16 v[20:23], v[4:7], a[144:151], v74
  ds_write_b32 v79, v31 offset:832
  v_smfmac_f32_16x16x64_bf16 v[20:23], v[8:11], a[160:167], v74
  v_smfmac_f32_16x16x64_bf16 v[24:27], v[12:15], a[104:111], v74
  v_smfmac_f32_16x16x64_bf16 v[24:27], v[0:3], a[120:127], v74
  v_smfmac_f32_16x16x64_bf16 v[24:27], v[16:19], a[136:143], v74
  s_waitcnt lgkmcnt(0)
  s_barrier
  ds_read_b64 v[52:53], v77 offset:384
  v_add_f32 v20, v20, v22
  v_smfmac_f32_16x16x64_bf16 v[24:27], v[4:7], a[152:159], v74
  v_add_f32 v21, v21, v23
  v_smfmac_f32_16x16x64_bf16 v[24:27], v[8:11], a[168:175], v74
  v_cvt_pk_bf16_f32 v54, v20, v21
  s_add_u32 s68, s68, 655360
  s_nop 3
  v_add_f32 v24, v24, v26
  v_add_f32 v25, v25, v27
  v_cvt_pk_bf16_f32 v55, v24, v25
  s_waitcnt lgkmcnt(0)
  buffer_store_dwordx4 v[52:55], v76, s[8:11], s68 offen sc1
  s_branch Cf2_done
Cf2_lastp:
  s_add_u32 s72, s72, 2
  s_cmp_ge_u32 s72, 131072
  s_cbranch_scc1 Cf2_lastg
  s_barrier
  buffer_load_dwordx4 v76, s[8:11], s55 offen offset:0 sc1 lds
  s_waitcnt vmcnt(0)
  s_barrier
  s_branch Cf2_lastr
Cf2_done:
  s_branch L_cexit
L_w3:
  v_mov_b64 v[20:21], 0
  v_mov_b64 v[22:23], 0
  v_mov_b64 v[24:25], 0
  v_mov_b64 v[26:27], 0
  v_mov_b64 v[28:29], 0
  v_mov_b64 v[30:31], 0
  v_mov_b64 v[32:33], 0
  v_mov_b64 v[34:35], 0
  s_mov_b32 s78, 0x3f803f80
  s_mov_b32 s79, s78
  s_mov_b32 s65, 360448
  s_mov_b32 m0, 15872
  s_lshl_b32 s71, s53, 2
  s_add_u32 s71, s71, 128
  s_movk_i32 s56, 0x1000
  v_lshlrev_b32 v73, 2, v76
  v_mov_b32 v72, 0
  s_mov_b64 s[16:17], s[8:9]
  s_mov_b32 s18, 268435456
  s_mov_b32 s19, 0x20000
  s_getpc_b64 s[20:21]
Cf3_pc:
  s_add_u32 s20, s20, (Cf3_last - Cf3_pc)
  s_addc_u32 s21, s21, 0
  v_mov_b32 v68, 14880
  buffer_load_dwordx4 v[52:55], v76, s[8:11], s59 offen offset:0 sc1
  buffer_load_dwordx4 v[56:59], v76, s[8:11], s59 offen offset:1024 sc1
  ds_read_b128 v[36:39], v76 offset:45056
  ds_read_b128 v[40:43], v76 offset:46080
  ds_read_b128 v[60:63], v76 offset:47104
  ds_read_b128 v[64:67], v76 offset:48128
  ds_read_b128 v[0:3], v76 offset:4608
  ds_read_b128 v[4:7], v76 offset:5632
  ds_read_b128 v[8:11], v76 offset:6656
  ds_read_b128 v[12:15], v76 offset:7680
  s_waitcnt lgkmcnt(0)
  s_cmp_eq_u32 s66, 1
  s_branch Cf3_top2
.p2align 6
Cf3_h2:
  v_lshlrev_b32 v73, 2, v76
  s_mov_b32 m0, 8704
  s_add_u32 s55, s65, 4096
  buffer_load_dwordx4 v[4:7], v76, s[8:11], s65 offen offset:1024 sc1
  s_waitcnt vmcnt(6)
  ds_read_b128 v[36:39], v76 offset:45056
  ds_read_b128 v[40:43], v76 offset:46080
  ds_read_b128 v[60:63], v76 offset:47104
  ds_read_b128 v[64:67], v76 offset:48128
  buffer_load_dwordx4 v[52:55], v76, s[8:11], s59 offen offset:0 sc1
  buffer_load_dwordx4 v[56:59], v76, s[8:11], s59 offen offset:1024 sc1
  s_waitcnt vmcnt(7)
  v_max3_u32 v72, v4, v5, v6
  v_max_u32 v72, v72, v7
  ds_write_b128 v76, v[4:7] offset:5632
  v_cmp_eq_u32 vcc, -1, v72
  s_cbranch_vccnz Cf3_h2r
Cf3_h2w:
  buffer_load_dwordx4 v76, s[8:11], s55 offen offset:0 sc1 lds
  buffer_load_dwordx4 v76, s[8:11], s55 offen offset:1024 sc1 lds
  s_cmp_eq_u32 s66, 63
  s_waitcnt lgkmcnt(0)
  s_barrier
  ds_read_b128 v[8:11], v76 offset:6656
Cf3_top2:
  v_smfmac_f32_16x16x64_bf16 v[20:23], v[4:7], v[96:103], v74
  s_cbranch_scc1 Cf3_last
  v_smfmac_f32_16x16x64_bf16 v[28:31], v[4:7], v[36:43], v74
  buffer_load_dwordx4 v[44:47], v76, s[8:11], s58 offen offset:0 sc1
  s_mov_b32 m0, 15872
  v_smfmac_f32_16x16x64_bf16 v[24:27], v[4:7], v[104:111], v74
  buffer_load_dwordx4 v[48:51], v76, s[8:11], s58 offen offset:1024 sc1
  v_smfmac_f32_16x16x64_bf16 v[32:35], v[4:7], v[60:67], v74
  ds_read_b128 v[0:3], v76 offset:4608
  s_waitcnt lgkmcnt(1)
  v_smfmac_f32_16x16x64_bf16 v[20:23], v[8:11], v[112:119], v74
  ds_read_b128 v[12:15], v76 offset:7680
  v_smfmac_f32_16x16x64_bf16 v[24:27], v[8:11], v[120:127], v74
  ds_read_b128 v[36:39], v76 offset:28672
  v_smfmac_f32_16x16x64_bf16 v[28:31], v[8:11], v[208:215], v74
  buffer_store_dwordx4 v[16:19], v76, s[8:11], s68 offen sc1
  ds_read_b128 v[40:43], v76 offset:29696
  v_smfmac_f32_16x16x64_bf16 v[32:35], v[8:11], v[216:223], v74
  ds_read_b128 v[60:63], v76 offset:30720
  s_waitcnt lgkmcnt(4)
  v_smfmac_f32_16x16x64_bf16 v[20:23], v[0:3], v[80:87], v74
  ds_read_b128 v[64:67], v76 offset:31744
  v_smfmac_f32_16x16x64_bf16 v[24:27], v[0:3], v[88:95], v74
  buffer_load_dword v73, s[16:19], s70 offen lds
  s_waitcnt vmcnt(4)
  s_waitcnt lgkmcnt(4)
  v_smfmac_f32_16x16x64_bf16 v[20:23], v[12:15], v[128:135], v74
  s_barrier
  s_waitcnt lgkmcnt(2)
  v_smfmac_f32_16x16x64_bf16 v[28:31], v[0:3], v[36:43], v74
  ds_read_b128 v[4:7], v76 offset:8704
  v_smfmac_f32_16x16x64_bf16 v[24:27], v[12:15], v[136:143], v74
  ds_read_b128 v[36:39], v76 offset:61440
  s_waitcnt lgkmcnt(2)
  v_smfmac_f32_16x16x64_bf16 v[32:35], v[0:3], v[60:67], v74
  ds_read_b128 v[40:43], v76 offset:62464
  v_smfmac_f32_16x16x64_bf16 v[28:31], v[12:15], v[224:231], v74
  ds_read_b128 v[60:63], v76 offset:63488
  v_smfmac_f32_16x16x64_bf16 v[32:35], v[12:15], v[232:239], v74
  ds_read_b128 v[64:67], v76 offset:64512
  s_waitcnt lgkmcnt(4)
  v_smfmac_f32_16x16x64_bf16 v[20:23], v[4:7], v[144:151], v74
  ds_read_b128 v[8:11], v76 offset:9728
  s_waitcnt lgkmcnt(3)
  v_smfmac_f32_16x16x64_bf16 v[28:31], v[4:7], v[36:43], v74
  s_barrier
  ds_read_b128 v[0:3], v76 offset:11776
  v_smfmac_f32_16x16x64_bf16 v[24:27], v[4:7], v[152:159], v74
  ds_read_b128 v[36:39], v75 offset:12288
  ds_read_b128 v[40:43], v75 offset:13312
  s_waitcnt lgkmcnt(4)
  v_smfmac_f32_16x16x64_bf16 v[32:35], v[4:7], v[60:67], v74
  ds_read_b128 v[16:19], v76 offset:10752
  s_waitcnt lgkmcnt(4)
  v_smfmac_f32_16x16x64_bf16 v[20:23], v[8:11], v[160:167], v74
  ds_read_b128 v[12:15], v76 offset:12800
  v_smfmac_f32_16x16x64_bf16 v[24:27], v[8:11], v[168:175], v74
  ds_read_b128 v[60:63], v75 offset:14336
  ds_read_b128 v[64:67], v75 offset:15360
  s_waitcnt lgkmcnt(6)
  v_smfmac_f32_16x16x64_bf16 v[20:23], v[0:3], v[176:183], v74
  s_waitcnt lgkmcnt(3)
  v_smfmac_f32_16x16x64_bf16 v[20:23], v[16:19], v[36:43], v74
  ds_read_b128 v[36:39], v75 offset:28672
  s_waitcnt lgkmcnt(3)
  v_smfmac_f32_16x16x64_bf16 v[20:23], v[12:15], v[192:199], v74
  ds_read_b128 v[40:43], v75 offset:29696
  s_waitcnt lgkmcnt(2)
  v_smfmac_f32_16x16x64_bf16 v[24:27], v[16:19], v[60:67], v74
  ds_read_b128 v[60:63], v75 offset:30720
  v_smfmac_f32_16x16x64_bf16 v[24:27], v[0:3], v[184:191], v74
  ds_read_b128 v[64:67], v75 offset:31744
  v_add_f32 v20, v20, v22
  v_smfmac_f32_16x16x64_bf16 v[24:27], v[12:15], v[200:207], v74
  v_add_f32 v21, v21, v23
  v_smfmac_f32_16x16x64_bf16 v[28:31], v[16:19], v[240:247], v74
  s_waitcnt lgkmcnt(2)
  v_mov_b64 v[70:71], s[78:79]
  v_smfmac_f32_16x16x64_bf16 v[28:31], v[8:11], v[36:43], v74
  ds_read_b128 v[36:39], v68
  v_add_f32 v24, v24, v26
  v_smfmac_f32_16x16x64_bf16 v[28:31], v[0:3], a[0:7], v74
  ds_read_b128 v[40:43], v68
  v_cvt_pk_bf16_f32 v22, v20, v24
  v_smfmac_f32_16x16x64_bf16 v[28:31], v[12:15], a[16:23], v74
  ds_write_b32 v79, v22 offset:0
  s_waitcnt lgkmcnt(3)
  v_add_f32 v25, v25, v27
  v_cvt_pk_bf16_f32 v23, v21, v25
  v_smfmac_f32_16x16x64_bf16 v[32:35], v[8:11], v[60:67], v74
  ds_write_b32 v79, v23 offset:576
  v_cmp_u_f32 vcc, v20, v21
  v_smfmac_f32_16x16x64_bf16 v[32:35], v[16:19], v[248:255], v74
  v_add_f32 v28, v28, v30
  v_smfmac_f32_16x16x64_bf16 v[32:35], v[0:3], a[8:15], v74
  v_add_f32 v29, v29, v31
  v_smfmac_f32_16x16x64_bf16 v[32:35], v[12:15], a[24:31], v74
  s_cbranch_vccnz Cf3_rec
Cf3_recok:
  s_waitcnt lgkmcnt(3)
  v_smfmac_f32_16x16x64_bf16 v[36:39], v[16:19], a[128:135], v74
  s_waitcnt lgkmcnt(0)
  s_barrier
  ds_read_b128 v[60:63], v77
  v_smfmac_f32_16x16x64_bf16 v[40:43], v[16:19], a[136:143], v74
  ds_read_b128 v[64:67], v77 offset:128
  v_add_f32 v32, v32, v34
  v_cvt_pk_bf16_f32 v30, v28, v32
  v_smfmac_f32_16x16x64_bf16 v[36:39], v[0:3], a[144:151], v74
  ds_write_b32 v79, v30 offset:256
  v_add_f32 v33, v33, v35
  v_cvt_pk_bf16_f32 v31, v29, v33
  v_smfmac_f32_16x16x64_bf16 v[40:43], v[0:3], a[152:159], v74
  ds_write_b32 v79, v31 offset:832
  v_xor_b32 v75, 0x8000, v75
  v_smfmac_f32_16x16x64_bf16 v[36:39], v[4:7], a[96:103], v74
  ds_read_b128 v[0:3], v76 offset:4608
  v_mov_b32 v29, 0
  v_smfmac_f32_16x16x64_bf16 v[40:43], v[4:7], a[104:111], v74
  s_waitcnt vmcnt(2) lgkmcnt(3)
  v_mov_b32 v30, 0
  v_mfma_f32_16x16x32_bf16 v[44:47], v[44:47], v[60:63], 0
  ds_read_b128 v[4:7], v76 offset:5632
  s_waitcnt lgkmcnt(2)
  v_mfma_f32_16x16x32_bf16 v[44:47], v[48:51], v[64:67], v[44:47]
  s_barrier
  v_smfmac_f32_16x16x64_bf16 v[36:39], v[8:11], a[112:119], v74
  ds_read_b128 v[20:23], v77 offset:256
  ds_read_b128 v[24:27], v77 offset:384
  v_smfmac_f32_16x16x64_bf16 v[40:43], v[8:11], a[120:127], v74
  ds_read_b128 v[8:11], v76 offset:6656
  v_add_f32_dpp v72, v46, v44 quad_perm:[2,3,0,1] row_mask:0xf bank_mask:0xf
  v_add_f32_dpp v73, v47, v45 quad_perm:[2,3,0,1] row_mask:0xf bank_mask:0xf
  v_smfmac_f32_16x16x64_bf16 v[36:39], v[12:15], a[160:167], v74
  s_waitcnt lgkmcnt(4)
  v_exp_f32_dpp v72, v72 quad_perm:[0,1,0,1] row_mask:0xf bank_mask:0xf
  v_smfmac_f32_16x16x64_bf16 v[40:43], v[12:15], a[168:175], v74
  ds_read_b128 v[12:15], v76 offset:7680
  v_exp_f32_dpp v73, v73 quad_perm:[0,1,0,1] row_mask:0xf bank_mask:0xf
  v_smfmac_f32_16x16x64_bf16 v[36:39], v[0:3], a[32:39], v74
  s_waitcnt lgkmcnt(2)
  v_cvt_pk_bf16_f32 v72, v72, v73
  v_mfma_f32_16x16x32_bf16 v[20:23], v[20:23], v[60:63], 0
  ds_write_b32 v78, v72 offset:524
  v_mov_b64 v[16:17], 0
  v_mfma_f32_16x16x32_bf16 v[20:23], v[24:27], v[64:67], v[20:23]
  ds_read_b128 v[44:47], v75 offset:28672
  v_mov_b64 v[18:19], 0
  v_smfmac_f32_16x16x64_bf16 v[40:43], v[0:3], a[40:47], v74
  ds_read_b128 v[48:51], v75 offset:29696
  v_mov_b64 v[68:69], s[78:79]
  v_smfmac_f32_16x16x64_bf16 v[36:39], v[4:7], a[48:55], v74
  s_waitcnt lgkmcnt(4)
  v_add_f32_dpp v24, v22, v20 quad_perm:[2,3,0,1] row_mask:0xf bank_mask:0xf
  v_add_f32_dpp v25, v23, v21 quad_perm:[2,3,0,1] row_mask:0xf bank_mask:0xf
  v_smfmac_f32_16x16x64_bf16 v[36:39], v[8:11], a[64:71], v74
  s_waitcnt lgkmcnt(2)
  s_barrier
  ds_read_b128 v[32:35], v78 offset:512
  v_smfmac_f32_16x16x64_bf16 v[36:39], v[12:15], a[80:87], v74
  ds_read_b128 v[60:63], v75 offset:30720
  v_mul_f32 v24, s69, v24
  v_smfmac_f32_16x16x64_bf16 v[40:43], v[4:7], a[56:63], v74
  ds_read_b128 v[64:67], v75 offset:31744
  v_mul_f32 v25, s69, v25
  v_smfmac_f32_16x16x64_bf16 v[40:43], v[8:11], a[72:79], v74
  v_exp_f32_dpp v24, v24 quad_perm:[0,1,0,1] row_mask:0xf bank_mask:0xf
  v_smfmac_f32_16x16x64_bf16 v[40:43], v[12:15], a[88:95], v74
  s_waitcnt lgkmcnt(2)
  v_exp_f32_dpp v25, v25 quad_perm:[0,1,0,1] row_mask:0xf bank_mask:0xf
  v_mfma_f32_16x16x32_bf16 v[8:11], v[32:35], v[68:71], 0
  v_add_f32 v36, v36, v38
  v_add_f32 v37, v37, v39
  v_mfma_f32_16x16x32_bf16 v[0:3], v[32:35], v[52:55], 0
  v_add_f32 v40, v40, v42
  v_add_f32 v41, v41, v43
  v_mfma_f32_16x16x32_bf16 v[4:7], v[32:35], v[56:59], 0
  v_cvt_pk_bf16_f32 v28, v24, v25
  v_cvt_pk_bf16_f32 v72, v36, v37
  v_cvt_pk_bf16_f32 v73, v40, v41
  v_mfma_f32_16x16x16_bf16 v[8:11], v[28:29], v[68:69], v[8:11]
  v_cvt_pk_bf16_f32 v31, v24, v25
  v_mov_b64 v[20:21], 0
  v_mfma_f32_16x16x16_bf16 v[0:3], v[28:29], v[72:73], v[0:3]
  ds_read_b128 v[68:71], v76 offset:13824
  v_mov_b64 v[22:23], 0
  v_mfma_f32_16x16x16_bf16 v[4:7], v[30:31], v[72:73], v[4:7]
  v_rcp_f32 v10, v8
  v_rcp_f32 v11, v9
  v_mul_f32 v0, v10, v0
  v_mul_f32 v1, v11, v1
  s_nop 0
  v_mul_f32 v4, v10, v4
  v_mul_f32 v5, v11, v5
  v_cvt_pk_bf16_f32 v2, v0, v4
  ds_write_b32 v79, v2 offset:8704
  v_cvt_pk_bf16_f32 v3, v1, v5
  ds_write_b32 v79, v3 offset:9280
  v_max3_f32 v8, v8, v9, v10
  v_max_f32 v8, v8, v11
  v_cmp_le_f32 vcc, 1317011456, v8
  v_mov_b64 v[24:25], 0
  v_mov_b64 v[26:27], 0
  s_cbranch_vccnz Cf3_mx
Cf3_mxok:
  s_waitcnt lgkmcnt(0)
  s_barrier
  ds_read_b128 v[0:3], v78 offset:8704
  ds_read_b128 v[4:7], v78 offset:8768
  ds_read_b128 v[8:11], v78 offset:8832
  ds_read_b128 v[12:15], v78 offset:8896
  s_waitcnt lgkmcnt(3)
  v_smfmac_f32_16x16x64_bf16 v[16:19], v[0:3], v[44:51], v74
  ds_read_b128 v[52:55], v75 offset:45056
  s_waitcnt lgkmcnt(3)
  v_smfmac_f32_16x16x64_bf16 v[16:19], v[4:7], v[60:67], v74
  ds_read_b128 v[56:59], v75 offset:46080
  s_waitcnt lgkmcnt(3)
  v_smfmac_f32_16x16x64_bf16 v[16:19], v[8:11], a[176:183], v74
  ds_read_b128 v[36:39], v75 offset:47104
  s_waitcnt lgkmcnt(3)
  v_smfmac_f32_16x16x64_bf16 v[16:19], v[12:15], a[184:191], v74
  ds_read_b128 v[40:43], v75 offset:48128
  ds_read_b128 v[44:47], v75 offset:61440
  v_smfmac_f32_16x16x64_bf16 v[20:23], v[0:3], a[192:199], v74
  ds_read_b128 v[48:51], v75 offset:62464
  ds_read_b128 v[60:63], v75 offset:63488
  v_smfmac_f32_16x16x64_bf16 v[20:23], v[4:7], a[200:207], v74
  ds_read_b128 v[64:67], v75 offset:64512
  s_waitcnt lgkmcnt(6)
  v_cvt_pk_bf16_f32 v16, v16, v17
  v_cvt_pk_bf16_f32 v17, v18, v19
  v_bfi_b32 v16, 1, s72, v16
  v_smfmac_f32_16x16x64_bf16 v[20:23], v[8:11], v[52:59], v74
  buffer_store_dwordx2 v[16:17], v68, s[8:11], s73 offen
  s_waitcnt lgkmcnt(4)
  v_smfmac_f32_16x16x64_bf16 v[20:23], v[12:15], v[36:43], v74
  ds_read_b128 v[52:55], v75 offset:8192
  v_mov_b64 v[32:33], 0
  v_smfmac_f32_16x16x64_bf16 v[24:27], v[0:3], a[208:215], v74
  ds_read_b128 v[56:59], v75 offset:9216
  v_mov_b64 v[34:35], 0
  v_smfmac_f32_16x16x64_bf16 v[24:27], v[4:7], a[216:223], v74
  ds_read_b128 v[36:39], v75 offset:10240
  s_waitcnt lgkmcnt(5)
  v_cvt_pk_bf16_f32 v20, v20, v21
  v_cvt_pk_bf16_f32 v21, v22, v23
  v_bfi_b32 v20, 1, s72, v20
  v_smfmac_f32_16x16x64_bf16 v[24:27], v[8:11], v[44:51], v74
  buffer_store_dwordx2 v[20:21], v68, s[8:11], s74 offen
  s_waitcnt lgkmcnt(3)
  v_smfmac_f32_16x16x64_bf16 v[24:27], v[12:15], v[60:67], v74
  ds_read_b128 v[40:43], v75 offset:11264
  v_mov_b64 v[28:29], 0
  v_smfmac_f32_16x16x64_bf16 v[32:35], v[0:3], a[224:231], v74
  ds_read_b128 v[44:47], v75 offset:12288
  ds_read_b128 v[48:51], v75 offset:13312
  v_smfmac_f32_16x16x64_bf16 v[32:35], v[4:7], a[232:239], v74
  ds_read_b128 v[60:63], v75 offset:14336
  v_cvt_pk_bf16_f32 v24, v24, v25
  v_cvt_pk_bf16_f32 v25, v26, v27
  v_bfi_b32 v24, 1, s72, v24
  v_smfmac_f32_16x16x64_bf16 v[32:35], v[8:11], a[240:247], v74
  buffer_store_dwordx2 v[24:25], v68, s[8:11], s75 offen
  v_mov_b64 v[30:31], 0
  v_smfmac_f32_16x16x64_bf16 v[32:35], v[12:15], a[248:255], v74
  ds_read_b128 v[64:67], v75 offset:15360
  s_waitcnt lgkmcnt(6)
  v_smfmac_f32_16x16x64_bf16 v[28:31], v[0:3], v[52:59], v74
  s_waitcnt lgkmcnt(4)
  v_smfmac_f32_16x16x64_bf16 v[28:31], v[4:7], v[36:43], v74
  s_waitcnt lgkmcnt(2)
  v_cvt_pk_bf16_f32 v32, v32, v33
  v_cvt_pk_bf16_f32 v33, v34, v35
  v_bfi_b32 v32, 1, s72, v32
  v_smfmac_f32_16x16x64_bf16 v[28:31], v[8:11], v[44:51], v74
  buffer_store_dwordx2 v[32:33], v68, s[8:11], s76 offen
  s_waitcnt lgkmcnt(0)
  v_smfmac_f32_16x16x64_bf16 v[28:31], v[12:15], v[60:67], v74
  ds_read_b128 v[52:55], v76 offset:14848
  ds_read_b64 v[16:17], v77 offset:392
  v_mov_b64 v[18:19], v[72:73]
  v_xor_b32 v75, 0x8000, v75
  s_nop 3
  v_cvt_pk_bf16_f32 v28, v28, v29
  v_cvt_pk_bf16_f32 v29, v30, v31
  v_bfi_b32 v28, 1, s72, v28
  buffer_store_dwordx2 v[28:29], v68, s[8:11], s77 offen
  v_mov_b64 v[20:21], 0
  v_mov_b64 v[22:23], 0
  v_mov_b64 v[24:25], 0
  v_mov_b64 v[26:27], 0
  v_mov_b64 v[28:29], 0
  v_mov_b64 v[30:31], 0
  v_mov_b64 v[32:33], 0
  v_mov_b64 v[34:35], 0
  v_mov_b32 v68, 14880
  s_add_u32 s58, s58, 655360
  s_add_u32 s59, s59, 655360
  s_add_u32 s70, s70, 655360
  s_add_u32 s68, s68, 655360
  s_add_u32 s66, s66, 1
  s_xor_b32 s64, s64, 16384
  s_xor_b32 s65, s65, 16384
  s_cmp_eq_u32 s66, 62
  s_cselect_b64 s[16:17], s[20:21], s[16:17]
  s_cselect_b32 s18, (Cf3_done - Cf3_last), s18
  s_cselect_b32 s70, 0, s70
  s_cmp_eq_u32 s66, 63
  s_cselect_b32 s59, 268435456, s59
  s_cselect_b32 s58, 268435456, s58
  s_nop 15
  s_nop 15
  s_nop 11
  buffer_load_dwordx4 v[0:3], v76, s[8:11], s60 offen offset:0 sc1
  buffer_load_dwordx4 v[4:7], v76, s[8:11], s60 offen offset:1024 sc1
  buffer_load_dwordx4 v[8:11], v76, s[8:11], s61 offen offset:0 sc1
  buffer_load_dwordx4 v[12:15], v76, s[8:11], s61 offen offset:1024 sc1
  s_waitcnt lgkmcnt(0)
  s_waitcnt vmcnt(3)
  v_mfma_f32_16x16x32_bf16 v[56:59], v[52:55], v[0:3], 0
  v_bitop3_b32 v72, v0, v2, s72 bitop3:0x7e
  s_waitcnt vmcnt(2)
  v_mfma_f32_16x16x32_bf16 v[56:59], v[52:55], v[4:7], v[56:59]
  v_bitop3_b32 v73, v4, v6, s72 bitop3:0x7e
  v_or_b32 v72, v72, v73
  s_waitcnt vmcnt(1)
  v_mfma_f32_16x16x32_bf16 v[36:39], v[52:55], v[8:11], 0
  v_bitop3_b32 v73, v8, v10, s72 bitop3:0x7e
  v_or_b32 v72, v72, v73
  s_waitcnt vmcnt(0)
  v_mfma_f32_16x16x32_bf16 v[36:39], v[52:55], v[12:15], v[36:39]
  v_bitop3_b32 v73, v12, v14, s72 bitop3:0x7e
  v_bitop3_b32 v72, v72, v73, 1 bitop3:0xa8
  v_cmp_ne_u32 vcc, 0, v72
  s_cbranch_vccnz Cf3_h1r
  buffer_load_dwordx4 v[4:7], v76, s[8:11], s65 offen offset:1024 sc1
  v_add_f32_dpp v56, v56, v56 row_ror:4 row_mask:0xf bank_mask:0xf
  v_add_f32_dpp v57, v57, v57 row_ror:4 row_mask:0xf bank_mask:0xf
  v_add_f32_dpp v36, v36, v36 row_ror:4 row_mask:0xf bank_mask:0xf
  v_add_f32_dpp v37, v37, v37 row_ror:4 row_mask:0xf bank_mask:0xf
  v_add_f32_dpp v56, v56, v56 row_ror:8 row_mask:0xf bank_mask:0xf
  v_add_f32_dpp v57, v57, v57 row_ror:8 row_mask:0xf bank_mask:0xf
  v_add_f32_dpp v36, v36, v36 row_ror:8 row_mask:0xf bank_mask:0xf
  v_add_f32_dpp v37, v37, v37 row_ror:8 row_mask:0xf bank_mask:0xf
  v_cvt_pk_bf16_f32 v56, v56, v57
  buffer_store_dword v56, v69, s[8:11], s62 offen
  v_cvt_pk_bf16_f32 v36, v36, v37
  buffer_store_dword v36, v70, s[8:11], s63 offen
  s_xor_b32 s62, s62, 16384
  buffer_store_dword v71, v69, s[8:11], s62 offen
  s_xor_b32 s63, s63, 16384
  buffer_store_dword v71, v70, s[8:11], s63 offen
  s_xor_b32 s72, s72, 1
  s_branch Cf3_h2
Cf3_h1r:
  s_mov_b64 exec, vcc
  buffer_load_dwordx4 v[0:3], v76, s[8:11], s60 offen offset:0 sc1
  buffer_load_dwordx4 v[4:7], v76, s[8:11], s60 offen offset:1024 sc1
  buffer_load_dwordx4 v[8:11], v76, s[8:11], s61 offen offset:0 sc1
  buffer_load_dwordx4 v[12:15], v76, s[8:11], s61 offen offset:1024 sc1
  s_mov_b64 exec, -1
  s_add_u32 s67, s67, 1
  s_waitcnt vmcnt(3)
  v_mfma_f32_16x16x32_bf16 v[56:59], v[52:55], v[0:3], 0
  v_bitop3_b32 v72, v0, v2, s72 bitop3:0x7e
  s_waitcnt vmcnt(2)
  v_mfma_f32_16x16x32_bf16 v[56:59], v[52:55], v[4:7], v[56:59]
  v_bitop3_b32 v73, v4, v6, s72 bitop3:0x7e
  v_or_b32 v72, v72, v73
  s_waitcnt vmcnt(1)
  v_mfma_f32_16x16x32_bf16 v[36:39], v[52:55], v[8:11], 0
  v_bitop3_b32 v73, v8, v10, s72 bitop3:0x7e
  v_or_b32 v72, v72, v73
  s_waitcnt vmcnt(0)
  v_mfma_f32_16x16x32_bf16 v[36:39], v[52:55], v[12:15], v[36:39]
  v_bitop3_b32 v73, v12, v14, s72 bitop3:0x7e
  v_bitop3_b32 v72, v72, v73, 1 bitop3:0xa8
  v_cmp_ne_u32 vcc, 0, v72
  s_cbranch_vccz Cf3_h1p
Cf3_h1s:
  s_mov_b64 exec, vcc
  buffer_load_dwordx4 v[0:3], v76, s[8:11], s60 offen offset:0 sc1
  buffer_load_dwordx4 v[4:7], v76, s[8:11], s60 offen offset:1024 sc1
  buffer_load_dwordx4 v[8:11], v76, s[8:11], s61 offen offset:0 sc1
  buffer_load_dwordx4 v[12:15], v76, s[8:11], s61 offen offset:1024 sc1
  s_mov_b64 exec, -1
  s_add_u32 s67, s67, 1
  s_waitcnt vmcnt(3)
  v_mfma_f32_16x16x32_bf16 v[56:59], v[52:55], v[0:3], 0
  v_bitop3_b32 v72, v0, v2, s72 bitop3:0x7e
  s_waitcnt vmcnt(2)
  v_mfma_f32_16x16x32_bf16 v[56:59], v[52:55], v[4:7], v[56:59]
  v_bitop3_b32 v73, v4, v6, s72 bitop3:0x7e
  v_or_b32 v72, v72, v73
  s_waitcnt vmcnt(1)
  v_mfma_f32_16x16x32_bf16 v[36:39], v[52:55], v[8:11], 0
  v_bitop3_b32 v73, v8, v10, s72 bitop3:0x7e
  v_or_b32 v72, v72, v73
  s_waitcnt vmcnt(0)
  v_mfma_f32_16x16x32_bf16 v[36:39], v[52:55], v[12:15], v[36:39]
  v_bitop3_b32 v73, v12, v14, s72 bitop3:0x7e
  v_bitop3_b32 v72, v72, v73, 1 bitop3:0xa8
  v_cmp_ne_u32 vcc, 0, v72
  s_cbranch_vccz Cf3_h1p
  s_cmp_lt_u32 s67, 131072
  s_cbranch_scc1 Cf3_h1s
Cf3_h1p:
  s_nop 2
  buffer_load_dwordx4 v[4:7], v76, s[8:11], s65 offen offset:1024 sc1
  v_add_f32_dpp v56, v56, v56 row_ror:4 row_mask:0xf bank_mask:0xf
  v_add_f32_dpp v57, v57, v57 row_ror:4 row_mask:0xf bank_mask:0xf
  v_add_f32_dpp v36, v36, v36 row_ror:4 row_mask:0xf bank_mask:0xf
  v_add_f32_dpp v37, v37, v37 row_ror:4 row_mask:0xf bank_mask:0xf
  v_add_f32_dpp v56, v56, v56 row_ror:8 row_mask:0xf bank_mask:0xf
  v_add_f32_dpp v57, v57, v57 row_ror:8 row_mask:0xf bank_mask:0xf
  v_add_f32_dpp v36, v36, v36 row_ror:8 row_mask:0xf bank_mask:0xf
  v_add_f32_dpp v37, v37, v37 row_ror:8 row_mask:0xf bank_mask:0xf
  v_cvt_pk_bf16_f32 v56, v56, v57
  buffer_store_dword v56, v69, s[8:11], s62 offen
  v_cvt_pk_bf16_f32 v36, v36, v37
  buffer_store_dword v36, v70, s[8:11], s63 offen
  s_xor_b32 s62, s62, 16384
  buffer_store_dword v71, v69, s[8:11], s62 offen
  s_xor_b32 s63, s63, 16384
  buffer_store_dword v71, v70, s[8:11], s63 offen
  s_xor_b32 s72, s72, 1
  s_branch Cf3_h2
Cf3_h2r:
  s_mov_b64 exec, vcc
  buffer_load_dwordx4 v[4:7], v76, s[8:11], s65 offen offset:1024 sc1
  s_mov_b64 exec, -1
  s_add_u32 s67, s67, 1
  s_waitcnt vmcnt(3)
  v_max3_u32 v72, v4, v5, v6
  v_max_u32 v72, v72, v7
  ds_write_b128 v76, v[4:7] offset:5632
  v_cmp_eq_u32 vcc, -1, v72
  s_cbranch_vccz Cf3_h2w
Cf3_h2s:
  s_mov_b64 exec, vcc
  buffer_load_dwordx4 v[4:7], v76, s[8:11], s65 offen offset:1024 sc1
  s_mov_b64 exec, -1
  s_add_u32 s67, s67, 1
  s_waitcnt vmcnt(1)
  v_max3_u32 v72, v4, v5, v6
  v_max_u32 v72, v72, v7
  ds_write_b128 v76, v[4:7] offset:5632
  v_cmp_eq_u32 vcc, -1, v72
  s_cbranch_vccz Cf3_h2w
  s_mov_b64 exec, vcc
  buffer_load_dwordx4 v[4:7], v76, s[8:11], s65 offen offset:1024 sc1
  s_mov_b64 exec, -1
  s_add_u32 s67, s67, 1
  s_waitcnt vmcnt(1)
  v_max3_u32 v72, v4, v5, v6
  v_max_u32 v72, v72, v7
  ds_write_b128 v76, v[4:7] offset:5632
  v_cmp_eq_u32 vcc, -1, v72
  s_cbranch_vccz Cf3_h2w
  s_mov_b64 exec, vcc
  buffer_load_dwordx4 v[4:7], v76, s[8:11], s65 offen offset:1024 sc1
  s_mov_b64 exec, -1
  s_add_u32 s67, s67, 1
  s_waitcnt vmcnt(1)
  v_max3_u32 v72, v4, v5, v6
  v_max_u32 v72, v72, v7
  ds_write_b128 v76, v[4:7] offset:5632
  v_cmp_eq_u32 vcc, -1, v72
  s_cbranch_vccz Cf3_h2w
  s_cmp_lt_u32 s67, 131072
  s_cbranch_scc1 Cf3_h2s
  s_branch Cf3_h2w
Cf3_rec:
  s_nop 7
  s_waitcnt vmcnt(0) lgkmcnt(0)
  v_max3_u32 v72, v0, v1, v2
  v_max3_u32 v72, v72, v3, v4
  v_max3_u32 v72, v72, v5, v6
  v_max3_u32 v72, v72, v7, v8
  v_max3_u32 v72, v72, v9, v10
  v_max3_u32 v72, v72, v11, v12
  v_max3_u32 v72, v72, v13, v14
  v_max3_u32 v72, v72, v15, v16
  v_max3_u32 v72, v72, v17, v18
  v_max_u32 v72, v72, v19
  v_cmp_eq_u32 vcc, -1, v72
  s_cbranch_vccz Cf3_recok
  s_barrier
Cf3_recp:
  buffer_load_dwordx4 v[0:3], v76, s[8:11], s64 offen offset:0 sc1
  buffer_load_dwordx4 v[4:7], v76, s[8:11], s64 offen offset:1024 sc1
  buffer_load_dwordx4 v[8:11], v76, s[8:11], s64 offen offset:2048 sc1
  s_add_u32 s67, s67, 1
  s_cmp_lt_u32 s67, 131072
  s_cselect_b32 s54, -2, -1
  s_waitcnt vmcnt(2)
  v_max3_u32 v72, v0, v1, v2
  s_waitcnt vmcnt(1)
  v_max3_u32 v72, v72, v3, v4
  v_max3_u32 v72, v72, v5, v6
  s_waitcnt vmcnt(0)
  v_max3_u32 v72, v72, v7, v8
  v_max3_u32 v72, v72, v9, v10
  v_max_u32 v72, v72, v11
  v_cmp_lt_u32 vcc, s54, v72
  s_cbranch_vccnz Cf3_recp
  ds_write_b128 v76, v[0:3] offset:10752
  ds_write_b128 v76, v[4:7] offset:11776
  ds_write_b128 v76, v[8:11] offset:12800
  v_mov_b64 v[20:21], 0
  v_mov_b64 v[22:23], 0
  v_mov_b64 v[24:25], 0
  v_mov_b64 v[26:27], 0
  v_mov_b64 v[28:29], 0
  v_mov_b64 v[30:31], 0
  v_mov_b64 v[32:33], 0
  v_mov_b64 v[34:35], 0
  s_waitcnt lgkmcnt(0)
  s_barrier
  ds_read_b128 v[0:3], v76 offset:4608
  s_waitcnt lgkmcnt(0)
  v_smfmac_f32_16x16x64_bf16 v[20:23], v[0:3], v[80:87], v74
  v_smfmac_f32_16x16x64_bf16 v[24:27], v[0:3], v[88:95], v74
  ds_read_b128 v[60:63], v76 offset:28672
  ds_read_b128 v[64:67], v76 offset:29696
  s_waitcnt lgkmcnt(0)
  v_smfmac_f32_16x16x64_bf16 v[28:31], v[0:3], v[60:67], v74
  ds_read_b128 v[60:63], v76 offset:30720
  ds_read_b128 v[64:67], v76 offset:31744
  s_waitcnt lgkmcnt(0)
  v_smfmac_f32_16x16x64_bf16 v[32:35], v[0:3], v[60:67], v74
  ds_read_b128 v[4:7], v76 offset:5632
  s_waitcnt lgkmcnt(0)
  v_smfmac_f32_16x16x64_bf16 v[20:23], v[4:7], v[96:103], v74
  v_smfmac_f32_16x16x64_bf16 v[24:27], v[4:7], v[104:111], v74
  ds_read_b128 v[60:63], v76 offset:45056
  ds_read_b128 v[64:67], v76 offset:46080
  s_waitcnt lgkmcnt(0)
  v_smfmac_f32_16x16x64_bf16 v[28:31], v[4:7], v[60:67], v74
  ds_read_b128 v[60:63], v76 offset:47104
  ds_read_b128 v[64:67], v76 offset:48128
  s_waitcnt lgkmcnt(0)
  v_smfmac_f32_16x16x64_bf16 v[32:35], v[4:7], v[60:67], v74
  ds_read_b128 v[8:11], v76 offset:6656
  s_waitcnt lgkmcnt(0)
  v_smfmac_f32_16x16x64_bf16 v[20:23], v[8:11], v[112:119], v74
  v_smfmac_f32_16x16x64_bf16 v[24:27], v[8:11], v[120:127], v74
  v_smfmac_f32_16x16x64_bf16 v[28:31], v[8:11], v[208:215], v74
  v_smfmac_f32_16x16x64_bf16 v[32:35], v[8:11], v[216:223], v74
  ds_read_b128 v[12:15], v76 offset:7680
  s_waitcnt lgkmcnt(0)
  v_smfmac_f32_16x16x64_bf16 v[20:23], v[12:15], v[128:135], v74
  v_smfmac_f32_16x16x64_bf16 v[24:27], v[12:15], v[136:143], v74
  v_smfmac_f32_16x16x64_bf16 v[28:31], v[12:15], v[224:231], v74
  v_smfmac_f32_16x16x64_bf16 v[32:35], v[12:15], v[232:239], v74
  ds_read_b128 v[4:7], v76 offset:8704
  s_waitcnt lgkmcnt(0)
  v_smfmac_f32_16x16x64_bf16 v[20:23], v[4:7], v[144:151], v74
  v_smfmac_f32_16x16x64_bf16 v[24:27], v[4:7], v[152:159], v74
  ds_read_b128 v[60:63], v76 offset:61440
  ds_read_b128 v[64:67], v76 offset:62464
  s_waitcnt lgkmcnt(0)
  v_smfmac_f32_16x16x64_bf16 v[28:31], v[4:7], v[60:67], v74
  ds_read_b128 v[60:63], v76 offset:63488
  ds_read_b128 v[64:67], v76 offset:64512
  s_waitcnt lgkmcnt(0)
  v_smfmac_f32_16x16x64_bf16 v[32:35], v[4:7], v[60:67], v74
  ds_read_b128 v[8:11], v76 offset:9728
  s_waitcnt lgkmcnt(0)
  v_smfmac_f32_16x16x64_bf16 v[20:23], v[8:11], v[160:167], v74
  v_smfmac_f32_16x16x64_bf16 v[24:27], v[8:11], v[168:175], v74
  ds_read_b128 v[60:63], v75 offset:28672
  ds_read_b128 v[64:67], v75 offset:29696
  s_waitcnt lgkmcnt(0)
  v_smfmac_f32_16x16x64_bf16 v[28:31], v[8:11], v[60:67], v74
  ds_read_b128 v[60:63], v75 offset:30720
  ds_read_b128 v[64:67], v75 offset:31744
  s_waitcnt lgkmcnt(0)
  v_smfmac_f32_16x16x64_bf16 v[32:35], v[8:11], v[60:67], v74
  ds_read_b128 v[16:19], v76 offset:10752
  ds_read_b128 v[60:63], v75 offset:12288
  ds_read_b128 v[64:67], v75 offset:13312
  s_waitcnt lgkmcnt(0)
  v_smfmac_f32_16x16x64_bf16 v[20:23], v[16:19], v[60:67], v74
  ds_read_b128 v[60:63], v75 offset:14336
  ds_read_b128 v[64:67], v75 offset:15360
  s_waitcnt lgkmcnt(0)
  v_smfmac_f32_16x16x64_bf16 v[24:27], v[16:19], v[60:67], v74
  v_smfmac_f32_16x16x64_bf16 v[28:31], v[16:19], v[240:247], v74
  v_smfmac_f32_16x16x64_bf16 v[32:35], v[16:19], v[248:255], v74
  ds_read_b128 v[0:3], v76 offset:11776
  s_waitcnt lgkmcnt(0)
  v_smfmac_f32_16x16x64_bf16 v[20:23], v[0:3], v[176:183], v74
  v_smfmac_f32_16x16x64_bf16 v[24:27], v[0:3], v[184:191], v74
  v_smfmac_f32_16x16x64_bf16 v[28:31], v[0:3], a[0:7], v74
  v_smfmac_f32_16x16x64_bf16 v[32:35], v[0:3], a[8:15], v74
  ds_read_b128 v[12:15], v76 offset:12800
  s_waitcnt lgkmcnt(0)
  v_smfmac_f32_16x16x64_bf16 v[20:23], v[12:15], v[192:199], v74
  v_smfmac_f32_16x16x64_bf16 v[24:27], v[12:15], v[200:207], v74
  v_smfmac_f32_16x16x64_bf16 v[28:31], v[12:15], a[16:23], v74
  v_smfmac_f32_16x16x64_bf16 v[32:35], v[12:15], a[24:31], v74
  v_add_f32 v20, v20, v22
  v_add_f32 v21, v21, v23
  v_add_f32 v24, v24, v26
  v_cvt_pk_bf16_f32 v22, v20, v24
  ds_write_b32 v79, v22 offset:0
  v_add_f32 v25, v25, v27
  v_cvt_pk_bf16_f32 v23, v21, v25
  ds_write_b32 v79, v23 offset:576
  v_add_f32 v28, v28, v30
  v_add_f32 v29, v29, v31
  s_waitcnt lgkmcnt(0)
  s_nop 1
  s_branch Cf3_recok
Cf3_mx:
  s_waitcnt lgkmcnt(0)
  s_barrier
  buffer_load_dwordx4 v[0:3], v76, s[8:11], s58 offen offset:0 sc1
  ds_read_b128 v[20:23], v77 offset:0
  ds_read_b128 v[28:31], v77 offset:256
  buffer_load_dwordx4 v[4:7], v76, s[8:11], s58 offen offset:1024 sc1
  ds_read_b128 v[24:27], v77 offset:128
  ds_read_b128 v[32:35], v77 offset:384
  s_waitcnt vmcnt(1) lgkmcnt(3)
  v_mfma_f32_16x16x32_bf16 v[8:11], v[0:3], v[20:23], 0
  s_waitcnt vmcnt(0) lgkmcnt(1)
  v_mfma_f32_16x16x32_bf16 v[8:11], v[4:7], v[24:27], v[8:11]
  v_mfma_f32_16x16x32_bf16 v[12:15], v[28:31], v[20:23], 0
  s_waitcnt lgkmcnt(0)
  v_mfma_f32_16x16x32_bf16 v[12:15], v[32:35], v[24:27], v[12:15]
  v_add_f32_dpp v8, v10, v8 quad_perm:[2,3,0,1] row_mask:0xf bank_mask:0xf
  v_add_f32_dpp v9, v11, v9 quad_perm:[2,3,0,1] row_mask:0xf bank_mask:0xf
  s_nop 0
  v_mov_b32_dpp v8, v8 quad_perm:[0,1,0,1] row_mask:0xf bank_mask:0xf
  v_mov_b32_dpp v9, v9 quad_perm:[0,1,0,1] row_mask:0xf bank_mask:0xf
  s_nop 1
  v_add_f32_dpp v12, v14, v12 quad_perm:[2,3,0,1] row_mask:0xf bank_mask:0xf
  v_add_f32_dpp v13, v15, v13 quad_perm:[2,3,0,1] row_mask:0xf bank_mask:0xf
  s_nop 0
  v_mov_b32_dpp v12, v12 quad_perm:[0,1,0,1] row_mask:0xf bank_mask:0xf
  v_mov_b32_dpp v13, v13 quad_perm:[0,1,0,1] row_mask:0xf bank_mask:0xf
  v_mul_f32 v12, s69, v12
  ds_write_b32 v78, v8 offset:8716
  v_mul_f32 v13, s69, v13
  ds_write_b32 v78, v9 offset:8780
  s_waitcnt lgkmcnt(0)
  s_barrier
  ds_read_b128 v[36:39], v78 offset:8704
  ds_read_b128 v[40:43], v78 offset:8768
  s_waitcnt lgkmcnt(0)
  s_barrier
  v_max_f32 v16, v36, v37
  v_max3_f32 v16, v16, v38, v39
  v_max3_f32 v16, v16, v40, v41
  v_max3_f32 v16, v16, v42, v43
  v_max3_f32 v16, v16, v12, v13
  v_mov_b32 v17, v16
  s_nop 1
  v_permlane16_swap_b32 v16, v17
  v_max_f32 v16, v16, v17
  v_mov_b32 v17, v16
  s_nop 1
  v_permlane32_swap_b32 v16, v17
  v_max_f32 v16, v16, v17
  v_sub_f32 v36, v36, v16
  v_sub_f32 v37, v37, v16
  v_sub_f32 v38, v38, v16
  v_sub_f32 v39, v39, v16
  v_sub_f32 v40, v40, v16
  v_sub_f32 v41, v41, v16
  v_sub_f32 v42, v42, v16
  v_sub_f32 v43, v43, v16
  v_sub_f32 v12, v12, v16
  v_sub_f32 v13, v13, v16
  v_exp_f32 v36, v36
  v_exp_f32 v37, v37
  v_exp_f32 v38, v38
  v_exp_f32 v39, v39
  v_exp_f32 v40, v40
  v_exp_f32 v41, v41
  v_exp_f32 v42, v42
  v_exp_f32 v43, v43
  v_exp_f32 v12, v12
  v_exp_f32 v13, v13
  v_cvt_pk_bf16_f32 v32, v36, v40
  v_cvt_pk_bf16_f32 v33, v37, v41
  v_cvt_pk_bf16_f32 v34, v38, v42
  v_cvt_pk_bf16_f32 v35, v39, v43
  v_cvt_pk_bf16_f32 v28, v12, v13
  v_cvt_pk_bf16_f32 v31, v12, v13
  v_mov_b32 v29, 0
  v_mov_b32 v30, 0
  v_mov_b32 v68, 0x3f803f80
  v_mov_b32 v69, 0x3f803f80
  v_mov_b32 v70, 0x3f803f80
  v_mov_b32 v71, 0x3f803f80
  s_nop 1
  v_mfma_f32_16x16x32_bf16 v[8:11], v[32:35], v[68:71], 0
  v_mfma_f32_16x16x32_bf16 v[0:3], v[32:35], v[52:55], 0
  v_mfma_f32_16x16x32_bf16 v[4:7], v[32:35], v[56:59], 0
  v_mfma_f32_16x16x16_bf16 v[8:11], v[28:29], v[68:69], v[8:11]
  v_mfma_f32_16x16x16_bf16 v[0:3], v[28:29], v[72:73], v[0:3]
  v_mfma_f32_16x16x16_bf16 v[4:7], v[30:31], v[72:73], v[4:7]
  ds_read_b128 v[68:71], v76 offset:13824
  v_rcp_f32 v10, v8
  v_rcp_f32 v11, v9
  v_mul_f32 v0, v10, v0
  v_mul_f32 v1, v11, v1
  s_nop 0
  v_mul_f32 v4, v10, v4
  v_mul_f32 v5, v11, v5
  v_cvt_pk_bf16_f32 v2, v0, v4
  ds_write_b32 v79, v2 offset:8704
  v_cvt_pk_bf16_f32 v3, v1, v5
  ds_write_b32 v79, v3 offset:9280
  v_mov_b64 v[16:17], 0
  v_mov_b64 v[18:19], 0
  v_mov_b64 v[20:21], 0
  v_mov_b64 v[22:23], 0
  v_mov_b64 v[24:25], 0
  v_mov_b64 v[26:27], 0
  s_branch Cf3_mxok
Cf3_last:
  ds_read_b128 v[0:3], v76 offset:4608
  ds_read_b128 v[12:15], v76 offset:7680
  ds_read_b128 v[44:47], v76 offset:28672
  ds_read_b128 v[48:51], v76 offset:29696
  s_nop 5
  v_mov_b64 v[20:21], 0
  v_mov_b64 v[22:23], 0
  v_mov_b64 v[24:25], 0
  v_mov_b64 v[26:27], 0
  v_smfmac_f32_16x16x64_bf16 v[28:31], v[4:7], v[36:43], v74
  ds_read_b128 v[36:39], v76 offset:30720
  ds_read_b128 v[40:43], v76 offset:31744
  v_smfmac_f32_16x16x64_bf16 v[32:35], v[4:7], v[60:67], v74
  s_waitcnt lgkmcnt(5)
  v_smfmac_f32_16x16x64_bf16 v[20:23], v[0:3], a[32:39], v74
  ds_read_b128 v[60:63], v76 offset:61440
  ds_read_b128 v[64:67], v76 offset:62464
  v_smfmac_f32_16x16x64_bf16 v[24:27], v[0:3], a[40:47], v74
  s_waitcnt lgkmcnt(4)
  v_smfmac_f32_16x16x64_bf16 v[20:23], v[4:7], a[48:55], v74
  buffer_store_dwordx4 v[16:19], v76, s[8:11], s68 offen sc1
  v_smfmac_f32_16x16x64_bf16 v[24:27], v[4:7], a[56:63], v74
  v_smfmac_f32_16x16x64_bf16 v[28:31], v[0:3], v[44:51], v74
  s_waitcnt lgkmcnt(2)
  v_smfmac_f32_16x16x64_bf16 v[20:23], v[8:11], a[64:71], v74
  ds_read_b128 v[44:47], v76 offset:63488
  ds_read_b128 v[48:51], v76 offset:64512
  v_smfmac_f32_16x16x64_bf16 v[24:27], v[8:11], a[72:79], v74
  v_smfmac_f32_16x16x64_bf16 v[32:35], v[0:3], v[36:43], v74
  v_smfmac_f32_16x16x64_bf16 v[28:31], v[8:11], v[208:215], v74
  ds_read_b128 v[36:39], v75 offset:28672
  ds_read_b128 v[40:43], v75 offset:29696
  v_smfmac_f32_16x16x64_bf16 v[32:35], v[8:11], v[216:223], v74
  v_smfmac_f32_16x16x64_bf16 v[20:23], v[12:15], a[80:87], v74
  v_smfmac_f32_16x16x64_bf16 v[24:27], v[12:15], a[88:95], v74
  v_smfmac_f32_16x16x64_bf16 v[28:31], v[12:15], v[224:231], v74
  v_smfmac_f32_16x16x64_bf16 v[32:35], v[12:15], v[232:239], v74
  s_waitcnt vmcnt(1)
  s_barrier
Cf3_lastr:
  ds_read_b128 v[4:7], v76 offset:8704
  ds_read_b128 v[8:11], v76 offset:9728
  ds_read_b128 v[16:19], v76 offset:10752
  ds_read_b128 v[0:3], v76 offset:11776
  ds_read_b128 v[12:15], v76 offset:12800
  s_waitcnt lgkmcnt(1)
  v_max3_u32 v72, v0, v1, v2
  v_max3_u32 v72, v72, v3, v4
  v_max3_u32 v72, v72, v5, v6
  v_max3_u32 v72, v72, v7, v8
  v_max3_u32 v72, v72, v9, v10
  s_waitcnt lgkmcnt(0)
  v_max3_u32 v72, v72, v11, v12
  v_max3_u32 v72, v72, v13, v14
  v_max3_u32 v72, v72, v15, v16
  v_max3_u32 v72, v72, v17, v18
  v_max_u32 v72, v72, v19
  v_cmp_eq_u32 vcc, -1, v72
  s_cbranch_vccnz Cf3_lastp
Cf3_lastg:
  v_smfmac_f32_16x16x64_bf16 v[28:31], v[4:7], v[60:67], v74
  ds_read_b128 v[60:63], v75 offset:30720
  ds_read_b128 v[64:67], v75 offset:31744
  v_smfmac_f32_16x16x64_bf16 v[32:35], v[4:7], v[44:51], v74
  v_smfmac_f32_16x16x64_bf16 v[28:31], v[8:11], v[36:43], v74
  v_smfmac_f32_16x16x64_bf16 v[28:31], v[16:19], v[240:247], v74
  v_smfmac_f32_16x16x64_bf16 v[28:31], v[0:3], a[0:7], v74
  v_smfmac_f32_16x16x64_bf16 v[28:31], v[12:15], a[16:23], v74
  v_smfmac_f32_16x16x64_bf16 v[32:35], v[16:19], v[248:255], v74
  v_smfmac_f32_16x16x64_bf16 v[32:35], v[0:3], a[8:15], v74
  s_waitcnt lgkmcnt(0)
  v_smfmac_f32_16x16x64_bf16 v[32:35], v[12:15], a[24:31], v74
  v_smfmac_f32_16x16x64_bf16 v[32:35], v[8:11], v[60:67], v74
  v_smfmac_f32_16x16x64_bf16 v[20:23], v[4:7], a[96:103], v74
  v_smfmac_f32_16x16x64_bf16 v[20:23], v[8:11], a[112:119], v74
  v_add_f32 v28, v28, v30
  v_add_f32 v32, v32, v34
  v_cvt_pk_bf16_f32 v30, v28, v32
  v_smfmac_f32_16x16x64_bf16 v[20:23], v[16:19], a[128:135], v74
  ds_write_b32 v79, v30 offset:256
  v_add_f32 v29, v29, v31
  v_add_f32 v33, v33, v35
  v_cvt_pk_bf16_f32 v31, v29, v33
  v_smfmac_f32_16x16x64_bf16 v[20:23], v[0:3], a[144:151], v74
  ds_write_b32 v79, v31 offset:832
  v_smfmac_f32_16x16x64_bf16 v[20:23], v[12:15], a[160:167], v74
  v_smfmac_f32_16x16x64_bf16 v[24:27], v[4:7], a[104:111], v74
  v_smfmac_f32_16x16x64_bf16 v[24:27], v[8:11], a[120:127], v74
  v_smfmac_f32_16x16x64_bf16 v[24:27], v[16:19], a[136:143], v74
  s_waitcnt lgkmcnt(0)
  s_barrier
  ds_read_b64 v[52:53], v77 offset:392
  v_add_f32 v20, v20, v22
  v_smfmac_f32_16x16x64_bf16 v[24:27], v[0:3], a[152:159], v74
  v_add_f32 v21, v21, v23
  v_smfmac_f32_16x16x64_bf16 v[24:27], v[12:15], a[168:175], v74
  v_cvt_pk_bf16_f32 v54, v20, v21
  s_add_u32 s68, s68, 655360
  s_nop 3
  v_add_f32 v24, v24, v26
  v_add_f32 v25, v25, v27
  v_cvt_pk_bf16_f32 v55, v24, v25
  s_waitcnt lgkmcnt(0)
  buffer_store_dwordx4 v[52:55], v76, s[8:11], s68 offen sc1
  s_branch Cf3_done
Cf3_lastp:
  s_add_u32 s72, s72, 2
  s_cmp_ge_u32 s72, 131072
  s_cbranch_scc1 Cf3_lastg
  s_barrier
  buffer_load_dwordx4 v76, s[8:11], s55 offen offset:0 sc1 lds
  buffer_load_dwordx4 v76, s[8:11], s55 offen offset:1024 sc1 lds
  s_waitcnt vmcnt(0)
  s_barrier
  s_branch Cf3_lastr
Cf3_done:
  s_branch L_cexit
L_w4:
  v_mov_b64 v[20:21], 0
  v_mov_b64 v[22:23], 0
  v_mov_b64 v[24:25], 0
  v_mov_b64 v[26:27], 0
  v_mov_b64 v[28:29], 0
  v_mov_b64 v[30:31], 0
  v_mov_b64 v[32:33], 0
  v_mov_b64 v[34:35], 0
  s_mov_b32 s78, 0x3f803f80
  s_mov_b32 s79, s78
  s_mov_b32 s65, 360448
  s_mov_b32 m0, 16128
  s_lshl_b32 s71, s53, 2
  s_add_u32 s71, s71, 128
  s_movk_i32 s56, 0x1000
  v_lshlrev_b32 v73, 2, v76
  v_mov_b32 v72, 0
  s_mov_b64 s[16:17], s[8:9]
  s_mov_b32 s18, 268435456
  s_mov_b32 s19, 0x20000
  s_getpc_b64 s[20:21]
Cs0_pc:
  s_add_u32 s20, s20, (Cs0_last - Cs0_pc)
  s_addc_u32 s21, s21, 0
  v_mov_b32 v68, 14880
  buffer_load_dwordx4 v[52:55], v76, s[8:11], s59 offen offset:0 sc1
  buffer_load_dwordx4 v[56:59], v76, s[8:11], s59 offen offset:1024 sc1
  ds_read_b128 v[36:39], v76 offset:16384
  ds_read_b128 v[40:43], v76 offset:17408
  ds_read_b128 v[60:63], v76 offset:18432
  ds_read_b128 v[64:67], v76 offset:19456
  ds_read_b128 v[0:3], v76 offset:4608
  ds_read_b128 v[4:7], v76 offset:5632
  ds_read_b128 v[8:11], v76 offset:6656
  ds_read_b128 v[12:15], v76 offset:7680
  s_waitcnt lgkmcnt(0)
  s_cmp_eq_u32 s66, 1
  s_branch Cs0_top2
.p2align 6
Cs0_h2:
  v_lshlrev_b32 v73, 2, v76
  s_mov_b32 m0, 10752
  s_add_u32 s55, s65, 6144
  s_cmp_eq_u32 s66, 12
  s_cselect_b32 s56, s71, 0x1000
  ds_read_b32 v72, v76 offset:16128
  s_cmp_eq_u32 s66, 13
  s_cselect_b32 s54, 0x700, 0
  s_waitcnt lgkmcnt(0)
  v_readfirstlane_b32 s57, v72
  s_nop 0
  s_cmp_lt_u32 s57, s54
  s_cbranch_scc1 Cs0_kv3
Cs0_kvb:
  s_nop 1
  buffer_load_dwordx4 v[0:3], v76, s[8:11], s65 offen offset:0 sc1
  s_nop 15
  s_nop 3
  buffer_load_dwordx4 v[0:3], v76, s[8:11], s65 offen offset:0 sc1
  s_nop 15
  s_nop 3
  buffer_load_dwordx4 v[0:3], v76, s[8:11], s65 offen offset:0 sc1
  s_waitcnt vmcnt(5)
  ds_read_b128 v[36:39], v76 offset:16384
  ds_read_b128 v[40:43], v76 offset:17408
  ds_read_b128 v[60:63], v76 offset:18432
  ds_read_b128 v[64:67], v76 offset:19456
  buffer_load_dwordx4 v[52:55], v76, s[8:11], s59 offen offset:0 sc1
  buffer_load_dwordx4 v[56:59], v76, s[8:11], s59 offen offset:1024 sc1
  s_waitcnt vmcnt(4)
  v_max3_u32 v72, v0, v1, v2
  v_max_u32 v72, v72, v3
  ds_write_b128 v76, v[0:3] offset:4608
  v_cmp_eq_u32 vcc, -1, v72
  s_cbranch_vccnz Cs0_h2r
Cs0_h2w:
  s_cmp_eq_u32 s66, 63
  s_waitcnt lgkmcnt(0)
  s_barrier
  ds_read_b128 v[8:11], v76 offset:6656
  buffer_load_dwordx4 v76, s[8:11], s55 offen offset:0 sc1 lds
Cs0_top2:
  v_smfmac_f32_16x16x64_bf16 v[20:23], v[0:3], v[80:87], v74
  s_cbranch_scc1 Cs0_last
  v_smfmac_f32_16x16x64_bf16 v[28:31], v[0:3], v[36:43], v74
  buffer_load_dwordx4 v[44:47], v76, s[8:11], s58 offen offset:0 sc1
  s_mov_b32 m0, 16128
  v_smfmac_f32_16x16x64_bf16 v[24:27], v[0:3], v[88:95], v74
  buffer_load_dwordx4 v[48:51], v76, s[8:11], s58 offen offset:1024 sc1
  v_smfmac_f32_16x16x64_bf16 v[32:35], v[0:3], v[60:67], v74
  ds_read_b128 v[4:7], v76 offset:5632
  s_waitcnt lgkmcnt(1)
  v_smfmac_f32_16x16x64_bf16 v[20:23], v[8:11], v[112:119], v74
  ds_read_b128 v[12:15], v76 offset:7680
  v_smfmac_f32_16x16x64_bf16 v[24:27], v[8:11], v[120:127], v74
  ds_read_b128 v[36:39], v76 offset:32768
  v_smfmac_f32_16x16x64_bf16 v[28:31], v[8:11], v[208:215], v74
  buffer_store_dwordx4 v[16:19], v76, s[8:11], s68 offen sc1
  ds_read_b128 v[40:43], v76 offset:33792
  v_smfmac_f32_16x16x64_bf16 v[32:35], v[8:11], v[216:223], v74
  ds_read_b128 v[60:63], v76 offset:34816
  s_waitcnt lgkmcnt(4)
  v_smfmac_f32_16x16x64_bf16 v[20:23], v[4:7], v[96:103], v74
  ds_read_b128 v[64:67], v76 offset:35840
  v_smfmac_f32_16x16x64_bf16 v[24:27], v[4:7], v[104:111], v74
  buffer_load_dword v73, s[16:19], s70 offen lds
  s_waitcnt vmcnt(5)
  s_waitcnt lgkmcnt(4)
  v_smfmac_f32_16x16x64_bf16 v[20:23], v[12:15], v[128:135], v74
  s_barrier
  s_waitcnt lgkmcnt(2)
  v_smfmac_f32_16x16x64_bf16 v[28:31], v[4:7], v[36:43], v74
  ds_read_b128 v[0:3], v76 offset:8704
  v_smfmac_f32_16x16x64_bf16 v[24:27], v[12:15], v[136:143], v74
  ds_read_b128 v[36:39], v76 offset:49152
  s_waitcnt lgkmcnt(2)
  v_smfmac_f32_16x16x64_bf16 v[32:35], v[4:7], v[60:67], v74
  ds_read_b128 v[40:43], v76 offset:50176
  v_smfmac_f32_16x16x64_bf16 v[28:31], v[12:15], v[224:231], v74
  ds_read_b128 v[60:63], v76 offset:51200
  v_smfmac_f32_16x16x64_bf16 v[32:35], v[12:15], v[232:239], v74
  ds_read_b128 v[64:67], v76 offset:52224
  s_waitcnt lgkmcnt(4)
  v_smfmac_f32_16x16x64_bf16 v[20:23], v[0:3], v[144:151], v74
  s_waitcnt vmcnt(4)
  ds_read_b128 v[8:11], v76 offset:9728
  s_waitcnt lgkmcnt(3)
  v_smfmac_f32_16x16x64_bf16 v[28:31], v[0:3], v[36:43], v74
  s_barrier
  ds_read_b128 v[4:7], v76 offset:11776
  v_smfmac_f32_16x16x64_bf16 v[24:27], v[0:3], v[152:159], v74
  ds_read_b128 v[36:39], v75 offset:0
  ds_read_b128 v[40:43], v75 offset:1024
  s_waitcnt lgkmcnt(4)
  v_smfmac_f32_16x16x64_bf16 v[32:35], v[0:3], v[60:67], v74
  ds_read_b128 v[16:19], v76 offset:10752
  s_waitcnt lgkmcnt(4)
  v_smfmac_f32_16x16x64_bf16 v[20:23], v[8:11], v[160:167], v74
  ds_read_b128 v[12:15], v76 offset:12800
  v_smfmac_f32_16x16x64_bf16 v[24:27], v[8:11], v[168:175], v74
  ds_read_b128 v[60:63], v75 offset:2048
  ds_read_b128 v[64:67], v75 offset:3072
  s_waitcnt lgkmcnt(6)
  v_smfmac_f32_16x16x64_bf16 v[20:23], v[4:7], v[176:183], v74
  s_waitcnt lgkmcnt(3)
  v_smfmac_f32_16x16x64_bf16 v[20:23], v[16:19], v[36:43], v74
  ds_read_b128 v[36:39], v75 offset:16384
  s_waitcnt lgkmcnt(3)
  v_smfmac_f32_16x16x64_bf16 v[20:23], v[12:15], v[192:199], v74
  ds_read_b128 v[40:43], v75 offset:17408
  s_waitcnt lgkmcnt(2)
  v_smfmac_f32_16x16x64_bf16 v[24:27], v[16:19], v[60:67], v74
  ds_read_b128 v[60:63], v75 offset:18432
  v_smfmac_f32_16x16x64_bf16 v[24:27], v[4:7], v[184:191], v74
  ds_read_b128 v[64:67], v75 offset:19456
  v_add_f32 v20, v20, v22
  v_smfmac_f32_16x16x64_bf16 v[24:27], v[12:15], v[200:207], v74
  buffer_load_dword off, s[12:15], s56 sc1 lds
  v_add_f32 v21, v21, v23
  v_smfmac_f32_16x16x64_bf16 v[28:31], v[16:19], v[240:247], v74
  s_waitcnt lgkmcnt(2)
  v_mov_b64 v[70:71], s[78:79]
  v_smfmac_f32_16x16x64_bf16 v[28:31], v[8:11], v[36:43], v74
  ds_read_b128 v[36:39], v68
  v_add_f32 v24, v24, v26
  v_smfmac_f32_16x16x64_bf16 v[28:31], v[4:7], a[0:7], v74
  ds_read_b128 v[40:43], v68
  v_cvt_pk_bf16_f32 v22, v20, v24
  v_smfmac_f32_16x16x64_bf16 v[28:31], v[12:15], a[16:23], v74
  ds_write_b32 v79, v22 offset:0
  s_waitcnt lgkmcnt(3)
  v_add_f32 v25, v25, v27
  v_cvt_pk_bf16_f32 v23, v21, v25
  v_smfmac_f32_16x16x64_bf16 v[32:35], v[8:11], v[60:67], v74
  ds_write_b32 v79, v23 offset:576
  v_cmp_u_f32 vcc, v20, v21
  v_smfmac_f32_16x16x64_bf16 v[32:35], v[16:19], v[248:255], v74
  v_add_f32 v28, v28, v30
  v_smfmac_f32_16x16x64_bf16 v[32:35], v[4:7], a[8:15], v74
  v_add_f32 v29, v29, v31
  v_smfmac_f32_16x16x64_bf16 v[32:35], v[12:15], a[24:31], v74
  s_cbranch_vccnz Cs0_rec
Cs0_recok:
  s_waitcnt lgkmcnt(3)
  v_smfmac_f32_16x16x64_bf16 v[36:39], v[16:19], a[128:135], v74
  s_waitcnt lgkmcnt(0)
  s_barrier
  ds_read_b128 v[60:63], v77
  v_smfmac_f32_16x16x64_bf16 v[40:43], v[16:19], a[136:143], v74
  ds_read_b128 v[64:67], v77 offset:128
  v_add_f32 v32, v32, v34
  v_cvt_pk_bf16_f32 v30, v28, v32
  v_smfmac_f32_16x16x64_bf16 v[36:39], v[0:3], a[96:103], v74
  ds_write_b32 v79, v30 offset:256
  v_add_f32 v33, v33, v35
  v_cvt_pk_bf16_f32 v31, v29, v33
  v_smfmac_f32_16x16x64_bf16 v[40:43], v[0:3], a[104:111], v74
  ds_write_b32 v79, v31 offset:832
  v_xor_b32 v75, 0x8000, v75
  v_smfmac_f32_16x16x64_bf16 v[36:39], v[4:7], a[144:151], v74
  ds_read_b128 v[0:3], v76 offset:4608
  v_mov_b32 v29, 0
  v_smfmac_f32_16x16x64_bf16 v[40:43], v[4:7], a[152:159], v74
  s_waitcnt vmcnt(3) lgkmcnt(3)
  v_mov_b32 v30, 0
  v_mfma_f32_16x16x32_bf16 v[44:47], v[44:47], v[60:63], 0
  ds_read_b128 v[4:7], v76 offset:5632
  s_waitcnt lgkmcnt(2)
  v_mfma_f32_16x16x32_bf16 v[44:47], v[48:51], v[64:67], v[44:47]
  s_barrier
  v_smfmac_f32_16x16x64_bf16 v[36:39], v[8:11], a[112:119], v74
  ds_read_b128 v[20:23], v77 offset:256
  ds_read_b128 v[24:27], v77 offset:384
  v_smfmac_f32_16x16x64_bf16 v[40:43], v[8:11], a[120:127], v74
  ds_read_b128 v[8:11], v76 offset:6656
  v_add_f32_dpp v72, v46, v44 quad_perm:[2,3,0,1] row_mask:0xf bank_mask:0xf
  v_add_f32_dpp v73, v47, v45 quad_perm:[2,3,0,1] row_mask:0xf bank_mask:0xf
  v_smfmac_f32_16x16x64_bf16 v[36:39], v[12:15], a[160:167], v74
  s_waitcnt lgkmcnt(4)
  v_exp_f32_dpp v72, v72 quad_perm:[0,1,0,1] row_mask:0xf bank_mask:0xf
  v_smfmac_f32_16x16x64_bf16 v[40:43], v[12:15], a[168:175], v74
  ds_read_b128 v[12:15], v76 offset:7680
  v_exp_f32_dpp v73, v73 quad_perm:[0,1,0,1] row_mask:0xf bank_mask:0xf
  v_smfmac_f32_16x16x64_bf16 v[36:39], v[0:3], a[32:39], v74
  s_waitcnt lgkmcnt(2)
  v_cvt_pk_bf16_f32 v72, v72, v73
  v_mfma_f32_16x16x32_bf16 v[20:23], v[20:23], v[60:63], 0
  ds_write_b32 v78, v72 offset:512
  v_mov_b64 v[16:17], 0
  v_mfma_f32_16x16x32_bf16 v[20:23], v[24:27], v[64:67], v[20:23]
  ds_read_b128 v[44:47], v75 offset:16384
  v_mov_b64 v[18:19], 0
  v_smfmac_f32_16x16x64_bf16 v[40:43], v[0:3], a[40:47], v74
  ds_read_b128 v[48:51], v75 offset:17408
  v_mov_b64 v[68:69], s[78:79]
  v_smfmac_f32_16x16x64_bf16 v[36:39], v[4:7], a[48:55], v74
  s_waitcnt lgkmcnt(4)
  v_add_f32_dpp v24, v22, v20 quad_perm:[2,3,0,1] row_mask:0xf bank_mask:0xf
  v_add_f32_dpp v25, v23, v21 quad_perm:[2,3,0,1] row_mask:0xf bank_mask:0xf
  v_smfmac_f32_16x16x64_bf16 v[36:39], v[8:11], a[64:71], v74
  s_waitcnt lgkmcnt(2)
  s_barrier
  ds_read_b128 v[32:35], v78 offset:512
  v_smfmac_f32_16x16x64_bf16 v[36:39], v[12:15], a[80:87], v74
  ds_read_b128 v[60:63], v75 offset:18432
  v_mul_f32 v24, s69, v24
  v_smfmac_f32_16x16x64_bf16 v[40:43], v[4:7], a[56:63], v74
  ds_read_b128 v[64:67], v75 offset:19456
  v_mul_f32 v25, s69, v25
  v_smfmac_f32_16x16x64_bf16 v[40:43], v[8:11], a[72:79], v74
  v_exp_f32_dpp v24, v24 quad_perm:[0,1,0,1] row_mask:0xf bank_mask:0xf
  v_smfmac_f32_16x16x64_bf16 v[40:43], v[12:15], a[88:95], v74
  s_waitcnt lgkmcnt(2)
  v_exp_f32_dpp v25, v25 quad_perm:[0,1,0,1] row_mask:0xf bank_mask:0xf
  v_mfma_f32_16x16x32_bf16 v[8:11], v[32:35], v[68:71], 0
  v_add_f32 v36, v36, v38
  v_add_f32 v37, v37, v39
  v_mfma_f32_16x16x32_bf16 v[0:3], v[32:35], v[52:55], 0
  v_add_f32 v40, v40, v42
  v_add_f32 v41, v41, v43
  v_mfma_f32_16x16x32_bf16 v[4:7], v[32:35], v[56:59], 0
  v_cvt_pk_bf16_f32 v28, v24, v25
  v_cvt_pk_bf16_f32 v72, v36, v37
  v_cvt_pk_bf16_f32 v73, v40, v41
  v_mfma_f32_16x16x16_bf16 v[8:11], v[28:29], v[68:69], v[8:11]
  v_cvt_pk_bf16_f32 v31, v24, v25
  v_mov_b64 v[20:21], 0
  v_mfma_f32_16x16x16_bf16 v[0:3], v[28:29], v[72:73], v[0:3]
  ds_read_b128 v[68:71], v76 offset:13824
  v_mov_b64 v[22:23], 0
  v_mfma_f32_16x16x16_bf16 v[4:7], v[30:31], v[72:73], v[4:7]
  v_rcp_f32 v10, v8
  v_rcp_f32 v11, v9
  v_mul_f32 v0, v10, v0
  v_mul_f32 v1, v11, v1
  s_nop 0
  v_mul_f32 v4, v10, v4
  v_mul_f32 v5, v11, v5
  v_cvt_pk_bf16_f32 v2, v0, v4
  ds_write_b32 v79, v2 offset:8704
  v_cvt_pk_bf16_f32 v3, v1, v5
  ds_write_b32 v79, v3 offset:9280
  v_max3_f32 v8, v8, v9, v10
  v_max_f32 v8, v8, v11
  v_cmp_le_f32 vcc, 1317011456, v8
  v_mov_b64 v[24:25], 0
  v_mov_b64 v[26:27], 0
  s_cbranch_vccnz Cs0_mx
Cs0_mxok:
  s_waitcnt lgkmcnt(0)
  s_barrier
  ds_read_b128 v[0:3], v78 offset:8704
  ds_read_b128 v[4:7], v78 offset:8768
  ds_read_b128 v[8:11], v78 offset:8832
  ds_read_b128 v[12:15], v78 offset:8896
  s_waitcnt lgkmcnt(3)
  v_smfmac_f32_16x16x64_bf16 v[16:19], v[0:3], v[44:51], v74
  ds_read_b128 v[52:55], v75 offset:32768
  s_waitcnt lgkmcnt(3)
  v_smfmac_f32_16x16x64_bf16 v[16:19], v[4:7], v[60:67], v74
  ds_read_b128 v[56:59], v75 offset:33792
  s_waitcnt lgkmcnt(3)
  v_smfmac_f32_16x16x64_bf16 v[16:19], v[8:11], a[176:183], v74
  ds_read_b128 v[36:39], v75 offset:34816
  s_waitcnt lgkmcnt(3)
  v_smfmac_f32_16x16x64_bf16 v[16:19], v[12:15], a[184:191], v74
  ds_read_b128 v[40:43], v75 offset:35840
  ds_read_b128 v[44:47], v75 offset:49152
  v_smfmac_f32_16x16x64_bf16 v[20:23], v[0:3], a[192:199], v74
  ds_read_b128 v[48:51], v75 offset:50176
  ds_read_b128 v[60:63], v75 offset:51200
  v_smfmac_f32_16x16x64_bf16 v[20:23], v[4:7], a[200:207], v74
  ds_read_b128 v[64:67], v75 offset:52224
  s_waitcnt lgkmcnt(6)
  v_cvt_pk_bf16_f32 v16, v16, v17
  v_cvt_pk_bf16_f32 v17, v18, v19
  v_bfi_b32 v16, 1, s72, v16
  v_smfmac_f32_16x16x64_bf16 v[20:23], v[8:11], v[52:59], v74
  buffer_store_dwordx2 v[16:17], v68, s[8:11], s73 offen sc1
  s_waitcnt lgkmcnt(4)
  v_smfmac_f32_16x16x64_bf16 v[20:23], v[12:15], v[36:43], v74
  v_mov_b64 v[32:33], 0
  v_smfmac_f32_16x16x64_bf16 v[24:27], v[0:3], a[208:215], v74
  v_mov_b64 v[34:35], 0
  v_smfmac_f32_16x16x64_bf16 v[24:27], v[4:7], a[216:223], v74
  s_waitcnt lgkmcnt(2)
  v_cvt_pk_bf16_f32 v20, v20, v21
  v_cvt_pk_bf16_f32 v21, v22, v23
  v_bfi_b32 v20, 1, s72, v20
  v_smfmac_f32_16x16x64_bf16 v[24:27], v[8:11], v[44:51], v74
  buffer_store_dwordx2 v[20:21], v68, s[8:11], s74 offen sc1
  s_waitcnt lgkmcnt(0)
  v_smfmac_f32_16x16x64_bf16 v[24:27], v[12:15], v[60:67], v74
  v_smfmac_f32_16x16x64_bf16 v[32:35], v[0:3], a[224:231], v74
  v_smfmac_f32_16x16x64_bf16 v[32:35], v[4:7], a[232:239], v74
  v_cvt_pk_bf16_f32 v24, v24, v25
  v_cvt_pk_bf16_f32 v25, v26, v27
  v_bfi_b32 v24, 1, s72, v24
  v_smfmac_f32_16x16x64_bf16 v[32:35], v[8:11], a[240:247], v74
  buffer_store_dwordx2 v[24:25], v68, s[8:11], s75 offen sc1
  v_smfmac_f32_16x16x64_bf16 v[32:35], v[12:15], a[248:255], v74
  ds_read_b128 v[0:3], v76 offset:14848
  ds_read_b64 v[16:17], v77 offset:256
  v_mov_b64 v[18:19], v[72:73]
  v_xor_b32 v75, 0x8000, v75
  s_nop 3
  v_cvt_pk_bf16_f32 v32, v32, v33
  v_cvt_pk_bf16_f32 v33, v34, v35
  v_bfi_b32 v32, 1, s72, v32
  buffer_store_dwordx2 v[32:33], v68, s[8:11], s76 offen sc1
  v_mov_b64 v[20:21], 0
  v_mov_b64 v[22:23], 0
  v_mov_b64 v[24:25], 0
  v_mov_b64 v[26:27], 0
  v_mov_b64 v[28:29], 0
  v_mov_b64 v[30:31], 0
  v_mov_b64 v[32:33], 0
  v_mov_b64 v[34:35], 0
  v_mov_b32 v68, 14880
  s_add_u32 s58, s58, 655360
  s_add_u32 s59, s59, 655360
  s_add_u32 s70, s70, 655360
  s_add_u32 s68, s68, 655360
  s_add_u32 s66, s66, 1
  s_xor_b32 s64, s64, 16384
  s_xor_b32 s65, s65, 16384
  s_cmp_eq_u32 s66, 62
  s_cselect_b64 s[16:17], s[20:21], s[16:17]
  s_cselect_b32 s18, (Cs0_done - Cs0_last), s18
  s_cselect_b32 s70, 0, s70
  s_cmp_eq_u32 s66, 63
  s_cselect_b32 s59, 268435456, s59
  s_cselect_b32 s58, 268435456, s58
  s_nop 13
  buffer_load_dwordx4 v[52:55], v76, s[8:11], s60 offen offset:0 sc1
  buffer_load_dwordx4 v[56:59], v76, s[8:11], s60 offen offset:1024 sc1
  s_waitcnt lgkmcnt(0)
  s_waitcnt vmcnt(1)
  v_mfma_f32_16x16x32_bf16 v[4:7], v[0:3], v[52:55], 0
  v_bitop3_b32 v72, v52, v54, s72 bitop3:0x7e
  s_waitcnt vmcnt(0)
  v_mfma_f32_16x16x32_bf16 v[4:7], v[0:3], v[56:59], v[4:7]
  v_bitop3_b32 v73, v56, v58, s72 bitop3:0x7e
  v_bitop3_b32 v72, v72, v73, 1 bitop3:0xa8
  v_cmp_ne_u32 vcc, 0, v72
  s_nop 0
  s_cmp_eq_u64 vcc, 0
  s_cselect_b32 s54, s62, 268435456
  s_nop 0
  v_add_f32_dpp v4, v4, v4 row_ror:4 row_mask:0xf bank_mask:0xf
  v_add_f32_dpp v5, v5, v5 row_ror:4 row_mask:0xf bank_mask:0xf
  s_nop 0
  v_add_f32_dpp v4, v4, v4 row_ror:8 row_mask:0xf bank_mask:0xf
  v_add_f32_dpp v5, v5, v5 row_ror:8 row_mask:0xf bank_mask:0xf
  v_cvt_pk_bf16_f32 v4, v4, v5
  buffer_store_dword v4, v69, s[8:11], s54 offen sc1
  s_cbranch_vccnz Cs0_h1r
  s_xor_b32 s62, s62, 16384
  buffer_store_dword v71, v69, s[8:11], s62 offen sc1
  s_xor_b32 s72, s72, 1
  s_branch Cs0_h2
Cs0_h1r:
  s_mov_b64 exec, vcc
  buffer_load_dwordx4 v[52:55], v76, s[8:11], s60 offen offset:0 sc1
  buffer_load_dwordx4 v[56:59], v76, s[8:11], s60 offen offset:1024 sc1
  s_mov_b64 exec, -1
  s_add_u32 s67, s67, 1
  s_waitcnt vmcnt(1)
  v_mfma_f32_16x16x32_bf16 v[4:7], v[0:3], v[52:55], 0
  v_bitop3_b32 v72, v52, v54, s72 bitop3:0x7e
  s_waitcnt vmcnt(0)
  v_mfma_f32_16x16x32_bf16 v[4:7], v[0:3], v[56:59], v[4:7]
  v_bitop3_b32 v73, v56, v58, s72 bitop3:0x7e
  v_bitop3_b32 v72, v72, v73, 1 bitop3:0xa8
  v_cmp_ne_u32 vcc, 0, v72
  s_cbranch_vccz Cs0_h1p
Cs0_h1s:
  s_mov_b64 exec, vcc
  buffer_load_dwordx4 v[52:55], v76, s[8:11], s60 offen offset:0 sc1
  buffer_load_dwordx4 v[56:59], v76, s[8:11], s60 offen offset:1024 sc1
  s_mov_b64 exec, -1
  s_add_u32 s67, s67, 1
  s_waitcnt vmcnt(1)
  v_mfma_f32_16x16x32_bf16 v[4:7], v[0:3], v[52:55], 0
  v_bitop3_b32 v72, v52, v54, s72 bitop3:0x7e
  s_waitcnt vmcnt(0)
  v_mfma_f32_16x16x32_bf16 v[4:7], v[0:3], v[56:59], v[4:7]
  v_bitop3_b32 v73, v56, v58, s72 bitop3:0x7e
  v_bitop3_b32 v72, v72, v73, 1 bitop3:0xa8
  v_cmp_ne_u32 vcc, 0, v72
  s_cbranch_vccz Cs0_h1p
  s_cmp_lt_u32 s67, 131072
  s_cbranch_scc1 Cs0_h1s
Cs0_h1p:
  s_nop 2
  v_add_f32_dpp v4, v4, v4 row_ror:4 row_mask:0xf bank_mask:0xf
  v_add_f32_dpp v5, v5, v5 row_ror:4 row_mask:0xf bank_mask:0xf
  s_nop 0
  v_add_f32_dpp v4, v4, v4 row_ror:8 row_mask:0xf bank_mask:0xf
  v_add_f32_dpp v5, v5, v5 row_ror:8 row_mask:0xf bank_mask:0xf
  v_cvt_pk_bf16_f32 v4, v4, v5
  buffer_store_dword v4, v69, s[8:11], s62 offen sc1
  s_xor_b32 s62, s62, 16384
  buffer_store_dword v71, v69, s[8:11], s62 offen sc1
  s_xor_b32 s72, s72, 1
  s_branch Cs0_h2
Cs0_h2r:
  s_mov_b64 exec, vcc
  buffer_load_dwordx4 v[0:3], v76, s[8:11], s65 offen offset:0 sc1
  s_mov_b64 exec, -1
  s_add_u32 s67, s67, 1
  s_waitcnt vmcnt(4)
  v_max3_u32 v72, v0, v1, v2
  v_max_u32 v72, v72, v3
  ds_write_b128 v76, v[0:3] offset:4608
  v_cmp_eq_u32 vcc, -1, v72
  s_cbranch_vccz Cs0_h2w
  s_mov_b64 exec, vcc
  buffer_load_dwordx4 v[0:3], v76, s[8:11], s65 offen offset:0 sc1
  s_mov_b64 exec, -1
  s_add_u32 s67, s67, 1
  s_waitcnt vmcnt(4)
  v_max3_u32 v72, v0, v1, v2
  v_max_u32 v72, v72, v3
  ds_write_b128 v76, v[0:3] offset:4608
  v_cmp_eq_u32 vcc, -1, v72
  s_cbranch_vccz Cs0_h2w
Cs0_h2s:
  s_mov_b64 exec, vcc
  buffer_load_dwordx4 v[0:3], v76, s[8:11], s65 offen offset:0 sc1
  s_mov_b64 exec, -1
  s_add_u32 s67, s67, 1
  s_waitcnt vmcnt(2)
  v_max3_u32 v72, v0, v1, v2
  v_max_u32 v72, v72, v3
  ds_write_b128 v76, v[0:3] offset:4608
  v_cmp_eq_u32 vcc, -1, v72
  s_cbranch_vccz Cs0_h2w
  s_mov_b64 exec, vcc
  buffer_load_dwordx4 v[0:3], v76, s[8:11], s65 offen offset:0 sc1
  s_mov_b64 exec, -1
  s_add_u32 s67, s67, 1
  s_waitcnt vmcnt(2)
  v_max3_u32 v72, v0, v1, v2
  v_max_u32 v72, v72, v3
  ds_write_b128 v76, v[0:3] offset:4608
  v_cmp_eq_u32 vcc, -1, v72
  s_cbranch_vccz Cs0_h2w
  s_mov_b64 exec, vcc
  buffer_load_dwordx4 v[0:3], v76, s[8:11], s65 offen offset:0 sc1
  s_mov_b64 exec, -1
  s_add_u32 s67, s67, 1
  s_waitcnt vmcnt(2)
  v_max3_u32 v72, v0, v1, v2
  v_max_u32 v72, v72, v3
  ds_write_b128 v76, v[0:3] offset:4608
  v_cmp_eq_u32 vcc, -1, v72
  s_cbranch_vccz Cs0_h2w
  s_cmp_lt_u32 s67, 131072
  s_cbranch_scc1 Cs0_h2s
  s_branch Cs0_h2w
Cs0_rec:
  s_nop 7
  s_waitcnt vmcnt(0) lgkmcnt(0)
  v_max3_u32 v72, v0, v1, v2
  v_max3_u32 v72, v72, v3, v4
  v_max3_u32 v72, v72, v5, v6
  v_max3_u32 v72, v72, v7, v8
  v_max3_u32 v72, v72, v9, v10
  v_max3_u32 v72, v72, v11, v12
  v_max3_u32 v72, v72, v13, v14
  v_max3_u32 v72, v72, v15, v16
  v_max3_u32 v72, v72, v17, v18
  v_max_u32 v72, v72, v19
  v_cmp_eq_u32 vcc, -1, v72
  s_cbranch_vccz Cs0_recok
  s_barrier
  v_mov_b64 v[20:21], 0
  v_mov_b64 v[22:23], 0
  v_mov_b64 v[24:25], 0
  v_mov_b64 v[26:27], 0
  v_mov_b64 v[28:29], 0
  v_mov_b64 v[30:31], 0
  v_mov_b64 v[32:33], 0
  v_mov_b64 v[34:35], 0
  s_waitcnt lgkmcnt(0)
  s_barrier
  ds_read_b128 v[0:3], v76 offset:4608
  s_waitcnt lgkmcnt(0)
  v_smfmac_f32_16x16x64_bf16 v[20:23], v[0:3], v[80:87], v74
  v_smfmac_f32_16x16x64_bf16 v[24:27], v[0:3], v[88:95], v74
  ds_read_b128 v[60:63], v76 offset:16384
  ds_read_b128 v[64:67], v76 offset:17408
  s_waitcnt lgkmcnt(0)
  v_smfmac_f32_16x16x64_bf16 v[28:31], v[0:3], v[60:67], v74
  ds_read_b128 v[60:63], v76 offset:18432
  ds_read_b128 v[64:67], v76 offset:19456
  s_waitcnt lgkmcnt(0)
  v_smfmac_f32_16x16x64_bf16 v[32:35], v[0:3], v[60:67], v74
  ds_read_b128 v[4:7], v76 offset:5632
  s_waitcnt lgkmcnt(0)
  v_smfmac_f32_16x16x64_bf16 v[20:23], v[4:7], v[96:103], v74
  v_smfmac_f32_16x16x64_bf16 v[24:27], v[4:7], v[104:111], v74
  ds_read_b128 v[60:63], v76 offset:32768
  ds_read_b128 v[64:67], v76 offset:33792
  s_waitcnt lgkmcnt(0)
  v_smfmac_f32_16x16x64_bf16 v[28:31], v[4:7], v[60:67], v74
  ds_read_b128 v[60:63], v76 offset:34816
  ds_read_b128 v[64:67], v76 offset:35840
  s_waitcnt lgkmcnt(0)
  v_smfmac_f32_16x16x64_bf16 v[32:35], v[4:7], v[60:67], v74
  ds_read_b128 v[8:11], v76 offset:6656
  s_waitcnt lgkmcnt(0)
  v_smfmac_f32_16x16x64_bf16 v[20:23], v[8:11], v[112:119], v74
  v_smfmac_f32_16x16x64_bf16 v[24:27], v[8:11], v[120:127], v74
  v_smfmac_f32_16x16x64_bf16 v[28:31], v[8:11], v[208:215], v74
  v_smfmac_f32_16x16x64_bf16 v[32:35], v[8:11], v[216:223], v74
  ds_read_b128 v[12:15], v76 offset:7680
  s_waitcnt lgkmcnt(0)
  v_smfmac_f32_16x16x64_bf16 v[20:23], v[12:15], v[128:135], v74
  v_smfmac_f32_16x16x64_bf16 v[24:27], v[12:15], v[136:143], v74
  v_smfmac_f32_16x16x64_bf16 v[28:31], v[12:15], v[224:231], v74
  v_smfmac_f32_16x16x64_bf16 v[32:35], v[12:15], v[232:239], v74
  ds_read_b128 v[0:3], v76 offset:8704
  s_waitcnt lgkmcnt(0)
  v_smfmac_f32_16x16x64_bf16 v[20:23], v[0:3], v[144:151], v74
  v_smfmac_f32_16x16x64_bf16 v[24:27], v[0:3], v[152:159], v74
  ds_read_b128 v[60:63], v76 offset:49152
  ds_read_b128 v[64:67], v76 offset:50176
  s_waitcnt lgkmcnt(0)
  v_smfmac_f32_16x16x64_bf16 v[28:31], v[0:3], v[60:67], v74
  ds_read_b128 v[60:63], v76 offset:51200
  ds_read_b128 v[64:67], v76 offset:52224
  s_waitcnt lgkmcnt(0)
  v_smfmac_f32_16x16x64_bf16 v[32:35], v[0:3], v[60:67], v74
  ds_read_b128 v[8:11], v76 offset:9728
  s_waitcnt lgkmcnt(0)
  v_smfmac_f32_16x16x64_bf16 v[20:23], v[8:11], v[160:167], v74
  v_smfmac_f32_16x16x64_bf16 v[24:27], v[8:11], v[168:175], v74
  ds_read_b128 v[60:63], v75 offset:16384
  ds_read_b128 v[64:67], v75 offset:17408
  s_waitcnt lgkmcnt(0)
  v_smfmac_f32_16x16x64_bf16 v[28:31], v[8:11], v[60:67], v74
  ds_read_b128 v[60:63], v75 offset:18432
  ds_read_b128 v[64:67], v75 offset:19456
  s_waitcnt lgkmcnt(0)
  v_smfmac_f32_16x16x64_bf16 v[32:35], v[8:11], v[60:67], v74
  ds_read_b128 v[16:19], v76 offset:10752
  ds_read_b128 v[60:63], v75 offset:0
  ds_read_b128 v[64:67], v75 offset:1024
  s_waitcnt lgkmcnt(0)
  v_smfmac_f32_16x16x64_bf16 v[20:23], v[16:19], v[60:67], v74
  ds_read_b128 v[60:63], v75 offset:2048
  ds_read_b128 v[64:67], v75 offset:3072
  s_waitcnt lgkmcnt(0)
  v_smfmac_f32_16x16x64_bf16 v[24:27], v[16:19], v[60:67], v74
  v_smfmac_f32_16x16x64_bf16 v[28:31], v[16:19], v[240:247], v74
  v_smfmac_f32_16x16x64_bf16 v[32:35], v[16:19], v[248:255], v74
  ds_read_b128 v[4:7], v76 offset:11776
  s_waitcnt lgkmcnt(0)
  v_smfmac_f32_16x16x64_bf16 v[20:23], v[4:7], v[176:183], v74
  v_smfmac_f32_16x16x64_bf16 v[24:27], v[4:7], v[184:191], v74
  v_smfmac_f32_16x16x64_bf16 v[28:31], v[4:7], a[0:7], v74
  v_smfmac_f32_16x16x64_bf16 v[32:35], v[4:7], a[8:15], v74
  ds_read_b128 v[12:15], v76 offset:12800
  s_waitcnt lgkmcnt(0)
  v_smfmac_f32_16x16x64_bf16 v[20:23], v[12:15], v[192:199], v74
  v_smfmac_f32_16x16x64_bf16 v[24:27], v[12:15], v[200:207], v74
  v_smfmac_f32_16x16x64_bf16 v[28:31], v[12:15], a[16:23], v74
  v_smfmac_f32_16x16x64_bf16 v[32:35], v[12:15], a[24:31], v74
  v_add_f32 v20, v20, v22
  v_add_f32 v21, v21, v23
  v_add_f32 v24, v24, v26
  v_cvt_pk_bf16_f32 v22, v20, v24
  ds_write_b32 v79, v22 offset:0
  v_add_f32 v25, v25, v27
  v_cvt_pk_bf16_f32 v23, v21, v25
  ds_write_b32 v79, v23 offset:576
  v_add_f32 v28, v28, v30
  v_add_f32 v29, v29, v31
  s_waitcnt lgkmcnt(0)
  s_nop 1
  s_branch Cs0_recok
Cs0_mx:
  s_waitcnt lgkmcnt(0)
  s_barrier
  buffer_load_dwordx4 v[0:3], v76, s[8:11], s58 offen offset:0 sc1
  ds_read_b128 v[20:23], v77 offset:0
  ds_read_b128 v[28:31], v77 offset:256
  buffer_load_dwordx4 v[4:7], v76, s[8:11], s58 offen offset:1024 sc1
  ds_read_b128 v[24:27], v77 offset:128
  ds_read_b128 v[32:35], v77 offset:384
  s_waitcnt vmcnt(1) lgkmcnt(3)
  v_mfma_f32_16x16x32_bf16 v[8:11], v[0:3], v[20:23], 0
  s_waitcnt vmcnt(0) lgkmcnt(1)
  v_mfma_f32_16x16x32_bf16 v[8:11], v[4:7], v[24:27], v[8:11]
  v_mfma_f32_16x16x32_bf16 v[12:15], v[28:31], v[20:23], 0
  s_waitcnt lgkmcnt(0)
  v_mfma_f32_16x16x32_bf16 v[12:15], v[32:35], v[24:27], v[12:15]
  v_add_f32_dpp v8, v10, v8 quad_perm:[2,3,0,1] row_mask:0xf bank_mask:0xf
  v_add_f32_dpp v9, v11, v9 quad_perm:[2,3,0,1] row_mask:0xf bank_mask:0xf
  s_nop 0
  v_mov_b32_dpp v8, v8 quad_perm:[0,1,0,1] row_mask:0xf bank_mask:0xf
  v_mov_b32_dpp v9, v9 quad_perm:[0,1,0,1] row_mask:0xf bank_mask:0xf
  s_nop 1
  v_add_f32_dpp v12, v14, v12 quad_perm:[2,3,0,1] row_mask:0xf bank_mask:0xf
  v_add_f32_dpp v13, v15, v13 quad_perm:[2,3,0,1] row_mask:0xf bank_mask:0xf
  s_nop 0
  v_mov_b32_dpp v12, v12 quad_perm:[0,1,0,1] row_mask:0xf bank_mask:0xf
  v_mov_b32_dpp v13, v13 quad_perm:[0,1,0,1] row_mask:0xf bank_mask:0xf
  v_mul_f32 v12, s69, v12
  ds_write_b32 v78, v8 offset:8704
  v_mul_f32 v13, s69, v13
  ds_write_b32 v78, v9 offset:8768
  s_waitcnt lgkmcnt(0)
  s_barrier
  ds_read_b128 v[36:39], v78 offset:8704
  ds_read_b128 v[40:43], v78 offset:8768
  s_waitcnt lgkmcnt(0)
  s_barrier
  v_max_f32 v16, v36, v37
  v_max3_f32 v16, v16, v38, v39
  v_max3_f32 v16, v16, v40, v41
  v_max3_f32 v16, v16, v42, v43
  v_max3_f32 v16, v16, v12, v13
  v_mov_b32 v17, v16
  s_nop 1
  v_permlane16_swap_b32 v16, v17
  v_max_f32 v16, v16, v17
  v_mov_b32 v17, v16
  s_nop 1
  v_permlane32_swap_b32 v16, v17
  v_max_f32 v16, v16, v17
  v_sub_f32 v36, v36, v16
  v_sub_f32 v37, v37, v16
  v_sub_f32 v38, v38, v16
  v_sub_f32 v39, v39, v16
  v_sub_f32 v40, v40, v16
  v_sub_f32 v41, v41, v16
  v_sub_f32 v42, v42, v16
  v_sub_f32 v43, v43, v16
  v_sub_f32 v12, v12, v16
  v_sub_f32 v13, v13, v16
  v_exp_f32 v36, v36
  v_exp_f32 v37, v37
  v_exp_f32 v38, v38
  v_exp_f32 v39, v39
  v_exp_f32 v40, v40
  v_exp_f32 v41, v41
  v_exp_f32 v42, v42
  v_exp_f32 v43, v43
  v_exp_f32 v12, v12
  v_exp_f32 v13, v13
  v_cvt_pk_bf16_f32 v32, v36, v40
  v_cvt_pk_bf16_f32 v33, v37, v41
  v_cvt_pk_bf16_f32 v34, v38, v42
  v_cvt_pk_bf16_f32 v35, v39, v43
  v_cvt_pk_bf16_f32 v28, v12, v13
  v_cvt_pk_bf16_f32 v31, v12, v13
  v_mov_b32 v29, 0
  v_mov_b32 v30, 0
  v_mov_b32 v68, 0x3f803f80
  v_mov_b32 v69, 0x3f803f80
  v_mov_b32 v70, 0x3f803f80
  v_mov_b32 v71, 0x3f803f80
  s_nop 1
  v_mfma_f32_16x16x32_bf16 v[8:11], v[32:35], v[68:71], 0
  v_mfma_f32_16x16x32_bf16 v[0:3], v[32:35], v[52:55], 0
  v_mfma_f32_16x16x32_bf16 v[4:7], v[32:35], v[56:59], 0
  v_mfma_f32_16x16x16_bf16 v[8:11], v[28:29], v[68:69], v[8:11]
  v_mfma_f32_16x16x16_bf16 v[0:3], v[28:29], v[72:73], v[0:3]
  v_mfma_f32_16x16x16_bf16 v[4:7], v[30:31], v[72:73], v[4:7]
  ds_read_b128 v[68:71], v76 offset:13824
  v_rcp_f32 v10, v8
  v_rcp_f32 v11, v9
  v_mul_f32 v0, v10, v0
  v_mul_f32 v1, v11, v1
  s_nop 0
  v_mul_f32 v4, v10, v4
  v_mul_f32 v5, v11, v5
  v_cvt_pk_bf16_f32 v2, v0, v4
  ds_write_b32 v79, v2 offset:8704
  v_cvt_pk_bf16_f32 v3, v1, v5
  ds_write_b32 v79, v3 offset:9280
  v_mov_b64 v[16:17], 0
  v_mov_b64 v[18:19], 0
  v_mov_b64 v[20:21], 0
  v_mov_b64 v[22:23], 0
  v_mov_b64 v[24:25], 0
  v_mov_b64 v[26:27], 0
  s_branch Cs0_mxok
Cs0_kv3:
  s_waitcnt lgkmcnt(0)
  s_cmp_ge_u32 s57, 0x700
  s_cbranch_scc1 Cs0_kvb
  s_load_dword s57, s[12:13], s71 glc
  s_add_u32 s67, s67, 1
  s_cmp_lt_u32 s67, 131072
  s_cbranch_scc1 Cs0_kv3
  s_waitcnt lgkmcnt(0)
  s_branch Cs0_kvb
Cs0_last:
  ds_read_b128 v[4:7], v76 offset:5632
  ds_read_b128 v[12:15], v76 offset:7680
  ds_read_b128 v[44:47], v76 offset:32768
  ds_read_b128 v[48:51], v76 offset:33792
  s_nop 5
  v_mov_b64 v[20:21], 0
  v_mov_b64 v[22:23], 0
  v_mov_b64 v[24:25], 0
  v_mov_b64 v[26:27], 0
  v_smfmac_f32_16x16x64_bf16 v[28:31], v[0:3], v[36:43], v74
  ds_read_b128 v[36:39], v76 offset:34816
  ds_read_b128 v[40:43], v76 offset:35840
  v_smfmac_f32_16x16x64_bf16 v[32:35], v[0:3], v[60:67], v74
  s_waitcnt lgkmcnt(5)
  v_smfmac_f32_16x16x64_bf16 v[20:23], v[0:3], a[32:39], v74
  ds_read_b128 v[60:63], v76 offset:49152
  ds_read_b128 v[64:67], v76 offset:50176
  v_smfmac_f32_16x16x64_bf16 v[24:27], v[0:3], a[40:47], v74
  s_waitcnt lgkmcnt(4)
  v_smfmac_f32_16x16x64_bf16 v[20:23], v[4:7], a[48:55], v74
  buffer_store_dwordx4 v[16:19], v76, s[8:11], s68 offen sc1
  v_smfmac_f32_16x16x64_bf16 v[24:27], v[4:7], a[56:63], v74
  v_smfmac_f32_16x16x64_bf16 v[28:31], v[4:7], v[44:51], v74
  s_waitcnt lgkmcnt(2)
  v_smfmac_f32_16x16x64_bf16 v[20:23], v[8:11], a[64:71], v74
  ds_read_b128 v[44:47], v76 offset:51200
  ds_read_b128 v[48:51], v76 offset:52224
  v_smfmac_f32_16x16x64_bf16 v[24:27], v[8:11], a[72:79], v74
  v_smfmac_f32_16x16x64_bf16 v[32:35], v[4:7], v[36:43], v74
  v_smfmac_f32_16x16x64_bf16 v[28:31], v[8:11], v[208:215], v74
  ds_read_b128 v[36:39], v75 offset:16384
  ds_read_b128 v[40:43], v75 offset:17408
  v_smfmac_f32_16x16x64_bf16 v[32:35], v[8:11], v[216:223], v74
  v_smfmac_f32_16x16x64_bf16 v[20:23], v[12:15], a[80:87], v74
  v_smfmac_f32_16x16x64_bf16 v[24:27], v[12:15], a[88:95], v74
  v_smfmac_f32_16x16x64_bf16 v[28:31], v[12:15], v[224:231], v74
  v_smfmac_f32_16x16x64_bf16 v[32:35], v[12:15], v[232:239], v74
  s_waitcnt vmcnt(2)
  s_waitcnt vmcnt(1)
  s_barrier
Cs0_lastr:
  ds_read_b128 v[0:3], v76 offset:8704
  ds_read_b128 v[8:11], v76 offset:9728
  ds_read_b128 v[16:19], v76 offset:10752
  ds_read_b128 v[4:7], v76 offset:11776
  ds_read_b128 v[12:15], v76 offset:12800
  s_waitcnt lgkmcnt(4)
  v_max3_u32 v72, v0, v1, v2
  s_waitcnt lgkmcnt(1)
  v_max3_u32 v72, v72, v3, v4
  v_max3_u32 v72, v72, v5, v6
  v_max3_u32 v72, v72, v7, v8
  v_max3_u32 v72, v72, v9, v10
  s_waitcnt lgkmcnt(0)
  v_max3_u32 v72, v72, v11, v12
  v_max3_u32 v72, v72, v13, v14
  v_max3_u32 v72, v72, v15, v16
  v_max3_u32 v72, v72, v17, v18
  v_max_u32 v72, v72, v19
  v_cmp_eq_u32 vcc, -1, v72
  s_cbranch_vccnz Cs0_lastp
Cs0_lastg:
  v_smfmac_f32_16x16x64_bf16 v[28:31], v[0:3], v[60:67], v74
  ds_read_b128 v[60:63], v75 offset:18432
  ds_read_b128 v[64:67], v75 offset:19456
  v_smfmac_f32_16x16x64_bf16 v[32:35], v[0:3], v[44:51], v74
  v_smfmac_f32_16x16x64_bf16 v[28:31], v[8:11], v[36:43], v74
  v_smfmac_f32_16x16x64_bf16 v[28:31], v[16:19], v[240:247], v74
  v_smfmac_f32_16x16x64_bf16 v[28:31], v[4:7], a[0:7], v74
  v_smfmac_f32_16x16x64_bf16 v[28:31], v[12:15], a[16:23], v74
  v_smfmac_f32_16x16x64_bf16 v[32:35], v[16:19], v[248:255], v74
  v_smfmac_f32_16x16x64_bf16 v[32:35], v[4:7], a[8:15], v74
  s_waitcnt lgkmcnt(0)
  v_smfmac_f32_16x16x64_bf16 v[32:35], v[12:15], a[24:31], v74
  v_smfmac_f32_16x16x64_bf16 v[32:35], v[8:11], v[60:67], v74
  v_smfmac_f32_16x16x64_bf16 v[20:23], v[0:3], a[96:103], v74
  v_smfmac_f32_16x16x64_bf16 v[20:23], v[8:11], a[112:119], v74
  v_add_f32 v28, v28, v30
  v_add_f32 v32, v32, v34
  v_cvt_pk_bf16_f32 v30, v28, v32
  v_smfmac_f32_16x16x64_bf16 v[20:23], v[16:19], a[128:135], v74
  ds_write_b32 v79, v30 offset:256
  v_add_f32 v29, v29, v31
  v_add_f32 v33, v33, v35
  v_cvt_pk_bf16_f32 v31, v29, v33
  v_smfmac_f32_16x16x64_bf16 v[20:23], v[4:7], a[144:151], v74
  ds_write_b32 v79, v31 offset:832
  v_smfmac_f32_16x16x64_bf16 v[20:23], v[12:15], a[160:167], v74
  v_smfmac_f32_16x16x64_bf16 v[24:27], v[0:3], a[104:111], v74
  v_smfmac_f32_16x16x64_bf16 v[24:27], v[8:11], a[120:127], v74
  v_smfmac_f32_16x16x64_bf16 v[24:27], v[16:19], a[136:143], v74
  s_waitcnt lgkmcnt(0)
  s_barrier
  ds_read_b64 v[52:53], v77 offset:256
  v_add_f32 v20, v20, v22
  v_smfmac_f32_16x16x64_bf16 v[24:27], v[4:7], a[152:159], v74
  v_add_f32 v21, v21, v23
  v_smfmac_f32_16x16x64_bf16 v[24:27], v[12:15], a[168:175], v74
  v_cvt_pk_bf16_f32 v54, v20, v21
  s_add_u32 s68, s68, 655360
  s_nop 3
  v_add_f32 v24, v24, v26
  v_add_f32 v25, v25, v27
  v_cvt_pk_bf16_f32 v55, v24, v25
  s_waitcnt lgkmcnt(0)
  buffer_store_dwordx4 v[52:55], v76, s[8:11], s68 offen sc1
  s_branch Cs0_done
Cs0_lastp:
  s_add_u32 s72, s72, 2
  s_cmp_ge_u32 s72, 131072
  s_cbranch_scc1 Cs0_lastg
  s_barrier
  buffer_load_dwordx4 v76, s[8:11], s55 offen offset:0 sc1 lds
  s_waitcnt vmcnt(0)
  s_barrier
  s_branch Cs0_lastr
Cs0_done:
  s_branch L_cexit
L_w5:
  v_mov_b64 v[20:21], 0
  v_mov_b64 v[22:23], 0
  v_mov_b64 v[24:25], 0
  v_mov_b64 v[26:27], 0
  v_mov_b64 v[28:29], 0
  v_mov_b64 v[30:31], 0
  v_mov_b64 v[32:33], 0
  v_mov_b64 v[34:35], 0
  s_mov_b32 s78, 0x3f803f80
  s_mov_b32 s79, s78
  s_mov_b32 s65, 360448
  s_mov_b32 m0, 15872
  s_lshl_b32 s71, s53, 2
  s_add_u32 s71, s71, 128
  s_movk_i32 s56, 0x1000
  v_lshlrev_b32 v73, 2, v76
  v_mov_b32 v72, 0
  s_mov_b64 s[16:17], s[8:9]
  s_mov_b32 s18, 268435456
  s_mov_b32 s19, 0x20000
  s_getpc_b64 s[20:21]
Cs1_pc:
  s_add_u32 s20, s20, (Cs1_last - Cs1_pc)
  s_addc_u32 s21, s21, 0
  v_mov_b32 v68, 14880
  buffer_load_dwordx4 v[52:55], v76, s[8:11], s59 offen offset:0 sc1
  buffer_load_dwordx4 v[56:59], v76, s[8:11], s59 offen offset:1024 sc1
  ds_read_b128 v[36:39], v76 offset:20480
  ds_read_b128 v[40:43], v76 offset:21504
  ds_read_b128 v[60:63], v76 offset:22528
  ds_read_b128 v[64:67], v76 offset:23552
  ds_read_b128 v[0:3], v76 offset:4608
  ds_read_b128 v[4:7], v76 offset:5632
  ds_read_b128 v[8:11], v76 offset:6656
  ds_read_b128 v[12:15], v76 offset:7680
  s_waitcnt lgkmcnt(0)
  s_cmp_eq_u32 s66, 1
  s_branch Cs1_top2
.p2align 6
Cs1_h2:
  v_lshlrev_b32 v73, 2, v76
  s_mov_b32 m0, 11776
  s_add_u32 s55, s65, 7168
  s_nop 15
  s_nop 3
  buffer_load_dwordx4 v[8:11], v76, s[8:11], s65 offen offset:2048 sc1
  s_nop 15
  s_nop 3
  buffer_load_dwordx4 v[8:11], v76, s[8:11], s65 offen offset:2048 sc1
  s_nop 15
  s_nop 3
  buffer_load_dwordx4 v[8:11], v76, s[8:11], s65 offen offset:2048 sc1
  s_waitcnt vmcnt(5)
  ds_read_b128 v[36:39], v76 offset:20480
  ds_read_b128 v[40:43], v76 offset:21504
  ds_read_b128 v[60:63], v76 offset:22528
  ds_read_b128 v[64:67], v76 offset:23552
  buffer_load_dwordx4 v[52:55], v76, s[8:11], s59 offen offset:0 sc1
  buffer_load_dwordx4 v[56:59], v76, s[8:11], s59 offen offset:1024 sc1
  s_waitcnt vmcnt(4)
  v_max3_u32 v72, v8, v9, v10
  v_max_u32 v72, v72, v11
  ds_write_b128 v76, v[8:11] offset:6656
  v_cmp_eq_u32 vcc, -1, v72
  s_cbranch_vccnz Cs1_h2r
Cs1_h2w:
  s_cmp_eq_u32 s66, 63
  s_waitcnt lgkmcnt(0)
  s_barrier
  ds_read_b128 v[0:3], v76 offset:4608
  buffer_load_dwordx4 v76, s[8:11], s55 offen offset:0 sc1 lds
Cs1_top2:
  v_smfmac_f32_16x16x64_bf16 v[20:23], v[8:11], v[112:119], v74
  s_cbranch_scc1 Cs1_last
  v_smfmac_f32_16x16x64_bf16 v[24:27], v[8:11], v[120:127], v74
  buffer_load_dwordx4 v[44:47], v76, s[8:11], s58 offen offset:0 sc1
  s_mov_b32 m0, 15872
  v_smfmac_f32_16x16x64_bf16 v[28:31], v[8:11], v[208:215], v74
  buffer_load_dwordx4 v[48:51], v76, s[8:11], s58 offen offset:1024 sc1
  v_smfmac_f32_16x16x64_bf16 v[32:35], v[8:11], v[216:223], v74
  ds_read_b128 v[4:7], v76 offset:5632
  s_waitcnt lgkmcnt(1)
  v_smfmac_f32_16x16x64_bf16 v[20:23], v[0:3], v[80:87], v74
  ds_read_b128 v[12:15], v76 offset:7680
  v_smfmac_f32_16x16x64_bf16 v[28:31], v[0:3], v[36:43], v74
  ds_read_b128 v[36:39], v76 offset:36864
  v_smfmac_f32_16x16x64_bf16 v[24:27], v[0:3], v[88:95], v74
  buffer_store_dwordx4 v[16:19], v76, s[8:11], s68 offen sc1
  ds_read_b128 v[40:43], v76 offset:37888
  v_smfmac_f32_16x16x64_bf16 v[32:35], v[0:3], v[60:67], v74
  ds_read_b128 v[60:63], v76 offset:38912
  s_waitcnt lgkmcnt(4)
  v_smfmac_f32_16x16x64_bf16 v[20:23], v[4:7], v[96:103], v74
  ds_read_b128 v[64:67], v76 offset:39936
  v_smfmac_f32_16x16x64_bf16 v[24:27], v[4:7], v[104:111], v74
  buffer_load_dword v73, s[16:19], s70 offen lds
  s_waitcnt vmcnt(5)
  s_waitcnt lgkmcnt(4)
  v_smfmac_f32_16x16x64_bf16 v[20:23], v[12:15], v[128:135], v74
  s_barrier
  s_waitcnt lgkmcnt(2)
  v_smfmac_f32_16x16x64_bf16 v[28:31], v[4:7], v[36:43], v74
  ds_read_b128 v[8:11], v76 offset:8704
  v_smfmac_f32_16x16x64_bf16 v[24:27], v[12:15], v[136:143], v74
  ds_read_b128 v[36:39], v76 offset:53248
  s_waitcnt lgkmcnt(2)
  v_smfmac_f32_16x16x64_bf16 v[32:35], v[4:7], v[60:67], v74
  ds_read_b128 v[40:43], v76 offset:54272
  v_smfmac_f32_16x16x64_bf16 v[28:31], v[12:15], v[224:231], v74
  ds_read_b128 v[60:63], v76 offset:55296
  v_smfmac_f32_16x16x64_bf16 v[32:35], v[12:15], v[232:239], v74
  ds_read_b128 v[64:67], v76 offset:56320
  s_waitcnt lgkmcnt(4)
  v_smfmac_f32_16x16x64_bf16 v[20:23], v[8:11], v[144:151], v74
  s_waitcnt vmcnt(4)
  ds_read_b128 v[0:3], v76 offset:9728
  s_waitcnt lgkmcnt(3)
  v_smfmac_f32_16x16x64_bf16 v[28:31], v[8:11], v[36:43], v74
  s_barrier
  ds_read_b128 v[4:7], v76 offset:11776
  v_smfmac_f32_16x16x64_bf16 v[24:27], v[8:11], v[152:159], v74
  ds_read_b128 v[36:39], v75 offset:4096
  ds_read_b128 v[40:43], v75 offset:5120
  s_waitcnt lgkmcnt(4)
  v_smfmac_f32_16x16x64_bf16 v[32:35], v[8:11], v[60:67], v74
  ds_read_b128 v[16:19], v76 offset:10752
  s_waitcnt lgkmcnt(4)
  v_smfmac_f32_16x16x64_bf16 v[20:23], v[0:3], v[160:167], v74
  ds_read_b128 v[12:15], v76 offset:12800
  v_smfmac_f32_16x16x64_bf16 v[24:27], v[0:3], v[168:175], v74
  ds_read_b128 v[60:63], v75 offset:6144
  ds_read_b128 v[64:67], v75 offset:7168
  s_waitcnt lgkmcnt(6)
  v_smfmac_f32_16x16x64_bf16 v[20:23], v[4:7], v[176:183], v74
  s_waitcnt lgkmcnt(3)
  v_smfmac_f32_16x16x64_bf16 v[20:23], v[16:19], v[36:43], v74
  ds_read_b128 v[36:39], v75 offset:20480
  s_waitcnt lgkmcnt(3)
  v_smfmac_f32_16x16x64_bf16 v[20:23], v[12:15], v[192:199], v74
  ds_read_b128 v[40:43], v75 offset:21504
  s_waitcnt lgkmcnt(2)
  v_smfmac_f32_16x16x64_bf16 v[24:27], v[16:19], v[60:67], v74
  ds_read_b128 v[60:63], v75 offset:22528
  v_smfmac_f32_16x16x64_bf16 v[24:27], v[4:7], v[184:191], v74
  ds_read_b128 v[64:67], v75 offset:23552
  v_add_f32 v20, v20, v22
  v_smfmac_f32_16x16x64_bf16 v[24:27], v[12:15], v[200:207], v74
  v_add_f32 v21, v21, v23
  v_smfmac_f32_16x16x64_bf16 v[28:31], v[16:19], v[240:247], v74
  s_waitcnt lgkmcnt(2)
  v_mov_b64 v[70:71], s[78:79]
  v_smfmac_f32_16x16x64_bf16 v[28:31], v[0:3], v[36:43], v74
  ds_read_b128 v[36:39], v68
  v_add_f32 v24, v24, v26
  v_smfmac_f32_16x16x64_bf16 v[28:31], v[4:7], a[0:7], v74
  ds_read_b128 v[40:43], v68
  v_cvt_pk_bf16_f32 v22, v20, v24
  v_smfmac_f32_16x16x64_bf16 v[28:31], v[12:15], a[16:23], v74
  ds_write_b32 v79, v22 offset:0
  s_waitcnt lgkmcnt(3)
  v_add_f32 v25, v25, v27
  v_cvt_pk_bf16_f32 v23, v21, v25
  v_smfmac_f32_16x16x64_bf16 v[32:35], v[0:3], v[60:67], v74
  ds_write_b32 v79, v23 offset:576
  v_cmp_u_f32 vcc, v20, v21
  v_smfmac_f32_16x16x64_bf16 v[32:35], v[16:19], v[248:255], v74
  v_add_f32 v28, v28, v30
  v_smfmac_f32_16x16x64_bf16 v[32:35], v[4:7], a[8:15], v74
  v_add_f32 v29, v29, v31
  v_smfmac_f32_16x16x64_bf16 v[32:35], v[12:15], a[24:31], v74
  s_cbranch_vccnz Cs1_rec
Cs1_recok:
  s_waitcnt lgkmcnt(3)
  v_smfmac_f32_16x16x64_bf16 v[36:39], v[16:19], a[128:135], v74
  s_waitcnt lgkmcnt(0)
  s_barrier
  ds_read_b128 v[60:63], v77
  v_smfmac_f32_16x16x64_bf16 v[40:43], v[16:19], a[136:143], v74
  ds_read_b128 v[64:67], v77 offset:128
  v_add_f32 v32, v32, v34
  v_cvt_pk_bf16_f32 v30, v28, v32
  v_smfmac_f32_16x16x64_bf16 v[36:39], v[0:3], a[112:119], v74
  ds_write_b32 v79, v30 offset:256
  v_add_f32 v33, v33, v35
  v_cvt_pk_bf16_f32 v31, v29, v33
  v_smfmac_f32_16x16x64_bf16 v[40:43], v[0:3], a[120:127], v74
  ds_write_b32 v79, v31 offset:832
  v_xor_b32 v75, 0x8000, v75
  v_smfmac_f32_16x16x64_bf16 v[36:39], v[4:7], a[144:151], v74
  ds_read_b128 v[0:3], v76 offset:4608
  v_mov_b32 v29, 0
  v_smfmac_f32_16x16x64_bf16 v[40:43], v[4:7], a[152:159], v74
  s_waitcnt vmcnt(2) lgkmcnt(3)
  v_mov_b32 v30, 0
  v_mfma_f32_16x16x32_bf16 v[44:47], v[44:47], v[60:63], 0
  ds_read_b128 v[4:7], v76 offset:5632
  s_waitcnt lgkmcnt(2)
  v_mfma_f32_16x16x32_bf16 v[44:47], v[48:51], v[64:67], v[44:47]
  s_barrier
  v_smfmac_f32_16x16x64_bf16 v[36:39], v[8:11], a[96:103], v74
  ds_read_b128 v[20:23], v77 offset:256
  ds_read_b128 v[24:27], v77 offset:384
  v_smfmac_f32_16x16x64_bf16 v[40:43], v[8:11], a[104:111], v74
  ds_read_b128 v[8:11], v76 offset:6656
  v_add_f32_dpp v72, v46, v44 quad_perm:[2,3,0,1] row_mask:0xf bank_mask:0xf
  v_add_f32_dpp v73, v47, v45 quad_perm:[2,3,0,1] row_mask:0xf bank_mask:0xf
  v_smfmac_f32_16x16x64_bf16 v[36:39], v[12:15], a[160:167], v74
  s_waitcnt lgkmcnt(4)
  v_exp_f32_dpp v72, v72 quad_perm:[0,1,0,1] row_mask:0xf bank_mask:0xf
  v_smfmac_f32_16x16x64_bf16 v[40:43], v[12:15], a[168:175], v74
  ds_read_b128 v[12:15], v76 offset:7680
  v_exp_f32_dpp v73, v73 quad_perm:[0,1,0,1] row_mask:0xf bank_mask:0xf
  v_smfmac_f32_16x16x64_bf16 v[36:39], v[0:3], a[32:39], v74
  s_waitcnt lgkmcnt(2)
  v_cvt_pk_bf16_f32 v72, v72, v73
  v_mfma_f32_16x16x32_bf16 v[20:23], v[20:23], v[60:63], 0
  ds_write_b32 v78, v72 offset:516
  v_mov_b64 v[16:17], 0
  v_mfma_f32_16x16x32_bf16 v[20:23], v[24:27], v[64:67], v[20:23]
  ds_read_b128 v[44:47], v75 offset:20480
  v_mov_b64 v[18:19], 0
  v_smfmac_f32_16x16x64_bf16 v[40:43], v[0:3], a[40:47], v74
  ds_read_b128 v[48:51], v75 offset:21504
  v_mov_b64 v[68:69], s[78:79]
  v_smfmac_f32_16x16x64_bf16 v[36:39], v[4:7], a[48:55], v74
  s_waitcnt lgkmcnt(4)
  v_add_f32_dpp v24, v22, v20 quad_perm:[2,3,0,1] row_mask:0xf bank_mask:0xf
  v_add_f32_dpp v25, v23, v21 quad_perm:[2,3,0,1] row_mask:0xf bank_mask:0xf
  v_smfmac_f32_16x16x64_bf16 v[36:39], v[8:11], a[64:71], v74
  s_waitcnt lgkmcnt(2)
  s_barrier
  ds_read_b128 v[32:35], v78 offset:512
  v_smfmac_f32_16x16x64_bf16 v[36:39], v[12:15], a[80:87], v74
  ds_read_b128 v[60:63], v75 offset:22528
  v_mul_f32 v24, s69, v24
  v_smfmac_f32_16x16x64_bf16 v[40:43], v[4:7], a[56:63], v74
  ds_read_b128 v[64:67], v75 offset:23552
  v_mul_f32 v25, s69, v25
  v_smfmac_f32_16x16x64_bf16 v[40:43], v[8:11], a[72:79], v74
  v_exp_f32_dpp v24, v24 quad_perm:[0,1,0,1] row_mask:0xf bank_mask:0xf
  v_smfmac_f32_16x16x64_bf16 v[40:43], v[12:15], a[88:95], v74
  s_waitcnt lgkmcnt(2)
  v_exp_f32_dpp v25, v25 quad_perm:[0,1,0,1] row_mask:0xf bank_mask:0xf
  v_mfma_f32_16x16x32_bf16 v[8:11], v[32:35], v[68:71], 0
  v_add_f32 v36, v36, v38
  v_add_f32 v37, v37, v39
  v_mfma_f32_16x16x32_bf16 v[0:3], v[32:35], v[52:55], 0
  v_add_f32 v40, v40, v42
  v_add_f32 v41, v41, v43
  v_mfma_f32_16x16x32_bf16 v[4:7], v[32:35], v[56:59], 0
  v_cvt_pk_bf16_f32 v28, v24, v25
  v_cvt_pk_bf16_f32 v72, v36, v37
  v_cvt_pk_bf16_f32 v73, v40, v41
  v_mfma_f32_16x16x16_bf16 v[8:11], v[28:29], v[68:69], v[8:11]
  v_cvt_pk_bf16_f32 v31, v24, v25
  v_mov_b64 v[20:21], 0
  v_mfma_f32_16x16x16_bf16 v[0:3], v[28:29], v[72:73], v[0:3]
  ds_read_b128 v[68:71], v76 offset:13824
  v_mov_b64 v[22:23], 0
  v_mfma_f32_16x16x16_bf16 v[4:7], v[30:31], v[72:73], v[4:7]
  v_rcp_f32 v10, v8
  v_rcp_f32 v11, v9
  v_mul_f32 v0, v10, v0
  v_mul_f32 v1, v11, v1
  s_nop 0
  v_mul_f32 v4, v10, v4
  v_mul_f32 v5, v11, v5
  v_cvt_pk_bf16_f32 v2, v0, v4
  ds_write_b32 v79, v2 offset:8704
  v_cvt_pk_bf16_f32 v3, v1, v5
  ds_write_b32 v79, v3 offset:9280
  v_max3_f32 v8, v8, v9, v10
  v_max_f32 v8, v8, v11
  v_cmp_le_f32 vcc, 1317011456, v8
  v_mov_b64 v[24:25], 0
  v_mov_b64 v[26:27], 0
  s_cbranch_vccnz Cs1_mx
Cs1_mxok:
  s_waitcnt lgkmcnt(0)
  s_barrier
  ds_read_b128 v[0:3], v78 offset:8704
  ds_read_b128 v[4:7], v78 offset:8768
  ds_read_b128 v[8:11], v78 offset:8832
  ds_read_b128 v[12:15], v78 offset:8896
  s_waitcnt lgkmcnt(3)
  v_smfmac_f32_16x16x64_bf16 v[16:19], v[0:3], v[44:51], v74
  ds_read_b128 v[52:55], v75 offset:36864
  s_waitcnt lgkmcnt(3)
  v_smfmac_f32_16x16x64_bf16 v[16:19], v[4:7], v[60:67], v74
  ds_read_b128 v[56:59], v75 offset:37888
  s_waitcnt lgkmcnt(3)
  v_smfmac_f32_16x16x64_bf16 v[16:19], v[8:11], a[176:183], v74
  ds_read_b128 v[36:39], v75 offset:38912
  s_waitcnt lgkmcnt(3)
  v_smfmac_f32_16x16x64_bf16 v[16:19], v[12:15], a[184:191], v74
  ds_read_b128 v[40:43], v75 offset:39936
  ds_read_b128 v[44:47], v75 offset:53248
  v_smfmac_f32_16x16x64_bf16 v[20:23], v[0:3], a[192:199], v74
  ds_read_b128 v[48:51], v75 offset:54272
  ds_read_b128 v[60:63], v75 offset:55296
  v_smfmac_f32_16x16x64_bf16 v[20:23], v[4:7], a[200:207], v74
  ds_read_b128 v[64:67], v75 offset:56320
  s_waitcnt lgkmcnt(6)
  v_cvt_pk_bf16_f32 v16, v16, v17
  v_cvt_pk_bf16_f32 v17, v18, v19
  v_bfi_b32 v16, 1, s72, v16
  v_smfmac_f32_16x16x64_bf16 v[20:23], v[8:11], v[52:59], v74
  buffer_store_dwordx2 v[16:17], v68, s[8:11], s73 offen sc1
  s_waitcnt lgkmcnt(4)
  v_smfmac_f32_16x16x64_bf16 v[20:23], v[12:15], v[36:43], v74
  v_mov_b64 v[32:33], 0
  v_smfmac_f32_16x16x64_bf16 v[24:27], v[0:3], a[208:215], v74
  v_mov_b64 v[34:35], 0
  v_smfmac_f32_16x16x64_bf16 v[24:27], v[4:7], a[216:223], v74
  s_waitcnt lgkmcnt(2)
  v_cvt_pk_bf16_f32 v20, v20, v21
  v_cvt_pk_bf16_f32 v21, v22, v23
  v_bfi_b32 v20, 1, s72, v20
  v_smfmac_f32_16x16x64_bf16 v[24:27], v[8:11], v[44:51], v74
  buffer_store_dwordx2 v[20:21], v68, s[8:11], s74 offen sc1
  s_waitcnt lgkmcnt(0)
  v_smfmac_f32_16x16x64_bf16 v[24:27], v[12:15], v[60:67], v74
  v_smfmac_f32_16x16x64_bf16 v[32:35], v[0:3], a[224:231], v74
  v_smfmac_f32_16x16x64_bf16 v[32:35], v[4:7], a[232:239], v74
  v_cvt_pk_bf16_f32 v24, v24, v25
  v_cvt_pk_bf16_f32 v25, v26, v27
  v_bfi_b32 v24, 1, s72, v24
  v_smfmac_f32_16x16x64_bf16 v[32:35], v[8:11], a[240:247], v74
  buffer_store_dwordx2 v[24:25], v68, s[8:11], s75 offen sc1
  v_smfmac_f32_16x16x64_bf16 v[32:35], v[12:15], a[248:255], v74
  ds_read_b128 v[0:3], v76 offset:14848
  ds_read_b64 v[16:17], v77 offset:264
  v_mov_b64 v[18:19], v[72:73]
  v_xor_b32 v75, 0x8000, v75
  s_nop 3
  v_cvt_pk_bf16_f32 v32, v32, v33
  v_cvt_pk_bf16_f32 v33, v34, v35
  v_bfi_b32 v32, 1, s72, v32
  buffer_store_dwordx2 v[32:33], v68, s[8:11], s76 offen sc1
  v_mov_b64 v[20:21], 0
  v_mov_b64 v[22:23], 0
  v_mov_b64 v[24:25], 0
  v_mov_b64 v[26:27], 0
  v_mov_b64 v[28:29], 0
  v_mov_b64 v[30:31], 0
  v_mov_b64 v[32:33], 0
  v_mov_b64 v[34:35], 0
  v_mov_b32 v68, 14880
  s_add_u32 s58, s58, 655360
  s_add_u32 s59, s59, 655360
  s_add_u32 s70, s70, 655360
  s_add_u32 s68, s68, 655360
  s_add_u32 s66, s66, 1
  s_xor_b32 s64, s64, 16384
  s_xor_b32 s65, s65, 16384
  s_cmp_eq_u32 s66, 62
  s_cselect_b64 s[16:17], s[20:21], s[16:17]
  s_cselect_b32 s18, (Cs1_done - Cs1_last), s18
  s_cselect_b32 s70, 0, s70
  s_cmp_eq_u32 s66, 63
  s_cselect_b32 s59, 268435456, s59
  s_cselect_b32 s58, 268435456, s58
  s_nop 15
  s_nop 13
  buffer_load_dwordx4 v[52:55], v76, s[8:11], s60 offen offset:0 sc1
  buffer_load_dwordx4 v[56:59], v76, s[8:11], s60 offen offset:1024 sc1
  s_waitcnt lgkmcnt(0)
  s_waitcnt vmcnt(1)
  v_mfma_f32_16x16x32_bf16 v[4:7], v[0:3], v[52:55], 0
  v_bitop3_b32 v72, v52, v54, s72 bitop3:0x7e
  s_waitcnt vmcnt(0)
  v_mfma_f32_16x16x32_bf16 v[4:7], v[0:3], v[56:59], v[4:7]
  v_bitop3_b32 v73, v56, v58, s72 bitop3:0x7e
  v_bitop3_b32 v72, v72, v73, 1 bitop3:0xa8
  v_cmp_ne_u32 vcc, 0, v72
  s_nop 0
  s_cmp_eq_u64 vcc, 0
  s_cselect_b32 s54, s62, 268435456
  s_nop 0
  v_add_f32_dpp v4, v4, v4 row_ror:4 row_mask:0xf bank_mask:0xf
  v_add_f32_dpp v5, v5, v5 row_ror:4 row_mask:0xf bank_mask:0xf
  s_nop 0
  v_add_f32_dpp v4, v4, v4 row_ror:8 row_mask:0xf bank_mask:0xf
  v_add_f32_dpp v5, v5, v5 row_ror:8 row_mask:0xf bank_mask:0xf
  v_cvt_pk_bf16_f32 v4, v4, v5
  buffer_store_dword v4, v69, s[8:11], s54 offen sc1
  s_cbranch_vccnz Cs1_h1r
  s_xor_b32 s62, s62, 16384
  buffer_store_dword v71, v69, s[8:11], s62 offen sc1
  s_xor_b32 s72, s72, 1
  s_branch Cs1_h2
Cs1_h1r:
  s_mov_b64 exec, vcc
  buffer_load_dwordx4 v[52:55], v76, s[8:11], s60 offen offset:0 sc1
  buffer_load_dwordx4 v[56:59], v76, s[8:11], s60 offen offset:1024 sc1
  s_mov_b64 exec, -1
  s_add_u32 s67, s67, 1
  s_waitcnt vmcnt(1)
  v_mfma_f32_16x16x32_bf16 v[4:7], v[0:3], v[52:55], 0
  v_bitop3_b32 v72, v52, v54, s72 bitop3:0x7e
  s_waitcnt vmcnt(0)
  v_mfma_f32_16x16x32_bf16 v[4:7], v[0:3], v[56:59], v[4:7]
  v_bitop3_b32 v73, v56, v58, s72 bitop3:0x7e
  v_bitop3_b32 v72, v72, v73, 1 bitop3:0xa8
  v_cmp_ne_u32 vcc, 0, v72
  s_cbranch_vccz Cs1_h1p
Cs1_h1s:
  s_mov_b64 exec, vcc
  buffer_load_dwordx4 v[52:55], v76, s[8:11], s60 offen offset:0 sc1
  buffer_load_dwordx4 v[56:59], v76, s[8:11], s60 offen offset:1024 sc1
  s_mov_b64 exec, -1
  s_add_u32 s67, s67, 1
  s_waitcnt vmcnt(1)
  v_mfma_f32_16x16x32_bf16 v[4:7], v[0:3], v[52:55], 0
  v_bitop3_b32 v72, v52, v54, s72 bitop3:0x7e
  s_waitcnt vmcnt(0)
  v_mfma_f32_16x16x32_bf16 v[4:7], v[0:3], v[56:59], v[4:7]
  v_bitop3_b32 v73, v56, v58, s72 bitop3:0x7e
  v_bitop3_b32 v72, v72, v73, 1 bitop3:0xa8
  v_cmp_ne_u32 vcc, 0, v72
  s_cbranch_vccz Cs1_h1p
  s_cmp_lt_u32 s67, 131072
  s_cbranch_scc1 Cs1_h1s
Cs1_h1p:
  s_nop 2
  v_add_f32_dpp v4, v4, v4 row_ror:4 row_mask:0xf bank_mask:0xf
  v_add_f32_dpp v5, v5, v5 row_ror:4 row_mask:0xf bank_mask:0xf
  s_nop 0
  v_add_f32_dpp v4, v4, v4 row_ror:8 row_mask:0xf bank_mask:0xf
  v_add_f32_dpp v5, v5, v5 row_ror:8 row_mask:0xf bank_mask:0xf
  v_cvt_pk_bf16_f32 v4, v4, v5
  buffer_store_dword v4, v69, s[8:11], s62 offen sc1
  s_xor_b32 s62, s62, 16384
  buffer_store_dword v71, v69, s[8:11], s62 offen sc1
  s_xor_b32 s72, s72, 1
  s_branch Cs1_h2
Cs1_h2r:
  s_mov_b64 exec, vcc
  buffer_load_dwordx4 v[8:11], v76, s[8:11], s65 offen offset:2048 sc1
  s_mov_b64 exec, -1
  s_add_u32 s67, s67, 1
  s_waitcnt vmcnt(4)
  v_max3_u32 v72, v8, v9, v10
  v_max_u32 v72, v72, v11
  ds_write_b128 v76, v[8:11] offset:6656
  v_cmp_eq_u32 vcc, -1, v72
  s_cbranch_vccz Cs1_h2w
  s_mov_b64 exec, vcc
  buffer_load_dwordx4 v[8:11], v76, s[8:11], s65 offen offset:2048 sc1
  s_mov_b64 exec, -1
  s_add_u32 s67, s67, 1
  s_waitcnt vmcnt(4)
  v_max3_u32 v72, v8, v9, v10
  v_max_u32 v72, v72, v11
  ds_write_b128 v76, v[8:11] offset:6656
  v_cmp_eq_u32 vcc, -1, v72
  s_cbranch_vccz Cs1_h2w
Cs1_h2s:
  s_mov_b64 exec, vcc
  buffer_load_dwordx4 v[8:11], v76, s[8:11], s65 offen offset:2048 sc1
  s_mov_b64 exec, -1
  s_add_u32 s67, s67, 1
  s_waitcnt vmcnt(2)
  v_max3_u32 v72, v8, v9, v10
  v_max_u32 v72, v72, v11
  ds_write_b128 v76, v[8:11] offset:6656
  v_cmp_eq_u32 vcc, -1, v72
  s_cbranch_vccz Cs1_h2w
  s_mov_b64 exec, vcc
  buffer_load_dwordx4 v[8:11], v76, s[8:11], s65 offen offset:2048 sc1
  s_mov_b64 exec, -1
  s_add_u32 s67, s67, 1
  s_waitcnt vmcnt(2)
  v_max3_u32 v72, v8, v9, v10
  v_max_u32 v72, v72, v11
  ds_write_b128 v76, v[8:11] offset:6656
  v_cmp_eq_u32 vcc, -1, v72
  s_cbranch_vccz Cs1_h2w
  s_mov_b64 exec, vcc
  buffer_load_dwordx4 v[8:11], v76, s[8:11], s65 offen offset:2048 sc1
  s_mov_b64 exec, -1
  s_add_u32 s67, s67, 1
  s_waitcnt vmcnt(2)
  v_max3_u32 v72, v8, v9, v10
  v_max_u32 v72, v72, v11
  ds_write_b128 v76, v[8:11] offset:6656
  v_cmp_eq_u32 vcc, -1, v72
  s_cbranch_vccz Cs1_h2w
  s_cmp_lt_u32 s67, 131072
  s_cbranch_scc1 Cs1_h2s
  s_branch Cs1_h2w
Cs1_rec:
  s_nop 7
  s_waitcnt vmcnt(0) lgkmcnt(0)
  v_max3_u32 v72, v0, v1, v2
  v_max3_u32 v72, v72, v3, v4
  v_max3_u32 v72, v72, v5, v6
  v_max3_u32 v72, v72, v7, v8
  v_max3_u32 v72, v72, v9, v10
  v_max3_u32 v72, v72, v11, v12
  v_max3_u32 v72, v72, v13, v14
  v_max3_u32 v72, v72, v15, v16
  v_max3_u32 v72, v72, v17, v18
  v_max_u32 v72, v72, v19
  v_cmp_eq_u32 vcc, -1, v72
  s_cbranch_vccz Cs1_recok
  s_barrier
  v_mov_b64 v[20:21], 0
  v_mov_b64 v[22:23], 0
  v_mov_b64 v[24:25], 0
  v_mov_b64 v[26:27], 0
  v_mov_b64 v[28:29], 0
  v_mov_b64 v[30:31], 0
  v_mov_b64 v[32:33], 0
  v_mov_b64 v[34:35], 0
  s_waitcnt lgkmcnt(0)
  s_barrier
  ds_read_b128 v[0:3], v76 offset:4608
  s_waitcnt lgkmcnt(0)
  v_smfmac_f32_16x16x64_bf16 v[20:23], v[0:3], v[80:87], v74
  v_smfmac_f32_16x16x64_bf16 v[24:27], v[0:3], v[88:95], v74
  ds_read_b128 v[60:63], v76 offset:20480
  ds_read_b128 v[64:67], v76 offset:21504
  s_waitcnt lgkmcnt(0)
  v_smfmac_f32_16x16x64_bf16 v[28:31], v[0:3], v[60:67], v74
  ds_read_b128 v[60:63], v76 offset:22528
  ds_read_b128 v[64:67], v76 offset:23552
  s_waitcnt lgkmcnt(0)
  v_smfmac_f32_16x16x64_bf16 v[32:35], v[0:3], v[60:67], v74
  ds_read_b128 v[4:7], v76 offset:5632
  s_waitcnt lgkmcnt(0)
  v_smfmac_f32_16x16x64_bf16 v[20:23], v[4:7], v[96:103], v74
  v_smfmac_f32_16x16x64_bf16 v[24:27], v[4:7], v[104:111], v74
  ds_read_b128 v[60:63], v76 offset:36864
  ds_read_b128 v[64:67], v76 offset:37888
  s_waitcnt lgkmcnt(0)
  v_smfmac_f32_16x16x64_bf16 v[28:31], v[4:7], v[60:67], v74
  ds_read_b128 v[60:63], v76 offset:38912
  ds_read_b128 v[64:67], v76 offset:39936
  s_waitcnt lgkmcnt(0)
  v_smfmac_f32_16x16x64_bf16 v[32:35], v[4:7], v[60:67], v74
  ds_read_b128 v[8:11], v76 offset:6656
  s_waitcnt lgkmcnt(0)
  v_smfmac_f32_16x16x64_bf16 v[20:23], v[8:11], v[112:119], v74
  v_smfmac_f32_16x16x64_bf16 v[24:27], v[8:11], v[120:127], v74
  v_smfmac_f32_16x16x64_bf16 v[28:31], v[8:11], v[208:215], v74
  v_smfmac_f32_16x16x64_bf16 v[32:35], v[8:11], v[216:223], v74
  ds_read_b128 v[12:15], v76 offset:7680
  s_waitcnt lgkmcnt(0)
  v_smfmac_f32_16x16x64_bf16 v[20:23], v[12:15], v[128:135], v74
  v_smfmac_f32_16x16x64_bf16 v[24:27], v[12:15], v[136:143], v74
  v_smfmac_f32_16x16x64_bf16 v[28:31], v[12:15], v[224:231], v74
  v_smfmac_f32_16x16x64_bf16 v[32:35], v[12:15], v[232:239], v74
  ds_read_b128 v[8:11], v76 offset:8704
  s_waitcnt lgkmcnt(0)
  v_smfmac_f32_16x16x64_bf16 v[20:23], v[8:11], v[144:151], v74
  v_smfmac_f32_16x16x64_bf16 v[24:27], v[8:11], v[152:159], v74
  ds_read_b128 v[60:63], v76 offset:53248
  ds_read_b128 v[64:67], v76 offset:54272
  s_waitcnt lgkmcnt(0)
  v_smfmac_f32_16x16x64_bf16 v[28:31], v[8:11], v[60:67], v74
  ds_read_b128 v[60:63], v76 offset:55296
  ds_read_b128 v[64:67], v76 offset:56320
  s_waitcnt lgkmcnt(0)
  v_smfmac_f32_16x16x64_bf16 v[32:35], v[8:11], v[60:67], v74
  ds_read_b128 v[0:3], v76 offset:9728
  s_waitcnt lgkmcnt(0)
  v_smfmac_f32_16x16x64_bf16 v[20:23], v[0:3], v[160:167], v74
  v_smfmac_f32_16x16x64_bf16 v[24:27], v[0:3], v[168:175], v74
  ds_read_b128 v[60:63], v75 offset:20480
  ds_read_b128 v[64:67], v75 offset:21504
  s_waitcnt lgkmcnt(0)
  v_smfmac_f32_16x16x64_bf16 v[28:31], v[0:3], v[60:67], v74
  ds_read_b128 v[60:63], v75 offset:22528
  ds_read_b128 v[64:67], v75 offset:23552
  s_waitcnt lgkmcnt(0)
  v_smfmac_f32_16x16x64_bf16 v[32:35], v[0:3], v[60:67], v74
  ds_read_b128 v[16:19], v76 offset:10752
  ds_read_b128 v[60:63], v75 offset:4096
  ds_read_b128 v[64:67], v75 offset:5120
  s_waitcnt lgkmcnt(0)
  v_smfmac_f32_16x16x64_bf16 v[20:23], v[16:19], v[60:67], v74
  ds_read_b128 v[60:63], v75 offset:6144
  ds_read_b128 v[64:67], v75 offset:7168
  s_waitcnt lgkmcnt(0)
  v_smfmac_f32_16x16x64_bf16 v[24:27], v[16:19], v[60:67], v74
  v_smfmac_f32_16x16x64_bf16 v[28:31], v[16:19], v[240:247], v74
  v_smfmac_f32_16x16x64_bf16 v[32:35], v[16:19], v[248:255], v74
  ds_read_b128 v[4:7], v76 offset:11776
  s_waitcnt lgkmcnt(0)
  v_smfmac_f32_16x16x64_bf16 v[20:23], v[4:7], v[176:183], v74
  v_smfmac_f32_16x16x64_bf16 v[24:27], v[4:7], v[184:191], v74
  v_smfmac_f32_16x16x64_bf16 v[28:31], v[4:7], a[0:7], v74
  v_smfmac_f32_16x16x64_bf16 v[32:35], v[4:7], a[8:15], v74
  ds_read_b128 v[12:15], v76 offset:12800
  s_waitcnt lgkmcnt(0)
  v_smfmac_f32_16x16x64_bf16 v[20:23], v[12:15], v[192:199], v74
  v_smfmac_f32_16x16x64_bf16 v[24:27], v[12:15], v[200:207], v74
  v_smfmac_f32_16x16x64_bf16 v[28:31], v[12:15], a[16:23], v74
  v_smfmac_f32_16x16x64_bf16 v[32:35], v[12:15], a[24:31], v74
  v_add_f32 v20, v20, v22
  v_add_f32 v21, v21, v23
  v_add_f32 v24, v24, v26
  v_cvt_pk_bf16_f32 v22, v20, v24
  ds_write_b32 v79, v22 offset:0
  v_add_f32 v25, v25, v27
  v_cvt_pk_bf16_f32 v23, v21, v25
  ds_write_b32 v79, v23 offset:576
  v_add_f32 v28, v28, v30
  v_add_f32 v29, v29, v31
  s_waitcnt lgkmcnt(0)
  s_nop 1
  s_branch Cs1_recok
Cs1_mx:
  s_waitcnt lgkmcnt(0)
  s_barrier
  buffer_load_dwordx4 v[0:3], v76, s[8:11], s58 offen offset:0 sc1
  ds_read_b128 v[20:23], v77 offset:0
  ds_read_b128 v[28:31], v77 offset:256
  buffer_load_dwordx4 v[4:7], v76, s[8:11], s58 offen offset:1024 sc1
  ds_read_b128 v[24:27], v77 offset:128
  ds_read_b128 v[32:35], v77 offset:384
  s_waitcnt vmcnt(1) lgkmcnt(3)
  v_mfma_f32_16x16x32_bf16 v[8:11], v[0:3], v[20:23], 0
  s_waitcnt vmcnt(0) lgkmcnt(1)
  v_mfma_f32_16x16x32_bf16 v[8:11], v[4:7], v[24:27], v[8:11]
  v_mfma_f32_16x16x32_bf16 v[12:15], v[28:31], v[20:23], 0
  s_waitcnt lgkmcnt(0)
  v_mfma_f32_16x16x32_bf16 v[12:15], v[32:35], v[24:27], v[12:15]
  v_add_f32_dpp v8, v10, v8 quad_perm:[2,3,0,1] row_mask:0xf bank_mask:0xf
  v_add_f32_dpp v9, v11, v9 quad_perm:[2,3,0,1] row_mask:0xf bank_mask:0xf
  s_nop 0
  v_mov_b32_dpp v8, v8 quad_perm:[0,1,0,1] row_mask:0xf bank_mask:0xf
  v_mov_b32_dpp v9, v9 quad_perm:[0,1,0,1] row_mask:0xf bank_mask:0xf
  s_nop 1
  v_add_f32_dpp v12, v14, v12 quad_perm:[2,3,0,1] row_mask:0xf bank_mask:0xf
  v_add_f32_dpp v13, v15, v13 quad_perm:[2,3,0,1] row_mask:0xf bank_mask:0xf
  s_nop 0
  v_mov_b32_dpp v12, v12 quad_perm:[0,1,0,1] row_mask:0xf bank_mask:0xf
  v_mov_b32_dpp v13, v13 quad_perm:[0,1,0,1] row_mask:0xf bank_mask:0xf
  v_mul_f32 v12, s69, v12
  ds_write_b32 v78, v8 offset:8708
  v_mul_f32 v13, s69, v13
  ds_write_b32 v78, v9 offset:8772
  s_waitcnt lgkmcnt(0)
  s_barrier
  ds_read_b128 v[36:39], v78 offset:8704
  ds_read_b128 v[40:43], v78 offset:8768
  s_waitcnt lgkmcnt(0)
  s_barrier
  v_max_f32 v16, v36, v37
  v_max3_f32 v16, v16, v38, v39
  v_max3_f32 v16, v16, v40, v41
  v_max3_f32 v16, v16, v42, v43
  v_max3_f32 v16, v16, v12, v13
  v_mov_b32 v17, v16
  s_nop 1
  v_permlane16_swap_b32 v16, v17
  v_max_f32 v16, v16, v17
  v_mov_b32 v17, v16
  s_nop 1
  v_permlane32_swap_b32 v16, v17
  v_max_f32 v16, v16, v17
  v_sub_f32 v36, v36, v16
  v_sub_f32 v37, v37, v16
  v_sub_f32 v38, v38, v16
  v_sub_f32 v39, v39, v16
  v_sub_f32 v40, v40, v16
  v_sub_f32 v41, v41, v16
  v_sub_f32 v42, v42, v16
  v_sub_f32 v43, v43, v16
  v_sub_f32 v12, v12, v16
  v_sub_f32 v13, v13, v16
  v_exp_f32 v36, v36
  v_exp_f32 v37, v37
  v_exp_f32 v38, v38
  v_exp_f32 v39, v39
  v_exp_f32 v40, v40
  v_exp_f32 v41, v41
  v_exp_f32 v42, v42
  v_exp_f32 v43, v43
  v_exp_f32 v12, v12
  v_exp_f32 v13, v13
  v_cvt_pk_bf16_f32 v32, v36, v40
  v_cvt_pk_bf16_f32 v33, v37, v41
  v_cvt_pk_bf16_f32 v34, v38, v42
  v_cvt_pk_bf16_f32 v35, v39, v43
  v_cvt_pk_bf16_f32 v28, v12, v13
  v_cvt_pk_bf16_f32 v31, v12, v13
  v_mov_b32 v29, 0
  v_mov_b32 v30, 0
  v_mov_b32 v68, 0x3f803f80
  v_mov_b32 v69, 0x3f803f80
  v_mov_b32 v70, 0x3f803f80
  v_mov_b32 v71, 0x3f803f80
  s_nop 1
  v_mfma_f32_16x16x32_bf16 v[8:11], v[32:35], v[68:71], 0
  v_mfma_f32_16x16x32_bf16 v[0:3], v[32:35], v[52:55], 0
  v_mfma_f32_16x16x32_bf16 v[4:7], v[32:35], v[56:59], 0
  v_mfma_f32_16x16x16_bf16 v[8:11], v[28:29], v[68:69], v[8:11]
  v_mfma_f32_16x16x16_bf16 v[0:3], v[28:29], v[72:73], v[0:3]
  v_mfma_f32_16x16x16_bf16 v[4:7], v[30:31], v[72:73], v[4:7]
  ds_read_b128 v[68:71], v76 offset:13824
  v_rcp_f32 v10, v8
  v_rcp_f32 v11, v9
  v_mul_f32 v0, v10, v0
  v_mul_f32 v1, v11, v1
  s_nop 0
  v_mul_f32 v4, v10, v4
  v_mul_f32 v5, v11, v5
  v_cvt_pk_bf16_f32 v2, v0, v4
  ds_write_b32 v79, v2 offset:8704
  v_cvt_pk_bf16_f32 v3, v1, v5
  ds_write_b32 v79, v3 offset:9280
  v_mov_b64 v[16:17], 0
  v_mov_b64 v[18:19], 0
  v_mov_b64 v[20:21], 0
  v_mov_b64 v[22:23], 0
  v_mov_b64 v[24:25], 0
  v_mov_b64 v[26:27], 0
  s_branch Cs1_mxok
Cs1_last:
  ds_read_b128 v[4:7], v76 offset:5632
  ds_read_b128 v[12:15], v76 offset:7680
  ds_read_b128 v[44:47], v76 offset:36864
  ds_read_b128 v[48:51], v76 offset:37888
  s_nop 5
  v_mov_b64 v[20:21], 0
  v_mov_b64 v[22:23], 0
  v_mov_b64 v[24:25], 0
  v_mov_b64 v[26:27], 0
  s_waitcnt lgkmcnt(4)
  v_smfmac_f32_16x16x64_bf16 v[28:31], v[0:3], v[36:43], v74
  ds_read_b128 v[36:39], v76 offset:38912
  ds_read_b128 v[40:43], v76 offset:39936
  v_smfmac_f32_16x16x64_bf16 v[32:35], v[0:3], v[60:67], v74
  s_waitcnt lgkmcnt(5)
  v_smfmac_f32_16x16x64_bf16 v[20:23], v[0:3], a[32:39], v74
  ds_read_b128 v[60:63], v76 offset:53248
  ds_read_b128 v[64:67], v76 offset:54272
  v_smfmac_f32_16x16x64_bf16 v[24:27], v[0:3], a[40:47], v74
  s_waitcnt lgkmcnt(4)
  v_smfmac_f32_16x16x64_bf16 v[20:23], v[4:7], a[48:55], v74
  buffer_store_dwordx4 v[16:19], v76, s[8:11], s68 offen sc1
  v_smfmac_f32_16x16x64_bf16 v[24:27], v[4:7], a[56:63], v74
  v_smfmac_f32_16x16x64_bf16 v[28:31], v[4:7], v[44:51], v74
  s_waitcnt lgkmcnt(2)
  v_smfmac_f32_16x16x64_bf16 v[20:23], v[8:11], a[64:71], v74
  ds_read_b128 v[44:47], v76 offset:55296
  ds_read_b128 v[48:51], v76 offset:56320
  v_smfmac_f32_16x16x64_bf16 v[24:27], v[8:11], a[72:79], v74
  v_smfmac_f32_16x16x64_bf16 v[32:35], v[4:7], v[36:43], v74
  v_smfmac_f32_16x16x64_bf16 v[28:31], v[8:11], v[208:215], v74
  ds_read_b128 v[36:39], v75 offset:20480
  ds_read_b128 v[40:43], v75 offset:21504
  v_smfmac_f32_16x16x64_bf16 v[32:35], v[8:11], v[216:223], v74
  v_smfmac_f32_16x16x64_bf16 v[20:23], v[12:15], a[80:87], v74
  v_smfmac_f32_16x16x64_bf16 v[24:27], v[12:15], a[88:95], v74
  v_smfmac_f32_16x16x64_bf16 v[28:31], v[12:15], v[224:231], v74
  v_smfmac_f32_16x16x64_bf16 v[32:35], v[12:15], v[232:239], v74
  s_waitcnt vmcnt(2)
  s_waitcnt vmcnt(1)
  s_barrier
Cs1_lastr:
  ds_read_b128 v[8:11], v76 offset:8704
  ds_read_b128 v[0:3], v76 offset:9728
  ds_read_b128 v[16:19], v76 offset:10752
  ds_read_b128 v[4:7], v76 offset:11776
  ds_read_b128 v[12:15], v76 offset:12800
  s_waitcnt lgkmcnt(3)
  v_max3_u32 v72, v0, v1, v2
  s_waitcnt lgkmcnt(1)
  v_max3_u32 v72, v72, v3, v4
  v_max3_u32 v72, v72, v5, v6
  v_max3_u32 v72, v72, v7, v8
  v_max3_u32 v72, v72, v9, v10
  s_waitcnt lgkmcnt(0)
  v_max3_u32 v72, v72, v11, v12
  v_max3_u32 v72, v72, v13, v14
  v_max3_u32 v72, v72, v15, v16
  v_max3_u32 v72, v72, v17, v18
  v_max_u32 v72, v72, v19
  v_cmp_eq_u32 vcc, -1, v72
  s_cbranch_vccnz Cs1_lastp
Cs1_lastg:
  v_smfmac_f32_16x16x64_bf16 v[28:31], v[8:11], v[60:67], v74
  ds_read_b128 v[60:63], v75 offset:22528
  ds_read_b128 v[64:67], v75 offset:23552
  v_smfmac_f32_16x16x64_bf16 v[32:35], v[8:11], v[44:51], v74
  v_smfmac_f32_16x16x64_bf16 v[28:31], v[0:3], v[36:43], v74
  v_smfmac_f32_16x16x64_bf16 v[28:31], v[16:19], v[240:247], v74
  v_smfmac_f32_16x16x64_bf16 v[28:31], v[4:7], a[0:7], v74
  v_smfmac_f32_16x16x64_bf16 v[28:31], v[12:15], a[16:23], v74
  v_smfmac_f32_16x16x64_bf16 v[32:35], v[16:19], v[248:255], v74
  v_smfmac_f32_16x16x64_bf16 v[32:35], v[4:7], a[8:15], v74
  s_waitcnt lgkmcnt(0)
  v_smfmac_f32_16x16x64_bf16 v[32:35], v[12:15], a[24:31], v74
  v_smfmac_f32_16x16x64_bf16 v[32:35], v[0:3], v[60:67], v74
  v_smfmac_f32_16x16x64_bf16 v[20:23], v[8:11], a[96:103], v74
  v_smfmac_f32_16x16x64_bf16 v[20:23], v[0:3], a[112:119], v74
  v_add_f32 v28, v28, v30
  v_add_f32 v32, v32, v34
  v_cvt_pk_bf16_f32 v30, v28, v32
  v_smfmac_f32_16x16x64_bf16 v[20:23], v[16:19], a[128:135], v74
  ds_write_b32 v79, v30 offset:256
  v_add_f32 v29, v29, v31
  v_add_f32 v33, v33, v35
  v_cvt_pk_bf16_f32 v31, v29, v33
  v_smfmac_f32_16x16x64_bf16 v[20:23], v[4:7], a[144:151], v74
  ds_write_b32 v79, v31 offset:832
  v_smfmac_f32_16x16x64_bf16 v[20:23], v[12:15], a[160:167], v74
  v_smfmac_f32_16x16x64_bf16 v[24:27], v[8:11], a[104:111], v74
  v_smfmac_f32_16x16x64_bf16 v[24:27], v[0:3], a[120:127], v74
  v_smfmac_f32_16x16x64_bf16 v[24:27], v[16:19], a[136:143], v74
  s_waitcnt lgkmcnt(0)
  s_barrier
  ds_read_b64 v[52:53], v77 offset:264
  v_add_f32 v20, v20, v22
  v_smfmac_f32_16x16x64_bf16 v[24:27], v[4:7], a[152:159], v74
  v_add_f32 v21, v21, v23
  v_smfmac_f32_16x16x64_bf16 v[24:27], v[12:15], a[168:175], v74
  v_cvt_pk_bf16_f32 v54, v20, v21
  s_add_u32 s68, s68, 655360
  s_nop 3
  v_add_f32 v24, v24, v26
  v_add_f32 v25, v25, v27
  v_cvt_pk_bf16_f32 v55, v24, v25
  s_waitcnt lgkmcnt(0)
  buffer_store_dwordx4 v[52:55], v76, s[8:11], s68 offen sc1
  s_branch Cs1_done
Cs1_lastp:
  s_add_u32 s72, s72, 2
  s_cmp_ge_u32 s72, 131072
  s_cbranch_scc1 Cs1_lastg
  s_barrier
  buffer_load_dwordx4 v76, s[8:11], s55 offen offset:0 sc1 lds
  s_waitcnt vmcnt(0)
  s_barrier
  s_branch Cs1_lastr
Cs1_done:
  s_branch L_cexit
L_w6:
  v_mov_b64 v[20:21], 0
  v_mov_b64 v[22:23], 0
  v_mov_b64 v[24:25], 0
  v_mov_b64 v[26:27], 0
  v_mov_b64 v[28:29], 0
  v_mov_b64 v[30:31], 0
  v_mov_b64 v[32:33], 0
  v_mov_b64 v[34:35], 0
  s_mov_b32 s78, 0x3f803f80
  s_mov_b32 s79, s78
  s_mov_b32 s65, 360448
  s_mov_b32 m0, 15872
  s_lshl_b32 s71, s53, 2
  s_add_u32 s71, s71, 128
  s_movk_i32 s56, 0x1000
  v_lshlrev_b32 v73, 2, v76
  v_mov_b32 v72, 0
  s_mov_b64 s[16:17], s[8:9]
  s_mov_b32 s18, 268435456
  s_mov_b32 s19, 0x20000
  s_getpc_b64 s[20:21]
Cs2_pc:
  s_add_u32 s20, s20, (Cs2_last - Cs2_pc)
  s_addc_u32 s21, s21, 0
  v_mov_b32 v68, 14880
  buffer_load_dwordx4 v[52:55], v76, s[8:11], s59 offen offset:0 sc1
  buffer_load_dwordx4 v[56:59], v76, s[8:11], s59 offen offset:1024 sc1
  ds_read_b128 v[36:39], v76 offset:24576
  ds_read_b128 v[40:43], v76 offset:25600
  ds_read_b128 v[60:63], v76 offset:26624
  ds_read_b128 v[64:67], v76 offset:27648
  ds_read_b128 v[0:3], v76 offset:4608
  ds_read_b128 v[4:7], v76 offset:5632
  ds_read_b128 v[8:11], v76 offset:6656
  ds_read_b128 v[12:15], v76 offset:7680
  s_waitcnt lgkmcnt(0)
  s_cmp_eq_u32 s66, 1
  s_branch Cs2_top2
.p2align 6
Cs2_h2:
  v_lshlrev_b32 v73, 2, v76
  s_mov_b32 m0, 12800
  s_add_u32 s55, s65, 8192
  s_nop 3
  buffer_load_dwordx4 v[12:15], v76, s[8:11], s65 offen offset:3072 sc1
  s_nop 15
  s_nop 3
  buffer_load_dwordx4 v[12:15], v76, s[8:11], s65 offen offset:3072 sc1
  s_nop 15
  s_nop 3
  buffer_load_dwordx4 v[12:15], v76, s[8:11], s65 offen offset:3072 sc1
  s_waitcnt vmcnt(5)
  ds_read_b128 v[36:39], v76 offset:24576
  ds_read_b128 v[40:43], v76 offset:25600
  ds_read_b128 v[60:63], v76 offset:26624
  ds_read_b128 v[64:67], v76 offset:27648
  buffer_load_dwordx4 v[52:55], v76, s[8:11], s59 offen offset:0 sc1
  buffer_load_dwordx4 v[56:59], v76, s[8:11], s59 offen offset:1024 sc1
  s_waitcnt vmcnt(4)
  v_max3_u32 v72, v12, v13, v14
  v_max_u32 v72, v72, v15
  ds_write_b128 v76, v[12:15] offset:7680
  v_cmp_eq_u32 vcc, -1, v72
  s_cbranch_vccnz Cs2_h2r
Cs2_h2w:
  s_cmp_eq_u32 s66, 63
  s_waitcnt lgkmcnt(0)
  s_barrier
  ds_read_b128 v[0:3], v76 offset:4608
  buffer_load_dwordx4 v76, s[8:11], s55 offen offset:0 sc1 lds
Cs2_top2:
  v_smfmac_f32_16x16x64_bf16 v[20:23], v[12:15], v[128:135], v74
  s_cbranch_scc1 Cs2_last
  v_smfmac_f32_16x16x64_bf16 v[24:27], v[12:15], v[136:143], v74
  buffer_load_dwordx4 v[44:47], v76, s[8:11], s58 offen offset:0 sc1
  s_mov_b32 m0, 15872
  v_smfmac_f32_16x16x64_bf16 v[28:31], v[12:15], v[224:231], v74
  buffer_load_dwordx4 v[48:51], v76, s[8:11], s58 offen offset:1024 sc1
  v_smfmac_f32_16x16x64_bf16 v[32:35], v[12:15], v[232:239], v74
  ds_read_b128 v[4:7], v76 offset:5632
  s_waitcnt lgkmcnt(1)
  v_smfmac_f32_16x16x64_bf16 v[20:23], v[0:3], v[80:87], v74
  ds_read_b128 v[8:11], v76 offset:6656
  v_smfmac_f32_16x16x64_bf16 v[28:31], v[0:3], v[36:43], v74
  ds_read_b128 v[36:39], v76 offset:40960
  v_smfmac_f32_16x16x64_bf16 v[24:27], v[0:3], v[88:95], v74
  buffer_store_dwordx4 v[16:19], v76, s[8:11], s68 offen sc1
  ds_read_b128 v[40:43], v76 offset:41984
  v_smfmac_f32_16x16x64_bf16 v[32:35], v[0:3], v[60:67], v74
  ds_read_b128 v[60:63], v76 offset:43008
  s_waitcnt lgkmcnt(4)
  v_smfmac_f32_16x16x64_bf16 v[20:23], v[4:7], v[96:103], v74
  ds_read_b128 v[64:67], v76 offset:44032
  v_smfmac_f32_16x16x64_bf16 v[24:27], v[4:7], v[104:111], v74
  buffer_load_dword v73, s[16:19], s70 offen lds
  s_waitcnt vmcnt(5)
  s_waitcnt lgkmcnt(4)
  v_smfmac_f32_16x16x64_bf16 v[20:23], v[8:11], v[112:119], v74
  s_barrier
  s_waitcnt lgkmcnt(2)
  v_smfmac_f32_16x16x64_bf16 v[28:31], v[4:7], v[36:43], v74
  ds_read_b128 v[12:15], v76 offset:8704
  v_smfmac_f32_16x16x64_bf16 v[24:27], v[8:11], v[120:127], v74
  ds_read_b128 v[36:39], v76 offset:57344
  s_waitcnt lgkmcnt(2)
  v_smfmac_f32_16x16x64_bf16 v[32:35], v[4:7], v[60:67], v74
  ds_read_b128 v[40:43], v76 offset:58368
  v_smfmac_f32_16x16x64_bf16 v[28:31], v[8:11], v[208:215], v74
  ds_read_b128 v[60:63], v76 offset:59392
  v_smfmac_f32_16x16x64_bf16 v[32:35], v[8:11], v[216:223], v74
  ds_read_b128 v[64:67], v76 offset:60416
  s_waitcnt lgkmcnt(4)
  v_smfmac_f32_16x16x64_bf16 v[20:23], v[12:15], v[144:151], v74
  s_waitcnt vmcnt(4)
  ds_read_b128 v[0:3], v76 offset:9728
  s_waitcnt lgkmcnt(3)
  v_smfmac_f32_16x16x64_bf16 v[28:31], v[12:15], v[36:43], v74
  s_barrier
  ds_read_b128 v[4:7], v76 offset:11776
  v_smfmac_f32_16x16x64_bf16 v[24:27], v[12:15], v[152:159], v74
  ds_read_b128 v[36:39], v75 offset:8192
  ds_read_b128 v[40:43], v75 offset:9216
  s_waitcnt lgkmcnt(4)
  v_smfmac_f32_16x16x64_bf16 v[32:35], v[12:15], v[60:67], v74
  ds_read_b128 v[16:19], v76 offset:10752
  s_waitcnt lgkmcnt(4)
  v_smfmac_f32_16x16x64_bf16 v[20:23], v[0:3], v[160:167], v74
  ds_read_b128 v[8:11], v76 offset:12800
  v_smfmac_f32_16x16x64_bf16 v[24:27], v[0:3], v[168:175], v74
  ds_read_b128 v[60:63], v75 offset:10240
  ds_read_b128 v[64:67], v75 offset:11264
  s_waitcnt lgkmcnt(6)
  v_smfmac_f32_16x16x64_bf16 v[20:23], v[4:7], v[176:183], v74
  s_waitcnt lgkmcnt(3)
  v_smfmac_f32_16x16x64_bf16 v[20:23], v[16:19], v[36:43], v74
  ds_read_b128 v[36:39], v75 offset:24576
  s_waitcnt lgkmcnt(3)
  v_smfmac_f32_16x16x64_bf16 v[20:23], v[8:11], v[192:199], v74
  ds_read_b128 v[40:43], v75 offset:25600
  s_waitcnt lgkmcnt(2)
  v_smfmac_f32_16x16x64_bf16 v[24:27], v[16:19], v[60:67], v74
  ds_read_b128 v[60:63], v75 offset:26624
  v_smfmac_f32_16x16x64_bf16 v[24:27], v[4:7], v[184:191], v74
  ds_read_b128 v[64:67], v75 offset:27648
  v_add_f32 v20, v20, v22
  v_smfmac_f32_16x16x64_bf16 v[24:27], v[8:11], v[200:207], v74
  v_add_f32 v21, v21, v23
  v_smfmac_f32_16x16x64_bf16 v[28:31], v[16:19], v[240:247], v74
  s_waitcnt lgkmcnt(2)
  v_mov_b64 v[70:71], s[78:79]
  v_smfmac_f32_16x16x64_bf16 v[28:31], v[0:3], v[36:43], v74
  ds_read_b128 v[36:39], v68
  v_add_f32 v24, v24, v26
  v_smfmac_f32_16x16x64_bf16 v[28:31], v[4:7], a[0:7], v74
  ds_read_b128 v[40:43], v68
  v_cvt_pk_bf16_f32 v22, v20, v24
  v_smfmac_f32_16x16x64_bf16 v[28:31], v[8:11], a[16:23], v74
  ds_write_b32 v79, v22 offset:0
  s_waitcnt lgkmcnt(3)
  v_add_f32 v25, v25, v27
  v_cvt_pk_bf16_f32 v23, v21, v25
  v_smfmac_f32_16x16x64_bf16 v[32:35], v[0:3], v[60:67], v74
  ds_write_b32 v79, v23 offset:576
  v_cmp_u_f32 vcc, v20, v21
  v_smfmac_f32_16x16x64_bf16 v[32:35], v[16:19], v[248:255], v74
  v_add_f32 v28, v28, v30
  v_smfmac_f32_16x16x64_bf16 v[32:35], v[4:7], a[8:15], v74
  v_add_f32 v29, v29, v31
  v_smfmac_f32_16x16x64_bf16 v[32:35], v[8:11], a[24:31], v74
  s_cbranch_vccnz Cs2_rec
Cs2_recok:
  s_waitcnt lgkmcnt(3)
  v_smfmac_f32_16x16x64_bf16 v[36:39], v[16:19], a[128:135], v74
  s_waitcnt lgkmcnt(0)
  s_barrier
  ds_read_b128 v[60:63], v77
  v_smfmac_f32_16x16x64_bf16 v[40:43], v[16:19], a[136:143], v74
  ds_read_b128 v[64:67], v77 offset:128
  v_add_f32 v32, v32, v34
  v_cvt_pk_bf16_f32 v30, v28, v32
  v_smfmac_f32_16x16x64_bf16 v[36:39], v[0:3], a[112:119], v74
  ds_write_b32 v79, v30 offset:256
  v_add_f32 v33, v33, v35
  v_cvt_pk_bf16_f32 v31, v29, v33
  v_smfmac_f32_16x16x64_bf16 v[40:43], v[0:3], a[120:127], v74
  ds_write_b32 v79, v31 offset:832
  v_xor_b32 v75, 0x8000, v75
  v_smfmac_f32_16x16x64_bf16 v[36:39], v[4:7], a[144:151], v74
  ds_read_b128 v[0:3], v76 offset:4608
  v_mov_b32 v29, 0
  v_smfmac_f32_16x16x64_bf16 v[40:43], v[4:7], a[152:159], v74
  s_waitcnt vmcnt(2) lgkmcnt(3)
  v_mov_b32 v30, 0
  v_mfma_f32_16x16x32_bf16 v[44:47], v[44:47], v[60:63], 0
  ds_read_b128 v[4:7], v76 offset:5632
  s_waitcnt lgkmcnt(2)
  v_mfma_f32_16x16x32_bf16 v[44:47], v[48:51], v[64:67], v[44:47]
  s_barrier
  v_smfmac_f32_16x16x64_bf16 v[36:39], v[8:11], a[160:167], v74
  ds_read_b128 v[20:23], v77 offset:256
  ds_read_b128 v[24:27], v77 offset:384
  v_smfmac_f32_16x16x64_bf16 v[40:43], v[8:11], a[168:175], v74
  ds_read_b128 v[8:11], v76 offset:6656
  v_add_f32_dpp v72, v46, v44 quad_perm:[2,3,0,1] row_mask:0xf bank_mask:0xf
  v_add_f32_dpp v73, v47, v45 quad_perm:[2,3,0,1] row_mask:0xf bank_mask:0xf
  v_smfmac_f32_16x16x64_bf16 v[36:39], v[12:15], a[96:103], v74
  s_waitcnt lgkmcnt(4)
  v_exp_f32_dpp v72, v72 quad_perm:[0,1,0,1] row_mask:0xf bank_mask:0xf
  v_smfmac_f32_16x16x64_bf16 v[40:43], v[12:15], a[104:111], v74
  ds_read_b128 v[12:15], v76 offset:7680
  v_exp_f32_dpp v73, v73 quad_perm:[0,1,0,1] row_mask:0xf bank_mask:0xf
  v_smfmac_f32_16x16x64_bf16 v[36:39], v[0:3], a[32:39], v74
  s_waitcnt lgkmcnt(2)
  v_cvt_pk_bf16_f32 v72, v72, v73
  v_mfma_f32_16x16x32_bf16 v[20:23], v[20:23], v[60:63], 0
  ds_write_b32 v78, v72 offset:520
  v_mov_b64 v[16:17], 0
  v_mfma_f32_16x16x32_bf16 v[20:23], v[24:27], v[64:67], v[20:23]
  ds_read_b128 v[44:47], v75 offset:24576
  v_mov_b64 v[18:19], 0
  v_smfmac_f32_16x16x64_bf16 v[40:43], v[0:3], a[40:47], v74
  ds_read_b128 v[48:51], v75 offset:25600
  v_mov_b64 v[68:69], s[78:79]
  v_smfmac_f32_16x16x64_bf16 v[36:39], v[4:7], a[48:55], v74
  s_waitcnt lgkmcnt(4)
  v_add_f32_dpp v24, v22, v20 quad_perm:[2,3,0,1] row_mask:0xf bank_mask:0xf
  v_add_f32_dpp v25, v23, v21 quad_perm:[2,3,0,1] row_mask:0xf bank_mask:0xf
  v_smfmac_f32_16x16x64_bf16 v[36:39], v[8:11], a[64:71], v74
  s_waitcnt lgkmcnt(2)
  s_barrier
  ds_read_b128 v[32:35], v78 offset:512
  v_smfmac_f32_16x16x64_bf16 v[36:39], v[12:15], a[80:87], v74
  ds_read_b128 v[60:63], v75 offset:26624
  v_mul_f32 v24, s69, v24
  v_smfmac_f32_16x16x64_bf16 v[40:43], v[4:7], a[56:63], v74
  ds_read_b128 v[64:67], v75 offset:27648
  v_mul_f32 v25, s69, v25
  v_smfmac_f32_16x16x64_bf16 v[40:43], v[8:11], a[72:79], v74
  v_exp_f32_dpp v24, v24 quad_perm:[0,1,0,1] row_mask:0xf bank_mask:0xf
  v_smfmac_f32_16x16x64_bf16 v[40:43], v[12:15], a[88:95], v74
  s_waitcnt lgkmcnt(2)
  v_exp_f32_dpp v25, v25 quad_perm:[0,1,0,1] row_mask:0xf bank_mask:0xf
  v_mfma_f32_16x16x32_bf16 v[8:11], v[32:35], v[68:71], 0
  v_add_f32 v36, v36, v38
  v_add_f32 v37, v37, v39
  v_mfma_f32_16x16x32_bf16 v[0:3], v[32:35], v[52:55], 0
  v_add_f32 v40, v40, v42
  v_add_f32 v41, v41, v43
  v_mfma_f32_16x16x32_bf16 v[4:7], v[32:35], v[56:59], 0
  v_cvt_pk_bf16_f32 v28, v24, v25
  v_cvt_pk_bf16_f32 v72, v36, v37
  v_cvt_pk_bf16_f32 v73, v40, v41
  v_mfma_f32_16x16x16_bf16 v[8:11], v[28:29], v[68:69], v[8:11]
  v_cvt_pk_bf16_f32 v31, v24, v25
  v_mov_b64 v[20:21], 0
  v_mfma_f32_16x16x16_bf16 v[0:3], v[28:29], v[72:73], v[0:3]
  ds_read_b128 v[68:71], v76 offset:13824
  v_mov_b64 v[22:23], 0
  v_mfma_f32_16x16x16_bf16 v[4:7], v[30:31], v[72:73], v[4:7]
  v_rcp_f32 v10, v8
  v_rcp_f32 v11, v9
  v_mul_f32 v0, v10, v0
  v_mul_f32 v1, v11, v1
  s_nop 0
  v_mul_f32 v4, v10, v4
  v_mul_f32 v5, v11, v5
  v_cvt_pk_bf16_f32 v2, v0, v4
  ds_write_b32 v79, v2 offset:8704
  v_cvt_pk_bf16_f32 v3, v1, v5
  ds_write_b32 v79, v3 offset:9280
  v_max3_f32 v8, v8, v9, v10
  v_max_f32 v8, v8, v11
  v_cmp_le_f32 vcc, 1317011456, v8
  v_mov_b64 v[24:25], 0
  v_mov_b64 v[26:27], 0
  s_cbranch_vccnz Cs2_mx
Cs2_mxok:
  s_waitcnt lgkmcnt(0)
  s_barrier
  ds_read_b128 v[0:3], v78 offset:8704
  ds_read_b128 v[4:7], v78 offset:8768
  ds_read_b128 v[8:11], v78 offset:8832
  ds_read_b128 v[12:15], v78 offset:8896
  s_waitcnt lgkmcnt(3)
  v_smfmac_f32_16x16x64_bf16 v[16:19], v[0:3], v[44:51], v74
  ds_read_b128 v[52:55], v75 offset:40960
  s_waitcnt lgkmcnt(3)
  v_smfmac_f32_16x16x64_bf16 v[16:19], v[4:7], v[60:67], v74
  ds_read_b128 v[56:59], v75 offset:41984
  s_waitcnt lgkmcnt(3)
  v_smfmac_f32_16x16x64_bf16 v[16:19], v[8:11], a[176:183], v74
  ds_read_b128 v[36:39], v75 offset:43008
  s_waitcnt lgkmcnt(3)
  v_smfmac_f32_16x16x64_bf16 v[16:19], v[12:15], a[184:191], v74
  ds_read_b128 v[40:43], v75 offset:44032
  ds_read_b128 v[44:47], v75 offset:57344
  v_smfmac_f32_16x16x64_bf16 v[20:23], v[0:3], a[192:199], v74
  ds_read_b128 v[48:51], v75 offset:58368
  ds_read_b128 v[60:63], v75 offset:59392
  v_smfmac_f32_16x16x64_bf16 v[20:23], v[4:7], a[200:207], v74
  ds_read_b128 v[64:67], v75 offset:60416
  s_waitcnt lgkmcnt(6)
  v_cvt_pk_bf16_f32 v16, v16, v17
  v_cvt_pk_bf16_f32 v17, v18, v19
  v_bfi_b32 v16, 1, s72, v16
  v_smfmac_f32_16x16x64_bf16 v[20:23], v[8:11], v[52:59], v74
  buffer_store_dwordx2 v[16:17], v68, s[8:11], s73 offen sc1
  s_waitcnt lgkmcnt(4)
  v_smfmac_f32_16x16x64_bf16 v[20:23], v[12:15], v[36:43], v74
  ds_read_b128 v[52:55], v75 offset:0
  v_mov_b64 v[32:33], 0
  v_smfmac_f32_16x16x64_bf16 v[24:27], v[0:3], a[208:215], v74
  ds_read_b128 v[56:59], v75 offset:1024
  v_mov_b64 v[34:35], 0
  v_smfmac_f32_16x16x64_bf16 v[24:27], v[4:7], a[216:223], v74
  ds_read_b128 v[36:39], v75 offset:2048
  s_waitcnt lgkmcnt(5)
  v_cvt_pk_bf16_f32 v20, v20, v21
  v_cvt_pk_bf16_f32 v21, v22, v23
  v_bfi_b32 v20, 1, s72, v20
  v_smfmac_f32_16x16x64_bf16 v[24:27], v[8:11], v[44:51], v74
  buffer_store_dwordx2 v[20:21], v68, s[8:11], s74 offen sc1
  s_waitcnt lgkmcnt(3)
  v_smfmac_f32_16x16x64_bf16 v[24:27], v[12:15], v[60:67], v74
  ds_read_b128 v[40:43], v75 offset:3072
  v_mov_b64 v[28:29], 0
  v_smfmac_f32_16x16x64_bf16 v[32:35], v[0:3], a[224:231], v74
  ds_read_b128 v[44:47], v75 offset:4096
  ds_read_b128 v[48:51], v75 offset:5120
  v_smfmac_f32_16x16x64_bf16 v[32:35], v[4:7], a[232:239], v74
  ds_read_b128 v[60:63], v75 offset:6144
  v_cvt_pk_bf16_f32 v24, v24, v25
  v_cvt_pk_bf16_f32 v25, v26, v27
  v_bfi_b32 v24, 1, s72, v24
  v_smfmac_f32_16x16x64_bf16 v[32:35], v[8:11], a[240:247], v74
  buffer_store_dwordx2 v[24:25], v68, s[8:11], s75 offen sc1
  v_mov_b64 v[30:31], 0
  v_smfmac_f32_16x16x64_bf16 v[32:35], v[12:15], a[248:255], v74
  ds_read_b128 v[64:67], v75 offset:7168
  s_waitcnt lgkmcnt(6)
  v_smfmac_f32_16x16x64_bf16 v[28:31], v[0:3], v[52:59], v74
  s_waitcnt lgkmcnt(4)
  v_smfmac_f32_16x16x64_bf16 v[28:31], v[4:7], v[36:43], v74
  s_waitcnt lgkmcnt(2)
  v_cvt_pk_bf16_f32 v32, v32, v33
  v_cvt_pk_bf16_f32 v33, v34, v35
  v_bfi_b32 v32, 1, s72, v32
  v_smfmac_f32_16x16x64_bf16 v[28:31], v[8:11], v[44:51], v74
  buffer_store_dwordx2 v[32:33], v68, s[8:11], s76 offen sc1
  s_waitcnt lgkmcnt(0)
  v_smfmac_f32_16x16x64_bf16 v[28:31], v[12:15], v[60:67], v74
  ds_read_b128 v[0:3], v76 offset:14848
  ds_read_b64 v[16:17], v77 offset:384
  v_mov_b64 v[18:19], v[72:73]
  v_xor_b32 v75, 0x8000, v75
  s_nop 3
  v_cvt_pk_bf16_f32 v28, v28, v29
  v_cvt_pk_bf16_f32 v29, v30, v31
  v_bfi_b32 v28, 1, s72, v28
  buffer_store_dwordx2 v[28:29], v68, s[8:11], s77 offen sc1
  v_mov_b64 v[20:21], 0
  v_mov_b64 v[22:23], 0
  v_mov_b64 v[24:25], 0
  v_mov_b64 v[26:27], 0
  v_mov_b64 v[28:29], 0
  v_mov_b64 v[30:31], 0
  v_mov_b64 v[32:33], 0
  v_mov_b64 v[34:35], 0
  v_mov_b32 v68, 14880
  s_add_u32 s58, s58, 655360
  s_add_u32 s59, s59, 655360
  s_add_u32 s70, s70, 655360
  s_add_u32 s68, s68, 655360
  s_add_u32 s66, s66, 1
  s_xor_b32 s64, s64, 16384
  s_xor_b32 s65, s65, 16384
  s_cmp_eq_u32 s66, 62
  s_cselect_b64 s[16:17], s[20:21], s[16:17]
  s_cselect_b32 s18, (Cs2_done - Cs2_last), s18
  s_cselect_b32 s70, 0, s70
  s_cmp_eq_u32 s66, 63
  s_cselect_b32 s59, 268435456, s59
  s_cselect_b32 s58, 268435456, s58
  s_nop 15
  s_nop 11
  buffer_load_dwordx4 v[52:55], v76, s[8:11], s60 offen offset:0 sc1
  buffer_load_dwordx4 v[56:59], v76, s[8:11], s60 offen offset:1024 sc1
  s_waitcnt lgkmcnt(0)
  s_waitcnt vmcnt(1)
  v_mfma_f32_16x16x32_bf16 v[4:7], v[0:3], v[52:55], 0
  v_bitop3_b32 v72, v52, v54, s72 bitop3:0x7e
  s_waitcnt vmcnt(0)
  v_mfma_f32_16x16x32_bf16 v[4:7], v[0:3], v[56:59], v[4:7]
  v_bitop3_b32 v73, v56, v58, s72 bitop3:0x7e
  v_bitop3_b32 v72, v72, v73, 1 bitop3:0xa8
  v_cmp_ne_u32 vcc, 0, v72
  s_nop 0
  s_cmp_eq_u64 vcc, 0
  s_cselect_b32 s54, s62, 268435456
  s_nop 0
  v_add_f32_dpp v4, v4, v4 row_ror:4 row_mask:0xf bank_mask:0xf
  v_add_f32_dpp v5, v5, v5 row_ror:4 row_mask:0xf bank_mask:0xf
  s_nop 0
  v_add_f32_dpp v4, v4, v4 row_ror:8 row_mask:0xf bank_mask:0xf
  v_add_f32_dpp v5, v5, v5 row_ror:8 row_mask:0xf bank_mask:0xf
  v_cvt_pk_bf16_f32 v4, v4, v5
  buffer_store_dword v4, v69, s[8:11], s54 offen sc1
  s_cbranch_vccnz Cs2_h1r
  s_xor_b32 s62, s62, 16384
  buffer_store_dword v71, v69, s[8:11], s62 offen sc1
  s_xor_b32 s72, s72, 1
  s_branch Cs2_h2
Cs2_h1r:
  s_mov_b64 exec, vcc
  buffer_load_dwordx4 v[52:55], v76, s[8:11], s60 offen offset:0 sc1
  buffer_load_dwordx4 v[56:59], v76, s[8:11], s60 offen offset:1024 sc1
  s_mov_b64 exec, -1
  s_add_u32 s67, s67, 1
  s_waitcnt vmcnt(1)
  v_mfma_f32_16x16x32_bf16 v[4:7], v[0:3], v[52:55], 0
  v_bitop3_b32 v72, v52, v54, s72 bitop3:0x7e
  s_waitcnt vmcnt(0)
  v_mfma_f32_16x16x32_bf16 v[4:7], v[0:3], v[56:59], v[4:7]
  v_bitop3_b32 v73, v56, v58, s72 bitop3:0x7e
  v_bitop3_b32 v72, v72, v73, 1 bitop3:0xa8
  v_cmp_ne_u32 vcc, 0, v72
  s_cbranch_vccz Cs2_h1p
Cs2_h1s:
  s_mov_b64 exec, vcc
  buffer_load_dwordx4 v[52:55], v76, s[8:11], s60 offen offset:0 sc1
  buffer_load_dwordx4 v[56:59], v76, s[8:11], s60 offen offset:1024 sc1
  s_mov_b64 exec, -1
  s_add_u32 s67, s67, 1
  s_waitcnt vmcnt(1)
  v_mfma_f32_16x16x32_bf16 v[4:7], v[0:3], v[52:55], 0
  v_bitop3_b32 v72, v52, v54, s72 bitop3:0x7e
  s_waitcnt vmcnt(0)
  v_mfma_f32_16x16x32_bf16 v[4:7], v[0:3], v[56:59], v[4:7]
  v_bitop3_b32 v73, v56, v58, s72 bitop3:0x7e
  v_bitop3_b32 v72, v72, v73, 1 bitop3:0xa8
  v_cmp_ne_u32 vcc, 0, v72
  s_cbranch_vccz Cs2_h1p
  s_cmp_lt_u32 s67, 131072
  s_cbranch_scc1 Cs2_h1s
Cs2_h1p:
  s_nop 2
  v_add_f32_dpp v4, v4, v4 row_ror:4 row_mask:0xf bank_mask:0xf
  v_add_f32_dpp v5, v5, v5 row_ror:4 row_mask:0xf bank_mask:0xf
  s_nop 0
  v_add_f32_dpp v4, v4, v4 row_ror:8 row_mask:0xf bank_mask:0xf
  v_add_f32_dpp v5, v5, v5 row_ror:8 row_mask:0xf bank_mask:0xf
  v_cvt_pk_bf16_f32 v4, v4, v5
  buffer_store_dword v4, v69, s[8:11], s62 offen sc1
  s_xor_b32 s62, s62, 16384
  buffer_store_dword v71, v69, s[8:11], s62 offen sc1
  s_xor_b32 s72, s72, 1
  s_branch Cs2_h2
Cs2_h2r:
  s_mov_b64 exec, vcc
  buffer_load_dwordx4 v[12:15], v76, s[8:11], s65 offen offset:3072 sc1
  s_mov_b64 exec, -1
  s_add_u32 s67, s67, 1
  s_waitcnt vmcnt(4)
  v_max3_u32 v72, v12, v13, v14
  v_max_u32 v72, v72, v15
  ds_write_b128 v76, v[12:15] offset:7680
  v_cmp_eq_u32 vcc, -1, v72
  s_cbranch_vccz Cs2_h2w
  s_mov_b64 exec, vcc
  buffer_load_dwordx4 v[12:15], v76, s[8:11], s65 offen offset:3072 sc1
  s_mov_b64 exec, -1
  s_add_u32 s67, s67, 1
  s_waitcnt vmcnt(4)
  v_max3_u32 v72, v12, v13, v14
  v_max_u32 v72, v72, v15
  ds_write_b128 v76, v[12:15] offset:7680
  v_cmp_eq_u32 vcc, -1, v72
  s_cbranch_vccz Cs2_h2w
Cs2_h2s:
  s_mov_b64 exec, vcc
  buffer_load_dwordx4 v[12:15], v76, s[8:11], s65 offen offset:3072 sc1
  s_mov_b64 exec, -1
  s_add_u32 s67, s67, 1
  s_waitcnt vmcnt(2)
  v_max3_u32 v72, v12, v13, v14
  v_max_u32 v72, v72, v15
  ds_write_b128 v76, v[12:15] offset:7680
  v_cmp_eq_u32 vcc, -1, v72
  s_cbranch_vccz Cs2_h2w
  s_mov_b64 exec, vcc
  buffer_load_dwordx4 v[12:15], v76, s[8:11], s65 offen offset:3072 sc1
  s_mov_b64 exec, -1
  s_add_u32 s67, s67, 1
  s_waitcnt vmcnt(2)
  v_max3_u32 v72, v12, v13, v14
  v_max_u32 v72, v72, v15
  ds_write_b128 v76, v[12:15] offset:7680
  v_cmp_eq_u32 vcc, -1, v72
  s_cbranch_vccz Cs2_h2w
  s_mov_b64 exec, vcc
  buffer_load_dwordx4 v[12:15], v76, s[8:11], s65 offen offset:3072 sc1
  s_mov_b64 exec, -1
  s_add_u32 s67, s67, 1
  s_waitcnt vmcnt(2)
  v_max3_u32 v72, v12, v13, v14
  v_max_u32 v72, v72, v15
  ds_write_b128 v76, v[12:15] offset:7680
  v_cmp_eq_u32 vcc, -1, v72
  s_cbranch_vccz Cs2_h2w
  s_cmp_lt_u32 s67, 131072
  s_cbranch_scc1 Cs2_h2s
  s_branch Cs2_h2w
Cs2_rec:
  s_nop 7
  s_waitcnt vmcnt(0) lgkmcnt(0)
  v_max3_u32 v72, v0, v1, v2
  v_max3_u32 v72, v72, v3, v4
  v_max3_u32 v72, v72, v5, v6
  v_max3_u32 v72, v72, v7, v8
  v_max3_u32 v72, v72, v9, v10
  v_max3_u32 v72, v72, v11, v12
  v_max3_u32 v72, v72, v13, v14
  v_max3_u32 v72, v72, v15, v16
  v_max3_u32 v72, v72, v17, v18
  v_max_u32 v72, v72, v19
  v_cmp_eq_u32 vcc, -1, v72
  s_cbranch_vccz Cs2_recok
  s_barrier
Cs2_recp:
  buffer_load_dwordx4 v[0:3], v76, s[8:11], s64 offen offset:0 sc1
  buffer_load_dwordx4 v[4:7], v76, s[8:11], s64 offen offset:1024 sc1
  s_add_u32 s67, s67, 1
  s_cmp_lt_u32 s67, 131072
  s_cselect_b32 s54, -2, -1
  s_waitcnt vmcnt(1)
  v_max3_u32 v72, v0, v1, v2
  s_waitcnt vmcnt(0)
  v_max3_u32 v72, v72, v3, v4
  v_max3_u32 v72, v72, v5, v6
  v_max_u32 v72, v72, v7
  v_cmp_lt_u32 vcc, s54, v72
  s_cbranch_vccnz Cs2_recp
  ds_write_b128 v76, v[0:3] offset:8704
  ds_write_b128 v76, v[4:7] offset:9728
  v_mov_b64 v[20:21], 0
  v_mov_b64 v[22:23], 0
  v_mov_b64 v[24:25], 0
  v_mov_b64 v[26:27], 0
  v_mov_b64 v[28:29], 0
  v_mov_b64 v[30:31], 0
  v_mov_b64 v[32:33], 0
  v_mov_b64 v[34:35], 0
  s_waitcnt lgkmcnt(0)
  s_barrier
  ds_read_b128 v[0:3], v76 offset:4608
  s_waitcnt lgkmcnt(0)
  v_smfmac_f32_16x16x64_bf16 v[20:23], v[0:3], v[80:87], v74
  v_smfmac_f32_16x16x64_bf16 v[24:27], v[0:3], v[88:95], v74
  ds_read_b128 v[60:63], v76 offset:24576
  ds_read_b128 v[64:67], v76 offset:25600
  s_waitcnt lgkmcnt(0)
  v_smfmac_f32_16x16x64_bf16 v[28:31], v[0:3], v[60:67], v74
  ds_read_b128 v[60:63], v76 offset:26624
  ds_read_b128 v[64:67], v76 offset:27648
  s_waitcnt lgkmcnt(0)
  v_smfmac_f32_16x16x64_bf16 v[32:35], v[0:3], v[60:67], v74
  ds_read_b128 v[4:7], v76 offset:5632
  s_waitcnt lgkmcnt(0)
  v_smfmac_f32_16x16x64_bf16 v[20:23], v[4:7], v[96:103], v74
  v_smfmac_f32_16x16x64_bf16 v[24:27], v[4:7], v[104:111], v74
  ds_read_b128 v[60:63], v76 offset:40960
  ds_read_b128 v[64:67], v76 offset:41984
  s_waitcnt lgkmcnt(0)
  v_smfmac_f32_16x16x64_bf16 v[28:31], v[4:7], v[60:67], v74
  ds_read_b128 v[60:63], v76 offset:43008
  ds_read_b128 v[64:67], v76 offset:44032
  s_waitcnt lgkmcnt(0)
  v_smfmac_f32_16x16x64_bf16 v[32:35], v[4:7], v[60:67], v74
  ds_read_b128 v[8:11], v76 offset:6656
  s_waitcnt lgkmcnt(0)
  v_smfmac_f32_16x16x64_bf16 v[20:23], v[8:11], v[112:119], v74
  v_smfmac_f32_16x16x64_bf16 v[24:27], v[8:11], v[120:127], v74
  v_smfmac_f32_16x16x64_bf16 v[28:31], v[8:11], v[208:215], v74
  v_smfmac_f32_16x16x64_bf16 v[32:35], v[8:11], v[216:223], v74
  ds_read_b128 v[12:15], v76 offset:7680
  s_waitcnt lgkmcnt(0)
  v_smfmac_f32_16x16x64_bf16 v[20:23], v[12:15], v[128:135], v74
  v_smfmac_f32_16x16x64_bf16 v[24:27], v[12:15], v[136:143], v74
  v_smfmac_f32_16x16x64_bf16 v[28:31], v[12:15], v[224:231], v74
  v_smfmac_f32_16x16x64_bf16 v[32:35], v[12:15], v[232:239], v74
  ds_read_b128 v[12:15], v76 offset:8704
  s_waitcnt lgkmcnt(0)
  v_smfmac_f32_16x16x64_bf16 v[20:23], v[12:15], v[144:151], v74
  v_smfmac_f32_16x16x64_bf16 v[24:27], v[12:15], v[152:159], v74
  ds_read_b128 v[60:63], v76 offset:57344
  ds_read_b128 v[64:67], v76 offset:58368
  s_waitcnt lgkmcnt(0)
  v_smfmac_f32_16x16x64_bf16 v[28:31], v[12:15], v[60:67], v74
  ds_read_b128 v[60:63], v76 offset:59392
  ds_read_b128 v[64:67], v76 offset:60416
  s_waitcnt lgkmcnt(0)
  v_smfmac_f32_16x16x64_bf16 v[32:35], v[12:15], v[60:67], v74
  ds_read_b128 v[0:3], v76 offset:9728
  s_waitcnt lgkmcnt(0)
  v_smfmac_f32_16x16x64_bf16 v[20:23], v[0:3], v[160:167], v74
  v_smfmac_f32_16x16x64_bf16 v[24:27], v[0:3], v[168:175], v74
  ds_read_b128 v[60:63], v75 offset:24576
  ds_read_b128 v[64:67], v75 offset:25600
  s_waitcnt lgkmcnt(0)
  v_smfmac_f32_16x16x64_bf16 v[28:31], v[0:3], v[60:67], v74
  ds_read_b128 v[60:63], v75 offset:26624
  ds_read_b128 v[64:67], v75 offset:27648
  s_waitcnt lgkmcnt(0)
  v_smfmac_f32_16x16x64_bf16 v[32:35], v[0:3], v[60:67], v74
  ds_read_b128 v[16:19], v76 offset:10752
  ds_read_b128 v[60:63], v75 offset:8192
  ds_read_b128 v[64:67], v75 offset:9216
  s_waitcnt lgkmcnt(0)
  v_smfmac_f32_16x16x64_bf16 v[20:23], v[16:19], v[60:67], v74
  ds_read_b128 v[60:63], v75 offset:10240
  ds_read_b128 v[64:67], v75 offset:11264
  s_waitcnt lgkmcnt(0)
  v_smfmac_f32_16x16x64_bf16 v[24:27], v[16:19], v[60:67], v74
  v_smfmac_f32_16x16x64_bf16 v[28:31], v[16:19], v[240:247], v74
  v_smfmac_f32_16x16x64_bf16 v[32:35], v[16:19], v[248:255], v74
  ds_read_b128 v[4:7], v76 offset:11776
  s_waitcnt lgkmcnt(0)
  v_smfmac_f32_16x16x64_bf16 v[20:23], v[4:7], v[176:183], v74
  v_smfmac_f32_16x16x64_bf16 v[24:27], v[4:7], v[184:191], v74
  v_smfmac_f32_16x16x64_bf16 v[28:31], v[4:7], a[0:7], v74
  v_smfmac_f32_16x16x64_bf16 v[32:35], v[4:7], a[8:15], v74
  ds_read_b128 v[8:11], v76 offset:12800
  s_waitcnt lgkmcnt(0)
  v_smfmac_f32_16x16x64_bf16 v[20:23], v[8:11], v[192:199], v74
  v_smfmac_f32_16x16x64_bf16 v[24:27], v[8:11], v[200:207], v74
  v_smfmac_f32_16x16x64_bf16 v[28:31], v[8:11], a[16:23], v74
  v_smfmac_f32_16x16x64_bf16 v[32:35], v[8:11], a[24:31], v74
  v_add_f32 v20, v20, v22
  v_add_f32 v21, v21, v23
  v_add_f32 v24, v24, v26
  v_cvt_pk_bf16_f32 v22, v20, v24
  ds_write_b32 v79, v22 offset:0
  v_add_f32 v25, v25, v27
  v_cvt_pk_bf16_f32 v23, v21, v25
  ds_write_b32 v79, v23 offset:576
  v_add_f32 v28, v28, v30
  v_add_f32 v29, v29, v31
  s_waitcnt lgkmcnt(0)
  s_nop 1
  s_branch Cs2_recok
Cs2_mx:
  s_waitcnt lgkmcnt(0)
  s_barrier
  buffer_load_dwordx4 v[0:3], v76, s[8:11], s58 offen offset:0 sc1
  ds_read_b128 v[20:23], v77 offset:0
  ds_read_b128 v[28:31], v77 offset:256
  buffer_load_dwordx4 v[4:7], v76, s[8:11], s58 offen offset:1024 sc1
  ds_read_b128 v[24:27], v77 offset:128
  ds_read_b128 v[32:35], v77 offset:384
  s_waitcnt vmcnt(1) lgkmcnt(3)
  v_mfma_f32_16x16x32_bf16 v[8:11], v[0:3], v[20:23], 0
  s_waitcnt vmcnt(0) lgkmcnt(1)
  v_mfma_f32_16x16x32_bf16 v[8:11], v[4:7], v[24:27], v[8:11]
  v_mfma_f32_16x16x32_bf16 v[12:15], v[28:31], v[20:23], 0
  s_waitcnt lgkmcnt(0)
  v_mfma_f32_16x16x32_bf16 v[12:15], v[32:35], v[24:27], v[12:15]
  v_add_f32_dpp v8, v10, v8 quad_perm:[2,3,0,1] row_mask:0xf bank_mask:0xf
  v_add_f32_dpp v9, v11, v9 quad_perm:[2,3,0,1] row_mask:0xf bank_mask:0xf
  s_nop 0
  v_mov_b32_dpp v8, v8 quad_perm:[0,1,0,1] row_mask:0xf bank_mask:0xf
  v_mov_b32_dpp v9, v9 quad_perm:[0,1,0,1] row_mask:0xf bank_mask:0xf
  s_nop 1
  v_add_f32_dpp v12, v14, v12 quad_perm:[2,3,0,1] row_mask:0xf bank_mask:0xf
  v_add_f32_dpp v13, v15, v13 quad_perm:[2,3,0,1] row_mask:0xf bank_mask:0xf
  s_nop 0
  v_mov_b32_dpp v12, v12 quad_perm:[0,1,0,1] row_mask:0xf bank_mask:0xf
  v_mov_b32_dpp v13, v13 quad_perm:[0,1,0,1] row_mask:0xf bank_mask:0xf
  v_mul_f32 v12, s69, v12
  ds_write_b32 v78, v8 offset:8712
  v_mul_f32 v13, s69, v13
  ds_write_b32 v78, v9 offset:8776
  s_waitcnt lgkmcnt(0)
  s_barrier
  ds_read_b128 v[36:39], v78 offset:8704
  ds_read_b128 v[40:43], v78 offset:8768
  s_waitcnt lgkmcnt(0)
  s_barrier
  v_max_f32 v16, v36, v37
  v_max3_f32 v16, v16, v38, v39
  v_max3_f32 v16, v16, v40, v41
  v_max3_f32 v16, v16, v42, v43
  v_max3_f32 v16, v16, v12, v13
  v_mov_b32 v17, v16
  s_nop 1
  v_permlane16_swap_b32 v16, v17
  v_max_f32 v16, v16, v17
  v_mov_b32 v17, v16
  s_nop 1
  v_permlane32_swap_b32 v16, v17
  v_max_f32 v16, v16, v17
  v_sub_f32 v36, v36, v16
  v_sub_f32 v37, v37, v16
  v_sub_f32 v38, v38, v16
  v_sub_f32 v39, v39, v16
  v_sub_f32 v40, v40, v16
  v_sub_f32 v41, v41, v16
  v_sub_f32 v42, v42, v16
  v_sub_f32 v43, v43, v16
  v_sub_f32 v12, v12, v16
  v_sub_f32 v13, v13, v16
  v_exp_f32 v36, v36
  v_exp_f32 v37, v37
  v_exp_f32 v38, v38
  v_exp_f32 v39, v39
  v_exp_f32 v40, v40
  v_exp_f32 v41, v41
  v_exp_f32 v42, v42
  v_exp_f32 v43, v43
  v_exp_f32 v12, v12
  v_exp_f32 v13, v13
  v_cvt_pk_bf16_f32 v32, v36, v40
  v_cvt_pk_bf16_f32 v33, v37, v41
  v_cvt_pk_bf16_f32 v34, v38, v42
  v_cvt_pk_bf16_f32 v35, v39, v43
  v_cvt_pk_bf16_f32 v28, v12, v13
  v_cvt_pk_bf16_f32 v31, v12, v13
  v_mov_b32 v29, 0
  v_mov_b32 v30, 0
  v_mov_b32 v68, 0x3f803f80
  v_mov_b32 v69, 0x3f803f80
  v_mov_b32 v70, 0x3f803f80
  v_mov_b32 v71, 0x3f803f80
  s_nop 1
  v_mfma_f32_16x16x32_bf16 v[8:11], v[32:35], v[68:71], 0
  v_mfma_f32_16x16x32_bf16 v[0:3], v[32:35], v[52:55], 0
  v_mfma_f32_16x16x32_bf16 v[4:7], v[32:35], v[56:59], 0
  v_mfma_f32_16x16x16_bf16 v[8:11], v[28:29], v[68:69], v[8:11]
  v_mfma_f32_16x16x16_bf16 v[0:3], v[28:29], v[72:73], v[0:3]
  v_mfma_f32_16x16x16_bf16 v[4:7], v[30:31], v[72:73], v[4:7]
  ds_read_b128 v[68:71], v76 offset:13824
  v_rcp_f32 v10, v8
  v_rcp_f32 v11, v9
  v_mul_f32 v0, v10, v0
  v_mul_f32 v1, v11, v1
  s_nop 0
  v_mul_f32 v4, v10, v4
  v_mul_f32 v5, v11, v5
  v_cvt_pk_bf16_f32 v2, v0, v4
  ds_write_b32 v79, v2 offset:8704
  v_cvt_pk_bf16_f32 v3, v1, v5
  ds_write_b32 v79, v3 offset:9280
  v_mov_b64 v[16:17], 0
  v_mov_b64 v[18:19], 0
  v_mov_b64 v[20:21], 0
  v_mov_b64 v[22:23], 0
  v_mov_b64 v[24:25], 0
  v_mov_b64 v[26:27], 0
  s_branch Cs2_mxok
Cs2_last:
  ds_read_b128 v[4:7], v76 offset:5632
  ds_read_b128 v[8:11], v76 offset:6656
  ds_read_b128 v[44:47], v76 offset:40960
  ds_read_b128 v[48:51], v76 offset:41984
  s_nop 5
  v_mov_b64 v[20:21], 0
  v_mov_b64 v[22:23], 0
  v_mov_b64 v[24:25], 0
  v_mov_b64 v[26:27], 0
  s_waitcnt lgkmcnt(4)
  v_smfmac_f32_16x16x64_bf16 v[28:31], v[0:3], v[36:43], v74
  ds_read_b128 v[36:39], v76 offset:43008
  ds_read_b128 v[40:43], v76 offset:44032
  v_smfmac_f32_16x16x64_bf16 v[32:35], v[0:3], v[60:67], v74
  s_waitcnt lgkmcnt(5)
  v_smfmac_f32_16x16x64_bf16 v[20:23], v[0:3], a[32:39], v74
  ds_read_b128 v[60:63], v76 offset:57344
  ds_read_b128 v[64:67], v76 offset:58368
  v_smfmac_f32_16x16x64_bf16 v[24:27], v[0:3], a[40:47], v74
  s_waitcnt lgkmcnt(4)
  v_smfmac_f32_16x16x64_bf16 v[20:23], v[4:7], a[48:55], v74
  buffer_store_dwordx4 v[16:19], v76, s[8:11], s68 offen sc1
  v_smfmac_f32_16x16x64_bf16 v[24:27], v[4:7], a[56:63], v74
  v_smfmac_f32_16x16x64_bf16 v[28:31], v[4:7], v[44:51], v74
  s_waitcnt lgkmcnt(2)
  v_smfmac_f32_16x16x64_bf16 v[20:23], v[8:11], a[64:71], v74
  ds_read_b128 v[44:47], v76 offset:59392
  ds_read_b128 v[48:51], v76 offset:60416
  v_smfmac_f32_16x16x64_bf16 v[24:27], v[8:11], a[72:79], v74
  v_smfmac_f32_16x16x64_bf16 v[32:35], v[4:7], v[36:43], v74
  v_smfmac_f32_16x16x64_bf16 v[28:31], v[8:11], v[208:215], v74
  ds_read_b128 v[36:39], v75 offset:24576
  ds_read_b128 v[40:43], v75 offset:25600
  v_smfmac_f32_16x16x64_bf16 v[32:35], v[8:11], v[216:223], v74
  v_smfmac_f32_16x16x64_bf16 v[20:23], v[12:15], a[80:87], v74
  v_smfmac_f32_16x16x64_bf16 v[24:27], v[12:15], a[88:95], v74
  v_smfmac_f32_16x16x64_bf16 v[28:31], v[12:15], v[224:231], v74
  v_smfmac_f32_16x16x64_bf16 v[32:35], v[12:15], v[232:239], v74
  s_waitcnt vmcnt(2)
  s_waitcnt vmcnt(1)
  s_barrier
Cs2_lastr:
  ds_read_b128 v[12:15], v76 offset:8704
  ds_read_b128 v[0:3], v76 offset:9728
  ds_read_b128 v[16:19], v76 offset:10752
  ds_read_b128 v[4:7], v76 offset:11776
  ds_read_b128 v[8:11], v76 offset:12800
  s_waitcnt lgkmcnt(3)
  v_max3_u32 v72, v0, v1, v2
  s_waitcnt lgkmcnt(1)
  v_max3_u32 v72, v72, v3, v4
  v_max3_u32 v72, v72, v5, v6
  s_waitcnt lgkmcnt(0)
  v_max3_u32 v72, v72, v7, v8
  v_max3_u32 v72, v72, v9, v10
  v_max3_u32 v72, v72, v11, v12
  v_max3_u32 v72, v72, v13, v14
  v_max3_u32 v72, v72, v15, v16
  v_max3_u32 v72, v72, v17, v18
  v_max_u32 v72, v72, v19
  v_cmp_eq_u32 vcc, -1, v72
  s_cbranch_vccnz Cs2_lastp
Cs2_lastg:
  v_smfmac_f32_16x16x64_bf16 v[28:31], v[12:15], v[60:67], v74
  ds_read_b128 v[60:63], v75 offset:26624
  ds_read_b128 v[64:67], v75 offset:27648
  v_smfmac_f32_16x16x64_bf16 v[32:35], v[12:15], v[44:51], v74
  v_smfmac_f32_16x16x64_bf16 v[28:31], v[0:3], v[36:43], v74
  v_smfmac_f32_16x16x64_bf16 v[28:31], v[16:19], v[240:247], v74
  v_smfmac_f32_16x16x64_bf16 v[28:31], v[4:7], a[0:7], v74
  v_smfmac_f32_16x16x64_bf16 v[28:31], v[8:11], a[16:23], v74
  v_smfmac_f32_16x16x64_bf16 v[32:35], v[16:19], v[248:255], v74
  v_smfmac_f32_16x16x64_bf16 v[32:35], v[4:7], a[8:15], v74
  s_waitcnt lgkmcnt(0)
  v_smfmac_f32_16x16x64_bf16 v[32:35], v[8:11], a[24:31], v74
  v_smfmac_f32_16x16x64_bf16 v[32:35], v[0:3], v[60:67], v74
  v_smfmac_f32_16x16x64_bf16 v[20:23], v[12:15], a[96:103], v74
  v_smfmac_f32_16x16x64_bf16 v[20:23], v[0:3], a[112:119], v74
  v_add_f32 v28, v28, v30
  v_add_f32 v32, v32, v34
  v_cvt_pk_bf16_f32 v30, v28, v32
  v_smfmac_f32_16x16x64_bf16 v[20:23], v[16:19], a[128:135], v74
  ds_write_b32 v79, v30 offset:256
  v_add_f32 v29, v29, v31
  v_add_f32 v33, v33, v35
  v_cvt_pk_bf16_f32 v31, v29, v33
  v_smfmac_f32_16x16x64_bf16 v[20:23], v[4:7], a[144:151], v74
  ds_write_b32 v79, v31 offset:832
  v_smfmac_f32_16x16x64_bf16 v[20:23], v[8:11], a[160:167], v74
  v_smfmac_f32_16x16x64_bf16 v[24:27], v[12:15], a[104:111], v74
  v_smfmac_f32_16x16x64_bf16 v[24:27], v[0:3], a[120:127], v74
  v_smfmac_f32_16x16x64_bf16 v[24:27], v[16:19], a[136:143], v74
  s_waitcnt lgkmcnt(0)
  s_barrier
  ds_read_b64 v[52:53], v77 offset:384
  v_add_f32 v20, v20, v22
  v_smfmac_f32_16x16x64_bf16 v[24:27], v[4:7], a[152:159], v74
  v_add_f32 v21, v21, v23
  v_smfmac_f32_16x16x64_bf16 v[24:27], v[8:11], a[168:175], v74
  v_cvt_pk_bf16_f32 v54, v20, v21
  s_add_u32 s68, s68, 655360
  s_nop 3
  v_add_f32 v24, v24, v26
  v_add_f32 v25, v25, v27
  v_cvt_pk_bf16_f32 v55, v24, v25
  s_waitcnt lgkmcnt(0)
  buffer_store_dwordx4 v[52:55], v76, s[8:11], s68 offen sc1
  s_branch Cs2_done
Cs2_lastp:
  s_add_u32 s72, s72, 2
  s_cmp_ge_u32 s72, 131072
  s_cbranch_scc1 Cs2_lastg
  s_barrier
  buffer_load_dwordx4 v76, s[8:11], s55 offen offset:0 sc1 lds
  s_waitcnt vmcnt(0)
  s_barrier
  s_branch Cs2_lastr
Cs2_done:
  s_branch L_cexit
L_w7:
  v_mov_b64 v[20:21], 0
  v_mov_b64 v[22:23], 0
  v_mov_b64 v[24:25], 0
  v_mov_b64 v[26:27], 0
  v_mov_b64 v[28:29], 0
  v_mov_b64 v[30:31], 0
  v_mov_b64 v[32:33], 0
  v_mov_b64 v[34:35], 0
  s_mov_b32 s78, 0x3f803f80
  s_mov_b32 s79, s78
  s_mov_b32 s65, 360448
  s_mov_b32 m0, 15872
  s_lshl_b32 s71, s53, 2
  s_add_u32 s71, s71, 128
  s_movk_i32 s56, 0x1000
  v_lshlrev_b32 v73, 2, v76
  v_mov_b32 v72, 0
  s_mov_b64 s[16:17], s[8:9]
  s_mov_b32 s18, 268435456
  s_mov_b32 s19, 0x20000
  s_getpc_b64 s[20:21]
Cs3_pc:
  s_add_u32 s20, s20, (Cs3_last - Cs3_pc)
  s_addc_u32 s21, s21, 0
  v_mov_b32 v68, 14880
  buffer_load_dwordx4 v[52:55], v76, s[8:11], s59 offen offset:0 sc1
  buffer_load_dwordx4 v[56:59], v76, s[8:11], s59 offen offset:1024 sc1
  ds_read_b128 v[36:39], v76 offset:45056
  ds_read_b128 v[40:43], v76 offset:46080
  ds_read_b128 v[60:63], v76 offset:47104
  ds_read_b128 v[64:67], v76 offset:48128
  ds_read_b128 v[0:3], v76 offset:4608
  ds_read_b128 v[4:7], v76 offset:5632
  ds_read_b128 v[8:11], v76 offset:6656
  ds_read_b128 v[12:15], v76 offset:7680
  s_waitcnt lgkmcnt(0)
  s_cmp_eq_u32 s66, 1
  s_branch Cs3_top2
.p2align 6
Cs3_h2:
  v_lshlrev_b32 v73, 2, v76
  s_mov_b32 m0, 8704
  s_add_u32 s55, s65, 4096
  buffer_load_dwordx4 v[4:7], v76, s[8:11], s65 offen offset:1024 sc1
  s_waitcnt vmcnt(6)
  ds_read_b128 v[36:39], v76 offset:45056
  ds_read_b128 v[40:43], v76 offset:46080
  ds_read_b128 v[60:63], v76 offset:47104
  ds_read_b128 v[64:67], v76 offset:48128
  buffer_load_dwordx4 v[52:55], v76, s[8:11], s59 offen offset:0 sc1
  buffer_load_dwordx4 v[56:59], v76, s[8:11], s59 offen offset:1024 sc1
  s_waitcnt vmcnt(7)
  v_max3_u32 v72, v4, v5, v6
  v_max_u32 v72, v72, v7
  ds_write_b128 v76, v[4:7] offset:5632
  v_cmp_eq_u32 vcc, -1, v72
  s_cbranch_vccnz Cs3_h2r
Cs3_h2w:
  buffer_load_dwordx4 v76, s[8:11], s55 offen offset:0 sc1 lds
  buffer_load_dwordx4 v76, s[8:11], s55 offen offset:1024 sc1 lds
  s_cmp_eq_u32 s66, 63
  s_waitcnt lgkmcnt(0)
  s_barrier
  ds_read_b128 v[8:11], v76 offset:6656
Cs3_top2:
  v_smfmac_f32_16x16x64_bf16 v[20:23], v[4:7], v[96:103], v74
  s_cbranch_scc1 Cs3_last
  v_smfmac_f32_16x16x64_bf16 v[28:31], v[4:7], v[36:43], v74
  buffer_load_dwordx4 v[44:47], v76, s[8:11], s58 offen offset:0 sc1
  s_mov_b32 m0, 15872
  v_smfmac_f32_16x16x64_bf16 v[24:27], v[4:7], v[104:111], v74
  buffer_load_dwordx4 v[48:51], v76, s[8:11], s58 offen offset:1024 sc1
  v_smfmac_f32_16x16x64_bf16 v[32:35], v[4:7], v[60:67], v74
  ds_read_b128 v[0:3], v76 offset:4608
  s_waitcnt lgkmcnt(1)
  v_smfmac_f32_16x16x64_bf16 v[20:23], v[8:11], v[112:119], v74
  ds_read_b128 v[12:15], v76 offset:7680
  v_smfmac_f32_16x16x64_bf16 v[24:27], v[8:11], v[120:127], v74
  ds_read_b128 v[36:39], v76 offset:28672
  v_smfmac_f32_16x16x64_bf16 v[28:31], v[8:11], v[208:215], v74
  buffer_store_dwordx4 v[16:19], v76, s[8:11], s68 offen sc1
  ds_read_b128 v[40:43], v76 offset:29696
  v_smfmac_f32_16x16x64_bf16 v[32:35], v[8:11], v[216:223], v74
  ds_read_b128 v[60:63], v76 offset:30720
  s_waitcnt lgkmcnt(4)
  v_smfmac_f32_16x16x64_bf16 v[20:23], v[0:3], v[80:87], v74
  ds_read_b128 v[64:67], v76 offset:31744
  v_smfmac_f32_16x16x64_bf16 v[24:27], v[0:3], v[88:95], v74
  buffer_load_dword v73, s[16:19], s70 offen lds
  s_waitcnt vmcnt(4)
  s_waitcnt lgkmcnt(4)
  v_smfmac_f32_16x16x64_bf16 v[20:23], v[12:15], v[128:135], v74
  s_barrier
  s_waitcnt lgkmcnt(2)
  v_smfmac_f32_16x16x64_bf16 v[28:31], v[0:3], v[36:43], v74
  ds_read_b128 v[4:7], v76 offset:8704
  v_smfmac_f32_16x16x64_bf16 v[24:27], v[12:15], v[136:143], v74
  ds_read_b128 v[36:39], v76 offset:61440
  s_waitcnt lgkmcnt(2)
  v_smfmac_f32_16x16x64_bf16 v[32:35], v[0:3], v[60:67], v74
  ds_read_b128 v[40:43], v76 offset:62464
  v_smfmac_f32_16x16x64_bf16 v[28:31], v[12:15], v[224:231], v74
  ds_read_b128 v[60:63], v76 offset:63488
  v_smfmac_f32_16x16x64_bf16 v[32:35], v[12:15], v[232:239], v74
  ds_read_b128 v[64:67], v76 offset:64512
  s_waitcnt lgkmcnt(4)
  v_smfmac_f32_16x16x64_bf16 v[20:23], v[4:7], v[144:151], v74
  ds_read_b128 v[8:11], v76 offset:9728
  s_waitcnt lgkmcnt(3)
  v_smfmac_f32_16x16x64_bf16 v[28:31], v[4:7], v[36:43], v74
  s_barrier
  ds_read_b128 v[0:3], v76 offset:11776
  v_smfmac_f32_16x16x64_bf16 v[24:27], v[4:7], v[152:159], v74
  ds_read_b128 v[36:39], v75 offset:12288
  ds_read_b128 v[40:43], v75 offset:13312
  s_waitcnt lgkmcnt(4)
  v_smfmac_f32_16x16x64_bf16 v[32:35], v[4:7], v[60:67], v74
  ds_read_b128 v[16:19], v76 offset:10752
  s_waitcnt lgkmcnt(4)
  v_smfmac_f32_16x16x64_bf16 v[20:23], v[8:11], v[160:167], v74
  ds_read_b128 v[12:15], v76 offset:12800
  v_smfmac_f32_16x16x64_bf16 v[24:27], v[8:11], v[168:175], v74
  ds_read_b128 v[60:63], v75 offset:14336
  ds_read_b128 v[64:67], v75 offset:15360
  s_waitcnt lgkmcnt(6)
  v_smfmac_f32_16x16x64_bf16 v[20:23], v[0:3], v[176:183], v74
  s_waitcnt lgkmcnt(3)
  v_smfmac_f32_16x16x64_bf16 v[20:23], v[16:19], v[36:43], v74
  ds_read_b128 v[36:39], v75 offset:28672
  s_waitcnt lgkmcnt(3)
  v_smfmac_f32_16x16x64_bf16 v[20:23], v[12:15], v[192:199], v74
  ds_read_b128 v[40:43], v75 offset:29696
  s_waitcnt lgkmcnt(2)
  v_smfmac_f32_16x16x64_bf16 v[24:27], v[16:19], v[60:67], v74
  ds_read_b128 v[60:63], v75 offset:30720
  v_smfmac_f32_16x16x64_bf16 v[24:27], v[0:3], v[184:191], v74
  ds_read_b128 v[64:67], v75 offset:31744
  v_add_f32 v20, v20, v22
  v_smfmac_f32_16x16x64_bf16 v[24:27], v[12:15], v[200:207], v74
  v_add_f32 v21, v21, v23
  v_smfmac_f32_16x16x64_bf16 v[28:31], v[16:19], v[240:247], v74
  s_waitcnt lgkmcnt(2)
  v_mov_b64 v[70:71], s[78:79]
  v_smfmac_f32_16x16x64_bf16 v[28:31], v[8:11], v[36:43], v74
  ds_read_b128 v[36:39], v68
  v_add_f32 v24, v24, v26
  v_smfmac_f32_16x16x64_bf16 v[28:31], v[0:3], a[0:7], v74
  ds_read_b128 v[40:43], v68
  v_cvt_pk_bf16_f32 v22, v20, v24
  v_smfmac_f32_16x16x64_bf16 v[28:31], v[12:15], a[16:23], v74
  ds_write_b32 v79, v22 offset:0
  s_waitcnt lgkmcnt(3)
  v_add_f32 v25, v25, v27
  v_cvt_pk_bf16_f32 v23, v21, v25
  v_smfmac_f32_16x16x64_bf16 v[32:35], v[8:11], v[60:67], v74
  ds_write_b32 v79, v23 offset:576
  v_cmp_u_f32 vcc, v20, v21
  v_smfmac_f32_16x16x64_bf16 v[32:35], v[16:19], v[248:255], v74
  v_add_f32 v28, v28, v30
  v_smfmac_f32_16x16x64_bf16 v[32:35], v[0:3], a[8:15], v74
  v_add_f32 v29, v29, v31
  v_smfmac_f32_16x16x64_bf16 v[32:35], v[12:15], a[24:31], v74
  s_cbranch_vccnz Cs3_rec
Cs3_recok:
  s_waitcnt lgkmcnt(3)
  v_smfmac_f32_16x16x64_bf16 v[36:39], v[16:19], a[128:135], v74
  s_waitcnt lgkmcnt(0)
  s_barrier
  ds_read_b128 v[60:63], v77
  v_smfmac_f32_16x16x64_bf16 v[40:43], v[16:19], a[136:143], v74
  ds_read_b128 v[64:67], v77 offset:128
  v_add_f32 v32, v32, v34
  v_cvt_pk_bf16_f32 v30, v28, v32
  v_smfmac_f32_16x16x64_bf16 v[36:39], v[0:3], a[144:151], v74
  ds_write_b32 v79, v30 offset:256
  v_add_f32 v33, v33, v35
  v_cvt_pk_bf16_f32 v31, v29, v33
  v_smfmac_f32_16x16x64_bf16 v[40:43], v[0:3], a[152:159], v74
  ds_write_b32 v79, v31 offset:832
  v_xor_b32 v75, 0x8000, v75
  v_smfmac_f32_16x16x64_bf16 v[36:39], v[4:7], a[96:103], v74
  ds_read_b128 v[0:3], v76 offset:4608
  v_mov_b32 v29, 0
  v_smfmac_f32_16x16x64_bf16 v[40:43], v[4:7], a[104:111], v74
  s_waitcnt vmcnt(2) lgkmcnt(3)
  v_mov_b32 v30, 0
  v_mfma_f32_16x16x32_bf16 v[44:47], v[44:47], v[60:63], 0
  ds_read_b128 v[4:7], v76 offset:5632
  s_waitcnt lgkmcnt(2)
  v_mfma_f32_16x16x32_bf16 v[44:47], v[48:51], v[64:67], v[44:47]
  s_barrier
  v_smfmac_f32_16x16x64_bf16 v[36:39], v[8:11], a[112:119], v74
  ds_read_b128 v[20:23], v77 offset:256
  ds_read_b128 v[24:27], v77 offset:384
  v_smfmac_f32_16x16x64_bf16 v[40:43], v[8:11], a[120:127], v74
  ds_read_b128 v[8:11], v76 offset:6656
  v_add_f32_dpp v72, v46, v44 quad_perm:[2,3,0,1] row_mask:0xf bank_mask:0xf
  v_add_f32_dpp v73, v47, v45 quad_perm:[2,3,0,1] row_mask:0xf bank_mask:0xf
  v_smfmac_f32_16x16x64_bf16 v[36:39], v[12:15], a[160:167], v74
  s_waitcnt lgkmcnt(4)
  v_exp_f32_dpp v72, v72 quad_perm:[0,1,0,1] row_mask:0xf bank_mask:0xf
  v_smfmac_f32_16x16x64_bf16 v[40:43], v[12:15], a[168:175], v74
  ds_read_b128 v[12:15], v76 offset:7680
  v_exp_f32_dpp v73, v73 quad_perm:[0,1,0,1] row_mask:0xf bank_mask:0xf
  v_smfmac_f32_16x16x64_bf16 v[36:39], v[0:3], a[32:39], v74
  s_waitcnt lgkmcnt(2)
  v_cvt_pk_bf16_f32 v72, v72, v73
  v_mfma_f32_16x16x32_bf16 v[20:23], v[20:23], v[60:63], 0
  ds_write_b32 v78, v72 offset:524
  v_mov_b64 v[16:17], 0
  v_mfma_f32_16x16x32_bf16 v[20:23], v[24:27], v[64:67], v[20:23]
  ds_read_b128 v[44:47], v75 offset:28672
  v_mov_b64 v[18:19], 0
  v_smfmac_f32_16x16x64_bf16 v[40:43], v[0:3], a[40:47], v74
  ds_read_b128 v[48:51], v75 offset:29696
  v_mov_b64 v[68:69], s[78:79]
  v_smfmac_f32_16x16x64_bf16 v[36:39], v[4:7], a[48:55], v74
  s_waitcnt lgkmcnt(4)
  v_add_f32_dpp v24, v22, v20 quad_perm:[2,3,0,1] row_mask:0xf bank_mask:0xf
  v_add_f32_dpp v25, v23, v21 quad_perm:[2,3,0,1] row_mask:0xf bank_mask:0xf
  v_smfmac_f32_16x16x64_bf16 v[36:39], v[8:11], a[64:71], v74
  s_waitcnt lgkmcnt(2)
  s_barrier
  ds_read_b128 v[32:35], v78 offset:512
  v_smfmac_f32_16x16x64_bf16 v[36:39], v[12:15], a[80:87], v74
  ds_read_b128 v[60:63], v75 offset:30720
  v_mul_f32 v24, s69, v24
  v_smfmac_f32_16x16x64_bf16 v[40:43], v[4:7], a[56:63], v74
  ds_read_b128 v[64:67], v75 offset:31744
  v_mul_f32 v25, s69, v25
  v_smfmac_f32_16x16x64_bf16 v[40:43], v[8:11], a[72:79], v74
  v_exp_f32_dpp v24, v24 quad_perm:[0,1,0,1] row_mask:0xf bank_mask:0xf
  v_smfmac_f32_16x16x64_bf16 v[40:43], v[12:15], a[88:95], v74
  s_waitcnt lgkmcnt(2)
  v_exp_f32_dpp v25, v25 quad_perm:[0,1,0,1] row_mask:0xf bank_mask:0xf
  v_mfma_f32_16x16x32_bf16 v[8:11], v[32:35], v[68:71], 0
  v_add_f32 v36, v36, v38
  v_add_f32 v37, v37, v39
  v_mfma_f32_16x16x32_bf16 v[0:3], v[32:35], v[52:55], 0
  v_add_f32 v40, v40, v42
  v_add_f32 v41, v41, v43
  v_mfma_f32_16x16x32_bf16 v[4:7], v[32:35], v[56:59], 0
  v_cvt_pk_bf16_f32 v28, v24, v25
  v_cvt_pk_bf16_f32 v72, v36, v37
  v_cvt_pk_bf16_f32 v73, v40, v41
  v_mfma_f32_16x16x16_bf16 v[8:11], v[28:29], v[68:69], v[8:11]
  v_cvt_pk_bf16_f32 v31, v24, v25
  v_mov_b64 v[20:21], 0
  v_mfma_f32_16x16x16_bf16 v[0:3], v[28:29], v[72:73], v[0:3]
  ds_read_b128 v[68:71], v76 offset:13824
  v_mov_b64 v[22:23], 0
  v_mfma_f32_16x16x16_bf16 v[4:7], v[30:31], v[72:73], v[4:7]
  v_rcp_f32 v10, v8
  v_rcp_f32 v11, v9
  v_mul_f32 v0, v10, v0
  v_mul_f32 v1, v11, v1
  s_nop 0
  v_mul_f32 v4, v10, v4
  v_mul_f32 v5, v11, v5
  v_cvt_pk_bf16_f32 v2, v0, v4
  ds_write_b32 v79, v2 offset:8704
  v_cvt_pk_bf16_f32 v3, v1, v5
  ds_write_b32 v79, v3 offset:9280
  v_max3_f32 v8, v8, v9, v10
  v_max_f32 v8, v8, v11
  v_cmp_le_f32 vcc, 1317011456, v8
  v_mov_b64 v[24:25], 0
  v_mov_b64 v[26:27], 0
  s_cbranch_vccnz Cs3_mx
Cs3_mxok:
  s_waitcnt lgkmcnt(0)
  s_barrier
  ds_read_b128 v[0:3], v78 offset:8704
  ds_read_b128 v[4:7], v78 offset:8768
  ds_read_b128 v[8:11], v78 offset:8832
  ds_read_b128 v[12:15], v78 offset:8896
  s_waitcnt lgkmcnt(3)
  v_smfmac_f32_16x16x64_bf16 v[16:19], v[0:3], v[44:51], v74
  ds_read_b128 v[52:55], v75 offset:45056
  s_waitcnt lgkmcnt(3)
  v_smfmac_f32_16x16x64_bf16 v[16:19], v[4:7], v[60:67], v74
  ds_read_b128 v[56:59], v75 offset:46080
  s_waitcnt lgkmcnt(3)
  v_smfmac_f32_16x16x64_bf16 v[16:19], v[8:11], a[176:183], v74
  ds_read_b128 v[36:39], v75 offset:47104
  s_waitcnt lgkmcnt(3)
  v_smfmac_f32_16x16x64_bf16 v[16:19], v[12:15], a[184:191], v74
  ds_read_b128 v[40:43], v75 offset:48128
  ds_read_b128 v[44:47], v75 offset:61440
  v_smfmac_f32_16x16x64_bf16 v[20:23], v[0:3], a[192:199], v74
  ds_read_b128 v[48:51], v75 offset:62464
  ds_read_b128 v[60:63], v75 offset:63488
  v_smfmac_f32_16x16x64_bf16 v[20:23], v[4:7], a[200:207], v74
  ds_read_b128 v[64:67], v75 offset:64512
  s_waitcnt lgkmcnt(6)
  v_cvt_pk_bf16_f32 v16, v16, v17
  v_cvt_pk_bf16_f32 v17, v18, v19
  v_bfi_b32 v16, 1, s72, v16
  v_smfmac_f32_16x16x64_bf16 v[20:23], v[8:11], v[52:59], v74
  buffer_store_dwordx2 v[16:17], v68, s[8:11], s73 offen sc1
  s_waitcnt lgkmcnt(4)
  v_smfmac_f32_16x16x64_bf16 v[20:23], v[12:15], v[36:43], v74
  ds_read_b128 v[52:55], v75 offset:8192
  v_mov_b64 v[32:33], 0
  v_smfmac_f32_16x16x64_bf16 v[24:27], v[0:3], a[208:215], v74
  ds_read_b128 v[56:59], v75 offset:9216
  v_mov_b64 v[34:35], 0
  v_smfmac_f32_16x16x64_bf16 v[24:27], v[4:7], a[216:223], v74
  ds_read_b128 v[36:39], v75 offset:10240
  s_waitcnt lgkmcnt(5)
  v_cvt_pk_bf16_f32 v20, v20, v21
  v_cvt_pk_bf16_f32 v21, v22, v23
  v_bfi_b32 v20, 1, s72, v20
  v_smfmac_f32_16x16x64_bf16 v[24:27], v[8:11], v[44:51], v74
  buffer_store_dwordx2 v[20:21], v68, s[8:11], s74 offen sc1
  s_waitcnt lgkmcnt(3)
  v_smfmac_f32_16x16x64_bf16 v[24:27], v[12:15], v[60:67], v74
  ds_read_b128 v[40:43], v75 offset:11264
  v_mov_b64 v[28:29], 0
  v_smfmac_f32_16x16x64_bf16 v[32:35], v[0:3], a[224:231], v74
  ds_read_b128 v[44:47], v75 offset:12288
  ds_read_b128 v[48:51], v75 offset:13312
  v_smfmac_f32_16x16x64_bf16 v[32:35], v[4:7], a[232:239], v74
  ds_read_b128 v[60:63], v75 offset:14336
  v_cvt_pk_bf16_f32 v24, v24, v25
  v_cvt_pk_bf16_f32 v25, v26, v27
  v_bfi_b32 v24, 1, s72, v24
  v_smfmac_f32_16x16x64_bf16 v[32:35], v[8:11], a[240:247], v74
  buffer_store_dwordx2 v[24:25], v68, s[8:11], s75 offen sc1
  v_mov_b64 v[30:31], 0
  v_smfmac_f32_16x16x64_bf16 v[32:35], v[12:15], a[248:255], v74
  ds_read_b128 v[64:67], v75 offset:15360
  s_waitcnt lgkmcnt(6)
  v_smfmac_f32_16x16x64_bf16 v[28:31], v[0:3], v[52:59], v74
  s_waitcnt lgkmcnt(4)
  v_smfmac_f32_16x16x64_bf16 v[28:31], v[4:7], v[36:43], v74
  s_waitcnt lgkmcnt(2)
  v_cvt_pk_bf16_f32 v32, v32, v33
  v_cvt_pk_bf16_f32 v33, v34, v35
  v_bfi_b32 v32, 1, s72, v32
  v_smfmac_f32_16x16x64_bf16 v[28:31], v[8:11], v[44:51], v74
  buffer_store_dwordx2 v[32:33], v68, s[8:11], s76 offen sc1
  s_waitcnt lgkmcnt(0)
  v_smfmac_f32_16x16x64_bf16 v[28:31], v[12:15], v[60:67], v74
  ds_read_b128 v[52:55], v76 offset:14848
  ds_read_b64 v[16:17], v77 offset:392
  v_mov_b64 v[18:19], v[72:73]
  v_xor_b32 v75, 0x8000, v75
  s_nop 3
  v_cvt_pk_bf16_f32 v28, v28, v29
  v_cvt_pk_bf16_f32 v29, v30, v31
  v_bfi_b32 v28, 1, s72, v28
  buffer_store_dwordx2 v[28:29], v68, s[8:11], s77 offen sc1
  v_mov_b64 v[20:21], 0
  v_mov_b64 v[22:23], 0
  v_mov_b64 v[24:25], 0
  v_mov_b64 v[26:27], 0
  v_mov_b64 v[28:29], 0
  v_mov_b64 v[30:31], 0
  v_mov_b64 v[32:33], 0
  v_mov_b64 v[34:35], 0
  v_mov_b32 v68, 14880
  s_add_u32 s58, s58, 655360
  s_add_u32 s59, s59, 655360
  s_add_u32 s70, s70, 655360
  s_add_u32 s68, s68, 655360
  s_add_u32 s66, s66, 1
  s_xor_b32 s64, s64, 16384
  s_xor_b32 s65, s65, 16384
  s_cmp_eq_u32 s66, 62
  s_cselect_b64 s[16:17], s[20:21], s[16:17]
  s_cselect_b32 s18, (Cs3_done - Cs3_last), s18
  s_cselect_b32 s70, 0, s70
  s_cmp_eq_u32 s66, 63
  s_cselect_b32 s59, 268435456, s59
  s_cselect_b32 s58, 268435456, s58
  s_nop 15
  s_nop 15
  s_nop 11
  buffer_load_dwordx4 v[0:3], v76, s[8:11], s60 offen offset:0 sc1
  buffer_load_dwordx4 v[4:7], v76, s[8:11], s60 offen offset:1024 sc1
  buffer_load_dwordx4 v[8:11], v76, s[8:11], s61 offen offset:0 sc1
  buffer_load_dwordx4 v[12:15], v76, s[8:11], s61 offen offset:1024 sc1
  s_waitcnt lgkmcnt(0)
  s_waitcnt vmcnt(3)
  v_mfma_f32_16x16x32_bf16 v[56:59], v[52:55], v[0:3], 0
  v_bitop3_b32 v72, v0, v2, s72 bitop3:0x7e
  s_waitcnt vmcnt(2)
  v_mfma_f32_16x16x32_bf16 v[56:59], v[52:55], v[4:7], v[56:59]
  v_bitop3_b32 v73, v4, v6, s72 bitop3:0x7e
  v_or_b32 v72, v72, v73
  s_waitcnt vmcnt(1)
  v_mfma_f32_16x16x32_bf16 v[36:39], v[52:55], v[8:11], 0
  v_bitop3_b32 v73, v8, v10, s72 bitop3:0x7e
  v_or_b32 v72, v72, v73
  s_waitcnt vmcnt(0)
  v_mfma_f32_16x16x32_bf16 v[36:39], v[52:55], v[12:15], v[36:39]
  v_bitop3_b32 v73, v12, v14, s72 bitop3:0x7e
  v_bitop3_b32 v72, v72, v73, 1 bitop3:0xa8
  v_cmp_ne_u32 vcc, 0, v72
  s_cbranch_vccnz Cs3_h1r
  buffer_load_dwordx4 v[4:7], v76, s[8:11], s65 offen offset:1024 sc1
  v_add_f32_dpp v56, v56, v56 row_ror:4 row_mask:0xf bank_mask:0xf
  v_add_f32_dpp v57, v57, v57 row_ror:4 row_mask:0xf bank_mask:0xf
  v_add_f32_dpp v36, v36, v36 row_ror:4 row_mask:0xf bank_mask:0xf
  v_add_f32_dpp v37, v37, v37 row_ror:4 row_mask:0xf bank_mask:0xf
  v_add_f32_dpp v56, v56, v56 row_ror:8 row_mask:0xf bank_mask:0xf
  v_add_f32_dpp v57, v57, v57 row_ror:8 row_mask:0xf bank_mask:0xf
  v_add_f32_dpp v36, v36, v36 row_ror:8 row_mask:0xf bank_mask:0xf
  v_add_f32_dpp v37, v37, v37 row_ror:8 row_mask:0xf bank_mask:0xf
  v_cvt_pk_bf16_f32 v56, v56, v57
  buffer_store_dword v56, v69, s[8:11], s62 offen sc1
  v_cvt_pk_bf16_f32 v36, v36, v37
  buffer_store_dword v36, v70, s[8:11], s63 offen sc1
  s_xor_b32 s62, s62, 16384
  buffer_store_dword v71, v69, s[8:11], s62 offen sc1
  s_xor_b32 s63, s63, 16384
  buffer_store_dword v71, v70, s[8:11], s63 offen sc1
  s_xor_b32 s72, s72, 1
  s_branch Cs3_h2
Cs3_h1r:
  s_mov_b64 exec, vcc
  buffer_load_dwordx4 v[0:3], v76, s[8:11], s60 offen offset:0 sc1
  buffer_load_dwordx4 v[4:7], v76, s[8:11], s60 offen offset:1024 sc1
  buffer_load_dwordx4 v[8:11], v76, s[8:11], s61 offen offset:0 sc1
  buffer_load_dwordx4 v[12:15], v76, s[8:11], s61 offen offset:1024 sc1
  s_mov_b64 exec, -1
  s_add_u32 s67, s67, 1
  s_waitcnt vmcnt(3)
  v_mfma_f32_16x16x32_bf16 v[56:59], v[52:55], v[0:3], 0
  v_bitop3_b32 v72, v0, v2, s72 bitop3:0x7e
  s_waitcnt vmcnt(2)
  v_mfma_f32_16x16x32_bf16 v[56:59], v[52:55], v[4:7], v[56:59]
  v_bitop3_b32 v73, v4, v6, s72 bitop3:0x7e
  v_or_b32 v72, v72, v73
  s_waitcnt vmcnt(1)
  v_mfma_f32_16x16x32_bf16 v[36:39], v[52:55], v[8:11], 0
  v_bitop3_b32 v73, v8, v10, s72 bitop3:0x7e
  v_or_b32 v72, v72, v73
  s_waitcnt vmcnt(0)
  v_mfma_f32_16x16x32_bf16 v[36:39], v[52:55], v[12:15], v[36:39]
  v_bitop3_b32 v73, v12, v14, s72 bitop3:0x7e
  v_bitop3_b32 v72, v72, v73, 1 bitop3:0xa8
  v_cmp_ne_u32 vcc, 0, v72
  s_cbranch_vccz Cs3_h1p
Cs3_h1s:
  s_mov_b64 exec, vcc
  buffer_load_dwordx4 v[0:3], v76, s[8:11], s60 offen offset:0 sc1
  buffer_load_dwordx4 v[4:7], v76, s[8:11], s60 offen offset:1024 sc1
  buffer_load_dwordx4 v[8:11], v76, s[8:11], s61 offen offset:0 sc1
  buffer_load_dwordx4 v[12:15], v76, s[8:11], s61 offen offset:1024 sc1
  s_mov_b64 exec, -1
  s_add_u32 s67, s67, 1
  s_waitcnt vmcnt(3)
  v_mfma_f32_16x16x32_bf16 v[56:59], v[52:55], v[0:3], 0
  v_bitop3_b32 v72, v0, v2, s72 bitop3:0x7e
  s_waitcnt vmcnt(2)
  v_mfma_f32_16x16x32_bf16 v[56:59], v[52:55], v[4:7], v[56:59]
  v_bitop3_b32 v73, v4, v6, s72 bitop3:0x7e
  v_or_b32 v72, v72, v73
  s_waitcnt vmcnt(1)
  v_mfma_f32_16x16x32_bf16 v[36:39], v[52:55], v[8:11], 0
  v_bitop3_b32 v73, v8, v10, s72 bitop3:0x7e
  v_or_b32 v72, v72, v73
  s_waitcnt vmcnt(0)
  v_mfma_f32_16x16x32_bf16 v[36:39], v[52:55], v[12:15], v[36:39]
  v_bitop3_b32 v73, v12, v14, s72 bitop3:0x7e
  v_bitop3_b32 v72, v72, v73, 1 bitop3:0xa8
  v_cmp_ne_u32 vcc, 0, v72
  s_cbranch_vccz Cs3_h1p
  s_cmp_lt_u32 s67, 131072
  s_cbranch_scc1 Cs3_h1s
Cs3_h1p:
  s_nop 2
  buffer_load_dwordx4 v[4:7], v76, s[8:11], s65 offen offset:1024 sc1
  v_add_f32_dpp v56, v56, v56 row_ror:4 row_mask:0xf bank_mask:0xf
  v_add_f32_dpp v57, v57, v57 row_ror:4 row_mask:0xf bank_mask:0xf
  v_add_f32_dpp v36, v36, v36 row_ror:4 row_mask:0xf bank_mask:0xf
  v_add_f32_dpp v37, v37, v37 row_ror:4 row_mask:0xf bank_mask:0xf
  v_add_f32_dpp v56, v56, v56 row_ror:8 row_mask:0xf bank_mask:0xf
  v_add_f32_dpp v57, v57, v57 row_ror:8 row_mask:0xf bank_mask:0xf
  v_add_f32_dpp v36, v36, v36 row_ror:8 row_mask:0xf bank_mask:0xf
  v_add_f32_dpp v37, v37, v37 row_ror:8 row_mask:0xf bank_mask:0xf
  v_cvt_pk_bf16_f32 v56, v56, v57
  buffer_store_dword v56, v69, s[8:11], s62 offen sc1
  v_cvt_pk_bf16_f32 v36, v36, v37
  buffer_store_dword v36, v70, s[8:11], s63 offen sc1
  s_xor_b32 s62, s62, 16384
  buffer_store_dword v71, v69, s[8:11], s62 offen sc1
  s_xor_b32 s63, s63, 16384
  buffer_store_dword v71, v70, s[8:11], s63 offen sc1
  s_xor_b32 s72, s72, 1
  s_branch Cs3_h2
Cs3_h2r:
  s_mov_b64 exec, vcc
  buffer_load_dwordx4 v[4:7], v76, s[8:11], s65 offen offset:1024 sc1
  s_mov_b64 exec, -1
  s_add_u32 s67, s67, 1
  s_waitcnt vmcnt(3)
  v_max3_u32 v72, v4, v5, v6
  v_max_u32 v72, v72, v7
  ds_write_b128 v76, v[4:7] offset:5632
  v_cmp_eq_u32 vcc, -1, v72
  s_cbranch_vccz Cs3_h2w
Cs3_h2s:
  s_mov_b64 exec, vcc
  buffer_load_dwordx4 v[4:7], v76, s[8:11], s65 offen offset:1024 sc1
  s_mov_b64 exec, -1
  s_add_u32 s67, s67, 1
  s_waitcnt vmcnt(1)
  v_max3_u32 v72, v4, v5, v6
  v_max_u32 v72, v72, v7
  ds_write_b128 v76, v[4:7] offset:5632
  v_cmp_eq_u32 vcc, -1, v72
  s_cbranch_vccz Cs3_h2w
  s_mov_b64 exec, vcc
  buffer_load_dwordx4 v[4:7], v76, s[8:11], s65 offen offset:1024 sc1
  s_mov_b64 exec, -1
  s_add_u32 s67, s67, 1
  s_waitcnt vmcnt(1)
  v_max3_u32 v72, v4, v5, v6
  v_max_u32 v72, v72, v7
  ds_write_b128 v76, v[4:7] offset:5632
  v_cmp_eq_u32 vcc, -1, v72
  s_cbranch_vccz Cs3_h2w
  s_mov_b64 exec, vcc
  buffer_load_dwordx4 v[4:7], v76, s[8:11], s65 offen offset:1024 sc1
  s_mov_b64 exec, -1
  s_add_u32 s67, s67, 1
  s_waitcnt vmcnt(1)
  v_max3_u32 v72, v4, v5, v6
  v_max_u32 v72, v72, v7
  ds_write_b128 v76, v[4:7] offset:5632
  v_cmp_eq_u32 vcc, -1, v72
  s_cbranch_vccz Cs3_h2w
  s_cmp_lt_u32 s67, 131072
  s_cbranch_scc1 Cs3_h2s
  s_branch Cs3_h2w
Cs3_rec:
  s_nop 7
  s_waitcnt vmcnt(0) lgkmcnt(0)
  v_max3_u32 v72, v0, v1, v2
  v_max3_u32 v72, v72, v3, v4
  v_max3_u32 v72, v72, v5, v6
  v_max3_u32 v72, v72, v7, v8
  v_max3_u32 v72, v72, v9, v10
  v_max3_u32 v72, v72, v11, v12
  v_max3_u32 v72, v72, v13, v14
  v_max3_u32 v72, v72, v15, v16
  v_max3_u32 v72, v72, v17, v18
  v_max_u32 v72, v72, v19
  v_cmp_eq_u32 vcc, -1, v72
  s_cbranch_vccz Cs3_recok
  s_barrier
Cs3_recp:
  buffer_load_dwordx4 v[0:3], v76, s[8:11], s64 offen offset:0 sc1
  buffer_load_dwordx4 v[4:7], v76, s[8:11], s64 offen offset:1024 sc1
  buffer_load_dwordx4 v[8:11], v76, s[8:11], s64 offen offset:2048 sc1
  s_add_u32 s67, s67, 1
  s_cmp_lt_u32 s67, 131072
  s_cselect_b32 s54, -2, -1
  s_waitcnt vmcnt(2)
  v_max3_u32 v72, v0, v1, v2
  s_waitcnt vmcnt(1)
  v_max3_u32 v72, v72, v3, v4
  v_max3_u32 v72, v72, v5, v6
  s_waitcnt vmcnt(0)
  v_max3_u32 v72, v72, v7, v8
  v_max3_u32 v72, v72, v9, v10
  v_max_u32 v72, v72, v11
  v_cmp_lt_u32 vcc, s54, v72
  s_cbranch_vccnz Cs3_recp
  ds_write_b128 v76, v[0:3] offset:10752
  ds_write_b128 v76, v[4:7] offset:11776
  ds_write_b128 v76, v[8:11] offset:12800
  v_mov_b64 v[20:21], 0
  v_mov_b64 v[22:23], 0
  v_mov_b64 v[24:25], 0
  v_mov_b64 v[26:27], 0
  v_mov_b64 v[28:29], 0
  v_mov_b64 v[30:31], 0
  v_mov_b64 v[32:33], 0
  v_mov_b64 v[34:35], 0
  s_waitcnt lgkmcnt(0)
  s_barrier
  ds_read_b128 v[0:3], v76 offset:4608
  s_waitcnt lgkmcnt(0)
  v_smfmac_f32_16x16x64_bf16 v[20:23], v[0:3], v[80:87], v74
  v_smfmac_f32_16x16x64_bf16 v[24:27], v[0:3], v[88:95], v74
  ds_read_b128 v[60:63], v76 offset:28672
  ds_read_b128 v[64:67], v76 offset:29696
  s_waitcnt lgkmcnt(0)
  v_smfmac_f32_16x16x64_bf16 v[28:31], v[0:3], v[60:67], v74
  ds_read_b128 v[60:63], v76 offset:30720
  ds_read_b128 v[64:67], v76 offset:31744
  s_waitcnt lgkmcnt(0)
  v_smfmac_f32_16x16x64_bf16 v[32:35], v[0:3], v[60:67], v74
  ds_read_b128 v[4:7], v76 offset:5632
  s_waitcnt lgkmcnt(0)
  v_smfmac_f32_16x16x64_bf16 v[20:23], v[4:7], v[96:103], v74
  v_smfmac_f32_16x16x64_bf16 v[24:27], v[4:7], v[104:111], v74
  ds_read_b128 v[60:63], v76 offset:45056
  ds_read_b128 v[64:67], v76 offset:46080
  s_waitcnt lgkmcnt(0)
  v_smfmac_f32_16x16x64_bf16 v[28:31], v[4:7], v[60:67], v74
  ds_read_b128 v[60:63], v76 offset:47104
  ds_read_b128 v[64:67], v76 offset:48128
  s_waitcnt lgkmcnt(0)
  v_smfmac_f32_16x16x64_bf16 v[32:35], v[4:7], v[60:67], v74
  ds_read_b128 v[8:11], v76 offset:6656
  s_waitcnt lgkmcnt(0)
  v_smfmac_f32_16x16x64_bf16 v[20:23], v[8:11], v[112:119], v74
  v_smfmac_f32_16x16x64_bf16 v[24:27], v[8:11], v[120:127], v74
  v_smfmac_f32_16x16x64_bf16 v[28:31], v[8:11], v[208:215], v74
  v_smfmac_f32_16x16x64_bf16 v[32:35], v[8:11], v[216:223], v74
  ds_read_b128 v[12:15], v76 offset:7680
  s_waitcnt lgkmcnt(0)
  v_smfmac_f32_16x16x64_bf16 v[20:23], v[12:15], v[128:135], v74
  v_smfmac_f32_16x16x64_bf16 v[24:27], v[12:15], v[136:143], v74
  v_smfmac_f32_16x16x64_bf16 v[28:31], v[12:15], v[224:231], v74
  v_smfmac_f32_16x16x64_bf16 v[32:35], v[12:15], v[232:239], v74
  ds_read_b128 v[4:7], v76 offset:8704
  s_waitcnt lgkmcnt(0)
  v_smfmac_f32_16x16x64_bf16 v[20:23], v[4:7], v[144:151], v74
  v_smfmac_f32_16x16x64_bf16 v[24:27], v[4:7], v[152:159], v74
  ds_read_b128 v[60:63], v76 offset:61440
  ds_read_b128 v[64:67], v76 offset:62464
  s_waitcnt lgkmcnt(0)
  v_smfmac_f32_16x16x64_bf16 v[28:31], v[4:7], v[60:67], v74
  ds_read_b128 v[60:63], v76 offset:63488
  ds_read_b128 v[64:67], v76 offset:64512
  s_waitcnt lgkmcnt(0)
  v_smfmac_f32_16x16x64_bf16 v[32:35], v[4:7], v[60:67], v74
  ds_read_b128 v[8:11], v76 offset:9728
  s_waitcnt lgkmcnt(0)
  v_smfmac_f32_16x16x64_bf16 v[20:23], v[8:11], v[160:167], v74
  v_smfmac_f32_16x16x64_bf16 v[24:27], v[8:11], v[168:175], v74
  ds_read_b128 v[60:63], v75 offset:28672
  ds_read_b128 v[64:67], v75 offset:29696
  s_waitcnt lgkmcnt(0)
  v_smfmac_f32_16x16x64_bf16 v[28:31], v[8:11], v[60:67], v74
  ds_read_b128 v[60:63], v75 offset:30720
  ds_read_b128 v[64:67], v75 offset:31744
  s_waitcnt lgkmcnt(0)
  v_smfmac_f32_16x16x64_bf16 v[32:35], v[8:11], v[60:67], v74
  ds_read_b128 v[16:19], v76 offset:10752
  ds_read_b128 v[60:63], v75 offset:12288
  ds_read_b128 v[64:67], v75 offset:13312
  s_waitcnt lgkmcnt(0)
  v_smfmac_f32_16x16x64_bf16 v[20:23], v[16:19], v[60:67], v74
  ds_read_b128 v[60:63], v75 offset:14336
  ds_read_b128 v[64:67], v75 offset:15360
  s_waitcnt lgkmcnt(0)
  v_smfmac_f32_16x16x64_bf16 v[24:27], v[16:19], v[60:67], v74
  v_smfmac_f32_16x16x64_bf16 v[28:31], v[16:19], v[240:247], v74
  v_smfmac_f32_16x16x64_bf16 v[32:35], v[16:19], v[248:255], v74
  ds_read_b128 v[0:3], v76 offset:11776
  s_waitcnt lgkmcnt(0)
  v_smfmac_f32_16x16x64_bf16 v[20:23], v[0:3], v[176:183], v74
  v_smfmac_f32_16x16x64_bf16 v[24:27], v[0:3], v[184:191], v74
  v_smfmac_f32_16x16x64_bf16 v[28:31], v[0:3], a[0:7], v74
  v_smfmac_f32_16x16x64_bf16 v[32:35], v[0:3], a[8:15], v74
  ds_read_b128 v[12:15], v76 offset:12800
  s_waitcnt lgkmcnt(0)
  v_smfmac_f32_16x16x64_bf16 v[20:23], v[12:15], v[192:199], v74
  v_smfmac_f32_16x16x64_bf16 v[24:27], v[12:15], v[200:207], v74
  v_smfmac_f32_16x16x64_bf16 v[28:31], v[12:15], a[16:23], v74
  v_smfmac_f32_16x16x64_bf16 v[32:35], v[12:15], a[24:31], v74
  v_add_f32 v20, v20, v22
  v_add_f32 v21, v21, v23
  v_add_f32 v24, v24, v26
  v_cvt_pk_bf16_f32 v22, v20, v24
  ds_write_b32 v79, v22 offset:0
  v_add_f32 v25, v25, v27
  v_cvt_pk_bf16_f32 v23, v21, v25
  ds_write_b32 v79, v23 offset:576
  v_add_f32 v28, v28, v30
  v_add_f32 v29, v29, v31
  s_waitcnt lgkmcnt(0)
  s_nop 1
  s_branch Cs3_recok
Cs3_mx:
  s_waitcnt lgkmcnt(0)
  s_barrier
  buffer_load_dwordx4 v[0:3], v76, s[8:11], s58 offen offset:0 sc1
  ds_read_b128 v[20:23], v77 offset:0
  ds_read_b128 v[28:31], v77 offset:256
  buffer_load_dwordx4 v[4:7], v76, s[8:11], s58 offen offset:1024 sc1
  ds_read_b128 v[24:27], v77 offset:128
  ds_read_b128 v[32:35], v77 offset:384
  s_waitcnt vmcnt(1) lgkmcnt(3)
  v_mfma_f32_16x16x32_bf16 v[8:11], v[0:3], v[20:23], 0
  s_waitcnt vmcnt(0) lgkmcnt(1)
  v_mfma_f32_16x16x32_bf16 v[8:11], v[4:7], v[24:27], v[8:11]
  v_mfma_f32_16x16x32_bf16 v[12:15], v[28:31], v[20:23], 0
  s_waitcnt lgkmcnt(0)
  v_mfma_f32_16x16x32_bf16 v[12:15], v[32:35], v[24:27], v[12:15]
  v_add_f32_dpp v8, v10, v8 quad_perm:[2,3,0,1] row_mask:0xf bank_mask:0xf
  v_add_f32_dpp v9, v11, v9 quad_perm:[2,3,0,1] row_mask:0xf bank_mask:0xf
  s_nop 0
  v_mov_b32_dpp v8, v8 quad_perm:[0,1,0,1] row_mask:0xf bank_mask:0xf
  v_mov_b32_dpp v9, v9 quad_perm:[0,1,0,1] row_mask:0xf bank_mask:0xf
  s_nop 1
  v_add_f32_dpp v12, v14, v12 quad_perm:[2,3,0,1] row_mask:0xf bank_mask:0xf
  v_add_f32_dpp v13, v15, v13 quad_perm:[2,3,0,1] row_mask:0xf bank_mask:0xf
  s_nop 0
  v_mov_b32_dpp v12, v12 quad_perm:[0,1,0,1] row_mask:0xf bank_mask:0xf
  v_mov_b32_dpp v13, v13 quad_perm:[0,1,0,1] row_mask:0xf bank_mask:0xf
  v_mul_f32 v12, s69, v12
  ds_write_b32 v78, v8 offset:8716
  v_mul_f32 v13, s69, v13
  ds_write_b32 v78, v9 offset:8780
  s_waitcnt lgkmcnt(0)
  s_barrier
  ds_read_b128 v[36:39], v78 offset:8704
  ds_read_b128 v[40:43], v78 offset:8768
  s_waitcnt lgkmcnt(0)
  s_barrier
  v_max_f32 v16, v36, v37
  v_max3_f32 v16, v16, v38, v39
  v_max3_f32 v16, v16, v40, v41
  v_max3_f32 v16, v16, v42, v43
  v_max3_f32 v16, v16, v12, v13
  v_mov_b32 v17, v16
  s_nop 1
  v_permlane16_swap_b32 v16, v17
  v_max_f32 v16, v16, v17
  v_mov_b32 v17, v16
  s_nop 1
  v_permlane32_swap_b32 v16, v17
  v_max_f32 v16, v16, v17
  v_sub_f32 v36, v36, v16
  v_sub_f32 v37, v37, v16
  v_sub_f32 v38, v38, v16
  v_sub_f32 v39, v39, v16
  v_sub_f32 v40, v40, v16
  v_sub_f32 v41, v41, v16
  v_sub_f32 v42, v42, v16
  v_sub_f32 v43, v43, v16
  v_sub_f32 v12, v12, v16
  v_sub_f32 v13, v13, v16
  v_exp_f32 v36, v36
  v_exp_f32 v37, v37
  v_exp_f32 v38, v38
  v_exp_f32 v39, v39
  v_exp_f32 v40, v40
  v_exp_f32 v41, v41
  v_exp_f32 v42, v42
  v_exp_f32 v43, v43
  v_exp_f32 v12, v12
  v_exp_f32 v13, v13
  v_cvt_pk_bf16_f32 v32, v36, v40
  v_cvt_pk_bf16_f32 v33, v37, v41
  v_cvt_pk_bf16_f32 v34, v38, v42
  v_cvt_pk_bf16_f32 v35, v39, v43
  v_cvt_pk_bf16_f32 v28, v12, v13
  v_cvt_pk_bf16_f32 v31, v12, v13
  v_mov_b32 v29, 0
  v_mov_b32 v30, 0
  v_mov_b32 v68, 0x3f803f80
  v_mov_b32 v69, 0x3f803f80
  v_mov_b32 v70, 0x3f803f80
  v_mov_b32 v71, 0x3f803f80
  s_nop 1
  v_mfma_f32_16x16x32_bf16 v[8:11], v[32:35], v[68:71], 0
  v_mfma_f32_16x16x32_bf16 v[0:3], v[32:35], v[52:55], 0
  v_mfma_f32_16x16x32_bf16 v[4:7], v[32:35], v[56:59], 0
  v_mfma_f32_16x16x16_bf16 v[8:11], v[28:29], v[68:69], v[8:11]
  v_mfma_f32_16x16x16_bf16 v[0:3], v[28:29], v[72:73], v[0:3]
  v_mfma_f32_16x16x16_bf16 v[4:7], v[30:31], v[72:73], v[4:7]
  ds_read_b128 v[68:71], v76 offset:13824
  v_rcp_f32 v10, v8
  v_rcp_f32 v11, v9
  v_mul_f32 v0, v10, v0
  v_mul_f32 v1, v11, v1
  s_nop 0
  v_mul_f32 v4, v10, v4
  v_mul_f32 v5, v11, v5
  v_cvt_pk_bf16_f32 v2, v0, v4
  ds_write_b32 v79, v2 offset:8704
  v_cvt_pk_bf16_f32 v3, v1, v5
  ds_write_b32 v79, v3 offset:9280
  v_mov_b64 v[16:17], 0
  v_mov_b64 v[18:19], 0
  v_mov_b64 v[20:21], 0
  v_mov_b64 v[22:23], 0
  v_mov_b64 v[24:25], 0
  v_mov_b64 v[26:27], 0
  s_branch Cs3_mxok
Cs3_last:
  ds_read_b128 v[0:3], v76 offset:4608
  ds_read_b128 v[12:15], v76 offset:7680
  ds_read_b128 v[44:47], v76 offset:28672
  ds_read_b128 v[48:51], v76 offset:29696
  s_nop 5
  v_mov_b64 v[20:21], 0
  v_mov_b64 v[22:23], 0
  v_mov_b64 v[24:25], 0
  v_mov_b64 v[26:27], 0
  v_smfmac_f32_16x16x64_bf16 v[28:31], v[4:7], v[36:43], v74
  ds_read_b128 v[36:39], v76 offset:30720
  ds_read_b128 v[40:43], v76 offset:31744
  v_smfmac_f32_16x16x64_bf16 v[32:35], v[4:7], v[60:67], v74
  s_waitcnt lgkmcnt(5)
  v_smfmac_f32_16x16x64_bf16 v[20:23], v[0:3], a[32:39], v74
  ds_read_b128 v[60:63], v76 offset:61440
  ds_read_b128 v[64:67], v76 offset:62464
  v_smfmac_f32_16x16x64_bf16 v[24:27], v[0:3], a[40:47], v74
  s_waitcnt lgkmcnt(4)
  v_smfmac_f32_16x16x64_bf16 v[20:23], v[4:7], a[48:55], v74
  buffer_store_dwordx4 v[16:19], v76, s[8:11], s68 offen sc1
  v_smfmac_f32_16x16x64_bf16 v[24:27], v[4:7], a[56:63], v74
  v_smfmac_f32_16x16x64_bf16 v[28:31], v[0:3], v[44:51], v74
  s_waitcnt lgkmcnt(2)
  v_smfmac_f32_16x16x64_bf16 v[20:23], v[8:11], a[64:71], v74
  ds_read_b128 v[44:47], v76 offset:63488
  ds_read_b128 v[48:51], v76 offset:64512
  v_smfmac_f32_16x16x64_bf16 v[24:27], v[8:11], a[72:79], v74
  v_smfmac_f32_16x16x64_bf16 v[32:35], v[0:3], v[36:43], v74
  v_smfmac_f32_16x16x64_bf16 v[28:31], v[8:11], v[208:215], v74
  ds_read_b128 v[36:39], v75 offset:28672
  ds_read_b128 v[40:43], v75 offset:29696
  v_smfmac_f32_16x16x64_bf16 v[32:35], v[8:11], v[216:223], v74
  v_smfmac_f32_16x16x64_bf16 v[20:23], v[12:15], a[80:87], v74
  v_smfmac_f32_16x16x64_bf16 v[24:27], v[12:15], a[88:95], v74
  v_smfmac_f32_16x16x64_bf16 v[28:31], v[12:15], v[224:231], v74
  v_smfmac_f32_16x16x64_bf16 v[32:35], v[12:15], v[232:239], v74
  s_waitcnt vmcnt(1)
  s_barrier
Cs3_lastr:
  ds_read_b128 v[4:7], v76 offset:8704
  ds_read_b128 v[8:11], v76 offset:9728
  ds_read_b128 v[16:19], v76 offset:10752
  ds_read_b128 v[0:3], v76 offset:11776
  ds_read_b128 v[12:15], v76 offset:12800
  s_waitcnt lgkmcnt(1)
  v_max3_u32 v72, v0, v1, v2
  v_max3_u32 v72, v72, v3, v4
  v_max3_u32 v72, v72, v5, v6
  v_max3_u32 v72, v72, v7, v8
  v_max3_u32 v72, v72, v9, v10
  s_waitcnt lgkmcnt(0)
  v_max3_u32 v72, v72, v11, v12
  v_max3_u32 v72, v72, v13, v14
  v_max3_u32 v72, v72, v15, v16
  v_max3_u32 v72, v72, v17, v18
  v_max_u32 v72, v72, v19
  v_cmp_eq_u32 vcc, -1, v72
  s_cbranch_vccnz Cs3_lastp
Cs3_lastg:
  v_smfmac_f32_16x16x64_bf16 v[28:31], v[4:7], v[60:67], v74
  ds_read_b128 v[60:63], v75 offset:30720
  ds_read_b128 v[64:67], v75 offset:31744
  v_smfmac_f32_16x16x64_bf16 v[32:35], v[4:7], v[44:51], v74
  v_smfmac_f32_16x16x64_bf16 v[28:31], v[8:11], v[36:43], v74
  v_smfmac_f32_16x16x64_bf16 v[28:31], v[16:19], v[240:247], v74
  v_smfmac_f32_16x16x64_bf16 v[28:31], v[0:3], a[0:7], v74
  v_smfmac_f32_16x16x64_bf16 v[28:31], v[12:15], a[16:23], v74
  v_smfmac_f32_16x16x64_bf16 v[32:35], v[16:19], v[248:255], v74
  v_smfmac_f32_16x16x64_bf16 v[32:35], v[0:3], a[8:15], v74
  s_waitcnt lgkmcnt(0)
  v_smfmac_f32_16x16x64_bf16 v[32:35], v[12:15], a[24:31], v74
  v_smfmac_f32_16x16x64_bf16 v[32:35], v[8:11], v[60:67], v74
  v_smfmac_f32_16x16x64_bf16 v[20:23], v[4:7], a[96:103], v74
  v_smfmac_f32_16x16x64_bf16 v[20:23], v[8:11], a[112:119], v74
  v_add_f32 v28, v28, v30
  v_add_f32 v32, v32, v34
  v_cvt_pk_bf16_f32 v30, v28, v32
  v_smfmac_f32_16x16x64_bf16 v[20:23], v[16:19], a[128:135], v74
  ds_write_b32 v79, v30 offset:256
  v_add_f32 v29, v29, v31
  v_add_f32 v33, v33, v35
  v_cvt_pk_bf16_f32 v31, v29, v33
  v_smfmac_f32_16x16x64_bf16 v[20:23], v[0:3], a[144:151], v74
  ds_write_b32 v79, v31 offset:832
  v_smfmac_f32_16x16x64_bf16 v[20:23], v[12:15], a[160:167], v74
  v_smfmac_f32_16x16x64_bf16 v[24:27], v[4:7], a[104:111], v74
  v_smfmac_f32_16x16x64_bf16 v[24:27], v[8:11], a[120:127], v74
  v_smfmac_f32_16x16x64_bf16 v[24:27], v[16:19], a[136:143], v74
  s_waitcnt lgkmcnt(0)
  s_barrier
  ds_read_b64 v[52:53], v77 offset:392
  v_add_f32 v20, v20, v22
  v_smfmac_f32_16x16x64_bf16 v[24:27], v[0:3], a[152:159], v74
  v_add_f32 v21, v21, v23
  v_smfmac_f32_16x16x64_bf16 v[24:27], v[12:15], a[168:175], v74
  v_cvt_pk_bf16_f32 v54, v20, v21
  s_add_u32 s68, s68, 655360
  s_nop 3
  v_add_f32 v24, v24, v26
  v_add_f32 v25, v25, v27
  v_cvt_pk_bf16_f32 v55, v24, v25
  s_waitcnt lgkmcnt(0)
  buffer_store_dwordx4 v[52:55], v76, s[8:11], s68 offen sc1
  s_branch Cs3_done
Cs3_lastp:
  s_add_u32 s72, s72, 2
  s_cmp_ge_u32 s72, 131072
  s_cbranch_scc1 Cs3_lastg
  s_barrier
  buffer_load_dwordx4 v76, s[8:11], s55 offen offset:0 sc1 lds
  buffer_load_dwordx4 v76, s[8:11], s55 offen offset:1024 sc1 lds
  s_waitcnt vmcnt(0)
  s_barrier
  s_branch Cs3_lastr
Cs3_done:
  s_branch L_cexit
L_conf:
  s_waitcnt vmcnt(0) lgkmcnt(0)
  s_barrier
  s_cmp_eq_u32 s52, 0
  s_cbranch_scc0 L_cf2
  s_mov_b64 exec, 1
  s_lshl_b32 s57, s2, 2
  v_mov_b32 v1, 0
L_cf0:
  s_cmp_eq_u32 s54, -1
  s_cbranch_scc1 L_cf1
  s_mov_b32 s55, s54
  s_lshr_b64 s[54:55], s[54:55], s0
  s_ff0_i32_b32 s56, s54
  s_add_u32 s0, s0, s56
  s_and_b32 s0, s0, 31
  s_lshl_b32 s56, 1, s0
  v_mov_b32 v35, s56
  buffer_atomic_or v35, v1, s[12:15], s57 offen sc0
  s_waitcnt vmcnt(0)
  v_readfirstlane_b32 s54, v35
  s_nop 0
  s_bitcmp1_b32 s54, s0
  s_cbranch_scc1 L_cf0
  v_mov_b32 v35, s0
  s_branch L_cf3
L_cf1:
  v_mov_b32 v35, 1
  buffer_atomic_add v35, v1, s[12:15], 0 offen offset:40 sc0
  s_waitcnt vmcnt(0)
  v_add_u32 v35, 32, v35
L_cf3:
  ds_write_b32 v33, v35
  s_mov_b64 exec, -1
  s_waitcnt lgkmcnt(0)
L_cf2:
  s_barrier
  ds_read_b32 v32, v33
  s_waitcnt lgkmcnt(0)
  v_readfirstlane_b32 s0, v32
  s_mov_b32 s1, 1
  s_cmp_lt_u32 s0, 32
  s_cbranch_scc1 L_role
  s_sub_u32 s53, s0, 32
  s_mov_b32 s57, 0
L_sur:
  s_load_dwordx16 s[60:75], s[12:13], 0 glc
  s_add_u32 s57, s57, 1
  s_waitcnt lgkmcnt(0)
  s_mov_b32 s55, s70
  s_bcnt1_i32_b32 s56, s60
  s_add_u32 s55, s55, s56
  s_bcnt1_i32_b32 s56, s61
  s_add_u32 s55, s55, s56
  s_bcnt1_i32_b32 s56, s62
  s_add_u32 s55, s55, s56
  s_bcnt1_i32_b32 s56, s63
  s_add_u32 s55, s55, s56
  s_bcnt1_i32_b32 s56, s64
  s_add_u32 s55, s55, s56
  s_bcnt1_i32_b32 s56, s65
  s_add_u32 s55, s55, s56
  s_bcnt1_i32_b32 s56, s66
  s_add_u32 s55, s55, s56
  s_bcnt1_i32_b32 s56, s67
  s_add_u32 s55, s55, s56
  s_cmp_ge_u32 s57, 131072
  s_cbranch_scc1 L_end
  s_cmp_lt_u32 s55, 256
  s_cbranch_scc1 L_sur
  s_mov_b32 s2, 0
  s_mov_b32 s54, s60
  s_bcnt0_i32_b32 s56, s54
  s_cmp_lt_u32 s53, s56
  s_cbranch_scc1 L_sur2
  s_sub_u32 s53, s53, s56
  s_mov_b32 s2, 1
  s_mov_b32 s54, s61
  s_bcnt0_i32_b32 s56, s54
  s_cmp_lt_u32 s53, s56
  s_cbranch_scc1 L_sur2
  s_sub_u32 s53, s53, s56
  s_mov_b32 s2, 2
  s_mov_b32 s54, s62
  s_bcnt0_i32_b32 s56, s54
  s_cmp_lt_u32 s53, s56
  s_cbranch_scc1 L_sur2
  s_sub_u32 s53, s53, s56
  s_mov_b32 s2, 3
  s_mov_b32 s54, s63
  s_bcnt0_i32_b32 s56, s54
  s_cmp_lt_u32 s53, s56
  s_cbranch_scc1 L_sur2
  s_sub_u32 s53, s53, s56
  s_mov_b32 s2, 4
  s_mov_b32 s54, s64
  s_bcnt0_i32_b32 s56, s54
  s_cmp_lt_u32 s53, s56
  s_cbranch_scc1 L_sur2
  s_sub_u32 s53, s53, s56
  s_mov_b32 s2, 5
  s_mov_b32 s54, s65
  s_bcnt0_i32_b32 s56, s54
  s_cmp_lt_u32 s53, s56
  s_cbranch_scc1 L_sur2
  s_sub_u32 s53, s53, s56
  s_mov_b32 s2, 6
  s_mov_b32 s54, s66
  s_bcnt0_i32_b32 s56, s54
  s_cmp_lt_u32 s53, s56
  s_cbranch_scc1 L_sur2
  s_sub_u32 s53, s53, s56
  s_mov_b32 s2, 7
  s_mov_b32 s54, s67
  s_bcnt0_i32_b32 s56, s54
  s_cmp_lt_u32 s53, s56
  s_cbranch_scc1 L_sur2
  s_sub_u32 s53, s53, s56
  s_branch L_end
L_sur2:
  s_ff0_i32_b32 s0, s54
  s_bitset1_b32 s54, s0
  s_sub_u32 s53, s53, 1
  s_cbranch_scc0 L_sur2
  s_branch L_role
L_worker:
  s_lshl_b32 s54, s2, 2
  s_lshr_b32 s54, 1412567136, s54
  s_and_b32 s54, s54, 7
  s_lshl_b32 s54, s54, 5
  s_add_u32 s53, s53, s54
  s_getpc_b64 s[80:81]
L_pc_2:
  s_and_b32 s55, s0, 1
  s_lshl_b32 s55, s55, 2
  s_add_u32 s55, s55, s52
  s_lshl_b32 s55, s55, 13
  v_and_b32 v199, 63, v0
  v_lshl_add_u32 v199, v199, 7, s55
  s_sub_u32 s82, s80, (L_pc_2 - L_w0)
  s_subb_u32 s83, s81, 0
  v_min_u32 v198, (L_w4 - L_w0), v199
  global_load_dword v196, v198, s[82:83]
  v_min_u32 v199, (L_end - L_pc_2), v199
  global_load_dword v196, v199, s[80:81]
  v_and_b32 v200, 63, v0
  v_lshlrev_b32 v201, 4, v200
  v_lshrrev_b32 v211, 3, v200
  s_lshl_b32 s54, s52, 3
  v_add_u32 v211, s54, v211
  v_bfe_u32 v212, v211, 1, 3
  v_and_b32 v213, 7, v200
  v_xor_b32 v212, v212, v213
  v_mul_u32_u24 v211, 1152, v211
  v_lshl_add_u32 v202, v212, 4, v211
  s_mul_i32 s67, s52, 9216
  v_and_b32 v211, 31, v200
  v_lshrrev_b32 v212, 3, v211
  v_mul_u32_u24 v212, 9216, v212
  v_and_b32 v213, 7, v211
  v_lshl_add_u32 v212, v213, 7, v212
  v_bfe_u32 v213, v211, 1, 3
  v_lshrrev_b32 v214, 5, v200
  v_xor_b32 v213, v213, v214
  v_lshl_add_u32 v203, v213, 4, v212
  v_xor_b32 v204, 32, v203
  v_xor_b32 v205, 64, v203
  v_xor_b32 v206, 0x60, v203
  v_bfe_u32 v211, v200, 2, 2
  v_lshl_add_u32 v212, v214, 3, v211
  v_lshlrev_b32 v212, 8, v212
  v_xor_b32 v211, s52, v211
  v_lshl_add_u32 v212, v211, 6, v212
  v_bfe_u32 v213, v200, 4, 1
  v_and_b32 v211, 3, v200
  v_lshl_add_u32 v210, v213, 5, v212
  v_lshl_add_u32 v210, v211, 3, v210
  v_lshl_add_u32 v209, v213, 4, v212
  v_and_b32 v213, 1, v211
  v_lshl_add_u32 v209, v213, 3, v209
  v_lshrrev_b32 v213, 1, v211
  v_lshl_add_u32 v209, v213, 5, v209
  s_mov_b32 s65, 0
  s_mul_i32 s58, s53, 9363
  s_lshr_b32 s58, s58, 16
  s_mul_i32 s54, s58, 7
  s_sub_u32 s59, s53, s54
  s_mul_i32 s60, s59, 36864
  s_add_u32 m0, s67, 0
  s_nop 0
  buffer_load_dwordx4 v202, s[4:7], s60 offen offset:0 lds
  s_add_u32 m0, s67, 896
  s_nop 0
  buffer_load_dwordx4 v202, s[4:7], s60 offen offset:128 lds
  s_add_u32 m0, s67, 1792
  s_nop 0
  buffer_load_dwordx4 v202, s[4:7], s60 offen offset:256 lds
  s_add_u32 m0, s67, 2688
  s_nop 0
  buffer_load_dwordx4 v202, s[4:7], s60 offen offset:384 lds
  s_add_u32 m0, s67, 3584
  s_nop 0
  buffer_load_dwordx4 v202, s[4:7], s60 offen offset:512 lds
  s_add_u32 m0, s67, 4480
  s_nop 0
  buffer_load_dwordx4 v202, s[4:7], s60 offen offset:640 lds
  s_add_u32 m0, s67, 5376
  s_nop 0
  buffer_load_dwordx4 v202, s[4:7], s60 offen offset:768 lds
  s_add_u32 m0, s67, 6272
  s_nop 0
  buffer_load_dwordx4 v202, s[4:7], s60 offen offset:896 lds
  s_add_u32 m0, s67, 7168
  s_nop 0
  buffer_load_dwordx4 v202, s[4:7], s60 offen offset:1024 lds
  v_lshrrev_b32 v211, 4, v200
  v_lshlrev_b32 v212, 2, v211
  v_and_b32 v213, 15, v200
  v_xor_b32 v212, v212, v213
  v_lshlrev_b32 v212, 4, v212
  v_lshl_add_u32 v207, v211, 13, v212
  s_lshl_b32 s62, s58, 8
  s_lshl_b32 s54, s52, 15
  s_add_u32 s62, s62, s54
  s_lshl_b32 s61, s52, 10
  s_add_u32 s61, s61, 36864
  s_add_u32 m0, s61, 0
  s_add_u32 s54, s62, 0
  buffer_load_dwordx4 v207, s[20:23], s54 offen lds
  s_add_u32 m0, s61, 4096
  s_add_u32 s54, s62, 131072
  buffer_load_dwordx4 v207, s[20:23], s54 offen lds
  s_add_u32 m0, s61, 8192
  s_add_u32 s54, s62, 262144
  buffer_load_dwordx4 v207, s[20:23], s54 offen lds
  s_add_u32 m0, s61, 12288
  s_add_u32 s54, s62, 393216
  buffer_load_dwordx4 v207, s[20:23], s54 offen lds
  s_add_u32 m0, s61, 16384
  s_add_u32 s54, s62, 0
  buffer_load_dwordx4 v207, s[24:27], s54 offen lds
  s_add_u32 m0, s61, 20480
  s_add_u32 s54, s62, 131072
  buffer_load_dwordx4 v207, s[24:27], s54 offen lds
  s_add_u32 m0, s61, 24576
  s_add_u32 s54, s62, 262144
  buffer_load_dwordx4 v207, s[24:27], s54 offen lds
  s_add_u32 m0, s61, 28672
  s_add_u32 s54, s62, 393216
  buffer_load_dwordx4 v207, s[24:27], s54 offen lds
  s_add_u32 m0, s61, 32768
  s_add_u32 s54, s62, 524288
  buffer_load_dwordx4 v207, s[20:23], s54 offen lds
  s_add_u32 m0, s61, 36864
  s_add_u32 s54, s62, 655360
  buffer_load_dwordx4 v207, s[20:23], s54 offen lds
  s_add_u32 m0, s61, 40960
  s_add_u32 s54, s62, 786432
  buffer_load_dwordx4 v207, s[20:23], s54 offen lds
  s_add_u32 m0, s61, 45056
  s_add_u32 s54, s62, 917504
  buffer_load_dwordx4 v207, s[20:23], s54 offen lds
  s_add_u32 m0, s61, 49152
  s_add_u32 s54, s62, 524288
  buffer_load_dwordx4 v207, s[24:27], s54 offen lds
  s_add_u32 m0, s61, 53248
  s_add_u32 s54, s62, 655360
  buffer_load_dwordx4 v207, s[24:27], s54 offen lds
  s_add_u32 m0, s61, 57344
  s_add_u32 s54, s62, 786432
  buffer_load_dwordx4 v207, s[24:27], s54 offen lds
  s_add_u32 m0, s61, 61440
  s_add_u32 s54, s62, 917504
  buffer_load_dwordx4 v207, s[24:27], s54 offen lds
  s_add_u32 m0, s61, 65536
  s_add_u32 s54, s62, 1048576
  buffer_load_dwordx4 v207, s[20:23], s54 offen lds
  s_add_u32 m0, s61, 69632
  s_add_u32 s54, s62, 1179648
  buffer_load_dwordx4 v207, s[20:23], s54 offen lds
  s_add_u32 m0, s61, 73728
  s_add_u32 s54, s62, 1310720
  buffer_load_dwordx4 v207, s[20:23], s54 offen lds
  s_add_u32 m0, s61, 77824
  s_add_u32 s54, s62, 1441792
  buffer_load_dwordx4 v207, s[20:23], s54 offen lds
  s_add_u32 m0, s61, 81920
  s_add_u32 s54, s62, 1048576
  buffer_load_dwordx4 v207, s[24:27], s54 offen lds
  s_add_u32 m0, s61, 86016
  s_add_u32 s54, s62, 1179648
  buffer_load_dwordx4 v207, s[24:27], s54 offen lds
  s_add_u32 m0, s61, 90112
  s_add_u32 s54, s62, 1310720
  buffer_load_dwordx4 v207, s[24:27], s54 offen lds
  s_add_u32 m0, s61, 94208
  s_add_u32 s54, s62, 1441792
  buffer_load_dwordx4 v207, s[24:27], s54 offen lds
  v_bfe_u32 v211, v200, 3, 2
  v_lshlrev_b32 v216, 11, v211
  v_bfe_u32 v211, v200, 1, 2
  v_lshl_add_u32 v216, v211, 6, v216
  v_lshrrev_b32 v212, 5, v200
  v_lshl_add_u32 v216, v212, 5, v216
  v_and_b32 v211, 1, v200
  v_lshl_add_u32 v216, v211, 4, v216
  v_bfe_u32 v211, v200, 4, 1
  v_lshlrev_b32 v217, 10, v211
  v_lshl_add_u32 v217, v212, 9, v217
  v_and_b32 v211, 15, v200
  v_lshl_add_u32 v217, v211, 4, v217
  s_lshl_b32 s54, s52, 11
  s_add_u32 s54, s54, 8192
  v_add_u32 v217, s54, v217
  s_cmp_eq_u32 s1, 1
  s_cbranch_scc1 W_ver_ok
  v_mov_b32 v33, 163832
  s_cmp_eq_u32 s52, 0
  s_cbranch_scc0 W_ver_b
  s_waitcnt vmcnt(35)
  s_mov_b64 exec, 1
  ds_write_b32 v33, v35
  s_mov_b64 exec, -1
  s_waitcnt lgkmcnt(0)
W_ver_b:
  s_barrier
  ds_read_b32 v32, v33
  s_waitcnt lgkmcnt(0)
  v_readfirstlane_b32 s54, v32
  s_nop 0
  s_bitcmp1_b32 s54, s0
  s_cbranch_scc1 L_conf
W_ver_ok:
  s_waitcnt vmcnt(20) lgkmcnt(0)
  s_barrier
  s_add_u32 m0, s61, 98304
  s_add_u32 s54, s62, 1572864
  buffer_load_dwordx4 v207, s[20:23], s54 offen lds
  s_add_u32 m0, s61, 102400
  s_add_u32 s54, s62, 1703936
  buffer_load_dwordx4 v207, s[20:23], s54 offen lds
  s_add_u32 m0, s61, 106496
  s_add_u32 s54, s62, 1835008
  buffer_load_dwordx4 v207, s[20:23], s54 offen lds
  s_add_u32 m0, s61, 110592
  s_add_u32 s54, s62, 1966080
  buffer_load_dwordx4 v207, s[20:23], s54 offen lds
  v_add_u32 v215, 36864, v209
  ds_read_b64_tr_b16 a[0:1], v215 offset:0
  ds_read_b64_tr_b16 a[2:3], v215 offset:1024
  ds_read_b64_tr_b16 a[4:5], v215 offset:4096
  ds_read_b64_tr_b16 a[6:7], v215 offset:5120
  ds_read_b64_tr_b16 a[8:9], v215 offset:8192
  ds_read_b64_tr_b16 a[10:11], v215 offset:9216
  ds_read_b64_tr_b16 a[12:13], v215 offset:12288
  ds_read_b64_tr_b16 a[14:15], v215 offset:13312
  s_waitcnt vmcnt(20) lgkmcnt(0)
  s_barrier
  s_add_u32 m0, s61, 0
  s_add_u32 s54, s62, 1572864
  buffer_load_dwordx4 v207, s[24:27], s54 offen lds
  s_add_u32 m0, s61, 4096
  s_add_u32 s54, s62, 1703936
  buffer_load_dwordx4 v207, s[24:27], s54 offen lds
  s_add_u32 m0, s61, 8192
  s_add_u32 s54, s62, 1835008
  buffer_load_dwordx4 v207, s[24:27], s54 offen lds
  s_add_u32 m0, s61, 12288
  s_add_u32 s54, s62, 1966080
  buffer_load_dwordx4 v207, s[24:27], s54 offen lds
  v_add_u32 v215, 53248, v210
  ds_read_b64_tr_b16 a[144:145], v215 offset:0
  ds_read_b64_tr_b16 a[146:147], v215 offset:1024
  ds_read_b64_tr_b16 a[148:149], v215 offset:4096
  ds_read_b64_tr_b16 a[150:151], v215 offset:5120
  ds_read_b64_tr_b16 a[152:153], v215 offset:8192
  ds_read_b64_tr_b16 a[154:155], v215 offset:9216
  ds_read_b64_tr_b16 a[156:157], v215 offset:12288
  ds_read_b64_tr_b16 a[158:159], v215 offset:13312
  s_waitcnt vmcnt(20) lgkmcnt(0)
  s_barrier
  s_add_u32 m0, s61, 16384
  s_add_u32 s54, s62, 2097152
  buffer_load_dwordx4 v207, s[20:23], s54 offen lds
  s_add_u32 m0, s61, 20480
  s_add_u32 s54, s62, 2228224
  buffer_load_dwordx4 v207, s[20:23], s54 offen lds
  s_add_u32 m0, s61, 24576
  s_add_u32 s54, s62, 2359296
  buffer_load_dwordx4 v207, s[20:23], s54 offen lds
  s_add_u32 m0, s61, 28672
  s_add_u32 s54, s62, 2490368
  buffer_load_dwordx4 v207, s[20:23], s54 offen lds
  v_add_u32 v215, 69632, v209
  ds_read_b64_tr_b16 a[16:17], v215 offset:0
  ds_read_b64_tr_b16 a[18:19], v215 offset:1024
  ds_read_b64_tr_b16 a[20:21], v215 offset:4096
  ds_read_b64_tr_b16 a[22:23], v215 offset:5120
  ds_read_b64_tr_b16 a[24:25], v215 offset:8192
  ds_read_b64_tr_b16 a[26:27], v215 offset:9216
  ds_read_b64_tr_b16 a[28:29], v215 offset:12288
  ds_read_b64_tr_b16 a[30:31], v215 offset:13312
  s_waitcnt vmcnt(20) lgkmcnt(0)
  s_barrier
  s_add_u32 m0, s61, 32768
  s_add_u32 s54, s62, 2097152
  buffer_load_dwordx4 v207, s[24:27], s54 offen lds
  s_add_u32 m0, s61, 36864
  s_add_u32 s54, s62, 2228224
  buffer_load_dwordx4 v207, s[24:27], s54 offen lds
  s_add_u32 m0, s61, 40960
  s_add_u32 s54, s62, 2359296
  buffer_load_dwordx4 v207, s[24:27], s54 offen lds
  s_add_u32 m0, s61, 45056
  s_add_u32 s54, s62, 2490368
  buffer_load_dwordx4 v207, s[24:27], s54 offen lds
  v_add_u32 v215, 86016, v210
  ds_read_b64_tr_b16 a[160:161], v215 offset:0
  ds_read_b64_tr_b16 a[162:163], v215 offset:1024
  ds_read_b64_tr_b16 a[164:165], v215 offset:4096
  ds_read_b64_tr_b16 a[166:167], v215 offset:5120
  ds_read_b64_tr_b16 a[168:169], v215 offset:8192
  ds_read_b64_tr_b16 a[170:171], v215 offset:9216
  ds_read_b64_tr_b16 a[172:173], v215 offset:12288
  ds_read_b64_tr_b16 a[174:175], v215 offset:13312
  s_waitcnt vmcnt(20) lgkmcnt(0)
  s_barrier
  s_add_u32 m0, s61, 49152
  s_add_u32 s54, s62, 2621440
  buffer_load_dwordx4 v207, s[20:23], s54 offen lds
  s_add_u32 m0, s61, 53248
  s_add_u32 s54, s62, 2752512
  buffer_load_dwordx4 v207, s[20:23], s54 offen lds
  s_add_u32 m0, s61, 57344
  s_add_u32 s54, s62, 2883584
  buffer_load_dwordx4 v207, s[20:23], s54 offen lds
  s_add_u32 m0, s61, 61440
  s_add_u32 s54, s62, 3014656
  buffer_load_dwordx4 v207, s[20:23], s54 offen lds
  v_add_u32 v215, 102400, v209
  ds_read_b64_tr_b16 a[32:33], v215 offset:0
  ds_read_b64_tr_b16 a[34:35], v215 offset:1024
  ds_read_b64_tr_b16 a[36:37], v215 offset:4096
  ds_read_b64_tr_b16 a[38:39], v215 offset:5120
  ds_read_b64_tr_b16 a[40:41], v215 offset:8192
  ds_read_b64_tr_b16 a[42:43], v215 offset:9216
  ds_read_b64_tr_b16 a[44:45], v215 offset:12288
  ds_read_b64_tr_b16 a[46:47], v215 offset:13312
  s_waitcnt vmcnt(20) lgkmcnt(0)
  s_barrier
  s_add_u32 m0, s61, 65536
  s_add_u32 s54, s62, 2621440
  buffer_load_dwordx4 v207, s[24:27], s54 offen lds
  s_add_u32 m0, s61, 69632
  s_add_u32 s54, s62, 2752512
  buffer_load_dwordx4 v207, s[24:27], s54 offen lds
  s_add_u32 m0, s61, 73728
  s_add_u32 s54, s62, 2883584
  buffer_load_dwordx4 v207, s[24:27], s54 offen lds
  s_add_u32 m0, s61, 77824
  s_add_u32 s54, s62, 3014656
  buffer_load_dwordx4 v207, s[24:27], s54 offen lds
  v_add_u32 v215, 118784, v210
  ds_read_b64_tr_b16 a[176:177], v215 offset:0
  ds_read_b64_tr_b16 a[178:179], v215 offset:1024
  ds_read_b64_tr_b16 a[180:181], v215 offset:4096
  ds_read_b64_tr_b16 a[182:183], v215 offset:5120
  ds_read_b64_tr_b16 a[184:185], v215 offset:8192
  ds_read_b64_tr_b16 a[186:187], v215 offset:9216
  ds_read_b64_tr_b16 a[188:189], v215 offset:12288
  ds_read_b64_tr_b16 a[190:191], v215 offset:13312
  s_waitcnt vmcnt(20) lgkmcnt(0)
  s_barrier
  s_add_u32 m0, s61, 81920
  s_add_u32 s54, s62, 3145728
  buffer_load_dwordx4 v207, s[20:23], s54 offen lds
  s_add_u32 m0, s61, 86016
  s_add_u32 s54, s62, 3276800
  buffer_load_dwordx4 v207, s[20:23], s54 offen lds
  s_add_u32 m0, s61, 90112
  s_add_u32 s54, s62, 3407872
  buffer_load_dwordx4 v207, s[20:23], s54 offen lds
  s_add_u32 m0, s61, 94208
  s_add_u32 s54, s62, 3538944
  buffer_load_dwordx4 v207, s[20:23], s54 offen lds
  v_add_u32 v215, 135168, v209
  ds_read_b64_tr_b16 a[48:49], v215 offset:0
  ds_read_b64_tr_b16 a[50:51], v215 offset:1024
  ds_read_b64_tr_b16 a[52:53], v215 offset:4096
  ds_read_b64_tr_b16 a[54:55], v215 offset:5120
  ds_read_b64_tr_b16 a[56:57], v215 offset:8192
  ds_read_b64_tr_b16 a[58:59], v215 offset:9216
  ds_read_b64_tr_b16 a[60:61], v215 offset:12288
  ds_read_b64_tr_b16 a[62:63], v215 offset:13312
  s_waitcnt vmcnt(20) lgkmcnt(0)
  s_barrier
  s_add_u32 m0, s61, 98304
  s_add_u32 s54, s62, 3145728
  buffer_load_dwordx4 v207, s[24:27], s54 offen lds
  s_add_u32 m0, s61, 102400
  s_add_u32 s54, s62, 3276800
  buffer_load_dwordx4 v207, s[24:27], s54 offen lds
  s_add_u32 m0, s61, 106496
  s_add_u32 s54, s62, 3407872
  buffer_load_dwordx4 v207, s[24:27], s54 offen lds
  s_add_u32 m0, s61, 110592
  s_add_u32 s54, s62, 3538944
  buffer_load_dwordx4 v207, s[24:27], s54 offen lds
  v_add_u32 v215, 36864, v210
  ds_read_b64_tr_b16 a[192:193], v215 offset:0
  ds_read_b64_tr_b16 a[194:195], v215 offset:1024
  ds_read_b64_tr_b16 a[196:197], v215 offset:4096
  ds_read_b64_tr_b16 a[198:199], v215 offset:5120
  ds_read_b64_tr_b16 a[200:201], v215 offset:8192
  ds_read_b64_tr_b16 a[202:203], v215 offset:9216
  ds_read_b64_tr_b16 a[204:205], v215 offset:12288
  ds_read_b64_tr_b16 a[206:207], v215 offset:13312
  s_waitcnt vmcnt(20) lgkmcnt(0)
  s_barrier
  s_add_u32 m0, s61, 0
  s_add_u32 s54, s62, 3670016
  buffer_load_dwordx4 v207, s[20:23], s54 offen lds
  s_add_u32 m0, s61, 4096
  s_add_u32 s54, s62, 3801088
  buffer_load_dwordx4 v207, s[20:23], s54 offen lds
  s_add_u32 m0, s61, 8192
  s_add_u32 s54, s62, 3932160
  buffer_load_dwordx4 v207, s[20:23], s54 offen lds
  s_add_u32 m0, s61, 12288
  s_add_u32 s54, s62, 4063232
  buffer_load_dwordx4 v207, s[20:23], s54 offen lds
  v_add_u32 v215, 53248, v209
  ds_read_b64_tr_b16 a[64:65], v215 offset:0
  ds_read_b64_tr_b16 a[66:67], v215 offset:1024
  ds_read_b64_tr_b16 a[68:69], v215 offset:4096
  ds_read_b64_tr_b16 a[70:71], v215 offset:5120
  ds_read_b64_tr_b16 a[72:73], v215 offset:8192
  ds_read_b64_tr_b16 a[74:75], v215 offset:9216
  ds_read_b64_tr_b16 a[76:77], v215 offset:12288
  ds_read_b64_tr_b16 a[78:79], v215 offset:13312
  s_waitcnt vmcnt(20) lgkmcnt(0)
  s_barrier
  s_add_u32 m0, s61, 16384
  s_add_u32 s54, s62, 3670016
  buffer_load_dwordx4 v207, s[24:27], s54 offen lds
  s_add_u32 m0, s61, 20480
  s_add_u32 s54, s62, 3801088
  buffer_load_dwordx4 v207, s[24:27], s54 offen lds
  s_add_u32 m0, s61, 24576
  s_add_u32 s54, s62, 3932160
  buffer_load_dwordx4 v207, s[24:27], s54 offen lds
  s_add_u32 m0, s61, 28672
  s_add_u32 s54, s62, 4063232
  buffer_load_dwordx4 v207, s[24:27], s54 offen lds
  v_add_u32 v215, 69632, v210
  ds_read_b64_tr_b16 a[208:209], v215 offset:0
  ds_read_b64_tr_b16 a[210:211], v215 offset:1024
  ds_read_b64_tr_b16 a[212:213], v215 offset:4096
  ds_read_b64_tr_b16 a[214:215], v215 offset:5120
  ds_read_b64_tr_b16 a[216:217], v215 offset:8192
  ds_read_b64_tr_b16 a[218:219], v215 offset:9216
  ds_read_b64_tr_b16 a[220:221], v215 offset:12288
  ds_read_b64_tr_b16 a[222:223], v215 offset:13312
  s_waitcnt vmcnt(20) lgkmcnt(0)
  s_barrier
  s_add_u32 m0, s61, 32768
  s_add_u32 s54, s62, 4194304
  buffer_load_dwordx4 v207, s[20:23], s54 offen lds
  s_add_u32 m0, s61, 36864
  s_add_u32 s54, s62, 4325376
  buffer_load_dwordx4 v207, s[20:23], s54 offen lds
  s_add_u32 m0, s61, 40960
  s_add_u32 s54, s62, 4456448
  buffer_load_dwordx4 v207, s[20:23], s54 offen lds
  s_add_u32 m0, s61, 45056
  s_add_u32 s54, s62, 4587520
  buffer_load_dwordx4 v207, s[20:23], s54 offen lds
  v_add_u32 v215, 86016, v209
  ds_read_b64_tr_b16 a[80:81], v215 offset:0
  ds_read_b64_tr_b16 a[82:83], v215 offset:1024
  ds_read_b64_tr_b16 a[84:85], v215 offset:4096
  ds_read_b64_tr_b16 a[86:87], v215 offset:5120
  ds_read_b64_tr_b16 a[88:89], v215 offset:8192
  ds_read_b64_tr_b16 a[90:91], v215 offset:9216
  ds_read_b64_tr_b16 a[92:93], v215 offset:12288
  ds_read_b64_tr_b16 a[94:95], v215 offset:13312
  s_waitcnt vmcnt(20) lgkmcnt(0)
  s_barrier
  s_add_u32 m0, s61, 49152
  s_add_u32 s54, s62, 4194304
  buffer_load_dwordx4 v207, s[24:27], s54 offen lds
  s_add_u32 m0, s61, 53248
  s_add_u32 s54, s62, 4325376
  buffer_load_dwordx4 v207, s[24:27], s54 offen lds
  s_add_u32 m0, s61, 57344
  s_add_u32 s54, s62, 4456448
  buffer_load_dwordx4 v207, s[24:27], s54 offen lds
  s_add_u32 m0, s61, 61440
  s_add_u32 s54, s62, 4587520
  buffer_load_dwordx4 v207, s[24:27], s54 offen lds
  s_mul_i32 s54, s53, 21120
  s_lshl_b32 s55, s52, 13
  s_add_u32 s54, s54, s55
  s_cmp_eq_u32 s52, 3
  s_cselect_b32 s54, 0x10000000, s54
  v_lshlrev_b32 v211, 3, v201
  buffer_load_dword v196, v211, s[28:31], s54 offen
  v_add_u32 v215, 102400, v210
  ds_read_b64_tr_b16 a[224:225], v215 offset:0
  ds_read_b64_tr_b16 a[226:227], v215 offset:1024
  ds_read_b64_tr_b16 a[228:229], v215 offset:4096
  ds_read_b64_tr_b16 a[230:231], v215 offset:5120
  ds_read_b64_tr_b16 a[232:233], v215 offset:8192
  ds_read_b64_tr_b16 a[234:235], v215 offset:9216
  ds_read_b64_tr_b16 a[236:237], v215 offset:12288
  ds_read_b64_tr_b16 a[238:239], v215 offset:13312
  s_waitcnt vmcnt(21) lgkmcnt(0)
  s_barrier
  s_lshl_b32 s54, s53, 13
  s_lshr_b32 s55, s53, 6
  s_or_b32 s55, s55, s52
  s_cmp_eq_u32 s55, 0
  s_cselect_b32 s54, s54, 0x10000000
  v_lshlrev_b32 v211, 3, v201
  buffer_load_dword v196, v211, s[16:19], s54 offen
  v_add_u32 v215, 118784, v209
  ds_read_b64_tr_b16 a[96:97], v215 offset:0
  ds_read_b64_tr_b16 a[98:99], v215 offset:1024
  ds_read_b64_tr_b16 a[100:101], v215 offset:4096
  ds_read_b64_tr_b16 a[102:103], v215 offset:5120
  ds_read_b64_tr_b16 a[104:105], v215 offset:8192
  ds_read_b64_tr_b16 a[106:107], v215 offset:9216
  ds_read_b64_tr_b16 a[108:109], v215 offset:12288
  ds_read_b64_tr_b16 a[110:111], v215 offset:13312
  s_waitcnt vmcnt(18) lgkmcnt(0)
  s_barrier
  v_add_u32 v215, 135168, v210
  ds_read_b64_tr_b16 a[240:241], v215 offset:0
  ds_read_b64_tr_b16 a[242:243], v215 offset:1024
  ds_read_b64_tr_b16 a[244:245], v215 offset:4096
  ds_read_b64_tr_b16 a[246:247], v215 offset:5120
  ds_read_b64_tr_b16 a[248:249], v215 offset:8192
  ds_read_b64_tr_b16 a[250:251], v215 offset:9216
  ds_read_b64_tr_b16 a[252:253], v215 offset:12288
  ds_read_b64_tr_b16 a[254:255], v215 offset:13312
  s_waitcnt vmcnt(14) lgkmcnt(0)
  s_barrier
  v_add_u32 v215, 36864, v209
  ds_read_b64_tr_b16 a[112:113], v215 offset:0
  ds_read_b64_tr_b16 a[114:115], v215 offset:1024
  ds_read_b64_tr_b16 a[116:117], v215 offset:4096
  ds_read_b64_tr_b16 a[118:119], v215 offset:5120
  ds_read_b64_tr_b16 a[120:121], v215 offset:8192
  ds_read_b64_tr_b16 a[122:123], v215 offset:9216
  ds_read_b64_tr_b16 a[124:125], v215 offset:12288
  ds_read_b64_tr_b16 a[126:127], v215 offset:13312
  s_waitcnt vmcnt(10) lgkmcnt(0)
  s_barrier
  v_add_u32 v215, 53248, v210
  ds_read_b64_tr_b16 v[224:225], v215 offset:0
  ds_read_b64_tr_b16 v[226:227], v215 offset:1024
  ds_read_b64_tr_b16 v[228:229], v215 offset:4096
  ds_read_b64_tr_b16 v[230:231], v215 offset:5120
  ds_read_b64_tr_b16 v[232:233], v215 offset:8192
  ds_read_b64_tr_b16 v[234:235], v215 offset:9216
  ds_read_b64_tr_b16 v[236:237], v215 offset:12288
  ds_read_b64_tr_b16 v[238:239], v215 offset:13312
  s_waitcnt vmcnt(6) lgkmcnt(0)
  s_barrier
  v_add_u32 v215, 69632, v209
  ds_read_b64_tr_b16 a[128:129], v215 offset:0
  ds_read_b64_tr_b16 a[130:131], v215 offset:1024
  ds_read_b64_tr_b16 a[132:133], v215 offset:4096
  ds_read_b64_tr_b16 a[134:135], v215 offset:5120
  ds_read_b64_tr_b16 a[136:137], v215 offset:8192
  ds_read_b64_tr_b16 a[138:139], v215 offset:9216
  ds_read_b64_tr_b16 a[140:141], v215 offset:12288
  ds_read_b64_tr_b16 a[142:143], v215 offset:13312
  s_waitcnt vmcnt(2) lgkmcnt(0)
  s_barrier
  v_add_u32 v215, 86016, v210
  ds_read_b64_tr_b16 v[240:241], v215 offset:0
  ds_read_b64_tr_b16 v[242:243], v215 offset:1024
  ds_read_b64_tr_b16 v[244:245], v215 offset:4096
  ds_read_b64_tr_b16 v[246:247], v215 offset:5120
  ds_read_b64_tr_b16 v[248:249], v215 offset:8192
  ds_read_b64_tr_b16 v[250:251], v215 offset:9216
  ds_read_b64_tr_b16 v[252:253], v215 offset:12288
  ds_read_b64_tr_b16 v[254:255], v215 offset:13312
  s_waitcnt lgkmcnt(0)
  s_barrier
  s_lshr_b32 s55, s53, 1
  s_and_b32 s56, s53, 1
  s_lshl_b32 s56, s56, 7
  s_lshl_b32 s55, s55, 2
  s_add_u32 s55, s55, s56
  s_add_u32 s55, s55, 356352
  s_cmp_lt_u32 s53, 64
  s_cselect_b32 s71, s55, 268435456
  v_mov_b32 v211, 0
  s_mov_b64 exec, 1
  buffer_store_dword v211, v211, s[8:11], s71 offen sc1
  s_mov_b64 exec, -1
  s_mov_b32 s68, 1040356334
  s_lshl_b32 s69, s52, 9
  s_lshl_b32 s70, s58, 2
  s_add_u32 s70, s70, 128
  s_mul_i32 s66, s58, -12288
  s_lshl_b32 s54, s52, 10
  s_add_u32 s66, s66, s54
  s_add_u32 s66, s66, 524288
  v_mov_b32 v64, -1
  v_mov_b32 v65, -1
  v_mov_b32 v66, -1
  v_mov_b32 v67, -1
  s_cmp_eq_u32 s59, 0
  s_cbranch_scc0 KV_na
  s_mul_i32 s54, s58, 2176
  s_mul_i32 s55, s52, 69632
  s_add_u32 s55, s55, s54
  s_add_u32 s55, s55, 0
  s_add_u32 s54, s54, 278528
  s_and_b32 s56, s58, 7
  s_lshl_b32 s56, s56, 12
  s_bfe_u32 s57, s58, 0x10003
  s_lshl_b32 s57, s57, 11
  s_add_u32 s56, s56, s57
  s_add_u32 s54, s56, 262144
  s_lshr_b32 s57, s58, 4
  s_lshl_b32 s57, s57, 15
  s_add_u32 s56, s56, s57
  s_lshl_b32 s57, s52, 16
  s_add_u32 s56, s56, s57
  s_add_u32 s55, s56, 0
  s_lshl_b32 s56, s58, 14
  s_mul_i32 s57, s52, 3072
  s_add_u32 s56, s56, s57
  s_add_u32 s56, s56, 360448
  s_cmp_lt_u32 s58, 2
  s_cselect_b32 s56, s56, 268435456
  s_cmp_eq_u32 s52, 0
  s_cselect_b32 s54, s54, 268435456
  buffer_store_dwordx4 v[64:67], v201, s[8:11], s55 offen offset:0 sc1
  buffer_store_dwordx4 v[64:67], v201, s[8:11], s55 offen offset:1024 sc1
  buffer_store_dwordx4 v[64:67], v201, s[8:11], s54 offen offset:0 sc1
  buffer_store_dwordx4 v[64:67], v201, s[8:11], s54 offen offset:1024 sc1
  buffer_store_dwordx4 v[64:67], v201, s[8:11], s56 offen offset:0 sc1
  buffer_store_dwordx4 v[64:67], v201, s[8:11], s56 offen offset:1024 sc1
  buffer_store_dwordx4 v[64:67], v201, s[8:11], s56 offen offset:2048 sc1
KV_na:
  s_add_u32 s60, s60, 258048
  ds_read_b128 v[32:35], v203 offset:0
  ds_read_b128 v[36:39], v204 offset:0
  ds_read_b128 v[40:43], v205 offset:0
  s_waitcnt lgkmcnt(2)
  v_mfma_f32_32x32x16_bf16 v[0:15], a[0:3], v[32:35], 0
  ds_read_b128 v[44:47], v206 offset:0
  s_add_u32 m0, s67, 36864
  s_nop 0
  buffer_load_dwordx4 v202, s[4:7], s60 offen offset:0 lds
  v_mfma_f32_32x32x16_bf16 v[16:31], v[32:35], a[144:147], 0
  s_waitcnt lgkmcnt(2)
  v_mfma_f32_32x32x16_bf16 v[0:15], a[4:7], v[36:39], v[0:15]
  ds_read_b128 v[32:35], v203 offset:1024
  s_add_u32 m0, s67, 37760
  s_nop 0
  buffer_load_dwordx4 v202, s[4:7], s60 offen offset:128 lds
  v_mfma_f32_32x32x16_bf16 v[16:31], v[36:39], a[148:151], v[16:31]
  s_waitcnt lgkmcnt(2)
  v_mfma_f32_32x32x16_bf16 v[0:15], a[8:11], v[40:43], v[0:15]
  ds_read_b128 v[36:39], v204 offset:1024
  s_add_u32 m0, s67, 38656
  s_nop 0
  buffer_load_dwordx4 v202, s[4:7], s60 offen offset:256 lds
  v_mfma_f32_32x32x16_bf16 v[16:31], v[40:43], a[152:155], v[16:31]
  s_waitcnt lgkmcnt(2)
  v_mfma_f32_32x32x16_bf16 v[0:15], a[12:15], v[44:47], v[0:15]
  ds_read_b128 v[40:43], v205 offset:1024
  s_add_u32 m0, s67, 39552
  s_nop 0
  buffer_load_dwordx4 v202, s[4:7], s60 offen offset:384 lds
  v_mfma_f32_32x32x16_bf16 v[16:31], v[44:47], a[156:159], v[16:31]
  s_waitcnt lgkmcnt(2)
  v_mfma_f32_32x32x16_bf16 v[0:15], a[16:19], v[32:35], v[0:15]
  ds_read_b128 v[44:47], v206 offset:1024
  s_add_u32 m0, s67, 40448
  s_nop 0
  buffer_load_dwordx4 v202, s[4:7], s60 offen offset:512 lds
  v_mfma_f32_32x32x16_bf16 v[16:31], v[32:35], a[160:163], v[16:31]
  s_waitcnt lgkmcnt(2)
  v_mfma_f32_32x32x16_bf16 v[0:15], a[20:23], v[36:39], v[0:15]
  ds_read_b128 v[32:35], v203 offset:2048
  s_add_u32 m0, s67, 41344
  s_nop 0
  buffer_load_dwordx4 v202, s[4:7], s60 offen offset:640 lds
  v_mfma_f32_32x32x16_bf16 v[16:31], v[36:39], a[164:167], v[16:31]
  s_waitcnt lgkmcnt(2)
  v_mfma_f32_32x32x16_bf16 v[0:15], a[24:27], v[40:43], v[0:15]
  ds_read_b128 v[36:39], v204 offset:2048
  s_add_u32 m0, s67, 42240
  s_nop 0
  buffer_load_dwordx4 v202, s[4:7], s60 offen offset:768 lds
  v_mfma_f32_32x32x16_bf16 v[16:31], v[40:43], a[168:171], v[16:31]
  s_waitcnt lgkmcnt(2)
  v_mfma_f32_32x32x16_bf16 v[0:15], a[28:31], v[44:47], v[0:15]
  ds_read_b128 v[40:43], v205 offset:2048
  s_add_u32 m0, s67, 43136
  s_nop 0
  buffer_load_dwordx4 v202, s[4:7], s60 offen offset:896 lds
  v_mfma_f32_32x32x16_bf16 v[16:31], v[44:47], a[172:175], v[16:31]
  s_waitcnt lgkmcnt(2)
  v_mfma_f32_32x32x16_bf16 v[0:15], a[32:35], v[32:35], v[0:15]
  ds_read_b128 v[44:47], v206 offset:2048
  s_add_u32 m0, s67, 44032
  s_nop 0
  buffer_load_dwordx4 v202, s[4:7], s60 offen offset:1024 lds
  v_mfma_f32_32x32x16_bf16 v[16:31], v[32:35], a[176:179], v[16:31]
  s_waitcnt lgkmcnt(2)
  v_mfma_f32_32x32x16_bf16 v[0:15], a[36:39], v[36:39], v[0:15]
  ds_read_b128 v[32:35], v203 offset:3072
  v_mfma_f32_32x32x16_bf16 v[16:31], v[36:39], a[180:183], v[16:31]
  s_waitcnt lgkmcnt(2)
  v_mfma_f32_32x32x16_bf16 v[0:15], a[40:43], v[40:43], v[0:15]
  ds_read_b128 v[36:39], v204 offset:3072
  v_mfma_f32_32x32x16_bf16 v[16:31], v[40:43], a[184:187], v[16:31]
  s_waitcnt lgkmcnt(2)
  v_mfma_f32_32x32x16_bf16 v[0:15], a[44:47], v[44:47], v[0:15]
  ds_read_b128 v[40:43], v205 offset:3072
  v_mfma_f32_32x32x16_bf16 v[16:31], v[44:47], a[188:191], v[16:31]
  s_waitcnt lgkmcnt(2)
  v_mfma_f32_32x32x16_bf16 v[0:15], a[48:51], v[32:35], v[0:15]
  ds_read_b128 v[44:47], v206 offset:3072
  v_mfma_f32_32x32x16_bf16 v[16:31], v[32:35], a[192:195], v[16:31]
  s_waitcnt lgkmcnt(2)
  v_mfma_f32_32x32x16_bf16 v[0:15], a[52:55], v[36:39], v[0:15]
  ds_read_b128 v[32:35], v203 offset:4096
  v_mfma_f32_32x32x16_bf16 v[16:31], v[36:39], a[196:199], v[16:31]
  s_waitcnt lgkmcnt(2)
  v_mfma_f32_32x32x16_bf16 v[0:15], a[56:59], v[40:43], v[0:15]
  ds_read_b128 v[36:39], v204 offset:4096
  v_mfma_f32_32x32x16_bf16 v[16:31], v[40:43], a[200:203], v[16:31]
  s_waitcnt lgkmcnt(2)
  v_mfma_f32_32x32x16_bf16 v[0:15], a[60:63], v[44:47], v[0:15]
  ds_read_b128 v[40:43], v205 offset:4096
  v_mfma_f32_32x32x16_bf16 v[16:31], v[44:47], a[204:207], v[16:31]
  s_waitcnt lgkmcnt(2)
  v_mfma_f32_32x32x16_bf16 v[0:15], a[64:67], v[32:35], v[0:15]
  ds_read_b128 v[44:47], v206 offset:4096
  v_mfma_f32_32x32x16_bf16 v[16:31], v[32:35], a[208:211], v[16:31]
  s_waitcnt lgkmcnt(2)
  v_mfma_f32_32x32x16_bf16 v[0:15], a[68:71], v[36:39], v[0:15]
  ds_read_b128 v[32:35], v203 offset:5120
  v_mfma_f32_32x32x16_bf16 v[16:31], v[36:39], a[212:215], v[16:31]
  s_waitcnt lgkmcnt(2)
  v_mfma_f32_32x32x16_bf16 v[0:15], a[72:75], v[40:43], v[0:15]
  ds_read_b128 v[36:39], v204 offset:5120
  v_mfma_f32_32x32x16_bf16 v[16:31], v[40:43], a[216:219], v[16:31]
  s_waitcnt lgkmcnt(2)
  v_mfma_f32_32x32x16_bf16 v[0:15], a[76:79], v[44:47], v[0:15]
  ds_read_b128 v[40:43], v205 offset:5120
  v_mfma_f32_32x32x16_bf16 v[16:31], v[44:47], a[220:223], v[16:31]
  s_waitcnt lgkmcnt(2)
  v_mfma_f32_32x32x16_bf16 v[0:15], a[80:83], v[32:35], v[0:15]
  ds_read_b128 v[44:47], v206 offset:5120
  v_mfma_f32_32x32x16_bf16 v[16:31], v[32:35], a[224:227], v[16:31]
  s_waitcnt lgkmcnt(2)
  v_mfma_f32_32x32x16_bf16 v[0:15], a[84:87], v[36:39], v[0:15]
  ds_read_b128 v[32:35], v203 offset:6144
  v_mfma_f32_32x32x16_bf16 v[16:31], v[36:39], a[228:231], v[16:31]
  s_waitcnt lgkmcnt(2)
  v_mfma_f32_32x32x16_bf16 v[0:15], a[88:91], v[40:43], v[0:15]
  ds_read_b128 v[36:39], v204 offset:6144
  v_mfma_f32_32x32x16_bf16 v[16:31], v[40:43], a[232:235], v[16:31]
  s_waitcnt lgkmcnt(2)
  v_mfma_f32_32x32x16_bf16 v[0:15], a[92:95], v[44:47], v[0:15]
  ds_read_b128 v[40:43], v205 offset:6144
  v_mfma_f32_32x32x16_bf16 v[16:31], v[44:47], a[236:239], v[16:31]
  s_waitcnt lgkmcnt(2)
  v_mfma_f32_32x32x16_bf16 v[0:15], a[96:99], v[32:35], v[0:15]
  ds_read_b128 v[44:47], v206 offset:6144
  v_mfma_f32_32x32x16_bf16 v[16:31], v[32:35], a[240:243], v[16:31]
  s_waitcnt lgkmcnt(2)
  v_mfma_f32_32x32x16_bf16 v[0:15], a[100:103], v[36:39], v[0:15]
  ds_read_b128 v[32:35], v203 offset:7168
  v_mfma_f32_32x32x16_bf16 v[16:31], v[36:39], a[244:247], v[16:31]
  s_waitcnt lgkmcnt(2)
  v_mfma_f32_32x32x16_bf16 v[0:15], a[104:107], v[40:43], v[0:15]
  ds_read_b128 v[36:39], v204 offset:7168
  v_mfma_f32_32x32x16_bf16 v[16:31], v[40:43], a[248:251], v[16:31]
  s_waitcnt lgkmcnt(2)
  v_mfma_f32_32x32x16_bf16 v[0:15], a[108:111], v[44:47], v[0:15]
  ds_read_b128 v[40:43], v205 offset:7168
  v_mfma_f32_32x32x16_bf16 v[16:31], v[44:47], a[252:255], v[16:31]
  s_waitcnt lgkmcnt(2)
  v_mfma_f32_32x32x16_bf16 v[0:15], a[112:115], v[32:35], v[0:15]
  ds_read_b128 v[44:47], v206 offset:7168
  v_mfma_f32_32x32x16_bf16 v[16:31], v[32:35], v[224:227], v[16:31]
  s_waitcnt lgkmcnt(2)
  v_mfma_f32_32x32x16_bf16 v[0:15], a[116:119], v[36:39], v[0:15]
  ds_read_b128 v[32:35], v203 offset:8192
  v_mfma_f32_32x32x16_bf16 v[16:31], v[36:39], v[228:231], v[16:31]
  s_waitcnt lgkmcnt(2)
  v_mfma_f32_32x32x16_bf16 v[0:15], a[120:123], v[40:43], v[0:15]
  ds_read_b128 v[36:39], v204 offset:8192
  v_mfma_f32_32x32x16_bf16 v[16:31], v[40:43], v[232:235], v[16:31]
  s_waitcnt lgkmcnt(2)
  v_mfma_f32_32x32x16_bf16 v[0:15], a[124:127], v[44:47], v[0:15]
  ds_read_b128 v[40:43], v205 offset:8192
  v_mfma_f32_32x32x16_bf16 v[16:31], v[44:47], v[236:239], v[16:31]
  s_waitcnt lgkmcnt(2)
  v_mfma_f32_32x32x16_bf16 v[0:15], a[128:131], v[32:35], v[0:15]
  ds_read_b128 v[44:47], v206 offset:8192
  v_mfma_f32_32x32x16_bf16 v[16:31], v[32:35], v[240:243], v[16:31]
  s_waitcnt lgkmcnt(2)
  v_mfma_f32_32x32x16_bf16 v[0:15], a[132:135], v[36:39], v[0:15]
  v_mfma_f32_32x32x16_bf16 v[16:31], v[36:39], v[244:247], v[16:31]
  s_waitcnt lgkmcnt(1)
  v_mfma_f32_32x32x16_bf16 v[0:15], a[136:139], v[40:43], v[0:15]
  v_mfma_f32_32x32x16_bf16 v[16:31], v[40:43], v[248:251], v[16:31]
  s_waitcnt lgkmcnt(0)
  v_mfma_f32_32x32x16_bf16 v[0:15], a[140:143], v[44:47], v[0:15]
  v_mfma_f32_32x32x16_bf16 v[16:31], v[44:47], v[252:255], v[16:31]
  s_mul_i32 s64, s59, 655360
  s_lshl_b32 s55, s58, 14
  s_add_u32 s64, s64, s55
  s_add_u32 s64, s64, 1048576
  s_add_u32 s72, s64, s69
  s_add_u32 s73, s64, s66
  s_add_u32 s59, s59, 7
  s_waitcnt vmcnt(0)
  s_barrier
KV_loop:
  s_add_u32 s60, s60, 258048
  ds_read_b128 v[32:35], v203 offset:36864
  ds_read_b128 v[36:39], v204 offset:36864
  ds_read_b128 v[40:43], v205 offset:36864
  s_waitcnt lgkmcnt(2)
  v_mfma_f32_32x32x16_bf16 v[68:83], a[0:3], v[32:35], 0
  ds_read_b128 v[44:47], v206 offset:36864
  s_add_u32 m0, s67, 0
  s_nop 0
  buffer_load_dwordx4 v202, s[4:7], s60 offen offset:0 lds
  v_mfma_f32_32x32x16_bf16 v[84:99], v[32:35], a[144:147], 0
  s_waitcnt lgkmcnt(2)
  v_mfma_f32_32x32x16_bf16 v[68:83], a[4:7], v[36:39], v[68:83]
  ds_read_b128 v[32:35], v203 offset:37888
  s_add_u32 m0, s67, 896
  s_nop 0
  buffer_load_dwordx4 v202, s[4:7], s60 offen offset:128 lds
  v_mfma_f32_32x32x16_bf16 v[84:99], v[36:39], a[148:151], v[84:99]
  s_waitcnt lgkmcnt(2)
  v_mfma_f32_32x32x16_bf16 v[68:83], a[8:11], v[40:43], v[68:83]
  ds_read_b128 v[36:39], v204 offset:37888
  s_add_u32 m0, s67, 1792
  s_nop 0
  buffer_load_dwordx4 v202, s[4:7], s60 offen offset:256 lds
  v_mfma_f32_32x32x16_bf16 v[84:99], v[40:43], a[152:155], v[84:99]
  s_waitcnt lgkmcnt(2)
  v_mfma_f32_32x32x16_bf16 v[68:83], a[12:15], v[44:47], v[68:83]
  ds_read_b128 v[40:43], v205 offset:37888
  s_add_u32 m0, s67, 2688
  s_nop 0
  buffer_load_dwordx4 v202, s[4:7], s60 offen offset:384 lds
  v_mfma_f32_32x32x16_bf16 v[84:99], v[44:47], a[156:159], v[84:99]
  s_waitcnt lgkmcnt(2)
  v_mfma_f32_32x32x16_bf16 v[68:83], a[16:19], v[32:35], v[68:83]
  ds_read_b128 v[44:47], v206 offset:37888
  s_add_u32 m0, s67, 3584
  s_nop 0
  buffer_load_dwordx4 v202, s[4:7], s60 offen offset:512 lds
  v_mfma_f32_32x32x16_bf16 v[84:99], v[32:35], a[160:163], v[84:99]
  s_waitcnt lgkmcnt(2)
  v_mfma_f32_32x32x16_bf16 v[68:83], a[20:23], v[36:39], v[68:83]
  ds_read_b128 v[32:35], v203 offset:38912
  s_add_u32 m0, s67, 4480
  s_nop 0
  buffer_load_dwordx4 v202, s[4:7], s60 offen offset:640 lds
  v_mfma_f32_32x32x16_bf16 v[84:99], v[36:39], a[164:167], v[84:99]
  s_waitcnt lgkmcnt(2)
  v_mfma_f32_32x32x16_bf16 v[68:83], a[24:27], v[40:43], v[68:83]
  ds_read_b128 v[36:39], v204 offset:38912
  s_add_u32 m0, s67, 5376
  s_nop 0
  buffer_load_dwordx4 v202, s[4:7], s60 offen offset:768 lds
  v_mfma_f32_32x32x16_bf16 v[84:99], v[40:43], a[168:171], v[84:99]
  s_waitcnt lgkmcnt(2)
  v_mfma_f32_32x32x16_bf16 v[68:83], a[28:31], v[44:47], v[68:83]
  ds_read_b128 v[40:43], v205 offset:38912
  s_add_u32 m0, s67, 6272
  s_nop 0
  buffer_load_dwordx4 v202, s[4:7], s60 offen offset:896 lds
  v_mfma_f32_32x32x16_bf16 v[84:99], v[44:47], a[172:175], v[84:99]
  s_waitcnt lgkmcnt(2)
  v_mfma_f32_32x32x16_bf16 v[68:83], a[32:35], v[32:35], v[68:83]
  ds_read_b128 v[44:47], v206 offset:38912
  s_add_u32 m0, s67, 7168
  s_nop 0
  buffer_load_dwordx4 v202, s[4:7], s60 offen offset:1024 lds
  v_mfma_f32_32x32x16_bf16 v[84:99], v[32:35], a[176:179], v[84:99]
  s_waitcnt lgkmcnt(2)
  v_mfma_f32_32x32x16_bf16 v[68:83], a[36:39], v[36:39], v[68:83]
  ds_read_b128 v[32:35], v203 offset:39936
  v_mul_f32 v0, s68, v0
  v_mul_f32 v1, s68, v1
  v_mul_f32 v2, s68, v2
  v_mul_f32 v3, s68, v3
  v_mfma_f32_32x32x16_bf16 v[84:99], v[36:39], a[180:183], v[84:99]
  v_mul_f32 v4, s68, v4
  v_mul_f32 v5, s68, v5
  v_mul_f32 v6, s68, v6
  v_mul_f32 v7, s68, v7
  s_waitcnt lgkmcnt(2)
  v_mfma_f32_32x32x16_bf16 v[68:83], a[40:43], v[40:43], v[68:83]
  ds_read_b128 v[36:39], v204 offset:39936
  v_cvt_pk_bf16_f32 v48, v0, v4
  v_cvt_pk_bf16_f32 v49, v1, v5
  v_cvt_pk_bf16_f32 v50, v2, v6
  v_cvt_pk_bf16_f32 v51, v3, v7
  v_mfma_f32_32x32x16_bf16 v[84:99], v[40:43], a[184:187], v[84:99]
  buffer_store_dwordx4 v[48:51], v216, s[8:11], s72 offen offset:0 sc1
  s_waitcnt lgkmcnt(2)
  v_mfma_f32_32x32x16_bf16 v[68:83], a[44:47], v[44:47], v[68:83]
  ds_read_b128 v[40:43], v205 offset:39936
  v_mfma_f32_32x32x16_bf16 v[84:99], v[44:47], a[188:191], v[84:99]
  s_waitcnt lgkmcnt(2)
  v_mfma_f32_32x32x16_bf16 v[68:83], a[48:51], v[32:35], v[68:83]
  ds_read_b128 v[44:47], v206 offset:39936
  v_mul_f32 v8, s68, v8
  v_mul_f32 v9, s68, v9
  v_mul_f32 v10, s68, v10
  v_mul_f32 v11, s68, v11
  v_mfma_f32_32x32x16_bf16 v[84:99], v[32:35], a[192:195], v[84:99]
  v_mul_f32 v12, s68, v12
  v_mul_f32 v13, s68, v13
  v_mul_f32 v14, s68, v14
  v_mul_f32 v15, s68, v15
  s_waitcnt lgkmcnt(2)
  v_mfma_f32_32x32x16_bf16 v[68:83], a[52:55], v[36:39], v[68:83]
  ds_read_b128 v[32:35], v203 offset:40960
  v_cvt_pk_bf16_f32 v52, v8, v12
  v_cvt_pk_bf16_f32 v53, v9, v13
  v_cvt_pk_bf16_f32 v54, v10, v14
  v_cvt_pk_bf16_f32 v55, v11, v15
  v_mfma_f32_32x32x16_bf16 v[84:99], v[36:39], a[196:199], v[84:99]
  buffer_store_dwordx4 v[52:55], v216, s[8:11], s72 offen offset:256 sc1
  s_waitcnt lgkmcnt(2)
  v_mfma_f32_32x32x16_bf16 v[68:83], a[56:59], v[40:43], v[68:83]
  ds_read_b128 v[36:39], v204 offset:40960
  v_mfma_f32_32x32x16_bf16 v[84:99], v[40:43], a[200:203], v[84:99]
  s_waitcnt lgkmcnt(2)
  v_mfma_f32_32x32x16_bf16 v[68:83], a[60:63], v[44:47], v[68:83]
  ds_read_b128 v[40:43], v205 offset:40960
  v_cvt_pk_bf16_f32 v56, v16, v17
  v_cvt_pk_bf16_f32 v57, v20, v21
  v_cvt_pk_bf16_f32 v58, v24, v25
  v_cvt_pk_bf16_f32 v59, v28, v29
  v_mfma_f32_32x32x16_bf16 v[84:99], v[44:47], a[204:207], v[84:99]
  buffer_store_dwordx4 v[56:59], v217, s[8:11], s64 offen offset:0 sc1
  s_waitcnt lgkmcnt(2)
  v_mfma_f32_32x32x16_bf16 v[68:83], a[64:67], v[32:35], v[68:83]
  ds_read_b128 v[44:47], v206 offset:40960
  v_mfma_f32_32x32x16_bf16 v[84:99], v[32:35], a[208:211], v[84:99]
  s_waitcnt lgkmcnt(2)
  v_mfma_f32_32x32x16_bf16 v[68:83], a[68:71], v[36:39], v[68:83]
  ds_read_b128 v[32:35], v203 offset:41984
  v_cvt_pk_bf16_f32 v60, v18, v19
  v_cvt_pk_bf16_f32 v61, v22, v23
  v_cvt_pk_bf16_f32 v62, v26, v27
  v_cvt_pk_bf16_f32 v63, v30, v31
  v_mfma_f32_32x32x16_bf16 v[84:99], v[36:39], a[212:215], v[84:99]
  buffer_store_dwordx4 v[60:63], v217, s[8:11], s64 offen offset:256 sc1
  s_waitcnt lgkmcnt(2)
  v_mfma_f32_32x32x16_bf16 v[68:83], a[72:75], v[40:43], v[68:83]
  ds_read_b128 v[36:39], v204 offset:41984
  v_mfma_f32_32x32x16_bf16 v[84:99], v[40:43], a[216:219], v[84:99]
  s_waitcnt lgkmcnt(2)
  v_mfma_f32_32x32x16_bf16 v[68:83], a[76:79], v[44:47], v[68:83]
  ds_read_b128 v[40:43], v205 offset:41984
  buffer_store_dwordx4 v[64:67], v201, s[8:11], s73 offen sc1
  v_mfma_f32_32x32x16_bf16 v[84:99], v[44:47], a[220:223], v[84:99]
  s_waitcnt lgkmcnt(2)
  v_mfma_f32_32x32x16_bf16 v[68:83], a[80:83], v[32:35], v[68:83]
  ds_read_b128 v[44:47], v206 offset:41984
  v_mfma_f32_32x32x16_bf16 v[84:99], v[32:35], a[224:227], v[84:99]
  s_waitcnt lgkmcnt(2)
  v_mfma_f32_32x32x16_bf16 v[68:83], a[84:87], v[36:39], v[68:83]
  ds_read_b128 v[32:35], v203 offset:43008
  v_mfma_f32_32x32x16_bf16 v[84:99], v[36:39], a[228:231], v[84:99]
  s_waitcnt lgkmcnt(2)
  v_mfma_f32_32x32x16_bf16 v[68:83], a[88:91], v[40:43], v[68:83]
  ds_read_b128 v[36:39], v204 offset:43008
  v_mfma_f32_32x32x16_bf16 v[84:99], v[40:43], a[232:235], v[84:99]
  s_waitcnt lgkmcnt(2)
  v_mfma_f32_32x32x16_bf16 v[68:83], a[92:95], v[44:47], v[68:83]
  ds_read_b128 v[40:43], v205 offset:43008
  v_mfma_f32_32x32x16_bf16 v[84:99], v[44:47], a[236:239], v[84:99]
  s_waitcnt lgkmcnt(2)
  v_mfma_f32_32x32x16_bf16 v[68:83], a[96:99], v[32:35], v[68:83]
  ds_read_b128 v[44:47], v206 offset:43008
  v_mfma_f32_32x32x16_bf16 v[84:99], v[32:35], a[240:243], v[84:99]
  s_waitcnt lgkmcnt(2)
  v_mfma_f32_32x32x16_bf16 v[68:83], a[100:103], v[36:39], v[68:83]
  ds_read_b128 v[32:35], v203 offset:44032
  v_mfma_f32_32x32x16_bf16 v[84:99], v[36:39], a[244:247], v[84:99]
  s_waitcnt lgkmcnt(2)
  v_mfma_f32_32x32x16_bf16 v[68:83], a[104:107], v[40:43], v[68:83]
  ds_read_b128 v[36:39], v204 offset:44032
  v_mfma_f32_32x32x16_bf16 v[84:99], v[40:43], a[248:251], v[84:99]
  s_waitcnt lgkmcnt(2)
  v_mfma_f32_32x32x16_bf16 v[68:83], a[108:111], v[44:47], v[68:83]
  ds_read_b128 v[40:43], v205 offset:44032
  v_mfma_f32_32x32x16_bf16 v[84:99], v[44:47], a[252:255], v[84:99]
  s_waitcnt lgkmcnt(2)
  v_mfma_f32_32x32x16_bf16 v[68:83], a[112:115], v[32:35], v[68:83]
  ds_read_b128 v[44:47], v206 offset:44032
  v_mfma_f32_32x32x16_bf16 v[84:99], v[32:35], v[224:227], v[84:99]
  s_waitcnt lgkmcnt(2)
  v_mfma_f32_32x32x16_bf16 v[68:83], a[116:119], v[36:39], v[68:83]
  ds_read_b128 v[32:35], v203 offset:45056
  v_mfma_f32_32x32x16_bf16 v[84:99], v[36:39], v[228:231], v[84:99]
  s_waitcnt lgkmcnt(2)
  v_mfma_f32_32x32x16_bf16 v[68:83], a[120:123], v[40:43], v[68:83]
  ds_read_b128 v[36:39], v204 offset:45056
  v_mfma_f32_32x32x16_bf16 v[84:99], v[40:43], v[232:235], v[84:99]
  s_waitcnt lgkmcnt(2)
  v_mfma_f32_32x32x16_bf16 v[68:83], a[124:127], v[44:47], v[68:83]
  ds_read_b128 v[40:43], v205 offset:45056
  v_mfma_f32_32x32x16_bf16 v[84:99], v[44:47], v[236:239], v[84:99]
  s_waitcnt lgkmcnt(2)
  v_mfma_f32_32x32x16_bf16 v[68:83], a[128:131], v[32:35], v[68:83]
  ds_read_b128 v[44:47], v206 offset:45056
  v_mfma_f32_32x32x16_bf16 v[84:99], v[32:35], v[240:243], v[84:99]
  s_waitcnt lgkmcnt(2)
  v_mfma_f32_32x32x16_bf16 v[68:83], a[132:135], v[36:39], v[68:83]
  v_mfma_f32_32x32x16_bf16 v[84:99], v[36:39], v[244:247], v[84:99]
  s_waitcnt lgkmcnt(1)
  v_mfma_f32_32x32x16_bf16 v[68:83], a[136:139], v[40:43], v[68:83]
  v_mfma_f32_32x32x16_bf16 v[84:99], v[40:43], v[248:251], v[84:99]
  s_waitcnt lgkmcnt(0)
  v_mfma_f32_32x32x16_bf16 v[68:83], a[140:143], v[44:47], v[68:83]
  v_mfma_f32_32x32x16_bf16 v[84:99], v[44:47], v[252:255], v[84:99]
  s_mul_i32 s64, s59, 655360
  s_lshl_b32 s55, s58, 14
  s_add_u32 s64, s64, s55
  s_add_u32 s64, s64, 1048576
  s_add_u32 s72, s64, s69
  s_add_u32 s73, s64, s66
  s_add_u32 s59, s59, 7
  s_cmp_ge_u32 s59, 64
  s_cbranch_scc1 KV_done1
  s_waitcnt vmcnt(5)
  s_barrier
  s_add_u32 s60, s60, 258048
  ds_read_b128 v[32:35], v203 offset:0
  ds_read_b128 v[36:39], v204 offset:0
  ds_read_b128 v[40:43], v205 offset:0
  s_waitcnt lgkmcnt(2)
  v_mfma_f32_32x32x16_bf16 v[0:15], a[0:3], v[32:35], 0
  ds_read_b128 v[44:47], v206 offset:0
  s_add_u32 m0, s67, 36864
  s_nop 0
  buffer_load_dwordx4 v202, s[4:7], s60 offen offset:0 lds
  v_mfma_f32_32x32x16_bf16 v[16:31], v[32:35], a[144:147], 0
  s_waitcnt lgkmcnt(2)
  v_mfma_f32_32x32x16_bf16 v[0:15], a[4:7], v[36:39], v[0:15]
  ds_read_b128 v[32:35], v203 offset:1024
  s_add_u32 m0, s67, 37760
  s_nop 0
  buffer_load_dwordx4 v202, s[4:7], s60 offen offset:128 lds
  v_mfma_f32_32x32x16_bf16 v[16:31], v[36:39], a[148:151], v[16:31]
  s_waitcnt lgkmcnt(2)
  v_mfma_f32_32x32x16_bf16 v[0:15], a[8:11], v[40:43], v[0:15]
  ds_read_b128 v[36:39], v204 offset:1024
  s_add_u32 m0, s67, 38656
  s_nop 0
  buffer_load_dwordx4 v202, s[4:7], s60 offen offset:256 lds
  v_mfma_f32_32x32x16_bf16 v[16:31], v[40:43], a[152:155], v[16:31]
  s_waitcnt lgkmcnt(2)
  v_mfma_f32_32x32x16_bf16 v[0:15], a[12:15], v[44:47], v[0:15]
  ds_read_b128 v[40:43], v205 offset:1024
  s_add_u32 m0, s67, 39552
  s_nop 0
  buffer_load_dwordx4 v202, s[4:7], s60 offen offset:384 lds
  v_mfma_f32_32x32x16_bf16 v[16:31], v[44:47], a[156:159], v[16:31]
  s_waitcnt lgkmcnt(2)
  v_mfma_f32_32x32x16_bf16 v[0:15], a[16:19], v[32:35], v[0:15]
  ds_read_b128 v[44:47], v206 offset:1024
  s_add_u32 m0, s67, 40448
  s_nop 0
  buffer_load_dwordx4 v202, s[4:7], s60 offen offset:512 lds
  v_mfma_f32_32x32x16_bf16 v[16:31], v[32:35], a[160:163], v[16:31]
  s_waitcnt lgkmcnt(2)
  v_mfma_f32_32x32x16_bf16 v[0:15], a[20:23], v[36:39], v[0:15]
  ds_read_b128 v[32:35], v203 offset:2048
  s_add_u32 m0, s67, 41344
  s_nop 0
  buffer_load_dwordx4 v202, s[4:7], s60 offen offset:640 lds
  v_mfma_f32_32x32x16_bf16 v[16:31], v[36:39], a[164:167], v[16:31]
  s_waitcnt lgkmcnt(2)
  v_mfma_f32_32x32x16_bf16 v[0:15], a[24:27], v[40:43], v[0:15]
  ds_read_b128 v[36:39], v204 offset:2048
  s_add_u32 m0, s67, 42240
  s_nop 0
  buffer_load_dwordx4 v202, s[4:7], s60 offen offset:768 lds
  v_mfma_f32_32x32x16_bf16 v[16:31], v[40:43], a[168:171], v[16:31]
  s_waitcnt lgkmcnt(2)
  v_mfma_f32_32x32x16_bf16 v[0:15], a[28:31], v[44:47], v[0:15]
  ds_read_b128 v[40:43], v205 offset:2048
  s_add_u32 m0, s67, 43136
  s_nop 0
  buffer_load_dwordx4 v202, s[4:7], s60 offen offset:896 lds
  v_mfma_f32_32x32x16_bf16 v[16:31], v[44:47], a[172:175], v[16:31]
  s_waitcnt lgkmcnt(2)
  v_mfma_f32_32x32x16_bf16 v[0:15], a[32:35], v[32:35], v[0:15]
  ds_read_b128 v[44:47], v206 offset:2048
  s_add_u32 m0, s67, 44032
  s_nop 0
  buffer_load_dwordx4 v202, s[4:7], s60 offen offset:1024 lds
  v_mfma_f32_32x32x16_bf16 v[16:31], v[32:35], a[176:179], v[16:31]
  s_waitcnt lgkmcnt(2)
  v_mfma_f32_32x32x16_bf16 v[0:15], a[36:39], v[36:39], v[0:15]
  ds_read_b128 v[32:35], v203 offset:3072
  v_mul_f32 v68, s68, v68
  v_mul_f32 v69, s68, v69
  v_mul_f32 v70, s68, v70
  v_mul_f32 v71, s68, v71
  v_mfma_f32_32x32x16_bf16 v[16:31], v[36:39], a[180:183], v[16:31]
  v_mul_f32 v72, s68, v72
  v_mul_f32 v73, s68, v73
  v_mul_f32 v74, s68, v74
  v_mul_f32 v75, s68, v75
  s_waitcnt lgkmcnt(2)
  v_mfma_f32_32x32x16_bf16 v[0:15], a[40:43], v[40:43], v[0:15]
  ds_read_b128 v[36:39], v204 offset:3072
  v_cvt_pk_bf16_f32 v48, v68, v72
  v_cvt_pk_bf16_f32 v49, v69, v73
  v_cvt_pk_bf16_f32 v50, v70, v74
  v_cvt_pk_bf16_f32 v51, v71, v75
  v_mfma_f32_32x32x16_bf16 v[16:31], v[40:43], a[184:187], v[16:31]
  buffer_store_dwordx4 v[48:51], v216, s[8:11], s72 offen offset:0 sc1
  s_waitcnt lgkmcnt(2)
  v_mfma_f32_32x32x16_bf16 v[0:15], a[44:47], v[44:47], v[0:15]
  ds_read_b128 v[40:43], v205 offset:3072
  v_mfma_f32_32x32x16_bf16 v[16:31], v[44:47], a[188:191], v[16:31]
  s_waitcnt lgkmcnt(2)
  v_mfma_f32_32x32x16_bf16 v[0:15], a[48:51], v[32:35], v[0:15]
  ds_read_b128 v[44:47], v206 offset:3072
  v_mul_f32 v76, s68, v76
  v_mul_f32 v77, s68, v77
  v_mul_f32 v78, s68, v78
  v_mul_f32 v79, s68, v79
  v_mfma_f32_32x32x16_bf16 v[16:31], v[32:35], a[192:195], v[16:31]
  v_mul_f32 v80, s68, v80
  v_mul_f32 v81, s68, v81
  v_mul_f32 v82, s68, v82
  v_mul_f32 v83, s68, v83
  s_waitcnt lgkmcnt(2)
  v_mfma_f32_32x32x16_bf16 v[0:15], a[52:55], v[36:39], v[0:15]
  ds_read_b128 v[32:35], v203 offset:4096
  v_cvt_pk_bf16_f32 v52, v76, v80
  v_cvt_pk_bf16_f32 v53, v77, v81
  v_cvt_pk_bf16_f32 v54, v78, v82
  v_cvt_pk_bf16_f32 v55, v79, v83
  v_mfma_f32_32x32x16_bf16 v[16:31], v[36:39], a[196:199], v[16:31]
  buffer_store_dwordx4 v[52:55], v216, s[8:11], s72 offen offset:256 sc1
  s_waitcnt lgkmcnt(2)
  v_mfma_f32_32x32x16_bf16 v[0:15], a[56:59], v[40:43], v[0:15]
  ds_read_b128 v[36:39], v204 offset:4096
  v_mfma_f32_32x32x16_bf16 v[16:31], v[40:43], a[200:203], v[16:31]
  s_waitcnt lgkmcnt(2)
  v_mfma_f32_32x32x16_bf16 v[0:15], a[60:63], v[44:47], v[0:15]
  ds_read_b128 v[40:43], v205 offset:4096
  v_cvt_pk_bf16_f32 v56, v84, v85
  v_cvt_pk_bf16_f32 v57, v88, v89
  v_cvt_pk_bf16_f32 v58, v92, v93
  v_cvt_pk_bf16_f32 v59, v96, v97
  v_mfma_f32_32x32x16_bf16 v[16:31], v[44:47], a[204:207], v[16:31]
  buffer_store_dwordx4 v[56:59], v217, s[8:11], s64 offen offset:0 sc1
  s_waitcnt lgkmcnt(2)
  v_mfma_f32_32x32x16_bf16 v[0:15], a[64:67], v[32:35], v[0:15]
  ds_read_b128 v[44:47], v206 offset:4096
  v_mfma_f32_32x32x16_bf16 v[16:31], v[32:35], a[208:211], v[16:31]
  s_waitcnt lgkmcnt(2)
  v_mfma_f32_32x32x16_bf16 v[0:15], a[68:71], v[36:39], v[0:15]
  ds_read_b128 v[32:35], v203 offset:5120
  v_cvt_pk_bf16_f32 v60, v86, v87
  v_cvt_pk_bf16_f32 v61, v90, v91
  v_cvt_pk_bf16_f32 v62, v94, v95
  v_cvt_pk_bf16_f32 v63, v98, v99
  v_mfma_f32_32x32x16_bf16 v[16:31], v[36:39], a[212:215], v[16:31]
  buffer_store_dwordx4 v[60:63], v217, s[8:11], s64 offen offset:256 sc1
  s_waitcnt lgkmcnt(2)
  v_mfma_f32_32x32x16_bf16 v[0:15], a[72:75], v[40:43], v[0:15]
  ds_read_b128 v[36:39], v204 offset:5120
  v_mfma_f32_32x32x16_bf16 v[16:31], v[40:43], a[216:219], v[16:31]
  s_waitcnt lgkmcnt(2)
  v_mfma_f32_32x32x16_bf16 v[0:15], a[76:79], v[44:47], v[0:15]
  ds_read_b128 v[40:43], v205 offset:5120
  buffer_store_dwordx4 v[64:67], v201, s[8:11], s73 offen sc1
  v_mfma_f32_32x32x16_bf16 v[16:31], v[44:47], a[220:223], v[16:31]
  s_waitcnt lgkmcnt(2)
  v_mfma_f32_32x32x16_bf16 v[0:15], a[80:83], v[32:35], v[0:15]
  ds_read_b128 v[44:47], v206 offset:5120
  v_mfma_f32_32x32x16_bf16 v[16:31], v[32:35], a[224:227], v[16:31]
  s_waitcnt lgkmcnt(2)
  v_mfma_f32_32x32x16_bf16 v[0:15], a[84:87], v[36:39], v[0:15]
  ds_read_b128 v[32:35], v203 offset:6144
  v_mfma_f32_32x32x16_bf16 v[16:31], v[36:39], a[228:231], v[16:31]
  s_waitcnt lgkmcnt(2)
  v_mfma_f32_32x32x16_bf16 v[0:15], a[88:91], v[40:43], v[0:15]
  ds_read_b128 v[36:39], v204 offset:6144
  v_mfma_f32_32x32x16_bf16 v[16:31], v[40:43], a[232:235], v[16:31]
  s_waitcnt lgkmcnt(2)
  v_mfma_f32_32x32x16_bf16 v[0:15], a[92:95], v[44:47], v[0:15]
  ds_read_b128 v[40:43], v205 offset:6144
  v_mfma_f32_32x32x16_bf16 v[16:31], v[44:47], a[236:239], v[16:31]
  s_waitcnt lgkmcnt(2)
  v_mfma_f32_32x32x16_bf16 v[0:15], a[96:99], v[32:35], v[0:15]
  ds_read_b128 v[44:47], v206 offset:6144
  v_mfma_f32_32x32x16_bf16 v[16:31], v[32:35], a[240:243], v[16:31]
  s_waitcnt lgkmcnt(2)
  v_mfma_f32_32x32x16_bf16 v[0:15], a[100:103], v[36:39], v[0:15]
  ds_read_b128 v[32:35], v203 offset:7168
  v_mfma_f32_32x32x16_bf16 v[16:31], v[36:39], a[244:247], v[16:31]
  s_waitcnt lgkmcnt(2)
  v_mfma_f32_32x32x16_bf16 v[0:15], a[104:107], v[40:43], v[0:15]
  ds_read_b128 v[36:39], v204 offset:7168
  v_mfma_f32_32x32x16_bf16 v[16:31], v[40:43], a[248:251], v[16:31]
  s_waitcnt lgkmcnt(2)
  v_mfma_f32_32x32x16_bf16 v[0:15], a[108:111], v[44:47], v[0:15]
  ds_read_b128 v[40:43], v205 offset:7168
  v_mfma_f32_32x32x16_bf16 v[16:31], v[44:47], a[252:255], v[16:31]
  s_waitcnt lgkmcnt(2)
  v_mfma_f32_32x32x16_bf16 v[0:15], a[112:115], v[32:35], v[0:15]
  ds_read_b128 v[44:47], v206 offset:7168
  v_mfma_f32_32x32x16_bf16 v[16:31], v[32:35], v[224:227], v[16:31]
  s_waitcnt lgkmcnt(2)
  v_mfma_f32_32x32x16_bf16 v[0:15], a[116:119], v[36:39], v[0:15]
  ds_read_b128 v[32:35], v203 offset:8192
  v_mfma_f32_32x32x16_bf16 v[16:31], v[36:39], v[228:231], v[16:31]
  s_waitcnt lgkmcnt(2)
  v_mfma_f32_32x32x16_bf16 v[0:15], a[120:123], v[40:43], v[0:15]
  ds_read_b128 v[36:39], v204 offset:8192
  v_mfma_f32_32x32x16_bf16 v[16:31], v[40:43], v[232:235], v[16:31]
  s_waitcnt lgkmcnt(2)
  v_mfma_f32_32x32x16_bf16 v[0:15], a[124:127], v[44:47], v[0:15]
  ds_read_b128 v[40:43], v205 offset:8192
  v_mfma_f32_32x32x16_bf16 v[16:31], v[44:47], v[236:239], v[16:31]
  s_waitcnt lgkmcnt(2)
  v_mfma_f32_32x32x16_bf16 v[0:15], a[128:131], v[32:35], v[0:15]
  ds_read_b128 v[44:47], v206 offset:8192
  v_mfma_f32_32x32x16_bf16 v[16:31], v[32:35], v[240:243], v[16:31]
  s_waitcnt lgkmcnt(2)
  v_mfma_f32_32x32x16_bf16 v[0:15], a[132:135], v[36:39], v[0:15]
  v_mfma_f32_32x32x16_bf16 v[16:31], v[36:39], v[244:247], v[16:31]
  s_waitcnt lgkmcnt(1)
  v_mfma_f32_32x32x16_bf16 v[0:15], a[136:139], v[40:43], v[0:15]
  v_mfma_f32_32x32x16_bf16 v[16:31], v[40:43], v[248:251], v[16:31]
  s_waitcnt lgkmcnt(0)
  v_mfma_f32_32x32x16_bf16 v[0:15], a[140:143], v[44:47], v[0:15]
  v_mfma_f32_32x32x16_bf16 v[16:31], v[44:47], v[252:255], v[16:31]
  s_mul_i32 s64, s59, 655360
  s_lshl_b32 s55, s58, 14
  s_add_u32 s64, s64, s55
  s_add_u32 s64, s64, 1048576
  s_add_u32 s72, s64, s69
  s_add_u32 s73, s64, s66
  s_add_u32 s59, s59, 7
  s_cmp_ge_u32 s59, 64
  s_cbranch_scc1 KV_done0
  s_sub_u32 s54, s59, 21
  s_cmp_lt_u32 s54, 7
  s_cbranch_scc1 KV_early
  s_waitcnt vmcnt(5)
  s_barrier
KV_cont:
  s_branch KV_loop
KV_early:
  s_waitcnt vmcnt(0)
  s_barrier
  s_cmp_eq_u32 s52, 0
  s_cbranch_scc0 KV_sig0
  v_mov_b32 v211, 1
  v_mov_b32 v212, 0
  s_mov_b64 exec, 1
  buffer_atomic_add v211, v212, s[12:15], s70 offen
  s_mov_b64 exec, -1
KV_sig0:
  s_branch KV_cont
KV_done1:
  s_nop 11
  v_mul_f32 v68, s68, v68
  v_mul_f32 v69, s68, v69
  v_mul_f32 v70, s68, v70
  v_mul_f32 v71, s68, v71
  v_mul_f32 v72, s68, v72
  v_mul_f32 v73, s68, v73
  v_mul_f32 v74, s68, v74
  v_mul_f32 v75, s68, v75
  v_cvt_pk_bf16_f32 v48, v68, v72
  v_cvt_pk_bf16_f32 v49, v69, v73
  v_cvt_pk_bf16_f32 v50, v70, v74
  v_cvt_pk_bf16_f32 v51, v71, v75
  buffer_store_dwordx4 v[48:51], v216, s[8:11], s72 offen offset:0 sc1
  v_mul_f32 v76, s68, v76
  v_mul_f32 v77, s68, v77
  v_mul_f32 v78, s68, v78
  v_mul_f32 v79, s68, v79
  v_mul_f32 v80, s68, v80
  v_mul_f32 v81, s68, v81
  v_mul_f32 v82, s68, v82
  v_mul_f32 v83, s68, v83
  v_cvt_pk_bf16_f32 v52, v76, v80
  v_cvt_pk_bf16_f32 v53, v77, v81
  v_cvt_pk_bf16_f32 v54, v78, v82
  v_cvt_pk_bf16_f32 v55, v79, v83
  buffer_store_dwordx4 v[52:55], v216, s[8:11], s72 offen offset:256 sc1
  v_cvt_pk_bf16_f32 v56, v84, v85
  v_cvt_pk_bf16_f32 v57, v88, v89
  v_cvt_pk_bf16_f32 v58, v92, v93
  v_cvt_pk_bf16_f32 v59, v96, v97
  buffer_store_dwordx4 v[56:59], v217, s[8:11], s64 offen offset:0 sc1
  v_cvt_pk_bf16_f32 v60, v86, v87
  v_cvt_pk_bf16_f32 v61, v90, v91
  v_cvt_pk_bf16_f32 v62, v94, v95
  v_cvt_pk_bf16_f32 v63, v98, v99
  buffer_store_dwordx4 v[60:63], v217, s[8:11], s64 offen offset:256 sc1
  buffer_store_dwordx4 v[64:67], v201, s[8:11], s73 offen sc1
  s_branch KV_fin
KV_done0:
  s_nop 11
  v_mul_f32 v0, s68, v0
  v_mul_f32 v1, s68, v1
  v_mul_f32 v2, s68, v2
  v_mul_f32 v3, s68, v3
  v_mul_f32 v4, s68, v4
  v_mul_f32 v5, s68, v5
  v_mul_f32 v6, s68, v6
  v_mul_f32 v7, s68, v7
  v_cvt_pk_bf16_f32 v48, v0, v4
  v_cvt_pk_bf16_f32 v49, v1, v5
  v_cvt_pk_bf16_f32 v50, v2, v6
  v_cvt_pk_bf16_f32 v51, v3, v7
  buffer_store_dwordx4 v[48:51], v216, s[8:11], s72 offen offset:0 sc1
  v_mul_f32 v8, s68, v8
  v_mul_f32 v9, s68, v9
  v_mul_f32 v10, s68, v10
  v_mul_f32 v11, s68, v11
  v_mul_f32 v12, s68, v12
  v_mul_f32 v13, s68, v13
  v_mul_f32 v14, s68, v14
  v_mul_f32 v15, s68, v15
  v_cvt_pk_bf16_f32 v52, v8, v12
  v_cvt_pk_bf16_f32 v53, v9, v13
  v_cvt_pk_bf16_f32 v54, v10, v14
  v_cvt_pk_bf16_f32 v55, v11, v15
  buffer_store_dwordx4 v[52:55], v216, s[8:11], s72 offen offset:256 sc1
  v_cvt_pk_bf16_f32 v56, v16, v17
  v_cvt_pk_bf16_f32 v57, v20, v21
  v_cvt_pk_bf16_f32 v58, v24, v25
  v_cvt_pk_bf16_f32 v59, v28, v29
  buffer_store_dwordx4 v[56:59], v217, s[8:11], s64 offen offset:0 sc1
  v_cvt_pk_bf16_f32 v60, v18, v19
  v_cvt_pk_bf16_f32 v61, v22, v23
  v_cvt_pk_bf16_f32 v62, v26, v27
  v_cvt_pk_bf16_f32 v63, v30, v31
  buffer_store_dwordx4 v[60:63], v217, s[8:11], s64 offen offset:256 sc1
  buffer_store_dwordx4 v[64:67], v201, s[8:11], s73 offen sc1
KV_fin:
  s_waitcnt vmcnt(0)
  s_barrier
  s_cmp_eq_u32 s52, 0
  s_cbranch_scc0 KV_sig
  v_mov_b32 v211, 256
  v_mov_b32 v212, 0
  s_mov_b64 exec, 1
  buffer_atomic_add v211, v212, s[12:15], s70 offen
  s_mov_b64 exec, -1
KV_sig:
  s_cmp_ge_u32 s53, 192
  s_cbranch_scc1 L_exit
  s_cmp_lt_u32 s53, 64
  s_cbranch_scc1 W_h
  s_sub_u32 s54, s53, 64
  s_lshr_b32 s68, s54, 4
  s_and_b32 s69, s54, 15
  s_lshl_b32 s60, s69, 2
  s_sub_u32 s60, s60, 1
  s_max_i32 s60, s60, 0
  s_mul_i32 s60, s60, 36864
  s_add_u32 m0, s67, 0
  s_nop 0
  buffer_load_dwordx4 v202, s[4:7], s60 offen offset:0 lds
  s_add_u32 m0, s67, 896
  s_nop 0
  buffer_load_dwordx4 v202, s[4:7], s60 offen offset:128 lds
  s_add_u32 m0, s67, 1792
  s_nop 0
  buffer_load_dwordx4 v202, s[4:7], s60 offen offset:256 lds
  s_add_u32 m0, s67, 2688
  s_nop 0
  buffer_load_dwordx4 v202, s[4:7], s60 offen offset:384 lds
  s_add_u32 m0, s67, 3584
  s_nop 0
  buffer_load_dwordx4 v202, s[4:7], s60 offen offset:512 lds
  s_add_u32 m0, s67, 4480
  s_nop 0
  buffer_load_dwordx4 v202, s[4:7], s60 offen offset:640 lds
  s_add_u32 m0, s67, 5376
  s_nop 0
  buffer_load_dwordx4 v202, s[4:7], s60 offen offset:768 lds
  s_add_u32 m0, s67, 6272
  s_nop 0
  buffer_load_dwordx4 v202, s[4:7], s60 offen offset:896 lds
  s_add_u32 m0, s67, 7168
  s_nop 0
  buffer_load_dwordx4 v202, s[4:7], s60 offen offset:1024 lds
  v_and_b32 v211, 15, v200
  v_mul_u32_u24 v211, 72, v211
  v_lshrrev_b32 v212, 4, v200
  v_mul_u32_u24 v213, 1152, v212
  v_add_u32 v213, v213, v211
  s_lshl_b32 s54, s54, 2
  s_add_u32 s70, s54, s52
  s_mul_i32 s55, s70, 4608
  buffer_load_dwordx4 v[48:51], v213, s[4:7], s55 offen offset:0
  buffer_load_dwordx4 v[52:55], v213, s[4:7], s55 offen offset:16
  buffer_load_dwordx4 v[56:59], v213, s[4:7], s55 offen offset:32
  buffer_load_dwordx4 v[60:63], v213, s[4:7], s55 offen offset:48
  buffer_load_dwordx2 v[64:65], v213, s[4:7], s55 offen offset:64
  buffer_load_dwordx4 v[68:71], v211, s[44:47], 0 offen offset:0
  buffer_load_dwordx4 v[72:75], v211, s[44:47], 0 offen offset:16
  buffer_load_dwordx4 v[76:79], v211, s[44:47], 0 offen offset:32
  buffer_load_dwordx4 v[80:83], v211, s[44:47], 0 offen offset:48
  buffer_load_dwordx2 v[84:85], v211, s[44:47], 0 offen offset:64
  v_mov_b32 v0, 0
  v_mov_b32 v1, 0x3f803f80
  s_waitcnt vmcnt(9)
  v_lshlrev_b32 v2, 16, v48
  s_waitcnt vmcnt(4)
  v_lshlrev_b32 v3, 16, v68
  v_and_b32 v4, 0xffff0000, v48
  v_and_b32 v5, 0xffff0000, v68
  v_mul_f32 v2, v2, v3
  v_mul_f32 v4, v4, v5
  v_cvt_pk_bf16_f32 v2, v2, v4
  v_lshlrev_b32 v3, 16, v2
  v_and_b32 v4, 0xffff0000, v2
  v_add_f32 v0, v0, v3
  v_add_f32 v0, v0, v4
  v_lshlrev_b32 v2, 16, v49
  v_lshlrev_b32 v3, 16, v69
  v_and_b32 v4, 0xffff0000, v49
  v_and_b32 v5, 0xffff0000, v69
  v_mul_f32 v2, v2, v3
  v_mul_f32 v4, v4, v5
  v_cvt_pk_bf16_f32 v2, v2, v4
  v_lshlrev_b32 v3, 16, v2
  v_and_b32 v4, 0xffff0000, v2
  v_add_f32 v0, v0, v3
  v_add_f32 v0, v0, v4
  v_lshlrev_b32 v2, 16, v50
  v_lshlrev_b32 v3, 16, v70
  v_and_b32 v4, 0xffff0000, v50
  v_and_b32 v5, 0xffff0000, v70
  v_mul_f32 v2, v2, v3
  v_mul_f32 v4, v4, v5
  v_cvt_pk_bf16_f32 v2, v2, v4
  v_lshlrev_b32 v3, 16, v2
  v_and_b32 v4, 0xffff0000, v2
  v_add_f32 v0, v0, v3
  v_add_f32 v0, v0, v4
  v_lshlrev_b32 v2, 16, v51
  v_lshlrev_b32 v3, 16, v71
  v_and_b32 v4, 0xffff0000, v51
  v_and_b32 v5, 0xffff0000, v71
  v_mul_f32 v2, v2, v3
  v_mul_f32 v4, v4, v5
  v_cvt_pk_bf16_f32 v2, v2, v4
  v_lshlrev_b32 v3, 16, v2
  v_and_b32 v4, 0xffff0000, v2
  v_add_f32 v0, v0, v3
  v_add_f32 v0, v0, v4
  v_lshlrev_b32 v2, 16, v52
  s_waitcnt vmcnt(3)
  v_lshlrev_b32 v3, 16, v72
  v_and_b32 v4, 0xffff0000, v52
  v_and_b32 v5, 0xffff0000, v72
  v_mul_f32 v2, v2, v3
  v_mul_f32 v4, v4, v5
  v_cvt_pk_bf16_f32 v2, v2, v4
  v_lshlrev_b32 v3, 16, v2
  v_and_b32 v4, 0xffff0000, v2
  v_add_f32 v0, v0, v3
  v_add_f32 v0, v0, v4
  v_lshlrev_b32 v2, 16, v53
  v_lshlrev_b32 v3, 16, v73
  v_and_b32 v4, 0xffff0000, v53
  v_and_b32 v5, 0xffff0000, v73
  v_mul_f32 v2, v2, v3
  v_mul_f32 v4, v4, v5
  v_cvt_pk_bf16_f32 v2, v2, v4
  v_lshlrev_b32 v3, 16, v2
  v_and_b32 v4, 0xffff0000, v2
  v_add_f32 v0, v0, v3
  v_add_f32 v0, v0, v4
  v_lshlrev_b32 v2, 16, v54
  v_lshlrev_b32 v3, 16, v74
  v_and_b32 v4, 0xffff0000, v54
  v_and_b32 v5, 0xffff0000, v74
  v_mul_f32 v2, v2, v3
  v_mul_f32 v4, v4, v5
  v_cvt_pk_bf16_f32 v2, v2, v4
  v_lshlrev_b32 v3, 16, v2
  v_and_b32 v4, 0xffff0000, v2
  v_add_f32 v0, v0, v3
  v_add_f32 v0, v0, v4
  v_lshlrev_b32 v2, 16, v55
  v_lshlrev_b32 v3, 16, v75
  v_and_b32 v4, 0xffff0000, v55
  v_and_b32 v5, 0xffff0000, v75
  v_mul_f32 v2, v2, v3
  v_mul_f32 v4, v4, v5
  v_cvt_pk_bf16_f32 v2, v2, v4
  v_lshlrev_b32 v3, 16, v2
  v_and_b32 v4, 0xffff0000, v2
  v_add_f32 v0, v0, v3
  v_add_f32 v0, v0, v4
  v_lshlrev_b32 v2, 16, v56
  s_waitcnt vmcnt(2)
  v_lshlrev_b32 v3, 16, v76
  v_and_b32 v4, 0xffff0000, v56
  v_and_b32 v5, 0xffff0000, v76
  v_mul_f32 v2, v2, v3
  v_mul_f32 v4, v4, v5
  v_cvt_pk_bf16_f32 v2, v2, v4
  v_lshlrev_b32 v3, 16, v2
  v_and_b32 v4, 0xffff0000, v2
  v_add_f32 v0, v0, v3
  v_add_f32 v0, v0, v4
  v_lshlrev_b32 v2, 16, v57
  v_lshlrev_b32 v3, 16, v77
  v_and_b32 v4, 0xffff0000, v57
  v_and_b32 v5, 0xffff0000, v77
  v_mul_f32 v2, v2, v3
  v_mul_f32 v4, v4, v5
  v_cvt_pk_bf16_f32 v2, v2, v4
  v_lshlrev_b32 v3, 16, v2
  v_and_b32 v4, 0xffff0000, v2
  v_add_f32 v0, v0, v3
  v_add_f32 v0, v0, v4
  v_lshlrev_b32 v2, 16, v58
  v_lshlrev_b32 v3, 16, v78
  v_and_b32 v4, 0xffff0000, v58
  v_and_b32 v5, 0xffff0000, v78
  v_mul_f32 v2, v2, v3
  v_mul_f32 v4, v4, v5
  v_cvt_pk_bf16_f32 v2, v2, v4
  v_lshlrev_b32 v3, 16, v2
  v_and_b32 v4, 0xffff0000, v2
  v_add_f32 v0, v0, v3
  v_add_f32 v0, v0, v4
  v_lshlrev_b32 v2, 16, v59
  v_lshlrev_b32 v3, 16, v79
  v_and_b32 v4, 0xffff0000, v59
  v_and_b32 v5, 0xffff0000, v79
  v_mul_f32 v2, v2, v3
  v_mul_f32 v4, v4, v5
  v_cvt_pk_bf16_f32 v2, v2, v4
  v_lshlrev_b32 v3, 16, v2
  v_and_b32 v4, 0xffff0000, v2
  v_add_f32 v0, v0, v3
  v_add_f32 v0, v0, v4
  v_lshlrev_b32 v2, 16, v60
  s_waitcnt vmcnt(1)
  v_lshlrev_b32 v3, 16, v80
  v_and_b32 v4, 0xffff0000, v60
  v_and_b32 v5, 0xffff0000, v80
  v_mul_f32 v2, v2, v3
  v_mul_f32 v4, v4, v5
  v_cvt_pk_bf16_f32 v2, v2, v4
  v_lshlrev_b32 v3, 16, v2
  v_and_b32 v4, 0xffff0000, v2
  v_add_f32 v0, v0, v3
  v_add_f32 v0, v0, v4
  v_lshlrev_b32 v2, 16, v61
  v_lshlrev_b32 v3, 16, v81
  v_and_b32 v4, 0xffff0000, v61
  v_and_b32 v5, 0xffff0000, v81
  v_mul_f32 v2, v2, v3
  v_mul_f32 v4, v4, v5
  v_cvt_pk_bf16_f32 v2, v2, v4
  v_lshlrev_b32 v3, 16, v2
  v_and_b32 v4, 0xffff0000, v2
  v_add_f32 v0, v0, v3
  v_add_f32 v0, v0, v4
  v_lshlrev_b32 v2, 16, v62
  v_lshlrev_b32 v3, 16, v82
  v_and_b32 v4, 0xffff0000, v62
  v_and_b32 v5, 0xffff0000, v82
  v_mul_f32 v2, v2, v3
  v_mul_f32 v4, v4, v5
  v_cvt_pk_bf16_f32 v2, v2, v4
  v_lshlrev_b32 v3, 16, v2
  v_and_b32 v4, 0xffff0000, v2
  v_add_f32 v0, v0, v3
  v_add_f32 v0, v0, v4
  v_lshlrev_b32 v2, 16, v63
  v_lshlrev_b32 v3, 16, v83
  v_and_b32 v4, 0xffff0000, v63
  v_and_b32 v5, 0xffff0000, v83
  v_mul_f32 v2, v2, v3
  v_mul_f32 v4, v4, v5
  v_cvt_pk_bf16_f32 v2, v2, v4
  v_lshlrev_b32 v3, 16, v2
  v_and_b32 v4, 0xffff0000, v2
  v_add_f32 v0, v0, v3
  v_add_f32 v0, v0, v4
  v_lshlrev_b32 v2, 16, v64
  s_waitcnt vmcnt(0)
  v_lshlrev_b32 v3, 16, v84
  v_and_b32 v4, 0xffff0000, v64
  v_and_b32 v5, 0xffff0000, v84
  v_mul_f32 v2, v2, v3
  v_mul_f32 v4, v4, v5
  v_cvt_pk_bf16_f32 v2, v2, v4
  v_lshlrev_b32 v3, 16, v2
  v_and_b32 v4, 0xffff0000, v2
  v_add_f32 v0, v0, v3
  v_add_f32 v0, v0, v4
  v_lshlrev_b32 v2, 16, v65
  v_lshlrev_b32 v3, 16, v85
  v_and_b32 v4, 0xffff0000, v65
  v_and_b32 v5, 0xffff0000, v85
  v_mul_f32 v2, v2, v3
  v_mul_f32 v4, v4, v5
  v_cvt_pk_bf16_f32 v2, v2, v4
  v_lshlrev_b32 v3, 16, v2
  v_and_b32 v4, 0xffff0000, v2
  v_add_f32 v0, v0, v3
  v_add_f32 v0, v0, v4
  s_nop 1
  v_add_f32_dpp v0, v0, v0 row_ror:1 row_mask:0xf bank_mask:0xf
  s_nop 1
  v_add_f32_dpp v0, v0, v0 row_ror:2 row_mask:0xf bank_mask:0xf
  s_nop 1
  v_add_f32_dpp v0, v0, v0 row_ror:4 row_mask:0xf bank_mask:0xf
  s_nop 1
  v_add_f32_dpp v0, v0, v0 row_ror:8 row_mask:0xf bank_mask:0xf
  v_cvt_pk_bf16_f32 v0, v0, v0
  v_lshlrev_b32 v0, 16, v0
  v_mul_f32 v0, 3216550459, v0
  v_exp_f32 v0, v0
  s_nop 0
  v_add_f32 v0, 1.0, v0
  v_rcp_f32 v0, v0
  s_nop 0
  v_cvt_pk_bf16_f32 v0, v0, v0
  v_lshlrev_b32 v0, 16, v0
  v_lshlrev_b32 v212, 2, v212
  s_lshl_b32 s55, s70, 4
  s_add_u32 s55, s55, 66060288
  s_mov_b32 exec_lo, 0x00010001
  s_mov_b32 exec_hi, 0x00010001
  buffer_store_dword v0, v212, s[8:11], s55 offen sc1
  s_mov_b64 exec, -1
  v_lshrrev_b32 v211, 4, v200
  v_lshlrev_b32 v212, 2, v211
  v_and_b32 v213, 15, v200
  v_xor_b32 v212, v212, v213
  v_mul_u32_u24 v211, 3456, v211
  v_mov_b32 v2, 0x40000000
  v_add_u32 v213, 0, v212
  v_mul_u32_u24 v214, 57, v213
  v_lshrrev_b32 v214, 9, v214
  v_mul_u32_u24 v214, 1008, v214
  v_lshl_add_u32 v214, v213, 4, v214
  v_add_u32 v214, v214, v211
  v_cmp_lt_u32 vcc, 26, v213
  s_nop 1
  v_cndmask_b32 v207, v214, v2, vcc
  v_add_u32 v213, 16, v212
  v_mul_u32_u24 v214, 57, v213
  v_lshrrev_b32 v214, 9, v214
  v_mul_u32_u24 v214, 1008, v214
  v_lshl_add_u32 v214, v213, 4, v214
  v_add_u32 v214, v214, v211
  v_cmp_lt_u32 vcc, 26, v213
  s_nop 1
  v_cndmask_b32 v208, v214, v2, vcc
  s_mul_i32 s62, s68, 144
  s_mul_i32 s54, s52, 13824
  s_add_u32 s62, s62, s54
  s_waitcnt vmcnt(0)
  s_lshl_b32 s61, s52, 10
  s_add_u32 s61, s61, 36864
  s_add_u32 m0, s61, 0
  s_add_u32 s54, s62, 0
  buffer_load_dwordx4 v207, s[36:39], s54 offen lds
  s_add_u32 m0, s61, 4096
  s_add_u32 s54, s62, 55296
  buffer_load_dwordx4 v207, s[36:39], s54 offen lds
  s_add_u32 m0, s61, 8192
  s_add_u32 s54, s62, 110592
  buffer_load_dwordx4 v207, s[36:39], s54 offen lds
  s_add_u32 m0, s61, 12288
  s_add_u32 s54, s62, 165888
  buffer_load_dwordx4 v207, s[36:39], s54 offen lds
  s_add_u32 m0, s61, 16384
  s_add_u32 s54, s62, 0
  buffer_load_dwordx4 v208, s[36:39], s54 offen lds
  s_add_u32 m0, s61, 20480
  s_add_u32 s54, s62, 55296
  buffer_load_dwordx4 v208, s[36:39], s54 offen lds
  s_add_u32 m0, s61, 24576
  s_add_u32 s54, s62, 110592
  buffer_load_dwordx4 v208, s[36:39], s54 offen lds
  s_add_u32 m0, s61, 28672
  s_add_u32 s54, s62, 165888
  buffer_load_dwordx4 v208, s[36:39], s54 offen lds
  s_add_u32 m0, s61, 32768
  s_add_u32 s54, s62, 221184
  buffer_load_dwordx4 v207, s[36:39], s54 offen lds
  s_add_u32 m0, s61, 36864
  s_add_u32 s54, s62, 276480
  buffer_load_dwordx4 v207, s[36:39], s54 offen lds
  s_add_u32 m0, s61, 40960
  s_add_u32 s54, s62, 331776
  buffer_load_dwordx4 v207, s[36:39], s54 offen lds
  s_add_u32 m0, s61, 45056
  s_add_u32 s54, s62, 387072
  buffer_load_dwordx4 v207, s[36:39], s54 offen lds
  s_add_u32 m0, s61, 49152
  s_add_u32 s54, s62, 221184
  buffer_load_dwordx4 v208, s[36:39], s54 offen lds
  s_add_u32 m0, s61, 53248
  s_add_u32 s54, s62, 276480
  buffer_load_dwordx4 v208, s[36:39], s54 offen lds
  s_add_u32 m0, s61, 57344
  s_add_u32 s54, s62, 331776
  buffer_load_dwordx4 v208, s[36:39], s54 offen lds
  s_add_u32 m0, s61, 61440
  s_add_u32 s54, s62, 387072
  buffer_load_dwordx4 v208, s[36:39], s54 offen lds
  s_add_u32 m0, s61, 65536
  s_add_u32 s54, s62, 442368
  buffer_load_dwordx4 v207, s[36:39], s54 offen lds
  s_add_u32 m0, s61, 69632
  s_add_u32 s54, s62, 497664
  buffer_load_dwordx4 v207, s[36:39], s54 offen lds
  s_add_u32 m0, s61, 73728
  s_add_u32 s54, s62, 552960
  buffer_load_dwordx4 v207, s[36:39], s54 offen lds
  s_add_u32 m0, s61, 77824
  s_add_u32 s54, s62, 608256
  buffer_load_dwordx4 v207, s[36:39], s54 offen lds
  s_add_u32 m0, s61, 81920
  s_add_u32 s54, s62, 442368
  buffer_load_dwordx4 v208, s[36:39], s54 offen lds
  s_add_u32 m0, s61, 86016
  s_add_u32 s54, s62, 497664
  buffer_load_dwordx4 v208, s[36:39], s54 offen lds
  s_add_u32 m0, s61, 90112
  s_add_u32 s54, s62, 552960
  buffer_load_dwordx4 v208, s[36:39], s54 offen lds
  s_add_u32 m0, s61, 94208
  s_add_u32 s54, s62, 608256
  buffer_load_dwordx4 v208, s[36:39], s54 offen lds
  s_waitcnt vmcnt(20) lgkmcnt(0)
  s_barrier
  s_add_u32 m0, s61, 98304
  s_add_u32 s54, s62, 663552
  buffer_load_dwordx4 v207, s[36:39], s54 offen lds
  s_add_u32 m0, s61, 102400
  s_add_u32 s54, s62, 718848
  buffer_load_dwordx4 v207, s[36:39], s54 offen lds
  s_add_u32 m0, s61, 106496
  s_add_u32 s54, s62, 774144
  buffer_load_dwordx4 v207, s[36:39], s54 offen lds
  s_add_u32 m0, s61, 110592
  s_add_u32 s54, s62, 829440
  buffer_load_dwordx4 v207, s[36:39], s54 offen lds
  v_add_u32 v215, 36864, v210
  ds_read_b64_tr_b16 a[0:1], v215 offset:0
  ds_read_b64_tr_b16 a[2:3], v215 offset:1024
  ds_read_b64_tr_b16 a[4:5], v215 offset:4096
  ds_read_b64_tr_b16 a[6:7], v215 offset:5120
  ds_read_b64_tr_b16 a[8:9], v215 offset:8192
  ds_read_b64_tr_b16 a[10:11], v215 offset:9216
  ds_read_b64_tr_b16 a[12:13], v215 offset:12288
  ds_read_b64_tr_b16 a[14:15], v215 offset:13312
  s_waitcnt vmcnt(20) lgkmcnt(0)
  s_barrier
  s_add_u32 m0, s61, 0
  s_add_u32 s54, s62, 663552
  buffer_load_dwordx4 v208, s[36:39], s54 offen lds
  s_add_u32 m0, s61, 4096
  s_add_u32 s54, s62, 718848
  buffer_load_dwordx4 v208, s[36:39], s54 offen lds
  s_add_u32 m0, s61, 8192
  s_add_u32 s54, s62, 774144
  buffer_load_dwordx4 v208, s[36:39], s54 offen lds
  s_add_u32 m0, s61, 12288
  s_add_u32 s54, s62, 829440
  buffer_load_dwordx4 v208, s[36:39], s54 offen lds
  v_add_u32 v215, 53248, v210
  ds_read_b64_tr_b16 a[144:145], v215 offset:0
  ds_read_b64_tr_b16 a[146:147], v215 offset:1024
  ds_read_b64_tr_b16 a[148:149], v215 offset:4096
  ds_read_b64_tr_b16 a[150:151], v215 offset:5120
  ds_read_b64_tr_b16 a[152:153], v215 offset:8192
  ds_read_b64_tr_b16 a[154:155], v215 offset:9216
  ds_read_b64_tr_b16 a[156:157], v215 offset:12288
  ds_read_b64_tr_b16 a[158:159], v215 offset:13312
  s_waitcnt vmcnt(20) lgkmcnt(0)
  s_barrier
  s_add_u32 m0, s61, 16384
  s_add_u32 s54, s62, 884736
  buffer_load_dwordx4 v207, s[36:39], s54 offen lds
  s_add_u32 m0, s61, 20480
  s_add_u32 s54, s62, 940032
  buffer_load_dwordx4 v207, s[36:39], s54 offen lds
  s_add_u32 m0, s61, 24576
  s_add_u32 s54, s62, 995328
  buffer_load_dwordx4 v207, s[36:39], s54 offen lds
  s_add_u32 m0, s61, 28672
  s_add_u32 s54, s62, 1050624
  buffer_load_dwordx4 v207, s[36:39], s54 offen lds
  v_add_u32 v215, 69632, v210
  ds_read_b64_tr_b16 a[16:17], v215 offset:0
  ds_read_b64_tr_b16 a[18:19], v215 offset:1024
  ds_read_b64_tr_b16 a[20:21], v215 offset:4096
  ds_read_b64_tr_b16 a[22:23], v215 offset:5120
  ds_read_b64_tr_b16 a[24:25], v215 offset:8192
  ds_read_b64_tr_b16 a[26:27], v215 offset:9216
  ds_read_b64_tr_b16 a[28:29], v215 offset:12288
  ds_read_b64_tr_b16 a[30:31], v215 offset:13312
  s_waitcnt vmcnt(20) lgkmcnt(0)
  s_barrier
  s_add_u32 m0, s61, 32768
  s_add_u32 s54, s62, 884736
  buffer_load_dwordx4 v208, s[36:39], s54 offen lds
  s_add_u32 m0, s61, 36864
  s_add_u32 s54, s62, 940032
  buffer_load_dwordx4 v208, s[36:39], s54 offen lds
  s_add_u32 m0, s61, 40960
  s_add_u32 s54, s62, 995328
  buffer_load_dwordx4 v208, s[36:39], s54 offen lds
  s_add_u32 m0, s61, 45056
  s_add_u32 s54, s62, 1050624
  buffer_load_dwordx4 v208, s[36:39], s54 offen lds
  v_add_u32 v215, 86016, v210
  ds_read_b64_tr_b16 a[160:161], v215 offset:0
  ds_read_b64_tr_b16 a[162:163], v215 offset:1024
  ds_read_b64_tr_b16 a[164:165], v215 offset:4096
  ds_read_b64_tr_b16 a[166:167], v215 offset:5120
  ds_read_b64_tr_b16 a[168:169], v215 offset:8192
  ds_read_b64_tr_b16 a[170:171], v215 offset:9216
  ds_read_b64_tr_b16 a[172:173], v215 offset:12288
  ds_read_b64_tr_b16 a[174:175], v215 offset:13312
  s_waitcnt vmcnt(20) lgkmcnt(0)
  s_barrier
  s_add_u32 m0, s61, 49152
  s_add_u32 s54, s62, 1105920
  buffer_load_dwordx4 v207, s[36:39], s54 offen lds
  s_add_u32 m0, s61, 53248
  s_add_u32 s54, s62, 1161216
  buffer_load_dwordx4 v207, s[36:39], s54 offen lds
  s_add_u32 m0, s61, 57344
  s_add_u32 s54, s62, 1216512
  buffer_load_dwordx4 v207, s[36:39], s54 offen lds
  s_add_u32 m0, s61, 61440
  s_add_u32 s54, s62, 1271808
  buffer_load_dwordx4 v207, s[36:39], s54 offen lds
  v_add_u32 v215, 102400, v210
  ds_read_b64_tr_b16 a[32:33], v215 offset:0
  ds_read_b64_tr_b16 a[34:35], v215 offset:1024
  ds_read_b64_tr_b16 a[36:37], v215 offset:4096
  ds_read_b64_tr_b16 a[38:39], v215 offset:5120
  ds_read_b64_tr_b16 a[40:41], v215 offset:8192
  ds_read_b64_tr_b16 a[42:43], v215 offset:9216
  ds_read_b64_tr_b16 a[44:45], v215 offset:12288
  ds_read_b64_tr_b16 a[46:47], v215 offset:13312
  s_waitcnt vmcnt(20) lgkmcnt(0)
  s_barrier
  s_add_u32 m0, s61, 65536
  s_add_u32 s54, s62, 1105920
  buffer_load_dwordx4 v208, s[36:39], s54 offen lds
  s_add_u32 m0, s61, 69632
  s_add_u32 s54, s62, 1161216
  buffer_load_dwordx4 v208, s[36:39], s54 offen lds
  s_add_u32 m0, s61, 73728
  s_add_u32 s54, s62, 1216512
  buffer_load_dwordx4 v208, s[36:39], s54 offen lds
  s_add_u32 m0, s61, 77824
  s_add_u32 s54, s62, 1271808
  buffer_load_dwordx4 v208, s[36:39], s54 offen lds
  v_add_u32 v215, 118784, v210
  ds_read_b64_tr_b16 a[176:177], v215 offset:0
  ds_read_b64_tr_b16 a[178:179], v215 offset:1024
  ds_read_b64_tr_b16 a[180:181], v215 offset:4096
  ds_read_b64_tr_b16 a[182:183], v215 offset:5120
  ds_read_b64_tr_b16 a[184:185], v215 offset:8192
  ds_read_b64_tr_b16 a[186:187], v215 offset:9216
  ds_read_b64_tr_b16 a[188:189], v215 offset:12288
  ds_read_b64_tr_b16 a[190:191], v215 offset:13312
  s_waitcnt vmcnt(20) lgkmcnt(0)
  s_barrier
  s_add_u32 m0, s61, 81920
  s_add_u32 s54, s62, 1327104
  buffer_load_dwordx4 v207, s[36:39], s54 offen lds
  s_add_u32 m0, s61, 86016
  s_add_u32 s54, s62, 1382400
  buffer_load_dwordx4 v207, s[36:39], s54 offen lds
  s_add_u32 m0, s61, 90112
  s_add_u32 s54, s62, 1437696
  buffer_load_dwordx4 v207, s[36:39], s54 offen lds
  s_add_u32 m0, s61, 94208
  s_add_u32 s54, s62, 1492992
  buffer_load_dwordx4 v207, s[36:39], s54 offen lds
  v_add_u32 v215, 135168, v210
  ds_read_b64_tr_b16 a[48:49], v215 offset:0
  ds_read_b64_tr_b16 a[50:51], v215 offset:1024
  ds_read_b64_tr_b16 a[52:53], v215 offset:4096
  ds_read_b64_tr_b16 a[54:55], v215 offset:5120
  ds_read_b64_tr_b16 a[56:57], v215 offset:8192
  ds_read_b64_tr_b16 a[58:59], v215 offset:9216
  ds_read_b64_tr_b16 a[60:61], v215 offset:12288
  ds_read_b64_tr_b16 a[62:63], v215 offset:13312
  s_waitcnt vmcnt(20) lgkmcnt(0)
  s_barrier
  s_add_u32 m0, s61, 98304
  s_add_u32 s54, s62, 1327104
  buffer_load_dwordx4 v208, s[36:39], s54 offen lds
  s_add_u32 m0, s61, 102400
  s_add_u32 s54, s62, 1382400
  buffer_load_dwordx4 v208, s[36:39], s54 offen lds
  s_add_u32 m0, s61, 106496
  s_add_u32 s54, s62, 1437696
  buffer_load_dwordx4 v208, s[36:39], s54 offen lds
  s_add_u32 m0, s61, 110592
  s_add_u32 s54, s62, 1492992
  buffer_load_dwordx4 v208, s[36:39], s54 offen lds
  v_add_u32 v215, 36864, v210
  ds_read_b64_tr_b16 a[192:193], v215 offset:0
  ds_read_b64_tr_b16 a[194:195], v215 offset:1024
  ds_read_b64_tr_b16 a[196:197], v215 offset:4096
  ds_read_b64_tr_b16 a[198:199], v215 offset:5120
  ds_read_b64_tr_b16 a[200:201], v215 offset:8192
  ds_read_b64_tr_b16 a[202:203], v215 offset:9216
  ds_read_b64_tr_b16 a[204:205], v215 offset:12288
  ds_read_b64_tr_b16 a[206:207], v215 offset:13312
  s_waitcnt vmcnt(20) lgkmcnt(0)
  s_barrier
  s_add_u32 m0, s61, 0
  s_add_u32 s54, s62, 1548288
  buffer_load_dwordx4 v207, s[36:39], s54 offen lds
  s_add_u32 m0, s61, 4096
  s_add_u32 s54, s62, 1603584
  buffer_load_dwordx4 v207, s[36:39], s54 offen lds
  s_add_u32 m0, s61, 8192
  s_add_u32 s54, s62, 1658880
  buffer_load_dwordx4 v207, s[36:39], s54 offen lds
  s_add_u32 m0, s61, 12288
  s_add_u32 s54, s62, 1714176
  buffer_load_dwordx4 v207, s[36:39], s54 offen lds
  v_add_u32 v215, 53248, v210
  ds_read_b64_tr_b16 a[64:65], v215 offset:0
  ds_read_b64_tr_b16 a[66:67], v215 offset:1024
  ds_read_b64_tr_b16 a[68:69], v215 offset:4096
  ds_read_b64_tr_b16 a[70:71], v215 offset:5120
  ds_read_b64_tr_b16 a[72:73], v215 offset:8192
  ds_read_b64_tr_b16 a[74:75], v215 offset:9216
  ds_read_b64_tr_b16 a[76:77], v215 offset:12288
  ds_read_b64_tr_b16 a[78:79], v215 offset:13312
  s_waitcnt vmcnt(20) lgkmcnt(0)
  s_barrier
  s_add_u32 m0, s61, 16384
  s_add_u32 s54, s62, 1548288
  buffer_load_dwordx4 v208, s[36:39], s54 offen lds
  s_add_u32 m0, s61, 20480
  s_add_u32 s54, s62, 1603584
  buffer_load_dwordx4 v208, s[36:39], s54 offen lds
  s_add_u32 m0, s61, 24576
  s_add_u32 s54, s62, 1658880
  buffer_load_dwordx4 v208, s[36:39], s54 offen lds
  s_add_u32 m0, s61, 28672
  s_add_u32 s54, s62, 1714176
  buffer_load_dwordx4 v208, s[36:39], s54 offen lds
  v_add_u32 v215, 69632, v210
  ds_read_b64_tr_b16 a[208:209], v215 offset:0
  ds_read_b64_tr_b16 a[210:211], v215 offset:1024
  ds_read_b64_tr_b16 a[212:213], v215 offset:4096
  ds_read_b64_tr_b16 a[214:215], v215 offset:5120
  ds_read_b64_tr_b16 a[216:217], v215 offset:8192
  ds_read_b64_tr_b16 a[218:219], v215 offset:9216
  ds_read_b64_tr_b16 a[220:221], v215 offset:12288
  ds_read_b64_tr_b16 a[222:223], v215 offset:13312
  s_waitcnt vmcnt(20) lgkmcnt(0)
  s_barrier
  s_add_u32 m0, s61, 32768
  s_add_u32 s54, s62, 1769472
  buffer_load_dwordx4 v207, s[36:39], s54 offen lds
  s_add_u32 m0, s61, 36864
  s_add_u32 s54, s62, 1824768
  buffer_load_dwordx4 v207, s[36:39], s54 offen lds
  s_add_u32 m0, s61, 40960
  s_add_u32 s54, s62, 1880064
  buffer_load_dwordx4 v207, s[36:39], s54 offen lds
  s_add_u32 m0, s61, 45056
  s_add_u32 s54, s62, 1935360
  buffer_load_dwordx4 v207, s[36:39], s54 offen lds
  v_add_u32 v215, 86016, v210
  ds_read_b64_tr_b16 a[80:81], v215 offset:0
  ds_read_b64_tr_b16 a[82:83], v215 offset:1024
  ds_read_b64_tr_b16 a[84:85], v215 offset:4096
  ds_read_b64_tr_b16 a[86:87], v215 offset:5120
  ds_read_b64_tr_b16 a[88:89], v215 offset:8192
  ds_read_b64_tr_b16 a[90:91], v215 offset:9216
  ds_read_b64_tr_b16 a[92:93], v215 offset:12288
  ds_read_b64_tr_b16 a[94:95], v215 offset:13312
  s_waitcnt vmcnt(20) lgkmcnt(0)
  s_barrier
  s_add_u32 m0, s61, 49152
  s_add_u32 s54, s62, 1769472
  buffer_load_dwordx4 v208, s[36:39], s54 offen lds
  s_add_u32 m0, s61, 53248
  s_add_u32 s54, s62, 1824768
  buffer_load_dwordx4 v208, s[36:39], s54 offen lds
  s_add_u32 m0, s61, 57344
  s_add_u32 s54, s62, 1880064
  buffer_load_dwordx4 v208, s[36:39], s54 offen lds
  s_add_u32 m0, s61, 61440
  s_add_u32 s54, s62, 1935360
  buffer_load_dwordx4 v208, s[36:39], s54 offen lds
  v_add_u32 v215, 102400, v210
  ds_read_b64_tr_b16 a[224:225], v215 offset:0
  ds_read_b64_tr_b16 a[226:227], v215 offset:1024
  ds_read_b64_tr_b16 a[228:229], v215 offset:4096
  ds_read_b64_tr_b16 a[230:231], v215 offset:5120
  ds_read_b64_tr_b16 a[232:233], v215 offset:8192
  ds_read_b64_tr_b16 a[234:235], v215 offset:9216
  ds_read_b64_tr_b16 a[236:237], v215 offset:12288
  ds_read_b64_tr_b16 a[238:239], v215 offset:13312
  s_waitcnt vmcnt(20) lgkmcnt(0)
  s_barrier
  v_add_u32 v215, 118784, v210
  ds_read_b64_tr_b16 a[96:97], v215 offset:0
  ds_read_b64_tr_b16 a[98:99], v215 offset:1024
  ds_read_b64_tr_b16 a[100:101], v215 offset:4096
  ds_read_b64_tr_b16 a[102:103], v215 offset:5120
  ds_read_b64_tr_b16 a[104:105], v215 offset:8192
  ds_read_b64_tr_b16 a[106:107], v215 offset:9216
  ds_read_b64_tr_b16 a[108:109], v215 offset:12288
  ds_read_b64_tr_b16 a[110:111], v215 offset:13312
  s_waitcnt vmcnt(16) lgkmcnt(0)
  s_barrier
  v_add_u32 v215, 135168, v210
  ds_read_b64_tr_b16 a[240:241], v215 offset:0
  ds_read_b64_tr_b16 a[242:243], v215 offset:1024
  ds_read_b64_tr_b16 a[244:245], v215 offset:4096
  ds_read_b64_tr_b16 a[246:247], v215 offset:5120
  ds_read_b64_tr_b16 a[248:249], v215 offset:8192
  ds_read_b64_tr_b16 a[250:251], v215 offset:9216
  ds_read_b64_tr_b16 a[252:253], v215 offset:12288
  ds_read_b64_tr_b16 a[254:255], v215 offset:13312
  s_waitcnt vmcnt(12) lgkmcnt(0)
  s_barrier
  v_add_u32 v215, 36864, v210
  ds_read_b64_tr_b16 a[112:113], v215 offset:0
  ds_read_b64_tr_b16 a[114:115], v215 offset:1024
  ds_read_b64_tr_b16 a[116:117], v215 offset:4096
  ds_read_b64_tr_b16 a[118:119], v215 offset:5120
  ds_read_b64_tr_b16 a[120:121], v215 offset:8192
  ds_read_b64_tr_b16 a[122:123], v215 offset:9216
  ds_read_b64_tr_b16 a[124:125], v215 offset:12288
  ds_read_b64_tr_b16 a[126:127], v215 offset:13312
  s_waitcnt vmcnt(8) lgkmcnt(0)
  s_barrier
  v_add_u32 v215, 53248, v210
  ds_read_b64_tr_b16 v[224:225], v215 offset:0
  ds_read_b64_tr_b16 v[226:227], v215 offset:1024
  ds_read_b64_tr_b16 v[228:229], v215 offset:4096
  ds_read_b64_tr_b16 v[230:231], v215 offset:5120
  ds_read_b64_tr_b16 v[232:233], v215 offset:8192
  ds_read_b64_tr_b16 v[234:235], v215 offset:9216
  ds_read_b64_tr_b16 v[236:237], v215 offset:12288
  ds_read_b64_tr_b16 v[238:239], v215 offset:13312
  s_waitcnt vmcnt(4) lgkmcnt(0)
  s_barrier
  v_add_u32 v215, 69632, v210
  ds_read_b64_tr_b16 a[128:129], v215 offset:0
  ds_read_b64_tr_b16 a[130:131], v215 offset:1024
  ds_read_b64_tr_b16 a[132:133], v215 offset:4096
  ds_read_b64_tr_b16 a[134:135], v215 offset:5120
  ds_read_b64_tr_b16 a[136:137], v215 offset:8192
  ds_read_b64_tr_b16 a[138:139], v215 offset:9216
  ds_read_b64_tr_b16 a[140:141], v215 offset:12288
  ds_read_b64_tr_b16 a[142:143], v215 offset:13312
  s_waitcnt vmcnt(0) lgkmcnt(0)
  s_barrier
  v_add_u32 v215, 86016, v210
  ds_read_b64_tr_b16 v[240:241], v215 offset:0
  ds_read_b64_tr_b16 v[242:243], v215 offset:1024
  ds_read_b64_tr_b16 v[244:245], v215 offset:4096
  ds_read_b64_tr_b16 v[246:247], v215 offset:5120
  ds_read_b64_tr_b16 v[248:249], v215 offset:8192
  ds_read_b64_tr_b16 v[250:251], v215 offset:9216
  ds_read_b64_tr_b16 v[252:253], v215 offset:12288
  ds_read_b64_tr_b16 v[254:255], v215 offset:13312
  s_waitcnt lgkmcnt(0)
  s_barrier
  v_and_b32 v211, 31, v200
  v_mul_u32_u24 v218, 516, v211
  v_lshrrev_b32 v212, 5, v200
  v_lshl_add_u32 v218, v212, 3, v218
  s_lshl_b32 s54, s52, 6
  s_add_u32 s54, s54, 73728
  v_add_u32 v218, s54, v218
  s_lshl_b32 s60, s69, 2
  s_mul_i32 s60, s60, 36864
  ds_read_b128 v[32:35], v203 offset:0
  ds_read_b128 v[36:39], v204 offset:0
  ds_read_b128 v[40:43], v205 offset:0
  s_waitcnt lgkmcnt(2)
  v_mfma_f32_32x32x16_bf16 v[0:15], a[0:3], v[32:35], 0
  ds_read_b128 v[44:47], v206 offset:0
  s_add_u32 m0, s67, 36864
  s_nop 0
  buffer_load_dwordx4 v202, s[4:7], s60 offen offset:0 lds
  v_mfma_f32_32x32x16_bf16 v[16:31], a[144:147], v[32:35], 0
  s_waitcnt lgkmcnt(2)
  v_mfma_f32_32x32x16_bf16 v[0:15], a[4:7], v[36:39], v[0:15]
  ds_read_b128 v[32:35], v203 offset:1024
  s_add_u32 m0, s67, 37760
  s_nop 0
  buffer_load_dwordx4 v202, s[4:7], s60 offen offset:128 lds
  v_mfma_f32_32x32x16_bf16 v[16:31], a[148:151], v[36:39], v[16:31]
  s_waitcnt lgkmcnt(2)
  v_mfma_f32_32x32x16_bf16 v[0:15], a[8:11], v[40:43], v[0:15]
  ds_read_b128 v[36:39], v204 offset:1024
  s_add_u32 m0, s67, 38656
  s_nop 0
  buffer_load_dwordx4 v202, s[4:7], s60 offen offset:256 lds
  v_mfma_f32_32x32x16_bf16 v[16:31], a[152:155], v[40:43], v[16:31]
  s_waitcnt lgkmcnt(2)
  v_mfma_f32_32x32x16_bf16 v[0:15], a[12:15], v[44:47], v[0:15]
  ds_read_b128 v[40:43], v205 offset:1024
  s_add_u32 m0, s67, 39552
  s_nop 0
  buffer_load_dwordx4 v202, s[4:7], s60 offen offset:384 lds
  v_mfma_f32_32x32x16_bf16 v[16:31], a[156:159], v[44:47], v[16:31]
  s_waitcnt lgkmcnt(2)
  v_mfma_f32_32x32x16_bf16 v[0:15], a[16:19], v[32:35], v[0:15]
  ds_read_b128 v[44:47], v206 offset:1024
  s_add_u32 m0, s67, 40448
  s_nop 0
  buffer_load_dwordx4 v202, s[4:7], s60 offen offset:512 lds
  v_mfma_f32_32x32x16_bf16 v[16:31], a[160:163], v[32:35], v[16:31]
  s_waitcnt lgkmcnt(2)
  v_mfma_f32_32x32x16_bf16 v[0:15], a[20:23], v[36:39], v[0:15]
  ds_read_b128 v[32:35], v203 offset:2048
  s_add_u32 m0, s67, 41344
  s_nop 0
  buffer_load_dwordx4 v202, s[4:7], s60 offen offset:640 lds
  v_mfma_f32_32x32x16_bf16 v[16:31], a[164:167], v[36:39], v[16:31]
  s_waitcnt lgkmcnt(2)
  v_mfma_f32_32x32x16_bf16 v[0:15], a[24:27], v[40:43], v[0:15]
  ds_read_b128 v[36:39], v204 offset:2048
  s_add_u32 m0, s67, 42240
  s_nop 0
  buffer_load_dwordx4 v202, s[4:7], s60 offen offset:768 lds
  v_mfma_f32_32x32x16_bf16 v[16:31], a[168:171], v[40:43], v[16:31]
  s_waitcnt lgkmcnt(2)
  v_mfma_f32_32x32x16_bf16 v[0:15], a[28:31], v[44:47], v[0:15]
  ds_read_b128 v[40:43], v205 offset:2048
  s_add_u32 m0, s67, 43136
  s_nop 0
  buffer_load_dwordx4 v202, s[4:7], s60 offen offset:896 lds
  v_mfma_f32_32x32x16_bf16 v[16:31], a[172:175], v[44:47], v[16:31]
  s_waitcnt lgkmcnt(2)
  v_mfma_f32_32x32x16_bf16 v[0:15], a[32:35], v[32:35], v[0:15]
  ds_read_b128 v[44:47], v206 offset:2048
  s_add_u32 m0, s67, 44032
  s_nop 0
  buffer_load_dwordx4 v202, s[4:7], s60 offen offset:1024 lds
  v_mfma_f32_32x32x16_bf16 v[16:31], a[176:179], v[32:35], v[16:31]
  s_waitcnt lgkmcnt(2)
  v_mfma_f32_32x32x16_bf16 v[0:15], a[36:39], v[36:39], v[0:15]
  ds_read_b128 v[32:35], v203 offset:3072
  v_mfma_f32_32x32x16_bf16 v[16:31], a[180:183], v[36:39], v[16:31]
  s_waitcnt lgkmcnt(2)
  v_mfma_f32_32x32x16_bf16 v[0:15], a[40:43], v[40:43], v[0:15]
  ds_read_b128 v[36:39], v204 offset:3072
  v_mfma_f32_32x32x16_bf16 v[16:31], a[184:187], v[40:43], v[16:31]
  s_waitcnt lgkmcnt(2)
  v_mfma_f32_32x32x16_bf16 v[0:15], a[44:47], v[44:47], v[0:15]
  ds_read_b128 v[40:43], v205 offset:3072
  v_mfma_f32_32x32x16_bf16 v[16:31], a[188:191], v[44:47], v[16:31]
  s_waitcnt lgkmcnt(2)
  v_mfma_f32_32x32x16_bf16 v[0:15], a[48:51], v[32:35], v[0:15]
  ds_read_b128 v[44:47], v206 offset:3072
  v_mfma_f32_32x32x16_bf16 v[16:31], a[192:195], v[32:35], v[16:31]
  s_waitcnt lgkmcnt(2)
  v_mfma_f32_32x32x16_bf16 v[0:15], a[52:55], v[36:39], v[0:15]
  ds_read_b128 v[32:35], v203 offset:4096
  v_mfma_f32_32x32x16_bf16 v[16:31], a[196:199], v[36:39], v[16:31]
  s_waitcnt lgkmcnt(2)
  v_mfma_f32_32x32x16_bf16 v[0:15], a[56:59], v[40:43], v[0:15]
  ds_read_b128 v[36:39], v204 offset:4096
  v_mfma_f32_32x32x16_bf16 v[16:31], a[200:203], v[40:43], v[16:31]
  s_waitcnt lgkmcnt(2)
  v_mfma_f32_32x32x16_bf16 v[0:15], a[60:63], v[44:47], v[0:15]
  ds_read_b128 v[40:43], v205 offset:4096
  v_mfma_f32_32x32x16_bf16 v[16:31], a[204:207], v[44:47], v[16:31]
  s_waitcnt lgkmcnt(2)
  v_mfma_f32_32x32x16_bf16 v[0:15], a[64:67], v[32:35], v[0:15]
  ds_read_b128 v[44:47], v206 offset:4096
  v_mfma_f32_32x32x16_bf16 v[16:31], a[208:211], v[32:35], v[16:31]
  s_waitcnt lgkmcnt(2)
  v_mfma_f32_32x32x16_bf16 v[0:15], a[68:71], v[36:39], v[0:15]
  ds_read_b128 v[32:35], v203 offset:5120
  v_mfma_f32_32x32x16_bf16 v[16:31], a[212:215], v[36:39], v[16:31]
  s_waitcnt lgkmcnt(2)
  v_mfma_f32_32x32x16_bf16 v[0:15], a[72:75], v[40:43], v[0:15]
  ds_read_b128 v[36:39], v204 offset:5120
  v_mfma_f32_32x32x16_bf16 v[16:31], a[216:219], v[40:43], v[16:31]
  s_waitcnt lgkmcnt(2)
  v_mfma_f32_32x32x16_bf16 v[0:15], a[76:79], v[44:47], v[0:15]
  ds_read_b128 v[40:43], v205 offset:5120
  v_mfma_f32_32x32x16_bf16 v[16:31], a[220:223], v[44:47], v[16:31]
  s_waitcnt lgkmcnt(2)
  v_mfma_f32_32x32x16_bf16 v[0:15], a[80:83], v[32:35], v[0:15]
  ds_read_b128 v[44:47], v206 offset:5120
  v_mfma_f32_32x32x16_bf16 v[16:31], a[224:227], v[32:35], v[16:31]
  s_waitcnt lgkmcnt(2)
  v_mfma_f32_32x32x16_bf16 v[0:15], a[84:87], v[36:39], v[0:15]
  ds_read_b128 v[32:35], v203 offset:6144
  v_mfma_f32_32x32x16_bf16 v[16:31], a[228:231], v[36:39], v[16:31]
  s_waitcnt lgkmcnt(2)
  v_mfma_f32_32x32x16_bf16 v[0:15], a[88:91], v[40:43], v[0:15]
  ds_read_b128 v[36:39], v204 offset:6144
  v_mfma_f32_32x32x16_bf16 v[16:31], a[232:235], v[40:43], v[16:31]
  s_waitcnt lgkmcnt(2)
  v_mfma_f32_32x32x16_bf16 v[0:15], a[92:95], v[44:47], v[0:15]
  ds_read_b128 v[40:43], v205 offset:6144
  v_mfma_f32_32x32x16_bf16 v[16:31], a[236:239], v[44:47], v[16:31]
  s_waitcnt lgkmcnt(2)
  v_mfma_f32_32x32x16_bf16 v[0:15], a[96:99], v[32:35], v[0:15]
  ds_read_b128 v[44:47], v206 offset:6144
  v_mfma_f32_32x32x16_bf16 v[16:31], a[240:243], v[32:35], v[16:31]
  s_waitcnt lgkmcnt(2)
  v_mfma_f32_32x32x16_bf16 v[0:15], a[100:103], v[36:39], v[0:15]
  ds_read_b128 v[32:35], v203 offset:7168
  v_mfma_f32_32x32x16_bf16 v[16:31], a[244:247], v[36:39], v[16:31]
  s_waitcnt lgkmcnt(2)
  v_mfma_f32_32x32x16_bf16 v[0:15], a[104:107], v[40:43], v[0:15]
  ds_read_b128 v[36:39], v204 offset:7168
  v_mfma_f32_32x32x16_bf16 v[16:31], a[248:251], v[40:43], v[16:31]
  s_waitcnt lgkmcnt(2)
  v_mfma_f32_32x32x16_bf16 v[0:15], a[108:111], v[44:47], v[0:15]
  ds_read_b128 v[40:43], v205 offset:7168
  v_mfma_f32_32x32x16_bf16 v[16:31], a[252:255], v[44:47], v[16:31]
  s_waitcnt lgkmcnt(2)
  v_mfma_f32_32x32x16_bf16 v[0:15], a[112:115], v[32:35], v[0:15]
  ds_read_b128 v[44:47], v206 offset:7168
  v_mfma_f32_32x32x16_bf16 v[16:31], v[224:227], v[32:35], v[16:31]
  s_waitcnt lgkmcnt(2)
  v_mfma_f32_32x32x16_bf16 v[0:15], a[116:119], v[36:39], v[0:15]
  ds_read_b128 v[32:35], v203 offset:8192
  v_mfma_f32_32x32x16_bf16 v[16:31], v[228:231], v[36:39], v[16:31]
  s_waitcnt lgkmcnt(2)
  v_mfma_f32_32x32x16_bf16 v[0:15], a[120:123], v[40:43], v[0:15]
  ds_read_b128 v[36:39], v204 offset:8192
  v_mfma_f32_32x32x16_bf16 v[16:31], v[232:235], v[40:43], v[16:31]
  s_waitcnt lgkmcnt(2)
  v_mfma_f32_32x32x16_bf16 v[0:15], a[124:127], v[44:47], v[0:15]
  ds_read_b128 v[40:43], v205 offset:8192
  v_mfma_f32_32x32x16_bf16 v[16:31], v[236:239], v[44:47], v[16:31]
  s_waitcnt lgkmcnt(2)
  v_mfma_f32_32x32x16_bf16 v[0:15], a[128:131], v[32:35], v[0:15]
  ds_read_b128 v[44:47], v206 offset:8192
  v_mfma_f32_32x32x16_bf16 v[16:31], v[240:243], v[32:35], v[16:31]
  s_waitcnt lgkmcnt(2)
  v_mfma_f32_32x32x16_bf16 v[0:15], a[132:135], v[36:39], v[0:15]
  v_mfma_f32_32x32x16_bf16 v[16:31], v[244:247], v[36:39], v[16:31]
  s_waitcnt lgkmcnt(1)
  v_mfma_f32_32x32x16_bf16 v[0:15], a[136:139], v[40:43], v[0:15]
  v_mfma_f32_32x32x16_bf16 v[16:31], v[248:251], v[40:43], v[16:31]
  s_waitcnt lgkmcnt(0)
  v_mfma_f32_32x32x16_bf16 v[0:15], a[140:143], v[44:47], v[0:15]
  v_mfma_f32_32x32x16_bf16 v[16:31], v[252:255], v[44:47], v[16:31]
  s_add_u32 s60, s60, 36864
  s_nop 2
  v_cvt_pk_bf16_f32 v48, v0, v1
  v_cvt_pk_bf16_f32 v49, v2, v3
  ds_write2_b32 v218, v48, v49 offset0:0 offset1:1
  v_cvt_pk_bf16_f32 v48, v4, v5
  v_cvt_pk_bf16_f32 v49, v6, v7
  ds_write2_b32 v218, v48, v49 offset0:4 offset1:5
  v_cvt_pk_bf16_f32 v48, v8, v9
  v_cvt_pk_bf16_f32 v49, v10, v11
  ds_write2_b32 v218, v48, v49 offset0:8 offset1:9
  v_cvt_pk_bf16_f32 v48, v12, v13
  v_cvt_pk_bf16_f32 v49, v14, v15
  ds_write2_b32 v218, v48, v49 offset0:12 offset1:13
  v_cvt_pk_bf16_f32 v48, v16, v17
  v_cvt_pk_bf16_f32 v49, v18, v19
  ds_write2_b32 v218, v48, v49 offset0:64 offset1:65
  v_cvt_pk_bf16_f32 v48, v20, v21
  v_cvt_pk_bf16_f32 v49, v22, v23
  ds_write2_b32 v218, v48, v49 offset0:68 offset1:69
  v_cvt_pk_bf16_f32 v48, v24, v25
  v_cvt_pk_bf16_f32 v49, v26, v27
  ds_write2_b32 v218, v48, v49 offset0:72 offset1:73
  v_cvt_pk_bf16_f32 v48, v28, v29
  v_cvt_pk_bf16_f32 v49, v30, v31
  ds_write2_b32 v218, v48, v49 offset0:76 offset1:77
  v_add_u32 v218, 16512, v218
  s_waitcnt vmcnt(0) lgkmcnt(0)
  s_barrier
  ds_read_b128 v[32:35], v203 offset:36864
  ds_read_b128 v[36:39], v204 offset:36864
  ds_read_b128 v[40:43], v205 offset:36864
  s_waitcnt lgkmcnt(2)
  v_mfma_f32_32x32x16_bf16 v[0:15], a[0:3], v[32:35], 0
  ds_read_b128 v[44:47], v206 offset:36864
  s_add_u32 m0, s67, 0
  s_nop 0
  buffer_load_dwordx4 v202, s[4:7], s60 offen offset:0 lds
  v_mfma_f32_32x32x16_bf16 v[16:31], a[144:147], v[32:35], 0
  s_waitcnt lgkmcnt(2)
  v_mfma_f32_32x32x16_bf16 v[0:15], a[4:7], v[36:39], v[0:15]
  ds_read_b128 v[32:35], v203 offset:37888
  s_add_u32 m0, s67, 896
  s_nop 0
  buffer_load_dwordx4 v202, s[4:7], s60 offen offset:128 lds
  v_mfma_f32_32x32x16_bf16 v[16:31], a[148:151], v[36:39], v[16:31]
  s_waitcnt lgkmcnt(2)
  v_mfma_f32_32x32x16_bf16 v[0:15], a[8:11], v[40:43], v[0:15]
  ds_read_b128 v[36:39], v204 offset:37888
  s_add_u32 m0, s67, 1792
  s_nop 0
  buffer_load_dwordx4 v202, s[4:7], s60 offen offset:256 lds
  v_mfma_f32_32x32x16_bf16 v[16:31], a[152:155], v[40:43], v[16:31]
  s_waitcnt lgkmcnt(2)
  v_mfma_f32_32x32x16_bf16 v[0:15], a[12:15], v[44:47], v[0:15]
  ds_read_b128 v[40:43], v205 offset:37888
  s_add_u32 m0, s67, 2688
  s_nop 0
  buffer_load_dwordx4 v202, s[4:7], s60 offen offset:384 lds
  v_mfma_f32_32x32x16_bf16 v[16:31], a[156:159], v[44:47], v[16:31]
  s_waitcnt lgkmcnt(2)
  v_mfma_f32_32x32x16_bf16 v[0:15], a[16:19], v[32:35], v[0:15]
  ds_read_b128 v[44:47], v206 offset:37888
  s_add_u32 m0, s67, 3584
  s_nop 0
  buffer_load_dwordx4 v202, s[4:7], s60 offen offset:512 lds
  v_mfma_f32_32x32x16_bf16 v[16:31], a[160:163], v[32:35], v[16:31]
  s_waitcnt lgkmcnt(2)
  v_mfma_f32_32x32x16_bf16 v[0:15], a[20:23], v[36:39], v[0:15]
  ds_read_b128 v[32:35], v203 offset:38912
  s_add_u32 m0, s67, 4480
  s_nop 0
  buffer_load_dwordx4 v202, s[4:7], s60 offen offset:640 lds
  v_mfma_f32_32x32x16_bf16 v[16:31], a[164:167], v[36:39], v[16:31]
  s_waitcnt lgkmcnt(2)
  v_mfma_f32_32x32x16_bf16 v[0:15], a[24:27], v[40:43], v[0:15]
  ds_read_b128 v[36:39], v204 offset:38912
  s_add_u32 m0, s67, 5376
  s_nop 0
  buffer_load_dwordx4 v202, s[4:7], s60 offen offset:768 lds
  v_mfma_f32_32x32x16_bf16 v[16:31], a[168:171], v[40:43], v[16:31]
  s_waitcnt lgkmcnt(2)
  v_mfma_f32_32x32x16_bf16 v[0:15], a[28:31], v[44:47], v[0:15]
  ds_read_b128 v[40:43], v205 offset:38912
  s_add_u32 m0, s67, 6272
  s_nop 0
  buffer_load_dwordx4 v202, s[4:7], s60 offen offset:896 lds
  v_mfma_f32_32x32x16_bf16 v[16:31], a[172:175], v[44:47], v[16:31]
  s_waitcnt lgkmcnt(2)
  v_mfma_f32_32x32x16_bf16 v[0:15], a[32:35], v[32:35], v[0:15]
  ds_read_b128 v[44:47], v206 offset:38912
  s_add_u32 m0, s67, 7168
  s_nop 0
  buffer_load_dwordx4 v202, s[4:7], s60 offen offset:1024 lds
  v_mfma_f32_32x32x16_bf16 v[16:31], a[176:179], v[32:35], v[16:31]
  s_waitcnt lgkmcnt(2)
  v_mfma_f32_32x32x16_bf16 v[0:15], a[36:39], v[36:39], v[0:15]
  ds_read_b128 v[32:35], v203 offset:39936
  v_mfma_f32_32x32x16_bf16 v[16:31], a[180:183], v[36:39], v[16:31]
  s_waitcnt lgkmcnt(2)
  v_mfma_f32_32x32x16_bf16 v[0:15], a[40:43], v[40:43], v[0:15]
  ds_read_b128 v[36:39], v204 offset:39936
  v_mfma_f32_32x32x16_bf16 v[16:31], a[184:187], v[40:43], v[16:31]
  s_waitcnt lgkmcnt(2)
  v_mfma_f32_32x32x16_bf16 v[0:15], a[44:47], v[44:47], v[0:15]
  ds_read_b128 v[40:43], v205 offset:39936
  v_mfma_f32_32x32x16_bf16 v[16:31], a[188:191], v[44:47], v[16:31]
  s_waitcnt lgkmcnt(2)
  v_mfma_f32_32x32x16_bf16 v[0:15], a[48:51], v[32:35], v[0:15]
  ds_read_b128 v[44:47], v206 offset:39936
  v_mfma_f32_32x32x16_bf16 v[16:31], a[192:195], v[32:35], v[16:31]
  s_waitcnt lgkmcnt(2)
  v_mfma_f32_32x32x16_bf16 v[0:15], a[52:55], v[36:39], v[0:15]
  ds_read_b128 v[32:35], v203 offset:40960
  v_mfma_f32_32x32x16_bf16 v[16:31], a[196:199], v[36:39], v[16:31]
  s_waitcnt lgkmcnt(2)
  v_mfma_f32_32x32x16_bf16 v[0:15], a[56:59], v[40:43], v[0:15]
  ds_read_b128 v[36:39], v204 offset:40960
  v_mfma_f32_32x32x16_bf16 v[16:31], a[200:203], v[40:43], v[16:31]
  s_waitcnt lgkmcnt(2)
  v_mfma_f32_32x32x16_bf16 v[0:15], a[60:63], v[44:47], v[0:15]
  ds_read_b128 v[40:43], v205 offset:40960
  v_mfma_f32_32x32x16_bf16 v[16:31], a[204:207], v[44:47], v[16:31]
  s_waitcnt lgkmcnt(2)
  v_mfma_f32_32x32x16_bf16 v[0:15], a[64:67], v[32:35], v[0:15]
  ds_read_b128 v[44:47], v206 offset:40960
  v_mfma_f32_32x32x16_bf16 v[16:31], a[208:211], v[32:35], v[16:31]
  s_waitcnt lgkmcnt(2)
  v_mfma_f32_32x32x16_bf16 v[0:15], a[68:71], v[36:39], v[0:15]
  ds_read_b128 v[32:35], v203 offset:41984
  v_mfma_f32_32x32x16_bf16 v[16:31], a[212:215], v[36:39], v[16:31]
  s_waitcnt lgkmcnt(2)
  v_mfma_f32_32x32x16_bf16 v[0:15], a[72:75], v[40:43], v[0:15]
  ds_read_b128 v[36:39], v204 offset:41984
  v_mfma_f32_32x32x16_bf16 v[16:31], a[216:219], v[40:43], v[16:31]
  s_waitcnt lgkmcnt(2)
  v_mfma_f32_32x32x16_bf16 v[0:15], a[76:79], v[44:47], v[0:15]
  ds_read_b128 v[40:43], v205 offset:41984
  v_mfma_f32_32x32x16_bf16 v[16:31], a[220:223], v[44:47], v[16:31]
  s_waitcnt lgkmcnt(2)
  v_mfma_f32_32x32x16_bf16 v[0:15], a[80:83], v[32:35], v[0:15]
  ds_read_b128 v[44:47], v206 offset:41984
  v_mfma_f32_32x32x16_bf16 v[16:31], a[224:227], v[32:35], v[16:31]
  s_waitcnt lgkmcnt(2)
  v_mfma_f32_32x32x16_bf16 v[0:15], a[84:87], v[36:39], v[0:15]
  ds_read_b128 v[32:35], v203 offset:43008
  v_mfma_f32_32x32x16_bf16 v[16:31], a[228:231], v[36:39], v[16:31]
  s_waitcnt lgkmcnt(2)
  v_mfma_f32_32x32x16_bf16 v[0:15], a[88:91], v[40:43], v[0:15]
  ds_read_b128 v[36:39], v204 offset:43008
  v_mfma_f32_32x32x16_bf16 v[16:31], a[232:235], v[40:43], v[16:31]
  s_waitcnt lgkmcnt(2)
  v_mfma_f32_32x32x16_bf16 v[0:15], a[92:95], v[44:47], v[0:15]
  ds_read_b128 v[40:43], v205 offset:43008
  v_mfma_f32_32x32x16_bf16 v[16:31], a[236:239], v[44:47], v[16:31]
  s_waitcnt lgkmcnt(2)
  v_mfma_f32_32x32x16_bf16 v[0:15], a[96:99], v[32:35], v[0:15]
  ds_read_b128 v[44:47], v206 offset:43008
  v_mfma_f32_32x32x16_bf16 v[16:31], a[240:243], v[32:35], v[16:31]
  s_waitcnt lgkmcnt(2)
  v_mfma_f32_32x32x16_bf16 v[0:15], a[100:103], v[36:39], v[0:15]
  ds_read_b128 v[32:35], v203 offset:44032
  v_mfma_f32_32x32x16_bf16 v[16:31], a[244:247], v[36:39], v[16:31]
  s_waitcnt lgkmcnt(2)
  v_mfma_f32_32x32x16_bf16 v[0:15], a[104:107], v[40:43], v[0:15]
  ds_read_b128 v[36:39], v204 offset:44032
  v_mfma_f32_32x32x16_bf16 v[16:31], a[248:251], v[40:43], v[16:31]
  s_waitcnt lgkmcnt(2)
  v_mfma_f32_32x32x16_bf16 v[0:15], a[108:111], v[44:47], v[0:15]
  ds_read_b128 v[40:43], v205 offset:44032
  v_mfma_f32_32x32x16_bf16 v[16:31], a[252:255], v[44:47], v[16:31]
  s_waitcnt lgkmcnt(2)
  v_mfma_f32_32x32x16_bf16 v[0:15], a[112:115], v[32:35], v[0:15]
  ds_read_b128 v[44:47], v206 offset:44032
  v_mfma_f32_32x32x16_bf16 v[16:31], v[224:227], v[32:35], v[16:31]
  s_waitcnt lgkmcnt(2)
  v_mfma_f32_32x32x16_bf16 v[0:15], a[116:119], v[36:39], v[0:15]
  ds_read_b128 v[32:35], v203 offset:45056
  v_mfma_f32_32x32x16_bf16 v[16:31], v[228:231], v[36:39], v[16:31]
  s_waitcnt lgkmcnt(2)
  v_mfma_f32_32x32x16_bf16 v[0:15], a[120:123], v[40:43], v[0:15]
  ds_read_b128 v[36:39], v204 offset:45056
  v_mfma_f32_32x32x16_bf16 v[16:31], v[232:235], v[40:43], v[16:31]
  s_waitcnt lgkmcnt(2)
  v_mfma_f32_32x32x16_bf16 v[0:15], a[124:127], v[44:47], v[0:15]
  ds_read_b128 v[40:43], v205 offset:45056
  v_mfma_f32_32x32x16_bf16 v[16:31], v[236:239], v[44:47], v[16:31]
  s_waitcnt lgkmcnt(2)
  v_mfma_f32_32x32x16_bf16 v[0:15], a[128:131], v[32:35], v[0:15]
  ds_read_b128 v[44:47], v206 offset:45056
  v_mfma_f32_32x32x16_bf16 v[16:31], v[240:243], v[32:35], v[16:31]
  s_waitcnt lgkmcnt(2)
  v_mfma_f32_32x32x16_bf16 v[0:15], a[132:135], v[36:39], v[0:15]
  v_mfma_f32_32x32x16_bf16 v[16:31], v[244:247], v[36:39], v[16:31]
  s_waitcnt lgkmcnt(1)
  v_mfma_f32_32x32x16_bf16 v[0:15], a[136:139], v[40:43], v[0:15]
  v_mfma_f32_32x32x16_bf16 v[16:31], v[248:251], v[40:43], v[16:31]
  s_waitcnt lgkmcnt(0)
  v_mfma_f32_32x32x16_bf16 v[0:15], a[140:143], v[44:47], v[0:15]
  v_mfma_f32_32x32x16_bf16 v[16:31], v[252:255], v[44:47], v[16:31]
  s_add_u32 s60, s60, 36864
  s_nop 2
  v_cvt_pk_bf16_f32 v48, v0, v1
  v_cvt_pk_bf16_f32 v49, v2, v3
  ds_write2_b32 v218, v48, v49 offset0:0 offset1:1
  v_cvt_pk_bf16_f32 v48, v4, v5
  v_cvt_pk_bf16_f32 v49, v6, v7
  ds_write2_b32 v218, v48, v49 offset0:4 offset1:5
  v_cvt_pk_bf16_f32 v48, v8, v9
  v_cvt_pk_bf16_f32 v49, v10, v11
  ds_write2_b32 v218, v48, v49 offset0:8 offset1:9
  v_cvt_pk_bf16_f32 v48, v12, v13
  v_cvt_pk_bf16_f32 v49, v14, v15
  ds_write2_b32 v218, v48, v49 offset0:12 offset1:13
  v_cvt_pk_bf16_f32 v48, v16, v17
  v_cvt_pk_bf16_f32 v49, v18, v19
  ds_write2_b32 v218, v48, v49 offset0:64 offset1:65
  v_cvt_pk_bf16_f32 v48, v20, v21
  v_cvt_pk_bf16_f32 v49, v22, v23
  ds_write2_b32 v218, v48, v49 offset0:68 offset1:69
  v_cvt_pk_bf16_f32 v48, v24, v25
  v_cvt_pk_bf16_f32 v49, v26, v27
  ds_write2_b32 v218, v48, v49 offset0:72 offset1:73
  v_cvt_pk_bf16_f32 v48, v28, v29
  v_cvt_pk_bf16_f32 v49, v30, v31
  ds_write2_b32 v218, v48, v49 offset0:76 offset1:77
  v_add_u32 v218, 16512, v218
  s_waitcnt vmcnt(0) lgkmcnt(0)
  s_barrier
  ds_read_b128 v[32:35], v203 offset:0
  ds_read_b128 v[36:39], v204 offset:0
  ds_read_b128 v[40:43], v205 offset:0
  s_waitcnt lgkmcnt(2)
  v_mfma_f32_32x32x16_bf16 v[0:15], a[0:3], v[32:35], 0
  ds_read_b128 v[44:47], v206 offset:0
  s_add_u32 m0, s67, 36864
  s_nop 0
  buffer_load_dwordx4 v202, s[4:7], s60 offen offset:0 lds
  v_mfma_f32_32x32x16_bf16 v[16:31], a[144:147], v[32:35], 0
  s_waitcnt lgkmcnt(2)
  v_mfma_f32_32x32x16_bf16 v[0:15], a[4:7], v[36:39], v[0:15]
  ds_read_b128 v[32:35], v203 offset:1024
  s_add_u32 m0, s67, 37760
  s_nop 0
  buffer_load_dwordx4 v202, s[4:7], s60 offen offset:128 lds
  v_mfma_f32_32x32x16_bf16 v[16:31], a[148:151], v[36:39], v[16:31]
  s_waitcnt lgkmcnt(2)
  v_mfma_f32_32x32x16_bf16 v[0:15], a[8:11], v[40:43], v[0:15]
  ds_read_b128 v[36:39], v204 offset:1024
  s_add_u32 m0, s67, 38656
  s_nop 0
  buffer_load_dwordx4 v202, s[4:7], s60 offen offset:256 lds
  v_mfma_f32_32x32x16_bf16 v[16:31], a[152:155], v[40:43], v[16:31]
  s_waitcnt lgkmcnt(2)
  v_mfma_f32_32x32x16_bf16 v[0:15], a[12:15], v[44:47], v[0:15]
  ds_read_b128 v[40:43], v205 offset:1024
  s_add_u32 m0, s67, 39552
  s_nop 0
  buffer_load_dwordx4 v202, s[4:7], s60 offen offset:384 lds
  v_mfma_f32_32x32x16_bf16 v[16:31], a[156:159], v[44:47], v[16:31]
  s_waitcnt lgkmcnt(2)
  v_mfma_f32_32x32x16_bf16 v[0:15], a[16:19], v[32:35], v[0:15]
  ds_read_b128 v[44:47], v206 offset:1024
  s_add_u32 m0, s67, 40448
  s_nop 0
  buffer_load_dwordx4 v202, s[4:7], s60 offen offset:512 lds
  v_mfma_f32_32x32x16_bf16 v[16:31], a[160:163], v[32:35], v[16:31]
  s_waitcnt lgkmcnt(2)
  v_mfma_f32_32x32x16_bf16 v[0:15], a[20:23], v[36:39], v[0:15]
  ds_read_b128 v[32:35], v203 offset:2048
  s_add_u32 m0, s67, 41344
  s_nop 0
  buffer_load_dwordx4 v202, s[4:7], s60 offen offset:640 lds
  v_mfma_f32_32x32x16_bf16 v[16:31], a[164:167], v[36:39], v[16:31]
  s_waitcnt lgkmcnt(2)
  v_mfma_f32_32x32x16_bf16 v[0:15], a[24:27], v[40:43], v[0:15]
  ds_read_b128 v[36:39], v204 offset:2048
  s_add_u32 m0, s67, 42240
  s_nop 0
  buffer_load_dwordx4 v202, s[4:7], s60 offen offset:768 lds
  v_mfma_f32_32x32x16_bf16 v[16:31], a[168:171], v[40:43], v[16:31]
  s_waitcnt lgkmcnt(2)
  v_mfma_f32_32x32x16_bf16 v[0:15], a[28:31], v[44:47], v[0:15]
  ds_read_b128 v[40:43], v205 offset:2048
  s_add_u32 m0, s67, 43136
  s_nop 0
  buffer_load_dwordx4 v202, s[4:7], s60 offen offset:896 lds
  v_mfma_f32_32x32x16_bf16 v[16:31], a[172:175], v[44:47], v[16:31]
  s_waitcnt lgkmcnt(2)
  v_mfma_f32_32x32x16_bf16 v[0:15], a[32:35], v[32:35], v[0:15]
  ds_read_b128 v[44:47], v206 offset:2048
  s_add_u32 m0, s67, 44032
  s_nop 0
  buffer_load_dwordx4 v202, s[4:7], s60 offen offset:1024 lds
  v_mfma_f32_32x32x16_bf16 v[16:31], a[176:179], v[32:35], v[16:31]
  s_waitcnt lgkmcnt(2)
  v_mfma_f32_32x32x16_bf16 v[0:15], a[36:39], v[36:39], v[0:15]
  ds_read_b128 v[32:35], v203 offset:3072
  v_mfma_f32_32x32x16_bf16 v[16:31], a[180:183], v[36:39], v[16:31]
  s_waitcnt lgkmcnt(2)
  v_mfma_f32_32x32x16_bf16 v[0:15], a[40:43], v[40:43], v[0:15]
  ds_read_b128 v[36:39], v204 offset:3072
  v_mfma_f32_32x32x16_bf16 v[16:31], a[184:187], v[40:43], v[16:31]
  s_waitcnt lgkmcnt(2)
  v_mfma_f32_32x32x16_bf16 v[0:15], a[44:47], v[44:47], v[0:15]
  ds_read_b128 v[40:43], v205 offset:3072
  v_mfma_f32_32x32x16_bf16 v[16:31], a[188:191], v[44:47], v[16:31]
  s_waitcnt lgkmcnt(2)
  v_mfma_f32_32x32x16_bf16 v[0:15], a[48:51], v[32:35], v[0:15]
  ds_read_b128 v[44:47], v206 offset:3072
  v_mfma_f32_32x32x16_bf16 v[16:31], a[192:195], v[32:35], v[16:31]
  s_waitcnt lgkmcnt(2)
  v_mfma_f32_32x32x16_bf16 v[0:15], a[52:55], v[36:39], v[0:15]
  ds_read_b128 v[32:35], v203 offset:4096
  v_mfma_f32_32x32x16_bf16 v[16:31], a[196:199], v[36:39], v[16:31]
  s_waitcnt lgkmcnt(2)
  v_mfma_f32_32x32x16_bf16 v[0:15], a[56:59], v[40:43], v[0:15]
  ds_read_b128 v[36:39], v204 offset:4096
  v_mfma_f32_32x32x16_bf16 v[16:31], a[200:203], v[40:43], v[16:31]
  s_waitcnt lgkmcnt(2)
  v_mfma_f32_32x32x16_bf16 v[0:15], a[60:63], v[44:47], v[0:15]
  ds_read_b128 v[40:43], v205 offset:4096
  v_mfma_f32_32x32x16_bf16 v[16:31], a[204:207], v[44:47], v[16:31]
  s_waitcnt lgkmcnt(2)
  v_mfma_f32_32x32x16_bf16 v[0:15], a[64:67], v[32:35], v[0:15]
  ds_read_b128 v[44:47], v206 offset:4096
  v_mfma_f32_32x32x16_bf16 v[16:31], a[208:211], v[32:35], v[16:31]
  s_waitcnt lgkmcnt(2)
  v_mfma_f32_32x32x16_bf16 v[0:15], a[68:71], v[36:39], v[0:15]
  ds_read_b128 v[32:35], v203 offset:5120
  v_mfma_f32_32x32x16_bf16 v[16:31], a[212:215], v[36:39], v[16:31]
  s_waitcnt lgkmcnt(2)
  v_mfma_f32_32x32x16_bf16 v[0:15], a[72:75], v[40:43], v[0:15]
  ds_read_b128 v[36:39], v204 offset:5120
  v_mfma_f32_32x32x16_bf16 v[16:31], a[216:219], v[40:43], v[16:31]
  s_waitcnt lgkmcnt(2)
  v_mfma_f32_32x32x16_bf16 v[0:15], a[76:79], v[44:47], v[0:15]
  ds_read_b128 v[40:43], v205 offset:5120
  v_mfma_f32_32x32x16_bf16 v[16:31], a[220:223], v[44:47], v[16:31]
  s_waitcnt lgkmcnt(2)
  v_mfma_f32_32x32x16_bf16 v[0:15], a[80:83], v[32:35], v[0:15]
  ds_read_b128 v[44:47], v206 offset:5120
  v_mfma_f32_32x32x16_bf16 v[16:31], a[224:227], v[32:35], v[16:31]
  s_waitcnt lgkmcnt(2)
  v_mfma_f32_32x32x16_bf16 v[0:15], a[84:87], v[36:39], v[0:15]
  ds_read_b128 v[32:35], v203 offset:6144
  v_mfma_f32_32x32x16_bf16 v[16:31], a[228:231], v[36:39], v[16:31]
  s_waitcnt lgkmcnt(2)
  v_mfma_f32_32x32x16_bf16 v[0:15], a[88:91], v[40:43], v[0:15]
  ds_read_b128 v[36:39], v204 offset:6144
  v_mfma_f32_32x32x16_bf16 v[16:31], a[232:235], v[40:43], v[16:31]
  s_waitcnt lgkmcnt(2)
  v_mfma_f32_32x32x16_bf16 v[0:15], a[92:95], v[44:47], v[0:15]
  ds_read_b128 v[40:43], v205 offset:6144
  v_mfma_f32_32x32x16_bf16 v[16:31], a[236:239], v[44:47], v[16:31]
  s_waitcnt lgkmcnt(2)
  v_mfma_f32_32x32x16_bf16 v[0:15], a[96:99], v[32:35], v[0:15]
  ds_read_b128 v[44:47], v206 offset:6144
  v_mfma_f32_32x32x16_bf16 v[16:31], a[240:243], v[32:35], v[16:31]
  s_waitcnt lgkmcnt(2)
  v_mfma_f32_32x32x16_bf16 v[0:15], a[100:103], v[36:39], v[0:15]
  ds_read_b128 v[32:35], v203 offset:7168
  v_mfma_f32_32x32x16_bf16 v[16:31], a[244:247], v[36:39], v[16:31]
  s_waitcnt lgkmcnt(2)
  v_mfma_f32_32x32x16_bf16 v[0:15], a[104:107], v[40:43], v[0:15]
  ds_read_b128 v[36:39], v204 offset:7168
  v_mfma_f32_32x32x16_bf16 v[16:31], a[248:251], v[40:43], v[16:31]
  s_waitcnt lgkmcnt(2)
  v_mfma_f32_32x32x16_bf16 v[0:15], a[108:111], v[44:47], v[0:15]
  ds_read_b128 v[40:43], v205 offset:7168
  v_mfma_f32_32x32x16_bf16 v[16:31], a[252:255], v[44:47], v[16:31]
  s_waitcnt lgkmcnt(2)
  v_mfma_f32_32x32x16_bf16 v[0:15], a[112:115], v[32:35], v[0:15]
  ds_read_b128 v[44:47], v206 offset:7168
  v_mfma_f32_32x32x16_bf16 v[16:31], v[224:227], v[32:35], v[16:31]
  s_waitcnt lgkmcnt(2)
  v_mfma_f32_32x32x16_bf16 v[0:15], a[116:119], v[36:39], v[0:15]
  ds_read_b128 v[32:35], v203 offset:8192
  v_mfma_f32_32x32x16_bf16 v[16:31], v[228:231], v[36:39], v[16:31]
  s_waitcnt lgkmcnt(2)
  v_mfma_f32_32x32x16_bf16 v[0:15], a[120:123], v[40:43], v[0:15]
  ds_read_b128 v[36:39], v204 offset:8192
  v_mfma_f32_32x32x16_bf16 v[16:31], v[232:235], v[40:43], v[16:31]
  s_waitcnt lgkmcnt(2)
  v_mfma_f32_32x32x16_bf16 v[0:15], a[124:127], v[44:47], v[0:15]
  ds_read_b128 v[40:43], v205 offset:8192
  v_mfma_f32_32x32x16_bf16 v[16:31], v[236:239], v[44:47], v[16:31]
  s_waitcnt lgkmcnt(2)
  v_mfma_f32_32x32x16_bf16 v[0:15], a[128:131], v[32:35], v[0:15]
  ds_read_b128 v[44:47], v206 offset:8192
  v_mfma_f32_32x32x16_bf16 v[16:31], v[240:243], v[32:35], v[16:31]
  s_waitcnt lgkmcnt(2)
  v_mfma_f32_32x32x16_bf16 v[0:15], a[132:135], v[36:39], v[0:15]
  v_mfma_f32_32x32x16_bf16 v[16:31], v[244:247], v[36:39], v[16:31]
  s_waitcnt lgkmcnt(1)
  v_mfma_f32_32x32x16_bf16 v[0:15], a[136:139], v[40:43], v[0:15]
  v_mfma_f32_32x32x16_bf16 v[16:31], v[248:251], v[40:43], v[16:31]
  s_waitcnt lgkmcnt(0)
  v_mfma_f32_32x32x16_bf16 v[0:15], a[140:143], v[44:47], v[0:15]
  v_mfma_f32_32x32x16_bf16 v[16:31], v[252:255], v[44:47], v[16:31]
  s_add_u32 s60, s60, 36864
  s_nop 2
  v_cvt_pk_bf16_f32 v48, v0, v1
  v_cvt_pk_bf16_f32 v49, v2, v3
  ds_write2_b32 v218, v48, v49 offset0:0 offset1:1
  v_cvt_pk_bf16_f32 v48, v4, v5
  v_cvt_pk_bf16_f32 v49, v6, v7
  ds_write2_b32 v218, v48, v49 offset0:4 offset1:5
  v_cvt_pk_bf16_f32 v48, v8, v9
  v_cvt_pk_bf16_f32 v49, v10, v11
  ds_write2_b32 v218, v48, v49 offset0:8 offset1:9
  v_cvt_pk_bf16_f32 v48, v12, v13
  v_cvt_pk_bf16_f32 v49, v14, v15
  ds_write2_b32 v218, v48, v49 offset0:12 offset1:13
  v_cvt_pk_bf16_f32 v48, v16, v17
  v_cvt_pk_bf16_f32 v49, v18, v19
  ds_write2_b32 v218, v48, v49 offset0:64 offset1:65
  v_cvt_pk_bf16_f32 v48, v20, v21
  v_cvt_pk_bf16_f32 v49, v22, v23
  ds_write2_b32 v218, v48, v49 offset0:68 offset1:69
  v_cvt_pk_bf16_f32 v48, v24, v25
  v_cvt_pk_bf16_f32 v49, v26, v27
  ds_write2_b32 v218, v48, v49 offset0:72 offset1:73
  v_cvt_pk_bf16_f32 v48, v28, v29
  v_cvt_pk_bf16_f32 v49, v30, v31
  ds_write2_b32 v218, v48, v49 offset0:76 offset1:77
  v_add_u32 v218, 16512, v218
  s_waitcnt vmcnt(0) lgkmcnt(0)
  s_barrier
  ds_read_b128 v[32:35], v203 offset:36864
  ds_read_b128 v[36:39], v204 offset:36864
  ds_read_b128 v[40:43], v205 offset:36864
  s_waitcnt lgkmcnt(2)
  v_mfma_f32_32x32x16_bf16 v[0:15], a[0:3], v[32:35], 0
  ds_read_b128 v[44:47], v206 offset:36864
  s_add_u32 m0, s67, 0
  s_nop 0
  buffer_load_dwordx4 v202, s[4:7], s60 offen offset:0 lds
  v_mfma_f32_32x32x16_bf16 v[16:31], a[144:147], v[32:35], 0
  s_waitcnt lgkmcnt(2)
  v_mfma_f32_32x32x16_bf16 v[0:15], a[4:7], v[36:39], v[0:15]
  ds_read_b128 v[32:35], v203 offset:37888
  s_add_u32 m0, s67, 896
  s_nop 0
  buffer_load_dwordx4 v202, s[4:7], s60 offen offset:128 lds
  v_mfma_f32_32x32x16_bf16 v[16:31], a[148:151], v[36:39], v[16:31]
  s_waitcnt lgkmcnt(2)
  v_mfma_f32_32x32x16_bf16 v[0:15], a[8:11], v[40:43], v[0:15]
  ds_read_b128 v[36:39], v204 offset:37888
  s_add_u32 m0, s67, 1792
  s_nop 0
  buffer_load_dwordx4 v202, s[4:7], s60 offen offset:256 lds
  v_mfma_f32_32x32x16_bf16 v[16:31], a[152:155], v[40:43], v[16:31]
  s_waitcnt lgkmcnt(2)
  v_mfma_f32_32x32x16_bf16 v[0:15], a[12:15], v[44:47], v[0:15]
  ds_read_b128 v[40:43], v205 offset:37888
  s_add_u32 m0, s67, 2688
  s_nop 0
  buffer_load_dwordx4 v202, s[4:7], s60 offen offset:384 lds
  v_mfma_f32_32x32x16_bf16 v[16:31], a[156:159], v[44:47], v[16:31]
  s_waitcnt lgkmcnt(2)
  v_mfma_f32_32x32x16_bf16 v[0:15], a[16:19], v[32:35], v[0:15]
  ds_read_b128 v[44:47], v206 offset:37888
  s_add_u32 m0, s67, 3584
  s_nop 0
  buffer_load_dwordx4 v202, s[4:7], s60 offen offset:512 lds
  v_mfma_f32_32x32x16_bf16 v[16:31], a[160:163], v[32:35], v[16:31]
  s_waitcnt lgkmcnt(2)
  v_mfma_f32_32x32x16_bf16 v[0:15], a[20:23], v[36:39], v[0:15]
  ds_read_b128 v[32:35], v203 offset:38912
  s_add_u32 m0, s67, 4480
  s_nop 0
  buffer_load_dwordx4 v202, s[4:7], s60 offen offset:640 lds
  v_mfma_f32_32x32x16_bf16 v[16:31], a[164:167], v[36:39], v[16:31]
  s_waitcnt lgkmcnt(2)
  v_mfma_f32_32x32x16_bf16 v[0:15], a[24:27], v[40:43], v[0:15]
  ds_read_b128 v[36:39], v204 offset:38912
  s_add_u32 m0, s67, 5376
  s_nop 0
  buffer_load_dwordx4 v202, s[4:7], s60 offen offset:768 lds
  v_mfma_f32_32x32x16_bf16 v[16:31], a[168:171], v[40:43], v[16:31]
  s_waitcnt lgkmcnt(2)
  v_mfma_f32_32x32x16_bf16 v[0:15], a[28:31], v[44:47], v[0:15]
  ds_read_b128 v[40:43], v205 offset:38912
  s_add_u32 m0, s67, 6272
  s_nop 0
  buffer_load_dwordx4 v202, s[4:7], s60 offen offset:896 lds
  v_mfma_f32_32x32x16_bf16 v[16:31], a[172:175], v[44:47], v[16:31]
  s_waitcnt lgkmcnt(2)
  v_mfma_f32_32x32x16_bf16 v[0:15], a[32:35], v[32:35], v[0:15]
  ds_read_b128 v[44:47], v206 offset:38912
  s_add_u32 m0, s67, 7168
  s_nop 0
  buffer_load_dwordx4 v202, s[4:7], s60 offen offset:1024 lds
  v_mfma_f32_32x32x16_bf16 v[16:31], a[176:179], v[32:35], v[16:31]
  s_waitcnt lgkmcnt(2)
  v_mfma_f32_32x32x16_bf16 v[0:15], a[36:39], v[36:39], v[0:15]
  ds_read_b128 v[32:35], v203 offset:39936
  v_mfma_f32_32x32x16_bf16 v[16:31], a[180:183], v[36:39], v[16:31]
  s_waitcnt lgkmcnt(2)
  v_mfma_f32_32x32x16_bf16 v[0:15], a[40:43], v[40:43], v[0:15]
  ds_read_b128 v[36:39], v204 offset:39936
  v_mfma_f32_32x32x16_bf16 v[16:31], a[184:187], v[40:43], v[16:31]
  s_waitcnt lgkmcnt(2)
  v_mfma_f32_32x32x16_bf16 v[0:15], a[44:47], v[44:47], v[0:15]
  ds_read_b128 v[40:43], v205 offset:39936
  v_mfma_f32_32x32x16_bf16 v[16:31], a[188:191], v[44:47], v[16:31]
  s_waitcnt lgkmcnt(2)
  v_mfma_f32_32x32x16_bf16 v[0:15], a[48:51], v[32:35], v[0:15]
  ds_read_b128 v[44:47], v206 offset:39936
  v_mfma_f32_32x32x16_bf16 v[16:31], a[192:195], v[32:35], v[16:31]
  s_waitcnt lgkmcnt(2)
  v_mfma_f32_32x32x16_bf16 v[0:15], a[52:55], v[36:39], v[0:15]
  ds_read_b128 v[32:35], v203 offset:40960
  v_mfma_f32_32x32x16_bf16 v[16:31], a[196:199], v[36:39], v[16:31]
  s_waitcnt lgkmcnt(2)
  v_mfma_f32_32x32x16_bf16 v[0:15], a[56:59], v[40:43], v[0:15]
  ds_read_b128 v[36:39], v204 offset:40960
  v_mfma_f32_32x32x16_bf16 v[16:31], a[200:203], v[40:43], v[16:31]
  s_waitcnt lgkmcnt(2)
  v_mfma_f32_32x32x16_bf16 v[0:15], a[60:63], v[44:47], v[0:15]
  ds_read_b128 v[40:43], v205 offset:40960
  v_mfma_f32_32x32x16_bf16 v[16:31], a[204:207], v[44:47], v[16:31]
  s_waitcnt lgkmcnt(2)
  v_mfma_f32_32x32x16_bf16 v[0:15], a[64:67], v[32:35], v[0:15]
  ds_read_b128 v[44:47], v206 offset:40960
  v_mfma_f32_32x32x16_bf16 v[16:31], a[208:211], v[32:35], v[16:31]
  s_waitcnt lgkmcnt(2)
  v_mfma_f32_32x32x16_bf16 v[0:15], a[68:71], v[36:39], v[0:15]
  ds_read_b128 v[32:35], v203 offset:41984
  v_mfma_f32_32x32x16_bf16 v[16:31], a[212:215], v[36:39], v[16:31]
  s_waitcnt lgkmcnt(2)
  v_mfma_f32_32x32x16_bf16 v[0:15], a[72:75], v[40:43], v[0:15]
  ds_read_b128 v[36:39], v204 offset:41984
  v_mfma_f32_32x32x16_bf16 v[16:31], a[216:219], v[40:43], v[16:31]
  s_waitcnt lgkmcnt(2)
  v_mfma_f32_32x32x16_bf16 v[0:15], a[76:79], v[44:47], v[0:15]
  ds_read_b128 v[40:43], v205 offset:41984
  v_mfma_f32_32x32x16_bf16 v[16:31], a[220:223], v[44:47], v[16:31]
  s_waitcnt lgkmcnt(2)
  v_mfma_f32_32x32x16_bf16 v[0:15], a[80:83], v[32:35], v[0:15]
  ds_read_b128 v[44:47], v206 offset:41984
  v_mfma_f32_32x32x16_bf16 v[16:31], a[224:227], v[32:35], v[16:31]
  s_waitcnt lgkmcnt(2)
  v_mfma_f32_32x32x16_bf16 v[0:15], a[84:87], v[36:39], v[0:15]
  ds_read_b128 v[32:35], v203 offset:43008
  v_mfma_f32_32x32x16_bf16 v[16:31], a[228:231], v[36:39], v[16:31]
  s_waitcnt lgkmcnt(2)
  v_mfma_f32_32x32x16_bf16 v[0:15], a[88:91], v[40:43], v[0:15]
  ds_read_b128 v[36:39], v204 offset:43008
  v_mfma_f32_32x32x16_bf16 v[16:31], a[232:235], v[40:43], v[16:31]
  s_waitcnt lgkmcnt(2)
  v_mfma_f32_32x32x16_bf16 v[0:15], a[92:95], v[44:47], v[0:15]
  ds_read_b128 v[40:43], v205 offset:43008
  v_mfma_f32_32x32x16_bf16 v[16:31], a[236:239], v[44:47], v[16:31]
  s_waitcnt lgkmcnt(2)
  v_mfma_f32_32x32x16_bf16 v[0:15], a[96:99], v[32:35], v[0:15]
  ds_read_b128 v[44:47], v206 offset:43008
  v_mfma_f32_32x32x16_bf16 v[16:31], a[240:243], v[32:35], v[16:31]
  s_waitcnt lgkmcnt(2)
  v_mfma_f32_32x32x16_bf16 v[0:15], a[100:103], v[36:39], v[0:15]
  ds_read_b128 v[32:35], v203 offset:44032
  v_mfma_f32_32x32x16_bf16 v[16:31], a[244:247], v[36:39], v[16:31]
  s_waitcnt lgkmcnt(2)
  v_mfma_f32_32x32x16_bf16 v[0:15], a[104:107], v[40:43], v[0:15]
  ds_read_b128 v[36:39], v204 offset:44032
  v_mfma_f32_32x32x16_bf16 v[16:31], a[248:251], v[40:43], v[16:31]
  s_waitcnt lgkmcnt(2)
  v_mfma_f32_32x32x16_bf16 v[0:15], a[108:111], v[44:47], v[0:15]
  ds_read_b128 v[40:43], v205 offset:44032
  v_mfma_f32_32x32x16_bf16 v[16:31], a[252:255], v[44:47], v[16:31]
  s_waitcnt lgkmcnt(2)
  v_mfma_f32_32x32x16_bf16 v[0:15], a[112:115], v[32:35], v[0:15]
  ds_read_b128 v[44:47], v206 offset:44032
  v_mfma_f32_32x32x16_bf16 v[16:31], v[224:227], v[32:35], v[16:31]
  s_waitcnt lgkmcnt(2)
  v_mfma_f32_32x32x16_bf16 v[0:15], a[116:119], v[36:39], v[0:15]
  ds_read_b128 v[32:35], v203 offset:45056
  v_mfma_f32_32x32x16_bf16 v[16:31], v[228:231], v[36:39], v[16:31]
  s_waitcnt lgkmcnt(2)
  v_mfma_f32_32x32x16_bf16 v[0:15], a[120:123], v[40:43], v[0:15]
  ds_read_b128 v[36:39], v204 offset:45056
  v_mfma_f32_32x32x16_bf16 v[16:31], v[232:235], v[40:43], v[16:31]
  s_waitcnt lgkmcnt(2)
  v_mfma_f32_32x32x16_bf16 v[0:15], a[124:127], v[44:47], v[0:15]
  ds_read_b128 v[40:43], v205 offset:45056
  v_mfma_f32_32x32x16_bf16 v[16:31], v[236:239], v[44:47], v[16:31]
  s_waitcnt lgkmcnt(2)
  v_mfma_f32_32x32x16_bf16 v[0:15], a[128:131], v[32:35], v[0:15]
  ds_read_b128 v[44:47], v206 offset:45056
  v_mfma_f32_32x32x16_bf16 v[16:31], v[240:243], v[32:35], v[16:31]
  s_waitcnt lgkmcnt(2)
  v_mfma_f32_32x32x16_bf16 v[0:15], a[132:135], v[36:39], v[0:15]
  v_mfma_f32_32x32x16_bf16 v[16:31], v[244:247], v[36:39], v[16:31]
  s_waitcnt lgkmcnt(1)
  v_mfma_f32_32x32x16_bf16 v[0:15], a[136:139], v[40:43], v[0:15]
  v_mfma_f32_32x32x16_bf16 v[16:31], v[248:251], v[40:43], v[16:31]
  s_waitcnt lgkmcnt(0)
  v_mfma_f32_32x32x16_bf16 v[0:15], a[140:143], v[44:47], v[0:15]
  v_mfma_f32_32x32x16_bf16 v[16:31], v[252:255], v[44:47], v[16:31]
  s_add_u32 s60, s60, 36864
  s_nop 2
  v_cvt_pk_bf16_f32 v48, v0, v1
  v_cvt_pk_bf16_f32 v49, v2, v3
  ds_write2_b32 v218, v48, v49 offset0:0 offset1:1
  v_cvt_pk_bf16_f32 v48, v4, v5
  v_cvt_pk_bf16_f32 v49, v6, v7
  ds_write2_b32 v218, v48, v49 offset0:4 offset1:5
  v_cvt_pk_bf16_f32 v48, v8, v9
  v_cvt_pk_bf16_f32 v49, v10, v11
  ds_write2_b32 v218, v48, v49 offset0:8 offset1:9
  v_cvt_pk_bf16_f32 v48, v12, v13
  v_cvt_pk_bf16_f32 v49, v14, v15
  ds_write2_b32 v218, v48, v49 offset0:12 offset1:13
  v_cvt_pk_bf16_f32 v48, v16, v17
  v_cvt_pk_bf16_f32 v49, v18, v19
  ds_write2_b32 v218, v48, v49 offset0:64 offset1:65
  v_cvt_pk_bf16_f32 v48, v20, v21
  v_cvt_pk_bf16_f32 v49, v22, v23
  ds_write2_b32 v218, v48, v49 offset0:68 offset1:69
  v_cvt_pk_bf16_f32 v48, v24, v25
  v_cvt_pk_bf16_f32 v49, v26, v27
  ds_write2_b32 v218, v48, v49 offset0:72 offset1:73
  v_cvt_pk_bf16_f32 v48, v28, v29
  v_cvt_pk_bf16_f32 v49, v30, v31
  ds_write2_b32 v218, v48, v49 offset0:76 offset1:77
  v_add_u32 v218, 16512, v218
  s_waitcnt vmcnt(0) lgkmcnt(0)
  s_barrier
  ds_read_b128 v[32:35], v203 offset:0
  ds_read_b128 v[36:39], v204 offset:0
  ds_read_b128 v[40:43], v205 offset:0
  s_waitcnt lgkmcnt(2)
  v_mfma_f32_32x32x16_bf16 v[0:15], a[0:3], v[32:35], 0
  ds_read_b128 v[44:47], v206 offset:0
  v_mfma_f32_32x32x16_bf16 v[16:31], a[144:147], v[32:35], 0
  s_waitcnt lgkmcnt(2)
  v_mfma_f32_32x32x16_bf16 v[0:15], a[4:7], v[36:39], v[0:15]
  ds_read_b128 v[32:35], v203 offset:1024
  v_mfma_f32_32x32x16_bf16 v[16:31], a[148:151], v[36:39], v[16:31]
  s_waitcnt lgkmcnt(2)
  v_mfma_f32_32x32x16_bf16 v[0:15], a[8:11], v[40:43], v[0:15]
  ds_read_b128 v[36:39], v204 offset:1024
  v_mfma_f32_32x32x16_bf16 v[16:31], a[152:155], v[40:43], v[16:31]
  s_waitcnt lgkmcnt(2)
  v_mfma_f32_32x32x16_bf16 v[0:15], a[12:15], v[44:47], v[0:15]
  ds_read_b128 v[40:43], v205 offset:1024
  v_mfma_f32_32x32x16_bf16 v[16:31], a[156:159], v[44:47], v[16:31]
  s_waitcnt lgkmcnt(2)
  v_mfma_f32_32x32x16_bf16 v[0:15], a[16:19], v[32:35], v[0:15]
  ds_read_b128 v[44:47], v206 offset:1024
  v_mfma_f32_32x32x16_bf16 v[16:31], a[160:163], v[32:35], v[16:31]
  s_waitcnt lgkmcnt(2)
  v_mfma_f32_32x32x16_bf16 v[0:15], a[20:23], v[36:39], v[0:15]
  ds_read_b128 v[32:35], v203 offset:2048
  v_mfma_f32_32x32x16_bf16 v[16:31], a[164:167], v[36:39], v[16:31]
  s_waitcnt lgkmcnt(2)
  v_mfma_f32_32x32x16_bf16 v[0:15], a[24:27], v[40:43], v[0:15]
  ds_read_b128 v[36:39], v204 offset:2048
  v_mfma_f32_32x32x16_bf16 v[16:31], a[168:171], v[40:43], v[16:31]
  s_waitcnt lgkmcnt(2)
  v_mfma_f32_32x32x16_bf16 v[0:15], a[28:31], v[44:47], v[0:15]
  ds_read_b128 v[40:43], v205 offset:2048
  v_mfma_f32_32x32x16_bf16 v[16:31], a[172:175], v[44:47], v[16:31]
  s_waitcnt lgkmcnt(2)
  v_mfma_f32_32x32x16_bf16 v[0:15], a[32:35], v[32:35], v[0:15]
  ds_read_b128 v[44:47], v206 offset:2048
  v_mfma_f32_32x32x16_bf16 v[16:31], a[176:179], v[32:35], v[16:31]
  s_waitcnt lgkmcnt(2)
  v_mfma_f32_32x32x16_bf16 v[0:15], a[36:39], v[36:39], v[0:15]
  ds_read_b128 v[32:35], v203 offset:3072
  v_mfma_f32_32x32x16_bf16 v[16:31], a[180:183], v[36:39], v[16:31]
  s_waitcnt lgkmcnt(2)
  v_mfma_f32_32x32x16_bf16 v[0:15], a[40:43], v[40:43], v[0:15]
  ds_read_b128 v[36:39], v204 offset:3072
  v_mfma_f32_32x32x16_bf16 v[16:31], a[184:187], v[40:43], v[16:31]
  s_waitcnt lgkmcnt(2)
  v_mfma_f32_32x32x16_bf16 v[0:15], a[44:47], v[44:47], v[0:15]
  ds_read_b128 v[40:43], v205 offset:3072
  v_mfma_f32_32x32x16_bf16 v[16:31], a[188:191], v[44:47], v[16:31]
  s_waitcnt lgkmcnt(2)
  v_mfma_f32_32x32x16_bf16 v[0:15], a[48:51], v[32:35], v[0:15]
  ds_read_b128 v[44:47], v206 offset:3072
  v_mfma_f32_32x32x16_bf16 v[16:31], a[192:195], v[32:35], v[16:31]
  s_waitcnt lgkmcnt(2)
  v_mfma_f32_32x32x16_bf16 v[0:15], a[52:55], v[36:39], v[0:15]
  ds_read_b128 v[32:35], v203 offset:4096
  v_mfma_f32_32x32x16_bf16 v[16:31], a[196:199], v[36:39], v[16:31]
  s_waitcnt lgkmcnt(2)
  v_mfma_f32_32x32x16_bf16 v[0:15], a[56:59], v[40:43], v[0:15]
  ds_read_b128 v[36:39], v204 offset:4096
  v_mfma_f32_32x32x16_bf16 v[16:31], a[200:203], v[40:43], v[16:31]
  s_waitcnt lgkmcnt(2)
  v_mfma_f32_32x32x16_bf16 v[0:15], a[60:63], v[44:47], v[0:15]
  ds_read_b128 v[40:43], v205 offset:4096
  v_mfma_f32_32x32x16_bf16 v[16:31], a[204:207], v[44:47], v[16:31]
  s_waitcnt lgkmcnt(2)
  v_mfma_f32_32x32x16_bf16 v[0:15], a[64:67], v[32:35], v[0:15]
  ds_read_b128 v[44:47], v206 offset:4096
  v_mfma_f32_32x32x16_bf16 v[16:31], a[208:211], v[32:35], v[16:31]
  s_waitcnt lgkmcnt(2)
  v_mfma_f32_32x32x16_bf16 v[0:15], a[68:71], v[36:39], v[0:15]
  ds_read_b128 v[32:35], v203 offset:5120
  v_mfma_f32_32x32x16_bf16 v[16:31], a[212:215], v[36:39], v[16:31]
  s_waitcnt lgkmcnt(2)
  v_mfma_f32_32x32x16_bf16 v[0:15], a[72:75], v[40:43], v[0:15]
  ds_read_b128 v[36:39], v204 offset:5120
  v_mfma_f32_32x32x16_bf16 v[16:31], a[216:219], v[40:43], v[16:31]
  s_waitcnt lgkmcnt(2)
  v_mfma_f32_32x32x16_bf16 v[0:15], a[76:79], v[44:47], v[0:15]
  ds_read_b128 v[40:43], v205 offset:5120
  v_mfma_f32_32x32x16_bf16 v[16:31], a[220:223], v[44:47], v[16:31]
  s_waitcnt lgkmcnt(2)
  v_mfma_f32_32x32x16_bf16 v[0:15], a[80:83], v[32:35], v[0:15]
  ds_read_b128 v[44:47], v206 offset:5120
  v_mfma_f32_32x32x16_bf16 v[16:31], a[224:227], v[32:35], v[16:31]
  s_waitcnt lgkmcnt(2)
  v_mfma_f32_32x32x16_bf16 v[0:15], a[84:87], v[36:39], v[0:15]
  ds_read_b128 v[32:35], v203 offset:6144
  v_mfma_f32_32x32x16_bf16 v[16:31], a[228:231], v[36:39], v[16:31]
  s_waitcnt lgkmcnt(2)
  v_mfma_f32_32x32x16_bf16 v[0:15], a[88:91], v[40:43], v[0:15]
  ds_read_b128 v[36:39], v204 offset:6144
  v_mfma_f32_32x32x16_bf16 v[16:31], a[232:235], v[40:43], v[16:31]
  s_waitcnt lgkmcnt(2)
  v_mfma_f32_32x32x16_bf16 v[0:15], a[92:95], v[44:47], v[0:15]
  ds_read_b128 v[40:43], v205 offset:6144
  v_mfma_f32_32x32x16_bf16 v[16:31], a[236:239], v[44:47], v[16:31]
  s_waitcnt lgkmcnt(2)
  v_mfma_f32_32x32x16_bf16 v[0:15], a[96:99], v[32:35], v[0:15]
  ds_read_b128 v[44:47], v206 offset:6144
  v_mfma_f32_32x32x16_bf16 v[16:31], a[240:243], v[32:35], v[16:31]
  s_waitcnt lgkmcnt(2)
  v_mfma_f32_32x32x16_bf16 v[0:15], a[100:103], v[36:39], v[0:15]
  ds_read_b128 v[32:35], v203 offset:7168
  v_mfma_f32_32x32x16_bf16 v[16:31], a[244:247], v[36:39], v[16:31]
  s_waitcnt lgkmcnt(2)
  v_mfma_f32_32x32x16_bf16 v[0:15], a[104:107], v[40:43], v[0:15]
  ds_read_b128 v[36:39], v204 offset:7168
  v_mfma_f32_32x32x16_bf16 v[16:31], a[248:251], v[40:43], v[16:31]
  s_waitcnt lgkmcnt(2)
  v_mfma_f32_32x32x16_bf16 v[0:15], a[108:111], v[44:47], v[0:15]
  ds_read_b128 v[40:43], v205 offset:7168
  v_mfma_f32_32x32x16_bf16 v[16:31], a[252:255], v[44:47], v[16:31]
  s_waitcnt lgkmcnt(2)
  v_mfma_f32_32x32x16_bf16 v[0:15], a[112:115], v[32:35], v[0:15]
  ds_read_b128 v[44:47], v206 offset:7168
  v_mfma_f32_32x32x16_bf16 v[16:31], v[224:227], v[32:35], v[16:31]
  s_waitcnt lgkmcnt(2)
  v_mfma_f32_32x32x16_bf16 v[0:15], a[116:119], v[36:39], v[0:15]
  ds_read_b128 v[32:35], v203 offset:8192
  v_mfma_f32_32x32x16_bf16 v[16:31], v[228:231], v[36:39], v[16:31]
  s_waitcnt lgkmcnt(2)
  v_mfma_f32_32x32x16_bf16 v[0:15], a[120:123], v[40:43], v[0:15]
  ds_read_b128 v[36:39], v204 offset:8192
  v_mfma_f32_32x32x16_bf16 v[16:31], v[232:235], v[40:43], v[16:31]
  s_waitcnt lgkmcnt(2)
  v_mfma_f32_32x32x16_bf16 v[0:15], a[124:127], v[44:47], v[0:15]
  ds_read_b128 v[40:43], v205 offset:8192
  v_mfma_f32_32x32x16_bf16 v[16:31], v[236:239], v[44:47], v[16:31]
  s_waitcnt lgkmcnt(2)
  v_mfma_f32_32x32x16_bf16 v[0:15], a[128:131], v[32:35], v[0:15]
  ds_read_b128 v[44:47], v206 offset:8192
  v_mfma_f32_32x32x16_bf16 v[16:31], v[240:243], v[32:35], v[16:31]
  s_waitcnt lgkmcnt(2)
  v_mfma_f32_32x32x16_bf16 v[0:15], a[132:135], v[36:39], v[0:15]
  v_mfma_f32_32x32x16_bf16 v[16:31], v[244:247], v[36:39], v[16:31]
  s_waitcnt lgkmcnt(1)
  v_mfma_f32_32x32x16_bf16 v[0:15], a[136:139], v[40:43], v[0:15]
  v_mfma_f32_32x32x16_bf16 v[16:31], v[248:251], v[40:43], v[16:31]
  s_waitcnt lgkmcnt(0)
  v_mfma_f32_32x32x16_bf16 v[0:15], a[140:143], v[44:47], v[0:15]
  v_mfma_f32_32x32x16_bf16 v[16:31], v[252:255], v[44:47], v[16:31]
  s_add_u32 s60, s60, 36864
  s_nop 2
  v_cvt_pk_bf16_f32 v48, v0, v1
  v_cvt_pk_bf16_f32 v49, v2, v3
  ds_write2_b32 v218, v48, v49 offset0:0 offset1:1
  v_cvt_pk_bf16_f32 v48, v4, v5
  v_cvt_pk_bf16_f32 v49, v6, v7
  ds_write2_b32 v218, v48, v49 offset0:4 offset1:5
  v_cvt_pk_bf16_f32 v48, v8, v9
  v_cvt_pk_bf16_f32 v49, v10, v11
  ds_write2_b32 v218, v48, v49 offset0:8 offset1:9
  v_cvt_pk_bf16_f32 v48, v12, v13
  v_cvt_pk_bf16_f32 v49, v14, v15
  ds_write2_b32 v218, v48, v49 offset0:12 offset1:13
  v_cvt_pk_bf16_f32 v48, v16, v17
  v_cvt_pk_bf16_f32 v49, v18, v19
  ds_write2_b32 v218, v48, v49 offset0:64 offset1:65
  v_cvt_pk_bf16_f32 v48, v20, v21
  v_cvt_pk_bf16_f32 v49, v22, v23
  ds_write2_b32 v218, v48, v49 offset0:68 offset1:69
  v_cvt_pk_bf16_f32 v48, v24, v25
  v_cvt_pk_bf16_f32 v49, v26, v27
  ds_write2_b32 v218, v48, v49 offset0:72 offset1:73
  v_cvt_pk_bf16_f32 v48, v28, v29
  v_cvt_pk_bf16_f32 v49, v30, v31
  ds_write2_b32 v218, v48, v49 offset0:76 offset1:77
  v_add_u32 v218, 16512, v218
  s_waitcnt vmcnt(0) lgkmcnt(0)
  s_barrier
  v_mul_u32_u24 v219, 516, v200
  s_mul_i32 s54, s52, 36
  s_add_u32 s55, s54, 83016
  v_add_u32 v219, s55, v219
  v_mul_u32_u24 v220, 1152, v200
  s_mul_i32 s55, s68, 144
  s_add_u32 s54, s54, s55
  s_mul_i32 s55, s69, 147456
  s_add_u32 s64, s54, s55
  s_add_u32 s64, s64, 62914560
  s_lshl_b32 s66, s69, 7
  s_mov_b32 s57, 1051597459
  ds_read_b32 v0, v219 offset:7224
  ds_read_b32 v1, v219 offset:7228
  ds_read_b32 v2, v219 offset:7232
  ds_read_b32 v3, v219 offset:7236
  ds_read_b32 v4, v219 offset:7240
  ds_read_b32 v5, v219 offset:7244
  ds_read_b32 v6, v219 offset:7248
  ds_read_b32 v7, v219 offset:7252
  ds_read_b32 v8, v219 offset:7256
  ds_read_b32 v16, v219 offset:7368
  ds_read_b32 v17, v219 offset:7372
  ds_read_b32 v18, v219 offset:7376
  ds_read_b32 v19, v219 offset:7380
  ds_read_b32 v20, v219 offset:7384
  ds_read_b32 v21, v219 offset:7388
  ds_read_b32 v22, v219 offset:7392
  ds_read_b32 v23, v219 offset:7396
  ds_read_b32 v24, v219 offset:7400
  ds_read_b32 v25, v219 offset:6336
  ds_read_b32 v26, v219 offset:6340
  ds_read_b32 v27, v219 offset:6344
  ds_read_b32 v28, v219 offset:6348
  ds_read_b32 v29, v219 offset:6352
  ds_read_b32 v30, v219 offset:6356
  ds_read_b32 v31, v219 offset:6360
  ds_read_b32 v32, v219 offset:6364
  ds_read_b32 v33, v219 offset:6368
  ds_read_b32 v34, v219 offset:5304
  ds_read_b32 v35, v219 offset:5308
  ds_read_b32 v36, v219 offset:5312
  ds_read_b32 v37, v219 offset:5316
  ds_read_b32 v38, v219 offset:5320
  ds_read_b32 v39, v219 offset:5324
  ds_read_b32 v40, v219 offset:5328
  ds_read_b32 v41, v219 offset:5332
  ds_read_b32 v42, v219 offset:5336
  ds_read_b32 v43, v219 offset:4272
  ds_read_b32 v44, v219 offset:4276
  ds_read_b32 v45, v219 offset:4280
  ds_read_b32 v46, v219 offset:4284
  ds_read_b32 v47, v219 offset:4288
  ds_read_b32 v48, v219 offset:4292
  ds_read_b32 v49, v219 offset:4296
  ds_read_b32 v50, v219 offset:4300
  ds_read_b32 v51, v219 offset:4304
  ds_read_b32 v52, v219 offset:3240
  ds_read_b32 v53, v219 offset:3244
  ds_read_b32 v54, v219 offset:3248
  ds_read_b32 v55, v219 offset:3252
  ds_read_b32 v56, v219 offset:3256
  ds_read_b32 v57, v219 offset:3260
  ds_read_b32 v58, v219 offset:3264
  ds_read_b32 v59, v219 offset:3268
  ds_read_b32 v60, v219 offset:3272
  ds_read_b32 v61, v219 offset:2208
  ds_read_b32 v62, v219 offset:2212
  ds_read_b32 v63, v219 offset:2216
  ds_read_b32 v64, v219 offset:2220
  ds_read_b32 v65, v219 offset:2224
  ds_read_b32 v66, v219 offset:2228
  ds_read_b32 v67, v219 offset:2232
  ds_read_b32 v68, v219 offset:2236
  ds_read_b32 v69, v219 offset:2240
  ds_read_b32 v70, v219 offset:1176
  ds_read_b32 v71, v219 offset:1180
  ds_read_b32 v72, v219 offset:1184
  ds_read_b32 v73, v219 offset:1188
  ds_read_b32 v74, v219 offset:1192
  ds_read_b32 v75, v219 offset:1196
  ds_read_b32 v76, v219 offset:1200
  ds_read_b32 v77, v219 offset:1204
  ds_read_b32 v78, v219 offset:1208
  ds_read_b32 v79, v219 offset:144
  ds_read_b32 v80, v219 offset:148
  ds_read_b32 v81, v219 offset:152
  ds_read_b32 v82, v219 offset:156
  ds_read_b32 v83, v219 offset:160
  ds_read_b32 v84, v219 offset:164
  ds_read_b32 v85, v219 offset:168
  ds_read_b32 v86, v219 offset:172
  ds_read_b32 v87, v219 offset:176
  v_mov_b32 v100, 0
  v_mov_b32 v101, 0
  v_mov_b32 v102, 0
  v_mov_b32 v103, 0
  v_mov_b32 v104, 0
  v_mov_b32 v105, 0
  v_mov_b32 v106, 0
  v_mov_b32 v107, 0
  s_waitcnt lgkmcnt(15)
  v_dot2c_f32_bf16 v100, v0, v16
  v_dot2c_f32_bf16 v101, v0, v25
  v_dot2c_f32_bf16 v102, v0, v34
  v_dot2c_f32_bf16 v103, v0, v43
  v_dot2c_f32_bf16 v104, v0, v52
  v_dot2c_f32_bf16 v105, v0, v61
  v_dot2c_f32_bf16 v106, v0, v70
  s_waitcnt lgkmcnt(8)
  v_dot2c_f32_bf16 v107, v0, v79
  v_dot2c_f32_bf16 v100, v1, v17
  v_dot2c_f32_bf16 v101, v1, v26
  v_dot2c_f32_bf16 v102, v1, v35
  v_dot2c_f32_bf16 v103, v1, v44
  v_dot2c_f32_bf16 v104, v1, v53
  v_dot2c_f32_bf16 v105, v1, v62
  v_dot2c_f32_bf16 v106, v1, v71
  s_waitcnt lgkmcnt(7)
  v_dot2c_f32_bf16 v107, v1, v80
  v_dot2c_f32_bf16 v100, v2, v18
  v_dot2c_f32_bf16 v101, v2, v27
  v_dot2c_f32_bf16 v102, v2, v36
  v_dot2c_f32_bf16 v103, v2, v45
  v_dot2c_f32_bf16 v104, v2, v54
  v_dot2c_f32_bf16 v105, v2, v63
  v_dot2c_f32_bf16 v106, v2, v72
  s_waitcnt lgkmcnt(6)
  v_dot2c_f32_bf16 v107, v2, v81
  v_dot2c_f32_bf16 v100, v3, v19
  v_dot2c_f32_bf16 v101, v3, v28
  v_dot2c_f32_bf16 v102, v3, v37
  v_dot2c_f32_bf16 v103, v3, v46
  v_dot2c_f32_bf16 v104, v3, v55
  v_dot2c_f32_bf16 v105, v3, v64
  v_dot2c_f32_bf16 v106, v3, v73
  s_waitcnt lgkmcnt(5)
  v_dot2c_f32_bf16 v107, v3, v82
  v_dot2c_f32_bf16 v100, v4, v20
  v_dot2c_f32_bf16 v101, v4, v29
  v_dot2c_f32_bf16 v102, v4, v38
  v_dot2c_f32_bf16 v103, v4, v47
  v_dot2c_f32_bf16 v104, v4, v56
  v_dot2c_f32_bf16 v105, v4, v65
  v_dot2c_f32_bf16 v106, v4, v74
  s_waitcnt lgkmcnt(4)
  v_dot2c_f32_bf16 v107, v4, v83
  v_dot2c_f32_bf16 v100, v5, v21
  v_dot2c_f32_bf16 v101, v5, v30
  v_dot2c_f32_bf16 v102, v5, v39
  v_dot2c_f32_bf16 v103, v5, v48
  v_dot2c_f32_bf16 v104, v5, v57
  v_dot2c_f32_bf16 v105, v5, v66
  v_dot2c_f32_bf16 v106, v5, v75
  s_waitcnt lgkmcnt(3)
  v_dot2c_f32_bf16 v107, v5, v84
  v_dot2c_f32_bf16 v100, v6, v22
  v_dot2c_f32_bf16 v101, v6, v31
  v_dot2c_f32_bf16 v102, v6, v40
  v_dot2c_f32_bf16 v103, v6, v49
  v_dot2c_f32_bf16 v104, v6, v58
  v_dot2c_f32_bf16 v105, v6, v67
  v_dot2c_f32_bf16 v106, v6, v76
  s_waitcnt lgkmcnt(2)
  v_dot2c_f32_bf16 v107, v6, v85
  v_dot2c_f32_bf16 v100, v7, v23
  v_dot2c_f32_bf16 v101, v7, v32
  v_dot2c_f32_bf16 v102, v7, v41
  v_dot2c_f32_bf16 v103, v7, v50
  v_dot2c_f32_bf16 v104, v7, v59
  v_dot2c_f32_bf16 v105, v7, v68
  v_dot2c_f32_bf16 v106, v7, v77
  s_waitcnt lgkmcnt(1)
  v_dot2c_f32_bf16 v107, v7, v86
  v_dot2c_f32_bf16 v100, v8, v24
  v_dot2c_f32_bf16 v101, v8, v33
  v_dot2c_f32_bf16 v102, v8, v42
  v_dot2c_f32_bf16 v103, v8, v51
  v_dot2c_f32_bf16 v104, v8, v60
  v_dot2c_f32_bf16 v105, v8, v69
  v_dot2c_f32_bf16 v106, v8, v78
  s_waitcnt lgkmcnt(0)
  v_dot2c_f32_bf16 v107, v8, v87
  ds_read_b32 v16, v219 offset:7512
  ds_read_b32 v17, v219 offset:7516
  ds_read_b32 v18, v219 offset:7520
  ds_read_b32 v19, v219 offset:7524
  ds_read_b32 v20, v219 offset:7528
  ds_read_b32 v21, v219 offset:7532
  ds_read_b32 v22, v219 offset:7536
  ds_read_b32 v23, v219 offset:7540
  ds_read_b32 v24, v219 offset:7544
  ds_read_b32 v25, v219 offset:6480
  ds_read_b32 v26, v219 offset:6484
  ds_read_b32 v27, v219 offset:6488
  ds_read_b32 v28, v219 offset:6492
  ds_read_b32 v29, v219 offset:6496
  ds_read_b32 v30, v219 offset:6500
  ds_read_b32 v31, v219 offset:6504
  ds_read_b32 v32, v219 offset:6508
  ds_read_b32 v33, v219 offset:6512
  ds_read_b32 v34, v219 offset:5448
  ds_read_b32 v35, v219 offset:5452
  ds_read_b32 v36, v219 offset:5456
  ds_read_b32 v37, v219 offset:5460
  ds_read_b32 v38, v219 offset:5464
  ds_read_b32 v39, v219 offset:5468
  ds_read_b32 v40, v219 offset:5472
  ds_read_b32 v41, v219 offset:5476
  ds_read_b32 v42, v219 offset:5480
  ds_read_b32 v43, v219 offset:4416
  ds_read_b32 v44, v219 offset:4420
  ds_read_b32 v45, v219 offset:4424
  ds_read_b32 v46, v219 offset:4428
  ds_read_b32 v47, v219 offset:4432
  ds_read_b32 v48, v219 offset:4436
  ds_read_b32 v49, v219 offset:4440
  ds_read_b32 v50, v219 offset:4444
  ds_read_b32 v51, v219 offset:4448
  ds_read_b32 v52, v219 offset:3384
  ds_read_b32 v53, v219 offset:3388
  ds_read_b32 v54, v219 offset:3392
  ds_read_b32 v55, v219 offset:3396
  ds_read_b32 v56, v219 offset:3400
  ds_read_b32 v57, v219 offset:3404
  ds_read_b32 v58, v219 offset:3408
  ds_read_b32 v59, v219 offset:3412
  ds_read_b32 v60, v219 offset:3416
  ds_read_b32 v61, v219 offset:2352
  ds_read_b32 v62, v219 offset:2356
  ds_read_b32 v63, v219 offset:2360
  ds_read_b32 v64, v219 offset:2364
  ds_read_b32 v65, v219 offset:2368
  ds_read_b32 v66, v219 offset:2372
  ds_read_b32 v67, v219 offset:2376
  ds_read_b32 v68, v219 offset:2380
  ds_read_b32 v69, v219 offset:2384
  ds_read_b32 v70, v219 offset:1320
  ds_read_b32 v71, v219 offset:1324
  ds_read_b32 v72, v219 offset:1328
  ds_read_b32 v73, v219 offset:1332
  ds_read_b32 v74, v219 offset:1336
  ds_read_b32 v75, v219 offset:1340
  ds_read_b32 v76, v219 offset:1344
  ds_read_b32 v77, v219 offset:1348
  ds_read_b32 v78, v219 offset:1352
  ds_read_b32 v79, v219 offset:288
  ds_read_b32 v80, v219 offset:292
  ds_read_b32 v81, v219 offset:296
  ds_read_b32 v82, v219 offset:300
  ds_read_b32 v83, v219 offset:304
  ds_read_b32 v84, v219 offset:308
  ds_read_b32 v85, v219 offset:312
  ds_read_b32 v86, v219 offset:316
  ds_read_b32 v87, v219 offset:320
  v_add_u32 v211, s66, v200
  v_mov_b32 v212, 0xf149f2ca
  v_mul_f32 v100, s57, v100
  v_mul_f32 v101, s57, v101
  v_mul_f32 v102, s57, v102
  v_mul_f32 v103, s57, v103
  v_mul_f32 v104, s57, v104
  v_mul_f32 v105, s57, v105
  v_mul_f32 v106, s57, v106
  v_mul_f32 v107, s57, v107
  v_cmp_gt_u32 vcc, 2, v211
  s_nop 1
  v_cndmask_b32 v101, v101, v212, vcc
  v_cmp_gt_u32 vcc, 4, v211
  s_nop 1
  v_cndmask_b32 v102, v102, v212, vcc
  v_cmp_gt_u32 vcc, 6, v211
  s_nop 1
  v_cndmask_b32 v103, v103, v212, vcc
  v_cmp_gt_u32 vcc, 8, v211
  s_nop 1
  v_cndmask_b32 v104, v104, v212, vcc
  v_cmp_gt_u32 vcc, 10, v211
  s_nop 1
  v_cndmask_b32 v105, v105, v212, vcc
  v_cmp_gt_u32 vcc, 12, v211
  s_nop 1
  v_cndmask_b32 v106, v106, v212, vcc
  v_cmp_gt_u32 vcc, 14, v211
  s_nop 1
  v_cndmask_b32 v107, v107, v212, vcc
  v_max3_f32 v213, v100, v101, v102
  v_max3_f32 v213, v213, v103, v104
  v_max3_f32 v213, v213, v105, v106
  v_max_f32 v213, v213, v107
  v_sub_f32 v100, v100, v213
  v_sub_f32 v101, v101, v213
  v_sub_f32 v102, v102, v213
  v_sub_f32 v103, v103, v213
  v_sub_f32 v104, v104, v213
  v_sub_f32 v105, v105, v213
  v_sub_f32 v106, v106, v213
  v_sub_f32 v107, v107, v213
  v_exp_f32 v100, v100
  v_exp_f32 v101, v101
  v_exp_f32 v102, v102
  v_exp_f32 v103, v103
  v_exp_f32 v104, v104
  v_exp_f32 v105, v105
  v_exp_f32 v106, v106
  v_exp_f32 v107, v107
  v_add_f32 v213, v100, v101
  v_add_f32 v213, v213, v102
  v_add_f32 v213, v213, v103
  v_add_f32 v213, v213, v104
  v_add_f32 v213, v213, v105
  v_add_f32 v213, v213, v106
  v_add_f32 v213, v213, v107
  v_rcp_f32 v213, v213
  v_mov_b32 v214, 0
  v_mul_f32 v100, v213, v100
  v_mul_f32 v101, v213, v101
  v_mul_f32 v102, v213, v102
  v_mul_f32 v103, v213, v103
  v_mul_f32 v104, v213, v104
  v_mul_f32 v105, v213, v105
  v_mul_f32 v106, v213, v106
  v_mul_f32 v107, v213, v107
  v_mov_b32 v112, 0
  v_mov_b32 v113, 0
  v_mov_b32 v114, 0
  v_mov_b32 v115, 0
  v_mov_b32 v116, 0
  v_mov_b32 v117, 0
  v_mov_b32 v118, 0
  v_mov_b32 v119, 0
  v_mov_b32 v120, 0
  v_mov_b32 v121, 0
  v_mov_b32 v122, 0
  v_mov_b32 v123, 0
  v_mov_b32 v124, 0
  v_mov_b32 v125, 0
  v_mov_b32 v126, 0
  v_mov_b32 v127, 0
  v_mov_b32 v128, 0
  v_mov_b32 v129, 0
  v_cvt_pk_bf16_f32 v0, v100, v214
  v_cvt_pk_bf16_f32 v1, v214, v100
  s_waitcnt lgkmcnt(15)
  v_dot2c_f32_bf16 v112, v16, v0
  v_dot2c_f32_bf16 v113, v16, v1
  v_dot2c_f32_bf16 v114, v17, v0
  v_dot2c_f32_bf16 v115, v17, v1
  v_dot2c_f32_bf16 v116, v18, v0
  v_dot2c_f32_bf16 v117, v18, v1
  v_dot2c_f32_bf16 v118, v19, v0
  v_dot2c_f32_bf16 v119, v19, v1
  v_dot2c_f32_bf16 v120, v20, v0
  v_dot2c_f32_bf16 v121, v20, v1
  v_dot2c_f32_bf16 v122, v21, v0
  v_dot2c_f32_bf16 v123, v21, v1
  v_dot2c_f32_bf16 v124, v22, v0
  v_dot2c_f32_bf16 v125, v22, v1
  v_dot2c_f32_bf16 v126, v23, v0
  v_dot2c_f32_bf16 v127, v23, v1
  v_dot2c_f32_bf16 v128, v24, v0
  v_dot2c_f32_bf16 v129, v24, v1
  v_cvt_pk_bf16_f32 v2, v101, v214
  v_cvt_pk_bf16_f32 v3, v214, v101
  v_dot2c_f32_bf16 v112, v25, v2
  v_dot2c_f32_bf16 v113, v25, v3
  v_dot2c_f32_bf16 v114, v26, v2
  v_dot2c_f32_bf16 v115, v26, v3
  v_dot2c_f32_bf16 v116, v27, v2
  v_dot2c_f32_bf16 v117, v27, v3
  v_dot2c_f32_bf16 v118, v28, v2
  v_dot2c_f32_bf16 v119, v28, v3
  v_dot2c_f32_bf16 v120, v29, v2
  v_dot2c_f32_bf16 v121, v29, v3
  v_dot2c_f32_bf16 v122, v30, v2
  v_dot2c_f32_bf16 v123, v30, v3
  v_dot2c_f32_bf16 v124, v31, v2
  v_dot2c_f32_bf16 v125, v31, v3
  v_dot2c_f32_bf16 v126, v32, v2
  v_dot2c_f32_bf16 v127, v32, v3
  v_dot2c_f32_bf16 v128, v33, v2
  v_dot2c_f32_bf16 v129, v33, v3
  v_cvt_pk_bf16_f32 v0, v102, v214
  v_cvt_pk_bf16_f32 v1, v214, v102
  v_dot2c_f32_bf16 v112, v34, v0
  v_dot2c_f32_bf16 v113, v34, v1
  v_dot2c_f32_bf16 v114, v35, v0
  v_dot2c_f32_bf16 v115, v35, v1
  v_dot2c_f32_bf16 v116, v36, v0
  v_dot2c_f32_bf16 v117, v36, v1
  v_dot2c_f32_bf16 v118, v37, v0
  v_dot2c_f32_bf16 v119, v37, v1
  v_dot2c_f32_bf16 v120, v38, v0
  v_dot2c_f32_bf16 v121, v38, v1
  v_dot2c_f32_bf16 v122, v39, v0
  v_dot2c_f32_bf16 v123, v39, v1
  v_dot2c_f32_bf16 v124, v40, v0
  v_dot2c_f32_bf16 v125, v40, v1
  v_dot2c_f32_bf16 v126, v41, v0
  v_dot2c_f32_bf16 v127, v41, v1
  v_dot2c_f32_bf16 v128, v42, v0
  v_dot2c_f32_bf16 v129, v42, v1
  v_cvt_pk_bf16_f32 v2, v103, v214
  v_cvt_pk_bf16_f32 v3, v214, v103
  v_dot2c_f32_bf16 v112, v43, v2
  v_dot2c_f32_bf16 v113, v43, v3
  v_dot2c_f32_bf16 v114, v44, v2
  v_dot2c_f32_bf16 v115, v44, v3
  v_dot2c_f32_bf16 v116, v45, v2
  v_dot2c_f32_bf16 v117, v45, v3
  v_dot2c_f32_bf16 v118, v46, v2
  v_dot2c_f32_bf16 v119, v46, v3
  v_dot2c_f32_bf16 v120, v47, v2
  v_dot2c_f32_bf16 v121, v47, v3
  v_dot2c_f32_bf16 v122, v48, v2
  v_dot2c_f32_bf16 v123, v48, v3
  v_dot2c_f32_bf16 v124, v49, v2
  v_dot2c_f32_bf16 v125, v49, v3
  v_dot2c_f32_bf16 v126, v50, v2
  v_dot2c_f32_bf16 v127, v50, v3
  v_dot2c_f32_bf16 v128, v51, v2
  v_dot2c_f32_bf16 v129, v51, v3
  v_cvt_pk_bf16_f32 v0, v104, v214
  v_cvt_pk_bf16_f32 v1, v214, v104
  v_dot2c_f32_bf16 v112, v52, v0
  v_dot2c_f32_bf16 v113, v52, v1
  v_dot2c_f32_bf16 v114, v53, v0
  v_dot2c_f32_bf16 v115, v53, v1
  v_dot2c_f32_bf16 v116, v54, v0
  v_dot2c_f32_bf16 v117, v54, v1
  v_dot2c_f32_bf16 v118, v55, v0
  v_dot2c_f32_bf16 v119, v55, v1
  v_dot2c_f32_bf16 v120, v56, v0
  v_dot2c_f32_bf16 v121, v56, v1
  v_dot2c_f32_bf16 v122, v57, v0
  v_dot2c_f32_bf16 v123, v57, v1
  v_dot2c_f32_bf16 v124, v58, v0
  v_dot2c_f32_bf16 v125, v58, v1
  v_dot2c_f32_bf16 v126, v59, v0
  v_dot2c_f32_bf16 v127, v59, v1
  v_dot2c_f32_bf16 v128, v60, v0
  v_dot2c_f32_bf16 v129, v60, v1
  v_cvt_pk_bf16_f32 v2, v105, v214
  v_cvt_pk_bf16_f32 v3, v214, v105
  v_dot2c_f32_bf16 v112, v61, v2
  v_dot2c_f32_bf16 v113, v61, v3
  v_dot2c_f32_bf16 v114, v62, v2
  v_dot2c_f32_bf16 v115, v62, v3
  v_dot2c_f32_bf16 v116, v63, v2
  v_dot2c_f32_bf16 v117, v63, v3
  v_dot2c_f32_bf16 v118, v64, v2
  v_dot2c_f32_bf16 v119, v64, v3
  v_dot2c_f32_bf16 v120, v65, v2
  v_dot2c_f32_bf16 v121, v65, v3
  v_dot2c_f32_bf16 v122, v66, v2
  v_dot2c_f32_bf16 v123, v66, v3
  v_dot2c_f32_bf16 v124, v67, v2
  v_dot2c_f32_bf16 v125, v67, v3
  v_dot2c_f32_bf16 v126, v68, v2
  v_dot2c_f32_bf16 v127, v68, v3
  v_dot2c_f32_bf16 v128, v69, v2
  v_dot2c_f32_bf16 v129, v69, v3
  v_cvt_pk_bf16_f32 v0, v106, v214
  v_cvt_pk_bf16_f32 v1, v214, v106
  v_dot2c_f32_bf16 v112, v70, v0
  v_dot2c_f32_bf16 v113, v70, v1
  v_dot2c_f32_bf16 v114, v71, v0
  v_dot2c_f32_bf16 v115, v71, v1
  v_dot2c_f32_bf16 v116, v72, v0
  v_dot2c_f32_bf16 v117, v72, v1
  s_waitcnt lgkmcnt(14)
  v_dot2c_f32_bf16 v118, v73, v0
  v_dot2c_f32_bf16 v119, v73, v1
  s_waitcnt lgkmcnt(13)
  v_dot2c_f32_bf16 v120, v74, v0
  v_dot2c_f32_bf16 v121, v74, v1
  s_waitcnt lgkmcnt(12)
  v_dot2c_f32_bf16 v122, v75, v0
  v_dot2c_f32_bf16 v123, v75, v1
  s_waitcnt lgkmcnt(11)
  v_dot2c_f32_bf16 v124, v76, v0
  v_dot2c_f32_bf16 v125, v76, v1
  s_waitcnt lgkmcnt(10)
  v_dot2c_f32_bf16 v126, v77, v0
  v_dot2c_f32_bf16 v127, v77, v1
  s_waitcnt lgkmcnt(9)
  v_dot2c_f32_bf16 v128, v78, v0
  v_dot2c_f32_bf16 v129, v78, v1
  v_cvt_pk_bf16_f32 v2, v107, v214
  v_cvt_pk_bf16_f32 v3, v214, v107
  s_waitcnt lgkmcnt(8)
  v_dot2c_f32_bf16 v112, v79, v2
  v_dot2c_f32_bf16 v113, v79, v3
  s_waitcnt lgkmcnt(7)
  v_dot2c_f32_bf16 v114, v80, v2
  v_dot2c_f32_bf16 v115, v80, v3
  s_waitcnt lgkmcnt(6)
  v_dot2c_f32_bf16 v116, v81, v2
  v_dot2c_f32_bf16 v117, v81, v3
  s_waitcnt lgkmcnt(5)
  v_dot2c_f32_bf16 v118, v82, v2
  v_dot2c_f32_bf16 v119, v82, v3
  s_waitcnt lgkmcnt(4)
  v_dot2c_f32_bf16 v120, v83, v2
  v_dot2c_f32_bf16 v121, v83, v3
  s_waitcnt lgkmcnt(3)
  v_dot2c_f32_bf16 v122, v84, v2
  v_dot2c_f32_bf16 v123, v84, v3
  s_waitcnt lgkmcnt(2)
  v_dot2c_f32_bf16 v124, v85, v2
  v_dot2c_f32_bf16 v125, v85, v3
  s_waitcnt lgkmcnt(1)
  v_dot2c_f32_bf16 v126, v86, v2
  v_dot2c_f32_bf16 v127, v86, v3
  s_waitcnt lgkmcnt(0)
  v_dot2c_f32_bf16 v128, v87, v2
  v_dot2c_f32_bf16 v129, v87, v3
  v_cvt_pk_bf16_f32 v132, v112, v113
  v_cvt_pk_bf16_f32 v133, v114, v115
  v_cvt_pk_bf16_f32 v134, v116, v117
  v_cvt_pk_bf16_f32 v135, v118, v119
  v_cvt_pk_bf16_f32 v136, v120, v121
  v_cvt_pk_bf16_f32 v137, v122, v123
  v_cvt_pk_bf16_f32 v138, v124, v125
  v_cvt_pk_bf16_f32 v139, v126, v127
  v_cvt_pk_bf16_f32 v140, v128, v129
  buffer_store_dwordx4 v[132:135], v220, s[8:11], s64 offen sc1
  buffer_store_dwordx4 v[136:139], v220, s[8:11], s64 offen offset:16 sc1
  buffer_store_dword v140, v220, s[8:11], s64 offen offset:32 sc1
  v_add_u32 v219, 33024, v219
  s_add_u32 s66, s66, 64
  s_add_u32 s64, s64, 73728
  ds_read_b32 v0, v219 offset:7224
  ds_read_b32 v1, v219 offset:7228
  ds_read_b32 v2, v219 offset:7232
  ds_read_b32 v3, v219 offset:7236
  ds_read_b32 v4, v219 offset:7240
  ds_read_b32 v5, v219 offset:7244
  ds_read_b32 v6, v219 offset:7248
  ds_read_b32 v7, v219 offset:7252
  ds_read_b32 v8, v219 offset:7256
  ds_read_b32 v16, v219 offset:7368
  ds_read_b32 v17, v219 offset:7372
  ds_read_b32 v18, v219 offset:7376
  ds_read_b32 v19, v219 offset:7380
  ds_read_b32 v20, v219 offset:7384
  ds_read_b32 v21, v219 offset:7388
  ds_read_b32 v22, v219 offset:7392
  ds_read_b32 v23, v219 offset:7396
  ds_read_b32 v24, v219 offset:7400
  ds_read_b32 v25, v219 offset:6336
  ds_read_b32 v26, v219 offset:6340
  ds_read_b32 v27, v219 offset:6344
  ds_read_b32 v28, v219 offset:6348
  ds_read_b32 v29, v219 offset:6352
  ds_read_b32 v30, v219 offset:6356
  ds_read_b32 v31, v219 offset:6360
  ds_read_b32 v32, v219 offset:6364
  ds_read_b32 v33, v219 offset:6368
  ds_read_b32 v34, v219 offset:5304
  ds_read_b32 v35, v219 offset:5308
  ds_read_b32 v36, v219 offset:5312
  ds_read_b32 v37, v219 offset:5316
  ds_read_b32 v38, v219 offset:5320
  ds_read_b32 v39, v219 offset:5324
  ds_read_b32 v40, v219 offset:5328
  ds_read_b32 v41, v219 offset:5332
  ds_read_b32 v42, v219 offset:5336
  ds_read_b32 v43, v219 offset:4272
  ds_read_b32 v44, v219 offset:4276
  ds_read_b32 v45, v219 offset:4280
  ds_read_b32 v46, v219 offset:4284
  ds_read_b32 v47, v219 offset:4288
  ds_read_b32 v48, v219 offset:4292
  ds_read_b32 v49, v219 offset:4296
  ds_read_b32 v50, v219 offset:4300
  ds_read_b32 v51, v219 offset:4304
  ds_read_b32 v52, v219 offset:3240
  ds_read_b32 v53, v219 offset:3244
  ds_read_b32 v54, v219 offset:3248
  ds_read_b32 v55, v219 offset:3252
  ds_read_b32 v56, v219 offset:3256
  ds_read_b32 v57, v219 offset:3260
  ds_read_b32 v58, v219 offset:3264
  ds_read_b32 v59, v219 offset:3268
  ds_read_b32 v60, v219 offset:3272
  ds_read_b32 v61, v219 offset:2208
  ds_read_b32 v62, v219 offset:2212
  ds_read_b32 v63, v219 offset:2216
  ds_read_b32 v64, v219 offset:2220
  ds_read_b32 v65, v219 offset:2224
  ds_read_b32 v66, v219 offset:2228
  ds_read_b32 v67, v219 offset:2232
  ds_read_b32 v68, v219 offset:2236
  ds_read_b32 v69, v219 offset:2240
  ds_read_b32 v70, v219 offset:1176
  ds_read_b32 v71, v219 offset:1180
  ds_read_b32 v72, v219 offset:1184
  ds_read_b32 v73, v219 offset:1188
  ds_read_b32 v74, v219 offset:1192
  ds_read_b32 v75, v219 offset:1196
  ds_read_b32 v76, v219 offset:1200
  ds_read_b32 v77, v219 offset:1204
  ds_read_b32 v78, v219 offset:1208
  ds_read_b32 v79, v219 offset:144
  ds_read_b32 v80, v219 offset:148
  ds_read_b32 v81, v219 offset:152
  ds_read_b32 v82, v219 offset:156
  ds_read_b32 v83, v219 offset:160
  ds_read_b32 v84, v219 offset:164
  ds_read_b32 v85, v219 offset:168
  ds_read_b32 v86, v219 offset:172
  ds_read_b32 v87, v219 offset:176
  v_mov_b32 v100, 0
  v_mov_b32 v101, 0
  v_mov_b32 v102, 0
  v_mov_b32 v103, 0
  v_mov_b32 v104, 0
  v_mov_b32 v105, 0
  v_mov_b32 v106, 0
  v_mov_b32 v107, 0
  s_waitcnt lgkmcnt(15)
  v_dot2c_f32_bf16 v100, v0, v16
  v_dot2c_f32_bf16 v101, v0, v25
  v_dot2c_f32_bf16 v102, v0, v34
  v_dot2c_f32_bf16 v103, v0, v43
  v_dot2c_f32_bf16 v104, v0, v52
  v_dot2c_f32_bf16 v105, v0, v61
  v_dot2c_f32_bf16 v106, v0, v70
  s_waitcnt lgkmcnt(8)
  v_dot2c_f32_bf16 v107, v0, v79
  v_dot2c_f32_bf16 v100, v1, v17
  v_dot2c_f32_bf16 v101, v1, v26
  v_dot2c_f32_bf16 v102, v1, v35
  v_dot2c_f32_bf16 v103, v1, v44
  v_dot2c_f32_bf16 v104, v1, v53
  v_dot2c_f32_bf16 v105, v1, v62
  v_dot2c_f32_bf16 v106, v1, v71
  s_waitcnt lgkmcnt(7)
  v_dot2c_f32_bf16 v107, v1, v80
  v_dot2c_f32_bf16 v100, v2, v18
  v_dot2c_f32_bf16 v101, v2, v27
  v_dot2c_f32_bf16 v102, v2, v36
  v_dot2c_f32_bf16 v103, v2, v45
  v_dot2c_f32_bf16 v104, v2, v54
  v_dot2c_f32_bf16 v105, v2, v63
  v_dot2c_f32_bf16 v106, v2, v72
  s_waitcnt lgkmcnt(6)
  v_dot2c_f32_bf16 v107, v2, v81
  v_dot2c_f32_bf16 v100, v3, v19
  v_dot2c_f32_bf16 v101, v3, v28
  v_dot2c_f32_bf16 v102, v3, v37
  v_dot2c_f32_bf16 v103, v3, v46
  v_dot2c_f32_bf16 v104, v3, v55
  v_dot2c_f32_bf16 v105, v3, v64
  v_dot2c_f32_bf16 v106, v3, v73
  s_waitcnt lgkmcnt(5)
  v_dot2c_f32_bf16 v107, v3, v82
  v_dot2c_f32_bf16 v100, v4, v20
  v_dot2c_f32_bf16 v101, v4, v29
  v_dot2c_f32_bf16 v102, v4, v38
  v_dot2c_f32_bf16 v103, v4, v47
  v_dot2c_f32_bf16 v104, v4, v56
  v_dot2c_f32_bf16 v105, v4, v65
  v_dot2c_f32_bf16 v106, v4, v74
  s_waitcnt lgkmcnt(4)
  v_dot2c_f32_bf16 v107, v4, v83
  v_dot2c_f32_bf16 v100, v5, v21
  v_dot2c_f32_bf16 v101, v5, v30
  v_dot2c_f32_bf16 v102, v5, v39
  v_dot2c_f32_bf16 v103, v5, v48
  v_dot2c_f32_bf16 v104, v5, v57
  v_dot2c_f32_bf16 v105, v5, v66
  v_dot2c_f32_bf16 v106, v5, v75
  s_waitcnt lgkmcnt(3)
  v_dot2c_f32_bf16 v107, v5, v84
  v_dot2c_f32_bf16 v100, v6, v22
  v_dot2c_f32_bf16 v101, v6, v31
  v_dot2c_f32_bf16 v102, v6, v40
  v_dot2c_f32_bf16 v103, v6, v49
  v_dot2c_f32_bf16 v104, v6, v58
  v_dot2c_f32_bf16 v105, v6, v67
  v_dot2c_f32_bf16 v106, v6, v76
  s_waitcnt lgkmcnt(2)
  v_dot2c_f32_bf16 v107, v6, v85
  v_dot2c_f32_bf16 v100, v7, v23
  v_dot2c_f32_bf16 v101, v7, v32
  v_dot2c_f32_bf16 v102, v7, v41
  v_dot2c_f32_bf16 v103, v7, v50
  v_dot2c_f32_bf16 v104, v7, v59
  v_dot2c_f32_bf16 v105, v7, v68
  v_dot2c_f32_bf16 v106, v7, v77
  s_waitcnt lgkmcnt(1)
  v_dot2c_f32_bf16 v107, v7, v86
  v_dot2c_f32_bf16 v100, v8, v24
  v_dot2c_f32_bf16 v101, v8, v33
  v_dot2c_f32_bf16 v102, v8, v42
  v_dot2c_f32_bf16 v103, v8, v51
  v_dot2c_f32_bf16 v104, v8, v60
  v_dot2c_f32_bf16 v105, v8, v69
  v_dot2c_f32_bf16 v106, v8, v78
  s_waitcnt lgkmcnt(0)
  v_dot2c_f32_bf16 v107, v8, v87
  ds_read_b32 v16, v219 offset:7512
  ds_read_b32 v17, v219 offset:7516
  ds_read_b32 v18, v219 offset:7520
  ds_read_b32 v19, v219 offset:7524
  ds_read_b32 v20, v219 offset:7528
  ds_read_b32 v21, v219 offset:7532
  ds_read_b32 v22, v219 offset:7536
  ds_read_b32 v23, v219 offset:7540
  ds_read_b32 v24, v219 offset:7544
  ds_read_b32 v25, v219 offset:6480
  ds_read_b32 v26, v219 offset:6484
  ds_read_b32 v27, v219 offset:6488
  ds_read_b32 v28, v219 offset:6492
  ds_read_b32 v29, v219 offset:6496
  ds_read_b32 v30, v219 offset:6500
  ds_read_b32 v31, v219 offset:6504
  ds_read_b32 v32, v219 offset:6508
  ds_read_b32 v33, v219 offset:6512
  ds_read_b32 v34, v219 offset:5448
  ds_read_b32 v35, v219 offset:5452
  ds_read_b32 v36, v219 offset:5456
  ds_read_b32 v37, v219 offset:5460
  ds_read_b32 v38, v219 offset:5464
  ds_read_b32 v39, v219 offset:5468
  ds_read_b32 v40, v219 offset:5472
  ds_read_b32 v41, v219 offset:5476
  ds_read_b32 v42, v219 offset:5480
  ds_read_b32 v43, v219 offset:4416
  ds_read_b32 v44, v219 offset:4420
  ds_read_b32 v45, v219 offset:4424
  ds_read_b32 v46, v219 offset:4428
  ds_read_b32 v47, v219 offset:4432
  ds_read_b32 v48, v219 offset:4436
  ds_read_b32 v49, v219 offset:4440
  ds_read_b32 v50, v219 offset:4444
  ds_read_b32 v51, v219 offset:4448
  ds_read_b32 v52, v219 offset:3384
  ds_read_b32 v53, v219 offset:3388
  ds_read_b32 v54, v219 offset:3392
  ds_read_b32 v55, v219 offset:3396
  ds_read_b32 v56, v219 offset:3400
  ds_read_b32 v57, v219 offset:3404
  ds_read_b32 v58, v219 offset:3408
  ds_read_b32 v59, v219 offset:3412
  ds_read_b32 v60, v219 offset:3416
  ds_read_b32 v61, v219 offset:2352
  ds_read_b32 v62, v219 offset:2356
  ds_read_b32 v63, v219 offset:2360
  ds_read_b32 v64, v219 offset:2364
  ds_read_b32 v65, v219 offset:2368
  ds_read_b32 v66, v219 offset:2372
  ds_read_b32 v67, v219 offset:2376
  ds_read_b32 v68, v219 offset:2380
  ds_read_b32 v69, v219 offset:2384
  ds_read_b32 v70, v219 offset:1320
  ds_read_b32 v71, v219 offset:1324
  ds_read_b32 v72, v219 offset:1328
  ds_read_b32 v73, v219 offset:1332
  ds_read_b32 v74, v219 offset:1336
  ds_read_b32 v75, v219 offset:1340
  ds_read_b32 v76, v219 offset:1344
  ds_read_b32 v77, v219 offset:1348
  ds_read_b32 v78, v219 offset:1352
  ds_read_b32 v79, v219 offset:288
  ds_read_b32 v80, v219 offset:292
  ds_read_b32 v81, v219 offset:296
  ds_read_b32 v82, v219 offset:300
  ds_read_b32 v83, v219 offset:304
  ds_read_b32 v84, v219 offset:308
  ds_read_b32 v85, v219 offset:312
  ds_read_b32 v86, v219 offset:316
  ds_read_b32 v87, v219 offset:320
  v_add_u32 v211, s66, v200
  v_mov_b32 v212, 0xf149f2ca
  v_mul_f32 v100, s57, v100
  v_mul_f32 v101, s57, v101
  v_mul_f32 v102, s57, v102
  v_mul_f32 v103, s57, v103
  v_mul_f32 v104, s57, v104
  v_mul_f32 v105, s57, v105
  v_mul_f32 v106, s57, v106
  v_mul_f32 v107, s57, v107
  v_cmp_gt_u32 vcc, 2, v211
  s_nop 1
  v_cndmask_b32 v101, v101, v212, vcc
  v_cmp_gt_u32 vcc, 4, v211
  s_nop 1
  v_cndmask_b32 v102, v102, v212, vcc
  v_cmp_gt_u32 vcc, 6, v211
  s_nop 1
  v_cndmask_b32 v103, v103, v212, vcc
  v_cmp_gt_u32 vcc, 8, v211
  s_nop 1
  v_cndmask_b32 v104, v104, v212, vcc
  v_cmp_gt_u32 vcc, 10, v211
  s_nop 1
  v_cndmask_b32 v105, v105, v212, vcc
  v_cmp_gt_u32 vcc, 12, v211
  s_nop 1
  v_cndmask_b32 v106, v106, v212, vcc
  v_cmp_gt_u32 vcc, 14, v211
  s_nop 1
  v_cndmask_b32 v107, v107, v212, vcc
  v_max3_f32 v213, v100, v101, v102
  v_max3_f32 v213, v213, v103, v104
  v_max3_f32 v213, v213, v105, v106
  v_max_f32 v213, v213, v107
  v_sub_f32 v100, v100, v213
  v_sub_f32 v101, v101, v213
  v_sub_f32 v102, v102, v213
  v_sub_f32 v103, v103, v213
  v_sub_f32 v104, v104, v213
  v_sub_f32 v105, v105, v213
  v_sub_f32 v106, v106, v213
  v_sub_f32 v107, v107, v213
  v_exp_f32 v100, v100
  v_exp_f32 v101, v101
  v_exp_f32 v102, v102
  v_exp_f32 v103, v103
  v_exp_f32 v104, v104
  v_exp_f32 v105, v105
  v_exp_f32 v106, v106
  v_exp_f32 v107, v107
  v_add_f32 v213, v100, v101
  v_add_f32 v213, v213, v102
  v_add_f32 v213, v213, v103
  v_add_f32 v213, v213, v104
  v_add_f32 v213, v213, v105
  v_add_f32 v213, v213, v106
  v_add_f32 v213, v213, v107
  v_rcp_f32 v213, v213
  v_mov_b32 v214, 0
  v_mul_f32 v100, v213, v100
  v_mul_f32 v101, v213, v101
  v_mul_f32 v102, v213, v102
  v_mul_f32 v103, v213, v103
  v_mul_f32 v104, v213, v104
  v_mul_f32 v105, v213, v105
  v_mul_f32 v106, v213, v106
  v_mul_f32 v107, v213, v107
  v_mov_b32 v112, 0
  v_mov_b32 v113, 0
  v_mov_b32 v114, 0
  v_mov_b32 v115, 0
  v_mov_b32 v116, 0
  v_mov_b32 v117, 0
  v_mov_b32 v118, 0
  v_mov_b32 v119, 0
  v_mov_b32 v120, 0
  v_mov_b32 v121, 0
  v_mov_b32 v122, 0
  v_mov_b32 v123, 0
  v_mov_b32 v124, 0
  v_mov_b32 v125, 0
  v_mov_b32 v126, 0
  v_mov_b32 v127, 0
  v_mov_b32 v128, 0
  v_mov_b32 v129, 0
  v_cvt_pk_bf16_f32 v0, v100, v214
  v_cvt_pk_bf16_f32 v1, v214, v100
  s_waitcnt lgkmcnt(15)
  v_dot2c_f32_bf16 v112, v16, v0
  v_dot2c_f32_bf16 v113, v16, v1
  v_dot2c_f32_bf16 v114, v17, v0
  v_dot2c_f32_bf16 v115, v17, v1
  v_dot2c_f32_bf16 v116, v18, v0
  v_dot2c_f32_bf16 v117, v18, v1
  v_dot2c_f32_bf16 v118, v19, v0
  v_dot2c_f32_bf16 v119, v19, v1
  v_dot2c_f32_bf16 v120, v20, v0
  v_dot2c_f32_bf16 v121, v20, v1
  v_dot2c_f32_bf16 v122, v21, v0
  v_dot2c_f32_bf16 v123, v21, v1
  v_dot2c_f32_bf16 v124, v22, v0
  v_dot2c_f32_bf16 v125, v22, v1
  v_dot2c_f32_bf16 v126, v23, v0
  v_dot2c_f32_bf16 v127, v23, v1
  v_dot2c_f32_bf16 v128, v24, v0
  v_dot2c_f32_bf16 v129, v24, v1
  v_cvt_pk_bf16_f32 v2, v101, v214
  v_cvt_pk_bf16_f32 v3, v214, v101
  v_dot2c_f32_bf16 v112, v25, v2
  v_dot2c_f32_bf16 v113, v25, v3
  v_dot2c_f32_bf16 v114, v26, v2
  v_dot2c_f32_bf16 v115, v26, v3
  v_dot2c_f32_bf16 v116, v27, v2
  v_dot2c_f32_bf16 v117, v27, v3
  v_dot2c_f32_bf16 v118, v28, v2
  v_dot2c_f32_bf16 v119, v28, v3
  v_dot2c_f32_bf16 v120, v29, v2
  v_dot2c_f32_bf16 v121, v29, v3
  v_dot2c_f32_bf16 v122, v30, v2
  v_dot2c_f32_bf16 v123, v30, v3
  v_dot2c_f32_bf16 v124, v31, v2
  v_dot2c_f32_bf16 v125, v31, v3
  v_dot2c_f32_bf16 v126, v32, v2
  v_dot2c_f32_bf16 v127, v32, v3
  v_dot2c_f32_bf16 v128, v33, v2
  v_dot2c_f32_bf16 v129, v33, v3
  v_cvt_pk_bf16_f32 v0, v102, v214
  v_cvt_pk_bf16_f32 v1, v214, v102
  v_dot2c_f32_bf16 v112, v34, v0
  v_dot2c_f32_bf16 v113, v34, v1
  v_dot2c_f32_bf16 v114, v35, v0
  v_dot2c_f32_bf16 v115, v35, v1
  v_dot2c_f32_bf16 v116, v36, v0
  v_dot2c_f32_bf16 v117, v36, v1
  v_dot2c_f32_bf16 v118, v37, v0
  v_dot2c_f32_bf16 v119, v37, v1
  v_dot2c_f32_bf16 v120, v38, v0
  v_dot2c_f32_bf16 v121, v38, v1
  v_dot2c_f32_bf16 v122, v39, v0
  v_dot2c_f32_bf16 v123, v39, v1
  v_dot2c_f32_bf16 v124, v40, v0
  v_dot2c_f32_bf16 v125, v40, v1
  v_dot2c_f32_bf16 v126, v41, v0
  v_dot2c_f32_bf16 v127, v41, v1
  v_dot2c_f32_bf16 v128, v42, v0
  v_dot2c_f32_bf16 v129, v42, v1
  v_cvt_pk_bf16_f32 v2, v103, v214
  v_cvt_pk_bf16_f32 v3, v214, v103
  v_dot2c_f32_bf16 v112, v43, v2
  v_dot2c_f32_bf16 v113, v43, v3
  v_dot2c_f32_bf16 v114, v44, v2
  v_dot2c_f32_bf16 v115, v44, v3
  v_dot2c_f32_bf16 v116, v45, v2
  v_dot2c_f32_bf16 v117, v45, v3
  v_dot2c_f32_bf16 v118, v46, v2
  v_dot2c_f32_bf16 v119, v46, v3
  v_dot2c_f32_bf16 v120, v47, v2
  v_dot2c_f32_bf16 v121, v47, v3
  v_dot2c_f32_bf16 v122, v48, v2
  v_dot2c_f32_bf16 v123, v48, v3
  v_dot2c_f32_bf16 v124, v49, v2
  v_dot2c_f32_bf16 v125, v49, v3
  v_dot2c_f32_bf16 v126, v50, v2
  v_dot2c_f32_bf16 v127, v50, v3
  v_dot2c_f32_bf16 v128, v51, v2
  v_dot2c_f32_bf16 v129, v51, v3
  v_cvt_pk_bf16_f32 v0, v104, v214
  v_cvt_pk_bf16_f32 v1, v214, v104
  v_dot2c_f32_bf16 v112, v52, v0
  v_dot2c_f32_bf16 v113, v52, v1
  v_dot2c_f32_bf16 v114, v53, v0
  v_dot2c_f32_bf16 v115, v53, v1
  v_dot2c_f32_bf16 v116, v54, v0
  v_dot2c_f32_bf16 v117, v54, v1
  v_dot2c_f32_bf16 v118, v55, v0
  v_dot2c_f32_bf16 v119, v55, v1
  v_dot2c_f32_bf16 v120, v56, v0
  v_dot2c_f32_bf16 v121, v56, v1
  v_dot2c_f32_bf16 v122, v57, v0
  v_dot2c_f32_bf16 v123, v57, v1
  v_dot2c_f32_bf16 v124, v58, v0
  v_dot2c_f32_bf16 v125, v58, v1
  v_dot2c_f32_bf16 v126, v59, v0
  v_dot2c_f32_bf16 v127, v59, v1
  v_dot2c_f32_bf16 v128, v60, v0
  v_dot2c_f32_bf16 v129, v60, v1
  v_cvt_pk_bf16_f32 v2, v105, v214
  v_cvt_pk_bf16_f32 v3, v214, v105
  v_dot2c_f32_bf16 v112, v61, v2
  v_dot2c_f32_bf16 v113, v61, v3
  v_dot2c_f32_bf16 v114, v62, v2
  v_dot2c_f32_bf16 v115, v62, v3
  v_dot2c_f32_bf16 v116, v63, v2
  v_dot2c_f32_bf16 v117, v63, v3
  v_dot2c_f32_bf16 v118, v64, v2
  v_dot2c_f32_bf16 v119, v64, v3
  v_dot2c_f32_bf16 v120, v65, v2
  v_dot2c_f32_bf16 v121, v65, v3
  v_dot2c_f32_bf16 v122, v66, v2
  v_dot2c_f32_bf16 v123, v66, v3
  v_dot2c_f32_bf16 v124, v67, v2
  v_dot2c_f32_bf16 v125, v67, v3
  v_dot2c_f32_bf16 v126, v68, v2
  v_dot2c_f32_bf16 v127, v68, v3
  v_dot2c_f32_bf16 v128, v69, v2
  v_dot2c_f32_bf16 v129, v69, v3
  v_cvt_pk_bf16_f32 v0, v106, v214
  v_cvt_pk_bf16_f32 v1, v214, v106
  v_dot2c_f32_bf16 v112, v70, v0
  v_dot2c_f32_bf16 v113, v70, v1
  v_dot2c_f32_bf16 v114, v71, v0
  v_dot2c_f32_bf16 v115, v71, v1
  v_dot2c_f32_bf16 v116, v72, v0
  v_dot2c_f32_bf16 v117, v72, v1
  s_waitcnt lgkmcnt(14)
  v_dot2c_f32_bf16 v118, v73, v0
  v_dot2c_f32_bf16 v119, v73, v1
  s_waitcnt lgkmcnt(13)
  v_dot2c_f32_bf16 v120, v74, v0
  v_dot2c_f32_bf16 v121, v74, v1
  s_waitcnt lgkmcnt(12)
  v_dot2c_f32_bf16 v122, v75, v0
  v_dot2c_f32_bf16 v123, v75, v1
  s_waitcnt lgkmcnt(11)
  v_dot2c_f32_bf16 v124, v76, v0
  v_dot2c_f32_bf16 v125, v76, v1
  s_waitcnt lgkmcnt(10)
  v_dot2c_f32_bf16 v126, v77, v0
  v_dot2c_f32_bf16 v127, v77, v1
  s_waitcnt lgkmcnt(9)
  v_dot2c_f32_bf16 v128, v78, v0
  v_dot2c_f32_bf16 v129, v78, v1
  v_cvt_pk_bf16_f32 v2, v107, v214
  v_cvt_pk_bf16_f32 v3, v214, v107
  s_waitcnt lgkmcnt(8)
  v_dot2c_f32_bf16 v112, v79, v2
  v_dot2c_f32_bf16 v113, v79, v3
  s_waitcnt lgkmcnt(7)
  v_dot2c_f32_bf16 v114, v80, v2
  v_dot2c_f32_bf16 v115, v80, v3
  s_waitcnt lgkmcnt(6)
  v_dot2c_f32_bf16 v116, v81, v2
  v_dot2c_f32_bf16 v117, v81, v3
  s_waitcnt lgkmcnt(5)
  v_dot2c_f32_bf16 v118, v82, v2
  v_dot2c_f32_bf16 v119, v82, v3
  s_waitcnt lgkmcnt(4)
  v_dot2c_f32_bf16 v120, v83, v2
  v_dot2c_f32_bf16 v121, v83, v3
  s_waitcnt lgkmcnt(3)
  v_dot2c_f32_bf16 v122, v84, v2
  v_dot2c_f32_bf16 v123, v84, v3
  s_waitcnt lgkmcnt(2)
  v_dot2c_f32_bf16 v124, v85, v2
  v_dot2c_f32_bf16 v125, v85, v3
  s_waitcnt lgkmcnt(1)
  v_dot2c_f32_bf16 v126, v86, v2
  v_dot2c_f32_bf16 v127, v86, v3
  s_waitcnt lgkmcnt(0)
  v_dot2c_f32_bf16 v128, v87, v2
  v_dot2c_f32_bf16 v129, v87, v3
  v_cvt_pk_bf16_f32 v132, v112, v113
  v_cvt_pk_bf16_f32 v133, v114, v115
  v_cvt_pk_bf16_f32 v134, v116, v117
  v_cvt_pk_bf16_f32 v135, v118, v119
  v_cvt_pk_bf16_f32 v136, v120, v121
  v_cvt_pk_bf16_f32 v137, v122, v123
  v_cvt_pk_bf16_f32 v138, v124, v125
  v_cvt_pk_bf16_f32 v139, v126, v127
  v_cvt_pk_bf16_f32 v140, v128, v129
  buffer_store_dwordx4 v[132:135], v220, s[8:11], s64 offen sc1
  buffer_store_dwordx4 v[136:139], v220, s[8:11], s64 offen offset:16 sc1
  buffer_store_dword v140, v220, s[8:11], s64 offen offset:32 sc1
  s_mov_b32 s56, 36
  s_waitcnt vmcnt(0)
  s_barrier
  s_cmp_eq_u32 s52, 0
  s_cbranch_scc0 A_sig
  v_mov_b32 v211, 1
  v_mov_b32 v212, 0
  s_mov_b64 exec, 1
  buffer_atomic_add v211, v212, s[12:15], s56 offen
  s_mov_b64 exec, -1
A_sig:
  s_and_b32 s54, s53, 31
  s_cmp_lt_u32 s54, 27
  s_cbranch_scc0 L_exit
  s_and_b32 s54, s53, 31
  s_mul_i32 s68, s54, 57
  s_lshr_b32 s68, s68, 9
  s_mul_i32 s56, s68, 9
  s_sub_u32 s70, s54, s56
  s_bfe_u32 s55, s53, 0x10005
  s_mul_i32 s55, s55, 9
  s_add_u32 s70, s70, s55
  s_bfe_u32 s69, s53, 0x10006
  v_lshrrev_b32 v211, 2, v200
  v_mul_u32_u24 v211, 1152, v211
  v_and_b32 v212, 3, v200
  v_lshl_add_u32 v207, v212, 4, v211
  s_lshl_b32 s54, s70, 6
  s_mul_i32 s55, s52, 1179648
  s_add_u32 s62, s54, s55
  s_mul_i32 s55, s52, 184320
  s_add_u32 s63, s54, s55
  s_mul_i32 s61, s52, 40960
  v_bfe_u32 v211, v200, 2, 2
  v_lshlrev_b32 v212, 4, v212
  v_add_u32 v212, s61, v212
  v_lshl_add_u32 v212, v211, 6, v212
  v_lshrrev_b32 v213, 4, v200
  v_lshl_add_u32 v210, v213, 9, v212
  v_lshrrev_b32 v214, 5, v200
  v_lshl_add_u32 v209, v214, 10, v212
  v_and_b32 v214, 1, v213
  v_lshl_add_u32 v209, v214, 8, v209
  s_add_u32 m0, s61, 0
  s_add_u32 s54, s62, 0
  buffer_load_dwordx4 v207, s[28:31], s54 offen lds
  s_add_u32 m0, s61, 1024
  s_add_u32 s54, s62, 18432
  buffer_load_dwordx4 v207, s[28:31], s54 offen lds
  s_add_u32 m0, s61, 2048
  s_add_u32 s54, s62, 36864
  buffer_load_dwordx4 v207, s[28:31], s54 offen lds
  s_add_u32 m0, s61, 3072
  s_add_u32 s54, s62, 55296
  buffer_load_dwordx4 v207, s[28:31], s54 offen lds
  s_add_u32 m0, s61, 4096
  s_add_u32 s54, s62, 73728
  buffer_load_dwordx4 v207, s[28:31], s54 offen lds
  s_add_u32 m0, s61, 5120
  s_add_u32 s54, s62, 92160
  buffer_load_dwordx4 v207, s[28:31], s54 offen lds
  s_add_u32 m0, s61, 6144
  s_add_u32 s54, s62, 110592
  buffer_load_dwordx4 v207, s[28:31], s54 offen lds
  s_add_u32 m0, s61, 7168
  s_add_u32 s54, s62, 129024
  buffer_load_dwordx4 v207, s[28:31], s54 offen lds
  s_add_u32 m0, s61, 8192
  s_add_u32 s54, s62, 147456
  buffer_load_dwordx4 v207, s[28:31], s54 offen lds
  s_add_u32 m0, s61, 9216
  s_add_u32 s54, s62, 165888
  buffer_load_dwordx4 v207, s[28:31], s54 offen lds
  s_add_u32 m0, s61, 10240
  s_add_u32 s54, s62, 184320
  buffer_load_dwordx4 v207, s[28:31], s54 offen lds
  s_add_u32 m0, s61, 11264
  s_add_u32 s54, s62, 202752
  buffer_load_dwordx4 v207, s[28:31], s54 offen lds
  s_add_u32 m0, s61, 12288
  s_add_u32 s54, s62, 221184
  buffer_load_dwordx4 v207, s[28:31], s54 offen lds
  s_add_u32 m0, s61, 13312
  s_add_u32 s54, s62, 239616
  buffer_load_dwordx4 v207, s[28:31], s54 offen lds
  s_add_u32 m0, s61, 14336
  s_add_u32 s54, s62, 258048
  buffer_load_dwordx4 v207, s[28:31], s54 offen lds
  s_add_u32 m0, s61, 15360
  s_add_u32 s54, s62, 276480
  buffer_load_dwordx4 v207, s[28:31], s54 offen lds
  s_add_u32 m0, s61, 16384
  s_add_u32 s54, s62, 294912
  buffer_load_dwordx4 v207, s[28:31], s54 offen lds
  s_add_u32 m0, s61, 17408
  s_add_u32 s54, s62, 313344
  buffer_load_dwordx4 v207, s[28:31], s54 offen lds
  s_add_u32 m0, s61, 18432
  s_add_u32 s54, s62, 331776
  buffer_load_dwordx4 v207, s[28:31], s54 offen lds
  s_add_u32 m0, s61, 19456
  s_add_u32 s54, s62, 350208
  buffer_load_dwordx4 v207, s[28:31], s54 offen lds
  s_add_u32 m0, s61, 20480
  s_add_u32 s54, s62, 368640
  buffer_load_dwordx4 v207, s[28:31], s54 offen lds
  s_add_u32 m0, s61, 21504
  s_add_u32 s54, s62, 387072
  buffer_load_dwordx4 v207, s[28:31], s54 offen lds
  s_add_u32 m0, s61, 22528
  s_add_u32 s54, s62, 405504
  buffer_load_dwordx4 v207, s[28:31], s54 offen lds
  s_add_u32 m0, s61, 23552
  s_add_u32 s54, s62, 423936
  buffer_load_dwordx4 v207, s[28:31], s54 offen lds
  s_add_u32 m0, s61, 24576
  s_add_u32 s54, s62, 442368
  buffer_load_dwordx4 v207, s[28:31], s54 offen lds
  s_add_u32 m0, s61, 25600
  s_add_u32 s54, s62, 460800
  buffer_load_dwordx4 v207, s[28:31], s54 offen lds
  s_add_u32 m0, s61, 26624
  s_add_u32 s54, s62, 479232
  buffer_load_dwordx4 v207, s[28:31], s54 offen lds
  s_add_u32 m0, s61, 27648
  s_add_u32 s54, s62, 497664
  buffer_load_dwordx4 v207, s[28:31], s54 offen lds
  s_add_u32 m0, s61, 28672
  s_add_u32 s54, s62, 516096
  buffer_load_dwordx4 v207, s[28:31], s54 offen lds
  s_add_u32 m0, s61, 29696
  s_add_u32 s54, s62, 534528
  buffer_load_dwordx4 v207, s[28:31], s54 offen lds
  s_add_u32 m0, s61, 30720
  s_add_u32 s54, s62, 552960
  buffer_load_dwordx4 v207, s[28:31], s54 offen lds
  s_add_u32 m0, s61, 31744
  s_add_u32 s54, s62, 571392
  buffer_load_dwordx4 v207, s[28:31], s54 offen lds
  s_add_u32 m0, s61, 32768
  s_add_u32 s54, s62, 589824
  buffer_load_dwordx4 v207, s[28:31], s54 offen lds
  s_add_u32 m0, s61, 33792
  s_add_u32 s54, s62, 608256
  buffer_load_dwordx4 v207, s[28:31], s54 offen lds
  s_add_u32 m0, s61, 34816
  s_add_u32 s54, s62, 626688
  buffer_load_dwordx4 v207, s[28:31], s54 offen lds
  s_add_u32 m0, s61, 35840
  s_add_u32 s54, s62, 645120
  buffer_load_dwordx4 v207, s[28:31], s54 offen lds
  s_add_u32 m0, s61, 36864
  s_add_u32 s54, s62, 663552
  buffer_load_dwordx4 v207, s[28:31], s54 offen lds
  s_add_u32 m0, s61, 37888
  s_add_u32 s54, s62, 681984
  buffer_load_dwordx4 v207, s[28:31], s54 offen lds
  s_waitcnt vmcnt(36) lgkmcnt(0)
  s_add_u32 m0, s61, 38912
  s_add_u32 s54, s62, 700416
  buffer_load_dwordx4 v207, s[28:31], s54 offen lds
  s_add_u32 m0, s61, 39936
  s_add_u32 s54, s62, 718848
  buffer_load_dwordx4 v207, s[28:31], s54 offen lds
  ds_read_b64_tr_b16 a[0:1], v209 offset:0
  ds_read_b64_tr_b16 a[2:3], v209 offset:512
  ds_read_b64_tr_b16 a[4:5], v209 offset:8
  ds_read_b64_tr_b16 a[6:7], v209 offset:520
  s_waitcnt vmcnt(36) lgkmcnt(0)
  s_add_u32 m0, s61, 0
  s_add_u32 s54, s62, 737280
  buffer_load_dwordx4 v207, s[28:31], s54 offen lds
  s_add_u32 m0, s61, 1024
  s_add_u32 s54, s62, 755712
  buffer_load_dwordx4 v207, s[28:31], s54 offen lds
  ds_read_b64_tr_b16 a[8:9], v209 offset:2048
  ds_read_b64_tr_b16 a[10:11], v209 offset:2560
  ds_read_b64_tr_b16 a[12:13], v209 offset:2056
  ds_read_b64_tr_b16 a[14:15], v209 offset:2568
  s_waitcnt vmcnt(36) lgkmcnt(0)
  s_add_u32 m0, s61, 2048
  s_add_u32 s54, s62, 774144
  buffer_load_dwordx4 v207, s[28:31], s54 offen lds
  s_add_u32 m0, s61, 3072
  s_add_u32 s54, s62, 792576
  buffer_load_dwordx4 v207, s[28:31], s54 offen lds
  ds_read_b64_tr_b16 a[16:17], v209 offset:4096
  ds_read_b64_tr_b16 a[18:19], v209 offset:4608
  ds_read_b64_tr_b16 a[20:21], v209 offset:4104
  ds_read_b64_tr_b16 a[22:23], v209 offset:4616
  s_waitcnt vmcnt(36) lgkmcnt(0)
  s_add_u32 m0, s61, 4096
  s_add_u32 s54, s62, 811008
  buffer_load_dwordx4 v207, s[28:31], s54 offen lds
  s_add_u32 m0, s61, 5120
  s_add_u32 s54, s62, 829440
  buffer_load_dwordx4 v207, s[28:31], s54 offen lds
  ds_read_b64_tr_b16 a[24:25], v209 offset:6144
  ds_read_b64_tr_b16 a[26:27], v209 offset:6656
  ds_read_b64_tr_b16 a[28:29], v209 offset:6152
  ds_read_b64_tr_b16 a[30:31], v209 offset:6664
  s_waitcnt vmcnt(36) lgkmcnt(0)
  s_add_u32 m0, s61, 6144
  s_add_u32 s54, s62, 847872
  buffer_load_dwordx4 v207, s[28:31], s54 offen lds
  s_add_u32 m0, s61, 7168
  s_add_u32 s54, s62, 866304
  buffer_load_dwordx4 v207, s[28:31], s54 offen lds
  ds_read_b64_tr_b16 a[32:33], v209 offset:8192
  ds_read_b64_tr_b16 a[34:35], v209 offset:8704
  ds_read_b64_tr_b16 a[36:37], v209 offset:8200
  ds_read_b64_tr_b16 a[38:39], v209 offset:8712
  s_waitcnt vmcnt(36) lgkmcnt(0)
  s_add_u32 m0, s61, 8192
  s_add_u32 s54, s62, 884736
  buffer_load_dwordx4 v207, s[28:31], s54 offen lds
  s_add_u32 m0, s61, 9216
  s_add_u32 s54, s62, 903168
  buffer_load_dwordx4 v207, s[28:31], s54 offen lds
  ds_read_b64_tr_b16 a[40:41], v209 offset:10240
  ds_read_b64_tr_b16 a[42:43], v209 offset:10752
  ds_read_b64_tr_b16 a[44:45], v209 offset:10248
  ds_read_b64_tr_b16 a[46:47], v209 offset:10760
  s_waitcnt vmcnt(36) lgkmcnt(0)
  s_add_u32 m0, s61, 10240
  s_add_u32 s54, s62, 921600
  buffer_load_dwordx4 v207, s[28:31], s54 offen lds
  s_add_u32 m0, s61, 11264
  s_add_u32 s54, s62, 940032
  buffer_load_dwordx4 v207, s[28:31], s54 offen lds
  ds_read_b64_tr_b16 a[48:49], v209 offset:12288
  ds_read_b64_tr_b16 a[50:51], v209 offset:12800
  ds_read_b64_tr_b16 a[52:53], v209 offset:12296
  ds_read_b64_tr_b16 a[54:55], v209 offset:12808
  s_waitcnt vmcnt(36) lgkmcnt(0)
  s_add_u32 m0, s61, 12288
  s_add_u32 s54, s62, 958464
  buffer_load_dwordx4 v207, s[28:31], s54 offen lds
  s_add_u32 m0, s61, 13312
  s_add_u32 s54, s62, 976896
  buffer_load_dwordx4 v207, s[28:31], s54 offen lds
  ds_read_b64_tr_b16 a[56:57], v209 offset:14336
  ds_read_b64_tr_b16 a[58:59], v209 offset:14848
  ds_read_b64_tr_b16 a[60:61], v209 offset:14344
  ds_read_b64_tr_b16 a[62:63], v209 offset:14856
  s_waitcnt vmcnt(36) lgkmcnt(0)
  s_add_u32 m0, s61, 14336
  s_add_u32 s54, s62, 995328
  buffer_load_dwordx4 v207, s[28:31], s54 offen lds
  s_add_u32 m0, s61, 15360
  s_add_u32 s54, s62, 1013760
  buffer_load_dwordx4 v207, s[28:31], s54 offen lds
  ds_read_b64_tr_b16 a[64:65], v209 offset:16384
  ds_read_b64_tr_b16 a[66:67], v209 offset:16896
  ds_read_b64_tr_b16 a[68:69], v209 offset:16392
  ds_read_b64_tr_b16 a[70:71], v209 offset:16904
  s_waitcnt vmcnt(36) lgkmcnt(0)
  s_add_u32 m0, s61, 16384
  s_add_u32 s54, s62, 1032192
  buffer_load_dwordx4 v207, s[28:31], s54 offen lds
  s_add_u32 m0, s61, 17408
  s_add_u32 s54, s62, 1050624
  buffer_load_dwordx4 v207, s[28:31], s54 offen lds
  ds_read_b64_tr_b16 a[72:73], v209 offset:18432
  ds_read_b64_tr_b16 a[74:75], v209 offset:18944
  ds_read_b64_tr_b16 a[76:77], v209 offset:18440
  ds_read_b64_tr_b16 a[78:79], v209 offset:18952
  s_waitcnt vmcnt(36) lgkmcnt(0)
  s_add_u32 m0, s61, 18432
  s_add_u32 s54, s62, 1069056
  buffer_load_dwordx4 v207, s[28:31], s54 offen lds
  s_add_u32 m0, s61, 19456
  s_add_u32 s54, s62, 1087488
  buffer_load_dwordx4 v207, s[28:31], s54 offen lds
  ds_read_b64_tr_b16 a[80:81], v209 offset:20480
  ds_read_b64_tr_b16 a[82:83], v209 offset:20992
  ds_read_b64_tr_b16 a[84:85], v209 offset:20488
  ds_read_b64_tr_b16 a[86:87], v209 offset:21000
  s_waitcnt vmcnt(36) lgkmcnt(0)
  s_add_u32 m0, s61, 20480
  s_add_u32 s54, s62, 1105920
  buffer_load_dwordx4 v207, s[28:31], s54 offen lds
  s_add_u32 m0, s61, 21504
  s_add_u32 s54, s62, 1124352
  buffer_load_dwordx4 v207, s[28:31], s54 offen lds
  ds_read_b64_tr_b16 a[88:89], v209 offset:22528
  ds_read_b64_tr_b16 a[90:91], v209 offset:23040
  ds_read_b64_tr_b16 a[92:93], v209 offset:22536
  ds_read_b64_tr_b16 a[94:95], v209 offset:23048
  s_waitcnt vmcnt(36) lgkmcnt(0)
  s_add_u32 m0, s61, 22528
  s_add_u32 s54, s62, 1142784
  buffer_load_dwordx4 v207, s[28:31], s54 offen lds
  s_add_u32 m0, s61, 23552
  s_add_u32 s54, s62, 1161216
  buffer_load_dwordx4 v207, s[28:31], s54 offen lds
  ds_read_b64_tr_b16 a[96:97], v209 offset:24576
  ds_read_b64_tr_b16 a[98:99], v209 offset:25088
  ds_read_b64_tr_b16 a[100:101], v209 offset:24584
  ds_read_b64_tr_b16 a[102:103], v209 offset:25096
  s_waitcnt vmcnt(36) lgkmcnt(0)
  s_add_u32 m0, s61, 24576
  s_add_u32 s54, s63, 0
  buffer_load_dwordx4 v207, s[40:43], s54 offen lds
  s_add_u32 m0, s61, 25600
  s_add_u32 s54, s63, 18432
  buffer_load_dwordx4 v207, s[40:43], s54 offen lds
  ds_read_b64_tr_b16 a[104:105], v209 offset:26624
  ds_read_b64_tr_b16 a[106:107], v209 offset:27136
  ds_read_b64_tr_b16 a[108:109], v209 offset:26632
  ds_read_b64_tr_b16 a[110:111], v209 offset:27144
  s_waitcnt vmcnt(36) lgkmcnt(0)
  s_add_u32 m0, s61, 26624
  s_add_u32 s54, s63, 36864
  buffer_load_dwordx4 v207, s[40:43], s54 offen lds
  s_add_u32 m0, s61, 27648
  s_add_u32 s54, s63, 55296
  buffer_load_dwordx4 v207, s[40:43], s54 offen lds
  ds_read_b64_tr_b16 a[112:113], v209 offset:28672
  ds_read_b64_tr_b16 a[114:115], v209 offset:29184
  ds_read_b64_tr_b16 a[116:117], v209 offset:28680
  ds_read_b64_tr_b16 a[118:119], v209 offset:29192
  s_waitcnt vmcnt(36) lgkmcnt(0)
  s_add_u32 m0, s61, 28672
  s_add_u32 s54, s63, 73728
  buffer_load_dwordx4 v207, s[40:43], s54 offen lds
  s_add_u32 m0, s61, 29696
  s_add_u32 s54, s63, 92160
  buffer_load_dwordx4 v207, s[40:43], s54 offen lds
  ds_read_b64_tr_b16 a[120:121], v209 offset:30720
  ds_read_b64_tr_b16 a[122:123], v209 offset:31232
  ds_read_b64_tr_b16 a[124:125], v209 offset:30728
  ds_read_b64_tr_b16 a[126:127], v209 offset:31240
  s_waitcnt vmcnt(36) lgkmcnt(0)
  s_add_u32 m0, s61, 30720
  s_add_u32 s54, s63, 110592
  buffer_load_dwordx4 v207, s[40:43], s54 offen lds
  s_add_u32 m0, s61, 31744
  s_add_u32 s54, s63, 129024
  buffer_load_dwordx4 v207, s[40:43], s54 offen lds
  ds_read_b64_tr_b16 a[128:129], v209 offset:32768
  ds_read_b64_tr_b16 a[130:131], v209 offset:33280
  ds_read_b64_tr_b16 a[132:133], v209 offset:32776
  ds_read_b64_tr_b16 a[134:135], v209 offset:33288
  s_waitcnt vmcnt(36) lgkmcnt(0)
  s_add_u32 m0, s61, 32768
  s_add_u32 s54, s63, 147456
  buffer_load_dwordx4 v207, s[40:43], s54 offen lds
  s_add_u32 m0, s61, 33792
  s_add_u32 s54, s63, 165888
  buffer_load_dwordx4 v207, s[40:43], s54 offen lds
  ds_read_b64_tr_b16 a[136:137], v209 offset:34816
  ds_read_b64_tr_b16 a[138:139], v209 offset:35328
  ds_read_b64_tr_b16 a[140:141], v209 offset:34824
  ds_read_b64_tr_b16 a[142:143], v209 offset:35336
  s_waitcnt vmcnt(36) lgkmcnt(0)
  ds_read_b64_tr_b16 a[144:145], v209 offset:36864
  ds_read_b64_tr_b16 a[146:147], v209 offset:37376
  ds_read_b64_tr_b16 a[148:149], v209 offset:36872
  ds_read_b64_tr_b16 a[150:151], v209 offset:37384
  s_waitcnt vmcnt(34) lgkmcnt(0)
  ds_read_b64_tr_b16 a[152:153], v209 offset:38912
  ds_read_b64_tr_b16 a[154:155], v209 offset:39424
  ds_read_b64_tr_b16 a[156:157], v209 offset:38920
  ds_read_b64_tr_b16 a[158:159], v209 offset:39432
  s_waitcnt vmcnt(32) lgkmcnt(0)
  ds_read_b64_tr_b16 a[160:161], v209 offset:0
  ds_read_b64_tr_b16 a[162:163], v209 offset:512
  ds_read_b64_tr_b16 a[164:165], v209 offset:8
  ds_read_b64_tr_b16 a[166:167], v209 offset:520
  s_waitcnt vmcnt(30) lgkmcnt(0)
  ds_read_b64_tr_b16 a[168:169], v209 offset:2048
  ds_read_b64_tr_b16 a[170:171], v209 offset:2560
  ds_read_b64_tr_b16 a[172:173], v209 offset:2056
  ds_read_b64_tr_b16 a[174:175], v209 offset:2568
  s_waitcnt vmcnt(28) lgkmcnt(0)
  ds_read_b64_tr_b16 a[176:177], v209 offset:4096
  ds_read_b64_tr_b16 a[178:179], v209 offset:4608
  ds_read_b64_tr_b16 a[180:181], v209 offset:4104
  ds_read_b64_tr_b16 a[182:183], v209 offset:4616
  s_waitcnt vmcnt(26) lgkmcnt(0)
  ds_read_b64_tr_b16 a[184:185], v209 offset:6144
  ds_read_b64_tr_b16 a[186:187], v209 offset:6656
  ds_read_b64_tr_b16 a[188:189], v209 offset:6152
  ds_read_b64_tr_b16 a[190:191], v209 offset:6664
  s_waitcnt vmcnt(24) lgkmcnt(0)
  ds_read_b64_tr_b16 a[192:193], v209 offset:8192
  ds_read_b64_tr_b16 a[194:195], v209 offset:8704
  ds_read_b64_tr_b16 a[196:197], v209 offset:8200
  ds_read_b64_tr_b16 a[198:199], v209 offset:8712
  s_waitcnt vmcnt(22) lgkmcnt(0)
  ds_read_b64_tr_b16 a[200:201], v209 offset:10240
  ds_read_b64_tr_b16 a[202:203], v209 offset:10752
  ds_read_b64_tr_b16 a[204:205], v209 offset:10248
  ds_read_b64_tr_b16 a[206:207], v209 offset:10760
  s_waitcnt vmcnt(20) lgkmcnt(0)
  ds_read_b64_tr_b16 a[208:209], v209 offset:12288
  ds_read_b64_tr_b16 a[210:211], v209 offset:12800
  ds_read_b64_tr_b16 a[212:213], v209 offset:12296
  ds_read_b64_tr_b16 a[214:215], v209 offset:12808
  s_waitcnt vmcnt(18) lgkmcnt(0)
  ds_read_b64_tr_b16 a[216:217], v209 offset:14336
  ds_read_b64_tr_b16 a[218:219], v209 offset:14848
  ds_read_b64_tr_b16 a[220:221], v209 offset:14344
  ds_read_b64_tr_b16 a[222:223], v209 offset:14856
  s_waitcnt vmcnt(16) lgkmcnt(0)
  ds_read_b64_tr_b16 a[224:225], v209 offset:16384
  ds_read_b64_tr_b16 a[226:227], v209 offset:16896
  ds_read_b64_tr_b16 a[228:229], v209 offset:16392
  ds_read_b64_tr_b16 a[230:231], v209 offset:16904
  s_waitcnt vmcnt(14) lgkmcnt(0)
  ds_read_b64_tr_b16 a[232:233], v209 offset:18432
  ds_read_b64_tr_b16 a[234:235], v209 offset:18944
  ds_read_b64_tr_b16 a[236:237], v209 offset:18440
  ds_read_b64_tr_b16 a[238:239], v209 offset:18952
  s_waitcnt vmcnt(12) lgkmcnt(0)
  ds_read_b64_tr_b16 a[240:241], v209 offset:20480
  ds_read_b64_tr_b16 a[242:243], v209 offset:20992
  ds_read_b64_tr_b16 a[244:245], v209 offset:20488
  ds_read_b64_tr_b16 a[246:247], v209 offset:21000
  s_waitcnt vmcnt(10) lgkmcnt(0)
  ds_read_b64_tr_b16 a[248:249], v209 offset:22528
  ds_read_b64_tr_b16 a[250:251], v209 offset:23040
  ds_read_b64_tr_b16 a[252:253], v209 offset:22536
  ds_read_b64_tr_b16 a[254:255], v209 offset:23048
  s_waitcnt vmcnt(8) lgkmcnt(0)
  ds_read_b64_tr_b16 v[216:217], v210 offset:24576
  ds_read_b64_tr_b16 v[218:219], v210 offset:24832
  ds_read_b64_tr_b16 v[220:221], v210 offset:24584
  ds_read_b64_tr_b16 v[222:223], v210 offset:24840
  s_waitcnt vmcnt(6) lgkmcnt(0)
  ds_read_b64_tr_b16 v[224:225], v210 offset:26624
  ds_read_b64_tr_b16 v[226:227], v210 offset:26880
  ds_read_b64_tr_b16 v[228:229], v210 offset:26632
  ds_read_b64_tr_b16 v[230:231], v210 offset:26888
  s_waitcnt vmcnt(4) lgkmcnt(0)
  ds_read_b64_tr_b16 v[232:233], v210 offset:28672
  ds_read_b64_tr_b16 v[234:235], v210 offset:28928
  ds_read_b64_tr_b16 v[236:237], v210 offset:28680
  ds_read_b64_tr_b16 v[238:239], v210 offset:28936
  s_waitcnt vmcnt(2) lgkmcnt(0)
  ds_read_b64_tr_b16 v[240:241], v210 offset:30720
  ds_read_b64_tr_b16 v[242:243], v210 offset:30976
  ds_read_b64_tr_b16 v[244:245], v210 offset:30728
  ds_read_b64_tr_b16 v[246:247], v210 offset:30984
  s_waitcnt vmcnt(0) lgkmcnt(0)
  ds_read_b64_tr_b16 v[248:249], v210 offset:32768
  ds_read_b64_tr_b16 v[250:251], v210 offset:33024
  ds_read_b64_tr_b16 v[252:253], v210 offset:32776
  ds_read_b64_tr_b16 v[254:255], v210 offset:33032
  v_and_b32 v211, 15, v200
  s_lshl_b32 s54, s69, 4
  v_add_u32 v211, s54, v211
  v_lshl_add_u32 v212, v214, 5, v211
  v_lshlrev_b32 v164, 4, v212
  v_lshrrev_b32 v212, 5, v200
  v_lshl_add_u32 v164, v212, 10, v164
  v_mul_u32_u24 v167, 1152, v211
  v_lshl_add_u32 v167, v213, 4, v167
  v_lshlrev_b32 v166, 2, v211
  v_lshlrev_b32 v208, 2, v200
  s_lshl_b32 s54, s52, 11
  v_add_u32 v168, s54, v201
  s_mov_b32 s59, s68
  s_mov_b32 s56, 128
  s_mov_b32 s57, 36
  s_waitcnt lgkmcnt(0)
  s_cmp_eq_u32 s52, 0
  s_cbranch_scc0 O_p1_d
  s_mov_b32 exec_hi, 0
  s_mov_b32 exec_lo, -1
O_p1:
  buffer_load_dword v211, v208, s[12:15], s56 offen sc1
  s_add_u32 s65, s65, 1
  s_waitcnt vmcnt(0)
  v_cmp_gt_u32 vcc, 0x700, v211
  s_cbranch_vccz O_p1_x
  s_sleep 16
  s_cmp_lt_u32 s65, 131072
  s_cbranch_scc1 O_p1
O_p1_x:
  s_mov_b64 exec, -1
O_p1_d:
  s_barrier
  s_cmp_eq_u32 s52, 0
  s_cbranch_scc0 O_a_d
  s_mov_b32 exec_hi, 0
  s_mov_b32 exec_lo, 1
O_a:
  buffer_load_dword v211, v208, s[12:15], s57 offen sc1
  s_add_u32 s65, s65, 1
  s_waitcnt vmcnt(0)
  v_cmp_gt_u32 vcc, 0x80, v211
  s_cbranch_vccz O_a_x
  s_sleep 16
  s_cmp_lt_u32 s65, 131072
  s_cbranch_scc1 O_a
O_a_x:
  s_mov_b64 exec, -1
O_a_d:
  s_barrier
  s_cmp_ge_u32 s70, 9
  s_cselect_b32 s54, 9, 0
  s_sub_u32 s54, s70, s54
  s_and_b32 s54, s54, 7
  s_lshl_b32 s54, s54, 13
  s_lshl_b32 s55, s69, 8
  s_add_u32 s54, s54, s55
  v_lshrrev_b32 v211, 2, v200
  v_lshl_add_u32 v172, v211, 9, s54
  v_and_b32 v211, 3, v200
  v_lshl_add_u32 v172, v211, 6, v172
  s_mul_i32 s55, s59, 36864
  s_mul_i32 s54, s52, 320
  s_add_u32 s55, s55, s54
  s_add_u32 s55, s55, 62914560
  s_cmp_eq_u32 s52, 3
  s_cselect_b32 s56, 268435456, s55
  buffer_load_dwordx4 v[128:131], v167, s[8:11], s55 offen offset:0 sc1
  buffer_load_dwordx4 v[132:135], v167, s[8:11], s55 offen offset:64 sc1
  buffer_load_dwordx4 v[136:139], v167, s[8:11], s55 offen offset:128 sc1
  buffer_load_dwordx4 v[140:143], v167, s[8:11], s56 offen offset:192 sc1
  buffer_load_dwordx4 v[144:147], v167, s[8:11], s56 offen offset:256 sc1
  s_lshl_b32 s55, s59, 7
  s_add_u32 s55, s55, 66060288
  buffer_load_dword v171, v166, s[8:11], s55 offen sc1
  v_mov_b32 v169, 0
  s_mov_b32 s66, 356352
  s_waitcnt vmcnt(0)
O_loop:
  v_mfma_f32_16x16x32_bf16 v[156:159], v[216:219], v[128:131], 0
  v_mfma_f32_16x16x32_bf16 v[160:163], v[220:223], v[128:131], 0
  v_mfma_f32_16x16x32_bf16 v[156:159], v[224:227], v[132:135], v[156:159]
  v_mfma_f32_16x16x32_bf16 v[160:163], v[228:231], v[132:135], v[160:163]
  v_mfma_f32_16x16x32_bf16 v[156:159], v[232:235], v[136:139], v[156:159]
  v_mfma_f32_16x16x32_bf16 v[160:163], v[236:239], v[136:139], v[160:163]
  v_mfma_f32_16x16x32_bf16 v[156:159], v[240:243], v[140:143], v[156:159]
  v_mfma_f32_16x16x32_bf16 v[160:163], v[244:247], v[140:143], v[160:163]
  v_mfma_f32_16x16x32_bf16 v[156:159], v[248:251], v[144:147], v[156:159]
  v_mfma_f32_16x16x32_bf16 v[160:163], v[252:255], v[144:147], v[160:163]
  s_mul_i32 s64, s59, 36864
  s_lshl_b32 s54, s70, 6
  s_add_u32 s64, s64, s54
  s_add_u32 s71, s59, 2
  s_lshl_b32 s55, s59, 18
  s_lshl_b32 s54, s52, 16
  s_add_u32 s55, s55, s54
  s_add_u32 s63, s55, 46137344
  s_and_b32 s54, s59, 1
  s_lshl_b32 s54, s54, 2
  s_add_u32 s54, s54, s52
  s_lshl_b32 s54, s54, 3
  s_lshl_b64 s[72:73], 0xff, s54
  v_sub_f32 v165, 1.0, v171
  v_cvt_pk_bf16_f32 v165, v165, v165
  v_lshlrev_b32 v165, 16, v165
  v_mul_f32 v156, v171, v156
  v_mul_f32 v157, v171, v157
  v_mul_f32 v158, v171, v158
  v_mul_f32 v159, v171, v159
  v_mul_f32 v160, v171, v160
  v_mul_f32 v161, v171, v161
  v_mul_f32 v162, v171, v162
  v_mul_f32 v163, v171, v163
  s_branch O_pc
O_pl:
  s_sleep 1
  buffer_load_dword v169, v208, s[8:11], s66 offen sc1
  s_add_u32 s65, s65, 1
  s_cmp_ge_u32 s65, 131072
  s_cbranch_scc1 O_ld
  s_waitcnt vmcnt(0)
O_pc:
  v_cmp_gt_u32 vcc, s71, v169
  s_nop 0
  s_and_b64 vcc, vcc, s[72:73]
  s_cbranch_scc1 O_pl
O_ld:
  s_mov_b32 s62, s63
  buffer_load_dword v173, v172, s[8:11], s63 offen sc1
  buffer_load_dwordx4 v[0:3], v164, s[8:11], s62 offen offset:0 sc1
  buffer_load_dwordx4 v[4:7], v164, s[8:11], s62 offen offset:2048 sc1
  s_add_u32 s62, s62, 4096
  buffer_load_dwordx4 v[8:11], v164, s[8:11], s62 offen offset:0 sc1
  buffer_load_dwordx4 v[12:15], v164, s[8:11], s62 offen offset:2048 sc1
  s_add_u32 s62, s62, 4096
  buffer_load_dwordx4 v[16:19], v164, s[8:11], s62 offen offset:0 sc1
  buffer_load_dwordx4 v[20:23], v164, s[8:11], s62 offen offset:2048 sc1
  s_add_u32 s62, s62, 4096
  buffer_load_dwordx4 v[24:27], v164, s[8:11], s62 offen offset:0 sc1
  buffer_load_dwordx4 v[28:31], v164, s[8:11], s62 offen offset:2048 sc1
  s_add_u32 s62, s62, 4096
  buffer_load_dwordx4 v[32:35], v164, s[8:11], s62 offen offset:0 sc1
  buffer_load_dwordx4 v[36:39], v164, s[8:11], s62 offen offset:2048 sc1
  s_add_u32 s62, s62, 4096
  buffer_load_dwordx4 v[40:43], v164, s[8:11], s62 offen offset:0 sc1
  buffer_load_dwordx4 v[44:47], v164, s[8:11], s62 offen offset:2048 sc1
  s_add_u32 s62, s62, 4096
  buffer_load_dwordx4 v[48:51], v164, s[8:11], s62 offen offset:0 sc1
  buffer_load_dwordx4 v[52:55], v164, s[8:11], s62 offen offset:2048 sc1
  s_add_u32 s62, s62, 4096
  buffer_load_dwordx4 v[56:59], v164, s[8:11], s62 offen offset:0 sc1
  buffer_load_dwordx4 v[60:63], v164, s[8:11], s62 offen offset:2048 sc1
  s_add_u32 s62, s62, 4096
  buffer_load_dwordx4 v[64:67], v164, s[8:11], s62 offen offset:0 sc1
  buffer_load_dwordx4 v[68:71], v164, s[8:11], s62 offen offset:2048 sc1
  s_add_u32 s62, s62, 4096
  buffer_load_dwordx4 v[72:75], v164, s[8:11], s62 offen offset:0 sc1
  buffer_load_dwordx4 v[76:79], v164, s[8:11], s62 offen offset:2048 sc1
  s_add_u32 s62, s62, 4096
  buffer_load_dwordx4 v[80:83], v164, s[8:11], s62 offen offset:0 sc1
  buffer_load_dwordx4 v[84:87], v164, s[8:11], s62 offen offset:2048 sc1
  s_add_u32 s62, s62, 4096
  buffer_load_dwordx4 v[88:91], v164, s[8:11], s62 offen offset:0 sc1
  buffer_load_dwordx4 v[92:95], v164, s[8:11], s62 offen offset:2048 sc1
  s_add_u32 s62, s62, 4096
  buffer_load_dwordx4 v[96:99], v164, s[8:11], s62 offen offset:0 sc1
  buffer_load_dwordx4 v[100:103], v164, s[8:11], s62 offen offset:2048 sc1
  s_add_u32 s62, s62, 4096
  buffer_load_dwordx4 v[104:107], v164, s[8:11], s62 offen offset:0 sc1
  buffer_load_dwordx4 v[108:111], v164, s[8:11], s62 offen offset:2048 sc1
  s_add_u32 s62, s62, 4096
  buffer_load_dwordx4 v[112:115], v164, s[8:11], s62 offen offset:0 sc1
  buffer_load_dwordx4 v[116:119], v164, s[8:11], s62 offen offset:2048 sc1
  s_add_u32 s62, s62, 4096
  buffer_load_dwordx4 v[120:123], v164, s[8:11], s62 offen offset:0 sc1
  buffer_load_dwordx4 v[124:127], v164, s[8:11], s62 offen offset:2048 sc1
  s_add_u32 s62, s62, 4096
  s_add_u32 s57, s59, 3
  s_min_u32 s74, s57, 63
  s_mul_i32 s55, s74, 36864
  s_mul_i32 s54, s52, 320
  s_add_u32 s55, s55, s54
  s_add_u32 s55, s55, 62914560
  s_cmp_eq_u32 s52, 3
  s_cselect_b32 s56, 268435456, s55
  buffer_load_dwordx4 v[128:131], v167, s[8:11], s55 offen offset:0 sc1
  buffer_load_dwordx4 v[132:135], v167, s[8:11], s55 offen offset:64 sc1
  buffer_load_dwordx4 v[136:139], v167, s[8:11], s55 offen offset:128 sc1
  buffer_load_dwordx4 v[140:143], v167, s[8:11], s56 offen offset:192 sc1
  buffer_load_dwordx4 v[144:147], v167, s[8:11], s56 offen offset:256 sc1
  s_lshl_b32 s55, s74, 7
  s_add_u32 s55, s55, 66060288
  buffer_load_dword v171, v166, s[8:11], s55 offen sc1
  s_add_u32 s65, s65, 1
  s_cmp_lt_u32 s65, 131072
  s_cselect_b32 s54, -2, -1
  s_waitcnt vmcnt(37)
  v_mfma_f32_16x16x32_bf16 v[148:151], a[0:3], v[0:3], 0
  v_mfma_f32_16x16x32_bf16 v[152:155], a[4:7], v[0:3], 0
  v_max3_u32 v170, v0, v1, v0
  v_max3_u32 v170, v2, v3, v170
  s_waitcnt vmcnt(36)
  v_mfma_f32_16x16x32_bf16 v[148:151], a[8:11], v[4:7], v[148:151]
  v_mfma_f32_16x16x32_bf16 v[152:155], a[12:15], v[4:7], v[152:155]
  v_max3_u32 v170, v4, v5, v170
  v_max3_u32 v170, v6, v7, v170
  s_waitcnt vmcnt(35)
  v_mfma_f32_16x16x32_bf16 v[148:151], a[16:19], v[8:11], v[148:151]
  v_mfma_f32_16x16x32_bf16 v[152:155], a[20:23], v[8:11], v[152:155]
  v_max3_u32 v170, v8, v9, v170
  v_max3_u32 v170, v10, v11, v170
  s_waitcnt vmcnt(34)
  v_mfma_f32_16x16x32_bf16 v[148:151], a[24:27], v[12:15], v[148:151]
  v_mfma_f32_16x16x32_bf16 v[152:155], a[28:31], v[12:15], v[152:155]
  v_max3_u32 v170, v12, v13, v170
  v_max3_u32 v170, v14, v15, v170
  s_waitcnt vmcnt(33)
  v_mfma_f32_16x16x32_bf16 v[148:151], a[32:35], v[16:19], v[148:151]
  v_mfma_f32_16x16x32_bf16 v[152:155], a[36:39], v[16:19], v[152:155]
  v_max3_u32 v170, v16, v17, v170
  v_max3_u32 v170, v18, v19, v170
  s_waitcnt vmcnt(32)
  v_mfma_f32_16x16x32_bf16 v[148:151], a[40:43], v[20:23], v[148:151]
  v_mfma_f32_16x16x32_bf16 v[152:155], a[44:47], v[20:23], v[152:155]
  v_max3_u32 v170, v20, v21, v170
  v_max3_u32 v170, v22, v23, v170
  s_waitcnt vmcnt(31)
  v_mfma_f32_16x16x32_bf16 v[148:151], a[48:51], v[24:27], v[148:151]
  v_mfma_f32_16x16x32_bf16 v[152:155], a[52:55], v[24:27], v[152:155]
  v_max3_u32 v170, v24, v25, v170
  v_max3_u32 v170, v26, v27, v170
  s_waitcnt vmcnt(30)
  v_mfma_f32_16x16x32_bf16 v[148:151], a[56:59], v[28:31], v[148:151]
  v_mfma_f32_16x16x32_bf16 v[152:155], a[60:63], v[28:31], v[152:155]
  v_max3_u32 v170, v28, v29, v170
  v_max3_u32 v170, v30, v31, v170
  s_waitcnt vmcnt(29)
  v_mfma_f32_16x16x32_bf16 v[148:151], a[64:67], v[32:35], v[148:151]
  v_mfma_f32_16x16x32_bf16 v[152:155], a[68:71], v[32:35], v[152:155]
  v_max3_u32 v170, v32, v33, v170
  v_max3_u32 v170, v34, v35, v170
  s_waitcnt vmcnt(28)
  v_mfma_f32_16x16x32_bf16 v[148:151], a[72:75], v[36:39], v[148:151]
  v_mfma_f32_16x16x32_bf16 v[152:155], a[76:79], v[36:39], v[152:155]
  v_max3_u32 v170, v36, v37, v170
  v_max3_u32 v170, v38, v39, v170
  s_waitcnt vmcnt(27)
  v_mfma_f32_16x16x32_bf16 v[148:151], a[80:83], v[40:43], v[148:151]
  v_mfma_f32_16x16x32_bf16 v[152:155], a[84:87], v[40:43], v[152:155]
  v_max3_u32 v170, v40, v41, v170
  v_max3_u32 v170, v42, v43, v170
  s_waitcnt vmcnt(26)
  v_mfma_f32_16x16x32_bf16 v[148:151], a[88:91], v[44:47], v[148:151]
  v_mfma_f32_16x16x32_bf16 v[152:155], a[92:95], v[44:47], v[152:155]
  v_max3_u32 v170, v44, v45, v170
  v_max3_u32 v170, v46, v47, v170
  s_waitcnt vmcnt(25)
  v_mfma_f32_16x16x32_bf16 v[148:151], a[96:99], v[48:51], v[148:151]
  v_mfma_f32_16x16x32_bf16 v[152:155], a[100:103], v[48:51], v[152:155]
  v_max3_u32 v170, v48, v49, v170
  v_max3_u32 v170, v50, v51, v170
  s_waitcnt vmcnt(24)
  v_mfma_f32_16x16x32_bf16 v[148:151], a[104:107], v[52:55], v[148:151]
  v_mfma_f32_16x16x32_bf16 v[152:155], a[108:111], v[52:55], v[152:155]
  v_max3_u32 v170, v52, v53, v170
  v_max3_u32 v170, v54, v55, v170
  s_waitcnt vmcnt(23)
  v_mfma_f32_16x16x32_bf16 v[148:151], a[112:115], v[56:59], v[148:151]
  v_mfma_f32_16x16x32_bf16 v[152:155], a[116:119], v[56:59], v[152:155]
  v_max3_u32 v170, v56, v57, v170
  v_max3_u32 v170, v58, v59, v170
  s_waitcnt vmcnt(22)
  v_mfma_f32_16x16x32_bf16 v[148:151], a[120:123], v[60:63], v[148:151]
  v_mfma_f32_16x16x32_bf16 v[152:155], a[124:127], v[60:63], v[152:155]
  v_max3_u32 v170, v60, v61, v170
  v_max3_u32 v170, v62, v63, v170
  s_waitcnt vmcnt(21)
  v_mfma_f32_16x16x32_bf16 v[148:151], a[128:131], v[64:67], v[148:151]
  v_mfma_f32_16x16x32_bf16 v[152:155], a[132:135], v[64:67], v[152:155]
  v_max3_u32 v170, v64, v65, v170
  v_max3_u32 v170, v66, v67, v170
  s_waitcnt vmcnt(20)
  v_mfma_f32_16x16x32_bf16 v[148:151], a[136:139], v[68:71], v[148:151]
  v_mfma_f32_16x16x32_bf16 v[152:155], a[140:143], v[68:71], v[152:155]
  v_max3_u32 v170, v68, v69, v170
  v_max3_u32 v170, v70, v71, v170
  s_waitcnt vmcnt(19)
  v_mfma_f32_16x16x32_bf16 v[148:151], a[144:147], v[72:75], v[148:151]
  v_mfma_f32_16x16x32_bf16 v[152:155], a[148:151], v[72:75], v[152:155]
  v_max3_u32 v170, v72, v73, v170
  v_max3_u32 v170, v74, v75, v170
  s_waitcnt vmcnt(18)
  v_mfma_f32_16x16x32_bf16 v[148:151], a[152:155], v[76:79], v[148:151]
  v_mfma_f32_16x16x32_bf16 v[152:155], a[156:159], v[76:79], v[152:155]
  v_max3_u32 v170, v76, v77, v170
  v_max3_u32 v170, v78, v79, v170
  s_waitcnt vmcnt(17)
  v_mfma_f32_16x16x32_bf16 v[148:151], a[160:163], v[80:83], v[148:151]
  v_mfma_f32_16x16x32_bf16 v[152:155], a[164:167], v[80:83], v[152:155]
  v_max3_u32 v170, v80, v81, v170
  v_max3_u32 v170, v82, v83, v170
  s_waitcnt vmcnt(16)
  v_mfma_f32_16x16x32_bf16 v[148:151], a[168:171], v[84:87], v[148:151]
  v_mfma_f32_16x16x32_bf16 v[152:155], a[172:175], v[84:87], v[152:155]
  v_max3_u32 v170, v84, v85, v170
  v_max3_u32 v170, v86, v87, v170
  s_waitcnt vmcnt(15)
  v_mfma_f32_16x16x32_bf16 v[148:151], a[176:179], v[88:91], v[148:151]
  v_mfma_f32_16x16x32_bf16 v[152:155], a[180:183], v[88:91], v[152:155]
  v_max3_u32 v170, v88, v89, v170
  v_max3_u32 v170, v90, v91, v170
  s_waitcnt vmcnt(14)
  v_mfma_f32_16x16x32_bf16 v[148:151], a[184:187], v[92:95], v[148:151]
  v_mfma_f32_16x16x32_bf16 v[152:155], a[188:191], v[92:95], v[152:155]
  v_max3_u32 v170, v92, v93, v170
  v_max3_u32 v170, v94, v95, v170
  s_waitcnt vmcnt(13)
  v_mfma_f32_16x16x32_bf16 v[148:151], a[192:195], v[96:99], v[148:151]
  v_mfma_f32_16x16x32_bf16 v[152:155], a[196:199], v[96:99], v[152:155]
  v_max3_u32 v170, v96, v97, v170
  v_max3_u32 v170, v98, v99, v170
  s_waitcnt vmcnt(12)
  v_mfma_f32_16x16x32_bf16 v[148:151], a[200:203], v[100:103], v[148:151]
  v_mfma_f32_16x16x32_bf16 v[152:155], a[204:207], v[100:103], v[152:155]
  v_max3_u32 v170, v100, v101, v170
  v_max3_u32 v170, v102, v103, v170
  s_waitcnt vmcnt(11)
  v_mfma_f32_16x16x32_bf16 v[148:151], a[208:211], v[104:107], v[148:151]
  v_mfma_f32_16x16x32_bf16 v[152:155], a[212:215], v[104:107], v[152:155]
  v_max3_u32 v170, v104, v105, v170
  v_max3_u32 v170, v106, v107, v170
  s_waitcnt vmcnt(10)
  v_mfma_f32_16x16x32_bf16 v[148:151], a[216:219], v[108:111], v[148:151]
  v_mfma_f32_16x16x32_bf16 v[152:155], a[220:223], v[108:111], v[152:155]
  v_max3_u32 v170, v108, v109, v170
  v_max3_u32 v170, v110, v111, v170
  s_waitcnt vmcnt(9)
  v_mfma_f32_16x16x32_bf16 v[148:151], a[224:227], v[112:115], v[148:151]
  v_mfma_f32_16x16x32_bf16 v[152:155], a[228:231], v[112:115], v[152:155]
  v_max3_u32 v170, v112, v113, v170
  v_max3_u32 v170, v114, v115, v170
  s_waitcnt vmcnt(8)
  v_mfma_f32_16x16x32_bf16 v[148:151], a[232:235], v[116:119], v[148:151]
  v_mfma_f32_16x16x32_bf16 v[152:155], a[236:239], v[116:119], v[152:155]
  v_max3_u32 v170, v116, v117, v170
  v_max3_u32 v170, v118, v119, v170
  s_waitcnt vmcnt(7)
  v_mfma_f32_16x16x32_bf16 v[148:151], a[240:243], v[120:123], v[148:151]
  v_mfma_f32_16x16x32_bf16 v[152:155], a[244:247], v[120:123], v[152:155]
  v_max3_u32 v170, v120, v121, v170
  v_max3_u32 v170, v122, v123, v170
  s_waitcnt vmcnt(6)
  v_mfma_f32_16x16x32_bf16 v[148:151], a[248:251], v[124:127], v[148:151]
  v_mfma_f32_16x16x32_bf16 v[152:155], a[252:255], v[124:127], v[152:155]
  v_max3_u32 v170, v124, v125, v170
  v_max3_u32 v170, v126, v127, v170
  v_cmp_lt_u32 vcc, s54, v170
  s_cbranch_vccnz O_ld
  v_fmac_f32 v156, v165, v148
  v_fmac_f32 v157, v165, v149
  v_fmac_f32 v158, v165, v150
  v_fmac_f32 v159, v165, v151
  v_fmac_f32 v160, v165, v152
  v_fmac_f32 v161, v165, v153
  v_fmac_f32 v162, v165, v154
  v_fmac_f32 v163, v165, v155
  ds_write_b128 v168, v[156:159]
  ds_write_b128 v168, v[160:163] offset:1024
  v_xor_b32 v168, 0x2000, v168
  s_mov_b32 s59, s57
  s_waitcnt lgkmcnt(0)
  s_barrier
  s_cmp_eq_u32 s52, 0
  s_cbranch_scc0 O_next
  v_xor_b32 v211, 0x2000, v168
  ds_read_b128 v[0:3], v211 offset:2048
  ds_read_b128 v[4:7], v211 offset:3072
  ds_read_b128 v[8:11], v211 offset:4096
  ds_read_b128 v[12:15], v211 offset:5120
  ds_read_b128 v[16:19], v211 offset:6144
  ds_read_b128 v[20:23], v211 offset:7168
  s_waitcnt lgkmcnt(5)
  v_add_f32 v156, v156, v0
  v_add_f32 v157, v157, v1
  v_add_f32 v158, v158, v2
  v_add_f32 v159, v159, v3
  s_waitcnt lgkmcnt(4)
  v_add_f32 v160, v160, v4
  v_add_f32 v161, v161, v5
  v_add_f32 v162, v162, v6
  v_add_f32 v163, v163, v7
  s_waitcnt lgkmcnt(3)
  v_add_f32 v156, v156, v8
  v_add_f32 v157, v157, v9
  v_add_f32 v158, v158, v10
  v_add_f32 v159, v159, v11
  s_waitcnt lgkmcnt(2)
  v_add_f32 v160, v160, v12
  v_add_f32 v161, v161, v13
  v_add_f32 v162, v162, v14
  v_add_f32 v163, v163, v15
  s_waitcnt lgkmcnt(1)
  v_add_f32 v156, v156, v16
  v_add_f32 v157, v157, v17
  v_add_f32 v158, v158, v18
  v_add_f32 v159, v159, v19
  s_waitcnt lgkmcnt(0)
  v_add_f32 v160, v160, v20
  v_add_f32 v161, v161, v21
  v_add_f32 v162, v162, v22
  v_add_f32 v163, v163, v23
  v_cvt_pk_bf16_f32 v148, v156, v157
  v_cvt_pk_bf16_f32 v149, v158, v159
  v_cvt_pk_bf16_f32 v150, v160, v161
  v_cvt_pk_bf16_f32 v151, v162, v163
  buffer_store_dwordx4 v[148:151], v167, s[48:51], s64 offen
  s_waitcnt vmcnt(1)
  s_branch O_nx2
O_next:
  s_waitcnt vmcnt(0)
O_nx2:
  s_cmp_lt_u32 s59, 64
  s_cbranch_scc1 O_loop
  s_branch L_exit
W_h:
  s_lshr_b32 s58, s53, 1
  s_and_b32 s59, s53, 1
  s_mul_i32 s60, s59, 36864
  s_add_u32 m0, s67, 0
  s_nop 0
  buffer_load_dwordx4 v202, s[4:7], s60 offen offset:0 lds
  s_add_u32 m0, s67, 896
  s_nop 0
  buffer_load_dwordx4 v202, s[4:7], s60 offen offset:128 lds
  s_add_u32 m0, s67, 1792
  s_nop 0
  buffer_load_dwordx4 v202, s[4:7], s60 offen offset:256 lds
  s_add_u32 m0, s67, 2688
  s_nop 0
  buffer_load_dwordx4 v202, s[4:7], s60 offen offset:384 lds
  s_add_u32 m0, s67, 3584
  s_nop 0
  buffer_load_dwordx4 v202, s[4:7], s60 offen offset:512 lds
  s_add_u32 m0, s67, 4480
  s_nop 0
  buffer_load_dwordx4 v202, s[4:7], s60 offen offset:640 lds
  s_add_u32 m0, s67, 5376
  s_nop 0
  buffer_load_dwordx4 v202, s[4:7], s60 offen offset:768 lds
  s_add_u32 m0, s67, 6272
  s_nop 0
  buffer_load_dwordx4 v202, s[4:7], s60 offen offset:896 lds
  s_add_u32 m0, s67, 7168
  s_nop 0
  buffer_load_dwordx4 v202, s[4:7], s60 offen offset:1024 lds
  v_lshrrev_b32 v211, 4, v200
  v_lshlrev_b32 v212, 2, v211
  v_and_b32 v213, 15, v200
  v_xor_b32 v212, v212, v213
  v_lshlrev_b32 v212, 4, v212
  v_lshl_add_u32 v207, v211, 13, v212
  s_lshl_b32 s62, s58, 8
  s_lshl_b32 s54, s52, 15
  s_add_u32 s62, s62, s54
  s_lshl_b32 s61, s52, 10
  s_add_u32 s61, s61, 36864
  s_add_u32 m0, s61, 0
  s_add_u32 s54, s62, 0
  buffer_load_dwordx4 v207, s[16:19], s54 offen lds
  s_add_u32 m0, s61, 4096
  s_add_u32 s54, s62, 131072
  buffer_load_dwordx4 v207, s[16:19], s54 offen lds
  s_add_u32 m0, s61, 8192
  s_add_u32 s54, s62, 262144
  buffer_load_dwordx4 v207, s[16:19], s54 offen lds
  s_add_u32 m0, s61, 12288
  s_add_u32 s54, s62, 393216
  buffer_load_dwordx4 v207, s[16:19], s54 offen lds
  s_add_u32 m0, s61, 16384
  s_add_u32 s54, s62, 524288
  buffer_load_dwordx4 v207, s[16:19], s54 offen lds
  s_add_u32 m0, s61, 20480
  s_add_u32 s54, s62, 655360
  buffer_load_dwordx4 v207, s[16:19], s54 offen lds
  s_add_u32 m0, s61, 24576
  s_add_u32 s54, s62, 786432
  buffer_load_dwordx4 v207, s[16:19], s54 offen lds
  s_add_u32 m0, s61, 28672
  s_add_u32 s54, s62, 917504
  buffer_load_dwordx4 v207, s[16:19], s54 offen lds
  s_add_u32 m0, s61, 32768
  s_add_u32 s54, s62, 1048576
  buffer_load_dwordx4 v207, s[16:19], s54 offen lds
  s_add_u32 m0, s61, 36864
  s_add_u32 s54, s62, 1179648
  buffer_load_dwordx4 v207, s[16:19], s54 offen lds
  s_add_u32 m0, s61, 40960
  s_add_u32 s54, s62, 1310720
  buffer_load_dwordx4 v207, s[16:19], s54 offen lds
  s_add_u32 m0, s61, 45056
  s_add_u32 s54, s62, 1441792
  buffer_load_dwordx4 v207, s[16:19], s54 offen lds
  s_add_u32 m0, s61, 49152
  s_add_u32 s54, s62, 1572864
  buffer_load_dwordx4 v207, s[16:19], s54 offen lds
  s_add_u32 m0, s61, 53248
  s_add_u32 s54, s62, 1703936
  buffer_load_dwordx4 v207, s[16:19], s54 offen lds
  s_add_u32 m0, s61, 57344
  s_add_u32 s54, s62, 1835008
  buffer_load_dwordx4 v207, s[16:19], s54 offen lds
  s_add_u32 m0, s61, 61440
  s_add_u32 s54, s62, 1966080
  buffer_load_dwordx4 v207, s[16:19], s54 offen lds
  s_add_u32 m0, s61, 65536
  s_add_u32 s54, s62, 2097152
  buffer_load_dwordx4 v207, s[16:19], s54 offen lds
  s_add_u32 m0, s61, 69632
  s_add_u32 s54, s62, 2228224
  buffer_load_dwordx4 v207, s[16:19], s54 offen lds
  s_add_u32 m0, s61, 73728
  s_add_u32 s54, s62, 2359296
  buffer_load_dwordx4 v207, s[16:19], s54 offen lds
  s_add_u32 m0, s61, 77824
  s_add_u32 s54, s62, 2490368
  buffer_load_dwordx4 v207, s[16:19], s54 offen lds
  s_add_u32 m0, s61, 81920
  s_add_u32 s54, s62, 2621440
  buffer_load_dwordx4 v207, s[16:19], s54 offen lds
  s_add_u32 m0, s61, 86016
  s_add_u32 s54, s62, 2752512
  buffer_load_dwordx4 v207, s[16:19], s54 offen lds
  s_add_u32 m0, s61, 90112
  s_add_u32 s54, s62, 2883584
  buffer_load_dwordx4 v207, s[16:19], s54 offen lds
  s_add_u32 m0, s61, 94208
  s_add_u32 s54, s62, 3014656
  buffer_load_dwordx4 v207, s[16:19], s54 offen lds
  s_waitcnt vmcnt(20) lgkmcnt(0)
  s_barrier
  s_add_u32 m0, s61, 98304
  s_add_u32 s54, s62, 3145728
  buffer_load_dwordx4 v207, s[16:19], s54 offen lds
  s_add_u32 m0, s61, 102400
  s_add_u32 s54, s62, 3276800
  buffer_load_dwordx4 v207, s[16:19], s54 offen lds
  s_add_u32 m0, s61, 106496
  s_add_u32 s54, s62, 3407872
  buffer_load_dwordx4 v207, s[16:19], s54 offen lds
  s_add_u32 m0, s61, 110592
  s_add_u32 s54, s62, 3538944
  buffer_load_dwordx4 v207, s[16:19], s54 offen lds
  v_add_u32 v215, 36864, v209
  ds_read_b64_tr_b16 a[0:1], v215 offset:0
  ds_read_b64_tr_b16 a[2:3], v215 offset:1024
  ds_read_b64_tr_b16 a[4:5], v215 offset:4096
  ds_read_b64_tr_b16 a[6:7], v215 offset:5120
  ds_read_b64_tr_b16 a[8:9], v215 offset:8192
  ds_read_b64_tr_b16 a[10:11], v215 offset:9216
  ds_read_b64_tr_b16 a[12:13], v215 offset:12288
  ds_read_b64_tr_b16 a[14:15], v215 offset:13312
  s_waitcnt vmcnt(20) lgkmcnt(0)
  s_barrier
  s_add_u32 m0, s61, 0
  s_add_u32 s54, s62, 3670016
  buffer_load_dwordx4 v207, s[16:19], s54 offen lds
  s_add_u32 m0, s61, 4096
  s_add_u32 s54, s62, 3801088
  buffer_load_dwordx4 v207, s[16:19], s54 offen lds
  s_add_u32 m0, s61, 8192
  s_add_u32 s54, s62, 3932160
  buffer_load_dwordx4 v207, s[16:19], s54 offen lds
  s_add_u32 m0, s61, 12288
  s_add_u32 s54, s62, 4063232
  buffer_load_dwordx4 v207, s[16:19], s54 offen lds
  v_add_u32 v215, 53248, v209
  ds_read_b64_tr_b16 a[16:17], v215 offset:0
  ds_read_b64_tr_b16 a[18:19], v215 offset:1024
  ds_read_b64_tr_b16 a[20:21], v215 offset:4096
  ds_read_b64_tr_b16 a[22:23], v215 offset:5120
  ds_read_b64_tr_b16 a[24:25], v215 offset:8192
  ds_read_b64_tr_b16 a[26:27], v215 offset:9216
  ds_read_b64_tr_b16 a[28:29], v215 offset:12288
  ds_read_b64_tr_b16 a[30:31], v215 offset:13312
  s_waitcnt vmcnt(20) lgkmcnt(0)
  s_barrier
  s_add_u32 m0, s61, 16384
  s_add_u32 s54, s62, 4194304
  buffer_load_dwordx4 v207, s[16:19], s54 offen lds
  s_add_u32 m0, s61, 20480
  s_add_u32 s54, s62, 4325376
  buffer_load_dwordx4 v207, s[16:19], s54 offen lds
  s_add_u32 m0, s61, 24576
  s_add_u32 s54, s62, 4456448
  buffer_load_dwordx4 v207, s[16:19], s54 offen lds
  s_add_u32 m0, s61, 28672
  s_add_u32 s54, s62, 4587520
  buffer_load_dwordx4 v207, s[16:19], s54 offen lds
  v_add_u32 v215, 69632, v209
  ds_read_b64_tr_b16 a[32:33], v215 offset:0
  ds_read_b64_tr_b16 a[34:35], v215 offset:1024
  ds_read_b64_tr_b16 a[36:37], v215 offset:4096
  ds_read_b64_tr_b16 a[38:39], v215 offset:5120
  ds_read_b64_tr_b16 a[40:41], v215 offset:8192
  ds_read_b64_tr_b16 a[42:43], v215 offset:9216
  ds_read_b64_tr_b16 a[44:45], v215 offset:12288
  ds_read_b64_tr_b16 a[46:47], v215 offset:13312
  s_waitcnt vmcnt(20) lgkmcnt(0)
  s_barrier
  v_add_u32 v215, 86016, v209
  ds_read_b64_tr_b16 a[48:49], v215 offset:0
  ds_read_b64_tr_b16 a[50:51], v215 offset:1024
  ds_read_b64_tr_b16 a[52:53], v215 offset:4096
  ds_read_b64_tr_b16 a[54:55], v215 offset:5120
  ds_read_b64_tr_b16 a[56:57], v215 offset:8192
  ds_read_b64_tr_b16 a[58:59], v215 offset:9216
  ds_read_b64_tr_b16 a[60:61], v215 offset:12288
  ds_read_b64_tr_b16 a[62:63], v215 offset:13312
  s_waitcnt vmcnt(16) lgkmcnt(0)
  s_barrier
  v_add_u32 v215, 102400, v209
  ds_read_b64_tr_b16 a[64:65], v215 offset:0
  ds_read_b64_tr_b16 a[66:67], v215 offset:1024
  ds_read_b64_tr_b16 a[68:69], v215 offset:4096
  ds_read_b64_tr_b16 a[70:71], v215 offset:5120
  ds_read_b64_tr_b16 a[72:73], v215 offset:8192
  ds_read_b64_tr_b16 a[74:75], v215 offset:9216
  ds_read_b64_tr_b16 a[76:77], v215 offset:12288
  ds_read_b64_tr_b16 a[78:79], v215 offset:13312
  s_waitcnt vmcnt(12) lgkmcnt(0)
  s_barrier
  v_add_u32 v215, 118784, v209
  ds_read_b64_tr_b16 a[80:81], v215 offset:0
  ds_read_b64_tr_b16 a[82:83], v215 offset:1024
  ds_read_b64_tr_b16 a[84:85], v215 offset:4096
  ds_read_b64_tr_b16 a[86:87], v215 offset:5120
  ds_read_b64_tr_b16 a[88:89], v215 offset:8192
  ds_read_b64_tr_b16 a[90:91], v215 offset:9216
  ds_read_b64_tr_b16 a[92:93], v215 offset:12288
  ds_read_b64_tr_b16 a[94:95], v215 offset:13312
  s_waitcnt vmcnt(8) lgkmcnt(0)
  s_barrier
  v_add_u32 v215, 135168, v209
  ds_read_b64_tr_b16 a[96:97], v215 offset:0
  ds_read_b64_tr_b16 a[98:99], v215 offset:1024
  ds_read_b64_tr_b16 a[100:101], v215 offset:4096
  ds_read_b64_tr_b16 a[102:103], v215 offset:5120
  ds_read_b64_tr_b16 a[104:105], v215 offset:8192
  ds_read_b64_tr_b16 a[106:107], v215 offset:9216
  ds_read_b64_tr_b16 a[108:109], v215 offset:12288
  ds_read_b64_tr_b16 a[110:111], v215 offset:13312
  s_waitcnt vmcnt(4) lgkmcnt(0)
  s_barrier
  v_add_u32 v215, 36864, v209
  ds_read_b64_tr_b16 a[112:113], v215 offset:0
  ds_read_b64_tr_b16 a[114:115], v215 offset:1024
  ds_read_b64_tr_b16 a[116:117], v215 offset:4096
  ds_read_b64_tr_b16 a[118:119], v215 offset:5120
  ds_read_b64_tr_b16 a[120:121], v215 offset:8192
  ds_read_b64_tr_b16 a[122:123], v215 offset:9216
  ds_read_b64_tr_b16 a[124:125], v215 offset:12288
  ds_read_b64_tr_b16 a[126:127], v215 offset:13312
  s_waitcnt vmcnt(0) lgkmcnt(0)
  s_barrier
  v_add_u32 v215, 53248, v209
  ds_read_b64_tr_b16 a[128:129], v215 offset:0
  ds_read_b64_tr_b16 a[130:131], v215 offset:1024
  ds_read_b64_tr_b16 a[132:133], v215 offset:4096
  ds_read_b64_tr_b16 a[134:135], v215 offset:5120
  ds_read_b64_tr_b16 a[136:137], v215 offset:8192
  ds_read_b64_tr_b16 a[138:139], v215 offset:9216
  ds_read_b64_tr_b16 a[140:141], v215 offset:12288
  ds_read_b64_tr_b16 a[142:143], v215 offset:13312
  s_waitcnt lgkmcnt(0)
  s_barrier
  v_and_b32 v211, 31, v200
  v_lshrrev_b32 v212, 5, v200
  v_lshlrev_b32 v213, 2, v212
  v_sub_u32 v211, v211, v213
  v_mov_b32 v214, 0xf149f2ca
  v_cmp_gt_i32 vcc, 0, v211
  s_nop 1
  v_cndmask_b32 v48, 0, v214, vcc
  v_cmp_gt_i32 vcc, 1, v211
  s_nop 1
  v_cndmask_b32 v49, 0, v214, vcc
  v_cmp_gt_i32 vcc, 2, v211
  s_nop 1
  v_cndmask_b32 v50, 0, v214, vcc
  v_cmp_gt_i32 vcc, 3, v211
  s_nop 1
  v_cndmask_b32 v51, 0, v214, vcc
  v_cmp_gt_i32 vcc, 8, v211
  s_nop 1
  v_cndmask_b32 v52, 0, v214, vcc
  v_cmp_gt_i32 vcc, 9, v211
  s_nop 1
  v_cndmask_b32 v53, 0, v214, vcc
  v_cmp_gt_i32 vcc, 10, v211
  s_nop 1
  v_cndmask_b32 v54, 0, v214, vcc
  v_cmp_gt_i32 vcc, 11, v211
  s_nop 1
  v_cndmask_b32 v55, 0, v214, vcc
  v_cmp_gt_i32 vcc, 16, v211
  s_nop 1
  v_cndmask_b32 v56, 0, v214, vcc
  v_cmp_gt_i32 vcc, 17, v211
  s_nop 1
  v_cndmask_b32 v57, 0, v214, vcc
  v_cmp_gt_i32 vcc, 18, v211
  s_nop 1
  v_cndmask_b32 v58, 0, v214, vcc
  v_cmp_gt_i32 vcc, 19, v211
  s_nop 1
  v_cndmask_b32 v59, 0, v214, vcc
  v_cmp_gt_i32 vcc, 24, v211
  s_nop 1
  v_cndmask_b32 v60, 0, v214, vcc
  v_cmp_gt_i32 vcc, 25, v211
  s_nop 1
  v_cndmask_b32 v61, 0, v214, vcc
  v_cmp_gt_i32 vcc, 26, v211
  s_nop 1
  v_cndmask_b32 v62, 0, v214, vcc
  v_cmp_gt_i32 vcc, 27, v211
  s_nop 1
  v_cndmask_b32 v63, 0, v214, vcc
  v_and_b32 v218, 0xff, v216
  v_add_u32 v218, 81920, v218
  v_and_b32 v211, 15, v200
  v_lshl_add_u32 v211, v212, 5, v211
  v_lshlrev_b32 v219, 3, v211
  v_bfe_u32 v211, v200, 4, 1
  v_lshl_add_u32 v219, v211, 2, v219
  s_lshl_b32 s54, s52, 9
  s_add_u32 s54, s54, 83968
  v_add_u32 v219, s54, v219
  v_lshl_add_u32 v221, v200, 3, s54
  s_lshr_b32 s54, s52, 1
  s_lshl_b32 s54, s54, 10
  s_and_b32 s55, s52, 1
  s_lshl_b32 s55, s55, 3
  s_add_u32 s54, s54, s55
  s_add_u32 s54, s54, 81920
  v_add_u32 v220, s54, v201
  s_lshl_b32 s54, s52, 11
  s_add_u32 s54, s54, 73728
  v_add_u32 v215, s54, v201
  v_add_u32 v208, 73728, v201
  s_mov_b32 s68, 1040356334
  s_cmp_eq_u32 s52, 0
  s_cselect_b32 s71, s71, 268435456
  s_lshl_b32 s56, s58, 2
  s_add_u32 s56, s56, 128
  v_mov_b32 v176, -1
  v_mov_b32 v177, -1
  v_mov_b32 v178, -1
  v_mov_b32 v179, -1
  s_cmp_eq_u32 s52, 0
  s_cbranch_scc0 AT_p1_d
  s_mov_b32 exec_hi, 0
  s_mov_b32 exec_lo, 1
AT_p1:
  buffer_load_dword v211, v201, s[12:15], s56 offen sc1
  s_add_u32 s65, s65, 1
  s_waitcnt vmcnt(0)
  v_cmp_gt_u32 vcc, 0x700, v211
  s_cbranch_vccz AT_p1_x
  s_sleep 8
  s_cmp_lt_u32 s65, 131072
  s_cbranch_scc1 AT_p1
AT_p1_x:
  s_mov_b64 exec, -1
AT_p1_d:
  s_barrier
  s_mov_b32 s74, s59
  s_mul_i32 s66, s59, 655360
  s_lshl_b32 s55, s58, 14
  s_add_u32 s55, s55, s66
  s_add_u32 s55, s55, 1048576
  s_lshl_b32 s73, s58, 2
  s_add_u32 s73, s73, s52
  s_lshl_b32 s72, s59, 7
  s_add_u32 s72, s72, s73
  s_lshl_b32 s72, s72, 11
  s_add_u32 s72, s72, 46137344
  s_lshl_b32 s73, s73, 10
  s_add_u32 s73, s73, s66
  s_add_u32 s73, s73, 1572864
  s_add_u32 s59, s59, 2
  buffer_load_dwordx4 v[128:131], v216, s[8:11], s55 offen offset:0 sc1
  buffer_load_dwordx4 v[132:135], v216, s[8:11], s55 offen offset:256 sc1
  buffer_load_dwordx4 v[136:139], v216, s[8:11], s55 offen offset:512 sc1
  buffer_load_dwordx4 v[140:143], v216, s[8:11], s55 offen offset:768 sc1
  buffer_load_dwordx4 v[144:147], v216, s[8:11], s55 offen offset:1024 sc1
  buffer_load_dwordx4 v[148:151], v216, s[8:11], s55 offen offset:1280 sc1
  buffer_load_dwordx4 v[152:155], v216, s[8:11], s55 offen offset:1536 sc1
  buffer_load_dwordx4 v[156:159], v216, s[8:11], s55 offen offset:1792 sc1
  buffer_load_dwordx4 v[160:163], v217, s[8:11], s55 offen offset:0 sc1
  buffer_load_dwordx4 v[164:167], v217, s[8:11], s55 offen offset:256 sc1
  s_add_u32 s60, s60, 73728
  ds_read_b128 v[32:35], v203 offset:0
  ds_read_b128 v[36:39], v204 offset:0
  ds_read_b128 v[40:43], v205 offset:0
  s_waitcnt lgkmcnt(2)
  v_mfma_f32_32x32x16_bf16 v[240:255], a[0:3], v[32:35], 0
  ds_read_b128 v[44:47], v206 offset:0
  s_add_u32 m0, s67, 36864
  s_nop 0
  buffer_load_dwordx4 v202, s[4:7], s60 offen offset:0 lds
  s_waitcnt lgkmcnt(2)
  v_mfma_f32_32x32x16_bf16 v[240:255], a[4:7], v[36:39], v[240:255]
  ds_read_b128 v[32:35], v203 offset:1024
  s_waitcnt lgkmcnt(2)
  v_mfma_f32_32x32x16_bf16 v[240:255], a[8:11], v[40:43], v[240:255]
  ds_read_b128 v[36:39], v204 offset:1024
  s_add_u32 m0, s67, 37760
  s_nop 0
  buffer_load_dwordx4 v202, s[4:7], s60 offen offset:128 lds
  s_waitcnt lgkmcnt(2)
  v_mfma_f32_32x32x16_bf16 v[240:255], a[12:15], v[44:47], v[240:255]
  ds_read_b128 v[40:43], v205 offset:1024
  s_waitcnt lgkmcnt(2)
  v_mfma_f32_32x32x16_bf16 v[240:255], a[16:19], v[32:35], v[240:255]
  ds_read_b128 v[44:47], v206 offset:1024
  s_add_u32 m0, s67, 38656
  s_nop 0
  buffer_load_dwordx4 v202, s[4:7], s60 offen offset:256 lds
  s_waitcnt lgkmcnt(2)
  v_mfma_f32_32x32x16_bf16 v[240:255], a[20:23], v[36:39], v[240:255]
  ds_read_b128 v[32:35], v203 offset:2048
  s_waitcnt lgkmcnt(2)
  v_mfma_f32_32x32x16_bf16 v[240:255], a[24:27], v[40:43], v[240:255]
  ds_read_b128 v[36:39], v204 offset:2048
  s_add_u32 m0, s67, 39552
  s_nop 0
  buffer_load_dwordx4 v202, s[4:7], s60 offen offset:384 lds
  s_waitcnt lgkmcnt(2)
  v_mfma_f32_32x32x16_bf16 v[240:255], a[28:31], v[44:47], v[240:255]
  ds_read_b128 v[40:43], v205 offset:2048
  s_waitcnt lgkmcnt(2)
  v_mfma_f32_32x32x16_bf16 v[240:255], a[32:35], v[32:35], v[240:255]
  ds_read_b128 v[44:47], v206 offset:2048
  s_add_u32 m0, s67, 40448
  s_nop 0
  buffer_load_dwordx4 v202, s[4:7], s60 offen offset:512 lds
  s_waitcnt lgkmcnt(2)
  v_mfma_f32_32x32x16_bf16 v[240:255], a[36:39], v[36:39], v[240:255]
  ds_read_b128 v[32:35], v203 offset:3072
  s_waitcnt lgkmcnt(2)
  v_mfma_f32_32x32x16_bf16 v[240:255], a[40:43], v[40:43], v[240:255]
  ds_read_b128 v[36:39], v204 offset:3072
  s_add_u32 m0, s67, 41344
  s_nop 0
  buffer_load_dwordx4 v202, s[4:7], s60 offen offset:640 lds
  s_waitcnt lgkmcnt(2)
  v_mfma_f32_32x32x16_bf16 v[240:255], a[44:47], v[44:47], v[240:255]
  ds_read_b128 v[40:43], v205 offset:3072
  s_waitcnt lgkmcnt(2)
  v_mfma_f32_32x32x16_bf16 v[240:255], a[48:51], v[32:35], v[240:255]
  ds_read_b128 v[44:47], v206 offset:3072
  s_add_u32 m0, s67, 42240
  s_nop 0
  buffer_load_dwordx4 v202, s[4:7], s60 offen offset:768 lds
  s_waitcnt lgkmcnt(2)
  v_mfma_f32_32x32x16_bf16 v[240:255], a[52:55], v[36:39], v[240:255]
  ds_read_b128 v[32:35], v203 offset:4096
  s_waitcnt lgkmcnt(2)
  v_mfma_f32_32x32x16_bf16 v[240:255], a[56:59], v[40:43], v[240:255]
  ds_read_b128 v[36:39], v204 offset:4096
  s_add_u32 m0, s67, 43136
  s_nop 0
  buffer_load_dwordx4 v202, s[4:7], s60 offen offset:896 lds
  s_waitcnt lgkmcnt(2)
  v_mfma_f32_32x32x16_bf16 v[240:255], a[60:63], v[44:47], v[240:255]
  ds_read_b128 v[40:43], v205 offset:4096
  s_waitcnt lgkmcnt(2)
  v_mfma_f32_32x32x16_bf16 v[240:255], a[64:67], v[32:35], v[240:255]
  ds_read_b128 v[44:47], v206 offset:4096
  s_add_u32 m0, s67, 44032
  s_nop 0
  buffer_load_dwordx4 v202, s[4:7], s60 offen offset:1024 lds
  s_waitcnt lgkmcnt(2)
  v_mfma_f32_32x32x16_bf16 v[240:255], a[68:71], v[36:39], v[240:255]
  ds_read_b128 v[32:35], v203 offset:5120
  s_waitcnt lgkmcnt(2)
  v_mfma_f32_32x32x16_bf16 v[240:255], a[72:75], v[40:43], v[240:255]
  ds_read_b128 v[36:39], v204 offset:5120
  buffer_store_dwordx4 v[176:179], v201, s[8:11], s72 offen offset:0 sc1
  s_waitcnt lgkmcnt(2)
  v_mfma_f32_32x32x16_bf16 v[240:255], a[76:79], v[44:47], v[240:255]
  ds_read_b128 v[40:43], v205 offset:5120
  s_waitcnt lgkmcnt(2)
  v_mfma_f32_32x32x16_bf16 v[240:255], a[80:83], v[32:35], v[240:255]
  ds_read_b128 v[44:47], v206 offset:5120
  buffer_store_dwordx4 v[176:179], v201, s[8:11], s72 offen offset:1024 sc1
  s_waitcnt lgkmcnt(2)
  v_mfma_f32_32x32x16_bf16 v[240:255], a[84:87], v[36:39], v[240:255]
  ds_read_b128 v[32:35], v203 offset:6144
  s_waitcnt lgkmcnt(2)
  v_mfma_f32_32x32x16_bf16 v[240:255], a[88:91], v[40:43], v[240:255]
  ds_read_b128 v[36:39], v204 offset:6144
  s_waitcnt lgkmcnt(2)
  v_mfma_f32_32x32x16_bf16 v[240:255], a[92:95], v[44:47], v[240:255]
  ds_read_b128 v[40:43], v205 offset:6144
  s_waitcnt lgkmcnt(2)
  v_mfma_f32_32x32x16_bf16 v[240:255], a[96:99], v[32:35], v[240:255]
  ds_read_b128 v[44:47], v206 offset:6144
  s_waitcnt lgkmcnt(2)
  v_mfma_f32_32x32x16_bf16 v[240:255], a[100:103], v[36:39], v[240:255]
  ds_read_b128 v[32:35], v203 offset:7168
  s_waitcnt lgkmcnt(2)
  v_mfma_f32_32x32x16_bf16 v[240:255], a[104:107], v[40:43], v[240:255]
  ds_read_b128 v[36:39], v204 offset:7168
  s_waitcnt lgkmcnt(2)
  v_mfma_f32_32x32x16_bf16 v[240:255], a[108:111], v[44:47], v[240:255]
  ds_read_b128 v[40:43], v205 offset:7168
  s_waitcnt lgkmcnt(2)
  v_mfma_f32_32x32x16_bf16 v[240:255], a[112:115], v[32:35], v[240:255]
  ds_read_b128 v[44:47], v206 offset:7168
  s_waitcnt lgkmcnt(2)
  v_mfma_f32_32x32x16_bf16 v[240:255], a[116:119], v[36:39], v[240:255]
  ds_read_b128 v[32:35], v203 offset:8192
  s_waitcnt lgkmcnt(2)
  v_mfma_f32_32x32x16_bf16 v[240:255], a[120:123], v[40:43], v[240:255]
  ds_read_b128 v[36:39], v204 offset:8192
  s_waitcnt lgkmcnt(2)
  v_mfma_f32_32x32x16_bf16 v[240:255], a[124:127], v[44:47], v[240:255]
  ds_read_b128 v[40:43], v205 offset:8192
  s_waitcnt lgkmcnt(2)
  v_mfma_f32_32x32x16_bf16 v[240:255], a[128:131], v[32:35], v[240:255]
  ds_read_b128 v[44:47], v206 offset:8192
  s_waitcnt lgkmcnt(2)
  v_mfma_f32_32x32x16_bf16 v[240:255], a[132:135], v[36:39], v[240:255]
  s_waitcnt lgkmcnt(1)
  v_mfma_f32_32x32x16_bf16 v[240:255], a[136:139], v[40:43], v[240:255]
  s_waitcnt lgkmcnt(0)
  v_mfma_f32_32x32x16_bf16 v[240:255], a[140:143], v[44:47], v[240:255]
  s_nop 11
  v_cvt_pk_bf16_f32 v16, v240, v244
  v_cvt_pk_bf16_f32 v17, v241, v245
  v_cvt_pk_bf16_f32 v18, v242, v246
  v_cvt_pk_bf16_f32 v19, v243, v247
  ds_write_b128 v215, v[16:19] offset:0
  v_cvt_pk_bf16_f32 v20, v248, v252
  v_cvt_pk_bf16_f32 v21, v249, v253
  v_cvt_pk_bf16_f32 v22, v250, v254
  v_cvt_pk_bf16_f32 v23, v251, v255
  ds_write_b128 v215, v[20:23] offset:1024
  s_waitcnt lgkmcnt(0)
  s_barrier
  ds_read_b128 v[96:99], v208 offset:0
  ds_read_b128 v[100:103], v208 offset:1024
  ds_read_b128 v[104:107], v208 offset:2048
  ds_read_b128 v[108:111], v208 offset:3072
  ds_read_b128 v[112:115], v208 offset:4096
  ds_read_b128 v[116:119], v208 offset:5120
  ds_read_b128 v[120:123], v208 offset:6144
  ds_read_b128 v[124:127], v208 offset:7168
  s_waitcnt vmcnt(20) lgkmcnt(7)
  v_mfma_f32_32x32x16_bf16 v[64:79], v[128:131], v[96:99], v[48:63]
  s_waitcnt vmcnt(19) lgkmcnt(6)
  v_mfma_f32_32x32x16_bf16 v[64:79], v[132:135], v[100:103], v[64:79]
  s_waitcnt vmcnt(18) lgkmcnt(5)
  v_mfma_f32_32x32x16_bf16 v[64:79], v[136:139], v[104:107], v[64:79]
  s_waitcnt vmcnt(17) lgkmcnt(4)
  v_mfma_f32_32x32x16_bf16 v[64:79], v[140:143], v[108:111], v[64:79]
  s_waitcnt vmcnt(16) lgkmcnt(3)
  v_mfma_f32_32x32x16_bf16 v[64:79], v[144:147], v[112:115], v[64:79]
  s_waitcnt vmcnt(15) lgkmcnt(2)
  v_mfma_f32_32x32x16_bf16 v[64:79], v[148:151], v[116:119], v[64:79]
  s_waitcnt vmcnt(14) lgkmcnt(1)
  v_mfma_f32_32x32x16_bf16 v[64:79], v[152:155], v[120:123], v[64:79]
  s_waitcnt vmcnt(13) lgkmcnt(0)
  v_mfma_f32_32x32x16_bf16 v[64:79], v[156:159], v[124:127], v[64:79]
  s_nop 11
  v_max3_f32 v180, v64, v65, v66
  v_max3_f32 v180, v180, v67, v68
  v_max3_f32 v180, v180, v69, v70
  v_max3_f32 v180, v180, v71, v72
  v_max3_f32 v180, v180, v73, v74
  v_max3_f32 v180, v180, v75, v76
  v_max3_f32 v180, v180, v77, v78
  v_max_f32 v180, v180, v79
  v_mov_b32 v181, v180
  s_nop 1
  v_permlane32_swap_b32 v180, v181
  v_max_f32 v180, v180, v181
  v_sub_f32 v64, v64, v180
  v_sub_f32 v65, v65, v180
  v_sub_f32 v66, v66, v180
  v_sub_f32 v67, v67, v180
  v_sub_f32 v68, v68, v180
  v_sub_f32 v69, v69, v180
  v_sub_f32 v70, v70, v180
  v_sub_f32 v71, v71, v180
  v_sub_f32 v72, v72, v180
  v_sub_f32 v73, v73, v180
  v_sub_f32 v74, v74, v180
  v_sub_f32 v75, v75, v180
  v_sub_f32 v76, v76, v180
  v_sub_f32 v77, v77, v180
  v_sub_f32 v78, v78, v180
  v_sub_f32 v79, v79, v180
  v_exp_f32 v64, v64
  v_exp_f32 v65, v65
  v_exp_f32 v66, v66
  v_exp_f32 v67, v67
  v_exp_f32 v68, v68
  v_exp_f32 v69, v69
  v_exp_f32 v70, v70
  v_exp_f32 v71, v71
  v_exp_f32 v72, v72
  v_exp_f32 v73, v73
  v_exp_f32 v74, v74
  v_exp_f32 v75, v75
  v_exp_f32 v76, v76
  v_exp_f32 v77, v77
  v_exp_f32 v78, v78
  v_exp_f32 v79, v79
  v_cvt_pk_bf16_f32 v20, v64, v65
  v_cvt_pk_bf16_f32 v21, v68, v69
  v_cvt_pk_bf16_f32 v22, v72, v73
  v_cvt_pk_bf16_f32 v23, v76, v77
  v_cvt_pk_bf16_f32 v24, v66, v67
  v_cvt_pk_bf16_f32 v25, v70, v71
  v_cvt_pk_bf16_f32 v26, v74, v75
  v_cvt_pk_bf16_f32 v27, v78, v79
  s_waitcnt vmcnt(12)
  v_mfma_f32_32x32x16_bf16 v[0:15], v[160:163], v[20:23], 0
  v_add_f32 v182, v64, v65
  v_add_f32 v182, v182, v66
  v_add_f32 v182, v182, v67
  v_add_f32 v182, v182, v68
  v_add_f32 v182, v182, v69
  v_add_f32 v182, v182, v70
  v_add_f32 v182, v182, v71
  s_waitcnt vmcnt(11)
  v_mfma_f32_32x32x16_bf16 v[0:15], v[164:167], v[24:27], v[0:15]
  v_add_f32 v182, v182, v72
  v_add_f32 v182, v182, v73
  v_add_f32 v182, v182, v74
  v_add_f32 v182, v182, v75
  v_add_f32 v182, v182, v76
  v_add_f32 v182, v182, v77
  v_add_f32 v182, v182, v78
  v_add_f32 v182, v182, v79
  s_waitcnt vmcnt(0)
  s_barrier
AT_loop:
  s_cmp_ge_u32 s59, 64
  s_cbranch_scc1 AT_l0
  s_mov_b32 s77, s59
  s_mul_i32 s66, s59, 655360
  s_lshl_b32 s55, s58, 14
  s_add_u32 s55, s55, s66
  s_add_u32 s55, s55, 1048576
  s_lshl_b32 s76, s58, 2
  s_add_u32 s76, s76, s52
  s_lshl_b32 s75, s59, 7
  s_add_u32 s75, s75, s76
  s_lshl_b32 s75, s75, 11
  s_add_u32 s75, s75, 46137344
  s_lshl_b32 s76, s76, 10
  s_add_u32 s76, s76, s66
  s_add_u32 s76, s76, 1572864
  s_add_u32 s59, s59, 2
  buffer_load_dwordx4 v[128:131], v216, s[8:11], s55 offen offset:0 sc1
  buffer_load_dwordx4 v[132:135], v216, s[8:11], s55 offen offset:256 sc1
  buffer_load_dwordx4 v[136:139], v216, s[8:11], s55 offen offset:512 sc1
  buffer_load_dwordx4 v[140:143], v216, s[8:11], s55 offen offset:768 sc1
  buffer_load_dwordx4 v[144:147], v216, s[8:11], s55 offen offset:1024 sc1
  buffer_load_dwordx4 v[148:151], v216, s[8:11], s55 offen offset:1280 sc1
  buffer_load_dwordx4 v[152:155], v216, s[8:11], s55 offen offset:1536 sc1
  buffer_load_dwordx4 v[156:159], v216, s[8:11], s55 offen offset:1792 sc1
  buffer_load_dwordx4 v[160:163], v217, s[8:11], s55 offen offset:0 sc1
  buffer_load_dwordx4 v[164:167], v217, s[8:11], s55 offen offset:256 sc1
  s_or_b32 s70, s73, 0xc00
  buffer_load_dword v172, off, s[8:11], s70 sc1
  s_add_u32 s60, s60, 73728
  ds_read_b128 v[32:35], v203 offset:36864
  ds_read_b128 v[36:39], v204 offset:36864
  ds_read_b128 v[40:43], v205 offset:36864
  s_waitcnt lgkmcnt(2)
  v_mfma_f32_32x32x16_bf16 v[240:255], a[0:3], v[32:35], 0
  ds_read_b128 v[44:47], v206 offset:36864
  s_add_u32 m0, s67, 0
  s_nop 0
  buffer_load_dwordx4 v202, s[4:7], s60 offen offset:0 lds
  s_waitcnt lgkmcnt(2)
  v_mfma_f32_32x32x16_bf16 v[240:255], a[4:7], v[36:39], v[240:255]
  ds_read_b128 v[32:35], v203 offset:37888
  s_waitcnt lgkmcnt(2)
  v_mfma_f32_32x32x16_bf16 v[240:255], a[8:11], v[40:43], v[240:255]
  ds_read_b128 v[36:39], v204 offset:37888
  s_add_u32 m0, s67, 896
  s_nop 0
  buffer_load_dwordx4 v202, s[4:7], s60 offen offset:128 lds
  s_waitcnt lgkmcnt(2)
  v_mfma_f32_32x32x16_bf16 v[240:255], a[12:15], v[44:47], v[240:255]
  ds_read_b128 v[40:43], v205 offset:37888
  s_waitcnt lgkmcnt(2)
  v_mfma_f32_32x32x16_bf16 v[240:255], a[16:19], v[32:35], v[240:255]
  ds_read_b128 v[44:47], v206 offset:37888
  s_add_u32 m0, s67, 1792
  s_nop 0
  buffer_load_dwordx4 v202, s[4:7], s60 offen offset:256 lds
  s_waitcnt lgkmcnt(2)
  v_mfma_f32_32x32x16_bf16 v[240:255], a[20:23], v[36:39], v[240:255]
  ds_read_b128 v[32:35], v203 offset:38912
  s_waitcnt lgkmcnt(2)
  v_mfma_f32_32x32x16_bf16 v[240:255], a[24:27], v[40:43], v[240:255]
  ds_read_b128 v[36:39], v204 offset:38912
  s_add_u32 m0, s67, 2688
  s_nop 0
  buffer_load_dwordx4 v202, s[4:7], s60 offen offset:384 lds
  s_waitcnt lgkmcnt(2)
  v_mfma_f32_32x32x16_bf16 v[240:255], a[28:31], v[44:47], v[240:255]
  ds_read_b128 v[40:43], v205 offset:38912
  s_waitcnt lgkmcnt(2)
  v_mfma_f32_32x32x16_bf16 v[240:255], a[32:35], v[32:35], v[240:255]
  ds_read_b128 v[44:47], v206 offset:38912
  s_add_u32 m0, s67, 3584
  s_nop 0
  buffer_load_dwordx4 v202, s[4:7], s60 offen offset:512 lds
  s_waitcnt lgkmcnt(2)
  v_mfma_f32_32x32x16_bf16 v[240:255], a[36:39], v[36:39], v[240:255]
  ds_read_b128 v[32:35], v203 offset:39936
  s_waitcnt lgkmcnt(2)
  v_mfma_f32_32x32x16_bf16 v[240:255], a[40:43], v[40:43], v[240:255]
  ds_read_b128 v[36:39], v204 offset:39936
  s_add_u32 m0, s67, 4480
  s_nop 0
  buffer_load_dwordx4 v202, s[4:7], s60 offen offset:640 lds
  s_waitcnt lgkmcnt(2)
  v_mfma_f32_32x32x16_bf16 v[240:255], a[44:47], v[44:47], v[240:255]
  ds_read_b128 v[40:43], v205 offset:39936
  s_waitcnt lgkmcnt(2)
  v_mfma_f32_32x32x16_bf16 v[240:255], a[48:51], v[32:35], v[240:255]
  ds_read_b128 v[44:47], v206 offset:39936
  s_add_u32 m0, s67, 5376
  s_nop 0
  buffer_load_dwordx4 v202, s[4:7], s60 offen offset:768 lds
  s_waitcnt lgkmcnt(2)
  v_mfma_f32_32x32x16_bf16 v[240:255], a[52:55], v[36:39], v[240:255]
  ds_read_b128 v[32:35], v203 offset:40960
  s_waitcnt lgkmcnt(2)
  v_mfma_f32_32x32x16_bf16 v[240:255], a[56:59], v[40:43], v[240:255]
  ds_read_b128 v[36:39], v204 offset:40960
  s_add_u32 m0, s67, 6272
  s_nop 0
  buffer_load_dwordx4 v202, s[4:7], s60 offen offset:896 lds
  s_waitcnt lgkmcnt(2)
  v_mfma_f32_32x32x16_bf16 v[240:255], a[60:63], v[44:47], v[240:255]
  ds_read_b128 v[40:43], v205 offset:40960
  s_waitcnt lgkmcnt(2)
  v_mfma_f32_32x32x16_bf16 v[240:255], a[64:67], v[32:35], v[240:255]
  ds_read_b128 v[44:47], v206 offset:40960
  s_add_u32 m0, s67, 7168
  s_nop 0
  buffer_load_dwordx4 v202, s[4:7], s60 offen offset:1024 lds
  s_waitcnt lgkmcnt(2)
  v_mfma_f32_32x32x16_bf16 v[240:255], a[68:71], v[36:39], v[240:255]
  ds_read_b128 v[32:35], v203 offset:41984
  s_waitcnt lgkmcnt(2)
  v_mfma_f32_32x32x16_bf16 v[240:255], a[72:75], v[40:43], v[240:255]
  ds_read_b128 v[36:39], v204 offset:41984
  buffer_store_dwordx4 v[176:179], v201, s[8:11], s75 offen offset:0 sc1
  s_waitcnt lgkmcnt(2)
  v_mfma_f32_32x32x16_bf16 v[240:255], a[76:79], v[44:47], v[240:255]
  ds_read_b128 v[40:43], v205 offset:41984
  s_waitcnt lgkmcnt(2)
  v_mfma_f32_32x32x16_bf16 v[240:255], a[80:83], v[32:35], v[240:255]
  ds_read_b128 v[44:47], v206 offset:41984
  buffer_store_dwordx4 v[176:179], v201, s[8:11], s75 offen offset:1024 sc1
  s_waitcnt lgkmcnt(2)
  v_mfma_f32_32x32x16_bf16 v[240:255], a[84:87], v[36:39], v[240:255]
  ds_read_b128 v[32:35], v203 offset:43008
  s_waitcnt lgkmcnt(2)
  v_mfma_f32_32x32x16_bf16 v[240:255], a[88:91], v[40:43], v[240:255]
  ds_read_b128 v[36:39], v204 offset:43008
  s_waitcnt lgkmcnt(2)
  v_mfma_f32_32x32x16_bf16 v[240:255], a[92:95], v[44:47], v[240:255]
  ds_read_b128 v[40:43], v205 offset:43008
  s_waitcnt lgkmcnt(2)
  v_mfma_f32_32x32x16_bf16 v[240:255], a[96:99], v[32:35], v[240:255]
  ds_read_b128 v[44:47], v206 offset:43008
  s_waitcnt lgkmcnt(2)
  v_mfma_f32_32x32x16_bf16 v[240:255], a[100:103], v[36:39], v[240:255]
  ds_read_b128 v[32:35], v203 offset:44032
  s_waitcnt lgkmcnt(2)
  v_mfma_f32_32x32x16_bf16 v[240:255], a[104:107], v[40:43], v[240:255]
  ds_read_b128 v[36:39], v204 offset:44032
  s_waitcnt lgkmcnt(2)
  v_mfma_f32_32x32x16_bf16 v[240:255], a[108:111], v[44:47], v[240:255]
  ds_read_b128 v[40:43], v205 offset:44032
  s_waitcnt lgkmcnt(2)
  v_mfma_f32_32x32x16_bf16 v[240:255], a[112:115], v[32:35], v[240:255]
  ds_read_b128 v[44:47], v206 offset:44032
  s_waitcnt lgkmcnt(2)
  v_mfma_f32_32x32x16_bf16 v[240:255], a[116:119], v[36:39], v[240:255]
  ds_read_b128 v[32:35], v203 offset:45056
  s_waitcnt lgkmcnt(2)
  v_mfma_f32_32x32x16_bf16 v[240:255], a[120:123], v[40:43], v[240:255]
  ds_read_b128 v[36:39], v204 offset:45056
  s_waitcnt lgkmcnt(2)
  v_mfma_f32_32x32x16_bf16 v[240:255], a[124:127], v[44:47], v[240:255]
  ds_read_b128 v[40:43], v205 offset:45056
  s_waitcnt lgkmcnt(2)
  v_mfma_f32_32x32x16_bf16 v[240:255], a[128:131], v[32:35], v[240:255]
  ds_read_b128 v[44:47], v206 offset:45056
  s_waitcnt lgkmcnt(2)
  v_mfma_f32_32x32x16_bf16 v[240:255], a[132:135], v[36:39], v[240:255]
  s_waitcnt lgkmcnt(1)
  v_mfma_f32_32x32x16_bf16 v[240:255], a[136:139], v[40:43], v[240:255]
  s_waitcnt lgkmcnt(0)
  v_mfma_f32_32x32x16_bf16 v[240:255], a[140:143], v[44:47], v[240:255]
  s_nop 11
  v_cvt_pk_bf16_f32 v16, v240, v244
  v_cvt_pk_bf16_f32 v17, v241, v245
  v_cvt_pk_bf16_f32 v18, v242, v246
  v_cvt_pk_bf16_f32 v19, v243, v247
  ds_write_b128 v215, v[16:19] offset:0
  v_cvt_pk_bf16_f32 v20, v248, v252
  v_cvt_pk_bf16_f32 v21, v249, v253
  v_cvt_pk_bf16_f32 v22, v250, v254
  v_cvt_pk_bf16_f32 v23, v251, v255
  ds_write_b128 v215, v[20:23] offset:1024
  s_waitcnt lgkmcnt(0)
  s_barrier
  ds_read_b128 a[144:147], v208 offset:0
  ds_read_b128 a[148:151], v208 offset:1024
  ds_read_b128 a[152:155], v208 offset:2048
  ds_read_b128 a[156:159], v208 offset:3072
  ds_read_b128 a[160:163], v208 offset:4096
  ds_read_b128 a[164:167], v208 offset:5120
  ds_read_b128 a[168:171], v208 offset:6144
  ds_read_b128 a[172:175], v208 offset:7168
  s_waitcnt vmcnt(11)
  v_cmp_eq_u32 vcc, -1, v172
  s_mov_b32 s69, 0
  s_cbranch_vccnz AT_e1
  s_mov_b32 s69, 1
  buffer_load_dwordx4 v[172:175], v201, s[8:11], s73 offen sc1
AT_e1:
  s_waitcnt lgkmcnt(7)
  v_mfma_f32_32x32x16_bf16 v[64:79], v[128:131], a[144:147], v[48:63]
  s_waitcnt lgkmcnt(6)
  v_mfma_f32_32x32x16_bf16 v[64:79], v[132:135], a[148:151], v[64:79]
  s_waitcnt lgkmcnt(5)
  v_mfma_f32_32x32x16_bf16 v[64:79], v[136:139], a[152:155], v[64:79]
  s_waitcnt lgkmcnt(4)
  v_mfma_f32_32x32x16_bf16 v[64:79], v[140:143], a[156:159], v[64:79]
  s_waitcnt lgkmcnt(3)
  v_mfma_f32_32x32x16_bf16 v[64:79], v[144:147], a[160:163], v[64:79]
  s_waitcnt lgkmcnt(2)
  v_mfma_f32_32x32x16_bf16 v[64:79], v[148:151], a[164:167], v[64:79]
  s_waitcnt lgkmcnt(1)
  v_mfma_f32_32x32x16_bf16 v[64:79], v[152:155], a[168:171], v[64:79]
  s_waitcnt lgkmcnt(0)
  v_mfma_f32_32x32x16_bf16 v[64:79], v[156:159], a[172:175], v[64:79]
  s_nop 11
  v_max3_f32 v184, v64, v65, v66
  v_max3_f32 v184, v184, v67, v68
  v_max3_f32 v184, v184, v69, v70
  v_max3_f32 v184, v184, v71, v72
  v_max3_f32 v184, v184, v73, v74
  v_max3_f32 v184, v184, v75, v76
  v_max3_f32 v184, v184, v77, v78
  v_max_f32 v184, v184, v79
  v_mov_b32 v185, v184
  s_nop 1
  v_permlane32_swap_b32 v184, v185
  v_max_f32 v184, v184, v185
  v_sub_f32 v64, v64, v184
  v_sub_f32 v65, v65, v184
  v_sub_f32 v66, v66, v184
  v_sub_f32 v67, v67, v184
  v_sub_f32 v68, v68, v184
  v_sub_f32 v69, v69, v184
  v_sub_f32 v70, v70, v184
  v_sub_f32 v71, v71, v184
  v_sub_f32 v72, v72, v184
  v_sub_f32 v73, v73, v184
  v_sub_f32 v74, v74, v184
  v_sub_f32 v75, v75, v184
  v_sub_f32 v76, v76, v184
  v_sub_f32 v77, v77, v184
  v_sub_f32 v78, v78, v184
  v_sub_f32 v79, v79, v184
  v_exp_f32 v64, v64
  v_exp_f32 v65, v65
  v_exp_f32 v66, v66
  v_exp_f32 v67, v67
  v_exp_f32 v68, v68
  v_exp_f32 v69, v69
  v_exp_f32 v70, v70
  v_exp_f32 v71, v71
  v_exp_f32 v72, v72
  v_exp_f32 v73, v73
  v_exp_f32 v74, v74
  v_exp_f32 v75, v75
  v_exp_f32 v76, v76
  v_exp_f32 v77, v77
  v_exp_f32 v78, v78
  v_exp_f32 v79, v79
  v_cvt_pk_bf16_f32 v20, v64, v65
  v_cvt_pk_bf16_f32 v21, v68, v69
  v_cvt_pk_bf16_f32 v22, v72, v73
  v_cvt_pk_bf16_f32 v23, v76, v77
  v_cvt_pk_bf16_f32 v24, v66, v67
  v_cvt_pk_bf16_f32 v25, v70, v71
  v_cvt_pk_bf16_f32 v26, v74, v75
  v_cvt_pk_bf16_f32 v27, v78, v79
  v_mfma_f32_32x32x16_bf16 v[224:239], v[160:163], v[20:23], 0
  v_add_f32 v186, v64, v65
  v_add_f32 v186, v186, v66
  v_add_f32 v186, v186, v67
  v_add_f32 v186, v186, v68
  v_add_f32 v186, v186, v69
  v_add_f32 v186, v186, v70
  v_add_f32 v186, v186, v71
  v_mfma_f32_32x32x16_bf16 v[224:239], v[164:167], v[24:27], v[224:239]
  v_add_f32 v186, v186, v72
  v_add_f32 v186, v186, v73
  v_add_f32 v186, v186, v74
  v_add_f32 v186, v186, v75
  v_add_f32 v186, v186, v76
  v_add_f32 v186, v186, v77
  v_add_f32 v186, v186, v78
  v_add_f32 v186, v186, v79
AT_l0:
  s_cmp_eq_u32 s69, 1
  s_cbranch_scc1 AT_v0
  s_cmp_ge_u32 s74, 62
  s_cbranch_scc1 AT_k0
  s_branch AT_c0
AT_h0:
  s_sleep 2
AT_c0:
  buffer_load_dword v172, off, s[8:11], s70 sc1
  s_add_u32 s65, s65, 1
  s_cmp_lt_u32 s65, 131072
  s_cselect_b32 s54, -2, -1
  s_waitcnt vmcnt(0)
  v_cmp_lt_u32 vcc, s54, v172
  s_cbranch_vccnz AT_h0
AT_k0:
  buffer_load_dwordx4 v[172:175], v201, s[8:11], s73 offen sc1
AT_v0:
  s_mov_b32 s69, 0
  s_add_u32 s65, s65, 1
  s_cmp_lt_u32 s65, 131072
  s_cselect_b32 s54, -2, -1
  s_waitcnt vmcnt(0)
  ds_write_b64 v220, v[172:173] offset:0
  ds_write_b64 v221, v[174:175] offset:0
  v_max3_u32 v213, v172, v173, v174
  v_max_u32 v213, v213, v175
  v_cmp_lt_u32 vcc, s54, v213
  s_cbranch_vccnz AT_k0
  s_waitcnt lgkmcnt(0)
  s_barrier
  ds_read_b128 v[128:131], v218 offset:0
  ds_read_b128 v[132:135], v218 offset:256
  ds_read_b128 v[136:139], v218 offset:512
  ds_read_b128 v[140:143], v218 offset:768
  ds_read_b128 v[144:147], v218 offset:1024
  ds_read_b128 v[148:151], v218 offset:1280
  ds_read_b128 v[152:155], v218 offset:1536
  ds_read_b128 v[156:159], v218 offset:1792
  ds_read_b32 v168, v219 offset:0
  ds_read_b32 v169, v219 offset:128
  s_waitcnt lgkmcnt(9)
  v_mfma_f32_32x32x16_bf16 v[80:95], v[128:131], v[96:99], 0
  s_waitcnt lgkmcnt(8)
  v_mfma_f32_32x32x16_bf16 v[80:95], v[132:135], v[100:103], v[80:95]
  s_waitcnt lgkmcnt(7)
  v_mfma_f32_32x32x16_bf16 v[80:95], v[136:139], v[104:107], v[80:95]
  s_waitcnt lgkmcnt(6)
  v_mfma_f32_32x32x16_bf16 v[80:95], v[140:143], v[108:111], v[80:95]
  s_waitcnt lgkmcnt(5)
  v_mfma_f32_32x32x16_bf16 v[80:95], v[144:147], v[112:115], v[80:95]
  s_waitcnt lgkmcnt(4)
  v_mfma_f32_32x32x16_bf16 v[80:95], v[148:151], v[116:119], v[80:95]
  s_waitcnt lgkmcnt(3)
  v_mfma_f32_32x32x16_bf16 v[80:95], v[152:155], v[120:123], v[80:95]
  s_waitcnt lgkmcnt(2)
  v_mfma_f32_32x32x16_bf16 v[80:95], v[156:159], v[124:127], v[80:95]
  s_add_u32 s74, s74, 2
  v_mov_b32 v212, s74
  s_nop 9
  v_mul_f32 v80, s68, v80
  v_mul_f32 v81, s68, v81
  v_mul_f32 v82, s68, v82
  v_mul_f32 v83, s68, v83
  v_max3_f32 v84, v180, v80, v81
  v_max3_f32 v84, v84, v82, v83
  v_mov_b32 v85, v84
  s_nop 1
  v_permlane32_swap_b32 v84, v85
  v_max_f32 v84, v84, v85
  v_sub_f32 v86, v180, v84
  v_sub_f32 v80, v80, v84
  v_sub_f32 v81, v81, v84
  v_sub_f32 v82, v82, v84
  v_sub_f32 v83, v83, v84
  v_exp_f32 v86, v86
  v_exp_f32 v80, v80
  v_exp_f32 v81, v81
  v_exp_f32 v82, v82
  v_exp_f32 v83, v83
  v_fma_f32 v182, v182, v86, v80
  v_add_f32 v84, v81, v82
  v_add_f32 v182, v182, v83
  v_add_f32 v182, v182, v84
  v_mov_b32 v183, v182
  s_nop 1
  v_permlane32_swap_b32 v182, v183
  v_add_f32 v182, v182, v183
  v_rcp_f32 v182, v182
  s_nop 0
  v_mul_f32 v86, v86, v182
  v_mul_f32 v80, v182, v80
  v_mul_f32 v81, v182, v81
  v_mul_f32 v82, v182, v82
  v_mul_f32 v83, v182, v83
  v_cvt_pk_bf16_f32 v28, v80, v81
  v_cvt_pk_bf16_f32 v29, v82, v83
  v_mul_f32 v0, v86, v0
  v_mul_f32 v1, v86, v1
  v_mul_f32 v2, v86, v2
  v_mul_f32 v3, v86, v3
  v_mul_f32 v4, v86, v4
  v_mul_f32 v5, v86, v5
  v_mul_f32 v6, v86, v6
  v_mul_f32 v7, v86, v7
  v_mul_f32 v8, v86, v8
  v_mul_f32 v9, v86, v9
  v_mul_f32 v10, v86, v10
  v_mul_f32 v11, v86, v11
  v_mul_f32 v12, v86, v12
  v_mul_f32 v13, v86, v13
  v_mul_f32 v14, v86, v14
  v_mul_f32 v15, v86, v15
  s_waitcnt lgkmcnt(0)
  s_nop 0
  v_mfma_f32_32x32x8_bf16 v[0:15], v[168:169], v[28:29], v[0:15]
  s_nop 11
  v_cvt_pk_bf16_f32 v20, v0, v1
  v_cvt_pk_bf16_f32 v21, v2, v3
  v_cvt_pk_bf16_f32 v22, v4, v5
  v_cvt_pk_bf16_f32 v23, v6, v7
  buffer_store_dwordx4 v[20:23], v201, s[8:11], s72 offen offset:0 sc1
  v_cvt_pk_bf16_f32 v24, v8, v9
  v_cvt_pk_bf16_f32 v25, v10, v11
  v_cvt_pk_bf16_f32 v26, v12, v13
  v_cvt_pk_bf16_f32 v27, v14, v15
  buffer_store_dwordx4 v[24:27], v201, s[8:11], s72 offen offset:1024 sc1
  s_mov_b64 exec, 1
  buffer_store_dword v212, v201, s[8:11], s71 offen sc1
  s_mov_b64 exec, -1
  s_cmp_ge_u32 s74, 64
  s_cbranch_scc1 L_exit
  s_cmp_ge_u32 s59, 64
  s_cbranch_scc1 AT_l1
  s_mov_b32 s74, s59
  s_mul_i32 s66, s59, 655360
  s_lshl_b32 s55, s58, 14
  s_add_u32 s55, s55, s66
  s_add_u32 s55, s55, 1048576
  s_lshl_b32 s73, s58, 2
  s_add_u32 s73, s73, s52
  s_lshl_b32 s72, s59, 7
  s_add_u32 s72, s72, s73
  s_lshl_b32 s72, s72, 11
  s_add_u32 s72, s72, 46137344
  s_lshl_b32 s73, s73, 10
  s_add_u32 s73, s73, s66
  s_add_u32 s73, s73, 1572864
  s_add_u32 s59, s59, 2
  buffer_load_dwordx4 v[128:131], v216, s[8:11], s55 offen offset:0 sc1
  buffer_load_dwordx4 v[132:135], v216, s[8:11], s55 offen offset:256 sc1
  buffer_load_dwordx4 v[136:139], v216, s[8:11], s55 offen offset:512 sc1
  buffer_load_dwordx4 v[140:143], v216, s[8:11], s55 offen offset:768 sc1
  buffer_load_dwordx4 v[144:147], v216, s[8:11], s55 offen offset:1024 sc1
  buffer_load_dwordx4 v[148:151], v216, s[8:11], s55 offen offset:1280 sc1
  buffer_load_dwordx4 v[152:155], v216, s[8:11], s55 offen offset:1536 sc1
  buffer_load_dwordx4 v[156:159], v216, s[8:11], s55 offen offset:1792 sc1
  buffer_load_dwordx4 v[160:163], v217, s[8:11], s55 offen offset:0 sc1
  buffer_load_dwordx4 v[164:167], v217, s[8:11], s55 offen offset:256 sc1
  s_or_b32 s70, s76, 0xc00
  buffer_load_dword v172, off, s[8:11], s70 sc1
  s_add_u32 s60, s60, 73728
  ds_read_b128 v[32:35], v203 offset:0
  ds_read_b128 v[36:39], v204 offset:0
  ds_read_b128 v[40:43], v205 offset:0
  s_waitcnt lgkmcnt(2)
  v_mfma_f32_32x32x16_bf16 v[240:255], a[0:3], v[32:35], 0
  ds_read_b128 v[44:47], v206 offset:0
  s_add_u32 m0, s67, 36864
  s_nop 0
  buffer_load_dwordx4 v202, s[4:7], s60 offen offset:0 lds
  s_waitcnt lgkmcnt(2)
  v_mfma_f32_32x32x16_bf16 v[240:255], a[4:7], v[36:39], v[240:255]
  ds_read_b128 v[32:35], v203 offset:1024
  s_waitcnt lgkmcnt(2)
  v_mfma_f32_32x32x16_bf16 v[240:255], a[8:11], v[40:43], v[240:255]
  ds_read_b128 v[36:39], v204 offset:1024
  s_add_u32 m0, s67, 37760
  s_nop 0
  buffer_load_dwordx4 v202, s[4:7], s60 offen offset:128 lds
  s_waitcnt lgkmcnt(2)
  v_mfma_f32_32x32x16_bf16 v[240:255], a[12:15], v[44:47], v[240:255]
  ds_read_b128 v[40:43], v205 offset:1024
  s_waitcnt lgkmcnt(2)
  v_mfma_f32_32x32x16_bf16 v[240:255], a[16:19], v[32:35], v[240:255]
  ds_read_b128 v[44:47], v206 offset:1024
  s_add_u32 m0, s67, 38656
  s_nop 0
  buffer_load_dwordx4 v202, s[4:7], s60 offen offset:256 lds
  s_waitcnt lgkmcnt(2)
  v_mfma_f32_32x32x16_bf16 v[240:255], a[20:23], v[36:39], v[240:255]
  ds_read_b128 v[32:35], v203 offset:2048
  s_waitcnt lgkmcnt(2)
  v_mfma_f32_32x32x16_bf16 v[240:255], a[24:27], v[40:43], v[240:255]
  ds_read_b128 v[36:39], v204 offset:2048
  s_add_u32 m0, s67, 39552
  s_nop 0
  buffer_load_dwordx4 v202, s[4:7], s60 offen offset:384 lds
  s_waitcnt lgkmcnt(2)
  v_mfma_f32_32x32x16_bf16 v[240:255], a[28:31], v[44:47], v[240:255]
  ds_read_b128 v[40:43], v205 offset:2048
  s_waitcnt lgkmcnt(2)
  v_mfma_f32_32x32x16_bf16 v[240:255], a[32:35], v[32:35], v[240:255]
  ds_read_b128 v[44:47], v206 offset:2048
  s_add_u32 m0, s67, 40448
  s_nop 0
  buffer_load_dwordx4 v202, s[4:7], s60 offen offset:512 lds
  s_waitcnt lgkmcnt(2)
  v_mfma_f32_32x32x16_bf16 v[240:255], a[36:39], v[36:39], v[240:255]
  ds_read_b128 v[32:35], v203 offset:3072
  s_waitcnt lgkmcnt(2)
  v_mfma_f32_32x32x16_bf16 v[240:255], a[40:43], v[40:43], v[240:255]
  ds_read_b128 v[36:39], v204 offset:3072
  s_add_u32 m0, s67, 41344
  s_nop 0
  buffer_load_dwordx4 v202, s[4:7], s60 offen offset:640 lds
  s_waitcnt lgkmcnt(2)
  v_mfma_f32_32x32x16_bf16 v[240:255], a[44:47], v[44:47], v[240:255]
  ds_read_b128 v[40:43], v205 offset:3072
  s_waitcnt lgkmcnt(2)
  v_mfma_f32_32x32x16_bf16 v[240:255], a[48:51], v[32:35], v[240:255]
  ds_read_b128 v[44:47], v206 offset:3072
  s_add_u32 m0, s67, 42240
  s_nop 0
  buffer_load_dwordx4 v202, s[4:7], s60 offen offset:768 lds
  s_waitcnt lgkmcnt(2)
  v_mfma_f32_32x32x16_bf16 v[240:255], a[52:55], v[36:39], v[240:255]
  ds_read_b128 v[32:35], v203 offset:4096
  s_waitcnt lgkmcnt(2)
  v_mfma_f32_32x32x16_bf16 v[240:255], a[56:59], v[40:43], v[240:255]
  ds_read_b128 v[36:39], v204 offset:4096
  s_add_u32 m0, s67, 43136
  s_nop 0
  buffer_load_dwordx4 v202, s[4:7], s60 offen offset:896 lds
  s_waitcnt lgkmcnt(2)
  v_mfma_f32_32x32x16_bf16 v[240:255], a[60:63], v[44:47], v[240:255]
  ds_read_b128 v[40:43], v205 offset:4096
  s_waitcnt lgkmcnt(2)
  v_mfma_f32_32x32x16_bf16 v[240:255], a[64:67], v[32:35], v[240:255]
  ds_read_b128 v[44:47], v206 offset:4096
  s_add_u32 m0, s67, 44032
  s_nop 0
  buffer_load_dwordx4 v202, s[4:7], s60 offen offset:1024 lds
  s_waitcnt lgkmcnt(2)
  v_mfma_f32_32x32x16_bf16 v[240:255], a[68:71], v[36:39], v[240:255]
  ds_read_b128 v[32:35], v203 offset:5120
  s_waitcnt lgkmcnt(2)
  v_mfma_f32_32x32x16_bf16 v[240:255], a[72:75], v[40:43], v[240:255]
  ds_read_b128 v[36:39], v204 offset:5120
  buffer_store_dwordx4 v[176:179], v201, s[8:11], s72 offen offset:0 sc1
  s_waitcnt lgkmcnt(2)
  v_mfma_f32_32x32x16_bf16 v[240:255], a[76:79], v[44:47], v[240:255]
  ds_read_b128 v[40:43], v205 offset:5120
  s_waitcnt lgkmcnt(2)
  v_mfma_f32_32x32x16_bf16 v[240:255], a[80:83], v[32:35], v[240:255]
  ds_read_b128 v[44:47], v206 offset:5120
  buffer_store_dwordx4 v[176:179], v201, s[8:11], s72 offen offset:1024 sc1
  s_waitcnt lgkmcnt(2)
  v_mfma_f32_32x32x16_bf16 v[240:255], a[84:87], v[36:39], v[240:255]
  ds_read_b128 v[32:35], v203 offset:6144
  s_waitcnt lgkmcnt(2)
  v_mfma_f32_32x32x16_bf16 v[240:255], a[88:91], v[40:43], v[240:255]
  ds_read_b128 v[36:39], v204 offset:6144
  s_waitcnt lgkmcnt(2)
  v_mfma_f32_32x32x16_bf16 v[240:255], a[92:95], v[44:47], v[240:255]
  ds_read_b128 v[40:43], v205 offset:6144
  s_waitcnt lgkmcnt(2)
  v_mfma_f32_32x32x16_bf16 v[240:255], a[96:99], v[32:35], v[240:255]
  ds_read_b128 v[44:47], v206 offset:6144
  s_waitcnt lgkmcnt(2)
  v_mfma_f32_32x32x16_bf16 v[240:255], a[100:103], v[36:39], v[240:255]
  ds_read_b128 v[32:35], v203 offset:7168
  s_waitcnt lgkmcnt(2)
  v_mfma_f32_32x32x16_bf16 v[240:255], a[104:107], v[40:43], v[240:255]
  ds_read_b128 v[36:39], v204 offset:7168
  s_waitcnt lgkmcnt(2)
  v_mfma_f32_32x32x16_bf16 v[240:255], a[108:111], v[44:47], v[240:255]
  ds_read_b128 v[40:43], v205 offset:7168
  s_waitcnt lgkmcnt(2)
  v_mfma_f32_32x32x16_bf16 v[240:255], a[112:115], v[32:35], v[240:255]
  ds_read_b128 v[44:47], v206 offset:7168
  s_waitcnt lgkmcnt(2)
  v_mfma_f32_32x32x16_bf16 v[240:255], a[116:119], v[36:39], v[240:255]
  ds_read_b128 v[32:35], v203 offset:8192
  s_waitcnt lgkmcnt(2)
  v_mfma_f32_32x32x16_bf16 v[240:255], a[120:123], v[40:43], v[240:255]
  ds_read_b128 v[36:39], v204 offset:8192
  s_waitcnt lgkmcnt(2)
  v_mfma_f32_32x32x16_bf16 v[240:255], a[124:127], v[44:47], v[240:255]
  ds_read_b128 v[40:43], v205 offset:8192
  s_waitcnt lgkmcnt(2)
  v_mfma_f32_32x32x16_bf16 v[240:255], a[128:131], v[32:35], v[240:255]
  ds_read_b128 v[44:47], v206 offset:8192
  s_waitcnt lgkmcnt(2)
  v_mfma_f32_32x32x16_bf16 v[240:255], a[132:135], v[36:39], v[240:255]
  s_waitcnt lgkmcnt(1)
  v_mfma_f32_32x32x16_bf16 v[240:255], a[136:139], v[40:43], v[240:255]
  s_waitcnt lgkmcnt(0)
  v_mfma_f32_32x32x16_bf16 v[240:255], a[140:143], v[44:47], v[240:255]
  s_nop 11
  v_cvt_pk_bf16_f32 v16, v240, v244
  v_cvt_pk_bf16_f32 v17, v241, v245
  v_cvt_pk_bf16_f32 v18, v242, v246
  v_cvt_pk_bf16_f32 v19, v243, v247
  ds_write_b128 v215, v[16:19] offset:0
  v_cvt_pk_bf16_f32 v20, v248, v252
  v_cvt_pk_bf16_f32 v21, v249, v253
  v_cvt_pk_bf16_f32 v22, v250, v254
  v_cvt_pk_bf16_f32 v23, v251, v255
  ds_write_b128 v215, v[20:23] offset:1024
  s_waitcnt lgkmcnt(0)
  s_barrier
  ds_read_b128 v[96:99], v208 offset:0
  ds_read_b128 v[100:103], v208 offset:1024
  ds_read_b128 v[104:107], v208 offset:2048
  ds_read_b128 v[108:111], v208 offset:3072
  ds_read_b128 v[112:115], v208 offset:4096
  ds_read_b128 v[116:119], v208 offset:5120
  ds_read_b128 v[120:123], v208 offset:6144
  ds_read_b128 v[124:127], v208 offset:7168
  s_waitcnt vmcnt(11)
  v_cmp_eq_u32 vcc, -1, v172
  s_mov_b32 s69, 0
  s_cbranch_vccnz AT_e0
  s_mov_b32 s69, 1
  buffer_load_dwordx4 v[172:175], v201, s[8:11], s76 offen sc1
AT_e0:
  s_waitcnt lgkmcnt(7)
  v_mfma_f32_32x32x16_bf16 v[64:79], v[128:131], v[96:99], v[48:63]
  s_waitcnt lgkmcnt(6)
  v_mfma_f32_32x32x16_bf16 v[64:79], v[132:135], v[100:103], v[64:79]
  s_waitcnt lgkmcnt(5)
  v_mfma_f32_32x32x16_bf16 v[64:79], v[136:139], v[104:107], v[64:79]
  s_waitcnt lgkmcnt(4)
  v_mfma_f32_32x32x16_bf16 v[64:79], v[140:143], v[108:111], v[64:79]
  s_waitcnt lgkmcnt(3)
  v_mfma_f32_32x32x16_bf16 v[64:79], v[144:147], v[112:115], v[64:79]
  s_waitcnt lgkmcnt(2)
  v_mfma_f32_32x32x16_bf16 v[64:79], v[148:151], v[116:119], v[64:79]
  s_waitcnt lgkmcnt(1)
  v_mfma_f32_32x32x16_bf16 v[64:79], v[152:155], v[120:123], v[64:79]
  s_waitcnt lgkmcnt(0)
  v_mfma_f32_32x32x16_bf16 v[64:79], v[156:159], v[124:127], v[64:79]
  s_nop 11
  v_max3_f32 v180, v64, v65, v66
  v_max3_f32 v180, v180, v67, v68
  v_max3_f32 v180, v180, v69, v70
  v_max3_f32 v180, v180, v71, v72
  v_max3_f32 v180, v180, v73, v74
  v_max3_f32 v180, v180, v75, v76
  v_max3_f32 v180, v180, v77, v78
  v_max_f32 v180, v180, v79
  v_mov_b32 v181, v180
  s_nop 1
  v_permlane32_swap_b32 v180, v181
  v_max_f32 v180, v180, v181
  v_sub_f32 v64, v64, v180
  v_sub_f32 v65, v65, v180
  v_sub_f32 v66, v66, v180
  v_sub_f32 v67, v67, v180
  v_sub_f32 v68, v68, v180
  v_sub_f32 v69, v69, v180
  v_sub_f32 v70, v70, v180
  v_sub_f32 v71, v71, v180
  v_sub_f32 v72, v72, v180
  v_sub_f32 v73, v73, v180
  v_sub_f32 v74, v74, v180
  v_sub_f32 v75, v75, v180
  v_sub_f32 v76, v76, v180
  v_sub_f32 v77, v77, v180
  v_sub_f32 v78, v78, v180
  v_sub_f32 v79, v79, v180
  v_exp_f32 v64, v64
  v_exp_f32 v65, v65
  v_exp_f32 v66, v66
  v_exp_f32 v67, v67
  v_exp_f32 v68, v68
  v_exp_f32 v69, v69
  v_exp_f32 v70, v70
  v_exp_f32 v71, v71
  v_exp_f32 v72, v72
  v_exp_f32 v73, v73
  v_exp_f32 v74, v74
  v_exp_f32 v75, v75
  v_exp_f32 v76, v76
  v_exp_f32 v77, v77
  v_exp_f32 v78, v78
  v_exp_f32 v79, v79
  v_cvt_pk_bf16_f32 v20, v64, v65
  v_cvt_pk_bf16_f32 v21, v68, v69
  v_cvt_pk_bf16_f32 v22, v72, v73
  v_cvt_pk_bf16_f32 v23, v76, v77
  v_cvt_pk_bf16_f32 v24, v66, v67
  v_cvt_pk_bf16_f32 v25, v70, v71
  v_cvt_pk_bf16_f32 v26, v74, v75
  v_cvt_pk_bf16_f32 v27, v78, v79
  v_mfma_f32_32x32x16_bf16 v[0:15], v[160:163], v[20:23], 0
  v_add_f32 v182, v64, v65
  v_add_f32 v182, v182, v66
  v_add_f32 v182, v182, v67
  v_add_f32 v182, v182, v68
  v_add_f32 v182, v182, v69
  v_add_f32 v182, v182, v70
  v_add_f32 v182, v182, v71
  v_mfma_f32_32x32x16_bf16 v[0:15], v[164:167], v[24:27], v[0:15]
  v_add_f32 v182, v182, v72
  v_add_f32 v182, v182, v73
  v_add_f32 v182, v182, v74
  v_add_f32 v182, v182, v75
  v_add_f32 v182, v182, v76
  v_add_f32 v182, v182, v77
  v_add_f32 v182, v182, v78
  v_add_f32 v182, v182, v79
AT_l1:
  s_cmp_eq_u32 s69, 1
  s_cbranch_scc1 AT_v1
  s_cmp_ge_u32 s77, 62
  s_cbranch_scc1 AT_k1
  s_branch AT_c1
AT_h1:
  s_sleep 2
AT_c1:
  buffer_load_dword v172, off, s[8:11], s70 sc1
  s_add_u32 s65, s65, 1
  s_cmp_lt_u32 s65, 131072
  s_cselect_b32 s54, -2, -1
  s_waitcnt vmcnt(0)
  v_cmp_lt_u32 vcc, s54, v172
  s_cbranch_vccnz AT_h1
AT_k1:
  buffer_load_dwordx4 v[172:175], v201, s[8:11], s76 offen sc1
AT_v1:
  s_mov_b32 s69, 0
  s_add_u32 s65, s65, 1
  s_cmp_lt_u32 s65, 131072
  s_cselect_b32 s54, -2, -1
  s_waitcnt vmcnt(0)
  ds_write_b64 v220, v[172:173] offset:4096
  ds_write_b64 v221, v[174:175] offset:4096
  v_max3_u32 v213, v172, v173, v174
  v_max_u32 v213, v213, v175
  v_cmp_lt_u32 vcc, s54, v213
  s_cbranch_vccnz AT_k1
  s_waitcnt lgkmcnt(0)
  s_barrier
  ds_read_b128 v[128:131], v218 offset:4096
  ds_read_b128 v[132:135], v218 offset:4352
  ds_read_b128 v[136:139], v218 offset:4608
  ds_read_b128 v[140:143], v218 offset:4864
  ds_read_b128 v[144:147], v218 offset:5120
  ds_read_b128 v[148:151], v218 offset:5376
  ds_read_b128 v[152:155], v218 offset:5632
  ds_read_b128 v[156:159], v218 offset:5888
  ds_read_b32 v168, v219 offset:4096
  ds_read_b32 v169, v219 offset:4224
  s_waitcnt lgkmcnt(9)
  v_mfma_f32_32x32x16_bf16 v[80:95], v[128:131], a[144:147], 0
  s_waitcnt lgkmcnt(8)
  v_mfma_f32_32x32x16_bf16 v[80:95], v[132:135], a[148:151], v[80:95]
  s_waitcnt lgkmcnt(7)
  v_mfma_f32_32x32x16_bf16 v[80:95], v[136:139], a[152:155], v[80:95]
  s_waitcnt lgkmcnt(6)
  v_mfma_f32_32x32x16_bf16 v[80:95], v[140:143], a[156:159], v[80:95]
  s_waitcnt lgkmcnt(5)
  v_mfma_f32_32x32x16_bf16 v[80:95], v[144:147], a[160:163], v[80:95]
  s_waitcnt lgkmcnt(4)
  v_mfma_f32_32x32x16_bf16 v[80:95], v[148:151], a[164:167], v[80:95]
  s_waitcnt lgkmcnt(3)
  v_mfma_f32_32x32x16_bf16 v[80:95], v[152:155], a[168:171], v[80:95]
  s_waitcnt lgkmcnt(2)
  v_mfma_f32_32x32x16_bf16 v[80:95], v[156:159], a[172:175], v[80:95]
  s_add_u32 s77, s77, 2
  v_mov_b32 v212, s77
  s_nop 9
  v_mul_f32 v80, s68, v80
  v_mul_f32 v81, s68, v81
  v_mul_f32 v82, s68, v82
  v_mul_f32 v83, s68, v83
  v_max3_f32 v84, v184, v80, v81
  v_max3_f32 v84, v84, v82, v83
  v_mov_b32 v85, v84
  s_nop 1
  v_permlane32_swap_b32 v84, v85
  v_max_f32 v84, v84, v85
  v_sub_f32 v86, v184, v84
  v_sub_f32 v80, v80, v84
  v_sub_f32 v81, v81, v84
  v_sub_f32 v82, v82, v84
  v_sub_f32 v83, v83, v84
  v_exp_f32 v86, v86
  v_exp_f32 v80, v80
  v_exp_f32 v81, v81
  v_exp_f32 v82, v82
  v_exp_f32 v83, v83
  v_fma_f32 v186, v186, v86, v80
  v_add_f32 v84, v81, v82
  v_add_f32 v186, v186, v83
  v_add_f32 v186, v186, v84
  v_mov_b32 v187, v186
  s_nop 1
  v_permlane32_swap_b32 v186, v187
  v_add_f32 v186, v186, v187
  v_rcp_f32 v186, v186
  s_nop 0
  v_mul_f32 v86, v86, v186
  v_mul_f32 v80, v186, v80
  v_mul_f32 v81, v186, v81
  v_mul_f32 v82, v186, v82
  v_mul_f32 v83, v186, v83
  v_cvt_pk_bf16_f32 v28, v80, v81
  v_cvt_pk_bf16_f32 v29, v82, v83
  v_mul_f32 v224, v86, v224
  v_mul_f32 v225, v86, v225
  v_mul_f32 v226, v86, v226
  v_mul_f32 v227, v86, v227
  v_mul_f32 v228, v86, v228
  v_mul_f32 v229, v86, v229
  v_mul_f32 v230, v86, v230
  v_mul_f32 v231, v86, v231
  v_mul_f32 v232, v86, v232
  v_mul_f32 v233, v86, v233
  v_mul_f32 v234, v86, v234
  v_mul_f32 v235, v86, v235
  v_mul_f32 v236, v86, v236
  v_mul_f32 v237, v86, v237
  v_mul_f32 v238, v86, v238
  v_mul_f32 v239, v86, v239
  s_waitcnt lgkmcnt(0)
  s_nop 0
  v_mfma_f32_32x32x8_bf16 v[224:239], v[168:169], v[28:29], v[224:239]
  s_nop 11
  v_cvt_pk_bf16_f32 v20, v224, v225
  v_cvt_pk_bf16_f32 v21, v226, v227
  v_cvt_pk_bf16_f32 v22, v228, v229
  v_cvt_pk_bf16_f32 v23, v230, v231
  buffer_store_dwordx4 v[20:23], v201, s[8:11], s75 offen offset:0 sc1
  v_cvt_pk_bf16_f32 v24, v232, v233
  v_cvt_pk_bf16_f32 v25, v234, v235
  v_cvt_pk_bf16_f32 v26, v236, v237
  v_cvt_pk_bf16_f32 v27, v238, v239
  buffer_store_dwordx4 v[24:27], v201, s[8:11], s75 offen offset:1024 sc1
  s_mov_b64 exec, 1
  buffer_store_dword v212, v201, s[8:11], s71 offen sc1
  s_mov_b64 exec, -1
  s_cmp_ge_u32 s77, 64
  s_cbranch_scc1 L_exit
  s_branch AT_loop
L_cexit:
L_exit:
L_end:
s_endpgm
.section .rodata,"a"
.p2align 6
.amdhsa_kernel gated_mix__sliding_local_dilated__memory_aug_recurrent_mem_tr__prompt_kernel
  .amdhsa_next_free_vgpr 512
  .amdhsa_next_free_sgpr 102
  .amdhsa_accum_offset 256
  .amdhsa_group_segment_fixed_size 0
  .amdhsa_kernarg_size 112
  .amdhsa_user_sgpr_count 2
  .amdhsa_user_sgpr_kernarg_segment_ptr 1
  .amdhsa_system_sgpr_workgroup_id_x 1
.end_amdhsa_kernel
```

```asm
; @launch grid=(256,1,1) block=(256,1,1) lds=163840
.amdgcn_target "amdgcn-amd-amdhsa--gfx950"
.text
.globl gated_mix__sliding_local_dilated__memory_aug_recurrent_mem_tr__prompt_kernel
.p2align 8
.type gated_mix__sliding_local_dilated__memory_aug_recurrent_mem_tr__prompt_kernel,@function
gated_mix__sliding_local_dilated__memory_aug_recurrent_mem_tr__prompt_kernel:
  s_cmp_ge_u32 s2, 256
  s_cbranch_scc1 L_end
  s_load_dwordx2 s[4:5], s[0:1], 0
  s_load_dwordx2 s[8:9], s[0:1], 104
  s_load_dwordx2 s[12:13], s[0:1], 96
  s_load_dwordx2 s[16:17], s[0:1], 40
  s_load_dwordx2 s[20:21], s[0:1], 48
  s_load_dwordx2 s[24:25], s[0:1], 56
  s_load_dwordx2 s[28:29], s[0:1], 64
  s_load_dwordx2 s[32:33], s[0:1], 32
  s_load_dwordx2 s[36:37], s[0:1], 8
  s_load_dwordx2 s[40:41], s[0:1], 16
  s_load_dwordx2 s[44:45], s[0:1], 80
  s_load_dwordx2 s[48:49], s[0:1], 88
  s_getreg_b32 s54, hwreg(HW_REG_XCC_ID, 0, 3)
  v_lshrrev_b32 v1, 6, v0
  s_nop 0
  v_readfirstlane_b32 s52, v1
  s_mov_b32 s6, 2359296
  s_mov_b32 s7, 0x20000
  s_mov_b32 s10, 268435456
  s_mov_b32 s11, 0x20000
  s_mov_b32 s14, 256
  s_mov_b32 s15, 0x20000
  s_mov_b32 s18, 4718592
  s_mov_b32 s19, 0x20000
  s_mov_b32 s22, 4718592
  s_mov_b32 s23, 0x20000
  s_mov_b32 s26, 4718592
  s_mov_b32 s27, 0x20000
  s_mov_b32 s30, 4718592
  s_mov_b32 s31, 0x20000
  s_mov_b32 s34, 9216
  s_mov_b32 s35, 0x20000
  s_mov_b32 s38, 1990656
  s_mov_b32 s39, 0x20000
  s_mov_b32 s42, 663552
  s_mov_b32 s43, 0x20000
  s_mov_b32 s46, 1152
  s_mov_b32 s47, 0x20000
  s_mov_b32 s50, 2359296
  s_mov_b32 s51, 0x20000
  s_waitcnt lgkmcnt(0)
  s_lshr_b32 s0, s2, 3
  s_mov_b32 s2, s54
  s_mov_b32 s1, 0
  s_lshl_b32 s55, s2, 2
  s_cmp_eq_u32 s52, 0
  s_cselect_b32 s55, s55, 0x1000
  s_lshl_b32 s56, 1, s0
  v_mov_b32 v1, 0
  v_mov_b32 v35, s56
  s_mov_b64 exec, 1
  buffer_atomic_or v35, v1, s[12:15], s55 offen sc0
  s_mov_b64 exec, -1
L_role:
  s_mov_b32 s53, s0
  s_cmp_eq_u32 s2, 0
  s_cbranch_scc0 L_worker
  v_and_b32 v0, 63, v0
  v_and_b32 v1, 15, v0
  v_lshrrev_b32 v2, 4, v0
  v_and_b32 v3, 1, v2
  s_lshl_b32 s54, s52, 1
  v_add_u32 v3, s54, v3
  v_lshlrev_b32 v3, 1, v3
  v_xor_b32 v3, v3, v1
  v_lshlrev_b32 v3, 4, v3
  v_lshl_add_u32 v8, v2, 13, v3
  s_lshl_b32 s78, s53, 8
  s_lshl_b32 s54, s52, 15
  s_add_u32 s78, s78, s54
  s_mul_i32 s79, s53, 147456
  s_lshl_b32 s57, s52, 10
  s_add_u32 s57, s57, 16384
  s_getpc_b64 s[80:81]
L_pc_1:
  s_and_b32 s55, s0, 1
  s_lshl_b32 s55, s55, 2
  s_add_u32 s55, s55, s52
  s_lshl_b32 s55, s55, 10
  v_and_b32 v199, 63, v0
  v_lshl_add_u32 v199, v199, 4, s55
  v_min_u32 v199, (L_w0 - L_pc_1), v199
  global_load_dword v196, v199, s[80:81]
  s_add_u32 m0, s57, 0
  s_add_u32 s54, s78, 0
  buffer_load_dwordx4 v8, s[16:19], s54 offen  lds
  s_add_u32 m0, s57, 4096
  s_add_u32 s54, s78, 131072
  buffer_load_dwordx4 v8, s[16:19], s54 offen  lds
  s_add_u32 m0, s57, 8192
  s_add_u32 s54, s78, 262144
  buffer_load_dwordx4 v8, s[16:19], s54 offen  lds
  s_add_u32 m0, s57, 12288
  s_add_u32 s54, s78, 393216
  buffer_load_dwordx4 v8, s[16:19], s54 offen  lds
  s_add_u32 m0, s57, 16384
  s_add_u32 s54, s78, 524288
  buffer_load_dwordx4 v8, s[16:19], s54 offen  lds
  s_add_u32 m0, s57, 20480
  s_add_u32 s54, s78, 655360
  buffer_load_dwordx4 v8, s[16:19], s54 offen  lds
  s_add_u32 m0, s57, 24576
  s_add_u32 s54, s78, 786432
  buffer_load_dwordx4 v8, s[16:19], s54 offen  lds
  s_add_u32 m0, s57, 28672
  s_add_u32 s54, s78, 917504
  buffer_load_dwordx4 v8, s[16:19], s54 offen  lds
  s_add_u32 m0, s57, 32768
  s_add_u32 s54, s78, 1048576
  buffer_load_dwordx4 v8, s[16:19], s54 offen  lds
  s_add_u32 m0, s57, 36864
  s_add_u32 s54, s78, 1179648
  buffer_load_dwordx4 v8, s[16:19], s54 offen  lds
  s_add_u32 m0, s57, 40960
  s_add_u32 s54, s78, 1310720
  buffer_load_dwordx4 v8, s[16:19], s54 offen  lds
  s_add_u32 m0, s57, 45056
  s_add_u32 s54, s78, 1441792
  buffer_load_dwordx4 v8, s[16:19], s54 offen  lds
  s_add_u32 m0, s57, 49152
  s_add_u32 s54, s78, 1572864
  buffer_load_dwordx4 v8, s[16:19], s54 offen  lds
  s_add_u32 m0, s57, 53248
  s_add_u32 s54, s78, 1703936
  buffer_load_dwordx4 v8, s[16:19], s54 offen  lds
  s_add_u32 m0, s57, 57344
  s_add_u32 s54, s78, 1835008
  buffer_load_dwordx4 v8, s[16:19], s54 offen  lds
  s_add_u32 m0, s57, 61440
  s_add_u32 s54, s78, 1966080
  buffer_load_dwordx4 v8, s[16:19], s54 offen  lds
  s_add_u32 m0, s57, 65536
  s_add_u32 s54, s78, 2097152
  buffer_load_dwordx4 v8, s[16:19], s54 offen  lds
  s_add_u32 m0, s57, 69632
  s_add_u32 s54, s78, 2228224
  buffer_load_dwordx4 v8, s[16:19], s54 offen  lds
  s_add_u32 m0, s57, 73728
  s_add_u32 s54, s78, 2359296
  buffer_load_dwordx4 v8, s[16:19], s54 offen  lds
  s_add_u32 m0, s57, 77824
  s_add_u32 s54, s78, 2490368
  buffer_load_dwordx4 v8, s[16:19], s54 offen  lds
  v_lshlrev_b32 v76, 4, v0
  v_add_u32 v75, 0x10000, v76
  v_lshrrev_b32 v3, 2, v1
  v_and_b32 v4, 1, v1
  v_lshl_add_u32 v3, v3, 1, v4
  v_bfe_u32 v4, v1, 1, 1
  v_mul_u32_u24 v74, 0xaaaa, v4
  v_add_u32 v74, 0x4444, v74
  v_mul_u32_u24 v5, 576, v3
  v_add_u32 v5, 0, v5
  v_lshl_add_u32 v78, v2, 4, v5
  v_lshl_add_u32 v77, v2, 5, v5
  v_lshl_add_u32 v77, v4, 4, v77
  v_mul_u32_u24 v15, 1152, v3
  v_lshl_add_u32 v15, v2, 5, v15
  v_lshl_add_u32 v15, v4, 4, v15
  s_lshl_b32 s54, s52, 8
  buffer_load_dwordx4 v[20:23], v15, s[32:35], s54 offen
  buffer_load_dwordx4 v[24:27], v15, s[32:35], s54 offen offset:128
  buffer_load_dwordx4 v[28:31], v15, s[32:35], 0 offen offset:1024
  v_mul_u32_u24 v79, 1152, v2
  v_lshl_add_u32 v79, v1, 2, v79
  s_lshl_b32 s54, s52, 6
  s_add_u32 s54, s54, 0
  v_add_u32 v79, s54, v79
  v_lshrrev_b32 v5, 3, v0
  v_mul_u32_u24 v68, 2176, v5
  v_and_b32 v5, 7, v0
  v_lshl_add_u32 v68, v5, 3, v68
  v_lshrrev_b32 v6, 3, v0
  s_lshr_b32 s54, s53, 2
  v_add_u32 v68, s54, v6
  v_and_b32 v68, 7, v68
  v_xor_b32 v68, v68, v6
  v_lshlrev_b32 v68, 8, v68
  v_lshl_add_u32 v68, v6, 12, v68
  v_lshl_add_u32 v68, v5, 3, v68
  s_and_b32 s54, s53, 3
  s_lshl_b32 s54, s54, 6
  v_add_u32 v68, s54, v68
  v_and_b32 v5, 1, v2
  v_lshlrev_b32 v5, 4, v5
  v_lshl_add_u32 v5, v1, 2, v5
  v_mov_b32 v6, 0x40000000
  v_cmp_lt_u32 vcc, 3, v1
  s_nop 1
  v_cndmask_b32 v5, v5, v6, vcc
  v_lshrrev_b32 v6, 1, v2
  v_lshl_add_u32 v69, v6, 10, v5
  v_lshl_add_u32 v70, v6, 8, v5
  v_mov_b32 v71, -1
  ds_write_b128 v76, v[68:71] offset:13824
  v_and_b32 v5, 3, v1
  v_lshrrev_b32 v6, 2, v1
  v_lshl_add_u32 v5, v5, 2, v6
  v_and_b32 v6, 1, v5
  v_lshlrev_b32 v6, 4, v6
  v_mov_b32 v7, 0x3f80
  v_lshlrev_b32 v6, v6, v7
  v_lshrrev_b32 v5, 1, v5
  v_cmp_eq_u32 vcc, 0, v5
  s_nop 1
  v_cndmask_b32 v40, 0, v6, vcc
  v_cmp_eq_u32 vcc, 1, v5
  s_nop 1
  v_cndmask_b32 v41, 0, v6, vcc
  v_cmp_eq_u32 vcc, 2, v5
  s_nop 1
  v_cndmask_b32 v42, 0, v6, vcc
  v_cmp_eq_u32 vcc, 3, v5
  s_nop 1
  v_cndmask_b32 v43, 0, v6, vcc
  ds_write_b128 v76, v[40:43] offset:14848
  s_and_b32 s54, s52, 1
  s_lshr_b32 s55, s52, 1
  v_lshrrev_b32 v3, 3, v0
  v_and_b32 v4, 1, v3
  v_lshlrev_b32 v4, 4, v4
  v_and_b32 v5, 6, v3
  v_add_u32 v4, v4, v5
  s_lshl_b32 s56, s55, 3
  s_add_u32 s56, s56, s54
  v_add_u32 v4, s56, v4
  v_mul_u32_u24 v4, 1152, v4
  v_and_b32 v5, 2, v3
  v_lshlrev_b32 v5, 1, v5
  v_and_b32 v6, 7, v0
  v_xor_b32 v6, v6, v5
  v_lshl_add_u32 v9, v6, 4, v4
  v_and_b32 v4, 1, v2
  v_lshlrev_b32 v4, 4, v4
  v_and_b32 v5, 2, v2
  v_add_u32 v4, v4, v5
  s_lshl_b32 s56, s55, 2
  s_add_u32 s56, s56, s54
  v_add_u32 v4, s56, v4
  v_mul_u32_u24 v4, 1152, v4
  v_lshlrev_b32 v6, 1, v2
  v_xor_b32 v6, v6, v1
  v_lshl_add_u32 v10, v6, 4, v4
  v_bfe_u32 v17, v1, 2, 1
  v_bfe_u32 v18, v1, 3, 1
  v_and_b32 v19, 1, v2
  v_lshrrev_b32 v72, 1, v2
  v_and_b32 v73, 3, v1
  v_lshl_add_u32 v3, v19, 1, v17
  v_lshl_add_u32 v6, v18, 2, v3
  v_lshl_add_u32 v4, v72, 4, v17
  v_lshl_add_u32 v4, v19, 2, v4
  v_lshl_add_u32 v4, v18, 3, v4
  v_lshlrev_b32 v4, 8, v4
  s_lshl_b32 s54, s52, 6
  v_lshl_add_u32 v5, v73, 3, s54
  v_lshlrev_b32 v7, 5, v6
  v_xor_b32 v5, v5, v7
  v_add_u32 v11, v4, v5
  v_xor_b32 v12, 32, v11
  v_lshl_add_u32 v4, v72, 2, v3
  v_lshlrev_b32 v4, 7, v4
  v_lshl_add_u32 v4, v73, 3, v4
  s_and_b32 s54, s52, 1
  v_xor_b32 v7, s54, v19
  v_lshl_add_u32 v7, v7, 1, v18
  v_lshl_add_u32 v13, v7, 5, v4
  v_lshlrev_b32 v4, 11, v72
  v_lshl_add_u32 v4, v73, 3, v4
  v_lshl_add_u32 v5, v3, 8, v4
  v_lshl_add_u32 v7, v18, 2, s52
  v_xor_b32 v7, v7, v3
  v_lshl_add_u32 v14, v7, 5, v5
  s_lshl_b32 s54, s53, 14
  s_lshl_b32 s55, s52, 11
  s_add_u32 s54, s54, 1048576
  s_add_u32 s58, s54, s55
  s_add_u32 s59, s58, 8192
  s_lshl_b32 s55, s52, 12
  s_add_u32 s70, s54, s55
  s_add_u32 s70, s70, 655360
  s_lshl_b32 s54, s53, 12
  s_lshl_b32 s55, s52, 10
  s_add_u32 s54, s54, s55
  s_add_u32 s68, s54, 917504
  s_lshl_b32 s54, s53, 6
  s_mul_i32 s55, s52, 17408
  s_add_u32 s55, s54, s55
  s_add_u32 s73, s55, 0
  s_add_u32 s74, s55, 69632
  s_add_u32 s75, s55, 139264
  s_add_u32 s76, s55, 208896
  s_and_b32 s56, s52, 1
  s_mul_i32 s55, s56, 17408
  s_add_u32 s55, s54, s55
  s_add_u32 s77, s55, 278528
  s_mul_i32 s54, s52, 69632
  s_mul_i32 s55, s53, 2176
  s_add_u32 s54, s54, s55
  s_add_u32 s60, s54, 0
  s_and_b32 s56, s53, 15
  s_mul_i32 s55, s56, 2176
  s_add_u32 s61, s55, 278528
  s_lshr_b32 s54, s52, 1
  s_lshl_b32 s54, s54, 15
  s_and_b32 s55, s52, 1
  s_lshl_b32 s55, s55, 11
  s_add_u32 s54, s54, s55
  s_add_u32 s73, s54, 0
  s_add_u32 s74, s54, 65536
  s_add_u32 s75, s54, 131072
  s_add_u32 s76, s54, 196608
  s_add_u32 s77, s55, 262144
  s_and_b32 s54, s53, 7
  s_lshl_b32 s54, s54, 12
  s_bfe_u32 s55, s53, 0x10003
  s_lshl_b32 s55, s55, 11
  s_add_u32 s54, s54, s55
  s_add_u32 s61, s54, 262144
  s_lshr_b32 s55, s53, 4
  s_lshl_b32 s55, s55, 15
  s_add_u32 s54, s54, s55
  s_lshl_b32 s55, s52, 16
  s_add_u32 s54, s54, s55
  s_add_u32 s60, s54, 0
  s_lshl_b32 s54, s52, 11
  s_add_u32 s64, s54, 360448
  s_mov_b32 s65, 368640
  s_lshl_b32 s55, s53, 5
  s_add_u32 s54, s54, s55
  s_add_u32 s62, s54, 376832
  s_lshr_b32 s54, s56, 3
  s_lshl_b32 s54, s54, 9
  s_and_b32 s55, s56, 7
  s_lshl_b32 s55, s55, 5
  s_add_u32 s54, s54, s55
  s_add_u32 s63, s54, 385024
  s_mov_b32 s66, 0
  s_mov_b32 s67, 0
  s_mov_b32 s72, 0
  s_mov_b32 s69, 1040356334
  s_waitcnt vmcnt(19) lgkmcnt(0)
  s_barrier
  s_add_u32 m0, s57, 81920
  s_add_u32 s54, s78, 2621440
  buffer_load_dwordx4 v8, s[16:19], s54 offen  lds
  s_add_u32 m0, s57, 86016
  s_add_u32 s54, s78, 2752512
  buffer_load_dwordx4 v8, s[16:19], s54 offen  lds
  s_add_u32 m0, s57, 90112
  s_add_u32 s54, s78, 2883584
  buffer_load_dwordx4 v8, s[16:19], s54 offen  lds
  s_add_u32 m0, s57, 94208
  s_add_u32 s54, s78, 3014656
  buffer_load_dwordx4 v8, s[16:19], s54 offen  lds
  v_add_u32 v15, 16384, v11
  v_add_u32 v16, 16384, v12
  ds_read_b64_tr_b16 v[80:81], v15 offset:0
  ds_read_b64_tr_b16 v[82:83], v15 offset:512
  ds_read_b64_tr_b16 v[84:85], v15 offset:8192
  ds_read_b64_tr_b16 v[86:87], v15 offset:8704
  ds_read_b64_tr_b16 v[88:89], v16 offset:0
  ds_read_b64_tr_b16 v[90:91], v16 offset:512
  ds_read_b64_tr_b16 v[92:93], v16 offset:8192
  ds_read_b64_tr_b16 v[94:95], v16 offset:8704
  s_waitcnt vmcnt(19) lgkmcnt(0)
  s_barrier
  s_add_u32 m0, s57, 98304
  s_add_u32 s54, s78, 3670016
  buffer_load_dwordx4 v8, s[16:19], s54 offen  lds
  s_add_u32 m0, s57, 102400
  s_add_u32 s54, s78, 3801088
  buffer_load_dwordx4 v8, s[16:19], s54 offen  lds
  s_add_u32 m0, s57, 106496
  s_add_u32 s54, s78, 3932160
  buffer_load_dwordx4 v8, s[16:19], s54 offen  lds
  s_add_u32 m0, s57, 110592
  s_add_u32 s54, s78, 4063232
  buffer_load_dwordx4 v8, s[16:19], s54 offen  lds
  v_add_u32 v15, 32768, v11
  v_add_u32 v16, 32768, v12
  ds_read_b64_tr_b16 v[96:97], v15 offset:0
  ds_read_b64_tr_b16 v[98:99], v15 offset:512
  ds_read_b64_tr_b16 v[100:101], v15 offset:8192
  ds_read_b64_tr_b16 v[102:103], v15 offset:8704
  ds_read_b64_tr_b16 v[104:105], v16 offset:0
  ds_read_b64_tr_b16 v[106:107], v16 offset:512
  ds_read_b64_tr_b16 v[108:109], v16 offset:8192
  ds_read_b64_tr_b16 v[110:111], v16 offset:8704
  s_waitcnt vmcnt(19) lgkmcnt(0)
  s_barrier
  s_add_u32 m0, s57, 114688
  s_add_u32 s54, s78, 4194304
  buffer_load_dwordx4 v8, s[16:19], s54 offen  lds
  s_add_u32 m0, s57, 118784
  s_add_u32 s54, s78, 4325376
  buffer_load_dwordx4 v8, s[16:19], s54 offen  lds
  s_add_u32 m0, s57, 122880
  s_add_u32 s54, s78, 4456448
  buffer_load_dwordx4 v8, s[16:19], s54 offen  lds
  s_add_u32 m0, s57, 126976
  s_add_u32 s54, s78, 4587520
  buffer_load_dwordx4 v8, s[16:19], s54 offen  lds
  v_add_u32 v15, 49152, v11
  v_add_u32 v16, 49152, v12
  ds_read_b64_tr_b16 v[112:113], v15 offset:0
  ds_read_b64_tr_b16 v[114:115], v15 offset:512
  ds_read_b64_tr_b16 v[116:117], v15 offset:8192
  ds_read_b64_tr_b16 v[118:119], v15 offset:8704
  ds_read_b64_tr_b16 v[120:121], v16 offset:0
  ds_read_b64_tr_b16 v[122:123], v16 offset:512
  ds_read_b64_tr_b16 v[124:125], v16 offset:8192
  ds_read_b64_tr_b16 v[126:127], v16 offset:8704
  s_waitcnt vmcnt(19) lgkmcnt(0)
  s_barrier
  s_add_u32 m0, s57, 131072
  s_add_u32 s54, s78, 1048576
  buffer_load_dwordx4 v8, s[20:23], s54 offen  lds
  s_add_u32 m0, s57, 135168
  s_add_u32 s54, s78, 1179648
  buffer_load_dwordx4 v8, s[20:23], s54 offen  lds
  s_add_u32 m0, s57, 139264
  s_add_u32 s54, s78, 1310720
  buffer_load_dwordx4 v8, s[20:23], s54 offen  lds
  s_add_u32 m0, s57, 143360
  s_add_u32 s54, s78, 1441792
  buffer_load_dwordx4 v8, s[20:23], s54 offen  lds
  v_add_u32 v15, 65536, v11
  v_add_u32 v16, 65536, v12
  ds_read_b64_tr_b16 v[128:129], v15 offset:0
  ds_read_b64_tr_b16 v[130:131], v15 offset:512
  ds_read_b64_tr_b16 v[132:133], v15 offset:8192
  ds_read_b64_tr_b16 v[134:135], v15 offset:8704
  ds_read_b64_tr_b16 v[136:137], v16 offset:0
  ds_read_b64_tr_b16 v[138:139], v16 offset:512
  ds_read_b64_tr_b16 v[140:141], v16 offset:8192
  ds_read_b64_tr_b16 v[142:143], v16 offset:8704
  s_waitcnt vmcnt(19) lgkmcnt(0)
  s_barrier
  s_add_u32 m0, s57, 0
  s_add_u32 s54, s78, 1572864
  buffer_load_dwordx4 v8, s[20:23], s54 offen  lds
  s_add_u32 m0, s57, 4096
  s_add_u32 s54, s78, 1703936
  buffer_load_dwordx4 v8, s[20:23], s54 offen  lds
  s_add_u32 m0, s57, 8192
  s_add_u32 s54, s78, 1835008
  buffer_load_dwordx4 v8, s[20:23], s54 offen  lds
  s_add_u32 m0, s57, 12288
  s_add_u32 s54, s78, 1966080
  buffer_load_dwordx4 v8, s[20:23], s54 offen  lds
  v_add_u32 v15, 81920, v11
  v_add_u32 v16, 81920, v12
  ds_read_b64_tr_b16 v[144:145], v15 offset:0
  ds_read_b64_tr_b16 v[146:147], v15 offset:512
  ds_read_b64_tr_b16 v[148:149], v15 offset:8192
  ds_read_b64_tr_b16 v[150:151], v15 offset:8704
  ds_read_b64_tr_b16 v[152:153], v16 offset:0
  ds_read_b64_tr_b16 v[154:155], v16 offset:512
  ds_read_b64_tr_b16 v[156:157], v16 offset:8192
  ds_read_b64_tr_b16 v[158:159], v16 offset:8704
  s_waitcnt vmcnt(16) lgkmcnt(0)
  s_barrier
  s_add_u32 m0, s57, 16384
  s_add_u32 s54, s78, 3145728
  buffer_load_dwordx4 v8, s[20:23], s54 offen  lds
  s_add_u32 m0, s57, 20480
  s_add_u32 s54, s78, 3276800
  buffer_load_dwordx4 v8, s[20:23], s54 offen  lds
  s_add_u32 m0, s57, 24576
  s_add_u32 s54, s78, 3407872
  buffer_load_dwordx4 v8, s[20:23], s54 offen  lds
  s_add_u32 m0, s57, 28672
  s_add_u32 s54, s78, 3538944
  buffer_load_dwordx4 v8, s[20:23], s54 offen  lds
  v_add_u32 v15, 98304, v11
  v_add_u32 v16, 98304, v12
  ds_read_b64_tr_b16 v[160:161], v15 offset:0
  ds_read_b64_tr_b16 v[162:163], v15 offset:512
  ds_read_b64_tr_b16 v[164:165], v15 offset:8192
  ds_read_b64_tr_b16 v[166:167], v15 offset:8704
  ds_read_b64_tr_b16 v[168:169], v16 offset:0
  ds_read_b64_tr_b16 v[170:171], v16 offset:512
  ds_read_b64_tr_b16 v[172:173], v16 offset:8192
  ds_read_b64_tr_b16 v[174:175], v16 offset:8704
  s_waitcnt vmcnt(16) lgkmcnt(0)
  s_barrier
  s_add_u32 m0, s57, 32768
  s_add_u32 s54, s78, 3670016
  buffer_load_dwordx4 v8, s[20:23], s54 offen  lds
  s_add_u32 m0, s57, 36864
  s_add_u32 s54, s78, 3801088
  buffer_load_dwordx4 v8, s[20:23], s54 offen  lds
  s_add_u32 m0, s57, 40960
  s_add_u32 s54, s78, 3932160
  buffer_load_dwordx4 v8, s[20:23], s54 offen  lds
  s_add_u32 m0, s57, 45056
  s_add_u32 s54, s78, 4063232
  buffer_load_dwordx4 v8, s[20:23], s54 offen  lds
  s_cmp_eq_u32 s1, 1
  s_cbranch_scc1 C_ver_ok
  v_mov_b32 v33, 16320
  s_cmp_eq_u32 s52, 0
  s_cbranch_scc0 C_ver_b
  s_waitcnt vmcnt(52)
  s_mov_b64 exec, 1
  ds_write_b32 v33, v35
  s_mov_b64 exec, -1
  s_waitcnt lgkmcnt(0)
C_ver_b:
  s_barrier
  ds_read_b32 v32, v33
  s_waitcnt lgkmcnt(0)
  v_readfirstlane_b32 s54, v32
  s_nop 0
  s_bitcmp1_b32 s54, s0
  s_cbranch_scc1 L_conf
C_ver_ok:
  v_add_u32 v15, 114688, v11
  v_add_u32 v16, 114688, v12
  ds_read_b64_tr_b16 v[176:177], v15 offset:0
  ds_read_b64_tr_b16 v[178:179], v15 offset:512
  ds_read_b64_tr_b16 v[180:181], v15 offset:8192
  ds_read_b64_tr_b16 v[182:183], v15 offset:8704
  ds_read_b64_tr_b16 v[184:185], v16 offset:0
  ds_read_b64_tr_b16 v[186:187], v16 offset:512
  ds_read_b64_tr_b16 v[188:189], v16 offset:8192
  ds_read_b64_tr_b16 v[190:191], v16 offset:8704
  s_waitcnt vmcnt(16) lgkmcnt(0)
  s_barrier
  s_add_u32 m0, s57, 49152
  s_add_u32 s54, s78, 4194304
  buffer_load_dwordx4 v8, s[20:23], s54 offen  lds
  s_add_u32 m0, s57, 53248
  s_add_u32 s54, s78, 4325376
  buffer_load_dwordx4 v8, s[20:23], s54 offen  lds
  s_add_u32 m0, s57, 57344
  s_add_u32 s54, s78, 4456448
  buffer_load_dwordx4 v8, s[20:23], s54 offen  lds
  s_add_u32 m0, s57, 61440
  s_add_u32 s54, s78, 4587520
  buffer_load_dwordx4 v8, s[20:23], s54 offen  lds
  v_add_u32 v15, 131072, v11
  v_add_u32 v16, 131072, v12
  ds_read_b64_tr_b16 v[192:193], v15 offset:0
  ds_read_b64_tr_b16 v[194:195], v15 offset:512
  ds_read_b64_tr_b16 v[196:197], v15 offset:8192
  ds_read_b64_tr_b16 v[198:199], v15 offset:8704
  ds_read_b64_tr_b16 v[200:201], v16 offset:0
  ds_read_b64_tr_b16 v[202:203], v16 offset:512
  ds_read_b64_tr_b16 v[204:205], v16 offset:8192
  ds_read_b64_tr_b16 v[206:207], v16 offset:8704
  s_waitcnt vmcnt(16) lgkmcnt(0)
  s_barrier
  s_add_u32 m0, s57, 65536
  s_add_u32 s54, s78, 0
  buffer_load_dwordx4 v8, s[24:27], s54 offen  lds
  s_add_u32 m0, s57, 69632
  s_add_u32 s54, s78, 131072
  buffer_load_dwordx4 v8, s[24:27], s54 offen  lds
  s_add_u32 m0, s57, 73728
  s_add_u32 s54, s78, 262144
  buffer_load_dwordx4 v8, s[24:27], s54 offen  lds
  s_add_u32 m0, s57, 77824
  s_add_u32 s54, s78, 393216
  buffer_load_dwordx4 v8, s[24:27], s54 offen  lds
  s_getpc_b64 s[80:81]
  v_lshlrev_b32 v7, 2, v76
  global_load_dword v35, v7, s[80:81] offset:1024
  v_min_u32 v20, -2, v20
  v_min_u32 v21, -2, v21
  v_min_u32 v22, -2, v22
  v_min_u32 v23, -2, v23
  v_min_u32 v24, -2, v24
  v_min_u32 v25, -2, v25
  v_min_u32 v26, -2, v26
  v_min_u32 v27, -2, v27
  v_min_u32 v28, -2, v28
  v_min_u32 v29, -2, v29
  v_min_u32 v30, -2, v30
  v_min_u32 v31, -2, v31
  s_lshl_b32 s54, s52, 11
  v_add_u32 v3, s54, v76
  ds_write_b128 v3, v[20:23] offset:4608
  ds_write_b128 v3, v[24:27] offset:5632
  ds_write_b128 v76, v[28:31] offset:12800
  v_add_u32 v15, 147456, v11
  v_add_u32 v16, 147456, v12
  ds_read_b64_tr_b16 v[208:209], v15 offset:0
  ds_read_b64_tr_b16 v[210:211], v15 offset:512
  ds_read_b64_tr_b16 v[212:213], v15 offset:8192
  ds_read_b64_tr_b16 v[214:215], v15 offset:8704
  ds_read_b64_tr_b16 v[216:217], v16 offset:0
  ds_read_b64_tr_b16 v[218:219], v16 offset:512
  ds_read_b64_tr_b16 v[220:221], v16 offset:8192
  ds_read_b64_tr_b16 v[222:223], v16 offset:8704
  s_waitcnt vmcnt(17) lgkmcnt(0)
  s_barrier
  s_add_u32 m0, s57, 81920
  s_add_u32 s54, s78, 524288
  buffer_load_dwordx4 v8, s[24:27], s54 offen  lds
  s_add_u32 m0, s57, 86016
  s_add_u32 s54, s78, 655360
  buffer_load_dwordx4 v8, s[24:27], s54 offen  lds
  s_add_u32 m0, s57, 90112
  s_add_u32 s54, s78, 786432
  buffer_load_dwordx4 v8, s[24:27], s54 offen  lds
  s_add_u32 m0, s57, 94208
  s_add_u32 s54, s78, 917504
  buffer_load_dwordx4 v8, s[24:27], s54 offen  lds
  v_add_u32 v15, 16384, v11
  v_add_u32 v16, 16384, v12
  ds_read_b64_tr_b16 v[224:225], v15 offset:0
  ds_read_b64_tr_b16 v[226:227], v15 offset:512
  ds_read_b64_tr_b16 v[228:229], v15 offset:8192
  ds_read_b64_tr_b16 v[230:231], v15 offset:8704
  ds_read_b64_tr_b16 v[232:233], v16 offset:0
  ds_read_b64_tr_b16 v[234:235], v16 offset:512
  ds_read_b64_tr_b16 v[236:237], v16 offset:8192
  ds_read_b64_tr_b16 v[238:239], v16 offset:8704
  s_waitcnt vmcnt(17) lgkmcnt(0)
  s_barrier
  s_add_u32 m0, s57, 98304
  s_add_u32 s54, s78, 1048576
  buffer_load_dwordx4 v8, s[24:27], s54 offen  lds
  s_add_u32 m0, s57, 102400
  s_add_u32 s54, s78, 1179648
  buffer_load_dwordx4 v8, s[24:27], s54 offen  lds
  s_add_u32 m0, s57, 106496
  s_add_u32 s54, s78, 1310720
  buffer_load_dwordx4 v8, s[24:27], s54 offen  lds
  s_add_u32 m0, s57, 110592
  s_add_u32 s54, s78, 1441792
  buffer_load_dwordx4 v8, s[24:27], s54 offen  lds
  v_add_u32 v15, 32768, v11
  v_add_u32 v16, 32768, v12
  ds_read_b64_tr_b16 v[240:241], v15 offset:0
  ds_read_b64_tr_b16 v[242:243], v15 offset:512
  ds_read_b64_tr_b16 v[244:245], v15 offset:8192
  ds_read_b64_tr_b16 v[246:247], v15 offset:8704
  ds_read_b64_tr_b16 v[248:249], v16 offset:0
  ds_read_b64_tr_b16 v[250:251], v16 offset:512
  ds_read_b64_tr_b16 v[252:253], v16 offset:8192
  ds_read_b64_tr_b16 v[254:255], v16 offset:8704
  s_waitcnt vmcnt(17) lgkmcnt(0)
  s_barrier
  s_add_u32 m0, s57, 114688
  s_add_u32 s54, s78, 1572864
  buffer_load_dwordx4 v8, s[24:27], s54 offen  lds
  s_add_u32 m0, s57, 118784
  s_add_u32 s54, s78, 1703936
  buffer_load_dwordx4 v8, s[24:27], s54 offen  lds
  s_add_u32 m0, s57, 122880
  s_add_u32 s54, s78, 1835008
  buffer_load_dwordx4 v8, s[24:27], s54 offen  lds
  s_add_u32 m0, s57, 126976
  s_add_u32 s54, s78, 1966080
  buffer_load_dwordx4 v8, s[24:27], s54 offen  lds
  v_add_u32 v15, 49152, v11
  v_add_u32 v16, 49152, v12
  ds_read_b64_tr_b16 a[0:1], v15 offset:0
  ds_read_b64_tr_b16 a[2:3], v15 offset:512
  ds_read_b64_tr_b16 a[4:5], v15 offset:8192
  ds_read_b64_tr_b16 a[6:7], v15 offset:8704
  ds_read_b64_tr_b16 a[8:9], v16 offset:0
  ds_read_b64_tr_b16 a[10:11], v16 offset:512
  ds_read_b64_tr_b16 a[12:13], v16 offset:8192
  ds_read_b64_tr_b16 a[14:15], v16 offset:8704
  s_waitcnt vmcnt(17) lgkmcnt(0)
  s_barrier
  s_add_u32 m0, s57, 131072
  s_add_u32 s54, s78, 2097152
  buffer_load_dwordx4 v8, s[24:27], s54 offen  lds
  s_add_u32 m0, s57, 135168
  s_add_u32 s54, s78, 2228224
  buffer_load_dwordx4 v8, s[24:27], s54 offen  lds
  s_add_u32 m0, s57, 139264
  s_add_u32 s54, s78, 2359296
  buffer_load_dwordx4 v8, s[24:27], s54 offen  lds
  s_add_u32 m0, s57, 143360
  s_add_u32 s54, s78, 2490368
  buffer_load_dwordx4 v8, s[24:27], s54 offen  lds
  v_add_u32 v15, 65536, v11
  v_add_u32 v16, 65536, v12
  ds_read_b64_tr_b16 a[16:17], v15 offset:0
  ds_read_b64_tr_b16 a[18:19], v15 offset:512
  ds_read_b64_tr_b16 a[20:21], v15 offset:8192
  ds_read_b64_tr_b16 a[22:23], v15 offset:8704
  ds_read_b64_tr_b16 a[24:25], v16 offset:0
  ds_read_b64_tr_b16 a[26:27], v16 offset:512
  ds_read_b64_tr_b16 a[28:29], v16 offset:8192
  ds_read_b64_tr_b16 a[30:31], v16 offset:8704
  s_waitcnt vmcnt(17) lgkmcnt(0)
  s_barrier
  s_add_u32 m0, s57, 0
  s_add_u32 s54, s78, 2621440
  buffer_load_dwordx4 v8, s[24:27], s54 offen  lds
  s_add_u32 m0, s57, 4096
  s_add_u32 s54, s78, 2752512
  buffer_load_dwordx4 v8, s[24:27], s54 offen  lds
  s_add_u32 m0, s57, 8192
  s_add_u32 s54, s78, 2883584
  buffer_load_dwordx4 v8, s[24:27], s54 offen  lds
  s_add_u32 m0, s57, 12288
  s_add_u32 s54, s78, 3014656
  buffer_load_dwordx4 v8, s[24:27], s54 offen  lds
  v_add_u32 v15, 81920, v11
  v_add_u32 v16, 81920, v12
  ds_read_b64_tr_b16 a[32:33], v15 offset:0
  ds_read_b64_tr_b16 a[34:35], v15 offset:512
  ds_read_b64_tr_b16 a[36:37], v15 offset:8192
  ds_read_b64_tr_b16 a[38:39], v15 offset:8704
  ds_read_b64_tr_b16 a[40:41], v16 offset:0
  ds_read_b64_tr_b16 a[42:43], v16 offset:512
  ds_read_b64_tr_b16 a[44:45], v16 offset:8192
  ds_read_b64_tr_b16 a[46:47], v16 offset:8704
  s_waitcnt vmcnt(16) lgkmcnt(0)
  s_barrier
  s_add_u32 m0, s57, 16384
  s_add_u32 s54, s78, 3145728
  buffer_load_dwordx4 v8, s[24:27], s54 offen  lds
  s_add_u32 m0, s57, 20480
  s_add_u32 s54, s78, 3276800
  buffer_load_dwordx4 v8, s[24:27], s54 offen  lds
  s_add_u32 m0, s57, 24576
  s_add_u32 s54, s78, 3407872
  buffer_load_dwordx4 v8, s[24:27], s54 offen  lds
  s_add_u32 m0, s57, 28672
  s_add_u32 s54, s78, 3538944
  buffer_load_dwordx4 v8, s[24:27], s54 offen  lds
  s_getpc_b64 s[80:81]
  v_lshlrev_b32 v7, 2, v76
  global_load_dword v35, v7, s[80:81] offset:1024
  v_add_u32 v15, 98304, v11
  v_add_u32 v16, 98304, v12
  ds_read_b64_tr_b16 a[48:49], v15 offset:0
  ds_read_b64_tr_b16 a[50:51], v15 offset:512
  ds_read_b64_tr_b16 a[52:53], v15 offset:8192
  ds_read_b64_tr_b16 a[54:55], v15 offset:8704
  ds_read_b64_tr_b16 a[56:57], v16 offset:0
  ds_read_b64_tr_b16 a[58:59], v16 offset:512
  ds_read_b64_tr_b16 a[60:61], v16 offset:8192
  ds_read_b64_tr_b16 a[62:63], v16 offset:8704
  s_waitcnt vmcnt(17) lgkmcnt(0)
  s_barrier
  s_add_u32 m0, s57, 32768
  s_add_u32 s54, s78, 3670016
  buffer_load_dwordx4 v8, s[24:27], s54 offen  lds
  s_add_u32 m0, s57, 36864
  s_add_u32 s54, s78, 3801088
  buffer_load_dwordx4 v8, s[24:27], s54 offen  lds
  s_add_u32 m0, s57, 40960
  s_add_u32 s54, s78, 3932160
  buffer_load_dwordx4 v8, s[24:27], s54 offen  lds
  s_add_u32 m0, s57, 45056
  s_add_u32 s54, s78, 4063232
  buffer_load_dwordx4 v8, s[24:27], s54 offen  lds
  v_add_u32 v15, 114688, v11
  v_add_u32 v16, 114688, v12
  ds_read_b64_tr_b16 a[64:65], v15 offset:0
  ds_read_b64_tr_b16 a[66:67], v15 offset:512
  ds_read_b64_tr_b16 a[68:69], v15 offset:8192
  ds_read_b64_tr_b16 a[70:71], v15 offset:8704
  ds_read_b64_tr_b16 a[72:73], v16 offset:0
  ds_read_b64_tr_b16 a[74:75], v16 offset:512
  ds_read_b64_tr_b16 a[76:77], v16 offset:8192
  ds_read_b64_tr_b16 a[78:79], v16 offset:8704
  s_waitcnt vmcnt(17) lgkmcnt(0)
  s_barrier
  s_add_u32 m0, s57, 49152
  s_add_u32 s54, s78, 4194304
  buffer_load_dwordx4 v8, s[24:27], s54 offen  lds
  s_add_u32 m0, s57, 53248
  s_add_u32 s54, s78, 4325376
  buffer_load_dwordx4 v8, s[24:27], s54 offen  lds
  s_add_u32 m0, s57, 57344
  s_add_u32 s54, s78, 4456448
  buffer_load_dwordx4 v8, s[24:27], s54 offen  lds
  s_add_u32 m0, s57, 61440
  s_add_u32 s54, s78, 4587520
  buffer_load_dwordx4 v8, s[24:27], s54 offen  lds
  v_add_u32 v15, 131072, v11
  v_add_u32 v16, 131072, v12
  ds_read_b64_tr_b16 a[80:81], v15 offset:0
  ds_read_b64_tr_b16 a[82:83], v15 offset:512
  ds_read_b64_tr_b16 a[84:85], v15 offset:8192
  ds_read_b64_tr_b16 a[86:87], v15 offset:8704
  ds_read_b64_tr_b16 a[88:89], v16 offset:0
  ds_read_b64_tr_b16 a[90:91], v16 offset:512
  ds_read_b64_tr_b16 a[92:93], v16 offset:8192
  ds_read_b64_tr_b16 a[94:95], v16 offset:8704
  s_waitcnt vmcnt(17) lgkmcnt(0)
  s_barrier
  s_add_u32 m0, s57, 65536
  s_add_u32 s54, s79, 73728
  buffer_load_dwordx4 v10, s[28:31], s54 offen  lds
  s_add_u32 m0, s57, 69632
  s_add_u32 s54, s79, 82944
  buffer_load_dwordx4 v10, s[28:31], s54 offen  lds
  s_add_u32 m0, s57, 73728
  s_add_u32 s54, s79, 110592
  buffer_load_dwordx4 v10, s[28:31], s54 offen  lds
  s_add_u32 m0, s57, 77824
  s_add_u32 s54, s79, 119808
  buffer_load_dwordx4 v10, s[28:31], s54 offen  lds
  v_add_u32 v15, 147456, v11
  v_add_u32 v16, 147456, v12
  ds_read_b64_tr_b16 a[96:97], v15 offset:0
  ds_read_b64_tr_b16 a[98:99], v15 offset:512
  ds_read_b64_tr_b16 a[100:101], v15 offset:8192
  ds_read_b64_tr_b16 a[102:103], v15 offset:8704
  ds_read_b64_tr_b16 a[104:105], v16 offset:0
  ds_read_b64_tr_b16 a[106:107], v16 offset:512
  ds_read_b64_tr_b16 a[108:109], v16 offset:8192
  ds_read_b64_tr_b16 a[110:111], v16 offset:8704
  s_waitcnt vmcnt(17) lgkmcnt(0)
  s_barrier
  s_add_u32 m0, s57, 81920
  s_add_u32 s54, s79, 256
  buffer_load_dwordx4 v10, s[28:31], s54 offen  lds
  s_add_u32 m0, s57, 86016
  s_add_u32 s54, s79, 9472
  buffer_load_dwordx4 v10, s[28:31], s54 offen  lds
  s_add_u32 m0, s57, 90112
  s_add_u32 s54, s79, 37120
  buffer_load_dwordx4 v10, s[28:31], s54 offen  lds
  s_add_u32 m0, s57, 94208
  s_add_u32 s54, s79, 46336
  buffer_load_dwordx4 v10, s[28:31], s54 offen  lds
  v_add_u32 v15, 16384, v11
  v_add_u32 v16, 16384, v12
  ds_read_b64_tr_b16 a[112:113], v15 offset:0
  ds_read_b64_tr_b16 a[114:115], v15 offset:512
  ds_read_b64_tr_b16 a[116:117], v15 offset:8192
  ds_read_b64_tr_b16 a[118:119], v15 offset:8704
  ds_read_b64_tr_b16 a[120:121], v16 offset:0
  ds_read_b64_tr_b16 a[122:123], v16 offset:512
  ds_read_b64_tr_b16 a[124:125], v16 offset:8192
  ds_read_b64_tr_b16 a[126:127], v16 offset:8704
  s_waitcnt vmcnt(17) lgkmcnt(0)
  s_barrier
  s_add_u32 m0, s57, 98304
  s_add_u32 s54, s79, 512
  buffer_load_dwordx4 v10, s[28:31], s54 offen  lds
  s_add_u32 m0, s57, 102400
  s_add_u32 s54, s79, 9728
  buffer_load_dwordx4 v10, s[28:31], s54 offen  lds
  s_add_u32 m0, s57, 106496
  s_add_u32 s54, s79, 37376
  buffer_load_dwordx4 v10, s[28:31], s54 offen  lds
  s_add_u32 m0, s57, 110592
  s_add_u32 s54, s79, 46592
  buffer_load_dwordx4 v10, s[28:31], s54 offen  lds
  v_add_u32 v15, 32768, v11
  v_add_u32 v16, 32768, v12
  ds_read_b64_tr_b16 a[128:129], v15 offset:0
  ds_read_b64_tr_b16 a[130:131], v15 offset:512
  ds_read_b64_tr_b16 a[132:133], v15 offset:8192
  ds_read_b64_tr_b16 a[134:135], v15 offset:8704
  ds_read_b64_tr_b16 a[136:137], v16 offset:0
  ds_read_b64_tr_b16 a[138:139], v16 offset:512
  ds_read_b64_tr_b16 a[140:141], v16 offset:8192
  ds_read_b64_tr_b16 a[142:143], v16 offset:8704
  s_waitcnt vmcnt(16) lgkmcnt(0)
  s_barrier
  s_add_u32 m0, s57, 114688
  s_add_u32 s54, s79, 768
  buffer_load_dwordx4 v10, s[28:31], s54 offen  lds
  s_add_u32 m0, s57, 118784
  s_add_u32 s54, s79, 9984
  buffer_load_dwordx4 v10, s[28:31], s54 offen  lds
  s_add_u32 m0, s57, 122880
  s_add_u32 s54, s79, 37632
  buffer_load_dwordx4 v10, s[28:31], s54 offen  lds
  s_add_u32 m0, s57, 126976
  s_add_u32 s54, s79, 46848
  buffer_load_dwordx4 v10, s[28:31], s54 offen  lds
  s_getpc_b64 s[80:81]
  v_lshlrev_b32 v7, 2, v76
  global_load_dword v35, v7, s[80:81] offset:1024
  v_add_u32 v15, 49152, v11
  v_add_u32 v16, 49152, v12
  ds_read_b64_tr_b16 a[144:145], v15 offset:0
  ds_read_b64_tr_b16 a[146:147], v15 offset:512
  ds_read_b64_tr_b16 a[148:149], v15 offset:8192
  ds_read_b64_tr_b16 a[150:151], v15 offset:8704
  ds_read_b64_tr_b16 a[152:153], v16 offset:0
  ds_read_b64_tr_b16 a[154:155], v16 offset:512
  ds_read_b64_tr_b16 a[156:157], v16 offset:8192
  ds_read_b64_tr_b16 a[158:159], v16 offset:8704
  s_waitcnt vmcnt(17) lgkmcnt(0)
  s_barrier
  s_add_u32 m0, s57, 131072
  s_add_u32 s54, s79, 74496
  buffer_load_dwordx4 v10, s[28:31], s54 offen  lds
  s_add_u32 m0, s57, 135168
  s_add_u32 s54, s79, 83712
  buffer_load_dwordx4 v10, s[28:31], s54 offen  lds
  s_add_u32 m0, s57, 139264
  s_add_u32 s54, s79, 111360
  buffer_load_dwordx4 v10, s[28:31], s54 offen  lds
  s_add_u32 m0, s57, 143360
  s_add_u32 s54, s79, 120576
  buffer_load_dwordx4 v10, s[28:31], s54 offen  lds
  v_add_u32 v15, 65536, v11
  v_add_u32 v16, 65536, v12
  ds_read_b64_tr_b16 a[160:161], v15 offset:0
  ds_read_b64_tr_b16 a[162:163], v15 offset:512
  ds_read_b64_tr_b16 a[164:165], v15 offset:8192
  ds_read_b64_tr_b16 a[166:167], v15 offset:8704
  ds_read_b64_tr_b16 a[168:169], v16 offset:0
  ds_read_b64_tr_b16 a[170:171], v16 offset:512
  ds_read_b64_tr_b16 a[172:173], v16 offset:8192
  ds_read_b64_tr_b16 a[174:175], v16 offset:8704
  s_waitcnt vmcnt(17) lgkmcnt(0)
  s_barrier
  s_add_u32 m0, s57, 0
  s_add_u32 s54, s78, 0
  buffer_load_dwordx4 v8, s[20:23], s54 offen  lds
  s_add_u32 m0, s57, 4096
  s_add_u32 s54, s78, 131072
  buffer_load_dwordx4 v8, s[20:23], s54 offen  lds
  s_add_u32 m0, s57, 8192
  s_add_u32 s54, s78, 262144
  buffer_load_dwordx4 v8, s[20:23], s54 offen  lds
  s_add_u32 m0, s57, 12288
  s_add_u32 s54, s78, 393216
  buffer_load_dwordx4 v8, s[20:23], s54 offen  lds
  v_add_u32 v15, 81920, v14
  ds_read_b64_tr_b16 a[176:177], v15 offset:0
  ds_read_b64_tr_b16 a[178:179], v15 offset:1024
  ds_read_b64_tr_b16 a[180:181], v15 offset:4096
  ds_read_b64_tr_b16 a[182:183], v15 offset:5120
  ds_read_b64_tr_b16 a[184:185], v15 offset:8192
  ds_read_b64_tr_b16 a[186:187], v15 offset:9216
  ds_read_b64_tr_b16 a[188:189], v15 offset:12288
  ds_read_b64_tr_b16 a[190:191], v15 offset:13312
  s_waitcnt vmcnt(17) lgkmcnt(0)
  s_barrier
  s_add_u32 m0, s57, 16384
  s_add_u32 s54, s78, 524288
  buffer_load_dwordx4 v8, s[20:23], s54 offen  lds
  s_add_u32 m0, s57, 20480
  s_add_u32 s54, s78, 655360
  buffer_load_dwordx4 v8, s[20:23], s54 offen  lds
  s_add_u32 m0, s57, 24576
  s_add_u32 s54, s78, 786432
  buffer_load_dwordx4 v8, s[20:23], s54 offen  lds
  s_add_u32 m0, s57, 28672
  s_add_u32 s54, s78, 917504
  buffer_load_dwordx4 v8, s[20:23], s54 offen  lds
  v_add_u32 v15, 98304, v14
  ds_read_b64_tr_b16 a[192:193], v15 offset:0
  ds_read_b64_tr_b16 a[194:195], v15 offset:1024
  ds_read_b64_tr_b16 a[196:197], v15 offset:4096
  ds_read_b64_tr_b16 a[198:199], v15 offset:5120
  ds_read_b64_tr_b16 a[200:201], v15 offset:8192
  ds_read_b64_tr_b16 a[202:203], v15 offset:9216
  ds_read_b64_tr_b16 a[204:205], v15 offset:12288
  ds_read_b64_tr_b16 a[206:207], v15 offset:13312
  s_waitcnt vmcnt(17) lgkmcnt(0)
  s_barrier
  s_add_u32 m0, s57, 32768
  s_add_u32 s54, s78, 2097152
  buffer_load_dwordx4 v8, s[20:23], s54 offen  lds
  s_add_u32 m0, s57, 36864
  s_add_u32 s54, s78, 2228224
  buffer_load_dwordx4 v8, s[20:23], s54 offen  lds
  s_add_u32 m0, s57, 40960
  s_add_u32 s54, s78, 2359296
  buffer_load_dwordx4 v8, s[20:23], s54 offen  lds
  s_add_u32 m0, s57, 45056
  s_add_u32 s54, s78, 2490368
  buffer_load_dwordx4 v8, s[20:23], s54 offen  lds
  v_add_u32 v15, 114688, v14
  ds_read_b64_tr_b16 a[208:209], v15 offset:0
  ds_read_b64_tr_b16 a[210:211], v15 offset:1024
  ds_read_b64_tr_b16 a[212:213], v15 offset:4096
  ds_read_b64_tr_b16 a[214:215], v15 offset:5120
  ds_read_b64_tr_b16 a[216:217], v15 offset:8192
  ds_read_b64_tr_b16 a[218:219], v15 offset:9216
  ds_read_b64_tr_b16 a[220:221], v15 offset:12288
  ds_read_b64_tr_b16 a[222:223], v15 offset:13312
  s_waitcnt vmcnt(17) lgkmcnt(0)
  s_barrier
  s_add_u32 m0, s57, 49152
  s_add_u32 s54, s78, 3145728
  buffer_load_dwordx4 v8, s[16:19], s54 offen  lds
  s_add_u32 m0, s57, 53248
  s_add_u32 s54, s78, 3276800
  buffer_load_dwordx4 v8, s[16:19], s54 offen  lds
  s_add_u32 m0, s57, 57344
  s_add_u32 s54, s78, 3407872
  buffer_load_dwordx4 v8, s[16:19], s54 offen  lds
  s_add_u32 m0, s57, 61440
  s_add_u32 s54, s78, 3538944
  buffer_load_dwordx4 v8, s[16:19], s54 offen  lds
  v_add_u32 v15, 131072, v14
  ds_read_b64_tr_b16 a[224:225], v15 offset:0
  ds_read_b64_tr_b16 a[226:227], v15 offset:1024
  ds_read_b64_tr_b16 a[228:229], v15 offset:4096
  ds_read_b64_tr_b16 a[230:231], v15 offset:5120
  ds_read_b64_tr_b16 a[232:233], v15 offset:8192
  ds_read_b64_tr_b16 a[234:235], v15 offset:9216
  ds_read_b64_tr_b16 a[236:237], v15 offset:12288
  ds_read_b64_tr_b16 a[238:239], v15 offset:13312
  s_waitcnt vmcnt(16) lgkmcnt(0)
  s_barrier
  s_add_u32 m0, s57, 65536
  s_add_u32 s54, s78, 2621440
  buffer_load_dwordx4 v8, s[20:23], s54 offen  lds
  s_add_u32 m0, s57, 69632
  s_add_u32 s54, s78, 2752512
  buffer_load_dwordx4 v8, s[20:23], s54 offen  lds
  s_add_u32 m0, s57, 73728
  s_add_u32 s54, s78, 2883584
  buffer_load_dwordx4 v8, s[20:23], s54 offen  lds
  s_add_u32 m0, s57, 77824
  s_add_u32 s54, s78, 3014656
  buffer_load_dwordx4 v8, s[20:23], s54 offen  lds
  v_add_u32 v15, 147456, v14
  ds_read_b64_tr_b16 a[240:241], v15 offset:0
  ds_read_b64_tr_b16 a[242:243], v15 offset:1024
  ds_read_b64_tr_b16 a[244:245], v15 offset:4096
  ds_read_b64_tr_b16 a[246:247], v15 offset:5120
  ds_read_b64_tr_b16 a[248:249], v15 offset:8192
  ds_read_b64_tr_b16 a[250:251], v15 offset:9216
  ds_read_b64_tr_b16 a[252:253], v15 offset:12288
  ds_read_b64_tr_b16 a[254:255], v15 offset:13312
  s_waitcnt vmcnt(16) lgkmcnt(0)
  s_barrier
  s_add_u32 m0, s57, 81920
  s_add_u32 s54, s79, 1024
  buffer_load_dwordx4 v9, s[28:31], s54 offen  lds
  s_add_u32 m0, s57, 86016
  s_add_u32 s54, s79, 37888
  buffer_load_dwordx4 v9, s[28:31], s54 offen  lds
  s_add_u32 m0, s57, 90112
  s_add_u32 s54, s79, 74752
  buffer_load_dwordx4 v9, s[28:31], s54 offen  lds
  s_add_u32 m0, s57, 94208
  s_add_u32 s54, s79, 111616
  buffer_load_dwordx4 v9, s[28:31], s54 offen  lds
  v_add_u32 v15, 16384, v11
  v_add_u32 v16, 16384, v12
  ds_read_b64_tr_b16 v[52:53], v15 offset:0
  ds_read_b64_tr_b16 v[54:55], v15 offset:512
  ds_read_b64_tr_b16 v[56:57], v15 offset:8192
  ds_read_b64_tr_b16 v[58:59], v15 offset:8704
  ds_read_b64_tr_b16 v[60:61], v16 offset:0
  ds_read_b64_tr_b16 v[62:63], v16 offset:512
  ds_read_b64_tr_b16 v[64:65], v16 offset:8192
  ds_read_b64_tr_b16 v[66:67], v16 offset:8704
  s_waitcnt vmcnt(16) lgkmcnt(0)
  s_barrier
  s_lshl_b32 s54, s52, 12
  s_add_u32 s54, s54, 16384
  v_add_u32 v7, s54, v76
  ds_write_b128 v7, v[52:55] offset:0
  ds_write_b128 v7, v[56:59] offset:1024
  ds_write_b128 v7, v[60:63] offset:2048
  ds_write_b128 v7, v[64:67] offset:3072
  s_add_u32 m0, s57, 98304
  s_add_u32 s54, s79, 0
  buffer_load_dwordx4 v10, s[28:31], s54 offen  lds
  s_add_u32 m0, s57, 102400
  s_add_u32 s54, s79, 9216
  buffer_load_dwordx4 v10, s[28:31], s54 offen  lds
  s_add_u32 m0, s57, 106496
  s_add_u32 s54, s79, 36864
  buffer_load_dwordx4 v10, s[28:31], s54 offen  lds
  s_add_u32 m0, s57, 110592
  s_add_u32 s54, s79, 46080
  buffer_load_dwordx4 v10, s[28:31], s54 offen  lds
  v_add_u32 v15, 32768, v11
  v_add_u32 v16, 32768, v12
  ds_read_b64_tr_b16 v[36:37], v15 offset:0
  ds_read_b64_tr_b16 v[38:39], v15 offset:512
  ds_read_b64_tr_b16 v[40:41], v15 offset:8192
  ds_read_b64_tr_b16 v[42:43], v15 offset:8704
  ds_read_b64_tr_b16 v[44:45], v16 offset:0
  ds_read_b64_tr_b16 v[46:47], v16 offset:512
  ds_read_b64_tr_b16 v[48:49], v16 offset:8192
  ds_read_b64_tr_b16 v[50:51], v16 offset:8704
  s_waitcnt vmcnt(16) lgkmcnt(0)
  s_barrier
  s_lshl_b32 s54, s52, 12
  s_add_u32 s54, s54, 32768
  v_add_u32 v7, s54, v76
  ds_write_b128 v7, v[36:39] offset:0
  ds_write_b128 v7, v[40:43] offset:1024
  ds_write_b128 v7, v[44:47] offset:2048
  ds_write_b128 v7, v[48:51] offset:3072
  s_add_u32 m0, s57, 114688
  s_add_u32 s54, s79, 73984
  buffer_load_dwordx4 v10, s[28:31], s54 offen  lds
  s_add_u32 m0, s57, 118784
  s_add_u32 s54, s79, 83200
  buffer_load_dwordx4 v10, s[28:31], s54 offen  lds
  s_add_u32 m0, s57, 122880
  s_add_u32 s54, s79, 110848
  buffer_load_dwordx4 v10, s[28:31], s54 offen  lds
  s_add_u32 m0, s57, 126976
  s_add_u32 s54, s79, 120064
  buffer_load_dwordx4 v10, s[28:31], s54 offen  lds
  v_add_u32 v15, 49152, v11
  v_add_u32 v16, 49152, v12
  ds_read_b64_tr_b16 v[52:53], v15 offset:0
  ds_read_b64_tr_b16 v[54:55], v15 offset:512
  ds_read_b64_tr_b16 v[56:57], v15 offset:8192
  ds_read_b64_tr_b16 v[58:59], v15 offset:8704
  ds_read_b64_tr_b16 v[60:61], v16 offset:0
  ds_read_b64_tr_b16 v[62:63], v16 offset:512
  ds_read_b64_tr_b16 v[64:65], v16 offset:8192
  ds_read_b64_tr_b16 v[66:67], v16 offset:8704
  s_waitcnt vmcnt(16) lgkmcnt(0)
  s_barrier
  s_lshl_b32 s54, s52, 12
  s_add_u32 s54, s54, 49152
  v_add_u32 v7, s54, v76
  ds_write_b128 v7, v[52:55] offset:0
  ds_write_b128 v7, v[56:59] offset:1024
  ds_write_b128 v7, v[60:63] offset:2048
  ds_write_b128 v7, v[64:67] offset:3072
  s_add_u32 m0, s57, 131072
  s_add_u32 s54, s79, 74240
  buffer_load_dwordx4 v10, s[28:31], s54 offen  lds
  s_add_u32 m0, s57, 135168
  s_add_u32 s54, s79, 83456
  buffer_load_dwordx4 v10, s[28:31], s54 offen  lds
  s_add_u32 m0, s57, 139264
  s_add_u32 s54, s79, 111104
  buffer_load_dwordx4 v10, s[28:31], s54 offen  lds
  s_add_u32 m0, s57, 143360
  s_add_u32 s54, s79, 120320
  buffer_load_dwordx4 v10, s[28:31], s54 offen  lds
  v_lshlrev_b32 v7, 3, v76
  s_lshl_b32 s54, s52, 13
  s_add_u32 s54, s54, 360448
  s_bitcmp1_b32 s52, 0
  s_cselect_b64 exec, 0xff, -1
  buffer_load_dword v35, v7, s[8:11], s54 offen sc1
  s_mov_b64 exec, -1
  s_getpc_b64 s[80:81]
C_pc:
  s_mov_b32 s55, (L_w0 - C_pc)
  s_cmp_eq_u32 s52, 1
  s_cselect_b32 s55, (L_w1 - C_pc), s55
  s_cmp_eq_u32 s52, 2
  s_cselect_b32 s55, (L_w2 - C_pc), s55
  s_cmp_eq_u32 s52, 3
  s_cselect_b32 s55, (L_w3 - C_pc), s55
  v_lshl_add_u32 v7, v76, 3, s55
  global_load_dword v35, v7, s[80:81]
  v_add_u32 v15, 65536, v11
  v_add_u32 v16, 65536, v12
  ds_read_b64_tr_b16 v[36:37], v15 offset:0
  ds_read_b64_tr_b16 v[38:39], v15 offset:512
  ds_read_b64_tr_b16 v[40:41], v15 offset:8192
  ds_read_b64_tr_b16 v[42:43], v15 offset:8704
  ds_read_b64_tr_b16 v[44:45], v16 offset:0
  ds_read_b64_tr_b16 v[46:47], v16 offset:512
  ds_read_b64_tr_b16 v[48:49], v16 offset:8192
  ds_read_b64_tr_b16 v[50:51], v16 offset:8704
  s_waitcnt vmcnt(18) lgkmcnt(0)
  s_barrier
  s_lshl_b32 s54, s52, 12
  s_add_u32 s54, s54, 65536
  v_add_u32 v7, s54, v76
  ds_write_b128 v7, v[36:39] offset:0
  ds_write_b128 v7, v[40:43] offset:1024
  ds_write_b128 v7, v[44:47] offset:2048
  ds_write_b128 v7, v[48:51] offset:3072
  v_lshrrev_b32 v20, 2, v76
  buffer_load_dword v21, v20, s[12:15], 0 offen sc1
  v_add_u32 v15, 81920, v11
  v_add_u32 v16, 81920, v12
  ds_read_b64_tr_b16 v[52:53], v15 offset:0
  ds_read_b64_tr_b16 v[54:55], v15 offset:512
  ds_read_b64_tr_b16 v[56:57], v15 offset:8192
  ds_read_b64_tr_b16 v[58:59], v15 offset:8704
  ds_read_b64_tr_b16 v[60:61], v16 offset:0
  ds_read_b64_tr_b16 v[62:63], v16 offset:512
  ds_read_b64_tr_b16 v[64:65], v16 offset:8192
  ds_read_b64_tr_b16 v[66:67], v16 offset:8704
  s_waitcnt vmcnt(15) lgkmcnt(0)
  s_barrier
  s_lshl_b32 s54, s52, 12
  s_add_u32 s54, s54, 81920
  v_add_u32 v7, s54, v76
  ds_write_b128 v7, v[52:55] offset:0
  ds_write_b128 v7, v[56:59] offset:1024
  ds_write_b128 v7, v[60:63] offset:2048
  ds_write_b128 v7, v[64:67] offset:3072
  v_add_u32 v15, 98304, v13
  s_waitcnt lgkmcnt(0)
  ds_read_b64_tr_b16 v[36:37], v15 offset:0
  ds_read_b64_tr_b16 v[38:39], v15 offset:1024
  ds_read_b64_tr_b16 v[40:41], v15 offset:2048
  ds_read_b64_tr_b16 v[42:43], v15 offset:3072
  ds_read_b64_tr_b16 v[44:45], v15 offset:4096
  ds_read_b64_tr_b16 v[46:47], v15 offset:5120
  ds_read_b64_tr_b16 v[48:49], v15 offset:6144
  ds_read_b64_tr_b16 v[50:51], v15 offset:7168
  ds_read_b64_tr_b16 v[52:53], v15 offset:8192
  ds_read_b64_tr_b16 v[54:55], v15 offset:9216
  ds_read_b64_tr_b16 v[56:57], v15 offset:10240
  ds_read_b64_tr_b16 v[58:59], v15 offset:11264
  ds_read_b64_tr_b16 v[60:61], v15 offset:12288
  ds_read_b64_tr_b16 v[62:63], v15 offset:13312
  ds_read_b64_tr_b16 v[64:65], v15 offset:14336
  ds_read_b64_tr_b16 v[66:67], v15 offset:15360
  s_waitcnt vmcnt(11) lgkmcnt(0)
  s_barrier
  s_and_b32 s54, s52, 1
  s_lshl_b32 s54, s54, 13
  s_add_u32 s54, s54, 98304
  v_add_u32 v7, s54, v76
  ds_write_b128 v7, v[36:39] offset:0
  ds_write_b128 v7, v[40:43] offset:1024
  ds_write_b128 v7, v[44:47] offset:2048
  ds_write_b128 v7, v[48:51] offset:3072
  ds_write_b128 v7, v[52:55] offset:4096
  ds_write_b128 v7, v[56:59] offset:5120
  ds_write_b128 v7, v[60:63] offset:6144
  ds_write_b128 v7, v[64:67] offset:7168
  v_add_u32 v15, 114688, v14
  ds_read_b64_tr_b16 v[52:53], v15 offset:0
  ds_read_b64_tr_b16 v[54:55], v15 offset:1024
  ds_read_b64_tr_b16 v[56:57], v15 offset:4096
  ds_read_b64_tr_b16 v[58:59], v15 offset:5120
  ds_read_b64_tr_b16 v[60:61], v15 offset:8192
  ds_read_b64_tr_b16 v[62:63], v15 offset:9216
  ds_read_b64_tr_b16 v[64:65], v15 offset:12288
  ds_read_b64_tr_b16 v[66:67], v15 offset:13312
  s_waitcnt vmcnt(7) lgkmcnt(0)
  s_barrier
  s_lshl_b32 s54, s52, 12
  s_add_u32 s54, s54, 114688
  v_add_u32 v7, s54, v76
  ds_write_b128 v7, v[52:55] offset:0
  ds_write_b128 v7, v[56:59] offset:1024
  ds_write_b128 v7, v[60:63] offset:2048
  ds_write_b128 v7, v[64:67] offset:3072
  v_add_u32 v15, 131072, v14
  ds_read_b64_tr_b16 v[36:37], v15 offset:0
  ds_read_b64_tr_b16 v[38:39], v15 offset:1024
  ds_read_b64_tr_b16 v[40:41], v15 offset:4096
  ds_read_b64_tr_b16 v[42:43], v15 offset:5120
  ds_read_b64_tr_b16 v[44:45], v15 offset:8192
  ds_read_b64_tr_b16 v[46:47], v15 offset:9216
  ds_read_b64_tr_b16 v[48:49], v15 offset:12288
  ds_read_b64_tr_b16 v[50:51], v15 offset:13312
  s_waitcnt vmcnt(3) lgkmcnt(0)
  s_barrier
  s_lshl_b32 s54, s52, 12
  s_add_u32 s54, s54, 131072
  v_add_u32 v7, s54, v76
  ds_write_b128 v7, v[36:39] offset:0
  ds_write_b128 v7, v[40:43] offset:1024
  ds_write_b128 v7, v[44:47] offset:2048
  ds_write_b128 v7, v[48:51] offset:3072
  v_add_u32 v15, 147456, v14
  ds_read_b64_tr_b16 v[52:53], v15 offset:0
  ds_read_b64_tr_b16 v[54:55], v15 offset:1024
  ds_read_b64_tr_b16 v[56:57], v15 offset:4096
  ds_read_b64_tr_b16 v[58:59], v15 offset:5120
  ds_read_b64_tr_b16 v[60:61], v15 offset:8192
  ds_read_b64_tr_b16 v[62:63], v15 offset:9216
  ds_read_b64_tr_b16 v[64:65], v15 offset:12288
  ds_read_b64_tr_b16 v[66:67], v15 offset:13312
  s_waitcnt vmcnt(0) lgkmcnt(0)
  s_barrier
  s_lshl_b32 s54, s52, 12
  s_add_u32 s54, s54, 147456
  v_add_u32 v7, s54, v76
  ds_write_b128 v7, v[52:55] offset:0
  ds_write_b128 v7, v[56:59] offset:1024
  ds_write_b128 v7, v[60:63] offset:2048
  ds_write_b128 v7, v[64:67] offset:3072
  s_waitcnt lgkmcnt(0)
  s_branch C_rd1
C_rd0:
  s_sleep 2
  buffer_load_dword v21, v20, s[12:15], 0 offen sc1
  s_waitcnt vmcnt(0)
C_rd1:
  v_and_b32 v22, 0xff, v21
  v_cmp_gt_u32 vcc, 7, v22
  v_readlane_b32 s56, v21, 0
  s_mov_b32 s3, 1
  s_add_u32 s67, s67, 1
  s_cmp_ge_u32 s67, 131072
  s_cbranch_scc1 C_rd2
  s_cmp_lg_u32 vcc_hi, 0
  s_cbranch_scc1 C_rd0
  s_mov_b32 s3, 0
  s_cmp_eq_u32 s56, -1
  s_cbranch_scc1 C_rd2
  s_mov_b32 s3, 1
  v_readlane_b32 s54, v21, 10
  v_readlane_b32 s55, v21, 0
  s_nop 0
  s_bcnt1_i32_b32 s55, s55
  s_add_u32 s54, s54, s55
  v_readlane_b32 s55, v21, 1
  s_nop 0
  s_bcnt1_i32_b32 s55, s55
  s_add_u32 s54, s54, s55
  v_readlane_b32 s55, v21, 2
  s_nop 0
  s_bcnt1_i32_b32 s55, s55
  s_add_u32 s54, s54, s55
  v_readlane_b32 s55, v21, 3
  s_nop 0
  s_bcnt1_i32_b32 s55, s55
  s_add_u32 s54, s54, s55
  v_readlane_b32 s55, v21, 4
  s_nop 0
  s_bcnt1_i32_b32 s55, s55
  s_add_u32 s54, s54, s55
  v_readlane_b32 s55, v21, 5
  s_nop 0
  s_bcnt1_i32_b32 s55, s55
  s_add_u32 s54, s54, s55
  v_readlane_b32 s55, v21, 6
  s_nop 0
  s_bcnt1_i32_b32 s55, s55
  s_add_u32 s54, s54, s55
  v_readlane_b32 s55, v21, 7
  s_nop 0
  s_bcnt1_i32_b32 s55, s55
  s_add_u32 s54, s54, s55
  s_cmp_lt_u32 s54, 256
  s_cbranch_scc1 C_rd0
C_rd2:
  s_lshl_b32 s54, s3, 2
  s_add_u32 s54, s54, s52
  s_cmp_eq_u32 s54, 1
  s_cbranch_scc1 L_w1
  s_cmp_eq_u32 s54, 2
  s_cbranch_scc1 L_w2
  s_cmp_eq_u32 s54, 3
  s_cbranch_scc1 L_w3
  s_cmp_eq_u32 s54, 4
  s_cbranch_scc1 L_w4
  s_cmp_eq_u32 s54, 5
  s_cbranch_scc1 L_w5
  s_cmp_eq_u32 s54, 6
  s_cbranch_scc1 L_w6
  s_cmp_eq_u32 s54, 7
  s_cbranch_scc1 L_w7
L_w0:
  v_mov_b64 v[20:21], 0
  v_mov_b64 v[22:23], 0
  v_mov_b64 v[24:25], 0
  v_mov_b64 v[26:27], 0
  v_mov_b64 v[28:29], 0
  v_mov_b64 v[30:31], 0
  v_mov_b64 v[32:33], 0
  v_mov_b64 v[34:35], 0
  s_mov_b32 s78, 0x3f803f80
  s_mov_b32 s79, s78
  s_mov_b32 s65, 360448
  s_mov_b32 m0, 16128
  s_lshl_b32 s71, s53, 2
  s_add_u32 s71, s71, 128
  s_movk_i32 s56, 0x1000
  v_lshlrev_b32 v73, 2, v76
  v_mov_b32 v72, 0
  s_mov_b64 s[16:17], s[8:9]
  s_mov_b32 s18, 268435456
  s_mov_b32 s19, 0x20000
  s_getpc_b64 s[20:21]
Cf0_pc:
  s_add_u32 s20, s20, (Cf0_last - Cf0_pc)
  s_addc_u32 s21, s21, 0
  v_mov_b32 v68, 14880
  buffer_load_dwordx4 v[52:55], v76, s[8:11], s59 offen offset:0 sc1
  buffer_load_dwordx4 v[56:59], v76, s[8:11], s59 offen offset:1024 sc1
  ds_read_b128 v[36:39], v76 offset:16384
  ds_read_b128 v[40:43], v76 offset:17408
  ds_read_b128 v[60:63], v76 offset:18432
  ds_read_b128 v[64:67], v76 offset:19456
  ds_read_b128 v[0:3], v76 offset:4608
  ds_read_b128 v[4:7], v76 offset:5632
  ds_read_b128 v[8:11], v76 offset:6656
  ds_read_b128 v[12:15], v76 offset:7680
  s_waitcnt lgkmcnt(0)
  s_cmp_eq_u32 s66, 1
  s_branch Cf0_top2
.p2align 6
Cf0_h2:
  s_cmp_eq_u32 s66, 62
  s_cselect_b64 s[16:17], s[20:21], s[16:17]
  s_cselect_b32 s18, (Cf0_done - Cf0_last), s18
  s_cselect_b32 s70, 0, s70
  s_cmp_eq_u32 s66, 63
  s_cselect_b32 s59, 268435456, s59
  s_cselect_b32 s58, 268435456, s58
  s_cmp_eq_u32 s66, 12
  s_cselect_b32 s56, s71, 0x1000
  ds_read_b32 v72, v76 offset:16128
  s_cmp_eq_u32 s66, 13
  s_cselect_b32 s54, 0x700, 0
  s_waitcnt lgkmcnt(0)
  v_readfirstlane_b32 s57, v72
  s_nop 0
  s_cmp_lt_u32 s57, s54
  s_cbranch_scc1 Cf0_kv3
Cf0_kvb:
  buffer_load_dwordx4 v[0:3], v76, s[8:11], s65 offen offset:0 sc1
  ds_read_b128 v[36:39], v76 offset:16384
  s_waitcnt lgkmcnt(0)
  v_mov_b64 v[20:21], 0
  v_mov_b64 v[22:23], 0
  v_mov_b64 v[24:25], 0
  v_mov_b64 v[26:27], 0
  v_mov_b32 v68, 14880
  buffer_load_dwordx4 v[0:3], v76, s[8:11], s65 offen offset:0 sc1
  ds_read_b128 v[40:43], v76 offset:17408
  s_waitcnt lgkmcnt(0)
  v_mov_b64 v[28:29], 0
  v_mov_b64 v[30:31], 0
  v_mov_b64 v[32:33], 0
  v_mov_b64 v[34:35], 0
  v_lshlrev_b32 v73, 2, v76
  buffer_load_dwordx4 v[0:3], v76, s[8:11], s65 offen offset:0 sc1
  ds_read_b128 v[60:63], v76 offset:18432
  s_waitcnt lgkmcnt(0)
  buffer_load_dwordx4 v[52:55], v76, s[8:11], s59 offen offset:0 sc1
  buffer_load_dwordx4 v[56:59], v76, s[8:11], s59 offen offset:1024 sc1
  s_waitcnt vmcnt(4)
  v_max3_u32 v72, v0, v1, v2
  v_max_u32 v72, v72, v3
  ds_write_b128 v76, v[0:3] offset:4608
  v_cmp_eq_u32 vcc, -1, v72
  s_cbranch_vccnz Cf0_h2r
Cf0_h2w:
  s_cmp_eq_u32 s66, 63
  s_waitcnt lgkmcnt(0)
  s_barrier
  ds_read_b128 v[8:11], v76 offset:6656
  buffer_load_dwordx4 v76, s[8:11], s85 offen offset:0 sc1 lds
Cf0_top2:
  v_smfmac_f32_16x16x64_bf16 v[20:23], v[0:3], v[80:87], v74
  s_cbranch_scc1 Cf0_last
  v_smfmac_f32_16x16x64_bf16 v[28:31], v[0:3], v[36:43], v74
  buffer_load_dwordx4 v[44:47], v76, s[8:11], s58 offen offset:0 sc1
  s_mov_b32 m0, 16128
  v_smfmac_f32_16x16x64_bf16 v[24:27], v[0:3], v[88:95], v74
  buffer_load_dwordx4 v[48:51], v76, s[8:11], s58 offen offset:1024 sc1
  v_smfmac_f32_16x16x64_bf16 v[32:35], v[0:3], v[60:67], v74
  ds_read_b128 v[4:7], v76 offset:5632
  s_waitcnt lgkmcnt(1)
  v_smfmac_f32_16x16x64_bf16 v[20:23], v[8:11], v[112:119], v74
  ds_read_b128 v[12:15], v76 offset:7680
  v_smfmac_f32_16x16x64_bf16 v[24:27], v[8:11], v[120:127], v74
  ds_read_b128 v[36:39], v76 offset:32768
  v_smfmac_f32_16x16x64_bf16 v[28:31], v[8:11], v[208:215], v74
  buffer_store_dwordx4 v[16:19], v76, s[8:11], s68 offen sc1
  ds_read_b128 v[40:43], v76 offset:33792
  v_smfmac_f32_16x16x64_bf16 v[32:35], v[8:11], v[216:223], v74
  ds_read_b128 v[60:63], v76 offset:34816
  s_waitcnt lgkmcnt(4)
  v_smfmac_f32_16x16x64_bf16 v[20:23], v[4:7], v[96:103], v74
  ds_read_b128 v[64:67], v76 offset:35840
  v_smfmac_f32_16x16x64_bf16 v[24:27], v[4:7], v[104:111], v74
  buffer_load_dword v73, s[16:19], s70 offen lds
  s_waitcnt vmcnt(5)
  s_waitcnt lgkmcnt(4)
  v_smfmac_f32_16x16x64_bf16 v[20:23], v[12:15], v[128:135], v74
  s_barrier
  s_waitcnt lgkmcnt(2)
  v_smfmac_f32_16x16x64_bf16 v[28:31], v[4:7], v[36:43], v74
  ds_read_b128 v[0:3], v76 offset:8704
  v_smfmac_f32_16x16x64_bf16 v[24:27], v[12:15], v[136:143], v74
  ds_read_b128 v[36:39], v76 offset:49152
  s_waitcnt lgkmcnt(2)
  v_smfmac_f32_16x16x64_bf16 v[32:35], v[4:7], v[60:67], v74
  ds_read_b128 v[40:43], v76 offset:50176
  v_smfmac_f32_16x16x64_bf16 v[28:31], v[12:15], v[224:231], v74
  ds_read_b128 v[60:63], v76 offset:51200
  v_smfmac_f32_16x16x64_bf16 v[32:35], v[12:15], v[232:239], v74
  ds_read_b128 v[64:67], v76 offset:52224
  s_waitcnt lgkmcnt(4)
  v_smfmac_f32_16x16x64_bf16 v[20:23], v[0:3], v[144:151], v74
  s_waitcnt vmcnt(4)
  ds_read_b128 v[8:11], v76 offset:9728
  s_waitcnt lgkmcnt(3)
  v_smfmac_f32_16x16x64_bf16 v[28:31], v[0:3], v[36:43], v74
  s_barrier
  ds_read_b128 v[4:7], v76 offset:11776
  v_smfmac_f32_16x16x64_bf16 v[24:27], v[0:3], v[152:159], v74
  ds_read_b128 v[36:39], v75 offset:0
  ds_read_b128 v[40:43], v75 offset:1024
  s_waitcnt lgkmcnt(4)
  v_smfmac_f32_16x16x64_bf16 v[32:35], v[0:3], v[60:67], v74
  ds_read_b128 v[16:19], v76 offset:10752
  s_waitcnt lgkmcnt(4)
  v_smfmac_f32_16x16x64_bf16 v[20:23], v[8:11], v[160:167], v74
  ds_read_b128 v[12:15], v76 offset:12800
  v_smfmac_f32_16x16x64_bf16 v[24:27], v[8:11], v[168:175], v74
  ds_read_b128 v[60:63], v75 offset:2048
  ds_read_b128 v[64:67], v75 offset:3072
  s_waitcnt lgkmcnt(6)
  v_smfmac_f32_16x16x64_bf16 v[20:23], v[4:7], v[176:183], v74
  s_waitcnt lgkmcnt(3)
  v_smfmac_f32_16x16x64_bf16 v[20:23], v[16:19], v[36:43], v74
  ds_read_b128 v[36:39], v75 offset:16384
  s_waitcnt lgkmcnt(3)
  v_smfmac_f32_16x16x64_bf16 v[20:23], v[12:15], v[192:199], v74
  ds_read_b128 v[40:43], v75 offset:17408
  s_waitcnt lgkmcnt(2)
  v_smfmac_f32_16x16x64_bf16 v[24:27], v[16:19], v[60:67], v74
  ds_read_b128 v[60:63], v75 offset:18432
  v_smfmac_f32_16x16x64_bf16 v[24:27], v[4:7], v[184:191], v74
  ds_read_b128 v[64:67], v75 offset:19456
  v_add_f32 v20, v20, v22
  v_smfmac_f32_16x16x64_bf16 v[24:27], v[12:15], v[200:207], v74
  buffer_load_dword off, s[12:15], s56 sc1 lds
  v_add_f32 v21, v21, v23
  v_smfmac_f32_16x16x64_bf16 v[28:31], v[16:19], v[240:247], v74
  s_waitcnt lgkmcnt(2)
  v_mov_b64 v[70:71], s[78:79]
  v_smfmac_f32_16x16x64_bf16 v[28:31], v[8:11], v[36:43], v74
  ds_read_b128 v[36:39], v68
  v_add_f32 v24, v24, v26
  v_smfmac_f32_16x16x64_bf16 v[28:31], v[4:7], a[0:7], v74
  ds_read_b128 v[40:43], v68
  v_cvt_pk_bf16_f32 v22, v20, v24
  v_smfmac_f32_16x16x64_bf16 v[28:31], v[12:15], a[16:23], v74
  ds_write_b32 v79, v22 offset:0
  s_waitcnt lgkmcnt(3)
  v_add_f32 v25, v25, v27
  v_cvt_pk_bf16_f32 v23, v21, v25
  v_smfmac_f32_16x16x64_bf16 v[32:35], v[8:11], v[60:67], v74
  ds_write_b32 v79, v23 offset:576
  v_cmp_u_f32 vcc, v20, v21
  v_smfmac_f32_16x16x64_bf16 v[32:35], v[16:19], v[248:255], v74
  v_add_f32 v28, v28, v30
  v_smfmac_f32_16x16x64_bf16 v[32:35], v[4:7], a[8:15], v74
  v_add_f32 v29, v29, v31
  v_smfmac_f32_16x16x64_bf16 v[32:35], v[12:15], a[24:31], v74
  s_cbranch_vccnz Cf0_rec
Cf0_recok:
  s_waitcnt lgkmcnt(3)
  v_smfmac_f32_16x16x64_bf16 v[36:39], v[16:19], a[128:135], v74
  s_waitcnt lgkmcnt(0)
  s_barrier
  ds_read_b128 v[60:63], v77
  v_smfmac_f32_16x16x64_bf16 v[40:43], v[16:19], a[136:143], v74
  ds_read_b128 v[64:67], v77 offset:128
  v_add_f32 v32, v32, v34
  v_cvt_pk_bf16_f32 v30, v28, v32
  v_smfmac_f32_16x16x64_bf16 v[36:39], v[0:3], a[96:103], v74
  ds_write_b32 v79, v30 offset:256
  v_add_f32 v33, v33, v35
  v_cvt_pk_bf16_f32 v31, v29, v33
  v_smfmac_f32_16x16x64_bf16 v[40:43], v[0:3], a[104:111], v74
  ds_write_b32 v79, v31 offset:832
  v_xor_b32 v75, 0x8000, v75
  v_smfmac_f32_16x16x64_bf16 v[36:39], v[4:7], a[144:151], v74
  ds_read_b128 v[0:3], v76 offset:4608
  v_mov_b32 v29, 0
  v_smfmac_f32_16x16x64_bf16 v[40:43], v[4:7], a[152:159], v74
  s_waitcnt vmcnt(3) lgkmcnt(3)
  v_mov_b32 v30, 0
  v_mfma_f32_16x16x32_bf16 v[44:47], v[44:47], v[60:63], 0
  ds_read_b128 v[4:7], v76 offset:5632
  s_waitcnt lgkmcnt(2)
  v_mfma_f32_16x16x32_bf16 v[44:47], v[48:51], v[64:67], v[44:47]
  s_barrier
  v_smfmac_f32_16x16x64_bf16 v[36:39], v[8:11], a[112:119], v74
  ds_read_b128 v[20:23], v77 offset:256
  ds_read_b128 v[24:27], v77 offset:384
  v_smfmac_f32_16x16x64_bf16 v[40:43], v[8:11], a[120:127], v74
  ds_read_b128 v[8:11], v76 offset:6656
  v_add_f32_dpp v72, v46, v44 quad_perm:[2,3,0,1] row_mask:0xf bank_mask:0xf
  v_add_f32_dpp v73, v47, v45 quad_perm:[2,3,0,1] row_mask:0xf bank_mask:0xf
  v_smfmac_f32_16x16x64_bf16 v[36:39], v[12:15], a[160:167], v74
  s_waitcnt lgkmcnt(4)
  v_exp_f32_dpp v72, v72 quad_perm:[0,1,0,1] row_mask:0xf bank_mask:0xf
  v_smfmac_f32_16x16x64_bf16 v[40:43], v[12:15], a[168:175], v74
  ds_read_b128 v[12:15], v76 offset:7680
  v_exp_f32_dpp v73, v73 quad_perm:[0,1,0,1] row_mask:0xf bank_mask:0xf
  v_smfmac_f32_16x16x64_bf16 v[36:39], v[0:3], a[32:39], v74
  s_waitcnt lgkmcnt(2)
  v_cvt_pk_bf16_f32 v72, v72, v73
  v_mfma_f32_16x16x32_bf16 v[20:23], v[20:23], v[60:63], 0
  ds_write_b32 v78, v72 offset:512
  v_mov_b64 v[16:17], 0
  v_mfma_f32_16x16x32_bf16 v[20:23], v[24:27], v[64:67], v[20:23]
  ds_read_b128 v[44:47], v75 offset:16384
  v_mov_b64 v[18:19], 0
  v_smfmac_f32_16x16x64_bf16 v[40:43], v[0:3], a[40:47], v74
  ds_read_b128 v[48:51], v75 offset:17408
  v_mov_b64 v[68:69], s[78:79]
  v_smfmac_f32_16x16x64_bf16 v[36:39], v[4:7], a[48:55], v74
  s_waitcnt lgkmcnt(4)
  v_add_f32_dpp v24, v22, v20 quad_perm:[2,3,0,1] row_mask:0xf bank_mask:0xf
  v_add_f32_dpp v25, v23, v21 quad_perm:[2,3,0,1] row_mask:0xf bank_mask:0xf
  v_smfmac_f32_16x16x64_bf16 v[36:39], v[8:11], a[64:71], v74
  s_waitcnt lgkmcnt(2)
  s_barrier
  ds_read_b128 v[32:35], v78 offset:512
  v_smfmac_f32_16x16x64_bf16 v[36:39], v[12:15], a[80:87], v74
  ds_read_b128 v[60:63], v75 offset:18432
  v_mul_f32 v24, s69, v24
  v_smfmac_f32_16x16x64_bf16 v[40:43], v[4:7], a[56:63], v74
  ds_read_b128 v[64:67], v75 offset:19456
  v_mul_f32 v25, s69, v25
  v_smfmac_f32_16x16x64_bf16 v[40:43], v[8:11], a[72:79], v74
  v_exp_f32_dpp v24, v24 quad_perm:[0,1,0,1] row_mask:0xf bank_mask:0xf
  v_smfmac_f32_16x16x64_bf16 v[40:43], v[12:15], a[88:95], v74
  s_waitcnt lgkmcnt(2)
  v_exp_f32_dpp v25, v25 quad_perm:[0,1,0,1] row_mask:0xf bank_mask:0xf
  v_mfma_f32_16x16x32_bf16 v[8:11], v[32:35], v[68:71], 0
  v_add_f32 v36, v36, v38
  v_add_f32 v37, v37, v39
  v_mfma_f32_16x16x32_bf16 v[0:3], v[32:35], v[52:55], 0
  v_add_f32 v40, v40, v42
  v_add_f32 v41, v41, v43
  v_mfma_f32_16x16x32_bf16 v[4:7], v[32:35], v[56:59], 0
  v_cvt_pk_bf16_f32 v28, v24, v25
  v_cvt_pk_bf16_f32 v72, v36, v37
  v_cvt_pk_bf16_f32 v73, v40, v41
  v_mfma_f32_16x16x16_bf16 v[8:11], v[28:29], v[68:69], v[8:11]
  v_cvt_pk_bf16_f32 v31, v24, v25
  v_mov_b64 v[20:21], 0
  v_mfma_f32_16x16x16_bf16 v[0:3], v[28:29], v[72:73], v[0:3]
  ds_read_b128 v[68:71], v76 offset:13824
  v_mov_b64 v[22:23], 0
  v_mfma_f32_16x16x16_bf16 v[4:7], v[30:31], v[72:73], v[4:7]
  v_rcp_f32 v10, v8
  v_rcp_f32 v11, v9
  v_mul_f32 v0, v10, v0
  v_mul_f32 v1, v11, v1
  s_nop 0
  v_mul_f32 v4, v10, v4
  v_mul_f32 v5, v11, v5
  v_cvt_pk_bf16_f32 v2, v0, v4
  ds_write_b32 v79, v2 offset:8704
  v_cvt_pk_bf16_f32 v3, v1, v5
  ds_write_b32 v79, v3 offset:9280
  v_max3_f32 v8, v8, v9, v10
  v_max_f32 v8, v8, v11
  v_cmp_le_f32 vcc, 1317011456, v8
  v_mov_b64 v[24:25], 0
  v_mov_b64 v[26:27], 0
  s_cbranch_vccnz Cf0_mx
Cf0_mxok:
  s_waitcnt lgkmcnt(0)
  s_barrier
  ds_read_b128 v[0:3], v78 offset:8704
  ds_read_b128 v[4:7], v78 offset:8768
  ds_read_b128 v[8:11], v78 offset:8832
  ds_read_b128 v[12:15], v78 offset:8896
  s_waitcnt lgkmcnt(3)
  v_smfmac_f32_16x16x64_bf16 v[16:19], v[0:3], v[44:51], v74
  ds_read_b128 v[52:55], v75 offset:32768
  s_waitcnt lgkmcnt(3)
  v_smfmac_f32_16x16x64_bf16 v[16:19], v[4:7], v[60:67], v74
  ds_read_b128 v[56:59], v75 offset:33792
  s_waitcnt lgkmcnt(3)
  v_smfmac_f32_16x16x64_bf16 v[16:19], v[8:11], a[176:183], v74
  ds_read_b128 v[36:39], v75 offset:34816
  s_waitcnt lgkmcnt(3)
  v_smfmac_f32_16x16x64_bf16 v[16:19], v[12:15], a[184:191], v74
  ds_read_b128 v[40:43], v75 offset:35840
  ds_read_b128 v[44:47], v75 offset:49152
  v_smfmac_f32_16x16x64_bf16 v[20:23], v[0:3], a[192:199], v74
  ds_read_b128 v[48:51], v75 offset:50176
  ds_read_b128 v[60:63], v75 offset:51200
  v_smfmac_f32_16x16x64_bf16 v[20:23], v[4:7], a[200:207], v74
  ds_read_b128 v[64:67], v75 offset:52224
  s_waitcnt lgkmcnt(6)
  v_cvt_pk_bf16_f32 v16, v16, v17
  v_cvt_pk_bf16_f32 v17, v18, v19
  v_bfi_b32 v16, 1, s72, v16
  v_smfmac_f32_16x16x64_bf16 v[20:23], v[8:11], v[52:59], v74
  buffer_store_dwordx2 v[16:17], v68, s[8:11], s73 offen
  s_waitcnt lgkmcnt(4)
  v_smfmac_f32_16x16x64_bf16 v[20:23], v[12:15], v[36:43], v74
  v_mov_b64 v[32:33], 0
  v_smfmac_f32_16x16x64_bf16 v[24:27], v[0:3], a[208:215], v74
  v_mov_b64 v[34:35], 0
  v_smfmac_f32_16x16x64_bf16 v[24:27], v[4:7], a[216:223], v74
  s_waitcnt lgkmcnt(2)
  v_cvt_pk_bf16_f32 v20, v20, v21
  v_cvt_pk_bf16_f32 v21, v22, v23
  v_bfi_b32 v20, 1, s72, v20
  v_smfmac_f32_16x16x64_bf16 v[24:27], v[8:11], v[44:51], v74
  buffer_store_dwordx2 v[20:21], v68, s[8:11], s74 offen
  s_waitcnt lgkmcnt(0)
  v_smfmac_f32_16x16x64_bf16 v[24:27], v[12:15], v[60:67], v74
  v_smfmac_f32_16x16x64_bf16 v[32:35], v[0:3], a[224:231], v74
  v_smfmac_f32_16x16x64_bf16 v[32:35], v[4:7], a[232:239], v74
  v_cvt_pk_bf16_f32 v24, v24, v25
  v_cvt_pk_bf16_f32 v25, v26, v27
  v_bfi_b32 v24, 1, s72, v24
  v_smfmac_f32_16x16x64_bf16 v[32:35], v[8:11], a[240:247], v74
  buffer_store_dwordx2 v[24:25], v68, s[8:11], s75 offen
  v_smfmac_f32_16x16x64_bf16 v[32:35], v[12:15], a[248:255], v74
  v_mov_b64 v[18:19], v[72:73]
  s_nop 4
  v_cvt_pk_bf16_f32 v32, v32, v33
  v_cvt_pk_bf16_f32 v33, v34, v35
  v_bfi_b32 v32, 1, s72, v32
  buffer_store_dwordx2 v[32:33], v68, s[8:11], s76 offen
  ds_read_b128 v[0:3], v76 offset:14848
  s_waitcnt lgkmcnt(0)
  ds_read_b64 v[16:17], v77 offset:256
  s_waitcnt lgkmcnt(0)
  ds_read_b128 v[64:67], v76 offset:19456
  s_waitcnt lgkmcnt(0)
  v_xor_b32 v75, 0x8000, v75
  buffer_load_dwordx4 v[52:55], v76, s[8:11], s60 offen offset:0 sc1
  buffer_load_dwordx4 v[56:59], v76, s[8:11], s60 offen offset:1024 sc1
  s_add_u32 s66, s66, 1
  s_xor_b32 s64, s64, 16384
  s_xor_b32 s65, s65, 16384
  s_add_u32 s58, s58, 655360
  s_add_u32 s59, s59, 655360
  s_add_u32 s70, s70, 655360
  s_add_u32 s68, s68, 655360
  s_mov_b32 m0, 10752
  s_add_u32 s85, s65, 6144
  s_waitcnt lgkmcnt(0)
  s_waitcnt vmcnt(1)
  v_mfma_f32_16x16x32_bf16 v[4:7], v[0:3], v[52:55], 0
  v_bitop3_b32 v72, v52, v54, s72 bitop3:0x7e
  s_waitcnt vmcnt(0)
  v_mfma_f32_16x16x32_bf16 v[4:7], v[0:3], v[56:59], v[4:7]
  v_bitop3_b32 v73, v56, v58, s72 bitop3:0x7e
  v_bitop3_b32 v72, v72, v73, 1 bitop3:0xa8
  v_cmp_ne_u32 vcc, 0, v72
  s_nop 0
  s_cmp_eq_u64 vcc, 0
  s_cselect_b32 s54, s62, 268435456
  s_nop 0
  v_add_f32_dpp v4, v4, v4 row_ror:4 row_mask:0xf bank_mask:0xf
  v_add_f32_dpp v5, v5, v5 row_ror:4 row_mask:0xf bank_mask:0xf
  s_nop 0
  v_add_f32_dpp v4, v4, v4 row_ror:8 row_mask:0xf bank_mask:0xf
  v_add_f32_dpp v5, v5, v5 row_ror:8 row_mask:0xf bank_mask:0xf
  v_cvt_pk_bf16_f32 v4, v4, v5
  buffer_store_dword v4, v69, s[8:11], s54 offen
  s_cbranch_vccnz Cf0_h1r
  s_xor_b32 s62, s62, 16384
  buffer_store_dword v71, v69, s[8:11], s62 offen
  s_xor_b32 s72, s72, 1
  s_branch Cf0_h2
Cf0_h1r:
  s_mov_b64 exec, vcc
  buffer_load_dwordx4 v[52:55], v76, s[8:11], s60 offen offset:0 sc1
  buffer_load_dwordx4 v[56:59], v76, s[8:11], s60 offen offset:1024 sc1
  s_mov_b64 exec, -1
  s_add_u32 s67, s67, 1
  s_waitcnt vmcnt(1)
  v_mfma_f32_16x16x32_bf16 v[4:7], v[0:3], v[52:55], 0
  v_bitop3_b32 v72, v52, v54, s72 bitop3:0x7e
  s_waitcnt vmcnt(0)
  v_mfma_f32_16x16x32_bf16 v[4:7], v[0:3], v[56:59], v[4:7]
  v_bitop3_b32 v73, v56, v58, s72 bitop3:0x7e
  v_bitop3_b32 v72, v72, v73, 1 bitop3:0xa8
  v_cmp_ne_u32 vcc, 0, v72
  s_cbranch_vccz Cf0_h1p
Cf0_h1s:
  s_mov_b64 exec, vcc
  buffer_load_dwordx4 v[52:55], v76, s[8:11], s60 offen offset:0 sc1
  buffer_load_dwordx4 v[56:59], v76, s[8:11], s60 offen offset:1024 sc1
  s_mov_b64 exec, -1
  s_add_u32 s67, s67, 1
  s_waitcnt vmcnt(1)
  v_mfma_f32_16x16x32_bf16 v[4:7], v[0:3], v[52:55], 0
  v_bitop3_b32 v72, v52, v54, s72 bitop3:0x7e
  s_waitcnt vmcnt(0)
  v_mfma_f32_16x16x32_bf16 v[4:7], v[0:3], v[56:59], v[4:7]
  v_bitop3_b32 v73, v56, v58, s72 bitop3:0x7e
  v_bitop3_b32 v72, v72, v73, 1 bitop3:0xa8
  v_cmp_ne_u32 vcc, 0, v72
  s_cbranch_vccz Cf0_h1p
  s_cmp_lt_u32 s67, 131072
  s_cbranch_scc1 Cf0_h1s
Cf0_h1p:
  s_nop 2
  v_add_f32_dpp v4, v4, v4 row_ror:4 row_mask:0xf bank_mask:0xf
  v_add_f32_dpp v5, v5, v5 row_ror:4 row_mask:0xf bank_mask:0xf
  s_nop 0
  v_add_f32_dpp v4, v4, v4 row_ror:8 row_mask:0xf bank_mask:0xf
  v_add_f32_dpp v5, v5, v5 row_ror:8 row_mask:0xf bank_mask:0xf
  v_cvt_pk_bf16_f32 v4, v4, v5
  buffer_store_dword v4, v69, s[8:11], s62 offen
  s_xor_b32 s62, s62, 16384
  buffer_store_dword v71, v69, s[8:11], s62 offen
  s_xor_b32 s72, s72, 1
  s_branch Cf0_h2
Cf0_h2r:
  s_mov_b64 exec, vcc
  buffer_load_dwordx4 v[0:3], v76, s[8:11], s65 offen offset:0 sc1
  s_mov_b64 exec, -1
  s_add_u32 s67, s67, 1
  s_waitcnt vmcnt(4)
  v_max3_u32 v72, v0, v1, v2
  v_max_u32 v72, v72, v3
  ds_write_b128 v76, v[0:3] offset:4608
  v_cmp_eq_u32 vcc, -1, v72
  s_cbranch_vccz Cf0_h2w
  s_mov_b64 exec, vcc
  buffer_load_dwordx4 v[0:3], v76, s[8:11], s65 offen offset:0 sc1
  s_mov_b64 exec, -1
  s_add_u32 s67, s67, 1
  s_waitcnt vmcnt(4)
  v_max3_u32 v72, v0, v1, v2
  v_max_u32 v72, v72, v3
  ds_write_b128 v76, v[0:3] offset:4608
  v_cmp_eq_u32 vcc, -1, v72
  s_cbranch_vccz Cf0_h2w
Cf0_h2s:
  s_mov_b64 exec, vcc
  buffer_load_dwordx4 v[0:3], v76, s[8:11], s65 offen offset:0 sc1
  s_mov_b64 exec, -1
  s_add_u32 s67, s67, 1
  s_waitcnt vmcnt(2)
  v_max3_u32 v72, v0, v1, v2
  v_max_u32 v72, v72, v3
  ds_write_b128 v76, v[0:3] offset:4608
  v_cmp_eq_u32 vcc, -1, v72
  s_cbranch_vccz Cf0_h2w
  s_mov_b64 exec, vcc
  buffer_load_dwordx4 v[0:3], v76, s[8:11], s65 offen offset:0 sc1
  s_mov_b64 exec, -1
  s_add_u32 s67, s67, 1
  s_waitcnt vmcnt(2)
  v_max3_u32 v72, v0, v1, v2
  v_max_u32 v72, v72, v3
  ds_write_b128 v76, v[0:3] offset:4608
  v_cmp_eq_u32 vcc, -1, v72
  s_cbranch_vccz Cf0_h2w
  s_mov_b64 exec, vcc
  buffer_load_dwordx4 v[0:3], v76, s[8:11], s65 offen offset:0 sc1
  s_mov_b64 exec, -1
  s_add_u32 s67, s67, 1
  s_waitcnt vmcnt(2)
  v_max3_u32 v72, v0, v1, v2
  v_max_u32 v72, v72, v3
  ds_write_b128 v76, v[0:3] offset:4608
  v_cmp_eq_u32 vcc, -1, v72
  s_cbranch_vccz Cf0_h2w
  s_cmp_lt_u32 s67, 131072
  s_cbranch_scc1 Cf0_h2s
  s_branch Cf0_h2w
Cf0_rec:
  s_nop 7
  s_waitcnt vmcnt(0) lgkmcnt(0)
  v_max3_u32 v72, v0, v1, v2
  v_max3_u32 v72, v72, v3, v4
  v_max3_u32 v72, v72, v5, v6
  v_max3_u32 v72, v72, v7, v8
  v_max3_u32 v72, v72, v9, v10
  v_max3_u32 v72, v72, v11, v12
  v_max3_u32 v72, v72, v13, v14
  v_max3_u32 v72, v72, v15, v16
  v_max3_u32 v72, v72, v17, v18
  v_max_u32 v72, v72, v19
  v_cmp_eq_u32 vcc, -1, v72
  s_cbranch_vccz Cf0_recok
  s_barrier
  v_mov_b64 v[20:21], 0
  v_mov_b64 v[22:23], 0
  v_mov_b64 v[24:25], 0
  v_mov_b64 v[26:27], 0
  v_mov_b64 v[28:29], 0
  v_mov_b64 v[30:31], 0
  v_mov_b64 v[32:33], 0
  v_mov_b64 v[34:35], 0
  s_waitcnt lgkmcnt(0)
  s_barrier
  ds_read_b128 v[0:3], v76 offset:4608
  s_waitcnt lgkmcnt(0)
  v_smfmac_f32_16x16x64_bf16 v[20:23], v[0:3], v[80:87], v74
  v_smfmac_f32_16x16x64_bf16 v[24:27], v[0:3], v[88:95], v74
  ds_read_b128 v[60:63], v76 offset:16384
  ds_read_b128 v[64:67], v76 offset:17408
  s_waitcnt lgkmcnt(0)
  v_smfmac_f32_16x16x64_bf16 v[28:31], v[0:3], v[60:67], v74
  ds_read_b128 v[60:63], v76 offset:18432
  ds_read_b128 v[64:67], v76 offset:19456
  s_waitcnt lgkmcnt(0)
  v_smfmac_f32_16x16x64_bf16 v[32:35], v[0:3], v[60:67], v74
  ds_read_b128 v[4:7], v76 offset:5632
  s_waitcnt lgkmcnt(0)
  v_smfmac_f32_16x16x64_bf16 v[20:23], v[4:7], v[96:103], v74
  v_smfmac_f32_16x16x64_bf16 v[24:27], v[4:7], v[104:111], v74
  ds_read_b128 v[60:63], v76 offset:32768
  ds_read_b128 v[64:67], v76 offset:33792
  s_waitcnt lgkmcnt(0)
  v_smfmac_f32_16x16x64_bf16 v[28:31], v[4:7], v[60:67], v74
  ds_read_b128 v[60:63], v76 offset:34816
  ds_read_b128 v[64:67], v76 offset:35840
  s_waitcnt lgkmcnt(0)
  v_smfmac_f32_16x16x64_bf16 v[32:35], v[4:7], v[60:67], v74
  ds_read_b128 v[8:11], v76 offset:6656
  s_waitcnt lgkmcnt(0)
  v_smfmac_f32_16x16x64_bf16 v[20:23], v[8:11], v[112:119], v74
  v_smfmac_f32_16x16x64_bf16 v[24:27], v[8:11], v[120:127], v74
  v_smfmac_f32_16x16x64_bf16 v[28:31], v[8:11], v[208:215], v74
  v_smfmac_f32_16x16x64_bf16 v[32:35], v[8:11], v[216:223], v74
  ds_read_b128 v[12:15], v76 offset:7680
  s_waitcnt lgkmcnt(0)
  v_smfmac_f32_16x16x64_bf16 v[20:23], v[12:15], v[128:135], v74
  v_smfmac_f32_16x16x64_bf16 v[24:27], v[12:15], v[136:143], v74
  v_smfmac_f32_16x16x64_bf16 v[28:31], v[12:15], v[224:231], v74
  v_smfmac_f32_16x16x64_bf16 v[32:35], v[12:15], v[232:239], v74
  ds_read_b128 v[0:3], v76 offset:8704
  s_waitcnt lgkmcnt(0)
  v_smfmac_f32_16x16x64_bf16 v[20:23], v[0:3], v[144:151], v74
  v_smfmac_f32_16x16x64_bf16 v[24:27], v[0:3], v[152:159], v74
  ds_read_b128 v[60:63], v76 offset:49152
  ds_read_b128 v[64:67], v76 offset:50176
  s_waitcnt lgkmcnt(0)
  v_smfmac_f32_16x16x64_bf16 v[28:31], v[0:3], v[60:67], v74
  ds_read_b128 v[60:63], v76 offset:51200
  ds_read_b128 v[64:67], v76 offset:52224
  s_waitcnt lgkmcnt(0)
  v_smfmac_f32_16x16x64_bf16 v[32:35], v[0:3], v[60:67], v74
  ds_read_b128 v[8:11], v76 offset:9728
  s_waitcnt lgkmcnt(0)
  v_smfmac_f32_16x16x64_bf16 v[20:23], v[8:11], v[160:167], v74
  v_smfmac_f32_16x16x64_bf16 v[24:27], v[8:11], v[168:175], v74
  ds_read_b128 v[60:63], v75 offset:16384
  ds_read_b128 v[64:67], v75 offset:17408
  s_waitcnt lgkmcnt(0)
  v_smfmac_f32_16x16x64_bf16 v[28:31], v[8:11], v[60:67], v74
  ds_read_b128 v[60:63], v75 offset:18432
  ds_read_b128 v[64:67], v75 offset:19456
  s_waitcnt lgkmcnt(0)
  v_smfmac_f32_16x16x64_bf16 v[32:35], v[8:11], v[60:67], v74
  ds_read_b128 v[16:19], v76 offset:10752
  ds_read_b128 v[60:63], v75 offset:0
  ds_read_b128 v[64:67], v75 offset:1024
  s_waitcnt lgkmcnt(0)
  v_smfmac_f32_16x16x64_bf16 v[20:23], v[16:19], v[60:67], v74
  ds_read_b128 v[60:63], v75 offset:2048
  ds_read_b128 v[64:67], v75 offset:3072
  s_waitcnt lgkmcnt(0)
  v_smfmac_f32_16x16x64_bf16 v[24:27], v[16:19], v[60:67], v74
  v_smfmac_f32_16x16x64_bf16 v[28:31], v[16:19], v[240:247], v74
  v_smfmac_f32_16x16x64_bf16 v[32:35], v[16:19], v[248:255], v74
  ds_read_b128 v[4:7], v76 offset:11776
  s_waitcnt lgkmcnt(0)
  v_smfmac_f32_16x16x64_bf16 v[20:23], v[4:7], v[176:183], v74
  v_smfmac_f32_16x16x64_bf16 v[24:27], v[4:7], v[184:191], v74
  v_smfmac_f32_16x16x64_bf16 v[28:31], v[4:7], a[0:7], v74
  v_smfmac_f32_16x16x64_bf16 v[32:35], v[4:7], a[8:15], v74
  ds_read_b128 v[12:15], v76 offset:12800
  s_waitcnt lgkmcnt(0)
  v_smfmac_f32_16x16x64_bf16 v[20:23], v[12:15], v[192:199], v74
  v_smfmac_f32_16x16x64_bf16 v[24:27], v[12:15], v[200:207], v74
  v_smfmac_f32_16x16x64_bf16 v[28:31], v[12:15], a[16:23], v74
  v_smfmac_f32_16x16x64_bf16 v[32:35], v[12:15], a[24:31], v74
  v_add_f32 v20, v20, v22
  v_add_f32 v21, v21, v23
  v_add_f32 v24, v24, v26
  v_cvt_pk_bf16_f32 v22, v20, v24
  ds_write_b32 v79, v22 offset:0
  v_add_f32 v25, v25, v27
  v_cvt_pk_bf16_f32 v23, v21, v25
  ds_write_b32 v79, v23 offset:576
  v_add_f32 v28, v28, v30
  v_add_f32 v29, v29, v31
  s_waitcnt lgkmcnt(0)
  s_nop 1
  s_branch Cf0_recok
Cf0_mx:
  s_waitcnt lgkmcnt(0)
  s_barrier
  buffer_load_dwordx4 v[0:3], v76, s[8:11], s58 offen offset:0 sc1
  ds_read_b128 v[20:23], v77 offset:0
  ds_read_b128 v[28:31], v77 offset:256
  buffer_load_dwordx4 v[4:7], v76, s[8:11], s58 offen offset:1024 sc1
  ds_read_b128 v[24:27], v77 offset:128
  ds_read_b128 v[32:35], v77 offset:384
  s_waitcnt vmcnt(1) lgkmcnt(3)
  v_mfma_f32_16x16x32_bf16 v[8:11], v[0:3], v[20:23], 0
  s_waitcnt vmcnt(0) lgkmcnt(1)
  v_mfma_f32_16x16x32_bf16 v[8:11], v[4:7], v[24:27], v[8:11]
  v_mfma_f32_16x16x32_bf16 v[12:15], v[28:31], v[20:23], 0
  s_waitcnt lgkmcnt(0)
  v_mfma_f32_16x16x32_bf16 v[12:15], v[32:35], v[24:27], v[12:15]
  v_add_f32_dpp v8, v10, v8 quad_perm:[2,3,0,1] row_mask:0xf bank_mask:0xf
  v_add_f32_dpp v9, v11, v9 quad_perm:[2,3,0,1] row_mask:0xf bank_mask:0xf
  s_nop 0
  v_mov_b32_dpp v8, v8 quad_perm:[0,1,0,1] row_mask:0xf bank_mask:0xf
  v_mov_b32_dpp v9, v9 quad_perm:[0,1,0,1] row_mask:0xf bank_mask:0xf
  s_nop 1
  v_add_f32_dpp v12, v14, v12 quad_perm:[2,3,0,1] row_mask:0xf bank_mask:0xf
  v_add_f32_dpp v13, v15, v13 quad_perm:[2,3,0,1] row_mask:0xf bank_mask:0xf
  s_nop 0
  v_mov_b32_dpp v12, v12 quad_perm:[0,1,0,1] row_mask:0xf bank_mask:0xf
  v_mov_b32_dpp v13, v13 quad_perm:[0,1,0,1] row_mask:0xf bank_mask:0xf
  v_mul_f32 v12, s69, v12
  ds_write_b32 v78, v8 offset:8704
  v_mul_f32 v13, s69, v13
  ds_write_b32 v78, v9 offset:8768
  s_waitcnt lgkmcnt(0)
  s_barrier
  ds_read_b128 v[36:39], v78 offset:8704
  ds_read_b128 v[40:43], v78 offset:8768
  s_waitcnt lgkmcnt(0)
  s_barrier
  v_max_f32 v16, v36, v37
  v_max3_f32 v16, v16, v38, v39
  v_max3_f32 v16, v16, v40, v41
  v_max3_f32 v16, v16, v42, v43
  v_max3_f32 v16, v16, v12, v13
  v_mov_b32 v17, v16
  s_nop 1
  v_permlane16_swap_b32 v16, v17
  v_max_f32 v16, v16, v17
  v_mov_b32 v17, v16
  s_nop 1
  v_permlane32_swap_b32 v16, v17
  v_max_f32 v16, v16, v17
  v_sub_f32 v36, v36, v16
  v_sub_f32 v37, v37, v16
  v_sub_f32 v38, v38, v16
  v_sub_f32 v39, v39, v16
  v_sub_f32 v40, v40, v16
  v_sub_f32 v41, v41, v16
  v_sub_f32 v42, v42, v16
  v_sub_f32 v43, v43, v16
  v_sub_f32 v12, v12, v16
  v_sub_f32 v13, v13, v16
  v_exp_f32 v36, v36
  v_exp_f32 v37, v37
  v_exp_f32 v38, v38
  v_exp_f32 v39, v39
  v_exp_f32 v40, v40
  v_exp_f32 v41, v41
  v_exp_f32 v42, v42
  v_exp_f32 v43, v43
  v_exp_f32 v12, v12
  v_exp_f32 v13, v13
  v_cvt_pk_bf16_f32 v32, v36, v40
  v_cvt_pk_bf16_f32 v33, v37, v41
  v_cvt_pk_bf16_f32 v34, v38, v42
  v_cvt_pk_bf16_f32 v35, v39, v43
  v_cvt_pk_bf16_f32 v28, v12, v13
  v_cvt_pk_bf16_f32 v31, v12, v13
  v_mov_b32 v29, 0
  v_mov_b32 v30, 0
  v_mov_b32 v68, 0x3f803f80
  v_mov_b32 v69, 0x3f803f80
  v_mov_b32 v70, 0x3f803f80
  v_mov_b32 v71, 0x3f803f80
  s_nop 1
  v_mfma_f32_16x16x32_bf16 v[8:11], v[32:35], v[68:71], 0
  v_mfma_f32_16x16x32_bf16 v[0:3], v[32:35], v[52:55], 0
  v_mfma_f32_16x16x32_bf16 v[4:7], v[32:35], v[56:59], 0
  v_mfma_f32_16x16x16_bf16 v[8:11], v[28:29], v[68:69], v[8:11]
  v_mfma_f32_16x16x16_bf16 v[0:3], v[28:29], v[72:73], v[0:3]
  v_mfma_f32_16x16x16_bf16 v[4:7], v[30:31], v[72:73], v[4:7]
  ds_read_b128 v[68:71], v76 offset:13824
  v_rcp_f32 v10, v8
  v_rcp_f32 v11, v9
  v_mul_f32 v0, v10, v0
  v_mul_f32 v1, v11, v1
  s_nop 0
  v_mul_f32 v4, v10, v4
  v_mul_f32 v5, v11, v5
  v_cvt_pk_bf16_f32 v2, v0, v4
  ds_write_b32 v79, v2 offset:8704
  v_cvt_pk_bf16_f32 v3, v1, v5
  ds_write_b32 v79, v3 offset:9280
  v_mov_b64 v[16:17], 0
  v_mov_b64 v[18:19], 0
  v_mov_b64 v[20:21], 0
  v_mov_b64 v[22:23], 0
  v_mov_b64 v[24:25], 0
  v_mov_b64 v[26:27], 0
  s_branch Cf0_mxok
Cf0_kv3:
  s_waitcnt lgkmcnt(0)
  s_cmp_ge_u32 s57, 0x700
  s_cbranch_scc1 Cf0_kvb
  s_load_dword s57, s[12:13], s71 glc
  s_add_u32 s67, s67, 1
  s_cmp_lt_u32 s67, 131072
  s_cbranch_scc1 Cf0_kv3
  s_waitcnt lgkmcnt(0)
  s_branch Cf0_kvb
Cf0_last:
  ds_read_b128 v[4:7], v76 offset:5632
  ds_read_b128 v[12:15], v76 offset:7680
  ds_read_b128 v[44:47], v76 offset:32768
  ds_read_b128 v[48:51], v76 offset:33792
  s_nop 5
  v_mov_b64 v[20:21], 0
  v_mov_b64 v[22:23], 0
  v_mov_b64 v[24:25], 0
  v_mov_b64 v[26:27], 0
  v_smfmac_f32_16x16x64_bf16 v[28:31], v[0:3], v[36:43], v74
  ds_read_b128 v[36:39], v76 offset:34816
  ds_read_b128 v[40:43], v76 offset:35840
  v_smfmac_f32_16x16x64_bf16 v[32:35], v[0:3], v[60:67], v74
  s_waitcnt lgkmcnt(5)
  v_smfmac_f32_16x16x64_bf16 v[20:23], v[0:3], a[32:39], v74
  ds_read_b128 v[60:63], v76 offset:49152
  ds_read_b128 v[64:67], v76 offset:50176
  v_smfmac_f32_16x16x64_bf16 v[24:27], v[0:3], a[40:47], v74
  s_waitcnt lgkmcnt(4)
  v_smfmac_f32_16x16x64_bf16 v[20:23], v[4:7], a[48:55], v74
  buffer_store_dwordx4 v[16:19], v76, s[8:11], s68 offen sc1
  v_smfmac_f32_16x16x64_bf16 v[24:27], v[4:7], a[56:63], v74
  v_smfmac_f32_16x16x64_bf16 v[28:31], v[4:7], v[44:51], v74
  s_waitcnt lgkmcnt(2)
  v_smfmac_f32_16x16x64_bf16 v[20:23], v[8:11], a[64:71], v74
  ds_read_b128 v[44:47], v76 offset:51200
  ds_read_b128 v[48:51], v76 offset:52224
  v_smfmac_f32_16x16x64_bf16 v[24:27], v[8:11], a[72:79], v74
  v_smfmac_f32_16x16x64_bf16 v[32:35], v[4:7], v[36:43], v74
  v_smfmac_f32_16x16x64_bf16 v[28:31], v[8:11], v[208:215], v74
  ds_read_b128 v[36:39], v75 offset:16384
  ds_read_b128 v[40:43], v75 offset:17408
  v_smfmac_f32_16x16x64_bf16 v[32:35], v[8:11], v[216:223], v74
  v_smfmac_f32_16x16x64_bf16 v[20:23], v[12:15], a[80:87], v74
  v_smfmac_f32_16x16x64_bf16 v[24:27], v[12:15], a[88:95], v74
  v_smfmac_f32_16x16x64_bf16 v[28:31], v[12:15], v[224:231], v74
  v_smfmac_f32_16x16x64_bf16 v[32:35], v[12:15], v[232:239], v74
  s_waitcnt vmcnt(2)
  s_waitcnt vmcnt(1)
  s_barrier
Cf0_lastr:
  ds_read_b128 v[0:3], v76 offset:8704
  ds_read_b128 v[8:11], v76 offset:9728
  ds_read_b128 v[16:19], v76 offset:10752
  ds_read_b128 v[4:7], v76 offset:11776
  ds_read_b128 v[12:15], v76 offset:12800
  s_waitcnt lgkmcnt(4)
  v_max3_u32 v72, v0, v1, v2
  s_waitcnt lgkmcnt(1)
  v_max3_u32 v72, v72, v3, v4
  v_max3_u32 v72, v72, v5, v6
  v_max3_u32 v72, v72, v7, v8
  v_max3_u32 v72, v72, v9, v10
  s_waitcnt lgkmcnt(0)
  v_max3_u32 v72, v72, v11, v12
  v_max3_u32 v72, v72, v13, v14
  v_max3_u32 v72, v72, v15, v16
  v_max3_u32 v72, v72, v17, v18
  v_max_u32 v72, v72, v19
  v_cmp_eq_u32 vcc, -1, v72
  s_cbranch_vccnz Cf0_lastp
Cf0_lastg:
  v_smfmac_f32_16x16x64_bf16 v[28:31], v[0:3], v[60:67], v74
  ds_read_b128 v[60:63], v75 offset:18432
  ds_read_b128 v[64:67], v75 offset:19456
  v_smfmac_f32_16x16x64_bf16 v[32:35], v[0:3], v[44:51], v74
  v_smfmac_f32_16x16x64_bf16 v[28:31], v[8:11], v[36:43], v74
  v_smfmac_f32_16x16x64_bf16 v[28:31], v[16:19], v[240:247], v74
  v_smfmac_f32_16x16x64_bf16 v[28:31], v[4:7], a[0:7], v74
  v_smfmac_f32_16x16x64_bf16 v[28:31], v[12:15], a[16:23], v74
  v_smfmac_f32_16x16x64_bf16 v[32:35], v[16:19], v[248:255], v74
  v_smfmac_f32_16x16x64_bf16 v[32:35], v[4:7], a[8:15], v74
  s_waitcnt lgkmcnt(0)
  v_smfmac_f32_16x16x64_bf16 v[32:35], v[12:15], a[24:31], v74
  v_smfmac_f32_16x16x64_bf16 v[32:35], v[8:11], v[60:67], v74
  v_smfmac_f32_16x16x64_bf16 v[20:23], v[0:3], a[96:103], v74
  v_smfmac_f32_16x16x64_bf16 v[20:23], v[8:11], a[112:119], v74
  v_add_f32 v28, v28, v30
  v_add_f32 v32, v32, v34
  v_cvt_pk_bf16_f32 v30, v28, v32
  v_smfmac_f32_16x16x64_bf16 v[20:23], v[16:19], a[128:135], v74
  ds_write_b32 v79, v30 offset:256
  v_add_f32 v29, v29, v31
  v_add_f32 v33, v33, v35
  v_cvt_pk_bf16_f32 v31, v29, v33
  v_smfmac_f32_16x16x64_bf16 v[20:23], v[4:7], a[144:151], v74
  ds_write_b32 v79, v31 offset:832
  v_smfmac_f32_16x16x64_bf16 v[20:23], v[12:15], a[160:167], v74
  v_smfmac_f32_16x16x64_bf16 v[24:27], v[0:3], a[104:111], v74
  v_smfmac_f32_16x16x64_bf16 v[24:27], v[8:11], a[120:127], v74
  v_smfmac_f32_16x16x64_bf16 v[24:27], v[16:19], a[136:143], v74
  s_waitcnt lgkmcnt(0)
  s_barrier
  ds_read_b64 v[52:53], v77 offset:256
  v_add_f32 v20, v20, v22
  v_smfmac_f32_16x16x64_bf16 v[24:27], v[4:7], a[152:159], v74
  v_add_f32 v21, v21, v23
  v_smfmac_f32_16x16x64_bf16 v[24:27], v[12:15], a[168:175], v74
  v_cvt_pk_bf16_f32 v54, v20, v21
  s_add_u32 s68, s68, 655360
  s_nop 3
  v_add_f32 v24, v24, v26
  v_add_f32 v25, v25, v27
  v_cvt_pk_bf16_f32 v55, v24, v25
  s_waitcnt lgkmcnt(0)
  buffer_store_dwordx4 v[52:55], v76, s[8:11], s68 offen sc1
  s_branch Cf0_done
Cf0_lastp:
  s_add_u32 s72, s72, 2
  s_cmp_ge_u32 s72, 131072
  s_cbranch_scc1 Cf0_lastg
  s_barrier
  buffer_load_dwordx4 v76, s[8:11], s85 offen offset:0 sc1 lds
  s_waitcnt vmcnt(0)
  s_barrier
  s_branch Cf0_lastr
Cf0_done:
  s_branch L_cexit
L_w1:
  v_mov_b64 v[20:21], 0
  v_mov_b64 v[22:23], 0
  v_mov_b64 v[24:25], 0
  v_mov_b64 v[26:27], 0
  v_mov_b64 v[28:29], 0
  v_mov_b64 v[30:31], 0
  v_mov_b64 v[32:33], 0
  v_mov_b64 v[34:35], 0
  s_mov_b32 s78, 0x3f803f80
  s_mov_b32 s79, s78
  s_mov_b32 s65, 360448
  s_mov_b32 m0, 15872
  s_lshl_b32 s71, s53, 2
  s_add_u32 s71, s71, 128
  s_movk_i32 s56, 0x1000
  v_lshlrev_b32 v73, 2, v76
  v_mov_b32 v72, 0
  s_mov_b64 s[16:17], s[8:9]
  s_mov_b32 s18, 268435456
  s_mov_b32 s19, 0x20000
  s_getpc_b64 s[20:21]
Cf1_pc:
  s_add_u32 s20, s20, (Cf1_last - Cf1_pc)
  s_addc_u32 s21, s21, 0
  v_mov_b32 v68, 14880
  buffer_load_dwordx4 v[52:55], v76, s[8:11], s59 offen offset:0 sc1
  buffer_load_dwordx4 v[56:59], v76, s[8:11], s59 offen offset:1024 sc1
  ds_read_b128 v[36:39], v76 offset:20480
  ds_read_b128 v[40:43], v76 offset:21504
  ds_read_b128 v[60:63], v76 offset:22528
  ds_read_b128 v[64:67], v76 offset:23552
  ds_read_b128 v[0:3], v76 offset:4608
  ds_read_b128 v[4:7], v76 offset:5632
  ds_read_b128 v[8:11], v76 offset:6656
  ds_read_b128 v[12:15], v76 offset:7680
  s_waitcnt lgkmcnt(0)
  s_cmp_eq_u32 s66, 1
  s_branch Cf1_top2
.p2align 6
Cf1_h2:
  ds_read_b128 v[36:39], v76 offset:20480
  s_waitcnt lgkmcnt(0)
  s_cmp_eq_u32 s66, 62
  s_cselect_b64 s[16:17], s[20:21], s[16:17]
  s_cselect_b32 s18, (Cf1_done - Cf1_last), s18
  s_cselect_b32 s70, 0, s70
  s_cmp_eq_u32 s66, 63
  s_cselect_b32 s59, 268435456, s59
  s_cselect_b32 s58, 268435456, s58
  buffer_load_dwordx4 v[8:11], v76, s[8:11], s65 offen offset:2048 sc1
  ds_read_b128 v[40:43], v76 offset:21504
  s_waitcnt lgkmcnt(0)
  v_mov_b64 v[20:21], 0
  v_mov_b64 v[22:23], 0
  v_mov_b64 v[24:25], 0
  v_mov_b64 v[26:27], 0
  v_mov_b32 v68, 14880
  buffer_load_dwordx4 v[8:11], v76, s[8:11], s65 offen offset:2048 sc1
  ds_read_b128 v[60:63], v76 offset:22528
  s_waitcnt lgkmcnt(0)
  v_mov_b64 v[28:29], 0
  v_mov_b64 v[30:31], 0
  v_mov_b64 v[32:33], 0
  v_mov_b64 v[34:35], 0
  v_lshlrev_b32 v73, 2, v76
  buffer_load_dwordx4 v[8:11], v76, s[8:11], s65 offen offset:2048 sc1
  buffer_load_dwordx4 v[52:55], v76, s[8:11], s59 offen offset:0 sc1
  buffer_load_dwordx4 v[56:59], v76, s[8:11], s59 offen offset:1024 sc1
  s_waitcnt vmcnt(4)
  v_max3_u32 v72, v8, v9, v10
  v_max_u32 v72, v72, v11
  ds_write_b128 v76, v[8:11] offset:6656
  v_cmp_eq_u32 vcc, -1, v72
  s_cbranch_vccnz Cf1_h2r
Cf1_h2w:
  s_cmp_eq_u32 s66, 63
  s_waitcnt lgkmcnt(0)
  s_barrier
  ds_read_b128 v[0:3], v76 offset:4608
  buffer_load_dwordx4 v76, s[8:11], s85 offen offset:0 sc1 lds
Cf1_top2:
  v_smfmac_f32_16x16x64_bf16 v[20:23], v[8:11], v[112:119], v74
  s_cbranch_scc1 Cf1_last
  v_smfmac_f32_16x16x64_bf16 v[24:27], v[8:11], v[120:127], v74
  buffer_load_dwordx4 v[44:47], v76, s[8:11], s58 offen offset:0 sc1
  s_mov_b32 m0, 15872
  v_smfmac_f32_16x16x64_bf16 v[28:31], v[8:11], v[208:215], v74
  buffer_load_dwordx4 v[48:51], v76, s[8:11], s58 offen offset:1024 sc1
  v_smfmac_f32_16x16x64_bf16 v[32:35], v[8:11], v[216:223], v74
  ds_read_b128 v[4:7], v76 offset:5632
  s_waitcnt lgkmcnt(1)
  v_smfmac_f32_16x16x64_bf16 v[20:23], v[0:3], v[80:87], v74
  ds_read_b128 v[12:15], v76 offset:7680
  v_smfmac_f32_16x16x64_bf16 v[28:31], v[0:3], v[36:43], v74
  ds_read_b128 v[36:39], v76 offset:36864
  v_smfmac_f32_16x16x64_bf16 v[24:27], v[0:3], v[88:95], v74
  buffer_store_dwordx4 v[16:19], v76, s[8:11], s68 offen sc1
  ds_read_b128 v[40:43], v76 offset:37888
  v_smfmac_f32_16x16x64_bf16 v[32:35], v[0:3], v[60:67], v74
  ds_read_b128 v[60:63], v76 offset:38912
  s_waitcnt lgkmcnt(4)
  v_smfmac_f32_16x16x64_bf16 v[20:23], v[4:7], v[96:103], v74
  ds_read_b128 v[64:67], v76 offset:39936
  v_smfmac_f32_16x16x64_bf16 v[24:27], v[4:7], v[104:111], v74
  buffer_load_dword v73, s[16:19], s70 offen lds
  s_waitcnt vmcnt(5)
  s_waitcnt lgkmcnt(4)
  v_smfmac_f32_16x16x64_bf16 v[20:23], v[12:15], v[128:135], v74
  s_barrier
  s_waitcnt lgkmcnt(2)
  v_smfmac_f32_16x16x64_bf16 v[28:31], v[4:7], v[36:43], v74
  ds_read_b128 v[8:11], v76 offset:8704
  v_smfmac_f32_16x16x64_bf16 v[24:27], v[12:15], v[136:143], v74
  ds_read_b128 v[36:39], v76 offset:53248
  s_waitcnt lgkmcnt(2)
  v_smfmac_f32_16x16x64_bf16 v[32:35], v[4:7], v[60:67], v74
  ds_read_b128 v[40:43], v76 offset:54272
  v_smfmac_f32_16x16x64_bf16 v[28:31], v[12:15], v[224:231], v74
  ds_read_b128 v[60:63], v76 offset:55296
  v_smfmac_f32_16x16x64_bf16 v[32:35], v[12:15], v[232:239], v74
  ds_read_b128 v[64:67], v76 offset:56320
  s_waitcnt lgkmcnt(4)
  v_smfmac_f32_16x16x64_bf16 v[20:23], v[8:11], v[144:151], v74
  s_waitcnt vmcnt(4)
  ds_read_b128 v[0:3], v76 offset:9728
  s_waitcnt lgkmcnt(3)
  v_smfmac_f32_16x16x64_bf16 v[28:31], v[8:11], v[36:43], v74
  s_barrier
  ds_read_b128 v[4:7], v76 offset:11776
  v_smfmac_f32_16x16x64_bf16 v[24:27], v[8:11], v[152:159], v74
  ds_read_b128 v[36:39], v75 offset:4096
  ds_read_b128 v[40:43], v75 offset:5120
  s_waitcnt lgkmcnt(4)
  v_smfmac_f32_16x16x64_bf16 v[32:35], v[8:11], v[60:67], v74
  ds_read_b128 v[16:19], v76 offset:10752
  s_waitcnt lgkmcnt(4)
  v_smfmac_f32_16x16x64_bf16 v[20:23], v[0:3], v[160:167], v74
  ds_read_b128 v[12:15], v76 offset:12800
  v_smfmac_f32_16x16x64_bf16 v[24:27], v[0:3], v[168:175], v74
  ds_read_b128 v[60:63], v75 offset:6144
  ds_read_b128 v[64:67], v75 offset:7168
  s_waitcnt lgkmcnt(6)
  v_smfmac_f32_16x16x64_bf16 v[20:23], v[4:7], v[176:183], v74
  s_waitcnt lgkmcnt(3)
  v_smfmac_f32_16x16x64_bf16 v[20:23], v[16:19], v[36:43], v74
  ds_read_b128 v[36:39], v75 offset:20480
  s_waitcnt lgkmcnt(3)
  v_smfmac_f32_16x16x64_bf16 v[20:23], v[12:15], v[192:199], v74
  ds_read_b128 v[40:43], v75 offset:21504
  s_waitcnt lgkmcnt(2)
  v_smfmac_f32_16x16x64_bf16 v[24:27], v[16:19], v[60:67], v74
  ds_read_b128 v[60:63], v75 offset:22528
  v_smfmac_f32_16x16x64_bf16 v[24:27], v[4:7], v[184:191], v74
  ds_read_b128 v[64:67], v75 offset:23552
  v_add_f32 v20, v20, v22
  v_smfmac_f32_16x16x64_bf16 v[24:27], v[12:15], v[200:207], v74
  v_add_f32 v21, v21, v23
  v_smfmac_f32_16x16x64_bf16 v[28:31], v[16:19], v[240:247], v74
  s_waitcnt lgkmcnt(2)
  v_mov_b64 v[70:71], s[78:79]
  v_smfmac_f32_16x16x64_bf16 v[28:31], v[0:3], v[36:43], v74
  ds_read_b128 v[36:39], v68
  v_add_f32 v24, v24, v26
  v_smfmac_f32_16x16x64_bf16 v[28:31], v[4:7], a[0:7], v74
  ds_read_b128 v[40:43], v68
  v_cvt_pk_bf16_f32 v22, v20, v24
  v_smfmac_f32_16x16x64_bf16 v[28:31], v[12:15], a[16:23], v74
  ds_write_b32 v79, v22 offset:0
  s_waitcnt lgkmcnt(3)
  v_add_f32 v25, v25, v27
  v_cvt_pk_bf16_f32 v23, v21, v25
  v_smfmac_f32_16x16x64_bf16 v[32:35], v[0:3], v[60:67], v74
  ds_write_b32 v79, v23 offset:576
  v_cmp_u_f32 vcc, v20, v21
  v_smfmac_f32_16x16x64_bf16 v[32:35], v[16:19], v[248:255], v74
  v_add_f32 v28, v28, v30
  v_smfmac_f32_16x16x64_bf16 v[32:35], v[4:7], a[8:15], v74
  v_add_f32 v29, v29, v31
  v_smfmac_f32_16x16x64_bf16 v[32:35], v[12:15], a[24:31], v74
  s_cbranch_vccnz Cf1_rec
Cf1_recok:
  s_waitcnt lgkmcnt(3)
  v_smfmac_f32_16x16x64_bf16 v[36:39], v[16:19], a[128:135], v74
  s_waitcnt lgkmcnt(0)
  s_barrier
  ds_read_b128 v[60:63], v77
  v_smfmac_f32_16x16x64_bf16 v[40:43], v[16:19], a[136:143], v74
  ds_read_b128 v[64:67], v77 offset:128
  v_add_f32 v32, v32, v34
  v_cvt_pk_bf16_f32 v30, v28, v32
  v_smfmac_f32_16x16x64_bf16 v[36:39], v[0:3], a[112:119], v74
  ds_write_b32 v79, v30 offset:256
  v_add_f32 v33, v33, v35
  v_cvt_pk_bf16_f32 v31, v29, v33
  v_smfmac_f32_16x16x64_bf16 v[40:43], v[0:3], a[120:127], v74
  ds_write_b32 v79, v31 offset:832
  v_xor_b32 v75, 0x8000, v75
  v_smfmac_f32_16x16x64_bf16 v[36:39], v[4:7], a[144:151], v74
  ds_read_b128 v[0:3], v76 offset:4608
  v_mov_b32 v29, 0
  v_smfmac_f32_16x16x64_bf16 v[40:43], v[4:7], a[152:159], v74
  s_waitcnt vmcnt(2) lgkmcnt(3)
  v_mov_b32 v30, 0
  v_mfma_f32_16x16x32_bf16 v[44:47], v[44:47], v[60:63], 0
  ds_read_b128 v[4:7], v76 offset:5632
  s_waitcnt lgkmcnt(2)
  v_mfma_f32_16x16x32_bf16 v[44:47], v[48:51], v[64:67], v[44:47]
  s_barrier
  v_smfmac_f32_16x16x64_bf16 v[36:39], v[8:11], a[96:103], v74
  ds_read_b128 v[20:23], v77 offset:256
  ds_read_b128 v[24:27], v77 offset:384
  v_smfmac_f32_16x16x64_bf16 v[40:43], v[8:11], a[104:111], v74
  ds_read_b128 v[8:11], v76 offset:6656
  v_add_f32_dpp v72, v46, v44 quad_perm:[2,3,0,1] row_mask:0xf bank_mask:0xf
  v_add_f32_dpp v73, v47, v45 quad_perm:[2,3,0,1] row_mask:0xf bank_mask:0xf
  v_smfmac_f32_16x16x64_bf16 v[36:39], v[12:15], a[160:167], v74
  s_waitcnt lgkmcnt(4)
  v_exp_f32_dpp v72, v72 quad_perm:[0,1,0,1] row_mask:0xf bank_mask:0xf
  v_smfmac_f32_16x16x64_bf16 v[40:43], v[12:15], a[168:175], v74
  ds_read_b128 v[12:15], v76 offset:7680
  v_exp_f32_dpp v73, v73 quad_perm:[0,1,0,1] row_mask:0xf bank_mask:0xf
  v_smfmac_f32_16x16x64_bf16 v[36:39], v[0:3], a[32:39], v74
  s_waitcnt lgkmcnt(2)
  v_cvt_pk_bf16_f32 v72, v72, v73
  v_mfma_f32_16x16x32_bf16 v[20:23], v[20:23], v[60:63], 0
  ds_write_b32 v78, v72 offset:516
  v_mov_b64 v[16:17], 0
  v_mfma_f32_16x16x32_bf16 v[20:23], v[24:27], v[64:67], v[20:23]
  ds_read_b128 v[44:47], v75 offset:20480
  v_mov_b64 v[18:19], 0
  v_smfmac_f32_16x16x64_bf16 v[40:43], v[0:3], a[40:47], v74
  ds_read_b128 v[48:51], v75 offset:21504
  v_mov_b64 v[68:69], s[78:79]
  v_smfmac_f32_16x16x64_bf16 v[36:39], v[4:7], a[48:55], v74
  s_waitcnt lgkmcnt(4)
  v_add_f32_dpp v24, v22, v20 quad_perm:[2,3,0,1] row_mask:0xf bank_mask:0xf
  v_add_f32_dpp v25, v23, v21 quad_perm:[2,3,0,1] row_mask:0xf bank_mask:0xf
  v_smfmac_f32_16x16x64_bf16 v[36:39], v[8:11], a[64:71], v74
  s_waitcnt lgkmcnt(2)
  s_barrier
  ds_read_b128 v[32:35], v78 offset:512
  v_smfmac_f32_16x16x64_bf16 v[36:39], v[12:15], a[80:87], v74
  ds_read_b128 v[60:63], v75 offset:22528
  v_mul_f32 v24, s69, v24
  v_smfmac_f32_16x16x64_bf16 v[40:43], v[4:7], a[56:63], v74
  ds_read_b128 v[64:67], v75 offset:23552
  v_mul_f32 v25, s69, v25
  v_smfmac_f32_16x16x64_bf16 v[40:43], v[8:11], a[72:79], v74
  v_exp_f32_dpp v24, v24 quad_perm:[0,1,0,1] row_mask:0xf bank_mask:0xf
  v_smfmac_f32_16x16x64_bf16 v[40:43], v[12:15], a[88:95], v74
  s_waitcnt lgkmcnt(2)
  v_exp_f32_dpp v25, v25 quad_perm:[0,1,0,1] row_mask:0xf bank_mask:0xf
  v_mfma_f32_16x16x32_bf16 v[8:11], v[32:35], v[68:71], 0
  v_add_f32 v36, v36, v38
  v_add_f32 v37, v37, v39
  v_mfma_f32_16x16x32_bf16 v[0:3], v[32:35], v[52:55], 0
  v_add_f32 v40, v40, v42
  v_add_f32 v41, v41, v43
  v_mfma_f32_16x16x32_bf16 v[4:7], v[32:35], v[56:59], 0
  v_cvt_pk_bf16_f32 v28, v24, v25
  v_cvt_pk_bf16_f32 v72, v36, v37
  v_cvt_pk_bf16_f32 v73, v40, v41
  v_mfma_f32_16x16x16_bf16 v[8:11], v[28:29], v[68:69], v[8:11]
  v_cvt_pk_bf16_f32 v31, v24, v25
  v_mov_b64 v[20:21], 0
  v_mfma_f32_16x16x16_bf16 v[0:3], v[28:29], v[72:73], v[0:3]
  ds_read_b128 v[68:71], v76 offset:13824
  v_mov_b64 v[22:23], 0
  v_mfma_f32_16x16x16_bf16 v[4:7], v[30:31], v[72:73], v[4:7]
  v_rcp_f32 v10, v8
  v_rcp_f32 v11, v9
  v_mul_f32 v0, v10, v0
  v_mul_f32 v1, v11, v1
  s_nop 0
  v_mul_f32 v4, v10, v4
  v_mul_f32 v5, v11, v5
  v_cvt_pk_bf16_f32 v2, v0, v4
  ds_write_b32 v79, v2 offset:8704
  v_cvt_pk_bf16_f32 v3, v1, v5
  ds_write_b32 v79, v3 offset:9280
  v_max3_f32 v8, v8, v9, v10
  v_max_f32 v8, v8, v11
  v_cmp_le_f32 vcc, 1317011456, v8
  v_mov_b64 v[24:25], 0
  v_mov_b64 v[26:27], 0
  s_cbranch_vccnz Cf1_mx
Cf1_mxok:
  s_waitcnt lgkmcnt(0)
  s_barrier
  ds_read_b128 v[0:3], v78 offset:8704
  ds_read_b128 v[4:7], v78 offset:8768
  ds_read_b128 v[8:11], v78 offset:8832
  ds_read_b128 v[12:15], v78 offset:8896
  s_waitcnt lgkmcnt(3)
  v_smfmac_f32_16x16x64_bf16 v[16:19], v[0:3], v[44:51], v74
  ds_read_b128 v[52:55], v75 offset:36864
  s_waitcnt lgkmcnt(3)
  v_smfmac_f32_16x16x64_bf16 v[16:19], v[4:7], v[60:67], v74
  ds_read_b128 v[56:59], v75 offset:37888
  s_waitcnt lgkmcnt(3)
  v_smfmac_f32_16x16x64_bf16 v[16:19], v[8:11], a[176:183], v74
  ds_read_b128 v[36:39], v75 offset:38912
  s_waitcnt lgkmcnt(3)
  v_smfmac_f32_16x16x64_bf16 v[16:19], v[12:15], a[184:191], v74
  ds_read_b128 v[40:43], v75 offset:39936
  ds_read_b128 v[44:47], v75 offset:53248
  v_smfmac_f32_16x16x64_bf16 v[20:23], v[0:3], a[192:199], v74
  ds_read_b128 v[48:51], v75 offset:54272
  ds_read_b128 v[60:63], v75 offset:55296
  v_smfmac_f32_16x16x64_bf16 v[20:23], v[4:7], a[200:207], v74
  ds_read_b128 v[64:67], v75 offset:56320
  s_waitcnt lgkmcnt(6)
  v_cvt_pk_bf16_f32 v16, v16, v17
  v_cvt_pk_bf16_f32 v17, v18, v19
  v_bfi_b32 v16, 1, s72, v16
  v_smfmac_f32_16x16x64_bf16 v[20:23], v[8:11], v[52:59], v74
  buffer_store_dwordx2 v[16:17], v68, s[8:11], s73 offen
  s_waitcnt lgkmcnt(4)
  v_smfmac_f32_16x16x64_bf16 v[20:23], v[12:15], v[36:43], v74
  v_mov_b64 v[32:33], 0
  v_smfmac_f32_16x16x64_bf16 v[24:27], v[0:3], a[208:215], v74
  v_mov_b64 v[34:35], 0
  v_smfmac_f32_16x16x64_bf16 v[24:27], v[4:7], a[216:223], v74
  s_waitcnt lgkmcnt(2)
  v_cvt_pk_bf16_f32 v20, v20, v21
  v_cvt_pk_bf16_f32 v21, v22, v23
  v_bfi_b32 v20, 1, s72, v20
  v_smfmac_f32_16x16x64_bf16 v[24:27], v[8:11], v[44:51], v74
  buffer_store_dwordx2 v[20:21], v68, s[8:11], s74 offen
  s_waitcnt lgkmcnt(0)
  v_smfmac_f32_16x16x64_bf16 v[24:27], v[12:15], v[60:67], v74
  v_smfmac_f32_16x16x64_bf16 v[32:35], v[0:3], a[224:231], v74
  v_smfmac_f32_16x16x64_bf16 v[32:35], v[4:7], a[232:239], v74
  v_cvt_pk_bf16_f32 v24, v24, v25
  v_cvt_pk_bf16_f32 v25, v26, v27
  v_bfi_b32 v24, 1, s72, v24
  v_smfmac_f32_16x16x64_bf16 v[32:35], v[8:11], a[240:247], v74
  buffer_store_dwordx2 v[24:25], v68, s[8:11], s75 offen
  v_smfmac_f32_16x16x64_bf16 v[32:35], v[12:15], a[248:255], v74
  v_mov_b64 v[18:19], v[72:73]
  s_nop 4
  v_cvt_pk_bf16_f32 v32, v32, v33
  v_cvt_pk_bf16_f32 v33, v34, v35
  v_bfi_b32 v32, 1, s72, v32
  buffer_store_dwordx2 v[32:33], v68, s[8:11], s76 offen
  ds_read_b128 v[0:3], v76 offset:14848
  s_waitcnt lgkmcnt(0)
  ds_read_b64 v[16:17], v77 offset:264
  s_waitcnt lgkmcnt(0)
  ds_read_b128 v[64:67], v76 offset:23552
  s_waitcnt lgkmcnt(0)
  s_add_u32 s66, s66, 1
  s_xor_b32 s64, s64, 16384
  s_xor_b32 s65, s65, 16384
  s_add_u32 s58, s58, 655360
  s_add_u32 s59, s59, 655360
  s_add_u32 s70, s70, 655360
  s_add_u32 s68, s68, 655360
  s_mov_b32 m0, 11776
  s_add_u32 s85, s65, 7168
  v_xor_b32 v75, 0x8000, v75
  buffer_load_dwordx4 v[52:55], v76, s[8:11], s60 offen offset:0 sc1
  buffer_load_dwordx4 v[56:59], v76, s[8:11], s60 offen offset:1024 sc1
  s_waitcnt lgkmcnt(0)
  s_waitcnt vmcnt(1)
  v_mfma_f32_16x16x32_bf16 v[4:7], v[0:3], v[52:55], 0
  v_bitop3_b32 v72, v52, v54, s72 bitop3:0x7e
  s_waitcnt vmcnt(0)
  v_mfma_f32_16x16x32_bf16 v[4:7], v[0:3], v[56:59], v[4:7]
  v_bitop3_b32 v73, v56, v58, s72 bitop3:0x7e
  v_bitop3_b32 v72, v72, v73, 1 bitop3:0xa8
  v_cmp_ne_u32 vcc, 0, v72
  s_nop 0
  s_cmp_eq_u64 vcc, 0
  s_cselect_b32 s54, s62, 268435456
  s_nop 0
  v_add_f32_dpp v4, v4, v4 row_ror:4 row_mask:0xf bank_mask:0xf
  v_add_f32_dpp v5, v5, v5 row_ror:4 row_mask:0xf bank_mask:0xf
  s_nop 0
  v_add_f32_dpp v4, v4, v4 row_ror:8 row_mask:0xf bank_mask:0xf
  v_add_f32_dpp v5, v5, v5 row_ror:8 row_mask:0xf bank_mask:0xf
  v_cvt_pk_bf16_f32 v4, v4, v5
  buffer_store_dword v4, v69, s[8:11], s54 offen
  s_cbranch_vccnz Cf1_h1r
  s_xor_b32 s62, s62, 16384
  buffer_store_dword v71, v69, s[8:11], s62 offen
  s_xor_b32 s72, s72, 1
  s_branch Cf1_h2
Cf1_h1r:
  s_mov_b64 exec, vcc
  buffer_load_dwordx4 v[52:55], v76, s[8:11], s60 offen offset:0 sc1
  buffer_load_dwordx4 v[56:59], v76, s[8:11], s60 offen offset:1024 sc1
  s_mov_b64 exec, -1
  s_add_u32 s67, s67, 1
  s_waitcnt vmcnt(1)
  v_mfma_f32_16x16x32_bf16 v[4:7], v[0:3], v[52:55], 0
  v_bitop3_b32 v72, v52, v54, s72 bitop3:0x7e
  s_waitcnt vmcnt(0)
  v_mfma_f32_16x16x32_bf16 v[4:7], v[0:3], v[56:59], v[4:7]
  v_bitop3_b32 v73, v56, v58, s72 bitop3:0x7e
  v_bitop3_b32 v72, v72, v73, 1 bitop3:0xa8
  v_cmp_ne_u32 vcc, 0, v72
  s_cbranch_vccz Cf1_h1p
Cf1_h1s:
  s_mov_b64 exec, vcc
  buffer_load_dwordx4 v[52:55], v76, s[8:11], s60 offen offset:0 sc1
  buffer_load_dwordx4 v[56:59], v76, s[8:11], s60 offen offset:1024 sc1
  s_mov_b64 exec, -1
  s_add_u32 s67, s67, 1
  s_waitcnt vmcnt(1)
  v_mfma_f32_16x16x32_bf16 v[4:7], v[0:3], v[52:55], 0
  v_bitop3_b32 v72, v52, v54, s72 bitop3:0x7e
  s_waitcnt vmcnt(0)
  v_mfma_f32_16x16x32_bf16 v[4:7], v[0:3], v[56:59], v[4:7]
  v_bitop3_b32 v73, v56, v58, s72 bitop3:0x7e
  v_bitop3_b32 v72, v72, v73, 1 bitop3:0xa8
  v_cmp_ne_u32 vcc, 0, v72
  s_cbranch_vccz Cf1_h1p
  s_cmp_lt_u32 s67, 131072
  s_cbranch_scc1 Cf1_h1s
Cf1_h1p:
  s_nop 2
  v_add_f32_dpp v4, v4, v4 row_ror:4 row_mask:0xf bank_mask:0xf
  v_add_f32_dpp v5, v5, v5 row_ror:4 row_mask:0xf bank_mask:0xf
  s_nop 0
  v_add_f32_dpp v4, v4, v4 row_ror:8 row_mask:0xf bank_mask:0xf
  v_add_f32_dpp v5, v5, v5 row_ror:8 row_mask:0xf bank_mask:0xf
  v_cvt_pk_bf16_f32 v4, v4, v5
  buffer_store_dword v4, v69, s[8:11], s62 offen
  s_xor_b32 s62, s62, 16384
  buffer_store_dword v71, v69, s[8:11], s62 offen
  s_xor_b32 s72, s72, 1
  s_branch Cf1_h2
Cf1_h2r:
  s_mov_b64 exec, vcc
  buffer_load_dwordx4 v[8:11], v76, s[8:11], s65 offen offset:2048 sc1
  s_mov_b64 exec, -1
  s_add_u32 s67, s67, 1
  s_waitcnt vmcnt(4)
  v_max3_u32 v72, v8, v9, v10
  v_max_u32 v72, v72, v11
  ds_write_b128 v76, v[8:11] offset:6656
  v_cmp_eq_u32 vcc, -1, v72
  s_cbranch_vccz Cf1_h2w
  s_mov_b64 exec, vcc
  buffer_load_dwordx4 v[8:11], v76, s[8:11], s65 offen offset:2048 sc1
  s_mov_b64 exec, -1
  s_add_u32 s67, s67, 1
  s_waitcnt vmcnt(4)
  v_max3_u32 v72, v8, v9, v10
  v_max_u32 v72, v72, v11
  ds_write_b128 v76, v[8:11] offset:6656
  v_cmp_eq_u32 vcc, -1, v72
  s_cbranch_vccz Cf1_h2w
Cf1_h2s:
  s_mov_b64 exec, vcc
  buffer_load_dwordx4 v[8:11], v76, s[8:11], s65 offen offset:2048 sc1
  s_mov_b64 exec, -1
  s_add_u32 s67, s67, 1
  s_waitcnt vmcnt(2)
  v_max3_u32 v72, v8, v9, v10
  v_max_u32 v72, v72, v11
  ds_write_b128 v76, v[8:11] offset:6656
  v_cmp_eq_u32 vcc, -1, v72
  s_cbranch_vccz Cf1_h2w
  s_mov_b64 exec, vcc
  buffer_load_dwordx4 v[8:11], v76, s[8:11], s65 offen offset:2048 sc1
  s_mov_b64 exec, -1
  s_add_u32 s67, s67, 1
  s_waitcnt vmcnt(2)
  v_max3_u32 v72, v8, v9, v10
  v_max_u32 v72, v72, v11
  ds_write_b128 v76, v[8:11] offset:6656
  v_cmp_eq_u32 vcc, -1, v72
  s_cbranch_vccz Cf1_h2w
  s_mov_b64 exec, vcc
  buffer_load_dwordx4 v[8:11], v76, s[8:11], s65 offen offset:2048 sc1
  s_mov_b64 exec, -1
  s_add_u32 s67, s67, 1
  s_waitcnt vmcnt(2)
  v_max3_u32 v72, v8, v9, v10
  v_max_u32 v72, v72, v11
  ds_write_b128 v76, v[8:11] offset:6656
  v_cmp_eq_u32 vcc, -1, v72
  s_cbranch_vccz Cf1_h2w
  s_cmp_lt_u32 s67, 131072
  s_cbranch_scc1 Cf1_h2s
  s_branch Cf1_h2w
Cf1_rec:
  s_nop 7
  s_waitcnt vmcnt(0) lgkmcnt(0)
  v_max3_u32 v72, v0, v1, v2
  v_max3_u32 v72, v72, v3, v4
  v_max3_u32 v72, v72, v5, v6
  v_max3_u32 v72, v72, v7, v8
  v_max3_u32 v72, v72, v9, v10
  v_max3_u32 v72, v72, v11, v12
  v_max3_u32 v72, v72, v13, v14
  v_max3_u32 v72, v72, v15, v16
  v_max3_u32 v72, v72, v17, v18
  v_max_u32 v72, v72, v19
  v_cmp_eq_u32 vcc, -1, v72
  s_cbranch_vccz Cf1_recok
  s_barrier
  v_mov_b64 v[20:21], 0
  v_mov_b64 v[22:23], 0
  v_mov_b64 v[24:25], 0
  v_mov_b64 v[26:27], 0
  v_mov_b64 v[28:29], 0
  v_mov_b64 v[30:31], 0
  v_mov_b64 v[32:33], 0
  v_mov_b64 v[34:35], 0
  s_waitcnt lgkmcnt(0)
  s_barrier
  ds_read_b128 v[0:3], v76 offset:4608
  s_waitcnt lgkmcnt(0)
  v_smfmac_f32_16x16x64_bf16 v[20:23], v[0:3], v[80:87], v74
  v_smfmac_f32_16x16x64_bf16 v[24:27], v[0:3], v[88:95], v74
  ds_read_b128 v[60:63], v76 offset:20480
  ds_read_b128 v[64:67], v76 offset:21504
  s_waitcnt lgkmcnt(0)
  v_smfmac_f32_16x16x64_bf16 v[28:31], v[0:3], v[60:67], v74
  ds_read_b128 v[60:63], v76 offset:22528
  ds_read_b128 v[64:67], v76 offset:23552
  s_waitcnt lgkmcnt(0)
  v_smfmac_f32_16x16x64_bf16 v[32:35], v[0:3], v[60:67], v74
  ds_read_b128 v[4:7], v76 offset:5632
  s_waitcnt lgkmcnt(0)
  v_smfmac_f32_16x16x64_bf16 v[20:23], v[4:7], v[96:103], v74
  v_smfmac_f32_16x16x64_bf16 v[24:27], v[4:7], v[104:111], v74
  ds_read_b128 v[60:63], v76 offset:36864
  ds_read_b128 v[64:67], v76 offset:37888
  s_waitcnt lgkmcnt(0)
  v_smfmac_f32_16x16x64_bf16 v[28:31], v[4:7], v[60:67], v74
  ds_read_b128 v[60:63], v76 offset:38912
  ds_read_b128 v[64:67], v76 offset:39936
  s_waitcnt lgkmcnt(0)
  v_smfmac_f32_16x16x64_bf16 v[32:35], v[4:7], v[60:67], v74
  ds_read_b128 v[8:11], v76 offset:6656
  s_waitcnt lgkmcnt(0)
  v_smfmac_f32_16x16x64_bf16 v[20:23], v[8:11], v[112:119], v74
  v_smfmac_f32_16x16x64_bf16 v[24:27], v[8:11], v[120:127], v74
  v_smfmac_f32_16x16x64_bf16 v[28:31], v[8:11], v[208:215], v74
  v_smfmac_f32_16x16x64_bf16 v[32:35], v[8:11], v[216:223], v74
  ds_read_b128 v[12:15], v76 offset:7680
  s_waitcnt lgkmcnt(0)
  v_smfmac_f32_16x16x64_bf16 v[20:23], v[12:15], v[128:135], v74
  v_smfmac_f32_16x16x64_bf16 v[24:27], v[12:15], v[136:143], v74
  v_smfmac_f32_16x16x64_bf16 v[28:31], v[12:15], v[224:231], v74
  v_smfmac_f32_16x16x64_bf16 v[32:35], v[12:15], v[232:239], v74
  ds_read_b128 v[8:11], v76 offset:8704
  s_waitcnt lgkmcnt(0)
  v_smfmac_f32_16x16x64_bf16 v[20:23], v[8:11], v[144:151], v74
  v_smfmac_f32_16x16x64_bf16 v[24:27], v[8:11], v[152:159], v74
  ds_read_b128 v[60:63], v76 offset:53248
  ds_read_b128 v[64:67], v76 offset:54272
  s_waitcnt lgkmcnt(0)
  v_smfmac_f32_16x16x64_bf16 v[28:31], v[8:11], v[60:67], v74
  ds_read_b128 v[60:63], v76 offset:55296
  ds_read_b128 v[64:67], v76 offset:56320
  s_waitcnt lgkmcnt(0)
  v_smfmac_f32_16x16x64_bf16 v[32:35], v[8:11], v[60:67], v74
  ds_read_b128 v[0:3], v76 offset:9728
  s_waitcnt lgkmcnt(0)
  v_smfmac_f32_16x16x64_bf16 v[20:23], v[0:3], v[160:167], v74
  v_smfmac_f32_16x16x64_bf16 v[24:27], v[0:3], v[168:175], v74
  ds_read_b128 v[60:63], v75 offset:20480
  ds_read_b128 v[64:67], v75 offset:21504
  s_waitcnt lgkmcnt(0)
  v_smfmac_f32_16x16x64_bf16 v[28:31], v[0:3], v[60:67], v74
  ds_read_b128 v[60:63], v75 offset:22528
  ds_read_b128 v[64:67], v75 offset:23552
  s_waitcnt lgkmcnt(0)
  v_smfmac_f32_16x16x64_bf16 v[32:35], v[0:3], v[60:67], v74
  ds_read_b128 v[16:19], v76 offset:10752
  ds_read_b128 v[60:63], v75 offset:4096
  ds_read_b128 v[64:67], v75 offset:5120
  s_waitcnt lgkmcnt(0)
  v_smfmac_f32_16x16x64_bf16 v[20:23], v[16:19], v[60:67], v74
  ds_read_b128 v[60:63], v75 offset:6144
  ds_read_b128 v[64:67], v75 offset:7168
  s_waitcnt lgkmcnt(0)
  v_smfmac_f32_16x16x64_bf16 v[24:27], v[16:19], v[60:67], v74
  v_smfmac_f32_16x16x64_bf16 v[28:31], v[16:19], v[240:247], v74
  v_smfmac_f32_16x16x64_bf16 v[32:35], v[16:19], v[248:255], v74
  ds_read_b128 v[4:7], v76 offset:11776
  s_waitcnt lgkmcnt(0)
  v_smfmac_f32_16x16x64_bf16 v[20:23], v[4:7], v[176:183], v74
  v_smfmac_f32_16x16x64_bf16 v[24:27], v[4:7], v[184:191], v74
  v_smfmac_f32_16x16x64_bf16 v[28:31], v[4:7], a[0:7], v74
  v_smfmac_f32_16x16x64_bf16 v[32:35], v[4:7], a[8:15], v74
  ds_read_b128 v[12:15], v76 offset:12800
  s_waitcnt lgkmcnt(0)
  v_smfmac_f32_16x16x64_bf16 v[20:23], v[12:15], v[192:199], v74
  v_smfmac_f32_16x16x64_bf16 v[24:27], v[12:15], v[200:207], v74
  v_smfmac_f32_16x16x64_bf16 v[28:31], v[12:15], a[16:23], v74
  v_smfmac_f32_16x16x64_bf16 v[32:35], v[12:15], a[24:31], v74
  v_add_f32 v20, v20, v22
  v_add_f32 v21, v21, v23
  v_add_f32 v24, v24, v26
  v_cvt_pk_bf16_f32 v22, v20, v24
  ds_write_b32 v79, v22 offset:0
  v_add_f32 v25, v25, v27
  v_cvt_pk_bf16_f32 v23, v21, v25
  ds_write_b32 v79, v23 offset:576
  v_add_f32 v28, v28, v30
  v_add_f32 v29, v29, v31
  s_waitcnt lgkmcnt(0)
  s_nop 1
  s_branch Cf1_recok
Cf1_mx:
  s_waitcnt lgkmcnt(0)
  s_barrier
  buffer_load_dwordx4 v[0:3], v76, s[8:11], s58 offen offset:0 sc1
  ds_read_b128 v[20:23], v77 offset:0
  ds_read_b128 v[28:31], v77 offset:256
  buffer_load_dwordx4 v[4:7], v76, s[8:11], s58 offen offset:1024 sc1
  ds_read_b128 v[24:27], v77 offset:128
  ds_read_b128 v[32:35], v77 offset:384
  s_waitcnt vmcnt(1) lgkmcnt(3)
  v_mfma_f32_16x16x32_bf16 v[8:11], v[0:3], v[20:23], 0
  s_waitcnt vmcnt(0) lgkmcnt(1)
  v_mfma_f32_16x16x32_bf16 v[8:11], v[4:7], v[24:27], v[8:11]
  v_mfma_f32_16x16x32_bf16 v[12:15], v[28:31], v[20:23], 0
  s_waitcnt lgkmcnt(0)
  v_mfma_f32_16x16x32_bf16 v[12:15], v[32:35], v[24:27], v[12:15]
  v_add_f32_dpp v8, v10, v8 quad_perm:[2,3,0,1] row_mask:0xf bank_mask:0xf
  v_add_f32_dpp v9, v11, v9 quad_perm:[2,3,0,1] row_mask:0xf bank_mask:0xf
  s_nop 0
  v_mov_b32_dpp v8, v8 quad_perm:[0,1,0,1] row_mask:0xf bank_mask:0xf
  v_mov_b32_dpp v9, v9 quad_perm:[0,1,0,1] row_mask:0xf bank_mask:0xf
  s_nop 1
  v_add_f32_dpp v12, v14, v12 quad_perm:[2,3,0,1] row_mask:0xf bank_mask:0xf
  v_add_f32_dpp v13, v15, v13 quad_perm:[2,3,0,1] row_mask:0xf bank_mask:0xf
  s_nop 0
  v_mov_b32_dpp v12, v12 quad_perm:[0,1,0,1] row_mask:0xf bank_mask:0xf
  v_mov_b32_dpp v13, v13 quad_perm:[0,1,0,1] row_mask:0xf bank_mask:0xf
  v_mul_f32 v12, s69, v12
  ds_write_b32 v78, v8 offset:8708
  v_mul_f32 v13, s69, v13
  ds_write_b32 v78, v9 offset:8772
  s_waitcnt lgkmcnt(0)
  s_barrier
  ds_read_b128 v[36:39], v78 offset:8704
  ds_read_b128 v[40:43], v78 offset:8768
  s_waitcnt lgkmcnt(0)
  s_barrier
  v_max_f32 v16, v36, v37
  v_max3_f32 v16, v16, v38, v39
  v_max3_f32 v16, v16, v40, v41
  v_max3_f32 v16, v16, v42, v43
  v_max3_f32 v16, v16, v12, v13
  v_mov_b32 v17, v16
  s_nop 1
  v_permlane16_swap_b32 v16, v17
  v_max_f32 v16, v16, v17
  v_mov_b32 v17, v16
  s_nop 1
  v_permlane32_swap_b32 v16, v17
  v_max_f32 v16, v16, v17
  v_sub_f32 v36, v36, v16
  v_sub_f32 v37, v37, v16
  v_sub_f32 v38, v38, v16
  v_sub_f32 v39, v39, v16
  v_sub_f32 v40, v40, v16
  v_sub_f32 v41, v41, v16
  v_sub_f32 v42, v42, v16
  v_sub_f32 v43, v43, v16
  v_sub_f32 v12, v12, v16
  v_sub_f32 v13, v13, v16
  v_exp_f32 v36, v36
  v_exp_f32 v37, v37
  v_exp_f32 v38, v38
  v_exp_f32 v39, v39
  v_exp_f32 v40, v40
  v_exp_f32 v41, v41
  v_exp_f32 v42, v42
  v_exp_f32 v43, v43
  v_exp_f32 v12, v12
  v_exp_f32 v13, v13
  v_cvt_pk_bf16_f32 v32, v36, v40
  v_cvt_pk_bf16_f32 v33, v37, v41
  v_cvt_pk_bf16_f32 v34, v38, v42
  v_cvt_pk_bf16_f32 v35, v39, v43
  v_cvt_pk_bf16_f32 v28, v12, v13
  v_cvt_pk_bf16_f32 v31, v12, v13
  v_mov_b32 v29, 0
  v_mov_b32 v30, 0
  v_mov_b32 v68, 0x3f803f80
  v_mov_b32 v69, 0x3f803f80
  v_mov_b32 v70, 0x3f803f80
  v_mov_b32 v71, 0x3f803f80
  s_nop 1
  v_mfma_f32_16x16x32_bf16 v[8:11], v[32:35], v[68:71], 0
  v_mfma_f32_16x16x32_bf16 v[0:3], v[32:35], v[52:55], 0
  v_mfma_f32_16x16x32_bf16 v[4:7], v[32:35], v[56:59], 0
  v_mfma_f32_16x16x16_bf16 v[8:11], v[28:29], v[68:69], v[8:11]
  v_mfma_f32_16x16x16_bf16 v[0:3], v[28:29], v[72:73], v[0:3]
  v_mfma_f32_16x16x16_bf16 v[4:7], v[30:31], v[72:73], v[4:7]
  ds_read_b128 v[68:71], v76 offset:13824
  v_rcp_f32 v10, v8
  v_rcp_f32 v11, v9
  v_mul_f32 v0, v10, v0
  v_mul_f32 v1, v11, v1
  s_nop 0
  v_mul_f32 v4, v10, v4
  v_mul_f32 v5, v11, v5
  v_cvt_pk_bf16_f32 v2, v0, v4
  ds_write_b32 v79, v2 offset:8704
  v_cvt_pk_bf16_f32 v3, v1, v5
  ds_write_b32 v79, v3 offset:9280
  v_mov_b64 v[16:17], 0
  v_mov_b64 v[18:19], 0
  v_mov_b64 v[20:21], 0
  v_mov_b64 v[22:23], 0
  v_mov_b64 v[24:25], 0
  v_mov_b64 v[26:27], 0
  s_branch Cf1_mxok
Cf1_last:
  ds_read_b128 v[4:7], v76 offset:5632
  ds_read_b128 v[12:15], v76 offset:7680
  ds_read_b128 v[44:47], v76 offset:36864
  ds_read_b128 v[48:51], v76 offset:37888
  s_nop 5
  v_mov_b64 v[20:21], 0
  v_mov_b64 v[22:23], 0
  v_mov_b64 v[24:25], 0
  v_mov_b64 v[26:27], 0
  s_waitcnt lgkmcnt(4)
  v_smfmac_f32_16x16x64_bf16 v[28:31], v[0:3], v[36:43], v74
  ds_read_b128 v[36:39], v76 offset:38912
  ds_read_b128 v[40:43], v76 offset:39936
  v_smfmac_f32_16x16x64_bf16 v[32:35], v[0:3], v[60:67], v74
  s_waitcnt lgkmcnt(5)
  v_smfmac_f32_16x16x64_bf16 v[20:23], v[0:3], a[32:39], v74
  ds_read_b128 v[60:63], v76 offset:53248
  ds_read_b128 v[64:67], v76 offset:54272
  v_smfmac_f32_16x16x64_bf16 v[24:27], v[0:3], a[40:47], v74
  s_waitcnt lgkmcnt(4)
  v_smfmac_f32_16x16x64_bf16 v[20:23], v[4:7], a[48:55], v74
  buffer_store_dwordx4 v[16:19], v76, s[8:11], s68 offen sc1
  v_smfmac_f32_16x16x64_bf16 v[24:27], v[4:7], a[56:63], v74
  v_smfmac_f32_16x16x64_bf16 v[28:31], v[4:7], v[44:51], v74
  s_waitcnt lgkmcnt(2)
  v_smfmac_f32_16x16x64_bf16 v[20:23], v[8:11], a[64:71], v74
  ds_read_b128 v[44:47], v76 offset:55296
  ds_read_b128 v[48:51], v76 offset:56320
  v_smfmac_f32_16x16x64_bf16 v[24:27], v[8:11], a[72:79], v74
  v_smfmac_f32_16x16x64_bf16 v[32:35], v[4:7], v[36:43], v74
  v_smfmac_f32_16x16x64_bf16 v[28:31], v[8:11], v[208:215], v74
  ds_read_b128 v[36:39], v75 offset:20480
  ds_read_b128 v[40:43], v75 offset:21504
  v_smfmac_f32_16x16x64_bf16 v[32:35], v[8:11], v[216:223], v74
  v_smfmac_f32_16x16x64_bf16 v[20:23], v[12:15], a[80:87], v74
  v_smfmac_f32_16x16x64_bf16 v[24:27], v[12:15], a[88:95], v74
  v_smfmac_f32_16x16x64_bf16 v[28:31], v[12:15], v[224:231], v74
  v_smfmac_f32_16x16x64_bf16 v[32:35], v[12:15], v[232:239], v74
  s_waitcnt vmcnt(2)
  s_waitcnt vmcnt(1)
  s_barrier
Cf1_lastr:
  ds_read_b128 v[8:11], v76 offset:8704
  ds_read_b128 v[0:3], v76 offset:9728
  ds_read_b128 v[16:19], v76 offset:10752
  ds_read_b128 v[4:7], v76 offset:11776
  ds_read_b128 v[12:15], v76 offset:12800
  s_waitcnt lgkmcnt(3)
  v_max3_u32 v72, v0, v1, v2
  s_waitcnt lgkmcnt(1)
  v_max3_u32 v72, v72, v3, v4
  v_max3_u32 v72, v72, v5, v6
  v_max3_u32 v72, v72, v7, v8
  v_max3_u32 v72, v72, v9, v10
  s_waitcnt lgkmcnt(0)
  v_max3_u32 v72, v72, v11, v12
  v_max3_u32 v72, v72, v13, v14
  v_max3_u32 v72, v72, v15, v16
  v_max3_u32 v72, v72, v17, v18
  v_max_u32 v72, v72, v19
  v_cmp_eq_u32 vcc, -1, v72
  s_cbranch_vccnz Cf1_lastp
Cf1_lastg:
  v_smfmac_f32_16x16x64_bf16 v[28:31], v[8:11], v[60:67], v74
  ds_read_b128 v[60:63], v75 offset:22528
  ds_read_b128 v[64:67], v75 offset:23552
  v_smfmac_f32_16x16x64_bf16 v[32:35], v[8:11], v[44:51], v74
  v_smfmac_f32_16x16x64_bf16 v[28:31], v[0:3], v[36:43], v74
  v_smfmac_f32_16x16x64_bf16 v[28:31], v[16:19], v[240:247], v74
  v_smfmac_f32_16x16x64_bf16 v[28:31], v[4:7], a[0:7], v74
  v_smfmac_f32_16x16x64_bf16 v[28:31], v[12:15], a[16:23], v74
  v_smfmac_f32_16x16x64_bf16 v[32:35], v[16:19], v[248:255], v74
  v_smfmac_f32_16x16x64_bf16 v[32:35], v[4:7], a[8:15], v74
  s_waitcnt lgkmcnt(0)
  v_smfmac_f32_16x16x64_bf16 v[32:35], v[12:15], a[24:31], v74
  v_smfmac_f32_16x16x64_bf16 v[32:35], v[0:3], v[60:67], v74
  v_smfmac_f32_16x16x64_bf16 v[20:23], v[8:11], a[96:103], v74
  v_smfmac_f32_16x16x64_bf16 v[20:23], v[0:3], a[112:119], v74
  v_add_f32 v28, v28, v30
  v_add_f32 v32, v32, v34
  v_cvt_pk_bf16_f32 v30, v28, v32
  v_smfmac_f32_16x16x64_bf16 v[20:23], v[16:19], a[128:135], v74
  ds_write_b32 v79, v30 offset:256
  v_add_f32 v29, v29, v31
  v_add_f32 v33, v33, v35
  v_cvt_pk_bf16_f32 v31, v29, v33
  v_smfmac_f32_16x16x64_bf16 v[20:23], v[4:7], a[144:151], v74
  ds_write_b32 v79, v31 offset:832
  v_smfmac_f32_16x16x64_bf16 v[20:23], v[12:15], a[160:167], v74
  v_smfmac_f32_16x16x64_bf16 v[24:27], v[8:11], a[104:111], v74
  v_smfmac_f32_16x16x64_bf16 v[24:27], v[0:3], a[120:127], v74
  v_smfmac_f32_16x16x64_bf16 v[24:27], v[16:19], a[136:143], v74
  s_waitcnt lgkmcnt(0)
  s_barrier
  ds_read_b64 v[52:53], v77 offset:264
  v_add_f32 v20, v20, v22
  v_smfmac_f32_16x16x64_bf16 v[24:27], v[4:7], a[152:159], v74
  v_add_f32 v21, v21, v23
  v_smfmac_f32_16x16x64_bf16 v[24:27], v[12:15], a[168:175], v74
  v_cvt_pk_bf16_f32 v54, v20, v21
  s_add_u32 s68, s68, 655360
  s_nop 3
  v_add_f32 v24, v24, v26
  v_add_f32 v25, v25, v27
  v_cvt_pk_bf16_f32 v55, v24, v25
  s_waitcnt lgkmcnt(0)
  buffer_store_dwordx4 v[52:55], v76, s[8:11], s68 offen sc1
  s_branch Cf1_done
Cf1_lastp:
  s_add_u32 s72, s72, 2
  s_cmp_ge_u32 s72, 131072
  s_cbranch_scc1 Cf1_lastg
  s_barrier
  buffer_load_dwordx4 v76, s[8:11], s85 offen offset:0 sc1 lds
  s_waitcnt vmcnt(0)
  s_barrier
  s_branch Cf1_lastr
Cf1_done:
  s_branch L_cexit
L_w2:
  v_mov_b64 v[20:21], 0
  v_mov_b64 v[22:23], 0
  v_mov_b64 v[24:25], 0
  v_mov_b64 v[26:27], 0
  v_mov_b64 v[28:29], 0
  v_mov_b64 v[30:31], 0
  v_mov_b64 v[32:33], 0
  v_mov_b64 v[34:35], 0
  s_mov_b32 s78, 0x3f803f80
  s_mov_b32 s79, s78
  s_mov_b32 s65, 360448
  s_mov_b32 m0, 15872
  s_lshl_b32 s71, s53, 2
  s_add_u32 s71, s71, 128
  s_movk_i32 s56, 0x1000
  v_lshlrev_b32 v73, 2, v76
  v_mov_b32 v72, 0
  s_mov_b64 s[16:17], s[8:9]
  s_mov_b32 s18, 268435456
  s_mov_b32 s19, 0x20000
  s_getpc_b64 s[20:21]
Cf2_pc:
  s_add_u32 s20, s20, (Cf2_last - Cf2_pc)
  s_addc_u32 s21, s21, 0
  v_mov_b32 v68, 14880
  buffer_load_dwordx4 v[52:55], v76, s[8:11], s59 offen offset:0 sc1
  buffer_load_dwordx4 v[56:59], v76, s[8:11], s59 offen offset:1024 sc1
  ds_read_b128 v[36:39], v76 offset:24576
  ds_read_b128 v[40:43], v76 offset:25600
  ds_read_b128 v[60:63], v76 offset:26624
  ds_read_b128 v[64:67], v76 offset:27648
  ds_read_b128 v[0:3], v76 offset:4608
  ds_read_b128 v[4:7], v76 offset:5632
  ds_read_b128 v[8:11], v76 offset:6656
  ds_read_b128 v[12:15], v76 offset:7680
  s_waitcnt lgkmcnt(0)
  s_cmp_eq_u32 s66, 1
  s_branch Cf2_top2
.p2align 6
Cf2_h2:
  s_cmp_eq_u32 s66, 62
  s_cselect_b64 s[16:17], s[20:21], s[16:17]
  s_cselect_b32 s18, (Cf2_done - Cf2_last), s18
  s_cselect_b32 s70, 0, s70
  s_cmp_eq_u32 s66, 63
  s_cselect_b32 s59, 268435456, s59
  s_cselect_b32 s58, 268435456, s58
  buffer_load_dwordx4 v[12:15], v76, s[8:11], s65 offen offset:3072 sc1
  ds_read_b128 v[36:39], v76 offset:24576
  s_waitcnt lgkmcnt(0)
  v_mov_b64 v[28:29], 0
  v_mov_b64 v[30:31], 0
  v_mov_b64 v[32:33], 0
  v_mov_b64 v[34:35], 0
  v_lshlrev_b32 v73, 2, v76
  buffer_load_dwordx4 v[12:15], v76, s[8:11], s65 offen offset:3072 sc1
  ds_read_b128 v[40:43], v76 offset:25600
  s_waitcnt lgkmcnt(0)
  v_mov_b64 v[20:21], 0
  v_mov_b64 v[22:23], 0
  v_mov_b64 v[24:25], 0
  v_mov_b64 v[26:27], 0
  v_mov_b32 v68, 14880
  buffer_load_dwordx4 v[12:15], v76, s[8:11], s65 offen offset:3072 sc1
  buffer_load_dwordx4 v[52:55], v76, s[8:11], s59 offen offset:0 sc1
  buffer_load_dwordx4 v[56:59], v76, s[8:11], s59 offen offset:1024 sc1
  s_waitcnt vmcnt(4)
  v_max3_u32 v72, v12, v13, v14
  v_max_u32 v72, v72, v15
  ds_write_b128 v76, v[12:15] offset:7680
  v_cmp_eq_u32 vcc, -1, v72
  s_cbranch_vccnz Cf2_h2r
Cf2_h2w:
  s_cmp_eq_u32 s66, 63
  s_waitcnt lgkmcnt(0)
  s_barrier
  ds_read_b128 v[0:3], v76 offset:4608
  buffer_load_dwordx4 v76, s[8:11], s85 offen offset:0 sc1 lds
Cf2_top2:
  v_smfmac_f32_16x16x64_bf16 v[20:23], v[12:15], v[128:135], v74
  s_cbranch_scc1 Cf2_last
  v_smfmac_f32_16x16x64_bf16 v[24:27], v[12:15], v[136:143], v74
  buffer_load_dwordx4 v[44:47], v76, s[8:11], s58 offen offset:0 sc1
  s_mov_b32 m0, 15872
  v_smfmac_f32_16x16x64_bf16 v[28:31], v[12:15], v[224:231], v74
  buffer_load_dwordx4 v[48:51], v76, s[8:11], s58 offen offset:1024 sc1
  v_smfmac_f32_16x16x64_bf16 v[32:35], v[12:15], v[232:239], v74
  ds_read_b128 v[4:7], v76 offset:5632
  s_waitcnt lgkmcnt(1)
  v_smfmac_f32_16x16x64_bf16 v[20:23], v[0:3], v[80:87], v74
  ds_read_b128 v[8:11], v76 offset:6656
  v_smfmac_f32_16x16x64_bf16 v[28:31], v[0:3], v[36:43], v74
  ds_read_b128 v[36:39], v76 offset:40960
  v_smfmac_f32_16x16x64_bf16 v[24:27], v[0:3], v[88:95], v74
  buffer_store_dwordx4 v[16:19], v76, s[8:11], s68 offen sc1
  ds_read_b128 v[40:43], v76 offset:41984
  v_smfmac_f32_16x16x64_bf16 v[32:35], v[0:3], v[60:67], v74
  ds_read_b128 v[60:63], v76 offset:43008
  s_waitcnt lgkmcnt(4)
  v_smfmac_f32_16x16x64_bf16 v[20:23], v[4:7], v[96:103], v74
  ds_read_b128 v[64:67], v76 offset:44032
  v_smfmac_f32_16x16x64_bf16 v[24:27], v[4:7], v[104:111], v74
  buffer_load_dword v73, s[16:19], s70 offen lds
  s_waitcnt vmcnt(5)
  s_waitcnt lgkmcnt(4)
  v_smfmac_f32_16x16x64_bf16 v[20:23], v[8:11], v[112:119], v74
  s_barrier
  s_waitcnt lgkmcnt(2)
  v_smfmac_f32_16x16x64_bf16 v[28:31], v[4:7], v[36:43], v74
  ds_read_b128 v[12:15], v76 offset:8704
  v_smfmac_f32_16x16x64_bf16 v[24:27], v[8:11], v[120:127], v74
  ds_read_b128 v[36:39], v76 offset:57344
  s_waitcnt lgkmcnt(2)
  v_smfmac_f32_16x16x64_bf16 v[32:35], v[4:7], v[60:67], v74
  ds_read_b128 v[40:43], v76 offset:58368
  v_smfmac_f32_16x16x64_bf16 v[28:31], v[8:11], v[208:215], v74
  ds_read_b128 v[60:63], v76 offset:59392
  v_smfmac_f32_16x16x64_bf16 v[32:35], v[8:11], v[216:223], v74
  ds_read_b128 v[64:67], v76 offset:60416
  s_waitcnt lgkmcnt(4)
  v_smfmac_f32_16x16x64_bf16 v[20:23], v[12:15], v[144:151], v74
  s_waitcnt vmcnt(4)
  ds_read_b128 v[0:3], v76 offset:9728
  s_waitcnt lgkmcnt(3)
  v_smfmac_f32_16x16x64_bf16 v[28:31], v[12:15], v[36:43], v74
  s_barrier
  ds_read_b128 v[4:7], v76 offset:11776
  v_smfmac_f32_16x16x64_bf16 v[24:27], v[12:15], v[152:159], v74
  ds_read_b128 v[36:39], v75 offset:8192
  ds_read_b128 v[40:43], v75 offset:9216
  s_waitcnt lgkmcnt(4)
  v_smfmac_f32_16x16x64_bf16 v[32:35], v[12:15], v[60:67], v74
  ds_read_b128 v[16:19], v76 offset:10752
  s_waitcnt lgkmcnt(4)
  v_smfmac_f32_16x16x64_bf16 v[20:23], v[0:3], v[160:167], v74
  ds_read_b128 v[8:11], v76 offset:12800
  v_smfmac_f32_16x16x64_bf16 v[24:27], v[0:3], v[168:175], v74
  ds_read_b128 v[60:63], v75 offset:10240
  ds_read_b128 v[64:67], v75 offset:11264
  s_waitcnt lgkmcnt(6)
  v_smfmac_f32_16x16x64_bf16 v[20:23], v[4:7], v[176:183], v74
  s_waitcnt lgkmcnt(3)
  v_smfmac_f32_16x16x64_bf16 v[20:23], v[16:19], v[36:43], v74
  ds_read_b128 v[36:39], v75 offset:24576
  s_waitcnt lgkmcnt(3)
  v_smfmac_f32_16x16x64_bf16 v[20:23], v[8:11], v[192:199], v74
  ds_read_b128 v[40:43], v75 offset:25600
  s_waitcnt lgkmcnt(2)
  v_smfmac_f32_16x16x64_bf16 v[24:27], v[16:19], v[60:67], v74
  ds_read_b128 v[60:63], v75 offset:26624
  v_smfmac_f32_16x16x64_bf16 v[24:27], v[4:7], v[184:191], v74
  ds_read_b128 v[64:67], v75 offset:27648
  v_add_f32 v20, v20, v22
  v_smfmac_f32_16x16x64_bf16 v[24:27], v[8:11], v[200:207], v74
  v_add_f32 v21, v21, v23
  v_smfmac_f32_16x16x64_bf16 v[28:31], v[16:19], v[240:247], v74
  s_waitcnt lgkmcnt(2)
  v_mov_b64 v[70:71], s[78:79]
  v_smfmac_f32_16x16x64_bf16 v[28:31], v[0:3], v[36:43], v74
  ds_read_b128 v[36:39], v68
  v_add_f32 v24, v24, v26
  v_smfmac_f32_16x16x64_bf16 v[28:31], v[4:7], a[0:7], v74
  ds_read_b128 v[40:43], v68
  v_cvt_pk_bf16_f32 v22, v20, v24
  v_smfmac_f32_16x16x64_bf16 v[28:31], v[8:11], a[16:23], v74
  ds_write_b32 v79, v22 offset:0
  s_waitcnt lgkmcnt(3)
  v_add_f32 v25, v25, v27
  v_cvt_pk_bf16_f32 v23, v21, v25
  v_smfmac_f32_16x16x64_bf16 v[32:35], v[0:3], v[60:67], v74
  ds_write_b32 v79, v23 offset:576
  v_cmp_u_f32 vcc, v20, v21
  v_smfmac_f32_16x16x64_bf16 v[32:35], v[16:19], v[248:255], v74
  v_add_f32 v28, v28, v30
  v_smfmac_f32_16x16x64_bf16 v[32:35], v[4:7], a[8:15], v74
  v_add_f32 v29, v29, v31
  v_smfmac_f32_16x16x64_bf16 v[32:35], v[8:11], a[24:31], v74
  s_cbranch_vccnz Cf2_rec
Cf2_recok:
  s_waitcnt lgkmcnt(3)
  v_smfmac_f32_16x16x64_bf16 v[36:39], v[16:19], a[128:135], v74
  s_waitcnt lgkmcnt(0)
  s_barrier
  ds_read_b128 v[60:63], v77
  v_smfmac_f32_16x16x64_bf16 v[40:43], v[16:19], a[136:143], v74
  ds_read_b128 v[64:67], v77 offset:128
  v_add_f32 v32, v32, v34
  v_cvt_pk_bf16_f32 v30, v28, v32
  v_smfmac_f32_16x16x64_bf16 v[36:39], v[0:3], a[112:119], v74
  ds_write_b32 v79, v30 offset:256
  v_add_f32 v33, v33, v35
  v_cvt_pk_bf16_f32 v31, v29, v33
  v_smfmac_f32_16x16x64_bf16 v[40:43], v[0:3], a[120:127], v74
  ds_write_b32 v79, v31 offset:832
  v_xor_b32 v75, 0x8000, v75
  v_smfmac_f32_16x16x64_bf16 v[36:39], v[4:7], a[144:151], v74
  ds_read_b128 v[0:3], v76 offset:4608
  v_mov_b32 v29, 0
  v_smfmac_f32_16x16x64_bf16 v[40:43], v[4:7], a[152:159], v74
  s_waitcnt vmcnt(2) lgkmcnt(3)
  v_mov_b32 v30, 0
  v_mfma_f32_16x16x32_bf16 v[44:47], v[44:47], v[60:63], 0
  ds_read_b128 v[4:7], v76 offset:5632
  s_waitcnt lgkmcnt(2)
  v_mfma_f32_16x16x32_bf16 v[44:47], v[48:51], v[64:67], v[44:47]
  s_barrier
  v_smfmac_f32_16x16x64_bf16 v[36:39], v[8:11], a[160:167], v74
  ds_read_b128 v[20:23], v77 offset:256
  ds_read_b128 v[24:27], v77 offset:384
  v_smfmac_f32_16x16x64_bf16 v[40:43], v[8:11], a[168:175], v74
  ds_read_b128 v[8:11], v76 offset:6656
  v_add_f32_dpp v72, v46, v44 quad_perm:[2,3,0,1] row_mask:0xf bank_mask:0xf
  v_add_f32_dpp v73, v47, v45 quad_perm:[2,3,0,1] row_mask:0xf bank_mask:0xf
  v_smfmac_f32_16x16x64_bf16 v[36:39], v[12:15], a[96:103], v74
  s_waitcnt lgkmcnt(4)
  v_exp_f32_dpp v72, v72 quad_perm:[0,1,0,1] row_mask:0xf bank_mask:0xf
  v_smfmac_f32_16x16x64_bf16 v[40:43], v[12:15], a[104:111], v74
  ds_read_b128 v[12:15], v76 offset:7680
  v_exp_f32_dpp v73, v73 quad_perm:[0,1,0,1] row_mask:0xf bank_mask:0xf
  v_smfmac_f32_16x16x64_bf16 v[36:39], v[0:3], a[32:39], v74
  s_waitcnt lgkmcnt(2)
  v_cvt_pk_bf16_f32 v72, v72, v73
  v_mfma_f32_16x16x32_bf16 v[20:23], v[20:23], v[60:63], 0
  ds_write_b32 v78, v72 offset:520
  v_mov_b64 v[16:17], 0
  v_mfma_f32_16x16x32_bf16 v[20:23], v[24:27], v[64:67], v[20:23]
  ds_read_b128 v[44:47], v75 offset:24576
  v_mov_b64 v[18:19], 0
  v_smfmac_f32_16x16x64_bf16 v[40:43], v[0:3], a[40:47], v74
  ds_read_b128 v[48:51], v75 offset:25600
  v_mov_b64 v[68:69], s[78:79]
  v_smfmac_f32_16x16x64_bf16 v[36:39], v[4:7], a[48:55], v74
  s_waitcnt lgkmcnt(4)
  v_add_f32_dpp v24, v22, v20 quad_perm:[2,3,0,1] row_mask:0xf bank_mask:0xf
  v_add_f32_dpp v25, v23, v21 quad_perm:[2,3,0,1] row_mask:0xf bank_mask:0xf
  v_smfmac_f32_16x16x64_bf16 v[36:39], v[8:11], a[64:71], v74
  s_waitcnt lgkmcnt(2)
  s_barrier
  ds_read_b128 v[32:35], v78 offset:512
  v_smfmac_f32_16x16x64_bf16 v[36:39], v[12:15], a[80:87], v74
  ds_read_b128 v[60:63], v75 offset:26624
  v_mul_f32 v24, s69, v24
  v_smfmac_f32_16x16x64_bf16 v[40:43], v[4:7], a[56:63], v74
  ds_read_b128 v[64:67], v75 offset:27648
  v_mul_f32 v25, s69, v25
  v_smfmac_f32_16x16x64_bf16 v[40:43], v[8:11], a[72:79], v74
  v_exp_f32_dpp v24, v24 quad_perm:[0,1,0,1] row_mask:0xf bank_mask:0xf
  v_smfmac_f32_16x16x64_bf16 v[40:43], v[12:15], a[88:95], v74
  s_waitcnt lgkmcnt(2)
  v_exp_f32_dpp v25, v25 quad_perm:[0,1,0,1] row_mask:0xf bank_mask:0xf
  v_mfma_f32_16x16x32_bf16 v[8:11], v[32:35], v[68:71], 0
  v_add_f32 v36, v36, v38
  v_add_f32 v37, v37, v39
  v_mfma_f32_16x16x32_bf16 v[0:3], v[32:35], v[52:55], 0
  v_add_f32 v40, v40, v42
  v_add_f32 v41, v41, v43
  v_mfma_f32_16x16x32_bf16 v[4:7], v[32:35], v[56:59], 0
  v_cvt_pk_bf16_f32 v28, v24, v25
  v_cvt_pk_bf16_f32 v72, v36, v37
  v_cvt_pk_bf16_f32 v73, v40, v41
  v_mfma_f32_16x16x16_bf16 v[8:11], v[28:29], v[68:69], v[8:11]
  v_cvt_pk_bf16_f32 v31, v24, v25
  v_mov_b64 v[20:21], 0
  v_mfma_f32_16x16x16_bf16 v[0:3], v[28:29], v[72:73], v[0:3]
  ds_read_b128 v[68:71], v76 offset:13824
  v_mov_b64 v[22:23], 0
  v_mfma_f32_16x16x16_bf16 v[4:7], v[30:31], v[72:73], v[4:7]
  v_rcp_f32 v10, v8
  v_rcp_f32 v11, v9
  v_mul_f32 v0, v10, v0
  v_mul_f32 v1, v11, v1
  s_nop 0
  v_mul_f32 v4, v10, v4
  v_mul_f32 v5, v11, v5
  v_cvt_pk_bf16_f32 v2, v0, v4
  ds_write_b32 v79, v2 offset:8704
  v_cvt_pk_bf16_f32 v3, v1, v5
  ds_write_b32 v79, v3 offset:9280
  v_max3_f32 v8, v8, v9, v10
  v_max_f32 v8, v8, v11
  v_cmp_le_f32 vcc, 1317011456, v8
  v_mov_b64 v[24:25], 0
  v_mov_b64 v[26:27], 0
  s_cbranch_vccnz Cf2_mx
Cf2_mxok:
  s_waitcnt lgkmcnt(0)
  s_barrier
  ds_read_b128 v[0:3], v78 offset:8704
  ds_read_b128 v[4:7], v78 offset:8768
  ds_read_b128 v[8:11], v78 offset:8832
  ds_read_b128 v[12:15], v78 offset:8896
  s_waitcnt lgkmcnt(3)
  v_smfmac_f32_16x16x64_bf16 v[16:19], v[0:3], v[44:51], v74
  ds_read_b128 v[52:55], v75 offset:40960
  s_waitcnt lgkmcnt(3)
  v_smfmac_f32_16x16x64_bf16 v[16:19], v[4:7], v[60:67], v74
  ds_read_b128 v[56:59], v75 offset:41984
  s_waitcnt lgkmcnt(3)
  v_smfmac_f32_16x16x64_bf16 v[16:19], v[8:11], a[176:183], v74
  ds_read_b128 v[36:39], v75 offset:43008
  s_waitcnt lgkmcnt(3)
  v_smfmac_f32_16x16x64_bf16 v[16:19], v[12:15], a[184:191], v74
  ds_read_b128 v[40:43], v75 offset:44032
  ds_read_b128 v[44:47], v75 offset:57344
  v_smfmac_f32_16x16x64_bf16 v[20:23], v[0:3], a[192:199], v74
  ds_read_b128 v[48:51], v75 offset:58368
  ds_read_b128 v[60:63], v75 offset:59392
  v_smfmac_f32_16x16x64_bf16 v[20:23], v[4:7], a[200:207], v74
  ds_read_b128 v[64:67], v75 offset:60416
  s_waitcnt lgkmcnt(6)
  v_cvt_pk_bf16_f32 v16, v16, v17
  v_cvt_pk_bf16_f32 v17, v18, v19
  v_bfi_b32 v16, 1, s72, v16
  v_smfmac_f32_16x16x64_bf16 v[20:23], v[8:11], v[52:59], v74
  buffer_store_dwordx2 v[16:17], v68, s[8:11], s73 offen
  s_waitcnt lgkmcnt(4)
  v_smfmac_f32_16x16x64_bf16 v[20:23], v[12:15], v[36:43], v74
  ds_read_b128 v[52:55], v75 offset:0
  v_mov_b64 v[32:33], 0
  v_smfmac_f32_16x16x64_bf16 v[24:27], v[0:3], a[208:215], v74
  ds_read_b128 v[56:59], v75 offset:1024
  v_mov_b64 v[34:35], 0
  v_smfmac_f32_16x16x64_bf16 v[24:27], v[4:7], a[216:223], v74
  ds_read_b128 v[36:39], v75 offset:2048
  s_waitcnt lgkmcnt(5)
  v_cvt_pk_bf16_f32 v20, v20, v21
  v_cvt_pk_bf16_f32 v21, v22, v23
  v_bfi_b32 v20, 1, s72, v20
  v_smfmac_f32_16x16x64_bf16 v[24:27], v[8:11], v[44:51], v74
  buffer_store_dwordx2 v[20:21], v68, s[8:11], s74 offen
  s_waitcnt lgkmcnt(3)
  v_smfmac_f32_16x16x64_bf16 v[24:27], v[12:15], v[60:67], v74
  ds_read_b128 v[40:43], v75 offset:3072
  v_mov_b64 v[28:29], 0
  v_smfmac_f32_16x16x64_bf16 v[32:35], v[0:3], a[224:231], v74
  ds_read_b128 v[44:47], v75 offset:4096
  ds_read_b128 v[48:51], v75 offset:5120
  v_smfmac_f32_16x16x64_bf16 v[32:35], v[4:7], a[232:239], v74
  ds_read_b128 v[60:63], v75 offset:6144
  v_cvt_pk_bf16_f32 v24, v24, v25
  v_cvt_pk_bf16_f32 v25, v26, v27
  v_bfi_b32 v24, 1, s72, v24
  v_smfmac_f32_16x16x64_bf16 v[32:35], v[8:11], a[240:247], v74
  buffer_store_dwordx2 v[24:25], v68, s[8:11], s75 offen
  v_mov_b64 v[30:31], 0
  v_smfmac_f32_16x16x64_bf16 v[32:35], v[12:15], a[248:255], v74
  ds_read_b128 v[64:67], v75 offset:7168
  s_waitcnt lgkmcnt(6)
  v_smfmac_f32_16x16x64_bf16 v[28:31], v[0:3], v[52:59], v74
  s_waitcnt lgkmcnt(4)
  v_smfmac_f32_16x16x64_bf16 v[28:31], v[4:7], v[36:43], v74
  s_waitcnt lgkmcnt(2)
  v_cvt_pk_bf16_f32 v32, v32, v33
  v_cvt_pk_bf16_f32 v33, v34, v35
  v_bfi_b32 v32, 1, s72, v32
  v_smfmac_f32_16x16x64_bf16 v[28:31], v[8:11], v[44:51], v74
  buffer_store_dwordx2 v[32:33], v68, s[8:11], s76 offen
  s_waitcnt lgkmcnt(0)
  v_smfmac_f32_16x16x64_bf16 v[28:31], v[12:15], v[60:67], v74
  v_mov_b64 v[18:19], v[72:73]
  s_nop 4
  v_cvt_pk_bf16_f32 v28, v28, v29
  v_cvt_pk_bf16_f32 v29, v30, v31
  v_bfi_b32 v28, 1, s72, v28
  buffer_store_dwordx2 v[28:29], v68, s[8:11], s77 offen
  ds_read_b128 v[0:3], v76 offset:14848
  s_waitcnt lgkmcnt(0)
  ds_read_b64 v[16:17], v77 offset:384
  s_waitcnt lgkmcnt(0)
  ds_read_b128 v[64:67], v76 offset:27648
  s_waitcnt lgkmcnt(0)
  ds_read_b128 v[60:63], v76 offset:26624
  s_waitcnt lgkmcnt(0)
  buffer_load_dwordx4 v[52:55], v76, s[8:11], s60 offen offset:0 sc1
  buffer_load_dwordx4 v[56:59], v76, s[8:11], s60 offen offset:1024 sc1
  s_add_u32 s66, s66, 1
  s_xor_b32 s64, s64, 16384
  s_xor_b32 s65, s65, 16384
  s_add_u32 s58, s58, 655360
  s_add_u32 s59, s59, 655360
  s_add_u32 s70, s70, 655360
  s_add_u32 s68, s68, 655360
  s_mov_b32 m0, 12800
  s_add_u32 s85, s65, 8192
  v_xor_b32 v75, 0x8000, v75
  s_waitcnt lgkmcnt(0)
  s_waitcnt vmcnt(1)
  v_mfma_f32_16x16x32_bf16 v[4:7], v[0:3], v[52:55], 0
  v_bitop3_b32 v72, v52, v54, s72 bitop3:0x7e
  s_waitcnt vmcnt(0)
  v_mfma_f32_16x16x32_bf16 v[4:7], v[0:3], v[56:59], v[4:7]
  v_bitop3_b32 v73, v56, v58, s72 bitop3:0x7e
  v_bitop3_b32 v72, v72, v73, 1 bitop3:0xa8
  v_cmp_ne_u32 vcc, 0, v72
  s_nop 0
  s_cmp_eq_u64 vcc, 0
  s_cselect_b32 s54, s62, 268435456
  s_nop 0
  v_add_f32_dpp v4, v4, v4 row_ror:4 row_mask:0xf bank_mask:0xf
  v_add_f32_dpp v5, v5, v5 row_ror:4 row_mask:0xf bank_mask:0xf
  s_nop 0
  v_add_f32_dpp v4, v4, v4 row_ror:8 row_mask:0xf bank_mask:0xf
  v_add_f32_dpp v5, v5, v5 row_ror:8 row_mask:0xf bank_mask:0xf
  v_cvt_pk_bf16_f32 v4, v4, v5
  buffer_store_dword v4, v69, s[8:11], s54 offen
  s_cbranch_vccnz Cf2_h1r
  s_xor_b32 s62, s62, 16384
  buffer_store_dword v71, v69, s[8:11], s62 offen
  s_xor_b32 s72, s72, 1
  s_branch Cf2_h2
Cf2_h1r:
  s_mov_b64 exec, vcc
  buffer_load_dwordx4 v[52:55], v76, s[8:11], s60 offen offset:0 sc1
  buffer_load_dwordx4 v[56:59], v76, s[8:11], s60 offen offset:1024 sc1
  s_mov_b64 exec, -1
  s_add_u32 s67, s67, 1
  s_waitcnt vmcnt(1)
  v_mfma_f32_16x16x32_bf16 v[4:7], v[0:3], v[52:55], 0
  v_bitop3_b32 v72, v52, v54, s72 bitop3:0x7e
  s_waitcnt vmcnt(0)
  v_mfma_f32_16x16x32_bf16 v[4:7], v[0:3], v[56:59], v[4:7]
  v_bitop3_b32 v73, v56, v58, s72 bitop3:0x7e
  v_bitop3_b32 v72, v72, v73, 1 bitop3:0xa8
  v_cmp_ne_u32 vcc, 0, v72
  s_cbranch_vccz Cf2_h1p
Cf2_h1s:
  s_mov_b64 exec, vcc
  buffer_load_dwordx4 v[52:55], v76, s[8:11], s60 offen offset:0 sc1
  buffer_load_dwordx4 v[56:59], v76, s[8:11], s60 offen offset:1024 sc1
  s_mov_b64 exec, -1
  s_add_u32 s67, s67, 1
  s_waitcnt vmcnt(1)
  v_mfma_f32_16x16x32_bf16 v[4:7], v[0:3], v[52:55], 0
  v_bitop3_b32 v72, v52, v54, s72 bitop3:0x7e
  s_waitcnt vmcnt(0)
  v_mfma_f32_16x16x32_bf16 v[4:7], v[0:3], v[56:59], v[4:7]
  v_bitop3_b32 v73, v56, v58, s72 bitop3:0x7e
  v_bitop3_b32 v72, v72, v73, 1 bitop3:0xa8
  v_cmp_ne_u32 vcc, 0, v72
  s_cbranch_vccz Cf2_h1p
  s_cmp_lt_u32 s67, 131072
  s_cbranch_scc1 Cf2_h1s
Cf2_h1p:
  s_nop 2
  v_add_f32_dpp v4, v4, v4 row_ror:4 row_mask:0xf bank_mask:0xf
  v_add_f32_dpp v5, v5, v5 row_ror:4 row_mask:0xf bank_mask:0xf
  s_nop 0
  v_add_f32_dpp v4, v4, v4 row_ror:8 row_mask:0xf bank_mask:0xf
  v_add_f32_dpp v5, v5, v5 row_ror:8 row_mask:0xf bank_mask:0xf
  v_cvt_pk_bf16_f32 v4, v4, v5
  buffer_store_dword v4, v69, s[8:11], s62 offen
  s_xor_b32 s62, s62, 16384
  buffer_store_dword v71, v69, s[8:11], s62 offen
  s_xor_b32 s72, s72, 1
  s_branch Cf2_h2
Cf2_h2r:
  s_mov_b64 exec, vcc
  buffer_load_dwordx4 v[12:15], v76, s[8:11], s65 offen offset:3072 sc1
  s_mov_b64 exec, -1
  s_add_u32 s67, s67, 1
  s_waitcnt vmcnt(4)
  v_max3_u32 v72, v12, v13, v14
  v_max_u32 v72, v72, v15
  ds_write_b128 v76, v[12:15] offset:7680
  v_cmp_eq_u32 vcc, -1, v72
  s_cbranch_vccz Cf2_h2w
  s_mov_b64 exec, vcc
  buffer_load_dwordx4 v[12:15], v76, s[8:11], s65 offen offset:3072 sc1
  s_mov_b64 exec, -1
  s_add_u32 s67, s67, 1
  s_waitcnt vmcnt(4)
  v_max3_u32 v72, v12, v13, v14
  v_max_u32 v72, v72, v15
  ds_write_b128 v76, v[12:15] offset:7680
  v_cmp_eq_u32 vcc, -1, v72
  s_cbranch_vccz Cf2_h2w
Cf2_h2s:
  s_mov_b64 exec, vcc
  buffer_load_dwordx4 v[12:15], v76, s[8:11], s65 offen offset:3072 sc1
  s_mov_b64 exec, -1
  s_add_u32 s67, s67, 1
  s_waitcnt vmcnt(2)
  v_max3_u32 v72, v12, v13, v14
  v_max_u32 v72, v72, v15
  ds_write_b128 v76, v[12:15] offset:7680
  v_cmp_eq_u32 vcc, -1, v72
  s_cbranch_vccz Cf2_h2w
  s_mov_b64 exec, vcc
  buffer_load_dwordx4 v[12:15], v76, s[8:11], s65 offen offset:3072 sc1
  s_mov_b64 exec, -1
  s_add_u32 s67, s67, 1
  s_waitcnt vmcnt(2)
  v_max3_u32 v72, v12, v13, v14
  v_max_u32 v72, v72, v15
  ds_write_b128 v76, v[12:15] offset:7680
  v_cmp_eq_u32 vcc, -1, v72
  s_cbranch_vccz Cf2_h2w
  s_mov_b64 exec, vcc
  buffer_load_dwordx4 v[12:15], v76, s[8:11], s65 offen offset:3072 sc1
  s_mov_b64 exec, -1
  s_add_u32 s67, s67, 1
  s_waitcnt vmcnt(2)
  v_max3_u32 v72, v12, v13, v14
  v_max_u32 v72, v72, v15
  ds_write_b128 v76, v[12:15] offset:7680
  v_cmp_eq_u32 vcc, -1, v72
  s_cbranch_vccz Cf2_h2w
  s_cmp_lt_u32 s67, 131072
  s_cbranch_scc1 Cf2_h2s
  s_branch Cf2_h2w
Cf2_rec:
  s_nop 7
  s_waitcnt vmcnt(0) lgkmcnt(0)
  v_max3_u32 v72, v0, v1, v2
  v_max3_u32 v72, v72, v3, v4
  v_max3_u32 v72, v72, v5, v6
  v_max3_u32 v72, v72, v7, v8
  v_max3_u32 v72, v72, v9, v10
  v_max3_u32 v72, v72, v11, v12
  v_max3_u32 v72, v72, v13, v14
  v_max3_u32 v72, v72, v15, v16
  v_max3_u32 v72, v72, v17, v18
  v_max_u32 v72, v72, v19
  v_cmp_eq_u32 vcc, -1, v72
  s_cbranch_vccz Cf2_recok
  s_barrier
Cf2_recp:
  buffer_load_dwordx4 v[0:3], v76, s[8:11], s64 offen offset:0 sc1
  buffer_load_dwordx4 v[4:7], v76, s[8:11], s64 offen offset:1024 sc1
  s_add_u32 s67, s67, 1
  s_cmp_lt_u32 s67, 131072
  s_cselect_b32 s54, -2, -1
  s_waitcnt vmcnt(1)
  v_max3_u32 v72, v0, v1, v2
  s_waitcnt vmcnt(0)
  v_max3_u32 v72, v72, v3, v4
  v_max3_u32 v72, v72, v5, v6
  v_max_u32 v72, v72, v7
  v_cmp_lt_u32 vcc, s54, v72
  s_cbranch_vccnz Cf2_recp
  ds_write_b128 v76, v[0:3] offset:8704
  ds_write_b128 v76, v[4:7] offset:9728
  v_mov_b64 v[20:21], 0
  v_mov_b64 v[22:23], 0
  v_mov_b64 v[24:25], 0
  v_mov_b64 v[26:27], 0
  v_mov_b64 v[28:29], 0
  v_mov_b64 v[30:31], 0
  v_mov_b64 v[32:33], 0
  v_mov_b64 v[34:35], 0
  s_waitcnt lgkmcnt(0)
  s_barrier
  ds_read_b128 v[0:3], v76 offset:4608
  s_waitcnt lgkmcnt(0)
  v_smfmac_f32_16x16x64_bf16 v[20:23], v[0:3], v[80:87], v74
  v_smfmac_f32_16x16x64_bf16 v[24:27], v[0:3], v[88:95], v74
  ds_read_b128 v[60:63], v76 offset:24576
  ds_read_b128 v[64:67], v76 offset:25600
  s_waitcnt lgkmcnt(0)
  v_smfmac_f32_16x16x64_bf16 v[28:31], v[0:3], v[60:67], v74
  ds_read_b128 v[60:63], v76 offset:26624
  ds_read_b128 v[64:67], v76 offset:27648
  s_waitcnt lgkmcnt(0)
  v_smfmac_f32_16x16x64_bf16 v[32:35], v[0:3], v[60:67], v74
  ds_read_b128 v[4:7], v76 offset:5632
  s_waitcnt lgkmcnt(0)
  v_smfmac_f32_16x16x64_bf16 v[20:23], v[4:7], v[96:103], v74
  v_smfmac_f32_16x16x64_bf16 v[24:27], v[4:7], v[104:111], v74
  ds_read_b128 v[60:63], v76 offset:40960
  ds_read_b128 v[64:67], v76 offset:41984
  s_waitcnt lgkmcnt(0)
  v_smfmac_f32_16x16x64_bf16 v[28:31], v[4:7], v[60:67], v74
  ds_read_b128 v[60:63], v76 offset:43008
  ds_read_b128 v[64:67], v76 offset:44032
  s_waitcnt lgkmcnt(0)
  v_smfmac_f32_16x16x64_bf16 v[32:35], v[4:7], v[60:67], v74
  ds_read_b128 v[8:11], v76 offset:6656
  s_waitcnt lgkmcnt(0)
  v_smfmac_f32_16x16x64_bf16 v[20:23], v[8:11], v[112:119], v74
  v_smfmac_f32_16x16x64_bf16 v[24:27], v[8:11], v[120:127], v74
  v_smfmac_f32_16x16x64_bf16 v[28:31], v[8:11], v[208:215], v74
  v_smfmac_f32_16x16x64_bf16 v[32:35], v[8:11], v[216:223], v74
  ds_read_b128 v[12:15], v76 offset:7680
  s_waitcnt lgkmcnt(0)
  v_smfmac_f32_16x16x64_bf16 v[20:23], v[12:15], v[128:135], v74
  v_smfmac_f32_16x16x64_bf16 v[24:27], v[12:15], v[136:143], v74
  v_smfmac_f32_16x16x64_bf16 v[28:31], v[12:15], v[224:231], v74
  v_smfmac_f32_16x16x64_bf16 v[32:35], v[12:15], v[232:239], v74
  ds_read_b128 v[12:15], v76 offset:8704
  s_waitcnt lgkmcnt(0)
  v_smfmac_f32_16x16x64_bf16 v[20:23], v[12:15], v[144:151], v74
  v_smfmac_f32_16x16x64_bf16 v[24:27], v[12:15], v[152:159], v74
  ds_read_b128 v[60:63], v76 offset:57344
  ds_read_b128 v[64:67], v76 offset:58368
  s_waitcnt lgkmcnt(0)
  v_smfmac_f32_16x16x64_bf16 v[28:31], v[12:15], v[60:67], v74
  ds_read_b128 v[60:63], v76 offset:59392
  ds_read_b128 v[64:67], v76 offset:60416
  s_waitcnt lgkmcnt(0)
  v_smfmac_f32_16x16x64_bf16 v[32:35], v[12:15], v[60:67], v74
  ds_read_b128 v[0:3], v76 offset:9728
  s_waitcnt lgkmcnt(0)
  v_smfmac_f32_16x16x64_bf16 v[20:23], v[0:3], v[160:167], v74
  v_smfmac_f32_16x16x64_bf16 v[24:27], v[0:3], v[168:175], v74
  ds_read_b128 v[60:63], v75 offset:24576
  ds_read_b128 v[64:67], v75 offset:25600
  s_waitcnt lgkmcnt(0)
  v_smfmac_f32_16x16x64_bf16 v[28:31], v[0:3], v[60:67], v74
  ds_read_b128 v[60:63], v75 offset:26624
  ds_read_b128 v[64:67], v75 offset:27648
  s_waitcnt lgkmcnt(0)
  v_smfmac_f32_16x16x64_bf16 v[32:35], v[0:3], v[60:67], v74
  ds_read_b128 v[16:19], v76 offset:10752
  ds_read_b128 v[60:63], v75 offset:8192
  ds_read_b128 v[64:67], v75 offset:9216
  s_waitcnt lgkmcnt(0)
  v_smfmac_f32_16x16x64_bf16 v[20:23], v[16:19], v[60:67], v74
  ds_read_b128 v[60:63], v75 offset:10240
  ds_read_b128 v[64:67], v75 offset:11264
  s_waitcnt lgkmcnt(0)
  v_smfmac_f32_16x16x64_bf16 v[24:27], v[16:19], v[60:67], v74
  v_smfmac_f32_16x16x64_bf16 v[28:31], v[16:19], v[240:247], v74
  v_smfmac_f32_16x16x64_bf16 v[32:35], v[16:19], v[248:255], v74
  ds_read_b128 v[4:7], v76 offset:11776
  s_waitcnt lgkmcnt(0)
  v_smfmac_f32_16x16x64_bf16 v[20:23], v[4:7], v[176:183], v74
  v_smfmac_f32_16x16x64_bf16 v[24:27], v[4:7], v[184:191], v74
  v_smfmac_f32_16x16x64_bf16 v[28:31], v[4:7], a[0:7], v74
  v_smfmac_f32_16x16x64_bf16 v[32:35], v[4:7], a[8:15], v74
  ds_read_b128 v[8:11], v76 offset:12800
  s_waitcnt lgkmcnt(0)
  v_smfmac_f32_16x16x64_bf16 v[20:23], v[8:11], v[192:199], v74
  v_smfmac_f32_16x16x64_bf16 v[24:27], v[8:11], v[200:207], v74
  v_smfmac_f32_16x16x64_bf16 v[28:31], v[8:11], a[16:23], v74
  v_smfmac_f32_16x16x64_bf16 v[32:35], v[8:11], a[24:31], v74
  v_add_f32 v20, v20, v22
  v_add_f32 v21, v21, v23
  v_add_f32 v24, v24, v26
  v_cvt_pk_bf16_f32 v22, v20, v24
  ds_write_b32 v79, v22 offset:0
  v_add_f32 v25, v25, v27
  v_cvt_pk_bf16_f32 v23, v21, v25
  ds_write_b32 v79, v23 offset:576
  v_add_f32 v28, v28, v30
  v_add_f32 v29, v29, v31
  s_waitcnt lgkmcnt(0)
  s_nop 1
  s_branch Cf2_recok
Cf2_mx:
  s_waitcnt lgkmcnt(0)
  s_barrier
  buffer_load_dwordx4 v[0:3], v76, s[8:11], s58 offen offset:0 sc1
  ds_read_b128 v[20:23], v77 offset:0
  ds_read_b128 v[28:31], v77 offset:256
  buffer_load_dwordx4 v[4:7], v76, s[8:11], s58 offen offset:1024 sc1
  ds_read_b128 v[24:27], v77 offset:128
  ds_read_b128 v[32:35], v77 offset:384
  s_waitcnt vmcnt(1) lgkmcnt(3)
  v_mfma_f32_16x16x32_bf16 v[8:11], v[0:3], v[20:23], 0
  s_waitcnt vmcnt(0) lgkmcnt(1)
  v_mfma_f32_16x16x32_bf16 v[8:11], v[4:7], v[24:27], v[8:11]
  v_mfma_f32_16x16x32_bf16 v[12:15], v[28:31], v[20:23], 0
  s_waitcnt lgkmcnt(0)
  v_mfma_f32_16x16x32_bf16 v[12:15], v[32:35], v[24:27], v[12:15]
  v_add_f32_dpp v8, v10, v8 quad_perm:[2,3,0,1] row_mask:0xf bank_mask:0xf
  v_add_f32_dpp v9, v11, v9 quad_perm:[2,3,0,1] row_mask:0xf bank_mask:0xf
  s_nop 0
  v_mov_b32_dpp v8, v8 quad_perm:[0,1,0,1] row_mask:0xf bank_mask:0xf
  v_mov_b32_dpp v9, v9 quad_perm:[0,1,0,1] row_mask:0xf bank_mask:0xf
  s_nop 1
  v_add_f32_dpp v12, v14, v12 quad_perm:[2,3,0,1] row_mask:0xf bank_mask:0xf
  v_add_f32_dpp v13, v15, v13 quad_perm:[2,3,0,1] row_mask:0xf bank_mask:0xf
  s_nop 0
  v_mov_b32_dpp v12, v12 quad_perm:[0,1,0,1] row_mask:0xf bank_mask:0xf
  v_mov_b32_dpp v13, v13 quad_perm:[0,1,0,1] row_mask:0xf bank_mask:0xf
  v_mul_f32 v12, s69, v12
  ds_write_b32 v78, v8 offset:8712
  v_mul_f32 v13, s69, v13
  ds_write_b32 v78, v9 offset:8776
  s_waitcnt lgkmcnt(0)
  s_barrier
  ds_read_b128 v[36:39], v78 offset:8704
  ds_read_b128 v[40:43], v78 offset:8768
  s_waitcnt lgkmcnt(0)
  s_barrier
  v_max_f32 v16, v36, v37
  v_max3_f32 v16, v16, v38, v39
  v_max3_f32 v16, v16, v40, v41
  v_max3_f32 v16, v16, v42, v43
  v_max3_f32 v16, v16, v12, v13
  v_mov_b32 v17, v16
  s_nop 1
  v_permlane16_swap_b32 v16, v17
  v_max_f32 v16, v16, v17
  v_mov_b32 v17, v16
  s_nop 1
  v_permlane32_swap_b32 v16, v17
  v_max_f32 v16, v16, v17
  v_sub_f32 v36, v36, v16
  v_sub_f32 v37, v37, v16
  v_sub_f32 v38, v38, v16
  v_sub_f32 v39, v39, v16
  v_sub_f32 v40, v40, v16
  v_sub_f32 v41, v41, v16
  v_sub_f32 v42, v42, v16
  v_sub_f32 v43, v43, v16
  v_sub_f32 v12, v12, v16
  v_sub_f32 v13, v13, v16
  v_exp_f32 v36, v36
  v_exp_f32 v37, v37
  v_exp_f32 v38, v38
  v_exp_f32 v39, v39
  v_exp_f32 v40, v40
  v_exp_f32 v41, v41
  v_exp_f32 v42, v42
  v_exp_f32 v43, v43
  v_exp_f32 v12, v12
  v_exp_f32 v13, v13
  v_cvt_pk_bf16_f32 v32, v36, v40
  v_cvt_pk_bf16_f32 v33, v37, v41
  v_cvt_pk_bf16_f32 v34, v38, v42
  v_cvt_pk_bf16_f32 v35, v39, v43
  v_cvt_pk_bf16_f32 v28, v12, v13
  v_cvt_pk_bf16_f32 v31, v12, v13
  v_mov_b32 v29, 0
  v_mov_b32 v30, 0
  v_mov_b32 v68, 0x3f803f80
  v_mov_b32 v69, 0x3f803f80
  v_mov_b32 v70, 0x3f803f80
  v_mov_b32 v71, 0x3f803f80
  s_nop 1
  v_mfma_f32_16x16x32_bf16 v[8:11], v[32:35], v[68:71], 0
  v_mfma_f32_16x16x32_bf16 v[0:3], v[32:35], v[52:55], 0
  v_mfma_f32_16x16x32_bf16 v[4:7], v[32:35], v[56:59], 0
  v_mfma_f32_16x16x16_bf16 v[8:11], v[28:29], v[68:69], v[8:11]
  v_mfma_f32_16x16x16_bf16 v[0:3], v[28:29], v[72:73], v[0:3]
  v_mfma_f32_16x16x16_bf16 v[4:7], v[30:31], v[72:73], v[4:7]
  ds_read_b128 v[68:71], v76 offset:13824
  v_rcp_f32 v10, v8
  v_rcp_f32 v11, v9
  v_mul_f32 v0, v10, v0
  v_mul_f32 v1, v11, v1
  s_nop 0
  v_mul_f32 v4, v10, v4
  v_mul_f32 v5, v11, v5
  v_cvt_pk_bf16_f32 v2, v0, v4
  ds_write_b32 v79, v2 offset:8704
  v_cvt_pk_bf16_f32 v3, v1, v5
  ds_write_b32 v79, v3 offset:9280
  v_mov_b64 v[16:17], 0
  v_mov_b64 v[18:19], 0
  v_mov_b64 v[20:21], 0
  v_mov_b64 v[22:23], 0
  v_mov_b64 v[24:25], 0
  v_mov_b64 v[26:27], 0
  s_branch Cf2_mxok
Cf2_last:
  ds_read_b128 v[4:7], v76 offset:5632
  ds_read_b128 v[8:11], v76 offset:6656
  ds_read_b128 v[44:47], v76 offset:40960
  ds_read_b128 v[48:51], v76 offset:41984
  s_nop 5
  v_mov_b64 v[20:21], 0
  v_mov_b64 v[22:23], 0
  v_mov_b64 v[24:25], 0
  v_mov_b64 v[26:27], 0
  s_waitcnt lgkmcnt(4)
  v_smfmac_f32_16x16x64_bf16 v[28:31], v[0:3], v[36:43], v74
  ds_read_b128 v[36:39], v76 offset:43008
  ds_read_b128 v[40:43], v76 offset:44032
  v_smfmac_f32_16x16x64_bf16 v[32:35], v[0:3], v[60:67], v74
  s_waitcnt lgkmcnt(5)
  v_smfmac_f32_16x16x64_bf16 v[20:23], v[0:3], a[32:39], v74
  ds_read_b128 v[60:63], v76 offset:57344
  ds_read_b128 v[64:67], v76 offset:58368
  v_smfmac_f32_16x16x64_bf16 v[24:27], v[0:3], a[40:47], v74
  s_waitcnt lgkmcnt(4)
  v_smfmac_f32_16x16x64_bf16 v[20:23], v[4:7], a[48:55], v74
  buffer_store_dwordx4 v[16:19], v76, s[8:11], s68 offen sc1
  v_smfmac_f32_16x16x64_bf16 v[24:27], v[4:7], a[56:63], v74
  v_smfmac_f32_16x16x64_bf16 v[28:31], v[4:7], v[44:51], v74
  s_waitcnt lgkmcnt(2)
  v_smfmac_f32_16x16x64_bf16 v[20:23], v[8:11], a[64:71], v74
  ds_read_b128 v[44:47], v76 offset:59392
  ds_read_b128 v[48:51], v76 offset:60416
  v_smfmac_f32_16x16x64_bf16 v[24:27], v[8:11], a[72:79], v74
  v_smfmac_f32_16x16x64_bf16 v[32:35], v[4:7], v[36:43], v74
  v_smfmac_f32_16x16x64_bf16 v[28:31], v[8:11], v[208:215], v74
  ds_read_b128 v[36:39], v75 offset:24576
  ds_read_b128 v[40:43], v75 offset:25600
  v_smfmac_f32_16x16x64_bf16 v[32:35], v[8:11], v[216:223], v74
  v_smfmac_f32_16x16x64_bf16 v[20:23], v[12:15], a[80:87], v74
  v_smfmac_f32_16x16x64_bf16 v[24:27], v[12:15], a[88:95], v74
  v_smfmac_f32_16x16x64_bf16 v[28:31], v[12:15], v[224:231], v74
  v_smfmac_f32_16x16x64_bf16 v[32:35], v[12:15], v[232:239], v74
  s_waitcnt vmcnt(2)
  s_waitcnt vmcnt(1)
  s_barrier
Cf2_lastr:
  ds_read_b128 v[12:15], v76 offset:8704
  ds_read_b128 v[0:3], v76 offset:9728
  ds_read_b128 v[16:19], v76 offset:10752
  ds_read_b128 v[4:7], v76 offset:11776
  ds_read_b128 v[8:11], v76 offset:12800
  s_waitcnt lgkmcnt(3)
  v_max3_u32 v72, v0, v1, v2
  s_waitcnt lgkmcnt(1)
  v_max3_u32 v72, v72, v3, v4
  v_max3_u32 v72, v72, v5, v6
  s_waitcnt lgkmcnt(0)
  v_max3_u32 v72, v72, v7, v8
  v_max3_u32 v72, v72, v9, v10
  v_max3_u32 v72, v72, v11, v12
  v_max3_u32 v72, v72, v13, v14
  v_max3_u32 v72, v72, v15, v16
  v_max3_u32 v72, v72, v17, v18
  v_max_u32 v72, v72, v19
  v_cmp_eq_u32 vcc, -1, v72
  s_cbranch_vccnz Cf2_lastp
Cf2_lastg:
  v_smfmac_f32_16x16x64_bf16 v[28:31], v[12:15], v[60:67], v74
  ds_read_b128 v[60:63], v75 offset:26624
  ds_read_b128 v[64:67], v75 offset:27648
  v_smfmac_f32_16x16x64_bf16 v[32:35], v[12:15], v[44:51], v74
  v_smfmac_f32_16x16x64_bf16 v[28:31], v[0:3], v[36:43], v74
  v_smfmac_f32_16x16x64_bf16 v[28:31], v[16:19], v[240:247], v74
  v_smfmac_f32_16x16x64_bf16 v[28:31], v[4:7], a[0:7], v74
  v_smfmac_f32_16x16x64_bf16 v[28:31], v[8:11], a[16:23], v74
  v_smfmac_f32_16x16x64_bf16 v[32:35], v[16:19], v[248:255], v74
  v_smfmac_f32_16x16x64_bf16 v[32:35], v[4:7], a[8:15], v74
  s_waitcnt lgkmcnt(0)
  v_smfmac_f32_16x16x64_bf16 v[32:35], v[8:11], a[24:31], v74
  v_smfmac_f32_16x16x64_bf16 v[32:35], v[0:3], v[60:67], v74
  v_smfmac_f32_16x16x64_bf16 v[20:23], v[12:15], a[96:103], v74
  v_smfmac_f32_16x16x64_bf16 v[20:23], v[0:3], a[112:119], v74
  v_add_f32 v28, v28, v30
  v_add_f32 v32, v32, v34
  v_cvt_pk_bf16_f32 v30, v28, v32
  v_smfmac_f32_16x16x64_bf16 v[20:23], v[16:19], a[128:135], v74
  ds_write_b32 v79, v30 offset:256
  v_add_f32 v29, v29, v31
  v_add_f32 v33, v33, v35
  v_cvt_pk_bf16_f32 v31, v29, v33
  v_smfmac_f32_16x16x64_bf16 v[20:23], v[4:7], a[144:151], v74
  ds_write_b32 v79, v31 offset:832
  v_smfmac_f32_16x16x64_bf16 v[20:23], v[8:11], a[160:167], v74
  v_smfmac_f32_16x16x64_bf16 v[24:27], v[12:15], a[104:111], v74
  v_smfmac_f32_16x16x64_bf16 v[24:27], v[0:3], a[120:127], v74
  v_smfmac_f32_16x16x64_bf16 v[24:27], v[16:19], a[136:143], v74
  s_waitcnt lgkmcnt(0)
  s_barrier
  ds_read_b64 v[52:53], v77 offset:384
  v_add_f32 v20, v20, v22
  v_smfmac_f32_16x16x64_bf16 v[24:27], v[4:7], a[152:159], v74
  v_add_f32 v21, v21, v23
  v_smfmac_f32_16x16x64_bf16 v[24:27], v[8:11], a[168:175], v74
  v_cvt_pk_bf16_f32 v54, v20, v21
  s_add_u32 s68, s68, 655360
  s_nop 3
  v_add_f32 v24, v24, v26
  v_add_f32 v25, v25, v27
  v_cvt_pk_bf16_f32 v55, v24, v25
  s_waitcnt lgkmcnt(0)
  buffer_store_dwordx4 v[52:55], v76, s[8:11], s68 offen sc1
  s_branch Cf2_done
Cf2_lastp:
  s_add_u32 s72, s72, 2
  s_cmp_ge_u32 s72, 131072
  s_cbranch_scc1 Cf2_lastg
  s_barrier
  buffer_load_dwordx4 v76, s[8:11], s85 offen offset:0 sc1 lds
  s_waitcnt vmcnt(0)
  s_barrier
  s_branch Cf2_lastr
Cf2_done:
  s_branch L_cexit
L_w3:
  v_mov_b64 v[20:21], 0
  v_mov_b64 v[22:23], 0
  v_mov_b64 v[24:25], 0
  v_mov_b64 v[26:27], 0
  v_mov_b64 v[28:29], 0
  v_mov_b64 v[30:31], 0
  v_mov_b64 v[32:33], 0
  v_mov_b64 v[34:35], 0
  s_mov_b32 s78, 0x3f803f80
  s_mov_b32 s79, s78
  s_mov_b32 s65, 360448
  s_mov_b32 m0, 15872
  s_lshl_b32 s71, s53, 2
  s_add_u32 s71, s71, 128
  s_movk_i32 s56, 0x1000
  v_lshlrev_b32 v73, 2, v76
  v_mov_b32 v72, 0
  s_mov_b64 s[16:17], s[8:9]
  s_mov_b32 s18, 268435456
  s_mov_b32 s19, 0x20000
  s_getpc_b64 s[20:21]
Cf3_pc:
  s_add_u32 s20, s20, (Cf3_last - Cf3_pc)
  s_addc_u32 s21, s21, 0
  v_mov_b32 v68, 14880
  buffer_load_dwordx4 v[52:55], v76, s[8:11], s59 offen offset:0 sc1
  buffer_load_dwordx4 v[56:59], v76, s[8:11], s59 offen offset:1024 sc1
  ds_read_b128 v[36:39], v76 offset:45056
  ds_read_b128 v[40:43], v76 offset:46080
  ds_read_b128 v[60:63], v76 offset:47104
  ds_read_b128 v[64:67], v76 offset:48128
  ds_read_b128 v[0:3], v76 offset:4608
  ds_read_b128 v[4:7], v76 offset:5632
  ds_read_b128 v[8:11], v76 offset:6656
  ds_read_b128 v[12:15], v76 offset:7680
  s_waitcnt lgkmcnt(0)
  s_cmp_eq_u32 s66, 1
  s_branch Cf3_top2
.p2align 6
Cf3_h2:
  v_lshlrev_b32 v73, 2, v76
  buffer_load_dwordx4 v[4:7], v76, s[8:11], s65 offen offset:1024 sc1
  ds_read_b128 v[36:39], v76 offset:45056
  ds_read_b128 v[40:43], v76 offset:46080
  buffer_load_dwordx4 v[52:55], v76, s[8:11], s59 offen offset:0 sc1
  buffer_load_dwordx4 v[56:59], v76, s[8:11], s59 offen offset:1024 sc1
  s_waitcnt vmcnt(7)
  v_max3_u32 v72, v4, v5, v6
  v_max_u32 v72, v72, v7
  ds_write_b128 v76, v[4:7] offset:5632
  v_cmp_eq_u32 vcc, -1, v72
  s_cbranch_vccnz Cf3_h2r
Cf3_h2w:
  buffer_load_dwordx4 v76, s[8:11], s85 offen offset:0 sc1 lds
  buffer_load_dwordx4 v76, s[8:11], s85 offen offset:1024 sc1 lds
  s_cmp_eq_u32 s66, 63
  s_waitcnt lgkmcnt(0)
  s_barrier
  ds_read_b128 v[8:11], v76 offset:6656
Cf3_top2:
  v_smfmac_f32_16x16x64_bf16 v[20:23], v[4:7], v[96:103], v74
  s_cbranch_scc1 Cf3_last
  v_smfmac_f32_16x16x64_bf16 v[28:31], v[4:7], v[36:43], v74
  buffer_load_dwordx4 v[44:47], v76, s[8:11], s58 offen offset:0 sc1
  s_mov_b32 m0, 15872
  v_smfmac_f32_16x16x64_bf16 v[24:27], v[4:7], v[104:111], v74
  buffer_load_dwordx4 v[48:51], v76, s[8:11], s58 offen offset:1024 sc1
  v_smfmac_f32_16x16x64_bf16 v[32:35], v[4:7], v[60:67], v74
  ds_read_b128 v[0:3], v76 offset:4608
  s_waitcnt lgkmcnt(1)
  v_smfmac_f32_16x16x64_bf16 v[20:23], v[8:11], v[112:119], v74
  ds_read_b128 v[12:15], v76 offset:7680
  v_smfmac_f32_16x16x64_bf16 v[24:27], v[8:11], v[120:127], v74
  ds_read_b128 v[36:39], v76 offset:28672
  v_smfmac_f32_16x16x64_bf16 v[28:31], v[8:11], v[208:215], v74
  buffer_store_dwordx4 v[16:19], v76, s[8:11], s68 offen sc1
  ds_read_b128 v[40:43], v76 offset:29696
  v_smfmac_f32_16x16x64_bf16 v[32:35], v[8:11], v[216:223], v74
  ds_read_b128 v[60:63], v76 offset:30720
  s_waitcnt lgkmcnt(4)
  v_smfmac_f32_16x16x64_bf16 v[20:23], v[0:3], v[80:87], v74
  ds_read_b128 v[64:67], v76 offset:31744
  v_smfmac_f32_16x16x64_bf16 v[24:27], v[0:3], v[88:95], v74
  buffer_load_dword v73, s[16:19], s70 offen lds
  s_waitcnt vmcnt(4)
  s_waitcnt lgkmcnt(4)
  v_smfmac_f32_16x16x64_bf16 v[20:23], v[12:15], v[128:135], v74
  s_barrier
  s_waitcnt lgkmcnt(2)
  v_smfmac_f32_16x16x64_bf16 v[28:31], v[0:3], v[36:43], v74
  ds_read_b128 v[4:7], v76 offset:8704
  v_smfmac_f32_16x16x64_bf16 v[24:27], v[12:15], v[136:143], v74
  ds_read_b128 v[36:39], v76 offset:61440
  s_waitcnt lgkmcnt(2)
  v_smfmac_f32_16x16x64_bf16 v[32:35], v[0:3], v[60:67], v74
  ds_read_b128 v[40:43], v76 offset:62464
  v_smfmac_f32_16x16x64_bf16 v[28:31], v[12:15], v[224:231], v74
  ds_read_b128 v[60:63], v76 offset:63488
  v_smfmac_f32_16x16x64_bf16 v[32:35], v[12:15], v[232:239], v74
  ds_read_b128 v[64:67], v76 offset:64512
  s_waitcnt lgkmcnt(4)
  v_smfmac_f32_16x16x64_bf16 v[20:23], v[4:7], v[144:151], v74
  ds_read_b128 v[8:11], v76 offset:9728
  s_waitcnt lgkmcnt(3)
  v_smfmac_f32_16x16x64_bf16 v[28:31], v[4:7], v[36:43], v74
  s_barrier
  ds_read_b128 v[0:3], v76 offset:11776
  v_smfmac_f32_16x16x64_bf16 v[24:27], v[4:7], v[152:159], v74
  ds_read_b128 v[36:39], v75 offset:12288
  ds_read_b128 v[40:43], v75 offset:13312
  s_waitcnt lgkmcnt(4)
  v_smfmac_f32_16x16x64_bf16 v[32:35], v[4:7], v[60:67], v74
  ds_read_b128 v[16:19], v76 offset:10752
  s_waitcnt lgkmcnt(4)
  v_smfmac_f32_16x16x64_bf16 v[20:23], v[8:11], v[160:167], v74
  ds_read_b128 v[12:15], v76 offset:12800
  v_smfmac_f32_16x16x64_bf16 v[24:27], v[8:11], v[168:175], v74
  ds_read_b128 v[60:63], v75 offset:14336
  ds_read_b128 v[64:67], v75 offset:15360
  s_waitcnt lgkmcnt(6)
  v_smfmac_f32_16x16x64_bf16 v[20:23], v[0:3], v[176:183], v74
  s_waitcnt lgkmcnt(3)
  v_smfmac_f32_16x16x64_bf16 v[20:23], v[16:19], v[36:43], v74
  ds_read_b128 v[36:39], v75 offset:28672
  s_waitcnt lgkmcnt(3)
  v_smfmac_f32_16x16x64_bf16 v[20:23], v[12:15], v[192:199], v74
  ds_read_b128 v[40:43], v75 offset:29696
  s_waitcnt lgkmcnt(2)
  v_smfmac_f32_16x16x64_bf16 v[24:27], v[16:19], v[60:67], v74
  ds_read_b128 v[60:63], v75 offset:30720
  v_smfmac_f32_16x16x64_bf16 v[24:27], v[0:3], v[184:191], v74
  ds_read_b128 v[64:67], v75 offset:31744
  v_add_f32 v20, v20, v22
  v_smfmac_f32_16x16x64_bf16 v[24:27], v[12:15], v[200:207], v74
  v_add_f32 v21, v21, v23
  v_smfmac_f32_16x16x64_bf16 v[28:31], v[16:19], v[240:247], v74
  s_waitcnt lgkmcnt(2)
  v_mov_b64 v[70:71], s[78:79]
  v_smfmac_f32_16x16x64_bf16 v[28:31], v[8:11], v[36:43], v74
  ds_read_b128 v[36:39], v68
  v_add_f32 v24, v24, v26
  v_smfmac_f32_16x16x64_bf16 v[28:31], v[0:3], a[0:7], v74
  ds_read_b128 v[40:43], v68
  v_cvt_pk_bf16_f32 v22, v20, v24
  v_smfmac_f32_16x16x64_bf16 v[28:31], v[12:15], a[16:23], v74
  ds_write_b32 v79, v22 offset:0
  s_waitcnt lgkmcnt(3)
  v_add_f32 v25, v25, v27
  v_cvt_pk_bf16_f32 v23, v21, v25
  v_smfmac_f32_16x16x64_bf16 v[32:35], v[8:11], v[60:67], v74
  ds_write_b32 v79, v23 offset:576
  v_cmp_u_f32 vcc, v20, v21
  v_smfmac_f32_16x16x64_bf16 v[32:35], v[16:19], v[248:255], v74
  v_add_f32 v28, v28, v30
  v_smfmac_f32_16x16x64_bf16 v[32:35], v[0:3], a[8:15], v74
  v_add_f32 v29, v29, v31
  v_smfmac_f32_16x16x64_bf16 v[32:35], v[12:15], a[24:31], v74
  s_cbranch_vccnz Cf3_rec
Cf3_recok:
  s_waitcnt lgkmcnt(3)
  v_smfmac_f32_16x16x64_bf16 v[36:39], v[16:19], a[128:135], v74
  s_waitcnt lgkmcnt(0)
  s_barrier
  ds_read_b128 v[60:63], v77
  v_smfmac_f32_16x16x64_bf16 v[40:43], v[16:19], a[136:143], v74
  ds_read_b128 v[64:67], v77 offset:128
  v_add_f32 v32, v32, v34
  v_cvt_pk_bf16_f32 v30, v28, v32
  v_smfmac_f32_16x16x64_bf16 v[36:39], v[0:3], a[144:151], v74
  ds_write_b32 v79, v30 offset:256
  v_add_f32 v33, v33, v35
  v_cvt_pk_bf16_f32 v31, v29, v33
  v_smfmac_f32_16x16x64_bf16 v[40:43], v[0:3], a[152:159], v74
  ds_write_b32 v79, v31 offset:832
  v_xor_b32 v75, 0x8000, v75
  v_smfmac_f32_16x16x64_bf16 v[36:39], v[4:7], a[96:103], v74
  ds_read_b128 v[0:3], v76 offset:4608
  v_mov_b32 v29, 0
  v_smfmac_f32_16x16x64_bf16 v[40:43], v[4:7], a[104:111], v74
  s_waitcnt vmcnt(2) lgkmcnt(3)
  v_mov_b32 v30, 0
  v_mfma_f32_16x16x32_bf16 v[44:47], v[44:47], v[60:63], 0
  ds_read_b128 v[4:7], v76 offset:5632
  s_waitcnt lgkmcnt(2)
  v_mfma_f32_16x16x32_bf16 v[44:47], v[48:51], v[64:67], v[44:47]
  s_barrier
  v_smfmac_f32_16x16x64_bf16 v[36:39], v[8:11], a[112:119], v74
  ds_read_b128 v[20:23], v77 offset:256
  ds_read_b128 v[24:27], v77 offset:384
  v_smfmac_f32_16x16x64_bf16 v[40:43], v[8:11], a[120:127], v74
  ds_read_b128 v[8:11], v76 offset:6656
  v_add_f32_dpp v72, v46, v44 quad_perm:[2,3,0,1] row_mask:0xf bank_mask:0xf
  v_add_f32_dpp v73, v47, v45 quad_perm:[2,3,0,1] row_mask:0xf bank_mask:0xf
  v_smfmac_f32_16x16x64_bf16 v[36:39], v[12:15], a[160:167], v74
  s_waitcnt lgkmcnt(4)
  v_exp_f32_dpp v72, v72 quad_perm:[0,1,0,1] row_mask:0xf bank_mask:0xf
  v_smfmac_f32_16x16x64_bf16 v[40:43], v[12:15], a[168:175], v74
  ds_read_b128 v[12:15], v76 offset:7680
  v_exp_f32_dpp v73, v73 quad_perm:[0,1,0,1] row_mask:0xf bank_mask:0xf
  v_smfmac_f32_16x16x64_bf16 v[36:39], v[0:3], a[32:39], v74
  s_waitcnt lgkmcnt(2)
  v_cvt_pk_bf16_f32 v72, v72, v73
  v_mfma_f32_16x16x32_bf16 v[20:23], v[20:23], v[60:63], 0
  ds_write_b32 v78, v72 offset:524
  v_mov_b64 v[16:17], 0
  v_mfma_f32_16x16x32_bf16 v[20:23], v[24:27], v[64:67], v[20:23]
  ds_read_b128 v[44:47], v75 offset:28672
  v_mov_b64 v[18:19], 0
  v_smfmac_f32_16x16x64_bf16 v[40:43], v[0:3], a[40:47], v74
  ds_read_b128 v[48:51], v75 offset:29696
  v_mov_b64 v[68:69], s[78:79]
  v_smfmac_f32_16x16x64_bf16 v[36:39], v[4:7], a[48:55], v74
  s_waitcnt lgkmcnt(4)
  v_add_f32_dpp v24, v22, v20 quad_perm:[2,3,0,1] row_mask:0xf bank_mask:0xf
  v_add_f32_dpp v25, v23, v21 quad_perm:[2,3,0,1] row_mask:0xf bank_mask:0xf
  v_smfmac_f32_16x16x64_bf16 v[36:39], v[8:11], a[64:71], v74
  s_waitcnt lgkmcnt(2)
  s_barrier
  ds_read_b128 v[32:35], v78 offset:512
  v_smfmac_f32_16x16x64_bf16 v[36:39], v[12:15], a[80:87], v74
  ds_read_b128 v[60:63], v75 offset:30720
  v_mul_f32 v24, s69, v24
  v_smfmac_f32_16x16x64_bf16 v[40:43], v[4:7], a[56:63], v74
  ds_read_b128 v[64:67], v75 offset:31744
  v_mul_f32 v25, s69, v25
  v_smfmac_f32_16x16x64_bf16 v[40:43], v[8:11], a[72:79], v74
  v_exp_f32_dpp v24, v24 quad_perm:[0,1,0,1] row_mask:0xf bank_mask:0xf
  v_smfmac_f32_16x16x64_bf16 v[40:43], v[12:15], a[88:95], v74
  s_waitcnt lgkmcnt(2)
  v_exp_f32_dpp v25, v25 quad_perm:[0,1,0,1] row_mask:0xf bank_mask:0xf
  v_mfma_f32_16x16x32_bf16 v[8:11], v[32:35], v[68:71], 0
  v_add_f32 v36, v36, v38
  v_add_f32 v37, v37, v39
  v_mfma_f32_16x16x32_bf16 v[0:3], v[32:35], v[52:55], 0
  v_add_f32 v40, v40, v42
  v_add_f32 v41, v41, v43
  v_mfma_f32_16x16x32_bf16 v[4:7], v[32:35], v[56:59], 0
  v_cvt_pk_bf16_f32 v28, v24, v25
  v_cvt_pk_bf16_f32 v72, v36, v37
  v_cvt_pk_bf16_f32 v73, v40, v41
  v_mfma_f32_16x16x16_bf16 v[8:11], v[28:29], v[68:69], v[8:11]
  v_cvt_pk_bf16_f32 v31, v24, v25
  v_mov_b64 v[20:21], 0
  v_mfma_f32_16x16x16_bf16 v[0:3], v[28:29], v[72:73], v[0:3]
  ds_read_b128 v[68:71], v76 offset:13824
  v_mov_b64 v[22:23], 0
  v_mfma_f32_16x16x16_bf16 v[4:7], v[30:31], v[72:73], v[4:7]
  v_rcp_f32 v10, v8
  v_rcp_f32 v11, v9
  v_mul_f32 v0, v10, v0
  v_mul_f32 v1, v11, v1
  s_nop 0
  v_mul_f32 v4, v10, v4
  v_mul_f32 v5, v11, v5
  v_cvt_pk_bf16_f32 v2, v0, v4
  ds_write_b32 v79, v2 offset:8704
  v_cvt_pk_bf16_f32 v3, v1, v5
  ds_write_b32 v79, v3 offset:9280
  v_max3_f32 v8, v8, v9, v10
  v_max_f32 v8, v8, v11
  v_cmp_le_f32 vcc, 1317011456, v8
  v_mov_b64 v[24:25], 0
  v_mov_b64 v[26:27], 0
  s_cbranch_vccnz Cf3_mx
Cf3_mxok:
  s_waitcnt lgkmcnt(0)
  s_barrier
  ds_read_b128 v[0:3], v78 offset:8704
  ds_read_b128 v[4:7], v78 offset:8768
  ds_read_b128 v[8:11], v78 offset:8832
  ds_read_b128 v[12:15], v78 offset:8896
  s_waitcnt lgkmcnt(3)
  v_smfmac_f32_16x16x64_bf16 v[16:19], v[0:3], v[44:51], v74
  ds_read_b128 v[52:55], v75 offset:45056
  s_waitcnt lgkmcnt(3)
  v_smfmac_f32_16x16x64_bf16 v[16:19], v[4:7], v[60:67], v74
  ds_read_b128 v[56:59], v75 offset:46080
  s_waitcnt lgkmcnt(3)
  v_smfmac_f32_16x16x64_bf16 v[16:19], v[8:11], a[176:183], v74
  ds_read_b128 v[36:39], v75 offset:47104
  s_waitcnt lgkmcnt(3)
  v_smfmac_f32_16x16x64_bf16 v[16:19], v[12:15], a[184:191], v74
  ds_read_b128 v[40:43], v75 offset:48128
  ds_read_b128 v[44:47], v75 offset:61440
  v_smfmac_f32_16x16x64_bf16 v[20:23], v[0:3], a[192:199], v74
  ds_read_b128 v[48:51], v75 offset:62464
  ds_read_b128 v[60:63], v75 offset:63488
  v_smfmac_f32_16x16x64_bf16 v[20:23], v[4:7], a[200:207], v74
  ds_read_b128 v[64:67], v75 offset:64512
  s_waitcnt lgkmcnt(6)
  v_cvt_pk_bf16_f32 v16, v16, v17
  v_cvt_pk_bf16_f32 v17, v18, v19
  v_bfi_b32 v16, 1, s72, v16
  v_smfmac_f32_16x16x64_bf16 v[20:23], v[8:11], v[52:59], v74
  buffer_store_dwordx2 v[16:17], v68, s[8:11], s73 offen
  s_waitcnt lgkmcnt(4)
  v_smfmac_f32_16x16x64_bf16 v[20:23], v[12:15], v[36:43], v74
  ds_read_b128 v[52:55], v75 offset:8192
  v_mov_b64 v[32:33], 0
  v_smfmac_f32_16x16x64_bf16 v[24:27], v[0:3], a[208:215], v74
  ds_read_b128 v[56:59], v75 offset:9216
  v_mov_b64 v[34:35], 0
  v_smfmac_f32_16x16x64_bf16 v[24:27], v[4:7], a[216:223], v74
  ds_read_b128 v[36:39], v75 offset:10240
  s_waitcnt lgkmcnt(5)
  v_cvt_pk_bf16_f32 v20, v20, v21
  v_cvt_pk_bf16_f32 v21, v22, v23
  v_bfi_b32 v20, 1, s72, v20
  v_smfmac_f32_16x16x64_bf16 v[24:27], v[8:11], v[44:51], v74
  buffer_store_dwordx2 v[20:21], v68, s[8:11], s74 offen
  s_waitcnt lgkmcnt(3)
  v_smfmac_f32_16x16x64_bf16 v[24:27], v[12:15], v[60:67], v74
  ds_read_b128 v[40:43], v75 offset:11264
  v_mov_b64 v[28:29], 0
  v_smfmac_f32_16x16x64_bf16 v[32:35], v[0:3], a[224:231], v74
  ds_read_b128 v[44:47], v75 offset:12288
  ds_read_b128 v[48:51], v75 offset:13312
  v_smfmac_f32_16x16x64_bf16 v[32:35], v[4:7], a[232:239], v74
  ds_read_b128 v[60:63], v75 offset:14336
  v_cvt_pk_bf16_f32 v24, v24, v25
  v_cvt_pk_bf16_f32 v25, v26, v27
  v_bfi_b32 v24, 1, s72, v24
  v_smfmac_f32_16x16x64_bf16 v[32:35], v[8:11], a[240:247], v74
  buffer_store_dwordx2 v[24:25], v68, s[8:11], s75 offen
  v_mov_b64 v[30:31], 0
  v_smfmac_f32_16x16x64_bf16 v[32:35], v[12:15], a[248:255], v74
  ds_read_b128 v[64:67], v75 offset:15360
  s_waitcnt lgkmcnt(6)
  v_smfmac_f32_16x16x64_bf16 v[28:31], v[0:3], v[52:59], v74
  s_waitcnt lgkmcnt(4)
  v_smfmac_f32_16x16x64_bf16 v[28:31], v[4:7], v[36:43], v74
  s_waitcnt lgkmcnt(2)
  v_cvt_pk_bf16_f32 v32, v32, v33
  v_cvt_pk_bf16_f32 v33, v34, v35
  v_bfi_b32 v32, 1, s72, v32
  v_smfmac_f32_16x16x64_bf16 v[28:31], v[8:11], v[44:51], v74
  buffer_store_dwordx2 v[32:33], v68, s[8:11], s76 offen
  s_waitcnt lgkmcnt(0)
  v_smfmac_f32_16x16x64_bf16 v[28:31], v[12:15], v[60:67], v74
  v_mov_b64 v[18:19], v[72:73]
  s_nop 4
  v_cvt_pk_bf16_f32 v28, v28, v29
  v_cvt_pk_bf16_f32 v29, v30, v31
  v_bfi_b32 v28, 1, s72, v28
  buffer_store_dwordx2 v[28:29], v68, s[8:11], s77 offen
  ds_read_b128 v[52:55], v76 offset:14848
  s_waitcnt lgkmcnt(0)
  ds_read_b64 v[16:17], v77 offset:392
  s_waitcnt lgkmcnt(0)
  ds_read_b128 v[60:63], v76 offset:47104
  s_waitcnt lgkmcnt(0)
  ds_read_b128 v[64:67], v76 offset:48128
  s_waitcnt lgkmcnt(0)
  s_add_u32 s66, s66, 1
  s_xor_b32 s64, s64, 16384
  s_xor_b32 s65, s65, 16384
  s_add_u32 s58, s58, 655360
  s_add_u32 s59, s59, 655360
  s_add_u32 s70, s70, 655360
  s_add_u32 s68, s68, 655360
  s_mov_b32 m0, 8704
  s_add_u32 s85, s65, 4096
  v_xor_b32 v75, 0x8000, v75
  buffer_load_dwordx4 v[0:3], v76, s[8:11], s60 offen offset:0 sc1
  buffer_load_dwordx4 v[4:7], v76, s[8:11], s60 offen offset:1024 sc1
  buffer_load_dwordx4 v[8:11], v76, s[8:11], s61 offen offset:0 sc1
  buffer_load_dwordx4 v[12:15], v76, s[8:11], s61 offen offset:1024 sc1
  v_mov_b64 v[20:21], 0
  v_mov_b64 v[22:23], 0
  v_mov_b64 v[24:25], 0
  v_mov_b64 v[26:27], 0
  v_mov_b32 v68, 14880
  v_mov_b64 v[28:29], 0
  v_mov_b64 v[30:31], 0
  v_mov_b64 v[32:33], 0
  v_mov_b64 v[34:35], 0
  s_cmp_eq_u32 s66, 62
  s_cselect_b64 s[16:17], s[20:21], s[16:17]
  s_cselect_b32 s18, (Cf3_done - Cf3_last), s18
  s_cselect_b32 s70, 0, s70
  s_cmp_eq_u32 s66, 63
  s_cselect_b32 s59, 268435456, s59
  s_cselect_b32 s58, 268435456, s58
  s_waitcnt lgkmcnt(0)
  s_waitcnt vmcnt(3)
  v_mfma_f32_16x16x32_bf16 v[56:59], v[52:55], v[0:3], 0
  v_bitop3_b32 v72, v0, v2, s72 bitop3:0x7e
  s_waitcnt vmcnt(2)
  v_mfma_f32_16x16x32_bf16 v[56:59], v[52:55], v[4:7], v[56:59]
  v_bitop3_b32 v73, v4, v6, s72 bitop3:0x7e
  v_or_b32 v72, v72, v73
  s_waitcnt vmcnt(1)
  v_mfma_f32_16x16x32_bf16 v[36:39], v[52:55], v[8:11], 0
  v_bitop3_b32 v73, v8, v10, s72 bitop3:0x7e
  v_or_b32 v72, v72, v73
  s_waitcnt vmcnt(0)
  v_mfma_f32_16x16x32_bf16 v[36:39], v[52:55], v[12:15], v[36:39]
  v_bitop3_b32 v73, v12, v14, s72 bitop3:0x7e
  v_bitop3_b32 v72, v72, v73, 1 bitop3:0xa8
  v_cmp_ne_u32 vcc, 0, v72
  s_cbranch_vccnz Cf3_h1r
  buffer_load_dwordx4 v[4:7], v76, s[8:11], s65 offen offset:1024 sc1
  v_add_f32_dpp v56, v56, v56 row_ror:4 row_mask:0xf bank_mask:0xf
  v_add_f32_dpp v57, v57, v57 row_ror:4 row_mask:0xf bank_mask:0xf
  v_add_f32_dpp v36, v36, v36 row_ror:4 row_mask:0xf bank_mask:0xf
  v_add_f32_dpp v37, v37, v37 row_ror:4 row_mask:0xf bank_mask:0xf
  v_add_f32_dpp v56, v56, v56 row_ror:8 row_mask:0xf bank_mask:0xf
  v_add_f32_dpp v57, v57, v57 row_ror:8 row_mask:0xf bank_mask:0xf
  v_add_f32_dpp v36, v36, v36 row_ror:8 row_mask:0xf bank_mask:0xf
  v_add_f32_dpp v37, v37, v37 row_ror:8 row_mask:0xf bank_mask:0xf
  v_cvt_pk_bf16_f32 v56, v56, v57
  buffer_store_dword v56, v69, s[8:11], s62 offen
  v_cvt_pk_bf16_f32 v36, v36, v37
  buffer_store_dword v36, v70, s[8:11], s63 offen
  s_xor_b32 s62, s62, 16384
  buffer_store_dword v71, v69, s[8:11], s62 offen
  s_xor_b32 s63, s63, 16384
  buffer_store_dword v71, v70, s[8:11], s63 offen
  s_xor_b32 s72, s72, 1
  s_branch Cf3_h2
Cf3_h1r:
  s_mov_b64 exec, vcc
  buffer_load_dwordx4 v[0:3], v76, s[8:11], s60 offen offset:0 sc1
  buffer_load_dwordx4 v[4:7], v76, s[8:11], s60 offen offset:1024 sc1
  buffer_load_dwordx4 v[8:11], v76, s[8:11], s61 offen offset:0 sc1
  buffer_load_dwordx4 v[12:15], v76, s[8:11], s61 offen offset:1024 sc1
  s_mov_b64 exec, -1
  s_add_u32 s67, s67, 1
  s_waitcnt vmcnt(3)
  v_mfma_f32_16x16x32_bf16 v[56:59], v[52:55], v[0:3], 0
  v_bitop3_b32 v72, v0, v2, s72 bitop3:0x7e
  s_waitcnt vmcnt(2)
  v_mfma_f32_16x16x32_bf16 v[56:59], v[52:55], v[4:7], v[56:59]
  v_bitop3_b32 v73, v4, v6, s72 bitop3:0x7e
  v_or_b32 v72, v72, v73
  s_waitcnt vmcnt(1)
  v_mfma_f32_16x16x32_bf16 v[36:39], v[52:55], v[8:11], 0
  v_bitop3_b32 v73, v8, v10, s72 bitop3:0x7e
  v_or_b32 v72, v72, v73
  s_waitcnt vmcnt(0)
  v_mfma_f32_16x16x32_bf16 v[36:39], v[52:55], v[12:15], v[36:39]
  v_bitop3_b32 v73, v12, v14, s72 bitop3:0x7e
  v_bitop3_b32 v72, v72, v73, 1 bitop3:0xa8
  v_cmp_ne_u32 vcc, 0, v72
  s_cbranch_vccz Cf3_h1p
Cf3_h1s:
  s_mov_b64 exec, vcc
  buffer_load_dwordx4 v[0:3], v76, s[8:11], s60 offen offset:0 sc1
  buffer_load_dwordx4 v[4:7], v76, s[8:11], s60 offen offset:1024 sc1
  buffer_load_dwordx4 v[8:11], v76, s[8:11], s61 offen offset:0 sc1
  buffer_load_dwordx4 v[12:15], v76, s[8:11], s61 offen offset:1024 sc1
  s_mov_b64 exec, -1
  s_add_u32 s67, s67, 1
  s_waitcnt vmcnt(3)
  v_mfma_f32_16x16x32_bf16 v[56:59], v[52:55], v[0:3], 0
  v_bitop3_b32 v72, v0, v2, s72 bitop3:0x7e
  s_waitcnt vmcnt(2)
  v_mfma_f32_16x16x32_bf16 v[56:59], v[52:55], v[4:7], v[56:59]
  v_bitop3_b32 v73, v4, v6, s72 bitop3:0x7e
  v_or_b32 v72, v72, v73
  s_waitcnt vmcnt(1)
  v_mfma_f32_16x16x32_bf16 v[36:39], v[52:55], v[8:11], 0
  v_bitop3_b32 v73, v8, v10, s72 bitop3:0x7e
  v_or_b32 v72, v72, v73
  s_waitcnt vmcnt(0)
  v_mfma_f32_16x16x32_bf16 v[36:39], v[52:55], v[12:15], v[36:39]
  v_bitop3_b32 v73, v12, v14, s72 bitop3:0x7e
  v_bitop3_b32 v72, v72, v73, 1 bitop3:0xa8
  v_cmp_ne_u32 vcc, 0, v72
  s_cbranch_vccz Cf3_h1p
  s_cmp_lt_u32 s67, 131072
  s_cbranch_scc1 Cf3_h1s
Cf3_h1p:
  s_nop 2
  buffer_load_dwordx4 v[4:7], v76, s[8:11], s65 offen offset:1024 sc1
  v_add_f32_dpp v56, v56, v56 row_ror:4 row_mask:0xf bank_mask:0xf
  v_add_f32_dpp v57, v57, v57 row_ror:4 row_mask:0xf bank_mask:0xf
  v_add_f32_dpp v36, v36, v36 row_ror:4 row_mask:0xf bank_mask:0xf
  v_add_f32_dpp v37, v37, v37 row_ror:4 row_mask:0xf bank_mask:0xf
  v_add_f32_dpp v56, v56, v56 row_ror:8 row_mask:0xf bank_mask:0xf
  v_add_f32_dpp v57, v57, v57 row_ror:8 row_mask:0xf bank_mask:0xf
  v_add_f32_dpp v36, v36, v36 row_ror:8 row_mask:0xf bank_mask:0xf
  v_add_f32_dpp v37, v37, v37 row_ror:8 row_mask:0xf bank_mask:0xf
  v_cvt_pk_bf16_f32 v56, v56, v57
  buffer_store_dword v56, v69, s[8:11], s62 offen
  v_cvt_pk_bf16_f32 v36, v36, v37
  buffer_store_dword v36, v70, s[8:11], s63 offen
  s_xor_b32 s62, s62, 16384
  buffer_store_dword v71, v69, s[8:11], s62 offen
  s_xor_b32 s63, s63, 16384
  buffer_store_dword v71, v70, s[8:11], s63 offen
  s_xor_b32 s72, s72, 1
  s_branch Cf3_h2
Cf3_h2r:
  s_mov_b64 exec, vcc
  buffer_load_dwordx4 v[4:7], v76, s[8:11], s65 offen offset:1024 sc1
  s_mov_b64 exec, -1
  s_add_u32 s67, s67, 1
  s_waitcnt vmcnt(3)
  v_max3_u32 v72, v4, v5, v6
  v_max_u32 v72, v72, v7
  ds_write_b128 v76, v[4:7] offset:5632
  v_cmp_eq_u32 vcc, -1, v72
  s_cbranch_vccz Cf3_h2w
Cf3_h2s:
  s_mov_b64 exec, vcc
  buffer_load_dwordx4 v[4:7], v76, s[8:11], s65 offen offset:1024 sc1
  s_mov_b64 exec, -1
  s_add_u32 s67, s67, 1
  s_waitcnt vmcnt(1)
  v_max3_u32 v72, v4, v5, v6
  v_max_u32 v72, v72, v7
  ds_write_b128 v76, v[4:7] offset:5632
  v_cmp_eq_u32 vcc, -1, v72
  s_cbranch_vccz Cf3_h2w
  s_mov_b64 exec, vcc
  buffer_load_dwordx4 v[4:7], v76, s[8:11], s65 offen offset:1024 sc1
  s_mov_b64 exec, -1
  s_add_u32 s67, s67, 1
  s_waitcnt vmcnt(1)
  v_max3_u32 v72, v4, v5, v6
  v_max_u32 v72, v72, v7
  ds_write_b128 v76, v[4:7] offset:5632
  v_cmp_eq_u32 vcc, -1, v72
  s_cbranch_vccz Cf3_h2w
  s_mov_b64 exec, vcc
  buffer_load_dwordx4 v[4:7], v76, s[8:11], s65 offen offset:1024 sc1
  s_mov_b64 exec, -1
  s_add_u32 s67, s67, 1
  s_waitcnt vmcnt(1)
  v_max3_u32 v72, v4, v5, v6
  v_max_u32 v72, v72, v7
  ds_write_b128 v76, v[4:7] offset:5632
  v_cmp_eq_u32 vcc, -1, v72
  s_cbranch_vccz Cf3_h2w
  s_cmp_lt_u32 s67, 131072
  s_cbranch_scc1 Cf3_h2s
  s_branch Cf3_h2w
Cf3_rec:
  s_nop 7
  s_waitcnt vmcnt(0) lgkmcnt(0)
  v_max3_u32 v72, v0, v1, v2
  v_max3_u32 v72, v72, v3, v4
  v_max3_u32 v72, v72, v5, v6
  v_max3_u32 v72, v72, v7, v8
  v_max3_u32 v72, v72, v9, v10
  v_max3_u32 v72, v72, v11, v12
  v_max3_u32 v72, v72, v13, v14
  v_max3_u32 v72, v72, v15, v16
  v_max3_u32 v72, v72, v17, v18
  v_max_u32 v72, v72, v19
  v_cmp_eq_u32 vcc, -1, v72
  s_cbranch_vccz Cf3_recok
  s_barrier
Cf3_recp:
  buffer_load_dwordx4 v[0:3], v76, s[8:11], s64 offen offset:0 sc1
  buffer_load_dwordx4 v[4:7], v76, s[8:11], s64 offen offset:1024 sc1
  buffer_load_dwordx4 v[8:11], v76, s[8:11], s64 offen offset:2048 sc1
  s_add_u32 s67, s67, 1
  s_cmp_lt_u32 s67, 131072
  s_cselect_b32 s54, -2, -1
  s_waitcnt vmcnt(2)
  v_max3_u32 v72, v0, v1, v2
  s_waitcnt vmcnt(1)
  v_max3_u32 v72, v72, v3, v4
  v_max3_u32 v72, v72, v5, v6
  s_waitcnt vmcnt(0)
  v_max3_u32 v72, v72, v7, v8
  v_max3_u32 v72, v72, v9, v10
  v_max_u32 v72, v72, v11
  v_cmp_lt_u32 vcc, s54, v72
  s_cbranch_vccnz Cf3_recp
  ds_write_b128 v76, v[0:3] offset:10752
  ds_write_b128 v76, v[4:7] offset:11776
  ds_write_b128 v76, v[8:11] offset:12800
  v_mov_b64 v[20:21], 0
  v_mov_b64 v[22:23], 0
  v_mov_b64 v[24:25], 0
  v_mov_b64 v[26:27], 0
  v_mov_b64 v[28:29], 0
  v_mov_b64 v[30:31], 0
  v_mov_b64 v[32:33], 0
  v_mov_b64 v[34:35], 0
  s_waitcnt lgkmcnt(0)
  s_barrier
  ds_read_b128 v[0:3], v76 offset:4608
  s_waitcnt lgkmcnt(0)
  v_smfmac_f32_16x16x64_bf16 v[20:23], v[0:3], v[80:87], v74
  v_smfmac_f32_16x16x64_bf16 v[24:27], v[0:3], v[88:95], v74
  ds_read_b128 v[60:63], v76 offset:28672
  ds_read_b128 v[64:67], v76 offset:29696
  s_waitcnt lgkmcnt(0)
  v_smfmac_f32_16x16x64_bf16 v[28:31], v[0:3], v[60:67], v74
  ds_read_b128 v[60:63], v76 offset:30720
  ds_read_b128 v[64:67], v76 offset:31744
  s_waitcnt lgkmcnt(0)
  v_smfmac_f32_16x16x64_bf16 v[32:35], v[0:3], v[60:67], v74
  ds_read_b128 v[4:7], v76 offset:5632
  s_waitcnt lgkmcnt(0)
  v_smfmac_f32_16x16x64_bf16 v[20:23], v[4:7], v[96:103], v74
  v_smfmac_f32_16x16x64_bf16 v[24:27], v[4:7], v[104:111], v74
  ds_read_b128 v[60:63], v76 offset:45056
  ds_read_b128 v[64:67], v76 offset:46080
  s_waitcnt lgkmcnt(0)
  v_smfmac_f32_16x16x64_bf16 v[28:31], v[4:7], v[60:67], v74
  ds_read_b128 v[60:63], v76 offset:47104
  ds_read_b128 v[64:67], v76 offset:48128
  s_waitcnt lgkmcnt(0)
  v_smfmac_f32_16x16x64_bf16 v[32:35], v[4:7], v[60:67], v74
  ds_read_b128 v[8:11], v76 offset:6656
  s_waitcnt lgkmcnt(0)
  v_smfmac_f32_16x16x64_bf16 v[20:23], v[8:11], v[112:119], v74
  v_smfmac_f32_16x16x64_bf16 v[24:27], v[8:11], v[120:127], v74
  v_smfmac_f32_16x16x64_bf16 v[28:31], v[8:11], v[208:215], v74
  v_smfmac_f32_16x16x64_bf16 v[32:35], v[8:11], v[216:223], v74
  ds_read_b128 v[12:15], v76 offset:7680
  s_waitcnt lgkmcnt(0)
  v_smfmac_f32_16x16x64_bf16 v[20:23], v[12:15], v[128:135], v74
  v_smfmac_f32_16x16x64_bf16 v[24:27], v[12:15], v[136:143], v74
  v_smfmac_f32_16x16x64_bf16 v[28:31], v[12:15], v[224:231], v74
  v_smfmac_f32_16x16x64_bf16 v[32:35], v[12:15], v[232:239], v74
  ds_read_b128 v[4:7], v76 offset:8704
  s_waitcnt lgkmcnt(0)
  v_smfmac_f32_16x16x64_bf16 v[20:23], v[4:7], v[144:151], v74
  v_smfmac_f32_16x16x64_bf16 v[24:27], v[4:7], v[152:159], v74
  ds_read_b128 v[60:63], v76 offset:61440
  ds_read_b128 v[64:67], v76 offset:62464
  s_waitcnt lgkmcnt(0)
  v_smfmac_f32_16x16x64_bf16 v[28:31], v[4:7], v[60:67], v74
  ds_read_b128 v[60:63], v76 offset:63488
  ds_read_b128 v[64:67], v76 offset:64512
  s_waitcnt lgkmcnt(0)
  v_smfmac_f32_16x16x64_bf16 v[32:35], v[4:7], v[60:67], v74
  ds_read_b128 v[8:11], v76 offset:9728
  s_waitcnt lgkmcnt(0)
  v_smfmac_f32_16x16x64_bf16 v[20:23], v[8:11], v[160:167], v74
  v_smfmac_f32_16x16x64_bf16 v[24:27], v[8:11], v[168:175], v74
  ds_read_b128 v[60:63], v75 offset:28672
  ds_read_b128 v[64:67], v75 offset:29696
  s_waitcnt lgkmcnt(0)
  v_smfmac_f32_16x16x64_bf16 v[28:31], v[8:11], v[60:67], v74
  ds_read_b128 v[60:63], v75 offset:30720
  ds_read_b128 v[64:67], v75 offset:31744
  s_waitcnt lgkmcnt(0)
  v_smfmac_f32_16x16x64_bf16 v[32:35], v[8:11], v[60:67], v74
  ds_read_b128 v[16:19], v76 offset:10752
  ds_read_b128 v[60:63], v75 offset:12288
  ds_read_b128 v[64:67], v75 offset:13312
  s_waitcnt lgkmcnt(0)
  v_smfmac_f32_16x16x64_bf16 v[20:23], v[16:19], v[60:67], v74
  ds_read_b128 v[60:63], v75 offset:14336
  ds_read_b128 v[64:67], v75 offset:15360
  s_waitcnt lgkmcnt(0)
  v_smfmac_f32_16x16x64_bf16 v[24:27], v[16:19], v[60:67], v74
  v_smfmac_f32_16x16x64_bf16 v[28:31], v[16:19], v[240:247], v74
  v_smfmac_f32_16x16x64_bf16 v[32:35], v[16:19], v[248:255], v74
  ds_read_b128 v[0:3], v76 offset:11776
  s_waitcnt lgkmcnt(0)
  v_smfmac_f32_16x16x64_bf16 v[20:23], v[0:3], v[176:183], v74
  v_smfmac_f32_16x16x64_bf16 v[24:27], v[0:3], v[184:191], v74
  v_smfmac_f32_16x16x64_bf16 v[28:31], v[0:3], a[0:7], v74
  v_smfmac_f32_16x16x64_bf16 v[32:35], v[0:3], a[8:15], v74
  ds_read_b128 v[12:15], v76 offset:12800
  s_waitcnt lgkmcnt(0)
  v_smfmac_f32_16x16x64_bf16 v[20:23], v[12:15], v[192:199], v74
  v_smfmac_f32_16x16x64_bf16 v[24:27], v[12:15], v[200:207], v74
  v_smfmac_f32_16x16x64_bf16 v[28:31], v[12:15], a[16:23], v74
  v_smfmac_f32_16x16x64_bf16 v[32:35], v[12:15], a[24:31], v74
  v_add_f32 v20, v20, v22
  v_add_f32 v21, v21, v23
  v_add_f32 v24, v24, v26
  v_cvt_pk_bf16_f32 v22, v20, v24
  ds_write_b32 v79, v22 offset:0
  v_add_f32 v25, v25, v27
  v_cvt_pk_bf16_f32 v23, v21, v25
  ds_write_b32 v79, v23 offset:576
  v_add_f32 v28, v28, v30
  v_add_f32 v29, v29, v31
  s_waitcnt lgkmcnt(0)
  s_nop 1
  s_branch Cf3_recok
Cf3_mx:
  s_waitcnt lgkmcnt(0)
  s_barrier
  buffer_load_dwordx4 v[0:3], v76, s[8:11], s58 offen offset:0 sc1
  ds_read_b128 v[20:23], v77 offset:0
  ds_read_b128 v[28:31], v77 offset:256
  buffer_load_dwordx4 v[4:7], v76, s[8:11], s58 offen offset:1024 sc1
  ds_read_b128 v[24:27], v77 offset:128
  ds_read_b128 v[32:35], v77 offset:384
  s_waitcnt vmcnt(1) lgkmcnt(3)
  v_mfma_f32_16x16x32_bf16 v[8:11], v[0:3], v[20:23], 0
  s_waitcnt vmcnt(0) lgkmcnt(1)
  v_mfma_f32_16x16x32_bf16 v[8:11], v[4:7], v[24:27], v[8:11]
  v_mfma_f32_16x16x32_bf16 v[12:15], v[28:31], v[20:23], 0
  s_waitcnt lgkmcnt(0)
  v_mfma_f32_16x16x32_bf16 v[12:15], v[32:35], v[24:27], v[12:15]
  v_add_f32_dpp v8, v10, v8 quad_perm:[2,3,0,1] row_mask:0xf bank_mask:0xf
  v_add_f32_dpp v9, v11, v9 quad_perm:[2,3,0,1] row_mask:0xf bank_mask:0xf
  s_nop 0
  v_mov_b32_dpp v8, v8 quad_perm:[0,1,0,1] row_mask:0xf bank_mask:0xf
  v_mov_b32_dpp v9, v9 quad_perm:[0,1,0,1] row_mask:0xf bank_mask:0xf
  s_nop 1
  v_add_f32_dpp v12, v14, v12 quad_perm:[2,3,0,1] row_mask:0xf bank_mask:0xf
  v_add_f32_dpp v13, v15, v13 quad_perm:[2,3,0,1] row_mask:0xf bank_mask:0xf
  s_nop 0
  v_mov_b32_dpp v12, v12 quad_perm:[0,1,0,1] row_mask:0xf bank_mask:0xf
  v_mov_b32_dpp v13, v13 quad_perm:[0,1,0,1] row_mask:0xf bank_mask:0xf
  v_mul_f32 v12, s69, v12
  ds_write_b32 v78, v8 offset:8716
  v_mul_f32 v13, s69, v13
  ds_write_b32 v78, v9 offset:8780
  s_waitcnt lgkmcnt(0)
  s_barrier
  ds_read_b128 v[36:39], v78 offset:8704
  ds_read_b128 v[40:43], v78 offset:8768
  s_waitcnt lgkmcnt(0)
  s_barrier
  v_max_f32 v16, v36, v37
  v_max3_f32 v16, v16, v38, v39
  v_max3_f32 v16, v16, v40, v41
  v_max3_f32 v16, v16, v42, v43
  v_max3_f32 v16, v16, v12, v13
  v_mov_b32 v17, v16
  s_nop 1
  v_permlane16_swap_b32 v16, v17
  v_max_f32 v16, v16, v17
  v_mov_b32 v17, v16
  s_nop 1
  v_permlane32_swap_b32 v16, v17
  v_max_f32 v16, v16, v17
  v_sub_f32 v36, v36, v16
  v_sub_f32 v37, v37, v16
  v_sub_f32 v38, v38, v16
  v_sub_f32 v39, v39, v16
  v_sub_f32 v40, v40, v16
  v_sub_f32 v41, v41, v16
  v_sub_f32 v42, v42, v16
  v_sub_f32 v43, v43, v16
  v_sub_f32 v12, v12, v16
  v_sub_f32 v13, v13, v16
  v_exp_f32 v36, v36
  v_exp_f32 v37, v37
  v_exp_f32 v38, v38
  v_exp_f32 v39, v39
  v_exp_f32 v40, v40
  v_exp_f32 v41, v41
  v_exp_f32 v42, v42
  v_exp_f32 v43, v43
  v_exp_f32 v12, v12
  v_exp_f32 v13, v13
  v_cvt_pk_bf16_f32 v32, v36, v40
  v_cvt_pk_bf16_f32 v33, v37, v41
  v_cvt_pk_bf16_f32 v34, v38, v42
  v_cvt_pk_bf16_f32 v35, v39, v43
  v_cvt_pk_bf16_f32 v28, v12, v13
  v_cvt_pk_bf16_f32 v31, v12, v13
  v_mov_b32 v29, 0
  v_mov_b32 v30, 0
  v_mov_b32 v68, 0x3f803f80
  v_mov_b32 v69, 0x3f803f80
  v_mov_b32 v70, 0x3f803f80
  v_mov_b32 v71, 0x3f803f80
  s_nop 1
  v_mfma_f32_16x16x32_bf16 v[8:11], v[32:35], v[68:71], 0
  v_mfma_f32_16x16x32_bf16 v[0:3], v[32:35], v[52:55], 0
  v_mfma_f32_16x16x32_bf16 v[4:7], v[32:35], v[56:59], 0
  v_mfma_f32_16x16x16_bf16 v[8:11], v[28:29], v[68:69], v[8:11]
  v_mfma_f32_16x16x16_bf16 v[0:3], v[28:29], v[72:73], v[0:3]
  v_mfma_f32_16x16x16_bf16 v[4:7], v[30:31], v[72:73], v[4:7]
  ds_read_b128 v[68:71], v76 offset:13824
  v_rcp_f32 v10, v8
  v_rcp_f32 v11, v9
  v_mul_f32 v0, v10, v0
  v_mul_f32 v1, v11, v1
  s_nop 0
  v_mul_f32 v4, v10, v4
  v_mul_f32 v5, v11, v5
  v_cvt_pk_bf16_f32 v2, v0, v4
  ds_write_b32 v79, v2 offset:8704
  v_cvt_pk_bf16_f32 v3, v1, v5
  ds_write_b32 v79, v3 offset:9280
  v_mov_b64 v[16:17], 0
  v_mov_b64 v[18:19], 0
  v_mov_b64 v[20:21], 0
  v_mov_b64 v[22:23], 0
  v_mov_b64 v[24:25], 0
  v_mov_b64 v[26:27], 0
  s_branch Cf3_mxok
Cf3_last:
  ds_read_b128 v[0:3], v76 offset:4608
  ds_read_b128 v[12:15], v76 offset:7680
  ds_read_b128 v[44:47], v76 offset:28672
  ds_read_b128 v[48:51], v76 offset:29696
  s_nop 5
  v_mov_b64 v[20:21], 0
  v_mov_b64 v[22:23], 0
  v_mov_b64 v[24:25], 0
  v_mov_b64 v[26:27], 0
  v_smfmac_f32_16x16x64_bf16 v[28:31], v[4:7], v[36:43], v74
  ds_read_b128 v[36:39], v76 offset:30720
  ds_read_b128 v[40:43], v76 offset:31744
  v_smfmac_f32_16x16x64_bf16 v[32:35], v[4:7], v[60:67], v74
  s_waitcnt lgkmcnt(5)
  v_smfmac_f32_16x16x64_bf16 v[20:23], v[0:3], a[32:39], v74
  ds_read_b128 v[60:63], v76 offset:61440
  ds_read_b128 v[64:67], v76 offset:62464
  v_smfmac_f32_16x16x64_bf16 v[24:27], v[0:3], a[40:47], v74
  s_waitcnt lgkmcnt(4)
  v_smfmac_f32_16x16x64_bf16 v[20:23], v[4:7], a[48:55], v74
  buffer_store_dwordx4 v[16:19], v76, s[8:11], s68 offen sc1
  v_smfmac_f32_16x16x64_bf16 v[24:27], v[4:7], a[56:63], v74
  v_smfmac_f32_16x16x64_bf16 v[28:31], v[0:3], v[44:51], v74
  s_waitcnt lgkmcnt(2)
  v_smfmac_f32_16x16x64_bf16 v[20:23], v[8:11], a[64:71], v74
  ds_read_b128 v[44:47], v76 offset:63488
  ds_read_b128 v[48:51], v76 offset:64512
  v_smfmac_f32_16x16x64_bf16 v[24:27], v[8:11], a[72:79], v74
  v_smfmac_f32_16x16x64_bf16 v[32:35], v[0:3], v[36:43], v74
  v_smfmac_f32_16x16x64_bf16 v[28:31], v[8:11], v[208:215], v74
  ds_read_b128 v[36:39], v75 offset:28672
  ds_read_b128 v[40:43], v75 offset:29696
  v_smfmac_f32_16x16x64_bf16 v[32:35], v[8:11], v[216:223], v74
  v_smfmac_f32_16x16x64_bf16 v[20:23], v[12:15], a[80:87], v74
  v_smfmac_f32_16x16x64_bf16 v[24:27], v[12:15], a[88:95], v74
  v_smfmac_f32_16x16x64_bf16 v[28:31], v[12:15], v[224:231], v74
  v_smfmac_f32_16x16x64_bf16 v[32:35], v[12:15], v[232:239], v74
  s_waitcnt vmcnt(1)
  s_barrier
Cf3_lastr:
  ds_read_b128 v[4:7], v76 offset:8704
  ds_read_b128 v[8:11], v76 offset:9728
  ds_read_b128 v[16:19], v76 offset:10752
  ds_read_b128 v[0:3], v76 offset:11776
  ds_read_b128 v[12:15], v76 offset:12800
  s_waitcnt lgkmcnt(1)
  v_max3_u32 v72, v0, v1, v2
  v_max3_u32 v72, v72, v3, v4
  v_max3_u32 v72, v72, v5, v6
  v_max3_u32 v72, v72, v7, v8
  v_max3_u32 v72, v72, v9, v10
  s_waitcnt lgkmcnt(0)
  v_max3_u32 v72, v72, v11, v12
  v_max3_u32 v72, v72, v13, v14
  v_max3_u32 v72, v72, v15, v16
  v_max3_u32 v72, v72, v17, v18
  v_max_u32 v72, v72, v19
  v_cmp_eq_u32 vcc, -1, v72
  s_cbranch_vccnz Cf3_lastp
Cf3_lastg:
  v_smfmac_f32_16x16x64_bf16 v[28:31], v[4:7], v[60:67], v74
  ds_read_b128 v[60:63], v75 offset:30720
  ds_read_b128 v[64:67], v75 offset:31744
  v_smfmac_f32_16x16x64_bf16 v[32:35], v[4:7], v[44:51], v74
  v_smfmac_f32_16x16x64_bf16 v[28:31], v[8:11], v[36:43], v74
  v_smfmac_f32_16x16x64_bf16 v[28:31], v[16:19], v[240:247], v74
  v_smfmac_f32_16x16x64_bf16 v[28:31], v[0:3], a[0:7], v74
  v_smfmac_f32_16x16x64_bf16 v[28:31], v[12:15], a[16:23], v74
  v_smfmac_f32_16x16x64_bf16 v[32:35], v[16:19], v[248:255], v74
  v_smfmac_f32_16x16x64_bf16 v[32:35], v[0:3], a[8:15], v74
  s_waitcnt lgkmcnt(0)
  v_smfmac_f32_16x16x64_bf16 v[32:35], v[12:15], a[24:31], v74
  v_smfmac_f32_16x16x64_bf16 v[32:35], v[8:11], v[60:67], v74
  v_smfmac_f32_16x16x64_bf16 v[20:23], v[4:7], a[96:103], v74
  v_smfmac_f32_16x16x64_bf16 v[20:23], v[8:11], a[112:119], v74
  v_add_f32 v28, v28, v30
  v_add_f32 v32, v32, v34
  v_cvt_pk_bf16_f32 v30, v28, v32
  v_smfmac_f32_16x16x64_bf16 v[20:23], v[16:19], a[128:135], v74
  ds_write_b32 v79, v30 offset:256
  v_add_f32 v29, v29, v31
  v_add_f32 v33, v33, v35
  v_cvt_pk_bf16_f32 v31, v29, v33
  v_smfmac_f32_16x16x64_bf16 v[20:23], v[0:3], a[144:151], v74
  ds_write_b32 v79, v31 offset:832
  v_smfmac_f32_16x16x64_bf16 v[20:23], v[12:15], a[160:167], v74
  v_smfmac_f32_16x16x64_bf16 v[24:27], v[4:7], a[104:111], v74
  v_smfmac_f32_16x16x64_bf16 v[24:27], v[8:11], a[120:127], v74
  v_smfmac_f32_16x16x64_bf16 v[24:27], v[16:19], a[136:143], v74
  s_waitcnt lgkmcnt(0)
  s_barrier
  ds_read_b64 v[52:53], v77 offset:392
  v_add_f32 v20, v20, v22
  v_smfmac_f32_16x16x64_bf16 v[24:27], v[0:3], a[152:159], v74
  v_add_f32 v21, v21, v23
  v_smfmac_f32_16x16x64_bf16 v[24:27], v[12:15], a[168:175], v74
  v_cvt_pk_bf16_f32 v54, v20, v21
  s_add_u32 s68, s68, 655360
  s_nop 3
  v_add_f32 v24, v24, v26
  v_add_f32 v25, v25, v27
  v_cvt_pk_bf16_f32 v55, v24, v25
  s_waitcnt lgkmcnt(0)
  buffer_store_dwordx4 v[52:55], v76, s[8:11], s68 offen sc1
  s_branch Cf3_done
Cf3_lastp:
  s_add_u32 s72, s72, 2
  s_cmp_ge_u32 s72, 131072
  s_cbranch_scc1 Cf3_lastg
  s_barrier
  buffer_load_dwordx4 v76, s[8:11], s85 offen offset:0 sc1 lds
  buffer_load_dwordx4 v76, s[8:11], s85 offen offset:1024 sc1 lds
  s_waitcnt vmcnt(0)
  s_barrier
  s_branch Cf3_lastr
Cf3_done:
  s_branch L_cexit
L_w4:
  v_mov_b64 v[20:21], 0
  v_mov_b64 v[22:23], 0
  v_mov_b64 v[24:25], 0
  v_mov_b64 v[26:27], 0
  v_mov_b64 v[28:29], 0
  v_mov_b64 v[30:31], 0
  v_mov_b64 v[32:33], 0
  v_mov_b64 v[34:35], 0
  s_mov_b32 s78, 0x3f803f80
  s_mov_b32 s79, s78
  s_mov_b32 s65, 360448
  s_mov_b32 m0, 16128
  s_lshl_b32 s71, s53, 2
  s_add_u32 s71, s71, 128
  s_movk_i32 s56, 0x1000
  v_lshlrev_b32 v73, 2, v76
  v_mov_b32 v72, 0
  s_mov_b64 s[16:17], s[8:9]
  s_mov_b32 s18, 268435456
  s_mov_b32 s19, 0x20000
  s_getpc_b64 s[20:21]
Cs0_pc:
  s_add_u32 s20, s20, (Cs0_last - Cs0_pc)
  s_addc_u32 s21, s21, 0
  v_mov_b32 v68, 14880
  buffer_load_dwordx4 v[52:55], v76, s[8:11], s59 offen offset:0 sc1
  buffer_load_dwordx4 v[56:59], v76, s[8:11], s59 offen offset:1024 sc1
  ds_read_b128 v[36:39], v76 offset:16384
  ds_read_b128 v[40:43], v76 offset:17408
  ds_read_b128 v[60:63], v76 offset:18432
  ds_read_b128 v[64:67], v76 offset:19456
  ds_read_b128 v[0:3], v76 offset:4608
  ds_read_b128 v[4:7], v76 offset:5632
  ds_read_b128 v[8:11], v76 offset:6656
  ds_read_b128 v[12:15], v76 offset:7680
  s_waitcnt lgkmcnt(0)
  s_cmp_eq_u32 s66, 1
  s_branch Cs0_top2
.p2align 6
Cs0_h2:
  s_cmp_eq_u32 s66, 62
  s_cselect_b64 s[16:17], s[20:21], s[16:17]
  s_cselect_b32 s18, (Cs0_done - Cs0_last), s18
  s_cselect_b32 s70, 0, s70
  s_cmp_eq_u32 s66, 63
  s_cselect_b32 s59, 268435456, s59
  s_cselect_b32 s58, 268435456, s58
  s_cmp_eq_u32 s66, 12
  s_cselect_b32 s56, s71, 0x1000
  ds_read_b32 v72, v76 offset:16128
  s_cmp_eq_u32 s66, 13
  s_cselect_b32 s54, 0x700, 0
  s_waitcnt lgkmcnt(0)
  v_readfirstlane_b32 s57, v72
  s_nop 0
  s_cmp_lt_u32 s57, s54
  s_cbranch_scc1 Cs0_kv3
Cs0_kvb:
  buffer_load_dwordx4 v[0:3], v76, s[8:11], s65 offen offset:0 sc1
  ds_read_b128 v[36:39], v76 offset:16384
  s_waitcnt lgkmcnt(0)
  v_mov_b64 v[20:21], 0
  v_mov_b64 v[22:23], 0
  v_mov_b64 v[24:25], 0
  v_mov_b64 v[26:27], 0
  v_mov_b32 v68, 14880
  buffer_load_dwordx4 v[0:3], v76, s[8:11], s65 offen offset:0 sc1
  ds_read_b128 v[40:43], v76 offset:17408
  s_waitcnt lgkmcnt(0)
  v_mov_b64 v[28:29], 0
  v_mov_b64 v[30:31], 0
  v_mov_b64 v[32:33], 0
  v_mov_b64 v[34:35], 0
  v_lshlrev_b32 v73, 2, v76
  buffer_load_dwordx4 v[0:3], v76, s[8:11], s65 offen offset:0 sc1
  ds_read_b128 v[60:63], v76 offset:18432
  s_waitcnt lgkmcnt(0)
  buffer_load_dwordx4 v[52:55], v76, s[8:11], s59 offen offset:0 sc1
  buffer_load_dwordx4 v[56:59], v76, s[8:11], s59 offen offset:1024 sc1
  s_waitcnt vmcnt(4)
  v_max3_u32 v72, v0, v1, v2
  v_max_u32 v72, v72, v3
  ds_write_b128 v76, v[0:3] offset:4608
  v_cmp_eq_u32 vcc, -1, v72
  s_cbranch_vccnz Cs0_h2r
Cs0_h2w:
  s_cmp_eq_u32 s66, 63
  s_waitcnt lgkmcnt(0)
  s_barrier
  ds_read_b128 v[8:11], v76 offset:6656
  buffer_load_dwordx4 v76, s[8:11], s85 offen offset:0 sc1 lds
Cs0_top2:
  v_smfmac_f32_16x16x64_bf16 v[20:23], v[0:3], v[80:87], v74
  s_cbranch_scc1 Cs0_last
  v_smfmac_f32_16x16x64_bf16 v[28:31], v[0:3], v[36:43], v74
  buffer_load_dwordx4 v[44:47], v76, s[8:11], s58 offen offset:0 sc1
  s_mov_b32 m0, 16128
  v_smfmac_f32_16x16x64_bf16 v[24:27], v[0:3], v[88:95], v74
  buffer_load_dwordx4 v[48:51], v76, s[8:11], s58 offen offset:1024 sc1
  v_smfmac_f32_16x16x64_bf16 v[32:35], v[0:3], v[60:67], v74
  ds_read_b128 v[4:7], v76 offset:5632
  s_waitcnt lgkmcnt(1)
  v_smfmac_f32_16x16x64_bf16 v[20:23], v[8:11], v[112:119], v74
  ds_read_b128 v[12:15], v76 offset:7680
  v_smfmac_f32_16x16x64_bf16 v[24:27], v[8:11], v[120:127], v74
  ds_read_b128 v[36:39], v76 offset:32768
  v_smfmac_f32_16x16x64_bf16 v[28:31], v[8:11], v[208:215], v74
  buffer_store_dwordx4 v[16:19], v76, s[8:11], s68 offen sc1
  ds_read_b128 v[40:43], v76 offset:33792
  v_smfmac_f32_16x16x64_bf16 v[32:35], v[8:11], v[216:223], v74
  ds_read_b128 v[60:63], v76 offset:34816
  s_waitcnt lgkmcnt(4)
  v_smfmac_f32_16x16x64_bf16 v[20:23], v[4:7], v[96:103], v74
  ds_read_b128 v[64:67], v76 offset:35840
  v_smfmac_f32_16x16x64_bf16 v[24:27], v[4:7], v[104:111], v74
  buffer_load_dword v73, s[16:19], s70 offen lds
  s_waitcnt vmcnt(5)
  s_waitcnt lgkmcnt(4)
  v_smfmac_f32_16x16x64_bf16 v[20:23], v[12:15], v[128:135], v74
  s_barrier
  s_waitcnt lgkmcnt(2)
  v_smfmac_f32_16x16x64_bf16 v[28:31], v[4:7], v[36:43], v74
  ds_read_b128 v[0:3], v76 offset:8704
  v_smfmac_f32_16x16x64_bf16 v[24:27], v[12:15], v[136:143], v74
  ds_read_b128 v[36:39], v76 offset:49152
  s_waitcnt lgkmcnt(2)
  v_smfmac_f32_16x16x64_bf16 v[32:35], v[4:7], v[60:67], v74
  ds_read_b128 v[40:43], v76 offset:50176
  v_smfmac_f32_16x16x64_bf16 v[28:31], v[12:15], v[224:231], v74
  ds_read_b128 v[60:63], v76 offset:51200
  v_smfmac_f32_16x16x64_bf16 v[32:35], v[12:15], v[232:239], v74
  ds_read_b128 v[64:67], v76 offset:52224
  s_waitcnt lgkmcnt(4)
  v_smfmac_f32_16x16x64_bf16 v[20:23], v[0:3], v[144:151], v74
  s_waitcnt vmcnt(4)
  ds_read_b128 v[8:11], v76 offset:9728
  s_waitcnt lgkmcnt(3)
  v_smfmac_f32_16x16x64_bf16 v[28:31], v[0:3], v[36:43], v74
  s_barrier
  ds_read_b128 v[4:7], v76 offset:11776
  v_smfmac_f32_16x16x64_bf16 v[24:27], v[0:3], v[152:159], v74
  ds_read_b128 v[36:39], v75 offset:0
  ds_read_b128 v[40:43], v75 offset:1024
  s_waitcnt lgkmcnt(4)
  v_smfmac_f32_16x16x64_bf16 v[32:35], v[0:3], v[60:67], v74
  ds_read_b128 v[16:19], v76 offset:10752
  s_waitcnt lgkmcnt(4)
  v_smfmac_f32_16x16x64_bf16 v[20:23], v[8:11], v[160:167], v74
  ds_read_b128 v[12:15], v76 offset:12800
  v_smfmac_f32_16x16x64_bf16 v[24:27], v[8:11], v[168:175], v74
  ds_read_b128 v[60:63], v75 offset:2048
  ds_read_b128 v[64:67], v75 offset:3072
  s_waitcnt lgkmcnt(6)
  v_smfmac_f32_16x16x64_bf16 v[20:23], v[4:7], v[176:183], v74
  s_waitcnt lgkmcnt(3)
  v_smfmac_f32_16x16x64_bf16 v[20:23], v[16:19], v[36:43], v74
  ds_read_b128 v[36:39], v75 offset:16384
  s_waitcnt lgkmcnt(3)
  v_smfmac_f32_16x16x64_bf16 v[20:23], v[12:15], v[192:199], v74
  ds_read_b128 v[40:43], v75 offset:17408
  s_waitcnt lgkmcnt(2)
  v_smfmac_f32_16x16x64_bf16 v[24:27], v[16:19], v[60:67], v74
  ds_read_b128 v[60:63], v75 offset:18432
  v_smfmac_f32_16x16x64_bf16 v[24:27], v[4:7], v[184:191], v74
  ds_read_b128 v[64:67], v75 offset:19456
  v_add_f32 v20, v20, v22
  v_smfmac_f32_16x16x64_bf16 v[24:27], v[12:15], v[200:207], v74
  buffer_load_dword off, s[12:15], s56 sc1 lds
  v_add_f32 v21, v21, v23
  v_smfmac_f32_16x16x64_bf16 v[28:31], v[16:19], v[240:247], v74
  s_waitcnt lgkmcnt(2)
  v_mov_b64 v[70:71], s[78:79]
  v_smfmac_f32_16x16x64_bf16 v[28:31], v[8:11], v[36:43], v74
  ds_read_b128 v[36:39], v68
  v_add_f32 v24, v24, v26
  v_smfmac_f32_16x16x64_bf16 v[28:31], v[4:7], a[0:7], v74
  ds_read_b128 v[40:43], v68
  v_cvt_pk_bf16_f32 v22, v20, v24
  v_smfmac_f32_16x16x64_bf16 v[28:31], v[12:15], a[16:23], v74
  ds_write_b32 v79, v22 offset:0
  s_waitcnt lgkmcnt(3)
  v_add_f32 v25, v25, v27
  v_cvt_pk_bf16_f32 v23, v21, v25
  v_smfmac_f32_16x16x64_bf16 v[32:35], v[8:11], v[60:67], v74
  ds_write_b32 v79, v23 offset:576
  v_cmp_u_f32 vcc, v20, v21
  v_smfmac_f32_16x16x64_bf16 v[32:35], v[16:19], v[248:255], v74
  v_add_f32 v28, v28, v30
  v_smfmac_f32_16x16x64_bf16 v[32:35], v[4:7], a[8:15], v74
  v_add_f32 v29, v29, v31
  v_smfmac_f32_16x16x64_bf16 v[32:35], v[12:15], a[24:31], v74
  s_cbranch_vccnz Cs0_rec
Cs0_recok:
  s_waitcnt lgkmcnt(3)
  v_smfmac_f32_16x16x64_bf16 v[36:39], v[16:19], a[128:135], v74
  s_waitcnt lgkmcnt(0)
  s_barrier
  ds_read_b128 v[60:63], v77
  v_smfmac_f32_16x16x64_bf16 v[40:43], v[16:19], a[136:143], v74
  ds_read_b128 v[64:67], v77 offset:128
  v_add_f32 v32, v32, v34
  v_cvt_pk_bf16_f32 v30, v28, v32
  v_smfmac_f32_16x16x64_bf16 v[36:39], v[0:3], a[96:103], v74
  ds_write_b32 v79, v30 offset:256
  v_add_f32 v33, v33, v35
  v_cvt_pk_bf16_f32 v31, v29, v33
  v_smfmac_f32_16x16x64_bf16 v[40:43], v[0:3], a[104:111], v74
  ds_write_b32 v79, v31 offset:832
  v_xor_b32 v75, 0x8000, v75
  v_smfmac_f32_16x16x64_bf16 v[36:39], v[4:7], a[144:151], v74
  ds_read_b128 v[0:3], v76 offset:4608
  v_mov_b32 v29, 0
  v_smfmac_f32_16x16x64_bf16 v[40:43], v[4:7], a[152:159], v74
  s_waitcnt vmcnt(3) lgkmcnt(3)
  v_mov_b32 v30, 0
  v_mfma_f32_16x16x32_bf16 v[44:47], v[44:47], v[60:63], 0
  ds_read_b128 v[4:7], v76 offset:5632
  s_waitcnt lgkmcnt(2)
  v_mfma_f32_16x16x32_bf16 v[44:47], v[48:51], v[64:67], v[44:47]
  s_barrier
  v_smfmac_f32_16x16x64_bf16 v[36:39], v[8:11], a[112:119], v74
  ds_read_b128 v[20:23], v77 offset:256
  ds_read_b128 v[24:27], v77 offset:384
  v_smfmac_f32_16x16x64_bf16 v[40:43], v[8:11], a[120:127], v74
  ds_read_b128 v[8:11], v76 offset:6656
  v_add_f32_dpp v72, v46, v44 quad_perm:[2,3,0,1] row_mask:0xf bank_mask:0xf
  v_add_f32_dpp v73, v47, v45 quad_perm:[2,3,0,1] row_mask:0xf bank_mask:0xf
  v_smfmac_f32_16x16x64_bf16 v[36:39], v[12:15], a[160:167], v74
  s_waitcnt lgkmcnt(4)
  v_exp_f32_dpp v72, v72 quad_perm:[0,1,0,1] row_mask:0xf bank_mask:0xf
  v_smfmac_f32_16x16x64_bf16 v[40:43], v[12:15], a[168:175], v74
  ds_read_b128 v[12:15], v76 offset:7680
  v_exp_f32_dpp v73, v73 quad_perm:[0,1,0,1] row_mask:0xf bank_mask:0xf
  v_smfmac_f32_16x16x64_bf16 v[36:39], v[0:3], a[32:39], v74
  s_waitcnt lgkmcnt(2)
  v_cvt_pk_bf16_f32 v72, v72, v73
  v_mfma_f32_16x16x32_bf16 v[20:23], v[20:23], v[60:63], 0
  ds_write_b32 v78, v72 offset:512
  v_mov_b64 v[16:17], 0
  v_mfma_f32_16x16x32_bf16 v[20:23], v[24:27], v[64:67], v[20:23]
  ds_read_b128 v[44:47], v75 offset:16384
  v_mov_b64 v[18:19], 0
  v_smfmac_f32_16x16x64_bf16 v[40:43], v[0:3], a[40:47], v74
  ds_read_b128 v[48:51], v75 offset:17408
  v_mov_b64 v[68:69], s[78:79]
  v_smfmac_f32_16x16x64_bf16 v[36:39], v[4:7], a[48:55], v74
  s_waitcnt lgkmcnt(4)
  v_add_f32_dpp v24, v22, v20 quad_perm:[2,3,0,1] row_mask:0xf bank_mask:0xf
  v_add_f32_dpp v25, v23, v21 quad_perm:[2,3,0,1] row_mask:0xf bank_mask:0xf
  v_smfmac_f32_16x16x64_bf16 v[36:39], v[8:11], a[64:71], v74
  s_waitcnt lgkmcnt(2)
  s_barrier
  ds_read_b128 v[32:35], v78 offset:512
  v_smfmac_f32_16x16x64_bf16 v[36:39], v[12:15], a[80:87], v74
  ds_read_b128 v[60:63], v75 offset:18432
  v_mul_f32 v24, s69, v24
  v_smfmac_f32_16x16x64_bf16 v[40:43], v[4:7], a[56:63], v74
  ds_read_b128 v[64:67], v75 offset:19456
  v_mul_f32 v25, s69, v25
  v_smfmac_f32_16x16x64_bf16 v[40:43], v[8:11], a[72:79], v74
  v_exp_f32_dpp v24, v24 quad_perm:[0,1,0,1] row_mask:0xf bank_mask:0xf
  v_smfmac_f32_16x16x64_bf16 v[40:43], v[12:15], a[88:95], v74
  s_waitcnt lgkmcnt(2)
  v_exp_f32_dpp v25, v25 quad_perm:[0,1,0,1] row_mask:0xf bank_mask:0xf
  v_mfma_f32_16x16x32_bf16 v[8:11], v[32:35], v[68:71], 0
  v_add_f32 v36, v36, v38
  v_add_f32 v37, v37, v39
  v_mfma_f32_16x16x32_bf16 v[0:3], v[32:35], v[52:55], 0
  v_add_f32 v40, v40, v42
  v_add_f32 v41, v41, v43
  v_mfma_f32_16x16x32_bf16 v[4:7], v[32:35], v[56:59], 0
  v_cvt_pk_bf16_f32 v28, v24, v25
  v_cvt_pk_bf16_f32 v72, v36, v37
  v_cvt_pk_bf16_f32 v73, v40, v41
  v_mfma_f32_16x16x16_bf16 v[8:11], v[28:29], v[68:69], v[8:11]
  v_cvt_pk_bf16_f32 v31, v24, v25
  v_mov_b64 v[20:21], 0
  v_mfma_f32_16x16x16_bf16 v[0:3], v[28:29], v[72:73], v[0:3]
  ds_read_b128 v[68:71], v76 offset:13824
  v_mov_b64 v[22:23], 0
  v_mfma_f32_16x16x16_bf16 v[4:7], v[30:31], v[72:73], v[4:7]
  v_rcp_f32 v10, v8
  v_rcp_f32 v11, v9
  v_mul_f32 v0, v10, v0
  v_mul_f32 v1, v11, v1
  s_nop 0
  v_mul_f32 v4, v10, v4
  v_mul_f32 v5, v11, v5
  v_cvt_pk_bf16_f32 v2, v0, v4
  ds_write_b32 v79, v2 offset:8704
  v_cvt_pk_bf16_f32 v3, v1, v5
  ds_write_b32 v79, v3 offset:9280
  v_max3_f32 v8, v8, v9, v10
  v_max_f32 v8, v8, v11
  v_cmp_le_f32 vcc, 1317011456, v8
  v_mov_b64 v[24:25], 0
  v_mov_b64 v[26:27], 0
  s_cbranch_vccnz Cs0_mx
Cs0_mxok:
  s_waitcnt lgkmcnt(0)
  s_barrier
  ds_read_b128 v[0:3], v78 offset:8704
  ds_read_b128 v[4:7], v78 offset:8768
  ds_read_b128 v[8:11], v78 offset:8832
  ds_read_b128 v[12:15], v78 offset:8896
  s_waitcnt lgkmcnt(3)
  v_smfmac_f32_16x16x64_bf16 v[16:19], v[0:3], v[44:51], v74
  ds_read_b128 v[52:55], v75 offset:32768
  s_waitcnt lgkmcnt(3)
  v_smfmac_f32_16x16x64_bf16 v[16:19], v[4:7], v[60:67], v74
  ds_read_b128 v[56:59], v75 offset:33792
  s_waitcnt lgkmcnt(3)
  v_smfmac_f32_16x16x64_bf16 v[16:19], v[8:11], a[176:183], v74
  ds_read_b128 v[36:39], v75 offset:34816
  s_waitcnt lgkmcnt(3)
  v_smfmac_f32_16x16x64_bf16 v[16:19], v[12:15], a[184:191], v74
  ds_read_b128 v[40:43], v75 offset:35840
  ds_read_b128 v[44:47], v75 offset:49152
  v_smfmac_f32_16x16x64_bf16 v[20:23], v[0:3], a[192:199], v74
  ds_read_b128 v[48:51], v75 offset:50176
  ds_read_b128 v[60:63], v75 offset:51200
  v_smfmac_f32_16x16x64_bf16 v[20:23], v[4:7], a[200:207], v74
  ds_read_b128 v[64:67], v75 offset:52224
  s_waitcnt lgkmcnt(6)
  v_cvt_pk_bf16_f32 v16, v16, v17
  v_cvt_pk_bf16_f32 v17, v18, v19
  v_bfi_b32 v16, 1, s72, v16
  v_smfmac_f32_16x16x64_bf16 v[20:23], v[8:11], v[52:59], v74
  buffer_store_dwordx2 v[16:17], v68, s[8:11], s73 offen sc1
  s_waitcnt lgkmcnt(4)
  v_smfmac_f32_16x16x64_bf16 v[20:23], v[12:15], v[36:43], v74
  v_mov_b64 v[32:33], 0
  v_smfmac_f32_16x16x64_bf16 v[24:27], v[0:3], a[208:215], v74
  v_mov_b64 v[34:35], 0
  v_smfmac_f32_16x16x64_bf16 v[24:27], v[4:7], a[216:223], v74
  s_waitcnt lgkmcnt(2)
  v_cvt_pk_bf16_f32 v20, v20, v21
  v_cvt_pk_bf16_f32 v21, v22, v23
  v_bfi_b32 v20, 1, s72, v20
  v_smfmac_f32_16x16x64_bf16 v[24:27], v[8:11], v[44:51], v74
  buffer_store_dwordx2 v[20:21], v68, s[8:11], s74 offen sc1
  s_waitcnt lgkmcnt(0)
  v_smfmac_f32_16x16x64_bf16 v[24:27], v[12:15], v[60:67], v74
  v_smfmac_f32_16x16x64_bf16 v[32:35], v[0:3], a[224:231], v74
  v_smfmac_f32_16x16x64_bf16 v[32:35], v[4:7], a[232:239], v74
  v_cvt_pk_bf16_f32 v24, v24, v25
  v_cvt_pk_bf16_f32 v25, v26, v27
  v_bfi_b32 v24, 1, s72, v24
  v_smfmac_f32_16x16x64_bf16 v[32:35], v[8:11], a[240:247], v74
  buffer_store_dwordx2 v[24:25], v68, s[8:11], s75 offen sc1
  v_smfmac_f32_16x16x64_bf16 v[32:35], v[12:15], a[248:255], v74
  v_mov_b64 v[18:19], v[72:73]
  s_nop 4
  v_cvt_pk_bf16_f32 v32, v32, v33
  v_cvt_pk_bf16_f32 v33, v34, v35
  v_bfi_b32 v32, 1, s72, v32
  buffer_store_dwordx2 v[32:33], v68, s[8:11], s76 offen sc1
  ds_read_b128 v[0:3], v76 offset:14848
  s_waitcnt lgkmcnt(0)
  ds_read_b64 v[16:17], v77 offset:256
  s_waitcnt lgkmcnt(0)
  ds_read_b128 v[64:67], v76 offset:19456
  s_waitcnt lgkmcnt(0)
  v_xor_b32 v75, 0x8000, v75
  buffer_load_dwordx4 v[52:55], v76, s[8:11], s60 offen offset:0 sc1
  buffer_load_dwordx4 v[56:59], v76, s[8:11], s60 offen offset:1024 sc1
  s_add_u32 s66, s66, 1
  s_xor_b32 s64, s64, 16384
  s_xor_b32 s65, s65, 16384
  s_add_u32 s58, s58, 655360
  s_add_u32 s59, s59, 655360
  s_add_u32 s70, s70, 655360
  s_add_u32 s68, s68, 655360
  s_mov_b32 m0, 10752
  s_add_u32 s85, s65, 6144
  s_waitcnt lgkmcnt(0)
  s_waitcnt vmcnt(1)
  v_mfma_f32_16x16x32_bf16 v[4:7], v[0:3], v[52:55], 0
  v_bitop3_b32 v72, v52, v54, s72 bitop3:0x7e
  s_waitcnt vmcnt(0)
  v_mfma_f32_16x16x32_bf16 v[4:7], v[0:3], v[56:59], v[4:7]
  v_bitop3_b32 v73, v56, v58, s72 bitop3:0x7e
  v_bitop3_b32 v72, v72, v73, 1 bitop3:0xa8
  v_cmp_ne_u32 vcc, 0, v72
  s_nop 0
  s_cmp_eq_u64 vcc, 0
  s_cselect_b32 s54, s62, 268435456
  s_nop 0
  v_add_f32_dpp v4, v4, v4 row_ror:4 row_mask:0xf bank_mask:0xf
  v_add_f32_dpp v5, v5, v5 row_ror:4 row_mask:0xf bank_mask:0xf
  s_nop 0
  v_add_f32_dpp v4, v4, v4 row_ror:8 row_mask:0xf bank_mask:0xf
  v_add_f32_dpp v5, v5, v5 row_ror:8 row_mask:0xf bank_mask:0xf
  v_cvt_pk_bf16_f32 v4, v4, v5
  buffer_store_dword v4, v69, s[8:11], s54 offen sc1
  s_cbranch_vccnz Cs0_h1r
  s_xor_b32 s62, s62, 16384
  buffer_store_dword v71, v69, s[8:11], s62 offen sc1
  s_xor_b32 s72, s72, 1
  s_branch Cs0_h2
Cs0_h1r:
  s_mov_b64 exec, vcc
  buffer_load_dwordx4 v[52:55], v76, s[8:11], s60 offen offset:0 sc1
  buffer_load_dwordx4 v[56:59], v76, s[8:11], s60 offen offset:1024 sc1
  s_mov_b64 exec, -1
  s_add_u32 s67, s67, 1
  s_waitcnt vmcnt(1)
  v_mfma_f32_16x16x32_bf16 v[4:7], v[0:3], v[52:55], 0
  v_bitop3_b32 v72, v52, v54, s72 bitop3:0x7e
  s_waitcnt vmcnt(0)
  v_mfma_f32_16x16x32_bf16 v[4:7], v[0:3], v[56:59], v[4:7]
  v_bitop3_b32 v73, v56, v58, s72 bitop3:0x7e
  v_bitop3_b32 v72, v72, v73, 1 bitop3:0xa8
  v_cmp_ne_u32 vcc, 0, v72
  s_cbranch_vccz Cs0_h1p
Cs0_h1s:
  s_mov_b64 exec, vcc
  buffer_load_dwordx4 v[52:55], v76, s[8:11], s60 offen offset:0 sc1
  buffer_load_dwordx4 v[56:59], v76, s[8:11], s60 offen offset:1024 sc1
  s_mov_b64 exec, -1
  s_add_u32 s67, s67, 1
  s_waitcnt vmcnt(1)
  v_mfma_f32_16x16x32_bf16 v[4:7], v[0:3], v[52:55], 0
  v_bitop3_b32 v72, v52, v54, s72 bitop3:0x7e
  s_waitcnt vmcnt(0)
  v_mfma_f32_16x16x32_bf16 v[4:7], v[0:3], v[56:59], v[4:7]
  v_bitop3_b32 v73, v56, v58, s72 bitop3:0x7e
  v_bitop3_b32 v72, v72, v73, 1 bitop3:0xa8
  v_cmp_ne_u32 vcc, 0, v72
  s_cbranch_vccz Cs0_h1p
  s_cmp_lt_u32 s67, 131072
  s_cbranch_scc1 Cs0_h1s
Cs0_h1p:
  s_nop 2
  v_add_f32_dpp v4, v4, v4 row_ror:4 row_mask:0xf bank_mask:0xf
  v_add_f32_dpp v5, v5, v5 row_ror:4 row_mask:0xf bank_mask:0xf
  s_nop 0
  v_add_f32_dpp v4, v4, v4 row_ror:8 row_mask:0xf bank_mask:0xf
  v_add_f32_dpp v5, v5, v5 row_ror:8 row_mask:0xf bank_mask:0xf
  v_cvt_pk_bf16_f32 v4, v4, v5
  buffer_store_dword v4, v69, s[8:11], s62 offen sc1
  s_xor_b32 s62, s62, 16384
  buffer_store_dword v71, v69, s[8:11], s62 offen sc1
  s_xor_b32 s72, s72, 1
  s_branch Cs0_h2
Cs0_h2r:
  s_mov_b64 exec, vcc
  buffer_load_dwordx4 v[0:3], v76, s[8:11], s65 offen offset:0 sc1
  s_mov_b64 exec, -1
  s_add_u32 s67, s67, 1
  s_waitcnt vmcnt(4)
  v_max3_u32 v72, v0, v1, v2
  v_max_u32 v72, v72, v3
  ds_write_b128 v76, v[0:3] offset:4608
  v_cmp_eq_u32 vcc, -1, v72
  s_cbranch_vccz Cs0_h2w
  s_mov_b64 exec, vcc
  buffer_load_dwordx4 v[0:3], v76, s[8:11], s65 offen offset:0 sc1
  s_mov_b64 exec, -1
  s_add_u32 s67, s67, 1
  s_waitcnt vmcnt(4)
  v_max3_u32 v72, v0, v1, v2
  v_max_u32 v72, v72, v3
  ds_write_b128 v76, v[0:3] offset:4608
  v_cmp_eq_u32 vcc, -1, v72
  s_cbranch_vccz Cs0_h2w
Cs0_h2s:
  s_mov_b64 exec, vcc
  buffer_load_dwordx4 v[0:3], v76, s[8:11], s65 offen offset:0 sc1
  s_mov_b64 exec, -1
  s_add_u32 s67, s67, 1
  s_waitcnt vmcnt(2)
  v_max3_u32 v72, v0, v1, v2
  v_max_u32 v72, v72, v3
  ds_write_b128 v76, v[0:3] offset:4608
  v_cmp_eq_u32 vcc, -1, v72
  s_cbranch_vccz Cs0_h2w
  s_mov_b64 exec, vcc
  buffer_load_dwordx4 v[0:3], v76, s[8:11], s65 offen offset:0 sc1
  s_mov_b64 exec, -1
  s_add_u32 s67, s67, 1
  s_waitcnt vmcnt(2)
  v_max3_u32 v72, v0, v1, v2
  v_max_u32 v72, v72, v3
  ds_write_b128 v76, v[0:3] offset:4608
  v_cmp_eq_u32 vcc, -1, v72
  s_cbranch_vccz Cs0_h2w
  s_mov_b64 exec, vcc
  buffer_load_dwordx4 v[0:3], v76, s[8:11], s65 offen offset:0 sc1
  s_mov_b64 exec, -1
  s_add_u32 s67, s67, 1
  s_waitcnt vmcnt(2)
  v_max3_u32 v72, v0, v1, v2
  v_max_u32 v72, v72, v3
  ds_write_b128 v76, v[0:3] offset:4608
  v_cmp_eq_u32 vcc, -1, v72
  s_cbranch_vccz Cs0_h2w
  s_cmp_lt_u32 s67, 131072
  s_cbranch_scc1 Cs0_h2s
  s_branch Cs0_h2w
Cs0_rec:
  s_nop 7
  s_waitcnt vmcnt(0) lgkmcnt(0)
  v_max3_u32 v72, v0, v1, v2
  v_max3_u32 v72, v72, v3, v4
  v_max3_u32 v72, v72, v5, v6
  v_max3_u32 v72, v72, v7, v8
  v_max3_u32 v72, v72, v9, v10
  v_max3_u32 v72, v72, v11, v12
  v_max3_u32 v72, v72, v13, v14
  v_max3_u32 v72, v72, v15, v16
  v_max3_u32 v72, v72, v17, v18
  v_max_u32 v72, v72, v19
  v_cmp_eq_u32 vcc, -1, v72
  s_cbranch_vccz Cs0_recok
  s_barrier
  v_mov_b64 v[20:21], 0
  v_mov_b64 v[22:23], 0
  v_mov_b64 v[24:25], 0
  v_mov_b64 v[26:27], 0
  v_mov_b64 v[28:29], 0
  v_mov_b64 v[30:31], 0
  v_mov_b64 v[32:33], 0
  v_mov_b64 v[34:35], 0
  s_waitcnt lgkmcnt(0)
  s_barrier
  ds_read_b128 v[0:3], v76 offset:4608
  s_waitcnt lgkmcnt(0)
  v_smfmac_f32_16x16x64_bf16 v[20:23], v[0:3], v[80:87], v74
  v_smfmac_f32_16x16x64_bf16 v[24:27], v[0:3], v[88:95], v74
  ds_read_b128 v[60:63], v76 offset:16384
  ds_read_b128 v[64:67], v76 offset:17408
  s_waitcnt lgkmcnt(0)
  v_smfmac_f32_16x16x64_bf16 v[28:31], v[0:3], v[60:67], v74
  ds_read_b128 v[60:63], v76 offset:18432
  ds_read_b128 v[64:67], v76 offset:19456
  s_waitcnt lgkmcnt(0)
  v_smfmac_f32_16x16x64_bf16 v[32:35], v[0:3], v[60:67], v74
  ds_read_b128 v[4:7], v76 offset:5632
  s_waitcnt lgkmcnt(0)
  v_smfmac_f32_16x16x64_bf16 v[20:23], v[4:7], v[96:103], v74
  v_smfmac_f32_16x16x64_bf16 v[24:27], v[4:7], v[104:111], v74
  ds_read_b128 v[60:63], v76 offset:32768
  ds_read_b128 v[64:67], v76 offset:33792
  s_waitcnt lgkmcnt(0)
  v_smfmac_f32_16x16x64_bf16 v[28:31], v[4:7], v[60:67], v74
  ds_read_b128 v[60:63], v76 offset:34816
  ds_read_b128 v[64:67], v76 offset:35840
  s_waitcnt lgkmcnt(0)
  v_smfmac_f32_16x16x64_bf16 v[32:35], v[4:7], v[60:67], v74
  ds_read_b128 v[8:11], v76 offset:6656
  s_waitcnt lgkmcnt(0)
  v_smfmac_f32_16x16x64_bf16 v[20:23], v[8:11], v[112:119], v74
  v_smfmac_f32_16x16x64_bf16 v[24:27], v[8:11], v[120:127], v74
  v_smfmac_f32_16x16x64_bf16 v[28:31], v[8:11], v[208:215], v74
  v_smfmac_f32_16x16x64_bf16 v[32:35], v[8:11], v[216:223], v74
  ds_read_b128 v[12:15], v76 offset:7680
  s_waitcnt lgkmcnt(0)
  v_smfmac_f32_16x16x64_bf16 v[20:23], v[12:15], v[128:135], v74
  v_smfmac_f32_16x16x64_bf16 v[24:27], v[12:15], v[136:143], v74
  v_smfmac_f32_16x16x64_bf16 v[28:31], v[12:15], v[224:231], v74
  v_smfmac_f32_16x16x64_bf16 v[32:35], v[12:15], v[232:239], v74
  ds_read_b128 v[0:3], v76 offset:8704
  s_waitcnt lgkmcnt(0)
  v_smfmac_f32_16x16x64_bf16 v[20:23], v[0:3], v[144:151], v74
  v_smfmac_f32_16x16x64_bf16 v[24:27], v[0:3], v[152:159], v74
  ds_read_b128 v[60:63], v76 offset:49152
  ds_read_b128 v[64:67], v76 offset:50176
  s_waitcnt lgkmcnt(0)
  v_smfmac_f32_16x16x64_bf16 v[28:31], v[0:3], v[60:67], v74
  ds_read_b128 v[60:63], v76 offset:51200
  ds_read_b128 v[64:67], v76 offset:52224
  s_waitcnt lgkmcnt(0)
  v_smfmac_f32_16x16x64_bf16 v[32:35], v[0:3], v[60:67], v74
  ds_read_b128 v[8:11], v76 offset:9728
  s_waitcnt lgkmcnt(0)
  v_smfmac_f32_16x16x64_bf16 v[20:23], v[8:11], v[160:167], v74
  v_smfmac_f32_16x16x64_bf16 v[24:27], v[8:11], v[168:175], v74
  ds_read_b128 v[60:63], v75 offset:16384
  ds_read_b128 v[64:67], v75 offset:17408
  s_waitcnt lgkmcnt(0)
  v_smfmac_f32_16x16x64_bf16 v[28:31], v[8:11], v[60:67], v74
  ds_read_b128 v[60:63], v75 offset:18432
  ds_read_b128 v[64:67], v75 offset:19456
  s_waitcnt lgkmcnt(0)
  v_smfmac_f32_16x16x64_bf16 v[32:35], v[8:11], v[60:67], v74
  ds_read_b128 v[16:19], v76 offset:10752
  ds_read_b128 v[60:63], v75 offset:0
  ds_read_b128 v[64:67], v75 offset:1024
  s_waitcnt lgkmcnt(0)
  v_smfmac_f32_16x16x64_bf16 v[20:23], v[16:19], v[60:67], v74
  ds_read_b128 v[60:63], v75 offset:2048
  ds_read_b128 v[64:67], v75 offset:3072
  s_waitcnt lgkmcnt(0)
  v_smfmac_f32_16x16x64_bf16 v[24:27], v[16:19], v[60:67], v74
  v_smfmac_f32_16x16x64_bf16 v[28:31], v[16:19], v[240:247], v74
  v_smfmac_f32_16x16x64_bf16 v[32:35], v[16:19], v[248:255], v74
  ds_read_b128 v[4:7], v76 offset:11776
  s_waitcnt lgkmcnt(0)
  v_smfmac_f32_16x16x64_bf16 v[20:23], v[4:7], v[176:183], v74
  v_smfmac_f32_16x16x64_bf16 v[24:27], v[4:7], v[184:191], v74
  v_smfmac_f32_16x16x64_bf16 v[28:31], v[4:7], a[0:7], v74
  v_smfmac_f32_16x16x64_bf16 v[32:35], v[4:7], a[8:15], v74
  ds_read_b128 v[12:15], v76 offset:12800
  s_waitcnt lgkmcnt(0)
  v_smfmac_f32_16x16x64_bf16 v[20:23], v[12:15], v[192:199], v74
  v_smfmac_f32_16x16x64_bf16 v[24:27], v[12:15], v[200:207], v74
  v_smfmac_f32_16x16x64_bf16 v[28:31], v[12:15], a[16:23], v74
  v_smfmac_f32_16x16x64_bf16 v[32:35], v[12:15], a[24:31], v74
  v_add_f32 v20, v20, v22
  v_add_f32 v21, v21, v23
  v_add_f32 v24, v24, v26
  v_cvt_pk_bf16_f32 v22, v20, v24
  ds_write_b32 v79, v22 offset:0
  v_add_f32 v25, v25, v27
  v_cvt_pk_bf16_f32 v23, v21, v25
  ds_write_b32 v79, v23 offset:576
  v_add_f32 v28, v28, v30
  v_add_f32 v29, v29, v31
  s_waitcnt lgkmcnt(0)
  s_nop 1
  s_branch Cs0_recok
Cs0_mx:
  s_waitcnt lgkmcnt(0)
  s_barrier
  buffer_load_dwordx4 v[0:3], v76, s[8:11], s58 offen offset:0 sc1
  ds_read_b128 v[20:23], v77 offset:0
  ds_read_b128 v[28:31], v77 offset:256
  buffer_load_dwordx4 v[4:7], v76, s[8:11], s58 offen offset:1024 sc1
  ds_read_b128 v[24:27], v77 offset:128
  ds_read_b128 v[32:35], v77 offset:384
  s_waitcnt vmcnt(1) lgkmcnt(3)
  v_mfma_f32_16x16x32_bf16 v[8:11], v[0:3], v[20:23], 0
  s_waitcnt vmcnt(0) lgkmcnt(1)
  v_mfma_f32_16x16x32_bf16 v[8:11], v[4:7], v[24:27], v[8:11]
  v_mfma_f32_16x16x32_bf16 v[12:15], v[28:31], v[20:23], 0
  s_waitcnt lgkmcnt(0)
  v_mfma_f32_16x16x32_bf16 v[12:15], v[32:35], v[24:27], v[12:15]
  v_add_f32_dpp v8, v10, v8 quad_perm:[2,3,0,1] row_mask:0xf bank_mask:0xf
  v_add_f32_dpp v9, v11, v9 quad_perm:[2,3,0,1] row_mask:0xf bank_mask:0xf
  s_nop 0
  v_mov_b32_dpp v8, v8 quad_perm:[0,1,0,1] row_mask:0xf bank_mask:0xf
  v_mov_b32_dpp v9, v9 quad_perm:[0,1,0,1] row_mask:0xf bank_mask:0xf
  s_nop 1
  v_add_f32_dpp v12, v14, v12 quad_perm:[2,3,0,1] row_mask:0xf bank_mask:0xf
  v_add_f32_dpp v13, v15, v13 quad_perm:[2,3,0,1] row_mask:0xf bank_mask:0xf
  s_nop 0
  v_mov_b32_dpp v12, v12 quad_perm:[0,1,0,1] row_mask:0xf bank_mask:0xf
  v_mov_b32_dpp v13, v13 quad_perm:[0,1,0,1] row_mask:0xf bank_mask:0xf
  v_mul_f32 v12, s69, v12
  ds_write_b32 v78, v8 offset:8704
  v_mul_f32 v13, s69, v13
  ds_write_b32 v78, v9 offset:8768
  s_waitcnt lgkmcnt(0)
  s_barrier
  ds_read_b128 v[36:39], v78 offset:8704
  ds_read_b128 v[40:43], v78 offset:8768
  s_waitcnt lgkmcnt(0)
  s_barrier
  v_max_f32 v16, v36, v37
  v_max3_f32 v16, v16, v38, v39
  v_max3_f32 v16, v16, v40, v41
  v_max3_f32 v16, v16, v42, v43
  v_max3_f32 v16, v16, v12, v13
  v_mov_b32 v17, v16
  s_nop 1
  v_permlane16_swap_b32 v16, v17
  v_max_f32 v16, v16, v17
  v_mov_b32 v17, v16
  s_nop 1
  v_permlane32_swap_b32 v16, v17
  v_max_f32 v16, v16, v17
  v_sub_f32 v36, v36, v16
  v_sub_f32 v37, v37, v16
  v_sub_f32 v38, v38, v16
  v_sub_f32 v39, v39, v16
  v_sub_f32 v40, v40, v16
  v_sub_f32 v41, v41, v16
  v_sub_f32 v42, v42, v16
  v_sub_f32 v43, v43, v16
  v_sub_f32 v12, v12, v16
  v_sub_f32 v13, v13, v16
  v_exp_f32 v36, v36
  v_exp_f32 v37, v37
  v_exp_f32 v38, v38
  v_exp_f32 v39, v39
  v_exp_f32 v40, v40
  v_exp_f32 v41, v41
  v_exp_f32 v42, v42
  v_exp_f32 v43, v43
  v_exp_f32 v12, v12
  v_exp_f32 v13, v13
  v_cvt_pk_bf16_f32 v32, v36, v40
  v_cvt_pk_bf16_f32 v33, v37, v41
  v_cvt_pk_bf16_f32 v34, v38, v42
  v_cvt_pk_bf16_f32 v35, v39, v43
  v_cvt_pk_bf16_f32 v28, v12, v13
  v_cvt_pk_bf16_f32 v31, v12, v13
  v_mov_b32 v29, 0
  v_mov_b32 v30, 0
  v_mov_b32 v68, 0x3f803f80
  v_mov_b32 v69, 0x3f803f80
  v_mov_b32 v70, 0x3f803f80
  v_mov_b32 v71, 0x3f803f80
  s_nop 1
  v_mfma_f32_16x16x32_bf16 v[8:11], v[32:35], v[68:71], 0
  v_mfma_f32_16x16x32_bf16 v[0:3], v[32:35], v[52:55], 0
  v_mfma_f32_16x16x32_bf16 v[4:7], v[32:35], v[56:59], 0
  v_mfma_f32_16x16x16_bf16 v[8:11], v[28:29], v[68:69], v[8:11]
  v_mfma_f32_16x16x16_bf16 v[0:3], v[28:29], v[72:73], v[0:3]
  v_mfma_f32_16x16x16_bf16 v[4:7], v[30:31], v[72:73], v[4:7]
  ds_read_b128 v[68:71], v76 offset:13824
  v_rcp_f32 v10, v8
  v_rcp_f32 v11, v9
  v_mul_f32 v0, v10, v0
  v_mul_f32 v1, v11, v1
  s_nop 0
  v_mul_f32 v4, v10, v4
  v_mul_f32 v5, v11, v5
  v_cvt_pk_bf16_f32 v2, v0, v4
  ds_write_b32 v79, v2 offset:8704
  v_cvt_pk_bf16_f32 v3, v1, v5
  ds_write_b32 v79, v3 offset:9280
  v_mov_b64 v[16:17], 0
  v_mov_b64 v[18:19], 0
  v_mov_b64 v[20:21], 0
  v_mov_b64 v[22:23], 0
  v_mov_b64 v[24:25], 0
  v_mov_b64 v[26:27], 0
  s_branch Cs0_mxok
Cs0_kv3:
  s_waitcnt lgkmcnt(0)
  s_cmp_ge_u32 s57, 0x700
  s_cbranch_scc1 Cs0_kvb
  s_load_dword s57, s[12:13], s71 glc
  s_add_u32 s67, s67, 1
  s_cmp_lt_u32 s67, 131072
  s_cbranch_scc1 Cs0_kv3
  s_waitcnt lgkmcnt(0)
  s_branch Cs0_kvb
Cs0_last:
  ds_read_b128 v[4:7], v76 offset:5632
  ds_read_b128 v[12:15], v76 offset:7680
  ds_read_b128 v[44:47], v76 offset:32768
  ds_read_b128 v[48:51], v76 offset:33792
  s_nop 5
  v_mov_b64 v[20:21], 0
  v_mov_b64 v[22:23], 0
  v_mov_b64 v[24:25], 0
  v_mov_b64 v[26:27], 0
  v_smfmac_f32_16x16x64_bf16 v[28:31], v[0:3], v[36:43], v74
  ds_read_b128 v[36:39], v76 offset:34816
  ds_read_b128 v[40:43], v76 offset:35840
  v_smfmac_f32_16x16x64_bf16 v[32:35], v[0:3], v[60:67], v74
  s_waitcnt lgkmcnt(5)
  v_smfmac_f32_16x16x64_bf16 v[20:23], v[0:3], a[32:39], v74
  ds_read_b128 v[60:63], v76 offset:49152
  ds_read_b128 v[64:67], v76 offset:50176
  v_smfmac_f32_16x16x64_bf16 v[24:27], v[0:3], a[40:47], v74
  s_waitcnt lgkmcnt(4)
  v_smfmac_f32_16x16x64_bf16 v[20:23], v[4:7], a[48:55], v74
  buffer_store_dwordx4 v[16:19], v76, s[8:11], s68 offen sc1
  v_smfmac_f32_16x16x64_bf16 v[24:27], v[4:7], a[56:63], v74
  v_smfmac_f32_16x16x64_bf16 v[28:31], v[4:7], v[44:51], v74
  s_waitcnt lgkmcnt(2)
  v_smfmac_f32_16x16x64_bf16 v[20:23], v[8:11], a[64:71], v74
  ds_read_b128 v[44:47], v76 offset:51200
  ds_read_b128 v[48:51], v76 offset:52224
  v_smfmac_f32_16x16x64_bf16 v[24:27], v[8:11], a[72:79], v74
  v_smfmac_f32_16x16x64_bf16 v[32:35], v[4:7], v[36:43], v74
  v_smfmac_f32_16x16x64_bf16 v[28:31], v[8:11], v[208:215], v74
  ds_read_b128 v[36:39], v75 offset:16384
  ds_read_b128 v[40:43], v75 offset:17408
  v_smfmac_f32_16x16x64_bf16 v[32:35], v[8:11], v[216:223], v74
  v_smfmac_f32_16x16x64_bf16 v[20:23], v[12:15], a[80:87], v74
  v_smfmac_f32_16x16x64_bf16 v[24:27], v[12:15], a[88:95], v74
  v_smfmac_f32_16x16x64_bf16 v[28:31], v[12:15], v[224:231], v74
  v_smfmac_f32_16x16x64_bf16 v[32:35], v[12:15], v[232:239], v74
  s_waitcnt vmcnt(2)
  s_waitcnt vmcnt(1)
  s_barrier
Cs0_lastr:
  ds_read_b128 v[0:3], v76 offset:8704
  ds_read_b128 v[8:11], v76 offset:9728
  ds_read_b128 v[16:19], v76 offset:10752
  ds_read_b128 v[4:7], v76 offset:11776
  ds_read_b128 v[12:15], v76 offset:12800
  s_waitcnt lgkmcnt(4)
  v_max3_u32 v72, v0, v1, v2
  s_waitcnt lgkmcnt(1)
  v_max3_u32 v72, v72, v3, v4
  v_max3_u32 v72, v72, v5, v6
  v_max3_u32 v72, v72, v7, v8
  v_max3_u32 v72, v72, v9, v10
  s_waitcnt lgkmcnt(0)
  v_max3_u32 v72, v72, v11, v12
  v_max3_u32 v72, v72, v13, v14
  v_max3_u32 v72, v72, v15, v16
  v_max3_u32 v72, v72, v17, v18
  v_max_u32 v72, v72, v19
  v_cmp_eq_u32 vcc, -1, v72
  s_cbranch_vccnz Cs0_lastp
Cs0_lastg:
  v_smfmac_f32_16x16x64_bf16 v[28:31], v[0:3], v[60:67], v74
  ds_read_b128 v[60:63], v75 offset:18432
  ds_read_b128 v[64:67], v75 offset:19456
  v_smfmac_f32_16x16x64_bf16 v[32:35], v[0:3], v[44:51], v74
  v_smfmac_f32_16x16x64_bf16 v[28:31], v[8:11], v[36:43], v74
  v_smfmac_f32_16x16x64_bf16 v[28:31], v[16:19], v[240:247], v74
  v_smfmac_f32_16x16x64_bf16 v[28:31], v[4:7], a[0:7], v74
  v_smfmac_f32_16x16x64_bf16 v[28:31], v[12:15], a[16:23], v74
  v_smfmac_f32_16x16x64_bf16 v[32:35], v[16:19], v[248:255], v74
  v_smfmac_f32_16x16x64_bf16 v[32:35], v[4:7], a[8:15], v74
  s_waitcnt lgkmcnt(0)
  v_smfmac_f32_16x16x64_bf16 v[32:35], v[12:15], a[24:31], v74
  v_smfmac_f32_16x16x64_bf16 v[32:35], v[8:11], v[60:67], v74
  v_smfmac_f32_16x16x64_bf16 v[20:23], v[0:3], a[96:103], v74
  v_smfmac_f32_16x16x64_bf16 v[20:23], v[8:11], a[112:119], v74
  v_add_f32 v28, v28, v30
  v_add_f32 v32, v32, v34
  v_cvt_pk_bf16_f32 v30, v28, v32
  v_smfmac_f32_16x16x64_bf16 v[20:23], v[16:19], a[128:135], v74
  ds_write_b32 v79, v30 offset:256
  v_add_f32 v29, v29, v31
  v_add_f32 v33, v33, v35
  v_cvt_pk_bf16_f32 v31, v29, v33
  v_smfmac_f32_16x16x64_bf16 v[20:23], v[4:7], a[144:151], v74
  ds_write_b32 v79, v31 offset:832
  v_smfmac_f32_16x16x64_bf16 v[20:23], v[12:15], a[160:167], v74
  v_smfmac_f32_16x16x64_bf16 v[24:27], v[0:3], a[104:111], v74
  v_smfmac_f32_16x16x64_bf16 v[24:27], v[8:11], a[120:127], v74
  v_smfmac_f32_16x16x64_bf16 v[24:27], v[16:19], a[136:143], v74
  s_waitcnt lgkmcnt(0)
  s_barrier
  ds_read_b64 v[52:53], v77 offset:256
  v_add_f32 v20, v20, v22
  v_smfmac_f32_16x16x64_bf16 v[24:27], v[4:7], a[152:159], v74
  v_add_f32 v21, v21, v23
  v_smfmac_f32_16x16x64_bf16 v[24:27], v[12:15], a[168:175], v74
  v_cvt_pk_bf16_f32 v54, v20, v21
  s_add_u32 s68, s68, 655360
  s_nop 3
  v_add_f32 v24, v24, v26
  v_add_f32 v25, v25, v27
  v_cvt_pk_bf16_f32 v55, v24, v25
  s_waitcnt lgkmcnt(0)
  buffer_store_dwordx4 v[52:55], v76, s[8:11], s68 offen sc1
  s_branch Cs0_done
Cs0_lastp:
  s_add_u32 s72, s72, 2
  s_cmp_ge_u32 s72, 131072
  s_cbranch_scc1 Cs0_lastg
  s_barrier
  buffer_load_dwordx4 v76, s[8:11], s85 offen offset:0 sc1 lds
  s_waitcnt vmcnt(0)
  s_barrier
  s_branch Cs0_lastr
Cs0_done:
  s_branch L_cexit
L_w5:
  v_mov_b64 v[20:21], 0
  v_mov_b64 v[22:23], 0
  v_mov_b64 v[24:25], 0
  v_mov_b64 v[26:27], 0
  v_mov_b64 v[28:29], 0
  v_mov_b64 v[30:31], 0
  v_mov_b64 v[32:33], 0
  v_mov_b64 v[34:35], 0
  s_mov_b32 s78, 0x3f803f80
  s_mov_b32 s79, s78
  s_mov_b32 s65, 360448
  s_mov_b32 m0, 15872
  s_lshl_b32 s71, s53, 2
  s_add_u32 s71, s71, 128
  s_movk_i32 s56, 0x1000
  v_lshlrev_b32 v73, 2, v76
  v_mov_b32 v72, 0
  s_mov_b64 s[16:17], s[8:9]
  s_mov_b32 s18, 268435456
  s_mov_b32 s19, 0x20000
  s_getpc_b64 s[20:21]
Cs1_pc:
  s_add_u32 s20, s20, (Cs1_last - Cs1_pc)
  s_addc_u32 s21, s21, 0
  v_mov_b32 v68, 14880
  buffer_load_dwordx4 v[52:55], v76, s[8:11], s59 offen offset:0 sc1
  buffer_load_dwordx4 v[56:59], v76, s[8:11], s59 offen offset:1024 sc1
  ds_read_b128 v[36:39], v76 offset:20480
  ds_read_b128 v[40:43], v76 offset:21504
  ds_read_b128 v[60:63], v76 offset:22528
  ds_read_b128 v[64:67], v76 offset:23552
  ds_read_b128 v[0:3], v76 offset:4608
  ds_read_b128 v[4:7], v76 offset:5632
  ds_read_b128 v[8:11], v76 offset:6656
  ds_read_b128 v[12:15], v76 offset:7680
  s_waitcnt lgkmcnt(0)
  s_cmp_eq_u32 s66, 1
  s_branch Cs1_top2
.p2align 6
Cs1_h2:
  ds_read_b128 v[36:39], v76 offset:20480
  s_waitcnt lgkmcnt(0)
  s_cmp_eq_u32 s66, 62
  s_cselect_b64 s[16:17], s[20:21], s[16:17]
  s_cselect_b32 s18, (Cs1_done - Cs1_last), s18
  s_cselect_b32 s70, 0, s70
  s_cmp_eq_u32 s66, 63
  s_cselect_b32 s59, 268435456, s59
  s_cselect_b32 s58, 268435456, s58
  buffer_load_dwordx4 v[8:11], v76, s[8:11], s65 offen offset:2048 sc1
  ds_read_b128 v[40:43], v76 offset:21504
  s_waitcnt lgkmcnt(0)
  v_mov_b64 v[20:21], 0
  v_mov_b64 v[22:23], 0
  v_mov_b64 v[24:25], 0
  v_mov_b64 v[26:27], 0
  v_mov_b32 v68, 14880
  buffer_load_dwordx4 v[8:11], v76, s[8:11], s65 offen offset:2048 sc1
  ds_read_b128 v[60:63], v76 offset:22528
  s_waitcnt lgkmcnt(0)
  v_mov_b64 v[28:29], 0
  v_mov_b64 v[30:31], 0
  v_mov_b64 v[32:33], 0
  v_mov_b64 v[34:35], 0
  v_lshlrev_b32 v73, 2, v76
  buffer_load_dwordx4 v[8:11], v76, s[8:11], s65 offen offset:2048 sc1
  buffer_load_dwordx4 v[52:55], v76, s[8:11], s59 offen offset:0 sc1
  buffer_load_dwordx4 v[56:59], v76, s[8:11], s59 offen offset:1024 sc1
  s_waitcnt vmcnt(4)
  v_max3_u32 v72, v8, v9, v10
  v_max_u32 v72, v72, v11
  ds_write_b128 v76, v[8:11] offset:6656
  v_cmp_eq_u32 vcc, -1, v72
  s_cbranch_vccnz Cs1_h2r
Cs1_h2w:
  s_cmp_eq_u32 s66, 63
  s_waitcnt lgkmcnt(0)
  s_barrier
  ds_read_b128 v[0:3], v76 offset:4608
  buffer_load_dwordx4 v76, s[8:11], s85 offen offset:0 sc1 lds
Cs1_top2:
  v_smfmac_f32_16x16x64_bf16 v[20:23], v[8:11], v[112:119], v74
  s_cbranch_scc1 Cs1_last
  v_smfmac_f32_16x16x64_bf16 v[24:27], v[8:11], v[120:127], v74
  buffer_load_dwordx4 v[44:47], v76, s[8:11], s58 offen offset:0 sc1
  s_mov_b32 m0, 15872
  v_smfmac_f32_16x16x64_bf16 v[28:31], v[8:11], v[208:215], v74
  buffer_load_dwordx4 v[48:51], v76, s[8:11], s58 offen offset:1024 sc1
  v_smfmac_f32_16x16x64_bf16 v[32:35], v[8:11], v[216:223], v74
  ds_read_b128 v[4:7], v76 offset:5632
  s_waitcnt lgkmcnt(1)
  v_smfmac_f32_16x16x64_bf16 v[20:23], v[0:3], v[80:87], v74
  ds_read_b128 v[12:15], v76 offset:7680
  v_smfmac_f32_16x16x64_bf16 v[28:31], v[0:3], v[36:43], v74
  ds_read_b128 v[36:39], v76 offset:36864
  v_smfmac_f32_16x16x64_bf16 v[24:27], v[0:3], v[88:95], v74
  buffer_store_dwordx4 v[16:19], v76, s[8:11], s68 offen sc1
  ds_read_b128 v[40:43], v76 offset:37888
  v_smfmac_f32_16x16x64_bf16 v[32:35], v[0:3], v[60:67], v74
  ds_read_b128 v[60:63], v76 offset:38912
  s_waitcnt lgkmcnt(4)
  v_smfmac_f32_16x16x64_bf16 v[20:23], v[4:7], v[96:103], v74
  ds_read_b128 v[64:67], v76 offset:39936
  v_smfmac_f32_16x16x64_bf16 v[24:27], v[4:7], v[104:111], v74
  buffer_load_dword v73, s[16:19], s70 offen lds
  s_waitcnt vmcnt(5)
  s_waitcnt lgkmcnt(4)
  v_smfmac_f32_16x16x64_bf16 v[20:23], v[12:15], v[128:135], v74
  s_barrier
  s_waitcnt lgkmcnt(2)
  v_smfmac_f32_16x16x64_bf16 v[28:31], v[4:7], v[36:43], v74
  ds_read_b128 v[8:11], v76 offset:8704
  v_smfmac_f32_16x16x64_bf16 v[24:27], v[12:15], v[136:143], v74
  ds_read_b128 v[36:39], v76 offset:53248
  s_waitcnt lgkmcnt(2)
  v_smfmac_f32_16x16x64_bf16 v[32:35], v[4:7], v[60:67], v74
  ds_read_b128 v[40:43], v76 offset:54272
  v_smfmac_f32_16x16x64_bf16 v[28:31], v[12:15], v[224:231], v74
  ds_read_b128 v[60:63], v76 offset:55296
  v_smfmac_f32_16x16x64_bf16 v[32:35], v[12:15], v[232:239], v74
  ds_read_b128 v[64:67], v76 offset:56320
  s_waitcnt lgkmcnt(4)
  v_smfmac_f32_16x16x64_bf16 v[20:23], v[8:11], v[144:151], v74
  s_waitcnt vmcnt(4)
  ds_read_b128 v[0:3], v76 offset:9728
  s_waitcnt lgkmcnt(3)
  v_smfmac_f32_16x16x64_bf16 v[28:31], v[8:11], v[36:43], v74
  s_barrier
  ds_read_b128 v[4:7], v76 offset:11776
  v_smfmac_f32_16x16x64_bf16 v[24:27], v[8:11], v[152:159], v74
  ds_read_b128 v[36:39], v75 offset:4096
  ds_read_b128 v[40:43], v75 offset:5120
  s_waitcnt lgkmcnt(4)
  v_smfmac_f32_16x16x64_bf16 v[32:35], v[8:11], v[60:67], v74
  ds_read_b128 v[16:19], v76 offset:10752
  s_waitcnt lgkmcnt(4)
  v_smfmac_f32_16x16x64_bf16 v[20:23], v[0:3], v[160:167], v74
  ds_read_b128 v[12:15], v76 offset:12800
  v_smfmac_f32_16x16x64_bf16 v[24:27], v[0:3], v[168:175], v74
  ds_read_b128 v[60:63], v75 offset:6144
  ds_read_b128 v[64:67], v75 offset:7168
  s_waitcnt lgkmcnt(6)
  v_smfmac_f32_16x16x64_bf16 v[20:23], v[4:7], v[176:183], v74
  s_waitcnt lgkmcnt(3)
  v_smfmac_f32_16x16x64_bf16 v[20:23], v[16:19], v[36:43], v74
  ds_read_b128 v[36:39], v75 offset:20480
  s_waitcnt lgkmcnt(3)
  v_smfmac_f32_16x16x64_bf16 v[20:23], v[12:15], v[192:199], v74
  ds_read_b128 v[40:43], v75 offset:21504
  s_waitcnt lgkmcnt(2)
  v_smfmac_f32_16x16x64_bf16 v[24:27], v[16:19], v[60:67], v74
  ds_read_b128 v[60:63], v75 offset:22528
  v_smfmac_f32_16x16x64_bf16 v[24:27], v[4:7], v[184:191], v74
  ds_read_b128 v[64:67], v75 offset:23552
  v_add_f32 v20, v20, v22
  v_smfmac_f32_16x16x64_bf16 v[24:27], v[12:15], v[200:207], v74
  v_add_f32 v21, v21, v23
  v_smfmac_f32_16x16x64_bf16 v[28:31], v[16:19], v[240:247], v74
  s_waitcnt lgkmcnt(2)
  v_mov_b64 v[70:71], s[78:79]
  v_smfmac_f32_16x16x64_bf16 v[28:31], v[0:3], v[36:43], v74
  ds_read_b128 v[36:39], v68
  v_add_f32 v24, v24, v26
  v_smfmac_f32_16x16x64_bf16 v[28:31], v[4:7], a[0:7], v74
  ds_read_b128 v[40:43], v68
  v_cvt_pk_bf16_f32 v22, v20, v24
  v_smfmac_f32_16x16x64_bf16 v[28:31], v[12:15], a[16:23], v74
  ds_write_b32 v79, v22 offset:0
  s_waitcnt lgkmcnt(3)
  v_add_f32 v25, v25, v27
  v_cvt_pk_bf16_f32 v23, v21, v25
  v_smfmac_f32_16x16x64_bf16 v[32:35], v[0:3], v[60:67], v74
  ds_write_b32 v79, v23 offset:576
  v_cmp_u_f32 vcc, v20, v21
  v_smfmac_f32_16x16x64_bf16 v[32:35], v[16:19], v[248:255], v74
  v_add_f32 v28, v28, v30
  v_smfmac_f32_16x16x64_bf16 v[32:35], v[4:7], a[8:15], v74
  v_add_f32 v29, v29, v31
  v_smfmac_f32_16x16x64_bf16 v[32:35], v[12:15], a[24:31], v74
  s_cbranch_vccnz Cs1_rec
Cs1_recok:
  s_waitcnt lgkmcnt(3)
  v_smfmac_f32_16x16x64_bf16 v[36:39], v[16:19], a[128:135], v74
  s_waitcnt lgkmcnt(0)
  s_barrier
  ds_read_b128 v[60:63], v77
  v_smfmac_f32_16x16x64_bf16 v[40:43], v[16:19], a[136:143], v74
  ds_read_b128 v[64:67], v77 offset:128
  v_add_f32 v32, v32, v34
  v_cvt_pk_bf16_f32 v30, v28, v32
  v_smfmac_f32_16x16x64_bf16 v[36:39], v[0:3], a[112:119], v74
  ds_write_b32 v79, v30 offset:256
  v_add_f32 v33, v33, v35
  v_cvt_pk_bf16_f32 v31, v29, v33
  v_smfmac_f32_16x16x64_bf16 v[40:43], v[0:3], a[120:127], v74
  ds_write_b32 v79, v31 offset:832
  v_xor_b32 v75, 0x8000, v75
  v_smfmac_f32_16x16x64_bf16 v[36:39], v[4:7], a[144:151], v74
  ds_read_b128 v[0:3], v76 offset:4608
  v_mov_b32 v29, 0
  v_smfmac_f32_16x16x64_bf16 v[40:43], v[4:7], a[152:159], v74
  s_waitcnt vmcnt(2) lgkmcnt(3)
  v_mov_b32 v30, 0
  v_mfma_f32_16x16x32_bf16 v[44:47], v[44:47], v[60:63], 0
  ds_read_b128 v[4:7], v76 offset:5632
  s_waitcnt lgkmcnt(2)
  v_mfma_f32_16x16x32_bf16 v[44:47], v[48:51], v[64:67], v[44:47]
  s_barrier
  v_smfmac_f32_16x16x64_bf16 v[36:39], v[8:11], a[96:103], v74
  ds_read_b128 v[20:23], v77 offset:256
  ds_read_b128 v[24:27], v77 offset:384
  v_smfmac_f32_16x16x64_bf16 v[40:43], v[8:11], a[104:111], v74
  ds_read_b128 v[8:11], v76 offset:6656
  v_add_f32_dpp v72, v46, v44 quad_perm:[2,3,0,1] row_mask:0xf bank_mask:0xf
  v_add_f32_dpp v73, v47, v45 quad_perm:[2,3,0,1] row_mask:0xf bank_mask:0xf
  v_smfmac_f32_16x16x64_bf16 v[36:39], v[12:15], a[160:167], v74
  s_waitcnt lgkmcnt(4)
  v_exp_f32_dpp v72, v72 quad_perm:[0,1,0,1] row_mask:0xf bank_mask:0xf
  v_smfmac_f32_16x16x64_bf16 v[40:43], v[12:15], a[168:175], v74
  ds_read_b128 v[12:15], v76 offset:7680
  v_exp_f32_dpp v73, v73 quad_perm:[0,1,0,1] row_mask:0xf bank_mask:0xf
  v_smfmac_f32_16x16x64_bf16 v[36:39], v[0:3], a[32:39], v74
  s_waitcnt lgkmcnt(2)
  v_cvt_pk_bf16_f32 v72, v72, v73
  v_mfma_f32_16x16x32_bf16 v[20:23], v[20:23], v[60:63], 0
  ds_write_b32 v78, v72 offset:516
  v_mov_b64 v[16:17], 0
  v_mfma_f32_16x16x32_bf16 v[20:23], v[24:27], v[64:67], v[20:23]
  ds_read_b128 v[44:47], v75 offset:20480
  v_mov_b64 v[18:19], 0
  v_smfmac_f32_16x16x64_bf16 v[40:43], v[0:3], a[40:47], v74
  ds_read_b128 v[48:51], v75 offset:21504
  v_mov_b64 v[68:69], s[78:79]
  v_smfmac_f32_16x16x64_bf16 v[36:39], v[4:7], a[48:55], v74
  s_waitcnt lgkmcnt(4)
  v_add_f32_dpp v24, v22, v20 quad_perm:[2,3,0,1] row_mask:0xf bank_mask:0xf
  v_add_f32_dpp v25, v23, v21 quad_perm:[2,3,0,1] row_mask:0xf bank_mask:0xf
  v_smfmac_f32_16x16x64_bf16 v[36:39], v[8:11], a[64:71], v74
  s_waitcnt lgkmcnt(2)
  s_barrier
  ds_read_b128 v[32:35], v78 offset:512
  v_smfmac_f32_16x16x64_bf16 v[36:39], v[12:15], a[80:87], v74
  ds_read_b128 v[60:63], v75 offset:22528
  v_mul_f32 v24, s69, v24
  v_smfmac_f32_16x16x64_bf16 v[40:43], v[4:7], a[56:63], v74
  ds_read_b128 v[64:67], v75 offset:23552
  v_mul_f32 v25, s69, v25
  v_smfmac_f32_16x16x64_bf16 v[40:43], v[8:11], a[72:79], v74
  v_exp_f32_dpp v24, v24 quad_perm:[0,1,0,1] row_mask:0xf bank_mask:0xf
  v_smfmac_f32_16x16x64_bf16 v[40:43], v[12:15], a[88:95], v74
  s_waitcnt lgkmcnt(2)
  v_exp_f32_dpp v25, v25 quad_perm:[0,1,0,1] row_mask:0xf bank_mask:0xf
  v_mfma_f32_16x16x32_bf16 v[8:11], v[32:35], v[68:71], 0
  v_add_f32 v36, v36, v38
  v_add_f32 v37, v37, v39
  v_mfma_f32_16x16x32_bf16 v[0:3], v[32:35], v[52:55], 0
  v_add_f32 v40, v40, v42
  v_add_f32 v41, v41, v43
  v_mfma_f32_16x16x32_bf16 v[4:7], v[32:35], v[56:59], 0
  v_cvt_pk_bf16_f32 v28, v24, v25
  v_cvt_pk_bf16_f32 v72, v36, v37
  v_cvt_pk_bf16_f32 v73, v40, v41
  v_mfma_f32_16x16x16_bf16 v[8:11], v[28:29], v[68:69], v[8:11]
  v_cvt_pk_bf16_f32 v31, v24, v25
  v_mov_b64 v[20:21], 0
  v_mfma_f32_16x16x16_bf16 v[0:3], v[28:29], v[72:73], v[0:3]
  ds_read_b128 v[68:71], v76 offset:13824
  v_mov_b64 v[22:23], 0
  v_mfma_f32_16x16x16_bf16 v[4:7], v[30:31], v[72:73], v[4:7]
  v_rcp_f32 v10, v8
  v_rcp_f32 v11, v9
  v_mul_f32 v0, v10, v0
  v_mul_f32 v1, v11, v1
  s_nop 0
  v_mul_f32 v4, v10, v4
  v_mul_f32 v5, v11, v5
  v_cvt_pk_bf16_f32 v2, v0, v4
  ds_write_b32 v79, v2 offset:8704
  v_cvt_pk_bf16_f32 v3, v1, v5
  ds_write_b32 v79, v3 offset:9280
  v_max3_f32 v8, v8, v9, v10
  v_max_f32 v8, v8, v11
  v_cmp_le_f32 vcc, 1317011456, v8
  v_mov_b64 v[24:25], 0
  v_mov_b64 v[26:27], 0
  s_cbranch_vccnz Cs1_mx
Cs1_mxok:
  s_waitcnt lgkmcnt(0)
  s_barrier
  ds_read_b128 v[0:3], v78 offset:8704
  ds_read_b128 v[4:7], v78 offset:8768
  ds_read_b128 v[8:11], v78 offset:8832
  ds_read_b128 v[12:15], v78 offset:8896
  s_waitcnt lgkmcnt(3)
  v_smfmac_f32_16x16x64_bf16 v[16:19], v[0:3], v[44:51], v74
  ds_read_b128 v[52:55], v75 offset:36864
  s_waitcnt lgkmcnt(3)
  v_smfmac_f32_16x16x64_bf16 v[16:19], v[4:7], v[60:67], v74
  ds_read_b128 v[56:59], v75 offset:37888
  s_waitcnt lgkmcnt(3)
  v_smfmac_f32_16x16x64_bf16 v[16:19], v[8:11], a[176:183], v74
  ds_read_b128 v[36:39], v75 offset:38912
  s_waitcnt lgkmcnt(3)
  v_smfmac_f32_16x16x64_bf16 v[16:19], v[12:15], a[184:191], v74
  ds_read_b128 v[40:43], v75 offset:39936
  ds_read_b128 v[44:47], v75 offset:53248
  v_smfmac_f32_16x16x64_bf16 v[20:23], v[0:3], a[192:199], v74
  ds_read_b128 v[48:51], v75 offset:54272
  ds_read_b128 v[60:63], v75 offset:55296
  v_smfmac_f32_16x16x64_bf16 v[20:23], v[4:7], a[200:207], v74
  ds_read_b128 v[64:67], v75 offset:56320
  s_waitcnt lgkmcnt(6)
  v_cvt_pk_bf16_f32 v16, v16, v17
  v_cvt_pk_bf16_f32 v17, v18, v19
  v_bfi_b32 v16, 1, s72, v16
  v_smfmac_f32_16x16x64_bf16 v[20:23], v[8:11], v[52:59], v74
  buffer_store_dwordx2 v[16:17], v68, s[8:11], s73 offen sc1
  s_waitcnt lgkmcnt(4)
  v_smfmac_f32_16x16x64_bf16 v[20:23], v[12:15], v[36:43], v74
  v_mov_b64 v[32:33], 0
  v_smfmac_f32_16x16x64_bf16 v[24:27], v[0:3], a[208:215], v74
  v_mov_b64 v[34:35], 0
  v_smfmac_f32_16x16x64_bf16 v[24:27], v[4:7], a[216:223], v74
  s_waitcnt lgkmcnt(2)
  v_cvt_pk_bf16_f32 v20, v20, v21
  v_cvt_pk_bf16_f32 v21, v22, v23
  v_bfi_b32 v20, 1, s72, v20
  v_smfmac_f32_16x16x64_bf16 v[24:27], v[8:11], v[44:51], v74
  buffer_store_dwordx2 v[20:21], v68, s[8:11], s74 offen sc1
  s_waitcnt lgkmcnt(0)
  v_smfmac_f32_16x16x64_bf16 v[24:27], v[12:15], v[60:67], v74
  v_smfmac_f32_16x16x64_bf16 v[32:35], v[0:3], a[224:231], v74
  v_smfmac_f32_16x16x64_bf16 v[32:35], v[4:7], a[232:239], v74
  v_cvt_pk_bf16_f32 v24, v24, v25
  v_cvt_pk_bf16_f32 v25, v26, v27
  v_bfi_b32 v24, 1, s72, v24
  v_smfmac_f32_16x16x64_bf16 v[32:35], v[8:11], a[240:247], v74
  buffer_store_dwordx2 v[24:25], v68, s[8:11], s75 offen sc1
  v_smfmac_f32_16x16x64_bf16 v[32:35], v[12:15], a[248:255], v74
  v_mov_b64 v[18:19], v[72:73]
  s_nop 4
  v_cvt_pk_bf16_f32 v32, v32, v33
  v_cvt_pk_bf16_f32 v33, v34, v35
  v_bfi_b32 v32, 1, s72, v32
  buffer_store_dwordx2 v[32:33], v68, s[8:11], s76 offen sc1
  ds_read_b128 v[0:3], v76 offset:14848
  s_waitcnt lgkmcnt(0)
  ds_read_b64 v[16:17], v77 offset:264
  s_waitcnt lgkmcnt(0)
  ds_read_b128 v[64:67], v76 offset:23552
  s_waitcnt lgkmcnt(0)
  s_add_u32 s66, s66, 1
  s_xor_b32 s64, s64, 16384
  s_xor_b32 s65, s65, 16384
  s_add_u32 s58, s58, 655360
  s_add_u32 s59, s59, 655360
  s_add_u32 s70, s70, 655360
  s_add_u32 s68, s68, 655360
  s_mov_b32 m0, 11776
  s_add_u32 s85, s65, 7168
  v_xor_b32 v75, 0x8000, v75
  buffer_load_dwordx4 v[52:55], v76, s[8:11], s60 offen offset:0 sc1
  buffer_load_dwordx4 v[56:59], v76, s[8:11], s60 offen offset:1024 sc1
  s_waitcnt lgkmcnt(0)
  s_waitcnt vmcnt(1)
  v_mfma_f32_16x16x32_bf16 v[4:7], v[0:3], v[52:55], 0
  v_bitop3_b32 v72, v52, v54, s72 bitop3:0x7e
  s_waitcnt vmcnt(0)
  v_mfma_f32_16x16x32_bf16 v[4:7], v[0:3], v[56:59], v[4:7]
  v_bitop3_b32 v73, v56, v58, s72 bitop3:0x7e
  v_bitop3_b32 v72, v72, v73, 1 bitop3:0xa8
  v_cmp_ne_u32 vcc, 0, v72
  s_nop 0
  s_cmp_eq_u64 vcc, 0
  s_cselect_b32 s54, s62, 268435456
  s_nop 0
  v_add_f32_dpp v4, v4, v4 row_ror:4 row_mask:0xf bank_mask:0xf
  v_add_f32_dpp v5, v5, v5 row_ror:4 row_mask:0xf bank_mask:0xf
  s_nop 0
  v_add_f32_dpp v4, v4, v4 row_ror:8 row_mask:0xf bank_mask:0xf
  v_add_f32_dpp v5, v5, v5 row_ror:8 row_mask:0xf bank_mask:0xf
  v_cvt_pk_bf16_f32 v4, v4, v5
  buffer_store_dword v4, v69, s[8:11], s54 offen sc1
  s_cbranch_vccnz Cs1_h1r
  s_xor_b32 s62, s62, 16384
  buffer_store_dword v71, v69, s[8:11], s62 offen sc1
  s_xor_b32 s72, s72, 1
  s_branch Cs1_h2
Cs1_h1r:
  s_mov_b64 exec, vcc
  buffer_load_dwordx4 v[52:55], v76, s[8:11], s60 offen offset:0 sc1
  buffer_load_dwordx4 v[56:59], v76, s[8:11], s60 offen offset:1024 sc1
  s_mov_b64 exec, -1
  s_add_u32 s67, s67, 1
  s_waitcnt vmcnt(1)
  v_mfma_f32_16x16x32_bf16 v[4:7], v[0:3], v[52:55], 0
  v_bitop3_b32 v72, v52, v54, s72 bitop3:0x7e
  s_waitcnt vmcnt(0)
  v_mfma_f32_16x16x32_bf16 v[4:7], v[0:3], v[56:59], v[4:7]
  v_bitop3_b32 v73, v56, v58, s72 bitop3:0x7e
  v_bitop3_b32 v72, v72, v73, 1 bitop3:0xa8
  v_cmp_ne_u32 vcc, 0, v72
  s_cbranch_vccz Cs1_h1p
Cs1_h1s:
  s_mov_b64 exec, vcc
  buffer_load_dwordx4 v[52:55], v76, s[8:11], s60 offen offset:0 sc1
  buffer_load_dwordx4 v[56:59], v76, s[8:11], s60 offen offset:1024 sc1
  s_mov_b64 exec, -1
  s_add_u32 s67, s67, 1
  s_waitcnt vmcnt(1)
  v_mfma_f32_16x16x32_bf16 v[4:7], v[0:3], v[52:55], 0
  v_bitop3_b32 v72, v52, v54, s72 bitop3:0x7e
  s_waitcnt vmcnt(0)
  v_mfma_f32_16x16x32_bf16 v[4:7], v[0:3], v[56:59], v[4:7]
  v_bitop3_b32 v73, v56, v58, s72 bitop3:0x7e
  v_bitop3_b32 v72, v72, v73, 1 bitop3:0xa8
  v_cmp_ne_u32 vcc, 0, v72
  s_cbranch_vccz Cs1_h1p
  s_cmp_lt_u32 s67, 131072
  s_cbranch_scc1 Cs1_h1s
Cs1_h1p:
  s_nop 2
  v_add_f32_dpp v4, v4, v4 row_ror:4 row_mask:0xf bank_mask:0xf
  v_add_f32_dpp v5, v5, v5 row_ror:4 row_mask:0xf bank_mask:0xf
  s_nop 0
  v_add_f32_dpp v4, v4, v4 row_ror:8 row_mask:0xf bank_mask:0xf
  v_add_f32_dpp v5, v5, v5 row_ror:8 row_mask:0xf bank_mask:0xf
  v_cvt_pk_bf16_f32 v4, v4, v5
  buffer_store_dword v4, v69, s[8:11], s62 offen sc1
  s_xor_b32 s62, s62, 16384
  buffer_store_dword v71, v69, s[8:11], s62 offen sc1
  s_xor_b32 s72, s72, 1
  s_branch Cs1_h2
Cs1_h2r:
  s_mov_b64 exec, vcc
  buffer_load_dwordx4 v[8:11], v76, s[8:11], s65 offen offset:2048 sc1
  s_mov_b64 exec, -1
  s_add_u32 s67, s67, 1
  s_waitcnt vmcnt(4)
  v_max3_u32 v72, v8, v9, v10
  v_max_u32 v72, v72, v11
  ds_write_b128 v76, v[8:11] offset:6656
  v_cmp_eq_u32 vcc, -1, v72
  s_cbranch_vccz Cs1_h2w
  s_mov_b64 exec, vcc
  buffer_load_dwordx4 v[8:11], v76, s[8:11], s65 offen offset:2048 sc1
  s_mov_b64 exec, -1
  s_add_u32 s67, s67, 1
  s_waitcnt vmcnt(4)
  v_max3_u32 v72, v8, v9, v10
  v_max_u32 v72, v72, v11
  ds_write_b128 v76, v[8:11] offset:6656
  v_cmp_eq_u32 vcc, -1, v72
  s_cbranch_vccz Cs1_h2w
Cs1_h2s:
  s_mov_b64 exec, vcc
  buffer_load_dwordx4 v[8:11], v76, s[8:11], s65 offen offset:2048 sc1
  s_mov_b64 exec, -1
  s_add_u32 s67, s67, 1
  s_waitcnt vmcnt(2)
  v_max3_u32 v72, v8, v9, v10
  v_max_u32 v72, v72, v11
  ds_write_b128 v76, v[8:11] offset:6656
  v_cmp_eq_u32 vcc, -1, v72
  s_cbranch_vccz Cs1_h2w
  s_mov_b64 exec, vcc
  buffer_load_dwordx4 v[8:11], v76, s[8:11], s65 offen offset:2048 sc1
  s_mov_b64 exec, -1
  s_add_u32 s67, s67, 1
  s_waitcnt vmcnt(2)
  v_max3_u32 v72, v8, v9, v10
  v_max_u32 v72, v72, v11
  ds_write_b128 v76, v[8:11] offset:6656
  v_cmp_eq_u32 vcc, -1, v72
  s_cbranch_vccz Cs1_h2w
  s_mov_b64 exec, vcc
  buffer_load_dwordx4 v[8:11], v76, s[8:11], s65 offen offset:2048 sc1
  s_mov_b64 exec, -1
  s_add_u32 s67, s67, 1
  s_waitcnt vmcnt(2)
  v_max3_u32 v72, v8, v9, v10
  v_max_u32 v72, v72, v11
  ds_write_b128 v76, v[8:11] offset:6656
  v_cmp_eq_u32 vcc, -1, v72
  s_cbranch_vccz Cs1_h2w
  s_cmp_lt_u32 s67, 131072
  s_cbranch_scc1 Cs1_h2s
  s_branch Cs1_h2w
Cs1_rec:
  s_nop 7
  s_waitcnt vmcnt(0) lgkmcnt(0)
  v_max3_u32 v72, v0, v1, v2
  v_max3_u32 v72, v72, v3, v4
  v_max3_u32 v72, v72, v5, v6
  v_max3_u32 v72, v72, v7, v8
  v_max3_u32 v72, v72, v9, v10
  v_max3_u32 v72, v72, v11, v12
  v_max3_u32 v72, v72, v13, v14
  v_max3_u32 v72, v72, v15, v16
  v_max3_u32 v72, v72, v17, v18
  v_max_u32 v72, v72, v19
  v_cmp_eq_u32 vcc, -1, v72
  s_cbranch_vccz Cs1_recok
  s_barrier
  v_mov_b64 v[20:21], 0
  v_mov_b64 v[22:23], 0
  v_mov_b64 v[24:25], 0
  v_mov_b64 v[26:27], 0
  v_mov_b64 v[28:29], 0
  v_mov_b64 v[30:31], 0
  v_mov_b64 v[32:33], 0
  v_mov_b64 v[34:35], 0
  s_waitcnt lgkmcnt(0)
  s_barrier
  ds_read_b128 v[0:3], v76 offset:4608
  s_waitcnt lgkmcnt(0)
  v_smfmac_f32_16x16x64_bf16 v[20:23], v[0:3], v[80:87], v74
  v_smfmac_f32_16x16x64_bf16 v[24:27], v[0:3], v[88:95], v74
  ds_read_b128 v[60:63], v76 offset:20480
  ds_read_b128 v[64:67], v76 offset:21504
  s_waitcnt lgkmcnt(0)
  v_smfmac_f32_16x16x64_bf16 v[28:31], v[0:3], v[60:67], v74
  ds_read_b128 v[60:63], v76 offset:22528
  ds_read_b128 v[64:67], v76 offset:23552
  s_waitcnt lgkmcnt(0)
  v_smfmac_f32_16x16x64_bf16 v[32:35], v[0:3], v[60:67], v74
  ds_read_b128 v[4:7], v76 offset:5632
  s_waitcnt lgkmcnt(0)
  v_smfmac_f32_16x16x64_bf16 v[20:23], v[4:7], v[96:103], v74
  v_smfmac_f32_16x16x64_bf16 v[24:27], v[4:7], v[104:111], v74
  ds_read_b128 v[60:63], v76 offset:36864
  ds_read_b128 v[64:67], v76 offset:37888
  s_waitcnt lgkmcnt(0)
  v_smfmac_f32_16x16x64_bf16 v[28:31], v[4:7], v[60:67], v74
  ds_read_b128 v[60:63], v76 offset:38912
  ds_read_b128 v[64:67], v76 offset:39936
  s_waitcnt lgkmcnt(0)
  v_smfmac_f32_16x16x64_bf16 v[32:35], v[4:7], v[60:67], v74
  ds_read_b128 v[8:11], v76 offset:6656
  s_waitcnt lgkmcnt(0)
  v_smfmac_f32_16x16x64_bf16 v[20:23], v[8:11], v[112:119], v74
  v_smfmac_f32_16x16x64_bf16 v[24:27], v[8:11], v[120:127], v74
  v_smfmac_f32_16x16x64_bf16 v[28:31], v[8:11], v[208:215], v74
  v_smfmac_f32_16x16x64_bf16 v[32:35], v[8:11], v[216:223], v74
  ds_read_b128 v[12:15], v76 offset:7680
  s_waitcnt lgkmcnt(0)
  v_smfmac_f32_16x16x64_bf16 v[20:23], v[12:15], v[128:135], v74
  v_smfmac_f32_16x16x64_bf16 v[24:27], v[12:15], v[136:143], v74
  v_smfmac_f32_16x16x64_bf16 v[28:31], v[12:15], v[224:231], v74
  v_smfmac_f32_16x16x64_bf16 v[32:35], v[12:15], v[232:239], v74
  ds_read_b128 v[8:11], v76 offset:8704
  s_waitcnt lgkmcnt(0)
  v_smfmac_f32_16x16x64_bf16 v[20:23], v[8:11], v[144:151], v74
  v_smfmac_f32_16x16x64_bf16 v[24:27], v[8:11], v[152:159], v74
  ds_read_b128 v[60:63], v76 offset:53248
  ds_read_b128 v[64:67], v76 offset:54272
  s_waitcnt lgkmcnt(0)
  v_smfmac_f32_16x16x64_bf16 v[28:31], v[8:11], v[60:67], v74
  ds_read_b128 v[60:63], v76 offset:55296
  ds_read_b128 v[64:67], v76 offset:56320
  s_waitcnt lgkmcnt(0)
  v_smfmac_f32_16x16x64_bf16 v[32:35], v[8:11], v[60:67], v74
  ds_read_b128 v[0:3], v76 offset:9728
  s_waitcnt lgkmcnt(0)
  v_smfmac_f32_16x16x64_bf16 v[20:23], v[0:3], v[160:167], v74
  v_smfmac_f32_16x16x64_bf16 v[24:27], v[0:3], v[168:175], v74
  ds_read_b128 v[60:63], v75 offset:20480
  ds_read_b128 v[64:67], v75 offset:21504
  s_waitcnt lgkmcnt(0)
  v_smfmac_f32_16x16x64_bf16 v[28:31], v[0:3], v[60:67], v74
  ds_read_b128 v[60:63], v75 offset:22528
  ds_read_b128 v[64:67], v75 offset:23552
  s_waitcnt lgkmcnt(0)
  v_smfmac_f32_16x16x64_bf16 v[32:35], v[0:3], v[60:67], v74
  ds_read_b128 v[16:19], v76 offset:10752
  ds_read_b128 v[60:63], v75 offset:4096
  ds_read_b128 v[64:67], v75 offset:5120
  s_waitcnt lgkmcnt(0)
  v_smfmac_f32_16x16x64_bf16 v[20:23], v[16:19], v[60:67], v74
  ds_read_b128 v[60:63], v75 offset:6144
  ds_read_b128 v[64:67], v75 offset:7168
  s_waitcnt lgkmcnt(0)
  v_smfmac_f32_16x16x64_bf16 v[24:27], v[16:19], v[60:67], v74
  v_smfmac_f32_16x16x64_bf16 v[28:31], v[16:19], v[240:247], v74
  v_smfmac_f32_16x16x64_bf16 v[32:35], v[16:19], v[248:255], v74
  ds_read_b128 v[4:7], v76 offset:11776
  s_waitcnt lgkmcnt(0)
  v_smfmac_f32_16x16x64_bf16 v[20:23], v[4:7], v[176:183], v74
  v_smfmac_f32_16x16x64_bf16 v[24:27], v[4:7], v[184:191], v74
  v_smfmac_f32_16x16x64_bf16 v[28:31], v[4:7], a[0:7], v74
  v_smfmac_f32_16x16x64_bf16 v[32:35], v[4:7], a[8:15], v74
  ds_read_b128 v[12:15], v76 offset:12800
  s_waitcnt lgkmcnt(0)
  v_smfmac_f32_16x16x64_bf16 v[20:23], v[12:15], v[192:199], v74
  v_smfmac_f32_16x16x64_bf16 v[24:27], v[12:15], v[200:207], v74
  v_smfmac_f32_16x16x64_bf16 v[28:31], v[12:15], a[16:23], v74
  v_smfmac_f32_16x16x64_bf16 v[32:35], v[12:15], a[24:31], v74
  v_add_f32 v20, v20, v22
  v_add_f32 v21, v21, v23
  v_add_f32 v24, v24, v26
  v_cvt_pk_bf16_f32 v22, v20, v24
  ds_write_b32 v79, v22 offset:0
  v_add_f32 v25, v25, v27
  v_cvt_pk_bf16_f32 v23, v21, v25
  ds_write_b32 v79, v23 offset:576
  v_add_f32 v28, v28, v30
  v_add_f32 v29, v29, v31
  s_waitcnt lgkmcnt(0)
  s_nop 1
  s_branch Cs1_recok
Cs1_mx:
  s_waitcnt lgkmcnt(0)
  s_barrier
  buffer_load_dwordx4 v[0:3], v76, s[8:11], s58 offen offset:0 sc1
  ds_read_b128 v[20:23], v77 offset:0
  ds_read_b128 v[28:31], v77 offset:256
  buffer_load_dwordx4 v[4:7], v76, s[8:11], s58 offen offset:1024 sc1
  ds_read_b128 v[24:27], v77 offset:128
  ds_read_b128 v[32:35], v77 offset:384
  s_waitcnt vmcnt(1) lgkmcnt(3)
  v_mfma_f32_16x16x32_bf16 v[8:11], v[0:3], v[20:23], 0
  s_waitcnt vmcnt(0) lgkmcnt(1)
  v_mfma_f32_16x16x32_bf16 v[8:11], v[4:7], v[24:27], v[8:11]
  v_mfma_f32_16x16x32_bf16 v[12:15], v[28:31], v[20:23], 0
  s_waitcnt lgkmcnt(0)
  v_mfma_f32_16x16x32_bf16 v[12:15], v[32:35], v[24:27], v[12:15]
  v_add_f32_dpp v8, v10, v8 quad_perm:[2,3,0,1] row_mask:0xf bank_mask:0xf
  v_add_f32_dpp v9, v11, v9 quad_perm:[2,3,0,1] row_mask:0xf bank_mask:0xf
  s_nop 0
  v_mov_b32_dpp v8, v8 quad_perm:[0,1,0,1] row_mask:0xf bank_mask:0xf
  v_mov_b32_dpp v9, v9 quad_perm:[0,1,0,1] row_mask:0xf bank_mask:0xf
  s_nop 1
  v_add_f32_dpp v12, v14, v12 quad_perm:[2,3,0,1] row_mask:0xf bank_mask:0xf
  v_add_f32_dpp v13, v15, v13 quad_perm:[2,3,0,1] row_mask:0xf bank_mask:0xf
  s_nop 0
  v_mov_b32_dpp v12, v12 quad_perm:[0,1,0,1] row_mask:0xf bank_mask:0xf
  v_mov_b32_dpp v13, v13 quad_perm:[0,1,0,1] row_mask:0xf bank_mask:0xf
  v_mul_f32 v12, s69, v12
  ds_write_b32 v78, v8 offset:8708
  v_mul_f32 v13, s69, v13
  ds_write_b32 v78, v9 offset:8772
  s_waitcnt lgkmcnt(0)
  s_barrier
  ds_read_b128 v[36:39], v78 offset:8704
  ds_read_b128 v[40:43], v78 offset:8768
  s_waitcnt lgkmcnt(0)
  s_barrier
  v_max_f32 v16, v36, v37
  v_max3_f32 v16, v16, v38, v39
  v_max3_f32 v16, v16, v40, v41
  v_max3_f32 v16, v16, v42, v43
  v_max3_f32 v16, v16, v12, v13
  v_mov_b32 v17, v16
  s_nop 1
  v_permlane16_swap_b32 v16, v17
  v_max_f32 v16, v16, v17
  v_mov_b32 v17, v16
  s_nop 1
  v_permlane32_swap_b32 v16, v17
  v_max_f32 v16, v16, v17
  v_sub_f32 v36, v36, v16
  v_sub_f32 v37, v37, v16
  v_sub_f32 v38, v38, v16
  v_sub_f32 v39, v39, v16
  v_sub_f32 v40, v40, v16
  v_sub_f32 v41, v41, v16
  v_sub_f32 v42, v42, v16
  v_sub_f32 v43, v43, v16
  v_sub_f32 v12, v12, v16
  v_sub_f32 v13, v13, v16
  v_exp_f32 v36, v36
  v_exp_f32 v37, v37
  v_exp_f32 v38, v38
  v_exp_f32 v39, v39
  v_exp_f32 v40, v40
  v_exp_f32 v41, v41
  v_exp_f32 v42, v42
  v_exp_f32 v43, v43
  v_exp_f32 v12, v12
  v_exp_f32 v13, v13
  v_cvt_pk_bf16_f32 v32, v36, v40
  v_cvt_pk_bf16_f32 v33, v37, v41
  v_cvt_pk_bf16_f32 v34, v38, v42
  v_cvt_pk_bf16_f32 v35, v39, v43
  v_cvt_pk_bf16_f32 v28, v12, v13
  v_cvt_pk_bf16_f32 v31, v12, v13
  v_mov_b32 v29, 0
  v_mov_b32 v30, 0
  v_mov_b32 v68, 0x3f803f80
  v_mov_b32 v69, 0x3f803f80
  v_mov_b32 v70, 0x3f803f80
  v_mov_b32 v71, 0x3f803f80
  s_nop 1
  v_mfma_f32_16x16x32_bf16 v[8:11], v[32:35], v[68:71], 0
  v_mfma_f32_16x16x32_bf16 v[0:3], v[32:35], v[52:55], 0
  v_mfma_f32_16x16x32_bf16 v[4:7], v[32:35], v[56:59], 0
  v_mfma_f32_16x16x16_bf16 v[8:11], v[28:29], v[68:69], v[8:11]
  v_mfma_f32_16x16x16_bf16 v[0:3], v[28:29], v[72:73], v[0:3]
  v_mfma_f32_16x16x16_bf16 v[4:7], v[30:31], v[72:73], v[4:7]
  ds_read_b128 v[68:71], v76 offset:13824
  v_rcp_f32 v10, v8
  v_rcp_f32 v11, v9
  v_mul_f32 v0, v10, v0
  v_mul_f32 v1, v11, v1
  s_nop 0
  v_mul_f32 v4, v10, v4
  v_mul_f32 v5, v11, v5
  v_cvt_pk_bf16_f32 v2, v0, v4
  ds_write_b32 v79, v2 offset:8704
  v_cvt_pk_bf16_f32 v3, v1, v5
  ds_write_b32 v79, v3 offset:9280
  v_mov_b64 v[16:17], 0
  v_mov_b64 v[18:19], 0
  v_mov_b64 v[20:21], 0
  v_mov_b64 v[22:23], 0
  v_mov_b64 v[24:25], 0
  v_mov_b64 v[26:27], 0
  s_branch Cs1_mxok
Cs1_last:
  ds_read_b128 v[4:7], v76 offset:5632
  ds_read_b128 v[12:15], v76 offset:7680
  ds_read_b128 v[44:47], v76 offset:36864
  ds_read_b128 v[48:51], v76 offset:37888
  s_nop 5
  v_mov_b64 v[20:21], 0
  v_mov_b64 v[22:23], 0
  v_mov_b64 v[24:25], 0
  v_mov_b64 v[26:27], 0
  s_waitcnt lgkmcnt(4)
  v_smfmac_f32_16x16x64_bf16 v[28:31], v[0:3], v[36:43], v74
  ds_read_b128 v[36:39], v76 offset:38912
  ds_read_b128 v[40:43], v76 offset:39936
  v_smfmac_f32_16x16x64_bf16 v[32:35], v[0:3], v[60:67], v74
  s_waitcnt lgkmcnt(5)
  v_smfmac_f32_16x16x64_bf16 v[20:23], v[0:3], a[32:39], v74
  ds_read_b128 v[60:63], v76 offset:53248
  ds_read_b128 v[64:67], v76 offset:54272
  v_smfmac_f32_16x16x64_bf16 v[24:27], v[0:3], a[40:47], v74
  s_waitcnt lgkmcnt(4)
  v_smfmac_f32_16x16x64_bf16 v[20:23], v[4:7], a[48:55], v74
  buffer_store_dwordx4 v[16:19], v76, s[8:11], s68 offen sc1
  v_smfmac_f32_16x16x64_bf16 v[24:27], v[4:7], a[56:63], v74
  v_smfmac_f32_16x16x64_bf16 v[28:31], v[4:7], v[44:51], v74
  s_waitcnt lgkmcnt(2)
  v_smfmac_f32_16x16x64_bf16 v[20:23], v[8:11], a[64:71], v74
  ds_read_b128 v[44:47], v76 offset:55296
  ds_read_b128 v[48:51], v76 offset:56320
  v_smfmac_f32_16x16x64_bf16 v[24:27], v[8:11], a[72:79], v74
  v_smfmac_f32_16x16x64_bf16 v[32:35], v[4:7], v[36:43], v74
  v_smfmac_f32_16x16x64_bf16 v[28:31], v[8:11], v[208:215], v74
  ds_read_b128 v[36:39], v75 offset:20480
  ds_read_b128 v[40:43], v75 offset:21504
  v_smfmac_f32_16x16x64_bf16 v[32:35], v[8:11], v[216:223], v74
  v_smfmac_f32_16x16x64_bf16 v[20:23], v[12:15], a[80:87], v74
  v_smfmac_f32_16x16x64_bf16 v[24:27], v[12:15], a[88:95], v74
  v_smfmac_f32_16x16x64_bf16 v[28:31], v[12:15], v[224:231], v74
  v_smfmac_f32_16x16x64_bf16 v[32:35], v[12:15], v[232:239], v74
  s_waitcnt vmcnt(2)
  s_waitcnt vmcnt(1)
  s_barrier
Cs1_lastr:
  ds_read_b128 v[8:11], v76 offset:8704
  ds_read_b128 v[0:3], v76 offset:9728
  ds_read_b128 v[16:19], v76 offset:10752
  ds_read_b128 v[4:7], v76 offset:11776
  ds_read_b128 v[12:15], v76 offset:12800
  s_waitcnt lgkmcnt(3)
  v_max3_u32 v72, v0, v1, v2
  s_waitcnt lgkmcnt(1)
  v_max3_u32 v72, v72, v3, v4
  v_max3_u32 v72, v72, v5, v6
  v_max3_u32 v72, v72, v7, v8
  v_max3_u32 v72, v72, v9, v10
  s_waitcnt lgkmcnt(0)
  v_max3_u32 v72, v72, v11, v12
  v_max3_u32 v72, v72, v13, v14
  v_max3_u32 v72, v72, v15, v16
  v_max3_u32 v72, v72, v17, v18
  v_max_u32 v72, v72, v19
  v_cmp_eq_u32 vcc, -1, v72
  s_cbranch_vccnz Cs1_lastp
Cs1_lastg:
  v_smfmac_f32_16x16x64_bf16 v[28:31], v[8:11], v[60:67], v74
  ds_read_b128 v[60:63], v75 offset:22528
  ds_read_b128 v[64:67], v75 offset:23552
  v_smfmac_f32_16x16x64_bf16 v[32:35], v[8:11], v[44:51], v74
  v_smfmac_f32_16x16x64_bf16 v[28:31], v[0:3], v[36:43], v74
  v_smfmac_f32_16x16x64_bf16 v[28:31], v[16:19], v[240:247], v74
  v_smfmac_f32_16x16x64_bf16 v[28:31], v[4:7], a[0:7], v74
  v_smfmac_f32_16x16x64_bf16 v[28:31], v[12:15], a[16:23], v74
  v_smfmac_f32_16x16x64_bf16 v[32:35], v[16:19], v[248:255], v74
  v_smfmac_f32_16x16x64_bf16 v[32:35], v[4:7], a[8:15], v74
  s_waitcnt lgkmcnt(0)
  v_smfmac_f32_16x16x64_bf16 v[32:35], v[12:15], a[24:31], v74
  v_smfmac_f32_16x16x64_bf16 v[32:35], v[0:3], v[60:67], v74
  v_smfmac_f32_16x16x64_bf16 v[20:23], v[8:11], a[96:103], v74
  v_smfmac_f32_16x16x64_bf16 v[20:23], v[0:3], a[112:119], v74
  v_add_f32 v28, v28, v30
  v_add_f32 v32, v32, v34
  v_cvt_pk_bf16_f32 v30, v28, v32
  v_smfmac_f32_16x16x64_bf16 v[20:23], v[16:19], a[128:135], v74
  ds_write_b32 v79, v30 offset:256
  v_add_f32 v29, v29, v31
  v_add_f32 v33, v33, v35
  v_cvt_pk_bf16_f32 v31, v29, v33
  v_smfmac_f32_16x16x64_bf16 v[20:23], v[4:7], a[144:151], v74
  ds_write_b32 v79, v31 offset:832
  v_smfmac_f32_16x16x64_bf16 v[20:23], v[12:15], a[160:167], v74
  v_smfmac_f32_16x16x64_bf16 v[24:27], v[8:11], a[104:111], v74
  v_smfmac_f32_16x16x64_bf16 v[24:27], v[0:3], a[120:127], v74
  v_smfmac_f32_16x16x64_bf16 v[24:27], v[16:19], a[136:143], v74
  s_waitcnt lgkmcnt(0)
  s_barrier
  ds_read_b64 v[52:53], v77 offset:264
  v_add_f32 v20, v20, v22
  v_smfmac_f32_16x16x64_bf16 v[24:27], v[4:7], a[152:159], v74
  v_add_f32 v21, v21, v23
  v_smfmac_f32_16x16x64_bf16 v[24:27], v[12:15], a[168:175], v74
  v_cvt_pk_bf16_f32 v54, v20, v21
  s_add_u32 s68, s68, 655360
  s_nop 3
  v_add_f32 v24, v24, v26
  v_add_f32 v25, v25, v27
  v_cvt_pk_bf16_f32 v55, v24, v25
  s_waitcnt lgkmcnt(0)
  buffer_store_dwordx4 v[52:55], v76, s[8:11], s68 offen sc1
  s_branch Cs1_done
Cs1_lastp:
  s_add_u32 s72, s72, 2
  s_cmp_ge_u32 s72, 131072
  s_cbranch_scc1 Cs1_lastg
  s_barrier
  buffer_load_dwordx4 v76, s[8:11], s85 offen offset:0 sc1 lds
  s_waitcnt vmcnt(0)
  s_barrier
  s_branch Cs1_lastr
Cs1_done:
  s_branch L_cexit
L_w6:
  v_mov_b64 v[20:21], 0
  v_mov_b64 v[22:23], 0
  v_mov_b64 v[24:25], 0
  v_mov_b64 v[26:27], 0
  v_mov_b64 v[28:29], 0
  v_mov_b64 v[30:31], 0
  v_mov_b64 v[32:33], 0
  v_mov_b64 v[34:35], 0
  s_mov_b32 s78, 0x3f803f80
  s_mov_b32 s79, s78
  s_mov_b32 s65, 360448
  s_mov_b32 m0, 15872
  s_lshl_b32 s71, s53, 2
  s_add_u32 s71, s71, 128
  s_movk_i32 s56, 0x1000
  v_lshlrev_b32 v73, 2, v76
  v_mov_b32 v72, 0
  s_mov_b64 s[16:17], s[8:9]
  s_mov_b32 s18, 268435456
  s_mov_b32 s19, 0x20000
  s_getpc_b64 s[20:21]
Cs2_pc:
  s_add_u32 s20, s20, (Cs2_last - Cs2_pc)
  s_addc_u32 s21, s21, 0
  v_mov_b32 v68, 14880
  buffer_load_dwordx4 v[52:55], v76, s[8:11], s59 offen offset:0 sc1
  buffer_load_dwordx4 v[56:59], v76, s[8:11], s59 offen offset:1024 sc1
  ds_read_b128 v[36:39], v76 offset:24576
  ds_read_b128 v[40:43], v76 offset:25600
  ds_read_b128 v[60:63], v76 offset:26624
  ds_read_b128 v[64:67], v76 offset:27648
  ds_read_b128 v[0:3], v76 offset:4608
  ds_read_b128 v[4:7], v76 offset:5632
  ds_read_b128 v[8:11], v76 offset:6656
  ds_read_b128 v[12:15], v76 offset:7680
  s_waitcnt lgkmcnt(0)
  s_cmp_eq_u32 s66, 1
  s_branch Cs2_top2
.p2align 6
Cs2_h2:
  s_cmp_eq_u32 s66, 62
  s_cselect_b64 s[16:17], s[20:21], s[16:17]
  s_cselect_b32 s18, (Cs2_done - Cs2_last), s18
  s_cselect_b32 s70, 0, s70
  s_cmp_eq_u32 s66, 63
  s_cselect_b32 s59, 268435456, s59
  s_cselect_b32 s58, 268435456, s58
  buffer_load_dwordx4 v[12:15], v76, s[8:11], s65 offen offset:3072 sc1
  ds_read_b128 v[36:39], v76 offset:24576
  s_waitcnt lgkmcnt(0)
  v_mov_b64 v[28:29], 0
  v_mov_b64 v[30:31], 0
  v_mov_b64 v[32:33], 0
  v_mov_b64 v[34:35], 0
  v_lshlrev_b32 v73, 2, v76
  buffer_load_dwordx4 v[12:15], v76, s[8:11], s65 offen offset:3072 sc1
  ds_read_b128 v[40:43], v76 offset:25600
  s_waitcnt lgkmcnt(0)
  v_mov_b64 v[20:21], 0
  v_mov_b64 v[22:23], 0
  v_mov_b64 v[24:25], 0
  v_mov_b64 v[26:27], 0
  v_mov_b32 v68, 14880
  buffer_load_dwordx4 v[12:15], v76, s[8:11], s65 offen offset:3072 sc1
  buffer_load_dwordx4 v[52:55], v76, s[8:11], s59 offen offset:0 sc1
  buffer_load_dwordx4 v[56:59], v76, s[8:11], s59 offen offset:1024 sc1
  s_waitcnt vmcnt(4)
  v_max3_u32 v72, v12, v13, v14
  v_max_u32 v72, v72, v15
  ds_write_b128 v76, v[12:15] offset:7680
  v_cmp_eq_u32 vcc, -1, v72
  s_cbranch_vccnz Cs2_h2r
Cs2_h2w:
  s_cmp_eq_u32 s66, 63
  s_waitcnt lgkmcnt(0)
  s_barrier
  ds_read_b128 v[0:3], v76 offset:4608
  buffer_load_dwordx4 v76, s[8:11], s85 offen offset:0 sc1 lds
Cs2_top2:
  v_smfmac_f32_16x16x64_bf16 v[20:23], v[12:15], v[128:135], v74
  s_cbranch_scc1 Cs2_last
  v_smfmac_f32_16x16x64_bf16 v[24:27], v[12:15], v[136:143], v74
  buffer_load_dwordx4 v[44:47], v76, s[8:11], s58 offen offset:0 sc1
  s_mov_b32 m0, 15872
  v_smfmac_f32_16x16x64_bf16 v[28:31], v[12:15], v[224:231], v74
  buffer_load_dwordx4 v[48:51], v76, s[8:11], s58 offen offset:1024 sc1
  v_smfmac_f32_16x16x64_bf16 v[32:35], v[12:15], v[232:239], v74
  ds_read_b128 v[4:7], v76 offset:5632
  s_waitcnt lgkmcnt(1)
  v_smfmac_f32_16x16x64_bf16 v[20:23], v[0:3], v[80:87], v74
  ds_read_b128 v[8:11], v76 offset:6656
  v_smfmac_f32_16x16x64_bf16 v[28:31], v[0:3], v[36:43], v74
  ds_read_b128 v[36:39], v76 offset:40960
  v_smfmac_f32_16x16x64_bf16 v[24:27], v[0:3], v[88:95], v74
  buffer_store_dwordx4 v[16:19], v76, s[8:11], s68 offen sc1
  ds_read_b128 v[40:43], v76 offset:41984
  v_smfmac_f32_16x16x64_bf16 v[32:35], v[0:3], v[60:67], v74
  ds_read_b128 v[60:63], v76 offset:43008
  s_waitcnt lgkmcnt(4)
  v_smfmac_f32_16x16x64_bf16 v[20:23], v[4:7], v[96:103], v74
  ds_read_b128 v[64:67], v76 offset:44032
  v_smfmac_f32_16x16x64_bf16 v[24:27], v[4:7], v[104:111], v74
  buffer_load_dword v73, s[16:19], s70 offen lds
  s_waitcnt vmcnt(5)
  s_waitcnt lgkmcnt(4)
  v_smfmac_f32_16x16x64_bf16 v[20:23], v[8:11], v[112:119], v74
  s_barrier
  s_waitcnt lgkmcnt(2)
  v_smfmac_f32_16x16x64_bf16 v[28:31], v[4:7], v[36:43], v74
  ds_read_b128 v[12:15], v76 offset:8704
  v_smfmac_f32_16x16x64_bf16 v[24:27], v[8:11], v[120:127], v74
  ds_read_b128 v[36:39], v76 offset:57344
  s_waitcnt lgkmcnt(2)
  v_smfmac_f32_16x16x64_bf16 v[32:35], v[4:7], v[60:67], v74
  ds_read_b128 v[40:43], v76 offset:58368
  v_smfmac_f32_16x16x64_bf16 v[28:31], v[8:11], v[208:215], v74
  ds_read_b128 v[60:63], v76 offset:59392
  v_smfmac_f32_16x16x64_bf16 v[32:35], v[8:11], v[216:223], v74
  ds_read_b128 v[64:67], v76 offset:60416
  s_waitcnt lgkmcnt(4)
  v_smfmac_f32_16x16x64_bf16 v[20:23], v[12:15], v[144:151], v74
  s_waitcnt vmcnt(4)
  ds_read_b128 v[0:3], v76 offset:9728
  s_waitcnt lgkmcnt(3)
  v_smfmac_f32_16x16x64_bf16 v[28:31], v[12:15], v[36:43], v74
  s_barrier
  ds_read_b128 v[4:7], v76 offset:11776
  v_smfmac_f32_16x16x64_bf16 v[24:27], v[12:15], v[152:159], v74
  ds_read_b128 v[36:39], v75 offset:8192
  ds_read_b128 v[40:43], v75 offset:9216
  s_waitcnt lgkmcnt(4)
  v_smfmac_f32_16x16x64_bf16 v[32:35], v[12:15], v[60:67], v74
  ds_read_b128 v[16:19], v76 offset:10752
  s_waitcnt lgkmcnt(4)
  v_smfmac_f32_16x16x64_bf16 v[20:23], v[0:3], v[160:167], v74
  ds_read_b128 v[8:11], v76 offset:12800
  v_smfmac_f32_16x16x64_bf16 v[24:27], v[0:3], v[168:175], v74
  ds_read_b128 v[60:63], v75 offset:10240
  ds_read_b128 v[64:67], v75 offset:11264
  s_waitcnt lgkmcnt(6)
  v_smfmac_f32_16x16x64_bf16 v[20:23], v[4:7], v[176:183], v74
  s_waitcnt lgkmcnt(3)
  v_smfmac_f32_16x16x64_bf16 v[20:23], v[16:19], v[36:43], v74
  ds_read_b128 v[36:39], v75 offset:24576
  s_waitcnt lgkmcnt(3)
  v_smfmac_f32_16x16x64_bf16 v[20:23], v[8:11], v[192:199], v74
  ds_read_b128 v[40:43], v75 offset:25600
  s_waitcnt lgkmcnt(2)
  v_smfmac_f32_16x16x64_bf16 v[24:27], v[16:19], v[60:67], v74
  ds_read_b128 v[60:63], v75 offset:26624
  v_smfmac_f32_16x16x64_bf16 v[24:27], v[4:7], v[184:191], v74
  ds_read_b128 v[64:67], v75 offset:27648
  v_add_f32 v20, v20, v22
  v_smfmac_f32_16x16x64_bf16 v[24:27], v[8:11], v[200:207], v74
  v_add_f32 v21, v21, v23
  v_smfmac_f32_16x16x64_bf16 v[28:31], v[16:19], v[240:247], v74
  s_waitcnt lgkmcnt(2)
  v_mov_b64 v[70:71], s[78:79]
  v_smfmac_f32_16x16x64_bf16 v[28:31], v[0:3], v[36:43], v74
  ds_read_b128 v[36:39], v68
  v_add_f32 v24, v24, v26
  v_smfmac_f32_16x16x64_bf16 v[28:31], v[4:7], a[0:7], v74
  ds_read_b128 v[40:43], v68
  v_cvt_pk_bf16_f32 v22, v20, v24
  v_smfmac_f32_16x16x64_bf16 v[28:31], v[8:11], a[16:23], v74
  ds_write_b32 v79, v22 offset:0
  s_waitcnt lgkmcnt(3)
  v_add_f32 v25, v25, v27
  v_cvt_pk_bf16_f32 v23, v21, v25
  v_smfmac_f32_16x16x64_bf16 v[32:35], v[0:3], v[60:67], v74
  ds_write_b32 v79, v23 offset:576
  v_cmp_u_f32 vcc, v20, v21
  v_smfmac_f32_16x16x64_bf16 v[32:35], v[16:19], v[248:255], v74
  v_add_f32 v28, v28, v30
  v_smfmac_f32_16x16x64_bf16 v[32:35], v[4:7], a[8:15], v74
  v_add_f32 v29, v29, v31
  v_smfmac_f32_16x16x64_bf16 v[32:35], v[8:11], a[24:31], v74
  s_cbranch_vccnz Cs2_rec
Cs2_recok:
  s_waitcnt lgkmcnt(3)
  v_smfmac_f32_16x16x64_bf16 v[36:39], v[16:19], a[128:135], v74
  s_waitcnt lgkmcnt(0)
  s_barrier
  ds_read_b128 v[60:63], v77
  v_smfmac_f32_16x16x64_bf16 v[40:43], v[16:19], a[136:143], v74
  ds_read_b128 v[64:67], v77 offset:128
  v_add_f32 v32, v32, v34
  v_cvt_pk_bf16_f32 v30, v28, v32
  v_smfmac_f32_16x16x64_bf16 v[36:39], v[0:3], a[112:119], v74
  ds_write_b32 v79, v30 offset:256
  v_add_f32 v33, v33, v35
  v_cvt_pk_bf16_f32 v31, v29, v33
  v_smfmac_f32_16x16x64_bf16 v[40:43], v[0:3], a[120:127], v74
  ds_write_b32 v79, v31 offset:832
  v_xor_b32 v75, 0x8000, v75
  v_smfmac_f32_16x16x64_bf16 v[36:39], v[4:7], a[144:151], v74
  ds_read_b128 v[0:3], v76 offset:4608
  v_mov_b32 v29, 0
  v_smfmac_f32_16x16x64_bf16 v[40:43], v[4:7], a[152:159], v74
  s_waitcnt vmcnt(2) lgkmcnt(3)
  v_mov_b32 v30, 0
  v_mfma_f32_16x16x32_bf16 v[44:47], v[44:47], v[60:63], 0
  ds_read_b128 v[4:7], v76 offset:5632
  s_waitcnt lgkmcnt(2)
  v_mfma_f32_16x16x32_bf16 v[44:47], v[48:51], v[64:67], v[44:47]
  s_barrier
  v_smfmac_f32_16x16x64_bf16 v[36:39], v[8:11], a[160:167], v74
  ds_read_b128 v[20:23], v77 offset:256
  ds_read_b128 v[24:27], v77 offset:384
  v_smfmac_f32_16x16x64_bf16 v[40:43], v[8:11], a[168:175], v74
  ds_read_b128 v[8:11], v76 offset:6656
  v_add_f32_dpp v72, v46, v44 quad_perm:[2,3,0,1] row_mask:0xf bank_mask:0xf
  v_add_f32_dpp v73, v47, v45 quad_perm:[2,3,0,1] row_mask:0xf bank_mask:0xf
  v_smfmac_f32_16x16x64_bf16 v[36:39], v[12:15], a[96:103], v74
  s_waitcnt lgkmcnt(4)
  v_exp_f32_dpp v72, v72 quad_perm:[0,1,0,1] row_mask:0xf bank_mask:0xf
  v_smfmac_f32_16x16x64_bf16 v[40:43], v[12:15], a[104:111], v74
  ds_read_b128 v[12:15], v76 offset:7680
  v_exp_f32_dpp v73, v73 quad_perm:[0,1,0,1] row_mask:0xf bank_mask:0xf
  v_smfmac_f32_16x16x64_bf16 v[36:39], v[0:3], a[32:39], v74
  s_waitcnt lgkmcnt(2)
  v_cvt_pk_bf16_f32 v72, v72, v73
  v_mfma_f32_16x16x32_bf16 v[20:23], v[20:23], v[60:63], 0
  ds_write_b32 v78, v72 offset:520
  v_mov_b64 v[16:17], 0
  v_mfma_f32_16x16x32_bf16 v[20:23], v[24:27], v[64:67], v[20:23]
  ds_read_b128 v[44:47], v75 offset:24576
  v_mov_b64 v[18:19], 0
  v_smfmac_f32_16x16x64_bf16 v[40:43], v[0:3], a[40:47], v74
  ds_read_b128 v[48:51], v75 offset:25600
  v_mov_b64 v[68:69], s[78:79]
  v_smfmac_f32_16x16x64_bf16 v[36:39], v[4:7], a[48:55], v74
  s_waitcnt lgkmcnt(4)
  v_add_f32_dpp v24, v22, v20 quad_perm:[2,3,0,1] row_mask:0xf bank_mask:0xf
  v_add_f32_dpp v25, v23, v21 quad_perm:[2,3,0,1] row_mask:0xf bank_mask:0xf
  v_smfmac_f32_16x16x64_bf16 v[36:39], v[8:11], a[64:71], v74
  s_waitcnt lgkmcnt(2)
  s_barrier
  ds_read_b128 v[32:35], v78 offset:512
  v_smfmac_f32_16x16x64_bf16 v[36:39], v[12:15], a[80:87], v74
  ds_read_b128 v[60:63], v75 offset:26624
  v_mul_f32 v24, s69, v24
  v_smfmac_f32_16x16x64_bf16 v[40:43], v[4:7], a[56:63], v74
  ds_read_b128 v[64:67], v75 offset:27648
  v_mul_f32 v25, s69, v25
  v_smfmac_f32_16x16x64_bf16 v[40:43], v[8:11], a[72:79], v74
  v_exp_f32_dpp v24, v24 quad_perm:[0,1,0,1] row_mask:0xf bank_mask:0xf
  v_smfmac_f32_16x16x64_bf16 v[40:43], v[12:15], a[88:95], v74
  s_waitcnt lgkmcnt(2)
  v_exp_f32_dpp v25, v25 quad_perm:[0,1,0,1] row_mask:0xf bank_mask:0xf
  v_mfma_f32_16x16x32_bf16 v[8:11], v[32:35], v[68:71], 0
  v_add_f32 v36, v36, v38
  v_add_f32 v37, v37, v39
  v_mfma_f32_16x16x32_bf16 v[0:3], v[32:35], v[52:55], 0
  v_add_f32 v40, v40, v42
  v_add_f32 v41, v41, v43
  v_mfma_f32_16x16x32_bf16 v[4:7], v[32:35], v[56:59], 0
  v_cvt_pk_bf16_f32 v28, v24, v25
  v_cvt_pk_bf16_f32 v72, v36, v37
  v_cvt_pk_bf16_f32 v73, v40, v41
  v_mfma_f32_16x16x16_bf16 v[8:11], v[28:29], v[68:69], v[8:11]
  v_cvt_pk_bf16_f32 v31, v24, v25
  v_mov_b64 v[20:21], 0
  v_mfma_f32_16x16x16_bf16 v[0:3], v[28:29], v[72:73], v[0:3]
  ds_read_b128 v[68:71], v76 offset:13824
  v_mov_b64 v[22:23], 0
  v_mfma_f32_16x16x16_bf16 v[4:7], v[30:31], v[72:73], v[4:7]
  v_rcp_f32 v10, v8
  v_rcp_f32 v11, v9
  v_mul_f32 v0, v10, v0
  v_mul_f32 v1, v11, v1
  s_nop 0
  v_mul_f32 v4, v10, v4
  v_mul_f32 v5, v11, v5
  v_cvt_pk_bf16_f32 v2, v0, v4
  ds_write_b32 v79, v2 offset:8704
  v_cvt_pk_bf16_f32 v3, v1, v5
  ds_write_b32 v79, v3 offset:9280
  v_max3_f32 v8, v8, v9, v10
  v_max_f32 v8, v8, v11
  v_cmp_le_f32 vcc, 1317011456, v8
  v_mov_b64 v[24:25], 0
  v_mov_b64 v[26:27], 0
  s_cbranch_vccnz Cs2_mx
Cs2_mxok:
  s_waitcnt lgkmcnt(0)
  s_barrier
  ds_read_b128 v[0:3], v78 offset:8704
  ds_read_b128 v[4:7], v78 offset:8768
  ds_read_b128 v[8:11], v78 offset:8832
  ds_read_b128 v[12:15], v78 offset:8896
  s_waitcnt lgkmcnt(3)
  v_smfmac_f32_16x16x64_bf16 v[16:19], v[0:3], v[44:51], v74
  ds_read_b128 v[52:55], v75 offset:40960
  s_waitcnt lgkmcnt(3)
  v_smfmac_f32_16x16x64_bf16 v[16:19], v[4:7], v[60:67], v74
  ds_read_b128 v[56:59], v75 offset:41984
  s_waitcnt lgkmcnt(3)
  v_smfmac_f32_16x16x64_bf16 v[16:19], v[8:11], a[176:183], v74
  ds_read_b128 v[36:39], v75 offset:43008
  s_waitcnt lgkmcnt(3)
  v_smfmac_f32_16x16x64_bf16 v[16:19], v[12:15], a[184:191], v74
  ds_read_b128 v[40:43], v75 offset:44032
  ds_read_b128 v[44:47], v75 offset:57344
  v_smfmac_f32_16x16x64_bf16 v[20:23], v[0:3], a[192:199], v74
  ds_read_b128 v[48:51], v75 offset:58368
  ds_read_b128 v[60:63], v75 offset:59392
  v_smfmac_f32_16x16x64_bf16 v[20:23], v[4:7], a[200:207], v74
  ds_read_b128 v[64:67], v75 offset:60416
  s_waitcnt lgkmcnt(6)
  v_cvt_pk_bf16_f32 v16, v16, v17
  v_cvt_pk_bf16_f32 v17, v18, v19
  v_bfi_b32 v16, 1, s72, v16
  v_smfmac_f32_16x16x64_bf16 v[20:23], v[8:11], v[52:59], v74
  buffer_store_dwordx2 v[16:17], v68, s[8:11], s73 offen sc1
  s_waitcnt lgkmcnt(4)
  v_smfmac_f32_16x16x64_bf16 v[20:23], v[12:15], v[36:43], v74
  ds_read_b128 v[52:55], v75 offset:0
  v_mov_b64 v[32:33], 0
  v_smfmac_f32_16x16x64_bf16 v[24:27], v[0:3], a[208:215], v74
  ds_read_b128 v[56:59], v75 offset:1024
  v_mov_b64 v[34:35], 0
  v_smfmac_f32_16x16x64_bf16 v[24:27], v[4:7], a[216:223], v74
  ds_read_b128 v[36:39], v75 offset:2048
  s_waitcnt lgkmcnt(5)
  v_cvt_pk_bf16_f32 v20, v20, v21
  v_cvt_pk_bf16_f32 v21, v22, v23
  v_bfi_b32 v20, 1, s72, v20
  v_smfmac_f32_16x16x64_bf16 v[24:27], v[8:11], v[44:51], v74
  buffer_store_dwordx2 v[20:21], v68, s[8:11], s74 offen sc1
  s_waitcnt lgkmcnt(3)
  v_smfmac_f32_16x16x64_bf16 v[24:27], v[12:15], v[60:67], v74
  ds_read_b128 v[40:43], v75 offset:3072
  v_mov_b64 v[28:29], 0
  v_smfmac_f32_16x16x64_bf16 v[32:35], v[0:3], a[224:231], v74
  ds_read_b128 v[44:47], v75 offset:4096
  ds_read_b128 v[48:51], v75 offset:5120
  v_smfmac_f32_16x16x64_bf16 v[32:35], v[4:7], a[232:239], v74
  ds_read_b128 v[60:63], v75 offset:6144
  v_cvt_pk_bf16_f32 v24, v24, v25
  v_cvt_pk_bf16_f32 v25, v26, v27
  v_bfi_b32 v24, 1, s72, v24
  v_smfmac_f32_16x16x64_bf16 v[32:35], v[8:11], a[240:247], v74
  buffer_store_dwordx2 v[24:25], v68, s[8:11], s75 offen sc1
  v_mov_b64 v[30:31], 0
  v_smfmac_f32_16x16x64_bf16 v[32:35], v[12:15], a[248:255], v74
  ds_read_b128 v[64:67], v75 offset:7168
  s_waitcnt lgkmcnt(6)
  v_smfmac_f32_16x16x64_bf16 v[28:31], v[0:3], v[52:59], v74
  s_waitcnt lgkmcnt(4)
  v_smfmac_f32_16x16x64_bf16 v[28:31], v[4:7], v[36:43], v74
  s_waitcnt lgkmcnt(2)
  v_cvt_pk_bf16_f32 v32, v32, v33
  v_cvt_pk_bf16_f32 v33, v34, v35
  v_bfi_b32 v32, 1, s72, v32
  v_smfmac_f32_16x16x64_bf16 v[28:31], v[8:11], v[44:51], v74
  buffer_store_dwordx2 v[32:33], v68, s[8:11], s76 offen sc1
  s_waitcnt lgkmcnt(0)
  v_smfmac_f32_16x16x64_bf16 v[28:31], v[12:15], v[60:67], v74
  v_mov_b64 v[18:19], v[72:73]
  s_nop 4
  v_cvt_pk_bf16_f32 v28, v28, v29
  v_cvt_pk_bf16_f32 v29, v30, v31
  v_bfi_b32 v28, 1, s72, v28
  buffer_store_dwordx2 v[28:29], v68, s[8:11], s77 offen sc1
  ds_read_b128 v[0:3], v76 offset:14848
  s_waitcnt lgkmcnt(0)
  ds_read_b64 v[16:17], v77 offset:384
  s_waitcnt lgkmcnt(0)
  ds_read_b128 v[64:67], v76 offset:27648
  s_waitcnt lgkmcnt(0)
  ds_read_b128 v[60:63], v76 offset:26624
  s_waitcnt lgkmcnt(0)
  buffer_load_dwordx4 v[52:55], v76, s[8:11], s60 offen offset:0 sc1
  buffer_load_dwordx4 v[56:59], v76, s[8:11], s60 offen offset:1024 sc1
  s_add_u32 s66, s66, 1
  s_xor_b32 s64, s64, 16384
  s_xor_b32 s65, s65, 16384
  s_add_u32 s58, s58, 655360
  s_add_u32 s59, s59, 655360
  s_add_u32 s70, s70, 655360
  s_add_u32 s68, s68, 655360
  s_mov_b32 m0, 12800
  s_add_u32 s85, s65, 8192
  v_xor_b32 v75, 0x8000, v75
  s_waitcnt lgkmcnt(0)
  s_waitcnt vmcnt(1)
  v_mfma_f32_16x16x32_bf16 v[4:7], v[0:3], v[52:55], 0
  v_bitop3_b32 v72, v52, v54, s72 bitop3:0x7e
  s_waitcnt vmcnt(0)
  v_mfma_f32_16x16x32_bf16 v[4:7], v[0:3], v[56:59], v[4:7]
  v_bitop3_b32 v73, v56, v58, s72 bitop3:0x7e
  v_bitop3_b32 v72, v72, v73, 1 bitop3:0xa8
  v_cmp_ne_u32 vcc, 0, v72
  s_nop 0
  s_cmp_eq_u64 vcc, 0
  s_cselect_b32 s54, s62, 268435456
  s_nop 0
  v_add_f32_dpp v4, v4, v4 row_ror:4 row_mask:0xf bank_mask:0xf
  v_add_f32_dpp v5, v5, v5 row_ror:4 row_mask:0xf bank_mask:0xf
  s_nop 0
  v_add_f32_dpp v4, v4, v4 row_ror:8 row_mask:0xf bank_mask:0xf
  v_add_f32_dpp v5, v5, v5 row_ror:8 row_mask:0xf bank_mask:0xf
  v_cvt_pk_bf16_f32 v4, v4, v5
  buffer_store_dword v4, v69, s[8:11], s54 offen sc1
  s_cbranch_vccnz Cs2_h1r
  s_xor_b32 s62, s62, 16384
  buffer_store_dword v71, v69, s[8:11], s62 offen sc1
  s_xor_b32 s72, s72, 1
  s_branch Cs2_h2
Cs2_h1r:
  s_mov_b64 exec, vcc
  buffer_load_dwordx4 v[52:55], v76, s[8:11], s60 offen offset:0 sc1
  buffer_load_dwordx4 v[56:59], v76, s[8:11], s60 offen offset:1024 sc1
  s_mov_b64 exec, -1
  s_add_u32 s67, s67, 1
  s_waitcnt vmcnt(1)
  v_mfma_f32_16x16x32_bf16 v[4:7], v[0:3], v[52:55], 0
  v_bitop3_b32 v72, v52, v54, s72 bitop3:0x7e
  s_waitcnt vmcnt(0)
  v_mfma_f32_16x16x32_bf16 v[4:7], v[0:3], v[56:59], v[4:7]
  v_bitop3_b32 v73, v56, v58, s72 bitop3:0x7e
  v_bitop3_b32 v72, v72, v73, 1 bitop3:0xa8
  v_cmp_ne_u32 vcc, 0, v72
  s_cbranch_vccz Cs2_h1p
Cs2_h1s:
  s_mov_b64 exec, vcc
  buffer_load_dwordx4 v[52:55], v76, s[8:11], s60 offen offset:0 sc1
  buffer_load_dwordx4 v[56:59], v76, s[8:11], s60 offen offset:1024 sc1
  s_mov_b64 exec, -1
  s_add_u32 s67, s67, 1
  s_waitcnt vmcnt(1)
  v_mfma_f32_16x16x32_bf16 v[4:7], v[0:3], v[52:55], 0
  v_bitop3_b32 v72, v52, v54, s72 bitop3:0x7e
  s_waitcnt vmcnt(0)
  v_mfma_f32_16x16x32_bf16 v[4:7], v[0:3], v[56:59], v[4:7]
  v_bitop3_b32 v73, v56, v58, s72 bitop3:0x7e
  v_bitop3_b32 v72, v72, v73, 1 bitop3:0xa8
  v_cmp_ne_u32 vcc, 0, v72
  s_cbranch_vccz Cs2_h1p
  s_cmp_lt_u32 s67, 131072
  s_cbranch_scc1 Cs2_h1s
Cs2_h1p:
  s_nop 2
  v_add_f32_dpp v4, v4, v4 row_ror:4 row_mask:0xf bank_mask:0xf
  v_add_f32_dpp v5, v5, v5 row_ror:4 row_mask:0xf bank_mask:0xf
  s_nop 0
  v_add_f32_dpp v4, v4, v4 row_ror:8 row_mask:0xf bank_mask:0xf
  v_add_f32_dpp v5, v5, v5 row_ror:8 row_mask:0xf bank_mask:0xf
  v_cvt_pk_bf16_f32 v4, v4, v5
  buffer_store_dword v4, v69, s[8:11], s62 offen sc1
  s_xor_b32 s62, s62, 16384
  buffer_store_dword v71, v69, s[8:11], s62 offen sc1
  s_xor_b32 s72, s72, 1
  s_branch Cs2_h2
Cs2_h2r:
  s_mov_b64 exec, vcc
  buffer_load_dwordx4 v[12:15], v76, s[8:11], s65 offen offset:3072 sc1
  s_mov_b64 exec, -1
  s_add_u32 s67, s67, 1
  s_waitcnt vmcnt(4)
  v_max3_u32 v72, v12, v13, v14
  v_max_u32 v72, v72, v15
  ds_write_b128 v76, v[12:15] offset:7680
  v_cmp_eq_u32 vcc, -1, v72
  s_cbranch_vccz Cs2_h2w
  s_mov_b64 exec, vcc
  buffer_load_dwordx4 v[12:15], v76, s[8:11], s65 offen offset:3072 sc1
  s_mov_b64 exec, -1
  s_add_u32 s67, s67, 1
  s_waitcnt vmcnt(4)
  v_max3_u32 v72, v12, v13, v14
  v_max_u32 v72, v72, v15
  ds_write_b128 v76, v[12:15] offset:7680
  v_cmp_eq_u32 vcc, -1, v72
  s_cbranch_vccz Cs2_h2w
Cs2_h2s:
  s_mov_b64 exec, vcc
  buffer_load_dwordx4 v[12:15], v76, s[8:11], s65 offen offset:3072 sc1
  s_mov_b64 exec, -1
  s_add_u32 s67, s67, 1
  s_waitcnt vmcnt(2)
  v_max3_u32 v72, v12, v13, v14
  v_max_u32 v72, v72, v15
  ds_write_b128 v76, v[12:15] offset:7680
  v_cmp_eq_u32 vcc, -1, v72
  s_cbranch_vccz Cs2_h2w
  s_mov_b64 exec, vcc
  buffer_load_dwordx4 v[12:15], v76, s[8:11], s65 offen offset:3072 sc1
  s_mov_b64 exec, -1
  s_add_u32 s67, s67, 1
  s_waitcnt vmcnt(2)
  v_max3_u32 v72, v12, v13, v14
  v_max_u32 v72, v72, v15
  ds_write_b128 v76, v[12:15] offset:7680
  v_cmp_eq_u32 vcc, -1, v72
  s_cbranch_vccz Cs2_h2w
  s_mov_b64 exec, vcc
  buffer_load_dwordx4 v[12:15], v76, s[8:11], s65 offen offset:3072 sc1
  s_mov_b64 exec, -1
  s_add_u32 s67, s67, 1
  s_waitcnt vmcnt(2)
  v_max3_u32 v72, v12, v13, v14
  v_max_u32 v72, v72, v15
  ds_write_b128 v76, v[12:15] offset:7680
  v_cmp_eq_u32 vcc, -1, v72
  s_cbranch_vccz Cs2_h2w
  s_cmp_lt_u32 s67, 131072
  s_cbranch_scc1 Cs2_h2s
  s_branch Cs2_h2w
Cs2_rec:
  s_nop 7
  s_waitcnt vmcnt(0) lgkmcnt(0)
  v_max3_u32 v72, v0, v1, v2
  v_max3_u32 v72, v72, v3, v4
  v_max3_u32 v72, v72, v5, v6
  v_max3_u32 v72, v72, v7, v8
  v_max3_u32 v72, v72, v9, v10
  v_max3_u32 v72, v72, v11, v12
  v_max3_u32 v72, v72, v13, v14
  v_max3_u32 v72, v72, v15, v16
  v_max3_u32 v72, v72, v17, v18
  v_max_u32 v72, v72, v19
  v_cmp_eq_u32 vcc, -1, v72
  s_cbranch_vccz Cs2_recok
  s_barrier
Cs2_recp:
  buffer_load_dwordx4 v[0:3], v76, s[8:11], s64 offen offset:0 sc1
  buffer_load_dwordx4 v[4:7], v76, s[8:11], s64 offen offset:1024 sc1
  s_add_u32 s67, s67, 1
  s_cmp_lt_u32 s67, 131072
  s_cselect_b32 s54, -2, -1
  s_waitcnt vmcnt(1)
  v_max3_u32 v72, v0, v1, v2
  s_waitcnt vmcnt(0)
  v_max3_u32 v72, v72, v3, v4
  v_max3_u32 v72, v72, v5, v6
  v_max_u32 v72, v72, v7
  v_cmp_lt_u32 vcc, s54, v72
  s_cbranch_vccnz Cs2_recp
  ds_write_b128 v76, v[0:3] offset:8704
  ds_write_b128 v76, v[4:7] offset:9728
  v_mov_b64 v[20:21], 0
  v_mov_b64 v[22:23], 0
  v_mov_b64 v[24:25], 0
  v_mov_b64 v[26:27], 0
  v_mov_b64 v[28:29], 0
  v_mov_b64 v[30:31], 0
  v_mov_b64 v[32:33], 0
  v_mov_b64 v[34:35], 0
  s_waitcnt lgkmcnt(0)
  s_barrier
  ds_read_b128 v[0:3], v76 offset:4608
  s_waitcnt lgkmcnt(0)
  v_smfmac_f32_16x16x64_bf16 v[20:23], v[0:3], v[80:87], v74
  v_smfmac_f32_16x16x64_bf16 v[24:27], v[0:3], v[88:95], v74
  ds_read_b128 v[60:63], v76 offset:24576
  ds_read_b128 v[64:67], v76 offset:25600
  s_waitcnt lgkmcnt(0)
  v_smfmac_f32_16x16x64_bf16 v[28:31], v[0:3], v[60:67], v74
  ds_read_b128 v[60:63], v76 offset:26624
  ds_read_b128 v[64:67], v76 offset:27648
  s_waitcnt lgkmcnt(0)
  v_smfmac_f32_16x16x64_bf16 v[32:35], v[0:3], v[60:67], v74
  ds_read_b128 v[4:7], v76 offset:5632
  s_waitcnt lgkmcnt(0)
  v_smfmac_f32_16x16x64_bf16 v[20:23], v[4:7], v[96:103], v74
  v_smfmac_f32_16x16x64_bf16 v[24:27], v[4:7], v[104:111], v74
  ds_read_b128 v[60:63], v76 offset:40960
  ds_read_b128 v[64:67], v76 offset:41984
  s_waitcnt lgkmcnt(0)
  v_smfmac_f32_16x16x64_bf16 v[28:31], v[4:7], v[60:67], v74
  ds_read_b128 v[60:63], v76 offset:43008
  ds_read_b128 v[64:67], v76 offset:44032
  s_waitcnt lgkmcnt(0)
  v_smfmac_f32_16x16x64_bf16 v[32:35], v[4:7], v[60:67], v74
  ds_read_b128 v[8:11], v76 offset:6656
  s_waitcnt lgkmcnt(0)
  v_smfmac_f32_16x16x64_bf16 v[20:23], v[8:11], v[112:119], v74
  v_smfmac_f32_16x16x64_bf16 v[24:27], v[8:11], v[120:127], v74
  v_smfmac_f32_16x16x64_bf16 v[28:31], v[8:11], v[208:215], v74
  v_smfmac_f32_16x16x64_bf16 v[32:35], v[8:11], v[216:223], v74
  ds_read_b128 v[12:15], v76 offset:7680
  s_waitcnt lgkmcnt(0)
  v_smfmac_f32_16x16x64_bf16 v[20:23], v[12:15], v[128:135], v74
  v_smfmac_f32_16x16x64_bf16 v[24:27], v[12:15], v[136:143], v74
  v_smfmac_f32_16x16x64_bf16 v[28:31], v[12:15], v[224:231], v74
  v_smfmac_f32_16x16x64_bf16 v[32:35], v[12:15], v[232:239], v74
  ds_read_b128 v[12:15], v76 offset:8704
  s_waitcnt lgkmcnt(0)
  v_smfmac_f32_16x16x64_bf16 v[20:23], v[12:15], v[144:151], v74
  v_smfmac_f32_16x16x64_bf16 v[24:27], v[12:15], v[152:159], v74
  ds_read_b128 v[60:63], v76 offset:57344
  ds_read_b128 v[64:67], v76 offset:58368
  s_waitcnt lgkmcnt(0)
  v_smfmac_f32_16x16x64_bf16 v[28:31], v[12:15], v[60:67], v74
  ds_read_b128 v[60:63], v76 offset:59392
  ds_read_b128 v[64:67], v76 offset:60416
  s_waitcnt lgkmcnt(0)
  v_smfmac_f32_16x16x64_bf16 v[32:35], v[12:15], v[60:67], v74
  ds_read_b128 v[0:3], v76 offset:9728
  s_waitcnt lgkmcnt(0)
  v_smfmac_f32_16x16x64_bf16 v[20:23], v[0:3], v[160:167], v74
  v_smfmac_f32_16x16x64_bf16 v[24:27], v[0:3], v[168:175], v74
  ds_read_b128 v[60:63], v75 offset:24576
  ds_read_b128 v[64:67], v75 offset:25600
  s_waitcnt lgkmcnt(0)
  v_smfmac_f32_16x16x64_bf16 v[28:31], v[0:3], v[60:67], v74
  ds_read_b128 v[60:63], v75 offset:26624
  ds_read_b128 v[64:67], v75 offset:27648
  s_waitcnt lgkmcnt(0)
  v_smfmac_f32_16x16x64_bf16 v[32:35], v[0:3], v[60:67], v74
  ds_read_b128 v[16:19], v76 offset:10752
  ds_read_b128 v[60:63], v75 offset:8192
  ds_read_b128 v[64:67], v75 offset:9216
  s_waitcnt lgkmcnt(0)
  v_smfmac_f32_16x16x64_bf16 v[20:23], v[16:19], v[60:67], v74
  ds_read_b128 v[60:63], v75 offset:10240
  ds_read_b128 v[64:67], v75 offset:11264
  s_waitcnt lgkmcnt(0)
  v_smfmac_f32_16x16x64_bf16 v[24:27], v[16:19], v[60:67], v74
  v_smfmac_f32_16x16x64_bf16 v[28:31], v[16:19], v[240:247], v74
  v_smfmac_f32_16x16x64_bf16 v[32:35], v[16:19], v[248:255], v74
  ds_read_b128 v[4:7], v76 offset:11776
  s_waitcnt lgkmcnt(0)
  v_smfmac_f32_16x16x64_bf16 v[20:23], v[4:7], v[176:183], v74
  v_smfmac_f32_16x16x64_bf16 v[24:27], v[4:7], v[184:191], v74
  v_smfmac_f32_16x16x64_bf16 v[28:31], v[4:7], a[0:7], v74
  v_smfmac_f32_16x16x64_bf16 v[32:35], v[4:7], a[8:15], v74
  ds_read_b128 v[8:11], v76 offset:12800
  s_waitcnt lgkmcnt(0)
  v_smfmac_f32_16x16x64_bf16 v[20:23], v[8:11], v[192:199], v74
  v_smfmac_f32_16x16x64_bf16 v[24:27], v[8:11], v[200:207], v74
  v_smfmac_f32_16x16x64_bf16 v[28:31], v[8:11], a[16:23], v74
  v_smfmac_f32_16x16x64_bf16 v[32:35], v[8:11], a[24:31], v74
  v_add_f32 v20, v20, v22
  v_add_f32 v21, v21, v23
  v_add_f32 v24, v24, v26
  v_cvt_pk_bf16_f32 v22, v20, v24
  ds_write_b32 v79, v22 offset:0
  v_add_f32 v25, v25, v27
  v_cvt_pk_bf16_f32 v23, v21, v25
  ds_write_b32 v79, v23 offset:576
  v_add_f32 v28, v28, v30
  v_add_f32 v29, v29, v31
  s_waitcnt lgkmcnt(0)
  s_nop 1
  s_branch Cs2_recok
Cs2_mx:
  s_waitcnt lgkmcnt(0)
  s_barrier
  buffer_load_dwordx4 v[0:3], v76, s[8:11], s58 offen offset:0 sc1
  ds_read_b128 v[20:23], v77 offset:0
  ds_read_b128 v[28:31], v77 offset:256
  buffer_load_dwordx4 v[4:7], v76, s[8:11], s58 offen offset:1024 sc1
  ds_read_b128 v[24:27], v77 offset:128
  ds_read_b128 v[32:35], v77 offset:384
  s_waitcnt vmcnt(1) lgkmcnt(3)
  v_mfma_f32_16x16x32_bf16 v[8:11], v[0:3], v[20:23], 0
  s_waitcnt vmcnt(0) lgkmcnt(1)
  v_mfma_f32_16x16x32_bf16 v[8:11], v[4:7], v[24:27], v[8:11]
  v_mfma_f32_16x16x32_bf16 v[12:15], v[28:31], v[20:23], 0
  s_waitcnt lgkmcnt(0)
  v_mfma_f32_16x16x32_bf16 v[12:15], v[32:35], v[24:27], v[12:15]
  v_add_f32_dpp v8, v10, v8 quad_perm:[2,3,0,1] row_mask:0xf bank_mask:0xf
  v_add_f32_dpp v9, v11, v9 quad_perm:[2,3,0,1] row_mask:0xf bank_mask:0xf
  s_nop 0
  v_mov_b32_dpp v8, v8 quad_perm:[0,1,0,1] row_mask:0xf bank_mask:0xf
  v_mov_b32_dpp v9, v9 quad_perm:[0,1,0,1] row_mask:0xf bank_mask:0xf
  s_nop 1
  v_add_f32_dpp v12, v14, v12 quad_perm:[2,3,0,1] row_mask:0xf bank_mask:0xf
  v_add_f32_dpp v13, v15, v13 quad_perm:[2,3,0,1] row_mask:0xf bank_mask:0xf
  s_nop 0
  v_mov_b32_dpp v12, v12 quad_perm:[0,1,0,1] row_mask:0xf bank_mask:0xf
  v_mov_b32_dpp v13, v13 quad_perm:[0,1,0,1] row_mask:0xf bank_mask:0xf
  v_mul_f32 v12, s69, v12
  ds_write_b32 v78, v8 offset:8712
  v_mul_f32 v13, s69, v13
  ds_write_b32 v78, v9 offset:8776
  s_waitcnt lgkmcnt(0)
  s_barrier
  ds_read_b128 v[36:39], v78 offset:8704
  ds_read_b128 v[40:43], v78 offset:8768
  s_waitcnt lgkmcnt(0)
  s_barrier
  v_max_f32 v16, v36, v37
  v_max3_f32 v16, v16, v38, v39
  v_max3_f32 v16, v16, v40, v41
  v_max3_f32 v16, v16, v42, v43
  v_max3_f32 v16, v16, v12, v13
  v_mov_b32 v17, v16
  s_nop 1
  v_permlane16_swap_b32 v16, v17
  v_max_f32 v16, v16, v17
  v_mov_b32 v17, v16
  s_nop 1
  v_permlane32_swap_b32 v16, v17
  v_max_f32 v16, v16, v17
  v_sub_f32 v36, v36, v16
  v_sub_f32 v37, v37, v16
  v_sub_f32 v38, v38, v16
  v_sub_f32 v39, v39, v16
  v_sub_f32 v40, v40, v16
  v_sub_f32 v41, v41, v16
  v_sub_f32 v42, v42, v16
  v_sub_f32 v43, v43, v16
  v_sub_f32 v12, v12, v16
  v_sub_f32 v13, v13, v16
  v_exp_f32 v36, v36
  v_exp_f32 v37, v37
  v_exp_f32 v38, v38
  v_exp_f32 v39, v39
  v_exp_f32 v40, v40
  v_exp_f32 v41, v41
  v_exp_f32 v42, v42
  v_exp_f32 v43, v43
  v_exp_f32 v12, v12
  v_exp_f32 v13, v13
  v_cvt_pk_bf16_f32 v32, v36, v40
  v_cvt_pk_bf16_f32 v33, v37, v41
  v_cvt_pk_bf16_f32 v34, v38, v42
  v_cvt_pk_bf16_f32 v35, v39, v43
  v_cvt_pk_bf16_f32 v28, v12, v13
  v_cvt_pk_bf16_f32 v31, v12, v13
  v_mov_b32 v29, 0
  v_mov_b32 v30, 0
  v_mov_b32 v68, 0x3f803f80
  v_mov_b32 v69, 0x3f803f80
  v_mov_b32 v70, 0x3f803f80
  v_mov_b32 v71, 0x3f803f80
  s_nop 1
  v_mfma_f32_16x16x32_bf16 v[8:11], v[32:35], v[68:71], 0
  v_mfma_f32_16x16x32_bf16 v[0:3], v[32:35], v[52:55], 0
  v_mfma_f32_16x16x32_bf16 v[4:7], v[32:35], v[56:59], 0
  v_mfma_f32_16x16x16_bf16 v[8:11], v[28:29], v[68:69], v[8:11]
  v_mfma_f32_16x16x16_bf16 v[0:3], v[28:29], v[72:73], v[0:3]
  v_mfma_f32_16x16x16_bf16 v[4:7], v[30:31], v[72:73], v[4:7]
  ds_read_b128 v[68:71], v76 offset:13824
  v_rcp_f32 v10, v8
  v_rcp_f32 v11, v9
  v_mul_f32 v0, v10, v0
  v_mul_f32 v1, v11, v1
  s_nop 0
  v_mul_f32 v4, v10, v4
  v_mul_f32 v5, v11, v5
  v_cvt_pk_bf16_f32 v2, v0, v4
  ds_write_b32 v79, v2 offset:8704
  v_cvt_pk_bf16_f32 v3, v1, v5
  ds_write_b32 v79, v3 offset:9280
  v_mov_b64 v[16:17], 0
  v_mov_b64 v[18:19], 0
  v_mov_b64 v[20:21], 0
  v_mov_b64 v[22:23], 0
  v_mov_b64 v[24:25], 0
  v_mov_b64 v[26:27], 0
  s_branch Cs2_mxok
Cs2_last:
  ds_read_b128 v[4:7], v76 offset:5632
  ds_read_b128 v[8:11], v76 offset:6656
  ds_read_b128 v[44:47], v76 offset:40960
  ds_read_b128 v[48:51], v76 offset:41984
  s_nop 5
  v_mov_b64 v[20:21], 0
  v_mov_b64 v[22:23], 0
  v_mov_b64 v[24:25], 0
  v_mov_b64 v[26:27], 0
  s_waitcnt lgkmcnt(4)
  v_smfmac_f32_16x16x64_bf16 v[28:31], v[0:3], v[36:43], v74
  ds_read_b128 v[36:39], v76 offset:43008
  ds_read_b128 v[40:43], v76 offset:44032
  v_smfmac_f32_16x16x64_bf16 v[32:35], v[0:3], v[60:67], v74
  s_waitcnt lgkmcnt(5)
  v_smfmac_f32_16x16x64_bf16 v[20:23], v[0:3], a[32:39], v74
  ds_read_b128 v[60:63], v76 offset:57344
  ds_read_b128 v[64:67], v76 offset:58368
  v_smfmac_f32_16x16x64_bf16 v[24:27], v[0:3], a[40:47], v74
  s_waitcnt lgkmcnt(4)
  v_smfmac_f32_16x16x64_bf16 v[20:23], v[4:7], a[48:55], v74
  buffer_store_dwordx4 v[16:19], v76, s[8:11], s68 offen sc1
  v_smfmac_f32_16x16x64_bf16 v[24:27], v[4:7], a[56:63], v74
  v_smfmac_f32_16x16x64_bf16 v[28:31], v[4:7], v[44:51], v74
  s_waitcnt lgkmcnt(2)
  v_smfmac_f32_16x16x64_bf16 v[20:23], v[8:11], a[64:71], v74
  ds_read_b128 v[44:47], v76 offset:59392
  ds_read_b128 v[48:51], v76 offset:60416
  v_smfmac_f32_16x16x64_bf16 v[24:27], v[8:11], a[72:79], v74
  v_smfmac_f32_16x16x64_bf16 v[32:35], v[4:7], v[36:43], v74
  v_smfmac_f32_16x16x64_bf16 v[28:31], v[8:11], v[208:215], v74
  ds_read_b128 v[36:39], v75 offset:24576
  ds_read_b128 v[40:43], v75 offset:25600
  v_smfmac_f32_16x16x64_bf16 v[32:35], v[8:11], v[216:223], v74
  v_smfmac_f32_16x16x64_bf16 v[20:23], v[12:15], a[80:87], v74
  v_smfmac_f32_16x16x64_bf16 v[24:27], v[12:15], a[88:95], v74
  v_smfmac_f32_16x16x64_bf16 v[28:31], v[12:15], v[224:231], v74
  v_smfmac_f32_16x16x64_bf16 v[32:35], v[12:15], v[232:239], v74
  s_waitcnt vmcnt(2)
  s_waitcnt vmcnt(1)
  s_barrier
Cs2_lastr:
  ds_read_b128 v[12:15], v76 offset:8704
  ds_read_b128 v[0:3], v76 offset:9728
  ds_read_b128 v[16:19], v76 offset:10752
  ds_read_b128 v[4:7], v76 offset:11776
  ds_read_b128 v[8:11], v76 offset:12800
  s_waitcnt lgkmcnt(3)
  v_max3_u32 v72, v0, v1, v2
  s_waitcnt lgkmcnt(1)
  v_max3_u32 v72, v72, v3, v4
  v_max3_u32 v72, v72, v5, v6
  s_waitcnt lgkmcnt(0)
  v_max3_u32 v72, v72, v7, v8
  v_max3_u32 v72, v72, v9, v10
  v_max3_u32 v72, v72, v11, v12
  v_max3_u32 v72, v72, v13, v14
  v_max3_u32 v72, v72, v15, v16
  v_max3_u32 v72, v72, v17, v18
  v_max_u32 v72, v72, v19
  v_cmp_eq_u32 vcc, -1, v72
  s_cbranch_vccnz Cs2_lastp
Cs2_lastg:
  v_smfmac_f32_16x16x64_bf16 v[28:31], v[12:15], v[60:67], v74
  ds_read_b128 v[60:63], v75 offset:26624
  ds_read_b128 v[64:67], v75 offset:27648
  v_smfmac_f32_16x16x64_bf16 v[32:35], v[12:15], v[44:51], v74
  v_smfmac_f32_16x16x64_bf16 v[28:31], v[0:3], v[36:43], v74
  v_smfmac_f32_16x16x64_bf16 v[28:31], v[16:19], v[240:247], v74
  v_smfmac_f32_16x16x64_bf16 v[28:31], v[4:7], a[0:7], v74
  v_smfmac_f32_16x16x64_bf16 v[28:31], v[8:11], a[16:23], v74
  v_smfmac_f32_16x16x64_bf16 v[32:35], v[16:19], v[248:255], v74
  v_smfmac_f32_16x16x64_bf16 v[32:35], v[4:7], a[8:15], v74
  s_waitcnt lgkmcnt(0)
  v_smfmac_f32_16x16x64_bf16 v[32:35], v[8:11], a[24:31], v74
  v_smfmac_f32_16x16x64_bf16 v[32:35], v[0:3], v[60:67], v74
  v_smfmac_f32_16x16x64_bf16 v[20:23], v[12:15], a[96:103], v74
  v_smfmac_f32_16x16x64_bf16 v[20:23], v[0:3], a[112:119], v74
  v_add_f32 v28, v28, v30
  v_add_f32 v32, v32, v34
  v_cvt_pk_bf16_f32 v30, v28, v32
  v_smfmac_f32_16x16x64_bf16 v[20:23], v[16:19], a[128:135], v74
  ds_write_b32 v79, v30 offset:256
  v_add_f32 v29, v29, v31
  v_add_f32 v33, v33, v35
  v_cvt_pk_bf16_f32 v31, v29, v33
  v_smfmac_f32_16x16x64_bf16 v[20:23], v[4:7], a[144:151], v74
  ds_write_b32 v79, v31 offset:832
  v_smfmac_f32_16x16x64_bf16 v[20:23], v[8:11], a[160:167], v74
  v_smfmac_f32_16x16x64_bf16 v[24:27], v[12:15], a[104:111], v74
  v_smfmac_f32_16x16x64_bf16 v[24:27], v[0:3], a[120:127], v74
  v_smfmac_f32_16x16x64_bf16 v[24:27], v[16:19], a[136:143], v74
  s_waitcnt lgkmcnt(0)
  s_barrier
  ds_read_b64 v[52:53], v77 offset:384
  v_add_f32 v20, v20, v22
  v_smfmac_f32_16x16x64_bf16 v[24:27], v[4:7], a[152:159], v74
  v_add_f32 v21, v21, v23
  v_smfmac_f32_16x16x64_bf16 v[24:27], v[8:11], a[168:175], v74
  v_cvt_pk_bf16_f32 v54, v20, v21
  s_add_u32 s68, s68, 655360
  s_nop 3
  v_add_f32 v24, v24, v26
  v_add_f32 v25, v25, v27
  v_cvt_pk_bf16_f32 v55, v24, v25
  s_waitcnt lgkmcnt(0)
  buffer_store_dwordx4 v[52:55], v76, s[8:11], s68 offen sc1
  s_branch Cs2_done
Cs2_lastp:
  s_add_u32 s72, s72, 2
  s_cmp_ge_u32 s72, 131072
  s_cbranch_scc1 Cs2_lastg
  s_barrier
  buffer_load_dwordx4 v76, s[8:11], s85 offen offset:0 sc1 lds
  s_waitcnt vmcnt(0)
  s_barrier
  s_branch Cs2_lastr
Cs2_done:
  s_branch L_cexit
L_w7:
  v_mov_b64 v[20:21], 0
  v_mov_b64 v[22:23], 0
  v_mov_b64 v[24:25], 0
  v_mov_b64 v[26:27], 0
  v_mov_b64 v[28:29], 0
  v_mov_b64 v[30:31], 0
  v_mov_b64 v[32:33], 0
  v_mov_b64 v[34:35], 0
  s_mov_b32 s78, 0x3f803f80
  s_mov_b32 s79, s78
  s_mov_b32 s65, 360448
  s_mov_b32 m0, 15872
  s_lshl_b32 s71, s53, 2
  s_add_u32 s71, s71, 128
  s_movk_i32 s56, 0x1000
  v_lshlrev_b32 v73, 2, v76
  v_mov_b32 v72, 0
  s_mov_b64 s[16:17], s[8:9]
  s_mov_b32 s18, 268435456
  s_mov_b32 s19, 0x20000
  s_getpc_b64 s[20:21]
Cs3_pc:
  s_add_u32 s20, s20, (Cs3_last - Cs3_pc)
  s_addc_u32 s21, s21, 0
  v_mov_b32 v68, 14880
  buffer_load_dwordx4 v[52:55], v76, s[8:11], s59 offen offset:0 sc1
  buffer_load_dwordx4 v[56:59], v76, s[8:11], s59 offen offset:1024 sc1
  ds_read_b128 v[36:39], v76 offset:45056
  ds_read_b128 v[40:43], v76 offset:46080
  ds_read_b128 v[60:63], v76 offset:47104
  ds_read_b128 v[64:67], v76 offset:48128
  ds_read_b128 v[0:3], v76 offset:4608
  ds_read_b128 v[4:7], v76 offset:5632
  ds_read_b128 v[8:11], v76 offset:6656
  ds_read_b128 v[12:15], v76 offset:7680
  s_waitcnt lgkmcnt(0)
  s_cmp_eq_u32 s66, 1
  s_branch Cs3_top2
.p2align 6
Cs3_h2:
  v_lshlrev_b32 v73, 2, v76
  buffer_load_dwordx4 v[4:7], v76, s[8:11], s65 offen offset:1024 sc1
  ds_read_b128 v[36:39], v76 offset:45056
  ds_read_b128 v[40:43], v76 offset:46080
  buffer_load_dwordx4 v[52:55], v76, s[8:11], s59 offen offset:0 sc1
  buffer_load_dwordx4 v[56:59], v76, s[8:11], s59 offen offset:1024 sc1
  s_waitcnt vmcnt(7)
  v_max3_u32 v72, v4, v5, v6
  v_max_u32 v72, v72, v7
  ds_write_b128 v76, v[4:7] offset:5632
  v_cmp_eq_u32 vcc, -1, v72
  s_cbranch_vccnz Cs3_h2r
Cs3_h2w:
  buffer_load_dwordx4 v76, s[8:11], s85 offen offset:0 sc1 lds
  buffer_load_dwordx4 v76, s[8:11], s85 offen offset:1024 sc1 lds
  s_cmp_eq_u32 s66, 63
  s_waitcnt lgkmcnt(0)
  s_barrier
  ds_read_b128 v[8:11], v76 offset:6656
Cs3_top2:
  v_smfmac_f32_16x16x64_bf16 v[20:23], v[4:7], v[96:103], v74
  s_cbranch_scc1 Cs3_last
  v_smfmac_f32_16x16x64_bf16 v[28:31], v[4:7], v[36:43], v74
  buffer_load_dwordx4 v[44:47], v76, s[8:11], s58 offen offset:0 sc1
  s_mov_b32 m0, 15872
  v_smfmac_f32_16x16x64_bf16 v[24:27], v[4:7], v[104:111], v74
  buffer_load_dwordx4 v[48:51], v76, s[8:11], s58 offen offset:1024 sc1
  v_smfmac_f32_16x16x64_bf16 v[32:35], v[4:7], v[60:67], v74
  ds_read_b128 v[0:3], v76 offset:4608
  s_waitcnt lgkmcnt(1)
  v_smfmac_f32_16x16x64_bf16 v[20:23], v[8:11], v[112:119], v74
  ds_read_b128 v[12:15], v76 offset:7680
  v_smfmac_f32_16x16x64_bf16 v[24:27], v[8:11], v[120:127], v74
  ds_read_b128 v[36:39], v76 offset:28672
  v_smfmac_f32_16x16x64_bf16 v[28:31], v[8:11], v[208:215], v74
  buffer_store_dwordx4 v[16:19], v76, s[8:11], s68 offen sc1
  ds_read_b128 v[40:43], v76 offset:29696
  v_smfmac_f32_16x16x64_bf16 v[32:35], v[8:11], v[216:223], v74
  ds_read_b128 v[60:63], v76 offset:30720
  s_waitcnt lgkmcnt(4)
  v_smfmac_f32_16x16x64_bf16 v[20:23], v[0:3], v[80:87], v74
  ds_read_b128 v[64:67], v76 offset:31744
  v_smfmac_f32_16x16x64_bf16 v[24:27], v[0:3], v[88:95], v74
  buffer_load_dword v73, s[16:19], s70 offen lds
  s_waitcnt vmcnt(4)
  s_waitcnt lgkmcnt(4)
  v_smfmac_f32_16x16x64_bf16 v[20:23], v[12:15], v[128:135], v74
  s_barrier
  s_waitcnt lgkmcnt(2)
  v_smfmac_f32_16x16x64_bf16 v[28:31], v[0:3], v[36:43], v74
  ds_read_b128 v[4:7], v76 offset:8704
  v_smfmac_f32_16x16x64_bf16 v[24:27], v[12:15], v[136:143], v74
  ds_read_b128 v[36:39], v76 offset:61440
  s_waitcnt lgkmcnt(2)
  v_smfmac_f32_16x16x64_bf16 v[32:35], v[0:3], v[60:67], v74
  ds_read_b128 v[40:43], v76 offset:62464
  v_smfmac_f32_16x16x64_bf16 v[28:31], v[12:15], v[224:231], v74
  ds_read_b128 v[60:63], v76 offset:63488
  v_smfmac_f32_16x16x64_bf16 v[32:35], v[12:15], v[232:239], v74
  ds_read_b128 v[64:67], v76 offset:64512
  s_waitcnt lgkmcnt(4)
  v_smfmac_f32_16x16x64_bf16 v[20:23], v[4:7], v[144:151], v74
  ds_read_b128 v[8:11], v76 offset:9728
  s_waitcnt lgkmcnt(3)
  v_smfmac_f32_16x16x64_bf16 v[28:31], v[4:7], v[36:43], v74
  s_barrier
  ds_read_b128 v[0:3], v76 offset:11776
  v_smfmac_f32_16x16x64_bf16 v[24:27], v[4:7], v[152:159], v74
  ds_read_b128 v[36:39], v75 offset:12288
  ds_read_b128 v[40:43], v75 offset:13312
  s_waitcnt lgkmcnt(4)
  v_smfmac_f32_16x16x64_bf16 v[32:35], v[4:7], v[60:67], v74
  ds_read_b128 v[16:19], v76 offset:10752
  s_waitcnt lgkmcnt(4)
  v_smfmac_f32_16x16x64_bf16 v[20:23], v[8:11], v[160:167], v74
  ds_read_b128 v[12:15], v76 offset:12800
  v_smfmac_f32_16x16x64_bf16 v[24:27], v[8:11], v[168:175], v74
  ds_read_b128 v[60:63], v75 offset:14336
  ds_read_b128 v[64:67], v75 offset:15360
  s_waitcnt lgkmcnt(6)
  v_smfmac_f32_16x16x64_bf16 v[20:23], v[0:3], v[176:183], v74
  s_waitcnt lgkmcnt(3)
  v_smfmac_f32_16x16x64_bf16 v[20:23], v[16:19], v[36:43], v74
  ds_read_b128 v[36:39], v75 offset:28672
  s_waitcnt lgkmcnt(3)
  v_smfmac_f32_16x16x64_bf16 v[20:23], v[12:15], v[192:199], v74
  ds_read_b128 v[40:43], v75 offset:29696
  s_waitcnt lgkmcnt(2)
  v_smfmac_f32_16x16x64_bf16 v[24:27], v[16:19], v[60:67], v74
  ds_read_b128 v[60:63], v75 offset:30720
  v_smfmac_f32_16x16x64_bf16 v[24:27], v[0:3], v[184:191], v74
  ds_read_b128 v[64:67], v75 offset:31744
  v_add_f32 v20, v20, v22
  v_smfmac_f32_16x16x64_bf16 v[24:27], v[12:15], v[200:207], v74
  v_add_f32 v21, v21, v23
  v_smfmac_f32_16x16x64_bf16 v[28:31], v[16:19], v[240:247], v74
  s_waitcnt lgkmcnt(2)
  v_mov_b64 v[70:71], s[78:79]
  v_smfmac_f32_16x16x64_bf16 v[28:31], v[8:11], v[36:43], v74
  ds_read_b128 v[36:39], v68
  v_add_f32 v24, v24, v26
  v_smfmac_f32_16x16x64_bf16 v[28:31], v[0:3], a[0:7], v74
  ds_read_b128 v[40:43], v68
  v_cvt_pk_bf16_f32 v22, v20, v24
  v_smfmac_f32_16x16x64_bf16 v[28:31], v[12:15], a[16:23], v74
  ds_write_b32 v79, v22 offset:0
  s_waitcnt lgkmcnt(3)
  v_add_f32 v25, v25, v27
  v_cvt_pk_bf16_f32 v23, v21, v25
  v_smfmac_f32_16x16x64_bf16 v[32:35], v[8:11], v[60:67], v74
  ds_write_b32 v79, v23 offset:576
  v_cmp_u_f32 vcc, v20, v21
  v_smfmac_f32_16x16x64_bf16 v[32:35], v[16:19], v[248:255], v74
  v_add_f32 v28, v28, v30
  v_smfmac_f32_16x16x64_bf16 v[32:35], v[0:3], a[8:15], v74
  v_add_f32 v29, v29, v31
  v_smfmac_f32_16x16x64_bf16 v[32:35], v[12:15], a[24:31], v74
  s_cbranch_vccnz Cs3_rec
Cs3_recok:
  s_waitcnt lgkmcnt(3)
  v_smfmac_f32_16x16x64_bf16 v[36:39], v[16:19], a[128:135], v74
  s_waitcnt lgkmcnt(0)
  s_barrier
  ds_read_b128 v[60:63], v77
  v_smfmac_f32_16x16x64_bf16 v[40:43], v[16:19], a[136:143], v74
  ds_read_b128 v[64:67], v77 offset:128
  v_add_f32 v32, v32, v34
  v_cvt_pk_bf16_f32 v30, v28, v32
  v_smfmac_f32_16x16x64_bf16 v[36:39], v[0:3], a[144:151], v74
  ds_write_b32 v79, v30 offset:256
  v_add_f32 v33, v33, v35
  v_cvt_pk_bf16_f32 v31, v29, v33
  v_smfmac_f32_16x16x64_bf16 v[40:43], v[0:3], a[152:159], v74
  ds_write_b32 v79, v31 offset:832
  v_xor_b32 v75, 0x8000, v75
  v_smfmac_f32_16x16x64_bf16 v[36:39], v[4:7], a[96:103], v74
  ds_read_b128 v[0:3], v76 offset:4608
  v_mov_b32 v29, 0
  v_smfmac_f32_16x16x64_bf16 v[40:43], v[4:7], a[104:111], v74
  s_waitcnt vmcnt(2) lgkmcnt(3)
  v_mov_b32 v30, 0
  v_mfma_f32_16x16x32_bf16 v[44:47], v[44:47], v[60:63], 0
  ds_read_b128 v[4:7], v76 offset:5632
  s_waitcnt lgkmcnt(2)
  v_mfma_f32_16x16x32_bf16 v[44:47], v[48:51], v[64:67], v[44:47]
  s_barrier
  v_smfmac_f32_16x16x64_bf16 v[36:39], v[8:11], a[112:119], v74
  ds_read_b128 v[20:23], v77 offset:256
  ds_read_b128 v[24:27], v77 offset:384
  v_smfmac_f32_16x16x64_bf16 v[40:43], v[8:11], a[120:127], v74
  ds_read_b128 v[8:11], v76 offset:6656
  v_add_f32_dpp v72, v46, v44 quad_perm:[2,3,0,1] row_mask:0xf bank_mask:0xf
  v_add_f32_dpp v73, v47, v45 quad_perm:[2,3,0,1] row_mask:0xf bank_mask:0xf
  v_smfmac_f32_16x16x64_bf16 v[36:39], v[12:15], a[160:167], v74
  s_waitcnt lgkmcnt(4)
  v_exp_f32_dpp v72, v72 quad_perm:[0,1,0,1] row_mask:0xf bank_mask:0xf
  v_smfmac_f32_16x16x64_bf16 v[40:43], v[12:15], a[168:175], v74
  ds_read_b128 v[12:15], v76 offset:7680
  v_exp_f32_dpp v73, v73 quad_perm:[0,1,0,1] row_mask:0xf bank_mask:0xf
  v_smfmac_f32_16x16x64_bf16 v[36:39], v[0:3], a[32:39], v74
  s_waitcnt lgkmcnt(2)
  v_cvt_pk_bf16_f32 v72, v72, v73
  v_mfma_f32_16x16x32_bf16 v[20:23], v[20:23], v[60:63], 0
  ds_write_b32 v78, v72 offset:524
  v_mov_b64 v[16:17], 0
  v_mfma_f32_16x16x32_bf16 v[20:23], v[24:27], v[64:67], v[20:23]
  ds_read_b128 v[44:47], v75 offset:28672
  v_mov_b64 v[18:19], 0
  v_smfmac_f32_16x16x64_bf16 v[40:43], v[0:3], a[40:47], v74
  ds_read_b128 v[48:51], v75 offset:29696
  v_mov_b64 v[68:69], s[78:79]
  v_smfmac_f32_16x16x64_bf16 v[36:39], v[4:7], a[48:55], v74
  s_waitcnt lgkmcnt(4)
  v_add_f32_dpp v24, v22, v20 quad_perm:[2,3,0,1] row_mask:0xf bank_mask:0xf
  v_add_f32_dpp v25, v23, v21 quad_perm:[2,3,0,1] row_mask:0xf bank_mask:0xf
  v_smfmac_f32_16x16x64_bf16 v[36:39], v[8:11], a[64:71], v74
  s_waitcnt lgkmcnt(2)
  s_barrier
  ds_read_b128 v[32:35], v78 offset:512
  v_smfmac_f32_16x16x64_bf16 v[36:39], v[12:15], a[80:87], v74
  ds_read_b128 v[60:63], v75 offset:30720
  v_mul_f32 v24, s69, v24
  v_smfmac_f32_16x16x64_bf16 v[40:43], v[4:7], a[56:63], v74
  ds_read_b128 v[64:67], v75 offset:31744
  v_mul_f32 v25, s69, v25
  v_smfmac_f32_16x16x64_bf16 v[40:43], v[8:11], a[72:79], v74
  v_exp_f32_dpp v24, v24 quad_perm:[0,1,0,1] row_mask:0xf bank_mask:0xf
  v_smfmac_f32_16x16x64_bf16 v[40:43], v[12:15], a[88:95], v74
  s_waitcnt lgkmcnt(2)
  v_exp_f32_dpp v25, v25 quad_perm:[0,1,0,1] row_mask:0xf bank_mask:0xf
  v_mfma_f32_16x16x32_bf16 v[8:11], v[32:35], v[68:71], 0
  v_add_f32 v36, v36, v38
  v_add_f32 v37, v37, v39
  v_mfma_f32_16x16x32_bf16 v[0:3], v[32:35], v[52:55], 0
  v_add_f32 v40, v40, v42
  v_add_f32 v41, v41, v43
  v_mfma_f32_16x16x32_bf16 v[4:7], v[32:35], v[56:59], 0
  v_cvt_pk_bf16_f32 v28, v24, v25
  v_cvt_pk_bf16_f32 v72, v36, v37
  v_cvt_pk_bf16_f32 v73, v40, v41
  v_mfma_f32_16x16x16_bf16 v[8:11], v[28:29], v[68:69], v[8:11]
  v_cvt_pk_bf16_f32 v31, v24, v25
  v_mov_b64 v[20:21], 0
  v_mfma_f32_16x16x16_bf16 v[0:3], v[28:29], v[72:73], v[0:3]
  ds_read_b128 v[68:71], v76 offset:13824
  v_mov_b64 v[22:23], 0
  v_mfma_f32_16x16x16_bf16 v[4:7], v[30:31], v[72:73], v[4:7]
  v_rcp_f32 v10, v8
  v_rcp_f32 v11, v9
  v_mul_f32 v0, v10, v0
  v_mul_f32 v1, v11, v1
  s_nop 0
  v_mul_f32 v4, v10, v4
  v_mul_f32 v5, v11, v5
  v_cvt_pk_bf16_f32 v2, v0, v4
  ds_write_b32 v79, v2 offset:8704
  v_cvt_pk_bf16_f32 v3, v1, v5
  ds_write_b32 v79, v3 offset:9280
  v_max3_f32 v8, v8, v9, v10
  v_max_f32 v8, v8, v11
  v_cmp_le_f32 vcc, 1317011456, v8
  v_mov_b64 v[24:25], 0
  v_mov_b64 v[26:27], 0
  s_cbranch_vccnz Cs3_mx
Cs3_mxok:
  s_waitcnt lgkmcnt(0)
  s_barrier
  ds_read_b128 v[0:3], v78 offset:8704
  ds_read_b128 v[4:7], v78 offset:8768
  ds_read_b128 v[8:11], v78 offset:8832
  ds_read_b128 v[12:15], v78 offset:8896
  s_waitcnt lgkmcnt(3)
  v_smfmac_f32_16x16x64_bf16 v[16:19], v[0:3], v[44:51], v74
  ds_read_b128 v[52:55], v75 offset:45056
  s_waitcnt lgkmcnt(3)
  v_smfmac_f32_16x16x64_bf16 v[16:19], v[4:7], v[60:67], v74
  ds_read_b128 v[56:59], v75 offset:46080
  s_waitcnt lgkmcnt(3)
  v_smfmac_f32_16x16x64_bf16 v[16:19], v[8:11], a[176:183], v74
  ds_read_b128 v[36:39], v75 offset:47104
  s_waitcnt lgkmcnt(3)
  v_smfmac_f32_16x16x64_bf16 v[16:19], v[12:15], a[184:191], v74
  ds_read_b128 v[40:43], v75 offset:48128
  ds_read_b128 v[44:47], v75 offset:61440
  v_smfmac_f32_16x16x64_bf16 v[20:23], v[0:3], a[192:199], v74
  ds_read_b128 v[48:51], v75 offset:62464
  ds_read_b128 v[60:63], v75 offset:63488
  v_smfmac_f32_16x16x64_bf16 v[20:23], v[4:7], a[200:207], v74
  ds_read_b128 v[64:67], v75 offset:64512
  s_waitcnt lgkmcnt(6)
  v_cvt_pk_bf16_f32 v16, v16, v17
  v_cvt_pk_bf16_f32 v17, v18, v19
  v_bfi_b32 v16, 1, s72, v16
  v_smfmac_f32_16x16x64_bf16 v[20:23], v[8:11], v[52:59], v74
  buffer_store_dwordx2 v[16:17], v68, s[8:11], s73 offen sc1
  s_waitcnt lgkmcnt(4)
  v_smfmac_f32_16x16x64_bf16 v[20:23], v[12:15], v[36:43], v74
  ds_read_b128 v[52:55], v75 offset:8192
  v_mov_b64 v[32:33], 0
  v_smfmac_f32_16x16x64_bf16 v[24:27], v[0:3], a[208:215], v74
  ds_read_b128 v[56:59], v75 offset:9216
  v_mov_b64 v[34:35], 0
  v_smfmac_f32_16x16x64_bf16 v[24:27], v[4:7], a[216:223], v74
  ds_read_b128 v[36:39], v75 offset:10240
  s_waitcnt lgkmcnt(5)
  v_cvt_pk_bf16_f32 v20, v20, v21
  v_cvt_pk_bf16_f32 v21, v22, v23
  v_bfi_b32 v20, 1, s72, v20
  v_smfmac_f32_16x16x64_bf16 v[24:27], v[8:11], v[44:51], v74
  buffer_store_dwordx2 v[20:21], v68, s[8:11], s74 offen sc1
  s_waitcnt lgkmcnt(3)
  v_smfmac_f32_16x16x64_bf16 v[24:27], v[12:15], v[60:67], v74
  ds_read_b128 v[40:43], v75 offset:11264
  v_mov_b64 v[28:29], 0
  v_smfmac_f32_16x16x64_bf16 v[32:35], v[0:3], a[224:231], v74
  ds_read_b128 v[44:47], v75 offset:12288
  ds_read_b128 v[48:51], v75 offset:13312
  v_smfmac_f32_16x16x64_bf16 v[32:35], v[4:7], a[232:239], v74
  ds_read_b128 v[60:63], v75 offset:14336
  v_cvt_pk_bf16_f32 v24, v24, v25
  v_cvt_pk_bf16_f32 v25, v26, v27
  v_bfi_b32 v24, 1, s72, v24
  v_smfmac_f32_16x16x64_bf16 v[32:35], v[8:11], a[240:247], v74
  buffer_store_dwordx2 v[24:25], v68, s[8:11], s75 offen sc1
  v_mov_b64 v[30:31], 0
  v_smfmac_f32_16x16x64_bf16 v[32:35], v[12:15], a[248:255], v74
  ds_read_b128 v[64:67], v75 offset:15360
  s_waitcnt lgkmcnt(6)
  v_smfmac_f32_16x16x64_bf16 v[28:31], v[0:3], v[52:59], v74
  s_waitcnt lgkmcnt(4)
  v_smfmac_f32_16x16x64_bf16 v[28:31], v[4:7], v[36:43], v74
  s_waitcnt lgkmcnt(2)
  v_cvt_pk_bf16_f32 v32, v32, v33
  v_cvt_pk_bf16_f32 v33, v34, v35
  v_bfi_b32 v32, 1, s72, v32
  v_smfmac_f32_16x16x64_bf16 v[28:31], v[8:11], v[44:51], v74
  buffer_store_dwordx2 v[32:33], v68, s[8:11], s76 offen sc1
  s_waitcnt lgkmcnt(0)
  v_smfmac_f32_16x16x64_bf16 v[28:31], v[12:15], v[60:67], v74
  v_mov_b64 v[18:19], v[72:73]
  s_nop 4
  v_cvt_pk_bf16_f32 v28, v28, v29
  v_cvt_pk_bf16_f32 v29, v30, v31
  v_bfi_b32 v28, 1, s72, v28
  buffer_store_dwordx2 v[28:29], v68, s[8:11], s77 offen sc1
  ds_read_b128 v[52:55], v76 offset:14848
  s_waitcnt lgkmcnt(0)
  ds_read_b64 v[16:17], v77 offset:392
  s_waitcnt lgkmcnt(0)
  ds_read_b128 v[60:63], v76 offset:47104
  s_waitcnt lgkmcnt(0)
  ds_read_b128 v[64:67], v76 offset:48128
  s_waitcnt lgkmcnt(0)
  s_add_u32 s66, s66, 1
  s_xor_b32 s64, s64, 16384
  s_xor_b32 s65, s65, 16384
  s_add_u32 s58, s58, 655360
  s_add_u32 s59, s59, 655360
  s_add_u32 s70, s70, 655360
  s_add_u32 s68, s68, 655360
  s_mov_b32 m0, 8704
  s_add_u32 s85, s65, 4096
  v_xor_b32 v75, 0x8000, v75
  buffer_load_dwordx4 v[0:3], v76, s[8:11], s60 offen offset:0 sc1
  buffer_load_dwordx4 v[4:7], v76, s[8:11], s60 offen offset:1024 sc1
  buffer_load_dwordx4 v[8:11], v76, s[8:11], s61 offen offset:0 sc1
  buffer_load_dwordx4 v[12:15], v76, s[8:11], s61 offen offset:1024 sc1
  v_mov_b64 v[20:21], 0
  v_mov_b64 v[22:23], 0
  v_mov_b64 v[24:25], 0
  v_mov_b64 v[26:27], 0
  v_mov_b32 v68, 14880
  v_mov_b64 v[28:29], 0
  v_mov_b64 v[30:31], 0
  v_mov_b64 v[32:33], 0
  v_mov_b64 v[34:35], 0
  s_cmp_eq_u32 s66, 62
  s_cselect_b64 s[16:17], s[20:21], s[16:17]
  s_cselect_b32 s18, (Cs3_done - Cs3_last), s18
  s_cselect_b32 s70, 0, s70
  s_cmp_eq_u32 s66, 63
  s_cselect_b32 s59, 268435456, s59
  s_cselect_b32 s58, 268435456, s58
  s_waitcnt lgkmcnt(0)
  s_waitcnt vmcnt(3)
  v_mfma_f32_16x16x32_bf16 v[56:59], v[52:55], v[0:3], 0
  v_bitop3_b32 v72, v0, v2, s72 bitop3:0x7e
  s_waitcnt vmcnt(2)
  v_mfma_f32_16x16x32_bf16 v[56:59], v[52:55], v[4:7], v[56:59]
  v_bitop3_b32 v73, v4, v6, s72 bitop3:0x7e
  v_or_b32 v72, v72, v73
  s_waitcnt vmcnt(1)
  v_mfma_f32_16x16x32_bf16 v[36:39], v[52:55], v[8:11], 0
  v_bitop3_b32 v73, v8, v10, s72 bitop3:0x7e
  v_or_b32 v72, v72, v73
  s_waitcnt vmcnt(0)
  v_mfma_f32_16x16x32_bf16 v[36:39], v[52:55], v[12:15], v[36:39]
  v_bitop3_b32 v73, v12, v14, s72 bitop3:0x7e
  v_bitop3_b32 v72, v72, v73, 1 bitop3:0xa8
  v_cmp_ne_u32 vcc, 0, v72
  s_cbranch_vccnz Cs3_h1r
  buffer_load_dwordx4 v[4:7], v76, s[8:11], s65 offen offset:1024 sc1
  v_add_f32_dpp v56, v56, v56 row_ror:4 row_mask:0xf bank_mask:0xf
  v_add_f32_dpp v57, v57, v57 row_ror:4 row_mask:0xf bank_mask:0xf
  v_add_f32_dpp v36, v36, v36 row_ror:4 row_mask:0xf bank_mask:0xf
  v_add_f32_dpp v37, v37, v37 row_ror:4 row_mask:0xf bank_mask:0xf
  v_add_f32_dpp v56, v56, v56 row_ror:8 row_mask:0xf bank_mask:0xf
  v_add_f32_dpp v57, v57, v57 row_ror:8 row_mask:0xf bank_mask:0xf
  v_add_f32_dpp v36, v36, v36 row_ror:8 row_mask:0xf bank_mask:0xf
  v_add_f32_dpp v37, v37, v37 row_ror:8 row_mask:0xf bank_mask:0xf
  v_cvt_pk_bf16_f32 v56, v56, v57
  buffer_store_dword v56, v69, s[8:11], s62 offen sc1
  v_cvt_pk_bf16_f32 v36, v36, v37
  buffer_store_dword v36, v70, s[8:11], s63 offen sc1
  s_xor_b32 s62, s62, 16384
  buffer_store_dword v71, v69, s[8:11], s62 offen sc1
  s_xor_b32 s63, s63, 16384
  buffer_store_dword v71, v70, s[8:11], s63 offen sc1
  s_xor_b32 s72, s72, 1
  s_branch Cs3_h2
Cs3_h1r:
  s_mov_b64 exec, vcc
  buffer_load_dwordx4 v[0:3], v76, s[8:11], s60 offen offset:0 sc1
  buffer_load_dwordx4 v[4:7], v76, s[8:11], s60 offen offset:1024 sc1
  buffer_load_dwordx4 v[8:11], v76, s[8:11], s61 offen offset:0 sc1
  buffer_load_dwordx4 v[12:15], v76, s[8:11], s61 offen offset:1024 sc1
  s_mov_b64 exec, -1
  s_add_u32 s67, s67, 1
  s_waitcnt vmcnt(3)
  v_mfma_f32_16x16x32_bf16 v[56:59], v[52:55], v[0:3], 0
  v_bitop3_b32 v72, v0, v2, s72 bitop3:0x7e
  s_waitcnt vmcnt(2)
  v_mfma_f32_16x16x32_bf16 v[56:59], v[52:55], v[4:7], v[56:59]
  v_bitop3_b32 v73, v4, v6, s72 bitop3:0x7e
  v_or_b32 v72, v72, v73
  s_waitcnt vmcnt(1)
  v_mfma_f32_16x16x32_bf16 v[36:39], v[52:55], v[8:11], 0
  v_bitop3_b32 v73, v8, v10, s72 bitop3:0x7e
  v_or_b32 v72, v72, v73
  s_waitcnt vmcnt(0)
  v_mfma_f32_16x16x32_bf16 v[36:39], v[52:55], v[12:15], v[36:39]
  v_bitop3_b32 v73, v12, v14, s72 bitop3:0x7e
  v_bitop3_b32 v72, v72, v73, 1 bitop3:0xa8
  v_cmp_ne_u32 vcc, 0, v72
  s_cbranch_vccz Cs3_h1p
Cs3_h1s:
  s_mov_b64 exec, vcc
  buffer_load_dwordx4 v[0:3], v76, s[8:11], s60 offen offset:0 sc1
  buffer_load_dwordx4 v[4:7], v76, s[8:11], s60 offen offset:1024 sc1
  buffer_load_dwordx4 v[8:11], v76, s[8:11], s61 offen offset:0 sc1
  buffer_load_dwordx4 v[12:15], v76, s[8:11], s61 offen offset:1024 sc1
  s_mov_b64 exec, -1
  s_add_u32 s67, s67, 1
  s_waitcnt vmcnt(3)
  v_mfma_f32_16x16x32_bf16 v[56:59], v[52:55], v[0:3], 0
  v_bitop3_b32 v72, v0, v2, s72 bitop3:0x7e
  s_waitcnt vmcnt(2)
  v_mfma_f32_16x16x32_bf16 v[56:59], v[52:55], v[4:7], v[56:59]
  v_bitop3_b32 v73, v4, v6, s72 bitop3:0x7e
  v_or_b32 v72, v72, v73
  s_waitcnt vmcnt(1)
  v_mfma_f32_16x16x32_bf16 v[36:39], v[52:55], v[8:11], 0
  v_bitop3_b32 v73, v8, v10, s72 bitop3:0x7e
  v_or_b32 v72, v72, v73
  s_waitcnt vmcnt(0)
  v_mfma_f32_16x16x32_bf16 v[36:39], v[52:55], v[12:15], v[36:39]
  v_bitop3_b32 v73, v12, v14, s72 bitop3:0x7e
  v_bitop3_b32 v72, v72, v73, 1 bitop3:0xa8
  v_cmp_ne_u32 vcc, 0, v72
  s_cbranch_vccz Cs3_h1p
  s_cmp_lt_u32 s67, 131072
  s_cbranch_scc1 Cs3_h1s
Cs3_h1p:
  s_nop 2
  buffer_load_dwordx4 v[4:7], v76, s[8:11], s65 offen offset:1024 sc1
  v_add_f32_dpp v56, v56, v56 row_ror:4 row_mask:0xf bank_mask:0xf
  v_add_f32_dpp v57, v57, v57 row_ror:4 row_mask:0xf bank_mask:0xf
  v_add_f32_dpp v36, v36, v36 row_ror:4 row_mask:0xf bank_mask:0xf
  v_add_f32_dpp v37, v37, v37 row_ror:4 row_mask:0xf bank_mask:0xf
  v_add_f32_dpp v56, v56, v56 row_ror:8 row_mask:0xf bank_mask:0xf
  v_add_f32_dpp v57, v57, v57 row_ror:8 row_mask:0xf bank_mask:0xf
  v_add_f32_dpp v36, v36, v36 row_ror:8 row_mask:0xf bank_mask:0xf
  v_add_f32_dpp v37, v37, v37 row_ror:8 row_mask:0xf bank_mask:0xf
  v_cvt_pk_bf16_f32 v56, v56, v57
  buffer_store_dword v56, v69, s[8:11], s62 offen sc1
  v_cvt_pk_bf16_f32 v36, v36, v37
  buffer_store_dword v36, v70, s[8:11], s63 offen sc1
  s_xor_b32 s62, s62, 16384
  buffer_store_dword v71, v69, s[8:11], s62 offen sc1
  s_xor_b32 s63, s63, 16384
  buffer_store_dword v71, v70, s[8:11], s63 offen sc1
  s_xor_b32 s72, s72, 1
  s_branch Cs3_h2
Cs3_h2r:
  s_mov_b64 exec, vcc
  buffer_load_dwordx4 v[4:7], v76, s[8:11], s65 offen offset:1024 sc1
  s_mov_b64 exec, -1
  s_add_u32 s67, s67, 1
  s_waitcnt vmcnt(3)
  v_max3_u32 v72, v4, v5, v6
  v_max_u32 v72, v72, v7
  ds_write_b128 v76, v[4:7] offset:5632
  v_cmp_eq_u32 vcc, -1, v72
  s_cbranch_vccz Cs3_h2w
Cs3_h2s:
  s_mov_b64 exec, vcc
  buffer_load_dwordx4 v[4:7], v76, s[8:11], s65 offen offset:1024 sc1
  s_mov_b64 exec, -1
  s_add_u32 s67, s67, 1
  s_waitcnt vmcnt(1)
  v_max3_u32 v72, v4, v5, v6
  v_max_u32 v72, v72, v7
  ds_write_b128 v76, v[4:7] offset:5632
  v_cmp_eq_u32 vcc, -1, v72
  s_cbranch_vccz Cs3_h2w
  s_mov_b64 exec, vcc
  buffer_load_dwordx4 v[4:7], v76, s[8:11], s65 offen offset:1024 sc1
  s_mov_b64 exec, -1
  s_add_u32 s67, s67, 1
  s_waitcnt vmcnt(1)
  v_max3_u32 v72, v4, v5, v6
  v_max_u32 v72, v72, v7
  ds_write_b128 v76, v[4:7] offset:5632
  v_cmp_eq_u32 vcc, -1, v72
  s_cbranch_vccz Cs3_h2w
  s_mov_b64 exec, vcc
  buffer_load_dwordx4 v[4:7], v76, s[8:11], s65 offen offset:1024 sc1
  s_mov_b64 exec, -1
  s_add_u32 s67, s67, 1
  s_waitcnt vmcnt(1)
  v_max3_u32 v72, v4, v5, v6
  v_max_u32 v72, v72, v7
  ds_write_b128 v76, v[4:7] offset:5632
  v_cmp_eq_u32 vcc, -1, v72
  s_cbranch_vccz Cs3_h2w
  s_cmp_lt_u32 s67, 131072
  s_cbranch_scc1 Cs3_h2s
  s_branch Cs3_h2w
Cs3_rec:
  s_nop 7
  s_waitcnt vmcnt(0) lgkmcnt(0)
  v_max3_u32 v72, v0, v1, v2
  v_max3_u32 v72, v72, v3, v4
  v_max3_u32 v72, v72, v5, v6
  v_max3_u32 v72, v72, v7, v8
  v_max3_u32 v72, v72, v9, v10
  v_max3_u32 v72, v72, v11, v12
  v_max3_u32 v72, v72, v13, v14
  v_max3_u32 v72, v72, v15, v16
  v_max3_u32 v72, v72, v17, v18
  v_max_u32 v72, v72, v19
  v_cmp_eq_u32 vcc, -1, v72
  s_cbranch_vccz Cs3_recok
  s_barrier
Cs3_recp:
  buffer_load_dwordx4 v[0:3], v76, s[8:11], s64 offen offset:0 sc1
  buffer_load_dwordx4 v[4:7], v76, s[8:11], s64 offen offset:1024 sc1
  buffer_load_dwordx4 v[8:11], v76, s[8:11], s64 offen offset:2048 sc1
  s_add_u32 s67, s67, 1
  s_cmp_lt_u32 s67, 131072
  s_cselect_b32 s54, -2, -1
  s_waitcnt vmcnt(2)
  v_max3_u32 v72, v0, v1, v2
  s_waitcnt vmcnt(1)
  v_max3_u32 v72, v72, v3, v4
  v_max3_u32 v72, v72, v5, v6
  s_waitcnt vmcnt(0)
  v_max3_u32 v72, v72, v7, v8
  v_max3_u32 v72, v72, v9, v10
  v_max_u32 v72, v72, v11
  v_cmp_lt_u32 vcc, s54, v72
  s_cbranch_vccnz Cs3_recp
  ds_write_b128 v76, v[0:3] offset:10752
  ds_write_b128 v76, v[4:7] offset:11776
  ds_write_b128 v76, v[8:11] offset:12800
  v_mov_b64 v[20:21], 0
  v_mov_b64 v[22:23], 0
  v_mov_b64 v[24:25], 0
  v_mov_b64 v[26:27], 0
  v_mov_b64 v[28:29], 0
  v_mov_b64 v[30:31], 0
  v_mov_b64 v[32:33], 0
  v_mov_b64 v[34:35], 0
  s_waitcnt lgkmcnt(0)
  s_barrier
  ds_read_b128 v[0:3], v76 offset:4608
  s_waitcnt lgkmcnt(0)
  v_smfmac_f32_16x16x64_bf16 v[20:23], v[0:3], v[80:87], v74
  v_smfmac_f32_16x16x64_bf16 v[24:27], v[0:3], v[88:95], v74
  ds_read_b128 v[60:63], v76 offset:28672
  ds_read_b128 v[64:67], v76 offset:29696
  s_waitcnt lgkmcnt(0)
  v_smfmac_f32_16x16x64_bf16 v[28:31], v[0:3], v[60:67], v74
  ds_read_b128 v[60:63], v76 offset:30720
  ds_read_b128 v[64:67], v76 offset:31744
  s_waitcnt lgkmcnt(0)
  v_smfmac_f32_16x16x64_bf16 v[32:35], v[0:3], v[60:67], v74
  ds_read_b128 v[4:7], v76 offset:5632
  s_waitcnt lgkmcnt(0)
  v_smfmac_f32_16x16x64_bf16 v[20:23], v[4:7], v[96:103], v74
  v_smfmac_f32_16x16x64_bf16 v[24:27], v[4:7], v[104:111], v74
  ds_read_b128 v[60:63], v76 offset:45056
  ds_read_b128 v[64:67], v76 offset:46080
  s_waitcnt lgkmcnt(0)
  v_smfmac_f32_16x16x64_bf16 v[28:31], v[4:7], v[60:67], v74
  ds_read_b128 v[60:63], v76 offset:47104
  ds_read_b128 v[64:67], v76 offset:48128
  s_waitcnt lgkmcnt(0)
  v_smfmac_f32_16x16x64_bf16 v[32:35], v[4:7], v[60:67], v74
  ds_read_b128 v[8:11], v76 offset:6656
  s_waitcnt lgkmcnt(0)
  v_smfmac_f32_16x16x64_bf16 v[20:23], v[8:11], v[112:119], v74
  v_smfmac_f32_16x16x64_bf16 v[24:27], v[8:11], v[120:127], v74
  v_smfmac_f32_16x16x64_bf16 v[28:31], v[8:11], v[208:215], v74
  v_smfmac_f32_16x16x64_bf16 v[32:35], v[8:11], v[216:223], v74
  ds_read_b128 v[12:15], v76 offset:7680
  s_waitcnt lgkmcnt(0)
  v_smfmac_f32_16x16x64_bf16 v[20:23], v[12:15], v[128:135], v74
  v_smfmac_f32_16x16x64_bf16 v[24:27], v[12:15], v[136:143], v74
  v_smfmac_f32_16x16x64_bf16 v[28:31], v[12:15], v[224:231], v74
  v_smfmac_f32_16x16x64_bf16 v[32:35], v[12:15], v[232:239], v74
  ds_read_b128 v[4:7], v76 offset:8704
  s_waitcnt lgkmcnt(0)
  v_smfmac_f32_16x16x64_bf16 v[20:23], v[4:7], v[144:151], v74
  v_smfmac_f32_16x16x64_bf16 v[24:27], v[4:7], v[152:159], v74
  ds_read_b128 v[60:63], v76 offset:61440
  ds_read_b128 v[64:67], v76 offset:62464
  s_waitcnt lgkmcnt(0)
  v_smfmac_f32_16x16x64_bf16 v[28:31], v[4:7], v[60:67], v74
  ds_read_b128 v[60:63], v76 offset:63488
  ds_read_b128 v[64:67], v76 offset:64512
  s_waitcnt lgkmcnt(0)
  v_smfmac_f32_16x16x64_bf16 v[32:35], v[4:7], v[60:67], v74
  ds_read_b128 v[8:11], v76 offset:9728
  s_waitcnt lgkmcnt(0)
  v_smfmac_f32_16x16x64_bf16 v[20:23], v[8:11], v[160:167], v74
  v_smfmac_f32_16x16x64_bf16 v[24:27], v[8:11], v[168:175], v74
  ds_read_b128 v[60:63], v75 offset:28672
  ds_read_b128 v[64:67], v75 offset:29696
  s_waitcnt lgkmcnt(0)
  v_smfmac_f32_16x16x64_bf16 v[28:31], v[8:11], v[60:67], v74
  ds_read_b128 v[60:63], v75 offset:30720
  ds_read_b128 v[64:67], v75 offset:31744
  s_waitcnt lgkmcnt(0)
  v_smfmac_f32_16x16x64_bf16 v[32:35], v[8:11], v[60:67], v74
  ds_read_b128 v[16:19], v76 offset:10752
  ds_read_b128 v[60:63], v75 offset:12288
  ds_read_b128 v[64:67], v75 offset:13312
  s_waitcnt lgkmcnt(0)
  v_smfmac_f32_16x16x64_bf16 v[20:23], v[16:19], v[60:67], v74
  ds_read_b128 v[60:63], v75 offset:14336
  ds_read_b128 v[64:67], v75 offset:15360
  s_waitcnt lgkmcnt(0)
  v_smfmac_f32_16x16x64_bf16 v[24:27], v[16:19], v[60:67], v74
  v_smfmac_f32_16x16x64_bf16 v[28:31], v[16:19], v[240:247], v74
  v_smfmac_f32_16x16x64_bf16 v[32:35], v[16:19], v[248:255], v74
  ds_read_b128 v[0:3], v76 offset:11776
  s_waitcnt lgkmcnt(0)
  v_smfmac_f32_16x16x64_bf16 v[20:23], v[0:3], v[176:183], v74
  v_smfmac_f32_16x16x64_bf16 v[24:27], v[0:3], v[184:191], v74
  v_smfmac_f32_16x16x64_bf16 v[28:31], v[0:3], a[0:7], v74
  v_smfmac_f32_16x16x64_bf16 v[32:35], v[0:3], a[8:15], v74
  ds_read_b128 v[12:15], v76 offset:12800
  s_waitcnt lgkmcnt(0)
  v_smfmac_f32_16x16x64_bf16 v[20:23], v[12:15], v[192:199], v74
  v_smfmac_f32_16x16x64_bf16 v[24:27], v[12:15], v[200:207], v74
  v_smfmac_f32_16x16x64_bf16 v[28:31], v[12:15], a[16:23], v74
  v_smfmac_f32_16x16x64_bf16 v[32:35], v[12:15], a[24:31], v74
  v_add_f32 v20, v20, v22
  v_add_f32 v21, v21, v23
  v_add_f32 v24, v24, v26
  v_cvt_pk_bf16_f32 v22, v20, v24
  ds_write_b32 v79, v22 offset:0
  v_add_f32 v25, v25, v27
  v_cvt_pk_bf16_f32 v23, v21, v25
  ds_write_b32 v79, v23 offset:576
  v_add_f32 v28, v28, v30
  v_add_f32 v29, v29, v31
  s_waitcnt lgkmcnt(0)
  s_nop 1
  s_branch Cs3_recok
Cs3_mx:
  s_waitcnt lgkmcnt(0)
  s_barrier
  buffer_load_dwordx4 v[0:3], v76, s[8:11], s58 offen offset:0 sc1
  ds_read_b128 v[20:23], v77 offset:0
  ds_read_b128 v[28:31], v77 offset:256
  buffer_load_dwordx4 v[4:7], v76, s[8:11], s58 offen offset:1024 sc1
  ds_read_b128 v[24:27], v77 offset:128
  ds_read_b128 v[32:35], v77 offset:384
  s_waitcnt vmcnt(1) lgkmcnt(3)
  v_mfma_f32_16x16x32_bf16 v[8:11], v[0:3], v[20:23], 0
  s_waitcnt vmcnt(0) lgkmcnt(1)
  v_mfma_f32_16x16x32_bf16 v[8:11], v[4:7], v[24:27], v[8:11]
  v_mfma_f32_16x16x32_bf16 v[12:15], v[28:31], v[20:23], 0
  s_waitcnt lgkmcnt(0)
  v_mfma_f32_16x16x32_bf16 v[12:15], v[32:35], v[24:27], v[12:15]
  v_add_f32_dpp v8, v10, v8 quad_perm:[2,3,0,1] row_mask:0xf bank_mask:0xf
  v_add_f32_dpp v9, v11, v9 quad_perm:[2,3,0,1] row_mask:0xf bank_mask:0xf
  s_nop 0
  v_mov_b32_dpp v8, v8 quad_perm:[0,1,0,1] row_mask:0xf bank_mask:0xf
  v_mov_b32_dpp v9, v9 quad_perm:[0,1,0,1] row_mask:0xf bank_mask:0xf
  s_nop 1
  v_add_f32_dpp v12, v14, v12 quad_perm:[2,3,0,1] row_mask:0xf bank_mask:0xf
  v_add_f32_dpp v13, v15, v13 quad_perm:[2,3,0,1] row_mask:0xf bank_mask:0xf
  s_nop 0
  v_mov_b32_dpp v12, v12 quad_perm:[0,1,0,1] row_mask:0xf bank_mask:0xf
  v_mov_b32_dpp v13, v13 quad_perm:[0,1,0,1] row_mask:0xf bank_mask:0xf
  v_mul_f32 v12, s69, v12
  ds_write_b32 v78, v8 offset:8716
  v_mul_f32 v13, s69, v13
  ds_write_b32 v78, v9 offset:8780
  s_waitcnt lgkmcnt(0)
  s_barrier
  ds_read_b128 v[36:39], v78 offset:8704
  ds_read_b128 v[40:43], v78 offset:8768
  s_waitcnt lgkmcnt(0)
  s_barrier
  v_max_f32 v16, v36, v37
  v_max3_f32 v16, v16, v38, v39
  v_max3_f32 v16, v16, v40, v41
  v_max3_f32 v16, v16, v42, v43
  v_max3_f32 v16, v16, v12, v13
  v_mov_b32 v17, v16
  s_nop 1
  v_permlane16_swap_b32 v16, v17
  v_max_f32 v16, v16, v17
  v_mov_b32 v17, v16
  s_nop 1
  v_permlane32_swap_b32 v16, v17
  v_max_f32 v16, v16, v17
  v_sub_f32 v36, v36, v16
  v_sub_f32 v37, v37, v16
  v_sub_f32 v38, v38, v16
  v_sub_f32 v39, v39, v16
  v_sub_f32 v40, v40, v16
  v_sub_f32 v41, v41, v16
  v_sub_f32 v42, v42, v16
  v_sub_f32 v43, v43, v16
  v_sub_f32 v12, v12, v16
  v_sub_f32 v13, v13, v16
  v_exp_f32 v36, v36
  v_exp_f32 v37, v37
  v_exp_f32 v38, v38
  v_exp_f32 v39, v39
  v_exp_f32 v40, v40
  v_exp_f32 v41, v41
  v_exp_f32 v42, v42
  v_exp_f32 v43, v43
  v_exp_f32 v12, v12
  v_exp_f32 v13, v13
  v_cvt_pk_bf16_f32 v32, v36, v40
  v_cvt_pk_bf16_f32 v33, v37, v41
  v_cvt_pk_bf16_f32 v34, v38, v42
  v_cvt_pk_bf16_f32 v35, v39, v43
  v_cvt_pk_bf16_f32 v28, v12, v13
  v_cvt_pk_bf16_f32 v31, v12, v13
  v_mov_b32 v29, 0
  v_mov_b32 v30, 0
  v_mov_b32 v68, 0x3f803f80
  v_mov_b32 v69, 0x3f803f80
  v_mov_b32 v70, 0x3f803f80
  v_mov_b32 v71, 0x3f803f80
  s_nop 1
  v_mfma_f32_16x16x32_bf16 v[8:11], v[32:35], v[68:71], 0
  v_mfma_f32_16x16x32_bf16 v[0:3], v[32:35], v[52:55], 0
  v_mfma_f32_16x16x32_bf16 v[4:7], v[32:35], v[56:59], 0
  v_mfma_f32_16x16x16_bf16 v[8:11], v[28:29], v[68:69], v[8:11]
  v_mfma_f32_16x16x16_bf16 v[0:3], v[28:29], v[72:73], v[0:3]
  v_mfma_f32_16x16x16_bf16 v[4:7], v[30:31], v[72:73], v[4:7]
  ds_read_b128 v[68:71], v76 offset:13824
  v_rcp_f32 v10, v8
  v_rcp_f32 v11, v9
  v_mul_f32 v0, v10, v0
  v_mul_f32 v1, v11, v1
  s_nop 0
  v_mul_f32 v4, v10, v4
  v_mul_f32 v5, v11, v5
  v_cvt_pk_bf16_f32 v2, v0, v4
  ds_write_b32 v79, v2 offset:8704
  v_cvt_pk_bf16_f32 v3, v1, v5
  ds_write_b32 v79, v3 offset:9280
  v_mov_b64 v[16:17], 0
  v_mov_b64 v[18:19], 0
  v_mov_b64 v[20:21], 0
  v_mov_b64 v[22:23], 0
  v_mov_b64 v[24:25], 0
  v_mov_b64 v[26:27], 0
  s_branch Cs3_mxok
Cs3_last:
  ds_read_b128 v[0:3], v76 offset:4608
  ds_read_b128 v[12:15], v76 offset:7680
  ds_read_b128 v[44:47], v76 offset:28672
  ds_read_b128 v[48:51], v76 offset:29696
  s_nop 5
  v_mov_b64 v[20:21], 0
  v_mov_b64 v[22:23], 0
  v_mov_b64 v[24:25], 0
  v_mov_b64 v[26:27], 0
  v_smfmac_f32_16x16x64_bf16 v[28:31], v[4:7], v[36:43], v74
  ds_read_b128 v[36:39], v76 offset:30720
  ds_read_b128 v[40:43], v76 offset:31744
  v_smfmac_f32_16x16x64_bf16 v[32:35], v[4:7], v[60:67], v74
  s_waitcnt lgkmcnt(5)
  v_smfmac_f32_16x16x64_bf16 v[20:23], v[0:3], a[32:39], v74
  ds_read_b128 v[60:63], v76 offset:61440
  ds_read_b128 v[64:67], v76 offset:62464
  v_smfmac_f32_16x16x64_bf16 v[24:27], v[0:3], a[40:47], v74
  s_waitcnt lgkmcnt(4)
  v_smfmac_f32_16x16x64_bf16 v[20:23], v[4:7], a[48:55], v74
  buffer_store_dwordx4 v[16:19], v76, s[8:11], s68 offen sc1
  v_smfmac_f32_16x16x64_bf16 v[24:27], v[4:7], a[56:63], v74
  v_smfmac_f32_16x16x64_bf16 v[28:31], v[0:3], v[44:51], v74
  s_waitcnt lgkmcnt(2)
  v_smfmac_f32_16x16x64_bf16 v[20:23], v[8:11], a[64:71], v74
  ds_read_b128 v[44:47], v76 offset:63488
  ds_read_b128 v[48:51], v76 offset:64512
  v_smfmac_f32_16x16x64_bf16 v[24:27], v[8:11], a[72:79], v74
  v_smfmac_f32_16x16x64_bf16 v[32:35], v[0:3], v[36:43], v74
  v_smfmac_f32_16x16x64_bf16 v[28:31], v[8:11], v[208:215], v74
  ds_read_b128 v[36:39], v75 offset:28672
  ds_read_b128 v[40:43], v75 offset:29696
  v_smfmac_f32_16x16x64_bf16 v[32:35], v[8:11], v[216:223], v74
  v_smfmac_f32_16x16x64_bf16 v[20:23], v[12:15], a[80:87], v74
  v_smfmac_f32_16x16x64_bf16 v[24:27], v[12:15], a[88:95], v74
  v_smfmac_f32_16x16x64_bf16 v[28:31], v[12:15], v[224:231], v74
  v_smfmac_f32_16x16x64_bf16 v[32:35], v[12:15], v[232:239], v74
  s_waitcnt vmcnt(1)
  s_barrier
Cs3_lastr:
  ds_read_b128 v[4:7], v76 offset:8704
  ds_read_b128 v[8:11], v76 offset:9728
  ds_read_b128 v[16:19], v76 offset:10752
  ds_read_b128 v[0:3], v76 offset:11776
  ds_read_b128 v[12:15], v76 offset:12800
  s_waitcnt lgkmcnt(1)
  v_max3_u32 v72, v0, v1, v2
  v_max3_u32 v72, v72, v3, v4
  v_max3_u32 v72, v72, v5, v6
  v_max3_u32 v72, v72, v7, v8
  v_max3_u32 v72, v72, v9, v10
  s_waitcnt lgkmcnt(0)
  v_max3_u32 v72, v72, v11, v12
  v_max3_u32 v72, v72, v13, v14
  v_max3_u32 v72, v72, v15, v16
  v_max3_u32 v72, v72, v17, v18
  v_max_u32 v72, v72, v19
  v_cmp_eq_u32 vcc, -1, v72
  s_cbranch_vccnz Cs3_lastp
Cs3_lastg:
  v_smfmac_f32_16x16x64_bf16 v[28:31], v[4:7], v[60:67], v74
  ds_read_b128 v[60:63], v75 offset:30720
  ds_read_b128 v[64:67], v75 offset:31744
  v_smfmac_f32_16x16x64_bf16 v[32:35], v[4:7], v[44:51], v74
  v_smfmac_f32_16x16x64_bf16 v[28:31], v[8:11], v[36:43], v74
  v_smfmac_f32_16x16x64_bf16 v[28:31], v[16:19], v[240:247], v74
  v_smfmac_f32_16x16x64_bf16 v[28:31], v[0:3], a[0:7], v74
  v_smfmac_f32_16x16x64_bf16 v[28:31], v[12:15], a[16:23], v74
  v_smfmac_f32_16x16x64_bf16 v[32:35], v[16:19], v[248:255], v74
  v_smfmac_f32_16x16x64_bf16 v[32:35], v[0:3], a[8:15], v74
  s_waitcnt lgkmcnt(0)
  v_smfmac_f32_16x16x64_bf16 v[32:35], v[12:15], a[24:31], v74
  v_smfmac_f32_16x16x64_bf16 v[32:35], v[8:11], v[60:67], v74
  v_smfmac_f32_16x16x64_bf16 v[20:23], v[4:7], a[96:103], v74
  v_smfmac_f32_16x16x64_bf16 v[20:23], v[8:11], a[112:119], v74
  v_add_f32 v28, v28, v30
  v_add_f32 v32, v32, v34
  v_cvt_pk_bf16_f32 v30, v28, v32
  v_smfmac_f32_16x16x64_bf16 v[20:23], v[16:19], a[128:135], v74
  ds_write_b32 v79, v30 offset:256
  v_add_f32 v29, v29, v31
  v_add_f32 v33, v33, v35
  v_cvt_pk_bf16_f32 v31, v29, v33
  v_smfmac_f32_16x16x64_bf16 v[20:23], v[0:3], a[144:151], v74
  ds_write_b32 v79, v31 offset:832
  v_smfmac_f32_16x16x64_bf16 v[20:23], v[12:15], a[160:167], v74
  v_smfmac_f32_16x16x64_bf16 v[24:27], v[4:7], a[104:111], v74
  v_smfmac_f32_16x16x64_bf16 v[24:27], v[8:11], a[120:127], v74
  v_smfmac_f32_16x16x64_bf16 v[24:27], v[16:19], a[136:143], v74
  s_waitcnt lgkmcnt(0)
  s_barrier
  ds_read_b64 v[52:53], v77 offset:392
  v_add_f32 v20, v20, v22
  v_smfmac_f32_16x16x64_bf16 v[24:27], v[0:3], a[152:159], v74
  v_add_f32 v21, v21, v23
  v_smfmac_f32_16x16x64_bf16 v[24:27], v[12:15], a[168:175], v74
  v_cvt_pk_bf16_f32 v54, v20, v21
  s_add_u32 s68, s68, 655360
  s_nop 3
  v_add_f32 v24, v24, v26
  v_add_f32 v25, v25, v27
  v_cvt_pk_bf16_f32 v55, v24, v25
  s_waitcnt lgkmcnt(0)
  buffer_store_dwordx4 v[52:55], v76, s[8:11], s68 offen sc1
  s_branch Cs3_done
Cs3_lastp:
  s_add_u32 s72, s72, 2
  s_cmp_ge_u32 s72, 131072
  s_cbranch_scc1 Cs3_lastg
  s_barrier
  buffer_load_dwordx4 v76, s[8:11], s85 offen offset:0 sc1 lds
  buffer_load_dwordx4 v76, s[8:11], s85 offen offset:1024 sc1 lds
  s_waitcnt vmcnt(0)
  s_barrier
  s_branch Cs3_lastr
Cs3_done:
  s_branch L_cexit
L_conf:
  s_waitcnt vmcnt(0) lgkmcnt(0)
  s_barrier
  s_cmp_eq_u32 s52, 0
  s_cbranch_scc0 L_cf2
  s_mov_b64 exec, 1
  s_lshl_b32 s57, s2, 2
  v_mov_b32 v1, 0
L_cf0:
  s_cmp_eq_u32 s54, -1
  s_cbranch_scc1 L_cf1
  s_mov_b32 s55, s54
  s_lshr_b64 s[54:55], s[54:55], s0
  s_ff0_i32_b32 s56, s54
  s_add_u32 s0, s0, s56
  s_and_b32 s0, s0, 31
  s_lshl_b32 s56, 1, s0
  v_mov_b32 v35, s56
  buffer_atomic_or v35, v1, s[12:15], s57 offen sc0
  s_waitcnt vmcnt(0)
  v_readfirstlane_b32 s54, v35
  s_nop 0
  s_bitcmp1_b32 s54, s0
  s_cbranch_scc1 L_cf0
  v_mov_b32 v35, s0
  s_branch L_cf3
L_cf1:
  v_mov_b32 v35, 1
  buffer_atomic_add v35, v1, s[12:15], 0 offen offset:40 sc0
  s_waitcnt vmcnt(0)
  v_add_u32 v35, 32, v35
L_cf3:
  ds_write_b32 v33, v35
  s_mov_b64 exec, -1
  s_waitcnt lgkmcnt(0)
L_cf2:
  s_barrier
  ds_read_b32 v32, v33
  s_waitcnt lgkmcnt(0)
  v_readfirstlane_b32 s0, v32
  s_mov_b32 s1, 1
  s_cmp_lt_u32 s0, 32
  s_cbranch_scc1 L_role
  s_sub_u32 s53, s0, 32
  s_mov_b32 s57, 0
L_sur:
  s_load_dwordx16 s[60:75], s[12:13], 0 glc
  s_add_u32 s57, s57, 1
  s_waitcnt lgkmcnt(0)
  s_mov_b32 s55, s70
  s_bcnt1_i32_b32 s56, s60
  s_add_u32 s55, s55, s56
  s_bcnt1_i32_b32 s56, s61
  s_add_u32 s55, s55, s56
  s_bcnt1_i32_b32 s56, s62
  s_add_u32 s55, s55, s56
  s_bcnt1_i32_b32 s56, s63
  s_add_u32 s55, s55, s56
  s_bcnt1_i32_b32 s56, s64
  s_add_u32 s55, s55, s56
  s_bcnt1_i32_b32 s56, s65
  s_add_u32 s55, s55, s56
  s_bcnt1_i32_b32 s56, s66
  s_add_u32 s55, s55, s56
  s_bcnt1_i32_b32 s56, s67
  s_add_u32 s55, s55, s56
  s_cmp_ge_u32 s57, 131072
  s_cbranch_scc1 L_end
  s_cmp_lt_u32 s55, 256
  s_cbranch_scc1 L_sur
  s_mov_b32 s2, 0
  s_mov_b32 s54, s60
  s_bcnt0_i32_b32 s56, s54
  s_cmp_lt_u32 s53, s56
  s_cbranch_scc1 L_sur2
  s_sub_u32 s53, s53, s56
  s_mov_b32 s2, 1
  s_mov_b32 s54, s61
  s_bcnt0_i32_b32 s56, s54
  s_cmp_lt_u32 s53, s56
  s_cbranch_scc1 L_sur2
  s_sub_u32 s53, s53, s56
  s_mov_b32 s2, 2
  s_mov_b32 s54, s62
  s_bcnt0_i32_b32 s56, s54
  s_cmp_lt_u32 s53, s56
  s_cbranch_scc1 L_sur2
  s_sub_u32 s53, s53, s56
  s_mov_b32 s2, 3
  s_mov_b32 s54, s63
  s_bcnt0_i32_b32 s56, s54
  s_cmp_lt_u32 s53, s56
  s_cbranch_scc1 L_sur2
  s_sub_u32 s53, s53, s56
  s_mov_b32 s2, 4
  s_mov_b32 s54, s64
  s_bcnt0_i32_b32 s56, s54
  s_cmp_lt_u32 s53, s56
  s_cbranch_scc1 L_sur2
  s_sub_u32 s53, s53, s56
  s_mov_b32 s2, 5
  s_mov_b32 s54, s65
  s_bcnt0_i32_b32 s56, s54
  s_cmp_lt_u32 s53, s56
  s_cbranch_scc1 L_sur2
  s_sub_u32 s53, s53, s56
  s_mov_b32 s2, 6
  s_mov_b32 s54, s66
  s_bcnt0_i32_b32 s56, s54
  s_cmp_lt_u32 s53, s56
  s_cbranch_scc1 L_sur2
  s_sub_u32 s53, s53, s56
  s_mov_b32 s2, 7
  s_mov_b32 s54, s67
  s_bcnt0_i32_b32 s56, s54
  s_cmp_lt_u32 s53, s56
  s_cbranch_scc1 L_sur2
  s_sub_u32 s53, s53, s56
  s_branch L_end
L_sur2:
  s_ff0_i32_b32 s0, s54
  s_bitset1_b32 s54, s0
  s_sub_u32 s53, s53, 1
  s_cbranch_scc0 L_sur2
  s_branch L_role
L_worker:
  s_lshl_b32 s54, s2, 2
  s_lshr_b32 s54, 1412567136, s54
  s_and_b32 s54, s54, 7
  s_lshl_b32 s54, s54, 5
  s_add_u32 s53, s53, s54
  s_getpc_b64 s[80:81]
L_pc_2:
  s_and_b32 s55, s0, 1
  s_lshl_b32 s55, s55, 2
  s_add_u32 s55, s55, s52
  s_lshl_b32 s55, s55, 13
  v_and_b32 v199, 63, v0
  v_lshl_add_u32 v199, v199, 7, s55
  s_sub_u32 s82, s80, (L_pc_2 - L_w0)
  s_subb_u32 s83, s81, 0
  v_min_u32 v198, (L_w4 - L_w0), v199
  global_load_dword v196, v198, s[82:83]
  v_min_u32 v199, (L_end - L_pc_2), v199
  global_load_dword v196, v199, s[80:81]
  v_and_b32 v200, 63, v0
  v_lshlrev_b32 v201, 4, v200
  v_lshrrev_b32 v211, 3, v200
  s_lshl_b32 s54, s52, 3
  v_add_u32 v211, s54, v211
  v_bfe_u32 v212, v211, 1, 3
  v_and_b32 v213, 7, v200
  v_xor_b32 v212, v212, v213
  v_mul_u32_u24 v211, 1152, v211
  v_lshl_add_u32 v202, v212, 4, v211
  s_mul_i32 s67, s52, 9216
  v_and_b32 v211, 31, v200
  v_lshrrev_b32 v212, 3, v211
  v_mul_u32_u24 v212, 9216, v212
  v_and_b32 v213, 7, v211
  v_lshl_add_u32 v212, v213, 7, v212
  v_bfe_u32 v213, v211, 1, 3
  v_lshrrev_b32 v214, 5, v200
  v_xor_b32 v213, v213, v214
  v_lshl_add_u32 v203, v213, 4, v212
  v_xor_b32 v204, 32, v203
  v_xor_b32 v205, 64, v203
  v_xor_b32 v206, 0x60, v203
  v_bfe_u32 v211, v200, 2, 2
  v_lshl_add_u32 v212, v214, 3, v211
  v_lshlrev_b32 v212, 8, v212
  v_xor_b32 v211, s52, v211
  v_lshl_add_u32 v212, v211, 6, v212
  v_bfe_u32 v213, v200, 4, 1
  v_and_b32 v211, 3, v200
  v_lshl_add_u32 v210, v213, 5, v212
  v_lshl_add_u32 v210, v211, 3, v210
  v_lshl_add_u32 v209, v213, 4, v212
  v_and_b32 v213, 1, v211
  v_lshl_add_u32 v209, v213, 3, v209
  v_lshrrev_b32 v213, 1, v211
  v_lshl_add_u32 v209, v213, 5, v209
  s_mov_b32 s65, 0
  s_mul_i32 s58, s53, 9363
  s_lshr_b32 s58, s58, 16
  s_mul_i32 s54, s58, 7
  s_sub_u32 s59, s53, s54
  s_mul_i32 s60, s59, 36864
  s_add_u32 m0, s67, 0
  s_nop 0
  buffer_load_dwordx4 v202, s[4:7], s60 offen offset:0 lds
  s_add_u32 m0, s67, 896
  s_nop 0
  buffer_load_dwordx4 v202, s[4:7], s60 offen offset:128 lds
  s_add_u32 m0, s67, 1792
  s_nop 0
  buffer_load_dwordx4 v202, s[4:7], s60 offen offset:256 lds
  s_add_u32 m0, s67, 2688
  s_nop 0
  buffer_load_dwordx4 v202, s[4:7], s60 offen offset:384 lds
  s_add_u32 m0, s67, 3584
  s_nop 0
  buffer_load_dwordx4 v202, s[4:7], s60 offen offset:512 lds
  s_add_u32 m0, s67, 4480
  s_nop 0
  buffer_load_dwordx4 v202, s[4:7], s60 offen offset:640 lds
  s_add_u32 m0, s67, 5376
  s_nop 0
  buffer_load_dwordx4 v202, s[4:7], s60 offen offset:768 lds
  s_add_u32 m0, s67, 6272
  s_nop 0
  buffer_load_dwordx4 v202, s[4:7], s60 offen offset:896 lds
  s_add_u32 m0, s67, 7168
  s_nop 0
  buffer_load_dwordx4 v202, s[4:7], s60 offen offset:1024 lds
  v_lshrrev_b32 v211, 4, v200
  v_lshlrev_b32 v212, 2, v211
  v_and_b32 v213, 15, v200
  v_xor_b32 v212, v212, v213
  v_lshlrev_b32 v212, 4, v212
  v_lshl_add_u32 v207, v211, 13, v212
  s_lshl_b32 s62, s58, 8
  s_lshl_b32 s54, s52, 15
  s_add_u32 s62, s62, s54
  s_lshl_b32 s61, s52, 10
  s_add_u32 s61, s61, 36864
  s_add_u32 m0, s61, 0
  s_add_u32 s54, s62, 0
  buffer_load_dwordx4 v207, s[20:23], s54 offen lds
  s_add_u32 m0, s61, 4096
  s_add_u32 s54, s62, 131072
  buffer_load_dwordx4 v207, s[20:23], s54 offen lds
  s_add_u32 m0, s61, 8192
  s_add_u32 s54, s62, 262144
  buffer_load_dwordx4 v207, s[20:23], s54 offen lds
  s_add_u32 m0, s61, 12288
  s_add_u32 s54, s62, 393216
  buffer_load_dwordx4 v207, s[20:23], s54 offen lds
  s_add_u32 m0, s61, 16384
  s_add_u32 s54, s62, 0
  buffer_load_dwordx4 v207, s[24:27], s54 offen lds
  s_add_u32 m0, s61, 20480
  s_add_u32 s54, s62, 131072
  buffer_load_dwordx4 v207, s[24:27], s54 offen lds
  s_add_u32 m0, s61, 24576
  s_add_u32 s54, s62, 262144
  buffer_load_dwordx4 v207, s[24:27], s54 offen lds
  s_add_u32 m0, s61, 28672
  s_add_u32 s54, s62, 393216
  buffer_load_dwordx4 v207, s[24:27], s54 offen lds
  s_add_u32 m0, s61, 32768
  s_add_u32 s54, s62, 524288
  buffer_load_dwordx4 v207, s[20:23], s54 offen lds
  s_add_u32 m0, s61, 36864
  s_add_u32 s54, s62, 655360
  buffer_load_dwordx4 v207, s[20:23], s54 offen lds
  s_add_u32 m0, s61, 40960
  s_add_u32 s54, s62, 786432
  buffer_load_dwordx4 v207, s[20:23], s54 offen lds
  s_add_u32 m0, s61, 45056
  s_add_u32 s54, s62, 917504
  buffer_load_dwordx4 v207, s[20:23], s54 offen lds
  s_add_u32 m0, s61, 49152
  s_add_u32 s54, s62, 524288
  buffer_load_dwordx4 v207, s[24:27], s54 offen lds
  s_add_u32 m0, s61, 53248
  s_add_u32 s54, s62, 655360
  buffer_load_dwordx4 v207, s[24:27], s54 offen lds
  s_add_u32 m0, s61, 57344
  s_add_u32 s54, s62, 786432
  buffer_load_dwordx4 v207, s[24:27], s54 offen lds
  s_add_u32 m0, s61, 61440
  s_add_u32 s54, s62, 917504
  buffer_load_dwordx4 v207, s[24:27], s54 offen lds
  s_add_u32 m0, s61, 65536
  s_add_u32 s54, s62, 1048576
  buffer_load_dwordx4 v207, s[20:23], s54 offen lds
  s_add_u32 m0, s61, 69632
  s_add_u32 s54, s62, 1179648
  buffer_load_dwordx4 v207, s[20:23], s54 offen lds
  s_add_u32 m0, s61, 73728
  s_add_u32 s54, s62, 1310720
  buffer_load_dwordx4 v207, s[20:23], s54 offen lds
  s_add_u32 m0, s61, 77824
  s_add_u32 s54, s62, 1441792
  buffer_load_dwordx4 v207, s[20:23], s54 offen lds
  s_add_u32 m0, s61, 81920
  s_add_u32 s54, s62, 1048576
  buffer_load_dwordx4 v207, s[24:27], s54 offen lds
  s_add_u32 m0, s61, 86016
  s_add_u32 s54, s62, 1179648
  buffer_load_dwordx4 v207, s[24:27], s54 offen lds
  s_add_u32 m0, s61, 90112
  s_add_u32 s54, s62, 1310720
  buffer_load_dwordx4 v207, s[24:27], s54 offen lds
  s_add_u32 m0, s61, 94208
  s_add_u32 s54, s62, 1441792
  buffer_load_dwordx4 v207, s[24:27], s54 offen lds
  v_bfe_u32 v211, v200, 3, 2
  v_lshlrev_b32 v216, 11, v211
  v_bfe_u32 v211, v200, 1, 2
  v_lshl_add_u32 v216, v211, 6, v216
  v_lshrrev_b32 v212, 5, v200
  v_lshl_add_u32 v216, v212, 5, v216
  v_and_b32 v211, 1, v200
  v_lshl_add_u32 v216, v211, 4, v216
  v_bfe_u32 v211, v200, 4, 1
  v_lshlrev_b32 v217, 10, v211
  v_lshl_add_u32 v217, v212, 9, v217
  v_and_b32 v211, 15, v200
  v_lshl_add_u32 v217, v211, 4, v217
  s_lshl_b32 s54, s52, 11
  s_add_u32 s54, s54, 8192
  v_add_u32 v217, s54, v217
  s_cmp_eq_u32 s1, 1
  s_cbranch_scc1 W_ver_ok
  v_mov_b32 v33, 163832
  s_cmp_eq_u32 s52, 0
  s_cbranch_scc0 W_ver_b
  s_waitcnt vmcnt(35)
  s_mov_b64 exec, 1
  ds_write_b32 v33, v35
  s_mov_b64 exec, -1
  s_waitcnt lgkmcnt(0)
W_ver_b:
  s_barrier
  ds_read_b32 v32, v33
  s_waitcnt lgkmcnt(0)
  v_readfirstlane_b32 s54, v32
  s_nop 0
  s_bitcmp1_b32 s54, s0
  s_cbranch_scc1 L_conf
W_ver_ok:
  s_waitcnt vmcnt(20) lgkmcnt(0)
  s_barrier
  s_add_u32 m0, s61, 98304
  s_add_u32 s54, s62, 1572864
  buffer_load_dwordx4 v207, s[20:23], s54 offen lds
  s_add_u32 m0, s61, 102400
  s_add_u32 s54, s62, 1703936
  buffer_load_dwordx4 v207, s[20:23], s54 offen lds
  s_add_u32 m0, s61, 106496
  s_add_u32 s54, s62, 1835008
  buffer_load_dwordx4 v207, s[20:23], s54 offen lds
  s_add_u32 m0, s61, 110592
  s_add_u32 s54, s62, 1966080
  buffer_load_dwordx4 v207, s[20:23], s54 offen lds
  v_add_u32 v215, 36864, v209
  ds_read_b64_tr_b16 a[0:1], v215 offset:0
  ds_read_b64_tr_b16 a[2:3], v215 offset:1024
  ds_read_b64_tr_b16 a[4:5], v215 offset:4096
  ds_read_b64_tr_b16 a[6:7], v215 offset:5120
  ds_read_b64_tr_b16 a[8:9], v215 offset:8192
  ds_read_b64_tr_b16 a[10:11], v215 offset:9216
  ds_read_b64_tr_b16 a[12:13], v215 offset:12288
  ds_read_b64_tr_b16 a[14:15], v215 offset:13312
  s_waitcnt vmcnt(20) lgkmcnt(0)
  s_barrier
  s_add_u32 m0, s61, 0
  s_add_u32 s54, s62, 1572864
  buffer_load_dwordx4 v207, s[24:27], s54 offen lds
  s_add_u32 m0, s61, 4096
  s_add_u32 s54, s62, 1703936
  buffer_load_dwordx4 v207, s[24:27], s54 offen lds
  s_add_u32 m0, s61, 8192
  s_add_u32 s54, s62, 1835008
  buffer_load_dwordx4 v207, s[24:27], s54 offen lds
  s_add_u32 m0, s61, 12288
  s_add_u32 s54, s62, 1966080
  buffer_load_dwordx4 v207, s[24:27], s54 offen lds
  v_add_u32 v215, 53248, v210
  ds_read_b64_tr_b16 a[144:145], v215 offset:0
  ds_read_b64_tr_b16 a[146:147], v215 offset:1024
  ds_read_b64_tr_b16 a[148:149], v215 offset:4096
  ds_read_b64_tr_b16 a[150:151], v215 offset:5120
  ds_read_b64_tr_b16 a[152:153], v215 offset:8192
  ds_read_b64_tr_b16 a[154:155], v215 offset:9216
  ds_read_b64_tr_b16 a[156:157], v215 offset:12288
  ds_read_b64_tr_b16 a[158:159], v215 offset:13312
  s_waitcnt vmcnt(20) lgkmcnt(0)
  s_barrier
  s_add_u32 m0, s61, 16384
  s_add_u32 s54, s62, 2097152
  buffer_load_dwordx4 v207, s[20:23], s54 offen lds
  s_add_u32 m0, s61, 20480
  s_add_u32 s54, s62, 2228224
  buffer_load_dwordx4 v207, s[20:23], s54 offen lds
  s_add_u32 m0, s61, 24576
  s_add_u32 s54, s62, 2359296
  buffer_load_dwordx4 v207, s[20:23], s54 offen lds
  s_add_u32 m0, s61, 28672
  s_add_u32 s54, s62, 2490368
  buffer_load_dwordx4 v207, s[20:23], s54 offen lds
  v_add_u32 v215, 69632, v209
  ds_read_b64_tr_b16 a[16:17], v215 offset:0
  ds_read_b64_tr_b16 a[18:19], v215 offset:1024
  ds_read_b64_tr_b16 a[20:21], v215 offset:4096
  ds_read_b64_tr_b16 a[22:23], v215 offset:5120
  ds_read_b64_tr_b16 a[24:25], v215 offset:8192
  ds_read_b64_tr_b16 a[26:27], v215 offset:9216
  ds_read_b64_tr_b16 a[28:29], v215 offset:12288
  ds_read_b64_tr_b16 a[30:31], v215 offset:13312
  s_waitcnt vmcnt(20) lgkmcnt(0)
  s_barrier
  s_add_u32 m0, s61, 32768
  s_add_u32 s54, s62, 2097152
  buffer_load_dwordx4 v207, s[24:27], s54 offen lds
  s_add_u32 m0, s61, 36864
  s_add_u32 s54, s62, 2228224
  buffer_load_dwordx4 v207, s[24:27], s54 offen lds
  s_add_u32 m0, s61, 40960
  s_add_u32 s54, s62, 2359296
  buffer_load_dwordx4 v207, s[24:27], s54 offen lds
  s_add_u32 m0, s61, 45056
  s_add_u32 s54, s62, 2490368
  buffer_load_dwordx4 v207, s[24:27], s54 offen lds
  v_add_u32 v215, 86016, v210
  ds_read_b64_tr_b16 a[160:161], v215 offset:0
  ds_read_b64_tr_b16 a[162:163], v215 offset:1024
  ds_read_b64_tr_b16 a[164:165], v215 offset:4096
  ds_read_b64_tr_b16 a[166:167], v215 offset:5120
  ds_read_b64_tr_b16 a[168:169], v215 offset:8192
  ds_read_b64_tr_b16 a[170:171], v215 offset:9216
  ds_read_b64_tr_b16 a[172:173], v215 offset:12288
  ds_read_b64_tr_b16 a[174:175], v215 offset:13312
  s_waitcnt vmcnt(20) lgkmcnt(0)
  s_barrier
  s_add_u32 m0, s61, 49152
  s_add_u32 s54, s62, 2621440
  buffer_load_dwordx4 v207, s[20:23], s54 offen lds
  s_add_u32 m0, s61, 53248
  s_add_u32 s54, s62, 2752512
  buffer_load_dwordx4 v207, s[20:23], s54 offen lds
  s_add_u32 m0, s61, 57344
  s_add_u32 s54, s62, 2883584
  buffer_load_dwordx4 v207, s[20:23], s54 offen lds
  s_add_u32 m0, s61, 61440
  s_add_u32 s54, s62, 3014656
  buffer_load_dwordx4 v207, s[20:23], s54 offen lds
  v_add_u32 v215, 102400, v209
  ds_read_b64_tr_b16 a[32:33], v215 offset:0
  ds_read_b64_tr_b16 a[34:35], v215 offset:1024
  ds_read_b64_tr_b16 a[36:37], v215 offset:4096
  ds_read_b64_tr_b16 a[38:39], v215 offset:5120
  ds_read_b64_tr_b16 a[40:41], v215 offset:8192
  ds_read_b64_tr_b16 a[42:43], v215 offset:9216
  ds_read_b64_tr_b16 a[44:45], v215 offset:12288
  ds_read_b64_tr_b16 a[46:47], v215 offset:13312
  s_waitcnt vmcnt(20) lgkmcnt(0)
  s_barrier
  s_add_u32 m0, s61, 65536
  s_add_u32 s54, s62, 2621440
  buffer_load_dwordx4 v207, s[24:27], s54 offen lds
  s_add_u32 m0, s61, 69632
  s_add_u32 s54, s62, 2752512
  buffer_load_dwordx4 v207, s[24:27], s54 offen lds
  s_add_u32 m0, s61, 73728
  s_add_u32 s54, s62, 2883584
  buffer_load_dwordx4 v207, s[24:27], s54 offen lds
  s_add_u32 m0, s61, 77824
  s_add_u32 s54, s62, 3014656
  buffer_load_dwordx4 v207, s[24:27], s54 offen lds
  v_add_u32 v215, 118784, v210
  ds_read_b64_tr_b16 a[176:177], v215 offset:0
  ds_read_b64_tr_b16 a[178:179], v215 offset:1024
  ds_read_b64_tr_b16 a[180:181], v215 offset:4096
  ds_read_b64_tr_b16 a[182:183], v215 offset:5120
  ds_read_b64_tr_b16 a[184:185], v215 offset:8192
  ds_read_b64_tr_b16 a[186:187], v215 offset:9216
  ds_read_b64_tr_b16 a[188:189], v215 offset:12288
  ds_read_b64_tr_b16 a[190:191], v215 offset:13312
  s_waitcnt vmcnt(20) lgkmcnt(0)
  s_barrier
  s_add_u32 m0, s61, 81920
  s_add_u32 s54, s62, 3145728
  buffer_load_dwordx4 v207, s[20:23], s54 offen lds
  s_add_u32 m0, s61, 86016
  s_add_u32 s54, s62, 3276800
  buffer_load_dwordx4 v207, s[20:23], s54 offen lds
  s_add_u32 m0, s61, 90112
  s_add_u32 s54, s62, 3407872
  buffer_load_dwordx4 v207, s[20:23], s54 offen lds
  s_add_u32 m0, s61, 94208
  s_add_u32 s54, s62, 3538944
  buffer_load_dwordx4 v207, s[20:23], s54 offen lds
  v_add_u32 v215, 135168, v209
  ds_read_b64_tr_b16 a[48:49], v215 offset:0
  ds_read_b64_tr_b16 a[50:51], v215 offset:1024
  ds_read_b64_tr_b16 a[52:53], v215 offset:4096
  ds_read_b64_tr_b16 a[54:55], v215 offset:5120
  ds_read_b64_tr_b16 a[56:57], v215 offset:8192
  ds_read_b64_tr_b16 a[58:59], v215 offset:9216
  ds_read_b64_tr_b16 a[60:61], v215 offset:12288
  ds_read_b64_tr_b16 a[62:63], v215 offset:13312
  s_waitcnt vmcnt(20) lgkmcnt(0)
  s_barrier
  s_add_u32 m0, s61, 98304
  s_add_u32 s54, s62, 3145728
  buffer_load_dwordx4 v207, s[24:27], s54 offen lds
  s_add_u32 m0, s61, 102400
  s_add_u32 s54, s62, 3276800
  buffer_load_dwordx4 v207, s[24:27], s54 offen lds
  s_add_u32 m0, s61, 106496
  s_add_u32 s54, s62, 3407872
  buffer_load_dwordx4 v207, s[24:27], s54 offen lds
  s_add_u32 m0, s61, 110592
  s_add_u32 s54, s62, 3538944
  buffer_load_dwordx4 v207, s[24:27], s54 offen lds
  v_add_u32 v215, 36864, v210
  ds_read_b64_tr_b16 a[192:193], v215 offset:0
  ds_read_b64_tr_b16 a[194:195], v215 offset:1024
  ds_read_b64_tr_b16 a[196:197], v215 offset:4096
  ds_read_b64_tr_b16 a[198:199], v215 offset:5120
  ds_read_b64_tr_b16 a[200:201], v215 offset:8192
  ds_read_b64_tr_b16 a[202:203], v215 offset:9216
  ds_read_b64_tr_b16 a[204:205], v215 offset:12288
  ds_read_b64_tr_b16 a[206:207], v215 offset:13312
  s_waitcnt vmcnt(20) lgkmcnt(0)
  s_barrier
  s_add_u32 m0, s61, 0
  s_add_u32 s54, s62, 3670016
  buffer_load_dwordx4 v207, s[20:23], s54 offen lds
  s_add_u32 m0, s61, 4096
  s_add_u32 s54, s62, 3801088
  buffer_load_dwordx4 v207, s[20:23], s54 offen lds
  s_add_u32 m0, s61, 8192
  s_add_u32 s54, s62, 3932160
  buffer_load_dwordx4 v207, s[20:23], s54 offen lds
  s_add_u32 m0, s61, 12288
  s_add_u32 s54, s62, 4063232
  buffer_load_dwordx4 v207, s[20:23], s54 offen lds
  v_add_u32 v215, 53248, v209
  ds_read_b64_tr_b16 a[64:65], v215 offset:0
  ds_read_b64_tr_b16 a[66:67], v215 offset:1024
  ds_read_b64_tr_b16 a[68:69], v215 offset:4096
  ds_read_b64_tr_b16 a[70:71], v215 offset:5120
  ds_read_b64_tr_b16 a[72:73], v215 offset:8192
  ds_read_b64_tr_b16 a[74:75], v215 offset:9216
  ds_read_b64_tr_b16 a[76:77], v215 offset:12288
  ds_read_b64_tr_b16 a[78:79], v215 offset:13312
  s_waitcnt vmcnt(20) lgkmcnt(0)
  s_barrier
  s_add_u32 m0, s61, 16384
  s_add_u32 s54, s62, 3670016
  buffer_load_dwordx4 v207, s[24:27], s54 offen lds
  s_add_u32 m0, s61, 20480
  s_add_u32 s54, s62, 3801088
  buffer_load_dwordx4 v207, s[24:27], s54 offen lds
  s_add_u32 m0, s61, 24576
  s_add_u32 s54, s62, 3932160
  buffer_load_dwordx4 v207, s[24:27], s54 offen lds
  s_add_u32 m0, s61, 28672
  s_add_u32 s54, s62, 4063232
  buffer_load_dwordx4 v207, s[24:27], s54 offen lds
  v_add_u32 v215, 69632, v210
  ds_read_b64_tr_b16 a[208:209], v215 offset:0
  ds_read_b64_tr_b16 a[210:211], v215 offset:1024
  ds_read_b64_tr_b16 a[212:213], v215 offset:4096
  ds_read_b64_tr_b16 a[214:215], v215 offset:5120
  ds_read_b64_tr_b16 a[216:217], v215 offset:8192
  ds_read_b64_tr_b16 a[218:219], v215 offset:9216
  ds_read_b64_tr_b16 a[220:221], v215 offset:12288
  ds_read_b64_tr_b16 a[222:223], v215 offset:13312
  s_waitcnt vmcnt(20) lgkmcnt(0)
  s_barrier
  s_add_u32 m0, s61, 32768
  s_add_u32 s54, s62, 4194304
  buffer_load_dwordx4 v207, s[20:23], s54 offen lds
  s_add_u32 m0, s61, 36864
  s_add_u32 s54, s62, 4325376
  buffer_load_dwordx4 v207, s[20:23], s54 offen lds
  s_add_u32 m0, s61, 40960
  s_add_u32 s54, s62, 4456448
  buffer_load_dwordx4 v207, s[20:23], s54 offen lds
  s_add_u32 m0, s61, 45056
  s_add_u32 s54, s62, 4587520
  buffer_load_dwordx4 v207, s[20:23], s54 offen lds
  v_add_u32 v215, 86016, v209
  ds_read_b64_tr_b16 a[80:81], v215 offset:0
  ds_read_b64_tr_b16 a[82:83], v215 offset:1024
  ds_read_b64_tr_b16 a[84:85], v215 offset:4096
  ds_read_b64_tr_b16 a[86:87], v215 offset:5120
  ds_read_b64_tr_b16 a[88:89], v215 offset:8192
  ds_read_b64_tr_b16 a[90:91], v215 offset:9216
  ds_read_b64_tr_b16 a[92:93], v215 offset:12288
  ds_read_b64_tr_b16 a[94:95], v215 offset:13312
  s_waitcnt vmcnt(20) lgkmcnt(0)
  s_barrier
  s_add_u32 m0, s61, 49152
  s_add_u32 s54, s62, 4194304
  buffer_load_dwordx4 v207, s[24:27], s54 offen lds
  s_add_u32 m0, s61, 53248
  s_add_u32 s54, s62, 4325376
  buffer_load_dwordx4 v207, s[24:27], s54 offen lds
  s_add_u32 m0, s61, 57344
  s_add_u32 s54, s62, 4456448
  buffer_load_dwordx4 v207, s[24:27], s54 offen lds
  s_add_u32 m0, s61, 61440
  s_add_u32 s54, s62, 4587520
  buffer_load_dwordx4 v207, s[24:27], s54 offen lds
  s_mul_i32 s54, s53, 21120
  s_lshl_b32 s55, s52, 13
  s_add_u32 s54, s54, s55
  s_cmp_eq_u32 s52, 3
  s_cselect_b32 s54, 0x10000000, s54
  v_lshlrev_b32 v211, 3, v201
  buffer_load_dword v196, v211, s[28:31], s54 offen
  v_add_u32 v215, 102400, v210
  ds_read_b64_tr_b16 a[224:225], v215 offset:0
  ds_read_b64_tr_b16 a[226:227], v215 offset:1024
  ds_read_b64_tr_b16 a[228:229], v215 offset:4096
  ds_read_b64_tr_b16 a[230:231], v215 offset:5120
  ds_read_b64_tr_b16 a[232:233], v215 offset:8192
  ds_read_b64_tr_b16 a[234:235], v215 offset:9216
  ds_read_b64_tr_b16 a[236:237], v215 offset:12288
  ds_read_b64_tr_b16 a[238:239], v215 offset:13312
  s_waitcnt vmcnt(21) lgkmcnt(0)
  s_barrier
  s_lshl_b32 s54, s53, 13
  s_lshr_b32 s55, s53, 6
  s_or_b32 s55, s55, s52
  s_cmp_eq_u32 s55, 0
  s_cselect_b32 s54, s54, 0x10000000
  v_lshlrev_b32 v211, 3, v201
  buffer_load_dword v196, v211, s[16:19], s54 offen
  v_add_u32 v215, 118784, v209
  ds_read_b64_tr_b16 a[96:97], v215 offset:0
  ds_read_b64_tr_b16 a[98:99], v215 offset:1024
  ds_read_b64_tr_b16 a[100:101], v215 offset:4096
  ds_read_b64_tr_b16 a[102:103], v215 offset:5120
  ds_read_b64_tr_b16 a[104:105], v215 offset:8192
  ds_read_b64_tr_b16 a[106:107], v215 offset:9216
  ds_read_b64_tr_b16 a[108:109], v215 offset:12288
  ds_read_b64_tr_b16 a[110:111], v215 offset:13312
  s_waitcnt vmcnt(18) lgkmcnt(0)
  s_barrier
  v_add_u32 v215, 135168, v210
  ds_read_b64_tr_b16 a[240:241], v215 offset:0
  ds_read_b64_tr_b16 a[242:243], v215 offset:1024
  ds_read_b64_tr_b16 a[244:245], v215 offset:4096
  ds_read_b64_tr_b16 a[246:247], v215 offset:5120
  ds_read_b64_tr_b16 a[248:249], v215 offset:8192
  ds_read_b64_tr_b16 a[250:251], v215 offset:9216
  ds_read_b64_tr_b16 a[252:253], v215 offset:12288
  ds_read_b64_tr_b16 a[254:255], v215 offset:13312
  s_waitcnt vmcnt(14) lgkmcnt(0)
  s_barrier
  v_add_u32 v215, 36864, v209
  ds_read_b64_tr_b16 a[112:113], v215 offset:0
  ds_read_b64_tr_b16 a[114:115], v215 offset:1024
  ds_read_b64_tr_b16 a[116:117], v215 offset:4096
  ds_read_b64_tr_b16 a[118:119], v215 offset:5120
  ds_read_b64_tr_b16 a[120:121], v215 offset:8192
  ds_read_b64_tr_b16 a[122:123], v215 offset:9216
  ds_read_b64_tr_b16 a[124:125], v215 offset:12288
  ds_read_b64_tr_b16 a[126:127], v215 offset:13312
  s_waitcnt vmcnt(10) lgkmcnt(0)
  s_barrier
  v_add_u32 v215, 53248, v210
  ds_read_b64_tr_b16 v[224:225], v215 offset:0
  ds_read_b64_tr_b16 v[226:227], v215 offset:1024
  ds_read_b64_tr_b16 v[228:229], v215 offset:4096
  ds_read_b64_tr_b16 v[230:231], v215 offset:5120
  ds_read_b64_tr_b16 v[232:233], v215 offset:8192
  ds_read_b64_tr_b16 v[234:235], v215 offset:9216
  ds_read_b64_tr_b16 v[236:237], v215 offset:12288
  ds_read_b64_tr_b16 v[238:239], v215 offset:13312
  s_waitcnt vmcnt(6) lgkmcnt(0)
  s_barrier
  v_add_u32 v215, 69632, v209
  ds_read_b64_tr_b16 a[128:129], v215 offset:0
  ds_read_b64_tr_b16 a[130:131], v215 offset:1024
  ds_read_b64_tr_b16 a[132:133], v215 offset:4096
  ds_read_b64_tr_b16 a[134:135], v215 offset:5120
  ds_read_b64_tr_b16 a[136:137], v215 offset:8192
  ds_read_b64_tr_b16 a[138:139], v215 offset:9216
  ds_read_b64_tr_b16 a[140:141], v215 offset:12288
  ds_read_b64_tr_b16 a[142:143], v215 offset:13312
  s_waitcnt vmcnt(2) lgkmcnt(0)
  s_barrier
  v_add_u32 v215, 86016, v210
  ds_read_b64_tr_b16 v[240:241], v215 offset:0
  ds_read_b64_tr_b16 v[242:243], v215 offset:1024
  ds_read_b64_tr_b16 v[244:245], v215 offset:4096
  ds_read_b64_tr_b16 v[246:247], v215 offset:5120
  ds_read_b64_tr_b16 v[248:249], v215 offset:8192
  ds_read_b64_tr_b16 v[250:251], v215 offset:9216
  ds_read_b64_tr_b16 v[252:253], v215 offset:12288
  ds_read_b64_tr_b16 v[254:255], v215 offset:13312
  s_waitcnt lgkmcnt(0)
  s_barrier
  s_lshr_b32 s55, s53, 1
  s_and_b32 s56, s53, 1
  s_lshl_b32 s56, s56, 7
  s_lshl_b32 s55, s55, 2
  s_add_u32 s55, s55, s56
  s_add_u32 s55, s55, 356352
  s_cmp_lt_u32 s53, 64
  s_cselect_b32 s71, s55, 268435456
  v_mov_b32 v211, 0
  s_mov_b64 exec, 1
  buffer_store_dword v211, v211, s[8:11], s71 offen sc1
  s_mov_b64 exec, -1
  s_mov_b32 s68, 1040356334
  s_lshl_b32 s69, s52, 9
  s_lshl_b32 s70, s58, 2
  s_add_u32 s70, s70, 128
  s_mul_i32 s66, s58, -12288
  s_lshl_b32 s54, s52, 10
  s_add_u32 s66, s66, s54
  s_add_u32 s66, s66, 524288
  v_mov_b32 v64, -1
  v_mov_b32 v65, -1
  v_mov_b32 v66, -1
  v_mov_b32 v67, -1
  s_cmp_eq_u32 s59, 0
  s_cbranch_scc0 KV_na
  s_mul_i32 s54, s58, 2176
  s_mul_i32 s55, s52, 69632
  s_add_u32 s55, s55, s54
  s_add_u32 s55, s55, 0
  s_add_u32 s54, s54, 278528
  s_and_b32 s56, s58, 7
  s_lshl_b32 s56, s56, 12
  s_bfe_u32 s57, s58, 0x10003
  s_lshl_b32 s57, s57, 11
  s_add_u32 s56, s56, s57
  s_add_u32 s54, s56, 262144
  s_lshr_b32 s57, s58, 4
  s_lshl_b32 s57, s57, 15
  s_add_u32 s56, s56, s57
  s_lshl_b32 s57, s52, 16
  s_add_u32 s56, s56, s57
  s_add_u32 s55, s56, 0
  s_lshl_b32 s56, s58, 14
  s_mul_i32 s57, s52, 3072
  s_add_u32 s56, s56, s57
  s_add_u32 s56, s56, 360448
  s_cmp_lt_u32 s58, 2
  s_cselect_b32 s56, s56, 268435456
  s_cmp_eq_u32 s52, 0
  s_cselect_b32 s54, s54, 268435456
  buffer_store_dwordx4 v[64:67], v201, s[8:11], s55 offen offset:0 sc1
  buffer_store_dwordx4 v[64:67], v201, s[8:11], s55 offen offset:1024 sc1
  buffer_store_dwordx4 v[64:67], v201, s[8:11], s54 offen offset:0 sc1
  buffer_store_dwordx4 v[64:67], v201, s[8:11], s54 offen offset:1024 sc1
  buffer_store_dwordx4 v[64:67], v201, s[8:11], s56 offen offset:0 sc1
  buffer_store_dwordx4 v[64:67], v201, s[8:11], s56 offen offset:1024 sc1
  buffer_store_dwordx4 v[64:67], v201, s[8:11], s56 offen offset:2048 sc1
KV_na:
  s_add_u32 s60, s60, 258048
  ds_read_b128 v[32:35], v203 offset:0
  ds_read_b128 v[36:39], v204 offset:0
  ds_read_b128 v[40:43], v205 offset:0
  s_waitcnt lgkmcnt(2)
  v_mfma_f32_32x32x16_bf16 v[0:15], a[0:3], v[32:35], 0
  ds_read_b128 v[44:47], v206 offset:0
  s_add_u32 m0, s67, 36864
  s_nop 0
  buffer_load_dwordx4 v202, s[4:7], s60 offen offset:0 lds
  v_mfma_f32_32x32x16_bf16 v[16:31], v[32:35], a[144:147], 0
  s_waitcnt lgkmcnt(2)
  v_mfma_f32_32x32x16_bf16 v[0:15], a[4:7], v[36:39], v[0:15]
  ds_read_b128 v[32:35], v203 offset:1024
  s_add_u32 m0, s67, 37760
  s_nop 0
  buffer_load_dwordx4 v202, s[4:7], s60 offen offset:128 lds
  v_mfma_f32_32x32x16_bf16 v[16:31], v[36:39], a[148:151], v[16:31]
  s_waitcnt lgkmcnt(2)
  v_mfma_f32_32x32x16_bf16 v[0:15], a[8:11], v[40:43], v[0:15]
  ds_read_b128 v[36:39], v204 offset:1024
  s_add_u32 m0, s67, 38656
  s_nop 0
  buffer_load_dwordx4 v202, s[4:7], s60 offen offset:256 lds
  v_mfma_f32_32x32x16_bf16 v[16:31], v[40:43], a[152:155], v[16:31]
  s_waitcnt lgkmcnt(2)
  v_mfma_f32_32x32x16_bf16 v[0:15], a[12:15], v[44:47], v[0:15]
  ds_read_b128 v[40:43], v205 offset:1024
  s_add_u32 m0, s67, 39552
  s_nop 0
  buffer_load_dwordx4 v202, s[4:7], s60 offen offset:384 lds
  v_mfma_f32_32x32x16_bf16 v[16:31], v[44:47], a[156:159], v[16:31]
  s_waitcnt lgkmcnt(2)
  v_mfma_f32_32x32x16_bf16 v[0:15], a[16:19], v[32:35], v[0:15]
  ds_read_b128 v[44:47], v206 offset:1024
  s_add_u32 m0, s67, 40448
  s_nop 0
  buffer_load_dwordx4 v202, s[4:7], s60 offen offset:512 lds
  v_mfma_f32_32x32x16_bf16 v[16:31], v[32:35], a[160:163], v[16:31]
  s_waitcnt lgkmcnt(2)
  v_mfma_f32_32x32x16_bf16 v[0:15], a[20:23], v[36:39], v[0:15]
  ds_read_b128 v[32:35], v203 offset:2048
  s_add_u32 m0, s67, 41344
  s_nop 0
  buffer_load_dwordx4 v202, s[4:7], s60 offen offset:640 lds
  v_mfma_f32_32x32x16_bf16 v[16:31], v[36:39], a[164:167], v[16:31]
  s_waitcnt lgkmcnt(2)
  v_mfma_f32_32x32x16_bf16 v[0:15], a[24:27], v[40:43], v[0:15]
  ds_read_b128 v[36:39], v204 offset:2048
  s_add_u32 m0, s67, 42240
  s_nop 0
  buffer_load_dwordx4 v202, s[4:7], s60 offen offset:768 lds
  v_mfma_f32_32x32x16_bf16 v[16:31], v[40:43], a[168:171], v[16:31]
  s_waitcnt lgkmcnt(2)
  v_mfma_f32_32x32x16_bf16 v[0:15], a[28:31], v[44:47], v[0:15]
  ds_read_b128 v[40:43], v205 offset:2048
  s_add_u32 m0, s67, 43136
  s_nop 0
  buffer_load_dwordx4 v202, s[4:7], s60 offen offset:896 lds
  v_mfma_f32_32x32x16_bf16 v[16:31], v[44:47], a[172:175], v[16:31]
  s_waitcnt lgkmcnt(2)
  v_mfma_f32_32x32x16_bf16 v[0:15], a[32:35], v[32:35], v[0:15]
  ds_read_b128 v[44:47], v206 offset:2048
  s_add_u32 m0, s67, 44032
  s_nop 0
  buffer_load_dwordx4 v202, s[4:7], s60 offen offset:1024 lds
  v_mfma_f32_32x32x16_bf16 v[16:31], v[32:35], a[176:179], v[16:31]
  s_waitcnt lgkmcnt(2)
  v_mfma_f32_32x32x16_bf16 v[0:15], a[36:39], v[36:39], v[0:15]
  ds_read_b128 v[32:35], v203 offset:3072
  v_mfma_f32_32x32x16_bf16 v[16:31], v[36:39], a[180:183], v[16:31]
  s_waitcnt lgkmcnt(2)
  v_mfma_f32_32x32x16_bf16 v[0:15], a[40:43], v[40:43], v[0:15]
  ds_read_b128 v[36:39], v204 offset:3072
  v_mfma_f32_32x32x16_bf16 v[16:31], v[40:43], a[184:187], v[16:31]
  s_waitcnt lgkmcnt(2)
  v_mfma_f32_32x32x16_bf16 v[0:15], a[44:47], v[44:47], v[0:15]
  ds_read_b128 v[40:43], v205 offset:3072
  v_mfma_f32_32x32x16_bf16 v[16:31], v[44:47], a[188:191], v[16:31]
  s_waitcnt lgkmcnt(2)
  v_mfma_f32_32x32x16_bf16 v[0:15], a[48:51], v[32:35], v[0:15]
  ds_read_b128 v[44:47], v206 offset:3072
  v_mfma_f32_32x32x16_bf16 v[16:31], v[32:35], a[192:195], v[16:31]
  s_waitcnt lgkmcnt(2)
  v_mfma_f32_32x32x16_bf16 v[0:15], a[52:55], v[36:39], v[0:15]
  ds_read_b128 v[32:35], v203 offset:4096
  v_mfma_f32_32x32x16_bf16 v[16:31], v[36:39], a[196:199], v[16:31]
  s_waitcnt lgkmcnt(2)
  v_mfma_f32_32x32x16_bf16 v[0:15], a[56:59], v[40:43], v[0:15]
  ds_read_b128 v[36:39], v204 offset:4096
  v_mfma_f32_32x32x16_bf16 v[16:31], v[40:43], a[200:203], v[16:31]
  s_waitcnt lgkmcnt(2)
  v_mfma_f32_32x32x16_bf16 v[0:15], a[60:63], v[44:47], v[0:15]
  ds_read_b128 v[40:43], v205 offset:4096
  v_mfma_f32_32x32x16_bf16 v[16:31], v[44:47], a[204:207], v[16:31]
  s_waitcnt lgkmcnt(2)
  v_mfma_f32_32x32x16_bf16 v[0:15], a[64:67], v[32:35], v[0:15]
  ds_read_b128 v[44:47], v206 offset:4096
  v_mfma_f32_32x32x16_bf16 v[16:31], v[32:35], a[208:211], v[16:31]
  s_waitcnt lgkmcnt(2)
  v_mfma_f32_32x32x16_bf16 v[0:15], a[68:71], v[36:39], v[0:15]
  ds_read_b128 v[32:35], v203 offset:5120
  v_mfma_f32_32x32x16_bf16 v[16:31], v[36:39], a[212:215], v[16:31]
  s_waitcnt lgkmcnt(2)
  v_mfma_f32_32x32x16_bf16 v[0:15], a[72:75], v[40:43], v[0:15]
  ds_read_b128 v[36:39], v204 offset:5120
  v_mfma_f32_32x32x16_bf16 v[16:31], v[40:43], a[216:219], v[16:31]
  s_waitcnt lgkmcnt(2)
  v_mfma_f32_32x32x16_bf16 v[0:15], a[76:79], v[44:47], v[0:15]
  ds_read_b128 v[40:43], v205 offset:5120
  v_mfma_f32_32x32x16_bf16 v[16:31], v[44:47], a[220:223], v[16:31]
  s_waitcnt lgkmcnt(2)
  v_mfma_f32_32x32x16_bf16 v[0:15], a[80:83], v[32:35], v[0:15]
  ds_read_b128 v[44:47], v206 offset:5120
  v_mfma_f32_32x32x16_bf16 v[16:31], v[32:35], a[224:227], v[16:31]
  s_waitcnt lgkmcnt(2)
  v_mfma_f32_32x32x16_bf16 v[0:15], a[84:87], v[36:39], v[0:15]
  ds_read_b128 v[32:35], v203 offset:6144
  v_mfma_f32_32x32x16_bf16 v[16:31], v[36:39], a[228:231], v[16:31]
  s_waitcnt lgkmcnt(2)
  v_mfma_f32_32x32x16_bf16 v[0:15], a[88:91], v[40:43], v[0:15]
  ds_read_b128 v[36:39], v204 offset:6144
  v_mfma_f32_32x32x16_bf16 v[16:31], v[40:43], a[232:235], v[16:31]
  s_waitcnt lgkmcnt(2)
  v_mfma_f32_32x32x16_bf16 v[0:15], a[92:95], v[44:47], v[0:15]
  ds_read_b128 v[40:43], v205 offset:6144
  v_mfma_f32_32x32x16_bf16 v[16:31], v[44:47], a[236:239], v[16:31]
  s_waitcnt lgkmcnt(2)
  v_mfma_f32_32x32x16_bf16 v[0:15], a[96:99], v[32:35], v[0:15]
  ds_read_b128 v[44:47], v206 offset:6144
  v_mfma_f32_32x32x16_bf16 v[16:31], v[32:35], a[240:243], v[16:31]
  s_waitcnt lgkmcnt(2)
  v_mfma_f32_32x32x16_bf16 v[0:15], a[100:103], v[36:39], v[0:15]
  ds_read_b128 v[32:35], v203 offset:7168
  v_mfma_f32_32x32x16_bf16 v[16:31], v[36:39], a[244:247], v[16:31]
  s_waitcnt lgkmcnt(2)
  v_mfma_f32_32x32x16_bf16 v[0:15], a[104:107], v[40:43], v[0:15]
  ds_read_b128 v[36:39], v204 offset:7168
  v_mfma_f32_32x32x16_bf16 v[16:31], v[40:43], a[248:251], v[16:31]
  s_waitcnt lgkmcnt(2)
  v_mfma_f32_32x32x16_bf16 v[0:15], a[108:111], v[44:47], v[0:15]
  ds_read_b128 v[40:43], v205 offset:7168
  v_mfma_f32_32x32x16_bf16 v[16:31], v[44:47], a[252:255], v[16:31]
  s_waitcnt lgkmcnt(2)
  v_mfma_f32_32x32x16_bf16 v[0:15], a[112:115], v[32:35], v[0:15]
  ds_read_b128 v[44:47], v206 offset:7168
  v_mfma_f32_32x32x16_bf16 v[16:31], v[32:35], v[224:227], v[16:31]
  s_waitcnt lgkmcnt(2)
  v_mfma_f32_32x32x16_bf16 v[0:15], a[116:119], v[36:39], v[0:15]
  ds_read_b128 v[32:35], v203 offset:8192
  v_mfma_f32_32x32x16_bf16 v[16:31], v[36:39], v[228:231], v[16:31]
  s_waitcnt lgkmcnt(2)
  v_mfma_f32_32x32x16_bf16 v[0:15], a[120:123], v[40:43], v[0:15]
  ds_read_b128 v[36:39], v204 offset:8192
  v_mfma_f32_32x32x16_bf16 v[16:31], v[40:43], v[232:235], v[16:31]
  s_waitcnt lgkmcnt(2)
  v_mfma_f32_32x32x16_bf16 v[0:15], a[124:127], v[44:47], v[0:15]
  ds_read_b128 v[40:43], v205 offset:8192
  v_mfma_f32_32x32x16_bf16 v[16:31], v[44:47], v[236:239], v[16:31]
  s_waitcnt lgkmcnt(2)
  v_mfma_f32_32x32x16_bf16 v[0:15], a[128:131], v[32:35], v[0:15]
  ds_read_b128 v[44:47], v206 offset:8192
  v_mfma_f32_32x32x16_bf16 v[16:31], v[32:35], v[240:243], v[16:31]
  s_waitcnt lgkmcnt(2)
  v_mfma_f32_32x32x16_bf16 v[0:15], a[132:135], v[36:39], v[0:15]
  v_mfma_f32_32x32x16_bf16 v[16:31], v[36:39], v[244:247], v[16:31]
  s_waitcnt lgkmcnt(1)
  v_mfma_f32_32x32x16_bf16 v[0:15], a[136:139], v[40:43], v[0:15]
  v_mfma_f32_32x32x16_bf16 v[16:31], v[40:43], v[248:251], v[16:31]
  s_waitcnt lgkmcnt(0)
  v_mfma_f32_32x32x16_bf16 v[0:15], a[140:143], v[44:47], v[0:15]
  v_mfma_f32_32x32x16_bf16 v[16:31], v[44:47], v[252:255], v[16:31]
  s_mul_i32 s64, s59, 655360
  s_lshl_b32 s55, s58, 14
  s_add_u32 s64, s64, s55
  s_add_u32 s64, s64, 1048576
  s_add_u32 s72, s64, s69
  s_add_u32 s73, s64, s66
  s_add_u32 s59, s59, 7
  s_waitcnt vmcnt(0)
  s_barrier
KV_loop:
  s_add_u32 s60, s60, 258048
  ds_read_b128 v[32:35], v203 offset:36864
  ds_read_b128 v[36:39], v204 offset:36864
  ds_read_b128 v[40:43], v205 offset:36864
  s_waitcnt lgkmcnt(2)
  v_mfma_f32_32x32x16_bf16 v[68:83], a[0:3], v[32:35], 0
  ds_read_b128 v[44:47], v206 offset:36864
  s_add_u32 m0, s67, 0
  s_nop 0
  buffer_load_dwordx4 v202, s[4:7], s60 offen offset:0 lds
  v_mfma_f32_32x32x16_bf16 v[84:99], v[32:35], a[144:147], 0
  s_waitcnt lgkmcnt(2)
  v_mfma_f32_32x32x16_bf16 v[68:83], a[4:7], v[36:39], v[68:83]
  ds_read_b128 v[32:35], v203 offset:37888
  s_add_u32 m0, s67, 896
  s_nop 0
  buffer_load_dwordx4 v202, s[4:7], s60 offen offset:128 lds
  v_mfma_f32_32x32x16_bf16 v[84:99], v[36:39], a[148:151], v[84:99]
  s_waitcnt lgkmcnt(2)
  v_mfma_f32_32x32x16_bf16 v[68:83], a[8:11], v[40:43], v[68:83]
  ds_read_b128 v[36:39], v204 offset:37888
  s_add_u32 m0, s67, 1792
  s_nop 0
  buffer_load_dwordx4 v202, s[4:7], s60 offen offset:256 lds
  v_mfma_f32_32x32x16_bf16 v[84:99], v[40:43], a[152:155], v[84:99]
  s_waitcnt lgkmcnt(2)
  v_mfma_f32_32x32x16_bf16 v[68:83], a[12:15], v[44:47], v[68:83]
  ds_read_b128 v[40:43], v205 offset:37888
  s_add_u32 m0, s67, 2688
  s_nop 0
  buffer_load_dwordx4 v202, s[4:7], s60 offen offset:384 lds
  v_mfma_f32_32x32x16_bf16 v[84:99], v[44:47], a[156:159], v[84:99]
  s_waitcnt lgkmcnt(2)
  v_mfma_f32_32x32x16_bf16 v[68:83], a[16:19], v[32:35], v[68:83]
  ds_read_b128 v[44:47], v206 offset:37888
  s_add_u32 m0, s67, 3584
  s_nop 0
  buffer_load_dwordx4 v202, s[4:7], s60 offen offset:512 lds
  v_mfma_f32_32x32x16_bf16 v[84:99], v[32:35], a[160:163], v[84:99]
  s_waitcnt lgkmcnt(2)
  v_mfma_f32_32x32x16_bf16 v[68:83], a[20:23], v[36:39], v[68:83]
  ds_read_b128 v[32:35], v203 offset:38912
  s_add_u32 m0, s67, 4480
  s_nop 0
  buffer_load_dwordx4 v202, s[4:7], s60 offen offset:640 lds
  v_mfma_f32_32x32x16_bf16 v[84:99], v[36:39], a[164:167], v[84:99]
  s_waitcnt lgkmcnt(2)
  v_mfma_f32_32x32x16_bf16 v[68:83], a[24:27], v[40:43], v[68:83]
  ds_read_b128 v[36:39], v204 offset:38912
  s_add_u32 m0, s67, 5376
  s_nop 0
  buffer_load_dwordx4 v202, s[4:7], s60 offen offset:768 lds
  v_mfma_f32_32x32x16_bf16 v[84:99], v[40:43], a[168:171], v[84:99]
  s_waitcnt lgkmcnt(2)
  v_mfma_f32_32x32x16_bf16 v[68:83], a[28:31], v[44:47], v[68:83]
  ds_read_b128 v[40:43], v205 offset:38912
  s_add_u32 m0, s67, 6272
  s_nop 0
  buffer_load_dwordx4 v202, s[4:7], s60 offen offset:896 lds
  v_mfma_f32_32x32x16_bf16 v[84:99], v[44:47], a[172:175], v[84:99]
  s_waitcnt lgkmcnt(2)
  v_mfma_f32_32x32x16_bf16 v[68:83], a[32:35], v[32:35], v[68:83]
  ds_read_b128 v[44:47], v206 offset:38912
  s_add_u32 m0, s67, 7168
  s_nop 0
  buffer_load_dwordx4 v202, s[4:7], s60 offen offset:1024 lds
  v_mfma_f32_32x32x16_bf16 v[84:99], v[32:35], a[176:179], v[84:99]
  s_waitcnt lgkmcnt(2)
  v_mfma_f32_32x32x16_bf16 v[68:83], a[36:39], v[36:39], v[68:83]
  ds_read_b128 v[32:35], v203 offset:39936
  v_mul_f32 v0, s68, v0
  v_mul_f32 v1, s68, v1
  v_mul_f32 v2, s68, v2
  v_mul_f32 v3, s68, v3
  v_mfma_f32_32x32x16_bf16 v[84:99], v[36:39], a[180:183], v[84:99]
  v_mul_f32 v4, s68, v4
  v_mul_f32 v5, s68, v5
  v_mul_f32 v6, s68, v6
  v_mul_f32 v7, s68, v7
  s_waitcnt lgkmcnt(2)
  v_mfma_f32_32x32x16_bf16 v[68:83], a[40:43], v[40:43], v[68:83]
  ds_read_b128 v[36:39], v204 offset:39936
  v_cvt_pk_bf16_f32 v48, v0, v4
  v_cvt_pk_bf16_f32 v49, v1, v5
  v_cvt_pk_bf16_f32 v50, v2, v6
  v_cvt_pk_bf16_f32 v51, v3, v7
  v_mfma_f32_32x32x16_bf16 v[84:99], v[40:43], a[184:187], v[84:99]
  buffer_store_dwordx4 v[48:51], v216, s[8:11], s72 offen offset:0 sc1
  s_waitcnt lgkmcnt(2)
  v_mfma_f32_32x32x16_bf16 v[68:83], a[44:47], v[44:47], v[68:83]
  ds_read_b128 v[40:43], v205 offset:39936
  v_mfma_f32_32x32x16_bf16 v[84:99], v[44:47], a[188:191], v[84:99]
  s_waitcnt lgkmcnt(2)
  v_mfma_f32_32x32x16_bf16 v[68:83], a[48:51], v[32:35], v[68:83]
  ds_read_b128 v[44:47], v206 offset:39936
  v_mul_f32 v8, s68, v8
  v_mul_f32 v9, s68, v9
  v_mul_f32 v10, s68, v10
  v_mul_f32 v11, s68, v11
  v_mfma_f32_32x32x16_bf16 v[84:99], v[32:35], a[192:195], v[84:99]
  v_mul_f32 v12, s68, v12
  v_mul_f32 v13, s68, v13
  v_mul_f32 v14, s68, v14
  v_mul_f32 v15, s68, v15
  s_waitcnt lgkmcnt(2)
  v_mfma_f32_32x32x16_bf16 v[68:83], a[52:55], v[36:39], v[68:83]
  ds_read_b128 v[32:35], v203 offset:40960
  v_cvt_pk_bf16_f32 v52, v8, v12
  v_cvt_pk_bf16_f32 v53, v9, v13
  v_cvt_pk_bf16_f32 v54, v10, v14
  v_cvt_pk_bf16_f32 v55, v11, v15
  v_mfma_f32_32x32x16_bf16 v[84:99], v[36:39], a[196:199], v[84:99]
  buffer_store_dwordx4 v[52:55], v216, s[8:11], s72 offen offset:256 sc1
  s_waitcnt lgkmcnt(2)
  v_mfma_f32_32x32x16_bf16 v[68:83], a[56:59], v[40:43], v[68:83]
  ds_read_b128 v[36:39], v204 offset:40960
  v_mfma_f32_32x32x16_bf16 v[84:99], v[40:43], a[200:203], v[84:99]
  s_waitcnt lgkmcnt(2)
  v_mfma_f32_32x32x16_bf16 v[68:83], a[60:63], v[44:47], v[68:83]
  ds_read_b128 v[40:43], v205 offset:40960
  v_cvt_pk_bf16_f32 v56, v16, v17
  v_cvt_pk_bf16_f32 v57, v20, v21
  v_cvt_pk_bf16_f32 v58, v24, v25
  v_cvt_pk_bf16_f32 v59, v28, v29
  v_mfma_f32_32x32x16_bf16 v[84:99], v[44:47], a[204:207], v[84:99]
  buffer_store_dwordx4 v[56:59], v217, s[8:11], s64 offen offset:0 sc1
  s_waitcnt lgkmcnt(2)
  v_mfma_f32_32x32x16_bf16 v[68:83], a[64:67], v[32:35], v[68:83]
  ds_read_b128 v[44:47], v206 offset:40960
  v_mfma_f32_32x32x16_bf16 v[84:99], v[32:35], a[208:211], v[84:99]
  s_waitcnt lgkmcnt(2)
  v_mfma_f32_32x32x16_bf16 v[68:83], a[68:71], v[36:39], v[68:83]
  ds_read_b128 v[32:35], v203 offset:41984
  v_cvt_pk_bf16_f32 v60, v18, v19
  v_cvt_pk_bf16_f32 v61, v22, v23
  v_cvt_pk_bf16_f32 v62, v26, v27
  v_cvt_pk_bf16_f32 v63, v30, v31
  v_mfma_f32_32x32x16_bf16 v[84:99], v[36:39], a[212:215], v[84:99]
  buffer_store_dwordx4 v[60:63], v217, s[8:11], s64 offen offset:256 sc1
  s_waitcnt lgkmcnt(2)
  v_mfma_f32_32x32x16_bf16 v[68:83], a[72:75], v[40:43], v[68:83]
  ds_read_b128 v[36:39], v204 offset:41984
  v_mfma_f32_32x32x16_bf16 v[84:99], v[40:43], a[216:219], v[84:99]
  s_waitcnt lgkmcnt(2)
  v_mfma_f32_32x32x16_bf16 v[68:83], a[76:79], v[44:47], v[68:83]
  ds_read_b128 v[40:43], v205 offset:41984
  buffer_store_dwordx4 v[64:67], v201, s[8:11], s73 offen sc1
  v_mfma_f32_32x32x16_bf16 v[84:99], v[44:47], a[220:223], v[84:99]
  s_waitcnt lgkmcnt(2)
  v_mfma_f32_32x32x16_bf16 v[68:83], a[80:83], v[32:35], v[68:83]
  ds_read_b128 v[44:47], v206 offset:41984
  v_mfma_f32_32x32x16_bf16 v[84:99], v[32:35], a[224:227], v[84:99]
  s_waitcnt lgkmcnt(2)
  v_mfma_f32_32x32x16_bf16 v[68:83], a[84:87], v[36:39], v[68:83]
  ds_read_b128 v[32:35], v203 offset:43008
  v_mfma_f32_32x32x16_bf16 v[84:99], v[36:39], a[228:231], v[84:99]
  s_waitcnt lgkmcnt(2)
  v_mfma_f32_32x32x16_bf16 v[68:83], a[88:91], v[40:43], v[68:83]
  ds_read_b128 v[36:39], v204 offset:43008
  v_mfma_f32_32x32x16_bf16 v[84:99], v[40:43], a[232:235], v[84:99]
  s_waitcnt lgkmcnt(2)
  v_mfma_f32_32x32x16_bf16 v[68:83], a[92:95], v[44:47], v[68:83]
  ds_read_b128 v[40:43], v205 offset:43008
  v_mfma_f32_32x32x16_bf16 v[84:99], v[44:47], a[236:239], v[84:99]
  s_waitcnt lgkmcnt(2)
  v_mfma_f32_32x32x16_bf16 v[68:83], a[96:99], v[32:35], v[68:83]
  ds_read_b128 v[44:47], v206 offset:43008
  v_mfma_f32_32x32x16_bf16 v[84:99], v[32:35], a[240:243], v[84:99]
  s_waitcnt lgkmcnt(2)
  v_mfma_f32_32x32x16_bf16 v[68:83], a[100:103], v[36:39], v[68:83]
  ds_read_b128 v[32:35], v203 offset:44032
  v_mfma_f32_32x32x16_bf16 v[84:99], v[36:39], a[244:247], v[84:99]
  s_waitcnt lgkmcnt(2)
  v_mfma_f32_32x32x16_bf16 v[68:83], a[104:107], v[40:43], v[68:83]
  ds_read_b128 v[36:39], v204 offset:44032
  v_mfma_f32_32x32x16_bf16 v[84:99], v[40:43], a[248:251], v[84:99]
  s_waitcnt lgkmcnt(2)
  v_mfma_f32_32x32x16_bf16 v[68:83], a[108:111], v[44:47], v[68:83]
  ds_read_b128 v[40:43], v205 offset:44032
  v_mfma_f32_32x32x16_bf16 v[84:99], v[44:47], a[252:255], v[84:99]
  s_waitcnt lgkmcnt(2)
  v_mfma_f32_32x32x16_bf16 v[68:83], a[112:115], v[32:35], v[68:83]
  ds_read_b128 v[44:47], v206 offset:44032
  v_mfma_f32_32x32x16_bf16 v[84:99], v[32:35], v[224:227], v[84:99]
  s_waitcnt lgkmcnt(2)
  v_mfma_f32_32x32x16_bf16 v[68:83], a[116:119], v[36:39], v[68:83]
  ds_read_b128 v[32:35], v203 offset:45056
  v_mfma_f32_32x32x16_bf16 v[84:99], v[36:39], v[228:231], v[84:99]
  s_waitcnt lgkmcnt(2)
  v_mfma_f32_32x32x16_bf16 v[68:83], a[120:123], v[40:43], v[68:83]
  ds_read_b128 v[36:39], v204 offset:45056
  v_mfma_f32_32x32x16_bf16 v[84:99], v[40:43], v[232:235], v[84:99]
  s_waitcnt lgkmcnt(2)
  v_mfma_f32_32x32x16_bf16 v[68:83], a[124:127], v[44:47], v[68:83]
  ds_read_b128 v[40:43], v205 offset:45056
  v_mfma_f32_32x32x16_bf16 v[84:99], v[44:47], v[236:239], v[84:99]
  s_waitcnt lgkmcnt(2)
  v_mfma_f32_32x32x16_bf16 v[68:83], a[128:131], v[32:35], v[68:83]
  ds_read_b128 v[44:47], v206 offset:45056
  v_mfma_f32_32x32x16_bf16 v[84:99], v[32:35], v[240:243], v[84:99]
  s_waitcnt lgkmcnt(2)
  v_mfma_f32_32x32x16_bf16 v[68:83], a[132:135], v[36:39], v[68:83]
  v_mfma_f32_32x32x16_bf16 v[84:99], v[36:39], v[244:247], v[84:99]
  s_waitcnt lgkmcnt(1)
  v_mfma_f32_32x32x16_bf16 v[68:83], a[136:139], v[40:43], v[68:83]
  v_mfma_f32_32x32x16_bf16 v[84:99], v[40:43], v[248:251], v[84:99]
  s_waitcnt lgkmcnt(0)
  v_mfma_f32_32x32x16_bf16 v[68:83], a[140:143], v[44:47], v[68:83]
  v_mfma_f32_32x32x16_bf16 v[84:99], v[44:47], v[252:255], v[84:99]
  s_mul_i32 s64, s59, 655360
  s_lshl_b32 s55, s58, 14
  s_add_u32 s64, s64, s55
  s_add_u32 s64, s64, 1048576
  s_add_u32 s72, s64, s69
  s_add_u32 s73, s64, s66
  s_add_u32 s59, s59, 7
  s_cmp_ge_u32 s59, 64
  s_cbranch_scc1 KV_done1
  s_waitcnt vmcnt(5)
  s_barrier
  s_add_u32 s60, s60, 258048
  ds_read_b128 v[32:35], v203 offset:0
  ds_read_b128 v[36:39], v204 offset:0
  ds_read_b128 v[40:43], v205 offset:0
  s_waitcnt lgkmcnt(2)
  v_mfma_f32_32x32x16_bf16 v[0:15], a[0:3], v[32:35], 0
  ds_read_b128 v[44:47], v206 offset:0
  s_add_u32 m0, s67, 36864
  s_nop 0
  buffer_load_dwordx4 v202, s[4:7], s60 offen offset:0 lds
  v_mfma_f32_32x32x16_bf16 v[16:31], v[32:35], a[144:147], 0
  s_waitcnt lgkmcnt(2)
  v_mfma_f32_32x32x16_bf16 v[0:15], a[4:7], v[36:39], v[0:15]
  ds_read_b128 v[32:35], v203 offset:1024
  s_add_u32 m0, s67, 37760
  s_nop 0
  buffer_load_dwordx4 v202, s[4:7], s60 offen offset:128 lds
  v_mfma_f32_32x32x16_bf16 v[16:31], v[36:39], a[148:151], v[16:31]
  s_waitcnt lgkmcnt(2)
  v_mfma_f32_32x32x16_bf16 v[0:15], a[8:11], v[40:43], v[0:15]
  ds_read_b128 v[36:39], v204 offset:1024
  s_add_u32 m0, s67, 38656
  s_nop 0
  buffer_load_dwordx4 v202, s[4:7], s60 offen offset:256 lds
  v_mfma_f32_32x32x16_bf16 v[16:31], v[40:43], a[152:155], v[16:31]
  s_waitcnt lgkmcnt(2)
  v_mfma_f32_32x32x16_bf16 v[0:15], a[12:15], v[44:47], v[0:15]
  ds_read_b128 v[40:43], v205 offset:1024
  s_add_u32 m0, s67, 39552
  s_nop 0
  buffer_load_dwordx4 v202, s[4:7], s60 offen offset:384 lds
  v_mfma_f32_32x32x16_bf16 v[16:31], v[44:47], a[156:159], v[16:31]
  s_waitcnt lgkmcnt(2)
  v_mfma_f32_32x32x16_bf16 v[0:15], a[16:19], v[32:35], v[0:15]
  ds_read_b128 v[44:47], v206 offset:1024
  s_add_u32 m0, s67, 40448
  s_nop 0
  buffer_load_dwordx4 v202, s[4:7], s60 offen offset:512 lds
  v_mfma_f32_32x32x16_bf16 v[16:31], v[32:35], a[160:163], v[16:31]
  s_waitcnt lgkmcnt(2)
  v_mfma_f32_32x32x16_bf16 v[0:15], a[20:23], v[36:39], v[0:15]
  ds_read_b128 v[32:35], v203 offset:2048
  s_add_u32 m0, s67, 41344
  s_nop 0
  buffer_load_dwordx4 v202, s[4:7], s60 offen offset:640 lds
  v_mfma_f32_32x32x16_bf16 v[16:31], v[36:39], a[164:167], v[16:31]
  s_waitcnt lgkmcnt(2)
  v_mfma_f32_32x32x16_bf16 v[0:15], a[24:27], v[40:43], v[0:15]
  ds_read_b128 v[36:39], v204 offset:2048
  s_add_u32 m0, s67, 42240
  s_nop 0
  buffer_load_dwordx4 v202, s[4:7], s60 offen offset:768 lds
  v_mfma_f32_32x32x16_bf16 v[16:31], v[40:43], a[168:171], v[16:31]
  s_waitcnt lgkmcnt(2)
  v_mfma_f32_32x32x16_bf16 v[0:15], a[28:31], v[44:47], v[0:15]
  ds_read_b128 v[40:43], v205 offset:2048
  s_add_u32 m0, s67, 43136
  s_nop 0
  buffer_load_dwordx4 v202, s[4:7], s60 offen offset:896 lds
  v_mfma_f32_32x32x16_bf16 v[16:31], v[44:47], a[172:175], v[16:31]
  s_waitcnt lgkmcnt(2)
  v_mfma_f32_32x32x16_bf16 v[0:15], a[32:35], v[32:35], v[0:15]
  ds_read_b128 v[44:47], v206 offset:2048
  s_add_u32 m0, s67, 44032
  s_nop 0
  buffer_load_dwordx4 v202, s[4:7], s60 offen offset:1024 lds
  v_mfma_f32_32x32x16_bf16 v[16:31], v[32:35], a[176:179], v[16:31]
  s_waitcnt lgkmcnt(2)
  v_mfma_f32_32x32x16_bf16 v[0:15], a[36:39], v[36:39], v[0:15]
  ds_read_b128 v[32:35], v203 offset:3072
  v_mul_f32 v68, s68, v68
  v_mul_f32 v69, s68, v69
  v_mul_f32 v70, s68, v70
  v_mul_f32 v71, s68, v71
  v_mfma_f32_32x32x16_bf16 v[16:31], v[36:39], a[180:183], v[16:31]
  v_mul_f32 v72, s68, v72
  v_mul_f32 v73, s68, v73
  v_mul_f32 v74, s68, v74
  v_mul_f32 v75, s68, v75
  s_waitcnt lgkmcnt(2)
  v_mfma_f32_32x32x16_bf16 v[0:15], a[40:43], v[40:43], v[0:15]
  ds_read_b128 v[36:39], v204 offset:3072
  v_cvt_pk_bf16_f32 v48, v68, v72
  v_cvt_pk_bf16_f32 v49, v69, v73
  v_cvt_pk_bf16_f32 v50, v70, v74
  v_cvt_pk_bf16_f32 v51, v71, v75
  v_mfma_f32_32x32x16_bf16 v[16:31], v[40:43], a[184:187], v[16:31]
  buffer_store_dwordx4 v[48:51], v216, s[8:11], s72 offen offset:0 sc1
  s_waitcnt lgkmcnt(2)
  v_mfma_f32_32x32x16_bf16 v[0:15], a[44:47], v[44:47], v[0:15]
  ds_read_b128 v[40:43], v205 offset:3072
  v_mfma_f32_32x32x16_bf16 v[16:31], v[44:47], a[188:191], v[16:31]
  s_waitcnt lgkmcnt(2)
  v_mfma_f32_32x32x16_bf16 v[0:15], a[48:51], v[32:35], v[0:15]
  ds_read_b128 v[44:47], v206 offset:3072
  v_mul_f32 v76, s68, v76
  v_mul_f32 v77, s68, v77
  v_mul_f32 v78, s68, v78
  v_mul_f32 v79, s68, v79
  v_mfma_f32_32x32x16_bf16 v[16:31], v[32:35], a[192:195], v[16:31]
  v_mul_f32 v80, s68, v80
  v_mul_f32 v81, s68, v81
  v_mul_f32 v82, s68, v82
  v_mul_f32 v83, s68, v83
  s_waitcnt lgkmcnt(2)
  v_mfma_f32_32x32x16_bf16 v[0:15], a[52:55], v[36:39], v[0:15]
  ds_read_b128 v[32:35], v203 offset:4096
  v_cvt_pk_bf16_f32 v52, v76, v80
  v_cvt_pk_bf16_f32 v53, v77, v81
  v_cvt_pk_bf16_f32 v54, v78, v82
  v_cvt_pk_bf16_f32 v55, v79, v83
  v_mfma_f32_32x32x16_bf16 v[16:31], v[36:39], a[196:199], v[16:31]
  buffer_store_dwordx4 v[52:55], v216, s[8:11], s72 offen offset:256 sc1
  s_waitcnt lgkmcnt(2)
  v_mfma_f32_32x32x16_bf16 v[0:15], a[56:59], v[40:43], v[0:15]
  ds_read_b128 v[36:39], v204 offset:4096
  v_mfma_f32_32x32x16_bf16 v[16:31], v[40:43], a[200:203], v[16:31]
  s_waitcnt lgkmcnt(2)
  v_mfma_f32_32x32x16_bf16 v[0:15], a[60:63], v[44:47], v[0:15]
  ds_read_b128 v[40:43], v205 offset:4096
  v_cvt_pk_bf16_f32 v56, v84, v85
  v_cvt_pk_bf16_f32 v57, v88, v89
  v_cvt_pk_bf16_f32 v58, v92, v93
  v_cvt_pk_bf16_f32 v59, v96, v97
  v_mfma_f32_32x32x16_bf16 v[16:31], v[44:47], a[204:207], v[16:31]
  buffer_store_dwordx4 v[56:59], v217, s[8:11], s64 offen offset:0 sc1
  s_waitcnt lgkmcnt(2)
  v_mfma_f32_32x32x16_bf16 v[0:15], a[64:67], v[32:35], v[0:15]
  ds_read_b128 v[44:47], v206 offset:4096
  v_mfma_f32_32x32x16_bf16 v[16:31], v[32:35], a[208:211], v[16:31]
  s_waitcnt lgkmcnt(2)
  v_mfma_f32_32x32x16_bf16 v[0:15], a[68:71], v[36:39], v[0:15]
  ds_read_b128 v[32:35], v203 offset:5120
  v_cvt_pk_bf16_f32 v60, v86, v87
  v_cvt_pk_bf16_f32 v61, v90, v91
  v_cvt_pk_bf16_f32 v62, v94, v95
  v_cvt_pk_bf16_f32 v63, v98, v99
  v_mfma_f32_32x32x16_bf16 v[16:31], v[36:39], a[212:215], v[16:31]
  buffer_store_dwordx4 v[60:63], v217, s[8:11], s64 offen offset:256 sc1
  s_waitcnt lgkmcnt(2)
  v_mfma_f32_32x32x16_bf16 v[0:15], a[72:75], v[40:43], v[0:15]
  ds_read_b128 v[36:39], v204 offset:5120
  v_mfma_f32_32x32x16_bf16 v[16:31], v[40:43], a[216:219], v[16:31]
  s_waitcnt lgkmcnt(2)
  v_mfma_f32_32x32x16_bf16 v[0:15], a[76:79], v[44:47], v[0:15]
  ds_read_b128 v[40:43], v205 offset:5120
  buffer_store_dwordx4 v[64:67], v201, s[8:11], s73 offen sc1
  v_mfma_f32_32x32x16_bf16 v[16:31], v[44:47], a[220:223], v[16:31]
  s_waitcnt lgkmcnt(2)
  v_mfma_f32_32x32x16_bf16 v[0:15], a[80:83], v[32:35], v[0:15]
  ds_read_b128 v[44:47], v206 offset:5120
  v_mfma_f32_32x32x16_bf16 v[16:31], v[32:35], a[224:227], v[16:31]
  s_waitcnt lgkmcnt(2)
  v_mfma_f32_32x32x16_bf16 v[0:15], a[84:87], v[36:39], v[0:15]
  ds_read_b128 v[32:35], v203 offset:6144
  v_mfma_f32_32x32x16_bf16 v[16:31], v[36:39], a[228:231], v[16:31]
  s_waitcnt lgkmcnt(2)
  v_mfma_f32_32x32x16_bf16 v[0:15], a[88:91], v[40:43], v[0:15]
  ds_read_b128 v[36:39], v204 offset:6144
  v_mfma_f32_32x32x16_bf16 v[16:31], v[40:43], a[232:235], v[16:31]
  s_waitcnt lgkmcnt(2)
  v_mfma_f32_32x32x16_bf16 v[0:15], a[92:95], v[44:47], v[0:15]
  ds_read_b128 v[40:43], v205 offset:6144
  v_mfma_f32_32x32x16_bf16 v[16:31], v[44:47], a[236:239], v[16:31]
  s_waitcnt lgkmcnt(2)
  v_mfma_f32_32x32x16_bf16 v[0:15], a[96:99], v[32:35], v[0:15]
  ds_read_b128 v[44:47], v206 offset:6144
  v_mfma_f32_32x32x16_bf16 v[16:31], v[32:35], a[240:243], v[16:31]
  s_waitcnt lgkmcnt(2)
  v_mfma_f32_32x32x16_bf16 v[0:15], a[100:103], v[36:39], v[0:15]
  ds_read_b128 v[32:35], v203 offset:7168
  v_mfma_f32_32x32x16_bf16 v[16:31], v[36:39], a[244:247], v[16:31]
  s_waitcnt lgkmcnt(2)
  v_mfma_f32_32x32x16_bf16 v[0:15], a[104:107], v[40:43], v[0:15]
  ds_read_b128 v[36:39], v204 offset:7168
  v_mfma_f32_32x32x16_bf16 v[16:31], v[40:43], a[248:251], v[16:31]
  s_waitcnt lgkmcnt(2)
  v_mfma_f32_32x32x16_bf16 v[0:15], a[108:111], v[44:47], v[0:15]
  ds_read_b128 v[40:43], v205 offset:7168
  v_mfma_f32_32x32x16_bf16 v[16:31], v[44:47], a[252:255], v[16:31]
  s_waitcnt lgkmcnt(2)
  v_mfma_f32_32x32x16_bf16 v[0:15], a[112:115], v[32:35], v[0:15]
  ds_read_b128 v[44:47], v206 offset:7168
  v_mfma_f32_32x32x16_bf16 v[16:31], v[32:35], v[224:227], v[16:31]
  s_waitcnt lgkmcnt(2)
  v_mfma_f32_32x32x16_bf16 v[0:15], a[116:119], v[36:39], v[0:15]
  ds_read_b128 v[32:35], v203 offset:8192
  v_mfma_f32_32x32x16_bf16 v[16:31], v[36:39], v[228:231], v[16:31]
  s_waitcnt lgkmcnt(2)
  v_mfma_f32_32x32x16_bf16 v[0:15], a[120:123], v[40:43], v[0:15]
  ds_read_b128 v[36:39], v204 offset:8192
  v_mfma_f32_32x32x16_bf16 v[16:31], v[40:43], v[232:235], v[16:31]
  s_waitcnt lgkmcnt(2)
  v_mfma_f32_32x32x16_bf16 v[0:15], a[124:127], v[44:47], v[0:15]
  ds_read_b128 v[40:43], v205 offset:8192
  v_mfma_f32_32x32x16_bf16 v[16:31], v[44:47], v[236:239], v[16:31]
  s_waitcnt lgkmcnt(2)
  v_mfma_f32_32x32x16_bf16 v[0:15], a[128:131], v[32:35], v[0:15]
  ds_read_b128 v[44:47], v206 offset:8192
  v_mfma_f32_32x32x16_bf16 v[16:31], v[32:35], v[240:243], v[16:31]
  s_waitcnt lgkmcnt(2)
  v_mfma_f32_32x32x16_bf16 v[0:15], a[132:135], v[36:39], v[0:15]
  v_mfma_f32_32x32x16_bf16 v[16:31], v[36:39], v[244:247], v[16:31]
  s_waitcnt lgkmcnt(1)
  v_mfma_f32_32x32x16_bf16 v[0:15], a[136:139], v[40:43], v[0:15]
  v_mfma_f32_32x32x16_bf16 v[16:31], v[40:43], v[248:251], v[16:31]
  s_waitcnt lgkmcnt(0)
  v_mfma_f32_32x32x16_bf16 v[0:15], a[140:143], v[44:47], v[0:15]
  v_mfma_f32_32x32x16_bf16 v[16:31], v[44:47], v[252:255], v[16:31]
  s_mul_i32 s64, s59, 655360
  s_lshl_b32 s55, s58, 14
  s_add_u32 s64, s64, s55
  s_add_u32 s64, s64, 1048576
  s_add_u32 s72, s64, s69
  s_add_u32 s73, s64, s66
  s_add_u32 s59, s59, 7
  s_cmp_ge_u32 s59, 64
  s_cbranch_scc1 KV_done0
  s_sub_u32 s54, s59, 21
  s_cmp_lt_u32 s54, 7
  s_cbranch_scc1 KV_early
  s_waitcnt vmcnt(5)
  s_barrier
KV_cont:
  s_branch KV_loop
KV_early:
  s_waitcnt vmcnt(0)
  s_barrier
  s_cmp_eq_u32 s52, 0
  s_cbranch_scc0 KV_sig0
  v_mov_b32 v211, 1
  v_mov_b32 v212, 0
  s_mov_b64 exec, 1
  buffer_atomic_add v211, v212, s[12:15], s70 offen
  s_mov_b64 exec, -1
KV_sig0:
  s_branch KV_cont
KV_done1:
  s_nop 11
  v_mul_f32 v68, s68, v68
  v_mul_f32 v69, s68, v69
  v_mul_f32 v70, s68, v70
  v_mul_f32 v71, s68, v71
  v_mul_f32 v72, s68, v72
  v_mul_f32 v73, s68, v73
  v_mul_f32 v74, s68, v74
  v_mul_f32 v75, s68, v75
  v_cvt_pk_bf16_f32 v48, v68, v72
  v_cvt_pk_bf16_f32 v49, v69, v73
  v_cvt_pk_bf16_f32 v50, v70, v74
  v_cvt_pk_bf16_f32 v51, v71, v75
  buffer_store_dwordx4 v[48:51], v216, s[8:11], s72 offen offset:0 sc1
  v_mul_f32 v76, s68, v76
  v_mul_f32 v77, s68, v77
  v_mul_f32 v78, s68, v78
  v_mul_f32 v79, s68, v79
  v_mul_f32 v80, s68, v80
  v_mul_f32 v81, s68, v81
  v_mul_f32 v82, s68, v82
  v_mul_f32 v83, s68, v83
  v_cvt_pk_bf16_f32 v52, v76, v80
  v_cvt_pk_bf16_f32 v53, v77, v81
  v_cvt_pk_bf16_f32 v54, v78, v82
  v_cvt_pk_bf16_f32 v55, v79, v83
  buffer_store_dwordx4 v[52:55], v216, s[8:11], s72 offen offset:256 sc1
  v_cvt_pk_bf16_f32 v56, v84, v85
  v_cvt_pk_bf16_f32 v57, v88, v89
  v_cvt_pk_bf16_f32 v58, v92, v93
  v_cvt_pk_bf16_f32 v59, v96, v97
  buffer_store_dwordx4 v[56:59], v217, s[8:11], s64 offen offset:0 sc1
  v_cvt_pk_bf16_f32 v60, v86, v87
  v_cvt_pk_bf16_f32 v61, v90, v91
  v_cvt_pk_bf16_f32 v62, v94, v95
  v_cvt_pk_bf16_f32 v63, v98, v99
  buffer_store_dwordx4 v[60:63], v217, s[8:11], s64 offen offset:256 sc1
  buffer_store_dwordx4 v[64:67], v201, s[8:11], s73 offen sc1
  s_branch KV_fin
KV_done0:
  s_nop 11
  v_mul_f32 v0, s68, v0
  v_mul_f32 v1, s68, v1
  v_mul_f32 v2, s68, v2
  v_mul_f32 v3, s68, v3
  v_mul_f32 v4, s68, v4
  v_mul_f32 v5, s68, v5
  v_mul_f32 v6, s68, v6
  v_mul_f32 v7, s68, v7
  v_cvt_pk_bf16_f32 v48, v0, v4
  v_cvt_pk_bf16_f32 v49, v1, v5
  v_cvt_pk_bf16_f32 v50, v2, v6
  v_cvt_pk_bf16_f32 v51, v3, v7
  buffer_store_dwordx4 v[48:51], v216, s[8:11], s72 offen offset:0 sc1
  v_mul_f32 v8, s68, v8
  v_mul_f32 v9, s68, v9
  v_mul_f32 v10, s68, v10
  v_mul_f32 v11, s68, v11
  v_mul_f32 v12, s68, v12
  v_mul_f32 v13, s68, v13
  v_mul_f32 v14, s68, v14
  v_mul_f32 v15, s68, v15
  v_cvt_pk_bf16_f32 v52, v8, v12
  v_cvt_pk_bf16_f32 v53, v9, v13
  v_cvt_pk_bf16_f32 v54, v10, v14
  v_cvt_pk_bf16_f32 v55, v11, v15
  buffer_store_dwordx4 v[52:55], v216, s[8:11], s72 offen offset:256 sc1
  v_cvt_pk_bf16_f32 v56, v16, v17
  v_cvt_pk_bf16_f32 v57, v20, v21
  v_cvt_pk_bf16_f32 v58, v24, v25
  v_cvt_pk_bf16_f32 v59, v28, v29
  buffer_store_dwordx4 v[56:59], v217, s[8:11], s64 offen offset:0 sc1
  v_cvt_pk_bf16_f32 v60, v18, v19
  v_cvt_pk_bf16_f32 v61, v22, v23
  v_cvt_pk_bf16_f32 v62, v26, v27
  v_cvt_pk_bf16_f32 v63, v30, v31
  buffer_store_dwordx4 v[60:63], v217, s[8:11], s64 offen offset:256 sc1
  buffer_store_dwordx4 v[64:67], v201, s[8:11], s73 offen sc1
KV_fin:
  s_waitcnt vmcnt(0)
  s_barrier
  s_cmp_eq_u32 s52, 0
  s_cbranch_scc0 KV_sig
  v_mov_b32 v211, 256
  v_mov_b32 v212, 0
  s_mov_b64 exec, 1
  buffer_atomic_add v211, v212, s[12:15], s70 offen
  s_mov_b64 exec, -1
KV_sig:
  s_cmp_ge_u32 s53, 192
  s_cbranch_scc1 L_exit
  s_cmp_lt_u32 s53, 64
  s_cbranch_scc1 W_h
  s_sub_u32 s54, s53, 64
  s_lshr_b32 s68, s54, 4
  s_and_b32 s69, s54, 15
  s_lshl_b32 s60, s69, 2
  s_sub_u32 s60, s60, 1
  s_max_i32 s60, s60, 0
  s_mul_i32 s60, s60, 36864
  s_add_u32 m0, s67, 0
  s_nop 0
  buffer_load_dwordx4 v202, s[4:7], s60 offen offset:0 lds
  s_add_u32 m0, s67, 896
  s_nop 0
  buffer_load_dwordx4 v202, s[4:7], s60 offen offset:128 lds
  s_add_u32 m0, s67, 1792
  s_nop 0
  buffer_load_dwordx4 v202, s[4:7], s60 offen offset:256 lds
  s_add_u32 m0, s67, 2688
  s_nop 0
  buffer_load_dwordx4 v202, s[4:7], s60 offen offset:384 lds
  s_add_u32 m0, s67, 3584
  s_nop 0
  buffer_load_dwordx4 v202, s[4:7], s60 offen offset:512 lds
  s_add_u32 m0, s67, 4480
  s_nop 0
  buffer_load_dwordx4 v202, s[4:7], s60 offen offset:640 lds
  s_add_u32 m0, s67, 5376
  s_nop 0
  buffer_load_dwordx4 v202, s[4:7], s60 offen offset:768 lds
  s_add_u32 m0, s67, 6272
  s_nop 0
  buffer_load_dwordx4 v202, s[4:7], s60 offen offset:896 lds
  s_add_u32 m0, s67, 7168
  s_nop 0
  buffer_load_dwordx4 v202, s[4:7], s60 offen offset:1024 lds
  v_and_b32 v211, 15, v200
  v_mul_u32_u24 v211, 72, v211
  v_lshrrev_b32 v212, 4, v200
  v_mul_u32_u24 v213, 1152, v212
  v_add_u32 v213, v213, v211
  s_lshl_b32 s54, s54, 2
  s_add_u32 s70, s54, s52
  s_mul_i32 s55, s70, 4608
  buffer_load_dwordx4 v[48:51], v213, s[4:7], s55 offen offset:0
  buffer_load_dwordx4 v[52:55], v213, s[4:7], s55 offen offset:16
  buffer_load_dwordx4 v[56:59], v213, s[4:7], s55 offen offset:32
  buffer_load_dwordx4 v[60:63], v213, s[4:7], s55 offen offset:48
  buffer_load_dwordx2 v[64:65], v213, s[4:7], s55 offen offset:64
  buffer_load_dwordx4 v[68:71], v211, s[44:47], 0 offen offset:0
  buffer_load_dwordx4 v[72:75], v211, s[44:47], 0 offen offset:16
  buffer_load_dwordx4 v[76:79], v211, s[44:47], 0 offen offset:32
  buffer_load_dwordx4 v[80:83], v211, s[44:47], 0 offen offset:48
  buffer_load_dwordx2 v[84:85], v211, s[44:47], 0 offen offset:64
  v_mov_b32 v0, 0
  v_mov_b32 v1, 0x3f803f80
  s_waitcnt vmcnt(9)
  v_lshlrev_b32 v2, 16, v48
  s_waitcnt vmcnt(4)
  v_lshlrev_b32 v3, 16, v68
  v_and_b32 v4, 0xffff0000, v48
  v_and_b32 v5, 0xffff0000, v68
  v_mul_f32 v2, v2, v3
  v_mul_f32 v4, v4, v5
  v_cvt_pk_bf16_f32 v2, v2, v4
  v_lshlrev_b32 v3, 16, v2
  v_and_b32 v4, 0xffff0000, v2
  v_add_f32 v0, v0, v3
  v_add_f32 v0, v0, v4
  v_lshlrev_b32 v2, 16, v49
  v_lshlrev_b32 v3, 16, v69
  v_and_b32 v4, 0xffff0000, v49
  v_and_b32 v5, 0xffff0000, v69
  v_mul_f32 v2, v2, v3
  v_mul_f32 v4, v4, v5
  v_cvt_pk_bf16_f32 v2, v2, v4
  v_lshlrev_b32 v3, 16, v2
  v_and_b32 v4, 0xffff0000, v2
  v_add_f32 v0, v0, v3
  v_add_f32 v0, v0, v4
  v_lshlrev_b32 v2, 16, v50
  v_lshlrev_b32 v3, 16, v70
  v_and_b32 v4, 0xffff0000, v50
  v_and_b32 v5, 0xffff0000, v70
  v_mul_f32 v2, v2, v3
  v_mul_f32 v4, v4, v5
  v_cvt_pk_bf16_f32 v2, v2, v4
  v_lshlrev_b32 v3, 16, v2
  v_and_b32 v4, 0xffff0000, v2
  v_add_f32 v0, v0, v3
  v_add_f32 v0, v0, v4
  v_lshlrev_b32 v2, 16, v51
  v_lshlrev_b32 v3, 16, v71
  v_and_b32 v4, 0xffff0000, v51
  v_and_b32 v5, 0xffff0000, v71
  v_mul_f32 v2, v2, v3
  v_mul_f32 v4, v4, v5
  v_cvt_pk_bf16_f32 v2, v2, v4
  v_lshlrev_b32 v3, 16, v2
  v_and_b32 v4, 0xffff0000, v2
  v_add_f32 v0, v0, v3
  v_add_f32 v0, v0, v4
  v_lshlrev_b32 v2, 16, v52
  s_waitcnt vmcnt(3)
  v_lshlrev_b32 v3, 16, v72
  v_and_b32 v4, 0xffff0000, v52
  v_and_b32 v5, 0xffff0000, v72
  v_mul_f32 v2, v2, v3
  v_mul_f32 v4, v4, v5
  v_cvt_pk_bf16_f32 v2, v2, v4
  v_lshlrev_b32 v3, 16, v2
  v_and_b32 v4, 0xffff0000, v2
  v_add_f32 v0, v0, v3
  v_add_f32 v0, v0, v4
  v_lshlrev_b32 v2, 16, v53
  v_lshlrev_b32 v3, 16, v73
  v_and_b32 v4, 0xffff0000, v53
  v_and_b32 v5, 0xffff0000, v73
  v_mul_f32 v2, v2, v3
  v_mul_f32 v4, v4, v5
  v_cvt_pk_bf16_f32 v2, v2, v4
  v_lshlrev_b32 v3, 16, v2
  v_and_b32 v4, 0xffff0000, v2
  v_add_f32 v0, v0, v3
  v_add_f32 v0, v0, v4
  v_lshlrev_b32 v2, 16, v54
  v_lshlrev_b32 v3, 16, v74
  v_and_b32 v4, 0xffff0000, v54
  v_and_b32 v5, 0xffff0000, v74
  v_mul_f32 v2, v2, v3
  v_mul_f32 v4, v4, v5
  v_cvt_pk_bf16_f32 v2, v2, v4
  v_lshlrev_b32 v3, 16, v2
  v_and_b32 v4, 0xffff0000, v2
  v_add_f32 v0, v0, v3
  v_add_f32 v0, v0, v4
  v_lshlrev_b32 v2, 16, v55
  v_lshlrev_b32 v3, 16, v75
  v_and_b32 v4, 0xffff0000, v55
  v_and_b32 v5, 0xffff0000, v75
  v_mul_f32 v2, v2, v3
  v_mul_f32 v4, v4, v5
  v_cvt_pk_bf16_f32 v2, v2, v4
  v_lshlrev_b32 v3, 16, v2
  v_and_b32 v4, 0xffff0000, v2
  v_add_f32 v0, v0, v3
  v_add_f32 v0, v0, v4
  v_lshlrev_b32 v2, 16, v56
  s_waitcnt vmcnt(2)
  v_lshlrev_b32 v3, 16, v76
  v_and_b32 v4, 0xffff0000, v56
  v_and_b32 v5, 0xffff0000, v76
  v_mul_f32 v2, v2, v3
  v_mul_f32 v4, v4, v5
  v_cvt_pk_bf16_f32 v2, v2, v4
  v_lshlrev_b32 v3, 16, v2
  v_and_b32 v4, 0xffff0000, v2
  v_add_f32 v0, v0, v3
  v_add_f32 v0, v0, v4
  v_lshlrev_b32 v2, 16, v57
  v_lshlrev_b32 v3, 16, v77
  v_and_b32 v4, 0xffff0000, v57
  v_and_b32 v5, 0xffff0000, v77
  v_mul_f32 v2, v2, v3
  v_mul_f32 v4, v4, v5
  v_cvt_pk_bf16_f32 v2, v2, v4
  v_lshlrev_b32 v3, 16, v2
  v_and_b32 v4, 0xffff0000, v2
  v_add_f32 v0, v0, v3
  v_add_f32 v0, v0, v4
  v_lshlrev_b32 v2, 16, v58
  v_lshlrev_b32 v3, 16, v78
  v_and_b32 v4, 0xffff0000, v58
  v_and_b32 v5, 0xffff0000, v78
  v_mul_f32 v2, v2, v3
  v_mul_f32 v4, v4, v5
  v_cvt_pk_bf16_f32 v2, v2, v4
  v_lshlrev_b32 v3, 16, v2
  v_and_b32 v4, 0xffff0000, v2
  v_add_f32 v0, v0, v3
  v_add_f32 v0, v0, v4
  v_lshlrev_b32 v2, 16, v59
  v_lshlrev_b32 v3, 16, v79
  v_and_b32 v4, 0xffff0000, v59
  v_and_b32 v5, 0xffff0000, v79
  v_mul_f32 v2, v2, v3
  v_mul_f32 v4, v4, v5
  v_cvt_pk_bf16_f32 v2, v2, v4
  v_lshlrev_b32 v3, 16, v2
  v_and_b32 v4, 0xffff0000, v2
  v_add_f32 v0, v0, v3
  v_add_f32 v0, v0, v4
  v_lshlrev_b32 v2, 16, v60
  s_waitcnt vmcnt(1)
  v_lshlrev_b32 v3, 16, v80
  v_and_b32 v4, 0xffff0000, v60
  v_and_b32 v5, 0xffff0000, v80
  v_mul_f32 v2, v2, v3
  v_mul_f32 v4, v4, v5
  v_cvt_pk_bf16_f32 v2, v2, v4
  v_lshlrev_b32 v3, 16, v2
  v_and_b32 v4, 0xffff0000, v2
  v_add_f32 v0, v0, v3
  v_add_f32 v0, v0, v4
  v_lshlrev_b32 v2, 16, v61
  v_lshlrev_b32 v3, 16, v81
  v_and_b32 v4, 0xffff0000, v61
  v_and_b32 v5, 0xffff0000, v81
  v_mul_f32 v2, v2, v3
  v_mul_f32 v4, v4, v5
  v_cvt_pk_bf16_f32 v2, v2, v4
  v_lshlrev_b32 v3, 16, v2
  v_and_b32 v4, 0xffff0000, v2
  v_add_f32 v0, v0, v3
  v_add_f32 v0, v0, v4
  v_lshlrev_b32 v2, 16, v62
  v_lshlrev_b32 v3, 16, v82
  v_and_b32 v4, 0xffff0000, v62
  v_and_b32 v5, 0xffff0000, v82
  v_mul_f32 v2, v2, v3
  v_mul_f32 v4, v4, v5
  v_cvt_pk_bf16_f32 v2, v2, v4
  v_lshlrev_b32 v3, 16, v2
  v_and_b32 v4, 0xffff0000, v2
  v_add_f32 v0, v0, v3
  v_add_f32 v0, v0, v4
  v_lshlrev_b32 v2, 16, v63
  v_lshlrev_b32 v3, 16, v83
  v_and_b32 v4, 0xffff0000, v63
  v_and_b32 v5, 0xffff0000, v83
  v_mul_f32 v2, v2, v3
  v_mul_f32 v4, v4, v5
  v_cvt_pk_bf16_f32 v2, v2, v4
  v_lshlrev_b32 v3, 16, v2
  v_and_b32 v4, 0xffff0000, v2
  v_add_f32 v0, v0, v3
  v_add_f32 v0, v0, v4
  v_lshlrev_b32 v2, 16, v64
  s_waitcnt vmcnt(0)
  v_lshlrev_b32 v3, 16, v84
  v_and_b32 v4, 0xffff0000, v64
  v_and_b32 v5, 0xffff0000, v84
  v_mul_f32 v2, v2, v3
  v_mul_f32 v4, v4, v5
  v_cvt_pk_bf16_f32 v2, v2, v4
  v_lshlrev_b32 v3, 16, v2
  v_and_b32 v4, 0xffff0000, v2
  v_add_f32 v0, v0, v3
  v_add_f32 v0, v0, v4
  v_lshlrev_b32 v2, 16, v65
  v_lshlrev_b32 v3, 16, v85
  v_and_b32 v4, 0xffff0000, v65
  v_and_b32 v5, 0xffff0000, v85
  v_mul_f32 v2, v2, v3
  v_mul_f32 v4, v4, v5
  v_cvt_pk_bf16_f32 v2, v2, v4
  v_lshlrev_b32 v3, 16, v2
  v_and_b32 v4, 0xffff0000, v2
  v_add_f32 v0, v0, v3
  v_add_f32 v0, v0, v4
  s_nop 1
  v_add_f32_dpp v0, v0, v0 row_ror:1 row_mask:0xf bank_mask:0xf
  s_nop 1
  v_add_f32_dpp v0, v0, v0 row_ror:2 row_mask:0xf bank_mask:0xf
  s_nop 1
  v_add_f32_dpp v0, v0, v0 row_ror:4 row_mask:0xf bank_mask:0xf
  s_nop 1
  v_add_f32_dpp v0, v0, v0 row_ror:8 row_mask:0xf bank_mask:0xf
  v_cvt_pk_bf16_f32 v0, v0, v0
  v_lshlrev_b32 v0, 16, v0
  v_mul_f32 v0, 3216550459, v0
  v_exp_f32 v0, v0
  s_nop 0
  v_add_f32 v0, 1.0, v0
  v_rcp_f32 v0, v0
  s_nop 0
  v_cvt_pk_bf16_f32 v0, v0, v0
  v_lshlrev_b32 v0, 16, v0
  v_lshlrev_b32 v212, 2, v212
  s_lshl_b32 s55, s70, 4
  s_add_u32 s55, s55, 66060288
  s_mov_b32 exec_lo, 0x00010001
  s_mov_b32 exec_hi, 0x00010001
  buffer_store_dword v0, v212, s[8:11], s55 offen sc1
  s_mov_b64 exec, -1
  v_lshrrev_b32 v211, 4, v200
  v_lshlrev_b32 v212, 2, v211
  v_and_b32 v213, 15, v200
  v_xor_b32 v212, v212, v213
  v_mul_u32_u24 v211, 3456, v211
  v_mov_b32 v2, 0x40000000
  v_add_u32 v213, 0, v212
  v_mul_u32_u24 v214, 57, v213
  v_lshrrev_b32 v214, 9, v214
  v_mul_u32_u24 v214, 1008, v214
  v_lshl_add_u32 v214, v213, 4, v214
  v_add_u32 v214, v214, v211
  v_cmp_lt_u32 vcc, 26, v213
  s_nop 1
  v_cndmask_b32 v207, v214, v2, vcc
  v_add_u32 v213, 16, v212
  v_mul_u32_u24 v214, 57, v213
  v_lshrrev_b32 v214, 9, v214
  v_mul_u32_u24 v214, 1008, v214
  v_lshl_add_u32 v214, v213, 4, v214
  v_add_u32 v214, v214, v211
  v_cmp_lt_u32 vcc, 26, v213
  s_nop 1
  v_cndmask_b32 v208, v214, v2, vcc
  s_mul_i32 s62, s68, 144
  s_mul_i32 s54, s52, 13824
  s_add_u32 s62, s62, s54
  s_waitcnt vmcnt(0)
  s_lshl_b32 s61, s52, 10
  s_add_u32 s61, s61, 36864
  s_add_u32 m0, s61, 0
  s_add_u32 s54, s62, 0
  buffer_load_dwordx4 v207, s[36:39], s54 offen lds
  s_add_u32 m0, s61, 4096
  s_add_u32 s54, s62, 55296
  buffer_load_dwordx4 v207, s[36:39], s54 offen lds
  s_add_u32 m0, s61, 8192
  s_add_u32 s54, s62, 110592
  buffer_load_dwordx4 v207, s[36:39], s54 offen lds
  s_add_u32 m0, s61, 12288
  s_add_u32 s54, s62, 165888
  buffer_load_dwordx4 v207, s[36:39], s54 offen lds
  s_add_u32 m0, s61, 16384
  s_add_u32 s54, s62, 0
  buffer_load_dwordx4 v208, s[36:39], s54 offen lds
  s_add_u32 m0, s61, 20480
  s_add_u32 s54, s62, 55296
  buffer_load_dwordx4 v208, s[36:39], s54 offen lds
  s_add_u32 m0, s61, 24576
  s_add_u32 s54, s62, 110592
  buffer_load_dwordx4 v208, s[36:39], s54 offen lds
  s_add_u32 m0, s61, 28672
  s_add_u32 s54, s62, 165888
  buffer_load_dwordx4 v208, s[36:39], s54 offen lds
  s_add_u32 m0, s61, 32768
  s_add_u32 s54, s62, 221184
  buffer_load_dwordx4 v207, s[36:39], s54 offen lds
  s_add_u32 m0, s61, 36864
  s_add_u32 s54, s62, 276480
  buffer_load_dwordx4 v207, s[36:39], s54 offen lds
  s_add_u32 m0, s61, 40960
  s_add_u32 s54, s62, 331776
  buffer_load_dwordx4 v207, s[36:39], s54 offen lds
  s_add_u32 m0, s61, 45056
  s_add_u32 s54, s62, 387072
  buffer_load_dwordx4 v207, s[36:39], s54 offen lds
  s_add_u32 m0, s61, 49152
  s_add_u32 s54, s62, 221184
  buffer_load_dwordx4 v208, s[36:39], s54 offen lds
  s_add_u32 m0, s61, 53248
  s_add_u32 s54, s62, 276480
  buffer_load_dwordx4 v208, s[36:39], s54 offen lds
  s_add_u32 m0, s61, 57344
  s_add_u32 s54, s62, 331776
  buffer_load_dwordx4 v208, s[36:39], s54 offen lds
  s_add_u32 m0, s61, 61440
  s_add_u32 s54, s62, 387072
  buffer_load_dwordx4 v208, s[36:39], s54 offen lds
  s_add_u32 m0, s61, 65536
  s_add_u32 s54, s62, 442368
  buffer_load_dwordx4 v207, s[36:39], s54 offen lds
  s_add_u32 m0, s61, 69632
  s_add_u32 s54, s62, 497664
  buffer_load_dwordx4 v207, s[36:39], s54 offen lds
  s_add_u32 m0, s61, 73728
  s_add_u32 s54, s62, 552960
  buffer_load_dwordx4 v207, s[36:39], s54 offen lds
  s_add_u32 m0, s61, 77824
  s_add_u32 s54, s62, 608256
  buffer_load_dwordx4 v207, s[36:39], s54 offen lds
  s_add_u32 m0, s61, 81920
  s_add_u32 s54, s62, 442368
  buffer_load_dwordx4 v208, s[36:39], s54 offen lds
  s_add_u32 m0, s61, 86016
  s_add_u32 s54, s62, 497664
  buffer_load_dwordx4 v208, s[36:39], s54 offen lds
  s_add_u32 m0, s61, 90112
  s_add_u32 s54, s62, 552960
  buffer_load_dwordx4 v208, s[36:39], s54 offen lds
  s_add_u32 m0, s61, 94208
  s_add_u32 s54, s62, 608256
  buffer_load_dwordx4 v208, s[36:39], s54 offen lds
  s_waitcnt vmcnt(20) lgkmcnt(0)
  s_barrier
  s_add_u32 m0, s61, 98304
  s_add_u32 s54, s62, 663552
  buffer_load_dwordx4 v207, s[36:39], s54 offen lds
  s_add_u32 m0, s61, 102400
  s_add_u32 s54, s62, 718848
  buffer_load_dwordx4 v207, s[36:39], s54 offen lds
  s_add_u32 m0, s61, 106496
  s_add_u32 s54, s62, 774144
  buffer_load_dwordx4 v207, s[36:39], s54 offen lds
  s_add_u32 m0, s61, 110592
  s_add_u32 s54, s62, 829440
  buffer_load_dwordx4 v207, s[36:39], s54 offen lds
  v_add_u32 v215, 36864, v210
  ds_read_b64_tr_b16 a[0:1], v215 offset:0
  ds_read_b64_tr_b16 a[2:3], v215 offset:1024
  ds_read_b64_tr_b16 a[4:5], v215 offset:4096
  ds_read_b64_tr_b16 a[6:7], v215 offset:5120
  ds_read_b64_tr_b16 a[8:9], v215 offset:8192
  ds_read_b64_tr_b16 a[10:11], v215 offset:9216
  ds_read_b64_tr_b16 a[12:13], v215 offset:12288
  ds_read_b64_tr_b16 a[14:15], v215 offset:13312
  s_waitcnt vmcnt(20) lgkmcnt(0)
  s_barrier
  s_add_u32 m0, s61, 0
  s_add_u32 s54, s62, 663552
  buffer_load_dwordx4 v208, s[36:39], s54 offen lds
  s_add_u32 m0, s61, 4096
  s_add_u32 s54, s62, 718848
  buffer_load_dwordx4 v208, s[36:39], s54 offen lds
  s_add_u32 m0, s61, 8192
  s_add_u32 s54, s62, 774144
  buffer_load_dwordx4 v208, s[36:39], s54 offen lds
  s_add_u32 m0, s61, 12288
  s_add_u32 s54, s62, 829440
  buffer_load_dwordx4 v208, s[36:39], s54 offen lds
  v_add_u32 v215, 53248, v210
  ds_read_b64_tr_b16 a[144:145], v215 offset:0
  ds_read_b64_tr_b16 a[146:147], v215 offset:1024
  ds_read_b64_tr_b16 a[148:149], v215 offset:4096
  ds_read_b64_tr_b16 a[150:151], v215 offset:5120
  ds_read_b64_tr_b16 a[152:153], v215 offset:8192
  ds_read_b64_tr_b16 a[154:155], v215 offset:9216
  ds_read_b64_tr_b16 a[156:157], v215 offset:12288
  ds_read_b64_tr_b16 a[158:159], v215 offset:13312
  s_waitcnt vmcnt(20) lgkmcnt(0)
  s_barrier
  s_add_u32 m0, s61, 16384
  s_add_u32 s54, s62, 884736
  buffer_load_dwordx4 v207, s[36:39], s54 offen lds
  s_add_u32 m0, s61, 20480
  s_add_u32 s54, s62, 940032
  buffer_load_dwordx4 v207, s[36:39], s54 offen lds
  s_add_u32 m0, s61, 24576
  s_add_u32 s54, s62, 995328
  buffer_load_dwordx4 v207, s[36:39], s54 offen lds
  s_add_u32 m0, s61, 28672
  s_add_u32 s54, s62, 1050624
  buffer_load_dwordx4 v207, s[36:39], s54 offen lds
  v_add_u32 v215, 69632, v210
  ds_read_b64_tr_b16 a[16:17], v215 offset:0
  ds_read_b64_tr_b16 a[18:19], v215 offset:1024
  ds_read_b64_tr_b16 a[20:21], v215 offset:4096
  ds_read_b64_tr_b16 a[22:23], v215 offset:5120
  ds_read_b64_tr_b16 a[24:25], v215 offset:8192
  ds_read_b64_tr_b16 a[26:27], v215 offset:9216
  ds_read_b64_tr_b16 a[28:29], v215 offset:12288
  ds_read_b64_tr_b16 a[30:31], v215 offset:13312
  s_waitcnt vmcnt(20) lgkmcnt(0)
  s_barrier
  s_add_u32 m0, s61, 32768
  s_add_u32 s54, s62, 884736
  buffer_load_dwordx4 v208, s[36:39], s54 offen lds
  s_add_u32 m0, s61, 36864
  s_add_u32 s54, s62, 940032
  buffer_load_dwordx4 v208, s[36:39], s54 offen lds
  s_add_u32 m0, s61, 40960
  s_add_u32 s54, s62, 995328
  buffer_load_dwordx4 v208, s[36:39], s54 offen lds
  s_add_u32 m0, s61, 45056
  s_add_u32 s54, s62, 1050624
  buffer_load_dwordx4 v208, s[36:39], s54 offen lds
  v_add_u32 v215, 86016, v210
  ds_read_b64_tr_b16 a[160:161], v215 offset:0
  ds_read_b64_tr_b16 a[162:163], v215 offset:1024
  ds_read_b64_tr_b16 a[164:165], v215 offset:4096
  ds_read_b64_tr_b16 a[166:167], v215 offset:5120
  ds_read_b64_tr_b16 a[168:169], v215 offset:8192
  ds_read_b64_tr_b16 a[170:171], v215 offset:9216
  ds_read_b64_tr_b16 a[172:173], v215 offset:12288
  ds_read_b64_tr_b16 a[174:175], v215 offset:13312
  s_waitcnt vmcnt(20) lgkmcnt(0)
  s_barrier
  s_add_u32 m0, s61, 49152
  s_add_u32 s54, s62, 1105920
  buffer_load_dwordx4 v207, s[36:39], s54 offen lds
  s_add_u32 m0, s61, 53248
  s_add_u32 s54, s62, 1161216
  buffer_load_dwordx4 v207, s[36:39], s54 offen lds
  s_add_u32 m0, s61, 57344
  s_add_u32 s54, s62, 1216512
  buffer_load_dwordx4 v207, s[36:39], s54 offen lds
  s_add_u32 m0, s61, 61440
  s_add_u32 s54, s62, 1271808
  buffer_load_dwordx4 v207, s[36:39], s54 offen lds
  v_add_u32 v215, 102400, v210
  ds_read_b64_tr_b16 a[32:33], v215 offset:0
  ds_read_b64_tr_b16 a[34:35], v215 offset:1024
  ds_read_b64_tr_b16 a[36:37], v215 offset:4096
  ds_read_b64_tr_b16 a[38:39], v215 offset:5120
  ds_read_b64_tr_b16 a[40:41], v215 offset:8192
  ds_read_b64_tr_b16 a[42:43], v215 offset:9216
  ds_read_b64_tr_b16 a[44:45], v215 offset:12288
  ds_read_b64_tr_b16 a[46:47], v215 offset:13312
  s_waitcnt vmcnt(20) lgkmcnt(0)
  s_barrier
  s_add_u32 m0, s61, 65536
  s_add_u32 s54, s62, 1105920
  buffer_load_dwordx4 v208, s[36:39], s54 offen lds
  s_add_u32 m0, s61, 69632
  s_add_u32 s54, s62, 1161216
  buffer_load_dwordx4 v208, s[36:39], s54 offen lds
  s_add_u32 m0, s61, 73728
  s_add_u32 s54, s62, 1216512
  buffer_load_dwordx4 v208, s[36:39], s54 offen lds
  s_add_u32 m0, s61, 77824
  s_add_u32 s54, s62, 1271808
  buffer_load_dwordx4 v208, s[36:39], s54 offen lds
  v_add_u32 v215, 118784, v210
  ds_read_b64_tr_b16 a[176:177], v215 offset:0
  ds_read_b64_tr_b16 a[178:179], v215 offset:1024
  ds_read_b64_tr_b16 a[180:181], v215 offset:4096
  ds_read_b64_tr_b16 a[182:183], v215 offset:5120
  ds_read_b64_tr_b16 a[184:185], v215 offset:8192
  ds_read_b64_tr_b16 a[186:187], v215 offset:9216
  ds_read_b64_tr_b16 a[188:189], v215 offset:12288
  ds_read_b64_tr_b16 a[190:191], v215 offset:13312
  s_waitcnt vmcnt(20) lgkmcnt(0)
  s_barrier
  s_add_u32 m0, s61, 81920
  s_add_u32 s54, s62, 1327104
  buffer_load_dwordx4 v207, s[36:39], s54 offen lds
  s_add_u32 m0, s61, 86016
  s_add_u32 s54, s62, 1382400
  buffer_load_dwordx4 v207, s[36:39], s54 offen lds
  s_add_u32 m0, s61, 90112
  s_add_u32 s54, s62, 1437696
  buffer_load_dwordx4 v207, s[36:39], s54 offen lds
  s_add_u32 m0, s61, 94208
  s_add_u32 s54, s62, 1492992
  buffer_load_dwordx4 v207, s[36:39], s54 offen lds
  v_add_u32 v215, 135168, v210
  ds_read_b64_tr_b16 a[48:49], v215 offset:0
  ds_read_b64_tr_b16 a[50:51], v215 offset:1024
  ds_read_b64_tr_b16 a[52:53], v215 offset:4096
  ds_read_b64_tr_b16 a[54:55], v215 offset:5120
  ds_read_b64_tr_b16 a[56:57], v215 offset:8192
  ds_read_b64_tr_b16 a[58:59], v215 offset:9216
  ds_read_b64_tr_b16 a[60:61], v215 offset:12288
  ds_read_b64_tr_b16 a[62:63], v215 offset:13312
  s_waitcnt vmcnt(20) lgkmcnt(0)
  s_barrier
  s_add_u32 m0, s61, 98304
  s_add_u32 s54, s62, 1327104
  buffer_load_dwordx4 v208, s[36:39], s54 offen lds
  s_add_u32 m0, s61, 102400
  s_add_u32 s54, s62, 1382400
  buffer_load_dwordx4 v208, s[36:39], s54 offen lds
  s_add_u32 m0, s61, 106496
  s_add_u32 s54, s62, 1437696
  buffer_load_dwordx4 v208, s[36:39], s54 offen lds
  s_add_u32 m0, s61, 110592
  s_add_u32 s54, s62, 1492992
  buffer_load_dwordx4 v208, s[36:39], s54 offen lds
  v_add_u32 v215, 36864, v210
  ds_read_b64_tr_b16 a[192:193], v215 offset:0
  ds_read_b64_tr_b16 a[194:195], v215 offset:1024
  ds_read_b64_tr_b16 a[196:197], v215 offset:4096
  ds_read_b64_tr_b16 a[198:199], v215 offset:5120
  ds_read_b64_tr_b16 a[200:201], v215 offset:8192
  ds_read_b64_tr_b16 a[202:203], v215 offset:9216
  ds_read_b64_tr_b16 a[204:205], v215 offset:12288
  ds_read_b64_tr_b16 a[206:207], v215 offset:13312
  s_waitcnt vmcnt(20) lgkmcnt(0)
  s_barrier
  s_add_u32 m0, s61, 0
  s_add_u32 s54, s62, 1548288
  buffer_load_dwordx4 v207, s[36:39], s54 offen lds
  s_add_u32 m0, s61, 4096
  s_add_u32 s54, s62, 1603584
  buffer_load_dwordx4 v207, s[36:39], s54 offen lds
  s_add_u32 m0, s61, 8192
  s_add_u32 s54, s62, 1658880
  buffer_load_dwordx4 v207, s[36:39], s54 offen lds
  s_add_u32 m0, s61, 12288
  s_add_u32 s54, s62, 1714176
  buffer_load_dwordx4 v207, s[36:39], s54 offen lds
  v_add_u32 v215, 53248, v210
  ds_read_b64_tr_b16 a[64:65], v215 offset:0
  ds_read_b64_tr_b16 a[66:67], v215 offset:1024
  ds_read_b64_tr_b16 a[68:69], v215 offset:4096
  ds_read_b64_tr_b16 a[70:71], v215 offset:5120
  ds_read_b64_tr_b16 a[72:73], v215 offset:8192
  ds_read_b64_tr_b16 a[74:75], v215 offset:9216
  ds_read_b64_tr_b16 a[76:77], v215 offset:12288
  ds_read_b64_tr_b16 a[78:79], v215 offset:13312
  s_waitcnt vmcnt(20) lgkmcnt(0)
  s_barrier
  s_add_u32 m0, s61, 16384
  s_add_u32 s54, s62, 1548288
  buffer_load_dwordx4 v208, s[36:39], s54 offen lds
  s_add_u32 m0, s61, 20480
  s_add_u32 s54, s62, 1603584
  buffer_load_dwordx4 v208, s[36:39], s54 offen lds
  s_add_u32 m0, s61, 24576
  s_add_u32 s54, s62, 1658880
  buffer_load_dwordx4 v208, s[36:39], s54 offen lds
  s_add_u32 m0, s61, 28672
  s_add_u32 s54, s62, 1714176
  buffer_load_dwordx4 v208, s[36:39], s54 offen lds
  v_add_u32 v215, 69632, v210
  ds_read_b64_tr_b16 a[208:209], v215 offset:0
  ds_read_b64_tr_b16 a[210:211], v215 offset:1024
  ds_read_b64_tr_b16 a[212:213], v215 offset:4096
  ds_read_b64_tr_b16 a[214:215], v215 offset:5120
  ds_read_b64_tr_b16 a[216:217], v215 offset:8192
  ds_read_b64_tr_b16 a[218:219], v215 offset:9216
  ds_read_b64_tr_b16 a[220:221], v215 offset:12288
  ds_read_b64_tr_b16 a[222:223], v215 offset:13312
  s_waitcnt vmcnt(20) lgkmcnt(0)
  s_barrier
  s_add_u32 m0, s61, 32768
  s_add_u32 s54, s62, 1769472
  buffer_load_dwordx4 v207, s[36:39], s54 offen lds
  s_add_u32 m0, s61, 36864
  s_add_u32 s54, s62, 1824768
  buffer_load_dwordx4 v207, s[36:39], s54 offen lds
  s_add_u32 m0, s61, 40960
  s_add_u32 s54, s62, 1880064
  buffer_load_dwordx4 v207, s[36:39], s54 offen lds
  s_add_u32 m0, s61, 45056
  s_add_u32 s54, s62, 1935360
  buffer_load_dwordx4 v207, s[36:39], s54 offen lds
  v_add_u32 v215, 86016, v210
  ds_read_b64_tr_b16 a[80:81], v215 offset:0
  ds_read_b64_tr_b16 a[82:83], v215 offset:1024
  ds_read_b64_tr_b16 a[84:85], v215 offset:4096
  ds_read_b64_tr_b16 a[86:87], v215 offset:5120
  ds_read_b64_tr_b16 a[88:89], v215 offset:8192
  ds_read_b64_tr_b16 a[90:91], v215 offset:9216
  ds_read_b64_tr_b16 a[92:93], v215 offset:12288
  ds_read_b64_tr_b16 a[94:95], v215 offset:13312
  s_waitcnt vmcnt(20) lgkmcnt(0)
  s_barrier
  s_add_u32 m0, s61, 49152
  s_add_u32 s54, s62, 1769472
  buffer_load_dwordx4 v208, s[36:39], s54 offen lds
  s_add_u32 m0, s61, 53248
  s_add_u32 s54, s62, 1824768
  buffer_load_dwordx4 v208, s[36:39], s54 offen lds
  s_add_u32 m0, s61, 57344
  s_add_u32 s54, s62, 1880064
  buffer_load_dwordx4 v208, s[36:39], s54 offen lds
  s_add_u32 m0, s61, 61440
  s_add_u32 s54, s62, 1935360
  buffer_load_dwordx4 v208, s[36:39], s54 offen lds
  v_add_u32 v215, 102400, v210
  ds_read_b64_tr_b16 a[224:225], v215 offset:0
  ds_read_b64_tr_b16 a[226:227], v215 offset:1024
  ds_read_b64_tr_b16 a[228:229], v215 offset:4096
  ds_read_b64_tr_b16 a[230:231], v215 offset:5120
  ds_read_b64_tr_b16 a[232:233], v215 offset:8192
  ds_read_b64_tr_b16 a[234:235], v215 offset:9216
  ds_read_b64_tr_b16 a[236:237], v215 offset:12288
  ds_read_b64_tr_b16 a[238:239], v215 offset:13312
  s_waitcnt vmcnt(20) lgkmcnt(0)
  s_barrier
  v_add_u32 v215, 118784, v210
  ds_read_b64_tr_b16 a[96:97], v215 offset:0
  ds_read_b64_tr_b16 a[98:99], v215 offset:1024
  ds_read_b64_tr_b16 a[100:101], v215 offset:4096
  ds_read_b64_tr_b16 a[102:103], v215 offset:5120
  ds_read_b64_tr_b16 a[104:105], v215 offset:8192
  ds_read_b64_tr_b16 a[106:107], v215 offset:9216
  ds_read_b64_tr_b16 a[108:109], v215 offset:12288
  ds_read_b64_tr_b16 a[110:111], v215 offset:13312
  s_waitcnt vmcnt(16) lgkmcnt(0)
  s_barrier
  v_add_u32 v215, 135168, v210
  ds_read_b64_tr_b16 a[240:241], v215 offset:0
  ds_read_b64_tr_b16 a[242:243], v215 offset:1024
  ds_read_b64_tr_b16 a[244:245], v215 offset:4096
  ds_read_b64_tr_b16 a[246:247], v215 offset:5120
  ds_read_b64_tr_b16 a[248:249], v215 offset:8192
  ds_read_b64_tr_b16 a[250:251], v215 offset:9216
  ds_read_b64_tr_b16 a[252:253], v215 offset:12288
  ds_read_b64_tr_b16 a[254:255], v215 offset:13312
  s_waitcnt vmcnt(12) lgkmcnt(0)
  s_barrier
  v_add_u32 v215, 36864, v210
  ds_read_b64_tr_b16 a[112:113], v215 offset:0
  ds_read_b64_tr_b16 a[114:115], v215 offset:1024
  ds_read_b64_tr_b16 a[116:117], v215 offset:4096
  ds_read_b64_tr_b16 a[118:119], v215 offset:5120
  ds_read_b64_tr_b16 a[120:121], v215 offset:8192
  ds_read_b64_tr_b16 a[122:123], v215 offset:9216
  ds_read_b64_tr_b16 a[124:125], v215 offset:12288
  ds_read_b64_tr_b16 a[126:127], v215 offset:13312
  s_waitcnt vmcnt(8) lgkmcnt(0)
  s_barrier
  v_add_u32 v215, 53248, v210
  ds_read_b64_tr_b16 v[224:225], v215 offset:0
  ds_read_b64_tr_b16 v[226:227], v215 offset:1024
  ds_read_b64_tr_b16 v[228:229], v215 offset:4096
  ds_read_b64_tr_b16 v[230:231], v215 offset:5120
  ds_read_b64_tr_b16 v[232:233], v215 offset:8192
  ds_read_b64_tr_b16 v[234:235], v215 offset:9216
  ds_read_b64_tr_b16 v[236:237], v215 offset:12288
  ds_read_b64_tr_b16 v[238:239], v215 offset:13312
  s_waitcnt vmcnt(4) lgkmcnt(0)
  s_barrier
  v_add_u32 v215, 69632, v210
  ds_read_b64_tr_b16 a[128:129], v215 offset:0
  ds_read_b64_tr_b16 a[130:131], v215 offset:1024
  ds_read_b64_tr_b16 a[132:133], v215 offset:4096
  ds_read_b64_tr_b16 a[134:135], v215 offset:5120
  ds_read_b64_tr_b16 a[136:137], v215 offset:8192
  ds_read_b64_tr_b16 a[138:139], v215 offset:9216
  ds_read_b64_tr_b16 a[140:141], v215 offset:12288
  ds_read_b64_tr_b16 a[142:143], v215 offset:13312
  s_waitcnt vmcnt(0) lgkmcnt(0)
  s_barrier
  v_add_u32 v215, 86016, v210
  ds_read_b64_tr_b16 v[240:241], v215 offset:0
  ds_read_b64_tr_b16 v[242:243], v215 offset:1024
  ds_read_b64_tr_b16 v[244:245], v215 offset:4096
  ds_read_b64_tr_b16 v[246:247], v215 offset:5120
  ds_read_b64_tr_b16 v[248:249], v215 offset:8192
  ds_read_b64_tr_b16 v[250:251], v215 offset:9216
  ds_read_b64_tr_b16 v[252:253], v215 offset:12288
  ds_read_b64_tr_b16 v[254:255], v215 offset:13312
  s_waitcnt lgkmcnt(0)
  s_barrier
  v_and_b32 v211, 31, v200
  v_mul_u32_u24 v218, 516, v211
  v_lshrrev_b32 v212, 5, v200
  v_lshl_add_u32 v218, v212, 3, v218
  s_lshl_b32 s54, s52, 6
  s_add_u32 s54, s54, 73728
  v_add_u32 v218, s54, v218
  s_lshl_b32 s60, s69, 2
  s_mul_i32 s60, s60, 36864
  ds_read_b128 v[32:35], v203 offset:0
  ds_read_b128 v[36:39], v204 offset:0
  ds_read_b128 v[40:43], v205 offset:0
  s_waitcnt lgkmcnt(2)
  v_mfma_f32_32x32x16_bf16 v[0:15], a[0:3], v[32:35], 0
  ds_read_b128 v[44:47], v206 offset:0
  s_add_u32 m0, s67, 36864
  s_nop 0
  buffer_load_dwordx4 v202, s[4:7], s60 offen offset:0 lds
  v_mfma_f32_32x32x16_bf16 v[16:31], a[144:147], v[32:35], 0
  s_waitcnt lgkmcnt(2)
  v_mfma_f32_32x32x16_bf16 v[0:15], a[4:7], v[36:39], v[0:15]
  ds_read_b128 v[32:35], v203 offset:1024
  s_add_u32 m0, s67, 37760
  s_nop 0
  buffer_load_dwordx4 v202, s[4:7], s60 offen offset:128 lds
  v_mfma_f32_32x32x16_bf16 v[16:31], a[148:151], v[36:39], v[16:31]
  s_waitcnt lgkmcnt(2)
  v_mfma_f32_32x32x16_bf16 v[0:15], a[8:11], v[40:43], v[0:15]
  ds_read_b128 v[36:39], v204 offset:1024
  s_add_u32 m0, s67, 38656
  s_nop 0
  buffer_load_dwordx4 v202, s[4:7], s60 offen offset:256 lds
  v_mfma_f32_32x32x16_bf16 v[16:31], a[152:155], v[40:43], v[16:31]
  s_waitcnt lgkmcnt(2)
  v_mfma_f32_32x32x16_bf16 v[0:15], a[12:15], v[44:47], v[0:15]
  ds_read_b128 v[40:43], v205 offset:1024
  s_add_u32 m0, s67, 39552
  s_nop 0
  buffer_load_dwordx4 v202, s[4:7], s60 offen offset:384 lds
  v_mfma_f32_32x32x16_bf16 v[16:31], a[156:159], v[44:47], v[16:31]
  s_waitcnt lgkmcnt(2)
  v_mfma_f32_32x32x16_bf16 v[0:15], a[16:19], v[32:35], v[0:15]
  ds_read_b128 v[44:47], v206 offset:1024
  s_add_u32 m0, s67, 40448
  s_nop 0
  buffer_load_dwordx4 v202, s[4:7], s60 offen offset:512 lds
  v_mfma_f32_32x32x16_bf16 v[16:31], a[160:163], v[32:35], v[16:31]
  s_waitcnt lgkmcnt(2)
  v_mfma_f32_32x32x16_bf16 v[0:15], a[20:23], v[36:39], v[0:15]
  ds_read_b128 v[32:35], v203 offset:2048
  s_add_u32 m0, s67, 41344
  s_nop 0
  buffer_load_dwordx4 v202, s[4:7], s60 offen offset:640 lds
  v_mfma_f32_32x32x16_bf16 v[16:31], a[164:167], v[36:39], v[16:31]
  s_waitcnt lgkmcnt(2)
  v_mfma_f32_32x32x16_bf16 v[0:15], a[24:27], v[40:43], v[0:15]
  ds_read_b128 v[36:39], v204 offset:2048
  s_add_u32 m0, s67, 42240
  s_nop 0
  buffer_load_dwordx4 v202, s[4:7], s60 offen offset:768 lds
  v_mfma_f32_32x32x16_bf16 v[16:31], a[168:171], v[40:43], v[16:31]
  s_waitcnt lgkmcnt(2)
  v_mfma_f32_32x32x16_bf16 v[0:15], a[28:31], v[44:47], v[0:15]
  ds_read_b128 v[40:43], v205 offset:2048
  s_add_u32 m0, s67, 43136
  s_nop 0
  buffer_load_dwordx4 v202, s[4:7], s60 offen offset:896 lds
  v_mfma_f32_32x32x16_bf16 v[16:31], a[172:175], v[44:47], v[16:31]
  s_waitcnt lgkmcnt(2)
  v_mfma_f32_32x32x16_bf16 v[0:15], a[32:35], v[32:35], v[0:15]
  ds_read_b128 v[44:47], v206 offset:2048
  s_add_u32 m0, s67, 44032
  s_nop 0
  buffer_load_dwordx4 v202, s[4:7], s60 offen offset:1024 lds
  v_mfma_f32_32x32x16_bf16 v[16:31], a[176:179], v[32:35], v[16:31]
  s_waitcnt lgkmcnt(2)
  v_mfma_f32_32x32x16_bf16 v[0:15], a[36:39], v[36:39], v[0:15]
  ds_read_b128 v[32:35], v203 offset:3072
  v_mfma_f32_32x32x16_bf16 v[16:31], a[180:183], v[36:39], v[16:31]
  s_waitcnt lgkmcnt(2)
  v_mfma_f32_32x32x16_bf16 v[0:15], a[40:43], v[40:43], v[0:15]
  ds_read_b128 v[36:39], v204 offset:3072
  v_mfma_f32_32x32x16_bf16 v[16:31], a[184:187], v[40:43], v[16:31]
  s_waitcnt lgkmcnt(2)
  v_mfma_f32_32x32x16_bf16 v[0:15], a[44:47], v[44:47], v[0:15]
  ds_read_b128 v[40:43], v205 offset:3072
  v_mfma_f32_32x32x16_bf16 v[16:31], a[188:191], v[44:47], v[16:31]
  s_waitcnt lgkmcnt(2)
  v_mfma_f32_32x32x16_bf16 v[0:15], a[48:51], v[32:35], v[0:15]
  ds_read_b128 v[44:47], v206 offset:3072
  v_mfma_f32_32x32x16_bf16 v[16:31], a[192:195], v[32:35], v[16:31]
  s_waitcnt lgkmcnt(2)
  v_mfma_f32_32x32x16_bf16 v[0:15], a[52:55], v[36:39], v[0:15]
  ds_read_b128 v[32:35], v203 offset:4096
  v_mfma_f32_32x32x16_bf16 v[16:31], a[196:199], v[36:39], v[16:31]
  s_waitcnt lgkmcnt(2)
  v_mfma_f32_32x32x16_bf16 v[0:15], a[56:59], v[40:43], v[0:15]
  ds_read_b128 v[36:39], v204 offset:4096
  v_mfma_f32_32x32x16_bf16 v[16:31], a[200:203], v[40:43], v[16:31]
  s_waitcnt lgkmcnt(2)
  v_mfma_f32_32x32x16_bf16 v[0:15], a[60:63], v[44:47], v[0:15]
  ds_read_b128 v[40:43], v205 offset:4096
  v_mfma_f32_32x32x16_bf16 v[16:31], a[204:207], v[44:47], v[16:31]
  s_waitcnt lgkmcnt(2)
  v_mfma_f32_32x32x16_bf16 v[0:15], a[64:67], v[32:35], v[0:15]
  ds_read_b128 v[44:47], v206 offset:4096
  v_mfma_f32_32x32x16_bf16 v[16:31], a[208:211], v[32:35], v[16:31]
  s_waitcnt lgkmcnt(2)
  v_mfma_f32_32x32x16_bf16 v[0:15], a[68:71], v[36:39], v[0:15]
  ds_read_b128 v[32:35], v203 offset:5120
  v_mfma_f32_32x32x16_bf16 v[16:31], a[212:215], v[36:39], v[16:31]
  s_waitcnt lgkmcnt(2)
  v_mfma_f32_32x32x16_bf16 v[0:15], a[72:75], v[40:43], v[0:15]
  ds_read_b128 v[36:39], v204 offset:5120
  v_mfma_f32_32x32x16_bf16 v[16:31], a[216:219], v[40:43], v[16:31]
  s_waitcnt lgkmcnt(2)
  v_mfma_f32_32x32x16_bf16 v[0:15], a[76:79], v[44:47], v[0:15]
  ds_read_b128 v[40:43], v205 offset:5120
  v_mfma_f32_32x32x16_bf16 v[16:31], a[220:223], v[44:47], v[16:31]
  s_waitcnt lgkmcnt(2)
  v_mfma_f32_32x32x16_bf16 v[0:15], a[80:83], v[32:35], v[0:15]
  ds_read_b128 v[44:47], v206 offset:5120
  v_mfma_f32_32x32x16_bf16 v[16:31], a[224:227], v[32:35], v[16:31]
  s_waitcnt lgkmcnt(2)
  v_mfma_f32_32x32x16_bf16 v[0:15], a[84:87], v[36:39], v[0:15]
  ds_read_b128 v[32:35], v203 offset:6144
  v_mfma_f32_32x32x16_bf16 v[16:31], a[228:231], v[36:39], v[16:31]
  s_waitcnt lgkmcnt(2)
  v_mfma_f32_32x32x16_bf16 v[0:15], a[88:91], v[40:43], v[0:15]
  ds_read_b128 v[36:39], v204 offset:6144
  v_mfma_f32_32x32x16_bf16 v[16:31], a[232:235], v[40:43], v[16:31]
  s_waitcnt lgkmcnt(2)
  v_mfma_f32_32x32x16_bf16 v[0:15], a[92:95], v[44:47], v[0:15]
  ds_read_b128 v[40:43], v205 offset:6144
  v_mfma_f32_32x32x16_bf16 v[16:31], a[236:239], v[44:47], v[16:31]
  s_waitcnt lgkmcnt(2)
  v_mfma_f32_32x32x16_bf16 v[0:15], a[96:99], v[32:35], v[0:15]
  ds_read_b128 v[44:47], v206 offset:6144
  v_mfma_f32_32x32x16_bf16 v[16:31], a[240:243], v[32:35], v[16:31]
  s_waitcnt lgkmcnt(2)
  v_mfma_f32_32x32x16_bf16 v[0:15], a[100:103], v[36:39], v[0:15]
  ds_read_b128 v[32:35], v203 offset:7168
  v_mfma_f32_32x32x16_bf16 v[16:31], a[244:247], v[36:39], v[16:31]
  s_waitcnt lgkmcnt(2)
  v_mfma_f32_32x32x16_bf16 v[0:15], a[104:107], v[40:43], v[0:15]
  ds_read_b128 v[36:39], v204 offset:7168
  v_mfma_f32_32x32x16_bf16 v[16:31], a[248:251], v[40:43], v[16:31]
  s_waitcnt lgkmcnt(2)
  v_mfma_f32_32x32x16_bf16 v[0:15], a[108:111], v[44:47], v[0:15]
  ds_read_b128 v[40:43], v205 offset:7168
  v_mfma_f32_32x32x16_bf16 v[16:31], a[252:255], v[44:47], v[16:31]
  s_waitcnt lgkmcnt(2)
  v_mfma_f32_32x32x16_bf16 v[0:15], a[112:115], v[32:35], v[0:15]
  ds_read_b128 v[44:47], v206 offset:7168
  v_mfma_f32_32x32x16_bf16 v[16:31], v[224:227], v[32:35], v[16:31]
  s_waitcnt lgkmcnt(2)
  v_mfma_f32_32x32x16_bf16 v[0:15], a[116:119], v[36:39], v[0:15]
  ds_read_b128 v[32:35], v203 offset:8192
  v_mfma_f32_32x32x16_bf16 v[16:31], v[228:231], v[36:39], v[16:31]
  s_waitcnt lgkmcnt(2)
  v_mfma_f32_32x32x16_bf16 v[0:15], a[120:123], v[40:43], v[0:15]
  ds_read_b128 v[36:39], v204 offset:8192
  v_mfma_f32_32x32x16_bf16 v[16:31], v[232:235], v[40:43], v[16:31]
  s_waitcnt lgkmcnt(2)
  v_mfma_f32_32x32x16_bf16 v[0:15], a[124:127], v[44:47], v[0:15]
  ds_read_b128 v[40:43], v205 offset:8192
  v_mfma_f32_32x32x16_bf16 v[16:31], v[236:239], v[44:47], v[16:31]
  s_waitcnt lgkmcnt(2)
  v_mfma_f32_32x32x16_bf16 v[0:15], a[128:131], v[32:35], v[0:15]
  ds_read_b128 v[44:47], v206 offset:8192
  v_mfma_f32_32x32x16_bf16 v[16:31], v[240:243], v[32:35], v[16:31]
  s_waitcnt lgkmcnt(2)
  v_mfma_f32_32x32x16_bf16 v[0:15], a[132:135], v[36:39], v[0:15]
  v_mfma_f32_32x32x16_bf16 v[16:31], v[244:247], v[36:39], v[16:31]
  s_waitcnt lgkmcnt(1)
  v_mfma_f32_32x32x16_bf16 v[0:15], a[136:139], v[40:43], v[0:15]
  v_mfma_f32_32x32x16_bf16 v[16:31], v[248:251], v[40:43], v[16:31]
  s_waitcnt lgkmcnt(0)
  v_mfma_f32_32x32x16_bf16 v[0:15], a[140:143], v[44:47], v[0:15]
  v_mfma_f32_32x32x16_bf16 v[16:31], v[252:255], v[44:47], v[16:31]
  s_add_u32 s60, s60, 36864
  s_nop 2
  v_cvt_pk_bf16_f32 v48, v0, v1
  v_cvt_pk_bf16_f32 v49, v2, v3
  ds_write2_b32 v218, v48, v49 offset0:0 offset1:1
  v_cvt_pk_bf16_f32 v48, v4, v5
  v_cvt_pk_bf16_f32 v49, v6, v7
  ds_write2_b32 v218, v48, v49 offset0:4 offset1:5
  v_cvt_pk_bf16_f32 v48, v8, v9
  v_cvt_pk_bf16_f32 v49, v10, v11
  ds_write2_b32 v218, v48, v49 offset0:8 offset1:9
  v_cvt_pk_bf16_f32 v48, v12, v13
  v_cvt_pk_bf16_f32 v49, v14, v15
  ds_write2_b32 v218, v48, v49 offset0:12 offset1:13
  v_cvt_pk_bf16_f32 v48, v16, v17
  v_cvt_pk_bf16_f32 v49, v18, v19
  ds_write2_b32 v218, v48, v49 offset0:64 offset1:65
  v_cvt_pk_bf16_f32 v48, v20, v21
  v_cvt_pk_bf16_f32 v49, v22, v23
  ds_write2_b32 v218, v48, v49 offset0:68 offset1:69
  v_cvt_pk_bf16_f32 v48, v24, v25
  v_cvt_pk_bf16_f32 v49, v26, v27
  ds_write2_b32 v218, v48, v49 offset0:72 offset1:73
  v_cvt_pk_bf16_f32 v48, v28, v29
  v_cvt_pk_bf16_f32 v49, v30, v31
  ds_write2_b32 v218, v48, v49 offset0:76 offset1:77
  v_add_u32 v218, 16512, v218
  s_waitcnt vmcnt(0) lgkmcnt(0)
  s_barrier
  ds_read_b128 v[32:35], v203 offset:36864
  ds_read_b128 v[36:39], v204 offset:36864
  ds_read_b128 v[40:43], v205 offset:36864
  s_waitcnt lgkmcnt(2)
  v_mfma_f32_32x32x16_bf16 v[0:15], a[0:3], v[32:35], 0
  ds_read_b128 v[44:47], v206 offset:36864
  s_add_u32 m0, s67, 0
  s_nop 0
  buffer_load_dwordx4 v202, s[4:7], s60 offen offset:0 lds
  v_mfma_f32_32x32x16_bf16 v[16:31], a[144:147], v[32:35], 0
  s_waitcnt lgkmcnt(2)
  v_mfma_f32_32x32x16_bf16 v[0:15], a[4:7], v[36:39], v[0:15]
  ds_read_b128 v[32:35], v203 offset:37888
  s_add_u32 m0, s67, 896
  s_nop 0
  buffer_load_dwordx4 v202, s[4:7], s60 offen offset:128 lds
  v_mfma_f32_32x32x16_bf16 v[16:31], a[148:151], v[36:39], v[16:31]
  s_waitcnt lgkmcnt(2)
  v_mfma_f32_32x32x16_bf16 v[0:15], a[8:11], v[40:43], v[0:15]
  ds_read_b128 v[36:39], v204 offset:37888
  s_add_u32 m0, s67, 1792
  s_nop 0
  buffer_load_dwordx4 v202, s[4:7], s60 offen offset:256 lds
  v_mfma_f32_32x32x16_bf16 v[16:31], a[152:155], v[40:43], v[16:31]
  s_waitcnt lgkmcnt(2)
  v_mfma_f32_32x32x16_bf16 v[0:15], a[12:15], v[44:47], v[0:15]
  ds_read_b128 v[40:43], v205 offset:37888
  s_add_u32 m0, s67, 2688
  s_nop 0
  buffer_load_dwordx4 v202, s[4:7], s60 offen offset:384 lds
  v_mfma_f32_32x32x16_bf16 v[16:31], a[156:159], v[44:47], v[16:31]
  s_waitcnt lgkmcnt(2)
  v_mfma_f32_32x32x16_bf16 v[0:15], a[16:19], v[32:35], v[0:15]
  ds_read_b128 v[44:47], v206 offset:37888
  s_add_u32 m0, s67, 3584
  s_nop 0
  buffer_load_dwordx4 v202, s[4:7], s60 offen offset:512 lds
  v_mfma_f32_32x32x16_bf16 v[16:31], a[160:163], v[32:35], v[16:31]
  s_waitcnt lgkmcnt(2)
  v_mfma_f32_32x32x16_bf16 v[0:15], a[20:23], v[36:39], v[0:15]
  ds_read_b128 v[32:35], v203 offset:38912
  s_add_u32 m0, s67, 4480
  s_nop 0
  buffer_load_dwordx4 v202, s[4:7], s60 offen offset:640 lds
  v_mfma_f32_32x32x16_bf16 v[16:31], a[164:167], v[36:39], v[16:31]
  s_waitcnt lgkmcnt(2)
  v_mfma_f32_32x32x16_bf16 v[0:15], a[24:27], v[40:43], v[0:15]
  ds_read_b128 v[36:39], v204 offset:38912
  s_add_u32 m0, s67, 5376
  s_nop 0
  buffer_load_dwordx4 v202, s[4:7], s60 offen offset:768 lds
  v_mfma_f32_32x32x16_bf16 v[16:31], a[168:171], v[40:43], v[16:31]
  s_waitcnt lgkmcnt(2)
  v_mfma_f32_32x32x16_bf16 v[0:15], a[28:31], v[44:47], v[0:15]
  ds_read_b128 v[40:43], v205 offset:38912
  s_add_u32 m0, s67, 6272
  s_nop 0
  buffer_load_dwordx4 v202, s[4:7], s60 offen offset:896 lds
  v_mfma_f32_32x32x16_bf16 v[16:31], a[172:175], v[44:47], v[16:31]
  s_waitcnt lgkmcnt(2)
  v_mfma_f32_32x32x16_bf16 v[0:15], a[32:35], v[32:35], v[0:15]
  ds_read_b128 v[44:47], v206 offset:38912
  s_add_u32 m0, s67, 7168
  s_nop 0
  buffer_load_dwordx4 v202, s[4:7], s60 offen offset:1024 lds
  v_mfma_f32_32x32x16_bf16 v[16:31], a[176:179], v[32:35], v[16:31]
  s_waitcnt lgkmcnt(2)
  v_mfma_f32_32x32x16_bf16 v[0:15], a[36:39], v[36:39], v[0:15]
  ds_read_b128 v[32:35], v203 offset:39936
  v_mfma_f32_32x32x16_bf16 v[16:31], a[180:183], v[36:39], v[16:31]
  s_waitcnt lgkmcnt(2)
  v_mfma_f32_32x32x16_bf16 v[0:15], a[40:43], v[40:43], v[0:15]
  ds_read_b128 v[36:39], v204 offset:39936
  v_mfma_f32_32x32x16_bf16 v[16:31], a[184:187], v[40:43], v[16:31]
  s_waitcnt lgkmcnt(2)
  v_mfma_f32_32x32x16_bf16 v[0:15], a[44:47], v[44:47], v[0:15]
  ds_read_b128 v[40:43], v205 offset:39936
  v_mfma_f32_32x32x16_bf16 v[16:31], a[188:191], v[44:47], v[16:31]
  s_waitcnt lgkmcnt(2)
  v_mfma_f32_32x32x16_bf16 v[0:15], a[48:51], v[32:35], v[0:15]
  ds_read_b128 v[44:47], v206 offset:39936
  v_mfma_f32_32x32x16_bf16 v[16:31], a[192:195], v[32:35], v[16:31]
  s_waitcnt lgkmcnt(2)
  v_mfma_f32_32x32x16_bf16 v[0:15], a[52:55], v[36:39], v[0:15]
  ds_read_b128 v[32:35], v203 offset:40960
  v_mfma_f32_32x32x16_bf16 v[16:31], a[196:199], v[36:39], v[16:31]
  s_waitcnt lgkmcnt(2)
  v_mfma_f32_32x32x16_bf16 v[0:15], a[56:59], v[40:43], v[0:15]
  ds_read_b128 v[36:39], v204 offset:40960
  v_mfma_f32_32x32x16_bf16 v[16:31], a[200:203], v[40:43], v[16:31]
  s_waitcnt lgkmcnt(2)
  v_mfma_f32_32x32x16_bf16 v[0:15], a[60:63], v[44:47], v[0:15]
  ds_read_b128 v[40:43], v205 offset:40960
  v_mfma_f32_32x32x16_bf16 v[16:31], a[204:207], v[44:47], v[16:31]
  s_waitcnt lgkmcnt(2)
  v_mfma_f32_32x32x16_bf16 v[0:15], a[64:67], v[32:35], v[0:15]
  ds_read_b128 v[44:47], v206 offset:40960
  v_mfma_f32_32x32x16_bf16 v[16:31], a[208:211], v[32:35], v[16:31]
  s_waitcnt lgkmcnt(2)
  v_mfma_f32_32x32x16_bf16 v[0:15], a[68:71], v[36:39], v[0:15]
  ds_read_b128 v[32:35], v203 offset:41984
  v_mfma_f32_32x32x16_bf16 v[16:31], a[212:215], v[36:39], v[16:31]
  s_waitcnt lgkmcnt(2)
  v_mfma_f32_32x32x16_bf16 v[0:15], a[72:75], v[40:43], v[0:15]
  ds_read_b128 v[36:39], v204 offset:41984
  v_mfma_f32_32x32x16_bf16 v[16:31], a[216:219], v[40:43], v[16:31]
  s_waitcnt lgkmcnt(2)
  v_mfma_f32_32x32x16_bf16 v[0:15], a[76:79], v[44:47], v[0:15]
  ds_read_b128 v[40:43], v205 offset:41984
  v_mfma_f32_32x32x16_bf16 v[16:31], a[220:223], v[44:47], v[16:31]
  s_waitcnt lgkmcnt(2)
  v_mfma_f32_32x32x16_bf16 v[0:15], a[80:83], v[32:35], v[0:15]
  ds_read_b128 v[44:47], v206 offset:41984
  v_mfma_f32_32x32x16_bf16 v[16:31], a[224:227], v[32:35], v[16:31]
  s_waitcnt lgkmcnt(2)
  v_mfma_f32_32x32x16_bf16 v[0:15], a[84:87], v[36:39], v[0:15]
  ds_read_b128 v[32:35], v203 offset:43008
  v_mfma_f32_32x32x16_bf16 v[16:31], a[228:231], v[36:39], v[16:31]
  s_waitcnt lgkmcnt(2)
  v_mfma_f32_32x32x16_bf16 v[0:15], a[88:91], v[40:43], v[0:15]
  ds_read_b128 v[36:39], v204 offset:43008
  v_mfma_f32_32x32x16_bf16 v[16:31], a[232:235], v[40:43], v[16:31]
  s_waitcnt lgkmcnt(2)
  v_mfma_f32_32x32x16_bf16 v[0:15], a[92:95], v[44:47], v[0:15]
  ds_read_b128 v[40:43], v205 offset:43008
  v_mfma_f32_32x32x16_bf16 v[16:31], a[236:239], v[44:47], v[16:31]
  s_waitcnt lgkmcnt(2)
  v_mfma_f32_32x32x16_bf16 v[0:15], a[96:99], v[32:35], v[0:15]
  ds_read_b128 v[44:47], v206 offset:43008
  v_mfma_f32_32x32x16_bf16 v[16:31], a[240:243], v[32:35], v[16:31]
  s_waitcnt lgkmcnt(2)
  v_mfma_f32_32x32x16_bf16 v[0:15], a[100:103], v[36:39], v[0:15]
  ds_read_b128 v[32:35], v203 offset:44032
  v_mfma_f32_32x32x16_bf16 v[16:31], a[244:247], v[36:39], v[16:31]
  s_waitcnt lgkmcnt(2)
  v_mfma_f32_32x32x16_bf16 v[0:15], a[104:107], v[40:43], v[0:15]
  ds_read_b128 v[36:39], v204 offset:44032
  v_mfma_f32_32x32x16_bf16 v[16:31], a[248:251], v[40:43], v[16:31]
  s_waitcnt lgkmcnt(2)
  v_mfma_f32_32x32x16_bf16 v[0:15], a[108:111], v[44:47], v[0:15]
  ds_read_b128 v[40:43], v205 offset:44032
  v_mfma_f32_32x32x16_bf16 v[16:31], a[252:255], v[44:47], v[16:31]
  s_waitcnt lgkmcnt(2)
  v_mfma_f32_32x32x16_bf16 v[0:15], a[112:115], v[32:35], v[0:15]
  ds_read_b128 v[44:47], v206 offset:44032
  v_mfma_f32_32x32x16_bf16 v[16:31], v[224:227], v[32:35], v[16:31]
  s_waitcnt lgkmcnt(2)
  v_mfma_f32_32x32x16_bf16 v[0:15], a[116:119], v[36:39], v[0:15]
  ds_read_b128 v[32:35], v203 offset:45056
  v_mfma_f32_32x32x16_bf16 v[16:31], v[228:231], v[36:39], v[16:31]
  s_waitcnt lgkmcnt(2)
  v_mfma_f32_32x32x16_bf16 v[0:15], a[120:123], v[40:43], v[0:15]
  ds_read_b128 v[36:39], v204 offset:45056
  v_mfma_f32_32x32x16_bf16 v[16:31], v[232:235], v[40:43], v[16:31]
  s_waitcnt lgkmcnt(2)
  v_mfma_f32_32x32x16_bf16 v[0:15], a[124:127], v[44:47], v[0:15]
  ds_read_b128 v[40:43], v205 offset:45056
  v_mfma_f32_32x32x16_bf16 v[16:31], v[236:239], v[44:47], v[16:31]
  s_waitcnt lgkmcnt(2)
  v_mfma_f32_32x32x16_bf16 v[0:15], a[128:131], v[32:35], v[0:15]
  ds_read_b128 v[44:47], v206 offset:45056
  v_mfma_f32_32x32x16_bf16 v[16:31], v[240:243], v[32:35], v[16:31]
  s_waitcnt lgkmcnt(2)
  v_mfma_f32_32x32x16_bf16 v[0:15], a[132:135], v[36:39], v[0:15]
  v_mfma_f32_32x32x16_bf16 v[16:31], v[244:247], v[36:39], v[16:31]
  s_waitcnt lgkmcnt(1)
  v_mfma_f32_32x32x16_bf16 v[0:15], a[136:139], v[40:43], v[0:15]
  v_mfma_f32_32x32x16_bf16 v[16:31], v[248:251], v[40:43], v[16:31]
  s_waitcnt lgkmcnt(0)
  v_mfma_f32_32x32x16_bf16 v[0:15], a[140:143], v[44:47], v[0:15]
  v_mfma_f32_32x32x16_bf16 v[16:31], v[252:255], v[44:47], v[16:31]
  s_add_u32 s60, s60, 36864
  s_nop 2
  v_cvt_pk_bf16_f32 v48, v0, v1
  v_cvt_pk_bf16_f32 v49, v2, v3
  ds_write2_b32 v218, v48, v49 offset0:0 offset1:1
  v_cvt_pk_bf16_f32 v48, v4, v5
  v_cvt_pk_bf16_f32 v49, v6, v7
  ds_write2_b32 v218, v48, v49 offset0:4 offset1:5
  v_cvt_pk_bf16_f32 v48, v8, v9
  v_cvt_pk_bf16_f32 v49, v10, v11
  ds_write2_b32 v218, v48, v49 offset0:8 offset1:9
  v_cvt_pk_bf16_f32 v48, v12, v13
  v_cvt_pk_bf16_f32 v49, v14, v15
  ds_write2_b32 v218, v48, v49 offset0:12 offset1:13
  v_cvt_pk_bf16_f32 v48, v16, v17
  v_cvt_pk_bf16_f32 v49, v18, v19
  ds_write2_b32 v218, v48, v49 offset0:64 offset1:65
  v_cvt_pk_bf16_f32 v48, v20, v21
  v_cvt_pk_bf16_f32 v49, v22, v23
  ds_write2_b32 v218, v48, v49 offset0:68 offset1:69
  v_cvt_pk_bf16_f32 v48, v24, v25
  v_cvt_pk_bf16_f32 v49, v26, v27
  ds_write2_b32 v218, v48, v49 offset0:72 offset1:73
  v_cvt_pk_bf16_f32 v48, v28, v29
  v_cvt_pk_bf16_f32 v49, v30, v31
  ds_write2_b32 v218, v48, v49 offset0:76 offset1:77
  v_add_u32 v218, 16512, v218
  s_waitcnt vmcnt(0) lgkmcnt(0)
  s_barrier
  ds_read_b128 v[32:35], v203 offset:0
  ds_read_b128 v[36:39], v204 offset:0
  ds_read_b128 v[40:43], v205 offset:0
  s_waitcnt lgkmcnt(2)
  v_mfma_f32_32x32x16_bf16 v[0:15], a[0:3], v[32:35], 0
  ds_read_b128 v[44:47], v206 offset:0
  s_add_u32 m0, s67, 36864
  s_nop 0
  buffer_load_dwordx4 v202, s[4:7], s60 offen offset:0 lds
  v_mfma_f32_32x32x16_bf16 v[16:31], a[144:147], v[32:35], 0
  s_waitcnt lgkmcnt(2)
  v_mfma_f32_32x32x16_bf16 v[0:15], a[4:7], v[36:39], v[0:15]
  ds_read_b128 v[32:35], v203 offset:1024
  s_add_u32 m0, s67, 37760
  s_nop 0
  buffer_load_dwordx4 v202, s[4:7], s60 offen offset:128 lds
  v_mfma_f32_32x32x16_bf16 v[16:31], a[148:151], v[36:39], v[16:31]
  s_waitcnt lgkmcnt(2)
  v_mfma_f32_32x32x16_bf16 v[0:15], a[8:11], v[40:43], v[0:15]
  ds_read_b128 v[36:39], v204 offset:1024
  s_add_u32 m0, s67, 38656
  s_nop 0
  buffer_load_dwordx4 v202, s[4:7], s60 offen offset:256 lds
  v_mfma_f32_32x32x16_bf16 v[16:31], a[152:155], v[40:43], v[16:31]
  s_waitcnt lgkmcnt(2)
  v_mfma_f32_32x32x16_bf16 v[0:15], a[12:15], v[44:47], v[0:15]
  ds_read_b128 v[40:43], v205 offset:1024
  s_add_u32 m0, s67, 39552
  s_nop 0
  buffer_load_dwordx4 v202, s[4:7], s60 offen offset:384 lds
  v_mfma_f32_32x32x16_bf16 v[16:31], a[156:159], v[44:47], v[16:31]
  s_waitcnt lgkmcnt(2)
  v_mfma_f32_32x32x16_bf16 v[0:15], a[16:19], v[32:35], v[0:15]
  ds_read_b128 v[44:47], v206 offset:1024
  s_add_u32 m0, s67, 40448
  s_nop 0
  buffer_load_dwordx4 v202, s[4:7], s60 offen offset:512 lds
  v_mfma_f32_32x32x16_bf16 v[16:31], a[160:163], v[32:35], v[16:31]
  s_waitcnt lgkmcnt(2)
  v_mfma_f32_32x32x16_bf16 v[0:15], a[20:23], v[36:39], v[0:15]
  ds_read_b128 v[32:35], v203 offset:2048
  s_add_u32 m0, s67, 41344
  s_nop 0
  buffer_load_dwordx4 v202, s[4:7], s60 offen offset:640 lds
  v_mfma_f32_32x32x16_bf16 v[16:31], a[164:167], v[36:39], v[16:31]
  s_waitcnt lgkmcnt(2)
  v_mfma_f32_32x32x16_bf16 v[0:15], a[24:27], v[40:43], v[0:15]
  ds_read_b128 v[36:39], v204 offset:2048
  s_add_u32 m0, s67, 42240
  s_nop 0
  buffer_load_dwordx4 v202, s[4:7], s60 offen offset:768 lds
  v_mfma_f32_32x32x16_bf16 v[16:31], a[168:171], v[40:43], v[16:31]
  s_waitcnt lgkmcnt(2)
  v_mfma_f32_32x32x16_bf16 v[0:15], a[28:31], v[44:47], v[0:15]
  ds_read_b128 v[40:43], v205 offset:2048
  s_add_u32 m0, s67, 43136
  s_nop 0
  buffer_load_dwordx4 v202, s[4:7], s60 offen offset:896 lds
  v_mfma_f32_32x32x16_bf16 v[16:31], a[172:175], v[44:47], v[16:31]
  s_waitcnt lgkmcnt(2)
  v_mfma_f32_32x32x16_bf16 v[0:15], a[32:35], v[32:35], v[0:15]
  ds_read_b128 v[44:47], v206 offset:2048
  s_add_u32 m0, s67, 44032
  s_nop 0
  buffer_load_dwordx4 v202, s[4:7], s60 offen offset:1024 lds
  v_mfma_f32_32x32x16_bf16 v[16:31], a[176:179], v[32:35], v[16:31]
  s_waitcnt lgkmcnt(2)
  v_mfma_f32_32x32x16_bf16 v[0:15], a[36:39], v[36:39], v[0:15]
  ds_read_b128 v[32:35], v203 offset:3072
  v_mfma_f32_32x32x16_bf16 v[16:31], a[180:183], v[36:39], v[16:31]
  s_waitcnt lgkmcnt(2)
  v_mfma_f32_32x32x16_bf16 v[0:15], a[40:43], v[40:43], v[0:15]
  ds_read_b128 v[36:39], v204 offset:3072
  v_mfma_f32_32x32x16_bf16 v[16:31], a[184:187], v[40:43], v[16:31]
  s_waitcnt lgkmcnt(2)
  v_mfma_f32_32x32x16_bf16 v[0:15], a[44:47], v[44:47], v[0:15]
  ds_read_b128 v[40:43], v205 offset:3072
  v_mfma_f32_32x32x16_bf16 v[16:31], a[188:191], v[44:47], v[16:31]
  s_waitcnt lgkmcnt(2)
  v_mfma_f32_32x32x16_bf16 v[0:15], a[48:51], v[32:35], v[0:15]
  ds_read_b128 v[44:47], v206 offset:3072
  v_mfma_f32_32x32x16_bf16 v[16:31], a[192:195], v[32:35], v[16:31]
  s_waitcnt lgkmcnt(2)
  v_mfma_f32_32x32x16_bf16 v[0:15], a[52:55], v[36:39], v[0:15]
  ds_read_b128 v[32:35], v203 offset:4096
  v_mfma_f32_32x32x16_bf16 v[16:31], a[196:199], v[36:39], v[16:31]
  s_waitcnt lgkmcnt(2)
  v_mfma_f32_32x32x16_bf16 v[0:15], a[56:59], v[40:43], v[0:15]
  ds_read_b128 v[36:39], v204 offset:4096
  v_mfma_f32_32x32x16_bf16 v[16:31], a[200:203], v[40:43], v[16:31]
  s_waitcnt lgkmcnt(2)
  v_mfma_f32_32x32x16_bf16 v[0:15], a[60:63], v[44:47], v[0:15]
  ds_read_b128 v[40:43], v205 offset:4096
  v_mfma_f32_32x32x16_bf16 v[16:31], a[204:207], v[44:47], v[16:31]
  s_waitcnt lgkmcnt(2)
  v_mfma_f32_32x32x16_bf16 v[0:15], a[64:67], v[32:35], v[0:15]
  ds_read_b128 v[44:47], v206 offset:4096
  v_mfma_f32_32x32x16_bf16 v[16:31], a[208:211], v[32:35], v[16:31]
  s_waitcnt lgkmcnt(2)
  v_mfma_f32_32x32x16_bf16 v[0:15], a[68:71], v[36:39], v[0:15]
  ds_read_b128 v[32:35], v203 offset:5120
  v_mfma_f32_32x32x16_bf16 v[16:31], a[212:215], v[36:39], v[16:31]
  s_waitcnt lgkmcnt(2)
  v_mfma_f32_32x32x16_bf16 v[0:15], a[72:75], v[40:43], v[0:15]
  ds_read_b128 v[36:39], v204 offset:5120
  v_mfma_f32_32x32x16_bf16 v[16:31], a[216:219], v[40:43], v[16:31]
  s_waitcnt lgkmcnt(2)
  v_mfma_f32_32x32x16_bf16 v[0:15], a[76:79], v[44:47], v[0:15]
  ds_read_b128 v[40:43], v205 offset:5120
  v_mfma_f32_32x32x16_bf16 v[16:31], a[220:223], v[44:47], v[16:31]
  s_waitcnt lgkmcnt(2)
  v_mfma_f32_32x32x16_bf16 v[0:15], a[80:83], v[32:35], v[0:15]
  ds_read_b128 v[44:47], v206 offset:5120
  v_mfma_f32_32x32x16_bf16 v[16:31], a[224:227], v[32:35], v[16:31]
  s_waitcnt lgkmcnt(2)
  v_mfma_f32_32x32x16_bf16 v[0:15], a[84:87], v[36:39], v[0:15]
  ds_read_b128 v[32:35], v203 offset:6144
  v_mfma_f32_32x32x16_bf16 v[16:31], a[228:231], v[36:39], v[16:31]
  s_waitcnt lgkmcnt(2)
  v_mfma_f32_32x32x16_bf16 v[0:15], a[88:91], v[40:43], v[0:15]
  ds_read_b128 v[36:39], v204 offset:6144
  v_mfma_f32_32x32x16_bf16 v[16:31], a[232:235], v[40:43], v[16:31]
  s_waitcnt lgkmcnt(2)
  v_mfma_f32_32x32x16_bf16 v[0:15], a[92:95], v[44:47], v[0:15]
  ds_read_b128 v[40:43], v205 offset:6144
  v_mfma_f32_32x32x16_bf16 v[16:31], a[236:239], v[44:47], v[16:31]
  s_waitcnt lgkmcnt(2)
  v_mfma_f32_32x32x16_bf16 v[0:15], a[96:99], v[32:35], v[0:15]
  ds_read_b128 v[44:47], v206 offset:6144
  v_mfma_f32_32x32x16_bf16 v[16:31], a[240:243], v[32:35], v[16:31]
  s_waitcnt lgkmcnt(2)
  v_mfma_f32_32x32x16_bf16 v[0:15], a[100:103], v[36:39], v[0:15]
  ds_read_b128 v[32:35], v203 offset:7168
  v_mfma_f32_32x32x16_bf16 v[16:31], a[244:247], v[36:39], v[16:31]
  s_waitcnt lgkmcnt(2)
  v_mfma_f32_32x32x16_bf16 v[0:15], a[104:107], v[40:43], v[0:15]
  ds_read_b128 v[36:39], v204 offset:7168
  v_mfma_f32_32x32x16_bf16 v[16:31], a[248:251], v[40:43], v[16:31]
  s_waitcnt lgkmcnt(2)
  v_mfma_f32_32x32x16_bf16 v[0:15], a[108:111], v[44:47], v[0:15]
  ds_read_b128 v[40:43], v205 offset:7168
  v_mfma_f32_32x32x16_bf16 v[16:31], a[252:255], v[44:47], v[16:31]
  s_waitcnt lgkmcnt(2)
  v_mfma_f32_32x32x16_bf16 v[0:15], a[112:115], v[32:35], v[0:15]
  ds_read_b128 v[44:47], v206 offset:7168
  v_mfma_f32_32x32x16_bf16 v[16:31], v[224:227], v[32:35], v[16:31]
  s_waitcnt lgkmcnt(2)
  v_mfma_f32_32x32x16_bf16 v[0:15], a[116:119], v[36:39], v[0:15]
  ds_read_b128 v[32:35], v203 offset:8192
  v_mfma_f32_32x32x16_bf16 v[16:31], v[228:231], v[36:39], v[16:31]
  s_waitcnt lgkmcnt(2)
  v_mfma_f32_32x32x16_bf16 v[0:15], a[120:123], v[40:43], v[0:15]
  ds_read_b128 v[36:39], v204 offset:8192
  v_mfma_f32_32x32x16_bf16 v[16:31], v[232:235], v[40:43], v[16:31]
  s_waitcnt lgkmcnt(2)
  v_mfma_f32_32x32x16_bf16 v[0:15], a[124:127], v[44:47], v[0:15]
  ds_read_b128 v[40:43], v205 offset:8192
  v_mfma_f32_32x32x16_bf16 v[16:31], v[236:239], v[44:47], v[16:31]
  s_waitcnt lgkmcnt(2)
  v_mfma_f32_32x32x16_bf16 v[0:15], a[128:131], v[32:35], v[0:15]
  ds_read_b128 v[44:47], v206 offset:8192
  v_mfma_f32_32x32x16_bf16 v[16:31], v[240:243], v[32:35], v[16:31]
  s_waitcnt lgkmcnt(2)
  v_mfma_f32_32x32x16_bf16 v[0:15], a[132:135], v[36:39], v[0:15]
  v_mfma_f32_32x32x16_bf16 v[16:31], v[244:247], v[36:39], v[16:31]
  s_waitcnt lgkmcnt(1)
  v_mfma_f32_32x32x16_bf16 v[0:15], a[136:139], v[40:43], v[0:15]
  v_mfma_f32_32x32x16_bf16 v[16:31], v[248:251], v[40:43], v[16:31]
  s_waitcnt lgkmcnt(0)
  v_mfma_f32_32x32x16_bf16 v[0:15], a[140:143], v[44:47], v[0:15]
  v_mfma_f32_32x32x16_bf16 v[16:31], v[252:255], v[44:47], v[16:31]
  s_add_u32 s60, s60, 36864
  s_nop 2
  v_cvt_pk_bf16_f32 v48, v0, v1
  v_cvt_pk_bf16_f32 v49, v2, v3
  ds_write2_b32 v218, v48, v49 offset0:0 offset1:1
  v_cvt_pk_bf16_f32 v48, v4, v5
  v_cvt_pk_bf16_f32 v49, v6, v7
  ds_write2_b32 v218, v48, v49 offset0:4 offset1:5
  v_cvt_pk_bf16_f32 v48, v8, v9
  v_cvt_pk_bf16_f32 v49, v10, v11
  ds_write2_b32 v218, v48, v49 offset0:8 offset1:9
  v_cvt_pk_bf16_f32 v48, v12, v13
  v_cvt_pk_bf16_f32 v49, v14, v15
  ds_write2_b32 v218, v48, v49 offset0:12 offset1:13
  v_cvt_pk_bf16_f32 v48, v16, v17
  v_cvt_pk_bf16_f32 v49, v18, v19
  ds_write2_b32 v218, v48, v49 offset0:64 offset1:65
  v_cvt_pk_bf16_f32 v48, v20, v21
  v_cvt_pk_bf16_f32 v49, v22, v23
  ds_write2_b32 v218, v48, v49 offset0:68 offset1:69
  v_cvt_pk_bf16_f32 v48, v24, v25
  v_cvt_pk_bf16_f32 v49, v26, v27
  ds_write2_b32 v218, v48, v49 offset0:72 offset1:73
  v_cvt_pk_bf16_f32 v48, v28, v29
  v_cvt_pk_bf16_f32 v49, v30, v31
  ds_write2_b32 v218, v48, v49 offset0:76 offset1:77
  v_add_u32 v218, 16512, v218
  s_waitcnt vmcnt(0) lgkmcnt(0)
  s_barrier
  ds_read_b128 v[32:35], v203 offset:36864
  ds_read_b128 v[36:39], v204 offset:36864
  ds_read_b128 v[40:43], v205 offset:36864
  s_waitcnt lgkmcnt(2)
  v_mfma_f32_32x32x16_bf16 v[0:15], a[0:3], v[32:35], 0
  ds_read_b128 v[44:47], v206 offset:36864
  s_add_u32 m0, s67, 0
  s_nop 0
  buffer_load_dwordx4 v202, s[4:7], s60 offen offset:0 lds
  v_mfma_f32_32x32x16_bf16 v[16:31], a[144:147], v[32:35], 0
  s_waitcnt lgkmcnt(2)
  v_mfma_f32_32x32x16_bf16 v[0:15], a[4:7], v[36:39], v[0:15]
  ds_read_b128 v[32:35], v203 offset:37888
  s_add_u32 m0, s67, 896
  s_nop 0
  buffer_load_dwordx4 v202, s[4:7], s60 offen offset:128 lds
  v_mfma_f32_32x32x16_bf16 v[16:31], a[148:151], v[36:39], v[16:31]
  s_waitcnt lgkmcnt(2)
  v_mfma_f32_32x32x16_bf16 v[0:15], a[8:11], v[40:43], v[0:15]
  ds_read_b128 v[36:39], v204 offset:37888
  s_add_u32 m0, s67, 1792
  s_nop 0
  buffer_load_dwordx4 v202, s[4:7], s60 offen offset:256 lds
  v_mfma_f32_32x32x16_bf16 v[16:31], a[152:155], v[40:43], v[16:31]
  s_waitcnt lgkmcnt(2)
  v_mfma_f32_32x32x16_bf16 v[0:15], a[12:15], v[44:47], v[0:15]
  ds_read_b128 v[40:43], v205 offset:37888
  s_add_u32 m0, s67, 2688
  s_nop 0
  buffer_load_dwordx4 v202, s[4:7], s60 offen offset:384 lds
  v_mfma_f32_32x32x16_bf16 v[16:31], a[156:159], v[44:47], v[16:31]
  s_waitcnt lgkmcnt(2)
  v_mfma_f32_32x32x16_bf16 v[0:15], a[16:19], v[32:35], v[0:15]
  ds_read_b128 v[44:47], v206 offset:37888
  s_add_u32 m0, s67, 3584
  s_nop 0
  buffer_load_dwordx4 v202, s[4:7], s60 offen offset:512 lds
  v_mfma_f32_32x32x16_bf16 v[16:31], a[160:163], v[32:35], v[16:31]
  s_waitcnt lgkmcnt(2)
  v_mfma_f32_32x32x16_bf16 v[0:15], a[20:23], v[36:39], v[0:15]
  ds_read_b128 v[32:35], v203 offset:38912
  s_add_u32 m0, s67, 4480
  s_nop 0
  buffer_load_dwordx4 v202, s[4:7], s60 offen offset:640 lds
  v_mfma_f32_32x32x16_bf16 v[16:31], a[164:167], v[36:39], v[16:31]
  s_waitcnt lgkmcnt(2)
  v_mfma_f32_32x32x16_bf16 v[0:15], a[24:27], v[40:43], v[0:15]
  ds_read_b128 v[36:39], v204 offset:38912
  s_add_u32 m0, s67, 5376
  s_nop 0
  buffer_load_dwordx4 v202, s[4:7], s60 offen offset:768 lds
  v_mfma_f32_32x32x16_bf16 v[16:31], a[168:171], v[40:43], v[16:31]
  s_waitcnt lgkmcnt(2)
  v_mfma_f32_32x32x16_bf16 v[0:15], a[28:31], v[44:47], v[0:15]
  ds_read_b128 v[40:43], v205 offset:38912
  s_add_u32 m0, s67, 6272
  s_nop 0
  buffer_load_dwordx4 v202, s[4:7], s60 offen offset:896 lds
  v_mfma_f32_32x32x16_bf16 v[16:31], a[172:175], v[44:47], v[16:31]
  s_waitcnt lgkmcnt(2)
  v_mfma_f32_32x32x16_bf16 v[0:15], a[32:35], v[32:35], v[0:15]
  ds_read_b128 v[44:47], v206 offset:38912
  s_add_u32 m0, s67, 7168
  s_nop 0
  buffer_load_dwordx4 v202, s[4:7], s60 offen offset:1024 lds
  v_mfma_f32_32x32x16_bf16 v[16:31], a[176:179], v[32:35], v[16:31]
  s_waitcnt lgkmcnt(2)
  v_mfma_f32_32x32x16_bf16 v[0:15], a[36:39], v[36:39], v[0:15]
  ds_read_b128 v[32:35], v203 offset:39936
  v_mfma_f32_32x32x16_bf16 v[16:31], a[180:183], v[36:39], v[16:31]
  s_waitcnt lgkmcnt(2)
  v_mfma_f32_32x32x16_bf16 v[0:15], a[40:43], v[40:43], v[0:15]
  ds_read_b128 v[36:39], v204 offset:39936
  v_mfma_f32_32x32x16_bf16 v[16:31], a[184:187], v[40:43], v[16:31]
  s_waitcnt lgkmcnt(2)
  v_mfma_f32_32x32x16_bf16 v[0:15], a[44:47], v[44:47], v[0:15]
  ds_read_b128 v[40:43], v205 offset:39936
  v_mfma_f32_32x32x16_bf16 v[16:31], a[188:191], v[44:47], v[16:31]
  s_waitcnt lgkmcnt(2)
  v_mfma_f32_32x32x16_bf16 v[0:15], a[48:51], v[32:35], v[0:15]
  ds_read_b128 v[44:47], v206 offset:39936
  v_mfma_f32_32x32x16_bf16 v[16:31], a[192:195], v[32:35], v[16:31]
  s_waitcnt lgkmcnt(2)
  v_mfma_f32_32x32x16_bf16 v[0:15], a[52:55], v[36:39], v[0:15]
  ds_read_b128 v[32:35], v203 offset:40960
  v_mfma_f32_32x32x16_bf16 v[16:31], a[196:199], v[36:39], v[16:31]
  s_waitcnt lgkmcnt(2)
  v_mfma_f32_32x32x16_bf16 v[0:15], a[56:59], v[40:43], v[0:15]
  ds_read_b128 v[36:39], v204 offset:40960
  v_mfma_f32_32x32x16_bf16 v[16:31], a[200:203], v[40:43], v[16:31]
  s_waitcnt lgkmcnt(2)
  v_mfma_f32_32x32x16_bf16 v[0:15], a[60:63], v[44:47], v[0:15]
  ds_read_b128 v[40:43], v205 offset:40960
  v_mfma_f32_32x32x16_bf16 v[16:31], a[204:207], v[44:47], v[16:31]
  s_waitcnt lgkmcnt(2)
  v_mfma_f32_32x32x16_bf16 v[0:15], a[64:67], v[32:35], v[0:15]
  ds_read_b128 v[44:47], v206 offset:40960
  v_mfma_f32_32x32x16_bf16 v[16:31], a[208:211], v[32:35], v[16:31]
  s_waitcnt lgkmcnt(2)
  v_mfma_f32_32x32x16_bf16 v[0:15], a[68:71], v[36:39], v[0:15]
  ds_read_b128 v[32:35], v203 offset:41984
  v_mfma_f32_32x32x16_bf16 v[16:31], a[212:215], v[36:39], v[16:31]
  s_waitcnt lgkmcnt(2)
  v_mfma_f32_32x32x16_bf16 v[0:15], a[72:75], v[40:43], v[0:15]
  ds_read_b128 v[36:39], v204 offset:41984
  v_mfma_f32_32x32x16_bf16 v[16:31], a[216:219], v[40:43], v[16:31]
  s_waitcnt lgkmcnt(2)
  v_mfma_f32_32x32x16_bf16 v[0:15], a[76:79], v[44:47], v[0:15]
  ds_read_b128 v[40:43], v205 offset:41984
  v_mfma_f32_32x32x16_bf16 v[16:31], a[220:223], v[44:47], v[16:31]
  s_waitcnt lgkmcnt(2)
  v_mfma_f32_32x32x16_bf16 v[0:15], a[80:83], v[32:35], v[0:15]
  ds_read_b128 v[44:47], v206 offset:41984
  v_mfma_f32_32x32x16_bf16 v[16:31], a[224:227], v[32:35], v[16:31]
  s_waitcnt lgkmcnt(2)
  v_mfma_f32_32x32x16_bf16 v[0:15], a[84:87], v[36:39], v[0:15]
  ds_read_b128 v[32:35], v203 offset:43008
  v_mfma_f32_32x32x16_bf16 v[16:31], a[228:231], v[36:39], v[16:31]
  s_waitcnt lgkmcnt(2)
  v_mfma_f32_32x32x16_bf16 v[0:15], a[88:91], v[40:43], v[0:15]
  ds_read_b128 v[36:39], v204 offset:43008
  v_mfma_f32_32x32x16_bf16 v[16:31], a[232:235], v[40:43], v[16:31]
  s_waitcnt lgkmcnt(2)
  v_mfma_f32_32x32x16_bf16 v[0:15], a[92:95], v[44:47], v[0:15]
  ds_read_b128 v[40:43], v205 offset:43008
  v_mfma_f32_32x32x16_bf16 v[16:31], a[236:239], v[44:47], v[16:31]
  s_waitcnt lgkmcnt(2)
  v_mfma_f32_32x32x16_bf16 v[0:15], a[96:99], v[32:35], v[0:15]
  ds_read_b128 v[44:47], v206 offset:43008
  v_mfma_f32_32x32x16_bf16 v[16:31], a[240:243], v[32:35], v[16:31]
  s_waitcnt lgkmcnt(2)
  v_mfma_f32_32x32x16_bf16 v[0:15], a[100:103], v[36:39], v[0:15]
  ds_read_b128 v[32:35], v203 offset:44032
  v_mfma_f32_32x32x16_bf16 v[16:31], a[244:247], v[36:39], v[16:31]
  s_waitcnt lgkmcnt(2)
  v_mfma_f32_32x32x16_bf16 v[0:15], a[104:107], v[40:43], v[0:15]
  ds_read_b128 v[36:39], v204 offset:44032
  v_mfma_f32_32x32x16_bf16 v[16:31], a[248:251], v[40:43], v[16:31]
  s_waitcnt lgkmcnt(2)
  v_mfma_f32_32x32x16_bf16 v[0:15], a[108:111], v[44:47], v[0:15]
  ds_read_b128 v[40:43], v205 offset:44032
  v_mfma_f32_32x32x16_bf16 v[16:31], a[252:255], v[44:47], v[16:31]
  s_waitcnt lgkmcnt(2)
  v_mfma_f32_32x32x16_bf16 v[0:15], a[112:115], v[32:35], v[0:15]
  ds_read_b128 v[44:47], v206 offset:44032
  v_mfma_f32_32x32x16_bf16 v[16:31], v[224:227], v[32:35], v[16:31]
  s_waitcnt lgkmcnt(2)
  v_mfma_f32_32x32x16_bf16 v[0:15], a[116:119], v[36:39], v[0:15]
  ds_read_b128 v[32:35], v203 offset:45056
  v_mfma_f32_32x32x16_bf16 v[16:31], v[228:231], v[36:39], v[16:31]
  s_waitcnt lgkmcnt(2)
  v_mfma_f32_32x32x16_bf16 v[0:15], a[120:123], v[40:43], v[0:15]
  ds_read_b128 v[36:39], v204 offset:45056
  v_mfma_f32_32x32x16_bf16 v[16:31], v[232:235], v[40:43], v[16:31]
  s_waitcnt lgkmcnt(2)
  v_mfma_f32_32x32x16_bf16 v[0:15], a[124:127], v[44:47], v[0:15]
  ds_read_b128 v[40:43], v205 offset:45056
  v_mfma_f32_32x32x16_bf16 v[16:31], v[236:239], v[44:47], v[16:31]
  s_waitcnt lgkmcnt(2)
  v_mfma_f32_32x32x16_bf16 v[0:15], a[128:131], v[32:35], v[0:15]
  ds_read_b128 v[44:47], v206 offset:45056
  v_mfma_f32_32x32x16_bf16 v[16:31], v[240:243], v[32:35], v[16:31]
  s_waitcnt lgkmcnt(2)
  v_mfma_f32_32x32x16_bf16 v[0:15], a[132:135], v[36:39], v[0:15]
  v_mfma_f32_32x32x16_bf16 v[16:31], v[244:247], v[36:39], v[16:31]
  s_waitcnt lgkmcnt(1)
  v_mfma_f32_32x32x16_bf16 v[0:15], a[136:139], v[40:43], v[0:15]
  v_mfma_f32_32x32x16_bf16 v[16:31], v[248:251], v[40:43], v[16:31]
  s_waitcnt lgkmcnt(0)
  v_mfma_f32_32x32x16_bf16 v[0:15], a[140:143], v[44:47], v[0:15]
  v_mfma_f32_32x32x16_bf16 v[16:31], v[252:255], v[44:47], v[16:31]
  s_add_u32 s60, s60, 36864
  s_nop 2
  v_cvt_pk_bf16_f32 v48, v0, v1
  v_cvt_pk_bf16_f32 v49, v2, v3
  ds_write2_b32 v218, v48, v49 offset0:0 offset1:1
  v_cvt_pk_bf16_f32 v48, v4, v5
  v_cvt_pk_bf16_f32 v49, v6, v7
  ds_write2_b32 v218, v48, v49 offset0:4 offset1:5
  v_cvt_pk_bf16_f32 v48, v8, v9
  v_cvt_pk_bf16_f32 v49, v10, v11
  ds_write2_b32 v218, v48, v49 offset0:8 offset1:9
  v_cvt_pk_bf16_f32 v48, v12, v13
  v_cvt_pk_bf16_f32 v49, v14, v15
  ds_write2_b32 v218, v48, v49 offset0:12 offset1:13
  v_cvt_pk_bf16_f32 v48, v16, v17
  v_cvt_pk_bf16_f32 v49, v18, v19
  ds_write2_b32 v218, v48, v49 offset0:64 offset1:65
  v_cvt_pk_bf16_f32 v48, v20, v21
  v_cvt_pk_bf16_f32 v49, v22, v23
  ds_write2_b32 v218, v48, v49 offset0:68 offset1:69
  v_cvt_pk_bf16_f32 v48, v24, v25
  v_cvt_pk_bf16_f32 v49, v26, v27
  ds_write2_b32 v218, v48, v49 offset0:72 offset1:73
  v_cvt_pk_bf16_f32 v48, v28, v29
  v_cvt_pk_bf16_f32 v49, v30, v31
  ds_write2_b32 v218, v48, v49 offset0:76 offset1:77
  v_add_u32 v218, 16512, v218
  s_waitcnt vmcnt(0) lgkmcnt(0)
  s_barrier
  ds_read_b128 v[32:35], v203 offset:0
  ds_read_b128 v[36:39], v204 offset:0
  ds_read_b128 v[40:43], v205 offset:0
  s_waitcnt lgkmcnt(2)
  v_mfma_f32_32x32x16_bf16 v[0:15], a[0:3], v[32:35], 0
  ds_read_b128 v[44:47], v206 offset:0
  v_mfma_f32_32x32x16_bf16 v[16:31], a[144:147], v[32:35], 0
  s_waitcnt lgkmcnt(2)
  v_mfma_f32_32x32x16_bf16 v[0:15], a[4:7], v[36:39], v[0:15]
  ds_read_b128 v[32:35], v203 offset:1024
  v_mfma_f32_32x32x16_bf16 v[16:31], a[148:151], v[36:39], v[16:31]
  s_waitcnt lgkmcnt(2)
  v_mfma_f32_32x32x16_bf16 v[0:15], a[8:11], v[40:43], v[0:15]
  ds_read_b128 v[36:39], v204 offset:1024
  v_mfma_f32_32x32x16_bf16 v[16:31], a[152:155], v[40:43], v[16:31]
  s_waitcnt lgkmcnt(2)
  v_mfma_f32_32x32x16_bf16 v[0:15], a[12:15], v[44:47], v[0:15]
  ds_read_b128 v[40:43], v205 offset:1024
  v_mfma_f32_32x32x16_bf16 v[16:31], a[156:159], v[44:47], v[16:31]
  s_waitcnt lgkmcnt(2)
  v_mfma_f32_32x32x16_bf16 v[0:15], a[16:19], v[32:35], v[0:15]
  ds_read_b128 v[44:47], v206 offset:1024
  v_mfma_f32_32x32x16_bf16 v[16:31], a[160:163], v[32:35], v[16:31]
  s_waitcnt lgkmcnt(2)
  v_mfma_f32_32x32x16_bf16 v[0:15], a[20:23], v[36:39], v[0:15]
  ds_read_b128 v[32:35], v203 offset:2048
  v_mfma_f32_32x32x16_bf16 v[16:31], a[164:167], v[36:39], v[16:31]
  s_waitcnt lgkmcnt(2)
  v_mfma_f32_32x32x16_bf16 v[0:15], a[24:27], v[40:43], v[0:15]
  ds_read_b128 v[36:39], v204 offset:2048
  v_mfma_f32_32x32x16_bf16 v[16:31], a[168:171], v[40:43], v[16:31]
  s_waitcnt lgkmcnt(2)
  v_mfma_f32_32x32x16_bf16 v[0:15], a[28:31], v[44:47], v[0:15]
  ds_read_b128 v[40:43], v205 offset:2048
  v_mfma_f32_32x32x16_bf16 v[16:31], a[172:175], v[44:47], v[16:31]
  s_waitcnt lgkmcnt(2)
  v_mfma_f32_32x32x16_bf16 v[0:15], a[32:35], v[32:35], v[0:15]
  ds_read_b128 v[44:47], v206 offset:2048
  v_mfma_f32_32x32x16_bf16 v[16:31], a[176:179], v[32:35], v[16:31]
  s_waitcnt lgkmcnt(2)
  v_mfma_f32_32x32x16_bf16 v[0:15], a[36:39], v[36:39], v[0:15]
  ds_read_b128 v[32:35], v203 offset:3072
  v_mfma_f32_32x32x16_bf16 v[16:31], a[180:183], v[36:39], v[16:31]
  s_waitcnt lgkmcnt(2)
  v_mfma_f32_32x32x16_bf16 v[0:15], a[40:43], v[40:43], v[0:15]
  ds_read_b128 v[36:39], v204 offset:3072
  v_mfma_f32_32x32x16_bf16 v[16:31], a[184:187], v[40:43], v[16:31]
  s_waitcnt lgkmcnt(2)
  v_mfma_f32_32x32x16_bf16 v[0:15], a[44:47], v[44:47], v[0:15]
  ds_read_b128 v[40:43], v205 offset:3072
  v_mfma_f32_32x32x16_bf16 v[16:31], a[188:191], v[44:47], v[16:31]
  s_waitcnt lgkmcnt(2)
  v_mfma_f32_32x32x16_bf16 v[0:15], a[48:51], v[32:35], v[0:15]
  ds_read_b128 v[44:47], v206 offset:3072
  v_mfma_f32_32x32x16_bf16 v[16:31], a[192:195], v[32:35], v[16:31]
  s_waitcnt lgkmcnt(2)
  v_mfma_f32_32x32x16_bf16 v[0:15], a[52:55], v[36:39], v[0:15]
  ds_read_b128 v[32:35], v203 offset:4096
  v_mfma_f32_32x32x16_bf16 v[16:31], a[196:199], v[36:39], v[16:31]
  s_waitcnt lgkmcnt(2)
  v_mfma_f32_32x32x16_bf16 v[0:15], a[56:59], v[40:43], v[0:15]
  ds_read_b128 v[36:39], v204 offset:4096
  v_mfma_f32_32x32x16_bf16 v[16:31], a[200:203], v[40:43], v[16:31]
  s_waitcnt lgkmcnt(2)
  v_mfma_f32_32x32x16_bf16 v[0:15], a[60:63], v[44:47], v[0:15]
  ds_read_b128 v[40:43], v205 offset:4096
  v_mfma_f32_32x32x16_bf16 v[16:31], a[204:207], v[44:47], v[16:31]
  s_waitcnt lgkmcnt(2)
  v_mfma_f32_32x32x16_bf16 v[0:15], a[64:67], v[32:35], v[0:15]
  ds_read_b128 v[44:47], v206 offset:4096
  v_mfma_f32_32x32x16_bf16 v[16:31], a[208:211], v[32:35], v[16:31]
  s_waitcnt lgkmcnt(2)
  v_mfma_f32_32x32x16_bf16 v[0:15], a[68:71], v[36:39], v[0:15]
  ds_read_b128 v[32:35], v203 offset:5120
  v_mfma_f32_32x32x16_bf16 v[16:31], a[212:215], v[36:39], v[16:31]
  s_waitcnt lgkmcnt(2)
  v_mfma_f32_32x32x16_bf16 v[0:15], a[72:75], v[40:43], v[0:15]
  ds_read_b128 v[36:39], v204 offset:5120
  v_mfma_f32_32x32x16_bf16 v[16:31], a[216:219], v[40:43], v[16:31]
  s_waitcnt lgkmcnt(2)
  v_mfma_f32_32x32x16_bf16 v[0:15], a[76:79], v[44:47], v[0:15]
  ds_read_b128 v[40:43], v205 offset:5120
  v_mfma_f32_32x32x16_bf16 v[16:31], a[220:223], v[44:47], v[16:31]
  s_waitcnt lgkmcnt(2)
  v_mfma_f32_32x32x16_bf16 v[0:15], a[80:83], v[32:35], v[0:15]
  ds_read_b128 v[44:47], v206 offset:5120
  v_mfma_f32_32x32x16_bf16 v[16:31], a[224:227], v[32:35], v[16:31]
  s_waitcnt lgkmcnt(2)
  v_mfma_f32_32x32x16_bf16 v[0:15], a[84:87], v[36:39], v[0:15]
  ds_read_b128 v[32:35], v203 offset:6144
  v_mfma_f32_32x32x16_bf16 v[16:31], a[228:231], v[36:39], v[16:31]
  s_waitcnt lgkmcnt(2)
  v_mfma_f32_32x32x16_bf16 v[0:15], a[88:91], v[40:43], v[0:15]
  ds_read_b128 v[36:39], v204 offset:6144
  v_mfma_f32_32x32x16_bf16 v[16:31], a[232:235], v[40:43], v[16:31]
  s_waitcnt lgkmcnt(2)
  v_mfma_f32_32x32x16_bf16 v[0:15], a[92:95], v[44:47], v[0:15]
  ds_read_b128 v[40:43], v205 offset:6144
  v_mfma_f32_32x32x16_bf16 v[16:31], a[236:239], v[44:47], v[16:31]
  s_waitcnt lgkmcnt(2)
  v_mfma_f32_32x32x16_bf16 v[0:15], a[96:99], v[32:35], v[0:15]
  ds_read_b128 v[44:47], v206 offset:6144
  v_mfma_f32_32x32x16_bf16 v[16:31], a[240:243], v[32:35], v[16:31]
  s_waitcnt lgkmcnt(2)
  v_mfma_f32_32x32x16_bf16 v[0:15], a[100:103], v[36:39], v[0:15]
  ds_read_b128 v[32:35], v203 offset:7168
  v_mfma_f32_32x32x16_bf16 v[16:31], a[244:247], v[36:39], v[16:31]
  s_waitcnt lgkmcnt(2)
  v_mfma_f32_32x32x16_bf16 v[0:15], a[104:107], v[40:43], v[0:15]
  ds_read_b128 v[36:39], v204 offset:7168
  v_mfma_f32_32x32x16_bf16 v[16:31], a[248:251], v[40:43], v[16:31]
  s_waitcnt lgkmcnt(2)
  v_mfma_f32_32x32x16_bf16 v[0:15], a[108:111], v[44:47], v[0:15]
  ds_read_b128 v[40:43], v205 offset:7168
  v_mfma_f32_32x32x16_bf16 v[16:31], a[252:255], v[44:47], v[16:31]
  s_waitcnt lgkmcnt(2)
  v_mfma_f32_32x32x16_bf16 v[0:15], a[112:115], v[32:35], v[0:15]
  ds_read_b128 v[44:47], v206 offset:7168
  v_mfma_f32_32x32x16_bf16 v[16:31], v[224:227], v[32:35], v[16:31]
  s_waitcnt lgkmcnt(2)
  v_mfma_f32_32x32x16_bf16 v[0:15], a[116:119], v[36:39], v[0:15]
  ds_read_b128 v[32:35], v203 offset:8192
  v_mfma_f32_32x32x16_bf16 v[16:31], v[228:231], v[36:39], v[16:31]
  s_waitcnt lgkmcnt(2)
  v_mfma_f32_32x32x16_bf16 v[0:15], a[120:123], v[40:43], v[0:15]
  ds_read_b128 v[36:39], v204 offset:8192
  v_mfma_f32_32x32x16_bf16 v[16:31], v[232:235], v[40:43], v[16:31]
  s_waitcnt lgkmcnt(2)
  v_mfma_f32_32x32x16_bf16 v[0:15], a[124:127], v[44:47], v[0:15]
  ds_read_b128 v[40:43], v205 offset:8192
  v_mfma_f32_32x32x16_bf16 v[16:31], v[236:239], v[44:47], v[16:31]
  s_waitcnt lgkmcnt(2)
  v_mfma_f32_32x32x16_bf16 v[0:15], a[128:131], v[32:35], v[0:15]
  ds_read_b128 v[44:47], v206 offset:8192
  v_mfma_f32_32x32x16_bf16 v[16:31], v[240:243], v[32:35], v[16:31]
  s_waitcnt lgkmcnt(2)
  v_mfma_f32_32x32x16_bf16 v[0:15], a[132:135], v[36:39], v[0:15]
  v_mfma_f32_32x32x16_bf16 v[16:31], v[244:247], v[36:39], v[16:31]
  s_waitcnt lgkmcnt(1)
  v_mfma_f32_32x32x16_bf16 v[0:15], a[136:139], v[40:43], v[0:15]
  v_mfma_f32_32x32x16_bf16 v[16:31], v[248:251], v[40:43], v[16:31]
  s_waitcnt lgkmcnt(0)
  v_mfma_f32_32x32x16_bf16 v[0:15], a[140:143], v[44:47], v[0:15]
  v_mfma_f32_32x32x16_bf16 v[16:31], v[252:255], v[44:47], v[16:31]
  s_add_u32 s60, s60, 36864
  s_nop 2
  v_cvt_pk_bf16_f32 v48, v0, v1
  v_cvt_pk_bf16_f32 v49, v2, v3
  ds_write2_b32 v218, v48, v49 offset0:0 offset1:1
  v_cvt_pk_bf16_f32 v48, v4, v5
  v_cvt_pk_bf16_f32 v49, v6, v7
  ds_write2_b32 v218, v48, v49 offset0:4 offset1:5
  v_cvt_pk_bf16_f32 v48, v8, v9
  v_cvt_pk_bf16_f32 v49, v10, v11
  ds_write2_b32 v218, v48, v49 offset0:8 offset1:9
  v_cvt_pk_bf16_f32 v48, v12, v13
  v_cvt_pk_bf16_f32 v49, v14, v15
  ds_write2_b32 v218, v48, v49 offset0:12 offset1:13
  v_cvt_pk_bf16_f32 v48, v16, v17
  v_cvt_pk_bf16_f32 v49, v18, v19
  ds_write2_b32 v218, v48, v49 offset0:64 offset1:65
  v_cvt_pk_bf16_f32 v48, v20, v21
  v_cvt_pk_bf16_f32 v49, v22, v23
  ds_write2_b32 v218, v48, v49 offset0:68 offset1:69
  v_cvt_pk_bf16_f32 v48, v24, v25
  v_cvt_pk_bf16_f32 v49, v26, v27
  ds_write2_b32 v218, v48, v49 offset0:72 offset1:73
  v_cvt_pk_bf16_f32 v48, v28, v29
  v_cvt_pk_bf16_f32 v49, v30, v31
  ds_write2_b32 v218, v48, v49 offset0:76 offset1:77
  v_add_u32 v218, 16512, v218
  s_waitcnt vmcnt(0) lgkmcnt(0)
  s_barrier
  v_mul_u32_u24 v219, 516, v200
  s_mul_i32 s54, s52, 36
  s_add_u32 s55, s54, 83016
  v_add_u32 v219, s55, v219
  v_mul_u32_u24 v220, 1152, v200
  s_mul_i32 s55, s68, 144
  s_add_u32 s54, s54, s55
  s_mul_i32 s55, s69, 147456
  s_add_u32 s64, s54, s55
  s_add_u32 s64, s64, 62914560
  s_lshl_b32 s66, s69, 7
  s_mov_b32 s57, 1051597459
  ds_read_b32 v0, v219 offset:7224
  ds_read_b32 v1, v219 offset:7228
  ds_read_b32 v2, v219 offset:7232
  ds_read_b32 v3, v219 offset:7236
  ds_read_b32 v4, v219 offset:7240
  ds_read_b32 v5, v219 offset:7244
  ds_read_b32 v6, v219 offset:7248
  ds_read_b32 v7, v219 offset:7252
  ds_read_b32 v8, v219 offset:7256
  ds_read_b32 v16, v219 offset:7368
  ds_read_b32 v17, v219 offset:7372
  ds_read_b32 v18, v219 offset:7376
  ds_read_b32 v19, v219 offset:7380
  ds_read_b32 v20, v219 offset:7384
  ds_read_b32 v21, v219 offset:7388
  ds_read_b32 v22, v219 offset:7392
  ds_read_b32 v23, v219 offset:7396
  ds_read_b32 v24, v219 offset:7400
  ds_read_b32 v25, v219 offset:6336
  ds_read_b32 v26, v219 offset:6340
  ds_read_b32 v27, v219 offset:6344
  ds_read_b32 v28, v219 offset:6348
  ds_read_b32 v29, v219 offset:6352
  ds_read_b32 v30, v219 offset:6356
  ds_read_b32 v31, v219 offset:6360
  ds_read_b32 v32, v219 offset:6364
  ds_read_b32 v33, v219 offset:6368
  ds_read_b32 v34, v219 offset:5304
  ds_read_b32 v35, v219 offset:5308
  ds_read_b32 v36, v219 offset:5312
  ds_read_b32 v37, v219 offset:5316
  ds_read_b32 v38, v219 offset:5320
  ds_read_b32 v39, v219 offset:5324
  ds_read_b32 v40, v219 offset:5328
  ds_read_b32 v41, v219 offset:5332
  ds_read_b32 v42, v219 offset:5336
  ds_read_b32 v43, v219 offset:4272
  ds_read_b32 v44, v219 offset:4276
  ds_read_b32 v45, v219 offset:4280
  ds_read_b32 v46, v219 offset:4284
  ds_read_b32 v47, v219 offset:4288
  ds_read_b32 v48, v219 offset:4292
  ds_read_b32 v49, v219 offset:4296
  ds_read_b32 v50, v219 offset:4300
  ds_read_b32 v51, v219 offset:4304
  ds_read_b32 v52, v219 offset:3240
  ds_read_b32 v53, v219 offset:3244
  ds_read_b32 v54, v219 offset:3248
  ds_read_b32 v55, v219 offset:3252
  ds_read_b32 v56, v219 offset:3256
  ds_read_b32 v57, v219 offset:3260
  ds_read_b32 v58, v219 offset:3264
  ds_read_b32 v59, v219 offset:3268
  ds_read_b32 v60, v219 offset:3272
  ds_read_b32 v61, v219 offset:2208
  ds_read_b32 v62, v219 offset:2212
  ds_read_b32 v63, v219 offset:2216
  ds_read_b32 v64, v219 offset:2220
  ds_read_b32 v65, v219 offset:2224
  ds_read_b32 v66, v219 offset:2228
  ds_read_b32 v67, v219 offset:2232
  ds_read_b32 v68, v219 offset:2236
  ds_read_b32 v69, v219 offset:2240
  ds_read_b32 v70, v219 offset:1176
  ds_read_b32 v71, v219 offset:1180
  ds_read_b32 v72, v219 offset:1184
  ds_read_b32 v73, v219 offset:1188
  ds_read_b32 v74, v219 offset:1192
  ds_read_b32 v75, v219 offset:1196
  ds_read_b32 v76, v219 offset:1200
  ds_read_b32 v77, v219 offset:1204
  ds_read_b32 v78, v219 offset:1208
  ds_read_b32 v79, v219 offset:144
  ds_read_b32 v80, v219 offset:148
  ds_read_b32 v81, v219 offset:152
  ds_read_b32 v82, v219 offset:156
  ds_read_b32 v83, v219 offset:160
  ds_read_b32 v84, v219 offset:164
  ds_read_b32 v85, v219 offset:168
  ds_read_b32 v86, v219 offset:172
  ds_read_b32 v87, v219 offset:176
  v_mov_b32 v100, 0
  v_mov_b32 v101, 0
  v_mov_b32 v102, 0
  v_mov_b32 v103, 0
  v_mov_b32 v104, 0
  v_mov_b32 v105, 0
  v_mov_b32 v106, 0
  v_mov_b32 v107, 0
  s_waitcnt lgkmcnt(15)
  v_dot2c_f32_bf16 v100, v0, v16
  v_dot2c_f32_bf16 v101, v0, v25
  v_dot2c_f32_bf16 v102, v0, v34
  v_dot2c_f32_bf16 v103, v0, v43
  v_dot2c_f32_bf16 v104, v0, v52
  v_dot2c_f32_bf16 v105, v0, v61
  v_dot2c_f32_bf16 v106, v0, v70
  s_waitcnt lgkmcnt(8)
  v_dot2c_f32_bf16 v107, v0, v79
  v_dot2c_f32_bf16 v100, v1, v17
  v_dot2c_f32_bf16 v101, v1, v26
  v_dot2c_f32_bf16 v102, v1, v35
  v_dot2c_f32_bf16 v103, v1, v44
  v_dot2c_f32_bf16 v104, v1, v53
  v_dot2c_f32_bf16 v105, v1, v62
  v_dot2c_f32_bf16 v106, v1, v71
  s_waitcnt lgkmcnt(7)
  v_dot2c_f32_bf16 v107, v1, v80
  v_dot2c_f32_bf16 v100, v2, v18
  v_dot2c_f32_bf16 v101, v2, v27
  v_dot2c_f32_bf16 v102, v2, v36
  v_dot2c_f32_bf16 v103, v2, v45
  v_dot2c_f32_bf16 v104, v2, v54
  v_dot2c_f32_bf16 v105, v2, v63
  v_dot2c_f32_bf16 v106, v2, v72
  s_waitcnt lgkmcnt(6)
  v_dot2c_f32_bf16 v107, v2, v81
  v_dot2c_f32_bf16 v100, v3, v19
  v_dot2c_f32_bf16 v101, v3, v28
  v_dot2c_f32_bf16 v102, v3, v37
  v_dot2c_f32_bf16 v103, v3, v46
  v_dot2c_f32_bf16 v104, v3, v55
  v_dot2c_f32_bf16 v105, v3, v64
  v_dot2c_f32_bf16 v106, v3, v73
  s_waitcnt lgkmcnt(5)
  v_dot2c_f32_bf16 v107, v3, v82
  v_dot2c_f32_bf16 v100, v4, v20
  v_dot2c_f32_bf16 v101, v4, v29
  v_dot2c_f32_bf16 v102, v4, v38
  v_dot2c_f32_bf16 v103, v4, v47
  v_dot2c_f32_bf16 v104, v4, v56
  v_dot2c_f32_bf16 v105, v4, v65
  v_dot2c_f32_bf16 v106, v4, v74
  s_waitcnt lgkmcnt(4)
  v_dot2c_f32_bf16 v107, v4, v83
  v_dot2c_f32_bf16 v100, v5, v21
  v_dot2c_f32_bf16 v101, v5, v30
  v_dot2c_f32_bf16 v102, v5, v39
  v_dot2c_f32_bf16 v103, v5, v48
  v_dot2c_f32_bf16 v104, v5, v57
  v_dot2c_f32_bf16 v105, v5, v66
  v_dot2c_f32_bf16 v106, v5, v75
  s_waitcnt lgkmcnt(3)
  v_dot2c_f32_bf16 v107, v5, v84
  v_dot2c_f32_bf16 v100, v6, v22
  v_dot2c_f32_bf16 v101, v6, v31
  v_dot2c_f32_bf16 v102, v6, v40
  v_dot2c_f32_bf16 v103, v6, v49
  v_dot2c_f32_bf16 v104, v6, v58
  v_dot2c_f32_bf16 v105, v6, v67
  v_dot2c_f32_bf16 v106, v6, v76
  s_waitcnt lgkmcnt(2)
  v_dot2c_f32_bf16 v107, v6, v85
  v_dot2c_f32_bf16 v100, v7, v23
  v_dot2c_f32_bf16 v101, v7, v32
  v_dot2c_f32_bf16 v102, v7, v41
  v_dot2c_f32_bf16 v103, v7, v50
  v_dot2c_f32_bf16 v104, v7, v59
  v_dot2c_f32_bf16 v105, v7, v68
  v_dot2c_f32_bf16 v106, v7, v77
  s_waitcnt lgkmcnt(1)
  v_dot2c_f32_bf16 v107, v7, v86
  v_dot2c_f32_bf16 v100, v8, v24
  v_dot2c_f32_bf16 v101, v8, v33
  v_dot2c_f32_bf16 v102, v8, v42
  v_dot2c_f32_bf16 v103, v8, v51
  v_dot2c_f32_bf16 v104, v8, v60
  v_dot2c_f32_bf16 v105, v8, v69
  v_dot2c_f32_bf16 v106, v8, v78
  s_waitcnt lgkmcnt(0)
  v_dot2c_f32_bf16 v107, v8, v87
  ds_read_b32 v16, v219 offset:7512
  ds_read_b32 v17, v219 offset:7516
  ds_read_b32 v18, v219 offset:7520
  ds_read_b32 v19, v219 offset:7524
  ds_read_b32 v20, v219 offset:7528
  ds_read_b32 v21, v219 offset:7532
  ds_read_b32 v22, v219 offset:7536
  ds_read_b32 v23, v219 offset:7540
  ds_read_b32 v24, v219 offset:7544
  ds_read_b32 v25, v219 offset:6480
  ds_read_b32 v26, v219 offset:6484
  ds_read_b32 v27, v219 offset:6488
  ds_read_b32 v28, v219 offset:6492
  ds_read_b32 v29, v219 offset:6496
  ds_read_b32 v30, v219 offset:6500
  ds_read_b32 v31, v219 offset:6504
  ds_read_b32 v32, v219 offset:6508
  ds_read_b32 v33, v219 offset:6512
  ds_read_b32 v34, v219 offset:5448
  ds_read_b32 v35, v219 offset:5452
  ds_read_b32 v36, v219 offset:5456
  ds_read_b32 v37, v219 offset:5460
  ds_read_b32 v38, v219 offset:5464
  ds_read_b32 v39, v219 offset:5468
  ds_read_b32 v40, v219 offset:5472
  ds_read_b32 v41, v219 offset:5476
  ds_read_b32 v42, v219 offset:5480
  ds_read_b32 v43, v219 offset:4416
  ds_read_b32 v44, v219 offset:4420
  ds_read_b32 v45, v219 offset:4424
  ds_read_b32 v46, v219 offset:4428
  ds_read_b32 v47, v219 offset:4432
  ds_read_b32 v48, v219 offset:4436
  ds_read_b32 v49, v219 offset:4440
  ds_read_b32 v50, v219 offset:4444
  ds_read_b32 v51, v219 offset:4448
  ds_read_b32 v52, v219 offset:3384
  ds_read_b32 v53, v219 offset:3388
  ds_read_b32 v54, v219 offset:3392
  ds_read_b32 v55, v219 offset:3396
  ds_read_b32 v56, v219 offset:3400
  ds_read_b32 v57, v219 offset:3404
  ds_read_b32 v58, v219 offset:3408
  ds_read_b32 v59, v219 offset:3412
  ds_read_b32 v60, v219 offset:3416
  ds_read_b32 v61, v219 offset:2352
  ds_read_b32 v62, v219 offset:2356
  ds_read_b32 v63, v219 offset:2360
  ds_read_b32 v64, v219 offset:2364
  ds_read_b32 v65, v219 offset:2368
  ds_read_b32 v66, v219 offset:2372
  ds_read_b32 v67, v219 offset:2376
  ds_read_b32 v68, v219 offset:2380
  ds_read_b32 v69, v219 offset:2384
  ds_read_b32 v70, v219 offset:1320
  ds_read_b32 v71, v219 offset:1324
  ds_read_b32 v72, v219 offset:1328
  ds_read_b32 v73, v219 offset:1332
  ds_read_b32 v74, v219 offset:1336
  ds_read_b32 v75, v219 offset:1340
  ds_read_b32 v76, v219 offset:1344
  ds_read_b32 v77, v219 offset:1348
  ds_read_b32 v78, v219 offset:1352
  ds_read_b32 v79, v219 offset:288
  ds_read_b32 v80, v219 offset:292
  ds_read_b32 v81, v219 offset:296
  ds_read_b32 v82, v219 offset:300
  ds_read_b32 v83, v219 offset:304
  ds_read_b32 v84, v219 offset:308
  ds_read_b32 v85, v219 offset:312
  ds_read_b32 v86, v219 offset:316
  ds_read_b32 v87, v219 offset:320
  v_add_u32 v211, s66, v200
  v_mov_b32 v212, 0xf149f2ca
  v_mul_f32 v100, s57, v100
  v_mul_f32 v101, s57, v101
  v_mul_f32 v102, s57, v102
  v_mul_f32 v103, s57, v103
  v_mul_f32 v104, s57, v104
  v_mul_f32 v105, s57, v105
  v_mul_f32 v106, s57, v106
  v_mul_f32 v107, s57, v107
  v_cmp_gt_u32 vcc, 2, v211
  s_nop 1
  v_cndmask_b32 v101, v101, v212, vcc
  v_cmp_gt_u32 vcc, 4, v211
  s_nop 1
  v_cndmask_b32 v102, v102, v212, vcc
  v_cmp_gt_u32 vcc, 6, v211
  s_nop 1
  v_cndmask_b32 v103, v103, v212, vcc
  v_cmp_gt_u32 vcc, 8, v211
  s_nop 1
  v_cndmask_b32 v104, v104, v212, vcc
  v_cmp_gt_u32 vcc, 10, v211
  s_nop 1
  v_cndmask_b32 v105, v105, v212, vcc
  v_cmp_gt_u32 vcc, 12, v211
  s_nop 1
  v_cndmask_b32 v106, v106, v212, vcc
  v_cmp_gt_u32 vcc, 14, v211
  s_nop 1
  v_cndmask_b32 v107, v107, v212, vcc
  v_max3_f32 v213, v100, v101, v102
  v_max3_f32 v213, v213, v103, v104
  v_max3_f32 v213, v213, v105, v106
  v_max_f32 v213, v213, v107
  v_sub_f32 v100, v100, v213
  v_sub_f32 v101, v101, v213
  v_sub_f32 v102, v102, v213
  v_sub_f32 v103, v103, v213
  v_sub_f32 v104, v104, v213
  v_sub_f32 v105, v105, v213
  v_sub_f32 v106, v106, v213
  v_sub_f32 v107, v107, v213
  v_exp_f32 v100, v100
  v_exp_f32 v101, v101
  v_exp_f32 v102, v102
  v_exp_f32 v103, v103
  v_exp_f32 v104, v104
  v_exp_f32 v105, v105
  v_exp_f32 v106, v106
  v_exp_f32 v107, v107
  v_add_f32 v213, v100, v101
  v_add_f32 v213, v213, v102
  v_add_f32 v213, v213, v103
  v_add_f32 v213, v213, v104
  v_add_f32 v213, v213, v105
  v_add_f32 v213, v213, v106
  v_add_f32 v213, v213, v107
  v_rcp_f32 v213, v213
  v_mov_b32 v214, 0
  v_mul_f32 v100, v213, v100
  v_mul_f32 v101, v213, v101
  v_mul_f32 v102, v213, v102
  v_mul_f32 v103, v213, v103
  v_mul_f32 v104, v213, v104
  v_mul_f32 v105, v213, v105
  v_mul_f32 v106, v213, v106
  v_mul_f32 v107, v213, v107
  v_mov_b32 v112, 0
  v_mov_b32 v113, 0
  v_mov_b32 v114, 0
  v_mov_b32 v115, 0
  v_mov_b32 v116, 0
  v_mov_b32 v117, 0
  v_mov_b32 v118, 0
  v_mov_b32 v119, 0
  v_mov_b32 v120, 0
  v_mov_b32 v121, 0
  v_mov_b32 v122, 0
  v_mov_b32 v123, 0
  v_mov_b32 v124, 0
  v_mov_b32 v125, 0
  v_mov_b32 v126, 0
  v_mov_b32 v127, 0
  v_mov_b32 v128, 0
  v_mov_b32 v129, 0
  v_cvt_pk_bf16_f32 v0, v100, v214
  v_cvt_pk_bf16_f32 v1, v214, v100
  s_waitcnt lgkmcnt(15)
  v_dot2c_f32_bf16 v112, v16, v0
  v_dot2c_f32_bf16 v113, v16, v1
  v_dot2c_f32_bf16 v114, v17, v0
  v_dot2c_f32_bf16 v115, v17, v1
  v_dot2c_f32_bf16 v116, v18, v0
  v_dot2c_f32_bf16 v117, v18, v1
  v_dot2c_f32_bf16 v118, v19, v0
  v_dot2c_f32_bf16 v119, v19, v1
  v_dot2c_f32_bf16 v120, v20, v0
  v_dot2c_f32_bf16 v121, v20, v1
  v_dot2c_f32_bf16 v122, v21, v0
  v_dot2c_f32_bf16 v123, v21, v1
  v_dot2c_f32_bf16 v124, v22, v0
  v_dot2c_f32_bf16 v125, v22, v1
  v_dot2c_f32_bf16 v126, v23, v0
  v_dot2c_f32_bf16 v127, v23, v1
  v_dot2c_f32_bf16 v128, v24, v0
  v_dot2c_f32_bf16 v129, v24, v1
  v_cvt_pk_bf16_f32 v2, v101, v214
  v_cvt_pk_bf16_f32 v3, v214, v101
  v_dot2c_f32_bf16 v112, v25, v2
  v_dot2c_f32_bf16 v113, v25, v3
  v_dot2c_f32_bf16 v114, v26, v2
  v_dot2c_f32_bf16 v115, v26, v3
  v_dot2c_f32_bf16 v116, v27, v2
  v_dot2c_f32_bf16 v117, v27, v3
  v_dot2c_f32_bf16 v118, v28, v2
  v_dot2c_f32_bf16 v119, v28, v3
  v_dot2c_f32_bf16 v120, v29, v2
  v_dot2c_f32_bf16 v121, v29, v3
  v_dot2c_f32_bf16 v122, v30, v2
  v_dot2c_f32_bf16 v123, v30, v3
  v_dot2c_f32_bf16 v124, v31, v2
  v_dot2c_f32_bf16 v125, v31, v3
  v_dot2c_f32_bf16 v126, v32, v2
  v_dot2c_f32_bf16 v127, v32, v3
  v_dot2c_f32_bf16 v128, v33, v2
  v_dot2c_f32_bf16 v129, v33, v3
  v_cvt_pk_bf16_f32 v0, v102, v214
  v_cvt_pk_bf16_f32 v1, v214, v102
  v_dot2c_f32_bf16 v112, v34, v0
  v_dot2c_f32_bf16 v113, v34, v1
  v_dot2c_f32_bf16 v114, v35, v0
  v_dot2c_f32_bf16 v115, v35, v1
  v_dot2c_f32_bf16 v116, v36, v0
  v_dot2c_f32_bf16 v117, v36, v1
  v_dot2c_f32_bf16 v118, v37, v0
  v_dot2c_f32_bf16 v119, v37, v1
  v_dot2c_f32_bf16 v120, v38, v0
  v_dot2c_f32_bf16 v121, v38, v1
  v_dot2c_f32_bf16 v122, v39, v0
  v_dot2c_f32_bf16 v123, v39, v1
  v_dot2c_f32_bf16 v124, v40, v0
  v_dot2c_f32_bf16 v125, v40, v1
  v_dot2c_f32_bf16 v126, v41, v0
  v_dot2c_f32_bf16 v127, v41, v1
  v_dot2c_f32_bf16 v128, v42, v0
  v_dot2c_f32_bf16 v129, v42, v1
  v_cvt_pk_bf16_f32 v2, v103, v214
  v_cvt_pk_bf16_f32 v3, v214, v103
  v_dot2c_f32_bf16 v112, v43, v2
  v_dot2c_f32_bf16 v113, v43, v3
  v_dot2c_f32_bf16 v114, v44, v2
  v_dot2c_f32_bf16 v115, v44, v3
  v_dot2c_f32_bf16 v116, v45, v2
  v_dot2c_f32_bf16 v117, v45, v3
  v_dot2c_f32_bf16 v118, v46, v2
  v_dot2c_f32_bf16 v119, v46, v3
  v_dot2c_f32_bf16 v120, v47, v2
  v_dot2c_f32_bf16 v121, v47, v3
  v_dot2c_f32_bf16 v122, v48, v2
  v_dot2c_f32_bf16 v123, v48, v3
  v_dot2c_f32_bf16 v124, v49, v2
  v_dot2c_f32_bf16 v125, v49, v3
  v_dot2c_f32_bf16 v126, v50, v2
  v_dot2c_f32_bf16 v127, v50, v3
  v_dot2c_f32_bf16 v128, v51, v2
  v_dot2c_f32_bf16 v129, v51, v3
  v_cvt_pk_bf16_f32 v0, v104, v214
  v_cvt_pk_bf16_f32 v1, v214, v104
  v_dot2c_f32_bf16 v112, v52, v0
  v_dot2c_f32_bf16 v113, v52, v1
  v_dot2c_f32_bf16 v114, v53, v0
  v_dot2c_f32_bf16 v115, v53, v1
  v_dot2c_f32_bf16 v116, v54, v0
  v_dot2c_f32_bf16 v117, v54, v1
  v_dot2c_f32_bf16 v118, v55, v0
  v_dot2c_f32_bf16 v119, v55, v1
  v_dot2c_f32_bf16 v120, v56, v0
  v_dot2c_f32_bf16 v121, v56, v1
  v_dot2c_f32_bf16 v122, v57, v0
  v_dot2c_f32_bf16 v123, v57, v1
  v_dot2c_f32_bf16 v124, v58, v0
  v_dot2c_f32_bf16 v125, v58, v1
  v_dot2c_f32_bf16 v126, v59, v0
  v_dot2c_f32_bf16 v127, v59, v1
  v_dot2c_f32_bf16 v128, v60, v0
  v_dot2c_f32_bf16 v129, v60, v1
  v_cvt_pk_bf16_f32 v2, v105, v214
  v_cvt_pk_bf16_f32 v3, v214, v105
  v_dot2c_f32_bf16 v112, v61, v2
  v_dot2c_f32_bf16 v113, v61, v3
  v_dot2c_f32_bf16 v114, v62, v2
  v_dot2c_f32_bf16 v115, v62, v3
  v_dot2c_f32_bf16 v116, v63, v2
  v_dot2c_f32_bf16 v117, v63, v3
  v_dot2c_f32_bf16 v118, v64, v2
  v_dot2c_f32_bf16 v119, v64, v3
  v_dot2c_f32_bf16 v120, v65, v2
  v_dot2c_f32_bf16 v121, v65, v3
  v_dot2c_f32_bf16 v122, v66, v2
  v_dot2c_f32_bf16 v123, v66, v3
  v_dot2c_f32_bf16 v124, v67, v2
  v_dot2c_f32_bf16 v125, v67, v3
  v_dot2c_f32_bf16 v126, v68, v2
  v_dot2c_f32_bf16 v127, v68, v3
  v_dot2c_f32_bf16 v128, v69, v2
  v_dot2c_f32_bf16 v129, v69, v3
  v_cvt_pk_bf16_f32 v0, v106, v214
  v_cvt_pk_bf16_f32 v1, v214, v106
  v_dot2c_f32_bf16 v112, v70, v0
  v_dot2c_f32_bf16 v113, v70, v1
  v_dot2c_f32_bf16 v114, v71, v0
  v_dot2c_f32_bf16 v115, v71, v1
  v_dot2c_f32_bf16 v116, v72, v0
  v_dot2c_f32_bf16 v117, v72, v1
  s_waitcnt lgkmcnt(14)
  v_dot2c_f32_bf16 v118, v73, v0
  v_dot2c_f32_bf16 v119, v73, v1
  s_waitcnt lgkmcnt(13)
  v_dot2c_f32_bf16 v120, v74, v0
  v_dot2c_f32_bf16 v121, v74, v1
  s_waitcnt lgkmcnt(12)
  v_dot2c_f32_bf16 v122, v75, v0
  v_dot2c_f32_bf16 v123, v75, v1
  s_waitcnt lgkmcnt(11)
  v_dot2c_f32_bf16 v124, v76, v0
  v_dot2c_f32_bf16 v125, v76, v1
  s_waitcnt lgkmcnt(10)
  v_dot2c_f32_bf16 v126, v77, v0
  v_dot2c_f32_bf16 v127, v77, v1
  s_waitcnt lgkmcnt(9)
  v_dot2c_f32_bf16 v128, v78, v0
  v_dot2c_f32_bf16 v129, v78, v1
  v_cvt_pk_bf16_f32 v2, v107, v214
  v_cvt_pk_bf16_f32 v3, v214, v107
  s_waitcnt lgkmcnt(8)
  v_dot2c_f32_bf16 v112, v79, v2
  v_dot2c_f32_bf16 v113, v79, v3
  s_waitcnt lgkmcnt(7)
  v_dot2c_f32_bf16 v114, v80, v2
  v_dot2c_f32_bf16 v115, v80, v3
  s_waitcnt lgkmcnt(6)
  v_dot2c_f32_bf16 v116, v81, v2
  v_dot2c_f32_bf16 v117, v81, v3
  s_waitcnt lgkmcnt(5)
  v_dot2c_f32_bf16 v118, v82, v2
  v_dot2c_f32_bf16 v119, v82, v3
  s_waitcnt lgkmcnt(4)
  v_dot2c_f32_bf16 v120, v83, v2
  v_dot2c_f32_bf16 v121, v83, v3
  s_waitcnt lgkmcnt(3)
  v_dot2c_f32_bf16 v122, v84, v2
  v_dot2c_f32_bf16 v123, v84, v3
  s_waitcnt lgkmcnt(2)
  v_dot2c_f32_bf16 v124, v85, v2
  v_dot2c_f32_bf16 v125, v85, v3
  s_waitcnt lgkmcnt(1)
  v_dot2c_f32_bf16 v126, v86, v2
  v_dot2c_f32_bf16 v127, v86, v3
  s_waitcnt lgkmcnt(0)
  v_dot2c_f32_bf16 v128, v87, v2
  v_dot2c_f32_bf16 v129, v87, v3
  v_cvt_pk_bf16_f32 v132, v112, v113
  v_cvt_pk_bf16_f32 v133, v114, v115
  v_cvt_pk_bf16_f32 v134, v116, v117
  v_cvt_pk_bf16_f32 v135, v118, v119
  v_cvt_pk_bf16_f32 v136, v120, v121
  v_cvt_pk_bf16_f32 v137, v122, v123
  v_cvt_pk_bf16_f32 v138, v124, v125
  v_cvt_pk_bf16_f32 v139, v126, v127
  v_cvt_pk_bf16_f32 v140, v128, v129
  buffer_store_dwordx4 v[132:135], v220, s[8:11], s64 offen sc1
  buffer_store_dwordx4 v[136:139], v220, s[8:11], s64 offen offset:16 sc1
  buffer_store_dword v140, v220, s[8:11], s64 offen offset:32 sc1
  v_add_u32 v219, 33024, v219
  s_add_u32 s66, s66, 64
  s_add_u32 s64, s64, 73728
  ds_read_b32 v0, v219 offset:7224
  ds_read_b32 v1, v219 offset:7228
  ds_read_b32 v2, v219 offset:7232
  ds_read_b32 v3, v219 offset:7236
  ds_read_b32 v4, v219 offset:7240
  ds_read_b32 v5, v219 offset:7244
  ds_read_b32 v6, v219 offset:7248
  ds_read_b32 v7, v219 offset:7252
  ds_read_b32 v8, v219 offset:7256
  ds_read_b32 v16, v219 offset:7368
  ds_read_b32 v17, v219 offset:7372
  ds_read_b32 v18, v219 offset:7376
  ds_read_b32 v19, v219 offset:7380
  ds_read_b32 v20, v219 offset:7384
  ds_read_b32 v21, v219 offset:7388
  ds_read_b32 v22, v219 offset:7392
  ds_read_b32 v23, v219 offset:7396
  ds_read_b32 v24, v219 offset:7400
  ds_read_b32 v25, v219 offset:6336
  ds_read_b32 v26, v219 offset:6340
  ds_read_b32 v27, v219 offset:6344
  ds_read_b32 v28, v219 offset:6348
  ds_read_b32 v29, v219 offset:6352
  ds_read_b32 v30, v219 offset:6356
  ds_read_b32 v31, v219 offset:6360
  ds_read_b32 v32, v219 offset:6364
  ds_read_b32 v33, v219 offset:6368
  ds_read_b32 v34, v219 offset:5304
  ds_read_b32 v35, v219 offset:5308
  ds_read_b32 v36, v219 offset:5312
  ds_read_b32 v37, v219 offset:5316
  ds_read_b32 v38, v219 offset:5320
  ds_read_b32 v39, v219 offset:5324
  ds_read_b32 v40, v219 offset:5328
  ds_read_b32 v41, v219 offset:5332
  ds_read_b32 v42, v219 offset:5336
  ds_read_b32 v43, v219 offset:4272
  ds_read_b32 v44, v219 offset:4276
  ds_read_b32 v45, v219 offset:4280
  ds_read_b32 v46, v219 offset:4284
  ds_read_b32 v47, v219 offset:4288
  ds_read_b32 v48, v219 offset:4292
  ds_read_b32 v49, v219 offset:4296
  ds_read_b32 v50, v219 offset:4300
  ds_read_b32 v51, v219 offset:4304
  ds_read_b32 v52, v219 offset:3240
  ds_read_b32 v53, v219 offset:3244
  ds_read_b32 v54, v219 offset:3248
  ds_read_b32 v55, v219 offset:3252
  ds_read_b32 v56, v219 offset:3256
  ds_read_b32 v57, v219 offset:3260
  ds_read_b32 v58, v219 offset:3264
  ds_read_b32 v59, v219 offset:3268
  ds_read_b32 v60, v219 offset:3272
  ds_read_b32 v61, v219 offset:2208
  ds_read_b32 v62, v219 offset:2212
  ds_read_b32 v63, v219 offset:2216
  ds_read_b32 v64, v219 offset:2220
  ds_read_b32 v65, v219 offset:2224
  ds_read_b32 v66, v219 offset:2228
  ds_read_b32 v67, v219 offset:2232
  ds_read_b32 v68, v219 offset:2236
  ds_read_b32 v69, v219 offset:2240
  ds_read_b32 v70, v219 offset:1176
  ds_read_b32 v71, v219 offset:1180
  ds_read_b32 v72, v219 offset:1184
  ds_read_b32 v73, v219 offset:1188
  ds_read_b32 v74, v219 offset:1192
  ds_read_b32 v75, v219 offset:1196
  ds_read_b32 v76, v219 offset:1200
  ds_read_b32 v77, v219 offset:1204
  ds_read_b32 v78, v219 offset:1208
  ds_read_b32 v79, v219 offset:144
  ds_read_b32 v80, v219 offset:148
  ds_read_b32 v81, v219 offset:152
  ds_read_b32 v82, v219 offset:156
  ds_read_b32 v83, v219 offset:160
  ds_read_b32 v84, v219 offset:164
  ds_read_b32 v85, v219 offset:168
  ds_read_b32 v86, v219 offset:172
  ds_read_b32 v87, v219 offset:176
  v_mov_b32 v100, 0
  v_mov_b32 v101, 0
  v_mov_b32 v102, 0
  v_mov_b32 v103, 0
  v_mov_b32 v104, 0
  v_mov_b32 v105, 0
  v_mov_b32 v106, 0
  v_mov_b32 v107, 0
  s_waitcnt lgkmcnt(15)
  v_dot2c_f32_bf16 v100, v0, v16
  v_dot2c_f32_bf16 v101, v0, v25
  v_dot2c_f32_bf16 v102, v0, v34
  v_dot2c_f32_bf16 v103, v0, v43
  v_dot2c_f32_bf16 v104, v0, v52
  v_dot2c_f32_bf16 v105, v0, v61
  v_dot2c_f32_bf16 v106, v0, v70
  s_waitcnt lgkmcnt(8)
  v_dot2c_f32_bf16 v107, v0, v79
  v_dot2c_f32_bf16 v100, v1, v17
  v_dot2c_f32_bf16 v101, v1, v26
  v_dot2c_f32_bf16 v102, v1, v35
  v_dot2c_f32_bf16 v103, v1, v44
  v_dot2c_f32_bf16 v104, v1, v53
  v_dot2c_f32_bf16 v105, v1, v62
  v_dot2c_f32_bf16 v106, v1, v71
  s_waitcnt lgkmcnt(7)
  v_dot2c_f32_bf16 v107, v1, v80
  v_dot2c_f32_bf16 v100, v2, v18
  v_dot2c_f32_bf16 v101, v2, v27
  v_dot2c_f32_bf16 v102, v2, v36
  v_dot2c_f32_bf16 v103, v2, v45
  v_dot2c_f32_bf16 v104, v2, v54
  v_dot2c_f32_bf16 v105, v2, v63
  v_dot2c_f32_bf16 v106, v2, v72
  s_waitcnt lgkmcnt(6)
  v_dot2c_f32_bf16 v107, v2, v81
  v_dot2c_f32_bf16 v100, v3, v19
  v_dot2c_f32_bf16 v101, v3, v28
  v_dot2c_f32_bf16 v102, v3, v37
  v_dot2c_f32_bf16 v103, v3, v46
  v_dot2c_f32_bf16 v104, v3, v55
  v_dot2c_f32_bf16 v105, v3, v64
  v_dot2c_f32_bf16 v106, v3, v73
  s_waitcnt lgkmcnt(5)
  v_dot2c_f32_bf16 v107, v3, v82
  v_dot2c_f32_bf16 v100, v4, v20
  v_dot2c_f32_bf16 v101, v4, v29
  v_dot2c_f32_bf16 v102, v4, v38
  v_dot2c_f32_bf16 v103, v4, v47
  v_dot2c_f32_bf16 v104, v4, v56
  v_dot2c_f32_bf16 v105, v4, v65
  v_dot2c_f32_bf16 v106, v4, v74
  s_waitcnt lgkmcnt(4)
  v_dot2c_f32_bf16 v107, v4, v83
  v_dot2c_f32_bf16 v100, v5, v21
  v_dot2c_f32_bf16 v101, v5, v30
  v_dot2c_f32_bf16 v102, v5, v39
  v_dot2c_f32_bf16 v103, v5, v48
  v_dot2c_f32_bf16 v104, v5, v57
  v_dot2c_f32_bf16 v105, v5, v66
  v_dot2c_f32_bf16 v106, v5, v75
  s_waitcnt lgkmcnt(3)
  v_dot2c_f32_bf16 v107, v5, v84
  v_dot2c_f32_bf16 v100, v6, v22
  v_dot2c_f32_bf16 v101, v6, v31
  v_dot2c_f32_bf16 v102, v6, v40
  v_dot2c_f32_bf16 v103, v6, v49
  v_dot2c_f32_bf16 v104, v6, v58
  v_dot2c_f32_bf16 v105, v6, v67
  v_dot2c_f32_bf16 v106, v6, v76
  s_waitcnt lgkmcnt(2)
  v_dot2c_f32_bf16 v107, v6, v85
  v_dot2c_f32_bf16 v100, v7, v23
  v_dot2c_f32_bf16 v101, v7, v32
  v_dot2c_f32_bf16 v102, v7, v41
  v_dot2c_f32_bf16 v103, v7, v50
  v_dot2c_f32_bf16 v104, v7, v59
  v_dot2c_f32_bf16 v105, v7, v68
  v_dot2c_f32_bf16 v106, v7, v77
  s_waitcnt lgkmcnt(1)
  v_dot2c_f32_bf16 v107, v7, v86
  v_dot2c_f32_bf16 v100, v8, v24
  v_dot2c_f32_bf16 v101, v8, v33
  v_dot2c_f32_bf16 v102, v8, v42
  v_dot2c_f32_bf16 v103, v8, v51
  v_dot2c_f32_bf16 v104, v8, v60
  v_dot2c_f32_bf16 v105, v8, v69
  v_dot2c_f32_bf16 v106, v8, v78
  s_waitcnt lgkmcnt(0)
  v_dot2c_f32_bf16 v107, v8, v87
  ds_read_b32 v16, v219 offset:7512
  ds_read_b32 v17, v219 offset:7516
  ds_read_b32 v18, v219 offset:7520
  ds_read_b32 v19, v219 offset:7524
  ds_read_b32 v20, v219 offset:7528
  ds_read_b32 v21, v219 offset:7532
  ds_read_b32 v22, v219 offset:7536
  ds_read_b32 v23, v219 offset:7540
  ds_read_b32 v24, v219 offset:7544
  ds_read_b32 v25, v219 offset:6480
  ds_read_b32 v26, v219 offset:6484
  ds_read_b32 v27, v219 offset:6488
  ds_read_b32 v28, v219 offset:6492
  ds_read_b32 v29, v219 offset:6496
  ds_read_b32 v30, v219 offset:6500
  ds_read_b32 v31, v219 offset:6504
  ds_read_b32 v32, v219 offset:6508
  ds_read_b32 v33, v219 offset:6512
  ds_read_b32 v34, v219 offset:5448
  ds_read_b32 v35, v219 offset:5452
  ds_read_b32 v36, v219 offset:5456
  ds_read_b32 v37, v219 offset:5460
  ds_read_b32 v38, v219 offset:5464
  ds_read_b32 v39, v219 offset:5468
  ds_read_b32 v40, v219 offset:5472
  ds_read_b32 v41, v219 offset:5476
  ds_read_b32 v42, v219 offset:5480
  ds_read_b32 v43, v219 offset:4416
  ds_read_b32 v44, v219 offset:4420
  ds_read_b32 v45, v219 offset:4424
  ds_read_b32 v46, v219 offset:4428
  ds_read_b32 v47, v219 offset:4432
  ds_read_b32 v48, v219 offset:4436
  ds_read_b32 v49, v219 offset:4440
  ds_read_b32 v50, v219 offset:4444
  ds_read_b32 v51, v219 offset:4448
  ds_read_b32 v52, v219 offset:3384
  ds_read_b32 v53, v219 offset:3388
  ds_read_b32 v54, v219 offset:3392
  ds_read_b32 v55, v219 offset:3396
  ds_read_b32 v56, v219 offset:3400
  ds_read_b32 v57, v219 offset:3404
  ds_read_b32 v58, v219 offset:3408
  ds_read_b32 v59, v219 offset:3412
  ds_read_b32 v60, v219 offset:3416
  ds_read_b32 v61, v219 offset:2352
  ds_read_b32 v62, v219 offset:2356
  ds_read_b32 v63, v219 offset:2360
  ds_read_b32 v64, v219 offset:2364
  ds_read_b32 v65, v219 offset:2368
  ds_read_b32 v66, v219 offset:2372
  ds_read_b32 v67, v219 offset:2376
  ds_read_b32 v68, v219 offset:2380
  ds_read_b32 v69, v219 offset:2384
  ds_read_b32 v70, v219 offset:1320
  ds_read_b32 v71, v219 offset:1324
  ds_read_b32 v72, v219 offset:1328
  ds_read_b32 v73, v219 offset:1332
  ds_read_b32 v74, v219 offset:1336
  ds_read_b32 v75, v219 offset:1340
  ds_read_b32 v76, v219 offset:1344
  ds_read_b32 v77, v219 offset:1348
  ds_read_b32 v78, v219 offset:1352
  ds_read_b32 v79, v219 offset:288
  ds_read_b32 v80, v219 offset:292
  ds_read_b32 v81, v219 offset:296
  ds_read_b32 v82, v219 offset:300
  ds_read_b32 v83, v219 offset:304
  ds_read_b32 v84, v219 offset:308
  ds_read_b32 v85, v219 offset:312
  ds_read_b32 v86, v219 offset:316
  ds_read_b32 v87, v219 offset:320
  v_add_u32 v211, s66, v200
  v_mov_b32 v212, 0xf149f2ca
  v_mul_f32 v100, s57, v100
  v_mul_f32 v101, s57, v101
  v_mul_f32 v102, s57, v102
  v_mul_f32 v103, s57, v103
  v_mul_f32 v104, s57, v104
  v_mul_f32 v105, s57, v105
  v_mul_f32 v106, s57, v106
  v_mul_f32 v107, s57, v107
  v_cmp_gt_u32 vcc, 2, v211
  s_nop 1
  v_cndmask_b32 v101, v101, v212, vcc
  v_cmp_gt_u32 vcc, 4, v211
  s_nop 1
  v_cndmask_b32 v102, v102, v212, vcc
  v_cmp_gt_u32 vcc, 6, v211
  s_nop 1
  v_cndmask_b32 v103, v103, v212, vcc
  v_cmp_gt_u32 vcc, 8, v211
  s_nop 1
  v_cndmask_b32 v104, v104, v212, vcc
  v_cmp_gt_u32 vcc, 10, v211
  s_nop 1
  v_cndmask_b32 v105, v105, v212, vcc
  v_cmp_gt_u32 vcc, 12, v211
  s_nop 1
  v_cndmask_b32 v106, v106, v212, vcc
  v_cmp_gt_u32 vcc, 14, v211
  s_nop 1
  v_cndmask_b32 v107, v107, v212, vcc
  v_max3_f32 v213, v100, v101, v102
  v_max3_f32 v213, v213, v103, v104
  v_max3_f32 v213, v213, v105, v106
  v_max_f32 v213, v213, v107
  v_sub_f32 v100, v100, v213
  v_sub_f32 v101, v101, v213
  v_sub_f32 v102, v102, v213
  v_sub_f32 v103, v103, v213
  v_sub_f32 v104, v104, v213
  v_sub_f32 v105, v105, v213
  v_sub_f32 v106, v106, v213
  v_sub_f32 v107, v107, v213
  v_exp_f32 v100, v100
  v_exp_f32 v101, v101
  v_exp_f32 v102, v102
  v_exp_f32 v103, v103
  v_exp_f32 v104, v104
  v_exp_f32 v105, v105
  v_exp_f32 v106, v106
  v_exp_f32 v107, v107
  v_add_f32 v213, v100, v101
  v_add_f32 v213, v213, v102
  v_add_f32 v213, v213, v103
  v_add_f32 v213, v213, v104
  v_add_f32 v213, v213, v105
  v_add_f32 v213, v213, v106
  v_add_f32 v213, v213, v107
  v_rcp_f32 v213, v213
  v_mov_b32 v214, 0
  v_mul_f32 v100, v213, v100
  v_mul_f32 v101, v213, v101
  v_mul_f32 v102, v213, v102
  v_mul_f32 v103, v213, v103
  v_mul_f32 v104, v213, v104
  v_mul_f32 v105, v213, v105
  v_mul_f32 v106, v213, v106
  v_mul_f32 v107, v213, v107
  v_mov_b32 v112, 0
  v_mov_b32 v113, 0
  v_mov_b32 v114, 0
  v_mov_b32 v115, 0
  v_mov_b32 v116, 0
  v_mov_b32 v117, 0
  v_mov_b32 v118, 0
  v_mov_b32 v119, 0
  v_mov_b32 v120, 0
  v_mov_b32 v121, 0
  v_mov_b32 v122, 0
  v_mov_b32 v123, 0
  v_mov_b32 v124, 0
  v_mov_b32 v125, 0
  v_mov_b32 v126, 0
  v_mov_b32 v127, 0
  v_mov_b32 v128, 0
  v_mov_b32 v129, 0
  v_cvt_pk_bf16_f32 v0, v100, v214
  v_cvt_pk_bf16_f32 v1, v214, v100
  s_waitcnt lgkmcnt(15)
  v_dot2c_f32_bf16 v112, v16, v0
  v_dot2c_f32_bf16 v113, v16, v1
  v_dot2c_f32_bf16 v114, v17, v0
  v_dot2c_f32_bf16 v115, v17, v1
  v_dot2c_f32_bf16 v116, v18, v0
  v_dot2c_f32_bf16 v117, v18, v1
  v_dot2c_f32_bf16 v118, v19, v0
  v_dot2c_f32_bf16 v119, v19, v1
  v_dot2c_f32_bf16 v120, v20, v0
  v_dot2c_f32_bf16 v121, v20, v1
  v_dot2c_f32_bf16 v122, v21, v0
  v_dot2c_f32_bf16 v123, v21, v1
  v_dot2c_f32_bf16 v124, v22, v0
  v_dot2c_f32_bf16 v125, v22, v1
  v_dot2c_f32_bf16 v126, v23, v0
  v_dot2c_f32_bf16 v127, v23, v1
  v_dot2c_f32_bf16 v128, v24, v0
  v_dot2c_f32_bf16 v129, v24, v1
  v_cvt_pk_bf16_f32 v2, v101, v214
  v_cvt_pk_bf16_f32 v3, v214, v101
  v_dot2c_f32_bf16 v112, v25, v2
  v_dot2c_f32_bf16 v113, v25, v3
  v_dot2c_f32_bf16 v114, v26, v2
  v_dot2c_f32_bf16 v115, v26, v3
  v_dot2c_f32_bf16 v116, v27, v2
  v_dot2c_f32_bf16 v117, v27, v3
  v_dot2c_f32_bf16 v118, v28, v2
  v_dot2c_f32_bf16 v119, v28, v3
  v_dot2c_f32_bf16 v120, v29, v2
  v_dot2c_f32_bf16 v121, v29, v3
  v_dot2c_f32_bf16 v122, v30, v2
  v_dot2c_f32_bf16 v123, v30, v3
  v_dot2c_f32_bf16 v124, v31, v2
  v_dot2c_f32_bf16 v125, v31, v3
  v_dot2c_f32_bf16 v126, v32, v2
  v_dot2c_f32_bf16 v127, v32, v3
  v_dot2c_f32_bf16 v128, v33, v2
  v_dot2c_f32_bf16 v129, v33, v3
  v_cvt_pk_bf16_f32 v0, v102, v214
  v_cvt_pk_bf16_f32 v1, v214, v102
  v_dot2c_f32_bf16 v112, v34, v0
  v_dot2c_f32_bf16 v113, v34, v1
  v_dot2c_f32_bf16 v114, v35, v0
  v_dot2c_f32_bf16 v115, v35, v1
  v_dot2c_f32_bf16 v116, v36, v0
  v_dot2c_f32_bf16 v117, v36, v1
  v_dot2c_f32_bf16 v118, v37, v0
  v_dot2c_f32_bf16 v119, v37, v1
  v_dot2c_f32_bf16 v120, v38, v0
  v_dot2c_f32_bf16 v121, v38, v1
  v_dot2c_f32_bf16 v122, v39, v0
  v_dot2c_f32_bf16 v123, v39, v1
  v_dot2c_f32_bf16 v124, v40, v0
  v_dot2c_f32_bf16 v125, v40, v1
  v_dot2c_f32_bf16 v126, v41, v0
  v_dot2c_f32_bf16 v127, v41, v1
  v_dot2c_f32_bf16 v128, v42, v0
  v_dot2c_f32_bf16 v129, v42, v1
  v_cvt_pk_bf16_f32 v2, v103, v214
  v_cvt_pk_bf16_f32 v3, v214, v103
  v_dot2c_f32_bf16 v112, v43, v2
  v_dot2c_f32_bf16 v113, v43, v3
  v_dot2c_f32_bf16 v114, v44, v2
  v_dot2c_f32_bf16 v115, v44, v3
  v_dot2c_f32_bf16 v116, v45, v2
  v_dot2c_f32_bf16 v117, v45, v3
  v_dot2c_f32_bf16 v118, v46, v2
  v_dot2c_f32_bf16 v119, v46, v3
  v_dot2c_f32_bf16 v120, v47, v2
  v_dot2c_f32_bf16 v121, v47, v3
  v_dot2c_f32_bf16 v122, v48, v2
  v_dot2c_f32_bf16 v123, v48, v3
  v_dot2c_f32_bf16 v124, v49, v2
  v_dot2c_f32_bf16 v125, v49, v3
  v_dot2c_f32_bf16 v126, v50, v2
  v_dot2c_f32_bf16 v127, v50, v3
  v_dot2c_f32_bf16 v128, v51, v2
  v_dot2c_f32_bf16 v129, v51, v3
  v_cvt_pk_bf16_f32 v0, v104, v214
  v_cvt_pk_bf16_f32 v1, v214, v104
  v_dot2c_f32_bf16 v112, v52, v0
  v_dot2c_f32_bf16 v113, v52, v1
  v_dot2c_f32_bf16 v114, v53, v0
  v_dot2c_f32_bf16 v115, v53, v1
  v_dot2c_f32_bf16 v116, v54, v0
  v_dot2c_f32_bf16 v117, v54, v1
  v_dot2c_f32_bf16 v118, v55, v0
  v_dot2c_f32_bf16 v119, v55, v1
  v_dot2c_f32_bf16 v120, v56, v0
  v_dot2c_f32_bf16 v121, v56, v1
  v_dot2c_f32_bf16 v122, v57, v0
  v_dot2c_f32_bf16 v123, v57, v1
  v_dot2c_f32_bf16 v124, v58, v0
  v_dot2c_f32_bf16 v125, v58, v1
  v_dot2c_f32_bf16 v126, v59, v0
  v_dot2c_f32_bf16 v127, v59, v1
  v_dot2c_f32_bf16 v128, v60, v0
  v_dot2c_f32_bf16 v129, v60, v1
  v_cvt_pk_bf16_f32 v2, v105, v214
  v_cvt_pk_bf16_f32 v3, v214, v105
  v_dot2c_f32_bf16 v112, v61, v2
  v_dot2c_f32_bf16 v113, v61, v3
  v_dot2c_f32_bf16 v114, v62, v2
  v_dot2c_f32_bf16 v115, v62, v3
  v_dot2c_f32_bf16 v116, v63, v2
  v_dot2c_f32_bf16 v117, v63, v3
  v_dot2c_f32_bf16 v118, v64, v2
  v_dot2c_f32_bf16 v119, v64, v3
  v_dot2c_f32_bf16 v120, v65, v2
  v_dot2c_f32_bf16 v121, v65, v3
  v_dot2c_f32_bf16 v122, v66, v2
  v_dot2c_f32_bf16 v123, v66, v3
  v_dot2c_f32_bf16 v124, v67, v2
  v_dot2c_f32_bf16 v125, v67, v3
  v_dot2c_f32_bf16 v126, v68, v2
  v_dot2c_f32_bf16 v127, v68, v3
  v_dot2c_f32_bf16 v128, v69, v2
  v_dot2c_f32_bf16 v129, v69, v3
  v_cvt_pk_bf16_f32 v0, v106, v214
  v_cvt_pk_bf16_f32 v1, v214, v106
  v_dot2c_f32_bf16 v112, v70, v0
  v_dot2c_f32_bf16 v113, v70, v1
  v_dot2c_f32_bf16 v114, v71, v0
  v_dot2c_f32_bf16 v115, v71, v1
  v_dot2c_f32_bf16 v116, v72, v0
  v_dot2c_f32_bf16 v117, v72, v1
  s_waitcnt lgkmcnt(14)
  v_dot2c_f32_bf16 v118, v73, v0
  v_dot2c_f32_bf16 v119, v73, v1
  s_waitcnt lgkmcnt(13)
  v_dot2c_f32_bf16 v120, v74, v0
  v_dot2c_f32_bf16 v121, v74, v1
  s_waitcnt lgkmcnt(12)
  v_dot2c_f32_bf16 v122, v75, v0
  v_dot2c_f32_bf16 v123, v75, v1
  s_waitcnt lgkmcnt(11)
  v_dot2c_f32_bf16 v124, v76, v0
  v_dot2c_f32_bf16 v125, v76, v1
  s_waitcnt lgkmcnt(10)
  v_dot2c_f32_bf16 v126, v77, v0
  v_dot2c_f32_bf16 v127, v77, v1
  s_waitcnt lgkmcnt(9)
  v_dot2c_f32_bf16 v128, v78, v0
  v_dot2c_f32_bf16 v129, v78, v1
  v_cvt_pk_bf16_f32 v2, v107, v214
  v_cvt_pk_bf16_f32 v3, v214, v107
  s_waitcnt lgkmcnt(8)
  v_dot2c_f32_bf16 v112, v79, v2
  v_dot2c_f32_bf16 v113, v79, v3
  s_waitcnt lgkmcnt(7)
  v_dot2c_f32_bf16 v114, v80, v2
  v_dot2c_f32_bf16 v115, v80, v3
  s_waitcnt lgkmcnt(6)
  v_dot2c_f32_bf16 v116, v81, v2
  v_dot2c_f32_bf16 v117, v81, v3
  s_waitcnt lgkmcnt(5)
  v_dot2c_f32_bf16 v118, v82, v2
  v_dot2c_f32_bf16 v119, v82, v3
  s_waitcnt lgkmcnt(4)
  v_dot2c_f32_bf16 v120, v83, v2
  v_dot2c_f32_bf16 v121, v83, v3
  s_waitcnt lgkmcnt(3)
  v_dot2c_f32_bf16 v122, v84, v2
  v_dot2c_f32_bf16 v123, v84, v3
  s_waitcnt lgkmcnt(2)
  v_dot2c_f32_bf16 v124, v85, v2
  v_dot2c_f32_bf16 v125, v85, v3
  s_waitcnt lgkmcnt(1)
  v_dot2c_f32_bf16 v126, v86, v2
  v_dot2c_f32_bf16 v127, v86, v3
  s_waitcnt lgkmcnt(0)
  v_dot2c_f32_bf16 v128, v87, v2
  v_dot2c_f32_bf16 v129, v87, v3
  v_cvt_pk_bf16_f32 v132, v112, v113
  v_cvt_pk_bf16_f32 v133, v114, v115
  v_cvt_pk_bf16_f32 v134, v116, v117
  v_cvt_pk_bf16_f32 v135, v118, v119
  v_cvt_pk_bf16_f32 v136, v120, v121
  v_cvt_pk_bf16_f32 v137, v122, v123
  v_cvt_pk_bf16_f32 v138, v124, v125
  v_cvt_pk_bf16_f32 v139, v126, v127
  v_cvt_pk_bf16_f32 v140, v128, v129
  buffer_store_dwordx4 v[132:135], v220, s[8:11], s64 offen sc1
  buffer_store_dwordx4 v[136:139], v220, s[8:11], s64 offen offset:16 sc1
  buffer_store_dword v140, v220, s[8:11], s64 offen offset:32 sc1
  s_mov_b32 s56, 36
  s_waitcnt vmcnt(0)
  s_barrier
  s_cmp_eq_u32 s52, 0
  s_cbranch_scc0 A_sig
  v_mov_b32 v211, 1
  v_mov_b32 v212, 0
  s_mov_b64 exec, 1
  buffer_atomic_add v211, v212, s[12:15], s56 offen
  s_mov_b64 exec, -1
A_sig:
  s_and_b32 s54, s53, 31
  s_cmp_lt_u32 s54, 27
  s_cbranch_scc0 L_exit
  s_and_b32 s54, s53, 31
  s_mul_i32 s68, s54, 57
  s_lshr_b32 s68, s68, 9
  s_mul_i32 s56, s68, 9
  s_sub_u32 s70, s54, s56
  s_bfe_u32 s55, s53, 0x10005
  s_mul_i32 s55, s55, 9
  s_add_u32 s70, s70, s55
  s_bfe_u32 s69, s53, 0x10006
  v_lshrrev_b32 v211, 2, v200
  v_mul_u32_u24 v211, 1152, v211
  v_and_b32 v212, 3, v200
  v_lshl_add_u32 v207, v212, 4, v211
  s_lshl_b32 s54, s70, 6
  s_mul_i32 s55, s52, 1179648
  s_add_u32 s62, s54, s55
  s_mul_i32 s55, s52, 184320
  s_add_u32 s63, s54, s55
  s_mul_i32 s61, s52, 40960
  v_bfe_u32 v211, v200, 2, 2
  v_lshlrev_b32 v212, 4, v212
  v_add_u32 v212, s61, v212
  v_lshl_add_u32 v212, v211, 6, v212
  v_lshrrev_b32 v213, 4, v200
  v_lshl_add_u32 v210, v213, 9, v212
  v_lshrrev_b32 v214, 5, v200
  v_lshl_add_u32 v209, v214, 10, v212
  v_and_b32 v214, 1, v213
  v_lshl_add_u32 v209, v214, 8, v209
  s_add_u32 m0, s61, 0
  s_add_u32 s54, s62, 0
  buffer_load_dwordx4 v207, s[28:31], s54 offen lds
  s_add_u32 m0, s61, 1024
  s_add_u32 s54, s62, 18432
  buffer_load_dwordx4 v207, s[28:31], s54 offen lds
  s_add_u32 m0, s61, 2048
  s_add_u32 s54, s62, 36864
  buffer_load_dwordx4 v207, s[28:31], s54 offen lds
  s_add_u32 m0, s61, 3072
  s_add_u32 s54, s62, 55296
  buffer_load_dwordx4 v207, s[28:31], s54 offen lds
  s_add_u32 m0, s61, 4096
  s_add_u32 s54, s62, 73728
  buffer_load_dwordx4 v207, s[28:31], s54 offen lds
  s_add_u32 m0, s61, 5120
  s_add_u32 s54, s62, 92160
  buffer_load_dwordx4 v207, s[28:31], s54 offen lds
  s_add_u32 m0, s61, 6144
  s_add_u32 s54, s62, 110592
  buffer_load_dwordx4 v207, s[28:31], s54 offen lds
  s_add_u32 m0, s61, 7168
  s_add_u32 s54, s62, 129024
  buffer_load_dwordx4 v207, s[28:31], s54 offen lds
  s_add_u32 m0, s61, 8192
  s_add_u32 s54, s62, 147456
  buffer_load_dwordx4 v207, s[28:31], s54 offen lds
  s_add_u32 m0, s61, 9216
  s_add_u32 s54, s62, 165888
  buffer_load_dwordx4 v207, s[28:31], s54 offen lds
  s_add_u32 m0, s61, 10240
  s_add_u32 s54, s62, 184320
  buffer_load_dwordx4 v207, s[28:31], s54 offen lds
  s_add_u32 m0, s61, 11264
  s_add_u32 s54, s62, 202752
  buffer_load_dwordx4 v207, s[28:31], s54 offen lds
  s_add_u32 m0, s61, 12288
  s_add_u32 s54, s62, 221184
  buffer_load_dwordx4 v207, s[28:31], s54 offen lds
  s_add_u32 m0, s61, 13312
  s_add_u32 s54, s62, 239616
  buffer_load_dwordx4 v207, s[28:31], s54 offen lds
  s_add_u32 m0, s61, 14336
  s_add_u32 s54, s62, 258048
  buffer_load_dwordx4 v207, s[28:31], s54 offen lds
  s_add_u32 m0, s61, 15360
  s_add_u32 s54, s62, 276480
  buffer_load_dwordx4 v207, s[28:31], s54 offen lds
  s_add_u32 m0, s61, 16384
  s_add_u32 s54, s62, 294912
  buffer_load_dwordx4 v207, s[28:31], s54 offen lds
  s_add_u32 m0, s61, 17408
  s_add_u32 s54, s62, 313344
  buffer_load_dwordx4 v207, s[28:31], s54 offen lds
  s_add_u32 m0, s61, 18432
  s_add_u32 s54, s62, 331776
  buffer_load_dwordx4 v207, s[28:31], s54 offen lds
  s_add_u32 m0, s61, 19456
  s_add_u32 s54, s62, 350208
  buffer_load_dwordx4 v207, s[28:31], s54 offen lds
  s_add_u32 m0, s61, 20480
  s_add_u32 s54, s62, 368640
  buffer_load_dwordx4 v207, s[28:31], s54 offen lds
  s_add_u32 m0, s61, 21504
  s_add_u32 s54, s62, 387072
  buffer_load_dwordx4 v207, s[28:31], s54 offen lds
  s_add_u32 m0, s61, 22528
  s_add_u32 s54, s62, 405504
  buffer_load_dwordx4 v207, s[28:31], s54 offen lds
  s_add_u32 m0, s61, 23552
  s_add_u32 s54, s62, 423936
  buffer_load_dwordx4 v207, s[28:31], s54 offen lds
  s_add_u32 m0, s61, 24576
  s_add_u32 s54, s62, 442368
  buffer_load_dwordx4 v207, s[28:31], s54 offen lds
  s_add_u32 m0, s61, 25600
  s_add_u32 s54, s62, 460800
  buffer_load_dwordx4 v207, s[28:31], s54 offen lds
  s_add_u32 m0, s61, 26624
  s_add_u32 s54, s62, 479232
  buffer_load_dwordx4 v207, s[28:31], s54 offen lds
  s_add_u32 m0, s61, 27648
  s_add_u32 s54, s62, 497664
  buffer_load_dwordx4 v207, s[28:31], s54 offen lds
  s_add_u32 m0, s61, 28672
  s_add_u32 s54, s62, 516096
  buffer_load_dwordx4 v207, s[28:31], s54 offen lds
  s_add_u32 m0, s61, 29696
  s_add_u32 s54, s62, 534528
  buffer_load_dwordx4 v207, s[28:31], s54 offen lds
  s_add_u32 m0, s61, 30720
  s_add_u32 s54, s62, 552960
  buffer_load_dwordx4 v207, s[28:31], s54 offen lds
  s_add_u32 m0, s61, 31744
  s_add_u32 s54, s62, 571392
  buffer_load_dwordx4 v207, s[28:31], s54 offen lds
  s_add_u32 m0, s61, 32768
  s_add_u32 s54, s62, 589824
  buffer_load_dwordx4 v207, s[28:31], s54 offen lds
  s_add_u32 m0, s61, 33792
  s_add_u32 s54, s62, 608256
  buffer_load_dwordx4 v207, s[28:31], s54 offen lds
  s_add_u32 m0, s61, 34816
  s_add_u32 s54, s62, 626688
  buffer_load_dwordx4 v207, s[28:31], s54 offen lds
  s_add_u32 m0, s61, 35840
  s_add_u32 s54, s62, 645120
  buffer_load_dwordx4 v207, s[28:31], s54 offen lds
  s_add_u32 m0, s61, 36864
  s_add_u32 s54, s62, 663552
  buffer_load_dwordx4 v207, s[28:31], s54 offen lds
  s_add_u32 m0, s61, 37888
  s_add_u32 s54, s62, 681984
  buffer_load_dwordx4 v207, s[28:31], s54 offen lds
  s_waitcnt vmcnt(36) lgkmcnt(0)
  s_add_u32 m0, s61, 38912
  s_add_u32 s54, s62, 700416
  buffer_load_dwordx4 v207, s[28:31], s54 offen lds
  s_add_u32 m0, s61, 39936
  s_add_u32 s54, s62, 718848
  buffer_load_dwordx4 v207, s[28:31], s54 offen lds
  ds_read_b64_tr_b16 a[0:1], v209 offset:0
  ds_read_b64_tr_b16 a[2:3], v209 offset:512
  ds_read_b64_tr_b16 a[4:5], v209 offset:8
  ds_read_b64_tr_b16 a[6:7], v209 offset:520
  s_waitcnt vmcnt(36) lgkmcnt(0)
  s_add_u32 m0, s61, 0
  s_add_u32 s54, s62, 737280
  buffer_load_dwordx4 v207, s[28:31], s54 offen lds
  s_add_u32 m0, s61, 1024
  s_add_u32 s54, s62, 755712
  buffer_load_dwordx4 v207, s[28:31], s54 offen lds
  ds_read_b64_tr_b16 a[8:9], v209 offset:2048
  ds_read_b64_tr_b16 a[10:11], v209 offset:2560
  ds_read_b64_tr_b16 a[12:13], v209 offset:2056
  ds_read_b64_tr_b16 a[14:15], v209 offset:2568
  s_waitcnt vmcnt(36) lgkmcnt(0)
  s_add_u32 m0, s61, 2048
  s_add_u32 s54, s62, 774144
  buffer_load_dwordx4 v207, s[28:31], s54 offen lds
  s_add_u32 m0, s61, 3072
  s_add_u32 s54, s62, 792576
  buffer_load_dwordx4 v207, s[28:31], s54 offen lds
  ds_read_b64_tr_b16 a[16:17], v209 offset:4096
  ds_read_b64_tr_b16 a[18:19], v209 offset:4608
  ds_read_b64_tr_b16 a[20:21], v209 offset:4104
  ds_read_b64_tr_b16 a[22:23], v209 offset:4616
  s_waitcnt vmcnt(36) lgkmcnt(0)
  s_add_u32 m0, s61, 4096
  s_add_u32 s54, s62, 811008
  buffer_load_dwordx4 v207, s[28:31], s54 offen lds
  s_add_u32 m0, s61, 5120
  s_add_u32 s54, s62, 829440
  buffer_load_dwordx4 v207, s[28:31], s54 offen lds
  ds_read_b64_tr_b16 a[24:25], v209 offset:6144
  ds_read_b64_tr_b16 a[26:27], v209 offset:6656
  ds_read_b64_tr_b16 a[28:29], v209 offset:6152
  ds_read_b64_tr_b16 a[30:31], v209 offset:6664
  s_waitcnt vmcnt(36) lgkmcnt(0)
  s_add_u32 m0, s61, 6144
  s_add_u32 s54, s62, 847872
  buffer_load_dwordx4 v207, s[28:31], s54 offen lds
  s_add_u32 m0, s61, 7168
  s_add_u32 s54, s62, 866304
  buffer_load_dwordx4 v207, s[28:31], s54 offen lds
  ds_read_b64_tr_b16 a[32:33], v209 offset:8192
  ds_read_b64_tr_b16 a[34:35], v209 offset:8704
  ds_read_b64_tr_b16 a[36:37], v209 offset:8200
  ds_read_b64_tr_b16 a[38:39], v209 offset:8712
  s_waitcnt vmcnt(36) lgkmcnt(0)
  s_add_u32 m0, s61, 8192
  s_add_u32 s54, s62, 884736
  buffer_load_dwordx4 v207, s[28:31], s54 offen lds
  s_add_u32 m0, s61, 9216
  s_add_u32 s54, s62, 903168
  buffer_load_dwordx4 v207, s[28:31], s54 offen lds
  ds_read_b64_tr_b16 a[40:41], v209 offset:10240
  ds_read_b64_tr_b16 a[42:43], v209 offset:10752
  ds_read_b64_tr_b16 a[44:45], v209 offset:10248
  ds_read_b64_tr_b16 a[46:47], v209 offset:10760
  s_waitcnt vmcnt(36) lgkmcnt(0)
  s_add_u32 m0, s61, 10240
  s_add_u32 s54, s62, 921600
  buffer_load_dwordx4 v207, s[28:31], s54 offen lds
  s_add_u32 m0, s61, 11264
  s_add_u32 s54, s62, 940032
  buffer_load_dwordx4 v207, s[28:31], s54 offen lds
  ds_read_b64_tr_b16 a[48:49], v209 offset:12288
  ds_read_b64_tr_b16 a[50:51], v209 offset:12800
  ds_read_b64_tr_b16 a[52:53], v209 offset:12296
  ds_read_b64_tr_b16 a[54:55], v209 offset:12808
  s_waitcnt vmcnt(36) lgkmcnt(0)
  s_add_u32 m0, s61, 12288
  s_add_u32 s54, s62, 958464
  buffer_load_dwordx4 v207, s[28:31], s54 offen lds
  s_add_u32 m0, s61, 13312
  s_add_u32 s54, s62, 976896
  buffer_load_dwordx4 v207, s[28:31], s54 offen lds
  ds_read_b64_tr_b16 a[56:57], v209 offset:14336
  ds_read_b64_tr_b16 a[58:59], v209 offset:14848
  ds_read_b64_tr_b16 a[60:61], v209 offset:14344
  ds_read_b64_tr_b16 a[62:63], v209 offset:14856
  s_waitcnt vmcnt(36) lgkmcnt(0)
  s_add_u32 m0, s61, 14336
  s_add_u32 s54, s62, 995328
  buffer_load_dwordx4 v207, s[28:31], s54 offen lds
  s_add_u32 m0, s61, 15360
  s_add_u32 s54, s62, 1013760
  buffer_load_dwordx4 v207, s[28:31], s54 offen lds
  ds_read_b64_tr_b16 a[64:65], v209 offset:16384
  ds_read_b64_tr_b16 a[66:67], v209 offset:16896
  ds_read_b64_tr_b16 a[68:69], v209 offset:16392
  ds_read_b64_tr_b16 a[70:71], v209 offset:16904
  s_waitcnt vmcnt(36) lgkmcnt(0)
  s_add_u32 m0, s61, 16384
  s_add_u32 s54, s62, 1032192
  buffer_load_dwordx4 v207, s[28:31], s54 offen lds
  s_add_u32 m0, s61, 17408
  s_add_u32 s54, s62, 1050624
  buffer_load_dwordx4 v207, s[28:31], s54 offen lds
  ds_read_b64_tr_b16 a[72:73], v209 offset:18432
  ds_read_b64_tr_b16 a[74:75], v209 offset:18944
  ds_read_b64_tr_b16 a[76:77], v209 offset:18440
  ds_read_b64_tr_b16 a[78:79], v209 offset:18952
  s_waitcnt vmcnt(36) lgkmcnt(0)
  s_add_u32 m0, s61, 18432
  s_add_u32 s54, s62, 1069056
  buffer_load_dwordx4 v207, s[28:31], s54 offen lds
  s_add_u32 m0, s61, 19456
  s_add_u32 s54, s62, 1087488
  buffer_load_dwordx4 v207, s[28:31], s54 offen lds
  ds_read_b64_tr_b16 a[80:81], v209 offset:20480
  ds_read_b64_tr_b16 a[82:83], v209 offset:20992
  ds_read_b64_tr_b16 a[84:85], v209 offset:20488
  ds_read_b64_tr_b16 a[86:87], v209 offset:21000
  s_waitcnt vmcnt(36) lgkmcnt(0)
  s_add_u32 m0, s61, 20480
  s_add_u32 s54, s62, 1105920
  buffer_load_dwordx4 v207, s[28:31], s54 offen lds
  s_add_u32 m0, s61, 21504
  s_add_u32 s54, s62, 1124352
  buffer_load_dwordx4 v207, s[28:31], s54 offen lds
  ds_read_b64_tr_b16 a[88:89], v209 offset:22528
  ds_read_b64_tr_b16 a[90:91], v209 offset:23040
  ds_read_b64_tr_b16 a[92:93], v209 offset:22536
  ds_read_b64_tr_b16 a[94:95], v209 offset:23048
  s_waitcnt vmcnt(36) lgkmcnt(0)
  s_add_u32 m0, s61, 22528
  s_add_u32 s54, s62, 1142784
  buffer_load_dwordx4 v207, s[28:31], s54 offen lds
  s_add_u32 m0, s61, 23552
  s_add_u32 s54, s62, 1161216
  buffer_load_dwordx4 v207, s[28:31], s54 offen lds
  ds_read_b64_tr_b16 a[96:97], v209 offset:24576
  ds_read_b64_tr_b16 a[98:99], v209 offset:25088
  ds_read_b64_tr_b16 a[100:101], v209 offset:24584
  ds_read_b64_tr_b16 a[102:103], v209 offset:25096
  s_waitcnt vmcnt(36) lgkmcnt(0)
  s_add_u32 m0, s61, 24576
  s_add_u32 s54, s63, 0
  buffer_load_dwordx4 v207, s[40:43], s54 offen lds
  s_add_u32 m0, s61, 25600
  s_add_u32 s54, s63, 18432
  buffer_load_dwordx4 v207, s[40:43], s54 offen lds
  ds_read_b64_tr_b16 a[104:105], v209 offset:26624
  ds_read_b64_tr_b16 a[106:107], v209 offset:27136
  ds_read_b64_tr_b16 a[108:109], v209 offset:26632
  ds_read_b64_tr_b16 a[110:111], v209 offset:27144
  s_waitcnt vmcnt(36) lgkmcnt(0)
  s_add_u32 m0, s61, 26624
  s_add_u32 s54, s63, 36864
  buffer_load_dwordx4 v207, s[40:43], s54 offen lds
  s_add_u32 m0, s61, 27648
  s_add_u32 s54, s63, 55296
  buffer_load_dwordx4 v207, s[40:43], s54 offen lds
  ds_read_b64_tr_b16 a[112:113], v209 offset:28672
  ds_read_b64_tr_b16 a[114:115], v209 offset:29184
  ds_read_b64_tr_b16 a[116:117], v209 offset:28680
  ds_read_b64_tr_b16 a[118:119], v209 offset:29192
  s_waitcnt vmcnt(36) lgkmcnt(0)
  s_add_u32 m0, s61, 28672
  s_add_u32 s54, s63, 73728
  buffer_load_dwordx4 v207, s[40:43], s54 offen lds
  s_add_u32 m0, s61, 29696
  s_add_u32 s54, s63, 92160
  buffer_load_dwordx4 v207, s[40:43], s54 offen lds
  ds_read_b64_tr_b16 a[120:121], v209 offset:30720
  ds_read_b64_tr_b16 a[122:123], v209 offset:31232
  ds_read_b64_tr_b16 a[124:125], v209 offset:30728
  ds_read_b64_tr_b16 a[126:127], v209 offset:31240
  s_waitcnt vmcnt(36) lgkmcnt(0)
  s_add_u32 m0, s61, 30720
  s_add_u32 s54, s63, 110592
  buffer_load_dwordx4 v207, s[40:43], s54 offen lds
  s_add_u32 m0, s61, 31744
  s_add_u32 s54, s63, 129024
  buffer_load_dwordx4 v207, s[40:43], s54 offen lds
  ds_read_b64_tr_b16 a[128:129], v209 offset:32768
  ds_read_b64_tr_b16 a[130:131], v209 offset:33280
  ds_read_b64_tr_b16 a[132:133], v209 offset:32776
  ds_read_b64_tr_b16 a[134:135], v209 offset:33288
  s_waitcnt vmcnt(36) lgkmcnt(0)
  s_add_u32 m0, s61, 32768
  s_add_u32 s54, s63, 147456
  buffer_load_dwordx4 v207, s[40:43], s54 offen lds
  s_add_u32 m0, s61, 33792
  s_add_u32 s54, s63, 165888
  buffer_load_dwordx4 v207, s[40:43], s54 offen lds
  ds_read_b64_tr_b16 a[136:137], v209 offset:34816
  ds_read_b64_tr_b16 a[138:139], v209 offset:35328
  ds_read_b64_tr_b16 a[140:141], v209 offset:34824
  ds_read_b64_tr_b16 a[142:143], v209 offset:35336
  s_waitcnt vmcnt(36) lgkmcnt(0)
  ds_read_b64_tr_b16 a[144:145], v209 offset:36864
  ds_read_b64_tr_b16 a[146:147], v209 offset:37376
  ds_read_b64_tr_b16 a[148:149], v209 offset:36872
  ds_read_b64_tr_b16 a[150:151], v209 offset:37384
  s_waitcnt vmcnt(34) lgkmcnt(0)
  ds_read_b64_tr_b16 a[152:153], v209 offset:38912
  ds_read_b64_tr_b16 a[154:155], v209 offset:39424
  ds_read_b64_tr_b16 a[156:157], v209 offset:38920
  ds_read_b64_tr_b16 a[158:159], v209 offset:39432
  s_waitcnt vmcnt(32) lgkmcnt(0)
  ds_read_b64_tr_b16 a[160:161], v209 offset:0
  ds_read_b64_tr_b16 a[162:163], v209 offset:512
  ds_read_b64_tr_b16 a[164:165], v209 offset:8
  ds_read_b64_tr_b16 a[166:167], v209 offset:520
  s_waitcnt vmcnt(30) lgkmcnt(0)
  ds_read_b64_tr_b16 a[168:169], v209 offset:2048
  ds_read_b64_tr_b16 a[170:171], v209 offset:2560
  ds_read_b64_tr_b16 a[172:173], v209 offset:2056
  ds_read_b64_tr_b16 a[174:175], v209 offset:2568
  s_waitcnt vmcnt(28) lgkmcnt(0)
  ds_read_b64_tr_b16 a[176:177], v209 offset:4096
  ds_read_b64_tr_b16 a[178:179], v209 offset:4608
  ds_read_b64_tr_b16 a[180:181], v209 offset:4104
  ds_read_b64_tr_b16 a[182:183], v209 offset:4616
  s_waitcnt vmcnt(26) lgkmcnt(0)
  ds_read_b64_tr_b16 a[184:185], v209 offset:6144
  ds_read_b64_tr_b16 a[186:187], v209 offset:6656
  ds_read_b64_tr_b16 a[188:189], v209 offset:6152
  ds_read_b64_tr_b16 a[190:191], v209 offset:6664
  s_waitcnt vmcnt(24) lgkmcnt(0)
  ds_read_b64_tr_b16 a[192:193], v209 offset:8192
  ds_read_b64_tr_b16 a[194:195], v209 offset:8704
  ds_read_b64_tr_b16 a[196:197], v209 offset:8200
  ds_read_b64_tr_b16 a[198:199], v209 offset:8712
  s_waitcnt vmcnt(22) lgkmcnt(0)
  ds_read_b64_tr_b16 a[200:201], v209 offset:10240
  ds_read_b64_tr_b16 a[202:203], v209 offset:10752
  ds_read_b64_tr_b16 a[204:205], v209 offset:10248
  ds_read_b64_tr_b16 a[206:207], v209 offset:10760
  s_waitcnt vmcnt(20) lgkmcnt(0)
  ds_read_b64_tr_b16 a[208:209], v209 offset:12288
  ds_read_b64_tr_b16 a[210:211], v209 offset:12800
  ds_read_b64_tr_b16 a[212:213], v209 offset:12296
  ds_read_b64_tr_b16 a[214:215], v209 offset:12808
  s_waitcnt vmcnt(18) lgkmcnt(0)
  ds_read_b64_tr_b16 a[216:217], v209 offset:14336
  ds_read_b64_tr_b16 a[218:219], v209 offset:14848
  ds_read_b64_tr_b16 a[220:221], v209 offset:14344
  ds_read_b64_tr_b16 a[222:223], v209 offset:14856
  s_waitcnt vmcnt(16) lgkmcnt(0)
  ds_read_b64_tr_b16 a[224:225], v209 offset:16384
  ds_read_b64_tr_b16 a[226:227], v209 offset:16896
  ds_read_b64_tr_b16 a[228:229], v209 offset:16392
  ds_read_b64_tr_b16 a[230:231], v209 offset:16904
  s_waitcnt vmcnt(14) lgkmcnt(0)
  ds_read_b64_tr_b16 a[232:233], v209 offset:18432
  ds_read_b64_tr_b16 a[234:235], v209 offset:18944
  ds_read_b64_tr_b16 a[236:237], v209 offset:18440
  ds_read_b64_tr_b16 a[238:239], v209 offset:18952
  s_waitcnt vmcnt(12) lgkmcnt(0)
  ds_read_b64_tr_b16 a[240:241], v209 offset:20480
  ds_read_b64_tr_b16 a[242:243], v209 offset:20992
  ds_read_b64_tr_b16 a[244:245], v209 offset:20488
  ds_read_b64_tr_b16 a[246:247], v209 offset:21000
  s_waitcnt vmcnt(10) lgkmcnt(0)
  ds_read_b64_tr_b16 a[248:249], v209 offset:22528
  ds_read_b64_tr_b16 a[250:251], v209 offset:23040
  ds_read_b64_tr_b16 a[252:253], v209 offset:22536
  ds_read_b64_tr_b16 a[254:255], v209 offset:23048
  s_waitcnt vmcnt(8) lgkmcnt(0)
  ds_read_b64_tr_b16 v[216:217], v210 offset:24576
  ds_read_b64_tr_b16 v[218:219], v210 offset:24832
  ds_read_b64_tr_b16 v[220:221], v210 offset:24584
  ds_read_b64_tr_b16 v[222:223], v210 offset:24840
  s_waitcnt vmcnt(6) lgkmcnt(0)
  ds_read_b64_tr_b16 v[224:225], v210 offset:26624
  ds_read_b64_tr_b16 v[226:227], v210 offset:26880
  ds_read_b64_tr_b16 v[228:229], v210 offset:26632
  ds_read_b64_tr_b16 v[230:231], v210 offset:26888
  s_waitcnt vmcnt(4) lgkmcnt(0)
  ds_read_b64_tr_b16 v[232:233], v210 offset:28672
  ds_read_b64_tr_b16 v[234:235], v210 offset:28928
  ds_read_b64_tr_b16 v[236:237], v210 offset:28680
  ds_read_b64_tr_b16 v[238:239], v210 offset:28936
  s_waitcnt vmcnt(2) lgkmcnt(0)
  ds_read_b64_tr_b16 v[240:241], v210 offset:30720
  ds_read_b64_tr_b16 v[242:243], v210 offset:30976
  ds_read_b64_tr_b16 v[244:245], v210 offset:30728
  ds_read_b64_tr_b16 v[246:247], v210 offset:30984
  s_waitcnt vmcnt(0) lgkmcnt(0)
  ds_read_b64_tr_b16 v[248:249], v210 offset:32768
  ds_read_b64_tr_b16 v[250:251], v210 offset:33024
  ds_read_b64_tr_b16 v[252:253], v210 offset:32776
  ds_read_b64_tr_b16 v[254:255], v210 offset:33032
  v_and_b32 v211, 15, v200
  s_lshl_b32 s54, s69, 4
  v_add_u32 v211, s54, v211
  v_lshl_add_u32 v212, v214, 5, v211
  v_lshlrev_b32 v164, 4, v212
  v_lshrrev_b32 v212, 5, v200
  v_lshl_add_u32 v164, v212, 10, v164
  v_mul_u32_u24 v167, 1152, v211
  v_lshl_add_u32 v167, v213, 4, v167
  v_lshlrev_b32 v166, 2, v211
  v_lshlrev_b32 v208, 2, v200
  s_lshl_b32 s54, s52, 11
  v_add_u32 v168, s54, v201
  s_mov_b32 s59, s68
  s_mov_b32 s56, 128
  s_mov_b32 s57, 36
  s_waitcnt lgkmcnt(0)
  s_cmp_eq_u32 s52, 0
  s_cbranch_scc0 O_p1_d
  s_mov_b32 exec_hi, 0
  s_mov_b32 exec_lo, -1
O_p1:
  buffer_load_dword v211, v208, s[12:15], s56 offen sc1
  s_add_u32 s65, s65, 1
  s_waitcnt vmcnt(0)
  v_cmp_gt_u32 vcc, 0x700, v211
  s_cbranch_vccz O_p1_x
  s_sleep 16
  s_cmp_lt_u32 s65, 131072
  s_cbranch_scc1 O_p1
O_p1_x:
  s_mov_b64 exec, -1
O_p1_d:
  s_barrier
  s_cmp_eq_u32 s52, 0
  s_cbranch_scc0 O_a_d
  s_mov_b32 exec_hi, 0
  s_mov_b32 exec_lo, 1
O_a:
  buffer_load_dword v211, v208, s[12:15], s57 offen sc1
  s_add_u32 s65, s65, 1
  s_waitcnt vmcnt(0)
  v_cmp_gt_u32 vcc, 0x80, v211
  s_cbranch_vccz O_a_x
  s_sleep 16
  s_cmp_lt_u32 s65, 131072
  s_cbranch_scc1 O_a
O_a_x:
  s_mov_b64 exec, -1
O_a_d:
  s_barrier
  s_cmp_ge_u32 s70, 9
  s_cselect_b32 s54, 9, 0
  s_sub_u32 s54, s70, s54
  s_and_b32 s54, s54, 7
  s_lshl_b32 s54, s54, 13
  s_lshl_b32 s55, s69, 8
  s_add_u32 s54, s54, s55
  v_lshrrev_b32 v211, 2, v200
  v_lshl_add_u32 v172, v211, 9, s54
  v_and_b32 v211, 3, v200
  v_lshl_add_u32 v172, v211, 6, v172
  s_mul_i32 s55, s59, 36864
  s_mul_i32 s54, s52, 320
  s_add_u32 s55, s55, s54
  s_add_u32 s55, s55, 62914560
  s_cmp_eq_u32 s52, 3
  s_cselect_b32 s56, 268435456, s55
  buffer_load_dwordx4 v[128:131], v167, s[8:11], s55 offen offset:0 sc1
  buffer_load_dwordx4 v[132:135], v167, s[8:11], s55 offen offset:64 sc1
  buffer_load_dwordx4 v[136:139], v167, s[8:11], s55 offen offset:128 sc1
  buffer_load_dwordx4 v[140:143], v167, s[8:11], s56 offen offset:192 sc1
  buffer_load_dwordx4 v[144:147], v167, s[8:11], s56 offen offset:256 sc1
  s_lshl_b32 s55, s59, 7
  s_add_u32 s55, s55, 66060288
  buffer_load_dword v171, v166, s[8:11], s55 offen sc1
  v_mov_b32 v169, 0
  s_mov_b32 s66, 356352
  s_waitcnt vmcnt(0)
O_loop:
  v_mfma_f32_16x16x32_bf16 v[156:159], v[216:219], v[128:131], 0
  v_mfma_f32_16x16x32_bf16 v[160:163], v[220:223], v[128:131], 0
  v_mfma_f32_16x16x32_bf16 v[156:159], v[224:227], v[132:135], v[156:159]
  v_mfma_f32_16x16x32_bf16 v[160:163], v[228:231], v[132:135], v[160:163]
  v_mfma_f32_16x16x32_bf16 v[156:159], v[232:235], v[136:139], v[156:159]
  v_mfma_f32_16x16x32_bf16 v[160:163], v[236:239], v[136:139], v[160:163]
  v_mfma_f32_16x16x32_bf16 v[156:159], v[240:243], v[140:143], v[156:159]
  v_mfma_f32_16x16x32_bf16 v[160:163], v[244:247], v[140:143], v[160:163]
  v_mfma_f32_16x16x32_bf16 v[156:159], v[248:251], v[144:147], v[156:159]
  v_mfma_f32_16x16x32_bf16 v[160:163], v[252:255], v[144:147], v[160:163]
  s_mul_i32 s64, s59, 36864
  s_lshl_b32 s54, s70, 6
  s_add_u32 s64, s64, s54
  s_add_u32 s71, s59, 2
  s_lshl_b32 s55, s59, 18
  s_lshl_b32 s54, s52, 16
  s_add_u32 s55, s55, s54
  s_add_u32 s63, s55, 46137344
  s_and_b32 s54, s59, 1
  s_lshl_b32 s54, s54, 2
  s_add_u32 s54, s54, s52
  s_lshl_b32 s54, s54, 3
  s_lshl_b64 s[72:73], 0xff, s54
  v_sub_f32 v165, 1.0, v171
  v_cvt_pk_bf16_f32 v165, v165, v165
  v_lshlrev_b32 v165, 16, v165
  v_mul_f32 v156, v171, v156
  v_mul_f32 v157, v171, v157
  v_mul_f32 v158, v171, v158
  v_mul_f32 v159, v171, v159
  v_mul_f32 v160, v171, v160
  v_mul_f32 v161, v171, v161
  v_mul_f32 v162, v171, v162
  v_mul_f32 v163, v171, v163
  s_branch O_pc
O_pl:
  s_sleep 1
  buffer_load_dword v169, v208, s[8:11], s66 offen sc1
  s_add_u32 s65, s65, 1
  s_cmp_ge_u32 s65, 131072
  s_cbranch_scc1 O_ld
  s_waitcnt vmcnt(0)
O_pc:
  v_cmp_gt_u32 vcc, s71, v169
  s_nop 0
  s_and_b64 vcc, vcc, s[72:73]
  s_cbranch_scc1 O_pl
O_ld:
  s_mov_b32 s62, s63
  buffer_load_dword v173, v172, s[8:11], s63 offen sc1
  buffer_load_dwordx4 v[0:3], v164, s[8:11], s62 offen offset:0 sc1
  buffer_load_dwordx4 v[4:7], v164, s[8:11], s62 offen offset:2048 sc1
  s_add_u32 s62, s62, 4096
  buffer_load_dwordx4 v[8:11], v164, s[8:11], s62 offen offset:0 sc1
  buffer_load_dwordx4 v[12:15], v164, s[8:11], s62 offen offset:2048 sc1
  s_add_u32 s62, s62, 4096
  buffer_load_dwordx4 v[16:19], v164, s[8:11], s62 offen offset:0 sc1
  buffer_load_dwordx4 v[20:23], v164, s[8:11], s62 offen offset:2048 sc1
  s_add_u32 s62, s62, 4096
  buffer_load_dwordx4 v[24:27], v164, s[8:11], s62 offen offset:0 sc1
  buffer_load_dwordx4 v[28:31], v164, s[8:11], s62 offen offset:2048 sc1
  s_add_u32 s62, s62, 4096
  buffer_load_dwordx4 v[32:35], v164, s[8:11], s62 offen offset:0 sc1
  buffer_load_dwordx4 v[36:39], v164, s[8:11], s62 offen offset:2048 sc1
  s_add_u32 s62, s62, 4096
  buffer_load_dwordx4 v[40:43], v164, s[8:11], s62 offen offset:0 sc1
  buffer_load_dwordx4 v[44:47], v164, s[8:11], s62 offen offset:2048 sc1
  s_add_u32 s62, s62, 4096
  buffer_load_dwordx4 v[48:51], v164, s[8:11], s62 offen offset:0 sc1
  buffer_load_dwordx4 v[52:55], v164, s[8:11], s62 offen offset:2048 sc1
  s_add_u32 s62, s62, 4096
  buffer_load_dwordx4 v[56:59], v164, s[8:11], s62 offen offset:0 sc1
  buffer_load_dwordx4 v[60:63], v164, s[8:11], s62 offen offset:2048 sc1
  s_add_u32 s62, s62, 4096
  buffer_load_dwordx4 v[64:67], v164, s[8:11], s62 offen offset:0 sc1
  buffer_load_dwordx4 v[68:71], v164, s[8:11], s62 offen offset:2048 sc1
  s_add_u32 s62, s62, 4096
  buffer_load_dwordx4 v[72:75], v164, s[8:11], s62 offen offset:0 sc1
  buffer_load_dwordx4 v[76:79], v164, s[8:11], s62 offen offset:2048 sc1
  s_add_u32 s62, s62, 4096
  buffer_load_dwordx4 v[80:83], v164, s[8:11], s62 offen offset:0 sc1
  buffer_load_dwordx4 v[84:87], v164, s[8:11], s62 offen offset:2048 sc1
  s_add_u32 s62, s62, 4096
  buffer_load_dwordx4 v[88:91], v164, s[8:11], s62 offen offset:0 sc1
  buffer_load_dwordx4 v[92:95], v164, s[8:11], s62 offen offset:2048 sc1
  s_add_u32 s62, s62, 4096
  buffer_load_dwordx4 v[96:99], v164, s[8:11], s62 offen offset:0 sc1
  buffer_load_dwordx4 v[100:103], v164, s[8:11], s62 offen offset:2048 sc1
  s_add_u32 s62, s62, 4096
  buffer_load_dwordx4 v[104:107], v164, s[8:11], s62 offen offset:0 sc1
  buffer_load_dwordx4 v[108:111], v164, s[8:11], s62 offen offset:2048 sc1
  s_add_u32 s62, s62, 4096
  buffer_load_dwordx4 v[112:115], v164, s[8:11], s62 offen offset:0 sc1
  buffer_load_dwordx4 v[116:119], v164, s[8:11], s62 offen offset:2048 sc1
  s_add_u32 s62, s62, 4096
  buffer_load_dwordx4 v[120:123], v164, s[8:11], s62 offen offset:0 sc1
  buffer_load_dwordx4 v[124:127], v164, s[8:11], s62 offen offset:2048 sc1
  s_add_u32 s62, s62, 4096
  s_add_u32 s57, s59, 3
  s_min_u32 s74, s57, 63
  s_mul_i32 s55, s74, 36864
  s_mul_i32 s54, s52, 320
  s_add_u32 s55, s55, s54
  s_add_u32 s55, s55, 62914560
  s_cmp_eq_u32 s52, 3
  s_cselect_b32 s56, 268435456, s55
  buffer_load_dwordx4 v[128:131], v167, s[8:11], s55 offen offset:0 sc1
  buffer_load_dwordx4 v[132:135], v167, s[8:11], s55 offen offset:64 sc1
  buffer_load_dwordx4 v[136:139], v167, s[8:11], s55 offen offset:128 sc1
  buffer_load_dwordx4 v[140:143], v167, s[8:11], s56 offen offset:192 sc1
  buffer_load_dwordx4 v[144:147], v167, s[8:11], s56 offen offset:256 sc1
  s_lshl_b32 s55, s74, 7
  s_add_u32 s55, s55, 66060288
  buffer_load_dword v171, v166, s[8:11], s55 offen sc1
  s_add_u32 s65, s65, 1
  s_cmp_lt_u32 s65, 131072
  s_cselect_b32 s54, -2, -1
  s_waitcnt vmcnt(37)
  v_mfma_f32_16x16x32_bf16 v[148:151], a[0:3], v[0:3], 0
  v_mfma_f32_16x16x32_bf16 v[152:155], a[4:7], v[0:3], 0
  v_max3_u32 v170, v0, v1, v0
  v_max3_u32 v170, v2, v3, v170
  s_waitcnt vmcnt(36)
  v_mfma_f32_16x16x32_bf16 v[148:151], a[8:11], v[4:7], v[148:151]
  v_mfma_f32_16x16x32_bf16 v[152:155], a[12:15], v[4:7], v[152:155]
  v_max3_u32 v170, v4, v5, v170
  v_max3_u32 v170, v6, v7, v170
  s_waitcnt vmcnt(35)
  v_mfma_f32_16x16x32_bf16 v[148:151], a[16:19], v[8:11], v[148:151]
  v_mfma_f32_16x16x32_bf16 v[152:155], a[20:23], v[8:11], v[152:155]
  v_max3_u32 v170, v8, v9, v170
  v_max3_u32 v170, v10, v11, v170
  s_waitcnt vmcnt(34)
  v_mfma_f32_16x16x32_bf16 v[148:151], a[24:27], v[12:15], v[148:151]
  v_mfma_f32_16x16x32_bf16 v[152:155], a[28:31], v[12:15], v[152:155]
  v_max3_u32 v170, v12, v13, v170
  v_max3_u32 v170, v14, v15, v170
  s_waitcnt vmcnt(33)
  v_mfma_f32_16x16x32_bf16 v[148:151], a[32:35], v[16:19], v[148:151]
  v_mfma_f32_16x16x32_bf16 v[152:155], a[36:39], v[16:19], v[152:155]
  v_max3_u32 v170, v16, v17, v170
  v_max3_u32 v170, v18, v19, v170
  s_waitcnt vmcnt(32)
  v_mfma_f32_16x16x32_bf16 v[148:151], a[40:43], v[20:23], v[148:151]
  v_mfma_f32_16x16x32_bf16 v[152:155], a[44:47], v[20:23], v[152:155]
  v_max3_u32 v170, v20, v21, v170
  v_max3_u32 v170, v22, v23, v170
  s_waitcnt vmcnt(31)
  v_mfma_f32_16x16x32_bf16 v[148:151], a[48:51], v[24:27], v[148:151]
  v_mfma_f32_16x16x32_bf16 v[152:155], a[52:55], v[24:27], v[152:155]
  v_max3_u32 v170, v24, v25, v170
  v_max3_u32 v170, v26, v27, v170
  s_waitcnt vmcnt(30)
  v_mfma_f32_16x16x32_bf16 v[148:151], a[56:59], v[28:31], v[148:151]
  v_mfma_f32_16x16x32_bf16 v[152:155], a[60:63], v[28:31], v[152:155]
  v_max3_u32 v170, v28, v29, v170
  v_max3_u32 v170, v30, v31, v170
  s_waitcnt vmcnt(29)
  v_mfma_f32_16x16x32_bf16 v[148:151], a[64:67], v[32:35], v[148:151]
  v_mfma_f32_16x16x32_bf16 v[152:155], a[68:71], v[32:35], v[152:155]
  v_max3_u32 v170, v32, v33, v170
  v_max3_u32 v170, v34, v35, v170
  s_waitcnt vmcnt(28)
  v_mfma_f32_16x16x32_bf16 v[148:151], a[72:75], v[36:39], v[148:151]
  v_mfma_f32_16x16x32_bf16 v[152:155], a[76:79], v[36:39], v[152:155]
  v_max3_u32 v170, v36, v37, v170
  v_max3_u32 v170, v38, v39, v170
  s_waitcnt vmcnt(27)
  v_mfma_f32_16x16x32_bf16 v[148:151], a[80:83], v[40:43], v[148:151]
  v_mfma_f32_16x16x32_bf16 v[152:155], a[84:87], v[40:43], v[152:155]
  v_max3_u32 v170, v40, v41, v170
  v_max3_u32 v170, v42, v43, v170
  s_waitcnt vmcnt(26)
  v_mfma_f32_16x16x32_bf16 v[148:151], a[88:91], v[44:47], v[148:151]
  v_mfma_f32_16x16x32_bf16 v[152:155], a[92:95], v[44:47], v[152:155]
  v_max3_u32 v170, v44, v45, v170
  v_max3_u32 v170, v46, v47, v170
  s_waitcnt vmcnt(25)
  v_mfma_f32_16x16x32_bf16 v[148:151], a[96:99], v[48:51], v[148:151]
  v_mfma_f32_16x16x32_bf16 v[152:155], a[100:103], v[48:51], v[152:155]
  v_max3_u32 v170, v48, v49, v170
  v_max3_u32 v170, v50, v51, v170
  s_waitcnt vmcnt(24)
  v_mfma_f32_16x16x32_bf16 v[148:151], a[104:107], v[52:55], v[148:151]
  v_mfma_f32_16x16x32_bf16 v[152:155], a[108:111], v[52:55], v[152:155]
  v_max3_u32 v170, v52, v53, v170
  v_max3_u32 v170, v54, v55, v170
  s_waitcnt vmcnt(23)
  v_mfma_f32_16x16x32_bf16 v[148:151], a[112:115], v[56:59], v[148:151]
  v_mfma_f32_16x16x32_bf16 v[152:155], a[116:119], v[56:59], v[152:155]
  v_max3_u32 v170, v56, v57, v170
  v_max3_u32 v170, v58, v59, v170
  s_waitcnt vmcnt(22)
  v_mfma_f32_16x16x32_bf16 v[148:151], a[120:123], v[60:63], v[148:151]
  v_mfma_f32_16x16x32_bf16 v[152:155], a[124:127], v[60:63], v[152:155]
  v_max3_u32 v170, v60, v61, v170
  v_max3_u32 v170, v62, v63, v170
  s_waitcnt vmcnt(21)
  v_mfma_f32_16x16x32_bf16 v[148:151], a[128:131], v[64:67], v[148:151]
  v_mfma_f32_16x16x32_bf16 v[152:155], a[132:135], v[64:67], v[152:155]
  v_max3_u32 v170, v64, v65, v170
  v_max3_u32 v170, v66, v67, v170
  s_waitcnt vmcnt(20)
  v_mfma_f32_16x16x32_bf16 v[148:151], a[136:139], v[68:71], v[148:151]
  v_mfma_f32_16x16x32_bf16 v[152:155], a[140:143], v[68:71], v[152:155]
  v_max3_u32 v170, v68, v69, v170
  v_max3_u32 v170, v70, v71, v170
  s_waitcnt vmcnt(19)
  v_mfma_f32_16x16x32_bf16 v[148:151], a[144:147], v[72:75], v[148:151]
  v_mfma_f32_16x16x32_bf16 v[152:155], a[148:151], v[72:75], v[152:155]
  v_max3_u32 v170, v72, v73, v170
  v_max3_u32 v170, v74, v75, v170
  s_waitcnt vmcnt(18)
  v_mfma_f32_16x16x32_bf16 v[148:151], a[152:155], v[76:79], v[148:151]
  v_mfma_f32_16x16x32_bf16 v[152:155], a[156:159], v[76:79], v[152:155]
  v_max3_u32 v170, v76, v77, v170
  v_max3_u32 v170, v78, v79, v170
  s_waitcnt vmcnt(17)
  v_mfma_f32_16x16x32_bf16 v[148:151], a[160:163], v[80:83], v[148:151]
  v_mfma_f32_16x16x32_bf16 v[152:155], a[164:167], v[80:83], v[152:155]
  v_max3_u32 v170, v80, v81, v170
  v_max3_u32 v170, v82, v83, v170
  s_waitcnt vmcnt(16)
  v_mfma_f32_16x16x32_bf16 v[148:151], a[168:171], v[84:87], v[148:151]
  v_mfma_f32_16x16x32_bf16 v[152:155], a[172:175], v[84:87], v[152:155]
  v_max3_u32 v170, v84, v85, v170
  v_max3_u32 v170, v86, v87, v170
  s_waitcnt vmcnt(15)
  v_mfma_f32_16x16x32_bf16 v[148:151], a[176:179], v[88:91], v[148:151]
  v_mfma_f32_16x16x32_bf16 v[152:155], a[180:183], v[88:91], v[152:155]
  v_max3_u32 v170, v88, v89, v170
  v_max3_u32 v170, v90, v91, v170
  s_waitcnt vmcnt(14)
  v_mfma_f32_16x16x32_bf16 v[148:151], a[184:187], v[92:95], v[148:151]
  v_mfma_f32_16x16x32_bf16 v[152:155], a[188:191], v[92:95], v[152:155]
  v_max3_u32 v170, v92, v93, v170
  v_max3_u32 v170, v94, v95, v170
  s_waitcnt vmcnt(13)
  v_mfma_f32_16x16x32_bf16 v[148:151], a[192:195], v[96:99], v[148:151]
  v_mfma_f32_16x16x32_bf16 v[152:155], a[196:199], v[96:99], v[152:155]
  v_max3_u32 v170, v96, v97, v170
  v_max3_u32 v170, v98, v99, v170
  s_waitcnt vmcnt(12)
  v_mfma_f32_16x16x32_bf16 v[148:151], a[200:203], v[100:103], v[148:151]
  v_mfma_f32_16x16x32_bf16 v[152:155], a[204:207], v[100:103], v[152:155]
  v_max3_u32 v170, v100, v101, v170
  v_max3_u32 v170, v102, v103, v170
  s_waitcnt vmcnt(11)
  v_mfma_f32_16x16x32_bf16 v[148:151], a[208:211], v[104:107], v[148:151]
  v_mfma_f32_16x16x32_bf16 v[152:155], a[212:215], v[104:107], v[152:155]
  v_max3_u32 v170, v104, v105, v170
  v_max3_u32 v170, v106, v107, v170
  s_waitcnt vmcnt(10)
  v_mfma_f32_16x16x32_bf16 v[148:151], a[216:219], v[108:111], v[148:151]
  v_mfma_f32_16x16x32_bf16 v[152:155], a[220:223], v[108:111], v[152:155]
  v_max3_u32 v170, v108, v109, v170
  v_max3_u32 v170, v110, v111, v170
  s_waitcnt vmcnt(9)
  v_mfma_f32_16x16x32_bf16 v[148:151], a[224:227], v[112:115], v[148:151]
  v_mfma_f32_16x16x32_bf16 v[152:155], a[228:231], v[112:115], v[152:155]
  v_max3_u32 v170, v112, v113, v170
  v_max3_u32 v170, v114, v115, v170
  s_waitcnt vmcnt(8)
  v_mfma_f32_16x16x32_bf16 v[148:151], a[232:235], v[116:119], v[148:151]
  v_mfma_f32_16x16x32_bf16 v[152:155], a[236:239], v[116:119], v[152:155]
  v_max3_u32 v170, v116, v117, v170
  v_max3_u32 v170, v118, v119, v170
  s_waitcnt vmcnt(7)
  v_mfma_f32_16x16x32_bf16 v[148:151], a[240:243], v[120:123], v[148:151]
  v_mfma_f32_16x16x32_bf16 v[152:155], a[244:247], v[120:123], v[152:155]
  v_max3_u32 v170, v120, v121, v170
  v_max3_u32 v170, v122, v123, v170
  s_waitcnt vmcnt(6)
  v_mfma_f32_16x16x32_bf16 v[148:151], a[248:251], v[124:127], v[148:151]
  v_mfma_f32_16x16x32_bf16 v[152:155], a[252:255], v[124:127], v[152:155]
  v_max3_u32 v170, v124, v125, v170
  v_max3_u32 v170, v126, v127, v170
  v_cmp_lt_u32 vcc, s54, v170
  s_cbranch_vccnz O_ld
  v_fmac_f32 v156, v165, v148
  v_fmac_f32 v157, v165, v149
  v_fmac_f32 v158, v165, v150
  v_fmac_f32 v159, v165, v151
  v_fmac_f32 v160, v165, v152
  v_fmac_f32 v161, v165, v153
  v_fmac_f32 v162, v165, v154
  v_fmac_f32 v163, v165, v155
  ds_write_b128 v168, v[156:159]
  ds_write_b128 v168, v[160:163] offset:1024
  v_xor_b32 v168, 0x2000, v168
  s_mov_b32 s59, s57
  s_waitcnt lgkmcnt(0)
  s_barrier
  s_cmp_eq_u32 s52, 0
  s_cbranch_scc0 O_next
  v_xor_b32 v211, 0x2000, v168
  ds_read_b128 v[0:3], v211 offset:2048
  ds_read_b128 v[4:7], v211 offset:3072
  ds_read_b128 v[8:11], v211 offset:4096
  ds_read_b128 v[12:15], v211 offset:5120
  ds_read_b128 v[16:19], v211 offset:6144
  ds_read_b128 v[20:23], v211 offset:7168
  s_waitcnt lgkmcnt(5)
  v_add_f32 v156, v156, v0
  v_add_f32 v157, v157, v1
  v_add_f32 v158, v158, v2
  v_add_f32 v159, v159, v3
  s_waitcnt lgkmcnt(4)
  v_add_f32 v160, v160, v4
  v_add_f32 v161, v161, v5
  v_add_f32 v162, v162, v6
  v_add_f32 v163, v163, v7
  s_waitcnt lgkmcnt(3)
  v_add_f32 v156, v156, v8
  v_add_f32 v157, v157, v9
  v_add_f32 v158, v158, v10
  v_add_f32 v159, v159, v11
  s_waitcnt lgkmcnt(2)
  v_add_f32 v160, v160, v12
  v_add_f32 v161, v161, v13
  v_add_f32 v162, v162, v14
  v_add_f32 v163, v163, v15
  s_waitcnt lgkmcnt(1)
  v_add_f32 v156, v156, v16
  v_add_f32 v157, v157, v17
  v_add_f32 v158, v158, v18
  v_add_f32 v159, v159, v19
  s_waitcnt lgkmcnt(0)
  v_add_f32 v160, v160, v20
  v_add_f32 v161, v161, v21
  v_add_f32 v162, v162, v22
  v_add_f32 v163, v163, v23
  v_cvt_pk_bf16_f32 v148, v156, v157
  v_cvt_pk_bf16_f32 v149, v158, v159
  v_cvt_pk_bf16_f32 v150, v160, v161
  v_cvt_pk_bf16_f32 v151, v162, v163
  buffer_store_dwordx4 v[148:151], v167, s[48:51], s64 offen
  s_waitcnt vmcnt(1)
  s_branch O_nx2
O_next:
  s_waitcnt vmcnt(0)
O_nx2:
  s_cmp_lt_u32 s59, 64
  s_cbranch_scc1 O_loop
  s_branch L_exit
W_h:
  s_lshr_b32 s58, s53, 1
  s_and_b32 s59, s53, 1
  s_mul_i32 s60, s59, 36864
  s_add_u32 m0, s67, 0
  s_nop 0
  buffer_load_dwordx4 v202, s[4:7], s60 offen offset:0 lds
  s_add_u32 m0, s67, 896
  s_nop 0
  buffer_load_dwordx4 v202, s[4:7], s60 offen offset:128 lds
  s_add_u32 m0, s67, 1792
  s_nop 0
  buffer_load_dwordx4 v202, s[4:7], s60 offen offset:256 lds
  s_add_u32 m0, s67, 2688
  s_nop 0
  buffer_load_dwordx4 v202, s[4:7], s60 offen offset:384 lds
  s_add_u32 m0, s67, 3584
  s_nop 0
  buffer_load_dwordx4 v202, s[4:7], s60 offen offset:512 lds
  s_add_u32 m0, s67, 4480
  s_nop 0
  buffer_load_dwordx4 v202, s[4:7], s60 offen offset:640 lds
  s_add_u32 m0, s67, 5376
  s_nop 0
  buffer_load_dwordx4 v202, s[4:7], s60 offen offset:768 lds
  s_add_u32 m0, s67, 6272
  s_nop 0
  buffer_load_dwordx4 v202, s[4:7], s60 offen offset:896 lds
  s_add_u32 m0, s67, 7168
  s_nop 0
  buffer_load_dwordx4 v202, s[4:7], s60 offen offset:1024 lds
  v_lshrrev_b32 v211, 4, v200
  v_lshlrev_b32 v212, 2, v211
  v_and_b32 v213, 15, v200
  v_xor_b32 v212, v212, v213
  v_lshlrev_b32 v212, 4, v212
  v_lshl_add_u32 v207, v211, 13, v212
  s_lshl_b32 s62, s58, 8
  s_lshl_b32 s54, s52, 15
  s_add_u32 s62, s62, s54
  s_lshl_b32 s61, s52, 10
  s_add_u32 s61, s61, 36864
  s_add_u32 m0, s61, 0
  s_add_u32 s54, s62, 0
  buffer_load_dwordx4 v207, s[16:19], s54 offen lds
  s_add_u32 m0, s61, 4096
  s_add_u32 s54, s62, 131072
  buffer_load_dwordx4 v207, s[16:19], s54 offen lds
  s_add_u32 m0, s61, 8192
  s_add_u32 s54, s62, 262144
  buffer_load_dwordx4 v207, s[16:19], s54 offen lds
  s_add_u32 m0, s61, 12288
  s_add_u32 s54, s62, 393216
  buffer_load_dwordx4 v207, s[16:19], s54 offen lds
  s_add_u32 m0, s61, 16384
  s_add_u32 s54, s62, 524288
  buffer_load_dwordx4 v207, s[16:19], s54 offen lds
  s_add_u32 m0, s61, 20480
  s_add_u32 s54, s62, 655360
  buffer_load_dwordx4 v207, s[16:19], s54 offen lds
  s_add_u32 m0, s61, 24576
  s_add_u32 s54, s62, 786432
  buffer_load_dwordx4 v207, s[16:19], s54 offen lds
  s_add_u32 m0, s61, 28672
  s_add_u32 s54, s62, 917504
  buffer_load_dwordx4 v207, s[16:19], s54 offen lds
  s_add_u32 m0, s61, 32768
  s_add_u32 s54, s62, 1048576
  buffer_load_dwordx4 v207, s[16:19], s54 offen lds
  s_add_u32 m0, s61, 36864
  s_add_u32 s54, s62, 1179648
  buffer_load_dwordx4 v207, s[16:19], s54 offen lds
  s_add_u32 m0, s61, 40960
  s_add_u32 s54, s62, 1310720
  buffer_load_dwordx4 v207, s[16:19], s54 offen lds
  s_add_u32 m0, s61, 45056
  s_add_u32 s54, s62, 1441792
  buffer_load_dwordx4 v207, s[16:19], s54 offen lds
  s_add_u32 m0, s61, 49152
  s_add_u32 s54, s62, 1572864
  buffer_load_dwordx4 v207, s[16:19], s54 offen lds
  s_add_u32 m0, s61, 53248
  s_add_u32 s54, s62, 1703936
  buffer_load_dwordx4 v207, s[16:19], s54 offen lds
  s_add_u32 m0, s61, 57344
  s_add_u32 s54, s62, 1835008
  buffer_load_dwordx4 v207, s[16:19], s54 offen lds
  s_add_u32 m0, s61, 61440
  s_add_u32 s54, s62, 1966080
  buffer_load_dwordx4 v207, s[16:19], s54 offen lds
  s_add_u32 m0, s61, 65536
  s_add_u32 s54, s62, 2097152
  buffer_load_dwordx4 v207, s[16:19], s54 offen lds
  s_add_u32 m0, s61, 69632
  s_add_u32 s54, s62, 2228224
  buffer_load_dwordx4 v207, s[16:19], s54 offen lds
  s_add_u32 m0, s61, 73728
  s_add_u32 s54, s62, 2359296
  buffer_load_dwordx4 v207, s[16:19], s54 offen lds
  s_add_u32 m0, s61, 77824
  s_add_u32 s54, s62, 2490368
  buffer_load_dwordx4 v207, s[16:19], s54 offen lds
  s_add_u32 m0, s61, 81920
  s_add_u32 s54, s62, 2621440
  buffer_load_dwordx4 v207, s[16:19], s54 offen lds
  s_add_u32 m0, s61, 86016
  s_add_u32 s54, s62, 2752512
  buffer_load_dwordx4 v207, s[16:19], s54 offen lds
  s_add_u32 m0, s61, 90112
  s_add_u32 s54, s62, 2883584
  buffer_load_dwordx4 v207, s[16:19], s54 offen lds
  s_add_u32 m0, s61, 94208
  s_add_u32 s54, s62, 3014656
  buffer_load_dwordx4 v207, s[16:19], s54 offen lds
  s_waitcnt vmcnt(20) lgkmcnt(0)
  s_barrier
  s_add_u32 m0, s61, 98304
  s_add_u32 s54, s62, 3145728
  buffer_load_dwordx4 v207, s[16:19], s54 offen lds
  s_add_u32 m0, s61, 102400
  s_add_u32 s54, s62, 3276800
  buffer_load_dwordx4 v207, s[16:19], s54 offen lds
  s_add_u32 m0, s61, 106496
  s_add_u32 s54, s62, 3407872
  buffer_load_dwordx4 v207, s[16:19], s54 offen lds
  s_add_u32 m0, s61, 110592
  s_add_u32 s54, s62, 3538944
  buffer_load_dwordx4 v207, s[16:19], s54 offen lds
  v_add_u32 v215, 36864, v209
  ds_read_b64_tr_b16 a[0:1], v215 offset:0
  ds_read_b64_tr_b16 a[2:3], v215 offset:1024
  ds_read_b64_tr_b16 a[4:5], v215 offset:4096
  ds_read_b64_tr_b16 a[6:7], v215 offset:5120
  ds_read_b64_tr_b16 a[8:9], v215 offset:8192
  ds_read_b64_tr_b16 a[10:11], v215 offset:9216
  ds_read_b64_tr_b16 a[12:13], v215 offset:12288
  ds_read_b64_tr_b16 a[14:15], v215 offset:13312
  s_waitcnt vmcnt(20) lgkmcnt(0)
  s_barrier
  s_add_u32 m0, s61, 0
  s_add_u32 s54, s62, 3670016
  buffer_load_dwordx4 v207, s[16:19], s54 offen lds
  s_add_u32 m0, s61, 4096
  s_add_u32 s54, s62, 3801088
  buffer_load_dwordx4 v207, s[16:19], s54 offen lds
  s_add_u32 m0, s61, 8192
  s_add_u32 s54, s62, 3932160
  buffer_load_dwordx4 v207, s[16:19], s54 offen lds
  s_add_u32 m0, s61, 12288
  s_add_u32 s54, s62, 4063232
  buffer_load_dwordx4 v207, s[16:19], s54 offen lds
  v_add_u32 v215, 53248, v209
  ds_read_b64_tr_b16 a[16:17], v215 offset:0
  ds_read_b64_tr_b16 a[18:19], v215 offset:1024
  ds_read_b64_tr_b16 a[20:21], v215 offset:4096
  ds_read_b64_tr_b16 a[22:23], v215 offset:5120
  ds_read_b64_tr_b16 a[24:25], v215 offset:8192
  ds_read_b64_tr_b16 a[26:27], v215 offset:9216
  ds_read_b64_tr_b16 a[28:29], v215 offset:12288
  ds_read_b64_tr_b16 a[30:31], v215 offset:13312
  s_waitcnt vmcnt(20) lgkmcnt(0)
  s_barrier
  s_add_u32 m0, s61, 16384
  s_add_u32 s54, s62, 4194304
  buffer_load_dwordx4 v207, s[16:19], s54 offen lds
  s_add_u32 m0, s61, 20480
  s_add_u32 s54, s62, 4325376
  buffer_load_dwordx4 v207, s[16:19], s54 offen lds
  s_add_u32 m0, s61, 24576
  s_add_u32 s54, s62, 4456448
  buffer_load_dwordx4 v207, s[16:19], s54 offen lds
  s_add_u32 m0, s61, 28672
  s_add_u32 s54, s62, 4587520
  buffer_load_dwordx4 v207, s[16:19], s54 offen lds
  v_add_u32 v215, 69632, v209
  ds_read_b64_tr_b16 a[32:33], v215 offset:0
  ds_read_b64_tr_b16 a[34:35], v215 offset:1024
  ds_read_b64_tr_b16 a[36:37], v215 offset:4096
  ds_read_b64_tr_b16 a[38:39], v215 offset:5120
  ds_read_b64_tr_b16 a[40:41], v215 offset:8192
  ds_read_b64_tr_b16 a[42:43], v215 offset:9216
  ds_read_b64_tr_b16 a[44:45], v215 offset:12288
  ds_read_b64_tr_b16 a[46:47], v215 offset:13312
  s_waitcnt vmcnt(20) lgkmcnt(0)
  s_barrier
  v_add_u32 v215, 86016, v209
  ds_read_b64_tr_b16 a[48:49], v215 offset:0
  ds_read_b64_tr_b16 a[50:51], v215 offset:1024
  ds_read_b64_tr_b16 a[52:53], v215 offset:4096
  ds_read_b64_tr_b16 a[54:55], v215 offset:5120
  ds_read_b64_tr_b16 a[56:57], v215 offset:8192
  ds_read_b64_tr_b16 a[58:59], v215 offset:9216
  ds_read_b64_tr_b16 a[60:61], v215 offset:12288
  ds_read_b64_tr_b16 a[62:63], v215 offset:13312
  s_waitcnt vmcnt(16) lgkmcnt(0)
  s_barrier
  v_add_u32 v215, 102400, v209
  ds_read_b64_tr_b16 a[64:65], v215 offset:0
  ds_read_b64_tr_b16 a[66:67], v215 offset:1024
  ds_read_b64_tr_b16 a[68:69], v215 offset:4096
  ds_read_b64_tr_b16 a[70:71], v215 offset:5120
  ds_read_b64_tr_b16 a[72:73], v215 offset:8192
  ds_read_b64_tr_b16 a[74:75], v215 offset:9216
  ds_read_b64_tr_b16 a[76:77], v215 offset:12288
  ds_read_b64_tr_b16 a[78:79], v215 offset:13312
  s_waitcnt vmcnt(12) lgkmcnt(0)
  s_barrier
  v_add_u32 v215, 118784, v209
  ds_read_b64_tr_b16 a[80:81], v215 offset:0
  ds_read_b64_tr_b16 a[82:83], v215 offset:1024
  ds_read_b64_tr_b16 a[84:85], v215 offset:4096
  ds_read_b64_tr_b16 a[86:87], v215 offset:5120
  ds_read_b64_tr_b16 a[88:89], v215 offset:8192
  ds_read_b64_tr_b16 a[90:91], v215 offset:9216
  ds_read_b64_tr_b16 a[92:93], v215 offset:12288
  ds_read_b64_tr_b16 a[94:95], v215 offset:13312
  s_waitcnt vmcnt(8) lgkmcnt(0)
  s_barrier
  v_add_u32 v215, 135168, v209
  ds_read_b64_tr_b16 a[96:97], v215 offset:0
  ds_read_b64_tr_b16 a[98:99], v215 offset:1024
  ds_read_b64_tr_b16 a[100:101], v215 offset:4096
  ds_read_b64_tr_b16 a[102:103], v215 offset:5120
  ds_read_b64_tr_b16 a[104:105], v215 offset:8192
  ds_read_b64_tr_b16 a[106:107], v215 offset:9216
  ds_read_b64_tr_b16 a[108:109], v215 offset:12288
  ds_read_b64_tr_b16 a[110:111], v215 offset:13312
  s_waitcnt vmcnt(4) lgkmcnt(0)
  s_barrier
  v_add_u32 v215, 36864, v209
  ds_read_b64_tr_b16 a[112:113], v215 offset:0
  ds_read_b64_tr_b16 a[114:115], v215 offset:1024
  ds_read_b64_tr_b16 a[116:117], v215 offset:4096
  ds_read_b64_tr_b16 a[118:119], v215 offset:5120
  ds_read_b64_tr_b16 a[120:121], v215 offset:8192
  ds_read_b64_tr_b16 a[122:123], v215 offset:9216
  ds_read_b64_tr_b16 a[124:125], v215 offset:12288
  ds_read_b64_tr_b16 a[126:127], v215 offset:13312
  s_waitcnt vmcnt(0) lgkmcnt(0)
  s_barrier
  v_add_u32 v215, 53248, v209
  ds_read_b64_tr_b16 a[128:129], v215 offset:0
  ds_read_b64_tr_b16 a[130:131], v215 offset:1024
  ds_read_b64_tr_b16 a[132:133], v215 offset:4096
  ds_read_b64_tr_b16 a[134:135], v215 offset:5120
  ds_read_b64_tr_b16 a[136:137], v215 offset:8192
  ds_read_b64_tr_b16 a[138:139], v215 offset:9216
  ds_read_b64_tr_b16 a[140:141], v215 offset:12288
  ds_read_b64_tr_b16 a[142:143], v215 offset:13312
  s_waitcnt lgkmcnt(0)
  s_barrier
  v_and_b32 v211, 31, v200
  v_lshrrev_b32 v212, 5, v200
  v_lshlrev_b32 v213, 2, v212
  v_sub_u32 v211, v211, v213
  v_mov_b32 v214, 0xf149f2ca
  v_cmp_gt_i32 vcc, 0, v211
  s_nop 1
  v_cndmask_b32 v48, 0, v214, vcc
  v_cmp_gt_i32 vcc, 1, v211
  s_nop 1
  v_cndmask_b32 v49, 0, v214, vcc
  v_cmp_gt_i32 vcc, 2, v211
  s_nop 1
  v_cndmask_b32 v50, 0, v214, vcc
  v_cmp_gt_i32 vcc, 3, v211
  s_nop 1
  v_cndmask_b32 v51, 0, v214, vcc
  v_cmp_gt_i32 vcc, 8, v211
  s_nop 1
  v_cndmask_b32 v52, 0, v214, vcc
  v_cmp_gt_i32 vcc, 9, v211
  s_nop 1
  v_cndmask_b32 v53, 0, v214, vcc
  v_cmp_gt_i32 vcc, 10, v211
  s_nop 1
  v_cndmask_b32 v54, 0, v214, vcc
  v_cmp_gt_i32 vcc, 11, v211
  s_nop 1
  v_cndmask_b32 v55, 0, v214, vcc
  v_cmp_gt_i32 vcc, 16, v211
  s_nop 1
  v_cndmask_b32 v56, 0, v214, vcc
  v_cmp_gt_i32 vcc, 17, v211
  s_nop 1
  v_cndmask_b32 v57, 0, v214, vcc
  v_cmp_gt_i32 vcc, 18, v211
  s_nop 1
  v_cndmask_b32 v58, 0, v214, vcc
  v_cmp_gt_i32 vcc, 19, v211
  s_nop 1
  v_cndmask_b32 v59, 0, v214, vcc
  v_cmp_gt_i32 vcc, 24, v211
  s_nop 1
  v_cndmask_b32 v60, 0, v214, vcc
  v_cmp_gt_i32 vcc, 25, v211
  s_nop 1
  v_cndmask_b32 v61, 0, v214, vcc
  v_cmp_gt_i32 vcc, 26, v211
  s_nop 1
  v_cndmask_b32 v62, 0, v214, vcc
  v_cmp_gt_i32 vcc, 27, v211
  s_nop 1
  v_cndmask_b32 v63, 0, v214, vcc
  v_and_b32 v218, 0xff, v216
  v_add_u32 v218, 81920, v218
  v_and_b32 v211, 15, v200
  v_lshl_add_u32 v211, v212, 5, v211
  v_lshlrev_b32 v219, 3, v211
  v_bfe_u32 v211, v200, 4, 1
  v_lshl_add_u32 v219, v211, 2, v219
  s_lshl_b32 s54, s52, 9
  s_add_u32 s54, s54, 83968
  v_add_u32 v219, s54, v219
  v_lshl_add_u32 v221, v200, 3, s54
  s_lshr_b32 s54, s52, 1
  s_lshl_b32 s54, s54, 10
  s_and_b32 s55, s52, 1
  s_lshl_b32 s55, s55, 3
  s_add_u32 s54, s54, s55
  s_add_u32 s54, s54, 81920
  v_add_u32 v220, s54, v201
  s_lshl_b32 s54, s52, 11
  s_add_u32 s54, s54, 73728
  v_add_u32 v215, s54, v201
  v_add_u32 v208, 73728, v201
  s_mov_b32 s68, 1040356334
  s_cmp_eq_u32 s52, 0
  s_cselect_b32 s71, s71, 268435456
  s_lshl_b32 s56, s58, 2
  s_add_u32 s56, s56, 128
  v_mov_b32 v176, -1
  v_mov_b32 v177, -1
  v_mov_b32 v178, -1
  v_mov_b32 v179, -1
  s_cmp_eq_u32 s52, 0
  s_cbranch_scc0 AT_p1_d
  s_mov_b32 exec_hi, 0
  s_mov_b32 exec_lo, 1
AT_p1:
  buffer_load_dword v211, v201, s[12:15], s56 offen sc1
  s_add_u32 s65, s65, 1
  s_waitcnt vmcnt(0)
  v_cmp_gt_u32 vcc, 0x700, v211
  s_cbranch_vccz AT_p1_x
  s_sleep 8
  s_cmp_lt_u32 s65, 131072
  s_cbranch_scc1 AT_p1
AT_p1_x:
  s_mov_b64 exec, -1
AT_p1_d:
  s_barrier
  s_mov_b32 s74, s59
  s_mul_i32 s66, s59, 655360
  s_lshl_b32 s55, s58, 14
  s_add_u32 s55, s55, s66
  s_add_u32 s55, s55, 1048576
  s_lshl_b32 s73, s58, 2
  s_add_u32 s73, s73, s52
  s_lshl_b32 s72, s59, 7
  s_add_u32 s72, s72, s73
  s_lshl_b32 s72, s72, 11
  s_add_u32 s72, s72, 46137344
  s_lshl_b32 s73, s73, 10
  s_add_u32 s73, s73, s66
  s_add_u32 s73, s73, 1572864
  s_add_u32 s59, s59, 2
  buffer_load_dwordx4 v[128:131], v216, s[8:11], s55 offen offset:0 sc1
  buffer_load_dwordx4 v[132:135], v216, s[8:11], s55 offen offset:256 sc1
  buffer_load_dwordx4 v[136:139], v216, s[8:11], s55 offen offset:512 sc1
  buffer_load_dwordx4 v[140:143], v216, s[8:11], s55 offen offset:768 sc1
  buffer_load_dwordx4 v[144:147], v216, s[8:11], s55 offen offset:1024 sc1
  buffer_load_dwordx4 v[148:151], v216, s[8:11], s55 offen offset:1280 sc1
  buffer_load_dwordx4 v[152:155], v216, s[8:11], s55 offen offset:1536 sc1
  buffer_load_dwordx4 v[156:159], v216, s[8:11], s55 offen offset:1792 sc1
  buffer_load_dwordx4 v[160:163], v217, s[8:11], s55 offen offset:0 sc1
  buffer_load_dwordx4 v[164:167], v217, s[8:11], s55 offen offset:256 sc1
  s_add_u32 s60, s60, 73728
  ds_read_b128 v[32:35], v203 offset:0
  ds_read_b128 v[36:39], v204 offset:0
  ds_read_b128 v[40:43], v205 offset:0
  s_waitcnt lgkmcnt(2)
  v_mfma_f32_32x32x16_bf16 v[240:255], a[0:3], v[32:35], 0
  ds_read_b128 v[44:47], v206 offset:0
  s_add_u32 m0, s67, 36864
  s_nop 0
  buffer_load_dwordx4 v202, s[4:7], s60 offen offset:0 lds
  s_waitcnt lgkmcnt(2)
  v_mfma_f32_32x32x16_bf16 v[240:255], a[4:7], v[36:39], v[240:255]
  ds_read_b128 v[32:35], v203 offset:1024
  s_waitcnt lgkmcnt(2)
  v_mfma_f32_32x32x16_bf16 v[240:255], a[8:11], v[40:43], v[240:255]
  ds_read_b128 v[36:39], v204 offset:1024
  s_add_u32 m0, s67, 37760
  s_nop 0
  buffer_load_dwordx4 v202, s[4:7], s60 offen offset:128 lds
  s_waitcnt lgkmcnt(2)
  v_mfma_f32_32x32x16_bf16 v[240:255], a[12:15], v[44:47], v[240:255]
  ds_read_b128 v[40:43], v205 offset:1024
  s_waitcnt lgkmcnt(2)
  v_mfma_f32_32x32x16_bf16 v[240:255], a[16:19], v[32:35], v[240:255]
  ds_read_b128 v[44:47], v206 offset:1024
  s_add_u32 m0, s67, 38656
  s_nop 0
  buffer_load_dwordx4 v202, s[4:7], s60 offen offset:256 lds
  s_waitcnt lgkmcnt(2)
  v_mfma_f32_32x32x16_bf16 v[240:255], a[20:23], v[36:39], v[240:255]
  ds_read_b128 v[32:35], v203 offset:2048
  s_waitcnt lgkmcnt(2)
  v_mfma_f32_32x32x16_bf16 v[240:255], a[24:27], v[40:43], v[240:255]
  ds_read_b128 v[36:39], v204 offset:2048
  s_add_u32 m0, s67, 39552
  s_nop 0
  buffer_load_dwordx4 v202, s[4:7], s60 offen offset:384 lds
  s_waitcnt lgkmcnt(2)
  v_mfma_f32_32x32x16_bf16 v[240:255], a[28:31], v[44:47], v[240:255]
  ds_read_b128 v[40:43], v205 offset:2048
  s_waitcnt lgkmcnt(2)
  v_mfma_f32_32x32x16_bf16 v[240:255], a[32:35], v[32:35], v[240:255]
  ds_read_b128 v[44:47], v206 offset:2048
  s_add_u32 m0, s67, 40448
  s_nop 0
  buffer_load_dwordx4 v202, s[4:7], s60 offen offset:512 lds
  s_waitcnt lgkmcnt(2)
  v_mfma_f32_32x32x16_bf16 v[240:255], a[36:39], v[36:39], v[240:255]
  ds_read_b128 v[32:35], v203 offset:3072
  s_waitcnt lgkmcnt(2)
  v_mfma_f32_32x32x16_bf16 v[240:255], a[40:43], v[40:43], v[240:255]
  ds_read_b128 v[36:39], v204 offset:3072
  s_add_u32 m0, s67, 41344
  s_nop 0
  buffer_load_dwordx4 v202, s[4:7], s60 offen offset:640 lds
  s_waitcnt lgkmcnt(2)
  v_mfma_f32_32x32x16_bf16 v[240:255], a[44:47], v[44:47], v[240:255]
  ds_read_b128 v[40:43], v205 offset:3072
  s_waitcnt lgkmcnt(2)
  v_mfma_f32_32x32x16_bf16 v[240:255], a[48:51], v[32:35], v[240:255]
  ds_read_b128 v[44:47], v206 offset:3072
  s_add_u32 m0, s67, 42240
  s_nop 0
  buffer_load_dwordx4 v202, s[4:7], s60 offen offset:768 lds
  s_waitcnt lgkmcnt(2)
  v_mfma_f32_32x32x16_bf16 v[240:255], a[52:55], v[36:39], v[240:255]
  ds_read_b128 v[32:35], v203 offset:4096
  s_waitcnt lgkmcnt(2)
  v_mfma_f32_32x32x16_bf16 v[240:255], a[56:59], v[40:43], v[240:255]
  ds_read_b128 v[36:39], v204 offset:4096
  s_add_u32 m0, s67, 43136
  s_nop 0
  buffer_load_dwordx4 v202, s[4:7], s60 offen offset:896 lds
  s_waitcnt lgkmcnt(2)
  v_mfma_f32_32x32x16_bf16 v[240:255], a[60:63], v[44:47], v[240:255]
  ds_read_b128 v[40:43], v205 offset:4096
  s_waitcnt lgkmcnt(2)
  v_mfma_f32_32x32x16_bf16 v[240:255], a[64:67], v[32:35], v[240:255]
  ds_read_b128 v[44:47], v206 offset:4096
  s_add_u32 m0, s67, 44032
  s_nop 0
  buffer_load_dwordx4 v202, s[4:7], s60 offen offset:1024 lds
  s_waitcnt lgkmcnt(2)
  v_mfma_f32_32x32x16_bf16 v[240:255], a[68:71], v[36:39], v[240:255]
  ds_read_b128 v[32:35], v203 offset:5120
  s_waitcnt lgkmcnt(2)
  v_mfma_f32_32x32x16_bf16 v[240:255], a[72:75], v[40:43], v[240:255]
  ds_read_b128 v[36:39], v204 offset:5120
  buffer_store_dwordx4 v[176:179], v201, s[8:11], s72 offen offset:0 sc1
  s_waitcnt lgkmcnt(2)
  v_mfma_f32_32x32x16_bf16 v[240:255], a[76:79], v[44:47], v[240:255]
  ds_read_b128 v[40:43], v205 offset:5120
  s_waitcnt lgkmcnt(2)
  v_mfma_f32_32x32x16_bf16 v[240:255], a[80:83], v[32:35], v[240:255]
  ds_read_b128 v[44:47], v206 offset:5120
  buffer_store_dwordx4 v[176:179], v201, s[8:11], s72 offen offset:1024 sc1
  s_waitcnt lgkmcnt(2)
  v_mfma_f32_32x32x16_bf16 v[240:255], a[84:87], v[36:39], v[240:255]
  ds_read_b128 v[32:35], v203 offset:6144
  s_waitcnt lgkmcnt(2)
  v_mfma_f32_32x32x16_bf16 v[240:255], a[88:91], v[40:43], v[240:255]
  ds_read_b128 v[36:39], v204 offset:6144
  s_waitcnt lgkmcnt(2)
  v_mfma_f32_32x32x16_bf16 v[240:255], a[92:95], v[44:47], v[240:255]
  ds_read_b128 v[40:43], v205 offset:6144
  s_waitcnt lgkmcnt(2)
  v_mfma_f32_32x32x16_bf16 v[240:255], a[96:99], v[32:35], v[240:255]
  ds_read_b128 v[44:47], v206 offset:6144
  s_waitcnt lgkmcnt(2)
  v_mfma_f32_32x32x16_bf16 v[240:255], a[100:103], v[36:39], v[240:255]
  ds_read_b128 v[32:35], v203 offset:7168
  s_waitcnt lgkmcnt(2)
  v_mfma_f32_32x32x16_bf16 v[240:255], a[104:107], v[40:43], v[240:255]
  ds_read_b128 v[36:39], v204 offset:7168
  s_waitcnt lgkmcnt(2)
  v_mfma_f32_32x32x16_bf16 v[240:255], a[108:111], v[44:47], v[240:255]
  ds_read_b128 v[40:43], v205 offset:7168
  s_waitcnt lgkmcnt(2)
  v_mfma_f32_32x32x16_bf16 v[240:255], a[112:115], v[32:35], v[240:255]
  ds_read_b128 v[44:47], v206 offset:7168
  s_waitcnt lgkmcnt(2)
  v_mfma_f32_32x32x16_bf16 v[240:255], a[116:119], v[36:39], v[240:255]
  ds_read_b128 v[32:35], v203 offset:8192
  s_waitcnt lgkmcnt(2)
  v_mfma_f32_32x32x16_bf16 v[240:255], a[120:123], v[40:43], v[240:255]
  ds_read_b128 v[36:39], v204 offset:8192
  s_waitcnt lgkmcnt(2)
  v_mfma_f32_32x32x16_bf16 v[240:255], a[124:127], v[44:47], v[240:255]
  ds_read_b128 v[40:43], v205 offset:8192
  s_waitcnt lgkmcnt(2)
  v_mfma_f32_32x32x16_bf16 v[240:255], a[128:131], v[32:35], v[240:255]
  ds_read_b128 v[44:47], v206 offset:8192
  s_waitcnt lgkmcnt(2)
  v_mfma_f32_32x32x16_bf16 v[240:255], a[132:135], v[36:39], v[240:255]
  s_waitcnt lgkmcnt(1)
  v_mfma_f32_32x32x16_bf16 v[240:255], a[136:139], v[40:43], v[240:255]
  s_waitcnt lgkmcnt(0)
  v_mfma_f32_32x32x16_bf16 v[240:255], a[140:143], v[44:47], v[240:255]
  s_nop 11
  v_cvt_pk_bf16_f32 v16, v240, v244
  v_cvt_pk_bf16_f32 v17, v241, v245
  v_cvt_pk_bf16_f32 v18, v242, v246
  v_cvt_pk_bf16_f32 v19, v243, v247
  ds_write_b128 v215, v[16:19] offset:0
  v_cvt_pk_bf16_f32 v20, v248, v252
  v_cvt_pk_bf16_f32 v21, v249, v253
  v_cvt_pk_bf16_f32 v22, v250, v254
  v_cvt_pk_bf16_f32 v23, v251, v255
  ds_write_b128 v215, v[20:23] offset:1024
  s_waitcnt lgkmcnt(0)
  s_barrier
  ds_read_b128 v[96:99], v208 offset:0
  ds_read_b128 v[100:103], v208 offset:1024
  ds_read_b128 v[104:107], v208 offset:2048
  ds_read_b128 v[108:111], v208 offset:3072
  ds_read_b128 v[112:115], v208 offset:4096
  ds_read_b128 v[116:119], v208 offset:5120
  ds_read_b128 v[120:123], v208 offset:6144
  ds_read_b128 v[124:127], v208 offset:7168
  s_waitcnt vmcnt(20) lgkmcnt(7)
  v_mfma_f32_32x32x16_bf16 v[64:79], v[128:131], v[96:99], v[48:63]
  s_waitcnt vmcnt(19) lgkmcnt(6)
  v_mfma_f32_32x32x16_bf16 v[64:79], v[132:135], v[100:103], v[64:79]
  s_waitcnt vmcnt(18) lgkmcnt(5)
  v_mfma_f32_32x32x16_bf16 v[64:79], v[136:139], v[104:107], v[64:79]
  s_waitcnt vmcnt(17) lgkmcnt(4)
  v_mfma_f32_32x32x16_bf16 v[64:79], v[140:143], v[108:111], v[64:79]
  s_waitcnt vmcnt(16) lgkmcnt(3)
  v_mfma_f32_32x32x16_bf16 v[64:79], v[144:147], v[112:115], v[64:79]
  s_waitcnt vmcnt(15) lgkmcnt(2)
  v_mfma_f32_32x32x16_bf16 v[64:79], v[148:151], v[116:119], v[64:79]
  s_waitcnt vmcnt(14) lgkmcnt(1)
  v_mfma_f32_32x32x16_bf16 v[64:79], v[152:155], v[120:123], v[64:79]
  s_waitcnt vmcnt(13) lgkmcnt(0)
  v_mfma_f32_32x32x16_bf16 v[64:79], v[156:159], v[124:127], v[64:79]
  s_nop 11
  v_max3_f32 v180, v64, v65, v66
  v_max3_f32 v180, v180, v67, v68
  v_max3_f32 v180, v180, v69, v70
  v_max3_f32 v180, v180, v71, v72
  v_max3_f32 v180, v180, v73, v74
  v_max3_f32 v180, v180, v75, v76
  v_max3_f32 v180, v180, v77, v78
  v_max_f32 v180, v180, v79
  v_mov_b32 v181, v180
  s_nop 1
  v_permlane32_swap_b32 v180, v181
  v_max_f32 v180, v180, v181
  v_sub_f32 v64, v64, v180
  v_sub_f32 v65, v65, v180
  v_sub_f32 v66, v66, v180
  v_sub_f32 v67, v67, v180
  v_sub_f32 v68, v68, v180
  v_sub_f32 v69, v69, v180
  v_sub_f32 v70, v70, v180
  v_sub_f32 v71, v71, v180
  v_sub_f32 v72, v72, v180
  v_sub_f32 v73, v73, v180
  v_sub_f32 v74, v74, v180
  v_sub_f32 v75, v75, v180
  v_sub_f32 v76, v76, v180
  v_sub_f32 v77, v77, v180
  v_sub_f32 v78, v78, v180
  v_sub_f32 v79, v79, v180
  v_exp_f32 v64, v64
  v_exp_f32 v65, v65
  v_exp_f32 v66, v66
  v_exp_f32 v67, v67
  v_exp_f32 v68, v68
  v_exp_f32 v69, v69
  v_exp_f32 v70, v70
  v_exp_f32 v71, v71
  v_exp_f32 v72, v72
  v_exp_f32 v73, v73
  v_exp_f32 v74, v74
  v_exp_f32 v75, v75
  v_exp_f32 v76, v76
  v_exp_f32 v77, v77
  v_exp_f32 v78, v78
  v_exp_f32 v79, v79
  v_cvt_pk_bf16_f32 v20, v64, v65
  v_cvt_pk_bf16_f32 v21, v68, v69
  v_cvt_pk_bf16_f32 v22, v72, v73
  v_cvt_pk_bf16_f32 v23, v76, v77
  v_cvt_pk_bf16_f32 v24, v66, v67
  v_cvt_pk_bf16_f32 v25, v70, v71
  v_cvt_pk_bf16_f32 v26, v74, v75
  v_cvt_pk_bf16_f32 v27, v78, v79
  s_waitcnt vmcnt(12)
  v_mfma_f32_32x32x16_bf16 v[0:15], v[160:163], v[20:23], 0
  v_add_f32 v182, v64, v65
  v_add_f32 v182, v182, v66
  v_add_f32 v182, v182, v67
  v_add_f32 v182, v182, v68
  v_add_f32 v182, v182, v69
  v_add_f32 v182, v182, v70
  v_add_f32 v182, v182, v71
  s_waitcnt vmcnt(11)
  v_mfma_f32_32x32x16_bf16 v[0:15], v[164:167], v[24:27], v[0:15]
  v_add_f32 v182, v182, v72
  v_add_f32 v182, v182, v73
  v_add_f32 v182, v182, v74
  v_add_f32 v182, v182, v75
  v_add_f32 v182, v182, v76
  v_add_f32 v182, v182, v77
  v_add_f32 v182, v182, v78
  v_add_f32 v182, v182, v79
  s_waitcnt vmcnt(0)
  s_barrier
AT_loop:
  s_cmp_ge_u32 s59, 64
  s_cbranch_scc1 AT_l0
  s_mov_b32 s77, s59
  s_mul_i32 s66, s59, 655360
  s_lshl_b32 s55, s58, 14
  s_add_u32 s55, s55, s66
  s_add_u32 s55, s55, 1048576
  s_lshl_b32 s76, s58, 2
  s_add_u32 s76, s76, s52
  s_lshl_b32 s75, s59, 7
  s_add_u32 s75, s75, s76
  s_lshl_b32 s75, s75, 11
  s_add_u32 s75, s75, 46137344
  s_lshl_b32 s76, s76, 10
  s_add_u32 s76, s76, s66
  s_add_u32 s76, s76, 1572864
  s_add_u32 s59, s59, 2
  buffer_load_dwordx4 v[128:131], v216, s[8:11], s55 offen offset:0 sc1
  buffer_load_dwordx4 v[132:135], v216, s[8:11], s55 offen offset:256 sc1
  buffer_load_dwordx4 v[136:139], v216, s[8:11], s55 offen offset:512 sc1
  buffer_load_dwordx4 v[140:143], v216, s[8:11], s55 offen offset:768 sc1
  buffer_load_dwordx4 v[144:147], v216, s[8:11], s55 offen offset:1024 sc1
  buffer_load_dwordx4 v[148:151], v216, s[8:11], s55 offen offset:1280 sc1
  buffer_load_dwordx4 v[152:155], v216, s[8:11], s55 offen offset:1536 sc1
  buffer_load_dwordx4 v[156:159], v216, s[8:11], s55 offen offset:1792 sc1
  buffer_load_dwordx4 v[160:163], v217, s[8:11], s55 offen offset:0 sc1
  buffer_load_dwordx4 v[164:167], v217, s[8:11], s55 offen offset:256 sc1
  s_or_b32 s70, s73, 0xc00
  buffer_load_dword v172, off, s[8:11], s70 sc1
  s_add_u32 s60, s60, 73728
  ds_read_b128 v[32:35], v203 offset:36864
  ds_read_b128 v[36:39], v204 offset:36864
  ds_read_b128 v[40:43], v205 offset:36864
  s_waitcnt lgkmcnt(2)
  v_mfma_f32_32x32x16_bf16 v[240:255], a[0:3], v[32:35], 0
  ds_read_b128 v[44:47], v206 offset:36864
  s_add_u32 m0, s67, 0
  s_nop 0
  buffer_load_dwordx4 v202, s[4:7], s60 offen offset:0 lds
  s_waitcnt lgkmcnt(2)
  v_mfma_f32_32x32x16_bf16 v[240:255], a[4:7], v[36:39], v[240:255]
  ds_read_b128 v[32:35], v203 offset:37888
  s_waitcnt lgkmcnt(2)
  v_mfma_f32_32x32x16_bf16 v[240:255], a[8:11], v[40:43], v[240:255]
  ds_read_b128 v[36:39], v204 offset:37888
  s_add_u32 m0, s67, 896
  s_nop 0
  buffer_load_dwordx4 v202, s[4:7], s60 offen offset:128 lds
  s_waitcnt lgkmcnt(2)
  v_mfma_f32_32x32x16_bf16 v[240:255], a[12:15], v[44:47], v[240:255]
  ds_read_b128 v[40:43], v205 offset:37888
  s_waitcnt lgkmcnt(2)
  v_mfma_f32_32x32x16_bf16 v[240:255], a[16:19], v[32:35], v[240:255]
  ds_read_b128 v[44:47], v206 offset:37888
  s_add_u32 m0, s67, 1792
  s_nop 0
  buffer_load_dwordx4 v202, s[4:7], s60 offen offset:256 lds
  s_waitcnt lgkmcnt(2)
  v_mfma_f32_32x32x16_bf16 v[240:255], a[20:23], v[36:39], v[240:255]
  ds_read_b128 v[32:35], v203 offset:38912
  s_waitcnt lgkmcnt(2)
  v_mfma_f32_32x32x16_bf16 v[240:255], a[24:27], v[40:43], v[240:255]
  ds_read_b128 v[36:39], v204 offset:38912
  s_add_u32 m0, s67, 2688
  s_nop 0
  buffer_load_dwordx4 v202, s[4:7], s60 offen offset:384 lds
  s_waitcnt lgkmcnt(2)
  v_mfma_f32_32x32x16_bf16 v[240:255], a[28:31], v[44:47], v[240:255]
  ds_read_b128 v[40:43], v205 offset:38912
  s_waitcnt lgkmcnt(2)
  v_mfma_f32_32x32x16_bf16 v[240:255], a[32:35], v[32:35], v[240:255]
  ds_read_b128 v[44:47], v206 offset:38912
  s_add_u32 m0, s67, 3584
  s_nop 0
  buffer_load_dwordx4 v202, s[4:7], s60 offen offset:512 lds
  s_waitcnt lgkmcnt(2)
  v_mfma_f32_32x32x16_bf16 v[240:255], a[36:39], v[36:39], v[240:255]
  ds_read_b128 v[32:35], v203 offset:39936
  s_waitcnt lgkmcnt(2)
  v_mfma_f32_32x32x16_bf16 v[240:255], a[40:43], v[40:43], v[240:255]
  ds_read_b128 v[36:39], v204 offset:39936
  s_add_u32 m0, s67, 4480
  s_nop 0
  buffer_load_dwordx4 v202, s[4:7], s60 offen offset:640 lds
  s_waitcnt lgkmcnt(2)
  v_mfma_f32_32x32x16_bf16 v[240:255], a[44:47], v[44:47], v[240:255]
  ds_read_b128 v[40:43], v205 offset:39936
  s_waitcnt lgkmcnt(2)
  v_mfma_f32_32x32x16_bf16 v[240:255], a[48:51], v[32:35], v[240:255]
  ds_read_b128 v[44:47], v206 offset:39936
  s_add_u32 m0, s67, 5376
  s_nop 0
  buffer_load_dwordx4 v202, s[4:7], s60 offen offset:768 lds
  s_waitcnt lgkmcnt(2)
  v_mfma_f32_32x32x16_bf16 v[240:255], a[52:55], v[36:39], v[240:255]
  ds_read_b128 v[32:35], v203 offset:40960
  s_waitcnt lgkmcnt(2)
  v_mfma_f32_32x32x16_bf16 v[240:255], a[56:59], v[40:43], v[240:255]
  ds_read_b128 v[36:39], v204 offset:40960
  s_add_u32 m0, s67, 6272
  s_nop 0
  buffer_load_dwordx4 v202, s[4:7], s60 offen offset:896 lds
  s_waitcnt lgkmcnt(2)
  v_mfma_f32_32x32x16_bf16 v[240:255], a[60:63], v[44:47], v[240:255]
  ds_read_b128 v[40:43], v205 offset:40960
  s_waitcnt lgkmcnt(2)
  v_mfma_f32_32x32x16_bf16 v[240:255], a[64:67], v[32:35], v[240:255]
  ds_read_b128 v[44:47], v206 offset:40960
  s_add_u32 m0, s67, 7168
  s_nop 0
  buffer_load_dwordx4 v202, s[4:7], s60 offen offset:1024 lds
  s_waitcnt lgkmcnt(2)
  v_mfma_f32_32x32x16_bf16 v[240:255], a[68:71], v[36:39], v[240:255]
  ds_read_b128 v[32:35], v203 offset:41984
  s_waitcnt lgkmcnt(2)
  v_mfma_f32_32x32x16_bf16 v[240:255], a[72:75], v[40:43], v[240:255]
  ds_read_b128 v[36:39], v204 offset:41984
  buffer_store_dwordx4 v[176:179], v201, s[8:11], s75 offen offset:0 sc1
  s_waitcnt lgkmcnt(2)
  v_mfma_f32_32x32x16_bf16 v[240:255], a[76:79], v[44:47], v[240:255]
  ds_read_b128 v[40:43], v205 offset:41984
  s_waitcnt lgkmcnt(2)
  v_mfma_f32_32x32x16_bf16 v[240:255], a[80:83], v[32:35], v[240:255]
  ds_read_b128 v[44:47], v206 offset:41984
  buffer_store_dwordx4 v[176:179], v201, s[8:11], s75 offen offset:1024 sc1
  s_waitcnt lgkmcnt(2)
  v_mfma_f32_32x32x16_bf16 v[240:255], a[84:87], v[36:39], v[240:255]
  ds_read_b128 v[32:35], v203 offset:43008
  s_waitcnt lgkmcnt(2)
  v_mfma_f32_32x32x16_bf16 v[240:255], a[88:91], v[40:43], v[240:255]
  ds_read_b128 v[36:39], v204 offset:43008
  s_waitcnt lgkmcnt(2)
  v_mfma_f32_32x32x16_bf16 v[240:255], a[92:95], v[44:47], v[240:255]
  ds_read_b128 v[40:43], v205 offset:43008
  s_waitcnt lgkmcnt(2)
  v_mfma_f32_32x32x16_bf16 v[240:255], a[96:99], v[32:35], v[240:255]
  ds_read_b128 v[44:47], v206 offset:43008
  s_waitcnt lgkmcnt(2)
  v_mfma_f32_32x32x16_bf16 v[240:255], a[100:103], v[36:39], v[240:255]
  ds_read_b128 v[32:35], v203 offset:44032
  s_waitcnt lgkmcnt(2)
  v_mfma_f32_32x32x16_bf16 v[240:255], a[104:107], v[40:43], v[240:255]
  ds_read_b128 v[36:39], v204 offset:44032
  s_waitcnt lgkmcnt(2)
  v_mfma_f32_32x32x16_bf16 v[240:255], a[108:111], v[44:47], v[240:255]
  ds_read_b128 v[40:43], v205 offset:44032
  s_waitcnt lgkmcnt(2)
  v_mfma_f32_32x32x16_bf16 v[240:255], a[112:115], v[32:35], v[240:255]
  ds_read_b128 v[44:47], v206 offset:44032
  s_waitcnt lgkmcnt(2)
  v_mfma_f32_32x32x16_bf16 v[240:255], a[116:119], v[36:39], v[240:255]
  ds_read_b128 v[32:35], v203 offset:45056
  s_waitcnt lgkmcnt(2)
  v_mfma_f32_32x32x16_bf16 v[240:255], a[120:123], v[40:43], v[240:255]
  ds_read_b128 v[36:39], v204 offset:45056
  s_waitcnt lgkmcnt(2)
  v_mfma_f32_32x32x16_bf16 v[240:255], a[124:127], v[44:47], v[240:255]
  ds_read_b128 v[40:43], v205 offset:45056
  s_waitcnt lgkmcnt(2)
  v_mfma_f32_32x32x16_bf16 v[240:255], a[128:131], v[32:35], v[240:255]
  ds_read_b128 v[44:47], v206 offset:45056
  s_waitcnt lgkmcnt(2)
  v_mfma_f32_32x32x16_bf16 v[240:255], a[132:135], v[36:39], v[240:255]
  s_waitcnt lgkmcnt(1)
  v_mfma_f32_32x32x16_bf16 v[240:255], a[136:139], v[40:43], v[240:255]
  s_waitcnt lgkmcnt(0)
  v_mfma_f32_32x32x16_bf16 v[240:255], a[140:143], v[44:47], v[240:255]
  s_nop 11
  v_cvt_pk_bf16_f32 v16, v240, v244
  v_cvt_pk_bf16_f32 v17, v241, v245
  v_cvt_pk_bf16_f32 v18, v242, v246
  v_cvt_pk_bf16_f32 v19, v243, v247
  ds_write_b128 v215, v[16:19] offset:0
  v_cvt_pk_bf16_f32 v20, v248, v252
  v_cvt_pk_bf16_f32 v21, v249, v253
  v_cvt_pk_bf16_f32 v22, v250, v254
  v_cvt_pk_bf16_f32 v23, v251, v255
  ds_write_b128 v215, v[20:23] offset:1024
  s_waitcnt lgkmcnt(0)
  s_barrier
  ds_read_b128 a[144:147], v208 offset:0
  ds_read_b128 a[148:151], v208 offset:1024
  ds_read_b128 a[152:155], v208 offset:2048
  ds_read_b128 a[156:159], v208 offset:3072
  ds_read_b128 a[160:163], v208 offset:4096
  ds_read_b128 a[164:167], v208 offset:5120
  ds_read_b128 a[168:171], v208 offset:6144
  ds_read_b128 a[172:175], v208 offset:7168
  s_waitcnt vmcnt(11)
  v_cmp_eq_u32 vcc, -1, v172
  s_mov_b32 s69, 0
  s_cbranch_vccnz AT_e1
  s_mov_b32 s69, 1
  buffer_load_dwordx4 v[172:175], v201, s[8:11], s73 offen sc1
AT_e1:
  s_waitcnt lgkmcnt(7)
  v_mfma_f32_32x32x16_bf16 v[64:79], v[128:131], a[144:147], v[48:63]
  s_waitcnt lgkmcnt(6)
  v_mfma_f32_32x32x16_bf16 v[64:79], v[132:135], a[148:151], v[64:79]
  s_waitcnt lgkmcnt(5)
  v_mfma_f32_32x32x16_bf16 v[64:79], v[136:139], a[152:155], v[64:79]
  s_waitcnt lgkmcnt(4)
  v_mfma_f32_32x32x16_bf16 v[64:79], v[140:143], a[156:159], v[64:79]
  s_waitcnt lgkmcnt(3)
  v_mfma_f32_32x32x16_bf16 v[64:79], v[144:147], a[160:163], v[64:79]
  s_waitcnt lgkmcnt(2)
  v_mfma_f32_32x32x16_bf16 v[64:79], v[148:151], a[164:167], v[64:79]
  s_waitcnt lgkmcnt(1)
  v_mfma_f32_32x32x16_bf16 v[64:79], v[152:155], a[168:171], v[64:79]
  s_waitcnt lgkmcnt(0)
  v_mfma_f32_32x32x16_bf16 v[64:79], v[156:159], a[172:175], v[64:79]
  s_nop 11
  v_max3_f32 v184, v64, v65, v66
  v_max3_f32 v184, v184, v67, v68
  v_max3_f32 v184, v184, v69, v70
  v_max3_f32 v184, v184, v71, v72
  v_max3_f32 v184, v184, v73, v74
  v_max3_f32 v184, v184, v75, v76
  v_max3_f32 v184, v184, v77, v78
  v_max_f32 v184, v184, v79
  v_mov_b32 v185, v184
  s_nop 1
  v_permlane32_swap_b32 v184, v185
  v_max_f32 v184, v184, v185
  v_sub_f32 v64, v64, v184
  v_sub_f32 v65, v65, v184
  v_sub_f32 v66, v66, v184
  v_sub_f32 v67, v67, v184
  v_sub_f32 v68, v68, v184
  v_sub_f32 v69, v69, v184
  v_sub_f32 v70, v70, v184
  v_sub_f32 v71, v71, v184
  v_sub_f32 v72, v72, v184
  v_sub_f32 v73, v73, v184
  v_sub_f32 v74, v74, v184
  v_sub_f32 v75, v75, v184
  v_sub_f32 v76, v76, v184
  v_sub_f32 v77, v77, v184
  v_sub_f32 v78, v78, v184
  v_sub_f32 v79, v79, v184
  v_exp_f32 v64, v64
  v_exp_f32 v65, v65
  v_exp_f32 v66, v66
  v_exp_f32 v67, v67
  v_exp_f32 v68, v68
  v_exp_f32 v69, v69
  v_exp_f32 v70, v70
  v_exp_f32 v71, v71
  v_exp_f32 v72, v72
  v_exp_f32 v73, v73
  v_exp_f32 v74, v74
  v_exp_f32 v75, v75
  v_exp_f32 v76, v76
  v_exp_f32 v77, v77
  v_exp_f32 v78, v78
  v_exp_f32 v79, v79
  v_cvt_pk_bf16_f32 v20, v64, v65
  v_cvt_pk_bf16_f32 v21, v68, v69
  v_cvt_pk_bf16_f32 v22, v72, v73
  v_cvt_pk_bf16_f32 v23, v76, v77
  v_cvt_pk_bf16_f32 v24, v66, v67
  v_cvt_pk_bf16_f32 v25, v70, v71
  v_cvt_pk_bf16_f32 v26, v74, v75
  v_cvt_pk_bf16_f32 v27, v78, v79
  v_mfma_f32_32x32x16_bf16 v[224:239], v[160:163], v[20:23], 0
  v_add_f32 v186, v64, v65
  v_add_f32 v186, v186, v66
  v_add_f32 v186, v186, v67
  v_add_f32 v186, v186, v68
  v_add_f32 v186, v186, v69
  v_add_f32 v186, v186, v70
  v_add_f32 v186, v186, v71
  v_mfma_f32_32x32x16_bf16 v[224:239], v[164:167], v[24:27], v[224:239]
  v_add_f32 v186, v186, v72
  v_add_f32 v186, v186, v73
  v_add_f32 v186, v186, v74
  v_add_f32 v186, v186, v75
  v_add_f32 v186, v186, v76
  v_add_f32 v186, v186, v77
  v_add_f32 v186, v186, v78
  v_add_f32 v186, v186, v79
AT_l0:
  s_cmp_eq_u32 s69, 1
  s_cbranch_scc1 AT_v0
  s_cmp_ge_u32 s74, 62
  s_cbranch_scc1 AT_k0
  s_branch AT_c0
AT_h0:
  s_sleep 2
AT_c0:
  buffer_load_dword v172, off, s[8:11], s70 sc1
  s_add_u32 s65, s65, 1
  s_cmp_lt_u32 s65, 131072
  s_cselect_b32 s54, -2, -1
  s_waitcnt vmcnt(0)
  v_cmp_lt_u32 vcc, s54, v172
  s_cbranch_vccnz AT_h0
AT_k0:
  buffer_load_dwordx4 v[172:175], v201, s[8:11], s73 offen sc1
AT_v0:
  s_mov_b32 s69, 0
  s_add_u32 s65, s65, 1
  s_cmp_lt_u32 s65, 131072
  s_cselect_b32 s54, -2, -1
  s_waitcnt vmcnt(0)
  ds_write_b64 v220, v[172:173] offset:0
  ds_write_b64 v221, v[174:175] offset:0
  v_max3_u32 v213, v172, v173, v174
  v_max_u32 v213, v213, v175
  v_cmp_lt_u32 vcc, s54, v213
  s_cbranch_vccnz AT_k0
  s_waitcnt lgkmcnt(0)
  s_barrier
  ds_read_b128 v[128:131], v218 offset:0
  ds_read_b128 v[132:135], v218 offset:256
  ds_read_b128 v[136:139], v218 offset:512
  ds_read_b128 v[140:143], v218 offset:768
  ds_read_b128 v[144:147], v218 offset:1024
  ds_read_b128 v[148:151], v218 offset:1280
  ds_read_b128 v[152:155], v218 offset:1536
  ds_read_b128 v[156:159], v218 offset:1792
  ds_read_b32 v168, v219 offset:0
  ds_read_b32 v169, v219 offset:128
  s_waitcnt lgkmcnt(9)
  v_mfma_f32_32x32x16_bf16 v[80:95], v[128:131], v[96:99], 0
  s_waitcnt lgkmcnt(8)
  v_mfma_f32_32x32x16_bf16 v[80:95], v[132:135], v[100:103], v[80:95]
  s_waitcnt lgkmcnt(7)
  v_mfma_f32_32x32x16_bf16 v[80:95], v[136:139], v[104:107], v[80:95]
  s_waitcnt lgkmcnt(6)
  v_mfma_f32_32x32x16_bf16 v[80:95], v[140:143], v[108:111], v[80:95]
  s_waitcnt lgkmcnt(5)
  v_mfma_f32_32x32x16_bf16 v[80:95], v[144:147], v[112:115], v[80:95]
  s_waitcnt lgkmcnt(4)
  v_mfma_f32_32x32x16_bf16 v[80:95], v[148:151], v[116:119], v[80:95]
  s_waitcnt lgkmcnt(3)
  v_mfma_f32_32x32x16_bf16 v[80:95], v[152:155], v[120:123], v[80:95]
  s_waitcnt lgkmcnt(2)
  v_mfma_f32_32x32x16_bf16 v[80:95], v[156:159], v[124:127], v[80:95]
  s_add_u32 s74, s74, 2
  v_mov_b32 v212, s74
  s_nop 9
  v_mul_f32 v80, s68, v80
  v_mul_f32 v81, s68, v81
  v_mul_f32 v82, s68, v82
  v_mul_f32 v83, s68, v83
  v_max3_f32 v84, v180, v80, v81
  v_max3_f32 v84, v84, v82, v83
  v_mov_b32 v85, v84
  s_nop 1
  v_permlane32_swap_b32 v84, v85
  v_max_f32 v84, v84, v85
  v_sub_f32 v86, v180, v84
  v_sub_f32 v80, v80, v84
  v_sub_f32 v81, v81, v84
  v_sub_f32 v82, v82, v84
  v_sub_f32 v83, v83, v84
  v_exp_f32 v86, v86
  v_exp_f32 v80, v80
  v_exp_f32 v81, v81
  v_exp_f32 v82, v82
  v_exp_f32 v83, v83
  v_fma_f32 v182, v182, v86, v80
  v_add_f32 v84, v81, v82
  v_add_f32 v182, v182, v83
  v_add_f32 v182, v182, v84
  v_mov_b32 v183, v182
  s_nop 1
  v_permlane32_swap_b32 v182, v183
  v_add_f32 v182, v182, v183
  v_rcp_f32 v182, v182
  s_nop 0
  v_mul_f32 v86, v86, v182
  v_mul_f32 v80, v182, v80
  v_mul_f32 v81, v182, v81
  v_mul_f32 v82, v182, v82
  v_mul_f32 v83, v182, v83
  v_cvt_pk_bf16_f32 v28, v80, v81
  v_cvt_pk_bf16_f32 v29, v82, v83
  v_mul_f32 v0, v86, v0
  v_mul_f32 v1, v86, v1
  v_mul_f32 v2, v86, v2
  v_mul_f32 v3, v86, v3
  v_mul_f32 v4, v86, v4
  v_mul_f32 v5, v86, v5
  v_mul_f32 v6, v86, v6
  v_mul_f32 v7, v86, v7
  v_mul_f32 v8, v86, v8
  v_mul_f32 v9, v86, v9
  v_mul_f32 v10, v86, v10
  v_mul_f32 v11, v86, v11
  v_mul_f32 v12, v86, v12
  v_mul_f32 v13, v86, v13
  v_mul_f32 v14, v86, v14
  v_mul_f32 v15, v86, v15
  s_waitcnt lgkmcnt(0)
  s_nop 0
  v_mfma_f32_32x32x8_bf16 v[0:15], v[168:169], v[28:29], v[0:15]
  s_nop 11
  v_cvt_pk_bf16_f32 v20, v0, v1
  v_cvt_pk_bf16_f32 v21, v2, v3
  v_cvt_pk_bf16_f32 v22, v4, v5
  v_cvt_pk_bf16_f32 v23, v6, v7
  buffer_store_dwordx4 v[20:23], v201, s[8:11], s72 offen offset:0 sc1
  v_cvt_pk_bf16_f32 v24, v8, v9
  v_cvt_pk_bf16_f32 v25, v10, v11
  v_cvt_pk_bf16_f32 v26, v12, v13
  v_cvt_pk_bf16_f32 v27, v14, v15
  buffer_store_dwordx4 v[24:27], v201, s[8:11], s72 offen offset:1024 sc1
  s_mov_b64 exec, 1
  buffer_store_dword v212, v201, s[8:11], s71 offen sc1
  s_mov_b64 exec, -1
  s_cmp_ge_u32 s74, 64
  s_cbranch_scc1 L_exit
  s_cmp_ge_u32 s59, 64
  s_cbranch_scc1 AT_l1
  s_mov_b32 s74, s59
  s_mul_i32 s66, s59, 655360
  s_lshl_b32 s55, s58, 14
  s_add_u32 s55, s55, s66
  s_add_u32 s55, s55, 1048576
  s_lshl_b32 s73, s58, 2
  s_add_u32 s73, s73, s52
  s_lshl_b32 s72, s59, 7
  s_add_u32 s72, s72, s73
  s_lshl_b32 s72, s72, 11
  s_add_u32 s72, s72, 46137344
  s_lshl_b32 s73, s73, 10
  s_add_u32 s73, s73, s66
  s_add_u32 s73, s73, 1572864
  s_add_u32 s59, s59, 2
  buffer_load_dwordx4 v[128:131], v216, s[8:11], s55 offen offset:0 sc1
  buffer_load_dwordx4 v[132:135], v216, s[8:11], s55 offen offset:256 sc1
  buffer_load_dwordx4 v[136:139], v216, s[8:11], s55 offen offset:512 sc1
  buffer_load_dwordx4 v[140:143], v216, s[8:11], s55 offen offset:768 sc1
  buffer_load_dwordx4 v[144:147], v216, s[8:11], s55 offen offset:1024 sc1
  buffer_load_dwordx4 v[148:151], v216, s[8:11], s55 offen offset:1280 sc1
  buffer_load_dwordx4 v[152:155], v216, s[8:11], s55 offen offset:1536 sc1
  buffer_load_dwordx4 v[156:159], v216, s[8:11], s55 offen offset:1792 sc1
  buffer_load_dwordx4 v[160:163], v217, s[8:11], s55 offen offset:0 sc1
  buffer_load_dwordx4 v[164:167], v217, s[8:11], s55 offen offset:256 sc1
  s_or_b32 s70, s76, 0xc00
  buffer_load_dword v172, off, s[8:11], s70 sc1
  s_add_u32 s60, s60, 73728
  ds_read_b128 v[32:35], v203 offset:0
  ds_read_b128 v[36:39], v204 offset:0
  ds_read_b128 v[40:43], v205 offset:0
  s_waitcnt lgkmcnt(2)
  v_mfma_f32_32x32x16_bf16 v[240:255], a[0:3], v[32:35], 0
  ds_read_b128 v[44:47], v206 offset:0
  s_add_u32 m0, s67, 36864
  s_nop 0
  buffer_load_dwordx4 v202, s[4:7], s60 offen offset:0 lds
  s_waitcnt lgkmcnt(2)
  v_mfma_f32_32x32x16_bf16 v[240:255], a[4:7], v[36:39], v[240:255]
  ds_read_b128 v[32:35], v203 offset:1024
  s_waitcnt lgkmcnt(2)
  v_mfma_f32_32x32x16_bf16 v[240:255], a[8:11], v[40:43], v[240:255]
  ds_read_b128 v[36:39], v204 offset:1024
  s_add_u32 m0, s67, 37760
  s_nop 0
  buffer_load_dwordx4 v202, s[4:7], s60 offen offset:128 lds
  s_waitcnt lgkmcnt(2)
  v_mfma_f32_32x32x16_bf16 v[240:255], a[12:15], v[44:47], v[240:255]
  ds_read_b128 v[40:43], v205 offset:1024
  s_waitcnt lgkmcnt(2)
  v_mfma_f32_32x32x16_bf16 v[240:255], a[16:19], v[32:35], v[240:255]
  ds_read_b128 v[44:47], v206 offset:1024
  s_add_u32 m0, s67, 38656
  s_nop 0
  buffer_load_dwordx4 v202, s[4:7], s60 offen offset:256 lds
  s_waitcnt lgkmcnt(2)
  v_mfma_f32_32x32x16_bf16 v[240:255], a[20:23], v[36:39], v[240:255]
  ds_read_b128 v[32:35], v203 offset:2048
  s_waitcnt lgkmcnt(2)
  v_mfma_f32_32x32x16_bf16 v[240:255], a[24:27], v[40:43], v[240:255]
  ds_read_b128 v[36:39], v204 offset:2048
  s_add_u32 m0, s67, 39552
  s_nop 0
  buffer_load_dwordx4 v202, s[4:7], s60 offen offset:384 lds
  s_waitcnt lgkmcnt(2)
  v_mfma_f32_32x32x16_bf16 v[240:255], a[28:31], v[44:47], v[240:255]
  ds_read_b128 v[40:43], v205 offset:2048
  s_waitcnt lgkmcnt(2)
  v_mfma_f32_32x32x16_bf16 v[240:255], a[32:35], v[32:35], v[240:255]
  ds_read_b128 v[44:47], v206 offset:2048
  s_add_u32 m0, s67, 40448
  s_nop 0
  buffer_load_dwordx4 v202, s[4:7], s60 offen offset:512 lds
  s_waitcnt lgkmcnt(2)
  v_mfma_f32_32x32x16_bf16 v[240:255], a[36:39], v[36:39], v[240:255]
  ds_read_b128 v[32:35], v203 offset:3072
  s_waitcnt lgkmcnt(2)
  v_mfma_f32_32x32x16_bf16 v[240:255], a[40:43], v[40:43], v[240:255]
  ds_read_b128 v[36:39], v204 offset:3072
  s_add_u32 m0, s67, 41344
  s_nop 0
  buffer_load_dwordx4 v202, s[4:7], s60 offen offset:640 lds
  s_waitcnt lgkmcnt(2)
  v_mfma_f32_32x32x16_bf16 v[240:255], a[44:47], v[44:47], v[240:255]
  ds_read_b128 v[40:43], v205 offset:3072
  s_waitcnt lgkmcnt(2)
  v_mfma_f32_32x32x16_bf16 v[240:255], a[48:51], v[32:35], v[240:255]
  ds_read_b128 v[44:47], v206 offset:3072
  s_add_u32 m0, s67, 42240
  s_nop 0
  buffer_load_dwordx4 v202, s[4:7], s60 offen offset:768 lds
  s_waitcnt lgkmcnt(2)
  v_mfma_f32_32x32x16_bf16 v[240:255], a[52:55], v[36:39], v[240:255]
  ds_read_b128 v[32:35], v203 offset:4096
  s_waitcnt lgkmcnt(2)
  v_mfma_f32_32x32x16_bf16 v[240:255], a[56:59], v[40:43], v[240:255]
  ds_read_b128 v[36:39], v204 offset:4096
  s_add_u32 m0, s67, 43136
  s_nop 0
  buffer_load_dwordx4 v202, s[4:7], s60 offen offset:896 lds
  s_waitcnt lgkmcnt(2)
  v_mfma_f32_32x32x16_bf16 v[240:255], a[60:63], v[44:47], v[240:255]
  ds_read_b128 v[40:43], v205 offset:4096
  s_waitcnt lgkmcnt(2)
  v_mfma_f32_32x32x16_bf16 v[240:255], a[64:67], v[32:35], v[240:255]
  ds_read_b128 v[44:47], v206 offset:4096
  s_add_u32 m0, s67, 44032
  s_nop 0
  buffer_load_dwordx4 v202, s[4:7], s60 offen offset:1024 lds
  s_waitcnt lgkmcnt(2)
  v_mfma_f32_32x32x16_bf16 v[240:255], a[68:71], v[36:39], v[240:255]
  ds_read_b128 v[32:35], v203 offset:5120
  s_waitcnt lgkmcnt(2)
  v_mfma_f32_32x32x16_bf16 v[240:255], a[72:75], v[40:43], v[240:255]
  ds_read_b128 v[36:39], v204 offset:5120
  buffer_store_dwordx4 v[176:179], v201, s[8:11], s72 offen offset:0 sc1
  s_waitcnt lgkmcnt(2)
  v_mfma_f32_32x32x16_bf16 v[240:255], a[76:79], v[44:47], v[240:255]
  ds_read_b128 v[40:43], v205 offset:5120
  s_waitcnt lgkmcnt(2)
  v_mfma_f32_32x32x16_bf16 v[240:255], a[80:83], v[32:35], v[240:255]
  ds_read_b128 v[44:47], v206 offset:5120
  buffer_store_dwordx4 v[176:179], v201, s[8:11], s72 offen offset:1024 sc1
  s_waitcnt lgkmcnt(2)
  v_mfma_f32_32x32x16_bf16 v[240:255], a[84:87], v[36:39], v[240:255]
  ds_read_b128 v[32:35], v203 offset:6144
  s_waitcnt lgkmcnt(2)
  v_mfma_f32_32x32x16_bf16 v[240:255], a[88:91], v[40:43], v[240:255]
  ds_read_b128 v[36:39], v204 offset:6144
  s_waitcnt lgkmcnt(2)
  v_mfma_f32_32x32x16_bf16 v[240:255], a[92:95], v[44:47], v[240:255]
  ds_read_b128 v[40:43], v205 offset:6144
  s_waitcnt lgkmcnt(2)
  v_mfma_f32_32x32x16_bf16 v[240:255], a[96:99], v[32:35], v[240:255]
  ds_read_b128 v[44:47], v206 offset:6144
  s_waitcnt lgkmcnt(2)
  v_mfma_f32_32x32x16_bf16 v[240:255], a[100:103], v[36:39], v[240:255]
  ds_read_b128 v[32:35], v203 offset:7168
  s_waitcnt lgkmcnt(2)
  v_mfma_f32_32x32x16_bf16 v[240:255], a[104:107], v[40:43], v[240:255]
  ds_read_b128 v[36:39], v204 offset:7168
  s_waitcnt lgkmcnt(2)
  v_mfma_f32_32x32x16_bf16 v[240:255], a[108:111], v[44:47], v[240:255]
  ds_read_b128 v[40:43], v205 offset:7168
  s_waitcnt lgkmcnt(2)
  v_mfma_f32_32x32x16_bf16 v[240:255], a[112:115], v[32:35], v[240:255]
  ds_read_b128 v[44:47], v206 offset:7168
  s_waitcnt lgkmcnt(2)
  v_mfma_f32_32x32x16_bf16 v[240:255], a[116:119], v[36:39], v[240:255]
  ds_read_b128 v[32:35], v203 offset:8192
  s_waitcnt lgkmcnt(2)
  v_mfma_f32_32x32x16_bf16 v[240:255], a[120:123], v[40:43], v[240:255]
  ds_read_b128 v[36:39], v204 offset:8192
  s_waitcnt lgkmcnt(2)
  v_mfma_f32_32x32x16_bf16 v[240:255], a[124:127], v[44:47], v[240:255]
  ds_read_b128 v[40:43], v205 offset:8192
  s_waitcnt lgkmcnt(2)
  v_mfma_f32_32x32x16_bf16 v[240:255], a[128:131], v[32:35], v[240:255]
  ds_read_b128 v[44:47], v206 offset:8192
  s_waitcnt lgkmcnt(2)
  v_mfma_f32_32x32x16_bf16 v[240:255], a[132:135], v[36:39], v[240:255]
  s_waitcnt lgkmcnt(1)
  v_mfma_f32_32x32x16_bf16 v[240:255], a[136:139], v[40:43], v[240:255]
  s_waitcnt lgkmcnt(0)
  v_mfma_f32_32x32x16_bf16 v[240:255], a[140:143], v[44:47], v[240:255]
  s_nop 11
  v_cvt_pk_bf16_f32 v16, v240, v244
  v_cvt_pk_bf16_f32 v17, v241, v245
  v_cvt_pk_bf16_f32 v18, v242, v246
  v_cvt_pk_bf16_f32 v19, v243, v247
  ds_write_b128 v215, v[16:19] offset:0
  v_cvt_pk_bf16_f32 v20, v248, v252
  v_cvt_pk_bf16_f32 v21, v249, v253
  v_cvt_pk_bf16_f32 v22, v250, v254
  v_cvt_pk_bf16_f32 v23, v251, v255
  ds_write_b128 v215, v[20:23] offset:1024
  s_waitcnt lgkmcnt(0)
  s_barrier
  ds_read_b128 v[96:99], v208 offset:0
  ds_read_b128 v[100:103], v208 offset:1024
  ds_read_b128 v[104:107], v208 offset:2048
  ds_read_b128 v[108:111], v208 offset:3072
  ds_read_b128 v[112:115], v208 offset:4096
  ds_read_b128 v[116:119], v208 offset:5120
  ds_read_b128 v[120:123], v208 offset:6144
  ds_read_b128 v[124:127], v208 offset:7168
  s_waitcnt vmcnt(11)
  v_cmp_eq_u32 vcc, -1, v172
  s_mov_b32 s69, 0
  s_cbranch_vccnz AT_e0
  s_mov_b32 s69, 1
  buffer_load_dwordx4 v[172:175], v201, s[8:11], s76 offen sc1
AT_e0:
  s_waitcnt lgkmcnt(7)
  v_mfma_f32_32x32x16_bf16 v[64:79], v[128:131], v[96:99], v[48:63]
  s_waitcnt lgkmcnt(6)
  v_mfma_f32_32x32x16_bf16 v[64:79], v[132:135], v[100:103], v[64:79]
  s_waitcnt lgkmcnt(5)
  v_mfma_f32_32x32x16_bf16 v[64:79], v[136:139], v[104:107], v[64:79]
  s_waitcnt lgkmcnt(4)
  v_mfma_f32_32x32x16_bf16 v[64:79], v[140:143], v[108:111], v[64:79]
  s_waitcnt lgkmcnt(3)
  v_mfma_f32_32x32x16_bf16 v[64:79], v[144:147], v[112:115], v[64:79]
  s_waitcnt lgkmcnt(2)
  v_mfma_f32_32x32x16_bf16 v[64:79], v[148:151], v[116:119], v[64:79]
  s_waitcnt lgkmcnt(1)
  v_mfma_f32_32x32x16_bf16 v[64:79], v[152:155], v[120:123], v[64:79]
  s_waitcnt lgkmcnt(0)
  v_mfma_f32_32x32x16_bf16 v[64:79], v[156:159], v[124:127], v[64:79]
  s_nop 11
  v_max3_f32 v180, v64, v65, v66
  v_max3_f32 v180, v180, v67, v68
  v_max3_f32 v180, v180, v69, v70
  v_max3_f32 v180, v180, v71, v72
  v_max3_f32 v180, v180, v73, v74
  v_max3_f32 v180, v180, v75, v76
  v_max3_f32 v180, v180, v77, v78
  v_max_f32 v180, v180, v79
  v_mov_b32 v181, v180
  s_nop 1
  v_permlane32_swap_b32 v180, v181
  v_max_f32 v180, v180, v181
  v_sub_f32 v64, v64, v180
  v_sub_f32 v65, v65, v180
  v_sub_f32 v66, v66, v180
  v_sub_f32 v67, v67, v180
  v_sub_f32 v68, v68, v180
  v_sub_f32 v69, v69, v180
  v_sub_f32 v70, v70, v180
  v_sub_f32 v71, v71, v180
  v_sub_f32 v72, v72, v180
  v_sub_f32 v73, v73, v180
  v_sub_f32 v74, v74, v180
  v_sub_f32 v75, v75, v180
  v_sub_f32 v76, v76, v180
  v_sub_f32 v77, v77, v180
  v_sub_f32 v78, v78, v180
  v_sub_f32 v79, v79, v180
  v_exp_f32 v64, v64
  v_exp_f32 v65, v65
  v_exp_f32 v66, v66
  v_exp_f32 v67, v67
  v_exp_f32 v68, v68
  v_exp_f32 v69, v69
  v_exp_f32 v70, v70
  v_exp_f32 v71, v71
  v_exp_f32 v72, v72
  v_exp_f32 v73, v73
  v_exp_f32 v74, v74
  v_exp_f32 v75, v75
  v_exp_f32 v76, v76
  v_exp_f32 v77, v77
  v_exp_f32 v78, v78
  v_exp_f32 v79, v79
  v_cvt_pk_bf16_f32 v20, v64, v65
  v_cvt_pk_bf16_f32 v21, v68, v69
  v_cvt_pk_bf16_f32 v22, v72, v73
  v_cvt_pk_bf16_f32 v23, v76, v77
  v_cvt_pk_bf16_f32 v24, v66, v67
  v_cvt_pk_bf16_f32 v25, v70, v71
  v_cvt_pk_bf16_f32 v26, v74, v75
  v_cvt_pk_bf16_f32 v27, v78, v79
  v_mfma_f32_32x32x16_bf16 v[0:15], v[160:163], v[20:23], 0
  v_add_f32 v182, v64, v65
  v_add_f32 v182, v182, v66
  v_add_f32 v182, v182, v67
  v_add_f32 v182, v182, v68
  v_add_f32 v182, v182, v69
  v_add_f32 v182, v182, v70
  v_add_f32 v182, v182, v71
  v_mfma_f32_32x32x16_bf16 v[0:15], v[164:167], v[24:27], v[0:15]
  v_add_f32 v182, v182, v72
  v_add_f32 v182, v182, v73
  v_add_f32 v182, v182, v74
  v_add_f32 v182, v182, v75
  v_add_f32 v182, v182, v76
  v_add_f32 v182, v182, v77
  v_add_f32 v182, v182, v78
  v_add_f32 v182, v182, v79
AT_l1:
  s_cmp_eq_u32 s69, 1
  s_cbranch_scc1 AT_v1
  s_cmp_ge_u32 s77, 62
  s_cbranch_scc1 AT_k1
  s_branch AT_c1
AT_h1:
  s_sleep 2
AT_c1:
  buffer_load_dword v172, off, s[8:11], s70 sc1
  s_add_u32 s65, s65, 1
  s_cmp_lt_u32 s65, 131072
  s_cselect_b32 s54, -2, -1
  s_waitcnt vmcnt(0)
  v_cmp_lt_u32 vcc, s54, v172
  s_cbranch_vccnz AT_h1
AT_k1:
  buffer_load_dwordx4 v[172:175], v201, s[8:11], s76 offen sc1
AT_v1:
  s_mov_b32 s69, 0
  s_add_u32 s65, s65, 1
  s_cmp_lt_u32 s65, 131072
  s_cselect_b32 s54, -2, -1
  s_waitcnt vmcnt(0)
  ds_write_b64 v220, v[172:173] offset:4096
  ds_write_b64 v221, v[174:175] offset:4096
  v_max3_u32 v213, v172, v173, v174
  v_max_u32 v213, v213, v175
  v_cmp_lt_u32 vcc, s54, v213
  s_cbranch_vccnz AT_k1
  s_waitcnt lgkmcnt(0)
  s_barrier
  ds_read_b128 v[128:131], v218 offset:4096
  ds_read_b128 v[132:135], v218 offset:4352
  ds_read_b128 v[136:139], v218 offset:4608
  ds_read_b128 v[140:143], v218 offset:4864
  ds_read_b128 v[144:147], v218 offset:5120
  ds_read_b128 v[148:151], v218 offset:5376
  ds_read_b128 v[152:155], v218 offset:5632
  ds_read_b128 v[156:159], v218 offset:5888
  ds_read_b32 v168, v219 offset:4096
  ds_read_b32 v169, v219 offset:4224
  s_waitcnt lgkmcnt(9)
  v_mfma_f32_32x32x16_bf16 v[80:95], v[128:131], a[144:147], 0
  s_waitcnt lgkmcnt(8)
  v_mfma_f32_32x32x16_bf16 v[80:95], v[132:135], a[148:151], v[80:95]
  s_waitcnt lgkmcnt(7)
  v_mfma_f32_32x32x16_bf16 v[80:95], v[136:139], a[152:155], v[80:95]
  s_waitcnt lgkmcnt(6)
  v_mfma_f32_32x32x16_bf16 v[80:95], v[140:143], a[156:159], v[80:95]
  s_waitcnt lgkmcnt(5)
  v_mfma_f32_32x32x16_bf16 v[80:95], v[144:147], a[160:163], v[80:95]
  s_waitcnt lgkmcnt(4)
  v_mfma_f32_32x32x16_bf16 v[80:95], v[148:151], a[164:167], v[80:95]
  s_waitcnt lgkmcnt(3)
  v_mfma_f32_32x32x16_bf16 v[80:95], v[152:155], a[168:171], v[80:95]
  s_waitcnt lgkmcnt(2)
  v_mfma_f32_32x32x16_bf16 v[80:95], v[156:159], a[172:175], v[80:95]
  s_add_u32 s77, s77, 2
  v_mov_b32 v212, s77
  s_nop 9
  v_mul_f32 v80, s68, v80
  v_mul_f32 v81, s68, v81
  v_mul_f32 v82, s68, v82
  v_mul_f32 v83, s68, v83
  v_max3_f32 v84, v184, v80, v81
  v_max3_f32 v84, v84, v82, v83
  v_mov_b32 v85, v84
  s_nop 1
  v_permlane32_swap_b32 v84, v85
  v_max_f32 v84, v84, v85
  v_sub_f32 v86, v184, v84
  v_sub_f32 v80, v80, v84
  v_sub_f32 v81, v81, v84
  v_sub_f32 v82, v82, v84
  v_sub_f32 v83, v83, v84
  v_exp_f32 v86, v86
  v_exp_f32 v80, v80
  v_exp_f32 v81, v81
  v_exp_f32 v82, v82
  v_exp_f32 v83, v83
  v_fma_f32 v186, v186, v86, v80
  v_add_f32 v84, v81, v82
  v_add_f32 v186, v186, v83
  v_add_f32 v186, v186, v84
  v_mov_b32 v187, v186
  s_nop 1
  v_permlane32_swap_b32 v186, v187
  v_add_f32 v186, v186, v187
  v_rcp_f32 v186, v186
  s_nop 0
  v_mul_f32 v86, v86, v186
  v_mul_f32 v80, v186, v80
  v_mul_f32 v81, v186, v81
  v_mul_f32 v82, v186, v82
  v_mul_f32 v83, v186, v83
  v_cvt_pk_bf16_f32 v28, v80, v81
  v_cvt_pk_bf16_f32 v29, v82, v83
  v_mul_f32 v224, v86, v224
  v_mul_f32 v225, v86, v225
  v_mul_f32 v226, v86, v226
  v_mul_f32 v227, v86, v227
  v_mul_f32 v228, v86, v228
  v_mul_f32 v229, v86, v229
  v_mul_f32 v230, v86, v230
  v_mul_f32 v231, v86, v231
  v_mul_f32 v232, v86, v232
  v_mul_f32 v233, v86, v233
  v_mul_f32 v234, v86, v234
  v_mul_f32 v235, v86, v235
  v_mul_f32 v236, v86, v236
  v_mul_f32 v237, v86, v237
  v_mul_f32 v238, v86, v238
  v_mul_f32 v239, v86, v239
  s_waitcnt lgkmcnt(0)
  s_nop 0
  v_mfma_f32_32x32x8_bf16 v[224:239], v[168:169], v[28:29], v[224:239]
  s_nop 11
  v_cvt_pk_bf16_f32 v20, v224, v225
  v_cvt_pk_bf16_f32 v21, v226, v227
  v_cvt_pk_bf16_f32 v22, v228, v229
  v_cvt_pk_bf16_f32 v23, v230, v231
  buffer_store_dwordx4 v[20:23], v201, s[8:11], s75 offen offset:0 sc1
  v_cvt_pk_bf16_f32 v24, v232, v233
  v_cvt_pk_bf16_f32 v25, v234, v235
  v_cvt_pk_bf16_f32 v26, v236, v237
  v_cvt_pk_bf16_f32 v27, v238, v239
  buffer_store_dwordx4 v[24:27], v201, s[8:11], s75 offen offset:1024 sc1
  s_mov_b64 exec, 1
  buffer_store_dword v212, v201, s[8:11], s71 offen sc1
  s_mov_b64 exec, -1
  s_cmp_ge_u32 s77, 64
  s_cbranch_scc1 L_exit
  s_branch AT_loop
L_cexit:
L_exit:
L_end:
s_endpgm
.section .rodata,"a"
.p2align 6
.amdhsa_kernel gated_mix__sliding_local_dilated__memory_aug_recurrent_mem_tr__prompt_kernel
  .amdhsa_next_free_vgpr 512
  .amdhsa_next_free_sgpr 102
  .amdhsa_accum_offset 256
  .amdhsa_group_segment_fixed_size 0
  .amdhsa_kernarg_size 112
  .amdhsa_user_sgpr_count 2
  .amdhsa_user_sgpr_kernarg_segment_ptr 1
  .amdhsa_system_sgpr_workgroup_id_x 1
.end_amdhsa_kernel
```

```asm
; @launch grid=(256,1,1) block=(256,1,1) lds=163840
.amdgcn_target "amdgcn-amd-amdhsa--gfx950"
.text
.globl gated_mix__sliding_local_dilated__memory_aug_recurrent_mem_tr__prompt_kernel
.p2align 8
.type gated_mix__sliding_local_dilated__memory_aug_recurrent_mem_tr__prompt_kernel,@function
gated_mix__sliding_local_dilated__memory_aug_recurrent_mem_tr__prompt_kernel:
  s_cmp_ge_u32 s2, 256
  s_cbranch_scc1 L_end
  s_load_dwordx2 s[4:5], s[0:1], 0
  s_load_dwordx2 s[8:9], s[0:1], 104
  s_load_dwordx2 s[12:13], s[0:1], 96
  s_load_dwordx2 s[16:17], s[0:1], 40
  s_load_dwordx2 s[20:21], s[0:1], 48
  s_load_dwordx2 s[24:25], s[0:1], 56
  s_load_dwordx2 s[28:29], s[0:1], 64
  s_load_dwordx2 s[32:33], s[0:1], 32
  s_load_dwordx2 s[36:37], s[0:1], 8
  s_load_dwordx2 s[40:41], s[0:1], 16
  s_load_dwordx2 s[44:45], s[0:1], 80
  s_load_dwordx2 s[48:49], s[0:1], 88
  s_getreg_b32 s54, hwreg(HW_REG_XCC_ID, 0, 3)
  v_lshrrev_b32 v1, 6, v0
  s_nop 0
  v_readfirstlane_b32 s52, v1
  s_mov_b32 s6, 2359296
  s_mov_b32 s7, 0x20000
  s_mov_b32 s10, 268435456
  s_mov_b32 s11, 0x20000
  s_mov_b32 s14, 256
  s_mov_b32 s15, 0x20000
  s_mov_b32 s18, 4718592
  s_mov_b32 s19, 0x20000
  s_mov_b32 s22, 4718592
  s_mov_b32 s23, 0x20000
  s_mov_b32 s26, 4718592
  s_mov_b32 s27, 0x20000
  s_mov_b32 s30, 4718592
  s_mov_b32 s31, 0x20000
  s_mov_b32 s34, 9216
  s_mov_b32 s35, 0x20000
  s_mov_b32 s38, 1990656
  s_mov_b32 s39, 0x20000
  s_mov_b32 s42, 663552
  s_mov_b32 s43, 0x20000
  s_mov_b32 s46, 1152
  s_mov_b32 s47, 0x20000
  s_mov_b32 s50, 2359296
  s_mov_b32 s51, 0x20000
  s_waitcnt lgkmcnt(0)
  s_lshr_b32 s0, s2, 3
  s_mov_b32 s2, s54
  s_mov_b32 s1, 0
  s_lshl_b32 s55, s2, 2
  s_cmp_eq_u32 s52, 0
  s_cselect_b32 s55, s55, 0x1000
  s_lshl_b32 s56, 1, s0
  v_mov_b32 v1, 0
  v_mov_b32 v35, s56
  s_mov_b64 exec, 1
  buffer_atomic_or v35, v1, s[12:15], s55 offen sc0
  s_mov_b64 exec, -1
L_role:
  s_mov_b32 s53, s0
  s_cmp_eq_u32 s2, 0
  s_cbranch_scc0 L_worker
  v_and_b32 v0, 63, v0
  v_and_b32 v1, 15, v0
  v_lshrrev_b32 v2, 4, v0
  v_and_b32 v3, 1, v2
  s_lshl_b32 s54, s52, 1
  v_add_u32 v3, s54, v3
  v_lshlrev_b32 v3, 1, v3
  v_xor_b32 v3, v3, v1
  v_lshlrev_b32 v3, 4, v3
  v_lshl_add_u32 v8, v2, 13, v3
  s_lshl_b32 s78, s53, 8
  s_lshl_b32 s54, s52, 15
  s_add_u32 s78, s78, s54
  s_mul_i32 s79, s53, 147456
  s_lshl_b32 s57, s52, 10
  s_add_u32 s57, s57, 16384
  s_getpc_b64 s[80:81]
L_pc_1:
  s_and_b32 s55, s0, 1
  s_lshl_b32 s55, s55, 2
  s_add_u32 s55, s55, s52
  s_lshl_b32 s55, s55, 10
  v_and_b32 v199, 63, v0
  v_lshl_add_u32 v199, v199, 4, s55
  v_min_u32 v199, (L_w0 - L_pc_1), v199
  global_load_dword v196, v199, s[80:81]
  s_add_u32 m0, s57, 0
  s_add_u32 s54, s78, 0
  buffer_load_dwordx4 v8, s[16:19], s54 offen  lds
  s_add_u32 m0, s57, 4096
  s_add_u32 s54, s78, 131072
  buffer_load_dwordx4 v8, s[16:19], s54 offen  lds
  s_add_u32 m0, s57, 8192
  s_add_u32 s54, s78, 262144
  buffer_load_dwordx4 v8, s[16:19], s54 offen  lds
  s_add_u32 m0, s57, 12288
  s_add_u32 s54, s78, 393216
  buffer_load_dwordx4 v8, s[16:19], s54 offen  lds
  s_add_u32 m0, s57, 16384
  s_add_u32 s54, s78, 524288
  buffer_load_dwordx4 v8, s[16:19], s54 offen  lds
  s_add_u32 m0, s57, 20480
  s_add_u32 s54, s78, 655360
  buffer_load_dwordx4 v8, s[16:19], s54 offen  lds
  s_add_u32 m0, s57, 24576
  s_add_u32 s54, s78, 786432
  buffer_load_dwordx4 v8, s[16:19], s54 offen  lds
  s_add_u32 m0, s57, 28672
  s_add_u32 s54, s78, 917504
  buffer_load_dwordx4 v8, s[16:19], s54 offen  lds
  s_add_u32 m0, s57, 32768
  s_add_u32 s54, s78, 1048576
  buffer_load_dwordx4 v8, s[16:19], s54 offen  lds
  s_add_u32 m0, s57, 36864
  s_add_u32 s54, s78, 1179648
  buffer_load_dwordx4 v8, s[16:19], s54 offen  lds
  s_add_u32 m0, s57, 40960
  s_add_u32 s54, s78, 1310720
  buffer_load_dwordx4 v8, s[16:19], s54 offen  lds
  s_add_u32 m0, s57, 45056
  s_add_u32 s54, s78, 1441792
  buffer_load_dwordx4 v8, s[16:19], s54 offen  lds
  s_add_u32 m0, s57, 49152
  s_add_u32 s54, s78, 1572864
  buffer_load_dwordx4 v8, s[16:19], s54 offen  lds
  s_add_u32 m0, s57, 53248
  s_add_u32 s54, s78, 1703936
  buffer_load_dwordx4 v8, s[16:19], s54 offen  lds
  s_add_u32 m0, s57, 57344
  s_add_u32 s54, s78, 1835008
  buffer_load_dwordx4 v8, s[16:19], s54 offen  lds
  s_add_u32 m0, s57, 61440
  s_add_u32 s54, s78, 1966080
  buffer_load_dwordx4 v8, s[16:19], s54 offen  lds
  s_add_u32 m0, s57, 65536
  s_add_u32 s54, s78, 2097152
  buffer_load_dwordx4 v8, s[16:19], s54 offen  lds
  s_add_u32 m0, s57, 69632
  s_add_u32 s54, s78, 2228224
  buffer_load_dwordx4 v8, s[16:19], s54 offen  lds
  s_add_u32 m0, s57, 73728
  s_add_u32 s54, s78, 2359296
  buffer_load_dwordx4 v8, s[16:19], s54 offen  lds
  s_add_u32 m0, s57, 77824
  s_add_u32 s54, s78, 2490368
  buffer_load_dwordx4 v8, s[16:19], s54 offen  lds
  v_lshlrev_b32 v76, 4, v0
  v_add_u32 v75, 0x10000, v76
  v_lshrrev_b32 v3, 2, v1
  v_and_b32 v4, 1, v1
  v_lshl_add_u32 v3, v3, 1, v4
  v_bfe_u32 v4, v1, 1, 1
  v_mul_u32_u24 v74, 0xaaaa, v4
  v_add_u32 v74, 0x4444, v74
  v_mul_u32_u24 v5, 576, v3
  v_add_u32 v5, 0, v5
  v_lshl_add_u32 v78, v2, 4, v5
  v_lshl_add_u32 v77, v2, 5, v5
  v_lshl_add_u32 v77, v4, 4, v77
  v_mul_u32_u24 v15, 1152, v3
  v_lshl_add_u32 v15, v2, 5, v15
  v_lshl_add_u32 v15, v4, 4, v15
  s_lshl_b32 s54, s52, 8
  buffer_load_dwordx4 v[20:23], v15, s[32:35], s54 offen
  buffer_load_dwordx4 v[24:27], v15, s[32:35], s54 offen offset:128
  buffer_load_dwordx4 v[28:31], v15, s[32:35], 0 offen offset:1024
  v_mul_u32_u24 v79, 1152, v2
  v_lshl_add_u32 v79, v1, 2, v79
  s_lshl_b32 s54, s52, 6
  s_add_u32 s54, s54, 0
  v_add_u32 v79, s54, v79
  v_lshrrev_b32 v5, 3, v0
  v_mul_u32_u24 v68, 2176, v5
  v_and_b32 v5, 7, v0
  v_lshl_add_u32 v68, v5, 3, v68
  v_lshrrev_b32 v6, 3, v0
  s_lshr_b32 s54, s53, 2
  v_add_u32 v68, s54, v6
  v_and_b32 v68, 7, v68
  v_xor_b32 v68, v68, v6
  v_lshlrev_b32 v68, 8, v68
  v_lshl_add_u32 v68, v6, 12, v68
  v_lshl_add_u32 v68, v5, 3, v68
  s_and_b32 s54, s53, 3
  s_lshl_b32 s54, s54, 6
  v_add_u32 v68, s54, v68
  v_and_b32 v5, 1, v2
  v_lshlrev_b32 v5, 4, v5
  v_lshl_add_u32 v5, v1, 2, v5
  v_mov_b32 v6, 0x40000000
  v_cmp_lt_u32 vcc, 3, v1
  s_nop 1
  v_cndmask_b32 v5, v5, v6, vcc
  v_lshrrev_b32 v6, 1, v2
  v_lshl_add_u32 v69, v6, 10, v5
  v_lshl_add_u32 v70, v6, 8, v5
  v_mov_b32 v71, -1
  ds_write_b128 v76, v[68:71] offset:13824
  v_and_b32 v5, 3, v1
  v_lshrrev_b32 v6, 2, v1
  v_lshl_add_u32 v5, v5, 2, v6
  v_and_b32 v6, 1, v5
  v_lshlrev_b32 v6, 4, v6
  v_mov_b32 v7, 0x3f80
  v_lshlrev_b32 v6, v6, v7
  v_lshrrev_b32 v5, 1, v5
  v_cmp_eq_u32 vcc, 0, v5
  s_nop 1
  v_cndmask_b32 v40, 0, v6, vcc
  v_cmp_eq_u32 vcc, 1, v5
  s_nop 1
  v_cndmask_b32 v41, 0, v6, vcc
  v_cmp_eq_u32 vcc, 2, v5
  s_nop 1
  v_cndmask_b32 v42, 0, v6, vcc
  v_cmp_eq_u32 vcc, 3, v5
  s_nop 1
  v_cndmask_b32 v43, 0, v6, vcc
  ds_write_b128 v76, v[40:43] offset:14848
  s_and_b32 s54, s52, 1
  s_lshr_b32 s55, s52, 1
  v_lshrrev_b32 v3, 3, v0
  v_and_b32 v4, 1, v3
  v_lshlrev_b32 v4, 4, v4
  v_and_b32 v5, 6, v3
  v_add_u32 v4, v4, v5
  s_lshl_b32 s56, s55, 3
  s_add_u32 s56, s56, s54
  v_add_u32 v4, s56, v4
  v_mul_u32_u24 v4, 1152, v4
  v_and_b32 v5, 2, v3
  v_lshlrev_b32 v5, 1, v5
  v_and_b32 v6, 7, v0
  v_xor_b32 v6, v6, v5
  v_lshl_add_u32 v9, v6, 4, v4
  v_and_b32 v4, 1, v2
  v_lshlrev_b32 v4, 4, v4
  v_and_b32 v5, 2, v2
  v_add_u32 v4, v4, v5
  s_lshl_b32 s56, s55, 2
  s_add_u32 s56, s56, s54
  v_add_u32 v4, s56, v4
  v_mul_u32_u24 v4, 1152, v4
  v_lshlrev_b32 v6, 1, v2
  v_xor_b32 v6, v6, v1
  v_lshl_add_u32 v10, v6, 4, v4
  v_bfe_u32 v17, v1, 2, 1
  v_bfe_u32 v18, v1, 3, 1
  v_and_b32 v19, 1, v2
  v_lshrrev_b32 v72, 1, v2
  v_and_b32 v73, 3, v1
  v_lshl_add_u32 v3, v19, 1, v17
  v_lshl_add_u32 v6, v18, 2, v3
  v_lshl_add_u32 v4, v72, 4, v17
  v_lshl_add_u32 v4, v19, 2, v4
  v_lshl_add_u32 v4, v18, 3, v4
  v_lshlrev_b32 v4, 8, v4
  s_lshl_b32 s54, s52, 6
  v_lshl_add_u32 v5, v73, 3, s54
  v_lshlrev_b32 v7, 5, v6
  v_xor_b32 v5, v5, v7
  v_add_u32 v11, v4, v5
  v_xor_b32 v12, 32, v11
  v_lshl_add_u32 v4, v72, 2, v3
  v_lshlrev_b32 v4, 7, v4
  v_lshl_add_u32 v4, v73, 3, v4
  s_and_b32 s54, s52, 1
  v_xor_b32 v7, s54, v19
  v_lshl_add_u32 v7, v7, 1, v18
  v_lshl_add_u32 v13, v7, 5, v4
  v_lshlrev_b32 v4, 11, v72
  v_lshl_add_u32 v4, v73, 3, v4
  v_lshl_add_u32 v5, v3, 8, v4
  v_lshl_add_u32 v7, v18, 2, s52
  v_xor_b32 v7, v7, v3
  v_lshl_add_u32 v14, v7, 5, v5
  s_lshl_b32 s54, s53, 14
  s_lshl_b32 s55, s52, 11
  s_add_u32 s54, s54, 1048576
  s_add_u32 s58, s54, s55
  s_add_u32 s59, s58, 8192
  s_lshl_b32 s55, s52, 12
  s_add_u32 s70, s54, s55
  s_add_u32 s70, s70, 655360
  s_lshl_b32 s54, s53, 12
  s_lshl_b32 s55, s52, 10
  s_add_u32 s54, s54, s55
  s_add_u32 s68, s54, 917504
  s_lshl_b32 s54, s53, 6
  s_mul_i32 s55, s52, 17408
  s_add_u32 s55, s54, s55
  s_add_u32 s73, s55, 0
  s_add_u32 s74, s55, 69632
  s_add_u32 s75, s55, 139264
  s_add_u32 s76, s55, 208896
  s_and_b32 s56, s52, 1
  s_mul_i32 s55, s56, 17408
  s_add_u32 s55, s54, s55
  s_add_u32 s77, s55, 278528
  s_mul_i32 s54, s52, 69632
  s_mul_i32 s55, s53, 2176
  s_add_u32 s54, s54, s55
  s_add_u32 s60, s54, 0
  s_and_b32 s56, s53, 15
  s_mul_i32 s55, s56, 2176
  s_add_u32 s61, s55, 278528
  s_lshr_b32 s54, s52, 1
  s_lshl_b32 s54, s54, 15
  s_and_b32 s55, s52, 1
  s_lshl_b32 s55, s55, 11
  s_add_u32 s54, s54, s55
  s_add_u32 s73, s54, 0
  s_add_u32 s74, s54, 65536
  s_add_u32 s75, s54, 131072
  s_add_u32 s76, s54, 196608
  s_add_u32 s77, s55, 262144
  s_and_b32 s54, s53, 7
  s_lshl_b32 s54, s54, 12
  s_bfe_u32 s55, s53, 0x10003
  s_lshl_b32 s55, s55, 11
  s_add_u32 s54, s54, s55
  s_add_u32 s61, s54, 262144
  s_lshr_b32 s55, s53, 4
  s_lshl_b32 s55, s55, 15
  s_add_u32 s54, s54, s55
  s_lshl_b32 s55, s52, 16
  s_add_u32 s54, s54, s55
  s_add_u32 s60, s54, 0
  s_lshl_b32 s54, s52, 11
  s_add_u32 s64, s54, 360448
  s_mov_b32 s65, 368640
  s_lshl_b32 s55, s53, 5
  s_add_u32 s54, s54, s55
  s_add_u32 s62, s54, 376832
  s_lshr_b32 s54, s56, 3
  s_lshl_b32 s54, s54, 9
  s_and_b32 s55, s56, 7
  s_lshl_b32 s55, s55, 5
  s_add_u32 s54, s54, s55
  s_add_u32 s63, s54, 385024
  s_mov_b32 s66, 0
  s_mov_b32 s67, 0
  s_mov_b32 s72, 0
  s_mov_b32 s69, 1040356334
  s_waitcnt vmcnt(19) lgkmcnt(0)
  s_barrier
  s_add_u32 m0, s57, 81920
  s_add_u32 s54, s78, 2621440
  buffer_load_dwordx4 v8, s[16:19], s54 offen  lds
  s_add_u32 m0, s57, 86016
  s_add_u32 s54, s78, 2752512
  buffer_load_dwordx4 v8, s[16:19], s54 offen  lds
  s_add_u32 m0, s57, 90112
  s_add_u32 s54, s78, 2883584
  buffer_load_dwordx4 v8, s[16:19], s54 offen  lds
  s_add_u32 m0, s57, 94208
  s_add_u32 s54, s78, 3014656
  buffer_load_dwordx4 v8, s[16:19], s54 offen  lds
  v_add_u32 v15, 16384, v11
  v_add_u32 v16, 16384, v12
  ds_read_b64_tr_b16 v[80:81], v15 offset:0
  ds_read_b64_tr_b16 v[82:83], v15 offset:512
  ds_read_b64_tr_b16 v[84:85], v15 offset:8192
  ds_read_b64_tr_b16 v[86:87], v15 offset:8704
  ds_read_b64_tr_b16 v[88:89], v16 offset:0
  ds_read_b64_tr_b16 v[90:91], v16 offset:512
  ds_read_b64_tr_b16 v[92:93], v16 offset:8192
  ds_read_b64_tr_b16 v[94:95], v16 offset:8704
  s_waitcnt vmcnt(19) lgkmcnt(0)
  s_barrier
  s_add_u32 m0, s57, 98304
  s_add_u32 s54, s78, 3670016
  buffer_load_dwordx4 v8, s[16:19], s54 offen  lds
  s_add_u32 m0, s57, 102400
  s_add_u32 s54, s78, 3801088
  buffer_load_dwordx4 v8, s[16:19], s54 offen  lds
  s_add_u32 m0, s57, 106496
  s_add_u32 s54, s78, 3932160
  buffer_load_dwordx4 v8, s[16:19], s54 offen  lds
  s_add_u32 m0, s57, 110592
  s_add_u32 s54, s78, 4063232
  buffer_load_dwordx4 v8, s[16:19], s54 offen  lds
  v_add_u32 v15, 32768, v11
  v_add_u32 v16, 32768, v12
  ds_read_b64_tr_b16 v[96:97], v15 offset:0
  ds_read_b64_tr_b16 v[98:99], v15 offset:512
  ds_read_b64_tr_b16 v[100:101], v15 offset:8192
  ds_read_b64_tr_b16 v[102:103], v15 offset:8704
  ds_read_b64_tr_b16 v[104:105], v16 offset:0
  ds_read_b64_tr_b16 v[106:107], v16 offset:512
  ds_read_b64_tr_b16 v[108:109], v16 offset:8192
  ds_read_b64_tr_b16 v[110:111], v16 offset:8704
  s_waitcnt vmcnt(19) lgkmcnt(0)
  s_barrier
  s_add_u32 m0, s57, 114688
  s_add_u32 s54, s78, 4194304
  buffer_load_dwordx4 v8, s[16:19], s54 offen  lds
  s_add_u32 m0, s57, 118784
  s_add_u32 s54, s78, 4325376
  buffer_load_dwordx4 v8, s[16:19], s54 offen  lds
  s_add_u32 m0, s57, 122880
  s_add_u32 s54, s78, 4456448
  buffer_load_dwordx4 v8, s[16:19], s54 offen  lds
  s_add_u32 m0, s57, 126976
  s_add_u32 s54, s78, 4587520
  buffer_load_dwordx4 v8, s[16:19], s54 offen  lds
  v_add_u32 v15, 49152, v11
  v_add_u32 v16, 49152, v12
  ds_read_b64_tr_b16 v[112:113], v15 offset:0
  ds_read_b64_tr_b16 v[114:115], v15 offset:512
  ds_read_b64_tr_b16 v[116:117], v15 offset:8192
  ds_read_b64_tr_b16 v[118:119], v15 offset:8704
  ds_read_b64_tr_b16 v[120:121], v16 offset:0
  ds_read_b64_tr_b16 v[122:123], v16 offset:512
  ds_read_b64_tr_b16 v[124:125], v16 offset:8192
  ds_read_b64_tr_b16 v[126:127], v16 offset:8704
  s_waitcnt vmcnt(19) lgkmcnt(0)
  s_barrier
  s_add_u32 m0, s57, 131072
  s_add_u32 s54, s78, 1048576
  buffer_load_dwordx4 v8, s[20:23], s54 offen  lds
  s_add_u32 m0, s57, 135168
  s_add_u32 s54, s78, 1179648
  buffer_load_dwordx4 v8, s[20:23], s54 offen  lds
  s_add_u32 m0, s57, 139264
  s_add_u32 s54, s78, 1310720
  buffer_load_dwordx4 v8, s[20:23], s54 offen  lds
  s_add_u32 m0, s57, 143360
  s_add_u32 s54, s78, 1441792
  buffer_load_dwordx4 v8, s[20:23], s54 offen  lds
  v_add_u32 v15, 65536, v11
  v_add_u32 v16, 65536, v12
  ds_read_b64_tr_b16 v[128:129], v15 offset:0
  ds_read_b64_tr_b16 v[130:131], v15 offset:512
  ds_read_b64_tr_b16 v[132:133], v15 offset:8192
  ds_read_b64_tr_b16 v[134:135], v15 offset:8704
  ds_read_b64_tr_b16 v[136:137], v16 offset:0
  ds_read_b64_tr_b16 v[138:139], v16 offset:512
  ds_read_b64_tr_b16 v[140:141], v16 offset:8192
  ds_read_b64_tr_b16 v[142:143], v16 offset:8704
  s_waitcnt vmcnt(19) lgkmcnt(0)
  s_barrier
  s_add_u32 m0, s57, 0
  s_add_u32 s54, s78, 1572864
  buffer_load_dwordx4 v8, s[20:23], s54 offen  lds
  s_add_u32 m0, s57, 4096
  s_add_u32 s54, s78, 1703936
  buffer_load_dwordx4 v8, s[20:23], s54 offen  lds
  s_add_u32 m0, s57, 8192
  s_add_u32 s54, s78, 1835008
  buffer_load_dwordx4 v8, s[20:23], s54 offen  lds
  s_add_u32 m0, s57, 12288
  s_add_u32 s54, s78, 1966080
  buffer_load_dwordx4 v8, s[20:23], s54 offen  lds
  v_add_u32 v15, 81920, v11
  v_add_u32 v16, 81920, v12
  ds_read_b64_tr_b16 v[144:145], v15 offset:0
  ds_read_b64_tr_b16 v[146:147], v15 offset:512
  ds_read_b64_tr_b16 v[148:149], v15 offset:8192
  ds_read_b64_tr_b16 v[150:151], v15 offset:8704
  ds_read_b64_tr_b16 v[152:153], v16 offset:0
  ds_read_b64_tr_b16 v[154:155], v16 offset:512
  ds_read_b64_tr_b16 v[156:157], v16 offset:8192
  ds_read_b64_tr_b16 v[158:159], v16 offset:8704
  s_waitcnt vmcnt(16) lgkmcnt(0)
  s_barrier
  s_add_u32 m0, s57, 16384
  s_add_u32 s54, s78, 3145728
  buffer_load_dwordx4 v8, s[20:23], s54 offen  lds
  s_add_u32 m0, s57, 20480
  s_add_u32 s54, s78, 3276800
  buffer_load_dwordx4 v8, s[20:23], s54 offen  lds
  s_add_u32 m0, s57, 24576
  s_add_u32 s54, s78, 3407872
  buffer_load_dwordx4 v8, s[20:23], s54 offen  lds
  s_add_u32 m0, s57, 28672
  s_add_u32 s54, s78, 3538944
  buffer_load_dwordx4 v8, s[20:23], s54 offen  lds
  v_add_u32 v15, 98304, v11
  v_add_u32 v16, 98304, v12
  ds_read_b64_tr_b16 v[160:161], v15 offset:0
  ds_read_b64_tr_b16 v[162:163], v15 offset:512
  ds_read_b64_tr_b16 v[164:165], v15 offset:8192
  ds_read_b64_tr_b16 v[166:167], v15 offset:8704
  ds_read_b64_tr_b16 v[168:169], v16 offset:0
  ds_read_b64_tr_b16 v[170:171], v16 offset:512
  ds_read_b64_tr_b16 v[172:173], v16 offset:8192
  ds_read_b64_tr_b16 v[174:175], v16 offset:8704
  s_waitcnt vmcnt(16) lgkmcnt(0)
  s_barrier
  s_add_u32 m0, s57, 32768
  s_add_u32 s54, s78, 3670016
  buffer_load_dwordx4 v8, s[20:23], s54 offen  lds
  s_add_u32 m0, s57, 36864
  s_add_u32 s54, s78, 3801088
  buffer_load_dwordx4 v8, s[20:23], s54 offen  lds
  s_add_u32 m0, s57, 40960
  s_add_u32 s54, s78, 3932160
  buffer_load_dwordx4 v8, s[20:23], s54 offen  lds
  s_add_u32 m0, s57, 45056
  s_add_u32 s54, s78, 4063232
  buffer_load_dwordx4 v8, s[20:23], s54 offen  lds
  s_cmp_eq_u32 s1, 1
  s_cbranch_scc1 C_ver_ok
  v_mov_b32 v33, 16320
  s_cmp_eq_u32 s52, 0
  s_cbranch_scc0 C_ver_b
  s_waitcnt vmcnt(52)
  s_mov_b64 exec, 1
  ds_write_b32 v33, v35
  s_mov_b64 exec, -1
  s_waitcnt lgkmcnt(0)
C_ver_b:
  s_barrier
  ds_read_b32 v32, v33
  s_waitcnt lgkmcnt(0)
  v_readfirstlane_b32 s54, v32
  s_nop 0
  s_bitcmp1_b32 s54, s0
  s_cbranch_scc1 L_conf
C_ver_ok:
  v_add_u32 v15, 114688, v11
  v_add_u32 v16, 114688, v12
  ds_read_b64_tr_b16 v[176:177], v15 offset:0
  ds_read_b64_tr_b16 v[178:179], v15 offset:512
  ds_read_b64_tr_b16 v[180:181], v15 offset:8192
  ds_read_b64_tr_b16 v[182:183], v15 offset:8704
  ds_read_b64_tr_b16 v[184:185], v16 offset:0
  ds_read_b64_tr_b16 v[186:187], v16 offset:512
  ds_read_b64_tr_b16 v[188:189], v16 offset:8192
  ds_read_b64_tr_b16 v[190:191], v16 offset:8704
  s_waitcnt vmcnt(16) lgkmcnt(0)
  s_barrier
  s_add_u32 m0, s57, 49152
  s_add_u32 s54, s78, 4194304
  buffer_load_dwordx4 v8, s[20:23], s54 offen  lds
  s_add_u32 m0, s57, 53248
  s_add_u32 s54, s78, 4325376
  buffer_load_dwordx4 v8, s[20:23], s54 offen  lds
  s_add_u32 m0, s57, 57344
  s_add_u32 s54, s78, 4456448
  buffer_load_dwordx4 v8, s[20:23], s54 offen  lds
  s_add_u32 m0, s57, 61440
  s_add_u32 s54, s78, 4587520
  buffer_load_dwordx4 v8, s[20:23], s54 offen  lds
  v_add_u32 v15, 131072, v11
  v_add_u32 v16, 131072, v12
  ds_read_b64_tr_b16 v[192:193], v15 offset:0
  ds_read_b64_tr_b16 v[194:195], v15 offset:512
  ds_read_b64_tr_b16 v[196:197], v15 offset:8192
  ds_read_b64_tr_b16 v[198:199], v15 offset:8704
  ds_read_b64_tr_b16 v[200:201], v16 offset:0
  ds_read_b64_tr_b16 v[202:203], v16 offset:512
  ds_read_b64_tr_b16 v[204:205], v16 offset:8192
  ds_read_b64_tr_b16 v[206:207], v16 offset:8704
  s_waitcnt vmcnt(16) lgkmcnt(0)
  s_barrier
  s_add_u32 m0, s57, 65536
  s_add_u32 s54, s78, 0
  buffer_load_dwordx4 v8, s[24:27], s54 offen  lds
  s_add_u32 m0, s57, 69632
  s_add_u32 s54, s78, 131072
  buffer_load_dwordx4 v8, s[24:27], s54 offen  lds
  s_add_u32 m0, s57, 73728
  s_add_u32 s54, s78, 262144
  buffer_load_dwordx4 v8, s[24:27], s54 offen  lds
  s_add_u32 m0, s57, 77824
  s_add_u32 s54, s78, 393216
  buffer_load_dwordx4 v8, s[24:27], s54 offen  lds
  s_getpc_b64 s[80:81]
  v_lshlrev_b32 v7, 2, v76
  global_load_dword v35, v7, s[80:81] offset:1024
  v_min_u32 v20, -2, v20
  v_min_u32 v21, -2, v21
  v_min_u32 v22, -2, v22
  v_min_u32 v23, -2, v23
  v_min_u32 v24, -2, v24
  v_min_u32 v25, -2, v25
  v_min_u32 v26, -2, v26
  v_min_u32 v27, -2, v27
  v_min_u32 v28, -2, v28
  v_min_u32 v29, -2, v29
  v_min_u32 v30, -2, v30
  v_min_u32 v31, -2, v31
  s_lshl_b32 s54, s52, 11
  v_add_u32 v3, s54, v76
  ds_write_b128 v3, v[20:23] offset:4608
  ds_write_b128 v3, v[24:27] offset:5632
  ds_write_b128 v76, v[28:31] offset:12800
  v_add_u32 v15, 147456, v11
  v_add_u32 v16, 147456, v12
  ds_read_b64_tr_b16 v[208:209], v15 offset:0
  ds_read_b64_tr_b16 v[210:211], v15 offset:512
  ds_read_b64_tr_b16 v[212:213], v15 offset:8192
  ds_read_b64_tr_b16 v[214:215], v15 offset:8704
  ds_read_b64_tr_b16 v[216:217], v16 offset:0
  ds_read_b64_tr_b16 v[218:219], v16 offset:512
  ds_read_b64_tr_b16 v[220:221], v16 offset:8192
  ds_read_b64_tr_b16 v[222:223], v16 offset:8704
  s_waitcnt vmcnt(17) lgkmcnt(0)
  s_barrier
  s_add_u32 m0, s57, 81920
  s_add_u32 s54, s78, 524288
  buffer_load_dwordx4 v8, s[24:27], s54 offen  lds
  s_add_u32 m0, s57, 86016
  s_add_u32 s54, s78, 655360
  buffer_load_dwordx4 v8, s[24:27], s54 offen  lds
  s_add_u32 m0, s57, 90112
  s_add_u32 s54, s78, 786432
  buffer_load_dwordx4 v8, s[24:27], s54 offen  lds
  s_add_u32 m0, s57, 94208
  s_add_u32 s54, s78, 917504
  buffer_load_dwordx4 v8, s[24:27], s54 offen  lds
  v_add_u32 v15, 16384, v11
  v_add_u32 v16, 16384, v12
  ds_read_b64_tr_b16 v[224:225], v15 offset:0
  ds_read_b64_tr_b16 v[226:227], v15 offset:512
  ds_read_b64_tr_b16 v[228:229], v15 offset:8192
  ds_read_b64_tr_b16 v[230:231], v15 offset:8704
  ds_read_b64_tr_b16 v[232:233], v16 offset:0
  ds_read_b64_tr_b16 v[234:235], v16 offset:512
  ds_read_b64_tr_b16 v[236:237], v16 offset:8192
  ds_read_b64_tr_b16 v[238:239], v16 offset:8704
  s_waitcnt vmcnt(17) lgkmcnt(0)
  s_barrier
  s_add_u32 m0, s57, 98304
  s_add_u32 s54, s78, 1048576
  buffer_load_dwordx4 v8, s[24:27], s54 offen  lds
  s_add_u32 m0, s57, 102400
  s_add_u32 s54, s78, 1179648
  buffer_load_dwordx4 v8, s[24:27], s54 offen  lds
  s_add_u32 m0, s57, 106496
  s_add_u32 s54, s78, 1310720
  buffer_load_dwordx4 v8, s[24:27], s54 offen  lds
  s_add_u32 m0, s57, 110592
  s_add_u32 s54, s78, 1441792
  buffer_load_dwordx4 v8, s[24:27], s54 offen  lds
  v_add_u32 v15, 32768, v11
  v_add_u32 v16, 32768, v12
  ds_read_b64_tr_b16 v[240:241], v15 offset:0
  ds_read_b64_tr_b16 v[242:243], v15 offset:512
  ds_read_b64_tr_b16 v[244:245], v15 offset:8192
  ds_read_b64_tr_b16 v[246:247], v15 offset:8704
  ds_read_b64_tr_b16 v[248:249], v16 offset:0
  ds_read_b64_tr_b16 v[250:251], v16 offset:512
  ds_read_b64_tr_b16 v[252:253], v16 offset:8192
  ds_read_b64_tr_b16 v[254:255], v16 offset:8704
  s_waitcnt vmcnt(17) lgkmcnt(0)
  s_barrier
  s_add_u32 m0, s57, 114688
  s_add_u32 s54, s78, 1572864
  buffer_load_dwordx4 v8, s[24:27], s54 offen  lds
  s_add_u32 m0, s57, 118784
  s_add_u32 s54, s78, 1703936
  buffer_load_dwordx4 v8, s[24:27], s54 offen  lds
  s_add_u32 m0, s57, 122880
  s_add_u32 s54, s78, 1835008
  buffer_load_dwordx4 v8, s[24:27], s54 offen  lds
  s_add_u32 m0, s57, 126976
  s_add_u32 s54, s78, 1966080
  buffer_load_dwordx4 v8, s[24:27], s54 offen  lds
  v_add_u32 v15, 49152, v11
  v_add_u32 v16, 49152, v12
  ds_read_b64_tr_b16 a[0:1], v15 offset:0
  ds_read_b64_tr_b16 a[2:3], v15 offset:512
  ds_read_b64_tr_b16 a[4:5], v15 offset:8192
  ds_read_b64_tr_b16 a[6:7], v15 offset:8704
  ds_read_b64_tr_b16 a[8:9], v16 offset:0
  ds_read_b64_tr_b16 a[10:11], v16 offset:512
  ds_read_b64_tr_b16 a[12:13], v16 offset:8192
  ds_read_b64_tr_b16 a[14:15], v16 offset:8704
  s_waitcnt vmcnt(17) lgkmcnt(0)
  s_barrier
  s_add_u32 m0, s57, 131072
  s_add_u32 s54, s78, 2097152
  buffer_load_dwordx4 v8, s[24:27], s54 offen  lds
  s_add_u32 m0, s57, 135168
  s_add_u32 s54, s78, 2228224
  buffer_load_dwordx4 v8, s[24:27], s54 offen  lds
  s_add_u32 m0, s57, 139264
  s_add_u32 s54, s78, 2359296
  buffer_load_dwordx4 v8, s[24:27], s54 offen  lds
  s_add_u32 m0, s57, 143360
  s_add_u32 s54, s78, 2490368
  buffer_load_dwordx4 v8, s[24:27], s54 offen  lds
  v_add_u32 v15, 65536, v11
  v_add_u32 v16, 65536, v12
  ds_read_b64_tr_b16 a[16:17], v15 offset:0
  ds_read_b64_tr_b16 a[18:19], v15 offset:512
  ds_read_b64_tr_b16 a[20:21], v15 offset:8192
  ds_read_b64_tr_b16 a[22:23], v15 offset:8704
  ds_read_b64_tr_b16 a[24:25], v16 offset:0
  ds_read_b64_tr_b16 a[26:27], v16 offset:512
  ds_read_b64_tr_b16 a[28:29], v16 offset:8192
  ds_read_b64_tr_b16 a[30:31], v16 offset:8704
  s_waitcnt vmcnt(17) lgkmcnt(0)
  s_barrier
  s_add_u32 m0, s57, 0
  s_add_u32 s54, s78, 2621440
  buffer_load_dwordx4 v8, s[24:27], s54 offen  lds
  s_add_u32 m0, s57, 4096
  s_add_u32 s54, s78, 2752512
  buffer_load_dwordx4 v8, s[24:27], s54 offen  lds
  s_add_u32 m0, s57, 8192
  s_add_u32 s54, s78, 2883584
  buffer_load_dwordx4 v8, s[24:27], s54 offen  lds
  s_add_u32 m0, s57, 12288
  s_add_u32 s54, s78, 3014656
  buffer_load_dwordx4 v8, s[24:27], s54 offen  lds
  v_add_u32 v15, 81920, v11
  v_add_u32 v16, 81920, v12
  ds_read_b64_tr_b16 a[32:33], v15 offset:0
  ds_read_b64_tr_b16 a[34:35], v15 offset:512
  ds_read_b64_tr_b16 a[36:37], v15 offset:8192
  ds_read_b64_tr_b16 a[38:39], v15 offset:8704
  ds_read_b64_tr_b16 a[40:41], v16 offset:0
  ds_read_b64_tr_b16 a[42:43], v16 offset:512
  ds_read_b64_tr_b16 a[44:45], v16 offset:8192
  ds_read_b64_tr_b16 a[46:47], v16 offset:8704
  s_waitcnt vmcnt(16) lgkmcnt(0)
  s_barrier
  s_add_u32 m0, s57, 16384
  s_add_u32 s54, s78, 3145728
  buffer_load_dwordx4 v8, s[24:27], s54 offen  lds
  s_add_u32 m0, s57, 20480
  s_add_u32 s54, s78, 3276800
  buffer_load_dwordx4 v8, s[24:27], s54 offen  lds
  s_add_u32 m0, s57, 24576
  s_add_u32 s54, s78, 3407872
  buffer_load_dwordx4 v8, s[24:27], s54 offen  lds
  s_add_u32 m0, s57, 28672
  s_add_u32 s54, s78, 3538944
  buffer_load_dwordx4 v8, s[24:27], s54 offen  lds
  s_getpc_b64 s[80:81]
  v_lshlrev_b32 v7, 2, v76
  global_load_dword v35, v7, s[80:81] offset:1024
  v_add_u32 v15, 98304, v11
  v_add_u32 v16, 98304, v12
  ds_read_b64_tr_b16 a[48:49], v15 offset:0
  ds_read_b64_tr_b16 a[50:51], v15 offset:512
  ds_read_b64_tr_b16 a[52:53], v15 offset:8192
  ds_read_b64_tr_b16 a[54:55], v15 offset:8704
  ds_read_b64_tr_b16 a[56:57], v16 offset:0
  ds_read_b64_tr_b16 a[58:59], v16 offset:512
  ds_read_b64_tr_b16 a[60:61], v16 offset:8192
  ds_read_b64_tr_b16 a[62:63], v16 offset:8704
  s_waitcnt vmcnt(17) lgkmcnt(0)
  s_barrier
  s_add_u32 m0, s57, 32768
  s_add_u32 s54, s78, 3670016
  buffer_load_dwordx4 v8, s[24:27], s54 offen  lds
  s_add_u32 m0, s57, 36864
  s_add_u32 s54, s78, 3801088
  buffer_load_dwordx4 v8, s[24:27], s54 offen  lds
  s_add_u32 m0, s57, 40960
  s_add_u32 s54, s78, 3932160
  buffer_load_dwordx4 v8, s[24:27], s54 offen  lds
  s_add_u32 m0, s57, 45056
  s_add_u32 s54, s78, 4063232
  buffer_load_dwordx4 v8, s[24:27], s54 offen  lds
  v_add_u32 v15, 114688, v11
  v_add_u32 v16, 114688, v12
  ds_read_b64_tr_b16 a[64:65], v15 offset:0
  ds_read_b64_tr_b16 a[66:67], v15 offset:512
  ds_read_b64_tr_b16 a[68:69], v15 offset:8192
  ds_read_b64_tr_b16 a[70:71], v15 offset:8704
  ds_read_b64_tr_b16 a[72:73], v16 offset:0
  ds_read_b64_tr_b16 a[74:75], v16 offset:512
  ds_read_b64_tr_b16 a[76:77], v16 offset:8192
  ds_read_b64_tr_b16 a[78:79], v16 offset:8704
  s_waitcnt vmcnt(17) lgkmcnt(0)
  s_barrier
  s_add_u32 m0, s57, 49152
  s_add_u32 s54, s78, 4194304
  buffer_load_dwordx4 v8, s[24:27], s54 offen  lds
  s_add_u32 m0, s57, 53248
  s_add_u32 s54, s78, 4325376
  buffer_load_dwordx4 v8, s[24:27], s54 offen  lds
  s_add_u32 m0, s57, 57344
  s_add_u32 s54, s78, 4456448
  buffer_load_dwordx4 v8, s[24:27], s54 offen  lds
  s_add_u32 m0, s57, 61440
  s_add_u32 s54, s78, 4587520
  buffer_load_dwordx4 v8, s[24:27], s54 offen  lds
  v_add_u32 v15, 131072, v11
  v_add_u32 v16, 131072, v12
  ds_read_b64_tr_b16 a[80:81], v15 offset:0
  ds_read_b64_tr_b16 a[82:83], v15 offset:512
  ds_read_b64_tr_b16 a[84:85], v15 offset:8192
  ds_read_b64_tr_b16 a[86:87], v15 offset:8704
  ds_read_b64_tr_b16 a[88:89], v16 offset:0
  ds_read_b64_tr_b16 a[90:91], v16 offset:512
  ds_read_b64_tr_b16 a[92:93], v16 offset:8192
  ds_read_b64_tr_b16 a[94:95], v16 offset:8704
  s_waitcnt vmcnt(17) lgkmcnt(0)
  s_barrier
  s_add_u32 m0, s57, 65536
  s_add_u32 s54, s79, 73728
  buffer_load_dwordx4 v10, s[28:31], s54 offen  lds
  s_add_u32 m0, s57, 69632
  s_add_u32 s54, s79, 82944
  buffer_load_dwordx4 v10, s[28:31], s54 offen  lds
  s_add_u32 m0, s57, 73728
  s_add_u32 s54, s79, 110592
  buffer_load_dwordx4 v10, s[28:31], s54 offen  lds
  s_add_u32 m0, s57, 77824
  s_add_u32 s54, s79, 119808
  buffer_load_dwordx4 v10, s[28:31], s54 offen  lds
  v_add_u32 v15, 147456, v11
  v_add_u32 v16, 147456, v12
  ds_read_b64_tr_b16 a[96:97], v15 offset:0
  ds_read_b64_tr_b16 a[98:99], v15 offset:512
  ds_read_b64_tr_b16 a[100:101], v15 offset:8192
  ds_read_b64_tr_b16 a[102:103], v15 offset:8704
  ds_read_b64_tr_b16 a[104:105], v16 offset:0
  ds_read_b64_tr_b16 a[106:107], v16 offset:512
  ds_read_b64_tr_b16 a[108:109], v16 offset:8192
  ds_read_b64_tr_b16 a[110:111], v16 offset:8704
  s_waitcnt vmcnt(17) lgkmcnt(0)
  s_barrier
  s_add_u32 m0, s57, 81920
  s_add_u32 s54, s79, 256
  buffer_load_dwordx4 v10, s[28:31], s54 offen  lds
  s_add_u32 m0, s57, 86016
  s_add_u32 s54, s79, 9472
  buffer_load_dwordx4 v10, s[28:31], s54 offen  lds
  s_add_u32 m0, s57, 90112
  s_add_u32 s54, s79, 37120
  buffer_load_dwordx4 v10, s[28:31], s54 offen  lds
  s_add_u32 m0, s57, 94208
  s_add_u32 s54, s79, 46336
  buffer_load_dwordx4 v10, s[28:31], s54 offen  lds
  v_add_u32 v15, 16384, v11
  v_add_u32 v16, 16384, v12
  ds_read_b64_tr_b16 a[112:113], v15 offset:0
  ds_read_b64_tr_b16 a[114:115], v15 offset:512
  ds_read_b64_tr_b16 a[116:117], v15 offset:8192
  ds_read_b64_tr_b16 a[118:119], v15 offset:8704
  ds_read_b64_tr_b16 a[120:121], v16 offset:0
  ds_read_b64_tr_b16 a[122:123], v16 offset:512
  ds_read_b64_tr_b16 a[124:125], v16 offset:8192
  ds_read_b64_tr_b16 a[126:127], v16 offset:8704
  s_waitcnt vmcnt(17) lgkmcnt(0)
  s_barrier
  s_add_u32 m0, s57, 98304
  s_add_u32 s54, s79, 512
  buffer_load_dwordx4 v10, s[28:31], s54 offen  lds
  s_add_u32 m0, s57, 102400
  s_add_u32 s54, s79, 9728
  buffer_load_dwordx4 v10, s[28:31], s54 offen  lds
  s_add_u32 m0, s57, 106496
  s_add_u32 s54, s79, 37376
  buffer_load_dwordx4 v10, s[28:31], s54 offen  lds
  s_add_u32 m0, s57, 110592
  s_add_u32 s54, s79, 46592
  buffer_load_dwordx4 v10, s[28:31], s54 offen  lds
  v_add_u32 v15, 32768, v11
  v_add_u32 v16, 32768, v12
  ds_read_b64_tr_b16 a[128:129], v15 offset:0
  ds_read_b64_tr_b16 a[130:131], v15 offset:512
  ds_read_b64_tr_b16 a[132:133], v15 offset:8192
  ds_read_b64_tr_b16 a[134:135], v15 offset:8704
  ds_read_b64_tr_b16 a[136:137], v16 offset:0
  ds_read_b64_tr_b16 a[138:139], v16 offset:512
  ds_read_b64_tr_b16 a[140:141], v16 offset:8192
  ds_read_b64_tr_b16 a[142:143], v16 offset:8704
  s_waitcnt vmcnt(16) lgkmcnt(0)
  s_barrier
  s_add_u32 m0, s57, 114688
  s_add_u32 s54, s79, 768
  buffer_load_dwordx4 v10, s[28:31], s54 offen  lds
  s_add_u32 m0, s57, 118784
  s_add_u32 s54, s79, 9984
  buffer_load_dwordx4 v10, s[28:31], s54 offen  lds
  s_add_u32 m0, s57, 122880
  s_add_u32 s54, s79, 37632
  buffer_load_dwordx4 v10, s[28:31], s54 offen  lds
  s_add_u32 m0, s57, 126976
  s_add_u32 s54, s79, 46848
  buffer_load_dwordx4 v10, s[28:31], s54 offen  lds
  s_getpc_b64 s[80:81]
  v_lshlrev_b32 v7, 2, v76
  global_load_dword v35, v7, s[80:81] offset:1024
  v_add_u32 v15, 49152, v11
  v_add_u32 v16, 49152, v12
  ds_read_b64_tr_b16 a[144:145], v15 offset:0
  ds_read_b64_tr_b16 a[146:147], v15 offset:512
  ds_read_b64_tr_b16 a[148:149], v15 offset:8192
  ds_read_b64_tr_b16 a[150:151], v15 offset:8704
  ds_read_b64_tr_b16 a[152:153], v16 offset:0
  ds_read_b64_tr_b16 a[154:155], v16 offset:512
  ds_read_b64_tr_b16 a[156:157], v16 offset:8192
  ds_read_b64_tr_b16 a[158:159], v16 offset:8704
  s_waitcnt vmcnt(17) lgkmcnt(0)
  s_barrier
  s_add_u32 m0, s57, 131072
  s_add_u32 s54, s79, 74496
  buffer_load_dwordx4 v10, s[28:31], s54 offen  lds
  s_add_u32 m0, s57, 135168
  s_add_u32 s54, s79, 83712
  buffer_load_dwordx4 v10, s[28:31], s54 offen  lds
  s_add_u32 m0, s57, 139264
  s_add_u32 s54, s79, 111360
  buffer_load_dwordx4 v10, s[28:31], s54 offen  lds
  s_add_u32 m0, s57, 143360
  s_add_u32 s54, s79, 120576
  buffer_load_dwordx4 v10, s[28:31], s54 offen  lds
  v_add_u32 v15, 65536, v11
  v_add_u32 v16, 65536, v12
  ds_read_b64_tr_b16 a[160:161], v15 offset:0
  ds_read_b64_tr_b16 a[162:163], v15 offset:512
  ds_read_b64_tr_b16 a[164:165], v15 offset:8192
  ds_read_b64_tr_b16 a[166:167], v15 offset:8704
  ds_read_b64_tr_b16 a[168:169], v16 offset:0
  ds_read_b64_tr_b16 a[170:171], v16 offset:512
  ds_read_b64_tr_b16 a[172:173], v16 offset:8192
  ds_read_b64_tr_b16 a[174:175], v16 offset:8704
  s_waitcnt vmcnt(17) lgkmcnt(0)
  s_barrier
  s_add_u32 m0, s57, 0
  s_add_u32 s54, s78, 0
  buffer_load_dwordx4 v8, s[20:23], s54 offen  lds
  s_add_u32 m0, s57, 4096
  s_add_u32 s54, s78, 131072
  buffer_load_dwordx4 v8, s[20:23], s54 offen  lds
  s_add_u32 m0, s57, 8192
  s_add_u32 s54, s78, 262144
  buffer_load_dwordx4 v8, s[20:23], s54 offen  lds
  s_add_u32 m0, s57, 12288
  s_add_u32 s54, s78, 393216
  buffer_load_dwordx4 v8, s[20:23], s54 offen  lds
  v_add_u32 v15, 81920, v14
  ds_read_b64_tr_b16 a[176:177], v15 offset:0
  ds_read_b64_tr_b16 a[178:179], v15 offset:1024
  ds_read_b64_tr_b16 a[180:181], v15 offset:4096
  ds_read_b64_tr_b16 a[182:183], v15 offset:5120
  ds_read_b64_tr_b16 a[184:185], v15 offset:8192
  ds_read_b64_tr_b16 a[186:187], v15 offset:9216
  ds_read_b64_tr_b16 a[188:189], v15 offset:12288
  ds_read_b64_tr_b16 a[190:191], v15 offset:13312
  s_waitcnt vmcnt(17) lgkmcnt(0)
  s_barrier
  s_add_u32 m0, s57, 16384
  s_add_u32 s54, s78, 524288
  buffer_load_dwordx4 v8, s[20:23], s54 offen  lds
  s_add_u32 m0, s57, 20480
  s_add_u32 s54, s78, 655360
  buffer_load_dwordx4 v8, s[20:23], s54 offen  lds
  s_add_u32 m0, s57, 24576
  s_add_u32 s54, s78, 786432
  buffer_load_dwordx4 v8, s[20:23], s54 offen  lds
  s_add_u32 m0, s57, 28672
  s_add_u32 s54, s78, 917504
  buffer_load_dwordx4 v8, s[20:23], s54 offen  lds
  v_add_u32 v15, 98304, v14
  ds_read_b64_tr_b16 a[192:193], v15 offset:0
  ds_read_b64_tr_b16 a[194:195], v15 offset:1024
  ds_read_b64_tr_b16 a[196:197], v15 offset:4096
  ds_read_b64_tr_b16 a[198:199], v15 offset:5120
  ds_read_b64_tr_b16 a[200:201], v15 offset:8192
  ds_read_b64_tr_b16 a[202:203], v15 offset:9216
  ds_read_b64_tr_b16 a[204:205], v15 offset:12288
  ds_read_b64_tr_b16 a[206:207], v15 offset:13312
  s_waitcnt vmcnt(17) lgkmcnt(0)
  s_barrier
  s_add_u32 m0, s57, 32768
  s_add_u32 s54, s78, 2097152
  buffer_load_dwordx4 v8, s[20:23], s54 offen  lds
  s_add_u32 m0, s57, 36864
  s_add_u32 s54, s78, 2228224
  buffer_load_dwordx4 v8, s[20:23], s54 offen  lds
  s_add_u32 m0, s57, 40960
  s_add_u32 s54, s78, 2359296
  buffer_load_dwordx4 v8, s[20:23], s54 offen  lds
  s_add_u32 m0, s57, 45056
  s_add_u32 s54, s78, 2490368
  buffer_load_dwordx4 v8, s[20:23], s54 offen  lds
  v_add_u32 v15, 114688, v14
  ds_read_b64_tr_b16 a[208:209], v15 offset:0
  ds_read_b64_tr_b16 a[210:211], v15 offset:1024
  ds_read_b64_tr_b16 a[212:213], v15 offset:4096
  ds_read_b64_tr_b16 a[214:215], v15 offset:5120
  ds_read_b64_tr_b16 a[216:217], v15 offset:8192
  ds_read_b64_tr_b16 a[218:219], v15 offset:9216
  ds_read_b64_tr_b16 a[220:221], v15 offset:12288
  ds_read_b64_tr_b16 a[222:223], v15 offset:13312
  s_waitcnt vmcnt(17) lgkmcnt(0)
  s_barrier
  s_add_u32 m0, s57, 49152
  s_add_u32 s54, s78, 3145728
  buffer_load_dwordx4 v8, s[16:19], s54 offen  lds
  s_add_u32 m0, s57, 53248
  s_add_u32 s54, s78, 3276800
  buffer_load_dwordx4 v8, s[16:19], s54 offen  lds
  s_add_u32 m0, s57, 57344
  s_add_u32 s54, s78, 3407872
  buffer_load_dwordx4 v8, s[16:19], s54 offen  lds
  s_add_u32 m0, s57, 61440
  s_add_u32 s54, s78, 3538944
  buffer_load_dwordx4 v8, s[16:19], s54 offen  lds
  v_add_u32 v15, 131072, v14
  ds_read_b64_tr_b16 a[224:225], v15 offset:0
  ds_read_b64_tr_b16 a[226:227], v15 offset:1024
  ds_read_b64_tr_b16 a[228:229], v15 offset:4096
  ds_read_b64_tr_b16 a[230:231], v15 offset:5120
  ds_read_b64_tr_b16 a[232:233], v15 offset:8192
  ds_read_b64_tr_b16 a[234:235], v15 offset:9216
  ds_read_b64_tr_b16 a[236:237], v15 offset:12288
  ds_read_b64_tr_b16 a[238:239], v15 offset:13312
  s_waitcnt vmcnt(16) lgkmcnt(0)
  s_barrier
  s_add_u32 m0, s57, 65536
  s_add_u32 s54, s78, 2621440
  buffer_load_dwordx4 v8, s[20:23], s54 offen  lds
  s_add_u32 m0, s57, 69632
  s_add_u32 s54, s78, 2752512
  buffer_load_dwordx4 v8, s[20:23], s54 offen  lds
  s_add_u32 m0, s57, 73728
  s_add_u32 s54, s78, 2883584
  buffer_load_dwordx4 v8, s[20:23], s54 offen  lds
  s_add_u32 m0, s57, 77824
  s_add_u32 s54, s78, 3014656
  buffer_load_dwordx4 v8, s[20:23], s54 offen  lds
  v_add_u32 v15, 147456, v14
  ds_read_b64_tr_b16 a[240:241], v15 offset:0
  ds_read_b64_tr_b16 a[242:243], v15 offset:1024
  ds_read_b64_tr_b16 a[244:245], v15 offset:4096
  ds_read_b64_tr_b16 a[246:247], v15 offset:5120
  ds_read_b64_tr_b16 a[248:249], v15 offset:8192
  ds_read_b64_tr_b16 a[250:251], v15 offset:9216
  ds_read_b64_tr_b16 a[252:253], v15 offset:12288
  ds_read_b64_tr_b16 a[254:255], v15 offset:13312
  s_waitcnt vmcnt(16) lgkmcnt(0)
  s_barrier
  s_add_u32 m0, s57, 81920
  s_add_u32 s54, s79, 1024
  buffer_load_dwordx4 v9, s[28:31], s54 offen  lds
  s_add_u32 m0, s57, 86016
  s_add_u32 s54, s79, 37888
  buffer_load_dwordx4 v9, s[28:31], s54 offen  lds
  s_add_u32 m0, s57, 90112
  s_add_u32 s54, s79, 74752
  buffer_load_dwordx4 v9, s[28:31], s54 offen  lds
  s_add_u32 m0, s57, 94208
  s_add_u32 s54, s79, 111616
  buffer_load_dwordx4 v9, s[28:31], s54 offen  lds
  v_add_u32 v15, 16384, v11
  v_add_u32 v16, 16384, v12
  ds_read_b64_tr_b16 v[52:53], v15 offset:0
  ds_read_b64_tr_b16 v[54:55], v15 offset:512
  ds_read_b64_tr_b16 v[56:57], v15 offset:8192
  ds_read_b64_tr_b16 v[58:59], v15 offset:8704
  ds_read_b64_tr_b16 v[60:61], v16 offset:0
  ds_read_b64_tr_b16 v[62:63], v16 offset:512
  ds_read_b64_tr_b16 v[64:65], v16 offset:8192
  ds_read_b64_tr_b16 v[66:67], v16 offset:8704
  s_waitcnt vmcnt(16) lgkmcnt(0)
  s_barrier
  s_lshl_b32 s54, s52, 12
  s_add_u32 s54, s54, 16384
  v_add_u32 v7, s54, v76
  ds_write_b128 v7, v[52:55] offset:0
  ds_write_b128 v7, v[56:59] offset:1024
  ds_write_b128 v7, v[60:63] offset:2048
  ds_write_b128 v7, v[64:67] offset:3072
  s_add_u32 m0, s57, 98304
  s_add_u32 s54, s79, 0
  buffer_load_dwordx4 v10, s[28:31], s54 offen  lds
  s_add_u32 m0, s57, 102400
  s_add_u32 s54, s79, 9216
  buffer_load_dwordx4 v10, s[28:31], s54 offen  lds
  s_add_u32 m0, s57, 106496
  s_add_u32 s54, s79, 36864
  buffer_load_dwordx4 v10, s[28:31], s54 offen  lds
  s_add_u32 m0, s57, 110592
  s_add_u32 s54, s79, 46080
  buffer_load_dwordx4 v10, s[28:31], s54 offen  lds
  v_add_u32 v15, 32768, v11
  v_add_u32 v16, 32768, v12
  ds_read_b64_tr_b16 v[36:37], v15 offset:0
  ds_read_b64_tr_b16 v[38:39], v15 offset:512
  ds_read_b64_tr_b16 v[40:41], v15 offset:8192
  ds_read_b64_tr_b16 v[42:43], v15 offset:8704
  ds_read_b64_tr_b16 v[44:45], v16 offset:0
  ds_read_b64_tr_b16 v[46:47], v16 offset:512
  ds_read_b64_tr_b16 v[48:49], v16 offset:8192
  ds_read_b64_tr_b16 v[50:51], v16 offset:8704
  s_waitcnt vmcnt(16) lgkmcnt(0)
  s_barrier
  s_lshl_b32 s54, s52, 12
  s_add_u32 s54, s54, 32768
  v_add_u32 v7, s54, v76
  ds_write_b128 v7, v[36:39] offset:0
  ds_write_b128 v7, v[40:43] offset:1024
  ds_write_b128 v7, v[44:47] offset:2048
  ds_write_b128 v7, v[48:51] offset:3072
  s_add_u32 m0, s57, 114688
  s_add_u32 s54, s79, 73984
  buffer_load_dwordx4 v10, s[28:31], s54 offen  lds
  s_add_u32 m0, s57, 118784
  s_add_u32 s54, s79, 83200
  buffer_load_dwordx4 v10, s[28:31], s54 offen  lds
  s_add_u32 m0, s57, 122880
  s_add_u32 s54, s79, 110848
  buffer_load_dwordx4 v10, s[28:31], s54 offen  lds
  s_add_u32 m0, s57, 126976
  s_add_u32 s54, s79, 120064
  buffer_load_dwordx4 v10, s[28:31], s54 offen  lds
  v_add_u32 v15, 49152, v11
  v_add_u32 v16, 49152, v12
  ds_read_b64_tr_b16 v[52:53], v15 offset:0
  ds_read_b64_tr_b16 v[54:55], v15 offset:512
  ds_read_b64_tr_b16 v[56:57], v15 offset:8192
  ds_read_b64_tr_b16 v[58:59], v15 offset:8704
  ds_read_b64_tr_b16 v[60:61], v16 offset:0
  ds_read_b64_tr_b16 v[62:63], v16 offset:512
  ds_read_b64_tr_b16 v[64:65], v16 offset:8192
  ds_read_b64_tr_b16 v[66:67], v16 offset:8704
  s_waitcnt vmcnt(16) lgkmcnt(0)
  s_barrier
  s_lshl_b32 s54, s52, 12
  s_add_u32 s54, s54, 49152
  v_add_u32 v7, s54, v76
  ds_write_b128 v7, v[52:55] offset:0
  ds_write_b128 v7, v[56:59] offset:1024
  ds_write_b128 v7, v[60:63] offset:2048
  ds_write_b128 v7, v[64:67] offset:3072
  s_add_u32 m0, s57, 131072
  s_add_u32 s54, s79, 74240
  buffer_load_dwordx4 v10, s[28:31], s54 offen  lds
  s_add_u32 m0, s57, 135168
  s_add_u32 s54, s79, 83456
  buffer_load_dwordx4 v10, s[28:31], s54 offen  lds
  s_add_u32 m0, s57, 139264
  s_add_u32 s54, s79, 111104
  buffer_load_dwordx4 v10, s[28:31], s54 offen  lds
  s_add_u32 m0, s57, 143360
  s_add_u32 s54, s79, 120320
  buffer_load_dwordx4 v10, s[28:31], s54 offen  lds
  v_lshlrev_b32 v7, 3, v76
  s_lshl_b32 s54, s52, 13
  s_add_u32 s54, s54, 360448
  s_bitcmp1_b32 s52, 0
  s_cselect_b64 exec, 0xff, -1
  buffer_load_dword v35, v7, s[8:11], s54 offen sc1
  s_mov_b64 exec, -1
  s_getpc_b64 s[80:81]
C_pc:
  s_mov_b32 s55, (L_w0 - C_pc)
  s_cmp_eq_u32 s52, 1
  s_cselect_b32 s55, (L_w1 - C_pc), s55
  s_cmp_eq_u32 s52, 2
  s_cselect_b32 s55, (L_w2 - C_pc), s55
  s_cmp_eq_u32 s52, 3
  s_cselect_b32 s55, (L_w3 - C_pc), s55
  v_lshl_add_u32 v7, v76, 3, s55
  global_load_dword v35, v7, s[80:81]
  v_add_u32 v15, 65536, v11
  v_add_u32 v16, 65536, v12
  ds_read_b64_tr_b16 v[36:37], v15 offset:0
  ds_read_b64_tr_b16 v[38:39], v15 offset:512
  ds_read_b64_tr_b16 v[40:41], v15 offset:8192
  ds_read_b64_tr_b16 v[42:43], v15 offset:8704
  ds_read_b64_tr_b16 v[44:45], v16 offset:0
  ds_read_b64_tr_b16 v[46:47], v16 offset:512
  ds_read_b64_tr_b16 v[48:49], v16 offset:8192
  ds_read_b64_tr_b16 v[50:51], v16 offset:8704
  s_waitcnt vmcnt(18) lgkmcnt(0)
  s_barrier
  s_lshl_b32 s54, s52, 12
  s_add_u32 s54, s54, 65536
  v_add_u32 v7, s54, v76
  ds_write_b128 v7, v[36:39] offset:0
  ds_write_b128 v7, v[40:43] offset:1024
  ds_write_b128 v7, v[44:47] offset:2048
  ds_write_b128 v7, v[48:51] offset:3072
  v_lshrrev_b32 v20, 2, v76
  buffer_load_dword v21, v20, s[12:15], 0 offen sc1
  v_add_u32 v15, 81920, v11
  v_add_u32 v16, 81920, v12
  ds_read_b64_tr_b16 v[52:53], v15 offset:0
  ds_read_b64_tr_b16 v[54:55], v15 offset:512
  ds_read_b64_tr_b16 v[56:57], v15 offset:8192
  ds_read_b64_tr_b16 v[58:59], v15 offset:8704
  ds_read_b64_tr_b16 v[60:61], v16 offset:0
  ds_read_b64_tr_b16 v[62:63], v16 offset:512
  ds_read_b64_tr_b16 v[64:65], v16 offset:8192
  ds_read_b64_tr_b16 v[66:67], v16 offset:8704
  s_waitcnt vmcnt(15) lgkmcnt(0)
  s_barrier
  s_lshl_b32 s54, s52, 12
  s_add_u32 s54, s54, 81920
  v_add_u32 v7, s54, v76
  ds_write_b128 v7, v[52:55] offset:0
  ds_write_b128 v7, v[56:59] offset:1024
  ds_write_b128 v7, v[60:63] offset:2048
  ds_write_b128 v7, v[64:67] offset:3072
  v_add_u32 v15, 98304, v13
  s_waitcnt lgkmcnt(0)
  ds_read_b64_tr_b16 v[36:37], v15 offset:0
  ds_read_b64_tr_b16 v[38:39], v15 offset:1024
  ds_read_b64_tr_b16 v[40:41], v15 offset:2048
  ds_read_b64_tr_b16 v[42:43], v15 offset:3072
  ds_read_b64_tr_b16 v[44:45], v15 offset:4096
  ds_read_b64_tr_b16 v[46:47], v15 offset:5120
  ds_read_b64_tr_b16 v[48:49], v15 offset:6144
  ds_read_b64_tr_b16 v[50:51], v15 offset:7168
  ds_read_b64_tr_b16 v[52:53], v15 offset:8192
  ds_read_b64_tr_b16 v[54:55], v15 offset:9216
  ds_read_b64_tr_b16 v[56:57], v15 offset:10240
  ds_read_b64_tr_b16 v[58:59], v15 offset:11264
  ds_read_b64_tr_b16 v[60:61], v15 offset:12288
  ds_read_b64_tr_b16 v[62:63], v15 offset:13312
  ds_read_b64_tr_b16 v[64:65], v15 offset:14336
  ds_read_b64_tr_b16 v[66:67], v15 offset:15360
  s_waitcnt vmcnt(11) lgkmcnt(0)
  s_barrier
  s_and_b32 s54, s52, 1
  s_lshl_b32 s54, s54, 13
  s_add_u32 s54, s54, 98304
  v_add_u32 v7, s54, v76
  ds_write_b128 v7, v[36:39] offset:0
  ds_write_b128 v7, v[40:43] offset:1024
  ds_write_b128 v7, v[44:47] offset:2048
  ds_write_b128 v7, v[48:51] offset:3072
  ds_write_b128 v7, v[52:55] offset:4096
  ds_write_b128 v7, v[56:59] offset:5120
  ds_write_b128 v7, v[60:63] offset:6144
  ds_write_b128 v7, v[64:67] offset:7168
  v_add_u32 v15, 114688, v14
  ds_read_b64_tr_b16 v[52:53], v15 offset:0
  ds_read_b64_tr_b16 v[54:55], v15 offset:1024
  ds_read_b64_tr_b16 v[56:57], v15 offset:4096
  ds_read_b64_tr_b16 v[58:59], v15 offset:5120
  ds_read_b64_tr_b16 v[60:61], v15 offset:8192
  ds_read_b64_tr_b16 v[62:63], v15 offset:9216
  ds_read_b64_tr_b16 v[64:65], v15 offset:12288
  ds_read_b64_tr_b16 v[66:67], v15 offset:13312
  s_waitcnt vmcnt(7) lgkmcnt(0)
  s_barrier
  s_lshl_b32 s54, s52, 12
  s_add_u32 s54, s54, 114688
  v_add_u32 v7, s54, v76
  ds_write_b128 v7, v[52:55] offset:0
  ds_write_b128 v7, v[56:59] offset:1024
  ds_write_b128 v7, v[60:63] offset:2048
  ds_write_b128 v7, v[64:67] offset:3072
  v_add_u32 v15, 131072, v14
  ds_read_b64_tr_b16 v[36:37], v15 offset:0
  ds_read_b64_tr_b16 v[38:39], v15 offset:1024
  ds_read_b64_tr_b16 v[40:41], v15 offset:4096
  ds_read_b64_tr_b16 v[42:43], v15 offset:5120
  ds_read_b64_tr_b16 v[44:45], v15 offset:8192
  ds_read_b64_tr_b16 v[46:47], v15 offset:9216
  ds_read_b64_tr_b16 v[48:49], v15 offset:12288
  ds_read_b64_tr_b16 v[50:51], v15 offset:13312
  s_waitcnt vmcnt(3) lgkmcnt(0)
  s_barrier
  s_lshl_b32 s54, s52, 12
  s_add_u32 s54, s54, 131072
  v_add_u32 v7, s54, v76
  ds_write_b128 v7, v[36:39] offset:0
  ds_write_b128 v7, v[40:43] offset:1024
  ds_write_b128 v7, v[44:47] offset:2048
  ds_write_b128 v7, v[48:51] offset:3072
  v_add_u32 v15, 147456, v14
  ds_read_b64_tr_b16 v[52:53], v15 offset:0
  ds_read_b64_tr_b16 v[54:55], v15 offset:1024
  ds_read_b64_tr_b16 v[56:57], v15 offset:4096
  ds_read_b64_tr_b16 v[58:59], v15 offset:5120
  ds_read_b64_tr_b16 v[60:61], v15 offset:8192
  ds_read_b64_tr_b16 v[62:63], v15 offset:9216
  ds_read_b64_tr_b16 v[64:65], v15 offset:12288
  ds_read_b64_tr_b16 v[66:67], v15 offset:13312
  s_waitcnt vmcnt(0) lgkmcnt(0)
  s_barrier
  s_lshl_b32 s54, s52, 12
  s_add_u32 s54, s54, 147456
  v_add_u32 v7, s54, v76
  ds_write_b128 v7, v[52:55] offset:0
  ds_write_b128 v7, v[56:59] offset:1024
  ds_write_b128 v7, v[60:63] offset:2048
  ds_write_b128 v7, v[64:67] offset:3072
  s_waitcnt lgkmcnt(0)
  s_branch C_rd1
C_rd0:
  s_sleep 2
  buffer_load_dword v21, v20, s[12:15], 0 offen sc1
  s_waitcnt vmcnt(0)
C_rd1:
  v_and_b32 v22, 0xff, v21
  v_cmp_gt_u32 vcc, 7, v22
  v_readlane_b32 s56, v21, 0
  s_mov_b32 s3, 1
  s_add_u32 s67, s67, 1
  s_cmp_ge_u32 s67, 131072
  s_cbranch_scc1 C_rd2
  s_cmp_lg_u32 vcc_hi, 0
  s_cbranch_scc1 C_rd0
  s_mov_b32 s3, 0
  s_cmp_eq_u32 s56, -1
  s_cbranch_scc1 C_rd2
  s_mov_b32 s3, 1
  v_readlane_b32 s54, v21, 10
  v_readlane_b32 s55, v21, 0
  s_nop 0
  s_bcnt1_i32_b32 s55, s55
  s_add_u32 s54, s54, s55
  v_readlane_b32 s55, v21, 1
  s_nop 0
  s_bcnt1_i32_b32 s55, s55
  s_add_u32 s54, s54, s55
  v_readlane_b32 s55, v21, 2
  s_nop 0
  s_bcnt1_i32_b32 s55, s55
  s_add_u32 s54, s54, s55
  v_readlane_b32 s55, v21, 3
  s_nop 0
  s_bcnt1_i32_b32 s55, s55
  s_add_u32 s54, s54, s55
  v_readlane_b32 s55, v21, 4
  s_nop 0
  s_bcnt1_i32_b32 s55, s55
  s_add_u32 s54, s54, s55
  v_readlane_b32 s55, v21, 5
  s_nop 0
  s_bcnt1_i32_b32 s55, s55
  s_add_u32 s54, s54, s55
  v_readlane_b32 s55, v21, 6
  s_nop 0
  s_bcnt1_i32_b32 s55, s55
  s_add_u32 s54, s54, s55
  v_readlane_b32 s55, v21, 7
  s_nop 0
  s_bcnt1_i32_b32 s55, s55
  s_add_u32 s54, s54, s55
  s_cmp_lt_u32 s54, 256
  s_cbranch_scc1 C_rd0
C_rd2:
  s_lshl_b32 s54, s3, 2
  s_add_u32 s54, s54, s52
  s_cmp_eq_u32 s54, 1
  s_cbranch_scc1 L_w1
  s_cmp_eq_u32 s54, 2
  s_cbranch_scc1 L_w2
  s_cmp_eq_u32 s54, 3
  s_cbranch_scc1 L_w3
  s_cmp_eq_u32 s54, 4
  s_cbranch_scc1 L_w4
  s_cmp_eq_u32 s54, 5
  s_cbranch_scc1 L_w5
  s_cmp_eq_u32 s54, 6
  s_cbranch_scc1 L_w6
  s_cmp_eq_u32 s54, 7
  s_cbranch_scc1 L_w7
L_w0:
  v_mov_b64 v[20:21], 0
  v_mov_b64 v[22:23], 0
  v_mov_b64 v[24:25], 0
  v_mov_b64 v[26:27], 0
  v_mov_b64 v[28:29], 0
  v_mov_b64 v[30:31], 0
  v_mov_b64 v[32:33], 0
  v_mov_b64 v[34:35], 0
  s_mov_b32 s78, 0x3f803f80
  s_mov_b32 s79, s78
  s_mov_b32 s65, 360448
  s_mov_b32 m0, 16128
  s_lshl_b32 s71, s53, 2
  s_add_u32 s71, s71, 128
  s_movk_i32 s56, 0x1000
  v_lshlrev_b32 v73, 2, v76
  v_mov_b32 v72, 0
  s_mov_b64 s[16:17], s[8:9]
  s_mov_b32 s18, 268435456
  s_mov_b32 s19, 0x20000
  s_getpc_b64 s[20:21]
Cf0_pc:
  s_add_u32 s20, s20, (Cf0_last - Cf0_pc)
  s_addc_u32 s21, s21, 0
  v_mov_b32 v68, 14880
  buffer_load_dwordx4 v[52:55], v76, s[8:11], s59 offen offset:0 sc1
  buffer_load_dwordx4 v[56:59], v76, s[8:11], s59 offen offset:1024 sc1
  ds_read_b128 v[36:39], v76 offset:16384
  ds_read_b128 v[40:43], v76 offset:17408
  ds_read_b128 v[60:63], v76 offset:18432
  ds_read_b128 v[64:67], v76 offset:19456
  ds_read_b128 v[0:3], v76 offset:4608
  ds_read_b128 v[4:7], v76 offset:5632
  ds_read_b128 v[8:11], v76 offset:6656
  ds_read_b128 v[12:15], v76 offset:7680
  s_waitcnt lgkmcnt(0)
  s_cmp_eq_u32 s66, 1
  s_branch Cf0_top2
.p2align 6
Cf0_h2:
  s_cmp_eq_u32 s66, 62
  s_cselect_b64 s[16:17], s[20:21], s[16:17]
  s_cselect_b32 s18, (Cf0_done - Cf0_last), s18
  s_cselect_b32 s70, 0, s70
  s_cmp_eq_u32 s66, 63
  s_cselect_b32 s59, 268435456, s59
  s_cselect_b32 s58, 268435456, s58
  s_cmp_eq_u32 s66, 12
  s_cselect_b32 s56, s71, 0x1000
  ds_read_b32 v72, v76 offset:16128
  s_cmp_eq_u32 s66, 13
  s_cselect_b32 s54, 0x700, 0
  s_waitcnt lgkmcnt(0)
  v_readfirstlane_b32 s57, v72
  s_nop 0
  s_cmp_lt_u32 s57, s54
  s_cbranch_scc1 Cf0_kv3
Cf0_kvb:
  buffer_load_dwordx4 v[0:3], v76, s[8:11], s65 offen offset:0 sc1
  ds_read_b128 v[36:39], v76 offset:16384
  s_waitcnt lgkmcnt(0)
  v_mov_b64 v[20:21], 0
  v_mov_b64 v[22:23], 0
  v_mov_b64 v[24:25], 0
  v_mov_b64 v[26:27], 0
  v_mov_b32 v68, 14880
  buffer_load_dwordx4 v[0:3], v76, s[8:11], s65 offen offset:0 sc1
  ds_read_b128 v[40:43], v76 offset:17408
  s_waitcnt lgkmcnt(0)
  v_mov_b64 v[28:29], 0
  v_mov_b64 v[30:31], 0
  v_mov_b64 v[32:33], 0
  v_mov_b64 v[34:35], 0
  v_lshlrev_b32 v73, 2, v76
  buffer_load_dwordx4 v[0:3], v76, s[8:11], s65 offen offset:0 sc1
  ds_read_b128 v[60:63], v76 offset:18432
  s_waitcnt lgkmcnt(0)
  buffer_load_dwordx4 v[52:55], v76, s[8:11], s59 offen offset:0 sc1
  buffer_load_dwordx4 v[56:59], v76, s[8:11], s59 offen offset:1024 sc1
  s_waitcnt vmcnt(4)
  v_max3_u32 v72, v0, v1, v2
  v_max_u32 v72, v72, v3
  ds_write_b128 v76, v[0:3] offset:4608
  v_cmp_eq_u32 vcc, -1, v72
  s_cbranch_vccnz Cf0_h2r
Cf0_h2w:
  s_cmp_eq_u32 s66, 63
  s_waitcnt lgkmcnt(0)
  s_barrier
  ds_read_b128 v[8:11], v76 offset:6656
  buffer_load_dwordx4 v76, s[8:11], s85 offen offset:0 sc1 lds
Cf0_top2:
  v_smfmac_f32_16x16x64_bf16 v[20:23], v[0:3], v[80:87], v74
  s_cbranch_scc1 Cf0_last
  v_smfmac_f32_16x16x64_bf16 v[28:31], v[0:3], v[36:43], v74
  buffer_load_dwordx4 v[44:47], v76, s[8:11], s58 offen offset:0 sc1
  s_mov_b32 m0, 16128
  v_smfmac_f32_16x16x64_bf16 v[24:27], v[0:3], v[88:95], v74
  buffer_load_dwordx4 v[48:51], v76, s[8:11], s58 offen offset:1024 sc1
  v_smfmac_f32_16x16x64_bf16 v[32:35], v[0:3], v[60:67], v74
  ds_read_b128 v[4:7], v76 offset:5632
  s_waitcnt lgkmcnt(1)
  v_smfmac_f32_16x16x64_bf16 v[20:23], v[8:11], v[112:119], v74
  ds_read_b128 v[12:15], v76 offset:7680
  v_smfmac_f32_16x16x64_bf16 v[24:27], v[8:11], v[120:127], v74
  ds_read_b128 v[36:39], v76 offset:32768
  v_smfmac_f32_16x16x64_bf16 v[28:31], v[8:11], v[208:215], v74
  buffer_store_dwordx4 v[16:19], v76, s[8:11], s68 offen sc1
  ds_read_b128 v[40:43], v76 offset:33792
  v_smfmac_f32_16x16x64_bf16 v[32:35], v[8:11], v[216:223], v74
  ds_read_b128 v[60:63], v76 offset:34816
  s_waitcnt lgkmcnt(4)
  v_smfmac_f32_16x16x64_bf16 v[20:23], v[4:7], v[96:103], v74
  ds_read_b128 v[64:67], v76 offset:35840
  v_smfmac_f32_16x16x64_bf16 v[24:27], v[4:7], v[104:111], v74
  buffer_load_dword v73, s[16:19], s70 offen lds
  s_waitcnt vmcnt(5)
  s_waitcnt lgkmcnt(4)
  v_smfmac_f32_16x16x64_bf16 v[20:23], v[12:15], v[128:135], v74
  s_barrier
  s_waitcnt lgkmcnt(2)
  v_smfmac_f32_16x16x64_bf16 v[28:31], v[4:7], v[36:43], v74
  ds_read_b128 v[0:3], v76 offset:8704
  v_smfmac_f32_16x16x64_bf16 v[24:27], v[12:15], v[136:143], v74
  ds_read_b128 v[36:39], v76 offset:49152
  s_waitcnt lgkmcnt(2)
  v_smfmac_f32_16x16x64_bf16 v[32:35], v[4:7], v[60:67], v74
  ds_read_b128 v[40:43], v76 offset:50176
  v_smfmac_f32_16x16x64_bf16 v[28:31], v[12:15], v[224:231], v74
  ds_read_b128 v[60:63], v76 offset:51200
  v_smfmac_f32_16x16x64_bf16 v[32:35], v[12:15], v[232:239], v74
  ds_read_b128 v[64:67], v76 offset:52224
  s_waitcnt lgkmcnt(4)
  v_smfmac_f32_16x16x64_bf16 v[20:23], v[0:3], v[144:151], v74
  s_waitcnt vmcnt(4)
  ds_read_b128 v[8:11], v76 offset:9728
  s_waitcnt lgkmcnt(3)
  v_smfmac_f32_16x16x64_bf16 v[28:31], v[0:3], v[36:43], v74
  s_barrier
  ds_read_b128 v[4:7], v76 offset:11776
  v_smfmac_f32_16x16x64_bf16 v[24:27], v[0:3], v[152:159], v74
  ds_read_b128 v[36:39], v75 offset:0
  ds_read_b128 v[40:43], v75 offset:1024
  s_waitcnt lgkmcnt(4)
  v_smfmac_f32_16x16x64_bf16 v[32:35], v[0:3], v[60:67], v74
  ds_read_b128 v[16:19], v76 offset:10752
  s_waitcnt lgkmcnt(4)
  v_smfmac_f32_16x16x64_bf16 v[20:23], v[8:11], v[160:167], v74
  ds_read_b128 v[12:15], v76 offset:12800
  v_smfmac_f32_16x16x64_bf16 v[24:27], v[8:11], v[168:175], v74
  ds_read_b128 v[60:63], v75 offset:2048
  ds_read_b128 v[64:67], v75 offset:3072
  s_waitcnt lgkmcnt(6)
  v_smfmac_f32_16x16x64_bf16 v[20:23], v[4:7], v[176:183], v74
  s_waitcnt lgkmcnt(3)
  v_smfmac_f32_16x16x64_bf16 v[20:23], v[16:19], v[36:43], v74
  ds_read_b128 v[36:39], v75 offset:16384
  s_waitcnt lgkmcnt(3)
  v_smfmac_f32_16x16x64_bf16 v[20:23], v[12:15], v[192:199], v74
  ds_read_b128 v[40:43], v75 offset:17408
  s_waitcnt lgkmcnt(2)
  v_smfmac_f32_16x16x64_bf16 v[24:27], v[16:19], v[60:67], v74
  ds_read_b128 v[60:63], v75 offset:18432
  v_smfmac_f32_16x16x64_bf16 v[24:27], v[4:7], v[184:191], v74
  ds_read_b128 v[64:67], v75 offset:19456
  v_add_f32 v20, v20, v22
  v_smfmac_f32_16x16x64_bf16 v[24:27], v[12:15], v[200:207], v74
  buffer_load_dword off, s[12:15], s56 sc1 lds
  v_add_f32 v21, v21, v23
  v_smfmac_f32_16x16x64_bf16 v[28:31], v[16:19], v[240:247], v74
  s_waitcnt lgkmcnt(2)
  v_mov_b64 v[70:71], s[78:79]
  v_smfmac_f32_16x16x64_bf16 v[28:31], v[8:11], v[36:43], v74
  ds_read_b128 v[36:39], v68
  v_add_f32 v24, v24, v26
  v_smfmac_f32_16x16x64_bf16 v[28:31], v[4:7], a[0:7], v74
  ds_read_b128 v[40:43], v68
  v_cvt_pk_bf16_f32 v22, v20, v24
  v_smfmac_f32_16x16x64_bf16 v[28:31], v[12:15], a[16:23], v74
  ds_write_b32 v79, v22 offset:0
  s_waitcnt lgkmcnt(3)
  v_add_f32 v25, v25, v27
  v_cvt_pk_bf16_f32 v23, v21, v25
  v_smfmac_f32_16x16x64_bf16 v[32:35], v[8:11], v[60:67], v74
  ds_write_b32 v79, v23 offset:576
  v_cmp_u_f32 vcc, v20, v21
  v_smfmac_f32_16x16x64_bf16 v[32:35], v[16:19], v[248:255], v74
  v_add_f32 v28, v28, v30
  v_smfmac_f32_16x16x64_bf16 v[32:35], v[4:7], a[8:15], v74
  v_add_f32 v29, v29, v31
  v_smfmac_f32_16x16x64_bf16 v[32:35], v[12:15], a[24:31], v74
  s_cbranch_vccnz Cf0_rec
Cf0_recok:
  s_waitcnt lgkmcnt(3)
  v_smfmac_f32_16x16x64_bf16 v[36:39], v[16:19], a[128:135], v74
  s_waitcnt lgkmcnt(0)
  s_barrier
  ds_read_b128 v[60:63], v77
  v_smfmac_f32_16x16x64_bf16 v[40:43], v[16:19], a[136:143], v74
  ds_read_b128 v[64:67], v77 offset:128
  v_add_f32 v32, v32, v34
  v_cvt_pk_bf16_f32 v30, v28, v32
  v_smfmac_f32_16x16x64_bf16 v[36:39], v[0:3], a[96:103], v74
  ds_write_b32 v79, v30 offset:256
  v_add_f32 v33, v33, v35
  v_cvt_pk_bf16_f32 v31, v29, v33
  v_smfmac_f32_16x16x64_bf16 v[40:43], v[0:3], a[104:111], v74
  ds_write_b32 v79, v31 offset:832
  v_xor_b32 v75, 0x8000, v75
  v_smfmac_f32_16x16x64_bf16 v[36:39], v[4:7], a[144:151], v74
  ds_read_b128 v[0:3], v76 offset:4608
  v_mov_b32 v29, 0
  v_smfmac_f32_16x16x64_bf16 v[40:43], v[4:7], a[152:159], v74
  s_waitcnt vmcnt(3) lgkmcnt(3)
  v_mov_b32 v30, 0
  v_mfma_f32_16x16x32_bf16 v[44:47], v[44:47], v[60:63], 0
  ds_read_b128 v[4:7], v76 offset:5632
  s_waitcnt lgkmcnt(2)
  v_mfma_f32_16x16x32_bf16 v[44:47], v[48:51], v[64:67], v[44:47]
  s_barrier
  v_smfmac_f32_16x16x64_bf16 v[36:39], v[8:11], a[112:119], v74
  ds_read_b128 v[20:23], v77 offset:256
  ds_read_b128 v[24:27], v77 offset:384
  v_smfmac_f32_16x16x64_bf16 v[40:43], v[8:11], a[120:127], v74
  ds_read_b128 v[8:11], v76 offset:6656
  v_add_f32_dpp v72, v46, v44 quad_perm:[2,3,0,1] row_mask:0xf bank_mask:0xf
  v_add_f32_dpp v73, v47, v45 quad_perm:[2,3,0,1] row_mask:0xf bank_mask:0xf
  v_smfmac_f32_16x16x64_bf16 v[36:39], v[12:15], a[160:167], v74
  s_waitcnt lgkmcnt(4)
  v_exp_f32_dpp v72, v72 quad_perm:[0,1,0,1] row_mask:0xf bank_mask:0xf
  v_smfmac_f32_16x16x64_bf16 v[40:43], v[12:15], a[168:175], v74
  ds_read_b128 v[12:15], v76 offset:7680
  v_exp_f32_dpp v73, v73 quad_perm:[0,1,0,1] row_mask:0xf bank_mask:0xf
  v_smfmac_f32_16x16x64_bf16 v[36:39], v[0:3], a[32:39], v74
  s_waitcnt lgkmcnt(2)
  v_cvt_pk_bf16_f32 v72, v72, v73
  v_mfma_f32_16x16x32_bf16 v[20:23], v[20:23], v[60:63], 0
  ds_write_b32 v78, v72 offset:512
  v_mov_b64 v[16:17], 0
  v_mfma_f32_16x16x32_bf16 v[20:23], v[24:27], v[64:67], v[20:23]
  ds_read_b128 v[44:47], v75 offset:16384
  v_mov_b64 v[18:19], 0
  v_smfmac_f32_16x16x64_bf16 v[40:43], v[0:3], a[40:47], v74
  ds_read_b128 v[48:51], v75 offset:17408
  v_mov_b64 v[68:69], s[78:79]
  v_smfmac_f32_16x16x64_bf16 v[36:39], v[4:7], a[48:55], v74
  s_waitcnt lgkmcnt(4)
  v_add_f32_dpp v24, v22, v20 quad_perm:[2,3,0,1] row_mask:0xf bank_mask:0xf
  v_add_f32_dpp v25, v23, v21 quad_perm:[2,3,0,1] row_mask:0xf bank_mask:0xf
  v_smfmac_f32_16x16x64_bf16 v[36:39], v[8:11], a[64:71], v74
  s_waitcnt lgkmcnt(2)
  s_barrier
  ds_read_b128 v[32:35], v78 offset:512
  v_smfmac_f32_16x16x64_bf16 v[36:39], v[12:15], a[80:87], v74
  ds_read_b128 v[60:63], v75 offset:18432
  v_mul_f32 v24, s69, v24
  v_smfmac_f32_16x16x64_bf16 v[40:43], v[4:7], a[56:63], v74
  ds_read_b128 v[64:67], v75 offset:19456
  v_mul_f32 v25, s69, v25
  v_smfmac_f32_16x16x64_bf16 v[40:43], v[8:11], a[72:79], v74
  v_exp_f32_dpp v24, v24 quad_perm:[0,1,0,1] row_mask:0xf bank_mask:0xf
  v_smfmac_f32_16x16x64_bf16 v[40:43], v[12:15], a[88:95], v74
  s_waitcnt lgkmcnt(2)
  v_exp_f32_dpp v25, v25 quad_perm:[0,1,0,1] row_mask:0xf bank_mask:0xf
  v_mfma_f32_16x16x32_bf16 v[8:11], v[32:35], v[68:71], 0
  v_add_f32 v36, v36, v38
  v_add_f32 v37, v37, v39
  v_mfma_f32_16x16x32_bf16 v[0:3], v[32:35], v[52:55], 0
  v_add_f32 v40, v40, v42
  v_add_f32 v41, v41, v43
  v_mfma_f32_16x16x32_bf16 v[4:7], v[32:35], v[56:59], 0
  v_cvt_pk_bf16_f32 v28, v24, v25
  v_cvt_pk_bf16_f32 v72, v36, v37
  v_cvt_pk_bf16_f32 v73, v40, v41
  v_mfma_f32_16x16x16_bf16 v[8:11], v[28:29], v[68:69], v[8:11]
  v_cvt_pk_bf16_f32 v31, v24, v25
  v_mov_b64 v[20:21], 0
  v_mfma_f32_16x16x16_bf16 v[0:3], v[28:29], v[72:73], v[0:3]
  ds_read_b128 v[68:71], v76 offset:13824
  v_mov_b64 v[22:23], 0
  v_mfma_f32_16x16x16_bf16 v[4:7], v[30:31], v[72:73], v[4:7]
  v_rcp_f32 v10, v8
  v_rcp_f32 v11, v9
  v_mul_f32 v0, v10, v0
  v_mul_f32 v1, v11, v1
  s_nop 0
  v_mul_f32 v4, v10, v4
  v_mul_f32 v5, v11, v5
  v_cvt_pk_bf16_f32 v2, v0, v4
  ds_write_b32 v79, v2 offset:8704
  v_cvt_pk_bf16_f32 v3, v1, v5
  ds_write_b32 v79, v3 offset:9280
  v_max3_f32 v8, v8, v9, v10
  v_max_f32 v8, v8, v11
  v_cmp_le_f32 vcc, 1317011456, v8
  v_mov_b64 v[24:25], 0
  v_mov_b64 v[26:27], 0
  s_cbranch_vccnz Cf0_mx
Cf0_mxok:
  s_waitcnt lgkmcnt(0)
  s_barrier
  ds_read_b128 v[0:3], v78 offset:8704
  ds_read_b128 v[4:7], v78 offset:8768
  ds_read_b128 v[8:11], v78 offset:8832
  ds_read_b128 v[12:15], v78 offset:8896
  s_waitcnt lgkmcnt(3)
  v_smfmac_f32_16x16x64_bf16 v[16:19], v[0:3], v[44:51], v74
  ds_read_b128 v[52:55], v75 offset:32768
  s_waitcnt lgkmcnt(3)
  v_smfmac_f32_16x16x64_bf16 v[16:19], v[4:7], v[60:67], v74
  ds_read_b128 v[56:59], v75 offset:33792
  s_waitcnt lgkmcnt(3)
  v_smfmac_f32_16x16x64_bf16 v[16:19], v[8:11], a[176:183], v74
  ds_read_b128 v[36:39], v75 offset:34816
  s_waitcnt lgkmcnt(3)
  v_smfmac_f32_16x16x64_bf16 v[16:19], v[12:15], a[184:191], v74
  ds_read_b128 v[40:43], v75 offset:35840
  ds_read_b128 v[44:47], v75 offset:49152
  v_smfmac_f32_16x16x64_bf16 v[20:23], v[0:3], a[192:199], v74
  ds_read_b128 v[48:51], v75 offset:50176
  ds_read_b128 v[60:63], v75 offset:51200
  v_smfmac_f32_16x16x64_bf16 v[20:23], v[4:7], a[200:207], v74
  ds_read_b128 v[64:67], v75 offset:52224
  s_waitcnt lgkmcnt(6)
  v_cvt_pk_bf16_f32 v16, v16, v17
  v_cvt_pk_bf16_f32 v17, v18, v19
  v_bfi_b32 v16, 1, s72, v16
  v_smfmac_f32_16x16x64_bf16 v[20:23], v[8:11], v[52:59], v74
  buffer_store_dwordx2 v[16:17], v68, s[8:11], s73 offen
  s_waitcnt lgkmcnt(4)
  v_smfmac_f32_16x16x64_bf16 v[20:23], v[12:15], v[36:43], v74
  v_mov_b64 v[32:33], 0
  v_smfmac_f32_16x16x64_bf16 v[24:27], v[0:3], a[208:215], v74
  v_mov_b64 v[34:35], 0
  v_smfmac_f32_16x16x64_bf16 v[24:27], v[4:7], a[216:223], v74
  s_waitcnt lgkmcnt(2)
  v_cvt_pk_bf16_f32 v20, v20, v21
  v_cvt_pk_bf16_f32 v21, v22, v23
  v_bfi_b32 v20, 1, s72, v20
  v_smfmac_f32_16x16x64_bf16 v[24:27], v[8:11], v[44:51], v74
  buffer_store_dwordx2 v[20:21], v68, s[8:11], s74 offen
  s_waitcnt lgkmcnt(0)
  v_smfmac_f32_16x16x64_bf16 v[24:27], v[12:15], v[60:67], v74
  v_smfmac_f32_16x16x64_bf16 v[32:35], v[0:3], a[224:231], v74
  v_smfmac_f32_16x16x64_bf16 v[32:35], v[4:7], a[232:239], v74
  v_cvt_pk_bf16_f32 v24, v24, v25
  v_cvt_pk_bf16_f32 v25, v26, v27
  v_bfi_b32 v24, 1, s72, v24
  v_smfmac_f32_16x16x64_bf16 v[32:35], v[8:11], a[240:247], v74
  buffer_store_dwordx2 v[24:25], v68, s[8:11], s75 offen
  v_smfmac_f32_16x16x64_bf16 v[32:35], v[12:15], a[248:255], v74
  v_mov_b64 v[18:19], v[72:73]
  s_nop 4
  v_cvt_pk_bf16_f32 v32, v32, v33
  v_cvt_pk_bf16_f32 v33, v34, v35
  v_bfi_b32 v32, 1, s72, v32
  buffer_store_dwordx2 v[32:33], v68, s[8:11], s76 offen
  ds_read_b128 v[0:3], v76 offset:14848
  s_waitcnt lgkmcnt(0)
  ds_read_b64 v[16:17], v77 offset:256
  s_waitcnt lgkmcnt(0)
  ds_read_b128 v[64:67], v76 offset:19456
  s_waitcnt lgkmcnt(0)
  v_xor_b32 v75, 0x8000, v75
  buffer_load_dwordx4 v[52:55], v76, s[8:11], s60 offen offset:0 sc1
  buffer_load_dwordx4 v[56:59], v76, s[8:11], s60 offen offset:1024 sc1
  s_add_u32 s66, s66, 1
  s_xor_b32 s64, s64, 16384
  s_xor_b32 s65, s65, 16384
  s_add_u32 s58, s58, 655360
  s_add_u32 s59, s59, 655360
  s_add_u32 s70, s70, 655360
  s_add_u32 s68, s68, 655360
  s_mov_b32 m0, 10752
  s_add_u32 s85, s65, 6144
  s_waitcnt lgkmcnt(0)
  s_waitcnt vmcnt(1)
  v_mfma_f32_16x16x32_bf16 v[4:7], v[0:3], v[52:55], 0
  v_bitop3_b32 v72, v52, v54, s72 bitop3:0x7e
  s_waitcnt vmcnt(0)
  v_mfma_f32_16x16x32_bf16 v[4:7], v[0:3], v[56:59], v[4:7]
  v_bitop3_b32 v73, v56, v58, s72 bitop3:0x7e
  v_bitop3_b32 v72, v72, v73, 1 bitop3:0xa8
  v_cmp_ne_u32 vcc, 0, v72
  s_nop 0
  s_cmp_eq_u64 vcc, 0
  s_cselect_b32 s54, s62, 268435456
  s_nop 0
  v_add_f32_dpp v4, v4, v4 row_ror:4 row_mask:0xf bank_mask:0xf
  v_add_f32_dpp v5, v5, v5 row_ror:4 row_mask:0xf bank_mask:0xf
  s_nop 0
  v_add_f32_dpp v4, v4, v4 row_ror:8 row_mask:0xf bank_mask:0xf
  v_add_f32_dpp v5, v5, v5 row_ror:8 row_mask:0xf bank_mask:0xf
  v_cvt_pk_bf16_f32 v4, v4, v5
  buffer_store_dword v4, v69, s[8:11], s54 offen
  s_cbranch_vccnz Cf0_h1r
  s_xor_b32 s62, s62, 16384
  buffer_store_dword v71, v69, s[8:11], s62 offen
  s_xor_b32 s72, s72, 1
  s_branch Cf0_h2
Cf0_h1r:
  s_mov_b64 exec, vcc
  buffer_load_dwordx4 v[52:55], v76, s[8:11], s60 offen offset:0 sc1
  buffer_load_dwordx4 v[56:59], v76, s[8:11], s60 offen offset:1024 sc1
  s_mov_b64 exec, -1
  s_add_u32 s67, s67, 1
  s_waitcnt vmcnt(1)
  v_mfma_f32_16x16x32_bf16 v[4:7], v[0:3], v[52:55], 0
  v_bitop3_b32 v72, v52, v54, s72 bitop3:0x7e
  s_waitcnt vmcnt(0)
  v_mfma_f32_16x16x32_bf16 v[4:7], v[0:3], v[56:59], v[4:7]
  v_bitop3_b32 v73, v56, v58, s72 bitop3:0x7e
  v_bitop3_b32 v72, v72, v73, 1 bitop3:0xa8
  v_cmp_ne_u32 vcc, 0, v72
  s_cbranch_vccz Cf0_h1p
Cf0_h1s:
  s_mov_b64 exec, vcc
  buffer_load_dwordx4 v[52:55], v76, s[8:11], s60 offen offset:0 sc1
  buffer_load_dwordx4 v[56:59], v76, s[8:11], s60 offen offset:1024 sc1
  s_mov_b64 exec, -1
  s_add_u32 s67, s67, 1
  s_waitcnt vmcnt(1)
  v_mfma_f32_16x16x32_bf16 v[4:7], v[0:3], v[52:55], 0
  v_bitop3_b32 v72, v52, v54, s72 bitop3:0x7e
  s_waitcnt vmcnt(0)
  v_mfma_f32_16x16x32_bf16 v[4:7], v[0:3], v[56:59], v[4:7]
  v_bitop3_b32 v73, v56, v58, s72 bitop3:0x7e
  v_bitop3_b32 v72, v72, v73, 1 bitop3:0xa8
  v_cmp_ne_u32 vcc, 0, v72
  s_cbranch_vccz Cf0_h1p
  s_cmp_lt_u32 s67, 131072
  s_cbranch_scc1 Cf0_h1s
Cf0_h1p:
  s_nop 2
  v_add_f32_dpp v4, v4, v4 row_ror:4 row_mask:0xf bank_mask:0xf
  v_add_f32_dpp v5, v5, v5 row_ror:4 row_mask:0xf bank_mask:0xf
  s_nop 0
  v_add_f32_dpp v4, v4, v4 row_ror:8 row_mask:0xf bank_mask:0xf
  v_add_f32_dpp v5, v5, v5 row_ror:8 row_mask:0xf bank_mask:0xf
  v_cvt_pk_bf16_f32 v4, v4, v5
  buffer_store_dword v4, v69, s[8:11], s62 offen
  s_xor_b32 s62, s62, 16384
  buffer_store_dword v71, v69, s[8:11], s62 offen
  s_xor_b32 s72, s72, 1
  s_branch Cf0_h2
Cf0_h2r:
  s_mov_b64 exec, vcc
  buffer_load_dwordx4 v[0:3], v76, s[8:11], s65 offen offset:0 sc1
  s_mov_b64 exec, -1
  s_add_u32 s67, s67, 1
  s_waitcnt vmcnt(4)
  v_max3_u32 v72, v0, v1, v2
  v_max_u32 v72, v72, v3
  ds_write_b128 v76, v[0:3] offset:4608
  v_cmp_eq_u32 vcc, -1, v72
  s_cbranch_vccz Cf0_h2w
  s_mov_b64 exec, vcc
  buffer_load_dwordx4 v[0:3], v76, s[8:11], s65 offen offset:0 sc1
  s_mov_b64 exec, -1
  s_add_u32 s67, s67, 1
  s_waitcnt vmcnt(4)
  v_max3_u32 v72, v0, v1, v2
  v_max_u32 v72, v72, v3
  ds_write_b128 v76, v[0:3] offset:4608
  v_cmp_eq_u32 vcc, -1, v72
  s_cbranch_vccz Cf0_h2w
Cf0_h2s:
  s_mov_b64 exec, vcc
  buffer_load_dwordx4 v[0:3], v76, s[8:11], s65 offen offset:0 sc1
  s_mov_b64 exec, -1
  s_add_u32 s67, s67, 1
  s_waitcnt vmcnt(2)
  v_max3_u32 v72, v0, v1, v2
  v_max_u32 v72, v72, v3
  ds_write_b128 v76, v[0:3] offset:4608
  v_cmp_eq_u32 vcc, -1, v72
  s_cbranch_vccz Cf0_h2w
  s_mov_b64 exec, vcc
  buffer_load_dwordx4 v[0:3], v76, s[8:11], s65 offen offset:0 sc1
  s_mov_b64 exec, -1
  s_add_u32 s67, s67, 1
  s_waitcnt vmcnt(2)
  v_max3_u32 v72, v0, v1, v2
  v_max_u32 v72, v72, v3
  ds_write_b128 v76, v[0:3] offset:4608
  v_cmp_eq_u32 vcc, -1, v72
  s_cbranch_vccz Cf0_h2w
  s_mov_b64 exec, vcc
  buffer_load_dwordx4 v[0:3], v76, s[8:11], s65 offen offset:0 sc1
  s_mov_b64 exec, -1
  s_add_u32 s67, s67, 1
  s_waitcnt vmcnt(2)
  v_max3_u32 v72, v0, v1, v2
  v_max_u32 v72, v72, v3
  ds_write_b128 v76, v[0:3] offset:4608
  v_cmp_eq_u32 vcc, -1, v72
  s_cbranch_vccz Cf0_h2w
  s_cmp_lt_u32 s67, 131072
  s_cbranch_scc1 Cf0_h2s
  s_branch Cf0_h2w
Cf0_rec:
  s_nop 7
  s_waitcnt vmcnt(0) lgkmcnt(0)
  v_max3_u32 v72, v0, v1, v2
  v_max3_u32 v72, v72, v3, v4
  v_max3_u32 v72, v72, v5, v6
  v_max3_u32 v72, v72, v7, v8
  v_max3_u32 v72, v72, v9, v10
  v_max3_u32 v72, v72, v11, v12
  v_max3_u32 v72, v72, v13, v14
  v_max3_u32 v72, v72, v15, v16
  v_max3_u32 v72, v72, v17, v18
  v_max_u32 v72, v72, v19
  v_cmp_eq_u32 vcc, -1, v72
  s_cbranch_vccz Cf0_recok
  s_barrier
  v_mov_b64 v[20:21], 0
  v_mov_b64 v[22:23], 0
  v_mov_b64 v[24:25], 0
  v_mov_b64 v[26:27], 0
  v_mov_b64 v[28:29], 0
  v_mov_b64 v[30:31], 0
  v_mov_b64 v[32:33], 0
  v_mov_b64 v[34:35], 0
  s_waitcnt lgkmcnt(0)
  s_barrier
  ds_read_b128 v[0:3], v76 offset:4608
  s_waitcnt lgkmcnt(0)
  v_smfmac_f32_16x16x64_bf16 v[20:23], v[0:3], v[80:87], v74
  v_smfmac_f32_16x16x64_bf16 v[24:27], v[0:3], v[88:95], v74
  ds_read_b128 v[60:63], v76 offset:16384
  ds_read_b128 v[64:67], v76 offset:17408
  s_waitcnt lgkmcnt(0)
  v_smfmac_f32_16x16x64_bf16 v[28:31], v[0:3], v[60:67], v74
  ds_read_b128 v[60:63], v76 offset:18432
  ds_read_b128 v[64:67], v76 offset:19456
  s_waitcnt lgkmcnt(0)
  v_smfmac_f32_16x16x64_bf16 v[32:35], v[0:3], v[60:67], v74
  ds_read_b128 v[4:7], v76 offset:5632
  s_waitcnt lgkmcnt(0)
  v_smfmac_f32_16x16x64_bf16 v[20:23], v[4:7], v[96:103], v74
  v_smfmac_f32_16x16x64_bf16 v[24:27], v[4:7], v[104:111], v74
  ds_read_b128 v[60:63], v76 offset:32768
  ds_read_b128 v[64:67], v76 offset:33792
  s_waitcnt lgkmcnt(0)
  v_smfmac_f32_16x16x64_bf16 v[28:31], v[4:7], v[60:67], v74
  ds_read_b128 v[60:63], v76 offset:34816
  ds_read_b128 v[64:67], v76 offset:35840
  s_waitcnt lgkmcnt(0)
  v_smfmac_f32_16x16x64_bf16 v[32:35], v[4:7], v[60:67], v74
  ds_read_b128 v[8:11], v76 offset:6656
  s_waitcnt lgkmcnt(0)
  v_smfmac_f32_16x16x64_bf16 v[20:23], v[8:11], v[112:119], v74
  v_smfmac_f32_16x16x64_bf16 v[24:27], v[8:11], v[120:127], v74
  v_smfmac_f32_16x16x64_bf16 v[28:31], v[8:11], v[208:215], v74
  v_smfmac_f32_16x16x64_bf16 v[32:35], v[8:11], v[216:223], v74
  ds_read_b128 v[12:15], v76 offset:7680
  s_waitcnt lgkmcnt(0)
  v_smfmac_f32_16x16x64_bf16 v[20:23], v[12:15], v[128:135], v74
  v_smfmac_f32_16x16x64_bf16 v[24:27], v[12:15], v[136:143], v74
  v_smfmac_f32_16x16x64_bf16 v[28:31], v[12:15], v[224:231], v74
  v_smfmac_f32_16x16x64_bf16 v[32:35], v[12:15], v[232:239], v74
  ds_read_b128 v[0:3], v76 offset:8704
  s_waitcnt lgkmcnt(0)
  v_smfmac_f32_16x16x64_bf16 v[20:23], v[0:3], v[144:151], v74
  v_smfmac_f32_16x16x64_bf16 v[24:27], v[0:3], v[152:159], v74
  ds_read_b128 v[60:63], v76 offset:49152
  ds_read_b128 v[64:67], v76 offset:50176
  s_waitcnt lgkmcnt(0)
  v_smfmac_f32_16x16x64_bf16 v[28:31], v[0:3], v[60:67], v74
  ds_read_b128 v[60:63], v76 offset:51200
  ds_read_b128 v[64:67], v76 offset:52224
  s_waitcnt lgkmcnt(0)
  v_smfmac_f32_16x16x64_bf16 v[32:35], v[0:3], v[60:67], v74
  ds_read_b128 v[8:11], v76 offset:9728
  s_waitcnt lgkmcnt(0)
  v_smfmac_f32_16x16x64_bf16 v[20:23], v[8:11], v[160:167], v74
  v_smfmac_f32_16x16x64_bf16 v[24:27], v[8:11], v[168:175], v74
  ds_read_b128 v[60:63], v75 offset:16384
  ds_read_b128 v[64:67], v75 offset:17408
  s_waitcnt lgkmcnt(0)
  v_smfmac_f32_16x16x64_bf16 v[28:31], v[8:11], v[60:67], v74
  ds_read_b128 v[60:63], v75 offset:18432
  ds_read_b128 v[64:67], v75 offset:19456
  s_waitcnt lgkmcnt(0)
  v_smfmac_f32_16x16x64_bf16 v[32:35], v[8:11], v[60:67], v74
  ds_read_b128 v[16:19], v76 offset:10752
  ds_read_b128 v[60:63], v75 offset:0
  ds_read_b128 v[64:67], v75 offset:1024
  s_waitcnt lgkmcnt(0)
  v_smfmac_f32_16x16x64_bf16 v[20:23], v[16:19], v[60:67], v74
  ds_read_b128 v[60:63], v75 offset:2048
  ds_read_b128 v[64:67], v75 offset:3072
  s_waitcnt lgkmcnt(0)
  v_smfmac_f32_16x16x64_bf16 v[24:27], v[16:19], v[60:67], v74
  v_smfmac_f32_16x16x64_bf16 v[28:31], v[16:19], v[240:247], v74
  v_smfmac_f32_16x16x64_bf16 v[32:35], v[16:19], v[248:255], v74
  ds_read_b128 v[4:7], v76 offset:11776
  s_waitcnt lgkmcnt(0)
  v_smfmac_f32_16x16x64_bf16 v[20:23], v[4:7], v[176:183], v74
  v_smfmac_f32_16x16x64_bf16 v[24:27], v[4:7], v[184:191], v74
  v_smfmac_f32_16x16x64_bf16 v[28:31], v[4:7], a[0:7], v74
  v_smfmac_f32_16x16x64_bf16 v[32:35], v[4:7], a[8:15], v74
  ds_read_b128 v[12:15], v76 offset:12800
  s_waitcnt lgkmcnt(0)
  v_smfmac_f32_16x16x64_bf16 v[20:23], v[12:15], v[192:199], v74
  v_smfmac_f32_16x16x64_bf16 v[24:27], v[12:15], v[200:207], v74
  v_smfmac_f32_16x16x64_bf16 v[28:31], v[12:15], a[16:23], v74
  v_smfmac_f32_16x16x64_bf16 v[32:35], v[12:15], a[24:31], v74
  v_add_f32 v20, v20, v22
  v_add_f32 v21, v21, v23
  v_add_f32 v24, v24, v26
  v_cvt_pk_bf16_f32 v22, v20, v24
  ds_write_b32 v79, v22 offset:0
  v_add_f32 v25, v25, v27
  v_cvt_pk_bf16_f32 v23, v21, v25
  ds_write_b32 v79, v23 offset:576
  v_add_f32 v28, v28, v30
  v_add_f32 v29, v29, v31
  s_waitcnt lgkmcnt(0)
  s_nop 1
  s_branch Cf0_recok
Cf0_mx:
  s_waitcnt lgkmcnt(0)
  s_barrier
  buffer_load_dwordx4 v[0:3], v76, s[8:11], s58 offen offset:0 sc1
  ds_read_b128 v[20:23], v77 offset:0
  ds_read_b128 v[28:31], v77 offset:256
  buffer_load_dwordx4 v[4:7], v76, s[8:11], s58 offen offset:1024 sc1
  ds_read_b128 v[24:27], v77 offset:128
  ds_read_b128 v[32:35], v77 offset:384
  s_waitcnt vmcnt(1) lgkmcnt(3)
  v_mfma_f32_16x16x32_bf16 v[8:11], v[0:3], v[20:23], 0
  s_waitcnt vmcnt(0) lgkmcnt(1)
  v_mfma_f32_16x16x32_bf16 v[8:11], v[4:7], v[24:27], v[8:11]
  v_mfma_f32_16x16x32_bf16 v[12:15], v[28:31], v[20:23], 0
  s_waitcnt lgkmcnt(0)
  v_mfma_f32_16x16x32_bf16 v[12:15], v[32:35], v[24:27], v[12:15]
  v_add_f32_dpp v8, v10, v8 quad_perm:[2,3,0,1] row_mask:0xf bank_mask:0xf
  v_add_f32_dpp v9, v11, v9 quad_perm:[2,3,0,1] row_mask:0xf bank_mask:0xf
  s_nop 0
  v_mov_b32_dpp v8, v8 quad_perm:[0,1,0,1] row_mask:0xf bank_mask:0xf
  v_mov_b32_dpp v9, v9 quad_perm:[0,1,0,1] row_mask:0xf bank_mask:0xf
  s_nop 1
  v_add_f32_dpp v12, v14, v12 quad_perm:[2,3,0,1] row_mask:0xf bank_mask:0xf
  v_add_f32_dpp v13, v15, v13 quad_perm:[2,3,0,1] row_mask:0xf bank_mask:0xf
  s_nop 0
  v_mov_b32_dpp v12, v12 quad_perm:[0,1,0,1] row_mask:0xf bank_mask:0xf
  v_mov_b32_dpp v13, v13 quad_perm:[0,1,0,1] row_mask:0xf bank_mask:0xf
  v_mul_f32 v12, s69, v12
  ds_write_b32 v78, v8 offset:8704
  v_mul_f32 v13, s69, v13
  ds_write_b32 v78, v9 offset:8768
  s_waitcnt lgkmcnt(0)
  s_barrier
  ds_read_b128 v[36:39], v78 offset:8704
  ds_read_b128 v[40:43], v78 offset:8768
  s_waitcnt lgkmcnt(0)
  s_barrier
  v_max_f32 v16, v36, v37
  v_max3_f32 v16, v16, v38, v39
  v_max3_f32 v16, v16, v40, v41
  v_max3_f32 v16, v16, v42, v43
  v_max3_f32 v16, v16, v12, v13
  v_mov_b32 v17, v16
  s_nop 1
  v_permlane16_swap_b32 v16, v17
  v_max_f32 v16, v16, v17
  v_mov_b32 v17, v16
  s_nop 1
  v_permlane32_swap_b32 v16, v17
  v_max_f32 v16, v16, v17
  v_sub_f32 v36, v36, v16
  v_sub_f32 v37, v37, v16
  v_sub_f32 v38, v38, v16
  v_sub_f32 v39, v39, v16
  v_sub_f32 v40, v40, v16
  v_sub_f32 v41, v41, v16
  v_sub_f32 v42, v42, v16
  v_sub_f32 v43, v43, v16
  v_sub_f32 v12, v12, v16
  v_sub_f32 v13, v13, v16
  v_exp_f32 v36, v36
  v_exp_f32 v37, v37
  v_exp_f32 v38, v38
  v_exp_f32 v39, v39
  v_exp_f32 v40, v40
  v_exp_f32 v41, v41
  v_exp_f32 v42, v42
  v_exp_f32 v43, v43
  v_exp_f32 v12, v12
  v_exp_f32 v13, v13
  v_cvt_pk_bf16_f32 v32, v36, v40
  v_cvt_pk_bf16_f32 v33, v37, v41
  v_cvt_pk_bf16_f32 v34, v38, v42
  v_cvt_pk_bf16_f32 v35, v39, v43
  v_cvt_pk_bf16_f32 v28, v12, v13
  v_cvt_pk_bf16_f32 v31, v12, v13
  v_mov_b32 v29, 0
  v_mov_b32 v30, 0
  v_mov_b32 v68, 0x3f803f80
  v_mov_b32 v69, 0x3f803f80
  v_mov_b32 v70, 0x3f803f80
  v_mov_b32 v71, 0x3f803f80
  s_nop 1
  v_mfma_f32_16x16x32_bf16 v[8:11], v[32:35], v[68:71], 0
  v_mfma_f32_16x16x32_bf16 v[0:3], v[32:35], v[52:55], 0
  v_mfma_f32_16x16x32_bf16 v[4:7], v[32:35], v[56:59], 0
  v_mfma_f32_16x16x16_bf16 v[8:11], v[28:29], v[68:69], v[8:11]
  v_mfma_f32_16x16x16_bf16 v[0:3], v[28:29], v[72:73], v[0:3]
  v_mfma_f32_16x16x16_bf16 v[4:7], v[30:31], v[72:73], v[4:7]
  ds_read_b128 v[68:71], v76 offset:13824
  v_rcp_f32 v10, v8
  v_rcp_f32 v11, v9
  v_mul_f32 v0, v10, v0
  v_mul_f32 v1, v11, v1
  s_nop 0
  v_mul_f32 v4, v10, v4
  v_mul_f32 v5, v11, v5
  v_cvt_pk_bf16_f32 v2, v0, v4
  ds_write_b32 v79, v2 offset:8704
  v_cvt_pk_bf16_f32 v3, v1, v5
  ds_write_b32 v79, v3 offset:9280
  v_mov_b64 v[16:17], 0
  v_mov_b64 v[18:19], 0
  v_mov_b64 v[20:21], 0
  v_mov_b64 v[22:23], 0
  v_mov_b64 v[24:25], 0
  v_mov_b64 v[26:27], 0
  s_branch Cf0_mxok
Cf0_kv3:
  s_waitcnt lgkmcnt(0)
  s_cmp_ge_u32 s57, 0x700
  s_cbranch_scc1 Cf0_kvb
  s_load_dword s57, s[12:13], s71 glc
  s_add_u32 s67, s67, 1
  s_cmp_lt_u32 s67, 131072
  s_cbranch_scc1 Cf0_kv3
  s_waitcnt lgkmcnt(0)
  s_branch Cf0_kvb
Cf0_last:
  ds_read_b128 v[4:7], v76 offset:5632
  ds_read_b128 v[12:15], v76 offset:7680
  ds_read_b128 v[44:47], v76 offset:32768
  ds_read_b128 v[48:51], v76 offset:33792
  s_nop 5
  v_mov_b64 v[20:21], 0
  v_mov_b64 v[22:23], 0
  v_mov_b64 v[24:25], 0
  v_mov_b64 v[26:27], 0
  v_smfmac_f32_16x16x64_bf16 v[28:31], v[0:3], v[36:43], v74
  ds_read_b128 v[36:39], v76 offset:34816
  ds_read_b128 v[40:43], v76 offset:35840
  v_smfmac_f32_16x16x64_bf16 v[32:35], v[0:3], v[60:67], v74
  s_waitcnt lgkmcnt(5)
  v_smfmac_f32_16x16x64_bf16 v[20:23], v[0:3], a[32:39], v74
  ds_read_b128 v[60:63], v76 offset:49152
  ds_read_b128 v[64:67], v76 offset:50176
  v_smfmac_f32_16x16x64_bf16 v[24:27], v[0:3], a[40:47], v74
  s_waitcnt lgkmcnt(4)
  v_smfmac_f32_16x16x64_bf16 v[20:23], v[4:7], a[48:55], v74
  buffer_store_dwordx4 v[16:19], v76, s[8:11], s68 offen sc1
  v_smfmac_f32_16x16x64_bf16 v[24:27], v[4:7], a[56:63], v74
  v_smfmac_f32_16x16x64_bf16 v[28:31], v[4:7], v[44:51], v74
  s_waitcnt lgkmcnt(2)
  v_smfmac_f32_16x16x64_bf16 v[20:23], v[8:11], a[64:71], v74
  ds_read_b128 v[44:47], v76 offset:51200
  ds_read_b128 v[48:51], v76 offset:52224
  v_smfmac_f32_16x16x64_bf16 v[24:27], v[8:11], a[72:79], v74
  v_smfmac_f32_16x16x64_bf16 v[32:35], v[4:7], v[36:43], v74
  v_smfmac_f32_16x16x64_bf16 v[28:31], v[8:11], v[208:215], v74
  ds_read_b128 v[36:39], v75 offset:16384
  ds_read_b128 v[40:43], v75 offset:17408
  v_smfmac_f32_16x16x64_bf16 v[32:35], v[8:11], v[216:223], v74
  v_smfmac_f32_16x16x64_bf16 v[20:23], v[12:15], a[80:87], v74
  v_smfmac_f32_16x16x64_bf16 v[24:27], v[12:15], a[88:95], v74
  v_smfmac_f32_16x16x64_bf16 v[28:31], v[12:15], v[224:231], v74
  v_smfmac_f32_16x16x64_bf16 v[32:35], v[12:15], v[232:239], v74
  s_waitcnt vmcnt(2)
  s_waitcnt vmcnt(1)
  s_barrier
Cf0_lastr:
  ds_read_b128 v[0:3], v76 offset:8704
  ds_read_b128 v[8:11], v76 offset:9728
  ds_read_b128 v[16:19], v76 offset:10752
  ds_read_b128 v[4:7], v76 offset:11776
  ds_read_b128 v[12:15], v76 offset:12800
  s_waitcnt lgkmcnt(4)
  v_max3_u32 v72, v0, v1, v2
  s_waitcnt lgkmcnt(1)
  v_max3_u32 v72, v72, v3, v4
  v_max3_u32 v72, v72, v5, v6
  v_max3_u32 v72, v72, v7, v8
  v_max3_u32 v72, v72, v9, v10
  s_waitcnt lgkmcnt(0)
  v_max3_u32 v72, v72, v11, v12
  v_max3_u32 v72, v72, v13, v14
  v_max3_u32 v72, v72, v15, v16
  v_max3_u32 v72, v72, v17, v18
  v_max_u32 v72, v72, v19
  v_cmp_eq_u32 vcc, -1, v72
  s_cbranch_vccnz Cf0_lastp
Cf0_lastg:
  v_smfmac_f32_16x16x64_bf16 v[28:31], v[0:3], v[60:67], v74
  ds_read_b128 v[60:63], v75 offset:18432
  ds_read_b128 v[64:67], v75 offset:19456
  v_smfmac_f32_16x16x64_bf16 v[32:35], v[0:3], v[44:51], v74
  v_smfmac_f32_16x16x64_bf16 v[28:31], v[8:11], v[36:43], v74
  v_smfmac_f32_16x16x64_bf16 v[28:31], v[16:19], v[240:247], v74
  v_smfmac_f32_16x16x64_bf16 v[28:31], v[4:7], a[0:7], v74
  v_smfmac_f32_16x16x64_bf16 v[28:31], v[12:15], a[16:23], v74
  v_smfmac_f32_16x16x64_bf16 v[32:35], v[16:19], v[248:255], v74
  v_smfmac_f32_16x16x64_bf16 v[32:35], v[4:7], a[8:15], v74
  s_waitcnt lgkmcnt(0)
  v_smfmac_f32_16x16x64_bf16 v[32:35], v[12:15], a[24:31], v74
  v_smfmac_f32_16x16x64_bf16 v[32:35], v[8:11], v[60:67], v74
  v_smfmac_f32_16x16x64_bf16 v[20:23], v[0:3], a[96:103], v74
  v_smfmac_f32_16x16x64_bf16 v[20:23], v[8:11], a[112:119], v74
  v_add_f32 v28, v28, v30
  v_add_f32 v32, v32, v34
  v_cvt_pk_bf16_f32 v30, v28, v32
  v_smfmac_f32_16x16x64_bf16 v[20:23], v[16:19], a[128:135], v74
  ds_write_b32 v79, v30 offset:256
  v_add_f32 v29, v29, v31
  v_add_f32 v33, v33, v35
  v_cvt_pk_bf16_f32 v31, v29, v33
  v_smfmac_f32_16x16x64_bf16 v[20:23], v[4:7], a[144:151], v74
  ds_write_b32 v79, v31 offset:832
  v_smfmac_f32_16x16x64_bf16 v[20:23], v[12:15], a[160:167], v74
  v_smfmac_f32_16x16x64_bf16 v[24:27], v[0:3], a[104:111], v74
  v_smfmac_f32_16x16x64_bf16 v[24:27], v[8:11], a[120:127], v74
  v_smfmac_f32_16x16x64_bf16 v[24:27], v[16:19], a[136:143], v74
  s_waitcnt lgkmcnt(0)
  s_barrier
  ds_read_b64 v[52:53], v77 offset:256
  v_add_f32 v20, v20, v22
  v_smfmac_f32_16x16x64_bf16 v[24:27], v[4:7], a[152:159], v74
  v_add_f32 v21, v21, v23
  v_smfmac_f32_16x16x64_bf16 v[24:27], v[12:15], a[168:175], v74
  v_cvt_pk_bf16_f32 v54, v20, v21
  s_add_u32 s68, s68, 655360
  s_nop 3
  v_add_f32 v24, v24, v26
  v_add_f32 v25, v25, v27
  v_cvt_pk_bf16_f32 v55, v24, v25
  s_waitcnt lgkmcnt(0)
  buffer_store_dwordx4 v[52:55], v76, s[8:11], s68 offen sc1
  s_branch Cf0_done
Cf0_lastp:
  s_add_u32 s72, s72, 2
  s_cmp_ge_u32 s72, 131072
  s_cbranch_scc1 Cf0_lastg
  s_barrier
  buffer_load_dwordx4 v76, s[8:11], s85 offen offset:0 sc1 lds
  s_waitcnt vmcnt(0)
  s_barrier
  s_branch Cf0_lastr
Cf0_done:
  s_branch L_cexit
L_w1:
  v_mov_b64 v[20:21], 0
  v_mov_b64 v[22:23], 0
  v_mov_b64 v[24:25], 0
  v_mov_b64 v[26:27], 0
  v_mov_b64 v[28:29], 0
  v_mov_b64 v[30:31], 0
  v_mov_b64 v[32:33], 0
  v_mov_b64 v[34:35], 0
  s_mov_b32 s78, 0x3f803f80
  s_mov_b32 s79, s78
  s_mov_b32 s65, 360448
  s_mov_b32 m0, 15872
  s_lshl_b32 s71, s53, 2
  s_add_u32 s71, s71, 128
  s_movk_i32 s56, 0x1000
  v_lshlrev_b32 v73, 2, v76
  v_mov_b32 v72, 0
  s_mov_b64 s[16:17], s[8:9]
  s_mov_b32 s18, 268435456
  s_mov_b32 s19, 0x20000
  s_getpc_b64 s[20:21]
Cf1_pc:
  s_add_u32 s20, s20, (Cf1_last - Cf1_pc)
  s_addc_u32 s21, s21, 0
  v_mov_b32 v68, 14880
  buffer_load_dwordx4 v[52:55], v76, s[8:11], s59 offen offset:0 sc1
  buffer_load_dwordx4 v[56:59], v76, s[8:11], s59 offen offset:1024 sc1
  ds_read_b128 v[36:39], v76 offset:20480
  ds_read_b128 v[40:43], v76 offset:21504
  ds_read_b128 v[60:63], v76 offset:22528
  ds_read_b128 v[64:67], v76 offset:23552
  ds_read_b128 v[0:3], v76 offset:4608
  ds_read_b128 v[4:7], v76 offset:5632
  ds_read_b128 v[8:11], v76 offset:6656
  ds_read_b128 v[12:15], v76 offset:7680
  s_waitcnt lgkmcnt(0)
  s_cmp_eq_u32 s66, 1
  s_branch Cf1_top2
.p2align 6
Cf1_h2:
  ds_read_b128 v[36:39], v76 offset:20480
  s_waitcnt lgkmcnt(0)
  s_cmp_eq_u32 s66, 62
  s_cselect_b64 s[16:17], s[20:21], s[16:17]
  s_cselect_b32 s18, (Cf1_done - Cf1_last), s18
  s_cselect_b32 s70, 0, s70
  s_cmp_eq_u32 s66, 63
  s_cselect_b32 s59, 268435456, s59
  s_cselect_b32 s58, 268435456, s58
  buffer_load_dwordx4 v[8:11], v76, s[8:11], s65 offen offset:2048 sc1
  ds_read_b128 v[40:43], v76 offset:21504
  s_waitcnt lgkmcnt(0)
  v_mov_b64 v[20:21], 0
  v_mov_b64 v[22:23], 0
  v_mov_b64 v[24:25], 0
  v_mov_b64 v[26:27], 0
  v_mov_b32 v68, 14880
  buffer_load_dwordx4 v[8:11], v76, s[8:11], s65 offen offset:2048 sc1
  ds_read_b128 v[60:63], v76 offset:22528
  s_waitcnt lgkmcnt(0)
  v_mov_b64 v[28:29], 0
  v_mov_b64 v[30:31], 0
  v_mov_b64 v[32:33], 0
  v_mov_b64 v[34:35], 0
  v_lshlrev_b32 v73, 2, v76
  buffer_load_dwordx4 v[8:11], v76, s[8:11], s65 offen offset:2048 sc1
  buffer_load_dwordx4 v[52:55], v76, s[8:11], s59 offen offset:0 sc1
  buffer_load_dwordx4 v[56:59], v76, s[8:11], s59 offen offset:1024 sc1
  s_waitcnt vmcnt(4)
  v_max3_u32 v72, v8, v9, v10
  v_max_u32 v72, v72, v11
  ds_write_b128 v76, v[8:11] offset:6656
  v_cmp_eq_u32 vcc, -1, v72
  s_cbranch_vccnz Cf1_h2r
Cf1_h2w:
  s_cmp_eq_u32 s66, 63
  s_waitcnt lgkmcnt(0)
  s_barrier
  ds_read_b128 v[0:3], v76 offset:4608
  buffer_load_dwordx4 v76, s[8:11], s85 offen offset:0 sc1 lds
Cf1_top2:
  v_smfmac_f32_16x16x64_bf16 v[20:23], v[8:11], v[112:119], v74
  s_cbranch_scc1 Cf1_last
  v_smfmac_f32_16x16x64_bf16 v[24:27], v[8:11], v[120:127], v74
  buffer_load_dwordx4 v[44:47], v76, s[8:11], s58 offen offset:0 sc1
  s_mov_b32 m0, 15872
  v_smfmac_f32_16x16x64_bf16 v[28:31], v[8:11], v[208:215], v74
  buffer_load_dwordx4 v[48:51], v76, s[8:11], s58 offen offset:1024 sc1
  v_smfmac_f32_16x16x64_bf16 v[32:35], v[8:11], v[216:223], v74
  ds_read_b128 v[4:7], v76 offset:5632
  s_waitcnt lgkmcnt(1)
  v_smfmac_f32_16x16x64_bf16 v[20:23], v[0:3], v[80:87], v74
  ds_read_b128 v[12:15], v76 offset:7680
  v_smfmac_f32_16x16x64_bf16 v[28:31], v[0:3], v[36:43], v74
  ds_read_b128 v[36:39], v76 offset:36864
  v_smfmac_f32_16x16x64_bf16 v[24:27], v[0:3], v[88:95], v74
  buffer_store_dwordx4 v[16:19], v76, s[8:11], s68 offen sc1
  ds_read_b128 v[40:43], v76 offset:37888
  v_smfmac_f32_16x16x64_bf16 v[32:35], v[0:3], v[60:67], v74
  ds_read_b128 v[60:63], v76 offset:38912
  s_waitcnt lgkmcnt(4)
  v_smfmac_f32_16x16x64_bf16 v[20:23], v[4:7], v[96:103], v74
  ds_read_b128 v[64:67], v76 offset:39936
  v_smfmac_f32_16x16x64_bf16 v[24:27], v[4:7], v[104:111], v74
  buffer_load_dword v73, s[16:19], s70 offen lds
  s_waitcnt vmcnt(5)
  s_waitcnt lgkmcnt(4)
  v_smfmac_f32_16x16x64_bf16 v[20:23], v[12:15], v[128:135], v74
  s_barrier
  s_waitcnt lgkmcnt(2)
  v_smfmac_f32_16x16x64_bf16 v[28:31], v[4:7], v[36:43], v74
  ds_read_b128 v[8:11], v76 offset:8704
  v_smfmac_f32_16x16x64_bf16 v[24:27], v[12:15], v[136:143], v74
  ds_read_b128 v[36:39], v76 offset:53248
  s_waitcnt lgkmcnt(2)
  v_smfmac_f32_16x16x64_bf16 v[32:35], v[4:7], v[60:67], v74
  ds_read_b128 v[40:43], v76 offset:54272
  v_smfmac_f32_16x16x64_bf16 v[28:31], v[12:15], v[224:231], v74
  ds_read_b128 v[60:63], v76 offset:55296
  v_smfmac_f32_16x16x64_bf16 v[32:35], v[12:15], v[232:239], v74
  ds_read_b128 v[64:67], v76 offset:56320
  s_waitcnt lgkmcnt(4)
  v_smfmac_f32_16x16x64_bf16 v[20:23], v[8:11], v[144:151], v74
  s_waitcnt vmcnt(4)
  ds_read_b128 v[0:3], v76 offset:9728
  s_waitcnt lgkmcnt(3)
  v_smfmac_f32_16x16x64_bf16 v[28:31], v[8:11], v[36:43], v74
  s_barrier
  ds_read_b128 v[4:7], v76 offset:11776
  v_smfmac_f32_16x16x64_bf16 v[24:27], v[8:11], v[152:159], v74
  ds_read_b128 v[36:39], v75 offset:4096
  ds_read_b128 v[40:43], v75 offset:5120
  s_waitcnt lgkmcnt(4)
  v_smfmac_f32_16x16x64_bf16 v[32:35], v[8:11], v[60:67], v74
  ds_read_b128 v[16:19], v76 offset:10752
  s_waitcnt lgkmcnt(4)
  v_smfmac_f32_16x16x64_bf16 v[20:23], v[0:3], v[160:167], v74
  ds_read_b128 v[12:15], v76 offset:12800
  v_smfmac_f32_16x16x64_bf16 v[24:27], v[0:3], v[168:175], v74
  ds_read_b128 v[60:63], v75 offset:6144
  ds_read_b128 v[64:67], v75 offset:7168
  s_waitcnt lgkmcnt(6)
  v_smfmac_f32_16x16x64_bf16 v[20:23], v[4:7], v[176:183], v74
  s_waitcnt lgkmcnt(3)
  v_smfmac_f32_16x16x64_bf16 v[20:23], v[16:19], v[36:43], v74
  ds_read_b128 v[36:39], v75 offset:20480
  s_waitcnt lgkmcnt(3)
  v_smfmac_f32_16x16x64_bf16 v[20:23], v[12:15], v[192:199], v74
  ds_read_b128 v[40:43], v75 offset:21504
  s_waitcnt lgkmcnt(2)
  v_smfmac_f32_16x16x64_bf16 v[24:27], v[16:19], v[60:67], v74
  ds_read_b128 v[60:63], v75 offset:22528
  v_smfmac_f32_16x16x64_bf16 v[24:27], v[4:7], v[184:191], v74
  ds_read_b128 v[64:67], v75 offset:23552
  v_add_f32 v20, v20, v22
  v_smfmac_f32_16x16x64_bf16 v[24:27], v[12:15], v[200:207], v74
  v_add_f32 v21, v21, v23
  v_smfmac_f32_16x16x64_bf16 v[28:31], v[16:19], v[240:247], v74
  s_waitcnt lgkmcnt(2)
  v_mov_b64 v[70:71], s[78:79]
  v_smfmac_f32_16x16x64_bf16 v[28:31], v[0:3], v[36:43], v74
  ds_read_b128 v[36:39], v68
  v_add_f32 v24, v24, v26
  v_smfmac_f32_16x16x64_bf16 v[28:31], v[4:7], a[0:7], v74
  ds_read_b128 v[40:43], v68
  v_cvt_pk_bf16_f32 v22, v20, v24
  v_smfmac_f32_16x16x64_bf16 v[28:31], v[12:15], a[16:23], v74
  ds_write_b32 v79, v22 offset:0
  s_waitcnt lgkmcnt(3)
  v_add_f32 v25, v25, v27
  v_cvt_pk_bf16_f32 v23, v21, v25
  v_smfmac_f32_16x16x64_bf16 v[32:35], v[0:3], v[60:67], v74
  ds_write_b32 v79, v23 offset:576
  v_cmp_u_f32 vcc, v20, v21
  v_smfmac_f32_16x16x64_bf16 v[32:35], v[16:19], v[248:255], v74
  v_add_f32 v28, v28, v30
  v_smfmac_f32_16x16x64_bf16 v[32:35], v[4:7], a[8:15], v74
  v_add_f32 v29, v29, v31
  v_smfmac_f32_16x16x64_bf16 v[32:35], v[12:15], a[24:31], v74
  s_cbranch_vccnz Cf1_rec
Cf1_recok:
  s_waitcnt lgkmcnt(3)
  v_smfmac_f32_16x16x64_bf16 v[36:39], v[16:19], a[128:135], v74
  s_waitcnt lgkmcnt(0)
  s_barrier
  ds_read_b128 v[60:63], v77
  v_smfmac_f32_16x16x64_bf16 v[40:43], v[16:19], a[136:143], v74
  ds_read_b128 v[64:67], v77 offset:128
  v_add_f32 v32, v32, v34
  v_cvt_pk_bf16_f32 v30, v28, v32
  v_smfmac_f32_16x16x64_bf16 v[36:39], v[0:3], a[112:119], v74
  ds_write_b32 v79, v30 offset:256
  v_add_f32 v33, v33, v35
  v_cvt_pk_bf16_f32 v31, v29, v33
  v_smfmac_f32_16x16x64_bf16 v[40:43], v[0:3], a[120:127], v74
  ds_write_b32 v79, v31 offset:832
  v_xor_b32 v75, 0x8000, v75
  v_smfmac_f32_16x16x64_bf16 v[36:39], v[4:7], a[144:151], v74
  ds_read_b128 v[0:3], v76 offset:4608
  v_mov_b32 v29, 0
  v_smfmac_f32_16x16x64_bf16 v[40:43], v[4:7], a[152:159], v74
  s_waitcnt vmcnt(2) lgkmcnt(3)
  v_mov_b32 v30, 0
  v_mfma_f32_16x16x32_bf16 v[44:47], v[44:47], v[60:63], 0
  ds_read_b128 v[4:7], v76 offset:5632
  s_waitcnt lgkmcnt(2)
  v_mfma_f32_16x16x32_bf16 v[44:47], v[48:51], v[64:67], v[44:47]
  s_barrier
  v_smfmac_f32_16x16x64_bf16 v[36:39], v[8:11], a[96:103], v74
  ds_read_b128 v[20:23], v77 offset:256
  ds_read_b128 v[24:27], v77 offset:384
  v_smfmac_f32_16x16x64_bf16 v[40:43], v[8:11], a[104:111], v74
  ds_read_b128 v[8:11], v76 offset:6656
  v_add_f32_dpp v72, v46, v44 quad_perm:[2,3,0,1] row_mask:0xf bank_mask:0xf
  v_add_f32_dpp v73, v47, v45 quad_perm:[2,3,0,1] row_mask:0xf bank_mask:0xf
  v_smfmac_f32_16x16x64_bf16 v[36:39], v[12:15], a[160:167], v74
  s_waitcnt lgkmcnt(4)
  v_exp_f32_dpp v72, v72 quad_perm:[0,1,0,1] row_mask:0xf bank_mask:0xf
  v_smfmac_f32_16x16x64_bf16 v[40:43], v[12:15], a[168:175], v74
  ds_read_b128 v[12:15], v76 offset:7680
  v_exp_f32_dpp v73, v73 quad_perm:[0,1,0,1] row_mask:0xf bank_mask:0xf
  v_smfmac_f32_16x16x64_bf16 v[36:39], v[0:3], a[32:39], v74
  s_waitcnt lgkmcnt(2)
  v_cvt_pk_bf16_f32 v72, v72, v73
  v_mfma_f32_16x16x32_bf16 v[20:23], v[20:23], v[60:63], 0
  ds_write_b32 v78, v72 offset:516
  v_mov_b64 v[16:17], 0
  v_mfma_f32_16x16x32_bf16 v[20:23], v[24:27], v[64:67], v[20:23]
  ds_read_b128 v[44:47], v75 offset:20480
  v_mov_b64 v[18:19], 0
  v_smfmac_f32_16x16x64_bf16 v[40:43], v[0:3], a[40:47], v74
  ds_read_b128 v[48:51], v75 offset:21504
  v_mov_b64 v[68:69], s[78:79]
  v_smfmac_f32_16x16x64_bf16 v[36:39], v[4:7], a[48:55], v74
  s_waitcnt lgkmcnt(4)
  v_add_f32_dpp v24, v22, v20 quad_perm:[2,3,0,1] row_mask:0xf bank_mask:0xf
  v_add_f32_dpp v25, v23, v21 quad_perm:[2,3,0,1] row_mask:0xf bank_mask:0xf
  v_smfmac_f32_16x16x64_bf16 v[36:39], v[8:11], a[64:71], v74
  s_waitcnt lgkmcnt(2)
  s_barrier
  ds_read_b128 v[32:35], v78 offset:512
  v_smfmac_f32_16x16x64_bf16 v[36:39], v[12:15], a[80:87], v74
  ds_read_b128 v[60:63], v75 offset:22528
  v_mul_f32 v24, s69, v24
  v_smfmac_f32_16x16x64_bf16 v[40:43], v[4:7], a[56:63], v74
  ds_read_b128 v[64:67], v75 offset:23552
  v_mul_f32 v25, s69, v25
  v_smfmac_f32_16x16x64_bf16 v[40:43], v[8:11], a[72:79], v74
  v_exp_f32_dpp v24, v24 quad_perm:[0,1,0,1] row_mask:0xf bank_mask:0xf
  v_smfmac_f32_16x16x64_bf16 v[40:43], v[12:15], a[88:95], v74
  s_waitcnt lgkmcnt(2)
  v_exp_f32_dpp v25, v25 quad_perm:[0,1,0,1] row_mask:0xf bank_mask:0xf
  v_mfma_f32_16x16x32_bf16 v[8:11], v[32:35], v[68:71], 0
  v_add_f32 v36, v36, v38
  v_add_f32 v37, v37, v39
  v_mfma_f32_16x16x32_bf16 v[0:3], v[32:35], v[52:55], 0
  v_add_f32 v40, v40, v42
  v_add_f32 v41, v41, v43
  v_mfma_f32_16x16x32_bf16 v[4:7], v[32:35], v[56:59], 0
  v_cvt_pk_bf16_f32 v28, v24, v25
  v_cvt_pk_bf16_f32 v72, v36, v37
  v_cvt_pk_bf16_f32 v73, v40, v41
  v_mfma_f32_16x16x16_bf16 v[8:11], v[28:29], v[68:69], v[8:11]
  v_cvt_pk_bf16_f32 v31, v24, v25
  v_mov_b64 v[20:21], 0
  v_mfma_f32_16x16x16_bf16 v[0:3], v[28:29], v[72:73], v[0:3]
  ds_read_b128 v[68:71], v76 offset:13824
  v_mov_b64 v[22:23], 0
  v_mfma_f32_16x16x16_bf16 v[4:7], v[30:31], v[72:73], v[4:7]
  v_rcp_f32 v10, v8
  v_rcp_f32 v11, v9
  v_mul_f32 v0, v10, v0
  v_mul_f32 v1, v11, v1
  s_nop 0
  v_mul_f32 v4, v10, v4
  v_mul_f32 v5, v11, v5
  v_cvt_pk_bf16_f32 v2, v0, v4
  ds_write_b32 v79, v2 offset:8704
  v_cvt_pk_bf16_f32 v3, v1, v5
  ds_write_b32 v79, v3 offset:9280
  v_max3_f32 v8, v8, v9, v10
  v_max_f32 v8, v8, v11
  v_cmp_le_f32 vcc, 1317011456, v8
  v_mov_b64 v[24:25], 0
  v_mov_b64 v[26:27], 0
  s_cbranch_vccnz Cf1_mx
Cf1_mxok:
  s_waitcnt lgkmcnt(0)
  s_barrier
  ds_read_b128 v[0:3], v78 offset:8704
  ds_read_b128 v[4:7], v78 offset:8768
  ds_read_b128 v[8:11], v78 offset:8832
  ds_read_b128 v[12:15], v78 offset:8896
  s_waitcnt lgkmcnt(3)
  v_smfmac_f32_16x16x64_bf16 v[16:19], v[0:3], v[44:51], v74
  ds_read_b128 v[52:55], v75 offset:36864
  s_waitcnt lgkmcnt(3)
  v_smfmac_f32_16x16x64_bf16 v[16:19], v[4:7], v[60:67], v74
  ds_read_b128 v[56:59], v75 offset:37888
  s_waitcnt lgkmcnt(3)
  v_smfmac_f32_16x16x64_bf16 v[16:19], v[8:11], a[176:183], v74
  ds_read_b128 v[36:39], v75 offset:38912
  s_waitcnt lgkmcnt(3)
  v_smfmac_f32_16x16x64_bf16 v[16:19], v[12:15], a[184:191], v74
  ds_read_b128 v[40:43], v75 offset:39936
  ds_read_b128 v[44:47], v75 offset:53248
  v_smfmac_f32_16x16x64_bf16 v[20:23], v[0:3], a[192:199], v74
  ds_read_b128 v[48:51], v75 offset:54272
  ds_read_b128 v[60:63], v75 offset:55296
  v_smfmac_f32_16x16x64_bf16 v[20:23], v[4:7], a[200:207], v74
  ds_read_b128 v[64:67], v75 offset:56320
  s_waitcnt lgkmcnt(6)
  v_cvt_pk_bf16_f32 v16, v16, v17
  v_cvt_pk_bf16_f32 v17, v18, v19
  v_bfi_b32 v16, 1, s72, v16
  v_smfmac_f32_16x16x64_bf16 v[20:23], v[8:11], v[52:59], v74
  buffer_store_dwordx2 v[16:17], v68, s[8:11], s73 offen
  s_waitcnt lgkmcnt(4)
  v_smfmac_f32_16x16x64_bf16 v[20:23], v[12:15], v[36:43], v74
  v_mov_b64 v[32:33], 0
  v_smfmac_f32_16x16x64_bf16 v[24:27], v[0:3], a[208:215], v74
  v_mov_b64 v[34:35], 0
  v_smfmac_f32_16x16x64_bf16 v[24:27], v[4:7], a[216:223], v74
  s_waitcnt lgkmcnt(2)
  v_cvt_pk_bf16_f32 v20, v20, v21
  v_cvt_pk_bf16_f32 v21, v22, v23
  v_bfi_b32 v20, 1, s72, v20
  v_smfmac_f32_16x16x64_bf16 v[24:27], v[8:11], v[44:51], v74
  buffer_store_dwordx2 v[20:21], v68, s[8:11], s74 offen
  s_waitcnt lgkmcnt(0)
  v_smfmac_f32_16x16x64_bf16 v[24:27], v[12:15], v[60:67], v74
  v_smfmac_f32_16x16x64_bf16 v[32:35], v[0:3], a[224:231], v74
  v_smfmac_f32_16x16x64_bf16 v[32:35], v[4:7], a[232:239], v74
  v_cvt_pk_bf16_f32 v24, v24, v25
  v_cvt_pk_bf16_f32 v25, v26, v27
  v_bfi_b32 v24, 1, s72, v24
  v_smfmac_f32_16x16x64_bf16 v[32:35], v[8:11], a[240:247], v74
  buffer_store_dwordx2 v[24:25], v68, s[8:11], s75 offen
  v_smfmac_f32_16x16x64_bf16 v[32:35], v[12:15], a[248:255], v74
  v_mov_b64 v[18:19], v[72:73]
  s_nop 4
  v_cvt_pk_bf16_f32 v32, v32, v33
  v_cvt_pk_bf16_f32 v33, v34, v35
  v_bfi_b32 v32, 1, s72, v32
  buffer_store_dwordx2 v[32:33], v68, s[8:11], s76 offen
  ds_read_b128 v[0:3], v76 offset:14848
  s_waitcnt lgkmcnt(0)
  ds_read_b64 v[16:17], v77 offset:264
  s_waitcnt lgkmcnt(0)
  ds_read_b128 v[64:67], v76 offset:23552
  s_waitcnt lgkmcnt(0)
  s_add_u32 s66, s66, 1
  s_xor_b32 s64, s64, 16384
  s_xor_b32 s65, s65, 16384
  s_add_u32 s58, s58, 655360
  s_add_u32 s59, s59, 655360
  s_add_u32 s70, s70, 655360
  s_add_u32 s68, s68, 655360
  s_mov_b32 m0, 11776
  s_add_u32 s85, s65, 7168
  v_xor_b32 v75, 0x8000, v75
  buffer_load_dwordx4 v[52:55], v76, s[8:11], s60 offen offset:0 sc1
  buffer_load_dwordx4 v[56:59], v76, s[8:11], s60 offen offset:1024 sc1
  s_waitcnt lgkmcnt(0)
  s_waitcnt vmcnt(1)
  v_mfma_f32_16x16x32_bf16 v[4:7], v[0:3], v[52:55], 0
  v_bitop3_b32 v72, v52, v54, s72 bitop3:0x7e
  s_waitcnt vmcnt(0)
  v_mfma_f32_16x16x32_bf16 v[4:7], v[0:3], v[56:59], v[4:7]
  v_bitop3_b32 v73, v56, v58, s72 bitop3:0x7e
  v_bitop3_b32 v72, v72, v73, 1 bitop3:0xa8
  v_cmp_ne_u32 vcc, 0, v72
  s_nop 0
  s_cmp_eq_u64 vcc, 0
  s_cselect_b32 s54, s62, 268435456
  s_nop 0
  v_add_f32_dpp v4, v4, v4 row_ror:4 row_mask:0xf bank_mask:0xf
  v_add_f32_dpp v5, v5, v5 row_ror:4 row_mask:0xf bank_mask:0xf
  s_nop 0
  v_add_f32_dpp v4, v4, v4 row_ror:8 row_mask:0xf bank_mask:0xf
  v_add_f32_dpp v5, v5, v5 row_ror:8 row_mask:0xf bank_mask:0xf
  v_cvt_pk_bf16_f32 v4, v4, v5
  buffer_store_dword v4, v69, s[8:11], s54 offen
  s_cbranch_vccnz Cf1_h1r
  s_xor_b32 s62, s62, 16384
  buffer_store_dword v71, v69, s[8:11], s62 offen
  s_xor_b32 s72, s72, 1
  s_branch Cf1_h2
Cf1_h1r:
  s_mov_b64 exec, vcc
  buffer_load_dwordx4 v[52:55], v76, s[8:11], s60 offen offset:0 sc1
  buffer_load_dwordx4 v[56:59], v76, s[8:11], s60 offen offset:1024 sc1
  s_mov_b64 exec, -1
  s_add_u32 s67, s67, 1
  s_waitcnt vmcnt(1)
  v_mfma_f32_16x16x32_bf16 v[4:7], v[0:3], v[52:55], 0
  v_bitop3_b32 v72, v52, v54, s72 bitop3:0x7e
  s_waitcnt vmcnt(0)
  v_mfma_f32_16x16x32_bf16 v[4:7], v[0:3], v[56:59], v[4:7]
  v_bitop3_b32 v73, v56, v58, s72 bitop3:0x7e
  v_bitop3_b32 v72, v72, v73, 1 bitop3:0xa8
  v_cmp_ne_u32 vcc, 0, v72
  s_cbranch_vccz Cf1_h1p
Cf1_h1s:
  s_mov_b64 exec, vcc
  buffer_load_dwordx4 v[52:55], v76, s[8:11], s60 offen offset:0 sc1
  buffer_load_dwordx4 v[56:59], v76, s[8:11], s60 offen offset:1024 sc1
  s_mov_b64 exec, -1
  s_add_u32 s67, s67, 1
  s_waitcnt vmcnt(1)
  v_mfma_f32_16x16x32_bf16 v[4:7], v[0:3], v[52:55], 0
  v_bitop3_b32 v72, v52, v54, s72 bitop3:0x7e
  s_waitcnt vmcnt(0)
  v_mfma_f32_16x16x32_bf16 v[4:7], v[0:3], v[56:59], v[4:7]
  v_bitop3_b32 v73, v56, v58, s72 bitop3:0x7e
  v_bitop3_b32 v72, v72, v73, 1 bitop3:0xa8
  v_cmp_ne_u32 vcc, 0, v72
  s_cbranch_vccz Cf1_h1p
  s_cmp_lt_u32 s67, 131072
  s_cbranch_scc1 Cf1_h1s
Cf1_h1p:
  s_nop 2
  v_add_f32_dpp v4, v4, v4 row_ror:4 row_mask:0xf bank_mask:0xf
  v_add_f32_dpp v5, v5, v5 row_ror:4 row_mask:0xf bank_mask:0xf
  s_nop 0
  v_add_f32_dpp v4, v4, v4 row_ror:8 row_mask:0xf bank_mask:0xf
  v_add_f32_dpp v5, v5, v5 row_ror:8 row_mask:0xf bank_mask:0xf
  v_cvt_pk_bf16_f32 v4, v4, v5
  buffer_store_dword v4, v69, s[8:11], s62 offen
  s_xor_b32 s62, s62, 16384
  buffer_store_dword v71, v69, s[8:11], s62 offen
  s_xor_b32 s72, s72, 1
  s_branch Cf1_h2
Cf1_h2r:
  s_mov_b64 exec, vcc
  buffer_load_dwordx4 v[8:11], v76, s[8:11], s65 offen offset:2048 sc1
  s_mov_b64 exec, -1
  s_add_u32 s67, s67, 1
  s_waitcnt vmcnt(4)
  v_max3_u32 v72, v8, v9, v10
  v_max_u32 v72, v72, v11
  ds_write_b128 v76, v[8:11] offset:6656
  v_cmp_eq_u32 vcc, -1, v72
  s_cbranch_vccz Cf1_h2w
  s_mov_b64 exec, vcc
  buffer_load_dwordx4 v[8:11], v76, s[8:11], s65 offen offset:2048 sc1
  s_mov_b64 exec, -1
  s_add_u32 s67, s67, 1
  s_waitcnt vmcnt(4)
  v_max3_u32 v72, v8, v9, v10
  v_max_u32 v72, v72, v11
  ds_write_b128 v76, v[8:11] offset:6656
  v_cmp_eq_u32 vcc, -1, v72
  s_cbranch_vccz Cf1_h2w
Cf1_h2s:
  s_mov_b64 exec, vcc
  buffer_load_dwordx4 v[8:11], v76, s[8:11], s65 offen offset:2048 sc1
  s_mov_b64 exec, -1
  s_add_u32 s67, s67, 1
  s_waitcnt vmcnt(2)
  v_max3_u32 v72, v8, v9, v10
  v_max_u32 v72, v72, v11
  ds_write_b128 v76, v[8:11] offset:6656
  v_cmp_eq_u32 vcc, -1, v72
  s_cbranch_vccz Cf1_h2w
  s_mov_b64 exec, vcc
  buffer_load_dwordx4 v[8:11], v76, s[8:11], s65 offen offset:2048 sc1
  s_mov_b64 exec, -1
  s_add_u32 s67, s67, 1
  s_waitcnt vmcnt(2)
  v_max3_u32 v72, v8, v9, v10
  v_max_u32 v72, v72, v11
  ds_write_b128 v76, v[8:11] offset:6656
  v_cmp_eq_u32 vcc, -1, v72
  s_cbranch_vccz Cf1_h2w
  s_mov_b64 exec, vcc
  buffer_load_dwordx4 v[8:11], v76, s[8:11], s65 offen offset:2048 sc1
  s_mov_b64 exec, -1
  s_add_u32 s67, s67, 1
  s_waitcnt vmcnt(2)
  v_max3_u32 v72, v8, v9, v10
  v_max_u32 v72, v72, v11
  ds_write_b128 v76, v[8:11] offset:6656
  v_cmp_eq_u32 vcc, -1, v72
  s_cbranch_vccz Cf1_h2w
  s_cmp_lt_u32 s67, 131072
  s_cbranch_scc1 Cf1_h2s
  s_branch Cf1_h2w
Cf1_rec:
  s_nop 7
  s_waitcnt vmcnt(0) lgkmcnt(0)
  v_max3_u32 v72, v0, v1, v2
  v_max3_u32 v72, v72, v3, v4
  v_max3_u32 v72, v72, v5, v6
  v_max3_u32 v72, v72, v7, v8
  v_max3_u32 v72, v72, v9, v10
  v_max3_u32 v72, v72, v11, v12
  v_max3_u32 v72, v72, v13, v14
  v_max3_u32 v72, v72, v15, v16
  v_max3_u32 v72, v72, v17, v18
  v_max_u32 v72, v72, v19
  v_cmp_eq_u32 vcc, -1, v72
  s_cbranch_vccz Cf1_recok
  s_barrier
  v_mov_b64 v[20:21], 0
  v_mov_b64 v[22:23], 0
  v_mov_b64 v[24:25], 0
  v_mov_b64 v[26:27], 0
  v_mov_b64 v[28:29], 0
  v_mov_b64 v[30:31], 0
  v_mov_b64 v[32:33], 0
  v_mov_b64 v[34:35], 0
  s_waitcnt lgkmcnt(0)
  s_barrier
  ds_read_b128 v[0:3], v76 offset:4608
  s_waitcnt lgkmcnt(0)
  v_smfmac_f32_16x16x64_bf16 v[20:23], v[0:3], v[80:87], v74
  v_smfmac_f32_16x16x64_bf16 v[24:27], v[0:3], v[88:95], v74
  ds_read_b128 v[60:63], v76 offset:20480
  ds_read_b128 v[64:67], v76 offset:21504
  s_waitcnt lgkmcnt(0)
  v_smfmac_f32_16x16x64_bf16 v[28:31], v[0:3], v[60:67], v74
  ds_read_b128 v[60:63], v76 offset:22528
  ds_read_b128 v[64:67], v76 offset:23552
  s_waitcnt lgkmcnt(0)
  v_smfmac_f32_16x16x64_bf16 v[32:35], v[0:3], v[60:67], v74
  ds_read_b128 v[4:7], v76 offset:5632
  s_waitcnt lgkmcnt(0)
  v_smfmac_f32_16x16x64_bf16 v[20:23], v[4:7], v[96:103], v74
  v_smfmac_f32_16x16x64_bf16 v[24:27], v[4:7], v[104:111], v74
  ds_read_b128 v[60:63], v76 offset:36864
  ds_read_b128 v[64:67], v76 offset:37888
  s_waitcnt lgkmcnt(0)
  v_smfmac_f32_16x16x64_bf16 v[28:31], v[4:7], v[60:67], v74
  ds_read_b128 v[60:63], v76 offset:38912
  ds_read_b128 v[64:67], v76 offset:39936
  s_waitcnt lgkmcnt(0)
  v_smfmac_f32_16x16x64_bf16 v[32:35], v[4:7], v[60:67], v74
  ds_read_b128 v[8:11], v76 offset:6656
  s_waitcnt lgkmcnt(0)
  v_smfmac_f32_16x16x64_bf16 v[20:23], v[8:11], v[112:119], v74
  v_smfmac_f32_16x16x64_bf16 v[24:27], v[8:11], v[120:127], v74
  v_smfmac_f32_16x16x64_bf16 v[28:31], v[8:11], v[208:215], v74
  v_smfmac_f32_16x16x64_bf16 v[32:35], v[8:11], v[216:223], v74
  ds_read_b128 v[12:15], v76 offset:7680
  s_waitcnt lgkmcnt(0)
  v_smfmac_f32_16x16x64_bf16 v[20:23], v[12:15], v[128:135], v74
  v_smfmac_f32_16x16x64_bf16 v[24:27], v[12:15], v[136:143], v74
  v_smfmac_f32_16x16x64_bf16 v[28:31], v[12:15], v[224:231], v74
  v_smfmac_f32_16x16x64_bf16 v[32:35], v[12:15], v[232:239], v74
  ds_read_b128 v[8:11], v76 offset:8704
  s_waitcnt lgkmcnt(0)
  v_smfmac_f32_16x16x64_bf16 v[20:23], v[8:11], v[144:151], v74
  v_smfmac_f32_16x16x64_bf16 v[24:27], v[8:11], v[152:159], v74
  ds_read_b128 v[60:63], v76 offset:53248
  ds_read_b128 v[64:67], v76 offset:54272
  s_waitcnt lgkmcnt(0)
  v_smfmac_f32_16x16x64_bf16 v[28:31], v[8:11], v[60:67], v74
  ds_read_b128 v[60:63], v76 offset:55296
  ds_read_b128 v[64:67], v76 offset:56320
  s_waitcnt lgkmcnt(0)
  v_smfmac_f32_16x16x64_bf16 v[32:35], v[8:11], v[60:67], v74
  ds_read_b128 v[0:3], v76 offset:9728
  s_waitcnt lgkmcnt(0)
  v_smfmac_f32_16x16x64_bf16 v[20:23], v[0:3], v[160:167], v74
  v_smfmac_f32_16x16x64_bf16 v[24:27], v[0:3], v[168:175], v74
  ds_read_b128 v[60:63], v75 offset:20480
  ds_read_b128 v[64:67], v75 offset:21504
  s_waitcnt lgkmcnt(0)
  v_smfmac_f32_16x16x64_bf16 v[28:31], v[0:3], v[60:67], v74
  ds_read_b128 v[60:63], v75 offset:22528
  ds_read_b128 v[64:67], v75 offset:23552
  s_waitcnt lgkmcnt(0)
  v_smfmac_f32_16x16x64_bf16 v[32:35], v[0:3], v[60:67], v74
  ds_read_b128 v[16:19], v76 offset:10752
  ds_read_b128 v[60:63], v75 offset:4096
  ds_read_b128 v[64:67], v75 offset:5120
  s_waitcnt lgkmcnt(0)
  v_smfmac_f32_16x16x64_bf16 v[20:23], v[16:19], v[60:67], v74
  ds_read_b128 v[60:63], v75 offset:6144
  ds_read_b128 v[64:67], v75 offset:7168
  s_waitcnt lgkmcnt(0)
  v_smfmac_f32_16x16x64_bf16 v[24:27], v[16:19], v[60:67], v74
  v_smfmac_f32_16x16x64_bf16 v[28:31], v[16:19], v[240:247], v74
  v_smfmac_f32_16x16x64_bf16 v[32:35], v[16:19], v[248:255], v74
  ds_read_b128 v[4:7], v76 offset:11776
  s_waitcnt lgkmcnt(0)
  v_smfmac_f32_16x16x64_bf16 v[20:23], v[4:7], v[176:183], v74
  v_smfmac_f32_16x16x64_bf16 v[24:27], v[4:7], v[184:191], v74
  v_smfmac_f32_16x16x64_bf16 v[28:31], v[4:7], a[0:7], v74
  v_smfmac_f32_16x16x64_bf16 v[32:35], v[4:7], a[8:15], v74
  ds_read_b128 v[12:15], v76 offset:12800
  s_waitcnt lgkmcnt(0)
  v_smfmac_f32_16x16x64_bf16 v[20:23], v[12:15], v[192:199], v74
  v_smfmac_f32_16x16x64_bf16 v[24:27], v[12:15], v[200:207], v74
  v_smfmac_f32_16x16x64_bf16 v[28:31], v[12:15], a[16:23], v74
  v_smfmac_f32_16x16x64_bf16 v[32:35], v[12:15], a[24:31], v74
  v_add_f32 v20, v20, v22
  v_add_f32 v21, v21, v23
  v_add_f32 v24, v24, v26
  v_cvt_pk_bf16_f32 v22, v20, v24
  ds_write_b32 v79, v22 offset:0
  v_add_f32 v25, v25, v27
  v_cvt_pk_bf16_f32 v23, v21, v25
  ds_write_b32 v79, v23 offset:576
  v_add_f32 v28, v28, v30
  v_add_f32 v29, v29, v31
  s_waitcnt lgkmcnt(0)
  s_nop 1
  s_branch Cf1_recok
Cf1_mx:
  s_waitcnt lgkmcnt(0)
  s_barrier
  buffer_load_dwordx4 v[0:3], v76, s[8:11], s58 offen offset:0 sc1
  ds_read_b128 v[20:23], v77 offset:0
  ds_read_b128 v[28:31], v77 offset:256
  buffer_load_dwordx4 v[4:7], v76, s[8:11], s58 offen offset:1024 sc1
  ds_read_b128 v[24:27], v77 offset:128
  ds_read_b128 v[32:35], v77 offset:384
  s_waitcnt vmcnt(1) lgkmcnt(3)
  v_mfma_f32_16x16x32_bf16 v[8:11], v[0:3], v[20:23], 0
  s_waitcnt vmcnt(0) lgkmcnt(1)
  v_mfma_f32_16x16x32_bf16 v[8:11], v[4:7], v[24:27], v[8:11]
  v_mfma_f32_16x16x32_bf16 v[12:15], v[28:31], v[20:23], 0
  s_waitcnt lgkmcnt(0)
  v_mfma_f32_16x16x32_bf16 v[12:15], v[32:35], v[24:27], v[12:15]
  v_add_f32_dpp v8, v10, v8 quad_perm:[2,3,0,1] row_mask:0xf bank_mask:0xf
  v_add_f32_dpp v9, v11, v9 quad_perm:[2,3,0,1] row_mask:0xf bank_mask:0xf
  s_nop 0
  v_mov_b32_dpp v8, v8 quad_perm:[0,1,0,1] row_mask:0xf bank_mask:0xf
  v_mov_b32_dpp v9, v9 quad_perm:[0,1,0,1] row_mask:0xf bank_mask:0xf
  s_nop 1
  v_add_f32_dpp v12, v14, v12 quad_perm:[2,3,0,1] row_mask:0xf bank_mask:0xf
  v_add_f32_dpp v13, v15, v13 quad_perm:[2,3,0,1] row_mask:0xf bank_mask:0xf
  s_nop 0
  v_mov_b32_dpp v12, v12 quad_perm:[0,1,0,1] row_mask:0xf bank_mask:0xf
  v_mov_b32_dpp v13, v13 quad_perm:[0,1,0,1] row_mask:0xf bank_mask:0xf
  v_mul_f32 v12, s69, v12
  ds_write_b32 v78, v8 offset:8708
  v_mul_f32 v13, s69, v13
  ds_write_b32 v78, v9 offset:8772
  s_waitcnt lgkmcnt(0)
  s_barrier
  ds_read_b128 v[36:39], v78 offset:8704
  ds_read_b128 v[40:43], v78 offset:8768
  s_waitcnt lgkmcnt(0)
  s_barrier
  v_max_f32 v16, v36, v37
  v_max3_f32 v16, v16, v38, v39
  v_max3_f32 v16, v16, v40, v41
  v_max3_f32 v16, v16, v42, v43
  v_max3_f32 v16, v16, v12, v13
  v_mov_b32 v17, v16
  s_nop 1
  v_permlane16_swap_b32 v16, v17
  v_max_f32 v16, v16, v17
  v_mov_b32 v17, v16
  s_nop 1
  v_permlane32_swap_b32 v16, v17
  v_max_f32 v16, v16, v17
  v_sub_f32 v36, v36, v16
  v_sub_f32 v37, v37, v16
  v_sub_f32 v38, v38, v16
  v_sub_f32 v39, v39, v16
  v_sub_f32 v40, v40, v16
  v_sub_f32 v41, v41, v16
  v_sub_f32 v42, v42, v16
  v_sub_f32 v43, v43, v16
  v_sub_f32 v12, v12, v16
  v_sub_f32 v13, v13, v16
  v_exp_f32 v36, v36
  v_exp_f32 v37, v37
  v_exp_f32 v38, v38
  v_exp_f32 v39, v39
  v_exp_f32 v40, v40
  v_exp_f32 v41, v41
  v_exp_f32 v42, v42
  v_exp_f32 v43, v43
  v_exp_f32 v12, v12
  v_exp_f32 v13, v13
  v_cvt_pk_bf16_f32 v32, v36, v40
  v_cvt_pk_bf16_f32 v33, v37, v41
  v_cvt_pk_bf16_f32 v34, v38, v42
  v_cvt_pk_bf16_f32 v35, v39, v43
  v_cvt_pk_bf16_f32 v28, v12, v13
  v_cvt_pk_bf16_f32 v31, v12, v13
  v_mov_b32 v29, 0
  v_mov_b32 v30, 0
  v_mov_b32 v68, 0x3f803f80
  v_mov_b32 v69, 0x3f803f80
  v_mov_b32 v70, 0x3f803f80
  v_mov_b32 v71, 0x3f803f80
  s_nop 1
  v_mfma_f32_16x16x32_bf16 v[8:11], v[32:35], v[68:71], 0
  v_mfma_f32_16x16x32_bf16 v[0:3], v[32:35], v[52:55], 0
  v_mfma_f32_16x16x32_bf16 v[4:7], v[32:35], v[56:59], 0
  v_mfma_f32_16x16x16_bf16 v[8:11], v[28:29], v[68:69], v[8:11]
  v_mfma_f32_16x16x16_bf16 v[0:3], v[28:29], v[72:73], v[0:3]
  v_mfma_f32_16x16x16_bf16 v[4:7], v[30:31], v[72:73], v[4:7]
  ds_read_b128 v[68:71], v76 offset:13824
  v_rcp_f32 v10, v8
  v_rcp_f32 v11, v9
  v_mul_f32 v0, v10, v0
  v_mul_f32 v1, v11, v1
  s_nop 0
  v_mul_f32 v4, v10, v4
  v_mul_f32 v5, v11, v5
  v_cvt_pk_bf16_f32 v2, v0, v4
  ds_write_b32 v79, v2 offset:8704
  v_cvt_pk_bf16_f32 v3, v1, v5
  ds_write_b32 v79, v3 offset:9280
  v_mov_b64 v[16:17], 0
  v_mov_b64 v[18:19], 0
  v_mov_b64 v[20:21], 0
  v_mov_b64 v[22:23], 0
  v_mov_b64 v[24:25], 0
  v_mov_b64 v[26:27], 0
  s_branch Cf1_mxok
Cf1_last:
  ds_read_b128 v[4:7], v76 offset:5632
  ds_read_b128 v[12:15], v76 offset:7680
  ds_read_b128 v[44:47], v76 offset:36864
  ds_read_b128 v[48:51], v76 offset:37888
  s_nop 5
  v_mov_b64 v[20:21], 0
  v_mov_b64 v[22:23], 0
  v_mov_b64 v[24:25], 0
  v_mov_b64 v[26:27], 0
  s_waitcnt lgkmcnt(4)
  v_smfmac_f32_16x16x64_bf16 v[28:31], v[0:3], v[36:43], v74
  ds_read_b128 v[36:39], v76 offset:38912
  ds_read_b128 v[40:43], v76 offset:39936
  v_smfmac_f32_16x16x64_bf16 v[32:35], v[0:3], v[60:67], v74
  s_waitcnt lgkmcnt(5)
  v_smfmac_f32_16x16x64_bf16 v[20:23], v[0:3], a[32:39], v74
  ds_read_b128 v[60:63], v76 offset:53248
  ds_read_b128 v[64:67], v76 offset:54272
  v_smfmac_f32_16x16x64_bf16 v[24:27], v[0:3], a[40:47], v74
  s_waitcnt lgkmcnt(4)
  v_smfmac_f32_16x16x64_bf16 v[20:23], v[4:7], a[48:55], v74
  buffer_store_dwordx4 v[16:19], v76, s[8:11], s68 offen sc1
  v_smfmac_f32_16x16x64_bf16 v[24:27], v[4:7], a[56:63], v74
  v_smfmac_f32_16x16x64_bf16 v[28:31], v[4:7], v[44:51], v74
  s_waitcnt lgkmcnt(2)
  v_smfmac_f32_16x16x64_bf16 v[20:23], v[8:11], a[64:71], v74
  ds_read_b128 v[44:47], v76 offset:55296
  ds_read_b128 v[48:51], v76 offset:56320
  v_smfmac_f32_16x16x64_bf16 v[24:27], v[8:11], a[72:79], v74
  v_smfmac_f32_16x16x64_bf16 v[32:35], v[4:7], v[36:43], v74
  v_smfmac_f32_16x16x64_bf16 v[28:31], v[8:11], v[208:215], v74
  ds_read_b128 v[36:39], v75 offset:20480
  ds_read_b128 v[40:43], v75 offset:21504
  v_smfmac_f32_16x16x64_bf16 v[32:35], v[8:11], v[216:223], v74
  v_smfmac_f32_16x16x64_bf16 v[20:23], v[12:15], a[80:87], v74
  v_smfmac_f32_16x16x64_bf16 v[24:27], v[12:15], a[88:95], v74
  v_smfmac_f32_16x16x64_bf16 v[28:31], v[12:15], v[224:231], v74
  v_smfmac_f32_16x16x64_bf16 v[32:35], v[12:15], v[232:239], v74
  s_waitcnt vmcnt(2)
  s_waitcnt vmcnt(1)
  s_barrier
Cf1_lastr:
  ds_read_b128 v[8:11], v76 offset:8704
  ds_read_b128 v[0:3], v76 offset:9728
  ds_read_b128 v[16:19], v76 offset:10752
  ds_read_b128 v[4:7], v76 offset:11776
  ds_read_b128 v[12:15], v76 offset:12800
  s_waitcnt lgkmcnt(3)
  v_max3_u32 v72, v0, v1, v2
  s_waitcnt lgkmcnt(1)
  v_max3_u32 v72, v72, v3, v4
  v_max3_u32 v72, v72, v5, v6
  v_max3_u32 v72, v72, v7, v8
  v_max3_u32 v72, v72, v9, v10
  s_waitcnt lgkmcnt(0)
  v_max3_u32 v72, v72, v11, v12
  v_max3_u32 v72, v72, v13, v14
  v_max3_u32 v72, v72, v15, v16
  v_max3_u32 v72, v72, v17, v18
  v_max_u32 v72, v72, v19
  v_cmp_eq_u32 vcc, -1, v72
  s_cbranch_vccnz Cf1_lastp
Cf1_lastg:
  v_smfmac_f32_16x16x64_bf16 v[28:31], v[8:11], v[60:67], v74
  ds_read_b128 v[60:63], v75 offset:22528
  ds_read_b128 v[64:67], v75 offset:23552
  v_smfmac_f32_16x16x64_bf16 v[32:35], v[8:11], v[44:51], v74
  v_smfmac_f32_16x16x64_bf16 v[28:31], v[0:3], v[36:43], v74
  v_smfmac_f32_16x16x64_bf16 v[28:31], v[16:19], v[240:247], v74
  v_smfmac_f32_16x16x64_bf16 v[28:31], v[4:7], a[0:7], v74
  v_smfmac_f32_16x16x64_bf16 v[28:31], v[12:15], a[16:23], v74
  v_smfmac_f32_16x16x64_bf16 v[32:35], v[16:19], v[248:255], v74
  v_smfmac_f32_16x16x64_bf16 v[32:35], v[4:7], a[8:15], v74
  s_waitcnt lgkmcnt(0)
  v_smfmac_f32_16x16x64_bf16 v[32:35], v[12:15], a[24:31], v74
  v_smfmac_f32_16x16x64_bf16 v[32:35], v[0:3], v[60:67], v74
  v_smfmac_f32_16x16x64_bf16 v[20:23], v[8:11], a[96:103], v74
  v_smfmac_f32_16x16x64_bf16 v[20:23], v[0:3], a[112:119], v74
  v_add_f32 v28, v28, v30
  v_add_f32 v32, v32, v34
  v_cvt_pk_bf16_f32 v30, v28, v32
  v_smfmac_f32_16x16x64_bf16 v[20:23], v[16:19], a[128:135], v74
  ds_write_b32 v79, v30 offset:256
  v_add_f32 v29, v29, v31
  v_add_f32 v33, v33, v35
  v_cvt_pk_bf16_f32 v31, v29, v33
  v_smfmac_f32_16x16x64_bf16 v[20:23], v[4:7], a[144:151], v74
  ds_write_b32 v79, v31 offset:832
  v_smfmac_f32_16x16x64_bf16 v[20:23], v[12:15], a[160:167], v74
  v_smfmac_f32_16x16x64_bf16 v[24:27], v[8:11], a[104:111], v74
  v_smfmac_f32_16x16x64_bf16 v[24:27], v[0:3], a[120:127], v74
  v_smfmac_f32_16x16x64_bf16 v[24:27], v[16:19], a[136:143], v74
  s_waitcnt lgkmcnt(0)
  s_barrier
  ds_read_b64 v[52:53], v77 offset:264
  v_add_f32 v20, v20, v22
  v_smfmac_f32_16x16x64_bf16 v[24:27], v[4:7], a[152:159], v74
  v_add_f32 v21, v21, v23
  v_smfmac_f32_16x16x64_bf16 v[24:27], v[12:15], a[168:175], v74
  v_cvt_pk_bf16_f32 v54, v20, v21
  s_add_u32 s68, s68, 655360
  s_nop 3
  v_add_f32 v24, v24, v26
  v_add_f32 v25, v25, v27
  v_cvt_pk_bf16_f32 v55, v24, v25
  s_waitcnt lgkmcnt(0)
  buffer_store_dwordx4 v[52:55], v76, s[8:11], s68 offen sc1
  s_branch Cf1_done
Cf1_lastp:
  s_add_u32 s72, s72, 2
  s_cmp_ge_u32 s72, 131072
  s_cbranch_scc1 Cf1_lastg
  s_barrier
  buffer_load_dwordx4 v76, s[8:11], s85 offen offset:0 sc1 lds
  s_waitcnt vmcnt(0)
  s_barrier
  s_branch Cf1_lastr
Cf1_done:
  s_branch L_cexit
L_w2:
  v_mov_b64 v[20:21], 0
  v_mov_b64 v[22:23], 0
  v_mov_b64 v[24:25], 0
  v_mov_b64 v[26:27], 0
  v_mov_b64 v[28:29], 0
  v_mov_b64 v[30:31], 0
  v_mov_b64 v[32:33], 0
  v_mov_b64 v[34:35], 0
  s_mov_b32 s78, 0x3f803f80
  s_mov_b32 s79, s78
  s_mov_b32 s65, 360448
  s_mov_b32 m0, 15872
  s_lshl_b32 s71, s53, 2
  s_add_u32 s71, s71, 128
  s_movk_i32 s56, 0x1000
  v_lshlrev_b32 v73, 2, v76
  v_mov_b32 v72, 0
  s_mov_b64 s[16:17], s[8:9]
  s_mov_b32 s18, 268435456
  s_mov_b32 s19, 0x20000
  s_getpc_b64 s[20:21]
Cf2_pc:
  s_add_u32 s20, s20, (Cf2_last - Cf2_pc)
  s_addc_u32 s21, s21, 0
  v_mov_b32 v68, 14880
  buffer_load_dwordx4 v[52:55], v76, s[8:11], s59 offen offset:0 sc1
  buffer_load_dwordx4 v[56:59], v76, s[8:11], s59 offen offset:1024 sc1
  ds_read_b128 v[36:39], v76 offset:24576
  ds_read_b128 v[40:43], v76 offset:25600
  ds_read_b128 v[60:63], v76 offset:26624
  ds_read_b128 v[64:67], v76 offset:27648
  ds_read_b128 v[0:3], v76 offset:4608
  ds_read_b128 v[4:7], v76 offset:5632
  ds_read_b128 v[8:11], v76 offset:6656
  ds_read_b128 v[12:15], v76 offset:7680
  s_waitcnt lgkmcnt(0)
  s_cmp_eq_u32 s66, 1
  s_branch Cf2_top2
.p2align 6
Cf2_h2:
  s_cmp_eq_u32 s66, 62
  s_cselect_b64 s[16:17], s[20:21], s[16:17]
  s_cselect_b32 s18, (Cf2_done - Cf2_last), s18
  s_cselect_b32 s70, 0, s70
  s_cmp_eq_u32 s66, 63
  s_cselect_b32 s59, 268435456, s59
  s_cselect_b32 s58, 268435456, s58
  buffer_load_dwordx4 v[12:15], v76, s[8:11], s65 offen offset:3072 sc1
  ds_read_b128 v[36:39], v76 offset:24576
  s_waitcnt lgkmcnt(0)
  v_mov_b64 v[28:29], 0
  v_mov_b64 v[30:31], 0
  v_mov_b64 v[32:33], 0
  v_mov_b64 v[34:35], 0
  v_lshlrev_b32 v73, 2, v76
  buffer_load_dwordx4 v[12:15], v76, s[8:11], s65 offen offset:3072 sc1
  ds_read_b128 v[40:43], v76 offset:25600
  s_waitcnt lgkmcnt(0)
  v_mov_b64 v[20:21], 0
  v_mov_b64 v[22:23], 0
  v_mov_b64 v[24:25], 0
  v_mov_b64 v[26:27], 0
  v_mov_b32 v68, 14880
  buffer_load_dwordx4 v[12:15], v76, s[8:11], s65 offen offset:3072 sc1
  buffer_load_dwordx4 v[52:55], v76, s[8:11], s59 offen offset:0 sc1
  buffer_load_dwordx4 v[56:59], v76, s[8:11], s59 offen offset:1024 sc1
  s_waitcnt vmcnt(4)
  v_max3_u32 v72, v12, v13, v14
  v_max_u32 v72, v72, v15
  ds_write_b128 v76, v[12:15] offset:7680
  v_cmp_eq_u32 vcc, -1, v72
  s_cbranch_vccnz Cf2_h2r
Cf2_h2w:
  s_cmp_eq_u32 s66, 63
  s_waitcnt lgkmcnt(0)
  s_barrier
  ds_read_b128 v[0:3], v76 offset:4608
  buffer_load_dwordx4 v76, s[8:11], s85 offen offset:0 sc1 lds
Cf2_top2:
  v_smfmac_f32_16x16x64_bf16 v[20:23], v[12:15], v[128:135], v74
  s_cbranch_scc1 Cf2_last
  v_smfmac_f32_16x16x64_bf16 v[24:27], v[12:15], v[136:143], v74
  buffer_load_dwordx4 v[44:47], v76, s[8:11], s58 offen offset:0 sc1
  s_mov_b32 m0, 15872
  v_smfmac_f32_16x16x64_bf16 v[28:31], v[12:15], v[224:231], v74
  buffer_load_dwordx4 v[48:51], v76, s[8:11], s58 offen offset:1024 sc1
  v_smfmac_f32_16x16x64_bf16 v[32:35], v[12:15], v[232:239], v74
  ds_read_b128 v[4:7], v76 offset:5632
  s_waitcnt lgkmcnt(1)
  v_smfmac_f32_16x16x64_bf16 v[20:23], v[0:3], v[80:87], v74
  ds_read_b128 v[8:11], v76 offset:6656
  v_smfmac_f32_16x16x64_bf16 v[28:31], v[0:3], v[36:43], v74
  ds_read_b128 v[36:39], v76 offset:40960
  v_smfmac_f32_16x16x64_bf16 v[24:27], v[0:3], v[88:95], v74
  buffer_store_dwordx4 v[16:19], v76, s[8:11], s68 offen sc1
  ds_read_b128 v[40:43], v76 offset:41984
  v_smfmac_f32_16x16x64_bf16 v[32:35], v[0:3], v[60:67], v74
  ds_read_b128 v[60:63], v76 offset:43008
  s_waitcnt lgkmcnt(4)
  v_smfmac_f32_16x16x64_bf16 v[20:23], v[4:7], v[96:103], v74
  ds_read_b128 v[64:67], v76 offset:44032
  v_smfmac_f32_16x16x64_bf16 v[24:27], v[4:7], v[104:111], v74
  buffer_load_dword v73, s[16:19], s70 offen lds
  s_waitcnt vmcnt(5)
  s_waitcnt lgkmcnt(4)
  v_smfmac_f32_16x16x64_bf16 v[20:23], v[8:11], v[112:119], v74
  s_barrier
  s_waitcnt lgkmcnt(2)
  v_smfmac_f32_16x16x64_bf16 v[28:31], v[4:7], v[36:43], v74
  ds_read_b128 v[12:15], v76 offset:8704
  v_smfmac_f32_16x16x64_bf16 v[24:27], v[8:11], v[120:127], v74
  ds_read_b128 v[36:39], v76 offset:57344
  s_waitcnt lgkmcnt(2)
  v_smfmac_f32_16x16x64_bf16 v[32:35], v[4:7], v[60:67], v74
  ds_read_b128 v[40:43], v76 offset:58368
  v_smfmac_f32_16x16x64_bf16 v[28:31], v[8:11], v[208:215], v74
  ds_read_b128 v[60:63], v76 offset:59392
  v_smfmac_f32_16x16x64_bf16 v[32:35], v[8:11], v[216:223], v74
  ds_read_b128 v[64:67], v76 offset:60416
  s_waitcnt lgkmcnt(4)
  v_smfmac_f32_16x16x64_bf16 v[20:23], v[12:15], v[144:151], v74
  s_waitcnt vmcnt(4)
  ds_read_b128 v[0:3], v76 offset:9728
  s_waitcnt lgkmcnt(3)
  v_smfmac_f32_16x16x64_bf16 v[28:31], v[12:15], v[36:43], v74
  s_barrier
  ds_read_b128 v[4:7], v76 offset:11776
  v_smfmac_f32_16x16x64_bf16 v[24:27], v[12:15], v[152:159], v74
  ds_read_b128 v[36:39], v75 offset:8192
  ds_read_b128 v[40:43], v75 offset:9216
  s_waitcnt lgkmcnt(4)
  v_smfmac_f32_16x16x64_bf16 v[32:35], v[12:15], v[60:67], v74
  ds_read_b128 v[16:19], v76 offset:10752
  s_waitcnt lgkmcnt(4)
  v_smfmac_f32_16x16x64_bf16 v[20:23], v[0:3], v[160:167], v74
  ds_read_b128 v[8:11], v76 offset:12800
  v_smfmac_f32_16x16x64_bf16 v[24:27], v[0:3], v[168:175], v74
  ds_read_b128 v[60:63], v75 offset:10240
  ds_read_b128 v[64:67], v75 offset:11264
  s_waitcnt lgkmcnt(6)
  v_smfmac_f32_16x16x64_bf16 v[20:23], v[4:7], v[176:183], v74
  s_waitcnt lgkmcnt(3)
  v_smfmac_f32_16x16x64_bf16 v[20:23], v[16:19], v[36:43], v74
  ds_read_b128 v[36:39], v75 offset:24576
  s_waitcnt lgkmcnt(3)
  v_smfmac_f32_16x16x64_bf16 v[20:23], v[8:11], v[192:199], v74
  ds_read_b128 v[40:43], v75 offset:25600
  s_waitcnt lgkmcnt(2)
  v_smfmac_f32_16x16x64_bf16 v[24:27], v[16:19], v[60:67], v74
  ds_read_b128 v[60:63], v75 offset:26624
  v_smfmac_f32_16x16x64_bf16 v[24:27], v[4:7], v[184:191], v74
  ds_read_b128 v[64:67], v75 offset:27648
  v_add_f32 v20, v20, v22
  v_smfmac_f32_16x16x64_bf16 v[24:27], v[8:11], v[200:207], v74
  v_add_f32 v21, v21, v23
  v_smfmac_f32_16x16x64_bf16 v[28:31], v[16:19], v[240:247], v74
  s_waitcnt lgkmcnt(2)
  v_mov_b64 v[70:71], s[78:79]
  v_smfmac_f32_16x16x64_bf16 v[28:31], v[0:3], v[36:43], v74
  ds_read_b128 v[36:39], v68
  v_add_f32 v24, v24, v26
  v_smfmac_f32_16x16x64_bf16 v[28:31], v[4:7], a[0:7], v74
  ds_read_b128 v[40:43], v68
  v_cvt_pk_bf16_f32 v22, v20, v24
  v_smfmac_f32_16x16x64_bf16 v[28:31], v[8:11], a[16:23], v74
  ds_write_b32 v79, v22 offset:0
  s_waitcnt lgkmcnt(3)
  v_add_f32 v25, v25, v27
  v_cvt_pk_bf16_f32 v23, v21, v25
  v_smfmac_f32_16x16x64_bf16 v[32:35], v[0:3], v[60:67], v74
  ds_write_b32 v79, v23 offset:576
  v_cmp_u_f32 vcc, v20, v21
  v_smfmac_f32_16x16x64_bf16 v[32:35], v[16:19], v[248:255], v74
  v_add_f32 v28, v28, v30
  v_smfmac_f32_16x16x64_bf16 v[32:35], v[4:7], a[8:15], v74
  v_add_f32 v29, v29, v31
  v_smfmac_f32_16x16x64_bf16 v[32:35], v[8:11], a[24:31], v74
  s_cbranch_vccnz Cf2_rec
Cf2_recok:
  s_waitcnt lgkmcnt(3)
  v_smfmac_f32_16x16x64_bf16 v[36:39], v[16:19], a[128:135], v74
  s_waitcnt lgkmcnt(0)
  s_barrier
  ds_read_b128 v[60:63], v77
  v_smfmac_f32_16x16x64_bf16 v[40:43], v[16:19], a[136:143], v74
  ds_read_b128 v[64:67], v77 offset:128
  v_add_f32 v32, v32, v34
  v_cvt_pk_bf16_f32 v30, v28, v32
  v_smfmac_f32_16x16x64_bf16 v[36:39], v[0:3], a[112:119], v74
  ds_write_b32 v79, v30 offset:256
  v_add_f32 v33, v33, v35
  v_cvt_pk_bf16_f32 v31, v29, v33
  v_smfmac_f32_16x16x64_bf16 v[40:43], v[0:3], a[120:127], v74
  ds_write_b32 v79, v31 offset:832
  v_xor_b32 v75, 0x8000, v75
  v_smfmac_f32_16x16x64_bf16 v[36:39], v[4:7], a[144:151], v74
  ds_read_b128 v[0:3], v76 offset:4608
  v_mov_b32 v29, 0
  v_smfmac_f32_16x16x64_bf16 v[40:43], v[4:7], a[152:159], v74
  s_waitcnt vmcnt(2) lgkmcnt(3)
  v_mov_b32 v30, 0
  v_mfma_f32_16x16x32_bf16 v[44:47], v[44:47], v[60:63], 0
  ds_read_b128 v[4:7], v76 offset:5632
  s_waitcnt lgkmcnt(2)
  v_mfma_f32_16x16x32_bf16 v[44:47], v[48:51], v[64:67], v[44:47]
  s_barrier
  v_smfmac_f32_16x16x64_bf16 v[36:39], v[8:11], a[160:167], v74
  ds_read_b128 v[20:23], v77 offset:256
  ds_read_b128 v[24:27], v77 offset:384
  v_smfmac_f32_16x16x64_bf16 v[40:43], v[8:11], a[168:175], v74
  ds_read_b128 v[8:11], v76 offset:6656
  v_add_f32_dpp v72, v46, v44 quad_perm:[2,3,0,1] row_mask:0xf bank_mask:0xf
  v_add_f32_dpp v73, v47, v45 quad_perm:[2,3,0,1] row_mask:0xf bank_mask:0xf
  v_smfmac_f32_16x16x64_bf16 v[36:39], v[12:15], a[96:103], v74
  s_waitcnt lgkmcnt(4)
  v_exp_f32_dpp v72, v72 quad_perm:[0,1,0,1] row_mask:0xf bank_mask:0xf
  v_smfmac_f32_16x16x64_bf16 v[40:43], v[12:15], a[104:111], v74
  ds_read_b128 v[12:15], v76 offset:7680
  v_exp_f32_dpp v73, v73 quad_perm:[0,1,0,1] row_mask:0xf bank_mask:0xf
  v_smfmac_f32_16x16x64_bf16 v[36:39], v[0:3], a[32:39], v74
  s_waitcnt lgkmcnt(2)
  v_cvt_pk_bf16_f32 v72, v72, v73
  v_mfma_f32_16x16x32_bf16 v[20:23], v[20:23], v[60:63], 0
  ds_write_b32 v78, v72 offset:520
  v_mov_b64 v[16:17], 0
  v_mfma_f32_16x16x32_bf16 v[20:23], v[24:27], v[64:67], v[20:23]
  ds_read_b128 v[44:47], v75 offset:24576
  v_mov_b64 v[18:19], 0
  v_smfmac_f32_16x16x64_bf16 v[40:43], v[0:3], a[40:47], v74
  ds_read_b128 v[48:51], v75 offset:25600
  v_mov_b64 v[68:69], s[78:79]
  v_smfmac_f32_16x16x64_bf16 v[36:39], v[4:7], a[48:55], v74
  s_waitcnt lgkmcnt(4)
  v_add_f32_dpp v24, v22, v20 quad_perm:[2,3,0,1] row_mask:0xf bank_mask:0xf
  v_add_f32_dpp v25, v23, v21 quad_perm:[2,3,0,1] row_mask:0xf bank_mask:0xf
  v_smfmac_f32_16x16x64_bf16 v[36:39], v[8:11], a[64:71], v74
  s_waitcnt lgkmcnt(2)
  s_barrier
  ds_read_b128 v[32:35], v78 offset:512
  v_smfmac_f32_16x16x64_bf16 v[36:39], v[12:15], a[80:87], v74
  ds_read_b128 v[60:63], v75 offset:26624
  v_mul_f32 v24, s69, v24
  v_smfmac_f32_16x16x64_bf16 v[40:43], v[4:7], a[56:63], v74
  ds_read_b128 v[64:67], v75 offset:27648
  v_mul_f32 v25, s69, v25
  v_smfmac_f32_16x16x64_bf16 v[40:43], v[8:11], a[72:79], v74
  v_exp_f32_dpp v24, v24 quad_perm:[0,1,0,1] row_mask:0xf bank_mask:0xf
  v_smfmac_f32_16x16x64_bf16 v[40:43], v[12:15], a[88:95], v74
  s_waitcnt lgkmcnt(2)
  v_exp_f32_dpp v25, v25 quad_perm:[0,1,0,1] row_mask:0xf bank_mask:0xf
  v_mfma_f32_16x16x32_bf16 v[8:11], v[32:35], v[68:71], 0
  v_add_f32 v36, v36, v38
  v_add_f32 v37, v37, v39
  v_mfma_f32_16x16x32_bf16 v[0:3], v[32:35], v[52:55], 0
  v_add_f32 v40, v40, v42
  v_add_f32 v41, v41, v43
  v_mfma_f32_16x16x32_bf16 v[4:7], v[32:35], v[56:59], 0
  v_cvt_pk_bf16_f32 v28, v24, v25
  v_cvt_pk_bf16_f32 v72, v36, v37
  v_cvt_pk_bf16_f32 v73, v40, v41
  v_mfma_f32_16x16x16_bf16 v[8:11], v[28:29], v[68:69], v[8:11]
  v_cvt_pk_bf16_f32 v31, v24, v25
  v_mov_b64 v[20:21], 0
  v_mfma_f32_16x16x16_bf16 v[0:3], v[28:29], v[72:73], v[0:3]
  ds_read_b128 v[68:71], v76 offset:13824
  v_mov_b64 v[22:23], 0
  v_mfma_f32_16x16x16_bf16 v[4:7], v[30:31], v[72:73], v[4:7]
  v_rcp_f32 v10, v8
  v_rcp_f32 v11, v9
  v_mul_f32 v0, v10, v0
  v_mul_f32 v1, v11, v1
  s_nop 0
  v_mul_f32 v4, v10, v4
  v_mul_f32 v5, v11, v5
  v_cvt_pk_bf16_f32 v2, v0, v4
  ds_write_b32 v79, v2 offset:8704
  v_cvt_pk_bf16_f32 v3, v1, v5
  ds_write_b32 v79, v3 offset:9280
  v_max3_f32 v8, v8, v9, v10
  v_max_f32 v8, v8, v11
  v_cmp_le_f32 vcc, 1317011456, v8
  v_mov_b64 v[24:25], 0
  v_mov_b64 v[26:27], 0
  s_cbranch_vccnz Cf2_mx
Cf2_mxok:
  s_waitcnt lgkmcnt(0)
  s_barrier
  ds_read_b128 v[0:3], v78 offset:8704
  ds_read_b128 v[4:7], v78 offset:8768
  ds_read_b128 v[8:11], v78 offset:8832
  ds_read_b128 v[12:15], v78 offset:8896
  s_waitcnt lgkmcnt(3)
  v_smfmac_f32_16x16x64_bf16 v[16:19], v[0:3], v[44:51], v74
  ds_read_b128 v[52:55], v75 offset:40960
  s_waitcnt lgkmcnt(3)
  v_smfmac_f32_16x16x64_bf16 v[16:19], v[4:7], v[60:67], v74
  ds_read_b128 v[56:59], v75 offset:41984
  s_waitcnt lgkmcnt(3)
  v_smfmac_f32_16x16x64_bf16 v[16:19], v[8:11], a[176:183], v74
  ds_read_b128 v[36:39], v75 offset:43008
  s_waitcnt lgkmcnt(3)
  v_smfmac_f32_16x16x64_bf16 v[16:19], v[12:15], a[184:191], v74
  ds_read_b128 v[40:43], v75 offset:44032
  ds_read_b128 v[44:47], v75 offset:57344
  v_smfmac_f32_16x16x64_bf16 v[20:23], v[0:3], a[192:199], v74
  ds_read_b128 v[48:51], v75 offset:58368
  ds_read_b128 v[60:63], v75 offset:59392
  v_smfmac_f32_16x16x64_bf16 v[20:23], v[4:7], a[200:207], v74
  ds_read_b128 v[64:67], v75 offset:60416
  s_waitcnt lgkmcnt(6)
  v_cvt_pk_bf16_f32 v16, v16, v17
  v_cvt_pk_bf16_f32 v17, v18, v19
  v_bfi_b32 v16, 1, s72, v16
  v_smfmac_f32_16x16x64_bf16 v[20:23], v[8:11], v[52:59], v74
  buffer_store_dwordx2 v[16:17], v68, s[8:11], s73 offen
  s_waitcnt lgkmcnt(4)
  v_smfmac_f32_16x16x64_bf16 v[20:23], v[12:15], v[36:43], v74
  ds_read_b128 v[52:55], v75 offset:0
  v_mov_b64 v[32:33], 0
  v_smfmac_f32_16x16x64_bf16 v[24:27], v[0:3], a[208:215], v74
  ds_read_b128 v[56:59], v75 offset:1024
  v_mov_b64 v[34:35], 0
  v_smfmac_f32_16x16x64_bf16 v[24:27], v[4:7], a[216:223], v74
  ds_read_b128 v[36:39], v75 offset:2048
  s_waitcnt lgkmcnt(5)
  v_cvt_pk_bf16_f32 v20, v20, v21
  v_cvt_pk_bf16_f32 v21, v22, v23
  v_bfi_b32 v20, 1, s72, v20
  v_smfmac_f32_16x16x64_bf16 v[24:27], v[8:11], v[44:51], v74
  buffer_store_dwordx2 v[20:21], v68, s[8:11], s74 offen
  s_waitcnt lgkmcnt(3)
  v_smfmac_f32_16x16x64_bf16 v[24:27], v[12:15], v[60:67], v74
  ds_read_b128 v[40:43], v75 offset:3072
  v_mov_b64 v[28:29], 0
  v_smfmac_f32_16x16x64_bf16 v[32:35], v[0:3], a[224:231], v74
  ds_read_b128 v[44:47], v75 offset:4096
  ds_read_b128 v[48:51], v75 offset:5120
  v_smfmac_f32_16x16x64_bf16 v[32:35], v[4:7], a[232:239], v74
  ds_read_b128 v[60:63], v75 offset:6144
  v_cvt_pk_bf16_f32 v24, v24, v25
  v_cvt_pk_bf16_f32 v25, v26, v27
  v_bfi_b32 v24, 1, s72, v24
  v_smfmac_f32_16x16x64_bf16 v[32:35], v[8:11], a[240:247], v74
  buffer_store_dwordx2 v[24:25], v68, s[8:11], s75 offen
  v_mov_b64 v[30:31], 0
  v_smfmac_f32_16x16x64_bf16 v[32:35], v[12:15], a[248:255], v74
  ds_read_b128 v[64:67], v75 offset:7168
  s_waitcnt lgkmcnt(6)
  v_smfmac_f32_16x16x64_bf16 v[28:31], v[0:3], v[52:59], v74
  s_waitcnt lgkmcnt(4)
  v_smfmac_f32_16x16x64_bf16 v[28:31], v[4:7], v[36:43], v74
  s_waitcnt lgkmcnt(2)
  v_cvt_pk_bf16_f32 v32, v32, v33
  v_cvt_pk_bf16_f32 v33, v34, v35
  v_bfi_b32 v32, 1, s72, v32
  v_smfmac_f32_16x16x64_bf16 v[28:31], v[8:11], v[44:51], v74
  buffer_store_dwordx2 v[32:33], v68, s[8:11], s76 offen
  s_waitcnt lgkmcnt(0)
  v_smfmac_f32_16x16x64_bf16 v[28:31], v[12:15], v[60:67], v74
  v_mov_b64 v[18:19], v[72:73]
  s_nop 4
  v_cvt_pk_bf16_f32 v28, v28, v29
  v_cvt_pk_bf16_f32 v29, v30, v31
  v_bfi_b32 v28, 1, s72, v28
  buffer_store_dwordx2 v[28:29], v68, s[8:11], s77 offen
  ds_read_b128 v[0:3], v76 offset:14848
  s_waitcnt lgkmcnt(0)
  ds_read_b64 v[16:17], v77 offset:384
  s_waitcnt lgkmcnt(0)
  ds_read_b128 v[64:67], v76 offset:27648
  s_waitcnt lgkmcnt(0)
  ds_read_b128 v[60:63], v76 offset:26624
  s_waitcnt lgkmcnt(0)
  buffer_load_dwordx4 v[52:55], v76, s[8:11], s60 offen offset:0 sc1
  buffer_load_dwordx4 v[56:59], v76, s[8:11], s60 offen offset:1024 sc1
  s_add_u32 s66, s66, 1
  s_xor_b32 s64, s64, 16384
  s_xor_b32 s65, s65, 16384
  s_add_u32 s58, s58, 655360
  s_add_u32 s59, s59, 655360
  s_add_u32 s70, s70, 655360
  s_add_u32 s68, s68, 655360
  s_mov_b32 m0, 12800
  s_add_u32 s85, s65, 8192
  v_xor_b32 v75, 0x8000, v75
  s_waitcnt lgkmcnt(0)
  s_waitcnt vmcnt(1)
  v_mfma_f32_16x16x32_bf16 v[4:7], v[0:3], v[52:55], 0
  v_bitop3_b32 v72, v52, v54, s72 bitop3:0x7e
  s_waitcnt vmcnt(0)
  v_mfma_f32_16x16x32_bf16 v[4:7], v[0:3], v[56:59], v[4:7]
  v_bitop3_b32 v73, v56, v58, s72 bitop3:0x7e
  v_bitop3_b32 v72, v72, v73, 1 bitop3:0xa8
  v_cmp_ne_u32 vcc, 0, v72
  s_nop 0
  s_cmp_eq_u64 vcc, 0
  s_cselect_b32 s54, s62, 268435456
  s_nop 0
  v_add_f32_dpp v4, v4, v4 row_ror:4 row_mask:0xf bank_mask:0xf
  v_add_f32_dpp v5, v5, v5 row_ror:4 row_mask:0xf bank_mask:0xf
  s_nop 0
  v_add_f32_dpp v4, v4, v4 row_ror:8 row_mask:0xf bank_mask:0xf
  v_add_f32_dpp v5, v5, v5 row_ror:8 row_mask:0xf bank_mask:0xf
  v_cvt_pk_bf16_f32 v4, v4, v5
  buffer_store_dword v4, v69, s[8:11], s54 offen
  s_cbranch_vccnz Cf2_h1r
  s_xor_b32 s62, s62, 16384
  buffer_store_dword v71, v69, s[8:11], s62 offen
  s_xor_b32 s72, s72, 1
  s_branch Cf2_h2
Cf2_h1r:
  s_mov_b64 exec, vcc
  buffer_load_dwordx4 v[52:55], v76, s[8:11], s60 offen offset:0 sc1
  buffer_load_dwordx4 v[56:59], v76, s[8:11], s60 offen offset:1024 sc1
  s_mov_b64 exec, -1
  s_add_u32 s67, s67, 1
  s_waitcnt vmcnt(1)
  v_mfma_f32_16x16x32_bf16 v[4:7], v[0:3], v[52:55], 0
  v_bitop3_b32 v72, v52, v54, s72 bitop3:0x7e
  s_waitcnt vmcnt(0)
  v_mfma_f32_16x16x32_bf16 v[4:7], v[0:3], v[56:59], v[4:7]
  v_bitop3_b32 v73, v56, v58, s72 bitop3:0x7e
  v_bitop3_b32 v72, v72, v73, 1 bitop3:0xa8
  v_cmp_ne_u32 vcc, 0, v72
  s_cbranch_vccz Cf2_h1p
Cf2_h1s:
  s_mov_b64 exec, vcc
  buffer_load_dwordx4 v[52:55], v76, s[8:11], s60 offen offset:0 sc1
  buffer_load_dwordx4 v[56:59], v76, s[8:11], s60 offen offset:1024 sc1
  s_mov_b64 exec, -1
  s_add_u32 s67, s67, 1
  s_waitcnt vmcnt(1)
  v_mfma_f32_16x16x32_bf16 v[4:7], v[0:3], v[52:55], 0
  v_bitop3_b32 v72, v52, v54, s72 bitop3:0x7e
  s_waitcnt vmcnt(0)
  v_mfma_f32_16x16x32_bf16 v[4:7], v[0:3], v[56:59], v[4:7]
  v_bitop3_b32 v73, v56, v58, s72 bitop3:0x7e
  v_bitop3_b32 v72, v72, v73, 1 bitop3:0xa8
  v_cmp_ne_u32 vcc, 0, v72
  s_cbranch_vccz Cf2_h1p
  s_cmp_lt_u32 s67, 131072
  s_cbranch_scc1 Cf2_h1s
Cf2_h1p:
  s_nop 2
  v_add_f32_dpp v4, v4, v4 row_ror:4 row_mask:0xf bank_mask:0xf
  v_add_f32_dpp v5, v5, v5 row_ror:4 row_mask:0xf bank_mask:0xf
  s_nop 0
  v_add_f32_dpp v4, v4, v4 row_ror:8 row_mask:0xf bank_mask:0xf
  v_add_f32_dpp v5, v5, v5 row_ror:8 row_mask:0xf bank_mask:0xf
  v_cvt_pk_bf16_f32 v4, v4, v5
  buffer_store_dword v4, v69, s[8:11], s62 offen
  s_xor_b32 s62, s62, 16384
  buffer_store_dword v71, v69, s[8:11], s62 offen
  s_xor_b32 s72, s72, 1
  s_branch Cf2_h2
Cf2_h2r:
  s_mov_b64 exec, vcc
  buffer_load_dwordx4 v[12:15], v76, s[8:11], s65 offen offset:3072 sc1
  s_mov_b64 exec, -1
  s_add_u32 s67, s67, 1
  s_waitcnt vmcnt(4)
  v_max3_u32 v72, v12, v13, v14
  v_max_u32 v72, v72, v15
  ds_write_b128 v76, v[12:15] offset:7680
  v_cmp_eq_u32 vcc, -1, v72
  s_cbranch_vccz Cf2_h2w
  s_mov_b64 exec, vcc
  buffer_load_dwordx4 v[12:15], v76, s[8:11], s65 offen offset:3072 sc1
  s_mov_b64 exec, -1
  s_add_u32 s67, s67, 1
  s_waitcnt vmcnt(4)
  v_max3_u32 v72, v12, v13, v14
  v_max_u32 v72, v72, v15
  ds_write_b128 v76, v[12:15] offset:7680
  v_cmp_eq_u32 vcc, -1, v72
  s_cbranch_vccz Cf2_h2w
Cf2_h2s:
  s_mov_b64 exec, vcc
  buffer_load_dwordx4 v[12:15], v76, s[8:11], s65 offen offset:3072 sc1
  s_mov_b64 exec, -1
  s_add_u32 s67, s67, 1
  s_waitcnt vmcnt(2)
  v_max3_u32 v72, v12, v13, v14
  v_max_u32 v72, v72, v15
  ds_write_b128 v76, v[12:15] offset:7680
  v_cmp_eq_u32 vcc, -1, v72
  s_cbranch_vccz Cf2_h2w
  s_mov_b64 exec, vcc
  buffer_load_dwordx4 v[12:15], v76, s[8:11], s65 offen offset:3072 sc1
  s_mov_b64 exec, -1
  s_add_u32 s67, s67, 1
  s_waitcnt vmcnt(2)
  v_max3_u32 v72, v12, v13, v14
  v_max_u32 v72, v72, v15
  ds_write_b128 v76, v[12:15] offset:7680
  v_cmp_eq_u32 vcc, -1, v72
  s_cbranch_vccz Cf2_h2w
  s_mov_b64 exec, vcc
  buffer_load_dwordx4 v[12:15], v76, s[8:11], s65 offen offset:3072 sc1
  s_mov_b64 exec, -1
  s_add_u32 s67, s67, 1
  s_waitcnt vmcnt(2)
  v_max3_u32 v72, v12, v13, v14
  v_max_u32 v72, v72, v15
  ds_write_b128 v76, v[12:15] offset:7680
  v_cmp_eq_u32 vcc, -1, v72
  s_cbranch_vccz Cf2_h2w
  s_cmp_lt_u32 s67, 131072
  s_cbranch_scc1 Cf2_h2s
  s_branch Cf2_h2w
Cf2_rec:
  s_nop 7
  s_waitcnt vmcnt(0) lgkmcnt(0)
  v_max3_u32 v72, v0, v1, v2
  v_max3_u32 v72, v72, v3, v4
  v_max3_u32 v72, v72, v5, v6
  v_max3_u32 v72, v72, v7, v8
  v_max3_u32 v72, v72, v9, v10
  v_max3_u32 v72, v72, v11, v12
  v_max3_u32 v72, v72, v13, v14
  v_max3_u32 v72, v72, v15, v16
  v_max3_u32 v72, v72, v17, v18
  v_max_u32 v72, v72, v19
  v_cmp_eq_u32 vcc, -1, v72
  s_cbranch_vccz Cf2_recok
  s_barrier
Cf2_recp:
  buffer_load_dwordx4 v[0:3], v76, s[8:11], s64 offen offset:0 sc1
  buffer_load_dwordx4 v[4:7], v76, s[8:11], s64 offen offset:1024 sc1
  s_add_u32 s67, s67, 1
  s_cmp_lt_u32 s67, 131072
  s_cselect_b32 s54, -2, -1
  s_waitcnt vmcnt(1)
  v_max3_u32 v72, v0, v1, v2
  s_waitcnt vmcnt(0)
  v_max3_u32 v72, v72, v3, v4
  v_max3_u32 v72, v72, v5, v6
  v_max_u32 v72, v72, v7
  v_cmp_lt_u32 vcc, s54, v72
  s_cbranch_vccnz Cf2_recp
  ds_write_b128 v76, v[0:3] offset:8704
  ds_write_b128 v76, v[4:7] offset:9728
  v_mov_b64 v[20:21], 0
  v_mov_b64 v[22:23], 0
  v_mov_b64 v[24:25], 0
  v_mov_b64 v[26:27], 0
  v_mov_b64 v[28:29], 0
  v_mov_b64 v[30:31], 0
  v_mov_b64 v[32:33], 0
  v_mov_b64 v[34:35], 0
  s_waitcnt lgkmcnt(0)
  s_barrier
  ds_read_b128 v[0:3], v76 offset:4608
  s_waitcnt lgkmcnt(0)
  v_smfmac_f32_16x16x64_bf16 v[20:23], v[0:3], v[80:87], v74
  v_smfmac_f32_16x16x64_bf16 v[24:27], v[0:3], v[88:95], v74
  ds_read_b128 v[60:63], v76 offset:24576
  ds_read_b128 v[64:67], v76 offset:25600
  s_waitcnt lgkmcnt(0)
  v_smfmac_f32_16x16x64_bf16 v[28:31], v[0:3], v[60:67], v74
  ds_read_b128 v[60:63], v76 offset:26624
  ds_read_b128 v[64:67], v76 offset:27648
  s_waitcnt lgkmcnt(0)
  v_smfmac_f32_16x16x64_bf16 v[32:35], v[0:3], v[60:67], v74
  ds_read_b128 v[4:7], v76 offset:5632
  s_waitcnt lgkmcnt(0)
  v_smfmac_f32_16x16x64_bf16 v[20:23], v[4:7], v[96:103], v74
  v_smfmac_f32_16x16x64_bf16 v[24:27], v[4:7], v[104:111], v74
  ds_read_b128 v[60:63], v76 offset:40960
  ds_read_b128 v[64:67], v76 offset:41984
  s_waitcnt lgkmcnt(0)
  v_smfmac_f32_16x16x64_bf16 v[28:31], v[4:7], v[60:67], v74
  ds_read_b128 v[60:63], v76 offset:43008
  ds_read_b128 v[64:67], v76 offset:44032
  s_waitcnt lgkmcnt(0)
  v_smfmac_f32_16x16x64_bf16 v[32:35], v[4:7], v[60:67], v74
  ds_read_b128 v[8:11], v76 offset:6656
  s_waitcnt lgkmcnt(0)
  v_smfmac_f32_16x16x64_bf16 v[20:23], v[8:11], v[112:119], v74
  v_smfmac_f32_16x16x64_bf16 v[24:27], v[8:11], v[120:127], v74
  v_smfmac_f32_16x16x64_bf16 v[28:31], v[8:11], v[208:215], v74
  v_smfmac_f32_16x16x64_bf16 v[32:35], v[8:11], v[216:223], v74
  ds_read_b128 v[12:15], v76 offset:7680
  s_waitcnt lgkmcnt(0)
  v_smfmac_f32_16x16x64_bf16 v[20:23], v[12:15], v[128:135], v74
  v_smfmac_f32_16x16x64_bf16 v[24:27], v[12:15], v[136:143], v74
  v_smfmac_f32_16x16x64_bf16 v[28:31], v[12:15], v[224:231], v74
  v_smfmac_f32_16x16x64_bf16 v[32:35], v[12:15], v[232:239], v74
  ds_read_b128 v[12:15], v76 offset:8704
  s_waitcnt lgkmcnt(0)
  v_smfmac_f32_16x16x64_bf16 v[20:23], v[12:15], v[144:151], v74
  v_smfmac_f32_16x16x64_bf16 v[24:27], v[12:15], v[152:159], v74
  ds_read_b128 v[60:63], v76 offset:57344
  ds_read_b128 v[64:67], v76 offset:58368
  s_waitcnt lgkmcnt(0)
  v_smfmac_f32_16x16x64_bf16 v[28:31], v[12:15], v[60:67], v74
  ds_read_b128 v[60:63], v76 offset:59392
  ds_read_b128 v[64:67], v76 offset:60416
  s_waitcnt lgkmcnt(0)
  v_smfmac_f32_16x16x64_bf16 v[32:35], v[12:15], v[60:67], v74
  ds_read_b128 v[0:3], v76 offset:9728
  s_waitcnt lgkmcnt(0)
  v_smfmac_f32_16x16x64_bf16 v[20:23], v[0:3], v[160:167], v74
  v_smfmac_f32_16x16x64_bf16 v[24:27], v[0:3], v[168:175], v74
  ds_read_b128 v[60:63], v75 offset:24576
  ds_read_b128 v[64:67], v75 offset:25600
  s_waitcnt lgkmcnt(0)
  v_smfmac_f32_16x16x64_bf16 v[28:31], v[0:3], v[60:67], v74
  ds_read_b128 v[60:63], v75 offset:26624
  ds_read_b128 v[64:67], v75 offset:27648
  s_waitcnt lgkmcnt(0)
  v_smfmac_f32_16x16x64_bf16 v[32:35], v[0:3], v[60:67], v74
  ds_read_b128 v[16:19], v76 offset:10752
  ds_read_b128 v[60:63], v75 offset:8192
  ds_read_b128 v[64:67], v75 offset:9216
  s_waitcnt lgkmcnt(0)
  v_smfmac_f32_16x16x64_bf16 v[20:23], v[16:19], v[60:67], v74
  ds_read_b128 v[60:63], v75 offset:10240
  ds_read_b128 v[64:67], v75 offset:11264
  s_waitcnt lgkmcnt(0)
  v_smfmac_f32_16x16x64_bf16 v[24:27], v[16:19], v[60:67], v74
  v_smfmac_f32_16x16x64_bf16 v[28:31], v[16:19], v[240:247], v74
  v_smfmac_f32_16x16x64_bf16 v[32:35], v[16:19], v[248:255], v74
  ds_read_b128 v[4:7], v76 offset:11776
  s_waitcnt lgkmcnt(0)
  v_smfmac_f32_16x16x64_bf16 v[20:23], v[4:7], v[176:183], v74
  v_smfmac_f32_16x16x64_bf16 v[24:27], v[4:7], v[184:191], v74
  v_smfmac_f32_16x16x64_bf16 v[28:31], v[4:7], a[0:7], v74
  v_smfmac_f32_16x16x64_bf16 v[32:35], v[4:7], a[8:15], v74
  ds_read_b128 v[8:11], v76 offset:12800
  s_waitcnt lgkmcnt(0)
  v_smfmac_f32_16x16x64_bf16 v[20:23], v[8:11], v[192:199], v74
  v_smfmac_f32_16x16x64_bf16 v[24:27], v[8:11], v[200:207], v74
  v_smfmac_f32_16x16x64_bf16 v[28:31], v[8:11], a[16:23], v74
  v_smfmac_f32_16x16x64_bf16 v[32:35], v[8:11], a[24:31], v74
  v_add_f32 v20, v20, v22
  v_add_f32 v21, v21, v23
  v_add_f32 v24, v24, v26
  v_cvt_pk_bf16_f32 v22, v20, v24
  ds_write_b32 v79, v22 offset:0
  v_add_f32 v25, v25, v27
  v_cvt_pk_bf16_f32 v23, v21, v25
  ds_write_b32 v79, v23 offset:576
  v_add_f32 v28, v28, v30
  v_add_f32 v29, v29, v31
  s_waitcnt lgkmcnt(0)
  s_nop 1
  s_branch Cf2_recok
Cf2_mx:
  s_waitcnt lgkmcnt(0)
  s_barrier
  buffer_load_dwordx4 v[0:3], v76, s[8:11], s58 offen offset:0 sc1
  ds_read_b128 v[20:23], v77 offset:0
  ds_read_b128 v[28:31], v77 offset:256
  buffer_load_dwordx4 v[4:7], v76, s[8:11], s58 offen offset:1024 sc1
  ds_read_b128 v[24:27], v77 offset:128
  ds_read_b128 v[32:35], v77 offset:384
  s_waitcnt vmcnt(1) lgkmcnt(3)
  v_mfma_f32_16x16x32_bf16 v[8:11], v[0:3], v[20:23], 0
  s_waitcnt vmcnt(0) lgkmcnt(1)
  v_mfma_f32_16x16x32_bf16 v[8:11], v[4:7], v[24:27], v[8:11]
  v_mfma_f32_16x16x32_bf16 v[12:15], v[28:31], v[20:23], 0
  s_waitcnt lgkmcnt(0)
  v_mfma_f32_16x16x32_bf16 v[12:15], v[32:35], v[24:27], v[12:15]
  v_add_f32_dpp v8, v10, v8 quad_perm:[2,3,0,1] row_mask:0xf bank_mask:0xf
  v_add_f32_dpp v9, v11, v9 quad_perm:[2,3,0,1] row_mask:0xf bank_mask:0xf
  s_nop 0
  v_mov_b32_dpp v8, v8 quad_perm:[0,1,0,1] row_mask:0xf bank_mask:0xf
  v_mov_b32_dpp v9, v9 quad_perm:[0,1,0,1] row_mask:0xf bank_mask:0xf
  s_nop 1
  v_add_f32_dpp v12, v14, v12 quad_perm:[2,3,0,1] row_mask:0xf bank_mask:0xf
  v_add_f32_dpp v13, v15, v13 quad_perm:[2,3,0,1] row_mask:0xf bank_mask:0xf
  s_nop 0
  v_mov_b32_dpp v12, v12 quad_perm:[0,1,0,1] row_mask:0xf bank_mask:0xf
  v_mov_b32_dpp v13, v13 quad_perm:[0,1,0,1] row_mask:0xf bank_mask:0xf
  v_mul_f32 v12, s69, v12
  ds_write_b32 v78, v8 offset:8712
  v_mul_f32 v13, s69, v13
  ds_write_b32 v78, v9 offset:8776
  s_waitcnt lgkmcnt(0)
  s_barrier
  ds_read_b128 v[36:39], v78 offset:8704
  ds_read_b128 v[40:43], v78 offset:8768
  s_waitcnt lgkmcnt(0)
  s_barrier
  v_max_f32 v16, v36, v37
  v_max3_f32 v16, v16, v38, v39
  v_max3_f32 v16, v16, v40, v41
  v_max3_f32 v16, v16, v42, v43
  v_max3_f32 v16, v16, v12, v13
  v_mov_b32 v17, v16
  s_nop 1
  v_permlane16_swap_b32 v16, v17
  v_max_f32 v16, v16, v17
  v_mov_b32 v17, v16
  s_nop 1
  v_permlane32_swap_b32 v16, v17
  v_max_f32 v16, v16, v17
  v_sub_f32 v36, v36, v16
  v_sub_f32 v37, v37, v16
  v_sub_f32 v38, v38, v16
  v_sub_f32 v39, v39, v16
  v_sub_f32 v40, v40, v16
  v_sub_f32 v41, v41, v16
  v_sub_f32 v42, v42, v16
  v_sub_f32 v43, v43, v16
  v_sub_f32 v12, v12, v16
  v_sub_f32 v13, v13, v16
  v_exp_f32 v36, v36
  v_exp_f32 v37, v37
  v_exp_f32 v38, v38
  v_exp_f32 v39, v39
  v_exp_f32 v40, v40
  v_exp_f32 v41, v41
  v_exp_f32 v42, v42
  v_exp_f32 v43, v43
  v_exp_f32 v12, v12
  v_exp_f32 v13, v13
  v_cvt_pk_bf16_f32 v32, v36, v40
  v_cvt_pk_bf16_f32 v33, v37, v41
  v_cvt_pk_bf16_f32 v34, v38, v42
  v_cvt_pk_bf16_f32 v35, v39, v43
  v_cvt_pk_bf16_f32 v28, v12, v13
  v_cvt_pk_bf16_f32 v31, v12, v13
  v_mov_b32 v29, 0
  v_mov_b32 v30, 0
  v_mov_b32 v68, 0x3f803f80
  v_mov_b32 v69, 0x3f803f80
  v_mov_b32 v70, 0x3f803f80
  v_mov_b32 v71, 0x3f803f80
  s_nop 1
  v_mfma_f32_16x16x32_bf16 v[8:11], v[32:35], v[68:71], 0
  v_mfma_f32_16x16x32_bf16 v[0:3], v[32:35], v[52:55], 0
  v_mfma_f32_16x16x32_bf16 v[4:7], v[32:35], v[56:59], 0
  v_mfma_f32_16x16x16_bf16 v[8:11], v[28:29], v[68:69], v[8:11]
  v_mfma_f32_16x16x16_bf16 v[0:3], v[28:29], v[72:73], v[0:3]
  v_mfma_f32_16x16x16_bf16 v[4:7], v[30:31], v[72:73], v[4:7]
  ds_read_b128 v[68:71], v76 offset:13824
  v_rcp_f32 v10, v8
  v_rcp_f32 v11, v9
  v_mul_f32 v0, v10, v0
  v_mul_f32 v1, v11, v1
  s_nop 0
  v_mul_f32 v4, v10, v4
  v_mul_f32 v5, v11, v5
  v_cvt_pk_bf16_f32 v2, v0, v4
  ds_write_b32 v79, v2 offset:8704
  v_cvt_pk_bf16_f32 v3, v1, v5
  ds_write_b32 v79, v3 offset:9280
  v_mov_b64 v[16:17], 0
  v_mov_b64 v[18:19], 0
  v_mov_b64 v[20:21], 0
  v_mov_b64 v[22:23], 0
  v_mov_b64 v[24:25], 0
  v_mov_b64 v[26:27], 0
  s_branch Cf2_mxok
Cf2_last:
  ds_read_b128 v[4:7], v76 offset:5632
  ds_read_b128 v[8:11], v76 offset:6656
  ds_read_b128 v[44:47], v76 offset:40960
  ds_read_b128 v[48:51], v76 offset:41984
  s_nop 5
  v_mov_b64 v[20:21], 0
  v_mov_b64 v[22:23], 0
  v_mov_b64 v[24:25], 0
  v_mov_b64 v[26:27], 0
  s_waitcnt lgkmcnt(4)
  v_smfmac_f32_16x16x64_bf16 v[28:31], v[0:3], v[36:43], v74
  ds_read_b128 v[36:39], v76 offset:43008
  ds_read_b128 v[40:43], v76 offset:44032
  v_smfmac_f32_16x16x64_bf16 v[32:35], v[0:3], v[60:67], v74
  s_waitcnt lgkmcnt(5)
  v_smfmac_f32_16x16x64_bf16 v[20:23], v[0:3], a[32:39], v74
  ds_read_b128 v[60:63], v76 offset:57344
  ds_read_b128 v[64:67], v76 offset:58368
  v_smfmac_f32_16x16x64_bf16 v[24:27], v[0:3], a[40:47], v74
  s_waitcnt lgkmcnt(4)
  v_smfmac_f32_16x16x64_bf16 v[20:23], v[4:7], a[48:55], v74
  buffer_store_dwordx4 v[16:19], v76, s[8:11], s68 offen sc1
  v_smfmac_f32_16x16x64_bf16 v[24:27], v[4:7], a[56:63], v74
  v_smfmac_f32_16x16x64_bf16 v[28:31], v[4:7], v[44:51], v74
  s_waitcnt lgkmcnt(2)
  v_smfmac_f32_16x16x64_bf16 v[20:23], v[8:11], a[64:71], v74
  ds_read_b128 v[44:47], v76 offset:59392
  ds_read_b128 v[48:51], v76 offset:60416
  v_smfmac_f32_16x16x64_bf16 v[24:27], v[8:11], a[72:79], v74
  v_smfmac_f32_16x16x64_bf16 v[32:35], v[4:7], v[36:43], v74
  v_smfmac_f32_16x16x64_bf16 v[28:31], v[8:11], v[208:215], v74
  ds_read_b128 v[36:39], v75 offset:24576
  ds_read_b128 v[40:43], v75 offset:25600
  v_smfmac_f32_16x16x64_bf16 v[32:35], v[8:11], v[216:223], v74
  v_smfmac_f32_16x16x64_bf16 v[20:23], v[12:15], a[80:87], v74
  v_smfmac_f32_16x16x64_bf16 v[24:27], v[12:15], a[88:95], v74
  v_smfmac_f32_16x16x64_bf16 v[28:31], v[12:15], v[224:231], v74
  v_smfmac_f32_16x16x64_bf16 v[32:35], v[12:15], v[232:239], v74
  s_waitcnt vmcnt(2)
  s_waitcnt vmcnt(1)
  s_barrier
Cf2_lastr:
  ds_read_b128 v[12:15], v76 offset:8704
  ds_read_b128 v[0:3], v76 offset:9728
  ds_read_b128 v[16:19], v76 offset:10752
  ds_read_b128 v[4:7], v76 offset:11776
  ds_read_b128 v[8:11], v76 offset:12800
  s_waitcnt lgkmcnt(3)
  v_max3_u32 v72, v0, v1, v2
  s_waitcnt lgkmcnt(1)
  v_max3_u32 v72, v72, v3, v4
  v_max3_u32 v72, v72, v5, v6
  s_waitcnt lgkmcnt(0)
  v_max3_u32 v72, v72, v7, v8
  v_max3_u32 v72, v72, v9, v10
  v_max3_u32 v72, v72, v11, v12
  v_max3_u32 v72, v72, v13, v14
  v_max3_u32 v72, v72, v15, v16
  v_max3_u32 v72, v72, v17, v18
  v_max_u32 v72, v72, v19
  v_cmp_eq_u32 vcc, -1, v72
  s_cbranch_vccnz Cf2_lastp
Cf2_lastg:
  v_smfmac_f32_16x16x64_bf16 v[28:31], v[12:15], v[60:67], v74
  ds_read_b128 v[60:63], v75 offset:26624
  ds_read_b128 v[64:67], v75 offset:27648
  v_smfmac_f32_16x16x64_bf16 v[32:35], v[12:15], v[44:51], v74
  v_smfmac_f32_16x16x64_bf16 v[28:31], v[0:3], v[36:43], v74
  v_smfmac_f32_16x16x64_bf16 v[28:31], v[16:19], v[240:247], v74
  v_smfmac_f32_16x16x64_bf16 v[28:31], v[4:7], a[0:7], v74
  v_smfmac_f32_16x16x64_bf16 v[28:31], v[8:11], a[16:23], v74
  v_smfmac_f32_16x16x64_bf16 v[32:35], v[16:19], v[248:255], v74
  v_smfmac_f32_16x16x64_bf16 v[32:35], v[4:7], a[8:15], v74
  s_waitcnt lgkmcnt(0)
  v_smfmac_f32_16x16x64_bf16 v[32:35], v[8:11], a[24:31], v74
  v_smfmac_f32_16x16x64_bf16 v[32:35], v[0:3], v[60:67], v74
  v_smfmac_f32_16x16x64_bf16 v[20:23], v[12:15], a[96:103], v74
  v_smfmac_f32_16x16x64_bf16 v[20:23], v[0:3], a[112:119], v74
  v_add_f32 v28, v28, v30
  v_add_f32 v32, v32, v34
  v_cvt_pk_bf16_f32 v30, v28, v32
  v_smfmac_f32_16x16x64_bf16 v[20:23], v[16:19], a[128:135], v74
  ds_write_b32 v79, v30 offset:256
  v_add_f32 v29, v29, v31
  v_add_f32 v33, v33, v35
  v_cvt_pk_bf16_f32 v31, v29, v33
  v_smfmac_f32_16x16x64_bf16 v[20:23], v[4:7], a[144:151], v74
  ds_write_b32 v79, v31 offset:832
  v_smfmac_f32_16x16x64_bf16 v[20:23], v[8:11], a[160:167], v74
  v_smfmac_f32_16x16x64_bf16 v[24:27], v[12:15], a[104:111], v74
  v_smfmac_f32_16x16x64_bf16 v[24:27], v[0:3], a[120:127], v74
  v_smfmac_f32_16x16x64_bf16 v[24:27], v[16:19], a[136:143], v74
  s_waitcnt lgkmcnt(0)
  s_barrier
  ds_read_b64 v[52:53], v77 offset:384
  v_add_f32 v20, v20, v22
  v_smfmac_f32_16x16x64_bf16 v[24:27], v[4:7], a[152:159], v74
  v_add_f32 v21, v21, v23
  v_smfmac_f32_16x16x64_bf16 v[24:27], v[8:11], a[168:175], v74
  v_cvt_pk_bf16_f32 v54, v20, v21
  s_add_u32 s68, s68, 655360
  s_nop 3
  v_add_f32 v24, v24, v26
  v_add_f32 v25, v25, v27
  v_cvt_pk_bf16_f32 v55, v24, v25
  s_waitcnt lgkmcnt(0)
  buffer_store_dwordx4 v[52:55], v76, s[8:11], s68 offen sc1
  s_branch Cf2_done
Cf2_lastp:
  s_add_u32 s72, s72, 2
  s_cmp_ge_u32 s72, 131072
  s_cbranch_scc1 Cf2_lastg
  s_barrier
  buffer_load_dwordx4 v76, s[8:11], s85 offen offset:0 sc1 lds
  s_waitcnt vmcnt(0)
  s_barrier
  s_branch Cf2_lastr
Cf2_done:
  s_branch L_cexit
L_w3:
  v_mov_b64 v[20:21], 0
  v_mov_b64 v[22:23], 0
  v_mov_b64 v[24:25], 0
  v_mov_b64 v[26:27], 0
  v_mov_b64 v[28:29], 0
  v_mov_b64 v[30:31], 0
  v_mov_b64 v[32:33], 0
  v_mov_b64 v[34:35], 0
  s_mov_b32 s78, 0x3f803f80
  s_mov_b32 s79, s78
  s_mov_b32 s65, 360448
  s_mov_b32 m0, 15872
  s_lshl_b32 s71, s53, 2
  s_add_u32 s71, s71, 128
  s_movk_i32 s56, 0x1000
  v_lshlrev_b32 v73, 2, v76
  v_mov_b32 v72, 0
  s_mov_b64 s[16:17], s[8:9]
  s_mov_b32 s18, 268435456
  s_mov_b32 s19, 0x20000
  s_getpc_b64 s[20:21]
Cf3_pc:
  s_add_u32 s20, s20, (Cf3_last - Cf3_pc)
  s_addc_u32 s21, s21, 0
  v_mov_b32 v68, 14880
  buffer_load_dwordx4 v[52:55], v76, s[8:11], s59 offen offset:0 sc1
  buffer_load_dwordx4 v[56:59], v76, s[8:11], s59 offen offset:1024 sc1
  ds_read_b128 v[36:39], v76 offset:45056
  ds_read_b128 v[40:43], v76 offset:46080
  ds_read_b128 v[60:63], v76 offset:47104
  ds_read_b128 v[64:67], v76 offset:48128
  ds_read_b128 v[0:3], v76 offset:4608
  ds_read_b128 v[4:7], v76 offset:5632
  ds_read_b128 v[8:11], v76 offset:6656
  ds_read_b128 v[12:15], v76 offset:7680
  s_waitcnt lgkmcnt(0)
  s_cmp_eq_u32 s66, 1
  s_branch Cf3_top2
.p2align 6
Cf3_h2:
  v_lshlrev_b32 v73, 2, v76
  buffer_load_dwordx4 v[4:7], v76, s[8:11], s65 offen offset:1024 sc1
  ds_read_b128 v[36:39], v76 offset:45056
  ds_read_b128 v[40:43], v76 offset:46080
  buffer_load_dwordx4 v[52:55], v76, s[8:11], s59 offen offset:0 sc1
  buffer_load_dwordx4 v[56:59], v76, s[8:11], s59 offen offset:1024 sc1
  s_waitcnt vmcnt(7)
  v_max3_u32 v72, v4, v5, v6
  v_max_u32 v72, v72, v7
  ds_write_b128 v76, v[4:7] offset:5632
  v_cmp_eq_u32 vcc, -1, v72
  s_cbranch_vccnz Cf3_h2r
Cf3_h2w:
  buffer_load_dwordx4 v76, s[8:11], s85 offen offset:0 sc1 lds
  buffer_load_dwordx4 v76, s[8:11], s85 offen offset:1024 sc1 lds
  s_cmp_eq_u32 s66, 63
  s_waitcnt lgkmcnt(0)
  s_barrier
  ds_read_b128 v[8:11], v76 offset:6656
Cf3_top2:
  v_smfmac_f32_16x16x64_bf16 v[20:23], v[4:7], v[96:103], v74
  s_cbranch_scc1 Cf3_last
  v_smfmac_f32_16x16x64_bf16 v[28:31], v[4:7], v[36:43], v74
  buffer_load_dwordx4 v[44:47], v76, s[8:11], s58 offen offset:0 sc1
  s_mov_b32 m0, 15872
  v_smfmac_f32_16x16x64_bf16 v[24:27], v[4:7], v[104:111], v74
  buffer_load_dwordx4 v[48:51], v76, s[8:11], s58 offen offset:1024 sc1
  v_smfmac_f32_16x16x64_bf16 v[32:35], v[4:7], v[60:67], v74
  ds_read_b128 v[0:3], v76 offset:4608
  s_waitcnt lgkmcnt(1)
  v_smfmac_f32_16x16x64_bf16 v[20:23], v[8:11], v[112:119], v74
  ds_read_b128 v[12:15], v76 offset:7680
  v_smfmac_f32_16x16x64_bf16 v[24:27], v[8:11], v[120:127], v74
  ds_read_b128 v[36:39], v76 offset:28672
  v_smfmac_f32_16x16x64_bf16 v[28:31], v[8:11], v[208:215], v74
  buffer_store_dwordx4 v[16:19], v76, s[8:11], s68 offen sc1
  ds_read_b128 v[40:43], v76 offset:29696
  v_smfmac_f32_16x16x64_bf16 v[32:35], v[8:11], v[216:223], v74
  ds_read_b128 v[60:63], v76 offset:30720
  s_waitcnt lgkmcnt(4)
  v_smfmac_f32_16x16x64_bf16 v[20:23], v[0:3], v[80:87], v74
  ds_read_b128 v[64:67], v76 offset:31744
  v_smfmac_f32_16x16x64_bf16 v[24:27], v[0:3], v[88:95], v74
  buffer_load_dword v73, s[16:19], s70 offen lds
  s_waitcnt vmcnt(4)
  s_waitcnt lgkmcnt(4)
  v_smfmac_f32_16x16x64_bf16 v[20:23], v[12:15], v[128:135], v74
  s_barrier
  s_waitcnt lgkmcnt(2)
  v_smfmac_f32_16x16x64_bf16 v[28:31], v[0:3], v[36:43], v74
  ds_read_b128 v[4:7], v76 offset:8704
  v_smfmac_f32_16x16x64_bf16 v[24:27], v[12:15], v[136:143], v74
  ds_read_b128 v[36:39], v76 offset:61440
  s_waitcnt lgkmcnt(2)
  v_smfmac_f32_16x16x64_bf16 v[32:35], v[0:3], v[60:67], v74
  ds_read_b128 v[40:43], v76 offset:62464
  v_smfmac_f32_16x16x64_bf16 v[28:31], v[12:15], v[224:231], v74
  ds_read_b128 v[60:63], v76 offset:63488
  v_smfmac_f32_16x16x64_bf16 v[32:35], v[12:15], v[232:239], v74
  ds_read_b128 v[64:67], v76 offset:64512
  s_waitcnt lgkmcnt(4)
  v_smfmac_f32_16x16x64_bf16 v[20:23], v[4:7], v[144:151], v74
  ds_read_b128 v[8:11], v76 offset:9728
  s_waitcnt lgkmcnt(3)
  v_smfmac_f32_16x16x64_bf16 v[28:31], v[4:7], v[36:43], v74
  s_barrier
  ds_read_b128 v[0:3], v76 offset:11776
  v_smfmac_f32_16x16x64_bf16 v[24:27], v[4:7], v[152:159], v74
  ds_read_b128 v[36:39], v75 offset:12288
  ds_read_b128 v[40:43], v75 offset:13312
  s_waitcnt lgkmcnt(4)
  v_smfmac_f32_16x16x64_bf16 v[32:35], v[4:7], v[60:67], v74
  ds_read_b128 v[16:19], v76 offset:10752
  s_waitcnt lgkmcnt(4)
  v_smfmac_f32_16x16x64_bf16 v[20:23], v[8:11], v[160:167], v74
  ds_read_b128 v[12:15], v76 offset:12800
  v_smfmac_f32_16x16x64_bf16 v[24:27], v[8:11], v[168:175], v74
  ds_read_b128 v[60:63], v75 offset:14336
  ds_read_b128 v[64:67], v75 offset:15360
  s_waitcnt lgkmcnt(6)
  v_smfmac_f32_16x16x64_bf16 v[20:23], v[0:3], v[176:183], v74
  s_waitcnt lgkmcnt(3)
  v_smfmac_f32_16x16x64_bf16 v[20:23], v[16:19], v[36:43], v74
  ds_read_b128 v[36:39], v75 offset:28672
  s_waitcnt lgkmcnt(3)
  v_smfmac_f32_16x16x64_bf16 v[20:23], v[12:15], v[192:199], v74
  ds_read_b128 v[40:43], v75 offset:29696
  s_waitcnt lgkmcnt(2)
  v_smfmac_f32_16x16x64_bf16 v[24:27], v[16:19], v[60:67], v74
  ds_read_b128 v[60:63], v75 offset:30720
  v_smfmac_f32_16x16x64_bf16 v[24:27], v[0:3], v[184:191], v74
  ds_read_b128 v[64:67], v75 offset:31744
  v_add_f32 v20, v20, v22
  v_smfmac_f32_16x16x64_bf16 v[24:27], v[12:15], v[200:207], v74
  v_add_f32 v21, v21, v23
  v_smfmac_f32_16x16x64_bf16 v[28:31], v[16:19], v[240:247], v74
  s_waitcnt lgkmcnt(2)
  v_mov_b64 v[70:71], s[78:79]
  v_smfmac_f32_16x16x64_bf16 v[28:31], v[8:11], v[36:43], v74
  ds_read_b128 v[36:39], v68
  v_add_f32 v24, v24, v26
  v_smfmac_f32_16x16x64_bf16 v[28:31], v[0:3], a[0:7], v74
  ds_read_b128 v[40:43], v68
  v_cvt_pk_bf16_f32 v22, v20, v24
  v_smfmac_f32_16x16x64_bf16 v[28:31], v[12:15], a[16:23], v74
  ds_write_b32 v79, v22 offset:0
  s_waitcnt lgkmcnt(3)
  v_add_f32 v25, v25, v27
  v_cvt_pk_bf16_f32 v23, v21, v25
  v_smfmac_f32_16x16x64_bf16 v[32:35], v[8:11], v[60:67], v74
  ds_write_b32 v79, v23 offset:576
  v_cmp_u_f32 vcc, v20, v21
  v_smfmac_f32_16x16x64_bf16 v[32:35], v[16:19], v[248:255], v74
  v_add_f32 v28, v28, v30
  v_smfmac_f32_16x16x64_bf16 v[32:35], v[0:3], a[8:15], v74
  v_add_f32 v29, v29, v31
  v_smfmac_f32_16x16x64_bf16 v[32:35], v[12:15], a[24:31], v74
  s_cbranch_vccnz Cf3_rec
Cf3_recok:
  s_waitcnt lgkmcnt(3)
  v_smfmac_f32_16x16x64_bf16 v[36:39], v[16:19], a[128:135], v74
  s_waitcnt lgkmcnt(0)
  s_barrier
  ds_read_b128 v[60:63], v77
  v_smfmac_f32_16x16x64_bf16 v[40:43], v[16:19], a[136:143], v74
  ds_read_b128 v[64:67], v77 offset:128
  v_add_f32 v32, v32, v34
  v_cvt_pk_bf16_f32 v30, v28, v32
  v_smfmac_f32_16x16x64_bf16 v[36:39], v[0:3], a[144:151], v74
  ds_write_b32 v79, v30 offset:256
  v_add_f32 v33, v33, v35
  v_cvt_pk_bf16_f32 v31, v29, v33
  v_smfmac_f32_16x16x64_bf16 v[40:43], v[0:3], a[152:159], v74
  ds_write_b32 v79, v31 offset:832
  v_xor_b32 v75, 0x8000, v75
  v_smfmac_f32_16x16x64_bf16 v[36:39], v[4:7], a[96:103], v74
  ds_read_b128 v[0:3], v76 offset:4608
  v_mov_b32 v29, 0
  v_smfmac_f32_16x16x64_bf16 v[40:43], v[4:7], a[104:111], v74
  s_waitcnt vmcnt(2) lgkmcnt(3)
  v_mov_b32 v30, 0
  v_mfma_f32_16x16x32_bf16 v[44:47], v[44:47], v[60:63], 0
  ds_read_b128 v[4:7], v76 offset:5632
  s_waitcnt lgkmcnt(2)
  v_mfma_f32_16x16x32_bf16 v[44:47], v[48:51], v[64:67], v[44:47]
  s_barrier
  v_smfmac_f32_16x16x64_bf16 v[36:39], v[8:11], a[112:119], v74
  ds_read_b128 v[20:23], v77 offset:256
  ds_read_b128 v[24:27], v77 offset:384
  v_smfmac_f32_16x16x64_bf16 v[40:43], v[8:11], a[120:127], v74
  ds_read_b128 v[8:11], v76 offset:6656
  v_add_f32_dpp v72, v46, v44 quad_perm:[2,3,0,1] row_mask:0xf bank_mask:0xf
  v_add_f32_dpp v73, v47, v45 quad_perm:[2,3,0,1] row_mask:0xf bank_mask:0xf
  v_smfmac_f32_16x16x64_bf16 v[36:39], v[12:15], a[160:167], v74
  s_waitcnt lgkmcnt(4)
  v_exp_f32_dpp v72, v72 quad_perm:[0,1,0,1] row_mask:0xf bank_mask:0xf
  v_smfmac_f32_16x16x64_bf16 v[40:43], v[12:15], a[168:175], v74
  ds_read_b128 v[12:15], v76 offset:7680
  v_exp_f32_dpp v73, v73 quad_perm:[0,1,0,1] row_mask:0xf bank_mask:0xf
  v_smfmac_f32_16x16x64_bf16 v[36:39], v[0:3], a[32:39], v74
  s_waitcnt lgkmcnt(2)
  v_cvt_pk_bf16_f32 v72, v72, v73
  v_mfma_f32_16x16x32_bf16 v[20:23], v[20:23], v[60:63], 0
  ds_write_b32 v78, v72 offset:524
  v_mov_b64 v[16:17], 0
  v_mfma_f32_16x16x32_bf16 v[20:23], v[24:27], v[64:67], v[20:23]
  ds_read_b128 v[44:47], v75 offset:28672
  v_mov_b64 v[18:19], 0
  v_smfmac_f32_16x16x64_bf16 v[40:43], v[0:3], a[40:47], v74
  ds_read_b128 v[48:51], v75 offset:29696
  v_mov_b64 v[68:69], s[78:79]
  v_smfmac_f32_16x16x64_bf16 v[36:39], v[4:7], a[48:55], v74
  s_waitcnt lgkmcnt(4)
  v_add_f32_dpp v24, v22, v20 quad_perm:[2,3,0,1] row_mask:0xf bank_mask:0xf
  v_add_f32_dpp v25, v23, v21 quad_perm:[2,3,0,1] row_mask:0xf bank_mask:0xf
  v_smfmac_f32_16x16x64_bf16 v[36:39], v[8:11], a[64:71], v74
  s_waitcnt lgkmcnt(2)
  s_barrier
  ds_read_b128 v[32:35], v78 offset:512
  v_smfmac_f32_16x16x64_bf16 v[36:39], v[12:15], a[80:87], v74
  ds_read_b128 v[60:63], v75 offset:30720
  v_mul_f32 v24, s69, v24
  v_smfmac_f32_16x16x64_bf16 v[40:43], v[4:7], a[56:63], v74
  ds_read_b128 v[64:67], v75 offset:31744
  v_mul_f32 v25, s69, v25
  v_smfmac_f32_16x16x64_bf16 v[40:43], v[8:11], a[72:79], v74
  v_exp_f32_dpp v24, v24 quad_perm:[0,1,0,1] row_mask:0xf bank_mask:0xf
  v_smfmac_f32_16x16x64_bf16 v[40:43], v[12:15], a[88:95], v74
  s_waitcnt lgkmcnt(2)
  v_exp_f32_dpp v25, v25 quad_perm:[0,1,0,1] row_mask:0xf bank_mask:0xf
  v_mfma_f32_16x16x32_bf16 v[8:11], v[32:35], v[68:71], 0
  v_add_f32 v36, v36, v38
  v_add_f32 v37, v37, v39
  v_mfma_f32_16x16x32_bf16 v[0:3], v[32:35], v[52:55], 0
  v_add_f32 v40, v40, v42
  v_add_f32 v41, v41, v43
  v_mfma_f32_16x16x32_bf16 v[4:7], v[32:35], v[56:59], 0
  v_cvt_pk_bf16_f32 v28, v24, v25
  v_cvt_pk_bf16_f32 v72, v36, v37
  v_cvt_pk_bf16_f32 v73, v40, v41
  v_mfma_f32_16x16x16_bf16 v[8:11], v[28:29], v[68:69], v[8:11]
  v_cvt_pk_bf16_f32 v31, v24, v25
  v_mov_b64 v[20:21], 0
  v_mfma_f32_16x16x16_bf16 v[0:3], v[28:29], v[72:73], v[0:3]
  ds_read_b128 v[68:71], v76 offset:13824
  v_mov_b64 v[22:23], 0
  v_mfma_f32_16x16x16_bf16 v[4:7], v[30:31], v[72:73], v[4:7]
  v_rcp_f32 v10, v8
  v_rcp_f32 v11, v9
  v_mul_f32 v0, v10, v0
  v_mul_f32 v1, v11, v1
  s_nop 0
  v_mul_f32 v4, v10, v4
  v_mul_f32 v5, v11, v5
  v_cvt_pk_bf16_f32 v2, v0, v4
  ds_write_b32 v79, v2 offset:8704
  v_cvt_pk_bf16_f32 v3, v1, v5
  ds_write_b32 v79, v3 offset:9280
  v_max3_f32 v8, v8, v9, v10
  v_max_f32 v8, v8, v11
  v_cmp_le_f32 vcc, 1317011456, v8
  v_mov_b64 v[24:25], 0
  v_mov_b64 v[26:27], 0
  s_cbranch_vccnz Cf3_mx
Cf3_mxok:
  s_waitcnt lgkmcnt(0)
  s_barrier
  ds_read_b128 v[0:3], v78 offset:8704
  ds_read_b128 v[4:7], v78 offset:8768
  ds_read_b128 v[8:11], v78 offset:8832
  ds_read_b128 v[12:15], v78 offset:8896
  s_waitcnt lgkmcnt(3)
  v_smfmac_f32_16x16x64_bf16 v[16:19], v[0:3], v[44:51], v74
  ds_read_b128 v[52:55], v75 offset:45056
  s_waitcnt lgkmcnt(3)
  v_smfmac_f32_16x16x64_bf16 v[16:19], v[4:7], v[60:67], v74
  ds_read_b128 v[56:59], v75 offset:46080
  s_waitcnt lgkmcnt(3)
  v_smfmac_f32_16x16x64_bf16 v[16:19], v[8:11], a[176:183], v74
  ds_read_b128 v[36:39], v75 offset:47104
  s_waitcnt lgkmcnt(3)
  v_smfmac_f32_16x16x64_bf16 v[16:19], v[12:15], a[184:191], v74
  ds_read_b128 v[40:43], v75 offset:48128
  ds_read_b128 v[44:47], v75 offset:61440
  v_smfmac_f32_16x16x64_bf16 v[20:23], v[0:3], a[192:199], v74
  ds_read_b128 v[48:51], v75 offset:62464
  ds_read_b128 v[60:63], v75 offset:63488
  v_smfmac_f32_16x16x64_bf16 v[20:23], v[4:7], a[200:207], v74
  ds_read_b128 v[64:67], v75 offset:64512
  s_waitcnt lgkmcnt(6)
  v_cvt_pk_bf16_f32 v16, v16, v17
  v_cvt_pk_bf16_f32 v17, v18, v19
  v_bfi_b32 v16, 1, s72, v16
  v_smfmac_f32_16x16x64_bf16 v[20:23], v[8:11], v[52:59], v74
  buffer_store_dwordx2 v[16:17], v68, s[8:11], s73 offen
  s_waitcnt lgkmcnt(4)
  v_smfmac_f32_16x16x64_bf16 v[20:23], v[12:15], v[36:43], v74
  ds_read_b128 v[52:55], v75 offset:8192
  v_mov_b64 v[32:33], 0
  v_smfmac_f32_16x16x64_bf16 v[24:27], v[0:3], a[208:215], v74
  ds_read_b128 v[56:59], v75 offset:9216
  v_mov_b64 v[34:35], 0
  v_smfmac_f32_16x16x64_bf16 v[24:27], v[4:7], a[216:223], v74
  ds_read_b128 v[36:39], v75 offset:10240
  s_waitcnt lgkmcnt(5)
  v_cvt_pk_bf16_f32 v20, v20, v21
  v_cvt_pk_bf16_f32 v21, v22, v23
  v_bfi_b32 v20, 1, s72, v20
  v_smfmac_f32_16x16x64_bf16 v[24:27], v[8:11], v[44:51], v74
  buffer_store_dwordx2 v[20:21], v68, s[8:11], s74 offen
  s_waitcnt lgkmcnt(3)
  v_smfmac_f32_16x16x64_bf16 v[24:27], v[12:15], v[60:67], v74
  ds_read_b128 v[40:43], v75 offset:11264
  v_mov_b64 v[28:29], 0
  v_smfmac_f32_16x16x64_bf16 v[32:35], v[0:3], a[224:231], v74
  ds_read_b128 v[44:47], v75 offset:12288
  ds_read_b128 v[48:51], v75 offset:13312
  v_smfmac_f32_16x16x64_bf16 v[32:35], v[4:7], a[232:239], v74
  ds_read_b128 v[60:63], v75 offset:14336
  v_cvt_pk_bf16_f32 v24, v24, v25
  v_cvt_pk_bf16_f32 v25, v26, v27
  v_bfi_b32 v24, 1, s72, v24
  v_smfmac_f32_16x16x64_bf16 v[32:35], v[8:11], a[240:247], v74
  buffer_store_dwordx2 v[24:25], v68, s[8:11], s75 offen
  v_mov_b64 v[30:31], 0
  v_smfmac_f32_16x16x64_bf16 v[32:35], v[12:15], a[248:255], v74
  ds_read_b128 v[64:67], v75 offset:15360
  s_waitcnt lgkmcnt(6)
  v_smfmac_f32_16x16x64_bf16 v[28:31], v[0:3], v[52:59], v74
  s_waitcnt lgkmcnt(4)
  v_smfmac_f32_16x16x64_bf16 v[28:31], v[4:7], v[36:43], v74
  s_waitcnt lgkmcnt(2)
  v_cvt_pk_bf16_f32 v32, v32, v33
  v_cvt_pk_bf16_f32 v33, v34, v35
  v_bfi_b32 v32, 1, s72, v32
  v_smfmac_f32_16x16x64_bf16 v[28:31], v[8:11], v[44:51], v74
  buffer_store_dwordx2 v[32:33], v68, s[8:11], s76 offen
  s_waitcnt lgkmcnt(0)
  v_smfmac_f32_16x16x64_bf16 v[28:31], v[12:15], v[60:67], v74
  v_mov_b64 v[18:19], v[72:73]
  s_nop 4
  v_cvt_pk_bf16_f32 v28, v28, v29
  v_cvt_pk_bf16_f32 v29, v30, v31
  v_bfi_b32 v28, 1, s72, v28
  buffer_store_dwordx2 v[28:29], v68, s[8:11], s77 offen
  ds_read_b128 v[52:55], v76 offset:14848
  s_waitcnt lgkmcnt(0)
  ds_read_b64 v[16:17], v77 offset:392
  s_waitcnt lgkmcnt(0)
  ds_read_b128 v[60:63], v76 offset:47104
  s_waitcnt lgkmcnt(0)
  ds_read_b128 v[64:67], v76 offset:48128
  s_waitcnt lgkmcnt(0)
  s_add_u32 s66, s66, 1
  s_xor_b32 s64, s64, 16384
  s_xor_b32 s65, s65, 16384
  s_add_u32 s58, s58, 655360
  s_add_u32 s59, s59, 655360
  s_add_u32 s70, s70, 655360
  s_add_u32 s68, s68, 655360
  s_mov_b32 m0, 8704
  s_add_u32 s85, s65, 4096
  v_xor_b32 v75, 0x8000, v75
  buffer_load_dwordx4 v[0:3], v76, s[8:11], s60 offen offset:0 sc1
  buffer_load_dwordx4 v[4:7], v76, s[8:11], s60 offen offset:1024 sc1
  buffer_load_dwordx4 v[8:11], v76, s[8:11], s61 offen offset:0 sc1
  buffer_load_dwordx4 v[12:15], v76, s[8:11], s61 offen offset:1024 sc1
  v_mov_b64 v[20:21], 0
  v_mov_b64 v[22:23], 0
  v_mov_b64 v[24:25], 0
  v_mov_b64 v[26:27], 0
  v_mov_b32 v68, 14880
  v_mov_b64 v[28:29], 0
  v_mov_b64 v[30:31], 0
  v_mov_b64 v[32:33], 0
  v_mov_b64 v[34:35], 0
  s_cmp_eq_u32 s66, 62
  s_cselect_b64 s[16:17], s[20:21], s[16:17]
  s_cselect_b32 s18, (Cf3_done - Cf3_last), s18
  s_cselect_b32 s70, 0, s70
  s_cmp_eq_u32 s66, 63
  s_cselect_b32 s59, 268435456, s59
  s_cselect_b32 s58, 268435456, s58
  s_waitcnt lgkmcnt(0)
  s_waitcnt vmcnt(3)
  v_mfma_f32_16x16x32_bf16 v[56:59], v[52:55], v[0:3], 0
  v_bitop3_b32 v72, v0, v2, s72 bitop3:0x7e
  s_waitcnt vmcnt(2)
  v_mfma_f32_16x16x32_bf16 v[56:59], v[52:55], v[4:7], v[56:59]
  v_bitop3_b32 v73, v4, v6, s72 bitop3:0x7e
  v_or_b32 v72, v72, v73
  s_waitcnt vmcnt(1)
  v_mfma_f32_16x16x32_bf16 v[36:39], v[52:55], v[8:11], 0
  v_bitop3_b32 v73, v8, v10, s72 bitop3:0x7e
  v_or_b32 v72, v72, v73
  s_waitcnt vmcnt(0)
  v_mfma_f32_16x16x32_bf16 v[36:39], v[52:55], v[12:15], v[36:39]
  v_bitop3_b32 v73, v12, v14, s72 bitop3:0x7e
  v_bitop3_b32 v72, v72, v73, 1 bitop3:0xa8
  v_cmp_ne_u32 vcc, 0, v72
  s_cbranch_vccnz Cf3_h1r
  buffer_load_dwordx4 v[4:7], v76, s[8:11], s65 offen offset:1024 sc1
  v_add_f32_dpp v56, v56, v56 row_ror:4 row_mask:0xf bank_mask:0xf
  v_add_f32_dpp v57, v57, v57 row_ror:4 row_mask:0xf bank_mask:0xf
  v_add_f32_dpp v36, v36, v36 row_ror:4 row_mask:0xf bank_mask:0xf
  v_add_f32_dpp v37, v37, v37 row_ror:4 row_mask:0xf bank_mask:0xf
  v_add_f32_dpp v56, v56, v56 row_ror:8 row_mask:0xf bank_mask:0xf
  v_add_f32_dpp v57, v57, v57 row_ror:8 row_mask:0xf bank_mask:0xf
  v_add_f32_dpp v36, v36, v36 row_ror:8 row_mask:0xf bank_mask:0xf
  v_add_f32_dpp v37, v37, v37 row_ror:8 row_mask:0xf bank_mask:0xf
  v_cvt_pk_bf16_f32 v56, v56, v57
  buffer_store_dword v56, v69, s[8:11], s62 offen
  v_cvt_pk_bf16_f32 v36, v36, v37
  buffer_store_dword v36, v70, s[8:11], s63 offen
  s_xor_b32 s62, s62, 16384
  buffer_store_dword v71, v69, s[8:11], s62 offen
  s_xor_b32 s63, s63, 16384
  buffer_store_dword v71, v70, s[8:11], s63 offen
  s_xor_b32 s72, s72, 1
  s_branch Cf3_h2
Cf3_h1r:
  s_mov_b64 exec, vcc
  buffer_load_dwordx4 v[0:3], v76, s[8:11], s60 offen offset:0 sc1
  buffer_load_dwordx4 v[4:7], v76, s[8:11], s60 offen offset:1024 sc1
  buffer_load_dwordx4 v[8:11], v76, s[8:11], s61 offen offset:0 sc1
  buffer_load_dwordx4 v[12:15], v76, s[8:11], s61 offen offset:1024 sc1
  s_mov_b64 exec, -1
  s_add_u32 s67, s67, 1
  s_waitcnt vmcnt(3)
  v_mfma_f32_16x16x32_bf16 v[56:59], v[52:55], v[0:3], 0
  v_bitop3_b32 v72, v0, v2, s72 bitop3:0x7e
  s_waitcnt vmcnt(2)
  v_mfma_f32_16x16x32_bf16 v[56:59], v[52:55], v[4:7], v[56:59]
  v_bitop3_b32 v73, v4, v6, s72 bitop3:0x7e
  v_or_b32 v72, v72, v73
  s_waitcnt vmcnt(1)
  v_mfma_f32_16x16x32_bf16 v[36:39], v[52:55], v[8:11], 0
  v_bitop3_b32 v73, v8, v10, s72 bitop3:0x7e
  v_or_b32 v72, v72, v73
  s_waitcnt vmcnt(0)
  v_mfma_f32_16x16x32_bf16 v[36:39], v[52:55], v[12:15], v[36:39]
  v_bitop3_b32 v73, v12, v14, s72 bitop3:0x7e
  v_bitop3_b32 v72, v72, v73, 1 bitop3:0xa8
  v_cmp_ne_u32 vcc, 0, v72
  s_cbranch_vccz Cf3_h1p
Cf3_h1s:
  s_mov_b64 exec, vcc
  buffer_load_dwordx4 v[0:3], v76, s[8:11], s60 offen offset:0 sc1
  buffer_load_dwordx4 v[4:7], v76, s[8:11], s60 offen offset:1024 sc1
  buffer_load_dwordx4 v[8:11], v76, s[8:11], s61 offen offset:0 sc1
  buffer_load_dwordx4 v[12:15], v76, s[8:11], s61 offen offset:1024 sc1
  s_mov_b64 exec, -1
  s_add_u32 s67, s67, 1
  s_waitcnt vmcnt(3)
  v_mfma_f32_16x16x32_bf16 v[56:59], v[52:55], v[0:3], 0
  v_bitop3_b32 v72, v0, v2, s72 bitop3:0x7e
  s_waitcnt vmcnt(2)
  v_mfma_f32_16x16x32_bf16 v[56:59], v[52:55], v[4:7], v[56:59]
  v_bitop3_b32 v73, v4, v6, s72 bitop3:0x7e
  v_or_b32 v72, v72, v73
  s_waitcnt vmcnt(1)
  v_mfma_f32_16x16x32_bf16 v[36:39], v[52:55], v[8:11], 0
  v_bitop3_b32 v73, v8, v10, s72 bitop3:0x7e
  v_or_b32 v72, v72, v73
  s_waitcnt vmcnt(0)
  v_mfma_f32_16x16x32_bf16 v[36:39], v[52:55], v[12:15], v[36:39]
  v_bitop3_b32 v73, v12, v14, s72 bitop3:0x7e
  v_bitop3_b32 v72, v72, v73, 1 bitop3:0xa8
  v_cmp_ne_u32 vcc, 0, v72
  s_cbranch_vccz Cf3_h1p
  s_cmp_lt_u32 s67, 131072
  s_cbranch_scc1 Cf3_h1s
Cf3_h1p:
  s_nop 2
  buffer_load_dwordx4 v[4:7], v76, s[8:11], s65 offen offset:1024 sc1
  v_add_f32_dpp v56, v56, v56 row_ror:4 row_mask:0xf bank_mask:0xf
  v_add_f32_dpp v57, v57, v57 row_ror:4 row_mask:0xf bank_mask:0xf
  v_add_f32_dpp v36, v36, v36 row_ror:4 row_mask:0xf bank_mask:0xf
  v_add_f32_dpp v37, v37, v37 row_ror:4 row_mask:0xf bank_mask:0xf
  v_add_f32_dpp v56, v56, v56 row_ror:8 row_mask:0xf bank_mask:0xf
  v_add_f32_dpp v57, v57, v57 row_ror:8 row_mask:0xf bank_mask:0xf
  v_add_f32_dpp v36, v36, v36 row_ror:8 row_mask:0xf bank_mask:0xf
  v_add_f32_dpp v37, v37, v37 row_ror:8 row_mask:0xf bank_mask:0xf
  v_cvt_pk_bf16_f32 v56, v56, v57
  buffer_store_dword v56, v69, s[8:11], s62 offen
  v_cvt_pk_bf16_f32 v36, v36, v37
  buffer_store_dword v36, v70, s[8:11], s63 offen
  s_xor_b32 s62, s62, 16384
  buffer_store_dword v71, v69, s[8:11], s62 offen
  s_xor_b32 s63, s63, 16384
  buffer_store_dword v71, v70, s[8:11], s63 offen
  s_xor_b32 s72, s72, 1
  s_branch Cf3_h2
Cf3_h2r:
  s_mov_b64 exec, vcc
  buffer_load_dwordx4 v[4:7], v76, s[8:11], s65 offen offset:1024 sc1
  s_mov_b64 exec, -1
  s_add_u32 s67, s67, 1
  s_waitcnt vmcnt(3)
  v_max3_u32 v72, v4, v5, v6
  v_max_u32 v72, v72, v7
  ds_write_b128 v76, v[4:7] offset:5632
  v_cmp_eq_u32 vcc, -1, v72
  s_cbranch_vccz Cf3_h2w
Cf3_h2s:
  s_mov_b64 exec, vcc
  buffer_load_dwordx4 v[4:7], v76, s[8:11], s65 offen offset:1024 sc1
  s_mov_b64 exec, -1
  s_add_u32 s67, s67, 1
  s_waitcnt vmcnt(1)
  v_max3_u32 v72, v4, v5, v6
  v_max_u32 v72, v72, v7
  ds_write_b128 v76, v[4:7] offset:5632
  v_cmp_eq_u32 vcc, -1, v72
  s_cbranch_vccz Cf3_h2w
  s_mov_b64 exec, vcc
  buffer_load_dwordx4 v[4:7], v76, s[8:11], s65 offen offset:1024 sc1
  s_mov_b64 exec, -1
  s_add_u32 s67, s67, 1
  s_waitcnt vmcnt(1)
  v_max3_u32 v72, v4, v5, v6
  v_max_u32 v72, v72, v7
  ds_write_b128 v76, v[4:7] offset:5632
  v_cmp_eq_u32 vcc, -1, v72
  s_cbranch_vccz Cf3_h2w
  s_mov_b64 exec, vcc
  buffer_load_dwordx4 v[4:7], v76, s[8:11], s65 offen offset:1024 sc1
  s_mov_b64 exec, -1
  s_add_u32 s67, s67, 1
  s_waitcnt vmcnt(1)
  v_max3_u32 v72, v4, v5, v6
  v_max_u32 v72, v72, v7
  ds_write_b128 v76, v[4:7] offset:5632
  v_cmp_eq_u32 vcc, -1, v72
  s_cbranch_vccz Cf3_h2w
  s_cmp_lt_u32 s67, 131072
  s_cbranch_scc1 Cf3_h2s
  s_branch Cf3_h2w
Cf3_rec:
  s_nop 7
  s_waitcnt vmcnt(0) lgkmcnt(0)
  v_max3_u32 v72, v0, v1, v2
  v_max3_u32 v72, v72, v3, v4
  v_max3_u32 v72, v72, v5, v6
  v_max3_u32 v72, v72, v7, v8
  v_max3_u32 v72, v72, v9, v10
  v_max3_u32 v72, v72, v11, v12
  v_max3_u32 v72, v72, v13, v14
  v_max3_u32 v72, v72, v15, v16
  v_max3_u32 v72, v72, v17, v18
  v_max_u32 v72, v72, v19
  v_cmp_eq_u32 vcc, -1, v72
  s_cbranch_vccz Cf3_recok
  s_barrier
Cf3_recp:
  buffer_load_dwordx4 v[0:3], v76, s[8:11], s64 offen offset:0 sc1
  buffer_load_dwordx4 v[4:7], v76, s[8:11], s64 offen offset:1024 sc1
  buffer_load_dwordx4 v[8:11], v76, s[8:11], s64 offen offset:2048 sc1
  s_add_u32 s67, s67, 1
  s_cmp_lt_u32 s67, 131072
  s_cselect_b32 s54, -2, -1
  s_waitcnt vmcnt(2)
  v_max3_u32 v72, v0, v1, v2
  s_waitcnt vmcnt(1)
  v_max3_u32 v72, v72, v3, v4
  v_max3_u32 v72, v72, v5, v6
  s_waitcnt vmcnt(0)
  v_max3_u32 v72, v72, v7, v8
  v_max3_u32 v72, v72, v9, v10
  v_max_u32 v72, v72, v11
  v_cmp_lt_u32 vcc, s54, v72
  s_cbranch_vccnz Cf3_recp
  ds_write_b128 v76, v[0:3] offset:10752
  ds_write_b128 v76, v[4:7] offset:11776
  ds_write_b128 v76, v[8:11] offset:12800
  v_mov_b64 v[20:21], 0
  v_mov_b64 v[22:23], 0
  v_mov_b64 v[24:25], 0
  v_mov_b64 v[26:27], 0
  v_mov_b64 v[28:29], 0
  v_mov_b64 v[30:31], 0
  v_mov_b64 v[32:33], 0
  v_mov_b64 v[34:35], 0
  s_waitcnt lgkmcnt(0)
  s_barrier
  ds_read_b128 v[0:3], v76 offset:4608
  s_waitcnt lgkmcnt(0)
  v_smfmac_f32_16x16x64_bf16 v[20:23], v[0:3], v[80:87], v74
  v_smfmac_f32_16x16x64_bf16 v[24:27], v[0:3], v[88:95], v74
  ds_read_b128 v[60:63], v76 offset:28672
  ds_read_b128 v[64:67], v76 offset:29696
  s_waitcnt lgkmcnt(0)
  v_smfmac_f32_16x16x64_bf16 v[28:31], v[0:3], v[60:67], v74
  ds_read_b128 v[60:63], v76 offset:30720
  ds_read_b128 v[64:67], v76 offset:31744
  s_waitcnt lgkmcnt(0)
  v_smfmac_f32_16x16x64_bf16 v[32:35], v[0:3], v[60:67], v74
  ds_read_b128 v[4:7], v76 offset:5632
  s_waitcnt lgkmcnt(0)
  v_smfmac_f32_16x16x64_bf16 v[20:23], v[4:7], v[96:103], v74
  v_smfmac_f32_16x16x64_bf16 v[24:27], v[4:7], v[104:111], v74
  ds_read_b128 v[60:63], v76 offset:45056
  ds_read_b128 v[64:67], v76 offset:46080
  s_waitcnt lgkmcnt(0)
  v_smfmac_f32_16x16x64_bf16 v[28:31], v[4:7], v[60:67], v74
  ds_read_b128 v[60:63], v76 offset:47104
  ds_read_b128 v[64:67], v76 offset:48128
  s_waitcnt lgkmcnt(0)
  v_smfmac_f32_16x16x64_bf16 v[32:35], v[4:7], v[60:67], v74
  ds_read_b128 v[8:11], v76 offset:6656
  s_waitcnt lgkmcnt(0)
  v_smfmac_f32_16x16x64_bf16 v[20:23], v[8:11], v[112:119], v74
  v_smfmac_f32_16x16x64_bf16 v[24:27], v[8:11], v[120:127], v74
  v_smfmac_f32_16x16x64_bf16 v[28:31], v[8:11], v[208:215], v74
  v_smfmac_f32_16x16x64_bf16 v[32:35], v[8:11], v[216:223], v74
  ds_read_b128 v[12:15], v76 offset:7680
  s_waitcnt lgkmcnt(0)
  v_smfmac_f32_16x16x64_bf16 v[20:23], v[12:15], v[128:135], v74
  v_smfmac_f32_16x16x64_bf16 v[24:27], v[12:15], v[136:143], v74
  v_smfmac_f32_16x16x64_bf16 v[28:31], v[12:15], v[224:231], v74
  v_smfmac_f32_16x16x64_bf16 v[32:35], v[12:15], v[232:239], v74
  ds_read_b128 v[4:7], v76 offset:8704
  s_waitcnt lgkmcnt(0)
  v_smfmac_f32_16x16x64_bf16 v[20:23], v[4:7], v[144:151], v74
  v_smfmac_f32_16x16x64_bf16 v[24:27], v[4:7], v[152:159], v74
  ds_read_b128 v[60:63], v76 offset:61440
  ds_read_b128 v[64:67], v76 offset:62464
  s_waitcnt lgkmcnt(0)
  v_smfmac_f32_16x16x64_bf16 v[28:31], v[4:7], v[60:67], v74
  ds_read_b128 v[60:63], v76 offset:63488
  ds_read_b128 v[64:67], v76 offset:64512
  s_waitcnt lgkmcnt(0)
  v_smfmac_f32_16x16x64_bf16 v[32:35], v[4:7], v[60:67], v74
  ds_read_b128 v[8:11], v76 offset:9728
  s_waitcnt lgkmcnt(0)
  v_smfmac_f32_16x16x64_bf16 v[20:23], v[8:11], v[160:167], v74
  v_smfmac_f32_16x16x64_bf16 v[24:27], v[8:11], v[168:175], v74
  ds_read_b128 v[60:63], v75 offset:28672
  ds_read_b128 v[64:67], v75 offset:29696
  s_waitcnt lgkmcnt(0)
  v_smfmac_f32_16x16x64_bf16 v[28:31], v[8:11], v[60:67], v74
  ds_read_b128 v[60:63], v75 offset:30720
  ds_read_b128 v[64:67], v75 offset:31744
  s_waitcnt lgkmcnt(0)
  v_smfmac_f32_16x16x64_bf16 v[32:35], v[8:11], v[60:67], v74
  ds_read_b128 v[16:19], v76 offset:10752
  ds_read_b128 v[60:63], v75 offset:12288
  ds_read_b128 v[64:67], v75 offset:13312
  s_waitcnt lgkmcnt(0)
  v_smfmac_f32_16x16x64_bf16 v[20:23], v[16:19], v[60:67], v74
  ds_read_b128 v[60:63], v75 offset:14336
  ds_read_b128 v[64:67], v75 offset:15360
  s_waitcnt lgkmcnt(0)
  v_smfmac_f32_16x16x64_bf16 v[24:27], v[16:19], v[60:67], v74
  v_smfmac_f32_16x16x64_bf16 v[28:31], v[16:19], v[240:247], v74
  v_smfmac_f32_16x16x64_bf16 v[32:35], v[16:19], v[248:255], v74
  ds_read_b128 v[0:3], v76 offset:11776
  s_waitcnt lgkmcnt(0)
  v_smfmac_f32_16x16x64_bf16 v[20:23], v[0:3], v[176:183], v74
  v_smfmac_f32_16x16x64_bf16 v[24:27], v[0:3], v[184:191], v74
  v_smfmac_f32_16x16x64_bf16 v[28:31], v[0:3], a[0:7], v74
  v_smfmac_f32_16x16x64_bf16 v[32:35], v[0:3], a[8:15], v74
  ds_read_b128 v[12:15], v76 offset:12800
  s_waitcnt lgkmcnt(0)
  v_smfmac_f32_16x16x64_bf16 v[20:23], v[12:15], v[192:199], v74
  v_smfmac_f32_16x16x64_bf16 v[24:27], v[12:15], v[200:207], v74
  v_smfmac_f32_16x16x64_bf16 v[28:31], v[12:15], a[16:23], v74
  v_smfmac_f32_16x16x64_bf16 v[32:35], v[12:15], a[24:31], v74
  v_add_f32 v20, v20, v22
  v_add_f32 v21, v21, v23
  v_add_f32 v24, v24, v26
  v_cvt_pk_bf16_f32 v22, v20, v24
  ds_write_b32 v79, v22 offset:0
  v_add_f32 v25, v25, v27
  v_cvt_pk_bf16_f32 v23, v21, v25
  ds_write_b32 v79, v23 offset:576
  v_add_f32 v28, v28, v30
  v_add_f32 v29, v29, v31
  s_waitcnt lgkmcnt(0)
  s_nop 1
  s_branch Cf3_recok
Cf3_mx:
  s_waitcnt lgkmcnt(0)
  s_barrier
  buffer_load_dwordx4 v[0:3], v76, s[8:11], s58 offen offset:0 sc1
  ds_read_b128 v[20:23], v77 offset:0
  ds_read_b128 v[28:31], v77 offset:256
  buffer_load_dwordx4 v[4:7], v76, s[8:11], s58 offen offset:1024 sc1
  ds_read_b128 v[24:27], v77 offset:128
  ds_read_b128 v[32:35], v77 offset:384
  s_waitcnt vmcnt(1) lgkmcnt(3)
  v_mfma_f32_16x16x32_bf16 v[8:11], v[0:3], v[20:23], 0
  s_waitcnt vmcnt(0) lgkmcnt(1)
  v_mfma_f32_16x16x32_bf16 v[8:11], v[4:7], v[24:27], v[8:11]
  v_mfma_f32_16x16x32_bf16 v[12:15], v[28:31], v[20:23], 0
  s_waitcnt lgkmcnt(0)
  v_mfma_f32_16x16x32_bf16 v[12:15], v[32:35], v[24:27], v[12:15]
  v_add_f32_dpp v8, v10, v8 quad_perm:[2,3,0,1] row_mask:0xf bank_mask:0xf
  v_add_f32_dpp v9, v11, v9 quad_perm:[2,3,0,1] row_mask:0xf bank_mask:0xf
  s_nop 0
  v_mov_b32_dpp v8, v8 quad_perm:[0,1,0,1] row_mask:0xf bank_mask:0xf
  v_mov_b32_dpp v9, v9 quad_perm:[0,1,0,1] row_mask:0xf bank_mask:0xf
  s_nop 1
  v_add_f32_dpp v12, v14, v12 quad_perm:[2,3,0,1] row_mask:0xf bank_mask:0xf
  v_add_f32_dpp v13, v15, v13 quad_perm:[2,3,0,1] row_mask:0xf bank_mask:0xf
  s_nop 0
  v_mov_b32_dpp v12, v12 quad_perm:[0,1,0,1] row_mask:0xf bank_mask:0xf
  v_mov_b32_dpp v13, v13 quad_perm:[0,1,0,1] row_mask:0xf bank_mask:0xf
  v_mul_f32 v12, s69, v12
  ds_write_b32 v78, v8 offset:8716
  v_mul_f32 v13, s69, v13
  ds_write_b32 v78, v9 offset:8780
  s_waitcnt lgkmcnt(0)
  s_barrier
  ds_read_b128 v[36:39], v78 offset:8704
  ds_read_b128 v[40:43], v78 offset:8768
  s_waitcnt lgkmcnt(0)
  s_barrier
  v_max_f32 v16, v36, v37
  v_max3_f32 v16, v16, v38, v39
  v_max3_f32 v16, v16, v40, v41
  v_max3_f32 v16, v16, v42, v43
  v_max3_f32 v16, v16, v12, v13
  v_mov_b32 v17, v16
  s_nop 1
  v_permlane16_swap_b32 v16, v17
  v_max_f32 v16, v16, v17
  v_mov_b32 v17, v16
  s_nop 1
  v_permlane32_swap_b32 v16, v17
  v_max_f32 v16, v16, v17
  v_sub_f32 v36, v36, v16
  v_sub_f32 v37, v37, v16
  v_sub_f32 v38, v38, v16
  v_sub_f32 v39, v39, v16
  v_sub_f32 v40, v40, v16
  v_sub_f32 v41, v41, v16
  v_sub_f32 v42, v42, v16
  v_sub_f32 v43, v43, v16
  v_sub_f32 v12, v12, v16
  v_sub_f32 v13, v13, v16
  v_exp_f32 v36, v36
  v_exp_f32 v37, v37
  v_exp_f32 v38, v38
  v_exp_f32 v39, v39
  v_exp_f32 v40, v40
  v_exp_f32 v41, v41
  v_exp_f32 v42, v42
  v_exp_f32 v43, v43
  v_exp_f32 v12, v12
  v_exp_f32 v13, v13
  v_cvt_pk_bf16_f32 v32, v36, v40
  v_cvt_pk_bf16_f32 v33, v37, v41
  v_cvt_pk_bf16_f32 v34, v38, v42
  v_cvt_pk_bf16_f32 v35, v39, v43
  v_cvt_pk_bf16_f32 v28, v12, v13
  v_cvt_pk_bf16_f32 v31, v12, v13
  v_mov_b32 v29, 0
  v_mov_b32 v30, 0
  v_mov_b32 v68, 0x3f803f80
  v_mov_b32 v69, 0x3f803f80
  v_mov_b32 v70, 0x3f803f80
  v_mov_b32 v71, 0x3f803f80
  s_nop 1
  v_mfma_f32_16x16x32_bf16 v[8:11], v[32:35], v[68:71], 0
  v_mfma_f32_16x16x32_bf16 v[0:3], v[32:35], v[52:55], 0
  v_mfma_f32_16x16x32_bf16 v[4:7], v[32:35], v[56:59], 0
  v_mfma_f32_16x16x16_bf16 v[8:11], v[28:29], v[68:69], v[8:11]
  v_mfma_f32_16x16x16_bf16 v[0:3], v[28:29], v[72:73], v[0:3]
  v_mfma_f32_16x16x16_bf16 v[4:7], v[30:31], v[72:73], v[4:7]
  ds_read_b128 v[68:71], v76 offset:13824
  v_rcp_f32 v10, v8
  v_rcp_f32 v11, v9
  v_mul_f32 v0, v10, v0
  v_mul_f32 v1, v11, v1
  s_nop 0
  v_mul_f32 v4, v10, v4
  v_mul_f32 v5, v11, v5
  v_cvt_pk_bf16_f32 v2, v0, v4
  ds_write_b32 v79, v2 offset:8704
  v_cvt_pk_bf16_f32 v3, v1, v5
  ds_write_b32 v79, v3 offset:9280
  v_mov_b64 v[16:17], 0
  v_mov_b64 v[18:19], 0
  v_mov_b64 v[20:21], 0
  v_mov_b64 v[22:23], 0
  v_mov_b64 v[24:25], 0
  v_mov_b64 v[26:27], 0
  s_branch Cf3_mxok
Cf3_last:
  ds_read_b128 v[0:3], v76 offset:4608
  ds_read_b128 v[12:15], v76 offset:7680
  ds_read_b128 v[44:47], v76 offset:28672
  ds_read_b128 v[48:51], v76 offset:29696
  s_nop 5
  v_mov_b64 v[20:21], 0
  v_mov_b64 v[22:23], 0
  v_mov_b64 v[24:25], 0
  v_mov_b64 v[26:27], 0
  v_smfmac_f32_16x16x64_bf16 v[28:31], v[4:7], v[36:43], v74
  ds_read_b128 v[36:39], v76 offset:30720
  ds_read_b128 v[40:43], v76 offset:31744
  v_smfmac_f32_16x16x64_bf16 v[32:35], v[4:7], v[60:67], v74
  s_waitcnt lgkmcnt(5)
  v_smfmac_f32_16x16x64_bf16 v[20:23], v[0:3], a[32:39], v74
  ds_read_b128 v[60:63], v76 offset:61440
  ds_read_b128 v[64:67], v76 offset:62464
  v_smfmac_f32_16x16x64_bf16 v[24:27], v[0:3], a[40:47], v74
  s_waitcnt lgkmcnt(4)
  v_smfmac_f32_16x16x64_bf16 v[20:23], v[4:7], a[48:55], v74
  buffer_store_dwordx4 v[16:19], v76, s[8:11], s68 offen sc1
  v_smfmac_f32_16x16x64_bf16 v[24:27], v[4:7], a[56:63], v74
  v_smfmac_f32_16x16x64_bf16 v[28:31], v[0:3], v[44:51], v74
  s_waitcnt lgkmcnt(2)
  v_smfmac_f32_16x16x64_bf16 v[20:23], v[8:11], a[64:71], v74
  ds_read_b128 v[44:47], v76 offset:63488
  ds_read_b128 v[48:51], v76 offset:64512
  v_smfmac_f32_16x16x64_bf16 v[24:27], v[8:11], a[72:79], v74
  v_smfmac_f32_16x16x64_bf16 v[32:35], v[0:3], v[36:43], v74
  v_smfmac_f32_16x16x64_bf16 v[28:31], v[8:11], v[208:215], v74
  ds_read_b128 v[36:39], v75 offset:28672
  ds_read_b128 v[40:43], v75 offset:29696
  v_smfmac_f32_16x16x64_bf16 v[32:35], v[8:11], v[216:223], v74
  v_smfmac_f32_16x16x64_bf16 v[20:23], v[12:15], a[80:87], v74
  v_smfmac_f32_16x16x64_bf16 v[24:27], v[12:15], a[88:95], v74
  v_smfmac_f32_16x16x64_bf16 v[28:31], v[12:15], v[224:231], v74
  v_smfmac_f32_16x16x64_bf16 v[32:35], v[12:15], v[232:239], v74
  s_waitcnt vmcnt(1)
  s_barrier
Cf3_lastr:
  ds_read_b128 v[4:7], v76 offset:8704
  ds_read_b128 v[8:11], v76 offset:9728
  ds_read_b128 v[16:19], v76 offset:10752
  ds_read_b128 v[0:3], v76 offset:11776
  ds_read_b128 v[12:15], v76 offset:12800
  s_waitcnt lgkmcnt(1)
  v_max3_u32 v72, v0, v1, v2
  v_max3_u32 v72, v72, v3, v4
  v_max3_u32 v72, v72, v5, v6
  v_max3_u32 v72, v72, v7, v8
  v_max3_u32 v72, v72, v9, v10
  s_waitcnt lgkmcnt(0)
  v_max3_u32 v72, v72, v11, v12
  v_max3_u32 v72, v72, v13, v14
  v_max3_u32 v72, v72, v15, v16
  v_max3_u32 v72, v72, v17, v18
  v_max_u32 v72, v72, v19
  v_cmp_eq_u32 vcc, -1, v72
  s_cbranch_vccnz Cf3_lastp
Cf3_lastg:
  v_smfmac_f32_16x16x64_bf16 v[28:31], v[4:7], v[60:67], v74
  ds_read_b128 v[60:63], v75 offset:30720
  ds_read_b128 v[64:67], v75 offset:31744
  v_smfmac_f32_16x16x64_bf16 v[32:35], v[4:7], v[44:51], v74
  v_smfmac_f32_16x16x64_bf16 v[28:31], v[8:11], v[36:43], v74
  v_smfmac_f32_16x16x64_bf16 v[28:31], v[16:19], v[240:247], v74
  v_smfmac_f32_16x16x64_bf16 v[28:31], v[0:3], a[0:7], v74
  v_smfmac_f32_16x16x64_bf16 v[28:31], v[12:15], a[16:23], v74
  v_smfmac_f32_16x16x64_bf16 v[32:35], v[16:19], v[248:255], v74
  v_smfmac_f32_16x16x64_bf16 v[32:35], v[0:3], a[8:15], v74
  s_waitcnt lgkmcnt(0)
  v_smfmac_f32_16x16x64_bf16 v[32:35], v[12:15], a[24:31], v74
  v_smfmac_f32_16x16x64_bf16 v[32:35], v[8:11], v[60:67], v74
  v_smfmac_f32_16x16x64_bf16 v[20:23], v[4:7], a[96:103], v74
  v_smfmac_f32_16x16x64_bf16 v[20:23], v[8:11], a[112:119], v74
  v_add_f32 v28, v28, v30
  v_add_f32 v32, v32, v34
  v_cvt_pk_bf16_f32 v30, v28, v32
  v_smfmac_f32_16x16x64_bf16 v[20:23], v[16:19], a[128:135], v74
  ds_write_b32 v79, v30 offset:256
  v_add_f32 v29, v29, v31
  v_add_f32 v33, v33, v35
  v_cvt_pk_bf16_f32 v31, v29, v33
  v_smfmac_f32_16x16x64_bf16 v[20:23], v[0:3], a[144:151], v74
  ds_write_b32 v79, v31 offset:832
  v_smfmac_f32_16x16x64_bf16 v[20:23], v[12:15], a[160:167], v74
  v_smfmac_f32_16x16x64_bf16 v[24:27], v[4:7], a[104:111], v74
  v_smfmac_f32_16x16x64_bf16 v[24:27], v[8:11], a[120:127], v74
  v_smfmac_f32_16x16x64_bf16 v[24:27], v[16:19], a[136:143], v74
  s_waitcnt lgkmcnt(0)
  s_barrier
  ds_read_b64 v[52:53], v77 offset:392
  v_add_f32 v20, v20, v22
  v_smfmac_f32_16x16x64_bf16 v[24:27], v[0:3], a[152:159], v74
  v_add_f32 v21, v21, v23
  v_smfmac_f32_16x16x64_bf16 v[24:27], v[12:15], a[168:175], v74
  v_cvt_pk_bf16_f32 v54, v20, v21
  s_add_u32 s68, s68, 655360
  s_nop 3
  v_add_f32 v24, v24, v26
  v_add_f32 v25, v25, v27
  v_cvt_pk_bf16_f32 v55, v24, v25
  s_waitcnt lgkmcnt(0)
  buffer_store_dwordx4 v[52:55], v76, s[8:11], s68 offen sc1
  s_branch Cf3_done
Cf3_lastp:
  s_add_u32 s72, s72, 2
  s_cmp_ge_u32 s72, 131072
  s_cbranch_scc1 Cf3_lastg
  s_barrier
  buffer_load_dwordx4 v76, s[8:11], s85 offen offset:0 sc1 lds
  buffer_load_dwordx4 v76, s[8:11], s85 offen offset:1024 sc1 lds
  s_waitcnt vmcnt(0)
  s_barrier
  s_branch Cf3_lastr
Cf3_done:
  s_branch L_cexit
L_w4:
  v_mov_b64 v[20:21], 0
  v_mov_b64 v[22:23], 0
  v_mov_b64 v[24:25], 0
  v_mov_b64 v[26:27], 0
  v_mov_b64 v[28:29], 0
  v_mov_b64 v[30:31], 0
  v_mov_b64 v[32:33], 0
  v_mov_b64 v[34:35], 0
  s_mov_b32 s78, 0x3f803f80
  s_mov_b32 s79, s78
  s_mov_b32 s65, 360448
  s_mov_b32 m0, 16128
  s_lshl_b32 s71, s53, 2
  s_add_u32 s71, s71, 128
  s_movk_i32 s56, 0x1000
  v_lshlrev_b32 v73, 2, v76
  v_mov_b32 v72, 0
  s_mov_b64 s[16:17], s[8:9]
  s_mov_b32 s18, 268435456
  s_mov_b32 s19, 0x20000
  s_getpc_b64 s[20:21]
Cs0_pc:
  s_add_u32 s20, s20, (Cs0_last - Cs0_pc)
  s_addc_u32 s21, s21, 0
  v_mov_b32 v68, 14880
  buffer_load_dwordx4 v[52:55], v76, s[8:11], s59 offen offset:0 sc1
  buffer_load_dwordx4 v[56:59], v76, s[8:11], s59 offen offset:1024 sc1
  ds_read_b128 v[36:39], v76 offset:16384
  ds_read_b128 v[40:43], v76 offset:17408
  ds_read_b128 v[60:63], v76 offset:18432
  ds_read_b128 v[64:67], v76 offset:19456
  ds_read_b128 v[0:3], v76 offset:4608
  ds_read_b128 v[4:7], v76 offset:5632
  ds_read_b128 v[8:11], v76 offset:6656
  ds_read_b128 v[12:15], v76 offset:7680
  s_waitcnt lgkmcnt(0)
  s_cmp_eq_u32 s66, 1
  s_branch Cs0_top2
.p2align 6
Cs0_h2:
  s_cmp_eq_u32 s66, 62
  s_cselect_b64 s[16:17], s[20:21], s[16:17]
  s_cselect_b32 s18, (Cs0_done - Cs0_last), s18
  s_cselect_b32 s70, 0, s70
  s_cmp_eq_u32 s66, 63
  s_cselect_b32 s59, 268435456, s59
  s_cselect_b32 s58, 268435456, s58
  ds_read_b128 v[36:39], v76 offset:16384
  v_mov_b64 v[20:21], 0
  v_mov_b64 v[22:23], 0
  v_mov_b64 v[24:25], 0
  v_mov_b64 v[26:27], 0
  v_mov_b32 v68, 14880
  ds_read_b128 v[40:43], v76 offset:17408
  v_mov_b64 v[28:29], 0
  v_mov_b64 v[30:31], 0
  v_mov_b64 v[32:33], 0
  v_mov_b64 v[34:35], 0
  v_lshlrev_b32 v73, 2, v76
  ds_read_b128 v[60:63], v76 offset:18432
  s_cmp_eq_u32 s66, 12
  s_cselect_b32 s56, s71, 0x1000
  ds_read_b32 v72, v76 offset:16128
  s_cmp_eq_u32 s66, 13
  s_cselect_b32 s54, 0x700, 0
  s_waitcnt lgkmcnt(0)
  v_readfirstlane_b32 s57, v72
  s_nop 0
  s_cmp_lt_u32 s57, s54
  s_cbranch_scc1 Cs0_kv3
Cs0_kvb:
  buffer_load_dwordx4 v[52:55], v76, s[8:11], s59 offen offset:0 sc1
  buffer_load_dwordx4 v[56:59], v76, s[8:11], s59 offen offset:1024 sc1
  s_waitcnt vmcnt(0)
  s_mov_b64 vcc, -1
Cs0_h2r:
  s_mov_b64 exec, vcc
  buffer_load_dwordx4 v[0:3], v76, s[8:11], s65 offen offset:0 sc1
  buffer_load_dwordx4 v[4:7], v76, s[8:11], s85 offen offset:0 sc1
  s_mov_b64 exec, -1
  s_add_u32 s67, s67, 1
  s_cmp_lt_u32 s67, 131072
  s_cselect_b32 s54, -2, -1
  s_waitcnt vmcnt(1)
  v_max3_u32 v72, v0, v1, v2
  s_waitcnt vmcnt(0)
  v_max3_u32 v72, v72, v3, v4
  v_max3_u32 v72, v72, v5, v6
  v_max_u32 v72, v72, v7
  v_cmp_lt_u32 vcc, s54, v72
  s_cbranch_vccnz Cs0_h2r
  ds_write_b128 v76, v[0:3] offset:4608
  ds_write_b128 v76, v[4:7] offset:10752
Cs0_h2w:
  s_cmp_eq_u32 s66, 63
  s_waitcnt lgkmcnt(0)
  s_barrier
  ds_read_b128 v[8:11], v76 offset:6656
Cs0_top2:
  v_smfmac_f32_16x16x64_bf16 v[20:23], v[0:3], v[80:87], v74
  s_cbranch_scc1 Cs0_last
  v_smfmac_f32_16x16x64_bf16 v[28:31], v[0:3], v[36:43], v74
  buffer_load_dwordx4 v[44:47], v76, s[8:11], s58 offen offset:0 sc1
  s_mov_b32 m0, 16128
  v_smfmac_f32_16x16x64_bf16 v[24:27], v[0:3], v[88:95], v74
  buffer_load_dwordx4 v[48:51], v76, s[8:11], s58 offen offset:1024 sc1
  v_smfmac_f32_16x16x64_bf16 v[32:35], v[0:3], v[60:67], v74
  ds_read_b128 v[4:7], v76 offset:5632
  s_waitcnt lgkmcnt(1)
  v_smfmac_f32_16x16x64_bf16 v[20:23], v[8:11], v[112:119], v74
  ds_read_b128 v[12:15], v76 offset:7680
  v_smfmac_f32_16x16x64_bf16 v[24:27], v[8:11], v[120:127], v74
  ds_read_b128 v[36:39], v76 offset:32768
  v_smfmac_f32_16x16x64_bf16 v[28:31], v[8:11], v[208:215], v74
  buffer_store_dwordx4 v[16:19], v76, s[8:11], s68 offen sc1
  ds_read_b128 v[40:43], v76 offset:33792
  v_smfmac_f32_16x16x64_bf16 v[32:35], v[8:11], v[216:223], v74
  ds_read_b128 v[60:63], v76 offset:34816
  s_waitcnt lgkmcnt(4)
  v_smfmac_f32_16x16x64_bf16 v[20:23], v[4:7], v[96:103], v74
  ds_read_b128 v[64:67], v76 offset:35840
  v_smfmac_f32_16x16x64_bf16 v[24:27], v[4:7], v[104:111], v74
  buffer_load_dword v73, s[16:19], s70 offen lds
  s_waitcnt vmcnt(4)
  s_waitcnt lgkmcnt(4)
  v_smfmac_f32_16x16x64_bf16 v[20:23], v[12:15], v[128:135], v74
  s_barrier
  s_waitcnt lgkmcnt(2)
  v_smfmac_f32_16x16x64_bf16 v[28:31], v[4:7], v[36:43], v74
  ds_read_b128 v[0:3], v76 offset:8704
  v_smfmac_f32_16x16x64_bf16 v[24:27], v[12:15], v[136:143], v74
  ds_read_b128 v[36:39], v76 offset:49152
  s_waitcnt lgkmcnt(2)
  v_smfmac_f32_16x16x64_bf16 v[32:35], v[4:7], v[60:67], v74
  ds_read_b128 v[40:43], v76 offset:50176
  v_smfmac_f32_16x16x64_bf16 v[28:31], v[12:15], v[224:231], v74
  ds_read_b128 v[60:63], v76 offset:51200
  v_smfmac_f32_16x16x64_bf16 v[32:35], v[12:15], v[232:239], v74
  ds_read_b128 v[64:67], v76 offset:52224
  s_waitcnt lgkmcnt(4)
  v_smfmac_f32_16x16x64_bf16 v[20:23], v[0:3], v[144:151], v74
  ds_read_b128 v[8:11], v76 offset:9728
  s_waitcnt lgkmcnt(3)
  v_smfmac_f32_16x16x64_bf16 v[28:31], v[0:3], v[36:43], v74
  s_barrier
  ds_read_b128 v[4:7], v76 offset:11776
  v_smfmac_f32_16x16x64_bf16 v[24:27], v[0:3], v[152:159], v74
  ds_read_b128 v[36:39], v75 offset:0
  ds_read_b128 v[40:43], v75 offset:1024
  s_waitcnt lgkmcnt(4)
  v_smfmac_f32_16x16x64_bf16 v[32:35], v[0:3], v[60:67], v74
  ds_read_b128 v[16:19], v76 offset:10752
  s_waitcnt lgkmcnt(4)
  v_smfmac_f32_16x16x64_bf16 v[20:23], v[8:11], v[160:167], v74
  ds_read_b128 v[12:15], v76 offset:12800
  v_smfmac_f32_16x16x64_bf16 v[24:27], v[8:11], v[168:175], v74
  ds_read_b128 v[60:63], v75 offset:2048
  ds_read_b128 v[64:67], v75 offset:3072
  s_waitcnt lgkmcnt(6)
  v_smfmac_f32_16x16x64_bf16 v[20:23], v[4:7], v[176:183], v74
  s_waitcnt lgkmcnt(3)
  v_smfmac_f32_16x16x64_bf16 v[20:23], v[16:19], v[36:43], v74
  ds_read_b128 v[36:39], v75 offset:16384
  s_waitcnt lgkmcnt(3)
  v_smfmac_f32_16x16x64_bf16 v[20:23], v[12:15], v[192:199], v74
  ds_read_b128 v[40:43], v75 offset:17408
  s_waitcnt lgkmcnt(2)
  v_smfmac_f32_16x16x64_bf16 v[24:27], v[16:19], v[60:67], v74
  ds_read_b128 v[60:63], v75 offset:18432
  v_smfmac_f32_16x16x64_bf16 v[24:27], v[4:7], v[184:191], v74
  ds_read_b128 v[64:67], v75 offset:19456
  v_add_f32 v20, v20, v22
  v_smfmac_f32_16x16x64_bf16 v[24:27], v[12:15], v[200:207], v74
  buffer_load_dword off, s[12:15], s56 sc1 lds
  v_add_f32 v21, v21, v23
  v_smfmac_f32_16x16x64_bf16 v[28:31], v[16:19], v[240:247], v74
  s_waitcnt lgkmcnt(2)
  v_mov_b64 v[70:71], s[78:79]
  v_smfmac_f32_16x16x64_bf16 v[28:31], v[8:11], v[36:43], v74
  ds_read_b128 v[36:39], v68
  v_add_f32 v24, v24, v26
  v_smfmac_f32_16x16x64_bf16 v[28:31], v[4:7], a[0:7], v74
  ds_read_b128 v[40:43], v68
  v_cvt_pk_bf16_f32 v22, v20, v24
  v_smfmac_f32_16x16x64_bf16 v[28:31], v[12:15], a[16:23], v74
  ds_write_b32 v79, v22 offset:0
  s_waitcnt lgkmcnt(3)
  v_add_f32 v25, v25, v27
  v_cvt_pk_bf16_f32 v23, v21, v25
  v_smfmac_f32_16x16x64_bf16 v[32:35], v[8:11], v[60:67], v74
  ds_write_b32 v79, v23 offset:576
  v_cmp_u_f32 vcc, v20, v21
  v_smfmac_f32_16x16x64_bf16 v[32:35], v[16:19], v[248:255], v74
  v_add_f32 v28, v28, v30
  v_smfmac_f32_16x16x64_bf16 v[32:35], v[4:7], a[8:15], v74
  v_add_f32 v29, v29, v31
  v_smfmac_f32_16x16x64_bf16 v[32:35], v[12:15], a[24:31], v74
  s_cbranch_vccnz Cs0_rec
Cs0_recok:
  s_waitcnt lgkmcnt(3)
  v_smfmac_f32_16x16x64_bf16 v[36:39], v[16:19], a[128:135], v74
  s_waitcnt lgkmcnt(0)
  s_barrier
  ds_read_b128 v[60:63], v77
  v_smfmac_f32_16x16x64_bf16 v[40:43], v[16:19], a[136:143], v74
  ds_read_b128 v[64:67], v77 offset:128
  v_add_f32 v32, v32, v34
  v_cvt_pk_bf16_f32 v30, v28, v32
  v_smfmac_f32_16x16x64_bf16 v[36:39], v[0:3], a[96:103], v74
  ds_write_b32 v79, v30 offset:256
  v_add_f32 v33, v33, v35
  v_cvt_pk_bf16_f32 v31, v29, v33
  v_smfmac_f32_16x16x64_bf16 v[40:43], v[0:3], a[104:111], v74
  ds_write_b32 v79, v31 offset:832
  v_xor_b32 v75, 0x8000, v75
  v_smfmac_f32_16x16x64_bf16 v[36:39], v[4:7], a[144:151], v74
  ds_read_b128 v[0:3], v76 offset:4608
  v_mov_b32 v29, 0
  v_smfmac_f32_16x16x64_bf16 v[40:43], v[4:7], a[152:159], v74
  s_waitcnt vmcnt(3) lgkmcnt(3)
  v_mov_b32 v30, 0
  v_mfma_f32_16x16x32_bf16 v[44:47], v[44:47], v[60:63], 0
  ds_read_b128 v[4:7], v76 offset:5632
  s_waitcnt lgkmcnt(2)
  v_mfma_f32_16x16x32_bf16 v[44:47], v[48:51], v[64:67], v[44:47]
  s_barrier
  v_smfmac_f32_16x16x64_bf16 v[36:39], v[8:11], a[112:119], v74
  ds_read_b128 v[20:23], v77 offset:256
  ds_read_b128 v[24:27], v77 offset:384
  v_smfmac_f32_16x16x64_bf16 v[40:43], v[8:11], a[120:127], v74
  ds_read_b128 v[8:11], v76 offset:6656
  v_add_f32_dpp v72, v46, v44 quad_perm:[2,3,0,1] row_mask:0xf bank_mask:0xf
  v_add_f32_dpp v73, v47, v45 quad_perm:[2,3,0,1] row_mask:0xf bank_mask:0xf
  v_smfmac_f32_16x16x64_bf16 v[36:39], v[12:15], a[160:167], v74
  s_waitcnt lgkmcnt(4)
  v_exp_f32_dpp v72, v72 quad_perm:[0,1,0,1] row_mask:0xf bank_mask:0xf
  v_smfmac_f32_16x16x64_bf16 v[40:43], v[12:15], a[168:175], v74
  ds_read_b128 v[12:15], v76 offset:7680
  v_exp_f32_dpp v73, v73 quad_perm:[0,1,0,1] row_mask:0xf bank_mask:0xf
  v_smfmac_f32_16x16x64_bf16 v[36:39], v[0:3], a[32:39], v74
  s_waitcnt lgkmcnt(2)
  v_cvt_pk_bf16_f32 v72, v72, v73
  v_mfma_f32_16x16x32_bf16 v[20:23], v[20:23], v[60:63], 0
  ds_write_b32 v78, v72 offset:512
  v_mov_b64 v[16:17], 0
  v_mfma_f32_16x16x32_bf16 v[20:23], v[24:27], v[64:67], v[20:23]
  ds_read_b128 v[44:47], v75 offset:16384
  v_mov_b64 v[18:19], 0
  v_smfmac_f32_16x16x64_bf16 v[40:43], v[0:3], a[40:47], v74
  ds_read_b128 v[48:51], v75 offset:17408
  v_mov_b64 v[68:69], s[78:79]
  v_smfmac_f32_16x16x64_bf16 v[36:39], v[4:7], a[48:55], v74
  s_waitcnt lgkmcnt(4)
  v_add_f32_dpp v24, v22, v20 quad_perm:[2,3,0,1] row_mask:0xf bank_mask:0xf
  v_add_f32_dpp v25, v23, v21 quad_perm:[2,3,0,1] row_mask:0xf bank_mask:0xf
  v_smfmac_f32_16x16x64_bf16 v[36:39], v[8:11], a[64:71], v74
  s_waitcnt lgkmcnt(2)
  s_barrier
  ds_read_b128 v[32:35], v78 offset:512
  v_smfmac_f32_16x16x64_bf16 v[36:39], v[12:15], a[80:87], v74
  ds_read_b128 v[60:63], v75 offset:18432
  v_mul_f32 v24, s69, v24
  v_smfmac_f32_16x16x64_bf16 v[40:43], v[4:7], a[56:63], v74
  ds_read_b128 v[64:67], v75 offset:19456
  v_mul_f32 v25, s69, v25
  v_smfmac_f32_16x16x64_bf16 v[40:43], v[8:11], a[72:79], v74
  v_exp_f32_dpp v24, v24 quad_perm:[0,1,0,1] row_mask:0xf bank_mask:0xf
  v_smfmac_f32_16x16x64_bf16 v[40:43], v[12:15], a[88:95], v74
  s_waitcnt lgkmcnt(2)
  v_exp_f32_dpp v25, v25 quad_perm:[0,1,0,1] row_mask:0xf bank_mask:0xf
  v_mfma_f32_16x16x32_bf16 v[8:11], v[32:35], v[68:71], 0
  v_add_f32 v36, v36, v38
  v_add_f32 v37, v37, v39
  v_mfma_f32_16x16x32_bf16 v[0:3], v[32:35], v[52:55], 0
  v_add_f32 v40, v40, v42
  v_add_f32 v41, v41, v43
  v_mfma_f32_16x16x32_bf16 v[4:7], v[32:35], v[56:59], 0
  v_cvt_pk_bf16_f32 v28, v24, v25
  v_cvt_pk_bf16_f32 v72, v36, v37
  v_cvt_pk_bf16_f32 v73, v40, v41
  v_mfma_f32_16x16x16_bf16 v[8:11], v[28:29], v[68:69], v[8:11]
  v_cvt_pk_bf16_f32 v31, v24, v25
  v_mov_b64 v[20:21], 0
  v_mfma_f32_16x16x16_bf16 v[0:3], v[28:29], v[72:73], v[0:3]
  ds_read_b128 v[68:71], v76 offset:13824
  v_mov_b64 v[22:23], 0
  v_mfma_f32_16x16x16_bf16 v[4:7], v[30:31], v[72:73], v[4:7]
  v_rcp_f32 v10, v8
  v_rcp_f32 v11, v9
  v_mul_f32 v0, v10, v0
  v_mul_f32 v1, v11, v1
  s_nop 0
  v_mul_f32 v4, v10, v4
  v_mul_f32 v5, v11, v5
  v_cvt_pk_bf16_f32 v2, v0, v4
  ds_write_b32 v79, v2 offset:8704
  v_cvt_pk_bf16_f32 v3, v1, v5
  ds_write_b32 v79, v3 offset:9280
  v_max3_f32 v8, v8, v9, v10
  v_max_f32 v8, v8, v11
  v_cmp_le_f32 vcc, 1317011456, v8
  v_mov_b64 v[24:25], 0
  v_mov_b64 v[26:27], 0
  s_cbranch_vccnz Cs0_mx
Cs0_mxok:
  s_waitcnt lgkmcnt(0)
  s_barrier
  ds_read_b128 v[0:3], v78 offset:8704
  ds_read_b128 v[4:7], v78 offset:8768
  ds_read_b128 v[8:11], v78 offset:8832
  ds_read_b128 v[12:15], v78 offset:8896
  s_waitcnt lgkmcnt(3)
  v_smfmac_f32_16x16x64_bf16 v[16:19], v[0:3], v[44:51], v74
  ds_read_b128 v[52:55], v75 offset:32768
  s_waitcnt lgkmcnt(3)
  v_smfmac_f32_16x16x64_bf16 v[16:19], v[4:7], v[60:67], v74
  ds_read_b128 v[56:59], v75 offset:33792
  s_waitcnt lgkmcnt(3)
  v_smfmac_f32_16x16x64_bf16 v[16:19], v[8:11], a[176:183], v74
  ds_read_b128 v[36:39], v75 offset:34816
  s_waitcnt lgkmcnt(3)
  v_smfmac_f32_16x16x64_bf16 v[16:19], v[12:15], a[184:191], v74
  ds_read_b128 v[40:43], v75 offset:35840
  ds_read_b128 v[44:47], v75 offset:49152
  v_smfmac_f32_16x16x64_bf16 v[20:23], v[0:3], a[192:199], v74
  ds_read_b128 v[48:51], v75 offset:50176
  ds_read_b128 v[60:63], v75 offset:51200
  v_smfmac_f32_16x16x64_bf16 v[20:23], v[4:7], a[200:207], v74
  ds_read_b128 v[64:67], v75 offset:52224
  s_waitcnt lgkmcnt(6)
  v_cvt_pk_bf16_f32 v16, v16, v17
  v_cvt_pk_bf16_f32 v17, v18, v19
  v_bfi_b32 v16, 1, s72, v16
  v_smfmac_f32_16x16x64_bf16 v[20:23], v[8:11], v[52:59], v74
  buffer_store_dwordx2 v[16:17], v68, s[8:11], s73 offen sc1
  s_waitcnt lgkmcnt(4)
  v_smfmac_f32_16x16x64_bf16 v[20:23], v[12:15], v[36:43], v74
  v_mov_b64 v[32:33], 0
  v_smfmac_f32_16x16x64_bf16 v[24:27], v[0:3], a[208:215], v74
  v_mov_b64 v[34:35], 0
  v_smfmac_f32_16x16x64_bf16 v[24:27], v[4:7], a[216:223], v74
  s_waitcnt lgkmcnt(2)
  v_cvt_pk_bf16_f32 v20, v20, v21
  v_cvt_pk_bf16_f32 v21, v22, v23
  v_bfi_b32 v20, 1, s72, v20
  v_smfmac_f32_16x16x64_bf16 v[24:27], v[8:11], v[44:51], v74
  buffer_store_dwordx2 v[20:21], v68, s[8:11], s74 offen sc1
  s_waitcnt lgkmcnt(0)
  v_smfmac_f32_16x16x64_bf16 v[24:27], v[12:15], v[60:67], v74
  v_smfmac_f32_16x16x64_bf16 v[32:35], v[0:3], a[224:231], v74
  v_smfmac_f32_16x16x64_bf16 v[32:35], v[4:7], a[232:239], v74
  v_cvt_pk_bf16_f32 v24, v24, v25
  v_cvt_pk_bf16_f32 v25, v26, v27
  v_bfi_b32 v24, 1, s72, v24
  v_smfmac_f32_16x16x64_bf16 v[32:35], v[8:11], a[240:247], v74
  buffer_store_dwordx2 v[24:25], v68, s[8:11], s75 offen sc1
  v_smfmac_f32_16x16x64_bf16 v[32:35], v[12:15], a[248:255], v74
  v_mov_b64 v[18:19], v[72:73]
  s_nop 4
  v_cvt_pk_bf16_f32 v32, v32, v33
  v_cvt_pk_bf16_f32 v33, v34, v35
  v_bfi_b32 v32, 1, s72, v32
  buffer_store_dwordx2 v[32:33], v68, s[8:11], s76 offen sc1
  ds_read_b128 v[0:3], v76 offset:14848
  s_waitcnt lgkmcnt(0)
  ds_read_b64 v[16:17], v77 offset:256
  s_waitcnt lgkmcnt(0)
  ds_read_b128 v[64:67], v76 offset:19456
  s_waitcnt lgkmcnt(0)
  v_xor_b32 v75, 0x8000, v75
  s_waitcnt vmcnt(0)
  buffer_load_dwordx4 v[52:55], v76, s[8:11], s60 offen offset:0 sc1
  buffer_load_dwordx4 v[56:59], v76, s[8:11], s60 offen offset:1024 sc1
  s_add_u32 s66, s66, 1
  s_xor_b32 s64, s64, 16384
  s_xor_b32 s65, s65, 16384
  s_add_u32 s58, s58, 655360
  s_add_u32 s59, s59, 655360
  s_add_u32 s70, s70, 655360
  s_add_u32 s68, s68, 655360
  s_mov_b32 m0, 10752
  s_add_u32 s85, s65, 6144
  s_waitcnt lgkmcnt(0)
  s_waitcnt vmcnt(1)
  v_mfma_f32_16x16x32_bf16 v[4:7], v[0:3], v[52:55], 0
  v_bitop3_b32 v72, v52, v54, s72 bitop3:0x7e
  s_waitcnt vmcnt(0)
  v_mfma_f32_16x16x32_bf16 v[4:7], v[0:3], v[56:59], v[4:7]
  v_bitop3_b32 v73, v56, v58, s72 bitop3:0x7e
  v_bitop3_b32 v72, v72, v73, 1 bitop3:0xa8
  v_cmp_ne_u32 vcc, 0, v72
  s_cbranch_vccnz Cs0_h1r
  s_nop 2
  v_add_f32_dpp v4, v4, v4 row_ror:4 row_mask:0xf bank_mask:0xf
  v_add_f32_dpp v5, v5, v5 row_ror:4 row_mask:0xf bank_mask:0xf
  s_nop 0
  v_add_f32_dpp v4, v4, v4 row_ror:8 row_mask:0xf bank_mask:0xf
  v_add_f32_dpp v5, v5, v5 row_ror:8 row_mask:0xf bank_mask:0xf
  v_cvt_pk_bf16_f32 v4, v4, v5
  buffer_store_dword v4, v69, s[8:11], s62 offen sc1
  s_xor_b32 s62, s62, 16384
  buffer_store_dword v71, v69, s[8:11], s62 offen sc1
  s_xor_b32 s72, s72, 1
  s_branch Cs0_h2
Cs0_h1r:
  s_mov_b64 exec, vcc
  buffer_load_dwordx4 v[52:55], v76, s[8:11], s60 offen offset:0 sc1
  buffer_load_dwordx4 v[56:59], v76, s[8:11], s60 offen offset:1024 sc1
  s_mov_b64 exec, -1
  s_add_u32 s67, s67, 1
  s_waitcnt vmcnt(1)
  v_mfma_f32_16x16x32_bf16 v[4:7], v[0:3], v[52:55], 0
  v_bitop3_b32 v72, v52, v54, s72 bitop3:0x7e
  s_waitcnt vmcnt(0)
  v_mfma_f32_16x16x32_bf16 v[4:7], v[0:3], v[56:59], v[4:7]
  v_bitop3_b32 v73, v56, v58, s72 bitop3:0x7e
  v_bitop3_b32 v72, v72, v73, 1 bitop3:0xa8
  v_cmp_ne_u32 vcc, 0, v72
  s_cbranch_vccz Cs0_h1p
Cs0_h1s:
  s_mov_b64 exec, vcc
  buffer_load_dwordx4 v[52:55], v76, s[8:11], s60 offen offset:0 sc1
  buffer_load_dwordx4 v[56:59], v76, s[8:11], s60 offen offset:1024 sc1
  s_mov_b64 exec, -1
  s_add_u32 s67, s67, 1
  s_waitcnt vmcnt(1)
  v_mfma_f32_16x16x32_bf16 v[4:7], v[0:3], v[52:55], 0
  v_bitop3_b32 v72, v52, v54, s72 bitop3:0x7e
  s_waitcnt vmcnt(0)
  v_mfma_f32_16x16x32_bf16 v[4:7], v[0:3], v[56:59], v[4:7]
  v_bitop3_b32 v73, v56, v58, s72 bitop3:0x7e
  v_bitop3_b32 v72, v72, v73, 1 bitop3:0xa8
  v_cmp_ne_u32 vcc, 0, v72
  s_cbranch_vccz Cs0_h1p
  s_cmp_lt_u32 s67, 131072
  s_cbranch_scc1 Cs0_h1s
Cs0_h1p:
  s_nop 2
  v_add_f32_dpp v4, v4, v4 row_ror:4 row_mask:0xf bank_mask:0xf
  v_add_f32_dpp v5, v5, v5 row_ror:4 row_mask:0xf bank_mask:0xf
  s_nop 0
  v_add_f32_dpp v4, v4, v4 row_ror:8 row_mask:0xf bank_mask:0xf
  v_add_f32_dpp v5, v5, v5 row_ror:8 row_mask:0xf bank_mask:0xf
  v_cvt_pk_bf16_f32 v4, v4, v5
  buffer_store_dword v4, v69, s[8:11], s62 offen sc1
  s_xor_b32 s62, s62, 16384
  buffer_store_dword v71, v69, s[8:11], s62 offen sc1
  s_xor_b32 s72, s72, 1
  s_branch Cs0_h2
Cs0_rec:
  s_nop 7
  s_waitcnt vmcnt(0) lgkmcnt(0)
  v_max3_u32 v72, v0, v1, v2
  v_max3_u32 v72, v72, v3, v4
  v_max3_u32 v72, v72, v5, v6
  v_max3_u32 v72, v72, v7, v8
  v_max3_u32 v72, v72, v9, v10
  v_max3_u32 v72, v72, v11, v12
  v_max3_u32 v72, v72, v13, v14
  v_max3_u32 v72, v72, v15, v16
  v_max3_u32 v72, v72, v17, v18
  v_max_u32 v72, v72, v19
  v_cmp_eq_u32 vcc, -1, v72
  s_cbranch_vccz Cs0_recok
  s_barrier
  v_mov_b64 v[20:21], 0
  v_mov_b64 v[22:23], 0
  v_mov_b64 v[24:25], 0
  v_mov_b64 v[26:27], 0
  v_mov_b64 v[28:29], 0
  v_mov_b64 v[30:31], 0
  v_mov_b64 v[32:33], 0
  v_mov_b64 v[34:35], 0
  s_waitcnt lgkmcnt(0)
  s_barrier
  ds_read_b128 v[0:3], v76 offset:4608
  s_waitcnt lgkmcnt(0)
  v_smfmac_f32_16x16x64_bf16 v[20:23], v[0:3], v[80:87], v74
  v_smfmac_f32_16x16x64_bf16 v[24:27], v[0:3], v[88:95], v74
  ds_read_b128 v[60:63], v76 offset:16384
  ds_read_b128 v[64:67], v76 offset:17408
  s_waitcnt lgkmcnt(0)
  v_smfmac_f32_16x16x64_bf16 v[28:31], v[0:3], v[60:67], v74
  ds_read_b128 v[60:63], v76 offset:18432
  ds_read_b128 v[64:67], v76 offset:19456
  s_waitcnt lgkmcnt(0)
  v_smfmac_f32_16x16x64_bf16 v[32:35], v[0:3], v[60:67], v74
  ds_read_b128 v[4:7], v76 offset:5632
  s_waitcnt lgkmcnt(0)
  v_smfmac_f32_16x16x64_bf16 v[20:23], v[4:7], v[96:103], v74
  v_smfmac_f32_16x16x64_bf16 v[24:27], v[4:7], v[104:111], v74
  ds_read_b128 v[60:63], v76 offset:32768
  ds_read_b128 v[64:67], v76 offset:33792
  s_waitcnt lgkmcnt(0)
  v_smfmac_f32_16x16x64_bf16 v[28:31], v[4:7], v[60:67], v74
  ds_read_b128 v[60:63], v76 offset:34816
  ds_read_b128 v[64:67], v76 offset:35840
  s_waitcnt lgkmcnt(0)
  v_smfmac_f32_16x16x64_bf16 v[32:35], v[4:7], v[60:67], v74
  ds_read_b128 v[8:11], v76 offset:6656
  s_waitcnt lgkmcnt(0)
  v_smfmac_f32_16x16x64_bf16 v[20:23], v[8:11], v[112:119], v74
  v_smfmac_f32_16x16x64_bf16 v[24:27], v[8:11], v[120:127], v74
  v_smfmac_f32_16x16x64_bf16 v[28:31], v[8:11], v[208:215], v74
  v_smfmac_f32_16x16x64_bf16 v[32:35], v[8:11], v[216:223], v74
  ds_read_b128 v[12:15], v76 offset:7680
  s_waitcnt lgkmcnt(0)
  v_smfmac_f32_16x16x64_bf16 v[20:23], v[12:15], v[128:135], v74
  v_smfmac_f32_16x16x64_bf16 v[24:27], v[12:15], v[136:143], v74
  v_smfmac_f32_16x16x64_bf16 v[28:31], v[12:15], v[224:231], v74
  v_smfmac_f32_16x16x64_bf16 v[32:35], v[12:15], v[232:239], v74
  ds_read_b128 v[0:3], v76 offset:8704
  s_waitcnt lgkmcnt(0)
  v_smfmac_f32_16x16x64_bf16 v[20:23], v[0:3], v[144:151], v74
  v_smfmac_f32_16x16x64_bf16 v[24:27], v[0:3], v[152:159], v74
  ds_read_b128 v[60:63], v76 offset:49152
  ds_read_b128 v[64:67], v76 offset:50176
  s_waitcnt lgkmcnt(0)
  v_smfmac_f32_16x16x64_bf16 v[28:31], v[0:3], v[60:67], v74
  ds_read_b128 v[60:63], v76 offset:51200
  ds_read_b128 v[64:67], v76 offset:52224
  s_waitcnt lgkmcnt(0)
  v_smfmac_f32_16x16x64_bf16 v[32:35], v[0:3], v[60:67], v74
  ds_read_b128 v[8:11], v76 offset:9728
  s_waitcnt lgkmcnt(0)
  v_smfmac_f32_16x16x64_bf16 v[20:23], v[8:11], v[160:167], v74
  v_smfmac_f32_16x16x64_bf16 v[24:27], v[8:11], v[168:175], v74
  ds_read_b128 v[60:63], v75 offset:16384
  ds_read_b128 v[64:67], v75 offset:17408
  s_waitcnt lgkmcnt(0)
  v_smfmac_f32_16x16x64_bf16 v[28:31], v[8:11], v[60:67], v74
  ds_read_b128 v[60:63], v75 offset:18432
  ds_read_b128 v[64:67], v75 offset:19456
  s_waitcnt lgkmcnt(0)
  v_smfmac_f32_16x16x64_bf16 v[32:35], v[8:11], v[60:67], v74
  ds_read_b128 v[16:19], v76 offset:10752
  ds_read_b128 v[60:63], v75 offset:0
  ds_read_b128 v[64:67], v75 offset:1024
  s_waitcnt lgkmcnt(0)
  v_smfmac_f32_16x16x64_bf16 v[20:23], v[16:19], v[60:67], v74
  ds_read_b128 v[60:63], v75 offset:2048
  ds_read_b128 v[64:67], v75 offset:3072
  s_waitcnt lgkmcnt(0)
  v_smfmac_f32_16x16x64_bf16 v[24:27], v[16:19], v[60:67], v74
  v_smfmac_f32_16x16x64_bf16 v[28:31], v[16:19], v[240:247], v74
  v_smfmac_f32_16x16x64_bf16 v[32:35], v[16:19], v[248:255], v74
  ds_read_b128 v[4:7], v76 offset:11776
  s_waitcnt lgkmcnt(0)
  v_smfmac_f32_16x16x64_bf16 v[20:23], v[4:7], v[176:183], v74
  v_smfmac_f32_16x16x64_bf16 v[24:27], v[4:7], v[184:191], v74
  v_smfmac_f32_16x16x64_bf16 v[28:31], v[4:7], a[0:7], v74
  v_smfmac_f32_16x16x64_bf16 v[32:35], v[4:7], a[8:15], v74
  ds_read_b128 v[12:15], v76 offset:12800
  s_waitcnt lgkmcnt(0)
  v_smfmac_f32_16x16x64_bf16 v[20:23], v[12:15], v[192:199], v74
  v_smfmac_f32_16x16x64_bf16 v[24:27], v[12:15], v[200:207], v74
  v_smfmac_f32_16x16x64_bf16 v[28:31], v[12:15], a[16:23], v74
  v_smfmac_f32_16x16x64_bf16 v[32:35], v[12:15], a[24:31], v74
  v_add_f32 v20, v20, v22
  v_add_f32 v21, v21, v23
  v_add_f32 v24, v24, v26
  v_cvt_pk_bf16_f32 v22, v20, v24
  ds_write_b32 v79, v22 offset:0
  v_add_f32 v25, v25, v27
  v_cvt_pk_bf16_f32 v23, v21, v25
  ds_write_b32 v79, v23 offset:576
  v_add_f32 v28, v28, v30
  v_add_f32 v29, v29, v31
  s_waitcnt lgkmcnt(0)
  s_nop 1
  s_branch Cs0_recok
Cs0_mx:
  s_waitcnt lgkmcnt(0)
  s_barrier
  buffer_load_dwordx4 v[0:3], v76, s[8:11], s58 offen offset:0 sc1
  ds_read_b128 v[20:23], v77 offset:0
  ds_read_b128 v[28:31], v77 offset:256
  buffer_load_dwordx4 v[4:7], v76, s[8:11], s58 offen offset:1024 sc1
  ds_read_b128 v[24:27], v77 offset:128
  ds_read_b128 v[32:35], v77 offset:384
  s_waitcnt vmcnt(1) lgkmcnt(3)
  v_mfma_f32_16x16x32_bf16 v[8:11], v[0:3], v[20:23], 0
  s_waitcnt vmcnt(0) lgkmcnt(1)
  v_mfma_f32_16x16x32_bf16 v[8:11], v[4:7], v[24:27], v[8:11]
  v_mfma_f32_16x16x32_bf16 v[12:15], v[28:31], v[20:23], 0
  s_waitcnt lgkmcnt(0)
  v_mfma_f32_16x16x32_bf16 v[12:15], v[32:35], v[24:27], v[12:15]
  v_add_f32_dpp v8, v10, v8 quad_perm:[2,3,0,1] row_mask:0xf bank_mask:0xf
  v_add_f32_dpp v9, v11, v9 quad_perm:[2,3,0,1] row_mask:0xf bank_mask:0xf
  s_nop 0
  v_mov_b32_dpp v8, v8 quad_perm:[0,1,0,1] row_mask:0xf bank_mask:0xf
  v_mov_b32_dpp v9, v9 quad_perm:[0,1,0,1] row_mask:0xf bank_mask:0xf
  s_nop 1
  v_add_f32_dpp v12, v14, v12 quad_perm:[2,3,0,1] row_mask:0xf bank_mask:0xf
  v_add_f32_dpp v13, v15, v13 quad_perm:[2,3,0,1] row_mask:0xf bank_mask:0xf
  s_nop 0
  v_mov_b32_dpp v12, v12 quad_perm:[0,1,0,1] row_mask:0xf bank_mask:0xf
  v_mov_b32_dpp v13, v13 quad_perm:[0,1,0,1] row_mask:0xf bank_mask:0xf
  v_mul_f32 v12, s69, v12
  ds_write_b32 v78, v8 offset:8704
  v_mul_f32 v13, s69, v13
  ds_write_b32 v78, v9 offset:8768
  s_waitcnt lgkmcnt(0)
  s_barrier
  ds_read_b128 v[36:39], v78 offset:8704
  ds_read_b128 v[40:43], v78 offset:8768
  s_waitcnt lgkmcnt(0)
  s_barrier
  v_max_f32 v16, v36, v37
  v_max3_f32 v16, v16, v38, v39
  v_max3_f32 v16, v16, v40, v41
  v_max3_f32 v16, v16, v42, v43
  v_max3_f32 v16, v16, v12, v13
  v_mov_b32 v17, v16
  s_nop 1
  v_permlane16_swap_b32 v16, v17
  v_max_f32 v16, v16, v17
  v_mov_b32 v17, v16
  s_nop 1
  v_permlane32_swap_b32 v16, v17
  v_max_f32 v16, v16, v17
  v_sub_f32 v36, v36, v16
  v_sub_f32 v37, v37, v16
  v_sub_f32 v38, v38, v16
  v_sub_f32 v39, v39, v16
  v_sub_f32 v40, v40, v16
  v_sub_f32 v41, v41, v16
  v_sub_f32 v42, v42, v16
  v_sub_f32 v43, v43, v16
  v_sub_f32 v12, v12, v16
  v_sub_f32 v13, v13, v16
  v_exp_f32 v36, v36
  v_exp_f32 v37, v37
  v_exp_f32 v38, v38
  v_exp_f32 v39, v39
  v_exp_f32 v40, v40
  v_exp_f32 v41, v41
  v_exp_f32 v42, v42
  v_exp_f32 v43, v43
  v_exp_f32 v12, v12
  v_exp_f32 v13, v13
  v_cvt_pk_bf16_f32 v32, v36, v40
  v_cvt_pk_bf16_f32 v33, v37, v41
  v_cvt_pk_bf16_f32 v34, v38, v42
  v_cvt_pk_bf16_f32 v35, v39, v43
  v_cvt_pk_bf16_f32 v28, v12, v13
  v_cvt_pk_bf16_f32 v31, v12, v13
  v_mov_b32 v29, 0
  v_mov_b32 v30, 0
  v_mov_b32 v68, 0x3f803f80
  v_mov_b32 v69, 0x3f803f80
  v_mov_b32 v70, 0x3f803f80
  v_mov_b32 v71, 0x3f803f80
  s_nop 1
  v_mfma_f32_16x16x32_bf16 v[8:11], v[32:35], v[68:71], 0
  v_mfma_f32_16x16x32_bf16 v[0:3], v[32:35], v[52:55], 0
  v_mfma_f32_16x16x32_bf16 v[4:7], v[32:35], v[56:59], 0
  v_mfma_f32_16x16x16_bf16 v[8:11], v[28:29], v[68:69], v[8:11]
  v_mfma_f32_16x16x16_bf16 v[0:3], v[28:29], v[72:73], v[0:3]
  v_mfma_f32_16x16x16_bf16 v[4:7], v[30:31], v[72:73], v[4:7]
  ds_read_b128 v[68:71], v76 offset:13824
  v_rcp_f32 v10, v8
  v_rcp_f32 v11, v9
  v_mul_f32 v0, v10, v0
  v_mul_f32 v1, v11, v1
  s_nop 0
  v_mul_f32 v4, v10, v4
  v_mul_f32 v5, v11, v5
  v_cvt_pk_bf16_f32 v2, v0, v4
  ds_write_b32 v79, v2 offset:8704
  v_cvt_pk_bf16_f32 v3, v1, v5
  ds_write_b32 v79, v3 offset:9280
  v_mov_b64 v[16:17], 0
  v_mov_b64 v[18:19], 0
  v_mov_b64 v[20:21], 0
  v_mov_b64 v[22:23], 0
  v_mov_b64 v[24:25], 0
  v_mov_b64 v[26:27], 0
  s_branch Cs0_mxok
Cs0_kv3:
  s_waitcnt lgkmcnt(0)
  s_cmp_ge_u32 s57, 0x700
  s_cbranch_scc1 Cs0_kvb
  s_load_dword s57, s[12:13], s71 glc
  s_add_u32 s67, s67, 1
  s_cmp_lt_u32 s67, 131072
  s_cbranch_scc1 Cs0_kv3
  s_waitcnt lgkmcnt(0)
  s_branch Cs0_kvb
Cs0_last:
  ds_read_b128 v[4:7], v76 offset:5632
  ds_read_b128 v[12:15], v76 offset:7680
  ds_read_b128 v[44:47], v76 offset:32768
  ds_read_b128 v[48:51], v76 offset:33792
  s_nop 5
  v_mov_b64 v[20:21], 0
  v_mov_b64 v[22:23], 0
  v_mov_b64 v[24:25], 0
  v_mov_b64 v[26:27], 0
  v_smfmac_f32_16x16x64_bf16 v[28:31], v[0:3], v[36:43], v74
  ds_read_b128 v[36:39], v76 offset:34816
  ds_read_b128 v[40:43], v76 offset:35840
  v_smfmac_f32_16x16x64_bf16 v[32:35], v[0:3], v[60:67], v74
  s_waitcnt lgkmcnt(5)
  v_smfmac_f32_16x16x64_bf16 v[20:23], v[0:3], a[32:39], v74
  ds_read_b128 v[60:63], v76 offset:49152
  ds_read_b128 v[64:67], v76 offset:50176
  v_smfmac_f32_16x16x64_bf16 v[24:27], v[0:3], a[40:47], v74
  s_waitcnt lgkmcnt(4)
  v_smfmac_f32_16x16x64_bf16 v[20:23], v[4:7], a[48:55], v74
  buffer_store_dwordx4 v[16:19], v76, s[8:11], s68 offen sc1
  v_smfmac_f32_16x16x64_bf16 v[24:27], v[4:7], a[56:63], v74
  v_smfmac_f32_16x16x64_bf16 v[28:31], v[4:7], v[44:51], v74
  s_waitcnt lgkmcnt(2)
  v_smfmac_f32_16x16x64_bf16 v[20:23], v[8:11], a[64:71], v74
  ds_read_b128 v[44:47], v76 offset:51200
  ds_read_b128 v[48:51], v76 offset:52224
  v_smfmac_f32_16x16x64_bf16 v[24:27], v[8:11], a[72:79], v74
  v_smfmac_f32_16x16x64_bf16 v[32:35], v[4:7], v[36:43], v74
  v_smfmac_f32_16x16x64_bf16 v[28:31], v[8:11], v[208:215], v74
  ds_read_b128 v[36:39], v75 offset:16384
  ds_read_b128 v[40:43], v75 offset:17408
  v_smfmac_f32_16x16x64_bf16 v[32:35], v[8:11], v[216:223], v74
  v_smfmac_f32_16x16x64_bf16 v[20:23], v[12:15], a[80:87], v74
  v_smfmac_f32_16x16x64_bf16 v[24:27], v[12:15], a[88:95], v74
  v_smfmac_f32_16x16x64_bf16 v[28:31], v[12:15], v[224:231], v74
  v_smfmac_f32_16x16x64_bf16 v[32:35], v[12:15], v[232:239], v74
  s_waitcnt vmcnt(1)
  s_barrier
Cs0_lastr:
  ds_read_b128 v[0:3], v76 offset:8704
  ds_read_b128 v[8:11], v76 offset:9728
  ds_read_b128 v[16:19], v76 offset:10752
  ds_read_b128 v[4:7], v76 offset:11776
  ds_read_b128 v[12:15], v76 offset:12800
  s_waitcnt lgkmcnt(4)
  v_max3_u32 v72, v0, v1, v2
  s_waitcnt lgkmcnt(1)
  v_max3_u32 v72, v72, v3, v4
  v_max3_u32 v72, v72, v5, v6
  v_max3_u32 v72, v72, v7, v8
  v_max3_u32 v72, v72, v9, v10
  s_waitcnt lgkmcnt(0)
  v_max3_u32 v72, v72, v11, v12
  v_max3_u32 v72, v72, v13, v14
  v_max3_u32 v72, v72, v15, v16
  v_max3_u32 v72, v72, v17, v18
  v_max_u32 v72, v72, v19
  v_cmp_eq_u32 vcc, -1, v72
  s_cbranch_vccnz Cs0_lastp
Cs0_lastg:
  v_smfmac_f32_16x16x64_bf16 v[28:31], v[0:3], v[60:67], v74
  ds_read_b128 v[60:63], v75 offset:18432
  ds_read_b128 v[64:67], v75 offset:19456
  v_smfmac_f32_16x16x64_bf16 v[32:35], v[0:3], v[44:51], v74
  v_smfmac_f32_16x16x64_bf16 v[28:31], v[8:11], v[36:43], v74
  v_smfmac_f32_16x16x64_bf16 v[28:31], v[16:19], v[240:247], v74
  v_smfmac_f32_16x16x64_bf16 v[28:31], v[4:7], a[0:7], v74
  v_smfmac_f32_16x16x64_bf16 v[28:31], v[12:15], a[16:23], v74
  v_smfmac_f32_16x16x64_bf16 v[32:35], v[16:19], v[248:255], v74
  v_smfmac_f32_16x16x64_bf16 v[32:35], v[4:7], a[8:15], v74
  s_waitcnt lgkmcnt(0)
  v_smfmac_f32_16x16x64_bf16 v[32:35], v[12:15], a[24:31], v74
  v_smfmac_f32_16x16x64_bf16 v[32:35], v[8:11], v[60:67], v74
  v_smfmac_f32_16x16x64_bf16 v[20:23], v[0:3], a[96:103], v74
  v_smfmac_f32_16x16x64_bf16 v[20:23], v[8:11], a[112:119], v74
  v_add_f32 v28, v28, v30
  v_add_f32 v32, v32, v34
  v_cvt_pk_bf16_f32 v30, v28, v32
  v_smfmac_f32_16x16x64_bf16 v[20:23], v[16:19], a[128:135], v74
  ds_write_b32 v79, v30 offset:256
  v_add_f32 v29, v29, v31
  v_add_f32 v33, v33, v35
  v_cvt_pk_bf16_f32 v31, v29, v33
  v_smfmac_f32_16x16x64_bf16 v[20:23], v[4:7], a[144:151], v74
  ds_write_b32 v79, v31 offset:832
  v_smfmac_f32_16x16x64_bf16 v[20:23], v[12:15], a[160:167], v74
  v_smfmac_f32_16x16x64_bf16 v[24:27], v[0:3], a[104:111], v74
  v_smfmac_f32_16x16x64_bf16 v[24:27], v[8:11], a[120:127], v74
  v_smfmac_f32_16x16x64_bf16 v[24:27], v[16:19], a[136:143], v74
  s_waitcnt lgkmcnt(0)
  s_barrier
  ds_read_b64 v[52:53], v77 offset:256
  v_add_f32 v20, v20, v22
  v_smfmac_f32_16x16x64_bf16 v[24:27], v[4:7], a[152:159], v74
  v_add_f32 v21, v21, v23
  v_smfmac_f32_16x16x64_bf16 v[24:27], v[12:15], a[168:175], v74
  v_cvt_pk_bf16_f32 v54, v20, v21
  s_add_u32 s68, s68, 655360
  s_nop 3
  v_add_f32 v24, v24, v26
  v_add_f32 v25, v25, v27
  v_cvt_pk_bf16_f32 v55, v24, v25
  s_waitcnt lgkmcnt(0)
  buffer_store_dwordx4 v[52:55], v76, s[8:11], s68 offen sc1
  s_branch Cs0_done
Cs0_lastp:
  s_add_u32 s72, s72, 2
  s_cmp_ge_u32 s72, 131072
  s_cbranch_scc1 Cs0_lastg
  s_barrier
  buffer_load_dwordx4 v76, s[8:11], s85 offen offset:0 sc1 lds
  s_waitcnt vmcnt(0)
  s_barrier
  s_branch Cs0_lastr
Cs0_done:
  s_branch L_cexit
L_w5:
  v_mov_b64 v[20:21], 0
  v_mov_b64 v[22:23], 0
  v_mov_b64 v[24:25], 0
  v_mov_b64 v[26:27], 0
  v_mov_b64 v[28:29], 0
  v_mov_b64 v[30:31], 0
  v_mov_b64 v[32:33], 0
  v_mov_b64 v[34:35], 0
  s_mov_b32 s78, 0x3f803f80
  s_mov_b32 s79, s78
  s_mov_b32 s65, 360448
  s_mov_b32 m0, 15872
  s_lshl_b32 s71, s53, 2
  s_add_u32 s71, s71, 128
  s_movk_i32 s56, 0x1000
  v_lshlrev_b32 v73, 2, v76
  v_mov_b32 v72, 0
  s_mov_b64 s[16:17], s[8:9]
  s_mov_b32 s18, 268435456
  s_mov_b32 s19, 0x20000
  s_getpc_b64 s[20:21]
Cs1_pc:
  s_add_u32 s20, s20, (Cs1_last - Cs1_pc)
  s_addc_u32 s21, s21, 0
  v_mov_b32 v68, 14880
  buffer_load_dwordx4 v[52:55], v76, s[8:11], s59 offen offset:0 sc1
  buffer_load_dwordx4 v[56:59], v76, s[8:11], s59 offen offset:1024 sc1
  ds_read_b128 v[36:39], v76 offset:20480
  ds_read_b128 v[40:43], v76 offset:21504
  ds_read_b128 v[60:63], v76 offset:22528
  ds_read_b128 v[64:67], v76 offset:23552
  ds_read_b128 v[0:3], v76 offset:4608
  ds_read_b128 v[4:7], v76 offset:5632
  ds_read_b128 v[8:11], v76 offset:6656
  ds_read_b128 v[12:15], v76 offset:7680
  s_waitcnt lgkmcnt(0)
  s_cmp_eq_u32 s66, 1
  s_branch Cs1_top2
.p2align 6
Cs1_h2:
  ds_read_b128 v[36:39], v76 offset:20480
  s_cmp_eq_u32 s66, 62
  s_cselect_b64 s[16:17], s[20:21], s[16:17]
  s_cselect_b32 s18, (Cs1_done - Cs1_last), s18
  s_cselect_b32 s70, 0, s70
  s_cmp_eq_u32 s66, 63
  s_cselect_b32 s59, 268435456, s59
  s_cselect_b32 s58, 268435456, s58
  ds_read_b128 v[40:43], v76 offset:21504
  v_mov_b64 v[20:21], 0
  v_mov_b64 v[22:23], 0
  v_mov_b64 v[24:25], 0
  v_mov_b64 v[26:27], 0
  v_mov_b32 v68, 14880
  ds_read_b128 v[60:63], v76 offset:22528
  v_mov_b64 v[28:29], 0
  v_mov_b64 v[30:31], 0
  v_mov_b64 v[32:33], 0
  v_mov_b64 v[34:35], 0
  v_lshlrev_b32 v73, 2, v76
  buffer_load_dwordx4 v[52:55], v76, s[8:11], s59 offen offset:0 sc1
  buffer_load_dwordx4 v[56:59], v76, s[8:11], s59 offen offset:1024 sc1
  s_waitcnt vmcnt(0)
  s_mov_b64 vcc, -1
Cs1_h2r:
  s_mov_b64 exec, vcc
  buffer_load_dwordx4 v[8:11], v76, s[8:11], s65 offen offset:2048 sc1
  buffer_load_dwordx4 v[0:3], v76, s[8:11], s85 offen offset:0 sc1
  s_mov_b64 exec, -1
  s_add_u32 s67, s67, 1
  s_cmp_lt_u32 s67, 131072
  s_cselect_b32 s54, -2, -1
  s_waitcnt vmcnt(1)
  v_max3_u32 v72, v8, v9, v10
  s_waitcnt vmcnt(0)
  v_max3_u32 v72, v72, v11, v0
  v_max3_u32 v72, v72, v1, v2
  v_max_u32 v72, v72, v3
  v_cmp_lt_u32 vcc, s54, v72
  s_cbranch_vccnz Cs1_h2r
  ds_write_b128 v76, v[8:11] offset:6656
  ds_write_b128 v76, v[0:3] offset:11776
Cs1_h2w:
  s_cmp_eq_u32 s66, 63
  s_waitcnt lgkmcnt(0)
  s_barrier
  ds_read_b128 v[0:3], v76 offset:4608
Cs1_top2:
  v_smfmac_f32_16x16x64_bf16 v[20:23], v[8:11], v[112:119], v74
  s_cbranch_scc1 Cs1_last
  v_smfmac_f32_16x16x64_bf16 v[24:27], v[8:11], v[120:127], v74
  buffer_load_dwordx4 v[44:47], v76, s[8:11], s58 offen offset:0 sc1
  s_mov_b32 m0, 15872
  v_smfmac_f32_16x16x64_bf16 v[28:31], v[8:11], v[208:215], v74
  buffer_load_dwordx4 v[48:51], v76, s[8:11], s58 offen offset:1024 sc1
  v_smfmac_f32_16x16x64_bf16 v[32:35], v[8:11], v[216:223], v74
  ds_read_b128 v[4:7], v76 offset:5632
  s_waitcnt lgkmcnt(1)
  v_smfmac_f32_16x16x64_bf16 v[20:23], v[0:3], v[80:87], v74
  ds_read_b128 v[12:15], v76 offset:7680
  v_smfmac_f32_16x16x64_bf16 v[28:31], v[0:3], v[36:43], v74
  ds_read_b128 v[36:39], v76 offset:36864
  v_smfmac_f32_16x16x64_bf16 v[24:27], v[0:3], v[88:95], v74
  buffer_store_dwordx4 v[16:19], v76, s[8:11], s68 offen sc1
  ds_read_b128 v[40:43], v76 offset:37888
  v_smfmac_f32_16x16x64_bf16 v[32:35], v[0:3], v[60:67], v74
  ds_read_b128 v[60:63], v76 offset:38912
  s_waitcnt lgkmcnt(4)
  v_smfmac_f32_16x16x64_bf16 v[20:23], v[4:7], v[96:103], v74
  ds_read_b128 v[64:67], v76 offset:39936
  v_smfmac_f32_16x16x64_bf16 v[24:27], v[4:7], v[104:111], v74
  buffer_load_dword v73, s[16:19], s70 offen lds
  s_waitcnt vmcnt(4)
  s_waitcnt lgkmcnt(4)
  v_smfmac_f32_16x16x64_bf16 v[20:23], v[12:15], v[128:135], v74
  s_barrier
  s_waitcnt lgkmcnt(2)
  v_smfmac_f32_16x16x64_bf16 v[28:31], v[4:7], v[36:43], v74
  ds_read_b128 v[8:11], v76 offset:8704
  v_smfmac_f32_16x16x64_bf16 v[24:27], v[12:15], v[136:143], v74
  ds_read_b128 v[36:39], v76 offset:53248
  s_waitcnt lgkmcnt(2)
  v_smfmac_f32_16x16x64_bf16 v[32:35], v[4:7], v[60:67], v74
  ds_read_b128 v[40:43], v76 offset:54272
  v_smfmac_f32_16x16x64_bf16 v[28:31], v[12:15], v[224:231], v74
  ds_read_b128 v[60:63], v76 offset:55296
  v_smfmac_f32_16x16x64_bf16 v[32:35], v[12:15], v[232:239], v74
  ds_read_b128 v[64:67], v76 offset:56320
  s_waitcnt lgkmcnt(4)
  v_smfmac_f32_16x16x64_bf16 v[20:23], v[8:11], v[144:151], v74
  ds_read_b128 v[0:3], v76 offset:9728
  s_waitcnt lgkmcnt(3)
  v_smfmac_f32_16x16x64_bf16 v[28:31], v[8:11], v[36:43], v74
  s_barrier
  ds_read_b128 v[4:7], v76 offset:11776
  v_smfmac_f32_16x16x64_bf16 v[24:27], v[8:11], v[152:159], v74
  ds_read_b128 v[36:39], v75 offset:4096
  ds_read_b128 v[40:43], v75 offset:5120
  s_waitcnt lgkmcnt(4)
  v_smfmac_f32_16x16x64_bf16 v[32:35], v[8:11], v[60:67], v74
  ds_read_b128 v[16:19], v76 offset:10752
  s_waitcnt lgkmcnt(4)
  v_smfmac_f32_16x16x64_bf16 v[20:23], v[0:3], v[160:167], v74
  ds_read_b128 v[12:15], v76 offset:12800
  v_smfmac_f32_16x16x64_bf16 v[24:27], v[0:3], v[168:175], v74
  ds_read_b128 v[60:63], v75 offset:6144
  ds_read_b128 v[64:67], v75 offset:7168
  s_waitcnt lgkmcnt(6)
  v_smfmac_f32_16x16x64_bf16 v[20:23], v[4:7], v[176:183], v74
  s_waitcnt lgkmcnt(3)
  v_smfmac_f32_16x16x64_bf16 v[20:23], v[16:19], v[36:43], v74
  ds_read_b128 v[36:39], v75 offset:20480
  s_waitcnt lgkmcnt(3)
  v_smfmac_f32_16x16x64_bf16 v[20:23], v[12:15], v[192:199], v74
  ds_read_b128 v[40:43], v75 offset:21504
  s_waitcnt lgkmcnt(2)
  v_smfmac_f32_16x16x64_bf16 v[24:27], v[16:19], v[60:67], v74
  ds_read_b128 v[60:63], v75 offset:22528
  v_smfmac_f32_16x16x64_bf16 v[24:27], v[4:7], v[184:191], v74
  ds_read_b128 v[64:67], v75 offset:23552
  v_add_f32 v20, v20, v22
  v_smfmac_f32_16x16x64_bf16 v[24:27], v[12:15], v[200:207], v74
  v_add_f32 v21, v21, v23
  v_smfmac_f32_16x16x64_bf16 v[28:31], v[16:19], v[240:247], v74
  s_waitcnt lgkmcnt(2)
  v_mov_b64 v[70:71], s[78:79]
  v_smfmac_f32_16x16x64_bf16 v[28:31], v[0:3], v[36:43], v74
  ds_read_b128 v[36:39], v68
  v_add_f32 v24, v24, v26
  v_smfmac_f32_16x16x64_bf16 v[28:31], v[4:7], a[0:7], v74
  ds_read_b128 v[40:43], v68
  v_cvt_pk_bf16_f32 v22, v20, v24
  v_smfmac_f32_16x16x64_bf16 v[28:31], v[12:15], a[16:23], v74
  ds_write_b32 v79, v22 offset:0
  s_waitcnt lgkmcnt(3)
  v_add_f32 v25, v25, v27
  v_cvt_pk_bf16_f32 v23, v21, v25
  v_smfmac_f32_16x16x64_bf16 v[32:35], v[0:3], v[60:67], v74
  ds_write_b32 v79, v23 offset:576
  v_cmp_u_f32 vcc, v20, v21
  v_smfmac_f32_16x16x64_bf16 v[32:35], v[16:19], v[248:255], v74
  v_add_f32 v28, v28, v30
  v_smfmac_f32_16x16x64_bf16 v[32:35], v[4:7], a[8:15], v74
  v_add_f32 v29, v29, v31
  v_smfmac_f32_16x16x64_bf16 v[32:35], v[12:15], a[24:31], v74
  s_cbranch_vccnz Cs1_rec
Cs1_recok:
  s_waitcnt lgkmcnt(3)
  v_smfmac_f32_16x16x64_bf16 v[36:39], v[16:19], a[128:135], v74
  s_waitcnt lgkmcnt(0)
  s_barrier
  ds_read_b128 v[60:63], v77
  v_smfmac_f32_16x16x64_bf16 v[40:43], v[16:19], a[136:143], v74
  ds_read_b128 v[64:67], v77 offset:128
  v_add_f32 v32, v32, v34
  v_cvt_pk_bf16_f32 v30, v28, v32
  v_smfmac_f32_16x16x64_bf16 v[36:39], v[0:3], a[112:119], v74
  ds_write_b32 v79, v30 offset:256
  v_add_f32 v33, v33, v35
  v_cvt_pk_bf16_f32 v31, v29, v33
  v_smfmac_f32_16x16x64_bf16 v[40:43], v[0:3], a[120:127], v74
  ds_write_b32 v79, v31 offset:832
  v_xor_b32 v75, 0x8000, v75
  v_smfmac_f32_16x16x64_bf16 v[36:39], v[4:7], a[144:151], v74
  ds_read_b128 v[0:3], v76 offset:4608
  v_mov_b32 v29, 0
  v_smfmac_f32_16x16x64_bf16 v[40:43], v[4:7], a[152:159], v74
  s_waitcnt vmcnt(2) lgkmcnt(3)
  v_mov_b32 v30, 0
  v_mfma_f32_16x16x32_bf16 v[44:47], v[44:47], v[60:63], 0
  ds_read_b128 v[4:7], v76 offset:5632
  s_waitcnt lgkmcnt(2)
  v_mfma_f32_16x16x32_bf16 v[44:47], v[48:51], v[64:67], v[44:47]
  s_barrier
  v_smfmac_f32_16x16x64_bf16 v[36:39], v[8:11], a[96:103], v74
  ds_read_b128 v[20:23], v77 offset:256
  ds_read_b128 v[24:27], v77 offset:384
  v_smfmac_f32_16x16x64_bf16 v[40:43], v[8:11], a[104:111], v74
  ds_read_b128 v[8:11], v76 offset:6656
  v_add_f32_dpp v72, v46, v44 quad_perm:[2,3,0,1] row_mask:0xf bank_mask:0xf
  v_add_f32_dpp v73, v47, v45 quad_perm:[2,3,0,1] row_mask:0xf bank_mask:0xf
  v_smfmac_f32_16x16x64_bf16 v[36:39], v[12:15], a[160:167], v74
  s_waitcnt lgkmcnt(4)
  v_exp_f32_dpp v72, v72 quad_perm:[0,1,0,1] row_mask:0xf bank_mask:0xf
  v_smfmac_f32_16x16x64_bf16 v[40:43], v[12:15], a[168:175], v74
  ds_read_b128 v[12:15], v76 offset:7680
  v_exp_f32_dpp v73, v73 quad_perm:[0,1,0,1] row_mask:0xf bank_mask:0xf
  v_smfmac_f32_16x16x64_bf16 v[36:39], v[0:3], a[32:39], v74
  s_waitcnt lgkmcnt(2)
  v_cvt_pk_bf16_f32 v72, v72, v73
  v_mfma_f32_16x16x32_bf16 v[20:23], v[20:23], v[60:63], 0
  ds_write_b32 v78, v72 offset:516
  v_mov_b64 v[16:17], 0
  v_mfma_f32_16x16x32_bf16 v[20:23], v[24:27], v[64:67], v[20:23]
  ds_read_b128 v[44:47], v75 offset:20480
  v_mov_b64 v[18:19], 0
  v_smfmac_f32_16x16x64_bf16 v[40:43], v[0:3], a[40:47], v74
  ds_read_b128 v[48:51], v75 offset:21504
  v_mov_b64 v[68:69], s[78:79]
  v_smfmac_f32_16x16x64_bf16 v[36:39], v[4:7], a[48:55], v74
  s_waitcnt lgkmcnt(4)
  v_add_f32_dpp v24, v22, v20 quad_perm:[2,3,0,1] row_mask:0xf bank_mask:0xf
  v_add_f32_dpp v25, v23, v21 quad_perm:[2,3,0,1] row_mask:0xf bank_mask:0xf
  v_smfmac_f32_16x16x64_bf16 v[36:39], v[8:11], a[64:71], v74
  s_waitcnt lgkmcnt(2)
  s_barrier
  ds_read_b128 v[32:35], v78 offset:512
  v_smfmac_f32_16x16x64_bf16 v[36:39], v[12:15], a[80:87], v74
  ds_read_b128 v[60:63], v75 offset:22528
  v_mul_f32 v24, s69, v24
  v_smfmac_f32_16x16x64_bf16 v[40:43], v[4:7], a[56:63], v74
  ds_read_b128 v[64:67], v75 offset:23552
  v_mul_f32 v25, s69, v25
  v_smfmac_f32_16x16x64_bf16 v[40:43], v[8:11], a[72:79], v74
  v_exp_f32_dpp v24, v24 quad_perm:[0,1,0,1] row_mask:0xf bank_mask:0xf
  v_smfmac_f32_16x16x64_bf16 v[40:43], v[12:15], a[88:95], v74
  s_waitcnt lgkmcnt(2)
  v_exp_f32_dpp v25, v25 quad_perm:[0,1,0,1] row_mask:0xf bank_mask:0xf
  v_mfma_f32_16x16x32_bf16 v[8:11], v[32:35], v[68:71], 0
  v_add_f32 v36, v36, v38
  v_add_f32 v37, v37, v39
  v_mfma_f32_16x16x32_bf16 v[0:3], v[32:35], v[52:55], 0
  v_add_f32 v40, v40, v42
  v_add_f32 v41, v41, v43
  v_mfma_f32_16x16x32_bf16 v[4:7], v[32:35], v[56:59], 0
  v_cvt_pk_bf16_f32 v28, v24, v25
  v_cvt_pk_bf16_f32 v72, v36, v37
  v_cvt_pk_bf16_f32 v73, v40, v41
  v_mfma_f32_16x16x16_bf16 v[8:11], v[28:29], v[68:69], v[8:11]
  v_cvt_pk_bf16_f32 v31, v24, v25
  v_mov_b64 v[20:21], 0
  v_mfma_f32_16x16x16_bf16 v[0:3], v[28:29], v[72:73], v[0:3]
  ds_read_b128 v[68:71], v76 offset:13824
  v_mov_b64 v[22:23], 0
  v_mfma_f32_16x16x16_bf16 v[4:7], v[30:31], v[72:73], v[4:7]
  v_rcp_f32 v10, v8
  v_rcp_f32 v11, v9
  v_mul_f32 v0, v10, v0
  v_mul_f32 v1, v11, v1
  s_nop 0
  v_mul_f32 v4, v10, v4
  v_mul_f32 v5, v11, v5
  v_cvt_pk_bf16_f32 v2, v0, v4
  ds_write_b32 v79, v2 offset:8704
  v_cvt_pk_bf16_f32 v3, v1, v5
  ds_write_b32 v79, v3 offset:9280
  v_max3_f32 v8, v8, v9, v10
  v_max_f32 v8, v8, v11
  v_cmp_le_f32 vcc, 1317011456, v8
  v_mov_b64 v[24:25], 0
  v_mov_b64 v[26:27], 0
  s_cbranch_vccnz Cs1_mx
Cs1_mxok:
  s_waitcnt lgkmcnt(0)
  s_barrier
  ds_read_b128 v[0:3], v78 offset:8704
  ds_read_b128 v[4:7], v78 offset:8768
  ds_read_b128 v[8:11], v78 offset:8832
  ds_read_b128 v[12:15], v78 offset:8896
  s_waitcnt lgkmcnt(3)
  v_smfmac_f32_16x16x64_bf16 v[16:19], v[0:3], v[44:51], v74
  ds_read_b128 v[52:55], v75 offset:36864
  s_waitcnt lgkmcnt(3)
  v_smfmac_f32_16x16x64_bf16 v[16:19], v[4:7], v[60:67], v74
  ds_read_b128 v[56:59], v75 offset:37888
  s_waitcnt lgkmcnt(3)
  v_smfmac_f32_16x16x64_bf16 v[16:19], v[8:11], a[176:183], v74
  ds_read_b128 v[36:39], v75 offset:38912
  s_waitcnt lgkmcnt(3)
  v_smfmac_f32_16x16x64_bf16 v[16:19], v[12:15], a[184:191], v74
  ds_read_b128 v[40:43], v75 offset:39936
  ds_read_b128 v[44:47], v75 offset:53248
  v_smfmac_f32_16x16x64_bf16 v[20:23], v[0:3], a[192:199], v74
  ds_read_b128 v[48:51], v75 offset:54272
  ds_read_b128 v[60:63], v75 offset:55296
  v_smfmac_f32_16x16x64_bf16 v[20:23], v[4:7], a[200:207], v74
  ds_read_b128 v[64:67], v75 offset:56320
  s_waitcnt lgkmcnt(6)
  v_cvt_pk_bf16_f32 v16, v16, v17
  v_cvt_pk_bf16_f32 v17, v18, v19
  v_bfi_b32 v16, 1, s72, v16
  v_smfmac_f32_16x16x64_bf16 v[20:23], v[8:11], v[52:59], v74
  buffer_store_dwordx2 v[16:17], v68, s[8:11], s73 offen sc1
  s_waitcnt lgkmcnt(4)
  v_smfmac_f32_16x16x64_bf16 v[20:23], v[12:15], v[36:43], v74
  v_mov_b64 v[32:33], 0
  v_smfmac_f32_16x16x64_bf16 v[24:27], v[0:3], a[208:215], v74
  v_mov_b64 v[34:35], 0
  v_smfmac_f32_16x16x64_bf16 v[24:27], v[4:7], a[216:223], v74
  s_waitcnt lgkmcnt(2)
  v_cvt_pk_bf16_f32 v20, v20, v21
  v_cvt_pk_bf16_f32 v21, v22, v23
  v_bfi_b32 v20, 1, s72, v20
  v_smfmac_f32_16x16x64_bf16 v[24:27], v[8:11], v[44:51], v74
  buffer_store_dwordx2 v[20:21], v68, s[8:11], s74 offen sc1
  s_waitcnt lgkmcnt(0)
  v_smfmac_f32_16x16x64_bf16 v[24:27], v[12:15], v[60:67], v74
  v_smfmac_f32_16x16x64_bf16 v[32:35], v[0:3], a[224:231], v74
  v_smfmac_f32_16x16x64_bf16 v[32:35], v[4:7], a[232:239], v74
  v_cvt_pk_bf16_f32 v24, v24, v25
  v_cvt_pk_bf16_f32 v25, v26, v27
  v_bfi_b32 v24, 1, s72, v24
  v_smfmac_f32_16x16x64_bf16 v[32:35], v[8:11], a[240:247], v74
  buffer_store_dwordx2 v[24:25], v68, s[8:11], s75 offen sc1
  v_smfmac_f32_16x16x64_bf16 v[32:35], v[12:15], a[248:255], v74
  v_mov_b64 v[18:19], v[72:73]
  s_nop 4
  v_cvt_pk_bf16_f32 v32, v32, v33
  v_cvt_pk_bf16_f32 v33, v34, v35
  v_bfi_b32 v32, 1, s72, v32
  buffer_store_dwordx2 v[32:33], v68, s[8:11], s76 offen sc1
  ds_read_b128 v[0:3], v76 offset:14848
  s_waitcnt lgkmcnt(0)
  ds_read_b64 v[16:17], v77 offset:264
  s_waitcnt lgkmcnt(0)
  ds_read_b128 v[64:67], v76 offset:23552
  s_waitcnt lgkmcnt(0)
  s_add_u32 s66, s66, 1
  s_xor_b32 s64, s64, 16384
  s_xor_b32 s65, s65, 16384
  s_add_u32 s58, s58, 655360
  s_add_u32 s59, s59, 655360
  s_add_u32 s70, s70, 655360
  s_add_u32 s68, s68, 655360
  s_mov_b32 m0, 11776
  s_add_u32 s85, s65, 7168
  v_xor_b32 v75, 0x8000, v75
  s_waitcnt vmcnt(0)
  buffer_load_dwordx4 v[52:55], v76, s[8:11], s60 offen offset:0 sc1
  buffer_load_dwordx4 v[56:59], v76, s[8:11], s60 offen offset:1024 sc1
  s_waitcnt lgkmcnt(0)
  s_waitcnt vmcnt(1)
  v_mfma_f32_16x16x32_bf16 v[4:7], v[0:3], v[52:55], 0
  v_bitop3_b32 v72, v52, v54, s72 bitop3:0x7e
  s_waitcnt vmcnt(0)
  v_mfma_f32_16x16x32_bf16 v[4:7], v[0:3], v[56:59], v[4:7]
  v_bitop3_b32 v73, v56, v58, s72 bitop3:0x7e
  v_bitop3_b32 v72, v72, v73, 1 bitop3:0xa8
  v_cmp_ne_u32 vcc, 0, v72
  s_cbranch_vccnz Cs1_h1r
  s_nop 2
  v_add_f32_dpp v4, v4, v4 row_ror:4 row_mask:0xf bank_mask:0xf
  v_add_f32_dpp v5, v5, v5 row_ror:4 row_mask:0xf bank_mask:0xf
  s_nop 0
  v_add_f32_dpp v4, v4, v4 row_ror:8 row_mask:0xf bank_mask:0xf
  v_add_f32_dpp v5, v5, v5 row_ror:8 row_mask:0xf bank_mask:0xf
  v_cvt_pk_bf16_f32 v4, v4, v5
  buffer_store_dword v4, v69, s[8:11], s62 offen sc1
  s_xor_b32 s62, s62, 16384
  buffer_store_dword v71, v69, s[8:11], s62 offen sc1
  s_xor_b32 s72, s72, 1
  s_branch Cs1_h2
Cs1_h1r:
  s_mov_b64 exec, vcc
  buffer_load_dwordx4 v[52:55], v76, s[8:11], s60 offen offset:0 sc1
  buffer_load_dwordx4 v[56:59], v76, s[8:11], s60 offen offset:1024 sc1
  s_mov_b64 exec, -1
  s_add_u32 s67, s67, 1
  s_waitcnt vmcnt(1)
  v_mfma_f32_16x16x32_bf16 v[4:7], v[0:3], v[52:55], 0
  v_bitop3_b32 v72, v52, v54, s72 bitop3:0x7e
  s_waitcnt vmcnt(0)
  v_mfma_f32_16x16x32_bf16 v[4:7], v[0:3], v[56:59], v[4:7]
  v_bitop3_b32 v73, v56, v58, s72 bitop3:0x7e
  v_bitop3_b32 v72, v72, v73, 1 bitop3:0xa8
  v_cmp_ne_u32 vcc, 0, v72
  s_cbranch_vccz Cs1_h1p
Cs1_h1s:
  s_mov_b64 exec, vcc
  buffer_load_dwordx4 v[52:55], v76, s[8:11], s60 offen offset:0 sc1
  buffer_load_dwordx4 v[56:59], v76, s[8:11], s60 offen offset:1024 sc1
  s_mov_b64 exec, -1
  s_add_u32 s67, s67, 1
  s_waitcnt vmcnt(1)
  v_mfma_f32_16x16x32_bf16 v[4:7], v[0:3], v[52:55], 0
  v_bitop3_b32 v72, v52, v54, s72 bitop3:0x7e
  s_waitcnt vmcnt(0)
  v_mfma_f32_16x16x32_bf16 v[4:7], v[0:3], v[56:59], v[4:7]
  v_bitop3_b32 v73, v56, v58, s72 bitop3:0x7e
  v_bitop3_b32 v72, v72, v73, 1 bitop3:0xa8
  v_cmp_ne_u32 vcc, 0, v72
  s_cbranch_vccz Cs1_h1p
  s_cmp_lt_u32 s67, 131072
  s_cbranch_scc1 Cs1_h1s
Cs1_h1p:
  s_nop 2
  v_add_f32_dpp v4, v4, v4 row_ror:4 row_mask:0xf bank_mask:0xf
  v_add_f32_dpp v5, v5, v5 row_ror:4 row_mask:0xf bank_mask:0xf
  s_nop 0
  v_add_f32_dpp v4, v4, v4 row_ror:8 row_mask:0xf bank_mask:0xf
  v_add_f32_dpp v5, v5, v5 row_ror:8 row_mask:0xf bank_mask:0xf
  v_cvt_pk_bf16_f32 v4, v4, v5
  buffer_store_dword v4, v69, s[8:11], s62 offen sc1
  s_xor_b32 s62, s62, 16384
  buffer_store_dword v71, v69, s[8:11], s62 offen sc1
  s_xor_b32 s72, s72, 1
  s_branch Cs1_h2
Cs1_rec:
  s_nop 7
  s_waitcnt vmcnt(0) lgkmcnt(0)
  v_max3_u32 v72, v0, v1, v2
  v_max3_u32 v72, v72, v3, v4
  v_max3_u32 v72, v72, v5, v6
  v_max3_u32 v72, v72, v7, v8
  v_max3_u32 v72, v72, v9, v10
  v_max3_u32 v72, v72, v11, v12
  v_max3_u32 v72, v72, v13, v14
  v_max3_u32 v72, v72, v15, v16
  v_max3_u32 v72, v72, v17, v18
  v_max_u32 v72, v72, v19
  v_cmp_eq_u32 vcc, -1, v72
  s_cbranch_vccz Cs1_recok
  s_barrier
  v_mov_b64 v[20:21], 0
  v_mov_b64 v[22:23], 0
  v_mov_b64 v[24:25], 0
  v_mov_b64 v[26:27], 0
  v_mov_b64 v[28:29], 0
  v_mov_b64 v[30:31], 0
  v_mov_b64 v[32:33], 0
  v_mov_b64 v[34:35], 0
  s_waitcnt lgkmcnt(0)
  s_barrier
  ds_read_b128 v[0:3], v76 offset:4608
  s_waitcnt lgkmcnt(0)
  v_smfmac_f32_16x16x64_bf16 v[20:23], v[0:3], v[80:87], v74
  v_smfmac_f32_16x16x64_bf16 v[24:27], v[0:3], v[88:95], v74
  ds_read_b128 v[60:63], v76 offset:20480
  ds_read_b128 v[64:67], v76 offset:21504
  s_waitcnt lgkmcnt(0)
  v_smfmac_f32_16x16x64_bf16 v[28:31], v[0:3], v[60:67], v74
  ds_read_b128 v[60:63], v76 offset:22528
  ds_read_b128 v[64:67], v76 offset:23552
  s_waitcnt lgkmcnt(0)
  v_smfmac_f32_16x16x64_bf16 v[32:35], v[0:3], v[60:67], v74
  ds_read_b128 v[4:7], v76 offset:5632
  s_waitcnt lgkmcnt(0)
  v_smfmac_f32_16x16x64_bf16 v[20:23], v[4:7], v[96:103], v74
  v_smfmac_f32_16x16x64_bf16 v[24:27], v[4:7], v[104:111], v74
  ds_read_b128 v[60:63], v76 offset:36864
  ds_read_b128 v[64:67], v76 offset:37888
  s_waitcnt lgkmcnt(0)
  v_smfmac_f32_16x16x64_bf16 v[28:31], v[4:7], v[60:67], v74
  ds_read_b128 v[60:63], v76 offset:38912
  ds_read_b128 v[64:67], v76 offset:39936
  s_waitcnt lgkmcnt(0)
  v_smfmac_f32_16x16x64_bf16 v[32:35], v[4:7], v[60:67], v74
  ds_read_b128 v[8:11], v76 offset:6656
  s_waitcnt lgkmcnt(0)
  v_smfmac_f32_16x16x64_bf16 v[20:23], v[8:11], v[112:119], v74
  v_smfmac_f32_16x16x64_bf16 v[24:27], v[8:11], v[120:127], v74
  v_smfmac_f32_16x16x64_bf16 v[28:31], v[8:11], v[208:215], v74
  v_smfmac_f32_16x16x64_bf16 v[32:35], v[8:11], v[216:223], v74
  ds_read_b128 v[12:15], v76 offset:7680
  s_waitcnt lgkmcnt(0)
  v_smfmac_f32_16x16x64_bf16 v[20:23], v[12:15], v[128:135], v74
  v_smfmac_f32_16x16x64_bf16 v[24:27], v[12:15], v[136:143], v74
  v_smfmac_f32_16x16x64_bf16 v[28:31], v[12:15], v[224:231], v74
  v_smfmac_f32_16x16x64_bf16 v[32:35], v[12:15], v[232:239], v74
  ds_read_b128 v[8:11], v76 offset:8704
  s_waitcnt lgkmcnt(0)
  v_smfmac_f32_16x16x64_bf16 v[20:23], v[8:11], v[144:151], v74
  v_smfmac_f32_16x16x64_bf16 v[24:27], v[8:11], v[152:159], v74
  ds_read_b128 v[60:63], v76 offset:53248
  ds_read_b128 v[64:67], v76 offset:54272
  s_waitcnt lgkmcnt(0)
  v_smfmac_f32_16x16x64_bf16 v[28:31], v[8:11], v[60:67], v74
  ds_read_b128 v[60:63], v76 offset:55296
  ds_read_b128 v[64:67], v76 offset:56320
  s_waitcnt lgkmcnt(0)
  v_smfmac_f32_16x16x64_bf16 v[32:35], v[8:11], v[60:67], v74
  ds_read_b128 v[0:3], v76 offset:9728
  s_waitcnt lgkmcnt(0)
  v_smfmac_f32_16x16x64_bf16 v[20:23], v[0:3], v[160:167], v74
  v_smfmac_f32_16x16x64_bf16 v[24:27], v[0:3], v[168:175], v74
  ds_read_b128 v[60:63], v75 offset:20480
  ds_read_b128 v[64:67], v75 offset:21504
  s_waitcnt lgkmcnt(0)
  v_smfmac_f32_16x16x64_bf16 v[28:31], v[0:3], v[60:67], v74
  ds_read_b128 v[60:63], v75 offset:22528
  ds_read_b128 v[64:67], v75 offset:23552
  s_waitcnt lgkmcnt(0)
  v_smfmac_f32_16x16x64_bf16 v[32:35], v[0:3], v[60:67], v74
  ds_read_b128 v[16:19], v76 offset:10752
  ds_read_b128 v[60:63], v75 offset:4096
  ds_read_b128 v[64:67], v75 offset:5120
  s_waitcnt lgkmcnt(0)
  v_smfmac_f32_16x16x64_bf16 v[20:23], v[16:19], v[60:67], v74
  ds_read_b128 v[60:63], v75 offset:6144
  ds_read_b128 v[64:67], v75 offset:7168
  s_waitcnt lgkmcnt(0)
  v_smfmac_f32_16x16x64_bf16 v[24:27], v[16:19], v[60:67], v74
  v_smfmac_f32_16x16x64_bf16 v[28:31], v[16:19], v[240:247], v74
  v_smfmac_f32_16x16x64_bf16 v[32:35], v[16:19], v[248:255], v74
  ds_read_b128 v[4:7], v76 offset:11776
  s_waitcnt lgkmcnt(0)
  v_smfmac_f32_16x16x64_bf16 v[20:23], v[4:7], v[176:183], v74
  v_smfmac_f32_16x16x64_bf16 v[24:27], v[4:7], v[184:191], v74
  v_smfmac_f32_16x16x64_bf16 v[28:31], v[4:7], a[0:7], v74
  v_smfmac_f32_16x16x64_bf16 v[32:35], v[4:7], a[8:15], v74
  ds_read_b128 v[12:15], v76 offset:12800
  s_waitcnt lgkmcnt(0)
  v_smfmac_f32_16x16x64_bf16 v[20:23], v[12:15], v[192:199], v74
  v_smfmac_f32_16x16x64_bf16 v[24:27], v[12:15], v[200:207], v74
  v_smfmac_f32_16x16x64_bf16 v[28:31], v[12:15], a[16:23], v74
  v_smfmac_f32_16x16x64_bf16 v[32:35], v[12:15], a[24:31], v74
  v_add_f32 v20, v20, v22
  v_add_f32 v21, v21, v23
  v_add_f32 v24, v24, v26
  v_cvt_pk_bf16_f32 v22, v20, v24
  ds_write_b32 v79, v22 offset:0
  v_add_f32 v25, v25, v27
  v_cvt_pk_bf16_f32 v23, v21, v25
  ds_write_b32 v79, v23 offset:576
  v_add_f32 v28, v28, v30
  v_add_f32 v29, v29, v31
  s_waitcnt lgkmcnt(0)
  s_nop 1
  s_branch Cs1_recok
Cs1_mx:
  s_waitcnt lgkmcnt(0)
  s_barrier
  buffer_load_dwordx4 v[0:3], v76, s[8:11], s58 offen offset:0 sc1
  ds_read_b128 v[20:23], v77 offset:0
  ds_read_b128 v[28:31], v77 offset:256
  buffer_load_dwordx4 v[4:7], v76, s[8:11], s58 offen offset:1024 sc1
  ds_read_b128 v[24:27], v77 offset:128
  ds_read_b128 v[32:35], v77 offset:384
  s_waitcnt vmcnt(1) lgkmcnt(3)
  v_mfma_f32_16x16x32_bf16 v[8:11], v[0:3], v[20:23], 0
  s_waitcnt vmcnt(0) lgkmcnt(1)
  v_mfma_f32_16x16x32_bf16 v[8:11], v[4:7], v[24:27], v[8:11]
  v_mfma_f32_16x16x32_bf16 v[12:15], v[28:31], v[20:23], 0
  s_waitcnt lgkmcnt(0)
  v_mfma_f32_16x16x32_bf16 v[12:15], v[32:35], v[24:27], v[12:15]
  v_add_f32_dpp v8, v10, v8 quad_perm:[2,3,0,1] row_mask:0xf bank_mask:0xf
  v_add_f32_dpp v9, v11, v9 quad_perm:[2,3,0,1] row_mask:0xf bank_mask:0xf
  s_nop 0
  v_mov_b32_dpp v8, v8 quad_perm:[0,1,0,1] row_mask:0xf bank_mask:0xf
  v_mov_b32_dpp v9, v9 quad_perm:[0,1,0,1] row_mask:0xf bank_mask:0xf
  s_nop 1
  v_add_f32_dpp v12, v14, v12 quad_perm:[2,3,0,1] row_mask:0xf bank_mask:0xf
  v_add_f32_dpp v13, v15, v13 quad_perm:[2,3,0,1] row_mask:0xf bank_mask:0xf
  s_nop 0
  v_mov_b32_dpp v12, v12 quad_perm:[0,1,0,1] row_mask:0xf bank_mask:0xf
  v_mov_b32_dpp v13, v13 quad_perm:[0,1,0,1] row_mask:0xf bank_mask:0xf
  v_mul_f32 v12, s69, v12
  ds_write_b32 v78, v8 offset:8708
  v_mul_f32 v13, s69, v13
  ds_write_b32 v78, v9 offset:8772
  s_waitcnt lgkmcnt(0)
  s_barrier
  ds_read_b128 v[36:39], v78 offset:8704
  ds_read_b128 v[40:43], v78 offset:8768
  s_waitcnt lgkmcnt(0)
  s_barrier
  v_max_f32 v16, v36, v37
  v_max3_f32 v16, v16, v38, v39
  v_max3_f32 v16, v16, v40, v41
  v_max3_f32 v16, v16, v42, v43
  v_max3_f32 v16, v16, v12, v13
  v_mov_b32 v17, v16
  s_nop 1
  v_permlane16_swap_b32 v16, v17
  v_max_f32 v16, v16, v17
  v_mov_b32 v17, v16
  s_nop 1
  v_permlane32_swap_b32 v16, v17
  v_max_f32 v16, v16, v17
  v_sub_f32 v36, v36, v16
  v_sub_f32 v37, v37, v16
  v_sub_f32 v38, v38, v16
  v_sub_f32 v39, v39, v16
  v_sub_f32 v40, v40, v16
  v_sub_f32 v41, v41, v16
  v_sub_f32 v42, v42, v16
  v_sub_f32 v43, v43, v16
  v_sub_f32 v12, v12, v16
  v_sub_f32 v13, v13, v16
  v_exp_f32 v36, v36
  v_exp_f32 v37, v37
  v_exp_f32 v38, v38
  v_exp_f32 v39, v39
  v_exp_f32 v40, v40
  v_exp_f32 v41, v41
  v_exp_f32 v42, v42
  v_exp_f32 v43, v43
  v_exp_f32 v12, v12
  v_exp_f32 v13, v13
  v_cvt_pk_bf16_f32 v32, v36, v40
  v_cvt_pk_bf16_f32 v33, v37, v41
  v_cvt_pk_bf16_f32 v34, v38, v42
  v_cvt_pk_bf16_f32 v35, v39, v43
  v_cvt_pk_bf16_f32 v28, v12, v13
  v_cvt_pk_bf16_f32 v31, v12, v13
  v_mov_b32 v29, 0
  v_mov_b32 v30, 0
  v_mov_b32 v68, 0x3f803f80
  v_mov_b32 v69, 0x3f803f80
  v_mov_b32 v70, 0x3f803f80
  v_mov_b32 v71, 0x3f803f80
  s_nop 1
  v_mfma_f32_16x16x32_bf16 v[8:11], v[32:35], v[68:71], 0
  v_mfma_f32_16x16x32_bf16 v[0:3], v[32:35], v[52:55], 0
  v_mfma_f32_16x16x32_bf16 v[4:7], v[32:35], v[56:59], 0
  v_mfma_f32_16x16x16_bf16 v[8:11], v[28:29], v[68:69], v[8:11]
  v_mfma_f32_16x16x16_bf16 v[0:3], v[28:29], v[72:73], v[0:3]
  v_mfma_f32_16x16x16_bf16 v[4:7], v[30:31], v[72:73], v[4:7]
  ds_read_b128 v[68:71], v76 offset:13824
  v_rcp_f32 v10, v8
  v_rcp_f32 v11, v9
  v_mul_f32 v0, v10, v0
  v_mul_f32 v1, v11, v1
  s_nop 0
  v_mul_f32 v4, v10, v4
  v_mul_f32 v5, v11, v5
  v_cvt_pk_bf16_f32 v2, v0, v4
  ds_write_b32 v79, v2 offset:8704
  v_cvt_pk_bf16_f32 v3, v1, v5
  ds_write_b32 v79, v3 offset:9280
  v_mov_b64 v[16:17], 0
  v_mov_b64 v[18:19], 0
  v_mov_b64 v[20:21], 0
  v_mov_b64 v[22:23], 0
  v_mov_b64 v[24:25], 0
  v_mov_b64 v[26:27], 0
  s_branch Cs1_mxok
Cs1_last:
  ds_read_b128 v[4:7], v76 offset:5632
  ds_read_b128 v[12:15], v76 offset:7680
  ds_read_b128 v[44:47], v76 offset:36864
  ds_read_b128 v[48:51], v76 offset:37888
  s_nop 5
  v_mov_b64 v[20:21], 0
  v_mov_b64 v[22:23], 0
  v_mov_b64 v[24:25], 0
  v_mov_b64 v[26:27], 0
  s_waitcnt lgkmcnt(4)
  v_smfmac_f32_16x16x64_bf16 v[28:31], v[0:3], v[36:43], v74
  ds_read_b128 v[36:39], v76 offset:38912
  ds_read_b128 v[40:43], v76 offset:39936
  v_smfmac_f32_16x16x64_bf16 v[32:35], v[0:3], v[60:67], v74
  s_waitcnt lgkmcnt(5)
  v_smfmac_f32_16x16x64_bf16 v[20:23], v[0:3], a[32:39], v74
  ds_read_b128 v[60:63], v76 offset:53248
  ds_read_b128 v[64:67], v76 offset:54272
  v_smfmac_f32_16x16x64_bf16 v[24:27], v[0:3], a[40:47], v74
  s_waitcnt lgkmcnt(4)
  v_smfmac_f32_16x16x64_bf16 v[20:23], v[4:7], a[48:55], v74
  buffer_store_dwordx4 v[16:19], v76, s[8:11], s68 offen sc1
  v_smfmac_f32_16x16x64_bf16 v[24:27], v[4:7], a[56:63], v74
  v_smfmac_f32_16x16x64_bf16 v[28:31], v[4:7], v[44:51], v74
  s_waitcnt lgkmcnt(2)
  v_smfmac_f32_16x16x64_bf16 v[20:23], v[8:11], a[64:71], v74
  ds_read_b128 v[44:47], v76 offset:55296
  ds_read_b128 v[48:51], v76 offset:56320
  v_smfmac_f32_16x16x64_bf16 v[24:27], v[8:11], a[72:79], v74
  v_smfmac_f32_16x16x64_bf16 v[32:35], v[4:7], v[36:43], v74
  v_smfmac_f32_16x16x64_bf16 v[28:31], v[8:11], v[208:215], v74
  ds_read_b128 v[36:39], v75 offset:20480
  ds_read_b128 v[40:43], v75 offset:21504
  v_smfmac_f32_16x16x64_bf16 v[32:35], v[8:11], v[216:223], v74
  v_smfmac_f32_16x16x64_bf16 v[20:23], v[12:15], a[80:87], v74
  v_smfmac_f32_16x16x64_bf16 v[24:27], v[12:15], a[88:95], v74
  v_smfmac_f32_16x16x64_bf16 v[28:31], v[12:15], v[224:231], v74
  v_smfmac_f32_16x16x64_bf16 v[32:35], v[12:15], v[232:239], v74
  s_waitcnt vmcnt(1)
  s_barrier
Cs1_lastr:
  ds_read_b128 v[8:11], v76 offset:8704
  ds_read_b128 v[0:3], v76 offset:9728
  ds_read_b128 v[16:19], v76 offset:10752
  ds_read_b128 v[4:7], v76 offset:11776
  ds_read_b128 v[12:15], v76 offset:12800
  s_waitcnt lgkmcnt(3)
  v_max3_u32 v72, v0, v1, v2
  s_waitcnt lgkmcnt(1)
  v_max3_u32 v72, v72, v3, v4
  v_max3_u32 v72, v72, v5, v6
  v_max3_u32 v72, v72, v7, v8
  v_max3_u32 v72, v72, v9, v10
  s_waitcnt lgkmcnt(0)
  v_max3_u32 v72, v72, v11, v12
  v_max3_u32 v72, v72, v13, v14
  v_max3_u32 v72, v72, v15, v16
  v_max3_u32 v72, v72, v17, v18
  v_max_u32 v72, v72, v19
  v_cmp_eq_u32 vcc, -1, v72
  s_cbranch_vccnz Cs1_lastp
Cs1_lastg:
  v_smfmac_f32_16x16x64_bf16 v[28:31], v[8:11], v[60:67], v74
  ds_read_b128 v[60:63], v75 offset:22528
  ds_read_b128 v[64:67], v75 offset:23552
  v_smfmac_f32_16x16x64_bf16 v[32:35], v[8:11], v[44:51], v74
  v_smfmac_f32_16x16x64_bf16 v[28:31], v[0:3], v[36:43], v74
  v_smfmac_f32_16x16x64_bf16 v[28:31], v[16:19], v[240:247], v74
  v_smfmac_f32_16x16x64_bf16 v[28:31], v[4:7], a[0:7], v74
  v_smfmac_f32_16x16x64_bf16 v[28:31], v[12:15], a[16:23], v74
  v_smfmac_f32_16x16x64_bf16 v[32:35], v[16:19], v[248:255], v74
  v_smfmac_f32_16x16x64_bf16 v[32:35], v[4:7], a[8:15], v74
  s_waitcnt lgkmcnt(0)
  v_smfmac_f32_16x16x64_bf16 v[32:35], v[12:15], a[24:31], v74
  v_smfmac_f32_16x16x64_bf16 v[32:35], v[0:3], v[60:67], v74
  v_smfmac_f32_16x16x64_bf16 v[20:23], v[8:11], a[96:103], v74
  v_smfmac_f32_16x16x64_bf16 v[20:23], v[0:3], a[112:119], v74
  v_add_f32 v28, v28, v30
  v_add_f32 v32, v32, v34
  v_cvt_pk_bf16_f32 v30, v28, v32
  v_smfmac_f32_16x16x64_bf16 v[20:23], v[16:19], a[128:135], v74
  ds_write_b32 v79, v30 offset:256
  v_add_f32 v29, v29, v31
  v_add_f32 v33, v33, v35
  v_cvt_pk_bf16_f32 v31, v29, v33
  v_smfmac_f32_16x16x64_bf16 v[20:23], v[4:7], a[144:151], v74
  ds_write_b32 v79, v31 offset:832
  v_smfmac_f32_16x16x64_bf16 v[20:23], v[12:15], a[160:167], v74
  v_smfmac_f32_16x16x64_bf16 v[24:27], v[8:11], a[104:111], v74
  v_smfmac_f32_16x16x64_bf16 v[24:27], v[0:3], a[120:127], v74
  v_smfmac_f32_16x16x64_bf16 v[24:27], v[16:19], a[136:143], v74
  s_waitcnt lgkmcnt(0)
  s_barrier
  ds_read_b64 v[52:53], v77 offset:264
  v_add_f32 v20, v20, v22
  v_smfmac_f32_16x16x64_bf16 v[24:27], v[4:7], a[152:159], v74
  v_add_f32 v21, v21, v23
  v_smfmac_f32_16x16x64_bf16 v[24:27], v[12:15], a[168:175], v74
  v_cvt_pk_bf16_f32 v54, v20, v21
  s_add_u32 s68, s68, 655360
  s_nop 3
  v_add_f32 v24, v24, v26
  v_add_f32 v25, v25, v27
  v_cvt_pk_bf16_f32 v55, v24, v25
  s_waitcnt lgkmcnt(0)
  buffer_store_dwordx4 v[52:55], v76, s[8:11], s68 offen sc1
  s_branch Cs1_done
Cs1_lastp:
  s_add_u32 s72, s72, 2
  s_cmp_ge_u32 s72, 131072
  s_cbranch_scc1 Cs1_lastg
  s_barrier
  buffer_load_dwordx4 v76, s[8:11], s85 offen offset:0 sc1 lds
  s_waitcnt vmcnt(0)
  s_barrier
  s_branch Cs1_lastr
Cs1_done:
  s_branch L_cexit
L_w6:
  v_mov_b64 v[20:21], 0
  v_mov_b64 v[22:23], 0
  v_mov_b64 v[24:25], 0
  v_mov_b64 v[26:27], 0
  v_mov_b64 v[28:29], 0
  v_mov_b64 v[30:31], 0
  v_mov_b64 v[32:33], 0
  v_mov_b64 v[34:35], 0
  s_mov_b32 s78, 0x3f803f80
  s_mov_b32 s79, s78
  s_mov_b32 s65, 360448
  s_mov_b32 m0, 15872
  s_lshl_b32 s71, s53, 2
  s_add_u32 s71, s71, 128
  s_movk_i32 s56, 0x1000
  v_lshlrev_b32 v73, 2, v76
  v_mov_b32 v72, 0
  s_mov_b64 s[16:17], s[8:9]
  s_mov_b32 s18, 268435456
  s_mov_b32 s19, 0x20000
  s_getpc_b64 s[20:21]
Cs2_pc:
  s_add_u32 s20, s20, (Cs2_last - Cs2_pc)
  s_addc_u32 s21, s21, 0
  v_mov_b32 v68, 14880
  buffer_load_dwordx4 v[52:55], v76, s[8:11], s59 offen offset:0 sc1
  buffer_load_dwordx4 v[56:59], v76, s[8:11], s59 offen offset:1024 sc1
  ds_read_b128 v[36:39], v76 offset:24576
  ds_read_b128 v[40:43], v76 offset:25600
  ds_read_b128 v[60:63], v76 offset:26624
  ds_read_b128 v[64:67], v76 offset:27648
  ds_read_b128 v[0:3], v76 offset:4608
  ds_read_b128 v[4:7], v76 offset:5632
  ds_read_b128 v[8:11], v76 offset:6656
  ds_read_b128 v[12:15], v76 offset:7680
  s_waitcnt lgkmcnt(0)
  s_cmp_eq_u32 s66, 1
  s_branch Cs2_top2
.p2align 6
Cs2_h2:
  s_cmp_eq_u32 s66, 62
  s_cselect_b64 s[16:17], s[20:21], s[16:17]
  s_cselect_b32 s18, (Cs2_done - Cs2_last), s18
  s_cselect_b32 s70, 0, s70
  s_cmp_eq_u32 s66, 63
  s_cselect_b32 s59, 268435456, s59
  s_cselect_b32 s58, 268435456, s58
  ds_read_b128 v[36:39], v76 offset:24576
  v_mov_b64 v[28:29], 0
  v_mov_b64 v[30:31], 0
  v_mov_b64 v[32:33], 0
  v_mov_b64 v[34:35], 0
  v_lshlrev_b32 v73, 2, v76
  ds_read_b128 v[40:43], v76 offset:25600
  v_mov_b64 v[20:21], 0
  v_mov_b64 v[22:23], 0
  v_mov_b64 v[24:25], 0
  v_mov_b64 v[26:27], 0
  v_mov_b32 v68, 14880
  buffer_load_dwordx4 v[52:55], v76, s[8:11], s59 offen offset:0 sc1
  buffer_load_dwordx4 v[56:59], v76, s[8:11], s59 offen offset:1024 sc1
  s_waitcnt vmcnt(0)
  s_mov_b64 vcc, -1
Cs2_h2r:
  s_mov_b64 exec, vcc
  buffer_load_dwordx4 v[12:15], v76, s[8:11], s65 offen offset:3072 sc1
  buffer_load_dwordx4 v[0:3], v76, s[8:11], s85 offen offset:0 sc1
  s_mov_b64 exec, -1
  s_add_u32 s67, s67, 1
  s_cmp_lt_u32 s67, 131072
  s_cselect_b32 s54, -2, -1
  s_waitcnt vmcnt(1)
  v_max3_u32 v72, v12, v13, v14
  s_waitcnt vmcnt(0)
  v_max3_u32 v72, v72, v15, v0
  v_max3_u32 v72, v72, v1, v2
  v_max_u32 v72, v72, v3
  v_cmp_lt_u32 vcc, s54, v72
  s_cbranch_vccnz Cs2_h2r
  ds_write_b128 v76, v[12:15] offset:7680
  ds_write_b128 v76, v[0:3] offset:12800
Cs2_h2w:
  s_cmp_eq_u32 s66, 63
  s_waitcnt lgkmcnt(0)
  s_barrier
  ds_read_b128 v[0:3], v76 offset:4608
Cs2_top2:
  v_smfmac_f32_16x16x64_bf16 v[20:23], v[12:15], v[128:135], v74
  s_cbranch_scc1 Cs2_last
  v_smfmac_f32_16x16x64_bf16 v[24:27], v[12:15], v[136:143], v74
  buffer_load_dwordx4 v[44:47], v76, s[8:11], s58 offen offset:0 sc1
  s_mov_b32 m0, 15872
  v_smfmac_f32_16x16x64_bf16 v[28:31], v[12:15], v[224:231], v74
  buffer_load_dwordx4 v[48:51], v76, s[8:11], s58 offen offset:1024 sc1
  v_smfmac_f32_16x16x64_bf16 v[32:35], v[12:15], v[232:239], v74
  ds_read_b128 v[4:7], v76 offset:5632
  s_waitcnt lgkmcnt(1)
  v_smfmac_f32_16x16x64_bf16 v[20:23], v[0:3], v[80:87], v74
  ds_read_b128 v[8:11], v76 offset:6656
  v_smfmac_f32_16x16x64_bf16 v[28:31], v[0:3], v[36:43], v74
  ds_read_b128 v[36:39], v76 offset:40960
  v_smfmac_f32_16x16x64_bf16 v[24:27], v[0:3], v[88:95], v74
  buffer_store_dwordx4 v[16:19], v76, s[8:11], s68 offen sc1
  ds_read_b128 v[40:43], v76 offset:41984
  v_smfmac_f32_16x16x64_bf16 v[32:35], v[0:3], v[60:67], v74
  ds_read_b128 v[60:63], v76 offset:43008
  s_waitcnt lgkmcnt(4)
  v_smfmac_f32_16x16x64_bf16 v[20:23], v[4:7], v[96:103], v74
  ds_read_b128 v[64:67], v76 offset:44032
  v_smfmac_f32_16x16x64_bf16 v[24:27], v[4:7], v[104:111], v74
  buffer_load_dword v73, s[16:19], s70 offen lds
  s_waitcnt vmcnt(4)
  s_waitcnt lgkmcnt(4)
  v_smfmac_f32_16x16x64_bf16 v[20:23], v[8:11], v[112:119], v74
  s_barrier
  s_waitcnt lgkmcnt(2)
  v_smfmac_f32_16x16x64_bf16 v[28:31], v[4:7], v[36:43], v74
  ds_read_b128 v[12:15], v76 offset:8704
  v_smfmac_f32_16x16x64_bf16 v[24:27], v[8:11], v[120:127], v74
  ds_read_b128 v[36:39], v76 offset:57344
  s_waitcnt lgkmcnt(2)
  v_smfmac_f32_16x16x64_bf16 v[32:35], v[4:7], v[60:67], v74
  ds_read_b128 v[40:43], v76 offset:58368
  v_smfmac_f32_16x16x64_bf16 v[28:31], v[8:11], v[208:215], v74
  ds_read_b128 v[60:63], v76 offset:59392
  v_smfmac_f32_16x16x64_bf16 v[32:35], v[8:11], v[216:223], v74
  ds_read_b128 v[64:67], v76 offset:60416
  s_waitcnt lgkmcnt(4)
  v_smfmac_f32_16x16x64_bf16 v[20:23], v[12:15], v[144:151], v74
  ds_read_b128 v[0:3], v76 offset:9728
  s_waitcnt lgkmcnt(3)
  v_smfmac_f32_16x16x64_bf16 v[28:31], v[12:15], v[36:43], v74
  s_barrier
  ds_read_b128 v[4:7], v76 offset:11776
  v_smfmac_f32_16x16x64_bf16 v[24:27], v[12:15], v[152:159], v74
  ds_read_b128 v[36:39], v75 offset:8192
  ds_read_b128 v[40:43], v75 offset:9216
  s_waitcnt lgkmcnt(4)
  v_smfmac_f32_16x16x64_bf16 v[32:35], v[12:15], v[60:67], v74
  ds_read_b128 v[16:19], v76 offset:10752
  s_waitcnt lgkmcnt(4)
  v_smfmac_f32_16x16x64_bf16 v[20:23], v[0:3], v[160:167], v74
  ds_read_b128 v[8:11], v76 offset:12800
  v_smfmac_f32_16x16x64_bf16 v[24:27], v[0:3], v[168:175], v74
  ds_read_b128 v[60:63], v75 offset:10240
  ds_read_b128 v[64:67], v75 offset:11264
  s_waitcnt lgkmcnt(6)
  v_smfmac_f32_16x16x64_bf16 v[20:23], v[4:7], v[176:183], v74
  s_waitcnt lgkmcnt(3)
  v_smfmac_f32_16x16x64_bf16 v[20:23], v[16:19], v[36:43], v74
  ds_read_b128 v[36:39], v75 offset:24576
  s_waitcnt lgkmcnt(3)
  v_smfmac_f32_16x16x64_bf16 v[20:23], v[8:11], v[192:199], v74
  ds_read_b128 v[40:43], v75 offset:25600
  s_waitcnt lgkmcnt(2)
  v_smfmac_f32_16x16x64_bf16 v[24:27], v[16:19], v[60:67], v74
  ds_read_b128 v[60:63], v75 offset:26624
  v_smfmac_f32_16x16x64_bf16 v[24:27], v[4:7], v[184:191], v74
  ds_read_b128 v[64:67], v75 offset:27648
  v_add_f32 v20, v20, v22
  v_smfmac_f32_16x16x64_bf16 v[24:27], v[8:11], v[200:207], v74
  v_add_f32 v21, v21, v23
  v_smfmac_f32_16x16x64_bf16 v[28:31], v[16:19], v[240:247], v74
  s_waitcnt lgkmcnt(2)
  v_mov_b64 v[70:71], s[78:79]
  v_smfmac_f32_16x16x64_bf16 v[28:31], v[0:3], v[36:43], v74
  ds_read_b128 v[36:39], v68
  v_add_f32 v24, v24, v26
  v_smfmac_f32_16x16x64_bf16 v[28:31], v[4:7], a[0:7], v74
  ds_read_b128 v[40:43], v68
  v_cvt_pk_bf16_f32 v22, v20, v24
  v_smfmac_f32_16x16x64_bf16 v[28:31], v[8:11], a[16:23], v74
  ds_write_b32 v79, v22 offset:0
  s_waitcnt lgkmcnt(3)
  v_add_f32 v25, v25, v27
  v_cvt_pk_bf16_f32 v23, v21, v25
  v_smfmac_f32_16x16x64_bf16 v[32:35], v[0:3], v[60:67], v74
  ds_write_b32 v79, v23 offset:576
  v_cmp_u_f32 vcc, v20, v21
  v_smfmac_f32_16x16x64_bf16 v[32:35], v[16:19], v[248:255], v74
  v_add_f32 v28, v28, v30
  v_smfmac_f32_16x16x64_bf16 v[32:35], v[4:7], a[8:15], v74
  v_add_f32 v29, v29, v31
  v_smfmac_f32_16x16x64_bf16 v[32:35], v[8:11], a[24:31], v74
  s_cbranch_vccnz Cs2_rec
Cs2_recok:
  s_waitcnt lgkmcnt(3)
  v_smfmac_f32_16x16x64_bf16 v[36:39], v[16:19], a[128:135], v74
  s_waitcnt lgkmcnt(0)
  s_barrier
  ds_read_b128 v[60:63], v77
  v_smfmac_f32_16x16x64_bf16 v[40:43], v[16:19], a[136:143], v74
  ds_read_b128 v[64:67], v77 offset:128
  v_add_f32 v32, v32, v34
  v_cvt_pk_bf16_f32 v30, v28, v32
  v_smfmac_f32_16x16x64_bf16 v[36:39], v[0:3], a[112:119], v74
  ds_write_b32 v79, v30 offset:256
  v_add_f32 v33, v33, v35
  v_cvt_pk_bf16_f32 v31, v29, v33
  v_smfmac_f32_16x16x64_bf16 v[40:43], v[0:3], a[120:127], v74
  ds_write_b32 v79, v31 offset:832
  v_xor_b32 v75, 0x8000, v75
  v_smfmac_f32_16x16x64_bf16 v[36:39], v[4:7], a[144:151], v74
  ds_read_b128 v[0:3], v76 offset:4608
  v_mov_b32 v29, 0
  v_smfmac_f32_16x16x64_bf16 v[40:43], v[4:7], a[152:159], v74
  s_waitcnt vmcnt(2) lgkmcnt(3)
  v_mov_b32 v30, 0
  v_mfma_f32_16x16x32_bf16 v[44:47], v[44:47], v[60:63], 0
  ds_read_b128 v[4:7], v76 offset:5632
  s_waitcnt lgkmcnt(2)
  v_mfma_f32_16x16x32_bf16 v[44:47], v[48:51], v[64:67], v[44:47]
  s_barrier
  v_smfmac_f32_16x16x64_bf16 v[36:39], v[8:11], a[160:167], v74
  ds_read_b128 v[20:23], v77 offset:256
  ds_read_b128 v[24:27], v77 offset:384
  v_smfmac_f32_16x16x64_bf16 v[40:43], v[8:11], a[168:175], v74
  ds_read_b128 v[8:11], v76 offset:6656
  v_add_f32_dpp v72, v46, v44 quad_perm:[2,3,0,1] row_mask:0xf bank_mask:0xf
  v_add_f32_dpp v73, v47, v45 quad_perm:[2,3,0,1] row_mask:0xf bank_mask:0xf
  v_smfmac_f32_16x16x64_bf16 v[36:39], v[12:15], a[96:103], v74
  s_waitcnt lgkmcnt(4)
  v_exp_f32_dpp v72, v72 quad_perm:[0,1,0,1] row_mask:0xf bank_mask:0xf
  v_smfmac_f32_16x16x64_bf16 v[40:43], v[12:15], a[104:111], v74
  ds_read_b128 v[12:15], v76 offset:7680
  v_exp_f32_dpp v73, v73 quad_perm:[0,1,0,1] row_mask:0xf bank_mask:0xf
  v_smfmac_f32_16x16x64_bf16 v[36:39], v[0:3], a[32:39], v74
  s_waitcnt lgkmcnt(2)
  v_cvt_pk_bf16_f32 v72, v72, v73
  v_mfma_f32_16x16x32_bf16 v[20:23], v[20:23], v[60:63], 0
  ds_write_b32 v78, v72 offset:520
  v_mov_b64 v[16:17], 0
  v_mfma_f32_16x16x32_bf16 v[20:23], v[24:27], v[64:67], v[20:23]
  ds_read_b128 v[44:47], v75 offset:24576
  v_mov_b64 v[18:19], 0
  v_smfmac_f32_16x16x64_bf16 v[40:43], v[0:3], a[40:47], v74
  ds_read_b128 v[48:51], v75 offset:25600
  v_mov_b64 v[68:69], s[78:79]
  v_smfmac_f32_16x16x64_bf16 v[36:39], v[4:7], a[48:55], v74
  s_waitcnt lgkmcnt(4)
  v_add_f32_dpp v24, v22, v20 quad_perm:[2,3,0,1] row_mask:0xf bank_mask:0xf
  v_add_f32_dpp v25, v23, v21 quad_perm:[2,3,0,1] row_mask:0xf bank_mask:0xf
  v_smfmac_f32_16x16x64_bf16 v[36:39], v[8:11], a[64:71], v74
  s_waitcnt lgkmcnt(2)
  s_barrier
  ds_read_b128 v[32:35], v78 offset:512
  v_smfmac_f32_16x16x64_bf16 v[36:39], v[12:15], a[80:87], v74
  ds_read_b128 v[60:63], v75 offset:26624
  v_mul_f32 v24, s69, v24
  v_smfmac_f32_16x16x64_bf16 v[40:43], v[4:7], a[56:63], v74
  ds_read_b128 v[64:67], v75 offset:27648
  v_mul_f32 v25, s69, v25
  v_smfmac_f32_16x16x64_bf16 v[40:43], v[8:11], a[72:79], v74
  v_exp_f32_dpp v24, v24 quad_perm:[0,1,0,1] row_mask:0xf bank_mask:0xf
  v_smfmac_f32_16x16x64_bf16 v[40:43], v[12:15], a[88:95], v74
  s_waitcnt lgkmcnt(2)
  v_exp_f32_dpp v25, v25 quad_perm:[0,1,0,1] row_mask:0xf bank_mask:0xf
  v_mfma_f32_16x16x32_bf16 v[8:11], v[32:35], v[68:71], 0
  v_add_f32 v36, v36, v38
  v_add_f32 v37, v37, v39
  v_mfma_f32_16x16x32_bf16 v[0:3], v[32:35], v[52:55], 0
  v_add_f32 v40, v40, v42
  v_add_f32 v41, v41, v43
  v_mfma_f32_16x16x32_bf16 v[4:7], v[32:35], v[56:59], 0
  v_cvt_pk_bf16_f32 v28, v24, v25
  v_cvt_pk_bf16_f32 v72, v36, v37
  v_cvt_pk_bf16_f32 v73, v40, v41
  v_mfma_f32_16x16x16_bf16 v[8:11], v[28:29], v[68:69], v[8:11]
  v_cvt_pk_bf16_f32 v31, v24, v25
  v_mov_b64 v[20:21], 0
  v_mfma_f32_16x16x16_bf16 v[0:3], v[28:29], v[72:73], v[0:3]
  ds_read_b128 v[68:71], v76 offset:13824
  v_mov_b64 v[22:23], 0
  v_mfma_f32_16x16x16_bf16 v[4:7], v[30:31], v[72:73], v[4:7]
  v_rcp_f32 v10, v8
  v_rcp_f32 v11, v9
  v_mul_f32 v0, v10, v0
  v_mul_f32 v1, v11, v1
  s_nop 0
  v_mul_f32 v4, v10, v4
  v_mul_f32 v5, v11, v5
  v_cvt_pk_bf16_f32 v2, v0, v4
  ds_write_b32 v79, v2 offset:8704
  v_cvt_pk_bf16_f32 v3, v1, v5
  ds_write_b32 v79, v3 offset:9280
  v_max3_f32 v8, v8, v9, v10
  v_max_f32 v8, v8, v11
  v_cmp_le_f32 vcc, 1317011456, v8
  v_mov_b64 v[24:25], 0
  v_mov_b64 v[26:27], 0
  s_cbranch_vccnz Cs2_mx
Cs2_mxok:
  s_waitcnt lgkmcnt(0)
  s_barrier
  ds_read_b128 v[0:3], v78 offset:8704
  ds_read_b128 v[4:7], v78 offset:8768
  ds_read_b128 v[8:11], v78 offset:8832
  ds_read_b128 v[12:15], v78 offset:8896
  s_waitcnt lgkmcnt(3)
  v_smfmac_f32_16x16x64_bf16 v[16:19], v[0:3], v[44:51], v74
  ds_read_b128 v[52:55], v75 offset:40960
  s_waitcnt lgkmcnt(3)
  v_smfmac_f32_16x16x64_bf16 v[16:19], v[4:7], v[60:67], v74
  ds_read_b128 v[56:59], v75 offset:41984
  s_waitcnt lgkmcnt(3)
  v_smfmac_f32_16x16x64_bf16 v[16:19], v[8:11], a[176:183], v74
  ds_read_b128 v[36:39], v75 offset:43008
  s_waitcnt lgkmcnt(3)
  v_smfmac_f32_16x16x64_bf16 v[16:19], v[12:15], a[184:191], v74
  ds_read_b128 v[40:43], v75 offset:44032
  ds_read_b128 v[44:47], v75 offset:57344
  v_smfmac_f32_16x16x64_bf16 v[20:23], v[0:3], a[192:199], v74
  ds_read_b128 v[48:51], v75 offset:58368
  ds_read_b128 v[60:63], v75 offset:59392
  v_smfmac_f32_16x16x64_bf16 v[20:23], v[4:7], a[200:207], v74
  ds_read_b128 v[64:67], v75 offset:60416
  s_waitcnt lgkmcnt(6)
  v_cvt_pk_bf16_f32 v16, v16, v17
  v_cvt_pk_bf16_f32 v17, v18, v19
  v_bfi_b32 v16, 1, s72, v16
  v_smfmac_f32_16x16x64_bf16 v[20:23], v[8:11], v[52:59], v74
  buffer_store_dwordx2 v[16:17], v68, s[8:11], s73 offen sc1
  s_waitcnt lgkmcnt(4)
  v_smfmac_f32_16x16x64_bf16 v[20:23], v[12:15], v[36:43], v74
  ds_read_b128 v[52:55], v75 offset:0
  v_mov_b64 v[32:33], 0
  v_smfmac_f32_16x16x64_bf16 v[24:27], v[0:3], a[208:215], v74
  ds_read_b128 v[56:59], v75 offset:1024
  v_mov_b64 v[34:35], 0
  v_smfmac_f32_16x16x64_bf16 v[24:27], v[4:7], a[216:223], v74
  ds_read_b128 v[36:39], v75 offset:2048
  s_waitcnt lgkmcnt(5)
  v_cvt_pk_bf16_f32 v20, v20, v21
  v_cvt_pk_bf16_f32 v21, v22, v23
  v_bfi_b32 v20, 1, s72, v20
  v_smfmac_f32_16x16x64_bf16 v[24:27], v[8:11], v[44:51], v74
  buffer_store_dwordx2 v[20:21], v68, s[8:11], s74 offen sc1
  s_waitcnt lgkmcnt(3)
  v_smfmac_f32_16x16x64_bf16 v[24:27], v[12:15], v[60:67], v74
  ds_read_b128 v[40:43], v75 offset:3072
  v_mov_b64 v[28:29], 0
  v_smfmac_f32_16x16x64_bf16 v[32:35], v[0:3], a[224:231], v74
  ds_read_b128 v[44:47], v75 offset:4096
  ds_read_b128 v[48:51], v75 offset:5120
  v_smfmac_f32_16x16x64_bf16 v[32:35], v[4:7], a[232:239], v74
  ds_read_b128 v[60:63], v75 offset:6144
  v_cvt_pk_bf16_f32 v24, v24, v25
  v_cvt_pk_bf16_f32 v25, v26, v27
  v_bfi_b32 v24, 1, s72, v24
  v_smfmac_f32_16x16x64_bf16 v[32:35], v[8:11], a[240:247], v74
  buffer_store_dwordx2 v[24:25], v68, s[8:11], s75 offen sc1
  v_mov_b64 v[30:31], 0
  v_smfmac_f32_16x16x64_bf16 v[32:35], v[12:15], a[248:255], v74
  ds_read_b128 v[64:67], v75 offset:7168
  s_waitcnt lgkmcnt(6)
  v_smfmac_f32_16x16x64_bf16 v[28:31], v[0:3], v[52:59], v74
  s_waitcnt lgkmcnt(4)
  v_smfmac_f32_16x16x64_bf16 v[28:31], v[4:7], v[36:43], v74
  s_waitcnt lgkmcnt(2)
  v_cvt_pk_bf16_f32 v32, v32, v33
  v_cvt_pk_bf16_f32 v33, v34, v35
  v_bfi_b32 v32, 1, s72, v32
  v_smfmac_f32_16x16x64_bf16 v[28:31], v[8:11], v[44:51], v74
  buffer_store_dwordx2 v[32:33], v68, s[8:11], s76 offen sc1
  s_waitcnt lgkmcnt(0)
  v_smfmac_f32_16x16x64_bf16 v[28:31], v[12:15], v[60:67], v74
  v_mov_b64 v[18:19], v[72:73]
  s_nop 4
  v_cvt_pk_bf16_f32 v28, v28, v29
  v_cvt_pk_bf16_f32 v29, v30, v31
  v_bfi_b32 v28, 1, s72, v28
  buffer_store_dwordx2 v[28:29], v68, s[8:11], s77 offen sc1
  ds_read_b128 v[0:3], v76 offset:14848
  s_waitcnt lgkmcnt(0)
  ds_read_b64 v[16:17], v77 offset:384
  s_waitcnt lgkmcnt(0)
  ds_read_b128 v[64:67], v76 offset:27648
  s_waitcnt lgkmcnt(0)
  ds_read_b128 v[60:63], v76 offset:26624
  s_waitcnt lgkmcnt(0)
  s_waitcnt vmcnt(0)
  buffer_load_dwordx4 v[52:55], v76, s[8:11], s60 offen offset:0 sc1
  buffer_load_dwordx4 v[56:59], v76, s[8:11], s60 offen offset:1024 sc1
  s_add_u32 s66, s66, 1
  s_xor_b32 s64, s64, 16384
  s_xor_b32 s65, s65, 16384
  s_add_u32 s58, s58, 655360
  s_add_u32 s59, s59, 655360
  s_add_u32 s70, s70, 655360
  s_add_u32 s68, s68, 655360
  s_mov_b32 m0, 12800
  s_add_u32 s85, s65, 8192
  v_xor_b32 v75, 0x8000, v75
  s_waitcnt lgkmcnt(0)
  s_waitcnt vmcnt(1)
  v_mfma_f32_16x16x32_bf16 v[4:7], v[0:3], v[52:55], 0
  v_bitop3_b32 v72, v52, v54, s72 bitop3:0x7e
  s_waitcnt vmcnt(0)
  v_mfma_f32_16x16x32_bf16 v[4:7], v[0:3], v[56:59], v[4:7]
  v_bitop3_b32 v73, v56, v58, s72 bitop3:0x7e
  v_bitop3_b32 v72, v72, v73, 1 bitop3:0xa8
  v_cmp_ne_u32 vcc, 0, v72
  s_cbranch_vccnz Cs2_h1r
  s_nop 2
  v_add_f32_dpp v4, v4, v4 row_ror:4 row_mask:0xf bank_mask:0xf
  v_add_f32_dpp v5, v5, v5 row_ror:4 row_mask:0xf bank_mask:0xf
  s_nop 0
  v_add_f32_dpp v4, v4, v4 row_ror:8 row_mask:0xf bank_mask:0xf
  v_add_f32_dpp v5, v5, v5 row_ror:8 row_mask:0xf bank_mask:0xf
  v_cvt_pk_bf16_f32 v4, v4, v5
  buffer_store_dword v4, v69, s[8:11], s62 offen sc1
  s_xor_b32 s62, s62, 16384
  buffer_store_dword v71, v69, s[8:11], s62 offen sc1
  s_xor_b32 s72, s72, 1
  s_branch Cs2_h2
Cs2_h1r:
  s_mov_b64 exec, vcc
  buffer_load_dwordx4 v[52:55], v76, s[8:11], s60 offen offset:0 sc1
  buffer_load_dwordx4 v[56:59], v76, s[8:11], s60 offen offset:1024 sc1
  s_mov_b64 exec, -1
  s_add_u32 s67, s67, 1
  s_waitcnt vmcnt(1)
  v_mfma_f32_16x16x32_bf16 v[4:7], v[0:3], v[52:55], 0
  v_bitop3_b32 v72, v52, v54, s72 bitop3:0x7e
  s_waitcnt vmcnt(0)
  v_mfma_f32_16x16x32_bf16 v[4:7], v[0:3], v[56:59], v[4:7]
  v_bitop3_b32 v73, v56, v58, s72 bitop3:0x7e
  v_bitop3_b32 v72, v72, v73, 1 bitop3:0xa8
  v_cmp_ne_u32 vcc, 0, v72
  s_cbranch_vccz Cs2_h1p
Cs2_h1s:
  s_mov_b64 exec, vcc
  buffer_load_dwordx4 v[52:55], v76, s[8:11], s60 offen offset:0 sc1
  buffer_load_dwordx4 v[56:59], v76, s[8:11], s60 offen offset:1024 sc1
  s_mov_b64 exec, -1
  s_add_u32 s67, s67, 1
  s_waitcnt vmcnt(1)
  v_mfma_f32_16x16x32_bf16 v[4:7], v[0:3], v[52:55], 0
  v_bitop3_b32 v72, v52, v54, s72 bitop3:0x7e
  s_waitcnt vmcnt(0)
  v_mfma_f32_16x16x32_bf16 v[4:7], v[0:3], v[56:59], v[4:7]
  v_bitop3_b32 v73, v56, v58, s72 bitop3:0x7e
  v_bitop3_b32 v72, v72, v73, 1 bitop3:0xa8
  v_cmp_ne_u32 vcc, 0, v72
  s_cbranch_vccz Cs2_h1p
  s_cmp_lt_u32 s67, 131072
  s_cbranch_scc1 Cs2_h1s
Cs2_h1p:
  s_nop 2
  v_add_f32_dpp v4, v4, v4 row_ror:4 row_mask:0xf bank_mask:0xf
  v_add_f32_dpp v5, v5, v5 row_ror:4 row_mask:0xf bank_mask:0xf
  s_nop 0
  v_add_f32_dpp v4, v4, v4 row_ror:8 row_mask:0xf bank_mask:0xf
  v_add_f32_dpp v5, v5, v5 row_ror:8 row_mask:0xf bank_mask:0xf
  v_cvt_pk_bf16_f32 v4, v4, v5
  buffer_store_dword v4, v69, s[8:11], s62 offen sc1
  s_xor_b32 s62, s62, 16384
  buffer_store_dword v71, v69, s[8:11], s62 offen sc1
  s_xor_b32 s72, s72, 1
  s_branch Cs2_h2
Cs2_rec:
  s_nop 7
  s_waitcnt vmcnt(0) lgkmcnt(0)
  v_max3_u32 v72, v0, v1, v2
  v_max3_u32 v72, v72, v3, v4
  v_max3_u32 v72, v72, v5, v6
  v_max3_u32 v72, v72, v7, v8
  v_max3_u32 v72, v72, v9, v10
  v_max3_u32 v72, v72, v11, v12
  v_max3_u32 v72, v72, v13, v14
  v_max3_u32 v72, v72, v15, v16
  v_max3_u32 v72, v72, v17, v18
  v_max_u32 v72, v72, v19
  v_cmp_eq_u32 vcc, -1, v72
  s_cbranch_vccz Cs2_recok
  s_barrier
Cs2_recp:
  buffer_load_dwordx4 v[0:3], v76, s[8:11], s64 offen offset:0 sc1
  buffer_load_dwordx4 v[4:7], v76, s[8:11], s64 offen offset:1024 sc1
  s_add_u32 s67, s67, 1
  s_cmp_lt_u32 s67, 131072
  s_cselect_b32 s54, -2, -1
  s_waitcnt vmcnt(1)
  v_max3_u32 v72, v0, v1, v2
  s_waitcnt vmcnt(0)
  v_max3_u32 v72, v72, v3, v4
  v_max3_u32 v72, v72, v5, v6
  v_max_u32 v72, v72, v7
  v_cmp_lt_u32 vcc, s54, v72
  s_cbranch_vccnz Cs2_recp
  ds_write_b128 v76, v[0:3] offset:8704
  ds_write_b128 v76, v[4:7] offset:9728
  v_mov_b64 v[20:21], 0
  v_mov_b64 v[22:23], 0
  v_mov_b64 v[24:25], 0
  v_mov_b64 v[26:27], 0
  v_mov_b64 v[28:29], 0
  v_mov_b64 v[30:31], 0
  v_mov_b64 v[32:33], 0
  v_mov_b64 v[34:35], 0
  s_waitcnt lgkmcnt(0)
  s_barrier
  ds_read_b128 v[0:3], v76 offset:4608
  s_waitcnt lgkmcnt(0)
  v_smfmac_f32_16x16x64_bf16 v[20:23], v[0:3], v[80:87], v74
  v_smfmac_f32_16x16x64_bf16 v[24:27], v[0:3], v[88:95], v74
  ds_read_b128 v[60:63], v76 offset:24576
  ds_read_b128 v[64:67], v76 offset:25600
  s_waitcnt lgkmcnt(0)
  v_smfmac_f32_16x16x64_bf16 v[28:31], v[0:3], v[60:67], v74
  ds_read_b128 v[60:63], v76 offset:26624
  ds_read_b128 v[64:67], v76 offset:27648
  s_waitcnt lgkmcnt(0)
  v_smfmac_f32_16x16x64_bf16 v[32:35], v[0:3], v[60:67], v74
  ds_read_b128 v[4:7], v76 offset:5632
  s_waitcnt lgkmcnt(0)
  v_smfmac_f32_16x16x64_bf16 v[20:23], v[4:7], v[96:103], v74
  v_smfmac_f32_16x16x64_bf16 v[24:27], v[4:7], v[104:111], v74
  ds_read_b128 v[60:63], v76 offset:40960
  ds_read_b128 v[64:67], v76 offset:41984
  s_waitcnt lgkmcnt(0)
  v_smfmac_f32_16x16x64_bf16 v[28:31], v[4:7], v[60:67], v74
  ds_read_b128 v[60:63], v76 offset:43008
  ds_read_b128 v[64:67], v76 offset:44032
  s_waitcnt lgkmcnt(0)
  v_smfmac_f32_16x16x64_bf16 v[32:35], v[4:7], v[60:67], v74
  ds_read_b128 v[8:11], v76 offset:6656
  s_waitcnt lgkmcnt(0)
  v_smfmac_f32_16x16x64_bf16 v[20:23], v[8:11], v[112:119], v74
  v_smfmac_f32_16x16x64_bf16 v[24:27], v[8:11], v[120:127], v74
  v_smfmac_f32_16x16x64_bf16 v[28:31], v[8:11], v[208:215], v74
  v_smfmac_f32_16x16x64_bf16 v[32:35], v[8:11], v[216:223], v74
  ds_read_b128 v[12:15], v76 offset:7680
  s_waitcnt lgkmcnt(0)
  v_smfmac_f32_16x16x64_bf16 v[20:23], v[12:15], v[128:135], v74
  v_smfmac_f32_16x16x64_bf16 v[24:27], v[12:15], v[136:143], v74
  v_smfmac_f32_16x16x64_bf16 v[28:31], v[12:15], v[224:231], v74
  v_smfmac_f32_16x16x64_bf16 v[32:35], v[12:15], v[232:239], v74
  ds_read_b128 v[12:15], v76 offset:8704
  s_waitcnt lgkmcnt(0)
  v_smfmac_f32_16x16x64_bf16 v[20:23], v[12:15], v[144:151], v74
  v_smfmac_f32_16x16x64_bf16 v[24:27], v[12:15], v[152:159], v74
  ds_read_b128 v[60:63], v76 offset:57344
  ds_read_b128 v[64:67], v76 offset:58368
  s_waitcnt lgkmcnt(0)
  v_smfmac_f32_16x16x64_bf16 v[28:31], v[12:15], v[60:67], v74
  ds_read_b128 v[60:63], v76 offset:59392
  ds_read_b128 v[64:67], v76 offset:60416
  s_waitcnt lgkmcnt(0)
  v_smfmac_f32_16x16x64_bf16 v[32:35], v[12:15], v[60:67], v74
  ds_read_b128 v[0:3], v76 offset:9728
  s_waitcnt lgkmcnt(0)
  v_smfmac_f32_16x16x64_bf16 v[20:23], v[0:3], v[160:167], v74
  v_smfmac_f32_16x16x64_bf16 v[24:27], v[0:3], v[168:175], v74
  ds_read_b128 v[60:63], v75 offset:24576
  ds_read_b128 v[64:67], v75 offset:25600
  s_waitcnt lgkmcnt(0)
  v_smfmac_f32_16x16x64_bf16 v[28:31], v[0:3], v[60:67], v74
  ds_read_b128 v[60:63], v75 offset:26624
  ds_read_b128 v[64:67], v75 offset:27648
  s_waitcnt lgkmcnt(0)
  v_smfmac_f32_16x16x64_bf16 v[32:35], v[0:3], v[60:67], v74
  ds_read_b128 v[16:19], v76 offset:10752
  ds_read_b128 v[60:63], v75 offset:8192
  ds_read_b128 v[64:67], v75 offset:9216
  s_waitcnt lgkmcnt(0)
  v_smfmac_f32_16x16x64_bf16 v[20:23], v[16:19], v[60:67], v74
  ds_read_b128 v[60:63], v75 offset:10240
  ds_read_b128 v[64:67], v75 offset:11264
  s_waitcnt lgkmcnt(0)
  v_smfmac_f32_16x16x64_bf16 v[24:27], v[16:19], v[60:67], v74
  v_smfmac_f32_16x16x64_bf16 v[28:31], v[16:19], v[240:247], v74
  v_smfmac_f32_16x16x64_bf16 v[32:35], v[16:19], v[248:255], v74
  ds_read_b128 v[4:7], v76 offset:11776
  s_waitcnt lgkmcnt(0)
  v_smfmac_f32_16x16x64_bf16 v[20:23], v[4:7], v[176:183], v74
  v_smfmac_f32_16x16x64_bf16 v[24:27], v[4:7], v[184:191], v74
  v_smfmac_f32_16x16x64_bf16 v[28:31], v[4:7], a[0:7], v74
  v_smfmac_f32_16x16x64_bf16 v[32:35], v[4:7], a[8:15], v74
  ds_read_b128 v[8:11], v76 offset:12800
  s_waitcnt lgkmcnt(0)
  v_smfmac_f32_16x16x64_bf16 v[20:23], v[8:11], v[192:199], v74
  v_smfmac_f32_16x16x64_bf16 v[24:27], v[8:11], v[200:207], v74
  v_smfmac_f32_16x16x64_bf16 v[28:31], v[8:11], a[16:23], v74
  v_smfmac_f32_16x16x64_bf16 v[32:35], v[8:11], a[24:31], v74
  v_add_f32 v20, v20, v22
  v_add_f32 v21, v21, v23
  v_add_f32 v24, v24, v26
  v_cvt_pk_bf16_f32 v22, v20, v24
  ds_write_b32 v79, v22 offset:0
  v_add_f32 v25, v25, v27
  v_cvt_pk_bf16_f32 v23, v21, v25
  ds_write_b32 v79, v23 offset:576
  v_add_f32 v28, v28, v30
  v_add_f32 v29, v29, v31
  s_waitcnt lgkmcnt(0)
  s_nop 1
  s_branch Cs2_recok
Cs2_mx:
  s_waitcnt lgkmcnt(0)
  s_barrier
  buffer_load_dwordx4 v[0:3], v76, s[8:11], s58 offen offset:0 sc1
  ds_read_b128 v[20:23], v77 offset:0
  ds_read_b128 v[28:31], v77 offset:256
  buffer_load_dwordx4 v[4:7], v76, s[8:11], s58 offen offset:1024 sc1
  ds_read_b128 v[24:27], v77 offset:128
  ds_read_b128 v[32:35], v77 offset:384
  s_waitcnt vmcnt(1) lgkmcnt(3)
  v_mfma_f32_16x16x32_bf16 v[8:11], v[0:3], v[20:23], 0
  s_waitcnt vmcnt(0) lgkmcnt(1)
  v_mfma_f32_16x16x32_bf16 v[8:11], v[4:7], v[24:27], v[8:11]
  v_mfma_f32_16x16x32_bf16 v[12:15], v[28:31], v[20:23], 0
  s_waitcnt lgkmcnt(0)
  v_mfma_f32_16x16x32_bf16 v[12:15], v[32:35], v[24:27], v[12:15]
  v_add_f32_dpp v8, v10, v8 quad_perm:[2,3,0,1] row_mask:0xf bank_mask:0xf
  v_add_f32_dpp v9, v11, v9 quad_perm:[2,3,0,1] row_mask:0xf bank_mask:0xf
  s_nop 0
  v_mov_b32_dpp v8, v8 quad_perm:[0,1,0,1] row_mask:0xf bank_mask:0xf
  v_mov_b32_dpp v9, v9 quad_perm:[0,1,0,1] row_mask:0xf bank_mask:0xf
  s_nop 1
  v_add_f32_dpp v12, v14, v12 quad_perm:[2,3,0,1] row_mask:0xf bank_mask:0xf
  v_add_f32_dpp v13, v15, v13 quad_perm:[2,3,0,1] row_mask:0xf bank_mask:0xf
  s_nop 0
  v_mov_b32_dpp v12, v12 quad_perm:[0,1,0,1] row_mask:0xf bank_mask:0xf
  v_mov_b32_dpp v13, v13 quad_perm:[0,1,0,1] row_mask:0xf bank_mask:0xf
  v_mul_f32 v12, s69, v12
  ds_write_b32 v78, v8 offset:8712
  v_mul_f32 v13, s69, v13
  ds_write_b32 v78, v9 offset:8776
  s_waitcnt lgkmcnt(0)
  s_barrier
  ds_read_b128 v[36:39], v78 offset:8704
  ds_read_b128 v[40:43], v78 offset:8768
  s_waitcnt lgkmcnt(0)
  s_barrier
  v_max_f32 v16, v36, v37
  v_max3_f32 v16, v16, v38, v39
  v_max3_f32 v16, v16, v40, v41
  v_max3_f32 v16, v16, v42, v43
  v_max3_f32 v16, v16, v12, v13
  v_mov_b32 v17, v16
  s_nop 1
  v_permlane16_swap_b32 v16, v17
  v_max_f32 v16, v16, v17
  v_mov_b32 v17, v16
  s_nop 1
  v_permlane32_swap_b32 v16, v17
  v_max_f32 v16, v16, v17
  v_sub_f32 v36, v36, v16
  v_sub_f32 v37, v37, v16
  v_sub_f32 v38, v38, v16
  v_sub_f32 v39, v39, v16
  v_sub_f32 v40, v40, v16
  v_sub_f32 v41, v41, v16
  v_sub_f32 v42, v42, v16
  v_sub_f32 v43, v43, v16
  v_sub_f32 v12, v12, v16
  v_sub_f32 v13, v13, v16
  v_exp_f32 v36, v36
  v_exp_f32 v37, v37
  v_exp_f32 v38, v38
  v_exp_f32 v39, v39
  v_exp_f32 v40, v40
  v_exp_f32 v41, v41
  v_exp_f32 v42, v42
  v_exp_f32 v43, v43
  v_exp_f32 v12, v12
  v_exp_f32 v13, v13
  v_cvt_pk_bf16_f32 v32, v36, v40
  v_cvt_pk_bf16_f32 v33, v37, v41
  v_cvt_pk_bf16_f32 v34, v38, v42
  v_cvt_pk_bf16_f32 v35, v39, v43
  v_cvt_pk_bf16_f32 v28, v12, v13
  v_cvt_pk_bf16_f32 v31, v12, v13
  v_mov_b32 v29, 0
  v_mov_b32 v30, 0
  v_mov_b32 v68, 0x3f803f80
  v_mov_b32 v69, 0x3f803f80
  v_mov_b32 v70, 0x3f803f80
  v_mov_b32 v71, 0x3f803f80
  s_nop 1
  v_mfma_f32_16x16x32_bf16 v[8:11], v[32:35], v[68:71], 0
  v_mfma_f32_16x16x32_bf16 v[0:3], v[32:35], v[52:55], 0
  v_mfma_f32_16x16x32_bf16 v[4:7], v[32:35], v[56:59], 0
  v_mfma_f32_16x16x16_bf16 v[8:11], v[28:29], v[68:69], v[8:11]
  v_mfma_f32_16x16x16_bf16 v[0:3], v[28:29], v[72:73], v[0:3]
  v_mfma_f32_16x16x16_bf16 v[4:7], v[30:31], v[72:73], v[4:7]
  ds_read_b128 v[68:71], v76 offset:13824
  v_rcp_f32 v10, v8
  v_rcp_f32 v11, v9
  v_mul_f32 v0, v10, v0
  v_mul_f32 v1, v11, v1
  s_nop 0
  v_mul_f32 v4, v10, v4
  v_mul_f32 v5, v11, v5
  v_cvt_pk_bf16_f32 v2, v0, v4
  ds_write_b32 v79, v2 offset:8704
  v_cvt_pk_bf16_f32 v3, v1, v5
  ds_write_b32 v79, v3 offset:9280
  v_mov_b64 v[16:17], 0
  v_mov_b64 v[18:19], 0
  v_mov_b64 v[20:21], 0
  v_mov_b64 v[22:23], 0
  v_mov_b64 v[24:25], 0
  v_mov_b64 v[26:27], 0
  s_branch Cs2_mxok
Cs2_last:
  ds_read_b128 v[4:7], v76 offset:5632
  ds_read_b128 v[8:11], v76 offset:6656
  ds_read_b128 v[44:47], v76 offset:40960
  ds_read_b128 v[48:51], v76 offset:41984
  s_nop 5
  v_mov_b64 v[20:21], 0
  v_mov_b64 v[22:23], 0
  v_mov_b64 v[24:25], 0
  v_mov_b64 v[26:27], 0
  s_waitcnt lgkmcnt(4)
  v_smfmac_f32_16x16x64_bf16 v[28:31], v[0:3], v[36:43], v74
  ds_read_b128 v[36:39], v76 offset:43008
  ds_read_b128 v[40:43], v76 offset:44032
  v_smfmac_f32_16x16x64_bf16 v[32:35], v[0:3], v[60:67], v74
  s_waitcnt lgkmcnt(5)
  v_smfmac_f32_16x16x64_bf16 v[20:23], v[0:3], a[32:39], v74
  ds_read_b128 v[60:63], v76 offset:57344
  ds_read_b128 v[64:67], v76 offset:58368
  v_smfmac_f32_16x16x64_bf16 v[24:27], v[0:3], a[40:47], v74
  s_waitcnt lgkmcnt(4)
  v_smfmac_f32_16x16x64_bf16 v[20:23], v[4:7], a[48:55], v74
  buffer_store_dwordx4 v[16:19], v76, s[8:11], s68 offen sc1
  v_smfmac_f32_16x16x64_bf16 v[24:27], v[4:7], a[56:63], v74
  v_smfmac_f32_16x16x64_bf16 v[28:31], v[4:7], v[44:51], v74
  s_waitcnt lgkmcnt(2)
  v_smfmac_f32_16x16x64_bf16 v[20:23], v[8:11], a[64:71], v74
  ds_read_b128 v[44:47], v76 offset:59392
  ds_read_b128 v[48:51], v76 offset:60416
  v_smfmac_f32_16x16x64_bf16 v[24:27], v[8:11], a[72:79], v74
  v_smfmac_f32_16x16x64_bf16 v[32:35], v[4:7], v[36:43], v74
  v_smfmac_f32_16x16x64_bf16 v[28:31], v[8:11], v[208:215], v74
  ds_read_b128 v[36:39], v75 offset:24576
  ds_read_b128 v[40:43], v75 offset:25600
  v_smfmac_f32_16x16x64_bf16 v[32:35], v[8:11], v[216:223], v74
  v_smfmac_f32_16x16x64_bf16 v[20:23], v[12:15], a[80:87], v74
  v_smfmac_f32_16x16x64_bf16 v[24:27], v[12:15], a[88:95], v74
  v_smfmac_f32_16x16x64_bf16 v[28:31], v[12:15], v[224:231], v74
  v_smfmac_f32_16x16x64_bf16 v[32:35], v[12:15], v[232:239], v74
  s_waitcnt vmcnt(1)
  s_barrier
Cs2_lastr:
  ds_read_b128 v[12:15], v76 offset:8704
  ds_read_b128 v[0:3], v76 offset:9728
  ds_read_b128 v[16:19], v76 offset:10752
  ds_read_b128 v[4:7], v76 offset:11776
  ds_read_b128 v[8:11], v76 offset:12800
  s_waitcnt lgkmcnt(3)
  v_max3_u32 v72, v0, v1, v2
  s_waitcnt lgkmcnt(1)
  v_max3_u32 v72, v72, v3, v4
  v_max3_u32 v72, v72, v5, v6
  s_waitcnt lgkmcnt(0)
  v_max3_u32 v72, v72, v7, v8
  v_max3_u32 v72, v72, v9, v10
  v_max3_u32 v72, v72, v11, v12
  v_max3_u32 v72, v72, v13, v14
  v_max3_u32 v72, v72, v15, v16
  v_max3_u32 v72, v72, v17, v18
  v_max_u32 v72, v72, v19
  v_cmp_eq_u32 vcc, -1, v72
  s_cbranch_vccnz Cs2_lastp
Cs2_lastg:
  v_smfmac_f32_16x16x64_bf16 v[28:31], v[12:15], v[60:67], v74
  ds_read_b128 v[60:63], v75 offset:26624
  ds_read_b128 v[64:67], v75 offset:27648
  v_smfmac_f32_16x16x64_bf16 v[32:35], v[12:15], v[44:51], v74
  v_smfmac_f32_16x16x64_bf16 v[28:31], v[0:3], v[36:43], v74
  v_smfmac_f32_16x16x64_bf16 v[28:31], v[16:19], v[240:247], v74
  v_smfmac_f32_16x16x64_bf16 v[28:31], v[4:7], a[0:7], v74
  v_smfmac_f32_16x16x64_bf16 v[28:31], v[8:11], a[16:23], v74
  v_smfmac_f32_16x16x64_bf16 v[32:35], v[16:19], v[248:255], v74
  v_smfmac_f32_16x16x64_bf16 v[32:35], v[4:7], a[8:15], v74
  s_waitcnt lgkmcnt(0)
  v_smfmac_f32_16x16x64_bf16 v[32:35], v[8:11], a[24:31], v74
  v_smfmac_f32_16x16x64_bf16 v[32:35], v[0:3], v[60:67], v74
  v_smfmac_f32_16x16x64_bf16 v[20:23], v[12:15], a[96:103], v74
  v_smfmac_f32_16x16x64_bf16 v[20:23], v[0:3], a[112:119], v74
  v_add_f32 v28, v28, v30
  v_add_f32 v32, v32, v34
  v_cvt_pk_bf16_f32 v30, v28, v32
  v_smfmac_f32_16x16x64_bf16 v[20:23], v[16:19], a[128:135], v74
  ds_write_b32 v79, v30 offset:256
  v_add_f32 v29, v29, v31
  v_add_f32 v33, v33, v35
  v_cvt_pk_bf16_f32 v31, v29, v33
  v_smfmac_f32_16x16x64_bf16 v[20:23], v[4:7], a[144:151], v74
  ds_write_b32 v79, v31 offset:832
  v_smfmac_f32_16x16x64_bf16 v[20:23], v[8:11], a[160:167], v74
  v_smfmac_f32_16x16x64_bf16 v[24:27], v[12:15], a[104:111], v74
  v_smfmac_f32_16x16x64_bf16 v[24:27], v[0:3], a[120:127], v74
  v_smfmac_f32_16x16x64_bf16 v[24:27], v[16:19], a[136:143], v74
  s_waitcnt lgkmcnt(0)
  s_barrier
  ds_read_b64 v[52:53], v77 offset:384
  v_add_f32 v20, v20, v22
  v_smfmac_f32_16x16x64_bf16 v[24:27], v[4:7], a[152:159], v74
  v_add_f32 v21, v21, v23
  v_smfmac_f32_16x16x64_bf16 v[24:27], v[8:11], a[168:175], v74
  v_cvt_pk_bf16_f32 v54, v20, v21
  s_add_u32 s68, s68, 655360
  s_nop 3
  v_add_f32 v24, v24, v26
  v_add_f32 v25, v25, v27
  v_cvt_pk_bf16_f32 v55, v24, v25
  s_waitcnt lgkmcnt(0)
  buffer_store_dwordx4 v[52:55], v76, s[8:11], s68 offen sc1
  s_branch Cs2_done
Cs2_lastp:
  s_add_u32 s72, s72, 2
  s_cmp_ge_u32 s72, 131072
  s_cbranch_scc1 Cs2_lastg
  s_barrier
  buffer_load_dwordx4 v76, s[8:11], s85 offen offset:0 sc1 lds
  s_waitcnt vmcnt(0)
  s_barrier
  s_branch Cs2_lastr
Cs2_done:
  s_branch L_cexit
L_w7:
  v_mov_b64 v[20:21], 0
  v_mov_b64 v[22:23], 0
  v_mov_b64 v[24:25], 0
  v_mov_b64 v[26:27], 0
  v_mov_b64 v[28:29], 0
  v_mov_b64 v[30:31], 0
  v_mov_b64 v[32:33], 0
  v_mov_b64 v[34:35], 0
  s_mov_b32 s78, 0x3f803f80
  s_mov_b32 s79, s78
  s_mov_b32 s65, 360448
  s_mov_b32 m0, 15872
  s_lshl_b32 s71, s53, 2
  s_add_u32 s71, s71, 128
  s_movk_i32 s56, 0x1000
  v_lshlrev_b32 v73, 2, v76
  v_mov_b32 v72, 0
  s_mov_b64 s[16:17], s[8:9]
  s_mov_b32 s18, 268435456
  s_mov_b32 s19, 0x20000
  s_getpc_b64 s[20:21]
Cs3_pc:
  s_add_u32 s20, s20, (Cs3_last - Cs3_pc)
  s_addc_u32 s21, s21, 0
  v_mov_b32 v68, 14880
  buffer_load_dwordx4 v[52:55], v76, s[8:11], s59 offen offset:0 sc1
  buffer_load_dwordx4 v[56:59], v76, s[8:11], s59 offen offset:1024 sc1
  ds_read_b128 v[36:39], v76 offset:45056
  ds_read_b128 v[40:43], v76 offset:46080
  ds_read_b128 v[60:63], v76 offset:47104
  ds_read_b128 v[64:67], v76 offset:48128
  ds_read_b128 v[0:3], v76 offset:4608
  ds_read_b128 v[4:7], v76 offset:5632
  ds_read_b128 v[8:11], v76 offset:6656
  ds_read_b128 v[12:15], v76 offset:7680
  s_waitcnt lgkmcnt(0)
  s_cmp_eq_u32 s66, 1
  s_branch Cs3_top2
.p2align 6
Cs3_h2:
  v_lshlrev_b32 v73, 2, v76
  ds_read_b128 v[36:39], v76 offset:45056
  ds_read_b128 v[40:43], v76 offset:46080
  buffer_load_dwordx4 v[52:55], v76, s[8:11], s59 offen offset:0 sc1
  buffer_load_dwordx4 v[56:59], v76, s[8:11], s59 offen offset:1024 sc1
  s_waitcnt vmcnt(0)
  s_mov_b64 vcc, -1
Cs3_h2r:
  s_mov_b64 exec, vcc
  buffer_load_dwordx4 v[4:7], v76, s[8:11], s65 offen offset:1024 sc1
  buffer_load_dwordx4 v[0:3], v76, s[8:11], s85 offen offset:0 sc1
  buffer_load_dwordx4 v[8:11], v76, s[8:11], s85 offen offset:1024 sc1
  s_mov_b64 exec, -1
  s_add_u32 s67, s67, 1
  s_cmp_lt_u32 s67, 131072
  s_cselect_b32 s54, -2, -1
  s_waitcnt vmcnt(2)
  v_max3_u32 v72, v4, v5, v6
  s_waitcnt vmcnt(1)
  v_max3_u32 v72, v72, v7, v0
  v_max3_u32 v72, v72, v1, v2
  s_waitcnt vmcnt(0)
  v_max3_u32 v72, v72, v3, v8
  v_max3_u32 v72, v72, v9, v10
  v_max_u32 v72, v72, v11
  v_cmp_lt_u32 vcc, s54, v72
  s_cbranch_vccnz Cs3_h2r
  ds_write_b128 v76, v[4:7] offset:5632
  ds_write_b128 v76, v[0:3] offset:8704
  ds_write_b128 v76, v[8:11] offset:9728
Cs3_h2w:
  s_cmp_eq_u32 s66, 63
  s_waitcnt lgkmcnt(0)
  s_barrier
  ds_read_b128 v[8:11], v76 offset:6656
Cs3_top2:
  v_smfmac_f32_16x16x64_bf16 v[20:23], v[4:7], v[96:103], v74
  s_cbranch_scc1 Cs3_last
  v_smfmac_f32_16x16x64_bf16 v[28:31], v[4:7], v[36:43], v74
  buffer_load_dwordx4 v[44:47], v76, s[8:11], s58 offen offset:0 sc1
  s_mov_b32 m0, 15872
  v_smfmac_f32_16x16x64_bf16 v[24:27], v[4:7], v[104:111], v74
  buffer_load_dwordx4 v[48:51], v76, s[8:11], s58 offen offset:1024 sc1
  v_smfmac_f32_16x16x64_bf16 v[32:35], v[4:7], v[60:67], v74
  ds_read_b128 v[0:3], v76 offset:4608
  s_waitcnt lgkmcnt(1)
  v_smfmac_f32_16x16x64_bf16 v[20:23], v[8:11], v[112:119], v74
  ds_read_b128 v[12:15], v76 offset:7680
  v_smfmac_f32_16x16x64_bf16 v[24:27], v[8:11], v[120:127], v74
  ds_read_b128 v[36:39], v76 offset:28672
  v_smfmac_f32_16x16x64_bf16 v[28:31], v[8:11], v[208:215], v74
  buffer_store_dwordx4 v[16:19], v76, s[8:11], s68 offen sc1
  ds_read_b128 v[40:43], v76 offset:29696
  v_smfmac_f32_16x16x64_bf16 v[32:35], v[8:11], v[216:223], v74
  ds_read_b128 v[60:63], v76 offset:30720
  s_waitcnt lgkmcnt(4)
  v_smfmac_f32_16x16x64_bf16 v[20:23], v[0:3], v[80:87], v74
  ds_read_b128 v[64:67], v76 offset:31744
  v_smfmac_f32_16x16x64_bf16 v[24:27], v[0:3], v[88:95], v74
  buffer_load_dword v73, s[16:19], s70 offen lds
  s_waitcnt vmcnt(4)
  s_waitcnt lgkmcnt(4)
  v_smfmac_f32_16x16x64_bf16 v[20:23], v[12:15], v[128:135], v74
  s_barrier
  s_waitcnt lgkmcnt(2)
  v_smfmac_f32_16x16x64_bf16 v[28:31], v[0:3], v[36:43], v74
  ds_read_b128 v[4:7], v76 offset:8704
  v_smfmac_f32_16x16x64_bf16 v[24:27], v[12:15], v[136:143], v74
  ds_read_b128 v[36:39], v76 offset:61440
  s_waitcnt lgkmcnt(2)
  v_smfmac_f32_16x16x64_bf16 v[32:35], v[0:3], v[60:67], v74
  ds_read_b128 v[40:43], v76 offset:62464
  v_smfmac_f32_16x16x64_bf16 v[28:31], v[12:15], v[224:231], v74
  ds_read_b128 v[60:63], v76 offset:63488
  v_smfmac_f32_16x16x64_bf16 v[32:35], v[12:15], v[232:239], v74
  ds_read_b128 v[64:67], v76 offset:64512
  s_waitcnt lgkmcnt(4)
  v_smfmac_f32_16x16x64_bf16 v[20:23], v[4:7], v[144:151], v74
  ds_read_b128 v[8:11], v76 offset:9728
  s_waitcnt lgkmcnt(3)
  v_smfmac_f32_16x16x64_bf16 v[28:31], v[4:7], v[36:43], v74
  s_barrier
  ds_read_b128 v[0:3], v76 offset:11776
  v_smfmac_f32_16x16x64_bf16 v[24:27], v[4:7], v[152:159], v74
  ds_read_b128 v[36:39], v75 offset:12288
  ds_read_b128 v[40:43], v75 offset:13312
  s_waitcnt lgkmcnt(4)
  v_smfmac_f32_16x16x64_bf16 v[32:35], v[4:7], v[60:67], v74
  ds_read_b128 v[16:19], v76 offset:10752
  s_waitcnt lgkmcnt(4)
  v_smfmac_f32_16x16x64_bf16 v[20:23], v[8:11], v[160:167], v74
  ds_read_b128 v[12:15], v76 offset:12800
  v_smfmac_f32_16x16x64_bf16 v[24:27], v[8:11], v[168:175], v74
  ds_read_b128 v[60:63], v75 offset:14336
  ds_read_b128 v[64:67], v75 offset:15360
  s_waitcnt lgkmcnt(6)
  v_smfmac_f32_16x16x64_bf16 v[20:23], v[0:3], v[176:183], v74
  s_waitcnt lgkmcnt(3)
  v_smfmac_f32_16x16x64_bf16 v[20:23], v[16:19], v[36:43], v74
  ds_read_b128 v[36:39], v75 offset:28672
  s_waitcnt lgkmcnt(3)
  v_smfmac_f32_16x16x64_bf16 v[20:23], v[12:15], v[192:199], v74
  ds_read_b128 v[40:43], v75 offset:29696
  s_waitcnt lgkmcnt(2)
  v_smfmac_f32_16x16x64_bf16 v[24:27], v[16:19], v[60:67], v74
  ds_read_b128 v[60:63], v75 offset:30720
  v_smfmac_f32_16x16x64_bf16 v[24:27], v[0:3], v[184:191], v74
  ds_read_b128 v[64:67], v75 offset:31744
  v_add_f32 v20, v20, v22
  v_smfmac_f32_16x16x64_bf16 v[24:27], v[12:15], v[200:207], v74
  v_add_f32 v21, v21, v23
  v_smfmac_f32_16x16x64_bf16 v[28:31], v[16:19], v[240:247], v74
  s_waitcnt lgkmcnt(2)
  v_mov_b64 v[70:71], s[78:79]
  v_smfmac_f32_16x16x64_bf16 v[28:31], v[8:11], v[36:43], v74
  ds_read_b128 v[36:39], v68
  v_add_f32 v24, v24, v26
  v_smfmac_f32_16x16x64_bf16 v[28:31], v[0:3], a[0:7], v74
  ds_read_b128 v[40:43], v68
  v_cvt_pk_bf16_f32 v22, v20, v24
  v_smfmac_f32_16x16x64_bf16 v[28:31], v[12:15], a[16:23], v74
  ds_write_b32 v79, v22 offset:0
  s_waitcnt lgkmcnt(3)
  v_add_f32 v25, v25, v27
  v_cvt_pk_bf16_f32 v23, v21, v25
  v_smfmac_f32_16x16x64_bf16 v[32:35], v[8:11], v[60:67], v74
  ds_write_b32 v79, v23 offset:576
  v_cmp_u_f32 vcc, v20, v21
  v_smfmac_f32_16x16x64_bf16 v[32:35], v[16:19], v[248:255], v74
  v_add_f32 v28, v28, v30
  v_smfmac_f32_16x16x64_bf16 v[32:35], v[0:3], a[8:15], v74
  v_add_f32 v29, v29, v31
  v_smfmac_f32_16x16x64_bf16 v[32:35], v[12:15], a[24:31], v74
  s_cbranch_vccnz Cs3_rec
Cs3_recok:
  s_waitcnt lgkmcnt(3)
  v_smfmac_f32_16x16x64_bf16 v[36:39], v[16:19], a[128:135], v74
  s_waitcnt lgkmcnt(0)
  s_barrier
  ds_read_b128 v[60:63], v77
  v_smfmac_f32_16x16x64_bf16 v[40:43], v[16:19], a[136:143], v74
  ds_read_b128 v[64:67], v77 offset:128
  v_add_f32 v32, v32, v34
  v_cvt_pk_bf16_f32 v30, v28, v32
  v_smfmac_f32_16x16x64_bf16 v[36:39], v[0:3], a[144:151], v74
  ds_write_b32 v79, v30 offset:256
  v_add_f32 v33, v33, v35
  v_cvt_pk_bf16_f32 v31, v29, v33
  v_smfmac_f32_16x16x64_bf16 v[40:43], v[0:3], a[152:159], v74
  ds_write_b32 v79, v31 offset:832
  v_xor_b32 v75, 0x8000, v75
  v_smfmac_f32_16x16x64_bf16 v[36:39], v[4:7], a[96:103], v74
  ds_read_b128 v[0:3], v76 offset:4608
  v_mov_b32 v29, 0
  v_smfmac_f32_16x16x64_bf16 v[40:43], v[4:7], a[104:111], v74
  s_waitcnt vmcnt(2) lgkmcnt(3)
  v_mov_b32 v30, 0
  v_mfma_f32_16x16x32_bf16 v[44:47], v[44:47], v[60:63], 0
  ds_read_b128 v[4:7], v76 offset:5632
  s_waitcnt lgkmcnt(2)
  v_mfma_f32_16x16x32_bf16 v[44:47], v[48:51], v[64:67], v[44:47]
  s_barrier
  v_smfmac_f32_16x16x64_bf16 v[36:39], v[8:11], a[112:119], v74
  ds_read_b128 v[20:23], v77 offset:256
  ds_read_b128 v[24:27], v77 offset:384
  v_smfmac_f32_16x16x64_bf16 v[40:43], v[8:11], a[120:127], v74
  ds_read_b128 v[8:11], v76 offset:6656
  v_add_f32_dpp v72, v46, v44 quad_perm:[2,3,0,1] row_mask:0xf bank_mask:0xf
  v_add_f32_dpp v73, v47, v45 quad_perm:[2,3,0,1] row_mask:0xf bank_mask:0xf
  v_smfmac_f32_16x16x64_bf16 v[36:39], v[12:15], a[160:167], v74
  s_waitcnt lgkmcnt(4)
  v_exp_f32_dpp v72, v72 quad_perm:[0,1,0,1] row_mask:0xf bank_mask:0xf
  v_smfmac_f32_16x16x64_bf16 v[40:43], v[12:15], a[168:175], v74
  ds_read_b128 v[12:15], v76 offset:7680
  v_exp_f32_dpp v73, v73 quad_perm:[0,1,0,1] row_mask:0xf bank_mask:0xf
  v_smfmac_f32_16x16x64_bf16 v[36:39], v[0:3], a[32:39], v74
  s_waitcnt lgkmcnt(2)
  v_cvt_pk_bf16_f32 v72, v72, v73
  v_mfma_f32_16x16x32_bf16 v[20:23], v[20:23], v[60:63], 0
  ds_write_b32 v78, v72 offset:524
  v_mov_b64 v[16:17], 0
  v_mfma_f32_16x16x32_bf16 v[20:23], v[24:27], v[64:67], v[20:23]
  ds_read_b128 v[44:47], v75 offset:28672
  v_mov_b64 v[18:19], 0
  v_smfmac_f32_16x16x64_bf16 v[40:43], v[0:3], a[40:47], v74
  ds_read_b128 v[48:51], v75 offset:29696
  v_mov_b64 v[68:69], s[78:79]
  v_smfmac_f32_16x16x64_bf16 v[36:39], v[4:7], a[48:55], v74
  s_waitcnt lgkmcnt(4)
  v_add_f32_dpp v24, v22, v20 quad_perm:[2,3,0,1] row_mask:0xf bank_mask:0xf
  v_add_f32_dpp v25, v23, v21 quad_perm:[2,3,0,1] row_mask:0xf bank_mask:0xf
  v_smfmac_f32_16x16x64_bf16 v[36:39], v[8:11], a[64:71], v74
  s_waitcnt lgkmcnt(2)
  s_barrier
  ds_read_b128 v[32:35], v78 offset:512
  v_smfmac_f32_16x16x64_bf16 v[36:39], v[12:15], a[80:87], v74
  ds_read_b128 v[60:63], v75 offset:30720
  v_mul_f32 v24, s69, v24
  v_smfmac_f32_16x16x64_bf16 v[40:43], v[4:7], a[56:63], v74
  ds_read_b128 v[64:67], v75 offset:31744
  v_mul_f32 v25, s69, v25
  v_smfmac_f32_16x16x64_bf16 v[40:43], v[8:11], a[72:79], v74
  v_exp_f32_dpp v24, v24 quad_perm:[0,1,0,1] row_mask:0xf bank_mask:0xf
  v_smfmac_f32_16x16x64_bf16 v[40:43], v[12:15], a[88:95], v74
  s_waitcnt lgkmcnt(2)
  v_exp_f32_dpp v25, v25 quad_perm:[0,1,0,1] row_mask:0xf bank_mask:0xf
  v_mfma_f32_16x16x32_bf16 v[8:11], v[32:35], v[68:71], 0
  v_add_f32 v36, v36, v38
  v_add_f32 v37, v37, v39
  v_mfma_f32_16x16x32_bf16 v[0:3], v[32:35], v[52:55], 0
  v_add_f32 v40, v40, v42
  v_add_f32 v41, v41, v43
  v_mfma_f32_16x16x32_bf16 v[4:7], v[32:35], v[56:59], 0
  v_cvt_pk_bf16_f32 v28, v24, v25
  v_cvt_pk_bf16_f32 v72, v36, v37
  v_cvt_pk_bf16_f32 v73, v40, v41
  v_mfma_f32_16x16x16_bf16 v[8:11], v[28:29], v[68:69], v[8:11]
  v_cvt_pk_bf16_f32 v31, v24, v25
  v_mov_b64 v[20:21], 0
  v_mfma_f32_16x16x16_bf16 v[0:3], v[28:29], v[72:73], v[0:3]
  ds_read_b128 v[68:71], v76 offset:13824
  v_mov_b64 v[22:23], 0
  v_mfma_f32_16x16x16_bf16 v[4:7], v[30:31], v[72:73], v[4:7]
  v_rcp_f32 v10, v8
  v_rcp_f32 v11, v9
  v_mul_f32 v0, v10, v0
  v_mul_f32 v1, v11, v1
  s_nop 0
  v_mul_f32 v4, v10, v4
  v_mul_f32 v5, v11, v5
  v_cvt_pk_bf16_f32 v2, v0, v4
  ds_write_b32 v79, v2 offset:8704
  v_cvt_pk_bf16_f32 v3, v1, v5
  ds_write_b32 v79, v3 offset:9280
  v_max3_f32 v8, v8, v9, v10
  v_max_f32 v8, v8, v11
  v_cmp_le_f32 vcc, 1317011456, v8
  v_mov_b64 v[24:25], 0
  v_mov_b64 v[26:27], 0
  s_cbranch_vccnz Cs3_mx
Cs3_mxok:
  s_waitcnt lgkmcnt(0)
  s_barrier
  ds_read_b128 v[0:3], v78 offset:8704
  ds_read_b128 v[4:7], v78 offset:8768
  ds_read_b128 v[8:11], v78 offset:8832
  ds_read_b128 v[12:15], v78 offset:8896
  s_waitcnt lgkmcnt(3)
  v_smfmac_f32_16x16x64_bf16 v[16:19], v[0:3], v[44:51], v74
  ds_read_b128 v[52:55], v75 offset:45056
  s_waitcnt lgkmcnt(3)
  v_smfmac_f32_16x16x64_bf16 v[16:19], v[4:7], v[60:67], v74
  ds_read_b128 v[56:59], v75 offset:46080
  s_waitcnt lgkmcnt(3)
  v_smfmac_f32_16x16x64_bf16 v[16:19], v[8:11], a[176:183], v74
  ds_read_b128 v[36:39], v75 offset:47104
  s_waitcnt lgkmcnt(3)
  v_smfmac_f32_16x16x64_bf16 v[16:19], v[12:15], a[184:191], v74
  ds_read_b128 v[40:43], v75 offset:48128
  ds_read_b128 v[44:47], v75 offset:61440
  v_smfmac_f32_16x16x64_bf16 v[20:23], v[0:3], a[192:199], v74
  ds_read_b128 v[48:51], v75 offset:62464
  ds_read_b128 v[60:63], v75 offset:63488
  v_smfmac_f32_16x16x64_bf16 v[20:23], v[4:7], a[200:207], v74
  ds_read_b128 v[64:67], v75 offset:64512
  s_waitcnt lgkmcnt(6)
  v_cvt_pk_bf16_f32 v16, v16, v17
  v_cvt_pk_bf16_f32 v17, v18, v19
  v_bfi_b32 v16, 1, s72, v16
  v_smfmac_f32_16x16x64_bf16 v[20:23], v[8:11], v[52:59], v74
  buffer_store_dwordx2 v[16:17], v68, s[8:11], s73 offen sc1
  s_waitcnt lgkmcnt(4)
  v_smfmac_f32_16x16x64_bf16 v[20:23], v[12:15], v[36:43], v74
  ds_read_b128 v[52:55], v75 offset:8192
  v_mov_b64 v[32:33], 0
  v_smfmac_f32_16x16x64_bf16 v[24:27], v[0:3], a[208:215], v74
  ds_read_b128 v[56:59], v75 offset:9216
  v_mov_b64 v[34:35], 0
  v_smfmac_f32_16x16x64_bf16 v[24:27], v[4:7], a[216:223], v74
  ds_read_b128 v[36:39], v75 offset:10240
  s_waitcnt lgkmcnt(5)
  v_cvt_pk_bf16_f32 v20, v20, v21
  v_cvt_pk_bf16_f32 v21, v22, v23
  v_bfi_b32 v20, 1, s72, v20
  v_smfmac_f32_16x16x64_bf16 v[24:27], v[8:11], v[44:51], v74
  buffer_store_dwordx2 v[20:21], v68, s[8:11], s74 offen sc1
  s_waitcnt lgkmcnt(3)
  v_smfmac_f32_16x16x64_bf16 v[24:27], v[12:15], v[60:67], v74
  ds_read_b128 v[40:43], v75 offset:11264
  v_mov_b64 v[28:29], 0
  v_smfmac_f32_16x16x64_bf16 v[32:35], v[0:3], a[224:231], v74
  ds_read_b128 v[44:47], v75 offset:12288
  ds_read_b128 v[48:51], v75 offset:13312
  v_smfmac_f32_16x16x64_bf16 v[32:35], v[4:7], a[232:239], v74
  ds_read_b128 v[60:63], v75 offset:14336
  v_cvt_pk_bf16_f32 v24, v24, v25
  v_cvt_pk_bf16_f32 v25, v26, v27
  v_bfi_b32 v24, 1, s72, v24
  v_smfmac_f32_16x16x64_bf16 v[32:35], v[8:11], a[240:247], v74
  buffer_store_dwordx2 v[24:25], v68, s[8:11], s75 offen sc1
  v_mov_b64 v[30:31], 0
  v_smfmac_f32_16x16x64_bf16 v[32:35], v[12:15], a[248:255], v74
  ds_read_b128 v[64:67], v75 offset:15360
  s_waitcnt lgkmcnt(6)
  v_smfmac_f32_16x16x64_bf16 v[28:31], v[0:3], v[52:59], v74
  s_waitcnt lgkmcnt(4)
  v_smfmac_f32_16x16x64_bf16 v[28:31], v[4:7], v[36:43], v74
  s_waitcnt lgkmcnt(2)
  v_cvt_pk_bf16_f32 v32, v32, v33
  v_cvt_pk_bf16_f32 v33, v34, v35
  v_bfi_b32 v32, 1, s72, v32
  v_smfmac_f32_16x16x64_bf16 v[28:31], v[8:11], v[44:51], v74
  buffer_store_dwordx2 v[32:33], v68, s[8:11], s76 offen sc1
  s_waitcnt lgkmcnt(0)
  v_smfmac_f32_16x16x64_bf16 v[28:31], v[12:15], v[60:67], v74
  v_mov_b64 v[18:19], v[72:73]
  s_nop 4
  v_cvt_pk_bf16_f32 v28, v28, v29
  v_cvt_pk_bf16_f32 v29, v30, v31
  v_bfi_b32 v28, 1, s72, v28
  buffer_store_dwordx2 v[28:29], v68, s[8:11], s77 offen sc1
  ds_read_b128 v[52:55], v76 offset:14848
  s_waitcnt lgkmcnt(0)
  ds_read_b64 v[16:17], v77 offset:392
  s_waitcnt lgkmcnt(0)
  ds_read_b128 v[60:63], v76 offset:47104
  s_waitcnt lgkmcnt(0)
  ds_read_b128 v[64:67], v76 offset:48128
  s_waitcnt lgkmcnt(0)
  s_add_u32 s66, s66, 1
  s_xor_b32 s64, s64, 16384
  s_xor_b32 s65, s65, 16384
  s_add_u32 s58, s58, 655360
  s_add_u32 s59, s59, 655360
  s_add_u32 s70, s70, 655360
  s_add_u32 s68, s68, 655360
  s_mov_b32 m0, 8704
  s_add_u32 s85, s65, 4096
  v_xor_b32 v75, 0x8000, v75
  s_waitcnt vmcnt(0)
  buffer_load_dwordx4 v[0:3], v76, s[8:11], s60 offen offset:0 sc1
  buffer_load_dwordx4 v[4:7], v76, s[8:11], s60 offen offset:1024 sc1
  buffer_load_dwordx4 v[8:11], v76, s[8:11], s61 offen offset:0 sc1
  buffer_load_dwordx4 v[12:15], v76, s[8:11], s61 offen offset:1024 sc1
  v_mov_b64 v[20:21], 0
  v_mov_b64 v[22:23], 0
  v_mov_b64 v[24:25], 0
  v_mov_b64 v[26:27], 0
  v_mov_b32 v68, 14880
  v_mov_b64 v[28:29], 0
  v_mov_b64 v[30:31], 0
  v_mov_b64 v[32:33], 0
  v_mov_b64 v[34:35], 0
  s_cmp_eq_u32 s66, 62
  s_cselect_b64 s[16:17], s[20:21], s[16:17]
  s_cselect_b32 s18, (Cs3_done - Cs3_last), s18
  s_cselect_b32 s70, 0, s70
  s_cmp_eq_u32 s66, 63
  s_cselect_b32 s59, 268435456, s59
  s_cselect_b32 s58, 268435456, s58
  s_waitcnt lgkmcnt(0)
  s_waitcnt vmcnt(3)
  v_mfma_f32_16x16x32_bf16 v[56:59], v[52:55], v[0:3], 0
  v_bitop3_b32 v72, v0, v2, s72 bitop3:0x7e
  s_waitcnt vmcnt(2)
  v_mfma_f32_16x16x32_bf16 v[56:59], v[52:55], v[4:7], v[56:59]
  v_bitop3_b32 v73, v4, v6, s72 bitop3:0x7e
  v_or_b32 v72, v72, v73
  s_waitcnt vmcnt(1)
  v_mfma_f32_16x16x32_bf16 v[36:39], v[52:55], v[8:11], 0
  v_bitop3_b32 v73, v8, v10, s72 bitop3:0x7e
  v_or_b32 v72, v72, v73
  s_waitcnt vmcnt(0)
  v_mfma_f32_16x16x32_bf16 v[36:39], v[52:55], v[12:15], v[36:39]
  v_bitop3_b32 v73, v12, v14, s72 bitop3:0x7e
  v_bitop3_b32 v72, v72, v73, 1 bitop3:0xa8
  v_cmp_ne_u32 vcc, 0, v72
  s_cbranch_vccnz Cs3_h1r
  v_add_f32_dpp v56, v56, v56 row_ror:4 row_mask:0xf bank_mask:0xf
  v_add_f32_dpp v57, v57, v57 row_ror:4 row_mask:0xf bank_mask:0xf
  s_nop 0
  v_add_f32_dpp v36, v36, v36 row_ror:4 row_mask:0xf bank_mask:0xf
  v_add_f32_dpp v37, v37, v37 row_ror:4 row_mask:0xf bank_mask:0xf
  v_add_f32_dpp v56, v56, v56 row_ror:8 row_mask:0xf bank_mask:0xf
  v_add_f32_dpp v57, v57, v57 row_ror:8 row_mask:0xf bank_mask:0xf
  v_add_f32_dpp v36, v36, v36 row_ror:8 row_mask:0xf bank_mask:0xf
  v_add_f32_dpp v37, v37, v37 row_ror:8 row_mask:0xf bank_mask:0xf
  v_cvt_pk_bf16_f32 v56, v56, v57
  buffer_store_dword v56, v69, s[8:11], s62 offen sc1
  v_cvt_pk_bf16_f32 v36, v36, v37
  buffer_store_dword v36, v70, s[8:11], s63 offen sc1
  s_xor_b32 s62, s62, 16384
  buffer_store_dword v71, v69, s[8:11], s62 offen sc1
  s_xor_b32 s63, s63, 16384
  buffer_store_dword v71, v70, s[8:11], s63 offen sc1
  s_xor_b32 s72, s72, 1
  s_branch Cs3_h2
Cs3_h1r:
  s_mov_b64 exec, vcc
  buffer_load_dwordx4 v[0:3], v76, s[8:11], s60 offen offset:0 sc1
  buffer_load_dwordx4 v[4:7], v76, s[8:11], s60 offen offset:1024 sc1
  buffer_load_dwordx4 v[8:11], v76, s[8:11], s61 offen offset:0 sc1
  buffer_load_dwordx4 v[12:15], v76, s[8:11], s61 offen offset:1024 sc1
  s_mov_b64 exec, -1
  s_add_u32 s67, s67, 1
  s_waitcnt vmcnt(3)
  v_mfma_f32_16x16x32_bf16 v[56:59], v[52:55], v[0:3], 0
  v_bitop3_b32 v72, v0, v2, s72 bitop3:0x7e
  s_waitcnt vmcnt(2)
  v_mfma_f32_16x16x32_bf16 v[56:59], v[52:55], v[4:7], v[56:59]
  v_bitop3_b32 v73, v4, v6, s72 bitop3:0x7e
  v_or_b32 v72, v72, v73
  s_waitcnt vmcnt(1)
  v_mfma_f32_16x16x32_bf16 v[36:39], v[52:55], v[8:11], 0
  v_bitop3_b32 v73, v8, v10, s72 bitop3:0x7e
  v_or_b32 v72, v72, v73
  s_waitcnt vmcnt(0)
  v_mfma_f32_16x16x32_bf16 v[36:39], v[52:55], v[12:15], v[36:39]
  v_bitop3_b32 v73, v12, v14, s72 bitop3:0x7e
  v_bitop3_b32 v72, v72, v73, 1 bitop3:0xa8
  v_cmp_ne_u32 vcc, 0, v72
  s_cbranch_vccz Cs3_h1p
Cs3_h1s:
  s_mov_b64 exec, vcc
  buffer_load_dwordx4 v[0:3], v76, s[8:11], s60 offen offset:0 sc1
  buffer_load_dwordx4 v[4:7], v76, s[8:11], s60 offen offset:1024 sc1
  buffer_load_dwordx4 v[8:11], v76, s[8:11], s61 offen offset:0 sc1
  buffer_load_dwordx4 v[12:15], v76, s[8:11], s61 offen offset:1024 sc1
  s_mov_b64 exec, -1
  s_add_u32 s67, s67, 1
  s_waitcnt vmcnt(3)
  v_mfma_f32_16x16x32_bf16 v[56:59], v[52:55], v[0:3], 0
  v_bitop3_b32 v72, v0, v2, s72 bitop3:0x7e
  s_waitcnt vmcnt(2)
  v_mfma_f32_16x16x32_bf16 v[56:59], v[52:55], v[4:7], v[56:59]
  v_bitop3_b32 v73, v4, v6, s72 bitop3:0x7e
  v_or_b32 v72, v72, v73
  s_waitcnt vmcnt(1)
  v_mfma_f32_16x16x32_bf16 v[36:39], v[52:55], v[8:11], 0
  v_bitop3_b32 v73, v8, v10, s72 bitop3:0x7e
  v_or_b32 v72, v72, v73
  s_waitcnt vmcnt(0)
  v_mfma_f32_16x16x32_bf16 v[36:39], v[52:55], v[12:15], v[36:39]
  v_bitop3_b32 v73, v12, v14, s72 bitop3:0x7e
  v_bitop3_b32 v72, v72, v73, 1 bitop3:0xa8
  v_cmp_ne_u32 vcc, 0, v72
  s_cbranch_vccz Cs3_h1p
  s_cmp_lt_u32 s67, 131072
  s_cbranch_scc1 Cs3_h1s
Cs3_h1p:
  s_nop 2
  v_add_f32_dpp v56, v56, v56 row_ror:4 row_mask:0xf bank_mask:0xf
  v_add_f32_dpp v57, v57, v57 row_ror:4 row_mask:0xf bank_mask:0xf
  v_add_f32_dpp v36, v36, v36 row_ror:4 row_mask:0xf bank_mask:0xf
  v_add_f32_dpp v37, v37, v37 row_ror:4 row_mask:0xf bank_mask:0xf
  v_add_f32_dpp v56, v56, v56 row_ror:8 row_mask:0xf bank_mask:0xf
  v_add_f32_dpp v57, v57, v57 row_ror:8 row_mask:0xf bank_mask:0xf
  v_add_f32_dpp v36, v36, v36 row_ror:8 row_mask:0xf bank_mask:0xf
  v_add_f32_dpp v37, v37, v37 row_ror:8 row_mask:0xf bank_mask:0xf
  v_cvt_pk_bf16_f32 v56, v56, v57
  buffer_store_dword v56, v69, s[8:11], s62 offen sc1
  v_cvt_pk_bf16_f32 v36, v36, v37
  buffer_store_dword v36, v70, s[8:11], s63 offen sc1
  s_xor_b32 s62, s62, 16384
  buffer_store_dword v71, v69, s[8:11], s62 offen sc1
  s_xor_b32 s63, s63, 16384
  buffer_store_dword v71, v70, s[8:11], s63 offen sc1
  s_xor_b32 s72, s72, 1
  s_branch Cs3_h2
Cs3_rec:
  s_nop 7
  s_waitcnt vmcnt(0) lgkmcnt(0)
  v_max3_u32 v72, v0, v1, v2
  v_max3_u32 v72, v72, v3, v4
  v_max3_u32 v72, v72, v5, v6
  v_max3_u32 v72, v72, v7, v8
  v_max3_u32 v72, v72, v9, v10
  v_max3_u32 v72, v72, v11, v12
  v_max3_u32 v72, v72, v13, v14
  v_max3_u32 v72, v72, v15, v16
  v_max3_u32 v72, v72, v17, v18
  v_max_u32 v72, v72, v19
  v_cmp_eq_u32 vcc, -1, v72
  s_cbranch_vccz Cs3_recok
  s_barrier
Cs3_recp:
  buffer_load_dwordx4 v[0:3], v76, s[8:11], s64 offen offset:0 sc1
  buffer_load_dwordx4 v[4:7], v76, s[8:11], s64 offen offset:1024 sc1
  buffer_load_dwordx4 v[8:11], v76, s[8:11], s64 offen offset:2048 sc1
  s_add_u32 s67, s67, 1
  s_cmp_lt_u32 s67, 131072
  s_cselect_b32 s54, -2, -1
  s_waitcnt vmcnt(2)
  v_max3_u32 v72, v0, v1, v2
  s_waitcnt vmcnt(1)
  v_max3_u32 v72, v72, v3, v4
  v_max3_u32 v72, v72, v5, v6
  s_waitcnt vmcnt(0)
  v_max3_u32 v72, v72, v7, v8
  v_max3_u32 v72, v72, v9, v10
  v_max_u32 v72, v72, v11
  v_cmp_lt_u32 vcc, s54, v72
  s_cbranch_vccnz Cs3_recp
  ds_write_b128 v76, v[0:3] offset:10752
  ds_write_b128 v76, v[4:7] offset:11776
  ds_write_b128 v76, v[8:11] offset:12800
  v_mov_b64 v[20:21], 0
  v_mov_b64 v[22:23], 0
  v_mov_b64 v[24:25], 0
  v_mov_b64 v[26:27], 0
  v_mov_b64 v[28:29], 0
  v_mov_b64 v[30:31], 0
  v_mov_b64 v[32:33], 0
  v_mov_b64 v[34:35], 0
  s_waitcnt lgkmcnt(0)
  s_barrier
  ds_read_b128 v[0:3], v76 offset:4608
  s_waitcnt lgkmcnt(0)
  v_smfmac_f32_16x16x64_bf16 v[20:23], v[0:3], v[80:87], v74
  v_smfmac_f32_16x16x64_bf16 v[24:27], v[0:3], v[88:95], v74
  ds_read_b128 v[60:63], v76 offset:28672
  ds_read_b128 v[64:67], v76 offset:29696
  s_waitcnt lgkmcnt(0)
  v_smfmac_f32_16x16x64_bf16 v[28:31], v[0:3], v[60:67], v74
  ds_read_b128 v[60:63], v76 offset:30720
  ds_read_b128 v[64:67], v76 offset:31744
  s_waitcnt lgkmcnt(0)
  v_smfmac_f32_16x16x64_bf16 v[32:35], v[0:3], v[60:67], v74
  ds_read_b128 v[4:7], v76 offset:5632
  s_waitcnt lgkmcnt(0)
  v_smfmac_f32_16x16x64_bf16 v[20:23], v[4:7], v[96:103], v74
  v_smfmac_f32_16x16x64_bf16 v[24:27], v[4:7], v[104:111], v74
  ds_read_b128 v[60:63], v76 offset:45056
  ds_read_b128 v[64:67], v76 offset:46080
  s_waitcnt lgkmcnt(0)
  v_smfmac_f32_16x16x64_bf16 v[28:31], v[4:7], v[60:67], v74
  ds_read_b128 v[60:63], v76 offset:47104
  ds_read_b128 v[64:67], v76 offset:48128
  s_waitcnt lgkmcnt(0)
  v_smfmac_f32_16x16x64_bf16 v[32:35], v[4:7], v[60:67], v74
  ds_read_b128 v[8:11], v76 offset:6656
  s_waitcnt lgkmcnt(0)
  v_smfmac_f32_16x16x64_bf16 v[20:23], v[8:11], v[112:119], v74
  v_smfmac_f32_16x16x64_bf16 v[24:27], v[8:11], v[120:127], v74
  v_smfmac_f32_16x16x64_bf16 v[28:31], v[8:11], v[208:215], v74
  v_smfmac_f32_16x16x64_bf16 v[32:35], v[8:11], v[216:223], v74
  ds_read_b128 v[12:15], v76 offset:7680
  s_waitcnt lgkmcnt(0)
  v_smfmac_f32_16x16x64_bf16 v[20:23], v[12:15], v[128:135], v74
  v_smfmac_f32_16x16x64_bf16 v[24:27], v[12:15], v[136:143], v74
  v_smfmac_f32_16x16x64_bf16 v[28:31], v[12:15], v[224:231], v74
  v_smfmac_f32_16x16x64_bf16 v[32:35], v[12:15], v[232:239], v74
  ds_read_b128 v[4:7], v76 offset:8704
  s_waitcnt lgkmcnt(0)
  v_smfmac_f32_16x16x64_bf16 v[20:23], v[4:7], v[144:151], v74
  v_smfmac_f32_16x16x64_bf16 v[24:27], v[4:7], v[152:159], v74
  ds_read_b128 v[60:63], v76 offset:61440
  ds_read_b128 v[64:67], v76 offset:62464
  s_waitcnt lgkmcnt(0)
  v_smfmac_f32_16x16x64_bf16 v[28:31], v[4:7], v[60:67], v74
  ds_read_b128 v[60:63], v76 offset:63488
  ds_read_b128 v[64:67], v76 offset:64512
  s_waitcnt lgkmcnt(0)
  v_smfmac_f32_16x16x64_bf16 v[32:35], v[4:7], v[60:67], v74
  ds_read_b128 v[8:11], v76 offset:9728
  s_waitcnt lgkmcnt(0)
  v_smfmac_f32_16x16x64_bf16 v[20:23], v[8:11], v[160:167], v74
  v_smfmac_f32_16x16x64_bf16 v[24:27], v[8:11], v[168:175], v74
  ds_read_b128 v[60:63], v75 offset:28672
  ds_read_b128 v[64:67], v75 offset:29696
  s_waitcnt lgkmcnt(0)
  v_smfmac_f32_16x16x64_bf16 v[28:31], v[8:11], v[60:67], v74
  ds_read_b128 v[60:63], v75 offset:30720
  ds_read_b128 v[64:67], v75 offset:31744
  s_waitcnt lgkmcnt(0)
  v_smfmac_f32_16x16x64_bf16 v[32:35], v[8:11], v[60:67], v74
  ds_read_b128 v[16:19], v76 offset:10752
  ds_read_b128 v[60:63], v75 offset:12288
  ds_read_b128 v[64:67], v75 offset:13312
  s_waitcnt lgkmcnt(0)
  v_smfmac_f32_16x16x64_bf16 v[20:23], v[16:19], v[60:67], v74
  ds_read_b128 v[60:63], v75 offset:14336
  ds_read_b128 v[64:67], v75 offset:15360
  s_waitcnt lgkmcnt(0)
  v_smfmac_f32_16x16x64_bf16 v[24:27], v[16:19], v[60:67], v74
  v_smfmac_f32_16x16x64_bf16 v[28:31], v[16:19], v[240:247], v74
  v_smfmac_f32_16x16x64_bf16 v[32:35], v[16:19], v[248:255], v74
  ds_read_b128 v[0:3], v76 offset:11776
  s_waitcnt lgkmcnt(0)
  v_smfmac_f32_16x16x64_bf16 v[20:23], v[0:3], v[176:183], v74
  v_smfmac_f32_16x16x64_bf16 v[24:27], v[0:3], v[184:191], v74
  v_smfmac_f32_16x16x64_bf16 v[28:31], v[0:3], a[0:7], v74
  v_smfmac_f32_16x16x64_bf16 v[32:35], v[0:3], a[8:15], v74
  ds_read_b128 v[12:15], v76 offset:12800
  s_waitcnt lgkmcnt(0)
  v_smfmac_f32_16x16x64_bf16 v[20:23], v[12:15], v[192:199], v74
  v_smfmac_f32_16x16x64_bf16 v[24:27], v[12:15], v[200:207], v74
  v_smfmac_f32_16x16x64_bf16 v[28:31], v[12:15], a[16:23], v74
  v_smfmac_f32_16x16x64_bf16 v[32:35], v[12:15], a[24:31], v74
  v_add_f32 v20, v20, v22
  v_add_f32 v21, v21, v23
  v_add_f32 v24, v24, v26
  v_cvt_pk_bf16_f32 v22, v20, v24
  ds_write_b32 v79, v22 offset:0
  v_add_f32 v25, v25, v27
  v_cvt_pk_bf16_f32 v23, v21, v25
  ds_write_b32 v79, v23 offset:576
  v_add_f32 v28, v28, v30
  v_add_f32 v29, v29, v31
  s_waitcnt lgkmcnt(0)
  s_nop 1
  s_branch Cs3_recok
Cs3_mx:
  s_waitcnt lgkmcnt(0)
  s_barrier
  buffer_load_dwordx4 v[0:3], v76, s[8:11], s58 offen offset:0 sc1
  ds_read_b128 v[20:23], v77 offset:0
  ds_read_b128 v[28:31], v77 offset:256
  buffer_load_dwordx4 v[4:7], v76, s[8:11], s58 offen offset:1024 sc1
  ds_read_b128 v[24:27], v77 offset:128
  ds_read_b128 v[32:35], v77 offset:384
  s_waitcnt vmcnt(1) lgkmcnt(3)
  v_mfma_f32_16x16x32_bf16 v[8:11], v[0:3], v[20:23], 0
  s_waitcnt vmcnt(0) lgkmcnt(1)
  v_mfma_f32_16x16x32_bf16 v[8:11], v[4:7], v[24:27], v[8:11]
  v_mfma_f32_16x16x32_bf16 v[12:15], v[28:31], v[20:23], 0
  s_waitcnt lgkmcnt(0)
  v_mfma_f32_16x16x32_bf16 v[12:15], v[32:35], v[24:27], v[12:15]
  v_add_f32_dpp v8, v10, v8 quad_perm:[2,3,0,1] row_mask:0xf bank_mask:0xf
  v_add_f32_dpp v9, v11, v9 quad_perm:[2,3,0,1] row_mask:0xf bank_mask:0xf
  s_nop 0
  v_mov_b32_dpp v8, v8 quad_perm:[0,1,0,1] row_mask:0xf bank_mask:0xf
  v_mov_b32_dpp v9, v9 quad_perm:[0,1,0,1] row_mask:0xf bank_mask:0xf
  s_nop 1
  v_add_f32_dpp v12, v14, v12 quad_perm:[2,3,0,1] row_mask:0xf bank_mask:0xf
  v_add_f32_dpp v13, v15, v13 quad_perm:[2,3,0,1] row_mask:0xf bank_mask:0xf
  s_nop 0
  v_mov_b32_dpp v12, v12 quad_perm:[0,1,0,1] row_mask:0xf bank_mask:0xf
  v_mov_b32_dpp v13, v13 quad_perm:[0,1,0,1] row_mask:0xf bank_mask:0xf
  v_mul_f32 v12, s69, v12
  ds_write_b32 v78, v8 offset:8716
  v_mul_f32 v13, s69, v13
  ds_write_b32 v78, v9 offset:8780
  s_waitcnt lgkmcnt(0)
  s_barrier
  ds_read_b128 v[36:39], v78 offset:8704
  ds_read_b128 v[40:43], v78 offset:8768
  s_waitcnt lgkmcnt(0)
  s_barrier
  v_max_f32 v16, v36, v37
  v_max3_f32 v16, v16, v38, v39
  v_max3_f32 v16, v16, v40, v41
  v_max3_f32 v16, v16, v42, v43
  v_max3_f32 v16, v16, v12, v13
  v_mov_b32 v17, v16
  s_nop 1
  v_permlane16_swap_b32 v16, v17
  v_max_f32 v16, v16, v17
  v_mov_b32 v17, v16
  s_nop 1
  v_permlane32_swap_b32 v16, v17
  v_max_f32 v16, v16, v17
  v_sub_f32 v36, v36, v16
  v_sub_f32 v37, v37, v16
  v_sub_f32 v38, v38, v16
  v_sub_f32 v39, v39, v16
  v_sub_f32 v40, v40, v16
  v_sub_f32 v41, v41, v16
  v_sub_f32 v42, v42, v16
  v_sub_f32 v43, v43, v16
  v_sub_f32 v12, v12, v16
  v_sub_f32 v13, v13, v16
  v_exp_f32 v36, v36
  v_exp_f32 v37, v37
  v_exp_f32 v38, v38
  v_exp_f32 v39, v39
  v_exp_f32 v40, v40
  v_exp_f32 v41, v41
  v_exp_f32 v42, v42
  v_exp_f32 v43, v43
  v_exp_f32 v12, v12
  v_exp_f32 v13, v13
  v_cvt_pk_bf16_f32 v32, v36, v40
  v_cvt_pk_bf16_f32 v33, v37, v41
  v_cvt_pk_bf16_f32 v34, v38, v42
  v_cvt_pk_bf16_f32 v35, v39, v43
  v_cvt_pk_bf16_f32 v28, v12, v13
  v_cvt_pk_bf16_f32 v31, v12, v13
  v_mov_b32 v29, 0
  v_mov_b32 v30, 0
  v_mov_b32 v68, 0x3f803f80
  v_mov_b32 v69, 0x3f803f80
  v_mov_b32 v70, 0x3f803f80
  v_mov_b32 v71, 0x3f803f80
  s_nop 1
  v_mfma_f32_16x16x32_bf16 v[8:11], v[32:35], v[68:71], 0
  v_mfma_f32_16x16x32_bf16 v[0:3], v[32:35], v[52:55], 0
  v_mfma_f32_16x16x32_bf16 v[4:7], v[32:35], v[56:59], 0
  v_mfma_f32_16x16x16_bf16 v[8:11], v[28:29], v[68:69], v[8:11]
  v_mfma_f32_16x16x16_bf16 v[0:3], v[28:29], v[72:73], v[0:3]
  v_mfma_f32_16x16x16_bf16 v[4:7], v[30:31], v[72:73], v[4:7]
  ds_read_b128 v[68:71], v76 offset:13824
  v_rcp_f32 v10, v8
  v_rcp_f32 v11, v9
  v_mul_f32 v0, v10, v0
  v_mul_f32 v1, v11, v1
  s_nop 0
  v_mul_f32 v4, v10, v4
  v_mul_f32 v5, v11, v5
  v_cvt_pk_bf16_f32 v2, v0, v4
  ds_write_b32 v79, v2 offset:8704
  v_cvt_pk_bf16_f32 v3, v1, v5
  ds_write_b32 v79, v3 offset:9280
  v_mov_b64 v[16:17], 0
  v_mov_b64 v[18:19], 0
  v_mov_b64 v[20:21], 0
  v_mov_b64 v[22:23], 0
  v_mov_b64 v[24:25], 0
  v_mov_b64 v[26:27], 0
  s_branch Cs3_mxok
Cs3_last:
  ds_read_b128 v[0:3], v76 offset:4608
  ds_read_b128 v[12:15], v76 offset:7680
  ds_read_b128 v[44:47], v76 offset:28672
  ds_read_b128 v[48:51], v76 offset:29696
  s_nop 5
  v_mov_b64 v[20:21], 0
  v_mov_b64 v[22:23], 0
  v_mov_b64 v[24:25], 0
  v_mov_b64 v[26:27], 0
  v_smfmac_f32_16x16x64_bf16 v[28:31], v[4:7], v[36:43], v74
  ds_read_b128 v[36:39], v76 offset:30720
  ds_read_b128 v[40:43], v76 offset:31744
  v_smfmac_f32_16x16x64_bf16 v[32:35], v[4:7], v[60:67], v74
  s_waitcnt lgkmcnt(5)
  v_smfmac_f32_16x16x64_bf16 v[20:23], v[0:3], a[32:39], v74
  ds_read_b128 v[60:63], v76 offset:61440
  ds_read_b128 v[64:67], v76 offset:62464
  v_smfmac_f32_16x16x64_bf16 v[24:27], v[0:3], a[40:47], v74
  s_waitcnt lgkmcnt(4)
  v_smfmac_f32_16x16x64_bf16 v[20:23], v[4:7], a[48:55], v74
  buffer_store_dwordx4 v[16:19], v76, s[8:11], s68 offen sc1
  v_smfmac_f32_16x16x64_bf16 v[24:27], v[4:7], a[56:63], v74
  v_smfmac_f32_16x16x64_bf16 v[28:31], v[0:3], v[44:51], v74
  s_waitcnt lgkmcnt(2)
  v_smfmac_f32_16x16x64_bf16 v[20:23], v[8:11], a[64:71], v74
  ds_read_b128 v[44:47], v76 offset:63488
  ds_read_b128 v[48:51], v76 offset:64512
  v_smfmac_f32_16x16x64_bf16 v[24:27], v[8:11], a[72:79], v74
  v_smfmac_f32_16x16x64_bf16 v[32:35], v[0:3], v[36:43], v74
  v_smfmac_f32_16x16x64_bf16 v[28:31], v[8:11], v[208:215], v74
  ds_read_b128 v[36:39], v75 offset:28672
  ds_read_b128 v[40:43], v75 offset:29696
  v_smfmac_f32_16x16x64_bf16 v[32:35], v[8:11], v[216:223], v74
  v_smfmac_f32_16x16x64_bf16 v[20:23], v[12:15], a[80:87], v74
  v_smfmac_f32_16x16x64_bf16 v[24:27], v[12:15], a[88:95], v74
  v_smfmac_f32_16x16x64_bf16 v[28:31], v[12:15], v[224:231], v74
  v_smfmac_f32_16x16x64_bf16 v[32:35], v[12:15], v[232:239], v74
  s_waitcnt vmcnt(1)
  s_barrier
Cs3_lastr:
  ds_read_b128 v[4:7], v76 offset:8704
  ds_read_b128 v[8:11], v76 offset:9728
  ds_read_b128 v[16:19], v76 offset:10752
  ds_read_b128 v[0:3], v76 offset:11776
  ds_read_b128 v[12:15], v76 offset:12800
  s_waitcnt lgkmcnt(1)
  v_max3_u32 v72, v0, v1, v2
  v_max3_u32 v72, v72, v3, v4
  v_max3_u32 v72, v72, v5, v6
  v_max3_u32 v72, v72, v7, v8
  v_max3_u32 v72, v72, v9, v10
  s_waitcnt lgkmcnt(0)
  v_max3_u32 v72, v72, v11, v12
  v_max3_u32 v72, v72, v13, v14
  v_max3_u32 v72, v72, v15, v16
  v_max3_u32 v72, v72, v17, v18
  v_max_u32 v72, v72, v19
  v_cmp_eq_u32 vcc, -1, v72
  s_cbranch_vccnz Cs3_lastp
Cs3_lastg:
  v_smfmac_f32_16x16x64_bf16 v[28:31], v[4:7], v[60:67], v74
  ds_read_b128 v[60:63], v75 offset:30720
  ds_read_b128 v[64:67], v75 offset:31744
  v_smfmac_f32_16x16x64_bf16 v[32:35], v[4:7], v[44:51], v74
  v_smfmac_f32_16x16x64_bf16 v[28:31], v[8:11], v[36:43], v74
  v_smfmac_f32_16x16x64_bf16 v[28:31], v[16:19], v[240:247], v74
  v_smfmac_f32_16x16x64_bf16 v[28:31], v[0:3], a[0:7], v74
  v_smfmac_f32_16x16x64_bf16 v[28:31], v[12:15], a[16:23], v74
  v_smfmac_f32_16x16x64_bf16 v[32:35], v[16:19], v[248:255], v74
  v_smfmac_f32_16x16x64_bf16 v[32:35], v[0:3], a[8:15], v74
  s_waitcnt lgkmcnt(0)
  v_smfmac_f32_16x16x64_bf16 v[32:35], v[12:15], a[24:31], v74
  v_smfmac_f32_16x16x64_bf16 v[32:35], v[8:11], v[60:67], v74
  v_smfmac_f32_16x16x64_bf16 v[20:23], v[4:7], a[96:103], v74
  v_smfmac_f32_16x16x64_bf16 v[20:23], v[8:11], a[112:119], v74
  v_add_f32 v28, v28, v30
  v_add_f32 v32, v32, v34
  v_cvt_pk_bf16_f32 v30, v28, v32
  v_smfmac_f32_16x16x64_bf16 v[20:23], v[16:19], a[128:135], v74
  ds_write_b32 v79, v30 offset:256
  v_add_f32 v29, v29, v31
  v_add_f32 v33, v33, v35
  v_cvt_pk_bf16_f32 v31, v29, v33
  v_smfmac_f32_16x16x64_bf16 v[20:23], v[0:3], a[144:151], v74
  ds_write_b32 v79, v31 offset:832
  v_smfmac_f32_16x16x64_bf16 v[20:23], v[12:15], a[160:167], v74
  v_smfmac_f32_16x16x64_bf16 v[24:27], v[4:7], a[104:111], v74
  v_smfmac_f32_16x16x64_bf16 v[24:27], v[8:11], a[120:127], v74
  v_smfmac_f32_16x16x64_bf16 v[24:27], v[16:19], a[136:143], v74
  s_waitcnt lgkmcnt(0)
  s_barrier
  ds_read_b64 v[52:53], v77 offset:392
  v_add_f32 v20, v20, v22
  v_smfmac_f32_16x16x64_bf16 v[24:27], v[0:3], a[152:159], v74
  v_add_f32 v21, v21, v23
  v_smfmac_f32_16x16x64_bf16 v[24:27], v[12:15], a[168:175], v74
  v_cvt_pk_bf16_f32 v54, v20, v21
  s_add_u32 s68, s68, 655360
  s_nop 3
  v_add_f32 v24, v24, v26
  v_add_f32 v25, v25, v27
  v_cvt_pk_bf16_f32 v55, v24, v25
  s_waitcnt lgkmcnt(0)
  buffer_store_dwordx4 v[52:55], v76, s[8:11], s68 offen sc1
  s_branch Cs3_done
Cs3_lastp:
  s_add_u32 s72, s72, 2
  s_cmp_ge_u32 s72, 131072
  s_cbranch_scc1 Cs3_lastg
  s_barrier
  buffer_load_dwordx4 v76, s[8:11], s85 offen offset:0 sc1 lds
  buffer_load_dwordx4 v76, s[8:11], s85 offen offset:1024 sc1 lds
  s_waitcnt vmcnt(0)
  s_barrier
  s_branch Cs3_lastr
Cs3_done:
  s_branch L_cexit
L_conf:
  s_waitcnt vmcnt(0) lgkmcnt(0)
  s_barrier
  s_cmp_eq_u32 s52, 0
  s_cbranch_scc0 L_cf2
  s_mov_b64 exec, 1
  s_lshl_b32 s57, s2, 2
  v_mov_b32 v1, 0
L_cf0:
  s_cmp_eq_u32 s54, -1
  s_cbranch_scc1 L_cf1
  s_mov_b32 s55, s54
  s_lshr_b64 s[54:55], s[54:55], s0
  s_ff0_i32_b32 s56, s54
  s_add_u32 s0, s0, s56
  s_and_b32 s0, s0, 31
  s_lshl_b32 s56, 1, s0
  v_mov_b32 v35, s56
  buffer_atomic_or v35, v1, s[12:15], s57 offen sc0
  s_waitcnt vmcnt(0)
  v_readfirstlane_b32 s54, v35
  s_nop 0
  s_bitcmp1_b32 s54, s0
  s_cbranch_scc1 L_cf0
  v_mov_b32 v35, s0
  s_branch L_cf3
L_cf1:
  v_mov_b32 v35, 1
  buffer_atomic_add v35, v1, s[12:15], 0 offen offset:40 sc0
  s_waitcnt vmcnt(0)
  v_add_u32 v35, 32, v35
L_cf3:
  ds_write_b32 v33, v35
  s_mov_b64 exec, -1
  s_waitcnt lgkmcnt(0)
L_cf2:
  s_barrier
  ds_read_b32 v32, v33
  s_waitcnt lgkmcnt(0)
  v_readfirstlane_b32 s0, v32
  s_mov_b32 s1, 1
  s_cmp_lt_u32 s0, 32
  s_cbranch_scc1 L_role
  s_sub_u32 s53, s0, 32
  s_mov_b32 s57, 0
L_sur:
  s_load_dwordx16 s[60:75], s[12:13], 0 glc
  s_add_u32 s57, s57, 1
  s_waitcnt lgkmcnt(0)
  s_mov_b32 s55, s70
  s_bcnt1_i32_b32 s56, s60
  s_add_u32 s55, s55, s56
  s_bcnt1_i32_b32 s56, s61
  s_add_u32 s55, s55, s56
  s_bcnt1_i32_b32 s56, s62
  s_add_u32 s55, s55, s56
  s_bcnt1_i32_b32 s56, s63
  s_add_u32 s55, s55, s56
  s_bcnt1_i32_b32 s56, s64
  s_add_u32 s55, s55, s56
  s_bcnt1_i32_b32 s56, s65
  s_add_u32 s55, s55, s56
  s_bcnt1_i32_b32 s56, s66
  s_add_u32 s55, s55, s56
  s_bcnt1_i32_b32 s56, s67
  s_add_u32 s55, s55, s56
  s_cmp_ge_u32 s57, 131072
  s_cbranch_scc1 L_end
  s_cmp_lt_u32 s55, 256
  s_cbranch_scc1 L_sur
  s_mov_b32 s2, 0
  s_mov_b32 s54, s60
  s_bcnt0_i32_b32 s56, s54
  s_cmp_lt_u32 s53, s56
  s_cbranch_scc1 L_sur2
  s_sub_u32 s53, s53, s56
  s_mov_b32 s2, 1
  s_mov_b32 s54, s61
  s_bcnt0_i32_b32 s56, s54
  s_cmp_lt_u32 s53, s56
  s_cbranch_scc1 L_sur2
  s_sub_u32 s53, s53, s56
  s_mov_b32 s2, 2
  s_mov_b32 s54, s62
  s_bcnt0_i32_b32 s56, s54
  s_cmp_lt_u32 s53, s56
  s_cbranch_scc1 L_sur2
  s_sub_u32 s53, s53, s56
  s_mov_b32 s2, 3
  s_mov_b32 s54, s63
  s_bcnt0_i32_b32 s56, s54
  s_cmp_lt_u32 s53, s56
  s_cbranch_scc1 L_sur2
  s_sub_u32 s53, s53, s56
  s_mov_b32 s2, 4
  s_mov_b32 s54, s64
  s_bcnt0_i32_b32 s56, s54
  s_cmp_lt_u32 s53, s56
  s_cbranch_scc1 L_sur2
  s_sub_u32 s53, s53, s56
  s_mov_b32 s2, 5
  s_mov_b32 s54, s65
  s_bcnt0_i32_b32 s56, s54
  s_cmp_lt_u32 s53, s56
  s_cbranch_scc1 L_sur2
  s_sub_u32 s53, s53, s56
  s_mov_b32 s2, 6
  s_mov_b32 s54, s66
  s_bcnt0_i32_b32 s56, s54
  s_cmp_lt_u32 s53, s56
  s_cbranch_scc1 L_sur2
  s_sub_u32 s53, s53, s56
  s_mov_b32 s2, 7
  s_mov_b32 s54, s67
  s_bcnt0_i32_b32 s56, s54
  s_cmp_lt_u32 s53, s56
  s_cbranch_scc1 L_sur2
  s_sub_u32 s53, s53, s56
  s_branch L_end
L_sur2:
  s_ff0_i32_b32 s0, s54
  s_bitset1_b32 s54, s0
  s_sub_u32 s53, s53, 1
  s_cbranch_scc0 L_sur2
  s_branch L_role
L_worker:
  s_lshl_b32 s54, s2, 2
  s_lshr_b32 s54, 1412567136, s54
  s_and_b32 s54, s54, 7
  s_lshl_b32 s54, s54, 5
  s_add_u32 s53, s53, s54
  s_getpc_b64 s[80:81]
L_pc_2:
  s_and_b32 s55, s0, 1
  s_lshl_b32 s55, s55, 2
  s_add_u32 s55, s55, s52
  s_lshl_b32 s55, s55, 13
  v_and_b32 v199, 63, v0
  v_lshl_add_u32 v199, v199, 7, s55
  s_sub_u32 s82, s80, (L_pc_2 - L_w0)
  s_subb_u32 s83, s81, 0
  v_min_u32 v198, (L_w4 - L_w0), v199
  global_load_dword v196, v198, s[82:83]
  v_min_u32 v199, (L_end - L_pc_2), v199
  global_load_dword v196, v199, s[80:81]
  v_and_b32 v200, 63, v0
  v_lshlrev_b32 v201, 4, v200
  v_lshrrev_b32 v211, 3, v200
  s_lshl_b32 s54, s52, 3
  v_add_u32 v211, s54, v211
  v_bfe_u32 v212, v211, 1, 3
  v_and_b32 v213, 7, v200
  v_xor_b32 v212, v212, v213
  v_mul_u32_u24 v211, 1152, v211
  v_lshl_add_u32 v202, v212, 4, v211
  s_mul_i32 s67, s52, 9216
  v_and_b32 v211, 31, v200
  v_lshrrev_b32 v212, 3, v211
  v_mul_u32_u24 v212, 9216, v212
  v_and_b32 v213, 7, v211
  v_lshl_add_u32 v212, v213, 7, v212
  v_bfe_u32 v213, v211, 1, 3
  v_lshrrev_b32 v214, 5, v200
  v_xor_b32 v213, v213, v214
  v_lshl_add_u32 v203, v213, 4, v212
  v_xor_b32 v204, 32, v203
  v_xor_b32 v205, 64, v203
  v_xor_b32 v206, 0x60, v203
  v_bfe_u32 v211, v200, 2, 2
  v_lshl_add_u32 v212, v214, 3, v211
  v_lshlrev_b32 v212, 8, v212
  v_xor_b32 v211, s52, v211
  v_lshl_add_u32 v212, v211, 6, v212
  v_bfe_u32 v213, v200, 4, 1
  v_and_b32 v211, 3, v200
  v_lshl_add_u32 v210, v213, 5, v212
  v_lshl_add_u32 v210, v211, 3, v210
  v_lshl_add_u32 v209, v213, 4, v212
  v_and_b32 v213, 1, v211
  v_lshl_add_u32 v209, v213, 3, v209
  v_lshrrev_b32 v213, 1, v211
  v_lshl_add_u32 v209, v213, 5, v209
  s_mov_b32 s65, 0
  s_mul_i32 s58, s53, 9363
  s_lshr_b32 s58, s58, 16
  s_mul_i32 s54, s58, 7
  s_sub_u32 s59, s53, s54
  s_mul_i32 s60, s59, 36864
  s_add_u32 m0, s67, 0
  s_nop 0
  buffer_load_dwordx4 v202, s[4:7], s60 offen offset:0 lds
  s_add_u32 m0, s67, 896
  s_nop 0
  buffer_load_dwordx4 v202, s[4:7], s60 offen offset:128 lds
  s_add_u32 m0, s67, 1792
  s_nop 0
  buffer_load_dwordx4 v202, s[4:7], s60 offen offset:256 lds
  s_add_u32 m0, s67, 2688
  s_nop 0
  buffer_load_dwordx4 v202, s[4:7], s60 offen offset:384 lds
  s_add_u32 m0, s67, 3584
  s_nop 0
  buffer_load_dwordx4 v202, s[4:7], s60 offen offset:512 lds
  s_add_u32 m0, s67, 4480
  s_nop 0
  buffer_load_dwordx4 v202, s[4:7], s60 offen offset:640 lds
  s_add_u32 m0, s67, 5376
  s_nop 0
  buffer_load_dwordx4 v202, s[4:7], s60 offen offset:768 lds
  s_add_u32 m0, s67, 6272
  s_nop 0
  buffer_load_dwordx4 v202, s[4:7], s60 offen offset:896 lds
  s_add_u32 m0, s67, 7168
  s_nop 0
  buffer_load_dwordx4 v202, s[4:7], s60 offen offset:1024 lds
  v_lshrrev_b32 v211, 4, v200
  v_lshlrev_b32 v212, 2, v211
  v_and_b32 v213, 15, v200
  v_xor_b32 v212, v212, v213
  v_lshlrev_b32 v212, 4, v212
  v_lshl_add_u32 v207, v211, 13, v212
  s_lshl_b32 s62, s58, 8
  s_lshl_b32 s54, s52, 15
  s_add_u32 s62, s62, s54
  s_lshl_b32 s61, s52, 10
  s_add_u32 s61, s61, 36864
  s_add_u32 m0, s61, 0
  s_add_u32 s54, s62, 0
  buffer_load_dwordx4 v207, s[20:23], s54 offen lds
  s_add_u32 m0, s61, 4096
  s_add_u32 s54, s62, 131072
  buffer_load_dwordx4 v207, s[20:23], s54 offen lds
  s_add_u32 m0, s61, 8192
  s_add_u32 s54, s62, 262144
  buffer_load_dwordx4 v207, s[20:23], s54 offen lds
  s_add_u32 m0, s61, 12288
  s_add_u32 s54, s62, 393216
  buffer_load_dwordx4 v207, s[20:23], s54 offen lds
  s_add_u32 m0, s61, 16384
  s_add_u32 s54, s62, 0
  buffer_load_dwordx4 v207, s[24:27], s54 offen lds
  s_add_u32 m0, s61, 20480
  s_add_u32 s54, s62, 131072
  buffer_load_dwordx4 v207, s[24:27], s54 offen lds
  s_add_u32 m0, s61, 24576
  s_add_u32 s54, s62, 262144
  buffer_load_dwordx4 v207, s[24:27], s54 offen lds
  s_add_u32 m0, s61, 28672
  s_add_u32 s54, s62, 393216
  buffer_load_dwordx4 v207, s[24:27], s54 offen lds
  s_add_u32 m0, s61, 32768
  s_add_u32 s54, s62, 524288
  buffer_load_dwordx4 v207, s[20:23], s54 offen lds
  s_add_u32 m0, s61, 36864
  s_add_u32 s54, s62, 655360
  buffer_load_dwordx4 v207, s[20:23], s54 offen lds
  s_add_u32 m0, s61, 40960
  s_add_u32 s54, s62, 786432
  buffer_load_dwordx4 v207, s[20:23], s54 offen lds
  s_add_u32 m0, s61, 45056
  s_add_u32 s54, s62, 917504
  buffer_load_dwordx4 v207, s[20:23], s54 offen lds
  s_add_u32 m0, s61, 49152
  s_add_u32 s54, s62, 524288
  buffer_load_dwordx4 v207, s[24:27], s54 offen lds
  s_add_u32 m0, s61, 53248
  s_add_u32 s54, s62, 655360
  buffer_load_dwordx4 v207, s[24:27], s54 offen lds
  s_add_u32 m0, s61, 57344
  s_add_u32 s54, s62, 786432
  buffer_load_dwordx4 v207, s[24:27], s54 offen lds
  s_add_u32 m0, s61, 61440
  s_add_u32 s54, s62, 917504
  buffer_load_dwordx4 v207, s[24:27], s54 offen lds
  s_add_u32 m0, s61, 65536
  s_add_u32 s54, s62, 1048576
  buffer_load_dwordx4 v207, s[20:23], s54 offen lds
  s_add_u32 m0, s61, 69632
  s_add_u32 s54, s62, 1179648
  buffer_load_dwordx4 v207, s[20:23], s54 offen lds
  s_add_u32 m0, s61, 73728
  s_add_u32 s54, s62, 1310720
  buffer_load_dwordx4 v207, s[20:23], s54 offen lds
  s_add_u32 m0, s61, 77824
  s_add_u32 s54, s62, 1441792
  buffer_load_dwordx4 v207, s[20:23], s54 offen lds
  s_add_u32 m0, s61, 81920
  s_add_u32 s54, s62, 1048576
  buffer_load_dwordx4 v207, s[24:27], s54 offen lds
  s_add_u32 m0, s61, 86016
  s_add_u32 s54, s62, 1179648
  buffer_load_dwordx4 v207, s[24:27], s54 offen lds
  s_add_u32 m0, s61, 90112
  s_add_u32 s54, s62, 1310720
  buffer_load_dwordx4 v207, s[24:27], s54 offen lds
  s_add_u32 m0, s61, 94208
  s_add_u32 s54, s62, 1441792
  buffer_load_dwordx4 v207, s[24:27], s54 offen lds
  v_bfe_u32 v211, v200, 3, 2
  v_lshlrev_b32 v216, 11, v211
  v_bfe_u32 v211, v200, 1, 2
  v_lshl_add_u32 v216, v211, 6, v216
  v_lshrrev_b32 v212, 5, v200
  v_lshl_add_u32 v216, v212, 5, v216
  v_and_b32 v211, 1, v200
  v_lshl_add_u32 v216, v211, 4, v216
  v_bfe_u32 v211, v200, 4, 1
  v_lshlrev_b32 v217, 10, v211
  v_lshl_add_u32 v217, v212, 9, v217
  v_and_b32 v211, 15, v200
  v_lshl_add_u32 v217, v211, 4, v217
  s_lshl_b32 s54, s52, 11
  s_add_u32 s54, s54, 8192
  v_add_u32 v217, s54, v217
  s_cmp_eq_u32 s1, 1
  s_cbranch_scc1 W_ver_ok
  v_mov_b32 v33, 163832
  s_cmp_eq_u32 s52, 0
  s_cbranch_scc0 W_ver_b
  s_waitcnt vmcnt(35)
  s_mov_b64 exec, 1
  ds_write_b32 v33, v35
  s_mov_b64 exec, -1
  s_waitcnt lgkmcnt(0)
W_ver_b:
  s_barrier
  ds_read_b32 v32, v33
  s_waitcnt lgkmcnt(0)
  v_readfirstlane_b32 s54, v32
  s_nop 0
  s_bitcmp1_b32 s54, s0
  s_cbranch_scc1 L_conf
W_ver_ok:
  s_waitcnt vmcnt(20) lgkmcnt(0)
  s_barrier
  s_add_u32 m0, s61, 98304
  s_add_u32 s54, s62, 1572864
  buffer_load_dwordx4 v207, s[20:23], s54 offen lds
  s_add_u32 m0, s61, 102400
  s_add_u32 s54, s62, 1703936
  buffer_load_dwordx4 v207, s[20:23], s54 offen lds
  s_add_u32 m0, s61, 106496
  s_add_u32 s54, s62, 1835008
  buffer_load_dwordx4 v207, s[20:23], s54 offen lds
  s_add_u32 m0, s61, 110592
  s_add_u32 s54, s62, 1966080
  buffer_load_dwordx4 v207, s[20:23], s54 offen lds
  v_add_u32 v215, 36864, v209
  ds_read_b64_tr_b16 a[0:1], v215 offset:0
  ds_read_b64_tr_b16 a[2:3], v215 offset:1024
  ds_read_b64_tr_b16 a[4:5], v215 offset:4096
  ds_read_b64_tr_b16 a[6:7], v215 offset:5120
  ds_read_b64_tr_b16 a[8:9], v215 offset:8192
  ds_read_b64_tr_b16 a[10:11], v215 offset:9216
  ds_read_b64_tr_b16 a[12:13], v215 offset:12288
  ds_read_b64_tr_b16 a[14:15], v215 offset:13312
  s_waitcnt vmcnt(20) lgkmcnt(0)
  s_barrier
  s_add_u32 m0, s61, 0
  s_add_u32 s54, s62, 1572864
  buffer_load_dwordx4 v207, s[24:27], s54 offen lds
  s_add_u32 m0, s61, 4096
  s_add_u32 s54, s62, 1703936
  buffer_load_dwordx4 v207, s[24:27], s54 offen lds
  s_add_u32 m0, s61, 8192
  s_add_u32 s54, s62, 1835008
  buffer_load_dwordx4 v207, s[24:27], s54 offen lds
  s_add_u32 m0, s61, 12288
  s_add_u32 s54, s62, 1966080
  buffer_load_dwordx4 v207, s[24:27], s54 offen lds
  v_add_u32 v215, 53248, v210
  ds_read_b64_tr_b16 a[144:145], v215 offset:0
  ds_read_b64_tr_b16 a[146:147], v215 offset:1024
  ds_read_b64_tr_b16 a[148:149], v215 offset:4096
  ds_read_b64_tr_b16 a[150:151], v215 offset:5120
  ds_read_b64_tr_b16 a[152:153], v215 offset:8192
  ds_read_b64_tr_b16 a[154:155], v215 offset:9216
  ds_read_b64_tr_b16 a[156:157], v215 offset:12288
  ds_read_b64_tr_b16 a[158:159], v215 offset:13312
  s_waitcnt vmcnt(20) lgkmcnt(0)
  s_barrier
  s_add_u32 m0, s61, 16384
  s_add_u32 s54, s62, 2097152
  buffer_load_dwordx4 v207, s[20:23], s54 offen lds
  s_add_u32 m0, s61, 20480
  s_add_u32 s54, s62, 2228224
  buffer_load_dwordx4 v207, s[20:23], s54 offen lds
  s_add_u32 m0, s61, 24576
  s_add_u32 s54, s62, 2359296
  buffer_load_dwordx4 v207, s[20:23], s54 offen lds
  s_add_u32 m0, s61, 28672
  s_add_u32 s54, s62, 2490368
  buffer_load_dwordx4 v207, s[20:23], s54 offen lds
  v_add_u32 v215, 69632, v209
  ds_read_b64_tr_b16 a[16:17], v215 offset:0
  ds_read_b64_tr_b16 a[18:19], v215 offset:1024
  ds_read_b64_tr_b16 a[20:21], v215 offset:4096
  ds_read_b64_tr_b16 a[22:23], v215 offset:5120
  ds_read_b64_tr_b16 a[24:25], v215 offset:8192
  ds_read_b64_tr_b16 a[26:27], v215 offset:9216
  ds_read_b64_tr_b16 a[28:29], v215 offset:12288
  ds_read_b64_tr_b16 a[30:31], v215 offset:13312
  s_waitcnt vmcnt(20) lgkmcnt(0)
  s_barrier
  s_add_u32 m0, s61, 32768
  s_add_u32 s54, s62, 2097152
  buffer_load_dwordx4 v207, s[24:27], s54 offen lds
  s_add_u32 m0, s61, 36864
  s_add_u32 s54, s62, 2228224
  buffer_load_dwordx4 v207, s[24:27], s54 offen lds
  s_add_u32 m0, s61, 40960
  s_add_u32 s54, s62, 2359296
  buffer_load_dwordx4 v207, s[24:27], s54 offen lds
  s_add_u32 m0, s61, 45056
  s_add_u32 s54, s62, 2490368
  buffer_load_dwordx4 v207, s[24:27], s54 offen lds
  v_add_u32 v215, 86016, v210
  ds_read_b64_tr_b16 a[160:161], v215 offset:0
  ds_read_b64_tr_b16 a[162:163], v215 offset:1024
  ds_read_b64_tr_b16 a[164:165], v215 offset:4096
  ds_read_b64_tr_b16 a[166:167], v215 offset:5120
  ds_read_b64_tr_b16 a[168:169], v215 offset:8192
  ds_read_b64_tr_b16 a[170:171], v215 offset:9216
  ds_read_b64_tr_b16 a[172:173], v215 offset:12288
  ds_read_b64_tr_b16 a[174:175], v215 offset:13312
  s_waitcnt vmcnt(20) lgkmcnt(0)
  s_barrier
  s_add_u32 m0, s61, 49152
  s_add_u32 s54, s62, 2621440
  buffer_load_dwordx4 v207, s[20:23], s54 offen lds
  s_add_u32 m0, s61, 53248
  s_add_u32 s54, s62, 2752512
  buffer_load_dwordx4 v207, s[20:23], s54 offen lds
  s_add_u32 m0, s61, 57344
  s_add_u32 s54, s62, 2883584
  buffer_load_dwordx4 v207, s[20:23], s54 offen lds
  s_add_u32 m0, s61, 61440
  s_add_u32 s54, s62, 3014656
  buffer_load_dwordx4 v207, s[20:23], s54 offen lds
  v_add_u32 v215, 102400, v209
  ds_read_b64_tr_b16 a[32:33], v215 offset:0
  ds_read_b64_tr_b16 a[34:35], v215 offset:1024
  ds_read_b64_tr_b16 a[36:37], v215 offset:4096
  ds_read_b64_tr_b16 a[38:39], v215 offset:5120
  ds_read_b64_tr_b16 a[40:41], v215 offset:8192
  ds_read_b64_tr_b16 a[42:43], v215 offset:9216
  ds_read_b64_tr_b16 a[44:45], v215 offset:12288
  ds_read_b64_tr_b16 a[46:47], v215 offset:13312
  s_waitcnt vmcnt(20) lgkmcnt(0)
  s_barrier
  s_add_u32 m0, s61, 65536
  s_add_u32 s54, s62, 2621440
  buffer_load_dwordx4 v207, s[24:27], s54 offen lds
  s_add_u32 m0, s61, 69632
  s_add_u32 s54, s62, 2752512
  buffer_load_dwordx4 v207, s[24:27], s54 offen lds
  s_add_u32 m0, s61, 73728
  s_add_u32 s54, s62, 2883584
  buffer_load_dwordx4 v207, s[24:27], s54 offen lds
  s_add_u32 m0, s61, 77824
  s_add_u32 s54, s62, 3014656
  buffer_load_dwordx4 v207, s[24:27], s54 offen lds
  v_add_u32 v215, 118784, v210
  ds_read_b64_tr_b16 a[176:177], v215 offset:0
  ds_read_b64_tr_b16 a[178:179], v215 offset:1024
  ds_read_b64_tr_b16 a[180:181], v215 offset:4096
  ds_read_b64_tr_b16 a[182:183], v215 offset:5120
  ds_read_b64_tr_b16 a[184:185], v215 offset:8192
  ds_read_b64_tr_b16 a[186:187], v215 offset:9216
  ds_read_b64_tr_b16 a[188:189], v215 offset:12288
  ds_read_b64_tr_b16 a[190:191], v215 offset:13312
  s_waitcnt vmcnt(20) lgkmcnt(0)
  s_barrier
  s_add_u32 m0, s61, 81920
  s_add_u32 s54, s62, 3145728
  buffer_load_dwordx4 v207, s[20:23], s54 offen lds
  s_add_u32 m0, s61, 86016
  s_add_u32 s54, s62, 3276800
  buffer_load_dwordx4 v207, s[20:23], s54 offen lds
  s_add_u32 m0, s61, 90112
  s_add_u32 s54, s62, 3407872
  buffer_load_dwordx4 v207, s[20:23], s54 offen lds
  s_add_u32 m0, s61, 94208
  s_add_u32 s54, s62, 3538944
  buffer_load_dwordx4 v207, s[20:23], s54 offen lds
  v_add_u32 v215, 135168, v209
  ds_read_b64_tr_b16 a[48:49], v215 offset:0
  ds_read_b64_tr_b16 a[50:51], v215 offset:1024
  ds_read_b64_tr_b16 a[52:53], v215 offset:4096
  ds_read_b64_tr_b16 a[54:55], v215 offset:5120
  ds_read_b64_tr_b16 a[56:57], v215 offset:8192
  ds_read_b64_tr_b16 a[58:59], v215 offset:9216
  ds_read_b64_tr_b16 a[60:61], v215 offset:12288
  ds_read_b64_tr_b16 a[62:63], v215 offset:13312
  s_waitcnt vmcnt(20) lgkmcnt(0)
  s_barrier
  s_add_u32 m0, s61, 98304
  s_add_u32 s54, s62, 3145728
  buffer_load_dwordx4 v207, s[24:27], s54 offen lds
  s_add_u32 m0, s61, 102400
  s_add_u32 s54, s62, 3276800
  buffer_load_dwordx4 v207, s[24:27], s54 offen lds
  s_add_u32 m0, s61, 106496
  s_add_u32 s54, s62, 3407872
  buffer_load_dwordx4 v207, s[24:27], s54 offen lds
  s_add_u32 m0, s61, 110592
  s_add_u32 s54, s62, 3538944
  buffer_load_dwordx4 v207, s[24:27], s54 offen lds
  v_add_u32 v215, 36864, v210
  ds_read_b64_tr_b16 a[192:193], v215 offset:0
  ds_read_b64_tr_b16 a[194:195], v215 offset:1024
  ds_read_b64_tr_b16 a[196:197], v215 offset:4096
  ds_read_b64_tr_b16 a[198:199], v215 offset:5120
  ds_read_b64_tr_b16 a[200:201], v215 offset:8192
  ds_read_b64_tr_b16 a[202:203], v215 offset:9216
  ds_read_b64_tr_b16 a[204:205], v215 offset:12288
  ds_read_b64_tr_b16 a[206:207], v215 offset:13312
  s_waitcnt vmcnt(20) lgkmcnt(0)
  s_barrier
  s_add_u32 m0, s61, 0
  s_add_u32 s54, s62, 3670016
  buffer_load_dwordx4 v207, s[20:23], s54 offen lds
  s_add_u32 m0, s61, 4096
  s_add_u32 s54, s62, 3801088
  buffer_load_dwordx4 v207, s[20:23], s54 offen lds
  s_add_u32 m0, s61, 8192
  s_add_u32 s54, s62, 3932160
  buffer_load_dwordx4 v207, s[20:23], s54 offen lds
  s_add_u32 m0, s61, 12288
  s_add_u32 s54, s62, 4063232
  buffer_load_dwordx4 v207, s[20:23], s54 offen lds
  v_add_u32 v215, 53248, v209
  ds_read_b64_tr_b16 a[64:65], v215 offset:0
  ds_read_b64_tr_b16 a[66:67], v215 offset:1024
  ds_read_b64_tr_b16 a[68:69], v215 offset:4096
  ds_read_b64_tr_b16 a[70:71], v215 offset:5120
  ds_read_b64_tr_b16 a[72:73], v215 offset:8192
  ds_read_b64_tr_b16 a[74:75], v215 offset:9216
  ds_read_b64_tr_b16 a[76:77], v215 offset:12288
  ds_read_b64_tr_b16 a[78:79], v215 offset:13312
  s_waitcnt vmcnt(20) lgkmcnt(0)
  s_barrier
  s_add_u32 m0, s61, 16384
  s_add_u32 s54, s62, 3670016
  buffer_load_dwordx4 v207, s[24:27], s54 offen lds
  s_add_u32 m0, s61, 20480
  s_add_u32 s54, s62, 3801088
  buffer_load_dwordx4 v207, s[24:27], s54 offen lds
  s_add_u32 m0, s61, 24576
  s_add_u32 s54, s62, 3932160
  buffer_load_dwordx4 v207, s[24:27], s54 offen lds
  s_add_u32 m0, s61, 28672
  s_add_u32 s54, s62, 4063232
  buffer_load_dwordx4 v207, s[24:27], s54 offen lds
  v_add_u32 v215, 69632, v210
  ds_read_b64_tr_b16 a[208:209], v215 offset:0
  ds_read_b64_tr_b16 a[210:211], v215 offset:1024
  ds_read_b64_tr_b16 a[212:213], v215 offset:4096
  ds_read_b64_tr_b16 a[214:215], v215 offset:5120
  ds_read_b64_tr_b16 a[216:217], v215 offset:8192
  ds_read_b64_tr_b16 a[218:219], v215 offset:9216
  ds_read_b64_tr_b16 a[220:221], v215 offset:12288
  ds_read_b64_tr_b16 a[222:223], v215 offset:13312
  s_waitcnt vmcnt(20) lgkmcnt(0)
  s_barrier
  s_add_u32 m0, s61, 32768
  s_add_u32 s54, s62, 4194304
  buffer_load_dwordx4 v207, s[20:23], s54 offen lds
  s_add_u32 m0, s61, 36864
  s_add_u32 s54, s62, 4325376
  buffer_load_dwordx4 v207, s[20:23], s54 offen lds
  s_add_u32 m0, s61, 40960
  s_add_u32 s54, s62, 4456448
  buffer_load_dwordx4 v207, s[20:23], s54 offen lds
  s_add_u32 m0, s61, 45056
  s_add_u32 s54, s62, 4587520
  buffer_load_dwordx4 v207, s[20:23], s54 offen lds
  v_add_u32 v215, 86016, v209
  ds_read_b64_tr_b16 a[80:81], v215 offset:0
  ds_read_b64_tr_b16 a[82:83], v215 offset:1024
  ds_read_b64_tr_b16 a[84:85], v215 offset:4096
  ds_read_b64_tr_b16 a[86:87], v215 offset:5120
  ds_read_b64_tr_b16 a[88:89], v215 offset:8192
  ds_read_b64_tr_b16 a[90:91], v215 offset:9216
  ds_read_b64_tr_b16 a[92:93], v215 offset:12288
  ds_read_b64_tr_b16 a[94:95], v215 offset:13312
  s_waitcnt vmcnt(20) lgkmcnt(0)
  s_barrier
  s_add_u32 m0, s61, 49152
  s_add_u32 s54, s62, 4194304
  buffer_load_dwordx4 v207, s[24:27], s54 offen lds
  s_add_u32 m0, s61, 53248
  s_add_u32 s54, s62, 4325376
  buffer_load_dwordx4 v207, s[24:27], s54 offen lds
  s_add_u32 m0, s61, 57344
  s_add_u32 s54, s62, 4456448
  buffer_load_dwordx4 v207, s[24:27], s54 offen lds
  s_add_u32 m0, s61, 61440
  s_add_u32 s54, s62, 4587520
  buffer_load_dwordx4 v207, s[24:27], s54 offen lds
  s_mul_i32 s54, s53, 21120
  s_lshl_b32 s55, s52, 13
  s_add_u32 s54, s54, s55
  s_cmp_eq_u32 s52, 3
  s_cselect_b32 s54, 0x10000000, s54
  v_lshlrev_b32 v211, 3, v201
  buffer_load_dword v196, v211, s[28:31], s54 offen
  v_add_u32 v215, 102400, v210
  ds_read_b64_tr_b16 a[224:225], v215 offset:0
  ds_read_b64_tr_b16 a[226:227], v215 offset:1024
  ds_read_b64_tr_b16 a[228:229], v215 offset:4096
  ds_read_b64_tr_b16 a[230:231], v215 offset:5120
  ds_read_b64_tr_b16 a[232:233], v215 offset:8192
  ds_read_b64_tr_b16 a[234:235], v215 offset:9216
  ds_read_b64_tr_b16 a[236:237], v215 offset:12288
  ds_read_b64_tr_b16 a[238:239], v215 offset:13312
  s_waitcnt vmcnt(21) lgkmcnt(0)
  s_barrier
  s_lshl_b32 s54, s53, 13
  s_lshr_b32 s55, s53, 6
  s_or_b32 s55, s55, s52
  s_cmp_eq_u32 s55, 0
  s_cselect_b32 s54, s54, 0x10000000
  v_lshlrev_b32 v211, 3, v201
  buffer_load_dword v196, v211, s[16:19], s54 offen
  v_add_u32 v215, 118784, v209
  ds_read_b64_tr_b16 a[96:97], v215 offset:0
  ds_read_b64_tr_b16 a[98:99], v215 offset:1024
  ds_read_b64_tr_b16 a[100:101], v215 offset:4096
  ds_read_b64_tr_b16 a[102:103], v215 offset:5120
  ds_read_b64_tr_b16 a[104:105], v215 offset:8192
  ds_read_b64_tr_b16 a[106:107], v215 offset:9216
  ds_read_b64_tr_b16 a[108:109], v215 offset:12288
  ds_read_b64_tr_b16 a[110:111], v215 offset:13312
  s_waitcnt vmcnt(18) lgkmcnt(0)
  s_barrier
  v_add_u32 v215, 135168, v210
  ds_read_b64_tr_b16 a[240:241], v215 offset:0
  ds_read_b64_tr_b16 a[242:243], v215 offset:1024
  ds_read_b64_tr_b16 a[244:245], v215 offset:4096
  ds_read_b64_tr_b16 a[246:247], v215 offset:5120
  ds_read_b64_tr_b16 a[248:249], v215 offset:8192
  ds_read_b64_tr_b16 a[250:251], v215 offset:9216
  ds_read_b64_tr_b16 a[252:253], v215 offset:12288
  ds_read_b64_tr_b16 a[254:255], v215 offset:13312
  s_waitcnt vmcnt(14) lgkmcnt(0)
  s_barrier
  v_add_u32 v215, 36864, v209
  ds_read_b64_tr_b16 a[112:113], v215 offset:0
  ds_read_b64_tr_b16 a[114:115], v215 offset:1024
  ds_read_b64_tr_b16 a[116:117], v215 offset:4096
  ds_read_b64_tr_b16 a[118:119], v215 offset:5120
  ds_read_b64_tr_b16 a[120:121], v215 offset:8192
  ds_read_b64_tr_b16 a[122:123], v215 offset:9216
  ds_read_b64_tr_b16 a[124:125], v215 offset:12288
  ds_read_b64_tr_b16 a[126:127], v215 offset:13312
  s_waitcnt vmcnt(10) lgkmcnt(0)
  s_barrier
  v_add_u32 v215, 53248, v210
  ds_read_b64_tr_b16 v[224:225], v215 offset:0
  ds_read_b64_tr_b16 v[226:227], v215 offset:1024
  ds_read_b64_tr_b16 v[228:229], v215 offset:4096
  ds_read_b64_tr_b16 v[230:231], v215 offset:5120
  ds_read_b64_tr_b16 v[232:233], v215 offset:8192
  ds_read_b64_tr_b16 v[234:235], v215 offset:9216
  ds_read_b64_tr_b16 v[236:237], v215 offset:12288
  ds_read_b64_tr_b16 v[238:239], v215 offset:13312
  s_waitcnt vmcnt(6) lgkmcnt(0)
  s_barrier
  v_add_u32 v215, 69632, v209
  ds_read_b64_tr_b16 a[128:129], v215 offset:0
  ds_read_b64_tr_b16 a[130:131], v215 offset:1024
  ds_read_b64_tr_b16 a[132:133], v215 offset:4096
  ds_read_b64_tr_b16 a[134:135], v215 offset:5120
  ds_read_b64_tr_b16 a[136:137], v215 offset:8192
  ds_read_b64_tr_b16 a[138:139], v215 offset:9216
  ds_read_b64_tr_b16 a[140:141], v215 offset:12288
  ds_read_b64_tr_b16 a[142:143], v215 offset:13312
  s_waitcnt vmcnt(2) lgkmcnt(0)
  s_barrier
  v_add_u32 v215, 86016, v210
  ds_read_b64_tr_b16 v[240:241], v215 offset:0
  ds_read_b64_tr_b16 v[242:243], v215 offset:1024
  ds_read_b64_tr_b16 v[244:245], v215 offset:4096
  ds_read_b64_tr_b16 v[246:247], v215 offset:5120
  ds_read_b64_tr_b16 v[248:249], v215 offset:8192
  ds_read_b64_tr_b16 v[250:251], v215 offset:9216
  ds_read_b64_tr_b16 v[252:253], v215 offset:12288
  ds_read_b64_tr_b16 v[254:255], v215 offset:13312
  s_waitcnt lgkmcnt(0)
  s_barrier
  s_lshr_b32 s55, s53, 1
  s_and_b32 s56, s53, 1
  s_lshl_b32 s56, s56, 7
  s_lshl_b32 s55, s55, 2
  s_add_u32 s55, s55, s56
  s_add_u32 s55, s55, 356352
  s_cmp_lt_u32 s53, 64
  s_cselect_b32 s71, s55, 268435456
  v_mov_b32 v211, 0
  s_mov_b64 exec, 1
  buffer_store_dword v211, v211, s[8:11], s71 offen sc1
  s_mov_b64 exec, -1
  s_mov_b32 s68, 1040356334
  s_lshl_b32 s69, s52, 9
  s_lshl_b32 s70, s58, 2
  s_add_u32 s70, s70, 128
  s_mul_i32 s66, s58, -12288
  s_lshl_b32 s54, s52, 10
  s_add_u32 s66, s66, s54
  s_add_u32 s66, s66, 524288
  v_mov_b32 v64, -1
  v_mov_b32 v65, -1
  v_mov_b32 v66, -1
  v_mov_b32 v67, -1
  s_cmp_eq_u32 s59, 0
  s_cbranch_scc0 KV_na
  s_mul_i32 s54, s58, 2176
  s_mul_i32 s55, s52, 69632
  s_add_u32 s55, s55, s54
  s_add_u32 s55, s55, 0
  s_add_u32 s54, s54, 278528
  s_and_b32 s56, s58, 7
  s_lshl_b32 s56, s56, 12
  s_bfe_u32 s57, s58, 0x10003
  s_lshl_b32 s57, s57, 11
  s_add_u32 s56, s56, s57
  s_add_u32 s54, s56, 262144
  s_lshr_b32 s57, s58, 4
  s_lshl_b32 s57, s57, 15
  s_add_u32 s56, s56, s57
  s_lshl_b32 s57, s52, 16
  s_add_u32 s56, s56, s57
  s_add_u32 s55, s56, 0
  s_lshl_b32 s56, s58, 14
  s_mul_i32 s57, s52, 3072
  s_add_u32 s56, s56, s57
  s_add_u32 s56, s56, 360448
  s_cmp_lt_u32 s58, 2
  s_cselect_b32 s56, s56, 268435456
  s_cmp_eq_u32 s52, 0
  s_cselect_b32 s54, s54, 268435456
  buffer_store_dwordx4 v[64:67], v201, s[8:11], s55 offen offset:0 sc1
  buffer_store_dwordx4 v[64:67], v201, s[8:11], s55 offen offset:1024 sc1
  buffer_store_dwordx4 v[64:67], v201, s[8:11], s54 offen offset:0 sc1
  buffer_store_dwordx4 v[64:67], v201, s[8:11], s54 offen offset:1024 sc1
  buffer_store_dwordx4 v[64:67], v201, s[8:11], s56 offen offset:0 sc1
  buffer_store_dwordx4 v[64:67], v201, s[8:11], s56 offen offset:1024 sc1
  buffer_store_dwordx4 v[64:67], v201, s[8:11], s56 offen offset:2048 sc1
KV_na:
  s_add_u32 s60, s60, 258048
  ds_read_b128 v[32:35], v203 offset:0
  ds_read_b128 v[36:39], v204 offset:0
  ds_read_b128 v[40:43], v205 offset:0
  s_waitcnt lgkmcnt(2)
  v_mfma_f32_32x32x16_bf16 v[0:15], a[0:3], v[32:35], 0
  ds_read_b128 v[44:47], v206 offset:0
  s_add_u32 m0, s67, 36864
  s_nop 0
  buffer_load_dwordx4 v202, s[4:7], s60 offen offset:0 lds
  v_mfma_f32_32x32x16_bf16 v[16:31], v[32:35], a[144:147], 0
  s_waitcnt lgkmcnt(2)
  v_mfma_f32_32x32x16_bf16 v[0:15], a[4:7], v[36:39], v[0:15]
  ds_read_b128 v[32:35], v203 offset:1024
  s_add_u32 m0, s67, 37760
  s_nop 0
  buffer_load_dwordx4 v202, s[4:7], s60 offen offset:128 lds
  v_mfma_f32_32x32x16_bf16 v[16:31], v[36:39], a[148:151], v[16:31]
  s_waitcnt lgkmcnt(2)
  v_mfma_f32_32x32x16_bf16 v[0:15], a[8:11], v[40:43], v[0:15]
  ds_read_b128 v[36:39], v204 offset:1024
  s_add_u32 m0, s67, 38656
  s_nop 0
  buffer_load_dwordx4 v202, s[4:7], s60 offen offset:256 lds
  v_mfma_f32_32x32x16_bf16 v[16:31], v[40:43], a[152:155], v[16:31]
  s_waitcnt lgkmcnt(2)
  v_mfma_f32_32x32x16_bf16 v[0:15], a[12:15], v[44:47], v[0:15]
  ds_read_b128 v[40:43], v205 offset:1024
  s_add_u32 m0, s67, 39552
  s_nop 0
  buffer_load_dwordx4 v202, s[4:7], s60 offen offset:384 lds
  v_mfma_f32_32x32x16_bf16 v[16:31], v[44:47], a[156:159], v[16:31]
  s_waitcnt lgkmcnt(2)
  v_mfma_f32_32x32x16_bf16 v[0:15], a[16:19], v[32:35], v[0:15]
  ds_read_b128 v[44:47], v206 offset:1024
  s_add_u32 m0, s67, 40448
  s_nop 0
  buffer_load_dwordx4 v202, s[4:7], s60 offen offset:512 lds
  v_mfma_f32_32x32x16_bf16 v[16:31], v[32:35], a[160:163], v[16:31]
  s_waitcnt lgkmcnt(2)
  v_mfma_f32_32x32x16_bf16 v[0:15], a[20:23], v[36:39], v[0:15]
  ds_read_b128 v[32:35], v203 offset:2048
  s_add_u32 m0, s67, 41344
  s_nop 0
  buffer_load_dwordx4 v202, s[4:7], s60 offen offset:640 lds
  v_mfma_f32_32x32x16_bf16 v[16:31], v[36:39], a[164:167], v[16:31]
  s_waitcnt lgkmcnt(2)
  v_mfma_f32_32x32x16_bf16 v[0:15], a[24:27], v[40:43], v[0:15]
  ds_read_b128 v[36:39], v204 offset:2048
  s_add_u32 m0, s67, 42240
  s_nop 0
  buffer_load_dwordx4 v202, s[4:7], s60 offen offset:768 lds
  v_mfma_f32_32x32x16_bf16 v[16:31], v[40:43], a[168:171], v[16:31]
  s_waitcnt lgkmcnt(2)
  v_mfma_f32_32x32x16_bf16 v[0:15], a[28:31], v[44:47], v[0:15]
  ds_read_b128 v[40:43], v205 offset:2048
  s_add_u32 m0, s67, 43136
  s_nop 0
  buffer_load_dwordx4 v202, s[4:7], s60 offen offset:896 lds
  v_mfma_f32_32x32x16_bf16 v[16:31], v[44:47], a[172:175], v[16:31]
  s_waitcnt lgkmcnt(2)
  v_mfma_f32_32x32x16_bf16 v[0:15], a[32:35], v[32:35], v[0:15]
  ds_read_b128 v[44:47], v206 offset:2048
  s_add_u32 m0, s67, 44032
  s_nop 0
  buffer_load_dwordx4 v202, s[4:7], s60 offen offset:1024 lds
  v_mfma_f32_32x32x16_bf16 v[16:31], v[32:35], a[176:179], v[16:31]
  s_waitcnt lgkmcnt(2)
  v_mfma_f32_32x32x16_bf16 v[0:15], a[36:39], v[36:39], v[0:15]
  ds_read_b128 v[32:35], v203 offset:3072
  v_mfma_f32_32x32x16_bf16 v[16:31], v[36:39], a[180:183], v[16:31]
  s_waitcnt lgkmcnt(2)
  v_mfma_f32_32x32x16_bf16 v[0:15], a[40:43], v[40:43], v[0:15]
  ds_read_b128 v[36:39], v204 offset:3072
  v_mfma_f32_32x32x16_bf16 v[16:31], v[40:43], a[184:187], v[16:31]
  s_waitcnt lgkmcnt(2)
  v_mfma_f32_32x32x16_bf16 v[0:15], a[44:47], v[44:47], v[0:15]
  ds_read_b128 v[40:43], v205 offset:3072
  v_mfma_f32_32x32x16_bf16 v[16:31], v[44:47], a[188:191], v[16:31]
  s_waitcnt lgkmcnt(2)
  v_mfma_f32_32x32x16_bf16 v[0:15], a[48:51], v[32:35], v[0:15]
  ds_read_b128 v[44:47], v206 offset:3072
  v_mfma_f32_32x32x16_bf16 v[16:31], v[32:35], a[192:195], v[16:31]
  s_waitcnt lgkmcnt(2)
  v_mfma_f32_32x32x16_bf16 v[0:15], a[52:55], v[36:39], v[0:15]
  ds_read_b128 v[32:35], v203 offset:4096
  v_mfma_f32_32x32x16_bf16 v[16:31], v[36:39], a[196:199], v[16:31]
  s_waitcnt lgkmcnt(2)
  v_mfma_f32_32x32x16_bf16 v[0:15], a[56:59], v[40:43], v[0:15]
  ds_read_b128 v[36:39], v204 offset:4096
  v_mfma_f32_32x32x16_bf16 v[16:31], v[40:43], a[200:203], v[16:31]
  s_waitcnt lgkmcnt(2)
  v_mfma_f32_32x32x16_bf16 v[0:15], a[60:63], v[44:47], v[0:15]
  ds_read_b128 v[40:43], v205 offset:4096
  v_mfma_f32_32x32x16_bf16 v[16:31], v[44:47], a[204:207], v[16:31]
  s_waitcnt lgkmcnt(2)
  v_mfma_f32_32x32x16_bf16 v[0:15], a[64:67], v[32:35], v[0:15]
  ds_read_b128 v[44:47], v206 offset:4096
  v_mfma_f32_32x32x16_bf16 v[16:31], v[32:35], a[208:211], v[16:31]
  s_waitcnt lgkmcnt(2)
  v_mfma_f32_32x32x16_bf16 v[0:15], a[68:71], v[36:39], v[0:15]
  ds_read_b128 v[32:35], v203 offset:5120
  v_mfma_f32_32x32x16_bf16 v[16:31], v[36:39], a[212:215], v[16:31]
  s_waitcnt lgkmcnt(2)
  v_mfma_f32_32x32x16_bf16 v[0:15], a[72:75], v[40:43], v[0:15]
  ds_read_b128 v[36:39], v204 offset:5120
  v_mfma_f32_32x32x16_bf16 v[16:31], v[40:43], a[216:219], v[16:31]
  s_waitcnt lgkmcnt(2)
  v_mfma_f32_32x32x16_bf16 v[0:15], a[76:79], v[44:47], v[0:15]
  ds_read_b128 v[40:43], v205 offset:5120
  v_mfma_f32_32x32x16_bf16 v[16:31], v[44:47], a[220:223], v[16:31]
  s_waitcnt lgkmcnt(2)
  v_mfma_f32_32x32x16_bf16 v[0:15], a[80:83], v[32:35], v[0:15]
  ds_read_b128 v[44:47], v206 offset:5120
  v_mfma_f32_32x32x16_bf16 v[16:31], v[32:35], a[224:227], v[16:31]
  s_waitcnt lgkmcnt(2)
  v_mfma_f32_32x32x16_bf16 v[0:15], a[84:87], v[36:39], v[0:15]
  ds_read_b128 v[32:35], v203 offset:6144
  v_mfma_f32_32x32x16_bf16 v[16:31], v[36:39], a[228:231], v[16:31]
  s_waitcnt lgkmcnt(2)
  v_mfma_f32_32x32x16_bf16 v[0:15], a[88:91], v[40:43], v[0:15]
  ds_read_b128 v[36:39], v204 offset:6144
  v_mfma_f32_32x32x16_bf16 v[16:31], v[40:43], a[232:235], v[16:31]
  s_waitcnt lgkmcnt(2)
  v_mfma_f32_32x32x16_bf16 v[0:15], a[92:95], v[44:47], v[0:15]
  ds_read_b128 v[40:43], v205 offset:6144
  v_mfma_f32_32x32x16_bf16 v[16:31], v[44:47], a[236:239], v[16:31]
  s_waitcnt lgkmcnt(2)
  v_mfma_f32_32x32x16_bf16 v[0:15], a[96:99], v[32:35], v[0:15]
  ds_read_b128 v[44:47], v206 offset:6144
  v_mfma_f32_32x32x16_bf16 v[16:31], v[32:35], a[240:243], v[16:31]
  s_waitcnt lgkmcnt(2)
  v_mfma_f32_32x32x16_bf16 v[0:15], a[100:103], v[36:39], v[0:15]
  ds_read_b128 v[32:35], v203 offset:7168
  v_mfma_f32_32x32x16_bf16 v[16:31], v[36:39], a[244:247], v[16:31]
  s_waitcnt lgkmcnt(2)
  v_mfma_f32_32x32x16_bf16 v[0:15], a[104:107], v[40:43], v[0:15]
  ds_read_b128 v[36:39], v204 offset:7168
  v_mfma_f32_32x32x16_bf16 v[16:31], v[40:43], a[248:251], v[16:31]
  s_waitcnt lgkmcnt(2)
  v_mfma_f32_32x32x16_bf16 v[0:15], a[108:111], v[44:47], v[0:15]
  ds_read_b128 v[40:43], v205 offset:7168
  v_mfma_f32_32x32x16_bf16 v[16:31], v[44:47], a[252:255], v[16:31]
  s_waitcnt lgkmcnt(2)
  v_mfma_f32_32x32x16_bf16 v[0:15], a[112:115], v[32:35], v[0:15]
  ds_read_b128 v[44:47], v206 offset:7168
  v_mfma_f32_32x32x16_bf16 v[16:31], v[32:35], v[224:227], v[16:31]
  s_waitcnt lgkmcnt(2)
  v_mfma_f32_32x32x16_bf16 v[0:15], a[116:119], v[36:39], v[0:15]
  ds_read_b128 v[32:35], v203 offset:8192
  v_mfma_f32_32x32x16_bf16 v[16:31], v[36:39], v[228:231], v[16:31]
  s_waitcnt lgkmcnt(2)
  v_mfma_f32_32x32x16_bf16 v[0:15], a[120:123], v[40:43], v[0:15]
  ds_read_b128 v[36:39], v204 offset:8192
  v_mfma_f32_32x32x16_bf16 v[16:31], v[40:43], v[232:235], v[16:31]
  s_waitcnt lgkmcnt(2)
  v_mfma_f32_32x32x16_bf16 v[0:15], a[124:127], v[44:47], v[0:15]
  ds_read_b128 v[40:43], v205 offset:8192
  v_mfma_f32_32x32x16_bf16 v[16:31], v[44:47], v[236:239], v[16:31]
  s_waitcnt lgkmcnt(2)
  v_mfma_f32_32x32x16_bf16 v[0:15], a[128:131], v[32:35], v[0:15]
  ds_read_b128 v[44:47], v206 offset:8192
  v_mfma_f32_32x32x16_bf16 v[16:31], v[32:35], v[240:243], v[16:31]
  s_waitcnt lgkmcnt(2)
  v_mfma_f32_32x32x16_bf16 v[0:15], a[132:135], v[36:39], v[0:15]
  v_mfma_f32_32x32x16_bf16 v[16:31], v[36:39], v[244:247], v[16:31]
  s_waitcnt lgkmcnt(1)
  v_mfma_f32_32x32x16_bf16 v[0:15], a[136:139], v[40:43], v[0:15]
  v_mfma_f32_32x32x16_bf16 v[16:31], v[40:43], v[248:251], v[16:31]
  s_waitcnt lgkmcnt(0)
  v_mfma_f32_32x32x16_bf16 v[0:15], a[140:143], v[44:47], v[0:15]
  v_mfma_f32_32x32x16_bf16 v[16:31], v[44:47], v[252:255], v[16:31]
  s_mul_i32 s64, s59, 655360
  s_lshl_b32 s55, s58, 14
  s_add_u32 s64, s64, s55
  s_add_u32 s64, s64, 1048576
  s_add_u32 s72, s64, s69
  s_add_u32 s73, s64, s66
  s_add_u32 s59, s59, 7
  s_waitcnt vmcnt(0)
  s_barrier
KV_loop:
  s_add_u32 s60, s60, 258048
  ds_read_b128 v[32:35], v203 offset:36864
  ds_read_b128 v[36:39], v204 offset:36864
  ds_read_b128 v[40:43], v205 offset:36864
  s_waitcnt lgkmcnt(2)
  v_mfma_f32_32x32x16_bf16 v[68:83], a[0:3], v[32:35], 0
  ds_read_b128 v[44:47], v206 offset:36864
  s_add_u32 m0, s67, 0
  s_nop 0
  buffer_load_dwordx4 v202, s[4:7], s60 offen offset:0 lds
  v_mfma_f32_32x32x16_bf16 v[84:99], v[32:35], a[144:147], 0
  s_waitcnt lgkmcnt(2)
  v_mfma_f32_32x32x16_bf16 v[68:83], a[4:7], v[36:39], v[68:83]
  ds_read_b128 v[32:35], v203 offset:37888
  s_add_u32 m0, s67, 896
  s_nop 0
  buffer_load_dwordx4 v202, s[4:7], s60 offen offset:128 lds
  v_mfma_f32_32x32x16_bf16 v[84:99], v[36:39], a[148:151], v[84:99]
  s_waitcnt lgkmcnt(2)
  v_mfma_f32_32x32x16_bf16 v[68:83], a[8:11], v[40:43], v[68:83]
  ds_read_b128 v[36:39], v204 offset:37888
  s_add_u32 m0, s67, 1792
  s_nop 0
  buffer_load_dwordx4 v202, s[4:7], s60 offen offset:256 lds
  v_mfma_f32_32x32x16_bf16 v[84:99], v[40:43], a[152:155], v[84:99]
  s_waitcnt lgkmcnt(2)
  v_mfma_f32_32x32x16_bf16 v[68:83], a[12:15], v[44:47], v[68:83]
  ds_read_b128 v[40:43], v205 offset:37888
  s_add_u32 m0, s67, 2688
  s_nop 0
  buffer_load_dwordx4 v202, s[4:7], s60 offen offset:384 lds
  v_mfma_f32_32x32x16_bf16 v[84:99], v[44:47], a[156:159], v[84:99]
  s_waitcnt lgkmcnt(2)
  v_mfma_f32_32x32x16_bf16 v[68:83], a[16:19], v[32:35], v[68:83]
  ds_read_b128 v[44:47], v206 offset:37888
  s_add_u32 m0, s67, 3584
  s_nop 0
  buffer_load_dwordx4 v202, s[4:7], s60 offen offset:512 lds
  v_mfma_f32_32x32x16_bf16 v[84:99], v[32:35], a[160:163], v[84:99]
  s_waitcnt lgkmcnt(2)
  v_mfma_f32_32x32x16_bf16 v[68:83], a[20:23], v[36:39], v[68:83]
  ds_read_b128 v[32:35], v203 offset:38912
  s_add_u32 m0, s67, 4480
  s_nop 0
  buffer_load_dwordx4 v202, s[4:7], s60 offen offset:640 lds
  v_mfma_f32_32x32x16_bf16 v[84:99], v[36:39], a[164:167], v[84:99]
  s_waitcnt lgkmcnt(2)
  v_mfma_f32_32x32x16_bf16 v[68:83], a[24:27], v[40:43], v[68:83]
  ds_read_b128 v[36:39], v204 offset:38912
  s_add_u32 m0, s67, 5376
  s_nop 0
  buffer_load_dwordx4 v202, s[4:7], s60 offen offset:768 lds
  v_mfma_f32_32x32x16_bf16 v[84:99], v[40:43], a[168:171], v[84:99]
  s_waitcnt lgkmcnt(2)
  v_mfma_f32_32x32x16_bf16 v[68:83], a[28:31], v[44:47], v[68:83]
  ds_read_b128 v[40:43], v205 offset:38912
  s_add_u32 m0, s67, 6272
  s_nop 0
  buffer_load_dwordx4 v202, s[4:7], s60 offen offset:896 lds
  v_mfma_f32_32x32x16_bf16 v[84:99], v[44:47], a[172:175], v[84:99]
  s_waitcnt lgkmcnt(2)
  v_mfma_f32_32x32x16_bf16 v[68:83], a[32:35], v[32:35], v[68:83]
  ds_read_b128 v[44:47], v206 offset:38912
  s_add_u32 m0, s67, 7168
  s_nop 0
  buffer_load_dwordx4 v202, s[4:7], s60 offen offset:1024 lds
  v_mfma_f32_32x32x16_bf16 v[84:99], v[32:35], a[176:179], v[84:99]
  s_waitcnt lgkmcnt(2)
  v_mfma_f32_32x32x16_bf16 v[68:83], a[36:39], v[36:39], v[68:83]
  ds_read_b128 v[32:35], v203 offset:39936
  v_mul_f32 v0, s68, v0
  v_mul_f32 v1, s68, v1
  v_mul_f32 v2, s68, v2
  v_mul_f32 v3, s68, v3
  v_mfma_f32_32x32x16_bf16 v[84:99], v[36:39], a[180:183], v[84:99]
  v_mul_f32 v4, s68, v4
  v_mul_f32 v5, s68, v5
  v_mul_f32 v6, s68, v6
  v_mul_f32 v7, s68, v7
  s_waitcnt lgkmcnt(2)
  v_mfma_f32_32x32x16_bf16 v[68:83], a[40:43], v[40:43], v[68:83]
  ds_read_b128 v[36:39], v204 offset:39936
  v_cvt_pk_bf16_f32 v48, v0, v4
  v_cvt_pk_bf16_f32 v49, v1, v5
  v_cvt_pk_bf16_f32 v50, v2, v6
  v_cvt_pk_bf16_f32 v51, v3, v7
  v_mfma_f32_32x32x16_bf16 v[84:99], v[40:43], a[184:187], v[84:99]
  buffer_store_dwordx4 v[48:51], v216, s[8:11], s72 offen offset:0 sc1
  s_waitcnt lgkmcnt(2)
  v_mfma_f32_32x32x16_bf16 v[68:83], a[44:47], v[44:47], v[68:83]
  ds_read_b128 v[40:43], v205 offset:39936
  v_mfma_f32_32x32x16_bf16 v[84:99], v[44:47], a[188:191], v[84:99]
  s_waitcnt lgkmcnt(2)
  v_mfma_f32_32x32x16_bf16 v[68:83], a[48:51], v[32:35], v[68:83]
  ds_read_b128 v[44:47], v206 offset:39936
  v_mul_f32 v8, s68, v8
  v_mul_f32 v9, s68, v9
  v_mul_f32 v10, s68, v10
  v_mul_f32 v11, s68, v11
  v_mfma_f32_32x32x16_bf16 v[84:99], v[32:35], a[192:195], v[84:99]
  v_mul_f32 v12, s68, v12
  v_mul_f32 v13, s68, v13
  v_mul_f32 v14, s68, v14
  v_mul_f32 v15, s68, v15
  s_waitcnt lgkmcnt(2)
  v_mfma_f32_32x32x16_bf16 v[68:83], a[52:55], v[36:39], v[68:83]
  ds_read_b128 v[32:35], v203 offset:40960
  v_cvt_pk_bf16_f32 v52, v8, v12
  v_cvt_pk_bf16_f32 v53, v9, v13
  v_cvt_pk_bf16_f32 v54, v10, v14
  v_cvt_pk_bf16_f32 v55, v11, v15
  v_mfma_f32_32x32x16_bf16 v[84:99], v[36:39], a[196:199], v[84:99]
  buffer_store_dwordx4 v[52:55], v216, s[8:11], s72 offen offset:256 sc1
  s_waitcnt lgkmcnt(2)
  v_mfma_f32_32x32x16_bf16 v[68:83], a[56:59], v[40:43], v[68:83]
  ds_read_b128 v[36:39], v204 offset:40960
  v_mfma_f32_32x32x16_bf16 v[84:99], v[40:43], a[200:203], v[84:99]
  s_waitcnt lgkmcnt(2)
  v_mfma_f32_32x32x16_bf16 v[68:83], a[60:63], v[44:47], v[68:83]
  ds_read_b128 v[40:43], v205 offset:40960
  v_cvt_pk_bf16_f32 v56, v16, v17
  v_cvt_pk_bf16_f32 v57, v20, v21
  v_cvt_pk_bf16_f32 v58, v24, v25
  v_cvt_pk_bf16_f32 v59, v28, v29
  v_mfma_f32_32x32x16_bf16 v[84:99], v[44:47], a[204:207], v[84:99]
  buffer_store_dwordx4 v[56:59], v217, s[8:11], s64 offen offset:0 sc1
  s_waitcnt lgkmcnt(2)
  v_mfma_f32_32x32x16_bf16 v[68:83], a[64:67], v[32:35], v[68:83]
  ds_read_b128 v[44:47], v206 offset:40960
  v_mfma_f32_32x32x16_bf16 v[84:99], v[32:35], a[208:211], v[84:99]
  s_waitcnt lgkmcnt(2)
  v_mfma_f32_32x32x16_bf16 v[68:83], a[68:71], v[36:39], v[68:83]
  ds_read_b128 v[32:35], v203 offset:41984
  v_cvt_pk_bf16_f32 v60, v18, v19
  v_cvt_pk_bf16_f32 v61, v22, v23
  v_cvt_pk_bf16_f32 v62, v26, v27
  v_cvt_pk_bf16_f32 v63, v30, v31
  v_mfma_f32_32x32x16_bf16 v[84:99], v[36:39], a[212:215], v[84:99]
  buffer_store_dwordx4 v[60:63], v217, s[8:11], s64 offen offset:256 sc1
  s_waitcnt lgkmcnt(2)
  v_mfma_f32_32x32x16_bf16 v[68:83], a[72:75], v[40:43], v[68:83]
  ds_read_b128 v[36:39], v204 offset:41984
  v_mfma_f32_32x32x16_bf16 v[84:99], v[40:43], a[216:219], v[84:99]
  s_waitcnt lgkmcnt(2)
  v_mfma_f32_32x32x16_bf16 v[68:83], a[76:79], v[44:47], v[68:83]
  ds_read_b128 v[40:43], v205 offset:41984
  buffer_store_dwordx4 v[64:67], v201, s[8:11], s73 offen sc1
  v_mfma_f32_32x32x16_bf16 v[84:99], v[44:47], a[220:223], v[84:99]
  s_waitcnt lgkmcnt(2)
  v_mfma_f32_32x32x16_bf16 v[68:83], a[80:83], v[32:35], v[68:83]
  ds_read_b128 v[44:47], v206 offset:41984
  v_mfma_f32_32x32x16_bf16 v[84:99], v[32:35], a[224:227], v[84:99]
  s_waitcnt lgkmcnt(2)
  v_mfma_f32_32x32x16_bf16 v[68:83], a[84:87], v[36:39], v[68:83]
  ds_read_b128 v[32:35], v203 offset:43008
  v_mfma_f32_32x32x16_bf16 v[84:99], v[36:39], a[228:231], v[84:99]
  s_waitcnt lgkmcnt(2)
  v_mfma_f32_32x32x16_bf16 v[68:83], a[88:91], v[40:43], v[68:83]
  ds_read_b128 v[36:39], v204 offset:43008
  v_mfma_f32_32x32x16_bf16 v[84:99], v[40:43], a[232:235], v[84:99]
  s_waitcnt lgkmcnt(2)
  v_mfma_f32_32x32x16_bf16 v[68:83], a[92:95], v[44:47], v[68:83]
  ds_read_b128 v[40:43], v205 offset:43008
  v_mfma_f32_32x32x16_bf16 v[84:99], v[44:47], a[236:239], v[84:99]
  s_waitcnt lgkmcnt(2)
  v_mfma_f32_32x32x16_bf16 v[68:83], a[96:99], v[32:35], v[68:83]
  ds_read_b128 v[44:47], v206 offset:43008
  v_mfma_f32_32x32x16_bf16 v[84:99], v[32:35], a[240:243], v[84:99]
  s_waitcnt lgkmcnt(2)
  v_mfma_f32_32x32x16_bf16 v[68:83], a[100:103], v[36:39], v[68:83]
  ds_read_b128 v[32:35], v203 offset:44032
  v_mfma_f32_32x32x16_bf16 v[84:99], v[36:39], a[244:247], v[84:99]
  s_waitcnt lgkmcnt(2)
  v_mfma_f32_32x32x16_bf16 v[68:83], a[104:107], v[40:43], v[68:83]
  ds_read_b128 v[36:39], v204 offset:44032
  v_mfma_f32_32x32x16_bf16 v[84:99], v[40:43], a[248:251], v[84:99]
  s_waitcnt lgkmcnt(2)
  v_mfma_f32_32x32x16_bf16 v[68:83], a[108:111], v[44:47], v[68:83]
  ds_read_b128 v[40:43], v205 offset:44032
  v_mfma_f32_32x32x16_bf16 v[84:99], v[44:47], a[252:255], v[84:99]
  s_waitcnt lgkmcnt(2)
  v_mfma_f32_32x32x16_bf16 v[68:83], a[112:115], v[32:35], v[68:83]
  ds_read_b128 v[44:47], v206 offset:44032
  v_mfma_f32_32x32x16_bf16 v[84:99], v[32:35], v[224:227], v[84:99]
  s_waitcnt lgkmcnt(2)
  v_mfma_f32_32x32x16_bf16 v[68:83], a[116:119], v[36:39], v[68:83]
  ds_read_b128 v[32:35], v203 offset:45056
  v_mfma_f32_32x32x16_bf16 v[84:99], v[36:39], v[228:231], v[84:99]
  s_waitcnt lgkmcnt(2)
  v_mfma_f32_32x32x16_bf16 v[68:83], a[120:123], v[40:43], v[68:83]
  ds_read_b128 v[36:39], v204 offset:45056
  v_mfma_f32_32x32x16_bf16 v[84:99], v[40:43], v[232:235], v[84:99]
  s_waitcnt lgkmcnt(2)
  v_mfma_f32_32x32x16_bf16 v[68:83], a[124:127], v[44:47], v[68:83]
  ds_read_b128 v[40:43], v205 offset:45056
  v_mfma_f32_32x32x16_bf16 v[84:99], v[44:47], v[236:239], v[84:99]
  s_waitcnt lgkmcnt(2)
  v_mfma_f32_32x32x16_bf16 v[68:83], a[128:131], v[32:35], v[68:83]
  ds_read_b128 v[44:47], v206 offset:45056
  v_mfma_f32_32x32x16_bf16 v[84:99], v[32:35], v[240:243], v[84:99]
  s_waitcnt lgkmcnt(2)
  v_mfma_f32_32x32x16_bf16 v[68:83], a[132:135], v[36:39], v[68:83]
  v_mfma_f32_32x32x16_bf16 v[84:99], v[36:39], v[244:247], v[84:99]
  s_waitcnt lgkmcnt(1)
  v_mfma_f32_32x32x16_bf16 v[68:83], a[136:139], v[40:43], v[68:83]
  v_mfma_f32_32x32x16_bf16 v[84:99], v[40:43], v[248:251], v[84:99]
  s_waitcnt lgkmcnt(0)
  v_mfma_f32_32x32x16_bf16 v[68:83], a[140:143], v[44:47], v[68:83]
  v_mfma_f32_32x32x16_bf16 v[84:99], v[44:47], v[252:255], v[84:99]
  s_mul_i32 s64, s59, 655360
  s_lshl_b32 s55, s58, 14
  s_add_u32 s64, s64, s55
  s_add_u32 s64, s64, 1048576
  s_add_u32 s72, s64, s69
  s_add_u32 s73, s64, s66
  s_add_u32 s59, s59, 7
  s_cmp_ge_u32 s59, 64
  s_cbranch_scc1 KV_done1
  s_waitcnt vmcnt(5)
  s_barrier
  s_add_u32 s60, s60, 258048
  ds_read_b128 v[32:35], v203 offset:0
  ds_read_b128 v[36:39], v204 offset:0
  ds_read_b128 v[40:43], v205 offset:0
  s_waitcnt lgkmcnt(2)
  v_mfma_f32_32x32x16_bf16 v[0:15], a[0:3], v[32:35], 0
  ds_read_b128 v[44:47], v206 offset:0
  s_add_u32 m0, s67, 36864
  s_nop 0
  buffer_load_dwordx4 v202, s[4:7], s60 offen offset:0 lds
  v_mfma_f32_32x32x16_bf16 v[16:31], v[32:35], a[144:147], 0
  s_waitcnt lgkmcnt(2)
  v_mfma_f32_32x32x16_bf16 v[0:15], a[4:7], v[36:39], v[0:15]
  ds_read_b128 v[32:35], v203 offset:1024
  s_add_u32 m0, s67, 37760
  s_nop 0
  buffer_load_dwordx4 v202, s[4:7], s60 offen offset:128 lds
  v_mfma_f32_32x32x16_bf16 v[16:31], v[36:39], a[148:151], v[16:31]
  s_waitcnt lgkmcnt(2)
  v_mfma_f32_32x32x16_bf16 v[0:15], a[8:11], v[40:43], v[0:15]
  ds_read_b128 v[36:39], v204 offset:1024
  s_add_u32 m0, s67, 38656
  s_nop 0
  buffer_load_dwordx4 v202, s[4:7], s60 offen offset:256 lds
  v_mfma_f32_32x32x16_bf16 v[16:31], v[40:43], a[152:155], v[16:31]
  s_waitcnt lgkmcnt(2)
  v_mfma_f32_32x32x16_bf16 v[0:15], a[12:15], v[44:47], v[0:15]
  ds_read_b128 v[40:43], v205 offset:1024
  s_add_u32 m0, s67, 39552
  s_nop 0
  buffer_load_dwordx4 v202, s[4:7], s60 offen offset:384 lds
  v_mfma_f32_32x32x16_bf16 v[16:31], v[44:47], a[156:159], v[16:31]
  s_waitcnt lgkmcnt(2)
  v_mfma_f32_32x32x16_bf16 v[0:15], a[16:19], v[32:35], v[0:15]
  ds_read_b128 v[44:47], v206 offset:1024
  s_add_u32 m0, s67, 40448
  s_nop 0
  buffer_load_dwordx4 v202, s[4:7], s60 offen offset:512 lds
  v_mfma_f32_32x32x16_bf16 v[16:31], v[32:35], a[160:163], v[16:31]
  s_waitcnt lgkmcnt(2)
  v_mfma_f32_32x32x16_bf16 v[0:15], a[20:23], v[36:39], v[0:15]
  ds_read_b128 v[32:35], v203 offset:2048
  s_add_u32 m0, s67, 41344
  s_nop 0
  buffer_load_dwordx4 v202, s[4:7], s60 offen offset:640 lds
  v_mfma_f32_32x32x16_bf16 v[16:31], v[36:39], a[164:167], v[16:31]
  s_waitcnt lgkmcnt(2)
  v_mfma_f32_32x32x16_bf16 v[0:15], a[24:27], v[40:43], v[0:15]
  ds_read_b128 v[36:39], v204 offset:2048
  s_add_u32 m0, s67, 42240
  s_nop 0
  buffer_load_dwordx4 v202, s[4:7], s60 offen offset:768 lds
  v_mfma_f32_32x32x16_bf16 v[16:31], v[40:43], a[168:171], v[16:31]
  s_waitcnt lgkmcnt(2)
  v_mfma_f32_32x32x16_bf16 v[0:15], a[28:31], v[44:47], v[0:15]
  ds_read_b128 v[40:43], v205 offset:2048
  s_add_u32 m0, s67, 43136
  s_nop 0
  buffer_load_dwordx4 v202, s[4:7], s60 offen offset:896 lds
  v_mfma_f32_32x32x16_bf16 v[16:31], v[44:47], a[172:175], v[16:31]
  s_waitcnt lgkmcnt(2)
  v_mfma_f32_32x32x16_bf16 v[0:15], a[32:35], v[32:35], v[0:15]
  ds_read_b128 v[44:47], v206 offset:2048
  s_add_u32 m0, s67, 44032
  s_nop 0
  buffer_load_dwordx4 v202, s[4:7], s60 offen offset:1024 lds
  v_mfma_f32_32x32x16_bf16 v[16:31], v[32:35], a[176:179], v[16:31]
  s_waitcnt lgkmcnt(2)
  v_mfma_f32_32x32x16_bf16 v[0:15], a[36:39], v[36:39], v[0:15]
  ds_read_b128 v[32:35], v203 offset:3072
  v_mul_f32 v68, s68, v68
  v_mul_f32 v69, s68, v69
  v_mul_f32 v70, s68, v70
  v_mul_f32 v71, s68, v71
  v_mfma_f32_32x32x16_bf16 v[16:31], v[36:39], a[180:183], v[16:31]
  v_mul_f32 v72, s68, v72
  v_mul_f32 v73, s68, v73
  v_mul_f32 v74, s68, v74
  v_mul_f32 v75, s68, v75
  s_waitcnt lgkmcnt(2)
  v_mfma_f32_32x32x16_bf16 v[0:15], a[40:43], v[40:43], v[0:15]
  ds_read_b128 v[36:39], v204 offset:3072
  v_cvt_pk_bf16_f32 v48, v68, v72
  v_cvt_pk_bf16_f32 v49, v69, v73
  v_cvt_pk_bf16_f32 v50, v70, v74
  v_cvt_pk_bf16_f32 v51, v71, v75
  v_mfma_f32_32x32x16_bf16 v[16:31], v[40:43], a[184:187], v[16:31]
  buffer_store_dwordx4 v[48:51], v216, s[8:11], s72 offen offset:0 sc1
  s_waitcnt lgkmcnt(2)
  v_mfma_f32_32x32x16_bf16 v[0:15], a[44:47], v[44:47], v[0:15]
  ds_read_b128 v[40:43], v205 offset:3072
  v_mfma_f32_32x32x16_bf16 v[16:31], v[44:47], a[188:191], v[16:31]
  s_waitcnt lgkmcnt(2)
  v_mfma_f32_32x32x16_bf16 v[0:15], a[48:51], v[32:35], v[0:15]
  ds_read_b128 v[44:47], v206 offset:3072
  v_mul_f32 v76, s68, v76
  v_mul_f32 v77, s68, v77
  v_mul_f32 v78, s68, v78
  v_mul_f32 v79, s68, v79
  v_mfma_f32_32x32x16_bf16 v[16:31], v[32:35], a[192:195], v[16:31]
  v_mul_f32 v80, s68, v80
  v_mul_f32 v81, s68, v81
  v_mul_f32 v82, s68, v82
  v_mul_f32 v83, s68, v83
  s_waitcnt lgkmcnt(2)
  v_mfma_f32_32x32x16_bf16 v[0:15], a[52:55], v[36:39], v[0:15]
  ds_read_b128 v[32:35], v203 offset:4096
  v_cvt_pk_bf16_f32 v52, v76, v80
  v_cvt_pk_bf16_f32 v53, v77, v81
  v_cvt_pk_bf16_f32 v54, v78, v82
  v_cvt_pk_bf16_f32 v55, v79, v83
  v_mfma_f32_32x32x16_bf16 v[16:31], v[36:39], a[196:199], v[16:31]
  buffer_store_dwordx4 v[52:55], v216, s[8:11], s72 offen offset:256 sc1
  s_waitcnt lgkmcnt(2)
  v_mfma_f32_32x32x16_bf16 v[0:15], a[56:59], v[40:43], v[0:15]
  ds_read_b128 v[36:39], v204 offset:4096
  v_mfma_f32_32x32x16_bf16 v[16:31], v[40:43], a[200:203], v[16:31]
  s_waitcnt lgkmcnt(2)
  v_mfma_f32_32x32x16_bf16 v[0:15], a[60:63], v[44:47], v[0:15]
  ds_read_b128 v[40:43], v205 offset:4096
  v_cvt_pk_bf16_f32 v56, v84, v85
  v_cvt_pk_bf16_f32 v57, v88, v89
  v_cvt_pk_bf16_f32 v58, v92, v93
  v_cvt_pk_bf16_f32 v59, v96, v97
  v_mfma_f32_32x32x16_bf16 v[16:31], v[44:47], a[204:207], v[16:31]
  buffer_store_dwordx4 v[56:59], v217, s[8:11], s64 offen offset:0 sc1
  s_waitcnt lgkmcnt(2)
  v_mfma_f32_32x32x16_bf16 v[0:15], a[64:67], v[32:35], v[0:15]
  ds_read_b128 v[44:47], v206 offset:4096
  v_mfma_f32_32x32x16_bf16 v[16:31], v[32:35], a[208:211], v[16:31]
  s_waitcnt lgkmcnt(2)
  v_mfma_f32_32x32x16_bf16 v[0:15], a[68:71], v[36:39], v[0:15]
  ds_read_b128 v[32:35], v203 offset:5120
  v_cvt_pk_bf16_f32 v60, v86, v87
  v_cvt_pk_bf16_f32 v61, v90, v91
  v_cvt_pk_bf16_f32 v62, v94, v95
  v_cvt_pk_bf16_f32 v63, v98, v99
  v_mfma_f32_32x32x16_bf16 v[16:31], v[36:39], a[212:215], v[16:31]
  buffer_store_dwordx4 v[60:63], v217, s[8:11], s64 offen offset:256 sc1
  s_waitcnt lgkmcnt(2)
  v_mfma_f32_32x32x16_bf16 v[0:15], a[72:75], v[40:43], v[0:15]
  ds_read_b128 v[36:39], v204 offset:5120
  v_mfma_f32_32x32x16_bf16 v[16:31], v[40:43], a[216:219], v[16:31]
  s_waitcnt lgkmcnt(2)
  v_mfma_f32_32x32x16_bf16 v[0:15], a[76:79], v[44:47], v[0:15]
  ds_read_b128 v[40:43], v205 offset:5120
  buffer_store_dwordx4 v[64:67], v201, s[8:11], s73 offen sc1
  v_mfma_f32_32x32x16_bf16 v[16:31], v[44:47], a[220:223], v[16:31]
  s_waitcnt lgkmcnt(2)
  v_mfma_f32_32x32x16_bf16 v[0:15], a[80:83], v[32:35], v[0:15]
  ds_read_b128 v[44:47], v206 offset:5120
  v_mfma_f32_32x32x16_bf16 v[16:31], v[32:35], a[224:227], v[16:31]
  s_waitcnt lgkmcnt(2)
  v_mfma_f32_32x32x16_bf16 v[0:15], a[84:87], v[36:39], v[0:15]
  ds_read_b128 v[32:35], v203 offset:6144
  v_mfma_f32_32x32x16_bf16 v[16:31], v[36:39], a[228:231], v[16:31]
  s_waitcnt lgkmcnt(2)
  v_mfma_f32_32x32x16_bf16 v[0:15], a[88:91], v[40:43], v[0:15]
  ds_read_b128 v[36:39], v204 offset:6144
  v_mfma_f32_32x32x16_bf16 v[16:31], v[40:43], a[232:235], v[16:31]
  s_waitcnt lgkmcnt(2)
  v_mfma_f32_32x32x16_bf16 v[0:15], a[92:95], v[44:47], v[0:15]
  ds_read_b128 v[40:43], v205 offset:6144
  v_mfma_f32_32x32x16_bf16 v[16:31], v[44:47], a[236:239], v[16:31]
  s_waitcnt lgkmcnt(2)
  v_mfma_f32_32x32x16_bf16 v[0:15], a[96:99], v[32:35], v[0:15]
  ds_read_b128 v[44:47], v206 offset:6144
  v_mfma_f32_32x32x16_bf16 v[16:31], v[32:35], a[240:243], v[16:31]
  s_waitcnt lgkmcnt(2)
  v_mfma_f32_32x32x16_bf16 v[0:15], a[100:103], v[36:39], v[0:15]
  ds_read_b128 v[32:35], v203 offset:7168
  v_mfma_f32_32x32x16_bf16 v[16:31], v[36:39], a[244:247], v[16:31]
  s_waitcnt lgkmcnt(2)
  v_mfma_f32_32x32x16_bf16 v[0:15], a[104:107], v[40:43], v[0:15]
  ds_read_b128 v[36:39], v204 offset:7168
  v_mfma_f32_32x32x16_bf16 v[16:31], v[40:43], a[248:251], v[16:31]
  s_waitcnt lgkmcnt(2)
  v_mfma_f32_32x32x16_bf16 v[0:15], a[108:111], v[44:47], v[0:15]
  ds_read_b128 v[40:43], v205 offset:7168
  v_mfma_f32_32x32x16_bf16 v[16:31], v[44:47], a[252:255], v[16:31]
  s_waitcnt lgkmcnt(2)
  v_mfma_f32_32x32x16_bf16 v[0:15], a[112:115], v[32:35], v[0:15]
  ds_read_b128 v[44:47], v206 offset:7168
  v_mfma_f32_32x32x16_bf16 v[16:31], v[32:35], v[224:227], v[16:31]
  s_waitcnt lgkmcnt(2)
  v_mfma_f32_32x32x16_bf16 v[0:15], a[116:119], v[36:39], v[0:15]
  ds_read_b128 v[32:35], v203 offset:8192
  v_mfma_f32_32x32x16_bf16 v[16:31], v[36:39], v[228:231], v[16:31]
  s_waitcnt lgkmcnt(2)
  v_mfma_f32_32x32x16_bf16 v[0:15], a[120:123], v[40:43], v[0:15]
  ds_read_b128 v[36:39], v204 offset:8192
  v_mfma_f32_32x32x16_bf16 v[16:31], v[40:43], v[232:235], v[16:31]
  s_waitcnt lgkmcnt(2)
  v_mfma_f32_32x32x16_bf16 v[0:15], a[124:127], v[44:47], v[0:15]
  ds_read_b128 v[40:43], v205 offset:8192
  v_mfma_f32_32x32x16_bf16 v[16:31], v[44:47], v[236:239], v[16:31]
  s_waitcnt lgkmcnt(2)
  v_mfma_f32_32x32x16_bf16 v[0:15], a[128:131], v[32:35], v[0:15]
  ds_read_b128 v[44:47], v206 offset:8192
  v_mfma_f32_32x32x16_bf16 v[16:31], v[32:35], v[240:243], v[16:31]
  s_waitcnt lgkmcnt(2)
  v_mfma_f32_32x32x16_bf16 v[0:15], a[132:135], v[36:39], v[0:15]
  v_mfma_f32_32x32x16_bf16 v[16:31], v[36:39], v[244:247], v[16:31]
  s_waitcnt lgkmcnt(1)
  v_mfma_f32_32x32x16_bf16 v[0:15], a[136:139], v[40:43], v[0:15]
  v_mfma_f32_32x32x16_bf16 v[16:31], v[40:43], v[248:251], v[16:31]
  s_waitcnt lgkmcnt(0)
  v_mfma_f32_32x32x16_bf16 v[0:15], a[140:143], v[44:47], v[0:15]
  v_mfma_f32_32x32x16_bf16 v[16:31], v[44:47], v[252:255], v[16:31]
  s_mul_i32 s64, s59, 655360
  s_lshl_b32 s55, s58, 14
  s_add_u32 s64, s64, s55
  s_add_u32 s64, s64, 1048576
  s_add_u32 s72, s64, s69
  s_add_u32 s73, s64, s66
  s_add_u32 s59, s59, 7
  s_cmp_ge_u32 s59, 64
  s_cbranch_scc1 KV_done0
  s_sub_u32 s54, s59, 21
  s_cmp_lt_u32 s54, 7
  s_cbranch_scc1 KV_early
  s_waitcnt vmcnt(5)
  s_barrier
KV_cont:
  s_branch KV_loop
KV_early:
  s_waitcnt vmcnt(0)
  s_barrier
  s_cmp_eq_u32 s52, 0
  s_cbranch_scc0 KV_sig0
  v_mov_b32 v211, 1
  v_mov_b32 v212, 0
  s_mov_b64 exec, 1
  buffer_atomic_add v211, v212, s[12:15], s70 offen
  s_mov_b64 exec, -1
KV_sig0:
  s_branch KV_cont
KV_done1:
  s_nop 11
  v_mul_f32 v68, s68, v68
  v_mul_f32 v69, s68, v69
  v_mul_f32 v70, s68, v70
  v_mul_f32 v71, s68, v71
  v_mul_f32 v72, s68, v72
  v_mul_f32 v73, s68, v73
  v_mul_f32 v74, s68, v74
  v_mul_f32 v75, s68, v75
  v_cvt_pk_bf16_f32 v48, v68, v72
  v_cvt_pk_bf16_f32 v49, v69, v73
  v_cvt_pk_bf16_f32 v50, v70, v74
  v_cvt_pk_bf16_f32 v51, v71, v75
  buffer_store_dwordx4 v[48:51], v216, s[8:11], s72 offen offset:0 sc1
  v_mul_f32 v76, s68, v76
  v_mul_f32 v77, s68, v77
  v_mul_f32 v78, s68, v78
  v_mul_f32 v79, s68, v79
  v_mul_f32 v80, s68, v80
  v_mul_f32 v81, s68, v81
  v_mul_f32 v82, s68, v82
  v_mul_f32 v83, s68, v83
  v_cvt_pk_bf16_f32 v52, v76, v80
  v_cvt_pk_bf16_f32 v53, v77, v81
  v_cvt_pk_bf16_f32 v54, v78, v82
  v_cvt_pk_bf16_f32 v55, v79, v83
  buffer_store_dwordx4 v[52:55], v216, s[8:11], s72 offen offset:256 sc1
  v_cvt_pk_bf16_f32 v56, v84, v85
  v_cvt_pk_bf16_f32 v57, v88, v89
  v_cvt_pk_bf16_f32 v58, v92, v93
  v_cvt_pk_bf16_f32 v59, v96, v97
  buffer_store_dwordx4 v[56:59], v217, s[8:11], s64 offen offset:0 sc1
  v_cvt_pk_bf16_f32 v60, v86, v87
  v_cvt_pk_bf16_f32 v61, v90, v91
  v_cvt_pk_bf16_f32 v62, v94, v95
  v_cvt_pk_bf16_f32 v63, v98, v99
  buffer_store_dwordx4 v[60:63], v217, s[8:11], s64 offen offset:256 sc1
  buffer_store_dwordx4 v[64:67], v201, s[8:11], s73 offen sc1
  s_branch KV_fin
KV_done0:
  s_nop 11
  v_mul_f32 v0, s68, v0
  v_mul_f32 v1, s68, v1
  v_mul_f32 v2, s68, v2
  v_mul_f32 v3, s68, v3
  v_mul_f32 v4, s68, v4
  v_mul_f32 v5, s68, v5
  v_mul_f32 v6, s68, v6
  v_mul_f32 v7, s68, v7
  v_cvt_pk_bf16_f32 v48, v0, v4
  v_cvt_pk_bf16_f32 v49, v1, v5
  v_cvt_pk_bf16_f32 v50, v2, v6
  v_cvt_pk_bf16_f32 v51, v3, v7
  buffer_store_dwordx4 v[48:51], v216, s[8:11], s72 offen offset:0 sc1
  v_mul_f32 v8, s68, v8
  v_mul_f32 v9, s68, v9
  v_mul_f32 v10, s68, v10
  v_mul_f32 v11, s68, v11
  v_mul_f32 v12, s68, v12
  v_mul_f32 v13, s68, v13
  v_mul_f32 v14, s68, v14
  v_mul_f32 v15, s68, v15
  v_cvt_pk_bf16_f32 v52, v8, v12
  v_cvt_pk_bf16_f32 v53, v9, v13
  v_cvt_pk_bf16_f32 v54, v10, v14
  v_cvt_pk_bf16_f32 v55, v11, v15
  buffer_store_dwordx4 v[52:55], v216, s[8:11], s72 offen offset:256 sc1
  v_cvt_pk_bf16_f32 v56, v16, v17
  v_cvt_pk_bf16_f32 v57, v20, v21
  v_cvt_pk_bf16_f32 v58, v24, v25
  v_cvt_pk_bf16_f32 v59, v28, v29
  buffer_store_dwordx4 v[56:59], v217, s[8:11], s64 offen offset:0 sc1
  v_cvt_pk_bf16_f32 v60, v18, v19
  v_cvt_pk_bf16_f32 v61, v22, v23
  v_cvt_pk_bf16_f32 v62, v26, v27
  v_cvt_pk_bf16_f32 v63, v30, v31
  buffer_store_dwordx4 v[60:63], v217, s[8:11], s64 offen offset:256 sc1
  buffer_store_dwordx4 v[64:67], v201, s[8:11], s73 offen sc1
KV_fin:
  s_waitcnt vmcnt(0)
  s_barrier
  s_cmp_eq_u32 s52, 0
  s_cbranch_scc0 KV_sig
  v_mov_b32 v211, 256
  v_mov_b32 v212, 0
  s_mov_b64 exec, 1
  buffer_atomic_add v211, v212, s[12:15], s70 offen
  s_mov_b64 exec, -1
KV_sig:
  s_cmp_ge_u32 s53, 192
  s_cbranch_scc1 L_exit
  s_cmp_lt_u32 s53, 64
  s_cbranch_scc1 W_h
  s_sub_u32 s54, s53, 64
  s_lshr_b32 s68, s54, 4
  s_and_b32 s69, s54, 15
  s_lshl_b32 s60, s69, 2
  s_sub_u32 s60, s60, 1
  s_max_i32 s60, s60, 0
  s_mul_i32 s60, s60, 36864
  s_add_u32 m0, s67, 0
  s_nop 0
  buffer_load_dwordx4 v202, s[4:7], s60 offen offset:0 lds
  s_add_u32 m0, s67, 896
  s_nop 0
  buffer_load_dwordx4 v202, s[4:7], s60 offen offset:128 lds
  s_add_u32 m0, s67, 1792
  s_nop 0
  buffer_load_dwordx4 v202, s[4:7], s60 offen offset:256 lds
  s_add_u32 m0, s67, 2688
  s_nop 0
  buffer_load_dwordx4 v202, s[4:7], s60 offen offset:384 lds
  s_add_u32 m0, s67, 3584
  s_nop 0
  buffer_load_dwordx4 v202, s[4:7], s60 offen offset:512 lds
  s_add_u32 m0, s67, 4480
  s_nop 0
  buffer_load_dwordx4 v202, s[4:7], s60 offen offset:640 lds
  s_add_u32 m0, s67, 5376
  s_nop 0
  buffer_load_dwordx4 v202, s[4:7], s60 offen offset:768 lds
  s_add_u32 m0, s67, 6272
  s_nop 0
  buffer_load_dwordx4 v202, s[4:7], s60 offen offset:896 lds
  s_add_u32 m0, s67, 7168
  s_nop 0
  buffer_load_dwordx4 v202, s[4:7], s60 offen offset:1024 lds
  v_and_b32 v211, 15, v200
  v_mul_u32_u24 v211, 72, v211
  v_lshrrev_b32 v212, 4, v200
  v_mul_u32_u24 v213, 1152, v212
  v_add_u32 v213, v213, v211
  s_lshl_b32 s54, s54, 2
  s_add_u32 s70, s54, s52
  s_mul_i32 s55, s70, 4608
  buffer_load_dwordx4 v[48:51], v213, s[4:7], s55 offen offset:0
  buffer_load_dwordx4 v[52:55], v213, s[4:7], s55 offen offset:16
  buffer_load_dwordx4 v[56:59], v213, s[4:7], s55 offen offset:32
  buffer_load_dwordx4 v[60:63], v213, s[4:7], s55 offen offset:48
  buffer_load_dwordx2 v[64:65], v213, s[4:7], s55 offen offset:64
  buffer_load_dwordx4 v[68:71], v211, s[44:47], 0 offen offset:0
  buffer_load_dwordx4 v[72:75], v211, s[44:47], 0 offen offset:16
  buffer_load_dwordx4 v[76:79], v211, s[44:47], 0 offen offset:32
  buffer_load_dwordx4 v[80:83], v211, s[44:47], 0 offen offset:48
  buffer_load_dwordx2 v[84:85], v211, s[44:47], 0 offen offset:64
  v_mov_b32 v0, 0
  v_mov_b32 v1, 0x3f803f80
  s_waitcnt vmcnt(9)
  v_lshlrev_b32 v2, 16, v48
  s_waitcnt vmcnt(4)
  v_lshlrev_b32 v3, 16, v68
  v_and_b32 v4, 0xffff0000, v48
  v_and_b32 v5, 0xffff0000, v68
  v_mul_f32 v2, v2, v3
  v_mul_f32 v4, v4, v5
  v_cvt_pk_bf16_f32 v2, v2, v4
  v_lshlrev_b32 v3, 16, v2
  v_and_b32 v4, 0xffff0000, v2
  v_add_f32 v0, v0, v3
  v_add_f32 v0, v0, v4
  v_lshlrev_b32 v2, 16, v49
  v_lshlrev_b32 v3, 16, v69
  v_and_b32 v4, 0xffff0000, v49
  v_and_b32 v5, 0xffff0000, v69
  v_mul_f32 v2, v2, v3
  v_mul_f32 v4, v4, v5
  v_cvt_pk_bf16_f32 v2, v2, v4
  v_lshlrev_b32 v3, 16, v2
  v_and_b32 v4, 0xffff0000, v2
  v_add_f32 v0, v0, v3
  v_add_f32 v0, v0, v4
  v_lshlrev_b32 v2, 16, v50
  v_lshlrev_b32 v3, 16, v70
  v_and_b32 v4, 0xffff0000, v50
  v_and_b32 v5, 0xffff0000, v70
  v_mul_f32 v2, v2, v3
  v_mul_f32 v4, v4, v5
  v_cvt_pk_bf16_f32 v2, v2, v4
  v_lshlrev_b32 v3, 16, v2
  v_and_b32 v4, 0xffff0000, v2
  v_add_f32 v0, v0, v3
  v_add_f32 v0, v0, v4
  v_lshlrev_b32 v2, 16, v51
  v_lshlrev_b32 v3, 16, v71
  v_and_b32 v4, 0xffff0000, v51
  v_and_b32 v5, 0xffff0000, v71
  v_mul_f32 v2, v2, v3
  v_mul_f32 v4, v4, v5
  v_cvt_pk_bf16_f32 v2, v2, v4
  v_lshlrev_b32 v3, 16, v2
  v_and_b32 v4, 0xffff0000, v2
  v_add_f32 v0, v0, v3
  v_add_f32 v0, v0, v4
  v_lshlrev_b32 v2, 16, v52
  s_waitcnt vmcnt(3)
  v_lshlrev_b32 v3, 16, v72
  v_and_b32 v4, 0xffff0000, v52
  v_and_b32 v5, 0xffff0000, v72
  v_mul_f32 v2, v2, v3
  v_mul_f32 v4, v4, v5
  v_cvt_pk_bf16_f32 v2, v2, v4
  v_lshlrev_b32 v3, 16, v2
  v_and_b32 v4, 0xffff0000, v2
  v_add_f32 v0, v0, v3
  v_add_f32 v0, v0, v4
  v_lshlrev_b32 v2, 16, v53
  v_lshlrev_b32 v3, 16, v73
  v_and_b32 v4, 0xffff0000, v53
  v_and_b32 v5, 0xffff0000, v73
  v_mul_f32 v2, v2, v3
  v_mul_f32 v4, v4, v5
  v_cvt_pk_bf16_f32 v2, v2, v4
  v_lshlrev_b32 v3, 16, v2
  v_and_b32 v4, 0xffff0000, v2
  v_add_f32 v0, v0, v3
  v_add_f32 v0, v0, v4
  v_lshlrev_b32 v2, 16, v54
  v_lshlrev_b32 v3, 16, v74
  v_and_b32 v4, 0xffff0000, v54
  v_and_b32 v5, 0xffff0000, v74
  v_mul_f32 v2, v2, v3
  v_mul_f32 v4, v4, v5
  v_cvt_pk_bf16_f32 v2, v2, v4
  v_lshlrev_b32 v3, 16, v2
  v_and_b32 v4, 0xffff0000, v2
  v_add_f32 v0, v0, v3
  v_add_f32 v0, v0, v4
  v_lshlrev_b32 v2, 16, v55
  v_lshlrev_b32 v3, 16, v75
  v_and_b32 v4, 0xffff0000, v55
  v_and_b32 v5, 0xffff0000, v75
  v_mul_f32 v2, v2, v3
  v_mul_f32 v4, v4, v5
  v_cvt_pk_bf16_f32 v2, v2, v4
  v_lshlrev_b32 v3, 16, v2
  v_and_b32 v4, 0xffff0000, v2
  v_add_f32 v0, v0, v3
  v_add_f32 v0, v0, v4
  v_lshlrev_b32 v2, 16, v56
  s_waitcnt vmcnt(2)
  v_lshlrev_b32 v3, 16, v76
  v_and_b32 v4, 0xffff0000, v56
  v_and_b32 v5, 0xffff0000, v76
  v_mul_f32 v2, v2, v3
  v_mul_f32 v4, v4, v5
  v_cvt_pk_bf16_f32 v2, v2, v4
  v_lshlrev_b32 v3, 16, v2
  v_and_b32 v4, 0xffff0000, v2
  v_add_f32 v0, v0, v3
  v_add_f32 v0, v0, v4
  v_lshlrev_b32 v2, 16, v57
  v_lshlrev_b32 v3, 16, v77
  v_and_b32 v4, 0xffff0000, v57
  v_and_b32 v5, 0xffff0000, v77
  v_mul_f32 v2, v2, v3
  v_mul_f32 v4, v4, v5
  v_cvt_pk_bf16_f32 v2, v2, v4
  v_lshlrev_b32 v3, 16, v2
  v_and_b32 v4, 0xffff0000, v2
  v_add_f32 v0, v0, v3
  v_add_f32 v0, v0, v4
  v_lshlrev_b32 v2, 16, v58
  v_lshlrev_b32 v3, 16, v78
  v_and_b32 v4, 0xffff0000, v58
  v_and_b32 v5, 0xffff0000, v78
  v_mul_f32 v2, v2, v3
  v_mul_f32 v4, v4, v5
  v_cvt_pk_bf16_f32 v2, v2, v4
  v_lshlrev_b32 v3, 16, v2
  v_and_b32 v4, 0xffff0000, v2
  v_add_f32 v0, v0, v3
  v_add_f32 v0, v0, v4
  v_lshlrev_b32 v2, 16, v59
  v_lshlrev_b32 v3, 16, v79
  v_and_b32 v4, 0xffff0000, v59
  v_and_b32 v5, 0xffff0000, v79
  v_mul_f32 v2, v2, v3
  v_mul_f32 v4, v4, v5
  v_cvt_pk_bf16_f32 v2, v2, v4
  v_lshlrev_b32 v3, 16, v2
  v_and_b32 v4, 0xffff0000, v2
  v_add_f32 v0, v0, v3
  v_add_f32 v0, v0, v4
  v_lshlrev_b32 v2, 16, v60
  s_waitcnt vmcnt(1)
  v_lshlrev_b32 v3, 16, v80
  v_and_b32 v4, 0xffff0000, v60
  v_and_b32 v5, 0xffff0000, v80
  v_mul_f32 v2, v2, v3
  v_mul_f32 v4, v4, v5
  v_cvt_pk_bf16_f32 v2, v2, v4
  v_lshlrev_b32 v3, 16, v2
  v_and_b32 v4, 0xffff0000, v2
  v_add_f32 v0, v0, v3
  v_add_f32 v0, v0, v4
  v_lshlrev_b32 v2, 16, v61
  v_lshlrev_b32 v3, 16, v81
  v_and_b32 v4, 0xffff0000, v61
  v_and_b32 v5, 0xffff0000, v81
  v_mul_f32 v2, v2, v3
  v_mul_f32 v4, v4, v5
  v_cvt_pk_bf16_f32 v2, v2, v4
  v_lshlrev_b32 v3, 16, v2
  v_and_b32 v4, 0xffff0000, v2
  v_add_f32 v0, v0, v3
  v_add_f32 v0, v0, v4
  v_lshlrev_b32 v2, 16, v62
  v_lshlrev_b32 v3, 16, v82
  v_and_b32 v4, 0xffff0000, v62
  v_and_b32 v5, 0xffff0000, v82
  v_mul_f32 v2, v2, v3
  v_mul_f32 v4, v4, v5
  v_cvt_pk_bf16_f32 v2, v2, v4
  v_lshlrev_b32 v3, 16, v2
  v_and_b32 v4, 0xffff0000, v2
  v_add_f32 v0, v0, v3
  v_add_f32 v0, v0, v4
  v_lshlrev_b32 v2, 16, v63
  v_lshlrev_b32 v3, 16, v83
  v_and_b32 v4, 0xffff0000, v63
  v_and_b32 v5, 0xffff0000, v83
  v_mul_f32 v2, v2, v3
  v_mul_f32 v4, v4, v5
  v_cvt_pk_bf16_f32 v2, v2, v4
  v_lshlrev_b32 v3, 16, v2
  v_and_b32 v4, 0xffff0000, v2
  v_add_f32 v0, v0, v3
  v_add_f32 v0, v0, v4
  v_lshlrev_b32 v2, 16, v64
  s_waitcnt vmcnt(0)
  v_lshlrev_b32 v3, 16, v84
  v_and_b32 v4, 0xffff0000, v64
  v_and_b32 v5, 0xffff0000, v84
  v_mul_f32 v2, v2, v3
  v_mul_f32 v4, v4, v5
  v_cvt_pk_bf16_f32 v2, v2, v4
  v_lshlrev_b32 v3, 16, v2
  v_and_b32 v4, 0xffff0000, v2
  v_add_f32 v0, v0, v3
  v_add_f32 v0, v0, v4
  v_lshlrev_b32 v2, 16, v65
  v_lshlrev_b32 v3, 16, v85
  v_and_b32 v4, 0xffff0000, v65
  v_and_b32 v5, 0xffff0000, v85
  v_mul_f32 v2, v2, v3
  v_mul_f32 v4, v4, v5
  v_cvt_pk_bf16_f32 v2, v2, v4
  v_lshlrev_b32 v3, 16, v2
  v_and_b32 v4, 0xffff0000, v2
  v_add_f32 v0, v0, v3
  v_add_f32 v0, v0, v4
  s_nop 1
  v_add_f32_dpp v0, v0, v0 row_ror:1 row_mask:0xf bank_mask:0xf
  s_nop 1
  v_add_f32_dpp v0, v0, v0 row_ror:2 row_mask:0xf bank_mask:0xf
  s_nop 1
  v_add_f32_dpp v0, v0, v0 row_ror:4 row_mask:0xf bank_mask:0xf
  s_nop 1
  v_add_f32_dpp v0, v0, v0 row_ror:8 row_mask:0xf bank_mask:0xf
  v_cvt_pk_bf16_f32 v0, v0, v0
  v_lshlrev_b32 v0, 16, v0
  v_mul_f32 v0, 3216550459, v0
  v_exp_f32 v0, v0
  s_nop 0
  v_add_f32 v0, 1.0, v0
  v_rcp_f32 v0, v0
  s_nop 0
  v_cvt_pk_bf16_f32 v0, v0, v0
  v_lshlrev_b32 v0, 16, v0
  v_lshlrev_b32 v212, 2, v212
  s_lshl_b32 s55, s70, 4
  s_add_u32 s55, s55, 66060288
  s_mov_b32 exec_lo, 0x00010001
  s_mov_b32 exec_hi, 0x00010001
  buffer_store_dword v0, v212, s[8:11], s55 offen sc1
  s_mov_b64 exec, -1
  v_lshrrev_b32 v211, 4, v200
  v_lshlrev_b32 v212, 2, v211
  v_and_b32 v213, 15, v200
  v_xor_b32 v212, v212, v213
  v_mul_u32_u24 v211, 3456, v211
  v_mov_b32 v2, 0x40000000
  v_add_u32 v213, 0, v212
  v_mul_u32_u24 v214, 57, v213
  v_lshrrev_b32 v214, 9, v214
  v_mul_u32_u24 v214, 1008, v214
  v_lshl_add_u32 v214, v213, 4, v214
  v_add_u32 v214, v214, v211
  v_cmp_lt_u32 vcc, 26, v213
  s_nop 1
  v_cndmask_b32 v207, v214, v2, vcc
  v_add_u32 v213, 16, v212
  v_mul_u32_u24 v214, 57, v213
  v_lshrrev_b32 v214, 9, v214
  v_mul_u32_u24 v214, 1008, v214
  v_lshl_add_u32 v214, v213, 4, v214
  v_add_u32 v214, v214, v211
  v_cmp_lt_u32 vcc, 26, v213
  s_nop 1
  v_cndmask_b32 v208, v214, v2, vcc
  s_mul_i32 s62, s68, 144
  s_mul_i32 s54, s52, 13824
  s_add_u32 s62, s62, s54
  s_waitcnt vmcnt(0)
  s_lshl_b32 s61, s52, 10
  s_add_u32 s61, s61, 36864
  s_add_u32 m0, s61, 0
  s_add_u32 s54, s62, 0
  buffer_load_dwordx4 v207, s[36:39], s54 offen lds
  s_add_u32 m0, s61, 4096
  s_add_u32 s54, s62, 55296
  buffer_load_dwordx4 v207, s[36:39], s54 offen lds
  s_add_u32 m0, s61, 8192
  s_add_u32 s54, s62, 110592
  buffer_load_dwordx4 v207, s[36:39], s54 offen lds
  s_add_u32 m0, s61, 12288
  s_add_u32 s54, s62, 165888
  buffer_load_dwordx4 v207, s[36:39], s54 offen lds
  s_add_u32 m0, s61, 16384
  s_add_u32 s54, s62, 0
  buffer_load_dwordx4 v208, s[36:39], s54 offen lds
  s_add_u32 m0, s61, 20480
  s_add_u32 s54, s62, 55296
  buffer_load_dwordx4 v208, s[36:39], s54 offen lds
  s_add_u32 m0, s61, 24576
  s_add_u32 s54, s62, 110592
  buffer_load_dwordx4 v208, s[36:39], s54 offen lds
  s_add_u32 m0, s61, 28672
  s_add_u32 s54, s62, 165888
  buffer_load_dwordx4 v208, s[36:39], s54 offen lds
  s_add_u32 m0, s61, 32768
  s_add_u32 s54, s62, 221184
  buffer_load_dwordx4 v207, s[36:39], s54 offen lds
  s_add_u32 m0, s61, 36864
  s_add_u32 s54, s62, 276480
  buffer_load_dwordx4 v207, s[36:39], s54 offen lds
  s_add_u32 m0, s61, 40960
  s_add_u32 s54, s62, 331776
  buffer_load_dwordx4 v207, s[36:39], s54 offen lds
  s_add_u32 m0, s61, 45056
  s_add_u32 s54, s62, 387072
  buffer_load_dwordx4 v207, s[36:39], s54 offen lds
  s_add_u32 m0, s61, 49152
  s_add_u32 s54, s62, 221184
  buffer_load_dwordx4 v208, s[36:39], s54 offen lds
  s_add_u32 m0, s61, 53248
  s_add_u32 s54, s62, 276480
  buffer_load_dwordx4 v208, s[36:39], s54 offen lds
  s_add_u32 m0, s61, 57344
  s_add_u32 s54, s62, 331776
  buffer_load_dwordx4 v208, s[36:39], s54 offen lds
  s_add_u32 m0, s61, 61440
  s_add_u32 s54, s62, 387072
  buffer_load_dwordx4 v208, s[36:39], s54 offen lds
  s_add_u32 m0, s61, 65536
  s_add_u32 s54, s62, 442368
  buffer_load_dwordx4 v207, s[36:39], s54 offen lds
  s_add_u32 m0, s61, 69632
  s_add_u32 s54, s62, 497664
  buffer_load_dwordx4 v207, s[36:39], s54 offen lds
  s_add_u32 m0, s61, 73728
  s_add_u32 s54, s62, 552960
  buffer_load_dwordx4 v207, s[36:39], s54 offen lds
  s_add_u32 m0, s61, 77824
  s_add_u32 s54, s62, 608256
  buffer_load_dwordx4 v207, s[36:39], s54 offen lds
  s_add_u32 m0, s61, 81920
  s_add_u32 s54, s62, 442368
  buffer_load_dwordx4 v208, s[36:39], s54 offen lds
  s_add_u32 m0, s61, 86016
  s_add_u32 s54, s62, 497664
  buffer_load_dwordx4 v208, s[36:39], s54 offen lds
  s_add_u32 m0, s61, 90112
  s_add_u32 s54, s62, 552960
  buffer_load_dwordx4 v208, s[36:39], s54 offen lds
  s_add_u32 m0, s61, 94208
  s_add_u32 s54, s62, 608256
  buffer_load_dwordx4 v208, s[36:39], s54 offen lds
  s_waitcnt vmcnt(20) lgkmcnt(0)
  s_barrier
  s_add_u32 m0, s61, 98304
  s_add_u32 s54, s62, 663552
  buffer_load_dwordx4 v207, s[36:39], s54 offen lds
  s_add_u32 m0, s61, 102400
  s_add_u32 s54, s62, 718848
  buffer_load_dwordx4 v207, s[36:39], s54 offen lds
  s_add_u32 m0, s61, 106496
  s_add_u32 s54, s62, 774144
  buffer_load_dwordx4 v207, s[36:39], s54 offen lds
  s_add_u32 m0, s61, 110592
  s_add_u32 s54, s62, 829440
  buffer_load_dwordx4 v207, s[36:39], s54 offen lds
  v_add_u32 v215, 36864, v210
  ds_read_b64_tr_b16 a[0:1], v215 offset:0
  ds_read_b64_tr_b16 a[2:3], v215 offset:1024
  ds_read_b64_tr_b16 a[4:5], v215 offset:4096
  ds_read_b64_tr_b16 a[6:7], v215 offset:5120
  ds_read_b64_tr_b16 a[8:9], v215 offset:8192
  ds_read_b64_tr_b16 a[10:11], v215 offset:9216
  ds_read_b64_tr_b16 a[12:13], v215 offset:12288
  ds_read_b64_tr_b16 a[14:15], v215 offset:13312
  s_waitcnt vmcnt(20) lgkmcnt(0)
  s_barrier
  s_add_u32 m0, s61, 0
  s_add_u32 s54, s62, 663552
  buffer_load_dwordx4 v208, s[36:39], s54 offen lds
  s_add_u32 m0, s61, 4096
  s_add_u32 s54, s62, 718848
  buffer_load_dwordx4 v208, s[36:39], s54 offen lds
  s_add_u32 m0, s61, 8192
  s_add_u32 s54, s62, 774144
  buffer_load_dwordx4 v208, s[36:39], s54 offen lds
  s_add_u32 m0, s61, 12288
  s_add_u32 s54, s62, 829440
  buffer_load_dwordx4 v208, s[36:39], s54 offen lds
  v_add_u32 v215, 53248, v210
  ds_read_b64_tr_b16 a[144:145], v215 offset:0
  ds_read_b64_tr_b16 a[146:147], v215 offset:1024
  ds_read_b64_tr_b16 a[148:149], v215 offset:4096
  ds_read_b64_tr_b16 a[150:151], v215 offset:5120
  ds_read_b64_tr_b16 a[152:153], v215 offset:8192
  ds_read_b64_tr_b16 a[154:155], v215 offset:9216
  ds_read_b64_tr_b16 a[156:157], v215 offset:12288
  ds_read_b64_tr_b16 a[158:159], v215 offset:13312
  s_waitcnt vmcnt(20) lgkmcnt(0)
  s_barrier
  s_add_u32 m0, s61, 16384
  s_add_u32 s54, s62, 884736
  buffer_load_dwordx4 v207, s[36:39], s54 offen lds
  s_add_u32 m0, s61, 20480
  s_add_u32 s54, s62, 940032
  buffer_load_dwordx4 v207, s[36:39], s54 offen lds
  s_add_u32 m0, s61, 24576
  s_add_u32 s54, s62, 995328
  buffer_load_dwordx4 v207, s[36:39], s54 offen lds
  s_add_u32 m0, s61, 28672
  s_add_u32 s54, s62, 1050624
  buffer_load_dwordx4 v207, s[36:39], s54 offen lds
  v_add_u32 v215, 69632, v210
  ds_read_b64_tr_b16 a[16:17], v215 offset:0
  ds_read_b64_tr_b16 a[18:19], v215 offset:1024
  ds_read_b64_tr_b16 a[20:21], v215 offset:4096
  ds_read_b64_tr_b16 a[22:23], v215 offset:5120
  ds_read_b64_tr_b16 a[24:25], v215 offset:8192
  ds_read_b64_tr_b16 a[26:27], v215 offset:9216
  ds_read_b64_tr_b16 a[28:29], v215 offset:12288
  ds_read_b64_tr_b16 a[30:31], v215 offset:13312
  s_waitcnt vmcnt(20) lgkmcnt(0)
  s_barrier
  s_add_u32 m0, s61, 32768
  s_add_u32 s54, s62, 884736
  buffer_load_dwordx4 v208, s[36:39], s54 offen lds
  s_add_u32 m0, s61, 36864
  s_add_u32 s54, s62, 940032
  buffer_load_dwordx4 v208, s[36:39], s54 offen lds
  s_add_u32 m0, s61, 40960
  s_add_u32 s54, s62, 995328
  buffer_load_dwordx4 v208, s[36:39], s54 offen lds
  s_add_u32 m0, s61, 45056
  s_add_u32 s54, s62, 1050624
  buffer_load_dwordx4 v208, s[36:39], s54 offen lds
  v_add_u32 v215, 86016, v210
  ds_read_b64_tr_b16 a[160:161], v215 offset:0
  ds_read_b64_tr_b16 a[162:163], v215 offset:1024
  ds_read_b64_tr_b16 a[164:165], v215 offset:4096
  ds_read_b64_tr_b16 a[166:167], v215 offset:5120
  ds_read_b64_tr_b16 a[168:169], v215 offset:8192
  ds_read_b64_tr_b16 a[170:171], v215 offset:9216
  ds_read_b64_tr_b16 a[172:173], v215 offset:12288
  ds_read_b64_tr_b16 a[174:175], v215 offset:13312
  s_waitcnt vmcnt(20) lgkmcnt(0)
  s_barrier
  s_add_u32 m0, s61, 49152
  s_add_u32 s54, s62, 1105920
  buffer_load_dwordx4 v207, s[36:39], s54 offen lds
  s_add_u32 m0, s61, 53248
  s_add_u32 s54, s62, 1161216
  buffer_load_dwordx4 v207, s[36:39], s54 offen lds
  s_add_u32 m0, s61, 57344
  s_add_u32 s54, s62, 1216512
  buffer_load_dwordx4 v207, s[36:39], s54 offen lds
  s_add_u32 m0, s61, 61440
  s_add_u32 s54, s62, 1271808
  buffer_load_dwordx4 v207, s[36:39], s54 offen lds
  v_add_u32 v215, 102400, v210
  ds_read_b64_tr_b16 a[32:33], v215 offset:0
  ds_read_b64_tr_b16 a[34:35], v215 offset:1024
  ds_read_b64_tr_b16 a[36:37], v215 offset:4096
  ds_read_b64_tr_b16 a[38:39], v215 offset:5120
  ds_read_b64_tr_b16 a[40:41], v215 offset:8192
  ds_read_b64_tr_b16 a[42:43], v215 offset:9216
  ds_read_b64_tr_b16 a[44:45], v215 offset:12288
  ds_read_b64_tr_b16 a[46:47], v215 offset:13312
  s_waitcnt vmcnt(20) lgkmcnt(0)
  s_barrier
  s_add_u32 m0, s61, 65536
  s_add_u32 s54, s62, 1105920
  buffer_load_dwordx4 v208, s[36:39], s54 offen lds
  s_add_u32 m0, s61, 69632
  s_add_u32 s54, s62, 1161216
  buffer_load_dwordx4 v208, s[36:39], s54 offen lds
  s_add_u32 m0, s61, 73728
  s_add_u32 s54, s62, 1216512
  buffer_load_dwordx4 v208, s[36:39], s54 offen lds
  s_add_u32 m0, s61, 77824
  s_add_u32 s54, s62, 1271808
  buffer_load_dwordx4 v208, s[36:39], s54 offen lds
  v_add_u32 v215, 118784, v210
  ds_read_b64_tr_b16 a[176:177], v215 offset:0
  ds_read_b64_tr_b16 a[178:179], v215 offset:1024
  ds_read_b64_tr_b16 a[180:181], v215 offset:4096
  ds_read_b64_tr_b16 a[182:183], v215 offset:5120
  ds_read_b64_tr_b16 a[184:185], v215 offset:8192
  ds_read_b64_tr_b16 a[186:187], v215 offset:9216
  ds_read_b64_tr_b16 a[188:189], v215 offset:12288
  ds_read_b64_tr_b16 a[190:191], v215 offset:13312
  s_waitcnt vmcnt(20) lgkmcnt(0)
  s_barrier
  s_add_u32 m0, s61, 81920
  s_add_u32 s54, s62, 1327104
  buffer_load_dwordx4 v207, s[36:39], s54 offen lds
  s_add_u32 m0, s61, 86016
  s_add_u32 s54, s62, 1382400
  buffer_load_dwordx4 v207, s[36:39], s54 offen lds
  s_add_u32 m0, s61, 90112
  s_add_u32 s54, s62, 1437696
  buffer_load_dwordx4 v207, s[36:39], s54 offen lds
  s_add_u32 m0, s61, 94208
  s_add_u32 s54, s62, 1492992
  buffer_load_dwordx4 v207, s[36:39], s54 offen lds
  v_add_u32 v215, 135168, v210
  ds_read_b64_tr_b16 a[48:49], v215 offset:0
  ds_read_b64_tr_b16 a[50:51], v215 offset:1024
  ds_read_b64_tr_b16 a[52:53], v215 offset:4096
  ds_read_b64_tr_b16 a[54:55], v215 offset:5120
  ds_read_b64_tr_b16 a[56:57], v215 offset:8192
  ds_read_b64_tr_b16 a[58:59], v215 offset:9216
  ds_read_b64_tr_b16 a[60:61], v215 offset:12288
  ds_read_b64_tr_b16 a[62:63], v215 offset:13312
  s_waitcnt vmcnt(20) lgkmcnt(0)
  s_barrier
  s_add_u32 m0, s61, 98304
  s_add_u32 s54, s62, 1327104
  buffer_load_dwordx4 v208, s[36:39], s54 offen lds
  s_add_u32 m0, s61, 102400
  s_add_u32 s54, s62, 1382400
  buffer_load_dwordx4 v208, s[36:39], s54 offen lds
  s_add_u32 m0, s61, 106496
  s_add_u32 s54, s62, 1437696
  buffer_load_dwordx4 v208, s[36:39], s54 offen lds
  s_add_u32 m0, s61, 110592
  s_add_u32 s54, s62, 1492992
  buffer_load_dwordx4 v208, s[36:39], s54 offen lds
  v_add_u32 v215, 36864, v210
  ds_read_b64_tr_b16 a[192:193], v215 offset:0
  ds_read_b64_tr_b16 a[194:195], v215 offset:1024
  ds_read_b64_tr_b16 a[196:197], v215 offset:4096
  ds_read_b64_tr_b16 a[198:199], v215 offset:5120
  ds_read_b64_tr_b16 a[200:201], v215 offset:8192
  ds_read_b64_tr_b16 a[202:203], v215 offset:9216
  ds_read_b64_tr_b16 a[204:205], v215 offset:12288
  ds_read_b64_tr_b16 a[206:207], v215 offset:13312
  s_waitcnt vmcnt(20) lgkmcnt(0)
  s_barrier
  s_add_u32 m0, s61, 0
  s_add_u32 s54, s62, 1548288
  buffer_load_dwordx4 v207, s[36:39], s54 offen lds
  s_add_u32 m0, s61, 4096
  s_add_u32 s54, s62, 1603584
  buffer_load_dwordx4 v207, s[36:39], s54 offen lds
  s_add_u32 m0, s61, 8192
  s_add_u32 s54, s62, 1658880
  buffer_load_dwordx4 v207, s[36:39], s54 offen lds
  s_add_u32 m0, s61, 12288
  s_add_u32 s54, s62, 1714176
  buffer_load_dwordx4 v207, s[36:39], s54 offen lds
  v_add_u32 v215, 53248, v210
  ds_read_b64_tr_b16 a[64:65], v215 offset:0
  ds_read_b64_tr_b16 a[66:67], v215 offset:1024
  ds_read_b64_tr_b16 a[68:69], v215 offset:4096
  ds_read_b64_tr_b16 a[70:71], v215 offset:5120
  ds_read_b64_tr_b16 a[72:73], v215 offset:8192
  ds_read_b64_tr_b16 a[74:75], v215 offset:9216
  ds_read_b64_tr_b16 a[76:77], v215 offset:12288
  ds_read_b64_tr_b16 a[78:79], v215 offset:13312
  s_waitcnt vmcnt(20) lgkmcnt(0)
  s_barrier
  s_add_u32 m0, s61, 16384
  s_add_u32 s54, s62, 1548288
  buffer_load_dwordx4 v208, s[36:39], s54 offen lds
  s_add_u32 m0, s61, 20480
  s_add_u32 s54, s62, 1603584
  buffer_load_dwordx4 v208, s[36:39], s54 offen lds
  s_add_u32 m0, s61, 24576
  s_add_u32 s54, s62, 1658880
  buffer_load_dwordx4 v208, s[36:39], s54 offen lds
  s_add_u32 m0, s61, 28672
  s_add_u32 s54, s62, 1714176
  buffer_load_dwordx4 v208, s[36:39], s54 offen lds
  v_add_u32 v215, 69632, v210
  ds_read_b64_tr_b16 a[208:209], v215 offset:0
  ds_read_b64_tr_b16 a[210:211], v215 offset:1024
  ds_read_b64_tr_b16 a[212:213], v215 offset:4096
  ds_read_b64_tr_b16 a[214:215], v215 offset:5120
  ds_read_b64_tr_b16 a[216:217], v215 offset:8192
  ds_read_b64_tr_b16 a[218:219], v215 offset:9216
  ds_read_b64_tr_b16 a[220:221], v215 offset:12288
  ds_read_b64_tr_b16 a[222:223], v215 offset:13312
  s_waitcnt vmcnt(20) lgkmcnt(0)
  s_barrier
  s_add_u32 m0, s61, 32768
  s_add_u32 s54, s62, 1769472
  buffer_load_dwordx4 v207, s[36:39], s54 offen lds
  s_add_u32 m0, s61, 36864
  s_add_u32 s54, s62, 1824768
  buffer_load_dwordx4 v207, s[36:39], s54 offen lds
  s_add_u32 m0, s61, 40960
  s_add_u32 s54, s62, 1880064
  buffer_load_dwordx4 v207, s[36:39], s54 offen lds
  s_add_u32 m0, s61, 45056
  s_add_u32 s54, s62, 1935360
  buffer_load_dwordx4 v207, s[36:39], s54 offen lds
  v_add_u32 v215, 86016, v210
  ds_read_b64_tr_b16 a[80:81], v215 offset:0
  ds_read_b64_tr_b16 a[82:83], v215 offset:1024
  ds_read_b64_tr_b16 a[84:85], v215 offset:4096
  ds_read_b64_tr_b16 a[86:87], v215 offset:5120
  ds_read_b64_tr_b16 a[88:89], v215 offset:8192
  ds_read_b64_tr_b16 a[90:91], v215 offset:9216
  ds_read_b64_tr_b16 a[92:93], v215 offset:12288
  ds_read_b64_tr_b16 a[94:95], v215 offset:13312
  s_waitcnt vmcnt(20) lgkmcnt(0)
  s_barrier
  s_add_u32 m0, s61, 49152
  s_add_u32 s54, s62, 1769472
  buffer_load_dwordx4 v208, s[36:39], s54 offen lds
  s_add_u32 m0, s61, 53248
  s_add_u32 s54, s62, 1824768
  buffer_load_dwordx4 v208, s[36:39], s54 offen lds
  s_add_u32 m0, s61, 57344
  s_add_u32 s54, s62, 1880064
  buffer_load_dwordx4 v208, s[36:39], s54 offen lds
  s_add_u32 m0, s61, 61440
  s_add_u32 s54, s62, 1935360
  buffer_load_dwordx4 v208, s[36:39], s54 offen lds
  v_add_u32 v215, 102400, v210
  ds_read_b64_tr_b16 a[224:225], v215 offset:0
  ds_read_b64_tr_b16 a[226:227], v215 offset:1024
  ds_read_b64_tr_b16 a[228:229], v215 offset:4096
  ds_read_b64_tr_b16 a[230:231], v215 offset:5120
  ds_read_b64_tr_b16 a[232:233], v215 offset:8192
  ds_read_b64_tr_b16 a[234:235], v215 offset:9216
  ds_read_b64_tr_b16 a[236:237], v215 offset:12288
  ds_read_b64_tr_b16 a[238:239], v215 offset:13312
  s_waitcnt vmcnt(20) lgkmcnt(0)
  s_barrier
  v_add_u32 v215, 118784, v210
  ds_read_b64_tr_b16 a[96:97], v215 offset:0
  ds_read_b64_tr_b16 a[98:99], v215 offset:1024
  ds_read_b64_tr_b16 a[100:101], v215 offset:4096
  ds_read_b64_tr_b16 a[102:103], v215 offset:5120
  ds_read_b64_tr_b16 a[104:105], v215 offset:8192
  ds_read_b64_tr_b16 a[106:107], v215 offset:9216
  ds_read_b64_tr_b16 a[108:109], v215 offset:12288
  ds_read_b64_tr_b16 a[110:111], v215 offset:13312
  s_waitcnt vmcnt(16) lgkmcnt(0)
  s_barrier
  v_add_u32 v215, 135168, v210
  ds_read_b64_tr_b16 a[240:241], v215 offset:0
  ds_read_b64_tr_b16 a[242:243], v215 offset:1024
  ds_read_b64_tr_b16 a[244:245], v215 offset:4096
  ds_read_b64_tr_b16 a[246:247], v215 offset:5120
  ds_read_b64_tr_b16 a[248:249], v215 offset:8192
  ds_read_b64_tr_b16 a[250:251], v215 offset:9216
  ds_read_b64_tr_b16 a[252:253], v215 offset:12288
  ds_read_b64_tr_b16 a[254:255], v215 offset:13312
  s_waitcnt vmcnt(12) lgkmcnt(0)
  s_barrier
  v_add_u32 v215, 36864, v210
  ds_read_b64_tr_b16 a[112:113], v215 offset:0
  ds_read_b64_tr_b16 a[114:115], v215 offset:1024
  ds_read_b64_tr_b16 a[116:117], v215 offset:4096
  ds_read_b64_tr_b16 a[118:119], v215 offset:5120
  ds_read_b64_tr_b16 a[120:121], v215 offset:8192
  ds_read_b64_tr_b16 a[122:123], v215 offset:9216
  ds_read_b64_tr_b16 a[124:125], v215 offset:12288
  ds_read_b64_tr_b16 a[126:127], v215 offset:13312
  s_waitcnt vmcnt(8) lgkmcnt(0)
  s_barrier
  v_add_u32 v215, 53248, v210
  ds_read_b64_tr_b16 v[224:225], v215 offset:0
  ds_read_b64_tr_b16 v[226:227], v215 offset:1024
  ds_read_b64_tr_b16 v[228:229], v215 offset:4096
  ds_read_b64_tr_b16 v[230:231], v215 offset:5120
  ds_read_b64_tr_b16 v[232:233], v215 offset:8192
  ds_read_b64_tr_b16 v[234:235], v215 offset:9216
  ds_read_b64_tr_b16 v[236:237], v215 offset:12288
  ds_read_b64_tr_b16 v[238:239], v215 offset:13312
  s_waitcnt vmcnt(4) lgkmcnt(0)
  s_barrier
  v_add_u32 v215, 69632, v210
  ds_read_b64_tr_b16 a[128:129], v215 offset:0
  ds_read_b64_tr_b16 a[130:131], v215 offset:1024
  ds_read_b64_tr_b16 a[132:133], v215 offset:4096
  ds_read_b64_tr_b16 a[134:135], v215 offset:5120
  ds_read_b64_tr_b16 a[136:137], v215 offset:8192
  ds_read_b64_tr_b16 a[138:139], v215 offset:9216
  ds_read_b64_tr_b16 a[140:141], v215 offset:12288
  ds_read_b64_tr_b16 a[142:143], v215 offset:13312
  s_waitcnt vmcnt(0) lgkmcnt(0)
  s_barrier
  v_add_u32 v215, 86016, v210
  ds_read_b64_tr_b16 v[240:241], v215 offset:0
  ds_read_b64_tr_b16 v[242:243], v215 offset:1024
  ds_read_b64_tr_b16 v[244:245], v215 offset:4096
  ds_read_b64_tr_b16 v[246:247], v215 offset:5120
  ds_read_b64_tr_b16 v[248:249], v215 offset:8192
  ds_read_b64_tr_b16 v[250:251], v215 offset:9216
  ds_read_b64_tr_b16 v[252:253], v215 offset:12288
  ds_read_b64_tr_b16 v[254:255], v215 offset:13312
  s_waitcnt lgkmcnt(0)
  s_barrier
  v_and_b32 v211, 31, v200
  v_mul_u32_u24 v218, 516, v211
  v_lshrrev_b32 v212, 5, v200
  v_lshl_add_u32 v218, v212, 3, v218
  s_lshl_b32 s54, s52, 6
  s_add_u32 s54, s54, 73728
  v_add_u32 v218, s54, v218
  s_lshl_b32 s60, s69, 2
  s_mul_i32 s60, s60, 36864
  ds_read_b128 v[32:35], v203 offset:0
  ds_read_b128 v[36:39], v204 offset:0
  ds_read_b128 v[40:43], v205 offset:0
  s_waitcnt lgkmcnt(2)
  v_mfma_f32_32x32x16_bf16 v[0:15], a[0:3], v[32:35], 0
  ds_read_b128 v[44:47], v206 offset:0
  s_add_u32 m0, s67, 36864
  s_nop 0
  buffer_load_dwordx4 v202, s[4:7], s60 offen offset:0 lds
  v_mfma_f32_32x32x16_bf16 v[16:31], a[144:147], v[32:35], 0
  s_waitcnt lgkmcnt(2)
  v_mfma_f32_32x32x16_bf16 v[0:15], a[4:7], v[36:39], v[0:15]
  ds_read_b128 v[32:35], v203 offset:1024
  s_add_u32 m0, s67, 37760
  s_nop 0
  buffer_load_dwordx4 v202, s[4:7], s60 offen offset:128 lds
  v_mfma_f32_32x32x16_bf16 v[16:31], a[148:151], v[36:39], v[16:31]
  s_waitcnt lgkmcnt(2)
  v_mfma_f32_32x32x16_bf16 v[0:15], a[8:11], v[40:43], v[0:15]
  ds_read_b128 v[36:39], v204 offset:1024
  s_add_u32 m0, s67, 38656
  s_nop 0
  buffer_load_dwordx4 v202, s[4:7], s60 offen offset:256 lds
  v_mfma_f32_32x32x16_bf16 v[16:31], a[152:155], v[40:43], v[16:31]
  s_waitcnt lgkmcnt(2)
  v_mfma_f32_32x32x16_bf16 v[0:15], a[12:15], v[44:47], v[0:15]
  ds_read_b128 v[40:43], v205 offset:1024
  s_add_u32 m0, s67, 39552
  s_nop 0
  buffer_load_dwordx4 v202, s[4:7], s60 offen offset:384 lds
  v_mfma_f32_32x32x16_bf16 v[16:31], a[156:159], v[44:47], v[16:31]
  s_waitcnt lgkmcnt(2)
  v_mfma_f32_32x32x16_bf16 v[0:15], a[16:19], v[32:35], v[0:15]
  ds_read_b128 v[44:47], v206 offset:1024
  s_add_u32 m0, s67, 40448
  s_nop 0
  buffer_load_dwordx4 v202, s[4:7], s60 offen offset:512 lds
  v_mfma_f32_32x32x16_bf16 v[16:31], a[160:163], v[32:35], v[16:31]
  s_waitcnt lgkmcnt(2)
  v_mfma_f32_32x32x16_bf16 v[0:15], a[20:23], v[36:39], v[0:15]
  ds_read_b128 v[32:35], v203 offset:2048
  s_add_u32 m0, s67, 41344
  s_nop 0
  buffer_load_dwordx4 v202, s[4:7], s60 offen offset:640 lds
  v_mfma_f32_32x32x16_bf16 v[16:31], a[164:167], v[36:39], v[16:31]
  s_waitcnt lgkmcnt(2)
  v_mfma_f32_32x32x16_bf16 v[0:15], a[24:27], v[40:43], v[0:15]
  ds_read_b128 v[36:39], v204 offset:2048
  s_add_u32 m0, s67, 42240
  s_nop 0
  buffer_load_dwordx4 v202, s[4:7], s60 offen offset:768 lds
  v_mfma_f32_32x32x16_bf16 v[16:31], a[168:171], v[40:43], v[16:31]
  s_waitcnt lgkmcnt(2)
  v_mfma_f32_32x32x16_bf16 v[0:15], a[28:31], v[44:47], v[0:15]
  ds_read_b128 v[40:43], v205 offset:2048
  s_add_u32 m0, s67, 43136
  s_nop 0
  buffer_load_dwordx4 v202, s[4:7], s60 offen offset:896 lds
  v_mfma_f32_32x32x16_bf16 v[16:31], a[172:175], v[44:47], v[16:31]
  s_waitcnt lgkmcnt(2)
  v_mfma_f32_32x32x16_bf16 v[0:15], a[32:35], v[32:35], v[0:15]
  ds_read_b128 v[44:47], v206 offset:2048
  s_add_u32 m0, s67, 44032
  s_nop 0
  buffer_load_dwordx4 v202, s[4:7], s60 offen offset:1024 lds
  v_mfma_f32_32x32x16_bf16 v[16:31], a[176:179], v[32:35], v[16:31]
  s_waitcnt lgkmcnt(2)
  v_mfma_f32_32x32x16_bf16 v[0:15], a[36:39], v[36:39], v[0:15]
  ds_read_b128 v[32:35], v203 offset:3072
  v_mfma_f32_32x32x16_bf16 v[16:31], a[180:183], v[36:39], v[16:31]
  s_waitcnt lgkmcnt(2)
  v_mfma_f32_32x32x16_bf16 v[0:15], a[40:43], v[40:43], v[0:15]
  ds_read_b128 v[36:39], v204 offset:3072
  v_mfma_f32_32x32x16_bf16 v[16:31], a[184:187], v[40:43], v[16:31]
  s_waitcnt lgkmcnt(2)
  v_mfma_f32_32x32x16_bf16 v[0:15], a[44:47], v[44:47], v[0:15]
  ds_read_b128 v[40:43], v205 offset:3072
  v_mfma_f32_32x32x16_bf16 v[16:31], a[188:191], v[44:47], v[16:31]
  s_waitcnt lgkmcnt(2)
  v_mfma_f32_32x32x16_bf16 v[0:15], a[48:51], v[32:35], v[0:15]
  ds_read_b128 v[44:47], v206 offset:3072
  v_mfma_f32_32x32x16_bf16 v[16:31], a[192:195], v[32:35], v[16:31]
  s_waitcnt lgkmcnt(2)
  v_mfma_f32_32x32x16_bf16 v[0:15], a[52:55], v[36:39], v[0:15]
  ds_read_b128 v[32:35], v203 offset:4096
  v_mfma_f32_32x32x16_bf16 v[16:31], a[196:199], v[36:39], v[16:31]
  s_waitcnt lgkmcnt(2)
  v_mfma_f32_32x32x16_bf16 v[0:15], a[56:59], v[40:43], v[0:15]
  ds_read_b128 v[36:39], v204 offset:4096
  v_mfma_f32_32x32x16_bf16 v[16:31], a[200:203], v[40:43], v[16:31]
  s_waitcnt lgkmcnt(2)
  v_mfma_f32_32x32x16_bf16 v[0:15], a[60:63], v[44:47], v[0:15]
  ds_read_b128 v[40:43], v205 offset:4096
  v_mfma_f32_32x32x16_bf16 v[16:31], a[204:207], v[44:47], v[16:31]
  s_waitcnt lgkmcnt(2)
  v_mfma_f32_32x32x16_bf16 v[0:15], a[64:67], v[32:35], v[0:15]
  ds_read_b128 v[44:47], v206 offset:4096
  v_mfma_f32_32x32x16_bf16 v[16:31], a[208:211], v[32:35], v[16:31]
  s_waitcnt lgkmcnt(2)
  v_mfma_f32_32x32x16_bf16 v[0:15], a[68:71], v[36:39], v[0:15]
  ds_read_b128 v[32:35], v203 offset:5120
  v_mfma_f32_32x32x16_bf16 v[16:31], a[212:215], v[36:39], v[16:31]
  s_waitcnt lgkmcnt(2)
  v_mfma_f32_32x32x16_bf16 v[0:15], a[72:75], v[40:43], v[0:15]
  ds_read_b128 v[36:39], v204 offset:5120
  v_mfma_f32_32x32x16_bf16 v[16:31], a[216:219], v[40:43], v[16:31]
  s_waitcnt lgkmcnt(2)
  v_mfma_f32_32x32x16_bf16 v[0:15], a[76:79], v[44:47], v[0:15]
  ds_read_b128 v[40:43], v205 offset:5120
  v_mfma_f32_32x32x16_bf16 v[16:31], a[220:223], v[44:47], v[16:31]
  s_waitcnt lgkmcnt(2)
  v_mfma_f32_32x32x16_bf16 v[0:15], a[80:83], v[32:35], v[0:15]
  ds_read_b128 v[44:47], v206 offset:5120
  v_mfma_f32_32x32x16_bf16 v[16:31], a[224:227], v[32:35], v[16:31]
  s_waitcnt lgkmcnt(2)
  v_mfma_f32_32x32x16_bf16 v[0:15], a[84:87], v[36:39], v[0:15]
  ds_read_b128 v[32:35], v203 offset:6144
  v_mfma_f32_32x32x16_bf16 v[16:31], a[228:231], v[36:39], v[16:31]
  s_waitcnt lgkmcnt(2)
  v_mfma_f32_32x32x16_bf16 v[0:15], a[88:91], v[40:43], v[0:15]
  ds_read_b128 v[36:39], v204 offset:6144
  v_mfma_f32_32x32x16_bf16 v[16:31], a[232:235], v[40:43], v[16:31]
  s_waitcnt lgkmcnt(2)
  v_mfma_f32_32x32x16_bf16 v[0:15], a[92:95], v[44:47], v[0:15]
  ds_read_b128 v[40:43], v205 offset:6144
  v_mfma_f32_32x32x16_bf16 v[16:31], a[236:239], v[44:47], v[16:31]
  s_waitcnt lgkmcnt(2)
  v_mfma_f32_32x32x16_bf16 v[0:15], a[96:99], v[32:35], v[0:15]
  ds_read_b128 v[44:47], v206 offset:6144
  v_mfma_f32_32x32x16_bf16 v[16:31], a[240:243], v[32:35], v[16:31]
  s_waitcnt lgkmcnt(2)
  v_mfma_f32_32x32x16_bf16 v[0:15], a[100:103], v[36:39], v[0:15]
  ds_read_b128 v[32:35], v203 offset:7168
  v_mfma_f32_32x32x16_bf16 v[16:31], a[244:247], v[36:39], v[16:31]
  s_waitcnt lgkmcnt(2)
  v_mfma_f32_32x32x16_bf16 v[0:15], a[104:107], v[40:43], v[0:15]
  ds_read_b128 v[36:39], v204 offset:7168
  v_mfma_f32_32x32x16_bf16 v[16:31], a[248:251], v[40:43], v[16:31]
  s_waitcnt lgkmcnt(2)
  v_mfma_f32_32x32x16_bf16 v[0:15], a[108:111], v[44:47], v[0:15]
  ds_read_b128 v[40:43], v205 offset:7168
  v_mfma_f32_32x32x16_bf16 v[16:31], a[252:255], v[44:47], v[16:31]
  s_waitcnt lgkmcnt(2)
  v_mfma_f32_32x32x16_bf16 v[0:15], a[112:115], v[32:35], v[0:15]
  ds_read_b128 v[44:47], v206 offset:7168
  v_mfma_f32_32x32x16_bf16 v[16:31], v[224:227], v[32:35], v[16:31]
  s_waitcnt lgkmcnt(2)
  v_mfma_f32_32x32x16_bf16 v[0:15], a[116:119], v[36:39], v[0:15]
  ds_read_b128 v[32:35], v203 offset:8192
  v_mfma_f32_32x32x16_bf16 v[16:31], v[228:231], v[36:39], v[16:31]
  s_waitcnt lgkmcnt(2)
  v_mfma_f32_32x32x16_bf16 v[0:15], a[120:123], v[40:43], v[0:15]
  ds_read_b128 v[36:39], v204 offset:8192
  v_mfma_f32_32x32x16_bf16 v[16:31], v[232:235], v[40:43], v[16:31]
  s_waitcnt lgkmcnt(2)
  v_mfma_f32_32x32x16_bf16 v[0:15], a[124:127], v[44:47], v[0:15]
  ds_read_b128 v[40:43], v205 offset:8192
  v_mfma_f32_32x32x16_bf16 v[16:31], v[236:239], v[44:47], v[16:31]
  s_waitcnt lgkmcnt(2)
  v_mfma_f32_32x32x16_bf16 v[0:15], a[128:131], v[32:35], v[0:15]
  ds_read_b128 v[44:47], v206 offset:8192
  v_mfma_f32_32x32x16_bf16 v[16:31], v[240:243], v[32:35], v[16:31]
  s_waitcnt lgkmcnt(2)
  v_mfma_f32_32x32x16_bf16 v[0:15], a[132:135], v[36:39], v[0:15]
  v_mfma_f32_32x32x16_bf16 v[16:31], v[244:247], v[36:39], v[16:31]
  s_waitcnt lgkmcnt(1)
  v_mfma_f32_32x32x16_bf16 v[0:15], a[136:139], v[40:43], v[0:15]
  v_mfma_f32_32x32x16_bf16 v[16:31], v[248:251], v[40:43], v[16:31]
  s_waitcnt lgkmcnt(0)
  v_mfma_f32_32x32x16_bf16 v[0:15], a[140:143], v[44:47], v[0:15]
  v_mfma_f32_32x32x16_bf16 v[16:31], v[252:255], v[44:47], v[16:31]
  s_add_u32 s60, s60, 36864
  s_nop 2
  v_cvt_pk_bf16_f32 v48, v0, v1
  v_cvt_pk_bf16_f32 v49, v2, v3
  ds_write2_b32 v218, v48, v49 offset0:0 offset1:1
  v_cvt_pk_bf16_f32 v48, v4, v5
  v_cvt_pk_bf16_f32 v49, v6, v7
  ds_write2_b32 v218, v48, v49 offset0:4 offset1:5
  v_cvt_pk_bf16_f32 v48, v8, v9
  v_cvt_pk_bf16_f32 v49, v10, v11
  ds_write2_b32 v218, v48, v49 offset0:8 offset1:9
  v_cvt_pk_bf16_f32 v48, v12, v13
  v_cvt_pk_bf16_f32 v49, v14, v15
  ds_write2_b32 v218, v48, v49 offset0:12 offset1:13
  v_cvt_pk_bf16_f32 v48, v16, v17
  v_cvt_pk_bf16_f32 v49, v18, v19
  ds_write2_b32 v218, v48, v49 offset0:64 offset1:65
  v_cvt_pk_bf16_f32 v48, v20, v21
  v_cvt_pk_bf16_f32 v49, v22, v23
  ds_write2_b32 v218, v48, v49 offset0:68 offset1:69
  v_cvt_pk_bf16_f32 v48, v24, v25
  v_cvt_pk_bf16_f32 v49, v26, v27
  ds_write2_b32 v218, v48, v49 offset0:72 offset1:73
  v_cvt_pk_bf16_f32 v48, v28, v29
  v_cvt_pk_bf16_f32 v49, v30, v31
  ds_write2_b32 v218, v48, v49 offset0:76 offset1:77
  v_add_u32 v218, 16512, v218
  s_waitcnt vmcnt(0) lgkmcnt(0)
  s_barrier
  ds_read_b128 v[32:35], v203 offset:36864
  ds_read_b128 v[36:39], v204 offset:36864
  ds_read_b128 v[40:43], v205 offset:36864
  s_waitcnt lgkmcnt(2)
  v_mfma_f32_32x32x16_bf16 v[0:15], a[0:3], v[32:35], 0
  ds_read_b128 v[44:47], v206 offset:36864
  s_add_u32 m0, s67, 0
  s_nop 0
  buffer_load_dwordx4 v202, s[4:7], s60 offen offset:0 lds
  v_mfma_f32_32x32x16_bf16 v[16:31], a[144:147], v[32:35], 0
  s_waitcnt lgkmcnt(2)
  v_mfma_f32_32x32x16_bf16 v[0:15], a[4:7], v[36:39], v[0:15]
  ds_read_b128 v[32:35], v203 offset:37888
  s_add_u32 m0, s67, 896
  s_nop 0
  buffer_load_dwordx4 v202, s[4:7], s60 offen offset:128 lds
  v_mfma_f32_32x32x16_bf16 v[16:31], a[148:151], v[36:39], v[16:31]
  s_waitcnt lgkmcnt(2)
  v_mfma_f32_32x32x16_bf16 v[0:15], a[8:11], v[40:43], v[0:15]
  ds_read_b128 v[36:39], v204 offset:37888
  s_add_u32 m0, s67, 1792
  s_nop 0
  buffer_load_dwordx4 v202, s[4:7], s60 offen offset:256 lds
  v_mfma_f32_32x32x16_bf16 v[16:31], a[152:155], v[40:43], v[16:31]
  s_waitcnt lgkmcnt(2)
  v_mfma_f32_32x32x16_bf16 v[0:15], a[12:15], v[44:47], v[0:15]
  ds_read_b128 v[40:43], v205 offset:37888
  s_add_u32 m0, s67, 2688
  s_nop 0
  buffer_load_dwordx4 v202, s[4:7], s60 offen offset:384 lds
  v_mfma_f32_32x32x16_bf16 v[16:31], a[156:159], v[44:47], v[16:31]
  s_waitcnt lgkmcnt(2)
  v_mfma_f32_32x32x16_bf16 v[0:15], a[16:19], v[32:35], v[0:15]
  ds_read_b128 v[44:47], v206 offset:37888
  s_add_u32 m0, s67, 3584
  s_nop 0
  buffer_load_dwordx4 v202, s[4:7], s60 offen offset:512 lds
  v_mfma_f32_32x32x16_bf16 v[16:31], a[160:163], v[32:35], v[16:31]
  s_waitcnt lgkmcnt(2)
  v_mfma_f32_32x32x16_bf16 v[0:15], a[20:23], v[36:39], v[0:15]
  ds_read_b128 v[32:35], v203 offset:38912
  s_add_u32 m0, s67, 4480
  s_nop 0
  buffer_load_dwordx4 v202, s[4:7], s60 offen offset:640 lds
  v_mfma_f32_32x32x16_bf16 v[16:31], a[164:167], v[36:39], v[16:31]
  s_waitcnt lgkmcnt(2)
  v_mfma_f32_32x32x16_bf16 v[0:15], a[24:27], v[40:43], v[0:15]
  ds_read_b128 v[36:39], v204 offset:38912
  s_add_u32 m0, s67, 5376
  s_nop 0
  buffer_load_dwordx4 v202, s[4:7], s60 offen offset:768 lds
  v_mfma_f32_32x32x16_bf16 v[16:31], a[168:171], v[40:43], v[16:31]
  s_waitcnt lgkmcnt(2)
  v_mfma_f32_32x32x16_bf16 v[0:15], a[28:31], v[44:47], v[0:15]
  ds_read_b128 v[40:43], v205 offset:38912
  s_add_u32 m0, s67, 6272
  s_nop 0
  buffer_load_dwordx4 v202, s[4:7], s60 offen offset:896 lds
  v_mfma_f32_32x32x16_bf16 v[16:31], a[172:175], v[44:47], v[16:31]
  s_waitcnt lgkmcnt(2)
  v_mfma_f32_32x32x16_bf16 v[0:15], a[32:35], v[32:35], v[0:15]
  ds_read_b128 v[44:47], v206 offset:38912
  s_add_u32 m0, s67, 7168
  s_nop 0
  buffer_load_dwordx4 v202, s[4:7], s60 offen offset:1024 lds
  v_mfma_f32_32x32x16_bf16 v[16:31], a[176:179], v[32:35], v[16:31]
  s_waitcnt lgkmcnt(2)
  v_mfma_f32_32x32x16_bf16 v[0:15], a[36:39], v[36:39], v[0:15]
  ds_read_b128 v[32:35], v203 offset:39936
  v_mfma_f32_32x32x16_bf16 v[16:31], a[180:183], v[36:39], v[16:31]
  s_waitcnt lgkmcnt(2)
  v_mfma_f32_32x32x16_bf16 v[0:15], a[40:43], v[40:43], v[0:15]
  ds_read_b128 v[36:39], v204 offset:39936
  v_mfma_f32_32x32x16_bf16 v[16:31], a[184:187], v[40:43], v[16:31]
  s_waitcnt lgkmcnt(2)
  v_mfma_f32_32x32x16_bf16 v[0:15], a[44:47], v[44:47], v[0:15]
  ds_read_b128 v[40:43], v205 offset:39936
  v_mfma_f32_32x32x16_bf16 v[16:31], a[188:191], v[44:47], v[16:31]
  s_waitcnt lgkmcnt(2)
  v_mfma_f32_32x32x16_bf16 v[0:15], a[48:51], v[32:35], v[0:15]
  ds_read_b128 v[44:47], v206 offset:39936
  v_mfma_f32_32x32x16_bf16 v[16:31], a[192:195], v[32:35], v[16:31]
  s_waitcnt lgkmcnt(2)
  v_mfma_f32_32x32x16_bf16 v[0:15], a[52:55], v[36:39], v[0:15]
  ds_read_b128 v[32:35], v203 offset:40960
  v_mfma_f32_32x32x16_bf16 v[16:31], a[196:199], v[36:39], v[16:31]
  s_waitcnt lgkmcnt(2)
  v_mfma_f32_32x32x16_bf16 v[0:15], a[56:59], v[40:43], v[0:15]
  ds_read_b128 v[36:39], v204 offset:40960
  v_mfma_f32_32x32x16_bf16 v[16:31], a[200:203], v[40:43], v[16:31]
  s_waitcnt lgkmcnt(2)
  v_mfma_f32_32x32x16_bf16 v[0:15], a[60:63], v[44:47], v[0:15]
  ds_read_b128 v[40:43], v205 offset:40960
  v_mfma_f32_32x32x16_bf16 v[16:31], a[204:207], v[44:47], v[16:31]
  s_waitcnt lgkmcnt(2)
  v_mfma_f32_32x32x16_bf16 v[0:15], a[64:67], v[32:35], v[0:15]
  ds_read_b128 v[44:47], v206 offset:40960
  v_mfma_f32_32x32x16_bf16 v[16:31], a[208:211], v[32:35], v[16:31]
  s_waitcnt lgkmcnt(2)
  v_mfma_f32_32x32x16_bf16 v[0:15], a[68:71], v[36:39], v[0:15]
  ds_read_b128 v[32:35], v203 offset:41984
  v_mfma_f32_32x32x16_bf16 v[16:31], a[212:215], v[36:39], v[16:31]
  s_waitcnt lgkmcnt(2)
  v_mfma_f32_32x32x16_bf16 v[0:15], a[72:75], v[40:43], v[0:15]
  ds_read_b128 v[36:39], v204 offset:41984
  v_mfma_f32_32x32x16_bf16 v[16:31], a[216:219], v[40:43], v[16:31]
  s_waitcnt lgkmcnt(2)
  v_mfma_f32_32x32x16_bf16 v[0:15], a[76:79], v[44:47], v[0:15]
  ds_read_b128 v[40:43], v205 offset:41984
  v_mfma_f32_32x32x16_bf16 v[16:31], a[220:223], v[44:47], v[16:31]
  s_waitcnt lgkmcnt(2)
  v_mfma_f32_32x32x16_bf16 v[0:15], a[80:83], v[32:35], v[0:15]
  ds_read_b128 v[44:47], v206 offset:41984
  v_mfma_f32_32x32x16_bf16 v[16:31], a[224:227], v[32:35], v[16:31]
  s_waitcnt lgkmcnt(2)
  v_mfma_f32_32x32x16_bf16 v[0:15], a[84:87], v[36:39], v[0:15]
  ds_read_b128 v[32:35], v203 offset:43008
  v_mfma_f32_32x32x16_bf16 v[16:31], a[228:231], v[36:39], v[16:31]
  s_waitcnt lgkmcnt(2)
  v_mfma_f32_32x32x16_bf16 v[0:15], a[88:91], v[40:43], v[0:15]
  ds_read_b128 v[36:39], v204 offset:43008
  v_mfma_f32_32x32x16_bf16 v[16:31], a[232:235], v[40:43], v[16:31]
  s_waitcnt lgkmcnt(2)
  v_mfma_f32_32x32x16_bf16 v[0:15], a[92:95], v[44:47], v[0:15]
  ds_read_b128 v[40:43], v205 offset:43008
  v_mfma_f32_32x32x16_bf16 v[16:31], a[236:239], v[44:47], v[16:31]
  s_waitcnt lgkmcnt(2)
  v_mfma_f32_32x32x16_bf16 v[0:15], a[96:99], v[32:35], v[0:15]
  ds_read_b128 v[44:47], v206 offset:43008
  v_mfma_f32_32x32x16_bf16 v[16:31], a[240:243], v[32:35], v[16:31]
  s_waitcnt lgkmcnt(2)
  v_mfma_f32_32x32x16_bf16 v[0:15], a[100:103], v[36:39], v[0:15]
  ds_read_b128 v[32:35], v203 offset:44032
  v_mfma_f32_32x32x16_bf16 v[16:31], a[244:247], v[36:39], v[16:31]
  s_waitcnt lgkmcnt(2)
  v_mfma_f32_32x32x16_bf16 v[0:15], a[104:107], v[40:43], v[0:15]
  ds_read_b128 v[36:39], v204 offset:44032
  v_mfma_f32_32x32x16_bf16 v[16:31], a[248:251], v[40:43], v[16:31]
  s_waitcnt lgkmcnt(2)
  v_mfma_f32_32x32x16_bf16 v[0:15], a[108:111], v[44:47], v[0:15]
  ds_read_b128 v[40:43], v205 offset:44032
  v_mfma_f32_32x32x16_bf16 v[16:31], a[252:255], v[44:47], v[16:31]
  s_waitcnt lgkmcnt(2)
  v_mfma_f32_32x32x16_bf16 v[0:15], a[112:115], v[32:35], v[0:15]
  ds_read_b128 v[44:47], v206 offset:44032
  v_mfma_f32_32x32x16_bf16 v[16:31], v[224:227], v[32:35], v[16:31]
  s_waitcnt lgkmcnt(2)
  v_mfma_f32_32x32x16_bf16 v[0:15], a[116:119], v[36:39], v[0:15]
  ds_read_b128 v[32:35], v203 offset:45056
  v_mfma_f32_32x32x16_bf16 v[16:31], v[228:231], v[36:39], v[16:31]
  s_waitcnt lgkmcnt(2)
  v_mfma_f32_32x32x16_bf16 v[0:15], a[120:123], v[40:43], v[0:15]
  ds_read_b128 v[36:39], v204 offset:45056
  v_mfma_f32_32x32x16_bf16 v[16:31], v[232:235], v[40:43], v[16:31]
  s_waitcnt lgkmcnt(2)
  v_mfma_f32_32x32x16_bf16 v[0:15], a[124:127], v[44:47], v[0:15]
  ds_read_b128 v[40:43], v205 offset:45056
  v_mfma_f32_32x32x16_bf16 v[16:31], v[236:239], v[44:47], v[16:31]
  s_waitcnt lgkmcnt(2)
  v_mfma_f32_32x32x16_bf16 v[0:15], a[128:131], v[32:35], v[0:15]
  ds_read_b128 v[44:47], v206 offset:45056
  v_mfma_f32_32x32x16_bf16 v[16:31], v[240:243], v[32:35], v[16:31]
  s_waitcnt lgkmcnt(2)
  v_mfma_f32_32x32x16_bf16 v[0:15], a[132:135], v[36:39], v[0:15]
  v_mfma_f32_32x32x16_bf16 v[16:31], v[244:247], v[36:39], v[16:31]
  s_waitcnt lgkmcnt(1)
  v_mfma_f32_32x32x16_bf16 v[0:15], a[136:139], v[40:43], v[0:15]
  v_mfma_f32_32x32x16_bf16 v[16:31], v[248:251], v[40:43], v[16:31]
  s_waitcnt lgkmcnt(0)
  v_mfma_f32_32x32x16_bf16 v[0:15], a[140:143], v[44:47], v[0:15]
  v_mfma_f32_32x32x16_bf16 v[16:31], v[252:255], v[44:47], v[16:31]
  s_add_u32 s60, s60, 36864
  s_nop 2
  v_cvt_pk_bf16_f32 v48, v0, v1
  v_cvt_pk_bf16_f32 v49, v2, v3
  ds_write2_b32 v218, v48, v49 offset0:0 offset1:1
  v_cvt_pk_bf16_f32 v48, v4, v5
  v_cvt_pk_bf16_f32 v49, v6, v7
  ds_write2_b32 v218, v48, v49 offset0:4 offset1:5
  v_cvt_pk_bf16_f32 v48, v8, v9
  v_cvt_pk_bf16_f32 v49, v10, v11
  ds_write2_b32 v218, v48, v49 offset0:8 offset1:9
  v_cvt_pk_bf16_f32 v48, v12, v13
  v_cvt_pk_bf16_f32 v49, v14, v15
  ds_write2_b32 v218, v48, v49 offset0:12 offset1:13
  v_cvt_pk_bf16_f32 v48, v16, v17
  v_cvt_pk_bf16_f32 v49, v18, v19
  ds_write2_b32 v218, v48, v49 offset0:64 offset1:65
  v_cvt_pk_bf16_f32 v48, v20, v21
  v_cvt_pk_bf16_f32 v49, v22, v23
  ds_write2_b32 v218, v48, v49 offset0:68 offset1:69
  v_cvt_pk_bf16_f32 v48, v24, v25
  v_cvt_pk_bf16_f32 v49, v26, v27
  ds_write2_b32 v218, v48, v49 offset0:72 offset1:73
  v_cvt_pk_bf16_f32 v48, v28, v29
  v_cvt_pk_bf16_f32 v49, v30, v31
  ds_write2_b32 v218, v48, v49 offset0:76 offset1:77
  v_add_u32 v218, 16512, v218
  s_waitcnt vmcnt(0) lgkmcnt(0)
  s_barrier
  ds_read_b128 v[32:35], v203 offset:0
  ds_read_b128 v[36:39], v204 offset:0
  ds_read_b128 v[40:43], v205 offset:0
  s_waitcnt lgkmcnt(2)
  v_mfma_f32_32x32x16_bf16 v[0:15], a[0:3], v[32:35], 0
  ds_read_b128 v[44:47], v206 offset:0
  s_add_u32 m0, s67, 36864
  s_nop 0
  buffer_load_dwordx4 v202, s[4:7], s60 offen offset:0 lds
  v_mfma_f32_32x32x16_bf16 v[16:31], a[144:147], v[32:35], 0
  s_waitcnt lgkmcnt(2)
  v_mfma_f32_32x32x16_bf16 v[0:15], a[4:7], v[36:39], v[0:15]
  ds_read_b128 v[32:35], v203 offset:1024
  s_add_u32 m0, s67, 37760
  s_nop 0
  buffer_load_dwordx4 v202, s[4:7], s60 offen offset:128 lds
  v_mfma_f32_32x32x16_bf16 v[16:31], a[148:151], v[36:39], v[16:31]
  s_waitcnt lgkmcnt(2)
  v_mfma_f32_32x32x16_bf16 v[0:15], a[8:11], v[40:43], v[0:15]
  ds_read_b128 v[36:39], v204 offset:1024
  s_add_u32 m0, s67, 38656
  s_nop 0
  buffer_load_dwordx4 v202, s[4:7], s60 offen offset:256 lds
  v_mfma_f32_32x32x16_bf16 v[16:31], a[152:155], v[40:43], v[16:31]
  s_waitcnt lgkmcnt(2)
  v_mfma_f32_32x32x16_bf16 v[0:15], a[12:15], v[44:47], v[0:15]
  ds_read_b128 v[40:43], v205 offset:1024
  s_add_u32 m0, s67, 39552
  s_nop 0
  buffer_load_dwordx4 v202, s[4:7], s60 offen offset:384 lds
  v_mfma_f32_32x32x16_bf16 v[16:31], a[156:159], v[44:47], v[16:31]
  s_waitcnt lgkmcnt(2)
  v_mfma_f32_32x32x16_bf16 v[0:15], a[16:19], v[32:35], v[0:15]
  ds_read_b128 v[44:47], v206 offset:1024
  s_add_u32 m0, s67, 40448
  s_nop 0
  buffer_load_dwordx4 v202, s[4:7], s60 offen offset:512 lds
  v_mfma_f32_32x32x16_bf16 v[16:31], a[160:163], v[32:35], v[16:31]
  s_waitcnt lgkmcnt(2)
  v_mfma_f32_32x32x16_bf16 v[0:15], a[20:23], v[36:39], v[0:15]
  ds_read_b128 v[32:35], v203 offset:2048
  s_add_u32 m0, s67, 41344
  s_nop 0
  buffer_load_dwordx4 v202, s[4:7], s60 offen offset:640 lds
  v_mfma_f32_32x32x16_bf16 v[16:31], a[164:167], v[36:39], v[16:31]
  s_waitcnt lgkmcnt(2)
  v_mfma_f32_32x32x16_bf16 v[0:15], a[24:27], v[40:43], v[0:15]
  ds_read_b128 v[36:39], v204 offset:2048
  s_add_u32 m0, s67, 42240
  s_nop 0
  buffer_load_dwordx4 v202, s[4:7], s60 offen offset:768 lds
  v_mfma_f32_32x32x16_bf16 v[16:31], a[168:171], v[40:43], v[16:31]
  s_waitcnt lgkmcnt(2)
  v_mfma_f32_32x32x16_bf16 v[0:15], a[28:31], v[44:47], v[0:15]
  ds_read_b128 v[40:43], v205 offset:2048
  s_add_u32 m0, s67, 43136
  s_nop 0
  buffer_load_dwordx4 v202, s[4:7], s60 offen offset:896 lds
  v_mfma_f32_32x32x16_bf16 v[16:31], a[172:175], v[44:47], v[16:31]
  s_waitcnt lgkmcnt(2)
  v_mfma_f32_32x32x16_bf16 v[0:15], a[32:35], v[32:35], v[0:15]
  ds_read_b128 v[44:47], v206 offset:2048
  s_add_u32 m0, s67, 44032
  s_nop 0
  buffer_load_dwordx4 v202, s[4:7], s60 offen offset:1024 lds
  v_mfma_f32_32x32x16_bf16 v[16:31], a[176:179], v[32:35], v[16:31]
  s_waitcnt lgkmcnt(2)
  v_mfma_f32_32x32x16_bf16 v[0:15], a[36:39], v[36:39], v[0:15]
  ds_read_b128 v[32:35], v203 offset:3072
  v_mfma_f32_32x32x16_bf16 v[16:31], a[180:183], v[36:39], v[16:31]
  s_waitcnt lgkmcnt(2)
  v_mfma_f32_32x32x16_bf16 v[0:15], a[40:43], v[40:43], v[0:15]
  ds_read_b128 v[36:39], v204 offset:3072
  v_mfma_f32_32x32x16_bf16 v[16:31], a[184:187], v[40:43], v[16:31]
  s_waitcnt lgkmcnt(2)
  v_mfma_f32_32x32x16_bf16 v[0:15], a[44:47], v[44:47], v[0:15]
  ds_read_b128 v[40:43], v205 offset:3072
  v_mfma_f32_32x32x16_bf16 v[16:31], a[188:191], v[44:47], v[16:31]
  s_waitcnt lgkmcnt(2)
  v_mfma_f32_32x32x16_bf16 v[0:15], a[48:51], v[32:35], v[0:15]
  ds_read_b128 v[44:47], v206 offset:3072
  v_mfma_f32_32x32x16_bf16 v[16:31], a[192:195], v[32:35], v[16:31]
  s_waitcnt lgkmcnt(2)
  v_mfma_f32_32x32x16_bf16 v[0:15], a[52:55], v[36:39], v[0:15]
  ds_read_b128 v[32:35], v203 offset:4096
  v_mfma_f32_32x32x16_bf16 v[16:31], a[196:199], v[36:39], v[16:31]
  s_waitcnt lgkmcnt(2)
  v_mfma_f32_32x32x16_bf16 v[0:15], a[56:59], v[40:43], v[0:15]
  ds_read_b128 v[36:39], v204 offset:4096
  v_mfma_f32_32x32x16_bf16 v[16:31], a[200:203], v[40:43], v[16:31]
  s_waitcnt lgkmcnt(2)
  v_mfma_f32_32x32x16_bf16 v[0:15], a[60:63], v[44:47], v[0:15]
  ds_read_b128 v[40:43], v205 offset:4096
  v_mfma_f32_32x32x16_bf16 v[16:31], a[204:207], v[44:47], v[16:31]
  s_waitcnt lgkmcnt(2)
  v_mfma_f32_32x32x16_bf16 v[0:15], a[64:67], v[32:35], v[0:15]
  ds_read_b128 v[44:47], v206 offset:4096
  v_mfma_f32_32x32x16_bf16 v[16:31], a[208:211], v[32:35], v[16:31]
  s_waitcnt lgkmcnt(2)
  v_mfma_f32_32x32x16_bf16 v[0:15], a[68:71], v[36:39], v[0:15]
  ds_read_b128 v[32:35], v203 offset:5120
  v_mfma_f32_32x32x16_bf16 v[16:31], a[212:215], v[36:39], v[16:31]
  s_waitcnt lgkmcnt(2)
  v_mfma_f32_32x32x16_bf16 v[0:15], a[72:75], v[40:43], v[0:15]
  ds_read_b128 v[36:39], v204 offset:5120
  v_mfma_f32_32x32x16_bf16 v[16:31], a[216:219], v[40:43], v[16:31]
  s_waitcnt lgkmcnt(2)
  v_mfma_f32_32x32x16_bf16 v[0:15], a[76:79], v[44:47], v[0:15]
  ds_read_b128 v[40:43], v205 offset:5120
  v_mfma_f32_32x32x16_bf16 v[16:31], a[220:223], v[44:47], v[16:31]
  s_waitcnt lgkmcnt(2)
  v_mfma_f32_32x32x16_bf16 v[0:15], a[80:83], v[32:35], v[0:15]
  ds_read_b128 v[44:47], v206 offset:5120
  v_mfma_f32_32x32x16_bf16 v[16:31], a[224:227], v[32:35], v[16:31]
  s_waitcnt lgkmcnt(2)
  v_mfma_f32_32x32x16_bf16 v[0:15], a[84:87], v[36:39], v[0:15]
  ds_read_b128 v[32:35], v203 offset:6144
  v_mfma_f32_32x32x16_bf16 v[16:31], a[228:231], v[36:39], v[16:31]
  s_waitcnt lgkmcnt(2)
  v_mfma_f32_32x32x16_bf16 v[0:15], a[88:91], v[40:43], v[0:15]
  ds_read_b128 v[36:39], v204 offset:6144
  v_mfma_f32_32x32x16_bf16 v[16:31], a[232:235], v[40:43], v[16:31]
  s_waitcnt lgkmcnt(2)
  v_mfma_f32_32x32x16_bf16 v[0:15], a[92:95], v[44:47], v[0:15]
  ds_read_b128 v[40:43], v205 offset:6144
  v_mfma_f32_32x32x16_bf16 v[16:31], a[236:239], v[44:47], v[16:31]
  s_waitcnt lgkmcnt(2)
  v_mfma_f32_32x32x16_bf16 v[0:15], a[96:99], v[32:35], v[0:15]
  ds_read_b128 v[44:47], v206 offset:6144
  v_mfma_f32_32x32x16_bf16 v[16:31], a[240:243], v[32:35], v[16:31]
  s_waitcnt lgkmcnt(2)
  v_mfma_f32_32x32x16_bf16 v[0:15], a[100:103], v[36:39], v[0:15]
  ds_read_b128 v[32:35], v203 offset:7168
  v_mfma_f32_32x32x16_bf16 v[16:31], a[244:247], v[36:39], v[16:31]
  s_waitcnt lgkmcnt(2)
  v_mfma_f32_32x32x16_bf16 v[0:15], a[104:107], v[40:43], v[0:15]
  ds_read_b128 v[36:39], v204 offset:7168
  v_mfma_f32_32x32x16_bf16 v[16:31], a[248:251], v[40:43], v[16:31]
  s_waitcnt lgkmcnt(2)
  v_mfma_f32_32x32x16_bf16 v[0:15], a[108:111], v[44:47], v[0:15]
  ds_read_b128 v[40:43], v205 offset:7168
  v_mfma_f32_32x32x16_bf16 v[16:31], a[252:255], v[44:47], v[16:31]
  s_waitcnt lgkmcnt(2)
  v_mfma_f32_32x32x16_bf16 v[0:15], a[112:115], v[32:35], v[0:15]
  ds_read_b128 v[44:47], v206 offset:7168
  v_mfma_f32_32x32x16_bf16 v[16:31], v[224:227], v[32:35], v[16:31]
  s_waitcnt lgkmcnt(2)
  v_mfma_f32_32x32x16_bf16 v[0:15], a[116:119], v[36:39], v[0:15]
  ds_read_b128 v[32:35], v203 offset:8192
  v_mfma_f32_32x32x16_bf16 v[16:31], v[228:231], v[36:39], v[16:31]
  s_waitcnt lgkmcnt(2)
  v_mfma_f32_32x32x16_bf16 v[0:15], a[120:123], v[40:43], v[0:15]
  ds_read_b128 v[36:39], v204 offset:8192
  v_mfma_f32_32x32x16_bf16 v[16:31], v[232:235], v[40:43], v[16:31]
  s_waitcnt lgkmcnt(2)
  v_mfma_f32_32x32x16_bf16 v[0:15], a[124:127], v[44:47], v[0:15]
  ds_read_b128 v[40:43], v205 offset:8192
  v_mfma_f32_32x32x16_bf16 v[16:31], v[236:239], v[44:47], v[16:31]
  s_waitcnt lgkmcnt(2)
  v_mfma_f32_32x32x16_bf16 v[0:15], a[128:131], v[32:35], v[0:15]
  ds_read_b128 v[44:47], v206 offset:8192
  v_mfma_f32_32x32x16_bf16 v[16:31], v[240:243], v[32:35], v[16:31]
  s_waitcnt lgkmcnt(2)
  v_mfma_f32_32x32x16_bf16 v[0:15], a[132:135], v[36:39], v[0:15]
  v_mfma_f32_32x32x16_bf16 v[16:31], v[244:247], v[36:39], v[16:31]
  s_waitcnt lgkmcnt(1)
  v_mfma_f32_32x32x16_bf16 v[0:15], a[136:139], v[40:43], v[0:15]
  v_mfma_f32_32x32x16_bf16 v[16:31], v[248:251], v[40:43], v[16:31]
  s_waitcnt lgkmcnt(0)
  v_mfma_f32_32x32x16_bf16 v[0:15], a[140:143], v[44:47], v[0:15]
  v_mfma_f32_32x32x16_bf16 v[16:31], v[252:255], v[44:47], v[16:31]
  s_add_u32 s60, s60, 36864
  s_nop 2
  v_cvt_pk_bf16_f32 v48, v0, v1
  v_cvt_pk_bf16_f32 v49, v2, v3
  ds_write2_b32 v218, v48, v49 offset0:0 offset1:1
  v_cvt_pk_bf16_f32 v48, v4, v5
  v_cvt_pk_bf16_f32 v49, v6, v7
  ds_write2_b32 v218, v48, v49 offset0:4 offset1:5
  v_cvt_pk_bf16_f32 v48, v8, v9
  v_cvt_pk_bf16_f32 v49, v10, v11
  ds_write2_b32 v218, v48, v49 offset0:8 offset1:9
  v_cvt_pk_bf16_f32 v48, v12, v13
  v_cvt_pk_bf16_f32 v49, v14, v15
  ds_write2_b32 v218, v48, v49 offset0:12 offset1:13
  v_cvt_pk_bf16_f32 v48, v16, v17
  v_cvt_pk_bf16_f32 v49, v18, v19
  ds_write2_b32 v218, v48, v49 offset0:64 offset1:65
  v_cvt_pk_bf16_f32 v48, v20, v21
  v_cvt_pk_bf16_f32 v49, v22, v23
  ds_write2_b32 v218, v48, v49 offset0:68 offset1:69
  v_cvt_pk_bf16_f32 v48, v24, v25
  v_cvt_pk_bf16_f32 v49, v26, v27
  ds_write2_b32 v218, v48, v49 offset0:72 offset1:73
  v_cvt_pk_bf16_f32 v48, v28, v29
  v_cvt_pk_bf16_f32 v49, v30, v31
  ds_write2_b32 v218, v48, v49 offset0:76 offset1:77
  v_add_u32 v218, 16512, v218
  s_waitcnt vmcnt(0) lgkmcnt(0)
  s_barrier
  ds_read_b128 v[32:35], v203 offset:36864
  ds_read_b128 v[36:39], v204 offset:36864
  ds_read_b128 v[40:43], v205 offset:36864
  s_waitcnt lgkmcnt(2)
  v_mfma_f32_32x32x16_bf16 v[0:15], a[0:3], v[32:35], 0
  ds_read_b128 v[44:47], v206 offset:36864
  s_add_u32 m0, s67, 0
  s_nop 0
  buffer_load_dwordx4 v202, s[4:7], s60 offen offset:0 lds
  v_mfma_f32_32x32x16_bf16 v[16:31], a[144:147], v[32:35], 0
  s_waitcnt lgkmcnt(2)
  v_mfma_f32_32x32x16_bf16 v[0:15], a[4:7], v[36:39], v[0:15]
  ds_read_b128 v[32:35], v203 offset:37888
  s_add_u32 m0, s67, 896
  s_nop 0
  buffer_load_dwordx4 v202, s[4:7], s60 offen offset:128 lds
  v_mfma_f32_32x32x16_bf16 v[16:31], a[148:151], v[36:39], v[16:31]
  s_waitcnt lgkmcnt(2)
  v_mfma_f32_32x32x16_bf16 v[0:15], a[8:11], v[40:43], v[0:15]
  ds_read_b128 v[36:39], v204 offset:37888
  s_add_u32 m0, s67, 1792
  s_nop 0
  buffer_load_dwordx4 v202, s[4:7], s60 offen offset:256 lds
  v_mfma_f32_32x32x16_bf16 v[16:31], a[152:155], v[40:43], v[16:31]
  s_waitcnt lgkmcnt(2)
  v_mfma_f32_32x32x16_bf16 v[0:15], a[12:15], v[44:47], v[0:15]
  ds_read_b128 v[40:43], v205 offset:37888
  s_add_u32 m0, s67, 2688
  s_nop 0
  buffer_load_dwordx4 v202, s[4:7], s60 offen offset:384 lds
  v_mfma_f32_32x32x16_bf16 v[16:31], a[156:159], v[44:47], v[16:31]
  s_waitcnt lgkmcnt(2)
  v_mfma_f32_32x32x16_bf16 v[0:15], a[16:19], v[32:35], v[0:15]
  ds_read_b128 v[44:47], v206 offset:37888
  s_add_u32 m0, s67, 3584
  s_nop 0
  buffer_load_dwordx4 v202, s[4:7], s60 offen offset:512 lds
  v_mfma_f32_32x32x16_bf16 v[16:31], a[160:163], v[32:35], v[16:31]
  s_waitcnt lgkmcnt(2)
  v_mfma_f32_32x32x16_bf16 v[0:15], a[20:23], v[36:39], v[0:15]
  ds_read_b128 v[32:35], v203 offset:38912
  s_add_u32 m0, s67, 4480
  s_nop 0
  buffer_load_dwordx4 v202, s[4:7], s60 offen offset:640 lds
  v_mfma_f32_32x32x16_bf16 v[16:31], a[164:167], v[36:39], v[16:31]
  s_waitcnt lgkmcnt(2)
  v_mfma_f32_32x32x16_bf16 v[0:15], a[24:27], v[40:43], v[0:15]
  ds_read_b128 v[36:39], v204 offset:38912
  s_add_u32 m0, s67, 5376
  s_nop 0
  buffer_load_dwordx4 v202, s[4:7], s60 offen offset:768 lds
  v_mfma_f32_32x32x16_bf16 v[16:31], a[168:171], v[40:43], v[16:31]
  s_waitcnt lgkmcnt(2)
  v_mfma_f32_32x32x16_bf16 v[0:15], a[28:31], v[44:47], v[0:15]
  ds_read_b128 v[40:43], v205 offset:38912
  s_add_u32 m0, s67, 6272
  s_nop 0
  buffer_load_dwordx4 v202, s[4:7], s60 offen offset:896 lds
  v_mfma_f32_32x32x16_bf16 v[16:31], a[172:175], v[44:47], v[16:31]
  s_waitcnt lgkmcnt(2)
  v_mfma_f32_32x32x16_bf16 v[0:15], a[32:35], v[32:35], v[0:15]
  ds_read_b128 v[44:47], v206 offset:38912
  s_add_u32 m0, s67, 7168
  s_nop 0
  buffer_load_dwordx4 v202, s[4:7], s60 offen offset:1024 lds
  v_mfma_f32_32x32x16_bf16 v[16:31], a[176:179], v[32:35], v[16:31]
  s_waitcnt lgkmcnt(2)
  v_mfma_f32_32x32x16_bf16 v[0:15], a[36:39], v[36:39], v[0:15]
  ds_read_b128 v[32:35], v203 offset:39936
  v_mfma_f32_32x32x16_bf16 v[16:31], a[180:183], v[36:39], v[16:31]
  s_waitcnt lgkmcnt(2)
  v_mfma_f32_32x32x16_bf16 v[0:15], a[40:43], v[40:43], v[0:15]
  ds_read_b128 v[36:39], v204 offset:39936
  v_mfma_f32_32x32x16_bf16 v[16:31], a[184:187], v[40:43], v[16:31]
  s_waitcnt lgkmcnt(2)
  v_mfma_f32_32x32x16_bf16 v[0:15], a[44:47], v[44:47], v[0:15]
  ds_read_b128 v[40:43], v205 offset:39936
  v_mfma_f32_32x32x16_bf16 v[16:31], a[188:191], v[44:47], v[16:31]
  s_waitcnt lgkmcnt(2)
  v_mfma_f32_32x32x16_bf16 v[0:15], a[48:51], v[32:35], v[0:15]
  ds_read_b128 v[44:47], v206 offset:39936
  v_mfma_f32_32x32x16_bf16 v[16:31], a[192:195], v[32:35], v[16:31]
  s_waitcnt lgkmcnt(2)
  v_mfma_f32_32x32x16_bf16 v[0:15], a[52:55], v[36:39], v[0:15]
  ds_read_b128 v[32:35], v203 offset:40960
  v_mfma_f32_32x32x16_bf16 v[16:31], a[196:199], v[36:39], v[16:31]
  s_waitcnt lgkmcnt(2)
  v_mfma_f32_32x32x16_bf16 v[0:15], a[56:59], v[40:43], v[0:15]
  ds_read_b128 v[36:39], v204 offset:40960
  v_mfma_f32_32x32x16_bf16 v[16:31], a[200:203], v[40:43], v[16:31]
  s_waitcnt lgkmcnt(2)
  v_mfma_f32_32x32x16_bf16 v[0:15], a[60:63], v[44:47], v[0:15]
  ds_read_b128 v[40:43], v205 offset:40960
  v_mfma_f32_32x32x16_bf16 v[16:31], a[204:207], v[44:47], v[16:31]
  s_waitcnt lgkmcnt(2)
  v_mfma_f32_32x32x16_bf16 v[0:15], a[64:67], v[32:35], v[0:15]
  ds_read_b128 v[44:47], v206 offset:40960
  v_mfma_f32_32x32x16_bf16 v[16:31], a[208:211], v[32:35], v[16:31]
  s_waitcnt lgkmcnt(2)
  v_mfma_f32_32x32x16_bf16 v[0:15], a[68:71], v[36:39], v[0:15]
  ds_read_b128 v[32:35], v203 offset:41984
  v_mfma_f32_32x32x16_bf16 v[16:31], a[212:215], v[36:39], v[16:31]
  s_waitcnt lgkmcnt(2)
  v_mfma_f32_32x32x16_bf16 v[0:15], a[72:75], v[40:43], v[0:15]
  ds_read_b128 v[36:39], v204 offset:41984
  v_mfma_f32_32x32x16_bf16 v[16:31], a[216:219], v[40:43], v[16:31]
  s_waitcnt lgkmcnt(2)
  v_mfma_f32_32x32x16_bf16 v[0:15], a[76:79], v[44:47], v[0:15]
  ds_read_b128 v[40:43], v205 offset:41984
  v_mfma_f32_32x32x16_bf16 v[16:31], a[220:223], v[44:47], v[16:31]
  s_waitcnt lgkmcnt(2)
  v_mfma_f32_32x32x16_bf16 v[0:15], a[80:83], v[32:35], v[0:15]
  ds_read_b128 v[44:47], v206 offset:41984
  v_mfma_f32_32x32x16_bf16 v[16:31], a[224:227], v[32:35], v[16:31]
  s_waitcnt lgkmcnt(2)
  v_mfma_f32_32x32x16_bf16 v[0:15], a[84:87], v[36:39], v[0:15]
  ds_read_b128 v[32:35], v203 offset:43008
  v_mfma_f32_32x32x16_bf16 v[16:31], a[228:231], v[36:39], v[16:31]
  s_waitcnt lgkmcnt(2)
  v_mfma_f32_32x32x16_bf16 v[0:15], a[88:91], v[40:43], v[0:15]
  ds_read_b128 v[36:39], v204 offset:43008
  v_mfma_f32_32x32x16_bf16 v[16:31], a[232:235], v[40:43], v[16:31]
  s_waitcnt lgkmcnt(2)
  v_mfma_f32_32x32x16_bf16 v[0:15], a[92:95], v[44:47], v[0:15]
  ds_read_b128 v[40:43], v205 offset:43008
  v_mfma_f32_32x32x16_bf16 v[16:31], a[236:239], v[44:47], v[16:31]
  s_waitcnt lgkmcnt(2)
  v_mfma_f32_32x32x16_bf16 v[0:15], a[96:99], v[32:35], v[0:15]
  ds_read_b128 v[44:47], v206 offset:43008
  v_mfma_f32_32x32x16_bf16 v[16:31], a[240:243], v[32:35], v[16:31]
  s_waitcnt lgkmcnt(2)
  v_mfma_f32_32x32x16_bf16 v[0:15], a[100:103], v[36:39], v[0:15]
  ds_read_b128 v[32:35], v203 offset:44032
  v_mfma_f32_32x32x16_bf16 v[16:31], a[244:247], v[36:39], v[16:31]
  s_waitcnt lgkmcnt(2)
  v_mfma_f32_32x32x16_bf16 v[0:15], a[104:107], v[40:43], v[0:15]
  ds_read_b128 v[36:39], v204 offset:44032
  v_mfma_f32_32x32x16_bf16 v[16:31], a[248:251], v[40:43], v[16:31]
  s_waitcnt lgkmcnt(2)
  v_mfma_f32_32x32x16_bf16 v[0:15], a[108:111], v[44:47], v[0:15]
  ds_read_b128 v[40:43], v205 offset:44032
  v_mfma_f32_32x32x16_bf16 v[16:31], a[252:255], v[44:47], v[16:31]
  s_waitcnt lgkmcnt(2)
  v_mfma_f32_32x32x16_bf16 v[0:15], a[112:115], v[32:35], v[0:15]
  ds_read_b128 v[44:47], v206 offset:44032
  v_mfma_f32_32x32x16_bf16 v[16:31], v[224:227], v[32:35], v[16:31]
  s_waitcnt lgkmcnt(2)
  v_mfma_f32_32x32x16_bf16 v[0:15], a[116:119], v[36:39], v[0:15]
  ds_read_b128 v[32:35], v203 offset:45056
  v_mfma_f32_32x32x16_bf16 v[16:31], v[228:231], v[36:39], v[16:31]
  s_waitcnt lgkmcnt(2)
  v_mfma_f32_32x32x16_bf16 v[0:15], a[120:123], v[40:43], v[0:15]
  ds_read_b128 v[36:39], v204 offset:45056
  v_mfma_f32_32x32x16_bf16 v[16:31], v[232:235], v[40:43], v[16:31]
  s_waitcnt lgkmcnt(2)
  v_mfma_f32_32x32x16_bf16 v[0:15], a[124:127], v[44:47], v[0:15]
  ds_read_b128 v[40:43], v205 offset:45056
  v_mfma_f32_32x32x16_bf16 v[16:31], v[236:239], v[44:47], v[16:31]
  s_waitcnt lgkmcnt(2)
  v_mfma_f32_32x32x16_bf16 v[0:15], a[128:131], v[32:35], v[0:15]
  ds_read_b128 v[44:47], v206 offset:45056
  v_mfma_f32_32x32x16_bf16 v[16:31], v[240:243], v[32:35], v[16:31]
  s_waitcnt lgkmcnt(2)
  v_mfma_f32_32x32x16_bf16 v[0:15], a[132:135], v[36:39], v[0:15]
  v_mfma_f32_32x32x16_bf16 v[16:31], v[244:247], v[36:39], v[16:31]
  s_waitcnt lgkmcnt(1)
  v_mfma_f32_32x32x16_bf16 v[0:15], a[136:139], v[40:43], v[0:15]
  v_mfma_f32_32x32x16_bf16 v[16:31], v[248:251], v[40:43], v[16:31]
  s_waitcnt lgkmcnt(0)
  v_mfma_f32_32x32x16_bf16 v[0:15], a[140:143], v[44:47], v[0:15]
  v_mfma_f32_32x32x16_bf16 v[16:31], v[252:255], v[44:47], v[16:31]
  s_add_u32 s60, s60, 36864
  s_nop 2
  v_cvt_pk_bf16_f32 v48, v0, v1
  v_cvt_pk_bf16_f32 v49, v2, v3
  ds_write2_b32 v218, v48, v49 offset0:0 offset1:1
  v_cvt_pk_bf16_f32 v48, v4, v5
  v_cvt_pk_bf16_f32 v49, v6, v7
  ds_write2_b32 v218, v48, v49 offset0:4 offset1:5
  v_cvt_pk_bf16_f32 v48, v8, v9
  v_cvt_pk_bf16_f32 v49, v10, v11
  ds_write2_b32 v218, v48, v49 offset0:8 offset1:9
  v_cvt_pk_bf16_f32 v48, v12, v13
  v_cvt_pk_bf16_f32 v49, v14, v15
  ds_write2_b32 v218, v48, v49 offset0:12 offset1:13
  v_cvt_pk_bf16_f32 v48, v16, v17
  v_cvt_pk_bf16_f32 v49, v18, v19
  ds_write2_b32 v218, v48, v49 offset0:64 offset1:65
  v_cvt_pk_bf16_f32 v48, v20, v21
  v_cvt_pk_bf16_f32 v49, v22, v23
  ds_write2_b32 v218, v48, v49 offset0:68 offset1:69
  v_cvt_pk_bf16_f32 v48, v24, v25
  v_cvt_pk_bf16_f32 v49, v26, v27
  ds_write2_b32 v218, v48, v49 offset0:72 offset1:73
  v_cvt_pk_bf16_f32 v48, v28, v29
  v_cvt_pk_bf16_f32 v49, v30, v31
  ds_write2_b32 v218, v48, v49 offset0:76 offset1:77
  v_add_u32 v218, 16512, v218
  s_waitcnt vmcnt(0) lgkmcnt(0)
  s_barrier
  ds_read_b128 v[32:35], v203 offset:0
  ds_read_b128 v[36:39], v204 offset:0
  ds_read_b128 v[40:43], v205 offset:0
  s_waitcnt lgkmcnt(2)
  v_mfma_f32_32x32x16_bf16 v[0:15], a[0:3], v[32:35], 0
  ds_read_b128 v[44:47], v206 offset:0
  v_mfma_f32_32x32x16_bf16 v[16:31], a[144:147], v[32:35], 0
  s_waitcnt lgkmcnt(2)
  v_mfma_f32_32x32x16_bf16 v[0:15], a[4:7], v[36:39], v[0:15]
  ds_read_b128 v[32:35], v203 offset:1024
  v_mfma_f32_32x32x16_bf16 v[16:31], a[148:151], v[36:39], v[16:31]
  s_waitcnt lgkmcnt(2)
  v_mfma_f32_32x32x16_bf16 v[0:15], a[8:11], v[40:43], v[0:15]
  ds_read_b128 v[36:39], v204 offset:1024
  v_mfma_f32_32x32x16_bf16 v[16:31], a[152:155], v[40:43], v[16:31]
  s_waitcnt lgkmcnt(2)
  v_mfma_f32_32x32x16_bf16 v[0:15], a[12:15], v[44:47], v[0:15]
  ds_read_b128 v[40:43], v205 offset:1024
  v_mfma_f32_32x32x16_bf16 v[16:31], a[156:159], v[44:47], v[16:31]
  s_waitcnt lgkmcnt(2)
  v_mfma_f32_32x32x16_bf16 v[0:15], a[16:19], v[32:35], v[0:15]
  ds_read_b128 v[44:47], v206 offset:1024
  v_mfma_f32_32x32x16_bf16 v[16:31], a[160:163], v[32:35], v[16:31]
  s_waitcnt lgkmcnt(2)
  v_mfma_f32_32x32x16_bf16 v[0:15], a[20:23], v[36:39], v[0:15]
  ds_read_b128 v[32:35], v203 offset:2048
  v_mfma_f32_32x32x16_bf16 v[16:31], a[164:167], v[36:39], v[16:31]
  s_waitcnt lgkmcnt(2)
  v_mfma_f32_32x32x16_bf16 v[0:15], a[24:27], v[40:43], v[0:15]
  ds_read_b128 v[36:39], v204 offset:2048
  v_mfma_f32_32x32x16_bf16 v[16:31], a[168:171], v[40:43], v[16:31]
  s_waitcnt lgkmcnt(2)
  v_mfma_f32_32x32x16_bf16 v[0:15], a[28:31], v[44:47], v[0:15]
  ds_read_b128 v[40:43], v205 offset:2048
  v_mfma_f32_32x32x16_bf16 v[16:31], a[172:175], v[44:47], v[16:31]
  s_waitcnt lgkmcnt(2)
  v_mfma_f32_32x32x16_bf16 v[0:15], a[32:35], v[32:35], v[0:15]
  ds_read_b128 v[44:47], v206 offset:2048
  v_mfma_f32_32x32x16_bf16 v[16:31], a[176:179], v[32:35], v[16:31]
  s_waitcnt lgkmcnt(2)
  v_mfma_f32_32x32x16_bf16 v[0:15], a[36:39], v[36:39], v[0:15]
  ds_read_b128 v[32:35], v203 offset:3072
  v_mfma_f32_32x32x16_bf16 v[16:31], a[180:183], v[36:39], v[16:31]
  s_waitcnt lgkmcnt(2)
  v_mfma_f32_32x32x16_bf16 v[0:15], a[40:43], v[40:43], v[0:15]
  ds_read_b128 v[36:39], v204 offset:3072
  v_mfma_f32_32x32x16_bf16 v[16:31], a[184:187], v[40:43], v[16:31]
  s_waitcnt lgkmcnt(2)
  v_mfma_f32_32x32x16_bf16 v[0:15], a[44:47], v[44:47], v[0:15]
  ds_read_b128 v[40:43], v205 offset:3072
  v_mfma_f32_32x32x16_bf16 v[16:31], a[188:191], v[44:47], v[16:31]
  s_waitcnt lgkmcnt(2)
  v_mfma_f32_32x32x16_bf16 v[0:15], a[48:51], v[32:35], v[0:15]
  ds_read_b128 v[44:47], v206 offset:3072
  v_mfma_f32_32x32x16_bf16 v[16:31], a[192:195], v[32:35], v[16:31]
  s_waitcnt lgkmcnt(2)
  v_mfma_f32_32x32x16_bf16 v[0:15], a[52:55], v[36:39], v[0:15]
  ds_read_b128 v[32:35], v203 offset:4096
  v_mfma_f32_32x32x16_bf16 v[16:31], a[196:199], v[36:39], v[16:31]
  s_waitcnt lgkmcnt(2)
  v_mfma_f32_32x32x16_bf16 v[0:15], a[56:59], v[40:43], v[0:15]
  ds_read_b128 v[36:39], v204 offset:4096
  v_mfma_f32_32x32x16_bf16 v[16:31], a[200:203], v[40:43], v[16:31]
  s_waitcnt lgkmcnt(2)
  v_mfma_f32_32x32x16_bf16 v[0:15], a[60:63], v[44:47], v[0:15]
  ds_read_b128 v[40:43], v205 offset:4096
  v_mfma_f32_32x32x16_bf16 v[16:31], a[204:207], v[44:47], v[16:31]
  s_waitcnt lgkmcnt(2)
  v_mfma_f32_32x32x16_bf16 v[0:15], a[64:67], v[32:35], v[0:15]
  ds_read_b128 v[44:47], v206 offset:4096
  v_mfma_f32_32x32x16_bf16 v[16:31], a[208:211], v[32:35], v[16:31]
  s_waitcnt lgkmcnt(2)
  v_mfma_f32_32x32x16_bf16 v[0:15], a[68:71], v[36:39], v[0:15]
  ds_read_b128 v[32:35], v203 offset:5120
  v_mfma_f32_32x32x16_bf16 v[16:31], a[212:215], v[36:39], v[16:31]
  s_waitcnt lgkmcnt(2)
  v_mfma_f32_32x32x16_bf16 v[0:15], a[72:75], v[40:43], v[0:15]
  ds_read_b128 v[36:39], v204 offset:5120
  v_mfma_f32_32x32x16_bf16 v[16:31], a[216:219], v[40:43], v[16:31]
  s_waitcnt lgkmcnt(2)
  v_mfma_f32_32x32x16_bf16 v[0:15], a[76:79], v[44:47], v[0:15]
  ds_read_b128 v[40:43], v205 offset:5120
  v_mfma_f32_32x32x16_bf16 v[16:31], a[220:223], v[44:47], v[16:31]
  s_waitcnt lgkmcnt(2)
  v_mfma_f32_32x32x16_bf16 v[0:15], a[80:83], v[32:35], v[0:15]
  ds_read_b128 v[44:47], v206 offset:5120
  v_mfma_f32_32x32x16_bf16 v[16:31], a[224:227], v[32:35], v[16:31]
  s_waitcnt lgkmcnt(2)
  v_mfma_f32_32x32x16_bf16 v[0:15], a[84:87], v[36:39], v[0:15]
  ds_read_b128 v[32:35], v203 offset:6144
  v_mfma_f32_32x32x16_bf16 v[16:31], a[228:231], v[36:39], v[16:31]
  s_waitcnt lgkmcnt(2)
  v_mfma_f32_32x32x16_bf16 v[0:15], a[88:91], v[40:43], v[0:15]
  ds_read_b128 v[36:39], v204 offset:6144
  v_mfma_f32_32x32x16_bf16 v[16:31], a[232:235], v[40:43], v[16:31]
  s_waitcnt lgkmcnt(2)
  v_mfma_f32_32x32x16_bf16 v[0:15], a[92:95], v[44:47], v[0:15]
  ds_read_b128 v[40:43], v205 offset:6144
  v_mfma_f32_32x32x16_bf16 v[16:31], a[236:239], v[44:47], v[16:31]
  s_waitcnt lgkmcnt(2)
  v_mfma_f32_32x32x16_bf16 v[0:15], a[96:99], v[32:35], v[0:15]
  ds_read_b128 v[44:47], v206 offset:6144
  v_mfma_f32_32x32x16_bf16 v[16:31], a[240:243], v[32:35], v[16:31]
  s_waitcnt lgkmcnt(2)
  v_mfma_f32_32x32x16_bf16 v[0:15], a[100:103], v[36:39], v[0:15]
  ds_read_b128 v[32:35], v203 offset:7168
  v_mfma_f32_32x32x16_bf16 v[16:31], a[244:247], v[36:39], v[16:31]
  s_waitcnt lgkmcnt(2)
  v_mfma_f32_32x32x16_bf16 v[0:15], a[104:107], v[40:43], v[0:15]
  ds_read_b128 v[36:39], v204 offset:7168
  v_mfma_f32_32x32x16_bf16 v[16:31], a[248:251], v[40:43], v[16:31]
  s_waitcnt lgkmcnt(2)
  v_mfma_f32_32x32x16_bf16 v[0:15], a[108:111], v[44:47], v[0:15]
  ds_read_b128 v[40:43], v205 offset:7168
  v_mfma_f32_32x32x16_bf16 v[16:31], a[252:255], v[44:47], v[16:31]
  s_waitcnt lgkmcnt(2)
  v_mfma_f32_32x32x16_bf16 v[0:15], a[112:115], v[32:35], v[0:15]
  ds_read_b128 v[44:47], v206 offset:7168
  v_mfma_f32_32x32x16_bf16 v[16:31], v[224:227], v[32:35], v[16:31]
  s_waitcnt lgkmcnt(2)
  v_mfma_f32_32x32x16_bf16 v[0:15], a[116:119], v[36:39], v[0:15]
  ds_read_b128 v[32:35], v203 offset:8192
  v_mfma_f32_32x32x16_bf16 v[16:31], v[228:231], v[36:39], v[16:31]
  s_waitcnt lgkmcnt(2)
  v_mfma_f32_32x32x16_bf16 v[0:15], a[120:123], v[40:43], v[0:15]
  ds_read_b128 v[36:39], v204 offset:8192
  v_mfma_f32_32x32x16_bf16 v[16:31], v[232:235], v[40:43], v[16:31]
  s_waitcnt lgkmcnt(2)
  v_mfma_f32_32x32x16_bf16 v[0:15], a[124:127], v[44:47], v[0:15]
  ds_read_b128 v[40:43], v205 offset:8192
  v_mfma_f32_32x32x16_bf16 v[16:31], v[236:239], v[44:47], v[16:31]
  s_waitcnt lgkmcnt(2)
  v_mfma_f32_32x32x16_bf16 v[0:15], a[128:131], v[32:35], v[0:15]
  ds_read_b128 v[44:47], v206 offset:8192
  v_mfma_f32_32x32x16_bf16 v[16:31], v[240:243], v[32:35], v[16:31]
  s_waitcnt lgkmcnt(2)
  v_mfma_f32_32x32x16_bf16 v[0:15], a[132:135], v[36:39], v[0:15]
  v_mfma_f32_32x32x16_bf16 v[16:31], v[244:247], v[36:39], v[16:31]
  s_waitcnt lgkmcnt(1)
  v_mfma_f32_32x32x16_bf16 v[0:15], a[136:139], v[40:43], v[0:15]
  v_mfma_f32_32x32x16_bf16 v[16:31], v[248:251], v[40:43], v[16:31]
  s_waitcnt lgkmcnt(0)
  v_mfma_f32_32x32x16_bf16 v[0:15], a[140:143], v[44:47], v[0:15]
  v_mfma_f32_32x32x16_bf16 v[16:31], v[252:255], v[44:47], v[16:31]
  s_add_u32 s60, s60, 36864
  s_nop 2
  v_cvt_pk_bf16_f32 v48, v0, v1
  v_cvt_pk_bf16_f32 v49, v2, v3
  ds_write2_b32 v218, v48, v49 offset0:0 offset1:1
  v_cvt_pk_bf16_f32 v48, v4, v5
  v_cvt_pk_bf16_f32 v49, v6, v7
  ds_write2_b32 v218, v48, v49 offset0:4 offset1:5
  v_cvt_pk_bf16_f32 v48, v8, v9
  v_cvt_pk_bf16_f32 v49, v10, v11
  ds_write2_b32 v218, v48, v49 offset0:8 offset1:9
  v_cvt_pk_bf16_f32 v48, v12, v13
  v_cvt_pk_bf16_f32 v49, v14, v15
  ds_write2_b32 v218, v48, v49 offset0:12 offset1:13
  v_cvt_pk_bf16_f32 v48, v16, v17
  v_cvt_pk_bf16_f32 v49, v18, v19
  ds_write2_b32 v218, v48, v49 offset0:64 offset1:65
  v_cvt_pk_bf16_f32 v48, v20, v21
  v_cvt_pk_bf16_f32 v49, v22, v23
  ds_write2_b32 v218, v48, v49 offset0:68 offset1:69
  v_cvt_pk_bf16_f32 v48, v24, v25
  v_cvt_pk_bf16_f32 v49, v26, v27
  ds_write2_b32 v218, v48, v49 offset0:72 offset1:73
  v_cvt_pk_bf16_f32 v48, v28, v29
  v_cvt_pk_bf16_f32 v49, v30, v31
  ds_write2_b32 v218, v48, v49 offset0:76 offset1:77
  v_add_u32 v218, 16512, v218
  s_waitcnt vmcnt(0) lgkmcnt(0)
  s_barrier
  v_mul_u32_u24 v219, 516, v200
  s_mul_i32 s54, s52, 36
  s_add_u32 s55, s54, 83016
  v_add_u32 v219, s55, v219
  v_mul_u32_u24 v220, 1152, v200
  s_mul_i32 s55, s68, 144
  s_add_u32 s54, s54, s55
  s_mul_i32 s55, s69, 147456
  s_add_u32 s64, s54, s55
  s_add_u32 s64, s64, 62914560
  s_lshl_b32 s66, s69, 7
  s_mov_b32 s57, 1051597459
  ds_read_b32 v0, v219 offset:7224
  ds_read_b32 v1, v219 offset:7228
  ds_read_b32 v2, v219 offset:7232
  ds_read_b32 v3, v219 offset:7236
  ds_read_b32 v4, v219 offset:7240
  ds_read_b32 v5, v219 offset:7244
  ds_read_b32 v6, v219 offset:7248
  ds_read_b32 v7, v219 offset:7252
  ds_read_b32 v8, v219 offset:7256
  ds_read_b32 v16, v219 offset:7368
  ds_read_b32 v17, v219 offset:7372
  ds_read_b32 v18, v219 offset:7376
  ds_read_b32 v19, v219 offset:7380
  ds_read_b32 v20, v219 offset:7384
  ds_read_b32 v21, v219 offset:7388
  ds_read_b32 v22, v219 offset:7392
  ds_read_b32 v23, v219 offset:7396
  ds_read_b32 v24, v219 offset:7400
  ds_read_b32 v25, v219 offset:6336
  ds_read_b32 v26, v219 offset:6340
  ds_read_b32 v27, v219 offset:6344
  ds_read_b32 v28, v219 offset:6348
  ds_read_b32 v29, v219 offset:6352
  ds_read_b32 v30, v219 offset:6356
  ds_read_b32 v31, v219 offset:6360
  ds_read_b32 v32, v219 offset:6364
  ds_read_b32 v33, v219 offset:6368
  ds_read_b32 v34, v219 offset:5304
  ds_read_b32 v35, v219 offset:5308
  ds_read_b32 v36, v219 offset:5312
  ds_read_b32 v37, v219 offset:5316
  ds_read_b32 v38, v219 offset:5320
  ds_read_b32 v39, v219 offset:5324
  ds_read_b32 v40, v219 offset:5328
  ds_read_b32 v41, v219 offset:5332
  ds_read_b32 v42, v219 offset:5336
  ds_read_b32 v43, v219 offset:4272
  ds_read_b32 v44, v219 offset:4276
  ds_read_b32 v45, v219 offset:4280
  ds_read_b32 v46, v219 offset:4284
  ds_read_b32 v47, v219 offset:4288
  ds_read_b32 v48, v219 offset:4292
  ds_read_b32 v49, v219 offset:4296
  ds_read_b32 v50, v219 offset:4300
  ds_read_b32 v51, v219 offset:4304
  ds_read_b32 v52, v219 offset:3240
  ds_read_b32 v53, v219 offset:3244
  ds_read_b32 v54, v219 offset:3248
  ds_read_b32 v55, v219 offset:3252
  ds_read_b32 v56, v219 offset:3256
  ds_read_b32 v57, v219 offset:3260
  ds_read_b32 v58, v219 offset:3264
  ds_read_b32 v59, v219 offset:3268
  ds_read_b32 v60, v219 offset:3272
  ds_read_b32 v61, v219 offset:2208
  ds_read_b32 v62, v219 offset:2212
  ds_read_b32 v63, v219 offset:2216
  ds_read_b32 v64, v219 offset:2220
  ds_read_b32 v65, v219 offset:2224
  ds_read_b32 v66, v219 offset:2228
  ds_read_b32 v67, v219 offset:2232
  ds_read_b32 v68, v219 offset:2236
  ds_read_b32 v69, v219 offset:2240
  ds_read_b32 v70, v219 offset:1176
  ds_read_b32 v71, v219 offset:1180
  ds_read_b32 v72, v219 offset:1184
  ds_read_b32 v73, v219 offset:1188
  ds_read_b32 v74, v219 offset:1192
  ds_read_b32 v75, v219 offset:1196
  ds_read_b32 v76, v219 offset:1200
  ds_read_b32 v77, v219 offset:1204
  ds_read_b32 v78, v219 offset:1208
  ds_read_b32 v79, v219 offset:144
  ds_read_b32 v80, v219 offset:148
  ds_read_b32 v81, v219 offset:152
  ds_read_b32 v82, v219 offset:156
  ds_read_b32 v83, v219 offset:160
  ds_read_b32 v84, v219 offset:164
  ds_read_b32 v85, v219 offset:168
  ds_read_b32 v86, v219 offset:172
  ds_read_b32 v87, v219 offset:176
  v_mov_b32 v100, 0
  v_mov_b32 v101, 0
  v_mov_b32 v102, 0
  v_mov_b32 v103, 0
  v_mov_b32 v104, 0
  v_mov_b32 v105, 0
  v_mov_b32 v106, 0
  v_mov_b32 v107, 0
  s_waitcnt lgkmcnt(15)
  v_dot2c_f32_bf16 v100, v0, v16
  v_dot2c_f32_bf16 v101, v0, v25
  v_dot2c_f32_bf16 v102, v0, v34
  v_dot2c_f32_bf16 v103, v0, v43
  v_dot2c_f32_bf16 v104, v0, v52
  v_dot2c_f32_bf16 v105, v0, v61
  v_dot2c_f32_bf16 v106, v0, v70
  s_waitcnt lgkmcnt(8)
  v_dot2c_f32_bf16 v107, v0, v79
  v_dot2c_f32_bf16 v100, v1, v17
  v_dot2c_f32_bf16 v101, v1, v26
  v_dot2c_f32_bf16 v102, v1, v35
  v_dot2c_f32_bf16 v103, v1, v44
  v_dot2c_f32_bf16 v104, v1, v53
  v_dot2c_f32_bf16 v105, v1, v62
  v_dot2c_f32_bf16 v106, v1, v71
  s_waitcnt lgkmcnt(7)
  v_dot2c_f32_bf16 v107, v1, v80
  v_dot2c_f32_bf16 v100, v2, v18
  v_dot2c_f32_bf16 v101, v2, v27
  v_dot2c_f32_bf16 v102, v2, v36
  v_dot2c_f32_bf16 v103, v2, v45
  v_dot2c_f32_bf16 v104, v2, v54
  v_dot2c_f32_bf16 v105, v2, v63
  v_dot2c_f32_bf16 v106, v2, v72
  s_waitcnt lgkmcnt(6)
  v_dot2c_f32_bf16 v107, v2, v81
  v_dot2c_f32_bf16 v100, v3, v19
  v_dot2c_f32_bf16 v101, v3, v28
  v_dot2c_f32_bf16 v102, v3, v37
  v_dot2c_f32_bf16 v103, v3, v46
  v_dot2c_f32_bf16 v104, v3, v55
  v_dot2c_f32_bf16 v105, v3, v64
  v_dot2c_f32_bf16 v106, v3, v73
  s_waitcnt lgkmcnt(5)
  v_dot2c_f32_bf16 v107, v3, v82
  v_dot2c_f32_bf16 v100, v4, v20
  v_dot2c_f32_bf16 v101, v4, v29
  v_dot2c_f32_bf16 v102, v4, v38
  v_dot2c_f32_bf16 v103, v4, v47
  v_dot2c_f32_bf16 v104, v4, v56
  v_dot2c_f32_bf16 v105, v4, v65
  v_dot2c_f32_bf16 v106, v4, v74
  s_waitcnt lgkmcnt(4)
  v_dot2c_f32_bf16 v107, v4, v83
  v_dot2c_f32_bf16 v100, v5, v21
  v_dot2c_f32_bf16 v101, v5, v30
  v_dot2c_f32_bf16 v102, v5, v39
  v_dot2c_f32_bf16 v103, v5, v48
  v_dot2c_f32_bf16 v104, v5, v57
  v_dot2c_f32_bf16 v105, v5, v66
  v_dot2c_f32_bf16 v106, v5, v75
  s_waitcnt lgkmcnt(3)
  v_dot2c_f32_bf16 v107, v5, v84
  v_dot2c_f32_bf16 v100, v6, v22
  v_dot2c_f32_bf16 v101, v6, v31
  v_dot2c_f32_bf16 v102, v6, v40
  v_dot2c_f32_bf16 v103, v6, v49
  v_dot2c_f32_bf16 v104, v6, v58
  v_dot2c_f32_bf16 v105, v6, v67
  v_dot2c_f32_bf16 v106, v6, v76
  s_waitcnt lgkmcnt(2)
  v_dot2c_f32_bf16 v107, v6, v85
  v_dot2c_f32_bf16 v100, v7, v23
  v_dot2c_f32_bf16 v101, v7, v32
  v_dot2c_f32_bf16 v102, v7, v41
  v_dot2c_f32_bf16 v103, v7, v50
  v_dot2c_f32_bf16 v104, v7, v59
  v_dot2c_f32_bf16 v105, v7, v68
  v_dot2c_f32_bf16 v106, v7, v77
  s_waitcnt lgkmcnt(1)
  v_dot2c_f32_bf16 v107, v7, v86
  v_dot2c_f32_bf16 v100, v8, v24
  v_dot2c_f32_bf16 v101, v8, v33
  v_dot2c_f32_bf16 v102, v8, v42
  v_dot2c_f32_bf16 v103, v8, v51
  v_dot2c_f32_bf16 v104, v8, v60
  v_dot2c_f32_bf16 v105, v8, v69
  v_dot2c_f32_bf16 v106, v8, v78
  s_waitcnt lgkmcnt(0)
  v_dot2c_f32_bf16 v107, v8, v87
  ds_read_b32 v16, v219 offset:7512
  ds_read_b32 v17, v219 offset:7516
  ds_read_b32 v18, v219 offset:7520
  ds_read_b32 v19, v219 offset:7524
  ds_read_b32 v20, v219 offset:7528
  ds_read_b32 v21, v219 offset:7532
  ds_read_b32 v22, v219 offset:7536
  ds_read_b32 v23, v219 offset:7540
  ds_read_b32 v24, v219 offset:7544
  ds_read_b32 v25, v219 offset:6480
  ds_read_b32 v26, v219 offset:6484
  ds_read_b32 v27, v219 offset:6488
  ds_read_b32 v28, v219 offset:6492
  ds_read_b32 v29, v219 offset:6496
  ds_read_b32 v30, v219 offset:6500
  ds_read_b32 v31, v219 offset:6504
  ds_read_b32 v32, v219 offset:6508
  ds_read_b32 v33, v219 offset:6512
  ds_read_b32 v34, v219 offset:5448
  ds_read_b32 v35, v219 offset:5452
  ds_read_b32 v36, v219 offset:5456
  ds_read_b32 v37, v219 offset:5460
  ds_read_b32 v38, v219 offset:5464
  ds_read_b32 v39, v219 offset:5468
  ds_read_b32 v40, v219 offset:5472
  ds_read_b32 v41, v219 offset:5476
  ds_read_b32 v42, v219 offset:5480
  ds_read_b32 v43, v219 offset:4416
  ds_read_b32 v44, v219 offset:4420
  ds_read_b32 v45, v219 offset:4424
  ds_read_b32 v46, v219 offset:4428
  ds_read_b32 v47, v219 offset:4432
  ds_read_b32 v48, v219 offset:4436
  ds_read_b32 v49, v219 offset:4440
  ds_read_b32 v50, v219 offset:4444
  ds_read_b32 v51, v219 offset:4448
  ds_read_b32 v52, v219 offset:3384
  ds_read_b32 v53, v219 offset:3388
  ds_read_b32 v54, v219 offset:3392
  ds_read_b32 v55, v219 offset:3396
  ds_read_b32 v56, v219 offset:3400
  ds_read_b32 v57, v219 offset:3404
  ds_read_b32 v58, v219 offset:3408
  ds_read_b32 v59, v219 offset:3412
  ds_read_b32 v60, v219 offset:3416
  ds_read_b32 v61, v219 offset:2352
  ds_read_b32 v62, v219 offset:2356
  ds_read_b32 v63, v219 offset:2360
  ds_read_b32 v64, v219 offset:2364
  ds_read_b32 v65, v219 offset:2368
  ds_read_b32 v66, v219 offset:2372
  ds_read_b32 v67, v219 offset:2376
  ds_read_b32 v68, v219 offset:2380
  ds_read_b32 v69, v219 offset:2384
  ds_read_b32 v70, v219 offset:1320
  ds_read_b32 v71, v219 offset:1324
  ds_read_b32 v72, v219 offset:1328
  ds_read_b32 v73, v219 offset:1332
  ds_read_b32 v74, v219 offset:1336
  ds_read_b32 v75, v219 offset:1340
  ds_read_b32 v76, v219 offset:1344
  ds_read_b32 v77, v219 offset:1348
  ds_read_b32 v78, v219 offset:1352
  ds_read_b32 v79, v219 offset:288
  ds_read_b32 v80, v219 offset:292
  ds_read_b32 v81, v219 offset:296
  ds_read_b32 v82, v219 offset:300
  ds_read_b32 v83, v219 offset:304
  ds_read_b32 v84, v219 offset:308
  ds_read_b32 v85, v219 offset:312
  ds_read_b32 v86, v219 offset:316
  ds_read_b32 v87, v219 offset:320
  v_add_u32 v211, s66, v200
  v_mov_b32 v212, 0xf149f2ca
  v_mul_f32 v100, s57, v100
  v_mul_f32 v101, s57, v101
  v_mul_f32 v102, s57, v102
  v_mul_f32 v103, s57, v103
  v_mul_f32 v104, s57, v104
  v_mul_f32 v105, s57, v105
  v_mul_f32 v106, s57, v106
  v_mul_f32 v107, s57, v107
  v_cmp_gt_u32 vcc, 2, v211
  s_nop 1
  v_cndmask_b32 v101, v101, v212, vcc
  v_cmp_gt_u32 vcc, 4, v211
  s_nop 1
  v_cndmask_b32 v102, v102, v212, vcc
  v_cmp_gt_u32 vcc, 6, v211
  s_nop 1
  v_cndmask_b32 v103, v103, v212, vcc
  v_cmp_gt_u32 vcc, 8, v211
  s_nop 1
  v_cndmask_b32 v104, v104, v212, vcc
  v_cmp_gt_u32 vcc, 10, v211
  s_nop 1
  v_cndmask_b32 v105, v105, v212, vcc
  v_cmp_gt_u32 vcc, 12, v211
  s_nop 1
  v_cndmask_b32 v106, v106, v212, vcc
  v_cmp_gt_u32 vcc, 14, v211
  s_nop 1
  v_cndmask_b32 v107, v107, v212, vcc
  v_max3_f32 v213, v100, v101, v102
  v_max3_f32 v213, v213, v103, v104
  v_max3_f32 v213, v213, v105, v106
  v_max_f32 v213, v213, v107
  v_sub_f32 v100, v100, v213
  v_sub_f32 v101, v101, v213
  v_sub_f32 v102, v102, v213
  v_sub_f32 v103, v103, v213
  v_sub_f32 v104, v104, v213
  v_sub_f32 v105, v105, v213
  v_sub_f32 v106, v106, v213
  v_sub_f32 v107, v107, v213
  v_exp_f32 v100, v100
  v_exp_f32 v101, v101
  v_exp_f32 v102, v102
  v_exp_f32 v103, v103
  v_exp_f32 v104, v104
  v_exp_f32 v105, v105
  v_exp_f32 v106, v106
  v_exp_f32 v107, v107
  v_add_f32 v213, v100, v101
  v_add_f32 v213, v213, v102
  v_add_f32 v213, v213, v103
  v_add_f32 v213, v213, v104
  v_add_f32 v213, v213, v105
  v_add_f32 v213, v213, v106
  v_add_f32 v213, v213, v107
  v_rcp_f32 v213, v213
  v_mov_b32 v214, 0
  v_mul_f32 v100, v213, v100
  v_mul_f32 v101, v213, v101
  v_mul_f32 v102, v213, v102
  v_mul_f32 v103, v213, v103
  v_mul_f32 v104, v213, v104
  v_mul_f32 v105, v213, v105
  v_mul_f32 v106, v213, v106
  v_mul_f32 v107, v213, v107
  v_mov_b32 v112, 0
  v_mov_b32 v113, 0
  v_mov_b32 v114, 0
  v_mov_b32 v115, 0
  v_mov_b32 v116, 0
  v_mov_b32 v117, 0
  v_mov_b32 v118, 0
  v_mov_b32 v119, 0
  v_mov_b32 v120, 0
  v_mov_b32 v121, 0
  v_mov_b32 v122, 0
  v_mov_b32 v123, 0
  v_mov_b32 v124, 0
  v_mov_b32 v125, 0
  v_mov_b32 v126, 0
  v_mov_b32 v127, 0
  v_mov_b32 v128, 0
  v_mov_b32 v129, 0
  v_cvt_pk_bf16_f32 v0, v100, v214
  v_cvt_pk_bf16_f32 v1, v214, v100
  s_waitcnt lgkmcnt(15)
  v_dot2c_f32_bf16 v112, v16, v0
  v_dot2c_f32_bf16 v113, v16, v1
  v_dot2c_f32_bf16 v114, v17, v0
  v_dot2c_f32_bf16 v115, v17, v1
  v_dot2c_f32_bf16 v116, v18, v0
  v_dot2c_f32_bf16 v117, v18, v1
  v_dot2c_f32_bf16 v118, v19, v0
  v_dot2c_f32_bf16 v119, v19, v1
  v_dot2c_f32_bf16 v120, v20, v0
  v_dot2c_f32_bf16 v121, v20, v1
  v_dot2c_f32_bf16 v122, v21, v0
  v_dot2c_f32_bf16 v123, v21, v1
  v_dot2c_f32_bf16 v124, v22, v0
  v_dot2c_f32_bf16 v125, v22, v1
  v_dot2c_f32_bf16 v126, v23, v0
  v_dot2c_f32_bf16 v127, v23, v1
  v_dot2c_f32_bf16 v128, v24, v0
  v_dot2c_f32_bf16 v129, v24, v1
  v_cvt_pk_bf16_f32 v2, v101, v214
  v_cvt_pk_bf16_f32 v3, v214, v101
  v_dot2c_f32_bf16 v112, v25, v2
  v_dot2c_f32_bf16 v113, v25, v3
  v_dot2c_f32_bf16 v114, v26, v2
  v_dot2c_f32_bf16 v115, v26, v3
  v_dot2c_f32_bf16 v116, v27, v2
  v_dot2c_f32_bf16 v117, v27, v3
  v_dot2c_f32_bf16 v118, v28, v2
  v_dot2c_f32_bf16 v119, v28, v3
  v_dot2c_f32_bf16 v120, v29, v2
  v_dot2c_f32_bf16 v121, v29, v3
  v_dot2c_f32_bf16 v122, v30, v2
  v_dot2c_f32_bf16 v123, v30, v3
  v_dot2c_f32_bf16 v124, v31, v2
  v_dot2c_f32_bf16 v125, v31, v3
  v_dot2c_f32_bf16 v126, v32, v2
  v_dot2c_f32_bf16 v127, v32, v3
  v_dot2c_f32_bf16 v128, v33, v2
  v_dot2c_f32_bf16 v129, v33, v3
  v_cvt_pk_bf16_f32 v0, v102, v214
  v_cvt_pk_bf16_f32 v1, v214, v102
  v_dot2c_f32_bf16 v112, v34, v0
  v_dot2c_f32_bf16 v113, v34, v1
  v_dot2c_f32_bf16 v114, v35, v0
  v_dot2c_f32_bf16 v115, v35, v1
  v_dot2c_f32_bf16 v116, v36, v0
  v_dot2c_f32_bf16 v117, v36, v1
  v_dot2c_f32_bf16 v118, v37, v0
  v_dot2c_f32_bf16 v119, v37, v1
  v_dot2c_f32_bf16 v120, v38, v0
  v_dot2c_f32_bf16 v121, v38, v1
  v_dot2c_f32_bf16 v122, v39, v0
  v_dot2c_f32_bf16 v123, v39, v1
  v_dot2c_f32_bf16 v124, v40, v0
  v_dot2c_f32_bf16 v125, v40, v1
  v_dot2c_f32_bf16 v126, v41, v0
  v_dot2c_f32_bf16 v127, v41, v1
  v_dot2c_f32_bf16 v128, v42, v0
  v_dot2c_f32_bf16 v129, v42, v1
  v_cvt_pk_bf16_f32 v2, v103, v214
  v_cvt_pk_bf16_f32 v3, v214, v103
  v_dot2c_f32_bf16 v112, v43, v2
  v_dot2c_f32_bf16 v113, v43, v3
  v_dot2c_f32_bf16 v114, v44, v2
  v_dot2c_f32_bf16 v115, v44, v3
  v_dot2c_f32_bf16 v116, v45, v2
  v_dot2c_f32_bf16 v117, v45, v3
  v_dot2c_f32_bf16 v118, v46, v2
  v_dot2c_f32_bf16 v119, v46, v3
  v_dot2c_f32_bf16 v120, v47, v2
  v_dot2c_f32_bf16 v121, v47, v3
  v_dot2c_f32_bf16 v122, v48, v2
  v_dot2c_f32_bf16 v123, v48, v3
  v_dot2c_f32_bf16 v124, v49, v2
  v_dot2c_f32_bf16 v125, v49, v3
  v_dot2c_f32_bf16 v126, v50, v2
  v_dot2c_f32_bf16 v127, v50, v3
  v_dot2c_f32_bf16 v128, v51, v2
  v_dot2c_f32_bf16 v129, v51, v3
  v_cvt_pk_bf16_f32 v0, v104, v214
  v_cvt_pk_bf16_f32 v1, v214, v104
  v_dot2c_f32_bf16 v112, v52, v0
  v_dot2c_f32_bf16 v113, v52, v1
  v_dot2c_f32_bf16 v114, v53, v0
  v_dot2c_f32_bf16 v115, v53, v1
  v_dot2c_f32_bf16 v116, v54, v0
  v_dot2c_f32_bf16 v117, v54, v1
  v_dot2c_f32_bf16 v118, v55, v0
  v_dot2c_f32_bf16 v119, v55, v1
  v_dot2c_f32_bf16 v120, v56, v0
  v_dot2c_f32_bf16 v121, v56, v1
  v_dot2c_f32_bf16 v122, v57, v0
  v_dot2c_f32_bf16 v123, v57, v1
  v_dot2c_f32_bf16 v124, v58, v0
  v_dot2c_f32_bf16 v125, v58, v1
  v_dot2c_f32_bf16 v126, v59, v0
  v_dot2c_f32_bf16 v127, v59, v1
  v_dot2c_f32_bf16 v128, v60, v0
  v_dot2c_f32_bf16 v129, v60, v1
  v_cvt_pk_bf16_f32 v2, v105, v214
  v_cvt_pk_bf16_f32 v3, v214, v105
  v_dot2c_f32_bf16 v112, v61, v2
  v_dot2c_f32_bf16 v113, v61, v3
  v_dot2c_f32_bf16 v114, v62, v2
  v_dot2c_f32_bf16 v115, v62, v3
  v_dot2c_f32_bf16 v116, v63, v2
  v_dot2c_f32_bf16 v117, v63, v3
  v_dot2c_f32_bf16 v118, v64, v2
  v_dot2c_f32_bf16 v119, v64, v3
  v_dot2c_f32_bf16 v120, v65, v2
  v_dot2c_f32_bf16 v121, v65, v3
  v_dot2c_f32_bf16 v122, v66, v2
  v_dot2c_f32_bf16 v123, v66, v3
  v_dot2c_f32_bf16 v124, v67, v2
  v_dot2c_f32_bf16 v125, v67, v3
  v_dot2c_f32_bf16 v126, v68, v2
  v_dot2c_f32_bf16 v127, v68, v3
  v_dot2c_f32_bf16 v128, v69, v2
  v_dot2c_f32_bf16 v129, v69, v3
  v_cvt_pk_bf16_f32 v0, v106, v214
  v_cvt_pk_bf16_f32 v1, v214, v106
  v_dot2c_f32_bf16 v112, v70, v0
  v_dot2c_f32_bf16 v113, v70, v1
  v_dot2c_f32_bf16 v114, v71, v0
  v_dot2c_f32_bf16 v115, v71, v1
  v_dot2c_f32_bf16 v116, v72, v0
  v_dot2c_f32_bf16 v117, v72, v1
  s_waitcnt lgkmcnt(14)
  v_dot2c_f32_bf16 v118, v73, v0
  v_dot2c_f32_bf16 v119, v73, v1
  s_waitcnt lgkmcnt(13)
  v_dot2c_f32_bf16 v120, v74, v0
  v_dot2c_f32_bf16 v121, v74, v1
  s_waitcnt lgkmcnt(12)
  v_dot2c_f32_bf16 v122, v75, v0
  v_dot2c_f32_bf16 v123, v75, v1
  s_waitcnt lgkmcnt(11)
  v_dot2c_f32_bf16 v124, v76, v0
  v_dot2c_f32_bf16 v125, v76, v1
  s_waitcnt lgkmcnt(10)
  v_dot2c_f32_bf16 v126, v77, v0
  v_dot2c_f32_bf16 v127, v77, v1
  s_waitcnt lgkmcnt(9)
  v_dot2c_f32_bf16 v128, v78, v0
  v_dot2c_f32_bf16 v129, v78, v1
  v_cvt_pk_bf16_f32 v2, v107, v214
  v_cvt_pk_bf16_f32 v3, v214, v107
  s_waitcnt lgkmcnt(8)
  v_dot2c_f32_bf16 v112, v79, v2
  v_dot2c_f32_bf16 v113, v79, v3
  s_waitcnt lgkmcnt(7)
  v_dot2c_f32_bf16 v114, v80, v2
  v_dot2c_f32_bf16 v115, v80, v3
  s_waitcnt lgkmcnt(6)
  v_dot2c_f32_bf16 v116, v81, v2
  v_dot2c_f32_bf16 v117, v81, v3
  s_waitcnt lgkmcnt(5)
  v_dot2c_f32_bf16 v118, v82, v2
  v_dot2c_f32_bf16 v119, v82, v3
  s_waitcnt lgkmcnt(4)
  v_dot2c_f32_bf16 v120, v83, v2
  v_dot2c_f32_bf16 v121, v83, v3
  s_waitcnt lgkmcnt(3)
  v_dot2c_f32_bf16 v122, v84, v2
  v_dot2c_f32_bf16 v123, v84, v3
  s_waitcnt lgkmcnt(2)
  v_dot2c_f32_bf16 v124, v85, v2
  v_dot2c_f32_bf16 v125, v85, v3
  s_waitcnt lgkmcnt(1)
  v_dot2c_f32_bf16 v126, v86, v2
  v_dot2c_f32_bf16 v127, v86, v3
  s_waitcnt lgkmcnt(0)
  v_dot2c_f32_bf16 v128, v87, v2
  v_dot2c_f32_bf16 v129, v87, v3
  v_cvt_pk_bf16_f32 v132, v112, v113
  v_cvt_pk_bf16_f32 v133, v114, v115
  v_cvt_pk_bf16_f32 v134, v116, v117
  v_cvt_pk_bf16_f32 v135, v118, v119
  v_cvt_pk_bf16_f32 v136, v120, v121
  v_cvt_pk_bf16_f32 v137, v122, v123
  v_cvt_pk_bf16_f32 v138, v124, v125
  v_cvt_pk_bf16_f32 v139, v126, v127
  v_cvt_pk_bf16_f32 v140, v128, v129
  buffer_store_dwordx4 v[132:135], v220, s[8:11], s64 offen sc1
  buffer_store_dwordx4 v[136:139], v220, s[8:11], s64 offen offset:16 sc1
  buffer_store_dword v140, v220, s[8:11], s64 offen offset:32 sc1
  v_add_u32 v219, 33024, v219
  s_add_u32 s66, s66, 64
  s_add_u32 s64, s64, 73728
  ds_read_b32 v0, v219 offset:7224
  ds_read_b32 v1, v219 offset:7228
  ds_read_b32 v2, v219 offset:7232
  ds_read_b32 v3, v219 offset:7236
  ds_read_b32 v4, v219 offset:7240
  ds_read_b32 v5, v219 offset:7244
  ds_read_b32 v6, v219 offset:7248
  ds_read_b32 v7, v219 offset:7252
  ds_read_b32 v8, v219 offset:7256
  ds_read_b32 v16, v219 offset:7368
  ds_read_b32 v17, v219 offset:7372
  ds_read_b32 v18, v219 offset:7376
  ds_read_b32 v19, v219 offset:7380
  ds_read_b32 v20, v219 offset:7384
  ds_read_b32 v21, v219 offset:7388
  ds_read_b32 v22, v219 offset:7392
  ds_read_b32 v23, v219 offset:7396
  ds_read_b32 v24, v219 offset:7400
  ds_read_b32 v25, v219 offset:6336
  ds_read_b32 v26, v219 offset:6340
  ds_read_b32 v27, v219 offset:6344
  ds_read_b32 v28, v219 offset:6348
  ds_read_b32 v29, v219 offset:6352
  ds_read_b32 v30, v219 offset:6356
  ds_read_b32 v31, v219 offset:6360
  ds_read_b32 v32, v219 offset:6364
  ds_read_b32 v33, v219 offset:6368
  ds_read_b32 v34, v219 offset:5304
  ds_read_b32 v35, v219 offset:5308
  ds_read_b32 v36, v219 offset:5312
  ds_read_b32 v37, v219 offset:5316
  ds_read_b32 v38, v219 offset:5320
  ds_read_b32 v39, v219 offset:5324
  ds_read_b32 v40, v219 offset:5328
  ds_read_b32 v41, v219 offset:5332
  ds_read_b32 v42, v219 offset:5336
  ds_read_b32 v43, v219 offset:4272
  ds_read_b32 v44, v219 offset:4276
  ds_read_b32 v45, v219 offset:4280
  ds_read_b32 v46, v219 offset:4284
  ds_read_b32 v47, v219 offset:4288
  ds_read_b32 v48, v219 offset:4292
  ds_read_b32 v49, v219 offset:4296
  ds_read_b32 v50, v219 offset:4300
  ds_read_b32 v51, v219 offset:4304
  ds_read_b32 v52, v219 offset:3240
  ds_read_b32 v53, v219 offset:3244
  ds_read_b32 v54, v219 offset:3248
  ds_read_b32 v55, v219 offset:3252
  ds_read_b32 v56, v219 offset:3256
  ds_read_b32 v57, v219 offset:3260
  ds_read_b32 v58, v219 offset:3264
  ds_read_b32 v59, v219 offset:3268
  ds_read_b32 v60, v219 offset:3272
  ds_read_b32 v61, v219 offset:2208
  ds_read_b32 v62, v219 offset:2212
  ds_read_b32 v63, v219 offset:2216
  ds_read_b32 v64, v219 offset:2220
  ds_read_b32 v65, v219 offset:2224
  ds_read_b32 v66, v219 offset:2228
  ds_read_b32 v67, v219 offset:2232
  ds_read_b32 v68, v219 offset:2236
  ds_read_b32 v69, v219 offset:2240
  ds_read_b32 v70, v219 offset:1176
  ds_read_b32 v71, v219 offset:1180
  ds_read_b32 v72, v219 offset:1184
  ds_read_b32 v73, v219 offset:1188
  ds_read_b32 v74, v219 offset:1192
  ds_read_b32 v75, v219 offset:1196
  ds_read_b32 v76, v219 offset:1200
  ds_read_b32 v77, v219 offset:1204
  ds_read_b32 v78, v219 offset:1208
  ds_read_b32 v79, v219 offset:144
  ds_read_b32 v80, v219 offset:148
  ds_read_b32 v81, v219 offset:152
  ds_read_b32 v82, v219 offset:156
  ds_read_b32 v83, v219 offset:160
  ds_read_b32 v84, v219 offset:164
  ds_read_b32 v85, v219 offset:168
  ds_read_b32 v86, v219 offset:172
  ds_read_b32 v87, v219 offset:176
  v_mov_b32 v100, 0
  v_mov_b32 v101, 0
  v_mov_b32 v102, 0
  v_mov_b32 v103, 0
  v_mov_b32 v104, 0
  v_mov_b32 v105, 0
  v_mov_b32 v106, 0
  v_mov_b32 v107, 0
  s_waitcnt lgkmcnt(15)
  v_dot2c_f32_bf16 v100, v0, v16
  v_dot2c_f32_bf16 v101, v0, v25
  v_dot2c_f32_bf16 v102, v0, v34
  v_dot2c_f32_bf16 v103, v0, v43
  v_dot2c_f32_bf16 v104, v0, v52
  v_dot2c_f32_bf16 v105, v0, v61
  v_dot2c_f32_bf16 v106, v0, v70
  s_waitcnt lgkmcnt(8)
  v_dot2c_f32_bf16 v107, v0, v79
  v_dot2c_f32_bf16 v100, v1, v17
  v_dot2c_f32_bf16 v101, v1, v26
  v_dot2c_f32_bf16 v102, v1, v35
  v_dot2c_f32_bf16 v103, v1, v44
  v_dot2c_f32_bf16 v104, v1, v53
  v_dot2c_f32_bf16 v105, v1, v62
  v_dot2c_f32_bf16 v106, v1, v71
  s_waitcnt lgkmcnt(7)
  v_dot2c_f32_bf16 v107, v1, v80
  v_dot2c_f32_bf16 v100, v2, v18
  v_dot2c_f32_bf16 v101, v2, v27
  v_dot2c_f32_bf16 v102, v2, v36
  v_dot2c_f32_bf16 v103, v2, v45
  v_dot2c_f32_bf16 v104, v2, v54
  v_dot2c_f32_bf16 v105, v2, v63
  v_dot2c_f32_bf16 v106, v2, v72
  s_waitcnt lgkmcnt(6)
  v_dot2c_f32_bf16 v107, v2, v81
  v_dot2c_f32_bf16 v100, v3, v19
  v_dot2c_f32_bf16 v101, v3, v28
  v_dot2c_f32_bf16 v102, v3, v37
  v_dot2c_f32_bf16 v103, v3, v46
  v_dot2c_f32_bf16 v104, v3, v55
  v_dot2c_f32_bf16 v105, v3, v64
  v_dot2c_f32_bf16 v106, v3, v73
  s_waitcnt lgkmcnt(5)
  v_dot2c_f32_bf16 v107, v3, v82
  v_dot2c_f32_bf16 v100, v4, v20
  v_dot2c_f32_bf16 v101, v4, v29
  v_dot2c_f32_bf16 v102, v4, v38
  v_dot2c_f32_bf16 v103, v4, v47
  v_dot2c_f32_bf16 v104, v4, v56
  v_dot2c_f32_bf16 v105, v4, v65
  v_dot2c_f32_bf16 v106, v4, v74
  s_waitcnt lgkmcnt(4)
  v_dot2c_f32_bf16 v107, v4, v83
  v_dot2c_f32_bf16 v100, v5, v21
  v_dot2c_f32_bf16 v101, v5, v30
  v_dot2c_f32_bf16 v102, v5, v39
  v_dot2c_f32_bf16 v103, v5, v48
  v_dot2c_f32_bf16 v104, v5, v57
  v_dot2c_f32_bf16 v105, v5, v66
  v_dot2c_f32_bf16 v106, v5, v75
  s_waitcnt lgkmcnt(3)
  v_dot2c_f32_bf16 v107, v5, v84
  v_dot2c_f32_bf16 v100, v6, v22
  v_dot2c_f32_bf16 v101, v6, v31
  v_dot2c_f32_bf16 v102, v6, v40
  v_dot2c_f32_bf16 v103, v6, v49
  v_dot2c_f32_bf16 v104, v6, v58
  v_dot2c_f32_bf16 v105, v6, v67
  v_dot2c_f32_bf16 v106, v6, v76
  s_waitcnt lgkmcnt(2)
  v_dot2c_f32_bf16 v107, v6, v85
  v_dot2c_f32_bf16 v100, v7, v23
  v_dot2c_f32_bf16 v101, v7, v32
  v_dot2c_f32_bf16 v102, v7, v41
  v_dot2c_f32_bf16 v103, v7, v50
  v_dot2c_f32_bf16 v104, v7, v59
  v_dot2c_f32_bf16 v105, v7, v68
  v_dot2c_f32_bf16 v106, v7, v77
  s_waitcnt lgkmcnt(1)
  v_dot2c_f32_bf16 v107, v7, v86
  v_dot2c_f32_bf16 v100, v8, v24
  v_dot2c_f32_bf16 v101, v8, v33
  v_dot2c_f32_bf16 v102, v8, v42
  v_dot2c_f32_bf16 v103, v8, v51
  v_dot2c_f32_bf16 v104, v8, v60
  v_dot2c_f32_bf16 v105, v8, v69
  v_dot2c_f32_bf16 v106, v8, v78
  s_waitcnt lgkmcnt(0)
  v_dot2c_f32_bf16 v107, v8, v87
  ds_read_b32 v16, v219 offset:7512
  ds_read_b32 v17, v219 offset:7516
  ds_read_b32 v18, v219 offset:7520
  ds_read_b32 v19, v219 offset:7524
  ds_read_b32 v20, v219 offset:7528
  ds_read_b32 v21, v219 offset:7532
  ds_read_b32 v22, v219 offset:7536
  ds_read_b32 v23, v219 offset:7540
  ds_read_b32 v24, v219 offset:7544
  ds_read_b32 v25, v219 offset:6480
  ds_read_b32 v26, v219 offset:6484
  ds_read_b32 v27, v219 offset:6488
  ds_read_b32 v28, v219 offset:6492
  ds_read_b32 v29, v219 offset:6496
  ds_read_b32 v30, v219 offset:6500
  ds_read_b32 v31, v219 offset:6504
  ds_read_b32 v32, v219 offset:6508
  ds_read_b32 v33, v219 offset:6512
  ds_read_b32 v34, v219 offset:5448
  ds_read_b32 v35, v219 offset:5452
  ds_read_b32 v36, v219 offset:5456
  ds_read_b32 v37, v219 offset:5460
  ds_read_b32 v38, v219 offset:5464
  ds_read_b32 v39, v219 offset:5468
  ds_read_b32 v40, v219 offset:5472
  ds_read_b32 v41, v219 offset:5476
  ds_read_b32 v42, v219 offset:5480
  ds_read_b32 v43, v219 offset:4416
  ds_read_b32 v44, v219 offset:4420
  ds_read_b32 v45, v219 offset:4424
  ds_read_b32 v46, v219 offset:4428
  ds_read_b32 v47, v219 offset:4432
  ds_read_b32 v48, v219 offset:4436
  ds_read_b32 v49, v219 offset:4440
  ds_read_b32 v50, v219 offset:4444
  ds_read_b32 v51, v219 offset:4448
  ds_read_b32 v52, v219 offset:3384
  ds_read_b32 v53, v219 offset:3388
  ds_read_b32 v54, v219 offset:3392
  ds_read_b32 v55, v219 offset:3396
  ds_read_b32 v56, v219 offset:3400
  ds_read_b32 v57, v219 offset:3404
  ds_read_b32 v58, v219 offset:3408
  ds_read_b32 v59, v219 offset:3412
  ds_read_b32 v60, v219 offset:3416
  ds_read_b32 v61, v219 offset:2352
  ds_read_b32 v62, v219 offset:2356
  ds_read_b32 v63, v219 offset:2360
  ds_read_b32 v64, v219 offset:2364
  ds_read_b32 v65, v219 offset:2368
  ds_read_b32 v66, v219 offset:2372
  ds_read_b32 v67, v219 offset:2376
  ds_read_b32 v68, v219 offset:2380
  ds_read_b32 v69, v219 offset:2384
  ds_read_b32 v70, v219 offset:1320
  ds_read_b32 v71, v219 offset:1324
  ds_read_b32 v72, v219 offset:1328
  ds_read_b32 v73, v219 offset:1332
  ds_read_b32 v74, v219 offset:1336
  ds_read_b32 v75, v219 offset:1340
  ds_read_b32 v76, v219 offset:1344
  ds_read_b32 v77, v219 offset:1348
  ds_read_b32 v78, v219 offset:1352
  ds_read_b32 v79, v219 offset:288
  ds_read_b32 v80, v219 offset:292
  ds_read_b32 v81, v219 offset:296
  ds_read_b32 v82, v219 offset:300
  ds_read_b32 v83, v219 offset:304
  ds_read_b32 v84, v219 offset:308
  ds_read_b32 v85, v219 offset:312
  ds_read_b32 v86, v219 offset:316
  ds_read_b32 v87, v219 offset:320
  v_add_u32 v211, s66, v200
  v_mov_b32 v212, 0xf149f2ca
  v_mul_f32 v100, s57, v100
  v_mul_f32 v101, s57, v101
  v_mul_f32 v102, s57, v102
  v_mul_f32 v103, s57, v103
  v_mul_f32 v104, s57, v104
  v_mul_f32 v105, s57, v105
  v_mul_f32 v106, s57, v106
  v_mul_f32 v107, s57, v107
  v_cmp_gt_u32 vcc, 2, v211
  s_nop 1
  v_cndmask_b32 v101, v101, v212, vcc
  v_cmp_gt_u32 vcc, 4, v211
  s_nop 1
  v_cndmask_b32 v102, v102, v212, vcc
  v_cmp_gt_u32 vcc, 6, v211
  s_nop 1
  v_cndmask_b32 v103, v103, v212, vcc
  v_cmp_gt_u32 vcc, 8, v211
  s_nop 1
  v_cndmask_b32 v104, v104, v212, vcc
  v_cmp_gt_u32 vcc, 10, v211
  s_nop 1
  v_cndmask_b32 v105, v105, v212, vcc
  v_cmp_gt_u32 vcc, 12, v211
  s_nop 1
  v_cndmask_b32 v106, v106, v212, vcc
  v_cmp_gt_u32 vcc, 14, v211
  s_nop 1
  v_cndmask_b32 v107, v107, v212, vcc
  v_max3_f32 v213, v100, v101, v102
  v_max3_f32 v213, v213, v103, v104
  v_max3_f32 v213, v213, v105, v106
  v_max_f32 v213, v213, v107
  v_sub_f32 v100, v100, v213
  v_sub_f32 v101, v101, v213
  v_sub_f32 v102, v102, v213
  v_sub_f32 v103, v103, v213
  v_sub_f32 v104, v104, v213
  v_sub_f32 v105, v105, v213
  v_sub_f32 v106, v106, v213
  v_sub_f32 v107, v107, v213
  v_exp_f32 v100, v100
  v_exp_f32 v101, v101
  v_exp_f32 v102, v102
  v_exp_f32 v103, v103
  v_exp_f32 v104, v104
  v_exp_f32 v105, v105
  v_exp_f32 v106, v106
  v_exp_f32 v107, v107
  v_add_f32 v213, v100, v101
  v_add_f32 v213, v213, v102
  v_add_f32 v213, v213, v103
  v_add_f32 v213, v213, v104
  v_add_f32 v213, v213, v105
  v_add_f32 v213, v213, v106
  v_add_f32 v213, v213, v107
  v_rcp_f32 v213, v213
  v_mov_b32 v214, 0
  v_mul_f32 v100, v213, v100
  v_mul_f32 v101, v213, v101
  v_mul_f32 v102, v213, v102
  v_mul_f32 v103, v213, v103
  v_mul_f32 v104, v213, v104
  v_mul_f32 v105, v213, v105
  v_mul_f32 v106, v213, v106
  v_mul_f32 v107, v213, v107
  v_mov_b32 v112, 0
  v_mov_b32 v113, 0
  v_mov_b32 v114, 0
  v_mov_b32 v115, 0
  v_mov_b32 v116, 0
  v_mov_b32 v117, 0
  v_mov_b32 v118, 0
  v_mov_b32 v119, 0
  v_mov_b32 v120, 0
  v_mov_b32 v121, 0
  v_mov_b32 v122, 0
  v_mov_b32 v123, 0
  v_mov_b32 v124, 0
  v_mov_b32 v125, 0
  v_mov_b32 v126, 0
  v_mov_b32 v127, 0
  v_mov_b32 v128, 0
  v_mov_b32 v129, 0
  v_cvt_pk_bf16_f32 v0, v100, v214
  v_cvt_pk_bf16_f32 v1, v214, v100
  s_waitcnt lgkmcnt(15)
  v_dot2c_f32_bf16 v112, v16, v0
  v_dot2c_f32_bf16 v113, v16, v1
  v_dot2c_f32_bf16 v114, v17, v0
  v_dot2c_f32_bf16 v115, v17, v1
  v_dot2c_f32_bf16 v116, v18, v0
  v_dot2c_f32_bf16 v117, v18, v1
  v_dot2c_f32_bf16 v118, v19, v0
  v_dot2c_f32_bf16 v119, v19, v1
  v_dot2c_f32_bf16 v120, v20, v0
  v_dot2c_f32_bf16 v121, v20, v1
  v_dot2c_f32_bf16 v122, v21, v0
  v_dot2c_f32_bf16 v123, v21, v1
  v_dot2c_f32_bf16 v124, v22, v0
  v_dot2c_f32_bf16 v125, v22, v1
  v_dot2c_f32_bf16 v126, v23, v0
  v_dot2c_f32_bf16 v127, v23, v1
  v_dot2c_f32_bf16 v128, v24, v0
  v_dot2c_f32_bf16 v129, v24, v1
  v_cvt_pk_bf16_f32 v2, v101, v214
  v_cvt_pk_bf16_f32 v3, v214, v101
  v_dot2c_f32_bf16 v112, v25, v2
  v_dot2c_f32_bf16 v113, v25, v3
  v_dot2c_f32_bf16 v114, v26, v2
  v_dot2c_f32_bf16 v115, v26, v3
  v_dot2c_f32_bf16 v116, v27, v2
  v_dot2c_f32_bf16 v117, v27, v3
  v_dot2c_f32_bf16 v118, v28, v2
  v_dot2c_f32_bf16 v119, v28, v3
  v_dot2c_f32_bf16 v120, v29, v2
  v_dot2c_f32_bf16 v121, v29, v3
  v_dot2c_f32_bf16 v122, v30, v2
  v_dot2c_f32_bf16 v123, v30, v3
  v_dot2c_f32_bf16 v124, v31, v2
  v_dot2c_f32_bf16 v125, v31, v3
  v_dot2c_f32_bf16 v126, v32, v2
  v_dot2c_f32_bf16 v127, v32, v3
  v_dot2c_f32_bf16 v128, v33, v2
  v_dot2c_f32_bf16 v129, v33, v3
  v_cvt_pk_bf16_f32 v0, v102, v214
  v_cvt_pk_bf16_f32 v1, v214, v102
  v_dot2c_f32_bf16 v112, v34, v0
  v_dot2c_f32_bf16 v113, v34, v1
  v_dot2c_f32_bf16 v114, v35, v0
  v_dot2c_f32_bf16 v115, v35, v1
  v_dot2c_f32_bf16 v116, v36, v0
  v_dot2c_f32_bf16 v117, v36, v1
  v_dot2c_f32_bf16 v118, v37, v0
  v_dot2c_f32_bf16 v119, v37, v1
  v_dot2c_f32_bf16 v120, v38, v0
  v_dot2c_f32_bf16 v121, v38, v1
  v_dot2c_f32_bf16 v122, v39, v0
  v_dot2c_f32_bf16 v123, v39, v1
  v_dot2c_f32_bf16 v124, v40, v0
  v_dot2c_f32_bf16 v125, v40, v1
  v_dot2c_f32_bf16 v126, v41, v0
  v_dot2c_f32_bf16 v127, v41, v1
  v_dot2c_f32_bf16 v128, v42, v0
  v_dot2c_f32_bf16 v129, v42, v1
  v_cvt_pk_bf16_f32 v2, v103, v214
  v_cvt_pk_bf16_f32 v3, v214, v103
  v_dot2c_f32_bf16 v112, v43, v2
  v_dot2c_f32_bf16 v113, v43, v3
  v_dot2c_f32_bf16 v114, v44, v2
  v_dot2c_f32_bf16 v115, v44, v3
  v_dot2c_f32_bf16 v116, v45, v2
  v_dot2c_f32_bf16 v117, v45, v3
  v_dot2c_f32_bf16 v118, v46, v2
  v_dot2c_f32_bf16 v119, v46, v3
  v_dot2c_f32_bf16 v120, v47, v2
  v_dot2c_f32_bf16 v121, v47, v3
  v_dot2c_f32_bf16 v122, v48, v2
  v_dot2c_f32_bf16 v123, v48, v3
  v_dot2c_f32_bf16 v124, v49, v2
  v_dot2c_f32_bf16 v125, v49, v3
  v_dot2c_f32_bf16 v126, v50, v2
  v_dot2c_f32_bf16 v127, v50, v3
  v_dot2c_f32_bf16 v128, v51, v2
  v_dot2c_f32_bf16 v129, v51, v3
  v_cvt_pk_bf16_f32 v0, v104, v214
  v_cvt_pk_bf16_f32 v1, v214, v104
  v_dot2c_f32_bf16 v112, v52, v0
  v_dot2c_f32_bf16 v113, v52, v1
  v_dot2c_f32_bf16 v114, v53, v0
  v_dot2c_f32_bf16 v115, v53, v1
  v_dot2c_f32_bf16 v116, v54, v0
  v_dot2c_f32_bf16 v117, v54, v1
  v_dot2c_f32_bf16 v118, v55, v0
  v_dot2c_f32_bf16 v119, v55, v1
  v_dot2c_f32_bf16 v120, v56, v0
  v_dot2c_f32_bf16 v121, v56, v1
  v_dot2c_f32_bf16 v122, v57, v0
  v_dot2c_f32_bf16 v123, v57, v1
  v_dot2c_f32_bf16 v124, v58, v0
  v_dot2c_f32_bf16 v125, v58, v1
  v_dot2c_f32_bf16 v126, v59, v0
  v_dot2c_f32_bf16 v127, v59, v1
  v_dot2c_f32_bf16 v128, v60, v0
  v_dot2c_f32_bf16 v129, v60, v1
  v_cvt_pk_bf16_f32 v2, v105, v214
  v_cvt_pk_bf16_f32 v3, v214, v105
  v_dot2c_f32_bf16 v112, v61, v2
  v_dot2c_f32_bf16 v113, v61, v3
  v_dot2c_f32_bf16 v114, v62, v2
  v_dot2c_f32_bf16 v115, v62, v3
  v_dot2c_f32_bf16 v116, v63, v2
  v_dot2c_f32_bf16 v117, v63, v3
  v_dot2c_f32_bf16 v118, v64, v2
  v_dot2c_f32_bf16 v119, v64, v3
  v_dot2c_f32_bf16 v120, v65, v2
  v_dot2c_f32_bf16 v121, v65, v3
  v_dot2c_f32_bf16 v122, v66, v2
  v_dot2c_f32_bf16 v123, v66, v3
  v_dot2c_f32_bf16 v124, v67, v2
  v_dot2c_f32_bf16 v125, v67, v3
  v_dot2c_f32_bf16 v126, v68, v2
  v_dot2c_f32_bf16 v127, v68, v3
  v_dot2c_f32_bf16 v128, v69, v2
  v_dot2c_f32_bf16 v129, v69, v3
  v_cvt_pk_bf16_f32 v0, v106, v214
  v_cvt_pk_bf16_f32 v1, v214, v106
  v_dot2c_f32_bf16 v112, v70, v0
  v_dot2c_f32_bf16 v113, v70, v1
  v_dot2c_f32_bf16 v114, v71, v0
  v_dot2c_f32_bf16 v115, v71, v1
  v_dot2c_f32_bf16 v116, v72, v0
  v_dot2c_f32_bf16 v117, v72, v1
  s_waitcnt lgkmcnt(14)
  v_dot2c_f32_bf16 v118, v73, v0
  v_dot2c_f32_bf16 v119, v73, v1
  s_waitcnt lgkmcnt(13)
  v_dot2c_f32_bf16 v120, v74, v0
  v_dot2c_f32_bf16 v121, v74, v1
  s_waitcnt lgkmcnt(12)
  v_dot2c_f32_bf16 v122, v75, v0
  v_dot2c_f32_bf16 v123, v75, v1
  s_waitcnt lgkmcnt(11)
  v_dot2c_f32_bf16 v124, v76, v0
  v_dot2c_f32_bf16 v125, v76, v1
  s_waitcnt lgkmcnt(10)
  v_dot2c_f32_bf16 v126, v77, v0
  v_dot2c_f32_bf16 v127, v77, v1
  s_waitcnt lgkmcnt(9)
  v_dot2c_f32_bf16 v128, v78, v0
  v_dot2c_f32_bf16 v129, v78, v1
  v_cvt_pk_bf16_f32 v2, v107, v214
  v_cvt_pk_bf16_f32 v3, v214, v107
  s_waitcnt lgkmcnt(8)
  v_dot2c_f32_bf16 v112, v79, v2
  v_dot2c_f32_bf16 v113, v79, v3
  s_waitcnt lgkmcnt(7)
  v_dot2c_f32_bf16 v114, v80, v2
  v_dot2c_f32_bf16 v115, v80, v3
  s_waitcnt lgkmcnt(6)
  v_dot2c_f32_bf16 v116, v81, v2
  v_dot2c_f32_bf16 v117, v81, v3
  s_waitcnt lgkmcnt(5)
  v_dot2c_f32_bf16 v118, v82, v2
  v_dot2c_f32_bf16 v119, v82, v3
  s_waitcnt lgkmcnt(4)
  v_dot2c_f32_bf16 v120, v83, v2
  v_dot2c_f32_bf16 v121, v83, v3
  s_waitcnt lgkmcnt(3)
  v_dot2c_f32_bf16 v122, v84, v2
  v_dot2c_f32_bf16 v123, v84, v3
  s_waitcnt lgkmcnt(2)
  v_dot2c_f32_bf16 v124, v85, v2
  v_dot2c_f32_bf16 v125, v85, v3
  s_waitcnt lgkmcnt(1)
  v_dot2c_f32_bf16 v126, v86, v2
  v_dot2c_f32_bf16 v127, v86, v3
  s_waitcnt lgkmcnt(0)
  v_dot2c_f32_bf16 v128, v87, v2
  v_dot2c_f32_bf16 v129, v87, v3
  v_cvt_pk_bf16_f32 v132, v112, v113
  v_cvt_pk_bf16_f32 v133, v114, v115
  v_cvt_pk_bf16_f32 v134, v116, v117
  v_cvt_pk_bf16_f32 v135, v118, v119
  v_cvt_pk_bf16_f32 v136, v120, v121
  v_cvt_pk_bf16_f32 v137, v122, v123
  v_cvt_pk_bf16_f32 v138, v124, v125
  v_cvt_pk_bf16_f32 v139, v126, v127
  v_cvt_pk_bf16_f32 v140, v128, v129
  buffer_store_dwordx4 v[132:135], v220, s[8:11], s64 offen sc1
  buffer_store_dwordx4 v[136:139], v220, s[8:11], s64 offen offset:16 sc1
  buffer_store_dword v140, v220, s[8:11], s64 offen offset:32 sc1
  s_mov_b32 s56, 36
  s_waitcnt vmcnt(0)
  s_barrier
  s_cmp_eq_u32 s52, 0
  s_cbranch_scc0 A_sig
  v_mov_b32 v211, 1
  v_mov_b32 v212, 0
  s_mov_b64 exec, 1
  buffer_atomic_add v211, v212, s[12:15], s56 offen
  s_mov_b64 exec, -1
A_sig:
  s_and_b32 s54, s53, 31
  s_cmp_lt_u32 s54, 27
  s_cbranch_scc0 L_exit
  s_and_b32 s54, s53, 31
  s_mul_i32 s68, s54, 57
  s_lshr_b32 s68, s68, 9
  s_mul_i32 s56, s68, 9
  s_sub_u32 s70, s54, s56
  s_bfe_u32 s55, s53, 0x10005
  s_mul_i32 s55, s55, 9
  s_add_u32 s70, s70, s55
  s_bfe_u32 s69, s53, 0x10006
  v_lshrrev_b32 v211, 2, v200
  v_mul_u32_u24 v211, 1152, v211
  v_and_b32 v212, 3, v200
  v_lshl_add_u32 v207, v212, 4, v211
  s_lshl_b32 s54, s70, 6
  s_mul_i32 s55, s52, 1179648
  s_add_u32 s62, s54, s55
  s_mul_i32 s55, s52, 184320
  s_add_u32 s63, s54, s55
  s_mul_i32 s61, s52, 40960
  v_bfe_u32 v211, v200, 2, 2
  v_lshlrev_b32 v212, 4, v212
  v_add_u32 v212, s61, v212
  v_lshl_add_u32 v212, v211, 6, v212
  v_lshrrev_b32 v213, 4, v200
  v_lshl_add_u32 v210, v213, 9, v212
  v_lshrrev_b32 v214, 5, v200
  v_lshl_add_u32 v209, v214, 10, v212
  v_and_b32 v214, 1, v213
  v_lshl_add_u32 v209, v214, 8, v209
  s_add_u32 m0, s61, 0
  s_add_u32 s54, s62, 0
  buffer_load_dwordx4 v207, s[28:31], s54 offen lds
  s_add_u32 m0, s61, 1024
  s_add_u32 s54, s62, 18432
  buffer_load_dwordx4 v207, s[28:31], s54 offen lds
  s_add_u32 m0, s61, 2048
  s_add_u32 s54, s62, 36864
  buffer_load_dwordx4 v207, s[28:31], s54 offen lds
  s_add_u32 m0, s61, 3072
  s_add_u32 s54, s62, 55296
  buffer_load_dwordx4 v207, s[28:31], s54 offen lds
  s_add_u32 m0, s61, 4096
  s_add_u32 s54, s62, 73728
  buffer_load_dwordx4 v207, s[28:31], s54 offen lds
  s_add_u32 m0, s61, 5120
  s_add_u32 s54, s62, 92160
  buffer_load_dwordx4 v207, s[28:31], s54 offen lds
  s_add_u32 m0, s61, 6144
  s_add_u32 s54, s62, 110592
  buffer_load_dwordx4 v207, s[28:31], s54 offen lds
  s_add_u32 m0, s61, 7168
  s_add_u32 s54, s62, 129024
  buffer_load_dwordx4 v207, s[28:31], s54 offen lds
  s_add_u32 m0, s61, 8192
  s_add_u32 s54, s62, 147456
  buffer_load_dwordx4 v207, s[28:31], s54 offen lds
  s_add_u32 m0, s61, 9216
  s_add_u32 s54, s62, 165888
  buffer_load_dwordx4 v207, s[28:31], s54 offen lds
  s_add_u32 m0, s61, 10240
  s_add_u32 s54, s62, 184320
  buffer_load_dwordx4 v207, s[28:31], s54 offen lds
  s_add_u32 m0, s61, 11264
  s_add_u32 s54, s62, 202752
  buffer_load_dwordx4 v207, s[28:31], s54 offen lds
  s_add_u32 m0, s61, 12288
  s_add_u32 s54, s62, 221184
  buffer_load_dwordx4 v207, s[28:31], s54 offen lds
  s_add_u32 m0, s61, 13312
  s_add_u32 s54, s62, 239616
  buffer_load_dwordx4 v207, s[28:31], s54 offen lds
  s_add_u32 m0, s61, 14336
  s_add_u32 s54, s62, 258048
  buffer_load_dwordx4 v207, s[28:31], s54 offen lds
  s_add_u32 m0, s61, 15360
  s_add_u32 s54, s62, 276480
  buffer_load_dwordx4 v207, s[28:31], s54 offen lds
  s_add_u32 m0, s61, 16384
  s_add_u32 s54, s62, 294912
  buffer_load_dwordx4 v207, s[28:31], s54 offen lds
  s_add_u32 m0, s61, 17408
  s_add_u32 s54, s62, 313344
  buffer_load_dwordx4 v207, s[28:31], s54 offen lds
  s_add_u32 m0, s61, 18432
  s_add_u32 s54, s62, 331776
  buffer_load_dwordx4 v207, s[28:31], s54 offen lds
  s_add_u32 m0, s61, 19456
  s_add_u32 s54, s62, 350208
  buffer_load_dwordx4 v207, s[28:31], s54 offen lds
  s_add_u32 m0, s61, 20480
  s_add_u32 s54, s62, 368640
  buffer_load_dwordx4 v207, s[28:31], s54 offen lds
  s_add_u32 m0, s61, 21504
  s_add_u32 s54, s62, 387072
  buffer_load_dwordx4 v207, s[28:31], s54 offen lds
  s_add_u32 m0, s61, 22528
  s_add_u32 s54, s62, 405504
  buffer_load_dwordx4 v207, s[28:31], s54 offen lds
  s_add_u32 m0, s61, 23552
  s_add_u32 s54, s62, 423936
  buffer_load_dwordx4 v207, s[28:31], s54 offen lds
  s_add_u32 m0, s61, 24576
  s_add_u32 s54, s62, 442368
  buffer_load_dwordx4 v207, s[28:31], s54 offen lds
  s_add_u32 m0, s61, 25600
  s_add_u32 s54, s62, 460800
  buffer_load_dwordx4 v207, s[28:31], s54 offen lds
  s_add_u32 m0, s61, 26624
  s_add_u32 s54, s62, 479232
  buffer_load_dwordx4 v207, s[28:31], s54 offen lds
  s_add_u32 m0, s61, 27648
  s_add_u32 s54, s62, 497664
  buffer_load_dwordx4 v207, s[28:31], s54 offen lds
  s_add_u32 m0, s61, 28672
  s_add_u32 s54, s62, 516096
  buffer_load_dwordx4 v207, s[28:31], s54 offen lds
  s_add_u32 m0, s61, 29696
  s_add_u32 s54, s62, 534528
  buffer_load_dwordx4 v207, s[28:31], s54 offen lds
  s_add_u32 m0, s61, 30720
  s_add_u32 s54, s62, 552960
  buffer_load_dwordx4 v207, s[28:31], s54 offen lds
  s_add_u32 m0, s61, 31744
  s_add_u32 s54, s62, 571392
  buffer_load_dwordx4 v207, s[28:31], s54 offen lds
  s_add_u32 m0, s61, 32768
  s_add_u32 s54, s62, 589824
  buffer_load_dwordx4 v207, s[28:31], s54 offen lds
  s_add_u32 m0, s61, 33792
  s_add_u32 s54, s62, 608256
  buffer_load_dwordx4 v207, s[28:31], s54 offen lds
  s_add_u32 m0, s61, 34816
  s_add_u32 s54, s62, 626688
  buffer_load_dwordx4 v207, s[28:31], s54 offen lds
  s_add_u32 m0, s61, 35840
  s_add_u32 s54, s62, 645120
  buffer_load_dwordx4 v207, s[28:31], s54 offen lds
  s_add_u32 m0, s61, 36864
  s_add_u32 s54, s62, 663552
  buffer_load_dwordx4 v207, s[28:31], s54 offen lds
  s_add_u32 m0, s61, 37888
  s_add_u32 s54, s62, 681984
  buffer_load_dwordx4 v207, s[28:31], s54 offen lds
  s_waitcnt vmcnt(36) lgkmcnt(0)
  s_add_u32 m0, s61, 38912
  s_add_u32 s54, s62, 700416
  buffer_load_dwordx4 v207, s[28:31], s54 offen lds
  s_add_u32 m0, s61, 39936
  s_add_u32 s54, s62, 718848
  buffer_load_dwordx4 v207, s[28:31], s54 offen lds
  ds_read_b64_tr_b16 a[0:1], v209 offset:0
  ds_read_b64_tr_b16 a[2:3], v209 offset:512
  ds_read_b64_tr_b16 a[4:5], v209 offset:8
  ds_read_b64_tr_b16 a[6:7], v209 offset:520
  s_waitcnt vmcnt(36) lgkmcnt(0)
  s_add_u32 m0, s61, 0
  s_add_u32 s54, s62, 737280
  buffer_load_dwordx4 v207, s[28:31], s54 offen lds
  s_add_u32 m0, s61, 1024
  s_add_u32 s54, s62, 755712
  buffer_load_dwordx4 v207, s[28:31], s54 offen lds
  ds_read_b64_tr_b16 a[8:9], v209 offset:2048
  ds_read_b64_tr_b16 a[10:11], v209 offset:2560
  ds_read_b64_tr_b16 a[12:13], v209 offset:2056
  ds_read_b64_tr_b16 a[14:15], v209 offset:2568
  s_waitcnt vmcnt(36) lgkmcnt(0)
  s_add_u32 m0, s61, 2048
  s_add_u32 s54, s62, 774144
  buffer_load_dwordx4 v207, s[28:31], s54 offen lds
  s_add_u32 m0, s61, 3072
  s_add_u32 s54, s62, 792576
  buffer_load_dwordx4 v207, s[28:31], s54 offen lds
  ds_read_b64_tr_b16 a[16:17], v209 offset:4096
  ds_read_b64_tr_b16 a[18:19], v209 offset:4608
  ds_read_b64_tr_b16 a[20:21], v209 offset:4104
  ds_read_b64_tr_b16 a[22:23], v209 offset:4616
  s_waitcnt vmcnt(36) lgkmcnt(0)
  s_add_u32 m0, s61, 4096
  s_add_u32 s54, s62, 811008
  buffer_load_dwordx4 v207, s[28:31], s54 offen lds
  s_add_u32 m0, s61, 5120
  s_add_u32 s54, s62, 829440
  buffer_load_dwordx4 v207, s[28:31], s54 offen lds
  ds_read_b64_tr_b16 a[24:25], v209 offset:6144
  ds_read_b64_tr_b16 a[26:27], v209 offset:6656
  ds_read_b64_tr_b16 a[28:29], v209 offset:6152
  ds_read_b64_tr_b16 a[30:31], v209 offset:6664
  s_waitcnt vmcnt(36) lgkmcnt(0)
  s_add_u32 m0, s61, 6144
  s_add_u32 s54, s62, 847872
  buffer_load_dwordx4 v207, s[28:31], s54 offen lds
  s_add_u32 m0, s61, 7168
  s_add_u32 s54, s62, 866304
  buffer_load_dwordx4 v207, s[28:31], s54 offen lds
  ds_read_b64_tr_b16 a[32:33], v209 offset:8192
  ds_read_b64_tr_b16 a[34:35], v209 offset:8704
  ds_read_b64_tr_b16 a[36:37], v209 offset:8200
  ds_read_b64_tr_b16 a[38:39], v209 offset:8712
  s_waitcnt vmcnt(36) lgkmcnt(0)
  s_add_u32 m0, s61, 8192
  s_add_u32 s54, s62, 884736
  buffer_load_dwordx4 v207, s[28:31], s54 offen lds
  s_add_u32 m0, s61, 9216
  s_add_u32 s54, s62, 903168
  buffer_load_dwordx4 v207, s[28:31], s54 offen lds
  ds_read_b64_tr_b16 a[40:41], v209 offset:10240
  ds_read_b64_tr_b16 a[42:43], v209 offset:10752
  ds_read_b64_tr_b16 a[44:45], v209 offset:10248
  ds_read_b64_tr_b16 a[46:47], v209 offset:10760
  s_waitcnt vmcnt(36) lgkmcnt(0)
  s_add_u32 m0, s61, 10240
  s_add_u32 s54, s62, 921600
  buffer_load_dwordx4 v207, s[28:31], s54 offen lds
  s_add_u32 m0, s61, 11264
  s_add_u32 s54, s62, 940032
  buffer_load_dwordx4 v207, s[28:31], s54 offen lds
  ds_read_b64_tr_b16 a[48:49], v209 offset:12288
  ds_read_b64_tr_b16 a[50:51], v209 offset:12800
  ds_read_b64_tr_b16 a[52:53], v209 offset:12296
  ds_read_b64_tr_b16 a[54:55], v209 offset:12808
  s_waitcnt vmcnt(36) lgkmcnt(0)
  s_add_u32 m0, s61, 12288
  s_add_u32 s54, s62, 958464
  buffer_load_dwordx4 v207, s[28:31], s54 offen lds
  s_add_u32 m0, s61, 13312
  s_add_u32 s54, s62, 976896
  buffer_load_dwordx4 v207, s[28:31], s54 offen lds
  ds_read_b64_tr_b16 a[56:57], v209 offset:14336
  ds_read_b64_tr_b16 a[58:59], v209 offset:14848
  ds_read_b64_tr_b16 a[60:61], v209 offset:14344
  ds_read_b64_tr_b16 a[62:63], v209 offset:14856
  s_waitcnt vmcnt(36) lgkmcnt(0)
  s_add_u32 m0, s61, 14336
  s_add_u32 s54, s62, 995328
  buffer_load_dwordx4 v207, s[28:31], s54 offen lds
  s_add_u32 m0, s61, 15360
  s_add_u32 s54, s62, 1013760
  buffer_load_dwordx4 v207, s[28:31], s54 offen lds
  ds_read_b64_tr_b16 a[64:65], v209 offset:16384
  ds_read_b64_tr_b16 a[66:67], v209 offset:16896
  ds_read_b64_tr_b16 a[68:69], v209 offset:16392
  ds_read_b64_tr_b16 a[70:71], v209 offset:16904
  s_waitcnt vmcnt(36) lgkmcnt(0)
  s_add_u32 m0, s61, 16384
  s_add_u32 s54, s62, 1032192
  buffer_load_dwordx4 v207, s[28:31], s54 offen lds
  s_add_u32 m0, s61, 17408
  s_add_u32 s54, s62, 1050624
  buffer_load_dwordx4 v207, s[28:31], s54 offen lds
  ds_read_b64_tr_b16 a[72:73], v209 offset:18432
  ds_read_b64_tr_b16 a[74:75], v209 offset:18944
  ds_read_b64_tr_b16 a[76:77], v209 offset:18440
  ds_read_b64_tr_b16 a[78:79], v209 offset:18952
  s_waitcnt vmcnt(36) lgkmcnt(0)
  s_add_u32 m0, s61, 18432
  s_add_u32 s54, s62, 1069056
  buffer_load_dwordx4 v207, s[28:31], s54 offen lds
  s_add_u32 m0, s61, 19456
  s_add_u32 s54, s62, 1087488
  buffer_load_dwordx4 v207, s[28:31], s54 offen lds
  ds_read_b64_tr_b16 a[80:81], v209 offset:20480
  ds_read_b64_tr_b16 a[82:83], v209 offset:20992
  ds_read_b64_tr_b16 a[84:85], v209 offset:20488
  ds_read_b64_tr_b16 a[86:87], v209 offset:21000
  s_waitcnt vmcnt(36) lgkmcnt(0)
  s_add_u32 m0, s61, 20480
  s_add_u32 s54, s62, 1105920
  buffer_load_dwordx4 v207, s[28:31], s54 offen lds
  s_add_u32 m0, s61, 21504
  s_add_u32 s54, s62, 1124352
  buffer_load_dwordx4 v207, s[28:31], s54 offen lds
  ds_read_b64_tr_b16 a[88:89], v209 offset:22528
  ds_read_b64_tr_b16 a[90:91], v209 offset:23040
  ds_read_b64_tr_b16 a[92:93], v209 offset:22536
  ds_read_b64_tr_b16 a[94:95], v209 offset:23048
  s_waitcnt vmcnt(36) lgkmcnt(0)
  s_add_u32 m0, s61, 22528
  s_add_u32 s54, s62, 1142784
  buffer_load_dwordx4 v207, s[28:31], s54 offen lds
  s_add_u32 m0, s61, 23552
  s_add_u32 s54, s62, 1161216
  buffer_load_dwordx4 v207, s[28:31], s54 offen lds
  ds_read_b64_tr_b16 a[96:97], v209 offset:24576
  ds_read_b64_tr_b16 a[98:99], v209 offset:25088
  ds_read_b64_tr_b16 a[100:101], v209 offset:24584
  ds_read_b64_tr_b16 a[102:103], v209 offset:25096
  s_waitcnt vmcnt(36) lgkmcnt(0)
  s_add_u32 m0, s61, 24576
  s_add_u32 s54, s63, 0
  buffer_load_dwordx4 v207, s[40:43], s54 offen lds
  s_add_u32 m0, s61, 25600
  s_add_u32 s54, s63, 18432
  buffer_load_dwordx4 v207, s[40:43], s54 offen lds
  ds_read_b64_tr_b16 a[104:105], v209 offset:26624
  ds_read_b64_tr_b16 a[106:107], v209 offset:27136
  ds_read_b64_tr_b16 a[108:109], v209 offset:26632
  ds_read_b64_tr_b16 a[110:111], v209 offset:27144
  s_waitcnt vmcnt(36) lgkmcnt(0)
  s_add_u32 m0, s61, 26624
  s_add_u32 s54, s63, 36864
  buffer_load_dwordx4 v207, s[40:43], s54 offen lds
  s_add_u32 m0, s61, 27648
  s_add_u32 s54, s63, 55296
  buffer_load_dwordx4 v207, s[40:43], s54 offen lds
  ds_read_b64_tr_b16 a[112:113], v209 offset:28672
  ds_read_b64_tr_b16 a[114:115], v209 offset:29184
  ds_read_b64_tr_b16 a[116:117], v209 offset:28680
  ds_read_b64_tr_b16 a[118:119], v209 offset:29192
  s_waitcnt vmcnt(36) lgkmcnt(0)
  s_add_u32 m0, s61, 28672
  s_add_u32 s54, s63, 73728
  buffer_load_dwordx4 v207, s[40:43], s54 offen lds
  s_add_u32 m0, s61, 29696
  s_add_u32 s54, s63, 92160
  buffer_load_dwordx4 v207, s[40:43], s54 offen lds
  ds_read_b64_tr_b16 a[120:121], v209 offset:30720
  ds_read_b64_tr_b16 a[122:123], v209 offset:31232
  ds_read_b64_tr_b16 a[124:125], v209 offset:30728
  ds_read_b64_tr_b16 a[126:127], v209 offset:31240
  s_waitcnt vmcnt(36) lgkmcnt(0)
  s_add_u32 m0, s61, 30720
  s_add_u32 s54, s63, 110592
  buffer_load_dwordx4 v207, s[40:43], s54 offen lds
  s_add_u32 m0, s61, 31744
  s_add_u32 s54, s63, 129024
  buffer_load_dwordx4 v207, s[40:43], s54 offen lds
  ds_read_b64_tr_b16 a[128:129], v209 offset:32768
  ds_read_b64_tr_b16 a[130:131], v209 offset:33280
  ds_read_b64_tr_b16 a[132:133], v209 offset:32776
  ds_read_b64_tr_b16 a[134:135], v209 offset:33288
  s_waitcnt vmcnt(36) lgkmcnt(0)
  s_add_u32 m0, s61, 32768
  s_add_u32 s54, s63, 147456
  buffer_load_dwordx4 v207, s[40:43], s54 offen lds
  s_add_u32 m0, s61, 33792
  s_add_u32 s54, s63, 165888
  buffer_load_dwordx4 v207, s[40:43], s54 offen lds
  ds_read_b64_tr_b16 a[136:137], v209 offset:34816
  ds_read_b64_tr_b16 a[138:139], v209 offset:35328
  ds_read_b64_tr_b16 a[140:141], v209 offset:34824
  ds_read_b64_tr_b16 a[142:143], v209 offset:35336
  s_waitcnt vmcnt(36) lgkmcnt(0)
  ds_read_b64_tr_b16 a[144:145], v209 offset:36864
  ds_read_b64_tr_b16 a[146:147], v209 offset:37376
  ds_read_b64_tr_b16 a[148:149], v209 offset:36872
  ds_read_b64_tr_b16 a[150:151], v209 offset:37384
  s_waitcnt vmcnt(34) lgkmcnt(0)
  ds_read_b64_tr_b16 a[152:153], v209 offset:38912
  ds_read_b64_tr_b16 a[154:155], v209 offset:39424
  ds_read_b64_tr_b16 a[156:157], v209 offset:38920
  ds_read_b64_tr_b16 a[158:159], v209 offset:39432
  s_waitcnt vmcnt(32) lgkmcnt(0)
  ds_read_b64_tr_b16 a[160:161], v209 offset:0
  ds_read_b64_tr_b16 a[162:163], v209 offset:512
  ds_read_b64_tr_b16 a[164:165], v209 offset:8
  ds_read_b64_tr_b16 a[166:167], v209 offset:520
  s_waitcnt vmcnt(30) lgkmcnt(0)
  ds_read_b64_tr_b16 a[168:169], v209 offset:2048
  ds_read_b64_tr_b16 a[170:171], v209 offset:2560
  ds_read_b64_tr_b16 a[172:173], v209 offset:2056
  ds_read_b64_tr_b16 a[174:175], v209 offset:2568
  s_waitcnt vmcnt(28) lgkmcnt(0)
  ds_read_b64_tr_b16 a[176:177], v209 offset:4096
  ds_read_b64_tr_b16 a[178:179], v209 offset:4608
  ds_read_b64_tr_b16 a[180:181], v209 offset:4104
  ds_read_b64_tr_b16 a[182:183], v209 offset:4616
  s_waitcnt vmcnt(26) lgkmcnt(0)
  ds_read_b64_tr_b16 a[184:185], v209 offset:6144
  ds_read_b64_tr_b16 a[186:187], v209 offset:6656
  ds_read_b64_tr_b16 a[188:189], v209 offset:6152
  ds_read_b64_tr_b16 a[190:191], v209 offset:6664
  s_waitcnt vmcnt(24) lgkmcnt(0)
  ds_read_b64_tr_b16 a[192:193], v209 offset:8192
  ds_read_b64_tr_b16 a[194:195], v209 offset:8704
  ds_read_b64_tr_b16 a[196:197], v209 offset:8200
  ds_read_b64_tr_b16 a[198:199], v209 offset:8712
  s_waitcnt vmcnt(22) lgkmcnt(0)
  ds_read_b64_tr_b16 a[200:201], v209 offset:10240
  ds_read_b64_tr_b16 a[202:203], v209 offset:10752
  ds_read_b64_tr_b16 a[204:205], v209 offset:10248
  ds_read_b64_tr_b16 a[206:207], v209 offset:10760
  s_waitcnt vmcnt(20) lgkmcnt(0)
  ds_read_b64_tr_b16 a[208:209], v209 offset:12288
  ds_read_b64_tr_b16 a[210:211], v209 offset:12800
  ds_read_b64_tr_b16 a[212:213], v209 offset:12296
  ds_read_b64_tr_b16 a[214:215], v209 offset:12808
  s_waitcnt vmcnt(18) lgkmcnt(0)
  ds_read_b64_tr_b16 a[216:217], v209 offset:14336
  ds_read_b64_tr_b16 a[218:219], v209 offset:14848
  ds_read_b64_tr_b16 a[220:221], v209 offset:14344
  ds_read_b64_tr_b16 a[222:223], v209 offset:14856
  s_waitcnt vmcnt(16) lgkmcnt(0)
  ds_read_b64_tr_b16 a[224:225], v209 offset:16384
  ds_read_b64_tr_b16 a[226:227], v209 offset:16896
  ds_read_b64_tr_b16 a[228:229], v209 offset:16392
  ds_read_b64_tr_b16 a[230:231], v209 offset:16904
  s_waitcnt vmcnt(14) lgkmcnt(0)
  ds_read_b64_tr_b16 a[232:233], v209 offset:18432
  ds_read_b64_tr_b16 a[234:235], v209 offset:18944
  ds_read_b64_tr_b16 a[236:237], v209 offset:18440
  ds_read_b64_tr_b16 a[238:239], v209 offset:18952
  s_waitcnt vmcnt(12) lgkmcnt(0)
  ds_read_b64_tr_b16 a[240:241], v209 offset:20480
  ds_read_b64_tr_b16 a[242:243], v209 offset:20992
  ds_read_b64_tr_b16 a[244:245], v209 offset:20488
  ds_read_b64_tr_b16 a[246:247], v209 offset:21000
  s_waitcnt vmcnt(10) lgkmcnt(0)
  ds_read_b64_tr_b16 a[248:249], v209 offset:22528
  ds_read_b64_tr_b16 a[250:251], v209 offset:23040
  ds_read_b64_tr_b16 a[252:253], v209 offset:22536
  ds_read_b64_tr_b16 a[254:255], v209 offset:23048
  s_waitcnt vmcnt(8) lgkmcnt(0)
  ds_read_b64_tr_b16 v[216:217], v210 offset:24576
  ds_read_b64_tr_b16 v[218:219], v210 offset:24832
  ds_read_b64_tr_b16 v[220:221], v210 offset:24584
  ds_read_b64_tr_b16 v[222:223], v210 offset:24840
  s_waitcnt vmcnt(6) lgkmcnt(0)
  ds_read_b64_tr_b16 v[224:225], v210 offset:26624
  ds_read_b64_tr_b16 v[226:227], v210 offset:26880
  ds_read_b64_tr_b16 v[228:229], v210 offset:26632
  ds_read_b64_tr_b16 v[230:231], v210 offset:26888
  s_waitcnt vmcnt(4) lgkmcnt(0)
  ds_read_b64_tr_b16 v[232:233], v210 offset:28672
  ds_read_b64_tr_b16 v[234:235], v210 offset:28928
  ds_read_b64_tr_b16 v[236:237], v210 offset:28680
  ds_read_b64_tr_b16 v[238:239], v210 offset:28936
  s_waitcnt vmcnt(2) lgkmcnt(0)
  ds_read_b64_tr_b16 v[240:241], v210 offset:30720
  ds_read_b64_tr_b16 v[242:243], v210 offset:30976
  ds_read_b64_tr_b16 v[244:245], v210 offset:30728
  ds_read_b64_tr_b16 v[246:247], v210 offset:30984
  s_waitcnt vmcnt(0) lgkmcnt(0)
  ds_read_b64_tr_b16 v[248:249], v210 offset:32768
  ds_read_b64_tr_b16 v[250:251], v210 offset:33024
  ds_read_b64_tr_b16 v[252:253], v210 offset:32776
  ds_read_b64_tr_b16 v[254:255], v210 offset:33032
  v_and_b32 v211, 15, v200
  s_lshl_b32 s54, s69, 4
  v_add_u32 v211, s54, v211
  v_lshl_add_u32 v212, v214, 5, v211
  v_lshlrev_b32 v164, 4, v212
  v_lshrrev_b32 v212, 5, v200
  v_lshl_add_u32 v164, v212, 10, v164
  v_mul_u32_u24 v167, 1152, v211
  v_lshl_add_u32 v167, v213, 4, v167
  v_lshlrev_b32 v166, 2, v211
  v_lshlrev_b32 v208, 2, v200
  s_lshl_b32 s54, s52, 11
  v_add_u32 v168, s54, v201
  s_mov_b32 s59, s68
  s_mov_b32 s56, 128
  s_mov_b32 s57, 36
  s_waitcnt lgkmcnt(0)
  s_cmp_eq_u32 s52, 0
  s_cbranch_scc0 O_p1_d
  s_mov_b32 exec_hi, 0
  s_mov_b32 exec_lo, -1
O_p1:
  buffer_load_dword v211, v208, s[12:15], s56 offen sc1
  s_add_u32 s65, s65, 1
  s_waitcnt vmcnt(0)
  v_cmp_gt_u32 vcc, 0x700, v211
  s_cbranch_vccz O_p1_x
  s_sleep 16
  s_cmp_lt_u32 s65, 131072
  s_cbranch_scc1 O_p1
O_p1_x:
  s_mov_b64 exec, -1
O_p1_d:
  s_barrier
  s_cmp_eq_u32 s52, 0
  s_cbranch_scc0 O_a_d
  s_mov_b32 exec_hi, 0
  s_mov_b32 exec_lo, 1
O_a:
  buffer_load_dword v211, v208, s[12:15], s57 offen sc1
  s_add_u32 s65, s65, 1
  s_waitcnt vmcnt(0)
  v_cmp_gt_u32 vcc, 0x80, v211
  s_cbranch_vccz O_a_x
  s_sleep 16
  s_cmp_lt_u32 s65, 131072
  s_cbranch_scc1 O_a
O_a_x:
  s_mov_b64 exec, -1
O_a_d:
  s_barrier
  s_cmp_ge_u32 s70, 9
  s_cselect_b32 s54, 9, 0
  s_sub_u32 s54, s70, s54
  s_and_b32 s54, s54, 7
  s_lshl_b32 s54, s54, 13
  s_lshl_b32 s55, s69, 8
  s_add_u32 s54, s54, s55
  v_lshrrev_b32 v211, 2, v200
  v_lshl_add_u32 v172, v211, 9, s54
  v_and_b32 v211, 3, v200
  v_lshl_add_u32 v172, v211, 6, v172
  s_mul_i32 s55, s59, 36864
  s_mul_i32 s54, s52, 320
  s_add_u32 s55, s55, s54
  s_add_u32 s55, s55, 62914560
  s_cmp_eq_u32 s52, 3
  s_cselect_b32 s56, 268435456, s55
  buffer_load_dwordx4 v[128:131], v167, s[8:11], s55 offen offset:0 sc1
  buffer_load_dwordx4 v[132:135], v167, s[8:11], s55 offen offset:64 sc1
  buffer_load_dwordx4 v[136:139], v167, s[8:11], s55 offen offset:128 sc1
  buffer_load_dwordx4 v[140:143], v167, s[8:11], s56 offen offset:192 sc1
  buffer_load_dwordx4 v[144:147], v167, s[8:11], s56 offen offset:256 sc1
  s_lshl_b32 s55, s59, 7
  s_add_u32 s55, s55, 66060288
  buffer_load_dword v171, v166, s[8:11], s55 offen sc1
  v_mov_b32 v169, 0
  s_mov_b32 s66, 356352
  s_waitcnt vmcnt(0)
O_loop:
  v_mfma_f32_16x16x32_bf16 v[156:159], v[216:219], v[128:131], 0
  v_mfma_f32_16x16x32_bf16 v[160:163], v[220:223], v[128:131], 0
  v_mfma_f32_16x16x32_bf16 v[156:159], v[224:227], v[132:135], v[156:159]
  v_mfma_f32_16x16x32_bf16 v[160:163], v[228:231], v[132:135], v[160:163]
  v_mfma_f32_16x16x32_bf16 v[156:159], v[232:235], v[136:139], v[156:159]
  v_mfma_f32_16x16x32_bf16 v[160:163], v[236:239], v[136:139], v[160:163]
  v_mfma_f32_16x16x32_bf16 v[156:159], v[240:243], v[140:143], v[156:159]
  v_mfma_f32_16x16x32_bf16 v[160:163], v[244:247], v[140:143], v[160:163]
  v_mfma_f32_16x16x32_bf16 v[156:159], v[248:251], v[144:147], v[156:159]
  v_mfma_f32_16x16x32_bf16 v[160:163], v[252:255], v[144:147], v[160:163]
  s_mul_i32 s64, s59, 36864
  s_lshl_b32 s54, s70, 6
  s_add_u32 s64, s64, s54
  s_add_u32 s71, s59, 2
  s_lshl_b32 s55, s59, 18
  s_lshl_b32 s54, s52, 16
  s_add_u32 s55, s55, s54
  s_add_u32 s63, s55, 46137344
  s_and_b32 s54, s59, 1
  s_lshl_b32 s54, s54, 2
  s_add_u32 s54, s54, s52
  s_lshl_b32 s54, s54, 3
  s_lshl_b64 s[72:73], 0xff, s54
  v_sub_f32 v165, 1.0, v171
  v_cvt_pk_bf16_f32 v165, v165, v165
  v_lshlrev_b32 v165, 16, v165
  v_mul_f32 v156, v171, v156
  v_mul_f32 v157, v171, v157
  v_mul_f32 v158, v171, v158
  v_mul_f32 v159, v171, v159
  v_mul_f32 v160, v171, v160
  v_mul_f32 v161, v171, v161
  v_mul_f32 v162, v171, v162
  v_mul_f32 v163, v171, v163
  s_branch O_pc
O_pl:
  s_sleep 1
  buffer_load_dword v169, v208, s[8:11], s66 offen sc1
  s_add_u32 s65, s65, 1
  s_cmp_ge_u32 s65, 131072
  s_cbranch_scc1 O_ld
  s_waitcnt vmcnt(0)
O_pc:
  v_cmp_gt_u32 vcc, s71, v169
  s_nop 0
  s_and_b64 vcc, vcc, s[72:73]
  s_cbranch_scc1 O_pl
O_ld:
  s_mov_b32 s62, s63
  buffer_load_dword v173, v172, s[8:11], s63 offen sc1
  buffer_load_dwordx4 v[0:3], v164, s[8:11], s62 offen offset:0 sc1
  buffer_load_dwordx4 v[4:7], v164, s[8:11], s62 offen offset:2048 sc1
  s_add_u32 s62, s62, 4096
  buffer_load_dwordx4 v[8:11], v164, s[8:11], s62 offen offset:0 sc1
  buffer_load_dwordx4 v[12:15], v164, s[8:11], s62 offen offset:2048 sc1
  s_add_u32 s62, s62, 4096
  buffer_load_dwordx4 v[16:19], v164, s[8:11], s62 offen offset:0 sc1
  buffer_load_dwordx4 v[20:23], v164, s[8:11], s62 offen offset:2048 sc1
  s_add_u32 s62, s62, 4096
  buffer_load_dwordx4 v[24:27], v164, s[8:11], s62 offen offset:0 sc1
  buffer_load_dwordx4 v[28:31], v164, s[8:11], s62 offen offset:2048 sc1
  s_add_u32 s62, s62, 4096
  buffer_load_dwordx4 v[32:35], v164, s[8:11], s62 offen offset:0 sc1
  buffer_load_dwordx4 v[36:39], v164, s[8:11], s62 offen offset:2048 sc1
  s_add_u32 s62, s62, 4096
  buffer_load_dwordx4 v[40:43], v164, s[8:11], s62 offen offset:0 sc1
  buffer_load_dwordx4 v[44:47], v164, s[8:11], s62 offen offset:2048 sc1
  s_add_u32 s62, s62, 4096
  buffer_load_dwordx4 v[48:51], v164, s[8:11], s62 offen offset:0 sc1
  buffer_load_dwordx4 v[52:55], v164, s[8:11], s62 offen offset:2048 sc1
  s_add_u32 s62, s62, 4096
  buffer_load_dwordx4 v[56:59], v164, s[8:11], s62 offen offset:0 sc1
  buffer_load_dwordx4 v[60:63], v164, s[8:11], s62 offen offset:2048 sc1
  s_add_u32 s62, s62, 4096
  buffer_load_dwordx4 v[64:67], v164, s[8:11], s62 offen offset:0 sc1
  buffer_load_dwordx4 v[68:71], v164, s[8:11], s62 offen offset:2048 sc1
  s_add_u32 s62, s62, 4096
  buffer_load_dwordx4 v[72:75], v164, s[8:11], s62 offen offset:0 sc1
  buffer_load_dwordx4 v[76:79], v164, s[8:11], s62 offen offset:2048 sc1
  s_add_u32 s62, s62, 4096
  buffer_load_dwordx4 v[80:83], v164, s[8:11], s62 offen offset:0 sc1
  buffer_load_dwordx4 v[84:87], v164, s[8:11], s62 offen offset:2048 sc1
  s_add_u32 s62, s62, 4096
  buffer_load_dwordx4 v[88:91], v164, s[8:11], s62 offen offset:0 sc1
  buffer_load_dwordx4 v[92:95], v164, s[8:11], s62 offen offset:2048 sc1
  s_add_u32 s62, s62, 4096
  buffer_load_dwordx4 v[96:99], v164, s[8:11], s62 offen offset:0 sc1
  buffer_load_dwordx4 v[100:103], v164, s[8:11], s62 offen offset:2048 sc1
  s_add_u32 s62, s62, 4096
  buffer_load_dwordx4 v[104:107], v164, s[8:11], s62 offen offset:0 sc1
  buffer_load_dwordx4 v[108:111], v164, s[8:11], s62 offen offset:2048 sc1
  s_add_u32 s62, s62, 4096
  buffer_load_dwordx4 v[112:115], v164, s[8:11], s62 offen offset:0 sc1
  buffer_load_dwordx4 v[116:119], v164, s[8:11], s62 offen offset:2048 sc1
  s_add_u32 s62, s62, 4096
  buffer_load_dwordx4 v[120:123], v164, s[8:11], s62 offen offset:0 sc1
  buffer_load_dwordx4 v[124:127], v164, s[8:11], s62 offen offset:2048 sc1
  s_add_u32 s62, s62, 4096
  s_add_u32 s57, s59, 3
  s_min_u32 s74, s57, 63
  s_mul_i32 s55, s74, 36864
  s_mul_i32 s54, s52, 320
  s_add_u32 s55, s55, s54
  s_add_u32 s55, s55, 62914560
  s_cmp_eq_u32 s52, 3
  s_cselect_b32 s56, 268435456, s55
  buffer_load_dwordx4 v[128:131], v167, s[8:11], s55 offen offset:0 sc1
  buffer_load_dwordx4 v[132:135], v167, s[8:11], s55 offen offset:64 sc1
  buffer_load_dwordx4 v[136:139], v167, s[8:11], s55 offen offset:128 sc1
  buffer_load_dwordx4 v[140:143], v167, s[8:11], s56 offen offset:192 sc1
  buffer_load_dwordx4 v[144:147], v167, s[8:11], s56 offen offset:256 sc1
  s_lshl_b32 s55, s74, 7
  s_add_u32 s55, s55, 66060288
  buffer_load_dword v171, v166, s[8:11], s55 offen sc1
  s_add_u32 s65, s65, 1
  s_cmp_lt_u32 s65, 131072
  s_cselect_b32 s54, -2, -1
  s_waitcnt vmcnt(37)
  v_mfma_f32_16x16x32_bf16 v[148:151], a[0:3], v[0:3], 0
  v_mfma_f32_16x16x32_bf16 v[152:155], a[4:7], v[0:3], 0
  v_max3_u32 v170, v0, v1, v0
  v_max3_u32 v170, v2, v3, v170
  s_waitcnt vmcnt(36)
  v_mfma_f32_16x16x32_bf16 v[148:151], a[8:11], v[4:7], v[148:151]
  v_mfma_f32_16x16x32_bf16 v[152:155], a[12:15], v[4:7], v[152:155]
  v_max3_u32 v170, v4, v5, v170
  v_max3_u32 v170, v6, v7, v170
  s_waitcnt vmcnt(35)
  v_mfma_f32_16x16x32_bf16 v[148:151], a[16:19], v[8:11], v[148:151]
  v_mfma_f32_16x16x32_bf16 v[152:155], a[20:23], v[8:11], v[152:155]
  v_max3_u32 v170, v8, v9, v170
  v_max3_u32 v170, v10, v11, v170
  s_waitcnt vmcnt(34)
  v_mfma_f32_16x16x32_bf16 v[148:151], a[24:27], v[12:15], v[148:151]
  v_mfma_f32_16x16x32_bf16 v[152:155], a[28:31], v[12:15], v[152:155]
  v_max3_u32 v170, v12, v13, v170
  v_max3_u32 v170, v14, v15, v170
  s_waitcnt vmcnt(33)
  v_mfma_f32_16x16x32_bf16 v[148:151], a[32:35], v[16:19], v[148:151]
  v_mfma_f32_16x16x32_bf16 v[152:155], a[36:39], v[16:19], v[152:155]
  v_max3_u32 v170, v16, v17, v170
  v_max3_u32 v170, v18, v19, v170
  s_waitcnt vmcnt(32)
  v_mfma_f32_16x16x32_bf16 v[148:151], a[40:43], v[20:23], v[148:151]
  v_mfma_f32_16x16x32_bf16 v[152:155], a[44:47], v[20:23], v[152:155]
  v_max3_u32 v170, v20, v21, v170
  v_max3_u32 v170, v22, v23, v170
  s_waitcnt vmcnt(31)
  v_mfma_f32_16x16x32_bf16 v[148:151], a[48:51], v[24:27], v[148:151]
  v_mfma_f32_16x16x32_bf16 v[152:155], a[52:55], v[24:27], v[152:155]
  v_max3_u32 v170, v24, v25, v170
  v_max3_u32 v170, v26, v27, v170
  s_waitcnt vmcnt(30)
  v_mfma_f32_16x16x32_bf16 v[148:151], a[56:59], v[28:31], v[148:151]
  v_mfma_f32_16x16x32_bf16 v[152:155], a[60:63], v[28:31], v[152:155]
  v_max3_u32 v170, v28, v29, v170
  v_max3_u32 v170, v30, v31, v170
  s_waitcnt vmcnt(29)
  v_mfma_f32_16x16x32_bf16 v[148:151], a[64:67], v[32:35], v[148:151]
  v_mfma_f32_16x16x32_bf16 v[152:155], a[68:71], v[32:35], v[152:155]
  v_max3_u32 v170, v32, v33, v170
  v_max3_u32 v170, v34, v35, v170
  s_waitcnt vmcnt(28)
  v_mfma_f32_16x16x32_bf16 v[148:151], a[72:75], v[36:39], v[148:151]
  v_mfma_f32_16x16x32_bf16 v[152:155], a[76:79], v[36:39], v[152:155]
  v_max3_u32 v170, v36, v37, v170
  v_max3_u32 v170, v38, v39, v170
  s_waitcnt vmcnt(27)
  v_mfma_f32_16x16x32_bf16 v[148:151], a[80:83], v[40:43], v[148:151]
  v_mfma_f32_16x16x32_bf16 v[152:155], a[84:87], v[40:43], v[152:155]
  v_max3_u32 v170, v40, v41, v170
  v_max3_u32 v170, v42, v43, v170
  s_waitcnt vmcnt(26)
  v_mfma_f32_16x16x32_bf16 v[148:151], a[88:91], v[44:47], v[148:151]
  v_mfma_f32_16x16x32_bf16 v[152:155], a[92:95], v[44:47], v[152:155]
  v_max3_u32 v170, v44, v45, v170
  v_max3_u32 v170, v46, v47, v170
  s_waitcnt vmcnt(25)
  v_mfma_f32_16x16x32_bf16 v[148:151], a[96:99], v[48:51], v[148:151]
  v_mfma_f32_16x16x32_bf16 v[152:155], a[100:103], v[48:51], v[152:155]
  v_max3_u32 v170, v48, v49, v170
  v_max3_u32 v170, v50, v51, v170
  s_waitcnt vmcnt(24)
  v_mfma_f32_16x16x32_bf16 v[148:151], a[104:107], v[52:55], v[148:151]
  v_mfma_f32_16x16x32_bf16 v[152:155], a[108:111], v[52:55], v[152:155]
  v_max3_u32 v170, v52, v53, v170
  v_max3_u32 v170, v54, v55, v170
  s_waitcnt vmcnt(23)
  v_mfma_f32_16x16x32_bf16 v[148:151], a[112:115], v[56:59], v[148:151]
  v_mfma_f32_16x16x32_bf16 v[152:155], a[116:119], v[56:59], v[152:155]
  v_max3_u32 v170, v56, v57, v170
  v_max3_u32 v170, v58, v59, v170
  s_waitcnt vmcnt(22)
  v_mfma_f32_16x16x32_bf16 v[148:151], a[120:123], v[60:63], v[148:151]
  v_mfma_f32_16x16x32_bf16 v[152:155], a[124:127], v[60:63], v[152:155]
  v_max3_u32 v170, v60, v61, v170
  v_max3_u32 v170, v62, v63, v170
  s_waitcnt vmcnt(21)
  v_mfma_f32_16x16x32_bf16 v[148:151], a[128:131], v[64:67], v[148:151]
  v_mfma_f32_16x16x32_bf16 v[152:155], a[132:135], v[64:67], v[152:155]
  v_max3_u32 v170, v64, v65, v170
  v_max3_u32 v170, v66, v67, v170
  s_waitcnt vmcnt(20)
  v_mfma_f32_16x16x32_bf16 v[148:151], a[136:139], v[68:71], v[148:151]
  v_mfma_f32_16x16x32_bf16 v[152:155], a[140:143], v[68:71], v[152:155]
  v_max3_u32 v170, v68, v69, v170
  v_max3_u32 v170, v70, v71, v170
  s_waitcnt vmcnt(19)
  v_mfma_f32_16x16x32_bf16 v[148:151], a[144:147], v[72:75], v[148:151]
  v_mfma_f32_16x16x32_bf16 v[152:155], a[148:151], v[72:75], v[152:155]
  v_max3_u32 v170, v72, v73, v170
  v_max3_u32 v170, v74, v75, v170
  s_waitcnt vmcnt(18)
  v_mfma_f32_16x16x32_bf16 v[148:151], a[152:155], v[76:79], v[148:151]
  v_mfma_f32_16x16x32_bf16 v[152:155], a[156:159], v[76:79], v[152:155]
  v_max3_u32 v170, v76, v77, v170
  v_max3_u32 v170, v78, v79, v170
  s_waitcnt vmcnt(17)
  v_mfma_f32_16x16x32_bf16 v[148:151], a[160:163], v[80:83], v[148:151]
  v_mfma_f32_16x16x32_bf16 v[152:155], a[164:167], v[80:83], v[152:155]
  v_max3_u32 v170, v80, v81, v170
  v_max3_u32 v170, v82, v83, v170
  s_waitcnt vmcnt(16)
  v_mfma_f32_16x16x32_bf16 v[148:151], a[168:171], v[84:87], v[148:151]
  v_mfma_f32_16x16x32_bf16 v[152:155], a[172:175], v[84:87], v[152:155]
  v_max3_u32 v170, v84, v85, v170
  v_max3_u32 v170, v86, v87, v170
  s_waitcnt vmcnt(15)
  v_mfma_f32_16x16x32_bf16 v[148:151], a[176:179], v[88:91], v[148:151]
  v_mfma_f32_16x16x32_bf16 v[152:155], a[180:183], v[88:91], v[152:155]
  v_max3_u32 v170, v88, v89, v170
  v_max3_u32 v170, v90, v91, v170
  s_waitcnt vmcnt(14)
  v_mfma_f32_16x16x32_bf16 v[148:151], a[184:187], v[92:95], v[148:151]
  v_mfma_f32_16x16x32_bf16 v[152:155], a[188:191], v[92:95], v[152:155]
  v_max3_u32 v170, v92, v93, v170
  v_max3_u32 v170, v94, v95, v170
  s_waitcnt vmcnt(13)
  v_mfma_f32_16x16x32_bf16 v[148:151], a[192:195], v[96:99], v[148:151]
  v_mfma_f32_16x16x32_bf16 v[152:155], a[196:199], v[96:99], v[152:155]
  v_max3_u32 v170, v96, v97, v170
  v_max3_u32 v170, v98, v99, v170
  s_waitcnt vmcnt(12)
  v_mfma_f32_16x16x32_bf16 v[148:151], a[200:203], v[100:103], v[148:151]
  v_mfma_f32_16x16x32_bf16 v[152:155], a[204:207], v[100:103], v[152:155]
  v_max3_u32 v170, v100, v101, v170
  v_max3_u32 v170, v102, v103, v170
  s_waitcnt vmcnt(11)
  v_mfma_f32_16x16x32_bf16 v[148:151], a[208:211], v[104:107], v[148:151]
  v_mfma_f32_16x16x32_bf16 v[152:155], a[212:215], v[104:107], v[152:155]
  v_max3_u32 v170, v104, v105, v170
  v_max3_u32 v170, v106, v107, v170
  s_waitcnt vmcnt(10)
  v_mfma_f32_16x16x32_bf16 v[148:151], a[216:219], v[108:111], v[148:151]
  v_mfma_f32_16x16x32_bf16 v[152:155], a[220:223], v[108:111], v[152:155]
  v_max3_u32 v170, v108, v109, v170
  v_max3_u32 v170, v110, v111, v170
  s_waitcnt vmcnt(9)
  v_mfma_f32_16x16x32_bf16 v[148:151], a[224:227], v[112:115], v[148:151]
  v_mfma_f32_16x16x32_bf16 v[152:155], a[228:231], v[112:115], v[152:155]
  v_max3_u32 v170, v112, v113, v170
  v_max3_u32 v170, v114, v115, v170
  s_waitcnt vmcnt(8)
  v_mfma_f32_16x16x32_bf16 v[148:151], a[232:235], v[116:119], v[148:151]
  v_mfma_f32_16x16x32_bf16 v[152:155], a[236:239], v[116:119], v[152:155]
  v_max3_u32 v170, v116, v117, v170
  v_max3_u32 v170, v118, v119, v170
  s_waitcnt vmcnt(7)
  v_mfma_f32_16x16x32_bf16 v[148:151], a[240:243], v[120:123], v[148:151]
  v_mfma_f32_16x16x32_bf16 v[152:155], a[244:247], v[120:123], v[152:155]
  v_max3_u32 v170, v120, v121, v170
  v_max3_u32 v170, v122, v123, v170
  s_waitcnt vmcnt(6)
  v_mfma_f32_16x16x32_bf16 v[148:151], a[248:251], v[124:127], v[148:151]
  v_mfma_f32_16x16x32_bf16 v[152:155], a[252:255], v[124:127], v[152:155]
  v_max3_u32 v170, v124, v125, v170
  v_max3_u32 v170, v126, v127, v170
  v_cmp_lt_u32 vcc, s54, v170
  s_cbranch_vccnz O_ld
  v_fmac_f32 v156, v165, v148
  v_fmac_f32 v157, v165, v149
  v_fmac_f32 v158, v165, v150
  v_fmac_f32 v159, v165, v151
  v_fmac_f32 v160, v165, v152
  v_fmac_f32 v161, v165, v153
  v_fmac_f32 v162, v165, v154
  v_fmac_f32 v163, v165, v155
  ds_write_b128 v168, v[156:159]
  ds_write_b128 v168, v[160:163] offset:1024
  v_xor_b32 v168, 0x2000, v168
  s_mov_b32 s59, s57
  s_waitcnt lgkmcnt(0)
  s_barrier
  s_cmp_eq_u32 s52, 0
  s_cbranch_scc0 O_next
  v_xor_b32 v211, 0x2000, v168
  ds_read_b128 v[0:3], v211 offset:2048
  ds_read_b128 v[4:7], v211 offset:3072
  ds_read_b128 v[8:11], v211 offset:4096
  ds_read_b128 v[12:15], v211 offset:5120
  ds_read_b128 v[16:19], v211 offset:6144
  ds_read_b128 v[20:23], v211 offset:7168
  s_waitcnt lgkmcnt(5)
  v_add_f32 v156, v156, v0
  v_add_f32 v157, v157, v1
  v_add_f32 v158, v158, v2
  v_add_f32 v159, v159, v3
  s_waitcnt lgkmcnt(4)
  v_add_f32 v160, v160, v4
  v_add_f32 v161, v161, v5
  v_add_f32 v162, v162, v6
  v_add_f32 v163, v163, v7
  s_waitcnt lgkmcnt(3)
  v_add_f32 v156, v156, v8
  v_add_f32 v157, v157, v9
  v_add_f32 v158, v158, v10
  v_add_f32 v159, v159, v11
  s_waitcnt lgkmcnt(2)
  v_add_f32 v160, v160, v12
  v_add_f32 v161, v161, v13
  v_add_f32 v162, v162, v14
  v_add_f32 v163, v163, v15
  s_waitcnt lgkmcnt(1)
  v_add_f32 v156, v156, v16
  v_add_f32 v157, v157, v17
  v_add_f32 v158, v158, v18
  v_add_f32 v159, v159, v19
  s_waitcnt lgkmcnt(0)
  v_add_f32 v160, v160, v20
  v_add_f32 v161, v161, v21
  v_add_f32 v162, v162, v22
  v_add_f32 v163, v163, v23
  v_cvt_pk_bf16_f32 v148, v156, v157
  v_cvt_pk_bf16_f32 v149, v158, v159
  v_cvt_pk_bf16_f32 v150, v160, v161
  v_cvt_pk_bf16_f32 v151, v162, v163
  buffer_store_dwordx4 v[148:151], v167, s[48:51], s64 offen
  s_waitcnt vmcnt(1)
  s_branch O_nx2
O_next:
  s_waitcnt vmcnt(0)
O_nx2:
  s_cmp_lt_u32 s59, 64
  s_cbranch_scc1 O_loop
  s_branch L_exit
W_h:
  s_lshr_b32 s58, s53, 1
  s_and_b32 s59, s53, 1
  s_mul_i32 s60, s59, 36864
  s_add_u32 m0, s67, 0
  s_nop 0
  buffer_load_dwordx4 v202, s[4:7], s60 offen offset:0 lds
  s_add_u32 m0, s67, 896
  s_nop 0
  buffer_load_dwordx4 v202, s[4:7], s60 offen offset:128 lds
  s_add_u32 m0, s67, 1792
  s_nop 0
  buffer_load_dwordx4 v202, s[4:7], s60 offen offset:256 lds
  s_add_u32 m0, s67, 2688
  s_nop 0
  buffer_load_dwordx4 v202, s[4:7], s60 offen offset:384 lds
  s_add_u32 m0, s67, 3584
  s_nop 0
  buffer_load_dwordx4 v202, s[4:7], s60 offen offset:512 lds
  s_add_u32 m0, s67, 4480
  s_nop 0
  buffer_load_dwordx4 v202, s[4:7], s60 offen offset:640 lds
  s_add_u32 m0, s67, 5376
  s_nop 0
  buffer_load_dwordx4 v202, s[4:7], s60 offen offset:768 lds
  s_add_u32 m0, s67, 6272
  s_nop 0
  buffer_load_dwordx4 v202, s[4:7], s60 offen offset:896 lds
  s_add_u32 m0, s67, 7168
  s_nop 0
  buffer_load_dwordx4 v202, s[4:7], s60 offen offset:1024 lds
  v_lshrrev_b32 v211, 4, v200
  v_lshlrev_b32 v212, 2, v211
  v_and_b32 v213, 15, v200
  v_xor_b32 v212, v212, v213
  v_lshlrev_b32 v212, 4, v212
  v_lshl_add_u32 v207, v211, 13, v212
  s_lshl_b32 s62, s58, 8
  s_lshl_b32 s54, s52, 15
  s_add_u32 s62, s62, s54
  s_lshl_b32 s61, s52, 10
  s_add_u32 s61, s61, 36864
  s_add_u32 m0, s61, 0
  s_add_u32 s54, s62, 0
  buffer_load_dwordx4 v207, s[16:19], s54 offen lds
  s_add_u32 m0, s61, 4096
  s_add_u32 s54, s62, 131072
  buffer_load_dwordx4 v207, s[16:19], s54 offen lds
  s_add_u32 m0, s61, 8192
  s_add_u32 s54, s62, 262144
  buffer_load_dwordx4 v207, s[16:19], s54 offen lds
  s_add_u32 m0, s61, 12288
  s_add_u32 s54, s62, 393216
  buffer_load_dwordx4 v207, s[16:19], s54 offen lds
  s_add_u32 m0, s61, 16384
  s_add_u32 s54, s62, 524288
  buffer_load_dwordx4 v207, s[16:19], s54 offen lds
  s_add_u32 m0, s61, 20480
  s_add_u32 s54, s62, 655360
  buffer_load_dwordx4 v207, s[16:19], s54 offen lds
  s_add_u32 m0, s61, 24576
  s_add_u32 s54, s62, 786432
  buffer_load_dwordx4 v207, s[16:19], s54 offen lds
  s_add_u32 m0, s61, 28672
  s_add_u32 s54, s62, 917504
  buffer_load_dwordx4 v207, s[16:19], s54 offen lds
  s_add_u32 m0, s61, 32768
  s_add_u32 s54, s62, 1048576
  buffer_load_dwordx4 v207, s[16:19], s54 offen lds
  s_add_u32 m0, s61, 36864
  s_add_u32 s54, s62, 1179648
  buffer_load_dwordx4 v207, s[16:19], s54 offen lds
  s_add_u32 m0, s61, 40960
  s_add_u32 s54, s62, 1310720
  buffer_load_dwordx4 v207, s[16:19], s54 offen lds
  s_add_u32 m0, s61, 45056
  s_add_u32 s54, s62, 1441792
  buffer_load_dwordx4 v207, s[16:19], s54 offen lds
  s_add_u32 m0, s61, 49152
  s_add_u32 s54, s62, 1572864
  buffer_load_dwordx4 v207, s[16:19], s54 offen lds
  s_add_u32 m0, s61, 53248
  s_add_u32 s54, s62, 1703936
  buffer_load_dwordx4 v207, s[16:19], s54 offen lds
  s_add_u32 m0, s61, 57344
  s_add_u32 s54, s62, 1835008
  buffer_load_dwordx4 v207, s[16:19], s54 offen lds
  s_add_u32 m0, s61, 61440
  s_add_u32 s54, s62, 1966080
  buffer_load_dwordx4 v207, s[16:19], s54 offen lds
  s_add_u32 m0, s61, 65536
  s_add_u32 s54, s62, 2097152
  buffer_load_dwordx4 v207, s[16:19], s54 offen lds
  s_add_u32 m0, s61, 69632
  s_add_u32 s54, s62, 2228224
  buffer_load_dwordx4 v207, s[16:19], s54 offen lds
  s_add_u32 m0, s61, 73728
  s_add_u32 s54, s62, 2359296
  buffer_load_dwordx4 v207, s[16:19], s54 offen lds
  s_add_u32 m0, s61, 77824
  s_add_u32 s54, s62, 2490368
  buffer_load_dwordx4 v207, s[16:19], s54 offen lds
  s_add_u32 m0, s61, 81920
  s_add_u32 s54, s62, 2621440
  buffer_load_dwordx4 v207, s[16:19], s54 offen lds
  s_add_u32 m0, s61, 86016
  s_add_u32 s54, s62, 2752512
  buffer_load_dwordx4 v207, s[16:19], s54 offen lds
  s_add_u32 m0, s61, 90112
  s_add_u32 s54, s62, 2883584
  buffer_load_dwordx4 v207, s[16:19], s54 offen lds
  s_add_u32 m0, s61, 94208
  s_add_u32 s54, s62, 3014656
  buffer_load_dwordx4 v207, s[16:19], s54 offen lds
  s_waitcnt vmcnt(20) lgkmcnt(0)
  s_barrier
  s_add_u32 m0, s61, 98304
  s_add_u32 s54, s62, 3145728
  buffer_load_dwordx4 v207, s[16:19], s54 offen lds
  s_add_u32 m0, s61, 102400
  s_add_u32 s54, s62, 3276800
  buffer_load_dwordx4 v207, s[16:19], s54 offen lds
  s_add_u32 m0, s61, 106496
  s_add_u32 s54, s62, 3407872
  buffer_load_dwordx4 v207, s[16:19], s54 offen lds
  s_add_u32 m0, s61, 110592
  s_add_u32 s54, s62, 3538944
  buffer_load_dwordx4 v207, s[16:19], s54 offen lds
  v_add_u32 v215, 36864, v209
  ds_read_b64_tr_b16 a[0:1], v215 offset:0
  ds_read_b64_tr_b16 a[2:3], v215 offset:1024
  ds_read_b64_tr_b16 a[4:5], v215 offset:4096
  ds_read_b64_tr_b16 a[6:7], v215 offset:5120
  ds_read_b64_tr_b16 a[8:9], v215 offset:8192
  ds_read_b64_tr_b16 a[10:11], v215 offset:9216
  ds_read_b64_tr_b16 a[12:13], v215 offset:12288
  ds_read_b64_tr_b16 a[14:15], v215 offset:13312
  s_waitcnt vmcnt(20) lgkmcnt(0)
  s_barrier
  s_add_u32 m0, s61, 0
  s_add_u32 s54, s62, 3670016
  buffer_load_dwordx4 v207, s[16:19], s54 offen lds
  s_add_u32 m0, s61, 4096
  s_add_u32 s54, s62, 3801088
  buffer_load_dwordx4 v207, s[16:19], s54 offen lds
  s_add_u32 m0, s61, 8192
  s_add_u32 s54, s62, 3932160
  buffer_load_dwordx4 v207, s[16:19], s54 offen lds
  s_add_u32 m0, s61, 12288
  s_add_u32 s54, s62, 4063232
  buffer_load_dwordx4 v207, s[16:19], s54 offen lds
  v_add_u32 v215, 53248, v209
  ds_read_b64_tr_b16 a[16:17], v215 offset:0
  ds_read_b64_tr_b16 a[18:19], v215 offset:1024
  ds_read_b64_tr_b16 a[20:21], v215 offset:4096
  ds_read_b64_tr_b16 a[22:23], v215 offset:5120
  ds_read_b64_tr_b16 a[24:25], v215 offset:8192
  ds_read_b64_tr_b16 a[26:27], v215 offset:9216
  ds_read_b64_tr_b16 a[28:29], v215 offset:12288
  ds_read_b64_tr_b16 a[30:31], v215 offset:13312
  s_waitcnt vmcnt(20) lgkmcnt(0)
  s_barrier
  s_add_u32 m0, s61, 16384
  s_add_u32 s54, s62, 4194304
  buffer_load_dwordx4 v207, s[16:19], s54 offen lds
  s_add_u32 m0, s61, 20480
  s_add_u32 s54, s62, 4325376
  buffer_load_dwordx4 v207, s[16:19], s54 offen lds
  s_add_u32 m0, s61, 24576
  s_add_u32 s54, s62, 4456448
  buffer_load_dwordx4 v207, s[16:19], s54 offen lds
  s_add_u32 m0, s61, 28672
  s_add_u32 s54, s62, 4587520
  buffer_load_dwordx4 v207, s[16:19], s54 offen lds
  v_add_u32 v215, 69632, v209
  ds_read_b64_tr_b16 a[32:33], v215 offset:0
  ds_read_b64_tr_b16 a[34:35], v215 offset:1024
  ds_read_b64_tr_b16 a[36:37], v215 offset:4096
  ds_read_b64_tr_b16 a[38:39], v215 offset:5120
  ds_read_b64_tr_b16 a[40:41], v215 offset:8192
  ds_read_b64_tr_b16 a[42:43], v215 offset:9216
  ds_read_b64_tr_b16 a[44:45], v215 offset:12288
  ds_read_b64_tr_b16 a[46:47], v215 offset:13312
  s_waitcnt vmcnt(20) lgkmcnt(0)
  s_barrier
  v_add_u32 v215, 86016, v209
  ds_read_b64_tr_b16 a[48:49], v215 offset:0
  ds_read_b64_tr_b16 a[50:51], v215 offset:1024
  ds_read_b64_tr_b16 a[52:53], v215 offset:4096
  ds_read_b64_tr_b16 a[54:55], v215 offset:5120
  ds_read_b64_tr_b16 a[56:57], v215 offset:8192
  ds_read_b64_tr_b16 a[58:59], v215 offset:9216
  ds_read_b64_tr_b16 a[60:61], v215 offset:12288
  ds_read_b64_tr_b16 a[62:63], v215 offset:13312
  s_waitcnt vmcnt(16) lgkmcnt(0)
  s_barrier
  v_add_u32 v215, 102400, v209
  ds_read_b64_tr_b16 a[64:65], v215 offset:0
  ds_read_b64_tr_b16 a[66:67], v215 offset:1024
  ds_read_b64_tr_b16 a[68:69], v215 offset:4096
  ds_read_b64_tr_b16 a[70:71], v215 offset:5120
  ds_read_b64_tr_b16 a[72:73], v215 offset:8192
  ds_read_b64_tr_b16 a[74:75], v215 offset:9216
  ds_read_b64_tr_b16 a[76:77], v215 offset:12288
  ds_read_b64_tr_b16 a[78:79], v215 offset:13312
  s_waitcnt vmcnt(12) lgkmcnt(0)
  s_barrier
  v_add_u32 v215, 118784, v209
  ds_read_b64_tr_b16 a[80:81], v215 offset:0
  ds_read_b64_tr_b16 a[82:83], v215 offset:1024
  ds_read_b64_tr_b16 a[84:85], v215 offset:4096
  ds_read_b64_tr_b16 a[86:87], v215 offset:5120
  ds_read_b64_tr_b16 a[88:89], v215 offset:8192
  ds_read_b64_tr_b16 a[90:91], v215 offset:9216
  ds_read_b64_tr_b16 a[92:93], v215 offset:12288
  ds_read_b64_tr_b16 a[94:95], v215 offset:13312
  s_waitcnt vmcnt(8) lgkmcnt(0)
  s_barrier
  v_add_u32 v215, 135168, v209
  ds_read_b64_tr_b16 a[96:97], v215 offset:0
  ds_read_b64_tr_b16 a[98:99], v215 offset:1024
  ds_read_b64_tr_b16 a[100:101], v215 offset:4096
  ds_read_b64_tr_b16 a[102:103], v215 offset:5120
  ds_read_b64_tr_b16 a[104:105], v215 offset:8192
  ds_read_b64_tr_b16 a[106:107], v215 offset:9216
  ds_read_b64_tr_b16 a[108:109], v215 offset:12288
  ds_read_b64_tr_b16 a[110:111], v215 offset:13312
  s_waitcnt vmcnt(4) lgkmcnt(0)
  s_barrier
  v_add_u32 v215, 36864, v209
  ds_read_b64_tr_b16 a[112:113], v215 offset:0
  ds_read_b64_tr_b16 a[114:115], v215 offset:1024
  ds_read_b64_tr_b16 a[116:117], v215 offset:4096
  ds_read_b64_tr_b16 a[118:119], v215 offset:5120
  ds_read_b64_tr_b16 a[120:121], v215 offset:8192
  ds_read_b64_tr_b16 a[122:123], v215 offset:9216
  ds_read_b64_tr_b16 a[124:125], v215 offset:12288
  ds_read_b64_tr_b16 a[126:127], v215 offset:13312
  s_waitcnt vmcnt(0) lgkmcnt(0)
  s_barrier
  v_add_u32 v215, 53248, v209
  ds_read_b64_tr_b16 a[128:129], v215 offset:0
  ds_read_b64_tr_b16 a[130:131], v215 offset:1024
  ds_read_b64_tr_b16 a[132:133], v215 offset:4096
  ds_read_b64_tr_b16 a[134:135], v215 offset:5120
  ds_read_b64_tr_b16 a[136:137], v215 offset:8192
  ds_read_b64_tr_b16 a[138:139], v215 offset:9216
  ds_read_b64_tr_b16 a[140:141], v215 offset:12288
  ds_read_b64_tr_b16 a[142:143], v215 offset:13312
  s_waitcnt lgkmcnt(0)
  s_barrier
  v_and_b32 v211, 31, v200
  v_lshrrev_b32 v212, 5, v200
  v_lshlrev_b32 v213, 2, v212
  v_sub_u32 v211, v211, v213
  v_mov_b32 v214, 0xf149f2ca
  v_cmp_gt_i32 vcc, 0, v211
  s_nop 1
  v_cndmask_b32 v48, 0, v214, vcc
  v_cmp_gt_i32 vcc, 1, v211
  s_nop 1
  v_cndmask_b32 v49, 0, v214, vcc
  v_cmp_gt_i32 vcc, 2, v211
  s_nop 1
  v_cndmask_b32 v50, 0, v214, vcc
  v_cmp_gt_i32 vcc, 3, v211
  s_nop 1
  v_cndmask_b32 v51, 0, v214, vcc
  v_cmp_gt_i32 vcc, 8, v211
  s_nop 1
  v_cndmask_b32 v52, 0, v214, vcc
  v_cmp_gt_i32 vcc, 9, v211
  s_nop 1
  v_cndmask_b32 v53, 0, v214, vcc
  v_cmp_gt_i32 vcc, 10, v211
  s_nop 1
  v_cndmask_b32 v54, 0, v214, vcc
  v_cmp_gt_i32 vcc, 11, v211
  s_nop 1
  v_cndmask_b32 v55, 0, v214, vcc
  v_cmp_gt_i32 vcc, 16, v211
  s_nop 1
  v_cndmask_b32 v56, 0, v214, vcc
  v_cmp_gt_i32 vcc, 17, v211
  s_nop 1
  v_cndmask_b32 v57, 0, v214, vcc
  v_cmp_gt_i32 vcc, 18, v211
  s_nop 1
  v_cndmask_b32 v58, 0, v214, vcc
  v_cmp_gt_i32 vcc, 19, v211
  s_nop 1
  v_cndmask_b32 v59, 0, v214, vcc
  v_cmp_gt_i32 vcc, 24, v211
  s_nop 1
  v_cndmask_b32 v60, 0, v214, vcc
  v_cmp_gt_i32 vcc, 25, v211
  s_nop 1
  v_cndmask_b32 v61, 0, v214, vcc
  v_cmp_gt_i32 vcc, 26, v211
  s_nop 1
  v_cndmask_b32 v62, 0, v214, vcc
  v_cmp_gt_i32 vcc, 27, v211
  s_nop 1
  v_cndmask_b32 v63, 0, v214, vcc
  v_and_b32 v218, 0xff, v216
  v_add_u32 v218, 81920, v218
  v_and_b32 v211, 15, v200
  v_lshl_add_u32 v211, v212, 5, v211
  v_lshlrev_b32 v219, 3, v211
  v_bfe_u32 v211, v200, 4, 1
  v_lshl_add_u32 v219, v211, 2, v219
  s_lshl_b32 s54, s52, 9
  s_add_u32 s54, s54, 83968
  v_add_u32 v219, s54, v219
  v_lshl_add_u32 v221, v200, 3, s54
  s_lshr_b32 s54, s52, 1
  s_lshl_b32 s54, s54, 10
  s_and_b32 s55, s52, 1
  s_lshl_b32 s55, s55, 3
  s_add_u32 s54, s54, s55
  s_add_u32 s54, s54, 81920
  v_add_u32 v220, s54, v201
  s_lshl_b32 s54, s52, 11
  s_add_u32 s54, s54, 73728
  v_add_u32 v215, s54, v201
  v_add_u32 v208, 73728, v201
  s_mov_b32 s68, 1040356334
  s_cmp_eq_u32 s52, 0
  s_cselect_b32 s71, s71, 268435456
  s_lshl_b32 s56, s58, 2
  s_add_u32 s56, s56, 128
  v_mov_b32 v176, -1
  v_mov_b32 v177, -1
  v_mov_b32 v178, -1
  v_mov_b32 v179, -1
  s_cmp_eq_u32 s52, 0
  s_cbranch_scc0 AT_p1_d
  s_mov_b32 exec_hi, 0
  s_mov_b32 exec_lo, 1
AT_p1:
  buffer_load_dword v211, v201, s[12:15], s56 offen sc1
  s_add_u32 s65, s65, 1
  s_waitcnt vmcnt(0)
  v_cmp_gt_u32 vcc, 0x700, v211
  s_cbranch_vccz AT_p1_x
  s_sleep 8
  s_cmp_lt_u32 s65, 131072
  s_cbranch_scc1 AT_p1
AT_p1_x:
  s_mov_b64 exec, -1
AT_p1_d:
  s_barrier
  s_mov_b32 s74, s59
  s_mul_i32 s66, s59, 655360
  s_lshl_b32 s55, s58, 14
  s_add_u32 s55, s55, s66
  s_add_u32 s55, s55, 1048576
  s_lshl_b32 s73, s58, 2
  s_add_u32 s73, s73, s52
  s_lshl_b32 s72, s59, 7
  s_add_u32 s72, s72, s73
  s_lshl_b32 s72, s72, 11
  s_add_u32 s72, s72, 46137344
  s_lshl_b32 s73, s73, 10
  s_add_u32 s73, s73, s66
  s_add_u32 s73, s73, 1572864
  s_add_u32 s59, s59, 2
  buffer_load_dwordx4 v[128:131], v216, s[8:11], s55 offen offset:0 sc1
  buffer_load_dwordx4 v[132:135], v216, s[8:11], s55 offen offset:256 sc1
  buffer_load_dwordx4 v[136:139], v216, s[8:11], s55 offen offset:512 sc1
  buffer_load_dwordx4 v[140:143], v216, s[8:11], s55 offen offset:768 sc1
  buffer_load_dwordx4 v[144:147], v216, s[8:11], s55 offen offset:1024 sc1
  buffer_load_dwordx4 v[148:151], v216, s[8:11], s55 offen offset:1280 sc1
  buffer_load_dwordx4 v[152:155], v216, s[8:11], s55 offen offset:1536 sc1
  buffer_load_dwordx4 v[156:159], v216, s[8:11], s55 offen offset:1792 sc1
  buffer_load_dwordx4 v[160:163], v217, s[8:11], s55 offen offset:0 sc1
  buffer_load_dwordx4 v[164:167], v217, s[8:11], s55 offen offset:256 sc1
  s_add_u32 s60, s60, 73728
  ds_read_b128 v[32:35], v203 offset:0
  ds_read_b128 v[36:39], v204 offset:0
  ds_read_b128 v[40:43], v205 offset:0
  s_waitcnt lgkmcnt(2)
  v_mfma_f32_32x32x16_bf16 v[240:255], a[0:3], v[32:35], 0
  ds_read_b128 v[44:47], v206 offset:0
  s_add_u32 m0, s67, 36864
  s_nop 0
  buffer_load_dwordx4 v202, s[4:7], s60 offen offset:0 lds
  s_waitcnt lgkmcnt(2)
  v_mfma_f32_32x32x16_bf16 v[240:255], a[4:7], v[36:39], v[240:255]
  ds_read_b128 v[32:35], v203 offset:1024
  s_waitcnt lgkmcnt(2)
  v_mfma_f32_32x32x16_bf16 v[240:255], a[8:11], v[40:43], v[240:255]
  ds_read_b128 v[36:39], v204 offset:1024
  s_add_u32 m0, s67, 37760
  s_nop 0
  buffer_load_dwordx4 v202, s[4:7], s60 offen offset:128 lds
  s_waitcnt lgkmcnt(2)
  v_mfma_f32_32x32x16_bf16 v[240:255], a[12:15], v[44:47], v[240:255]
  ds_read_b128 v[40:43], v205 offset:1024
  s_waitcnt lgkmcnt(2)
  v_mfma_f32_32x32x16_bf16 v[240:255], a[16:19], v[32:35], v[240:255]
  ds_read_b128 v[44:47], v206 offset:1024
  s_add_u32 m0, s67, 38656
  s_nop 0
  buffer_load_dwordx4 v202, s[4:7], s60 offen offset:256 lds
  s_waitcnt lgkmcnt(2)
  v_mfma_f32_32x32x16_bf16 v[240:255], a[20:23], v[36:39], v[240:255]
  ds_read_b128 v[32:35], v203 offset:2048
  s_waitcnt lgkmcnt(2)
  v_mfma_f32_32x32x16_bf16 v[240:255], a[24:27], v[40:43], v[240:255]
  ds_read_b128 v[36:39], v204 offset:2048
  s_add_u32 m0, s67, 39552
  s_nop 0
  buffer_load_dwordx4 v202, s[4:7], s60 offen offset:384 lds
  s_waitcnt lgkmcnt(2)
  v_mfma_f32_32x32x16_bf16 v[240:255], a[28:31], v[44:47], v[240:255]
  ds_read_b128 v[40:43], v205 offset:2048
  s_waitcnt lgkmcnt(2)
  v_mfma_f32_32x32x16_bf16 v[240:255], a[32:35], v[32:35], v[240:255]
  ds_read_b128 v[44:47], v206 offset:2048
  s_add_u32 m0, s67, 40448
  s_nop 0
  buffer_load_dwordx4 v202, s[4:7], s60 offen offset:512 lds
  s_waitcnt lgkmcnt(2)
  v_mfma_f32_32x32x16_bf16 v[240:255], a[36:39], v[36:39], v[240:255]
  ds_read_b128 v[32:35], v203 offset:3072
  s_waitcnt lgkmcnt(2)
  v_mfma_f32_32x32x16_bf16 v[240:255], a[40:43], v[40:43], v[240:255]
  ds_read_b128 v[36:39], v204 offset:3072
  s_add_u32 m0, s67, 41344
  s_nop 0
  buffer_load_dwordx4 v202, s[4:7], s60 offen offset:640 lds
  s_waitcnt lgkmcnt(2)
  v_mfma_f32_32x32x16_bf16 v[240:255], a[44:47], v[44:47], v[240:255]
  ds_read_b128 v[40:43], v205 offset:3072
  s_waitcnt lgkmcnt(2)
  v_mfma_f32_32x32x16_bf16 v[240:255], a[48:51], v[32:35], v[240:255]
  ds_read_b128 v[44:47], v206 offset:3072
  s_add_u32 m0, s67, 42240
  s_nop 0
  buffer_load_dwordx4 v202, s[4:7], s60 offen offset:768 lds
  s_waitcnt lgkmcnt(2)
  v_mfma_f32_32x32x16_bf16 v[240:255], a[52:55], v[36:39], v[240:255]
  ds_read_b128 v[32:35], v203 offset:4096
  s_waitcnt lgkmcnt(2)
  v_mfma_f32_32x32x16_bf16 v[240:255], a[56:59], v[40:43], v[240:255]
  ds_read_b128 v[36:39], v204 offset:4096
  s_add_u32 m0, s67, 43136
  s_nop 0
  buffer_load_dwordx4 v202, s[4:7], s60 offen offset:896 lds
  s_waitcnt lgkmcnt(2)
  v_mfma_f32_32x32x16_bf16 v[240:255], a[60:63], v[44:47], v[240:255]
  ds_read_b128 v[40:43], v205 offset:4096
  s_waitcnt lgkmcnt(2)
  v_mfma_f32_32x32x16_bf16 v[240:255], a[64:67], v[32:35], v[240:255]
  ds_read_b128 v[44:47], v206 offset:4096
  s_add_u32 m0, s67, 44032
  s_nop 0
  buffer_load_dwordx4 v202, s[4:7], s60 offen offset:1024 lds
  s_waitcnt lgkmcnt(2)
  v_mfma_f32_32x32x16_bf16 v[240:255], a[68:71], v[36:39], v[240:255]
  ds_read_b128 v[32:35], v203 offset:5120
  s_waitcnt lgkmcnt(2)
  v_mfma_f32_32x32x16_bf16 v[240:255], a[72:75], v[40:43], v[240:255]
  ds_read_b128 v[36:39], v204 offset:5120
  buffer_store_dwordx4 v[176:179], v201, s[8:11], s72 offen offset:0 sc1
  s_waitcnt lgkmcnt(2)
  v_mfma_f32_32x32x16_bf16 v[240:255], a[76:79], v[44:47], v[240:255]
  ds_read_b128 v[40:43], v205 offset:5120
  s_waitcnt lgkmcnt(2)
  v_mfma_f32_32x32x16_bf16 v[240:255], a[80:83], v[32:35], v[240:255]
  ds_read_b128 v[44:47], v206 offset:5120
  buffer_store_dwordx4 v[176:179], v201, s[8:11], s72 offen offset:1024 sc1
  s_waitcnt lgkmcnt(2)
  v_mfma_f32_32x32x16_bf16 v[240:255], a[84:87], v[36:39], v[240:255]
  ds_read_b128 v[32:35], v203 offset:6144
  s_waitcnt lgkmcnt(2)
  v_mfma_f32_32x32x16_bf16 v[240:255], a[88:91], v[40:43], v[240:255]
  ds_read_b128 v[36:39], v204 offset:6144
  s_waitcnt lgkmcnt(2)
  v_mfma_f32_32x32x16_bf16 v[240:255], a[92:95], v[44:47], v[240:255]
  ds_read_b128 v[40:43], v205 offset:6144
  s_waitcnt lgkmcnt(2)
  v_mfma_f32_32x32x16_bf16 v[240:255], a[96:99], v[32:35], v[240:255]
  ds_read_b128 v[44:47], v206 offset:6144
  s_waitcnt lgkmcnt(2)
  v_mfma_f32_32x32x16_bf16 v[240:255], a[100:103], v[36:39], v[240:255]
  ds_read_b128 v[32:35], v203 offset:7168
  s_waitcnt lgkmcnt(2)
  v_mfma_f32_32x32x16_bf16 v[240:255], a[104:107], v[40:43], v[240:255]
  ds_read_b128 v[36:39], v204 offset:7168
  s_waitcnt lgkmcnt(2)
  v_mfma_f32_32x32x16_bf16 v[240:255], a[108:111], v[44:47], v[240:255]
  ds_read_b128 v[40:43], v205 offset:7168
  s_waitcnt lgkmcnt(2)
  v_mfma_f32_32x32x16_bf16 v[240:255], a[112:115], v[32:35], v[240:255]
  ds_read_b128 v[44:47], v206 offset:7168
  s_waitcnt lgkmcnt(2)
  v_mfma_f32_32x32x16_bf16 v[240:255], a[116:119], v[36:39], v[240:255]
  ds_read_b128 v[32:35], v203 offset:8192
  s_waitcnt lgkmcnt(2)
  v_mfma_f32_32x32x16_bf16 v[240:255], a[120:123], v[40:43], v[240:255]
  ds_read_b128 v[36:39], v204 offset:8192
  s_waitcnt lgkmcnt(2)
  v_mfma_f32_32x32x16_bf16 v[240:255], a[124:127], v[44:47], v[240:255]
  ds_read_b128 v[40:43], v205 offset:8192
  s_waitcnt lgkmcnt(2)
  v_mfma_f32_32x32x16_bf16 v[240:255], a[128:131], v[32:35], v[240:255]
  ds_read_b128 v[44:47], v206 offset:8192
  s_waitcnt lgkmcnt(2)
  v_mfma_f32_32x32x16_bf16 v[240:255], a[132:135], v[36:39], v[240:255]
  s_waitcnt lgkmcnt(1)
  v_mfma_f32_32x32x16_bf16 v[240:255], a[136:139], v[40:43], v[240:255]
  s_waitcnt lgkmcnt(0)
  v_mfma_f32_32x32x16_bf16 v[240:255], a[140:143], v[44:47], v[240:255]
  s_nop 11
  v_cvt_pk_bf16_f32 v16, v240, v244
  v_cvt_pk_bf16_f32 v17, v241, v245
  v_cvt_pk_bf16_f32 v18, v242, v246
  v_cvt_pk_bf16_f32 v19, v243, v247
  ds_write_b128 v215, v[16:19] offset:0
  v_cvt_pk_bf16_f32 v20, v248, v252
  v_cvt_pk_bf16_f32 v21, v249, v253
  v_cvt_pk_bf16_f32 v22, v250, v254
  v_cvt_pk_bf16_f32 v23, v251, v255
  ds_write_b128 v215, v[20:23] offset:1024
  s_waitcnt lgkmcnt(0)
  s_barrier
  ds_read_b128 v[96:99], v208 offset:0
  ds_read_b128 v[100:103], v208 offset:1024
  ds_read_b128 v[104:107], v208 offset:2048
  ds_read_b128 v[108:111], v208 offset:3072
  ds_read_b128 v[112:115], v208 offset:4096
  ds_read_b128 v[116:119], v208 offset:5120
  ds_read_b128 v[120:123], v208 offset:6144
  ds_read_b128 v[124:127], v208 offset:7168
  s_waitcnt vmcnt(20) lgkmcnt(7)
  v_mfma_f32_32x32x16_bf16 v[64:79], v[128:131], v[96:99], v[48:63]
  s_waitcnt vmcnt(19) lgkmcnt(6)
  v_mfma_f32_32x32x16_bf16 v[64:79], v[132:135], v[100:103], v[64:79]
  s_waitcnt vmcnt(18) lgkmcnt(5)
  v_mfma_f32_32x32x16_bf16 v[64:79], v[136:139], v[104:107], v[64:79]
  s_waitcnt vmcnt(17) lgkmcnt(4)
  v_mfma_f32_32x32x16_bf16 v[64:79], v[140:143], v[108:111], v[64:79]
  s_waitcnt vmcnt(16) lgkmcnt(3)
  v_mfma_f32_32x32x16_bf16 v[64:79], v[144:147], v[112:115], v[64:79]
  s_waitcnt vmcnt(15) lgkmcnt(2)
  v_mfma_f32_32x32x16_bf16 v[64:79], v[148:151], v[116:119], v[64:79]
  s_waitcnt vmcnt(14) lgkmcnt(1)
  v_mfma_f32_32x32x16_bf16 v[64:79], v[152:155], v[120:123], v[64:79]
  s_waitcnt vmcnt(13) lgkmcnt(0)
  v_mfma_f32_32x32x16_bf16 v[64:79], v[156:159], v[124:127], v[64:79]
  s_nop 11
  v_max3_f32 v180, v64, v65, v66
  v_max3_f32 v180, v180, v67, v68
  v_max3_f32 v180, v180, v69, v70
  v_max3_f32 v180, v180, v71, v72
  v_max3_f32 v180, v180, v73, v74
  v_max3_f32 v180, v180, v75, v76
  v_max3_f32 v180, v180, v77, v78
  v_max_f32 v180, v180, v79
  v_mov_b32 v181, v180
  s_nop 1
  v_permlane32_swap_b32 v180, v181
  v_max_f32 v180, v180, v181
  v_sub_f32 v64, v64, v180
  v_sub_f32 v65, v65, v180
  v_sub_f32 v66, v66, v180
  v_sub_f32 v67, v67, v180
  v_sub_f32 v68, v68, v180
  v_sub_f32 v69, v69, v180
  v_sub_f32 v70, v70, v180
  v_sub_f32 v71, v71, v180
  v_sub_f32 v72, v72, v180
  v_sub_f32 v73, v73, v180
  v_sub_f32 v74, v74, v180
  v_sub_f32 v75, v75, v180
  v_sub_f32 v76, v76, v180
  v_sub_f32 v77, v77, v180
  v_sub_f32 v78, v78, v180
  v_sub_f32 v79, v79, v180
  v_exp_f32 v64, v64
  v_exp_f32 v65, v65
  v_exp_f32 v66, v66
  v_exp_f32 v67, v67
  v_exp_f32 v68, v68
  v_exp_f32 v69, v69
  v_exp_f32 v70, v70
  v_exp_f32 v71, v71
  v_exp_f32 v72, v72
  v_exp_f32 v73, v73
  v_exp_f32 v74, v74
  v_exp_f32 v75, v75
  v_exp_f32 v76, v76
  v_exp_f32 v77, v77
  v_exp_f32 v78, v78
  v_exp_f32 v79, v79
  v_cvt_pk_bf16_f32 v20, v64, v65
  v_cvt_pk_bf16_f32 v21, v68, v69
  v_cvt_pk_bf16_f32 v22, v72, v73
  v_cvt_pk_bf16_f32 v23, v76, v77
  v_cvt_pk_bf16_f32 v24, v66, v67
  v_cvt_pk_bf16_f32 v25, v70, v71
  v_cvt_pk_bf16_f32 v26, v74, v75
  v_cvt_pk_bf16_f32 v27, v78, v79
  s_waitcnt vmcnt(12)
  v_mfma_f32_32x32x16_bf16 v[0:15], v[160:163], v[20:23], 0
  v_add_f32 v182, v64, v65
  v_add_f32 v182, v182, v66
  v_add_f32 v182, v182, v67
  v_add_f32 v182, v182, v68
  v_add_f32 v182, v182, v69
  v_add_f32 v182, v182, v70
  v_add_f32 v182, v182, v71
  s_waitcnt vmcnt(11)
  v_mfma_f32_32x32x16_bf16 v[0:15], v[164:167], v[24:27], v[0:15]
  v_add_f32 v182, v182, v72
  v_add_f32 v182, v182, v73
  v_add_f32 v182, v182, v74
  v_add_f32 v182, v182, v75
  v_add_f32 v182, v182, v76
  v_add_f32 v182, v182, v77
  v_add_f32 v182, v182, v78
  v_add_f32 v182, v182, v79
  s_waitcnt vmcnt(0)
  s_barrier
AT_loop:
  s_cmp_ge_u32 s59, 64
  s_cbranch_scc1 AT_l0
  s_mov_b32 s77, s59
  s_mul_i32 s66, s59, 655360
  s_lshl_b32 s55, s58, 14
  s_add_u32 s55, s55, s66
  s_add_u32 s55, s55, 1048576
  s_lshl_b32 s76, s58, 2
  s_add_u32 s76, s76, s52
  s_lshl_b32 s75, s59, 7
  s_add_u32 s75, s75, s76
  s_lshl_b32 s75, s75, 11
  s_add_u32 s75, s75, 46137344
  s_lshl_b32 s76, s76, 10
  s_add_u32 s76, s76, s66
  s_add_u32 s76, s76, 1572864
  s_add_u32 s59, s59, 2
  buffer_load_dwordx4 v[128:131], v216, s[8:11], s55 offen offset:0 sc1
  buffer_load_dwordx4 v[132:135], v216, s[8:11], s55 offen offset:256 sc1
  buffer_load_dwordx4 v[136:139], v216, s[8:11], s55 offen offset:512 sc1
  buffer_load_dwordx4 v[140:143], v216, s[8:11], s55 offen offset:768 sc1
  buffer_load_dwordx4 v[144:147], v216, s[8:11], s55 offen offset:1024 sc1
  buffer_load_dwordx4 v[148:151], v216, s[8:11], s55 offen offset:1280 sc1
  buffer_load_dwordx4 v[152:155], v216, s[8:11], s55 offen offset:1536 sc1
  buffer_load_dwordx4 v[156:159], v216, s[8:11], s55 offen offset:1792 sc1
  buffer_load_dwordx4 v[160:163], v217, s[8:11], s55 offen offset:0 sc1
  buffer_load_dwordx4 v[164:167], v217, s[8:11], s55 offen offset:256 sc1
  s_or_b32 s70, s73, 0xc00
  buffer_load_dword v172, off, s[8:11], s70 sc1
  s_add_u32 s60, s60, 73728
  ds_read_b128 v[32:35], v203 offset:36864
  ds_read_b128 v[36:39], v204 offset:36864
  ds_read_b128 v[40:43], v205 offset:36864
  s_waitcnt lgkmcnt(2)
  v_mfma_f32_32x32x16_bf16 v[240:255], a[0:3], v[32:35], 0
  ds_read_b128 v[44:47], v206 offset:36864
  s_add_u32 m0, s67, 0
  s_nop 0
  buffer_load_dwordx4 v202, s[4:7], s60 offen offset:0 lds
  s_waitcnt lgkmcnt(2)
  v_mfma_f32_32x32x16_bf16 v[240:255], a[4:7], v[36:39], v[240:255]
  ds_read_b128 v[32:35], v203 offset:37888
  s_waitcnt lgkmcnt(2)
  v_mfma_f32_32x32x16_bf16 v[240:255], a[8:11], v[40:43], v[240:255]
  ds_read_b128 v[36:39], v204 offset:37888
  s_add_u32 m0, s67, 896
  s_nop 0
  buffer_load_dwordx4 v202, s[4:7], s60 offen offset:128 lds
  s_waitcnt lgkmcnt(2)
  v_mfma_f32_32x32x16_bf16 v[240:255], a[12:15], v[44:47], v[240:255]
  ds_read_b128 v[40:43], v205 offset:37888
  s_waitcnt lgkmcnt(2)
  v_mfma_f32_32x32x16_bf16 v[240:255], a[16:19], v[32:35], v[240:255]
  ds_read_b128 v[44:47], v206 offset:37888
  s_add_u32 m0, s67, 1792
  s_nop 0
  buffer_load_dwordx4 v202, s[4:7], s60 offen offset:256 lds
  s_waitcnt lgkmcnt(2)
  v_mfma_f32_32x32x16_bf16 v[240:255], a[20:23], v[36:39], v[240:255]
  ds_read_b128 v[32:35], v203 offset:38912
  s_waitcnt lgkmcnt(2)
  v_mfma_f32_32x32x16_bf16 v[240:255], a[24:27], v[40:43], v[240:255]
  ds_read_b128 v[36:39], v204 offset:38912
  s_add_u32 m0, s67, 2688
  s_nop 0
  buffer_load_dwordx4 v202, s[4:7], s60 offen offset:384 lds
  s_waitcnt lgkmcnt(2)
  v_mfma_f32_32x32x16_bf16 v[240:255], a[28:31], v[44:47], v[240:255]
  ds_read_b128 v[40:43], v205 offset:38912
  s_waitcnt lgkmcnt(2)
  v_mfma_f32_32x32x16_bf16 v[240:255], a[32:35], v[32:35], v[240:255]
  ds_read_b128 v[44:47], v206 offset:38912
  s_add_u32 m0, s67, 3584
  s_nop 0
  buffer_load_dwordx4 v202, s[4:7], s60 offen offset:512 lds
  s_waitcnt lgkmcnt(2)
  v_mfma_f32_32x32x16_bf16 v[240:255], a[36:39], v[36:39], v[240:255]
  ds_read_b128 v[32:35], v203 offset:39936
  s_waitcnt lgkmcnt(2)
  v_mfma_f32_32x32x16_bf16 v[240:255], a[40:43], v[40:43], v[240:255]
  ds_read_b128 v[36:39], v204 offset:39936
  s_add_u32 m0, s67, 4480
  s_nop 0
  buffer_load_dwordx4 v202, s[4:7], s60 offen offset:640 lds
  s_waitcnt lgkmcnt(2)
  v_mfma_f32_32x32x16_bf16 v[240:255], a[44:47], v[44:47], v[240:255]
  ds_read_b128 v[40:43], v205 offset:39936
  s_waitcnt lgkmcnt(2)
  v_mfma_f32_32x32x16_bf16 v[240:255], a[48:51], v[32:35], v[240:255]
  ds_read_b128 v[44:47], v206 offset:39936
  s_add_u32 m0, s67, 5376
  s_nop 0
  buffer_load_dwordx4 v202, s[4:7], s60 offen offset:768 lds
  s_waitcnt lgkmcnt(2)
  v_mfma_f32_32x32x16_bf16 v[240:255], a[52:55], v[36:39], v[240:255]
  ds_read_b128 v[32:35], v203 offset:40960
  s_waitcnt lgkmcnt(2)
  v_mfma_f32_32x32x16_bf16 v[240:255], a[56:59], v[40:43], v[240:255]
  ds_read_b128 v[36:39], v204 offset:40960
  s_add_u32 m0, s67, 6272
  s_nop 0
  buffer_load_dwordx4 v202, s[4:7], s60 offen offset:896 lds
  s_waitcnt lgkmcnt(2)
  v_mfma_f32_32x32x16_bf16 v[240:255], a[60:63], v[44:47], v[240:255]
  ds_read_b128 v[40:43], v205 offset:40960
  s_waitcnt lgkmcnt(2)
  v_mfma_f32_32x32x16_bf16 v[240:255], a[64:67], v[32:35], v[240:255]
  ds_read_b128 v[44:47], v206 offset:40960
  s_add_u32 m0, s67, 7168
  s_nop 0
  buffer_load_dwordx4 v202, s[4:7], s60 offen offset:1024 lds
  s_waitcnt lgkmcnt(2)
  v_mfma_f32_32x32x16_bf16 v[240:255], a[68:71], v[36:39], v[240:255]
  ds_read_b128 v[32:35], v203 offset:41984
  s_waitcnt lgkmcnt(2)
  v_mfma_f32_32x32x16_bf16 v[240:255], a[72:75], v[40:43], v[240:255]
  ds_read_b128 v[36:39], v204 offset:41984
  buffer_store_dwordx4 v[176:179], v201, s[8:11], s75 offen offset:0 sc1
  s_waitcnt lgkmcnt(2)
  v_mfma_f32_32x32x16_bf16 v[240:255], a[76:79], v[44:47], v[240:255]
  ds_read_b128 v[40:43], v205 offset:41984
  s_waitcnt lgkmcnt(2)
  v_mfma_f32_32x32x16_bf16 v[240:255], a[80:83], v[32:35], v[240:255]
  ds_read_b128 v[44:47], v206 offset:41984
  buffer_store_dwordx4 v[176:179], v201, s[8:11], s75 offen offset:1024 sc1
  s_waitcnt lgkmcnt(2)
  v_mfma_f32_32x32x16_bf16 v[240:255], a[84:87], v[36:39], v[240:255]
  ds_read_b128 v[32:35], v203 offset:43008
  s_waitcnt lgkmcnt(2)
  v_mfma_f32_32x32x16_bf16 v[240:255], a[88:91], v[40:43], v[240:255]
  ds_read_b128 v[36:39], v204 offset:43008
  s_waitcnt lgkmcnt(2)
  v_mfma_f32_32x32x16_bf16 v[240:255], a[92:95], v[44:47], v[240:255]
  ds_read_b128 v[40:43], v205 offset:43008
  s_waitcnt lgkmcnt(2)
  v_mfma_f32_32x32x16_bf16 v[240:255], a[96:99], v[32:35], v[240:255]
  ds_read_b128 v[44:47], v206 offset:43008
  s_waitcnt lgkmcnt(2)
  v_mfma_f32_32x32x16_bf16 v[240:255], a[100:103], v[36:39], v[240:255]
  ds_read_b128 v[32:35], v203 offset:44032
  s_waitcnt lgkmcnt(2)
  v_mfma_f32_32x32x16_bf16 v[240:255], a[104:107], v[40:43], v[240:255]
  ds_read_b128 v[36:39], v204 offset:44032
  s_waitcnt lgkmcnt(2)
  v_mfma_f32_32x32x16_bf16 v[240:255], a[108:111], v[44:47], v[240:255]
  ds_read_b128 v[40:43], v205 offset:44032
  s_waitcnt lgkmcnt(2)
  v_mfma_f32_32x32x16_bf16 v[240:255], a[112:115], v[32:35], v[240:255]
  ds_read_b128 v[44:47], v206 offset:44032
  s_waitcnt lgkmcnt(2)
  v_mfma_f32_32x32x16_bf16 v[240:255], a[116:119], v[36:39], v[240:255]
  ds_read_b128 v[32:35], v203 offset:45056
  s_waitcnt lgkmcnt(2)
  v_mfma_f32_32x32x16_bf16 v[240:255], a[120:123], v[40:43], v[240:255]
  ds_read_b128 v[36:39], v204 offset:45056
  s_waitcnt lgkmcnt(2)
  v_mfma_f32_32x32x16_bf16 v[240:255], a[124:127], v[44:47], v[240:255]
  ds_read_b128 v[40:43], v205 offset:45056
  s_waitcnt lgkmcnt(2)
  v_mfma_f32_32x32x16_bf16 v[240:255], a[128:131], v[32:35], v[240:255]
  ds_read_b128 v[44:47], v206 offset:45056
  s_waitcnt lgkmcnt(2)
  v_mfma_f32_32x32x16_bf16 v[240:255], a[132:135], v[36:39], v[240:255]
  s_waitcnt lgkmcnt(1)
  v_mfma_f32_32x32x16_bf16 v[240:255], a[136:139], v[40:43], v[240:255]
  s_waitcnt lgkmcnt(0)
  v_mfma_f32_32x32x16_bf16 v[240:255], a[140:143], v[44:47], v[240:255]
  s_nop 11
  v_cvt_pk_bf16_f32 v16, v240, v244
  v_cvt_pk_bf16_f32 v17, v241, v245
  v_cvt_pk_bf16_f32 v18, v242, v246
  v_cvt_pk_bf16_f32 v19, v243, v247
  ds_write_b128 v215, v[16:19] offset:0
  v_cvt_pk_bf16_f32 v20, v248, v252
  v_cvt_pk_bf16_f32 v21, v249, v253
  v_cvt_pk_bf16_f32 v22, v250, v254
  v_cvt_pk_bf16_f32 v23, v251, v255
  ds_write_b128 v215, v[20:23] offset:1024
  s_waitcnt lgkmcnt(0)
  s_barrier
  ds_read_b128 a[144:147], v208 offset:0
  ds_read_b128 a[148:151], v208 offset:1024
  ds_read_b128 a[152:155], v208 offset:2048
  ds_read_b128 a[156:159], v208 offset:3072
  ds_read_b128 a[160:163], v208 offset:4096
  ds_read_b128 a[164:167], v208 offset:5120
  ds_read_b128 a[168:171], v208 offset:6144
  ds_read_b128 a[172:175], v208 offset:7168
  s_waitcnt vmcnt(11)
  v_cmp_eq_u32 vcc, -1, v172
  s_mov_b32 s69, 0
  s_cbranch_vccnz AT_e1
  s_mov_b32 s69, 1
  buffer_load_dwordx4 v[172:175], v201, s[8:11], s73 offen sc1
AT_e1:
  s_waitcnt lgkmcnt(7)
  v_mfma_f32_32x32x16_bf16 v[64:79], v[128:131], a[144:147], v[48:63]
  s_waitcnt lgkmcnt(6)
  v_mfma_f32_32x32x16_bf16 v[64:79], v[132:135], a[148:151], v[64:79]
  s_waitcnt lgkmcnt(5)
  v_mfma_f32_32x32x16_bf16 v[64:79], v[136:139], a[152:155], v[64:79]
  s_waitcnt lgkmcnt(4)
  v_mfma_f32_32x32x16_bf16 v[64:79], v[140:143], a[156:159], v[64:79]
  s_waitcnt lgkmcnt(3)
  v_mfma_f32_32x32x16_bf16 v[64:79], v[144:147], a[160:163], v[64:79]
  s_waitcnt lgkmcnt(2)
  v_mfma_f32_32x32x16_bf16 v[64:79], v[148:151], a[164:167], v[64:79]
  s_waitcnt lgkmcnt(1)
  v_mfma_f32_32x32x16_bf16 v[64:79], v[152:155], a[168:171], v[64:79]
  s_waitcnt lgkmcnt(0)
  v_mfma_f32_32x32x16_bf16 v[64:79], v[156:159], a[172:175], v[64:79]
  s_nop 11
  v_max3_f32 v184, v64, v65, v66
  v_max3_f32 v184, v184, v67, v68
  v_max3_f32 v184, v184, v69, v70
  v_max3_f32 v184, v184, v71, v72
  v_max3_f32 v184, v184, v73, v74
  v_max3_f32 v184, v184, v75, v76
  v_max3_f32 v184, v184, v77, v78
  v_max_f32 v184, v184, v79
  v_mov_b32 v185, v184
  s_nop 1
  v_permlane32_swap_b32 v184, v185
  v_max_f32 v184, v184, v185
  v_sub_f32 v64, v64, v184
  v_sub_f32 v65, v65, v184
  v_sub_f32 v66, v66, v184
  v_sub_f32 v67, v67, v184
  v_sub_f32 v68, v68, v184
  v_sub_f32 v69, v69, v184
  v_sub_f32 v70, v70, v184
  v_sub_f32 v71, v71, v184
  v_sub_f32 v72, v72, v184
  v_sub_f32 v73, v73, v184
  v_sub_f32 v74, v74, v184
  v_sub_f32 v75, v75, v184
  v_sub_f32 v76, v76, v184
  v_sub_f32 v77, v77, v184
  v_sub_f32 v78, v78, v184
  v_sub_f32 v79, v79, v184
  v_exp_f32 v64, v64
  v_exp_f32 v65, v65
  v_exp_f32 v66, v66
  v_exp_f32 v67, v67
  v_exp_f32 v68, v68
  v_exp_f32 v69, v69
  v_exp_f32 v70, v70
  v_exp_f32 v71, v71
  v_exp_f32 v72, v72
  v_exp_f32 v73, v73
  v_exp_f32 v74, v74
  v_exp_f32 v75, v75
  v_exp_f32 v76, v76
  v_exp_f32 v77, v77
  v_exp_f32 v78, v78
  v_exp_f32 v79, v79
  v_cvt_pk_bf16_f32 v20, v64, v65
  v_cvt_pk_bf16_f32 v21, v68, v69
  v_cvt_pk_bf16_f32 v22, v72, v73
  v_cvt_pk_bf16_f32 v23, v76, v77
  v_cvt_pk_bf16_f32 v24, v66, v67
  v_cvt_pk_bf16_f32 v25, v70, v71
  v_cvt_pk_bf16_f32 v26, v74, v75
  v_cvt_pk_bf16_f32 v27, v78, v79
  v_mfma_f32_32x32x16_bf16 v[224:239], v[160:163], v[20:23], 0
  v_add_f32 v186, v64, v65
  v_add_f32 v186, v186, v66
  v_add_f32 v186, v186, v67
  v_add_f32 v186, v186, v68
  v_add_f32 v186, v186, v69
  v_add_f32 v186, v186, v70
  v_add_f32 v186, v186, v71
  v_mfma_f32_32x32x16_bf16 v[224:239], v[164:167], v[24:27], v[224:239]
  v_add_f32 v186, v186, v72
  v_add_f32 v186, v186, v73
  v_add_f32 v186, v186, v74
  v_add_f32 v186, v186, v75
  v_add_f32 v186, v186, v76
  v_add_f32 v186, v186, v77
  v_add_f32 v186, v186, v78
  v_add_f32 v186, v186, v79
AT_l0:
  s_cmp_eq_u32 s69, 1
  s_cbranch_scc1 AT_v0
  s_cmp_ge_u32 s74, 62
  s_cbranch_scc1 AT_k0
  s_branch AT_c0
AT_h0:
  s_sleep 2
AT_c0:
  buffer_load_dword v172, off, s[8:11], s70 sc1
  s_add_u32 s65, s65, 1
  s_cmp_lt_u32 s65, 131072
  s_cselect_b32 s54, -2, -1
  s_waitcnt vmcnt(0)
  v_cmp_lt_u32 vcc, s54, v172
  s_cbranch_vccnz AT_h0
AT_k0:
  buffer_load_dwordx4 v[172:175], v201, s[8:11], s73 offen sc1
AT_v0:
  s_mov_b32 s69, 0
  s_add_u32 s65, s65, 1
  s_cmp_lt_u32 s65, 131072
  s_cselect_b32 s54, -2, -1
  s_waitcnt vmcnt(0)
  ds_write_b64 v220, v[172:173] offset:0
  ds_write_b64 v221, v[174:175] offset:0
  v_max3_u32 v213, v172, v173, v174
  v_max_u32 v213, v213, v175
  v_cmp_lt_u32 vcc, s54, v213
  s_cbranch_vccnz AT_k0
  s_waitcnt lgkmcnt(0)
  s_barrier
  ds_read_b128 v[128:131], v218 offset:0
  ds_read_b128 v[132:135], v218 offset:256
  ds_read_b128 v[136:139], v218 offset:512
  ds_read_b128 v[140:143], v218 offset:768
  ds_read_b128 v[144:147], v218 offset:1024
  ds_read_b128 v[148:151], v218 offset:1280
  ds_read_b128 v[152:155], v218 offset:1536
  ds_read_b128 v[156:159], v218 offset:1792
  ds_read_b32 v168, v219 offset:0
  ds_read_b32 v169, v219 offset:128
  s_waitcnt lgkmcnt(9)
  v_mfma_f32_32x32x16_bf16 v[80:95], v[128:131], v[96:99], 0
  s_waitcnt lgkmcnt(8)
  v_mfma_f32_32x32x16_bf16 v[80:95], v[132:135], v[100:103], v[80:95]
  s_waitcnt lgkmcnt(7)
  v_mfma_f32_32x32x16_bf16 v[80:95], v[136:139], v[104:107], v[80:95]
  s_waitcnt lgkmcnt(6)
  v_mfma_f32_32x32x16_bf16 v[80:95], v[140:143], v[108:111], v[80:95]
  s_waitcnt lgkmcnt(5)
  v_mfma_f32_32x32x16_bf16 v[80:95], v[144:147], v[112:115], v[80:95]
  s_waitcnt lgkmcnt(4)
  v_mfma_f32_32x32x16_bf16 v[80:95], v[148:151], v[116:119], v[80:95]
  s_waitcnt lgkmcnt(3)
  v_mfma_f32_32x32x16_bf16 v[80:95], v[152:155], v[120:123], v[80:95]
  s_waitcnt lgkmcnt(2)
  v_mfma_f32_32x32x16_bf16 v[80:95], v[156:159], v[124:127], v[80:95]
  s_add_u32 s74, s74, 2
  v_mov_b32 v212, s74
  s_nop 9
  v_mul_f32 v80, s68, v80
  v_mul_f32 v81, s68, v81
  v_mul_f32 v82, s68, v82
  v_mul_f32 v83, s68, v83
  v_max3_f32 v84, v180, v80, v81
  v_max3_f32 v84, v84, v82, v83
  v_mov_b32 v85, v84
  s_nop 1
  v_permlane32_swap_b32 v84, v85
  v_max_f32 v84, v84, v85
  v_sub_f32 v86, v180, v84
  v_sub_f32 v80, v80, v84
  v_sub_f32 v81, v81, v84
  v_sub_f32 v82, v82, v84
  v_sub_f32 v83, v83, v84
  v_exp_f32 v86, v86
  v_exp_f32 v80, v80
  v_exp_f32 v81, v81
  v_exp_f32 v82, v82
  v_exp_f32 v83, v83
  v_fma_f32 v182, v182, v86, v80
  v_add_f32 v84, v81, v82
  v_add_f32 v182, v182, v83
  v_add_f32 v182, v182, v84
  v_mov_b32 v183, v182
  s_nop 1
  v_permlane32_swap_b32 v182, v183
  v_add_f32 v182, v182, v183
  v_rcp_f32 v182, v182
  s_nop 0
  v_mul_f32 v86, v86, v182
  v_mul_f32 v80, v182, v80
  v_mul_f32 v81, v182, v81
  v_mul_f32 v82, v182, v82
  v_mul_f32 v83, v182, v83
  v_cvt_pk_bf16_f32 v28, v80, v81
  v_cvt_pk_bf16_f32 v29, v82, v83
  v_mul_f32 v0, v86, v0
  v_mul_f32 v1, v86, v1
  v_mul_f32 v2, v86, v2
  v_mul_f32 v3, v86, v3
  v_mul_f32 v4, v86, v4
  v_mul_f32 v5, v86, v5
  v_mul_f32 v6, v86, v6
  v_mul_f32 v7, v86, v7
  v_mul_f32 v8, v86, v8
  v_mul_f32 v9, v86, v9
  v_mul_f32 v10, v86, v10
  v_mul_f32 v11, v86, v11
  v_mul_f32 v12, v86, v12
  v_mul_f32 v13, v86, v13
  v_mul_f32 v14, v86, v14
  v_mul_f32 v15, v86, v15
  s_waitcnt lgkmcnt(0)
  s_nop 0
  v_mfma_f32_32x32x8_bf16 v[0:15], v[168:169], v[28:29], v[0:15]
  s_nop 11
  v_cvt_pk_bf16_f32 v20, v0, v1
  v_cvt_pk_bf16_f32 v21, v2, v3
  v_cvt_pk_bf16_f32 v22, v4, v5
  v_cvt_pk_bf16_f32 v23, v6, v7
  buffer_store_dwordx4 v[20:23], v201, s[8:11], s72 offen offset:0 sc1
  v_cvt_pk_bf16_f32 v24, v8, v9
  v_cvt_pk_bf16_f32 v25, v10, v11
  v_cvt_pk_bf16_f32 v26, v12, v13
  v_cvt_pk_bf16_f32 v27, v14, v15
  buffer_store_dwordx4 v[24:27], v201, s[8:11], s72 offen offset:1024 sc1
  s_mov_b64 exec, 1
  buffer_store_dword v212, v201, s[8:11], s71 offen sc1
  s_mov_b64 exec, -1
  s_cmp_ge_u32 s74, 64
  s_cbranch_scc1 L_exit
  s_cmp_ge_u32 s59, 64
  s_cbranch_scc1 AT_l1
  s_mov_b32 s74, s59
  s_mul_i32 s66, s59, 655360
  s_lshl_b32 s55, s58, 14
  s_add_u32 s55, s55, s66
  s_add_u32 s55, s55, 1048576
  s_lshl_b32 s73, s58, 2
  s_add_u32 s73, s73, s52
  s_lshl_b32 s72, s59, 7
  s_add_u32 s72, s72, s73
  s_lshl_b32 s72, s72, 11
  s_add_u32 s72, s72, 46137344
  s_lshl_b32 s73, s73, 10
  s_add_u32 s73, s73, s66
  s_add_u32 s73, s73, 1572864
  s_add_u32 s59, s59, 2
  buffer_load_dwordx4 v[128:131], v216, s[8:11], s55 offen offset:0 sc1
  buffer_load_dwordx4 v[132:135], v216, s[8:11], s55 offen offset:256 sc1
  buffer_load_dwordx4 v[136:139], v216, s[8:11], s55 offen offset:512 sc1
  buffer_load_dwordx4 v[140:143], v216, s[8:11], s55 offen offset:768 sc1
  buffer_load_dwordx4 v[144:147], v216, s[8:11], s55 offen offset:1024 sc1
  buffer_load_dwordx4 v[148:151], v216, s[8:11], s55 offen offset:1280 sc1
  buffer_load_dwordx4 v[152:155], v216, s[8:11], s55 offen offset:1536 sc1
  buffer_load_dwordx4 v[156:159], v216, s[8:11], s55 offen offset:1792 sc1
  buffer_load_dwordx4 v[160:163], v217, s[8:11], s55 offen offset:0 sc1
  buffer_load_dwordx4 v[164:167], v217, s[8:11], s55 offen offset:256 sc1
  s_or_b32 s70, s76, 0xc00
  buffer_load_dword v172, off, s[8:11], s70 sc1
  s_add_u32 s60, s60, 73728
  ds_read_b128 v[32:35], v203 offset:0
  ds_read_b128 v[36:39], v204 offset:0
  ds_read_b128 v[40:43], v205 offset:0
  s_waitcnt lgkmcnt(2)
  v_mfma_f32_32x32x16_bf16 v[240:255], a[0:3], v[32:35], 0
  ds_read_b128 v[44:47], v206 offset:0
  s_add_u32 m0, s67, 36864
  s_nop 0
  buffer_load_dwordx4 v202, s[4:7], s60 offen offset:0 lds
  s_waitcnt lgkmcnt(2)
  v_mfma_f32_32x32x16_bf16 v[240:255], a[4:7], v[36:39], v[240:255]
  ds_read_b128 v[32:35], v203 offset:1024
  s_waitcnt lgkmcnt(2)
  v_mfma_f32_32x32x16_bf16 v[240:255], a[8:11], v[40:43], v[240:255]
  ds_read_b128 v[36:39], v204 offset:1024
  s_add_u32 m0, s67, 37760
  s_nop 0
  buffer_load_dwordx4 v202, s[4:7], s60 offen offset:128 lds
  s_waitcnt lgkmcnt(2)
  v_mfma_f32_32x32x16_bf16 v[240:255], a[12:15], v[44:47], v[240:255]
  ds_read_b128 v[40:43], v205 offset:1024
  s_waitcnt lgkmcnt(2)
  v_mfma_f32_32x32x16_bf16 v[240:255], a[16:19], v[32:35], v[240:255]
  ds_read_b128 v[44:47], v206 offset:1024
  s_add_u32 m0, s67, 38656
  s_nop 0
  buffer_load_dwordx4 v202, s[4:7], s60 offen offset:256 lds
  s_waitcnt lgkmcnt(2)
  v_mfma_f32_32x32x16_bf16 v[240:255], a[20:23], v[36:39], v[240:255]
  ds_read_b128 v[32:35], v203 offset:2048
  s_waitcnt lgkmcnt(2)
  v_mfma_f32_32x32x16_bf16 v[240:255], a[24:27], v[40:43], v[240:255]
  ds_read_b128 v[36:39], v204 offset:2048
  s_add_u32 m0, s67, 39552
  s_nop 0
  buffer_load_dwordx4 v202, s[4:7], s60 offen offset:384 lds
  s_waitcnt lgkmcnt(2)
  v_mfma_f32_32x32x16_bf16 v[240:255], a[28:31], v[44:47], v[240:255]
  ds_read_b128 v[40:43], v205 offset:2048
  s_waitcnt lgkmcnt(2)
  v_mfma_f32_32x32x16_bf16 v[240:255], a[32:35], v[32:35], v[240:255]
  ds_read_b128 v[44:47], v206 offset:2048
  s_add_u32 m0, s67, 40448
  s_nop 0
  buffer_load_dwordx4 v202, s[4:7], s60 offen offset:512 lds
  s_waitcnt lgkmcnt(2)
  v_mfma_f32_32x32x16_bf16 v[240:255], a[36:39], v[36:39], v[240:255]
  ds_read_b128 v[32:35], v203 offset:3072
  s_waitcnt lgkmcnt(2)
  v_mfma_f32_32x32x16_bf16 v[240:255], a[40:43], v[40:43], v[240:255]
  ds_read_b128 v[36:39], v204 offset:3072
  s_add_u32 m0, s67, 41344
  s_nop 0
  buffer_load_dwordx4 v202, s[4:7], s60 offen offset:640 lds
  s_waitcnt lgkmcnt(2)
  v_mfma_f32_32x32x16_bf16 v[240:255], a[44:47], v[44:47], v[240:255]
  ds_read_b128 v[40:43], v205 offset:3072
  s_waitcnt lgkmcnt(2)
  v_mfma_f32_32x32x16_bf16 v[240:255], a[48:51], v[32:35], v[240:255]
  ds_read_b128 v[44:47], v206 offset:3072
  s_add_u32 m0, s67, 42240
  s_nop 0
  buffer_load_dwordx4 v202, s[4:7], s60 offen offset:768 lds
  s_waitcnt lgkmcnt(2)
  v_mfma_f32_32x32x16_bf16 v[240:255], a[52:55], v[36:39], v[240:255]
  ds_read_b128 v[32:35], v203 offset:4096
  s_waitcnt lgkmcnt(2)
  v_mfma_f32_32x32x16_bf16 v[240:255], a[56:59], v[40:43], v[240:255]
  ds_read_b128 v[36:39], v204 offset:4096
  s_add_u32 m0, s67, 43136
  s_nop 0
  buffer_load_dwordx4 v202, s[4:7], s60 offen offset:896 lds
  s_waitcnt lgkmcnt(2)
  v_mfma_f32_32x32x16_bf16 v[240:255], a[60:63], v[44:47], v[240:255]
  ds_read_b128 v[40:43], v205 offset:4096
  s_waitcnt lgkmcnt(2)
  v_mfma_f32_32x32x16_bf16 v[240:255], a[64:67], v[32:35], v[240:255]
  ds_read_b128 v[44:47], v206 offset:4096
  s_add_u32 m0, s67, 44032
  s_nop 0
  buffer_load_dwordx4 v202, s[4:7], s60 offen offset:1024 lds
  s_waitcnt lgkmcnt(2)
  v_mfma_f32_32x32x16_bf16 v[240:255], a[68:71], v[36:39], v[240:255]
  ds_read_b128 v[32:35], v203 offset:5120
  s_waitcnt lgkmcnt(2)
  v_mfma_f32_32x32x16_bf16 v[240:255], a[72:75], v[40:43], v[240:255]
  ds_read_b128 v[36:39], v204 offset:5120
  buffer_store_dwordx4 v[176:179], v201, s[8:11], s72 offen offset:0 sc1
  s_waitcnt lgkmcnt(2)
  v_mfma_f32_32x32x16_bf16 v[240:255], a[76:79], v[44:47], v[240:255]
  ds_read_b128 v[40:43], v205 offset:5120
  s_waitcnt lgkmcnt(2)
  v_mfma_f32_32x32x16_bf16 v[240:255], a[80:83], v[32:35], v[240:255]
  ds_read_b128 v[44:47], v206 offset:5120
  buffer_store_dwordx4 v[176:179], v201, s[8:11], s72 offen offset:1024 sc1
  s_waitcnt lgkmcnt(2)
  v_mfma_f32_32x32x16_bf16 v[240:255], a[84:87], v[36:39], v[240:255]
  ds_read_b128 v[32:35], v203 offset:6144
  s_waitcnt lgkmcnt(2)
  v_mfma_f32_32x32x16_bf16 v[240:255], a[88:91], v[40:43], v[240:255]
  ds_read_b128 v[36:39], v204 offset:6144
  s_waitcnt lgkmcnt(2)
  v_mfma_f32_32x32x16_bf16 v[240:255], a[92:95], v[44:47], v[240:255]
  ds_read_b128 v[40:43], v205 offset:6144
  s_waitcnt lgkmcnt(2)
  v_mfma_f32_32x32x16_bf16 v[240:255], a[96:99], v[32:35], v[240:255]
  ds_read_b128 v[44:47], v206 offset:6144
  s_waitcnt lgkmcnt(2)
  v_mfma_f32_32x32x16_bf16 v[240:255], a[100:103], v[36:39], v[240:255]
  ds_read_b128 v[32:35], v203 offset:7168
  s_waitcnt lgkmcnt(2)
  v_mfma_f32_32x32x16_bf16 v[240:255], a[104:107], v[40:43], v[240:255]
  ds_read_b128 v[36:39], v204 offset:7168
  s_waitcnt lgkmcnt(2)
  v_mfma_f32_32x32x16_bf16 v[240:255], a[108:111], v[44:47], v[240:255]
  ds_read_b128 v[40:43], v205 offset:7168
  s_waitcnt lgkmcnt(2)
  v_mfma_f32_32x32x16_bf16 v[240:255], a[112:115], v[32:35], v[240:255]
  ds_read_b128 v[44:47], v206 offset:7168
  s_waitcnt lgkmcnt(2)
  v_mfma_f32_32x32x16_bf16 v[240:255], a[116:119], v[36:39], v[240:255]
  ds_read_b128 v[32:35], v203 offset:8192
  s_waitcnt lgkmcnt(2)
  v_mfma_f32_32x32x16_bf16 v[240:255], a[120:123], v[40:43], v[240:255]
  ds_read_b128 v[36:39], v204 offset:8192
  s_waitcnt lgkmcnt(2)
  v_mfma_f32_32x32x16_bf16 v[240:255], a[124:127], v[44:47], v[240:255]
  ds_read_b128 v[40:43], v205 offset:8192
  s_waitcnt lgkmcnt(2)
  v_mfma_f32_32x32x16_bf16 v[240:255], a[128:131], v[32:35], v[240:255]
  ds_read_b128 v[44:47], v206 offset:8192
  s_waitcnt lgkmcnt(2)
  v_mfma_f32_32x32x16_bf16 v[240:255], a[132:135], v[36:39], v[240:255]
  s_waitcnt lgkmcnt(1)
  v_mfma_f32_32x32x16_bf16 v[240:255], a[136:139], v[40:43], v[240:255]
  s_waitcnt lgkmcnt(0)
  v_mfma_f32_32x32x16_bf16 v[240:255], a[140:143], v[44:47], v[240:255]
  s_nop 11
  v_cvt_pk_bf16_f32 v16, v240, v244
  v_cvt_pk_bf16_f32 v17, v241, v245
  v_cvt_pk_bf16_f32 v18, v242, v246
  v_cvt_pk_bf16_f32 v19, v243, v247
  ds_write_b128 v215, v[16:19] offset:0
  v_cvt_pk_bf16_f32 v20, v248, v252
  v_cvt_pk_bf16_f32 v21, v249, v253
  v_cvt_pk_bf16_f32 v22, v250, v254
  v_cvt_pk_bf16_f32 v23, v251, v255
  ds_write_b128 v215, v[20:23] offset:1024
  s_waitcnt lgkmcnt(0)
  s_barrier
  ds_read_b128 v[96:99], v208 offset:0
  ds_read_b128 v[100:103], v208 offset:1024
  ds_read_b128 v[104:107], v208 offset:2048
  ds_read_b128 v[108:111], v208 offset:3072
  ds_read_b128 v[112:115], v208 offset:4096
  ds_read_b128 v[116:119], v208 offset:5120
  ds_read_b128 v[120:123], v208 offset:6144
  ds_read_b128 v[124:127], v208 offset:7168
  s_waitcnt vmcnt(11)
  v_cmp_eq_u32 vcc, -1, v172
  s_mov_b32 s69, 0
  s_cbranch_vccnz AT_e0
  s_mov_b32 s69, 1
  buffer_load_dwordx4 v[172:175], v201, s[8:11], s76 offen sc1
AT_e0:
  s_waitcnt lgkmcnt(7)
  v_mfma_f32_32x32x16_bf16 v[64:79], v[128:131], v[96:99], v[48:63]
  s_waitcnt lgkmcnt(6)
  v_mfma_f32_32x32x16_bf16 v[64:79], v[132:135], v[100:103], v[64:79]
  s_waitcnt lgkmcnt(5)
  v_mfma_f32_32x32x16_bf16 v[64:79], v[136:139], v[104:107], v[64:79]
  s_waitcnt lgkmcnt(4)
  v_mfma_f32_32x32x16_bf16 v[64:79], v[140:143], v[108:111], v[64:79]
  s_waitcnt lgkmcnt(3)
  v_mfma_f32_32x32x16_bf16 v[64:79], v[144:147], v[112:115], v[64:79]
  s_waitcnt lgkmcnt(2)
  v_mfma_f32_32x32x16_bf16 v[64:79], v[148:151], v[116:119], v[64:79]
  s_waitcnt lgkmcnt(1)
  v_mfma_f32_32x32x16_bf16 v[64:79], v[152:155], v[120:123], v[64:79]
  s_waitcnt lgkmcnt(0)
  v_mfma_f32_32x32x16_bf16 v[64:79], v[156:159], v[124:127], v[64:79]
  s_nop 11
  v_max3_f32 v180, v64, v65, v66
  v_max3_f32 v180, v180, v67, v68
  v_max3_f32 v180, v180, v69, v70
  v_max3_f32 v180, v180, v71, v72
  v_max3_f32 v180, v180, v73, v74
  v_max3_f32 v180, v180, v75, v76
  v_max3_f32 v180, v180, v77, v78
  v_max_f32 v180, v180, v79
  v_mov_b32 v181, v180
  s_nop 1
  v_permlane32_swap_b32 v180, v181
  v_max_f32 v180, v180, v181
  v_sub_f32 v64, v64, v180
  v_sub_f32 v65, v65, v180
  v_sub_f32 v66, v66, v180
  v_sub_f32 v67, v67, v180
  v_sub_f32 v68, v68, v180
  v_sub_f32 v69, v69, v180
  v_sub_f32 v70, v70, v180
  v_sub_f32 v71, v71, v180
  v_sub_f32 v72, v72, v180
  v_sub_f32 v73, v73, v180
  v_sub_f32 v74, v74, v180
  v_sub_f32 v75, v75, v180
  v_sub_f32 v76, v76, v180
  v_sub_f32 v77, v77, v180
  v_sub_f32 v78, v78, v180
  v_sub_f32 v79, v79, v180
  v_exp_f32 v64, v64
  v_exp_f32 v65, v65
  v_exp_f32 v66, v66
  v_exp_f32 v67, v67
  v_exp_f32 v68, v68
  v_exp_f32 v69, v69
  v_exp_f32 v70, v70
  v_exp_f32 v71, v71
  v_exp_f32 v72, v72
  v_exp_f32 v73, v73
  v_exp_f32 v74, v74
  v_exp_f32 v75, v75
  v_exp_f32 v76, v76
  v_exp_f32 v77, v77
  v_exp_f32 v78, v78
  v_exp_f32 v79, v79
  v_cvt_pk_bf16_f32 v20, v64, v65
  v_cvt_pk_bf16_f32 v21, v68, v69
  v_cvt_pk_bf16_f32 v22, v72, v73
  v_cvt_pk_bf16_f32 v23, v76, v77
  v_cvt_pk_bf16_f32 v24, v66, v67
  v_cvt_pk_bf16_f32 v25, v70, v71
  v_cvt_pk_bf16_f32 v26, v74, v75
  v_cvt_pk_bf16_f32 v27, v78, v79
  v_mfma_f32_32x32x16_bf16 v[0:15], v[160:163], v[20:23], 0
  v_add_f32 v182, v64, v65
  v_add_f32 v182, v182, v66
  v_add_f32 v182, v182, v67
  v_add_f32 v182, v182, v68
  v_add_f32 v182, v182, v69
  v_add_f32 v182, v182, v70
  v_add_f32 v182, v182, v71
  v_mfma_f32_32x32x16_bf16 v[0:15], v[164:167], v[24:27], v[0:15]
  v_add_f32 v182, v182, v72
  v_add_f32 v182, v182, v73
  v_add_f32 v182, v182, v74
  v_add_f32 v182, v182, v75
  v_add_f32 v182, v182, v76
  v_add_f32 v182, v182, v77
  v_add_f32 v182, v182, v78
  v_add_f32 v182, v182, v79
AT_l1:
  s_cmp_eq_u32 s69, 1
  s_cbranch_scc1 AT_v1
  s_cmp_ge_u32 s77, 62
  s_cbranch_scc1 AT_k1
  s_branch AT_c1
AT_h1:
  s_sleep 2
AT_c1:
  buffer_load_dword v172, off, s[8:11], s70 sc1
  s_add_u32 s65, s65, 1
  s_cmp_lt_u32 s65, 131072
  s_cselect_b32 s54, -2, -1
  s_waitcnt vmcnt(0)
  v_cmp_lt_u32 vcc, s54, v172
  s_cbranch_vccnz AT_h1
AT_k1:
  buffer_load_dwordx4 v[172:175], v201, s[8:11], s76 offen sc1
AT_v1:
  s_mov_b32 s69, 0
  s_add_u32 s65, s65, 1
  s_cmp_lt_u32 s65, 131072
  s_cselect_b32 s54, -2, -1
  s_waitcnt vmcnt(0)
  ds_write_b64 v220, v[172:173] offset:4096
  ds_write_b64 v221, v[174:175] offset:4096
  v_max3_u32 v213, v172, v173, v174
  v_max_u32 v213, v213, v175
  v_cmp_lt_u32 vcc, s54, v213
  s_cbranch_vccnz AT_k1
  s_waitcnt lgkmcnt(0)
  s_barrier
  ds_read_b128 v[128:131], v218 offset:4096
  ds_read_b128 v[132:135], v218 offset:4352
  ds_read_b128 v[136:139], v218 offset:4608
  ds_read_b128 v[140:143], v218 offset:4864
  ds_read_b128 v[144:147], v218 offset:5120
  ds_read_b128 v[148:151], v218 offset:5376
  ds_read_b128 v[152:155], v218 offset:5632
  ds_read_b128 v[156:159], v218 offset:5888
  ds_read_b32 v168, v219 offset:4096
  ds_read_b32 v169, v219 offset:4224
  s_waitcnt lgkmcnt(9)
  v_mfma_f32_32x32x16_bf16 v[80:95], v[128:131], a[144:147], 0
  s_waitcnt lgkmcnt(8)
  v_mfma_f32_32x32x16_bf16 v[80:95], v[132:135], a[148:151], v[80:95]
  s_waitcnt lgkmcnt(7)
  v_mfma_f32_32x32x16_bf16 v[80:95], v[136:139], a[152:155], v[80:95]
  s_waitcnt lgkmcnt(6)
  v_mfma_f32_32x32x16_bf16 v[80:95], v[140:143], a[156:159], v[80:95]
  s_waitcnt lgkmcnt(5)
  v_mfma_f32_32x32x16_bf16 v[80:95], v[144:147], a[160:163], v[80:95]
  s_waitcnt lgkmcnt(4)
  v_mfma_f32_32x32x16_bf16 v[80:95], v[148:151], a[164:167], v[80:95]
  s_waitcnt lgkmcnt(3)
  v_mfma_f32_32x32x16_bf16 v[80:95], v[152:155], a[168:171], v[80:95]
  s_waitcnt lgkmcnt(2)
  v_mfma_f32_32x32x16_bf16 v[80:95], v[156:159], a[172:175], v[80:95]
  s_add_u32 s77, s77, 2
  v_mov_b32 v212, s77
  s_nop 9
  v_mul_f32 v80, s68, v80
  v_mul_f32 v81, s68, v81
  v_mul_f32 v82, s68, v82
  v_mul_f32 v83, s68, v83
  v_max3_f32 v84, v184, v80, v81
  v_max3_f32 v84, v84, v82, v83
  v_mov_b32 v85, v84
  s_nop 1
  v_permlane32_swap_b32 v84, v85
  v_max_f32 v84, v84, v85
  v_sub_f32 v86, v184, v84
  v_sub_f32 v80, v80, v84
  v_sub_f32 v81, v81, v84
  v_sub_f32 v82, v82, v84
  v_sub_f32 v83, v83, v84
  v_exp_f32 v86, v86
  v_exp_f32 v80, v80
  v_exp_f32 v81, v81
  v_exp_f32 v82, v82
  v_exp_f32 v83, v83
  v_fma_f32 v186, v186, v86, v80
  v_add_f32 v84, v81, v82
  v_add_f32 v186, v186, v83
  v_add_f32 v186, v186, v84
  v_mov_b32 v187, v186
  s_nop 1
  v_permlane32_swap_b32 v186, v187
  v_add_f32 v186, v186, v187
  v_rcp_f32 v186, v186
  s_nop 0
  v_mul_f32 v86, v86, v186
  v_mul_f32 v80, v186, v80
  v_mul_f32 v81, v186, v81
  v_mul_f32 v82, v186, v82
  v_mul_f32 v83, v186, v83
  v_cvt_pk_bf16_f32 v28, v80, v81
  v_cvt_pk_bf16_f32 v29, v82, v83
  v_mul_f32 v224, v86, v224
  v_mul_f32 v225, v86, v225
  v_mul_f32 v226, v86, v226
  v_mul_f32 v227, v86, v227
  v_mul_f32 v228, v86, v228
  v_mul_f32 v229, v86, v229
  v_mul_f32 v230, v86, v230
  v_mul_f32 v231, v86, v231
  v_mul_f32 v232, v86, v232
  v_mul_f32 v233, v86, v233
  v_mul_f32 v234, v86, v234
  v_mul_f32 v235, v86, v235
  v_mul_f32 v236, v86, v236
  v_mul_f32 v237, v86, v237
  v_mul_f32 v238, v86, v238
  v_mul_f32 v239, v86, v239
  s_waitcnt lgkmcnt(0)
  s_nop 0
  v_mfma_f32_32x32x8_bf16 v[224:239], v[168:169], v[28:29], v[224:239]
  s_nop 11
  v_cvt_pk_bf16_f32 v20, v224, v225
  v_cvt_pk_bf16_f32 v21, v226, v227
  v_cvt_pk_bf16_f32 v22, v228, v229
  v_cvt_pk_bf16_f32 v23, v230, v231
  buffer_store_dwordx4 v[20:23], v201, s[8:11], s75 offen offset:0 sc1
  v_cvt_pk_bf16_f32 v24, v232, v233
  v_cvt_pk_bf16_f32 v25, v234, v235
  v_cvt_pk_bf16_f32 v26, v236, v237
  v_cvt_pk_bf16_f32 v27, v238, v239
  buffer_store_dwordx4 v[24:27], v201, s[8:11], s75 offen offset:1024 sc1
  s_mov_b64 exec, 1
  buffer_store_dword v212, v201, s[8:11], s71 offen sc1
  s_mov_b64 exec, -1
  s_cmp_ge_u32 s77, 64
  s_cbranch_scc1 L_exit
  s_branch AT_loop
L_cexit:
L_exit:
L_end:
s_endpgm
.section .rodata,"a"
.p2align 6
.amdhsa_kernel gated_mix__sliding_local_dilated__memory_aug_recurrent_mem_tr__prompt_kernel
  .amdhsa_next_free_vgpr 512
  .amdhsa_next_free_sgpr 102
  .amdhsa_accum_offset 256
  .amdhsa_group_segment_fixed_size 0
  .amdhsa_kernarg_size 112
  .amdhsa_user_sgpr_count 2
  .amdhsa_user_sgpr_kernarg_segment_ptr 1
  .amdhsa_system_sgpr_workgroup_id_x 1
.end_amdhsa_kernel
```

```asm
; @launch grid=(256,1,1) block=(256,1,1) lds=163840
.amdgcn_target "amdgcn-amd-amdhsa--gfx950"
.text
.globl gated_mix__sliding_local_dilated__memory_aug_recurrent_mem_tr__prompt_kernel
.p2align 8
.type gated_mix__sliding_local_dilated__memory_aug_recurrent_mem_tr__prompt_kernel,@function
gated_mix__sliding_local_dilated__memory_aug_recurrent_mem_tr__prompt_kernel:
  s_cmp_ge_u32 s2, 256
  s_cbranch_scc1 L_end
  s_load_dwordx2 s[4:5], s[0:1], 0
  s_load_dwordx2 s[8:9], s[0:1], 104
  s_load_dwordx2 s[12:13], s[0:1], 96
  s_load_dwordx2 s[16:17], s[0:1], 40
  s_load_dwordx2 s[20:21], s[0:1], 48
  s_load_dwordx2 s[24:25], s[0:1], 56
  s_load_dwordx2 s[28:29], s[0:1], 64
  s_load_dwordx2 s[32:33], s[0:1], 32
  s_load_dwordx2 s[36:37], s[0:1], 8
  s_load_dwordx2 s[40:41], s[0:1], 16
  s_load_dwordx2 s[44:45], s[0:1], 80
  s_load_dwordx2 s[48:49], s[0:1], 88
  s_getreg_b32 s54, hwreg(HW_REG_XCC_ID, 0, 3)
  v_lshrrev_b32 v1, 6, v0
  s_nop 0
  v_readfirstlane_b32 s52, v1
  s_mov_b32 s6, 2359296
  s_mov_b32 s7, 0x20000
  s_mov_b32 s10, 268435456
  s_mov_b32 s11, 0x20000
  s_mov_b32 s14, 256
  s_mov_b32 s15, 0x20000
  s_mov_b32 s18, 4718592
  s_mov_b32 s19, 0x20000
  s_mov_b32 s22, 4718592
  s_mov_b32 s23, 0x20000
  s_mov_b32 s26, 4718592
  s_mov_b32 s27, 0x20000
  s_mov_b32 s30, 4718592
  s_mov_b32 s31, 0x20000
  s_mov_b32 s34, 9216
  s_mov_b32 s35, 0x20000
  s_mov_b32 s38, 1990656
  s_mov_b32 s39, 0x20000
  s_mov_b32 s42, 663552
  s_mov_b32 s43, 0x20000
  s_mov_b32 s46, 1152
  s_mov_b32 s47, 0x20000
  s_mov_b32 s50, 2359296
  s_mov_b32 s51, 0x20000
  s_waitcnt lgkmcnt(0)
  s_lshr_b32 s0, s2, 3
  s_mov_b32 s2, s54
  s_mov_b32 s1, 0
L_role:
  s_mov_b32 s53, s0
  s_cmp_eq_u32 s2, 0
  s_cbranch_scc0 L_worker
  v_and_b32 v0, 63, v0
  v_and_b32 v1, 15, v0
  v_lshrrev_b32 v2, 4, v0
  v_and_b32 v3, 1, v2
  s_lshl_b32 s54, s52, 1
  v_add_u32 v3, s54, v3
  v_lshlrev_b32 v3, 1, v3
  v_xor_b32 v3, v3, v1
  v_lshlrev_b32 v3, 4, v3
  v_lshl_add_u32 v8, v2, 13, v3
  s_lshl_b32 s78, s53, 8
  s_lshl_b32 s54, s52, 15
  s_add_u32 s78, s78, s54
  s_mul_i32 s79, s53, 147456
  s_lshl_b32 s57, s52, 10
  s_add_u32 s57, s57, 16384
  s_getpc_b64 s[80:81]
L_pc_1:
  s_and_b32 s55, s0, 1
  s_lshl_b32 s55, s55, 2
  s_add_u32 s55, s55, s52
  s_lshl_b32 s55, s55, 10
  v_and_b32 v199, 63, v0
  v_lshl_add_u32 v199, v199, 4, s55
  v_min_u32 v199, (L_w0 - L_pc_1), v199
  global_load_dword v196, v199, s[80:81]
  s_add_u32 m0, s57, 0
  s_add_u32 s54, s78, 0
  buffer_load_dwordx4 v8, s[16:19], s54 offen  lds
  s_add_u32 m0, s57, 4096
  s_add_u32 s54, s78, 131072
  buffer_load_dwordx4 v8, s[16:19], s54 offen  lds
  s_add_u32 m0, s57, 8192
  s_add_u32 s54, s78, 262144
  buffer_load_dwordx4 v8, s[16:19], s54 offen  lds
  s_add_u32 m0, s57, 12288
  s_add_u32 s54, s78, 393216
  buffer_load_dwordx4 v8, s[16:19], s54 offen  lds
  s_add_u32 m0, s57, 16384
  s_add_u32 s54, s78, 524288
  buffer_load_dwordx4 v8, s[16:19], s54 offen  lds
  s_add_u32 m0, s57, 20480
  s_add_u32 s54, s78, 655360
  buffer_load_dwordx4 v8, s[16:19], s54 offen  lds
  s_add_u32 m0, s57, 24576
  s_add_u32 s54, s78, 786432
  buffer_load_dwordx4 v8, s[16:19], s54 offen  lds
  s_add_u32 m0, s57, 28672
  s_add_u32 s54, s78, 917504
  buffer_load_dwordx4 v8, s[16:19], s54 offen  lds
  s_add_u32 m0, s57, 32768
  s_add_u32 s54, s78, 1048576
  buffer_load_dwordx4 v8, s[16:19], s54 offen  lds
  s_add_u32 m0, s57, 36864
  s_add_u32 s54, s78, 1179648
  buffer_load_dwordx4 v8, s[16:19], s54 offen  lds
  s_add_u32 m0, s57, 40960
  s_add_u32 s54, s78, 1310720
  buffer_load_dwordx4 v8, s[16:19], s54 offen  lds
  s_add_u32 m0, s57, 45056
  s_add_u32 s54, s78, 1441792
  buffer_load_dwordx4 v8, s[16:19], s54 offen  lds
  s_add_u32 m0, s57, 49152
  s_add_u32 s54, s78, 1572864
  buffer_load_dwordx4 v8, s[16:19], s54 offen  lds
  s_add_u32 m0, s57, 53248
  s_add_u32 s54, s78, 1703936
  buffer_load_dwordx4 v8, s[16:19], s54 offen  lds
  s_add_u32 m0, s57, 57344
  s_add_u32 s54, s78, 1835008
  buffer_load_dwordx4 v8, s[16:19], s54 offen  lds
  s_add_u32 m0, s57, 61440
  s_add_u32 s54, s78, 1966080
  buffer_load_dwordx4 v8, s[16:19], s54 offen  lds
  s_add_u32 m0, s57, 65536
  s_add_u32 s54, s78, 2097152
  buffer_load_dwordx4 v8, s[16:19], s54 offen  lds
  s_add_u32 m0, s57, 69632
  s_add_u32 s54, s78, 2228224
  buffer_load_dwordx4 v8, s[16:19], s54 offen  lds
  s_add_u32 m0, s57, 73728
  s_add_u32 s54, s78, 2359296
  buffer_load_dwordx4 v8, s[16:19], s54 offen  lds
  s_add_u32 m0, s57, 77824
  s_add_u32 s54, s78, 2490368
  buffer_load_dwordx4 v8, s[16:19], s54 offen  lds
  v_lshlrev_b32 v76, 4, v0
  v_add_u32 v75, 0x10000, v76
  v_lshrrev_b32 v3, 2, v1
  v_and_b32 v4, 1, v1
  v_lshl_add_u32 v3, v3, 1, v4
  v_bfe_u32 v4, v1, 1, 1
  v_mul_u32_u24 v74, 0xaaaa, v4
  v_add_u32 v74, 0x4444, v74
  v_mul_u32_u24 v5, 576, v3
  v_add_u32 v5, 0, v5
  v_lshl_add_u32 v78, v2, 4, v5
  v_lshl_add_u32 v77, v2, 5, v5
  v_lshl_add_u32 v77, v4, 4, v77
  v_mul_u32_u24 v15, 1152, v3
  v_lshl_add_u32 v15, v2, 5, v15
  v_lshl_add_u32 v15, v4, 4, v15
  s_lshl_b32 s54, s52, 8
  buffer_load_dwordx4 v[20:23], v15, s[32:35], s54 offen
  buffer_load_dwordx4 v[24:27], v15, s[32:35], s54 offen offset:128
  buffer_load_dwordx4 v[28:31], v15, s[32:35], 0 offen offset:1024
  v_mul_u32_u24 v79, 1152, v2
  v_lshl_add_u32 v79, v1, 2, v79
  s_lshl_b32 s54, s52, 6
  s_add_u32 s54, s54, 0
  v_add_u32 v79, s54, v79
  v_lshrrev_b32 v5, 3, v0
  v_mul_u32_u24 v68, 2176, v5
  v_and_b32 v5, 7, v0
  v_lshl_add_u32 v68, v5, 3, v68
  v_lshrrev_b32 v6, 3, v0
  s_lshr_b32 s54, s53, 2
  v_add_u32 v68, s54, v6
  v_and_b32 v68, 7, v68
  v_xor_b32 v68, v68, v6
  v_lshlrev_b32 v68, 8, v68
  v_lshl_add_u32 v68, v6, 12, v68
  v_lshl_add_u32 v68, v5, 3, v68
  s_and_b32 s54, s53, 3
  s_lshl_b32 s54, s54, 6
  v_add_u32 v68, s54, v68
  v_and_b32 v5, 1, v2
  v_lshlrev_b32 v5, 4, v5
  v_lshl_add_u32 v5, v1, 2, v5
  v_mov_b32 v6, 0x40000000
  v_cmp_lt_u32 vcc, 3, v1
  s_nop 1
  v_cndmask_b32 v5, v5, v6, vcc
  v_lshrrev_b32 v6, 1, v2
  v_lshl_add_u32 v69, v6, 10, v5
  v_lshl_add_u32 v70, v6, 8, v5
  v_mov_b32 v71, -1
  ds_write_b128 v76, v[68:71] offset:13824
  v_and_b32 v5, 3, v1
  v_lshrrev_b32 v6, 2, v1
  v_lshl_add_u32 v5, v5, 2, v6
  v_and_b32 v6, 1, v5
  v_lshlrev_b32 v6, 4, v6
  v_mov_b32 v7, 0x3f80
  v_lshlrev_b32 v6, v6, v7
  v_lshrrev_b32 v5, 1, v5
  v_cmp_eq_u32 vcc, 0, v5
  s_nop 1
  v_cndmask_b32 v40, 0, v6, vcc
  v_cmp_eq_u32 vcc, 1, v5
  s_nop 1
  v_cndmask_b32 v41, 0, v6, vcc
  v_cmp_eq_u32 vcc, 2, v5
  s_nop 1
  v_cndmask_b32 v42, 0, v6, vcc
  v_cmp_eq_u32 vcc, 3, v5
  s_nop 1
  v_cndmask_b32 v43, 0, v6, vcc
  ds_write_b128 v76, v[40:43] offset:14848
  s_and_b32 s54, s52, 1
  s_lshr_b32 s55, s52, 1
  v_lshrrev_b32 v3, 3, v0
  v_and_b32 v4, 1, v3
  v_lshlrev_b32 v4, 4, v4
  v_and_b32 v5, 6, v3
  v_add_u32 v4, v4, v5
  s_lshl_b32 s56, s55, 3
  s_add_u32 s56, s56, s54
  v_add_u32 v4, s56, v4
  v_mul_u32_u24 v4, 1152, v4
  v_and_b32 v5, 2, v3
  v_lshlrev_b32 v5, 1, v5
  v_and_b32 v6, 7, v0
  v_xor_b32 v6, v6, v5
  v_lshl_add_u32 v9, v6, 4, v4
  v_and_b32 v4, 1, v2
  v_lshlrev_b32 v4, 4, v4
  v_and_b32 v5, 2, v2
  v_add_u32 v4, v4, v5
  s_lshl_b32 s56, s55, 2
  s_add_u32 s56, s56, s54
  v_add_u32 v4, s56, v4
  v_mul_u32_u24 v4, 1152, v4
  v_lshlrev_b32 v6, 1, v2
  v_xor_b32 v6, v6, v1
  v_lshl_add_u32 v10, v6, 4, v4
  v_bfe_u32 v17, v1, 2, 1
  v_bfe_u32 v18, v1, 3, 1
  v_and_b32 v19, 1, v2
  v_lshrrev_b32 v72, 1, v2
  v_and_b32 v73, 3, v1
  v_lshl_add_u32 v3, v19, 1, v17
  v_lshl_add_u32 v6, v18, 2, v3
  v_lshl_add_u32 v4, v72, 4, v17
  v_lshl_add_u32 v4, v19, 2, v4
  v_lshl_add_u32 v4, v18, 3, v4
  v_lshlrev_b32 v4, 8, v4
  s_lshl_b32 s54, s52, 6
  v_lshl_add_u32 v5, v73, 3, s54
  v_lshlrev_b32 v7, 5, v6
  v_xor_b32 v5, v5, v7
  v_add_u32 v11, v4, v5
  v_xor_b32 v12, 32, v11
  v_lshl_add_u32 v4, v72, 2, v3
  v_lshlrev_b32 v4, 7, v4
  v_lshl_add_u32 v4, v73, 3, v4
  s_and_b32 s54, s52, 1
  v_xor_b32 v7, s54, v19
  v_lshl_add_u32 v7, v7, 1, v18
  v_lshl_add_u32 v13, v7, 5, v4
  v_lshlrev_b32 v4, 11, v72
  v_lshl_add_u32 v4, v73, 3, v4
  v_lshl_add_u32 v5, v3, 8, v4
  v_lshl_add_u32 v7, v18, 2, s52
  v_xor_b32 v7, v7, v3
  v_lshl_add_u32 v14, v7, 5, v5
  s_lshl_b32 s54, s53, 14
  s_lshl_b32 s55, s52, 11
  s_add_u32 s54, s54, 1048576
  s_add_u32 s58, s54, s55
  s_add_u32 s59, s58, 8192
  s_lshl_b32 s55, s52, 12
  s_add_u32 s70, s54, s55
  s_add_u32 s70, s70, 655360
  s_lshl_b32 s54, s53, 12
  s_lshl_b32 s55, s52, 10
  s_add_u32 s54, s54, s55
  s_add_u32 s68, s54, 917504
  s_lshl_b32 s54, s53, 6
  s_mul_i32 s55, s52, 17408
  s_add_u32 s55, s54, s55
  s_add_u32 s73, s55, 0
  s_add_u32 s74, s55, 69632
  s_add_u32 s75, s55, 139264
  s_add_u32 s76, s55, 208896
  s_and_b32 s56, s52, 1
  s_mul_i32 s55, s56, 17408
  s_add_u32 s55, s54, s55
  s_add_u32 s77, s55, 278528
  s_mul_i32 s54, s52, 69632
  s_mul_i32 s55, s53, 2176
  s_add_u32 s54, s54, s55
  s_add_u32 s60, s54, 0
  s_and_b32 s56, s53, 15
  s_mul_i32 s55, s56, 2176
  s_add_u32 s61, s55, 278528
  s_lshr_b32 s54, s52, 1
  s_lshl_b32 s54, s54, 15
  s_and_b32 s55, s52, 1
  s_lshl_b32 s55, s55, 11
  s_add_u32 s54, s54, s55
  s_add_u32 s73, s54, 0
  s_add_u32 s74, s54, 65536
  s_add_u32 s75, s54, 131072
  s_add_u32 s76, s54, 196608
  s_add_u32 s77, s55, 262144
  s_and_b32 s54, s53, 7
  s_lshl_b32 s54, s54, 12
  s_bfe_u32 s55, s53, 0x10003
  s_lshl_b32 s55, s55, 11
  s_add_u32 s54, s54, s55
  s_add_u32 s61, s54, 262144
  s_lshr_b32 s55, s53, 4
  s_lshl_b32 s55, s55, 15
  s_add_u32 s54, s54, s55
  s_lshl_b32 s55, s52, 16
  s_add_u32 s54, s54, s55
  s_add_u32 s60, s54, 0
  s_lshl_b32 s54, s52, 11
  s_add_u32 s64, s54, 360448
  s_mov_b32 s65, 368640
  s_lshl_b32 s55, s53, 5
  s_add_u32 s54, s54, s55
  s_add_u32 s62, s54, 376832
  s_lshr_b32 s54, s56, 3
  s_lshl_b32 s54, s54, 9
  s_and_b32 s55, s56, 7
  s_lshl_b32 s55, s55, 5
  s_add_u32 s54, s54, s55
  s_add_u32 s63, s54, 385024
  s_mov_b32 s66, 0
  s_mov_b32 s67, 0
  s_mov_b32 s72, 0
  s_mov_b32 s69, 1040356334
  s_waitcnt vmcnt(19) lgkmcnt(0)
  s_barrier
  s_add_u32 m0, s57, 81920
  s_add_u32 s54, s78, 2621440
  buffer_load_dwordx4 v8, s[16:19], s54 offen  lds
  s_add_u32 m0, s57, 86016
  s_add_u32 s54, s78, 2752512
  buffer_load_dwordx4 v8, s[16:19], s54 offen  lds
  s_add_u32 m0, s57, 90112
  s_add_u32 s54, s78, 2883584
  buffer_load_dwordx4 v8, s[16:19], s54 offen  lds
  s_add_u32 m0, s57, 94208
  s_add_u32 s54, s78, 3014656
  buffer_load_dwordx4 v8, s[16:19], s54 offen  lds
  v_add_u32 v15, 16384, v11
  v_add_u32 v16, 16384, v12
  ds_read_b64_tr_b16 v[80:81], v15 offset:0
  ds_read_b64_tr_b16 v[82:83], v15 offset:512
  ds_read_b64_tr_b16 v[84:85], v15 offset:8192
  ds_read_b64_tr_b16 v[86:87], v15 offset:8704
  ds_read_b64_tr_b16 v[88:89], v16 offset:0
  ds_read_b64_tr_b16 v[90:91], v16 offset:512
  ds_read_b64_tr_b16 v[92:93], v16 offset:8192
  ds_read_b64_tr_b16 v[94:95], v16 offset:8704
  s_waitcnt vmcnt(19) lgkmcnt(0)
  s_barrier
  s_add_u32 m0, s57, 98304
  s_add_u32 s54, s78, 3670016
  buffer_load_dwordx4 v8, s[16:19], s54 offen  lds
  s_add_u32 m0, s57, 102400
  s_add_u32 s54, s78, 3801088
  buffer_load_dwordx4 v8, s[16:19], s54 offen  lds
  s_add_u32 m0, s57, 106496
  s_add_u32 s54, s78, 3932160
  buffer_load_dwordx4 v8, s[16:19], s54 offen  lds
  s_add_u32 m0, s57, 110592
  s_add_u32 s54, s78, 4063232
  buffer_load_dwordx4 v8, s[16:19], s54 offen  lds
  v_add_u32 v15, 32768, v11
  v_add_u32 v16, 32768, v12
  ds_read_b64_tr_b16 v[96:97], v15 offset:0
  ds_read_b64_tr_b16 v[98:99], v15 offset:512
  ds_read_b64_tr_b16 v[100:101], v15 offset:8192
  ds_read_b64_tr_b16 v[102:103], v15 offset:8704
  ds_read_b64_tr_b16 v[104:105], v16 offset:0
  ds_read_b64_tr_b16 v[106:107], v16 offset:512
  ds_read_b64_tr_b16 v[108:109], v16 offset:8192
  ds_read_b64_tr_b16 v[110:111], v16 offset:8704
  s_waitcnt vmcnt(19) lgkmcnt(0)
  s_barrier
  s_add_u32 m0, s57, 114688
  s_add_u32 s54, s78, 4194304
  buffer_load_dwordx4 v8, s[16:19], s54 offen  lds
  s_add_u32 m0, s57, 118784
  s_add_u32 s54, s78, 4325376
  buffer_load_dwordx4 v8, s[16:19], s54 offen  lds
  s_add_u32 m0, s57, 122880
  s_add_u32 s54, s78, 4456448
  buffer_load_dwordx4 v8, s[16:19], s54 offen  lds
  s_add_u32 m0, s57, 126976
  s_add_u32 s54, s78, 4587520
  buffer_load_dwordx4 v8, s[16:19], s54 offen  lds
  s_lshl_b32 s55, s2, 2
  s_or_b32 s56, s52, s1
  s_cmp_eq_u32 s56, 0
  s_cselect_b32 s55, s55, 0x1000
  s_lshl_b32 s56, 1, s0
  v_mov_b32 v35, s56
  s_mov_b64 exec, 1
  buffer_atomic_or v35, off, s[12:15], s55 sc0
  s_mov_b64 exec, -1
  v_add_u32 v15, 49152, v11
  v_add_u32 v16, 49152, v12
  ds_read_b64_tr_b16 v[112:113], v15 offset:0
  ds_read_b64_tr_b16 v[114:115], v15 offset:512
  ds_read_b64_tr_b16 v[116:117], v15 offset:8192
  ds_read_b64_tr_b16 v[118:119], v15 offset:8704
  ds_read_b64_tr_b16 v[120:121], v16 offset:0
  ds_read_b64_tr_b16 v[122:123], v16 offset:512
  ds_read_b64_tr_b16 v[124:125], v16 offset:8192
  ds_read_b64_tr_b16 v[126:127], v16 offset:8704
  s_waitcnt vmcnt(20) lgkmcnt(0)
  s_barrier
  s_add_u32 m0, s57, 131072
  s_add_u32 s54, s78, 1048576
  buffer_load_dwordx4 v8, s[20:23], s54 offen  lds
  s_add_u32 m0, s57, 135168
  s_add_u32 s54, s78, 1179648
  buffer_load_dwordx4 v8, s[20:23], s54 offen  lds
  s_add_u32 m0, s57, 139264
  s_add_u32 s54, s78, 1310720
  buffer_load_dwordx4 v8, s[20:23], s54 offen  lds
  s_add_u32 m0, s57, 143360
  s_add_u32 s54, s78, 1441792
  buffer_load_dwordx4 v8, s[20:23], s54 offen  lds
  v_add_u32 v15, 65536, v11
  v_add_u32 v16, 65536, v12
  ds_read_b64_tr_b16 v[128:129], v15 offset:0
  ds_read_b64_tr_b16 v[130:131], v15 offset:512
  ds_read_b64_tr_b16 v[132:133], v15 offset:8192
  ds_read_b64_tr_b16 v[134:135], v15 offset:8704
  ds_read_b64_tr_b16 v[136:137], v16 offset:0
  ds_read_b64_tr_b16 v[138:139], v16 offset:512
  ds_read_b64_tr_b16 v[140:141], v16 offset:8192
  ds_read_b64_tr_b16 v[142:143], v16 offset:8704
  s_waitcnt vmcnt(20) lgkmcnt(0)
  s_barrier
  s_add_u32 m0, s57, 0
  s_add_u32 s54, s78, 1572864
  buffer_load_dwordx4 v8, s[20:23], s54 offen  lds
  s_add_u32 m0, s57, 4096
  s_add_u32 s54, s78, 1703936
  buffer_load_dwordx4 v8, s[20:23], s54 offen  lds
  s_add_u32 m0, s57, 8192
  s_add_u32 s54, s78, 1835008
  buffer_load_dwordx4 v8, s[20:23], s54 offen  lds
  s_add_u32 m0, s57, 12288
  s_add_u32 s54, s78, 1966080
  buffer_load_dwordx4 v8, s[20:23], s54 offen  lds
  v_add_u32 v15, 81920, v11
  v_add_u32 v16, 81920, v12
  ds_read_b64_tr_b16 v[144:145], v15 offset:0
  ds_read_b64_tr_b16 v[146:147], v15 offset:512
  ds_read_b64_tr_b16 v[148:149], v15 offset:8192
  ds_read_b64_tr_b16 v[150:151], v15 offset:8704
  ds_read_b64_tr_b16 v[152:153], v16 offset:0
  ds_read_b64_tr_b16 v[154:155], v16 offset:512
  ds_read_b64_tr_b16 v[156:157], v16 offset:8192
  ds_read_b64_tr_b16 v[158:159], v16 offset:8704
  s_waitcnt vmcnt(17) lgkmcnt(0)
  s_barrier
  s_add_u32 m0, s57, 16384
  s_add_u32 s54, s78, 3145728
  buffer_load_dwordx4 v8, s[20:23], s54 offen  lds
  s_add_u32 m0, s57, 20480
  s_add_u32 s54, s78, 3276800
  buffer_load_dwordx4 v8, s[20:23], s54 offen  lds
  s_add_u32 m0, s57, 24576
  s_add_u32 s54, s78, 3407872
  buffer_load_dwordx4 v8, s[20:23], s54 offen  lds
  s_add_u32 m0, s57, 28672
  s_add_u32 s54, s78, 3538944
  buffer_load_dwordx4 v8, s[20:23], s54 offen  lds
  v_add_u32 v15, 98304, v11
  v_add_u32 v16, 98304, v12
  ds_read_b64_tr_b16 v[160:161], v15 offset:0
  ds_read_b64_tr_b16 v[162:163], v15 offset:512
  ds_read_b64_tr_b16 v[164:165], v15 offset:8192
  ds_read_b64_tr_b16 v[166:167], v15 offset:8704
  ds_read_b64_tr_b16 v[168:169], v16 offset:0
  ds_read_b64_tr_b16 v[170:171], v16 offset:512
  ds_read_b64_tr_b16 v[172:173], v16 offset:8192
  ds_read_b64_tr_b16 v[174:175], v16 offset:8704
  s_waitcnt vmcnt(17) lgkmcnt(0)
  s_barrier
  s_add_u32 m0, s57, 32768
  s_add_u32 s54, s78, 3670016
  buffer_load_dwordx4 v8, s[20:23], s54 offen  lds
  s_add_u32 m0, s57, 36864
  s_add_u32 s54, s78, 3801088
  buffer_load_dwordx4 v8, s[20:23], s54 offen  lds
  s_add_u32 m0, s57, 40960
  s_add_u32 s54, s78, 3932160
  buffer_load_dwordx4 v8, s[20:23], s54 offen  lds
  s_add_u32 m0, s57, 45056
  s_add_u32 s54, s78, 4063232
  buffer_load_dwordx4 v8, s[20:23], s54 offen  lds
  v_add_u32 v15, 114688, v11
  v_add_u32 v16, 114688, v12
  ds_read_b64_tr_b16 v[176:177], v15 offset:0
  ds_read_b64_tr_b16 v[178:179], v15 offset:512
  ds_read_b64_tr_b16 v[180:181], v15 offset:8192
  ds_read_b64_tr_b16 v[182:183], v15 offset:8704
  ds_read_b64_tr_b16 v[184:185], v16 offset:0
  ds_read_b64_tr_b16 v[186:187], v16 offset:512
  ds_read_b64_tr_b16 v[188:189], v16 offset:8192
  ds_read_b64_tr_b16 v[190:191], v16 offset:8704
  s_waitcnt vmcnt(17) lgkmcnt(0)
  s_barrier
  s_add_u32 m0, s57, 49152
  s_add_u32 s54, s78, 4194304
  buffer_load_dwordx4 v8, s[20:23], s54 offen  lds
  s_add_u32 m0, s57, 53248
  s_add_u32 s54, s78, 4325376
  buffer_load_dwordx4 v8, s[20:23], s54 offen  lds
  s_add_u32 m0, s57, 57344
  s_add_u32 s54, s78, 4456448
  buffer_load_dwordx4 v8, s[20:23], s54 offen  lds
  s_add_u32 m0, s57, 61440
  s_add_u32 s54, s78, 4587520
  buffer_load_dwordx4 v8, s[20:23], s54 offen  lds
  v_add_u32 v15, 131072, v11
  v_add_u32 v16, 131072, v12
  ds_read_b64_tr_b16 v[192:193], v15 offset:0
  ds_read_b64_tr_b16 v[194:195], v15 offset:512
  ds_read_b64_tr_b16 v[196:197], v15 offset:8192
  ds_read_b64_tr_b16 v[198:199], v15 offset:8704
  ds_read_b64_tr_b16 v[200:201], v16 offset:0
  ds_read_b64_tr_b16 v[202:203], v16 offset:512
  ds_read_b64_tr_b16 v[204:205], v16 offset:8192
  ds_read_b64_tr_b16 v[206:207], v16 offset:8704
  s_waitcnt vmcnt(16) lgkmcnt(0)
  s_barrier
  s_add_u32 m0, s57, 65536
  s_add_u32 s54, s78, 0
  buffer_load_dwordx4 v8, s[24:27], s54 offen  lds
  s_add_u32 m0, s57, 69632
  s_add_u32 s54, s78, 131072
  buffer_load_dwordx4 v8, s[24:27], s54 offen  lds
  s_add_u32 m0, s57, 73728
  s_add_u32 s54, s78, 262144
  buffer_load_dwordx4 v8, s[24:27], s54 offen  lds
  s_add_u32 m0, s57, 77824
  s_add_u32 s54, s78, 393216
  buffer_load_dwordx4 v8, s[24:27], s54 offen  lds
  s_getpc_b64 s[80:81]
  v_lshlrev_b32 v7, 2, v76
  global_load_dword v19, v7, s[80:81] offset:1024
  v_min_u32 v20, -2, v20
  v_min_u32 v21, -2, v21
  v_min_u32 v22, -2, v22
  v_min_u32 v23, -2, v23
  v_min_u32 v24, -2, v24
  v_min_u32 v25, -2, v25
  v_min_u32 v26, -2, v26
  v_min_u32 v27, -2, v27
  v_min_u32 v28, -2, v28
  v_min_u32 v29, -2, v29
  v_min_u32 v30, -2, v30
  v_min_u32 v31, -2, v31
  s_lshl_b32 s54, s52, 11
  v_add_u32 v3, s54, v76
  ds_write_b128 v3, v[20:23] offset:4608
  ds_write_b128 v3, v[24:27] offset:5632
  ds_write_b128 v76, v[28:31] offset:12800
  v_add_u32 v15, 147456, v11
  v_add_u32 v16, 147456, v12
  ds_read_b64_tr_b16 v[208:209], v15 offset:0
  ds_read_b64_tr_b16 v[210:211], v15 offset:512
  ds_read_b64_tr_b16 v[212:213], v15 offset:8192
  ds_read_b64_tr_b16 v[214:215], v15 offset:8704
  ds_read_b64_tr_b16 v[216:217], v16 offset:0
  ds_read_b64_tr_b16 v[218:219], v16 offset:512
  ds_read_b64_tr_b16 v[220:221], v16 offset:8192
  ds_read_b64_tr_b16 v[222:223], v16 offset:8704
  s_waitcnt vmcnt(17) lgkmcnt(0)
  s_barrier
  s_add_u32 m0, s57, 81920
  s_add_u32 s54, s78, 524288
  buffer_load_dwordx4 v8, s[24:27], s54 offen  lds
  s_add_u32 m0, s57, 86016
  s_add_u32 s54, s78, 655360
  buffer_load_dwordx4 v8, s[24:27], s54 offen  lds
  s_add_u32 m0, s57, 90112
  s_add_u32 s54, s78, 786432
  buffer_load_dwordx4 v8, s[24:27], s54 offen  lds
  s_add_u32 m0, s57, 94208
  s_add_u32 s54, s78, 917504
  buffer_load_dwordx4 v8, s[24:27], s54 offen  lds
  v_add_u32 v15, 16384, v11
  v_add_u32 v16, 16384, v12
  ds_read_b64_tr_b16 v[224:225], v15 offset:0
  ds_read_b64_tr_b16 v[226:227], v15 offset:512
  ds_read_b64_tr_b16 v[228:229], v15 offset:8192
  ds_read_b64_tr_b16 v[230:231], v15 offset:8704
  ds_read_b64_tr_b16 v[232:233], v16 offset:0
  ds_read_b64_tr_b16 v[234:235], v16 offset:512
  ds_read_b64_tr_b16 v[236:237], v16 offset:8192
  ds_read_b64_tr_b16 v[238:239], v16 offset:8704
  s_waitcnt vmcnt(17) lgkmcnt(0)
  s_barrier
  s_add_u32 m0, s57, 98304
  s_add_u32 s54, s78, 1048576
  buffer_load_dwordx4 v8, s[24:27], s54 offen  lds
  s_add_u32 m0, s57, 102400
  s_add_u32 s54, s78, 1179648
  buffer_load_dwordx4 v8, s[24:27], s54 offen  lds
  s_add_u32 m0, s57, 106496
  s_add_u32 s54, s78, 1310720
  buffer_load_dwordx4 v8, s[24:27], s54 offen  lds
  s_add_u32 m0, s57, 110592
  s_add_u32 s54, s78, 1441792
  buffer_load_dwordx4 v8, s[24:27], s54 offen  lds
  s_cmp_eq_u32 s1, 1
  s_cbranch_scc1 C_ver_ok
  v_mov_b32 v33, 16320
  s_cmp_eq_u32 s52, 0
  s_cbranch_scc0 C_ver_b
  s_waitcnt vmcnt(33)
  s_mov_b64 exec, 1
  ds_write_b32 v33, v35
  s_mov_b64 exec, -1
  s_waitcnt lgkmcnt(0)
C_ver_b:
  s_barrier
  ds_read_b32 v32, v33
  s_waitcnt lgkmcnt(0)
  v_readfirstlane_b32 s54, v32
  s_nop 0
  s_bitcmp1_b32 s54, s0
  s_cbranch_scc1 L_conf
C_ver_ok:
  v_add_u32 v15, 32768, v11
  v_add_u32 v16, 32768, v12
  ds_read_b64_tr_b16 v[240:241], v15 offset:0
  ds_read_b64_tr_b16 v[242:243], v15 offset:512
  ds_read_b64_tr_b16 v[244:245], v15 offset:8192
  ds_read_b64_tr_b16 v[246:247], v15 offset:8704
  ds_read_b64_tr_b16 v[248:249], v16 offset:0
  ds_read_b64_tr_b16 v[250:251], v16 offset:512
  ds_read_b64_tr_b16 v[252:253], v16 offset:8192
  ds_read_b64_tr_b16 v[254:255], v16 offset:8704
  s_waitcnt vmcnt(17) lgkmcnt(0)
  s_barrier
  s_add_u32 m0, s57, 114688
  s_add_u32 s54, s78, 1572864
  buffer_load_dwordx4 v8, s[24:27], s54 offen  lds
  s_add_u32 m0, s57, 118784
  s_add_u32 s54, s78, 1703936
  buffer_load_dwordx4 v8, s[24:27], s54 offen  lds
  s_add_u32 m0, s57, 122880
  s_add_u32 s54, s78, 1835008
  buffer_load_dwordx4 v8, s[24:27], s54 offen  lds
  s_add_u32 m0, s57, 126976
  s_add_u32 s54, s78, 1966080
  buffer_load_dwordx4 v8, s[24:27], s54 offen  lds
  v_add_u32 v15, 49152, v11
  v_add_u32 v16, 49152, v12
  ds_read_b64_tr_b16 a[0:1], v15 offset:0
  ds_read_b64_tr_b16 a[2:3], v15 offset:512
  ds_read_b64_tr_b16 a[4:5], v15 offset:8192
  ds_read_b64_tr_b16 a[6:7], v15 offset:8704
  ds_read_b64_tr_b16 a[8:9], v16 offset:0
  ds_read_b64_tr_b16 a[10:11], v16 offset:512
  ds_read_b64_tr_b16 a[12:13], v16 offset:8192
  ds_read_b64_tr_b16 a[14:15], v16 offset:8704
  s_waitcnt vmcnt(17) lgkmcnt(0)
  s_barrier
  s_add_u32 m0, s57, 131072
  s_add_u32 s54, s78, 2097152
  buffer_load_dwordx4 v8, s[24:27], s54 offen  lds
  s_add_u32 m0, s57, 135168
  s_add_u32 s54, s78, 2228224
  buffer_load_dwordx4 v8, s[24:27], s54 offen  lds
  s_add_u32 m0, s57, 139264
  s_add_u32 s54, s78, 2359296
  buffer_load_dwordx4 v8, s[24:27], s54 offen  lds
  s_add_u32 m0, s57, 143360
  s_add_u32 s54, s78, 2490368
  buffer_load_dwordx4 v8, s[24:27], s54 offen  lds
  v_add_u32 v15, 65536, v11
  v_add_u32 v16, 65536, v12
  ds_read_b64_tr_b16 a[16:17], v15 offset:0
  ds_read_b64_tr_b16 a[18:19], v15 offset:512
  ds_read_b64_tr_b16 a[20:21], v15 offset:8192
  ds_read_b64_tr_b16 a[22:23], v15 offset:8704
  ds_read_b64_tr_b16 a[24:25], v16 offset:0
  ds_read_b64_tr_b16 a[26:27], v16 offset:512
  ds_read_b64_tr_b16 a[28:29], v16 offset:8192
  ds_read_b64_tr_b16 a[30:31], v16 offset:8704
  s_waitcnt vmcnt(17) lgkmcnt(0)
  s_barrier
  s_add_u32 m0, s57, 0
  s_add_u32 s54, s78, 2621440
  buffer_load_dwordx4 v8, s[24:27], s54 offen  lds
  s_add_u32 m0, s57, 4096
  s_add_u32 s54, s78, 2752512
  buffer_load_dwordx4 v8, s[24:27], s54 offen  lds
  s_add_u32 m0, s57, 8192
  s_add_u32 s54, s78, 2883584
  buffer_load_dwordx4 v8, s[24:27], s54 offen  lds
  s_add_u32 m0, s57, 12288
  s_add_u32 s54, s78, 3014656
  buffer_load_dwordx4 v8, s[24:27], s54 offen  lds
  v_add_u32 v15, 81920, v11
  v_add_u32 v16, 81920, v12
  ds_read_b64_tr_b16 a[32:33], v15 offset:0
  ds_read_b64_tr_b16 a[34:35], v15 offset:512
  ds_read_b64_tr_b16 a[36:37], v15 offset:8192
  ds_read_b64_tr_b16 a[38:39], v15 offset:8704
  ds_read_b64_tr_b16 a[40:41], v16 offset:0
  ds_read_b64_tr_b16 a[42:43], v16 offset:512
  ds_read_b64_tr_b16 a[44:45], v16 offset:8192
  ds_read_b64_tr_b16 a[46:47], v16 offset:8704
  s_waitcnt vmcnt(16) lgkmcnt(0)
  s_barrier
  s_add_u32 m0, s57, 16384
  s_add_u32 s54, s78, 3145728
  buffer_load_dwordx4 v8, s[24:27], s54 offen  lds
  s_add_u32 m0, s57, 20480
  s_add_u32 s54, s78, 3276800
  buffer_load_dwordx4 v8, s[24:27], s54 offen  lds
  s_add_u32 m0, s57, 24576
  s_add_u32 s54, s78, 3407872
  buffer_load_dwordx4 v8, s[24:27], s54 offen  lds
  s_add_u32 m0, s57, 28672
  s_add_u32 s54, s78, 3538944
  buffer_load_dwordx4 v8, s[24:27], s54 offen  lds
  s_getpc_b64 s[80:81]
  v_lshlrev_b32 v7, 2, v76
  global_load_dword v19, v7, s[80:81] offset:1024
  v_add_u32 v15, 98304, v11
  v_add_u32 v16, 98304, v12
  ds_read_b64_tr_b16 a[48:49], v15 offset:0
  ds_read_b64_tr_b16 a[50:51], v15 offset:512
  ds_read_b64_tr_b16 a[52:53], v15 offset:8192
  ds_read_b64_tr_b16 a[54:55], v15 offset:8704
  ds_read_b64_tr_b16 a[56:57], v16 offset:0
  ds_read_b64_tr_b16 a[58:59], v16 offset:512
  ds_read_b64_tr_b16 a[60:61], v16 offset:8192
  ds_read_b64_tr_b16 a[62:63], v16 offset:8704
  s_waitcnt vmcnt(17) lgkmcnt(0)
  s_barrier
  s_add_u32 m0, s57, 32768
  s_add_u32 s54, s78, 3670016
  buffer_load_dwordx4 v8, s[24:27], s54 offen  lds
  s_add_u32 m0, s57, 36864
  s_add_u32 s54, s78, 3801088
  buffer_load_dwordx4 v8, s[24:27], s54 offen  lds
  s_add_u32 m0, s57, 40960
  s_add_u32 s54, s78, 3932160
  buffer_load_dwordx4 v8, s[24:27], s54 offen  lds
  s_add_u32 m0, s57, 45056
  s_add_u32 s54, s78, 4063232
  buffer_load_dwordx4 v8, s[24:27], s54 offen  lds
  v_add_u32 v15, 114688, v11
  v_add_u32 v16, 114688, v12
  ds_read_b64_tr_b16 a[64:65], v15 offset:0
  ds_read_b64_tr_b16 a[66:67], v15 offset:512
  ds_read_b64_tr_b16 a[68:69], v15 offset:8192
  ds_read_b64_tr_b16 a[70:71], v15 offset:8704
  ds_read_b64_tr_b16 a[72:73], v16 offset:0
  ds_read_b64_tr_b16 a[74:75], v16 offset:512
  ds_read_b64_tr_b16 a[76:77], v16 offset:8192
  ds_read_b64_tr_b16 a[78:79], v16 offset:8704
  s_waitcnt vmcnt(17) lgkmcnt(0)
  s_barrier
  s_add_u32 m0, s57, 49152
  s_add_u32 s54, s78, 4194304
  buffer_load_dwordx4 v8, s[24:27], s54 offen  lds
  s_add_u32 m0, s57, 53248
  s_add_u32 s54, s78, 4325376
  buffer_load_dwordx4 v8, s[24:27], s54 offen  lds
  s_add_u32 m0, s57, 57344
  s_add_u32 s54, s78, 4456448
  buffer_load_dwordx4 v8, s[24:27], s54 offen  lds
  s_add_u32 m0, s57, 61440
  s_add_u32 s54, s78, 4587520
  buffer_load_dwordx4 v8, s[24:27], s54 offen  lds
  v_add_u32 v15, 131072, v11
  v_add_u32 v16, 131072, v12
  ds_read_b64_tr_b16 a[80:81], v15 offset:0
  ds_read_b64_tr_b16 a[82:83], v15 offset:512
  ds_read_b64_tr_b16 a[84:85], v15 offset:8192
  ds_read_b64_tr_b16 a[86:87], v15 offset:8704
  ds_read_b64_tr_b16 a[88:89], v16 offset:0
  ds_read_b64_tr_b16 a[90:91], v16 offset:512
  ds_read_b64_tr_b16 a[92:93], v16 offset:8192
  ds_read_b64_tr_b16 a[94:95], v16 offset:8704
  s_waitcnt vmcnt(17) lgkmcnt(0)
  s_barrier
  s_add_u32 m0, s57, 65536
  s_add_u32 s54, s79, 73728
  buffer_load_dwordx4 v10, s[28:31], s54 offen  lds
  s_add_u32 m0, s57, 69632
  s_add_u32 s54, s79, 82944
  buffer_load_dwordx4 v10, s[28:31], s54 offen  lds
  s_add_u32 m0, s57, 73728
  s_add_u32 s54, s79, 110592
  buffer_load_dwordx4 v10, s[28:31], s54 offen  lds
  s_add_u32 m0, s57, 77824
  s_add_u32 s54, s79, 119808
  buffer_load_dwordx4 v10, s[28:31], s54 offen  lds
  v_add_u32 v15, 147456, v11
  v_add_u32 v16, 147456, v12
  ds_read_b64_tr_b16 a[96:97], v15 offset:0
  ds_read_b64_tr_b16 a[98:99], v15 offset:512
  ds_read_b64_tr_b16 a[100:101], v15 offset:8192
  ds_read_b64_tr_b16 a[102:103], v15 offset:8704
  ds_read_b64_tr_b16 a[104:105], v16 offset:0
  ds_read_b64_tr_b16 a[106:107], v16 offset:512
  ds_read_b64_tr_b16 a[108:109], v16 offset:8192
  ds_read_b64_tr_b16 a[110:111], v16 offset:8704
  s_waitcnt vmcnt(17) lgkmcnt(0)
  s_barrier
  s_add_u32 m0, s57, 81920
  s_add_u32 s54, s79, 256
  buffer_load_dwordx4 v10, s[28:31], s54 offen  lds
  s_add_u32 m0, s57, 86016
  s_add_u32 s54, s79, 9472
  buffer_load_dwordx4 v10, s[28:31], s54 offen  lds
  s_add_u32 m0, s57, 90112
  s_add_u32 s54, s79, 37120
  buffer_load_dwordx4 v10, s[28:31], s54 offen  lds
  s_add_u32 m0, s57, 94208
  s_add_u32 s54, s79, 46336
  buffer_load_dwordx4 v10, s[28:31], s54 offen  lds
  v_add_u32 v15, 16384, v11
  v_add_u32 v16, 16384, v12
  ds_read_b64_tr_b16 a[112:113], v15 offset:0
  ds_read_b64_tr_b16 a[114:115], v15 offset:512
  ds_read_b64_tr_b16 a[116:117], v15 offset:8192
  ds_read_b64_tr_b16 a[118:119], v15 offset:8704
  ds_read_b64_tr_b16 a[120:121], v16 offset:0
  ds_read_b64_tr_b16 a[122:123], v16 offset:512
  ds_read_b64_tr_b16 a[124:125], v16 offset:8192
  ds_read_b64_tr_b16 a[126:127], v16 offset:8704
  s_waitcnt vmcnt(17) lgkmcnt(0)
  s_barrier
  s_add_u32 m0, s57, 98304
  s_add_u32 s54, s79, 512
  buffer_load_dwordx4 v10, s[28:31], s54 offen  lds
  s_add_u32 m0, s57, 102400
  s_add_u32 s54, s79, 9728
  buffer_load_dwordx4 v10, s[28:31], s54 offen  lds
  s_add_u32 m0, s57, 106496
  s_add_u32 s54, s79, 37376
  buffer_load_dwordx4 v10, s[28:31], s54 offen  lds
  s_add_u32 m0, s57, 110592
  s_add_u32 s54, s79, 46592
  buffer_load_dwordx4 v10, s[28:31], s54 offen  lds
  v_add_u32 v15, 32768, v11
  v_add_u32 v16, 32768, v12
  ds_read_b64_tr_b16 a[128:129], v15 offset:0
  ds_read_b64_tr_b16 a[130:131], v15 offset:512
  ds_read_b64_tr_b16 a[132:133], v15 offset:8192
  ds_read_b64_tr_b16 a[134:135], v15 offset:8704
  ds_read_b64_tr_b16 a[136:137], v16 offset:0
  ds_read_b64_tr_b16 a[138:139], v16 offset:512
  ds_read_b64_tr_b16 a[140:141], v16 offset:8192
  ds_read_b64_tr_b16 a[142:143], v16 offset:8704
  s_waitcnt vmcnt(16) lgkmcnt(0)
  s_barrier
  s_add_u32 m0, s57, 114688
  s_add_u32 s54, s79, 768
  buffer_load_dwordx4 v10, s[28:31], s54 offen  lds
  s_add_u32 m0, s57, 118784
  s_add_u32 s54, s79, 9984
  buffer_load_dwordx4 v10, s[28:31], s54 offen  lds
  s_add_u32 m0, s57, 122880
  s_add_u32 s54, s79, 37632
  buffer_load_dwordx4 v10, s[28:31], s54 offen  lds
  s_add_u32 m0, s57, 126976
  s_add_u32 s54, s79, 46848
  buffer_load_dwordx4 v10, s[28:31], s54 offen  lds
  s_getpc_b64 s[80:81]
  v_lshlrev_b32 v7, 2, v76
  global_load_dword v19, v7, s[80:81] offset:1024
  v_add_u32 v15, 49152, v11
  v_add_u32 v16, 49152, v12
  ds_read_b64_tr_b16 a[144:145], v15 offset:0
  ds_read_b64_tr_b16 a[146:147], v15 offset:512
  ds_read_b64_tr_b16 a[148:149], v15 offset:8192
  ds_read_b64_tr_b16 a[150:151], v15 offset:8704
  ds_read_b64_tr_b16 a[152:153], v16 offset:0
  ds_read_b64_tr_b16 a[154:155], v16 offset:512
  ds_read_b64_tr_b16 a[156:157], v16 offset:8192
  ds_read_b64_tr_b16 a[158:159], v16 offset:8704
  s_waitcnt vmcnt(17) lgkmcnt(0)
  s_barrier
  s_add_u32 m0, s57, 131072
  s_add_u32 s54, s79, 74496
  buffer_load_dwordx4 v10, s[28:31], s54 offen  lds
  s_add_u32 m0, s57, 135168
  s_add_u32 s54, s79, 83712
  buffer_load_dwordx4 v10, s[28:31], s54 offen  lds
  s_add_u32 m0, s57, 139264
  s_add_u32 s54, s79, 111360
  buffer_load_dwordx4 v10, s[28:31], s54 offen  lds
  s_add_u32 m0, s57, 143360
  s_add_u32 s54, s79, 120576
  buffer_load_dwordx4 v10, s[28:31], s54 offen  lds
  v_add_u32 v15, 65536, v11
  v_add_u32 v16, 65536, v12
  ds_read_b64_tr_b16 a[160:161], v15 offset:0
  ds_read_b64_tr_b16 a[162:163], v15 offset:512
  ds_read_b64_tr_b16 a[164:165], v15 offset:8192
  ds_read_b64_tr_b16 a[166:167], v15 offset:8704
  ds_read_b64_tr_b16 a[168:169], v16 offset:0
  ds_read_b64_tr_b16 a[170:171], v16 offset:512
  ds_read_b64_tr_b16 a[172:173], v16 offset:8192
  ds_read_b64_tr_b16 a[174:175], v16 offset:8704
  s_waitcnt vmcnt(17) lgkmcnt(0)
  s_barrier
  s_add_u32 m0, s57, 0
  s_add_u32 s54, s78, 0
  buffer_load_dwordx4 v8, s[20:23], s54 offen  lds
  s_add_u32 m0, s57, 4096
  s_add_u32 s54, s78, 131072
  buffer_load_dwordx4 v8, s[20:23], s54 offen  lds
  s_add_u32 m0, s57, 8192
  s_add_u32 s54, s78, 262144
  buffer_load_dwordx4 v8, s[20:23], s54 offen  lds
  s_add_u32 m0, s57, 12288
  s_add_u32 s54, s78, 393216
  buffer_load_dwordx4 v8, s[20:23], s54 offen  lds
  v_add_u32 v15, 81920, v14
  ds_read_b64_tr_b16 a[176:177], v15 offset:0
  ds_read_b64_tr_b16 a[178:179], v15 offset:1024
  ds_read_b64_tr_b16 a[180:181], v15 offset:4096
  ds_read_b64_tr_b16 a[182:183], v15 offset:5120
  ds_read_b64_tr_b16 a[184:185], v15 offset:8192
  ds_read_b64_tr_b16 a[186:187], v15 offset:9216
  ds_read_b64_tr_b16 a[188:189], v15 offset:12288
  ds_read_b64_tr_b16 a[190:191], v15 offset:13312
  s_waitcnt vmcnt(17) lgkmcnt(0)
  s_barrier
  s_add_u32 m0, s57, 16384
  s_add_u32 s54, s78, 524288
  buffer_load_dwordx4 v8, s[20:23], s54 offen  lds
  s_add_u32 m0, s57, 20480
  s_add_u32 s54, s78, 655360
  buffer_load_dwordx4 v8, s[20:23], s54 offen  lds
  s_add_u32 m0, s57, 24576
  s_add_u32 s54, s78, 786432
  buffer_load_dwordx4 v8, s[20:23], s54 offen  lds
  s_add_u32 m0, s57, 28672
  s_add_u32 s54, s78, 917504
  buffer_load_dwordx4 v8, s[20:23], s54 offen  lds
  v_add_u32 v15, 98304, v14
  ds_read_b64_tr_b16 a[192:193], v15 offset:0
  ds_read_b64_tr_b16 a[194:195], v15 offset:1024
  ds_read_b64_tr_b16 a[196:197], v15 offset:4096
  ds_read_b64_tr_b16 a[198:199], v15 offset:5120
  ds_read_b64_tr_b16 a[200:201], v15 offset:8192
  ds_read_b64_tr_b16 a[202:203], v15 offset:9216
  ds_read_b64_tr_b16 a[204:205], v15 offset:12288
  ds_read_b64_tr_b16 a[206:207], v15 offset:13312
  s_waitcnt vmcnt(17) lgkmcnt(0)
  s_barrier
  s_add_u32 m0, s57, 32768
  s_add_u32 s54, s78, 2097152
  buffer_load_dwordx4 v8, s[20:23], s54 offen  lds
  s_add_u32 m0, s57, 36864
  s_add_u32 s54, s78, 2228224
  buffer_load_dwordx4 v8, s[20:23], s54 offen  lds
  s_add_u32 m0, s57, 40960
  s_add_u32 s54, s78, 2359296
  buffer_load_dwordx4 v8, s[20:23], s54 offen  lds
  s_add_u32 m0, s57, 45056
  s_add_u32 s54, s78, 2490368
  buffer_load_dwordx4 v8, s[20:23], s54 offen  lds
  v_add_u32 v15, 114688, v14
  ds_read_b64_tr_b16 a[208:209], v15 offset:0
  ds_read_b64_tr_b16 a[210:211], v15 offset:1024
  ds_read_b64_tr_b16 a[212:213], v15 offset:4096
  ds_read_b64_tr_b16 a[214:215], v15 offset:5120
  ds_read_b64_tr_b16 a[216:217], v15 offset:8192
  ds_read_b64_tr_b16 a[218:219], v15 offset:9216
  ds_read_b64_tr_b16 a[220:221], v15 offset:12288
  ds_read_b64_tr_b16 a[222:223], v15 offset:13312
  s_waitcnt vmcnt(17) lgkmcnt(0)
  s_barrier
  s_add_u32 m0, s57, 49152
  s_add_u32 s54, s78, 3145728
  buffer_load_dwordx4 v8, s[16:19], s54 offen  lds
  s_add_u32 m0, s57, 53248
  s_add_u32 s54, s78, 3276800
  buffer_load_dwordx4 v8, s[16:19], s54 offen  lds
  s_add_u32 m0, s57, 57344
  s_add_u32 s54, s78, 3407872
  buffer_load_dwordx4 v8, s[16:19], s54 offen  lds
  s_add_u32 m0, s57, 61440
  s_add_u32 s54, s78, 3538944
  buffer_load_dwordx4 v8, s[16:19], s54 offen  lds
  v_add_u32 v15, 131072, v14
  ds_read_b64_tr_b16 a[224:225], v15 offset:0
  ds_read_b64_tr_b16 a[226:227], v15 offset:1024
  ds_read_b64_tr_b16 a[228:229], v15 offset:4096
  ds_read_b64_tr_b16 a[230:231], v15 offset:5120
  ds_read_b64_tr_b16 a[232:233], v15 offset:8192
  ds_read_b64_tr_b16 a[234:235], v15 offset:9216
  ds_read_b64_tr_b16 a[236:237], v15 offset:12288
  ds_read_b64_tr_b16 a[238:239], v15 offset:13312
  s_waitcnt vmcnt(16) lgkmcnt(0)
  s_barrier
  s_add_u32 m0, s57, 65536
  s_add_u32 s54, s78, 2621440
  buffer_load_dwordx4 v8, s[20:23], s54 offen  lds
  s_add_u32 m0, s57, 69632
  s_add_u32 s54, s78, 2752512
  buffer_load_dwordx4 v8, s[20:23], s54 offen  lds
  s_add_u32 m0, s57, 73728
  s_add_u32 s54, s78, 2883584
  buffer_load_dwordx4 v8, s[20:23], s54 offen  lds
  s_add_u32 m0, s57, 77824
  s_add_u32 s54, s78, 3014656
  buffer_load_dwordx4 v8, s[20:23], s54 offen  lds
  v_add_u32 v15, 147456, v14
  ds_read_b64_tr_b16 a[240:241], v15 offset:0
  ds_read_b64_tr_b16 a[242:243], v15 offset:1024
  ds_read_b64_tr_b16 a[244:245], v15 offset:4096
  ds_read_b64_tr_b16 a[246:247], v15 offset:5120
  ds_read_b64_tr_b16 a[248:249], v15 offset:8192
  ds_read_b64_tr_b16 a[250:251], v15 offset:9216
  ds_read_b64_tr_b16 a[252:253], v15 offset:12288
  ds_read_b64_tr_b16 a[254:255], v15 offset:13312
  s_waitcnt vmcnt(16) lgkmcnt(0)
  s_barrier
  s_add_u32 m0, s57, 81920
  s_add_u32 s54, s79, 1024
  buffer_load_dwordx4 v9, s[28:31], s54 offen  lds
  s_add_u32 m0, s57, 86016
  s_add_u32 s54, s79, 37888
  buffer_load_dwordx4 v9, s[28:31], s54 offen  lds
  s_add_u32 m0, s57, 90112
  s_add_u32 s54, s79, 74752
  buffer_load_dwordx4 v9, s[28:31], s54 offen  lds
  s_add_u32 m0, s57, 94208
  s_add_u32 s54, s79, 111616
  buffer_load_dwordx4 v9, s[28:31], s54 offen  lds
  v_add_u32 v15, 16384, v11
  v_add_u32 v16, 16384, v12
  ds_read_b64_tr_b16 v[52:53], v15 offset:0
  ds_read_b64_tr_b16 v[54:55], v15 offset:512
  ds_read_b64_tr_b16 v[56:57], v15 offset:8192
  ds_read_b64_tr_b16 v[58:59], v15 offset:8704
  ds_read_b64_tr_b16 v[60:61], v16 offset:0
  ds_read_b64_tr_b16 v[62:63], v16 offset:512
  ds_read_b64_tr_b16 v[64:65], v16 offset:8192
  ds_read_b64_tr_b16 v[66:67], v16 offset:8704
  s_waitcnt vmcnt(16) lgkmcnt(0)
  s_barrier
  s_lshl_b32 s54, s52, 12
  s_add_u32 s54, s54, 16384
  v_add_u32 v7, s54, v76
  ds_write_b128 v7, v[52:55] offset:0
  ds_write_b128 v7, v[56:59] offset:1024
  ds_write_b128 v7, v[60:63] offset:2048
  ds_write_b128 v7, v[64:67] offset:3072
  s_add_u32 m0, s57, 98304
  s_add_u32 s54, s79, 0
  buffer_load_dwordx4 v10, s[28:31], s54 offen  lds
  s_add_u32 m0, s57, 102400
  s_add_u32 s54, s79, 9216
  buffer_load_dwordx4 v10, s[28:31], s54 offen  lds
  s_add_u32 m0, s57, 106496
  s_add_u32 s54, s79, 36864
  buffer_load_dwordx4 v10, s[28:31], s54 offen  lds
  s_add_u32 m0, s57, 110592
  s_add_u32 s54, s79, 46080
  buffer_load_dwordx4 v10, s[28:31], s54 offen  lds
  v_add_u32 v15, 32768, v11
  v_add_u32 v16, 32768, v12
  ds_read_b64_tr_b16 v[36:37], v15 offset:0
  ds_read_b64_tr_b16 v[38:39], v15 offset:512
  ds_read_b64_tr_b16 v[40:41], v15 offset:8192
  ds_read_b64_tr_b16 v[42:43], v15 offset:8704
  ds_read_b64_tr_b16 v[44:45], v16 offset:0
  ds_read_b64_tr_b16 v[46:47], v16 offset:512
  ds_read_b64_tr_b16 v[48:49], v16 offset:8192
  ds_read_b64_tr_b16 v[50:51], v16 offset:8704
  s_waitcnt vmcnt(16) lgkmcnt(0)
  s_barrier
  s_lshl_b32 s54, s52, 12
  s_add_u32 s54, s54, 32768
  v_add_u32 v7, s54, v76
  ds_write_b128 v7, v[36:39] offset:0
  ds_write_b128 v7, v[40:43] offset:1024
  ds_write_b128 v7, v[44:47] offset:2048
  ds_write_b128 v7, v[48:51] offset:3072
  s_add_u32 m0, s57, 114688
  s_add_u32 s54, s79, 73984
  buffer_load_dwordx4 v10, s[28:31], s54 offen  lds
  s_add_u32 m0, s57, 118784
  s_add_u32 s54, s79, 83200
  buffer_load_dwordx4 v10, s[28:31], s54 offen  lds
  s_add_u32 m0, s57, 122880
  s_add_u32 s54, s79, 110848
  buffer_load_dwordx4 v10, s[28:31], s54 offen  lds
  s_add_u32 m0, s57, 126976
  s_add_u32 s54, s79, 120064
  buffer_load_dwordx4 v10, s[28:31], s54 offen  lds
  v_add_u32 v15, 49152, v11
  v_add_u32 v16, 49152, v12
  ds_read_b64_tr_b16 v[52:53], v15 offset:0
  ds_read_b64_tr_b16 v[54:55], v15 offset:512
  ds_read_b64_tr_b16 v[56:57], v15 offset:8192
  ds_read_b64_tr_b16 v[58:59], v15 offset:8704
  ds_read_b64_tr_b16 v[60:61], v16 offset:0
  ds_read_b64_tr_b16 v[62:63], v16 offset:512
  ds_read_b64_tr_b16 v[64:65], v16 offset:8192
  ds_read_b64_tr_b16 v[66:67], v16 offset:8704
  s_waitcnt vmcnt(16) lgkmcnt(0)
  s_barrier
  s_lshl_b32 s54, s52, 12
  s_add_u32 s54, s54, 49152
  v_add_u32 v7, s54, v76
  ds_write_b128 v7, v[52:55] offset:0
  ds_write_b128 v7, v[56:59] offset:1024
  ds_write_b128 v7, v[60:63] offset:2048
  ds_write_b128 v7, v[64:67] offset:3072
  s_add_u32 m0, s57, 131072
  s_add_u32 s54, s79, 74240
  buffer_load_dwordx4 v10, s[28:31], s54 offen  lds
  s_add_u32 m0, s57, 135168
  s_add_u32 s54, s79, 83456
  buffer_load_dwordx4 v10, s[28:31], s54 offen  lds
  s_add_u32 m0, s57, 139264
  s_add_u32 s54, s79, 111104
  buffer_load_dwordx4 v10, s[28:31], s54 offen  lds
  s_add_u32 m0, s57, 143360
  s_add_u32 s54, s79, 120320
  buffer_load_dwordx4 v10, s[28:31], s54 offen  lds
  v_lshlrev_b32 v7, 3, v76
  s_lshl_b32 s54, s52, 13
  s_add_u32 s54, s54, 360448
  s_bitcmp1_b32 s52, 0
  s_cselect_b64 exec, 0xff, -1
  buffer_load_dword v35, v7, s[8:11], s54 offen sc1
  s_mov_b64 exec, -1
  s_getpc_b64 s[80:81]
C_pc:
  s_mov_b32 s55, (L_w0 - C_pc)
  s_cmp_eq_u32 s52, 1
  s_cselect_b32 s55, (L_w1 - C_pc), s55
  s_cmp_eq_u32 s52, 2
  s_cselect_b32 s55, (L_w2 - C_pc), s55
  s_cmp_eq_u32 s52, 3
  s_cselect_b32 s55, (L_w3 - C_pc), s55
  v_lshl_add_u32 v7, v76, 3, s55
  global_load_dword v35, v7, s[80:81]
  v_add_u32 v15, 65536, v11
  v_add_u32 v16, 65536, v12
  ds_read_b64_tr_b16 v[36:37], v15 offset:0
  ds_read_b64_tr_b16 v[38:39], v15 offset:512
  ds_read_b64_tr_b16 v[40:41], v15 offset:8192
  ds_read_b64_tr_b16 v[42:43], v15 offset:8704
  ds_read_b64_tr_b16 v[44:45], v16 offset:0
  ds_read_b64_tr_b16 v[46:47], v16 offset:512
  ds_read_b64_tr_b16 v[48:49], v16 offset:8192
  ds_read_b64_tr_b16 v[50:51], v16 offset:8704
  s_waitcnt vmcnt(18) lgkmcnt(0)
  s_barrier
  s_lshl_b32 s54, s52, 12
  s_add_u32 s54, s54, 65536
  v_add_u32 v7, s54, v76
  ds_write_b128 v7, v[36:39] offset:0
  ds_write_b128 v7, v[40:43] offset:1024
  ds_write_b128 v7, v[44:47] offset:2048
  ds_write_b128 v7, v[48:51] offset:3072
  v_lshrrev_b32 v20, 2, v76
  buffer_load_dword v21, v20, s[12:15], 0 offen sc1
  v_add_u32 v15, 81920, v11
  v_add_u32 v16, 81920, v12
  ds_read_b64_tr_b16 v[52:53], v15 offset:0
  ds_read_b64_tr_b16 v[54:55], v15 offset:512
  ds_read_b64_tr_b16 v[56:57], v15 offset:8192
  ds_read_b64_tr_b16 v[58:59], v15 offset:8704
  ds_read_b64_tr_b16 v[60:61], v16 offset:0
  ds_read_b64_tr_b16 v[62:63], v16 offset:512
  ds_read_b64_tr_b16 v[64:65], v16 offset:8192
  ds_read_b64_tr_b16 v[66:67], v16 offset:8704
  s_waitcnt vmcnt(15) lgkmcnt(0)
  s_barrier
  s_lshl_b32 s54, s52, 12
  s_add_u32 s54, s54, 81920
  v_add_u32 v7, s54, v76
  ds_write_b128 v7, v[52:55] offset:0
  ds_write_b128 v7, v[56:59] offset:1024
  ds_write_b128 v7, v[60:63] offset:2048
  ds_write_b128 v7, v[64:67] offset:3072
  v_add_u32 v15, 98304, v13
  s_waitcnt lgkmcnt(0)
  ds_read_b64_tr_b16 v[36:37], v15 offset:0
  ds_read_b64_tr_b16 v[38:39], v15 offset:1024
  ds_read_b64_tr_b16 v[40:41], v15 offset:2048
  ds_read_b64_tr_b16 v[42:43], v15 offset:3072
  ds_read_b64_tr_b16 v[44:45], v15 offset:4096
  ds_read_b64_tr_b16 v[46:47], v15 offset:5120
  ds_read_b64_tr_b16 v[48:49], v15 offset:6144
  ds_read_b64_tr_b16 v[50:51], v15 offset:7168
  ds_read_b64_tr_b16 v[52:53], v15 offset:8192
  ds_read_b64_tr_b16 v[54:55], v15 offset:9216
  ds_read_b64_tr_b16 v[56:57], v15 offset:10240
  ds_read_b64_tr_b16 v[58:59], v15 offset:11264
  ds_read_b64_tr_b16 v[60:61], v15 offset:12288
  ds_read_b64_tr_b16 v[62:63], v15 offset:13312
  ds_read_b64_tr_b16 v[64:65], v15 offset:14336
  ds_read_b64_tr_b16 v[66:67], v15 offset:15360
  s_waitcnt vmcnt(11) lgkmcnt(0)
  s_barrier
  s_and_b32 s54, s52, 1
  s_lshl_b32 s54, s54, 13
  s_add_u32 s54, s54, 98304
  v_add_u32 v7, s54, v76
  ds_write_b128 v7, v[36:39] offset:0
  ds_write_b128 v7, v[40:43] offset:1024
  ds_write_b128 v7, v[44:47] offset:2048
  ds_write_b128 v7, v[48:51] offset:3072
  ds_write_b128 v7, v[52:55] offset:4096
  ds_write_b128 v7, v[56:59] offset:5120
  ds_write_b128 v7, v[60:63] offset:6144
  ds_write_b128 v7, v[64:67] offset:7168
  v_add_u32 v15, 114688, v14
  ds_read_b64_tr_b16 v[52:53], v15 offset:0
  ds_read_b64_tr_b16 v[54:55], v15 offset:1024
  ds_read_b64_tr_b16 v[56:57], v15 offset:4096
  ds_read_b64_tr_b16 v[58:59], v15 offset:5120
  ds_read_b64_tr_b16 v[60:61], v15 offset:8192
  ds_read_b64_tr_b16 v[62:63], v15 offset:9216
  ds_read_b64_tr_b16 v[64:65], v15 offset:12288
  ds_read_b64_tr_b16 v[66:67], v15 offset:13312
  s_waitcnt vmcnt(7) lgkmcnt(0)
  s_barrier
  s_lshl_b32 s54, s52, 12
  s_add_u32 s54, s54, 114688
  v_add_u32 v7, s54, v76
  ds_write_b128 v7, v[52:55] offset:0
  ds_write_b128 v7, v[56:59] offset:1024
  ds_write_b128 v7, v[60:63] offset:2048
  ds_write_b128 v7, v[64:67] offset:3072
  v_add_u32 v15, 131072, v14
  ds_read_b64_tr_b16 v[36:37], v15 offset:0
  ds_read_b64_tr_b16 v[38:39], v15 offset:1024
  ds_read_b64_tr_b16 v[40:41], v15 offset:4096
  ds_read_b64_tr_b16 v[42:43], v15 offset:5120
  ds_read_b64_tr_b16 v[44:45], v15 offset:8192
  ds_read_b64_tr_b16 v[46:47], v15 offset:9216
  ds_read_b64_tr_b16 v[48:49], v15 offset:12288
  ds_read_b64_tr_b16 v[50:51], v15 offset:13312
  s_waitcnt vmcnt(3) lgkmcnt(0)
  s_barrier
  s_lshl_b32 s54, s52, 12
  s_add_u32 s54, s54, 131072
  v_add_u32 v7, s54, v76
  ds_write_b128 v7, v[36:39] offset:0
  ds_write_b128 v7, v[40:43] offset:1024
  ds_write_b128 v7, v[44:47] offset:2048
  ds_write_b128 v7, v[48:51] offset:3072
  v_add_u32 v15, 147456, v14
  ds_read_b64_tr_b16 v[52:53], v15 offset:0
  ds_read_b64_tr_b16 v[54:55], v15 offset:1024
  ds_read_b64_tr_b16 v[56:57], v15 offset:4096
  ds_read_b64_tr_b16 v[58:59], v15 offset:5120
  ds_read_b64_tr_b16 v[60:61], v15 offset:8192
  ds_read_b64_tr_b16 v[62:63], v15 offset:9216
  ds_read_b64_tr_b16 v[64:65], v15 offset:12288
  ds_read_b64_tr_b16 v[66:67], v15 offset:13312
  s_waitcnt vmcnt(0) lgkmcnt(0)
  s_barrier
  s_lshl_b32 s54, s52, 12
  s_add_u32 s54, s54, 147456
  v_add_u32 v7, s54, v76
  ds_write_b128 v7, v[52:55] offset:0
  ds_write_b128 v7, v[56:59] offset:1024
  ds_write_b128 v7, v[60:63] offset:2048
  ds_write_b128 v7, v[64:67] offset:3072
  s_waitcnt lgkmcnt(0)
  s_branch C_rd1
C_rd0:
  s_sleep 2
  buffer_load_dword v21, v20, s[12:15], 0 offen sc1
  s_waitcnt vmcnt(0)
C_rd1:
  v_and_b32 v22, 0xff, v21
  v_cmp_gt_u32 vcc, 7, v22
  v_readlane_b32 s56, v21, 0
  s_mov_b32 s3, 1
  s_add_u32 s67, s67, 1
  s_cmp_ge_u32 s67, 131072
  s_cbranch_scc1 C_rd2
  s_cmp_lg_u32 vcc_hi, 0
  s_cbranch_scc1 C_rd0
  s_mov_b32 s3, 0
  s_cmp_eq_u32 s56, -1
  s_cbranch_scc1 C_rd2
  s_mov_b32 s3, 1
  v_readlane_b32 s54, v21, 10
  v_readlane_b32 s55, v21, 0
  s_nop 0
  s_bcnt1_i32_b32 s55, s55
  s_add_u32 s54, s54, s55
  v_readlane_b32 s55, v21, 1
  s_nop 0
  s_bcnt1_i32_b32 s55, s55
  s_add_u32 s54, s54, s55
  v_readlane_b32 s55, v21, 2
  s_nop 0
  s_bcnt1_i32_b32 s55, s55
  s_add_u32 s54, s54, s55
  v_readlane_b32 s55, v21, 3
  s_nop 0
  s_bcnt1_i32_b32 s55, s55
  s_add_u32 s54, s54, s55
  v_readlane_b32 s55, v21, 4
  s_nop 0
  s_bcnt1_i32_b32 s55, s55
  s_add_u32 s54, s54, s55
  v_readlane_b32 s55, v21, 5
  s_nop 0
  s_bcnt1_i32_b32 s55, s55
  s_add_u32 s54, s54, s55
  v_readlane_b32 s55, v21, 6
  s_nop 0
  s_bcnt1_i32_b32 s55, s55
  s_add_u32 s54, s54, s55
  v_readlane_b32 s55, v21, 7
  s_nop 0
  s_bcnt1_i32_b32 s55, s55
  s_add_u32 s54, s54, s55
  s_cmp_lt_u32 s54, 256
  s_cbranch_scc1 C_rd0
C_rd2:
  s_lshl_b32 s54, s3, 2
  s_add_u32 s54, s54, s52
  s_cmp_eq_u32 s54, 1
  s_cbranch_scc1 L_w1
  s_cmp_eq_u32 s54, 2
  s_cbranch_scc1 L_w2
  s_cmp_eq_u32 s54, 3
  s_cbranch_scc1 L_w3
  s_cmp_eq_u32 s54, 4
  s_cbranch_scc1 L_w4
  s_cmp_eq_u32 s54, 5
  s_cbranch_scc1 L_w5
  s_cmp_eq_u32 s54, 6
  s_cbranch_scc1 L_w6
  s_cmp_eq_u32 s54, 7
  s_cbranch_scc1 L_w7
L_w0:
  v_mov_b64 v[20:21], 0
  v_mov_b64 v[22:23], 0
  v_mov_b64 v[24:25], 0
  v_mov_b64 v[26:27], 0
  v_mov_b64 v[28:29], 0
  v_mov_b64 v[30:31], 0
  v_mov_b64 v[32:33], 0
  v_mov_b64 v[34:35], 0
  s_mov_b32 s78, 0x3f803f80
  s_mov_b32 s79, s78
  s_mov_b32 s65, 360448
  s_mov_b32 m0, 16128
  s_lshl_b32 s71, s53, 2
  s_add_u32 s71, s71, 128
  s_movk_i32 s56, 0x1000
  v_lshlrev_b32 v73, 2, v76
  v_mov_b32 v72, 0
  s_mov_b64 s[16:17], s[8:9]
  s_mov_b32 s18, 268435456
  s_mov_b32 s19, 0x20000
  s_getpc_b64 s[20:21]
Cf0_pc:
  s_add_u32 s20, s20, (Cf0_last - Cf0_pc)
  s_addc_u32 s21, s21, 0
  v_mov_b32 v68, 14880
  buffer_load_dwordx4 v[52:55], v76, s[8:11], s59 offen offset:0 sc1
  buffer_load_dwordx4 v[56:59], v76, s[8:11], s59 offen offset:1024 sc1
  ds_read_b128 v[36:39], v76 offset:16384
  ds_read_b128 v[40:43], v76 offset:17408
  ds_read_b128 v[60:63], v76 offset:18432
  ds_read_b128 v[64:67], v76 offset:19456
  ds_read_b128 v[0:3], v76 offset:4608
  ds_read_b128 v[4:7], v76 offset:5632
  ds_read_b128 v[8:11], v76 offset:6656
  ds_read_b128 v[12:15], v76 offset:7680
  s_waitcnt lgkmcnt(0)
  s_cmp_eq_u32 s66, 1
  s_branch Cf0_top2
.p2align 6
Cf0_h2:
  s_cmp_eq_u32 s66, 12
  s_cselect_b32 s56, s71, 0x1000
  ds_read_b32 v72, v76 offset:16128
  s_cmp_eq_u32 s66, 13
  s_cselect_b32 s54, 0x700, 0
  s_waitcnt lgkmcnt(0)
  v_readfirstlane_b32 s57, v72
  s_nop 0
  s_cmp_lt_u32 s57, s54
  s_cbranch_scc1 Cf0_kv3
Cf0_kvb:
  buffer_load_dwordx4 v[0:3], v76, s[8:11], s65 offen offset:0 sc1
  ds_read_b128 v[36:39], v76 offset:16384
  s_waitcnt lgkmcnt(0)
  v_mov_b64 v[20:21], 0
  v_mov_b64 v[22:23], 0
  v_mov_b64 v[24:25], 0
  v_mov_b64 v[26:27], 0
  v_mov_b32 v68, 14880
  buffer_load_dwordx4 v[0:3], v76, s[8:11], s65 offen offset:0 sc1
  ds_read_b128 v[40:43], v76 offset:17408
  s_waitcnt lgkmcnt(0)
  v_mov_b64 v[28:29], 0
  v_mov_b64 v[30:31], 0
  v_mov_b64 v[32:33], 0
  v_mov_b64 v[34:35], 0
  v_lshlrev_b32 v73, 2, v76
  buffer_load_dwordx4 v[0:3], v76, s[8:11], s65 offen offset:0 sc1
  ds_read_b128 v[60:63], v76 offset:18432
  s_waitcnt lgkmcnt(0)
  buffer_load_dwordx4 v[52:55], v76, s[8:11], s59 offen offset:0 sc1
  buffer_load_dwordx4 v[56:59], v76, s[8:11], s59 offen offset:1024 sc1
  s_waitcnt vmcnt(4)
  v_max3_u32 v72, v0, v1, v2
  v_max_u32 v72, v72, v3
  ds_write_b128 v76, v[0:3] offset:4608
  v_cmp_eq_u32 vcc, -1, v72
  s_cbranch_vccnz Cf0_h2r
Cf0_h2w:
  s_cmp_eq_u32 s66, 63
  s_waitcnt lgkmcnt(0)
  s_barrier
  ds_read_b128 v[8:11], v76 offset:6656
  buffer_load_dwordx4 v76, s[8:11], s85 offen offset:0 sc1 lds
Cf0_top2:
  v_smfmac_f32_16x16x64_bf16 v[20:23], v[0:3], v[80:87], v74
  s_cbranch_scc1 Cf0_last
  v_smfmac_f32_16x16x64_bf16 v[28:31], v[0:3], v[36:43], v74
  buffer_load_dwordx4 v[44:47], v76, s[8:11], s58 offen offset:0 sc1
  s_mov_b32 m0, 16128
  v_smfmac_f32_16x16x64_bf16 v[24:27], v[0:3], v[88:95], v74
  buffer_load_dwordx4 v[48:51], v76, s[8:11], s58 offen offset:1024 sc1
  v_smfmac_f32_16x16x64_bf16 v[32:35], v[0:3], v[60:67], v74
  ds_read_b128 v[4:7], v76 offset:5632
  s_waitcnt lgkmcnt(1)
  v_smfmac_f32_16x16x64_bf16 v[20:23], v[8:11], v[112:119], v74
  ds_read_b128 v[12:15], v76 offset:7680
  v_smfmac_f32_16x16x64_bf16 v[24:27], v[8:11], v[120:127], v74
  ds_read_b128 v[36:39], v76 offset:32768
  v_smfmac_f32_16x16x64_bf16 v[28:31], v[8:11], v[208:215], v74
  buffer_store_dwordx4 v[16:19], v76, s[8:11], s68 offen sc1
  ds_read_b128 v[40:43], v76 offset:33792
  v_smfmac_f32_16x16x64_bf16 v[32:35], v[8:11], v[216:223], v74
  buffer_load_dword v73, s[16:19], s70 offen lds
  ds_read_b128 v[60:63], v76 offset:34816
  s_waitcnt lgkmcnt(4)
  v_smfmac_f32_16x16x64_bf16 v[20:23], v[4:7], v[96:103], v74
  ds_read_b128 v[64:67], v76 offset:35840
  v_smfmac_f32_16x16x64_bf16 v[24:27], v[4:7], v[104:111], v74
  s_waitcnt vmcnt(5)
  s_waitcnt lgkmcnt(4)
  v_smfmac_f32_16x16x64_bf16 v[20:23], v[12:15], v[128:135], v74
  s_barrier
  ds_read_b128 v[0:3], v76 offset:8704
  s_waitcnt lgkmcnt(3)
  v_smfmac_f32_16x16x64_bf16 v[28:31], v[4:7], v[36:43], v74
  ds_read_b128 v[36:39], v76 offset:49152
  v_smfmac_f32_16x16x64_bf16 v[24:27], v[12:15], v[136:143], v74
  ds_read_b128 v[40:43], v76 offset:50176
  s_waitcnt lgkmcnt(3)
  v_smfmac_f32_16x16x64_bf16 v[32:35], v[4:7], v[60:67], v74
  ds_read_b128 v[8:11], v76 offset:9728
  v_smfmac_f32_16x16x64_bf16 v[28:31], v[12:15], v[224:231], v74
  ds_read_b128 v[60:63], v76 offset:51200
  v_smfmac_f32_16x16x64_bf16 v[32:35], v[12:15], v[232:239], v74
  s_waitcnt vmcnt(4)
  ds_read_b128 v[64:67], v76 offset:52224
  s_waitcnt lgkmcnt(5)
  v_smfmac_f32_16x16x64_bf16 v[20:23], v[0:3], v[144:151], v74
  s_barrier
  ds_read_b128 v[4:7], v76 offset:11776
  s_waitcnt lgkmcnt(4)
  v_smfmac_f32_16x16x64_bf16 v[28:31], v[0:3], v[36:43], v74
  ds_read_b128 v[12:15], v76 offset:12800
  ds_read_b128 v[36:39], v75 offset:0
  v_smfmac_f32_16x16x64_bf16 v[24:27], v[0:3], v[152:159], v74
  ds_read_b128 v[16:19], v76 offset:10752
  s_waitcnt lgkmcnt(6)
  v_smfmac_f32_16x16x64_bf16 v[20:23], v[8:11], v[160:167], v74
  ds_read_b128 v[40:43], v75 offset:1024
  s_waitcnt lgkmcnt(5)
  v_smfmac_f32_16x16x64_bf16 v[32:35], v[0:3], v[60:67], v74
  ds_read_b128 v[60:63], v75 offset:2048
  v_smfmac_f32_16x16x64_bf16 v[24:27], v[8:11], v[168:175], v74
  ds_read_b128 v[64:67], v75 offset:3072
  s_waitcnt lgkmcnt(6)
  v_smfmac_f32_16x16x64_bf16 v[20:23], v[4:7], v[176:183], v74
  buffer_load_dword off, s[12:15], s56 sc1 lds
  s_waitcnt lgkmcnt(5)
  v_smfmac_f32_16x16x64_bf16 v[20:23], v[12:15], v[192:199], v74
  s_waitcnt lgkmcnt(2)
  v_smfmac_f32_16x16x64_bf16 v[20:23], v[16:19], v[36:43], v74
  ds_read_b128 v[36:39], v75 offset:16384
  v_smfmac_f32_16x16x64_bf16 v[24:27], v[4:7], v[184:191], v74
  ds_read_b128 v[40:43], v75 offset:17408
  s_waitcnt lgkmcnt(2)
  v_smfmac_f32_16x16x64_bf16 v[24:27], v[16:19], v[60:67], v74
  ds_read_b128 v[60:63], v75 offset:18432
  v_add_f32 v20, v20, v22
  v_smfmac_f32_16x16x64_bf16 v[24:27], v[12:15], v[200:207], v74
  ds_read_b128 v[64:67], v75 offset:19456
  v_add_f32 v21, v21, v23
  v_smfmac_f32_16x16x64_bf16 v[28:31], v[16:19], v[240:247], v74
  v_mov_b64 v[70:71], s[78:79]
  v_smfmac_f32_16x16x64_bf16 v[28:31], v[4:7], a[0:7], v74
  s_waitcnt lgkmcnt(2)
  v_add_f32 v24, v24, v26
  v_smfmac_f32_16x16x64_bf16 v[28:31], v[8:11], v[36:43], v74
  ds_read_b128 v[36:39], v68
  v_cvt_pk_bf16_f32 v22, v20, v24
  v_smfmac_f32_16x16x64_bf16 v[28:31], v[12:15], a[16:23], v74
  ds_read_b128 v[40:43], v68
  ds_write_b32 v79, v22 offset:0
  s_waitcnt lgkmcnt(3)
  v_add_f32 v25, v25, v27
  v_cvt_pk_bf16_f32 v23, v21, v25
  v_smfmac_f32_16x16x64_bf16 v[32:35], v[8:11], v[60:67], v74
  ds_write_b32 v79, v23 offset:576
  v_cmp_u_f32 vcc, v20, v21
  v_smfmac_f32_16x16x64_bf16 v[32:35], v[16:19], v[248:255], v74
  v_add_f32 v28, v28, v30
  v_smfmac_f32_16x16x64_bf16 v[32:35], v[4:7], a[8:15], v74
  v_add_f32 v29, v29, v31
  v_smfmac_f32_16x16x64_bf16 v[32:35], v[12:15], a[24:31], v74
  s_cbranch_vccnz Cf0_rec
Cf0_recok:
  s_waitcnt lgkmcnt(3)
  v_smfmac_f32_16x16x64_bf16 v[36:39], v[16:19], a[128:135], v74
  s_waitcnt lgkmcnt(0)
  s_barrier
  ds_read_b128 v[60:63], v77
  v_smfmac_f32_16x16x64_bf16 v[40:43], v[16:19], a[136:143], v74
  ds_read_b128 v[64:67], v77 offset:128
  v_add_f32 v32, v32, v34
  v_cvt_pk_bf16_f32 v30, v28, v32
  v_smfmac_f32_16x16x64_bf16 v[36:39], v[0:3], a[96:103], v74
  ds_write_b32 v79, v30 offset:256
  v_add_f32 v33, v33, v35
  v_cvt_pk_bf16_f32 v31, v29, v33
  v_smfmac_f32_16x16x64_bf16 v[40:43], v[0:3], a[104:111], v74
  ds_write_b32 v79, v31 offset:832
  v_xor_b32 v75, 0x8000, v75
  v_smfmac_f32_16x16x64_bf16 v[36:39], v[4:7], a[144:151], v74
  ds_read_b128 v[0:3], v76 offset:4608
  v_mov_b32 v29, 0
  v_smfmac_f32_16x16x64_bf16 v[40:43], v[4:7], a[152:159], v74
  s_waitcnt vmcnt(3) lgkmcnt(3)
  v_mov_b32 v30, 0
  v_mfma_f32_16x16x32_bf16 v[44:47], v[44:47], v[60:63], 0
  ds_read_b128 v[4:7], v76 offset:5632
  s_waitcnt lgkmcnt(2)
  v_mfma_f32_16x16x32_bf16 v[44:47], v[48:51], v[64:67], v[44:47]
  s_barrier
  v_smfmac_f32_16x16x64_bf16 v[36:39], v[8:11], a[112:119], v74
  ds_read_b128 v[20:23], v77 offset:256
  ds_read_b128 v[24:27], v77 offset:384
  v_smfmac_f32_16x16x64_bf16 v[40:43], v[8:11], a[120:127], v74
  ds_read_b128 v[8:11], v76 offset:6656
  v_add_f32_dpp v72, v46, v44 quad_perm:[2,3,0,1] row_mask:0xf bank_mask:0xf
  v_add_f32_dpp v73, v47, v45 quad_perm:[2,3,0,1] row_mask:0xf bank_mask:0xf
  v_smfmac_f32_16x16x64_bf16 v[36:39], v[12:15], a[160:167], v74
  s_waitcnt lgkmcnt(4)
  v_exp_f32_dpp v72, v72 quad_perm:[0,1,0,1] row_mask:0xf bank_mask:0xf
  v_smfmac_f32_16x16x64_bf16 v[40:43], v[12:15], a[168:175], v74
  ds_read_b128 v[12:15], v76 offset:7680
  v_exp_f32_dpp v73, v73 quad_perm:[0,1,0,1] row_mask:0xf bank_mask:0xf
  v_smfmac_f32_16x16x64_bf16 v[36:39], v[0:3], a[32:39], v74
  s_waitcnt lgkmcnt(2)
  v_cvt_pk_bf16_f32 v72, v72, v73
  v_mfma_f32_16x16x32_bf16 v[20:23], v[20:23], v[60:63], 0
  ds_write_b32 v78, v72 offset:512
  v_mov_b64 v[16:17], 0
  v_mfma_f32_16x16x32_bf16 v[20:23], v[24:27], v[64:67], v[20:23]
  ds_read_b128 v[44:47], v75 offset:16384
  v_mov_b64 v[18:19], 0
  v_smfmac_f32_16x16x64_bf16 v[40:43], v[0:3], a[40:47], v74
  ds_read_b128 v[48:51], v75 offset:17408
  v_mov_b64 v[68:69], s[78:79]
  v_smfmac_f32_16x16x64_bf16 v[36:39], v[4:7], a[48:55], v74
  s_waitcnt lgkmcnt(4)
  v_add_f32_dpp v24, v22, v20 quad_perm:[2,3,0,1] row_mask:0xf bank_mask:0xf
  v_add_f32_dpp v25, v23, v21 quad_perm:[2,3,0,1] row_mask:0xf bank_mask:0xf
  v_smfmac_f32_16x16x64_bf16 v[36:39], v[8:11], a[64:71], v74
  s_waitcnt lgkmcnt(2)
  s_barrier
  ds_read_b128 v[32:35], v78 offset:512
  v_smfmac_f32_16x16x64_bf16 v[36:39], v[12:15], a[80:87], v74
  ds_read_b128 v[60:63], v75 offset:18432
  v_mul_f32 v24, s69, v24
  v_smfmac_f32_16x16x64_bf16 v[40:43], v[4:7], a[56:63], v74
  ds_read_b128 v[64:67], v75 offset:19456
  v_mul_f32 v25, s69, v25
  v_smfmac_f32_16x16x64_bf16 v[40:43], v[8:11], a[72:79], v74
  v_exp_f32_dpp v24, v24 quad_perm:[0,1,0,1] row_mask:0xf bank_mask:0xf
  v_smfmac_f32_16x16x64_bf16 v[40:43], v[12:15], a[88:95], v74
  s_waitcnt lgkmcnt(2)
  v_exp_f32_dpp v25, v25 quad_perm:[0,1,0,1] row_mask:0xf bank_mask:0xf
  v_mfma_f32_16x16x32_bf16 v[8:11], v[32:35], v[68:71], 0
  v_add_f32 v36, v36, v38
  v_add_f32 v37, v37, v39
  v_mfma_f32_16x16x32_bf16 v[0:3], v[32:35], v[52:55], 0
  v_add_f32 v40, v40, v42
  v_add_f32 v41, v41, v43
  v_mfma_f32_16x16x32_bf16 v[4:7], v[32:35], v[56:59], 0
  v_cvt_pk_bf16_f32 v28, v24, v25
  v_cvt_pk_bf16_f32 v72, v36, v37
  v_cvt_pk_bf16_f32 v73, v40, v41
  v_mfma_f32_16x16x16_bf16 v[8:11], v[28:29], v[68:69], v[8:11]
  v_cvt_pk_bf16_f32 v31, v24, v25
  v_mov_b64 v[20:21], 0
  v_mfma_f32_16x16x16_bf16 v[0:3], v[28:29], v[72:73], v[0:3]
  ds_read_b128 v[68:71], v76 offset:13824
  v_mov_b64 v[22:23], 0
  v_mfma_f32_16x16x16_bf16 v[4:7], v[30:31], v[72:73], v[4:7]
  v_rcp_f32 v10, v8
  v_rcp_f32 v11, v9
  v_mul_f32 v0, v10, v0
  v_mul_f32 v1, v11, v1
  s_nop 0
  v_mul_f32 v4, v10, v4
  v_mul_f32 v5, v11, v5
  v_cvt_pk_bf16_f32 v2, v0, v4
  ds_write_b32 v79, v2 offset:8704
  v_cvt_pk_bf16_f32 v3, v1, v5
  ds_write_b32 v79, v3 offset:9280
  v_max3_f32 v8, v8, v9, v10
  v_max_f32 v8, v8, v11
  v_cmp_le_f32 vcc, 1317011456, v8
  v_mov_b64 v[24:25], 0
  v_mov_b64 v[26:27], 0
  s_cbranch_vccnz Cf0_mx
Cf0_mxok:
  s_waitcnt lgkmcnt(0)
  s_barrier
  ds_read_b128 v[0:3], v78 offset:8704
  ds_read_b128 v[4:7], v78 offset:8768
  ds_read_b128 v[8:11], v78 offset:8832
  ds_read_b128 v[12:15], v78 offset:8896
  s_waitcnt lgkmcnt(3)
  v_smfmac_f32_16x16x64_bf16 v[16:19], v[0:3], v[44:51], v74
  ds_read_b128 v[52:55], v75 offset:32768
  s_waitcnt lgkmcnt(3)
  v_smfmac_f32_16x16x64_bf16 v[16:19], v[4:7], v[60:67], v74
  ds_read_b128 v[56:59], v75 offset:33792
  s_waitcnt lgkmcnt(3)
  v_smfmac_f32_16x16x64_bf16 v[16:19], v[8:11], a[176:183], v74
  ds_read_b128 v[36:39], v75 offset:34816
  s_waitcnt lgkmcnt(3)
  v_smfmac_f32_16x16x64_bf16 v[16:19], v[12:15], a[184:191], v74
  ds_read_b128 v[40:43], v75 offset:35840
  ds_read_b128 v[44:47], v75 offset:49152
  v_smfmac_f32_16x16x64_bf16 v[20:23], v[0:3], a[192:199], v74
  ds_read_b128 v[48:51], v75 offset:50176
  ds_read_b128 v[60:63], v75 offset:51200
  v_smfmac_f32_16x16x64_bf16 v[20:23], v[4:7], a[200:207], v74
  ds_read_b128 v[64:67], v75 offset:52224
  s_waitcnt lgkmcnt(6)
  v_cvt_pk_bf16_f32 v16, v16, v17
  v_cvt_pk_bf16_f32 v17, v18, v19
  v_bfi_b32 v16, 1, s72, v16
  v_smfmac_f32_16x16x64_bf16 v[20:23], v[8:11], v[52:59], v74
  buffer_store_dwordx2 v[16:17], v68, s[8:11], s73 offen
  s_waitcnt lgkmcnt(4)
  v_smfmac_f32_16x16x64_bf16 v[20:23], v[12:15], v[36:43], v74
  v_mov_b64 v[32:33], 0
  v_smfmac_f32_16x16x64_bf16 v[24:27], v[0:3], a[208:215], v74
  v_mov_b64 v[34:35], 0
  v_smfmac_f32_16x16x64_bf16 v[24:27], v[4:7], a[216:223], v74
  s_waitcnt lgkmcnt(2)
  v_cvt_pk_bf16_f32 v20, v20, v21
  v_cvt_pk_bf16_f32 v21, v22, v23
  v_bfi_b32 v20, 1, s72, v20
  v_smfmac_f32_16x16x64_bf16 v[24:27], v[8:11], v[44:51], v74
  buffer_store_dwordx2 v[20:21], v68, s[8:11], s74 offen
  s_waitcnt lgkmcnt(0)
  v_smfmac_f32_16x16x64_bf16 v[24:27], v[12:15], v[60:67], v74
  v_smfmac_f32_16x16x64_bf16 v[32:35], v[0:3], a[224:231], v74
  v_smfmac_f32_16x16x64_bf16 v[32:35], v[4:7], a[232:239], v74
  v_cvt_pk_bf16_f32 v24, v24, v25
  v_cvt_pk_bf16_f32 v25, v26, v27
  v_bfi_b32 v24, 1, s72, v24
  v_smfmac_f32_16x16x64_bf16 v[32:35], v[8:11], a[240:247], v74
  buffer_store_dwordx2 v[24:25], v68, s[8:11], s75 offen
  v_smfmac_f32_16x16x64_bf16 v[32:35], v[12:15], a[248:255], v74
  v_mov_b64 v[18:19], v[72:73]
  s_nop 4
  v_cvt_pk_bf16_f32 v32, v32, v33
  v_cvt_pk_bf16_f32 v33, v34, v35
  v_bfi_b32 v32, 1, s72, v32
  buffer_store_dwordx2 v[32:33], v68, s[8:11], s76 offen
  ds_read_b128 v[0:3], v76 offset:14848
  s_waitcnt lgkmcnt(0)
  ds_read_b64 v[16:17], v77 offset:256
  s_waitcnt lgkmcnt(0)
  ds_read_b128 v[64:67], v76 offset:19456
  s_waitcnt lgkmcnt(0)
  v_xor_b32 v75, 0x8000, v75
  buffer_load_dwordx4 v[52:55], v76, s[8:11], s60 offen offset:0 sc1
  buffer_load_dwordx4 v[56:59], v76, s[8:11], s60 offen offset:1024 sc1
  s_add_u32 s66, s66, 1
  s_xor_b32 s64, s64, 16384
  s_xor_b32 s65, s65, 16384
  s_add_u32 s58, s58, 655360
  s_add_u32 s59, s59, 655360
  s_add_u32 s70, s70, 655360
  s_add_u32 s68, s68, 655360
  s_mov_b32 m0, 10752
  s_add_u32 s85, s65, 6144
  s_cmp_eq_u32 s66, 62
  s_cselect_b64 s[16:17], s[20:21], s[16:17]
  s_cselect_b32 s18, (Cf0_done - Cf0_last), s18
  s_cselect_b32 s70, 0, s70
  s_cmp_eq_u32 s66, 63
  s_cselect_b32 s59, 268435456, s59
  s_cselect_b32 s58, 268435456, s58
  s_waitcnt lgkmcnt(0)
  s_waitcnt vmcnt(1)
  v_mfma_f32_16x16x32_bf16 v[4:7], v[0:3], v[52:55], 0
  v_bitop3_b32 v72, v52, v54, s72 bitop3:0x7e
  s_waitcnt vmcnt(0)
  v_mfma_f32_16x16x32_bf16 v[4:7], v[0:3], v[56:59], v[4:7]
  v_bitop3_b32 v73, v56, v58, s72 bitop3:0x7e
  v_bitop3_b32 v72, v72, v73, 1 bitop3:0xa8
  v_cmp_ne_u32 vcc, 0, v72
  s_nop 3
  v_add_f32_dpp v4, v4, v4 row_ror:4 row_mask:0xf bank_mask:0xf
  v_add_f32_dpp v5, v5, v5 row_ror:4 row_mask:0xf bank_mask:0xf
  s_cmp_eq_u64 vcc, 0
  v_add_f32_dpp v4, v4, v4 row_ror:8 row_mask:0xf bank_mask:0xf
  v_add_f32_dpp v5, v5, v5 row_ror:8 row_mask:0xf bank_mask:0xf
  s_cselect_b32 s54, s62, 268435456
  v_cvt_pk_bf16_f32 v4, v4, v5
  buffer_store_dword v4, v69, s[8:11], s54 offen
  s_cbranch_vccnz Cf0_h1r
  s_xor_b32 s62, s62, 16384
  buffer_store_dword v71, v69, s[8:11], s62 offen
  s_xor_b32 s72, s72, 1
  s_branch Cf0_h2
Cf0_h1r:
  s_mov_b64 exec, vcc
  buffer_load_dwordx4 v[52:55], v76, s[8:11], s60 offen offset:0 sc1
  buffer_load_dwordx4 v[56:59], v76, s[8:11], s60 offen offset:1024 sc1
  s_mov_b64 exec, -1
  s_add_u32 s67, s67, 1
  s_waitcnt vmcnt(1)
  v_mfma_f32_16x16x32_bf16 v[4:7], v[0:3], v[52:55], 0
  v_bitop3_b32 v72, v52, v54, s72 bitop3:0x7e
  s_waitcnt vmcnt(0)
  v_mfma_f32_16x16x32_bf16 v[4:7], v[0:3], v[56:59], v[4:7]
  v_bitop3_b32 v73, v56, v58, s72 bitop3:0x7e
  v_bitop3_b32 v72, v72, v73, 1 bitop3:0xa8
  v_cmp_ne_u32 vcc, 0, v72
  s_cbranch_vccz Cf0_h1p
Cf0_h1s:
  s_mov_b64 exec, vcc
  buffer_load_dwordx4 v[52:55], v76, s[8:11], s60 offen offset:0 sc1
  buffer_load_dwordx4 v[56:59], v76, s[8:11], s60 offen offset:1024 sc1
  s_mov_b64 exec, -1
  s_add_u32 s67, s67, 1
  s_waitcnt vmcnt(1)
  v_mfma_f32_16x16x32_bf16 v[4:7], v[0:3], v[52:55], 0
  v_bitop3_b32 v72, v52, v54, s72 bitop3:0x7e
  s_waitcnt vmcnt(0)
  v_mfma_f32_16x16x32_bf16 v[4:7], v[0:3], v[56:59], v[4:7]
  v_bitop3_b32 v73, v56, v58, s72 bitop3:0x7e
  v_bitop3_b32 v72, v72, v73, 1 bitop3:0xa8
  v_cmp_ne_u32 vcc, 0, v72
  s_cbranch_vccz Cf0_h1p
  s_cmp_lt_u32 s67, 131072
  s_cbranch_scc1 Cf0_h1s
Cf0_h1p:
  s_nop 2
  v_add_f32_dpp v4, v4, v4 row_ror:4 row_mask:0xf bank_mask:0xf
  v_add_f32_dpp v5, v5, v5 row_ror:4 row_mask:0xf bank_mask:0xf
  s_nop 0
  v_add_f32_dpp v4, v4, v4 row_ror:8 row_mask:0xf bank_mask:0xf
  v_add_f32_dpp v5, v5, v5 row_ror:8 row_mask:0xf bank_mask:0xf
  v_cvt_pk_bf16_f32 v4, v4, v5
  buffer_store_dword v4, v69, s[8:11], s62 offen
  s_xor_b32 s62, s62, 16384
  buffer_store_dword v71, v69, s[8:11], s62 offen
  s_xor_b32 s72, s72, 1
  s_branch Cf0_h2
Cf0_h2r:
  s_mov_b64 exec, vcc
  buffer_load_dwordx4 v[0:3], v76, s[8:11], s65 offen offset:0 sc1
  s_mov_b64 exec, -1
  s_add_u32 s67, s67, 1
  s_waitcnt vmcnt(4)
  v_max3_u32 v72, v0, v1, v2
  v_max_u32 v72, v72, v3
  ds_write_b128 v76, v[0:3] offset:4608
  v_cmp_eq_u32 vcc, -1, v72
  s_cbranch_vccz Cf0_h2w
  s_mov_b64 exec, vcc
  buffer_load_dwordx4 v[0:3], v76, s[8:11], s65 offen offset:0 sc1
  s_mov_b64 exec, -1
  s_add_u32 s67, s67, 1
  s_waitcnt vmcnt(4)
  v_max3_u32 v72, v0, v1, v2
  v_max_u32 v72, v72, v3
  ds_write_b128 v76, v[0:3] offset:4608
  v_cmp_eq_u32 vcc, -1, v72
  s_cbranch_vccz Cf0_h2w
Cf0_h2s:
  s_mov_b64 exec, vcc
  buffer_load_dwordx4 v[0:3], v76, s[8:11], s65 offen offset:0 sc1
  s_mov_b64 exec, -1
  s_add_u32 s67, s67, 1
  s_waitcnt vmcnt(2)
  v_max3_u32 v72, v0, v1, v2
  v_max_u32 v72, v72, v3
  ds_write_b128 v76, v[0:3] offset:4608
  v_cmp_eq_u32 vcc, -1, v72
  s_cbranch_vccz Cf0_h2w
  s_mov_b64 exec, vcc
  buffer_load_dwordx4 v[0:3], v76, s[8:11], s65 offen offset:0 sc1
  s_mov_b64 exec, -1
  s_add_u32 s67, s67, 1
  s_waitcnt vmcnt(2)
  v_max3_u32 v72, v0, v1, v2
  v_max_u32 v72, v72, v3
  ds_write_b128 v76, v[0:3] offset:4608
  v_cmp_eq_u32 vcc, -1, v72
  s_cbranch_vccz Cf0_h2w
  s_mov_b64 exec, vcc
  buffer_load_dwordx4 v[0:3], v76, s[8:11], s65 offen offset:0 sc1
  s_mov_b64 exec, -1
  s_add_u32 s67, s67, 1
  s_waitcnt vmcnt(2)
  v_max3_u32 v72, v0, v1, v2
  v_max_u32 v72, v72, v3
  ds_write_b128 v76, v[0:3] offset:4608
  v_cmp_eq_u32 vcc, -1, v72
  s_cbranch_vccz Cf0_h2w
  s_cmp_lt_u32 s67, 131072
  s_cbranch_scc1 Cf0_h2s
  s_branch Cf0_h2w
Cf0_rec:
  s_nop 7
  s_waitcnt vmcnt(0) lgkmcnt(0)
  v_max3_u32 v72, v0, v1, v2
  v_max3_u32 v72, v72, v3, v4
  v_max3_u32 v72, v72, v5, v6
  v_max3_u32 v72, v72, v7, v8
  v_max3_u32 v72, v72, v9, v10
  v_max3_u32 v72, v72, v11, v12
  v_max3_u32 v72, v72, v13, v14
  v_max3_u32 v72, v72, v15, v16
  v_max3_u32 v72, v72, v17, v18
  v_max_u32 v72, v72, v19
  v_cmp_eq_u32 vcc, -1, v72
  s_cbranch_vccz Cf0_recok
  s_barrier
  v_mov_b64 v[20:21], 0
  v_mov_b64 v[22:23], 0
  v_mov_b64 v[24:25], 0
  v_mov_b64 v[26:27], 0
  v_mov_b64 v[28:29], 0
  v_mov_b64 v[30:31], 0
  v_mov_b64 v[32:33], 0
  v_mov_b64 v[34:35], 0
  s_waitcnt lgkmcnt(0)
  s_barrier
  ds_read_b128 v[0:3], v76 offset:4608
  s_waitcnt lgkmcnt(0)
  v_smfmac_f32_16x16x64_bf16 v[20:23], v[0:3], v[80:87], v74
  v_smfmac_f32_16x16x64_bf16 v[24:27], v[0:3], v[88:95], v74
  ds_read_b128 v[60:63], v76 offset:16384
  ds_read_b128 v[64:67], v76 offset:17408
  s_waitcnt lgkmcnt(0)
  v_smfmac_f32_16x16x64_bf16 v[28:31], v[0:3], v[60:67], v74
  ds_read_b128 v[60:63], v76 offset:18432
  ds_read_b128 v[64:67], v76 offset:19456
  s_waitcnt lgkmcnt(0)
  v_smfmac_f32_16x16x64_bf16 v[32:35], v[0:3], v[60:67], v74
  ds_read_b128 v[4:7], v76 offset:5632
  s_waitcnt lgkmcnt(0)
  v_smfmac_f32_16x16x64_bf16 v[20:23], v[4:7], v[96:103], v74
  v_smfmac_f32_16x16x64_bf16 v[24:27], v[4:7], v[104:111], v74
  ds_read_b128 v[60:63], v76 offset:32768
  ds_read_b128 v[64:67], v76 offset:33792
  s_waitcnt lgkmcnt(0)
  v_smfmac_f32_16x16x64_bf16 v[28:31], v[4:7], v[60:67], v74
  ds_read_b128 v[60:63], v76 offset:34816
  ds_read_b128 v[64:67], v76 offset:35840
  s_waitcnt lgkmcnt(0)
  v_smfmac_f32_16x16x64_bf16 v[32:35], v[4:7], v[60:67], v74
  ds_read_b128 v[8:11], v76 offset:6656
  s_waitcnt lgkmcnt(0)
  v_smfmac_f32_16x16x64_bf16 v[20:23], v[8:11], v[112:119], v74
  v_smfmac_f32_16x16x64_bf16 v[24:27], v[8:11], v[120:127], v74
  v_smfmac_f32_16x16x64_bf16 v[28:31], v[8:11], v[208:215], v74
  v_smfmac_f32_16x16x64_bf16 v[32:35], v[8:11], v[216:223], v74
  ds_read_b128 v[12:15], v76 offset:7680
  s_waitcnt lgkmcnt(0)
  v_smfmac_f32_16x16x64_bf16 v[20:23], v[12:15], v[128:135], v74
  v_smfmac_f32_16x16x64_bf16 v[24:27], v[12:15], v[136:143], v74
  v_smfmac_f32_16x16x64_bf16 v[28:31], v[12:15], v[224:231], v74
  v_smfmac_f32_16x16x64_bf16 v[32:35], v[12:15], v[232:239], v74
  ds_read_b128 v[0:3], v76 offset:8704
  s_waitcnt lgkmcnt(0)
  v_smfmac_f32_16x16x64_bf16 v[20:23], v[0:3], v[144:151], v74
  v_smfmac_f32_16x16x64_bf16 v[24:27], v[0:3], v[152:159], v74
  ds_read_b128 v[60:63], v76 offset:49152
  ds_read_b128 v[64:67], v76 offset:50176
  s_waitcnt lgkmcnt(0)
  v_smfmac_f32_16x16x64_bf16 v[28:31], v[0:3], v[60:67], v74
  ds_read_b128 v[60:63], v76 offset:51200
  ds_read_b128 v[64:67], v76 offset:52224
  s_waitcnt lgkmcnt(0)
  v_smfmac_f32_16x16x64_bf16 v[32:35], v[0:3], v[60:67], v74
  ds_read_b128 v[8:11], v76 offset:9728
  s_waitcnt lgkmcnt(0)
  v_smfmac_f32_16x16x64_bf16 v[20:23], v[8:11], v[160:167], v74
  v_smfmac_f32_16x16x64_bf16 v[24:27], v[8:11], v[168:175], v74
  ds_read_b128 v[60:63], v75 offset:16384
  ds_read_b128 v[64:67], v75 offset:17408
  s_waitcnt lgkmcnt(0)
  v_smfmac_f32_16x16x64_bf16 v[28:31], v[8:11], v[60:67], v74
  ds_read_b128 v[60:63], v75 offset:18432
  ds_read_b128 v[64:67], v75 offset:19456
  s_waitcnt lgkmcnt(0)
  v_smfmac_f32_16x16x64_bf16 v[32:35], v[8:11], v[60:67], v74
  ds_read_b128 v[16:19], v76 offset:10752
  ds_read_b128 v[60:63], v75 offset:0
  ds_read_b128 v[64:67], v75 offset:1024
  s_waitcnt lgkmcnt(0)
  v_smfmac_f32_16x16x64_bf16 v[20:23], v[16:19], v[60:67], v74
  ds_read_b128 v[60:63], v75 offset:2048
  ds_read_b128 v[64:67], v75 offset:3072
  s_waitcnt lgkmcnt(0)
  v_smfmac_f32_16x16x64_bf16 v[24:27], v[16:19], v[60:67], v74
  v_smfmac_f32_16x16x64_bf16 v[28:31], v[16:19], v[240:247], v74
  v_smfmac_f32_16x16x64_bf16 v[32:35], v[16:19], v[248:255], v74
  ds_read_b128 v[4:7], v76 offset:11776
  s_waitcnt lgkmcnt(0)
  v_smfmac_f32_16x16x64_bf16 v[20:23], v[4:7], v[176:183], v74
  v_smfmac_f32_16x16x64_bf16 v[24:27], v[4:7], v[184:191], v74
  v_smfmac_f32_16x16x64_bf16 v[28:31], v[4:7], a[0:7], v74
  v_smfmac_f32_16x16x64_bf16 v[32:35], v[4:7], a[8:15], v74
  ds_read_b128 v[12:15], v76 offset:12800
  s_waitcnt lgkmcnt(0)
  v_smfmac_f32_16x16x64_bf16 v[20:23], v[12:15], v[192:199], v74
  v_smfmac_f32_16x16x64_bf16 v[24:27], v[12:15], v[200:207], v74
  v_smfmac_f32_16x16x64_bf16 v[28:31], v[12:15], a[16:23], v74
  v_smfmac_f32_16x16x64_bf16 v[32:35], v[12:15], a[24:31], v74
  v_add_f32 v20, v20, v22
  v_add_f32 v21, v21, v23
  v_add_f32 v24, v24, v26
  v_cvt_pk_bf16_f32 v22, v20, v24
  ds_write_b32 v79, v22 offset:0
  v_add_f32 v25, v25, v27
  v_cvt_pk_bf16_f32 v23, v21, v25
  ds_write_b32 v79, v23 offset:576
  v_add_f32 v28, v28, v30
  v_add_f32 v29, v29, v31
  s_waitcnt lgkmcnt(0)
  s_nop 1
  s_branch Cf0_recok
Cf0_mx:
  s_waitcnt lgkmcnt(0)
  s_barrier
  buffer_load_dwordx4 v[0:3], v76, s[8:11], s58 offen offset:0 sc1
  ds_read_b128 v[20:23], v77 offset:0
  ds_read_b128 v[28:31], v77 offset:256
  buffer_load_dwordx4 v[4:7], v76, s[8:11], s58 offen offset:1024 sc1
  ds_read_b128 v[24:27], v77 offset:128
  ds_read_b128 v[32:35], v77 offset:384
  s_waitcnt vmcnt(1) lgkmcnt(3)
  v_mfma_f32_16x16x32_bf16 v[8:11], v[0:3], v[20:23], 0
  s_waitcnt vmcnt(0) lgkmcnt(1)
  v_mfma_f32_16x16x32_bf16 v[8:11], v[4:7], v[24:27], v[8:11]
  v_mfma_f32_16x16x32_bf16 v[12:15], v[28:31], v[20:23], 0
  s_waitcnt lgkmcnt(0)
  v_mfma_f32_16x16x32_bf16 v[12:15], v[32:35], v[24:27], v[12:15]
  v_add_f32_dpp v8, v10, v8 quad_perm:[2,3,0,1] row_mask:0xf bank_mask:0xf
  v_add_f32_dpp v9, v11, v9 quad_perm:[2,3,0,1] row_mask:0xf bank_mask:0xf
  s_nop 0
  v_mov_b32_dpp v8, v8 quad_perm:[0,1,0,1] row_mask:0xf bank_mask:0xf
  v_mov_b32_dpp v9, v9 quad_perm:[0,1,0,1] row_mask:0xf bank_mask:0xf
  s_nop 1
  v_add_f32_dpp v12, v14, v12 quad_perm:[2,3,0,1] row_mask:0xf bank_mask:0xf
  v_add_f32_dpp v13, v15, v13 quad_perm:[2,3,0,1] row_mask:0xf bank_mask:0xf
  s_nop 0
  v_mov_b32_dpp v12, v12 quad_perm:[0,1,0,1] row_mask:0xf bank_mask:0xf
  v_mov_b32_dpp v13, v13 quad_perm:[0,1,0,1] row_mask:0xf bank_mask:0xf
  v_mul_f32 v12, s69, v12
  ds_write_b32 v78, v8 offset:8704
  v_mul_f32 v13, s69, v13
  ds_write_b32 v78, v9 offset:8768
  s_waitcnt lgkmcnt(0)
  s_barrier
  ds_read_b128 v[36:39], v78 offset:8704
  ds_read_b128 v[40:43], v78 offset:8768
  s_waitcnt lgkmcnt(0)
  s_barrier
  v_max_f32 v16, v36, v37
  v_max3_f32 v16, v16, v38, v39
  v_max3_f32 v16, v16, v40, v41
  v_max3_f32 v16, v16, v42, v43
  v_max3_f32 v16, v16, v12, v13
  v_mov_b32 v17, v16
  s_nop 1
  v_permlane16_swap_b32 v16, v17
  v_max_f32 v16, v16, v17
  v_mov_b32 v17, v16
  s_nop 1
  v_permlane32_swap_b32 v16, v17
  v_max_f32 v16, v16, v17
  v_sub_f32 v36, v36, v16
  v_sub_f32 v37, v37, v16
  v_sub_f32 v38, v38, v16
  v_sub_f32 v39, v39, v16
  v_sub_f32 v40, v40, v16
  v_sub_f32 v41, v41, v16
  v_sub_f32 v42, v42, v16
  v_sub_f32 v43, v43, v16
  v_sub_f32 v12, v12, v16
  v_sub_f32 v13, v13, v16
  v_exp_f32 v36, v36
  v_exp_f32 v37, v37
  v_exp_f32 v38, v38
  v_exp_f32 v39, v39
  v_exp_f32 v40, v40
  v_exp_f32 v41, v41
  v_exp_f32 v42, v42
  v_exp_f32 v43, v43
  v_exp_f32 v12, v12
  v_exp_f32 v13, v13
  v_cvt_pk_bf16_f32 v32, v36, v40
  v_cvt_pk_bf16_f32 v33, v37, v41
  v_cvt_pk_bf16_f32 v34, v38, v42
  v_cvt_pk_bf16_f32 v35, v39, v43
  v_cvt_pk_bf16_f32 v28, v12, v13
  v_cvt_pk_bf16_f32 v31, v12, v13
  v_mov_b32 v29, 0
  v_mov_b32 v30, 0
  v_mov_b32 v68, 0x3f803f80
  v_mov_b32 v69, 0x3f803f80
  v_mov_b32 v70, 0x3f803f80
  v_mov_b32 v71, 0x3f803f80
  s_nop 1
  v_mfma_f32_16x16x32_bf16 v[8:11], v[32:35], v[68:71], 0
  v_mfma_f32_16x16x32_bf16 v[0:3], v[32:35], v[52:55], 0
  v_mfma_f32_16x16x32_bf16 v[4:7], v[32:35], v[56:59], 0
  v_mfma_f32_16x16x16_bf16 v[8:11], v[28:29], v[68:69], v[8:11]
  v_mfma_f32_16x16x16_bf16 v[0:3], v[28:29], v[72:73], v[0:3]
  v_mfma_f32_16x16x16_bf16 v[4:7], v[30:31], v[72:73], v[4:7]
  ds_read_b128 v[68:71], v76 offset:13824
  v_rcp_f32 v10, v8
  v_rcp_f32 v11, v9
  v_mul_f32 v0, v10, v0
  v_mul_f32 v1, v11, v1
  s_nop 0
  v_mul_f32 v4, v10, v4
  v_mul_f32 v5, v11, v5
  v_cvt_pk_bf16_f32 v2, v0, v4
  ds_write_b32 v79, v2 offset:8704
  v_cvt_pk_bf16_f32 v3, v1, v5
  ds_write_b32 v79, v3 offset:9280
  v_mov_b64 v[16:17], 0
  v_mov_b64 v[18:19], 0
  v_mov_b64 v[20:21], 0
  v_mov_b64 v[22:23], 0
  v_mov_b64 v[24:25], 0
  v_mov_b64 v[26:27], 0
  s_branch Cf0_mxok
Cf0_kv3:
  s_waitcnt lgkmcnt(0)
  s_cmp_ge_u32 s57, 0x700
  s_cbranch_scc1 Cf0_kvb
  s_load_dword s57, s[12:13], s71 glc
  s_add_u32 s67, s67, 1
  s_cmp_lt_u32 s67, 131072
  s_cbranch_scc1 Cf0_kv3
  s_waitcnt lgkmcnt(0)
  s_branch Cf0_kvb
Cf0_last:
  ds_read_b128 v[4:7], v76 offset:5632
  ds_read_b128 v[12:15], v76 offset:7680
  ds_read_b128 v[44:47], v76 offset:32768
  ds_read_b128 v[48:51], v76 offset:33792
  s_nop 5
  v_mov_b64 v[20:21], 0
  v_mov_b64 v[22:23], 0
  v_mov_b64 v[24:25], 0
  v_mov_b64 v[26:27], 0
  v_smfmac_f32_16x16x64_bf16 v[28:31], v[0:3], v[36:43], v74
  ds_read_b128 v[36:39], v76 offset:34816
  ds_read_b128 v[40:43], v76 offset:35840
  v_smfmac_f32_16x16x64_bf16 v[32:35], v[0:3], v[60:67], v74
  s_waitcnt lgkmcnt(5)
  v_smfmac_f32_16x16x64_bf16 v[20:23], v[0:3], a[32:39], v74
  ds_read_b128 v[60:63], v76 offset:49152
  ds_read_b128 v[64:67], v76 offset:50176
  v_smfmac_f32_16x16x64_bf16 v[24:27], v[0:3], a[40:47], v74
  s_waitcnt lgkmcnt(4)
  v_smfmac_f32_16x16x64_bf16 v[20:23], v[4:7], a[48:55], v74
  buffer_store_dwordx4 v[16:19], v76, s[8:11], s68 offen sc1
  v_smfmac_f32_16x16x64_bf16 v[24:27], v[4:7], a[56:63], v74
  v_smfmac_f32_16x16x64_bf16 v[28:31], v[4:7], v[44:51], v74
  s_waitcnt lgkmcnt(2)
  v_smfmac_f32_16x16x64_bf16 v[20:23], v[8:11], a[64:71], v74
  ds_read_b128 v[44:47], v76 offset:51200
  ds_read_b128 v[48:51], v76 offset:52224
  v_smfmac_f32_16x16x64_bf16 v[24:27], v[8:11], a[72:79], v74
  v_smfmac_f32_16x16x64_bf16 v[32:35], v[4:7], v[36:43], v74
  v_smfmac_f32_16x16x64_bf16 v[28:31], v[8:11], v[208:215], v74
  ds_read_b128 v[36:39], v75 offset:16384
  ds_read_b128 v[40:43], v75 offset:17408
  v_smfmac_f32_16x16x64_bf16 v[32:35], v[8:11], v[216:223], v74
  v_smfmac_f32_16x16x64_bf16 v[20:23], v[12:15], a[80:87], v74
  v_smfmac_f32_16x16x64_bf16 v[24:27], v[12:15], a[88:95], v74
  v_smfmac_f32_16x16x64_bf16 v[28:31], v[12:15], v[224:231], v74
  v_smfmac_f32_16x16x64_bf16 v[32:35], v[12:15], v[232:239], v74
  s_waitcnt vmcnt(2)
  s_waitcnt vmcnt(1)
  s_barrier
Cf0_lastr:
  ds_read_b128 v[0:3], v76 offset:8704
  ds_read_b128 v[8:11], v76 offset:9728
  ds_read_b128 v[16:19], v76 offset:10752
  ds_read_b128 v[4:7], v76 offset:11776
  ds_read_b128 v[12:15], v76 offset:12800
  s_waitcnt lgkmcnt(4)
  v_max3_u32 v72, v0, v1, v2
  s_waitcnt lgkmcnt(1)
  v_max3_u32 v72, v72, v3, v4
  v_max3_u32 v72, v72, v5, v6
  v_max3_u32 v72, v72, v7, v8
  v_max3_u32 v72, v72, v9, v10
  s_waitcnt lgkmcnt(0)
  v_max3_u32 v72, v72, v11, v12
  v_max3_u32 v72, v72, v13, v14
  v_max3_u32 v72, v72, v15, v16
  v_max3_u32 v72, v72, v17, v18
  v_max_u32 v72, v72, v19
  v_cmp_eq_u32 vcc, -1, v72
  s_cbranch_vccnz Cf0_lastp
Cf0_lastg:
  v_smfmac_f32_16x16x64_bf16 v[28:31], v[0:3], v[60:67], v74
  ds_read_b128 v[60:63], v75 offset:18432
  ds_read_b128 v[64:67], v75 offset:19456
  v_smfmac_f32_16x16x64_bf16 v[32:35], v[0:3], v[44:51], v74
  v_smfmac_f32_16x16x64_bf16 v[28:31], v[8:11], v[36:43], v74
  v_smfmac_f32_16x16x64_bf16 v[28:31], v[16:19], v[240:247], v74
  v_smfmac_f32_16x16x64_bf16 v[28:31], v[4:7], a[0:7], v74
  v_smfmac_f32_16x16x64_bf16 v[28:31], v[12:15], a[16:23], v74
  v_smfmac_f32_16x16x64_bf16 v[32:35], v[16:19], v[248:255], v74
  v_smfmac_f32_16x16x64_bf16 v[32:35], v[4:7], a[8:15], v74
  s_waitcnt lgkmcnt(0)
  v_smfmac_f32_16x16x64_bf16 v[32:35], v[12:15], a[24:31], v74
  v_smfmac_f32_16x16x64_bf16 v[32:35], v[8:11], v[60:67], v74
  v_smfmac_f32_16x16x64_bf16 v[20:23], v[0:3], a[96:103], v74
  v_smfmac_f32_16x16x64_bf16 v[20:23], v[8:11], a[112:119], v74
  v_add_f32 v28, v28, v30
  v_add_f32 v32, v32, v34
  v_cvt_pk_bf16_f32 v30, v28, v32
  v_smfmac_f32_16x16x64_bf16 v[20:23], v[16:19], a[128:135], v74
  ds_write_b32 v79, v30 offset:256
  v_add_f32 v29, v29, v31
  v_add_f32 v33, v33, v35
  v_cvt_pk_bf16_f32 v31, v29, v33
  v_smfmac_f32_16x16x64_bf16 v[20:23], v[4:7], a[144:151], v74
  ds_write_b32 v79, v31 offset:832
  v_smfmac_f32_16x16x64_bf16 v[20:23], v[12:15], a[160:167], v74
  v_smfmac_f32_16x16x64_bf16 v[24:27], v[0:3], a[104:111], v74
  v_smfmac_f32_16x16x64_bf16 v[24:27], v[8:11], a[120:127], v74
  v_smfmac_f32_16x16x64_bf16 v[24:27], v[16:19], a[136:143], v74
  s_waitcnt lgkmcnt(0)
  s_barrier
  ds_read_b64 v[52:53], v77 offset:256
  v_add_f32 v20, v20, v22
  v_smfmac_f32_16x16x64_bf16 v[24:27], v[4:7], a[152:159], v74
  v_add_f32 v21, v21, v23
  v_smfmac_f32_16x16x64_bf16 v[24:27], v[12:15], a[168:175], v74
  v_cvt_pk_bf16_f32 v54, v20, v21
  s_add_u32 s68, s68, 655360
  s_nop 3
  v_add_f32 v24, v24, v26
  v_add_f32 v25, v25, v27
  v_cvt_pk_bf16_f32 v55, v24, v25
  s_waitcnt lgkmcnt(0)
  buffer_store_dwordx4 v[52:55], v76, s[8:11], s68 offen sc1
  s_branch Cf0_done
Cf0_lastp:
  s_add_u32 s72, s72, 2
  s_cmp_ge_u32 s72, 131072
  s_cbranch_scc1 Cf0_lastg
  s_barrier
  buffer_load_dwordx4 v76, s[8:11], s85 offen offset:0 sc1 lds
  s_waitcnt vmcnt(0)
  s_barrier
  s_branch Cf0_lastr
Cf0_done:
  s_branch L_cexit
L_w1:
  v_mov_b64 v[20:21], 0
  v_mov_b64 v[22:23], 0
  v_mov_b64 v[24:25], 0
  v_mov_b64 v[26:27], 0
  v_mov_b64 v[28:29], 0
  v_mov_b64 v[30:31], 0
  v_mov_b64 v[32:33], 0
  v_mov_b64 v[34:35], 0
  s_mov_b32 s78, 0x3f803f80
  s_mov_b32 s79, s78
  s_mov_b32 s65, 360448
  s_mov_b32 m0, 15872
  s_lshl_b32 s71, s53, 2
  s_add_u32 s71, s71, 128
  s_movk_i32 s56, 0x1000
  v_lshlrev_b32 v73, 2, v76
  v_mov_b32 v72, 0
  s_mov_b64 s[16:17], s[8:9]
  s_mov_b32 s18, 268435456
  s_mov_b32 s19, 0x20000
  s_getpc_b64 s[20:21]
Cf1_pc:
  s_add_u32 s20, s20, (Cf1_last - Cf1_pc)
  s_addc_u32 s21, s21, 0
  v_mov_b32 v68, 14880
  buffer_load_dwordx4 v[52:55], v76, s[8:11], s59 offen offset:0 sc1
  buffer_load_dwordx4 v[56:59], v76, s[8:11], s59 offen offset:1024 sc1
  ds_read_b128 v[36:39], v76 offset:20480
  ds_read_b128 v[40:43], v76 offset:21504
  ds_read_b128 v[60:63], v76 offset:22528
  ds_read_b128 v[64:67], v76 offset:23552
  ds_read_b128 v[0:3], v76 offset:4608
  ds_read_b128 v[4:7], v76 offset:5632
  ds_read_b128 v[8:11], v76 offset:6656
  ds_read_b128 v[12:15], v76 offset:7680
  s_waitcnt lgkmcnt(0)
  s_cmp_eq_u32 s66, 1
  s_branch Cf1_top2
.p2align 6
Cf1_h2:
  ds_read_b128 v[36:39], v76 offset:20480
  s_waitcnt lgkmcnt(0)
  s_cmp_eq_u32 s66, 62
  s_cselect_b64 s[16:17], s[20:21], s[16:17]
  s_cselect_b32 s18, (Cf1_done - Cf1_last), s18
  s_cselect_b32 s70, 0, s70
  s_cmp_eq_u32 s66, 63
  s_cselect_b32 s59, 268435456, s59
  s_cselect_b32 s58, 268435456, s58
  buffer_load_dwordx4 v[8:11], v76, s[8:11], s65 offen offset:2048 sc1
  ds_read_b128 v[40:43], v76 offset:21504
  s_waitcnt lgkmcnt(0)
  v_mov_b64 v[20:21], 0
  v_mov_b64 v[22:23], 0
  v_mov_b64 v[24:25], 0
  v_mov_b64 v[26:27], 0
  v_mov_b32 v68, 14880
  buffer_load_dwordx4 v[8:11], v76, s[8:11], s65 offen offset:2048 sc1
  ds_read_b128 v[60:63], v76 offset:22528
  s_waitcnt lgkmcnt(0)
  v_mov_b64 v[28:29], 0
  v_mov_b64 v[30:31], 0
  v_mov_b64 v[32:33], 0
  v_mov_b64 v[34:35], 0
  v_lshlrev_b32 v73, 2, v76
  buffer_load_dwordx4 v[8:11], v76, s[8:11], s65 offen offset:2048 sc1
  buffer_load_dwordx4 v[52:55], v76, s[8:11], s59 offen offset:0 sc1
  buffer_load_dwordx4 v[56:59], v76, s[8:11], s59 offen offset:1024 sc1
  s_waitcnt vmcnt(4)
  v_max3_u32 v72, v8, v9, v10
  v_max_u32 v72, v72, v11
  ds_write_b128 v76, v[8:11] offset:6656
  v_cmp_eq_u32 vcc, -1, v72
  s_cbranch_vccnz Cf1_h2r
Cf1_h2w:
  s_cmp_eq_u32 s66, 63
  s_waitcnt lgkmcnt(0)
  s_barrier
  ds_read_b128 v[0:3], v76 offset:4608
  buffer_load_dwordx4 v76, s[8:11], s85 offen offset:0 sc1 lds
Cf1_top2:
  v_smfmac_f32_16x16x64_bf16 v[20:23], v[8:11], v[112:119], v74
  s_cbranch_scc1 Cf1_last
  v_smfmac_f32_16x16x64_bf16 v[24:27], v[8:11], v[120:127], v74
  buffer_load_dwordx4 v[44:47], v76, s[8:11], s58 offen offset:0 sc1
  s_mov_b32 m0, 15872
  v_smfmac_f32_16x16x64_bf16 v[28:31], v[8:11], v[208:215], v74
  buffer_load_dwordx4 v[48:51], v76, s[8:11], s58 offen offset:1024 sc1
  v_smfmac_f32_16x16x64_bf16 v[32:35], v[8:11], v[216:223], v74
  ds_read_b128 v[4:7], v76 offset:5632
  s_waitcnt lgkmcnt(1)
  v_smfmac_f32_16x16x64_bf16 v[20:23], v[0:3], v[80:87], v74
  ds_read_b128 v[12:15], v76 offset:7680
  v_smfmac_f32_16x16x64_bf16 v[28:31], v[0:3], v[36:43], v74
  ds_read_b128 v[36:39], v76 offset:36864
  v_smfmac_f32_16x16x64_bf16 v[24:27], v[0:3], v[88:95], v74
  buffer_store_dwordx4 v[16:19], v76, s[8:11], s68 offen sc1
  ds_read_b128 v[40:43], v76 offset:37888
  v_smfmac_f32_16x16x64_bf16 v[32:35], v[0:3], v[60:67], v74
  buffer_load_dword v73, s[16:19], s70 offen lds
  ds_read_b128 v[60:63], v76 offset:38912
  s_waitcnt lgkmcnt(4)
  v_smfmac_f32_16x16x64_bf16 v[20:23], v[4:7], v[96:103], v74
  ds_read_b128 v[64:67], v76 offset:39936
  v_smfmac_f32_16x16x64_bf16 v[24:27], v[4:7], v[104:111], v74
  s_waitcnt vmcnt(5)
  s_waitcnt lgkmcnt(4)
  v_smfmac_f32_16x16x64_bf16 v[20:23], v[12:15], v[128:135], v74
  s_barrier
  ds_read_b128 v[8:11], v76 offset:8704
  s_waitcnt lgkmcnt(3)
  v_smfmac_f32_16x16x64_bf16 v[28:31], v[4:7], v[36:43], v74
  ds_read_b128 v[36:39], v76 offset:53248
  v_smfmac_f32_16x16x64_bf16 v[24:27], v[12:15], v[136:143], v74
  ds_read_b128 v[40:43], v76 offset:54272
  s_waitcnt lgkmcnt(3)
  v_smfmac_f32_16x16x64_bf16 v[32:35], v[4:7], v[60:67], v74
  ds_read_b128 v[0:3], v76 offset:9728
  v_smfmac_f32_16x16x64_bf16 v[28:31], v[12:15], v[224:231], v74
  ds_read_b128 v[60:63], v76 offset:55296
  v_smfmac_f32_16x16x64_bf16 v[32:35], v[12:15], v[232:239], v74
  s_waitcnt vmcnt(4)
  ds_read_b128 v[64:67], v76 offset:56320
  s_waitcnt lgkmcnt(5)
  v_smfmac_f32_16x16x64_bf16 v[20:23], v[8:11], v[144:151], v74
  s_barrier
  ds_read_b128 v[4:7], v76 offset:11776
  s_waitcnt lgkmcnt(4)
  v_smfmac_f32_16x16x64_bf16 v[28:31], v[8:11], v[36:43], v74
  ds_read_b128 v[12:15], v76 offset:12800
  ds_read_b128 v[36:39], v75 offset:4096
  v_smfmac_f32_16x16x64_bf16 v[24:27], v[8:11], v[152:159], v74
  ds_read_b128 v[16:19], v76 offset:10752
  s_waitcnt lgkmcnt(6)
  v_smfmac_f32_16x16x64_bf16 v[20:23], v[0:3], v[160:167], v74
  ds_read_b128 v[40:43], v75 offset:5120
  s_waitcnt lgkmcnt(5)
  v_smfmac_f32_16x16x64_bf16 v[32:35], v[8:11], v[60:67], v74
  ds_read_b128 v[60:63], v75 offset:6144
  v_smfmac_f32_16x16x64_bf16 v[24:27], v[0:3], v[168:175], v74
  ds_read_b128 v[64:67], v75 offset:7168
  s_waitcnt lgkmcnt(6)
  v_smfmac_f32_16x16x64_bf16 v[20:23], v[4:7], v[176:183], v74
  s_waitcnt lgkmcnt(5)
  v_smfmac_f32_16x16x64_bf16 v[20:23], v[12:15], v[192:199], v74
  s_waitcnt lgkmcnt(2)
  v_smfmac_f32_16x16x64_bf16 v[20:23], v[16:19], v[36:43], v74
  ds_read_b128 v[36:39], v75 offset:20480
  v_smfmac_f32_16x16x64_bf16 v[24:27], v[4:7], v[184:191], v74
  ds_read_b128 v[40:43], v75 offset:21504
  s_waitcnt lgkmcnt(2)
  v_smfmac_f32_16x16x64_bf16 v[24:27], v[16:19], v[60:67], v74
  ds_read_b128 v[60:63], v75 offset:22528
  v_add_f32 v20, v20, v22
  v_smfmac_f32_16x16x64_bf16 v[24:27], v[12:15], v[200:207], v74
  ds_read_b128 v[64:67], v75 offset:23552
  v_add_f32 v21, v21, v23
  v_smfmac_f32_16x16x64_bf16 v[28:31], v[16:19], v[240:247], v74
  v_mov_b64 v[70:71], s[78:79]
  v_smfmac_f32_16x16x64_bf16 v[28:31], v[4:7], a[0:7], v74
  s_waitcnt lgkmcnt(2)
  v_add_f32 v24, v24, v26
  v_smfmac_f32_16x16x64_bf16 v[28:31], v[0:3], v[36:43], v74
  ds_read_b128 v[36:39], v68
  v_cvt_pk_bf16_f32 v22, v20, v24
  v_smfmac_f32_16x16x64_bf16 v[28:31], v[12:15], a[16:23], v74
  ds_read_b128 v[40:43], v68
  ds_write_b32 v79, v22 offset:0
  s_waitcnt lgkmcnt(3)
  v_add_f32 v25, v25, v27
  v_cvt_pk_bf16_f32 v23, v21, v25
  v_smfmac_f32_16x16x64_bf16 v[32:35], v[0:3], v[60:67], v74
  ds_write_b32 v79, v23 offset:576
  v_cmp_u_f32 vcc, v20, v21
  v_smfmac_f32_16x16x64_bf16 v[32:35], v[16:19], v[248:255], v74
  v_add_f32 v28, v28, v30
  v_smfmac_f32_16x16x64_bf16 v[32:35], v[4:7], a[8:15], v74
  v_add_f32 v29, v29, v31
  v_smfmac_f32_16x16x64_bf16 v[32:35], v[12:15], a[24:31], v74
  s_cbranch_vccnz Cf1_rec
Cf1_recok:
  s_waitcnt lgkmcnt(3)
  v_smfmac_f32_16x16x64_bf16 v[36:39], v[16:19], a[128:135], v74
  s_waitcnt lgkmcnt(0)
  s_barrier
  ds_read_b128 v[60:63], v77
  v_smfmac_f32_16x16x64_bf16 v[40:43], v[16:19], a[136:143], v74
  ds_read_b128 v[64:67], v77 offset:128
  v_add_f32 v32, v32, v34
  v_cvt_pk_bf16_f32 v30, v28, v32
  v_smfmac_f32_16x16x64_bf16 v[36:39], v[0:3], a[112:119], v74
  ds_write_b32 v79, v30 offset:256
  v_add_f32 v33, v33, v35
  v_cvt_pk_bf16_f32 v31, v29, v33
  v_smfmac_f32_16x16x64_bf16 v[40:43], v[0:3], a[120:127], v74
  ds_write_b32 v79, v31 offset:832
  v_xor_b32 v75, 0x8000, v75
  v_smfmac_f32_16x16x64_bf16 v[36:39], v[4:7], a[144:151], v74
  ds_read_b128 v[0:3], v76 offset:4608
  v_mov_b32 v29, 0
  v_smfmac_f32_16x16x64_bf16 v[40:43], v[4:7], a[152:159], v74
  s_waitcnt vmcnt(2) lgkmcnt(3)
  v_mov_b32 v30, 0
  v_mfma_f32_16x16x32_bf16 v[44:47], v[44:47], v[60:63], 0
  ds_read_b128 v[4:7], v76 offset:5632
  s_waitcnt lgkmcnt(2)
  v_mfma_f32_16x16x32_bf16 v[44:47], v[48:51], v[64:67], v[44:47]
  s_barrier
  v_smfmac_f32_16x16x64_bf16 v[36:39], v[8:11], a[96:103], v74
  ds_read_b128 v[20:23], v77 offset:256
  ds_read_b128 v[24:27], v77 offset:384
  v_smfmac_f32_16x16x64_bf16 v[40:43], v[8:11], a[104:111], v74
  ds_read_b128 v[8:11], v76 offset:6656
  v_add_f32_dpp v72, v46, v44 quad_perm:[2,3,0,1] row_mask:0xf bank_mask:0xf
  v_add_f32_dpp v73, v47, v45 quad_perm:[2,3,0,1] row_mask:0xf bank_mask:0xf
  v_smfmac_f32_16x16x64_bf16 v[36:39], v[12:15], a[160:167], v74
  s_waitcnt lgkmcnt(4)
  v_exp_f32_dpp v72, v72 quad_perm:[0,1,0,1] row_mask:0xf bank_mask:0xf
  v_smfmac_f32_16x16x64_bf16 v[40:43], v[12:15], a[168:175], v74
  ds_read_b128 v[12:15], v76 offset:7680
  v_exp_f32_dpp v73, v73 quad_perm:[0,1,0,1] row_mask:0xf bank_mask:0xf
  v_smfmac_f32_16x16x64_bf16 v[36:39], v[0:3], a[32:39], v74
  s_waitcnt lgkmcnt(2)
  v_cvt_pk_bf16_f32 v72, v72, v73
  v_mfma_f32_16x16x32_bf16 v[20:23], v[20:23], v[60:63], 0
  ds_write_b32 v78, v72 offset:516
  v_mov_b64 v[16:17], 0
  v_mfma_f32_16x16x32_bf16 v[20:23], v[24:27], v[64:67], v[20:23]
  ds_read_b128 v[44:47], v75 offset:20480
  v_mov_b64 v[18:19], 0
  v_smfmac_f32_16x16x64_bf16 v[40:43], v[0:3], a[40:47], v74
  ds_read_b128 v[48:51], v75 offset:21504
  v_mov_b64 v[68:69], s[78:79]
  v_smfmac_f32_16x16x64_bf16 v[36:39], v[4:7], a[48:55], v74
  s_waitcnt lgkmcnt(4)
  v_add_f32_dpp v24, v22, v20 quad_perm:[2,3,0,1] row_mask:0xf bank_mask:0xf
  v_add_f32_dpp v25, v23, v21 quad_perm:[2,3,0,1] row_mask:0xf bank_mask:0xf
  v_smfmac_f32_16x16x64_bf16 v[36:39], v[8:11], a[64:71], v74
  s_waitcnt lgkmcnt(2)
  s_barrier
  ds_read_b128 v[32:35], v78 offset:512
  v_smfmac_f32_16x16x64_bf16 v[36:39], v[12:15], a[80:87], v74
  ds_read_b128 v[60:63], v75 offset:22528
  v_mul_f32 v24, s69, v24
  v_smfmac_f32_16x16x64_bf16 v[40:43], v[4:7], a[56:63], v74
  ds_read_b128 v[64:67], v75 offset:23552
  v_mul_f32 v25, s69, v25
  v_smfmac_f32_16x16x64_bf16 v[40:43], v[8:11], a[72:79], v74
  v_exp_f32_dpp v24, v24 quad_perm:[0,1,0,1] row_mask:0xf bank_mask:0xf
  v_smfmac_f32_16x16x64_bf16 v[40:43], v[12:15], a[88:95], v74
  s_waitcnt lgkmcnt(2)
  v_exp_f32_dpp v25, v25 quad_perm:[0,1,0,1] row_mask:0xf bank_mask:0xf
  v_mfma_f32_16x16x32_bf16 v[8:11], v[32:35], v[68:71], 0
  v_add_f32 v36, v36, v38
  v_add_f32 v37, v37, v39
  v_mfma_f32_16x16x32_bf16 v[0:3], v[32:35], v[52:55], 0
  v_add_f32 v40, v40, v42
  v_add_f32 v41, v41, v43
  v_mfma_f32_16x16x32_bf16 v[4:7], v[32:35], v[56:59], 0
  v_cvt_pk_bf16_f32 v28, v24, v25
  v_cvt_pk_bf16_f32 v72, v36, v37
  v_cvt_pk_bf16_f32 v73, v40, v41
  v_mfma_f32_16x16x16_bf16 v[8:11], v[28:29], v[68:69], v[8:11]
  v_cvt_pk_bf16_f32 v31, v24, v25
  v_mov_b64 v[20:21], 0
  v_mfma_f32_16x16x16_bf16 v[0:3], v[28:29], v[72:73], v[0:3]
  ds_read_b128 v[68:71], v76 offset:13824
  v_mov_b64 v[22:23], 0
  v_mfma_f32_16x16x16_bf16 v[4:7], v[30:31], v[72:73], v[4:7]
  v_rcp_f32 v10, v8
  v_rcp_f32 v11, v9
  v_mul_f32 v0, v10, v0
  v_mul_f32 v1, v11, v1
  s_nop 0
  v_mul_f32 v4, v10, v4
  v_mul_f32 v5, v11, v5
  v_cvt_pk_bf16_f32 v2, v0, v4
  ds_write_b32 v79, v2 offset:8704
  v_cvt_pk_bf16_f32 v3, v1, v5
  ds_write_b32 v79, v3 offset:9280
  v_max3_f32 v8, v8, v9, v10
  v_max_f32 v8, v8, v11
  v_cmp_le_f32 vcc, 1317011456, v8
  v_mov_b64 v[24:25], 0
  v_mov_b64 v[26:27], 0
  s_cbranch_vccnz Cf1_mx
Cf1_mxok:
  s_waitcnt lgkmcnt(0)
  s_barrier
  ds_read_b128 v[0:3], v78 offset:8704
  ds_read_b128 v[4:7], v78 offset:8768
  ds_read_b128 v[8:11], v78 offset:8832
  ds_read_b128 v[12:15], v78 offset:8896
  s_waitcnt lgkmcnt(3)
  v_smfmac_f32_16x16x64_bf16 v[16:19], v[0:3], v[44:51], v74
  ds_read_b128 v[52:55], v75 offset:36864
  s_waitcnt lgkmcnt(3)
  v_smfmac_f32_16x16x64_bf16 v[16:19], v[4:7], v[60:67], v74
  ds_read_b128 v[56:59], v75 offset:37888
  s_waitcnt lgkmcnt(3)
  v_smfmac_f32_16x16x64_bf16 v[16:19], v[8:11], a[176:183], v74
  ds_read_b128 v[36:39], v75 offset:38912
  s_waitcnt lgkmcnt(3)
  v_smfmac_f32_16x16x64_bf16 v[16:19], v[12:15], a[184:191], v74
  ds_read_b128 v[40:43], v75 offset:39936
  ds_read_b128 v[44:47], v75 offset:53248
  v_smfmac_f32_16x16x64_bf16 v[20:23], v[0:3], a[192:199], v74
  ds_read_b128 v[48:51], v75 offset:54272
  ds_read_b128 v[60:63], v75 offset:55296
  v_smfmac_f32_16x16x64_bf16 v[20:23], v[4:7], a[200:207], v74
  ds_read_b128 v[64:67], v75 offset:56320
  s_waitcnt lgkmcnt(6)
  v_cvt_pk_bf16_f32 v16, v16, v17
  v_cvt_pk_bf16_f32 v17, v18, v19
  v_bfi_b32 v16, 1, s72, v16
  v_smfmac_f32_16x16x64_bf16 v[20:23], v[8:11], v[52:59], v74
  buffer_store_dwordx2 v[16:17], v68, s[8:11], s73 offen
  s_waitcnt lgkmcnt(4)
  v_smfmac_f32_16x16x64_bf16 v[20:23], v[12:15], v[36:43], v74
  v_mov_b64 v[32:33], 0
  v_smfmac_f32_16x16x64_bf16 v[24:27], v[0:3], a[208:215], v74
  v_mov_b64 v[34:35], 0
  v_smfmac_f32_16x16x64_bf16 v[24:27], v[4:7], a[216:223], v74
  s_waitcnt lgkmcnt(2)
  v_cvt_pk_bf16_f32 v20, v20, v21
  v_cvt_pk_bf16_f32 v21, v22, v23
  v_bfi_b32 v20, 1, s72, v20
  v_smfmac_f32_16x16x64_bf16 v[24:27], v[8:11], v[44:51], v74
  buffer_store_dwordx2 v[20:21], v68, s[8:11], s74 offen
  s_waitcnt lgkmcnt(0)
  v_smfmac_f32_16x16x64_bf16 v[24:27], v[12:15], v[60:67], v74
  v_smfmac_f32_16x16x64_bf16 v[32:35], v[0:3], a[224:231], v74
  v_smfmac_f32_16x16x64_bf16 v[32:35], v[4:7], a[232:239], v74
  v_cvt_pk_bf16_f32 v24, v24, v25
  v_cvt_pk_bf16_f32 v25, v26, v27
  v_bfi_b32 v24, 1, s72, v24
  v_smfmac_f32_16x16x64_bf16 v[32:35], v[8:11], a[240:247], v74
  buffer_store_dwordx2 v[24:25], v68, s[8:11], s75 offen
  v_smfmac_f32_16x16x64_bf16 v[32:35], v[12:15], a[248:255], v74
  v_mov_b64 v[18:19], v[72:73]
  s_nop 4
  v_cvt_pk_bf16_f32 v32, v32, v33
  v_cvt_pk_bf16_f32 v33, v34, v35
  v_bfi_b32 v32, 1, s72, v32
  buffer_store_dwordx2 v[32:33], v68, s[8:11], s76 offen
  ds_read_b128 v[0:3], v76 offset:14848
  s_waitcnt lgkmcnt(0)
  ds_read_b64 v[16:17], v77 offset:264
  s_waitcnt lgkmcnt(0)
  ds_read_b128 v[64:67], v76 offset:23552
  s_waitcnt lgkmcnt(0)
  s_add_u32 s66, s66, 1
  s_xor_b32 s64, s64, 16384
  s_xor_b32 s65, s65, 16384
  s_add_u32 s58, s58, 655360
  s_add_u32 s59, s59, 655360
  s_add_u32 s70, s70, 655360
  s_add_u32 s68, s68, 655360
  s_mov_b32 m0, 11776
  s_add_u32 s85, s65, 7168
  v_xor_b32 v75, 0x8000, v75
  buffer_load_dwordx4 v[52:55], v76, s[8:11], s60 offen offset:0 sc1
  buffer_load_dwordx4 v[56:59], v76, s[8:11], s60 offen offset:1024 sc1
  s_waitcnt lgkmcnt(0)
  s_waitcnt vmcnt(1)
  v_mfma_f32_16x16x32_bf16 v[4:7], v[0:3], v[52:55], 0
  v_bitop3_b32 v72, v52, v54, s72 bitop3:0x7e
  s_waitcnt vmcnt(0)
  v_mfma_f32_16x16x32_bf16 v[4:7], v[0:3], v[56:59], v[4:7]
  v_bitop3_b32 v73, v56, v58, s72 bitop3:0x7e
  v_bitop3_b32 v72, v72, v73, 1 bitop3:0xa8
  v_cmp_ne_u32 vcc, 0, v72
  s_nop 3
  v_add_f32_dpp v4, v4, v4 row_ror:4 row_mask:0xf bank_mask:0xf
  v_add_f32_dpp v5, v5, v5 row_ror:4 row_mask:0xf bank_mask:0xf
  s_cmp_eq_u64 vcc, 0
  v_add_f32_dpp v4, v4, v4 row_ror:8 row_mask:0xf bank_mask:0xf
  v_add_f32_dpp v5, v5, v5 row_ror:8 row_mask:0xf bank_mask:0xf
  s_cselect_b32 s54, s62, 268435456
  v_cvt_pk_bf16_f32 v4, v4, v5
  buffer_store_dword v4, v69, s[8:11], s54 offen
  s_cbranch_vccnz Cf1_h1r
  s_xor_b32 s62, s62, 16384
  buffer_store_dword v71, v69, s[8:11], s62 offen
  s_xor_b32 s72, s72, 1
  s_branch Cf1_h2
Cf1_h1r:
  s_mov_b64 exec, vcc
  buffer_load_dwordx4 v[52:55], v76, s[8:11], s60 offen offset:0 sc1
  buffer_load_dwordx4 v[56:59], v76, s[8:11], s60 offen offset:1024 sc1
  s_mov_b64 exec, -1
  s_add_u32 s67, s67, 1
  s_waitcnt vmcnt(1)
  v_mfma_f32_16x16x32_bf16 v[4:7], v[0:3], v[52:55], 0
  v_bitop3_b32 v72, v52, v54, s72 bitop3:0x7e
  s_waitcnt vmcnt(0)
  v_mfma_f32_16x16x32_bf16 v[4:7], v[0:3], v[56:59], v[4:7]
  v_bitop3_b32 v73, v56, v58, s72 bitop3:0x7e
  v_bitop3_b32 v72, v72, v73, 1 bitop3:0xa8
  v_cmp_ne_u32 vcc, 0, v72
  s_cbranch_vccz Cf1_h1p
Cf1_h1s:
  s_mov_b64 exec, vcc
  buffer_load_dwordx4 v[52:55], v76, s[8:11], s60 offen offset:0 sc1
  buffer_load_dwordx4 v[56:59], v76, s[8:11], s60 offen offset:1024 sc1
  s_mov_b64 exec, -1
  s_add_u32 s67, s67, 1
  s_waitcnt vmcnt(1)
  v_mfma_f32_16x16x32_bf16 v[4:7], v[0:3], v[52:55], 0
  v_bitop3_b32 v72, v52, v54, s72 bitop3:0x7e
  s_waitcnt vmcnt(0)
  v_mfma_f32_16x16x32_bf16 v[4:7], v[0:3], v[56:59], v[4:7]
  v_bitop3_b32 v73, v56, v58, s72 bitop3:0x7e
  v_bitop3_b32 v72, v72, v73, 1 bitop3:0xa8
  v_cmp_ne_u32 vcc, 0, v72
  s_cbranch_vccz Cf1_h1p
  s_cmp_lt_u32 s67, 131072
  s_cbranch_scc1 Cf1_h1s
Cf1_h1p:
  s_nop 2
  v_add_f32_dpp v4, v4, v4 row_ror:4 row_mask:0xf bank_mask:0xf
  v_add_f32_dpp v5, v5, v5 row_ror:4 row_mask:0xf bank_mask:0xf
  s_nop 0
  v_add_f32_dpp v4, v4, v4 row_ror:8 row_mask:0xf bank_mask:0xf
  v_add_f32_dpp v5, v5, v5 row_ror:8 row_mask:0xf bank_mask:0xf
  v_cvt_pk_bf16_f32 v4, v4, v5
  buffer_store_dword v4, v69, s[8:11], s62 offen
  s_xor_b32 s62, s62, 16384
  buffer_store_dword v71, v69, s[8:11], s62 offen
  s_xor_b32 s72, s72, 1
  s_branch Cf1_h2
Cf1_h2r:
  s_mov_b64 exec, vcc
  buffer_load_dwordx4 v[8:11], v76, s[8:11], s65 offen offset:2048 sc1
  s_mov_b64 exec, -1
  s_add_u32 s67, s67, 1
  s_waitcnt vmcnt(4)
  v_max3_u32 v72, v8, v9, v10
  v_max_u32 v72, v72, v11
  ds_write_b128 v76, v[8:11] offset:6656
  v_cmp_eq_u32 vcc, -1, v72
  s_cbranch_vccz Cf1_h2w
  s_mov_b64 exec, vcc
  buffer_load_dwordx4 v[8:11], v76, s[8:11], s65 offen offset:2048 sc1
  s_mov_b64 exec, -1
  s_add_u32 s67, s67, 1
  s_waitcnt vmcnt(4)
  v_max3_u32 v72, v8, v9, v10
  v_max_u32 v72, v72, v11
  ds_write_b128 v76, v[8:11] offset:6656
  v_cmp_eq_u32 vcc, -1, v72
  s_cbranch_vccz Cf1_h2w
Cf1_h2s:
  s_mov_b64 exec, vcc
  buffer_load_dwordx4 v[8:11], v76, s[8:11], s65 offen offset:2048 sc1
  s_mov_b64 exec, -1
  s_add_u32 s67, s67, 1
  s_waitcnt vmcnt(2)
  v_max3_u32 v72, v8, v9, v10
  v_max_u32 v72, v72, v11
  ds_write_b128 v76, v[8:11] offset:6656
  v_cmp_eq_u32 vcc, -1, v72
  s_cbranch_vccz Cf1_h2w
  s_mov_b64 exec, vcc
  buffer_load_dwordx4 v[8:11], v76, s[8:11], s65 offen offset:2048 sc1
  s_mov_b64 exec, -1
  s_add_u32 s67, s67, 1
  s_waitcnt vmcnt(2)
  v_max3_u32 v72, v8, v9, v10
  v_max_u32 v72, v72, v11
  ds_write_b128 v76, v[8:11] offset:6656
  v_cmp_eq_u32 vcc, -1, v72
  s_cbranch_vccz Cf1_h2w
  s_mov_b64 exec, vcc
  buffer_load_dwordx4 v[8:11], v76, s[8:11], s65 offen offset:2048 sc1
  s_mov_b64 exec, -1
  s_add_u32 s67, s67, 1
  s_waitcnt vmcnt(2)
  v_max3_u32 v72, v8, v9, v10
  v_max_u32 v72, v72, v11
  ds_write_b128 v76, v[8:11] offset:6656
  v_cmp_eq_u32 vcc, -1, v72
  s_cbranch_vccz Cf1_h2w
  s_cmp_lt_u32 s67, 131072
  s_cbranch_scc1 Cf1_h2s
  s_branch Cf1_h2w
Cf1_rec:
  s_nop 7
  s_waitcnt vmcnt(0) lgkmcnt(0)
  v_max3_u32 v72, v0, v1, v2
  v_max3_u32 v72, v72, v3, v4
  v_max3_u32 v72, v72, v5, v6
  v_max3_u32 v72, v72, v7, v8
  v_max3_u32 v72, v72, v9, v10
  v_max3_u32 v72, v72, v11, v12
  v_max3_u32 v72, v72, v13, v14
  v_max3_u32 v72, v72, v15, v16
  v_max3_u32 v72, v72, v17, v18
  v_max_u32 v72, v72, v19
  v_cmp_eq_u32 vcc, -1, v72
  s_cbranch_vccz Cf1_recok
  s_barrier
  v_mov_b64 v[20:21], 0
  v_mov_b64 v[22:23], 0
  v_mov_b64 v[24:25], 0
  v_mov_b64 v[26:27], 0
  v_mov_b64 v[28:29], 0
  v_mov_b64 v[30:31], 0
  v_mov_b64 v[32:33], 0
  v_mov_b64 v[34:35], 0
  s_waitcnt lgkmcnt(0)
  s_barrier
  ds_read_b128 v[0:3], v76 offset:4608
  s_waitcnt lgkmcnt(0)
  v_smfmac_f32_16x16x64_bf16 v[20:23], v[0:3], v[80:87], v74
  v_smfmac_f32_16x16x64_bf16 v[24:27], v[0:3], v[88:95], v74
  ds_read_b128 v[60:63], v76 offset:20480
  ds_read_b128 v[64:67], v76 offset:21504
  s_waitcnt lgkmcnt(0)
  v_smfmac_f32_16x16x64_bf16 v[28:31], v[0:3], v[60:67], v74
  ds_read_b128 v[60:63], v76 offset:22528
  ds_read_b128 v[64:67], v76 offset:23552
  s_waitcnt lgkmcnt(0)
  v_smfmac_f32_16x16x64_bf16 v[32:35], v[0:3], v[60:67], v74
  ds_read_b128 v[4:7], v76 offset:5632
  s_waitcnt lgkmcnt(0)
  v_smfmac_f32_16x16x64_bf16 v[20:23], v[4:7], v[96:103], v74
  v_smfmac_f32_16x16x64_bf16 v[24:27], v[4:7], v[104:111], v74
  ds_read_b128 v[60:63], v76 offset:36864
  ds_read_b128 v[64:67], v76 offset:37888
  s_waitcnt lgkmcnt(0)
  v_smfmac_f32_16x16x64_bf16 v[28:31], v[4:7], v[60:67], v74
  ds_read_b128 v[60:63], v76 offset:38912
  ds_read_b128 v[64:67], v76 offset:39936
  s_waitcnt lgkmcnt(0)
  v_smfmac_f32_16x16x64_bf16 v[32:35], v[4:7], v[60:67], v74
  ds_read_b128 v[8:11], v76 offset:6656
  s_waitcnt lgkmcnt(0)
  v_smfmac_f32_16x16x64_bf16 v[20:23], v[8:11], v[112:119], v74
  v_smfmac_f32_16x16x64_bf16 v[24:27], v[8:11], v[120:127], v74
  v_smfmac_f32_16x16x64_bf16 v[28:31], v[8:11], v[208:215], v74
  v_smfmac_f32_16x16x64_bf16 v[32:35], v[8:11], v[216:223], v74
  ds_read_b128 v[12:15], v76 offset:7680
  s_waitcnt lgkmcnt(0)
  v_smfmac_f32_16x16x64_bf16 v[20:23], v[12:15], v[128:135], v74
  v_smfmac_f32_16x16x64_bf16 v[24:27], v[12:15], v[136:143], v74
  v_smfmac_f32_16x16x64_bf16 v[28:31], v[12:15], v[224:231], v74
  v_smfmac_f32_16x16x64_bf16 v[32:35], v[12:15], v[232:239], v74
  ds_read_b128 v[8:11], v76 offset:8704
  s_waitcnt lgkmcnt(0)
  v_smfmac_f32_16x16x64_bf16 v[20:23], v[8:11], v[144:151], v74
  v_smfmac_f32_16x16x64_bf16 v[24:27], v[8:11], v[152:159], v74
  ds_read_b128 v[60:63], v76 offset:53248
  ds_read_b128 v[64:67], v76 offset:54272
  s_waitcnt lgkmcnt(0)
  v_smfmac_f32_16x16x64_bf16 v[28:31], v[8:11], v[60:67], v74
  ds_read_b128 v[60:63], v76 offset:55296
  ds_read_b128 v[64:67], v76 offset:56320
  s_waitcnt lgkmcnt(0)
  v_smfmac_f32_16x16x64_bf16 v[32:35], v[8:11], v[60:67], v74
  ds_read_b128 v[0:3], v76 offset:9728
  s_waitcnt lgkmcnt(0)
  v_smfmac_f32_16x16x64_bf16 v[20:23], v[0:3], v[160:167], v74
  v_smfmac_f32_16x16x64_bf16 v[24:27], v[0:3], v[168:175], v74
  ds_read_b128 v[60:63], v75 offset:20480
  ds_read_b128 v[64:67], v75 offset:21504
  s_waitcnt lgkmcnt(0)
  v_smfmac_f32_16x16x64_bf16 v[28:31], v[0:3], v[60:67], v74
  ds_read_b128 v[60:63], v75 offset:22528
  ds_read_b128 v[64:67], v75 offset:23552
  s_waitcnt lgkmcnt(0)
  v_smfmac_f32_16x16x64_bf16 v[32:35], v[0:3], v[60:67], v74
  ds_read_b128 v[16:19], v76 offset:10752
  ds_read_b128 v[60:63], v75 offset:4096
  ds_read_b128 v[64:67], v75 offset:5120
  s_waitcnt lgkmcnt(0)
  v_smfmac_f32_16x16x64_bf16 v[20:23], v[16:19], v[60:67], v74
  ds_read_b128 v[60:63], v75 offset:6144
  ds_read_b128 v[64:67], v75 offset:7168
  s_waitcnt lgkmcnt(0)
  v_smfmac_f32_16x16x64_bf16 v[24:27], v[16:19], v[60:67], v74
  v_smfmac_f32_16x16x64_bf16 v[28:31], v[16:19], v[240:247], v74
  v_smfmac_f32_16x16x64_bf16 v[32:35], v[16:19], v[248:255], v74
  ds_read_b128 v[4:7], v76 offset:11776
  s_waitcnt lgkmcnt(0)
  v_smfmac_f32_16x16x64_bf16 v[20:23], v[4:7], v[176:183], v74
  v_smfmac_f32_16x16x64_bf16 v[24:27], v[4:7], v[184:191], v74
  v_smfmac_f32_16x16x64_bf16 v[28:31], v[4:7], a[0:7], v74
  v_smfmac_f32_16x16x64_bf16 v[32:35], v[4:7], a[8:15], v74
  ds_read_b128 v[12:15], v76 offset:12800
  s_waitcnt lgkmcnt(0)
  v_smfmac_f32_16x16x64_bf16 v[20:23], v[12:15], v[192:199], v74
  v_smfmac_f32_16x16x64_bf16 v[24:27], v[12:15], v[200:207], v74
  v_smfmac_f32_16x16x64_bf16 v[28:31], v[12:15], a[16:23], v74
  v_smfmac_f32_16x16x64_bf16 v[32:35], v[12:15], a[24:31], v74
  v_add_f32 v20, v20, v22
  v_add_f32 v21, v21, v23
  v_add_f32 v24, v24, v26
  v_cvt_pk_bf16_f32 v22, v20, v24
  ds_write_b32 v79, v22 offset:0
  v_add_f32 v25, v25, v27
  v_cvt_pk_bf16_f32 v23, v21, v25
  ds_write_b32 v79, v23 offset:576
  v_add_f32 v28, v28, v30
  v_add_f32 v29, v29, v31
  s_waitcnt lgkmcnt(0)
  s_nop 1
  s_branch Cf1_recok
Cf1_mx:
  s_waitcnt lgkmcnt(0)
  s_barrier
  buffer_load_dwordx4 v[0:3], v76, s[8:11], s58 offen offset:0 sc1
  ds_read_b128 v[20:23], v77 offset:0
  ds_read_b128 v[28:31], v77 offset:256
  buffer_load_dwordx4 v[4:7], v76, s[8:11], s58 offen offset:1024 sc1
  ds_read_b128 v[24:27], v77 offset:128
  ds_read_b128 v[32:35], v77 offset:384
  s_waitcnt vmcnt(1) lgkmcnt(3)
  v_mfma_f32_16x16x32_bf16 v[8:11], v[0:3], v[20:23], 0
  s_waitcnt vmcnt(0) lgkmcnt(1)
  v_mfma_f32_16x16x32_bf16 v[8:11], v[4:7], v[24:27], v[8:11]
  v_mfma_f32_16x16x32_bf16 v[12:15], v[28:31], v[20:23], 0
  s_waitcnt lgkmcnt(0)
  v_mfma_f32_16x16x32_bf16 v[12:15], v[32:35], v[24:27], v[12:15]
  v_add_f32_dpp v8, v10, v8 quad_perm:[2,3,0,1] row_mask:0xf bank_mask:0xf
  v_add_f32_dpp v9, v11, v9 quad_perm:[2,3,0,1] row_mask:0xf bank_mask:0xf
  s_nop 0
  v_mov_b32_dpp v8, v8 quad_perm:[0,1,0,1] row_mask:0xf bank_mask:0xf
  v_mov_b32_dpp v9, v9 quad_perm:[0,1,0,1] row_mask:0xf bank_mask:0xf
  s_nop 1
  v_add_f32_dpp v12, v14, v12 quad_perm:[2,3,0,1] row_mask:0xf bank_mask:0xf
  v_add_f32_dpp v13, v15, v13 quad_perm:[2,3,0,1] row_mask:0xf bank_mask:0xf
  s_nop 0
  v_mov_b32_dpp v12, v12 quad_perm:[0,1,0,1] row_mask:0xf bank_mask:0xf
  v_mov_b32_dpp v13, v13 quad_perm:[0,1,0,1] row_mask:0xf bank_mask:0xf
  v_mul_f32 v12, s69, v12
  ds_write_b32 v78, v8 offset:8708
  v_mul_f32 v13, s69, v13
  ds_write_b32 v78, v9 offset:8772
  s_waitcnt lgkmcnt(0)
  s_barrier
  ds_read_b128 v[36:39], v78 offset:8704
  ds_read_b128 v[40:43], v78 offset:8768
  s_waitcnt lgkmcnt(0)
  s_barrier
  v_max_f32 v16, v36, v37
  v_max3_f32 v16, v16, v38, v39
  v_max3_f32 v16, v16, v40, v41
  v_max3_f32 v16, v16, v42, v43
  v_max3_f32 v16, v16, v12, v13
  v_mov_b32 v17, v16
  s_nop 1
  v_permlane16_swap_b32 v16, v17
  v_max_f32 v16, v16, v17
  v_mov_b32 v17, v16
  s_nop 1
  v_permlane32_swap_b32 v16, v17
  v_max_f32 v16, v16, v17
  v_sub_f32 v36, v36, v16
  v_sub_f32 v37, v37, v16
  v_sub_f32 v38, v38, v16
  v_sub_f32 v39, v39, v16
  v_sub_f32 v40, v40, v16
  v_sub_f32 v41, v41, v16
  v_sub_f32 v42, v42, v16
  v_sub_f32 v43, v43, v16
  v_sub_f32 v12, v12, v16
  v_sub_f32 v13, v13, v16
  v_exp_f32 v36, v36
  v_exp_f32 v37, v37
  v_exp_f32 v38, v38
  v_exp_f32 v39, v39
  v_exp_f32 v40, v40
  v_exp_f32 v41, v41
  v_exp_f32 v42, v42
  v_exp_f32 v43, v43
  v_exp_f32 v12, v12
  v_exp_f32 v13, v13
  v_cvt_pk_bf16_f32 v32, v36, v40
  v_cvt_pk_bf16_f32 v33, v37, v41
  v_cvt_pk_bf16_f32 v34, v38, v42
  v_cvt_pk_bf16_f32 v35, v39, v43
  v_cvt_pk_bf16_f32 v28, v12, v13
  v_cvt_pk_bf16_f32 v31, v12, v13
  v_mov_b32 v29, 0
  v_mov_b32 v30, 0
  v_mov_b32 v68, 0x3f803f80
  v_mov_b32 v69, 0x3f803f80
  v_mov_b32 v70, 0x3f803f80
  v_mov_b32 v71, 0x3f803f80
  s_nop 1
  v_mfma_f32_16x16x32_bf16 v[8:11], v[32:35], v[68:71], 0
  v_mfma_f32_16x16x32_bf16 v[0:3], v[32:35], v[52:55], 0
  v_mfma_f32_16x16x32_bf16 v[4:7], v[32:35], v[56:59], 0
  v_mfma_f32_16x16x16_bf16 v[8:11], v[28:29], v[68:69], v[8:11]
  v_mfma_f32_16x16x16_bf16 v[0:3], v[28:29], v[72:73], v[0:3]
  v_mfma_f32_16x16x16_bf16 v[4:7], v[30:31], v[72:73], v[4:7]
  ds_read_b128 v[68:71], v76 offset:13824
  v_rcp_f32 v10, v8
  v_rcp_f32 v11, v9
  v_mul_f32 v0, v10, v0
  v_mul_f32 v1, v11, v1
  s_nop 0
  v_mul_f32 v4, v10, v4
  v_mul_f32 v5, v11, v5
  v_cvt_pk_bf16_f32 v2, v0, v4
  ds_write_b32 v79, v2 offset:8704
  v_cvt_pk_bf16_f32 v3, v1, v5
  ds_write_b32 v79, v3 offset:9280
  v_mov_b64 v[16:17], 0
  v_mov_b64 v[18:19], 0
  v_mov_b64 v[20:21], 0
  v_mov_b64 v[22:23], 0
  v_mov_b64 v[24:25], 0
  v_mov_b64 v[26:27], 0
  s_branch Cf1_mxok
Cf1_last:
  ds_read_b128 v[4:7], v76 offset:5632
  ds_read_b128 v[12:15], v76 offset:7680
  ds_read_b128 v[44:47], v76 offset:36864
  ds_read_b128 v[48:51], v76 offset:37888
  s_nop 5
  v_mov_b64 v[20:21], 0
  v_mov_b64 v[22:23], 0
  v_mov_b64 v[24:25], 0
  v_mov_b64 v[26:27], 0
  s_waitcnt lgkmcnt(4)
  v_smfmac_f32_16x16x64_bf16 v[28:31], v[0:3], v[36:43], v74
  ds_read_b128 v[36:39], v76 offset:38912
  ds_read_b128 v[40:43], v76 offset:39936
  v_smfmac_f32_16x16x64_bf16 v[32:35], v[0:3], v[60:67], v74
  s_waitcnt lgkmcnt(5)
  v_smfmac_f32_16x16x64_bf16 v[20:23], v[0:3], a[32:39], v74
  ds_read_b128 v[60:63], v76 offset:53248
  ds_read_b128 v[64:67], v76 offset:54272
  v_smfmac_f32_16x16x64_bf16 v[24:27], v[0:3], a[40:47], v74
  s_waitcnt lgkmcnt(4)
  v_smfmac_f32_16x16x64_bf16 v[20:23], v[4:7], a[48:55], v74
  buffer_store_dwordx4 v[16:19], v76, s[8:11], s68 offen sc1
  v_smfmac_f32_16x16x64_bf16 v[24:27], v[4:7], a[56:63], v74
  v_smfmac_f32_16x16x64_bf16 v[28:31], v[4:7], v[44:51], v74
  s_waitcnt lgkmcnt(2)
  v_smfmac_f32_16x16x64_bf16 v[20:23], v[8:11], a[64:71], v74
  ds_read_b128 v[44:47], v76 offset:55296
  ds_read_b128 v[48:51], v76 offset:56320
  v_smfmac_f32_16x16x64_bf16 v[24:27], v[8:11], a[72:79], v74
  v_smfmac_f32_16x16x64_bf16 v[32:35], v[4:7], v[36:43], v74
  v_smfmac_f32_16x16x64_bf16 v[28:31], v[8:11], v[208:215], v74
  ds_read_b128 v[36:39], v75 offset:20480
  ds_read_b128 v[40:43], v75 offset:21504
  v_smfmac_f32_16x16x64_bf16 v[32:35], v[8:11], v[216:223], v74
  v_smfmac_f32_16x16x64_bf16 v[20:23], v[12:15], a[80:87], v74
  v_smfmac_f32_16x16x64_bf16 v[24:27], v[12:15], a[88:95], v74
  v_smfmac_f32_16x16x64_bf16 v[28:31], v[12:15], v[224:231], v74
  v_smfmac_f32_16x16x64_bf16 v[32:35], v[12:15], v[232:239], v74
  s_waitcnt vmcnt(2)
  s_waitcnt vmcnt(1)
  s_barrier
Cf1_lastr:
  ds_read_b128 v[8:11], v76 offset:8704
  ds_read_b128 v[0:3], v76 offset:9728
  ds_read_b128 v[16:19], v76 offset:10752
  ds_read_b128 v[4:7], v76 offset:11776
  ds_read_b128 v[12:15], v76 offset:12800
  s_waitcnt lgkmcnt(3)
  v_max3_u32 v72, v0, v1, v2
  s_waitcnt lgkmcnt(1)
  v_max3_u32 v72, v72, v3, v4
  v_max3_u32 v72, v72, v5, v6
  v_max3_u32 v72, v72, v7, v8
  v_max3_u32 v72, v72, v9, v10
  s_waitcnt lgkmcnt(0)
  v_max3_u32 v72, v72, v11, v12
  v_max3_u32 v72, v72, v13, v14
  v_max3_u32 v72, v72, v15, v16
  v_max3_u32 v72, v72, v17, v18
  v_max_u32 v72, v72, v19
  v_cmp_eq_u32 vcc, -1, v72
  s_cbranch_vccnz Cf1_lastp
Cf1_lastg:
  v_smfmac_f32_16x16x64_bf16 v[28:31], v[8:11], v[60:67], v74
  ds_read_b128 v[60:63], v75 offset:22528
  ds_read_b128 v[64:67], v75 offset:23552
  v_smfmac_f32_16x16x64_bf16 v[32:35], v[8:11], v[44:51], v74
  v_smfmac_f32_16x16x64_bf16 v[28:31], v[0:3], v[36:43], v74
  v_smfmac_f32_16x16x64_bf16 v[28:31], v[16:19], v[240:247], v74
  v_smfmac_f32_16x16x64_bf16 v[28:31], v[4:7], a[0:7], v74
  v_smfmac_f32_16x16x64_bf16 v[28:31], v[12:15], a[16:23], v74
  v_smfmac_f32_16x16x64_bf16 v[32:35], v[16:19], v[248:255], v74
  v_smfmac_f32_16x16x64_bf16 v[32:35], v[4:7], a[8:15], v74
  s_waitcnt lgkmcnt(0)
  v_smfmac_f32_16x16x64_bf16 v[32:35], v[12:15], a[24:31], v74
  v_smfmac_f32_16x16x64_bf16 v[32:35], v[0:3], v[60:67], v74
  v_smfmac_f32_16x16x64_bf16 v[20:23], v[8:11], a[96:103], v74
  v_smfmac_f32_16x16x64_bf16 v[20:23], v[0:3], a[112:119], v74
  v_add_f32 v28, v28, v30
  v_add_f32 v32, v32, v34
  v_cvt_pk_bf16_f32 v30, v28, v32
  v_smfmac_f32_16x16x64_bf16 v[20:23], v[16:19], a[128:135], v74
  ds_write_b32 v79, v30 offset:256
  v_add_f32 v29, v29, v31
  v_add_f32 v33, v33, v35
  v_cvt_pk_bf16_f32 v31, v29, v33
  v_smfmac_f32_16x16x64_bf16 v[20:23], v[4:7], a[144:151], v74
  ds_write_b32 v79, v31 offset:832
  v_smfmac_f32_16x16x64_bf16 v[20:23], v[12:15], a[160:167], v74
  v_smfmac_f32_16x16x64_bf16 v[24:27], v[8:11], a[104:111], v74
  v_smfmac_f32_16x16x64_bf16 v[24:27], v[0:3], a[120:127], v74
  v_smfmac_f32_16x16x64_bf16 v[24:27], v[16:19], a[136:143], v74
  s_waitcnt lgkmcnt(0)
  s_barrier
  ds_read_b64 v[52:53], v77 offset:264
  v_add_f32 v20, v20, v22
  v_smfmac_f32_16x16x64_bf16 v[24:27], v[4:7], a[152:159], v74
  v_add_f32 v21, v21, v23
  v_smfmac_f32_16x16x64_bf16 v[24:27], v[12:15], a[168:175], v74
  v_cvt_pk_bf16_f32 v54, v20, v21
  s_add_u32 s68, s68, 655360
  s_nop 3
  v_add_f32 v24, v24, v26
  v_add_f32 v25, v25, v27
  v_cvt_pk_bf16_f32 v55, v24, v25
  s_waitcnt lgkmcnt(0)
  buffer_store_dwordx4 v[52:55], v76, s[8:11], s68 offen sc1
  s_branch Cf1_done
Cf1_lastp:
  s_add_u32 s72, s72, 2
  s_cmp_ge_u32 s72, 131072
  s_cbranch_scc1 Cf1_lastg
  s_barrier
  buffer_load_dwordx4 v76, s[8:11], s85 offen offset:0 sc1 lds
  s_waitcnt vmcnt(0)
  s_barrier
  s_branch Cf1_lastr
Cf1_done:
  s_branch L_cexit
L_w2:
  v_mov_b64 v[20:21], 0
  v_mov_b64 v[22:23], 0
  v_mov_b64 v[24:25], 0
  v_mov_b64 v[26:27], 0
  v_mov_b64 v[28:29], 0
  v_mov_b64 v[30:31], 0
  v_mov_b64 v[32:33], 0
  v_mov_b64 v[34:35], 0
  s_mov_b32 s78, 0x3f803f80
  s_mov_b32 s79, s78
  s_mov_b32 s65, 360448
  s_mov_b32 m0, 15872
  s_lshl_b32 s71, s53, 2
  s_add_u32 s71, s71, 128
  s_movk_i32 s56, 0x1000
  v_lshlrev_b32 v73, 2, v76
  v_mov_b32 v72, 0
  s_mov_b64 s[16:17], s[8:9]
  s_mov_b32 s18, 268435456
  s_mov_b32 s19, 0x20000
  s_getpc_b64 s[20:21]
Cf2_pc:
  s_add_u32 s20, s20, (Cf2_last - Cf2_pc)
  s_addc_u32 s21, s21, 0
  v_mov_b32 v68, 14880
  buffer_load_dwordx4 v[52:55], v76, s[8:11], s59 offen offset:0 sc1
  buffer_load_dwordx4 v[56:59], v76, s[8:11], s59 offen offset:1024 sc1
  ds_read_b128 v[36:39], v76 offset:24576
  ds_read_b128 v[40:43], v76 offset:25600
  ds_read_b128 v[60:63], v76 offset:26624
  ds_read_b128 v[64:67], v76 offset:27648
  ds_read_b128 v[0:3], v76 offset:4608
  ds_read_b128 v[4:7], v76 offset:5632
  ds_read_b128 v[8:11], v76 offset:6656
  ds_read_b128 v[12:15], v76 offset:7680
  s_waitcnt lgkmcnt(0)
  s_cmp_eq_u32 s66, 1
  s_branch Cf2_top2
.p2align 6
Cf2_h2:
  s_cmp_eq_u32 s66, 62
  s_cselect_b64 s[16:17], s[20:21], s[16:17]
  s_cselect_b32 s18, (Cf2_done - Cf2_last), s18
  s_cselect_b32 s70, 0, s70
  s_cmp_eq_u32 s66, 63
  s_cselect_b32 s59, 268435456, s59
  s_cselect_b32 s58, 268435456, s58
  buffer_load_dwordx4 v[12:15], v76, s[8:11], s65 offen offset:3072 sc1
  ds_read_b128 v[36:39], v76 offset:24576
  s_waitcnt lgkmcnt(0)
  v_mov_b64 v[28:29], 0
  v_mov_b64 v[30:31], 0
  v_mov_b64 v[32:33], 0
  v_mov_b64 v[34:35], 0
  v_lshlrev_b32 v73, 2, v76
  buffer_load_dwordx4 v[12:15], v76, s[8:11], s65 offen offset:3072 sc1
  ds_read_b128 v[40:43], v76 offset:25600
  s_waitcnt lgkmcnt(0)
  v_mov_b64 v[20:21], 0
  v_mov_b64 v[22:23], 0
  v_mov_b64 v[24:25], 0
  v_mov_b64 v[26:27], 0
  v_mov_b32 v68, 14880
  buffer_load_dwordx4 v[12:15], v76, s[8:11], s65 offen offset:3072 sc1
  buffer_load_dwordx4 v[52:55], v76, s[8:11], s59 offen offset:0 sc1
  buffer_load_dwordx4 v[56:59], v76, s[8:11], s59 offen offset:1024 sc1
  s_waitcnt vmcnt(4)
  v_max3_u32 v72, v12, v13, v14
  v_max_u32 v72, v72, v15
  ds_write_b128 v76, v[12:15] offset:7680
  v_cmp_eq_u32 vcc, -1, v72
  s_cbranch_vccnz Cf2_h2r
Cf2_h2w:
  s_cmp_eq_u32 s66, 63
  s_waitcnt lgkmcnt(0)
  s_barrier
  ds_read_b128 v[0:3], v76 offset:4608
  buffer_load_dwordx4 v76, s[8:11], s85 offen offset:0 sc1 lds
Cf2_top2:
  v_smfmac_f32_16x16x64_bf16 v[20:23], v[12:15], v[128:135], v74
  s_cbranch_scc1 Cf2_last
  v_smfmac_f32_16x16x64_bf16 v[24:27], v[12:15], v[136:143], v74
  buffer_load_dwordx4 v[44:47], v76, s[8:11], s58 offen offset:0 sc1
  s_mov_b32 m0, 15872
  v_smfmac_f32_16x16x64_bf16 v[28:31], v[12:15], v[224:231], v74
  buffer_load_dwordx4 v[48:51], v76, s[8:11], s58 offen offset:1024 sc1
  v_smfmac_f32_16x16x64_bf16 v[32:35], v[12:15], v[232:239], v74
  ds_read_b128 v[4:7], v76 offset:5632
  s_waitcnt lgkmcnt(1)
  v_smfmac_f32_16x16x64_bf16 v[20:23], v[0:3], v[80:87], v74
  ds_read_b128 v[8:11], v76 offset:6656
  v_smfmac_f32_16x16x64_bf16 v[28:31], v[0:3], v[36:43], v74
  ds_read_b128 v[36:39], v76 offset:40960
  v_smfmac_f32_16x16x64_bf16 v[24:27], v[0:3], v[88:95], v74
  buffer_store_dwordx4 v[16:19], v76, s[8:11], s68 offen sc1
  ds_read_b128 v[40:43], v76 offset:41984
  v_smfmac_f32_16x16x64_bf16 v[32:35], v[0:3], v[60:67], v74
  buffer_load_dword v73, s[16:19], s70 offen lds
  ds_read_b128 v[60:63], v76 offset:43008
  s_waitcnt lgkmcnt(4)
  v_smfmac_f32_16x16x64_bf16 v[20:23], v[4:7], v[96:103], v74
  ds_read_b128 v[64:67], v76 offset:44032
  v_smfmac_f32_16x16x64_bf16 v[24:27], v[4:7], v[104:111], v74
  s_waitcnt vmcnt(5)
  s_waitcnt lgkmcnt(4)
  v_smfmac_f32_16x16x64_bf16 v[20:23], v[8:11], v[112:119], v74
  s_barrier
  ds_read_b128 v[12:15], v76 offset:8704
  s_waitcnt lgkmcnt(3)
  v_smfmac_f32_16x16x64_bf16 v[28:31], v[4:7], v[36:43], v74
  ds_read_b128 v[36:39], v76 offset:57344
  v_smfmac_f32_16x16x64_bf16 v[24:27], v[8:11], v[120:127], v74
  ds_read_b128 v[40:43], v76 offset:58368
  s_waitcnt lgkmcnt(3)
  v_smfmac_f32_16x16x64_bf16 v[32:35], v[4:7], v[60:67], v74
  ds_read_b128 v[0:3], v76 offset:9728
  v_smfmac_f32_16x16x64_bf16 v[28:31], v[8:11], v[208:215], v74
  ds_read_b128 v[60:63], v76 offset:59392
  v_smfmac_f32_16x16x64_bf16 v[32:35], v[8:11], v[216:223], v74
  s_waitcnt vmcnt(4)
  ds_read_b128 v[64:67], v76 offset:60416
  s_waitcnt lgkmcnt(5)
  v_smfmac_f32_16x16x64_bf16 v[20:23], v[12:15], v[144:151], v74
  s_barrier
  ds_read_b128 v[4:7], v76 offset:11776
  s_waitcnt lgkmcnt(4)
  v_smfmac_f32_16x16x64_bf16 v[28:31], v[12:15], v[36:43], v74
  ds_read_b128 v[8:11], v76 offset:12800
  ds_read_b128 v[36:39], v75 offset:8192
  v_smfmac_f32_16x16x64_bf16 v[24:27], v[12:15], v[152:159], v74
  ds_read_b128 v[16:19], v76 offset:10752
  s_waitcnt lgkmcnt(6)
  v_smfmac_f32_16x16x64_bf16 v[20:23], v[0:3], v[160:167], v74
  ds_read_b128 v[40:43], v75 offset:9216
  s_waitcnt lgkmcnt(5)
  v_smfmac_f32_16x16x64_bf16 v[32:35], v[12:15], v[60:67], v74
  ds_read_b128 v[60:63], v75 offset:10240
  v_smfmac_f32_16x16x64_bf16 v[24:27], v[0:3], v[168:175], v74
  ds_read_b128 v[64:67], v75 offset:11264
  s_waitcnt lgkmcnt(6)
  v_smfmac_f32_16x16x64_bf16 v[20:23], v[4:7], v[176:183], v74
  s_waitcnt lgkmcnt(5)
  v_smfmac_f32_16x16x64_bf16 v[20:23], v[8:11], v[192:199], v74
  s_waitcnt lgkmcnt(2)
  v_smfmac_f32_16x16x64_bf16 v[20:23], v[16:19], v[36:43], v74
  ds_read_b128 v[36:39], v75 offset:24576
  v_smfmac_f32_16x16x64_bf16 v[24:27], v[4:7], v[184:191], v74
  ds_read_b128 v[40:43], v75 offset:25600
  s_waitcnt lgkmcnt(2)
  v_smfmac_f32_16x16x64_bf16 v[24:27], v[16:19], v[60:67], v74
  ds_read_b128 v[60:63], v75 offset:26624
  v_add_f32 v20, v20, v22
  v_smfmac_f32_16x16x64_bf16 v[24:27], v[8:11], v[200:207], v74
  ds_read_b128 v[64:67], v75 offset:27648
  v_add_f32 v21, v21, v23
  v_smfmac_f32_16x16x64_bf16 v[28:31], v[16:19], v[240:247], v74
  v_mov_b64 v[70:71], s[78:79]
  v_smfmac_f32_16x16x64_bf16 v[28:31], v[4:7], a[0:7], v74
  s_waitcnt lgkmcnt(2)
  v_add_f32 v24, v24, v26
  v_smfmac_f32_16x16x64_bf16 v[28:31], v[0:3], v[36:43], v74
  ds_read_b128 v[36:39], v68
  v_cvt_pk_bf16_f32 v22, v20, v24
  v_smfmac_f32_16x16x64_bf16 v[28:31], v[8:11], a[16:23], v74
  ds_read_b128 v[40:43], v68
  ds_write_b32 v79, v22 offset:0
  s_waitcnt lgkmcnt(3)
  v_add_f32 v25, v25, v27
  v_cvt_pk_bf16_f32 v23, v21, v25
  v_smfmac_f32_16x16x64_bf16 v[32:35], v[0:3], v[60:67], v74
  ds_write_b32 v79, v23 offset:576
  v_cmp_u_f32 vcc, v20, v21
  v_smfmac_f32_16x16x64_bf16 v[32:35], v[16:19], v[248:255], v74
  v_add_f32 v28, v28, v30
  v_smfmac_f32_16x16x64_bf16 v[32:35], v[4:7], a[8:15], v74
  v_add_f32 v29, v29, v31
  v_smfmac_f32_16x16x64_bf16 v[32:35], v[8:11], a[24:31], v74
  s_cbranch_vccnz Cf2_rec
Cf2_recok:
  s_waitcnt lgkmcnt(3)
  v_smfmac_f32_16x16x64_bf16 v[36:39], v[16:19], a[128:135], v74
  s_waitcnt lgkmcnt(0)
  s_barrier
  ds_read_b128 v[60:63], v77
  v_smfmac_f32_16x16x64_bf16 v[40:43], v[16:19], a[136:143], v74
  ds_read_b128 v[64:67], v77 offset:128
  v_add_f32 v32, v32, v34
  v_cvt_pk_bf16_f32 v30, v28, v32
  v_smfmac_f32_16x16x64_bf16 v[36:39], v[0:3], a[112:119], v74
  ds_write_b32 v79, v30 offset:256
  v_add_f32 v33, v33, v35
  v_cvt_pk_bf16_f32 v31, v29, v33
  v_smfmac_f32_16x16x64_bf16 v[40:43], v[0:3], a[120:127], v74
  ds_write_b32 v79, v31 offset:832
  v_xor_b32 v75, 0x8000, v75
  v_smfmac_f32_16x16x64_bf16 v[36:39], v[4:7], a[144:151], v74
  ds_read_b128 v[0:3], v76 offset:4608
  v_mov_b32 v29, 0
  v_smfmac_f32_16x16x64_bf16 v[40:43], v[4:7], a[152:159], v74
  s_waitcnt vmcnt(2) lgkmcnt(3)
  v_mov_b32 v30, 0
  v_mfma_f32_16x16x32_bf16 v[44:47], v[44:47], v[60:63], 0
  ds_read_b128 v[4:7], v76 offset:5632
  s_waitcnt lgkmcnt(2)
  v_mfma_f32_16x16x32_bf16 v[44:47], v[48:51], v[64:67], v[44:47]
  s_barrier
  v_smfmac_f32_16x16x64_bf16 v[36:39], v[8:11], a[160:167], v74
  ds_read_b128 v[20:23], v77 offset:256
  ds_read_b128 v[24:27], v77 offset:384
  v_smfmac_f32_16x16x64_bf16 v[40:43], v[8:11], a[168:175], v74
  ds_read_b128 v[8:11], v76 offset:6656
  v_add_f32_dpp v72, v46, v44 quad_perm:[2,3,0,1] row_mask:0xf bank_mask:0xf
  v_add_f32_dpp v73, v47, v45 quad_perm:[2,3,0,1] row_mask:0xf bank_mask:0xf
  v_smfmac_f32_16x16x64_bf16 v[36:39], v[12:15], a[96:103], v74
  s_waitcnt lgkmcnt(4)
  v_exp_f32_dpp v72, v72 quad_perm:[0,1,0,1] row_mask:0xf bank_mask:0xf
  v_smfmac_f32_16x16x64_bf16 v[40:43], v[12:15], a[104:111], v74
  ds_read_b128 v[12:15], v76 offset:7680
  v_exp_f32_dpp v73, v73 quad_perm:[0,1,0,1] row_mask:0xf bank_mask:0xf
  v_smfmac_f32_16x16x64_bf16 v[36:39], v[0:3], a[32:39], v74
  s_waitcnt lgkmcnt(2)
  v_cvt_pk_bf16_f32 v72, v72, v73
  v_mfma_f32_16x16x32_bf16 v[20:23], v[20:23], v[60:63], 0
  ds_write_b32 v78, v72 offset:520
  v_mov_b64 v[16:17], 0
  v_mfma_f32_16x16x32_bf16 v[20:23], v[24:27], v[64:67], v[20:23]
  ds_read_b128 v[44:47], v75 offset:24576
  v_mov_b64 v[18:19], 0
  v_smfmac_f32_16x16x64_bf16 v[40:43], v[0:3], a[40:47], v74
  ds_read_b128 v[48:51], v75 offset:25600
  v_mov_b64 v[68:69], s[78:79]
  v_smfmac_f32_16x16x64_bf16 v[36:39], v[4:7], a[48:55], v74
  s_waitcnt lgkmcnt(4)
  v_add_f32_dpp v24, v22, v20 quad_perm:[2,3,0,1] row_mask:0xf bank_mask:0xf
  v_add_f32_dpp v25, v23, v21 quad_perm:[2,3,0,1] row_mask:0xf bank_mask:0xf
  v_smfmac_f32_16x16x64_bf16 v[36:39], v[8:11], a[64:71], v74
  s_waitcnt lgkmcnt(2)
  s_barrier
  ds_read_b128 v[32:35], v78 offset:512
  v_smfmac_f32_16x16x64_bf16 v[36:39], v[12:15], a[80:87], v74
  ds_read_b128 v[60:63], v75 offset:26624
  v_mul_f32 v24, s69, v24
  v_smfmac_f32_16x16x64_bf16 v[40:43], v[4:7], a[56:63], v74
  ds_read_b128 v[64:67], v75 offset:27648
  v_mul_f32 v25, s69, v25
  v_smfmac_f32_16x16x64_bf16 v[40:43], v[8:11], a[72:79], v74
  v_exp_f32_dpp v24, v24 quad_perm:[0,1,0,1] row_mask:0xf bank_mask:0xf
  v_smfmac_f32_16x16x64_bf16 v[40:43], v[12:15], a[88:95], v74
  s_waitcnt lgkmcnt(2)
  v_exp_f32_dpp v25, v25 quad_perm:[0,1,0,1] row_mask:0xf bank_mask:0xf
  v_mfma_f32_16x16x32_bf16 v[8:11], v[32:35], v[68:71], 0
  v_add_f32 v36, v36, v38
  v_add_f32 v37, v37, v39
  v_mfma_f32_16x16x32_bf16 v[0:3], v[32:35], v[52:55], 0
  v_add_f32 v40, v40, v42
  v_add_f32 v41, v41, v43
  v_mfma_f32_16x16x32_bf16 v[4:7], v[32:35], v[56:59], 0
  v_cvt_pk_bf16_f32 v28, v24, v25
  v_cvt_pk_bf16_f32 v72, v36, v37
  v_cvt_pk_bf16_f32 v73, v40, v41
  v_mfma_f32_16x16x16_bf16 v[8:11], v[28:29], v[68:69], v[8:11]
  v_cvt_pk_bf16_f32 v31, v24, v25
  v_mov_b64 v[20:21], 0
  v_mfma_f32_16x16x16_bf16 v[0:3], v[28:29], v[72:73], v[0:3]
  ds_read_b128 v[68:71], v76 offset:13824
  v_mov_b64 v[22:23], 0
  v_mfma_f32_16x16x16_bf16 v[4:7], v[30:31], v[72:73], v[4:7]
  v_rcp_f32 v10, v8
  v_rcp_f32 v11, v9
  v_mul_f32 v0, v10, v0
  v_mul_f32 v1, v11, v1
  s_nop 0
  v_mul_f32 v4, v10, v4
  v_mul_f32 v5, v11, v5
  v_cvt_pk_bf16_f32 v2, v0, v4
  ds_write_b32 v79, v2 offset:8704
  v_cvt_pk_bf16_f32 v3, v1, v5
  ds_write_b32 v79, v3 offset:9280
  v_max3_f32 v8, v8, v9, v10
  v_max_f32 v8, v8, v11
  v_cmp_le_f32 vcc, 1317011456, v8
  v_mov_b64 v[24:25], 0
  v_mov_b64 v[26:27], 0
  s_cbranch_vccnz Cf2_mx
Cf2_mxok:
  s_waitcnt lgkmcnt(0)
  s_barrier
  ds_read_b128 v[0:3], v78 offset:8704
  ds_read_b128 v[4:7], v78 offset:8768
  ds_read_b128 v[8:11], v78 offset:8832
  ds_read_b128 v[12:15], v78 offset:8896
  s_waitcnt lgkmcnt(3)
  v_smfmac_f32_16x16x64_bf16 v[16:19], v[0:3], v[44:51], v74
  ds_read_b128 v[52:55], v75 offset:40960
  s_waitcnt lgkmcnt(3)
  v_smfmac_f32_16x16x64_bf16 v[16:19], v[4:7], v[60:67], v74
  ds_read_b128 v[56:59], v75 offset:41984
  s_waitcnt lgkmcnt(3)
  v_smfmac_f32_16x16x64_bf16 v[16:19], v[8:11], a[176:183], v74
  ds_read_b128 v[36:39], v75 offset:43008
  s_waitcnt lgkmcnt(3)
  v_smfmac_f32_16x16x64_bf16 v[16:19], v[12:15], a[184:191], v74
  ds_read_b128 v[40:43], v75 offset:44032
  ds_read_b128 v[44:47], v75 offset:57344
  v_smfmac_f32_16x16x64_bf16 v[20:23], v[0:3], a[192:199], v74
  ds_read_b128 v[48:51], v75 offset:58368
  ds_read_b128 v[60:63], v75 offset:59392
  v_smfmac_f32_16x16x64_bf16 v[20:23], v[4:7], a[200:207], v74
  ds_read_b128 v[64:67], v75 offset:60416
  s_waitcnt lgkmcnt(6)
  v_cvt_pk_bf16_f32 v16, v16, v17
  v_cvt_pk_bf16_f32 v17, v18, v19
  v_bfi_b32 v16, 1, s72, v16
  v_smfmac_f32_16x16x64_bf16 v[20:23], v[8:11], v[52:59], v74
  buffer_store_dwordx2 v[16:17], v68, s[8:11], s73 offen
  s_waitcnt lgkmcnt(4)
  v_smfmac_f32_16x16x64_bf16 v[20:23], v[12:15], v[36:43], v74
  ds_read_b128 v[52:55], v75 offset:0
  v_mov_b64 v[32:33], 0
  v_smfmac_f32_16x16x64_bf16 v[24:27], v[0:3], a[208:215], v74
  ds_read_b128 v[56:59], v75 offset:1024
  v_mov_b64 v[34:35], 0
  v_smfmac_f32_16x16x64_bf16 v[24:27], v[4:7], a[216:223], v74
  ds_read_b128 v[36:39], v75 offset:2048
  s_waitcnt lgkmcnt(5)
  v_cvt_pk_bf16_f32 v20, v20, v21
  v_cvt_pk_bf16_f32 v21, v22, v23
  v_bfi_b32 v20, 1, s72, v20
  v_smfmac_f32_16x16x64_bf16 v[24:27], v[8:11], v[44:51], v74
  buffer_store_dwordx2 v[20:21], v68, s[8:11], s74 offen
  s_waitcnt lgkmcnt(3)
  v_smfmac_f32_16x16x64_bf16 v[24:27], v[12:15], v[60:67], v74
  ds_read_b128 v[40:43], v75 offset:3072
  v_mov_b64 v[28:29], 0
  v_smfmac_f32_16x16x64_bf16 v[32:35], v[0:3], a[224:231], v74
  ds_read_b128 v[44:47], v75 offset:4096
  ds_read_b128 v[48:51], v75 offset:5120
  v_smfmac_f32_16x16x64_bf16 v[32:35], v[4:7], a[232:239], v74
  ds_read_b128 v[60:63], v75 offset:6144
  v_cvt_pk_bf16_f32 v24, v24, v25
  v_cvt_pk_bf16_f32 v25, v26, v27
  v_bfi_b32 v24, 1, s72, v24
  v_smfmac_f32_16x16x64_bf16 v[32:35], v[8:11], a[240:247], v74
  buffer_store_dwordx2 v[24:25], v68, s[8:11], s75 offen
  v_mov_b64 v[30:31], 0
  v_smfmac_f32_16x16x64_bf16 v[32:35], v[12:15], a[248:255], v74
  ds_read_b128 v[64:67], v75 offset:7168
  s_waitcnt lgkmcnt(6)
  v_smfmac_f32_16x16x64_bf16 v[28:31], v[0:3], v[52:59], v74
  s_waitcnt lgkmcnt(4)
  v_smfmac_f32_16x16x64_bf16 v[28:31], v[4:7], v[36:43], v74
  s_waitcnt lgkmcnt(2)
  v_cvt_pk_bf16_f32 v32, v32, v33
  v_cvt_pk_bf16_f32 v33, v34, v35
  v_bfi_b32 v32, 1, s72, v32
  v_smfmac_f32_16x16x64_bf16 v[28:31], v[8:11], v[44:51], v74
  buffer_store_dwordx2 v[32:33], v68, s[8:11], s76 offen
  s_waitcnt lgkmcnt(0)
  v_smfmac_f32_16x16x64_bf16 v[28:31], v[12:15], v[60:67], v74
  v_mov_b64 v[18:19], v[72:73]
  s_nop 4
  v_cvt_pk_bf16_f32 v28, v28, v29
  v_cvt_pk_bf16_f32 v29, v30, v31
  v_bfi_b32 v28, 1, s72, v28
  buffer_store_dwordx2 v[28:29], v68, s[8:11], s77 offen
  ds_read_b128 v[0:3], v76 offset:14848
  s_waitcnt lgkmcnt(0)
  ds_read_b64 v[16:17], v77 offset:384
  s_waitcnt lgkmcnt(0)
  ds_read_b128 v[64:67], v76 offset:27648
  s_waitcnt lgkmcnt(0)
  ds_read_b128 v[60:63], v76 offset:26624
  s_waitcnt lgkmcnt(0)
  buffer_load_dwordx4 v[52:55], v76, s[8:11], s60 offen offset:0 sc1
  buffer_load_dwordx4 v[56:59], v76, s[8:11], s60 offen offset:1024 sc1
  s_add_u32 s66, s66, 1
  s_xor_b32 s64, s64, 16384
  s_xor_b32 s65, s65, 16384
  s_add_u32 s58, s58, 655360
  s_add_u32 s59, s59, 655360
  s_add_u32 s70, s70, 655360
  s_add_u32 s68, s68, 655360
  s_mov_b32 m0, 12800
  s_add_u32 s85, s65, 8192
  v_xor_b32 v75, 0x8000, v75
  s_waitcnt lgkmcnt(0)
  s_waitcnt vmcnt(1)
  v_mfma_f32_16x16x32_bf16 v[4:7], v[0:3], v[52:55], 0
  v_bitop3_b32 v72, v52, v54, s72 bitop3:0x7e
  s_waitcnt vmcnt(0)
  v_mfma_f32_16x16x32_bf16 v[4:7], v[0:3], v[56:59], v[4:7]
  v_bitop3_b32 v73, v56, v58, s72 bitop3:0x7e
  v_bitop3_b32 v72, v72, v73, 1 bitop3:0xa8
  v_cmp_ne_u32 vcc, 0, v72
  s_nop 3
  v_add_f32_dpp v4, v4, v4 row_ror:4 row_mask:0xf bank_mask:0xf
  v_add_f32_dpp v5, v5, v5 row_ror:4 row_mask:0xf bank_mask:0xf
  s_cmp_eq_u64 vcc, 0
  v_add_f32_dpp v4, v4, v4 row_ror:8 row_mask:0xf bank_mask:0xf
  v_add_f32_dpp v5, v5, v5 row_ror:8 row_mask:0xf bank_mask:0xf
  s_cselect_b32 s54, s62, 268435456
  v_cvt_pk_bf16_f32 v4, v4, v5
  buffer_store_dword v4, v69, s[8:11], s54 offen
  s_cbranch_vccnz Cf2_h1r
  s_xor_b32 s62, s62, 16384
  buffer_store_dword v71, v69, s[8:11], s62 offen
  s_xor_b32 s72, s72, 1
  s_branch Cf2_h2
Cf2_h1r:
  s_mov_b64 exec, vcc
  buffer_load_dwordx4 v[52:55], v76, s[8:11], s60 offen offset:0 sc1
  buffer_load_dwordx4 v[56:59], v76, s[8:11], s60 offen offset:1024 sc1
  s_mov_b64 exec, -1
  s_add_u32 s67, s67, 1
  s_waitcnt vmcnt(1)
  v_mfma_f32_16x16x32_bf16 v[4:7], v[0:3], v[52:55], 0
  v_bitop3_b32 v72, v52, v54, s72 bitop3:0x7e
  s_waitcnt vmcnt(0)
  v_mfma_f32_16x16x32_bf16 v[4:7], v[0:3], v[56:59], v[4:7]
  v_bitop3_b32 v73, v56, v58, s72 bitop3:0x7e
  v_bitop3_b32 v72, v72, v73, 1 bitop3:0xa8
  v_cmp_ne_u32 vcc, 0, v72
  s_cbranch_vccz Cf2_h1p
Cf2_h1s:
  s_mov_b64 exec, vcc
  buffer_load_dwordx4 v[52:55], v76, s[8:11], s60 offen offset:0 sc1
  buffer_load_dwordx4 v[56:59], v76, s[8:11], s60 offen offset:1024 sc1
  s_mov_b64 exec, -1
  s_add_u32 s67, s67, 1
  s_waitcnt vmcnt(1)
  v_mfma_f32_16x16x32_bf16 v[4:7], v[0:3], v[52:55], 0
  v_bitop3_b32 v72, v52, v54, s72 bitop3:0x7e
  s_waitcnt vmcnt(0)
  v_mfma_f32_16x16x32_bf16 v[4:7], v[0:3], v[56:59], v[4:7]
  v_bitop3_b32 v73, v56, v58, s72 bitop3:0x7e
  v_bitop3_b32 v72, v72, v73, 1 bitop3:0xa8
  v_cmp_ne_u32 vcc, 0, v72
  s_cbranch_vccz Cf2_h1p
  s_cmp_lt_u32 s67, 131072
  s_cbranch_scc1 Cf2_h1s
Cf2_h1p:
  s_nop 2
  v_add_f32_dpp v4, v4, v4 row_ror:4 row_mask:0xf bank_mask:0xf
  v_add_f32_dpp v5, v5, v5 row_ror:4 row_mask:0xf bank_mask:0xf
  s_nop 0
  v_add_f32_dpp v4, v4, v4 row_ror:8 row_mask:0xf bank_mask:0xf
  v_add_f32_dpp v5, v5, v5 row_ror:8 row_mask:0xf bank_mask:0xf
  v_cvt_pk_bf16_f32 v4, v4, v5
  buffer_store_dword v4, v69, s[8:11], s62 offen
  s_xor_b32 s62, s62, 16384
  buffer_store_dword v71, v69, s[8:11], s62 offen
  s_xor_b32 s72, s72, 1
  s_branch Cf2_h2
Cf2_h2r:
  s_mov_b64 exec, vcc
  buffer_load_dwordx4 v[12:15], v76, s[8:11], s65 offen offset:3072 sc1
  s_mov_b64 exec, -1
  s_add_u32 s67, s67, 1
  s_waitcnt vmcnt(4)
  v_max3_u32 v72, v12, v13, v14
  v_max_u32 v72, v72, v15
  ds_write_b128 v76, v[12:15] offset:7680
  v_cmp_eq_u32 vcc, -1, v72
  s_cbranch_vccz Cf2_h2w
  s_mov_b64 exec, vcc
  buffer_load_dwordx4 v[12:15], v76, s[8:11], s65 offen offset:3072 sc1
  s_mov_b64 exec, -1
  s_add_u32 s67, s67, 1
  s_waitcnt vmcnt(4)
  v_max3_u32 v72, v12, v13, v14
  v_max_u32 v72, v72, v15
  ds_write_b128 v76, v[12:15] offset:7680
  v_cmp_eq_u32 vcc, -1, v72
  s_cbranch_vccz Cf2_h2w
Cf2_h2s:
  s_mov_b64 exec, vcc
  buffer_load_dwordx4 v[12:15], v76, s[8:11], s65 offen offset:3072 sc1
  s_mov_b64 exec, -1
  s_add_u32 s67, s67, 1
  s_waitcnt vmcnt(2)
  v_max3_u32 v72, v12, v13, v14
  v_max_u32 v72, v72, v15
  ds_write_b128 v76, v[12:15] offset:7680
  v_cmp_eq_u32 vcc, -1, v72
  s_cbranch_vccz Cf2_h2w
  s_mov_b64 exec, vcc
  buffer_load_dwordx4 v[12:15], v76, s[8:11], s65 offen offset:3072 sc1
  s_mov_b64 exec, -1
  s_add_u32 s67, s67, 1
  s_waitcnt vmcnt(2)
  v_max3_u32 v72, v12, v13, v14
  v_max_u32 v72, v72, v15
  ds_write_b128 v76, v[12:15] offset:7680
  v_cmp_eq_u32 vcc, -1, v72
  s_cbranch_vccz Cf2_h2w
  s_mov_b64 exec, vcc
  buffer_load_dwordx4 v[12:15], v76, s[8:11], s65 offen offset:3072 sc1
  s_mov_b64 exec, -1
  s_add_u32 s67, s67, 1
  s_waitcnt vmcnt(2)
  v_max3_u32 v72, v12, v13, v14
  v_max_u32 v72, v72, v15
  ds_write_b128 v76, v[12:15] offset:7680
  v_cmp_eq_u32 vcc, -1, v72
  s_cbranch_vccz Cf2_h2w
  s_cmp_lt_u32 s67, 131072
  s_cbranch_scc1 Cf2_h2s
  s_branch Cf2_h2w
Cf2_rec:
  s_nop 7
  s_waitcnt vmcnt(0) lgkmcnt(0)
  v_max3_u32 v72, v0, v1, v2
  v_max3_u32 v72, v72, v3, v4
  v_max3_u32 v72, v72, v5, v6
  v_max3_u32 v72, v72, v7, v8
  v_max3_u32 v72, v72, v9, v10
  v_max3_u32 v72, v72, v11, v12
  v_max3_u32 v72, v72, v13, v14
  v_max3_u32 v72, v72, v15, v16
  v_max3_u32 v72, v72, v17, v18
  v_max_u32 v72, v72, v19
  v_cmp_eq_u32 vcc, -1, v72
  s_cbranch_vccz Cf2_recok
  s_barrier
Cf2_recp:
  buffer_load_dwordx4 v[0:3], v76, s[8:11], s64 offen offset:0 sc1
  buffer_load_dwordx4 v[4:7], v76, s[8:11], s64 offen offset:1024 sc1
  s_add_u32 s67, s67, 1
  s_cmp_lt_u32 s67, 131072
  s_cselect_b32 s54, -2, -1
  s_waitcnt vmcnt(1)
  v_max3_u32 v72, v0, v1, v2
  s_waitcnt vmcnt(0)
  v_max3_u32 v72, v72, v3, v4
  v_max3_u32 v72, v72, v5, v6
  v_max_u32 v72, v72, v7
  v_cmp_lt_u32 vcc, s54, v72
  s_cbranch_vccnz Cf2_recp
  ds_write_b128 v76, v[0:3] offset:8704
  ds_write_b128 v76, v[4:7] offset:9728
  v_mov_b64 v[20:21], 0
  v_mov_b64 v[22:23], 0
  v_mov_b64 v[24:25], 0
  v_mov_b64 v[26:27], 0
  v_mov_b64 v[28:29], 0
  v_mov_b64 v[30:31], 0
  v_mov_b64 v[32:33], 0
  v_mov_b64 v[34:35], 0
  s_waitcnt lgkmcnt(0)
  s_barrier
  ds_read_b128 v[0:3], v76 offset:4608
  s_waitcnt lgkmcnt(0)
  v_smfmac_f32_16x16x64_bf16 v[20:23], v[0:3], v[80:87], v74
  v_smfmac_f32_16x16x64_bf16 v[24:27], v[0:3], v[88:95], v74
  ds_read_b128 v[60:63], v76 offset:24576
  ds_read_b128 v[64:67], v76 offset:25600
  s_waitcnt lgkmcnt(0)
  v_smfmac_f32_16x16x64_bf16 v[28:31], v[0:3], v[60:67], v74
  ds_read_b128 v[60:63], v76 offset:26624
  ds_read_b128 v[64:67], v76 offset:27648
  s_waitcnt lgkmcnt(0)
  v_smfmac_f32_16x16x64_bf16 v[32:35], v[0:3], v[60:67], v74
  ds_read_b128 v[4:7], v76 offset:5632
  s_waitcnt lgkmcnt(0)
  v_smfmac_f32_16x16x64_bf16 v[20:23], v[4:7], v[96:103], v74
  v_smfmac_f32_16x16x64_bf16 v[24:27], v[4:7], v[104:111], v74
  ds_read_b128 v[60:63], v76 offset:40960
  ds_read_b128 v[64:67], v76 offset:41984
  s_waitcnt lgkmcnt(0)
  v_smfmac_f32_16x16x64_bf16 v[28:31], v[4:7], v[60:67], v74
  ds_read_b128 v[60:63], v76 offset:43008
  ds_read_b128 v[64:67], v76 offset:44032
  s_waitcnt lgkmcnt(0)
  v_smfmac_f32_16x16x64_bf16 v[32:35], v[4:7], v[60:67], v74
  ds_read_b128 v[8:11], v76 offset:6656
  s_waitcnt lgkmcnt(0)
  v_smfmac_f32_16x16x64_bf16 v[20:23], v[8:11], v[112:119], v74
  v_smfmac_f32_16x16x64_bf16 v[24:27], v[8:11], v[120:127], v74
  v_smfmac_f32_16x16x64_bf16 v[28:31], v[8:11], v[208:215], v74
  v_smfmac_f32_16x16x64_bf16 v[32:35], v[8:11], v[216:223], v74
  ds_read_b128 v[12:15], v76 offset:7680
  s_waitcnt lgkmcnt(0)
  v_smfmac_f32_16x16x64_bf16 v[20:23], v[12:15], v[128:135], v74
  v_smfmac_f32_16x16x64_bf16 v[24:27], v[12:15], v[136:143], v74
  v_smfmac_f32_16x16x64_bf16 v[28:31], v[12:15], v[224:231], v74
  v_smfmac_f32_16x16x64_bf16 v[32:35], v[12:15], v[232:239], v74
  ds_read_b128 v[12:15], v76 offset:8704
  s_waitcnt lgkmcnt(0)
  v_smfmac_f32_16x16x64_bf16 v[20:23], v[12:15], v[144:151], v74
  v_smfmac_f32_16x16x64_bf16 v[24:27], v[12:15], v[152:159], v74
  ds_read_b128 v[60:63], v76 offset:57344
  ds_read_b128 v[64:67], v76 offset:58368
  s_waitcnt lgkmcnt(0)
  v_smfmac_f32_16x16x64_bf16 v[28:31], v[12:15], v[60:67], v74
  ds_read_b128 v[60:63], v76 offset:59392
  ds_read_b128 v[64:67], v76 offset:60416
  s_waitcnt lgkmcnt(0)
  v_smfmac_f32_16x16x64_bf16 v[32:35], v[12:15], v[60:67], v74
  ds_read_b128 v[0:3], v76 offset:9728
  s_waitcnt lgkmcnt(0)
  v_smfmac_f32_16x16x64_bf16 v[20:23], v[0:3], v[160:167], v74
  v_smfmac_f32_16x16x64_bf16 v[24:27], v[0:3], v[168:175], v74
  ds_read_b128 v[60:63], v75 offset:24576
  ds_read_b128 v[64:67], v75 offset:25600
  s_waitcnt lgkmcnt(0)
  v_smfmac_f32_16x16x64_bf16 v[28:31], v[0:3], v[60:67], v74
  ds_read_b128 v[60:63], v75 offset:26624
  ds_read_b128 v[64:67], v75 offset:27648
  s_waitcnt lgkmcnt(0)
  v_smfmac_f32_16x16x64_bf16 v[32:35], v[0:3], v[60:67], v74
  ds_read_b128 v[16:19], v76 offset:10752
  ds_read_b128 v[60:63], v75 offset:8192
  ds_read_b128 v[64:67], v75 offset:9216
  s_waitcnt lgkmcnt(0)
  v_smfmac_f32_16x16x64_bf16 v[20:23], v[16:19], v[60:67], v74
  ds_read_b128 v[60:63], v75 offset:10240
  ds_read_b128 v[64:67], v75 offset:11264
  s_waitcnt lgkmcnt(0)
  v_smfmac_f32_16x16x64_bf16 v[24:27], v[16:19], v[60:67], v74
  v_smfmac_f32_16x16x64_bf16 v[28:31], v[16:19], v[240:247], v74
  v_smfmac_f32_16x16x64_bf16 v[32:35], v[16:19], v[248:255], v74
  ds_read_b128 v[4:7], v76 offset:11776
  s_waitcnt lgkmcnt(0)
  v_smfmac_f32_16x16x64_bf16 v[20:23], v[4:7], v[176:183], v74
  v_smfmac_f32_16x16x64_bf16 v[24:27], v[4:7], v[184:191], v74
  v_smfmac_f32_16x16x64_bf16 v[28:31], v[4:7], a[0:7], v74
  v_smfmac_f32_16x16x64_bf16 v[32:35], v[4:7], a[8:15], v74
  ds_read_b128 v[8:11], v76 offset:12800
  s_waitcnt lgkmcnt(0)
  v_smfmac_f32_16x16x64_bf16 v[20:23], v[8:11], v[192:199], v74
  v_smfmac_f32_16x16x64_bf16 v[24:27], v[8:11], v[200:207], v74
  v_smfmac_f32_16x16x64_bf16 v[28:31], v[8:11], a[16:23], v74
  v_smfmac_f32_16x16x64_bf16 v[32:35], v[8:11], a[24:31], v74
  v_add_f32 v20, v20, v22
  v_add_f32 v21, v21, v23
  v_add_f32 v24, v24, v26
  v_cvt_pk_bf16_f32 v22, v20, v24
  ds_write_b32 v79, v22 offset:0
  v_add_f32 v25, v25, v27
  v_cvt_pk_bf16_f32 v23, v21, v25
  ds_write_b32 v79, v23 offset:576
  v_add_f32 v28, v28, v30
  v_add_f32 v29, v29, v31
  s_waitcnt lgkmcnt(0)
  s_nop 1
  s_branch Cf2_recok
Cf2_mx:
  s_waitcnt lgkmcnt(0)
  s_barrier
  buffer_load_dwordx4 v[0:3], v76, s[8:11], s58 offen offset:0 sc1
  ds_read_b128 v[20:23], v77 offset:0
  ds_read_b128 v[28:31], v77 offset:256
  buffer_load_dwordx4 v[4:7], v76, s[8:11], s58 offen offset:1024 sc1
  ds_read_b128 v[24:27], v77 offset:128
  ds_read_b128 v[32:35], v77 offset:384
  s_waitcnt vmcnt(1) lgkmcnt(3)
  v_mfma_f32_16x16x32_bf16 v[8:11], v[0:3], v[20:23], 0
  s_waitcnt vmcnt(0) lgkmcnt(1)
  v_mfma_f32_16x16x32_bf16 v[8:11], v[4:7], v[24:27], v[8:11]
  v_mfma_f32_16x16x32_bf16 v[12:15], v[28:31], v[20:23], 0
  s_waitcnt lgkmcnt(0)
  v_mfma_f32_16x16x32_bf16 v[12:15], v[32:35], v[24:27], v[12:15]
  v_add_f32_dpp v8, v10, v8 quad_perm:[2,3,0,1] row_mask:0xf bank_mask:0xf
  v_add_f32_dpp v9, v11, v9 quad_perm:[2,3,0,1] row_mask:0xf bank_mask:0xf
  s_nop 0
  v_mov_b32_dpp v8, v8 quad_perm:[0,1,0,1] row_mask:0xf bank_mask:0xf
  v_mov_b32_dpp v9, v9 quad_perm:[0,1,0,1] row_mask:0xf bank_mask:0xf
  s_nop 1
  v_add_f32_dpp v12, v14, v12 quad_perm:[2,3,0,1] row_mask:0xf bank_mask:0xf
  v_add_f32_dpp v13, v15, v13 quad_perm:[2,3,0,1] row_mask:0xf bank_mask:0xf
  s_nop 0
  v_mov_b32_dpp v12, v12 quad_perm:[0,1,0,1] row_mask:0xf bank_mask:0xf
  v_mov_b32_dpp v13, v13 quad_perm:[0,1,0,1] row_mask:0xf bank_mask:0xf
  v_mul_f32 v12, s69, v12
  ds_write_b32 v78, v8 offset:8712
  v_mul_f32 v13, s69, v13
  ds_write_b32 v78, v9 offset:8776
  s_waitcnt lgkmcnt(0)
  s_barrier
  ds_read_b128 v[36:39], v78 offset:8704
  ds_read_b128 v[40:43], v78 offset:8768
  s_waitcnt lgkmcnt(0)
  s_barrier
  v_max_f32 v16, v36, v37
  v_max3_f32 v16, v16, v38, v39
  v_max3_f32 v16, v16, v40, v41
  v_max3_f32 v16, v16, v42, v43
  v_max3_f32 v16, v16, v12, v13
  v_mov_b32 v17, v16
  s_nop 1
  v_permlane16_swap_b32 v16, v17
  v_max_f32 v16, v16, v17
  v_mov_b32 v17, v16
  s_nop 1
  v_permlane32_swap_b32 v16, v17
  v_max_f32 v16, v16, v17
  v_sub_f32 v36, v36, v16
  v_sub_f32 v37, v37, v16
  v_sub_f32 v38, v38, v16
  v_sub_f32 v39, v39, v16
  v_sub_f32 v40, v40, v16
  v_sub_f32 v41, v41, v16
  v_sub_f32 v42, v42, v16
  v_sub_f32 v43, v43, v16
  v_sub_f32 v12, v12, v16
  v_sub_f32 v13, v13, v16
  v_exp_f32 v36, v36
  v_exp_f32 v37, v37
  v_exp_f32 v38, v38
  v_exp_f32 v39, v39
  v_exp_f32 v40, v40
  v_exp_f32 v41, v41
  v_exp_f32 v42, v42
  v_exp_f32 v43, v43
  v_exp_f32 v12, v12
  v_exp_f32 v13, v13
  v_cvt_pk_bf16_f32 v32, v36, v40
  v_cvt_pk_bf16_f32 v33, v37, v41
  v_cvt_pk_bf16_f32 v34, v38, v42
  v_cvt_pk_bf16_f32 v35, v39, v43
  v_cvt_pk_bf16_f32 v28, v12, v13
  v_cvt_pk_bf16_f32 v31, v12, v13
  v_mov_b32 v29, 0
  v_mov_b32 v30, 0
  v_mov_b32 v68, 0x3f803f80
  v_mov_b32 v69, 0x3f803f80
  v_mov_b32 v70, 0x3f803f80
  v_mov_b32 v71, 0x3f803f80
  s_nop 1
  v_mfma_f32_16x16x32_bf16 v[8:11], v[32:35], v[68:71], 0
  v_mfma_f32_16x16x32_bf16 v[0:3], v[32:35], v[52:55], 0
  v_mfma_f32_16x16x32_bf16 v[4:7], v[32:35], v[56:59], 0
  v_mfma_f32_16x16x16_bf16 v[8:11], v[28:29], v[68:69], v[8:11]
  v_mfma_f32_16x16x16_bf16 v[0:3], v[28:29], v[72:73], v[0:3]
  v_mfma_f32_16x16x16_bf16 v[4:7], v[30:31], v[72:73], v[4:7]
  ds_read_b128 v[68:71], v76 offset:13824
  v_rcp_f32 v10, v8
  v_rcp_f32 v11, v9
  v_mul_f32 v0, v10, v0
  v_mul_f32 v1, v11, v1
  s_nop 0
  v_mul_f32 v4, v10, v4
  v_mul_f32 v5, v11, v5
  v_cvt_pk_bf16_f32 v2, v0, v4
  ds_write_b32 v79, v2 offset:8704
  v_cvt_pk_bf16_f32 v3, v1, v5
  ds_write_b32 v79, v3 offset:9280
  v_mov_b64 v[16:17], 0
  v_mov_b64 v[18:19], 0
  v_mov_b64 v[20:21], 0
  v_mov_b64 v[22:23], 0
  v_mov_b64 v[24:25], 0
  v_mov_b64 v[26:27], 0
  s_branch Cf2_mxok
Cf2_last:
  ds_read_b128 v[4:7], v76 offset:5632
  ds_read_b128 v[8:11], v76 offset:6656
  ds_read_b128 v[44:47], v76 offset:40960
  ds_read_b128 v[48:51], v76 offset:41984
  s_nop 5
  v_mov_b64 v[20:21], 0
  v_mov_b64 v[22:23], 0
  v_mov_b64 v[24:25], 0
  v_mov_b64 v[26:27], 0
  s_waitcnt lgkmcnt(4)
  v_smfmac_f32_16x16x64_bf16 v[28:31], v[0:3], v[36:43], v74
  ds_read_b128 v[36:39], v76 offset:43008
  ds_read_b128 v[40:43], v76 offset:44032
  v_smfmac_f32_16x16x64_bf16 v[32:35], v[0:3], v[60:67], v74
  s_waitcnt lgkmcnt(5)
  v_smfmac_f32_16x16x64_bf16 v[20:23], v[0:3], a[32:39], v74
  ds_read_b128 v[60:63], v76 offset:57344
  ds_read_b128 v[64:67], v76 offset:58368
  v_smfmac_f32_16x16x64_bf16 v[24:27], v[0:3], a[40:47], v74
  s_waitcnt lgkmcnt(4)
  v_smfmac_f32_16x16x64_bf16 v[20:23], v[4:7], a[48:55], v74
  buffer_store_dwordx4 v[16:19], v76, s[8:11], s68 offen sc1
  v_smfmac_f32_16x16x64_bf16 v[24:27], v[4:7], a[56:63], v74
  v_smfmac_f32_16x16x64_bf16 v[28:31], v[4:7], v[44:51], v74
  s_waitcnt lgkmcnt(2)
  v_smfmac_f32_16x16x64_bf16 v[20:23], v[8:11], a[64:71], v74
  ds_read_b128 v[44:47], v76 offset:59392
  ds_read_b128 v[48:51], v76 offset:60416
  v_smfmac_f32_16x16x64_bf16 v[24:27], v[8:11], a[72:79], v74
  v_smfmac_f32_16x16x64_bf16 v[32:35], v[4:7], v[36:43], v74
  v_smfmac_f32_16x16x64_bf16 v[28:31], v[8:11], v[208:215], v74
  ds_read_b128 v[36:39], v75 offset:24576
  ds_read_b128 v[40:43], v75 offset:25600
  v_smfmac_f32_16x16x64_bf16 v[32:35], v[8:11], v[216:223], v74
  v_smfmac_f32_16x16x64_bf16 v[20:23], v[12:15], a[80:87], v74
  v_smfmac_f32_16x16x64_bf16 v[24:27], v[12:15], a[88:95], v74
  v_smfmac_f32_16x16x64_bf16 v[28:31], v[12:15], v[224:231], v74
  v_smfmac_f32_16x16x64_bf16 v[32:35], v[12:15], v[232:239], v74
  s_waitcnt vmcnt(2)
  s_waitcnt vmcnt(1)
  s_barrier
Cf2_lastr:
  ds_read_b128 v[12:15], v76 offset:8704
  ds_read_b128 v[0:3], v76 offset:9728
  ds_read_b128 v[16:19], v76 offset:10752
  ds_read_b128 v[4:7], v76 offset:11776
  ds_read_b128 v[8:11], v76 offset:12800
  s_waitcnt lgkmcnt(3)
  v_max3_u32 v72, v0, v1, v2
  s_waitcnt lgkmcnt(1)
  v_max3_u32 v72, v72, v3, v4
  v_max3_u32 v72, v72, v5, v6
  s_waitcnt lgkmcnt(0)
  v_max3_u32 v72, v72, v7, v8
  v_max3_u32 v72, v72, v9, v10
  v_max3_u32 v72, v72, v11, v12
  v_max3_u32 v72, v72, v13, v14
  v_max3_u32 v72, v72, v15, v16
  v_max3_u32 v72, v72, v17, v18
  v_max_u32 v72, v72, v19
  v_cmp_eq_u32 vcc, -1, v72
  s_cbranch_vccnz Cf2_lastp
Cf2_lastg:
  v_smfmac_f32_16x16x64_bf16 v[28:31], v[12:15], v[60:67], v74
  ds_read_b128 v[60:63], v75 offset:26624
  ds_read_b128 v[64:67], v75 offset:27648
  v_smfmac_f32_16x16x64_bf16 v[32:35], v[12:15], v[44:51], v74
  v_smfmac_f32_16x16x64_bf16 v[28:31], v[0:3], v[36:43], v74
  v_smfmac_f32_16x16x64_bf16 v[28:31], v[16:19], v[240:247], v74
  v_smfmac_f32_16x16x64_bf16 v[28:31], v[4:7], a[0:7], v74
  v_smfmac_f32_16x16x64_bf16 v[28:31], v[8:11], a[16:23], v74
  v_smfmac_f32_16x16x64_bf16 v[32:35], v[16:19], v[248:255], v74
  v_smfmac_f32_16x16x64_bf16 v[32:35], v[4:7], a[8:15], v74
  s_waitcnt lgkmcnt(0)
  v_smfmac_f32_16x16x64_bf16 v[32:35], v[8:11], a[24:31], v74
  v_smfmac_f32_16x16x64_bf16 v[32:35], v[0:3], v[60:67], v74
  v_smfmac_f32_16x16x64_bf16 v[20:23], v[12:15], a[96:103], v74
  v_smfmac_f32_16x16x64_bf16 v[20:23], v[0:3], a[112:119], v74
  v_add_f32 v28, v28, v30
  v_add_f32 v32, v32, v34
  v_cvt_pk_bf16_f32 v30, v28, v32
  v_smfmac_f32_16x16x64_bf16 v[20:23], v[16:19], a[128:135], v74
  ds_write_b32 v79, v30 offset:256
  v_add_f32 v29, v29, v31
  v_add_f32 v33, v33, v35
  v_cvt_pk_bf16_f32 v31, v29, v33
  v_smfmac_f32_16x16x64_bf16 v[20:23], v[4:7], a[144:151], v74
  ds_write_b32 v79, v31 offset:832
  v_smfmac_f32_16x16x64_bf16 v[20:23], v[8:11], a[160:167], v74
  v_smfmac_f32_16x16x64_bf16 v[24:27], v[12:15], a[104:111], v74
  v_smfmac_f32_16x16x64_bf16 v[24:27], v[0:3], a[120:127], v74
  v_smfmac_f32_16x16x64_bf16 v[24:27], v[16:19], a[136:143], v74
  s_waitcnt lgkmcnt(0)
  s_barrier
  ds_read_b64 v[52:53], v77 offset:384
  v_add_f32 v20, v20, v22
  v_smfmac_f32_16x16x64_bf16 v[24:27], v[4:7], a[152:159], v74
  v_add_f32 v21, v21, v23
  v_smfmac_f32_16x16x64_bf16 v[24:27], v[8:11], a[168:175], v74
  v_cvt_pk_bf16_f32 v54, v20, v21
  s_add_u32 s68, s68, 655360
  s_nop 3
  v_add_f32 v24, v24, v26
  v_add_f32 v25, v25, v27
  v_cvt_pk_bf16_f32 v55, v24, v25
  s_waitcnt lgkmcnt(0)
  buffer_store_dwordx4 v[52:55], v76, s[8:11], s68 offen sc1
  s_branch Cf2_done
Cf2_lastp:
  s_add_u32 s72, s72, 2
  s_cmp_ge_u32 s72, 131072
  s_cbranch_scc1 Cf2_lastg
  s_barrier
  buffer_load_dwordx4 v76, s[8:11], s85 offen offset:0 sc1 lds
  s_waitcnt vmcnt(0)
  s_barrier
  s_branch Cf2_lastr
Cf2_done:
  s_branch L_cexit
L_w3:
  v_mov_b64 v[20:21], 0
  v_mov_b64 v[22:23], 0
  v_mov_b64 v[24:25], 0
  v_mov_b64 v[26:27], 0
  v_mov_b64 v[28:29], 0
  v_mov_b64 v[30:31], 0
  v_mov_b64 v[32:33], 0
  v_mov_b64 v[34:35], 0
  s_mov_b32 s78, 0x3f803f80
  s_mov_b32 s79, s78
  s_mov_b32 s65, 360448
  s_mov_b32 m0, 15872
  s_lshl_b32 s71, s53, 2
  s_add_u32 s71, s71, 128
  s_movk_i32 s56, 0x1000
  v_lshlrev_b32 v73, 2, v76
  v_mov_b32 v72, 0
  s_mov_b64 s[16:17], s[8:9]
  s_mov_b32 s18, 268435456
  s_mov_b32 s19, 0x20000
  s_getpc_b64 s[20:21]
Cf3_pc:
  s_add_u32 s20, s20, (Cf3_last - Cf3_pc)
  s_addc_u32 s21, s21, 0
  v_mov_b32 v68, 14880
  buffer_load_dwordx4 v[52:55], v76, s[8:11], s59 offen offset:0 sc1
  buffer_load_dwordx4 v[56:59], v76, s[8:11], s59 offen offset:1024 sc1
  ds_read_b128 v[36:39], v76 offset:45056
  ds_read_b128 v[40:43], v76 offset:46080
  ds_read_b128 v[60:63], v76 offset:47104
  ds_read_b128 v[64:67], v76 offset:48128
  ds_read_b128 v[0:3], v76 offset:4608
  ds_read_b128 v[4:7], v76 offset:5632
  ds_read_b128 v[8:11], v76 offset:6656
  ds_read_b128 v[12:15], v76 offset:7680
  s_waitcnt lgkmcnt(0)
  s_cmp_eq_u32 s66, 1
  s_branch Cf3_top2
.p2align 6
Cf3_h2:
  v_lshlrev_b32 v73, 2, v76
  buffer_load_dwordx4 v[4:7], v76, s[8:11], s65 offen offset:1024 sc1
  ds_read_b128 v[36:39], v76 offset:45056
  ds_read_b128 v[40:43], v76 offset:46080
  buffer_load_dwordx4 v[52:55], v76, s[8:11], s59 offen offset:0 sc1
  buffer_load_dwordx4 v[56:59], v76, s[8:11], s59 offen offset:1024 sc1
  s_waitcnt vmcnt(7)
  v_max3_u32 v72, v4, v5, v6
  v_max_u32 v72, v72, v7
  ds_write_b128 v76, v[4:7] offset:5632
  v_cmp_eq_u32 vcc, -1, v72
  s_cbranch_vccnz Cf3_h2r
Cf3_h2w:
  buffer_load_dwordx4 v76, s[8:11], s85 offen offset:0 sc1 lds
  buffer_load_dwordx4 v76, s[8:11], s85 offen offset:1024 sc1 lds
  s_cmp_eq_u32 s66, 63
  s_waitcnt lgkmcnt(0)
  s_barrier
  ds_read_b128 v[8:11], v76 offset:6656
Cf3_top2:
  v_smfmac_f32_16x16x64_bf16 v[20:23], v[4:7], v[96:103], v74
  s_cbranch_scc1 Cf3_last
  v_smfmac_f32_16x16x64_bf16 v[28:31], v[4:7], v[36:43], v74
  buffer_load_dwordx4 v[44:47], v76, s[8:11], s58 offen offset:0 sc1
  s_mov_b32 m0, 15872
  v_smfmac_f32_16x16x64_bf16 v[24:27], v[4:7], v[104:111], v74
  buffer_load_dwordx4 v[48:51], v76, s[8:11], s58 offen offset:1024 sc1
  v_smfmac_f32_16x16x64_bf16 v[32:35], v[4:7], v[60:67], v74
  ds_read_b128 v[0:3], v76 offset:4608
  s_waitcnt lgkmcnt(1)
  v_smfmac_f32_16x16x64_bf16 v[20:23], v[8:11], v[112:119], v74
  ds_read_b128 v[12:15], v76 offset:7680
  v_smfmac_f32_16x16x64_bf16 v[24:27], v[8:11], v[120:127], v74
  ds_read_b128 v[36:39], v76 offset:28672
  v_smfmac_f32_16x16x64_bf16 v[28:31], v[8:11], v[208:215], v74
  buffer_store_dwordx4 v[16:19], v76, s[8:11], s68 offen sc1
  ds_read_b128 v[40:43], v76 offset:29696
  v_smfmac_f32_16x16x64_bf16 v[32:35], v[8:11], v[216:223], v74
  buffer_load_dword v73, s[16:19], s70 offen lds
  ds_read_b128 v[60:63], v76 offset:30720
  s_waitcnt lgkmcnt(4)
  v_smfmac_f32_16x16x64_bf16 v[20:23], v[0:3], v[80:87], v74
  ds_read_b128 v[64:67], v76 offset:31744
  v_smfmac_f32_16x16x64_bf16 v[24:27], v[0:3], v[88:95], v74
  s_waitcnt vmcnt(4)
  s_waitcnt lgkmcnt(4)
  v_smfmac_f32_16x16x64_bf16 v[20:23], v[12:15], v[128:135], v74
  s_barrier
  ds_read_b128 v[4:7], v76 offset:8704
  s_waitcnt lgkmcnt(3)
  v_smfmac_f32_16x16x64_bf16 v[28:31], v[0:3], v[36:43], v74
  ds_read_b128 v[36:39], v76 offset:61440
  v_smfmac_f32_16x16x64_bf16 v[24:27], v[12:15], v[136:143], v74
  ds_read_b128 v[40:43], v76 offset:62464
  s_waitcnt lgkmcnt(3)
  v_smfmac_f32_16x16x64_bf16 v[32:35], v[0:3], v[60:67], v74
  ds_read_b128 v[8:11], v76 offset:9728
  v_smfmac_f32_16x16x64_bf16 v[28:31], v[12:15], v[224:231], v74
  ds_read_b128 v[60:63], v76 offset:63488
  v_smfmac_f32_16x16x64_bf16 v[32:35], v[12:15], v[232:239], v74
  ds_read_b128 v[64:67], v76 offset:64512
  s_waitcnt lgkmcnt(5)
  v_smfmac_f32_16x16x64_bf16 v[20:23], v[4:7], v[144:151], v74
  s_barrier
  ds_read_b128 v[0:3], v76 offset:11776
  s_waitcnt lgkmcnt(4)
  v_smfmac_f32_16x16x64_bf16 v[28:31], v[4:7], v[36:43], v74
  ds_read_b128 v[12:15], v76 offset:12800
  ds_read_b128 v[36:39], v75 offset:12288
  v_smfmac_f32_16x16x64_bf16 v[24:27], v[4:7], v[152:159], v74
  ds_read_b128 v[16:19], v76 offset:10752
  s_waitcnt lgkmcnt(6)
  v_smfmac_f32_16x16x64_bf16 v[20:23], v[8:11], v[160:167], v74
  ds_read_b128 v[40:43], v75 offset:13312
  s_waitcnt lgkmcnt(5)
  v_smfmac_f32_16x16x64_bf16 v[32:35], v[4:7], v[60:67], v74
  ds_read_b128 v[60:63], v75 offset:14336
  v_smfmac_f32_16x16x64_bf16 v[24:27], v[8:11], v[168:175], v74
  ds_read_b128 v[64:67], v75 offset:15360
  s_waitcnt lgkmcnt(6)
  v_smfmac_f32_16x16x64_bf16 v[20:23], v[0:3], v[176:183], v74
  s_waitcnt lgkmcnt(5)
  v_smfmac_f32_16x16x64_bf16 v[20:23], v[12:15], v[192:199], v74
  s_waitcnt lgkmcnt(2)
  v_smfmac_f32_16x16x64_bf16 v[20:23], v[16:19], v[36:43], v74
  ds_read_b128 v[36:39], v75 offset:28672
  v_smfmac_f32_16x16x64_bf16 v[24:27], v[0:3], v[184:191], v74
  ds_read_b128 v[40:43], v75 offset:29696
  s_waitcnt lgkmcnt(2)
  v_smfmac_f32_16x16x64_bf16 v[24:27], v[16:19], v[60:67], v74
  ds_read_b128 v[60:63], v75 offset:30720
  v_add_f32 v20, v20, v22
  v_smfmac_f32_16x16x64_bf16 v[24:27], v[12:15], v[200:207], v74
  ds_read_b128 v[64:67], v75 offset:31744
  v_add_f32 v21, v21, v23
  v_smfmac_f32_16x16x64_bf16 v[28:31], v[16:19], v[240:247], v74
  v_mov_b64 v[70:71], s[78:79]
  v_smfmac_f32_16x16x64_bf16 v[28:31], v[0:3], a[0:7], v74
  s_waitcnt lgkmcnt(2)
  v_add_f32 v24, v24, v26
  v_smfmac_f32_16x16x64_bf16 v[28:31], v[8:11], v[36:43], v74
  ds_read_b128 v[36:39], v68
  v_cvt_pk_bf16_f32 v22, v20, v24
  v_smfmac_f32_16x16x64_bf16 v[28:31], v[12:15], a[16:23], v74
  ds_read_b128 v[40:43], v68
  ds_write_b32 v79, v22 offset:0
  s_waitcnt lgkmcnt(3)
  v_add_f32 v25, v25, v27
  v_cvt_pk_bf16_f32 v23, v21, v25
  v_smfmac_f32_16x16x64_bf16 v[32:35], v[8:11], v[60:67], v74
  ds_write_b32 v79, v23 offset:576
  v_cmp_u_f32 vcc, v20, v21
  v_smfmac_f32_16x16x64_bf16 v[32:35], v[16:19], v[248:255], v74
  v_add_f32 v28, v28, v30
  v_smfmac_f32_16x16x64_bf16 v[32:35], v[0:3], a[8:15], v74
  v_add_f32 v29, v29, v31
  v_smfmac_f32_16x16x64_bf16 v[32:35], v[12:15], a[24:31], v74
  s_cbranch_vccnz Cf3_rec
Cf3_recok:
  s_waitcnt lgkmcnt(3)
  v_smfmac_f32_16x16x64_bf16 v[36:39], v[16:19], a[128:135], v74
  s_waitcnt lgkmcnt(0)
  s_barrier
  ds_read_b128 v[60:63], v77
  v_smfmac_f32_16x16x64_bf16 v[40:43], v[16:19], a[136:143], v74
  ds_read_b128 v[64:67], v77 offset:128
  v_add_f32 v32, v32, v34
  v_cvt_pk_bf16_f32 v30, v28, v32
  v_smfmac_f32_16x16x64_bf16 v[36:39], v[0:3], a[144:151], v74
  ds_write_b32 v79, v30 offset:256
  v_add_f32 v33, v33, v35
  v_cvt_pk_bf16_f32 v31, v29, v33
  v_smfmac_f32_16x16x64_bf16 v[40:43], v[0:3], a[152:159], v74
  ds_write_b32 v79, v31 offset:832
  v_xor_b32 v75, 0x8000, v75
  v_smfmac_f32_16x16x64_bf16 v[36:39], v[4:7], a[96:103], v74
  ds_read_b128 v[0:3], v76 offset:4608
  v_mov_b32 v29, 0
  v_smfmac_f32_16x16x64_bf16 v[40:43], v[4:7], a[104:111], v74
  s_waitcnt vmcnt(2) lgkmcnt(3)
  v_mov_b32 v30, 0
  v_mfma_f32_16x16x32_bf16 v[44:47], v[44:47], v[60:63], 0
  ds_read_b128 v[4:7], v76 offset:5632
  s_waitcnt lgkmcnt(2)
  v_mfma_f32_16x16x32_bf16 v[44:47], v[48:51], v[64:67], v[44:47]
  s_barrier
  v_smfmac_f32_16x16x64_bf16 v[36:39], v[8:11], a[112:119], v74
  ds_read_b128 v[20:23], v77 offset:256
  ds_read_b128 v[24:27], v77 offset:384
  v_smfmac_f32_16x16x64_bf16 v[40:43], v[8:11], a[120:127], v74
  ds_read_b128 v[8:11], v76 offset:6656
  v_add_f32_dpp v72, v46, v44 quad_perm:[2,3,0,1] row_mask:0xf bank_mask:0xf
  v_add_f32_dpp v73, v47, v45 quad_perm:[2,3,0,1] row_mask:0xf bank_mask:0xf
  v_smfmac_f32_16x16x64_bf16 v[36:39], v[12:15], a[160:167], v74
  s_waitcnt lgkmcnt(4)
  v_exp_f32_dpp v72, v72 quad_perm:[0,1,0,1] row_mask:0xf bank_mask:0xf
  v_smfmac_f32_16x16x64_bf16 v[40:43], v[12:15], a[168:175], v74
  ds_read_b128 v[12:15], v76 offset:7680
  v_exp_f32_dpp v73, v73 quad_perm:[0,1,0,1] row_mask:0xf bank_mask:0xf
  v_smfmac_f32_16x16x64_bf16 v[36:39], v[0:3], a[32:39], v74
  s_waitcnt lgkmcnt(2)
  v_cvt_pk_bf16_f32 v72, v72, v73
  v_mfma_f32_16x16x32_bf16 v[20:23], v[20:23], v[60:63], 0
  ds_write_b32 v78, v72 offset:524
  v_mov_b64 v[16:17], 0
  v_mfma_f32_16x16x32_bf16 v[20:23], v[24:27], v[64:67], v[20:23]
  ds_read_b128 v[44:47], v75 offset:28672
  v_mov_b64 v[18:19], 0
  v_smfmac_f32_16x16x64_bf16 v[40:43], v[0:3], a[40:47], v74
  ds_read_b128 v[48:51], v75 offset:29696
  v_mov_b64 v[68:69], s[78:79]
  v_smfmac_f32_16x16x64_bf16 v[36:39], v[4:7], a[48:55], v74
  s_waitcnt lgkmcnt(4)
  v_add_f32_dpp v24, v22, v20 quad_perm:[2,3,0,1] row_mask:0xf bank_mask:0xf
  v_add_f32_dpp v25, v23, v21 quad_perm:[2,3,0,1] row_mask:0xf bank_mask:0xf
  v_smfmac_f32_16x16x64_bf16 v[36:39], v[8:11], a[64:71], v74
  s_waitcnt lgkmcnt(2)
  s_barrier
  ds_read_b128 v[32:35], v78 offset:512
  v_smfmac_f32_16x16x64_bf16 v[36:39], v[12:15], a[80:87], v74
  ds_read_b128 v[60:63], v75 offset:30720
  v_mul_f32 v24, s69, v24
  v_smfmac_f32_16x16x64_bf16 v[40:43], v[4:7], a[56:63], v74
  ds_read_b128 v[64:67], v75 offset:31744
  v_mul_f32 v25, s69, v25
  v_smfmac_f32_16x16x64_bf16 v[40:43], v[8:11], a[72:79], v74
  v_exp_f32_dpp v24, v24 quad_perm:[0,1,0,1] row_mask:0xf bank_mask:0xf
  v_smfmac_f32_16x16x64_bf16 v[40:43], v[12:15], a[88:95], v74
  s_waitcnt lgkmcnt(2)
  v_exp_f32_dpp v25, v25 quad_perm:[0,1,0,1] row_mask:0xf bank_mask:0xf
  v_mfma_f32_16x16x32_bf16 v[8:11], v[32:35], v[68:71], 0
  v_add_f32 v36, v36, v38
  v_add_f32 v37, v37, v39
  v_mfma_f32_16x16x32_bf16 v[0:3], v[32:35], v[52:55], 0
  v_add_f32 v40, v40, v42
  v_add_f32 v41, v41, v43
  v_mfma_f32_16x16x32_bf16 v[4:7], v[32:35], v[56:59], 0
  v_cvt_pk_bf16_f32 v28, v24, v25
  v_cvt_pk_bf16_f32 v72, v36, v37
  v_cvt_pk_bf16_f32 v73, v40, v41
  v_mfma_f32_16x16x16_bf16 v[8:11], v[28:29], v[68:69], v[8:11]
  v_cvt_pk_bf16_f32 v31, v24, v25
  v_mov_b64 v[20:21], 0
  v_mfma_f32_16x16x16_bf16 v[0:3], v[28:29], v[72:73], v[0:3]
  ds_read_b128 v[68:71], v76 offset:13824
  v_mov_b64 v[22:23], 0
  v_mfma_f32_16x16x16_bf16 v[4:7], v[30:31], v[72:73], v[4:7]
  v_rcp_f32 v10, v8
  v_rcp_f32 v11, v9
  v_mul_f32 v0, v10, v0
  v_mul_f32 v1, v11, v1
  s_nop 0
  v_mul_f32 v4, v10, v4
  v_mul_f32 v5, v11, v5
  v_cvt_pk_bf16_f32 v2, v0, v4
  ds_write_b32 v79, v2 offset:8704
  v_cvt_pk_bf16_f32 v3, v1, v5
  ds_write_b32 v79, v3 offset:9280
  v_max3_f32 v8, v8, v9, v10
  v_max_f32 v8, v8, v11
  v_cmp_le_f32 vcc, 1317011456, v8
  v_mov_b64 v[24:25], 0
  v_mov_b64 v[26:27], 0
  s_cbranch_vccnz Cf3_mx
Cf3_mxok:
  s_waitcnt lgkmcnt(0)
  s_barrier
  ds_read_b128 v[0:3], v78 offset:8704
  ds_read_b128 v[4:7], v78 offset:8768
  ds_read_b128 v[8:11], v78 offset:8832
  ds_read_b128 v[12:15], v78 offset:8896
  s_waitcnt lgkmcnt(3)
  v_smfmac_f32_16x16x64_bf16 v[16:19], v[0:3], v[44:51], v74
  ds_read_b128 v[52:55], v75 offset:45056
  s_waitcnt lgkmcnt(3)
  v_smfmac_f32_16x16x64_bf16 v[16:19], v[4:7], v[60:67], v74
  ds_read_b128 v[56:59], v75 offset:46080
  s_waitcnt lgkmcnt(3)
  v_smfmac_f32_16x16x64_bf16 v[16:19], v[8:11], a[176:183], v74
  ds_read_b128 v[36:39], v75 offset:47104
  s_waitcnt lgkmcnt(3)
  v_smfmac_f32_16x16x64_bf16 v[16:19], v[12:15], a[184:191], v74
  ds_read_b128 v[40:43], v75 offset:48128
  ds_read_b128 v[44:47], v75 offset:61440
  v_smfmac_f32_16x16x64_bf16 v[20:23], v[0:3], a[192:199], v74
  ds_read_b128 v[48:51], v75 offset:62464
  ds_read_b128 v[60:63], v75 offset:63488
  v_smfmac_f32_16x16x64_bf16 v[20:23], v[4:7], a[200:207], v74
  ds_read_b128 v[64:67], v75 offset:64512
  s_waitcnt lgkmcnt(6)
  v_cvt_pk_bf16_f32 v16, v16, v17
  v_cvt_pk_bf16_f32 v17, v18, v19
  v_bfi_b32 v16, 1, s72, v16
  v_smfmac_f32_16x16x64_bf16 v[20:23], v[8:11], v[52:59], v74
  buffer_store_dwordx2 v[16:17], v68, s[8:11], s73 offen
  s_waitcnt lgkmcnt(4)
  v_smfmac_f32_16x16x64_bf16 v[20:23], v[12:15], v[36:43], v74
  ds_read_b128 v[52:55], v75 offset:8192
  v_mov_b64 v[32:33], 0
  v_smfmac_f32_16x16x64_bf16 v[24:27], v[0:3], a[208:215], v74
  ds_read_b128 v[56:59], v75 offset:9216
  v_mov_b64 v[34:35], 0
  v_smfmac_f32_16x16x64_bf16 v[24:27], v[4:7], a[216:223], v74
  ds_read_b128 v[36:39], v75 offset:10240
  s_waitcnt lgkmcnt(5)
  v_cvt_pk_bf16_f32 v20, v20, v21
  v_cvt_pk_bf16_f32 v21, v22, v23
  v_bfi_b32 v20, 1, s72, v20
  v_smfmac_f32_16x16x64_bf16 v[24:27], v[8:11], v[44:51], v74
  buffer_store_dwordx2 v[20:21], v68, s[8:11], s74 offen
  s_waitcnt lgkmcnt(3)
  v_smfmac_f32_16x16x64_bf16 v[24:27], v[12:15], v[60:67], v74
  ds_read_b128 v[40:43], v75 offset:11264
  v_mov_b64 v[28:29], 0
  v_smfmac_f32_16x16x64_bf16 v[32:35], v[0:3], a[224:231], v74
  ds_read_b128 v[44:47], v75 offset:12288
  ds_read_b128 v[48:51], v75 offset:13312
  v_smfmac_f32_16x16x64_bf16 v[32:35], v[4:7], a[232:239], v74
  ds_read_b128 v[60:63], v75 offset:14336
  v_cvt_pk_bf16_f32 v24, v24, v25
  v_cvt_pk_bf16_f32 v25, v26, v27
  v_bfi_b32 v24, 1, s72, v24
  v_smfmac_f32_16x16x64_bf16 v[32:35], v[8:11], a[240:247], v74
  buffer_store_dwordx2 v[24:25], v68, s[8:11], s75 offen
  v_mov_b64 v[30:31], 0
  v_smfmac_f32_16x16x64_bf16 v[32:35], v[12:15], a[248:255], v74
  ds_read_b128 v[64:67], v75 offset:15360
  s_waitcnt lgkmcnt(6)
  v_smfmac_f32_16x16x64_bf16 v[28:31], v[0:3], v[52:59], v74
  s_waitcnt lgkmcnt(4)
  v_smfmac_f32_16x16x64_bf16 v[28:31], v[4:7], v[36:43], v74
  s_waitcnt lgkmcnt(2)
  v_cvt_pk_bf16_f32 v32, v32, v33
  v_cvt_pk_bf16_f32 v33, v34, v35
  v_bfi_b32 v32, 1, s72, v32
  v_smfmac_f32_16x16x64_bf16 v[28:31], v[8:11], v[44:51], v74
  buffer_store_dwordx2 v[32:33], v68, s[8:11], s76 offen
  s_waitcnt lgkmcnt(0)
  v_smfmac_f32_16x16x64_bf16 v[28:31], v[12:15], v[60:67], v74
  v_mov_b64 v[18:19], v[72:73]
  s_nop 4
  v_cvt_pk_bf16_f32 v28, v28, v29
  v_cvt_pk_bf16_f32 v29, v30, v31
  v_bfi_b32 v28, 1, s72, v28
  buffer_store_dwordx2 v[28:29], v68, s[8:11], s77 offen
  ds_read_b128 v[52:55], v76 offset:14848
  s_waitcnt lgkmcnt(0)
  ds_read_b64 v[16:17], v77 offset:392
  s_waitcnt lgkmcnt(0)
  ds_read_b128 v[60:63], v76 offset:47104
  s_waitcnt lgkmcnt(0)
  ds_read_b128 v[64:67], v76 offset:48128
  s_waitcnt lgkmcnt(0)
  s_add_u32 s66, s66, 1
  s_xor_b32 s64, s64, 16384
  s_xor_b32 s65, s65, 16384
  s_add_u32 s58, s58, 655360
  s_add_u32 s59, s59, 655360
  s_add_u32 s70, s70, 655360
  s_add_u32 s68, s68, 655360
  s_mov_b32 m0, 8704
  s_add_u32 s85, s65, 4096
  v_xor_b32 v75, 0x8000, v75
  buffer_load_dwordx4 v[0:3], v76, s[8:11], s60 offen offset:0 sc1
  buffer_load_dwordx4 v[4:7], v76, s[8:11], s60 offen offset:1024 sc1
  buffer_load_dwordx4 v[8:11], v76, s[8:11], s61 offen offset:0 sc1
  buffer_load_dwordx4 v[12:15], v76, s[8:11], s61 offen offset:1024 sc1
  v_mov_b64 v[20:21], 0
  v_mov_b64 v[22:23], 0
  v_mov_b64 v[24:25], 0
  v_mov_b64 v[26:27], 0
  v_mov_b32 v68, 14880
  v_mov_b64 v[28:29], 0
  v_mov_b64 v[30:31], 0
  v_mov_b64 v[32:33], 0
  v_mov_b64 v[34:35], 0
  s_cmp_eq_u32 s66, 62
  s_cselect_b64 s[16:17], s[20:21], s[16:17]
  s_cselect_b32 s18, (Cf3_done - Cf3_last), s18
  s_cselect_b32 s70, 0, s70
  s_cmp_eq_u32 s66, 63
  s_cselect_b32 s59, 268435456, s59
  s_cselect_b32 s58, 268435456, s58
  s_waitcnt lgkmcnt(0)
  s_waitcnt vmcnt(3)
  v_mfma_f32_16x16x32_bf16 v[56:59], v[52:55], v[0:3], 0
  v_bitop3_b32 v72, v0, v2, s72 bitop3:0x7e
  s_waitcnt vmcnt(2)
  v_mfma_f32_16x16x32_bf16 v[56:59], v[52:55], v[4:7], v[56:59]
  v_bitop3_b32 v73, v4, v6, s72 bitop3:0x7e
  v_or_b32 v72, v72, v73
  s_waitcnt vmcnt(1)
  v_mfma_f32_16x16x32_bf16 v[36:39], v[52:55], v[8:11], 0
  v_bitop3_b32 v73, v8, v10, s72 bitop3:0x7e
  v_or_b32 v72, v72, v73
  s_waitcnt vmcnt(0)
  v_mfma_f32_16x16x32_bf16 v[36:39], v[52:55], v[12:15], v[36:39]
  v_bitop3_b32 v73, v12, v14, s72 bitop3:0x7e
  v_bitop3_b32 v72, v72, v73, 1 bitop3:0xa8
  v_cmp_ne_u32 vcc, 0, v72
  s_cbranch_vccnz Cf3_h1r
  buffer_load_dwordx4 v[4:7], v76, s[8:11], s65 offen offset:1024 sc1
  v_add_f32_dpp v56, v56, v56 row_ror:4 row_mask:0xf bank_mask:0xf
  v_add_f32_dpp v57, v57, v57 row_ror:4 row_mask:0xf bank_mask:0xf
  v_add_f32_dpp v36, v36, v36 row_ror:4 row_mask:0xf bank_mask:0xf
  v_add_f32_dpp v37, v37, v37 row_ror:4 row_mask:0xf bank_mask:0xf
  v_add_f32_dpp v56, v56, v56 row_ror:8 row_mask:0xf bank_mask:0xf
  v_add_f32_dpp v57, v57, v57 row_ror:8 row_mask:0xf bank_mask:0xf
  v_add_f32_dpp v36, v36, v36 row_ror:8 row_mask:0xf bank_mask:0xf
  v_add_f32_dpp v37, v37, v37 row_ror:8 row_mask:0xf bank_mask:0xf
  v_cvt_pk_bf16_f32 v56, v56, v57
  buffer_store_dword v56, v69, s[8:11], s62 offen
  v_cvt_pk_bf16_f32 v36, v36, v37
  buffer_store_dword v36, v70, s[8:11], s63 offen
  s_xor_b32 s62, s62, 16384
  buffer_store_dword v71, v69, s[8:11], s62 offen
  s_xor_b32 s63, s63, 16384
  buffer_store_dword v71, v70, s[8:11], s63 offen
  s_xor_b32 s72, s72, 1
  s_branch Cf3_h2
Cf3_h1r:
  s_mov_b64 exec, vcc
  buffer_load_dwordx4 v[0:3], v76, s[8:11], s60 offen offset:0 sc1
  buffer_load_dwordx4 v[4:7], v76, s[8:11], s60 offen offset:1024 sc1
  buffer_load_dwordx4 v[8:11], v76, s[8:11], s61 offen offset:0 sc1
  buffer_load_dwordx4 v[12:15], v76, s[8:11], s61 offen offset:1024 sc1
  s_mov_b64 exec, -1
  s_add_u32 s67, s67, 1
  s_waitcnt vmcnt(3)
  v_mfma_f32_16x16x32_bf16 v[56:59], v[52:55], v[0:3], 0
  v_bitop3_b32 v72, v0, v2, s72 bitop3:0x7e
  s_waitcnt vmcnt(2)
  v_mfma_f32_16x16x32_bf16 v[56:59], v[52:55], v[4:7], v[56:59]
  v_bitop3_b32 v73, v4, v6, s72 bitop3:0x7e
  v_or_b32 v72, v72, v73
  s_waitcnt vmcnt(1)
  v_mfma_f32_16x16x32_bf16 v[36:39], v[52:55], v[8:11], 0
  v_bitop3_b32 v73, v8, v10, s72 bitop3:0x7e
  v_or_b32 v72, v72, v73
  s_waitcnt vmcnt(0)
  v_mfma_f32_16x16x32_bf16 v[36:39], v[52:55], v[12:15], v[36:39]
  v_bitop3_b32 v73, v12, v14, s72 bitop3:0x7e
  v_bitop3_b32 v72, v72, v73, 1 bitop3:0xa8
  v_cmp_ne_u32 vcc, 0, v72
  s_cbranch_vccz Cf3_h1p
Cf3_h1s:
  s_mov_b64 exec, vcc
  buffer_load_dwordx4 v[0:3], v76, s[8:11], s60 offen offset:0 sc1
  buffer_load_dwordx4 v[4:7], v76, s[8:11], s60 offen offset:1024 sc1
  buffer_load_dwordx4 v[8:11], v76, s[8:11], s61 offen offset:0 sc1
  buffer_load_dwordx4 v[12:15], v76, s[8:11], s61 offen offset:1024 sc1
  s_mov_b64 exec, -1
  s_add_u32 s67, s67, 1
  s_waitcnt vmcnt(3)
  v_mfma_f32_16x16x32_bf16 v[56:59], v[52:55], v[0:3], 0
  v_bitop3_b32 v72, v0, v2, s72 bitop3:0x7e
  s_waitcnt vmcnt(2)
  v_mfma_f32_16x16x32_bf16 v[56:59], v[52:55], v[4:7], v[56:59]
  v_bitop3_b32 v73, v4, v6, s72 bitop3:0x7e
  v_or_b32 v72, v72, v73
  s_waitcnt vmcnt(1)
  v_mfma_f32_16x16x32_bf16 v[36:39], v[52:55], v[8:11], 0
  v_bitop3_b32 v73, v8, v10, s72 bitop3:0x7e
  v_or_b32 v72, v72, v73
  s_waitcnt vmcnt(0)
  v_mfma_f32_16x16x32_bf16 v[36:39], v[52:55], v[12:15], v[36:39]
  v_bitop3_b32 v73, v12, v14, s72 bitop3:0x7e
  v_bitop3_b32 v72, v72, v73, 1 bitop3:0xa8
  v_cmp_ne_u32 vcc, 0, v72
  s_cbranch_vccz Cf3_h1p
  s_cmp_lt_u32 s67, 131072
  s_cbranch_scc1 Cf3_h1s
Cf3_h1p:
  s_nop 2
  buffer_load_dwordx4 v[4:7], v76, s[8:11], s65 offen offset:1024 sc1
  v_add_f32_dpp v56, v56, v56 row_ror:4 row_mask:0xf bank_mask:0xf
  v_add_f32_dpp v57, v57, v57 row_ror:4 row_mask:0xf bank_mask:0xf
  v_add_f32_dpp v36, v36, v36 row_ror:4 row_mask:0xf bank_mask:0xf
  v_add_f32_dpp v37, v37, v37 row_ror:4 row_mask:0xf bank_mask:0xf
  v_add_f32_dpp v56, v56, v56 row_ror:8 row_mask:0xf bank_mask:0xf
  v_add_f32_dpp v57, v57, v57 row_ror:8 row_mask:0xf bank_mask:0xf
  v_add_f32_dpp v36, v36, v36 row_ror:8 row_mask:0xf bank_mask:0xf
  v_add_f32_dpp v37, v37, v37 row_ror:8 row_mask:0xf bank_mask:0xf
  v_cvt_pk_bf16_f32 v56, v56, v57
  buffer_store_dword v56, v69, s[8:11], s62 offen
  v_cvt_pk_bf16_f32 v36, v36, v37
  buffer_store_dword v36, v70, s[8:11], s63 offen
  s_xor_b32 s62, s62, 16384
  buffer_store_dword v71, v69, s[8:11], s62 offen
  s_xor_b32 s63, s63, 16384
  buffer_store_dword v71, v70, s[8:11], s63 offen
  s_xor_b32 s72, s72, 1
  s_branch Cf3_h2
Cf3_h2r:
  s_mov_b64 exec, vcc
  buffer_load_dwordx4 v[4:7], v76, s[8:11], s65 offen offset:1024 sc1
  s_mov_b64 exec, -1
  s_add_u32 s67, s67, 1
  s_waitcnt vmcnt(3)
  v_max3_u32 v72, v4, v5, v6
  v_max_u32 v72, v72, v7
  ds_write_b128 v76, v[4:7] offset:5632
  v_cmp_eq_u32 vcc, -1, v72
  s_cbranch_vccz Cf3_h2w
Cf3_h2s:
  s_mov_b64 exec, vcc
  buffer_load_dwordx4 v[4:7], v76, s[8:11], s65 offen offset:1024 sc1
  s_mov_b64 exec, -1
  s_add_u32 s67, s67, 1
  s_waitcnt vmcnt(1)
  v_max3_u32 v72, v4, v5, v6
  v_max_u32 v72, v72, v7
  ds_write_b128 v76, v[4:7] offset:5632
  v_cmp_eq_u32 vcc, -1, v72
  s_cbranch_vccz Cf3_h2w
  s_mov_b64 exec, vcc
  buffer_load_dwordx4 v[4:7], v76, s[8:11], s65 offen offset:1024 sc1
  s_mov_b64 exec, -1
  s_add_u32 s67, s67, 1
  s_waitcnt vmcnt(1)
  v_max3_u32 v72, v4, v5, v6
  v_max_u32 v72, v72, v7
  ds_write_b128 v76, v[4:7] offset:5632
  v_cmp_eq_u32 vcc, -1, v72
  s_cbranch_vccz Cf3_h2w
  s_mov_b64 exec, vcc
  buffer_load_dwordx4 v[4:7], v76, s[8:11], s65 offen offset:1024 sc1
  s_mov_b64 exec, -1
  s_add_u32 s67, s67, 1
  s_waitcnt vmcnt(1)
  v_max3_u32 v72, v4, v5, v6
  v_max_u32 v72, v72, v7
  ds_write_b128 v76, v[4:7] offset:5632
  v_cmp_eq_u32 vcc, -1, v72
  s_cbranch_vccz Cf3_h2w
  s_cmp_lt_u32 s67, 131072
  s_cbranch_scc1 Cf3_h2s
  s_branch Cf3_h2w
Cf3_rec:
  s_nop 7
  s_waitcnt vmcnt(0) lgkmcnt(0)
  v_max3_u32 v72, v0, v1, v2
  v_max3_u32 v72, v72, v3, v4
  v_max3_u32 v72, v72, v5, v6
  v_max3_u32 v72, v72, v7, v8
  v_max3_u32 v72, v72, v9, v10
  v_max3_u32 v72, v72, v11, v12
  v_max3_u32 v72, v72, v13, v14
  v_max3_u32 v72, v72, v15, v16
  v_max3_u32 v72, v72, v17, v18
  v_max_u32 v72, v72, v19
  v_cmp_eq_u32 vcc, -1, v72
  s_cbranch_vccz Cf3_recok
  s_barrier
Cf3_recp:
  buffer_load_dwordx4 v[0:3], v76, s[8:11], s64 offen offset:0 sc1
  buffer_load_dwordx4 v[4:7], v76, s[8:11], s64 offen offset:1024 sc1
  buffer_load_dwordx4 v[8:11], v76, s[8:11], s64 offen offset:2048 sc1
  s_add_u32 s67, s67, 1
  s_cmp_lt_u32 s67, 131072
  s_cselect_b32 s54, -2, -1
  s_waitcnt vmcnt(2)
  v_max3_u32 v72, v0, v1, v2
  s_waitcnt vmcnt(1)
  v_max3_u32 v72, v72, v3, v4
  v_max3_u32 v72, v72, v5, v6
  s_waitcnt vmcnt(0)
  v_max3_u32 v72, v72, v7, v8
  v_max3_u32 v72, v72, v9, v10
  v_max_u32 v72, v72, v11
  v_cmp_lt_u32 vcc, s54, v72
  s_cbranch_vccnz Cf3_recp
  ds_write_b128 v76, v[0:3] offset:10752
  ds_write_b128 v76, v[4:7] offset:11776
  ds_write_b128 v76, v[8:11] offset:12800
  v_mov_b64 v[20:21], 0
  v_mov_b64 v[22:23], 0
  v_mov_b64 v[24:25], 0
  v_mov_b64 v[26:27], 0
  v_mov_b64 v[28:29], 0
  v_mov_b64 v[30:31], 0
  v_mov_b64 v[32:33], 0
  v_mov_b64 v[34:35], 0
  s_waitcnt lgkmcnt(0)
  s_barrier
  ds_read_b128 v[0:3], v76 offset:4608
  s_waitcnt lgkmcnt(0)
  v_smfmac_f32_16x16x64_bf16 v[20:23], v[0:3], v[80:87], v74
  v_smfmac_f32_16x16x64_bf16 v[24:27], v[0:3], v[88:95], v74
  ds_read_b128 v[60:63], v76 offset:28672
  ds_read_b128 v[64:67], v76 offset:29696
  s_waitcnt lgkmcnt(0)
  v_smfmac_f32_16x16x64_bf16 v[28:31], v[0:3], v[60:67], v74
  ds_read_b128 v[60:63], v76 offset:30720
  ds_read_b128 v[64:67], v76 offset:31744
  s_waitcnt lgkmcnt(0)
  v_smfmac_f32_16x16x64_bf16 v[32:35], v[0:3], v[60:67], v74
  ds_read_b128 v[4:7], v76 offset:5632
  s_waitcnt lgkmcnt(0)
  v_smfmac_f32_16x16x64_bf16 v[20:23], v[4:7], v[96:103], v74
  v_smfmac_f32_16x16x64_bf16 v[24:27], v[4:7], v[104:111], v74
  ds_read_b128 v[60:63], v76 offset:45056
  ds_read_b128 v[64:67], v76 offset:46080
  s_waitcnt lgkmcnt(0)
  v_smfmac_f32_16x16x64_bf16 v[28:31], v[4:7], v[60:67], v74
  ds_read_b128 v[60:63], v76 offset:47104
  ds_read_b128 v[64:67], v76 offset:48128
  s_waitcnt lgkmcnt(0)
  v_smfmac_f32_16x16x64_bf16 v[32:35], v[4:7], v[60:67], v74
  ds_read_b128 v[8:11], v76 offset:6656
  s_waitcnt lgkmcnt(0)
  v_smfmac_f32_16x16x64_bf16 v[20:23], v[8:11], v[112:119], v74
  v_smfmac_f32_16x16x64_bf16 v[24:27], v[8:11], v[120:127], v74
  v_smfmac_f32_16x16x64_bf16 v[28:31], v[8:11], v[208:215], v74
  v_smfmac_f32_16x16x64_bf16 v[32:35], v[8:11], v[216:223], v74
  ds_read_b128 v[12:15], v76 offset:7680
  s_waitcnt lgkmcnt(0)
  v_smfmac_f32_16x16x64_bf16 v[20:23], v[12:15], v[128:135], v74
  v_smfmac_f32_16x16x64_bf16 v[24:27], v[12:15], v[136:143], v74
  v_smfmac_f32_16x16x64_bf16 v[28:31], v[12:15], v[224:231], v74
  v_smfmac_f32_16x16x64_bf16 v[32:35], v[12:15], v[232:239], v74
  ds_read_b128 v[4:7], v76 offset:8704
  s_waitcnt lgkmcnt(0)
  v_smfmac_f32_16x16x64_bf16 v[20:23], v[4:7], v[144:151], v74
  v_smfmac_f32_16x16x64_bf16 v[24:27], v[4:7], v[152:159], v74
  ds_read_b128 v[60:63], v76 offset:61440
  ds_read_b128 v[64:67], v76 offset:62464
  s_waitcnt lgkmcnt(0)
  v_smfmac_f32_16x16x64_bf16 v[28:31], v[4:7], v[60:67], v74
  ds_read_b128 v[60:63], v76 offset:63488
  ds_read_b128 v[64:67], v76 offset:64512
  s_waitcnt lgkmcnt(0)
  v_smfmac_f32_16x16x64_bf16 v[32:35], v[4:7], v[60:67], v74
  ds_read_b128 v[8:11], v76 offset:9728
  s_waitcnt lgkmcnt(0)
  v_smfmac_f32_16x16x64_bf16 v[20:23], v[8:11], v[160:167], v74
  v_smfmac_f32_16x16x64_bf16 v[24:27], v[8:11], v[168:175], v74
  ds_read_b128 v[60:63], v75 offset:28672
  ds_read_b128 v[64:67], v75 offset:29696
  s_waitcnt lgkmcnt(0)
  v_smfmac_f32_16x16x64_bf16 v[28:31], v[8:11], v[60:67], v74
  ds_read_b128 v[60:63], v75 offset:30720
  ds_read_b128 v[64:67], v75 offset:31744
  s_waitcnt lgkmcnt(0)
  v_smfmac_f32_16x16x64_bf16 v[32:35], v[8:11], v[60:67], v74
  ds_read_b128 v[16:19], v76 offset:10752
  ds_read_b128 v[60:63], v75 offset:12288
  ds_read_b128 v[64:67], v75 offset:13312
  s_waitcnt lgkmcnt(0)
  v_smfmac_f32_16x16x64_bf16 v[20:23], v[16:19], v[60:67], v74
  ds_read_b128 v[60:63], v75 offset:14336
  ds_read_b128 v[64:67], v75 offset:15360
  s_waitcnt lgkmcnt(0)
  v_smfmac_f32_16x16x64_bf16 v[24:27], v[16:19], v[60:67], v74
  v_smfmac_f32_16x16x64_bf16 v[28:31], v[16:19], v[240:247], v74
  v_smfmac_f32_16x16x64_bf16 v[32:35], v[16:19], v[248:255], v74
  ds_read_b128 v[0:3], v76 offset:11776
  s_waitcnt lgkmcnt(0)
  v_smfmac_f32_16x16x64_bf16 v[20:23], v[0:3], v[176:183], v74
  v_smfmac_f32_16x16x64_bf16 v[24:27], v[0:3], v[184:191], v74
  v_smfmac_f32_16x16x64_bf16 v[28:31], v[0:3], a[0:7], v74
  v_smfmac_f32_16x16x64_bf16 v[32:35], v[0:3], a[8:15], v74
  ds_read_b128 v[12:15], v76 offset:12800
  s_waitcnt lgkmcnt(0)
  v_smfmac_f32_16x16x64_bf16 v[20:23], v[12:15], v[192:199], v74
  v_smfmac_f32_16x16x64_bf16 v[24:27], v[12:15], v[200:207], v74
  v_smfmac_f32_16x16x64_bf16 v[28:31], v[12:15], a[16:23], v74
  v_smfmac_f32_16x16x64_bf16 v[32:35], v[12:15], a[24:31], v74
  v_add_f32 v20, v20, v22
  v_add_f32 v21, v21, v23
  v_add_f32 v24, v24, v26
  v_cvt_pk_bf16_f32 v22, v20, v24
  ds_write_b32 v79, v22 offset:0
  v_add_f32 v25, v25, v27
  v_cvt_pk_bf16_f32 v23, v21, v25
  ds_write_b32 v79, v23 offset:576
  v_add_f32 v28, v28, v30
  v_add_f32 v29, v29, v31
  s_waitcnt lgkmcnt(0)
  s_nop 1
  s_branch Cf3_recok
Cf3_mx:
  s_waitcnt lgkmcnt(0)
  s_barrier
  buffer_load_dwordx4 v[0:3], v76, s[8:11], s58 offen offset:0 sc1
  ds_read_b128 v[20:23], v77 offset:0
  ds_read_b128 v[28:31], v77 offset:256
  buffer_load_dwordx4 v[4:7], v76, s[8:11], s58 offen offset:1024 sc1
  ds_read_b128 v[24:27], v77 offset:128
  ds_read_b128 v[32:35], v77 offset:384
  s_waitcnt vmcnt(1) lgkmcnt(3)
  v_mfma_f32_16x16x32_bf16 v[8:11], v[0:3], v[20:23], 0
  s_waitcnt vmcnt(0) lgkmcnt(1)
  v_mfma_f32_16x16x32_bf16 v[8:11], v[4:7], v[24:27], v[8:11]
  v_mfma_f32_16x16x32_bf16 v[12:15], v[28:31], v[20:23], 0
  s_waitcnt lgkmcnt(0)
  v_mfma_f32_16x16x32_bf16 v[12:15], v[32:35], v[24:27], v[12:15]
  v_add_f32_dpp v8, v10, v8 quad_perm:[2,3,0,1] row_mask:0xf bank_mask:0xf
  v_add_f32_dpp v9, v11, v9 quad_perm:[2,3,0,1] row_mask:0xf bank_mask:0xf
  s_nop 0
  v_mov_b32_dpp v8, v8 quad_perm:[0,1,0,1] row_mask:0xf bank_mask:0xf
  v_mov_b32_dpp v9, v9 quad_perm:[0,1,0,1] row_mask:0xf bank_mask:0xf
  s_nop 1
  v_add_f32_dpp v12, v14, v12 quad_perm:[2,3,0,1] row_mask:0xf bank_mask:0xf
  v_add_f32_dpp v13, v15, v13 quad_perm:[2,3,0,1] row_mask:0xf bank_mask:0xf
  s_nop 0
  v_mov_b32_dpp v12, v12 quad_perm:[0,1,0,1] row_mask:0xf bank_mask:0xf
  v_mov_b32_dpp v13, v13 quad_perm:[0,1,0,1] row_mask:0xf bank_mask:0xf
  v_mul_f32 v12, s69, v12
  ds_write_b32 v78, v8 offset:8716
  v_mul_f32 v13, s69, v13
  ds_write_b32 v78, v9 offset:8780
  s_waitcnt lgkmcnt(0)
  s_barrier
  ds_read_b128 v[36:39], v78 offset:8704
  ds_read_b128 v[40:43], v78 offset:8768
  s_waitcnt lgkmcnt(0)
  s_barrier
  v_max_f32 v16, v36, v37
  v_max3_f32 v16, v16, v38, v39
  v_max3_f32 v16, v16, v40, v41
  v_max3_f32 v16, v16, v42, v43
  v_max3_f32 v16, v16, v12, v13
  v_mov_b32 v17, v16
  s_nop 1
  v_permlane16_swap_b32 v16, v17
  v_max_f32 v16, v16, v17
  v_mov_b32 v17, v16
  s_nop 1
  v_permlane32_swap_b32 v16, v17
  v_max_f32 v16, v16, v17
  v_sub_f32 v36, v36, v16
  v_sub_f32 v37, v37, v16
  v_sub_f32 v38, v38, v16
  v_sub_f32 v39, v39, v16
  v_sub_f32 v40, v40, v16
  v_sub_f32 v41, v41, v16
  v_sub_f32 v42, v42, v16
  v_sub_f32 v43, v43, v16
  v_sub_f32 v12, v12, v16
  v_sub_f32 v13, v13, v16
  v_exp_f32 v36, v36
  v_exp_f32 v37, v37
  v_exp_f32 v38, v38
  v_exp_f32 v39, v39
  v_exp_f32 v40, v40
  v_exp_f32 v41, v41
  v_exp_f32 v42, v42
  v_exp_f32 v43, v43
  v_exp_f32 v12, v12
  v_exp_f32 v13, v13
  v_cvt_pk_bf16_f32 v32, v36, v40
  v_cvt_pk_bf16_f32 v33, v37, v41
  v_cvt_pk_bf16_f32 v34, v38, v42
  v_cvt_pk_bf16_f32 v35, v39, v43
  v_cvt_pk_bf16_f32 v28, v12, v13
  v_cvt_pk_bf16_f32 v31, v12, v13
  v_mov_b32 v29, 0
  v_mov_b32 v30, 0
  v_mov_b32 v68, 0x3f803f80
  v_mov_b32 v69, 0x3f803f80
  v_mov_b32 v70, 0x3f803f80
  v_mov_b32 v71, 0x3f803f80
  s_nop 1
  v_mfma_f32_16x16x32_bf16 v[8:11], v[32:35], v[68:71], 0
  v_mfma_f32_16x16x32_bf16 v[0:3], v[32:35], v[52:55], 0
  v_mfma_f32_16x16x32_bf16 v[4:7], v[32:35], v[56:59], 0
  v_mfma_f32_16x16x16_bf16 v[8:11], v[28:29], v[68:69], v[8:11]
  v_mfma_f32_16x16x16_bf16 v[0:3], v[28:29], v[72:73], v[0:3]
  v_mfma_f32_16x16x16_bf16 v[4:7], v[30:31], v[72:73], v[4:7]
  ds_read_b128 v[68:71], v76 offset:13824
  v_rcp_f32 v10, v8
  v_rcp_f32 v11, v9
  v_mul_f32 v0, v10, v0
  v_mul_f32 v1, v11, v1
  s_nop 0
  v_mul_f32 v4, v10, v4
  v_mul_f32 v5, v11, v5
  v_cvt_pk_bf16_f32 v2, v0, v4
  ds_write_b32 v79, v2 offset:8704
  v_cvt_pk_bf16_f32 v3, v1, v5
  ds_write_b32 v79, v3 offset:9280
  v_mov_b64 v[16:17], 0
  v_mov_b64 v[18:19], 0
  v_mov_b64 v[20:21], 0
  v_mov_b64 v[22:23], 0
  v_mov_b64 v[24:25], 0
  v_mov_b64 v[26:27], 0
  s_branch Cf3_mxok
Cf3_last:
  ds_read_b128 v[0:3], v76 offset:4608
  ds_read_b128 v[12:15], v76 offset:7680
  ds_read_b128 v[44:47], v76 offset:28672
  ds_read_b128 v[48:51], v76 offset:29696
  s_nop 5
  v_mov_b64 v[20:21], 0
  v_mov_b64 v[22:23], 0
  v_mov_b64 v[24:25], 0
  v_mov_b64 v[26:27], 0
  v_smfmac_f32_16x16x64_bf16 v[28:31], v[4:7], v[36:43], v74
  ds_read_b128 v[36:39], v76 offset:30720
  ds_read_b128 v[40:43], v76 offset:31744
  v_smfmac_f32_16x16x64_bf16 v[32:35], v[4:7], v[60:67], v74
  s_waitcnt lgkmcnt(5)
  v_smfmac_f32_16x16x64_bf16 v[20:23], v[0:3], a[32:39], v74
  ds_read_b128 v[60:63], v76 offset:61440
  ds_read_b128 v[64:67], v76 offset:62464
  v_smfmac_f32_16x16x64_bf16 v[24:27], v[0:3], a[40:47], v74
  s_waitcnt lgkmcnt(4)
  v_smfmac_f32_16x16x64_bf16 v[20:23], v[4:7], a[48:55], v74
  buffer_store_dwordx4 v[16:19], v76, s[8:11], s68 offen sc1
  v_smfmac_f32_16x16x64_bf16 v[24:27], v[4:7], a[56:63], v74
  v_smfmac_f32_16x16x64_bf16 v[28:31], v[0:3], v[44:51], v74
  s_waitcnt lgkmcnt(2)
  v_smfmac_f32_16x16x64_bf16 v[20:23], v[8:11], a[64:71], v74
  ds_read_b128 v[44:47], v76 offset:63488
  ds_read_b128 v[48:51], v76 offset:64512
  v_smfmac_f32_16x16x64_bf16 v[24:27], v[8:11], a[72:79], v74
  v_smfmac_f32_16x16x64_bf16 v[32:35], v[0:3], v[36:43], v74
  v_smfmac_f32_16x16x64_bf16 v[28:31], v[8:11], v[208:215], v74
  ds_read_b128 v[36:39], v75 offset:28672
  ds_read_b128 v[40:43], v75 offset:29696
  v_smfmac_f32_16x16x64_bf16 v[32:35], v[8:11], v[216:223], v74
  v_smfmac_f32_16x16x64_bf16 v[20:23], v[12:15], a[80:87], v74
  v_smfmac_f32_16x16x64_bf16 v[24:27], v[12:15], a[88:95], v74
  v_smfmac_f32_16x16x64_bf16 v[28:31], v[12:15], v[224:231], v74
  v_smfmac_f32_16x16x64_bf16 v[32:35], v[12:15], v[232:239], v74
  s_waitcnt vmcnt(1)
  s_barrier
Cf3_lastr:
  ds_read_b128 v[4:7], v76 offset:8704
  ds_read_b128 v[8:11], v76 offset:9728
  ds_read_b128 v[16:19], v76 offset:10752
  ds_read_b128 v[0:3], v76 offset:11776
  ds_read_b128 v[12:15], v76 offset:12800
  s_waitcnt lgkmcnt(1)
  v_max3_u32 v72, v0, v1, v2
  v_max3_u32 v72, v72, v3, v4
  v_max3_u32 v72, v72, v5, v6
  v_max3_u32 v72, v72, v7, v8
  v_max3_u32 v72, v72, v9, v10
  s_waitcnt lgkmcnt(0)
  v_max3_u32 v72, v72, v11, v12
  v_max3_u32 v72, v72, v13, v14
  v_max3_u32 v72, v72, v15, v16
  v_max3_u32 v72, v72, v17, v18
  v_max_u32 v72, v72, v19
  v_cmp_eq_u32 vcc, -1, v72
  s_cbranch_vccnz Cf3_lastp
Cf3_lastg:
  v_smfmac_f32_16x16x64_bf16 v[28:31], v[4:7], v[60:67], v74
  ds_read_b128 v[60:63], v75 offset:30720
  ds_read_b128 v[64:67], v75 offset:31744
  v_smfmac_f32_16x16x64_bf16 v[32:35], v[4:7], v[44:51], v74
  v_smfmac_f32_16x16x64_bf16 v[28:31], v[8:11], v[36:43], v74
  v_smfmac_f32_16x16x64_bf16 v[28:31], v[16:19], v[240:247], v74
  v_smfmac_f32_16x16x64_bf16 v[28:31], v[0:3], a[0:7], v74
  v_smfmac_f32_16x16x64_bf16 v[28:31], v[12:15], a[16:23], v74
  v_smfmac_f32_16x16x64_bf16 v[32:35], v[16:19], v[248:255], v74
  v_smfmac_f32_16x16x64_bf16 v[32:35], v[0:3], a[8:15], v74
  s_waitcnt lgkmcnt(0)
  v_smfmac_f32_16x16x64_bf16 v[32:35], v[12:15], a[24:31], v74
  v_smfmac_f32_16x16x64_bf16 v[32:35], v[8:11], v[60:67], v74
  v_smfmac_f32_16x16x64_bf16 v[20:23], v[4:7], a[96:103], v74
  v_smfmac_f32_16x16x64_bf16 v[20:23], v[8:11], a[112:119], v74
  v_add_f32 v28, v28, v30
  v_add_f32 v32, v32, v34
  v_cvt_pk_bf16_f32 v30, v28, v32
  v_smfmac_f32_16x16x64_bf16 v[20:23], v[16:19], a[128:135], v74
  ds_write_b32 v79, v30 offset:256
  v_add_f32 v29, v29, v31
  v_add_f32 v33, v33, v35
  v_cvt_pk_bf16_f32 v31, v29, v33
  v_smfmac_f32_16x16x64_bf16 v[20:23], v[0:3], a[144:151], v74
  ds_write_b32 v79, v31 offset:832
  v_smfmac_f32_16x16x64_bf16 v[20:23], v[12:15], a[160:167], v74
  v_smfmac_f32_16x16x64_bf16 v[24:27], v[4:7], a[104:111], v74
  v_smfmac_f32_16x16x64_bf16 v[24:27], v[8:11], a[120:127], v74
  v_smfmac_f32_16x16x64_bf16 v[24:27], v[16:19], a[136:143], v74
  s_waitcnt lgkmcnt(0)
  s_barrier
  ds_read_b64 v[52:53], v77 offset:392
  v_add_f32 v20, v20, v22
  v_smfmac_f32_16x16x64_bf16 v[24:27], v[0:3], a[152:159], v74
  v_add_f32 v21, v21, v23
  v_smfmac_f32_16x16x64_bf16 v[24:27], v[12:15], a[168:175], v74
  v_cvt_pk_bf16_f32 v54, v20, v21
  s_add_u32 s68, s68, 655360
  s_nop 3
  v_add_f32 v24, v24, v26
  v_add_f32 v25, v25, v27
  v_cvt_pk_bf16_f32 v55, v24, v25
  s_waitcnt lgkmcnt(0)
  buffer_store_dwordx4 v[52:55], v76, s[8:11], s68 offen sc1
  s_branch Cf3_done
Cf3_lastp:
  s_add_u32 s72, s72, 2
  s_cmp_ge_u32 s72, 131072
  s_cbranch_scc1 Cf3_lastg
  s_barrier
  buffer_load_dwordx4 v76, s[8:11], s85 offen offset:0 sc1 lds
  buffer_load_dwordx4 v76, s[8:11], s85 offen offset:1024 sc1 lds
  s_waitcnt vmcnt(0)
  s_barrier
  s_branch Cf3_lastr
Cf3_done:
  s_branch L_cexit
L_w4:
  v_mov_b64 v[20:21], 0
  v_mov_b64 v[22:23], 0
  v_mov_b64 v[24:25], 0
  v_mov_b64 v[26:27], 0
  v_mov_b64 v[28:29], 0
  v_mov_b64 v[30:31], 0
  v_mov_b64 v[32:33], 0
  v_mov_b64 v[34:35], 0
  s_mov_b32 s78, 0x3f803f80
  s_mov_b32 s79, s78
  s_mov_b32 s65, 360448
  s_mov_b32 m0, 16128
  s_lshl_b32 s71, s53, 2
  s_add_u32 s71, s71, 128
  s_movk_i32 s56, 0x1000
  v_lshlrev_b32 v73, 2, v76
  v_mov_b32 v72, 0
  s_mov_b64 s[16:17], s[8:9]
  s_mov_b32 s18, 268435456
  s_mov_b32 s19, 0x20000
  s_getpc_b64 s[20:21]
Cs0_pc:
  s_add_u32 s20, s20, (Cs0_last - Cs0_pc)
  s_addc_u32 s21, s21, 0
  v_mov_b32 v68, 14880
  buffer_load_dwordx4 v[52:55], v76, s[8:11], s59 offen offset:0 sc1
  buffer_load_dwordx4 v[56:59], v76, s[8:11], s59 offen offset:1024 sc1
  ds_read_b128 v[36:39], v76 offset:16384
  ds_read_b128 v[40:43], v76 offset:17408
  ds_read_b128 v[60:63], v76 offset:18432
  ds_read_b128 v[64:67], v76 offset:19456
  ds_read_b128 v[0:3], v76 offset:4608
  ds_read_b128 v[4:7], v76 offset:5632
  ds_read_b128 v[8:11], v76 offset:6656
  ds_read_b128 v[12:15], v76 offset:7680
  s_waitcnt lgkmcnt(0)
  s_cmp_eq_u32 s66, 1
  s_branch Cs0_top2
.p2align 6
Cs0_h2:
  ds_read_b128 v[36:39], v76 offset:16384
  v_mov_b64 v[20:21], 0
  v_mov_b64 v[22:23], 0
  v_mov_b64 v[24:25], 0
  v_mov_b64 v[26:27], 0
  v_mov_b32 v68, 14880
  ds_read_b128 v[40:43], v76 offset:17408
  v_mov_b64 v[28:29], 0
  v_mov_b64 v[30:31], 0
  v_mov_b64 v[32:33], 0
  v_mov_b64 v[34:35], 0
  v_lshlrev_b32 v73, 2, v76
  ds_read_b128 v[60:63], v76 offset:18432
  s_cmp_eq_u32 s66, 12
  s_cselect_b32 s56, s71, 0x1000
  ds_read_b32 v72, v76 offset:16128
  s_cmp_eq_u32 s66, 13
  s_cselect_b32 s54, 0x700, 0
  s_waitcnt lgkmcnt(0)
  v_readfirstlane_b32 s57, v72
  s_nop 0
  s_cmp_lt_u32 s57, s54
  s_cbranch_scc1 Cs0_kv3
Cs0_kvb:
  buffer_load_dwordx4 v[52:55], v76, s[8:11], s59 offen offset:0 sc1
  buffer_load_dwordx4 v[56:59], v76, s[8:11], s59 offen offset:1024 sc1
  s_waitcnt vmcnt(0)
  s_mov_b64 vcc, -1
Cs0_h2r:
  s_mov_b64 exec, vcc
  buffer_load_dwordx4 v[0:3], v76, s[8:11], s65 offen offset:0 sc1
  buffer_load_dwordx4 v[4:7], v76, s[8:11], s85 offen offset:0 sc1
  s_mov_b64 exec, -1
  s_add_u32 s67, s67, 1
  s_cmp_lt_u32 s67, 131072
  s_cselect_b32 s54, -2, -1
  s_waitcnt vmcnt(1)
  v_max3_u32 v72, v0, v1, v2
  s_waitcnt vmcnt(0)
  v_max3_u32 v72, v72, v3, v4
  v_max3_u32 v72, v72, v5, v6
  v_max_u32 v72, v72, v7
  v_cmp_lt_u32 vcc, s54, v72
  s_cbranch_vccnz Cs0_h2r
  ds_write_b128 v76, v[0:3] offset:4608
  ds_write_b128 v76, v[4:7] offset:10752
Cs0_h2w:
  s_cmp_eq_u32 s66, 63
  s_waitcnt lgkmcnt(0)
  s_barrier
  ds_read_b128 v[8:11], v76 offset:6656
Cs0_top2:
  v_smfmac_f32_16x16x64_bf16 v[20:23], v[0:3], v[80:87], v74
  s_cbranch_scc1 Cs0_last
  v_smfmac_f32_16x16x64_bf16 v[28:31], v[0:3], v[36:43], v74
  buffer_load_dwordx4 v[44:47], v76, s[8:11], s58 offen offset:0 sc1
  s_mov_b32 m0, 16128
  v_smfmac_f32_16x16x64_bf16 v[24:27], v[0:3], v[88:95], v74
  buffer_load_dwordx4 v[48:51], v76, s[8:11], s58 offen offset:1024 sc1
  v_smfmac_f32_16x16x64_bf16 v[32:35], v[0:3], v[60:67], v74
  ds_read_b128 v[4:7], v76 offset:5632
  s_waitcnt lgkmcnt(1)
  v_smfmac_f32_16x16x64_bf16 v[20:23], v[8:11], v[112:119], v74
  ds_read_b128 v[12:15], v76 offset:7680
  v_smfmac_f32_16x16x64_bf16 v[24:27], v[8:11], v[120:127], v74
  ds_read_b128 v[36:39], v76 offset:32768
  v_smfmac_f32_16x16x64_bf16 v[28:31], v[8:11], v[208:215], v74
  buffer_store_dwordx4 v[16:19], v76, s[8:11], s68 offen sc1
  ds_read_b128 v[40:43], v76 offset:33792
  v_smfmac_f32_16x16x64_bf16 v[32:35], v[8:11], v[216:223], v74
  buffer_load_dword v73, s[16:19], s70 offen lds
  ds_read_b128 v[60:63], v76 offset:34816
  s_waitcnt lgkmcnt(4)
  v_smfmac_f32_16x16x64_bf16 v[20:23], v[4:7], v[96:103], v74
  ds_read_b128 v[64:67], v76 offset:35840
  v_smfmac_f32_16x16x64_bf16 v[24:27], v[4:7], v[104:111], v74
  s_waitcnt vmcnt(4)
  s_waitcnt lgkmcnt(4)
  v_smfmac_f32_16x16x64_bf16 v[20:23], v[12:15], v[128:135], v74
  s_barrier
  ds_read_b128 v[0:3], v76 offset:8704
  s_waitcnt lgkmcnt(3)
  v_smfmac_f32_16x16x64_bf16 v[28:31], v[4:7], v[36:43], v74
  ds_read_b128 v[36:39], v76 offset:49152
  v_smfmac_f32_16x16x64_bf16 v[24:27], v[12:15], v[136:143], v74
  ds_read_b128 v[40:43], v76 offset:50176
  s_waitcnt lgkmcnt(3)
  v_smfmac_f32_16x16x64_bf16 v[32:35], v[4:7], v[60:67], v74
  ds_read_b128 v[8:11], v76 offset:9728
  v_smfmac_f32_16x16x64_bf16 v[28:31], v[12:15], v[224:231], v74
  ds_read_b128 v[60:63], v76 offset:51200
  v_smfmac_f32_16x16x64_bf16 v[32:35], v[12:15], v[232:239], v74
  ds_read_b128 v[64:67], v76 offset:52224
  s_waitcnt lgkmcnt(5)
  v_smfmac_f32_16x16x64_bf16 v[20:23], v[0:3], v[144:151], v74
  s_barrier
  ds_read_b128 v[4:7], v76 offset:11776
  s_waitcnt lgkmcnt(4)
  v_smfmac_f32_16x16x64_bf16 v[28:31], v[0:3], v[36:43], v74
  ds_read_b128 v[12:15], v76 offset:12800
  ds_read_b128 v[36:39], v75 offset:0
  v_smfmac_f32_16x16x64_bf16 v[24:27], v[0:3], v[152:159], v74
  ds_read_b128 v[16:19], v76 offset:10752
  s_waitcnt lgkmcnt(6)
  v_smfmac_f32_16x16x64_bf16 v[20:23], v[8:11], v[160:167], v74
  ds_read_b128 v[40:43], v75 offset:1024
  s_waitcnt lgkmcnt(5)
  v_smfmac_f32_16x16x64_bf16 v[32:35], v[0:3], v[60:67], v74
  ds_read_b128 v[60:63], v75 offset:2048
  v_smfmac_f32_16x16x64_bf16 v[24:27], v[8:11], v[168:175], v74
  ds_read_b128 v[64:67], v75 offset:3072
  s_waitcnt lgkmcnt(6)
  v_smfmac_f32_16x16x64_bf16 v[20:23], v[4:7], v[176:183], v74
  buffer_load_dword off, s[12:15], s56 sc1 lds
  s_waitcnt lgkmcnt(5)
  v_smfmac_f32_16x16x64_bf16 v[20:23], v[12:15], v[192:199], v74
  s_waitcnt lgkmcnt(2)
  v_smfmac_f32_16x16x64_bf16 v[20:23], v[16:19], v[36:43], v74
  ds_read_b128 v[36:39], v75 offset:16384
  v_smfmac_f32_16x16x64_bf16 v[24:27], v[4:7], v[184:191], v74
  ds_read_b128 v[40:43], v75 offset:17408
  s_waitcnt lgkmcnt(2)
  v_smfmac_f32_16x16x64_bf16 v[24:27], v[16:19], v[60:67], v74
  ds_read_b128 v[60:63], v75 offset:18432
  v_add_f32 v20, v20, v22
  v_smfmac_f32_16x16x64_bf16 v[24:27], v[12:15], v[200:207], v74
  ds_read_b128 v[64:67], v75 offset:19456
  v_add_f32 v21, v21, v23
  v_smfmac_f32_16x16x64_bf16 v[28:31], v[16:19], v[240:247], v74
  v_mov_b64 v[70:71], s[78:79]
  v_smfmac_f32_16x16x64_bf16 v[28:31], v[4:7], a[0:7], v74
  s_waitcnt lgkmcnt(2)
  v_add_f32 v24, v24, v26
  v_smfmac_f32_16x16x64_bf16 v[28:31], v[8:11], v[36:43], v74
  ds_read_b128 v[36:39], v68
  v_cvt_pk_bf16_f32 v22, v20, v24
  v_smfmac_f32_16x16x64_bf16 v[28:31], v[12:15], a[16:23], v74
  ds_read_b128 v[40:43], v68
  ds_write_b32 v79, v22 offset:0
  s_waitcnt lgkmcnt(3)
  v_add_f32 v25, v25, v27
  v_cvt_pk_bf16_f32 v23, v21, v25
  v_smfmac_f32_16x16x64_bf16 v[32:35], v[8:11], v[60:67], v74
  ds_write_b32 v79, v23 offset:576
  v_cmp_u_f32 vcc, v20, v21
  v_smfmac_f32_16x16x64_bf16 v[32:35], v[16:19], v[248:255], v74
  v_add_f32 v28, v28, v30
  v_smfmac_f32_16x16x64_bf16 v[32:35], v[4:7], a[8:15], v74
  v_add_f32 v29, v29, v31
  v_smfmac_f32_16x16x64_bf16 v[32:35], v[12:15], a[24:31], v74
  s_cbranch_vccnz Cs0_rec
Cs0_recok:
  s_waitcnt lgkmcnt(3)
  v_smfmac_f32_16x16x64_bf16 v[36:39], v[16:19], a[128:135], v74
  s_waitcnt lgkmcnt(0)
  s_barrier
  ds_read_b128 v[60:63], v77
  v_smfmac_f32_16x16x64_bf16 v[40:43], v[16:19], a[136:143], v74
  ds_read_b128 v[64:67], v77 offset:128
  v_add_f32 v32, v32, v34
  v_cvt_pk_bf16_f32 v30, v28, v32
  v_smfmac_f32_16x16x64_bf16 v[36:39], v[0:3], a[96:103], v74
  ds_write_b32 v79, v30 offset:256
  v_add_f32 v33, v33, v35
  v_cvt_pk_bf16_f32 v31, v29, v33
  v_smfmac_f32_16x16x64_bf16 v[40:43], v[0:3], a[104:111], v74
  ds_write_b32 v79, v31 offset:832
  v_xor_b32 v75, 0x8000, v75
  v_smfmac_f32_16x16x64_bf16 v[36:39], v[4:7], a[144:151], v74
  ds_read_b128 v[0:3], v76 offset:4608
  v_mov_b32 v29, 0
  v_smfmac_f32_16x16x64_bf16 v[40:43], v[4:7], a[152:159], v74
  s_waitcnt vmcnt(3) lgkmcnt(3)
  v_mov_b32 v30, 0
  v_mfma_f32_16x16x32_bf16 v[44:47], v[44:47], v[60:63], 0
  ds_read_b128 v[4:7], v76 offset:5632
  s_waitcnt lgkmcnt(2)
  v_mfma_f32_16x16x32_bf16 v[44:47], v[48:51], v[64:67], v[44:47]
  s_barrier
  v_smfmac_f32_16x16x64_bf16 v[36:39], v[8:11], a[112:119], v74
  ds_read_b128 v[20:23], v77 offset:256
  ds_read_b128 v[24:27], v77 offset:384
  v_smfmac_f32_16x16x64_bf16 v[40:43], v[8:11], a[120:127], v74
  ds_read_b128 v[8:11], v76 offset:6656
  v_add_f32_dpp v72, v46, v44 quad_perm:[2,3,0,1] row_mask:0xf bank_mask:0xf
  v_add_f32_dpp v73, v47, v45 quad_perm:[2,3,0,1] row_mask:0xf bank_mask:0xf
  v_smfmac_f32_16x16x64_bf16 v[36:39], v[12:15], a[160:167], v74
  s_waitcnt lgkmcnt(4)
  v_exp_f32_dpp v72, v72 quad_perm:[0,1,0,1] row_mask:0xf bank_mask:0xf
  v_smfmac_f32_16x16x64_bf16 v[40:43], v[12:15], a[168:175], v74
  ds_read_b128 v[12:15], v76 offset:7680
  v_exp_f32_dpp v73, v73 quad_perm:[0,1,0,1] row_mask:0xf bank_mask:0xf
  v_smfmac_f32_16x16x64_bf16 v[36:39], v[0:3], a[32:39], v74
  s_waitcnt lgkmcnt(2)
  v_cvt_pk_bf16_f32 v72, v72, v73
  v_mfma_f32_16x16x32_bf16 v[20:23], v[20:23], v[60:63], 0
  ds_write_b32 v78, v72 offset:512
  v_mov_b64 v[16:17], 0
  v_mfma_f32_16x16x32_bf16 v[20:23], v[24:27], v[64:67], v[20:23]
  ds_read_b128 v[44:47], v75 offset:16384
  v_mov_b64 v[18:19], 0
  v_smfmac_f32_16x16x64_bf16 v[40:43], v[0:3], a[40:47], v74
  ds_read_b128 v[48:51], v75 offset:17408
  v_mov_b64 v[68:69], s[78:79]
  v_smfmac_f32_16x16x64_bf16 v[36:39], v[4:7], a[48:55], v74
  s_waitcnt lgkmcnt(4)
  v_add_f32_dpp v24, v22, v20 quad_perm:[2,3,0,1] row_mask:0xf bank_mask:0xf
  v_add_f32_dpp v25, v23, v21 quad_perm:[2,3,0,1] row_mask:0xf bank_mask:0xf
  v_smfmac_f32_16x16x64_bf16 v[36:39], v[8:11], a[64:71], v74
  s_waitcnt lgkmcnt(2)
  s_barrier
  ds_read_b128 v[32:35], v78 offset:512
  v_smfmac_f32_16x16x64_bf16 v[36:39], v[12:15], a[80:87], v74
  ds_read_b128 v[60:63], v75 offset:18432
  v_mul_f32 v24, s69, v24
  v_smfmac_f32_16x16x64_bf16 v[40:43], v[4:7], a[56:63], v74
  ds_read_b128 v[64:67], v75 offset:19456
  v_mul_f32 v25, s69, v25
  v_smfmac_f32_16x16x64_bf16 v[40:43], v[8:11], a[72:79], v74
  v_exp_f32_dpp v24, v24 quad_perm:[0,1,0,1] row_mask:0xf bank_mask:0xf
  v_smfmac_f32_16x16x64_bf16 v[40:43], v[12:15], a[88:95], v74
  s_waitcnt lgkmcnt(2)
  v_exp_f32_dpp v25, v25 quad_perm:[0,1,0,1] row_mask:0xf bank_mask:0xf
  v_mfma_f32_16x16x32_bf16 v[8:11], v[32:35], v[68:71], 0
  v_add_f32 v36, v36, v38
  v_add_f32 v37, v37, v39
  v_mfma_f32_16x16x32_bf16 v[0:3], v[32:35], v[52:55], 0
  v_add_f32 v40, v40, v42
  v_add_f32 v41, v41, v43
  v_mfma_f32_16x16x32_bf16 v[4:7], v[32:35], v[56:59], 0
  v_cvt_pk_bf16_f32 v28, v24, v25
  v_cvt_pk_bf16_f32 v72, v36, v37
  v_cvt_pk_bf16_f32 v73, v40, v41
  v_mfma_f32_16x16x16_bf16 v[8:11], v[28:29], v[68:69], v[8:11]
  v_cvt_pk_bf16_f32 v31, v24, v25
  v_mov_b64 v[20:21], 0
  v_mfma_f32_16x16x16_bf16 v[0:3], v[28:29], v[72:73], v[0:3]
  ds_read_b128 v[68:71], v76 offset:13824
  v_mov_b64 v[22:23], 0
  v_mfma_f32_16x16x16_bf16 v[4:7], v[30:31], v[72:73], v[4:7]
  v_rcp_f32 v10, v8
  v_rcp_f32 v11, v9
  v_mul_f32 v0, v10, v0
  v_mul_f32 v1, v11, v1
  s_nop 0
  v_mul_f32 v4, v10, v4
  v_mul_f32 v5, v11, v5
  v_cvt_pk_bf16_f32 v2, v0, v4
  ds_write_b32 v79, v2 offset:8704
  v_cvt_pk_bf16_f32 v3, v1, v5
  ds_write_b32 v79, v3 offset:9280
  v_max3_f32 v8, v8, v9, v10
  v_max_f32 v8, v8, v11
  v_cmp_le_f32 vcc, 1317011456, v8
  v_mov_b64 v[24:25], 0
  v_mov_b64 v[26:27], 0
  s_cbranch_vccnz Cs0_mx
Cs0_mxok:
  s_waitcnt lgkmcnt(0)
  s_barrier
  ds_read_b128 v[0:3], v78 offset:8704
  ds_read_b128 v[4:7], v78 offset:8768
  ds_read_b128 v[8:11], v78 offset:8832
  ds_read_b128 v[12:15], v78 offset:8896
  s_waitcnt lgkmcnt(3)
  v_smfmac_f32_16x16x64_bf16 v[16:19], v[0:3], v[44:51], v74
  ds_read_b128 v[52:55], v75 offset:32768
  s_waitcnt lgkmcnt(3)
  v_smfmac_f32_16x16x64_bf16 v[16:19], v[4:7], v[60:67], v74
  ds_read_b128 v[56:59], v75 offset:33792
  s_waitcnt lgkmcnt(3)
  v_smfmac_f32_16x16x64_bf16 v[16:19], v[8:11], a[176:183], v74
  ds_read_b128 v[36:39], v75 offset:34816
  s_waitcnt lgkmcnt(3)
  v_smfmac_f32_16x16x64_bf16 v[16:19], v[12:15], a[184:191], v74
  ds_read_b128 v[40:43], v75 offset:35840
  ds_read_b128 v[44:47], v75 offset:49152
  v_smfmac_f32_16x16x64_bf16 v[20:23], v[0:3], a[192:199], v74
  ds_read_b128 v[48:51], v75 offset:50176
  ds_read_b128 v[60:63], v75 offset:51200
  v_smfmac_f32_16x16x64_bf16 v[20:23], v[4:7], a[200:207], v74
  ds_read_b128 v[64:67], v75 offset:52224
  s_waitcnt lgkmcnt(6)
  v_cvt_pk_bf16_f32 v16, v16, v17
  v_cvt_pk_bf16_f32 v17, v18, v19
  v_bfi_b32 v16, 1, s72, v16
  v_smfmac_f32_16x16x64_bf16 v[20:23], v[8:11], v[52:59], v74
  buffer_store_dwordx2 v[16:17], v68, s[8:11], s73 offen sc1
  s_waitcnt lgkmcnt(4)
  v_smfmac_f32_16x16x64_bf16 v[20:23], v[12:15], v[36:43], v74
  v_mov_b64 v[32:33], 0
  v_smfmac_f32_16x16x64_bf16 v[24:27], v[0:3], a[208:215], v74
  v_mov_b64 v[34:35], 0
  v_smfmac_f32_16x16x64_bf16 v[24:27], v[4:7], a[216:223], v74
  s_waitcnt lgkmcnt(2)
  v_cvt_pk_bf16_f32 v20, v20, v21
  v_cvt_pk_bf16_f32 v21, v22, v23
  v_bfi_b32 v20, 1, s72, v20
  v_smfmac_f32_16x16x64_bf16 v[24:27], v[8:11], v[44:51], v74
  buffer_store_dwordx2 v[20:21], v68, s[8:11], s74 offen sc1
  s_waitcnt lgkmcnt(0)
  v_smfmac_f32_16x16x64_bf16 v[24:27], v[12:15], v[60:67], v74
  v_smfmac_f32_16x16x64_bf16 v[32:35], v[0:3], a[224:231], v74
  v_smfmac_f32_16x16x64_bf16 v[32:35], v[4:7], a[232:239], v74
  v_cvt_pk_bf16_f32 v24, v24, v25
  v_cvt_pk_bf16_f32 v25, v26, v27
  v_bfi_b32 v24, 1, s72, v24
  v_smfmac_f32_16x16x64_bf16 v[32:35], v[8:11], a[240:247], v74
  buffer_store_dwordx2 v[24:25], v68, s[8:11], s75 offen sc1
  v_smfmac_f32_16x16x64_bf16 v[32:35], v[12:15], a[248:255], v74
  v_mov_b64 v[18:19], v[72:73]
  s_nop 4
  v_cvt_pk_bf16_f32 v32, v32, v33
  v_cvt_pk_bf16_f32 v33, v34, v35
  v_bfi_b32 v32, 1, s72, v32
  buffer_store_dwordx2 v[32:33], v68, s[8:11], s76 offen sc1
  ds_read_b128 v[0:3], v76 offset:14848
  s_waitcnt lgkmcnt(0)
  ds_read_b64 v[16:17], v77 offset:256
  s_waitcnt lgkmcnt(0)
  ds_read_b128 v[64:67], v76 offset:19456
  s_waitcnt lgkmcnt(0)
  v_xor_b32 v75, 0x8000, v75
  s_waitcnt vmcnt(0)
  buffer_load_dwordx4 v[52:55], v76, s[8:11], s60 offen offset:0 sc1
  buffer_load_dwordx4 v[56:59], v76, s[8:11], s60 offen offset:1024 sc1
  s_add_u32 s66, s66, 1
  s_xor_b32 s64, s64, 16384
  s_xor_b32 s65, s65, 16384
  s_add_u32 s58, s58, 655360
  s_add_u32 s59, s59, 655360
  s_add_u32 s70, s70, 655360
  s_add_u32 s68, s68, 655360
  s_mov_b32 m0, 10752
  s_add_u32 s85, s65, 6144
  s_cmp_eq_u32 s66, 62
  s_cselect_b64 s[16:17], s[20:21], s[16:17]
  s_cselect_b32 s18, (Cs0_done - Cs0_last), s18
  s_cselect_b32 s70, 0, s70
  s_cmp_eq_u32 s66, 63
  s_cselect_b32 s59, 268435456, s59
  s_cselect_b32 s58, 268435456, s58
  s_waitcnt lgkmcnt(0)
  s_waitcnt vmcnt(1)
  v_mfma_f32_16x16x32_bf16 v[4:7], v[0:3], v[52:55], 0
  v_bitop3_b32 v72, v52, v54, s72 bitop3:0x7e
  s_waitcnt vmcnt(0)
  v_mfma_f32_16x16x32_bf16 v[4:7], v[0:3], v[56:59], v[4:7]
  v_bitop3_b32 v73, v56, v58, s72 bitop3:0x7e
  v_bitop3_b32 v72, v72, v73, 1 bitop3:0xa8
  v_cmp_ne_u32 vcc, 0, v72
  s_cbranch_vccnz Cs0_h1r
  s_nop 2
  v_add_f32_dpp v4, v4, v4 row_ror:4 row_mask:0xf bank_mask:0xf
  v_add_f32_dpp v5, v5, v5 row_ror:4 row_mask:0xf bank_mask:0xf
  s_nop 0
  v_add_f32_dpp v4, v4, v4 row_ror:8 row_mask:0xf bank_mask:0xf
  v_add_f32_dpp v5, v5, v5 row_ror:8 row_mask:0xf bank_mask:0xf
  v_cvt_pk_bf16_f32 v4, v4, v5
  buffer_store_dword v4, v69, s[8:11], s62 offen sc1
  s_xor_b32 s62, s62, 16384
  buffer_store_dword v71, v69, s[8:11], s62 offen sc1
  s_xor_b32 s72, s72, 1
  s_branch Cs0_h2
Cs0_h1r:
  s_mov_b64 exec, vcc
  buffer_load_dwordx4 v[52:55], v76, s[8:11], s60 offen offset:0 sc1
  buffer_load_dwordx4 v[56:59], v76, s[8:11], s60 offen offset:1024 sc1
  s_mov_b64 exec, -1
  s_add_u32 s67, s67, 1
  s_waitcnt vmcnt(1)
  v_mfma_f32_16x16x32_bf16 v[4:7], v[0:3], v[52:55], 0
  v_bitop3_b32 v72, v52, v54, s72 bitop3:0x7e
  s_waitcnt vmcnt(0)
  v_mfma_f32_16x16x32_bf16 v[4:7], v[0:3], v[56:59], v[4:7]
  v_bitop3_b32 v73, v56, v58, s72 bitop3:0x7e
  v_bitop3_b32 v72, v72, v73, 1 bitop3:0xa8
  v_cmp_ne_u32 vcc, 0, v72
  s_cbranch_vccz Cs0_h1p
Cs0_h1s:
  s_mov_b64 exec, vcc
  buffer_load_dwordx4 v[52:55], v76, s[8:11], s60 offen offset:0 sc1
  buffer_load_dwordx4 v[56:59], v76, s[8:11], s60 offen offset:1024 sc1
  s_mov_b64 exec, -1
  s_add_u32 s67, s67, 1
  s_waitcnt vmcnt(1)
  v_mfma_f32_16x16x32_bf16 v[4:7], v[0:3], v[52:55], 0
  v_bitop3_b32 v72, v52, v54, s72 bitop3:0x7e
  s_waitcnt vmcnt(0)
  v_mfma_f32_16x16x32_bf16 v[4:7], v[0:3], v[56:59], v[4:7]
  v_bitop3_b32 v73, v56, v58, s72 bitop3:0x7e
  v_bitop3_b32 v72, v72, v73, 1 bitop3:0xa8
  v_cmp_ne_u32 vcc, 0, v72
  s_cbranch_vccz Cs0_h1p
  s_cmp_lt_u32 s67, 131072
  s_cbranch_scc1 Cs0_h1s
Cs0_h1p:
  s_nop 2
  v_add_f32_dpp v4, v4, v4 row_ror:4 row_mask:0xf bank_mask:0xf
  v_add_f32_dpp v5, v5, v5 row_ror:4 row_mask:0xf bank_mask:0xf
  s_nop 0
  v_add_f32_dpp v4, v4, v4 row_ror:8 row_mask:0xf bank_mask:0xf
  v_add_f32_dpp v5, v5, v5 row_ror:8 row_mask:0xf bank_mask:0xf
  v_cvt_pk_bf16_f32 v4, v4, v5
  buffer_store_dword v4, v69, s[8:11], s62 offen sc1
  s_xor_b32 s62, s62, 16384
  buffer_store_dword v71, v69, s[8:11], s62 offen sc1
  s_xor_b32 s72, s72, 1
  s_branch Cs0_h2
Cs0_rec:
  s_nop 7
  s_waitcnt vmcnt(0) lgkmcnt(0)
  v_max3_u32 v72, v0, v1, v2
  v_max3_u32 v72, v72, v3, v4
  v_max3_u32 v72, v72, v5, v6
  v_max3_u32 v72, v72, v7, v8
  v_max3_u32 v72, v72, v9, v10
  v_max3_u32 v72, v72, v11, v12
  v_max3_u32 v72, v72, v13, v14
  v_max3_u32 v72, v72, v15, v16
  v_max3_u32 v72, v72, v17, v18
  v_max_u32 v72, v72, v19
  v_cmp_eq_u32 vcc, -1, v72
  s_cbranch_vccz Cs0_recok
  s_barrier
  v_mov_b64 v[20:21], 0
  v_mov_b64 v[22:23], 0
  v_mov_b64 v[24:25], 0
  v_mov_b64 v[26:27], 0
  v_mov_b64 v[28:29], 0
  v_mov_b64 v[30:31], 0
  v_mov_b64 v[32:33], 0
  v_mov_b64 v[34:35], 0
  s_waitcnt lgkmcnt(0)
  s_barrier
  ds_read_b128 v[0:3], v76 offset:4608
  s_waitcnt lgkmcnt(0)
  v_smfmac_f32_16x16x64_bf16 v[20:23], v[0:3], v[80:87], v74
  v_smfmac_f32_16x16x64_bf16 v[24:27], v[0:3], v[88:95], v74
  ds_read_b128 v[60:63], v76 offset:16384
  ds_read_b128 v[64:67], v76 offset:17408
  s_waitcnt lgkmcnt(0)
  v_smfmac_f32_16x16x64_bf16 v[28:31], v[0:3], v[60:67], v74
  ds_read_b128 v[60:63], v76 offset:18432
  ds_read_b128 v[64:67], v76 offset:19456
  s_waitcnt lgkmcnt(0)
  v_smfmac_f32_16x16x64_bf16 v[32:35], v[0:3], v[60:67], v74
  ds_read_b128 v[4:7], v76 offset:5632
  s_waitcnt lgkmcnt(0)
  v_smfmac_f32_16x16x64_bf16 v[20:23], v[4:7], v[96:103], v74
  v_smfmac_f32_16x16x64_bf16 v[24:27], v[4:7], v[104:111], v74
  ds_read_b128 v[60:63], v76 offset:32768
  ds_read_b128 v[64:67], v76 offset:33792
  s_waitcnt lgkmcnt(0)
  v_smfmac_f32_16x16x64_bf16 v[28:31], v[4:7], v[60:67], v74
  ds_read_b128 v[60:63], v76 offset:34816
  ds_read_b128 v[64:67], v76 offset:35840
  s_waitcnt lgkmcnt(0)
  v_smfmac_f32_16x16x64_bf16 v[32:35], v[4:7], v[60:67], v74
  ds_read_b128 v[8:11], v76 offset:6656
  s_waitcnt lgkmcnt(0)
  v_smfmac_f32_16x16x64_bf16 v[20:23], v[8:11], v[112:119], v74
  v_smfmac_f32_16x16x64_bf16 v[24:27], v[8:11], v[120:127], v74
  v_smfmac_f32_16x16x64_bf16 v[28:31], v[8:11], v[208:215], v74
  v_smfmac_f32_16x16x64_bf16 v[32:35], v[8:11], v[216:223], v74
  ds_read_b128 v[12:15], v76 offset:7680
  s_waitcnt lgkmcnt(0)
  v_smfmac_f32_16x16x64_bf16 v[20:23], v[12:15], v[128:135], v74
  v_smfmac_f32_16x16x64_bf16 v[24:27], v[12:15], v[136:143], v74
  v_smfmac_f32_16x16x64_bf16 v[28:31], v[12:15], v[224:231], v74
  v_smfmac_f32_16x16x64_bf16 v[32:35], v[12:15], v[232:239], v74
  ds_read_b128 v[0:3], v76 offset:8704
  s_waitcnt lgkmcnt(0)
  v_smfmac_f32_16x16x64_bf16 v[20:23], v[0:3], v[144:151], v74
  v_smfmac_f32_16x16x64_bf16 v[24:27], v[0:3], v[152:159], v74
  ds_read_b128 v[60:63], v76 offset:49152
  ds_read_b128 v[64:67], v76 offset:50176
  s_waitcnt lgkmcnt(0)
  v_smfmac_f32_16x16x64_bf16 v[28:31], v[0:3], v[60:67], v74
  ds_read_b128 v[60:63], v76 offset:51200
  ds_read_b128 v[64:67], v76 offset:52224
  s_waitcnt lgkmcnt(0)
  v_smfmac_f32_16x16x64_bf16 v[32:35], v[0:3], v[60:67], v74
  ds_read_b128 v[8:11], v76 offset:9728
  s_waitcnt lgkmcnt(0)
  v_smfmac_f32_16x16x64_bf16 v[20:23], v[8:11], v[160:167], v74
  v_smfmac_f32_16x16x64_bf16 v[24:27], v[8:11], v[168:175], v74
  ds_read_b128 v[60:63], v75 offset:16384
  ds_read_b128 v[64:67], v75 offset:17408
  s_waitcnt lgkmcnt(0)
  v_smfmac_f32_16x16x64_bf16 v[28:31], v[8:11], v[60:67], v74
  ds_read_b128 v[60:63], v75 offset:18432
  ds_read_b128 v[64:67], v75 offset:19456
  s_waitcnt lgkmcnt(0)
  v_smfmac_f32_16x16x64_bf16 v[32:35], v[8:11], v[60:67], v74
  ds_read_b128 v[16:19], v76 offset:10752
  ds_read_b128 v[60:63], v75 offset:0
  ds_read_b128 v[64:67], v75 offset:1024
  s_waitcnt lgkmcnt(0)
  v_smfmac_f32_16x16x64_bf16 v[20:23], v[16:19], v[60:67], v74
  ds_read_b128 v[60:63], v75 offset:2048
  ds_read_b128 v[64:67], v75 offset:3072
  s_waitcnt lgkmcnt(0)
  v_smfmac_f32_16x16x64_bf16 v[24:27], v[16:19], v[60:67], v74
  v_smfmac_f32_16x16x64_bf16 v[28:31], v[16:19], v[240:247], v74
  v_smfmac_f32_16x16x64_bf16 v[32:35], v[16:19], v[248:255], v74
  ds_read_b128 v[4:7], v76 offset:11776
  s_waitcnt lgkmcnt(0)
  v_smfmac_f32_16x16x64_bf16 v[20:23], v[4:7], v[176:183], v74
  v_smfmac_f32_16x16x64_bf16 v[24:27], v[4:7], v[184:191], v74
  v_smfmac_f32_16x16x64_bf16 v[28:31], v[4:7], a[0:7], v74
  v_smfmac_f32_16x16x64_bf16 v[32:35], v[4:7], a[8:15], v74
  ds_read_b128 v[12:15], v76 offset:12800
  s_waitcnt lgkmcnt(0)
  v_smfmac_f32_16x16x64_bf16 v[20:23], v[12:15], v[192:199], v74
  v_smfmac_f32_16x16x64_bf16 v[24:27], v[12:15], v[200:207], v74
  v_smfmac_f32_16x16x64_bf16 v[28:31], v[12:15], a[16:23], v74
  v_smfmac_f32_16x16x64_bf16 v[32:35], v[12:15], a[24:31], v74
  v_add_f32 v20, v20, v22
  v_add_f32 v21, v21, v23
  v_add_f32 v24, v24, v26
  v_cvt_pk_bf16_f32 v22, v20, v24
  ds_write_b32 v79, v22 offset:0
  v_add_f32 v25, v25, v27
  v_cvt_pk_bf16_f32 v23, v21, v25
  ds_write_b32 v79, v23 offset:576
  v_add_f32 v28, v28, v30
  v_add_f32 v29, v29, v31
  s_waitcnt lgkmcnt(0)
  s_nop 1
  s_branch Cs0_recok
Cs0_mx:
  s_waitcnt lgkmcnt(0)
  s_barrier
  buffer_load_dwordx4 v[0:3], v76, s[8:11], s58 offen offset:0 sc1
  ds_read_b128 v[20:23], v77 offset:0
  ds_read_b128 v[28:31], v77 offset:256
  buffer_load_dwordx4 v[4:7], v76, s[8:11], s58 offen offset:1024 sc1
  ds_read_b128 v[24:27], v77 offset:128
  ds_read_b128 v[32:35], v77 offset:384
  s_waitcnt vmcnt(1) lgkmcnt(3)
  v_mfma_f32_16x16x32_bf16 v[8:11], v[0:3], v[20:23], 0
  s_waitcnt vmcnt(0) lgkmcnt(1)
  v_mfma_f32_16x16x32_bf16 v[8:11], v[4:7], v[24:27], v[8:11]
  v_mfma_f32_16x16x32_bf16 v[12:15], v[28:31], v[20:23], 0
  s_waitcnt lgkmcnt(0)
  v_mfma_f32_16x16x32_bf16 v[12:15], v[32:35], v[24:27], v[12:15]
  v_add_f32_dpp v8, v10, v8 quad_perm:[2,3,0,1] row_mask:0xf bank_mask:0xf
  v_add_f32_dpp v9, v11, v9 quad_perm:[2,3,0,1] row_mask:0xf bank_mask:0xf
  s_nop 0
  v_mov_b32_dpp v8, v8 quad_perm:[0,1,0,1] row_mask:0xf bank_mask:0xf
  v_mov_b32_dpp v9, v9 quad_perm:[0,1,0,1] row_mask:0xf bank_mask:0xf
  s_nop 1
  v_add_f32_dpp v12, v14, v12 quad_perm:[2,3,0,1] row_mask:0xf bank_mask:0xf
  v_add_f32_dpp v13, v15, v13 quad_perm:[2,3,0,1] row_mask:0xf bank_mask:0xf
  s_nop 0
  v_mov_b32_dpp v12, v12 quad_perm:[0,1,0,1] row_mask:0xf bank_mask:0xf
  v_mov_b32_dpp v13, v13 quad_perm:[0,1,0,1] row_mask:0xf bank_mask:0xf
  v_mul_f32 v12, s69, v12
  ds_write_b32 v78, v8 offset:8704
  v_mul_f32 v13, s69, v13
  ds_write_b32 v78, v9 offset:8768
  s_waitcnt lgkmcnt(0)
  s_barrier
  ds_read_b128 v[36:39], v78 offset:8704
  ds_read_b128 v[40:43], v78 offset:8768
  s_waitcnt lgkmcnt(0)
  s_barrier
  v_max_f32 v16, v36, v37
  v_max3_f32 v16, v16, v38, v39
  v_max3_f32 v16, v16, v40, v41
  v_max3_f32 v16, v16, v42, v43
  v_max3_f32 v16, v16, v12, v13
  v_mov_b32 v17, v16
  s_nop 1
  v_permlane16_swap_b32 v16, v17
  v_max_f32 v16, v16, v17
  v_mov_b32 v17, v16
  s_nop 1
  v_permlane32_swap_b32 v16, v17
  v_max_f32 v16, v16, v17
  v_sub_f32 v36, v36, v16
  v_sub_f32 v37, v37, v16
  v_sub_f32 v38, v38, v16
  v_sub_f32 v39, v39, v16
  v_sub_f32 v40, v40, v16
  v_sub_f32 v41, v41, v16
  v_sub_f32 v42, v42, v16
  v_sub_f32 v43, v43, v16
  v_sub_f32 v12, v12, v16
  v_sub_f32 v13, v13, v16
  v_exp_f32 v36, v36
  v_exp_f32 v37, v37
  v_exp_f32 v38, v38
  v_exp_f32 v39, v39
  v_exp_f32 v40, v40
  v_exp_f32 v41, v41
  v_exp_f32 v42, v42
  v_exp_f32 v43, v43
  v_exp_f32 v12, v12
  v_exp_f32 v13, v13
  v_cvt_pk_bf16_f32 v32, v36, v40
  v_cvt_pk_bf16_f32 v33, v37, v41
  v_cvt_pk_bf16_f32 v34, v38, v42
  v_cvt_pk_bf16_f32 v35, v39, v43
  v_cvt_pk_bf16_f32 v28, v12, v13
  v_cvt_pk_bf16_f32 v31, v12, v13
  v_mov_b32 v29, 0
  v_mov_b32 v30, 0
  v_mov_b32 v68, 0x3f803f80
  v_mov_b32 v69, 0x3f803f80
  v_mov_b32 v70, 0x3f803f80
  v_mov_b32 v71, 0x3f803f80
  s_nop 1
  v_mfma_f32_16x16x32_bf16 v[8:11], v[32:35], v[68:71], 0
  v_mfma_f32_16x16x32_bf16 v[0:3], v[32:35], v[52:55], 0
  v_mfma_f32_16x16x32_bf16 v[4:7], v[32:35], v[56:59], 0
  v_mfma_f32_16x16x16_bf16 v[8:11], v[28:29], v[68:69], v[8:11]
  v_mfma_f32_16x16x16_bf16 v[0:3], v[28:29], v[72:73], v[0:3]
  v_mfma_f32_16x16x16_bf16 v[4:7], v[30:31], v[72:73], v[4:7]
  ds_read_b128 v[68:71], v76 offset:13824
  v_rcp_f32 v10, v8
  v_rcp_f32 v11, v9
  v_mul_f32 v0, v10, v0
  v_mul_f32 v1, v11, v1
  s_nop 0
  v_mul_f32 v4, v10, v4
  v_mul_f32 v5, v11, v5
  v_cvt_pk_bf16_f32 v2, v0, v4
  ds_write_b32 v79, v2 offset:8704
  v_cvt_pk_bf16_f32 v3, v1, v5
  ds_write_b32 v79, v3 offset:9280
  v_mov_b64 v[16:17], 0
  v_mov_b64 v[18:19], 0
  v_mov_b64 v[20:21], 0
  v_mov_b64 v[22:23], 0
  v_mov_b64 v[24:25], 0
  v_mov_b64 v[26:27], 0
  s_branch Cs0_mxok
Cs0_kv3:
  s_waitcnt lgkmcnt(0)
  s_cmp_ge_u32 s57, 0x700
  s_cbranch_scc1 Cs0_kvb
  s_load_dword s57, s[12:13], s71 glc
  s_add_u32 s67, s67, 1
  s_cmp_lt_u32 s67, 131072
  s_cbranch_scc1 Cs0_kv3
  s_waitcnt lgkmcnt(0)
  s_branch Cs0_kvb
Cs0_last:
  ds_read_b128 v[4:7], v76 offset:5632
  ds_read_b128 v[12:15], v76 offset:7680
  ds_read_b128 v[44:47], v76 offset:32768
  ds_read_b128 v[48:51], v76 offset:33792
  s_nop 5
  v_mov_b64 v[20:21], 0
  v_mov_b64 v[22:23], 0
  v_mov_b64 v[24:25], 0
  v_mov_b64 v[26:27], 0
  v_smfmac_f32_16x16x64_bf16 v[28:31], v[0:3], v[36:43], v74
  ds_read_b128 v[36:39], v76 offset:34816
  ds_read_b128 v[40:43], v76 offset:35840
  v_smfmac_f32_16x16x64_bf16 v[32:35], v[0:3], v[60:67], v74
  s_waitcnt lgkmcnt(5)
  v_smfmac_f32_16x16x64_bf16 v[20:23], v[0:3], a[32:39], v74
  ds_read_b128 v[60:63], v76 offset:49152
  ds_read_b128 v[64:67], v76 offset:50176
  v_smfmac_f32_16x16x64_bf16 v[24:27], v[0:3], a[40:47], v74
  s_waitcnt lgkmcnt(4)
  v_smfmac_f32_16x16x64_bf16 v[20:23], v[4:7], a[48:55], v74
  buffer_store_dwordx4 v[16:19], v76, s[8:11], s68 offen sc1
  v_smfmac_f32_16x16x64_bf16 v[24:27], v[4:7], a[56:63], v74
  v_smfmac_f32_16x16x64_bf16 v[28:31], v[4:7], v[44:51], v74
  s_waitcnt lgkmcnt(2)
  v_smfmac_f32_16x16x64_bf16 v[20:23], v[8:11], a[64:71], v74
  ds_read_b128 v[44:47], v76 offset:51200
  ds_read_b128 v[48:51], v76 offset:52224
  v_smfmac_f32_16x16x64_bf16 v[24:27], v[8:11], a[72:79], v74
  v_smfmac_f32_16x16x64_bf16 v[32:35], v[4:7], v[36:43], v74
  v_smfmac_f32_16x16x64_bf16 v[28:31], v[8:11], v[208:215], v74
  ds_read_b128 v[36:39], v75 offset:16384
  ds_read_b128 v[40:43], v75 offset:17408
  v_smfmac_f32_16x16x64_bf16 v[32:35], v[8:11], v[216:223], v74
  v_smfmac_f32_16x16x64_bf16 v[20:23], v[12:15], a[80:87], v74
  v_smfmac_f32_16x16x64_bf16 v[24:27], v[12:15], a[88:95], v74
  v_smfmac_f32_16x16x64_bf16 v[28:31], v[12:15], v[224:231], v74
  v_smfmac_f32_16x16x64_bf16 v[32:35], v[12:15], v[232:239], v74
  s_waitcnt vmcnt(1)
  s_barrier
Cs0_lastr:
  ds_read_b128 v[0:3], v76 offset:8704
  ds_read_b128 v[8:11], v76 offset:9728
  ds_read_b128 v[16:19], v76 offset:10752
  ds_read_b128 v[4:7], v76 offset:11776
  ds_read_b128 v[12:15], v76 offset:12800
  s_waitcnt lgkmcnt(4)
  v_max3_u32 v72, v0, v1, v2
  s_waitcnt lgkmcnt(1)
  v_max3_u32 v72, v72, v3, v4
  v_max3_u32 v72, v72, v5, v6
  v_max3_u32 v72, v72, v7, v8
  v_max3_u32 v72, v72, v9, v10
  s_waitcnt lgkmcnt(0)
  v_max3_u32 v72, v72, v11, v12
  v_max3_u32 v72, v72, v13, v14
  v_max3_u32 v72, v72, v15, v16
  v_max3_u32 v72, v72, v17, v18
  v_max_u32 v72, v72, v19
  v_cmp_eq_u32 vcc, -1, v72
  s_cbranch_vccnz Cs0_lastp
Cs0_lastg:
  v_smfmac_f32_16x16x64_bf16 v[28:31], v[0:3], v[60:67], v74
  ds_read_b128 v[60:63], v75 offset:18432
  ds_read_b128 v[64:67], v75 offset:19456
  v_smfmac_f32_16x16x64_bf16 v[32:35], v[0:3], v[44:51], v74
  v_smfmac_f32_16x16x64_bf16 v[28:31], v[8:11], v[36:43], v74
  v_smfmac_f32_16x16x64_bf16 v[28:31], v[16:19], v[240:247], v74
  v_smfmac_f32_16x16x64_bf16 v[28:31], v[4:7], a[0:7], v74
  v_smfmac_f32_16x16x64_bf16 v[28:31], v[12:15], a[16:23], v74
  v_smfmac_f32_16x16x64_bf16 v[32:35], v[16:19], v[248:255], v74
  v_smfmac_f32_16x16x64_bf16 v[32:35], v[4:7], a[8:15], v74
  s_waitcnt lgkmcnt(0)
  v_smfmac_f32_16x16x64_bf16 v[32:35], v[12:15], a[24:31], v74
  v_smfmac_f32_16x16x64_bf16 v[32:35], v[8:11], v[60:67], v74
  v_smfmac_f32_16x16x64_bf16 v[20:23], v[0:3], a[96:103], v74
  v_smfmac_f32_16x16x64_bf16 v[20:23], v[8:11], a[112:119], v74
  v_add_f32 v28, v28, v30
  v_add_f32 v32, v32, v34
  v_cvt_pk_bf16_f32 v30, v28, v32
  v_smfmac_f32_16x16x64_bf16 v[20:23], v[16:19], a[128:135], v74
  ds_write_b32 v79, v30 offset:256
  v_add_f32 v29, v29, v31
  v_add_f32 v33, v33, v35
  v_cvt_pk_bf16_f32 v31, v29, v33
  v_smfmac_f32_16x16x64_bf16 v[20:23], v[4:7], a[144:151], v74
  ds_write_b32 v79, v31 offset:832
  v_smfmac_f32_16x16x64_bf16 v[20:23], v[12:15], a[160:167], v74
  v_smfmac_f32_16x16x64_bf16 v[24:27], v[0:3], a[104:111], v74
  v_smfmac_f32_16x16x64_bf16 v[24:27], v[8:11], a[120:127], v74
  v_smfmac_f32_16x16x64_bf16 v[24:27], v[16:19], a[136:143], v74
  s_waitcnt lgkmcnt(0)
  s_barrier
  ds_read_b64 v[52:53], v77 offset:256
  v_add_f32 v20, v20, v22
  v_smfmac_f32_16x16x64_bf16 v[24:27], v[4:7], a[152:159], v74
  v_add_f32 v21, v21, v23
  v_smfmac_f32_16x16x64_bf16 v[24:27], v[12:15], a[168:175], v74
  v_cvt_pk_bf16_f32 v54, v20, v21
  s_add_u32 s68, s68, 655360
  s_nop 3
  v_add_f32 v24, v24, v26
  v_add_f32 v25, v25, v27
  v_cvt_pk_bf16_f32 v55, v24, v25
  s_waitcnt lgkmcnt(0)
  buffer_store_dwordx4 v[52:55], v76, s[8:11], s68 offen sc1
  s_branch Cs0_done
Cs0_lastp:
  s_add_u32 s72, s72, 2
  s_cmp_ge_u32 s72, 131072
  s_cbranch_scc1 Cs0_lastg
  s_barrier
  buffer_load_dwordx4 v76, s[8:11], s85 offen offset:0 sc1 lds
  s_waitcnt vmcnt(0)
  s_barrier
  s_branch Cs0_lastr
Cs0_done:
  s_branch L_cexit
L_w5:
  v_mov_b64 v[20:21], 0
  v_mov_b64 v[22:23], 0
  v_mov_b64 v[24:25], 0
  v_mov_b64 v[26:27], 0
  v_mov_b64 v[28:29], 0
  v_mov_b64 v[30:31], 0
  v_mov_b64 v[32:33], 0
  v_mov_b64 v[34:35], 0
  s_mov_b32 s78, 0x3f803f80
  s_mov_b32 s79, s78
  s_mov_b32 s65, 360448
  s_mov_b32 m0, 15872
  s_lshl_b32 s71, s53, 2
  s_add_u32 s71, s71, 128
  s_movk_i32 s56, 0x1000
  v_lshlrev_b32 v73, 2, v76
  v_mov_b32 v72, 0
  s_mov_b64 s[16:17], s[8:9]
  s_mov_b32 s18, 268435456
  s_mov_b32 s19, 0x20000
  s_getpc_b64 s[20:21]
Cs1_pc:
  s_add_u32 s20, s20, (Cs1_last - Cs1_pc)
  s_addc_u32 s21, s21, 0
  v_mov_b32 v68, 14880
  buffer_load_dwordx4 v[52:55], v76, s[8:11], s59 offen offset:0 sc1
  buffer_load_dwordx4 v[56:59], v76, s[8:11], s59 offen offset:1024 sc1
  ds_read_b128 v[36:39], v76 offset:20480
  ds_read_b128 v[40:43], v76 offset:21504
  ds_read_b128 v[60:63], v76 offset:22528
  ds_read_b128 v[64:67], v76 offset:23552
  ds_read_b128 v[0:3], v76 offset:4608
  ds_read_b128 v[4:7], v76 offset:5632
  ds_read_b128 v[8:11], v76 offset:6656
  ds_read_b128 v[12:15], v76 offset:7680
  s_waitcnt lgkmcnt(0)
  s_cmp_eq_u32 s66, 1
  s_branch Cs1_top2
.p2align 6
Cs1_h2:
  ds_read_b128 v[36:39], v76 offset:20480
  s_cmp_eq_u32 s66, 62
  s_cselect_b64 s[16:17], s[20:21], s[16:17]
  s_cselect_b32 s18, (Cs1_done - Cs1_last), s18
  s_cselect_b32 s70, 0, s70
  s_cmp_eq_u32 s66, 63
  s_cselect_b32 s59, 268435456, s59
  s_cselect_b32 s58, 268435456, s58
  ds_read_b128 v[40:43], v76 offset:21504
  v_mov_b64 v[20:21], 0
  v_mov_b64 v[22:23], 0
  v_mov_b64 v[24:25], 0
  v_mov_b64 v[26:27], 0
  v_mov_b32 v68, 14880
  ds_read_b128 v[60:63], v76 offset:22528
  v_mov_b64 v[28:29], 0
  v_mov_b64 v[30:31], 0
  v_mov_b64 v[32:33], 0
  v_mov_b64 v[34:35], 0
  v_lshlrev_b32 v73, 2, v76
  buffer_load_dwordx4 v[52:55], v76, s[8:11], s59 offen offset:0 sc1
  buffer_load_dwordx4 v[56:59], v76, s[8:11], s59 offen offset:1024 sc1
  s_waitcnt vmcnt(0)
  s_mov_b64 vcc, -1
Cs1_h2r:
  s_mov_b64 exec, vcc
  buffer_load_dwordx4 v[8:11], v76, s[8:11], s65 offen offset:2048 sc1
  buffer_load_dwordx4 v[0:3], v76, s[8:11], s85 offen offset:0 sc1
  s_mov_b64 exec, -1
  s_add_u32 s67, s67, 1
  s_cmp_lt_u32 s67, 131072
  s_cselect_b32 s54, -2, -1
  s_waitcnt vmcnt(1)
  v_max3_u32 v72, v8, v9, v10
  s_waitcnt vmcnt(0)
  v_max3_u32 v72, v72, v11, v0
  v_max3_u32 v72, v72, v1, v2
  v_max_u32 v72, v72, v3
  v_cmp_lt_u32 vcc, s54, v72
  s_cbranch_vccnz Cs1_h2r
  ds_write_b128 v76, v[8:11] offset:6656
  ds_write_b128 v76, v[0:3] offset:11776
Cs1_h2w:
  s_cmp_eq_u32 s66, 63
  s_waitcnt lgkmcnt(0)
  s_barrier
  ds_read_b128 v[0:3], v76 offset:4608
Cs1_top2:
  v_smfmac_f32_16x16x64_bf16 v[20:23], v[8:11], v[112:119], v74
  s_cbranch_scc1 Cs1_last
  v_smfmac_f32_16x16x64_bf16 v[24:27], v[8:11], v[120:127], v74
  buffer_load_dwordx4 v[44:47], v76, s[8:11], s58 offen offset:0 sc1
  s_mov_b32 m0, 15872
  v_smfmac_f32_16x16x64_bf16 v[28:31], v[8:11], v[208:215], v74
  buffer_load_dwordx4 v[48:51], v76, s[8:11], s58 offen offset:1024 sc1
  v_smfmac_f32_16x16x64_bf16 v[32:35], v[8:11], v[216:223], v74
  ds_read_b128 v[4:7], v76 offset:5632
  s_waitcnt lgkmcnt(1)
  v_smfmac_f32_16x16x64_bf16 v[20:23], v[0:3], v[80:87], v74
  ds_read_b128 v[12:15], v76 offset:7680
  v_smfmac_f32_16x16x64_bf16 v[28:31], v[0:3], v[36:43], v74
  ds_read_b128 v[36:39], v76 offset:36864
  v_smfmac_f32_16x16x64_bf16 v[24:27], v[0:3], v[88:95], v74
  buffer_store_dwordx4 v[16:19], v76, s[8:11], s68 offen sc1
  ds_read_b128 v[40:43], v76 offset:37888
  v_smfmac_f32_16x16x64_bf16 v[32:35], v[0:3], v[60:67], v74
  buffer_load_dword v73, s[16:19], s70 offen lds
  ds_read_b128 v[60:63], v76 offset:38912
  s_waitcnt lgkmcnt(4)
  v_smfmac_f32_16x16x64_bf16 v[20:23], v[4:7], v[96:103], v74
  ds_read_b128 v[64:67], v76 offset:39936
  v_smfmac_f32_16x16x64_bf16 v[24:27], v[4:7], v[104:111], v74
  s_waitcnt vmcnt(4)
  s_waitcnt lgkmcnt(4)
  v_smfmac_f32_16x16x64_bf16 v[20:23], v[12:15], v[128:135], v74
  s_barrier
  ds_read_b128 v[8:11], v76 offset:8704
  s_waitcnt lgkmcnt(3)
  v_smfmac_f32_16x16x64_bf16 v[28:31], v[4:7], v[36:43], v74
  ds_read_b128 v[36:39], v76 offset:53248
  v_smfmac_f32_16x16x64_bf16 v[24:27], v[12:15], v[136:143], v74
  ds_read_b128 v[40:43], v76 offset:54272
  s_waitcnt lgkmcnt(3)
  v_smfmac_f32_16x16x64_bf16 v[32:35], v[4:7], v[60:67], v74
  ds_read_b128 v[0:3], v76 offset:9728
  v_smfmac_f32_16x16x64_bf16 v[28:31], v[12:15], v[224:231], v74
  ds_read_b128 v[60:63], v76 offset:55296
  v_smfmac_f32_16x16x64_bf16 v[32:35], v[12:15], v[232:239], v74
  ds_read_b128 v[64:67], v76 offset:56320
  s_waitcnt lgkmcnt(5)
  v_smfmac_f32_16x16x64_bf16 v[20:23], v[8:11], v[144:151], v74
  s_barrier
  ds_read_b128 v[4:7], v76 offset:11776
  s_waitcnt lgkmcnt(4)
  v_smfmac_f32_16x16x64_bf16 v[28:31], v[8:11], v[36:43], v74
  ds_read_b128 v[12:15], v76 offset:12800
  ds_read_b128 v[36:39], v75 offset:4096
  v_smfmac_f32_16x16x64_bf16 v[24:27], v[8:11], v[152:159], v74
  ds_read_b128 v[16:19], v76 offset:10752
  s_waitcnt lgkmcnt(6)
  v_smfmac_f32_16x16x64_bf16 v[20:23], v[0:3], v[160:167], v74
  ds_read_b128 v[40:43], v75 offset:5120
  s_waitcnt lgkmcnt(5)
  v_smfmac_f32_16x16x64_bf16 v[32:35], v[8:11], v[60:67], v74
  ds_read_b128 v[60:63], v75 offset:6144
  v_smfmac_f32_16x16x64_bf16 v[24:27], v[0:3], v[168:175], v74
  ds_read_b128 v[64:67], v75 offset:7168
  s_waitcnt lgkmcnt(6)
  v_smfmac_f32_16x16x64_bf16 v[20:23], v[4:7], v[176:183], v74
  s_waitcnt lgkmcnt(5)
  v_smfmac_f32_16x16x64_bf16 v[20:23], v[12:15], v[192:199], v74
  s_waitcnt lgkmcnt(2)
  v_smfmac_f32_16x16x64_bf16 v[20:23], v[16:19], v[36:43], v74
  ds_read_b128 v[36:39], v75 offset:20480
  v_smfmac_f32_16x16x64_bf16 v[24:27], v[4:7], v[184:191], v74
  ds_read_b128 v[40:43], v75 offset:21504
  s_waitcnt lgkmcnt(2)
  v_smfmac_f32_16x16x64_bf16 v[24:27], v[16:19], v[60:67], v74
  ds_read_b128 v[60:63], v75 offset:22528
  v_add_f32 v20, v20, v22
  v_smfmac_f32_16x16x64_bf16 v[24:27], v[12:15], v[200:207], v74
  ds_read_b128 v[64:67], v75 offset:23552
  v_add_f32 v21, v21, v23
  v_smfmac_f32_16x16x64_bf16 v[28:31], v[16:19], v[240:247], v74
  v_mov_b64 v[70:71], s[78:79]
  v_smfmac_f32_16x16x64_bf16 v[28:31], v[4:7], a[0:7], v74
  s_waitcnt lgkmcnt(2)
  v_add_f32 v24, v24, v26
  v_smfmac_f32_16x16x64_bf16 v[28:31], v[0:3], v[36:43], v74
  ds_read_b128 v[36:39], v68
  v_cvt_pk_bf16_f32 v22, v20, v24
  v_smfmac_f32_16x16x64_bf16 v[28:31], v[12:15], a[16:23], v74
  ds_read_b128 v[40:43], v68
  ds_write_b32 v79, v22 offset:0
  s_waitcnt lgkmcnt(3)
  v_add_f32 v25, v25, v27
  v_cvt_pk_bf16_f32 v23, v21, v25
  v_smfmac_f32_16x16x64_bf16 v[32:35], v[0:3], v[60:67], v74
  ds_write_b32 v79, v23 offset:576
  v_cmp_u_f32 vcc, v20, v21
  v_smfmac_f32_16x16x64_bf16 v[32:35], v[16:19], v[248:255], v74
  v_add_f32 v28, v28, v30
  v_smfmac_f32_16x16x64_bf16 v[32:35], v[4:7], a[8:15], v74
  v_add_f32 v29, v29, v31
  v_smfmac_f32_16x16x64_bf16 v[32:35], v[12:15], a[24:31], v74
  s_cbranch_vccnz Cs1_rec
Cs1_recok:
  s_waitcnt lgkmcnt(3)
  v_smfmac_f32_16x16x64_bf16 v[36:39], v[16:19], a[128:135], v74
  s_waitcnt lgkmcnt(0)
  s_barrier
  ds_read_b128 v[60:63], v77
  v_smfmac_f32_16x16x64_bf16 v[40:43], v[16:19], a[136:143], v74
  ds_read_b128 v[64:67], v77 offset:128
  v_add_f32 v32, v32, v34
  v_cvt_pk_bf16_f32 v30, v28, v32
  v_smfmac_f32_16x16x64_bf16 v[36:39], v[0:3], a[112:119], v74
  ds_write_b32 v79, v30 offset:256
  v_add_f32 v33, v33, v35
  v_cvt_pk_bf16_f32 v31, v29, v33
  v_smfmac_f32_16x16x64_bf16 v[40:43], v[0:3], a[120:127], v74
  ds_write_b32 v79, v31 offset:832
  v_xor_b32 v75, 0x8000, v75
  v_smfmac_f32_16x16x64_bf16 v[36:39], v[4:7], a[144:151], v74
  ds_read_b128 v[0:3], v76 offset:4608
  v_mov_b32 v29, 0
  v_smfmac_f32_16x16x64_bf16 v[40:43], v[4:7], a[152:159], v74
  s_waitcnt vmcnt(2) lgkmcnt(3)
  v_mov_b32 v30, 0
  v_mfma_f32_16x16x32_bf16 v[44:47], v[44:47], v[60:63], 0
  ds_read_b128 v[4:7], v76 offset:5632
  s_waitcnt lgkmcnt(2)
  v_mfma_f32_16x16x32_bf16 v[44:47], v[48:51], v[64:67], v[44:47]
  s_barrier
  v_smfmac_f32_16x16x64_bf16 v[36:39], v[8:11], a[96:103], v74
  ds_read_b128 v[20:23], v77 offset:256
  ds_read_b128 v[24:27], v77 offset:384
  v_smfmac_f32_16x16x64_bf16 v[40:43], v[8:11], a[104:111], v74
  ds_read_b128 v[8:11], v76 offset:6656
  v_add_f32_dpp v72, v46, v44 quad_perm:[2,3,0,1] row_mask:0xf bank_mask:0xf
  v_add_f32_dpp v73, v47, v45 quad_perm:[2,3,0,1] row_mask:0xf bank_mask:0xf
  v_smfmac_f32_16x16x64_bf16 v[36:39], v[12:15], a[160:167], v74
  s_waitcnt lgkmcnt(4)
  v_exp_f32_dpp v72, v72 quad_perm:[0,1,0,1] row_mask:0xf bank_mask:0xf
  v_smfmac_f32_16x16x64_bf16 v[40:43], v[12:15], a[168:175], v74
  ds_read_b128 v[12:15], v76 offset:7680
  v_exp_f32_dpp v73, v73 quad_perm:[0,1,0,1] row_mask:0xf bank_mask:0xf
  v_smfmac_f32_16x16x64_bf16 v[36:39], v[0:3], a[32:39], v74
  s_waitcnt lgkmcnt(2)
  v_cvt_pk_bf16_f32 v72, v72, v73
  v_mfma_f32_16x16x32_bf16 v[20:23], v[20:23], v[60:63], 0
  ds_write_b32 v78, v72 offset:516
  v_mov_b64 v[16:17], 0
  v_mfma_f32_16x16x32_bf16 v[20:23], v[24:27], v[64:67], v[20:23]
  ds_read_b128 v[44:47], v75 offset:20480
  v_mov_b64 v[18:19], 0
  v_smfmac_f32_16x16x64_bf16 v[40:43], v[0:3], a[40:47], v74
  ds_read_b128 v[48:51], v75 offset:21504
  v_mov_b64 v[68:69], s[78:79]
  v_smfmac_f32_16x16x64_bf16 v[36:39], v[4:7], a[48:55], v74
  s_waitcnt lgkmcnt(4)
  v_add_f32_dpp v24, v22, v20 quad_perm:[2,3,0,1] row_mask:0xf bank_mask:0xf
  v_add_f32_dpp v25, v23, v21 quad_perm:[2,3,0,1] row_mask:0xf bank_mask:0xf
  v_smfmac_f32_16x16x64_bf16 v[36:39], v[8:11], a[64:71], v74
  s_waitcnt lgkmcnt(2)
  s_barrier
  ds_read_b128 v[32:35], v78 offset:512
  v_smfmac_f32_16x16x64_bf16 v[36:39], v[12:15], a[80:87], v74
  ds_read_b128 v[60:63], v75 offset:22528
  v_mul_f32 v24, s69, v24
  v_smfmac_f32_16x16x64_bf16 v[40:43], v[4:7], a[56:63], v74
  ds_read_b128 v[64:67], v75 offset:23552
  v_mul_f32 v25, s69, v25
  v_smfmac_f32_16x16x64_bf16 v[40:43], v[8:11], a[72:79], v74
  v_exp_f32_dpp v24, v24 quad_perm:[0,1,0,1] row_mask:0xf bank_mask:0xf
  v_smfmac_f32_16x16x64_bf16 v[40:43], v[12:15], a[88:95], v74
  s_waitcnt lgkmcnt(2)
  v_exp_f32_dpp v25, v25 quad_perm:[0,1,0,1] row_mask:0xf bank_mask:0xf
  v_mfma_f32_16x16x32_bf16 v[8:11], v[32:35], v[68:71], 0
  v_add_f32 v36, v36, v38
  v_add_f32 v37, v37, v39
  v_mfma_f32_16x16x32_bf16 v[0:3], v[32:35], v[52:55], 0
  v_add_f32 v40, v40, v42
  v_add_f32 v41, v41, v43
  v_mfma_f32_16x16x32_bf16 v[4:7], v[32:35], v[56:59], 0
  v_cvt_pk_bf16_f32 v28, v24, v25
  v_cvt_pk_bf16_f32 v72, v36, v37
  v_cvt_pk_bf16_f32 v73, v40, v41
  v_mfma_f32_16x16x16_bf16 v[8:11], v[28:29], v[68:69], v[8:11]
  v_cvt_pk_bf16_f32 v31, v24, v25
  v_mov_b64 v[20:21], 0
  v_mfma_f32_16x16x16_bf16 v[0:3], v[28:29], v[72:73], v[0:3]
  ds_read_b128 v[68:71], v76 offset:13824
  v_mov_b64 v[22:23], 0
  v_mfma_f32_16x16x16_bf16 v[4:7], v[30:31], v[72:73], v[4:7]
  v_rcp_f32 v10, v8
  v_rcp_f32 v11, v9
  v_mul_f32 v0, v10, v0
  v_mul_f32 v1, v11, v1
  s_nop 0
  v_mul_f32 v4, v10, v4
  v_mul_f32 v5, v11, v5
  v_cvt_pk_bf16_f32 v2, v0, v4
  ds_write_b32 v79, v2 offset:8704
  v_cvt_pk_bf16_f32 v3, v1, v5
  ds_write_b32 v79, v3 offset:9280
  v_max3_f32 v8, v8, v9, v10
  v_max_f32 v8, v8, v11
  v_cmp_le_f32 vcc, 1317011456, v8
  v_mov_b64 v[24:25], 0
  v_mov_b64 v[26:27], 0
  s_cbranch_vccnz Cs1_mx
Cs1_mxok:
  s_waitcnt lgkmcnt(0)
  s_barrier
  ds_read_b128 v[0:3], v78 offset:8704
  ds_read_b128 v[4:7], v78 offset:8768
  ds_read_b128 v[8:11], v78 offset:8832
  ds_read_b128 v[12:15], v78 offset:8896
  s_waitcnt lgkmcnt(3)
  v_smfmac_f32_16x16x64_bf16 v[16:19], v[0:3], v[44:51], v74
  ds_read_b128 v[52:55], v75 offset:36864
  s_waitcnt lgkmcnt(3)
  v_smfmac_f32_16x16x64_bf16 v[16:19], v[4:7], v[60:67], v74
  ds_read_b128 v[56:59], v75 offset:37888
  s_waitcnt lgkmcnt(3)
  v_smfmac_f32_16x16x64_bf16 v[16:19], v[8:11], a[176:183], v74
  ds_read_b128 v[36:39], v75 offset:38912
  s_waitcnt lgkmcnt(3)
  v_smfmac_f32_16x16x64_bf16 v[16:19], v[12:15], a[184:191], v74
  ds_read_b128 v[40:43], v75 offset:39936
  ds_read_b128 v[44:47], v75 offset:53248
  v_smfmac_f32_16x16x64_bf16 v[20:23], v[0:3], a[192:199], v74
  ds_read_b128 v[48:51], v75 offset:54272
  ds_read_b128 v[60:63], v75 offset:55296
  v_smfmac_f32_16x16x64_bf16 v[20:23], v[4:7], a[200:207], v74
  ds_read_b128 v[64:67], v75 offset:56320
  s_waitcnt lgkmcnt(6)
  v_cvt_pk_bf16_f32 v16, v16, v17
  v_cvt_pk_bf16_f32 v17, v18, v19
  v_bfi_b32 v16, 1, s72, v16
  v_smfmac_f32_16x16x64_bf16 v[20:23], v[8:11], v[52:59], v74
  buffer_store_dwordx2 v[16:17], v68, s[8:11], s73 offen sc1
  s_waitcnt lgkmcnt(4)
  v_smfmac_f32_16x16x64_bf16 v[20:23], v[12:15], v[36:43], v74
  v_mov_b64 v[32:33], 0
  v_smfmac_f32_16x16x64_bf16 v[24:27], v[0:3], a[208:215], v74
  v_mov_b64 v[34:35], 0
  v_smfmac_f32_16x16x64_bf16 v[24:27], v[4:7], a[216:223], v74
  s_waitcnt lgkmcnt(2)
  v_cvt_pk_bf16_f32 v20, v20, v21
  v_cvt_pk_bf16_f32 v21, v22, v23
  v_bfi_b32 v20, 1, s72, v20
  v_smfmac_f32_16x16x64_bf16 v[24:27], v[8:11], v[44:51], v74
  buffer_store_dwordx2 v[20:21], v68, s[8:11], s74 offen sc1
  s_waitcnt lgkmcnt(0)
  v_smfmac_f32_16x16x64_bf16 v[24:27], v[12:15], v[60:67], v74
  v_smfmac_f32_16x16x64_bf16 v[32:35], v[0:3], a[224:231], v74
  v_smfmac_f32_16x16x64_bf16 v[32:35], v[4:7], a[232:239], v74
  v_cvt_pk_bf16_f32 v24, v24, v25
  v_cvt_pk_bf16_f32 v25, v26, v27
  v_bfi_b32 v24, 1, s72, v24
  v_smfmac_f32_16x16x64_bf16 v[32:35], v[8:11], a[240:247], v74
  buffer_store_dwordx2 v[24:25], v68, s[8:11], s75 offen sc1
  v_smfmac_f32_16x16x64_bf16 v[32:35], v[12:15], a[248:255], v74
  v_mov_b64 v[18:19], v[72:73]
  s_nop 4
  v_cvt_pk_bf16_f32 v32, v32, v33
  v_cvt_pk_bf16_f32 v33, v34, v35
  v_bfi_b32 v32, 1, s72, v32
  buffer_store_dwordx2 v[32:33], v68, s[8:11], s76 offen sc1
  ds_read_b128 v[0:3], v76 offset:14848
  s_waitcnt lgkmcnt(0)
  ds_read_b64 v[16:17], v77 offset:264
  s_waitcnt lgkmcnt(0)
  ds_read_b128 v[64:67], v76 offset:23552
  s_waitcnt lgkmcnt(0)
  s_add_u32 s66, s66, 1
  s_xor_b32 s64, s64, 16384
  s_xor_b32 s65, s65, 16384
  s_add_u32 s58, s58, 655360
  s_add_u32 s59, s59, 655360
  s_add_u32 s70, s70, 655360
  s_add_u32 s68, s68, 655360
  s_mov_b32 m0, 11776
  s_add_u32 s85, s65, 7168
  v_xor_b32 v75, 0x8000, v75
  s_waitcnt vmcnt(0)
  buffer_load_dwordx4 v[52:55], v76, s[8:11], s60 offen offset:0 sc1
  buffer_load_dwordx4 v[56:59], v76, s[8:11], s60 offen offset:1024 sc1
  s_waitcnt lgkmcnt(0)
  s_waitcnt vmcnt(1)
  v_mfma_f32_16x16x32_bf16 v[4:7], v[0:3], v[52:55], 0
  v_bitop3_b32 v72, v52, v54, s72 bitop3:0x7e
  s_waitcnt vmcnt(0)
  v_mfma_f32_16x16x32_bf16 v[4:7], v[0:3], v[56:59], v[4:7]
  v_bitop3_b32 v73, v56, v58, s72 bitop3:0x7e
  v_bitop3_b32 v72, v72, v73, 1 bitop3:0xa8
  v_cmp_ne_u32 vcc, 0, v72
  s_cbranch_vccnz Cs1_h1r
  s_nop 2
  v_add_f32_dpp v4, v4, v4 row_ror:4 row_mask:0xf bank_mask:0xf
  v_add_f32_dpp v5, v5, v5 row_ror:4 row_mask:0xf bank_mask:0xf
  s_nop 0
  v_add_f32_dpp v4, v4, v4 row_ror:8 row_mask:0xf bank_mask:0xf
  v_add_f32_dpp v5, v5, v5 row_ror:8 row_mask:0xf bank_mask:0xf
  v_cvt_pk_bf16_f32 v4, v4, v5
  buffer_store_dword v4, v69, s[8:11], s62 offen sc1
  s_xor_b32 s62, s62, 16384
  buffer_store_dword v71, v69, s[8:11], s62 offen sc1
  s_xor_b32 s72, s72, 1
  s_branch Cs1_h2
Cs1_h1r:
  s_mov_b64 exec, vcc
  buffer_load_dwordx4 v[52:55], v76, s[8:11], s60 offen offset:0 sc1
  buffer_load_dwordx4 v[56:59], v76, s[8:11], s60 offen offset:1024 sc1
  s_mov_b64 exec, -1
  s_add_u32 s67, s67, 1
  s_waitcnt vmcnt(1)
  v_mfma_f32_16x16x32_bf16 v[4:7], v[0:3], v[52:55], 0
  v_bitop3_b32 v72, v52, v54, s72 bitop3:0x7e
  s_waitcnt vmcnt(0)
  v_mfma_f32_16x16x32_bf16 v[4:7], v[0:3], v[56:59], v[4:7]
  v_bitop3_b32 v73, v56, v58, s72 bitop3:0x7e
  v_bitop3_b32 v72, v72, v73, 1 bitop3:0xa8
  v_cmp_ne_u32 vcc, 0, v72
  s_cbranch_vccz Cs1_h1p
Cs1_h1s:
  s_mov_b64 exec, vcc
  buffer_load_dwordx4 v[52:55], v76, s[8:11], s60 offen offset:0 sc1
  buffer_load_dwordx4 v[56:59], v76, s[8:11], s60 offen offset:1024 sc1
  s_mov_b64 exec, -1
  s_add_u32 s67, s67, 1
  s_waitcnt vmcnt(1)
  v_mfma_f32_16x16x32_bf16 v[4:7], v[0:3], v[52:55], 0
  v_bitop3_b32 v72, v52, v54, s72 bitop3:0x7e
  s_waitcnt vmcnt(0)
  v_mfma_f32_16x16x32_bf16 v[4:7], v[0:3], v[56:59], v[4:7]
  v_bitop3_b32 v73, v56, v58, s72 bitop3:0x7e
  v_bitop3_b32 v72, v72, v73, 1 bitop3:0xa8
  v_cmp_ne_u32 vcc, 0, v72
  s_cbranch_vccz Cs1_h1p
  s_cmp_lt_u32 s67, 131072
  s_cbranch_scc1 Cs1_h1s
Cs1_h1p:
  s_nop 2
  v_add_f32_dpp v4, v4, v4 row_ror:4 row_mask:0xf bank_mask:0xf
  v_add_f32_dpp v5, v5, v5 row_ror:4 row_mask:0xf bank_mask:0xf
  s_nop 0
  v_add_f32_dpp v4, v4, v4 row_ror:8 row_mask:0xf bank_mask:0xf
  v_add_f32_dpp v5, v5, v5 row_ror:8 row_mask:0xf bank_mask:0xf
  v_cvt_pk_bf16_f32 v4, v4, v5
  buffer_store_dword v4, v69, s[8:11], s62 offen sc1
  s_xor_b32 s62, s62, 16384
  buffer_store_dword v71, v69, s[8:11], s62 offen sc1
  s_xor_b32 s72, s72, 1
  s_branch Cs1_h2
Cs1_rec:
  s_nop 7
  s_waitcnt vmcnt(0) lgkmcnt(0)
  v_max3_u32 v72, v0, v1, v2
  v_max3_u32 v72, v72, v3, v4
  v_max3_u32 v72, v72, v5, v6
  v_max3_u32 v72, v72, v7, v8
  v_max3_u32 v72, v72, v9, v10
  v_max3_u32 v72, v72, v11, v12
  v_max3_u32 v72, v72, v13, v14
  v_max3_u32 v72, v72, v15, v16
  v_max3_u32 v72, v72, v17, v18
  v_max_u32 v72, v72, v19
  v_cmp_eq_u32 vcc, -1, v72
  s_cbranch_vccz Cs1_recok
  s_barrier
  v_mov_b64 v[20:21], 0
  v_mov_b64 v[22:23], 0
  v_mov_b64 v[24:25], 0
  v_mov_b64 v[26:27], 0
  v_mov_b64 v[28:29], 0
  v_mov_b64 v[30:31], 0
  v_mov_b64 v[32:33], 0
  v_mov_b64 v[34:35], 0
  s_waitcnt lgkmcnt(0)
  s_barrier
  ds_read_b128 v[0:3], v76 offset:4608
  s_waitcnt lgkmcnt(0)
  v_smfmac_f32_16x16x64_bf16 v[20:23], v[0:3], v[80:87], v74
  v_smfmac_f32_16x16x64_bf16 v[24:27], v[0:3], v[88:95], v74
  ds_read_b128 v[60:63], v76 offset:20480
  ds_read_b128 v[64:67], v76 offset:21504
  s_waitcnt lgkmcnt(0)
  v_smfmac_f32_16x16x64_bf16 v[28:31], v[0:3], v[60:67], v74
  ds_read_b128 v[60:63], v76 offset:22528
  ds_read_b128 v[64:67], v76 offset:23552
  s_waitcnt lgkmcnt(0)
  v_smfmac_f32_16x16x64_bf16 v[32:35], v[0:3], v[60:67], v74
  ds_read_b128 v[4:7], v76 offset:5632
  s_waitcnt lgkmcnt(0)
  v_smfmac_f32_16x16x64_bf16 v[20:23], v[4:7], v[96:103], v74
  v_smfmac_f32_16x16x64_bf16 v[24:27], v[4:7], v[104:111], v74
  ds_read_b128 v[60:63], v76 offset:36864
  ds_read_b128 v[64:67], v76 offset:37888
  s_waitcnt lgkmcnt(0)
  v_smfmac_f32_16x16x64_bf16 v[28:31], v[4:7], v[60:67], v74
  ds_read_b128 v[60:63], v76 offset:38912
  ds_read_b128 v[64:67], v76 offset:39936
  s_waitcnt lgkmcnt(0)
  v_smfmac_f32_16x16x64_bf16 v[32:35], v[4:7], v[60:67], v74
  ds_read_b128 v[8:11], v76 offset:6656
  s_waitcnt lgkmcnt(0)
  v_smfmac_f32_16x16x64_bf16 v[20:23], v[8:11], v[112:119], v74
  v_smfmac_f32_16x16x64_bf16 v[24:27], v[8:11], v[120:127], v74
  v_smfmac_f32_16x16x64_bf16 v[28:31], v[8:11], v[208:215], v74
  v_smfmac_f32_16x16x64_bf16 v[32:35], v[8:11], v[216:223], v74
  ds_read_b128 v[12:15], v76 offset:7680
  s_waitcnt lgkmcnt(0)
  v_smfmac_f32_16x16x64_bf16 v[20:23], v[12:15], v[128:135], v74
  v_smfmac_f32_16x16x64_bf16 v[24:27], v[12:15], v[136:143], v74
  v_smfmac_f32_16x16x64_bf16 v[28:31], v[12:15], v[224:231], v74
  v_smfmac_f32_16x16x64_bf16 v[32:35], v[12:15], v[232:239], v74
  ds_read_b128 v[8:11], v76 offset:8704
  s_waitcnt lgkmcnt(0)
  v_smfmac_f32_16x16x64_bf16 v[20:23], v[8:11], v[144:151], v74
  v_smfmac_f32_16x16x64_bf16 v[24:27], v[8:11], v[152:159], v74
  ds_read_b128 v[60:63], v76 offset:53248
  ds_read_b128 v[64:67], v76 offset:54272
  s_waitcnt lgkmcnt(0)
  v_smfmac_f32_16x16x64_bf16 v[28:31], v[8:11], v[60:67], v74
  ds_read_b128 v[60:63], v76 offset:55296
  ds_read_b128 v[64:67], v76 offset:56320
  s_waitcnt lgkmcnt(0)
  v_smfmac_f32_16x16x64_bf16 v[32:35], v[8:11], v[60:67], v74
  ds_read_b128 v[0:3], v76 offset:9728
  s_waitcnt lgkmcnt(0)
  v_smfmac_f32_16x16x64_bf16 v[20:23], v[0:3], v[160:167], v74
  v_smfmac_f32_16x16x64_bf16 v[24:27], v[0:3], v[168:175], v74
  ds_read_b128 v[60:63], v75 offset:20480
  ds_read_b128 v[64:67], v75 offset:21504
  s_waitcnt lgkmcnt(0)
  v_smfmac_f32_16x16x64_bf16 v[28:31], v[0:3], v[60:67], v74
  ds_read_b128 v[60:63], v75 offset:22528
  ds_read_b128 v[64:67], v75 offset:23552
  s_waitcnt lgkmcnt(0)
  v_smfmac_f32_16x16x64_bf16 v[32:35], v[0:3], v[60:67], v74
  ds_read_b128 v[16:19], v76 offset:10752
  ds_read_b128 v[60:63], v75 offset:4096
  ds_read_b128 v[64:67], v75 offset:5120
  s_waitcnt lgkmcnt(0)
  v_smfmac_f32_16x16x64_bf16 v[20:23], v[16:19], v[60:67], v74
  ds_read_b128 v[60:63], v75 offset:6144
  ds_read_b128 v[64:67], v75 offset:7168
  s_waitcnt lgkmcnt(0)
  v_smfmac_f32_16x16x64_bf16 v[24:27], v[16:19], v[60:67], v74
  v_smfmac_f32_16x16x64_bf16 v[28:31], v[16:19], v[240:247], v74
  v_smfmac_f32_16x16x64_bf16 v[32:35], v[16:19], v[248:255], v74
  ds_read_b128 v[4:7], v76 offset:11776
  s_waitcnt lgkmcnt(0)
  v_smfmac_f32_16x16x64_bf16 v[20:23], v[4:7], v[176:183], v74
  v_smfmac_f32_16x16x64_bf16 v[24:27], v[4:7], v[184:191], v74
  v_smfmac_f32_16x16x64_bf16 v[28:31], v[4:7], a[0:7], v74
  v_smfmac_f32_16x16x64_bf16 v[32:35], v[4:7], a[8:15], v74
  ds_read_b128 v[12:15], v76 offset:12800
  s_waitcnt lgkmcnt(0)
  v_smfmac_f32_16x16x64_bf16 v[20:23], v[12:15], v[192:199], v74
  v_smfmac_f32_16x16x64_bf16 v[24:27], v[12:15], v[200:207], v74
  v_smfmac_f32_16x16x64_bf16 v[28:31], v[12:15], a[16:23], v74
  v_smfmac_f32_16x16x64_bf16 v[32:35], v[12:15], a[24:31], v74
  v_add_f32 v20, v20, v22
  v_add_f32 v21, v21, v23
  v_add_f32 v24, v24, v26
  v_cvt_pk_bf16_f32 v22, v20, v24
  ds_write_b32 v79, v22 offset:0
  v_add_f32 v25, v25, v27
  v_cvt_pk_bf16_f32 v23, v21, v25
  ds_write_b32 v79, v23 offset:576
  v_add_f32 v28, v28, v30
  v_add_f32 v29, v29, v31
  s_waitcnt lgkmcnt(0)
  s_nop 1
  s_branch Cs1_recok
Cs1_mx:
  s_waitcnt lgkmcnt(0)
  s_barrier
  buffer_load_dwordx4 v[0:3], v76, s[8:11], s58 offen offset:0 sc1
  ds_read_b128 v[20:23], v77 offset:0
  ds_read_b128 v[28:31], v77 offset:256
  buffer_load_dwordx4 v[4:7], v76, s[8:11], s58 offen offset:1024 sc1
  ds_read_b128 v[24:27], v77 offset:128
  ds_read_b128 v[32:35], v77 offset:384
  s_waitcnt vmcnt(1) lgkmcnt(3)
  v_mfma_f32_16x16x32_bf16 v[8:11], v[0:3], v[20:23], 0
  s_waitcnt vmcnt(0) lgkmcnt(1)
  v_mfma_f32_16x16x32_bf16 v[8:11], v[4:7], v[24:27], v[8:11]
  v_mfma_f32_16x16x32_bf16 v[12:15], v[28:31], v[20:23], 0
  s_waitcnt lgkmcnt(0)
  v_mfma_f32_16x16x32_bf16 v[12:15], v[32:35], v[24:27], v[12:15]
  v_add_f32_dpp v8, v10, v8 quad_perm:[2,3,0,1] row_mask:0xf bank_mask:0xf
  v_add_f32_dpp v9, v11, v9 quad_perm:[2,3,0,1] row_mask:0xf bank_mask:0xf
  s_nop 0
  v_mov_b32_dpp v8, v8 quad_perm:[0,1,0,1] row_mask:0xf bank_mask:0xf
  v_mov_b32_dpp v9, v9 quad_perm:[0,1,0,1] row_mask:0xf bank_mask:0xf
  s_nop 1
  v_add_f32_dpp v12, v14, v12 quad_perm:[2,3,0,1] row_mask:0xf bank_mask:0xf
  v_add_f32_dpp v13, v15, v13 quad_perm:[2,3,0,1] row_mask:0xf bank_mask:0xf
  s_nop 0
  v_mov_b32_dpp v12, v12 quad_perm:[0,1,0,1] row_mask:0xf bank_mask:0xf
  v_mov_b32_dpp v13, v13 quad_perm:[0,1,0,1] row_mask:0xf bank_mask:0xf
  v_mul_f32 v12, s69, v12
  ds_write_b32 v78, v8 offset:8708
  v_mul_f32 v13, s69, v13
  ds_write_b32 v78, v9 offset:8772
  s_waitcnt lgkmcnt(0)
  s_barrier
  ds_read_b128 v[36:39], v78 offset:8704
  ds_read_b128 v[40:43], v78 offset:8768
  s_waitcnt lgkmcnt(0)
  s_barrier
  v_max_f32 v16, v36, v37
  v_max3_f32 v16, v16, v38, v39
  v_max3_f32 v16, v16, v40, v41
  v_max3_f32 v16, v16, v42, v43
  v_max3_f32 v16, v16, v12, v13
  v_mov_b32 v17, v16
  s_nop 1
  v_permlane16_swap_b32 v16, v17
  v_max_f32 v16, v16, v17
  v_mov_b32 v17, v16
  s_nop 1
  v_permlane32_swap_b32 v16, v17
  v_max_f32 v16, v16, v17
  v_sub_f32 v36, v36, v16
  v_sub_f32 v37, v37, v16
  v_sub_f32 v38, v38, v16
  v_sub_f32 v39, v39, v16
  v_sub_f32 v40, v40, v16
  v_sub_f32 v41, v41, v16
  v_sub_f32 v42, v42, v16
  v_sub_f32 v43, v43, v16
  v_sub_f32 v12, v12, v16
  v_sub_f32 v13, v13, v16
  v_exp_f32 v36, v36
  v_exp_f32 v37, v37
  v_exp_f32 v38, v38
  v_exp_f32 v39, v39
  v_exp_f32 v40, v40
  v_exp_f32 v41, v41
  v_exp_f32 v42, v42
  v_exp_f32 v43, v43
  v_exp_f32 v12, v12
  v_exp_f32 v13, v13
  v_cvt_pk_bf16_f32 v32, v36, v40
  v_cvt_pk_bf16_f32 v33, v37, v41
  v_cvt_pk_bf16_f32 v34, v38, v42
  v_cvt_pk_bf16_f32 v35, v39, v43
  v_cvt_pk_bf16_f32 v28, v12, v13
  v_cvt_pk_bf16_f32 v31, v12, v13
  v_mov_b32 v29, 0
  v_mov_b32 v30, 0
  v_mov_b32 v68, 0x3f803f80
  v_mov_b32 v69, 0x3f803f80
  v_mov_b32 v70, 0x3f803f80
  v_mov_b32 v71, 0x3f803f80
  s_nop 1
  v_mfma_f32_16x16x32_bf16 v[8:11], v[32:35], v[68:71], 0
  v_mfma_f32_16x16x32_bf16 v[0:3], v[32:35], v[52:55], 0
  v_mfma_f32_16x16x32_bf16 v[4:7], v[32:35], v[56:59], 0
  v_mfma_f32_16x16x16_bf16 v[8:11], v[28:29], v[68:69], v[8:11]
  v_mfma_f32_16x16x16_bf16 v[0:3], v[28:29], v[72:73], v[0:3]
  v_mfma_f32_16x16x16_bf16 v[4:7], v[30:31], v[72:73], v[4:7]
  ds_read_b128 v[68:71], v76 offset:13824
  v_rcp_f32 v10, v8
  v_rcp_f32 v11, v9
  v_mul_f32 v0, v10, v0
  v_mul_f32 v1, v11, v1
  s_nop 0
  v_mul_f32 v4, v10, v4
  v_mul_f32 v5, v11, v5
  v_cvt_pk_bf16_f32 v2, v0, v4
  ds_write_b32 v79, v2 offset:8704
  v_cvt_pk_bf16_f32 v3, v1, v5
  ds_write_b32 v79, v3 offset:9280
  v_mov_b64 v[16:17], 0
  v_mov_b64 v[18:19], 0
  v_mov_b64 v[20:21], 0
  v_mov_b64 v[22:23], 0
  v_mov_b64 v[24:25], 0
  v_mov_b64 v[26:27], 0
  s_branch Cs1_mxok
Cs1_last:
  ds_read_b128 v[4:7], v76 offset:5632
  ds_read_b128 v[12:15], v76 offset:7680
  ds_read_b128 v[44:47], v76 offset:36864
  ds_read_b128 v[48:51], v76 offset:37888
  s_nop 5
  v_mov_b64 v[20:21], 0
  v_mov_b64 v[22:23], 0
  v_mov_b64 v[24:25], 0
  v_mov_b64 v[26:27], 0
  s_waitcnt lgkmcnt(4)
  v_smfmac_f32_16x16x64_bf16 v[28:31], v[0:3], v[36:43], v74
  ds_read_b128 v[36:39], v76 offset:38912
  ds_read_b128 v[40:43], v76 offset:39936
  v_smfmac_f32_16x16x64_bf16 v[32:35], v[0:3], v[60:67], v74
  s_waitcnt lgkmcnt(5)
  v_smfmac_f32_16x16x64_bf16 v[20:23], v[0:3], a[32:39], v74
  ds_read_b128 v[60:63], v76 offset:53248
  ds_read_b128 v[64:67], v76 offset:54272
  v_smfmac_f32_16x16x64_bf16 v[24:27], v[0:3], a[40:47], v74
  s_waitcnt lgkmcnt(4)
  v_smfmac_f32_16x16x64_bf16 v[20:23], v[4:7], a[48:55], v74
  buffer_store_dwordx4 v[16:19], v76, s[8:11], s68 offen sc1
  v_smfmac_f32_16x16x64_bf16 v[24:27], v[4:7], a[56:63], v74
  v_smfmac_f32_16x16x64_bf16 v[28:31], v[4:7], v[44:51], v74
  s_waitcnt lgkmcnt(2)
  v_smfmac_f32_16x16x64_bf16 v[20:23], v[8:11], a[64:71], v74
  ds_read_b128 v[44:47], v76 offset:55296
  ds_read_b128 v[48:51], v76 offset:56320
  v_smfmac_f32_16x16x64_bf16 v[24:27], v[8:11], a[72:79], v74
  v_smfmac_f32_16x16x64_bf16 v[32:35], v[4:7], v[36:43], v74
  v_smfmac_f32_16x16x64_bf16 v[28:31], v[8:11], v[208:215], v74
  ds_read_b128 v[36:39], v75 offset:20480
  ds_read_b128 v[40:43], v75 offset:21504
  v_smfmac_f32_16x16x64_bf16 v[32:35], v[8:11], v[216:223], v74
  v_smfmac_f32_16x16x64_bf16 v[20:23], v[12:15], a[80:87], v74
  v_smfmac_f32_16x16x64_bf16 v[24:27], v[12:15], a[88:95], v74
  v_smfmac_f32_16x16x64_bf16 v[28:31], v[12:15], v[224:231], v74
  v_smfmac_f32_16x16x64_bf16 v[32:35], v[12:15], v[232:239], v74
  s_waitcnt vmcnt(1)
  s_barrier
Cs1_lastr:
  ds_read_b128 v[8:11], v76 offset:8704
  ds_read_b128 v[0:3], v76 offset:9728
  ds_read_b128 v[16:19], v76 offset:10752
  ds_read_b128 v[4:7], v76 offset:11776
  ds_read_b128 v[12:15], v76 offset:12800
  s_waitcnt lgkmcnt(3)
  v_max3_u32 v72, v0, v1, v2
  s_waitcnt lgkmcnt(1)
  v_max3_u32 v72, v72, v3, v4
  v_max3_u32 v72, v72, v5, v6
  v_max3_u32 v72, v72, v7, v8
  v_max3_u32 v72, v72, v9, v10
  s_waitcnt lgkmcnt(0)
  v_max3_u32 v72, v72, v11, v12
  v_max3_u32 v72, v72, v13, v14
  v_max3_u32 v72, v72, v15, v16
  v_max3_u32 v72, v72, v17, v18
  v_max_u32 v72, v72, v19
  v_cmp_eq_u32 vcc, -1, v72
  s_cbranch_vccnz Cs1_lastp
Cs1_lastg:
  v_smfmac_f32_16x16x64_bf16 v[28:31], v[8:11], v[60:67], v74
  ds_read_b128 v[60:63], v75 offset:22528
  ds_read_b128 v[64:67], v75 offset:23552
  v_smfmac_f32_16x16x64_bf16 v[32:35], v[8:11], v[44:51], v74
  v_smfmac_f32_16x16x64_bf16 v[28:31], v[0:3], v[36:43], v74
  v_smfmac_f32_16x16x64_bf16 v[28:31], v[16:19], v[240:247], v74
  v_smfmac_f32_16x16x64_bf16 v[28:31], v[4:7], a[0:7], v74
  v_smfmac_f32_16x16x64_bf16 v[28:31], v[12:15], a[16:23], v74
  v_smfmac_f32_16x16x64_bf16 v[32:35], v[16:19], v[248:255], v74
  v_smfmac_f32_16x16x64_bf16 v[32:35], v[4:7], a[8:15], v74
  s_waitcnt lgkmcnt(0)
  v_smfmac_f32_16x16x64_bf16 v[32:35], v[12:15], a[24:31], v74
  v_smfmac_f32_16x16x64_bf16 v[32:35], v[0:3], v[60:67], v74
  v_smfmac_f32_16x16x64_bf16 v[20:23], v[8:11], a[96:103], v74
  v_smfmac_f32_16x16x64_bf16 v[20:23], v[0:3], a[112:119], v74
  v_add_f32 v28, v28, v30
  v_add_f32 v32, v32, v34
  v_cvt_pk_bf16_f32 v30, v28, v32
  v_smfmac_f32_16x16x64_bf16 v[20:23], v[16:19], a[128:135], v74
  ds_write_b32 v79, v30 offset:256
  v_add_f32 v29, v29, v31
  v_add_f32 v33, v33, v35
  v_cvt_pk_bf16_f32 v31, v29, v33
  v_smfmac_f32_16x16x64_bf16 v[20:23], v[4:7], a[144:151], v74
  ds_write_b32 v79, v31 offset:832
  v_smfmac_f32_16x16x64_bf16 v[20:23], v[12:15], a[160:167], v74
  v_smfmac_f32_16x16x64_bf16 v[24:27], v[8:11], a[104:111], v74
  v_smfmac_f32_16x16x64_bf16 v[24:27], v[0:3], a[120:127], v74
  v_smfmac_f32_16x16x64_bf16 v[24:27], v[16:19], a[136:143], v74
  s_waitcnt lgkmcnt(0)
  s_barrier
  ds_read_b64 v[52:53], v77 offset:264
  v_add_f32 v20, v20, v22
  v_smfmac_f32_16x16x64_bf16 v[24:27], v[4:7], a[152:159], v74
  v_add_f32 v21, v21, v23
  v_smfmac_f32_16x16x64_bf16 v[24:27], v[12:15], a[168:175], v74
  v_cvt_pk_bf16_f32 v54, v20, v21
  s_add_u32 s68, s68, 655360
  s_nop 3
  v_add_f32 v24, v24, v26
  v_add_f32 v25, v25, v27
  v_cvt_pk_bf16_f32 v55, v24, v25
  s_waitcnt lgkmcnt(0)
  buffer_store_dwordx4 v[52:55], v76, s[8:11], s68 offen sc1
  s_branch Cs1_done
Cs1_lastp:
  s_add_u32 s72, s72, 2
  s_cmp_ge_u32 s72, 131072
  s_cbranch_scc1 Cs1_lastg
  s_barrier
  buffer_load_dwordx4 v76, s[8:11], s85 offen offset:0 sc1 lds
  s_waitcnt vmcnt(0)
  s_barrier
  s_branch Cs1_lastr
Cs1_done:
  s_branch L_cexit
L_w6:
  v_mov_b64 v[20:21], 0
  v_mov_b64 v[22:23], 0
  v_mov_b64 v[24:25], 0
  v_mov_b64 v[26:27], 0
  v_mov_b64 v[28:29], 0
  v_mov_b64 v[30:31], 0
  v_mov_b64 v[32:33], 0
  v_mov_b64 v[34:35], 0
  s_mov_b32 s78, 0x3f803f80
  s_mov_b32 s79, s78
  s_mov_b32 s65, 360448
  s_mov_b32 m0, 15872
  s_lshl_b32 s71, s53, 2
  s_add_u32 s71, s71, 128
  s_movk_i32 s56, 0x1000
  v_lshlrev_b32 v73, 2, v76
  v_mov_b32 v72, 0
  s_mov_b64 s[16:17], s[8:9]
  s_mov_b32 s18, 268435456
  s_mov_b32 s19, 0x20000
  s_getpc_b64 s[20:21]
Cs2_pc:
  s_add_u32 s20, s20, (Cs2_last - Cs2_pc)
  s_addc_u32 s21, s21, 0
  v_mov_b32 v68, 14880
  buffer_load_dwordx4 v[52:55], v76, s[8:11], s59 offen offset:0 sc1
  buffer_load_dwordx4 v[56:59], v76, s[8:11], s59 offen offset:1024 sc1
  ds_read_b128 v[36:39], v76 offset:24576
  ds_read_b128 v[40:43], v76 offset:25600
  ds_read_b128 v[60:63], v76 offset:26624
  ds_read_b128 v[64:67], v76 offset:27648
  ds_read_b128 v[0:3], v76 offset:4608
  ds_read_b128 v[4:7], v76 offset:5632
  ds_read_b128 v[8:11], v76 offset:6656
  ds_read_b128 v[12:15], v76 offset:7680
  s_waitcnt lgkmcnt(0)
  s_cmp_eq_u32 s66, 1
  s_branch Cs2_top2
.p2align 6
Cs2_h2:
  s_cmp_eq_u32 s66, 62
  s_cselect_b64 s[16:17], s[20:21], s[16:17]
  s_cselect_b32 s18, (Cs2_done - Cs2_last), s18
  s_cselect_b32 s70, 0, s70
  s_cmp_eq_u32 s66, 63
  s_cselect_b32 s59, 268435456, s59
  s_cselect_b32 s58, 268435456, s58
  ds_read_b128 v[36:39], v76 offset:24576
  v_mov_b64 v[28:29], 0
  v_mov_b64 v[30:31], 0
  v_mov_b64 v[32:33], 0
  v_mov_b64 v[34:35], 0
  v_lshlrev_b32 v73, 2, v76
  ds_read_b128 v[40:43], v76 offset:25600
  v_mov_b64 v[20:21], 0
  v_mov_b64 v[22:23], 0
  v_mov_b64 v[24:25], 0
  v_mov_b64 v[26:27], 0
  v_mov_b32 v68, 14880
  buffer_load_dwordx4 v[52:55], v76, s[8:11], s59 offen offset:0 sc1
  buffer_load_dwordx4 v[56:59], v76, s[8:11], s59 offen offset:1024 sc1
  s_waitcnt vmcnt(0)
  s_mov_b64 vcc, -1
Cs2_h2r:
  s_mov_b64 exec, vcc
  buffer_load_dwordx4 v[12:15], v76, s[8:11], s65 offen offset:3072 sc1
  buffer_load_dwordx4 v[0:3], v76, s[8:11], s85 offen offset:0 sc1
  s_mov_b64 exec, -1
  s_add_u32 s67, s67, 1
  s_cmp_lt_u32 s67, 131072
  s_cselect_b32 s54, -2, -1
  s_waitcnt vmcnt(1)
  v_max3_u32 v72, v12, v13, v14
  s_waitcnt vmcnt(0)
  v_max3_u32 v72, v72, v15, v0
  v_max3_u32 v72, v72, v1, v2
  v_max_u32 v72, v72, v3
  v_cmp_lt_u32 vcc, s54, v72
  s_cbranch_vccnz Cs2_h2r
  ds_write_b128 v76, v[12:15] offset:7680
  ds_write_b128 v76, v[0:3] offset:12800
Cs2_h2w:
  s_cmp_eq_u32 s66, 63
  s_waitcnt lgkmcnt(0)
  s_barrier
  ds_read_b128 v[0:3], v76 offset:4608
Cs2_top2:
  v_smfmac_f32_16x16x64_bf16 v[20:23], v[12:15], v[128:135], v74
  s_cbranch_scc1 Cs2_last
  v_smfmac_f32_16x16x64_bf16 v[24:27], v[12:15], v[136:143], v74
  buffer_load_dwordx4 v[44:47], v76, s[8:11], s58 offen offset:0 sc1
  s_mov_b32 m0, 15872
  v_smfmac_f32_16x16x64_bf16 v[28:31], v[12:15], v[224:231], v74
  buffer_load_dwordx4 v[48:51], v76, s[8:11], s58 offen offset:1024 sc1
  v_smfmac_f32_16x16x64_bf16 v[32:35], v[12:15], v[232:239], v74
  ds_read_b128 v[4:7], v76 offset:5632
  s_waitcnt lgkmcnt(1)
  v_smfmac_f32_16x16x64_bf16 v[20:23], v[0:3], v[80:87], v74
  ds_read_b128 v[8:11], v76 offset:6656
  v_smfmac_f32_16x16x64_bf16 v[28:31], v[0:3], v[36:43], v74
  ds_read_b128 v[36:39], v76 offset:40960
  v_smfmac_f32_16x16x64_bf16 v[24:27], v[0:3], v[88:95], v74
  buffer_store_dwordx4 v[16:19], v76, s[8:11], s68 offen sc1
  ds_read_b128 v[40:43], v76 offset:41984
  v_smfmac_f32_16x16x64_bf16 v[32:35], v[0:3], v[60:67], v74
  buffer_load_dword v73, s[16:19], s70 offen lds
  ds_read_b128 v[60:63], v76 offset:43008
  s_waitcnt lgkmcnt(4)
  v_smfmac_f32_16x16x64_bf16 v[20:23], v[4:7], v[96:103], v74
  ds_read_b128 v[64:67], v76 offset:44032
  v_smfmac_f32_16x16x64_bf16 v[24:27], v[4:7], v[104:111], v74
  s_waitcnt vmcnt(4)
  s_waitcnt lgkmcnt(4)
  v_smfmac_f32_16x16x64_bf16 v[20:23], v[8:11], v[112:119], v74
  s_barrier
  ds_read_b128 v[12:15], v76 offset:8704
  s_waitcnt lgkmcnt(3)
  v_smfmac_f32_16x16x64_bf16 v[28:31], v[4:7], v[36:43], v74
  ds_read_b128 v[36:39], v76 offset:57344
  v_smfmac_f32_16x16x64_bf16 v[24:27], v[8:11], v[120:127], v74
  ds_read_b128 v[40:43], v76 offset:58368
  s_waitcnt lgkmcnt(3)
  v_smfmac_f32_16x16x64_bf16 v[32:35], v[4:7], v[60:67], v74
  ds_read_b128 v[0:3], v76 offset:9728
  v_smfmac_f32_16x16x64_bf16 v[28:31], v[8:11], v[208:215], v74
  ds_read_b128 v[60:63], v76 offset:59392
  v_smfmac_f32_16x16x64_bf16 v[32:35], v[8:11], v[216:223], v74
  ds_read_b128 v[64:67], v76 offset:60416
  s_waitcnt lgkmcnt(5)
  v_smfmac_f32_16x16x64_bf16 v[20:23], v[12:15], v[144:151], v74
  s_barrier
  ds_read_b128 v[4:7], v76 offset:11776
  s_waitcnt lgkmcnt(4)
  v_smfmac_f32_16x16x64_bf16 v[28:31], v[12:15], v[36:43], v74
  ds_read_b128 v[8:11], v76 offset:12800
  ds_read_b128 v[36:39], v75 offset:8192
  v_smfmac_f32_16x16x64_bf16 v[24:27], v[12:15], v[152:159], v74
  ds_read_b128 v[16:19], v76 offset:10752
  s_waitcnt lgkmcnt(6)
  v_smfmac_f32_16x16x64_bf16 v[20:23], v[0:3], v[160:167], v74
  ds_read_b128 v[40:43], v75 offset:9216
  s_waitcnt lgkmcnt(5)
  v_smfmac_f32_16x16x64_bf16 v[32:35], v[12:15], v[60:67], v74
  ds_read_b128 v[60:63], v75 offset:10240
  v_smfmac_f32_16x16x64_bf16 v[24:27], v[0:3], v[168:175], v74
  ds_read_b128 v[64:67], v75 offset:11264
  s_waitcnt lgkmcnt(6)
  v_smfmac_f32_16x16x64_bf16 v[20:23], v[4:7], v[176:183], v74
  s_waitcnt lgkmcnt(5)
  v_smfmac_f32_16x16x64_bf16 v[20:23], v[8:11], v[192:199], v74
  s_waitcnt lgkmcnt(2)
  v_smfmac_f32_16x16x64_bf16 v[20:23], v[16:19], v[36:43], v74
  ds_read_b128 v[36:39], v75 offset:24576
  v_smfmac_f32_16x16x64_bf16 v[24:27], v[4:7], v[184:191], v74
  ds_read_b128 v[40:43], v75 offset:25600
  s_waitcnt lgkmcnt(2)
  v_smfmac_f32_16x16x64_bf16 v[24:27], v[16:19], v[60:67], v74
  ds_read_b128 v[60:63], v75 offset:26624
  v_add_f32 v20, v20, v22
  v_smfmac_f32_16x16x64_bf16 v[24:27], v[8:11], v[200:207], v74
  ds_read_b128 v[64:67], v75 offset:27648
  v_add_f32 v21, v21, v23
  v_smfmac_f32_16x16x64_bf16 v[28:31], v[16:19], v[240:247], v74
  v_mov_b64 v[70:71], s[78:79]
  v_smfmac_f32_16x16x64_bf16 v[28:31], v[4:7], a[0:7], v74
  s_waitcnt lgkmcnt(2)
  v_add_f32 v24, v24, v26
  v_smfmac_f32_16x16x64_bf16 v[28:31], v[0:3], v[36:43], v74
  ds_read_b128 v[36:39], v68
  v_cvt_pk_bf16_f32 v22, v20, v24
  v_smfmac_f32_16x16x64_bf16 v[28:31], v[8:11], a[16:23], v74
  ds_read_b128 v[40:43], v68
  ds_write_b32 v79, v22 offset:0
  s_waitcnt lgkmcnt(3)
  v_add_f32 v25, v25, v27
  v_cvt_pk_bf16_f32 v23, v21, v25
  v_smfmac_f32_16x16x64_bf16 v[32:35], v[0:3], v[60:67], v74
  ds_write_b32 v79, v23 offset:576
  v_cmp_u_f32 vcc, v20, v21
  v_smfmac_f32_16x16x64_bf16 v[32:35], v[16:19], v[248:255], v74
  v_add_f32 v28, v28, v30
  v_smfmac_f32_16x16x64_bf16 v[32:35], v[4:7], a[8:15], v74
  v_add_f32 v29, v29, v31
  v_smfmac_f32_16x16x64_bf16 v[32:35], v[8:11], a[24:31], v74
  s_cbranch_vccnz Cs2_rec
Cs2_recok:
  s_waitcnt lgkmcnt(3)
  v_smfmac_f32_16x16x64_bf16 v[36:39], v[16:19], a[128:135], v74
  s_waitcnt lgkmcnt(0)
  s_barrier
  ds_read_b128 v[60:63], v77
  v_smfmac_f32_16x16x64_bf16 v[40:43], v[16:19], a[136:143], v74
  ds_read_b128 v[64:67], v77 offset:128
  v_add_f32 v32, v32, v34
  v_cvt_pk_bf16_f32 v30, v28, v32
  v_smfmac_f32_16x16x64_bf16 v[36:39], v[0:3], a[112:119], v74
  ds_write_b32 v79, v30 offset:256
  v_add_f32 v33, v33, v35
  v_cvt_pk_bf16_f32 v31, v29, v33
  v_smfmac_f32_16x16x64_bf16 v[40:43], v[0:3], a[120:127], v74
  ds_write_b32 v79, v31 offset:832
  v_xor_b32 v75, 0x8000, v75
  v_smfmac_f32_16x16x64_bf16 v[36:39], v[4:7], a[144:151], v74
  ds_read_b128 v[0:3], v76 offset:4608
  v_mov_b32 v29, 0
  v_smfmac_f32_16x16x64_bf16 v[40:43], v[4:7], a[152:159], v74
  s_waitcnt vmcnt(2) lgkmcnt(3)
  v_mov_b32 v30, 0
  v_mfma_f32_16x16x32_bf16 v[44:47], v[44:47], v[60:63], 0
  ds_read_b128 v[4:7], v76 offset:5632
  s_waitcnt lgkmcnt(2)
  v_mfma_f32_16x16x32_bf16 v[44:47], v[48:51], v[64:67], v[44:47]
  s_barrier
  v_smfmac_f32_16x16x64_bf16 v[36:39], v[8:11], a[160:167], v74
  ds_read_b128 v[20:23], v77 offset:256
  ds_read_b128 v[24:27], v77 offset:384
  v_smfmac_f32_16x16x64_bf16 v[40:43], v[8:11], a[168:175], v74
  ds_read_b128 v[8:11], v76 offset:6656
  v_add_f32_dpp v72, v46, v44 quad_perm:[2,3,0,1] row_mask:0xf bank_mask:0xf
  v_add_f32_dpp v73, v47, v45 quad_perm:[2,3,0,1] row_mask:0xf bank_mask:0xf
  v_smfmac_f32_16x16x64_bf16 v[36:39], v[12:15], a[96:103], v74
  s_waitcnt lgkmcnt(4)
  v_exp_f32_dpp v72, v72 quad_perm:[0,1,0,1] row_mask:0xf bank_mask:0xf
  v_smfmac_f32_16x16x64_bf16 v[40:43], v[12:15], a[104:111], v74
  ds_read_b128 v[12:15], v76 offset:7680
  v_exp_f32_dpp v73, v73 quad_perm:[0,1,0,1] row_mask:0xf bank_mask:0xf
  v_smfmac_f32_16x16x64_bf16 v[36:39], v[0:3], a[32:39], v74
  s_waitcnt lgkmcnt(2)
  v_cvt_pk_bf16_f32 v72, v72, v73
  v_mfma_f32_16x16x32_bf16 v[20:23], v[20:23], v[60:63], 0
  ds_write_b32 v78, v72 offset:520
  v_mov_b64 v[16:17], 0
  v_mfma_f32_16x16x32_bf16 v[20:23], v[24:27], v[64:67], v[20:23]
  ds_read_b128 v[44:47], v75 offset:24576
  v_mov_b64 v[18:19], 0
  v_smfmac_f32_16x16x64_bf16 v[40:43], v[0:3], a[40:47], v74
  ds_read_b128 v[48:51], v75 offset:25600
  v_mov_b64 v[68:69], s[78:79]
  v_smfmac_f32_16x16x64_bf16 v[36:39], v[4:7], a[48:55], v74
  s_waitcnt lgkmcnt(4)
  v_add_f32_dpp v24, v22, v20 quad_perm:[2,3,0,1] row_mask:0xf bank_mask:0xf
  v_add_f32_dpp v25, v23, v21 quad_perm:[2,3,0,1] row_mask:0xf bank_mask:0xf
  v_smfmac_f32_16x16x64_bf16 v[36:39], v[8:11], a[64:71], v74
  s_waitcnt lgkmcnt(2)
  s_barrier
  ds_read_b128 v[32:35], v78 offset:512
  v_smfmac_f32_16x16x64_bf16 v[36:39], v[12:15], a[80:87], v74
  ds_read_b128 v[60:63], v75 offset:26624
  v_mul_f32 v24, s69, v24
  v_smfmac_f32_16x16x64_bf16 v[40:43], v[4:7], a[56:63], v74
  ds_read_b128 v[64:67], v75 offset:27648
  v_mul_f32 v25, s69, v25
  v_smfmac_f32_16x16x64_bf16 v[40:43], v[8:11], a[72:79], v74
  v_exp_f32_dpp v24, v24 quad_perm:[0,1,0,1] row_mask:0xf bank_mask:0xf
  v_smfmac_f32_16x16x64_bf16 v[40:43], v[12:15], a[88:95], v74
  s_waitcnt lgkmcnt(2)
  v_exp_f32_dpp v25, v25 quad_perm:[0,1,0,1] row_mask:0xf bank_mask:0xf
  v_mfma_f32_16x16x32_bf16 v[8:11], v[32:35], v[68:71], 0
  v_add_f32 v36, v36, v38
  v_add_f32 v37, v37, v39
  v_mfma_f32_16x16x32_bf16 v[0:3], v[32:35], v[52:55], 0
  v_add_f32 v40, v40, v42
  v_add_f32 v41, v41, v43
  v_mfma_f32_16x16x32_bf16 v[4:7], v[32:35], v[56:59], 0
  v_cvt_pk_bf16_f32 v28, v24, v25
  v_cvt_pk_bf16_f32 v72, v36, v37
  v_cvt_pk_bf16_f32 v73, v40, v41
  v_mfma_f32_16x16x16_bf16 v[8:11], v[28:29], v[68:69], v[8:11]
  v_cvt_pk_bf16_f32 v31, v24, v25
  v_mov_b64 v[20:21], 0
  v_mfma_f32_16x16x16_bf16 v[0:3], v[28:29], v[72:73], v[0:3]
  ds_read_b128 v[68:71], v76 offset:13824
  v_mov_b64 v[22:23], 0
  v_mfma_f32_16x16x16_bf16 v[4:7], v[30:31], v[72:73], v[4:7]
  v_rcp_f32 v10, v8
  v_rcp_f32 v11, v9
  v_mul_f32 v0, v10, v0
  v_mul_f32 v1, v11, v1
  s_nop 0
  v_mul_f32 v4, v10, v4
  v_mul_f32 v5, v11, v5
  v_cvt_pk_bf16_f32 v2, v0, v4
  ds_write_b32 v79, v2 offset:8704
  v_cvt_pk_bf16_f32 v3, v1, v5
  ds_write_b32 v79, v3 offset:9280
  v_max3_f32 v8, v8, v9, v10
  v_max_f32 v8, v8, v11
  v_cmp_le_f32 vcc, 1317011456, v8
  v_mov_b64 v[24:25], 0
  v_mov_b64 v[26:27], 0
  s_cbranch_vccnz Cs2_mx
Cs2_mxok:
  s_waitcnt lgkmcnt(0)
  s_barrier
  ds_read_b128 v[0:3], v78 offset:8704
  ds_read_b128 v[4:7], v78 offset:8768
  ds_read_b128 v[8:11], v78 offset:8832
  ds_read_b128 v[12:15], v78 offset:8896
  s_waitcnt lgkmcnt(3)
  v_smfmac_f32_16x16x64_bf16 v[16:19], v[0:3], v[44:51], v74
  ds_read_b128 v[52:55], v75 offset:40960
  s_waitcnt lgkmcnt(3)
  v_smfmac_f32_16x16x64_bf16 v[16:19], v[4:7], v[60:67], v74
  ds_read_b128 v[56:59], v75 offset:41984
  s_waitcnt lgkmcnt(3)
  v_smfmac_f32_16x16x64_bf16 v[16:19], v[8:11], a[176:183], v74
  ds_read_b128 v[36:39], v75 offset:43008
  s_waitcnt lgkmcnt(3)
  v_smfmac_f32_16x16x64_bf16 v[16:19], v[12:15], a[184:191], v74
  ds_read_b128 v[40:43], v75 offset:44032
  ds_read_b128 v[44:47], v75 offset:57344
  v_smfmac_f32_16x16x64_bf16 v[20:23], v[0:3], a[192:199], v74
  ds_read_b128 v[48:51], v75 offset:58368
  ds_read_b128 v[60:63], v75 offset:59392
  v_smfmac_f32_16x16x64_bf16 v[20:23], v[4:7], a[200:207], v74
  ds_read_b128 v[64:67], v75 offset:60416
  s_waitcnt lgkmcnt(6)
  v_cvt_pk_bf16_f32 v16, v16, v17
  v_cvt_pk_bf16_f32 v17, v18, v19
  v_bfi_b32 v16, 1, s72, v16
  v_smfmac_f32_16x16x64_bf16 v[20:23], v[8:11], v[52:59], v74
  buffer_store_dwordx2 v[16:17], v68, s[8:11], s73 offen sc1
  s_waitcnt lgkmcnt(4)
  v_smfmac_f32_16x16x64_bf16 v[20:23], v[12:15], v[36:43], v74
  ds_read_b128 v[52:55], v75 offset:0
  v_mov_b64 v[32:33], 0
  v_smfmac_f32_16x16x64_bf16 v[24:27], v[0:3], a[208:215], v74
  ds_read_b128 v[56:59], v75 offset:1024
  v_mov_b64 v[34:35], 0
  v_smfmac_f32_16x16x64_bf16 v[24:27], v[4:7], a[216:223], v74
  ds_read_b128 v[36:39], v75 offset:2048
  s_waitcnt lgkmcnt(5)
  v_cvt_pk_bf16_f32 v20, v20, v21
  v_cvt_pk_bf16_f32 v21, v22, v23
  v_bfi_b32 v20, 1, s72, v20
  v_smfmac_f32_16x16x64_bf16 v[24:27], v[8:11], v[44:51], v74
  buffer_store_dwordx2 v[20:21], v68, s[8:11], s74 offen sc1
  s_waitcnt lgkmcnt(3)
  v_smfmac_f32_16x16x64_bf16 v[24:27], v[12:15], v[60:67], v74
  ds_read_b128 v[40:43], v75 offset:3072
  v_mov_b64 v[28:29], 0
  v_smfmac_f32_16x16x64_bf16 v[32:35], v[0:3], a[224:231], v74
  ds_read_b128 v[44:47], v75 offset:4096
  ds_read_b128 v[48:51], v75 offset:5120
  v_smfmac_f32_16x16x64_bf16 v[32:35], v[4:7], a[232:239], v74
  ds_read_b128 v[60:63], v75 offset:6144
  v_cvt_pk_bf16_f32 v24, v24, v25
  v_cvt_pk_bf16_f32 v25, v26, v27
  v_bfi_b32 v24, 1, s72, v24
  v_smfmac_f32_16x16x64_bf16 v[32:35], v[8:11], a[240:247], v74
  buffer_store_dwordx2 v[24:25], v68, s[8:11], s75 offen sc1
  v_mov_b64 v[30:31], 0
  v_smfmac_f32_16x16x64_bf16 v[32:35], v[12:15], a[248:255], v74
  ds_read_b128 v[64:67], v75 offset:7168
  s_waitcnt lgkmcnt(6)
  v_smfmac_f32_16x16x64_bf16 v[28:31], v[0:3], v[52:59], v74
  s_waitcnt lgkmcnt(4)
  v_smfmac_f32_16x16x64_bf16 v[28:31], v[4:7], v[36:43], v74
  s_waitcnt lgkmcnt(2)
  v_cvt_pk_bf16_f32 v32, v32, v33
  v_cvt_pk_bf16_f32 v33, v34, v35
  v_bfi_b32 v32, 1, s72, v32
  v_smfmac_f32_16x16x64_bf16 v[28:31], v[8:11], v[44:51], v74
  buffer_store_dwordx2 v[32:33], v68, s[8:11], s76 offen sc1
  s_waitcnt lgkmcnt(0)
  v_smfmac_f32_16x16x64_bf16 v[28:31], v[12:15], v[60:67], v74
  v_mov_b64 v[18:19], v[72:73]
  s_nop 4
  v_cvt_pk_bf16_f32 v28, v28, v29
  v_cvt_pk_bf16_f32 v29, v30, v31
  v_bfi_b32 v28, 1, s72, v28
  buffer_store_dwordx2 v[28:29], v68, s[8:11], s77 offen sc1
  ds_read_b128 v[0:3], v76 offset:14848
  s_waitcnt lgkmcnt(0)
  ds_read_b64 v[16:17], v77 offset:384
  s_waitcnt lgkmcnt(0)
  ds_read_b128 v[64:67], v76 offset:27648
  s_waitcnt lgkmcnt(0)
  ds_read_b128 v[60:63], v76 offset:26624
  s_waitcnt lgkmcnt(0)
  s_waitcnt vmcnt(0)
  buffer_load_dwordx4 v[52:55], v76, s[8:11], s60 offen offset:0 sc1
  buffer_load_dwordx4 v[56:59], v76, s[8:11], s60 offen offset:1024 sc1
  s_add_u32 s66, s66, 1
  s_xor_b32 s64, s64, 16384
  s_xor_b32 s65, s65, 16384
  s_add_u32 s58, s58, 655360
  s_add_u32 s59, s59, 655360
  s_add_u32 s70, s70, 655360
  s_add_u32 s68, s68, 655360
  s_mov_b32 m0, 12800
  s_add_u32 s85, s65, 8192
  v_xor_b32 v75, 0x8000, v75
  s_waitcnt lgkmcnt(0)
  s_waitcnt vmcnt(1)
  v_mfma_f32_16x16x32_bf16 v[4:7], v[0:3], v[52:55], 0
  v_bitop3_b32 v72, v52, v54, s72 bitop3:0x7e
  s_waitcnt vmcnt(0)
  v_mfma_f32_16x16x32_bf16 v[4:7], v[0:3], v[56:59], v[4:7]
  v_bitop3_b32 v73, v56, v58, s72 bitop3:0x7e
  v_bitop3_b32 v72, v72, v73, 1 bitop3:0xa8
  v_cmp_ne_u32 vcc, 0, v72
  s_cbranch_vccnz Cs2_h1r
  s_nop 2
  v_add_f32_dpp v4, v4, v4 row_ror:4 row_mask:0xf bank_mask:0xf
  v_add_f32_dpp v5, v5, v5 row_ror:4 row_mask:0xf bank_mask:0xf
  s_nop 0
  v_add_f32_dpp v4, v4, v4 row_ror:8 row_mask:0xf bank_mask:0xf
  v_add_f32_dpp v5, v5, v5 row_ror:8 row_mask:0xf bank_mask:0xf
  v_cvt_pk_bf16_f32 v4, v4, v5
  buffer_store_dword v4, v69, s[8:11], s62 offen sc1
  s_xor_b32 s62, s62, 16384
  buffer_store_dword v71, v69, s[8:11], s62 offen sc1
  s_xor_b32 s72, s72, 1
  s_branch Cs2_h2
Cs2_h1r:
  s_mov_b64 exec, vcc
  buffer_load_dwordx4 v[52:55], v76, s[8:11], s60 offen offset:0 sc1
  buffer_load_dwordx4 v[56:59], v76, s[8:11], s60 offen offset:1024 sc1
  s_mov_b64 exec, -1
  s_add_u32 s67, s67, 1
  s_waitcnt vmcnt(1)
  v_mfma_f32_16x16x32_bf16 v[4:7], v[0:3], v[52:55], 0
  v_bitop3_b32 v72, v52, v54, s72 bitop3:0x7e
  s_waitcnt vmcnt(0)
  v_mfma_f32_16x16x32_bf16 v[4:7], v[0:3], v[56:59], v[4:7]
  v_bitop3_b32 v73, v56, v58, s72 bitop3:0x7e
  v_bitop3_b32 v72, v72, v73, 1 bitop3:0xa8
  v_cmp_ne_u32 vcc, 0, v72
  s_cbranch_vccz Cs2_h1p
Cs2_h1s:
  s_mov_b64 exec, vcc
  buffer_load_dwordx4 v[52:55], v76, s[8:11], s60 offen offset:0 sc1
  buffer_load_dwordx4 v[56:59], v76, s[8:11], s60 offen offset:1024 sc1
  s_mov_b64 exec, -1
  s_add_u32 s67, s67, 1
  s_waitcnt vmcnt(1)
  v_mfma_f32_16x16x32_bf16 v[4:7], v[0:3], v[52:55], 0
  v_bitop3_b32 v72, v52, v54, s72 bitop3:0x7e
  s_waitcnt vmcnt(0)
  v_mfma_f32_16x16x32_bf16 v[4:7], v[0:3], v[56:59], v[4:7]
  v_bitop3_b32 v73, v56, v58, s72 bitop3:0x7e
  v_bitop3_b32 v72, v72, v73, 1 bitop3:0xa8
  v_cmp_ne_u32 vcc, 0, v72
  s_cbranch_vccz Cs2_h1p
  s_cmp_lt_u32 s67, 131072
  s_cbranch_scc1 Cs2_h1s
Cs2_h1p:
  s_nop 2
  v_add_f32_dpp v4, v4, v4 row_ror:4 row_mask:0xf bank_mask:0xf
  v_add_f32_dpp v5, v5, v5 row_ror:4 row_mask:0xf bank_mask:0xf
  s_nop 0
  v_add_f32_dpp v4, v4, v4 row_ror:8 row_mask:0xf bank_mask:0xf
  v_add_f32_dpp v5, v5, v5 row_ror:8 row_mask:0xf bank_mask:0xf
  v_cvt_pk_bf16_f32 v4, v4, v5
  buffer_store_dword v4, v69, s[8:11], s62 offen sc1
  s_xor_b32 s62, s62, 16384
  buffer_store_dword v71, v69, s[8:11], s62 offen sc1
  s_xor_b32 s72, s72, 1
  s_branch Cs2_h2
Cs2_rec:
  s_nop 7
  s_waitcnt vmcnt(0) lgkmcnt(0)
  v_max3_u32 v72, v0, v1, v2
  v_max3_u32 v72, v72, v3, v4
  v_max3_u32 v72, v72, v5, v6
  v_max3_u32 v72, v72, v7, v8
  v_max3_u32 v72, v72, v9, v10
  v_max3_u32 v72, v72, v11, v12
  v_max3_u32 v72, v72, v13, v14
  v_max3_u32 v72, v72, v15, v16
  v_max3_u32 v72, v72, v17, v18
  v_max_u32 v72, v72, v19
  v_cmp_eq_u32 vcc, -1, v72
  s_cbranch_vccz Cs2_recok
  s_barrier
Cs2_recp:
  buffer_load_dwordx4 v[0:3], v76, s[8:11], s64 offen offset:0 sc1
  buffer_load_dwordx4 v[4:7], v76, s[8:11], s64 offen offset:1024 sc1
  s_add_u32 s67, s67, 1
  s_cmp_lt_u32 s67, 131072
  s_cselect_b32 s54, -2, -1
  s_waitcnt vmcnt(1)
  v_max3_u32 v72, v0, v1, v2
  s_waitcnt vmcnt(0)
  v_max3_u32 v72, v72, v3, v4
  v_max3_u32 v72, v72, v5, v6
  v_max_u32 v72, v72, v7
  v_cmp_lt_u32 vcc, s54, v72
  s_cbranch_vccnz Cs2_recp
  ds_write_b128 v76, v[0:3] offset:8704
  ds_write_b128 v76, v[4:7] offset:9728
  v_mov_b64 v[20:21], 0
  v_mov_b64 v[22:23], 0
  v_mov_b64 v[24:25], 0
  v_mov_b64 v[26:27], 0
  v_mov_b64 v[28:29], 0
  v_mov_b64 v[30:31], 0
  v_mov_b64 v[32:33], 0
  v_mov_b64 v[34:35], 0
  s_waitcnt lgkmcnt(0)
  s_barrier
  ds_read_b128 v[0:3], v76 offset:4608
  s_waitcnt lgkmcnt(0)
  v_smfmac_f32_16x16x64_bf16 v[20:23], v[0:3], v[80:87], v74
  v_smfmac_f32_16x16x64_bf16 v[24:27], v[0:3], v[88:95], v74
  ds_read_b128 v[60:63], v76 offset:24576
  ds_read_b128 v[64:67], v76 offset:25600
  s_waitcnt lgkmcnt(0)
  v_smfmac_f32_16x16x64_bf16 v[28:31], v[0:3], v[60:67], v74
  ds_read_b128 v[60:63], v76 offset:26624
  ds_read_b128 v[64:67], v76 offset:27648
  s_waitcnt lgkmcnt(0)
  v_smfmac_f32_16x16x64_bf16 v[32:35], v[0:3], v[60:67], v74
  ds_read_b128 v[4:7], v76 offset:5632
  s_waitcnt lgkmcnt(0)
  v_smfmac_f32_16x16x64_bf16 v[20:23], v[4:7], v[96:103], v74
  v_smfmac_f32_16x16x64_bf16 v[24:27], v[4:7], v[104:111], v74
  ds_read_b128 v[60:63], v76 offset:40960
  ds_read_b128 v[64:67], v76 offset:41984
  s_waitcnt lgkmcnt(0)
  v_smfmac_f32_16x16x64_bf16 v[28:31], v[4:7], v[60:67], v74
  ds_read_b128 v[60:63], v76 offset:43008
  ds_read_b128 v[64:67], v76 offset:44032
  s_waitcnt lgkmcnt(0)
  v_smfmac_f32_16x16x64_bf16 v[32:35], v[4:7], v[60:67], v74
  ds_read_b128 v[8:11], v76 offset:6656
  s_waitcnt lgkmcnt(0)
  v_smfmac_f32_16x16x64_bf16 v[20:23], v[8:11], v[112:119], v74
  v_smfmac_f32_16x16x64_bf16 v[24:27], v[8:11], v[120:127], v74
  v_smfmac_f32_16x16x64_bf16 v[28:31], v[8:11], v[208:215], v74
  v_smfmac_f32_16x16x64_bf16 v[32:35], v[8:11], v[216:223], v74
  ds_read_b128 v[12:15], v76 offset:7680
  s_waitcnt lgkmcnt(0)
  v_smfmac_f32_16x16x64_bf16 v[20:23], v[12:15], v[128:135], v74
  v_smfmac_f32_16x16x64_bf16 v[24:27], v[12:15], v[136:143], v74
  v_smfmac_f32_16x16x64_bf16 v[28:31], v[12:15], v[224:231], v74
  v_smfmac_f32_16x16x64_bf16 v[32:35], v[12:15], v[232:239], v74
  ds_read_b128 v[12:15], v76 offset:8704
  s_waitcnt lgkmcnt(0)
  v_smfmac_f32_16x16x64_bf16 v[20:23], v[12:15], v[144:151], v74
  v_smfmac_f32_16x16x64_bf16 v[24:27], v[12:15], v[152:159], v74
  ds_read_b128 v[60:63], v76 offset:57344
  ds_read_b128 v[64:67], v76 offset:58368
  s_waitcnt lgkmcnt(0)
  v_smfmac_f32_16x16x64_bf16 v[28:31], v[12:15], v[60:67], v74
  ds_read_b128 v[60:63], v76 offset:59392
  ds_read_b128 v[64:67], v76 offset:60416
  s_waitcnt lgkmcnt(0)
  v_smfmac_f32_16x16x64_bf16 v[32:35], v[12:15], v[60:67], v74
  ds_read_b128 v[0:3], v76 offset:9728
  s_waitcnt lgkmcnt(0)
  v_smfmac_f32_16x16x64_bf16 v[20:23], v[0:3], v[160:167], v74
  v_smfmac_f32_16x16x64_bf16 v[24:27], v[0:3], v[168:175], v74
  ds_read_b128 v[60:63], v75 offset:24576
  ds_read_b128 v[64:67], v75 offset:25600
  s_waitcnt lgkmcnt(0)
  v_smfmac_f32_16x16x64_bf16 v[28:31], v[0:3], v[60:67], v74
  ds_read_b128 v[60:63], v75 offset:26624
  ds_read_b128 v[64:67], v75 offset:27648
  s_waitcnt lgkmcnt(0)
  v_smfmac_f32_16x16x64_bf16 v[32:35], v[0:3], v[60:67], v74
  ds_read_b128 v[16:19], v76 offset:10752
  ds_read_b128 v[60:63], v75 offset:8192
  ds_read_b128 v[64:67], v75 offset:9216
  s_waitcnt lgkmcnt(0)
  v_smfmac_f32_16x16x64_bf16 v[20:23], v[16:19], v[60:67], v74
  ds_read_b128 v[60:63], v75 offset:10240
  ds_read_b128 v[64:67], v75 offset:11264
  s_waitcnt lgkmcnt(0)
  v_smfmac_f32_16x16x64_bf16 v[24:27], v[16:19], v[60:67], v74
  v_smfmac_f32_16x16x64_bf16 v[28:31], v[16:19], v[240:247], v74
  v_smfmac_f32_16x16x64_bf16 v[32:35], v[16:19], v[248:255], v74
  ds_read_b128 v[4:7], v76 offset:11776
  s_waitcnt lgkmcnt(0)
  v_smfmac_f32_16x16x64_bf16 v[20:23], v[4:7], v[176:183], v74
  v_smfmac_f32_16x16x64_bf16 v[24:27], v[4:7], v[184:191], v74
  v_smfmac_f32_16x16x64_bf16 v[28:31], v[4:7], a[0:7], v74
  v_smfmac_f32_16x16x64_bf16 v[32:35], v[4:7], a[8:15], v74
  ds_read_b128 v[8:11], v76 offset:12800
  s_waitcnt lgkmcnt(0)
  v_smfmac_f32_16x16x64_bf16 v[20:23], v[8:11], v[192:199], v74
  v_smfmac_f32_16x16x64_bf16 v[24:27], v[8:11], v[200:207], v74
  v_smfmac_f32_16x16x64_bf16 v[28:31], v[8:11], a[16:23], v74
  v_smfmac_f32_16x16x64_bf16 v[32:35], v[8:11], a[24:31], v74
  v_add_f32 v20, v20, v22
  v_add_f32 v21, v21, v23
  v_add_f32 v24, v24, v26
  v_cvt_pk_bf16_f32 v22, v20, v24
  ds_write_b32 v79, v22 offset:0
  v_add_f32 v25, v25, v27
  v_cvt_pk_bf16_f32 v23, v21, v25
  ds_write_b32 v79, v23 offset:576
  v_add_f32 v28, v28, v30
  v_add_f32 v29, v29, v31
  s_waitcnt lgkmcnt(0)
  s_nop 1
  s_branch Cs2_recok
Cs2_mx:
  s_waitcnt lgkmcnt(0)
  s_barrier
  buffer_load_dwordx4 v[0:3], v76, s[8:11], s58 offen offset:0 sc1
  ds_read_b128 v[20:23], v77 offset:0
  ds_read_b128 v[28:31], v77 offset:256
  buffer_load_dwordx4 v[4:7], v76, s[8:11], s58 offen offset:1024 sc1
  ds_read_b128 v[24:27], v77 offset:128
  ds_read_b128 v[32:35], v77 offset:384
  s_waitcnt vmcnt(1) lgkmcnt(3)
  v_mfma_f32_16x16x32_bf16 v[8:11], v[0:3], v[20:23], 0
  s_waitcnt vmcnt(0) lgkmcnt(1)
  v_mfma_f32_16x16x32_bf16 v[8:11], v[4:7], v[24:27], v[8:11]
  v_mfma_f32_16x16x32_bf16 v[12:15], v[28:31], v[20:23], 0
  s_waitcnt lgkmcnt(0)
  v_mfma_f32_16x16x32_bf16 v[12:15], v[32:35], v[24:27], v[12:15]
  v_add_f32_dpp v8, v10, v8 quad_perm:[2,3,0,1] row_mask:0xf bank_mask:0xf
  v_add_f32_dpp v9, v11, v9 quad_perm:[2,3,0,1] row_mask:0xf bank_mask:0xf
  s_nop 0
  v_mov_b32_dpp v8, v8 quad_perm:[0,1,0,1] row_mask:0xf bank_mask:0xf
  v_mov_b32_dpp v9, v9 quad_perm:[0,1,0,1] row_mask:0xf bank_mask:0xf
  s_nop 1
  v_add_f32_dpp v12, v14, v12 quad_perm:[2,3,0,1] row_mask:0xf bank_mask:0xf
  v_add_f32_dpp v13, v15, v13 quad_perm:[2,3,0,1] row_mask:0xf bank_mask:0xf
  s_nop 0
  v_mov_b32_dpp v12, v12 quad_perm:[0,1,0,1] row_mask:0xf bank_mask:0xf
  v_mov_b32_dpp v13, v13 quad_perm:[0,1,0,1] row_mask:0xf bank_mask:0xf
  v_mul_f32 v12, s69, v12
  ds_write_b32 v78, v8 offset:8712
  v_mul_f32 v13, s69, v13
  ds_write_b32 v78, v9 offset:8776
  s_waitcnt lgkmcnt(0)
  s_barrier
  ds_read_b128 v[36:39], v78 offset:8704
  ds_read_b128 v[40:43], v78 offset:8768
  s_waitcnt lgkmcnt(0)
  s_barrier
  v_max_f32 v16, v36, v37
  v_max3_f32 v16, v16, v38, v39
  v_max3_f32 v16, v16, v40, v41
  v_max3_f32 v16, v16, v42, v43
  v_max3_f32 v16, v16, v12, v13
  v_mov_b32 v17, v16
  s_nop 1
  v_permlane16_swap_b32 v16, v17
  v_max_f32 v16, v16, v17
  v_mov_b32 v17, v16
  s_nop 1
  v_permlane32_swap_b32 v16, v17
  v_max_f32 v16, v16, v17
  v_sub_f32 v36, v36, v16
  v_sub_f32 v37, v37, v16
  v_sub_f32 v38, v38, v16
  v_sub_f32 v39, v39, v16
  v_sub_f32 v40, v40, v16
  v_sub_f32 v41, v41, v16
  v_sub_f32 v42, v42, v16
  v_sub_f32 v43, v43, v16
  v_sub_f32 v12, v12, v16
  v_sub_f32 v13, v13, v16
  v_exp_f32 v36, v36
  v_exp_f32 v37, v37
  v_exp_f32 v38, v38
  v_exp_f32 v39, v39
  v_exp_f32 v40, v40
  v_exp_f32 v41, v41
  v_exp_f32 v42, v42
  v_exp_f32 v43, v43
  v_exp_f32 v12, v12
  v_exp_f32 v13, v13
  v_cvt_pk_bf16_f32 v32, v36, v40
  v_cvt_pk_bf16_f32 v33, v37, v41
  v_cvt_pk_bf16_f32 v34, v38, v42
  v_cvt_pk_bf16_f32 v35, v39, v43
  v_cvt_pk_bf16_f32 v28, v12, v13
  v_cvt_pk_bf16_f32 v31, v12, v13
  v_mov_b32 v29, 0
  v_mov_b32 v30, 0
  v_mov_b32 v68, 0x3f803f80
  v_mov_b32 v69, 0x3f803f80
  v_mov_b32 v70, 0x3f803f80
  v_mov_b32 v71, 0x3f803f80
  s_nop 1
  v_mfma_f32_16x16x32_bf16 v[8:11], v[32:35], v[68:71], 0
  v_mfma_f32_16x16x32_bf16 v[0:3], v[32:35], v[52:55], 0
  v_mfma_f32_16x16x32_bf16 v[4:7], v[32:35], v[56:59], 0
  v_mfma_f32_16x16x16_bf16 v[8:11], v[28:29], v[68:69], v[8:11]
  v_mfma_f32_16x16x16_bf16 v[0:3], v[28:29], v[72:73], v[0:3]
  v_mfma_f32_16x16x16_bf16 v[4:7], v[30:31], v[72:73], v[4:7]
  ds_read_b128 v[68:71], v76 offset:13824
  v_rcp_f32 v10, v8
  v_rcp_f32 v11, v9
  v_mul_f32 v0, v10, v0
  v_mul_f32 v1, v11, v1
  s_nop 0
  v_mul_f32 v4, v10, v4
  v_mul_f32 v5, v11, v5
  v_cvt_pk_bf16_f32 v2, v0, v4
  ds_write_b32 v79, v2 offset:8704
  v_cvt_pk_bf16_f32 v3, v1, v5
  ds_write_b32 v79, v3 offset:9280
  v_mov_b64 v[16:17], 0
  v_mov_b64 v[18:19], 0
  v_mov_b64 v[20:21], 0
  v_mov_b64 v[22:23], 0
  v_mov_b64 v[24:25], 0
  v_mov_b64 v[26:27], 0
  s_branch Cs2_mxok
Cs2_last:
  ds_read_b128 v[4:7], v76 offset:5632
  ds_read_b128 v[8:11], v76 offset:6656
  ds_read_b128 v[44:47], v76 offset:40960
  ds_read_b128 v[48:51], v76 offset:41984
  s_nop 5
  v_mov_b64 v[20:21], 0
  v_mov_b64 v[22:23], 0
  v_mov_b64 v[24:25], 0
  v_mov_b64 v[26:27], 0
  s_waitcnt lgkmcnt(4)
  v_smfmac_f32_16x16x64_bf16 v[28:31], v[0:3], v[36:43], v74
  ds_read_b128 v[36:39], v76 offset:43008
  ds_read_b128 v[40:43], v76 offset:44032
  v_smfmac_f32_16x16x64_bf16 v[32:35], v[0:3], v[60:67], v74
  s_waitcnt lgkmcnt(5)
  v_smfmac_f32_16x16x64_bf16 v[20:23], v[0:3], a[32:39], v74
  ds_read_b128 v[60:63], v76 offset:57344
  ds_read_b128 v[64:67], v76 offset:58368
  v_smfmac_f32_16x16x64_bf16 v[24:27], v[0:3], a[40:47], v74
  s_waitcnt lgkmcnt(4)
  v_smfmac_f32_16x16x64_bf16 v[20:23], v[4:7], a[48:55], v74
  buffer_store_dwordx4 v[16:19], v76, s[8:11], s68 offen sc1
  v_smfmac_f32_16x16x64_bf16 v[24:27], v[4:7], a[56:63], v74
  v_smfmac_f32_16x16x64_bf16 v[28:31], v[4:7], v[44:51], v74
  s_waitcnt lgkmcnt(2)
  v_smfmac_f32_16x16x64_bf16 v[20:23], v[8:11], a[64:71], v74
  ds_read_b128 v[44:47], v76 offset:59392
  ds_read_b128 v[48:51], v76 offset:60416
  v_smfmac_f32_16x16x64_bf16 v[24:27], v[8:11], a[72:79], v74
  v_smfmac_f32_16x16x64_bf16 v[32:35], v[4:7], v[36:43], v74
  v_smfmac_f32_16x16x64_bf16 v[28:31], v[8:11], v[208:215], v74
  ds_read_b128 v[36:39], v75 offset:24576
  ds_read_b128 v[40:43], v75 offset:25600
  v_smfmac_f32_16x16x64_bf16 v[32:35], v[8:11], v[216:223], v74
  v_smfmac_f32_16x16x64_bf16 v[20:23], v[12:15], a[80:87], v74
  v_smfmac_f32_16x16x64_bf16 v[24:27], v[12:15], a[88:95], v74
  v_smfmac_f32_16x16x64_bf16 v[28:31], v[12:15], v[224:231], v74
  v_smfmac_f32_16x16x64_bf16 v[32:35], v[12:15], v[232:239], v74
  s_waitcnt vmcnt(1)
  s_barrier
Cs2_lastr:
  ds_read_b128 v[12:15], v76 offset:8704
  ds_read_b128 v[0:3], v76 offset:9728
  ds_read_b128 v[16:19], v76 offset:10752
  ds_read_b128 v[4:7], v76 offset:11776
  ds_read_b128 v[8:11], v76 offset:12800
  s_waitcnt lgkmcnt(3)
  v_max3_u32 v72, v0, v1, v2
  s_waitcnt lgkmcnt(1)
  v_max3_u32 v72, v72, v3, v4
  v_max3_u32 v72, v72, v5, v6
  s_waitcnt lgkmcnt(0)
  v_max3_u32 v72, v72, v7, v8
  v_max3_u32 v72, v72, v9, v10
  v_max3_u32 v72, v72, v11, v12
  v_max3_u32 v72, v72, v13, v14
  v_max3_u32 v72, v72, v15, v16
  v_max3_u32 v72, v72, v17, v18
  v_max_u32 v72, v72, v19
  v_cmp_eq_u32 vcc, -1, v72
  s_cbranch_vccnz Cs2_lastp
Cs2_lastg:
  v_smfmac_f32_16x16x64_bf16 v[28:31], v[12:15], v[60:67], v74
  ds_read_b128 v[60:63], v75 offset:26624
  ds_read_b128 v[64:67], v75 offset:27648
  v_smfmac_f32_16x16x64_bf16 v[32:35], v[12:15], v[44:51], v74
  v_smfmac_f32_16x16x64_bf16 v[28:31], v[0:3], v[36:43], v74
  v_smfmac_f32_16x16x64_bf16 v[28:31], v[16:19], v[240:247], v74
  v_smfmac_f32_16x16x64_bf16 v[28:31], v[4:7], a[0:7], v74
  v_smfmac_f32_16x16x64_bf16 v[28:31], v[8:11], a[16:23], v74
  v_smfmac_f32_16x16x64_bf16 v[32:35], v[16:19], v[248:255], v74
  v_smfmac_f32_16x16x64_bf16 v[32:35], v[4:7], a[8:15], v74
  s_waitcnt lgkmcnt(0)
  v_smfmac_f32_16x16x64_bf16 v[32:35], v[8:11], a[24:31], v74
  v_smfmac_f32_16x16x64_bf16 v[32:35], v[0:3], v[60:67], v74
  v_smfmac_f32_16x16x64_bf16 v[20:23], v[12:15], a[96:103], v74
  v_smfmac_f32_16x16x64_bf16 v[20:23], v[0:3], a[112:119], v74
  v_add_f32 v28, v28, v30
  v_add_f32 v32, v32, v34
  v_cvt_pk_bf16_f32 v30, v28, v32
  v_smfmac_f32_16x16x64_bf16 v[20:23], v[16:19], a[128:135], v74
  ds_write_b32 v79, v30 offset:256
  v_add_f32 v29, v29, v31
  v_add_f32 v33, v33, v35
  v_cvt_pk_bf16_f32 v31, v29, v33
  v_smfmac_f32_16x16x64_bf16 v[20:23], v[4:7], a[144:151], v74
  ds_write_b32 v79, v31 offset:832
  v_smfmac_f32_16x16x64_bf16 v[20:23], v[8:11], a[160:167], v74
  v_smfmac_f32_16x16x64_bf16 v[24:27], v[12:15], a[104:111], v74
  v_smfmac_f32_16x16x64_bf16 v[24:27], v[0:3], a[120:127], v74
  v_smfmac_f32_16x16x64_bf16 v[24:27], v[16:19], a[136:143], v74
  s_waitcnt lgkmcnt(0)
  s_barrier
  ds_read_b64 v[52:53], v77 offset:384
  v_add_f32 v20, v20, v22
  v_smfmac_f32_16x16x64_bf16 v[24:27], v[4:7], a[152:159], v74
  v_add_f32 v21, v21, v23
  v_smfmac_f32_16x16x64_bf16 v[24:27], v[8:11], a[168:175], v74
  v_cvt_pk_bf16_f32 v54, v20, v21
  s_add_u32 s68, s68, 655360
  s_nop 3
  v_add_f32 v24, v24, v26
  v_add_f32 v25, v25, v27
  v_cvt_pk_bf16_f32 v55, v24, v25
  s_waitcnt lgkmcnt(0)
  buffer_store_dwordx4 v[52:55], v76, s[8:11], s68 offen sc1
  s_branch Cs2_done
Cs2_lastp:
  s_add_u32 s72, s72, 2
  s_cmp_ge_u32 s72, 131072
  s_cbranch_scc1 Cs2_lastg
  s_barrier
  buffer_load_dwordx4 v76, s[8:11], s85 offen offset:0 sc1 lds
  s_waitcnt vmcnt(0)
  s_barrier
  s_branch Cs2_lastr
Cs2_done:
  s_branch L_cexit
L_w7:
  v_mov_b64 v[20:21], 0
  v_mov_b64 v[22:23], 0
  v_mov_b64 v[24:25], 0
  v_mov_b64 v[26:27], 0
  v_mov_b64 v[28:29], 0
  v_mov_b64 v[30:31], 0
  v_mov_b64 v[32:33], 0
  v_mov_b64 v[34:35], 0
  s_mov_b32 s78, 0x3f803f80
  s_mov_b32 s79, s78
  s_mov_b32 s65, 360448
  s_mov_b32 m0, 15872
  s_lshl_b32 s71, s53, 2
  s_add_u32 s71, s71, 128
  s_movk_i32 s56, 0x1000
  v_lshlrev_b32 v73, 2, v76
  v_mov_b32 v72, 0
  s_mov_b64 s[16:17], s[8:9]
  s_mov_b32 s18, 268435456
  s_mov_b32 s19, 0x20000
  s_getpc_b64 s[20:21]
Cs3_pc:
  s_add_u32 s20, s20, (Cs3_last - Cs3_pc)
  s_addc_u32 s21, s21, 0
  v_mov_b32 v68, 14880
  buffer_load_dwordx4 v[52:55], v76, s[8:11], s59 offen offset:0 sc1
  buffer_load_dwordx4 v[56:59], v76, s[8:11], s59 offen offset:1024 sc1
  ds_read_b128 v[36:39], v76 offset:45056
  ds_read_b128 v[40:43], v76 offset:46080
  ds_read_b128 v[60:63], v76 offset:47104
  ds_read_b128 v[64:67], v76 offset:48128
  ds_read_b128 v[0:3], v76 offset:4608
  ds_read_b128 v[4:7], v76 offset:5632
  ds_read_b128 v[8:11], v76 offset:6656
  ds_read_b128 v[12:15], v76 offset:7680
  s_waitcnt lgkmcnt(0)
  s_cmp_eq_u32 s66, 1
  s_branch Cs3_top2
.p2align 6
Cs3_h2:
  v_lshlrev_b32 v73, 2, v76
  ds_read_b128 v[36:39], v76 offset:45056
  ds_read_b128 v[40:43], v76 offset:46080
  buffer_load_dwordx4 v[52:55], v76, s[8:11], s59 offen offset:0 sc1
  buffer_load_dwordx4 v[56:59], v76, s[8:11], s59 offen offset:1024 sc1
  s_waitcnt vmcnt(0)
  s_mov_b64 vcc, -1
Cs3_h2r:
  s_mov_b64 exec, vcc
  buffer_load_dwordx4 v[4:7], v76, s[8:11], s65 offen offset:1024 sc1
  buffer_load_dwordx4 v[0:3], v76, s[8:11], s85 offen offset:0 sc1
  buffer_load_dwordx4 v[8:11], v76, s[8:11], s85 offen offset:1024 sc1
  s_mov_b64 exec, -1
  s_add_u32 s67, s67, 1
  s_cmp_lt_u32 s67, 131072
  s_cselect_b32 s54, -2, -1
  s_waitcnt vmcnt(2)
  v_max3_u32 v72, v4, v5, v6
  s_waitcnt vmcnt(1)
  v_max3_u32 v72, v72, v7, v0
  v_max3_u32 v72, v72, v1, v2
  s_waitcnt vmcnt(0)
  v_max3_u32 v72, v72, v3, v8
  v_max3_u32 v72, v72, v9, v10
  v_max_u32 v72, v72, v11
  v_cmp_lt_u32 vcc, s54, v72
  s_cbranch_vccnz Cs3_h2r
  ds_write_b128 v76, v[4:7] offset:5632
  ds_write_b128 v76, v[0:3] offset:8704
  ds_write_b128 v76, v[8:11] offset:9728
Cs3_h2w:
  s_cmp_eq_u32 s66, 63
  s_waitcnt lgkmcnt(0)
  s_barrier
  ds_read_b128 v[8:11], v76 offset:6656
Cs3_top2:
  v_smfmac_f32_16x16x64_bf16 v[20:23], v[4:7], v[96:103], v74
  s_cbranch_scc1 Cs3_last
  v_smfmac_f32_16x16x64_bf16 v[28:31], v[4:7], v[36:43], v74
  buffer_load_dwordx4 v[44:47], v76, s[8:11], s58 offen offset:0 sc1
  s_mov_b32 m0, 15872
  v_smfmac_f32_16x16x64_bf16 v[24:27], v[4:7], v[104:111], v74
  buffer_load_dwordx4 v[48:51], v76, s[8:11], s58 offen offset:1024 sc1
  v_smfmac_f32_16x16x64_bf16 v[32:35], v[4:7], v[60:67], v74
  ds_read_b128 v[0:3], v76 offset:4608
  s_waitcnt lgkmcnt(1)
  v_smfmac_f32_16x16x64_bf16 v[20:23], v[8:11], v[112:119], v74
  ds_read_b128 v[12:15], v76 offset:7680
  v_smfmac_f32_16x16x64_bf16 v[24:27], v[8:11], v[120:127], v74
  ds_read_b128 v[36:39], v76 offset:28672
  v_smfmac_f32_16x16x64_bf16 v[28:31], v[8:11], v[208:215], v74
  buffer_store_dwordx4 v[16:19], v76, s[8:11], s68 offen sc1
  ds_read_b128 v[40:43], v76 offset:29696
  v_smfmac_f32_16x16x64_bf16 v[32:35], v[8:11], v[216:223], v74
  buffer_load_dword v73, s[16:19], s70 offen lds
  ds_read_b128 v[60:63], v76 offset:30720
  s_waitcnt lgkmcnt(4)
  v_smfmac_f32_16x16x64_bf16 v[20:23], v[0:3], v[80:87], v74
  ds_read_b128 v[64:67], v76 offset:31744
  v_smfmac_f32_16x16x64_bf16 v[24:27], v[0:3], v[88:95], v74
  s_waitcnt vmcnt(4)
  s_waitcnt lgkmcnt(4)
  v_smfmac_f32_16x16x64_bf16 v[20:23], v[12:15], v[128:135], v74
  s_barrier
  ds_read_b128 v[4:7], v76 offset:8704
  s_waitcnt lgkmcnt(3)
  v_smfmac_f32_16x16x64_bf16 v[28:31], v[0:3], v[36:43], v74
  ds_read_b128 v[36:39], v76 offset:61440
  v_smfmac_f32_16x16x64_bf16 v[24:27], v[12:15], v[136:143], v74
  ds_read_b128 v[40:43], v76 offset:62464
  s_waitcnt lgkmcnt(3)
  v_smfmac_f32_16x16x64_bf16 v[32:35], v[0:3], v[60:67], v74
  ds_read_b128 v[8:11], v76 offset:9728
  v_smfmac_f32_16x16x64_bf16 v[28:31], v[12:15], v[224:231], v74
  ds_read_b128 v[60:63], v76 offset:63488
  v_smfmac_f32_16x16x64_bf16 v[32:35], v[12:15], v[232:239], v74
  ds_read_b128 v[64:67], v76 offset:64512
  s_waitcnt lgkmcnt(5)
  v_smfmac_f32_16x16x64_bf16 v[20:23], v[4:7], v[144:151], v74
  s_barrier
  ds_read_b128 v[0:3], v76 offset:11776
  s_waitcnt lgkmcnt(4)
  v_smfmac_f32_16x16x64_bf16 v[28:31], v[4:7], v[36:43], v74
  ds_read_b128 v[12:15], v76 offset:12800
  ds_read_b128 v[36:39], v75 offset:12288
  v_smfmac_f32_16x16x64_bf16 v[24:27], v[4:7], v[152:159], v74
  ds_read_b128 v[16:19], v76 offset:10752
  s_waitcnt lgkmcnt(6)
  v_smfmac_f32_16x16x64_bf16 v[20:23], v[8:11], v[160:167], v74
  ds_read_b128 v[40:43], v75 offset:13312
  s_waitcnt lgkmcnt(5)
  v_smfmac_f32_16x16x64_bf16 v[32:35], v[4:7], v[60:67], v74
  ds_read_b128 v[60:63], v75 offset:14336
  v_smfmac_f32_16x16x64_bf16 v[24:27], v[8:11], v[168:175], v74
  ds_read_b128 v[64:67], v75 offset:15360
  s_waitcnt lgkmcnt(6)
  v_smfmac_f32_16x16x64_bf16 v[20:23], v[0:3], v[176:183], v74
  s_waitcnt lgkmcnt(5)
  v_smfmac_f32_16x16x64_bf16 v[20:23], v[12:15], v[192:199], v74
  s_waitcnt lgkmcnt(2)
  v_smfmac_f32_16x16x64_bf16 v[20:23], v[16:19], v[36:43], v74
  ds_read_b128 v[36:39], v75 offset:28672
  v_smfmac_f32_16x16x64_bf16 v[24:27], v[0:3], v[184:191], v74
  ds_read_b128 v[40:43], v75 offset:29696
  s_waitcnt lgkmcnt(2)
  v_smfmac_f32_16x16x64_bf16 v[24:27], v[16:19], v[60:67], v74
  ds_read_b128 v[60:63], v75 offset:30720
  v_add_f32 v20, v20, v22
  v_smfmac_f32_16x16x64_bf16 v[24:27], v[12:15], v[200:207], v74
  ds_read_b128 v[64:67], v75 offset:31744
  v_add_f32 v21, v21, v23
  v_smfmac_f32_16x16x64_bf16 v[28:31], v[16:19], v[240:247], v74
  v_mov_b64 v[70:71], s[78:79]
  v_smfmac_f32_16x16x64_bf16 v[28:31], v[0:3], a[0:7], v74
  s_waitcnt lgkmcnt(2)
  v_add_f32 v24, v24, v26
  v_smfmac_f32_16x16x64_bf16 v[28:31], v[8:11], v[36:43], v74
  ds_read_b128 v[36:39], v68
  v_cvt_pk_bf16_f32 v22, v20, v24
  v_smfmac_f32_16x16x64_bf16 v[28:31], v[12:15], a[16:23], v74
  ds_read_b128 v[40:43], v68
  ds_write_b32 v79, v22 offset:0
  s_waitcnt lgkmcnt(3)
  v_add_f32 v25, v25, v27
  v_cvt_pk_bf16_f32 v23, v21, v25
  v_smfmac_f32_16x16x64_bf16 v[32:35], v[8:11], v[60:67], v74
  ds_write_b32 v79, v23 offset:576
  v_cmp_u_f32 vcc, v20, v21
  v_smfmac_f32_16x16x64_bf16 v[32:35], v[16:19], v[248:255], v74
  v_add_f32 v28, v28, v30
  v_smfmac_f32_16x16x64_bf16 v[32:35], v[0:3], a[8:15], v74
  v_add_f32 v29, v29, v31
  v_smfmac_f32_16x16x64_bf16 v[32:35], v[12:15], a[24:31], v74
  s_cbranch_vccnz Cs3_rec
Cs3_recok:
  s_waitcnt lgkmcnt(3)
  v_smfmac_f32_16x16x64_bf16 v[36:39], v[16:19], a[128:135], v74
  s_waitcnt lgkmcnt(0)
  s_barrier
  ds_read_b128 v[60:63], v77
  v_smfmac_f32_16x16x64_bf16 v[40:43], v[16:19], a[136:143], v74
  ds_read_b128 v[64:67], v77 offset:128
  v_add_f32 v32, v32, v34
  v_cvt_pk_bf16_f32 v30, v28, v32
  v_smfmac_f32_16x16x64_bf16 v[36:39], v[0:3], a[144:151], v74
  ds_write_b32 v79, v30 offset:256
  v_add_f32 v33, v33, v35
  v_cvt_pk_bf16_f32 v31, v29, v33
  v_smfmac_f32_16x16x64_bf16 v[40:43], v[0:3], a[152:159], v74
  ds_write_b32 v79, v31 offset:832
  v_xor_b32 v75, 0x8000, v75
  v_smfmac_f32_16x16x64_bf16 v[36:39], v[4:7], a[96:103], v74
  ds_read_b128 v[0:3], v76 offset:4608
  v_mov_b32 v29, 0
  v_smfmac_f32_16x16x64_bf16 v[40:43], v[4:7], a[104:111], v74
  s_waitcnt vmcnt(2) lgkmcnt(3)
  v_mov_b32 v30, 0
  v_mfma_f32_16x16x32_bf16 v[44:47], v[44:47], v[60:63], 0
  ds_read_b128 v[4:7], v76 offset:5632
  s_waitcnt lgkmcnt(2)
  v_mfma_f32_16x16x32_bf16 v[44:47], v[48:51], v[64:67], v[44:47]
  s_barrier
  v_smfmac_f32_16x16x64_bf16 v[36:39], v[8:11], a[112:119], v74
  ds_read_b128 v[20:23], v77 offset:256
  ds_read_b128 v[24:27], v77 offset:384
  v_smfmac_f32_16x16x64_bf16 v[40:43], v[8:11], a[120:127], v74
  ds_read_b128 v[8:11], v76 offset:6656
  v_add_f32_dpp v72, v46, v44 quad_perm:[2,3,0,1] row_mask:0xf bank_mask:0xf
  v_add_f32_dpp v73, v47, v45 quad_perm:[2,3,0,1] row_mask:0xf bank_mask:0xf
  v_smfmac_f32_16x16x64_bf16 v[36:39], v[12:15], a[160:167], v74
  s_waitcnt lgkmcnt(4)
  v_exp_f32_dpp v72, v72 quad_perm:[0,1,0,1] row_mask:0xf bank_mask:0xf
  v_smfmac_f32_16x16x64_bf16 v[40:43], v[12:15], a[168:175], v74
  ds_read_b128 v[12:15], v76 offset:7680
  v_exp_f32_dpp v73, v73 quad_perm:[0,1,0,1] row_mask:0xf bank_mask:0xf
  v_smfmac_f32_16x16x64_bf16 v[36:39], v[0:3], a[32:39], v74
  s_waitcnt lgkmcnt(2)
  v_cvt_pk_bf16_f32 v72, v72, v73
  v_mfma_f32_16x16x32_bf16 v[20:23], v[20:23], v[60:63], 0
  ds_write_b32 v78, v72 offset:524
  v_mov_b64 v[16:17], 0
  v_mfma_f32_16x16x32_bf16 v[20:23], v[24:27], v[64:67], v[20:23]
  ds_read_b128 v[44:47], v75 offset:28672
  v_mov_b64 v[18:19], 0
  v_smfmac_f32_16x16x64_bf16 v[40:43], v[0:3], a[40:47], v74
  ds_read_b128 v[48:51], v75 offset:29696
  v_mov_b64 v[68:69], s[78:79]
  v_smfmac_f32_16x16x64_bf16 v[36:39], v[4:7], a[48:55], v74
  s_waitcnt lgkmcnt(4)
  v_add_f32_dpp v24, v22, v20 quad_perm:[2,3,0,1] row_mask:0xf bank_mask:0xf
  v_add_f32_dpp v25, v23, v21 quad_perm:[2,3,0,1] row_mask:0xf bank_mask:0xf
  v_smfmac_f32_16x16x64_bf16 v[36:39], v[8:11], a[64:71], v74
  s_waitcnt lgkmcnt(2)
  s_barrier
  ds_read_b128 v[32:35], v78 offset:512
  v_smfmac_f32_16x16x64_bf16 v[36:39], v[12:15], a[80:87], v74
  ds_read_b128 v[60:63], v75 offset:30720
  v_mul_f32 v24, s69, v24
  v_smfmac_f32_16x16x64_bf16 v[40:43], v[4:7], a[56:63], v74
  ds_read_b128 v[64:67], v75 offset:31744
  v_mul_f32 v25, s69, v25
  v_smfmac_f32_16x16x64_bf16 v[40:43], v[8:11], a[72:79], v74
  v_exp_f32_dpp v24, v24 quad_perm:[0,1,0,1] row_mask:0xf bank_mask:0xf
  v_smfmac_f32_16x16x64_bf16 v[40:43], v[12:15], a[88:95], v74
  s_waitcnt lgkmcnt(2)
  v_exp_f32_dpp v25, v25 quad_perm:[0,1,0,1] row_mask:0xf bank_mask:0xf
  v_mfma_f32_16x16x32_bf16 v[8:11], v[32:35], v[68:71], 0
  v_add_f32 v36, v36, v38
  v_add_f32 v37, v37, v39
  v_mfma_f32_16x16x32_bf16 v[0:3], v[32:35], v[52:55], 0
  v_add_f32 v40, v40, v42
  v_add_f32 v41, v41, v43
  v_mfma_f32_16x16x32_bf16 v[4:7], v[32:35], v[56:59], 0
  v_cvt_pk_bf16_f32 v28, v24, v25
  v_cvt_pk_bf16_f32 v72, v36, v37
  v_cvt_pk_bf16_f32 v73, v40, v41
  v_mfma_f32_16x16x16_bf16 v[8:11], v[28:29], v[68:69], v[8:11]
  v_cvt_pk_bf16_f32 v31, v24, v25
  v_mov_b64 v[20:21], 0
  v_mfma_f32_16x16x16_bf16 v[0:3], v[28:29], v[72:73], v[0:3]
  ds_read_b128 v[68:71], v76 offset:13824
  v_mov_b64 v[22:23], 0
  v_mfma_f32_16x16x16_bf16 v[4:7], v[30:31], v[72:73], v[4:7]
  v_rcp_f32 v10, v8
  v_rcp_f32 v11, v9
  v_mul_f32 v0, v10, v0
  v_mul_f32 v1, v11, v1
  s_nop 0
  v_mul_f32 v4, v10, v4
  v_mul_f32 v5, v11, v5
  v_cvt_pk_bf16_f32 v2, v0, v4
  ds_write_b32 v79, v2 offset:8704
  v_cvt_pk_bf16_f32 v3, v1, v5
  ds_write_b32 v79, v3 offset:9280
  v_max3_f32 v8, v8, v9, v10
  v_max_f32 v8, v8, v11
  v_cmp_le_f32 vcc, 1317011456, v8
  v_mov_b64 v[24:25], 0
  v_mov_b64 v[26:27], 0
  s_cbranch_vccnz Cs3_mx
Cs3_mxok:
  s_waitcnt lgkmcnt(0)
  s_barrier
  ds_read_b128 v[0:3], v78 offset:8704
  ds_read_b128 v[4:7], v78 offset:8768
  ds_read_b128 v[8:11], v78 offset:8832
  ds_read_b128 v[12:15], v78 offset:8896
  s_waitcnt lgkmcnt(3)
  v_smfmac_f32_16x16x64_bf16 v[16:19], v[0:3], v[44:51], v74
  ds_read_b128 v[52:55], v75 offset:45056
  s_waitcnt lgkmcnt(3)
  v_smfmac_f32_16x16x64_bf16 v[16:19], v[4:7], v[60:67], v74
  ds_read_b128 v[56:59], v75 offset:46080
  s_waitcnt lgkmcnt(3)
  v_smfmac_f32_16x16x64_bf16 v[16:19], v[8:11], a[176:183], v74
  ds_read_b128 v[36:39], v75 offset:47104
  s_waitcnt lgkmcnt(3)
  v_smfmac_f32_16x16x64_bf16 v[16:19], v[12:15], a[184:191], v74
  ds_read_b128 v[40:43], v75 offset:48128
  ds_read_b128 v[44:47], v75 offset:61440
  v_smfmac_f32_16x16x64_bf16 v[20:23], v[0:3], a[192:199], v74
  ds_read_b128 v[48:51], v75 offset:62464
  ds_read_b128 v[60:63], v75 offset:63488
  v_smfmac_f32_16x16x64_bf16 v[20:23], v[4:7], a[200:207], v74
  ds_read_b128 v[64:67], v75 offset:64512
  s_waitcnt lgkmcnt(6)
  v_cvt_pk_bf16_f32 v16, v16, v17
  v_cvt_pk_bf16_f32 v17, v18, v19
  v_bfi_b32 v16, 1, s72, v16
  v_smfmac_f32_16x16x64_bf16 v[20:23], v[8:11], v[52:59], v74
  buffer_store_dwordx2 v[16:17], v68, s[8:11], s73 offen sc1
  s_waitcnt lgkmcnt(4)
  v_smfmac_f32_16x16x64_bf16 v[20:23], v[12:15], v[36:43], v74
  ds_read_b128 v[52:55], v75 offset:8192
  v_mov_b64 v[32:33], 0
  v_smfmac_f32_16x16x64_bf16 v[24:27], v[0:3], a[208:215], v74
  ds_read_b128 v[56:59], v75 offset:9216
  v_mov_b64 v[34:35], 0
  v_smfmac_f32_16x16x64_bf16 v[24:27], v[4:7], a[216:223], v74
  ds_read_b128 v[36:39], v75 offset:10240
  s_waitcnt lgkmcnt(5)
  v_cvt_pk_bf16_f32 v20, v20, v21
  v_cvt_pk_bf16_f32 v21, v22, v23
  v_bfi_b32 v20, 1, s72, v20
  v_smfmac_f32_16x16x64_bf16 v[24:27], v[8:11], v[44:51], v74
  buffer_store_dwordx2 v[20:21], v68, s[8:11], s74 offen sc1
  s_waitcnt lgkmcnt(3)
  v_smfmac_f32_16x16x64_bf16 v[24:27], v[12:15], v[60:67], v74
  ds_read_b128 v[40:43], v75 offset:11264
  v_mov_b64 v[28:29], 0
  v_smfmac_f32_16x16x64_bf16 v[32:35], v[0:3], a[224:231], v74
  ds_read_b128 v[44:47], v75 offset:12288
  ds_read_b128 v[48:51], v75 offset:13312
  v_smfmac_f32_16x16x64_bf16 v[32:35], v[4:7], a[232:239], v74
  ds_read_b128 v[60:63], v75 offset:14336
  v_cvt_pk_bf16_f32 v24, v24, v25
  v_cvt_pk_bf16_f32 v25, v26, v27
  v_bfi_b32 v24, 1, s72, v24
  v_smfmac_f32_16x16x64_bf16 v[32:35], v[8:11], a[240:247], v74
  buffer_store_dwordx2 v[24:25], v68, s[8:11], s75 offen sc1
  v_mov_b64 v[30:31], 0
  v_smfmac_f32_16x16x64_bf16 v[32:35], v[12:15], a[248:255], v74
  ds_read_b128 v[64:67], v75 offset:15360
  s_waitcnt lgkmcnt(6)
  v_smfmac_f32_16x16x64_bf16 v[28:31], v[0:3], v[52:59], v74
  s_waitcnt lgkmcnt(4)
  v_smfmac_f32_16x16x64_bf16 v[28:31], v[4:7], v[36:43], v74
  s_waitcnt lgkmcnt(2)
  v_cvt_pk_bf16_f32 v32, v32, v33
  v_cvt_pk_bf16_f32 v33, v34, v35
  v_bfi_b32 v32, 1, s72, v32
  v_smfmac_f32_16x16x64_bf16 v[28:31], v[8:11], v[44:51], v74
  buffer_store_dwordx2 v[32:33], v68, s[8:11], s76 offen sc1
  s_waitcnt lgkmcnt(0)
  v_smfmac_f32_16x16x64_bf16 v[28:31], v[12:15], v[60:67], v74
  v_mov_b64 v[18:19], v[72:73]
  s_nop 4
  v_cvt_pk_bf16_f32 v28, v28, v29
  v_cvt_pk_bf16_f32 v29, v30, v31
  v_bfi_b32 v28, 1, s72, v28
  buffer_store_dwordx2 v[28:29], v68, s[8:11], s77 offen sc1
  ds_read_b128 v[52:55], v76 offset:14848
  s_waitcnt lgkmcnt(0)
  ds_read_b64 v[16:17], v77 offset:392
  s_waitcnt lgkmcnt(0)
  ds_read_b128 v[60:63], v76 offset:47104
  s_waitcnt lgkmcnt(0)
  ds_read_b128 v[64:67], v76 offset:48128
  s_waitcnt lgkmcnt(0)
  s_add_u32 s66, s66, 1
  s_xor_b32 s64, s64, 16384
  s_xor_b32 s65, s65, 16384
  s_add_u32 s58, s58, 655360
  s_add_u32 s59, s59, 655360
  s_add_u32 s70, s70, 655360
  s_add_u32 s68, s68, 655360
  s_mov_b32 m0, 8704
  s_add_u32 s85, s65, 4096
  v_xor_b32 v75, 0x8000, v75
  s_waitcnt vmcnt(0)
  buffer_load_dwordx4 v[0:3], v76, s[8:11], s60 offen offset:0 sc1
  buffer_load_dwordx4 v[4:7], v76, s[8:11], s60 offen offset:1024 sc1
  buffer_load_dwordx4 v[8:11], v76, s[8:11], s61 offen offset:0 sc1
  buffer_load_dwordx4 v[12:15], v76, s[8:11], s61 offen offset:1024 sc1
  v_mov_b64 v[20:21], 0
  v_mov_b64 v[22:23], 0
  v_mov_b64 v[24:25], 0
  v_mov_b64 v[26:27], 0
  v_mov_b32 v68, 14880
  v_mov_b64 v[28:29], 0
  v_mov_b64 v[30:31], 0
  v_mov_b64 v[32:33], 0
  v_mov_b64 v[34:35], 0
  s_cmp_eq_u32 s66, 62
  s_cselect_b64 s[16:17], s[20:21], s[16:17]
  s_cselect_b32 s18, (Cs3_done - Cs3_last), s18
  s_cselect_b32 s70, 0, s70
  s_cmp_eq_u32 s66, 63
  s_cselect_b32 s59, 268435456, s59
  s_cselect_b32 s58, 268435456, s58
  s_waitcnt lgkmcnt(0)
  s_waitcnt vmcnt(3)
  v_mfma_f32_16x16x32_bf16 v[56:59], v[52:55], v[0:3], 0
  v_bitop3_b32 v72, v0, v2, s72 bitop3:0x7e
  s_waitcnt vmcnt(2)
  v_mfma_f32_16x16x32_bf16 v[56:59], v[52:55], v[4:7], v[56:59]
  v_bitop3_b32 v73, v4, v6, s72 bitop3:0x7e
  v_or_b32 v72, v72, v73
  s_waitcnt vmcnt(1)
  v_mfma_f32_16x16x32_bf16 v[36:39], v[52:55], v[8:11], 0
  v_bitop3_b32 v73, v8, v10, s72 bitop3:0x7e
  v_or_b32 v72, v72, v73
  s_waitcnt vmcnt(0)
  v_mfma_f32_16x16x32_bf16 v[36:39], v[52:55], v[12:15], v[36:39]
  v_bitop3_b32 v73, v12, v14, s72 bitop3:0x7e
  v_bitop3_b32 v72, v72, v73, 1 bitop3:0xa8
  v_cmp_ne_u32 vcc, 0, v72
  s_cbranch_vccnz Cs3_h1r
  v_add_f32_dpp v56, v56, v56 row_ror:4 row_mask:0xf bank_mask:0xf
  v_add_f32_dpp v57, v57, v57 row_ror:4 row_mask:0xf bank_mask:0xf
  s_nop 0
  v_add_f32_dpp v36, v36, v36 row_ror:4 row_mask:0xf bank_mask:0xf
  v_add_f32_dpp v37, v37, v37 row_ror:4 row_mask:0xf bank_mask:0xf
  v_add_f32_dpp v56, v56, v56 row_ror:8 row_mask:0xf bank_mask:0xf
  v_add_f32_dpp v57, v57, v57 row_ror:8 row_mask:0xf bank_mask:0xf
  v_add_f32_dpp v36, v36, v36 row_ror:8 row_mask:0xf bank_mask:0xf
  v_add_f32_dpp v37, v37, v37 row_ror:8 row_mask:0xf bank_mask:0xf
  v_cvt_pk_bf16_f32 v56, v56, v57
  buffer_store_dword v56, v69, s[8:11], s62 offen sc1
  v_cvt_pk_bf16_f32 v36, v36, v37
  buffer_store_dword v36, v70, s[8:11], s63 offen sc1
  s_xor_b32 s62, s62, 16384
  buffer_store_dword v71, v69, s[8:11], s62 offen sc1
  s_xor_b32 s63, s63, 16384
  buffer_store_dword v71, v70, s[8:11], s63 offen sc1
  s_xor_b32 s72, s72, 1
  s_branch Cs3_h2
Cs3_h1r:
  s_mov_b64 exec, vcc
  buffer_load_dwordx4 v[0:3], v76, s[8:11], s60 offen offset:0 sc1
  buffer_load_dwordx4 v[4:7], v76, s[8:11], s60 offen offset:1024 sc1
  buffer_load_dwordx4 v[8:11], v76, s[8:11], s61 offen offset:0 sc1
  buffer_load_dwordx4 v[12:15], v76, s[8:11], s61 offen offset:1024 sc1
  s_mov_b64 exec, -1
  s_add_u32 s67, s67, 1
  s_waitcnt vmcnt(3)
  v_mfma_f32_16x16x32_bf16 v[56:59], v[52:55], v[0:3], 0
  v_bitop3_b32 v72, v0, v2, s72 bitop3:0x7e
  s_waitcnt vmcnt(2)
  v_mfma_f32_16x16x32_bf16 v[56:59], v[52:55], v[4:7], v[56:59]
  v_bitop3_b32 v73, v4, v6, s72 bitop3:0x7e
  v_or_b32 v72, v72, v73
  s_waitcnt vmcnt(1)
  v_mfma_f32_16x16x32_bf16 v[36:39], v[52:55], v[8:11], 0
  v_bitop3_b32 v73, v8, v10, s72 bitop3:0x7e
  v_or_b32 v72, v72, v73
  s_waitcnt vmcnt(0)
  v_mfma_f32_16x16x32_bf16 v[36:39], v[52:55], v[12:15], v[36:39]
  v_bitop3_b32 v73, v12, v14, s72 bitop3:0x7e
  v_bitop3_b32 v72, v72, v73, 1 bitop3:0xa8
  v_cmp_ne_u32 vcc, 0, v72
  s_cbranch_vccz Cs3_h1p
Cs3_h1s:
  s_mov_b64 exec, vcc
  buffer_load_dwordx4 v[0:3], v76, s[8:11], s60 offen offset:0 sc1
  buffer_load_dwordx4 v[4:7], v76, s[8:11], s60 offen offset:1024 sc1
  buffer_load_dwordx4 v[8:11], v76, s[8:11], s61 offen offset:0 sc1
  buffer_load_dwordx4 v[12:15], v76, s[8:11], s61 offen offset:1024 sc1
  s_mov_b64 exec, -1
  s_add_u32 s67, s67, 1
  s_waitcnt vmcnt(3)
  v_mfma_f32_16x16x32_bf16 v[56:59], v[52:55], v[0:3], 0
  v_bitop3_b32 v72, v0, v2, s72 bitop3:0x7e
  s_waitcnt vmcnt(2)
  v_mfma_f32_16x16x32_bf16 v[56:59], v[52:55], v[4:7], v[56:59]
  v_bitop3_b32 v73, v4, v6, s72 bitop3:0x7e
  v_or_b32 v72, v72, v73
  s_waitcnt vmcnt(1)
  v_mfma_f32_16x16x32_bf16 v[36:39], v[52:55], v[8:11], 0
  v_bitop3_b32 v73, v8, v10, s72 bitop3:0x7e
  v_or_b32 v72, v72, v73
  s_waitcnt vmcnt(0)
  v_mfma_f32_16x16x32_bf16 v[36:39], v[52:55], v[12:15], v[36:39]
  v_bitop3_b32 v73, v12, v14, s72 bitop3:0x7e
  v_bitop3_b32 v72, v72, v73, 1 bitop3:0xa8
  v_cmp_ne_u32 vcc, 0, v72
  s_cbranch_vccz Cs3_h1p
  s_cmp_lt_u32 s67, 131072
  s_cbranch_scc1 Cs3_h1s
Cs3_h1p:
  s_nop 2
  v_add_f32_dpp v56, v56, v56 row_ror:4 row_mask:0xf bank_mask:0xf
  v_add_f32_dpp v57, v57, v57 row_ror:4 row_mask:0xf bank_mask:0xf
  v_add_f32_dpp v36, v36, v36 row_ror:4 row_mask:0xf bank_mask:0xf
  v_add_f32_dpp v37, v37, v37 row_ror:4 row_mask:0xf bank_mask:0xf
  v_add_f32_dpp v56, v56, v56 row_ror:8 row_mask:0xf bank_mask:0xf
  v_add_f32_dpp v57, v57, v57 row_ror:8 row_mask:0xf bank_mask:0xf
  v_add_f32_dpp v36, v36, v36 row_ror:8 row_mask:0xf bank_mask:0xf
  v_add_f32_dpp v37, v37, v37 row_ror:8 row_mask:0xf bank_mask:0xf
  v_cvt_pk_bf16_f32 v56, v56, v57
  buffer_store_dword v56, v69, s[8:11], s62 offen sc1
  v_cvt_pk_bf16_f32 v36, v36, v37
  buffer_store_dword v36, v70, s[8:11], s63 offen sc1
  s_xor_b32 s62, s62, 16384
  buffer_store_dword v71, v69, s[8:11], s62 offen sc1
  s_xor_b32 s63, s63, 16384
  buffer_store_dword v71, v70, s[8:11], s63 offen sc1
  s_xor_b32 s72, s72, 1
  s_branch Cs3_h2
Cs3_rec:
  s_nop 7
  s_waitcnt vmcnt(0) lgkmcnt(0)
  v_max3_u32 v72, v0, v1, v2
  v_max3_u32 v72, v72, v3, v4
  v_max3_u32 v72, v72, v5, v6
  v_max3_u32 v72, v72, v7, v8
  v_max3_u32 v72, v72, v9, v10
  v_max3_u32 v72, v72, v11, v12
  v_max3_u32 v72, v72, v13, v14
  v_max3_u32 v72, v72, v15, v16
  v_max3_u32 v72, v72, v17, v18
  v_max_u32 v72, v72, v19
  v_cmp_eq_u32 vcc, -1, v72
  s_cbranch_vccz Cs3_recok
  s_barrier
Cs3_recp:
  buffer_load_dwordx4 v[0:3], v76, s[8:11], s64 offen offset:0 sc1
  buffer_load_dwordx4 v[4:7], v76, s[8:11], s64 offen offset:1024 sc1
  buffer_load_dwordx4 v[8:11], v76, s[8:11], s64 offen offset:2048 sc1
  s_add_u32 s67, s67, 1
  s_cmp_lt_u32 s67, 131072
  s_cselect_b32 s54, -2, -1
  s_waitcnt vmcnt(2)
  v_max3_u32 v72, v0, v1, v2
  s_waitcnt vmcnt(1)
  v_max3_u32 v72, v72, v3, v4
  v_max3_u32 v72, v72, v5, v6
  s_waitcnt vmcnt(0)
  v_max3_u32 v72, v72, v7, v8
  v_max3_u32 v72, v72, v9, v10
  v_max_u32 v72, v72, v11
  v_cmp_lt_u32 vcc, s54, v72
  s_cbranch_vccnz Cs3_recp
  ds_write_b128 v76, v[0:3] offset:10752
  ds_write_b128 v76, v[4:7] offset:11776
  ds_write_b128 v76, v[8:11] offset:12800
  v_mov_b64 v[20:21], 0
  v_mov_b64 v[22:23], 0
  v_mov_b64 v[24:25], 0
  v_mov_b64 v[26:27], 0
  v_mov_b64 v[28:29], 0
  v_mov_b64 v[30:31], 0
  v_mov_b64 v[32:33], 0
  v_mov_b64 v[34:35], 0
  s_waitcnt lgkmcnt(0)
  s_barrier
  ds_read_b128 v[0:3], v76 offset:4608
  s_waitcnt lgkmcnt(0)
  v_smfmac_f32_16x16x64_bf16 v[20:23], v[0:3], v[80:87], v74
  v_smfmac_f32_16x16x64_bf16 v[24:27], v[0:3], v[88:95], v74
  ds_read_b128 v[60:63], v76 offset:28672
  ds_read_b128 v[64:67], v76 offset:29696
  s_waitcnt lgkmcnt(0)
  v_smfmac_f32_16x16x64_bf16 v[28:31], v[0:3], v[60:67], v74
  ds_read_b128 v[60:63], v76 offset:30720
  ds_read_b128 v[64:67], v76 offset:31744
  s_waitcnt lgkmcnt(0)
  v_smfmac_f32_16x16x64_bf16 v[32:35], v[0:3], v[60:67], v74
  ds_read_b128 v[4:7], v76 offset:5632
  s_waitcnt lgkmcnt(0)
  v_smfmac_f32_16x16x64_bf16 v[20:23], v[4:7], v[96:103], v74
  v_smfmac_f32_16x16x64_bf16 v[24:27], v[4:7], v[104:111], v74
  ds_read_b128 v[60:63], v76 offset:45056
  ds_read_b128 v[64:67], v76 offset:46080
  s_waitcnt lgkmcnt(0)
  v_smfmac_f32_16x16x64_bf16 v[28:31], v[4:7], v[60:67], v74
  ds_read_b128 v[60:63], v76 offset:47104
  ds_read_b128 v[64:67], v76 offset:48128
  s_waitcnt lgkmcnt(0)
  v_smfmac_f32_16x16x64_bf16 v[32:35], v[4:7], v[60:67], v74
  ds_read_b128 v[8:11], v76 offset:6656
  s_waitcnt lgkmcnt(0)
  v_smfmac_f32_16x16x64_bf16 v[20:23], v[8:11], v[112:119], v74
  v_smfmac_f32_16x16x64_bf16 v[24:27], v[8:11], v[120:127], v74
  v_smfmac_f32_16x16x64_bf16 v[28:31], v[8:11], v[208:215], v74
  v_smfmac_f32_16x16x64_bf16 v[32:35], v[8:11], v[216:223], v74
  ds_read_b128 v[12:15], v76 offset:7680
  s_waitcnt lgkmcnt(0)
  v_smfmac_f32_16x16x64_bf16 v[20:23], v[12:15], v[128:135], v74
  v_smfmac_f32_16x16x64_bf16 v[24:27], v[12:15], v[136:143], v74
  v_smfmac_f32_16x16x64_bf16 v[28:31], v[12:15], v[224:231], v74
  v_smfmac_f32_16x16x64_bf16 v[32:35], v[12:15], v[232:239], v74
  ds_read_b128 v[4:7], v76 offset:8704
  s_waitcnt lgkmcnt(0)
  v_smfmac_f32_16x16x64_bf16 v[20:23], v[4:7], v[144:151], v74
  v_smfmac_f32_16x16x64_bf16 v[24:27], v[4:7], v[152:159], v74
  ds_read_b128 v[60:63], v76 offset:61440
  ds_read_b128 v[64:67], v76 offset:62464
  s_waitcnt lgkmcnt(0)
  v_smfmac_f32_16x16x64_bf16 v[28:31], v[4:7], v[60:67], v74
  ds_read_b128 v[60:63], v76 offset:63488
  ds_read_b128 v[64:67], v76 offset:64512
  s_waitcnt lgkmcnt(0)
  v_smfmac_f32_16x16x64_bf16 v[32:35], v[4:7], v[60:67], v74
  ds_read_b128 v[8:11], v76 offset:9728
  s_waitcnt lgkmcnt(0)
  v_smfmac_f32_16x16x64_bf16 v[20:23], v[8:11], v[160:167], v74
  v_smfmac_f32_16x16x64_bf16 v[24:27], v[8:11], v[168:175], v74
  ds_read_b128 v[60:63], v75 offset:28672
  ds_read_b128 v[64:67], v75 offset:29696
  s_waitcnt lgkmcnt(0)
  v_smfmac_f32_16x16x64_bf16 v[28:31], v[8:11], v[60:67], v74
  ds_read_b128 v[60:63], v75 offset:30720
  ds_read_b128 v[64:67], v75 offset:31744
  s_waitcnt lgkmcnt(0)
  v_smfmac_f32_16x16x64_bf16 v[32:35], v[8:11], v[60:67], v74
  ds_read_b128 v[16:19], v76 offset:10752
  ds_read_b128 v[60:63], v75 offset:12288
  ds_read_b128 v[64:67], v75 offset:13312
  s_waitcnt lgkmcnt(0)
  v_smfmac_f32_16x16x64_bf16 v[20:23], v[16:19], v[60:67], v74
  ds_read_b128 v[60:63], v75 offset:14336
  ds_read_b128 v[64:67], v75 offset:15360
  s_waitcnt lgkmcnt(0)
  v_smfmac_f32_16x16x64_bf16 v[24:27], v[16:19], v[60:67], v74
  v_smfmac_f32_16x16x64_bf16 v[28:31], v[16:19], v[240:247], v74
  v_smfmac_f32_16x16x64_bf16 v[32:35], v[16:19], v[248:255], v74
  ds_read_b128 v[0:3], v76 offset:11776
  s_waitcnt lgkmcnt(0)
  v_smfmac_f32_16x16x64_bf16 v[20:23], v[0:3], v[176:183], v74
  v_smfmac_f32_16x16x64_bf16 v[24:27], v[0:3], v[184:191], v74
  v_smfmac_f32_16x16x64_bf16 v[28:31], v[0:3], a[0:7], v74
  v_smfmac_f32_16x16x64_bf16 v[32:35], v[0:3], a[8:15], v74
  ds_read_b128 v[12:15], v76 offset:12800
  s_waitcnt lgkmcnt(0)
  v_smfmac_f32_16x16x64_bf16 v[20:23], v[12:15], v[192:199], v74
  v_smfmac_f32_16x16x64_bf16 v[24:27], v[12:15], v[200:207], v74
  v_smfmac_f32_16x16x64_bf16 v[28:31], v[12:15], a[16:23], v74
  v_smfmac_f32_16x16x64_bf16 v[32:35], v[12:15], a[24:31], v74
  v_add_f32 v20, v20, v22
  v_add_f32 v21, v21, v23
  v_add_f32 v24, v24, v26
  v_cvt_pk_bf16_f32 v22, v20, v24
  ds_write_b32 v79, v22 offset:0
  v_add_f32 v25, v25, v27
  v_cvt_pk_bf16_f32 v23, v21, v25
  ds_write_b32 v79, v23 offset:576
  v_add_f32 v28, v28, v30
  v_add_f32 v29, v29, v31
  s_waitcnt lgkmcnt(0)
  s_nop 1
  s_branch Cs3_recok
Cs3_mx:
  s_waitcnt lgkmcnt(0)
  s_barrier
  buffer_load_dwordx4 v[0:3], v76, s[8:11], s58 offen offset:0 sc1
  ds_read_b128 v[20:23], v77 offset:0
  ds_read_b128 v[28:31], v77 offset:256
  buffer_load_dwordx4 v[4:7], v76, s[8:11], s58 offen offset:1024 sc1
  ds_read_b128 v[24:27], v77 offset:128
  ds_read_b128 v[32:35], v77 offset:384
  s_waitcnt vmcnt(1) lgkmcnt(3)
  v_mfma_f32_16x16x32_bf16 v[8:11], v[0:3], v[20:23], 0
  s_waitcnt vmcnt(0) lgkmcnt(1)
  v_mfma_f32_16x16x32_bf16 v[8:11], v[4:7], v[24:27], v[8:11]
  v_mfma_f32_16x16x32_bf16 v[12:15], v[28:31], v[20:23], 0
  s_waitcnt lgkmcnt(0)
  v_mfma_f32_16x16x32_bf16 v[12:15], v[32:35], v[24:27], v[12:15]
  v_add_f32_dpp v8, v10, v8 quad_perm:[2,3,0,1] row_mask:0xf bank_mask:0xf
  v_add_f32_dpp v9, v11, v9 quad_perm:[2,3,0,1] row_mask:0xf bank_mask:0xf
  s_nop 0
  v_mov_b32_dpp v8, v8 quad_perm:[0,1,0,1] row_mask:0xf bank_mask:0xf
  v_mov_b32_dpp v9, v9 quad_perm:[0,1,0,1] row_mask:0xf bank_mask:0xf
  s_nop 1
  v_add_f32_dpp v12, v14, v12 quad_perm:[2,3,0,1] row_mask:0xf bank_mask:0xf
  v_add_f32_dpp v13, v15, v13 quad_perm:[2,3,0,1] row_mask:0xf bank_mask:0xf
  s_nop 0
  v_mov_b32_dpp v12, v12 quad_perm:[0,1,0,1] row_mask:0xf bank_mask:0xf
  v_mov_b32_dpp v13, v13 quad_perm:[0,1,0,1] row_mask:0xf bank_mask:0xf
  v_mul_f32 v12, s69, v12
  ds_write_b32 v78, v8 offset:8716
  v_mul_f32 v13, s69, v13
  ds_write_b32 v78, v9 offset:8780
  s_waitcnt lgkmcnt(0)
  s_barrier
  ds_read_b128 v[36:39], v78 offset:8704
  ds_read_b128 v[40:43], v78 offset:8768
  s_waitcnt lgkmcnt(0)
  s_barrier
  v_max_f32 v16, v36, v37
  v_max3_f32 v16, v16, v38, v39
  v_max3_f32 v16, v16, v40, v41
  v_max3_f32 v16, v16, v42, v43
  v_max3_f32 v16, v16, v12, v13
  v_mov_b32 v17, v16
  s_nop 1
  v_permlane16_swap_b32 v16, v17
  v_max_f32 v16, v16, v17
  v_mov_b32 v17, v16
  s_nop 1
  v_permlane32_swap_b32 v16, v17
  v_max_f32 v16, v16, v17
  v_sub_f32 v36, v36, v16
  v_sub_f32 v37, v37, v16
  v_sub_f32 v38, v38, v16
  v_sub_f32 v39, v39, v16
  v_sub_f32 v40, v40, v16
  v_sub_f32 v41, v41, v16
  v_sub_f32 v42, v42, v16
  v_sub_f32 v43, v43, v16
  v_sub_f32 v12, v12, v16
  v_sub_f32 v13, v13, v16
  v_exp_f32 v36, v36
  v_exp_f32 v37, v37
  v_exp_f32 v38, v38
  v_exp_f32 v39, v39
  v_exp_f32 v40, v40
  v_exp_f32 v41, v41
  v_exp_f32 v42, v42
  v_exp_f32 v43, v43
  v_exp_f32 v12, v12
  v_exp_f32 v13, v13
  v_cvt_pk_bf16_f32 v32, v36, v40
  v_cvt_pk_bf16_f32 v33, v37, v41
  v_cvt_pk_bf16_f32 v34, v38, v42
  v_cvt_pk_bf16_f32 v35, v39, v43
  v_cvt_pk_bf16_f32 v28, v12, v13
  v_cvt_pk_bf16_f32 v31, v12, v13
  v_mov_b32 v29, 0
  v_mov_b32 v30, 0
  v_mov_b32 v68, 0x3f803f80
  v_mov_b32 v69, 0x3f803f80
  v_mov_b32 v70, 0x3f803f80
  v_mov_b32 v71, 0x3f803f80
  s_nop 1
  v_mfma_f32_16x16x32_bf16 v[8:11], v[32:35], v[68:71], 0
  v_mfma_f32_16x16x32_bf16 v[0:3], v[32:35], v[52:55], 0
  v_mfma_f32_16x16x32_bf16 v[4:7], v[32:35], v[56:59], 0
  v_mfma_f32_16x16x16_bf16 v[8:11], v[28:29], v[68:69], v[8:11]
  v_mfma_f32_16x16x16_bf16 v[0:3], v[28:29], v[72:73], v[0:3]
  v_mfma_f32_16x16x16_bf16 v[4:7], v[30:31], v[72:73], v[4:7]
  ds_read_b128 v[68:71], v76 offset:13824
  v_rcp_f32 v10, v8
  v_rcp_f32 v11, v9
  v_mul_f32 v0, v10, v0
  v_mul_f32 v1, v11, v1
  s_nop 0
  v_mul_f32 v4, v10, v4
  v_mul_f32 v5, v11, v5
  v_cvt_pk_bf16_f32 v2, v0, v4
  ds_write_b32 v79, v2 offset:8704
  v_cvt_pk_bf16_f32 v3, v1, v5
  ds_write_b32 v79, v3 offset:9280
  v_mov_b64 v[16:17], 0
  v_mov_b64 v[18:19], 0
  v_mov_b64 v[20:21], 0
  v_mov_b64 v[22:23], 0
  v_mov_b64 v[24:25], 0
  v_mov_b64 v[26:27], 0
  s_branch Cs3_mxok
Cs3_last:
  ds_read_b128 v[0:3], v76 offset:4608
  ds_read_b128 v[12:15], v76 offset:7680
  ds_read_b128 v[44:47], v76 offset:28672
  ds_read_b128 v[48:51], v76 offset:29696
  s_nop 5
  v_mov_b64 v[20:21], 0
  v_mov_b64 v[22:23], 0
  v_mov_b64 v[24:25], 0
  v_mov_b64 v[26:27], 0
  v_smfmac_f32_16x16x64_bf16 v[28:31], v[4:7], v[36:43], v74
  ds_read_b128 v[36:39], v76 offset:30720
  ds_read_b128 v[40:43], v76 offset:31744
  v_smfmac_f32_16x16x64_bf16 v[32:35], v[4:7], v[60:67], v74
  s_waitcnt lgkmcnt(5)
  v_smfmac_f32_16x16x64_bf16 v[20:23], v[0:3], a[32:39], v74
  ds_read_b128 v[60:63], v76 offset:61440
  ds_read_b128 v[64:67], v76 offset:62464
  v_smfmac_f32_16x16x64_bf16 v[24:27], v[0:3], a[40:47], v74
  s_waitcnt lgkmcnt(4)
  v_smfmac_f32_16x16x64_bf16 v[20:23], v[4:7], a[48:55], v74
  buffer_store_dwordx4 v[16:19], v76, s[8:11], s68 offen sc1
  v_smfmac_f32_16x16x64_bf16 v[24:27], v[4:7], a[56:63], v74
  v_smfmac_f32_16x16x64_bf16 v[28:31], v[0:3], v[44:51], v74
  s_waitcnt lgkmcnt(2)
  v_smfmac_f32_16x16x64_bf16 v[20:23], v[8:11], a[64:71], v74
  ds_read_b128 v[44:47], v76 offset:63488
  ds_read_b128 v[48:51], v76 offset:64512
  v_smfmac_f32_16x16x64_bf16 v[24:27], v[8:11], a[72:79], v74
  v_smfmac_f32_16x16x64_bf16 v[32:35], v[0:3], v[36:43], v74
  v_smfmac_f32_16x16x64_bf16 v[28:31], v[8:11], v[208:215], v74
  ds_read_b128 v[36:39], v75 offset:28672
  ds_read_b128 v[40:43], v75 offset:29696
  v_smfmac_f32_16x16x64_bf16 v[32:35], v[8:11], v[216:223], v74
  v_smfmac_f32_16x16x64_bf16 v[20:23], v[12:15], a[80:87], v74
  v_smfmac_f32_16x16x64_bf16 v[24:27], v[12:15], a[88:95], v74
  v_smfmac_f32_16x16x64_bf16 v[28:31], v[12:15], v[224:231], v74
  v_smfmac_f32_16x16x64_bf16 v[32:35], v[12:15], v[232:239], v74
  s_waitcnt vmcnt(1)
  s_barrier
Cs3_lastr:
  ds_read_b128 v[4:7], v76 offset:8704
  ds_read_b128 v[8:11], v76 offset:9728
  ds_read_b128 v[16:19], v76 offset:10752
  ds_read_b128 v[0:3], v76 offset:11776
  ds_read_b128 v[12:15], v76 offset:12800
  s_waitcnt lgkmcnt(1)
  v_max3_u32 v72, v0, v1, v2
  v_max3_u32 v72, v72, v3, v4
  v_max3_u32 v72, v72, v5, v6
  v_max3_u32 v72, v72, v7, v8
  v_max3_u32 v72, v72, v9, v10
  s_waitcnt lgkmcnt(0)
  v_max3_u32 v72, v72, v11, v12
  v_max3_u32 v72, v72, v13, v14
  v_max3_u32 v72, v72, v15, v16
  v_max3_u32 v72, v72, v17, v18
  v_max_u32 v72, v72, v19
  v_cmp_eq_u32 vcc, -1, v72
  s_cbranch_vccnz Cs3_lastp
Cs3_lastg:
  v_smfmac_f32_16x16x64_bf16 v[28:31], v[4:7], v[60:67], v74
  ds_read_b128 v[60:63], v75 offset:30720
  ds_read_b128 v[64:67], v75 offset:31744
  v_smfmac_f32_16x16x64_bf16 v[32:35], v[4:7], v[44:51], v74
  v_smfmac_f32_16x16x64_bf16 v[28:31], v[8:11], v[36:43], v74
  v_smfmac_f32_16x16x64_bf16 v[28:31], v[16:19], v[240:247], v74
  v_smfmac_f32_16x16x64_bf16 v[28:31], v[0:3], a[0:7], v74
  v_smfmac_f32_16x16x64_bf16 v[28:31], v[12:15], a[16:23], v74
  v_smfmac_f32_16x16x64_bf16 v[32:35], v[16:19], v[248:255], v74
  v_smfmac_f32_16x16x64_bf16 v[32:35], v[0:3], a[8:15], v74
  s_waitcnt lgkmcnt(0)
  v_smfmac_f32_16x16x64_bf16 v[32:35], v[12:15], a[24:31], v74
  v_smfmac_f32_16x16x64_bf16 v[32:35], v[8:11], v[60:67], v74
  v_smfmac_f32_16x16x64_bf16 v[20:23], v[4:7], a[96:103], v74
  v_smfmac_f32_16x16x64_bf16 v[20:23], v[8:11], a[112:119], v74
  v_add_f32 v28, v28, v30
  v_add_f32 v32, v32, v34
  v_cvt_pk_bf16_f32 v30, v28, v32
  v_smfmac_f32_16x16x64_bf16 v[20:23], v[16:19], a[128:135], v74
  ds_write_b32 v79, v30 offset:256
  v_add_f32 v29, v29, v31
  v_add_f32 v33, v33, v35
  v_cvt_pk_bf16_f32 v31, v29, v33
  v_smfmac_f32_16x16x64_bf16 v[20:23], v[0:3], a[144:151], v74
  ds_write_b32 v79, v31 offset:832
  v_smfmac_f32_16x16x64_bf16 v[20:23], v[12:15], a[160:167], v74
  v_smfmac_f32_16x16x64_bf16 v[24:27], v[4:7], a[104:111], v74
  v_smfmac_f32_16x16x64_bf16 v[24:27], v[8:11], a[120:127], v74
  v_smfmac_f32_16x16x64_bf16 v[24:27], v[16:19], a[136:143], v74
  s_waitcnt lgkmcnt(0)
  s_barrier
  ds_read_b64 v[52:53], v77 offset:392
  v_add_f32 v20, v20, v22
  v_smfmac_f32_16x16x64_bf16 v[24:27], v[0:3], a[152:159], v74
  v_add_f32 v21, v21, v23
  v_smfmac_f32_16x16x64_bf16 v[24:27], v[12:15], a[168:175], v74
  v_cvt_pk_bf16_f32 v54, v20, v21
  s_add_u32 s68, s68, 655360
  s_nop 3
  v_add_f32 v24, v24, v26
  v_add_f32 v25, v25, v27
  v_cvt_pk_bf16_f32 v55, v24, v25
  s_waitcnt lgkmcnt(0)
  buffer_store_dwordx4 v[52:55], v76, s[8:11], s68 offen sc1
  s_branch Cs3_done
Cs3_lastp:
  s_add_u32 s72, s72, 2
  s_cmp_ge_u32 s72, 131072
  s_cbranch_scc1 Cs3_lastg
  s_barrier
  buffer_load_dwordx4 v76, s[8:11], s85 offen offset:0 sc1 lds
  buffer_load_dwordx4 v76, s[8:11], s85 offen offset:1024 sc1 lds
  s_waitcnt vmcnt(0)
  s_barrier
  s_branch Cs3_lastr
Cs3_done:
  s_branch L_cexit
L_conf:
  s_nop 11
  s_waitcnt vmcnt(0) lgkmcnt(0)
  s_barrier
  s_cmp_eq_u32 s52, 0
  s_cbranch_scc0 L_cf2
  s_mov_b64 exec, 1
  s_lshl_b32 s57, s2, 2
  v_mov_b32 v1, 0
L_cf0:
  s_cmp_eq_u32 s54, -1
  s_cbranch_scc1 L_cf1
  s_mov_b32 s55, s54
  s_lshr_b64 s[54:55], s[54:55], s0
  s_ff0_i32_b32 s56, s54
  s_add_u32 s0, s0, s56
  s_and_b32 s0, s0, 31
  s_lshl_b32 s56, 1, s0
  v_mov_b32 v35, s56
  buffer_atomic_or v35, v1, s[12:15], s57 offen sc0
  s_waitcnt vmcnt(0)
  v_readfirstlane_b32 s54, v35
  s_nop 0
  s_bitcmp1_b32 s54, s0
  s_cbranch_scc1 L_cf0
  v_mov_b32 v35, s0
  s_branch L_cf3
L_cf1:
  v_mov_b32 v35, 1
  buffer_atomic_add v35, v1, s[12:15], 0 offen offset:40 sc0
  s_waitcnt vmcnt(0)
  v_add_u32 v35, 32, v35
L_cf3:
  ds_write_b32 v33, v35
  s_mov_b64 exec, -1
  s_waitcnt lgkmcnt(0)
L_cf2:
  s_barrier
  ds_read_b32 v32, v33
  s_waitcnt lgkmcnt(0)
  v_readfirstlane_b32 s0, v32
  v_mbcnt_lo_u32_b32 v0, -1, 0
  v_mbcnt_hi_u32_b32 v0, -1, v0
  s_mov_b32 s1, 1
  s_cmp_lt_u32 s0, 32
  s_cbranch_scc1 L_role
  s_sub_u32 s53, s0, 32
  s_mov_b32 s57, 0
L_sur:
  s_load_dwordx16 s[60:75], s[12:13], 0 glc
  s_add_u32 s57, s57, 1
  s_waitcnt lgkmcnt(0)
  s_mov_b32 s55, s70
  s_bcnt1_i32_b32 s56, s60
  s_add_u32 s55, s55, s56
  s_bcnt1_i32_b32 s56, s61
  s_add_u32 s55, s55, s56
  s_bcnt1_i32_b32 s56, s62
  s_add_u32 s55, s55, s56
  s_bcnt1_i32_b32 s56, s63
  s_add_u32 s55, s55, s56
  s_bcnt1_i32_b32 s56, s64
  s_add_u32 s55, s55, s56
  s_bcnt1_i32_b32 s56, s65
  s_add_u32 s55, s55, s56
  s_bcnt1_i32_b32 s56, s66
  s_add_u32 s55, s55, s56
  s_bcnt1_i32_b32 s56, s67
  s_add_u32 s55, s55, s56
  s_cmp_ge_u32 s57, 131072
  s_cbranch_scc1 L_end
  s_cmp_lt_u32 s55, 256
  s_cbranch_scc1 L_sur
  s_mov_b32 s2, 0
  s_mov_b32 s54, s60
  s_bcnt0_i32_b32 s56, s54
  s_cmp_lt_u32 s53, s56
  s_cbranch_scc1 L_sur2
  s_sub_u32 s53, s53, s56
  s_mov_b32 s2, 1
  s_mov_b32 s54, s61
  s_bcnt0_i32_b32 s56, s54
  s_cmp_lt_u32 s53, s56
  s_cbranch_scc1 L_sur2
  s_sub_u32 s53, s53, s56
  s_mov_b32 s2, 2
  s_mov_b32 s54, s62
  s_bcnt0_i32_b32 s56, s54
  s_cmp_lt_u32 s53, s56
  s_cbranch_scc1 L_sur2
  s_sub_u32 s53, s53, s56
  s_mov_b32 s2, 3
  s_mov_b32 s54, s63
  s_bcnt0_i32_b32 s56, s54
  s_cmp_lt_u32 s53, s56
  s_cbranch_scc1 L_sur2
  s_sub_u32 s53, s53, s56
  s_mov_b32 s2, 4
  s_mov_b32 s54, s64
  s_bcnt0_i32_b32 s56, s54
  s_cmp_lt_u32 s53, s56
  s_cbranch_scc1 L_sur2
  s_sub_u32 s53, s53, s56
  s_mov_b32 s2, 5
  s_mov_b32 s54, s65
  s_bcnt0_i32_b32 s56, s54
  s_cmp_lt_u32 s53, s56
  s_cbranch_scc1 L_sur2
  s_sub_u32 s53, s53, s56
  s_mov_b32 s2, 6
  s_mov_b32 s54, s66
  s_bcnt0_i32_b32 s56, s54
  s_cmp_lt_u32 s53, s56
  s_cbranch_scc1 L_sur2
  s_sub_u32 s53, s53, s56
  s_mov_b32 s2, 7
  s_mov_b32 s54, s67
  s_bcnt0_i32_b32 s56, s54
  s_cmp_lt_u32 s53, s56
  s_cbranch_scc1 L_sur2
  s_sub_u32 s53, s53, s56
  s_branch L_end
L_sur2:
  s_ff0_i32_b32 s0, s54
  s_bitset1_b32 s54, s0
  s_sub_u32 s53, s53, 1
  s_cbranch_scc0 L_sur2
  s_branch L_role
L_worker:
  s_lshl_b32 s54, s2, 2
  s_lshr_b32 s54, 1412567136, s54
  s_and_b32 s54, s54, 7
  s_lshl_b32 s54, s54, 5
  s_add_u32 s53, s53, s54
  s_getpc_b64 s[80:81]
L_pc_2:
  s_and_b32 s55, s0, 1
  s_lshl_b32 s55, s55, 2
  s_add_u32 s55, s55, s52
  s_lshl_b32 s55, s55, 13
  v_and_b32 v199, 63, v0
  v_lshl_add_u32 v199, v199, 7, s55
  s_sub_u32 s82, s80, (L_pc_2 - L_w0)
  s_subb_u32 s83, s81, 0
  v_min_u32 v198, (L_w4 - L_w0), v199
  global_load_dword v196, v198, s[82:83]
  v_min_u32 v199, (L_end - L_pc_2), v199
  global_load_dword v196, v199, s[80:81]
  v_and_b32 v200, 63, v0
  v_lshlrev_b32 v201, 4, v200
  v_lshrrev_b32 v211, 3, v200
  s_lshl_b32 s54, s52, 3
  v_add_u32 v211, s54, v211
  v_bfe_u32 v212, v211, 1, 3
  v_and_b32 v213, 7, v200
  v_xor_b32 v212, v212, v213
  v_mul_u32_u24 v211, 1152, v211
  v_lshl_add_u32 v202, v212, 4, v211
  s_mul_i32 s67, s52, 9216
  v_and_b32 v211, 31, v200
  v_lshrrev_b32 v212, 3, v211
  v_mul_u32_u24 v212, 9216, v212
  v_and_b32 v213, 7, v211
  v_lshl_add_u32 v212, v213, 7, v212
  v_bfe_u32 v213, v211, 1, 3
  v_lshrrev_b32 v214, 5, v200
  v_xor_b32 v213, v213, v214
  v_lshl_add_u32 v203, v213, 4, v212
  v_xor_b32 v204, 32, v203
  v_xor_b32 v205, 64, v203
  v_xor_b32 v206, 0x60, v203
  v_bfe_u32 v211, v200, 2, 2
  v_lshl_add_u32 v212, v214, 3, v211
  v_lshlrev_b32 v212, 8, v212
  v_xor_b32 v211, s52, v211
  v_lshl_add_u32 v212, v211, 6, v212
  v_bfe_u32 v213, v200, 4, 1
  v_and_b32 v211, 3, v200
  v_lshl_add_u32 v210, v213, 5, v212
  v_lshl_add_u32 v210, v211, 3, v210
  v_lshl_add_u32 v209, v213, 4, v212
  v_and_b32 v213, 1, v211
  v_lshl_add_u32 v209, v213, 3, v209
  v_lshrrev_b32 v213, 1, v211
  v_lshl_add_u32 v209, v213, 5, v209
  s_mov_b32 s65, 0
  s_mul_i32 s58, s53, 9363
  s_lshr_b32 s58, s58, 16
  s_mul_i32 s54, s58, 7
  s_sub_u32 s59, s53, s54
  s_mul_i32 s60, s59, 36864
  s_add_u32 m0, s67, 0
  s_nop 0
  buffer_load_dwordx4 v202, s[4:7], s60 offen offset:0 lds
  s_add_u32 m0, s67, 896
  s_nop 0
  buffer_load_dwordx4 v202, s[4:7], s60 offen offset:128 lds
  s_add_u32 m0, s67, 1792
  s_nop 0
  buffer_load_dwordx4 v202, s[4:7], s60 offen offset:256 lds
  s_add_u32 m0, s67, 2688
  s_nop 0
  buffer_load_dwordx4 v202, s[4:7], s60 offen offset:384 lds
  s_add_u32 m0, s67, 3584
  s_nop 0
  buffer_load_dwordx4 v202, s[4:7], s60 offen offset:512 lds
  s_add_u32 m0, s67, 4480
  s_nop 0
  buffer_load_dwordx4 v202, s[4:7], s60 offen offset:640 lds
  s_add_u32 m0, s67, 5376
  s_nop 0
  buffer_load_dwordx4 v202, s[4:7], s60 offen offset:768 lds
  s_add_u32 m0, s67, 6272
  s_nop 0
  buffer_load_dwordx4 v202, s[4:7], s60 offen offset:896 lds
  s_add_u32 m0, s67, 7168
  s_nop 0
  buffer_load_dwordx4 v202, s[4:7], s60 offen offset:1024 lds
  v_lshrrev_b32 v211, 4, v200
  v_lshlrev_b32 v212, 2, v211
  v_and_b32 v213, 15, v200
  v_xor_b32 v212, v212, v213
  v_lshlrev_b32 v212, 4, v212
  v_lshl_add_u32 v207, v211, 13, v212
  s_lshl_b32 s62, s58, 8
  s_lshl_b32 s54, s52, 15
  s_add_u32 s62, s62, s54
  s_lshl_b32 s61, s52, 10
  s_add_u32 s61, s61, 36864
  s_add_u32 m0, s61, 0
  s_add_u32 s54, s62, 0
  buffer_load_dwordx4 v207, s[20:23], s54 offen lds
  s_add_u32 m0, s61, 4096
  s_add_u32 s54, s62, 131072
  buffer_load_dwordx4 v207, s[20:23], s54 offen lds
  s_add_u32 m0, s61, 8192
  s_add_u32 s54, s62, 262144
  buffer_load_dwordx4 v207, s[20:23], s54 offen lds
  s_add_u32 m0, s61, 12288
  s_add_u32 s54, s62, 393216
  buffer_load_dwordx4 v207, s[20:23], s54 offen lds
  s_add_u32 m0, s61, 16384
  s_add_u32 s54, s62, 0
  buffer_load_dwordx4 v207, s[24:27], s54 offen lds
  s_add_u32 m0, s61, 20480
  s_add_u32 s54, s62, 131072
  buffer_load_dwordx4 v207, s[24:27], s54 offen lds
  s_add_u32 m0, s61, 24576
  s_add_u32 s54, s62, 262144
  buffer_load_dwordx4 v207, s[24:27], s54 offen lds
  s_add_u32 m0, s61, 28672
  s_add_u32 s54, s62, 393216
  buffer_load_dwordx4 v207, s[24:27], s54 offen lds
  s_add_u32 m0, s61, 32768
  s_add_u32 s54, s62, 524288
  buffer_load_dwordx4 v207, s[20:23], s54 offen lds
  s_add_u32 m0, s61, 36864
  s_add_u32 s54, s62, 655360
  buffer_load_dwordx4 v207, s[20:23], s54 offen lds
  s_add_u32 m0, s61, 40960
  s_add_u32 s54, s62, 786432
  buffer_load_dwordx4 v207, s[20:23], s54 offen lds
  s_add_u32 m0, s61, 45056
  s_add_u32 s54, s62, 917504
  buffer_load_dwordx4 v207, s[20:23], s54 offen lds
  s_add_u32 m0, s61, 49152
  s_add_u32 s54, s62, 524288
  buffer_load_dwordx4 v207, s[24:27], s54 offen lds
  s_add_u32 m0, s61, 53248
  s_add_u32 s54, s62, 655360
  buffer_load_dwordx4 v207, s[24:27], s54 offen lds
  s_add_u32 m0, s61, 57344
  s_add_u32 s54, s62, 786432
  buffer_load_dwordx4 v207, s[24:27], s54 offen lds
  s_add_u32 m0, s61, 61440
  s_add_u32 s54, s62, 917504
  buffer_load_dwordx4 v207, s[24:27], s54 offen lds
  s_add_u32 m0, s61, 65536
  s_add_u32 s54, s62, 1048576
  buffer_load_dwordx4 v207, s[20:23], s54 offen lds
  s_add_u32 m0, s61, 69632
  s_add_u32 s54, s62, 1179648
  buffer_load_dwordx4 v207, s[20:23], s54 offen lds
  s_add_u32 m0, s61, 73728
  s_add_u32 s54, s62, 1310720
  buffer_load_dwordx4 v207, s[20:23], s54 offen lds
  s_add_u32 m0, s61, 77824
  s_add_u32 s54, s62, 1441792
  buffer_load_dwordx4 v207, s[20:23], s54 offen lds
  s_add_u32 m0, s61, 81920
  s_add_u32 s54, s62, 1048576
  buffer_load_dwordx4 v207, s[24:27], s54 offen lds
  s_add_u32 m0, s61, 86016
  s_add_u32 s54, s62, 1179648
  buffer_load_dwordx4 v207, s[24:27], s54 offen lds
  s_add_u32 m0, s61, 90112
  s_add_u32 s54, s62, 1310720
  buffer_load_dwordx4 v207, s[24:27], s54 offen lds
  s_add_u32 m0, s61, 94208
  s_add_u32 s54, s62, 1441792
  buffer_load_dwordx4 v207, s[24:27], s54 offen lds
  v_bfe_u32 v211, v200, 3, 2
  v_lshlrev_b32 v216, 11, v211
  v_bfe_u32 v211, v200, 1, 2
  v_lshl_add_u32 v216, v211, 6, v216
  v_lshrrev_b32 v212, 5, v200
  v_lshl_add_u32 v216, v212, 5, v216
  v_and_b32 v211, 1, v200
  v_lshl_add_u32 v216, v211, 4, v216
  v_bfe_u32 v211, v200, 4, 1
  v_lshlrev_b32 v217, 10, v211
  v_lshl_add_u32 v217, v212, 9, v217
  v_and_b32 v211, 15, v200
  v_lshl_add_u32 v217, v211, 4, v217
  s_lshl_b32 s54, s52, 11
  s_add_u32 s54, s54, 8192
  v_add_u32 v217, s54, v217
  s_waitcnt vmcnt(20) lgkmcnt(0)
  s_barrier
  s_add_u32 m0, s61, 98304
  s_add_u32 s54, s62, 1572864
  buffer_load_dwordx4 v207, s[20:23], s54 offen lds
  s_add_u32 m0, s61, 102400
  s_add_u32 s54, s62, 1703936
  buffer_load_dwordx4 v207, s[20:23], s54 offen lds
  s_add_u32 m0, s61, 106496
  s_add_u32 s54, s62, 1835008
  buffer_load_dwordx4 v207, s[20:23], s54 offen lds
  s_add_u32 m0, s61, 110592
  s_add_u32 s54, s62, 1966080
  buffer_load_dwordx4 v207, s[20:23], s54 offen lds
  v_add_u32 v215, 36864, v209
  ds_read_b64_tr_b16 a[0:1], v215 offset:0
  ds_read_b64_tr_b16 a[2:3], v215 offset:1024
  ds_read_b64_tr_b16 a[4:5], v215 offset:4096
  ds_read_b64_tr_b16 a[6:7], v215 offset:5120
  ds_read_b64_tr_b16 a[8:9], v215 offset:8192
  ds_read_b64_tr_b16 a[10:11], v215 offset:9216
  ds_read_b64_tr_b16 a[12:13], v215 offset:12288
  ds_read_b64_tr_b16 a[14:15], v215 offset:13312
  s_waitcnt vmcnt(20) lgkmcnt(0)
  s_barrier
  s_add_u32 m0, s61, 0
  s_add_u32 s54, s62, 1572864
  buffer_load_dwordx4 v207, s[24:27], s54 offen lds
  s_add_u32 m0, s61, 4096
  s_add_u32 s54, s62, 1703936
  buffer_load_dwordx4 v207, s[24:27], s54 offen lds
  s_add_u32 m0, s61, 8192
  s_add_u32 s54, s62, 1835008
  buffer_load_dwordx4 v207, s[24:27], s54 offen lds
  s_add_u32 m0, s61, 12288
  s_add_u32 s54, s62, 1966080
  buffer_load_dwordx4 v207, s[24:27], s54 offen lds
  v_add_u32 v215, 53248, v210
  ds_read_b64_tr_b16 a[144:145], v215 offset:0
  ds_read_b64_tr_b16 a[146:147], v215 offset:1024
  ds_read_b64_tr_b16 a[148:149], v215 offset:4096
  ds_read_b64_tr_b16 a[150:151], v215 offset:5120
  ds_read_b64_tr_b16 a[152:153], v215 offset:8192
  ds_read_b64_tr_b16 a[154:155], v215 offset:9216
  ds_read_b64_tr_b16 a[156:157], v215 offset:12288
  ds_read_b64_tr_b16 a[158:159], v215 offset:13312
  s_waitcnt vmcnt(20) lgkmcnt(0)
  s_barrier
  s_add_u32 m0, s61, 16384
  s_add_u32 s54, s62, 2097152
  buffer_load_dwordx4 v207, s[20:23], s54 offen lds
  s_add_u32 m0, s61, 20480
  s_add_u32 s54, s62, 2228224
  buffer_load_dwordx4 v207, s[20:23], s54 offen lds
  s_add_u32 m0, s61, 24576
  s_add_u32 s54, s62, 2359296
  buffer_load_dwordx4 v207, s[20:23], s54 offen lds
  s_add_u32 m0, s61, 28672
  s_add_u32 s54, s62, 2490368
  buffer_load_dwordx4 v207, s[20:23], s54 offen lds
  v_add_u32 v215, 69632, v209
  ds_read_b64_tr_b16 a[16:17], v215 offset:0
  ds_read_b64_tr_b16 a[18:19], v215 offset:1024
  ds_read_b64_tr_b16 a[20:21], v215 offset:4096
  ds_read_b64_tr_b16 a[22:23], v215 offset:5120
  ds_read_b64_tr_b16 a[24:25], v215 offset:8192
  ds_read_b64_tr_b16 a[26:27], v215 offset:9216
  ds_read_b64_tr_b16 a[28:29], v215 offset:12288
  ds_read_b64_tr_b16 a[30:31], v215 offset:13312
  s_waitcnt vmcnt(20) lgkmcnt(0)
  s_barrier
  s_add_u32 m0, s61, 32768
  s_add_u32 s54, s62, 2097152
  buffer_load_dwordx4 v207, s[24:27], s54 offen lds
  s_add_u32 m0, s61, 36864
  s_add_u32 s54, s62, 2228224
  buffer_load_dwordx4 v207, s[24:27], s54 offen lds
  s_add_u32 m0, s61, 40960
  s_add_u32 s54, s62, 2359296
  buffer_load_dwordx4 v207, s[24:27], s54 offen lds
  s_add_u32 m0, s61, 45056
  s_add_u32 s54, s62, 2490368
  buffer_load_dwordx4 v207, s[24:27], s54 offen lds
  v_add_u32 v215, 86016, v210
  ds_read_b64_tr_b16 a[160:161], v215 offset:0
  ds_read_b64_tr_b16 a[162:163], v215 offset:1024
  ds_read_b64_tr_b16 a[164:165], v215 offset:4096
  ds_read_b64_tr_b16 a[166:167], v215 offset:5120
  ds_read_b64_tr_b16 a[168:169], v215 offset:8192
  ds_read_b64_tr_b16 a[170:171], v215 offset:9216
  ds_read_b64_tr_b16 a[172:173], v215 offset:12288
  ds_read_b64_tr_b16 a[174:175], v215 offset:13312
  s_waitcnt vmcnt(20) lgkmcnt(0)
  s_barrier
  s_add_u32 m0, s61, 49152
  s_add_u32 s54, s62, 2621440
  buffer_load_dwordx4 v207, s[20:23], s54 offen lds
  s_add_u32 m0, s61, 53248
  s_add_u32 s54, s62, 2752512
  buffer_load_dwordx4 v207, s[20:23], s54 offen lds
  s_add_u32 m0, s61, 57344
  s_add_u32 s54, s62, 2883584
  buffer_load_dwordx4 v207, s[20:23], s54 offen lds
  s_add_u32 m0, s61, 61440
  s_add_u32 s54, s62, 3014656
  buffer_load_dwordx4 v207, s[20:23], s54 offen lds
  v_add_u32 v215, 102400, v209
  ds_read_b64_tr_b16 a[32:33], v215 offset:0
  ds_read_b64_tr_b16 a[34:35], v215 offset:1024
  ds_read_b64_tr_b16 a[36:37], v215 offset:4096
  ds_read_b64_tr_b16 a[38:39], v215 offset:5120
  ds_read_b64_tr_b16 a[40:41], v215 offset:8192
  ds_read_b64_tr_b16 a[42:43], v215 offset:9216
  ds_read_b64_tr_b16 a[44:45], v215 offset:12288
  ds_read_b64_tr_b16 a[46:47], v215 offset:13312
  s_waitcnt vmcnt(20) lgkmcnt(0)
  s_barrier
  s_add_u32 m0, s61, 65536
  s_add_u32 s54, s62, 2621440
  buffer_load_dwordx4 v207, s[24:27], s54 offen lds
  s_add_u32 m0, s61, 69632
  s_add_u32 s54, s62, 2752512
  buffer_load_dwordx4 v207, s[24:27], s54 offen lds
  s_add_u32 m0, s61, 73728
  s_add_u32 s54, s62, 2883584
  buffer_load_dwordx4 v207, s[24:27], s54 offen lds
  s_add_u32 m0, s61, 77824
  s_add_u32 s54, s62, 3014656
  buffer_load_dwordx4 v207, s[24:27], s54 offen lds
  v_add_u32 v215, 118784, v210
  ds_read_b64_tr_b16 a[176:177], v215 offset:0
  ds_read_b64_tr_b16 a[178:179], v215 offset:1024
  ds_read_b64_tr_b16 a[180:181], v215 offset:4096
  ds_read_b64_tr_b16 a[182:183], v215 offset:5120
  ds_read_b64_tr_b16 a[184:185], v215 offset:8192
  ds_read_b64_tr_b16 a[186:187], v215 offset:9216
  ds_read_b64_tr_b16 a[188:189], v215 offset:12288
  ds_read_b64_tr_b16 a[190:191], v215 offset:13312
  s_waitcnt vmcnt(20) lgkmcnt(0)
  s_barrier
  s_add_u32 m0, s61, 81920
  s_add_u32 s54, s62, 3145728
  buffer_load_dwordx4 v207, s[20:23], s54 offen lds
  s_add_u32 m0, s61, 86016
  s_add_u32 s54, s62, 3276800
  buffer_load_dwordx4 v207, s[20:23], s54 offen lds
  s_add_u32 m0, s61, 90112
  s_add_u32 s54, s62, 3407872
  buffer_load_dwordx4 v207, s[20:23], s54 offen lds
  s_add_u32 m0, s61, 94208
  s_add_u32 s54, s62, 3538944
  buffer_load_dwordx4 v207, s[20:23], s54 offen lds
  v_add_u32 v215, 135168, v209
  ds_read_b64_tr_b16 a[48:49], v215 offset:0
  ds_read_b64_tr_b16 a[50:51], v215 offset:1024
  ds_read_b64_tr_b16 a[52:53], v215 offset:4096
  ds_read_b64_tr_b16 a[54:55], v215 offset:5120
  ds_read_b64_tr_b16 a[56:57], v215 offset:8192
  ds_read_b64_tr_b16 a[58:59], v215 offset:9216
  ds_read_b64_tr_b16 a[60:61], v215 offset:12288
  ds_read_b64_tr_b16 a[62:63], v215 offset:13312
  s_waitcnt vmcnt(20) lgkmcnt(0)
  s_barrier
  s_add_u32 m0, s61, 98304
  s_add_u32 s54, s62, 3145728
  buffer_load_dwordx4 v207, s[24:27], s54 offen lds
  s_add_u32 m0, s61, 102400
  s_add_u32 s54, s62, 3276800
  buffer_load_dwordx4 v207, s[24:27], s54 offen lds
  s_add_u32 m0, s61, 106496
  s_add_u32 s54, s62, 3407872
  buffer_load_dwordx4 v207, s[24:27], s54 offen lds
  s_add_u32 m0, s61, 110592
  s_add_u32 s54, s62, 3538944
  buffer_load_dwordx4 v207, s[24:27], s54 offen lds
  v_add_u32 v215, 36864, v210
  ds_read_b64_tr_b16 a[192:193], v215 offset:0
  ds_read_b64_tr_b16 a[194:195], v215 offset:1024
  ds_read_b64_tr_b16 a[196:197], v215 offset:4096
  ds_read_b64_tr_b16 a[198:199], v215 offset:5120
  ds_read_b64_tr_b16 a[200:201], v215 offset:8192
  ds_read_b64_tr_b16 a[202:203], v215 offset:9216
  ds_read_b64_tr_b16 a[204:205], v215 offset:12288
  ds_read_b64_tr_b16 a[206:207], v215 offset:13312
  s_waitcnt vmcnt(20) lgkmcnt(0)
  s_barrier
  s_add_u32 m0, s61, 0
  s_add_u32 s54, s62, 3670016
  buffer_load_dwordx4 v207, s[20:23], s54 offen lds
  s_add_u32 m0, s61, 4096
  s_add_u32 s54, s62, 3801088
  buffer_load_dwordx4 v207, s[20:23], s54 offen lds
  s_add_u32 m0, s61, 8192
  s_add_u32 s54, s62, 3932160
  buffer_load_dwordx4 v207, s[20:23], s54 offen lds
  s_add_u32 m0, s61, 12288
  s_add_u32 s54, s62, 4063232
  buffer_load_dwordx4 v207, s[20:23], s54 offen lds
  v_add_u32 v215, 53248, v209
  ds_read_b64_tr_b16 a[64:65], v215 offset:0
  ds_read_b64_tr_b16 a[66:67], v215 offset:1024
  ds_read_b64_tr_b16 a[68:69], v215 offset:4096
  ds_read_b64_tr_b16 a[70:71], v215 offset:5120
  ds_read_b64_tr_b16 a[72:73], v215 offset:8192
  ds_read_b64_tr_b16 a[74:75], v215 offset:9216
  ds_read_b64_tr_b16 a[76:77], v215 offset:12288
  ds_read_b64_tr_b16 a[78:79], v215 offset:13312
  s_waitcnt vmcnt(20) lgkmcnt(0)
  s_barrier
  s_add_u32 m0, s61, 16384
  s_add_u32 s54, s62, 3670016
  buffer_load_dwordx4 v207, s[24:27], s54 offen lds
  s_add_u32 m0, s61, 20480
  s_add_u32 s54, s62, 3801088
  buffer_load_dwordx4 v207, s[24:27], s54 offen lds
  s_add_u32 m0, s61, 24576
  s_add_u32 s54, s62, 3932160
  buffer_load_dwordx4 v207, s[24:27], s54 offen lds
  s_add_u32 m0, s61, 28672
  s_add_u32 s54, s62, 4063232
  buffer_load_dwordx4 v207, s[24:27], s54 offen lds
  v_add_u32 v215, 69632, v210
  ds_read_b64_tr_b16 a[208:209], v215 offset:0
  ds_read_b64_tr_b16 a[210:211], v215 offset:1024
  ds_read_b64_tr_b16 a[212:213], v215 offset:4096
  ds_read_b64_tr_b16 a[214:215], v215 offset:5120
  ds_read_b64_tr_b16 a[216:217], v215 offset:8192
  ds_read_b64_tr_b16 a[218:219], v215 offset:9216
  ds_read_b64_tr_b16 a[220:221], v215 offset:12288
  ds_read_b64_tr_b16 a[222:223], v215 offset:13312
  s_waitcnt vmcnt(20) lgkmcnt(0)
  s_barrier
  s_add_u32 m0, s61, 32768
  s_add_u32 s54, s62, 4194304
  buffer_load_dwordx4 v207, s[20:23], s54 offen lds
  s_add_u32 m0, s61, 36864
  s_add_u32 s54, s62, 4325376
  buffer_load_dwordx4 v207, s[20:23], s54 offen lds
  s_add_u32 m0, s61, 40960
  s_add_u32 s54, s62, 4456448
  buffer_load_dwordx4 v207, s[20:23], s54 offen lds
  s_add_u32 m0, s61, 45056
  s_add_u32 s54, s62, 4587520
  buffer_load_dwordx4 v207, s[20:23], s54 offen lds
  v_add_u32 v215, 86016, v209
  ds_read_b64_tr_b16 a[80:81], v215 offset:0
  ds_read_b64_tr_b16 a[82:83], v215 offset:1024
  ds_read_b64_tr_b16 a[84:85], v215 offset:4096
  ds_read_b64_tr_b16 a[86:87], v215 offset:5120
  ds_read_b64_tr_b16 a[88:89], v215 offset:8192
  ds_read_b64_tr_b16 a[90:91], v215 offset:9216
  ds_read_b64_tr_b16 a[92:93], v215 offset:12288
  ds_read_b64_tr_b16 a[94:95], v215 offset:13312
  s_waitcnt vmcnt(20) lgkmcnt(0)
  s_barrier
  s_add_u32 m0, s61, 49152
  s_add_u32 s54, s62, 4194304
  buffer_load_dwordx4 v207, s[24:27], s54 offen lds
  s_add_u32 m0, s61, 53248
  s_add_u32 s54, s62, 4325376
  buffer_load_dwordx4 v207, s[24:27], s54 offen lds
  s_add_u32 m0, s61, 57344
  s_add_u32 s54, s62, 4456448
  buffer_load_dwordx4 v207, s[24:27], s54 offen lds
  s_add_u32 m0, s61, 61440
  s_add_u32 s54, s62, 4587520
  buffer_load_dwordx4 v207, s[24:27], s54 offen lds
  s_mul_i32 s54, s53, 21120
  s_lshl_b32 s55, s52, 13
  s_add_u32 s54, s54, s55
  s_cmp_eq_u32 s52, 3
  s_cselect_b32 s54, 0x10000000, s54
  v_lshlrev_b32 v211, 3, v201
  buffer_load_dword v196, v211, s[28:31], s54 offen
  v_add_u32 v215, 102400, v210
  ds_read_b64_tr_b16 a[224:225], v215 offset:0
  ds_read_b64_tr_b16 a[226:227], v215 offset:1024
  ds_read_b64_tr_b16 a[228:229], v215 offset:4096
  ds_read_b64_tr_b16 a[230:231], v215 offset:5120
  ds_read_b64_tr_b16 a[232:233], v215 offset:8192
  ds_read_b64_tr_b16 a[234:235], v215 offset:9216
  ds_read_b64_tr_b16 a[236:237], v215 offset:12288
  ds_read_b64_tr_b16 a[238:239], v215 offset:13312
  s_waitcnt vmcnt(21) lgkmcnt(0)
  s_barrier
  s_lshl_b32 s54, s53, 13
  s_lshr_b32 s55, s53, 6
  s_or_b32 s55, s55, s52
  s_cmp_eq_u32 s55, 0
  s_cselect_b32 s54, s54, 0x10000000
  v_lshlrev_b32 v211, 3, v201
  s_add_u32 s54, s54, 3145728
  buffer_load_dword v196, v211, s[16:19], s54 offen
  v_add_u32 v215, 118784, v209
  ds_read_b64_tr_b16 a[96:97], v215 offset:0
  ds_read_b64_tr_b16 a[98:99], v215 offset:1024
  ds_read_b64_tr_b16 a[100:101], v215 offset:4096
  ds_read_b64_tr_b16 a[102:103], v215 offset:5120
  ds_read_b64_tr_b16 a[104:105], v215 offset:8192
  ds_read_b64_tr_b16 a[106:107], v215 offset:9216
  ds_read_b64_tr_b16 a[108:109], v215 offset:12288
  ds_read_b64_tr_b16 a[110:111], v215 offset:13312
  s_waitcnt vmcnt(18) lgkmcnt(0)
  s_barrier
  s_lshl_b32 s55, s2, 2
  s_or_b32 s56, s52, s1
  s_cmp_eq_u32 s56, 0
  s_cselect_b32 s55, s55, 0x1000
  s_lshl_b32 s56, 1, s0
  v_mov_b32 v197, s56
  s_mov_b64 exec, 1
  buffer_atomic_or v197, off, s[12:15], s55 sc0
  s_mov_b64 exec, -1
  v_add_u32 v215, 135168, v210
  ds_read_b64_tr_b16 a[240:241], v215 offset:0
  ds_read_b64_tr_b16 a[242:243], v215 offset:1024
  ds_read_b64_tr_b16 a[244:245], v215 offset:4096
  ds_read_b64_tr_b16 a[246:247], v215 offset:5120
  ds_read_b64_tr_b16 a[248:249], v215 offset:8192
  ds_read_b64_tr_b16 a[250:251], v215 offset:9216
  ds_read_b64_tr_b16 a[252:253], v215 offset:12288
  ds_read_b64_tr_b16 a[254:255], v215 offset:13312
  s_waitcnt vmcnt(15) lgkmcnt(0)
  s_barrier
  v_add_u32 v215, 36864, v209
  ds_read_b64_tr_b16 a[112:113], v215 offset:0
  ds_read_b64_tr_b16 a[114:115], v215 offset:1024
  ds_read_b64_tr_b16 a[116:117], v215 offset:4096
  ds_read_b64_tr_b16 a[118:119], v215 offset:5120
  ds_read_b64_tr_b16 a[120:121], v215 offset:8192
  ds_read_b64_tr_b16 a[122:123], v215 offset:9216
  ds_read_b64_tr_b16 a[124:125], v215 offset:12288
  ds_read_b64_tr_b16 a[126:127], v215 offset:13312
  s_waitcnt vmcnt(11) lgkmcnt(0)
  s_barrier
  v_add_u32 v215, 53248, v210
  ds_read_b64_tr_b16 v[224:225], v215 offset:0
  ds_read_b64_tr_b16 v[226:227], v215 offset:1024
  ds_read_b64_tr_b16 v[228:229], v215 offset:4096
  ds_read_b64_tr_b16 v[230:231], v215 offset:5120
  ds_read_b64_tr_b16 v[232:233], v215 offset:8192
  ds_read_b64_tr_b16 v[234:235], v215 offset:9216
  ds_read_b64_tr_b16 v[236:237], v215 offset:12288
  ds_read_b64_tr_b16 v[238:239], v215 offset:13312
  s_waitcnt vmcnt(7) lgkmcnt(0)
  s_barrier
  v_add_u32 v215, 69632, v209
  ds_read_b64_tr_b16 a[128:129], v215 offset:0
  ds_read_b64_tr_b16 a[130:131], v215 offset:1024
  ds_read_b64_tr_b16 a[132:133], v215 offset:4096
  ds_read_b64_tr_b16 a[134:135], v215 offset:5120
  ds_read_b64_tr_b16 a[136:137], v215 offset:8192
  ds_read_b64_tr_b16 a[138:139], v215 offset:9216
  ds_read_b64_tr_b16 a[140:141], v215 offset:12288
  ds_read_b64_tr_b16 a[142:143], v215 offset:13312
  s_waitcnt vmcnt(3) lgkmcnt(0)
  s_barrier
  v_add_u32 v215, 86016, v210
  ds_read_b64_tr_b16 v[240:241], v215 offset:0
  ds_read_b64_tr_b16 v[242:243], v215 offset:1024
  ds_read_b64_tr_b16 v[244:245], v215 offset:4096
  ds_read_b64_tr_b16 v[246:247], v215 offset:5120
  ds_read_b64_tr_b16 v[248:249], v215 offset:8192
  ds_read_b64_tr_b16 v[250:251], v215 offset:9216
  ds_read_b64_tr_b16 v[252:253], v215 offset:12288
  ds_read_b64_tr_b16 v[254:255], v215 offset:13312
  s_waitcnt lgkmcnt(0)
  s_barrier
  s_mov_b32 s68, 1040356334
  s_lshl_b32 s69, s52, 9
  s_lshl_b32 s70, s58, 2
  s_add_u32 s70, s70, 128
  s_mul_i32 s66, s58, -12288
  s_lshl_b32 s54, s52, 10
  s_add_u32 s66, s66, s54
  s_add_u32 s66, s66, 524288
  v_mov_b32 v64, -1
  v_mov_b32 v65, -1
  v_mov_b32 v66, -1
  v_mov_b32 v67, -1
  s_add_u32 s60, s60, 258048
  ds_read_b128 v[32:35], v203 offset:0
  ds_read_b128 v[36:39], v204 offset:0
  ds_read_b128 v[40:43], v205 offset:0
  s_waitcnt lgkmcnt(2)
  v_mfma_f32_32x32x16_bf16 v[0:15], a[0:3], v[32:35], 0
  ds_read_b128 v[44:47], v206 offset:0
  s_add_u32 m0, s67, 36864
  s_nop 0
  buffer_load_dwordx4 v202, s[4:7], s60 offen offset:0 lds
  v_mfma_f32_32x32x16_bf16 v[16:31], v[32:35], a[144:147], 0
  s_waitcnt lgkmcnt(2)
  v_mfma_f32_32x32x16_bf16 v[0:15], a[4:7], v[36:39], v[0:15]
  ds_read_b128 v[32:35], v203 offset:1024
  s_add_u32 m0, s67, 37760
  s_nop 0
  buffer_load_dwordx4 v202, s[4:7], s60 offen offset:128 lds
  v_mfma_f32_32x32x16_bf16 v[16:31], v[36:39], a[148:151], v[16:31]
  s_waitcnt lgkmcnt(2)
  v_mfma_f32_32x32x16_bf16 v[0:15], a[8:11], v[40:43], v[0:15]
  ds_read_b128 v[36:39], v204 offset:1024
  s_add_u32 m0, s67, 38656
  s_nop 0
  buffer_load_dwordx4 v202, s[4:7], s60 offen offset:256 lds
  v_mfma_f32_32x32x16_bf16 v[16:31], v[40:43], a[152:155], v[16:31]
  s_waitcnt lgkmcnt(2)
  v_mfma_f32_32x32x16_bf16 v[0:15], a[12:15], v[44:47], v[0:15]
  ds_read_b128 v[40:43], v205 offset:1024
  s_add_u32 m0, s67, 39552
  s_nop 0
  buffer_load_dwordx4 v202, s[4:7], s60 offen offset:384 lds
  v_mfma_f32_32x32x16_bf16 v[16:31], v[44:47], a[156:159], v[16:31]
  s_waitcnt lgkmcnt(2)
  v_mfma_f32_32x32x16_bf16 v[0:15], a[16:19], v[32:35], v[0:15]
  ds_read_b128 v[44:47], v206 offset:1024
  s_add_u32 m0, s67, 40448
  s_nop 0
  buffer_load_dwordx4 v202, s[4:7], s60 offen offset:512 lds
  v_mfma_f32_32x32x16_bf16 v[16:31], v[32:35], a[160:163], v[16:31]
  s_waitcnt lgkmcnt(2)
  v_mfma_f32_32x32x16_bf16 v[0:15], a[20:23], v[36:39], v[0:15]
  ds_read_b128 v[32:35], v203 offset:2048
  s_add_u32 m0, s67, 41344
  s_nop 0
  buffer_load_dwordx4 v202, s[4:7], s60 offen offset:640 lds
  v_mfma_f32_32x32x16_bf16 v[16:31], v[36:39], a[164:167], v[16:31]
  s_waitcnt lgkmcnt(2)
  v_mfma_f32_32x32x16_bf16 v[0:15], a[24:27], v[40:43], v[0:15]
  ds_read_b128 v[36:39], v204 offset:2048
  s_add_u32 m0, s67, 42240
  s_nop 0
  buffer_load_dwordx4 v202, s[4:7], s60 offen offset:768 lds
  v_mfma_f32_32x32x16_bf16 v[16:31], v[40:43], a[168:171], v[16:31]
  s_waitcnt lgkmcnt(2)
  v_mfma_f32_32x32x16_bf16 v[0:15], a[28:31], v[44:47], v[0:15]
  ds_read_b128 v[40:43], v205 offset:2048
  s_add_u32 m0, s67, 43136
  s_nop 0
  buffer_load_dwordx4 v202, s[4:7], s60 offen offset:896 lds
  v_mfma_f32_32x32x16_bf16 v[16:31], v[44:47], a[172:175], v[16:31]
  s_waitcnt lgkmcnt(2)
  v_mfma_f32_32x32x16_bf16 v[0:15], a[32:35], v[32:35], v[0:15]
  ds_read_b128 v[44:47], v206 offset:2048
  s_add_u32 m0, s67, 44032
  s_nop 0
  buffer_load_dwordx4 v202, s[4:7], s60 offen offset:1024 lds
  v_mfma_f32_32x32x16_bf16 v[16:31], v[32:35], a[176:179], v[16:31]
  s_waitcnt lgkmcnt(2)
  v_mfma_f32_32x32x16_bf16 v[0:15], a[36:39], v[36:39], v[0:15]
  ds_read_b128 v[32:35], v203 offset:3072
  v_mfma_f32_32x32x16_bf16 v[16:31], v[36:39], a[180:183], v[16:31]
  s_waitcnt lgkmcnt(2)
  v_mfma_f32_32x32x16_bf16 v[0:15], a[40:43], v[40:43], v[0:15]
  ds_read_b128 v[36:39], v204 offset:3072
  v_mfma_f32_32x32x16_bf16 v[16:31], v[40:43], a[184:187], v[16:31]
  s_waitcnt lgkmcnt(2)
  v_mfma_f32_32x32x16_bf16 v[0:15], a[44:47], v[44:47], v[0:15]
  ds_read_b128 v[40:43], v205 offset:3072
  v_mfma_f32_32x32x16_bf16 v[16:31], v[44:47], a[188:191], v[16:31]
  s_waitcnt lgkmcnt(2)
  v_mfma_f32_32x32x16_bf16 v[0:15], a[48:51], v[32:35], v[0:15]
  ds_read_b128 v[44:47], v206 offset:3072
  v_mfma_f32_32x32x16_bf16 v[16:31], v[32:35], a[192:195], v[16:31]
  s_waitcnt lgkmcnt(2)
  v_mfma_f32_32x32x16_bf16 v[0:15], a[52:55], v[36:39], v[0:15]
  ds_read_b128 v[32:35], v203 offset:4096
  v_mfma_f32_32x32x16_bf16 v[16:31], v[36:39], a[196:199], v[16:31]
  s_waitcnt lgkmcnt(2)
  v_mfma_f32_32x32x16_bf16 v[0:15], a[56:59], v[40:43], v[0:15]
  ds_read_b128 v[36:39], v204 offset:4096
  v_mfma_f32_32x32x16_bf16 v[16:31], v[40:43], a[200:203], v[16:31]
  s_waitcnt lgkmcnt(2)
  v_mfma_f32_32x32x16_bf16 v[0:15], a[60:63], v[44:47], v[0:15]
  ds_read_b128 v[40:43], v205 offset:4096
  v_mfma_f32_32x32x16_bf16 v[16:31], v[44:47], a[204:207], v[16:31]
  s_waitcnt lgkmcnt(2)
  v_mfma_f32_32x32x16_bf16 v[0:15], a[64:67], v[32:35], v[0:15]
  ds_read_b128 v[44:47], v206 offset:4096
  v_mfma_f32_32x32x16_bf16 v[16:31], v[32:35], a[208:211], v[16:31]
  s_waitcnt lgkmcnt(2)
  v_mfma_f32_32x32x16_bf16 v[0:15], a[68:71], v[36:39], v[0:15]
  ds_read_b128 v[32:35], v203 offset:5120
  v_mfma_f32_32x32x16_bf16 v[16:31], v[36:39], a[212:215], v[16:31]
  s_waitcnt lgkmcnt(2)
  v_mfma_f32_32x32x16_bf16 v[0:15], a[72:75], v[40:43], v[0:15]
  ds_read_b128 v[36:39], v204 offset:5120
  v_mfma_f32_32x32x16_bf16 v[16:31], v[40:43], a[216:219], v[16:31]
  s_waitcnt lgkmcnt(2)
  v_mfma_f32_32x32x16_bf16 v[0:15], a[76:79], v[44:47], v[0:15]
  ds_read_b128 v[40:43], v205 offset:5120
  v_mfma_f32_32x32x16_bf16 v[16:31], v[44:47], a[220:223], v[16:31]
  s_waitcnt lgkmcnt(2)
  v_mfma_f32_32x32x16_bf16 v[0:15], a[80:83], v[32:35], v[0:15]
  ds_read_b128 v[44:47], v206 offset:5120
  v_mfma_f32_32x32x16_bf16 v[16:31], v[32:35], a[224:227], v[16:31]
  s_waitcnt lgkmcnt(2)
  v_mfma_f32_32x32x16_bf16 v[0:15], a[84:87], v[36:39], v[0:15]
  ds_read_b128 v[32:35], v203 offset:6144
  v_mfma_f32_32x32x16_bf16 v[16:31], v[36:39], a[228:231], v[16:31]
  s_waitcnt lgkmcnt(2)
  v_mfma_f32_32x32x16_bf16 v[0:15], a[88:91], v[40:43], v[0:15]
  ds_read_b128 v[36:39], v204 offset:6144
  v_mfma_f32_32x32x16_bf16 v[16:31], v[40:43], a[232:235], v[16:31]
  s_waitcnt lgkmcnt(2)
  v_mfma_f32_32x32x16_bf16 v[0:15], a[92:95], v[44:47], v[0:15]
  ds_read_b128 v[40:43], v205 offset:6144
  v_mfma_f32_32x32x16_bf16 v[16:31], v[44:47], a[236:239], v[16:31]
  s_waitcnt lgkmcnt(2)
  v_mfma_f32_32x32x16_bf16 v[0:15], a[96:99], v[32:35], v[0:15]
  ds_read_b128 v[44:47], v206 offset:6144
  v_mfma_f32_32x32x16_bf16 v[16:31], v[32:35], a[240:243], v[16:31]
  s_waitcnt lgkmcnt(2)
  v_mfma_f32_32x32x16_bf16 v[0:15], a[100:103], v[36:39], v[0:15]
  ds_read_b128 v[32:35], v203 offset:7168
  v_mfma_f32_32x32x16_bf16 v[16:31], v[36:39], a[244:247], v[16:31]
  s_waitcnt lgkmcnt(2)
  v_mfma_f32_32x32x16_bf16 v[0:15], a[104:107], v[40:43], v[0:15]
  ds_read_b128 v[36:39], v204 offset:7168
  v_mfma_f32_32x32x16_bf16 v[16:31], v[40:43], a[248:251], v[16:31]
  s_waitcnt lgkmcnt(2)
  v_mfma_f32_32x32x16_bf16 v[0:15], a[108:111], v[44:47], v[0:15]
  ds_read_b128 v[40:43], v205 offset:7168
  v_mfma_f32_32x32x16_bf16 v[16:31], v[44:47], a[252:255], v[16:31]
  s_waitcnt lgkmcnt(2)
  v_mfma_f32_32x32x16_bf16 v[0:15], a[112:115], v[32:35], v[0:15]
  ds_read_b128 v[44:47], v206 offset:7168
  v_mfma_f32_32x32x16_bf16 v[16:31], v[32:35], v[224:227], v[16:31]
  s_waitcnt lgkmcnt(2)
  v_mfma_f32_32x32x16_bf16 v[0:15], a[116:119], v[36:39], v[0:15]
  ds_read_b128 v[32:35], v203 offset:8192
  v_mfma_f32_32x32x16_bf16 v[16:31], v[36:39], v[228:231], v[16:31]
  s_waitcnt lgkmcnt(2)
  v_mfma_f32_32x32x16_bf16 v[0:15], a[120:123], v[40:43], v[0:15]
  ds_read_b128 v[36:39], v204 offset:8192
  v_mfma_f32_32x32x16_bf16 v[16:31], v[40:43], v[232:235], v[16:31]
  s_waitcnt lgkmcnt(2)
  v_mfma_f32_32x32x16_bf16 v[0:15], a[124:127], v[44:47], v[0:15]
  ds_read_b128 v[40:43], v205 offset:8192
  v_mfma_f32_32x32x16_bf16 v[16:31], v[44:47], v[236:239], v[16:31]
  s_waitcnt lgkmcnt(2)
  v_mfma_f32_32x32x16_bf16 v[0:15], a[128:131], v[32:35], v[0:15]
  ds_read_b128 v[44:47], v206 offset:8192
  v_mfma_f32_32x32x16_bf16 v[16:31], v[32:35], v[240:243], v[16:31]
  s_waitcnt lgkmcnt(2)
  v_mfma_f32_32x32x16_bf16 v[0:15], a[132:135], v[36:39], v[0:15]
  v_mfma_f32_32x32x16_bf16 v[16:31], v[36:39], v[244:247], v[16:31]
  s_waitcnt lgkmcnt(1)
  v_mfma_f32_32x32x16_bf16 v[0:15], a[136:139], v[40:43], v[0:15]
  v_mfma_f32_32x32x16_bf16 v[16:31], v[40:43], v[248:251], v[16:31]
  s_waitcnt lgkmcnt(0)
  v_mfma_f32_32x32x16_bf16 v[0:15], a[140:143], v[44:47], v[0:15]
  v_mfma_f32_32x32x16_bf16 v[16:31], v[44:47], v[252:255], v[16:31]
  s_mul_i32 s64, s59, 655360
  s_lshl_b32 s55, s58, 14
  s_add_u32 s64, s64, s55
  s_add_u32 s64, s64, 1048576
  s_add_u32 s72, s64, s69
  s_add_u32 s73, s64, s66
  s_add_u32 s59, s59, 7
  s_waitcnt vmcnt(0)
  s_barrier
  s_cmp_eq_u32 s1, 1
  s_cbranch_scc1 W_ver_ok
  v_mov_b32 v33, 163832
  s_cmp_eq_u32 s52, 0
  s_cbranch_scc0 W_ver_b
  s_waitcnt vmcnt(0)
  s_mov_b64 exec, 1
  ds_write_b32 v33, v197
  s_mov_b64 exec, -1
  s_waitcnt lgkmcnt(0)
W_ver_b:
  s_barrier
  ds_read_b32 v32, v33
  s_waitcnt lgkmcnt(0)
  v_readfirstlane_b32 s54, v32
  s_nop 0
  s_bitcmp1_b32 s54, s0
  s_cbranch_scc1 L_conf
W_ver_ok:
  s_lshr_b32 s55, s53, 1
  s_and_b32 s56, s53, 1
  s_lshl_b32 s56, s56, 7
  s_lshl_b32 s55, s55, 2
  s_add_u32 s55, s55, s56
  s_add_u32 s55, s55, 356352
  s_cmp_lt_u32 s53, 64
  s_cselect_b32 s71, s55, 268435456
  v_mov_b32 v211, 0
  s_mov_b64 exec, 1
  buffer_store_dword v211, v211, s[8:11], s71 offen sc1
  s_mov_b64 exec, -1
  s_cmp_eq_u32 s59, 7
  s_cbranch_scc0 KV_na
  s_mul_i32 s54, s58, 2176
  s_mul_i32 s55, s52, 69632
  s_add_u32 s55, s55, s54
  s_add_u32 s55, s55, 0
  s_add_u32 s54, s54, 278528
  s_and_b32 s56, s58, 7
  s_lshl_b32 s56, s56, 12
  s_bfe_u32 s57, s58, 0x10003
  s_lshl_b32 s57, s57, 11
  s_add_u32 s56, s56, s57
  s_add_u32 s54, s56, 262144
  s_lshr_b32 s57, s58, 4
  s_lshl_b32 s57, s57, 15
  s_add_u32 s56, s56, s57
  s_lshl_b32 s57, s52, 16
  s_add_u32 s56, s56, s57
  s_add_u32 s55, s56, 0
  s_lshl_b32 s56, s58, 14
  s_mul_i32 s57, s52, 3072
  s_add_u32 s56, s56, s57
  s_add_u32 s56, s56, 360448
  s_cmp_lt_u32 s58, 2
  s_cselect_b32 s56, s56, 268435456
  s_cmp_eq_u32 s52, 0
  s_cselect_b32 s54, s54, 268435456
  buffer_store_dwordx4 v[64:67], v201, s[8:11], s55 offen offset:0 sc1
  buffer_store_dwordx4 v[64:67], v201, s[8:11], s55 offen offset:1024 sc1
  buffer_store_dwordx4 v[64:67], v201, s[8:11], s54 offen offset:0 sc1
  buffer_store_dwordx4 v[64:67], v201, s[8:11], s54 offen offset:1024 sc1
  buffer_store_dwordx4 v[64:67], v201, s[8:11], s56 offen offset:0 sc1
  buffer_store_dwordx4 v[64:67], v201, s[8:11], s56 offen offset:1024 sc1
  buffer_store_dwordx4 v[64:67], v201, s[8:11], s56 offen offset:2048 sc1
KV_na:
KV_loop:
  s_add_u32 s60, s60, 258048
  ds_read_b128 v[32:35], v203 offset:36864
  ds_read_b128 v[36:39], v204 offset:36864
  ds_read_b128 v[40:43], v205 offset:36864
  s_waitcnt lgkmcnt(2)
  v_mfma_f32_32x32x16_bf16 v[68:83], a[0:3], v[32:35], 0
  ds_read_b128 v[44:47], v206 offset:36864
  s_add_u32 m0, s67, 0
  s_nop 0
  buffer_load_dwordx4 v202, s[4:7], s60 offen offset:0 lds
  v_mfma_f32_32x32x16_bf16 v[84:99], v[32:35], a[144:147], 0
  s_waitcnt lgkmcnt(2)
  v_mfma_f32_32x32x16_bf16 v[68:83], a[4:7], v[36:39], v[68:83]
  ds_read_b128 v[32:35], v203 offset:37888
  s_add_u32 m0, s67, 896
  s_nop 0
  buffer_load_dwordx4 v202, s[4:7], s60 offen offset:128 lds
  v_mfma_f32_32x32x16_bf16 v[84:99], v[36:39], a[148:151], v[84:99]
  s_waitcnt lgkmcnt(2)
  v_mfma_f32_32x32x16_bf16 v[68:83], a[8:11], v[40:43], v[68:83]
  ds_read_b128 v[36:39], v204 offset:37888
  s_add_u32 m0, s67, 1792
  s_nop 0
  buffer_load_dwordx4 v202, s[4:7], s60 offen offset:256 lds
  v_mfma_f32_32x32x16_bf16 v[84:99], v[40:43], a[152:155], v[84:99]
  s_waitcnt lgkmcnt(2)
  v_mfma_f32_32x32x16_bf16 v[68:83], a[12:15], v[44:47], v[68:83]
  ds_read_b128 v[40:43], v205 offset:37888
  s_add_u32 m0, s67, 2688
  s_nop 0
  buffer_load_dwordx4 v202, s[4:7], s60 offen offset:384 lds
  v_mfma_f32_32x32x16_bf16 v[84:99], v[44:47], a[156:159], v[84:99]
  s_waitcnt lgkmcnt(2)
  v_mfma_f32_32x32x16_bf16 v[68:83], a[16:19], v[32:35], v[68:83]
  ds_read_b128 v[44:47], v206 offset:37888
  s_add_u32 m0, s67, 3584
  s_nop 0
  buffer_load_dwordx4 v202, s[4:7], s60 offen offset:512 lds
  v_mfma_f32_32x32x16_bf16 v[84:99], v[32:35], a[160:163], v[84:99]
  s_waitcnt lgkmcnt(2)
  v_mfma_f32_32x32x16_bf16 v[68:83], a[20:23], v[36:39], v[68:83]
  ds_read_b128 v[32:35], v203 offset:38912
  s_add_u32 m0, s67, 4480
  s_nop 0
  buffer_load_dwordx4 v202, s[4:7], s60 offen offset:640 lds
  v_mfma_f32_32x32x16_bf16 v[84:99], v[36:39], a[164:167], v[84:99]
  s_waitcnt lgkmcnt(2)
  v_mfma_f32_32x32x16_bf16 v[68:83], a[24:27], v[40:43], v[68:83]
  ds_read_b128 v[36:39], v204 offset:38912
  s_add_u32 m0, s67, 5376
  s_nop 0
  buffer_load_dwordx4 v202, s[4:7], s60 offen offset:768 lds
  v_mfma_f32_32x32x16_bf16 v[84:99], v[40:43], a[168:171], v[84:99]
  s_waitcnt lgkmcnt(2)
  v_mfma_f32_32x32x16_bf16 v[68:83], a[28:31], v[44:47], v[68:83]
  ds_read_b128 v[40:43], v205 offset:38912
  s_add_u32 m0, s67, 6272
  s_nop 0
  buffer_load_dwordx4 v202, s[4:7], s60 offen offset:896 lds
  v_mfma_f32_32x32x16_bf16 v[84:99], v[44:47], a[172:175], v[84:99]
  s_waitcnt lgkmcnt(2)
  v_mfma_f32_32x32x16_bf16 v[68:83], a[32:35], v[32:35], v[68:83]
  ds_read_b128 v[44:47], v206 offset:38912
  s_add_u32 m0, s67, 7168
  s_nop 0
  buffer_load_dwordx4 v202, s[4:7], s60 offen offset:1024 lds
  v_mfma_f32_32x32x16_bf16 v[84:99], v[32:35], a[176:179], v[84:99]
  s_waitcnt lgkmcnt(2)
  v_mfma_f32_32x32x16_bf16 v[68:83], a[36:39], v[36:39], v[68:83]
  ds_read_b128 v[32:35], v203 offset:39936
  v_mul_f32 v0, s68, v0
  v_mul_f32 v1, s68, v1
  v_mul_f32 v2, s68, v2
  v_mul_f32 v3, s68, v3
  v_mfma_f32_32x32x16_bf16 v[84:99], v[36:39], a[180:183], v[84:99]
  v_mul_f32 v4, s68, v4
  v_mul_f32 v5, s68, v5
  v_mul_f32 v6, s68, v6
  v_mul_f32 v7, s68, v7
  s_waitcnt lgkmcnt(2)
  v_mfma_f32_32x32x16_bf16 v[68:83], a[40:43], v[40:43], v[68:83]
  ds_read_b128 v[36:39], v204 offset:39936
  v_cvt_pk_bf16_f32 v48, v0, v4
  v_cvt_pk_bf16_f32 v49, v1, v5
  v_cvt_pk_bf16_f32 v50, v2, v6
  v_cvt_pk_bf16_f32 v51, v3, v7
  v_mfma_f32_32x32x16_bf16 v[84:99], v[40:43], a[184:187], v[84:99]
  buffer_store_dwordx4 v[48:51], v216, s[8:11], s72 offen offset:0 sc1
  s_waitcnt lgkmcnt(2)
  v_mfma_f32_32x32x16_bf16 v[68:83], a[44:47], v[44:47], v[68:83]
  ds_read_b128 v[40:43], v205 offset:39936
  v_mfma_f32_32x32x16_bf16 v[84:99], v[44:47], a[188:191], v[84:99]
  s_waitcnt lgkmcnt(2)
  v_mfma_f32_32x32x16_bf16 v[68:83], a[48:51], v[32:35], v[68:83]
  ds_read_b128 v[44:47], v206 offset:39936
  v_mul_f32 v8, s68, v8
  v_mul_f32 v9, s68, v9
  v_mul_f32 v10, s68, v10
  v_mul_f32 v11, s68, v11
  v_mfma_f32_32x32x16_bf16 v[84:99], v[32:35], a[192:195], v[84:99]
  v_mul_f32 v12, s68, v12
  v_mul_f32 v13, s68, v13
  v_mul_f32 v14, s68, v14
  v_mul_f32 v15, s68, v15
  s_waitcnt lgkmcnt(2)
  v_mfma_f32_32x32x16_bf16 v[68:83], a[52:55], v[36:39], v[68:83]
  ds_read_b128 v[32:35], v203 offset:40960
  v_cvt_pk_bf16_f32 v52, v8, v12
  v_cvt_pk_bf16_f32 v53, v9, v13
  v_cvt_pk_bf16_f32 v54, v10, v14
  v_cvt_pk_bf16_f32 v55, v11, v15
  v_mfma_f32_32x32x16_bf16 v[84:99], v[36:39], a[196:199], v[84:99]
  buffer_store_dwordx4 v[52:55], v216, s[8:11], s72 offen offset:256 sc1
  s_waitcnt lgkmcnt(2)
  v_mfma_f32_32x32x16_bf16 v[68:83], a[56:59], v[40:43], v[68:83]
  ds_read_b128 v[36:39], v204 offset:40960
  v_mfma_f32_32x32x16_bf16 v[84:99], v[40:43], a[200:203], v[84:99]
  s_waitcnt lgkmcnt(2)
  v_mfma_f32_32x32x16_bf16 v[68:83], a[60:63], v[44:47], v[68:83]
  ds_read_b128 v[40:43], v205 offset:40960
  v_cvt_pk_bf16_f32 v56, v16, v17
  v_cvt_pk_bf16_f32 v57, v20, v21
  v_cvt_pk_bf16_f32 v58, v24, v25
  v_cvt_pk_bf16_f32 v59, v28, v29
  v_mfma_f32_32x32x16_bf16 v[84:99], v[44:47], a[204:207], v[84:99]
  buffer_store_dwordx4 v[56:59], v217, s[8:11], s64 offen offset:0 sc1
  s_waitcnt lgkmcnt(2)
  v_mfma_f32_32x32x16_bf16 v[68:83], a[64:67], v[32:35], v[68:83]
  ds_read_b128 v[44:47], v206 offset:40960
  v_mfma_f32_32x32x16_bf16 v[84:99], v[32:35], a[208:211], v[84:99]
  s_waitcnt lgkmcnt(2)
  v_mfma_f32_32x32x16_bf16 v[68:83], a[68:71], v[36:39], v[68:83]
  ds_read_b128 v[32:35], v203 offset:41984
  v_cvt_pk_bf16_f32 v60, v18, v19
  v_cvt_pk_bf16_f32 v61, v22, v23
  v_cvt_pk_bf16_f32 v62, v26, v27
  v_cvt_pk_bf16_f32 v63, v30, v31
  v_mfma_f32_32x32x16_bf16 v[84:99], v[36:39], a[212:215], v[84:99]
  buffer_store_dwordx4 v[60:63], v217, s[8:11], s64 offen offset:256 sc1
  s_waitcnt lgkmcnt(2)
  v_mfma_f32_32x32x16_bf16 v[68:83], a[72:75], v[40:43], v[68:83]
  ds_read_b128 v[36:39], v204 offset:41984
  v_mfma_f32_32x32x16_bf16 v[84:99], v[40:43], a[216:219], v[84:99]
  s_waitcnt lgkmcnt(2)
  v_mfma_f32_32x32x16_bf16 v[68:83], a[76:79], v[44:47], v[68:83]
  ds_read_b128 v[40:43], v205 offset:41984
  buffer_store_dwordx4 v[64:67], v201, s[8:11], s73 offen sc1
  v_mfma_f32_32x32x16_bf16 v[84:99], v[44:47], a[220:223], v[84:99]
  s_waitcnt lgkmcnt(2)
  v_mfma_f32_32x32x16_bf16 v[68:83], a[80:83], v[32:35], v[68:83]
  ds_read_b128 v[44:47], v206 offset:41984
  v_mfma_f32_32x32x16_bf16 v[84:99], v[32:35], a[224:227], v[84:99]
  s_waitcnt lgkmcnt(2)
  v_mfma_f32_32x32x16_bf16 v[68:83], a[84:87], v[36:39], v[68:83]
  ds_read_b128 v[32:35], v203 offset:43008
  v_mfma_f32_32x32x16_bf16 v[84:99], v[36:39], a[228:231], v[84:99]
  s_waitcnt lgkmcnt(2)
  v_mfma_f32_32x32x16_bf16 v[68:83], a[88:91], v[40:43], v[68:83]
  ds_read_b128 v[36:39], v204 offset:43008
  v_mfma_f32_32x32x16_bf16 v[84:99], v[40:43], a[232:235], v[84:99]
  s_waitcnt lgkmcnt(2)
  v_mfma_f32_32x32x16_bf16 v[68:83], a[92:95], v[44:47], v[68:83]
  ds_read_b128 v[40:43], v205 offset:43008
  v_mfma_f32_32x32x16_bf16 v[84:99], v[44:47], a[236:239], v[84:99]
  s_waitcnt lgkmcnt(2)
  v_mfma_f32_32x32x16_bf16 v[68:83], a[96:99], v[32:35], v[68:83]
  ds_read_b128 v[44:47], v206 offset:43008
  v_mfma_f32_32x32x16_bf16 v[84:99], v[32:35], a[240:243], v[84:99]
  s_waitcnt lgkmcnt(2)
  v_mfma_f32_32x32x16_bf16 v[68:83], a[100:103], v[36:39], v[68:83]
  ds_read_b128 v[32:35], v203 offset:44032
  v_mfma_f32_32x32x16_bf16 v[84:99], v[36:39], a[244:247], v[84:99]
  s_waitcnt lgkmcnt(2)
  v_mfma_f32_32x32x16_bf16 v[68:83], a[104:107], v[40:43], v[68:83]
  ds_read_b128 v[36:39], v204 offset:44032
  v_mfma_f32_32x32x16_bf16 v[84:99], v[40:43], a[248:251], v[84:99]
  s_waitcnt lgkmcnt(2)
  v_mfma_f32_32x32x16_bf16 v[68:83], a[108:111], v[44:47], v[68:83]
  ds_read_b128 v[40:43], v205 offset:44032
  v_mfma_f32_32x32x16_bf16 v[84:99], v[44:47], a[252:255], v[84:99]
  s_waitcnt lgkmcnt(2)
  v_mfma_f32_32x32x16_bf16 v[68:83], a[112:115], v[32:35], v[68:83]
  ds_read_b128 v[44:47], v206 offset:44032
  v_mfma_f32_32x32x16_bf16 v[84:99], v[32:35], v[224:227], v[84:99]
  s_waitcnt lgkmcnt(2)
  v_mfma_f32_32x32x16_bf16 v[68:83], a[116:119], v[36:39], v[68:83]
  ds_read_b128 v[32:35], v203 offset:45056
  v_mfma_f32_32x32x16_bf16 v[84:99], v[36:39], v[228:231], v[84:99]
  s_waitcnt lgkmcnt(2)
  v_mfma_f32_32x32x16_bf16 v[68:83], a[120:123], v[40:43], v[68:83]
  ds_read_b128 v[36:39], v204 offset:45056
  v_mfma_f32_32x32x16_bf16 v[84:99], v[40:43], v[232:235], v[84:99]
  s_waitcnt lgkmcnt(2)
  v_mfma_f32_32x32x16_bf16 v[68:83], a[124:127], v[44:47], v[68:83]
  ds_read_b128 v[40:43], v205 offset:45056
  v_mfma_f32_32x32x16_bf16 v[84:99], v[44:47], v[236:239], v[84:99]
  s_waitcnt lgkmcnt(2)
  v_mfma_f32_32x32x16_bf16 v[68:83], a[128:131], v[32:35], v[68:83]
  ds_read_b128 v[44:47], v206 offset:45056
  v_mfma_f32_32x32x16_bf16 v[84:99], v[32:35], v[240:243], v[84:99]
  s_waitcnt lgkmcnt(2)
  v_mfma_f32_32x32x16_bf16 v[68:83], a[132:135], v[36:39], v[68:83]
  v_mfma_f32_32x32x16_bf16 v[84:99], v[36:39], v[244:247], v[84:99]
  s_waitcnt lgkmcnt(1)
  v_mfma_f32_32x32x16_bf16 v[68:83], a[136:139], v[40:43], v[68:83]
  v_mfma_f32_32x32x16_bf16 v[84:99], v[40:43], v[248:251], v[84:99]
  s_waitcnt lgkmcnt(0)
  v_mfma_f32_32x32x16_bf16 v[68:83], a[140:143], v[44:47], v[68:83]
  v_mfma_f32_32x32x16_bf16 v[84:99], v[44:47], v[252:255], v[84:99]
  s_mul_i32 s64, s59, 655360
  s_lshl_b32 s55, s58, 14
  s_add_u32 s64, s64, s55
  s_add_u32 s64, s64, 1048576
  s_add_u32 s72, s64, s69
  s_add_u32 s73, s64, s66
  s_add_u32 s59, s59, 7
  s_cmp_ge_u32 s59, 64
  s_cbranch_scc1 KV_done1
  s_waitcnt vmcnt(5)
  s_barrier
  s_add_u32 s60, s60, 258048
  ds_read_b128 v[32:35], v203 offset:0
  ds_read_b128 v[36:39], v204 offset:0
  ds_read_b128 v[40:43], v205 offset:0
  s_waitcnt lgkmcnt(2)
  v_mfma_f32_32x32x16_bf16 v[0:15], a[0:3], v[32:35], 0
  ds_read_b128 v[44:47], v206 offset:0
  s_add_u32 m0, s67, 36864
  s_nop 0
  buffer_load_dwordx4 v202, s[4:7], s60 offen offset:0 lds
  v_mfma_f32_32x32x16_bf16 v[16:31], v[32:35], a[144:147], 0
  s_waitcnt lgkmcnt(2)
  v_mfma_f32_32x32x16_bf16 v[0:15], a[4:7], v[36:39], v[0:15]
  ds_read_b128 v[32:35], v203 offset:1024
  s_add_u32 m0, s67, 37760
  s_nop 0
  buffer_load_dwordx4 v202, s[4:7], s60 offen offset:128 lds
  v_mfma_f32_32x32x16_bf16 v[16:31], v[36:39], a[148:151], v[16:31]
  s_waitcnt lgkmcnt(2)
  v_mfma_f32_32x32x16_bf16 v[0:15], a[8:11], v[40:43], v[0:15]
  ds_read_b128 v[36:39], v204 offset:1024
  s_add_u32 m0, s67, 38656
  s_nop 0
  buffer_load_dwordx4 v202, s[4:7], s60 offen offset:256 lds
  v_mfma_f32_32x32x16_bf16 v[16:31], v[40:43], a[152:155], v[16:31]
  s_waitcnt lgkmcnt(2)
  v_mfma_f32_32x32x16_bf16 v[0:15], a[12:15], v[44:47], v[0:15]
  ds_read_b128 v[40:43], v205 offset:1024
  s_add_u32 m0, s67, 39552
  s_nop 0
  buffer_load_dwordx4 v202, s[4:7], s60 offen offset:384 lds
  v_mfma_f32_32x32x16_bf16 v[16:31], v[44:47], a[156:159], v[16:31]
  s_waitcnt lgkmcnt(2)
  v_mfma_f32_32x32x16_bf16 v[0:15], a[16:19], v[32:35], v[0:15]
  ds_read_b128 v[44:47], v206 offset:1024
  s_add_u32 m0, s67, 40448
  s_nop 0
  buffer_load_dwordx4 v202, s[4:7], s60 offen offset:512 lds
  v_mfma_f32_32x32x16_bf16 v[16:31], v[32:35], a[160:163], v[16:31]
  s_waitcnt lgkmcnt(2)
  v_mfma_f32_32x32x16_bf16 v[0:15], a[20:23], v[36:39], v[0:15]
  ds_read_b128 v[32:35], v203 offset:2048
  s_add_u32 m0, s67, 41344
  s_nop 0
  buffer_load_dwordx4 v202, s[4:7], s60 offen offset:640 lds
  v_mfma_f32_32x32x16_bf16 v[16:31], v[36:39], a[164:167], v[16:31]
  s_waitcnt lgkmcnt(2)
  v_mfma_f32_32x32x16_bf16 v[0:15], a[24:27], v[40:43], v[0:15]
  ds_read_b128 v[36:39], v204 offset:2048
  s_add_u32 m0, s67, 42240
  s_nop 0
  buffer_load_dwordx4 v202, s[4:7], s60 offen offset:768 lds
  v_mfma_f32_32x32x16_bf16 v[16:31], v[40:43], a[168:171], v[16:31]
  s_waitcnt lgkmcnt(2)
  v_mfma_f32_32x32x16_bf16 v[0:15], a[28:31], v[44:47], v[0:15]
  ds_read_b128 v[40:43], v205 offset:2048
  s_add_u32 m0, s67, 43136
  s_nop 0
  buffer_load_dwordx4 v202, s[4:7], s60 offen offset:896 lds
  v_mfma_f32_32x32x16_bf16 v[16:31], v[44:47], a[172:175], v[16:31]
  s_waitcnt lgkmcnt(2)
  v_mfma_f32_32x32x16_bf16 v[0:15], a[32:35], v[32:35], v[0:15]
  ds_read_b128 v[44:47], v206 offset:2048
  s_add_u32 m0, s67, 44032
  s_nop 0
  buffer_load_dwordx4 v202, s[4:7], s60 offen offset:1024 lds
  v_mfma_f32_32x32x16_bf16 v[16:31], v[32:35], a[176:179], v[16:31]
  s_waitcnt lgkmcnt(2)
  v_mfma_f32_32x32x16_bf16 v[0:15], a[36:39], v[36:39], v[0:15]
  ds_read_b128 v[32:35], v203 offset:3072
  v_mul_f32 v68, s68, v68
  v_mul_f32 v69, s68, v69
  v_mul_f32 v70, s68, v70
  v_mul_f32 v71, s68, v71
  v_mfma_f32_32x32x16_bf16 v[16:31], v[36:39], a[180:183], v[16:31]
  v_mul_f32 v72, s68, v72
  v_mul_f32 v73, s68, v73
  v_mul_f32 v74, s68, v74
  v_mul_f32 v75, s68, v75
  s_waitcnt lgkmcnt(2)
  v_mfma_f32_32x32x16_bf16 v[0:15], a[40:43], v[40:43], v[0:15]
  ds_read_b128 v[36:39], v204 offset:3072
  v_cvt_pk_bf16_f32 v48, v68, v72
  v_cvt_pk_bf16_f32 v49, v69, v73
  v_cvt_pk_bf16_f32 v50, v70, v74
  v_cvt_pk_bf16_f32 v51, v71, v75
  v_mfma_f32_32x32x16_bf16 v[16:31], v[40:43], a[184:187], v[16:31]
  buffer_store_dwordx4 v[48:51], v216, s[8:11], s72 offen offset:0 sc1
  s_waitcnt lgkmcnt(2)
  v_mfma_f32_32x32x16_bf16 v[0:15], a[44:47], v[44:47], v[0:15]
  ds_read_b128 v[40:43], v205 offset:3072
  v_mfma_f32_32x32x16_bf16 v[16:31], v[44:47], a[188:191], v[16:31]
  s_waitcnt lgkmcnt(2)
  v_mfma_f32_32x32x16_bf16 v[0:15], a[48:51], v[32:35], v[0:15]
  ds_read_b128 v[44:47], v206 offset:3072
  v_mul_f32 v76, s68, v76
  v_mul_f32 v77, s68, v77
  v_mul_f32 v78, s68, v78
  v_mul_f32 v79, s68, v79
  v_mfma_f32_32x32x16_bf16 v[16:31], v[32:35], a[192:195], v[16:31]
  v_mul_f32 v80, s68, v80
  v_mul_f32 v81, s68, v81
  v_mul_f32 v82, s68, v82
  v_mul_f32 v83, s68, v83
  s_waitcnt lgkmcnt(2)
  v_mfma_f32_32x32x16_bf16 v[0:15], a[52:55], v[36:39], v[0:15]
  ds_read_b128 v[32:35], v203 offset:4096
  v_cvt_pk_bf16_f32 v52, v76, v80
  v_cvt_pk_bf16_f32 v53, v77, v81
  v_cvt_pk_bf16_f32 v54, v78, v82
  v_cvt_pk_bf16_f32 v55, v79, v83
  v_mfma_f32_32x32x16_bf16 v[16:31], v[36:39], a[196:199], v[16:31]
  buffer_store_dwordx4 v[52:55], v216, s[8:11], s72 offen offset:256 sc1
  s_waitcnt lgkmcnt(2)
  v_mfma_f32_32x32x16_bf16 v[0:15], a[56:59], v[40:43], v[0:15]
  ds_read_b128 v[36:39], v204 offset:4096
  v_mfma_f32_32x32x16_bf16 v[16:31], v[40:43], a[200:203], v[16:31]
  s_waitcnt lgkmcnt(2)
  v_mfma_f32_32x32x16_bf16 v[0:15], a[60:63], v[44:47], v[0:15]
  ds_read_b128 v[40:43], v205 offset:4096
  v_cvt_pk_bf16_f32 v56, v84, v85
  v_cvt_pk_bf16_f32 v57, v88, v89
  v_cvt_pk_bf16_f32 v58, v92, v93
  v_cvt_pk_bf16_f32 v59, v96, v97
  v_mfma_f32_32x32x16_bf16 v[16:31], v[44:47], a[204:207], v[16:31]
  buffer_store_dwordx4 v[56:59], v217, s[8:11], s64 offen offset:0 sc1
  s_waitcnt lgkmcnt(2)
  v_mfma_f32_32x32x16_bf16 v[0:15], a[64:67], v[32:35], v[0:15]
  ds_read_b128 v[44:47], v206 offset:4096
  v_mfma_f32_32x32x16_bf16 v[16:31], v[32:35], a[208:211], v[16:31]
  s_waitcnt lgkmcnt(2)
  v_mfma_f32_32x32x16_bf16 v[0:15], a[68:71], v[36:39], v[0:15]
  ds_read_b128 v[32:35], v203 offset:5120
  v_cvt_pk_bf16_f32 v60, v86, v87
  v_cvt_pk_bf16_f32 v61, v90, v91
  v_cvt_pk_bf16_f32 v62, v94, v95
  v_cvt_pk_bf16_f32 v63, v98, v99
  v_mfma_f32_32x32x16_bf16 v[16:31], v[36:39], a[212:215], v[16:31]
  buffer_store_dwordx4 v[60:63], v217, s[8:11], s64 offen offset:256 sc1
  s_waitcnt lgkmcnt(2)
  v_mfma_f32_32x32x16_bf16 v[0:15], a[72:75], v[40:43], v[0:15]
  ds_read_b128 v[36:39], v204 offset:5120
  v_mfma_f32_32x32x16_bf16 v[16:31], v[40:43], a[216:219], v[16:31]
  s_waitcnt lgkmcnt(2)
  v_mfma_f32_32x32x16_bf16 v[0:15], a[76:79], v[44:47], v[0:15]
  ds_read_b128 v[40:43], v205 offset:5120
  buffer_store_dwordx4 v[64:67], v201, s[8:11], s73 offen sc1
  v_mfma_f32_32x32x16_bf16 v[16:31], v[44:47], a[220:223], v[16:31]
  s_waitcnt lgkmcnt(2)
  v_mfma_f32_32x32x16_bf16 v[0:15], a[80:83], v[32:35], v[0:15]
  ds_read_b128 v[44:47], v206 offset:5120
  v_mfma_f32_32x32x16_bf16 v[16:31], v[32:35], a[224:227], v[16:31]
  s_waitcnt lgkmcnt(2)
  v_mfma_f32_32x32x16_bf16 v[0:15], a[84:87], v[36:39], v[0:15]
  ds_read_b128 v[32:35], v203 offset:6144
  v_mfma_f32_32x32x16_bf16 v[16:31], v[36:39], a[228:231], v[16:31]
  s_waitcnt lgkmcnt(2)
  v_mfma_f32_32x32x16_bf16 v[0:15], a[88:91], v[40:43], v[0:15]
  ds_read_b128 v[36:39], v204 offset:6144
  v_mfma_f32_32x32x16_bf16 v[16:31], v[40:43], a[232:235], v[16:31]
  s_waitcnt lgkmcnt(2)
  v_mfma_f32_32x32x16_bf16 v[0:15], a[92:95], v[44:47], v[0:15]
  ds_read_b128 v[40:43], v205 offset:6144
  v_mfma_f32_32x32x16_bf16 v[16:31], v[44:47], a[236:239], v[16:31]
  s_waitcnt lgkmcnt(2)
  v_mfma_f32_32x32x16_bf16 v[0:15], a[96:99], v[32:35], v[0:15]
  ds_read_b128 v[44:47], v206 offset:6144
  v_mfma_f32_32x32x16_bf16 v[16:31], v[32:35], a[240:243], v[16:31]
  s_waitcnt lgkmcnt(2)
  v_mfma_f32_32x32x16_bf16 v[0:15], a[100:103], v[36:39], v[0:15]
  ds_read_b128 v[32:35], v203 offset:7168
  v_mfma_f32_32x32x16_bf16 v[16:31], v[36:39], a[244:247], v[16:31]
  s_waitcnt lgkmcnt(2)
  v_mfma_f32_32x32x16_bf16 v[0:15], a[104:107], v[40:43], v[0:15]
  ds_read_b128 v[36:39], v204 offset:7168
  v_mfma_f32_32x32x16_bf16 v[16:31], v[40:43], a[248:251], v[16:31]
  s_waitcnt lgkmcnt(2)
  v_mfma_f32_32x32x16_bf16 v[0:15], a[108:111], v[44:47], v[0:15]
  ds_read_b128 v[40:43], v205 offset:7168
  v_mfma_f32_32x32x16_bf16 v[16:31], v[44:47], a[252:255], v[16:31]
  s_waitcnt lgkmcnt(2)
  v_mfma_f32_32x32x16_bf16 v[0:15], a[112:115], v[32:35], v[0:15]
  ds_read_b128 v[44:47], v206 offset:7168
  v_mfma_f32_32x32x16_bf16 v[16:31], v[32:35], v[224:227], v[16:31]
  s_waitcnt lgkmcnt(2)
  v_mfma_f32_32x32x16_bf16 v[0:15], a[116:119], v[36:39], v[0:15]
  ds_read_b128 v[32:35], v203 offset:8192
  v_mfma_f32_32x32x16_bf16 v[16:31], v[36:39], v[228:231], v[16:31]
  s_waitcnt lgkmcnt(2)
  v_mfma_f32_32x32x16_bf16 v[0:15], a[120:123], v[40:43], v[0:15]
  ds_read_b128 v[36:39], v204 offset:8192
  v_mfma_f32_32x32x16_bf16 v[16:31], v[40:43], v[232:235], v[16:31]
  s_waitcnt lgkmcnt(2)
  v_mfma_f32_32x32x16_bf16 v[0:15], a[124:127], v[44:47], v[0:15]
  ds_read_b128 v[40:43], v205 offset:8192
  v_mfma_f32_32x32x16_bf16 v[16:31], v[44:47], v[236:239], v[16:31]
  s_waitcnt lgkmcnt(2)
  v_mfma_f32_32x32x16_bf16 v[0:15], a[128:131], v[32:35], v[0:15]
  ds_read_b128 v[44:47], v206 offset:8192
  v_mfma_f32_32x32x16_bf16 v[16:31], v[32:35], v[240:243], v[16:31]
  s_waitcnt lgkmcnt(2)
  v_mfma_f32_32x32x16_bf16 v[0:15], a[132:135], v[36:39], v[0:15]
  v_mfma_f32_32x32x16_bf16 v[16:31], v[36:39], v[244:247], v[16:31]
  s_waitcnt lgkmcnt(1)
  v_mfma_f32_32x32x16_bf16 v[0:15], a[136:139], v[40:43], v[0:15]
  v_mfma_f32_32x32x16_bf16 v[16:31], v[40:43], v[248:251], v[16:31]
  s_waitcnt lgkmcnt(0)
  v_mfma_f32_32x32x16_bf16 v[0:15], a[140:143], v[44:47], v[0:15]
  v_mfma_f32_32x32x16_bf16 v[16:31], v[44:47], v[252:255], v[16:31]
  s_mul_i32 s64, s59, 655360
  s_lshl_b32 s55, s58, 14
  s_add_u32 s64, s64, s55
  s_add_u32 s64, s64, 1048576
  s_add_u32 s72, s64, s69
  s_add_u32 s73, s64, s66
  s_add_u32 s59, s59, 7
  s_cmp_ge_u32 s59, 64
  s_cbranch_scc1 KV_done0
  s_sub_u32 s54, s59, 21
  s_cmp_lt_u32 s54, 7
  s_cbranch_scc1 KV_early
  s_waitcnt vmcnt(5)
  s_barrier
KV_cont:
  s_branch KV_loop
KV_early:
  s_waitcnt vmcnt(0)
  s_barrier
  s_cmp_eq_u32 s52, 0
  s_cbranch_scc0 KV_sig0
  v_mov_b32 v211, 1
  v_mov_b32 v212, 0
  s_mov_b64 exec, 1
  buffer_atomic_add v211, v212, s[12:15], s70 offen
  s_mov_b64 exec, -1
KV_sig0:
  s_branch KV_cont
KV_done1:
  s_nop 11
  v_mul_f32 v68, s68, v68
  v_mul_f32 v69, s68, v69
  v_mul_f32 v70, s68, v70
  v_mul_f32 v71, s68, v71
  v_mul_f32 v72, s68, v72
  v_mul_f32 v73, s68, v73
  v_mul_f32 v74, s68, v74
  v_mul_f32 v75, s68, v75
  v_cvt_pk_bf16_f32 v48, v68, v72
  v_cvt_pk_bf16_f32 v49, v69, v73
  v_cvt_pk_bf16_f32 v50, v70, v74
  v_cvt_pk_bf16_f32 v51, v71, v75
  buffer_store_dwordx4 v[48:51], v216, s[8:11], s72 offen offset:0 sc1
  v_mul_f32 v76, s68, v76
  v_mul_f32 v77, s68, v77
  v_mul_f32 v78, s68, v78
  v_mul_f32 v79, s68, v79
  v_mul_f32 v80, s68, v80
  v_mul_f32 v81, s68, v81
  v_mul_f32 v82, s68, v82
  v_mul_f32 v83, s68, v83
  v_cvt_pk_bf16_f32 v52, v76, v80
  v_cvt_pk_bf16_f32 v53, v77, v81
  v_cvt_pk_bf16_f32 v54, v78, v82
  v_cvt_pk_bf16_f32 v55, v79, v83
  buffer_store_dwordx4 v[52:55], v216, s[8:11], s72 offen offset:256 sc1
  v_cvt_pk_bf16_f32 v56, v84, v85
  v_cvt_pk_bf16_f32 v57, v88, v89
  v_cvt_pk_bf16_f32 v58, v92, v93
  v_cvt_pk_bf16_f32 v59, v96, v97
  buffer_store_dwordx4 v[56:59], v217, s[8:11], s64 offen offset:0 sc1
  v_cvt_pk_bf16_f32 v60, v86, v87
  v_cvt_pk_bf16_f32 v61, v90, v91
  v_cvt_pk_bf16_f32 v62, v94, v95
  v_cvt_pk_bf16_f32 v63, v98, v99
  buffer_store_dwordx4 v[60:63], v217, s[8:11], s64 offen offset:256 sc1
  buffer_store_dwordx4 v[64:67], v201, s[8:11], s73 offen sc1
  s_branch KV_fin
KV_done0:
  s_nop 11
  v_mul_f32 v0, s68, v0
  v_mul_f32 v1, s68, v1
  v_mul_f32 v2, s68, v2
  v_mul_f32 v3, s68, v3
  v_mul_f32 v4, s68, v4
  v_mul_f32 v5, s68, v5
  v_mul_f32 v6, s68, v6
  v_mul_f32 v7, s68, v7
  v_cvt_pk_bf16_f32 v48, v0, v4
  v_cvt_pk_bf16_f32 v49, v1, v5
  v_cvt_pk_bf16_f32 v50, v2, v6
  v_cvt_pk_bf16_f32 v51, v3, v7
  buffer_store_dwordx4 v[48:51], v216, s[8:11], s72 offen offset:0 sc1
  v_mul_f32 v8, s68, v8
  v_mul_f32 v9, s68, v9
  v_mul_f32 v10, s68, v10
  v_mul_f32 v11, s68, v11
  v_mul_f32 v12, s68, v12
  v_mul_f32 v13, s68, v13
  v_mul_f32 v14, s68, v14
  v_mul_f32 v15, s68, v15
  v_cvt_pk_bf16_f32 v52, v8, v12
  v_cvt_pk_bf16_f32 v53, v9, v13
  v_cvt_pk_bf16_f32 v54, v10, v14
  v_cvt_pk_bf16_f32 v55, v11, v15
  buffer_store_dwordx4 v[52:55], v216, s[8:11], s72 offen offset:256 sc1
  v_cvt_pk_bf16_f32 v56, v16, v17
  v_cvt_pk_bf16_f32 v57, v20, v21
  v_cvt_pk_bf16_f32 v58, v24, v25
  v_cvt_pk_bf16_f32 v59, v28, v29
  buffer_store_dwordx4 v[56:59], v217, s[8:11], s64 offen offset:0 sc1
  v_cvt_pk_bf16_f32 v60, v18, v19
  v_cvt_pk_bf16_f32 v61, v22, v23
  v_cvt_pk_bf16_f32 v62, v26, v27
  v_cvt_pk_bf16_f32 v63, v30, v31
  buffer_store_dwordx4 v[60:63], v217, s[8:11], s64 offen offset:256 sc1
  buffer_store_dwordx4 v[64:67], v201, s[8:11], s73 offen sc1
KV_fin:
  s_waitcnt vmcnt(0)
  s_barrier
  s_cmp_eq_u32 s52, 0
  s_cbranch_scc0 KV_sig
  v_mov_b32 v211, 256
  v_mov_b32 v212, 0
  s_mov_b64 exec, 1
  buffer_atomic_add v211, v212, s[12:15], s70 offen
  s_mov_b64 exec, -1
KV_sig:
  s_cmp_ge_u32 s53, 192
  s_cbranch_scc1 L_exit
  s_cmp_lt_u32 s53, 64
  s_cbranch_scc1 W_h
  s_sub_u32 s54, s53, 64
  s_lshr_b32 s68, s54, 4
  s_and_b32 s69, s54, 15
  s_lshl_b32 s60, s69, 2
  s_sub_u32 s60, s60, 1
  s_max_i32 s60, s60, 0
  s_mul_i32 s60, s60, 36864
  s_add_u32 m0, s67, 0
  s_nop 0
  buffer_load_dwordx4 v202, s[4:7], s60 offen offset:0 lds
  s_add_u32 m0, s67, 896
  s_nop 0
  buffer_load_dwordx4 v202, s[4:7], s60 offen offset:128 lds
  s_add_u32 m0, s67, 1792
  s_nop 0
  buffer_load_dwordx4 v202, s[4:7], s60 offen offset:256 lds
  s_add_u32 m0, s67, 2688
  s_nop 0
  buffer_load_dwordx4 v202, s[4:7], s60 offen offset:384 lds
  s_add_u32 m0, s67, 3584
  s_nop 0
  buffer_load_dwordx4 v202, s[4:7], s60 offen offset:512 lds
  s_add_u32 m0, s67, 4480
  s_nop 0
  buffer_load_dwordx4 v202, s[4:7], s60 offen offset:640 lds
  s_add_u32 m0, s67, 5376
  s_nop 0
  buffer_load_dwordx4 v202, s[4:7], s60 offen offset:768 lds
  s_add_u32 m0, s67, 6272
  s_nop 0
  buffer_load_dwordx4 v202, s[4:7], s60 offen offset:896 lds
  s_add_u32 m0, s67, 7168
  s_nop 0
  buffer_load_dwordx4 v202, s[4:7], s60 offen offset:1024 lds
  v_and_b32 v211, 15, v200
  v_mul_u32_u24 v211, 72, v211
  v_lshrrev_b32 v212, 4, v200
  v_mul_u32_u24 v213, 1152, v212
  v_add_u32 v213, v213, v211
  s_lshl_b32 s54, s54, 2
  s_add_u32 s70, s54, s52
  s_mul_i32 s55, s70, 4608
  buffer_load_dwordx4 v[48:51], v213, s[4:7], s55 offen offset:0
  buffer_load_dwordx4 v[52:55], v213, s[4:7], s55 offen offset:16
  buffer_load_dwordx4 v[56:59], v213, s[4:7], s55 offen offset:32
  buffer_load_dwordx4 v[60:63], v213, s[4:7], s55 offen offset:48
  buffer_load_dwordx2 v[64:65], v213, s[4:7], s55 offen offset:64
  buffer_load_dwordx4 v[68:71], v211, s[44:47], 0 offen offset:0
  buffer_load_dwordx4 v[72:75], v211, s[44:47], 0 offen offset:16
  buffer_load_dwordx4 v[76:79], v211, s[44:47], 0 offen offset:32
  buffer_load_dwordx4 v[80:83], v211, s[44:47], 0 offen offset:48
  buffer_load_dwordx2 v[84:85], v211, s[44:47], 0 offen offset:64
  v_mov_b32 v0, 0
  v_mov_b32 v1, 0x3f803f80
  s_waitcnt vmcnt(9)
  v_lshlrev_b32 v2, 16, v48
  s_waitcnt vmcnt(4)
  v_lshlrev_b32 v3, 16, v68
  v_and_b32 v4, 0xffff0000, v48
  v_and_b32 v5, 0xffff0000, v68
  v_mul_f32 v2, v2, v3
  v_mul_f32 v4, v4, v5
  v_cvt_pk_bf16_f32 v2, v2, v4
  v_lshlrev_b32 v3, 16, v2
  v_and_b32 v4, 0xffff0000, v2
  v_add_f32 v0, v0, v3
  v_add_f32 v0, v0, v4
  v_lshlrev_b32 v2, 16, v49
  v_lshlrev_b32 v3, 16, v69
  v_and_b32 v4, 0xffff0000, v49
  v_and_b32 v5, 0xffff0000, v69
  v_mul_f32 v2, v2, v3
  v_mul_f32 v4, v4, v5
  v_cvt_pk_bf16_f32 v2, v2, v4
  v_lshlrev_b32 v3, 16, v2
  v_and_b32 v4, 0xffff0000, v2
  v_add_f32 v0, v0, v3
  v_add_f32 v0, v0, v4
  v_lshlrev_b32 v2, 16, v50
  v_lshlrev_b32 v3, 16, v70
  v_and_b32 v4, 0xffff0000, v50
  v_and_b32 v5, 0xffff0000, v70
  v_mul_f32 v2, v2, v3
  v_mul_f32 v4, v4, v5
  v_cvt_pk_bf16_f32 v2, v2, v4
  v_lshlrev_b32 v3, 16, v2
  v_and_b32 v4, 0xffff0000, v2
  v_add_f32 v0, v0, v3
  v_add_f32 v0, v0, v4
  v_lshlrev_b32 v2, 16, v51
  v_lshlrev_b32 v3, 16, v71
  v_and_b32 v4, 0xffff0000, v51
  v_and_b32 v5, 0xffff0000, v71
  v_mul_f32 v2, v2, v3
  v_mul_f32 v4, v4, v5
  v_cvt_pk_bf16_f32 v2, v2, v4
  v_lshlrev_b32 v3, 16, v2
  v_and_b32 v4, 0xffff0000, v2
  v_add_f32 v0, v0, v3
  v_add_f32 v0, v0, v4
  v_lshlrev_b32 v2, 16, v52
  s_waitcnt vmcnt(3)
  v_lshlrev_b32 v3, 16, v72
  v_and_b32 v4, 0xffff0000, v52
  v_and_b32 v5, 0xffff0000, v72
  v_mul_f32 v2, v2, v3
  v_mul_f32 v4, v4, v5
  v_cvt_pk_bf16_f32 v2, v2, v4
  v_lshlrev_b32 v3, 16, v2
  v_and_b32 v4, 0xffff0000, v2
  v_add_f32 v0, v0, v3
  v_add_f32 v0, v0, v4
  v_lshlrev_b32 v2, 16, v53
  v_lshlrev_b32 v3, 16, v73
  v_and_b32 v4, 0xffff0000, v53
  v_and_b32 v5, 0xffff0000, v73
  v_mul_f32 v2, v2, v3
  v_mul_f32 v4, v4, v5
  v_cvt_pk_bf16_f32 v2, v2, v4
  v_lshlrev_b32 v3, 16, v2
  v_and_b32 v4, 0xffff0000, v2
  v_add_f32 v0, v0, v3
  v_add_f32 v0, v0, v4
  v_lshlrev_b32 v2, 16, v54
  v_lshlrev_b32 v3, 16, v74
  v_and_b32 v4, 0xffff0000, v54
  v_and_b32 v5, 0xffff0000, v74
  v_mul_f32 v2, v2, v3
  v_mul_f32 v4, v4, v5
  v_cvt_pk_bf16_f32 v2, v2, v4
  v_lshlrev_b32 v3, 16, v2
  v_and_b32 v4, 0xffff0000, v2
  v_add_f32 v0, v0, v3
  v_add_f32 v0, v0, v4
  v_lshlrev_b32 v2, 16, v55
  v_lshlrev_b32 v3, 16, v75
  v_and_b32 v4, 0xffff0000, v55
  v_and_b32 v5, 0xffff0000, v75
  v_mul_f32 v2, v2, v3
  v_mul_f32 v4, v4, v5
  v_cvt_pk_bf16_f32 v2, v2, v4
  v_lshlrev_b32 v3, 16, v2
  v_and_b32 v4, 0xffff0000, v2
  v_add_f32 v0, v0, v3
  v_add_f32 v0, v0, v4
  v_lshlrev_b32 v2, 16, v56
  s_waitcnt vmcnt(2)
  v_lshlrev_b32 v3, 16, v76
  v_and_b32 v4, 0xffff0000, v56
  v_and_b32 v5, 0xffff0000, v76
  v_mul_f32 v2, v2, v3
  v_mul_f32 v4, v4, v5
  v_cvt_pk_bf16_f32 v2, v2, v4
  v_lshlrev_b32 v3, 16, v2
  v_and_b32 v4, 0xffff0000, v2
  v_add_f32 v0, v0, v3
  v_add_f32 v0, v0, v4
  v_lshlrev_b32 v2, 16, v57
  v_lshlrev_b32 v3, 16, v77
  v_and_b32 v4, 0xffff0000, v57
  v_and_b32 v5, 0xffff0000, v77
  v_mul_f32 v2, v2, v3
  v_mul_f32 v4, v4, v5
  v_cvt_pk_bf16_f32 v2, v2, v4
  v_lshlrev_b32 v3, 16, v2
  v_and_b32 v4, 0xffff0000, v2
  v_add_f32 v0, v0, v3
  v_add_f32 v0, v0, v4
  v_lshlrev_b32 v2, 16, v58
  v_lshlrev_b32 v3, 16, v78
  v_and_b32 v4, 0xffff0000, v58
  v_and_b32 v5, 0xffff0000, v78
  v_mul_f32 v2, v2, v3
  v_mul_f32 v4, v4, v5
  v_cvt_pk_bf16_f32 v2, v2, v4
  v_lshlrev_b32 v3, 16, v2
  v_and_b32 v4, 0xffff0000, v2
  v_add_f32 v0, v0, v3
  v_add_f32 v0, v0, v4
  v_lshlrev_b32 v2, 16, v59
  v_lshlrev_b32 v3, 16, v79
  v_and_b32 v4, 0xffff0000, v59
  v_and_b32 v5, 0xffff0000, v79
  v_mul_f32 v2, v2, v3
  v_mul_f32 v4, v4, v5
  v_cvt_pk_bf16_f32 v2, v2, v4
  v_lshlrev_b32 v3, 16, v2
  v_and_b32 v4, 0xffff0000, v2
  v_add_f32 v0, v0, v3
  v_add_f32 v0, v0, v4
  v_lshlrev_b32 v2, 16, v60
  s_waitcnt vmcnt(1)
  v_lshlrev_b32 v3, 16, v80
  v_and_b32 v4, 0xffff0000, v60
  v_and_b32 v5, 0xffff0000, v80
  v_mul_f32 v2, v2, v3
  v_mul_f32 v4, v4, v5
  v_cvt_pk_bf16_f32 v2, v2, v4
  v_lshlrev_b32 v3, 16, v2
  v_and_b32 v4, 0xffff0000, v2
  v_add_f32 v0, v0, v3
  v_add_f32 v0, v0, v4
  v_lshlrev_b32 v2, 16, v61
  v_lshlrev_b32 v3, 16, v81
  v_and_b32 v4, 0xffff0000, v61
  v_and_b32 v5, 0xffff0000, v81
  v_mul_f32 v2, v2, v3
  v_mul_f32 v4, v4, v5
  v_cvt_pk_bf16_f32 v2, v2, v4
  v_lshlrev_b32 v3, 16, v2
  v_and_b32 v4, 0xffff0000, v2
  v_add_f32 v0, v0, v3
  v_add_f32 v0, v0, v4
  v_lshlrev_b32 v2, 16, v62
  v_lshlrev_b32 v3, 16, v82
  v_and_b32 v4, 0xffff0000, v62
  v_and_b32 v5, 0xffff0000, v82
  v_mul_f32 v2, v2, v3
  v_mul_f32 v4, v4, v5
  v_cvt_pk_bf16_f32 v2, v2, v4
  v_lshlrev_b32 v3, 16, v2
  v_and_b32 v4, 0xffff0000, v2
  v_add_f32 v0, v0, v3
  v_add_f32 v0, v0, v4
  v_lshlrev_b32 v2, 16, v63
  v_lshlrev_b32 v3, 16, v83
  v_and_b32 v4, 0xffff0000, v63
  v_and_b32 v5, 0xffff0000, v83
  v_mul_f32 v2, v2, v3
  v_mul_f32 v4, v4, v5
  v_cvt_pk_bf16_f32 v2, v2, v4
  v_lshlrev_b32 v3, 16, v2
  v_and_b32 v4, 0xffff0000, v2
  v_add_f32 v0, v0, v3
  v_add_f32 v0, v0, v4
  v_lshlrev_b32 v2, 16, v64
  s_waitcnt vmcnt(0)
  v_lshlrev_b32 v3, 16, v84
  v_and_b32 v4, 0xffff0000, v64
  v_and_b32 v5, 0xffff0000, v84
  v_mul_f32 v2, v2, v3
  v_mul_f32 v4, v4, v5
  v_cvt_pk_bf16_f32 v2, v2, v4
  v_lshlrev_b32 v3, 16, v2
  v_and_b32 v4, 0xffff0000, v2
  v_add_f32 v0, v0, v3
  v_add_f32 v0, v0, v4
  v_lshlrev_b32 v2, 16, v65
  v_lshlrev_b32 v3, 16, v85
  v_and_b32 v4, 0xffff0000, v65
  v_and_b32 v5, 0xffff0000, v85
  v_mul_f32 v2, v2, v3
  v_mul_f32 v4, v4, v5
  v_cvt_pk_bf16_f32 v2, v2, v4
  v_lshlrev_b32 v3, 16, v2
  v_and_b32 v4, 0xffff0000, v2
  v_add_f32 v0, v0, v3
  v_add_f32 v0, v0, v4
  s_nop 1
  v_add_f32_dpp v0, v0, v0 row_ror:1 row_mask:0xf bank_mask:0xf
  s_nop 1
  v_add_f32_dpp v0, v0, v0 row_ror:2 row_mask:0xf bank_mask:0xf
  s_nop 1
  v_add_f32_dpp v0, v0, v0 row_ror:4 row_mask:0xf bank_mask:0xf
  s_nop 1
  v_add_f32_dpp v0, v0, v0 row_ror:8 row_mask:0xf bank_mask:0xf
  v_cvt_pk_bf16_f32 v0, v0, v0
  v_lshlrev_b32 v0, 16, v0
  v_mul_f32 v0, 3216550459, v0
  v_exp_f32 v0, v0
  s_nop 0
  v_add_f32 v0, 1.0, v0
  v_rcp_f32 v0, v0
  s_nop 0
  v_cvt_pk_bf16_f32 v0, v0, v0
  v_lshlrev_b32 v0, 16, v0
  v_lshlrev_b32 v212, 2, v212
  s_lshl_b32 s55, s70, 4
  s_add_u32 s55, s55, 66060288
  s_mov_b32 exec_lo, 0x00010001
  s_mov_b32 exec_hi, 0x00010001
  buffer_store_dword v0, v212, s[8:11], s55 offen sc1
  s_mov_b64 exec, -1
  v_lshrrev_b32 v211, 4, v200
  v_lshlrev_b32 v212, 2, v211
  v_and_b32 v213, 15, v200
  v_xor_b32 v212, v212, v213
  v_mul_u32_u24 v211, 3456, v211
  v_mov_b32 v2, 0x40000000
  v_add_u32 v213, 0, v212
  v_mul_u32_u24 v214, 57, v213
  v_lshrrev_b32 v214, 9, v214
  v_mul_u32_u24 v214, 1008, v214
  v_lshl_add_u32 v214, v213, 4, v214
  v_add_u32 v214, v214, v211
  v_cmp_lt_u32 vcc, 26, v213
  s_nop 1
  v_cndmask_b32 v207, v214, v2, vcc
  v_add_u32 v213, 16, v212
  v_mul_u32_u24 v214, 57, v213
  v_lshrrev_b32 v214, 9, v214
  v_mul_u32_u24 v214, 1008, v214
  v_lshl_add_u32 v214, v213, 4, v214
  v_add_u32 v214, v214, v211
  v_cmp_lt_u32 vcc, 26, v213
  s_nop 1
  v_cndmask_b32 v208, v214, v2, vcc
  s_mul_i32 s62, s68, 144
  s_mul_i32 s54, s52, 13824
  s_add_u32 s62, s62, s54
  s_waitcnt vmcnt(0)
  s_lshl_b32 s61, s52, 10
  s_add_u32 s61, s61, 36864
  s_add_u32 m0, s61, 0
  s_add_u32 s54, s62, 0
  buffer_load_dwordx4 v207, s[36:39], s54 offen lds
  s_add_u32 m0, s61, 4096
  s_add_u32 s54, s62, 55296
  buffer_load_dwordx4 v207, s[36:39], s54 offen lds
  s_add_u32 m0, s61, 8192
  s_add_u32 s54, s62, 110592
  buffer_load_dwordx4 v207, s[36:39], s54 offen lds
  s_add_u32 m0, s61, 12288
  s_add_u32 s54, s62, 165888
  buffer_load_dwordx4 v207, s[36:39], s54 offen lds
  s_add_u32 m0, s61, 16384
  s_add_u32 s54, s62, 0
  buffer_load_dwordx4 v208, s[36:39], s54 offen lds
  s_add_u32 m0, s61, 20480
  s_add_u32 s54, s62, 55296
  buffer_load_dwordx4 v208, s[36:39], s54 offen lds
  s_add_u32 m0, s61, 24576
  s_add_u32 s54, s62, 110592
  buffer_load_dwordx4 v208, s[36:39], s54 offen lds
  s_add_u32 m0, s61, 28672
  s_add_u32 s54, s62, 165888
  buffer_load_dwordx4 v208, s[36:39], s54 offen lds
  s_add_u32 m0, s61, 32768
  s_add_u32 s54, s62, 221184
  buffer_load_dwordx4 v207, s[36:39], s54 offen lds
  s_add_u32 m0, s61, 36864
  s_add_u32 s54, s62, 276480
  buffer_load_dwordx4 v207, s[36:39], s54 offen lds
  s_add_u32 m0, s61, 40960
  s_add_u32 s54, s62, 331776
  buffer_load_dwordx4 v207, s[36:39], s54 offen lds
  s_add_u32 m0, s61, 45056
  s_add_u32 s54, s62, 387072
  buffer_load_dwordx4 v207, s[36:39], s54 offen lds
  s_add_u32 m0, s61, 49152
  s_add_u32 s54, s62, 221184
  buffer_load_dwordx4 v208, s[36:39], s54 offen lds
  s_add_u32 m0, s61, 53248
  s_add_u32 s54, s62, 276480
  buffer_load_dwordx4 v208, s[36:39], s54 offen lds
  s_add_u32 m0, s61, 57344
  s_add_u32 s54, s62, 331776
  buffer_load_dwordx4 v208, s[36:39], s54 offen lds
  s_add_u32 m0, s61, 61440
  s_add_u32 s54, s62, 387072
  buffer_load_dwordx4 v208, s[36:39], s54 offen lds
  s_add_u32 m0, s61, 65536
  s_add_u32 s54, s62, 442368
  buffer_load_dwordx4 v207, s[36:39], s54 offen lds
  s_add_u32 m0, s61, 69632
  s_add_u32 s54, s62, 497664
  buffer_load_dwordx4 v207, s[36:39], s54 offen lds
  s_add_u32 m0, s61, 73728
  s_add_u32 s54, s62, 552960
  buffer_load_dwordx4 v207, s[36:39], s54 offen lds
  s_add_u32 m0, s61, 77824
  s_add_u32 s54, s62, 608256
  buffer_load_dwordx4 v207, s[36:39], s54 offen lds
  s_add_u32 m0, s61, 81920
  s_add_u32 s54, s62, 442368
  buffer_load_dwordx4 v208, s[36:39], s54 offen lds
  s_add_u32 m0, s61, 86016
  s_add_u32 s54, s62, 497664
  buffer_load_dwordx4 v208, s[36:39], s54 offen lds
  s_add_u32 m0, s61, 90112
  s_add_u32 s54, s62, 552960
  buffer_load_dwordx4 v208, s[36:39], s54 offen lds
  s_add_u32 m0, s61, 94208
  s_add_u32 s54, s62, 608256
  buffer_load_dwordx4 v208, s[36:39], s54 offen lds
  s_waitcnt vmcnt(20) lgkmcnt(0)
  s_barrier
  s_add_u32 m0, s61, 98304
  s_add_u32 s54, s62, 663552
  buffer_load_dwordx4 v207, s[36:39], s54 offen lds
  s_add_u32 m0, s61, 102400
  s_add_u32 s54, s62, 718848
  buffer_load_dwordx4 v207, s[36:39], s54 offen lds
  s_add_u32 m0, s61, 106496
  s_add_u32 s54, s62, 774144
  buffer_load_dwordx4 v207, s[36:39], s54 offen lds
  s_add_u32 m0, s61, 110592
  s_add_u32 s54, s62, 829440
  buffer_load_dwordx4 v207, s[36:39], s54 offen lds
  v_add_u32 v215, 36864, v210
  ds_read_b64_tr_b16 a[0:1], v215 offset:0
  ds_read_b64_tr_b16 a[2:3], v215 offset:1024
  ds_read_b64_tr_b16 a[4:5], v215 offset:4096
  ds_read_b64_tr_b16 a[6:7], v215 offset:5120
  ds_read_b64_tr_b16 a[8:9], v215 offset:8192
  ds_read_b64_tr_b16 a[10:11], v215 offset:9216
  ds_read_b64_tr_b16 a[12:13], v215 offset:12288
  ds_read_b64_tr_b16 a[14:15], v215 offset:13312
  s_waitcnt vmcnt(20) lgkmcnt(0)
  s_barrier
  s_add_u32 m0, s61, 0
  s_add_u32 s54, s62, 663552
  buffer_load_dwordx4 v208, s[36:39], s54 offen lds
  s_add_u32 m0, s61, 4096
  s_add_u32 s54, s62, 718848
  buffer_load_dwordx4 v208, s[36:39], s54 offen lds
  s_add_u32 m0, s61, 8192
  s_add_u32 s54, s62, 774144
  buffer_load_dwordx4 v208, s[36:39], s54 offen lds
  s_add_u32 m0, s61, 12288
  s_add_u32 s54, s62, 829440
  buffer_load_dwordx4 v208, s[36:39], s54 offen lds
  v_add_u32 v215, 53248, v210
  ds_read_b64_tr_b16 a[144:145], v215 offset:0
  ds_read_b64_tr_b16 a[146:147], v215 offset:1024
  ds_read_b64_tr_b16 a[148:149], v215 offset:4096
  ds_read_b64_tr_b16 a[150:151], v215 offset:5120
  ds_read_b64_tr_b16 a[152:153], v215 offset:8192
  ds_read_b64_tr_b16 a[154:155], v215 offset:9216
  ds_read_b64_tr_b16 a[156:157], v215 offset:12288
  ds_read_b64_tr_b16 a[158:159], v215 offset:13312
  s_waitcnt vmcnt(20) lgkmcnt(0)
  s_barrier
  s_add_u32 m0, s61, 16384
  s_add_u32 s54, s62, 884736
  buffer_load_dwordx4 v207, s[36:39], s54 offen lds
  s_add_u32 m0, s61, 20480
  s_add_u32 s54, s62, 940032
  buffer_load_dwordx4 v207, s[36:39], s54 offen lds
  s_add_u32 m0, s61, 24576
  s_add_u32 s54, s62, 995328
  buffer_load_dwordx4 v207, s[36:39], s54 offen lds
  s_add_u32 m0, s61, 28672
  s_add_u32 s54, s62, 1050624
  buffer_load_dwordx4 v207, s[36:39], s54 offen lds
  v_add_u32 v215, 69632, v210
  ds_read_b64_tr_b16 a[16:17], v215 offset:0
  ds_read_b64_tr_b16 a[18:19], v215 offset:1024
  ds_read_b64_tr_b16 a[20:21], v215 offset:4096
  ds_read_b64_tr_b16 a[22:23], v215 offset:5120
  ds_read_b64_tr_b16 a[24:25], v215 offset:8192
  ds_read_b64_tr_b16 a[26:27], v215 offset:9216
  ds_read_b64_tr_b16 a[28:29], v215 offset:12288
  ds_read_b64_tr_b16 a[30:31], v215 offset:13312
  s_waitcnt vmcnt(20) lgkmcnt(0)
  s_barrier
  s_add_u32 m0, s61, 32768
  s_add_u32 s54, s62, 884736
  buffer_load_dwordx4 v208, s[36:39], s54 offen lds
  s_add_u32 m0, s61, 36864
  s_add_u32 s54, s62, 940032
  buffer_load_dwordx4 v208, s[36:39], s54 offen lds
  s_add_u32 m0, s61, 40960
  s_add_u32 s54, s62, 995328
  buffer_load_dwordx4 v208, s[36:39], s54 offen lds
  s_add_u32 m0, s61, 45056
  s_add_u32 s54, s62, 1050624
  buffer_load_dwordx4 v208, s[36:39], s54 offen lds
  v_add_u32 v215, 86016, v210
  ds_read_b64_tr_b16 a[160:161], v215 offset:0
  ds_read_b64_tr_b16 a[162:163], v215 offset:1024
  ds_read_b64_tr_b16 a[164:165], v215 offset:4096
  ds_read_b64_tr_b16 a[166:167], v215 offset:5120
  ds_read_b64_tr_b16 a[168:169], v215 offset:8192
  ds_read_b64_tr_b16 a[170:171], v215 offset:9216
  ds_read_b64_tr_b16 a[172:173], v215 offset:12288
  ds_read_b64_tr_b16 a[174:175], v215 offset:13312
  s_waitcnt vmcnt(20) lgkmcnt(0)
  s_barrier
  s_add_u32 m0, s61, 49152
  s_add_u32 s54, s62, 1105920
  buffer_load_dwordx4 v207, s[36:39], s54 offen lds
  s_add_u32 m0, s61, 53248
  s_add_u32 s54, s62, 1161216
  buffer_load_dwordx4 v207, s[36:39], s54 offen lds
  s_add_u32 m0, s61, 57344
  s_add_u32 s54, s62, 1216512
  buffer_load_dwordx4 v207, s[36:39], s54 offen lds
  s_add_u32 m0, s61, 61440
  s_add_u32 s54, s62, 1271808
  buffer_load_dwordx4 v207, s[36:39], s54 offen lds
  v_add_u32 v215, 102400, v210
  ds_read_b64_tr_b16 a[32:33], v215 offset:0
  ds_read_b64_tr_b16 a[34:35], v215 offset:1024
  ds_read_b64_tr_b16 a[36:37], v215 offset:4096
  ds_read_b64_tr_b16 a[38:39], v215 offset:5120
  ds_read_b64_tr_b16 a[40:41], v215 offset:8192
  ds_read_b64_tr_b16 a[42:43], v215 offset:9216
  ds_read_b64_tr_b16 a[44:45], v215 offset:12288
  ds_read_b64_tr_b16 a[46:47], v215 offset:13312
  s_waitcnt vmcnt(20) lgkmcnt(0)
  s_barrier
  s_add_u32 m0, s61, 65536
  s_add_u32 s54, s62, 1105920
  buffer_load_dwordx4 v208, s[36:39], s54 offen lds
  s_add_u32 m0, s61, 69632
  s_add_u32 s54, s62, 1161216
  buffer_load_dwordx4 v208, s[36:39], s54 offen lds
  s_add_u32 m0, s61, 73728
  s_add_u32 s54, s62, 1216512
  buffer_load_dwordx4 v208, s[36:39], s54 offen lds
  s_add_u32 m0, s61, 77824
  s_add_u32 s54, s62, 1271808
  buffer_load_dwordx4 v208, s[36:39], s54 offen lds
  v_add_u32 v215, 118784, v210
  ds_read_b64_tr_b16 a[176:177], v215 offset:0
  ds_read_b64_tr_b16 a[178:179], v215 offset:1024
  ds_read_b64_tr_b16 a[180:181], v215 offset:4096
  ds_read_b64_tr_b16 a[182:183], v215 offset:5120
  ds_read_b64_tr_b16 a[184:185], v215 offset:8192
  ds_read_b64_tr_b16 a[186:187], v215 offset:9216
  ds_read_b64_tr_b16 a[188:189], v215 offset:12288
  ds_read_b64_tr_b16 a[190:191], v215 offset:13312
  s_waitcnt vmcnt(20) lgkmcnt(0)
  s_barrier
  s_add_u32 m0, s61, 81920
  s_add_u32 s54, s62, 1327104
  buffer_load_dwordx4 v207, s[36:39], s54 offen lds
  s_add_u32 m0, s61, 86016
  s_add_u32 s54, s62, 1382400
  buffer_load_dwordx4 v207, s[36:39], s54 offen lds
  s_add_u32 m0, s61, 90112
  s_add_u32 s54, s62, 1437696
  buffer_load_dwordx4 v207, s[36:39], s54 offen lds
  s_add_u32 m0, s61, 94208
  s_add_u32 s54, s62, 1492992
  buffer_load_dwordx4 v207, s[36:39], s54 offen lds
  v_add_u32 v215, 135168, v210
  ds_read_b64_tr_b16 a[48:49], v215 offset:0
  ds_read_b64_tr_b16 a[50:51], v215 offset:1024
  ds_read_b64_tr_b16 a[52:53], v215 offset:4096
  ds_read_b64_tr_b16 a[54:55], v215 offset:5120
  ds_read_b64_tr_b16 a[56:57], v215 offset:8192
  ds_read_b64_tr_b16 a[58:59], v215 offset:9216
  ds_read_b64_tr_b16 a[60:61], v215 offset:12288
  ds_read_b64_tr_b16 a[62:63], v215 offset:13312
  s_waitcnt vmcnt(20) lgkmcnt(0)
  s_barrier
  s_add_u32 m0, s61, 98304
  s_add_u32 s54, s62, 1327104
  buffer_load_dwordx4 v208, s[36:39], s54 offen lds
  s_add_u32 m0, s61, 102400
  s_add_u32 s54, s62, 1382400
  buffer_load_dwordx4 v208, s[36:39], s54 offen lds
  s_add_u32 m0, s61, 106496
  s_add_u32 s54, s62, 1437696
  buffer_load_dwordx4 v208, s[36:39], s54 offen lds
  s_add_u32 m0, s61, 110592
  s_add_u32 s54, s62, 1492992
  buffer_load_dwordx4 v208, s[36:39], s54 offen lds
  v_add_u32 v215, 36864, v210
  ds_read_b64_tr_b16 a[192:193], v215 offset:0
  ds_read_b64_tr_b16 a[194:195], v215 offset:1024
  ds_read_b64_tr_b16 a[196:197], v215 offset:4096
  ds_read_b64_tr_b16 a[198:199], v215 offset:5120
  ds_read_b64_tr_b16 a[200:201], v215 offset:8192
  ds_read_b64_tr_b16 a[202:203], v215 offset:9216
  ds_read_b64_tr_b16 a[204:205], v215 offset:12288
  ds_read_b64_tr_b16 a[206:207], v215 offset:13312
  s_waitcnt vmcnt(20) lgkmcnt(0)
  s_barrier
  s_add_u32 m0, s61, 0
  s_add_u32 s54, s62, 1548288
  buffer_load_dwordx4 v207, s[36:39], s54 offen lds
  s_add_u32 m0, s61, 4096
  s_add_u32 s54, s62, 1603584
  buffer_load_dwordx4 v207, s[36:39], s54 offen lds
  s_add_u32 m0, s61, 8192
  s_add_u32 s54, s62, 1658880
  buffer_load_dwordx4 v207, s[36:39], s54 offen lds
  s_add_u32 m0, s61, 12288
  s_add_u32 s54, s62, 1714176
  buffer_load_dwordx4 v207, s[36:39], s54 offen lds
  v_add_u32 v215, 53248, v210
  ds_read_b64_tr_b16 a[64:65], v215 offset:0
  ds_read_b64_tr_b16 a[66:67], v215 offset:1024
  ds_read_b64_tr_b16 a[68:69], v215 offset:4096
  ds_read_b64_tr_b16 a[70:71], v215 offset:5120
  ds_read_b64_tr_b16 a[72:73], v215 offset:8192
  ds_read_b64_tr_b16 a[74:75], v215 offset:9216
  ds_read_b64_tr_b16 a[76:77], v215 offset:12288
  ds_read_b64_tr_b16 a[78:79], v215 offset:13312
  s_waitcnt vmcnt(20) lgkmcnt(0)
  s_barrier
  s_add_u32 m0, s61, 16384
  s_add_u32 s54, s62, 1548288
  buffer_load_dwordx4 v208, s[36:39], s54 offen lds
  s_add_u32 m0, s61, 20480
  s_add_u32 s54, s62, 1603584
  buffer_load_dwordx4 v208, s[36:39], s54 offen lds
  s_add_u32 m0, s61, 24576
  s_add_u32 s54, s62, 1658880
  buffer_load_dwordx4 v208, s[36:39], s54 offen lds
  s_add_u32 m0, s61, 28672
  s_add_u32 s54, s62, 1714176
  buffer_load_dwordx4 v208, s[36:39], s54 offen lds
  v_add_u32 v215, 69632, v210
  ds_read_b64_tr_b16 a[208:209], v215 offset:0
  ds_read_b64_tr_b16 a[210:211], v215 offset:1024
  ds_read_b64_tr_b16 a[212:213], v215 offset:4096
  ds_read_b64_tr_b16 a[214:215], v215 offset:5120
  ds_read_b64_tr_b16 a[216:217], v215 offset:8192
  ds_read_b64_tr_b16 a[218:219], v215 offset:9216
  ds_read_b64_tr_b16 a[220:221], v215 offset:12288
  ds_read_b64_tr_b16 a[222:223], v215 offset:13312
  s_waitcnt vmcnt(20) lgkmcnt(0)
  s_barrier
  s_add_u32 m0, s61, 32768
  s_add_u32 s54, s62, 1769472
  buffer_load_dwordx4 v207, s[36:39], s54 offen lds
  s_add_u32 m0, s61, 36864
  s_add_u32 s54, s62, 1824768
  buffer_load_dwordx4 v207, s[36:39], s54 offen lds
  s_add_u32 m0, s61, 40960
  s_add_u32 s54, s62, 1880064
  buffer_load_dwordx4 v207, s[36:39], s54 offen lds
  s_add_u32 m0, s61, 45056
  s_add_u32 s54, s62, 1935360
  buffer_load_dwordx4 v207, s[36:39], s54 offen lds
  v_add_u32 v215, 86016, v210
  ds_read_b64_tr_b16 a[80:81], v215 offset:0
  ds_read_b64_tr_b16 a[82:83], v215 offset:1024
  ds_read_b64_tr_b16 a[84:85], v215 offset:4096
  ds_read_b64_tr_b16 a[86:87], v215 offset:5120
  ds_read_b64_tr_b16 a[88:89], v215 offset:8192
  ds_read_b64_tr_b16 a[90:91], v215 offset:9216
  ds_read_b64_tr_b16 a[92:93], v215 offset:12288
  ds_read_b64_tr_b16 a[94:95], v215 offset:13312
  s_waitcnt vmcnt(20) lgkmcnt(0)
  s_barrier
  s_add_u32 m0, s61, 49152
  s_add_u32 s54, s62, 1769472
  buffer_load_dwordx4 v208, s[36:39], s54 offen lds
  s_add_u32 m0, s61, 53248
  s_add_u32 s54, s62, 1824768
  buffer_load_dwordx4 v208, s[36:39], s54 offen lds
  s_add_u32 m0, s61, 57344
  s_add_u32 s54, s62, 1880064
  buffer_load_dwordx4 v208, s[36:39], s54 offen lds
  s_add_u32 m0, s61, 61440
  s_add_u32 s54, s62, 1935360
  buffer_load_dwordx4 v208, s[36:39], s54 offen lds
  v_add_u32 v215, 102400, v210
  ds_read_b64_tr_b16 a[224:225], v215 offset:0
  ds_read_b64_tr_b16 a[226:227], v215 offset:1024
  ds_read_b64_tr_b16 a[228:229], v215 offset:4096
  ds_read_b64_tr_b16 a[230:231], v215 offset:5120
  ds_read_b64_tr_b16 a[232:233], v215 offset:8192
  ds_read_b64_tr_b16 a[234:235], v215 offset:9216
  ds_read_b64_tr_b16 a[236:237], v215 offset:12288
  ds_read_b64_tr_b16 a[238:239], v215 offset:13312
  s_waitcnt vmcnt(20) lgkmcnt(0)
  s_barrier
  v_add_u32 v215, 118784, v210
  ds_read_b64_tr_b16 a[96:97], v215 offset:0
  ds_read_b64_tr_b16 a[98:99], v215 offset:1024
  ds_read_b64_tr_b16 a[100:101], v215 offset:4096
  ds_read_b64_tr_b16 a[102:103], v215 offset:5120
  ds_read_b64_tr_b16 a[104:105], v215 offset:8192
  ds_read_b64_tr_b16 a[106:107], v215 offset:9216
  ds_read_b64_tr_b16 a[108:109], v215 offset:12288
  ds_read_b64_tr_b16 a[110:111], v215 offset:13312
  s_waitcnt vmcnt(16) lgkmcnt(0)
  s_barrier
  v_add_u32 v215, 135168, v210
  ds_read_b64_tr_b16 a[240:241], v215 offset:0
  ds_read_b64_tr_b16 a[242:243], v215 offset:1024
  ds_read_b64_tr_b16 a[244:245], v215 offset:4096
  ds_read_b64_tr_b16 a[246:247], v215 offset:5120
  ds_read_b64_tr_b16 a[248:249], v215 offset:8192
  ds_read_b64_tr_b16 a[250:251], v215 offset:9216
  ds_read_b64_tr_b16 a[252:253], v215 offset:12288
  ds_read_b64_tr_b16 a[254:255], v215 offset:13312
  s_waitcnt vmcnt(12) lgkmcnt(0)
  s_barrier
  v_add_u32 v215, 36864, v210
  ds_read_b64_tr_b16 a[112:113], v215 offset:0
  ds_read_b64_tr_b16 a[114:115], v215 offset:1024
  ds_read_b64_tr_b16 a[116:117], v215 offset:4096
  ds_read_b64_tr_b16 a[118:119], v215 offset:5120
  ds_read_b64_tr_b16 a[120:121], v215 offset:8192
  ds_read_b64_tr_b16 a[122:123], v215 offset:9216
  ds_read_b64_tr_b16 a[124:125], v215 offset:12288
  ds_read_b64_tr_b16 a[126:127], v215 offset:13312
  s_waitcnt vmcnt(8) lgkmcnt(0)
  s_barrier
  v_add_u32 v215, 53248, v210
  ds_read_b64_tr_b16 v[224:225], v215 offset:0
  ds_read_b64_tr_b16 v[226:227], v215 offset:1024
  ds_read_b64_tr_b16 v[228:229], v215 offset:4096
  ds_read_b64_tr_b16 v[230:231], v215 offset:5120
  ds_read_b64_tr_b16 v[232:233], v215 offset:8192
  ds_read_b64_tr_b16 v[234:235], v215 offset:9216
  ds_read_b64_tr_b16 v[236:237], v215 offset:12288
  ds_read_b64_tr_b16 v[238:239], v215 offset:13312
  s_waitcnt vmcnt(4) lgkmcnt(0)
  s_barrier
  v_add_u32 v215, 69632, v210
  ds_read_b64_tr_b16 a[128:129], v215 offset:0
  ds_read_b64_tr_b16 a[130:131], v215 offset:1024
  ds_read_b64_tr_b16 a[132:133], v215 offset:4096
  ds_read_b64_tr_b16 a[134:135], v215 offset:5120
  ds_read_b64_tr_b16 a[136:137], v215 offset:8192
  ds_read_b64_tr_b16 a[138:139], v215 offset:9216
  ds_read_b64_tr_b16 a[140:141], v215 offset:12288
  ds_read_b64_tr_b16 a[142:143], v215 offset:13312
  s_waitcnt vmcnt(0) lgkmcnt(0)
  s_barrier
  v_add_u32 v215, 86016, v210
  ds_read_b64_tr_b16 v[240:241], v215 offset:0
  ds_read_b64_tr_b16 v[242:243], v215 offset:1024
  ds_read_b64_tr_b16 v[244:245], v215 offset:4096
  ds_read_b64_tr_b16 v[246:247], v215 offset:5120
  ds_read_b64_tr_b16 v[248:249], v215 offset:8192
  ds_read_b64_tr_b16 v[250:251], v215 offset:9216
  ds_read_b64_tr_b16 v[252:253], v215 offset:12288
  ds_read_b64_tr_b16 v[254:255], v215 offset:13312
  s_waitcnt lgkmcnt(0)
  s_barrier
  v_and_b32 v211, 31, v200
  v_mul_u32_u24 v218, 516, v211
  v_lshrrev_b32 v212, 5, v200
  v_lshl_add_u32 v218, v212, 3, v218
  s_lshl_b32 s54, s52, 6
  s_add_u32 s54, s54, 73728
  v_add_u32 v218, s54, v218
  s_lshl_b32 s60, s69, 2
  s_mul_i32 s60, s60, 36864
  ds_read_b128 v[32:35], v203 offset:0
  ds_read_b128 v[36:39], v204 offset:0
  ds_read_b128 v[40:43], v205 offset:0
  s_waitcnt lgkmcnt(2)
  v_mfma_f32_32x32x16_bf16 v[0:15], a[0:3], v[32:35], 0
  ds_read_b128 v[44:47], v206 offset:0
  s_add_u32 m0, s67, 36864
  s_nop 0
  buffer_load_dwordx4 v202, s[4:7], s60 offen offset:0 lds
  v_mfma_f32_32x32x16_bf16 v[16:31], a[144:147], v[32:35], 0
  s_waitcnt lgkmcnt(2)
  v_mfma_f32_32x32x16_bf16 v[0:15], a[4:7], v[36:39], v[0:15]
  ds_read_b128 v[32:35], v203 offset:1024
  s_add_u32 m0, s67, 37760
  s_nop 0
  buffer_load_dwordx4 v202, s[4:7], s60 offen offset:128 lds
  v_mfma_f32_32x32x16_bf16 v[16:31], a[148:151], v[36:39], v[16:31]
  s_waitcnt lgkmcnt(2)
  v_mfma_f32_32x32x16_bf16 v[0:15], a[8:11], v[40:43], v[0:15]
  ds_read_b128 v[36:39], v204 offset:1024
  s_add_u32 m0, s67, 38656
  s_nop 0
  buffer_load_dwordx4 v202, s[4:7], s60 offen offset:256 lds
  v_mfma_f32_32x32x16_bf16 v[16:31], a[152:155], v[40:43], v[16:31]
  s_waitcnt lgkmcnt(2)
  v_mfma_f32_32x32x16_bf16 v[0:15], a[12:15], v[44:47], v[0:15]
  ds_read_b128 v[40:43], v205 offset:1024
  s_add_u32 m0, s67, 39552
  s_nop 0
  buffer_load_dwordx4 v202, s[4:7], s60 offen offset:384 lds
  v_mfma_f32_32x32x16_bf16 v[16:31], a[156:159], v[44:47], v[16:31]
  s_waitcnt lgkmcnt(2)
  v_mfma_f32_32x32x16_bf16 v[0:15], a[16:19], v[32:35], v[0:15]
  ds_read_b128 v[44:47], v206 offset:1024
  s_add_u32 m0, s67, 40448
  s_nop 0
  buffer_load_dwordx4 v202, s[4:7], s60 offen offset:512 lds
  v_mfma_f32_32x32x16_bf16 v[16:31], a[160:163], v[32:35], v[16:31]
  s_waitcnt lgkmcnt(2)
  v_mfma_f32_32x32x16_bf16 v[0:15], a[20:23], v[36:39], v[0:15]
  ds_read_b128 v[32:35], v203 offset:2048
  s_add_u32 m0, s67, 41344
  s_nop 0
  buffer_load_dwordx4 v202, s[4:7], s60 offen offset:640 lds
  v_mfma_f32_32x32x16_bf16 v[16:31], a[164:167], v[36:39], v[16:31]
  s_waitcnt lgkmcnt(2)
  v_mfma_f32_32x32x16_bf16 v[0:15], a[24:27], v[40:43], v[0:15]
  ds_read_b128 v[36:39], v204 offset:2048
  s_add_u32 m0, s67, 42240
  s_nop 0
  buffer_load_dwordx4 v202, s[4:7], s60 offen offset:768 lds
  v_mfma_f32_32x32x16_bf16 v[16:31], a[168:171], v[40:43], v[16:31]
  s_waitcnt lgkmcnt(2)
  v_mfma_f32_32x32x16_bf16 v[0:15], a[28:31], v[44:47], v[0:15]
  ds_read_b128 v[40:43], v205 offset:2048
  s_add_u32 m0, s67, 43136
  s_nop 0
  buffer_load_dwordx4 v202, s[4:7], s60 offen offset:896 lds
  v_mfma_f32_32x32x16_bf16 v[16:31], a[172:175], v[44:47], v[16:31]
  s_waitcnt lgkmcnt(2)
  v_mfma_f32_32x32x16_bf16 v[0:15], a[32:35], v[32:35], v[0:15]
  ds_read_b128 v[44:47], v206 offset:2048
  s_add_u32 m0, s67, 44032
  s_nop 0
  buffer_load_dwordx4 v202, s[4:7], s60 offen offset:1024 lds
  v_mfma_f32_32x32x16_bf16 v[16:31], a[176:179], v[32:35], v[16:31]
  s_waitcnt lgkmcnt(2)
  v_mfma_f32_32x32x16_bf16 v[0:15], a[36:39], v[36:39], v[0:15]
  ds_read_b128 v[32:35], v203 offset:3072
  v_mfma_f32_32x32x16_bf16 v[16:31], a[180:183], v[36:39], v[16:31]
  s_waitcnt lgkmcnt(2)
  v_mfma_f32_32x32x16_bf16 v[0:15], a[40:43], v[40:43], v[0:15]
  ds_read_b128 v[36:39], v204 offset:3072
  v_mfma_f32_32x32x16_bf16 v[16:31], a[184:187], v[40:43], v[16:31]
  s_waitcnt lgkmcnt(2)
  v_mfma_f32_32x32x16_bf16 v[0:15], a[44:47], v[44:47], v[0:15]
  ds_read_b128 v[40:43], v205 offset:3072
  v_mfma_f32_32x32x16_bf16 v[16:31], a[188:191], v[44:47], v[16:31]
  s_waitcnt lgkmcnt(2)
  v_mfma_f32_32x32x16_bf16 v[0:15], a[48:51], v[32:35], v[0:15]
  ds_read_b128 v[44:47], v206 offset:3072
  v_mfma_f32_32x32x16_bf16 v[16:31], a[192:195], v[32:35], v[16:31]
  s_waitcnt lgkmcnt(2)
  v_mfma_f32_32x32x16_bf16 v[0:15], a[52:55], v[36:39], v[0:15]
  ds_read_b128 v[32:35], v203 offset:4096
  v_mfma_f32_32x32x16_bf16 v[16:31], a[196:199], v[36:39], v[16:31]
  s_waitcnt lgkmcnt(2)
  v_mfma_f32_32x32x16_bf16 v[0:15], a[56:59], v[40:43], v[0:15]
  ds_read_b128 v[36:39], v204 offset:4096
  v_mfma_f32_32x32x16_bf16 v[16:31], a[200:203], v[40:43], v[16:31]
  s_waitcnt lgkmcnt(2)
  v_mfma_f32_32x32x16_bf16 v[0:15], a[60:63], v[44:47], v[0:15]
  ds_read_b128 v[40:43], v205 offset:4096
  v_mfma_f32_32x32x16_bf16 v[16:31], a[204:207], v[44:47], v[16:31]
  s_waitcnt lgkmcnt(2)
  v_mfma_f32_32x32x16_bf16 v[0:15], a[64:67], v[32:35], v[0:15]
  ds_read_b128 v[44:47], v206 offset:4096
  v_mfma_f32_32x32x16_bf16 v[16:31], a[208:211], v[32:35], v[16:31]
  s_waitcnt lgkmcnt(2)
  v_mfma_f32_32x32x16_bf16 v[0:15], a[68:71], v[36:39], v[0:15]
  ds_read_b128 v[32:35], v203 offset:5120
  v_mfma_f32_32x32x16_bf16 v[16:31], a[212:215], v[36:39], v[16:31]
  s_waitcnt lgkmcnt(2)
  v_mfma_f32_32x32x16_bf16 v[0:15], a[72:75], v[40:43], v[0:15]
  ds_read_b128 v[36:39], v204 offset:5120
  v_mfma_f32_32x32x16_bf16 v[16:31], a[216:219], v[40:43], v[16:31]
  s_waitcnt lgkmcnt(2)
  v_mfma_f32_32x32x16_bf16 v[0:15], a[76:79], v[44:47], v[0:15]
  ds_read_b128 v[40:43], v205 offset:5120
  v_mfma_f32_32x32x16_bf16 v[16:31], a[220:223], v[44:47], v[16:31]
  s_waitcnt lgkmcnt(2)
  v_mfma_f32_32x32x16_bf16 v[0:15], a[80:83], v[32:35], v[0:15]
  ds_read_b128 v[44:47], v206 offset:5120
  v_mfma_f32_32x32x16_bf16 v[16:31], a[224:227], v[32:35], v[16:31]
  s_waitcnt lgkmcnt(2)
  v_mfma_f32_32x32x16_bf16 v[0:15], a[84:87], v[36:39], v[0:15]
  ds_read_b128 v[32:35], v203 offset:6144
  v_mfma_f32_32x32x16_bf16 v[16:31], a[228:231], v[36:39], v[16:31]
  s_waitcnt lgkmcnt(2)
  v_mfma_f32_32x32x16_bf16 v[0:15], a[88:91], v[40:43], v[0:15]
  ds_read_b128 v[36:39], v204 offset:6144
  v_mfma_f32_32x32x16_bf16 v[16:31], a[232:235], v[40:43], v[16:31]
  s_waitcnt lgkmcnt(2)
  v_mfma_f32_32x32x16_bf16 v[0:15], a[92:95], v[44:47], v[0:15]
  ds_read_b128 v[40:43], v205 offset:6144
  v_mfma_f32_32x32x16_bf16 v[16:31], a[236:239], v[44:47], v[16:31]
  s_waitcnt lgkmcnt(2)
  v_mfma_f32_32x32x16_bf16 v[0:15], a[96:99], v[32:35], v[0:15]
  ds_read_b128 v[44:47], v206 offset:6144
  v_mfma_f32_32x32x16_bf16 v[16:31], a[240:243], v[32:35], v[16:31]
  s_waitcnt lgkmcnt(2)
  v_mfma_f32_32x32x16_bf16 v[0:15], a[100:103], v[36:39], v[0:15]
  ds_read_b128 v[32:35], v203 offset:7168
  v_mfma_f32_32x32x16_bf16 v[16:31], a[244:247], v[36:39], v[16:31]
  s_waitcnt lgkmcnt(2)
  v_mfma_f32_32x32x16_bf16 v[0:15], a[104:107], v[40:43], v[0:15]
  ds_read_b128 v[36:39], v204 offset:7168
  v_mfma_f32_32x32x16_bf16 v[16:31], a[248:251], v[40:43], v[16:31]
  s_waitcnt lgkmcnt(2)
  v_mfma_f32_32x32x16_bf16 v[0:15], a[108:111], v[44:47], v[0:15]
  ds_read_b128 v[40:43], v205 offset:7168
  v_mfma_f32_32x32x16_bf16 v[16:31], a[252:255], v[44:47], v[16:31]
  s_waitcnt lgkmcnt(2)
  v_mfma_f32_32x32x16_bf16 v[0:15], a[112:115], v[32:35], v[0:15]
  ds_read_b128 v[44:47], v206 offset:7168
  v_mfma_f32_32x32x16_bf16 v[16:31], v[224:227], v[32:35], v[16:31]
  s_waitcnt lgkmcnt(2)
  v_mfma_f32_32x32x16_bf16 v[0:15], a[116:119], v[36:39], v[0:15]
  ds_read_b128 v[32:35], v203 offset:8192
  v_mfma_f32_32x32x16_bf16 v[16:31], v[228:231], v[36:39], v[16:31]
  s_waitcnt lgkmcnt(2)
  v_mfma_f32_32x32x16_bf16 v[0:15], a[120:123], v[40:43], v[0:15]
  ds_read_b128 v[36:39], v204 offset:8192
  v_mfma_f32_32x32x16_bf16 v[16:31], v[232:235], v[40:43], v[16:31]
  s_waitcnt lgkmcnt(2)
  v_mfma_f32_32x32x16_bf16 v[0:15], a[124:127], v[44:47], v[0:15]
  ds_read_b128 v[40:43], v205 offset:8192
  v_mfma_f32_32x32x16_bf16 v[16:31], v[236:239], v[44:47], v[16:31]
  s_waitcnt lgkmcnt(2)
  v_mfma_f32_32x32x16_bf16 v[0:15], a[128:131], v[32:35], v[0:15]
  ds_read_b128 v[44:47], v206 offset:8192
  v_mfma_f32_32x32x16_bf16 v[16:31], v[240:243], v[32:35], v[16:31]
  s_waitcnt lgkmcnt(2)
  v_mfma_f32_32x32x16_bf16 v[0:15], a[132:135], v[36:39], v[0:15]
  v_mfma_f32_32x32x16_bf16 v[16:31], v[244:247], v[36:39], v[16:31]
  s_waitcnt lgkmcnt(1)
  v_mfma_f32_32x32x16_bf16 v[0:15], a[136:139], v[40:43], v[0:15]
  v_mfma_f32_32x32x16_bf16 v[16:31], v[248:251], v[40:43], v[16:31]
  s_waitcnt lgkmcnt(0)
  v_mfma_f32_32x32x16_bf16 v[0:15], a[140:143], v[44:47], v[0:15]
  v_mfma_f32_32x32x16_bf16 v[16:31], v[252:255], v[44:47], v[16:31]
  s_add_u32 s60, s60, 36864
  s_nop 2
  v_cvt_pk_bf16_f32 v48, v0, v1
  v_cvt_pk_bf16_f32 v49, v2, v3
  ds_write2_b32 v218, v48, v49 offset0:0 offset1:1
  v_cvt_pk_bf16_f32 v48, v4, v5
  v_cvt_pk_bf16_f32 v49, v6, v7
  ds_write2_b32 v218, v48, v49 offset0:4 offset1:5
  v_cvt_pk_bf16_f32 v48, v8, v9
  v_cvt_pk_bf16_f32 v49, v10, v11
  ds_write2_b32 v218, v48, v49 offset0:8 offset1:9
  v_cvt_pk_bf16_f32 v48, v12, v13
  v_cvt_pk_bf16_f32 v49, v14, v15
  ds_write2_b32 v218, v48, v49 offset0:12 offset1:13
  v_cvt_pk_bf16_f32 v48, v16, v17
  v_cvt_pk_bf16_f32 v49, v18, v19
  ds_write2_b32 v218, v48, v49 offset0:64 offset1:65
  v_cvt_pk_bf16_f32 v48, v20, v21
  v_cvt_pk_bf16_f32 v49, v22, v23
  ds_write2_b32 v218, v48, v49 offset0:68 offset1:69
  v_cvt_pk_bf16_f32 v48, v24, v25
  v_cvt_pk_bf16_f32 v49, v26, v27
  ds_write2_b32 v218, v48, v49 offset0:72 offset1:73
  v_cvt_pk_bf16_f32 v48, v28, v29
  v_cvt_pk_bf16_f32 v49, v30, v31
  ds_write2_b32 v218, v48, v49 offset0:76 offset1:77
  v_add_u32 v218, 16512, v218
  s_waitcnt vmcnt(0) lgkmcnt(0)
  s_barrier
  ds_read_b128 v[32:35], v203 offset:36864
  ds_read_b128 v[36:39], v204 offset:36864
  ds_read_b128 v[40:43], v205 offset:36864
  s_waitcnt lgkmcnt(2)
  v_mfma_f32_32x32x16_bf16 v[0:15], a[0:3], v[32:35], 0
  ds_read_b128 v[44:47], v206 offset:36864
  s_add_u32 m0, s67, 0
  s_nop 0
  buffer_load_dwordx4 v202, s[4:7], s60 offen offset:0 lds
  v_mfma_f32_32x32x16_bf16 v[16:31], a[144:147], v[32:35], 0
  s_waitcnt lgkmcnt(2)
  v_mfma_f32_32x32x16_bf16 v[0:15], a[4:7], v[36:39], v[0:15]
  ds_read_b128 v[32:35], v203 offset:37888
  s_add_u32 m0, s67, 896
  s_nop 0
  buffer_load_dwordx4 v202, s[4:7], s60 offen offset:128 lds
  v_mfma_f32_32x32x16_bf16 v[16:31], a[148:151], v[36:39], v[16:31]
  s_waitcnt lgkmcnt(2)
  v_mfma_f32_32x32x16_bf16 v[0:15], a[8:11], v[40:43], v[0:15]
  ds_read_b128 v[36:39], v204 offset:37888
  s_add_u32 m0, s67, 1792
  s_nop 0
  buffer_load_dwordx4 v202, s[4:7], s60 offen offset:256 lds
  v_mfma_f32_32x32x16_bf16 v[16:31], a[152:155], v[40:43], v[16:31]
  s_waitcnt lgkmcnt(2)
  v_mfma_f32_32x32x16_bf16 v[0:15], a[12:15], v[44:47], v[0:15]
  ds_read_b128 v[40:43], v205 offset:37888
  s_add_u32 m0, s67, 2688
  s_nop 0
  buffer_load_dwordx4 v202, s[4:7], s60 offen offset:384 lds
  v_mfma_f32_32x32x16_bf16 v[16:31], a[156:159], v[44:47], v[16:31]
  s_waitcnt lgkmcnt(2)
  v_mfma_f32_32x32x16_bf16 v[0:15], a[16:19], v[32:35], v[0:15]
  ds_read_b128 v[44:47], v206 offset:37888
  s_add_u32 m0, s67, 3584
  s_nop 0
  buffer_load_dwordx4 v202, s[4:7], s60 offen offset:512 lds
  v_mfma_f32_32x32x16_bf16 v[16:31], a[160:163], v[32:35], v[16:31]
  s_waitcnt lgkmcnt(2)
  v_mfma_f32_32x32x16_bf16 v[0:15], a[20:23], v[36:39], v[0:15]
  ds_read_b128 v[32:35], v203 offset:38912
  s_add_u32 m0, s67, 4480
  s_nop 0
  buffer_load_dwordx4 v202, s[4:7], s60 offen offset:640 lds
  v_mfma_f32_32x32x16_bf16 v[16:31], a[164:167], v[36:39], v[16:31]
  s_waitcnt lgkmcnt(2)
  v_mfma_f32_32x32x16_bf16 v[0:15], a[24:27], v[40:43], v[0:15]
  ds_read_b128 v[36:39], v204 offset:38912
  s_add_u32 m0, s67, 5376
  s_nop 0
  buffer_load_dwordx4 v202, s[4:7], s60 offen offset:768 lds
  v_mfma_f32_32x32x16_bf16 v[16:31], a[168:171], v[40:43], v[16:31]
  s_waitcnt lgkmcnt(2)
  v_mfma_f32_32x32x16_bf16 v[0:15], a[28:31], v[44:47], v[0:15]
  ds_read_b128 v[40:43], v205 offset:38912
  s_add_u32 m0, s67, 6272
  s_nop 0
  buffer_load_dwordx4 v202, s[4:7], s60 offen offset:896 lds
  v_mfma_f32_32x32x16_bf16 v[16:31], a[172:175], v[44:47], v[16:31]
  s_waitcnt lgkmcnt(2)
  v_mfma_f32_32x32x16_bf16 v[0:15], a[32:35], v[32:35], v[0:15]
  ds_read_b128 v[44:47], v206 offset:38912
  s_add_u32 m0, s67, 7168
  s_nop 0
  buffer_load_dwordx4 v202, s[4:7], s60 offen offset:1024 lds
  v_mfma_f32_32x32x16_bf16 v[16:31], a[176:179], v[32:35], v[16:31]
  s_waitcnt lgkmcnt(2)
  v_mfma_f32_32x32x16_bf16 v[0:15], a[36:39], v[36:39], v[0:15]
  ds_read_b128 v[32:35], v203 offset:39936
  v_mfma_f32_32x32x16_bf16 v[16:31], a[180:183], v[36:39], v[16:31]
  s_waitcnt lgkmcnt(2)
  v_mfma_f32_32x32x16_bf16 v[0:15], a[40:43], v[40:43], v[0:15]
  ds_read_b128 v[36:39], v204 offset:39936
  v_mfma_f32_32x32x16_bf16 v[16:31], a[184:187], v[40:43], v[16:31]
  s_waitcnt lgkmcnt(2)
  v_mfma_f32_32x32x16_bf16 v[0:15], a[44:47], v[44:47], v[0:15]
  ds_read_b128 v[40:43], v205 offset:39936
  v_mfma_f32_32x32x16_bf16 v[16:31], a[188:191], v[44:47], v[16:31]
  s_waitcnt lgkmcnt(2)
  v_mfma_f32_32x32x16_bf16 v[0:15], a[48:51], v[32:35], v[0:15]
  ds_read_b128 v[44:47], v206 offset:39936
  v_mfma_f32_32x32x16_bf16 v[16:31], a[192:195], v[32:35], v[16:31]
  s_waitcnt lgkmcnt(2)
  v_mfma_f32_32x32x16_bf16 v[0:15], a[52:55], v[36:39], v[0:15]
  ds_read_b128 v[32:35], v203 offset:40960
  v_mfma_f32_32x32x16_bf16 v[16:31], a[196:199], v[36:39], v[16:31]
  s_waitcnt lgkmcnt(2)
  v_mfma_f32_32x32x16_bf16 v[0:15], a[56:59], v[40:43], v[0:15]
  ds_read_b128 v[36:39], v204 offset:40960
  v_mfma_f32_32x32x16_bf16 v[16:31], a[200:203], v[40:43], v[16:31]
  s_waitcnt lgkmcnt(2)
  v_mfma_f32_32x32x16_bf16 v[0:15], a[60:63], v[44:47], v[0:15]
  ds_read_b128 v[40:43], v205 offset:40960
  v_mfma_f32_32x32x16_bf16 v[16:31], a[204:207], v[44:47], v[16:31]
  s_waitcnt lgkmcnt(2)
  v_mfma_f32_32x32x16_bf16 v[0:15], a[64:67], v[32:35], v[0:15]
  ds_read_b128 v[44:47], v206 offset:40960
  v_mfma_f32_32x32x16_bf16 v[16:31], a[208:211], v[32:35], v[16:31]
  s_waitcnt lgkmcnt(2)
  v_mfma_f32_32x32x16_bf16 v[0:15], a[68:71], v[36:39], v[0:15]
  ds_read_b128 v[32:35], v203 offset:41984
  v_mfma_f32_32x32x16_bf16 v[16:31], a[212:215], v[36:39], v[16:31]
  s_waitcnt lgkmcnt(2)
  v_mfma_f32_32x32x16_bf16 v[0:15], a[72:75], v[40:43], v[0:15]
  ds_read_b128 v[36:39], v204 offset:41984
  v_mfma_f32_32x32x16_bf16 v[16:31], a[216:219], v[40:43], v[16:31]
  s_waitcnt lgkmcnt(2)
  v_mfma_f32_32x32x16_bf16 v[0:15], a[76:79], v[44:47], v[0:15]
  ds_read_b128 v[40:43], v205 offset:41984
  v_mfma_f32_32x32x16_bf16 v[16:31], a[220:223], v[44:47], v[16:31]
  s_waitcnt lgkmcnt(2)
  v_mfma_f32_32x32x16_bf16 v[0:15], a[80:83], v[32:35], v[0:15]
  ds_read_b128 v[44:47], v206 offset:41984
  v_mfma_f32_32x32x16_bf16 v[16:31], a[224:227], v[32:35], v[16:31]
  s_waitcnt lgkmcnt(2)
  v_mfma_f32_32x32x16_bf16 v[0:15], a[84:87], v[36:39], v[0:15]
  ds_read_b128 v[32:35], v203 offset:43008
  v_mfma_f32_32x32x16_bf16 v[16:31], a[228:231], v[36:39], v[16:31]
  s_waitcnt lgkmcnt(2)
  v_mfma_f32_32x32x16_bf16 v[0:15], a[88:91], v[40:43], v[0:15]
  ds_read_b128 v[36:39], v204 offset:43008
  v_mfma_f32_32x32x16_bf16 v[16:31], a[232:235], v[40:43], v[16:31]
  s_waitcnt lgkmcnt(2)
  v_mfma_f32_32x32x16_bf16 v[0:15], a[92:95], v[44:47], v[0:15]
  ds_read_b128 v[40:43], v205 offset:43008
  v_mfma_f32_32x32x16_bf16 v[16:31], a[236:239], v[44:47], v[16:31]
  s_waitcnt lgkmcnt(2)
  v_mfma_f32_32x32x16_bf16 v[0:15], a[96:99], v[32:35], v[0:15]
  ds_read_b128 v[44:47], v206 offset:43008
  v_mfma_f32_32x32x16_bf16 v[16:31], a[240:243], v[32:35], v[16:31]
  s_waitcnt lgkmcnt(2)
  v_mfma_f32_32x32x16_bf16 v[0:15], a[100:103], v[36:39], v[0:15]
  ds_read_b128 v[32:35], v203 offset:44032
  v_mfma_f32_32x32x16_bf16 v[16:31], a[244:247], v[36:39], v[16:31]
  s_waitcnt lgkmcnt(2)
  v_mfma_f32_32x32x16_bf16 v[0:15], a[104:107], v[40:43], v[0:15]
  ds_read_b128 v[36:39], v204 offset:44032
  v_mfma_f32_32x32x16_bf16 v[16:31], a[248:251], v[40:43], v[16:31]
  s_waitcnt lgkmcnt(2)
  v_mfma_f32_32x32x16_bf16 v[0:15], a[108:111], v[44:47], v[0:15]
  ds_read_b128 v[40:43], v205 offset:44032
  v_mfma_f32_32x32x16_bf16 v[16:31], a[252:255], v[44:47], v[16:31]
  s_waitcnt lgkmcnt(2)
  v_mfma_f32_32x32x16_bf16 v[0:15], a[112:115], v[32:35], v[0:15]
  ds_read_b128 v[44:47], v206 offset:44032
  v_mfma_f32_32x32x16_bf16 v[16:31], v[224:227], v[32:35], v[16:31]
  s_waitcnt lgkmcnt(2)
  v_mfma_f32_32x32x16_bf16 v[0:15], a[116:119], v[36:39], v[0:15]
  ds_read_b128 v[32:35], v203 offset:45056
  v_mfma_f32_32x32x16_bf16 v[16:31], v[228:231], v[36:39], v[16:31]
  s_waitcnt lgkmcnt(2)
  v_mfma_f32_32x32x16_bf16 v[0:15], a[120:123], v[40:43], v[0:15]
  ds_read_b128 v[36:39], v204 offset:45056
  v_mfma_f32_32x32x16_bf16 v[16:31], v[232:235], v[40:43], v[16:31]
  s_waitcnt lgkmcnt(2)
  v_mfma_f32_32x32x16_bf16 v[0:15], a[124:127], v[44:47], v[0:15]
  ds_read_b128 v[40:43], v205 offset:45056
  v_mfma_f32_32x32x16_bf16 v[16:31], v[236:239], v[44:47], v[16:31]
  s_waitcnt lgkmcnt(2)
  v_mfma_f32_32x32x16_bf16 v[0:15], a[128:131], v[32:35], v[0:15]
  ds_read_b128 v[44:47], v206 offset:45056
  v_mfma_f32_32x32x16_bf16 v[16:31], v[240:243], v[32:35], v[16:31]
  s_waitcnt lgkmcnt(2)
  v_mfma_f32_32x32x16_bf16 v[0:15], a[132:135], v[36:39], v[0:15]
  v_mfma_f32_32x32x16_bf16 v[16:31], v[244:247], v[36:39], v[16:31]
  s_waitcnt lgkmcnt(1)
  v_mfma_f32_32x32x16_bf16 v[0:15], a[136:139], v[40:43], v[0:15]
  v_mfma_f32_32x32x16_bf16 v[16:31], v[248:251], v[40:43], v[16:31]
  s_waitcnt lgkmcnt(0)
  v_mfma_f32_32x32x16_bf16 v[0:15], a[140:143], v[44:47], v[0:15]
  v_mfma_f32_32x32x16_bf16 v[16:31], v[252:255], v[44:47], v[16:31]
  s_add_u32 s60, s60, 36864
  s_nop 2
  v_cvt_pk_bf16_f32 v48, v0, v1
  v_cvt_pk_bf16_f32 v49, v2, v3
  ds_write2_b32 v218, v48, v49 offset0:0 offset1:1
  v_cvt_pk_bf16_f32 v48, v4, v5
  v_cvt_pk_bf16_f32 v49, v6, v7
  ds_write2_b32 v218, v48, v49 offset0:4 offset1:5
  v_cvt_pk_bf16_f32 v48, v8, v9
  v_cvt_pk_bf16_f32 v49, v10, v11
  ds_write2_b32 v218, v48, v49 offset0:8 offset1:9
  v_cvt_pk_bf16_f32 v48, v12, v13
  v_cvt_pk_bf16_f32 v49, v14, v15
  ds_write2_b32 v218, v48, v49 offset0:12 offset1:13
  v_cvt_pk_bf16_f32 v48, v16, v17
  v_cvt_pk_bf16_f32 v49, v18, v19
  ds_write2_b32 v218, v48, v49 offset0:64 offset1:65
  v_cvt_pk_bf16_f32 v48, v20, v21
  v_cvt_pk_bf16_f32 v49, v22, v23
  ds_write2_b32 v218, v48, v49 offset0:68 offset1:69
  v_cvt_pk_bf16_f32 v48, v24, v25
  v_cvt_pk_bf16_f32 v49, v26, v27
  ds_write2_b32 v218, v48, v49 offset0:72 offset1:73
  v_cvt_pk_bf16_f32 v48, v28, v29
  v_cvt_pk_bf16_f32 v49, v30, v31
  ds_write2_b32 v218, v48, v49 offset0:76 offset1:77
  v_add_u32 v218, 16512, v218
  s_waitcnt vmcnt(0) lgkmcnt(0)
  s_barrier
  ds_read_b128 v[32:35], v203 offset:0
  ds_read_b128 v[36:39], v204 offset:0
  ds_read_b128 v[40:43], v205 offset:0
  s_waitcnt lgkmcnt(2)
  v_mfma_f32_32x32x16_bf16 v[0:15], a[0:3], v[32:35], 0
  ds_read_b128 v[44:47], v206 offset:0
  s_add_u32 m0, s67, 36864
  s_nop 0
  buffer_load_dwordx4 v202, s[4:7], s60 offen offset:0 lds
  v_mfma_f32_32x32x16_bf16 v[16:31], a[144:147], v[32:35], 0
  s_waitcnt lgkmcnt(2)
  v_mfma_f32_32x32x16_bf16 v[0:15], a[4:7], v[36:39], v[0:15]
  ds_read_b128 v[32:35], v203 offset:1024
  s_add_u32 m0, s67, 37760
  s_nop 0
  buffer_load_dwordx4 v202, s[4:7], s60 offen offset:128 lds
  v_mfma_f32_32x32x16_bf16 v[16:31], a[148:151], v[36:39], v[16:31]
  s_waitcnt lgkmcnt(2)
  v_mfma_f32_32x32x16_bf16 v[0:15], a[8:11], v[40:43], v[0:15]
  ds_read_b128 v[36:39], v204 offset:1024
  s_add_u32 m0, s67, 38656
  s_nop 0
  buffer_load_dwordx4 v202, s[4:7], s60 offen offset:256 lds
  v_mfma_f32_32x32x16_bf16 v[16:31], a[152:155], v[40:43], v[16:31]
  s_waitcnt lgkmcnt(2)
  v_mfma_f32_32x32x16_bf16 v[0:15], a[12:15], v[44:47], v[0:15]
  ds_read_b128 v[40:43], v205 offset:1024
  s_add_u32 m0, s67, 39552
  s_nop 0
  buffer_load_dwordx4 v202, s[4:7], s60 offen offset:384 lds
  v_mfma_f32_32x32x16_bf16 v[16:31], a[156:159], v[44:47], v[16:31]
  s_waitcnt lgkmcnt(2)
  v_mfma_f32_32x32x16_bf16 v[0:15], a[16:19], v[32:35], v[0:15]
  ds_read_b128 v[44:47], v206 offset:1024
  s_add_u32 m0, s67, 40448
  s_nop 0
  buffer_load_dwordx4 v202, s[4:7], s60 offen offset:512 lds
  v_mfma_f32_32x32x16_bf16 v[16:31], a[160:163], v[32:35], v[16:31]
  s_waitcnt lgkmcnt(2)
  v_mfma_f32_32x32x16_bf16 v[0:15], a[20:23], v[36:39], v[0:15]
  ds_read_b128 v[32:35], v203 offset:2048
  s_add_u32 m0, s67, 41344
  s_nop 0
  buffer_load_dwordx4 v202, s[4:7], s60 offen offset:640 lds
  v_mfma_f32_32x32x16_bf16 v[16:31], a[164:167], v[36:39], v[16:31]
  s_waitcnt lgkmcnt(2)
  v_mfma_f32_32x32x16_bf16 v[0:15], a[24:27], v[40:43], v[0:15]
  ds_read_b128 v[36:39], v204 offset:2048
  s_add_u32 m0, s67, 42240
  s_nop 0
  buffer_load_dwordx4 v202, s[4:7], s60 offen offset:768 lds
  v_mfma_f32_32x32x16_bf16 v[16:31], a[168:171], v[40:43], v[16:31]
  s_waitcnt lgkmcnt(2)
  v_mfma_f32_32x32x16_bf16 v[0:15], a[28:31], v[44:47], v[0:15]
  ds_read_b128 v[40:43], v205 offset:2048
  s_add_u32 m0, s67, 43136
  s_nop 0
  buffer_load_dwordx4 v202, s[4:7], s60 offen offset:896 lds
  v_mfma_f32_32x32x16_bf16 v[16:31], a[172:175], v[44:47], v[16:31]
  s_waitcnt lgkmcnt(2)
  v_mfma_f32_32x32x16_bf16 v[0:15], a[32:35], v[32:35], v[0:15]
  ds_read_b128 v[44:47], v206 offset:2048
  s_add_u32 m0, s67, 44032
  s_nop 0
  buffer_load_dwordx4 v202, s[4:7], s60 offen offset:1024 lds
  v_mfma_f32_32x32x16_bf16 v[16:31], a[176:179], v[32:35], v[16:31]
  s_waitcnt lgkmcnt(2)
  v_mfma_f32_32x32x16_bf16 v[0:15], a[36:39], v[36:39], v[0:15]
  ds_read_b128 v[32:35], v203 offset:3072
  v_mfma_f32_32x32x16_bf16 v[16:31], a[180:183], v[36:39], v[16:31]
  s_waitcnt lgkmcnt(2)
  v_mfma_f32_32x32x16_bf16 v[0:15], a[40:43], v[40:43], v[0:15]
  ds_read_b128 v[36:39], v204 offset:3072
  v_mfma_f32_32x32x16_bf16 v[16:31], a[184:187], v[40:43], v[16:31]
  s_waitcnt lgkmcnt(2)
  v_mfma_f32_32x32x16_bf16 v[0:15], a[44:47], v[44:47], v[0:15]
  ds_read_b128 v[40:43], v205 offset:3072
  v_mfma_f32_32x32x16_bf16 v[16:31], a[188:191], v[44:47], v[16:31]
  s_waitcnt lgkmcnt(2)
  v_mfma_f32_32x32x16_bf16 v[0:15], a[48:51], v[32:35], v[0:15]
  ds_read_b128 v[44:47], v206 offset:3072
  v_mfma_f32_32x32x16_bf16 v[16:31], a[192:195], v[32:35], v[16:31]
  s_waitcnt lgkmcnt(2)
  v_mfma_f32_32x32x16_bf16 v[0:15], a[52:55], v[36:39], v[0:15]
  ds_read_b128 v[32:35], v203 offset:4096
  v_mfma_f32_32x32x16_bf16 v[16:31], a[196:199], v[36:39], v[16:31]
  s_waitcnt lgkmcnt(2)
  v_mfma_f32_32x32x16_bf16 v[0:15], a[56:59], v[40:43], v[0:15]
  ds_read_b128 v[36:39], v204 offset:4096
  v_mfma_f32_32x32x16_bf16 v[16:31], a[200:203], v[40:43], v[16:31]
  s_waitcnt lgkmcnt(2)
  v_mfma_f32_32x32x16_bf16 v[0:15], a[60:63], v[44:47], v[0:15]
  ds_read_b128 v[40:43], v205 offset:4096
  v_mfma_f32_32x32x16_bf16 v[16:31], a[204:207], v[44:47], v[16:31]
  s_waitcnt lgkmcnt(2)
  v_mfma_f32_32x32x16_bf16 v[0:15], a[64:67], v[32:35], v[0:15]
  ds_read_b128 v[44:47], v206 offset:4096
  v_mfma_f32_32x32x16_bf16 v[16:31], a[208:211], v[32:35], v[16:31]
  s_waitcnt lgkmcnt(2)
  v_mfma_f32_32x32x16_bf16 v[0:15], a[68:71], v[36:39], v[0:15]
  ds_read_b128 v[32:35], v203 offset:5120
  v_mfma_f32_32x32x16_bf16 v[16:31], a[212:215], v[36:39], v[16:31]
  s_waitcnt lgkmcnt(2)
  v_mfma_f32_32x32x16_bf16 v[0:15], a[72:75], v[40:43], v[0:15]
  ds_read_b128 v[36:39], v204 offset:5120
  v_mfma_f32_32x32x16_bf16 v[16:31], a[216:219], v[40:43], v[16:31]
  s_waitcnt lgkmcnt(2)
  v_mfma_f32_32x32x16_bf16 v[0:15], a[76:79], v[44:47], v[0:15]
  ds_read_b128 v[40:43], v205 offset:5120
  v_mfma_f32_32x32x16_bf16 v[16:31], a[220:223], v[44:47], v[16:31]
  s_waitcnt lgkmcnt(2)
  v_mfma_f32_32x32x16_bf16 v[0:15], a[80:83], v[32:35], v[0:15]
  ds_read_b128 v[44:47], v206 offset:5120
  v_mfma_f32_32x32x16_bf16 v[16:31], a[224:227], v[32:35], v[16:31]
  s_waitcnt lgkmcnt(2)
  v_mfma_f32_32x32x16_bf16 v[0:15], a[84:87], v[36:39], v[0:15]
  ds_read_b128 v[32:35], v203 offset:6144
  v_mfma_f32_32x32x16_bf16 v[16:31], a[228:231], v[36:39], v[16:31]
  s_waitcnt lgkmcnt(2)
  v_mfma_f32_32x32x16_bf16 v[0:15], a[88:91], v[40:43], v[0:15]
  ds_read_b128 v[36:39], v204 offset:6144
  v_mfma_f32_32x32x16_bf16 v[16:31], a[232:235], v[40:43], v[16:31]
  s_waitcnt lgkmcnt(2)
  v_mfma_f32_32x32x16_bf16 v[0:15], a[92:95], v[44:47], v[0:15]
  ds_read_b128 v[40:43], v205 offset:6144
  v_mfma_f32_32x32x16_bf16 v[16:31], a[236:239], v[44:47], v[16:31]
  s_waitcnt lgkmcnt(2)
  v_mfma_f32_32x32x16_bf16 v[0:15], a[96:99], v[32:35], v[0:15]
  ds_read_b128 v[44:47], v206 offset:6144
  v_mfma_f32_32x32x16_bf16 v[16:31], a[240:243], v[32:35], v[16:31]
  s_waitcnt lgkmcnt(2)
  v_mfma_f32_32x32x16_bf16 v[0:15], a[100:103], v[36:39], v[0:15]
  ds_read_b128 v[32:35], v203 offset:7168
  v_mfma_f32_32x32x16_bf16 v[16:31], a[244:247], v[36:39], v[16:31]
  s_waitcnt lgkmcnt(2)
  v_mfma_f32_32x32x16_bf16 v[0:15], a[104:107], v[40:43], v[0:15]
  ds_read_b128 v[36:39], v204 offset:7168
  v_mfma_f32_32x32x16_bf16 v[16:31], a[248:251], v[40:43], v[16:31]
  s_waitcnt lgkmcnt(2)
  v_mfma_f32_32x32x16_bf16 v[0:15], a[108:111], v[44:47], v[0:15]
  ds_read_b128 v[40:43], v205 offset:7168
  v_mfma_f32_32x32x16_bf16 v[16:31], a[252:255], v[44:47], v[16:31]
  s_waitcnt lgkmcnt(2)
  v_mfma_f32_32x32x16_bf16 v[0:15], a[112:115], v[32:35], v[0:15]
  ds_read_b128 v[44:47], v206 offset:7168
  v_mfma_f32_32x32x16_bf16 v[16:31], v[224:227], v[32:35], v[16:31]
  s_waitcnt lgkmcnt(2)
  v_mfma_f32_32x32x16_bf16 v[0:15], a[116:119], v[36:39], v[0:15]
  ds_read_b128 v[32:35], v203 offset:8192
  v_mfma_f32_32x32x16_bf16 v[16:31], v[228:231], v[36:39], v[16:31]
  s_waitcnt lgkmcnt(2)
  v_mfma_f32_32x32x16_bf16 v[0:15], a[120:123], v[40:43], v[0:15]
  ds_read_b128 v[36:39], v204 offset:8192
  v_mfma_f32_32x32x16_bf16 v[16:31], v[232:235], v[40:43], v[16:31]
  s_waitcnt lgkmcnt(2)
  v_mfma_f32_32x32x16_bf16 v[0:15], a[124:127], v[44:47], v[0:15]
  ds_read_b128 v[40:43], v205 offset:8192
  v_mfma_f32_32x32x16_bf16 v[16:31], v[236:239], v[44:47], v[16:31]
  s_waitcnt lgkmcnt(2)
  v_mfma_f32_32x32x16_bf16 v[0:15], a[128:131], v[32:35], v[0:15]
  ds_read_b128 v[44:47], v206 offset:8192
  v_mfma_f32_32x32x16_bf16 v[16:31], v[240:243], v[32:35], v[16:31]
  s_waitcnt lgkmcnt(2)
  v_mfma_f32_32x32x16_bf16 v[0:15], a[132:135], v[36:39], v[0:15]
  v_mfma_f32_32x32x16_bf16 v[16:31], v[244:247], v[36:39], v[16:31]
  s_waitcnt lgkmcnt(1)
  v_mfma_f32_32x32x16_bf16 v[0:15], a[136:139], v[40:43], v[0:15]
  v_mfma_f32_32x32x16_bf16 v[16:31], v[248:251], v[40:43], v[16:31]
  s_waitcnt lgkmcnt(0)
  v_mfma_f32_32x32x16_bf16 v[0:15], a[140:143], v[44:47], v[0:15]
  v_mfma_f32_32x32x16_bf16 v[16:31], v[252:255], v[44:47], v[16:31]
  s_add_u32 s60, s60, 36864
  s_nop 2
  v_cvt_pk_bf16_f32 v48, v0, v1
  v_cvt_pk_bf16_f32 v49, v2, v3
  ds_write2_b32 v218, v48, v49 offset0:0 offset1:1
  v_cvt_pk_bf16_f32 v48, v4, v5
  v_cvt_pk_bf16_f32 v49, v6, v7
  ds_write2_b32 v218, v48, v49 offset0:4 offset1:5
  v_cvt_pk_bf16_f32 v48, v8, v9
  v_cvt_pk_bf16_f32 v49, v10, v11
  ds_write2_b32 v218, v48, v49 offset0:8 offset1:9
  v_cvt_pk_bf16_f32 v48, v12, v13
  v_cvt_pk_bf16_f32 v49, v14, v15
  ds_write2_b32 v218, v48, v49 offset0:12 offset1:13
  v_cvt_pk_bf16_f32 v48, v16, v17
  v_cvt_pk_bf16_f32 v49, v18, v19
  ds_write2_b32 v218, v48, v49 offset0:64 offset1:65
  v_cvt_pk_bf16_f32 v48, v20, v21
  v_cvt_pk_bf16_f32 v49, v22, v23
  ds_write2_b32 v218, v48, v49 offset0:68 offset1:69
  v_cvt_pk_bf16_f32 v48, v24, v25
  v_cvt_pk_bf16_f32 v49, v26, v27
  ds_write2_b32 v218, v48, v49 offset0:72 offset1:73
  v_cvt_pk_bf16_f32 v48, v28, v29
  v_cvt_pk_bf16_f32 v49, v30, v31
  ds_write2_b32 v218, v48, v49 offset0:76 offset1:77
  v_add_u32 v218, 16512, v218
  s_waitcnt vmcnt(0) lgkmcnt(0)
  s_barrier
  ds_read_b128 v[32:35], v203 offset:36864
  ds_read_b128 v[36:39], v204 offset:36864
  ds_read_b128 v[40:43], v205 offset:36864
  s_waitcnt lgkmcnt(2)
  v_mfma_f32_32x32x16_bf16 v[0:15], a[0:3], v[32:35], 0
  ds_read_b128 v[44:47], v206 offset:36864
  s_add_u32 m0, s67, 0
  s_nop 0
  buffer_load_dwordx4 v202, s[4:7], s60 offen offset:0 lds
  v_mfma_f32_32x32x16_bf16 v[16:31], a[144:147], v[32:35], 0
  s_waitcnt lgkmcnt(2)
  v_mfma_f32_32x32x16_bf16 v[0:15], a[4:7], v[36:39], v[0:15]
  ds_read_b128 v[32:35], v203 offset:37888
  s_add_u32 m0, s67, 896
  s_nop 0
  buffer_load_dwordx4 v202, s[4:7], s60 offen offset:128 lds
  v_mfma_f32_32x32x16_bf16 v[16:31], a[148:151], v[36:39], v[16:31]
  s_waitcnt lgkmcnt(2)
  v_mfma_f32_32x32x16_bf16 v[0:15], a[8:11], v[40:43], v[0:15]
  ds_read_b128 v[36:39], v204 offset:37888
  s_add_u32 m0, s67, 1792
  s_nop 0
  buffer_load_dwordx4 v202, s[4:7], s60 offen offset:256 lds
  v_mfma_f32_32x32x16_bf16 v[16:31], a[152:155], v[40:43], v[16:31]
  s_waitcnt lgkmcnt(2)
  v_mfma_f32_32x32x16_bf16 v[0:15], a[12:15], v[44:47], v[0:15]
  ds_read_b128 v[40:43], v205 offset:37888
  s_add_u32 m0, s67, 2688
  s_nop 0
  buffer_load_dwordx4 v202, s[4:7], s60 offen offset:384 lds
  v_mfma_f32_32x32x16_bf16 v[16:31], a[156:159], v[44:47], v[16:31]
  s_waitcnt lgkmcnt(2)
  v_mfma_f32_32x32x16_bf16 v[0:15], a[16:19], v[32:35], v[0:15]
  ds_read_b128 v[44:47], v206 offset:37888
  s_add_u32 m0, s67, 3584
  s_nop 0
  buffer_load_dwordx4 v202, s[4:7], s60 offen offset:512 lds
  v_mfma_f32_32x32x16_bf16 v[16:31], a[160:163], v[32:35], v[16:31]
  s_waitcnt lgkmcnt(2)
  v_mfma_f32_32x32x16_bf16 v[0:15], a[20:23], v[36:39], v[0:15]
  ds_read_b128 v[32:35], v203 offset:38912
  s_add_u32 m0, s67, 4480
  s_nop 0
  buffer_load_dwordx4 v202, s[4:7], s60 offen offset:640 lds
  v_mfma_f32_32x32x16_bf16 v[16:31], a[164:167], v[36:39], v[16:31]
  s_waitcnt lgkmcnt(2)
  v_mfma_f32_32x32x16_bf16 v[0:15], a[24:27], v[40:43], v[0:15]
  ds_read_b128 v[36:39], v204 offset:38912
  s_add_u32 m0, s67, 5376
  s_nop 0
  buffer_load_dwordx4 v202, s[4:7], s60 offen offset:768 lds
  v_mfma_f32_32x32x16_bf16 v[16:31], a[168:171], v[40:43], v[16:31]
  s_waitcnt lgkmcnt(2)
  v_mfma_f32_32x32x16_bf16 v[0:15], a[28:31], v[44:47], v[0:15]
  ds_read_b128 v[40:43], v205 offset:38912
  s_add_u32 m0, s67, 6272
  s_nop 0
  buffer_load_dwordx4 v202, s[4:7], s60 offen offset:896 lds
  v_mfma_f32_32x32x16_bf16 v[16:31], a[172:175], v[44:47], v[16:31]
  s_waitcnt lgkmcnt(2)
  v_mfma_f32_32x32x16_bf16 v[0:15], a[32:35], v[32:35], v[0:15]
  ds_read_b128 v[44:47], v206 offset:38912
  s_add_u32 m0, s67, 7168
  s_nop 0
  buffer_load_dwordx4 v202, s[4:7], s60 offen offset:1024 lds
  v_mfma_f32_32x32x16_bf16 v[16:31], a[176:179], v[32:35], v[16:31]
  s_waitcnt lgkmcnt(2)
  v_mfma_f32_32x32x16_bf16 v[0:15], a[36:39], v[36:39], v[0:15]
  ds_read_b128 v[32:35], v203 offset:39936
  v_mfma_f32_32x32x16_bf16 v[16:31], a[180:183], v[36:39], v[16:31]
  s_waitcnt lgkmcnt(2)
  v_mfma_f32_32x32x16_bf16 v[0:15], a[40:43], v[40:43], v[0:15]
  ds_read_b128 v[36:39], v204 offset:39936
  v_mfma_f32_32x32x16_bf16 v[16:31], a[184:187], v[40:43], v[16:31]
  s_waitcnt lgkmcnt(2)
  v_mfma_f32_32x32x16_bf16 v[0:15], a[44:47], v[44:47], v[0:15]
  ds_read_b128 v[40:43], v205 offset:39936
  v_mfma_f32_32x32x16_bf16 v[16:31], a[188:191], v[44:47], v[16:31]
  s_waitcnt lgkmcnt(2)
  v_mfma_f32_32x32x16_bf16 v[0:15], a[48:51], v[32:35], v[0:15]
  ds_read_b128 v[44:47], v206 offset:39936
  v_mfma_f32_32x32x16_bf16 v[16:31], a[192:195], v[32:35], v[16:31]
  s_waitcnt lgkmcnt(2)
  v_mfma_f32_32x32x16_bf16 v[0:15], a[52:55], v[36:39], v[0:15]
  ds_read_b128 v[32:35], v203 offset:40960
  v_mfma_f32_32x32x16_bf16 v[16:31], a[196:199], v[36:39], v[16:31]
  s_waitcnt lgkmcnt(2)
  v_mfma_f32_32x32x16_bf16 v[0:15], a[56:59], v[40:43], v[0:15]
  ds_read_b128 v[36:39], v204 offset:40960
  v_mfma_f32_32x32x16_bf16 v[16:31], a[200:203], v[40:43], v[16:31]
  s_waitcnt lgkmcnt(2)
  v_mfma_f32_32x32x16_bf16 v[0:15], a[60:63], v[44:47], v[0:15]
  ds_read_b128 v[40:43], v205 offset:40960
  v_mfma_f32_32x32x16_bf16 v[16:31], a[204:207], v[44:47], v[16:31]
  s_waitcnt lgkmcnt(2)
  v_mfma_f32_32x32x16_bf16 v[0:15], a[64:67], v[32:35], v[0:15]
  ds_read_b128 v[44:47], v206 offset:40960
  v_mfma_f32_32x32x16_bf16 v[16:31], a[208:211], v[32:35], v[16:31]
  s_waitcnt lgkmcnt(2)
  v_mfma_f32_32x32x16_bf16 v[0:15], a[68:71], v[36:39], v[0:15]
  ds_read_b128 v[32:35], v203 offset:41984
  v_mfma_f32_32x32x16_bf16 v[16:31], a[212:215], v[36:39], v[16:31]
  s_waitcnt lgkmcnt(2)
  v_mfma_f32_32x32x16_bf16 v[0:15], a[72:75], v[40:43], v[0:15]
  ds_read_b128 v[36:39], v204 offset:41984
  v_mfma_f32_32x32x16_bf16 v[16:31], a[216:219], v[40:43], v[16:31]
  s_waitcnt lgkmcnt(2)
  v_mfma_f32_32x32x16_bf16 v[0:15], a[76:79], v[44:47], v[0:15]
  ds_read_b128 v[40:43], v205 offset:41984
  v_mfma_f32_32x32x16_bf16 v[16:31], a[220:223], v[44:47], v[16:31]
  s_waitcnt lgkmcnt(2)
  v_mfma_f32_32x32x16_bf16 v[0:15], a[80:83], v[32:35], v[0:15]
  ds_read_b128 v[44:47], v206 offset:41984
  v_mfma_f32_32x32x16_bf16 v[16:31], a[224:227], v[32:35], v[16:31]
  s_waitcnt lgkmcnt(2)
  v_mfma_f32_32x32x16_bf16 v[0:15], a[84:87], v[36:39], v[0:15]
  ds_read_b128 v[32:35], v203 offset:43008
  v_mfma_f32_32x32x16_bf16 v[16:31], a[228:231], v[36:39], v[16:31]
  s_waitcnt lgkmcnt(2)
  v_mfma_f32_32x32x16_bf16 v[0:15], a[88:91], v[40:43], v[0:15]
  ds_read_b128 v[36:39], v204 offset:43008
  v_mfma_f32_32x32x16_bf16 v[16:31], a[232:235], v[40:43], v[16:31]
  s_waitcnt lgkmcnt(2)
  v_mfma_f32_32x32x16_bf16 v[0:15], a[92:95], v[44:47], v[0:15]
  ds_read_b128 v[40:43], v205 offset:43008
  v_mfma_f32_32x32x16_bf16 v[16:31], a[236:239], v[44:47], v[16:31]
  s_waitcnt lgkmcnt(2)
  v_mfma_f32_32x32x16_bf16 v[0:15], a[96:99], v[32:35], v[0:15]
  ds_read_b128 v[44:47], v206 offset:43008
  v_mfma_f32_32x32x16_bf16 v[16:31], a[240:243], v[32:35], v[16:31]
  s_waitcnt lgkmcnt(2)
  v_mfma_f32_32x32x16_bf16 v[0:15], a[100:103], v[36:39], v[0:15]
  ds_read_b128 v[32:35], v203 offset:44032
  v_mfma_f32_32x32x16_bf16 v[16:31], a[244:247], v[36:39], v[16:31]
  s_waitcnt lgkmcnt(2)
  v_mfma_f32_32x32x16_bf16 v[0:15], a[104:107], v[40:43], v[0:15]
  ds_read_b128 v[36:39], v204 offset:44032
  v_mfma_f32_32x32x16_bf16 v[16:31], a[248:251], v[40:43], v[16:31]
  s_waitcnt lgkmcnt(2)
  v_mfma_f32_32x32x16_bf16 v[0:15], a[108:111], v[44:47], v[0:15]
  ds_read_b128 v[40:43], v205 offset:44032
  v_mfma_f32_32x32x16_bf16 v[16:31], a[252:255], v[44:47], v[16:31]
  s_waitcnt lgkmcnt(2)
  v_mfma_f32_32x32x16_bf16 v[0:15], a[112:115], v[32:35], v[0:15]
  ds_read_b128 v[44:47], v206 offset:44032
  v_mfma_f32_32x32x16_bf16 v[16:31], v[224:227], v[32:35], v[16:31]
  s_waitcnt lgkmcnt(2)
  v_mfma_f32_32x32x16_bf16 v[0:15], a[116:119], v[36:39], v[0:15]
  ds_read_b128 v[32:35], v203 offset:45056
  v_mfma_f32_32x32x16_bf16 v[16:31], v[228:231], v[36:39], v[16:31]
  s_waitcnt lgkmcnt(2)
  v_mfma_f32_32x32x16_bf16 v[0:15], a[120:123], v[40:43], v[0:15]
  ds_read_b128 v[36:39], v204 offset:45056
  v_mfma_f32_32x32x16_bf16 v[16:31], v[232:235], v[40:43], v[16:31]
  s_waitcnt lgkmcnt(2)
  v_mfma_f32_32x32x16_bf16 v[0:15], a[124:127], v[44:47], v[0:15]
  ds_read_b128 v[40:43], v205 offset:45056
  v_mfma_f32_32x32x16_bf16 v[16:31], v[236:239], v[44:47], v[16:31]
  s_waitcnt lgkmcnt(2)
  v_mfma_f32_32x32x16_bf16 v[0:15], a[128:131], v[32:35], v[0:15]
  ds_read_b128 v[44:47], v206 offset:45056
  v_mfma_f32_32x32x16_bf16 v[16:31], v[240:243], v[32:35], v[16:31]
  s_waitcnt lgkmcnt(2)
  v_mfma_f32_32x32x16_bf16 v[0:15], a[132:135], v[36:39], v[0:15]
  v_mfma_f32_32x32x16_bf16 v[16:31], v[244:247], v[36:39], v[16:31]
  s_waitcnt lgkmcnt(1)
  v_mfma_f32_32x32x16_bf16 v[0:15], a[136:139], v[40:43], v[0:15]
  v_mfma_f32_32x32x16_bf16 v[16:31], v[248:251], v[40:43], v[16:31]
  s_waitcnt lgkmcnt(0)
  v_mfma_f32_32x32x16_bf16 v[0:15], a[140:143], v[44:47], v[0:15]
  v_mfma_f32_32x32x16_bf16 v[16:31], v[252:255], v[44:47], v[16:31]
  s_add_u32 s60, s60, 36864
  s_nop 2
  v_cvt_pk_bf16_f32 v48, v0, v1
  v_cvt_pk_bf16_f32 v49, v2, v3
  ds_write2_b32 v218, v48, v49 offset0:0 offset1:1
  v_cvt_pk_bf16_f32 v48, v4, v5
  v_cvt_pk_bf16_f32 v49, v6, v7
  ds_write2_b32 v218, v48, v49 offset0:4 offset1:5
  v_cvt_pk_bf16_f32 v48, v8, v9
  v_cvt_pk_bf16_f32 v49, v10, v11
  ds_write2_b32 v218, v48, v49 offset0:8 offset1:9
  v_cvt_pk_bf16_f32 v48, v12, v13
  v_cvt_pk_bf16_f32 v49, v14, v15
  ds_write2_b32 v218, v48, v49 offset0:12 offset1:13
  v_cvt_pk_bf16_f32 v48, v16, v17
  v_cvt_pk_bf16_f32 v49, v18, v19
  ds_write2_b32 v218, v48, v49 offset0:64 offset1:65
  v_cvt_pk_bf16_f32 v48, v20, v21
  v_cvt_pk_bf16_f32 v49, v22, v23
  ds_write2_b32 v218, v48, v49 offset0:68 offset1:69
  v_cvt_pk_bf16_f32 v48, v24, v25
  v_cvt_pk_bf16_f32 v49, v26, v27
  ds_write2_b32 v218, v48, v49 offset0:72 offset1:73
  v_cvt_pk_bf16_f32 v48, v28, v29
  v_cvt_pk_bf16_f32 v49, v30, v31
  ds_write2_b32 v218, v48, v49 offset0:76 offset1:77
  v_add_u32 v218, 16512, v218
  s_waitcnt vmcnt(0) lgkmcnt(0)
  s_barrier
  ds_read_b128 v[32:35], v203 offset:0
  ds_read_b128 v[36:39], v204 offset:0
  ds_read_b128 v[40:43], v205 offset:0
  s_waitcnt lgkmcnt(2)
  v_mfma_f32_32x32x16_bf16 v[0:15], a[0:3], v[32:35], 0
  ds_read_b128 v[44:47], v206 offset:0
  v_mfma_f32_32x32x16_bf16 v[16:31], a[144:147], v[32:35], 0
  s_waitcnt lgkmcnt(2)
  v_mfma_f32_32x32x16_bf16 v[0:15], a[4:7], v[36:39], v[0:15]
  ds_read_b128 v[32:35], v203 offset:1024
  v_mfma_f32_32x32x16_bf16 v[16:31], a[148:151], v[36:39], v[16:31]
  s_waitcnt lgkmcnt(2)
  v_mfma_f32_32x32x16_bf16 v[0:15], a[8:11], v[40:43], v[0:15]
  ds_read_b128 v[36:39], v204 offset:1024
  v_mfma_f32_32x32x16_bf16 v[16:31], a[152:155], v[40:43], v[16:31]
  s_waitcnt lgkmcnt(2)
  v_mfma_f32_32x32x16_bf16 v[0:15], a[12:15], v[44:47], v[0:15]
  ds_read_b128 v[40:43], v205 offset:1024
  v_mfma_f32_32x32x16_bf16 v[16:31], a[156:159], v[44:47], v[16:31]
  s_waitcnt lgkmcnt(2)
  v_mfma_f32_32x32x16_bf16 v[0:15], a[16:19], v[32:35], v[0:15]
  ds_read_b128 v[44:47], v206 offset:1024
  v_mfma_f32_32x32x16_bf16 v[16:31], a[160:163], v[32:35], v[16:31]
  s_waitcnt lgkmcnt(2)
  v_mfma_f32_32x32x16_bf16 v[0:15], a[20:23], v[36:39], v[0:15]
  ds_read_b128 v[32:35], v203 offset:2048
  v_mfma_f32_32x32x16_bf16 v[16:31], a[164:167], v[36:39], v[16:31]
  s_waitcnt lgkmcnt(2)
  v_mfma_f32_32x32x16_bf16 v[0:15], a[24:27], v[40:43], v[0:15]
  ds_read_b128 v[36:39], v204 offset:2048
  v_mfma_f32_32x32x16_bf16 v[16:31], a[168:171], v[40:43], v[16:31]
  s_waitcnt lgkmcnt(2)
  v_mfma_f32_32x32x16_bf16 v[0:15], a[28:31], v[44:47], v[0:15]
  ds_read_b128 v[40:43], v205 offset:2048
  v_mfma_f32_32x32x16_bf16 v[16:31], a[172:175], v[44:47], v[16:31]
  s_waitcnt lgkmcnt(2)
  v_mfma_f32_32x32x16_bf16 v[0:15], a[32:35], v[32:35], v[0:15]
  ds_read_b128 v[44:47], v206 offset:2048
  v_mfma_f32_32x32x16_bf16 v[16:31], a[176:179], v[32:35], v[16:31]
  s_waitcnt lgkmcnt(2)
  v_mfma_f32_32x32x16_bf16 v[0:15], a[36:39], v[36:39], v[0:15]
  ds_read_b128 v[32:35], v203 offset:3072
  v_mfma_f32_32x32x16_bf16 v[16:31], a[180:183], v[36:39], v[16:31]
  s_waitcnt lgkmcnt(2)
  v_mfma_f32_32x32x16_bf16 v[0:15], a[40:43], v[40:43], v[0:15]
  ds_read_b128 v[36:39], v204 offset:3072
  v_mfma_f32_32x32x16_bf16 v[16:31], a[184:187], v[40:43], v[16:31]
  s_waitcnt lgkmcnt(2)
  v_mfma_f32_32x32x16_bf16 v[0:15], a[44:47], v[44:47], v[0:15]
  ds_read_b128 v[40:43], v205 offset:3072
  v_mfma_f32_32x32x16_bf16 v[16:31], a[188:191], v[44:47], v[16:31]
  s_waitcnt lgkmcnt(2)
  v_mfma_f32_32x32x16_bf16 v[0:15], a[48:51], v[32:35], v[0:15]
  ds_read_b128 v[44:47], v206 offset:3072
  v_mfma_f32_32x32x16_bf16 v[16:31], a[192:195], v[32:35], v[16:31]
  s_waitcnt lgkmcnt(2)
  v_mfma_f32_32x32x16_bf16 v[0:15], a[52:55], v[36:39], v[0:15]
  ds_read_b128 v[32:35], v203 offset:4096
  v_mfma_f32_32x32x16_bf16 v[16:31], a[196:199], v[36:39], v[16:31]
  s_waitcnt lgkmcnt(2)
  v_mfma_f32_32x32x16_bf16 v[0:15], a[56:59], v[40:43], v[0:15]
  ds_read_b128 v[36:39], v204 offset:4096
  v_mfma_f32_32x32x16_bf16 v[16:31], a[200:203], v[40:43], v[16:31]
  s_waitcnt lgkmcnt(2)
  v_mfma_f32_32x32x16_bf16 v[0:15], a[60:63], v[44:47], v[0:15]
  ds_read_b128 v[40:43], v205 offset:4096
  v_mfma_f32_32x32x16_bf16 v[16:31], a[204:207], v[44:47], v[16:31]
  s_waitcnt lgkmcnt(2)
  v_mfma_f32_32x32x16_bf16 v[0:15], a[64:67], v[32:35], v[0:15]
  ds_read_b128 v[44:47], v206 offset:4096
  v_mfma_f32_32x32x16_bf16 v[16:31], a[208:211], v[32:35], v[16:31]
  s_waitcnt lgkmcnt(2)
  v_mfma_f32_32x32x16_bf16 v[0:15], a[68:71], v[36:39], v[0:15]
  ds_read_b128 v[32:35], v203 offset:5120
  v_mfma_f32_32x32x16_bf16 v[16:31], a[212:215], v[36:39], v[16:31]
  s_waitcnt lgkmcnt(2)
  v_mfma_f32_32x32x16_bf16 v[0:15], a[72:75], v[40:43], v[0:15]
  ds_read_b128 v[36:39], v204 offset:5120
  v_mfma_f32_32x32x16_bf16 v[16:31], a[216:219], v[40:43], v[16:31]
  s_waitcnt lgkmcnt(2)
  v_mfma_f32_32x32x16_bf16 v[0:15], a[76:79], v[44:47], v[0:15]
  ds_read_b128 v[40:43], v205 offset:5120
  v_mfma_f32_32x32x16_bf16 v[16:31], a[220:223], v[44:47], v[16:31]
  s_waitcnt lgkmcnt(2)
  v_mfma_f32_32x32x16_bf16 v[0:15], a[80:83], v[32:35], v[0:15]
  ds_read_b128 v[44:47], v206 offset:5120
  v_mfma_f32_32x32x16_bf16 v[16:31], a[224:227], v[32:35], v[16:31]
  s_waitcnt lgkmcnt(2)
  v_mfma_f32_32x32x16_bf16 v[0:15], a[84:87], v[36:39], v[0:15]
  ds_read_b128 v[32:35], v203 offset:6144
  v_mfma_f32_32x32x16_bf16 v[16:31], a[228:231], v[36:39], v[16:31]
  s_waitcnt lgkmcnt(2)
  v_mfma_f32_32x32x16_bf16 v[0:15], a[88:91], v[40:43], v[0:15]
  ds_read_b128 v[36:39], v204 offset:6144
  v_mfma_f32_32x32x16_bf16 v[16:31], a[232:235], v[40:43], v[16:31]
  s_waitcnt lgkmcnt(2)
  v_mfma_f32_32x32x16_bf16 v[0:15], a[92:95], v[44:47], v[0:15]
  ds_read_b128 v[40:43], v205 offset:6144
  v_mfma_f32_32x32x16_bf16 v[16:31], a[236:239], v[44:47], v[16:31]
  s_waitcnt lgkmcnt(2)
  v_mfma_f32_32x32x16_bf16 v[0:15], a[96:99], v[32:35], v[0:15]
  ds_read_b128 v[44:47], v206 offset:6144
  v_mfma_f32_32x32x16_bf16 v[16:31], a[240:243], v[32:35], v[16:31]
  s_waitcnt lgkmcnt(2)
  v_mfma_f32_32x32x16_bf16 v[0:15], a[100:103], v[36:39], v[0:15]
  ds_read_b128 v[32:35], v203 offset:7168
  v_mfma_f32_32x32x16_bf16 v[16:31], a[244:247], v[36:39], v[16:31]
  s_waitcnt lgkmcnt(2)
  v_mfma_f32_32x32x16_bf16 v[0:15], a[104:107], v[40:43], v[0:15]
  ds_read_b128 v[36:39], v204 offset:7168
  v_mfma_f32_32x32x16_bf16 v[16:31], a[248:251], v[40:43], v[16:31]
  s_waitcnt lgkmcnt(2)
  v_mfma_f32_32x32x16_bf16 v[0:15], a[108:111], v[44:47], v[0:15]
  ds_read_b128 v[40:43], v205 offset:7168
  v_mfma_f32_32x32x16_bf16 v[16:31], a[252:255], v[44:47], v[16:31]
  s_waitcnt lgkmcnt(2)
  v_mfma_f32_32x32x16_bf16 v[0:15], a[112:115], v[32:35], v[0:15]
  ds_read_b128 v[44:47], v206 offset:7168
  v_mfma_f32_32x32x16_bf16 v[16:31], v[224:227], v[32:35], v[16:31]
  s_waitcnt lgkmcnt(2)
  v_mfma_f32_32x32x16_bf16 v[0:15], a[116:119], v[36:39], v[0:15]
  ds_read_b128 v[32:35], v203 offset:8192
  v_mfma_f32_32x32x16_bf16 v[16:31], v[228:231], v[36:39], v[16:31]
  s_waitcnt lgkmcnt(2)
  v_mfma_f32_32x32x16_bf16 v[0:15], a[120:123], v[40:43], v[0:15]
  ds_read_b128 v[36:39], v204 offset:8192
  v_mfma_f32_32x32x16_bf16 v[16:31], v[232:235], v[40:43], v[16:31]
  s_waitcnt lgkmcnt(2)
  v_mfma_f32_32x32x16_bf16 v[0:15], a[124:127], v[44:47], v[0:15]
  ds_read_b128 v[40:43], v205 offset:8192
  v_mfma_f32_32x32x16_bf16 v[16:31], v[236:239], v[44:47], v[16:31]
  s_waitcnt lgkmcnt(2)
  v_mfma_f32_32x32x16_bf16 v[0:15], a[128:131], v[32:35], v[0:15]
  ds_read_b128 v[44:47], v206 offset:8192
  v_mfma_f32_32x32x16_bf16 v[16:31], v[240:243], v[32:35], v[16:31]
  s_waitcnt lgkmcnt(2)
  v_mfma_f32_32x32x16_bf16 v[0:15], a[132:135], v[36:39], v[0:15]
  v_mfma_f32_32x32x16_bf16 v[16:31], v[244:247], v[36:39], v[16:31]
  s_waitcnt lgkmcnt(1)
  v_mfma_f32_32x32x16_bf16 v[0:15], a[136:139], v[40:43], v[0:15]
  v_mfma_f32_32x32x16_bf16 v[16:31], v[248:251], v[40:43], v[16:31]
  s_waitcnt lgkmcnt(0)
  v_mfma_f32_32x32x16_bf16 v[0:15], a[140:143], v[44:47], v[0:15]
  v_mfma_f32_32x32x16_bf16 v[16:31], v[252:255], v[44:47], v[16:31]
  s_add_u32 s60, s60, 36864
  s_nop 2
  v_cvt_pk_bf16_f32 v48, v0, v1
  v_cvt_pk_bf16_f32 v49, v2, v3
  ds_write2_b32 v218, v48, v49 offset0:0 offset1:1
  v_cvt_pk_bf16_f32 v48, v4, v5
  v_cvt_pk_bf16_f32 v49, v6, v7
  ds_write2_b32 v218, v48, v49 offset0:4 offset1:5
  v_cvt_pk_bf16_f32 v48, v8, v9
  v_cvt_pk_bf16_f32 v49, v10, v11
  ds_write2_b32 v218, v48, v49 offset0:8 offset1:9
  v_cvt_pk_bf16_f32 v48, v12, v13
  v_cvt_pk_bf16_f32 v49, v14, v15
  ds_write2_b32 v218, v48, v49 offset0:12 offset1:13
  v_cvt_pk_bf16_f32 v48, v16, v17
  v_cvt_pk_bf16_f32 v49, v18, v19
  ds_write2_b32 v218, v48, v49 offset0:64 offset1:65
  v_cvt_pk_bf16_f32 v48, v20, v21
  v_cvt_pk_bf16_f32 v49, v22, v23
  ds_write2_b32 v218, v48, v49 offset0:68 offset1:69
  v_cvt_pk_bf16_f32 v48, v24, v25
  v_cvt_pk_bf16_f32 v49, v26, v27
  ds_write2_b32 v218, v48, v49 offset0:72 offset1:73
  v_cvt_pk_bf16_f32 v48, v28, v29
  v_cvt_pk_bf16_f32 v49, v30, v31
  ds_write2_b32 v218, v48, v49 offset0:76 offset1:77
  v_add_u32 v218, 16512, v218
  s_waitcnt vmcnt(0) lgkmcnt(0)
  s_barrier
  v_mul_u32_u24 v219, 516, v200
  s_mul_i32 s54, s52, 36
  s_add_u32 s55, s54, 83016
  v_add_u32 v219, s55, v219
  v_mul_u32_u24 v220, 1152, v200
  s_mul_i32 s55, s68, 144
  s_add_u32 s54, s54, s55
  s_mul_i32 s55, s69, 147456
  s_add_u32 s64, s54, s55
  s_add_u32 s64, s64, 62914560
  s_lshl_b32 s66, s69, 7
  s_mov_b32 s57, 1051597459
  ds_read_b32 v0, v219 offset:7224
  ds_read_b32 v1, v219 offset:7228
  ds_read_b32 v2, v219 offset:7232
  ds_read_b32 v3, v219 offset:7236
  ds_read_b32 v4, v219 offset:7240
  ds_read_b32 v5, v219 offset:7244
  ds_read_b32 v6, v219 offset:7248
  ds_read_b32 v7, v219 offset:7252
  ds_read_b32 v8, v219 offset:7256
  ds_read_b32 v16, v219 offset:7368
  ds_read_b32 v17, v219 offset:7372
  ds_read_b32 v18, v219 offset:7376
  ds_read_b32 v19, v219 offset:7380
  ds_read_b32 v20, v219 offset:7384
  ds_read_b32 v21, v219 offset:7388
  ds_read_b32 v22, v219 offset:7392
  ds_read_b32 v23, v219 offset:7396
  ds_read_b32 v24, v219 offset:7400
  ds_read_b32 v25, v219 offset:6336
  ds_read_b32 v26, v219 offset:6340
  ds_read_b32 v27, v219 offset:6344
  ds_read_b32 v28, v219 offset:6348
  ds_read_b32 v29, v219 offset:6352
  ds_read_b32 v30, v219 offset:6356
  ds_read_b32 v31, v219 offset:6360
  ds_read_b32 v32, v219 offset:6364
  ds_read_b32 v33, v219 offset:6368
  ds_read_b32 v34, v219 offset:5304
  ds_read_b32 v35, v219 offset:5308
  ds_read_b32 v36, v219 offset:5312
  ds_read_b32 v37, v219 offset:5316
  ds_read_b32 v38, v219 offset:5320
  ds_read_b32 v39, v219 offset:5324
  ds_read_b32 v40, v219 offset:5328
  ds_read_b32 v41, v219 offset:5332
  ds_read_b32 v42, v219 offset:5336
  ds_read_b32 v43, v219 offset:4272
  ds_read_b32 v44, v219 offset:4276
  ds_read_b32 v45, v219 offset:4280
  ds_read_b32 v46, v219 offset:4284
  ds_read_b32 v47, v219 offset:4288
  ds_read_b32 v48, v219 offset:4292
  ds_read_b32 v49, v219 offset:4296
  ds_read_b32 v50, v219 offset:4300
  ds_read_b32 v51, v219 offset:4304
  ds_read_b32 v52, v219 offset:3240
  ds_read_b32 v53, v219 offset:3244
  ds_read_b32 v54, v219 offset:3248
  ds_read_b32 v55, v219 offset:3252
  ds_read_b32 v56, v219 offset:3256
  ds_read_b32 v57, v219 offset:3260
  ds_read_b32 v58, v219 offset:3264
  ds_read_b32 v59, v219 offset:3268
  ds_read_b32 v60, v219 offset:3272
  ds_read_b32 v61, v219 offset:2208
  ds_read_b32 v62, v219 offset:2212
  ds_read_b32 v63, v219 offset:2216
  ds_read_b32 v64, v219 offset:2220
  ds_read_b32 v65, v219 offset:2224
  ds_read_b32 v66, v219 offset:2228
  ds_read_b32 v67, v219 offset:2232
  ds_read_b32 v68, v219 offset:2236
  ds_read_b32 v69, v219 offset:2240
  ds_read_b32 v70, v219 offset:1176
  ds_read_b32 v71, v219 offset:1180
  ds_read_b32 v72, v219 offset:1184
  ds_read_b32 v73, v219 offset:1188
  ds_read_b32 v74, v219 offset:1192
  ds_read_b32 v75, v219 offset:1196
  ds_read_b32 v76, v219 offset:1200
  ds_read_b32 v77, v219 offset:1204
  ds_read_b32 v78, v219 offset:1208
  ds_read_b32 v79, v219 offset:144
  ds_read_b32 v80, v219 offset:148
  ds_read_b32 v81, v219 offset:152
  ds_read_b32 v82, v219 offset:156
  ds_read_b32 v83, v219 offset:160
  ds_read_b32 v84, v219 offset:164
  ds_read_b32 v85, v219 offset:168
  ds_read_b32 v86, v219 offset:172
  ds_read_b32 v87, v219 offset:176
  v_mov_b32 v100, 0
  v_mov_b32 v101, 0
  v_mov_b32 v102, 0
  v_mov_b32 v103, 0
  v_mov_b32 v104, 0
  v_mov_b32 v105, 0
  v_mov_b32 v106, 0
  v_mov_b32 v107, 0
  s_waitcnt lgkmcnt(15)
  v_dot2c_f32_bf16 v100, v0, v16
  v_dot2c_f32_bf16 v101, v0, v25
  v_dot2c_f32_bf16 v102, v0, v34
  v_dot2c_f32_bf16 v103, v0, v43
  v_dot2c_f32_bf16 v104, v0, v52
  v_dot2c_f32_bf16 v105, v0, v61
  v_dot2c_f32_bf16 v106, v0, v70
  s_waitcnt lgkmcnt(8)
  v_dot2c_f32_bf16 v107, v0, v79
  v_dot2c_f32_bf16 v100, v1, v17
  v_dot2c_f32_bf16 v101, v1, v26
  v_dot2c_f32_bf16 v102, v1, v35
  v_dot2c_f32_bf16 v103, v1, v44
  v_dot2c_f32_bf16 v104, v1, v53
  v_dot2c_f32_bf16 v105, v1, v62
  v_dot2c_f32_bf16 v106, v1, v71
  s_waitcnt lgkmcnt(7)
  v_dot2c_f32_bf16 v107, v1, v80
  v_dot2c_f32_bf16 v100, v2, v18
  v_dot2c_f32_bf16 v101, v2, v27
  v_dot2c_f32_bf16 v102, v2, v36
  v_dot2c_f32_bf16 v103, v2, v45
  v_dot2c_f32_bf16 v104, v2, v54
  v_dot2c_f32_bf16 v105, v2, v63
  v_dot2c_f32_bf16 v106, v2, v72
  s_waitcnt lgkmcnt(6)
  v_dot2c_f32_bf16 v107, v2, v81
  v_dot2c_f32_bf16 v100, v3, v19
  v_dot2c_f32_bf16 v101, v3, v28
  v_dot2c_f32_bf16 v102, v3, v37
  v_dot2c_f32_bf16 v103, v3, v46
  v_dot2c_f32_bf16 v104, v3, v55
  v_dot2c_f32_bf16 v105, v3, v64
  v_dot2c_f32_bf16 v106, v3, v73
  s_waitcnt lgkmcnt(5)
  v_dot2c_f32_bf16 v107, v3, v82
  v_dot2c_f32_bf16 v100, v4, v20
  v_dot2c_f32_bf16 v101, v4, v29
  v_dot2c_f32_bf16 v102, v4, v38
  v_dot2c_f32_bf16 v103, v4, v47
  v_dot2c_f32_bf16 v104, v4, v56
  v_dot2c_f32_bf16 v105, v4, v65
  v_dot2c_f32_bf16 v106, v4, v74
  s_waitcnt lgkmcnt(4)
  v_dot2c_f32_bf16 v107, v4, v83
  v_dot2c_f32_bf16 v100, v5, v21
  v_dot2c_f32_bf16 v101, v5, v30
  v_dot2c_f32_bf16 v102, v5, v39
  v_dot2c_f32_bf16 v103, v5, v48
  v_dot2c_f32_bf16 v104, v5, v57
  v_dot2c_f32_bf16 v105, v5, v66
  v_dot2c_f32_bf16 v106, v5, v75
  s_waitcnt lgkmcnt(3)
  v_dot2c_f32_bf16 v107, v5, v84
  v_dot2c_f32_bf16 v100, v6, v22
  v_dot2c_f32_bf16 v101, v6, v31
  v_dot2c_f32_bf16 v102, v6, v40
  v_dot2c_f32_bf16 v103, v6, v49
  v_dot2c_f32_bf16 v104, v6, v58
  v_dot2c_f32_bf16 v105, v6, v67
  v_dot2c_f32_bf16 v106, v6, v76
  s_waitcnt lgkmcnt(2)
  v_dot2c_f32_bf16 v107, v6, v85
  v_dot2c_f32_bf16 v100, v7, v23
  v_dot2c_f32_bf16 v101, v7, v32
  v_dot2c_f32_bf16 v102, v7, v41
  v_dot2c_f32_bf16 v103, v7, v50
  v_dot2c_f32_bf16 v104, v7, v59
  v_dot2c_f32_bf16 v105, v7, v68
  v_dot2c_f32_bf16 v106, v7, v77
  s_waitcnt lgkmcnt(1)
  v_dot2c_f32_bf16 v107, v7, v86
  v_dot2c_f32_bf16 v100, v8, v24
  v_dot2c_f32_bf16 v101, v8, v33
  v_dot2c_f32_bf16 v102, v8, v42
  v_dot2c_f32_bf16 v103, v8, v51
  v_dot2c_f32_bf16 v104, v8, v60
  v_dot2c_f32_bf16 v105, v8, v69
  v_dot2c_f32_bf16 v106, v8, v78
  s_waitcnt lgkmcnt(0)
  v_dot2c_f32_bf16 v107, v8, v87
  ds_read_b32 v16, v219 offset:7512
  ds_read_b32 v17, v219 offset:7516
  ds_read_b32 v18, v219 offset:7520
  ds_read_b32 v19, v219 offset:7524
  ds_read_b32 v20, v219 offset:7528
  ds_read_b32 v21, v219 offset:7532
  ds_read_b32 v22, v219 offset:7536
  ds_read_b32 v23, v219 offset:7540
  ds_read_b32 v24, v219 offset:7544
  ds_read_b32 v25, v219 offset:6480
  ds_read_b32 v26, v219 offset:6484
  ds_read_b32 v27, v219 offset:6488
  ds_read_b32 v28, v219 offset:6492
  ds_read_b32 v29, v219 offset:6496
  ds_read_b32 v30, v219 offset:6500
  ds_read_b32 v31, v219 offset:6504
  ds_read_b32 v32, v219 offset:6508
  ds_read_b32 v33, v219 offset:6512
  ds_read_b32 v34, v219 offset:5448
  ds_read_b32 v35, v219 offset:5452
  ds_read_b32 v36, v219 offset:5456
  ds_read_b32 v37, v219 offset:5460
  ds_read_b32 v38, v219 offset:5464
  ds_read_b32 v39, v219 offset:5468
  ds_read_b32 v40, v219 offset:5472
  ds_read_b32 v41, v219 offset:5476
  ds_read_b32 v42, v219 offset:5480
  ds_read_b32 v43, v219 offset:4416
  ds_read_b32 v44, v219 offset:4420
  ds_read_b32 v45, v219 offset:4424
  ds_read_b32 v46, v219 offset:4428
  ds_read_b32 v47, v219 offset:4432
  ds_read_b32 v48, v219 offset:4436
  ds_read_b32 v49, v219 offset:4440
  ds_read_b32 v50, v219 offset:4444
  ds_read_b32 v51, v219 offset:4448
  ds_read_b32 v52, v219 offset:3384
  ds_read_b32 v53, v219 offset:3388
  ds_read_b32 v54, v219 offset:3392
  ds_read_b32 v55, v219 offset:3396
  ds_read_b32 v56, v219 offset:3400
  ds_read_b32 v57, v219 offset:3404
  ds_read_b32 v58, v219 offset:3408
  ds_read_b32 v59, v219 offset:3412
  ds_read_b32 v60, v219 offset:3416
  ds_read_b32 v61, v219 offset:2352
  ds_read_b32 v62, v219 offset:2356
  ds_read_b32 v63, v219 offset:2360
  ds_read_b32 v64, v219 offset:2364
  ds_read_b32 v65, v219 offset:2368
  ds_read_b32 v66, v219 offset:2372
  ds_read_b32 v67, v219 offset:2376
  ds_read_b32 v68, v219 offset:2380
  ds_read_b32 v69, v219 offset:2384
  ds_read_b32 v70, v219 offset:1320
  ds_read_b32 v71, v219 offset:1324
  ds_read_b32 v72, v219 offset:1328
  ds_read_b32 v73, v219 offset:1332
  ds_read_b32 v74, v219 offset:1336
  ds_read_b32 v75, v219 offset:1340
  ds_read_b32 v76, v219 offset:1344
  ds_read_b32 v77, v219 offset:1348
  ds_read_b32 v78, v219 offset:1352
  ds_read_b32 v79, v219 offset:288
  ds_read_b32 v80, v219 offset:292
  ds_read_b32 v81, v219 offset:296
  ds_read_b32 v82, v219 offset:300
  ds_read_b32 v83, v219 offset:304
  ds_read_b32 v84, v219 offset:308
  ds_read_b32 v85, v219 offset:312
  ds_read_b32 v86, v219 offset:316
  ds_read_b32 v87, v219 offset:320
  v_add_u32 v211, s66, v200
  v_mov_b32 v212, 0xf149f2ca
  v_mul_f32 v100, s57, v100
  v_mul_f32 v101, s57, v101
  v_mul_f32 v102, s57, v102
  v_mul_f32 v103, s57, v103
  v_mul_f32 v104, s57, v104
  v_mul_f32 v105, s57, v105
  v_mul_f32 v106, s57, v106
  v_mul_f32 v107, s57, v107
  v_cmp_gt_u32 vcc, 2, v211
  s_nop 1
  v_cndmask_b32 v101, v101, v212, vcc
  v_cmp_gt_u32 vcc, 4, v211
  s_nop 1
  v_cndmask_b32 v102, v102, v212, vcc
  v_cmp_gt_u32 vcc, 6, v211
  s_nop 1
  v_cndmask_b32 v103, v103, v212, vcc
  v_cmp_gt_u32 vcc, 8, v211
  s_nop 1
  v_cndmask_b32 v104, v104, v212, vcc
  v_cmp_gt_u32 vcc, 10, v211
  s_nop 1
  v_cndmask_b32 v105, v105, v212, vcc
  v_cmp_gt_u32 vcc, 12, v211
  s_nop 1
  v_cndmask_b32 v106, v106, v212, vcc
  v_cmp_gt_u32 vcc, 14, v211
  s_nop 1
  v_cndmask_b32 v107, v107, v212, vcc
  v_max3_f32 v213, v100, v101, v102
  v_max3_f32 v213, v213, v103, v104
  v_max3_f32 v213, v213, v105, v106
  v_max_f32 v213, v213, v107
  v_sub_f32 v100, v100, v213
  v_sub_f32 v101, v101, v213
  v_sub_f32 v102, v102, v213
  v_sub_f32 v103, v103, v213
  v_sub_f32 v104, v104, v213
  v_sub_f32 v105, v105, v213
  v_sub_f32 v106, v106, v213
  v_sub_f32 v107, v107, v213
  v_exp_f32 v100, v100
  v_exp_f32 v101, v101
  v_exp_f32 v102, v102
  v_exp_f32 v103, v103
  v_exp_f32 v104, v104
  v_exp_f32 v105, v105
  v_exp_f32 v106, v106
  v_exp_f32 v107, v107
  v_add_f32 v213, v100, v101
  v_add_f32 v213, v213, v102
  v_add_f32 v213, v213, v103
  v_add_f32 v213, v213, v104
  v_add_f32 v213, v213, v105
  v_add_f32 v213, v213, v106
  v_add_f32 v213, v213, v107
  v_rcp_f32 v213, v213
  v_mov_b32 v214, 0
  v_mul_f32 v100, v213, v100
  v_mul_f32 v101, v213, v101
  v_mul_f32 v102, v213, v102
  v_mul_f32 v103, v213, v103
  v_mul_f32 v104, v213, v104
  v_mul_f32 v105, v213, v105
  v_mul_f32 v106, v213, v106
  v_mul_f32 v107, v213, v107
  v_mov_b32 v112, 0
  v_mov_b32 v113, 0
  v_mov_b32 v114, 0
  v_mov_b32 v115, 0
  v_mov_b32 v116, 0
  v_mov_b32 v117, 0
  v_mov_b32 v118, 0
  v_mov_b32 v119, 0
  v_mov_b32 v120, 0
  v_mov_b32 v121, 0
  v_mov_b32 v122, 0
  v_mov_b32 v123, 0
  v_mov_b32 v124, 0
  v_mov_b32 v125, 0
  v_mov_b32 v126, 0
  v_mov_b32 v127, 0
  v_mov_b32 v128, 0
  v_mov_b32 v129, 0
  v_cvt_pk_bf16_f32 v0, v100, v214
  v_cvt_pk_bf16_f32 v1, v214, v100
  s_waitcnt lgkmcnt(15)
  v_dot2c_f32_bf16 v112, v16, v0
  v_dot2c_f32_bf16 v113, v16, v1
  v_dot2c_f32_bf16 v114, v17, v0
  v_dot2c_f32_bf16 v115, v17, v1
  v_dot2c_f32_bf16 v116, v18, v0
  v_dot2c_f32_bf16 v117, v18, v1
  v_dot2c_f32_bf16 v118, v19, v0
  v_dot2c_f32_bf16 v119, v19, v1
  v_dot2c_f32_bf16 v120, v20, v0
  v_dot2c_f32_bf16 v121, v20, v1
  v_dot2c_f32_bf16 v122, v21, v0
  v_dot2c_f32_bf16 v123, v21, v1
  v_dot2c_f32_bf16 v124, v22, v0
  v_dot2c_f32_bf16 v125, v22, v1
  v_dot2c_f32_bf16 v126, v23, v0
  v_dot2c_f32_bf16 v127, v23, v1
  v_dot2c_f32_bf16 v128, v24, v0
  v_dot2c_f32_bf16 v129, v24, v1
  v_cvt_pk_bf16_f32 v2, v101, v214
  v_cvt_pk_bf16_f32 v3, v214, v101
  v_dot2c_f32_bf16 v112, v25, v2
  v_dot2c_f32_bf16 v113, v25, v3
  v_dot2c_f32_bf16 v114, v26, v2
  v_dot2c_f32_bf16 v115, v26, v3
  v_dot2c_f32_bf16 v116, v27, v2
  v_dot2c_f32_bf16 v117, v27, v3
  v_dot2c_f32_bf16 v118, v28, v2
  v_dot2c_f32_bf16 v119, v28, v3
  v_dot2c_f32_bf16 v120, v29, v2
  v_dot2c_f32_bf16 v121, v29, v3
  v_dot2c_f32_bf16 v122, v30, v2
  v_dot2c_f32_bf16 v123, v30, v3
  v_dot2c_f32_bf16 v124, v31, v2
  v_dot2c_f32_bf16 v125, v31, v3
  v_dot2c_f32_bf16 v126, v32, v2
  v_dot2c_f32_bf16 v127, v32, v3
  v_dot2c_f32_bf16 v128, v33, v2
  v_dot2c_f32_bf16 v129, v33, v3
  v_cvt_pk_bf16_f32 v0, v102, v214
  v_cvt_pk_bf16_f32 v1, v214, v102
  v_dot2c_f32_bf16 v112, v34, v0
  v_dot2c_f32_bf16 v113, v34, v1
  v_dot2c_f32_bf16 v114, v35, v0
  v_dot2c_f32_bf16 v115, v35, v1
  v_dot2c_f32_bf16 v116, v36, v0
  v_dot2c_f32_bf16 v117, v36, v1
  v_dot2c_f32_bf16 v118, v37, v0
  v_dot2c_f32_bf16 v119, v37, v1
  v_dot2c_f32_bf16 v120, v38, v0
  v_dot2c_f32_bf16 v121, v38, v1
  v_dot2c_f32_bf16 v122, v39, v0
  v_dot2c_f32_bf16 v123, v39, v1
  v_dot2c_f32_bf16 v124, v40, v0
  v_dot2c_f32_bf16 v125, v40, v1
  v_dot2c_f32_bf16 v126, v41, v0
  v_dot2c_f32_bf16 v127, v41, v1
  v_dot2c_f32_bf16 v128, v42, v0
  v_dot2c_f32_bf16 v129, v42, v1
  v_cvt_pk_bf16_f32 v2, v103, v214
  v_cvt_pk_bf16_f32 v3, v214, v103
  v_dot2c_f32_bf16 v112, v43, v2
  v_dot2c_f32_bf16 v113, v43, v3
  v_dot2c_f32_bf16 v114, v44, v2
  v_dot2c_f32_bf16 v115, v44, v3
  v_dot2c_f32_bf16 v116, v45, v2
  v_dot2c_f32_bf16 v117, v45, v3
  v_dot2c_f32_bf16 v118, v46, v2
  v_dot2c_f32_bf16 v119, v46, v3
  v_dot2c_f32_bf16 v120, v47, v2
  v_dot2c_f32_bf16 v121, v47, v3
  v_dot2c_f32_bf16 v122, v48, v2
  v_dot2c_f32_bf16 v123, v48, v3
  v_dot2c_f32_bf16 v124, v49, v2
  v_dot2c_f32_bf16 v125, v49, v3
  v_dot2c_f32_bf16 v126, v50, v2
  v_dot2c_f32_bf16 v127, v50, v3
  v_dot2c_f32_bf16 v128, v51, v2
  v_dot2c_f32_bf16 v129, v51, v3
  v_cvt_pk_bf16_f32 v0, v104, v214
  v_cvt_pk_bf16_f32 v1, v214, v104
  v_dot2c_f32_bf16 v112, v52, v0
  v_dot2c_f32_bf16 v113, v52, v1
  v_dot2c_f32_bf16 v114, v53, v0
  v_dot2c_f32_bf16 v115, v53, v1
  v_dot2c_f32_bf16 v116, v54, v0
  v_dot2c_f32_bf16 v117, v54, v1
  v_dot2c_f32_bf16 v118, v55, v0
  v_dot2c_f32_bf16 v119, v55, v1
  v_dot2c_f32_bf16 v120, v56, v0
  v_dot2c_f32_bf16 v121, v56, v1
  v_dot2c_f32_bf16 v122, v57, v0
  v_dot2c_f32_bf16 v123, v57, v1
  v_dot2c_f32_bf16 v124, v58, v0
  v_dot2c_f32_bf16 v125, v58, v1
  v_dot2c_f32_bf16 v126, v59, v0
  v_dot2c_f32_bf16 v127, v59, v1
  v_dot2c_f32_bf16 v128, v60, v0
  v_dot2c_f32_bf16 v129, v60, v1
  v_cvt_pk_bf16_f32 v2, v105, v214
  v_cvt_pk_bf16_f32 v3, v214, v105
  v_dot2c_f32_bf16 v112, v61, v2
  v_dot2c_f32_bf16 v113, v61, v3
  v_dot2c_f32_bf16 v114, v62, v2
  v_dot2c_f32_bf16 v115, v62, v3
  v_dot2c_f32_bf16 v116, v63, v2
  v_dot2c_f32_bf16 v117, v63, v3
  v_dot2c_f32_bf16 v118, v64, v2
  v_dot2c_f32_bf16 v119, v64, v3
  v_dot2c_f32_bf16 v120, v65, v2
  v_dot2c_f32_bf16 v121, v65, v3
  v_dot2c_f32_bf16 v122, v66, v2
  v_dot2c_f32_bf16 v123, v66, v3
  v_dot2c_f32_bf16 v124, v67, v2
  v_dot2c_f32_bf16 v125, v67, v3
  v_dot2c_f32_bf16 v126, v68, v2
  v_dot2c_f32_bf16 v127, v68, v3
  v_dot2c_f32_bf16 v128, v69, v2
  v_dot2c_f32_bf16 v129, v69, v3
  v_cvt_pk_bf16_f32 v0, v106, v214
  v_cvt_pk_bf16_f32 v1, v214, v106
  v_dot2c_f32_bf16 v112, v70, v0
  v_dot2c_f32_bf16 v113, v70, v1
  v_dot2c_f32_bf16 v114, v71, v0
  v_dot2c_f32_bf16 v115, v71, v1
  v_dot2c_f32_bf16 v116, v72, v0
  v_dot2c_f32_bf16 v117, v72, v1
  s_waitcnt lgkmcnt(14)
  v_dot2c_f32_bf16 v118, v73, v0
  v_dot2c_f32_bf16 v119, v73, v1
  s_waitcnt lgkmcnt(13)
  v_dot2c_f32_bf16 v120, v74, v0
  v_dot2c_f32_bf16 v121, v74, v1
  s_waitcnt lgkmcnt(12)
  v_dot2c_f32_bf16 v122, v75, v0
  v_dot2c_f32_bf16 v123, v75, v1
  s_waitcnt lgkmcnt(11)
  v_dot2c_f32_bf16 v124, v76, v0
  v_dot2c_f32_bf16 v125, v76, v1
  s_waitcnt lgkmcnt(10)
  v_dot2c_f32_bf16 v126, v77, v0
  v_dot2c_f32_bf16 v127, v77, v1
  s_waitcnt lgkmcnt(9)
  v_dot2c_f32_bf16 v128, v78, v0
  v_dot2c_f32_bf16 v129, v78, v1
  v_cvt_pk_bf16_f32 v2, v107, v214
  v_cvt_pk_bf16_f32 v3, v214, v107
  s_waitcnt lgkmcnt(8)
  v_dot2c_f32_bf16 v112, v79, v2
  v_dot2c_f32_bf16 v113, v79, v3
  s_waitcnt lgkmcnt(7)
  v_dot2c_f32_bf16 v114, v80, v2
  v_dot2c_f32_bf16 v115, v80, v3
  s_waitcnt lgkmcnt(6)
  v_dot2c_f32_bf16 v116, v81, v2
  v_dot2c_f32_bf16 v117, v81, v3
  s_waitcnt lgkmcnt(5)
  v_dot2c_f32_bf16 v118, v82, v2
  v_dot2c_f32_bf16 v119, v82, v3
  s_waitcnt lgkmcnt(4)
  v_dot2c_f32_bf16 v120, v83, v2
  v_dot2c_f32_bf16 v121, v83, v3
  s_waitcnt lgkmcnt(3)
  v_dot2c_f32_bf16 v122, v84, v2
  v_dot2c_f32_bf16 v123, v84, v3
  s_waitcnt lgkmcnt(2)
  v_dot2c_f32_bf16 v124, v85, v2
  v_dot2c_f32_bf16 v125, v85, v3
  s_waitcnt lgkmcnt(1)
  v_dot2c_f32_bf16 v126, v86, v2
  v_dot2c_f32_bf16 v127, v86, v3
  s_waitcnt lgkmcnt(0)
  v_dot2c_f32_bf16 v128, v87, v2
  v_dot2c_f32_bf16 v129, v87, v3
  v_cvt_pk_bf16_f32 v132, v112, v113
  v_cvt_pk_bf16_f32 v133, v114, v115
  v_cvt_pk_bf16_f32 v134, v116, v117
  v_cvt_pk_bf16_f32 v135, v118, v119
  v_cvt_pk_bf16_f32 v136, v120, v121
  v_cvt_pk_bf16_f32 v137, v122, v123
  v_cvt_pk_bf16_f32 v138, v124, v125
  v_cvt_pk_bf16_f32 v139, v126, v127
  v_cvt_pk_bf16_f32 v140, v128, v129
  buffer_store_dwordx4 v[132:135], v220, s[8:11], s64 offen sc1
  buffer_store_dwordx4 v[136:139], v220, s[8:11], s64 offen offset:16 sc1
  buffer_store_dword v140, v220, s[8:11], s64 offen offset:32 sc1
  v_add_u32 v219, 33024, v219
  s_add_u32 s66, s66, 64
  s_add_u32 s64, s64, 73728
  ds_read_b32 v0, v219 offset:7224
  ds_read_b32 v1, v219 offset:7228
  ds_read_b32 v2, v219 offset:7232
  ds_read_b32 v3, v219 offset:7236
  ds_read_b32 v4, v219 offset:7240
  ds_read_b32 v5, v219 offset:7244
  ds_read_b32 v6, v219 offset:7248
  ds_read_b32 v7, v219 offset:7252
  ds_read_b32 v8, v219 offset:7256
  ds_read_b32 v16, v219 offset:7368
  ds_read_b32 v17, v219 offset:7372
  ds_read_b32 v18, v219 offset:7376
  ds_read_b32 v19, v219 offset:7380
  ds_read_b32 v20, v219 offset:7384
  ds_read_b32 v21, v219 offset:7388
  ds_read_b32 v22, v219 offset:7392
  ds_read_b32 v23, v219 offset:7396
  ds_read_b32 v24, v219 offset:7400
  ds_read_b32 v25, v219 offset:6336
  ds_read_b32 v26, v219 offset:6340
  ds_read_b32 v27, v219 offset:6344
  ds_read_b32 v28, v219 offset:6348
  ds_read_b32 v29, v219 offset:6352
  ds_read_b32 v30, v219 offset:6356
  ds_read_b32 v31, v219 offset:6360
  ds_read_b32 v32, v219 offset:6364
  ds_read_b32 v33, v219 offset:6368
  ds_read_b32 v34, v219 offset:5304
  ds_read_b32 v35, v219 offset:5308
  ds_read_b32 v36, v219 offset:5312
  ds_read_b32 v37, v219 offset:5316
  ds_read_b32 v38, v219 offset:5320
  ds_read_b32 v39, v219 offset:5324
  ds_read_b32 v40, v219 offset:5328
  ds_read_b32 v41, v219 offset:5332
  ds_read_b32 v42, v219 offset:5336
  ds_read_b32 v43, v219 offset:4272
  ds_read_b32 v44, v219 offset:4276
  ds_read_b32 v45, v219 offset:4280
  ds_read_b32 v46, v219 offset:4284
  ds_read_b32 v47, v219 offset:4288
  ds_read_b32 v48, v219 offset:4292
  ds_read_b32 v49, v219 offset:4296
  ds_read_b32 v50, v219 offset:4300
  ds_read_b32 v51, v219 offset:4304
  ds_read_b32 v52, v219 offset:3240
  ds_read_b32 v53, v219 offset:3244
  ds_read_b32 v54, v219 offset:3248
  ds_read_b32 v55, v219 offset:3252
  ds_read_b32 v56, v219 offset:3256
  ds_read_b32 v57, v219 offset:3260
  ds_read_b32 v58, v219 offset:3264
  ds_read_b32 v59, v219 offset:3268
  ds_read_b32 v60, v219 offset:3272
  ds_read_b32 v61, v219 offset:2208
  ds_read_b32 v62, v219 offset:2212
  ds_read_b32 v63, v219 offset:2216
  ds_read_b32 v64, v219 offset:2220
  ds_read_b32 v65, v219 offset:2224
  ds_read_b32 v66, v219 offset:2228
  ds_read_b32 v67, v219 offset:2232
  ds_read_b32 v68, v219 offset:2236
  ds_read_b32 v69, v219 offset:2240
  ds_read_b32 v70, v219 offset:1176
  ds_read_b32 v71, v219 offset:1180
  ds_read_b32 v72, v219 offset:1184
  ds_read_b32 v73, v219 offset:1188
  ds_read_b32 v74, v219 offset:1192
  ds_read_b32 v75, v219 offset:1196
  ds_read_b32 v76, v219 offset:1200
  ds_read_b32 v77, v219 offset:1204
  ds_read_b32 v78, v219 offset:1208
  ds_read_b32 v79, v219 offset:144
  ds_read_b32 v80, v219 offset:148
  ds_read_b32 v81, v219 offset:152
  ds_read_b32 v82, v219 offset:156
  ds_read_b32 v83, v219 offset:160
  ds_read_b32 v84, v219 offset:164
  ds_read_b32 v85, v219 offset:168
  ds_read_b32 v86, v219 offset:172
  ds_read_b32 v87, v219 offset:176
  v_mov_b32 v100, 0
  v_mov_b32 v101, 0
  v_mov_b32 v102, 0
  v_mov_b32 v103, 0
  v_mov_b32 v104, 0
  v_mov_b32 v105, 0
  v_mov_b32 v106, 0
  v_mov_b32 v107, 0
  s_waitcnt lgkmcnt(15)
  v_dot2c_f32_bf16 v100, v0, v16
  v_dot2c_f32_bf16 v101, v0, v25
  v_dot2c_f32_bf16 v102, v0, v34
  v_dot2c_f32_bf16 v103, v0, v43
  v_dot2c_f32_bf16 v104, v0, v52
  v_dot2c_f32_bf16 v105, v0, v61
  v_dot2c_f32_bf16 v106, v0, v70
  s_waitcnt lgkmcnt(8)
  v_dot2c_f32_bf16 v107, v0, v79
  v_dot2c_f32_bf16 v100, v1, v17
  v_dot2c_f32_bf16 v101, v1, v26
  v_dot2c_f32_bf16 v102, v1, v35
  v_dot2c_f32_bf16 v103, v1, v44
  v_dot2c_f32_bf16 v104, v1, v53
  v_dot2c_f32_bf16 v105, v1, v62
  v_dot2c_f32_bf16 v106, v1, v71
  s_waitcnt lgkmcnt(7)
  v_dot2c_f32_bf16 v107, v1, v80
  v_dot2c_f32_bf16 v100, v2, v18
  v_dot2c_f32_bf16 v101, v2, v27
  v_dot2c_f32_bf16 v102, v2, v36
  v_dot2c_f32_bf16 v103, v2, v45
  v_dot2c_f32_bf16 v104, v2, v54
  v_dot2c_f32_bf16 v105, v2, v63
  v_dot2c_f32_bf16 v106, v2, v72
  s_waitcnt lgkmcnt(6)
  v_dot2c_f32_bf16 v107, v2, v81
  v_dot2c_f32_bf16 v100, v3, v19
  v_dot2c_f32_bf16 v101, v3, v28
  v_dot2c_f32_bf16 v102, v3, v37
  v_dot2c_f32_bf16 v103, v3, v46
  v_dot2c_f32_bf16 v104, v3, v55
  v_dot2c_f32_bf16 v105, v3, v64
  v_dot2c_f32_bf16 v106, v3, v73
  s_waitcnt lgkmcnt(5)
  v_dot2c_f32_bf16 v107, v3, v82
  v_dot2c_f32_bf16 v100, v4, v20
  v_dot2c_f32_bf16 v101, v4, v29
  v_dot2c_f32_bf16 v102, v4, v38
  v_dot2c_f32_bf16 v103, v4, v47
  v_dot2c_f32_bf16 v104, v4, v56
  v_dot2c_f32_bf16 v105, v4, v65
  v_dot2c_f32_bf16 v106, v4, v74
  s_waitcnt lgkmcnt(4)
  v_dot2c_f32_bf16 v107, v4, v83
  v_dot2c_f32_bf16 v100, v5, v21
  v_dot2c_f32_bf16 v101, v5, v30
  v_dot2c_f32_bf16 v102, v5, v39
  v_dot2c_f32_bf16 v103, v5, v48
  v_dot2c_f32_bf16 v104, v5, v57
  v_dot2c_f32_bf16 v105, v5, v66
  v_dot2c_f32_bf16 v106, v5, v75
  s_waitcnt lgkmcnt(3)
  v_dot2c_f32_bf16 v107, v5, v84
  v_dot2c_f32_bf16 v100, v6, v22
  v_dot2c_f32_bf16 v101, v6, v31
  v_dot2c_f32_bf16 v102, v6, v40
  v_dot2c_f32_bf16 v103, v6, v49
  v_dot2c_f32_bf16 v104, v6, v58
  v_dot2c_f32_bf16 v105, v6, v67
  v_dot2c_f32_bf16 v106, v6, v76
  s_waitcnt lgkmcnt(2)
  v_dot2c_f32_bf16 v107, v6, v85
  v_dot2c_f32_bf16 v100, v7, v23
  v_dot2c_f32_bf16 v101, v7, v32
  v_dot2c_f32_bf16 v102, v7, v41
  v_dot2c_f32_bf16 v103, v7, v50
  v_dot2c_f32_bf16 v104, v7, v59
  v_dot2c_f32_bf16 v105, v7, v68
  v_dot2c_f32_bf16 v106, v7, v77
  s_waitcnt lgkmcnt(1)
  v_dot2c_f32_bf16 v107, v7, v86
  v_dot2c_f32_bf16 v100, v8, v24
  v_dot2c_f32_bf16 v101, v8, v33
  v_dot2c_f32_bf16 v102, v8, v42
  v_dot2c_f32_bf16 v103, v8, v51
  v_dot2c_f32_bf16 v104, v8, v60
  v_dot2c_f32_bf16 v105, v8, v69
  v_dot2c_f32_bf16 v106, v8, v78
  s_waitcnt lgkmcnt(0)
  v_dot2c_f32_bf16 v107, v8, v87
  ds_read_b32 v16, v219 offset:7512
  ds_read_b32 v17, v219 offset:7516
  ds_read_b32 v18, v219 offset:7520
  ds_read_b32 v19, v219 offset:7524
  ds_read_b32 v20, v219 offset:7528
  ds_read_b32 v21, v219 offset:7532
  ds_read_b32 v22, v219 offset:7536
  ds_read_b32 v23, v219 offset:7540
  ds_read_b32 v24, v219 offset:7544
  ds_read_b32 v25, v219 offset:6480
  ds_read_b32 v26, v219 offset:6484
  ds_read_b32 v27, v219 offset:6488
  ds_read_b32 v28, v219 offset:6492
  ds_read_b32 v29, v219 offset:6496
  ds_read_b32 v30, v219 offset:6500
  ds_read_b32 v31, v219 offset:6504
  ds_read_b32 v32, v219 offset:6508
  ds_read_b32 v33, v219 offset:6512
  ds_read_b32 v34, v219 offset:5448
  ds_read_b32 v35, v219 offset:5452
  ds_read_b32 v36, v219 offset:5456
  ds_read_b32 v37, v219 offset:5460
  ds_read_b32 v38, v219 offset:5464
  ds_read_b32 v39, v219 offset:5468
  ds_read_b32 v40, v219 offset:5472
  ds_read_b32 v41, v219 offset:5476
  ds_read_b32 v42, v219 offset:5480
  ds_read_b32 v43, v219 offset:4416
  ds_read_b32 v44, v219 offset:4420
  ds_read_b32 v45, v219 offset:4424
  ds_read_b32 v46, v219 offset:4428
  ds_read_b32 v47, v219 offset:4432
  ds_read_b32 v48, v219 offset:4436
  ds_read_b32 v49, v219 offset:4440
  ds_read_b32 v50, v219 offset:4444
  ds_read_b32 v51, v219 offset:4448
  ds_read_b32 v52, v219 offset:3384
  ds_read_b32 v53, v219 offset:3388
  ds_read_b32 v54, v219 offset:3392
  ds_read_b32 v55, v219 offset:3396
  ds_read_b32 v56, v219 offset:3400
  ds_read_b32 v57, v219 offset:3404
  ds_read_b32 v58, v219 offset:3408
  ds_read_b32 v59, v219 offset:3412
  ds_read_b32 v60, v219 offset:3416
  ds_read_b32 v61, v219 offset:2352
  ds_read_b32 v62, v219 offset:2356
  ds_read_b32 v63, v219 offset:2360
  ds_read_b32 v64, v219 offset:2364
  ds_read_b32 v65, v219 offset:2368
  ds_read_b32 v66, v219 offset:2372
  ds_read_b32 v67, v219 offset:2376
  ds_read_b32 v68, v219 offset:2380
  ds_read_b32 v69, v219 offset:2384
  ds_read_b32 v70, v219 offset:1320
  ds_read_b32 v71, v219 offset:1324
  ds_read_b32 v72, v219 offset:1328
  ds_read_b32 v73, v219 offset:1332
  ds_read_b32 v74, v219 offset:1336
  ds_read_b32 v75, v219 offset:1340
  ds_read_b32 v76, v219 offset:1344
  ds_read_b32 v77, v219 offset:1348
  ds_read_b32 v78, v219 offset:1352
  ds_read_b32 v79, v219 offset:288
  ds_read_b32 v80, v219 offset:292
  ds_read_b32 v81, v219 offset:296
  ds_read_b32 v82, v219 offset:300
  ds_read_b32 v83, v219 offset:304
  ds_read_b32 v84, v219 offset:308
  ds_read_b32 v85, v219 offset:312
  ds_read_b32 v86, v219 offset:316
  ds_read_b32 v87, v219 offset:320
  v_add_u32 v211, s66, v200
  v_mov_b32 v212, 0xf149f2ca
  v_mul_f32 v100, s57, v100
  v_mul_f32 v101, s57, v101
  v_mul_f32 v102, s57, v102
  v_mul_f32 v103, s57, v103
  v_mul_f32 v104, s57, v104
  v_mul_f32 v105, s57, v105
  v_mul_f32 v106, s57, v106
  v_mul_f32 v107, s57, v107
  v_cmp_gt_u32 vcc, 2, v211
  s_nop 1
  v_cndmask_b32 v101, v101, v212, vcc
  v_cmp_gt_u32 vcc, 4, v211
  s_nop 1
  v_cndmask_b32 v102, v102, v212, vcc
  v_cmp_gt_u32 vcc, 6, v211
  s_nop 1
  v_cndmask_b32 v103, v103, v212, vcc
  v_cmp_gt_u32 vcc, 8, v211
  s_nop 1
  v_cndmask_b32 v104, v104, v212, vcc
  v_cmp_gt_u32 vcc, 10, v211
  s_nop 1
  v_cndmask_b32 v105, v105, v212, vcc
  v_cmp_gt_u32 vcc, 12, v211
  s_nop 1
  v_cndmask_b32 v106, v106, v212, vcc
  v_cmp_gt_u32 vcc, 14, v211
  s_nop 1
  v_cndmask_b32 v107, v107, v212, vcc
  v_max3_f32 v213, v100, v101, v102
  v_max3_f32 v213, v213, v103, v104
  v_max3_f32 v213, v213, v105, v106
  v_max_f32 v213, v213, v107
  v_sub_f32 v100, v100, v213
  v_sub_f32 v101, v101, v213
  v_sub_f32 v102, v102, v213
  v_sub_f32 v103, v103, v213
  v_sub_f32 v104, v104, v213
  v_sub_f32 v105, v105, v213
  v_sub_f32 v106, v106, v213
  v_sub_f32 v107, v107, v213
  v_exp_f32 v100, v100
  v_exp_f32 v101, v101
  v_exp_f32 v102, v102
  v_exp_f32 v103, v103
  v_exp_f32 v104, v104
  v_exp_f32 v105, v105
  v_exp_f32 v106, v106
  v_exp_f32 v107, v107
  v_add_f32 v213, v100, v101
  v_add_f32 v213, v213, v102
  v_add_f32 v213, v213, v103
  v_add_f32 v213, v213, v104
  v_add_f32 v213, v213, v105
  v_add_f32 v213, v213, v106
  v_add_f32 v213, v213, v107
  v_rcp_f32 v213, v213
  v_mov_b32 v214, 0
  v_mul_f32 v100, v213, v100
  v_mul_f32 v101, v213, v101
  v_mul_f32 v102, v213, v102
  v_mul_f32 v103, v213, v103
  v_mul_f32 v104, v213, v104
  v_mul_f32 v105, v213, v105
  v_mul_f32 v106, v213, v106
  v_mul_f32 v107, v213, v107
  v_mov_b32 v112, 0
  v_mov_b32 v113, 0
  v_mov_b32 v114, 0
  v_mov_b32 v115, 0
  v_mov_b32 v116, 0
  v_mov_b32 v117, 0
  v_mov_b32 v118, 0
  v_mov_b32 v119, 0
  v_mov_b32 v120, 0
  v_mov_b32 v121, 0
  v_mov_b32 v122, 0
  v_mov_b32 v123, 0
  v_mov_b32 v124, 0
  v_mov_b32 v125, 0
  v_mov_b32 v126, 0
  v_mov_b32 v127, 0
  v_mov_b32 v128, 0
  v_mov_b32 v129, 0
  v_cvt_pk_bf16_f32 v0, v100, v214
  v_cvt_pk_bf16_f32 v1, v214, v100
  s_waitcnt lgkmcnt(15)
  v_dot2c_f32_bf16 v112, v16, v0
  v_dot2c_f32_bf16 v113, v16, v1
  v_dot2c_f32_bf16 v114, v17, v0
  v_dot2c_f32_bf16 v115, v17, v1
  v_dot2c_f32_bf16 v116, v18, v0
  v_dot2c_f32_bf16 v117, v18, v1
  v_dot2c_f32_bf16 v118, v19, v0
  v_dot2c_f32_bf16 v119, v19, v1
  v_dot2c_f32_bf16 v120, v20, v0
  v_dot2c_f32_bf16 v121, v20, v1
  v_dot2c_f32_bf16 v122, v21, v0
  v_dot2c_f32_bf16 v123, v21, v1
  v_dot2c_f32_bf16 v124, v22, v0
  v_dot2c_f32_bf16 v125, v22, v1
  v_dot2c_f32_bf16 v126, v23, v0
  v_dot2c_f32_bf16 v127, v23, v1
  v_dot2c_f32_bf16 v128, v24, v0
  v_dot2c_f32_bf16 v129, v24, v1
  v_cvt_pk_bf16_f32 v2, v101, v214
  v_cvt_pk_bf16_f32 v3, v214, v101
  v_dot2c_f32_bf16 v112, v25, v2
  v_dot2c_f32_bf16 v113, v25, v3
  v_dot2c_f32_bf16 v114, v26, v2
  v_dot2c_f32_bf16 v115, v26, v3
  v_dot2c_f32_bf16 v116, v27, v2
  v_dot2c_f32_bf16 v117, v27, v3
  v_dot2c_f32_bf16 v118, v28, v2
  v_dot2c_f32_bf16 v119, v28, v3
  v_dot2c_f32_bf16 v120, v29, v2
  v_dot2c_f32_bf16 v121, v29, v3
  v_dot2c_f32_bf16 v122, v30, v2
  v_dot2c_f32_bf16 v123, v30, v3
  v_dot2c_f32_bf16 v124, v31, v2
  v_dot2c_f32_bf16 v125, v31, v3
  v_dot2c_f32_bf16 v126, v32, v2
  v_dot2c_f32_bf16 v127, v32, v3
  v_dot2c_f32_bf16 v128, v33, v2
  v_dot2c_f32_bf16 v129, v33, v3
  v_cvt_pk_bf16_f32 v0, v102, v214
  v_cvt_pk_bf16_f32 v1, v214, v102
  v_dot2c_f32_bf16 v112, v34, v0
  v_dot2c_f32_bf16 v113, v34, v1
  v_dot2c_f32_bf16 v114, v35, v0
  v_dot2c_f32_bf16 v115, v35, v1
  v_dot2c_f32_bf16 v116, v36, v0
  v_dot2c_f32_bf16 v117, v36, v1
  v_dot2c_f32_bf16 v118, v37, v0
  v_dot2c_f32_bf16 v119, v37, v1
  v_dot2c_f32_bf16 v120, v38, v0
  v_dot2c_f32_bf16 v121, v38, v1
  v_dot2c_f32_bf16 v122, v39, v0
  v_dot2c_f32_bf16 v123, v39, v1
  v_dot2c_f32_bf16 v124, v40, v0
  v_dot2c_f32_bf16 v125, v40, v1
  v_dot2c_f32_bf16 v126, v41, v0
  v_dot2c_f32_bf16 v127, v41, v1
  v_dot2c_f32_bf16 v128, v42, v0
  v_dot2c_f32_bf16 v129, v42, v1
  v_cvt_pk_bf16_f32 v2, v103, v214
  v_cvt_pk_bf16_f32 v3, v214, v103
  v_dot2c_f32_bf16 v112, v43, v2
  v_dot2c_f32_bf16 v113, v43, v3
  v_dot2c_f32_bf16 v114, v44, v2
  v_dot2c_f32_bf16 v115, v44, v3
  v_dot2c_f32_bf16 v116, v45, v2
  v_dot2c_f32_bf16 v117, v45, v3
  v_dot2c_f32_bf16 v118, v46, v2
  v_dot2c_f32_bf16 v119, v46, v3
  v_dot2c_f32_bf16 v120, v47, v2
  v_dot2c_f32_bf16 v121, v47, v3
  v_dot2c_f32_bf16 v122, v48, v2
  v_dot2c_f32_bf16 v123, v48, v3
  v_dot2c_f32_bf16 v124, v49, v2
  v_dot2c_f32_bf16 v125, v49, v3
  v_dot2c_f32_bf16 v126, v50, v2
  v_dot2c_f32_bf16 v127, v50, v3
  v_dot2c_f32_bf16 v128, v51, v2
  v_dot2c_f32_bf16 v129, v51, v3
  v_cvt_pk_bf16_f32 v0, v104, v214
  v_cvt_pk_bf16_f32 v1, v214, v104
  v_dot2c_f32_bf16 v112, v52, v0
  v_dot2c_f32_bf16 v113, v52, v1
  v_dot2c_f32_bf16 v114, v53, v0
  v_dot2c_f32_bf16 v115, v53, v1
  v_dot2c_f32_bf16 v116, v54, v0
  v_dot2c_f32_bf16 v117, v54, v1
  v_dot2c_f32_bf16 v118, v55, v0
  v_dot2c_f32_bf16 v119, v55, v1
  v_dot2c_f32_bf16 v120, v56, v0
  v_dot2c_f32_bf16 v121, v56, v1
  v_dot2c_f32_bf16 v122, v57, v0
  v_dot2c_f32_bf16 v123, v57, v1
  v_dot2c_f32_bf16 v124, v58, v0
  v_dot2c_f32_bf16 v125, v58, v1
  v_dot2c_f32_bf16 v126, v59, v0
  v_dot2c_f32_bf16 v127, v59, v1
  v_dot2c_f32_bf16 v128, v60, v0
  v_dot2c_f32_bf16 v129, v60, v1
  v_cvt_pk_bf16_f32 v2, v105, v214
  v_cvt_pk_bf16_f32 v3, v214, v105
  v_dot2c_f32_bf16 v112, v61, v2
  v_dot2c_f32_bf16 v113, v61, v3
  v_dot2c_f32_bf16 v114, v62, v2
  v_dot2c_f32_bf16 v115, v62, v3
  v_dot2c_f32_bf16 v116, v63, v2
  v_dot2c_f32_bf16 v117, v63, v3
  v_dot2c_f32_bf16 v118, v64, v2
  v_dot2c_f32_bf16 v119, v64, v3
  v_dot2c_f32_bf16 v120, v65, v2
  v_dot2c_f32_bf16 v121, v65, v3
  v_dot2c_f32_bf16 v122, v66, v2
  v_dot2c_f32_bf16 v123, v66, v3
  v_dot2c_f32_bf16 v124, v67, v2
  v_dot2c_f32_bf16 v125, v67, v3
  v_dot2c_f32_bf16 v126, v68, v2
  v_dot2c_f32_bf16 v127, v68, v3
  v_dot2c_f32_bf16 v128, v69, v2
  v_dot2c_f32_bf16 v129, v69, v3
  v_cvt_pk_bf16_f32 v0, v106, v214
  v_cvt_pk_bf16_f32 v1, v214, v106
  v_dot2c_f32_bf16 v112, v70, v0
  v_dot2c_f32_bf16 v113, v70, v1
  v_dot2c_f32_bf16 v114, v71, v0
  v_dot2c_f32_bf16 v115, v71, v1
  v_dot2c_f32_bf16 v116, v72, v0
  v_dot2c_f32_bf16 v117, v72, v1
  s_waitcnt lgkmcnt(14)
  v_dot2c_f32_bf16 v118, v73, v0
  v_dot2c_f32_bf16 v119, v73, v1
  s_waitcnt lgkmcnt(13)
  v_dot2c_f32_bf16 v120, v74, v0
  v_dot2c_f32_bf16 v121, v74, v1
  s_waitcnt lgkmcnt(12)
  v_dot2c_f32_bf16 v122, v75, v0
  v_dot2c_f32_bf16 v123, v75, v1
  s_waitcnt lgkmcnt(11)
  v_dot2c_f32_bf16 v124, v76, v0
  v_dot2c_f32_bf16 v125, v76, v1
  s_waitcnt lgkmcnt(10)
  v_dot2c_f32_bf16 v126, v77, v0
  v_dot2c_f32_bf16 v127, v77, v1
  s_waitcnt lgkmcnt(9)
  v_dot2c_f32_bf16 v128, v78, v0
  v_dot2c_f32_bf16 v129, v78, v1
  v_cvt_pk_bf16_f32 v2, v107, v214
  v_cvt_pk_bf16_f32 v3, v214, v107
  s_waitcnt lgkmcnt(8)
  v_dot2c_f32_bf16 v112, v79, v2
  v_dot2c_f32_bf16 v113, v79, v3
  s_waitcnt lgkmcnt(7)
  v_dot2c_f32_bf16 v114, v80, v2
  v_dot2c_f32_bf16 v115, v80, v3
  s_waitcnt lgkmcnt(6)
  v_dot2c_f32_bf16 v116, v81, v2
  v_dot2c_f32_bf16 v117, v81, v3
  s_waitcnt lgkmcnt(5)
  v_dot2c_f32_bf16 v118, v82, v2
  v_dot2c_f32_bf16 v119, v82, v3
  s_waitcnt lgkmcnt(4)
  v_dot2c_f32_bf16 v120, v83, v2
  v_dot2c_f32_bf16 v121, v83, v3
  s_waitcnt lgkmcnt(3)
  v_dot2c_f32_bf16 v122, v84, v2
  v_dot2c_f32_bf16 v123, v84, v3
  s_waitcnt lgkmcnt(2)
  v_dot2c_f32_bf16 v124, v85, v2
  v_dot2c_f32_bf16 v125, v85, v3
  s_waitcnt lgkmcnt(1)
  v_dot2c_f32_bf16 v126, v86, v2
  v_dot2c_f32_bf16 v127, v86, v3
  s_waitcnt lgkmcnt(0)
  v_dot2c_f32_bf16 v128, v87, v2
  v_dot2c_f32_bf16 v129, v87, v3
  v_cvt_pk_bf16_f32 v132, v112, v113
  v_cvt_pk_bf16_f32 v133, v114, v115
  v_cvt_pk_bf16_f32 v134, v116, v117
  v_cvt_pk_bf16_f32 v135, v118, v119
  v_cvt_pk_bf16_f32 v136, v120, v121
  v_cvt_pk_bf16_f32 v137, v122, v123
  v_cvt_pk_bf16_f32 v138, v124, v125
  v_cvt_pk_bf16_f32 v139, v126, v127
  v_cvt_pk_bf16_f32 v140, v128, v129
  buffer_store_dwordx4 v[132:135], v220, s[8:11], s64 offen sc1
  buffer_store_dwordx4 v[136:139], v220, s[8:11], s64 offen offset:16 sc1
  buffer_store_dword v140, v220, s[8:11], s64 offen offset:32 sc1
  s_mov_b32 s56, 36
  s_waitcnt vmcnt(0)
  s_barrier
  s_cmp_eq_u32 s52, 0
  s_cbranch_scc0 A_sig
  v_mov_b32 v211, 1
  v_mov_b32 v212, 0
  s_mov_b64 exec, 1
  buffer_atomic_add v211, v212, s[12:15], s56 offen
  s_mov_b64 exec, -1
A_sig:
  s_and_b32 s54, s53, 31
  s_cmp_lt_u32 s54, 27
  s_cbranch_scc0 L_exit
  s_and_b32 s54, s53, 31
  s_mul_i32 s68, s54, 57
  s_lshr_b32 s68, s68, 9
  s_mul_i32 s56, s68, 9
  s_sub_u32 s70, s54, s56
  s_bfe_u32 s55, s53, 0x10005
  s_mul_i32 s55, s55, 9
  s_add_u32 s70, s70, s55
  s_bfe_u32 s69, s53, 0x10006
  v_lshrrev_b32 v211, 2, v200
  v_mul_u32_u24 v211, 1152, v211
  v_and_b32 v212, 3, v200
  v_lshl_add_u32 v207, v212, 4, v211
  s_lshl_b32 s54, s70, 6
  s_mul_i32 s55, s52, 1179648
  s_add_u32 s62, s54, s55
  s_mul_i32 s55, s52, 184320
  s_add_u32 s63, s54, s55
  s_mul_i32 s61, s52, 40960
  v_bfe_u32 v211, v200, 2, 2
  v_lshlrev_b32 v212, 4, v212
  v_add_u32 v212, s61, v212
  v_lshl_add_u32 v212, v211, 6, v212
  v_lshrrev_b32 v213, 4, v200
  v_lshl_add_u32 v210, v213, 9, v212
  v_lshrrev_b32 v214, 5, v200
  v_lshl_add_u32 v209, v214, 10, v212
  v_and_b32 v214, 1, v213
  v_lshl_add_u32 v209, v214, 8, v209
  s_add_u32 m0, s61, 0
  s_add_u32 s54, s62, 0
  buffer_load_dwordx4 v207, s[28:31], s54 offen lds
  s_add_u32 m0, s61, 1024
  s_add_u32 s54, s62, 18432
  buffer_load_dwordx4 v207, s[28:31], s54 offen lds
  s_add_u32 m0, s61, 2048
  s_add_u32 s54, s62, 36864
  buffer_load_dwordx4 v207, s[28:31], s54 offen lds
  s_add_u32 m0, s61, 3072
  s_add_u32 s54, s62, 55296
  buffer_load_dwordx4 v207, s[28:31], s54 offen lds
  s_add_u32 m0, s61, 4096
  s_add_u32 s54, s62, 73728
  buffer_load_dwordx4 v207, s[28:31], s54 offen lds
  s_add_u32 m0, s61, 5120
  s_add_u32 s54, s62, 92160
  buffer_load_dwordx4 v207, s[28:31], s54 offen lds
  s_add_u32 m0, s61, 6144
  s_add_u32 s54, s62, 110592
  buffer_load_dwordx4 v207, s[28:31], s54 offen lds
  s_add_u32 m0, s61, 7168
  s_add_u32 s54, s62, 129024
  buffer_load_dwordx4 v207, s[28:31], s54 offen lds
  s_add_u32 m0, s61, 8192
  s_add_u32 s54, s62, 147456
  buffer_load_dwordx4 v207, s[28:31], s54 offen lds
  s_add_u32 m0, s61, 9216
  s_add_u32 s54, s62, 165888
  buffer_load_dwordx4 v207, s[28:31], s54 offen lds
  s_add_u32 m0, s61, 10240
  s_add_u32 s54, s62, 184320
  buffer_load_dwordx4 v207, s[28:31], s54 offen lds
  s_add_u32 m0, s61, 11264
  s_add_u32 s54, s62, 202752
  buffer_load_dwordx4 v207, s[28:31], s54 offen lds
  s_add_u32 m0, s61, 12288
  s_add_u32 s54, s62, 221184
  buffer_load_dwordx4 v207, s[28:31], s54 offen lds
  s_add_u32 m0, s61, 13312
  s_add_u32 s54, s62, 239616
  buffer_load_dwordx4 v207, s[28:31], s54 offen lds
  s_add_u32 m0, s61, 14336
  s_add_u32 s54, s62, 258048
  buffer_load_dwordx4 v207, s[28:31], s54 offen lds
  s_add_u32 m0, s61, 15360
  s_add_u32 s54, s62, 276480
  buffer_load_dwordx4 v207, s[28:31], s54 offen lds
  s_add_u32 m0, s61, 16384
  s_add_u32 s54, s62, 294912
  buffer_load_dwordx4 v207, s[28:31], s54 offen lds
  s_add_u32 m0, s61, 17408
  s_add_u32 s54, s62, 313344
  buffer_load_dwordx4 v207, s[28:31], s54 offen lds
  s_add_u32 m0, s61, 18432
  s_add_u32 s54, s62, 331776
  buffer_load_dwordx4 v207, s[28:31], s54 offen lds
  s_add_u32 m0, s61, 19456
  s_add_u32 s54, s62, 350208
  buffer_load_dwordx4 v207, s[28:31], s54 offen lds
  s_add_u32 m0, s61, 20480
  s_add_u32 s54, s62, 368640
  buffer_load_dwordx4 v207, s[28:31], s54 offen lds
  s_add_u32 m0, s61, 21504
  s_add_u32 s54, s62, 387072
  buffer_load_dwordx4 v207, s[28:31], s54 offen lds
  s_add_u32 m0, s61, 22528
  s_add_u32 s54, s62, 405504
  buffer_load_dwordx4 v207, s[28:31], s54 offen lds
  s_add_u32 m0, s61, 23552
  s_add_u32 s54, s62, 423936
  buffer_load_dwordx4 v207, s[28:31], s54 offen lds
  s_add_u32 m0, s61, 24576
  s_add_u32 s54, s62, 442368
  buffer_load_dwordx4 v207, s[28:31], s54 offen lds
  s_add_u32 m0, s61, 25600
  s_add_u32 s54, s62, 460800
  buffer_load_dwordx4 v207, s[28:31], s54 offen lds
  s_add_u32 m0, s61, 26624
  s_add_u32 s54, s62, 479232
  buffer_load_dwordx4 v207, s[28:31], s54 offen lds
  s_add_u32 m0, s61, 27648
  s_add_u32 s54, s62, 497664
  buffer_load_dwordx4 v207, s[28:31], s54 offen lds
  s_add_u32 m0, s61, 28672
  s_add_u32 s54, s62, 516096
  buffer_load_dwordx4 v207, s[28:31], s54 offen lds
  s_add_u32 m0, s61, 29696
  s_add_u32 s54, s62, 534528
  buffer_load_dwordx4 v207, s[28:31], s54 offen lds
  s_add_u32 m0, s61, 30720
  s_add_u32 s54, s62, 552960
  buffer_load_dwordx4 v207, s[28:31], s54 offen lds
  s_add_u32 m0, s61, 31744
  s_add_u32 s54, s62, 571392
  buffer_load_dwordx4 v207, s[28:31], s54 offen lds
  s_add_u32 m0, s61, 32768
  s_add_u32 s54, s62, 589824
  buffer_load_dwordx4 v207, s[28:31], s54 offen lds
  s_add_u32 m0, s61, 33792
  s_add_u32 s54, s62, 608256
  buffer_load_dwordx4 v207, s[28:31], s54 offen lds
  s_add_u32 m0, s61, 34816
  s_add_u32 s54, s62, 626688
  buffer_load_dwordx4 v207, s[28:31], s54 offen lds
  s_add_u32 m0, s61, 35840
  s_add_u32 s54, s62, 645120
  buffer_load_dwordx4 v207, s[28:31], s54 offen lds
  s_add_u32 m0, s61, 36864
  s_add_u32 s54, s62, 663552
  buffer_load_dwordx4 v207, s[28:31], s54 offen lds
  s_add_u32 m0, s61, 37888
  s_add_u32 s54, s62, 681984
  buffer_load_dwordx4 v207, s[28:31], s54 offen lds
  s_waitcnt vmcnt(36) lgkmcnt(0)
  s_add_u32 m0, s61, 38912
  s_add_u32 s54, s62, 700416
  buffer_load_dwordx4 v207, s[28:31], s54 offen lds
  s_add_u32 m0, s61, 39936
  s_add_u32 s54, s62, 718848
  buffer_load_dwordx4 v207, s[28:31], s54 offen lds
  ds_read_b64_tr_b16 a[0:1], v209 offset:0
  ds_read_b64_tr_b16 a[2:3], v209 offset:512
  ds_read_b64_tr_b16 a[4:5], v209 offset:8
  ds_read_b64_tr_b16 a[6:7], v209 offset:520
  s_waitcnt vmcnt(36) lgkmcnt(0)
  s_add_u32 m0, s61, 0
  s_add_u32 s54, s62, 737280
  buffer_load_dwordx4 v207, s[28:31], s54 offen lds
  s_add_u32 m0, s61, 1024
  s_add_u32 s54, s62, 755712
  buffer_load_dwordx4 v207, s[28:31], s54 offen lds
  ds_read_b64_tr_b16 a[8:9], v209 offset:2048
  ds_read_b64_tr_b16 a[10:11], v209 offset:2560
  ds_read_b64_tr_b16 a[12:13], v209 offset:2056
  ds_read_b64_tr_b16 a[14:15], v209 offset:2568
  s_waitcnt vmcnt(36) lgkmcnt(0)
  s_add_u32 m0, s61, 2048
  s_add_u32 s54, s62, 774144
  buffer_load_dwordx4 v207, s[28:31], s54 offen lds
  s_add_u32 m0, s61, 3072
  s_add_u32 s54, s62, 792576
  buffer_load_dwordx4 v207, s[28:31], s54 offen lds
  ds_read_b64_tr_b16 a[16:17], v209 offset:4096
  ds_read_b64_tr_b16 a[18:19], v209 offset:4608
  ds_read_b64_tr_b16 a[20:21], v209 offset:4104
  ds_read_b64_tr_b16 a[22:23], v209 offset:4616
  s_waitcnt vmcnt(36) lgkmcnt(0)
  s_add_u32 m0, s61, 4096
  s_add_u32 s54, s62, 811008
  buffer_load_dwordx4 v207, s[28:31], s54 offen lds
  s_add_u32 m0, s61, 5120
  s_add_u32 s54, s62, 829440
  buffer_load_dwordx4 v207, s[28:31], s54 offen lds
  ds_read_b64_tr_b16 a[24:25], v209 offset:6144
  ds_read_b64_tr_b16 a[26:27], v209 offset:6656
  ds_read_b64_tr_b16 a[28:29], v209 offset:6152
  ds_read_b64_tr_b16 a[30:31], v209 offset:6664
  s_waitcnt vmcnt(36) lgkmcnt(0)
  s_add_u32 m0, s61, 6144
  s_add_u32 s54, s62, 847872
  buffer_load_dwordx4 v207, s[28:31], s54 offen lds
  s_add_u32 m0, s61, 7168
  s_add_u32 s54, s62, 866304
  buffer_load_dwordx4 v207, s[28:31], s54 offen lds
  ds_read_b64_tr_b16 a[32:33], v209 offset:8192
  ds_read_b64_tr_b16 a[34:35], v209 offset:8704
  ds_read_b64_tr_b16 a[36:37], v209 offset:8200
  ds_read_b64_tr_b16 a[38:39], v209 offset:8712
  s_waitcnt vmcnt(36) lgkmcnt(0)
  s_add_u32 m0, s61, 8192
  s_add_u32 s54, s62, 884736
  buffer_load_dwordx4 v207, s[28:31], s54 offen lds
  s_add_u32 m0, s61, 9216
  s_add_u32 s54, s62, 903168
  buffer_load_dwordx4 v207, s[28:31], s54 offen lds
  ds_read_b64_tr_b16 a[40:41], v209 offset:10240
  ds_read_b64_tr_b16 a[42:43], v209 offset:10752
  ds_read_b64_tr_b16 a[44:45], v209 offset:10248
  ds_read_b64_tr_b16 a[46:47], v209 offset:10760
  s_waitcnt vmcnt(36) lgkmcnt(0)
  s_add_u32 m0, s61, 10240
  s_add_u32 s54, s62, 921600
  buffer_load_dwordx4 v207, s[28:31], s54 offen lds
  s_add_u32 m0, s61, 11264
  s_add_u32 s54, s62, 940032
  buffer_load_dwordx4 v207, s[28:31], s54 offen lds
  ds_read_b64_tr_b16 a[48:49], v209 offset:12288
  ds_read_b64_tr_b16 a[50:51], v209 offset:12800
  ds_read_b64_tr_b16 a[52:53], v209 offset:12296
  ds_read_b64_tr_b16 a[54:55], v209 offset:12808
  s_waitcnt vmcnt(36) lgkmcnt(0)
  s_add_u32 m0, s61, 12288
  s_add_u32 s54, s62, 958464
  buffer_load_dwordx4 v207, s[28:31], s54 offen lds
  s_add_u32 m0, s61, 13312
  s_add_u32 s54, s62, 976896
  buffer_load_dwordx4 v207, s[28:31], s54 offen lds
  ds_read_b64_tr_b16 a[56:57], v209 offset:14336
  ds_read_b64_tr_b16 a[58:59], v209 offset:14848
  ds_read_b64_tr_b16 a[60:61], v209 offset:14344
  ds_read_b64_tr_b16 a[62:63], v209 offset:14856
  s_waitcnt vmcnt(36) lgkmcnt(0)
  s_add_u32 m0, s61, 14336
  s_add_u32 s54, s62, 995328
  buffer_load_dwordx4 v207, s[28:31], s54 offen lds
  s_add_u32 m0, s61, 15360
  s_add_u32 s54, s62, 1013760
  buffer_load_dwordx4 v207, s[28:31], s54 offen lds
  ds_read_b64_tr_b16 a[64:65], v209 offset:16384
  ds_read_b64_tr_b16 a[66:67], v209 offset:16896
  ds_read_b64_tr_b16 a[68:69], v209 offset:16392
  ds_read_b64_tr_b16 a[70:71], v209 offset:16904
  s_waitcnt vmcnt(36) lgkmcnt(0)
  s_add_u32 m0, s61, 16384
  s_add_u32 s54, s62, 1032192
  buffer_load_dwordx4 v207, s[28:31], s54 offen lds
  s_add_u32 m0, s61, 17408
  s_add_u32 s54, s62, 1050624
  buffer_load_dwordx4 v207, s[28:31], s54 offen lds
  ds_read_b64_tr_b16 a[72:73], v209 offset:18432
  ds_read_b64_tr_b16 a[74:75], v209 offset:18944
  ds_read_b64_tr_b16 a[76:77], v209 offset:18440
  ds_read_b64_tr_b16 a[78:79], v209 offset:18952
  s_waitcnt vmcnt(36) lgkmcnt(0)
  s_add_u32 m0, s61, 18432
  s_add_u32 s54, s62, 1069056
  buffer_load_dwordx4 v207, s[28:31], s54 offen lds
  s_add_u32 m0, s61, 19456
  s_add_u32 s54, s62, 1087488
  buffer_load_dwordx4 v207, s[28:31], s54 offen lds
  ds_read_b64_tr_b16 a[80:81], v209 offset:20480
  ds_read_b64_tr_b16 a[82:83], v209 offset:20992
  ds_read_b64_tr_b16 a[84:85], v209 offset:20488
  ds_read_b64_tr_b16 a[86:87], v209 offset:21000
  s_waitcnt vmcnt(36) lgkmcnt(0)
  s_add_u32 m0, s61, 20480
  s_add_u32 s54, s62, 1105920
  buffer_load_dwordx4 v207, s[28:31], s54 offen lds
  s_add_u32 m0, s61, 21504
  s_add_u32 s54, s62, 1124352
  buffer_load_dwordx4 v207, s[28:31], s54 offen lds
  ds_read_b64_tr_b16 a[88:89], v209 offset:22528
  ds_read_b64_tr_b16 a[90:91], v209 offset:23040
  ds_read_b64_tr_b16 a[92:93], v209 offset:22536
  ds_read_b64_tr_b16 a[94:95], v209 offset:23048
  s_waitcnt vmcnt(36) lgkmcnt(0)
  s_add_u32 m0, s61, 22528
  s_add_u32 s54, s62, 1142784
  buffer_load_dwordx4 v207, s[28:31], s54 offen lds
  s_add_u32 m0, s61, 23552
  s_add_u32 s54, s62, 1161216
  buffer_load_dwordx4 v207, s[28:31], s54 offen lds
  ds_read_b64_tr_b16 a[96:97], v209 offset:24576
  ds_read_b64_tr_b16 a[98:99], v209 offset:25088
  ds_read_b64_tr_b16 a[100:101], v209 offset:24584
  ds_read_b64_tr_b16 a[102:103], v209 offset:25096
  s_waitcnt vmcnt(36) lgkmcnt(0)
  s_add_u32 m0, s61, 24576
  s_add_u32 s54, s63, 0
  buffer_load_dwordx4 v207, s[40:43], s54 offen lds
  s_add_u32 m0, s61, 25600
  s_add_u32 s54, s63, 18432
  buffer_load_dwordx4 v207, s[40:43], s54 offen lds
  ds_read_b64_tr_b16 a[104:105], v209 offset:26624
  ds_read_b64_tr_b16 a[106:107], v209 offset:27136
  ds_read_b64_tr_b16 a[108:109], v209 offset:26632
  ds_read_b64_tr_b16 a[110:111], v209 offset:27144
  s_waitcnt vmcnt(36) lgkmcnt(0)
  s_add_u32 m0, s61, 26624
  s_add_u32 s54, s63, 36864
  buffer_load_dwordx4 v207, s[40:43], s54 offen lds
  s_add_u32 m0, s61, 27648
  s_add_u32 s54, s63, 55296
  buffer_load_dwordx4 v207, s[40:43], s54 offen lds
  ds_read_b64_tr_b16 a[112:113], v209 offset:28672
  ds_read_b64_tr_b16 a[114:115], v209 offset:29184
  ds_read_b64_tr_b16 a[116:117], v209 offset:28680
  ds_read_b64_tr_b16 a[118:119], v209 offset:29192
  s_waitcnt vmcnt(36) lgkmcnt(0)
  s_add_u32 m0, s61, 28672
  s_add_u32 s54, s63, 73728
  buffer_load_dwordx4 v207, s[40:43], s54 offen lds
  s_add_u32 m0, s61, 29696
  s_add_u32 s54, s63, 92160
  buffer_load_dwordx4 v207, s[40:43], s54 offen lds
  ds_read_b64_tr_b16 a[120:121], v209 offset:30720
  ds_read_b64_tr_b16 a[122:123], v209 offset:31232
  ds_read_b64_tr_b16 a[124:125], v209 offset:30728
  ds_read_b64_tr_b16 a[126:127], v209 offset:31240
  s_waitcnt vmcnt(36) lgkmcnt(0)
  s_add_u32 m0, s61, 30720
  s_add_u32 s54, s63, 110592
  buffer_load_dwordx4 v207, s[40:43], s54 offen lds
  s_add_u32 m0, s61, 31744
  s_add_u32 s54, s63, 129024
  buffer_load_dwordx4 v207, s[40:43], s54 offen lds
  ds_read_b64_tr_b16 a[128:129], v209 offset:32768
  ds_read_b64_tr_b16 a[130:131], v209 offset:33280
  ds_read_b64_tr_b16 a[132:133], v209 offset:32776
  ds_read_b64_tr_b16 a[134:135], v209 offset:33288
  s_waitcnt vmcnt(36) lgkmcnt(0)
  s_add_u32 m0, s61, 32768
  s_add_u32 s54, s63, 147456
  buffer_load_dwordx4 v207, s[40:43], s54 offen lds
  s_add_u32 m0, s61, 33792
  s_add_u32 s54, s63, 165888
  buffer_load_dwordx4 v207, s[40:43], s54 offen lds
  ds_read_b64_tr_b16 a[136:137], v209 offset:34816
  ds_read_b64_tr_b16 a[138:139], v209 offset:35328
  ds_read_b64_tr_b16 a[140:141], v209 offset:34824
  ds_read_b64_tr_b16 a[142:143], v209 offset:35336
  s_waitcnt vmcnt(36) lgkmcnt(0)
  ds_read_b64_tr_b16 a[144:145], v209 offset:36864
  ds_read_b64_tr_b16 a[146:147], v209 offset:37376
  ds_read_b64_tr_b16 a[148:149], v209 offset:36872
  ds_read_b64_tr_b16 a[150:151], v209 offset:37384
  s_waitcnt vmcnt(34) lgkmcnt(0)
  ds_read_b64_tr_b16 a[152:153], v209 offset:38912
  ds_read_b64_tr_b16 a[154:155], v209 offset:39424
  ds_read_b64_tr_b16 a[156:157], v209 offset:38920
  ds_read_b64_tr_b16 a[158:159], v209 offset:39432
  s_waitcnt vmcnt(32) lgkmcnt(0)
  ds_read_b64_tr_b16 a[160:161], v209 offset:0
  ds_read_b64_tr_b16 a[162:163], v209 offset:512
  ds_read_b64_tr_b16 a[164:165], v209 offset:8
  ds_read_b64_tr_b16 a[166:167], v209 offset:520
  s_waitcnt vmcnt(30) lgkmcnt(0)
  ds_read_b64_tr_b16 a[168:169], v209 offset:2048
  ds_read_b64_tr_b16 a[170:171], v209 offset:2560
  ds_read_b64_tr_b16 a[172:173], v209 offset:2056
  ds_read_b64_tr_b16 a[174:175], v209 offset:2568
  s_waitcnt vmcnt(28) lgkmcnt(0)
  ds_read_b64_tr_b16 a[176:177], v209 offset:4096
  ds_read_b64_tr_b16 a[178:179], v209 offset:4608
  ds_read_b64_tr_b16 a[180:181], v209 offset:4104
  ds_read_b64_tr_b16 a[182:183], v209 offset:4616
  s_waitcnt vmcnt(26) lgkmcnt(0)
  ds_read_b64_tr_b16 a[184:185], v209 offset:6144
  ds_read_b64_tr_b16 a[186:187], v209 offset:6656
  ds_read_b64_tr_b16 a[188:189], v209 offset:6152
  ds_read_b64_tr_b16 a[190:191], v209 offset:6664
  s_waitcnt vmcnt(24) lgkmcnt(0)
  ds_read_b64_tr_b16 a[192:193], v209 offset:8192
  ds_read_b64_tr_b16 a[194:195], v209 offset:8704
  ds_read_b64_tr_b16 a[196:197], v209 offset:8200
  ds_read_b64_tr_b16 a[198:199], v209 offset:8712
  s_waitcnt vmcnt(22) lgkmcnt(0)
  ds_read_b64_tr_b16 a[200:201], v209 offset:10240
  ds_read_b64_tr_b16 a[202:203], v209 offset:10752
  ds_read_b64_tr_b16 a[204:205], v209 offset:10248
  ds_read_b64_tr_b16 a[206:207], v209 offset:10760
  s_waitcnt vmcnt(20) lgkmcnt(0)
  ds_read_b64_tr_b16 a[208:209], v209 offset:12288
  ds_read_b64_tr_b16 a[210:211], v209 offset:12800
  ds_read_b64_tr_b16 a[212:213], v209 offset:12296
  ds_read_b64_tr_b16 a[214:215], v209 offset:12808
  s_waitcnt vmcnt(18) lgkmcnt(0)
  ds_read_b64_tr_b16 a[216:217], v209 offset:14336
  ds_read_b64_tr_b16 a[218:219], v209 offset:14848
  ds_read_b64_tr_b16 a[220:221], v209 offset:14344
  ds_read_b64_tr_b16 a[222:223], v209 offset:14856
  s_waitcnt vmcnt(16) lgkmcnt(0)
  ds_read_b64_tr_b16 a[224:225], v209 offset:16384
  ds_read_b64_tr_b16 a[226:227], v209 offset:16896
  ds_read_b64_tr_b16 a[228:229], v209 offset:16392
  ds_read_b64_tr_b16 a[230:231], v209 offset:16904
  s_waitcnt vmcnt(14) lgkmcnt(0)
  ds_read_b64_tr_b16 a[232:233], v209 offset:18432
  ds_read_b64_tr_b16 a[234:235], v209 offset:18944
  ds_read_b64_tr_b16 a[236:237], v209 offset:18440
  ds_read_b64_tr_b16 a[238:239], v209 offset:18952
  s_waitcnt vmcnt(12) lgkmcnt(0)
  ds_read_b64_tr_b16 a[240:241], v209 offset:20480
  ds_read_b64_tr_b16 a[242:243], v209 offset:20992
  ds_read_b64_tr_b16 a[244:245], v209 offset:20488
  ds_read_b64_tr_b16 a[246:247], v209 offset:21000
  s_waitcnt vmcnt(10) lgkmcnt(0)
  ds_read_b64_tr_b16 a[248:249], v209 offset:22528
  ds_read_b64_tr_b16 a[250:251], v209 offset:23040
  ds_read_b64_tr_b16 a[252:253], v209 offset:22536
  ds_read_b64_tr_b16 a[254:255], v209 offset:23048
  s_waitcnt vmcnt(8) lgkmcnt(0)
  ds_read_b64_tr_b16 v[216:217], v210 offset:24576
  ds_read_b64_tr_b16 v[218:219], v210 offset:24832
  ds_read_b64_tr_b16 v[220:221], v210 offset:24584
  ds_read_b64_tr_b16 v[222:223], v210 offset:24840
  s_waitcnt vmcnt(6) lgkmcnt(0)
  ds_read_b64_tr_b16 v[224:225], v210 offset:26624
  ds_read_b64_tr_b16 v[226:227], v210 offset:26880
  ds_read_b64_tr_b16 v[228:229], v210 offset:26632
  ds_read_b64_tr_b16 v[230:231], v210 offset:26888
  s_waitcnt vmcnt(4) lgkmcnt(0)
  ds_read_b64_tr_b16 v[232:233], v210 offset:28672
  ds_read_b64_tr_b16 v[234:235], v210 offset:28928
  ds_read_b64_tr_b16 v[236:237], v210 offset:28680
  ds_read_b64_tr_b16 v[238:239], v210 offset:28936
  s_waitcnt vmcnt(2) lgkmcnt(0)
  ds_read_b64_tr_b16 v[240:241], v210 offset:30720
  ds_read_b64_tr_b16 v[242:243], v210 offset:30976
  ds_read_b64_tr_b16 v[244:245], v210 offset:30728
  ds_read_b64_tr_b16 v[246:247], v210 offset:30984
  s_waitcnt vmcnt(0) lgkmcnt(0)
  ds_read_b64_tr_b16 v[248:249], v210 offset:32768
  ds_read_b64_tr_b16 v[250:251], v210 offset:33024
  ds_read_b64_tr_b16 v[252:253], v210 offset:32776
  ds_read_b64_tr_b16 v[254:255], v210 offset:33032
  v_and_b32 v211, 15, v200
  s_lshl_b32 s54, s69, 4
  v_add_u32 v211, s54, v211
  v_lshl_add_u32 v212, v214, 5, v211
  v_lshlrev_b32 v164, 4, v212
  v_lshrrev_b32 v212, 5, v200
  v_lshl_add_u32 v164, v212, 10, v164
  v_mul_u32_u24 v167, 1152, v211
  v_lshl_add_u32 v167, v213, 4, v167
  v_lshlrev_b32 v166, 2, v211
  v_lshlrev_b32 v208, 2, v200
  s_lshl_b32 s54, s52, 11
  v_add_u32 v168, s54, v201
  s_mov_b32 s59, s68
  s_mov_b32 s56, 128
  s_mov_b32 s57, 36
  s_waitcnt lgkmcnt(0)
  s_cmp_eq_u32 s52, 0
  s_cbranch_scc0 O_p1_d
  s_mov_b32 exec_hi, 0
  s_mov_b32 exec_lo, -1
O_p1:
  buffer_load_dword v211, v208, s[12:15], s56 offen sc1
  s_add_u32 s65, s65, 1
  s_waitcnt vmcnt(0)
  v_cmp_gt_u32 vcc, 0x700, v211
  s_cbranch_vccz O_p1_x
  s_sleep 16
  s_cmp_lt_u32 s65, 131072
  s_cbranch_scc1 O_p1
O_p1_x:
  s_mov_b64 exec, -1
O_p1_d:
  s_barrier
  s_cmp_eq_u32 s52, 0
  s_cbranch_scc0 O_a_d
  s_mov_b32 exec_hi, 0
  s_mov_b32 exec_lo, 1
O_a:
  buffer_load_dword v211, v208, s[12:15], s57 offen sc1
  s_add_u32 s65, s65, 1
  s_waitcnt vmcnt(0)
  v_cmp_gt_u32 vcc, 0x80, v211
  s_cbranch_vccz O_a_x
  s_sleep 16
  s_cmp_lt_u32 s65, 131072
  s_cbranch_scc1 O_a
O_a_x:
  s_mov_b64 exec, -1
O_a_d:
  s_barrier
  s_cmp_ge_u32 s70, 9
  s_cselect_b32 s54, 9, 0
  s_sub_u32 s54, s70, s54
  s_and_b32 s54, s54, 7
  s_lshl_b32 s54, s54, 13
  s_lshl_b32 s55, s69, 8
  s_add_u32 s54, s54, s55
  v_lshrrev_b32 v211, 2, v200
  v_lshl_add_u32 v172, v211, 9, s54
  v_and_b32 v211, 3, v200
  v_lshl_add_u32 v172, v211, 6, v172
  s_mul_i32 s55, s59, 36864
  s_mul_i32 s54, s52, 320
  s_add_u32 s55, s55, s54
  s_add_u32 s55, s55, 62914560
  s_cmp_eq_u32 s52, 3
  s_cselect_b32 s56, 268435456, s55
  buffer_load_dwordx4 v[128:131], v167, s[8:11], s55 offen offset:0 sc1
  buffer_load_dwordx4 v[132:135], v167, s[8:11], s55 offen offset:64 sc1
  buffer_load_dwordx4 v[136:139], v167, s[8:11], s55 offen offset:128 sc1
  buffer_load_dwordx4 v[140:143], v167, s[8:11], s56 offen offset:192 sc1
  buffer_load_dwordx4 v[144:147], v167, s[8:11], s56 offen offset:256 sc1
  s_lshl_b32 s55, s59, 7
  s_add_u32 s55, s55, 66060288
  buffer_load_dword v171, v166, s[8:11], s55 offen sc1
  v_mov_b32 v169, 0
  s_mov_b32 s66, 356352
  s_waitcnt vmcnt(0)
O_loop:
  v_mfma_f32_16x16x32_bf16 v[156:159], v[216:219], v[128:131], 0
  v_mfma_f32_16x16x32_bf16 v[160:163], v[220:223], v[128:131], 0
  v_mfma_f32_16x16x32_bf16 v[156:159], v[224:227], v[132:135], v[156:159]
  v_mfma_f32_16x16x32_bf16 v[160:163], v[228:231], v[132:135], v[160:163]
  v_mfma_f32_16x16x32_bf16 v[156:159], v[232:235], v[136:139], v[156:159]
  v_mfma_f32_16x16x32_bf16 v[160:163], v[236:239], v[136:139], v[160:163]
  v_mfma_f32_16x16x32_bf16 v[156:159], v[240:243], v[140:143], v[156:159]
  v_mfma_f32_16x16x32_bf16 v[160:163], v[244:247], v[140:143], v[160:163]
  v_mfma_f32_16x16x32_bf16 v[156:159], v[248:251], v[144:147], v[156:159]
  v_mfma_f32_16x16x32_bf16 v[160:163], v[252:255], v[144:147], v[160:163]
  s_mul_i32 s64, s59, 36864
  s_lshl_b32 s54, s70, 6
  s_add_u32 s64, s64, s54
  s_add_u32 s71, s59, 2
  s_lshl_b32 s55, s59, 18
  s_lshl_b32 s54, s52, 16
  s_add_u32 s55, s55, s54
  s_add_u32 s63, s55, 46137344
  s_and_b32 s54, s59, 1
  s_lshl_b32 s54, s54, 2
  s_add_u32 s54, s54, s52
  s_lshl_b32 s54, s54, 3
  s_lshl_b64 s[72:73], 0xff, s54
  v_sub_f32 v165, 1.0, v171
  v_cvt_pk_bf16_f32 v165, v165, v165
  v_lshlrev_b32 v165, 16, v165
  v_mul_f32 v156, v171, v156
  v_mul_f32 v157, v171, v157
  v_mul_f32 v158, v171, v158
  v_mul_f32 v159, v171, v159
  v_mul_f32 v160, v171, v160
  v_mul_f32 v161, v171, v161
  v_mul_f32 v162, v171, v162
  v_mul_f32 v163, v171, v163
  s_branch O_pc
O_pl:
  s_sleep 1
  buffer_load_dword v169, v208, s[8:11], s66 offen sc1
  s_add_u32 s65, s65, 1
  s_cmp_ge_u32 s65, 131072
  s_cbranch_scc1 O_ld
  s_waitcnt vmcnt(0)
O_pc:
  v_cmp_gt_u32 vcc, s71, v169
  s_nop 0
  s_and_b64 vcc, vcc, s[72:73]
  s_cbranch_scc1 O_pl
O_ld:
  s_mov_b32 s62, s63
  buffer_load_dword v173, v172, s[8:11], s63 offen sc1
  buffer_load_dwordx4 v[0:3], v164, s[8:11], s62 offen offset:0 sc1
  buffer_load_dwordx4 v[4:7], v164, s[8:11], s62 offen offset:2048 sc1
  s_add_u32 s62, s62, 4096
  buffer_load_dwordx4 v[8:11], v164, s[8:11], s62 offen offset:0 sc1
  buffer_load_dwordx4 v[12:15], v164, s[8:11], s62 offen offset:2048 sc1
  s_add_u32 s62, s62, 4096
  buffer_load_dwordx4 v[16:19], v164, s[8:11], s62 offen offset:0 sc1
  buffer_load_dwordx4 v[20:23], v164, s[8:11], s62 offen offset:2048 sc1
  s_add_u32 s62, s62, 4096
  buffer_load_dwordx4 v[24:27], v164, s[8:11], s62 offen offset:0 sc1
  buffer_load_dwordx4 v[28:31], v164, s[8:11], s62 offen offset:2048 sc1
  s_add_u32 s62, s62, 4096
  buffer_load_dwordx4 v[32:35], v164, s[8:11], s62 offen offset:0 sc1
  buffer_load_dwordx4 v[36:39], v164, s[8:11], s62 offen offset:2048 sc1
  s_add_u32 s62, s62, 4096
  buffer_load_dwordx4 v[40:43], v164, s[8:11], s62 offen offset:0 sc1
  buffer_load_dwordx4 v[44:47], v164, s[8:11], s62 offen offset:2048 sc1
  s_add_u32 s62, s62, 4096
  buffer_load_dwordx4 v[48:51], v164, s[8:11], s62 offen offset:0 sc1
  buffer_load_dwordx4 v[52:55], v164, s[8:11], s62 offen offset:2048 sc1
  s_add_u32 s62, s62, 4096
  buffer_load_dwordx4 v[56:59], v164, s[8:11], s62 offen offset:0 sc1
  buffer_load_dwordx4 v[60:63], v164, s[8:11], s62 offen offset:2048 sc1
  s_add_u32 s62, s62, 4096
  buffer_load_dwordx4 v[64:67], v164, s[8:11], s62 offen offset:0 sc1
  buffer_load_dwordx4 v[68:71], v164, s[8:11], s62 offen offset:2048 sc1
  s_add_u32 s62, s62, 4096
  buffer_load_dwordx4 v[72:75], v164, s[8:11], s62 offen offset:0 sc1
  buffer_load_dwordx4 v[76:79], v164, s[8:11], s62 offen offset:2048 sc1
  s_add_u32 s62, s62, 4096
  buffer_load_dwordx4 v[80:83], v164, s[8:11], s62 offen offset:0 sc1
  buffer_load_dwordx4 v[84:87], v164, s[8:11], s62 offen offset:2048 sc1
  s_add_u32 s62, s62, 4096
  buffer_load_dwordx4 v[88:91], v164, s[8:11], s62 offen offset:0 sc1
  buffer_load_dwordx4 v[92:95], v164, s[8:11], s62 offen offset:2048 sc1
  s_add_u32 s62, s62, 4096
  buffer_load_dwordx4 v[96:99], v164, s[8:11], s62 offen offset:0 sc1
  buffer_load_dwordx4 v[100:103], v164, s[8:11], s62 offen offset:2048 sc1
  s_add_u32 s62, s62, 4096
  buffer_load_dwordx4 v[104:107], v164, s[8:11], s62 offen offset:0 sc1
  buffer_load_dwordx4 v[108:111], v164, s[8:11], s62 offen offset:2048 sc1
  s_add_u32 s62, s62, 4096
  buffer_load_dwordx4 v[112:115], v164, s[8:11], s62 offen offset:0 sc1
  buffer_load_dwordx4 v[116:119], v164, s[8:11], s62 offen offset:2048 sc1
  s_add_u32 s62, s62, 4096
  buffer_load_dwordx4 v[120:123], v164, s[8:11], s62 offen offset:0 sc1
  buffer_load_dwordx4 v[124:127], v164, s[8:11], s62 offen offset:2048 sc1
  s_add_u32 s62, s62, 4096
  s_add_u32 s57, s59, 3
  s_min_u32 s74, s57, 63
  s_mul_i32 s55, s74, 36864
  s_mul_i32 s54, s52, 320
  s_add_u32 s55, s55, s54
  s_add_u32 s55, s55, 62914560
  s_cmp_eq_u32 s52, 3
  s_cselect_b32 s56, 268435456, s55
  buffer_load_dwordx4 v[128:131], v167, s[8:11], s55 offen offset:0 sc1
  buffer_load_dwordx4 v[132:135], v167, s[8:11], s55 offen offset:64 sc1
  buffer_load_dwordx4 v[136:139], v167, s[8:11], s55 offen offset:128 sc1
  buffer_load_dwordx4 v[140:143], v167, s[8:11], s56 offen offset:192 sc1
  buffer_load_dwordx4 v[144:147], v167, s[8:11], s56 offen offset:256 sc1
  s_lshl_b32 s55, s74, 7
  s_add_u32 s55, s55, 66060288
  buffer_load_dword v171, v166, s[8:11], s55 offen sc1
  s_add_u32 s65, s65, 1
  s_cmp_lt_u32 s65, 131072
  s_cselect_b32 s54, -2, -1
  s_waitcnt vmcnt(37)
  v_mfma_f32_16x16x32_bf16 v[148:151], a[0:3], v[0:3], 0
  v_mfma_f32_16x16x32_bf16 v[152:155], a[4:7], v[0:3], 0
  v_max3_u32 v170, v0, v1, v0
  v_max3_u32 v170, v2, v3, v170
  s_waitcnt vmcnt(36)
  v_mfma_f32_16x16x32_bf16 v[148:151], a[8:11], v[4:7], v[148:151]
  v_mfma_f32_16x16x32_bf16 v[152:155], a[12:15], v[4:7], v[152:155]
  v_max3_u32 v170, v4, v5, v170
  v_max3_u32 v170, v6, v7, v170
  s_waitcnt vmcnt(35)
  v_mfma_f32_16x16x32_bf16 v[148:151], a[16:19], v[8:11], v[148:151]
  v_mfma_f32_16x16x32_bf16 v[152:155], a[20:23], v[8:11], v[152:155]
  v_max3_u32 v170, v8, v9, v170
  v_max3_u32 v170, v10, v11, v170
  s_waitcnt vmcnt(34)
  v_mfma_f32_16x16x32_bf16 v[148:151], a[24:27], v[12:15], v[148:151]
  v_mfma_f32_16x16x32_bf16 v[152:155], a[28:31], v[12:15], v[152:155]
  v_max3_u32 v170, v12, v13, v170
  v_max3_u32 v170, v14, v15, v170
  s_waitcnt vmcnt(33)
  v_mfma_f32_16x16x32_bf16 v[148:151], a[32:35], v[16:19], v[148:151]
  v_mfma_f32_16x16x32_bf16 v[152:155], a[36:39], v[16:19], v[152:155]
  v_max3_u32 v170, v16, v17, v170
  v_max3_u32 v170, v18, v19, v170
  s_waitcnt vmcnt(32)
  v_mfma_f32_16x16x32_bf16 v[148:151], a[40:43], v[20:23], v[148:151]
  v_mfma_f32_16x16x32_bf16 v[152:155], a[44:47], v[20:23], v[152:155]
  v_max3_u32 v170, v20, v21, v170
  v_max3_u32 v170, v22, v23, v170
  s_waitcnt vmcnt(31)
  v_mfma_f32_16x16x32_bf16 v[148:151], a[48:51], v[24:27], v[148:151]
  v_mfma_f32_16x16x32_bf16 v[152:155], a[52:55], v[24:27], v[152:155]
  v_max3_u32 v170, v24, v25, v170
  v_max3_u32 v170, v26, v27, v170
  s_waitcnt vmcnt(30)
  v_mfma_f32_16x16x32_bf16 v[148:151], a[56:59], v[28:31], v[148:151]
  v_mfma_f32_16x16x32_bf16 v[152:155], a[60:63], v[28:31], v[152:155]
  v_max3_u32 v170, v28, v29, v170
  v_max3_u32 v170, v30, v31, v170
  s_waitcnt vmcnt(29)
  v_mfma_f32_16x16x32_bf16 v[148:151], a[64:67], v[32:35], v[148:151]
  v_mfma_f32_16x16x32_bf16 v[152:155], a[68:71], v[32:35], v[152:155]
  v_max3_u32 v170, v32, v33, v170
  v_max3_u32 v170, v34, v35, v170
  s_waitcnt vmcnt(28)
  v_mfma_f32_16x16x32_bf16 v[148:151], a[72:75], v[36:39], v[148:151]
  v_mfma_f32_16x16x32_bf16 v[152:155], a[76:79], v[36:39], v[152:155]
  v_max3_u32 v170, v36, v37, v170
  v_max3_u32 v170, v38, v39, v170
  s_waitcnt vmcnt(27)
  v_mfma_f32_16x16x32_bf16 v[148:151], a[80:83], v[40:43], v[148:151]
  v_mfma_f32_16x16x32_bf16 v[152:155], a[84:87], v[40:43], v[152:155]
  v_max3_u32 v170, v40, v41, v170
  v_max3_u32 v170, v42, v43, v170
  s_waitcnt vmcnt(26)
  v_mfma_f32_16x16x32_bf16 v[148:151], a[88:91], v[44:47], v[148:151]
  v_mfma_f32_16x16x32_bf16 v[152:155], a[92:95], v[44:47], v[152:155]
  v_max3_u32 v170, v44, v45, v170
  v_max3_u32 v170, v46, v47, v170
  s_waitcnt vmcnt(25)
  v_mfma_f32_16x16x32_bf16 v[148:151], a[96:99], v[48:51], v[148:151]
  v_mfma_f32_16x16x32_bf16 v[152:155], a[100:103], v[48:51], v[152:155]
  v_max3_u32 v170, v48, v49, v170
  v_max3_u32 v170, v50, v51, v170
  s_waitcnt vmcnt(24)
  v_mfma_f32_16x16x32_bf16 v[148:151], a[104:107], v[52:55], v[148:151]
  v_mfma_f32_16x16x32_bf16 v[152:155], a[108:111], v[52:55], v[152:155]
  v_max3_u32 v170, v52, v53, v170
  v_max3_u32 v170, v54, v55, v170
  s_waitcnt vmcnt(23)
  v_mfma_f32_16x16x32_bf16 v[148:151], a[112:115], v[56:59], v[148:151]
  v_mfma_f32_16x16x32_bf16 v[152:155], a[116:119], v[56:59], v[152:155]
  v_max3_u32 v170, v56, v57, v170
  v_max3_u32 v170, v58, v59, v170
  s_waitcnt vmcnt(22)
  v_mfma_f32_16x16x32_bf16 v[148:151], a[120:123], v[60:63], v[148:151]
  v_mfma_f32_16x16x32_bf16 v[152:155], a[124:127], v[60:63], v[152:155]
  v_max3_u32 v170, v60, v61, v170
  v_max3_u32 v170, v62, v63, v170
  s_waitcnt vmcnt(21)
  v_mfma_f32_16x16x32_bf16 v[148:151], a[128:131], v[64:67], v[148:151]
  v_mfma_f32_16x16x32_bf16 v[152:155], a[132:135], v[64:67], v[152:155]
  v_max3_u32 v170, v64, v65, v170
  v_max3_u32 v170, v66, v67, v170
  s_waitcnt vmcnt(20)
  v_mfma_f32_16x16x32_bf16 v[148:151], a[136:139], v[68:71], v[148:151]
  v_mfma_f32_16x16x32_bf16 v[152:155], a[140:143], v[68:71], v[152:155]
  v_max3_u32 v170, v68, v69, v170
  v_max3_u32 v170, v70, v71, v170
  s_waitcnt vmcnt(19)
  v_mfma_f32_16x16x32_bf16 v[148:151], a[144:147], v[72:75], v[148:151]
  v_mfma_f32_16x16x32_bf16 v[152:155], a[148:151], v[72:75], v[152:155]
  v_max3_u32 v170, v72, v73, v170
  v_max3_u32 v170, v74, v75, v170
  s_waitcnt vmcnt(18)
  v_mfma_f32_16x16x32_bf16 v[148:151], a[152:155], v[76:79], v[148:151]
  v_mfma_f32_16x16x32_bf16 v[152:155], a[156:159], v[76:79], v[152:155]
  v_max3_u32 v170, v76, v77, v170
  v_max3_u32 v170, v78, v79, v170
  s_waitcnt vmcnt(17)
  v_mfma_f32_16x16x32_bf16 v[148:151], a[160:163], v[80:83], v[148:151]
  v_mfma_f32_16x16x32_bf16 v[152:155], a[164:167], v[80:83], v[152:155]
  v_max3_u32 v170, v80, v81, v170
  v_max3_u32 v170, v82, v83, v170
  s_waitcnt vmcnt(16)
  v_mfma_f32_16x16x32_bf16 v[148:151], a[168:171], v[84:87], v[148:151]
  v_mfma_f32_16x16x32_bf16 v[152:155], a[172:175], v[84:87], v[152:155]
  v_max3_u32 v170, v84, v85, v170
  v_max3_u32 v170, v86, v87, v170
  s_waitcnt vmcnt(15)
  v_mfma_f32_16x16x32_bf16 v[148:151], a[176:179], v[88:91], v[148:151]
  v_mfma_f32_16x16x32_bf16 v[152:155], a[180:183], v[88:91], v[152:155]
  v_max3_u32 v170, v88, v89, v170
  v_max3_u32 v170, v90, v91, v170
  s_waitcnt vmcnt(14)
  v_mfma_f32_16x16x32_bf16 v[148:151], a[184:187], v[92:95], v[148:151]
  v_mfma_f32_16x16x32_bf16 v[152:155], a[188:191], v[92:95], v[152:155]
  v_max3_u32 v170, v92, v93, v170
  v_max3_u32 v170, v94, v95, v170
  s_waitcnt vmcnt(13)
  v_mfma_f32_16x16x32_bf16 v[148:151], a[192:195], v[96:99], v[148:151]
  v_mfma_f32_16x16x32_bf16 v[152:155], a[196:199], v[96:99], v[152:155]
  v_max3_u32 v170, v96, v97, v170
  v_max3_u32 v170, v98, v99, v170
  s_waitcnt vmcnt(12)
  v_mfma_f32_16x16x32_bf16 v[148:151], a[200:203], v[100:103], v[148:151]
  v_mfma_f32_16x16x32_bf16 v[152:155], a[204:207], v[100:103], v[152:155]
  v_max3_u32 v170, v100, v101, v170
  v_max3_u32 v170, v102, v103, v170
  s_waitcnt vmcnt(11)
  v_mfma_f32_16x16x32_bf16 v[148:151], a[208:211], v[104:107], v[148:151]
  v_mfma_f32_16x16x32_bf16 v[152:155], a[212:215], v[104:107], v[152:155]
  v_max3_u32 v170, v104, v105, v170
  v_max3_u32 v170, v106, v107, v170
  s_waitcnt vmcnt(10)
  v_mfma_f32_16x16x32_bf16 v[148:151], a[216:219], v[108:111], v[148:151]
  v_mfma_f32_16x16x32_bf16 v[152:155], a[220:223], v[108:111], v[152:155]
  v_max3_u32 v170, v108, v109, v170
  v_max3_u32 v170, v110, v111, v170
  s_waitcnt vmcnt(9)
  v_mfma_f32_16x16x32_bf16 v[148:151], a[224:227], v[112:115], v[148:151]
  v_mfma_f32_16x16x32_bf16 v[152:155], a[228:231], v[112:115], v[152:155]
  v_max3_u32 v170, v112, v113, v170
  v_max3_u32 v170, v114, v115, v170
  s_waitcnt vmcnt(8)
  v_mfma_f32_16x16x32_bf16 v[148:151], a[232:235], v[116:119], v[148:151]
  v_mfma_f32_16x16x32_bf16 v[152:155], a[236:239], v[116:119], v[152:155]
  v_max3_u32 v170, v116, v117, v170
  v_max3_u32 v170, v118, v119, v170
  s_waitcnt vmcnt(7)
  v_mfma_f32_16x16x32_bf16 v[148:151], a[240:243], v[120:123], v[148:151]
  v_mfma_f32_16x16x32_bf16 v[152:155], a[244:247], v[120:123], v[152:155]
  v_max3_u32 v170, v120, v121, v170
  v_max3_u32 v170, v122, v123, v170
  s_waitcnt vmcnt(6)
  v_mfma_f32_16x16x32_bf16 v[148:151], a[248:251], v[124:127], v[148:151]
  v_mfma_f32_16x16x32_bf16 v[152:155], a[252:255], v[124:127], v[152:155]
  v_max3_u32 v170, v124, v125, v170
  v_max3_u32 v170, v126, v127, v170
  v_cmp_lt_u32 vcc, s54, v170
  s_cbranch_vccnz O_ld
  v_fmac_f32 v156, v165, v148
  v_fmac_f32 v157, v165, v149
  v_fmac_f32 v158, v165, v150
  v_fmac_f32 v159, v165, v151
  v_fmac_f32 v160, v165, v152
  v_fmac_f32 v161, v165, v153
  v_fmac_f32 v162, v165, v154
  v_fmac_f32 v163, v165, v155
  ds_write_b128 v168, v[156:159]
  ds_write_b128 v168, v[160:163] offset:1024
  v_xor_b32 v168, 0x2000, v168
  s_mov_b32 s59, s57
  s_waitcnt lgkmcnt(0)
  s_barrier
  s_cmp_eq_u32 s52, 0
  s_cbranch_scc0 O_next
  v_xor_b32 v211, 0x2000, v168
  ds_read_b128 v[0:3], v211 offset:2048
  ds_read_b128 v[4:7], v211 offset:3072
  ds_read_b128 v[8:11], v211 offset:4096
  ds_read_b128 v[12:15], v211 offset:5120
  ds_read_b128 v[16:19], v211 offset:6144
  ds_read_b128 v[20:23], v211 offset:7168
  s_waitcnt lgkmcnt(5)
  v_add_f32 v156, v156, v0
  v_add_f32 v157, v157, v1
  v_add_f32 v158, v158, v2
  v_add_f32 v159, v159, v3
  s_waitcnt lgkmcnt(4)
  v_add_f32 v160, v160, v4
  v_add_f32 v161, v161, v5
  v_add_f32 v162, v162, v6
  v_add_f32 v163, v163, v7
  s_waitcnt lgkmcnt(3)
  v_add_f32 v156, v156, v8
  v_add_f32 v157, v157, v9
  v_add_f32 v158, v158, v10
  v_add_f32 v159, v159, v11
  s_waitcnt lgkmcnt(2)
  v_add_f32 v160, v160, v12
  v_add_f32 v161, v161, v13
  v_add_f32 v162, v162, v14
  v_add_f32 v163, v163, v15
  s_waitcnt lgkmcnt(1)
  v_add_f32 v156, v156, v16
  v_add_f32 v157, v157, v17
  v_add_f32 v158, v158, v18
  v_add_f32 v159, v159, v19
  s_waitcnt lgkmcnt(0)
  v_add_f32 v160, v160, v20
  v_add_f32 v161, v161, v21
  v_add_f32 v162, v162, v22
  v_add_f32 v163, v163, v23
  v_cvt_pk_bf16_f32 v148, v156, v157
  v_cvt_pk_bf16_f32 v149, v158, v159
  v_cvt_pk_bf16_f32 v150, v160, v161
  v_cvt_pk_bf16_f32 v151, v162, v163
  buffer_store_dwordx4 v[148:151], v167, s[48:51], s64 offen
  s_waitcnt vmcnt(1)
  s_branch O_nx2
O_next:
  s_waitcnt vmcnt(0)
O_nx2:
  s_cmp_lt_u32 s59, 64
  s_cbranch_scc1 O_loop
  s_branch L_exit
W_h:
  s_lshr_b32 s58, s53, 1
  s_and_b32 s59, s53, 1
  s_mul_i32 s60, s59, 36864
  s_add_u32 m0, s67, 0
  s_nop 0
  buffer_load_dwordx4 v202, s[4:7], s60 offen offset:0 lds
  s_add_u32 m0, s67, 896
  s_nop 0
  buffer_load_dwordx4 v202, s[4:7], s60 offen offset:128 lds
  s_add_u32 m0, s67, 1792
  s_nop 0
  buffer_load_dwordx4 v202, s[4:7], s60 offen offset:256 lds
  s_add_u32 m0, s67, 2688
  s_nop 0
  buffer_load_dwordx4 v202, s[4:7], s60 offen offset:384 lds
  s_add_u32 m0, s67, 3584
  s_nop 0
  buffer_load_dwordx4 v202, s[4:7], s60 offen offset:512 lds
  s_add_u32 m0, s67, 4480
  s_nop 0
  buffer_load_dwordx4 v202, s[4:7], s60 offen offset:640 lds
  s_add_u32 m0, s67, 5376
  s_nop 0
  buffer_load_dwordx4 v202, s[4:7], s60 offen offset:768 lds
  s_add_u32 m0, s67, 6272
  s_nop 0
  buffer_load_dwordx4 v202, s[4:7], s60 offen offset:896 lds
  s_add_u32 m0, s67, 7168
  s_nop 0
  buffer_load_dwordx4 v202, s[4:7], s60 offen offset:1024 lds
  v_lshrrev_b32 v211, 4, v200
  v_lshlrev_b32 v212, 2, v211
  v_and_b32 v213, 15, v200
  v_xor_b32 v212, v212, v213
  v_lshlrev_b32 v212, 4, v212
  v_lshl_add_u32 v207, v211, 13, v212
  s_lshl_b32 s62, s58, 8
  s_lshl_b32 s54, s52, 15
  s_add_u32 s62, s62, s54
  s_lshl_b32 s61, s52, 10
  s_add_u32 s61, s61, 36864
  s_add_u32 m0, s61, 0
  s_add_u32 s54, s62, 0
  buffer_load_dwordx4 v207, s[16:19], s54 offen lds
  s_add_u32 m0, s61, 4096
  s_add_u32 s54, s62, 131072
  buffer_load_dwordx4 v207, s[16:19], s54 offen lds
  s_add_u32 m0, s61, 8192
  s_add_u32 s54, s62, 262144
  buffer_load_dwordx4 v207, s[16:19], s54 offen lds
  s_add_u32 m0, s61, 12288
  s_add_u32 s54, s62, 393216
  buffer_load_dwordx4 v207, s[16:19], s54 offen lds
  s_add_u32 m0, s61, 16384
  s_add_u32 s54, s62, 524288
  buffer_load_dwordx4 v207, s[16:19], s54 offen lds
  s_add_u32 m0, s61, 20480
  s_add_u32 s54, s62, 655360
  buffer_load_dwordx4 v207, s[16:19], s54 offen lds
  s_add_u32 m0, s61, 24576
  s_add_u32 s54, s62, 786432
  buffer_load_dwordx4 v207, s[16:19], s54 offen lds
  s_add_u32 m0, s61, 28672
  s_add_u32 s54, s62, 917504
  buffer_load_dwordx4 v207, s[16:19], s54 offen lds
  s_add_u32 m0, s61, 32768
  s_add_u32 s54, s62, 1048576
  buffer_load_dwordx4 v207, s[16:19], s54 offen lds
  s_add_u32 m0, s61, 36864
  s_add_u32 s54, s62, 1179648
  buffer_load_dwordx4 v207, s[16:19], s54 offen lds
  s_add_u32 m0, s61, 40960
  s_add_u32 s54, s62, 1310720
  buffer_load_dwordx4 v207, s[16:19], s54 offen lds
  s_add_u32 m0, s61, 45056
  s_add_u32 s54, s62, 1441792
  buffer_load_dwordx4 v207, s[16:19], s54 offen lds
  s_add_u32 m0, s61, 49152
  s_add_u32 s54, s62, 1572864
  buffer_load_dwordx4 v207, s[16:19], s54 offen lds
  s_add_u32 m0, s61, 53248
  s_add_u32 s54, s62, 1703936
  buffer_load_dwordx4 v207, s[16:19], s54 offen lds
  s_add_u32 m0, s61, 57344
  s_add_u32 s54, s62, 1835008
  buffer_load_dwordx4 v207, s[16:19], s54 offen lds
  s_add_u32 m0, s61, 61440
  s_add_u32 s54, s62, 1966080
  buffer_load_dwordx4 v207, s[16:19], s54 offen lds
  s_add_u32 m0, s61, 65536
  s_add_u32 s54, s62, 2097152
  buffer_load_dwordx4 v207, s[16:19], s54 offen lds
  s_add_u32 m0, s61, 69632
  s_add_u32 s54, s62, 2228224
  buffer_load_dwordx4 v207, s[16:19], s54 offen lds
  s_add_u32 m0, s61, 73728
  s_add_u32 s54, s62, 2359296
  buffer_load_dwordx4 v207, s[16:19], s54 offen lds
  s_add_u32 m0, s61, 77824
  s_add_u32 s54, s62, 2490368
  buffer_load_dwordx4 v207, s[16:19], s54 offen lds
  s_add_u32 m0, s61, 81920
  s_add_u32 s54, s62, 2621440
  buffer_load_dwordx4 v207, s[16:19], s54 offen lds
  s_add_u32 m0, s61, 86016
  s_add_u32 s54, s62, 2752512
  buffer_load_dwordx4 v207, s[16:19], s54 offen lds
  s_add_u32 m0, s61, 90112
  s_add_u32 s54, s62, 2883584
  buffer_load_dwordx4 v207, s[16:19], s54 offen lds
  s_add_u32 m0, s61, 94208
  s_add_u32 s54, s62, 3014656
  buffer_load_dwordx4 v207, s[16:19], s54 offen lds
  s_waitcnt vmcnt(20) lgkmcnt(0)
  s_barrier
  s_add_u32 m0, s61, 98304
  s_add_u32 s54, s62, 3145728
  buffer_load_dwordx4 v207, s[16:19], s54 offen lds
  s_add_u32 m0, s61, 102400
  s_add_u32 s54, s62, 3276800
  buffer_load_dwordx4 v207, s[16:19], s54 offen lds
  s_add_u32 m0, s61, 106496
  s_add_u32 s54, s62, 3407872
  buffer_load_dwordx4 v207, s[16:19], s54 offen lds
  s_add_u32 m0, s61, 110592
  s_add_u32 s54, s62, 3538944
  buffer_load_dwordx4 v207, s[16:19], s54 offen lds
  v_add_u32 v215, 36864, v209
  ds_read_b64_tr_b16 a[0:1], v215 offset:0
  ds_read_b64_tr_b16 a[2:3], v215 offset:1024
  ds_read_b64_tr_b16 a[4:5], v215 offset:4096
  ds_read_b64_tr_b16 a[6:7], v215 offset:5120
  ds_read_b64_tr_b16 a[8:9], v215 offset:8192
  ds_read_b64_tr_b16 a[10:11], v215 offset:9216
  ds_read_b64_tr_b16 a[12:13], v215 offset:12288
  ds_read_b64_tr_b16 a[14:15], v215 offset:13312
  s_waitcnt vmcnt(20) lgkmcnt(0)
  s_barrier
  s_add_u32 m0, s61, 0
  s_add_u32 s54, s62, 3670016
  buffer_load_dwordx4 v207, s[16:19], s54 offen lds
  s_add_u32 m0, s61, 4096
  s_add_u32 s54, s62, 3801088
  buffer_load_dwordx4 v207, s[16:19], s54 offen lds
  s_add_u32 m0, s61, 8192
  s_add_u32 s54, s62, 3932160
  buffer_load_dwordx4 v207, s[16:19], s54 offen lds
  s_add_u32 m0, s61, 12288
  s_add_u32 s54, s62, 4063232
  buffer_load_dwordx4 v207, s[16:19], s54 offen lds
  v_add_u32 v215, 53248, v209
  ds_read_b64_tr_b16 a[16:17], v215 offset:0
  ds_read_b64_tr_b16 a[18:19], v215 offset:1024
  ds_read_b64_tr_b16 a[20:21], v215 offset:4096
  ds_read_b64_tr_b16 a[22:23], v215 offset:5120
  ds_read_b64_tr_b16 a[24:25], v215 offset:8192
  ds_read_b64_tr_b16 a[26:27], v215 offset:9216
  ds_read_b64_tr_b16 a[28:29], v215 offset:12288
  ds_read_b64_tr_b16 a[30:31], v215 offset:13312
  s_waitcnt vmcnt(20) lgkmcnt(0)
  s_barrier
  s_add_u32 m0, s61, 16384
  s_add_u32 s54, s62, 4194304
  buffer_load_dwordx4 v207, s[16:19], s54 offen lds
  s_add_u32 m0, s61, 20480
  s_add_u32 s54, s62, 4325376
  buffer_load_dwordx4 v207, s[16:19], s54 offen lds
  s_add_u32 m0, s61, 24576
  s_add_u32 s54, s62, 4456448
  buffer_load_dwordx4 v207, s[16:19], s54 offen lds
  s_add_u32 m0, s61, 28672
  s_add_u32 s54, s62, 4587520
  buffer_load_dwordx4 v207, s[16:19], s54 offen lds
  v_add_u32 v215, 69632, v209
  ds_read_b64_tr_b16 a[32:33], v215 offset:0
  ds_read_b64_tr_b16 a[34:35], v215 offset:1024
  ds_read_b64_tr_b16 a[36:37], v215 offset:4096
  ds_read_b64_tr_b16 a[38:39], v215 offset:5120
  ds_read_b64_tr_b16 a[40:41], v215 offset:8192
  ds_read_b64_tr_b16 a[42:43], v215 offset:9216
  ds_read_b64_tr_b16 a[44:45], v215 offset:12288
  ds_read_b64_tr_b16 a[46:47], v215 offset:13312
  s_waitcnt vmcnt(20) lgkmcnt(0)
  s_barrier
  v_add_u32 v215, 86016, v209
  ds_read_b64_tr_b16 a[48:49], v215 offset:0
  ds_read_b64_tr_b16 a[50:51], v215 offset:1024
  ds_read_b64_tr_b16 a[52:53], v215 offset:4096
  ds_read_b64_tr_b16 a[54:55], v215 offset:5120
  ds_read_b64_tr_b16 a[56:57], v215 offset:8192
  ds_read_b64_tr_b16 a[58:59], v215 offset:9216
  ds_read_b64_tr_b16 a[60:61], v215 offset:12288
  ds_read_b64_tr_b16 a[62:63], v215 offset:13312
  s_waitcnt vmcnt(16) lgkmcnt(0)
  s_barrier
  v_add_u32 v215, 102400, v209
  ds_read_b64_tr_b16 a[64:65], v215 offset:0
  ds_read_b64_tr_b16 a[66:67], v215 offset:1024
  ds_read_b64_tr_b16 a[68:69], v215 offset:4096
  ds_read_b64_tr_b16 a[70:71], v215 offset:5120
  ds_read_b64_tr_b16 a[72:73], v215 offset:8192
  ds_read_b64_tr_b16 a[74:75], v215 offset:9216
  ds_read_b64_tr_b16 a[76:77], v215 offset:12288
  ds_read_b64_tr_b16 a[78:79], v215 offset:13312
  s_waitcnt vmcnt(12) lgkmcnt(0)
  s_barrier
  v_add_u32 v215, 118784, v209
  ds_read_b64_tr_b16 a[80:81], v215 offset:0
  ds_read_b64_tr_b16 a[82:83], v215 offset:1024
  ds_read_b64_tr_b16 a[84:85], v215 offset:4096
  ds_read_b64_tr_b16 a[86:87], v215 offset:5120
  ds_read_b64_tr_b16 a[88:89], v215 offset:8192
  ds_read_b64_tr_b16 a[90:91], v215 offset:9216
  ds_read_b64_tr_b16 a[92:93], v215 offset:12288
  ds_read_b64_tr_b16 a[94:95], v215 offset:13312
  s_waitcnt vmcnt(8) lgkmcnt(0)
  s_barrier
  v_add_u32 v215, 135168, v209
  ds_read_b64_tr_b16 a[96:97], v215 offset:0
  ds_read_b64_tr_b16 a[98:99], v215 offset:1024
  ds_read_b64_tr_b16 a[100:101], v215 offset:4096
  ds_read_b64_tr_b16 a[102:103], v215 offset:5120
  ds_read_b64_tr_b16 a[104:105], v215 offset:8192
  ds_read_b64_tr_b16 a[106:107], v215 offset:9216
  ds_read_b64_tr_b16 a[108:109], v215 offset:12288
  ds_read_b64_tr_b16 a[110:111], v215 offset:13312
  s_waitcnt vmcnt(4) lgkmcnt(0)
  s_barrier
  v_add_u32 v215, 36864, v209
  ds_read_b64_tr_b16 a[112:113], v215 offset:0
  ds_read_b64_tr_b16 a[114:115], v215 offset:1024
  ds_read_b64_tr_b16 a[116:117], v215 offset:4096
  ds_read_b64_tr_b16 a[118:119], v215 offset:5120
  ds_read_b64_tr_b16 a[120:121], v215 offset:8192
  ds_read_b64_tr_b16 a[122:123], v215 offset:9216
  ds_read_b64_tr_b16 a[124:125], v215 offset:12288
  ds_read_b64_tr_b16 a[126:127], v215 offset:13312
  s_waitcnt vmcnt(0) lgkmcnt(0)
  s_barrier
  v_add_u32 v215, 53248, v209
  ds_read_b64_tr_b16 a[128:129], v215 offset:0
  ds_read_b64_tr_b16 a[130:131], v215 offset:1024
  ds_read_b64_tr_b16 a[132:133], v215 offset:4096
  ds_read_b64_tr_b16 a[134:135], v215 offset:5120
  ds_read_b64_tr_b16 a[136:137], v215 offset:8192
  ds_read_b64_tr_b16 a[138:139], v215 offset:9216
  ds_read_b64_tr_b16 a[140:141], v215 offset:12288
  ds_read_b64_tr_b16 a[142:143], v215 offset:13312
  s_waitcnt lgkmcnt(0)
  s_barrier
  v_and_b32 v211, 31, v200
  v_lshrrev_b32 v212, 5, v200
  v_lshlrev_b32 v213, 2, v212
  v_sub_u32 v211, v211, v213
  v_mov_b32 v214, 0xf149f2ca
  v_cmp_gt_i32 vcc, 0, v211
  s_nop 1
  v_cndmask_b32 v48, 0, v214, vcc
  v_cmp_gt_i32 vcc, 1, v211
  s_nop 1
  v_cndmask_b32 v49, 0, v214, vcc
  v_cmp_gt_i32 vcc, 2, v211
  s_nop 1
  v_cndmask_b32 v50, 0, v214, vcc
  v_cmp_gt_i32 vcc, 3, v211
  s_nop 1
  v_cndmask_b32 v51, 0, v214, vcc
  v_cmp_gt_i32 vcc, 8, v211
  s_nop 1
  v_cndmask_b32 v52, 0, v214, vcc
  v_cmp_gt_i32 vcc, 9, v211
  s_nop 1
  v_cndmask_b32 v53, 0, v214, vcc
  v_cmp_gt_i32 vcc, 10, v211
  s_nop 1
  v_cndmask_b32 v54, 0, v214, vcc
  v_cmp_gt_i32 vcc, 11, v211
  s_nop 1
  v_cndmask_b32 v55, 0, v214, vcc
  v_cmp_gt_i32 vcc, 16, v211
  s_nop 1
  v_cndmask_b32 v56, 0, v214, vcc
  v_cmp_gt_i32 vcc, 17, v211
  s_nop 1
  v_cndmask_b32 v57, 0, v214, vcc
  v_cmp_gt_i32 vcc, 18, v211
  s_nop 1
  v_cndmask_b32 v58, 0, v214, vcc
  v_cmp_gt_i32 vcc, 19, v211
  s_nop 1
  v_cndmask_b32 v59, 0, v214, vcc
  v_cmp_gt_i32 vcc, 24, v211
  s_nop 1
  v_cndmask_b32 v60, 0, v214, vcc
  v_cmp_gt_i32 vcc, 25, v211
  s_nop 1
  v_cndmask_b32 v61, 0, v214, vcc
  v_cmp_gt_i32 vcc, 26, v211
  s_nop 1
  v_cndmask_b32 v62, 0, v214, vcc
  v_cmp_gt_i32 vcc, 27, v211
  s_nop 1
  v_cndmask_b32 v63, 0, v214, vcc
  v_and_b32 v218, 0xff, v216
  v_add_u32 v218, 81920, v218
  v_and_b32 v211, 15, v200
  v_lshl_add_u32 v211, v212, 5, v211
  v_lshlrev_b32 v219, 3, v211
  v_bfe_u32 v211, v200, 4, 1
  v_lshl_add_u32 v219, v211, 2, v219
  s_lshl_b32 s54, s52, 9
  s_add_u32 s54, s54, 83968
  v_add_u32 v219, s54, v219
  v_lshl_add_u32 v221, v200, 3, s54
  s_lshr_b32 s54, s52, 1
  s_lshl_b32 s54, s54, 10
  s_and_b32 s55, s52, 1
  s_lshl_b32 s55, s55, 3
  s_add_u32 s54, s54, s55
  s_add_u32 s54, s54, 81920
  v_add_u32 v220, s54, v201
  s_lshl_b32 s54, s52, 11
  s_add_u32 s54, s54, 73728
  v_add_u32 v215, s54, v201
  v_add_u32 v208, 73728, v201
  s_mov_b32 s68, 1040356334
  s_cmp_eq_u32 s52, 0
  s_cselect_b32 s71, s71, 268435456
  s_lshl_b32 s56, s58, 2
  s_add_u32 s56, s56, 128
  v_mov_b32 v176, -1
  v_mov_b32 v177, -1
  v_mov_b32 v178, -1
  v_mov_b32 v179, -1
  s_cmp_eq_u32 s52, 0
  s_cbranch_scc0 AT_p1_d
  s_mov_b32 exec_hi, 0
  s_mov_b32 exec_lo, 1
AT_p1:
  buffer_load_dword v211, v201, s[12:15], s56 offen sc1
  s_add_u32 s65, s65, 1
  s_waitcnt vmcnt(0)
  v_cmp_gt_u32 vcc, 0x700, v211
  s_cbranch_vccz AT_p1_x
  s_sleep 8
  s_cmp_lt_u32 s65, 131072
  s_cbranch_scc1 AT_p1
AT_p1_x:
  s_mov_b64 exec, -1
AT_p1_d:
  s_barrier
  s_mov_b32 s74, s59
  s_mul_i32 s66, s59, 655360
  s_lshl_b32 s55, s58, 14
  s_add_u32 s55, s55, s66
  s_add_u32 s55, s55, 1048576
  s_lshl_b32 s73, s58, 2
  s_add_u32 s73, s73, s52
  s_lshl_b32 s72, s59, 7
  s_add_u32 s72, s72, s73
  s_lshl_b32 s72, s72, 11
  s_add_u32 s72, s72, 46137344
  s_lshl_b32 s73, s73, 10
  s_add_u32 s73, s73, s66
  s_add_u32 s73, s73, 1572864
  s_add_u32 s59, s59, 2
  buffer_load_dwordx4 v[128:131], v216, s[8:11], s55 offen offset:0 sc1
  buffer_load_dwordx4 v[132:135], v216, s[8:11], s55 offen offset:256 sc1
  buffer_load_dwordx4 v[136:139], v216, s[8:11], s55 offen offset:512 sc1
  buffer_load_dwordx4 v[140:143], v216, s[8:11], s55 offen offset:768 sc1
  buffer_load_dwordx4 v[144:147], v216, s[8:11], s55 offen offset:1024 sc1
  buffer_load_dwordx4 v[148:151], v216, s[8:11], s55 offen offset:1280 sc1
  buffer_load_dwordx4 v[152:155], v216, s[8:11], s55 offen offset:1536 sc1
  buffer_load_dwordx4 v[156:159], v216, s[8:11], s55 offen offset:1792 sc1
  buffer_load_dwordx4 v[160:163], v217, s[8:11], s55 offen offset:0 sc1
  buffer_load_dwordx4 v[164:167], v217, s[8:11], s55 offen offset:256 sc1
  s_add_u32 s60, s60, 73728
  ds_read_b128 v[32:35], v203 offset:0
  ds_read_b128 v[36:39], v204 offset:0
  ds_read_b128 v[40:43], v205 offset:0
  s_waitcnt lgkmcnt(2)
  v_mfma_f32_32x32x16_bf16 v[240:255], a[0:3], v[32:35], 0
  ds_read_b128 v[44:47], v206 offset:0
  s_add_u32 m0, s67, 36864
  s_nop 0
  buffer_load_dwordx4 v202, s[4:7], s60 offen offset:0 lds
  s_waitcnt lgkmcnt(2)
  v_mfma_f32_32x32x16_bf16 v[240:255], a[4:7], v[36:39], v[240:255]
  ds_read_b128 v[32:35], v203 offset:1024
  s_waitcnt lgkmcnt(2)
  v_mfma_f32_32x32x16_bf16 v[240:255], a[8:11], v[40:43], v[240:255]
  ds_read_b128 v[36:39], v204 offset:1024
  s_add_u32 m0, s67, 37760
  s_nop 0
  buffer_load_dwordx4 v202, s[4:7], s60 offen offset:128 lds
  s_waitcnt lgkmcnt(2)
  v_mfma_f32_32x32x16_bf16 v[240:255], a[12:15], v[44:47], v[240:255]
  ds_read_b128 v[40:43], v205 offset:1024
  s_waitcnt lgkmcnt(2)
  v_mfma_f32_32x32x16_bf16 v[240:255], a[16:19], v[32:35], v[240:255]
  ds_read_b128 v[44:47], v206 offset:1024
  s_add_u32 m0, s67, 38656
  s_nop 0
  buffer_load_dwordx4 v202, s[4:7], s60 offen offset:256 lds
  s_waitcnt lgkmcnt(2)
  v_mfma_f32_32x32x16_bf16 v[240:255], a[20:23], v[36:39], v[240:255]
  ds_read_b128 v[32:35], v203 offset:2048
  s_waitcnt lgkmcnt(2)
  v_mfma_f32_32x32x16_bf16 v[240:255], a[24:27], v[40:43], v[240:255]
  ds_read_b128 v[36:39], v204 offset:2048
  s_add_u32 m0, s67, 39552
  s_nop 0
  buffer_load_dwordx4 v202, s[4:7], s60 offen offset:384 lds
  s_waitcnt lgkmcnt(2)
  v_mfma_f32_32x32x16_bf16 v[240:255], a[28:31], v[44:47], v[240:255]
  ds_read_b128 v[40:43], v205 offset:2048
  s_waitcnt lgkmcnt(2)
  v_mfma_f32_32x32x16_bf16 v[240:255], a[32:35], v[32:35], v[240:255]
  ds_read_b128 v[44:47], v206 offset:2048
  s_add_u32 m0, s67, 40448
  s_nop 0
  buffer_load_dwordx4 v202, s[4:7], s60 offen offset:512 lds
  s_waitcnt lgkmcnt(2)
  v_mfma_f32_32x32x16_bf16 v[240:255], a[36:39], v[36:39], v[240:255]
  ds_read_b128 v[32:35], v203 offset:3072
  s_waitcnt lgkmcnt(2)
  v_mfma_f32_32x32x16_bf16 v[240:255], a[40:43], v[40:43], v[240:255]
  ds_read_b128 v[36:39], v204 offset:3072
  s_add_u32 m0, s67, 41344
  s_nop 0
  buffer_load_dwordx4 v202, s[4:7], s60 offen offset:640 lds
  s_waitcnt lgkmcnt(2)
  v_mfma_f32_32x32x16_bf16 v[240:255], a[44:47], v[44:47], v[240:255]
  ds_read_b128 v[40:43], v205 offset:3072
  s_waitcnt lgkmcnt(2)
  v_mfma_f32_32x32x16_bf16 v[240:255], a[48:51], v[32:35], v[240:255]
  ds_read_b128 v[44:47], v206 offset:3072
  s_add_u32 m0, s67, 42240
  s_nop 0
  buffer_load_dwordx4 v202, s[4:7], s60 offen offset:768 lds
  s_waitcnt lgkmcnt(2)
  v_mfma_f32_32x32x16_bf16 v[240:255], a[52:55], v[36:39], v[240:255]
  ds_read_b128 v[32:35], v203 offset:4096
  s_waitcnt lgkmcnt(2)
  v_mfma_f32_32x32x16_bf16 v[240:255], a[56:59], v[40:43], v[240:255]
  ds_read_b128 v[36:39], v204 offset:4096
  s_add_u32 m0, s67, 43136
  s_nop 0
  buffer_load_dwordx4 v202, s[4:7], s60 offen offset:896 lds
  s_waitcnt lgkmcnt(2)
  v_mfma_f32_32x32x16_bf16 v[240:255], a[60:63], v[44:47], v[240:255]
  ds_read_b128 v[40:43], v205 offset:4096
  s_waitcnt lgkmcnt(2)
  v_mfma_f32_32x32x16_bf16 v[240:255], a[64:67], v[32:35], v[240:255]
  ds_read_b128 v[44:47], v206 offset:4096
  s_add_u32 m0, s67, 44032
  s_nop 0
  buffer_load_dwordx4 v202, s[4:7], s60 offen offset:1024 lds
  s_waitcnt lgkmcnt(2)
  v_mfma_f32_32x32x16_bf16 v[240:255], a[68:71], v[36:39], v[240:255]
  ds_read_b128 v[32:35], v203 offset:5120
  s_waitcnt lgkmcnt(2)
  v_mfma_f32_32x32x16_bf16 v[240:255], a[72:75], v[40:43], v[240:255]
  ds_read_b128 v[36:39], v204 offset:5120
  buffer_store_dwordx4 v[176:179], v201, s[8:11], s72 offen offset:0 sc1
  s_waitcnt lgkmcnt(2)
  v_mfma_f32_32x32x16_bf16 v[240:255], a[76:79], v[44:47], v[240:255]
  ds_read_b128 v[40:43], v205 offset:5120
  s_waitcnt lgkmcnt(2)
  v_mfma_f32_32x32x16_bf16 v[240:255], a[80:83], v[32:35], v[240:255]
  ds_read_b128 v[44:47], v206 offset:5120
  buffer_store_dwordx4 v[176:179], v201, s[8:11], s72 offen offset:1024 sc1
  s_waitcnt lgkmcnt(2)
  v_mfma_f32_32x32x16_bf16 v[240:255], a[84:87], v[36:39], v[240:255]
  ds_read_b128 v[32:35], v203 offset:6144
  s_waitcnt lgkmcnt(2)
  v_mfma_f32_32x32x16_bf16 v[240:255], a[88:91], v[40:43], v[240:255]
  ds_read_b128 v[36:39], v204 offset:6144
  s_waitcnt lgkmcnt(2)
  v_mfma_f32_32x32x16_bf16 v[240:255], a[92:95], v[44:47], v[240:255]
  ds_read_b128 v[40:43], v205 offset:6144
  s_waitcnt lgkmcnt(2)
  v_mfma_f32_32x32x16_bf16 v[240:255], a[96:99], v[32:35], v[240:255]
  ds_read_b128 v[44:47], v206 offset:6144
  s_waitcnt lgkmcnt(2)
  v_mfma_f32_32x32x16_bf16 v[240:255], a[100:103], v[36:39], v[240:255]
  ds_read_b128 v[32:35], v203 offset:7168
  s_waitcnt lgkmcnt(2)
  v_mfma_f32_32x32x16_bf16 v[240:255], a[104:107], v[40:43], v[240:255]
  ds_read_b128 v[36:39], v204 offset:7168
  s_waitcnt lgkmcnt(2)
  v_mfma_f32_32x32x16_bf16 v[240:255], a[108:111], v[44:47], v[240:255]
  ds_read_b128 v[40:43], v205 offset:7168
  s_waitcnt lgkmcnt(2)
  v_mfma_f32_32x32x16_bf16 v[240:255], a[112:115], v[32:35], v[240:255]
  ds_read_b128 v[44:47], v206 offset:7168
  s_waitcnt lgkmcnt(2)
  v_mfma_f32_32x32x16_bf16 v[240:255], a[116:119], v[36:39], v[240:255]
  ds_read_b128 v[32:35], v203 offset:8192
  s_waitcnt lgkmcnt(2)
  v_mfma_f32_32x32x16_bf16 v[240:255], a[120:123], v[40:43], v[240:255]
  ds_read_b128 v[36:39], v204 offset:8192
  s_waitcnt lgkmcnt(2)
  v_mfma_f32_32x32x16_bf16 v[240:255], a[124:127], v[44:47], v[240:255]
  ds_read_b128 v[40:43], v205 offset:8192
  s_waitcnt lgkmcnt(2)
  v_mfma_f32_32x32x16_bf16 v[240:255], a[128:131], v[32:35], v[240:255]
  ds_read_b128 v[44:47], v206 offset:8192
  s_waitcnt lgkmcnt(2)
  v_mfma_f32_32x32x16_bf16 v[240:255], a[132:135], v[36:39], v[240:255]
  s_waitcnt lgkmcnt(1)
  v_mfma_f32_32x32x16_bf16 v[240:255], a[136:139], v[40:43], v[240:255]
  s_waitcnt lgkmcnt(0)
  v_mfma_f32_32x32x16_bf16 v[240:255], a[140:143], v[44:47], v[240:255]
  s_nop 11
  v_cvt_pk_bf16_f32 v16, v240, v244
  v_cvt_pk_bf16_f32 v17, v241, v245
  v_cvt_pk_bf16_f32 v18, v242, v246
  v_cvt_pk_bf16_f32 v19, v243, v247
  ds_write_b128 v215, v[16:19] offset:0
  v_cvt_pk_bf16_f32 v20, v248, v252
  v_cvt_pk_bf16_f32 v21, v249, v253
  v_cvt_pk_bf16_f32 v22, v250, v254
  v_cvt_pk_bf16_f32 v23, v251, v255
  ds_write_b128 v215, v[20:23] offset:1024
  s_waitcnt lgkmcnt(0)
  s_barrier
  ds_read_b128 v[96:99], v208 offset:0
  ds_read_b128 v[100:103], v208 offset:1024
  ds_read_b128 v[104:107], v208 offset:2048
  ds_read_b128 v[108:111], v208 offset:3072
  ds_read_b128 v[112:115], v208 offset:4096
  ds_read_b128 v[116:119], v208 offset:5120
  ds_read_b128 v[120:123], v208 offset:6144
  ds_read_b128 v[124:127], v208 offset:7168
  s_waitcnt vmcnt(20) lgkmcnt(7)
  v_mfma_f32_32x32x16_bf16 v[64:79], v[128:131], v[96:99], v[48:63]
  s_waitcnt vmcnt(19) lgkmcnt(6)
  v_mfma_f32_32x32x16_bf16 v[64:79], v[132:135], v[100:103], v[64:79]
  s_waitcnt vmcnt(18) lgkmcnt(5)
  v_mfma_f32_32x32x16_bf16 v[64:79], v[136:139], v[104:107], v[64:79]
  s_waitcnt vmcnt(17) lgkmcnt(4)
  v_mfma_f32_32x32x16_bf16 v[64:79], v[140:143], v[108:111], v[64:79]
  s_waitcnt vmcnt(16) lgkmcnt(3)
  v_mfma_f32_32x32x16_bf16 v[64:79], v[144:147], v[112:115], v[64:79]
  s_waitcnt vmcnt(15) lgkmcnt(2)
  v_mfma_f32_32x32x16_bf16 v[64:79], v[148:151], v[116:119], v[64:79]
  s_waitcnt vmcnt(14) lgkmcnt(1)
  v_mfma_f32_32x32x16_bf16 v[64:79], v[152:155], v[120:123], v[64:79]
  s_waitcnt vmcnt(13) lgkmcnt(0)
  v_mfma_f32_32x32x16_bf16 v[64:79], v[156:159], v[124:127], v[64:79]
  s_nop 11
  v_max3_f32 v180, v64, v65, v66
  v_max3_f32 v180, v180, v67, v68
  v_max3_f32 v180, v180, v69, v70
  v_max3_f32 v180, v180, v71, v72
  v_max3_f32 v180, v180, v73, v74
  v_max3_f32 v180, v180, v75, v76
  v_max3_f32 v180, v180, v77, v78
  v_max_f32 v180, v180, v79
  v_mov_b32 v181, v180
  s_nop 1
  v_permlane32_swap_b32 v180, v181
  v_max_f32 v180, v180, v181
  v_sub_f32 v64, v64, v180
  v_sub_f32 v65, v65, v180
  v_sub_f32 v66, v66, v180
  v_sub_f32 v67, v67, v180
  v_sub_f32 v68, v68, v180
  v_sub_f32 v69, v69, v180
  v_sub_f32 v70, v70, v180
  v_sub_f32 v71, v71, v180
  v_sub_f32 v72, v72, v180
  v_sub_f32 v73, v73, v180
  v_sub_f32 v74, v74, v180
  v_sub_f32 v75, v75, v180
  v_sub_f32 v76, v76, v180
  v_sub_f32 v77, v77, v180
  v_sub_f32 v78, v78, v180
  v_sub_f32 v79, v79, v180
  v_exp_f32 v64, v64
  v_exp_f32 v65, v65
  v_exp_f32 v66, v66
  v_exp_f32 v67, v67
  v_exp_f32 v68, v68
  v_exp_f32 v69, v69
  v_exp_f32 v70, v70
  v_exp_f32 v71, v71
  v_exp_f32 v72, v72
  v_exp_f32 v73, v73
  v_exp_f32 v74, v74
  v_exp_f32 v75, v75
  v_exp_f32 v76, v76
  v_exp_f32 v77, v77
  v_exp_f32 v78, v78
  v_exp_f32 v79, v79
  v_cvt_pk_bf16_f32 v20, v64, v65
  v_cvt_pk_bf16_f32 v21, v68, v69
  v_cvt_pk_bf16_f32 v22, v72, v73
  v_cvt_pk_bf16_f32 v23, v76, v77
  v_cvt_pk_bf16_f32 v24, v66, v67
  v_cvt_pk_bf16_f32 v25, v70, v71
  v_cvt_pk_bf16_f32 v26, v74, v75
  v_cvt_pk_bf16_f32 v27, v78, v79
  s_waitcnt vmcnt(12)
  v_mfma_f32_32x32x16_bf16 v[0:15], v[160:163], v[20:23], 0
  v_add_f32 v182, v64, v65
  v_add_f32 v182, v182, v66
  v_add_f32 v182, v182, v67
  v_add_f32 v182, v182, v68
  v_add_f32 v182, v182, v69
  v_add_f32 v182, v182, v70
  v_add_f32 v182, v182, v71
  s_waitcnt vmcnt(11)
  v_mfma_f32_32x32x16_bf16 v[0:15], v[164:167], v[24:27], v[0:15]
  v_add_f32 v182, v182, v72
  v_add_f32 v182, v182, v73
  v_add_f32 v182, v182, v74
  v_add_f32 v182, v182, v75
  v_add_f32 v182, v182, v76
  v_add_f32 v182, v182, v77
  v_add_f32 v182, v182, v78
  v_add_f32 v182, v182, v79
  s_waitcnt vmcnt(0)
  s_barrier
AT_loop:
  s_cmp_ge_u32 s59, 64
  s_cbranch_scc1 AT_l0
  s_mov_b32 s77, s59
  s_mul_i32 s66, s59, 655360
  s_lshl_b32 s55, s58, 14
  s_add_u32 s55, s55, s66
  s_add_u32 s55, s55, 1048576
  s_lshl_b32 s76, s58, 2
  s_add_u32 s76, s76, s52
  s_lshl_b32 s75, s59, 7
  s_add_u32 s75, s75, s76
  s_lshl_b32 s75, s75, 11
  s_add_u32 s75, s75, 46137344
  s_lshl_b32 s76, s76, 10
  s_add_u32 s76, s76, s66
  s_add_u32 s76, s76, 1572864
  s_add_u32 s59, s59, 2
  buffer_load_dwordx4 v[128:131], v216, s[8:11], s55 offen offset:0 sc1
  buffer_load_dwordx4 v[132:135], v216, s[8:11], s55 offen offset:256 sc1
  buffer_load_dwordx4 v[136:139], v216, s[8:11], s55 offen offset:512 sc1
  buffer_load_dwordx4 v[140:143], v216, s[8:11], s55 offen offset:768 sc1
  buffer_load_dwordx4 v[144:147], v216, s[8:11], s55 offen offset:1024 sc1
  buffer_load_dwordx4 v[148:151], v216, s[8:11], s55 offen offset:1280 sc1
  buffer_load_dwordx4 v[152:155], v216, s[8:11], s55 offen offset:1536 sc1
  buffer_load_dwordx4 v[156:159], v216, s[8:11], s55 offen offset:1792 sc1
  buffer_load_dwordx4 v[160:163], v217, s[8:11], s55 offen offset:0 sc1
  buffer_load_dwordx4 v[164:167], v217, s[8:11], s55 offen offset:256 sc1
  s_or_b32 s70, s73, 0xc00
  buffer_load_dword v172, off, s[8:11], s70 sc1
  s_add_u32 s60, s60, 73728
  ds_read_b128 v[32:35], v203 offset:36864
  ds_read_b128 v[36:39], v204 offset:36864
  ds_read_b128 v[40:43], v205 offset:36864
  s_waitcnt lgkmcnt(2)
  v_mfma_f32_32x32x16_bf16 v[240:255], a[0:3], v[32:35], 0
  ds_read_b128 v[44:47], v206 offset:36864
  s_add_u32 m0, s67, 0
  s_nop 0
  buffer_load_dwordx4 v202, s[4:7], s60 offen offset:0 lds
  s_waitcnt lgkmcnt(2)
  v_mfma_f32_32x32x16_bf16 v[240:255], a[4:7], v[36:39], v[240:255]
  ds_read_b128 v[32:35], v203 offset:37888
  s_waitcnt lgkmcnt(2)
  v_mfma_f32_32x32x16_bf16 v[240:255], a[8:11], v[40:43], v[240:255]
  ds_read_b128 v[36:39], v204 offset:37888
  s_add_u32 m0, s67, 896
  s_nop 0
  buffer_load_dwordx4 v202, s[4:7], s60 offen offset:128 lds
  s_waitcnt lgkmcnt(2)
  v_mfma_f32_32x32x16_bf16 v[240:255], a[12:15], v[44:47], v[240:255]
  ds_read_b128 v[40:43], v205 offset:37888
  s_waitcnt lgkmcnt(2)
  v_mfma_f32_32x32x16_bf16 v[240:255], a[16:19], v[32:35], v[240:255]
  ds_read_b128 v[44:47], v206 offset:37888
  s_add_u32 m0, s67, 1792
  s_nop 0
  buffer_load_dwordx4 v202, s[4:7], s60 offen offset:256 lds
  s_waitcnt lgkmcnt(2)
  v_mfma_f32_32x32x16_bf16 v[240:255], a[20:23], v[36:39], v[240:255]
  ds_read_b128 v[32:35], v203 offset:38912
  s_waitcnt lgkmcnt(2)
  v_mfma_f32_32x32x16_bf16 v[240:255], a[24:27], v[40:43], v[240:255]
  ds_read_b128 v[36:39], v204 offset:38912
  s_add_u32 m0, s67, 2688
  s_nop 0
  buffer_load_dwordx4 v202, s[4:7], s60 offen offset:384 lds
  s_waitcnt lgkmcnt(2)
  v_mfma_f32_32x32x16_bf16 v[240:255], a[28:31], v[44:47], v[240:255]
  ds_read_b128 v[40:43], v205 offset:38912
  s_waitcnt lgkmcnt(2)
  v_mfma_f32_32x32x16_bf16 v[240:255], a[32:35], v[32:35], v[240:255]
  ds_read_b128 v[44:47], v206 offset:38912
  s_add_u32 m0, s67, 3584
  s_nop 0
  buffer_load_dwordx4 v202, s[4:7], s60 offen offset:512 lds
  s_waitcnt lgkmcnt(2)
  v_mfma_f32_32x32x16_bf16 v[240:255], a[36:39], v[36:39], v[240:255]
  ds_read_b128 v[32:35], v203 offset:39936
  s_waitcnt lgkmcnt(2)
  v_mfma_f32_32x32x16_bf16 v[240:255], a[40:43], v[40:43], v[240:255]
  ds_read_b128 v[36:39], v204 offset:39936
  s_add_u32 m0, s67, 4480
  s_nop 0
  buffer_load_dwordx4 v202, s[4:7], s60 offen offset:640 lds
  s_waitcnt lgkmcnt(2)
  v_mfma_f32_32x32x16_bf16 v[240:255], a[44:47], v[44:47], v[240:255]
  ds_read_b128 v[40:43], v205 offset:39936
  s_waitcnt lgkmcnt(2)
  v_mfma_f32_32x32x16_bf16 v[240:255], a[48:51], v[32:35], v[240:255]
  ds_read_b128 v[44:47], v206 offset:39936
  s_add_u32 m0, s67, 5376
  s_nop 0
  buffer_load_dwordx4 v202, s[4:7], s60 offen offset:768 lds
  s_waitcnt lgkmcnt(2)
  v_mfma_f32_32x32x16_bf16 v[240:255], a[52:55], v[36:39], v[240:255]
  ds_read_b128 v[32:35], v203 offset:40960
  s_waitcnt lgkmcnt(2)
  v_mfma_f32_32x32x16_bf16 v[240:255], a[56:59], v[40:43], v[240:255]
  ds_read_b128 v[36:39], v204 offset:40960
  s_add_u32 m0, s67, 6272
  s_nop 0
  buffer_load_dwordx4 v202, s[4:7], s60 offen offset:896 lds
  s_waitcnt lgkmcnt(2)
  v_mfma_f32_32x32x16_bf16 v[240:255], a[60:63], v[44:47], v[240:255]
  ds_read_b128 v[40:43], v205 offset:40960
  s_waitcnt lgkmcnt(2)
  v_mfma_f32_32x32x16_bf16 v[240:255], a[64:67], v[32:35], v[240:255]
  ds_read_b128 v[44:47], v206 offset:40960
  s_add_u32 m0, s67, 7168
  s_nop 0
  buffer_load_dwordx4 v202, s[4:7], s60 offen offset:1024 lds
  s_waitcnt lgkmcnt(2)
  v_mfma_f32_32x32x16_bf16 v[240:255], a[68:71], v[36:39], v[240:255]
  ds_read_b128 v[32:35], v203 offset:41984
  s_waitcnt lgkmcnt(2)
  v_mfma_f32_32x32x16_bf16 v[240:255], a[72:75], v[40:43], v[240:255]
  ds_read_b128 v[36:39], v204 offset:41984
  buffer_store_dwordx4 v[176:179], v201, s[8:11], s75 offen offset:0 sc1
  s_waitcnt lgkmcnt(2)
  v_mfma_f32_32x32x16_bf16 v[240:255], a[76:79], v[44:47], v[240:255]
  ds_read_b128 v[40:43], v205 offset:41984
  s_waitcnt lgkmcnt(2)
  v_mfma_f32_32x32x16_bf16 v[240:255], a[80:83], v[32:35], v[240:255]
  ds_read_b128 v[44:47], v206 offset:41984
  buffer_store_dwordx4 v[176:179], v201, s[8:11], s75 offen offset:1024 sc1
  s_waitcnt lgkmcnt(2)
  v_mfma_f32_32x32x16_bf16 v[240:255], a[84:87], v[36:39], v[240:255]
  ds_read_b128 v[32:35], v203 offset:43008
  s_waitcnt lgkmcnt(2)
  v_mfma_f32_32x32x16_bf16 v[240:255], a[88:91], v[40:43], v[240:255]
  ds_read_b128 v[36:39], v204 offset:43008
  s_waitcnt lgkmcnt(2)
  v_mfma_f32_32x32x16_bf16 v[240:255], a[92:95], v[44:47], v[240:255]
  ds_read_b128 v[40:43], v205 offset:43008
  s_waitcnt lgkmcnt(2)
  v_mfma_f32_32x32x16_bf16 v[240:255], a[96:99], v[32:35], v[240:255]
  ds_read_b128 v[44:47], v206 offset:43008
  s_waitcnt lgkmcnt(2)
  v_mfma_f32_32x32x16_bf16 v[240:255], a[100:103], v[36:39], v[240:255]
  ds_read_b128 v[32:35], v203 offset:44032
  s_waitcnt lgkmcnt(2)
  v_mfma_f32_32x32x16_bf16 v[240:255], a[104:107], v[40:43], v[240:255]
  ds_read_b128 v[36:39], v204 offset:44032
  s_waitcnt lgkmcnt(2)
  v_mfma_f32_32x32x16_bf16 v[240:255], a[108:111], v[44:47], v[240:255]
  ds_read_b128 v[40:43], v205 offset:44032
  s_waitcnt lgkmcnt(2)
  v_mfma_f32_32x32x16_bf16 v[240:255], a[112:115], v[32:35], v[240:255]
  ds_read_b128 v[44:47], v206 offset:44032
  s_waitcnt lgkmcnt(2)
  v_mfma_f32_32x32x16_bf16 v[240:255], a[116:119], v[36:39], v[240:255]
  ds_read_b128 v[32:35], v203 offset:45056
  s_waitcnt lgkmcnt(2)
  v_mfma_f32_32x32x16_bf16 v[240:255], a[120:123], v[40:43], v[240:255]
  ds_read_b128 v[36:39], v204 offset:45056
  s_waitcnt lgkmcnt(2)
  v_mfma_f32_32x32x16_bf16 v[240:255], a[124:127], v[44:47], v[240:255]
  ds_read_b128 v[40:43], v205 offset:45056
  s_waitcnt lgkmcnt(2)
  v_mfma_f32_32x32x16_bf16 v[240:255], a[128:131], v[32:35], v[240:255]
  ds_read_b128 v[44:47], v206 offset:45056
  s_waitcnt lgkmcnt(2)
  v_mfma_f32_32x32x16_bf16 v[240:255], a[132:135], v[36:39], v[240:255]
  s_waitcnt lgkmcnt(1)
  v_mfma_f32_32x32x16_bf16 v[240:255], a[136:139], v[40:43], v[240:255]
  s_waitcnt lgkmcnt(0)
  v_mfma_f32_32x32x16_bf16 v[240:255], a[140:143], v[44:47], v[240:255]
  s_nop 11
  v_cvt_pk_bf16_f32 v16, v240, v244
  v_cvt_pk_bf16_f32 v17, v241, v245
  v_cvt_pk_bf16_f32 v18, v242, v246
  v_cvt_pk_bf16_f32 v19, v243, v247
  ds_write_b128 v215, v[16:19] offset:0
  v_cvt_pk_bf16_f32 v20, v248, v252
  v_cvt_pk_bf16_f32 v21, v249, v253
  v_cvt_pk_bf16_f32 v22, v250, v254
  v_cvt_pk_bf16_f32 v23, v251, v255
  ds_write_b128 v215, v[20:23] offset:1024
  s_waitcnt lgkmcnt(0)
  s_barrier
  ds_read_b128 a[144:147], v208 offset:0
  ds_read_b128 a[148:151], v208 offset:1024
  ds_read_b128 a[152:155], v208 offset:2048
  ds_read_b128 a[156:159], v208 offset:3072
  ds_read_b128 a[160:163], v208 offset:4096
  ds_read_b128 a[164:167], v208 offset:5120
  ds_read_b128 a[168:171], v208 offset:6144
  ds_read_b128 a[172:175], v208 offset:7168
  s_waitcnt vmcnt(11)
  v_cmp_eq_u32 vcc, -1, v172
  s_mov_b32 s69, 0
  s_cbranch_vccnz AT_e1
  s_mov_b32 s69, 1
  buffer_load_dwordx4 v[172:175], v201, s[8:11], s73 offen sc1
AT_e1:
  s_waitcnt lgkmcnt(7)
  v_mfma_f32_32x32x16_bf16 v[64:79], v[128:131], a[144:147], v[48:63]
  s_waitcnt lgkmcnt(6)
  v_mfma_f32_32x32x16_bf16 v[64:79], v[132:135], a[148:151], v[64:79]
  s_waitcnt lgkmcnt(5)
  v_mfma_f32_32x32x16_bf16 v[64:79], v[136:139], a[152:155], v[64:79]
  s_waitcnt lgkmcnt(4)
  v_mfma_f32_32x32x16_bf16 v[64:79], v[140:143], a[156:159], v[64:79]
  s_waitcnt lgkmcnt(3)
  v_mfma_f32_32x32x16_bf16 v[64:79], v[144:147], a[160:163], v[64:79]
  s_waitcnt lgkmcnt(2)
  v_mfma_f32_32x32x16_bf16 v[64:79], v[148:151], a[164:167], v[64:79]
  s_waitcnt lgkmcnt(1)
  v_mfma_f32_32x32x16_bf16 v[64:79], v[152:155], a[168:171], v[64:79]
  s_waitcnt lgkmcnt(0)
  v_mfma_f32_32x32x16_bf16 v[64:79], v[156:159], a[172:175], v[64:79]
  s_nop 11
  v_max3_f32 v184, v64, v65, v66
  v_max3_f32 v184, v184, v67, v68
  v_max3_f32 v184, v184, v69, v70
  v_max3_f32 v184, v184, v71, v72
  v_max3_f32 v184, v184, v73, v74
  v_max3_f32 v184, v184, v75, v76
  v_max3_f32 v184, v184, v77, v78
  v_max_f32 v184, v184, v79
  v_mov_b32 v185, v184
  s_nop 1
  v_permlane32_swap_b32 v184, v185
  v_max_f32 v184, v184, v185
  v_sub_f32 v64, v64, v184
  v_sub_f32 v65, v65, v184
  v_sub_f32 v66, v66, v184
  v_sub_f32 v67, v67, v184
  v_sub_f32 v68, v68, v184
  v_sub_f32 v69, v69, v184
  v_sub_f32 v70, v70, v184
  v_sub_f32 v71, v71, v184
  v_sub_f32 v72, v72, v184
  v_sub_f32 v73, v73, v184
  v_sub_f32 v74, v74, v184
  v_sub_f32 v75, v75, v184
  v_sub_f32 v76, v76, v184
  v_sub_f32 v77, v77, v184
  v_sub_f32 v78, v78, v184
  v_sub_f32 v79, v79, v184
  v_exp_f32 v64, v64
  v_exp_f32 v65, v65
  v_exp_f32 v66, v66
  v_exp_f32 v67, v67
  v_exp_f32 v68, v68
  v_exp_f32 v69, v69
  v_exp_f32 v70, v70
  v_exp_f32 v71, v71
  v_exp_f32 v72, v72
  v_exp_f32 v73, v73
  v_exp_f32 v74, v74
  v_exp_f32 v75, v75
  v_exp_f32 v76, v76
  v_exp_f32 v77, v77
  v_exp_f32 v78, v78
  v_exp_f32 v79, v79
  v_cvt_pk_bf16_f32 v20, v64, v65
  v_cvt_pk_bf16_f32 v21, v68, v69
  v_cvt_pk_bf16_f32 v22, v72, v73
  v_cvt_pk_bf16_f32 v23, v76, v77
  v_cvt_pk_bf16_f32 v24, v66, v67
  v_cvt_pk_bf16_f32 v25, v70, v71
  v_cvt_pk_bf16_f32 v26, v74, v75
  v_cvt_pk_bf16_f32 v27, v78, v79
  v_mfma_f32_32x32x16_bf16 v[224:239], v[160:163], v[20:23], 0
  v_add_f32 v186, v64, v65
  v_add_f32 v186, v186, v66
  v_add_f32 v186, v186, v67
  v_add_f32 v186, v186, v68
  v_add_f32 v186, v186, v69
  v_add_f32 v186, v186, v70
  v_add_f32 v186, v186, v71
  v_mfma_f32_32x32x16_bf16 v[224:239], v[164:167], v[24:27], v[224:239]
  v_add_f32 v186, v186, v72
  v_add_f32 v186, v186, v73
  v_add_f32 v186, v186, v74
  v_add_f32 v186, v186, v75
  v_add_f32 v186, v186, v76
  v_add_f32 v186, v186, v77
  v_add_f32 v186, v186, v78
  v_add_f32 v186, v186, v79
AT_l0:
  s_cmp_eq_u32 s69, 1
  s_cbranch_scc1 AT_v0
  s_cmp_ge_u32 s74, 62
  s_cbranch_scc1 AT_k0
  s_branch AT_c0
AT_h0:
  s_sleep 2
AT_c0:
  buffer_load_dword v172, off, s[8:11], s70 sc1
  s_add_u32 s65, s65, 1
  s_cmp_lt_u32 s65, 131072
  s_cselect_b32 s54, -2, -1
  s_waitcnt vmcnt(0)
  v_cmp_lt_u32 vcc, s54, v172
  s_cbranch_vccnz AT_h0
AT_k0:
  buffer_load_dwordx4 v[172:175], v201, s[8:11], s73 offen sc1
AT_v0:
  s_mov_b32 s69, 0
  s_add_u32 s65, s65, 1
  s_cmp_lt_u32 s65, 131072
  s_cselect_b32 s54, -2, -1
  s_waitcnt vmcnt(0)
  ds_write_b64 v220, v[172:173] offset:0
  ds_write_b64 v221, v[174:175] offset:0
  v_max3_u32 v213, v172, v173, v174
  v_max_u32 v213, v213, v175
  v_cmp_lt_u32 vcc, s54, v213
  s_cbranch_vccnz AT_k0
  s_waitcnt lgkmcnt(0)
  s_barrier
  ds_read_b128 v[128:131], v218 offset:0
  ds_read_b128 v[132:135], v218 offset:256
  ds_read_b128 v[136:139], v218 offset:512
  ds_read_b128 v[140:143], v218 offset:768
  ds_read_b128 v[144:147], v218 offset:1024
  ds_read_b128 v[148:151], v218 offset:1280
  ds_read_b128 v[152:155], v218 offset:1536
  ds_read_b128 v[156:159], v218 offset:1792
  ds_read_b32 v168, v219 offset:0
  ds_read_b32 v169, v219 offset:128
  s_waitcnt lgkmcnt(9)
  v_mfma_f32_32x32x16_bf16 v[80:95], v[128:131], v[96:99], 0
  s_waitcnt lgkmcnt(8)
  v_mfma_f32_32x32x16_bf16 v[80:95], v[132:135], v[100:103], v[80:95]
  s_waitcnt lgkmcnt(7)
  v_mfma_f32_32x32x16_bf16 v[80:95], v[136:139], v[104:107], v[80:95]
  s_waitcnt lgkmcnt(6)
  v_mfma_f32_32x32x16_bf16 v[80:95], v[140:143], v[108:111], v[80:95]
  s_waitcnt lgkmcnt(5)
  v_mfma_f32_32x32x16_bf16 v[80:95], v[144:147], v[112:115], v[80:95]
  s_waitcnt lgkmcnt(4)
  v_mfma_f32_32x32x16_bf16 v[80:95], v[148:151], v[116:119], v[80:95]
  s_waitcnt lgkmcnt(3)
  v_mfma_f32_32x32x16_bf16 v[80:95], v[152:155], v[120:123], v[80:95]
  s_waitcnt lgkmcnt(2)
  v_mfma_f32_32x32x16_bf16 v[80:95], v[156:159], v[124:127], v[80:95]
  s_add_u32 s74, s74, 2
  v_mov_b32 v212, s74
  s_nop 9
  v_mul_f32 v80, s68, v80
  v_mul_f32 v81, s68, v81
  v_mul_f32 v82, s68, v82
  v_mul_f32 v83, s68, v83
  v_max3_f32 v84, v180, v80, v81
  v_max3_f32 v84, v84, v82, v83
  v_mov_b32 v85, v84
  s_nop 1
  v_permlane32_swap_b32 v84, v85
  v_max_f32 v84, v84, v85
  v_sub_f32 v86, v180, v84
  v_sub_f32 v80, v80, v84
  v_sub_f32 v81, v81, v84
  v_sub_f32 v82, v82, v84
  v_sub_f32 v83, v83, v84
  v_exp_f32 v86, v86
  v_exp_f32 v80, v80
  v_exp_f32 v81, v81
  v_exp_f32 v82, v82
  v_exp_f32 v83, v83
  v_fma_f32 v182, v182, v86, v80
  v_add_f32 v84, v81, v82
  v_add_f32 v182, v182, v83
  v_add_f32 v182, v182, v84
  v_mov_b32 v183, v182
  s_nop 1
  v_permlane32_swap_b32 v182, v183
  v_add_f32 v182, v182, v183
  v_rcp_f32 v182, v182
  s_nop 0
  v_mul_f32 v86, v86, v182
  v_mul_f32 v80, v182, v80
  v_mul_f32 v81, v182, v81
  v_mul_f32 v82, v182, v82
  v_mul_f32 v83, v182, v83
  v_cvt_pk_bf16_f32 v28, v80, v81
  v_cvt_pk_bf16_f32 v29, v82, v83
  v_mul_f32 v0, v86, v0
  v_mul_f32 v1, v86, v1
  v_mul_f32 v2, v86, v2
  v_mul_f32 v3, v86, v3
  v_mul_f32 v4, v86, v4
  v_mul_f32 v5, v86, v5
  v_mul_f32 v6, v86, v6
  v_mul_f32 v7, v86, v7
  v_mul_f32 v8, v86, v8
  v_mul_f32 v9, v86, v9
  v_mul_f32 v10, v86, v10
  v_mul_f32 v11, v86, v11
  v_mul_f32 v12, v86, v12
  v_mul_f32 v13, v86, v13
  v_mul_f32 v14, v86, v14
  v_mul_f32 v15, v86, v15
  s_waitcnt lgkmcnt(0)
  s_nop 0
  v_mfma_f32_32x32x8_bf16 v[0:15], v[168:169], v[28:29], v[0:15]
  s_nop 11
  v_cvt_pk_bf16_f32 v20, v0, v1
  v_cvt_pk_bf16_f32 v21, v2, v3
  v_cvt_pk_bf16_f32 v22, v4, v5
  v_cvt_pk_bf16_f32 v23, v6, v7
  buffer_store_dwordx4 v[20:23], v201, s[8:11], s72 offen offset:0 sc1
  v_cvt_pk_bf16_f32 v24, v8, v9
  v_cvt_pk_bf16_f32 v25, v10, v11
  v_cvt_pk_bf16_f32 v26, v12, v13
  v_cvt_pk_bf16_f32 v27, v14, v15
  buffer_store_dwordx4 v[24:27], v201, s[8:11], s72 offen offset:1024 sc1
  s_mov_b64 exec, 1
  buffer_store_dword v212, v201, s[8:11], s71 offen sc1
  s_mov_b64 exec, -1
  s_cmp_ge_u32 s74, 64
  s_cbranch_scc1 L_exit
  s_cmp_ge_u32 s59, 64
  s_cbranch_scc1 AT_l1
  s_mov_b32 s74, s59
  s_mul_i32 s66, s59, 655360
  s_lshl_b32 s55, s58, 14
  s_add_u32 s55, s55, s66
  s_add_u32 s55, s55, 1048576
  s_lshl_b32 s73, s58, 2
  s_add_u32 s73, s73, s52
  s_lshl_b32 s72, s59, 7
  s_add_u32 s72, s72, s73
  s_lshl_b32 s72, s72, 11
  s_add_u32 s72, s72, 46137344
  s_lshl_b32 s73, s73, 10
  s_add_u32 s73, s73, s66
  s_add_u32 s73, s73, 1572864
  s_add_u32 s59, s59, 2
  buffer_load_dwordx4 v[128:131], v216, s[8:11], s55 offen offset:0 sc1
  buffer_load_dwordx4 v[132:135], v216, s[8:11], s55 offen offset:256 sc1
  buffer_load_dwordx4 v[136:139], v216, s[8:11], s55 offen offset:512 sc1
  buffer_load_dwordx4 v[140:143], v216, s[8:11], s55 offen offset:768 sc1
  buffer_load_dwordx4 v[144:147], v216, s[8:11], s55 offen offset:1024 sc1
  buffer_load_dwordx4 v[148:151], v216, s[8:11], s55 offen offset:1280 sc1
  buffer_load_dwordx4 v[152:155], v216, s[8:11], s55 offen offset:1536 sc1
  buffer_load_dwordx4 v[156:159], v216, s[8:11], s55 offen offset:1792 sc1
  buffer_load_dwordx4 v[160:163], v217, s[8:11], s55 offen offset:0 sc1
  buffer_load_dwordx4 v[164:167], v217, s[8:11], s55 offen offset:256 sc1
  s_or_b32 s70, s76, 0xc00
  buffer_load_dword v172, off, s[8:11], s70 sc1
  s_add_u32 s60, s60, 73728
  ds_read_b128 v[32:35], v203 offset:0
  ds_read_b128 v[36:39], v204 offset:0
  ds_read_b128 v[40:43], v205 offset:0
  s_waitcnt lgkmcnt(2)
  v_mfma_f32_32x32x16_bf16 v[240:255], a[0:3], v[32:35], 0
  ds_read_b128 v[44:47], v206 offset:0
  s_add_u32 m0, s67, 36864
  s_nop 0
  buffer_load_dwordx4 v202, s[4:7], s60 offen offset:0 lds
  s_waitcnt lgkmcnt(2)
  v_mfma_f32_32x32x16_bf16 v[240:255], a[4:7], v[36:39], v[240:255]
  ds_read_b128 v[32:35], v203 offset:1024
  s_waitcnt lgkmcnt(2)
  v_mfma_f32_32x32x16_bf16 v[240:255], a[8:11], v[40:43], v[240:255]
  ds_read_b128 v[36:39], v204 offset:1024
  s_add_u32 m0, s67, 37760
  s_nop 0
  buffer_load_dwordx4 v202, s[4:7], s60 offen offset:128 lds
  s_waitcnt lgkmcnt(2)
  v_mfma_f32_32x32x16_bf16 v[240:255], a[12:15], v[44:47], v[240:255]
  ds_read_b128 v[40:43], v205 offset:1024
  s_waitcnt lgkmcnt(2)
  v_mfma_f32_32x32x16_bf16 v[240:255], a[16:19], v[32:35], v[240:255]
  ds_read_b128 v[44:47], v206 offset:1024
  s_add_u32 m0, s67, 38656
  s_nop 0
  buffer_load_dwordx4 v202, s[4:7], s60 offen offset:256 lds
  s_waitcnt lgkmcnt(2)
  v_mfma_f32_32x32x16_bf16 v[240:255], a[20:23], v[36:39], v[240:255]
  ds_read_b128 v[32:35], v203 offset:2048
  s_waitcnt lgkmcnt(2)
  v_mfma_f32_32x32x16_bf16 v[240:255], a[24:27], v[40:43], v[240:255]
  ds_read_b128 v[36:39], v204 offset:2048
  s_add_u32 m0, s67, 39552
  s_nop 0
  buffer_load_dwordx4 v202, s[4:7], s60 offen offset:384 lds
  s_waitcnt lgkmcnt(2)
  v_mfma_f32_32x32x16_bf16 v[240:255], a[28:31], v[44:47], v[240:255]
  ds_read_b128 v[40:43], v205 offset:2048
  s_waitcnt lgkmcnt(2)
  v_mfma_f32_32x32x16_bf16 v[240:255], a[32:35], v[32:35], v[240:255]
  ds_read_b128 v[44:47], v206 offset:2048
  s_add_u32 m0, s67, 40448
  s_nop 0
  buffer_load_dwordx4 v202, s[4:7], s60 offen offset:512 lds
  s_waitcnt lgkmcnt(2)
  v_mfma_f32_32x32x16_bf16 v[240:255], a[36:39], v[36:39], v[240:255]
  ds_read_b128 v[32:35], v203 offset:3072
  s_waitcnt lgkmcnt(2)
  v_mfma_f32_32x32x16_bf16 v[240:255], a[40:43], v[40:43], v[240:255]
  ds_read_b128 v[36:39], v204 offset:3072
  s_add_u32 m0, s67, 41344
  s_nop 0
  buffer_load_dwordx4 v202, s[4:7], s60 offen offset:640 lds
  s_waitcnt lgkmcnt(2)
  v_mfma_f32_32x32x16_bf16 v[240:255], a[44:47], v[44:47], v[240:255]
  ds_read_b128 v[40:43], v205 offset:3072
  s_waitcnt lgkmcnt(2)
  v_mfma_f32_32x32x16_bf16 v[240:255], a[48:51], v[32:35], v[240:255]
  ds_read_b128 v[44:47], v206 offset:3072
  s_add_u32 m0, s67, 42240
  s_nop 0
  buffer_load_dwordx4 v202, s[4:7], s60 offen offset:768 lds
  s_waitcnt lgkmcnt(2)
  v_mfma_f32_32x32x16_bf16 v[240:255], a[52:55], v[36:39], v[240:255]
  ds_read_b128 v[32:35], v203 offset:4096
  s_waitcnt lgkmcnt(2)
  v_mfma_f32_32x32x16_bf16 v[240:255], a[56:59], v[40:43], v[240:255]
  ds_read_b128 v[36:39], v204 offset:4096
  s_add_u32 m0, s67, 43136
  s_nop 0
  buffer_load_dwordx4 v202, s[4:7], s60 offen offset:896 lds
  s_waitcnt lgkmcnt(2)
  v_mfma_f32_32x32x16_bf16 v[240:255], a[60:63], v[44:47], v[240:255]
  ds_read_b128 v[40:43], v205 offset:4096
  s_waitcnt lgkmcnt(2)
  v_mfma_f32_32x32x16_bf16 v[240:255], a[64:67], v[32:35], v[240:255]
  ds_read_b128 v[44:47], v206 offset:4096
  s_add_u32 m0, s67, 44032
  s_nop 0
  buffer_load_dwordx4 v202, s[4:7], s60 offen offset:1024 lds
  s_waitcnt lgkmcnt(2)
  v_mfma_f32_32x32x16_bf16 v[240:255], a[68:71], v[36:39], v[240:255]
  ds_read_b128 v[32:35], v203 offset:5120
  s_waitcnt lgkmcnt(2)
  v_mfma_f32_32x32x16_bf16 v[240:255], a[72:75], v[40:43], v[240:255]
  ds_read_b128 v[36:39], v204 offset:5120
  buffer_store_dwordx4 v[176:179], v201, s[8:11], s72 offen offset:0 sc1
  s_waitcnt lgkmcnt(2)
  v_mfma_f32_32x32x16_bf16 v[240:255], a[76:79], v[44:47], v[240:255]
  ds_read_b128 v[40:43], v205 offset:5120
  s_waitcnt lgkmcnt(2)
  v_mfma_f32_32x32x16_bf16 v[240:255], a[80:83], v[32:35], v[240:255]
  ds_read_b128 v[44:47], v206 offset:5120
  buffer_store_dwordx4 v[176:179], v201, s[8:11], s72 offen offset:1024 sc1
  s_waitcnt lgkmcnt(2)
  v_mfma_f32_32x32x16_bf16 v[240:255], a[84:87], v[36:39], v[240:255]
  ds_read_b128 v[32:35], v203 offset:6144
  s_waitcnt lgkmcnt(2)
  v_mfma_f32_32x32x16_bf16 v[240:255], a[88:91], v[40:43], v[240:255]
  ds_read_b128 v[36:39], v204 offset:6144
  s_waitcnt lgkmcnt(2)
  v_mfma_f32_32x32x16_bf16 v[240:255], a[92:95], v[44:47], v[240:255]
  ds_read_b128 v[40:43], v205 offset:6144
  s_waitcnt lgkmcnt(2)
  v_mfma_f32_32x32x16_bf16 v[240:255], a[96:99], v[32:35], v[240:255]
  ds_read_b128 v[44:47], v206 offset:6144
  s_waitcnt lgkmcnt(2)
  v_mfma_f32_32x32x16_bf16 v[240:255], a[100:103], v[36:39], v[240:255]
  ds_read_b128 v[32:35], v203 offset:7168
  s_waitcnt lgkmcnt(2)
  v_mfma_f32_32x32x16_bf16 v[240:255], a[104:107], v[40:43], v[240:255]
  ds_read_b128 v[36:39], v204 offset:7168
  s_waitcnt lgkmcnt(2)
  v_mfma_f32_32x32x16_bf16 v[240:255], a[108:111], v[44:47], v[240:255]
  ds_read_b128 v[40:43], v205 offset:7168
  s_waitcnt lgkmcnt(2)
  v_mfma_f32_32x32x16_bf16 v[240:255], a[112:115], v[32:35], v[240:255]
  ds_read_b128 v[44:47], v206 offset:7168
  s_waitcnt lgkmcnt(2)
  v_mfma_f32_32x32x16_bf16 v[240:255], a[116:119], v[36:39], v[240:255]
  ds_read_b128 v[32:35], v203 offset:8192
  s_waitcnt lgkmcnt(2)
  v_mfma_f32_32x32x16_bf16 v[240:255], a[120:123], v[40:43], v[240:255]
  ds_read_b128 v[36:39], v204 offset:8192
  s_waitcnt lgkmcnt(2)
  v_mfma_f32_32x32x16_bf16 v[240:255], a[124:127], v[44:47], v[240:255]
  ds_read_b128 v[40:43], v205 offset:8192
  s_waitcnt lgkmcnt(2)
  v_mfma_f32_32x32x16_bf16 v[240:255], a[128:131], v[32:35], v[240:255]
  ds_read_b128 v[44:47], v206 offset:8192
  s_waitcnt lgkmcnt(2)
  v_mfma_f32_32x32x16_bf16 v[240:255], a[132:135], v[36:39], v[240:255]
  s_waitcnt lgkmcnt(1)
  v_mfma_f32_32x32x16_bf16 v[240:255], a[136:139], v[40:43], v[240:255]
  s_waitcnt lgkmcnt(0)
  v_mfma_f32_32x32x16_bf16 v[240:255], a[140:143], v[44:47], v[240:255]
  s_nop 11
  v_cvt_pk_bf16_f32 v16, v240, v244
  v_cvt_pk_bf16_f32 v17, v241, v245
  v_cvt_pk_bf16_f32 v18, v242, v246
  v_cvt_pk_bf16_f32 v19, v243, v247
  ds_write_b128 v215, v[16:19] offset:0
  v_cvt_pk_bf16_f32 v20, v248, v252
  v_cvt_pk_bf16_f32 v21, v249, v253
  v_cvt_pk_bf16_f32 v22, v250, v254
  v_cvt_pk_bf16_f32 v23, v251, v255
  ds_write_b128 v215, v[20:23] offset:1024
  s_waitcnt lgkmcnt(0)
  s_barrier
  ds_read_b128 v[96:99], v208 offset:0
  ds_read_b128 v[100:103], v208 offset:1024
  ds_read_b128 v[104:107], v208 offset:2048
  ds_read_b128 v[108:111], v208 offset:3072
  ds_read_b128 v[112:115], v208 offset:4096
  ds_read_b128 v[116:119], v208 offset:5120
  ds_read_b128 v[120:123], v208 offset:6144
  ds_read_b128 v[124:127], v208 offset:7168
  s_waitcnt vmcnt(11)
  v_cmp_eq_u32 vcc, -1, v172
  s_mov_b32 s69, 0
  s_cbranch_vccnz AT_e0
  s_mov_b32 s69, 1
  buffer_load_dwordx4 v[172:175], v201, s[8:11], s76 offen sc1
AT_e0:
  s_waitcnt lgkmcnt(7)
  v_mfma_f32_32x32x16_bf16 v[64:79], v[128:131], v[96:99], v[48:63]
  s_waitcnt lgkmcnt(6)
  v_mfma_f32_32x32x16_bf16 v[64:79], v[132:135], v[100:103], v[64:79]
  s_waitcnt lgkmcnt(5)
  v_mfma_f32_32x32x16_bf16 v[64:79], v[136:139], v[104:107], v[64:79]
  s_waitcnt lgkmcnt(4)
  v_mfma_f32_32x32x16_bf16 v[64:79], v[140:143], v[108:111], v[64:79]
  s_waitcnt lgkmcnt(3)
  v_mfma_f32_32x32x16_bf16 v[64:79], v[144:147], v[112:115], v[64:79]
  s_waitcnt lgkmcnt(2)
  v_mfma_f32_32x32x16_bf16 v[64:79], v[148:151], v[116:119], v[64:79]
  s_waitcnt lgkmcnt(1)
  v_mfma_f32_32x32x16_bf16 v[64:79], v[152:155], v[120:123], v[64:79]
  s_waitcnt lgkmcnt(0)
  v_mfma_f32_32x32x16_bf16 v[64:79], v[156:159], v[124:127], v[64:79]
  s_nop 11
  v_max3_f32 v180, v64, v65, v66
  v_max3_f32 v180, v180, v67, v68
  v_max3_f32 v180, v180, v69, v70
  v_max3_f32 v180, v180, v71, v72
  v_max3_f32 v180, v180, v73, v74
  v_max3_f32 v180, v180, v75, v76
  v_max3_f32 v180, v180, v77, v78
  v_max_f32 v180, v180, v79
  v_mov_b32 v181, v180
  s_nop 1
  v_permlane32_swap_b32 v180, v181
  v_max_f32 v180, v180, v181
  v_sub_f32 v64, v64, v180
  v_sub_f32 v65, v65, v180
  v_sub_f32 v66, v66, v180
  v_sub_f32 v67, v67, v180
  v_sub_f32 v68, v68, v180
  v_sub_f32 v69, v69, v180
  v_sub_f32 v70, v70, v180
  v_sub_f32 v71, v71, v180
  v_sub_f32 v72, v72, v180
  v_sub_f32 v73, v73, v180
  v_sub_f32 v74, v74, v180
  v_sub_f32 v75, v75, v180
  v_sub_f32 v76, v76, v180
  v_sub_f32 v77, v77, v180
  v_sub_f32 v78, v78, v180
  v_sub_f32 v79, v79, v180
  v_exp_f32 v64, v64
  v_exp_f32 v65, v65
  v_exp_f32 v66, v66
  v_exp_f32 v67, v67
  v_exp_f32 v68, v68
  v_exp_f32 v69, v69
  v_exp_f32 v70, v70
  v_exp_f32 v71, v71
  v_exp_f32 v72, v72
  v_exp_f32 v73, v73
  v_exp_f32 v74, v74
  v_exp_f32 v75, v75
  v_exp_f32 v76, v76
  v_exp_f32 v77, v77
  v_exp_f32 v78, v78
  v_exp_f32 v79, v79
  v_cvt_pk_bf16_f32 v20, v64, v65
  v_cvt_pk_bf16_f32 v21, v68, v69
  v_cvt_pk_bf16_f32 v22, v72, v73
  v_cvt_pk_bf16_f32 v23, v76, v77
  v_cvt_pk_bf16_f32 v24, v66, v67
  v_cvt_pk_bf16_f32 v25, v70, v71
  v_cvt_pk_bf16_f32 v26, v74, v75
  v_cvt_pk_bf16_f32 v27, v78, v79
  v_mfma_f32_32x32x16_bf16 v[0:15], v[160:163], v[20:23], 0
  v_add_f32 v182, v64, v65
  v_add_f32 v182, v182, v66
  v_add_f32 v182, v182, v67
  v_add_f32 v182, v182, v68
  v_add_f32 v182, v182, v69
  v_add_f32 v182, v182, v70
  v_add_f32 v182, v182, v71
  v_mfma_f32_32x32x16_bf16 v[0:15], v[164:167], v[24:27], v[0:15]
  v_add_f32 v182, v182, v72
  v_add_f32 v182, v182, v73
  v_add_f32 v182, v182, v74
  v_add_f32 v182, v182, v75
  v_add_f32 v182, v182, v76
  v_add_f32 v182, v182, v77
  v_add_f32 v182, v182, v78
  v_add_f32 v182, v182, v79
AT_l1:
  s_cmp_eq_u32 s69, 1
  s_cbranch_scc1 AT_v1
  s_cmp_ge_u32 s77, 62
  s_cbranch_scc1 AT_k1
  s_branch AT_c1
AT_h1:
  s_sleep 2
AT_c1:
  buffer_load_dword v172, off, s[8:11], s70 sc1
  s_add_u32 s65, s65, 1
  s_cmp_lt_u32 s65, 131072
  s_cselect_b32 s54, -2, -1
  s_waitcnt vmcnt(0)
  v_cmp_lt_u32 vcc, s54, v172
  s_cbranch_vccnz AT_h1
AT_k1:
  buffer_load_dwordx4 v[172:175], v201, s[8:11], s76 offen sc1
AT_v1:
  s_mov_b32 s69, 0
  s_add_u32 s65, s65, 1
  s_cmp_lt_u32 s65, 131072
  s_cselect_b32 s54, -2, -1
  s_waitcnt vmcnt(0)
  ds_write_b64 v220, v[172:173] offset:4096
  ds_write_b64 v221, v[174:175] offset:4096
  v_max3_u32 v213, v172, v173, v174
  v_max_u32 v213, v213, v175
  v_cmp_lt_u32 vcc, s54, v213
  s_cbranch_vccnz AT_k1
  s_waitcnt lgkmcnt(0)
  s_barrier
  ds_read_b128 v[128:131], v218 offset:4096
  ds_read_b128 v[132:135], v218 offset:4352
  ds_read_b128 v[136:139], v218 offset:4608
  ds_read_b128 v[140:143], v218 offset:4864
  ds_read_b128 v[144:147], v218 offset:5120
  ds_read_b128 v[148:151], v218 offset:5376
  ds_read_b128 v[152:155], v218 offset:5632
  ds_read_b128 v[156:159], v218 offset:5888
  ds_read_b32 v168, v219 offset:4096
  ds_read_b32 v169, v219 offset:4224
  s_waitcnt lgkmcnt(9)
  v_mfma_f32_32x32x16_bf16 v[80:95], v[128:131], a[144:147], 0
  s_waitcnt lgkmcnt(8)
  v_mfma_f32_32x32x16_bf16 v[80:95], v[132:135], a[148:151], v[80:95]
  s_waitcnt lgkmcnt(7)
  v_mfma_f32_32x32x16_bf16 v[80:95], v[136:139], a[152:155], v[80:95]
  s_waitcnt lgkmcnt(6)
  v_mfma_f32_32x32x16_bf16 v[80:95], v[140:143], a[156:159], v[80:95]
  s_waitcnt lgkmcnt(5)
  v_mfma_f32_32x32x16_bf16 v[80:95], v[144:147], a[160:163], v[80:95]
  s_waitcnt lgkmcnt(4)
  v_mfma_f32_32x32x16_bf16 v[80:95], v[148:151], a[164:167], v[80:95]
  s_waitcnt lgkmcnt(3)
  v_mfma_f32_32x32x16_bf16 v[80:95], v[152:155], a[168:171], v[80:95]
  s_waitcnt lgkmcnt(2)
  v_mfma_f32_32x32x16_bf16 v[80:95], v[156:159], a[172:175], v[80:95]
  s_add_u32 s77, s77, 2
  v_mov_b32 v212, s77
  s_nop 9
  v_mul_f32 v80, s68, v80
  v_mul_f32 v81, s68, v81
  v_mul_f32 v82, s68, v82
  v_mul_f32 v83, s68, v83
  v_max3_f32 v84, v184, v80, v81
  v_max3_f32 v84, v84, v82, v83
  v_mov_b32 v85, v84
  s_nop 1
  v_permlane32_swap_b32 v84, v85
  v_max_f32 v84, v84, v85
  v_sub_f32 v86, v184, v84
  v_sub_f32 v80, v80, v84
  v_sub_f32 v81, v81, v84
  v_sub_f32 v82, v82, v84
  v_sub_f32 v83, v83, v84
  v_exp_f32 v86, v86
  v_exp_f32 v80, v80
  v_exp_f32 v81, v81
  v_exp_f32 v82, v82
  v_exp_f32 v83, v83
  v_fma_f32 v186, v186, v86, v80
  v_add_f32 v84, v81, v82
  v_add_f32 v186, v186, v83
  v_add_f32 v186, v186, v84
  v_mov_b32 v187, v186
  s_nop 1
  v_permlane32_swap_b32 v186, v187
  v_add_f32 v186, v186, v187
  v_rcp_f32 v186, v186
  s_nop 0
  v_mul_f32 v86, v86, v186
  v_mul_f32 v80, v186, v80
  v_mul_f32 v81, v186, v81
  v_mul_f32 v82, v186, v82
  v_mul_f32 v83, v186, v83
  v_cvt_pk_bf16_f32 v28, v80, v81
  v_cvt_pk_bf16_f32 v29, v82, v83
  v_mul_f32 v224, v86, v224
  v_mul_f32 v225, v86, v225
  v_mul_f32 v226, v86, v226
  v_mul_f32 v227, v86, v227
  v_mul_f32 v228, v86, v228
  v_mul_f32 v229, v86, v229
  v_mul_f32 v230, v86, v230
  v_mul_f32 v231, v86, v231
  v_mul_f32 v232, v86, v232
  v_mul_f32 v233, v86, v233
  v_mul_f32 v234, v86, v234
  v_mul_f32 v235, v86, v235
  v_mul_f32 v236, v86, v236
  v_mul_f32 v237, v86, v237
  v_mul_f32 v238, v86, v238
  v_mul_f32 v239, v86, v239
  s_waitcnt lgkmcnt(0)
  s_nop 0
  v_mfma_f32_32x32x8_bf16 v[224:239], v[168:169], v[28:29], v[224:239]
  s_nop 11
  v_cvt_pk_bf16_f32 v20, v224, v225
  v_cvt_pk_bf16_f32 v21, v226, v227
  v_cvt_pk_bf16_f32 v22, v228, v229
  v_cvt_pk_bf16_f32 v23, v230, v231
  buffer_store_dwordx4 v[20:23], v201, s[8:11], s75 offen offset:0 sc1
  v_cvt_pk_bf16_f32 v24, v232, v233
  v_cvt_pk_bf16_f32 v25, v234, v235
  v_cvt_pk_bf16_f32 v26, v236, v237
  v_cvt_pk_bf16_f32 v27, v238, v239
  buffer_store_dwordx4 v[24:27], v201, s[8:11], s75 offen offset:1024 sc1
  s_mov_b64 exec, 1
  buffer_store_dword v212, v201, s[8:11], s71 offen sc1
  s_mov_b64 exec, -1
  s_cmp_ge_u32 s77, 64
  s_cbranch_scc1 L_exit
  s_branch AT_loop
L_cexit:
L_exit:
L_end:
s_endpgm
.section .rodata,"a"
.p2align 6
.amdhsa_kernel gated_mix__sliding_local_dilated__memory_aug_recurrent_mem_tr__prompt_kernel
  .amdhsa_next_free_vgpr 512
  .amdhsa_next_free_sgpr 102
  .amdhsa_accum_offset 256
  .amdhsa_group_segment_fixed_size 0
  .amdhsa_kernarg_size 112
  .amdhsa_user_sgpr_count 2
  .amdhsa_user_sgpr_kernarg_segment_ptr 1
  .amdhsa_system_sgpr_workgroup_id_x 1
.end_amdhsa_kernel
```

```asm
; @launch grid=(256,1,1) block=(256,1,1) lds=163840
.amdgcn_target "amdgcn-amd-amdhsa--gfx950"
.text
.globl gated_mix__sliding_local_dilated__memory_aug_recurrent_mem_tr__prompt_kernel
.p2align 8
.type gated_mix__sliding_local_dilated__memory_aug_recurrent_mem_tr__prompt_kernel,@function
gated_mix__sliding_local_dilated__memory_aug_recurrent_mem_tr__prompt_kernel:
  s_cmp_ge_u32 s2, 256
  s_cbranch_scc1 L_end
  s_load_dwordx2 s[4:5], s[0:1], 0
  s_load_dwordx2 s[8:9], s[0:1], 104
  s_load_dwordx2 s[12:13], s[0:1], 96
  s_load_dwordx2 s[16:17], s[0:1], 40
  s_load_dwordx2 s[20:21], s[0:1], 48
  s_load_dwordx2 s[24:25], s[0:1], 56
  s_load_dwordx2 s[28:29], s[0:1], 64
  s_load_dwordx2 s[32:33], s[0:1], 32
  s_load_dwordx2 s[36:37], s[0:1], 8
  s_load_dwordx2 s[40:41], s[0:1], 16
  s_load_dwordx2 s[44:45], s[0:1], 80
  s_load_dwordx2 s[48:49], s[0:1], 88
  s_getreg_b32 s54, hwreg(HW_REG_XCC_ID, 0, 3)
  v_lshrrev_b32 v1, 6, v0
  s_nop 0
  v_readfirstlane_b32 s52, v1
  s_mov_b32 s6, 2359296
  s_mov_b32 s7, 0x20000
  s_mov_b32 s10, 268435456
  s_mov_b32 s11, 0x20000
  s_mov_b32 s14, 256
  s_mov_b32 s15, 0x20000
  s_mov_b32 s18, 4718592
  s_mov_b32 s19, 0x20000
  s_mov_b32 s22, 4718592
  s_mov_b32 s23, 0x20000
  s_mov_b32 s26, 4718592
  s_mov_b32 s27, 0x20000
  s_mov_b32 s30, 4718592
  s_mov_b32 s31, 0x20000
  s_mov_b32 s34, 9216
  s_mov_b32 s35, 0x20000
  s_mov_b32 s38, 1990656
  s_mov_b32 s39, 0x20000
  s_mov_b32 s42, 663552
  s_mov_b32 s43, 0x20000
  s_mov_b32 s46, 1152
  s_mov_b32 s47, 0x20000
  s_mov_b32 s50, 2359296
  s_mov_b32 s51, 0x20000
  s_waitcnt lgkmcnt(0)
  s_lshr_b32 s0, s2, 3
  s_mov_b32 s2, s54
  s_mov_b32 s1, 0
L_role:
  s_mov_b32 s53, s0
  s_cmp_eq_u32 s2, 0
  s_cbranch_scc0 L_worker
  v_and_b32 v0, 63, v0
  v_and_b32 v1, 15, v0
  v_lshrrev_b32 v2, 4, v0
  v_and_b32 v3, 1, v2
  s_lshl_b32 s54, s52, 1
  v_add_u32 v3, s54, v3
  v_lshlrev_b32 v3, 1, v3
  v_xor_b32 v3, v3, v1
  v_lshlrev_b32 v3, 4, v3
  v_lshl_add_u32 v8, v2, 13, v3
  s_lshl_b32 s78, s53, 8
  s_lshl_b32 s54, s52, 15
  s_add_u32 s78, s78, s54
  s_mul_i32 s79, s53, 147456
  s_lshl_b32 s57, s52, 10
  s_add_u32 s57, s57, 16384
  s_getpc_b64 s[80:81]
L_pc_1:
  s_and_b32 s55, s0, 1
  s_lshl_b32 s55, s55, 2
  s_add_u32 s55, s55, s52
  s_lshl_b32 s55, s55, 10
  v_and_b32 v199, 63, v0
  v_lshl_add_u32 v199, v199, 4, s55
  v_min_u32 v199, (L_w0 - L_pc_1), v199
  global_load_dword v196, v199, s[80:81]
  s_add_u32 m0, s57, 0
  s_add_u32 s54, s78, 0
  buffer_load_dwordx4 v8, s[16:19], s54 offen  lds
  s_add_u32 m0, s57, 4096
  s_add_u32 s54, s78, 131072
  buffer_load_dwordx4 v8, s[16:19], s54 offen  lds
  s_add_u32 m0, s57, 8192
  s_add_u32 s54, s78, 262144
  buffer_load_dwordx4 v8, s[16:19], s54 offen  lds
  s_add_u32 m0, s57, 12288
  s_add_u32 s54, s78, 393216
  buffer_load_dwordx4 v8, s[16:19], s54 offen  lds
  s_add_u32 m0, s57, 16384
  s_add_u32 s54, s78, 524288
  buffer_load_dwordx4 v8, s[16:19], s54 offen  lds
  s_add_u32 m0, s57, 20480
  s_add_u32 s54, s78, 655360
  buffer_load_dwordx4 v8, s[16:19], s54 offen  lds
  s_add_u32 m0, s57, 24576
  s_add_u32 s54, s78, 786432
  buffer_load_dwordx4 v8, s[16:19], s54 offen  lds
  s_add_u32 m0, s57, 28672
  s_add_u32 s54, s78, 917504
  buffer_load_dwordx4 v8, s[16:19], s54 offen  lds
  s_add_u32 m0, s57, 32768
  s_add_u32 s54, s78, 1048576
  buffer_load_dwordx4 v8, s[16:19], s54 offen  lds
  s_add_u32 m0, s57, 36864
  s_add_u32 s54, s78, 1179648
  buffer_load_dwordx4 v8, s[16:19], s54 offen  lds
  s_add_u32 m0, s57, 40960
  s_add_u32 s54, s78, 1310720
  buffer_load_dwordx4 v8, s[16:19], s54 offen  lds
  s_add_u32 m0, s57, 45056
  s_add_u32 s54, s78, 1441792
  buffer_load_dwordx4 v8, s[16:19], s54 offen  lds
  s_add_u32 m0, s57, 49152
  s_add_u32 s54, s78, 1572864
  buffer_load_dwordx4 v8, s[16:19], s54 offen  lds
  s_add_u32 m0, s57, 53248
  s_add_u32 s54, s78, 1703936
  buffer_load_dwordx4 v8, s[16:19], s54 offen  lds
  s_add_u32 m0, s57, 57344
  s_add_u32 s54, s78, 1835008
  buffer_load_dwordx4 v8, s[16:19], s54 offen  lds
  s_add_u32 m0, s57, 61440
  s_add_u32 s54, s78, 1966080
  buffer_load_dwordx4 v8, s[16:19], s54 offen  lds
  v_lshlrev_b32 v76, 4, v0
  v_add_u32 v75, 0x10000, v76
  v_lshrrev_b32 v3, 2, v1
  v_and_b32 v4, 1, v1
  v_lshl_add_u32 v3, v3, 1, v4
  v_bfe_u32 v4, v1, 1, 1
  v_mul_u32_u24 v74, 0xaaaa, v4
  v_add_u32 v74, 0x4444, v74
  v_mul_u32_u24 v5, 576, v3
  v_add_u32 v5, 0, v5
  v_lshl_add_u32 v78, v2, 4, v5
  v_lshl_add_u32 v77, v2, 5, v5
  v_lshl_add_u32 v77, v4, 4, v77
  v_mul_u32_u24 v15, 1152, v3
  v_lshl_add_u32 v15, v2, 5, v15
  v_lshl_add_u32 v15, v4, 4, v15
  s_lshl_b32 s54, s52, 8
  buffer_load_dwordx4 v[20:23], v15, s[32:35], s54 offen
  buffer_load_dwordx4 v[24:27], v15, s[32:35], s54 offen offset:128
  buffer_load_dwordx4 v[28:31], v15, s[32:35], 0 offen offset:1024
  v_mul_u32_u24 v79, 1152, v2
  v_lshl_add_u32 v79, v1, 2, v79
  s_lshl_b32 s54, s52, 6
  s_add_u32 s54, s54, 0
  v_add_u32 v79, s54, v79
  v_lshrrev_b32 v5, 3, v0
  v_mul_u32_u24 v68, 2176, v5
  v_and_b32 v5, 7, v0
  v_lshl_add_u32 v68, v5, 3, v68
  v_lshrrev_b32 v6, 3, v0
  s_lshr_b32 s54, s53, 2
  v_add_u32 v68, s54, v6
  v_and_b32 v68, 7, v68
  v_xor_b32 v68, v68, v6
  v_lshlrev_b32 v68, 8, v68
  v_lshl_add_u32 v68, v6, 12, v68
  v_lshl_add_u32 v68, v5, 3, v68
  s_and_b32 s54, s53, 3
  s_lshl_b32 s54, s54, 6
  v_add_u32 v68, s54, v68
  v_and_b32 v5, 1, v2
  v_lshlrev_b32 v5, 4, v5
  v_lshl_add_u32 v5, v1, 2, v5
  v_mov_b32 v6, 0x40000000
  v_cmp_lt_u32 vcc, 3, v1
  s_nop 1
  v_cndmask_b32 v5, v5, v6, vcc
  v_lshrrev_b32 v6, 1, v2
  v_lshl_add_u32 v69, v6, 10, v5
  v_lshl_add_u32 v70, v6, 8, v5
  v_mov_b32 v71, -1
  ds_write_b128 v76, v[68:71] offset:13824
  v_and_b32 v5, 3, v1
  v_lshrrev_b32 v6, 2, v1
  v_lshl_add_u32 v5, v5, 2, v6
  v_and_b32 v6, 1, v5
  v_lshlrev_b32 v6, 4, v6
  v_mov_b32 v7, 0x3f80
  v_lshlrev_b32 v6, v6, v7
  v_lshrrev_b32 v5, 1, v5
  v_cmp_eq_u32 vcc, 0, v5
  s_nop 1
  v_cndmask_b32 v40, 0, v6, vcc
  v_cmp_eq_u32 vcc, 1, v5
  s_nop 1
  v_cndmask_b32 v41, 0, v6, vcc
  v_cmp_eq_u32 vcc, 2, v5
  s_nop 1
  v_cndmask_b32 v42, 0, v6, vcc
  v_cmp_eq_u32 vcc, 3, v5
  s_nop 1
  v_cndmask_b32 v43, 0, v6, vcc
  ds_write_b128 v76, v[40:43] offset:14848
  s_and_b32 s54, s52, 1
  s_lshr_b32 s55, s52, 1
  v_lshrrev_b32 v3, 3, v0
  v_and_b32 v4, 1, v3
  v_lshlrev_b32 v4, 4, v4
  v_and_b32 v5, 6, v3
  v_add_u32 v4, v4, v5
  s_lshl_b32 s56, s55, 3
  s_add_u32 s56, s56, s54
  v_add_u32 v4, s56, v4
  v_mul_u32_u24 v4, 1152, v4
  v_and_b32 v5, 2, v3
  v_lshlrev_b32 v5, 1, v5
  v_and_b32 v6, 7, v0
  v_xor_b32 v6, v6, v5
  v_lshl_add_u32 v9, v6, 4, v4
  v_and_b32 v4, 1, v2
  v_lshlrev_b32 v4, 4, v4
  v_and_b32 v5, 2, v2
  v_add_u32 v4, v4, v5
  s_lshl_b32 s56, s55, 2
  s_add_u32 s56, s56, s54
  v_add_u32 v4, s56, v4
  v_mul_u32_u24 v4, 1152, v4
  v_lshlrev_b32 v6, 1, v2
  v_xor_b32 v6, v6, v1
  v_lshl_add_u32 v10, v6, 4, v4
  v_bfe_u32 v17, v1, 2, 1
  v_bfe_u32 v18, v1, 3, 1
  v_and_b32 v19, 1, v2
  v_lshrrev_b32 v72, 1, v2
  v_and_b32 v73, 3, v1
  v_lshl_add_u32 v3, v19, 1, v17
  v_lshl_add_u32 v6, v18, 2, v3
  v_lshl_add_u32 v4, v72, 4, v17
  v_lshl_add_u32 v4, v19, 2, v4
  v_lshl_add_u32 v4, v18, 3, v4
  v_lshlrev_b32 v4, 8, v4
  s_lshl_b32 s54, s52, 6
  v_lshl_add_u32 v5, v73, 3, s54
  v_lshlrev_b32 v7, 5, v6
  v_xor_b32 v5, v5, v7
  v_add_u32 v11, v4, v5
  v_xor_b32 v12, 32, v11
  v_lshl_add_u32 v4, v72, 2, v3
  v_lshlrev_b32 v4, 7, v4
  v_lshl_add_u32 v4, v73, 3, v4
  s_and_b32 s54, s52, 1
  v_xor_b32 v7, s54, v19
  v_lshl_add_u32 v7, v7, 1, v18
  v_lshl_add_u32 v13, v7, 5, v4
  v_lshlrev_b32 v4, 11, v72
  v_lshl_add_u32 v4, v73, 3, v4
  v_lshl_add_u32 v5, v3, 8, v4
  v_lshl_add_u32 v7, v18, 2, s52
  v_xor_b32 v7, v7, v3
  v_lshl_add_u32 v14, v7, 5, v5
  s_lshl_b32 s54, s53, 14
  s_lshl_b32 s55, s52, 11
  s_add_u32 s54, s54, 1048576
  s_add_u32 s58, s54, s55
  s_add_u32 s59, s58, 8192
  s_lshl_b32 s55, s52, 12
  s_add_u32 s70, s54, s55
  s_add_u32 s70, s70, 655360
  s_lshl_b32 s54, s53, 12
  s_lshl_b32 s55, s52, 10
  s_add_u32 s54, s54, s55
  s_add_u32 s68, s54, 917504
  s_lshl_b32 s54, s53, 6
  s_mul_i32 s55, s52, 17408
  s_add_u32 s55, s54, s55
  s_add_u32 s73, s55, 0
  s_add_u32 s74, s55, 69632
  s_add_u32 s75, s55, 139264
  s_add_u32 s76, s55, 208896
  s_and_b32 s56, s52, 1
  s_mul_i32 s55, s56, 17408
  s_add_u32 s55, s54, s55
  s_add_u32 s77, s55, 278528
  s_mul_i32 s54, s52, 69632
  s_mul_i32 s55, s53, 2176
  s_add_u32 s54, s54, s55
  s_add_u32 s60, s54, 0
  s_and_b32 s56, s53, 15
  s_mul_i32 s55, s56, 2176
  s_add_u32 s61, s55, 278528
  s_lshr_b32 s54, s52, 1
  s_lshl_b32 s54, s54, 15
  s_and_b32 s55, s52, 1
  s_lshl_b32 s55, s55, 11
  s_add_u32 s54, s54, s55
  s_add_u32 s73, s54, 0
  s_add_u32 s74, s54, 65536
  s_add_u32 s75, s54, 131072
  s_add_u32 s76, s54, 196608
  s_add_u32 s77, s55, 262144
  s_and_b32 s54, s53, 7
  s_lshl_b32 s54, s54, 12
  s_bfe_u32 s55, s53, 0x10003
  s_lshl_b32 s55, s55, 11
  s_add_u32 s54, s54, s55
  s_add_u32 s61, s54, 262144
  s_lshr_b32 s55, s53, 4
  s_lshl_b32 s55, s55, 15
  s_add_u32 s54, s54, s55
  s_lshl_b32 s55, s52, 16
  s_add_u32 s54, s54, s55
  s_add_u32 s60, s54, 0
  s_lshl_b32 s54, s52, 11
  s_add_u32 s64, s54, 360448
  s_mov_b32 s65, 368640
  s_lshl_b32 s55, s53, 5
  s_add_u32 s54, s54, s55
  s_add_u32 s62, s54, 376832
  s_lshr_b32 s54, s56, 3
  s_lshl_b32 s54, s54, 9
  s_and_b32 s55, s56, 7
  s_lshl_b32 s55, s55, 5
  s_add_u32 s54, s54, s55
  s_add_u32 s63, s54, 385024
  s_mov_b32 s66, 0
  s_mov_b32 s67, 0
  s_mov_b32 s72, 0
  s_mov_b32 s69, 1040356334
  s_waitcnt vmcnt(15) lgkmcnt(0)
  s_barrier
  s_add_u32 m0, s57, 65536
  s_add_u32 s54, s78, 2097152
  buffer_load_dwordx4 v8, s[16:19], s54 offen  lds
  s_add_u32 m0, s57, 69632
  s_add_u32 s54, s78, 2228224
  buffer_load_dwordx4 v8, s[16:19], s54 offen  lds
  s_add_u32 m0, s57, 73728
  s_add_u32 s54, s78, 2359296
  buffer_load_dwordx4 v8, s[16:19], s54 offen  lds
  s_add_u32 m0, s57, 77824
  s_add_u32 s54, s78, 2490368
  buffer_load_dwordx4 v8, s[16:19], s54 offen  lds
  s_lshl_b32 s55, s2, 2
  s_or_b32 s56, s52, s1
  s_cmp_eq_u32 s56, 0
  s_cselect_b32 s55, s55, 0x1000
  s_lshl_b32 s56, 1, s0
  v_mov_b32 v35, s56
  s_mov_b64 exec, 1
  buffer_atomic_or v35, off, s[12:15], s55 sc0
  s_mov_b64 exec, -1
  v_add_u32 v15, 16384, v11
  v_add_u32 v16, 16384, v12
  ds_read_b64_tr_b16 v[80:81], v15 offset:0
  ds_read_b64_tr_b16 v[82:83], v15 offset:512
  ds_read_b64_tr_b16 v[84:85], v15 offset:8192
  ds_read_b64_tr_b16 v[86:87], v15 offset:8704
  ds_read_b64_tr_b16 v[88:89], v16 offset:0
  ds_read_b64_tr_b16 v[90:91], v16 offset:512
  ds_read_b64_tr_b16 v[92:93], v16 offset:8192
  ds_read_b64_tr_b16 v[94:95], v16 offset:8704
  s_waitcnt vmcnt(16) lgkmcnt(0)
  s_barrier
  s_add_u32 m0, s57, 81920
  s_add_u32 s54, s78, 2621440
  buffer_load_dwordx4 v8, s[16:19], s54 offen  lds
  s_add_u32 m0, s57, 86016
  s_add_u32 s54, s78, 2752512
  buffer_load_dwordx4 v8, s[16:19], s54 offen  lds
  s_add_u32 m0, s57, 90112
  s_add_u32 s54, s78, 2883584
  buffer_load_dwordx4 v8, s[16:19], s54 offen  lds
  s_add_u32 m0, s57, 94208
  s_add_u32 s54, s78, 3014656
  buffer_load_dwordx4 v8, s[16:19], s54 offen  lds
  v_add_u32 v15, 32768, v11
  v_add_u32 v16, 32768, v12
  ds_read_b64_tr_b16 v[96:97], v15 offset:0
  ds_read_b64_tr_b16 v[98:99], v15 offset:512
  ds_read_b64_tr_b16 v[100:101], v15 offset:8192
  ds_read_b64_tr_b16 v[102:103], v15 offset:8704
  ds_read_b64_tr_b16 v[104:105], v16 offset:0
  ds_read_b64_tr_b16 v[106:107], v16 offset:512
  ds_read_b64_tr_b16 v[108:109], v16 offset:8192
  ds_read_b64_tr_b16 v[110:111], v16 offset:8704
  s_waitcnt vmcnt(16) lgkmcnt(0)
  s_barrier
  s_add_u32 m0, s57, 98304
  s_add_u32 s54, s78, 3670016
  buffer_load_dwordx4 v8, s[16:19], s54 offen  lds
  s_add_u32 m0, s57, 102400
  s_add_u32 s54, s78, 3801088
  buffer_load_dwordx4 v8, s[16:19], s54 offen  lds
  s_add_u32 m0, s57, 106496
  s_add_u32 s54, s78, 3932160
  buffer_load_dwordx4 v8, s[16:19], s54 offen  lds
  s_add_u32 m0, s57, 110592
  s_add_u32 s54, s78, 4063232
  buffer_load_dwordx4 v8, s[16:19], s54 offen  lds
  v_add_u32 v15, 49152, v11
  v_add_u32 v16, 49152, v12
  ds_read_b64_tr_b16 v[112:113], v15 offset:0
  ds_read_b64_tr_b16 v[114:115], v15 offset:512
  ds_read_b64_tr_b16 v[116:117], v15 offset:8192
  ds_read_b64_tr_b16 v[118:119], v15 offset:8704
  ds_read_b64_tr_b16 v[120:121], v16 offset:0
  ds_read_b64_tr_b16 v[122:123], v16 offset:512
  ds_read_b64_tr_b16 v[124:125], v16 offset:8192
  ds_read_b64_tr_b16 v[126:127], v16 offset:8704
  s_waitcnt vmcnt(16) lgkmcnt(0)
  s_barrier
  s_add_u32 m0, s57, 114688
  s_add_u32 s54, s78, 4194304
  buffer_load_dwordx4 v8, s[16:19], s54 offen  lds
  s_add_u32 m0, s57, 118784
  s_add_u32 s54, s78, 4325376
  buffer_load_dwordx4 v8, s[16:19], s54 offen  lds
  s_add_u32 m0, s57, 122880
  s_add_u32 s54, s78, 4456448
  buffer_load_dwordx4 v8, s[16:19], s54 offen  lds
  s_add_u32 m0, s57, 126976
  s_add_u32 s54, s78, 4587520
  buffer_load_dwordx4 v8, s[16:19], s54 offen  lds
  v_add_u32 v15, 65536, v11
  v_add_u32 v16, 65536, v12
  ds_read_b64_tr_b16 v[128:129], v15 offset:0
  ds_read_b64_tr_b16 v[130:131], v15 offset:512
  ds_read_b64_tr_b16 v[132:133], v15 offset:8192
  ds_read_b64_tr_b16 v[134:135], v15 offset:8704
  ds_read_b64_tr_b16 v[136:137], v16 offset:0
  ds_read_b64_tr_b16 v[138:139], v16 offset:512
  ds_read_b64_tr_b16 v[140:141], v16 offset:8192
  ds_read_b64_tr_b16 v[142:143], v16 offset:8704
  s_waitcnt vmcnt(13) lgkmcnt(0)
  s_barrier
  s_add_u32 m0, s57, 131072
  s_add_u32 s54, s78, 1048576
  buffer_load_dwordx4 v8, s[20:23], s54 offen  lds
  s_add_u32 m0, s57, 135168
  s_add_u32 s54, s78, 1179648
  buffer_load_dwordx4 v8, s[20:23], s54 offen  lds
  s_add_u32 m0, s57, 139264
  s_add_u32 s54, s78, 1310720
  buffer_load_dwordx4 v8, s[20:23], s54 offen  lds
  s_add_u32 m0, s57, 143360
  s_add_u32 s54, s78, 1441792
  buffer_load_dwordx4 v8, s[20:23], s54 offen  lds
  v_add_u32 v15, 81920, v11
  v_add_u32 v16, 81920, v12
  ds_read_b64_tr_b16 v[144:145], v15 offset:0
  ds_read_b64_tr_b16 v[146:147], v15 offset:512
  ds_read_b64_tr_b16 v[148:149], v15 offset:8192
  ds_read_b64_tr_b16 v[150:151], v15 offset:8704
  ds_read_b64_tr_b16 v[152:153], v16 offset:0
  ds_read_b64_tr_b16 v[154:155], v16 offset:512
  ds_read_b64_tr_b16 v[156:157], v16 offset:8192
  ds_read_b64_tr_b16 v[158:159], v16 offset:8704
  s_waitcnt vmcnt(12) lgkmcnt(0)
  s_barrier
  s_add_u32 m0, s57, 0
  s_add_u32 s54, s78, 1572864
  buffer_load_dwordx4 v8, s[20:23], s54 offen  lds
  s_add_u32 m0, s57, 4096
  s_add_u32 s54, s78, 1703936
  buffer_load_dwordx4 v8, s[20:23], s54 offen  lds
  s_add_u32 m0, s57, 8192
  s_add_u32 s54, s78, 1835008
  buffer_load_dwordx4 v8, s[20:23], s54 offen  lds
  s_add_u32 m0, s57, 12288
  s_add_u32 s54, s78, 1966080
  buffer_load_dwordx4 v8, s[20:23], s54 offen  lds
  v_add_u32 v15, 98304, v11
  v_add_u32 v16, 98304, v12
  ds_read_b64_tr_b16 v[160:161], v15 offset:0
  ds_read_b64_tr_b16 v[162:163], v15 offset:512
  ds_read_b64_tr_b16 v[164:165], v15 offset:8192
  ds_read_b64_tr_b16 v[166:167], v15 offset:8704
  ds_read_b64_tr_b16 v[168:169], v16 offset:0
  ds_read_b64_tr_b16 v[170:171], v16 offset:512
  ds_read_b64_tr_b16 v[172:173], v16 offset:8192
  ds_read_b64_tr_b16 v[174:175], v16 offset:8704
  s_waitcnt vmcnt(12) lgkmcnt(0)
  s_barrier
  s_add_u32 m0, s57, 16384
  s_add_u32 s54, s78, 3145728
  buffer_load_dwordx4 v8, s[20:23], s54 offen  lds
  s_add_u32 m0, s57, 20480
  s_add_u32 s54, s78, 3276800
  buffer_load_dwordx4 v8, s[20:23], s54 offen  lds
  s_add_u32 m0, s57, 24576
  s_add_u32 s54, s78, 3407872
  buffer_load_dwordx4 v8, s[20:23], s54 offen  lds
  s_add_u32 m0, s57, 28672
  s_add_u32 s54, s78, 3538944
  buffer_load_dwordx4 v8, s[20:23], s54 offen  lds
  v_add_u32 v15, 114688, v11
  v_add_u32 v16, 114688, v12
  ds_read_b64_tr_b16 v[176:177], v15 offset:0
  ds_read_b64_tr_b16 v[178:179], v15 offset:512
  ds_read_b64_tr_b16 v[180:181], v15 offset:8192
  ds_read_b64_tr_b16 v[182:183], v15 offset:8704
  ds_read_b64_tr_b16 v[184:185], v16 offset:0
  ds_read_b64_tr_b16 v[186:187], v16 offset:512
  ds_read_b64_tr_b16 v[188:189], v16 offset:8192
  ds_read_b64_tr_b16 v[190:191], v16 offset:8704
  s_waitcnt vmcnt(12) lgkmcnt(0)
  s_barrier
  s_add_u32 m0, s57, 32768
  s_add_u32 s54, s78, 3670016
  buffer_load_dwordx4 v8, s[20:23], s54 offen  lds
  s_add_u32 m0, s57, 36864
  s_add_u32 s54, s78, 3801088
  buffer_load_dwordx4 v8, s[20:23], s54 offen  lds
  s_add_u32 m0, s57, 40960
  s_add_u32 s54, s78, 3932160
  buffer_load_dwordx4 v8, s[20:23], s54 offen  lds
  s_add_u32 m0, s57, 45056
  s_add_u32 s54, s78, 4063232
  buffer_load_dwordx4 v8, s[20:23], s54 offen  lds
  v_add_u32 v15, 131072, v11
  v_add_u32 v16, 131072, v12
  ds_read_b64_tr_b16 v[192:193], v15 offset:0
  ds_read_b64_tr_b16 v[194:195], v15 offset:512
  ds_read_b64_tr_b16 v[196:197], v15 offset:8192
  ds_read_b64_tr_b16 v[198:199], v15 offset:8704
  ds_read_b64_tr_b16 v[200:201], v16 offset:0
  ds_read_b64_tr_b16 v[202:203], v16 offset:512
  ds_read_b64_tr_b16 v[204:205], v16 offset:8192
  ds_read_b64_tr_b16 v[206:207], v16 offset:8704
  s_waitcnt vmcnt(12) lgkmcnt(0)
  s_barrier
  s_add_u32 m0, s57, 49152
  s_add_u32 s54, s78, 4194304
  buffer_load_dwordx4 v8, s[20:23], s54 offen  lds
  s_add_u32 m0, s57, 53248
  s_add_u32 s54, s78, 4325376
  buffer_load_dwordx4 v8, s[20:23], s54 offen  lds
  s_add_u32 m0, s57, 57344
  s_add_u32 s54, s78, 4456448
  buffer_load_dwordx4 v8, s[20:23], s54 offen  lds
  s_add_u32 m0, s57, 61440
  s_add_u32 s54, s78, 4587520
  buffer_load_dwordx4 v8, s[20:23], s54 offen  lds
  s_getpc_b64 s[80:81]
  v_lshlrev_b32 v7, 2, v76
  global_load_dword v19, v7, s[80:81] offset:1024
  s_cmp_eq_u32 s1, 1
  s_cbranch_scc1 C_ver_ok
  v_mov_b32 v33, 16320
  s_cmp_eq_u32 s52, 0
  s_cbranch_scc0 C_ver_b
  s_waitcnt vmcnt(33)
  s_mov_b64 exec, 1
  ds_write_b32 v33, v35
  s_mov_b64 exec, -1
  s_waitcnt lgkmcnt(0)
C_ver_b:
  s_barrier
  ds_read_b32 v32, v33
  s_waitcnt lgkmcnt(0)
  v_readfirstlane_b32 s54, v32
  s_nop 0
  s_bitcmp1_b32 s54, s0
  s_cbranch_scc1 L_conf
C_ver_ok:
  v_min_u32 v20, -2, v20
  v_min_u32 v21, -2, v21
  v_min_u32 v22, -2, v22
  v_min_u32 v23, -2, v23
  v_min_u32 v24, -2, v24
  v_min_u32 v25, -2, v25
  v_min_u32 v26, -2, v26
  v_min_u32 v27, -2, v27
  v_min_u32 v28, -2, v28
  v_min_u32 v29, -2, v29
  v_min_u32 v30, -2, v30
  v_min_u32 v31, -2, v31
  s_lshl_b32 s54, s52, 11
  v_add_u32 v3, s54, v76
  ds_write_b128 v3, v[20:23] offset:4608
  ds_write_b128 v3, v[24:27] offset:5632
  ds_write_b128 v76, v[28:31] offset:12800
  v_add_u32 v15, 147456, v11
  v_add_u32 v16, 147456, v12
  ds_read_b64_tr_b16 v[208:209], v15 offset:0
  ds_read_b64_tr_b16 v[210:211], v15 offset:512
  ds_read_b64_tr_b16 v[212:213], v15 offset:8192
  ds_read_b64_tr_b16 v[214:215], v15 offset:8704
  ds_read_b64_tr_b16 v[216:217], v16 offset:0
  ds_read_b64_tr_b16 v[218:219], v16 offset:512
  ds_read_b64_tr_b16 v[220:221], v16 offset:8192
  ds_read_b64_tr_b16 v[222:223], v16 offset:8704
  s_waitcnt vmcnt(13) lgkmcnt(0)
  s_barrier
  s_add_u32 m0, s57, 65536
  s_add_u32 s54, s78, 0
  buffer_load_dwordx4 v8, s[24:27], s54 offen  lds
  s_add_u32 m0, s57, 69632
  s_add_u32 s54, s78, 131072
  buffer_load_dwordx4 v8, s[24:27], s54 offen  lds
  s_add_u32 m0, s57, 73728
  s_add_u32 s54, s78, 262144
  buffer_load_dwordx4 v8, s[24:27], s54 offen  lds
  s_add_u32 m0, s57, 77824
  s_add_u32 s54, s78, 393216
  buffer_load_dwordx4 v8, s[24:27], s54 offen  lds
  v_add_u32 v15, 16384, v11
  v_add_u32 v16, 16384, v12
  ds_read_b64_tr_b16 v[224:225], v15 offset:0
  ds_read_b64_tr_b16 v[226:227], v15 offset:512
  ds_read_b64_tr_b16 v[228:229], v15 offset:8192
  ds_read_b64_tr_b16 v[230:231], v15 offset:8704
  ds_read_b64_tr_b16 v[232:233], v16 offset:0
  ds_read_b64_tr_b16 v[234:235], v16 offset:512
  ds_read_b64_tr_b16 v[236:237], v16 offset:8192
  ds_read_b64_tr_b16 v[238:239], v16 offset:8704
  s_waitcnt vmcnt(13) lgkmcnt(0)
  s_barrier
  s_add_u32 m0, s57, 81920
  s_add_u32 s54, s78, 524288
  buffer_load_dwordx4 v8, s[24:27], s54 offen  lds
  s_add_u32 m0, s57, 86016
  s_add_u32 s54, s78, 655360
  buffer_load_dwordx4 v8, s[24:27], s54 offen  lds
  s_add_u32 m0, s57, 90112
  s_add_u32 s54, s78, 786432
  buffer_load_dwordx4 v8, s[24:27], s54 offen  lds
  s_add_u32 m0, s57, 94208
  s_add_u32 s54, s78, 917504
  buffer_load_dwordx4 v8, s[24:27], s54 offen  lds
  v_add_u32 v15, 32768, v11
  v_add_u32 v16, 32768, v12
  ds_read_b64_tr_b16 v[240:241], v15 offset:0
  ds_read_b64_tr_b16 v[242:243], v15 offset:512
  ds_read_b64_tr_b16 v[244:245], v15 offset:8192
  ds_read_b64_tr_b16 v[246:247], v15 offset:8704
  ds_read_b64_tr_b16 v[248:249], v16 offset:0
  ds_read_b64_tr_b16 v[250:251], v16 offset:512
  ds_read_b64_tr_b16 v[252:253], v16 offset:8192
  ds_read_b64_tr_b16 v[254:255], v16 offset:8704
  s_waitcnt vmcnt(13) lgkmcnt(0)
  s_barrier
  s_add_u32 m0, s57, 98304
  s_add_u32 s54, s78, 1048576
  buffer_load_dwordx4 v8, s[24:27], s54 offen  lds
  s_add_u32 m0, s57, 102400
  s_add_u32 s54, s78, 1179648
  buffer_load_dwordx4 v8, s[24:27], s54 offen  lds
  s_add_u32 m0, s57, 106496
  s_add_u32 s54, s78, 1310720
  buffer_load_dwordx4 v8, s[24:27], s54 offen  lds
  s_add_u32 m0, s57, 110592
  s_add_u32 s54, s78, 1441792
  buffer_load_dwordx4 v8, s[24:27], s54 offen  lds
  v_add_u32 v15, 49152, v11
  v_add_u32 v16, 49152, v12
  ds_read_b64_tr_b16 a[0:1], v15 offset:0
  ds_read_b64_tr_b16 a[2:3], v15 offset:512
  ds_read_b64_tr_b16 a[4:5], v15 offset:8192
  ds_read_b64_tr_b16 a[6:7], v15 offset:8704
  ds_read_b64_tr_b16 a[8:9], v16 offset:0
  ds_read_b64_tr_b16 a[10:11], v16 offset:512
  ds_read_b64_tr_b16 a[12:13], v16 offset:8192
  ds_read_b64_tr_b16 a[14:15], v16 offset:8704
  s_waitcnt vmcnt(13) lgkmcnt(0)
  s_barrier
  s_add_u32 m0, s57, 114688
  s_add_u32 s54, s78, 1572864
  buffer_load_dwordx4 v8, s[24:27], s54 offen  lds
  s_add_u32 m0, s57, 118784
  s_add_u32 s54, s78, 1703936
  buffer_load_dwordx4 v8, s[24:27], s54 offen  lds
  s_add_u32 m0, s57, 122880
  s_add_u32 s54, s78, 1835008
  buffer_load_dwordx4 v8, s[24:27], s54 offen  lds
  s_add_u32 m0, s57, 126976
  s_add_u32 s54, s78, 1966080
  buffer_load_dwordx4 v8, s[24:27], s54 offen  lds
  v_add_u32 v15, 65536, v11
  v_add_u32 v16, 65536, v12
  ds_read_b64_tr_b16 a[16:17], v15 offset:0
  ds_read_b64_tr_b16 a[18:19], v15 offset:512
  ds_read_b64_tr_b16 a[20:21], v15 offset:8192
  ds_read_b64_tr_b16 a[22:23], v15 offset:8704
  ds_read_b64_tr_b16 a[24:25], v16 offset:0
  ds_read_b64_tr_b16 a[26:27], v16 offset:512
  ds_read_b64_tr_b16 a[28:29], v16 offset:8192
  ds_read_b64_tr_b16 a[30:31], v16 offset:8704
  s_waitcnt vmcnt(12) lgkmcnt(0)
  s_barrier
  s_add_u32 m0, s57, 131072
  s_add_u32 s54, s78, 2097152
  buffer_load_dwordx4 v8, s[24:27], s54 offen  lds
  s_add_u32 m0, s57, 135168
  s_add_u32 s54, s78, 2228224
  buffer_load_dwordx4 v8, s[24:27], s54 offen  lds
  s_add_u32 m0, s57, 139264
  s_add_u32 s54, s78, 2359296
  buffer_load_dwordx4 v8, s[24:27], s54 offen  lds
  s_add_u32 m0, s57, 143360
  s_add_u32 s54, s78, 2490368
  buffer_load_dwordx4 v8, s[24:27], s54 offen  lds
  v_add_u32 v15, 81920, v11
  v_add_u32 v16, 81920, v12
  ds_read_b64_tr_b16 a[32:33], v15 offset:0
  ds_read_b64_tr_b16 a[34:35], v15 offset:512
  ds_read_b64_tr_b16 a[36:37], v15 offset:8192
  ds_read_b64_tr_b16 a[38:39], v15 offset:8704
  ds_read_b64_tr_b16 a[40:41], v16 offset:0
  ds_read_b64_tr_b16 a[42:43], v16 offset:512
  ds_read_b64_tr_b16 a[44:45], v16 offset:8192
  ds_read_b64_tr_b16 a[46:47], v16 offset:8704
  s_waitcnt vmcnt(12) lgkmcnt(0)
  s_barrier
  s_add_u32 m0, s57, 0
  s_add_u32 s54, s78, 2621440
  buffer_load_dwordx4 v8, s[24:27], s54 offen  lds
  s_add_u32 m0, s57, 4096
  s_add_u32 s54, s78, 2752512
  buffer_load_dwordx4 v8, s[24:27], s54 offen  lds
  s_add_u32 m0, s57, 8192
  s_add_u32 s54, s78, 2883584
  buffer_load_dwordx4 v8, s[24:27], s54 offen  lds
  s_add_u32 m0, s57, 12288
  s_add_u32 s54, s78, 3014656
  buffer_load_dwordx4 v8, s[24:27], s54 offen  lds
  s_getpc_b64 s[80:81]
  v_lshlrev_b32 v7, 2, v76
  global_load_dword v19, v7, s[80:81] offset:1024
  v_add_u32 v15, 98304, v11
  v_add_u32 v16, 98304, v12
  ds_read_b64_tr_b16 a[48:49], v15 offset:0
  ds_read_b64_tr_b16 a[50:51], v15 offset:512
  ds_read_b64_tr_b16 a[52:53], v15 offset:8192
  ds_read_b64_tr_b16 a[54:55], v15 offset:8704
  ds_read_b64_tr_b16 a[56:57], v16 offset:0
  ds_read_b64_tr_b16 a[58:59], v16 offset:512
  ds_read_b64_tr_b16 a[60:61], v16 offset:8192
  ds_read_b64_tr_b16 a[62:63], v16 offset:8704
  s_waitcnt vmcnt(13) lgkmcnt(0)
  s_barrier
  s_add_u32 m0, s57, 16384
  s_add_u32 s54, s78, 3145728
  buffer_load_dwordx4 v8, s[24:27], s54 offen  lds
  s_add_u32 m0, s57, 20480
  s_add_u32 s54, s78, 3276800
  buffer_load_dwordx4 v8, s[24:27], s54 offen  lds
  s_add_u32 m0, s57, 24576
  s_add_u32 s54, s78, 3407872
  buffer_load_dwordx4 v8, s[24:27], s54 offen  lds
  s_add_u32 m0, s57, 28672
  s_add_u32 s54, s78, 3538944
  buffer_load_dwordx4 v8, s[24:27], s54 offen  lds
  v_add_u32 v15, 114688, v11
  v_add_u32 v16, 114688, v12
  ds_read_b64_tr_b16 a[64:65], v15 offset:0
  ds_read_b64_tr_b16 a[66:67], v15 offset:512
  ds_read_b64_tr_b16 a[68:69], v15 offset:8192
  ds_read_b64_tr_b16 a[70:71], v15 offset:8704
  ds_read_b64_tr_b16 a[72:73], v16 offset:0
  ds_read_b64_tr_b16 a[74:75], v16 offset:512
  ds_read_b64_tr_b16 a[76:77], v16 offset:8192
  ds_read_b64_tr_b16 a[78:79], v16 offset:8704
  s_waitcnt vmcnt(13) lgkmcnt(0)
  s_barrier
  s_add_u32 m0, s57, 32768
  s_add_u32 s54, s78, 3670016
  buffer_load_dwordx4 v8, s[24:27], s54 offen  lds
  s_add_u32 m0, s57, 36864
  s_add_u32 s54, s78, 3801088
  buffer_load_dwordx4 v8, s[24:27], s54 offen  lds
  s_add_u32 m0, s57, 40960
  s_add_u32 s54, s78, 3932160
  buffer_load_dwordx4 v8, s[24:27], s54 offen  lds
  s_add_u32 m0, s57, 45056
  s_add_u32 s54, s78, 4063232
  buffer_load_dwordx4 v8, s[24:27], s54 offen  lds
  v_add_u32 v15, 131072, v11
  v_add_u32 v16, 131072, v12
  ds_read_b64_tr_b16 a[80:81], v15 offset:0
  ds_read_b64_tr_b16 a[82:83], v15 offset:512
  ds_read_b64_tr_b16 a[84:85], v15 offset:8192
  ds_read_b64_tr_b16 a[86:87], v15 offset:8704
  ds_read_b64_tr_b16 a[88:89], v16 offset:0
  ds_read_b64_tr_b16 a[90:91], v16 offset:512
  ds_read_b64_tr_b16 a[92:93], v16 offset:8192
  ds_read_b64_tr_b16 a[94:95], v16 offset:8704
  s_waitcnt vmcnt(13) lgkmcnt(0)
  s_barrier
  s_add_u32 m0, s57, 49152
  s_add_u32 s54, s78, 4194304
  buffer_load_dwordx4 v8, s[24:27], s54 offen  lds
  s_add_u32 m0, s57, 53248
  s_add_u32 s54, s78, 4325376
  buffer_load_dwordx4 v8, s[24:27], s54 offen  lds
  s_add_u32 m0, s57, 57344
  s_add_u32 s54, s78, 4456448
  buffer_load_dwordx4 v8, s[24:27], s54 offen  lds
  s_add_u32 m0, s57, 61440
  s_add_u32 s54, s78, 4587520
  buffer_load_dwordx4 v8, s[24:27], s54 offen  lds
  v_add_u32 v15, 147456, v11
  v_add_u32 v16, 147456, v12
  ds_read_b64_tr_b16 a[96:97], v15 offset:0
  ds_read_b64_tr_b16 a[98:99], v15 offset:512
  ds_read_b64_tr_b16 a[100:101], v15 offset:8192
  ds_read_b64_tr_b16 a[102:103], v15 offset:8704
  ds_read_b64_tr_b16 a[104:105], v16 offset:0
  ds_read_b64_tr_b16 a[106:107], v16 offset:512
  ds_read_b64_tr_b16 a[108:109], v16 offset:8192
  ds_read_b64_tr_b16 a[110:111], v16 offset:8704
  s_waitcnt vmcnt(13) lgkmcnt(0)
  s_barrier
  s_add_u32 m0, s57, 65536
  s_add_u32 s54, s79, 73728
  buffer_load_dwordx4 v10, s[28:31], s54 offen  lds
  s_add_u32 m0, s57, 69632
  s_add_u32 s54, s79, 82944
  buffer_load_dwordx4 v10, s[28:31], s54 offen  lds
  s_add_u32 m0, s57, 73728
  s_add_u32 s54, s79, 110592
  buffer_load_dwordx4 v10, s[28:31], s54 offen  lds
  s_add_u32 m0, s57, 77824
  s_add_u32 s54, s79, 119808
  buffer_load_dwordx4 v10, s[28:31], s54 offen  lds
  v_add_u32 v15, 16384, v11
  v_add_u32 v16, 16384, v12
  ds_read_b64_tr_b16 a[112:113], v15 offset:0
  ds_read_b64_tr_b16 a[114:115], v15 offset:512
  ds_read_b64_tr_b16 a[116:117], v15 offset:8192
  ds_read_b64_tr_b16 a[118:119], v15 offset:8704
  ds_read_b64_tr_b16 a[120:121], v16 offset:0
  ds_read_b64_tr_b16 a[122:123], v16 offset:512
  ds_read_b64_tr_b16 a[124:125], v16 offset:8192
  ds_read_b64_tr_b16 a[126:127], v16 offset:8704
  s_waitcnt vmcnt(12) lgkmcnt(0)
  s_barrier
  s_add_u32 m0, s57, 81920
  s_add_u32 s54, s79, 256
  buffer_load_dwordx4 v10, s[28:31], s54 offen  lds
  s_add_u32 m0, s57, 86016
  s_add_u32 s54, s79, 9472
  buffer_load_dwordx4 v10, s[28:31], s54 offen  lds
  s_add_u32 m0, s57, 90112
  s_add_u32 s54, s79, 37120
  buffer_load_dwordx4 v10, s[28:31], s54 offen  lds
  s_add_u32 m0, s57, 94208
  s_add_u32 s54, s79, 46336
  buffer_load_dwordx4 v10, s[28:31], s54 offen  lds
  v_add_u32 v15, 32768, v11
  v_add_u32 v16, 32768, v12
  ds_read_b64_tr_b16 a[128:129], v15 offset:0
  ds_read_b64_tr_b16 a[130:131], v15 offset:512
  ds_read_b64_tr_b16 a[132:133], v15 offset:8192
  ds_read_b64_tr_b16 a[134:135], v15 offset:8704
  ds_read_b64_tr_b16 a[136:137], v16 offset:0
  ds_read_b64_tr_b16 a[138:139], v16 offset:512
  ds_read_b64_tr_b16 a[140:141], v16 offset:8192
  ds_read_b64_tr_b16 a[142:143], v16 offset:8704
  s_waitcnt vmcnt(12) lgkmcnt(0)
  s_barrier
  s_add_u32 m0, s57, 98304
  s_add_u32 s54, s79, 512
  buffer_load_dwordx4 v10, s[28:31], s54 offen  lds
  s_add_u32 m0, s57, 102400
  s_add_u32 s54, s79, 9728
  buffer_load_dwordx4 v10, s[28:31], s54 offen  lds
  s_add_u32 m0, s57, 106496
  s_add_u32 s54, s79, 37376
  buffer_load_dwordx4 v10, s[28:31], s54 offen  lds
  s_add_u32 m0, s57, 110592
  s_add_u32 s54, s79, 46592
  buffer_load_dwordx4 v10, s[28:31], s54 offen  lds
  s_getpc_b64 s[80:81]
  v_lshlrev_b32 v7, 2, v76
  global_load_dword v19, v7, s[80:81] offset:1024
  v_add_u32 v15, 49152, v11
  v_add_u32 v16, 49152, v12
  ds_read_b64_tr_b16 a[144:145], v15 offset:0
  ds_read_b64_tr_b16 a[146:147], v15 offset:512
  ds_read_b64_tr_b16 a[148:149], v15 offset:8192
  ds_read_b64_tr_b16 a[150:151], v15 offset:8704
  ds_read_b64_tr_b16 a[152:153], v16 offset:0
  ds_read_b64_tr_b16 a[154:155], v16 offset:512
  ds_read_b64_tr_b16 a[156:157], v16 offset:8192
  ds_read_b64_tr_b16 a[158:159], v16 offset:8704
  s_waitcnt vmcnt(13) lgkmcnt(0)
  s_barrier
  s_add_u32 m0, s57, 114688
  s_add_u32 s54, s79, 768
  buffer_load_dwordx4 v10, s[28:31], s54 offen  lds
  s_add_u32 m0, s57, 118784
  s_add_u32 s54, s79, 9984
  buffer_load_dwordx4 v10, s[28:31], s54 offen  lds
  s_add_u32 m0, s57, 122880
  s_add_u32 s54, s79, 37632
  buffer_load_dwordx4 v10, s[28:31], s54 offen  lds
  s_add_u32 m0, s57, 126976
  s_add_u32 s54, s79, 46848
  buffer_load_dwordx4 v10, s[28:31], s54 offen  lds
  v_add_u32 v15, 65536, v11
  v_add_u32 v16, 65536, v12
  ds_read_b64_tr_b16 a[160:161], v15 offset:0
  ds_read_b64_tr_b16 a[162:163], v15 offset:512
  ds_read_b64_tr_b16 a[164:165], v15 offset:8192
  ds_read_b64_tr_b16 a[166:167], v15 offset:8704
  ds_read_b64_tr_b16 a[168:169], v16 offset:0
  ds_read_b64_tr_b16 a[170:171], v16 offset:512
  ds_read_b64_tr_b16 a[172:173], v16 offset:8192
  ds_read_b64_tr_b16 a[174:175], v16 offset:8704
  s_waitcnt vmcnt(13) lgkmcnt(0)
  s_barrier
  s_add_u32 m0, s57, 131072
  s_add_u32 s54, s79, 74496
  buffer_load_dwordx4 v10, s[28:31], s54 offen  lds
  s_add_u32 m0, s57, 135168
  s_add_u32 s54, s79, 83712
  buffer_load_dwordx4 v10, s[28:31], s54 offen  lds
  s_add_u32 m0, s57, 139264
  s_add_u32 s54, s79, 111360
  buffer_load_dwordx4 v10, s[28:31], s54 offen  lds
  s_add_u32 m0, s57, 143360
  s_add_u32 s54, s79, 120576
  buffer_load_dwordx4 v10, s[28:31], s54 offen  lds
  v_add_u32 v15, 81920, v14
  ds_read_b64_tr_b16 a[176:177], v15 offset:0
  ds_read_b64_tr_b16 a[178:179], v15 offset:1024
  ds_read_b64_tr_b16 a[180:181], v15 offset:4096
  ds_read_b64_tr_b16 a[182:183], v15 offset:5120
  ds_read_b64_tr_b16 a[184:185], v15 offset:8192
  ds_read_b64_tr_b16 a[186:187], v15 offset:9216
  ds_read_b64_tr_b16 a[188:189], v15 offset:12288
  ds_read_b64_tr_b16 a[190:191], v15 offset:13312
  s_waitcnt vmcnt(13) lgkmcnt(0)
  s_barrier
  s_add_u32 m0, s57, 0
  s_add_u32 s54, s78, 0
  buffer_load_dwordx4 v8, s[20:23], s54 offen  lds
  s_add_u32 m0, s57, 4096
  s_add_u32 s54, s78, 131072
  buffer_load_dwordx4 v8, s[20:23], s54 offen  lds
  s_add_u32 m0, s57, 8192
  s_add_u32 s54, s78, 262144
  buffer_load_dwordx4 v8, s[20:23], s54 offen  lds
  s_add_u32 m0, s57, 12288
  s_add_u32 s54, s78, 393216
  buffer_load_dwordx4 v8, s[20:23], s54 offen  lds
  v_add_u32 v15, 98304, v14
  ds_read_b64_tr_b16 a[192:193], v15 offset:0
  ds_read_b64_tr_b16 a[194:195], v15 offset:1024
  ds_read_b64_tr_b16 a[196:197], v15 offset:4096
  ds_read_b64_tr_b16 a[198:199], v15 offset:5120
  ds_read_b64_tr_b16 a[200:201], v15 offset:8192
  ds_read_b64_tr_b16 a[202:203], v15 offset:9216
  ds_read_b64_tr_b16 a[204:205], v15 offset:12288
  ds_read_b64_tr_b16 a[206:207], v15 offset:13312
  s_waitcnt vmcnt(13) lgkmcnt(0)
  s_barrier
  s_add_u32 m0, s57, 16384
  s_add_u32 s54, s78, 524288
  buffer_load_dwordx4 v8, s[20:23], s54 offen  lds
  s_add_u32 m0, s57, 20480
  s_add_u32 s54, s78, 655360
  buffer_load_dwordx4 v8, s[20:23], s54 offen  lds
  s_add_u32 m0, s57, 24576
  s_add_u32 s54, s78, 786432
  buffer_load_dwordx4 v8, s[20:23], s54 offen  lds
  s_add_u32 m0, s57, 28672
  s_add_u32 s54, s78, 917504
  buffer_load_dwordx4 v8, s[20:23], s54 offen  lds
  v_add_u32 v15, 114688, v14
  ds_read_b64_tr_b16 a[208:209], v15 offset:0
  ds_read_b64_tr_b16 a[210:211], v15 offset:1024
  ds_read_b64_tr_b16 a[212:213], v15 offset:4096
  ds_read_b64_tr_b16 a[214:215], v15 offset:5120
  ds_read_b64_tr_b16 a[216:217], v15 offset:8192
  ds_read_b64_tr_b16 a[218:219], v15 offset:9216
  ds_read_b64_tr_b16 a[220:221], v15 offset:12288
  ds_read_b64_tr_b16 a[222:223], v15 offset:13312
  s_waitcnt vmcnt(12) lgkmcnt(0)
  s_barrier
  s_add_u32 m0, s57, 32768
  s_add_u32 s54, s78, 2097152
  buffer_load_dwordx4 v8, s[20:23], s54 offen  lds
  s_add_u32 m0, s57, 36864
  s_add_u32 s54, s78, 2228224
  buffer_load_dwordx4 v8, s[20:23], s54 offen  lds
  s_add_u32 m0, s57, 40960
  s_add_u32 s54, s78, 2359296
  buffer_load_dwordx4 v8, s[20:23], s54 offen  lds
  s_add_u32 m0, s57, 45056
  s_add_u32 s54, s78, 2490368
  buffer_load_dwordx4 v8, s[20:23], s54 offen  lds
  v_add_u32 v15, 131072, v14
  ds_read_b64_tr_b16 a[224:225], v15 offset:0
  ds_read_b64_tr_b16 a[226:227], v15 offset:1024
  ds_read_b64_tr_b16 a[228:229], v15 offset:4096
  ds_read_b64_tr_b16 a[230:231], v15 offset:5120
  ds_read_b64_tr_b16 a[232:233], v15 offset:8192
  ds_read_b64_tr_b16 a[234:235], v15 offset:9216
  ds_read_b64_tr_b16 a[236:237], v15 offset:12288
  ds_read_b64_tr_b16 a[238:239], v15 offset:13312
  s_waitcnt vmcnt(12) lgkmcnt(0)
  s_barrier
  s_add_u32 m0, s57, 49152
  s_add_u32 s54, s78, 3145728
  buffer_load_dwordx4 v8, s[16:19], s54 offen  lds
  s_add_u32 m0, s57, 53248
  s_add_u32 s54, s78, 3276800
  buffer_load_dwordx4 v8, s[16:19], s54 offen  lds
  s_add_u32 m0, s57, 57344
  s_add_u32 s54, s78, 3407872
  buffer_load_dwordx4 v8, s[16:19], s54 offen  lds
  s_add_u32 m0, s57, 61440
  s_add_u32 s54, s78, 3538944
  buffer_load_dwordx4 v8, s[16:19], s54 offen  lds
  v_add_u32 v15, 147456, v14
  ds_read_b64_tr_b16 a[240:241], v15 offset:0
  ds_read_b64_tr_b16 a[242:243], v15 offset:1024
  ds_read_b64_tr_b16 a[244:245], v15 offset:4096
  ds_read_b64_tr_b16 a[246:247], v15 offset:5120
  ds_read_b64_tr_b16 a[248:249], v15 offset:8192
  ds_read_b64_tr_b16 a[250:251], v15 offset:9216
  ds_read_b64_tr_b16 a[252:253], v15 offset:12288
  ds_read_b64_tr_b16 a[254:255], v15 offset:13312
  s_waitcnt vmcnt(12) lgkmcnt(0)
  s_barrier
  s_add_u32 m0, s57, 65536
  s_add_u32 s54, s78, 2621440
  buffer_load_dwordx4 v8, s[20:23], s54 offen  lds
  s_add_u32 m0, s57, 69632
  s_add_u32 s54, s78, 2752512
  buffer_load_dwordx4 v8, s[20:23], s54 offen  lds
  s_add_u32 m0, s57, 73728
  s_add_u32 s54, s78, 2883584
  buffer_load_dwordx4 v8, s[20:23], s54 offen  lds
  s_add_u32 m0, s57, 77824
  s_add_u32 s54, s78, 3014656
  buffer_load_dwordx4 v8, s[20:23], s54 offen  lds
  v_add_u32 v15, 16384, v11
  v_add_u32 v16, 16384, v12
  ds_read_b64_tr_b16 v[52:53], v15 offset:0
  ds_read_b64_tr_b16 v[54:55], v15 offset:512
  ds_read_b64_tr_b16 v[56:57], v15 offset:8192
  ds_read_b64_tr_b16 v[58:59], v15 offset:8704
  ds_read_b64_tr_b16 v[60:61], v16 offset:0
  ds_read_b64_tr_b16 v[62:63], v16 offset:512
  ds_read_b64_tr_b16 v[64:65], v16 offset:8192
  ds_read_b64_tr_b16 v[66:67], v16 offset:8704
  s_waitcnt vmcnt(12) lgkmcnt(0)
  s_barrier
  s_lshl_b32 s54, s52, 12
  s_add_u32 s54, s54, 16384
  v_add_u32 v7, s54, v76
  ds_write_b128 v7, v[52:55] offset:0
  ds_write_b128 v7, v[56:59] offset:1024
  ds_write_b128 v7, v[60:63] offset:2048
  ds_write_b128 v7, v[64:67] offset:3072
  s_add_u32 m0, s57, 81920
  s_add_u32 s54, s79, 1024
  buffer_load_dwordx4 v9, s[28:31], s54 offen  lds
  s_add_u32 m0, s57, 86016
  s_add_u32 s54, s79, 37888
  buffer_load_dwordx4 v9, s[28:31], s54 offen  lds
  s_add_u32 m0, s57, 90112
  s_add_u32 s54, s79, 74752
  buffer_load_dwordx4 v9, s[28:31], s54 offen  lds
  s_add_u32 m0, s57, 94208
  s_add_u32 s54, s79, 111616
  buffer_load_dwordx4 v9, s[28:31], s54 offen  lds
  v_add_u32 v15, 32768, v11
  v_add_u32 v16, 32768, v12
  ds_read_b64_tr_b16 v[36:37], v15 offset:0
  ds_read_b64_tr_b16 v[38:39], v15 offset:512
  ds_read_b64_tr_b16 v[40:41], v15 offset:8192
  ds_read_b64_tr_b16 v[42:43], v15 offset:8704
  ds_read_b64_tr_b16 v[44:45], v16 offset:0
  ds_read_b64_tr_b16 v[46:47], v16 offset:512
  ds_read_b64_tr_b16 v[48:49], v16 offset:8192
  ds_read_b64_tr_b16 v[50:51], v16 offset:8704
  s_waitcnt vmcnt(12) lgkmcnt(0)
  s_barrier
  s_lshl_b32 s54, s52, 12
  s_add_u32 s54, s54, 32768
  v_add_u32 v7, s54, v76
  ds_write_b128 v7, v[36:39] offset:0
  ds_write_b128 v7, v[40:43] offset:1024
  ds_write_b128 v7, v[44:47] offset:2048
  ds_write_b128 v7, v[48:51] offset:3072
  s_add_u32 m0, s57, 98304
  s_add_u32 s54, s79, 0
  buffer_load_dwordx4 v10, s[28:31], s54 offen  lds
  s_add_u32 m0, s57, 102400
  s_add_u32 s54, s79, 9216
  buffer_load_dwordx4 v10, s[28:31], s54 offen  lds
  s_add_u32 m0, s57, 106496
  s_add_u32 s54, s79, 36864
  buffer_load_dwordx4 v10, s[28:31], s54 offen  lds
  s_add_u32 m0, s57, 110592
  s_add_u32 s54, s79, 46080
  buffer_load_dwordx4 v10, s[28:31], s54 offen  lds
  v_add_u32 v15, 49152, v11
  v_add_u32 v16, 49152, v12
  ds_read_b64_tr_b16 v[52:53], v15 offset:0
  ds_read_b64_tr_b16 v[54:55], v15 offset:512
  ds_read_b64_tr_b16 v[56:57], v15 offset:8192
  ds_read_b64_tr_b16 v[58:59], v15 offset:8704
  ds_read_b64_tr_b16 v[60:61], v16 offset:0
  ds_read_b64_tr_b16 v[62:63], v16 offset:512
  ds_read_b64_tr_b16 v[64:65], v16 offset:8192
  ds_read_b64_tr_b16 v[66:67], v16 offset:8704
  s_waitcnt vmcnt(12) lgkmcnt(0)
  s_barrier
  s_lshl_b32 s54, s52, 12
  s_add_u32 s54, s54, 49152
  v_add_u32 v7, s54, v76
  ds_write_b128 v7, v[52:55] offset:0
  ds_write_b128 v7, v[56:59] offset:1024
  ds_write_b128 v7, v[60:63] offset:2048
  ds_write_b128 v7, v[64:67] offset:3072
  s_add_u32 m0, s57, 114688
  s_add_u32 s54, s79, 73984
  buffer_load_dwordx4 v10, s[28:31], s54 offen  lds
  s_add_u32 m0, s57, 118784
  s_add_u32 s54, s79, 83200
  buffer_load_dwordx4 v10, s[28:31], s54 offen  lds
  s_add_u32 m0, s57, 122880
  s_add_u32 s54, s79, 110848
  buffer_load_dwordx4 v10, s[28:31], s54 offen  lds
  s_add_u32 m0, s57, 126976
  s_add_u32 s54, s79, 120064
  buffer_load_dwordx4 v10, s[28:31], s54 offen  lds
  v_add_u32 v15, 65536, v11
  v_add_u32 v16, 65536, v12
  ds_read_b64_tr_b16 v[36:37], v15 offset:0
  ds_read_b64_tr_b16 v[38:39], v15 offset:512
  ds_read_b64_tr_b16 v[40:41], v15 offset:8192
  ds_read_b64_tr_b16 v[42:43], v15 offset:8704
  ds_read_b64_tr_b16 v[44:45], v16 offset:0
  ds_read_b64_tr_b16 v[46:47], v16 offset:512
  ds_read_b64_tr_b16 v[48:49], v16 offset:8192
  ds_read_b64_tr_b16 v[50:51], v16 offset:8704
  s_waitcnt vmcnt(12) lgkmcnt(0)
  s_barrier
  s_lshl_b32 s54, s52, 12
  s_add_u32 s54, s54, 65536
  v_add_u32 v7, s54, v76
  ds_write_b128 v7, v[36:39] offset:0
  ds_write_b128 v7, v[40:43] offset:1024
  ds_write_b128 v7, v[44:47] offset:2048
  ds_write_b128 v7, v[48:51] offset:3072
  s_add_u32 m0, s57, 131072
  s_add_u32 s54, s79, 74240
  buffer_load_dwordx4 v10, s[28:31], s54 offen  lds
  s_add_u32 m0, s57, 135168
  s_add_u32 s54, s79, 83456
  buffer_load_dwordx4 v10, s[28:31], s54 offen  lds
  s_add_u32 m0, s57, 139264
  s_add_u32 s54, s79, 111104
  buffer_load_dwordx4 v10, s[28:31], s54 offen  lds
  s_add_u32 m0, s57, 143360
  s_add_u32 s54, s79, 120320
  buffer_load_dwordx4 v10, s[28:31], s54 offen  lds
  v_lshlrev_b32 v7, 3, v76
  s_lshl_b32 s54, s52, 13
  s_add_u32 s54, s54, 360448
  s_bitcmp1_b32 s52, 0
  s_cselect_b64 exec, 0xff, -1
  buffer_load_dword v35, v7, s[8:11], s54 offen sc1
  s_mov_b64 exec, -1
  s_getpc_b64 s[80:81]
C_pc:
  s_mov_b32 s55, (L_w0 - C_pc)
  s_cmp_eq_u32 s52, 1
  s_cselect_b32 s55, (L_w1 - C_pc), s55
  s_cmp_eq_u32 s52, 2
  s_cselect_b32 s55, (L_w2 - C_pc), s55
  s_cmp_eq_u32 s52, 3
  s_cselect_b32 s55, (L_w3 - C_pc), s55
  v_lshl_add_u32 v7, v76, 3, s55
  global_load_dword v35, v7, s[80:81]
  v_add_u32 v15, 81920, v11
  v_add_u32 v16, 81920, v12
  ds_read_b64_tr_b16 v[52:53], v15 offset:0
  ds_read_b64_tr_b16 v[54:55], v15 offset:512
  ds_read_b64_tr_b16 v[56:57], v15 offset:8192
  ds_read_b64_tr_b16 v[58:59], v15 offset:8704
  ds_read_b64_tr_b16 v[60:61], v16 offset:0
  ds_read_b64_tr_b16 v[62:63], v16 offset:512
  ds_read_b64_tr_b16 v[64:65], v16 offset:8192
  ds_read_b64_tr_b16 v[66:67], v16 offset:8704
  s_waitcnt vmcnt(14) lgkmcnt(0)
  s_barrier
  s_lshl_b32 s54, s52, 12
  s_add_u32 s54, s54, 81920
  v_add_u32 v7, s54, v76
  ds_write_b128 v7, v[52:55] offset:0
  ds_write_b128 v7, v[56:59] offset:1024
  ds_write_b128 v7, v[60:63] offset:2048
  ds_write_b128 v7, v[64:67] offset:3072
  v_lshrrev_b32 v20, 2, v76
  buffer_load_dword v21, v20, s[12:15], 0 offen sc1
  v_add_u32 v15, 98304, v13
  s_waitcnt lgkmcnt(0)
  ds_read_b64_tr_b16 v[36:37], v15 offset:0
  ds_read_b64_tr_b16 v[38:39], v15 offset:1024
  ds_read_b64_tr_b16 v[40:41], v15 offset:2048
  ds_read_b64_tr_b16 v[42:43], v15 offset:3072
  ds_read_b64_tr_b16 v[44:45], v15 offset:4096
  ds_read_b64_tr_b16 v[46:47], v15 offset:5120
  ds_read_b64_tr_b16 v[48:49], v15 offset:6144
  ds_read_b64_tr_b16 v[50:51], v15 offset:7168
  ds_read_b64_tr_b16 v[52:53], v15 offset:8192
  ds_read_b64_tr_b16 v[54:55], v15 offset:9216
  ds_read_b64_tr_b16 v[56:57], v15 offset:10240
  ds_read_b64_tr_b16 v[58:59], v15 offset:11264
  ds_read_b64_tr_b16 v[60:61], v15 offset:12288
  ds_read_b64_tr_b16 v[62:63], v15 offset:13312
  ds_read_b64_tr_b16 v[64:65], v15 offset:14336
  ds_read_b64_tr_b16 v[66:67], v15 offset:15360
  s_waitcnt vmcnt(11) lgkmcnt(0)
  s_barrier
  s_and_b32 s54, s52, 1
  s_lshl_b32 s54, s54, 13
  s_add_u32 s54, s54, 98304
  v_add_u32 v7, s54, v76
  ds_write_b128 v7, v[36:39] offset:0
  ds_write_b128 v7, v[40:43] offset:1024
  ds_write_b128 v7, v[44:47] offset:2048
  ds_write_b128 v7, v[48:51] offset:3072
  ds_write_b128 v7, v[52:55] offset:4096
  ds_write_b128 v7, v[56:59] offset:5120
  ds_write_b128 v7, v[60:63] offset:6144
  ds_write_b128 v7, v[64:67] offset:7168
  v_add_u32 v15, 114688, v14
  ds_read_b64_tr_b16 v[52:53], v15 offset:0
  ds_read_b64_tr_b16 v[54:55], v15 offset:1024
  ds_read_b64_tr_b16 v[56:57], v15 offset:4096
  ds_read_b64_tr_b16 v[58:59], v15 offset:5120
  ds_read_b64_tr_b16 v[60:61], v15 offset:8192
  ds_read_b64_tr_b16 v[62:63], v15 offset:9216
  ds_read_b64_tr_b16 v[64:65], v15 offset:12288
  ds_read_b64_tr_b16 v[66:67], v15 offset:13312
  s_waitcnt vmcnt(7) lgkmcnt(0)
  s_barrier
  s_lshl_b32 s54, s52, 12
  s_add_u32 s54, s54, 114688
  v_add_u32 v7, s54, v76
  ds_write_b128 v7, v[52:55] offset:0
  ds_write_b128 v7, v[56:59] offset:1024
  ds_write_b128 v7, v[60:63] offset:2048
  ds_write_b128 v7, v[64:67] offset:3072
  v_add_u32 v15, 131072, v14
  ds_read_b64_tr_b16 v[36:37], v15 offset:0
  ds_read_b64_tr_b16 v[38:39], v15 offset:1024
  ds_read_b64_tr_b16 v[40:41], v15 offset:4096
  ds_read_b64_tr_b16 v[42:43], v15 offset:5120
  ds_read_b64_tr_b16 v[44:45], v15 offset:8192
  ds_read_b64_tr_b16 v[46:47], v15 offset:9216
  ds_read_b64_tr_b16 v[48:49], v15 offset:12288
  ds_read_b64_tr_b16 v[50:51], v15 offset:13312
  s_waitcnt vmcnt(3) lgkmcnt(0)
  s_barrier
  s_lshl_b32 s54, s52, 12
  s_add_u32 s54, s54, 131072
  v_add_u32 v7, s54, v76
  ds_write_b128 v7, v[36:39] offset:0
  ds_write_b128 v7, v[40:43] offset:1024
  ds_write_b128 v7, v[44:47] offset:2048
  ds_write_b128 v7, v[48:51] offset:3072
  v_add_u32 v15, 147456, v14
  ds_read_b64_tr_b16 v[52:53], v15 offset:0
  ds_read_b64_tr_b16 v[54:55], v15 offset:1024
  ds_read_b64_tr_b16 v[56:57], v15 offset:4096
  ds_read_b64_tr_b16 v[58:59], v15 offset:5120
  ds_read_b64_tr_b16 v[60:61], v15 offset:8192
  ds_read_b64_tr_b16 v[62:63], v15 offset:9216
  ds_read_b64_tr_b16 v[64:65], v15 offset:12288
  ds_read_b64_tr_b16 v[66:67], v15 offset:13312
  s_waitcnt vmcnt(0) lgkmcnt(0)
  s_barrier
  s_lshl_b32 s54, s52, 12
  s_add_u32 s54, s54, 147456
  v_add_u32 v7, s54, v76
  ds_write_b128 v7, v[52:55] offset:0
  ds_write_b128 v7, v[56:59] offset:1024
  ds_write_b128 v7, v[60:63] offset:2048
  ds_write_b128 v7, v[64:67] offset:3072
  s_waitcnt lgkmcnt(0)
  s_branch C_rd1
C_rd0:
  s_sleep 2
  buffer_load_dword v21, v20, s[12:15], 0 offen sc1
  s_waitcnt vmcnt(0)
C_rd1:
  v_and_b32 v22, 0xff, v21
  v_cmp_gt_u32 vcc, 7, v22
  v_readlane_b32 s56, v21, 0
  s_mov_b32 s3, 1
  s_add_u32 s67, s67, 1
  s_cmp_ge_u32 s67, 131072
  s_cbranch_scc1 C_rd2
  s_cmp_lg_u32 vcc_hi, 0
  s_cbranch_scc1 C_rd0
  s_mov_b32 s3, 0
  s_cmp_eq_u32 s56, -1
  s_cbranch_scc1 C_rd2
  s_mov_b32 s3, 1
  v_readlane_b32 s54, v21, 10
  v_readlane_b32 s55, v21, 0
  s_nop 0
  s_bcnt1_i32_b32 s55, s55
  s_add_u32 s54, s54, s55
  v_readlane_b32 s55, v21, 1
  s_nop 0
  s_bcnt1_i32_b32 s55, s55
  s_add_u32 s54, s54, s55
  v_readlane_b32 s55, v21, 2
  s_nop 0
  s_bcnt1_i32_b32 s55, s55
  s_add_u32 s54, s54, s55
  v_readlane_b32 s55, v21, 3
  s_nop 0
  s_bcnt1_i32_b32 s55, s55
  s_add_u32 s54, s54, s55
  v_readlane_b32 s55, v21, 4
  s_nop 0
  s_bcnt1_i32_b32 s55, s55
  s_add_u32 s54, s54, s55
  v_readlane_b32 s55, v21, 5
  s_nop 0
  s_bcnt1_i32_b32 s55, s55
  s_add_u32 s54, s54, s55
  v_readlane_b32 s55, v21, 6
  s_nop 0
  s_bcnt1_i32_b32 s55, s55
  s_add_u32 s54, s54, s55
  v_readlane_b32 s55, v21, 7
  s_nop 0
  s_bcnt1_i32_b32 s55, s55
  s_add_u32 s54, s54, s55
  s_cmp_lt_u32 s54, 256
  s_cbranch_scc1 C_rd0
C_rd2:
  s_lshl_b32 s54, s3, 2
  s_add_u32 s54, s54, s52
  s_cmp_eq_u32 s54, 1
  s_cbranch_scc1 L_w1
  s_cmp_eq_u32 s54, 2
  s_cbranch_scc1 L_w2
  s_cmp_eq_u32 s54, 3
  s_cbranch_scc1 L_w3
  s_cmp_eq_u32 s54, 4
  s_cbranch_scc1 L_w4
  s_cmp_eq_u32 s54, 5
  s_cbranch_scc1 L_w5
  s_cmp_eq_u32 s54, 6
  s_cbranch_scc1 L_w6
  s_cmp_eq_u32 s54, 7
  s_cbranch_scc1 L_w7
L_w0:
  v_mov_b64 v[20:21], 0
  v_mov_b64 v[22:23], 0
  v_mov_b64 v[24:25], 0
  v_mov_b64 v[26:27], 0
  v_mov_b64 v[28:29], 0
  v_mov_b64 v[30:31], 0
  v_mov_b64 v[32:33], 0
  v_mov_b64 v[34:35], 0
  s_mov_b32 s78, 0x3f803f80
  s_mov_b32 s79, s78
  s_mov_b32 s65, 360448
  s_mov_b32 m0, 16128
  s_lshl_b32 s71, s53, 2
  s_add_u32 s71, s71, 128
  s_movk_i32 s56, 0x1000
  v_lshlrev_b32 v73, 2, v76
  v_mov_b32 v72, 0
  s_mov_b64 s[16:17], s[8:9]
  s_mov_b32 s18, 268435456
  s_mov_b32 s19, 0x20000
  s_getpc_b64 s[20:21]
Cf0_pc:
  s_add_u32 s20, s20, (Cf0_last - Cf0_pc)
  s_addc_u32 s21, s21, 0
  v_mov_b32 v68, 14880
  buffer_load_dwordx4 v[52:55], v76, s[8:11], s59 offen offset:0 sc1
  buffer_load_dwordx4 v[56:59], v76, s[8:11], s59 offen offset:1024 sc1
  ds_read_b128 v[36:39], v76 offset:16384
  ds_read_b128 v[40:43], v76 offset:17408
  ds_read_b128 v[60:63], v76 offset:18432
  ds_read_b128 v[64:67], v76 offset:19456
  ds_read_b128 v[0:3], v76 offset:4608
  ds_read_b128 v[4:7], v76 offset:5632
  ds_read_b128 v[8:11], v76 offset:6656
  ds_read_b128 v[12:15], v76 offset:7680
  s_waitcnt lgkmcnt(0)
  s_cmp_eq_u32 s66, 1
  s_branch Cf0_top2
.p2align 6
Cf0_h2:
  s_cmp_eq_u32 s66, 12
  s_cselect_b32 s56, s71, 0x1000
  ds_read_b32 v72, v76 offset:16128
  s_cmp_eq_u32 s66, 13
  s_cselect_b32 s54, 0x700, 0
  s_waitcnt lgkmcnt(0)
  v_readfirstlane_b32 s57, v72
  s_nop 0
  s_cmp_lt_u32 s57, s54
  s_cbranch_scc1 Cf0_kv3
Cf0_kvb:
  buffer_load_dwordx4 v[0:3], v76, s[8:11], s65 offen offset:0 sc1
  ds_read_b128 v[36:39], v76 offset:16384
  s_waitcnt lgkmcnt(0)
  v_mov_b64 v[20:21], 0
  v_mov_b64 v[22:23], 0
  v_mov_b64 v[24:25], 0
  v_mov_b64 v[26:27], 0
  v_mov_b32 v68, 14880
  buffer_load_dwordx4 v[0:3], v76, s[8:11], s65 offen offset:0 sc1
  ds_read_b128 v[40:43], v76 offset:17408
  s_waitcnt lgkmcnt(0)
  v_mov_b64 v[28:29], 0
  v_mov_b64 v[30:31], 0
  v_mov_b64 v[32:33], 0
  v_mov_b64 v[34:35], 0
  v_lshlrev_b32 v73, 2, v76
  buffer_load_dwordx4 v[0:3], v76, s[8:11], s65 offen offset:0 sc1
  ds_read_b128 v[60:63], v76 offset:18432
  s_waitcnt lgkmcnt(0)
  buffer_load_dwordx4 v[52:55], v76, s[8:11], s59 offen offset:0 sc1
  buffer_load_dwordx4 v[56:59], v76, s[8:11], s59 offen offset:1024 sc1
  s_waitcnt vmcnt(4)
  v_max3_u32 v72, v0, v1, v2
  v_max_u32 v72, v72, v3
  ds_write_b128 v76, v[0:3] offset:4608
  v_cmp_eq_u32 vcc, -1, v72
  s_cbranch_vccnz Cf0_h2r
Cf0_h2w:
  s_cmp_eq_u32 s66, 63
  s_waitcnt lgkmcnt(0)
  s_barrier
  ds_read_b128 v[8:11], v76 offset:6656
  buffer_load_dwordx4 v76, s[8:11], s85 offen offset:0 sc1 lds
Cf0_top2:
  v_smfmac_f32_16x16x64_bf16 v[20:23], v[0:3], v[80:87], v74
  s_cbranch_scc1 Cf0_last
  v_smfmac_f32_16x16x64_bf16 v[28:31], v[0:3], v[36:43], v74
  buffer_load_dwordx4 v[44:47], v76, s[8:11], s58 offen offset:0 sc1
  s_mov_b32 m0, 16128
  v_smfmac_f32_16x16x64_bf16 v[24:27], v[0:3], v[88:95], v74
  buffer_load_dwordx4 v[48:51], v76, s[8:11], s58 offen offset:1024 sc1
  v_smfmac_f32_16x16x64_bf16 v[32:35], v[0:3], v[60:67], v74
  ds_read_b128 v[4:7], v76 offset:5632
  s_waitcnt lgkmcnt(1)
  v_smfmac_f32_16x16x64_bf16 v[20:23], v[8:11], v[112:119], v74
  ds_read_b128 v[12:15], v76 offset:7680
  v_smfmac_f32_16x16x64_bf16 v[24:27], v[8:11], v[120:127], v74
  ds_read_b128 v[36:39], v76 offset:32768
  v_smfmac_f32_16x16x64_bf16 v[28:31], v[8:11], v[208:215], v74
  buffer_store_dwordx4 v[16:19], v76, s[8:11], s68 offen sc1
  ds_read_b128 v[40:43], v76 offset:33792
  v_smfmac_f32_16x16x64_bf16 v[32:35], v[8:11], v[216:223], v74
  buffer_load_dword v73, s[16:19], s70 offen lds
  ds_read_b128 v[60:63], v76 offset:34816
  s_waitcnt lgkmcnt(4)
  v_smfmac_f32_16x16x64_bf16 v[20:23], v[4:7], v[96:103], v74
  ds_read_b128 v[64:67], v76 offset:35840
  v_smfmac_f32_16x16x64_bf16 v[24:27], v[4:7], v[104:111], v74
  s_waitcnt vmcnt(5)
  s_waitcnt lgkmcnt(4)
  v_smfmac_f32_16x16x64_bf16 v[20:23], v[12:15], v[128:135], v74
  s_barrier
  ds_read_b128 v[0:3], v76 offset:8704
  s_waitcnt lgkmcnt(3)
  v_smfmac_f32_16x16x64_bf16 v[28:31], v[4:7], v[36:43], v74
  ds_read_b128 v[36:39], v76 offset:49152
  v_smfmac_f32_16x16x64_bf16 v[24:27], v[12:15], v[136:143], v74
  ds_read_b128 v[40:43], v76 offset:50176
  s_waitcnt lgkmcnt(3)
  v_smfmac_f32_16x16x64_bf16 v[32:35], v[4:7], v[60:67], v74
  ds_read_b128 v[8:11], v76 offset:9728
  v_smfmac_f32_16x16x64_bf16 v[28:31], v[12:15], v[224:231], v74
  ds_read_b128 v[60:63], v76 offset:51200
  v_smfmac_f32_16x16x64_bf16 v[32:35], v[12:15], v[232:239], v74
  s_waitcnt vmcnt(4)
  ds_read_b128 v[64:67], v76 offset:52224
  s_waitcnt lgkmcnt(5)
  v_smfmac_f32_16x16x64_bf16 v[20:23], v[0:3], v[144:151], v74
  s_barrier
  ds_read_b128 v[4:7], v76 offset:11776
  s_waitcnt lgkmcnt(4)
  v_smfmac_f32_16x16x64_bf16 v[28:31], v[0:3], v[36:43], v74
  ds_read_b128 v[12:15], v76 offset:12800
  ds_read_b128 v[36:39], v75 offset:0
  v_smfmac_f32_16x16x64_bf16 v[24:27], v[0:3], v[152:159], v74
  ds_read_b128 v[16:19], v76 offset:10752
  s_waitcnt lgkmcnt(6)
  v_smfmac_f32_16x16x64_bf16 v[20:23], v[8:11], v[160:167], v74
  ds_read_b128 v[40:43], v75 offset:1024
  s_waitcnt lgkmcnt(5)
  v_smfmac_f32_16x16x64_bf16 v[32:35], v[0:3], v[60:67], v74
  ds_read_b128 v[60:63], v75 offset:2048
  v_smfmac_f32_16x16x64_bf16 v[24:27], v[8:11], v[168:175], v74
  ds_read_b128 v[64:67], v75 offset:3072
  s_waitcnt lgkmcnt(6)
  v_smfmac_f32_16x16x64_bf16 v[20:23], v[4:7], v[176:183], v74
  buffer_load_dword off, s[12:15], s56 sc1 lds
  s_waitcnt lgkmcnt(5)
  v_smfmac_f32_16x16x64_bf16 v[20:23], v[12:15], v[192:199], v74
  s_waitcnt lgkmcnt(2)
  v_smfmac_f32_16x16x64_bf16 v[20:23], v[16:19], v[36:43], v74
  ds_read_b128 v[36:39], v75 offset:16384
  v_smfmac_f32_16x16x64_bf16 v[24:27], v[4:7], v[184:191], v74
  ds_read_b128 v[40:43], v75 offset:17408
  s_waitcnt lgkmcnt(2)
  v_smfmac_f32_16x16x64_bf16 v[24:27], v[16:19], v[60:67], v74
  ds_read_b128 v[60:63], v75 offset:18432
  v_add_f32 v20, v20, v22
  v_smfmac_f32_16x16x64_bf16 v[24:27], v[12:15], v[200:207], v74
  ds_read_b128 v[64:67], v75 offset:19456
  v_add_f32 v21, v21, v23
  v_smfmac_f32_16x16x64_bf16 v[28:31], v[16:19], v[240:247], v74
  v_mov_b64 v[70:71], s[78:79]
  v_smfmac_f32_16x16x64_bf16 v[28:31], v[4:7], a[0:7], v74
  s_waitcnt lgkmcnt(2)
  v_add_f32 v24, v24, v26
  v_smfmac_f32_16x16x64_bf16 v[28:31], v[8:11], v[36:43], v74
  ds_read_b128 v[36:39], v68
  v_cvt_pk_bf16_f32 v22, v20, v24
  v_smfmac_f32_16x16x64_bf16 v[28:31], v[12:15], a[16:23], v74
  ds_read_b128 v[40:43], v68
  ds_write_b32 v79, v22 offset:0
  s_waitcnt lgkmcnt(3)
  v_add_f32 v25, v25, v27
  v_cvt_pk_bf16_f32 v23, v21, v25
  v_smfmac_f32_16x16x64_bf16 v[32:35], v[8:11], v[60:67], v74
  ds_write_b32 v79, v23 offset:576
  v_cmp_u_f32 vcc, v20, v21
  v_smfmac_f32_16x16x64_bf16 v[32:35], v[16:19], v[248:255], v74
  v_add_f32 v28, v28, v30
  v_smfmac_f32_16x16x64_bf16 v[32:35], v[4:7], a[8:15], v74
  v_add_f32 v29, v29, v31
  v_smfmac_f32_16x16x64_bf16 v[32:35], v[12:15], a[24:31], v74
  s_cbranch_vccnz Cf0_rec
Cf0_recok:
  s_waitcnt lgkmcnt(3)
  v_smfmac_f32_16x16x64_bf16 v[36:39], v[16:19], a[128:135], v74
  s_waitcnt lgkmcnt(0)
  s_barrier
  ds_read_b128 v[60:63], v77
  v_smfmac_f32_16x16x64_bf16 v[40:43], v[16:19], a[136:143], v74
  ds_read_b128 v[64:67], v77 offset:128
  v_add_f32 v32, v32, v34
  v_cvt_pk_bf16_f32 v30, v28, v32
  v_smfmac_f32_16x16x64_bf16 v[36:39], v[0:3], a[96:103], v74
  ds_write_b32 v79, v30 offset:256
  v_add_f32 v33, v33, v35
  v_cvt_pk_bf16_f32 v31, v29, v33
  v_smfmac_f32_16x16x64_bf16 v[40:43], v[0:3], a[104:111], v74
  ds_write_b32 v79, v31 offset:832
  v_xor_b32 v75, 0x8000, v75
  v_smfmac_f32_16x16x64_bf16 v[36:39], v[4:7], a[144:151], v74
  ds_read_b128 v[0:3], v76 offset:4608
  v_mov_b32 v29, 0
  v_smfmac_f32_16x16x64_bf16 v[40:43], v[4:7], a[152:159], v74
  s_waitcnt vmcnt(3) lgkmcnt(3)
  v_mov_b32 v30, 0
  v_mfma_f32_16x16x32_bf16 v[44:47], v[44:47], v[60:63], 0
  ds_read_b128 v[4:7], v76 offset:5632
  s_waitcnt lgkmcnt(2)
  v_mfma_f32_16x16x32_bf16 v[44:47], v[48:51], v[64:67], v[44:47]
  s_barrier
  v_smfmac_f32_16x16x64_bf16 v[36:39], v[8:11], a[112:119], v74
  ds_read_b128 v[20:23], v77 offset:256
  ds_read_b128 v[24:27], v77 offset:384
  v_smfmac_f32_16x16x64_bf16 v[40:43], v[8:11], a[120:127], v74
  ds_read_b128 v[8:11], v76 offset:6656
  v_add_f32_dpp v72, v46, v44 quad_perm:[2,3,0,1] row_mask:0xf bank_mask:0xf
  v_add_f32_dpp v73, v47, v45 quad_perm:[2,3,0,1] row_mask:0xf bank_mask:0xf
  v_smfmac_f32_16x16x64_bf16 v[36:39], v[12:15], a[160:167], v74
  s_waitcnt lgkmcnt(4)
  v_exp_f32_dpp v72, v72 quad_perm:[0,1,0,1] row_mask:0xf bank_mask:0xf
  v_smfmac_f32_16x16x64_bf16 v[40:43], v[12:15], a[168:175], v74
  ds_read_b128 v[12:15], v76 offset:7680
  v_exp_f32_dpp v73, v73 quad_perm:[0,1,0,1] row_mask:0xf bank_mask:0xf
  v_smfmac_f32_16x16x64_bf16 v[36:39], v[0:3], a[32:39], v74
  s_waitcnt lgkmcnt(2)
  v_cvt_pk_bf16_f32 v72, v72, v73
  v_mfma_f32_16x16x32_bf16 v[20:23], v[20:23], v[60:63], 0
  ds_write_b32 v78, v72 offset:512
  v_mov_b64 v[16:17], 0
  v_mfma_f32_16x16x32_bf16 v[20:23], v[24:27], v[64:67], v[20:23]
  ds_read_b128 v[44:47], v75 offset:16384
  v_mov_b64 v[18:19], 0
  v_smfmac_f32_16x16x64_bf16 v[40:43], v[0:3], a[40:47], v74
  ds_read_b128 v[48:51], v75 offset:17408
  v_mov_b64 v[68:69], s[78:79]
  v_smfmac_f32_16x16x64_bf16 v[36:39], v[4:7], a[48:55], v74
  s_waitcnt lgkmcnt(4)
  v_add_f32_dpp v24, v22, v20 quad_perm:[2,3,0,1] row_mask:0xf bank_mask:0xf
  v_add_f32_dpp v25, v23, v21 quad_perm:[2,3,0,1] row_mask:0xf bank_mask:0xf
  v_smfmac_f32_16x16x64_bf16 v[36:39], v[8:11], a[64:71], v74
  s_waitcnt lgkmcnt(2)
  s_barrier
  ds_read_b128 v[32:35], v78 offset:512
  v_smfmac_f32_16x16x64_bf16 v[36:39], v[12:15], a[80:87], v74
  ds_read_b128 v[60:63], v75 offset:18432
  v_mul_f32 v24, s69, v24
  v_smfmac_f32_16x16x64_bf16 v[40:43], v[4:7], a[56:63], v74
  ds_read_b128 v[64:67], v75 offset:19456
  v_mul_f32 v25, s69, v25
  v_smfmac_f32_16x16x64_bf16 v[40:43], v[8:11], a[72:79], v74
  v_exp_f32_dpp v24, v24 quad_perm:[0,1,0,1] row_mask:0xf bank_mask:0xf
  v_smfmac_f32_16x16x64_bf16 v[40:43], v[12:15], a[88:95], v74
  s_waitcnt lgkmcnt(2)
  v_exp_f32_dpp v25, v25 quad_perm:[0,1,0,1] row_mask:0xf bank_mask:0xf
  v_mfma_f32_16x16x32_bf16 v[8:11], v[32:35], v[68:71], 0
  v_add_f32 v36, v36, v38
  v_add_f32 v37, v37, v39
  v_mfma_f32_16x16x32_bf16 v[0:3], v[32:35], v[52:55], 0
  v_add_f32 v40, v40, v42
  v_add_f32 v41, v41, v43
  v_mfma_f32_16x16x32_bf16 v[4:7], v[32:35], v[56:59], 0
  v_cvt_pk_bf16_f32 v28, v24, v25
  v_cvt_pk_bf16_f32 v72, v36, v37
  v_cvt_pk_bf16_f32 v73, v40, v41
  v_mfma_f32_16x16x16_bf16 v[8:11], v[28:29], v[68:69], v[8:11]
  v_cvt_pk_bf16_f32 v31, v24, v25
  v_mov_b64 v[20:21], 0
  v_mfma_f32_16x16x16_bf16 v[0:3], v[28:29], v[72:73], v[0:3]
  ds_read_b128 v[68:71], v76 offset:13824
  v_mov_b64 v[22:23], 0
  v_mfma_f32_16x16x16_bf16 v[4:7], v[30:31], v[72:73], v[4:7]
  v_rcp_f32 v10, v8
  v_rcp_f32 v11, v9
  v_mul_f32 v0, v10, v0
  v_mul_f32 v1, v11, v1
  s_nop 0
  v_mul_f32 v4, v10, v4
  v_mul_f32 v5, v11, v5
  v_cvt_pk_bf16_f32 v2, v0, v4
  ds_write_b32 v79, v2 offset:8704
  v_cvt_pk_bf16_f32 v3, v1, v5
  ds_write_b32 v79, v3 offset:9280
  v_max3_f32 v8, v8, v9, v10
  v_max_f32 v8, v8, v11
  v_cmp_le_f32 vcc, 1317011456, v8
  v_mov_b64 v[24:25], 0
  v_mov_b64 v[26:27], 0
  s_cbranch_vccnz Cf0_mx
Cf0_mxok:
  s_waitcnt lgkmcnt(0)
  s_barrier
  ds_read_b128 v[0:3], v78 offset:8704
  ds_read_b128 v[4:7], v78 offset:8768
  ds_read_b128 v[8:11], v78 offset:8832
  ds_read_b128 v[12:15], v78 offset:8896
  s_waitcnt lgkmcnt(3)
  v_smfmac_f32_16x16x64_bf16 v[16:19], v[0:3], v[44:51], v74
  ds_read_b128 v[52:55], v75 offset:32768
  s_waitcnt lgkmcnt(3)
  v_smfmac_f32_16x16x64_bf16 v[16:19], v[4:7], v[60:67], v74
  ds_read_b128 v[56:59], v75 offset:33792
  s_waitcnt lgkmcnt(3)
  v_smfmac_f32_16x16x64_bf16 v[16:19], v[8:11], a[176:183], v74
  ds_read_b128 v[36:39], v75 offset:34816
  s_waitcnt lgkmcnt(3)
  v_smfmac_f32_16x16x64_bf16 v[16:19], v[12:15], a[184:191], v74
  ds_read_b128 v[40:43], v75 offset:35840
  ds_read_b128 v[44:47], v75 offset:49152
  v_smfmac_f32_16x16x64_bf16 v[20:23], v[0:3], a[192:199], v74
  ds_read_b128 v[48:51], v75 offset:50176
  ds_read_b128 v[60:63], v75 offset:51200
  v_smfmac_f32_16x16x64_bf16 v[20:23], v[4:7], a[200:207], v74
  ds_read_b128 v[64:67], v75 offset:52224
  s_waitcnt lgkmcnt(6)
  v_cvt_pk_bf16_f32 v16, v16, v17
  v_cvt_pk_bf16_f32 v17, v18, v19
  v_bfi_b32 v16, 1, s72, v16
  v_smfmac_f32_16x16x64_bf16 v[20:23], v[8:11], v[52:59], v74
  buffer_store_dwordx2 v[16:17], v68, s[8:11], s73 offen
  s_waitcnt lgkmcnt(4)
  v_smfmac_f32_16x16x64_bf16 v[20:23], v[12:15], v[36:43], v74
  v_mov_b64 v[32:33], 0
  v_smfmac_f32_16x16x64_bf16 v[24:27], v[0:3], a[208:215], v74
  v_mov_b64 v[34:35], 0
  v_smfmac_f32_16x16x64_bf16 v[24:27], v[4:7], a[216:223], v74
  s_waitcnt lgkmcnt(2)
  v_cvt_pk_bf16_f32 v20, v20, v21
  v_cvt_pk_bf16_f32 v21, v22, v23
  v_bfi_b32 v20, 1, s72, v20
  v_smfmac_f32_16x16x64_bf16 v[24:27], v[8:11], v[44:51], v74
  buffer_store_dwordx2 v[20:21], v68, s[8:11], s74 offen
  s_waitcnt lgkmcnt(0)
  v_smfmac_f32_16x16x64_bf16 v[24:27], v[12:15], v[60:67], v74
  v_smfmac_f32_16x16x64_bf16 v[32:35], v[0:3], a[224:231], v74
  v_smfmac_f32_16x16x64_bf16 v[32:35], v[4:7], a[232:239], v74
  v_cvt_pk_bf16_f32 v24, v24, v25
  v_cvt_pk_bf16_f32 v25, v26, v27
  v_bfi_b32 v24, 1, s72, v24
  v_smfmac_f32_16x16x64_bf16 v[32:35], v[8:11], a[240:247], v74
  buffer_store_dwordx2 v[24:25], v68, s[8:11], s75 offen
  v_smfmac_f32_16x16x64_bf16 v[32:35], v[12:15], a[248:255], v74
  v_mov_b64 v[18:19], v[72:73]
  s_nop 4
  v_cvt_pk_bf16_f32 v32, v32, v33
  v_cvt_pk_bf16_f32 v33, v34, v35
  v_bfi_b32 v32, 1, s72, v32
  buffer_store_dwordx2 v[32:33], v68, s[8:11], s76 offen
  ds_read_b128 v[0:3], v76 offset:14848
  s_waitcnt lgkmcnt(0)
  ds_read_b64 v[16:17], v77 offset:256
  s_waitcnt lgkmcnt(0)
  ds_read_b128 v[64:67], v76 offset:19456
  s_waitcnt lgkmcnt(0)
  v_xor_b32 v75, 0x8000, v75
  buffer_load_dwordx4 v[52:55], v76, s[8:11], s60 offen offset:0 sc1
  buffer_load_dwordx4 v[56:59], v76, s[8:11], s60 offen offset:1024 sc1
  s_add_u32 s66, s66, 1
  s_xor_b32 s64, s64, 16384
  s_xor_b32 s65, s65, 16384
  s_add_u32 s58, s58, 655360
  s_add_u32 s59, s59, 655360
  s_add_u32 s70, s70, 655360
  s_add_u32 s68, s68, 655360
  s_mov_b32 m0, 10752
  s_add_u32 s85, s65, 6144
  s_cmp_eq_u32 s66, 62
  s_cselect_b64 s[16:17], s[20:21], s[16:17]
  s_cselect_b32 s18, (Cf0_done - Cf0_last), s18
  s_cselect_b32 s70, 0, s70
  s_cmp_eq_u32 s66, 63
  s_cselect_b32 s59, 268435456, s59
  s_cselect_b32 s58, 268435456, s58
  s_waitcnt lgkmcnt(0)
  s_waitcnt vmcnt(1)
  v_mfma_f32_16x16x32_bf16 v[4:7], v[0:3], v[52:55], 0
  v_bitop3_b32 v72, v52, v54, s72 bitop3:0x7e
  s_waitcnt vmcnt(0)
  v_mfma_f32_16x16x32_bf16 v[4:7], v[0:3], v[56:59], v[4:7]
  v_bitop3_b32 v73, v56, v58, s72 bitop3:0x7e
  v_bitop3_b32 v72, v72, v73, 1 bitop3:0xa8
  v_cmp_ne_u32 vcc, 0, v72
  s_nop 3
  v_add_f32_dpp v4, v4, v4 row_ror:4 row_mask:0xf bank_mask:0xf
  v_add_f32_dpp v5, v5, v5 row_ror:4 row_mask:0xf bank_mask:0xf
  s_cmp_eq_u64 vcc, 0
  v_add_f32_dpp v4, v4, v4 row_ror:8 row_mask:0xf bank_mask:0xf
  v_add_f32_dpp v5, v5, v5 row_ror:8 row_mask:0xf bank_mask:0xf
  s_cselect_b32 s54, s62, 268435456
  v_cvt_pk_bf16_f32 v4, v4, v5
  buffer_store_dword v4, v69, s[8:11], s54 offen
  s_cbranch_vccnz Cf0_h1r
  s_xor_b32 s62, s62, 16384
  buffer_store_dword v71, v69, s[8:11], s62 offen
  s_xor_b32 s72, s72, 1
  s_branch Cf0_h2
Cf0_h1r:
  s_mov_b64 exec, vcc
  buffer_load_dwordx4 v[52:55], v76, s[8:11], s60 offen offset:0 sc1
  buffer_load_dwordx4 v[56:59], v76, s[8:11], s60 offen offset:1024 sc1
  s_mov_b64 exec, -1
  s_add_u32 s67, s67, 1
  s_waitcnt vmcnt(1)
  v_mfma_f32_16x16x32_bf16 v[4:7], v[0:3], v[52:55], 0
  v_bitop3_b32 v72, v52, v54, s72 bitop3:0x7e
  s_waitcnt vmcnt(0)
  v_mfma_f32_16x16x32_bf16 v[4:7], v[0:3], v[56:59], v[4:7]
  v_bitop3_b32 v73, v56, v58, s72 bitop3:0x7e
  v_bitop3_b32 v72, v72, v73, 1 bitop3:0xa8
  v_cmp_ne_u32 vcc, 0, v72
  s_cbranch_vccz Cf0_h1p
Cf0_h1s:
  s_mov_b64 exec, vcc
  buffer_load_dwordx4 v[52:55], v76, s[8:11], s60 offen offset:0 sc1
  buffer_load_dwordx4 v[56:59], v76, s[8:11], s60 offen offset:1024 sc1
  s_mov_b64 exec, -1
  s_add_u32 s67, s67, 1
  s_waitcnt vmcnt(1)
  v_mfma_f32_16x16x32_bf16 v[4:7], v[0:3], v[52:55], 0
  v_bitop3_b32 v72, v52, v54, s72 bitop3:0x7e
  s_waitcnt vmcnt(0)
  v_mfma_f32_16x16x32_bf16 v[4:7], v[0:3], v[56:59], v[4:7]
  v_bitop3_b32 v73, v56, v58, s72 bitop3:0x7e
  v_bitop3_b32 v72, v72, v73, 1 bitop3:0xa8
  v_cmp_ne_u32 vcc, 0, v72
  s_cbranch_vccz Cf0_h1p
  s_cmp_lt_u32 s67, 131072
  s_cbranch_scc1 Cf0_h1s
Cf0_h1p:
  s_nop 2
  v_add_f32_dpp v4, v4, v4 row_ror:4 row_mask:0xf bank_mask:0xf
  v_add_f32_dpp v5, v5, v5 row_ror:4 row_mask:0xf bank_mask:0xf
  s_nop 0
  v_add_f32_dpp v4, v4, v4 row_ror:8 row_mask:0xf bank_mask:0xf
  v_add_f32_dpp v5, v5, v5 row_ror:8 row_mask:0xf bank_mask:0xf
  v_cvt_pk_bf16_f32 v4, v4, v5
  buffer_store_dword v4, v69, s[8:11], s62 offen
  s_xor_b32 s62, s62, 16384
  buffer_store_dword v71, v69, s[8:11], s62 offen
  s_xor_b32 s72, s72, 1
  s_branch Cf0_h2
Cf0_h2r:
  s_mov_b64 exec, vcc
  buffer_load_dwordx4 v[0:3], v76, s[8:11], s65 offen offset:0 sc1
  s_mov_b64 exec, -1
  s_add_u32 s67, s67, 1
  s_waitcnt vmcnt(4)
  v_max3_u32 v72, v0, v1, v2
  v_max_u32 v72, v72, v3
  ds_write_b128 v76, v[0:3] offset:4608
  v_cmp_eq_u32 vcc, -1, v72
  s_cbranch_vccz Cf0_h2w
  s_mov_b64 exec, vcc
  buffer_load_dwordx4 v[0:3], v76, s[8:11], s65 offen offset:0 sc1
  s_mov_b64 exec, -1
  s_add_u32 s67, s67, 1
  s_waitcnt vmcnt(4)
  v_max3_u32 v72, v0, v1, v2
  v_max_u32 v72, v72, v3
  ds_write_b128 v76, v[0:3] offset:4608
  v_cmp_eq_u32 vcc, -1, v72
  s_cbranch_vccz Cf0_h2w
Cf0_h2s:
  s_mov_b64 exec, vcc
  buffer_load_dwordx4 v[0:3], v76, s[8:11], s65 offen offset:0 sc1
  s_mov_b64 exec, -1
  s_add_u32 s67, s67, 1
  s_waitcnt vmcnt(2)
  v_max3_u32 v72, v0, v1, v2
  v_max_u32 v72, v72, v3
  ds_write_b128 v76, v[0:3] offset:4608
  v_cmp_eq_u32 vcc, -1, v72
  s_cbranch_vccz Cf0_h2w
  s_mov_b64 exec, vcc
  buffer_load_dwordx4 v[0:3], v76, s[8:11], s65 offen offset:0 sc1
  s_mov_b64 exec, -1
  s_add_u32 s67, s67, 1
  s_waitcnt vmcnt(2)
  v_max3_u32 v72, v0, v1, v2
  v_max_u32 v72, v72, v3
  ds_write_b128 v76, v[0:3] offset:4608
  v_cmp_eq_u32 vcc, -1, v72
  s_cbranch_vccz Cf0_h2w
  s_mov_b64 exec, vcc
  buffer_load_dwordx4 v[0:3], v76, s[8:11], s65 offen offset:0 sc1
  s_mov_b64 exec, -1
  s_add_u32 s67, s67, 1
  s_waitcnt vmcnt(2)
  v_max3_u32 v72, v0, v1, v2
  v_max_u32 v72, v72, v3
  ds_write_b128 v76, v[0:3] offset:4608
  v_cmp_eq_u32 vcc, -1, v72
  s_cbranch_vccz Cf0_h2w
  s_cmp_lt_u32 s67, 131072
  s_cbranch_scc1 Cf0_h2s
  s_branch Cf0_h2w
Cf0_rec:
  s_nop 7
  s_waitcnt vmcnt(0) lgkmcnt(0)
  v_max3_u32 v72, v0, v1, v2
  v_max3_u32 v72, v72, v3, v4
  v_max3_u32 v72, v72, v5, v6
  v_max3_u32 v72, v72, v7, v8
  v_max3_u32 v72, v72, v9, v10
  v_max3_u32 v72, v72, v11, v12
  v_max3_u32 v72, v72, v13, v14
  v_max3_u32 v72, v72, v15, v16
  v_max3_u32 v72, v72, v17, v18
  v_max_u32 v72, v72, v19
  v_cmp_eq_u32 vcc, -1, v72
  s_cbranch_vccz Cf0_recok
  s_barrier
  v_mov_b64 v[20:21], 0
  v_mov_b64 v[22:23], 0
  v_mov_b64 v[24:25], 0
  v_mov_b64 v[26:27], 0
  v_mov_b64 v[28:29], 0
  v_mov_b64 v[30:31], 0
  v_mov_b64 v[32:33], 0
  v_mov_b64 v[34:35], 0
  s_waitcnt lgkmcnt(0)
  s_barrier
  ds_read_b128 v[0:3], v76 offset:4608
  s_waitcnt lgkmcnt(0)
  v_smfmac_f32_16x16x64_bf16 v[20:23], v[0:3], v[80:87], v74
  v_smfmac_f32_16x16x64_bf16 v[24:27], v[0:3], v[88:95], v74
  ds_read_b128 v[60:63], v76 offset:16384
  ds_read_b128 v[64:67], v76 offset:17408
  s_waitcnt lgkmcnt(0)
  v_smfmac_f32_16x16x64_bf16 v[28:31], v[0:3], v[60:67], v74
  ds_read_b128 v[60:63], v76 offset:18432
  ds_read_b128 v[64:67], v76 offset:19456
  s_waitcnt lgkmcnt(0)
  v_smfmac_f32_16x16x64_bf16 v[32:35], v[0:3], v[60:67], v74
  ds_read_b128 v[4:7], v76 offset:5632
  s_waitcnt lgkmcnt(0)
  v_smfmac_f32_16x16x64_bf16 v[20:23], v[4:7], v[96:103], v74
  v_smfmac_f32_16x16x64_bf16 v[24:27], v[4:7], v[104:111], v74
  ds_read_b128 v[60:63], v76 offset:32768
  ds_read_b128 v[64:67], v76 offset:33792
  s_waitcnt lgkmcnt(0)
  v_smfmac_f32_16x16x64_bf16 v[28:31], v[4:7], v[60:67], v74
  ds_read_b128 v[60:63], v76 offset:34816
  ds_read_b128 v[64:67], v76 offset:35840
  s_waitcnt lgkmcnt(0)
  v_smfmac_f32_16x16x64_bf16 v[32:35], v[4:7], v[60:67], v74
  ds_read_b128 v[8:11], v76 offset:6656
  s_waitcnt lgkmcnt(0)
  v_smfmac_f32_16x16x64_bf16 v[20:23], v[8:11], v[112:119], v74
  v_smfmac_f32_16x16x64_bf16 v[24:27], v[8:11], v[120:127], v74
  v_smfmac_f32_16x16x64_bf16 v[28:31], v[8:11], v[208:215], v74
  v_smfmac_f32_16x16x64_bf16 v[32:35], v[8:11], v[216:223], v74
  ds_read_b128 v[12:15], v76 offset:7680
  s_waitcnt lgkmcnt(0)
  v_smfmac_f32_16x16x64_bf16 v[20:23], v[12:15], v[128:135], v74
  v_smfmac_f32_16x16x64_bf16 v[24:27], v[12:15], v[136:143], v74
  v_smfmac_f32_16x16x64_bf16 v[28:31], v[12:15], v[224:231], v74
  v_smfmac_f32_16x16x64_bf16 v[32:35], v[12:15], v[232:239], v74
  ds_read_b128 v[0:3], v76 offset:8704
  s_waitcnt lgkmcnt(0)
  v_smfmac_f32_16x16x64_bf16 v[20:23], v[0:3], v[144:151], v74
  v_smfmac_f32_16x16x64_bf16 v[24:27], v[0:3], v[152:159], v74
  ds_read_b128 v[60:63], v76 offset:49152
  ds_read_b128 v[64:67], v76 offset:50176
  s_waitcnt lgkmcnt(0)
  v_smfmac_f32_16x16x64_bf16 v[28:31], v[0:3], v[60:67], v74
  ds_read_b128 v[60:63], v76 offset:51200
  ds_read_b128 v[64:67], v76 offset:52224
  s_waitcnt lgkmcnt(0)
  v_smfmac_f32_16x16x64_bf16 v[32:35], v[0:3], v[60:67], v74
  ds_read_b128 v[8:11], v76 offset:9728
  s_waitcnt lgkmcnt(0)
  v_smfmac_f32_16x16x64_bf16 v[20:23], v[8:11], v[160:167], v74
  v_smfmac_f32_16x16x64_bf16 v[24:27], v[8:11], v[168:175], v74
  ds_read_b128 v[60:63], v75 offset:16384
  ds_read_b128 v[64:67], v75 offset:17408
  s_waitcnt lgkmcnt(0)
  v_smfmac_f32_16x16x64_bf16 v[28:31], v[8:11], v[60:67], v74
  ds_read_b128 v[60:63], v75 offset:18432
  ds_read_b128 v[64:67], v75 offset:19456
  s_waitcnt lgkmcnt(0)
  v_smfmac_f32_16x16x64_bf16 v[32:35], v[8:11], v[60:67], v74
  ds_read_b128 v[16:19], v76 offset:10752
  ds_read_b128 v[60:63], v75 offset:0
  ds_read_b128 v[64:67], v75 offset:1024
  s_waitcnt lgkmcnt(0)
  v_smfmac_f32_16x16x64_bf16 v[20:23], v[16:19], v[60:67], v74
  ds_read_b128 v[60:63], v75 offset:2048
  ds_read_b128 v[64:67], v75 offset:3072
  s_waitcnt lgkmcnt(0)
  v_smfmac_f32_16x16x64_bf16 v[24:27], v[16:19], v[60:67], v74
  v_smfmac_f32_16x16x64_bf16 v[28:31], v[16:19], v[240:247], v74
  v_smfmac_f32_16x16x64_bf16 v[32:35], v[16:19], v[248:255], v74
  ds_read_b128 v[4:7], v76 offset:11776
  s_waitcnt lgkmcnt(0)
  v_smfmac_f32_16x16x64_bf16 v[20:23], v[4:7], v[176:183], v74
  v_smfmac_f32_16x16x64_bf16 v[24:27], v[4:7], v[184:191], v74
  v_smfmac_f32_16x16x64_bf16 v[28:31], v[4:7], a[0:7], v74
  v_smfmac_f32_16x16x64_bf16 v[32:35], v[4:7], a[8:15], v74
  ds_read_b128 v[12:15], v76 offset:12800
  s_waitcnt lgkmcnt(0)
  v_smfmac_f32_16x16x64_bf16 v[20:23], v[12:15], v[192:199], v74
  v_smfmac_f32_16x16x64_bf16 v[24:27], v[12:15], v[200:207], v74
  v_smfmac_f32_16x16x64_bf16 v[28:31], v[12:15], a[16:23], v74
  v_smfmac_f32_16x16x64_bf16 v[32:35], v[12:15], a[24:31], v74
  v_add_f32 v20, v20, v22
  v_add_f32 v21, v21, v23
  v_add_f32 v24, v24, v26
  v_cvt_pk_bf16_f32 v22, v20, v24
  ds_write_b32 v79, v22 offset:0
  v_add_f32 v25, v25, v27
  v_cvt_pk_bf16_f32 v23, v21, v25
  ds_write_b32 v79, v23 offset:576
  v_add_f32 v28, v28, v30
  v_add_f32 v29, v29, v31
  s_waitcnt lgkmcnt(0)
  s_nop 1
  s_branch Cf0_recok
Cf0_mx:
  s_waitcnt lgkmcnt(0)
  s_barrier
  buffer_load_dwordx4 v[0:3], v76, s[8:11], s58 offen offset:0 sc1
  ds_read_b128 v[20:23], v77 offset:0
  ds_read_b128 v[28:31], v77 offset:256
  buffer_load_dwordx4 v[4:7], v76, s[8:11], s58 offen offset:1024 sc1
  ds_read_b128 v[24:27], v77 offset:128
  ds_read_b128 v[32:35], v77 offset:384
  s_waitcnt vmcnt(1) lgkmcnt(3)
  v_mfma_f32_16x16x32_bf16 v[8:11], v[0:3], v[20:23], 0
  s_waitcnt vmcnt(0) lgkmcnt(1)
  v_mfma_f32_16x16x32_bf16 v[8:11], v[4:7], v[24:27], v[8:11]
  v_mfma_f32_16x16x32_bf16 v[12:15], v[28:31], v[20:23], 0
  s_waitcnt lgkmcnt(0)
  v_mfma_f32_16x16x32_bf16 v[12:15], v[32:35], v[24:27], v[12:15]
  v_add_f32_dpp v8, v10, v8 quad_perm:[2,3,0,1] row_mask:0xf bank_mask:0xf
  v_add_f32_dpp v9, v11, v9 quad_perm:[2,3,0,1] row_mask:0xf bank_mask:0xf
  s_nop 0
  v_mov_b32_dpp v8, v8 quad_perm:[0,1,0,1] row_mask:0xf bank_mask:0xf
  v_mov_b32_dpp v9, v9 quad_perm:[0,1,0,1] row_mask:0xf bank_mask:0xf
  s_nop 1
  v_add_f32_dpp v12, v14, v12 quad_perm:[2,3,0,1] row_mask:0xf bank_mask:0xf
  v_add_f32_dpp v13, v15, v13 quad_perm:[2,3,0,1] row_mask:0xf bank_mask:0xf
  s_nop 0
  v_mov_b32_dpp v12, v12 quad_perm:[0,1,0,1] row_mask:0xf bank_mask:0xf
  v_mov_b32_dpp v13, v13 quad_perm:[0,1,0,1] row_mask:0xf bank_mask:0xf
  v_mul_f32 v12, s69, v12
  ds_write_b32 v78, v8 offset:8704
  v_mul_f32 v13, s69, v13
  ds_write_b32 v78, v9 offset:8768
  s_waitcnt lgkmcnt(0)
  s_barrier
  ds_read_b128 v[36:39], v78 offset:8704
  ds_read_b128 v[40:43], v78 offset:8768
  s_waitcnt lgkmcnt(0)
  s_barrier
  v_max_f32 v16, v36, v37
  v_max3_f32 v16, v16, v38, v39
  v_max3_f32 v16, v16, v40, v41
  v_max3_f32 v16, v16, v42, v43
  v_max3_f32 v16, v16, v12, v13
  v_mov_b32 v17, v16
  s_nop 1
  v_permlane16_swap_b32 v16, v17
  v_max_f32 v16, v16, v17
  v_mov_b32 v17, v16
  s_nop 1
  v_permlane32_swap_b32 v16, v17
  v_max_f32 v16, v16, v17
  v_sub_f32 v36, v36, v16
  v_sub_f32 v37, v37, v16
  v_sub_f32 v38, v38, v16
  v_sub_f32 v39, v39, v16
  v_sub_f32 v40, v40, v16
  v_sub_f32 v41, v41, v16
  v_sub_f32 v42, v42, v16
  v_sub_f32 v43, v43, v16
  v_sub_f32 v12, v12, v16
  v_sub_f32 v13, v13, v16
  v_exp_f32 v36, v36
  v_exp_f32 v37, v37
  v_exp_f32 v38, v38
  v_exp_f32 v39, v39
  v_exp_f32 v40, v40
  v_exp_f32 v41, v41
  v_exp_f32 v42, v42
  v_exp_f32 v43, v43
  v_exp_f32 v12, v12
  v_exp_f32 v13, v13
  v_cvt_pk_bf16_f32 v32, v36, v40
  v_cvt_pk_bf16_f32 v33, v37, v41
  v_cvt_pk_bf16_f32 v34, v38, v42
  v_cvt_pk_bf16_f32 v35, v39, v43
  v_cvt_pk_bf16_f32 v28, v12, v13
  v_cvt_pk_bf16_f32 v31, v12, v13
  v_mov_b32 v29, 0
  v_mov_b32 v30, 0
  v_mov_b32 v68, 0x3f803f80
  v_mov_b32 v69, 0x3f803f80
  v_mov_b32 v70, 0x3f803f80
  v_mov_b32 v71, 0x3f803f80
  s_nop 1
  v_mfma_f32_16x16x32_bf16 v[8:11], v[32:35], v[68:71], 0
  v_mfma_f32_16x16x32_bf16 v[0:3], v[32:35], v[52:55], 0
  v_mfma_f32_16x16x32_bf16 v[4:7], v[32:35], v[56:59], 0
  v_mfma_f32_16x16x16_bf16 v[8:11], v[28:29], v[68:69], v[8:11]
  v_mfma_f32_16x16x16_bf16 v[0:3], v[28:29], v[72:73], v[0:3]
  v_mfma_f32_16x16x16_bf16 v[4:7], v[30:31], v[72:73], v[4:7]
  ds_read_b128 v[68:71], v76 offset:13824
  v_rcp_f32 v10, v8
  v_rcp_f32 v11, v9
  v_mul_f32 v0, v10, v0
  v_mul_f32 v1, v11, v1
  s_nop 0
  v_mul_f32 v4, v10, v4
  v_mul_f32 v5, v11, v5
  v_cvt_pk_bf16_f32 v2, v0, v4
  ds_write_b32 v79, v2 offset:8704
  v_cvt_pk_bf16_f32 v3, v1, v5
  ds_write_b32 v79, v3 offset:9280
  v_mov_b64 v[16:17], 0
  v_mov_b64 v[18:19], 0
  v_mov_b64 v[20:21], 0
  v_mov_b64 v[22:23], 0
  v_mov_b64 v[24:25], 0
  v_mov_b64 v[26:27], 0
  s_branch Cf0_mxok
Cf0_kv3:
  s_waitcnt lgkmcnt(0)
  s_cmp_ge_u32 s57, 0x700
  s_cbranch_scc1 Cf0_kvb
  s_load_dword s57, s[12:13], s71 glc
  s_add_u32 s67, s67, 1
  s_cmp_lt_u32 s67, 131072
  s_cbranch_scc1 Cf0_kv3
  s_waitcnt lgkmcnt(0)
  s_branch Cf0_kvb
Cf0_last:
  ds_read_b128 v[4:7], v76 offset:5632
  ds_read_b128 v[12:15], v76 offset:7680
  ds_read_b128 v[44:47], v76 offset:32768
  ds_read_b128 v[48:51], v76 offset:33792
  s_nop 5
  v_mov_b64 v[20:21], 0
  v_mov_b64 v[22:23], 0
  v_mov_b64 v[24:25], 0
  v_mov_b64 v[26:27], 0
  v_smfmac_f32_16x16x64_bf16 v[28:31], v[0:3], v[36:43], v74
  ds_read_b128 v[36:39], v76 offset:34816
  ds_read_b128 v[40:43], v76 offset:35840
  v_smfmac_f32_16x16x64_bf16 v[32:35], v[0:3], v[60:67], v74
  s_waitcnt lgkmcnt(5)
  v_smfmac_f32_16x16x64_bf16 v[20:23], v[0:3], a[32:39], v74
  ds_read_b128 v[60:63], v76 offset:49152
  ds_read_b128 v[64:67], v76 offset:50176
  v_smfmac_f32_16x16x64_bf16 v[24:27], v[0:3], a[40:47], v74
  s_waitcnt lgkmcnt(4)
  v_smfmac_f32_16x16x64_bf16 v[20:23], v[4:7], a[48:55], v74
  buffer_store_dwordx4 v[16:19], v76, s[8:11], s68 offen sc1
  v_smfmac_f32_16x16x64_bf16 v[24:27], v[4:7], a[56:63], v74
  v_smfmac_f32_16x16x64_bf16 v[28:31], v[4:7], v[44:51], v74
  s_waitcnt lgkmcnt(2)
  v_smfmac_f32_16x16x64_bf16 v[20:23], v[8:11], a[64:71], v74
  ds_read_b128 v[44:47], v76 offset:51200
  ds_read_b128 v[48:51], v76 offset:52224
  v_smfmac_f32_16x16x64_bf16 v[24:27], v[8:11], a[72:79], v74
  v_smfmac_f32_16x16x64_bf16 v[32:35], v[4:7], v[36:43], v74
  v_smfmac_f32_16x16x64_bf16 v[28:31], v[8:11], v[208:215], v74
  ds_read_b128 v[36:39], v75 offset:16384
  ds_read_b128 v[40:43], v75 offset:17408
  v_smfmac_f32_16x16x64_bf16 v[32:35], v[8:11], v[216:223], v74
  v_smfmac_f32_16x16x64_bf16 v[20:23], v[12:15], a[80:87], v74
  v_smfmac_f32_16x16x64_bf16 v[24:27], v[12:15], a[88:95], v74
  v_smfmac_f32_16x16x64_bf16 v[28:31], v[12:15], v[224:231], v74
  v_smfmac_f32_16x16x64_bf16 v[32:35], v[12:15], v[232:239], v74
  s_waitcnt vmcnt(2)
  s_waitcnt vmcnt(1)
  s_barrier
Cf0_lastr:
  ds_read_b128 v[0:3], v76 offset:8704
  ds_read_b128 v[8:11], v76 offset:9728
  ds_read_b128 v[16:19], v76 offset:10752
  ds_read_b128 v[4:7], v76 offset:11776
  ds_read_b128 v[12:15], v76 offset:12800
  s_waitcnt lgkmcnt(4)
  v_max3_u32 v72, v0, v1, v2
  s_waitcnt lgkmcnt(1)
  v_max3_u32 v72, v72, v3, v4
  v_max3_u32 v72, v72, v5, v6
  v_max3_u32 v72, v72, v7, v8
  v_max3_u32 v72, v72, v9, v10
  s_waitcnt lgkmcnt(0)
  v_max3_u32 v72, v72, v11, v12
  v_max3_u32 v72, v72, v13, v14
  v_max3_u32 v72, v72, v15, v16
  v_max3_u32 v72, v72, v17, v18
  v_max_u32 v72, v72, v19
  v_cmp_eq_u32 vcc, -1, v72
  s_cbranch_vccnz Cf0_lastp
Cf0_lastg:
  v_smfmac_f32_16x16x64_bf16 v[28:31], v[0:3], v[60:67], v74
  ds_read_b128 v[60:63], v75 offset:18432
  ds_read_b128 v[64:67], v75 offset:19456
  v_smfmac_f32_16x16x64_bf16 v[32:35], v[0:3], v[44:51], v74
  v_smfmac_f32_16x16x64_bf16 v[28:31], v[8:11], v[36:43], v74
  v_smfmac_f32_16x16x64_bf16 v[28:31], v[16:19], v[240:247], v74
  v_smfmac_f32_16x16x64_bf16 v[28:31], v[4:7], a[0:7], v74
  v_smfmac_f32_16x16x64_bf16 v[28:31], v[12:15], a[16:23], v74
  v_smfmac_f32_16x16x64_bf16 v[32:35], v[16:19], v[248:255], v74
  v_smfmac_f32_16x16x64_bf16 v[32:35], v[4:7], a[8:15], v74
  s_waitcnt lgkmcnt(0)
  v_smfmac_f32_16x16x64_bf16 v[32:35], v[12:15], a[24:31], v74
  v_smfmac_f32_16x16x64_bf16 v[32:35], v[8:11], v[60:67], v74
  v_smfmac_f32_16x16x64_bf16 v[20:23], v[0:3], a[96:103], v74
  v_smfmac_f32_16x16x64_bf16 v[20:23], v[8:11], a[112:119], v74
  v_add_f32 v28, v28, v30
  v_add_f32 v32, v32, v34
  v_cvt_pk_bf16_f32 v30, v28, v32
  v_smfmac_f32_16x16x64_bf16 v[20:23], v[16:19], a[128:135], v74
  ds_write_b32 v79, v30 offset:256
  v_add_f32 v29, v29, v31
  v_add_f32 v33, v33, v35
  v_cvt_pk_bf16_f32 v31, v29, v33
  v_smfmac_f32_16x16x64_bf16 v[20:23], v[4:7], a[144:151], v74
  ds_write_b32 v79, v31 offset:832
  v_smfmac_f32_16x16x64_bf16 v[20:23], v[12:15], a[160:167], v74
  v_smfmac_f32_16x16x64_bf16 v[24:27], v[0:3], a[104:111], v74
  v_smfmac_f32_16x16x64_bf16 v[24:27], v[8:11], a[120:127], v74
  v_smfmac_f32_16x16x64_bf16 v[24:27], v[16:19], a[136:143], v74
  s_waitcnt lgkmcnt(0)
  s_barrier
  ds_read_b64 v[52:53], v77 offset:256
  v_add_f32 v20, v20, v22
  v_smfmac_f32_16x16x64_bf16 v[24:27], v[4:7], a[152:159], v74
  v_add_f32 v21, v21, v23
  v_smfmac_f32_16x16x64_bf16 v[24:27], v[12:15], a[168:175], v74
  v_cvt_pk_bf16_f32 v54, v20, v21
  s_add_u32 s68, s68, 655360
  s_nop 3
  v_add_f32 v24, v24, v26
  v_add_f32 v25, v25, v27
  v_cvt_pk_bf16_f32 v55, v24, v25
  s_waitcnt lgkmcnt(0)
  buffer_store_dwordx4 v[52:55], v76, s[8:11], s68 offen sc1
  s_branch Cf0_done
Cf0_lastp:
  s_add_u32 s72, s72, 2
  s_cmp_ge_u32 s72, 131072
  s_cbranch_scc1 Cf0_lastg
  s_barrier
  buffer_load_dwordx4 v76, s[8:11], s85 offen offset:0 sc1 lds
  s_waitcnt vmcnt(0)
  s_barrier
  s_branch Cf0_lastr
Cf0_done:
  s_branch L_cexit
L_w1:
  v_mov_b64 v[20:21], 0
  v_mov_b64 v[22:23], 0
  v_mov_b64 v[24:25], 0
  v_mov_b64 v[26:27], 0
  v_mov_b64 v[28:29], 0
  v_mov_b64 v[30:31], 0
  v_mov_b64 v[32:33], 0
  v_mov_b64 v[34:35], 0
  s_mov_b32 s78, 0x3f803f80
  s_mov_b32 s79, s78
  s_mov_b32 s65, 360448
  s_mov_b32 m0, 15872
  s_lshl_b32 s71, s53, 2
  s_add_u32 s71, s71, 128
  s_movk_i32 s56, 0x1000
  v_lshlrev_b32 v73, 2, v76
  v_mov_b32 v72, 0
  s_mov_b64 s[16:17], s[8:9]
  s_mov_b32 s18, 268435456
  s_mov_b32 s19, 0x20000
  s_getpc_b64 s[20:21]
Cf1_pc:
  s_add_u32 s20, s20, (Cf1_last - Cf1_pc)
  s_addc_u32 s21, s21, 0
  v_mov_b32 v68, 14880
  buffer_load_dwordx4 v[52:55], v76, s[8:11], s59 offen offset:0 sc1
  buffer_load_dwordx4 v[56:59], v76, s[8:11], s59 offen offset:1024 sc1
  ds_read_b128 v[36:39], v76 offset:20480
  ds_read_b128 v[40:43], v76 offset:21504
  ds_read_b128 v[60:63], v76 offset:22528
  ds_read_b128 v[64:67], v76 offset:23552
  ds_read_b128 v[0:3], v76 offset:4608
  ds_read_b128 v[4:7], v76 offset:5632
  ds_read_b128 v[8:11], v76 offset:6656
  ds_read_b128 v[12:15], v76 offset:7680
  s_waitcnt lgkmcnt(0)
  s_cmp_eq_u32 s66, 1
  s_branch Cf1_top2
.p2align 6
Cf1_h2:
  ds_read_b128 v[36:39], v76 offset:20480
  s_waitcnt lgkmcnt(0)
  s_cmp_eq_u32 s66, 62
  s_cselect_b64 s[16:17], s[20:21], s[16:17]
  s_cselect_b32 s18, (Cf1_done - Cf1_last), s18
  s_cselect_b32 s70, 0, s70
  s_cmp_eq_u32 s66, 63
  s_cselect_b32 s59, 268435456, s59
  s_cselect_b32 s58, 268435456, s58
  buffer_load_dwordx4 v[8:11], v76, s[8:11], s65 offen offset:2048 sc1
  ds_read_b128 v[40:43], v76 offset:21504
  s_waitcnt lgkmcnt(0)
  v_mov_b64 v[20:21], 0
  v_mov_b64 v[22:23], 0
  v_mov_b64 v[24:25], 0
  v_mov_b64 v[26:27], 0
  v_mov_b32 v68, 14880
  buffer_load_dwordx4 v[8:11], v76, s[8:11], s65 offen offset:2048 sc1
  ds_read_b128 v[60:63], v76 offset:22528
  s_waitcnt lgkmcnt(0)
  v_mov_b64 v[28:29], 0
  v_mov_b64 v[30:31], 0
  v_mov_b64 v[32:33], 0
  v_mov_b64 v[34:35], 0
  v_lshlrev_b32 v73, 2, v76
  buffer_load_dwordx4 v[8:11], v76, s[8:11], s65 offen offset:2048 sc1
  buffer_load_dwordx4 v[52:55], v76, s[8:11], s59 offen offset:0 sc1
  buffer_load_dwordx4 v[56:59], v76, s[8:11], s59 offen offset:1024 sc1
  s_waitcnt vmcnt(4)
  v_max3_u32 v72, v8, v9, v10
  v_max_u32 v72, v72, v11
  ds_write_b128 v76, v[8:11] offset:6656
  v_cmp_eq_u32 vcc, -1, v72
  s_cbranch_vccnz Cf1_h2r
Cf1_h2w:
  s_cmp_eq_u32 s66, 63
  s_waitcnt lgkmcnt(0)
  s_barrier
  ds_read_b128 v[0:3], v76 offset:4608
  buffer_load_dwordx4 v76, s[8:11], s85 offen offset:0 sc1 lds
Cf1_top2:
  v_smfmac_f32_16x16x64_bf16 v[20:23], v[8:11], v[112:119], v74
  s_cbranch_scc1 Cf1_last
  v_smfmac_f32_16x16x64_bf16 v[24:27], v[8:11], v[120:127], v74
  buffer_load_dwordx4 v[44:47], v76, s[8:11], s58 offen offset:0 sc1
  s_mov_b32 m0, 15872
  v_smfmac_f32_16x16x64_bf16 v[28:31], v[8:11], v[208:215], v74
  buffer_load_dwordx4 v[48:51], v76, s[8:11], s58 offen offset:1024 sc1
  v_smfmac_f32_16x16x64_bf16 v[32:35], v[8:11], v[216:223], v74
  ds_read_b128 v[4:7], v76 offset:5632
  s_waitcnt lgkmcnt(1)
  v_smfmac_f32_16x16x64_bf16 v[20:23], v[0:3], v[80:87], v74
  ds_read_b128 v[12:15], v76 offset:7680
  v_smfmac_f32_16x16x64_bf16 v[28:31], v[0:3], v[36:43], v74
  ds_read_b128 v[36:39], v76 offset:36864
  v_smfmac_f32_16x16x64_bf16 v[24:27], v[0:3], v[88:95], v74
  buffer_store_dwordx4 v[16:19], v76, s[8:11], s68 offen sc1
  ds_read_b128 v[40:43], v76 offset:37888
  v_smfmac_f32_16x16x64_bf16 v[32:35], v[0:3], v[60:67], v74
  buffer_load_dword v73, s[16:19], s70 offen lds
  ds_read_b128 v[60:63], v76 offset:38912
  s_waitcnt lgkmcnt(4)
  v_smfmac_f32_16x16x64_bf16 v[20:23], v[4:7], v[96:103], v74
  ds_read_b128 v[64:67], v76 offset:39936
  v_smfmac_f32_16x16x64_bf16 v[24:27], v[4:7], v[104:111], v74
  s_waitcnt vmcnt(5)
  s_waitcnt lgkmcnt(4)
  v_smfmac_f32_16x16x64_bf16 v[20:23], v[12:15], v[128:135], v74
  s_barrier
  ds_read_b128 v[8:11], v76 offset:8704
  s_waitcnt lgkmcnt(3)
  v_smfmac_f32_16x16x64_bf16 v[28:31], v[4:7], v[36:43], v74
  ds_read_b128 v[36:39], v76 offset:53248
  v_smfmac_f32_16x16x64_bf16 v[24:27], v[12:15], v[136:143], v74
  ds_read_b128 v[40:43], v76 offset:54272
  s_waitcnt lgkmcnt(3)
  v_smfmac_f32_16x16x64_bf16 v[32:35], v[4:7], v[60:67], v74
  ds_read_b128 v[0:3], v76 offset:9728
  v_smfmac_f32_16x16x64_bf16 v[28:31], v[12:15], v[224:231], v74
  ds_read_b128 v[60:63], v76 offset:55296
  v_smfmac_f32_16x16x64_bf16 v[32:35], v[12:15], v[232:239], v74
  s_waitcnt vmcnt(4)
  ds_read_b128 v[64:67], v76 offset:56320
  s_waitcnt lgkmcnt(5)
  v_smfmac_f32_16x16x64_bf16 v[20:23], v[8:11], v[144:151], v74
  s_barrier
  ds_read_b128 v[4:7], v76 offset:11776
  s_waitcnt lgkmcnt(4)
  v_smfmac_f32_16x16x64_bf16 v[28:31], v[8:11], v[36:43], v74
  ds_read_b128 v[12:15], v76 offset:12800
  ds_read_b128 v[36:39], v75 offset:4096
  v_smfmac_f32_16x16x64_bf16 v[24:27], v[8:11], v[152:159], v74
  ds_read_b128 v[16:19], v76 offset:10752
  s_waitcnt lgkmcnt(6)
  v_smfmac_f32_16x16x64_bf16 v[20:23], v[0:3], v[160:167], v74
  ds_read_b128 v[40:43], v75 offset:5120
  s_waitcnt lgkmcnt(5)
  v_smfmac_f32_16x16x64_bf16 v[32:35], v[8:11], v[60:67], v74
  ds_read_b128 v[60:63], v75 offset:6144
  v_smfmac_f32_16x16x64_bf16 v[24:27], v[0:3], v[168:175], v74
  ds_read_b128 v[64:67], v75 offset:7168
  s_waitcnt lgkmcnt(6)
  v_smfmac_f32_16x16x64_bf16 v[20:23], v[4:7], v[176:183], v74
  s_waitcnt lgkmcnt(5)
  v_smfmac_f32_16x16x64_bf16 v[20:23], v[12:15], v[192:199], v74
  s_waitcnt lgkmcnt(2)
  v_smfmac_f32_16x16x64_bf16 v[20:23], v[16:19], v[36:43], v74
  ds_read_b128 v[36:39], v75 offset:20480
  v_smfmac_f32_16x16x64_bf16 v[24:27], v[4:7], v[184:191], v74
  ds_read_b128 v[40:43], v75 offset:21504
  s_waitcnt lgkmcnt(2)
  v_smfmac_f32_16x16x64_bf16 v[24:27], v[16:19], v[60:67], v74
  ds_read_b128 v[60:63], v75 offset:22528
  v_add_f32 v20, v20, v22
  v_smfmac_f32_16x16x64_bf16 v[24:27], v[12:15], v[200:207], v74
  ds_read_b128 v[64:67], v75 offset:23552
  v_add_f32 v21, v21, v23
  v_smfmac_f32_16x16x64_bf16 v[28:31], v[16:19], v[240:247], v74
  v_mov_b64 v[70:71], s[78:79]
  v_smfmac_f32_16x16x64_bf16 v[28:31], v[4:7], a[0:7], v74
  s_waitcnt lgkmcnt(2)
  v_add_f32 v24, v24, v26
  v_smfmac_f32_16x16x64_bf16 v[28:31], v[0:3], v[36:43], v74
  ds_read_b128 v[36:39], v68
  v_cvt_pk_bf16_f32 v22, v20, v24
  v_smfmac_f32_16x16x64_bf16 v[28:31], v[12:15], a[16:23], v74
  ds_read_b128 v[40:43], v68
  ds_write_b32 v79, v22 offset:0
  s_waitcnt lgkmcnt(3)
  v_add_f32 v25, v25, v27
  v_cvt_pk_bf16_f32 v23, v21, v25
  v_smfmac_f32_16x16x64_bf16 v[32:35], v[0:3], v[60:67], v74
  ds_write_b32 v79, v23 offset:576
  v_cmp_u_f32 vcc, v20, v21
  v_smfmac_f32_16x16x64_bf16 v[32:35], v[16:19], v[248:255], v74
  v_add_f32 v28, v28, v30
  v_smfmac_f32_16x16x64_bf16 v[32:35], v[4:7], a[8:15], v74
  v_add_f32 v29, v29, v31
  v_smfmac_f32_16x16x64_bf16 v[32:35], v[12:15], a[24:31], v74
  s_cbranch_vccnz Cf1_rec
Cf1_recok:
  s_waitcnt lgkmcnt(3)
  v_smfmac_f32_16x16x64_bf16 v[36:39], v[16:19], a[128:135], v74
  s_waitcnt lgkmcnt(0)
  s_barrier
  ds_read_b128 v[60:63], v77
  v_smfmac_f32_16x16x64_bf16 v[40:43], v[16:19], a[136:143], v74
  ds_read_b128 v[64:67], v77 offset:128
  v_add_f32 v32, v32, v34
  v_cvt_pk_bf16_f32 v30, v28, v32
  v_smfmac_f32_16x16x64_bf16 v[36:39], v[0:3], a[112:119], v74
  ds_write_b32 v79, v30 offset:256
  v_add_f32 v33, v33, v35
  v_cvt_pk_bf16_f32 v31, v29, v33
  v_smfmac_f32_16x16x64_bf16 v[40:43], v[0:3], a[120:127], v74
  ds_write_b32 v79, v31 offset:832
  v_xor_b32 v75, 0x8000, v75
  v_smfmac_f32_16x16x64_bf16 v[36:39], v[4:7], a[144:151], v74
  ds_read_b128 v[0:3], v76 offset:4608
  v_mov_b32 v29, 0
  v_smfmac_f32_16x16x64_bf16 v[40:43], v[4:7], a[152:159], v74
  s_waitcnt vmcnt(2) lgkmcnt(3)
  v_mov_b32 v30, 0
  v_mfma_f32_16x16x32_bf16 v[44:47], v[44:47], v[60:63], 0
  ds_read_b128 v[4:7], v76 offset:5632
  s_waitcnt lgkmcnt(2)
  v_mfma_f32_16x16x32_bf16 v[44:47], v[48:51], v[64:67], v[44:47]
  s_barrier
  v_smfmac_f32_16x16x64_bf16 v[36:39], v[8:11], a[96:103], v74
  ds_read_b128 v[20:23], v77 offset:256
  ds_read_b128 v[24:27], v77 offset:384
  v_smfmac_f32_16x16x64_bf16 v[40:43], v[8:11], a[104:111], v74
  ds_read_b128 v[8:11], v76 offset:6656
  v_add_f32_dpp v72, v46, v44 quad_perm:[2,3,0,1] row_mask:0xf bank_mask:0xf
  v_add_f32_dpp v73, v47, v45 quad_perm:[2,3,0,1] row_mask:0xf bank_mask:0xf
  v_smfmac_f32_16x16x64_bf16 v[36:39], v[12:15], a[160:167], v74
  s_waitcnt lgkmcnt(4)
  v_exp_f32_dpp v72, v72 quad_perm:[0,1,0,1] row_mask:0xf bank_mask:0xf
  v_smfmac_f32_16x16x64_bf16 v[40:43], v[12:15], a[168:175], v74
  ds_read_b128 v[12:15], v76 offset:7680
  v_exp_f32_dpp v73, v73 quad_perm:[0,1,0,1] row_mask:0xf bank_mask:0xf
  v_smfmac_f32_16x16x64_bf16 v[36:39], v[0:3], a[32:39], v74
  s_waitcnt lgkmcnt(2)
  v_cvt_pk_bf16_f32 v72, v72, v73
  v_mfma_f32_16x16x32_bf16 v[20:23], v[20:23], v[60:63], 0
  ds_write_b32 v78, v72 offset:516
  v_mov_b64 v[16:17], 0
  v_mfma_f32_16x16x32_bf16 v[20:23], v[24:27], v[64:67], v[20:23]
  ds_read_b128 v[44:47], v75 offset:20480
  v_mov_b64 v[18:19], 0
  v_smfmac_f32_16x16x64_bf16 v[40:43], v[0:3], a[40:47], v74
  ds_read_b128 v[48:51], v75 offset:21504
  v_mov_b64 v[68:69], s[78:79]
  v_smfmac_f32_16x16x64_bf16 v[36:39], v[4:7], a[48:55], v74
  s_waitcnt lgkmcnt(4)
  v_add_f32_dpp v24, v22, v20 quad_perm:[2,3,0,1] row_mask:0xf bank_mask:0xf
  v_add_f32_dpp v25, v23, v21 quad_perm:[2,3,0,1] row_mask:0xf bank_mask:0xf
  v_smfmac_f32_16x16x64_bf16 v[36:39], v[8:11], a[64:71], v74
  s_waitcnt lgkmcnt(2)
  s_barrier
  ds_read_b128 v[32:35], v78 offset:512
  v_smfmac_f32_16x16x64_bf16 v[36:39], v[12:15], a[80:87], v74
  ds_read_b128 v[60:63], v75 offset:22528
  v_mul_f32 v24, s69, v24
  v_smfmac_f32_16x16x64_bf16 v[40:43], v[4:7], a[56:63], v74
  ds_read_b128 v[64:67], v75 offset:23552
  v_mul_f32 v25, s69, v25
  v_smfmac_f32_16x16x64_bf16 v[40:43], v[8:11], a[72:79], v74
  v_exp_f32_dpp v24, v24 quad_perm:[0,1,0,1] row_mask:0xf bank_mask:0xf
  v_smfmac_f32_16x16x64_bf16 v[40:43], v[12:15], a[88:95], v74
  s_waitcnt lgkmcnt(2)
  v_exp_f32_dpp v25, v25 quad_perm:[0,1,0,1] row_mask:0xf bank_mask:0xf
  v_mfma_f32_16x16x32_bf16 v[8:11], v[32:35], v[68:71], 0
  v_add_f32 v36, v36, v38
  v_add_f32 v37, v37, v39
  v_mfma_f32_16x16x32_bf16 v[0:3], v[32:35], v[52:55], 0
  v_add_f32 v40, v40, v42
  v_add_f32 v41, v41, v43
  v_mfma_f32_16x16x32_bf16 v[4:7], v[32:35], v[56:59], 0
  v_cvt_pk_bf16_f32 v28, v24, v25
  v_cvt_pk_bf16_f32 v72, v36, v37
  v_cvt_pk_bf16_f32 v73, v40, v41
  v_mfma_f32_16x16x16_bf16 v[8:11], v[28:29], v[68:69], v[8:11]
  v_cvt_pk_bf16_f32 v31, v24, v25
  v_mov_b64 v[20:21], 0
  v_mfma_f32_16x16x16_bf16 v[0:3], v[28:29], v[72:73], v[0:3]
  ds_read_b128 v[68:71], v76 offset:13824
  v_mov_b64 v[22:23], 0
  v_mfma_f32_16x16x16_bf16 v[4:7], v[30:31], v[72:73], v[4:7]
  v_rcp_f32 v10, v8
  v_rcp_f32 v11, v9
  v_mul_f32 v0, v10, v0
  v_mul_f32 v1, v11, v1
  s_nop 0
  v_mul_f32 v4, v10, v4
  v_mul_f32 v5, v11, v5
  v_cvt_pk_bf16_f32 v2, v0, v4
  ds_write_b32 v79, v2 offset:8704
  v_cvt_pk_bf16_f32 v3, v1, v5
  ds_write_b32 v79, v3 offset:9280
  v_max3_f32 v8, v8, v9, v10
  v_max_f32 v8, v8, v11
  v_cmp_le_f32 vcc, 1317011456, v8
  v_mov_b64 v[24:25], 0
  v_mov_b64 v[26:27], 0
  s_cbranch_vccnz Cf1_mx
Cf1_mxok:
  s_waitcnt lgkmcnt(0)
  s_barrier
  ds_read_b128 v[0:3], v78 offset:8704
  ds_read_b128 v[4:7], v78 offset:8768
  ds_read_b128 v[8:11], v78 offset:8832
  ds_read_b128 v[12:15], v78 offset:8896
  s_waitcnt lgkmcnt(3)
  v_smfmac_f32_16x16x64_bf16 v[16:19], v[0:3], v[44:51], v74
  ds_read_b128 v[52:55], v75 offset:36864
  s_waitcnt lgkmcnt(3)
  v_smfmac_f32_16x16x64_bf16 v[16:19], v[4:7], v[60:67], v74
  ds_read_b128 v[56:59], v75 offset:37888
  s_waitcnt lgkmcnt(3)
  v_smfmac_f32_16x16x64_bf16 v[16:19], v[8:11], a[176:183], v74
  ds_read_b128 v[36:39], v75 offset:38912
  s_waitcnt lgkmcnt(3)
  v_smfmac_f32_16x16x64_bf16 v[16:19], v[12:15], a[184:191], v74
  ds_read_b128 v[40:43], v75 offset:39936
  ds_read_b128 v[44:47], v75 offset:53248
  v_smfmac_f32_16x16x64_bf16 v[20:23], v[0:3], a[192:199], v74
  ds_read_b128 v[48:51], v75 offset:54272
  ds_read_b128 v[60:63], v75 offset:55296
  v_smfmac_f32_16x16x64_bf16 v[20:23], v[4:7], a[200:207], v74
  ds_read_b128 v[64:67], v75 offset:56320
  s_waitcnt lgkmcnt(6)
  v_cvt_pk_bf16_f32 v16, v16, v17
  v_cvt_pk_bf16_f32 v17, v18, v19
  v_bfi_b32 v16, 1, s72, v16
  v_smfmac_f32_16x16x64_bf16 v[20:23], v[8:11], v[52:59], v74
  buffer_store_dwordx2 v[16:17], v68, s[8:11], s73 offen
  s_waitcnt lgkmcnt(4)
  v_smfmac_f32_16x16x64_bf16 v[20:23], v[12:15], v[36:43], v74
  v_mov_b64 v[32:33], 0
  v_smfmac_f32_16x16x64_bf16 v[24:27], v[0:3], a[208:215], v74
  v_mov_b64 v[34:35], 0
  v_smfmac_f32_16x16x64_bf16 v[24:27], v[4:7], a[216:223], v74
  s_waitcnt lgkmcnt(2)
  v_cvt_pk_bf16_f32 v20, v20, v21
  v_cvt_pk_bf16_f32 v21, v22, v23
  v_bfi_b32 v20, 1, s72, v20
  v_smfmac_f32_16x16x64_bf16 v[24:27], v[8:11], v[44:51], v74
  buffer_store_dwordx2 v[20:21], v68, s[8:11], s74 offen
  s_waitcnt lgkmcnt(0)
  v_smfmac_f32_16x16x64_bf16 v[24:27], v[12:15], v[60:67], v74
  v_smfmac_f32_16x16x64_bf16 v[32:35], v[0:3], a[224:231], v74
  v_smfmac_f32_16x16x64_bf16 v[32:35], v[4:7], a[232:239], v74
  v_cvt_pk_bf16_f32 v24, v24, v25
  v_cvt_pk_bf16_f32 v25, v26, v27
  v_bfi_b32 v24, 1, s72, v24
  v_smfmac_f32_16x16x64_bf16 v[32:35], v[8:11], a[240:247], v74
  buffer_store_dwordx2 v[24:25], v68, s[8:11], s75 offen
  v_smfmac_f32_16x16x64_bf16 v[32:35], v[12:15], a[248:255], v74
  v_mov_b64 v[18:19], v[72:73]
  s_nop 4
  v_cvt_pk_bf16_f32 v32, v32, v33
  v_cvt_pk_bf16_f32 v33, v34, v35
  v_bfi_b32 v32, 1, s72, v32
  buffer_store_dwordx2 v[32:33], v68, s[8:11], s76 offen
  ds_read_b128 v[0:3], v76 offset:14848
  s_waitcnt lgkmcnt(0)
  ds_read_b64 v[16:17], v77 offset:264
  s_waitcnt lgkmcnt(0)
  ds_read_b128 v[64:67], v76 offset:23552
  s_waitcnt lgkmcnt(0)
  s_add_u32 s66, s66, 1
  s_xor_b32 s64, s64, 16384
  s_xor_b32 s65, s65, 16384
  s_add_u32 s58, s58, 655360
  s_add_u32 s59, s59, 655360
  s_add_u32 s70, s70, 655360
  s_add_u32 s68, s68, 655360
  s_mov_b32 m0, 11776
  s_add_u32 s85, s65, 7168
  v_xor_b32 v75, 0x8000, v75
  buffer_load_dwordx4 v[52:55], v76, s[8:11], s60 offen offset:0 sc1
  buffer_load_dwordx4 v[56:59], v76, s[8:11], s60 offen offset:1024 sc1
  s_waitcnt lgkmcnt(0)
  s_waitcnt vmcnt(1)
  v_mfma_f32_16x16x32_bf16 v[4:7], v[0:3], v[52:55], 0
  v_bitop3_b32 v72, v52, v54, s72 bitop3:0x7e
  s_waitcnt vmcnt(0)
  v_mfma_f32_16x16x32_bf16 v[4:7], v[0:3], v[56:59], v[4:7]
  v_bitop3_b32 v73, v56, v58, s72 bitop3:0x7e
  v_bitop3_b32 v72, v72, v73, 1 bitop3:0xa8
  v_cmp_ne_u32 vcc, 0, v72
  s_nop 3
  v_add_f32_dpp v4, v4, v4 row_ror:4 row_mask:0xf bank_mask:0xf
  v_add_f32_dpp v5, v5, v5 row_ror:4 row_mask:0xf bank_mask:0xf
  s_cmp_eq_u64 vcc, 0
  v_add_f32_dpp v4, v4, v4 row_ror:8 row_mask:0xf bank_mask:0xf
  v_add_f32_dpp v5, v5, v5 row_ror:8 row_mask:0xf bank_mask:0xf
  s_cselect_b32 s54, s62, 268435456
  v_cvt_pk_bf16_f32 v4, v4, v5
  buffer_store_dword v4, v69, s[8:11], s54 offen
  s_cbranch_vccnz Cf1_h1r
  s_xor_b32 s62, s62, 16384
  buffer_store_dword v71, v69, s[8:11], s62 offen
  s_xor_b32 s72, s72, 1
  s_branch Cf1_h2
Cf1_h1r:
  s_mov_b64 exec, vcc
  buffer_load_dwordx4 v[52:55], v76, s[8:11], s60 offen offset:0 sc1
  buffer_load_dwordx4 v[56:59], v76, s[8:11], s60 offen offset:1024 sc1
  s_mov_b64 exec, -1
  s_add_u32 s67, s67, 1
  s_waitcnt vmcnt(1)
  v_mfma_f32_16x16x32_bf16 v[4:7], v[0:3], v[52:55], 0
  v_bitop3_b32 v72, v52, v54, s72 bitop3:0x7e
  s_waitcnt vmcnt(0)
  v_mfma_f32_16x16x32_bf16 v[4:7], v[0:3], v[56:59], v[4:7]
  v_bitop3_b32 v73, v56, v58, s72 bitop3:0x7e
  v_bitop3_b32 v72, v72, v73, 1 bitop3:0xa8
  v_cmp_ne_u32 vcc, 0, v72
  s_cbranch_vccz Cf1_h1p
Cf1_h1s:
  s_mov_b64 exec, vcc
  buffer_load_dwordx4 v[52:55], v76, s[8:11], s60 offen offset:0 sc1
  buffer_load_dwordx4 v[56:59], v76, s[8:11], s60 offen offset:1024 sc1
  s_mov_b64 exec, -1
  s_add_u32 s67, s67, 1
  s_waitcnt vmcnt(1)
  v_mfma_f32_16x16x32_bf16 v[4:7], v[0:3], v[52:55], 0
  v_bitop3_b32 v72, v52, v54, s72 bitop3:0x7e
  s_waitcnt vmcnt(0)
  v_mfma_f32_16x16x32_bf16 v[4:7], v[0:3], v[56:59], v[4:7]
  v_bitop3_b32 v73, v56, v58, s72 bitop3:0x7e
  v_bitop3_b32 v72, v72, v73, 1 bitop3:0xa8
  v_cmp_ne_u32 vcc, 0, v72
  s_cbranch_vccz Cf1_h1p
  s_cmp_lt_u32 s67, 131072
  s_cbranch_scc1 Cf1_h1s
Cf1_h1p:
  s_nop 2
  v_add_f32_dpp v4, v4, v4 row_ror:4 row_mask:0xf bank_mask:0xf
  v_add_f32_dpp v5, v5, v5 row_ror:4 row_mask:0xf bank_mask:0xf
  s_nop 0
  v_add_f32_dpp v4, v4, v4 row_ror:8 row_mask:0xf bank_mask:0xf
  v_add_f32_dpp v5, v5, v5 row_ror:8 row_mask:0xf bank_mask:0xf
  v_cvt_pk_bf16_f32 v4, v4, v5
  buffer_store_dword v4, v69, s[8:11], s62 offen
  s_xor_b32 s62, s62, 16384
  buffer_store_dword v71, v69, s[8:11], s62 offen
  s_xor_b32 s72, s72, 1
  s_branch Cf1_h2
Cf1_h2r:
  s_mov_b64 exec, vcc
  buffer_load_dwordx4 v[8:11], v76, s[8:11], s65 offen offset:2048 sc1
  s_mov_b64 exec, -1
  s_add_u32 s67, s67, 1
  s_waitcnt vmcnt(4)
  v_max3_u32 v72, v8, v9, v10
  v_max_u32 v72, v72, v11
  ds_write_b128 v76, v[8:11] offset:6656
  v_cmp_eq_u32 vcc, -1, v72
  s_cbranch_vccz Cf1_h2w
  s_mov_b64 exec, vcc
  buffer_load_dwordx4 v[8:11], v76, s[8:11], s65 offen offset:2048 sc1
  s_mov_b64 exec, -1
  s_add_u32 s67, s67, 1
  s_waitcnt vmcnt(4)
  v_max3_u32 v72, v8, v9, v10
  v_max_u32 v72, v72, v11
  ds_write_b128 v76, v[8:11] offset:6656
  v_cmp_eq_u32 vcc, -1, v72
  s_cbranch_vccz Cf1_h2w
Cf1_h2s:
  s_mov_b64 exec, vcc
  buffer_load_dwordx4 v[8:11], v76, s[8:11], s65 offen offset:2048 sc1
  s_mov_b64 exec, -1
  s_add_u32 s67, s67, 1
  s_waitcnt vmcnt(2)
  v_max3_u32 v72, v8, v9, v10
  v_max_u32 v72, v72, v11
  ds_write_b128 v76, v[8:11] offset:6656
  v_cmp_eq_u32 vcc, -1, v72
  s_cbranch_vccz Cf1_h2w
  s_mov_b64 exec, vcc
  buffer_load_dwordx4 v[8:11], v76, s[8:11], s65 offen offset:2048 sc1
  s_mov_b64 exec, -1
  s_add_u32 s67, s67, 1
  s_waitcnt vmcnt(2)
  v_max3_u32 v72, v8, v9, v10
  v_max_u32 v72, v72, v11
  ds_write_b128 v76, v[8:11] offset:6656
  v_cmp_eq_u32 vcc, -1, v72
  s_cbranch_vccz Cf1_h2w
  s_mov_b64 exec, vcc
  buffer_load_dwordx4 v[8:11], v76, s[8:11], s65 offen offset:2048 sc1
  s_mov_b64 exec, -1
  s_add_u32 s67, s67, 1
  s_waitcnt vmcnt(2)
  v_max3_u32 v72, v8, v9, v10
  v_max_u32 v72, v72, v11
  ds_write_b128 v76, v[8:11] offset:6656
  v_cmp_eq_u32 vcc, -1, v72
  s_cbranch_vccz Cf1_h2w
  s_cmp_lt_u32 s67, 131072
  s_cbranch_scc1 Cf1_h2s
  s_branch Cf1_h2w
Cf1_rec:
  s_nop 7
  s_waitcnt vmcnt(0) lgkmcnt(0)
  v_max3_u32 v72, v0, v1, v2
  v_max3_u32 v72, v72, v3, v4
  v_max3_u32 v72, v72, v5, v6
  v_max3_u32 v72, v72, v7, v8
  v_max3_u32 v72, v72, v9, v10
  v_max3_u32 v72, v72, v11, v12
  v_max3_u32 v72, v72, v13, v14
  v_max3_u32 v72, v72, v15, v16
  v_max3_u32 v72, v72, v17, v18
  v_max_u32 v72, v72, v19
  v_cmp_eq_u32 vcc, -1, v72
  s_cbranch_vccz Cf1_recok
  s_barrier
  v_mov_b64 v[20:21], 0
  v_mov_b64 v[22:23], 0
  v_mov_b64 v[24:25], 0
  v_mov_b64 v[26:27], 0
  v_mov_b64 v[28:29], 0
  v_mov_b64 v[30:31], 0
  v_mov_b64 v[32:33], 0
  v_mov_b64 v[34:35], 0
  s_waitcnt lgkmcnt(0)
  s_barrier
  ds_read_b128 v[0:3], v76 offset:4608
  s_waitcnt lgkmcnt(0)
  v_smfmac_f32_16x16x64_bf16 v[20:23], v[0:3], v[80:87], v74
  v_smfmac_f32_16x16x64_bf16 v[24:27], v[0:3], v[88:95], v74
  ds_read_b128 v[60:63], v76 offset:20480
  ds_read_b128 v[64:67], v76 offset:21504
  s_waitcnt lgkmcnt(0)
  v_smfmac_f32_16x16x64_bf16 v[28:31], v[0:3], v[60:67], v74
  ds_read_b128 v[60:63], v76 offset:22528
  ds_read_b128 v[64:67], v76 offset:23552
  s_waitcnt lgkmcnt(0)
  v_smfmac_f32_16x16x64_bf16 v[32:35], v[0:3], v[60:67], v74
  ds_read_b128 v[4:7], v76 offset:5632
  s_waitcnt lgkmcnt(0)
  v_smfmac_f32_16x16x64_bf16 v[20:23], v[4:7], v[96:103], v74
  v_smfmac_f32_16x16x64_bf16 v[24:27], v[4:7], v[104:111], v74
  ds_read_b128 v[60:63], v76 offset:36864
  ds_read_b128 v[64:67], v76 offset:37888
  s_waitcnt lgkmcnt(0)
  v_smfmac_f32_16x16x64_bf16 v[28:31], v[4:7], v[60:67], v74
  ds_read_b128 v[60:63], v76 offset:38912
  ds_read_b128 v[64:67], v76 offset:39936
  s_waitcnt lgkmcnt(0)
  v_smfmac_f32_16x16x64_bf16 v[32:35], v[4:7], v[60:67], v74
  ds_read_b128 v[8:11], v76 offset:6656
  s_waitcnt lgkmcnt(0)
  v_smfmac_f32_16x16x64_bf16 v[20:23], v[8:11], v[112:119], v74
  v_smfmac_f32_16x16x64_bf16 v[24:27], v[8:11], v[120:127], v74
  v_smfmac_f32_16x16x64_bf16 v[28:31], v[8:11], v[208:215], v74
  v_smfmac_f32_16x16x64_bf16 v[32:35], v[8:11], v[216:223], v74
  ds_read_b128 v[12:15], v76 offset:7680
  s_waitcnt lgkmcnt(0)
  v_smfmac_f32_16x16x64_bf16 v[20:23], v[12:15], v[128:135], v74
  v_smfmac_f32_16x16x64_bf16 v[24:27], v[12:15], v[136:143], v74
  v_smfmac_f32_16x16x64_bf16 v[28:31], v[12:15], v[224:231], v74
  v_smfmac_f32_16x16x64_bf16 v[32:35], v[12:15], v[232:239], v74
  ds_read_b128 v[8:11], v76 offset:8704
  s_waitcnt lgkmcnt(0)
  v_smfmac_f32_16x16x64_bf16 v[20:23], v[8:11], v[144:151], v74
  v_smfmac_f32_16x16x64_bf16 v[24:27], v[8:11], v[152:159], v74
  ds_read_b128 v[60:63], v76 offset:53248
  ds_read_b128 v[64:67], v76 offset:54272
  s_waitcnt lgkmcnt(0)
  v_smfmac_f32_16x16x64_bf16 v[28:31], v[8:11], v[60:67], v74
  ds_read_b128 v[60:63], v76 offset:55296
  ds_read_b128 v[64:67], v76 offset:56320
  s_waitcnt lgkmcnt(0)
  v_smfmac_f32_16x16x64_bf16 v[32:35], v[8:11], v[60:67], v74
  ds_read_b128 v[0:3], v76 offset:9728
  s_waitcnt lgkmcnt(0)
  v_smfmac_f32_16x16x64_bf16 v[20:23], v[0:3], v[160:167], v74
  v_smfmac_f32_16x16x64_bf16 v[24:27], v[0:3], v[168:175], v74
  ds_read_b128 v[60:63], v75 offset:20480
  ds_read_b128 v[64:67], v75 offset:21504
  s_waitcnt lgkmcnt(0)
  v_smfmac_f32_16x16x64_bf16 v[28:31], v[0:3], v[60:67], v74
  ds_read_b128 v[60:63], v75 offset:22528
  ds_read_b128 v[64:67], v75 offset:23552
  s_waitcnt lgkmcnt(0)
  v_smfmac_f32_16x16x64_bf16 v[32:35], v[0:3], v[60:67], v74
  ds_read_b128 v[16:19], v76 offset:10752
  ds_read_b128 v[60:63], v75 offset:4096
  ds_read_b128 v[64:67], v75 offset:5120
  s_waitcnt lgkmcnt(0)
  v_smfmac_f32_16x16x64_bf16 v[20:23], v[16:19], v[60:67], v74
  ds_read_b128 v[60:63], v75 offset:6144
  ds_read_b128 v[64:67], v75 offset:7168
  s_waitcnt lgkmcnt(0)
  v_smfmac_f32_16x16x64_bf16 v[24:27], v[16:19], v[60:67], v74
  v_smfmac_f32_16x16x64_bf16 v[28:31], v[16:19], v[240:247], v74
  v_smfmac_f32_16x16x64_bf16 v[32:35], v[16:19], v[248:255], v74
  ds_read_b128 v[4:7], v76 offset:11776
  s_waitcnt lgkmcnt(0)
  v_smfmac_f32_16x16x64_bf16 v[20:23], v[4:7], v[176:183], v74
  v_smfmac_f32_16x16x64_bf16 v[24:27], v[4:7], v[184:191], v74
  v_smfmac_f32_16x16x64_bf16 v[28:31], v[4:7], a[0:7], v74
  v_smfmac_f32_16x16x64_bf16 v[32:35], v[4:7], a[8:15], v74
  ds_read_b128 v[12:15], v76 offset:12800
  s_waitcnt lgkmcnt(0)
  v_smfmac_f32_16x16x64_bf16 v[20:23], v[12:15], v[192:199], v74
  v_smfmac_f32_16x16x64_bf16 v[24:27], v[12:15], v[200:207], v74
  v_smfmac_f32_16x16x64_bf16 v[28:31], v[12:15], a[16:23], v74
  v_smfmac_f32_16x16x64_bf16 v[32:35], v[12:15], a[24:31], v74
  v_add_f32 v20, v20, v22
  v_add_f32 v21, v21, v23
  v_add_f32 v24, v24, v26
  v_cvt_pk_bf16_f32 v22, v20, v24
  ds_write_b32 v79, v22 offset:0
  v_add_f32 v25, v25, v27
  v_cvt_pk_bf16_f32 v23, v21, v25
  ds_write_b32 v79, v23 offset:576
  v_add_f32 v28, v28, v30
  v_add_f32 v29, v29, v31
  s_waitcnt lgkmcnt(0)
  s_nop 1
  s_branch Cf1_recok
Cf1_mx:
  s_waitcnt lgkmcnt(0)
  s_barrier
  buffer_load_dwordx4 v[0:3], v76, s[8:11], s58 offen offset:0 sc1
  ds_read_b128 v[20:23], v77 offset:0
  ds_read_b128 v[28:31], v77 offset:256
  buffer_load_dwordx4 v[4:7], v76, s[8:11], s58 offen offset:1024 sc1
  ds_read_b128 v[24:27], v77 offset:128
  ds_read_b128 v[32:35], v77 offset:384
  s_waitcnt vmcnt(1) lgkmcnt(3)
  v_mfma_f32_16x16x32_bf16 v[8:11], v[0:3], v[20:23], 0
  s_waitcnt vmcnt(0) lgkmcnt(1)
  v_mfma_f32_16x16x32_bf16 v[8:11], v[4:7], v[24:27], v[8:11]
  v_mfma_f32_16x16x32_bf16 v[12:15], v[28:31], v[20:23], 0
  s_waitcnt lgkmcnt(0)
  v_mfma_f32_16x16x32_bf16 v[12:15], v[32:35], v[24:27], v[12:15]
  v_add_f32_dpp v8, v10, v8 quad_perm:[2,3,0,1] row_mask:0xf bank_mask:0xf
  v_add_f32_dpp v9, v11, v9 quad_perm:[2,3,0,1] row_mask:0xf bank_mask:0xf
  s_nop 0
  v_mov_b32_dpp v8, v8 quad_perm:[0,1,0,1] row_mask:0xf bank_mask:0xf
  v_mov_b32_dpp v9, v9 quad_perm:[0,1,0,1] row_mask:0xf bank_mask:0xf
  s_nop 1
  v_add_f32_dpp v12, v14, v12 quad_perm:[2,3,0,1] row_mask:0xf bank_mask:0xf
  v_add_f32_dpp v13, v15, v13 quad_perm:[2,3,0,1] row_mask:0xf bank_mask:0xf
  s_nop 0
  v_mov_b32_dpp v12, v12 quad_perm:[0,1,0,1] row_mask:0xf bank_mask:0xf
  v_mov_b32_dpp v13, v13 quad_perm:[0,1,0,1] row_mask:0xf bank_mask:0xf
  v_mul_f32 v12, s69, v12
  ds_write_b32 v78, v8 offset:8708
  v_mul_f32 v13, s69, v13
  ds_write_b32 v78, v9 offset:8772
  s_waitcnt lgkmcnt(0)
  s_barrier
  ds_read_b128 v[36:39], v78 offset:8704
  ds_read_b128 v[40:43], v78 offset:8768
  s_waitcnt lgkmcnt(0)
  s_barrier
  v_max_f32 v16, v36, v37
  v_max3_f32 v16, v16, v38, v39
  v_max3_f32 v16, v16, v40, v41
  v_max3_f32 v16, v16, v42, v43
  v_max3_f32 v16, v16, v12, v13
  v_mov_b32 v17, v16
  s_nop 1
  v_permlane16_swap_b32 v16, v17
  v_max_f32 v16, v16, v17
  v_mov_b32 v17, v16
  s_nop 1
  v_permlane32_swap_b32 v16, v17
  v_max_f32 v16, v16, v17
  v_sub_f32 v36, v36, v16
  v_sub_f32 v37, v37, v16
  v_sub_f32 v38, v38, v16
  v_sub_f32 v39, v39, v16
  v_sub_f32 v40, v40, v16
  v_sub_f32 v41, v41, v16
  v_sub_f32 v42, v42, v16
  v_sub_f32 v43, v43, v16
  v_sub_f32 v12, v12, v16
  v_sub_f32 v13, v13, v16
  v_exp_f32 v36, v36
  v_exp_f32 v37, v37
  v_exp_f32 v38, v38
  v_exp_f32 v39, v39
  v_exp_f32 v40, v40
  v_exp_f32 v41, v41
  v_exp_f32 v42, v42
  v_exp_f32 v43, v43
  v_exp_f32 v12, v12
  v_exp_f32 v13, v13
  v_cvt_pk_bf16_f32 v32, v36, v40
  v_cvt_pk_bf16_f32 v33, v37, v41
  v_cvt_pk_bf16_f32 v34, v38, v42
  v_cvt_pk_bf16_f32 v35, v39, v43
  v_cvt_pk_bf16_f32 v28, v12, v13
  v_cvt_pk_bf16_f32 v31, v12, v13
  v_mov_b32 v29, 0
  v_mov_b32 v30, 0
  v_mov_b32 v68, 0x3f803f80
  v_mov_b32 v69, 0x3f803f80
  v_mov_b32 v70, 0x3f803f80
  v_mov_b32 v71, 0x3f803f80
  s_nop 1
  v_mfma_f32_16x16x32_bf16 v[8:11], v[32:35], v[68:71], 0
  v_mfma_f32_16x16x32_bf16 v[0:3], v[32:35], v[52:55], 0
  v_mfma_f32_16x16x32_bf16 v[4:7], v[32:35], v[56:59], 0
  v_mfma_f32_16x16x16_bf16 v[8:11], v[28:29], v[68:69], v[8:11]
  v_mfma_f32_16x16x16_bf16 v[0:3], v[28:29], v[72:73], v[0:3]
  v_mfma_f32_16x16x16_bf16 v[4:7], v[30:31], v[72:73], v[4:7]
  ds_read_b128 v[68:71], v76 offset:13824
  v_rcp_f32 v10, v8
  v_rcp_f32 v11, v9
  v_mul_f32 v0, v10, v0
  v_mul_f32 v1, v11, v1
  s_nop 0
  v_mul_f32 v4, v10, v4
  v_mul_f32 v5, v11, v5
  v_cvt_pk_bf16_f32 v2, v0, v4
  ds_write_b32 v79, v2 offset:8704
  v_cvt_pk_bf16_f32 v3, v1, v5
  ds_write_b32 v79, v3 offset:9280
  v_mov_b64 v[16:17], 0
  v_mov_b64 v[18:19], 0
  v_mov_b64 v[20:21], 0
  v_mov_b64 v[22:23], 0
  v_mov_b64 v[24:25], 0
  v_mov_b64 v[26:27], 0
  s_branch Cf1_mxok
Cf1_last:
  ds_read_b128 v[4:7], v76 offset:5632
  ds_read_b128 v[12:15], v76 offset:7680
  ds_read_b128 v[44:47], v76 offset:36864
  ds_read_b128 v[48:51], v76 offset:37888
  s_nop 5
  v_mov_b64 v[20:21], 0
  v_mov_b64 v[22:23], 0
  v_mov_b64 v[24:25], 0
  v_mov_b64 v[26:27], 0
  s_waitcnt lgkmcnt(4)
  v_smfmac_f32_16x16x64_bf16 v[28:31], v[0:3], v[36:43], v74
  ds_read_b128 v[36:39], v76 offset:38912
  ds_read_b128 v[40:43], v76 offset:39936
  v_smfmac_f32_16x16x64_bf16 v[32:35], v[0:3], v[60:67], v74
  s_waitcnt lgkmcnt(5)
  v_smfmac_f32_16x16x64_bf16 v[20:23], v[0:3], a[32:39], v74
  ds_read_b128 v[60:63], v76 offset:53248
  ds_read_b128 v[64:67], v76 offset:54272
  v_smfmac_f32_16x16x64_bf16 v[24:27], v[0:3], a[40:47], v74
  s_waitcnt lgkmcnt(4)
  v_smfmac_f32_16x16x64_bf16 v[20:23], v[4:7], a[48:55], v74
  buffer_store_dwordx4 v[16:19], v76, s[8:11], s68 offen sc1
  v_smfmac_f32_16x16x64_bf16 v[24:27], v[4:7], a[56:63], v74
  v_smfmac_f32_16x16x64_bf16 v[28:31], v[4:7], v[44:51], v74
  s_waitcnt lgkmcnt(2)
  v_smfmac_f32_16x16x64_bf16 v[20:23], v[8:11], a[64:71], v74
  ds_read_b128 v[44:47], v76 offset:55296
  ds_read_b128 v[48:51], v76 offset:56320
  v_smfmac_f32_16x16x64_bf16 v[24:27], v[8:11], a[72:79], v74
  v_smfmac_f32_16x16x64_bf16 v[32:35], v[4:7], v[36:43], v74
  v_smfmac_f32_16x16x64_bf16 v[28:31], v[8:11], v[208:215], v74
  ds_read_b128 v[36:39], v75 offset:20480
  ds_read_b128 v[40:43], v75 offset:21504
  v_smfmac_f32_16x16x64_bf16 v[32:35], v[8:11], v[216:223], v74
  v_smfmac_f32_16x16x64_bf16 v[20:23], v[12:15], a[80:87], v74
  v_smfmac_f32_16x16x64_bf16 v[24:27], v[12:15], a[88:95], v74
  v_smfmac_f32_16x16x64_bf16 v[28:31], v[12:15], v[224:231], v74
  v_smfmac_f32_16x16x64_bf16 v[32:35], v[12:15], v[232:239], v74
  s_waitcnt vmcnt(2)
  s_waitcnt vmcnt(1)
  s_barrier
Cf1_lastr:
  ds_read_b128 v[8:11], v76 offset:8704
  ds_read_b128 v[0:3], v76 offset:9728
  ds_read_b128 v[16:19], v76 offset:10752
  ds_read_b128 v[4:7], v76 offset:11776
  ds_read_b128 v[12:15], v76 offset:12800
  s_waitcnt lgkmcnt(3)
  v_max3_u32 v72, v0, v1, v2
  s_waitcnt lgkmcnt(1)
  v_max3_u32 v72, v72, v3, v4
  v_max3_u32 v72, v72, v5, v6
  v_max3_u32 v72, v72, v7, v8
  v_max3_u32 v72, v72, v9, v10
  s_waitcnt lgkmcnt(0)
  v_max3_u32 v72, v72, v11, v12
  v_max3_u32 v72, v72, v13, v14
  v_max3_u32 v72, v72, v15, v16
  v_max3_u32 v72, v72, v17, v18
  v_max_u32 v72, v72, v19
  v_cmp_eq_u32 vcc, -1, v72
  s_cbranch_vccnz Cf1_lastp
Cf1_lastg:
  v_smfmac_f32_16x16x64_bf16 v[28:31], v[8:11], v[60:67], v74
  ds_read_b128 v[60:63], v75 offset:22528
  ds_read_b128 v[64:67], v75 offset:23552
  v_smfmac_f32_16x16x64_bf16 v[32:35], v[8:11], v[44:51], v74
  v_smfmac_f32_16x16x64_bf16 v[28:31], v[0:3], v[36:43], v74
  v_smfmac_f32_16x16x64_bf16 v[28:31], v[16:19], v[240:247], v74
  v_smfmac_f32_16x16x64_bf16 v[28:31], v[4:7], a[0:7], v74
  v_smfmac_f32_16x16x64_bf16 v[28:31], v[12:15], a[16:23], v74
  v_smfmac_f32_16x16x64_bf16 v[32:35], v[16:19], v[248:255], v74
  v_smfmac_f32_16x16x64_bf16 v[32:35], v[4:7], a[8:15], v74
  s_waitcnt lgkmcnt(0)
  v_smfmac_f32_16x16x64_bf16 v[32:35], v[12:15], a[24:31], v74
  v_smfmac_f32_16x16x64_bf16 v[32:35], v[0:3], v[60:67], v74
  v_smfmac_f32_16x16x64_bf16 v[20:23], v[8:11], a[96:103], v74
  v_smfmac_f32_16x16x64_bf16 v[20:23], v[0:3], a[112:119], v74
  v_add_f32 v28, v28, v30
  v_add_f32 v32, v32, v34
  v_cvt_pk_bf16_f32 v30, v28, v32
  v_smfmac_f32_16x16x64_bf16 v[20:23], v[16:19], a[128:135], v74
  ds_write_b32 v79, v30 offset:256
  v_add_f32 v29, v29, v31
  v_add_f32 v33, v33, v35
  v_cvt_pk_bf16_f32 v31, v29, v33
  v_smfmac_f32_16x16x64_bf16 v[20:23], v[4:7], a[144:151], v74
  ds_write_b32 v79, v31 offset:832
  v_smfmac_f32_16x16x64_bf16 v[20:23], v[12:15], a[160:167], v74
  v_smfmac_f32_16x16x64_bf16 v[24:27], v[8:11], a[104:111], v74
  v_smfmac_f32_16x16x64_bf16 v[24:27], v[0:3], a[120:127], v74
  v_smfmac_f32_16x16x64_bf16 v[24:27], v[16:19], a[136:143], v74
  s_waitcnt lgkmcnt(0)
  s_barrier
  ds_read_b64 v[52:53], v77 offset:264
  v_add_f32 v20, v20, v22
  v_smfmac_f32_16x16x64_bf16 v[24:27], v[4:7], a[152:159], v74
  v_add_f32 v21, v21, v23
  v_smfmac_f32_16x16x64_bf16 v[24:27], v[12:15], a[168:175], v74
  v_cvt_pk_bf16_f32 v54, v20, v21
  s_add_u32 s68, s68, 655360
  s_nop 3
  v_add_f32 v24, v24, v26
  v_add_f32 v25, v25, v27
  v_cvt_pk_bf16_f32 v55, v24, v25
  s_waitcnt lgkmcnt(0)
  buffer_store_dwordx4 v[52:55], v76, s[8:11], s68 offen sc1
  s_branch Cf1_done
Cf1_lastp:
  s_add_u32 s72, s72, 2
  s_cmp_ge_u32 s72, 131072
  s_cbranch_scc1 Cf1_lastg
  s_barrier
  buffer_load_dwordx4 v76, s[8:11], s85 offen offset:0 sc1 lds
  s_waitcnt vmcnt(0)
  s_barrier
  s_branch Cf1_lastr
Cf1_done:
  s_branch L_cexit
L_w2:
  v_mov_b64 v[20:21], 0
  v_mov_b64 v[22:23], 0
  v_mov_b64 v[24:25], 0
  v_mov_b64 v[26:27], 0
  v_mov_b64 v[28:29], 0
  v_mov_b64 v[30:31], 0
  v_mov_b64 v[32:33], 0
  v_mov_b64 v[34:35], 0
  s_mov_b32 s78, 0x3f803f80
  s_mov_b32 s79, s78
  s_mov_b32 s65, 360448
  s_mov_b32 m0, 15872
  s_lshl_b32 s71, s53, 2
  s_add_u32 s71, s71, 128
  s_movk_i32 s56, 0x1000
  v_lshlrev_b32 v73, 2, v76
  v_mov_b32 v72, 0
  s_mov_b64 s[16:17], s[8:9]
  s_mov_b32 s18, 268435456
  s_mov_b32 s19, 0x20000
  s_getpc_b64 s[20:21]
Cf2_pc:
  s_add_u32 s20, s20, (Cf2_last - Cf2_pc)
  s_addc_u32 s21, s21, 0
  v_mov_b32 v68, 14880
  buffer_load_dwordx4 v[52:55], v76, s[8:11], s59 offen offset:0 sc1
  buffer_load_dwordx4 v[56:59], v76, s[8:11], s59 offen offset:1024 sc1
  ds_read_b128 v[36:39], v76 offset:24576
  ds_read_b128 v[40:43], v76 offset:25600
  ds_read_b128 v[60:63], v76 offset:26624
  ds_read_b128 v[64:67], v76 offset:27648
  ds_read_b128 v[0:3], v76 offset:4608
  ds_read_b128 v[4:7], v76 offset:5632
  ds_read_b128 v[8:11], v76 offset:6656
  ds_read_b128 v[12:15], v76 offset:7680
  s_waitcnt lgkmcnt(0)
  s_cmp_eq_u32 s66, 1
  s_branch Cf2_top2
.p2align 6
Cf2_h2:
  s_cmp_eq_u32 s66, 62
  s_cselect_b64 s[16:17], s[20:21], s[16:17]
  s_cselect_b32 s18, (Cf2_done - Cf2_last), s18
  s_cselect_b32 s70, 0, s70
  s_cmp_eq_u32 s66, 63
  s_cselect_b32 s59, 268435456, s59
  s_cselect_b32 s58, 268435456, s58
  buffer_load_dwordx4 v[12:15], v76, s[8:11], s65 offen offset:3072 sc1
  ds_read_b128 v[36:39], v76 offset:24576
  s_waitcnt lgkmcnt(0)
  v_mov_b64 v[28:29], 0
  v_mov_b64 v[30:31], 0
  v_mov_b64 v[32:33], 0
  v_mov_b64 v[34:35], 0
  v_lshlrev_b32 v73, 2, v76
  buffer_load_dwordx4 v[12:15], v76, s[8:11], s65 offen offset:3072 sc1
  ds_read_b128 v[40:43], v76 offset:25600
  s_waitcnt lgkmcnt(0)
  v_mov_b64 v[20:21], 0
  v_mov_b64 v[22:23], 0
  v_mov_b64 v[24:25], 0
  v_mov_b64 v[26:27], 0
  v_mov_b32 v68, 14880
  buffer_load_dwordx4 v[12:15], v76, s[8:11], s65 offen offset:3072 sc1
  buffer_load_dwordx4 v[52:55], v76, s[8:11], s59 offen offset:0 sc1
  buffer_load_dwordx4 v[56:59], v76, s[8:11], s59 offen offset:1024 sc1
  s_waitcnt vmcnt(4)
  v_max3_u32 v72, v12, v13, v14
  v_max_u32 v72, v72, v15
  ds_write_b128 v76, v[12:15] offset:7680
  v_cmp_eq_u32 vcc, -1, v72
  s_cbranch_vccnz Cf2_h2r
Cf2_h2w:
  s_cmp_eq_u32 s66, 63
  s_waitcnt lgkmcnt(0)
  s_barrier
  ds_read_b128 v[0:3], v76 offset:4608
  buffer_load_dwordx4 v76, s[8:11], s85 offen offset:0 sc1 lds
Cf2_top2:
  v_smfmac_f32_16x16x64_bf16 v[20:23], v[12:15], v[128:135], v74
  s_cbranch_scc1 Cf2_last
  v_smfmac_f32_16x16x64_bf16 v[24:27], v[12:15], v[136:143], v74
  buffer_load_dwordx4 v[44:47], v76, s[8:11], s58 offen offset:0 sc1
  s_mov_b32 m0, 15872
  v_smfmac_f32_16x16x64_bf16 v[28:31], v[12:15], v[224:231], v74
  buffer_load_dwordx4 v[48:51], v76, s[8:11], s58 offen offset:1024 sc1
  v_smfmac_f32_16x16x64_bf16 v[32:35], v[12:15], v[232:239], v74
  ds_read_b128 v[4:7], v76 offset:5632
  s_waitcnt lgkmcnt(1)
  v_smfmac_f32_16x16x64_bf16 v[20:23], v[0:3], v[80:87], v74
  ds_read_b128 v[8:11], v76 offset:6656
  v_smfmac_f32_16x16x64_bf16 v[28:31], v[0:3], v[36:43], v74
  ds_read_b128 v[36:39], v76 offset:40960
  v_smfmac_f32_16x16x64_bf16 v[24:27], v[0:3], v[88:95], v74
  buffer_store_dwordx4 v[16:19], v76, s[8:11], s68 offen sc1
  ds_read_b128 v[40:43], v76 offset:41984
  v_smfmac_f32_16x16x64_bf16 v[32:35], v[0:3], v[60:67], v74
  buffer_load_dword v73, s[16:19], s70 offen lds
  ds_read_b128 v[60:63], v76 offset:43008
  s_waitcnt lgkmcnt(4)
  v_smfmac_f32_16x16x64_bf16 v[20:23], v[4:7], v[96:103], v74
  ds_read_b128 v[64:67], v76 offset:44032
  v_smfmac_f32_16x16x64_bf16 v[24:27], v[4:7], v[104:111], v74
  s_waitcnt vmcnt(5)
  s_waitcnt lgkmcnt(4)
  v_smfmac_f32_16x16x64_bf16 v[20:23], v[8:11], v[112:119], v74
  s_barrier
  ds_read_b128 v[12:15], v76 offset:8704
  s_waitcnt lgkmcnt(3)
  v_smfmac_f32_16x16x64_bf16 v[28:31], v[4:7], v[36:43], v74
  ds_read_b128 v[36:39], v76 offset:57344
  v_smfmac_f32_16x16x64_bf16 v[24:27], v[8:11], v[120:127], v74
  ds_read_b128 v[40:43], v76 offset:58368
  s_waitcnt lgkmcnt(3)
  v_smfmac_f32_16x16x64_bf16 v[32:35], v[4:7], v[60:67], v74
  ds_read_b128 v[0:3], v76 offset:9728
  v_smfmac_f32_16x16x64_bf16 v[28:31], v[8:11], v[208:215], v74
  ds_read_b128 v[60:63], v76 offset:59392
  v_smfmac_f32_16x16x64_bf16 v[32:35], v[8:11], v[216:223], v74
  s_waitcnt vmcnt(4)
  ds_read_b128 v[64:67], v76 offset:60416
  s_waitcnt lgkmcnt(5)
  v_smfmac_f32_16x16x64_bf16 v[20:23], v[12:15], v[144:151], v74
  s_barrier
  ds_read_b128 v[4:7], v76 offset:11776
  s_waitcnt lgkmcnt(4)
  v_smfmac_f32_16x16x64_bf16 v[28:31], v[12:15], v[36:43], v74
  ds_read_b128 v[8:11], v76 offset:12800
  ds_read_b128 v[36:39], v75 offset:8192
  v_smfmac_f32_16x16x64_bf16 v[24:27], v[12:15], v[152:159], v74
  ds_read_b128 v[16:19], v76 offset:10752
  s_waitcnt lgkmcnt(6)
  v_smfmac_f32_16x16x64_bf16 v[20:23], v[0:3], v[160:167], v74
  ds_read_b128 v[40:43], v75 offset:9216
  s_waitcnt lgkmcnt(5)
  v_smfmac_f32_16x16x64_bf16 v[32:35], v[12:15], v[60:67], v74
  ds_read_b128 v[60:63], v75 offset:10240
  v_smfmac_f32_16x16x64_bf16 v[24:27], v[0:3], v[168:175], v74
  ds_read_b128 v[64:67], v75 offset:11264
  s_waitcnt lgkmcnt(6)
  v_smfmac_f32_16x16x64_bf16 v[20:23], v[4:7], v[176:183], v74
  s_waitcnt lgkmcnt(5)
  v_smfmac_f32_16x16x64_bf16 v[20:23], v[8:11], v[192:199], v74
  s_waitcnt lgkmcnt(2)
  v_smfmac_f32_16x16x64_bf16 v[20:23], v[16:19], v[36:43], v74
  ds_read_b128 v[36:39], v75 offset:24576
  v_smfmac_f32_16x16x64_bf16 v[24:27], v[4:7], v[184:191], v74
  ds_read_b128 v[40:43], v75 offset:25600
  s_waitcnt lgkmcnt(2)
  v_smfmac_f32_16x16x64_bf16 v[24:27], v[16:19], v[60:67], v74
  ds_read_b128 v[60:63], v75 offset:26624
  v_add_f32 v20, v20, v22
  v_smfmac_f32_16x16x64_bf16 v[24:27], v[8:11], v[200:207], v74
  ds_read_b128 v[64:67], v75 offset:27648
  v_add_f32 v21, v21, v23
  v_smfmac_f32_16x16x64_bf16 v[28:31], v[16:19], v[240:247], v74
  v_mov_b64 v[70:71], s[78:79]
  v_smfmac_f32_16x16x64_bf16 v[28:31], v[4:7], a[0:7], v74
  s_waitcnt lgkmcnt(2)
  v_add_f32 v24, v24, v26
  v_smfmac_f32_16x16x64_bf16 v[28:31], v[0:3], v[36:43], v74
  ds_read_b128 v[36:39], v68
  v_cvt_pk_bf16_f32 v22, v20, v24
  v_smfmac_f32_16x16x64_bf16 v[28:31], v[8:11], a[16:23], v74
  ds_read_b128 v[40:43], v68
  ds_write_b32 v79, v22 offset:0
  s_waitcnt lgkmcnt(3)
  v_add_f32 v25, v25, v27
  v_cvt_pk_bf16_f32 v23, v21, v25
  v_smfmac_f32_16x16x64_bf16 v[32:35], v[0:3], v[60:67], v74
  ds_write_b32 v79, v23 offset:576
  v_cmp_u_f32 vcc, v20, v21
  v_smfmac_f32_16x16x64_bf16 v[32:35], v[16:19], v[248:255], v74
  v_add_f32 v28, v28, v30
  v_smfmac_f32_16x16x64_bf16 v[32:35], v[4:7], a[8:15], v74
  v_add_f32 v29, v29, v31
  v_smfmac_f32_16x16x64_bf16 v[32:35], v[8:11], a[24:31], v74
  s_cbranch_vccnz Cf2_rec
Cf2_recok:
  s_waitcnt lgkmcnt(3)
  v_smfmac_f32_16x16x64_bf16 v[36:39], v[16:19], a[128:135], v74
  s_waitcnt lgkmcnt(0)
  s_barrier
  ds_read_b128 v[60:63], v77
  v_smfmac_f32_16x16x64_bf16 v[40:43], v[16:19], a[136:143], v74
  ds_read_b128 v[64:67], v77 offset:128
  v_add_f32 v32, v32, v34
  v_cvt_pk_bf16_f32 v30, v28, v32
  v_smfmac_f32_16x16x64_bf16 v[36:39], v[0:3], a[112:119], v74
  ds_write_b32 v79, v30 offset:256
  v_add_f32 v33, v33, v35
  v_cvt_pk_bf16_f32 v31, v29, v33
  v_smfmac_f32_16x16x64_bf16 v[40:43], v[0:3], a[120:127], v74
  ds_write_b32 v79, v31 offset:832
  v_xor_b32 v75, 0x8000, v75
  v_smfmac_f32_16x16x64_bf16 v[36:39], v[4:7], a[144:151], v74
  ds_read_b128 v[0:3], v76 offset:4608
  v_mov_b32 v29, 0
  v_smfmac_f32_16x16x64_bf16 v[40:43], v[4:7], a[152:159], v74
  s_waitcnt vmcnt(2) lgkmcnt(3)
  v_mov_b32 v30, 0
  v_mfma_f32_16x16x32_bf16 v[44:47], v[44:47], v[60:63], 0
  ds_read_b128 v[4:7], v76 offset:5632
  s_waitcnt lgkmcnt(2)
  v_mfma_f32_16x16x32_bf16 v[44:47], v[48:51], v[64:67], v[44:47]
  s_barrier
  v_smfmac_f32_16x16x64_bf16 v[36:39], v[8:11], a[160:167], v74
  ds_read_b128 v[20:23], v77 offset:256
  ds_read_b128 v[24:27], v77 offset:384
  v_smfmac_f32_16x16x64_bf16 v[40:43], v[8:11], a[168:175], v74
  ds_read_b128 v[8:11], v76 offset:6656
  v_add_f32_dpp v72, v46, v44 quad_perm:[2,3,0,1] row_mask:0xf bank_mask:0xf
  v_add_f32_dpp v73, v47, v45 quad_perm:[2,3,0,1] row_mask:0xf bank_mask:0xf
  v_smfmac_f32_16x16x64_bf16 v[36:39], v[12:15], a[96:103], v74
  s_waitcnt lgkmcnt(4)
  v_exp_f32_dpp v72, v72 quad_perm:[0,1,0,1] row_mask:0xf bank_mask:0xf
  v_smfmac_f32_16x16x64_bf16 v[40:43], v[12:15], a[104:111], v74
  ds_read_b128 v[12:15], v76 offset:7680
  v_exp_f32_dpp v73, v73 quad_perm:[0,1,0,1] row_mask:0xf bank_mask:0xf
  v_smfmac_f32_16x16x64_bf16 v[36:39], v[0:3], a[32:39], v74
  s_waitcnt lgkmcnt(2)
  v_cvt_pk_bf16_f32 v72, v72, v73
  v_mfma_f32_16x16x32_bf16 v[20:23], v[20:23], v[60:63], 0
  ds_write_b32 v78, v72 offset:520
  v_mov_b64 v[16:17], 0
  v_mfma_f32_16x16x32_bf16 v[20:23], v[24:27], v[64:67], v[20:23]
  ds_read_b128 v[44:47], v75 offset:24576
  v_mov_b64 v[18:19], 0
  v_smfmac_f32_16x16x64_bf16 v[40:43], v[0:3], a[40:47], v74
  ds_read_b128 v[48:51], v75 offset:25600
  v_mov_b64 v[68:69], s[78:79]
  v_smfmac_f32_16x16x64_bf16 v[36:39], v[4:7], a[48:55], v74
  s_waitcnt lgkmcnt(4)
  v_add_f32_dpp v24, v22, v20 quad_perm:[2,3,0,1] row_mask:0xf bank_mask:0xf
  v_add_f32_dpp v25, v23, v21 quad_perm:[2,3,0,1] row_mask:0xf bank_mask:0xf
  v_smfmac_f32_16x16x64_bf16 v[36:39], v[8:11], a[64:71], v74
  s_waitcnt lgkmcnt(2)
  s_barrier
  ds_read_b128 v[32:35], v78 offset:512
  v_smfmac_f32_16x16x64_bf16 v[36:39], v[12:15], a[80:87], v74
  ds_read_b128 v[60:63], v75 offset:26624
  v_mul_f32 v24, s69, v24
  v_smfmac_f32_16x16x64_bf16 v[40:43], v[4:7], a[56:63], v74
  ds_read_b128 v[64:67], v75 offset:27648
  v_mul_f32 v25, s69, v25
  v_smfmac_f32_16x16x64_bf16 v[40:43], v[8:11], a[72:79], v74
  v_exp_f32_dpp v24, v24 quad_perm:[0,1,0,1] row_mask:0xf bank_mask:0xf
  v_smfmac_f32_16x16x64_bf16 v[40:43], v[12:15], a[88:95], v74
  s_waitcnt lgkmcnt(2)
  v_exp_f32_dpp v25, v25 quad_perm:[0,1,0,1] row_mask:0xf bank_mask:0xf
  v_mfma_f32_16x16x32_bf16 v[8:11], v[32:35], v[68:71], 0
  v_add_f32 v36, v36, v38
  v_add_f32 v37, v37, v39
  v_mfma_f32_16x16x32_bf16 v[0:3], v[32:35], v[52:55], 0
  v_add_f32 v40, v40, v42
  v_add_f32 v41, v41, v43
  v_mfma_f32_16x16x32_bf16 v[4:7], v[32:35], v[56:59], 0
  v_cvt_pk_bf16_f32 v28, v24, v25
  v_cvt_pk_bf16_f32 v72, v36, v37
  v_cvt_pk_bf16_f32 v73, v40, v41
  v_mfma_f32_16x16x16_bf16 v[8:11], v[28:29], v[68:69], v[8:11]
  v_cvt_pk_bf16_f32 v31, v24, v25
  v_mov_b64 v[20:21], 0
  v_mfma_f32_16x16x16_bf16 v[0:3], v[28:29], v[72:73], v[0:3]
  ds_read_b128 v[68:71], v76 offset:13824
  v_mov_b64 v[22:23], 0
  v_mfma_f32_16x16x16_bf16 v[4:7], v[30:31], v[72:73], v[4:7]
  v_rcp_f32 v10, v8
  v_rcp_f32 v11, v9
  v_mul_f32 v0, v10, v0
  v_mul_f32 v1, v11, v1
  s_nop 0
  v_mul_f32 v4, v10, v4
  v_mul_f32 v5, v11, v5
  v_cvt_pk_bf16_f32 v2, v0, v4
  ds_write_b32 v79, v2 offset:8704
  v_cvt_pk_bf16_f32 v3, v1, v5
  ds_write_b32 v79, v3 offset:9280
  v_max3_f32 v8, v8, v9, v10
  v_max_f32 v8, v8, v11
  v_cmp_le_f32 vcc, 1317011456, v8
  v_mov_b64 v[24:25], 0
  v_mov_b64 v[26:27], 0
  s_cbranch_vccnz Cf2_mx
Cf2_mxok:
  s_waitcnt lgkmcnt(0)
  s_barrier
  ds_read_b128 v[0:3], v78 offset:8704
  ds_read_b128 v[4:7], v78 offset:8768
  ds_read_b128 v[8:11], v78 offset:8832
  ds_read_b128 v[12:15], v78 offset:8896
  s_waitcnt lgkmcnt(3)
  v_smfmac_f32_16x16x64_bf16 v[16:19], v[0:3], v[44:51], v74
  ds_read_b128 v[52:55], v75 offset:40960
  s_waitcnt lgkmcnt(3)
  v_smfmac_f32_16x16x64_bf16 v[16:19], v[4:7], v[60:67], v74
  ds_read_b128 v[56:59], v75 offset:41984
  s_waitcnt lgkmcnt(3)
  v_smfmac_f32_16x16x64_bf16 v[16:19], v[8:11], a[176:183], v74
  ds_read_b128 v[36:39], v75 offset:43008
  s_waitcnt lgkmcnt(3)
  v_smfmac_f32_16x16x64_bf16 v[16:19], v[12:15], a[184:191], v74
  ds_read_b128 v[40:43], v75 offset:44032
  ds_read_b128 v[44:47], v75 offset:57344
  v_smfmac_f32_16x16x64_bf16 v[20:23], v[0:3], a[192:199], v74
  ds_read_b128 v[48:51], v75 offset:58368
  ds_read_b128 v[60:63], v75 offset:59392
  v_smfmac_f32_16x16x64_bf16 v[20:23], v[4:7], a[200:207], v74
  ds_read_b128 v[64:67], v75 offset:60416
  s_waitcnt lgkmcnt(6)
  v_cvt_pk_bf16_f32 v16, v16, v17
  v_cvt_pk_bf16_f32 v17, v18, v19
  v_bfi_b32 v16, 1, s72, v16
  v_smfmac_f32_16x16x64_bf16 v[20:23], v[8:11], v[52:59], v74
  buffer_store_dwordx2 v[16:17], v68, s[8:11], s73 offen
  s_waitcnt lgkmcnt(4)
  v_smfmac_f32_16x16x64_bf16 v[20:23], v[12:15], v[36:43], v74
  ds_read_b128 v[52:55], v75 offset:0
  v_mov_b64 v[32:33], 0
  v_smfmac_f32_16x16x64_bf16 v[24:27], v[0:3], a[208:215], v74
  ds_read_b128 v[56:59], v75 offset:1024
  v_mov_b64 v[34:35], 0
  v_smfmac_f32_16x16x64_bf16 v[24:27], v[4:7], a[216:223], v74
  ds_read_b128 v[36:39], v75 offset:2048
  s_waitcnt lgkmcnt(5)
  v_cvt_pk_bf16_f32 v20, v20, v21
  v_cvt_pk_bf16_f32 v21, v22, v23
  v_bfi_b32 v20, 1, s72, v20
  v_smfmac_f32_16x16x64_bf16 v[24:27], v[8:11], v[44:51], v74
  buffer_store_dwordx2 v[20:21], v68, s[8:11], s74 offen
  s_waitcnt lgkmcnt(3)
  v_smfmac_f32_16x16x64_bf16 v[24:27], v[12:15], v[60:67], v74
  ds_read_b128 v[40:43], v75 offset:3072
  v_mov_b64 v[28:29], 0
  v_smfmac_f32_16x16x64_bf16 v[32:35], v[0:3], a[224:231], v74
  ds_read_b128 v[44:47], v75 offset:4096
  ds_read_b128 v[48:51], v75 offset:5120
  v_smfmac_f32_16x16x64_bf16 v[32:35], v[4:7], a[232:239], v74
  ds_read_b128 v[60:63], v75 offset:6144
  v_cvt_pk_bf16_f32 v24, v24, v25
  v_cvt_pk_bf16_f32 v25, v26, v27
  v_bfi_b32 v24, 1, s72, v24
  v_smfmac_f32_16x16x64_bf16 v[32:35], v[8:11], a[240:247], v74
  buffer_store_dwordx2 v[24:25], v68, s[8:11], s75 offen
  v_mov_b64 v[30:31], 0
  v_smfmac_f32_16x16x64_bf16 v[32:35], v[12:15], a[248:255], v74
  ds_read_b128 v[64:67], v75 offset:7168
  s_waitcnt lgkmcnt(6)
  v_smfmac_f32_16x16x64_bf16 v[28:31], v[0:3], v[52:59], v74
  s_waitcnt lgkmcnt(4)
  v_smfmac_f32_16x16x64_bf16 v[28:31], v[4:7], v[36:43], v74
  s_waitcnt lgkmcnt(2)
  v_cvt_pk_bf16_f32 v32, v32, v33
  v_cvt_pk_bf16_f32 v33, v34, v35
  v_bfi_b32 v32, 1, s72, v32
  v_smfmac_f32_16x16x64_bf16 v[28:31], v[8:11], v[44:51], v74
  buffer_store_dwordx2 v[32:33], v68, s[8:11], s76 offen
  s_waitcnt lgkmcnt(0)
  v_smfmac_f32_16x16x64_bf16 v[28:31], v[12:15], v[60:67], v74
  v_mov_b64 v[18:19], v[72:73]
  s_nop 4
  v_cvt_pk_bf16_f32 v28, v28, v29
  v_cvt_pk_bf16_f32 v29, v30, v31
  v_bfi_b32 v28, 1, s72, v28
  buffer_store_dwordx2 v[28:29], v68, s[8:11], s77 offen
  ds_read_b128 v[0:3], v76 offset:14848
  s_waitcnt lgkmcnt(0)
  ds_read_b64 v[16:17], v77 offset:384
  s_waitcnt lgkmcnt(0)
  ds_read_b128 v[64:67], v76 offset:27648
  s_waitcnt lgkmcnt(0)
  ds_read_b128 v[60:63], v76 offset:26624
  s_waitcnt lgkmcnt(0)
  buffer_load_dwordx4 v[52:55], v76, s[8:11], s60 offen offset:0 sc1
  buffer_load_dwordx4 v[56:59], v76, s[8:11], s60 offen offset:1024 sc1
  s_add_u32 s66, s66, 1
  s_xor_b32 s64, s64, 16384
  s_xor_b32 s65, s65, 16384
  s_add_u32 s58, s58, 655360
  s_add_u32 s59, s59, 655360
  s_add_u32 s70, s70, 655360
  s_add_u32 s68, s68, 655360
  s_mov_b32 m0, 12800
  s_add_u32 s85, s65, 8192
  v_xor_b32 v75, 0x8000, v75
  s_waitcnt lgkmcnt(0)
  s_waitcnt vmcnt(1)
  v_mfma_f32_16x16x32_bf16 v[4:7], v[0:3], v[52:55], 0
  v_bitop3_b32 v72, v52, v54, s72 bitop3:0x7e
  s_waitcnt vmcnt(0)
  v_mfma_f32_16x16x32_bf16 v[4:7], v[0:3], v[56:59], v[4:7]
  v_bitop3_b32 v73, v56, v58, s72 bitop3:0x7e
  v_bitop3_b32 v72, v72, v73, 1 bitop3:0xa8
  v_cmp_ne_u32 vcc, 0, v72
  s_nop 3
  v_add_f32_dpp v4, v4, v4 row_ror:4 row_mask:0xf bank_mask:0xf
  v_add_f32_dpp v5, v5, v5 row_ror:4 row_mask:0xf bank_mask:0xf
  s_cmp_eq_u64 vcc, 0
  v_add_f32_dpp v4, v4, v4 row_ror:8 row_mask:0xf bank_mask:0xf
  v_add_f32_dpp v5, v5, v5 row_ror:8 row_mask:0xf bank_mask:0xf
  s_cselect_b32 s54, s62, 268435456
  v_cvt_pk_bf16_f32 v4, v4, v5
  buffer_store_dword v4, v69, s[8:11], s54 offen
  s_cbranch_vccnz Cf2_h1r
  s_xor_b32 s62, s62, 16384
  buffer_store_dword v71, v69, s[8:11], s62 offen
  s_xor_b32 s72, s72, 1
  s_branch Cf2_h2
Cf2_h1r:
  s_mov_b64 exec, vcc
  buffer_load_dwordx4 v[52:55], v76, s[8:11], s60 offen offset:0 sc1
  buffer_load_dwordx4 v[56:59], v76, s[8:11], s60 offen offset:1024 sc1
  s_mov_b64 exec, -1
  s_add_u32 s67, s67, 1
  s_waitcnt vmcnt(1)
  v_mfma_f32_16x16x32_bf16 v[4:7], v[0:3], v[52:55], 0
  v_bitop3_b32 v72, v52, v54, s72 bitop3:0x7e
  s_waitcnt vmcnt(0)
  v_mfma_f32_16x16x32_bf16 v[4:7], v[0:3], v[56:59], v[4:7]
  v_bitop3_b32 v73, v56, v58, s72 bitop3:0x7e
  v_bitop3_b32 v72, v72, v73, 1 bitop3:0xa8
  v_cmp_ne_u32 vcc, 0, v72
  s_cbranch_vccz Cf2_h1p
Cf2_h1s:
  s_mov_b64 exec, vcc
  buffer_load_dwordx4 v[52:55], v76, s[8:11], s60 offen offset:0 sc1
  buffer_load_dwordx4 v[56:59], v76, s[8:11], s60 offen offset:1024 sc1
  s_mov_b64 exec, -1
  s_add_u32 s67, s67, 1
  s_waitcnt vmcnt(1)
  v_mfma_f32_16x16x32_bf16 v[4:7], v[0:3], v[52:55], 0
  v_bitop3_b32 v72, v52, v54, s72 bitop3:0x7e
  s_waitcnt vmcnt(0)
  v_mfma_f32_16x16x32_bf16 v[4:7], v[0:3], v[56:59], v[4:7]
  v_bitop3_b32 v73, v56, v58, s72 bitop3:0x7e
  v_bitop3_b32 v72, v72, v73, 1 bitop3:0xa8
  v_cmp_ne_u32 vcc, 0, v72
  s_cbranch_vccz Cf2_h1p
  s_cmp_lt_u32 s67, 131072
  s_cbranch_scc1 Cf2_h1s
Cf2_h1p:
  s_nop 2
  v_add_f32_dpp v4, v4, v4 row_ror:4 row_mask:0xf bank_mask:0xf
  v_add_f32_dpp v5, v5, v5 row_ror:4 row_mask:0xf bank_mask:0xf
  s_nop 0
  v_add_f32_dpp v4, v4, v4 row_ror:8 row_mask:0xf bank_mask:0xf
  v_add_f32_dpp v5, v5, v5 row_ror:8 row_mask:0xf bank_mask:0xf
  v_cvt_pk_bf16_f32 v4, v4, v5
  buffer_store_dword v4, v69, s[8:11], s62 offen
  s_xor_b32 s62, s62, 16384
  buffer_store_dword v71, v69, s[8:11], s62 offen
  s_xor_b32 s72, s72, 1
  s_branch Cf2_h2
Cf2_h2r:
  s_mov_b64 exec, vcc
  buffer_load_dwordx4 v[12:15], v76, s[8:11], s65 offen offset:3072 sc1
  s_mov_b64 exec, -1
  s_add_u32 s67, s67, 1
  s_waitcnt vmcnt(4)
  v_max3_u32 v72, v12, v13, v14
  v_max_u32 v72, v72, v15
  ds_write_b128 v76, v[12:15] offset:7680
  v_cmp_eq_u32 vcc, -1, v72
  s_cbranch_vccz Cf2_h2w
  s_mov_b64 exec, vcc
  buffer_load_dwordx4 v[12:15], v76, s[8:11], s65 offen offset:3072 sc1
  s_mov_b64 exec, -1
  s_add_u32 s67, s67, 1
  s_waitcnt vmcnt(4)
  v_max3_u32 v72, v12, v13, v14
  v_max_u32 v72, v72, v15
  ds_write_b128 v76, v[12:15] offset:7680
  v_cmp_eq_u32 vcc, -1, v72
  s_cbranch_vccz Cf2_h2w
Cf2_h2s:
  s_mov_b64 exec, vcc
  buffer_load_dwordx4 v[12:15], v76, s[8:11], s65 offen offset:3072 sc1
  s_mov_b64 exec, -1
  s_add_u32 s67, s67, 1
  s_waitcnt vmcnt(2)
  v_max3_u32 v72, v12, v13, v14
  v_max_u32 v72, v72, v15
  ds_write_b128 v76, v[12:15] offset:7680
  v_cmp_eq_u32 vcc, -1, v72
  s_cbranch_vccz Cf2_h2w
  s_mov_b64 exec, vcc
  buffer_load_dwordx4 v[12:15], v76, s[8:11], s65 offen offset:3072 sc1
  s_mov_b64 exec, -1
  s_add_u32 s67, s67, 1
  s_waitcnt vmcnt(2)
  v_max3_u32 v72, v12, v13, v14
  v_max_u32 v72, v72, v15
  ds_write_b128 v76, v[12:15] offset:7680
  v_cmp_eq_u32 vcc, -1, v72
  s_cbranch_vccz Cf2_h2w
  s_mov_b64 exec, vcc
  buffer_load_dwordx4 v[12:15], v76, s[8:11], s65 offen offset:3072 sc1
  s_mov_b64 exec, -1
  s_add_u32 s67, s67, 1
  s_waitcnt vmcnt(2)
  v_max3_u32 v72, v12, v13, v14
  v_max_u32 v72, v72, v15
  ds_write_b128 v76, v[12:15] offset:7680
  v_cmp_eq_u32 vcc, -1, v72
  s_cbranch_vccz Cf2_h2w
  s_cmp_lt_u32 s67, 131072
  s_cbranch_scc1 Cf2_h2s
  s_branch Cf2_h2w
Cf2_rec:
  s_nop 7
  s_waitcnt vmcnt(0) lgkmcnt(0)
  v_max3_u32 v72, v0, v1, v2
  v_max3_u32 v72, v72, v3, v4
  v_max3_u32 v72, v72, v5, v6
  v_max3_u32 v72, v72, v7, v8
  v_max3_u32 v72, v72, v9, v10
  v_max3_u32 v72, v72, v11, v12
  v_max3_u32 v72, v72, v13, v14
  v_max3_u32 v72, v72, v15, v16
  v_max3_u32 v72, v72, v17, v18
  v_max_u32 v72, v72, v19
  v_cmp_eq_u32 vcc, -1, v72
  s_cbranch_vccz Cf2_recok
  s_barrier
Cf2_recp:
  buffer_load_dwordx4 v[0:3], v76, s[8:11], s64 offen offset:0 sc1
  buffer_load_dwordx4 v[4:7], v76, s[8:11], s64 offen offset:1024 sc1
  s_add_u32 s67, s67, 1
  s_cmp_lt_u32 s67, 131072
  s_cselect_b32 s54, -2, -1
  s_waitcnt vmcnt(1)
  v_max3_u32 v72, v0, v1, v2
  s_waitcnt vmcnt(0)
  v_max3_u32 v72, v72, v3, v4
  v_max3_u32 v72, v72, v5, v6
  v_max_u32 v72, v72, v7
  v_cmp_lt_u32 vcc, s54, v72
  s_cbranch_vccnz Cf2_recp
  ds_write_b128 v76, v[0:3] offset:8704
  ds_write_b128 v76, v[4:7] offset:9728
  v_mov_b64 v[20:21], 0
  v_mov_b64 v[22:23], 0
  v_mov_b64 v[24:25], 0
  v_mov_b64 v[26:27], 0
  v_mov_b64 v[28:29], 0
  v_mov_b64 v[30:31], 0
  v_mov_b64 v[32:33], 0
  v_mov_b64 v[34:35], 0
  s_waitcnt lgkmcnt(0)
  s_barrier
  ds_read_b128 v[0:3], v76 offset:4608
  s_waitcnt lgkmcnt(0)
  v_smfmac_f32_16x16x64_bf16 v[20:23], v[0:3], v[80:87], v74
  v_smfmac_f32_16x16x64_bf16 v[24:27], v[0:3], v[88:95], v74
  ds_read_b128 v[60:63], v76 offset:24576
  ds_read_b128 v[64:67], v76 offset:25600
  s_waitcnt lgkmcnt(0)
  v_smfmac_f32_16x16x64_bf16 v[28:31], v[0:3], v[60:67], v74
  ds_read_b128 v[60:63], v76 offset:26624
  ds_read_b128 v[64:67], v76 offset:27648
  s_waitcnt lgkmcnt(0)
  v_smfmac_f32_16x16x64_bf16 v[32:35], v[0:3], v[60:67], v74
  ds_read_b128 v[4:7], v76 offset:5632
  s_waitcnt lgkmcnt(0)
  v_smfmac_f32_16x16x64_bf16 v[20:23], v[4:7], v[96:103], v74
  v_smfmac_f32_16x16x64_bf16 v[24:27], v[4:7], v[104:111], v74
  ds_read_b128 v[60:63], v76 offset:40960
  ds_read_b128 v[64:67], v76 offset:41984
  s_waitcnt lgkmcnt(0)
  v_smfmac_f32_16x16x64_bf16 v[28:31], v[4:7], v[60:67], v74
  ds_read_b128 v[60:63], v76 offset:43008
  ds_read_b128 v[64:67], v76 offset:44032
  s_waitcnt lgkmcnt(0)
  v_smfmac_f32_16x16x64_bf16 v[32:35], v[4:7], v[60:67], v74
  ds_read_b128 v[8:11], v76 offset:6656
  s_waitcnt lgkmcnt(0)
  v_smfmac_f32_16x16x64_bf16 v[20:23], v[8:11], v[112:119], v74
  v_smfmac_f32_16x16x64_bf16 v[24:27], v[8:11], v[120:127], v74
  v_smfmac_f32_16x16x64_bf16 v[28:31], v[8:11], v[208:215], v74
  v_smfmac_f32_16x16x64_bf16 v[32:35], v[8:11], v[216:223], v74
  ds_read_b128 v[12:15], v76 offset:7680
  s_waitcnt lgkmcnt(0)
  v_smfmac_f32_16x16x64_bf16 v[20:23], v[12:15], v[128:135], v74
  v_smfmac_f32_16x16x64_bf16 v[24:27], v[12:15], v[136:143], v74
  v_smfmac_f32_16x16x64_bf16 v[28:31], v[12:15], v[224:231], v74
  v_smfmac_f32_16x16x64_bf16 v[32:35], v[12:15], v[232:239], v74
  ds_read_b128 v[12:15], v76 offset:8704
  s_waitcnt lgkmcnt(0)
  v_smfmac_f32_16x16x64_bf16 v[20:23], v[12:15], v[144:151], v74
  v_smfmac_f32_16x16x64_bf16 v[24:27], v[12:15], v[152:159], v74
  ds_read_b128 v[60:63], v76 offset:57344
  ds_read_b128 v[64:67], v76 offset:58368
  s_waitcnt lgkmcnt(0)
  v_smfmac_f32_16x16x64_bf16 v[28:31], v[12:15], v[60:67], v74
  ds_read_b128 v[60:63], v76 offset:59392
  ds_read_b128 v[64:67], v76 offset:60416
  s_waitcnt lgkmcnt(0)
  v_smfmac_f32_16x16x64_bf16 v[32:35], v[12:15], v[60:67], v74
  ds_read_b128 v[0:3], v76 offset:9728
  s_waitcnt lgkmcnt(0)
  v_smfmac_f32_16x16x64_bf16 v[20:23], v[0:3], v[160:167], v74
  v_smfmac_f32_16x16x64_bf16 v[24:27], v[0:3], v[168:175], v74
  ds_read_b128 v[60:63], v75 offset:24576
  ds_read_b128 v[64:67], v75 offset:25600
  s_waitcnt lgkmcnt(0)
  v_smfmac_f32_16x16x64_bf16 v[28:31], v[0:3], v[60:67], v74
  ds_read_b128 v[60:63], v75 offset:26624
  ds_read_b128 v[64:67], v75 offset:27648
  s_waitcnt lgkmcnt(0)
  v_smfmac_f32_16x16x64_bf16 v[32:35], v[0:3], v[60:67], v74
  ds_read_b128 v[16:19], v76 offset:10752
  ds_read_b128 v[60:63], v75 offset:8192
  ds_read_b128 v[64:67], v75 offset:9216
  s_waitcnt lgkmcnt(0)
  v_smfmac_f32_16x16x64_bf16 v[20:23], v[16:19], v[60:67], v74
  ds_read_b128 v[60:63], v75 offset:10240
  ds_read_b128 v[64:67], v75 offset:11264
  s_waitcnt lgkmcnt(0)
  v_smfmac_f32_16x16x64_bf16 v[24:27], v[16:19], v[60:67], v74
  v_smfmac_f32_16x16x64_bf16 v[28:31], v[16:19], v[240:247], v74
  v_smfmac_f32_16x16x64_bf16 v[32:35], v[16:19], v[248:255], v74
  ds_read_b128 v[4:7], v76 offset:11776
  s_waitcnt lgkmcnt(0)
  v_smfmac_f32_16x16x64_bf16 v[20:23], v[4:7], v[176:183], v74
  v_smfmac_f32_16x16x64_bf16 v[24:27], v[4:7], v[184:191], v74
  v_smfmac_f32_16x16x64_bf16 v[28:31], v[4:7], a[0:7], v74
  v_smfmac_f32_16x16x64_bf16 v[32:35], v[4:7], a[8:15], v74
  ds_read_b128 v[8:11], v76 offset:12800
  s_waitcnt lgkmcnt(0)
  v_smfmac_f32_16x16x64_bf16 v[20:23], v[8:11], v[192:199], v74
  v_smfmac_f32_16x16x64_bf16 v[24:27], v[8:11], v[200:207], v74
  v_smfmac_f32_16x16x64_bf16 v[28:31], v[8:11], a[16:23], v74
  v_smfmac_f32_16x16x64_bf16 v[32:35], v[8:11], a[24:31], v74
  v_add_f32 v20, v20, v22
  v_add_f32 v21, v21, v23
  v_add_f32 v24, v24, v26
  v_cvt_pk_bf16_f32 v22, v20, v24
  ds_write_b32 v79, v22 offset:0
  v_add_f32 v25, v25, v27
  v_cvt_pk_bf16_f32 v23, v21, v25
  ds_write_b32 v79, v23 offset:576
  v_add_f32 v28, v28, v30
  v_add_f32 v29, v29, v31
  s_waitcnt lgkmcnt(0)
  s_nop 1
  s_branch Cf2_recok
Cf2_mx:
  s_waitcnt lgkmcnt(0)
  s_barrier
  buffer_load_dwordx4 v[0:3], v76, s[8:11], s58 offen offset:0 sc1
  ds_read_b128 v[20:23], v77 offset:0
  ds_read_b128 v[28:31], v77 offset:256
  buffer_load_dwordx4 v[4:7], v76, s[8:11], s58 offen offset:1024 sc1
  ds_read_b128 v[24:27], v77 offset:128
  ds_read_b128 v[32:35], v77 offset:384
  s_waitcnt vmcnt(1) lgkmcnt(3)
  v_mfma_f32_16x16x32_bf16 v[8:11], v[0:3], v[20:23], 0
  s_waitcnt vmcnt(0) lgkmcnt(1)
  v_mfma_f32_16x16x32_bf16 v[8:11], v[4:7], v[24:27], v[8:11]
  v_mfma_f32_16x16x32_bf16 v[12:15], v[28:31], v[20:23], 0
  s_waitcnt lgkmcnt(0)
  v_mfma_f32_16x16x32_bf16 v[12:15], v[32:35], v[24:27], v[12:15]
  v_add_f32_dpp v8, v10, v8 quad_perm:[2,3,0,1] row_mask:0xf bank_mask:0xf
  v_add_f32_dpp v9, v11, v9 quad_perm:[2,3,0,1] row_mask:0xf bank_mask:0xf
  s_nop 0
  v_mov_b32_dpp v8, v8 quad_perm:[0,1,0,1] row_mask:0xf bank_mask:0xf
  v_mov_b32_dpp v9, v9 quad_perm:[0,1,0,1] row_mask:0xf bank_mask:0xf
  s_nop 1
  v_add_f32_dpp v12, v14, v12 quad_perm:[2,3,0,1] row_mask:0xf bank_mask:0xf
  v_add_f32_dpp v13, v15, v13 quad_perm:[2,3,0,1] row_mask:0xf bank_mask:0xf
  s_nop 0
  v_mov_b32_dpp v12, v12 quad_perm:[0,1,0,1] row_mask:0xf bank_mask:0xf
  v_mov_b32_dpp v13, v13 quad_perm:[0,1,0,1] row_mask:0xf bank_mask:0xf
  v_mul_f32 v12, s69, v12
  ds_write_b32 v78, v8 offset:8712
  v_mul_f32 v13, s69, v13
  ds_write_b32 v78, v9 offset:8776
  s_waitcnt lgkmcnt(0)
  s_barrier
  ds_read_b128 v[36:39], v78 offset:8704
  ds_read_b128 v[40:43], v78 offset:8768
  s_waitcnt lgkmcnt(0)
  s_barrier
  v_max_f32 v16, v36, v37
  v_max3_f32 v16, v16, v38, v39
  v_max3_f32 v16, v16, v40, v41
  v_max3_f32 v16, v16, v42, v43
  v_max3_f32 v16, v16, v12, v13
  v_mov_b32 v17, v16
  s_nop 1
  v_permlane16_swap_b32 v16, v17
  v_max_f32 v16, v16, v17
  v_mov_b32 v17, v16
  s_nop 1
  v_permlane32_swap_b32 v16, v17
  v_max_f32 v16, v16, v17
  v_sub_f32 v36, v36, v16
  v_sub_f32 v37, v37, v16
  v_sub_f32 v38, v38, v16
  v_sub_f32 v39, v39, v16
  v_sub_f32 v40, v40, v16
  v_sub_f32 v41, v41, v16
  v_sub_f32 v42, v42, v16
  v_sub_f32 v43, v43, v16
  v_sub_f32 v12, v12, v16
  v_sub_f32 v13, v13, v16
  v_exp_f32 v36, v36
  v_exp_f32 v37, v37
  v_exp_f32 v38, v38
  v_exp_f32 v39, v39
  v_exp_f32 v40, v40
  v_exp_f32 v41, v41
  v_exp_f32 v42, v42
  v_exp_f32 v43, v43
  v_exp_f32 v12, v12
  v_exp_f32 v13, v13
  v_cvt_pk_bf16_f32 v32, v36, v40
  v_cvt_pk_bf16_f32 v33, v37, v41
  v_cvt_pk_bf16_f32 v34, v38, v42
  v_cvt_pk_bf16_f32 v35, v39, v43
  v_cvt_pk_bf16_f32 v28, v12, v13
  v_cvt_pk_bf16_f32 v31, v12, v13
  v_mov_b32 v29, 0
  v_mov_b32 v30, 0
  v_mov_b32 v68, 0x3f803f80
  v_mov_b32 v69, 0x3f803f80
  v_mov_b32 v70, 0x3f803f80
  v_mov_b32 v71, 0x3f803f80
  s_nop 1
  v_mfma_f32_16x16x32_bf16 v[8:11], v[32:35], v[68:71], 0
  v_mfma_f32_16x16x32_bf16 v[0:3], v[32:35], v[52:55], 0
  v_mfma_f32_16x16x32_bf16 v[4:7], v[32:35], v[56:59], 0
  v_mfma_f32_16x16x16_bf16 v[8:11], v[28:29], v[68:69], v[8:11]
  v_mfma_f32_16x16x16_bf16 v[0:3], v[28:29], v[72:73], v[0:3]
  v_mfma_f32_16x16x16_bf16 v[4:7], v[30:31], v[72:73], v[4:7]
  ds_read_b128 v[68:71], v76 offset:13824
  v_rcp_f32 v10, v8
  v_rcp_f32 v11, v9
  v_mul_f32 v0, v10, v0
  v_mul_f32 v1, v11, v1
  s_nop 0
  v_mul_f32 v4, v10, v4
  v_mul_f32 v5, v11, v5
  v_cvt_pk_bf16_f32 v2, v0, v4
  ds_write_b32 v79, v2 offset:8704
  v_cvt_pk_bf16_f32 v3, v1, v5
  ds_write_b32 v79, v3 offset:9280
  v_mov_b64 v[16:17], 0
  v_mov_b64 v[18:19], 0
  v_mov_b64 v[20:21], 0
  v_mov_b64 v[22:23], 0
  v_mov_b64 v[24:25], 0
  v_mov_b64 v[26:27], 0
  s_branch Cf2_mxok
Cf2_last:
  ds_read_b128 v[4:7], v76 offset:5632
  ds_read_b128 v[8:11], v76 offset:6656
  ds_read_b128 v[44:47], v76 offset:40960
  ds_read_b128 v[48:51], v76 offset:41984
  s_nop 5
  v_mov_b64 v[20:21], 0
  v_mov_b64 v[22:23], 0
  v_mov_b64 v[24:25], 0
  v_mov_b64 v[26:27], 0
  s_waitcnt lgkmcnt(4)
  v_smfmac_f32_16x16x64_bf16 v[28:31], v[0:3], v[36:43], v74
  ds_read_b128 v[36:39], v76 offset:43008
  ds_read_b128 v[40:43], v76 offset:44032
  v_smfmac_f32_16x16x64_bf16 v[32:35], v[0:3], v[60:67], v74
  s_waitcnt lgkmcnt(5)
  v_smfmac_f32_16x16x64_bf16 v[20:23], v[0:3], a[32:39], v74
  ds_read_b128 v[60:63], v76 offset:57344
  ds_read_b128 v[64:67], v76 offset:58368
  v_smfmac_f32_16x16x64_bf16 v[24:27], v[0:3], a[40:47], v74
  s_waitcnt lgkmcnt(4)
  v_smfmac_f32_16x16x64_bf16 v[20:23], v[4:7], a[48:55], v74
  buffer_store_dwordx4 v[16:19], v76, s[8:11], s68 offen sc1
  v_smfmac_f32_16x16x64_bf16 v[24:27], v[4:7], a[56:63], v74
  v_smfmac_f32_16x16x64_bf16 v[28:31], v[4:7], v[44:51], v74
  s_waitcnt lgkmcnt(2)
  v_smfmac_f32_16x16x64_bf16 v[20:23], v[8:11], a[64:71], v74
  ds_read_b128 v[44:47], v76 offset:59392
  ds_read_b128 v[48:51], v76 offset:60416
  v_smfmac_f32_16x16x64_bf16 v[24:27], v[8:11], a[72:79], v74
  v_smfmac_f32_16x16x64_bf16 v[32:35], v[4:7], v[36:43], v74
  v_smfmac_f32_16x16x64_bf16 v[28:31], v[8:11], v[208:215], v74
  ds_read_b128 v[36:39], v75 offset:24576
  ds_read_b128 v[40:43], v75 offset:25600
  v_smfmac_f32_16x16x64_bf16 v[32:35], v[8:11], v[216:223], v74
  v_smfmac_f32_16x16x64_bf16 v[20:23], v[12:15], a[80:87], v74
  v_smfmac_f32_16x16x64_bf16 v[24:27], v[12:15], a[88:95], v74
  v_smfmac_f32_16x16x64_bf16 v[28:31], v[12:15], v[224:231], v74
  v_smfmac_f32_16x16x64_bf16 v[32:35], v[12:15], v[232:239], v74
  s_waitcnt vmcnt(2)
  s_waitcnt vmcnt(1)
  s_barrier
Cf2_lastr:
  ds_read_b128 v[12:15], v76 offset:8704
  ds_read_b128 v[0:3], v76 offset:9728
  ds_read_b128 v[16:19], v76 offset:10752
  ds_read_b128 v[4:7], v76 offset:11776
  ds_read_b128 v[8:11], v76 offset:12800
  s_waitcnt lgkmcnt(3)
  v_max3_u32 v72, v0, v1, v2
  s_waitcnt lgkmcnt(1)
  v_max3_u32 v72, v72, v3, v4
  v_max3_u32 v72, v72, v5, v6
  s_waitcnt lgkmcnt(0)
  v_max3_u32 v72, v72, v7, v8
  v_max3_u32 v72, v72, v9, v10
  v_max3_u32 v72, v72, v11, v12
  v_max3_u32 v72, v72, v13, v14
  v_max3_u32 v72, v72, v15, v16
  v_max3_u32 v72, v72, v17, v18
  v_max_u32 v72, v72, v19
  v_cmp_eq_u32 vcc, -1, v72
  s_cbranch_vccnz Cf2_lastp
Cf2_lastg:
  v_smfmac_f32_16x16x64_bf16 v[28:31], v[12:15], v[60:67], v74
  ds_read_b128 v[60:63], v75 offset:26624
  ds_read_b128 v[64:67], v75 offset:27648
  v_smfmac_f32_16x16x64_bf16 v[32:35], v[12:15], v[44:51], v74
  v_smfmac_f32_16x16x64_bf16 v[28:31], v[0:3], v[36:43], v74
  v_smfmac_f32_16x16x64_bf16 v[28:31], v[16:19], v[240:247], v74
  v_smfmac_f32_16x16x64_bf16 v[28:31], v[4:7], a[0:7], v74
  v_smfmac_f32_16x16x64_bf16 v[28:31], v[8:11], a[16:23], v74
  v_smfmac_f32_16x16x64_bf16 v[32:35], v[16:19], v[248:255], v74
  v_smfmac_f32_16x16x64_bf16 v[32:35], v[4:7], a[8:15], v74
  s_waitcnt lgkmcnt(0)
  v_smfmac_f32_16x16x64_bf16 v[32:35], v[8:11], a[24:31], v74
  v_smfmac_f32_16x16x64_bf16 v[32:35], v[0:3], v[60:67], v74
  v_smfmac_f32_16x16x64_bf16 v[20:23], v[12:15], a[96:103], v74
  v_smfmac_f32_16x16x64_bf16 v[20:23], v[0:3], a[112:119], v74
  v_add_f32 v28, v28, v30
  v_add_f32 v32, v32, v34
  v_cvt_pk_bf16_f32 v30, v28, v32
  v_smfmac_f32_16x16x64_bf16 v[20:23], v[16:19], a[128:135], v74
  ds_write_b32 v79, v30 offset:256
  v_add_f32 v29, v29, v31
  v_add_f32 v33, v33, v35
  v_cvt_pk_bf16_f32 v31, v29, v33
  v_smfmac_f32_16x16x64_bf16 v[20:23], v[4:7], a[144:151], v74
  ds_write_b32 v79, v31 offset:832
  v_smfmac_f32_16x16x64_bf16 v[20:23], v[8:11], a[160:167], v74
  v_smfmac_f32_16x16x64_bf16 v[24:27], v[12:15], a[104:111], v74
  v_smfmac_f32_16x16x64_bf16 v[24:27], v[0:3], a[120:127], v74
  v_smfmac_f32_16x16x64_bf16 v[24:27], v[16:19], a[136:143], v74
  s_waitcnt lgkmcnt(0)
  s_barrier
  ds_read_b64 v[52:53], v77 offset:384
  v_add_f32 v20, v20, v22
  v_smfmac_f32_16x16x64_bf16 v[24:27], v[4:7], a[152:159], v74
  v_add_f32 v21, v21, v23
  v_smfmac_f32_16x16x64_bf16 v[24:27], v[8:11], a[168:175], v74
  v_cvt_pk_bf16_f32 v54, v20, v21
  s_add_u32 s68, s68, 655360
  s_nop 3
  v_add_f32 v24, v24, v26
  v_add_f32 v25, v25, v27
  v_cvt_pk_bf16_f32 v55, v24, v25
  s_waitcnt lgkmcnt(0)
  buffer_store_dwordx4 v[52:55], v76, s[8:11], s68 offen sc1
  s_branch Cf2_done
Cf2_lastp:
  s_add_u32 s72, s72, 2
  s_cmp_ge_u32 s72, 131072
  s_cbranch_scc1 Cf2_lastg
  s_barrier
  buffer_load_dwordx4 v76, s[8:11], s85 offen offset:0 sc1 lds
  s_waitcnt vmcnt(0)
  s_barrier
  s_branch Cf2_lastr
Cf2_done:
  s_branch L_cexit
L_w3:
  v_mov_b64 v[20:21], 0
  v_mov_b64 v[22:23], 0
  v_mov_b64 v[24:25], 0
  v_mov_b64 v[26:27], 0
  v_mov_b64 v[28:29], 0
  v_mov_b64 v[30:31], 0
  v_mov_b64 v[32:33], 0
  v_mov_b64 v[34:35], 0
  s_mov_b32 s78, 0x3f803f80
  s_mov_b32 s79, s78
  s_mov_b32 s65, 360448
  s_mov_b32 m0, 15872
  s_lshl_b32 s71, s53, 2
  s_add_u32 s71, s71, 128
  s_movk_i32 s56, 0x1000
  v_lshlrev_b32 v73, 2, v76
  v_mov_b32 v72, 0
  s_mov_b64 s[16:17], s[8:9]
  s_mov_b32 s18, 268435456
  s_mov_b32 s19, 0x20000
  s_getpc_b64 s[20:21]
Cf3_pc:
  s_add_u32 s20, s20, (Cf3_last - Cf3_pc)
  s_addc_u32 s21, s21, 0
  v_mov_b32 v68, 14880
  buffer_load_dwordx4 v[52:55], v76, s[8:11], s59 offen offset:0 sc1
  buffer_load_dwordx4 v[56:59], v76, s[8:11], s59 offen offset:1024 sc1
  ds_read_b128 v[36:39], v76 offset:45056
  ds_read_b128 v[40:43], v76 offset:46080
  ds_read_b128 v[60:63], v76 offset:47104
  ds_read_b128 v[64:67], v76 offset:48128
  ds_read_b128 v[0:3], v76 offset:4608
  ds_read_b128 v[4:7], v76 offset:5632
  ds_read_b128 v[8:11], v76 offset:6656
  ds_read_b128 v[12:15], v76 offset:7680
  s_waitcnt lgkmcnt(0)
  s_cmp_eq_u32 s66, 1
  s_branch Cf3_top2
.p2align 6
Cf3_h2:
  v_lshlrev_b32 v73, 2, v76
  buffer_load_dwordx4 v[4:7], v76, s[8:11], s65 offen offset:1024 sc1
  ds_read_b128 v[36:39], v76 offset:45056
  ds_read_b128 v[40:43], v76 offset:46080
  buffer_load_dwordx4 v[52:55], v76, s[8:11], s59 offen offset:0 sc1
  buffer_load_dwordx4 v[56:59], v76, s[8:11], s59 offen offset:1024 sc1
  s_waitcnt vmcnt(7)
  v_max3_u32 v72, v4, v5, v6
  v_max_u32 v72, v72, v7
  ds_write_b128 v76, v[4:7] offset:5632
  v_cmp_eq_u32 vcc, -1, v72
  s_cbranch_vccnz Cf3_h2r
Cf3_h2w:
  buffer_load_dwordx4 v76, s[8:11], s85 offen offset:0 sc1 lds
  buffer_load_dwordx4 v76, s[8:11], s85 offen offset:1024 sc1 lds
  s_cmp_eq_u32 s66, 63
  s_waitcnt lgkmcnt(0)
  s_barrier
  ds_read_b128 v[8:11], v76 offset:6656
Cf3_top2:
  v_smfmac_f32_16x16x64_bf16 v[20:23], v[4:7], v[96:103], v74
  s_cbranch_scc1 Cf3_last
  v_smfmac_f32_16x16x64_bf16 v[28:31], v[4:7], v[36:43], v74
  buffer_load_dwordx4 v[44:47], v76, s[8:11], s58 offen offset:0 sc1
  s_mov_b32 m0, 15872
  v_smfmac_f32_16x16x64_bf16 v[24:27], v[4:7], v[104:111], v74
  buffer_load_dwordx4 v[48:51], v76, s[8:11], s58 offen offset:1024 sc1
  v_smfmac_f32_16x16x64_bf16 v[32:35], v[4:7], v[60:67], v74
  ds_read_b128 v[0:3], v76 offset:4608
  s_waitcnt lgkmcnt(1)
  v_smfmac_f32_16x16x64_bf16 v[20:23], v[8:11], v[112:119], v74
  ds_read_b128 v[12:15], v76 offset:7680
  v_smfmac_f32_16x16x64_bf16 v[24:27], v[8:11], v[120:127], v74
  ds_read_b128 v[36:39], v76 offset:28672
  v_smfmac_f32_16x16x64_bf16 v[28:31], v[8:11], v[208:215], v74
  buffer_store_dwordx4 v[16:19], v76, s[8:11], s68 offen sc1
  ds_read_b128 v[40:43], v76 offset:29696
  v_smfmac_f32_16x16x64_bf16 v[32:35], v[8:11], v[216:223], v74
  buffer_load_dword v73, s[16:19], s70 offen lds
  ds_read_b128 v[60:63], v76 offset:30720
  s_waitcnt lgkmcnt(4)
  v_smfmac_f32_16x16x64_bf16 v[20:23], v[0:3], v[80:87], v74
  ds_read_b128 v[64:67], v76 offset:31744
  v_smfmac_f32_16x16x64_bf16 v[24:27], v[0:3], v[88:95], v74
  s_waitcnt vmcnt(4)
  s_waitcnt lgkmcnt(4)
  v_smfmac_f32_16x16x64_bf16 v[20:23], v[12:15], v[128:135], v74
  s_barrier
  ds_read_b128 v[4:7], v76 offset:8704
  s_waitcnt lgkmcnt(3)
  v_smfmac_f32_16x16x64_bf16 v[28:31], v[0:3], v[36:43], v74
  ds_read_b128 v[36:39], v76 offset:61440
  v_smfmac_f32_16x16x64_bf16 v[24:27], v[12:15], v[136:143], v74
  ds_read_b128 v[40:43], v76 offset:62464
  s_waitcnt lgkmcnt(3)
  v_smfmac_f32_16x16x64_bf16 v[32:35], v[0:3], v[60:67], v74
  ds_read_b128 v[8:11], v76 offset:9728
  v_smfmac_f32_16x16x64_bf16 v[28:31], v[12:15], v[224:231], v74
  ds_read_b128 v[60:63], v76 offset:63488
  v_smfmac_f32_16x16x64_bf16 v[32:35], v[12:15], v[232:239], v74
  ds_read_b128 v[64:67], v76 offset:64512
  s_waitcnt lgkmcnt(5)
  v_smfmac_f32_16x16x64_bf16 v[20:23], v[4:7], v[144:151], v74
  s_barrier
  ds_read_b128 v[0:3], v76 offset:11776
  s_waitcnt lgkmcnt(4)
  v_smfmac_f32_16x16x64_bf16 v[28:31], v[4:7], v[36:43], v74
  ds_read_b128 v[12:15], v76 offset:12800
  ds_read_b128 v[36:39], v75 offset:12288
  v_smfmac_f32_16x16x64_bf16 v[24:27], v[4:7], v[152:159], v74
  ds_read_b128 v[16:19], v76 offset:10752
  s_waitcnt lgkmcnt(6)
  v_smfmac_f32_16x16x64_bf16 v[20:23], v[8:11], v[160:167], v74
  ds_read_b128 v[40:43], v75 offset:13312
  s_waitcnt lgkmcnt(5)
  v_smfmac_f32_16x16x64_bf16 v[32:35], v[4:7], v[60:67], v74
  ds_read_b128 v[60:63], v75 offset:14336
  v_smfmac_f32_16x16x64_bf16 v[24:27], v[8:11], v[168:175], v74
  ds_read_b128 v[64:67], v75 offset:15360
  s_waitcnt lgkmcnt(6)
  v_smfmac_f32_16x16x64_bf16 v[20:23], v[0:3], v[176:183], v74
  s_waitcnt lgkmcnt(5)
  v_smfmac_f32_16x16x64_bf16 v[20:23], v[12:15], v[192:199], v74
  s_waitcnt lgkmcnt(2)
  v_smfmac_f32_16x16x64_bf16 v[20:23], v[16:19], v[36:43], v74
  ds_read_b128 v[36:39], v75 offset:28672
  v_smfmac_f32_16x16x64_bf16 v[24:27], v[0:3], v[184:191], v74
  ds_read_b128 v[40:43], v75 offset:29696
  s_waitcnt lgkmcnt(2)
  v_smfmac_f32_16x16x64_bf16 v[24:27], v[16:19], v[60:67], v74
  ds_read_b128 v[60:63], v75 offset:30720
  v_add_f32 v20, v20, v22
  v_smfmac_f32_16x16x64_bf16 v[24:27], v[12:15], v[200:207], v74
  ds_read_b128 v[64:67], v75 offset:31744
  v_add_f32 v21, v21, v23
  v_smfmac_f32_16x16x64_bf16 v[28:31], v[16:19], v[240:247], v74
  v_mov_b64 v[70:71], s[78:79]
  v_smfmac_f32_16x16x64_bf16 v[28:31], v[0:3], a[0:7], v74
  s_waitcnt lgkmcnt(2)
  v_add_f32 v24, v24, v26
  v_smfmac_f32_16x16x64_bf16 v[28:31], v[8:11], v[36:43], v74
  ds_read_b128 v[36:39], v68
  v_cvt_pk_bf16_f32 v22, v20, v24
  v_smfmac_f32_16x16x64_bf16 v[28:31], v[12:15], a[16:23], v74
  ds_read_b128 v[40:43], v68
  ds_write_b32 v79, v22 offset:0
  s_waitcnt lgkmcnt(3)
  v_add_f32 v25, v25, v27
  v_cvt_pk_bf16_f32 v23, v21, v25
  v_smfmac_f32_16x16x64_bf16 v[32:35], v[8:11], v[60:67], v74
  ds_write_b32 v79, v23 offset:576
  v_cmp_u_f32 vcc, v20, v21
  v_smfmac_f32_16x16x64_bf16 v[32:35], v[16:19], v[248:255], v74
  v_add_f32 v28, v28, v30
  v_smfmac_f32_16x16x64_bf16 v[32:35], v[0:3], a[8:15], v74
  v_add_f32 v29, v29, v31
  v_smfmac_f32_16x16x64_bf16 v[32:35], v[12:15], a[24:31], v74
  s_cbranch_vccnz Cf3_rec
Cf3_recok:
  s_waitcnt lgkmcnt(3)
  v_smfmac_f32_16x16x64_bf16 v[36:39], v[16:19], a[128:135], v74
  s_waitcnt lgkmcnt(0)
  s_barrier
  ds_read_b128 v[60:63], v77
  v_smfmac_f32_16x16x64_bf16 v[40:43], v[16:19], a[136:143], v74
  ds_read_b128 v[64:67], v77 offset:128
  v_add_f32 v32, v32, v34
  v_cvt_pk_bf16_f32 v30, v28, v32
  v_smfmac_f32_16x16x64_bf16 v[36:39], v[0:3], a[144:151], v74
  ds_write_b32 v79, v30 offset:256
  v_add_f32 v33, v33, v35
  v_cvt_pk_bf16_f32 v31, v29, v33
  v_smfmac_f32_16x16x64_bf16 v[40:43], v[0:3], a[152:159], v74
  ds_write_b32 v79, v31 offset:832
  v_xor_b32 v75, 0x8000, v75
  v_smfmac_f32_16x16x64_bf16 v[36:39], v[4:7], a[96:103], v74
  ds_read_b128 v[0:3], v76 offset:4608
  v_mov_b32 v29, 0
  v_smfmac_f32_16x16x64_bf16 v[40:43], v[4:7], a[104:111], v74
  s_waitcnt vmcnt(2) lgkmcnt(3)
  v_mov_b32 v30, 0
  v_mfma_f32_16x16x32_bf16 v[44:47], v[44:47], v[60:63], 0
  ds_read_b128 v[4:7], v76 offset:5632
  s_waitcnt lgkmcnt(2)
  v_mfma_f32_16x16x32_bf16 v[44:47], v[48:51], v[64:67], v[44:47]
  s_barrier
  v_smfmac_f32_16x16x64_bf16 v[36:39], v[8:11], a[112:119], v74
  ds_read_b128 v[20:23], v77 offset:256
  ds_read_b128 v[24:27], v77 offset:384
  v_smfmac_f32_16x16x64_bf16 v[40:43], v[8:11], a[120:127], v74
  ds_read_b128 v[8:11], v76 offset:6656
  v_add_f32_dpp v72, v46, v44 quad_perm:[2,3,0,1] row_mask:0xf bank_mask:0xf
  v_add_f32_dpp v73, v47, v45 quad_perm:[2,3,0,1] row_mask:0xf bank_mask:0xf
  v_smfmac_f32_16x16x64_bf16 v[36:39], v[12:15], a[160:167], v74
  s_waitcnt lgkmcnt(4)
  v_exp_f32_dpp v72, v72 quad_perm:[0,1,0,1] row_mask:0xf bank_mask:0xf
  v_smfmac_f32_16x16x64_bf16 v[40:43], v[12:15], a[168:175], v74
  ds_read_b128 v[12:15], v76 offset:7680
  v_exp_f32_dpp v73, v73 quad_perm:[0,1,0,1] row_mask:0xf bank_mask:0xf
  v_smfmac_f32_16x16x64_bf16 v[36:39], v[0:3], a[32:39], v74
  s_waitcnt lgkmcnt(2)
  v_cvt_pk_bf16_f32 v72, v72, v73
  v_mfma_f32_16x16x32_bf16 v[20:23], v[20:23], v[60:63], 0
  ds_write_b32 v78, v72 offset:524
  v_mov_b64 v[16:17], 0
  v_mfma_f32_16x16x32_bf16 v[20:23], v[24:27], v[64:67], v[20:23]
  ds_read_b128 v[44:47], v75 offset:28672
  v_mov_b64 v[18:19], 0
  v_smfmac_f32_16x16x64_bf16 v[40:43], v[0:3], a[40:47], v74
  ds_read_b128 v[48:51], v75 offset:29696
  v_mov_b64 v[68:69], s[78:79]
  v_smfmac_f32_16x16x64_bf16 v[36:39], v[4:7], a[48:55], v74
  s_waitcnt lgkmcnt(4)
  v_add_f32_dpp v24, v22, v20 quad_perm:[2,3,0,1] row_mask:0xf bank_mask:0xf
  v_add_f32_dpp v25, v23, v21 quad_perm:[2,3,0,1] row_mask:0xf bank_mask:0xf
  v_smfmac_f32_16x16x64_bf16 v[36:39], v[8:11], a[64:71], v74
  s_waitcnt lgkmcnt(2)
  s_barrier
  ds_read_b128 v[32:35], v78 offset:512
  v_smfmac_f32_16x16x64_bf16 v[36:39], v[12:15], a[80:87], v74
  ds_read_b128 v[60:63], v75 offset:30720
  v_mul_f32 v24, s69, v24
  v_smfmac_f32_16x16x64_bf16 v[40:43], v[4:7], a[56:63], v74
  ds_read_b128 v[64:67], v75 offset:31744
  v_mul_f32 v25, s69, v25
  v_smfmac_f32_16x16x64_bf16 v[40:43], v[8:11], a[72:79], v74
  v_exp_f32_dpp v24, v24 quad_perm:[0,1,0,1] row_mask:0xf bank_mask:0xf
  v_smfmac_f32_16x16x64_bf16 v[40:43], v[12:15], a[88:95], v74
  s_waitcnt lgkmcnt(2)
  v_exp_f32_dpp v25, v25 quad_perm:[0,1,0,1] row_mask:0xf bank_mask:0xf
  v_mfma_f32_16x16x32_bf16 v[8:11], v[32:35], v[68:71], 0
  v_add_f32 v36, v36, v38
  v_add_f32 v37, v37, v39
  v_mfma_f32_16x16x32_bf16 v[0:3], v[32:35], v[52:55], 0
  v_add_f32 v40, v40, v42
  v_add_f32 v41, v41, v43
  v_mfma_f32_16x16x32_bf16 v[4:7], v[32:35], v[56:59], 0
  v_cvt_pk_bf16_f32 v28, v24, v25
  v_cvt_pk_bf16_f32 v72, v36, v37
  v_cvt_pk_bf16_f32 v73, v40, v41
  v_mfma_f32_16x16x16_bf16 v[8:11], v[28:29], v[68:69], v[8:11]
  v_cvt_pk_bf16_f32 v31, v24, v25
  v_mov_b64 v[20:21], 0
  v_mfma_f32_16x16x16_bf16 v[0:3], v[28:29], v[72:73], v[0:3]
  ds_read_b128 v[68:71], v76 offset:13824
  v_mov_b64 v[22:23], 0
  v_mfma_f32_16x16x16_bf16 v[4:7], v[30:31], v[72:73], v[4:7]
  v_rcp_f32 v10, v8
  v_rcp_f32 v11, v9
  v_mul_f32 v0, v10, v0
  v_mul_f32 v1, v11, v1
  s_nop 0
  v_mul_f32 v4, v10, v4
  v_mul_f32 v5, v11, v5
  v_cvt_pk_bf16_f32 v2, v0, v4
  ds_write_b32 v79, v2 offset:8704
  v_cvt_pk_bf16_f32 v3, v1, v5
  ds_write_b32 v79, v3 offset:9280
  v_max3_f32 v8, v8, v9, v10
  v_max_f32 v8, v8, v11
  v_cmp_le_f32 vcc, 1317011456, v8
  v_mov_b64 v[24:25], 0
  v_mov_b64 v[26:27], 0
  s_cbranch_vccnz Cf3_mx
Cf3_mxok:
  s_waitcnt lgkmcnt(0)
  s_barrier
  ds_read_b128 v[0:3], v78 offset:8704
  ds_read_b128 v[4:7], v78 offset:8768
  ds_read_b128 v[8:11], v78 offset:8832
  ds_read_b128 v[12:15], v78 offset:8896
  s_waitcnt lgkmcnt(3)
  v_smfmac_f32_16x16x64_bf16 v[16:19], v[0:3], v[44:51], v74
  ds_read_b128 v[52:55], v75 offset:45056
  s_waitcnt lgkmcnt(3)
  v_smfmac_f32_16x16x64_bf16 v[16:19], v[4:7], v[60:67], v74
  ds_read_b128 v[56:59], v75 offset:46080
  s_waitcnt lgkmcnt(3)
  v_smfmac_f32_16x16x64_bf16 v[16:19], v[8:11], a[176:183], v74
  ds_read_b128 v[36:39], v75 offset:47104
  s_waitcnt lgkmcnt(3)
  v_smfmac_f32_16x16x64_bf16 v[16:19], v[12:15], a[184:191], v74
  ds_read_b128 v[40:43], v75 offset:48128
  ds_read_b128 v[44:47], v75 offset:61440
  v_smfmac_f32_16x16x64_bf16 v[20:23], v[0:3], a[192:199], v74
  ds_read_b128 v[48:51], v75 offset:62464
  ds_read_b128 v[60:63], v75 offset:63488
  v_smfmac_f32_16x16x64_bf16 v[20:23], v[4:7], a[200:207], v74
  ds_read_b128 v[64:67], v75 offset:64512
  s_waitcnt lgkmcnt(6)
  v_cvt_pk_bf16_f32 v16, v16, v17
  v_cvt_pk_bf16_f32 v17, v18, v19
  v_bfi_b32 v16, 1, s72, v16
  v_smfmac_f32_16x16x64_bf16 v[20:23], v[8:11], v[52:59], v74
  buffer_store_dwordx2 v[16:17], v68, s[8:11], s73 offen
  s_waitcnt lgkmcnt(4)
  v_smfmac_f32_16x16x64_bf16 v[20:23], v[12:15], v[36:43], v74
  ds_read_b128 v[52:55], v75 offset:8192
  v_mov_b64 v[32:33], 0
  v_smfmac_f32_16x16x64_bf16 v[24:27], v[0:3], a[208:215], v74
  ds_read_b128 v[56:59], v75 offset:9216
  v_mov_b64 v[34:35], 0
  v_smfmac_f32_16x16x64_bf16 v[24:27], v[4:7], a[216:223], v74
  ds_read_b128 v[36:39], v75 offset:10240
  s_waitcnt lgkmcnt(5)
  v_cvt_pk_bf16_f32 v20, v20, v21
  v_cvt_pk_bf16_f32 v21, v22, v23
  v_bfi_b32 v20, 1, s72, v20
  v_smfmac_f32_16x16x64_bf16 v[24:27], v[8:11], v[44:51], v74
  buffer_store_dwordx2 v[20:21], v68, s[8:11], s74 offen
  s_waitcnt lgkmcnt(3)
  v_smfmac_f32_16x16x64_bf16 v[24:27], v[12:15], v[60:67], v74
  ds_read_b128 v[40:43], v75 offset:11264
  v_mov_b64 v[28:29], 0
  v_smfmac_f32_16x16x64_bf16 v[32:35], v[0:3], a[224:231], v74
  ds_read_b128 v[44:47], v75 offset:12288
  ds_read_b128 v[48:51], v75 offset:13312
  v_smfmac_f32_16x16x64_bf16 v[32:35], v[4:7], a[232:239], v74
  ds_read_b128 v[60:63], v75 offset:14336
  v_cvt_pk_bf16_f32 v24, v24, v25
  v_cvt_pk_bf16_f32 v25, v26, v27
  v_bfi_b32 v24, 1, s72, v24
  v_smfmac_f32_16x16x64_bf16 v[32:35], v[8:11], a[240:247], v74
  buffer_store_dwordx2 v[24:25], v68, s[8:11], s75 offen
  v_mov_b64 v[30:31], 0
  v_smfmac_f32_16x16x64_bf16 v[32:35], v[12:15], a[248:255], v74
  ds_read_b128 v[64:67], v75 offset:15360
  s_waitcnt lgkmcnt(6)
  v_smfmac_f32_16x16x64_bf16 v[28:31], v[0:3], v[52:59], v74
  s_waitcnt lgkmcnt(4)
  v_smfmac_f32_16x16x64_bf16 v[28:31], v[4:7], v[36:43], v74
  s_waitcnt lgkmcnt(2)
  v_cvt_pk_bf16_f32 v32, v32, v33
  v_cvt_pk_bf16_f32 v33, v34, v35
  v_bfi_b32 v32, 1, s72, v32
  v_smfmac_f32_16x16x64_bf16 v[28:31], v[8:11], v[44:51], v74
  buffer_store_dwordx2 v[32:33], v68, s[8:11], s76 offen
  s_waitcnt lgkmcnt(0)
  v_smfmac_f32_16x16x64_bf16 v[28:31], v[12:15], v[60:67], v74
  v_mov_b64 v[18:19], v[72:73]
  s_nop 4
  v_cvt_pk_bf16_f32 v28, v28, v29
  v_cvt_pk_bf16_f32 v29, v30, v31
  v_bfi_b32 v28, 1, s72, v28
  buffer_store_dwordx2 v[28:29], v68, s[8:11], s77 offen
  ds_read_b128 v[52:55], v76 offset:14848
  s_waitcnt lgkmcnt(0)
  ds_read_b64 v[16:17], v77 offset:392
  s_waitcnt lgkmcnt(0)
  ds_read_b128 v[60:63], v76 offset:47104
  s_waitcnt lgkmcnt(0)
  ds_read_b128 v[64:67], v76 offset:48128
  s_waitcnt lgkmcnt(0)
  s_add_u32 s66, s66, 1
  s_xor_b32 s64, s64, 16384
  s_xor_b32 s65, s65, 16384
  s_add_u32 s58, s58, 655360
  s_add_u32 s59, s59, 655360
  s_add_u32 s70, s70, 655360
  s_add_u32 s68, s68, 655360
  s_mov_b32 m0, 8704
  s_add_u32 s85, s65, 4096
  v_xor_b32 v75, 0x8000, v75
  buffer_load_dwordx4 v[0:3], v76, s[8:11], s60 offen offset:0 sc1
  buffer_load_dwordx4 v[4:7], v76, s[8:11], s60 offen offset:1024 sc1
  buffer_load_dwordx4 v[8:11], v76, s[8:11], s61 offen offset:0 sc1
  buffer_load_dwordx4 v[12:15], v76, s[8:11], s61 offen offset:1024 sc1
  v_mov_b64 v[20:21], 0
  v_mov_b64 v[22:23], 0
  v_mov_b64 v[24:25], 0
  v_mov_b64 v[26:27], 0
  v_mov_b32 v68, 14880
  v_mov_b64 v[28:29], 0
  v_mov_b64 v[30:31], 0
  v_mov_b64 v[32:33], 0
  v_mov_b64 v[34:35], 0
  s_cmp_eq_u32 s66, 62
  s_cselect_b64 s[16:17], s[20:21], s[16:17]
  s_cselect_b32 s18, (Cf3_done - Cf3_last), s18
  s_cselect_b32 s70, 0, s70
  s_cmp_eq_u32 s66, 63
  s_cselect_b32 s59, 268435456, s59
  s_cselect_b32 s58, 268435456, s58
  s_waitcnt lgkmcnt(0)
  s_waitcnt vmcnt(3)
  v_mfma_f32_16x16x32_bf16 v[56:59], v[52:55], v[0:3], 0
  v_bitop3_b32 v72, v0, v2, s72 bitop3:0x7e
  s_waitcnt vmcnt(2)
  v_mfma_f32_16x16x32_bf16 v[56:59], v[52:55], v[4:7], v[56:59]
  v_bitop3_b32 v73, v4, v6, s72 bitop3:0x7e
  v_or_b32 v72, v72, v73
  s_waitcnt vmcnt(1)
  v_mfma_f32_16x16x32_bf16 v[36:39], v[52:55], v[8:11], 0
  v_bitop3_b32 v73, v8, v10, s72 bitop3:0x7e
  v_or_b32 v72, v72, v73
  s_waitcnt vmcnt(0)
  v_mfma_f32_16x16x32_bf16 v[36:39], v[52:55], v[12:15], v[36:39]
  v_bitop3_b32 v73, v12, v14, s72 bitop3:0x7e
  v_bitop3_b32 v72, v72, v73, 1 bitop3:0xa8
  v_cmp_ne_u32 vcc, 0, v72
  s_cbranch_vccnz Cf3_h1r
  buffer_load_dwordx4 v[4:7], v76, s[8:11], s65 offen offset:1024 sc1
  v_add_f32_dpp v56, v56, v56 row_ror:4 row_mask:0xf bank_mask:0xf
  v_add_f32_dpp v57, v57, v57 row_ror:4 row_mask:0xf bank_mask:0xf
  v_add_f32_dpp v36, v36, v36 row_ror:4 row_mask:0xf bank_mask:0xf
  v_add_f32_dpp v37, v37, v37 row_ror:4 row_mask:0xf bank_mask:0xf
  v_add_f32_dpp v56, v56, v56 row_ror:8 row_mask:0xf bank_mask:0xf
  v_add_f32_dpp v57, v57, v57 row_ror:8 row_mask:0xf bank_mask:0xf
  v_add_f32_dpp v36, v36, v36 row_ror:8 row_mask:0xf bank_mask:0xf
  v_add_f32_dpp v37, v37, v37 row_ror:8 row_mask:0xf bank_mask:0xf
  v_cvt_pk_bf16_f32 v56, v56, v57
  buffer_store_dword v56, v69, s[8:11], s62 offen
  v_cvt_pk_bf16_f32 v36, v36, v37
  buffer_store_dword v36, v70, s[8:11], s63 offen
  s_xor_b32 s62, s62, 16384
  buffer_store_dword v71, v69, s[8:11], s62 offen
  s_xor_b32 s63, s63, 16384
  buffer_store_dword v71, v70, s[8:11], s63 offen
  s_xor_b32 s72, s72, 1
  s_branch Cf3_h2
Cf3_h1r:
  s_mov_b64 exec, vcc
  buffer_load_dwordx4 v[0:3], v76, s[8:11], s60 offen offset:0 sc1
  buffer_load_dwordx4 v[4:7], v76, s[8:11], s60 offen offset:1024 sc1
  buffer_load_dwordx4 v[8:11], v76, s[8:11], s61 offen offset:0 sc1
  buffer_load_dwordx4 v[12:15], v76, s[8:11], s61 offen offset:1024 sc1
  s_mov_b64 exec, -1
  s_add_u32 s67, s67, 1
  s_waitcnt vmcnt(3)
  v_mfma_f32_16x16x32_bf16 v[56:59], v[52:55], v[0:3], 0
  v_bitop3_b32 v72, v0, v2, s72 bitop3:0x7e
  s_waitcnt vmcnt(2)
  v_mfma_f32_16x16x32_bf16 v[56:59], v[52:55], v[4:7], v[56:59]
  v_bitop3_b32 v73, v4, v6, s72 bitop3:0x7e
  v_or_b32 v72, v72, v73
  s_waitcnt vmcnt(1)
  v_mfma_f32_16x16x32_bf16 v[36:39], v[52:55], v[8:11], 0
  v_bitop3_b32 v73, v8, v10, s72 bitop3:0x7e
  v_or_b32 v72, v72, v73
  s_waitcnt vmcnt(0)
  v_mfma_f32_16x16x32_bf16 v[36:39], v[52:55], v[12:15], v[36:39]
  v_bitop3_b32 v73, v12, v14, s72 bitop3:0x7e
  v_bitop3_b32 v72, v72, v73, 1 bitop3:0xa8
  v_cmp_ne_u32 vcc, 0, v72
  s_cbranch_vccz Cf3_h1p
Cf3_h1s:
  s_mov_b64 exec, vcc
  buffer_load_dwordx4 v[0:3], v76, s[8:11], s60 offen offset:0 sc1
  buffer_load_dwordx4 v[4:7], v76, s[8:11], s60 offen offset:1024 sc1
  buffer_load_dwordx4 v[8:11], v76, s[8:11], s61 offen offset:0 sc1
  buffer_load_dwordx4 v[12:15], v76, s[8:11], s61 offen offset:1024 sc1
  s_mov_b64 exec, -1
  s_add_u32 s67, s67, 1
  s_waitcnt vmcnt(3)
  v_mfma_f32_16x16x32_bf16 v[56:59], v[52:55], v[0:3], 0
  v_bitop3_b32 v72, v0, v2, s72 bitop3:0x7e
  s_waitcnt vmcnt(2)
  v_mfma_f32_16x16x32_bf16 v[56:59], v[52:55], v[4:7], v[56:59]
  v_bitop3_b32 v73, v4, v6, s72 bitop3:0x7e
  v_or_b32 v72, v72, v73
  s_waitcnt vmcnt(1)
  v_mfma_f32_16x16x32_bf16 v[36:39], v[52:55], v[8:11], 0
  v_bitop3_b32 v73, v8, v10, s72 bitop3:0x7e
  v_or_b32 v72, v72, v73
  s_waitcnt vmcnt(0)
  v_mfma_f32_16x16x32_bf16 v[36:39], v[52:55], v[12:15], v[36:39]
  v_bitop3_b32 v73, v12, v14, s72 bitop3:0x7e
  v_bitop3_b32 v72, v72, v73, 1 bitop3:0xa8
  v_cmp_ne_u32 vcc, 0, v72
  s_cbranch_vccz Cf3_h1p
  s_cmp_lt_u32 s67, 131072
  s_cbranch_scc1 Cf3_h1s
Cf3_h1p:
  s_nop 2
  buffer_load_dwordx4 v[4:7], v76, s[8:11], s65 offen offset:1024 sc1
  v_add_f32_dpp v56, v56, v56 row_ror:4 row_mask:0xf bank_mask:0xf
  v_add_f32_dpp v57, v57, v57 row_ror:4 row_mask:0xf bank_mask:0xf
  v_add_f32_dpp v36, v36, v36 row_ror:4 row_mask:0xf bank_mask:0xf
  v_add_f32_dpp v37, v37, v37 row_ror:4 row_mask:0xf bank_mask:0xf
  v_add_f32_dpp v56, v56, v56 row_ror:8 row_mask:0xf bank_mask:0xf
  v_add_f32_dpp v57, v57, v57 row_ror:8 row_mask:0xf bank_mask:0xf
  v_add_f32_dpp v36, v36, v36 row_ror:8 row_mask:0xf bank_mask:0xf
  v_add_f32_dpp v37, v37, v37 row_ror:8 row_mask:0xf bank_mask:0xf
  v_cvt_pk_bf16_f32 v56, v56, v57
  buffer_store_dword v56, v69, s[8:11], s62 offen
  v_cvt_pk_bf16_f32 v36, v36, v37
  buffer_store_dword v36, v70, s[8:11], s63 offen
  s_xor_b32 s62, s62, 16384
  buffer_store_dword v71, v69, s[8:11], s62 offen
  s_xor_b32 s63, s63, 16384
  buffer_store_dword v71, v70, s[8:11], s63 offen
  s_xor_b32 s72, s72, 1
  s_branch Cf3_h2
Cf3_h2r:
  s_mov_b64 exec, vcc
  buffer_load_dwordx4 v[4:7], v76, s[8:11], s65 offen offset:1024 sc1
  s_mov_b64 exec, -1
  s_add_u32 s67, s67, 1
  s_waitcnt vmcnt(3)
  v_max3_u32 v72, v4, v5, v6
  v_max_u32 v72, v72, v7
  ds_write_b128 v76, v[4:7] offset:5632
  v_cmp_eq_u32 vcc, -1, v72
  s_cbranch_vccz Cf3_h2w
Cf3_h2s:
  s_mov_b64 exec, vcc
  buffer_load_dwordx4 v[4:7], v76, s[8:11], s65 offen offset:1024 sc1
  s_mov_b64 exec, -1
  s_add_u32 s67, s67, 1
  s_waitcnt vmcnt(1)
  v_max3_u32 v72, v4, v5, v6
  v_max_u32 v72, v72, v7
  ds_write_b128 v76, v[4:7] offset:5632
  v_cmp_eq_u32 vcc, -1, v72
  s_cbranch_vccz Cf3_h2w
  s_mov_b64 exec, vcc
  buffer_load_dwordx4 v[4:7], v76, s[8:11], s65 offen offset:1024 sc1
  s_mov_b64 exec, -1
  s_add_u32 s67, s67, 1
  s_waitcnt vmcnt(1)
  v_max3_u32 v72, v4, v5, v6
  v_max_u32 v72, v72, v7
  ds_write_b128 v76, v[4:7] offset:5632
  v_cmp_eq_u32 vcc, -1, v72
  s_cbranch_vccz Cf3_h2w
  s_mov_b64 exec, vcc
  buffer_load_dwordx4 v[4:7], v76, s[8:11], s65 offen offset:1024 sc1
  s_mov_b64 exec, -1
  s_add_u32 s67, s67, 1
  s_waitcnt vmcnt(1)
  v_max3_u32 v72, v4, v5, v6
  v_max_u32 v72, v72, v7
  ds_write_b128 v76, v[4:7] offset:5632
  v_cmp_eq_u32 vcc, -1, v72
  s_cbranch_vccz Cf3_h2w
  s_cmp_lt_u32 s67, 131072
  s_cbranch_scc1 Cf3_h2s
  s_branch Cf3_h2w
Cf3_rec:
  s_nop 7
  s_waitcnt vmcnt(0) lgkmcnt(0)
  v_max3_u32 v72, v0, v1, v2
  v_max3_u32 v72, v72, v3, v4
  v_max3_u32 v72, v72, v5, v6
  v_max3_u32 v72, v72, v7, v8
  v_max3_u32 v72, v72, v9, v10
  v_max3_u32 v72, v72, v11, v12
  v_max3_u32 v72, v72, v13, v14
  v_max3_u32 v72, v72, v15, v16
  v_max3_u32 v72, v72, v17, v18
  v_max_u32 v72, v72, v19
  v_cmp_eq_u32 vcc, -1, v72
  s_cbranch_vccz Cf3_recok
  s_barrier
Cf3_recp:
  buffer_load_dwordx4 v[0:3], v76, s[8:11], s64 offen offset:0 sc1
  buffer_load_dwordx4 v[4:7], v76, s[8:11], s64 offen offset:1024 sc1
  buffer_load_dwordx4 v[8:11], v76, s[8:11], s64 offen offset:2048 sc1
  s_add_u32 s67, s67, 1
  s_cmp_lt_u32 s67, 131072
  s_cselect_b32 s54, -2, -1
  s_waitcnt vmcnt(2)
  v_max3_u32 v72, v0, v1, v2
  s_waitcnt vmcnt(1)
  v_max3_u32 v72, v72, v3, v4
  v_max3_u32 v72, v72, v5, v6
  s_waitcnt vmcnt(0)
  v_max3_u32 v72, v72, v7, v8
  v_max3_u32 v72, v72, v9, v10
  v_max_u32 v72, v72, v11
  v_cmp_lt_u32 vcc, s54, v72
  s_cbranch_vccnz Cf3_recp
  ds_write_b128 v76, v[0:3] offset:10752
  ds_write_b128 v76, v[4:7] offset:11776
  ds_write_b128 v76, v[8:11] offset:12800
  v_mov_b64 v[20:21], 0
  v_mov_b64 v[22:23], 0
  v_mov_b64 v[24:25], 0
  v_mov_b64 v[26:27], 0
  v_mov_b64 v[28:29], 0
  v_mov_b64 v[30:31], 0
  v_mov_b64 v[32:33], 0
  v_mov_b64 v[34:35], 0
  s_waitcnt lgkmcnt(0)
  s_barrier
  ds_read_b128 v[0:3], v76 offset:4608
  s_waitcnt lgkmcnt(0)
  v_smfmac_f32_16x16x64_bf16 v[20:23], v[0:3], v[80:87], v74
  v_smfmac_f32_16x16x64_bf16 v[24:27], v[0:3], v[88:95], v74
  ds_read_b128 v[60:63], v76 offset:28672
  ds_read_b128 v[64:67], v76 offset:29696
  s_waitcnt lgkmcnt(0)
  v_smfmac_f32_16x16x64_bf16 v[28:31], v[0:3], v[60:67], v74
  ds_read_b128 v[60:63], v76 offset:30720
  ds_read_b128 v[64:67], v76 offset:31744
  s_waitcnt lgkmcnt(0)
  v_smfmac_f32_16x16x64_bf16 v[32:35], v[0:3], v[60:67], v74
  ds_read_b128 v[4:7], v76 offset:5632
  s_waitcnt lgkmcnt(0)
  v_smfmac_f32_16x16x64_bf16 v[20:23], v[4:7], v[96:103], v74
  v_smfmac_f32_16x16x64_bf16 v[24:27], v[4:7], v[104:111], v74
  ds_read_b128 v[60:63], v76 offset:45056
  ds_read_b128 v[64:67], v76 offset:46080
  s_waitcnt lgkmcnt(0)
  v_smfmac_f32_16x16x64_bf16 v[28:31], v[4:7], v[60:67], v74
  ds_read_b128 v[60:63], v76 offset:47104
  ds_read_b128 v[64:67], v76 offset:48128
  s_waitcnt lgkmcnt(0)
  v_smfmac_f32_16x16x64_bf16 v[32:35], v[4:7], v[60:67], v74
  ds_read_b128 v[8:11], v76 offset:6656
  s_waitcnt lgkmcnt(0)
  v_smfmac_f32_16x16x64_bf16 v[20:23], v[8:11], v[112:119], v74
  v_smfmac_f32_16x16x64_bf16 v[24:27], v[8:11], v[120:127], v74
  v_smfmac_f32_16x16x64_bf16 v[28:31], v[8:11], v[208:215], v74
  v_smfmac_f32_16x16x64_bf16 v[32:35], v[8:11], v[216:223], v74
  ds_read_b128 v[12:15], v76 offset:7680
  s_waitcnt lgkmcnt(0)
  v_smfmac_f32_16x16x64_bf16 v[20:23], v[12:15], v[128:135], v74
  v_smfmac_f32_16x16x64_bf16 v[24:27], v[12:15], v[136:143], v74
  v_smfmac_f32_16x16x64_bf16 v[28:31], v[12:15], v[224:231], v74
  v_smfmac_f32_16x16x64_bf16 v[32:35], v[12:15], v[232:239], v74
  ds_read_b128 v[4:7], v76 offset:8704
  s_waitcnt lgkmcnt(0)
  v_smfmac_f32_16x16x64_bf16 v[20:23], v[4:7], v[144:151], v74
  v_smfmac_f32_16x16x64_bf16 v[24:27], v[4:7], v[152:159], v74
  ds_read_b128 v[60:63], v76 offset:61440
  ds_read_b128 v[64:67], v76 offset:62464
  s_waitcnt lgkmcnt(0)
  v_smfmac_f32_16x16x64_bf16 v[28:31], v[4:7], v[60:67], v74
  ds_read_b128 v[60:63], v76 offset:63488
  ds_read_b128 v[64:67], v76 offset:64512
  s_waitcnt lgkmcnt(0)
  v_smfmac_f32_16x16x64_bf16 v[32:35], v[4:7], v[60:67], v74
  ds_read_b128 v[8:11], v76 offset:9728
  s_waitcnt lgkmcnt(0)
  v_smfmac_f32_16x16x64_bf16 v[20:23], v[8:11], v[160:167], v74
  v_smfmac_f32_16x16x64_bf16 v[24:27], v[8:11], v[168:175], v74
  ds_read_b128 v[60:63], v75 offset:28672
  ds_read_b128 v[64:67], v75 offset:29696
  s_waitcnt lgkmcnt(0)
  v_smfmac_f32_16x16x64_bf16 v[28:31], v[8:11], v[60:67], v74
  ds_read_b128 v[60:63], v75 offset:30720
  ds_read_b128 v[64:67], v75 offset:31744
  s_waitcnt lgkmcnt(0)
  v_smfmac_f32_16x16x64_bf16 v[32:35], v[8:11], v[60:67], v74
  ds_read_b128 v[16:19], v76 offset:10752
  ds_read_b128 v[60:63], v75 offset:12288
  ds_read_b128 v[64:67], v75 offset:13312
  s_waitcnt lgkmcnt(0)
  v_smfmac_f32_16x16x64_bf16 v[20:23], v[16:19], v[60:67], v74
  ds_read_b128 v[60:63], v75 offset:14336
  ds_read_b128 v[64:67], v75 offset:15360
  s_waitcnt lgkmcnt(0)
  v_smfmac_f32_16x16x64_bf16 v[24:27], v[16:19], v[60:67], v74
  v_smfmac_f32_16x16x64_bf16 v[28:31], v[16:19], v[240:247], v74
  v_smfmac_f32_16x16x64_bf16 v[32:35], v[16:19], v[248:255], v74
  ds_read_b128 v[0:3], v76 offset:11776
  s_waitcnt lgkmcnt(0)
  v_smfmac_f32_16x16x64_bf16 v[20:23], v[0:3], v[176:183], v74
  v_smfmac_f32_16x16x64_bf16 v[24:27], v[0:3], v[184:191], v74
  v_smfmac_f32_16x16x64_bf16 v[28:31], v[0:3], a[0:7], v74
  v_smfmac_f32_16x16x64_bf16 v[32:35], v[0:3], a[8:15], v74
  ds_read_b128 v[12:15], v76 offset:12800
  s_waitcnt lgkmcnt(0)
  v_smfmac_f32_16x16x64_bf16 v[20:23], v[12:15], v[192:199], v74
  v_smfmac_f32_16x16x64_bf16 v[24:27], v[12:15], v[200:207], v74
  v_smfmac_f32_16x16x64_bf16 v[28:31], v[12:15], a[16:23], v74
  v_smfmac_f32_16x16x64_bf16 v[32:35], v[12:15], a[24:31], v74
  v_add_f32 v20, v20, v22
  v_add_f32 v21, v21, v23
  v_add_f32 v24, v24, v26
  v_cvt_pk_bf16_f32 v22, v20, v24
  ds_write_b32 v79, v22 offset:0
  v_add_f32 v25, v25, v27
  v_cvt_pk_bf16_f32 v23, v21, v25
  ds_write_b32 v79, v23 offset:576
  v_add_f32 v28, v28, v30
  v_add_f32 v29, v29, v31
  s_waitcnt lgkmcnt(0)
  s_nop 1
  s_branch Cf3_recok
Cf3_mx:
  s_waitcnt lgkmcnt(0)
  s_barrier
  buffer_load_dwordx4 v[0:3], v76, s[8:11], s58 offen offset:0 sc1
  ds_read_b128 v[20:23], v77 offset:0
  ds_read_b128 v[28:31], v77 offset:256
  buffer_load_dwordx4 v[4:7], v76, s[8:11], s58 offen offset:1024 sc1
  ds_read_b128 v[24:27], v77 offset:128
  ds_read_b128 v[32:35], v77 offset:384
  s_waitcnt vmcnt(1) lgkmcnt(3)
  v_mfma_f32_16x16x32_bf16 v[8:11], v[0:3], v[20:23], 0
  s_waitcnt vmcnt(0) lgkmcnt(1)
  v_mfma_f32_16x16x32_bf16 v[8:11], v[4:7], v[24:27], v[8:11]
  v_mfma_f32_16x16x32_bf16 v[12:15], v[28:31], v[20:23], 0
  s_waitcnt lgkmcnt(0)
  v_mfma_f32_16x16x32_bf16 v[12:15], v[32:35], v[24:27], v[12:15]
  v_add_f32_dpp v8, v10, v8 quad_perm:[2,3,0,1] row_mask:0xf bank_mask:0xf
  v_add_f32_dpp v9, v11, v9 quad_perm:[2,3,0,1] row_mask:0xf bank_mask:0xf
  s_nop 0
  v_mov_b32_dpp v8, v8 quad_perm:[0,1,0,1] row_mask:0xf bank_mask:0xf
  v_mov_b32_dpp v9, v9 quad_perm:[0,1,0,1] row_mask:0xf bank_mask:0xf
  s_nop 1
  v_add_f32_dpp v12, v14, v12 quad_perm:[2,3,0,1] row_mask:0xf bank_mask:0xf
  v_add_f32_dpp v13, v15, v13 quad_perm:[2,3,0,1] row_mask:0xf bank_mask:0xf
  s_nop 0
  v_mov_b32_dpp v12, v12 quad_perm:[0,1,0,1] row_mask:0xf bank_mask:0xf
  v_mov_b32_dpp v13, v13 quad_perm:[0,1,0,1] row_mask:0xf bank_mask:0xf
  v_mul_f32 v12, s69, v12
  ds_write_b32 v78, v8 offset:8716
  v_mul_f32 v13, s69, v13
  ds_write_b32 v78, v9 offset:8780
  s_waitcnt lgkmcnt(0)
  s_barrier
  ds_read_b128 v[36:39], v78 offset:8704
  ds_read_b128 v[40:43], v78 offset:8768
  s_waitcnt lgkmcnt(0)
  s_barrier
  v_max_f32 v16, v36, v37
  v_max3_f32 v16, v16, v38, v39
  v_max3_f32 v16, v16, v40, v41
  v_max3_f32 v16, v16, v42, v43
  v_max3_f32 v16, v16, v12, v13
  v_mov_b32 v17, v16
  s_nop 1
  v_permlane16_swap_b32 v16, v17
  v_max_f32 v16, v16, v17
  v_mov_b32 v17, v16
  s_nop 1
  v_permlane32_swap_b32 v16, v17
  v_max_f32 v16, v16, v17
  v_sub_f32 v36, v36, v16
  v_sub_f32 v37, v37, v16
  v_sub_f32 v38, v38, v16
  v_sub_f32 v39, v39, v16
  v_sub_f32 v40, v40, v16
  v_sub_f32 v41, v41, v16
  v_sub_f32 v42, v42, v16
  v_sub_f32 v43, v43, v16
  v_sub_f32 v12, v12, v16
  v_sub_f32 v13, v13, v16
  v_exp_f32 v36, v36
  v_exp_f32 v37, v37
  v_exp_f32 v38, v38
  v_exp_f32 v39, v39
  v_exp_f32 v40, v40
  v_exp_f32 v41, v41
  v_exp_f32 v42, v42
  v_exp_f32 v43, v43
  v_exp_f32 v12, v12
  v_exp_f32 v13, v13
  v_cvt_pk_bf16_f32 v32, v36, v40
  v_cvt_pk_bf16_f32 v33, v37, v41
  v_cvt_pk_bf16_f32 v34, v38, v42
  v_cvt_pk_bf16_f32 v35, v39, v43
  v_cvt_pk_bf16_f32 v28, v12, v13
  v_cvt_pk_bf16_f32 v31, v12, v13
  v_mov_b32 v29, 0
  v_mov_b32 v30, 0
  v_mov_b32 v68, 0x3f803f80
  v_mov_b32 v69, 0x3f803f80
  v_mov_b32 v70, 0x3f803f80
  v_mov_b32 v71, 0x3f803f80
  s_nop 1
  v_mfma_f32_16x16x32_bf16 v[8:11], v[32:35], v[68:71], 0
  v_mfma_f32_16x16x32_bf16 v[0:3], v[32:35], v[52:55], 0
  v_mfma_f32_16x16x32_bf16 v[4:7], v[32:35], v[56:59], 0
  v_mfma_f32_16x16x16_bf16 v[8:11], v[28:29], v[68:69], v[8:11]
  v_mfma_f32_16x16x16_bf16 v[0:3], v[28:29], v[72:73], v[0:3]
  v_mfma_f32_16x16x16_bf16 v[4:7], v[30:31], v[72:73], v[4:7]
  ds_read_b128 v[68:71], v76 offset:13824
  v_rcp_f32 v10, v8
  v_rcp_f32 v11, v9
  v_mul_f32 v0, v10, v0
  v_mul_f32 v1, v11, v1
  s_nop 0
  v_mul_f32 v4, v10, v4
  v_mul_f32 v5, v11, v5
  v_cvt_pk_bf16_f32 v2, v0, v4
  ds_write_b32 v79, v2 offset:8704
  v_cvt_pk_bf16_f32 v3, v1, v5
  ds_write_b32 v79, v3 offset:9280
  v_mov_b64 v[16:17], 0
  v_mov_b64 v[18:19], 0
  v_mov_b64 v[20:21], 0
  v_mov_b64 v[22:23], 0
  v_mov_b64 v[24:25], 0
  v_mov_b64 v[26:27], 0
  s_branch Cf3_mxok
Cf3_last:
  ds_read_b128 v[0:3], v76 offset:4608
  ds_read_b128 v[12:15], v76 offset:7680
  ds_read_b128 v[44:47], v76 offset:28672
  ds_read_b128 v[48:51], v76 offset:29696
  s_nop 5
  v_mov_b64 v[20:21], 0
  v_mov_b64 v[22:23], 0
  v_mov_b64 v[24:25], 0
  v_mov_b64 v[26:27], 0
  v_smfmac_f32_16x16x64_bf16 v[28:31], v[4:7], v[36:43], v74
  ds_read_b128 v[36:39], v76 offset:30720
  ds_read_b128 v[40:43], v76 offset:31744
  v_smfmac_f32_16x16x64_bf16 v[32:35], v[4:7], v[60:67], v74
  s_waitcnt lgkmcnt(5)
  v_smfmac_f32_16x16x64_bf16 v[20:23], v[0:3], a[32:39], v74
  ds_read_b128 v[60:63], v76 offset:61440
  ds_read_b128 v[64:67], v76 offset:62464
  v_smfmac_f32_16x16x64_bf16 v[24:27], v[0:3], a[40:47], v74
  s_waitcnt lgkmcnt(4)
  v_smfmac_f32_16x16x64_bf16 v[20:23], v[4:7], a[48:55], v74
  buffer_store_dwordx4 v[16:19], v76, s[8:11], s68 offen sc1
  v_smfmac_f32_16x16x64_bf16 v[24:27], v[4:7], a[56:63], v74
  v_smfmac_f32_16x16x64_bf16 v[28:31], v[0:3], v[44:51], v74
  s_waitcnt lgkmcnt(2)
  v_smfmac_f32_16x16x64_bf16 v[20:23], v[8:11], a[64:71], v74
  ds_read_b128 v[44:47], v76 offset:63488
  ds_read_b128 v[48:51], v76 offset:64512
  v_smfmac_f32_16x16x64_bf16 v[24:27], v[8:11], a[72:79], v74
  v_smfmac_f32_16x16x64_bf16 v[32:35], v[0:3], v[36:43], v74
  v_smfmac_f32_16x16x64_bf16 v[28:31], v[8:11], v[208:215], v74
  ds_read_b128 v[36:39], v75 offset:28672
  ds_read_b128 v[40:43], v75 offset:29696
  v_smfmac_f32_16x16x64_bf16 v[32:35], v[8:11], v[216:223], v74
  v_smfmac_f32_16x16x64_bf16 v[20:23], v[12:15], a[80:87], v74
  v_smfmac_f32_16x16x64_bf16 v[24:27], v[12:15], a[88:95], v74
  v_smfmac_f32_16x16x64_bf16 v[28:31], v[12:15], v[224:231], v74
  v_smfmac_f32_16x16x64_bf16 v[32:35], v[12:15], v[232:239], v74
  s_waitcnt vmcnt(1)
  s_barrier
Cf3_lastr:
  ds_read_b128 v[4:7], v76 offset:8704
  ds_read_b128 v[8:11], v76 offset:9728
  ds_read_b128 v[16:19], v76 offset:10752
  ds_read_b128 v[0:3], v76 offset:11776
  ds_read_b128 v[12:15], v76 offset:12800
  s_waitcnt lgkmcnt(1)
  v_max3_u32 v72, v0, v1, v2
  v_max3_u32 v72, v72, v3, v4
  v_max3_u32 v72, v72, v5, v6
  v_max3_u32 v72, v72, v7, v8
  v_max3_u32 v72, v72, v9, v10
  s_waitcnt lgkmcnt(0)
  v_max3_u32 v72, v72, v11, v12
  v_max3_u32 v72, v72, v13, v14
  v_max3_u32 v72, v72, v15, v16
  v_max3_u32 v72, v72, v17, v18
  v_max_u32 v72, v72, v19
  v_cmp_eq_u32 vcc, -1, v72
  s_cbranch_vccnz Cf3_lastp
Cf3_lastg:
  v_smfmac_f32_16x16x64_bf16 v[28:31], v[4:7], v[60:67], v74
  ds_read_b128 v[60:63], v75 offset:30720
  ds_read_b128 v[64:67], v75 offset:31744
  v_smfmac_f32_16x16x64_bf16 v[32:35], v[4:7], v[44:51], v74
  v_smfmac_f32_16x16x64_bf16 v[28:31], v[8:11], v[36:43], v74
  v_smfmac_f32_16x16x64_bf16 v[28:31], v[16:19], v[240:247], v74
  v_smfmac_f32_16x16x64_bf16 v[28:31], v[0:3], a[0:7], v74
  v_smfmac_f32_16x16x64_bf16 v[28:31], v[12:15], a[16:23], v74
  v_smfmac_f32_16x16x64_bf16 v[32:35], v[16:19], v[248:255], v74
  v_smfmac_f32_16x16x64_bf16 v[32:35], v[0:3], a[8:15], v74
  s_waitcnt lgkmcnt(0)
  v_smfmac_f32_16x16x64_bf16 v[32:35], v[12:15], a[24:31], v74
  v_smfmac_f32_16x16x64_bf16 v[32:35], v[8:11], v[60:67], v74
  v_smfmac_f32_16x16x64_bf16 v[20:23], v[4:7], a[96:103], v74
  v_smfmac_f32_16x16x64_bf16 v[20:23], v[8:11], a[112:119], v74
  v_add_f32 v28, v28, v30
  v_add_f32 v32, v32, v34
  v_cvt_pk_bf16_f32 v30, v28, v32
  v_smfmac_f32_16x16x64_bf16 v[20:23], v[16:19], a[128:135], v74
  ds_write_b32 v79, v30 offset:256
  v_add_f32 v29, v29, v31
  v_add_f32 v33, v33, v35
  v_cvt_pk_bf16_f32 v31, v29, v33
  v_smfmac_f32_16x16x64_bf16 v[20:23], v[0:3], a[144:151], v74
  ds_write_b32 v79, v31 offset:832
  v_smfmac_f32_16x16x64_bf16 v[20:23], v[12:15], a[160:167], v74
  v_smfmac_f32_16x16x64_bf16 v[24:27], v[4:7], a[104:111], v74
  v_smfmac_f32_16x16x64_bf16 v[24:27], v[8:11], a[120:127], v74
  v_smfmac_f32_16x16x64_bf16 v[24:27], v[16:19], a[136:143], v74
  s_waitcnt lgkmcnt(0)
  s_barrier
  ds_read_b64 v[52:53], v77 offset:392
  v_add_f32 v20, v20, v22
  v_smfmac_f32_16x16x64_bf16 v[24:27], v[0:3], a[152:159], v74
  v_add_f32 v21, v21, v23
  v_smfmac_f32_16x16x64_bf16 v[24:27], v[12:15], a[168:175], v74
  v_cvt_pk_bf16_f32 v54, v20, v21
  s_add_u32 s68, s68, 655360
  s_nop 3
  v_add_f32 v24, v24, v26
  v_add_f32 v25, v25, v27
  v_cvt_pk_bf16_f32 v55, v24, v25
  s_waitcnt lgkmcnt(0)
  buffer_store_dwordx4 v[52:55], v76, s[8:11], s68 offen sc1
  s_branch Cf3_done
Cf3_lastp:
  s_add_u32 s72, s72, 2
  s_cmp_ge_u32 s72, 131072
  s_cbranch_scc1 Cf3_lastg
  s_barrier
  buffer_load_dwordx4 v76, s[8:11], s85 offen offset:0 sc1 lds
  buffer_load_dwordx4 v76, s[8:11], s85 offen offset:1024 sc1 lds
  s_waitcnt vmcnt(0)
  s_barrier
  s_branch Cf3_lastr
Cf3_done:
  s_branch L_cexit
L_w4:
  v_mov_b64 v[20:21], 0
  v_mov_b64 v[22:23], 0
  v_mov_b64 v[24:25], 0
  v_mov_b64 v[26:27], 0
  v_mov_b64 v[28:29], 0
  v_mov_b64 v[30:31], 0
  v_mov_b64 v[32:33], 0
  v_mov_b64 v[34:35], 0
  s_mov_b32 s78, 0x3f803f80
  s_mov_b32 s79, s78
  s_mov_b32 s65, 360448
  s_mov_b32 m0, 16128
  s_lshl_b32 s71, s53, 2
  s_add_u32 s71, s71, 128
  s_movk_i32 s56, 0x1000
  v_lshlrev_b32 v73, 2, v76
  v_mov_b32 v72, 0
  s_mov_b64 s[16:17], s[8:9]
  s_mov_b32 s18, 268435456
  s_mov_b32 s19, 0x20000
  s_getpc_b64 s[20:21]
Cs0_pc:
  s_add_u32 s20, s20, (Cs0_last - Cs0_pc)
  s_addc_u32 s21, s21, 0
  v_mov_b32 v68, 14880
  buffer_load_dwordx4 v[52:55], v76, s[8:11], s59 offen offset:0 sc1
  buffer_load_dwordx4 v[56:59], v76, s[8:11], s59 offen offset:1024 sc1
  ds_read_b128 v[36:39], v76 offset:16384
  ds_read_b128 v[40:43], v76 offset:17408
  ds_read_b128 v[60:63], v76 offset:18432
  ds_read_b128 v[64:67], v76 offset:19456
  ds_read_b128 v[0:3], v76 offset:4608
  ds_read_b128 v[4:7], v76 offset:5632
  ds_read_b128 v[8:11], v76 offset:6656
  ds_read_b128 v[12:15], v76 offset:7680
  s_waitcnt lgkmcnt(0)
  s_cmp_eq_u32 s66, 1
  s_branch Cs0_top2
.p2align 6
Cs0_h2:
  ds_read_b128 v[36:39], v76 offset:16384
  v_mov_b64 v[20:21], 0
  v_mov_b64 v[22:23], 0
  v_mov_b64 v[24:25], 0
  v_mov_b64 v[26:27], 0
  v_mov_b32 v68, 14880
  ds_read_b128 v[40:43], v76 offset:17408
  v_mov_b64 v[28:29], 0
  v_mov_b64 v[30:31], 0
  v_mov_b64 v[32:33], 0
  v_mov_b64 v[34:35], 0
  v_lshlrev_b32 v73, 2, v76
  ds_read_b128 v[60:63], v76 offset:18432
  s_cmp_eq_u32 s66, 12
  s_cselect_b32 s56, s71, 0x1000
  ds_read_b32 v72, v76 offset:16128
  s_cmp_eq_u32 s66, 13
  s_cselect_b32 s54, 0x700, 0
  s_waitcnt lgkmcnt(0)
  v_readfirstlane_b32 s57, v72
  s_nop 0
  s_cmp_lt_u32 s57, s54
  s_cbranch_scc1 Cs0_kv3
Cs0_kvb:
  buffer_load_dwordx4 v[52:55], v76, s[8:11], s59 offen offset:0 sc1
  buffer_load_dwordx4 v[56:59], v76, s[8:11], s59 offen offset:1024 sc1
  s_waitcnt vmcnt(0)
  s_mov_b64 vcc, -1
Cs0_h2r:
  s_mov_b64 exec, vcc
  buffer_load_dwordx4 v[0:3], v76, s[8:11], s65 offen offset:0 sc1
  buffer_load_dwordx4 v[4:7], v76, s[8:11], s85 offen offset:0 sc1
  s_mov_b64 exec, -1
  s_add_u32 s67, s67, 1
  s_cmp_lt_u32 s67, 131072
  s_cselect_b32 s54, -2, -1
  s_waitcnt vmcnt(1)
  v_max3_u32 v72, v0, v1, v2
  s_waitcnt vmcnt(0)
  v_max3_u32 v72, v72, v3, v4
  v_max3_u32 v72, v72, v5, v6
  v_max_u32 v72, v72, v7
  v_cmp_lt_u32 vcc, s54, v72
  s_cbranch_vccnz Cs0_h2r
  ds_write_b128 v76, v[0:3] offset:4608
  ds_write_b128 v76, v[4:7] offset:10752
Cs0_h2w:
  s_cmp_eq_u32 s66, 63
  s_waitcnt lgkmcnt(0)
  s_barrier
  ds_read_b128 v[8:11], v76 offset:6656
Cs0_top2:
  v_smfmac_f32_16x16x64_bf16 v[20:23], v[0:3], v[80:87], v74
  s_cbranch_scc1 Cs0_last
  v_smfmac_f32_16x16x64_bf16 v[28:31], v[0:3], v[36:43], v74
  buffer_load_dwordx4 v[44:47], v76, s[8:11], s58 offen offset:0 sc1
  s_mov_b32 m0, 16128
  v_smfmac_f32_16x16x64_bf16 v[24:27], v[0:3], v[88:95], v74
  buffer_load_dwordx4 v[48:51], v76, s[8:11], s58 offen offset:1024 sc1
  v_smfmac_f32_16x16x64_bf16 v[32:35], v[0:3], v[60:67], v74
  ds_read_b128 v[4:7], v76 offset:5632
  s_waitcnt lgkmcnt(1)
  v_smfmac_f32_16x16x64_bf16 v[20:23], v[8:11], v[112:119], v74
  ds_read_b128 v[12:15], v76 offset:7680
  v_smfmac_f32_16x16x64_bf16 v[24:27], v[8:11], v[120:127], v74
  ds_read_b128 v[36:39], v76 offset:32768
  v_smfmac_f32_16x16x64_bf16 v[28:31], v[8:11], v[208:215], v74
  buffer_store_dwordx4 v[16:19], v76, s[8:11], s68 offen sc1
  ds_read_b128 v[40:43], v76 offset:33792
  v_smfmac_f32_16x16x64_bf16 v[32:35], v[8:11], v[216:223], v74
  buffer_load_dword v73, s[16:19], s70 offen lds
  ds_read_b128 v[60:63], v76 offset:34816
  s_waitcnt lgkmcnt(4)
  v_smfmac_f32_16x16x64_bf16 v[20:23], v[4:7], v[96:103], v74
  ds_read_b128 v[64:67], v76 offset:35840
  v_smfmac_f32_16x16x64_bf16 v[24:27], v[4:7], v[104:111], v74
  s_waitcnt vmcnt(4)
  s_waitcnt lgkmcnt(4)
  v_smfmac_f32_16x16x64_bf16 v[20:23], v[12:15], v[128:135], v74
  s_barrier
  ds_read_b128 v[0:3], v76 offset:8704
  s_waitcnt lgkmcnt(3)
  v_smfmac_f32_16x16x64_bf16 v[28:31], v[4:7], v[36:43], v74
  ds_read_b128 v[36:39], v76 offset:49152
  v_smfmac_f32_16x16x64_bf16 v[24:27], v[12:15], v[136:143], v74
  ds_read_b128 v[40:43], v76 offset:50176
  s_waitcnt lgkmcnt(3)
  v_smfmac_f32_16x16x64_bf16 v[32:35], v[4:7], v[60:67], v74
  ds_read_b128 v[8:11], v76 offset:9728
  v_smfmac_f32_16x16x64_bf16 v[28:31], v[12:15], v[224:231], v74
  ds_read_b128 v[60:63], v76 offset:51200
  v_smfmac_f32_16x16x64_bf16 v[32:35], v[12:15], v[232:239], v74
  ds_read_b128 v[64:67], v76 offset:52224
  s_waitcnt lgkmcnt(5)
  v_smfmac_f32_16x16x64_bf16 v[20:23], v[0:3], v[144:151], v74
  s_barrier
  ds_read_b128 v[4:7], v76 offset:11776
  s_waitcnt lgkmcnt(4)
  v_smfmac_f32_16x16x64_bf16 v[28:31], v[0:3], v[36:43], v74
  ds_read_b128 v[12:15], v76 offset:12800
  ds_read_b128 v[36:39], v75 offset:0
  v_smfmac_f32_16x16x64_bf16 v[24:27], v[0:3], v[152:159], v74
  ds_read_b128 v[16:19], v76 offset:10752
  s_waitcnt lgkmcnt(6)
  v_smfmac_f32_16x16x64_bf16 v[20:23], v[8:11], v[160:167], v74
  ds_read_b128 v[40:43], v75 offset:1024
  s_waitcnt lgkmcnt(5)
  v_smfmac_f32_16x16x64_bf16 v[32:35], v[0:3], v[60:67], v74
  ds_read_b128 v[60:63], v75 offset:2048
  v_smfmac_f32_16x16x64_bf16 v[24:27], v[8:11], v[168:175], v74
  ds_read_b128 v[64:67], v75 offset:3072
  s_waitcnt lgkmcnt(6)
  v_smfmac_f32_16x16x64_bf16 v[20:23], v[4:7], v[176:183], v74
  buffer_load_dword off, s[12:15], s56 sc1 lds
  s_waitcnt lgkmcnt(5)
  v_smfmac_f32_16x16x64_bf16 v[20:23], v[12:15], v[192:199], v74
  s_waitcnt lgkmcnt(2)
  v_smfmac_f32_16x16x64_bf16 v[20:23], v[16:19], v[36:43], v74
  ds_read_b128 v[36:39], v75 offset:16384
  v_smfmac_f32_16x16x64_bf16 v[24:27], v[4:7], v[184:191], v74
  ds_read_b128 v[40:43], v75 offset:17408
  s_waitcnt lgkmcnt(2)
  v_smfmac_f32_16x16x64_bf16 v[24:27], v[16:19], v[60:67], v74
  ds_read_b128 v[60:63], v75 offset:18432
  v_add_f32 v20, v20, v22
  v_smfmac_f32_16x16x64_bf16 v[24:27], v[12:15], v[200:207], v74
  ds_read_b128 v[64:67], v75 offset:19456
  v_add_f32 v21, v21, v23
  v_smfmac_f32_16x16x64_bf16 v[28:31], v[16:19], v[240:247], v74
  v_mov_b64 v[70:71], s[78:79]
  v_smfmac_f32_16x16x64_bf16 v[28:31], v[4:7], a[0:7], v74
  s_waitcnt lgkmcnt(2)
  v_add_f32 v24, v24, v26
  v_smfmac_f32_16x16x64_bf16 v[28:31], v[8:11], v[36:43], v74
  ds_read_b128 v[36:39], v68
  v_cvt_pk_bf16_f32 v22, v20, v24
  v_smfmac_f32_16x16x64_bf16 v[28:31], v[12:15], a[16:23], v74
  ds_read_b128 v[40:43], v68
  ds_write_b32 v79, v22 offset:0
  s_waitcnt lgkmcnt(3)
  v_add_f32 v25, v25, v27
  v_cvt_pk_bf16_f32 v23, v21, v25
  v_smfmac_f32_16x16x64_bf16 v[32:35], v[8:11], v[60:67], v74
  ds_write_b32 v79, v23 offset:576
  v_cmp_u_f32 vcc, v20, v21
  v_smfmac_f32_16x16x64_bf16 v[32:35], v[16:19], v[248:255], v74
  v_add_f32 v28, v28, v30
  v_smfmac_f32_16x16x64_bf16 v[32:35], v[4:7], a[8:15], v74
  v_add_f32 v29, v29, v31
  v_smfmac_f32_16x16x64_bf16 v[32:35], v[12:15], a[24:31], v74
  s_cbranch_vccnz Cs0_rec
Cs0_recok:
  s_waitcnt lgkmcnt(3)
  v_smfmac_f32_16x16x64_bf16 v[36:39], v[16:19], a[128:135], v74
  s_waitcnt lgkmcnt(0)
  s_barrier
  ds_read_b128 v[60:63], v77
  v_smfmac_f32_16x16x64_bf16 v[40:43], v[16:19], a[136:143], v74
  ds_read_b128 v[64:67], v77 offset:128
  v_add_f32 v32, v32, v34
  v_cvt_pk_bf16_f32 v30, v28, v32
  v_smfmac_f32_16x16x64_bf16 v[36:39], v[0:3], a[96:103], v74
  ds_write_b32 v79, v30 offset:256
  v_add_f32 v33, v33, v35
  v_cvt_pk_bf16_f32 v31, v29, v33
  v_smfmac_f32_16x16x64_bf16 v[40:43], v[0:3], a[104:111], v74
  ds_write_b32 v79, v31 offset:832
  v_xor_b32 v75, 0x8000, v75
  v_smfmac_f32_16x16x64_bf16 v[36:39], v[4:7], a[144:151], v74
  ds_read_b128 v[0:3], v76 offset:4608
  v_mov_b32 v29, 0
  v_smfmac_f32_16x16x64_bf16 v[40:43], v[4:7], a[152:159], v74
  s_waitcnt vmcnt(3) lgkmcnt(3)
  v_mov_b32 v30, 0
  v_mfma_f32_16x16x32_bf16 v[44:47], v[44:47], v[60:63], 0
  ds_read_b128 v[4:7], v76 offset:5632
  s_waitcnt lgkmcnt(2)
  v_mfma_f32_16x16x32_bf16 v[44:47], v[48:51], v[64:67], v[44:47]
  s_barrier
  v_smfmac_f32_16x16x64_bf16 v[36:39], v[8:11], a[112:119], v74
  ds_read_b128 v[20:23], v77 offset:256
  ds_read_b128 v[24:27], v77 offset:384
  v_smfmac_f32_16x16x64_bf16 v[40:43], v[8:11], a[120:127], v74
  ds_read_b128 v[8:11], v76 offset:6656
  v_add_f32_dpp v72, v46, v44 quad_perm:[2,3,0,1] row_mask:0xf bank_mask:0xf
  v_add_f32_dpp v73, v47, v45 quad_perm:[2,3,0,1] row_mask:0xf bank_mask:0xf
  v_smfmac_f32_16x16x64_bf16 v[36:39], v[12:15], a[160:167], v74
  s_waitcnt lgkmcnt(4)
  v_exp_f32_dpp v72, v72 quad_perm:[0,1,0,1] row_mask:0xf bank_mask:0xf
  v_smfmac_f32_16x16x64_bf16 v[40:43], v[12:15], a[168:175], v74
  ds_read_b128 v[12:15], v76 offset:7680
  v_exp_f32_dpp v73, v73 quad_perm:[0,1,0,1] row_mask:0xf bank_mask:0xf
  v_smfmac_f32_16x16x64_bf16 v[36:39], v[0:3], a[32:39], v74
  s_waitcnt lgkmcnt(2)
  v_cvt_pk_bf16_f32 v72, v72, v73
  v_mfma_f32_16x16x32_bf16 v[20:23], v[20:23], v[60:63], 0
  ds_write_b32 v78, v72 offset:512
  v_mov_b64 v[16:17], 0
  v_mfma_f32_16x16x32_bf16 v[20:23], v[24:27], v[64:67], v[20:23]
  ds_read_b128 v[44:47], v75 offset:16384
  v_mov_b64 v[18:19], 0
  v_smfmac_f32_16x16x64_bf16 v[40:43], v[0:3], a[40:47], v74
  ds_read_b128 v[48:51], v75 offset:17408
  v_mov_b64 v[68:69], s[78:79]
  v_smfmac_f32_16x16x64_bf16 v[36:39], v[4:7], a[48:55], v74
  s_waitcnt lgkmcnt(4)
  v_add_f32_dpp v24, v22, v20 quad_perm:[2,3,0,1] row_mask:0xf bank_mask:0xf
  v_add_f32_dpp v25, v23, v21 quad_perm:[2,3,0,1] row_mask:0xf bank_mask:0xf
  v_smfmac_f32_16x16x64_bf16 v[36:39], v[8:11], a[64:71], v74
  s_waitcnt lgkmcnt(2)
  s_barrier
  ds_read_b128 v[32:35], v78 offset:512
  v_smfmac_f32_16x16x64_bf16 v[36:39], v[12:15], a[80:87], v74
  ds_read_b128 v[60:63], v75 offset:18432
  v_mul_f32 v24, s69, v24
  v_smfmac_f32_16x16x64_bf16 v[40:43], v[4:7], a[56:63], v74
  ds_read_b128 v[64:67], v75 offset:19456
  v_mul_f32 v25, s69, v25
  v_smfmac_f32_16x16x64_bf16 v[40:43], v[8:11], a[72:79], v74
  v_exp_f32_dpp v24, v24 quad_perm:[0,1,0,1] row_mask:0xf bank_mask:0xf
  v_smfmac_f32_16x16x64_bf16 v[40:43], v[12:15], a[88:95], v74
  s_waitcnt lgkmcnt(2)
  v_exp_f32_dpp v25, v25 quad_perm:[0,1,0,1] row_mask:0xf bank_mask:0xf
  v_mfma_f32_16x16x32_bf16 v[8:11], v[32:35], v[68:71], 0
  v_add_f32 v36, v36, v38
  v_add_f32 v37, v37, v39
  v_mfma_f32_16x16x32_bf16 v[0:3], v[32:35], v[52:55], 0
  v_add_f32 v40, v40, v42
  v_add_f32 v41, v41, v43
  v_mfma_f32_16x16x32_bf16 v[4:7], v[32:35], v[56:59], 0
  v_cvt_pk_bf16_f32 v28, v24, v25
  v_cvt_pk_bf16_f32 v72, v36, v37
  v_cvt_pk_bf16_f32 v73, v40, v41
  v_mfma_f32_16x16x16_bf16 v[8:11], v[28:29], v[68:69], v[8:11]
  v_cvt_pk_bf16_f32 v31, v24, v25
  v_mov_b64 v[20:21], 0
  v_mfma_f32_16x16x16_bf16 v[0:3], v[28:29], v[72:73], v[0:3]
  ds_read_b128 v[68:71], v76 offset:13824
  v_mov_b64 v[22:23], 0
  v_mfma_f32_16x16x16_bf16 v[4:7], v[30:31], v[72:73], v[4:7]
  v_rcp_f32 v10, v8
  v_rcp_f32 v11, v9
  v_mul_f32 v0, v10, v0
  v_mul_f32 v1, v11, v1
  s_nop 0
  v_mul_f32 v4, v10, v4
  v_mul_f32 v5, v11, v5
  v_cvt_pk_bf16_f32 v2, v0, v4
  ds_write_b32 v79, v2 offset:8704
  v_cvt_pk_bf16_f32 v3, v1, v5
  ds_write_b32 v79, v3 offset:9280
  v_max3_f32 v8, v8, v9, v10
  v_max_f32 v8, v8, v11
  v_cmp_le_f32 vcc, 1317011456, v8
  v_mov_b64 v[24:25], 0
  v_mov_b64 v[26:27], 0
  s_cbranch_vccnz Cs0_mx
Cs0_mxok:
  s_waitcnt lgkmcnt(0)
  s_barrier
  ds_read_b128 v[0:3], v78 offset:8704
  ds_read_b128 v[4:7], v78 offset:8768
  ds_read_b128 v[8:11], v78 offset:8832
  ds_read_b128 v[12:15], v78 offset:8896
  s_waitcnt lgkmcnt(3)
  v_smfmac_f32_16x16x64_bf16 v[16:19], v[0:3], v[44:51], v74
  ds_read_b128 v[52:55], v75 offset:32768
  s_waitcnt lgkmcnt(3)
  v_smfmac_f32_16x16x64_bf16 v[16:19], v[4:7], v[60:67], v74
  ds_read_b128 v[56:59], v75 offset:33792
  s_waitcnt lgkmcnt(3)
  v_smfmac_f32_16x16x64_bf16 v[16:19], v[8:11], a[176:183], v74
  ds_read_b128 v[36:39], v75 offset:34816
  s_waitcnt lgkmcnt(3)
  v_smfmac_f32_16x16x64_bf16 v[16:19], v[12:15], a[184:191], v74
  ds_read_b128 v[40:43], v75 offset:35840
  ds_read_b128 v[44:47], v75 offset:49152
  v_smfmac_f32_16x16x64_bf16 v[20:23], v[0:3], a[192:199], v74
  ds_read_b128 v[48:51], v75 offset:50176
  ds_read_b128 v[60:63], v75 offset:51200
  v_smfmac_f32_16x16x64_bf16 v[20:23], v[4:7], a[200:207], v74
  ds_read_b128 v[64:67], v75 offset:52224
  s_waitcnt lgkmcnt(6)
  v_cvt_pk_bf16_f32 v16, v16, v17
  v_cvt_pk_bf16_f32 v17, v18, v19
  v_bfi_b32 v16, 1, s72, v16
  v_smfmac_f32_16x16x64_bf16 v[20:23], v[8:11], v[52:59], v74
  buffer_store_dwordx2 v[16:17], v68, s[8:11], s73 offen sc1
  s_waitcnt lgkmcnt(4)
  v_smfmac_f32_16x16x64_bf16 v[20:23], v[12:15], v[36:43], v74
  v_mov_b64 v[32:33], 0
  v_smfmac_f32_16x16x64_bf16 v[24:27], v[0:3], a[208:215], v74
  v_mov_b64 v[34:35], 0
  v_smfmac_f32_16x16x64_bf16 v[24:27], v[4:7], a[216:223], v74
  s_waitcnt lgkmcnt(2)
  v_cvt_pk_bf16_f32 v20, v20, v21
  v_cvt_pk_bf16_f32 v21, v22, v23
  v_bfi_b32 v20, 1, s72, v20
  v_smfmac_f32_16x16x64_bf16 v[24:27], v[8:11], v[44:51], v74
  buffer_store_dwordx2 v[20:21], v68, s[8:11], s74 offen sc1
  s_waitcnt lgkmcnt(0)
  v_smfmac_f32_16x16x64_bf16 v[24:27], v[12:15], v[60:67], v74
  v_smfmac_f32_16x16x64_bf16 v[32:35], v[0:3], a[224:231], v74
  v_smfmac_f32_16x16x64_bf16 v[32:35], v[4:7], a[232:239], v74
  v_cvt_pk_bf16_f32 v24, v24, v25
  v_cvt_pk_bf16_f32 v25, v26, v27
  v_bfi_b32 v24, 1, s72, v24
  v_smfmac_f32_16x16x64_bf16 v[32:35], v[8:11], a[240:247], v74
  buffer_store_dwordx2 v[24:25], v68, s[8:11], s75 offen sc1
  v_smfmac_f32_16x16x64_bf16 v[32:35], v[12:15], a[248:255], v74
  v_mov_b64 v[18:19], v[72:73]
  s_nop 4
  v_cvt_pk_bf16_f32 v32, v32, v33
  v_cvt_pk_bf16_f32 v33, v34, v35
  v_bfi_b32 v32, 1, s72, v32
  buffer_store_dwordx2 v[32:33], v68, s[8:11], s76 offen sc1
  ds_read_b128 v[0:3], v76 offset:14848
  s_waitcnt lgkmcnt(0)
  ds_read_b64 v[16:17], v77 offset:256
  s_waitcnt lgkmcnt(0)
  ds_read_b128 v[64:67], v76 offset:19456
  s_waitcnt lgkmcnt(0)
  v_xor_b32 v75, 0x8000, v75
  s_waitcnt vmcnt(0)
  buffer_load_dwordx4 v[52:55], v76, s[8:11], s60 offen offset:0 sc1
  buffer_load_dwordx4 v[56:59], v76, s[8:11], s60 offen offset:1024 sc1
  s_add_u32 s66, s66, 1
  s_xor_b32 s64, s64, 16384
  s_xor_b32 s65, s65, 16384
  s_add_u32 s58, s58, 655360
  s_add_u32 s59, s59, 655360
  s_add_u32 s70, s70, 655360
  s_add_u32 s68, s68, 655360
  s_mov_b32 m0, 10752
  s_add_u32 s85, s65, 6144
  s_cmp_eq_u32 s66, 62
  s_cselect_b64 s[16:17], s[20:21], s[16:17]
  s_cselect_b32 s18, (Cs0_done - Cs0_last), s18
  s_cselect_b32 s70, 0, s70
  s_cmp_eq_u32 s66, 63
  s_cselect_b32 s59, 268435456, s59
  s_cselect_b32 s58, 268435456, s58
  s_waitcnt lgkmcnt(0)
  s_waitcnt vmcnt(1)
  v_mfma_f32_16x16x32_bf16 v[4:7], v[0:3], v[52:55], 0
  v_bitop3_b32 v72, v52, v54, s72 bitop3:0x7e
  s_waitcnt vmcnt(0)
  v_mfma_f32_16x16x32_bf16 v[4:7], v[0:3], v[56:59], v[4:7]
  v_bitop3_b32 v73, v56, v58, s72 bitop3:0x7e
  v_bitop3_b32 v72, v72, v73, 1 bitop3:0xa8
  v_cmp_ne_u32 vcc, 0, v72
  s_cbranch_vccnz Cs0_h1r
  s_nop 2
  v_add_f32_dpp v4, v4, v4 row_ror:4 row_mask:0xf bank_mask:0xf
  v_add_f32_dpp v5, v5, v5 row_ror:4 row_mask:0xf bank_mask:0xf
  s_nop 0
  v_add_f32_dpp v4, v4, v4 row_ror:8 row_mask:0xf bank_mask:0xf
  v_add_f32_dpp v5, v5, v5 row_ror:8 row_mask:0xf bank_mask:0xf
  v_cvt_pk_bf16_f32 v4, v4, v5
  buffer_store_dword v4, v69, s[8:11], s62 offen sc1
  s_xor_b32 s62, s62, 16384
  buffer_store_dword v71, v69, s[8:11], s62 offen sc1
  s_xor_b32 s72, s72, 1
  s_branch Cs0_h2
Cs0_h1r:
  s_mov_b64 exec, vcc
  buffer_load_dwordx4 v[52:55], v76, s[8:11], s60 offen offset:0 sc1
  buffer_load_dwordx4 v[56:59], v76, s[8:11], s60 offen offset:1024 sc1
  s_mov_b64 exec, -1
  s_add_u32 s67, s67, 1
  s_waitcnt vmcnt(1)
  v_mfma_f32_16x16x32_bf16 v[4:7], v[0:3], v[52:55], 0
  v_bitop3_b32 v72, v52, v54, s72 bitop3:0x7e
  s_waitcnt vmcnt(0)
  v_mfma_f32_16x16x32_bf16 v[4:7], v[0:3], v[56:59], v[4:7]
  v_bitop3_b32 v73, v56, v58, s72 bitop3:0x7e
  v_bitop3_b32 v72, v72, v73, 1 bitop3:0xa8
  v_cmp_ne_u32 vcc, 0, v72
  s_cbranch_vccz Cs0_h1p
Cs0_h1s:
  s_mov_b64 exec, vcc
  buffer_load_dwordx4 v[52:55], v76, s[8:11], s60 offen offset:0 sc1
  buffer_load_dwordx4 v[56:59], v76, s[8:11], s60 offen offset:1024 sc1
  s_mov_b64 exec, -1
  s_add_u32 s67, s67, 1
  s_waitcnt vmcnt(1)
  v_mfma_f32_16x16x32_bf16 v[4:7], v[0:3], v[52:55], 0
  v_bitop3_b32 v72, v52, v54, s72 bitop3:0x7e
  s_waitcnt vmcnt(0)
  v_mfma_f32_16x16x32_bf16 v[4:7], v[0:3], v[56:59], v[4:7]
  v_bitop3_b32 v73, v56, v58, s72 bitop3:0x7e
  v_bitop3_b32 v72, v72, v73, 1 bitop3:0xa8
  v_cmp_ne_u32 vcc, 0, v72
  s_cbranch_vccz Cs0_h1p
  s_cmp_lt_u32 s67, 131072
  s_cbranch_scc1 Cs0_h1s
Cs0_h1p:
  s_nop 2
  v_add_f32_dpp v4, v4, v4 row_ror:4 row_mask:0xf bank_mask:0xf
  v_add_f32_dpp v5, v5, v5 row_ror:4 row_mask:0xf bank_mask:0xf
  s_nop 0
  v_add_f32_dpp v4, v4, v4 row_ror:8 row_mask:0xf bank_mask:0xf
  v_add_f32_dpp v5, v5, v5 row_ror:8 row_mask:0xf bank_mask:0xf
  v_cvt_pk_bf16_f32 v4, v4, v5
  buffer_store_dword v4, v69, s[8:11], s62 offen sc1
  s_xor_b32 s62, s62, 16384
  buffer_store_dword v71, v69, s[8:11], s62 offen sc1
  s_xor_b32 s72, s72, 1
  s_branch Cs0_h2
Cs0_rec:
  s_nop 7
  s_waitcnt vmcnt(0) lgkmcnt(0)
  v_max3_u32 v72, v0, v1, v2
  v_max3_u32 v72, v72, v3, v4
  v_max3_u32 v72, v72, v5, v6
  v_max3_u32 v72, v72, v7, v8
  v_max3_u32 v72, v72, v9, v10
  v_max3_u32 v72, v72, v11, v12
  v_max3_u32 v72, v72, v13, v14
  v_max3_u32 v72, v72, v15, v16
  v_max3_u32 v72, v72, v17, v18
  v_max_u32 v72, v72, v19
  v_cmp_eq_u32 vcc, -1, v72
  s_cbranch_vccz Cs0_recok
  s_barrier
  v_mov_b64 v[20:21], 0
  v_mov_b64 v[22:23], 0
  v_mov_b64 v[24:25], 0
  v_mov_b64 v[26:27], 0
  v_mov_b64 v[28:29], 0
  v_mov_b64 v[30:31], 0
  v_mov_b64 v[32:33], 0
  v_mov_b64 v[34:35], 0
  s_waitcnt lgkmcnt(0)
  s_barrier
  ds_read_b128 v[0:3], v76 offset:4608
  s_waitcnt lgkmcnt(0)
  v_smfmac_f32_16x16x64_bf16 v[20:23], v[0:3], v[80:87], v74
  v_smfmac_f32_16x16x64_bf16 v[24:27], v[0:3], v[88:95], v74
  ds_read_b128 v[60:63], v76 offset:16384
  ds_read_b128 v[64:67], v76 offset:17408
  s_waitcnt lgkmcnt(0)
  v_smfmac_f32_16x16x64_bf16 v[28:31], v[0:3], v[60:67], v74
  ds_read_b128 v[60:63], v76 offset:18432
  ds_read_b128 v[64:67], v76 offset:19456
  s_waitcnt lgkmcnt(0)
  v_smfmac_f32_16x16x64_bf16 v[32:35], v[0:3], v[60:67], v74
  ds_read_b128 v[4:7], v76 offset:5632
  s_waitcnt lgkmcnt(0)
  v_smfmac_f32_16x16x64_bf16 v[20:23], v[4:7], v[96:103], v74
  v_smfmac_f32_16x16x64_bf16 v[24:27], v[4:7], v[104:111], v74
  ds_read_b128 v[60:63], v76 offset:32768
  ds_read_b128 v[64:67], v76 offset:33792
  s_waitcnt lgkmcnt(0)
  v_smfmac_f32_16x16x64_bf16 v[28:31], v[4:7], v[60:67], v74
  ds_read_b128 v[60:63], v76 offset:34816
  ds_read_b128 v[64:67], v76 offset:35840
  s_waitcnt lgkmcnt(0)
  v_smfmac_f32_16x16x64_bf16 v[32:35], v[4:7], v[60:67], v74
  ds_read_b128 v[8:11], v76 offset:6656
  s_waitcnt lgkmcnt(0)
  v_smfmac_f32_16x16x64_bf16 v[20:23], v[8:11], v[112:119], v74
  v_smfmac_f32_16x16x64_bf16 v[24:27], v[8:11], v[120:127], v74
  v_smfmac_f32_16x16x64_bf16 v[28:31], v[8:11], v[208:215], v74
  v_smfmac_f32_16x16x64_bf16 v[32:35], v[8:11], v[216:223], v74
  ds_read_b128 v[12:15], v76 offset:7680
  s_waitcnt lgkmcnt(0)
  v_smfmac_f32_16x16x64_bf16 v[20:23], v[12:15], v[128:135], v74
  v_smfmac_f32_16x16x64_bf16 v[24:27], v[12:15], v[136:143], v74
  v_smfmac_f32_16x16x64_bf16 v[28:31], v[12:15], v[224:231], v74
  v_smfmac_f32_16x16x64_bf16 v[32:35], v[12:15], v[232:239], v74
  ds_read_b128 v[0:3], v76 offset:8704
  s_waitcnt lgkmcnt(0)
  v_smfmac_f32_16x16x64_bf16 v[20:23], v[0:3], v[144:151], v74
  v_smfmac_f32_16x16x64_bf16 v[24:27], v[0:3], v[152:159], v74
  ds_read_b128 v[60:63], v76 offset:49152
  ds_read_b128 v[64:67], v76 offset:50176
  s_waitcnt lgkmcnt(0)
  v_smfmac_f32_16x16x64_bf16 v[28:31], v[0:3], v[60:67], v74
  ds_read_b128 v[60:63], v76 offset:51200
  ds_read_b128 v[64:67], v76 offset:52224
  s_waitcnt lgkmcnt(0)
  v_smfmac_f32_16x16x64_bf16 v[32:35], v[0:3], v[60:67], v74
  ds_read_b128 v[8:11], v76 offset:9728
  s_waitcnt lgkmcnt(0)
  v_smfmac_f32_16x16x64_bf16 v[20:23], v[8:11], v[160:167], v74
  v_smfmac_f32_16x16x64_bf16 v[24:27], v[8:11], v[168:175], v74
  ds_read_b128 v[60:63], v75 offset:16384
  ds_read_b128 v[64:67], v75 offset:17408
  s_waitcnt lgkmcnt(0)
  v_smfmac_f32_16x16x64_bf16 v[28:31], v[8:11], v[60:67], v74
  ds_read_b128 v[60:63], v75 offset:18432
  ds_read_b128 v[64:67], v75 offset:19456
  s_waitcnt lgkmcnt(0)
  v_smfmac_f32_16x16x64_bf16 v[32:35], v[8:11], v[60:67], v74
  ds_read_b128 v[16:19], v76 offset:10752
  ds_read_b128 v[60:63], v75 offset:0
  ds_read_b128 v[64:67], v75 offset:1024
  s_waitcnt lgkmcnt(0)
  v_smfmac_f32_16x16x64_bf16 v[20:23], v[16:19], v[60:67], v74
  ds_read_b128 v[60:63], v75 offset:2048
  ds_read_b128 v[64:67], v75 offset:3072
  s_waitcnt lgkmcnt(0)
  v_smfmac_f32_16x16x64_bf16 v[24:27], v[16:19], v[60:67], v74
  v_smfmac_f32_16x16x64_bf16 v[28:31], v[16:19], v[240:247], v74
  v_smfmac_f32_16x16x64_bf16 v[32:35], v[16:19], v[248:255], v74
  ds_read_b128 v[4:7], v76 offset:11776
  s_waitcnt lgkmcnt(0)
  v_smfmac_f32_16x16x64_bf16 v[20:23], v[4:7], v[176:183], v74
  v_smfmac_f32_16x16x64_bf16 v[24:27], v[4:7], v[184:191], v74
  v_smfmac_f32_16x16x64_bf16 v[28:31], v[4:7], a[0:7], v74
  v_smfmac_f32_16x16x64_bf16 v[32:35], v[4:7], a[8:15], v74
  ds_read_b128 v[12:15], v76 offset:12800
  s_waitcnt lgkmcnt(0)
  v_smfmac_f32_16x16x64_bf16 v[20:23], v[12:15], v[192:199], v74
  v_smfmac_f32_16x16x64_bf16 v[24:27], v[12:15], v[200:207], v74
  v_smfmac_f32_16x16x64_bf16 v[28:31], v[12:15], a[16:23], v74
  v_smfmac_f32_16x16x64_bf16 v[32:35], v[12:15], a[24:31], v74
  v_add_f32 v20, v20, v22
  v_add_f32 v21, v21, v23
  v_add_f32 v24, v24, v26
  v_cvt_pk_bf16_f32 v22, v20, v24
  ds_write_b32 v79, v22 offset:0
  v_add_f32 v25, v25, v27
  v_cvt_pk_bf16_f32 v23, v21, v25
  ds_write_b32 v79, v23 offset:576
  v_add_f32 v28, v28, v30
  v_add_f32 v29, v29, v31
  s_waitcnt lgkmcnt(0)
  s_nop 1
  s_branch Cs0_recok
Cs0_mx:
  s_waitcnt lgkmcnt(0)
  s_barrier
  buffer_load_dwordx4 v[0:3], v76, s[8:11], s58 offen offset:0 sc1
  ds_read_b128 v[20:23], v77 offset:0
  ds_read_b128 v[28:31], v77 offset:256
  buffer_load_dwordx4 v[4:7], v76, s[8:11], s58 offen offset:1024 sc1
  ds_read_b128 v[24:27], v77 offset:128
  ds_read_b128 v[32:35], v77 offset:384
  s_waitcnt vmcnt(1) lgkmcnt(3)
  v_mfma_f32_16x16x32_bf16 v[8:11], v[0:3], v[20:23], 0
  s_waitcnt vmcnt(0) lgkmcnt(1)
  v_mfma_f32_16x16x32_bf16 v[8:11], v[4:7], v[24:27], v[8:11]
  v_mfma_f32_16x16x32_bf16 v[12:15], v[28:31], v[20:23], 0
  s_waitcnt lgkmcnt(0)
  v_mfma_f32_16x16x32_bf16 v[12:15], v[32:35], v[24:27], v[12:15]
  v_add_f32_dpp v8, v10, v8 quad_perm:[2,3,0,1] row_mask:0xf bank_mask:0xf
  v_add_f32_dpp v9, v11, v9 quad_perm:[2,3,0,1] row_mask:0xf bank_mask:0xf
  s_nop 0
  v_mov_b32_dpp v8, v8 quad_perm:[0,1,0,1] row_mask:0xf bank_mask:0xf
  v_mov_b32_dpp v9, v9 quad_perm:[0,1,0,1] row_mask:0xf bank_mask:0xf
  s_nop 1
  v_add_f32_dpp v12, v14, v12 quad_perm:[2,3,0,1] row_mask:0xf bank_mask:0xf
  v_add_f32_dpp v13, v15, v13 quad_perm:[2,3,0,1] row_mask:0xf bank_mask:0xf
  s_nop 0
  v_mov_b32_dpp v12, v12 quad_perm:[0,1,0,1] row_mask:0xf bank_mask:0xf
  v_mov_b32_dpp v13, v13 quad_perm:[0,1,0,1] row_mask:0xf bank_mask:0xf
  v_mul_f32 v12, s69, v12
  ds_write_b32 v78, v8 offset:8704
  v_mul_f32 v13, s69, v13
  ds_write_b32 v78, v9 offset:8768
  s_waitcnt lgkmcnt(0)
  s_barrier
  ds_read_b128 v[36:39], v78 offset:8704
  ds_read_b128 v[40:43], v78 offset:8768
  s_waitcnt lgkmcnt(0)
  s_barrier
  v_max_f32 v16, v36, v37
  v_max3_f32 v16, v16, v38, v39
  v_max3_f32 v16, v16, v40, v41
  v_max3_f32 v16, v16, v42, v43
  v_max3_f32 v16, v16, v12, v13
  v_mov_b32 v17, v16
  s_nop 1
  v_permlane16_swap_b32 v16, v17
  v_max_f32 v16, v16, v17
  v_mov_b32 v17, v16
  s_nop 1
  v_permlane32_swap_b32 v16, v17
  v_max_f32 v16, v16, v17
  v_sub_f32 v36, v36, v16
  v_sub_f32 v37, v37, v16
  v_sub_f32 v38, v38, v16
  v_sub_f32 v39, v39, v16
  v_sub_f32 v40, v40, v16
  v_sub_f32 v41, v41, v16
  v_sub_f32 v42, v42, v16
  v_sub_f32 v43, v43, v16
  v_sub_f32 v12, v12, v16
  v_sub_f32 v13, v13, v16
  v_exp_f32 v36, v36
  v_exp_f32 v37, v37
  v_exp_f32 v38, v38
  v_exp_f32 v39, v39
  v_exp_f32 v40, v40
  v_exp_f32 v41, v41
  v_exp_f32 v42, v42
  v_exp_f32 v43, v43
  v_exp_f32 v12, v12
  v_exp_f32 v13, v13
  v_cvt_pk_bf16_f32 v32, v36, v40
  v_cvt_pk_bf16_f32 v33, v37, v41
  v_cvt_pk_bf16_f32 v34, v38, v42
  v_cvt_pk_bf16_f32 v35, v39, v43
  v_cvt_pk_bf16_f32 v28, v12, v13
  v_cvt_pk_bf16_f32 v31, v12, v13
  v_mov_b32 v29, 0
  v_mov_b32 v30, 0
  v_mov_b32 v68, 0x3f803f80
  v_mov_b32 v69, 0x3f803f80
  v_mov_b32 v70, 0x3f803f80
  v_mov_b32 v71, 0x3f803f80
  s_nop 1
  v_mfma_f32_16x16x32_bf16 v[8:11], v[32:35], v[68:71], 0
  v_mfma_f32_16x16x32_bf16 v[0:3], v[32:35], v[52:55], 0
  v_mfma_f32_16x16x32_bf16 v[4:7], v[32:35], v[56:59], 0
  v_mfma_f32_16x16x16_bf16 v[8:11], v[28:29], v[68:69], v[8:11]
  v_mfma_f32_16x16x16_bf16 v[0:3], v[28:29], v[72:73], v[0:3]
  v_mfma_f32_16x16x16_bf16 v[4:7], v[30:31], v[72:73], v[4:7]
  ds_read_b128 v[68:71], v76 offset:13824
  v_rcp_f32 v10, v8
  v_rcp_f32 v11, v9
  v_mul_f32 v0, v10, v0
  v_mul_f32 v1, v11, v1
  s_nop 0
  v_mul_f32 v4, v10, v4
  v_mul_f32 v5, v11, v5
  v_cvt_pk_bf16_f32 v2, v0, v4
  ds_write_b32 v79, v2 offset:8704
  v_cvt_pk_bf16_f32 v3, v1, v5
  ds_write_b32 v79, v3 offset:9280
  v_mov_b64 v[16:17], 0
  v_mov_b64 v[18:19], 0
  v_mov_b64 v[20:21], 0
  v_mov_b64 v[22:23], 0
  v_mov_b64 v[24:25], 0
  v_mov_b64 v[26:27], 0
  s_branch Cs0_mxok
Cs0_kv3:
  s_waitcnt lgkmcnt(0)
  s_cmp_ge_u32 s57, 0x700
  s_cbranch_scc1 Cs0_kvb
  s_load_dword s57, s[12:13], s71 glc
  s_add_u32 s67, s67, 1
  s_cmp_lt_u32 s67, 131072
  s_cbranch_scc1 Cs0_kv3
  s_waitcnt lgkmcnt(0)
  s_branch Cs0_kvb
Cs0_last:
  ds_read_b128 v[4:7], v76 offset:5632
  ds_read_b128 v[12:15], v76 offset:7680
  ds_read_b128 v[44:47], v76 offset:32768
  ds_read_b128 v[48:51], v76 offset:33792
  s_nop 5
  v_mov_b64 v[20:21], 0
  v_mov_b64 v[22:23], 0
  v_mov_b64 v[24:25], 0
  v_mov_b64 v[26:27], 0
  v_smfmac_f32_16x16x64_bf16 v[28:31], v[0:3], v[36:43], v74
  ds_read_b128 v[36:39], v76 offset:34816
  ds_read_b128 v[40:43], v76 offset:35840
  v_smfmac_f32_16x16x64_bf16 v[32:35], v[0:3], v[60:67], v74
  s_waitcnt lgkmcnt(5)
  v_smfmac_f32_16x16x64_bf16 v[20:23], v[0:3], a[32:39], v74
  ds_read_b128 v[60:63], v76 offset:49152
  ds_read_b128 v[64:67], v76 offset:50176
  v_smfmac_f32_16x16x64_bf16 v[24:27], v[0:3], a[40:47], v74
  s_waitcnt lgkmcnt(4)
  v_smfmac_f32_16x16x64_bf16 v[20:23], v[4:7], a[48:55], v74
  buffer_store_dwordx4 v[16:19], v76, s[8:11], s68 offen sc1
  v_smfmac_f32_16x16x64_bf16 v[24:27], v[4:7], a[56:63], v74
  v_smfmac_f32_16x16x64_bf16 v[28:31], v[4:7], v[44:51], v74
  s_waitcnt lgkmcnt(2)
  v_smfmac_f32_16x16x64_bf16 v[20:23], v[8:11], a[64:71], v74
  ds_read_b128 v[44:47], v76 offset:51200
  ds_read_b128 v[48:51], v76 offset:52224
  v_smfmac_f32_16x16x64_bf16 v[24:27], v[8:11], a[72:79], v74
  v_smfmac_f32_16x16x64_bf16 v[32:35], v[4:7], v[36:43], v74
  v_smfmac_f32_16x16x64_bf16 v[28:31], v[8:11], v[208:215], v74
  ds_read_b128 v[36:39], v75 offset:16384
  ds_read_b128 v[40:43], v75 offset:17408
  v_smfmac_f32_16x16x64_bf16 v[32:35], v[8:11], v[216:223], v74
  v_smfmac_f32_16x16x64_bf16 v[20:23], v[12:15], a[80:87], v74
  v_smfmac_f32_16x16x64_bf16 v[24:27], v[12:15], a[88:95], v74
  v_smfmac_f32_16x16x64_bf16 v[28:31], v[12:15], v[224:231], v74
  v_smfmac_f32_16x16x64_bf16 v[32:35], v[12:15], v[232:239], v74
  s_waitcnt vmcnt(1)
  s_barrier
Cs0_lastr:
  ds_read_b128 v[0:3], v76 offset:8704
  ds_read_b128 v[8:11], v76 offset:9728
  ds_read_b128 v[16:19], v76 offset:10752
  ds_read_b128 v[4:7], v76 offset:11776
  ds_read_b128 v[12:15], v76 offset:12800
  s_waitcnt lgkmcnt(4)
  v_max3_u32 v72, v0, v1, v2
  s_waitcnt lgkmcnt(1)
  v_max3_u32 v72, v72, v3, v4
  v_max3_u32 v72, v72, v5, v6
  v_max3_u32 v72, v72, v7, v8
  v_max3_u32 v72, v72, v9, v10
  s_waitcnt lgkmcnt(0)
  v_max3_u32 v72, v72, v11, v12
  v_max3_u32 v72, v72, v13, v14
  v_max3_u32 v72, v72, v15, v16
  v_max3_u32 v72, v72, v17, v18
  v_max_u32 v72, v72, v19
  v_cmp_eq_u32 vcc, -1, v72
  s_cbranch_vccnz Cs0_lastp
Cs0_lastg:
  v_smfmac_f32_16x16x64_bf16 v[28:31], v[0:3], v[60:67], v74
  ds_read_b128 v[60:63], v75 offset:18432
  ds_read_b128 v[64:67], v75 offset:19456
  v_smfmac_f32_16x16x64_bf16 v[32:35], v[0:3], v[44:51], v74
  v_smfmac_f32_16x16x64_bf16 v[28:31], v[8:11], v[36:43], v74
  v_smfmac_f32_16x16x64_bf16 v[28:31], v[16:19], v[240:247], v74
  v_smfmac_f32_16x16x64_bf16 v[28:31], v[4:7], a[0:7], v74
  v_smfmac_f32_16x16x64_bf16 v[28:31], v[12:15], a[16:23], v74
  v_smfmac_f32_16x16x64_bf16 v[32:35], v[16:19], v[248:255], v74
  v_smfmac_f32_16x16x64_bf16 v[32:35], v[4:7], a[8:15], v74
  s_waitcnt lgkmcnt(0)
  v_smfmac_f32_16x16x64_bf16 v[32:35], v[12:15], a[24:31], v74
  v_smfmac_f32_16x16x64_bf16 v[32:35], v[8:11], v[60:67], v74
  v_smfmac_f32_16x16x64_bf16 v[20:23], v[0:3], a[96:103], v74
  v_smfmac_f32_16x16x64_bf16 v[20:23], v[8:11], a[112:119], v74
  v_add_f32 v28, v28, v30
  v_add_f32 v32, v32, v34
  v_cvt_pk_bf16_f32 v30, v28, v32
  v_smfmac_f32_16x16x64_bf16 v[20:23], v[16:19], a[128:135], v74
  ds_write_b32 v79, v30 offset:256
  v_add_f32 v29, v29, v31
  v_add_f32 v33, v33, v35
  v_cvt_pk_bf16_f32 v31, v29, v33
  v_smfmac_f32_16x16x64_bf16 v[20:23], v[4:7], a[144:151], v74
  ds_write_b32 v79, v31 offset:832
  v_smfmac_f32_16x16x64_bf16 v[20:23], v[12:15], a[160:167], v74
  v_smfmac_f32_16x16x64_bf16 v[24:27], v[0:3], a[104:111], v74
  v_smfmac_f32_16x16x64_bf16 v[24:27], v[8:11], a[120:127], v74
  v_smfmac_f32_16x16x64_bf16 v[24:27], v[16:19], a[136:143], v74
  s_waitcnt lgkmcnt(0)
  s_barrier
  ds_read_b64 v[52:53], v77 offset:256
  v_add_f32 v20, v20, v22
  v_smfmac_f32_16x16x64_bf16 v[24:27], v[4:7], a[152:159], v74
  v_add_f32 v21, v21, v23
  v_smfmac_f32_16x16x64_bf16 v[24:27], v[12:15], a[168:175], v74
  v_cvt_pk_bf16_f32 v54, v20, v21
  s_add_u32 s68, s68, 655360
  s_nop 3
  v_add_f32 v24, v24, v26
  v_add_f32 v25, v25, v27
  v_cvt_pk_bf16_f32 v55, v24, v25
  s_waitcnt lgkmcnt(0)
  buffer_store_dwordx4 v[52:55], v76, s[8:11], s68 offen sc1
  s_branch Cs0_done
Cs0_lastp:
  s_add_u32 s72, s72, 2
  s_cmp_ge_u32 s72, 131072
  s_cbranch_scc1 Cs0_lastg
  s_barrier
  buffer_load_dwordx4 v76, s[8:11], s85 offen offset:0 sc1 lds
  s_waitcnt vmcnt(0)
  s_barrier
  s_branch Cs0_lastr
Cs0_done:
  s_branch L_cexit
L_w5:
  v_mov_b64 v[20:21], 0
  v_mov_b64 v[22:23], 0
  v_mov_b64 v[24:25], 0
  v_mov_b64 v[26:27], 0
  v_mov_b64 v[28:29], 0
  v_mov_b64 v[30:31], 0
  v_mov_b64 v[32:33], 0
  v_mov_b64 v[34:35], 0
  s_mov_b32 s78, 0x3f803f80
  s_mov_b32 s79, s78
  s_mov_b32 s65, 360448
  s_mov_b32 m0, 15872
  s_lshl_b32 s71, s53, 2
  s_add_u32 s71, s71, 128
  s_movk_i32 s56, 0x1000
  v_lshlrev_b32 v73, 2, v76
  v_mov_b32 v72, 0
  s_mov_b64 s[16:17], s[8:9]
  s_mov_b32 s18, 268435456
  s_mov_b32 s19, 0x20000
  s_getpc_b64 s[20:21]
Cs1_pc:
  s_add_u32 s20, s20, (Cs1_last - Cs1_pc)
  s_addc_u32 s21, s21, 0
  v_mov_b32 v68, 14880
  buffer_load_dwordx4 v[52:55], v76, s[8:11], s59 offen offset:0 sc1
  buffer_load_dwordx4 v[56:59], v76, s[8:11], s59 offen offset:1024 sc1
  ds_read_b128 v[36:39], v76 offset:20480
  ds_read_b128 v[40:43], v76 offset:21504
  ds_read_b128 v[60:63], v76 offset:22528
  ds_read_b128 v[64:67], v76 offset:23552
  ds_read_b128 v[0:3], v76 offset:4608
  ds_read_b128 v[4:7], v76 offset:5632
  ds_read_b128 v[8:11], v76 offset:6656
  ds_read_b128 v[12:15], v76 offset:7680
  s_waitcnt lgkmcnt(0)
  s_cmp_eq_u32 s66, 1
  s_branch Cs1_top2
.p2align 6
Cs1_h2:
  ds_read_b128 v[36:39], v76 offset:20480
  s_cmp_eq_u32 s66, 62
  s_cselect_b64 s[16:17], s[20:21], s[16:17]
  s_cselect_b32 s18, (Cs1_done - Cs1_last), s18
  s_cselect_b32 s70, 0, s70
  s_cmp_eq_u32 s66, 63
  s_cselect_b32 s59, 268435456, s59
  s_cselect_b32 s58, 268435456, s58
  ds_read_b128 v[40:43], v76 offset:21504
  v_mov_b64 v[20:21], 0
  v_mov_b64 v[22:23], 0
  v_mov_b64 v[24:25], 0
  v_mov_b64 v[26:27], 0
  v_mov_b32 v68, 14880
  ds_read_b128 v[60:63], v76 offset:22528
  v_mov_b64 v[28:29], 0
  v_mov_b64 v[30:31], 0
  v_mov_b64 v[32:33], 0
  v_mov_b64 v[34:35], 0
  v_lshlrev_b32 v73, 2, v76
  buffer_load_dwordx4 v[52:55], v76, s[8:11], s59 offen offset:0 sc1
  buffer_load_dwordx4 v[56:59], v76, s[8:11], s59 offen offset:1024 sc1
  s_waitcnt vmcnt(0)
  s_mov_b64 vcc, -1
Cs1_h2r:
  s_mov_b64 exec, vcc
  buffer_load_dwordx4 v[8:11], v76, s[8:11], s65 offen offset:2048 sc1
  buffer_load_dwordx4 v[0:3], v76, s[8:11], s85 offen offset:0 sc1
  s_mov_b64 exec, -1
  s_add_u32 s67, s67, 1
  s_cmp_lt_u32 s67, 131072
  s_cselect_b32 s54, -2, -1
  s_waitcnt vmcnt(1)
  v_max3_u32 v72, v8, v9, v10
  s_waitcnt vmcnt(0)
  v_max3_u32 v72, v72, v11, v0
  v_max3_u32 v72, v72, v1, v2
  v_max_u32 v72, v72, v3
  v_cmp_lt_u32 vcc, s54, v72
  s_cbranch_vccnz Cs1_h2r
  ds_write_b128 v76, v[8:11] offset:6656
  ds_write_b128 v76, v[0:3] offset:11776
Cs1_h2w:
  s_cmp_eq_u32 s66, 63
  s_waitcnt lgkmcnt(0)
  s_barrier
  ds_read_b128 v[0:3], v76 offset:4608
Cs1_top2:
  v_smfmac_f32_16x16x64_bf16 v[20:23], v[8:11], v[112:119], v74
  s_cbranch_scc1 Cs1_last
  v_smfmac_f32_16x16x64_bf16 v[24:27], v[8:11], v[120:127], v74
  buffer_load_dwordx4 v[44:47], v76, s[8:11], s58 offen offset:0 sc1
  s_mov_b32 m0, 15872
  v_smfmac_f32_16x16x64_bf16 v[28:31], v[8:11], v[208:215], v74
  buffer_load_dwordx4 v[48:51], v76, s[8:11], s58 offen offset:1024 sc1
  v_smfmac_f32_16x16x64_bf16 v[32:35], v[8:11], v[216:223], v74
  ds_read_b128 v[4:7], v76 offset:5632
  s_waitcnt lgkmcnt(1)
  v_smfmac_f32_16x16x64_bf16 v[20:23], v[0:3], v[80:87], v74
  ds_read_b128 v[12:15], v76 offset:7680
  v_smfmac_f32_16x16x64_bf16 v[28:31], v[0:3], v[36:43], v74
  ds_read_b128 v[36:39], v76 offset:36864
  v_smfmac_f32_16x16x64_bf16 v[24:27], v[0:3], v[88:95], v74
  buffer_store_dwordx4 v[16:19], v76, s[8:11], s68 offen sc1
  ds_read_b128 v[40:43], v76 offset:37888
  v_smfmac_f32_16x16x64_bf16 v[32:35], v[0:3], v[60:67], v74
  buffer_load_dword v73, s[16:19], s70 offen lds
  ds_read_b128 v[60:63], v76 offset:38912
  s_waitcnt lgkmcnt(4)
  v_smfmac_f32_16x16x64_bf16 v[20:23], v[4:7], v[96:103], v74
  ds_read_b128 v[64:67], v76 offset:39936
  v_smfmac_f32_16x16x64_bf16 v[24:27], v[4:7], v[104:111], v74
  s_waitcnt vmcnt(4)
  s_waitcnt lgkmcnt(4)
  v_smfmac_f32_16x16x64_bf16 v[20:23], v[12:15], v[128:135], v74
  s_barrier
  ds_read_b128 v[8:11], v76 offset:8704
  s_waitcnt lgkmcnt(3)
  v_smfmac_f32_16x16x64_bf16 v[28:31], v[4:7], v[36:43], v74
  ds_read_b128 v[36:39], v76 offset:53248
  v_smfmac_f32_16x16x64_bf16 v[24:27], v[12:15], v[136:143], v74
  ds_read_b128 v[40:43], v76 offset:54272
  s_waitcnt lgkmcnt(3)
  v_smfmac_f32_16x16x64_bf16 v[32:35], v[4:7], v[60:67], v74
  ds_read_b128 v[0:3], v76 offset:9728
  v_smfmac_f32_16x16x64_bf16 v[28:31], v[12:15], v[224:231], v74
  ds_read_b128 v[60:63], v76 offset:55296
  v_smfmac_f32_16x16x64_bf16 v[32:35], v[12:15], v[232:239], v74
  ds_read_b128 v[64:67], v76 offset:56320
  s_waitcnt lgkmcnt(5)
  v_smfmac_f32_16x16x64_bf16 v[20:23], v[8:11], v[144:151], v74
  s_barrier
  ds_read_b128 v[4:7], v76 offset:11776
  s_waitcnt lgkmcnt(4)
  v_smfmac_f32_16x16x64_bf16 v[28:31], v[8:11], v[36:43], v74
  ds_read_b128 v[12:15], v76 offset:12800
  ds_read_b128 v[36:39], v75 offset:4096
  v_smfmac_f32_16x16x64_bf16 v[24:27], v[8:11], v[152:159], v74
  ds_read_b128 v[16:19], v76 offset:10752
  s_waitcnt lgkmcnt(6)
  v_smfmac_f32_16x16x64_bf16 v[20:23], v[0:3], v[160:167], v74
  ds_read_b128 v[40:43], v75 offset:5120
  s_waitcnt lgkmcnt(5)
  v_smfmac_f32_16x16x64_bf16 v[32:35], v[8:11], v[60:67], v74
  ds_read_b128 v[60:63], v75 offset:6144
  v_smfmac_f32_16x16x64_bf16 v[24:27], v[0:3], v[168:175], v74
  ds_read_b128 v[64:67], v75 offset:7168
  s_waitcnt lgkmcnt(6)
  v_smfmac_f32_16x16x64_bf16 v[20:23], v[4:7], v[176:183], v74
  s_waitcnt lgkmcnt(5)
  v_smfmac_f32_16x16x64_bf16 v[20:23], v[12:15], v[192:199], v74
  s_waitcnt lgkmcnt(2)
  v_smfmac_f32_16x16x64_bf16 v[20:23], v[16:19], v[36:43], v74
  ds_read_b128 v[36:39], v75 offset:20480
  v_smfmac_f32_16x16x64_bf16 v[24:27], v[4:7], v[184:191], v74
  ds_read_b128 v[40:43], v75 offset:21504
  s_waitcnt lgkmcnt(2)
  v_smfmac_f32_16x16x64_bf16 v[24:27], v[16:19], v[60:67], v74
  ds_read_b128 v[60:63], v75 offset:22528
  v_add_f32 v20, v20, v22
  v_smfmac_f32_16x16x64_bf16 v[24:27], v[12:15], v[200:207], v74
  ds_read_b128 v[64:67], v75 offset:23552
  v_add_f32 v21, v21, v23
  v_smfmac_f32_16x16x64_bf16 v[28:31], v[16:19], v[240:247], v74
  v_mov_b64 v[70:71], s[78:79]
  v_smfmac_f32_16x16x64_bf16 v[28:31], v[4:7], a[0:7], v74
  s_waitcnt lgkmcnt(2)
  v_add_f32 v24, v24, v26
  v_smfmac_f32_16x16x64_bf16 v[28:31], v[0:3], v[36:43], v74
  ds_read_b128 v[36:39], v68
  v_cvt_pk_bf16_f32 v22, v20, v24
  v_smfmac_f32_16x16x64_bf16 v[28:31], v[12:15], a[16:23], v74
  ds_read_b128 v[40:43], v68
  ds_write_b32 v79, v22 offset:0
  s_waitcnt lgkmcnt(3)
  v_add_f32 v25, v25, v27
  v_cvt_pk_bf16_f32 v23, v21, v25
  v_smfmac_f32_16x16x64_bf16 v[32:35], v[0:3], v[60:67], v74
  ds_write_b32 v79, v23 offset:576
  v_cmp_u_f32 vcc, v20, v21
  v_smfmac_f32_16x16x64_bf16 v[32:35], v[16:19], v[248:255], v74
  v_add_f32 v28, v28, v30
  v_smfmac_f32_16x16x64_bf16 v[32:35], v[4:7], a[8:15], v74
  v_add_f32 v29, v29, v31
  v_smfmac_f32_16x16x64_bf16 v[32:35], v[12:15], a[24:31], v74
  s_cbranch_vccnz Cs1_rec
Cs1_recok:
  s_waitcnt lgkmcnt(3)
  v_smfmac_f32_16x16x64_bf16 v[36:39], v[16:19], a[128:135], v74
  s_waitcnt lgkmcnt(0)
  s_barrier
  ds_read_b128 v[60:63], v77
  v_smfmac_f32_16x16x64_bf16 v[40:43], v[16:19], a[136:143], v74
  ds_read_b128 v[64:67], v77 offset:128
  v_add_f32 v32, v32, v34
  v_cvt_pk_bf16_f32 v30, v28, v32
  v_smfmac_f32_16x16x64_bf16 v[36:39], v[0:3], a[112:119], v74
  ds_write_b32 v79, v30 offset:256
  v_add_f32 v33, v33, v35
  v_cvt_pk_bf16_f32 v31, v29, v33
  v_smfmac_f32_16x16x64_bf16 v[40:43], v[0:3], a[120:127], v74
  ds_write_b32 v79, v31 offset:832
  v_xor_b32 v75, 0x8000, v75
  v_smfmac_f32_16x16x64_bf16 v[36:39], v[4:7], a[144:151], v74
  ds_read_b128 v[0:3], v76 offset:4608
  v_mov_b32 v29, 0
  v_smfmac_f32_16x16x64_bf16 v[40:43], v[4:7], a[152:159], v74
  s_waitcnt vmcnt(2) lgkmcnt(3)
  v_mov_b32 v30, 0
  v_mfma_f32_16x16x32_bf16 v[44:47], v[44:47], v[60:63], 0
  ds_read_b128 v[4:7], v76 offset:5632
  s_waitcnt lgkmcnt(2)
  v_mfma_f32_16x16x32_bf16 v[44:47], v[48:51], v[64:67], v[44:47]
  s_barrier
  v_smfmac_f32_16x16x64_bf16 v[36:39], v[8:11], a[96:103], v74
  ds_read_b128 v[20:23], v77 offset:256
  ds_read_b128 v[24:27], v77 offset:384
  v_smfmac_f32_16x16x64_bf16 v[40:43], v[8:11], a[104:111], v74
  ds_read_b128 v[8:11], v76 offset:6656
  v_add_f32_dpp v72, v46, v44 quad_perm:[2,3,0,1] row_mask:0xf bank_mask:0xf
  v_add_f32_dpp v73, v47, v45 quad_perm:[2,3,0,1] row_mask:0xf bank_mask:0xf
  v_smfmac_f32_16x16x64_bf16 v[36:39], v[12:15], a[160:167], v74
  s_waitcnt lgkmcnt(4)
  v_exp_f32_dpp v72, v72 quad_perm:[0,1,0,1] row_mask:0xf bank_mask:0xf
  v_smfmac_f32_16x16x64_bf16 v[40:43], v[12:15], a[168:175], v74
  ds_read_b128 v[12:15], v76 offset:7680
  v_exp_f32_dpp v73, v73 quad_perm:[0,1,0,1] row_mask:0xf bank_mask:0xf
  v_smfmac_f32_16x16x64_bf16 v[36:39], v[0:3], a[32:39], v74
  s_waitcnt lgkmcnt(2)
  v_cvt_pk_bf16_f32 v72, v72, v73
  v_mfma_f32_16x16x32_bf16 v[20:23], v[20:23], v[60:63], 0
  ds_write_b32 v78, v72 offset:516
  v_mov_b64 v[16:17], 0
  v_mfma_f32_16x16x32_bf16 v[20:23], v[24:27], v[64:67], v[20:23]
  ds_read_b128 v[44:47], v75 offset:20480
  v_mov_b64 v[18:19], 0
  v_smfmac_f32_16x16x64_bf16 v[40:43], v[0:3], a[40:47], v74
  ds_read_b128 v[48:51], v75 offset:21504
  v_mov_b64 v[68:69], s[78:79]
  v_smfmac_f32_16x16x64_bf16 v[36:39], v[4:7], a[48:55], v74
  s_waitcnt lgkmcnt(4)
  v_add_f32_dpp v24, v22, v20 quad_perm:[2,3,0,1] row_mask:0xf bank_mask:0xf
  v_add_f32_dpp v25, v23, v21 quad_perm:[2,3,0,1] row_mask:0xf bank_mask:0xf
  v_smfmac_f32_16x16x64_bf16 v[36:39], v[8:11], a[64:71], v74
  s_waitcnt lgkmcnt(2)
  s_barrier
  ds_read_b128 v[32:35], v78 offset:512
  v_smfmac_f32_16x16x64_bf16 v[36:39], v[12:15], a[80:87], v74
  ds_read_b128 v[60:63], v75 offset:22528
  v_mul_f32 v24, s69, v24
  v_smfmac_f32_16x16x64_bf16 v[40:43], v[4:7], a[56:63], v74
  ds_read_b128 v[64:67], v75 offset:23552
  v_mul_f32 v25, s69, v25
  v_smfmac_f32_16x16x64_bf16 v[40:43], v[8:11], a[72:79], v74
  v_exp_f32_dpp v24, v24 quad_perm:[0,1,0,1] row_mask:0xf bank_mask:0xf
  v_smfmac_f32_16x16x64_bf16 v[40:43], v[12:15], a[88:95], v74
  s_waitcnt lgkmcnt(2)
  v_exp_f32_dpp v25, v25 quad_perm:[0,1,0,1] row_mask:0xf bank_mask:0xf
  v_mfma_f32_16x16x32_bf16 v[8:11], v[32:35], v[68:71], 0
  v_add_f32 v36, v36, v38
  v_add_f32 v37, v37, v39
  v_mfma_f32_16x16x32_bf16 v[0:3], v[32:35], v[52:55], 0
  v_add_f32 v40, v40, v42
  v_add_f32 v41, v41, v43
  v_mfma_f32_16x16x32_bf16 v[4:7], v[32:35], v[56:59], 0
  v_cvt_pk_bf16_f32 v28, v24, v25
  v_cvt_pk_bf16_f32 v72, v36, v37
  v_cvt_pk_bf16_f32 v73, v40, v41
  v_mfma_f32_16x16x16_bf16 v[8:11], v[28:29], v[68:69], v[8:11]
  v_cvt_pk_bf16_f32 v31, v24, v25
  v_mov_b64 v[20:21], 0
  v_mfma_f32_16x16x16_bf16 v[0:3], v[28:29], v[72:73], v[0:3]
  ds_read_b128 v[68:71], v76 offset:13824
  v_mov_b64 v[22:23], 0
  v_mfma_f32_16x16x16_bf16 v[4:7], v[30:31], v[72:73], v[4:7]
  v_rcp_f32 v10, v8
  v_rcp_f32 v11, v9
  v_mul_f32 v0, v10, v0
  v_mul_f32 v1, v11, v1
  s_nop 0
  v_mul_f32 v4, v10, v4
  v_mul_f32 v5, v11, v5
  v_cvt_pk_bf16_f32 v2, v0, v4
  ds_write_b32 v79, v2 offset:8704
  v_cvt_pk_bf16_f32 v3, v1, v5
  ds_write_b32 v79, v3 offset:9280
  v_max3_f32 v8, v8, v9, v10
  v_max_f32 v8, v8, v11
  v_cmp_le_f32 vcc, 1317011456, v8
  v_mov_b64 v[24:25], 0
  v_mov_b64 v[26:27], 0
  s_cbranch_vccnz Cs1_mx
Cs1_mxok:
  s_waitcnt lgkmcnt(0)
  s_barrier
  ds_read_b128 v[0:3], v78 offset:8704
  ds_read_b128 v[4:7], v78 offset:8768
  ds_read_b128 v[8:11], v78 offset:8832
  ds_read_b128 v[12:15], v78 offset:8896
  s_waitcnt lgkmcnt(3)
  v_smfmac_f32_16x16x64_bf16 v[16:19], v[0:3], v[44:51], v74
  ds_read_b128 v[52:55], v75 offset:36864
  s_waitcnt lgkmcnt(3)
  v_smfmac_f32_16x16x64_bf16 v[16:19], v[4:7], v[60:67], v74
  ds_read_b128 v[56:59], v75 offset:37888
  s_waitcnt lgkmcnt(3)
  v_smfmac_f32_16x16x64_bf16 v[16:19], v[8:11], a[176:183], v74
  ds_read_b128 v[36:39], v75 offset:38912
  s_waitcnt lgkmcnt(3)
  v_smfmac_f32_16x16x64_bf16 v[16:19], v[12:15], a[184:191], v74
  ds_read_b128 v[40:43], v75 offset:39936
  ds_read_b128 v[44:47], v75 offset:53248
  v_smfmac_f32_16x16x64_bf16 v[20:23], v[0:3], a[192:199], v74
  ds_read_b128 v[48:51], v75 offset:54272
  ds_read_b128 v[60:63], v75 offset:55296
  v_smfmac_f32_16x16x64_bf16 v[20:23], v[4:7], a[200:207], v74
  ds_read_b128 v[64:67], v75 offset:56320
  s_waitcnt lgkmcnt(6)
  v_cvt_pk_bf16_f32 v16, v16, v17
  v_cvt_pk_bf16_f32 v17, v18, v19
  v_bfi_b32 v16, 1, s72, v16
  v_smfmac_f32_16x16x64_bf16 v[20:23], v[8:11], v[52:59], v74
  buffer_store_dwordx2 v[16:17], v68, s[8:11], s73 offen sc1
  s_waitcnt lgkmcnt(4)
  v_smfmac_f32_16x16x64_bf16 v[20:23], v[12:15], v[36:43], v74
  v_mov_b64 v[32:33], 0
  v_smfmac_f32_16x16x64_bf16 v[24:27], v[0:3], a[208:215], v74
  v_mov_b64 v[34:35], 0
  v_smfmac_f32_16x16x64_bf16 v[24:27], v[4:7], a[216:223], v74
  s_waitcnt lgkmcnt(2)
  v_cvt_pk_bf16_f32 v20, v20, v21
  v_cvt_pk_bf16_f32 v21, v22, v23
  v_bfi_b32 v20, 1, s72, v20
  v_smfmac_f32_16x16x64_bf16 v[24:27], v[8:11], v[44:51], v74
  buffer_store_dwordx2 v[20:21], v68, s[8:11], s74 offen sc1
  s_waitcnt lgkmcnt(0)
  v_smfmac_f32_16x16x64_bf16 v[24:27], v[12:15], v[60:67], v74
  v_smfmac_f32_16x16x64_bf16 v[32:35], v[0:3], a[224:231], v74
  v_smfmac_f32_16x16x64_bf16 v[32:35], v[4:7], a[232:239], v74
  v_cvt_pk_bf16_f32 v24, v24, v25
  v_cvt_pk_bf16_f32 v25, v26, v27
  v_bfi_b32 v24, 1, s72, v24
  v_smfmac_f32_16x16x64_bf16 v[32:35], v[8:11], a[240:247], v74
  buffer_store_dwordx2 v[24:25], v68, s[8:11], s75 offen sc1
  v_smfmac_f32_16x16x64_bf16 v[32:35], v[12:15], a[248:255], v74
  v_mov_b64 v[18:19], v[72:73]
  s_nop 4
  v_cvt_pk_bf16_f32 v32, v32, v33
  v_cvt_pk_bf16_f32 v33, v34, v35
  v_bfi_b32 v32, 1, s72, v32
  buffer_store_dwordx2 v[32:33], v68, s[8:11], s76 offen sc1
  ds_read_b128 v[0:3], v76 offset:14848
  s_waitcnt lgkmcnt(0)
  ds_read_b64 v[16:17], v77 offset:264
  s_waitcnt lgkmcnt(0)
  ds_read_b128 v[64:67], v76 offset:23552
  s_waitcnt lgkmcnt(0)
  s_add_u32 s66, s66, 1
  s_xor_b32 s64, s64, 16384
  s_xor_b32 s65, s65, 16384
  s_add_u32 s58, s58, 655360
  s_add_u32 s59, s59, 655360
  s_add_u32 s70, s70, 655360
  s_add_u32 s68, s68, 655360
  s_mov_b32 m0, 11776
  s_add_u32 s85, s65, 7168
  v_xor_b32 v75, 0x8000, v75
  s_waitcnt vmcnt(0)
  buffer_load_dwordx4 v[52:55], v76, s[8:11], s60 offen offset:0 sc1
  buffer_load_dwordx4 v[56:59], v76, s[8:11], s60 offen offset:1024 sc1
  s_waitcnt lgkmcnt(0)
  s_waitcnt vmcnt(1)
  v_mfma_f32_16x16x32_bf16 v[4:7], v[0:3], v[52:55], 0
  v_bitop3_b32 v72, v52, v54, s72 bitop3:0x7e
  s_waitcnt vmcnt(0)
  v_mfma_f32_16x16x32_bf16 v[4:7], v[0:3], v[56:59], v[4:7]
  v_bitop3_b32 v73, v56, v58, s72 bitop3:0x7e
  v_bitop3_b32 v72, v72, v73, 1 bitop3:0xa8
  v_cmp_ne_u32 vcc, 0, v72
  s_cbranch_vccnz Cs1_h1r
  s_nop 2
  v_add_f32_dpp v4, v4, v4 row_ror:4 row_mask:0xf bank_mask:0xf
  v_add_f32_dpp v5, v5, v5 row_ror:4 row_mask:0xf bank_mask:0xf
  s_nop 0
  v_add_f32_dpp v4, v4, v4 row_ror:8 row_mask:0xf bank_mask:0xf
  v_add_f32_dpp v5, v5, v5 row_ror:8 row_mask:0xf bank_mask:0xf
  v_cvt_pk_bf16_f32 v4, v4, v5
  buffer_store_dword v4, v69, s[8:11], s62 offen sc1
  s_xor_b32 s62, s62, 16384
  buffer_store_dword v71, v69, s[8:11], s62 offen sc1
  s_xor_b32 s72, s72, 1
  s_branch Cs1_h2
Cs1_h1r:
  s_mov_b64 exec, vcc
  buffer_load_dwordx4 v[52:55], v76, s[8:11], s60 offen offset:0 sc1
  buffer_load_dwordx4 v[56:59], v76, s[8:11], s60 offen offset:1024 sc1
  s_mov_b64 exec, -1
  s_add_u32 s67, s67, 1
  s_waitcnt vmcnt(1)
  v_mfma_f32_16x16x32_bf16 v[4:7], v[0:3], v[52:55], 0
  v_bitop3_b32 v72, v52, v54, s72 bitop3:0x7e
  s_waitcnt vmcnt(0)
  v_mfma_f32_16x16x32_bf16 v[4:7], v[0:3], v[56:59], v[4:7]
  v_bitop3_b32 v73, v56, v58, s72 bitop3:0x7e
  v_bitop3_b32 v72, v72, v73, 1 bitop3:0xa8
  v_cmp_ne_u32 vcc, 0, v72
  s_cbranch_vccz Cs1_h1p
Cs1_h1s:
  s_mov_b64 exec, vcc
  buffer_load_dwordx4 v[52:55], v76, s[8:11], s60 offen offset:0 sc1
  buffer_load_dwordx4 v[56:59], v76, s[8:11], s60 offen offset:1024 sc1
  s_mov_b64 exec, -1
  s_add_u32 s67, s67, 1
  s_waitcnt vmcnt(1)
  v_mfma_f32_16x16x32_bf16 v[4:7], v[0:3], v[52:55], 0
  v_bitop3_b32 v72, v52, v54, s72 bitop3:0x7e
  s_waitcnt vmcnt(0)
  v_mfma_f32_16x16x32_bf16 v[4:7], v[0:3], v[56:59], v[4:7]
  v_bitop3_b32 v73, v56, v58, s72 bitop3:0x7e
  v_bitop3_b32 v72, v72, v73, 1 bitop3:0xa8
  v_cmp_ne_u32 vcc, 0, v72
  s_cbranch_vccz Cs1_h1p
  s_cmp_lt_u32 s67, 131072
  s_cbranch_scc1 Cs1_h1s
Cs1_h1p:
  s_nop 2
  v_add_f32_dpp v4, v4, v4 row_ror:4 row_mask:0xf bank_mask:0xf
  v_add_f32_dpp v5, v5, v5 row_ror:4 row_mask:0xf bank_mask:0xf
  s_nop 0
  v_add_f32_dpp v4, v4, v4 row_ror:8 row_mask:0xf bank_mask:0xf
  v_add_f32_dpp v5, v5, v5 row_ror:8 row_mask:0xf bank_mask:0xf
  v_cvt_pk_bf16_f32 v4, v4, v5
  buffer_store_dword v4, v69, s[8:11], s62 offen sc1
  s_xor_b32 s62, s62, 16384
  buffer_store_dword v71, v69, s[8:11], s62 offen sc1
  s_xor_b32 s72, s72, 1
  s_branch Cs1_h2
Cs1_rec:
  s_nop 7
  s_waitcnt vmcnt(0) lgkmcnt(0)
  v_max3_u32 v72, v0, v1, v2
  v_max3_u32 v72, v72, v3, v4
  v_max3_u32 v72, v72, v5, v6
  v_max3_u32 v72, v72, v7, v8
  v_max3_u32 v72, v72, v9, v10
  v_max3_u32 v72, v72, v11, v12
  v_max3_u32 v72, v72, v13, v14
  v_max3_u32 v72, v72, v15, v16
  v_max3_u32 v72, v72, v17, v18
  v_max_u32 v72, v72, v19
  v_cmp_eq_u32 vcc, -1, v72
  s_cbranch_vccz Cs1_recok
  s_barrier
  v_mov_b64 v[20:21], 0
  v_mov_b64 v[22:23], 0
  v_mov_b64 v[24:25], 0
  v_mov_b64 v[26:27], 0
  v_mov_b64 v[28:29], 0
  v_mov_b64 v[30:31], 0
  v_mov_b64 v[32:33], 0
  v_mov_b64 v[34:35], 0
  s_waitcnt lgkmcnt(0)
  s_barrier
  ds_read_b128 v[0:3], v76 offset:4608
  s_waitcnt lgkmcnt(0)
  v_smfmac_f32_16x16x64_bf16 v[20:23], v[0:3], v[80:87], v74
  v_smfmac_f32_16x16x64_bf16 v[24:27], v[0:3], v[88:95], v74
  ds_read_b128 v[60:63], v76 offset:20480
  ds_read_b128 v[64:67], v76 offset:21504
  s_waitcnt lgkmcnt(0)
  v_smfmac_f32_16x16x64_bf16 v[28:31], v[0:3], v[60:67], v74
  ds_read_b128 v[60:63], v76 offset:22528
  ds_read_b128 v[64:67], v76 offset:23552
  s_waitcnt lgkmcnt(0)
  v_smfmac_f32_16x16x64_bf16 v[32:35], v[0:3], v[60:67], v74
  ds_read_b128 v[4:7], v76 offset:5632
  s_waitcnt lgkmcnt(0)
  v_smfmac_f32_16x16x64_bf16 v[20:23], v[4:7], v[96:103], v74
  v_smfmac_f32_16x16x64_bf16 v[24:27], v[4:7], v[104:111], v74
  ds_read_b128 v[60:63], v76 offset:36864
  ds_read_b128 v[64:67], v76 offset:37888
  s_waitcnt lgkmcnt(0)
  v_smfmac_f32_16x16x64_bf16 v[28:31], v[4:7], v[60:67], v74
  ds_read_b128 v[60:63], v76 offset:38912
  ds_read_b128 v[64:67], v76 offset:39936
  s_waitcnt lgkmcnt(0)
  v_smfmac_f32_16x16x64_bf16 v[32:35], v[4:7], v[60:67], v74
  ds_read_b128 v[8:11], v76 offset:6656
  s_waitcnt lgkmcnt(0)
  v_smfmac_f32_16x16x64_bf16 v[20:23], v[8:11], v[112:119], v74
  v_smfmac_f32_16x16x64_bf16 v[24:27], v[8:11], v[120:127], v74
  v_smfmac_f32_16x16x64_bf16 v[28:31], v[8:11], v[208:215], v74
  v_smfmac_f32_16x16x64_bf16 v[32:35], v[8:11], v[216:223], v74
  ds_read_b128 v[12:15], v76 offset:7680
  s_waitcnt lgkmcnt(0)
  v_smfmac_f32_16x16x64_bf16 v[20:23], v[12:15], v[128:135], v74
  v_smfmac_f32_16x16x64_bf16 v[24:27], v[12:15], v[136:143], v74
  v_smfmac_f32_16x16x64_bf16 v[28:31], v[12:15], v[224:231], v74
  v_smfmac_f32_16x16x64_bf16 v[32:35], v[12:15], v[232:239], v74
  ds_read_b128 v[8:11], v76 offset:8704
  s_waitcnt lgkmcnt(0)
  v_smfmac_f32_16x16x64_bf16 v[20:23], v[8:11], v[144:151], v74
  v_smfmac_f32_16x16x64_bf16 v[24:27], v[8:11], v[152:159], v74
  ds_read_b128 v[60:63], v76 offset:53248
  ds_read_b128 v[64:67], v76 offset:54272
  s_waitcnt lgkmcnt(0)
  v_smfmac_f32_16x16x64_bf16 v[28:31], v[8:11], v[60:67], v74
  ds_read_b128 v[60:63], v76 offset:55296
  ds_read_b128 v[64:67], v76 offset:56320
  s_waitcnt lgkmcnt(0)
  v_smfmac_f32_16x16x64_bf16 v[32:35], v[8:11], v[60:67], v74
  ds_read_b128 v[0:3], v76 offset:9728
  s_waitcnt lgkmcnt(0)
  v_smfmac_f32_16x16x64_bf16 v[20:23], v[0:3], v[160:167], v74
  v_smfmac_f32_16x16x64_bf16 v[24:27], v[0:3], v[168:175], v74
  ds_read_b128 v[60:63], v75 offset:20480
  ds_read_b128 v[64:67], v75 offset:21504
  s_waitcnt lgkmcnt(0)
  v_smfmac_f32_16x16x64_bf16 v[28:31], v[0:3], v[60:67], v74
  ds_read_b128 v[60:63], v75 offset:22528
  ds_read_b128 v[64:67], v75 offset:23552
  s_waitcnt lgkmcnt(0)
  v_smfmac_f32_16x16x64_bf16 v[32:35], v[0:3], v[60:67], v74
  ds_read_b128 v[16:19], v76 offset:10752
  ds_read_b128 v[60:63], v75 offset:4096
  ds_read_b128 v[64:67], v75 offset:5120
  s_waitcnt lgkmcnt(0)
  v_smfmac_f32_16x16x64_bf16 v[20:23], v[16:19], v[60:67], v74
  ds_read_b128 v[60:63], v75 offset:6144
  ds_read_b128 v[64:67], v75 offset:7168
  s_waitcnt lgkmcnt(0)
  v_smfmac_f32_16x16x64_bf16 v[24:27], v[16:19], v[60:67], v74
  v_smfmac_f32_16x16x64_bf16 v[28:31], v[16:19], v[240:247], v74
  v_smfmac_f32_16x16x64_bf16 v[32:35], v[16:19], v[248:255], v74
  ds_read_b128 v[4:7], v76 offset:11776
  s_waitcnt lgkmcnt(0)
  v_smfmac_f32_16x16x64_bf16 v[20:23], v[4:7], v[176:183], v74
  v_smfmac_f32_16x16x64_bf16 v[24:27], v[4:7], v[184:191], v74
  v_smfmac_f32_16x16x64_bf16 v[28:31], v[4:7], a[0:7], v74
  v_smfmac_f32_16x16x64_bf16 v[32:35], v[4:7], a[8:15], v74
  ds_read_b128 v[12:15], v76 offset:12800
  s_waitcnt lgkmcnt(0)
  v_smfmac_f32_16x16x64_bf16 v[20:23], v[12:15], v[192:199], v74
  v_smfmac_f32_16x16x64_bf16 v[24:27], v[12:15], v[200:207], v74
  v_smfmac_f32_16x16x64_bf16 v[28:31], v[12:15], a[16:23], v74
  v_smfmac_f32_16x16x64_bf16 v[32:35], v[12:15], a[24:31], v74
  v_add_f32 v20, v20, v22
  v_add_f32 v21, v21, v23
  v_add_f32 v24, v24, v26
  v_cvt_pk_bf16_f32 v22, v20, v24
  ds_write_b32 v79, v22 offset:0
  v_add_f32 v25, v25, v27
  v_cvt_pk_bf16_f32 v23, v21, v25
  ds_write_b32 v79, v23 offset:576
  v_add_f32 v28, v28, v30
  v_add_f32 v29, v29, v31
  s_waitcnt lgkmcnt(0)
  s_nop 1
  s_branch Cs1_recok
Cs1_mx:
  s_waitcnt lgkmcnt(0)
  s_barrier
  buffer_load_dwordx4 v[0:3], v76, s[8:11], s58 offen offset:0 sc1
  ds_read_b128 v[20:23], v77 offset:0
  ds_read_b128 v[28:31], v77 offset:256
  buffer_load_dwordx4 v[4:7], v76, s[8:11], s58 offen offset:1024 sc1
  ds_read_b128 v[24:27], v77 offset:128
  ds_read_b128 v[32:35], v77 offset:384
  s_waitcnt vmcnt(1) lgkmcnt(3)
  v_mfma_f32_16x16x32_bf16 v[8:11], v[0:3], v[20:23], 0
  s_waitcnt vmcnt(0) lgkmcnt(1)
  v_mfma_f32_16x16x32_bf16 v[8:11], v[4:7], v[24:27], v[8:11]
  v_mfma_f32_16x16x32_bf16 v[12:15], v[28:31], v[20:23], 0
  s_waitcnt lgkmcnt(0)
  v_mfma_f32_16x16x32_bf16 v[12:15], v[32:35], v[24:27], v[12:15]
  v_add_f32_dpp v8, v10, v8 quad_perm:[2,3,0,1] row_mask:0xf bank_mask:0xf
  v_add_f32_dpp v9, v11, v9 quad_perm:[2,3,0,1] row_mask:0xf bank_mask:0xf
  s_nop 0
  v_mov_b32_dpp v8, v8 quad_perm:[0,1,0,1] row_mask:0xf bank_mask:0xf
  v_mov_b32_dpp v9, v9 quad_perm:[0,1,0,1] row_mask:0xf bank_mask:0xf
  s_nop 1
  v_add_f32_dpp v12, v14, v12 quad_perm:[2,3,0,1] row_mask:0xf bank_mask:0xf
  v_add_f32_dpp v13, v15, v13 quad_perm:[2,3,0,1] row_mask:0xf bank_mask:0xf
  s_nop 0
  v_mov_b32_dpp v12, v12 quad_perm:[0,1,0,1] row_mask:0xf bank_mask:0xf
  v_mov_b32_dpp v13, v13 quad_perm:[0,1,0,1] row_mask:0xf bank_mask:0xf
  v_mul_f32 v12, s69, v12
  ds_write_b32 v78, v8 offset:8708
  v_mul_f32 v13, s69, v13
  ds_write_b32 v78, v9 offset:8772
  s_waitcnt lgkmcnt(0)
  s_barrier
  ds_read_b128 v[36:39], v78 offset:8704
  ds_read_b128 v[40:43], v78 offset:8768
  s_waitcnt lgkmcnt(0)
  s_barrier
  v_max_f32 v16, v36, v37
  v_max3_f32 v16, v16, v38, v39
  v_max3_f32 v16, v16, v40, v41
  v_max3_f32 v16, v16, v42, v43
  v_max3_f32 v16, v16, v12, v13
  v_mov_b32 v17, v16
  s_nop 1
  v_permlane16_swap_b32 v16, v17
  v_max_f32 v16, v16, v17
  v_mov_b32 v17, v16
  s_nop 1
  v_permlane32_swap_b32 v16, v17
  v_max_f32 v16, v16, v17
  v_sub_f32 v36, v36, v16
  v_sub_f32 v37, v37, v16
  v_sub_f32 v38, v38, v16
  v_sub_f32 v39, v39, v16
  v_sub_f32 v40, v40, v16
  v_sub_f32 v41, v41, v16
  v_sub_f32 v42, v42, v16
  v_sub_f32 v43, v43, v16
  v_sub_f32 v12, v12, v16
  v_sub_f32 v13, v13, v16
  v_exp_f32 v36, v36
  v_exp_f32 v37, v37
  v_exp_f32 v38, v38
  v_exp_f32 v39, v39
  v_exp_f32 v40, v40
  v_exp_f32 v41, v41
  v_exp_f32 v42, v42
  v_exp_f32 v43, v43
  v_exp_f32 v12, v12
  v_exp_f32 v13, v13
  v_cvt_pk_bf16_f32 v32, v36, v40
  v_cvt_pk_bf16_f32 v33, v37, v41
  v_cvt_pk_bf16_f32 v34, v38, v42
  v_cvt_pk_bf16_f32 v35, v39, v43
  v_cvt_pk_bf16_f32 v28, v12, v13
  v_cvt_pk_bf16_f32 v31, v12, v13
  v_mov_b32 v29, 0
  v_mov_b32 v30, 0
  v_mov_b32 v68, 0x3f803f80
  v_mov_b32 v69, 0x3f803f80
  v_mov_b32 v70, 0x3f803f80
  v_mov_b32 v71, 0x3f803f80
  s_nop 1
  v_mfma_f32_16x16x32_bf16 v[8:11], v[32:35], v[68:71], 0
  v_mfma_f32_16x16x32_bf16 v[0:3], v[32:35], v[52:55], 0
  v_mfma_f32_16x16x32_bf16 v[4:7], v[32:35], v[56:59], 0
  v_mfma_f32_16x16x16_bf16 v[8:11], v[28:29], v[68:69], v[8:11]
  v_mfma_f32_16x16x16_bf16 v[0:3], v[28:29], v[72:73], v[0:3]
  v_mfma_f32_16x16x16_bf16 v[4:7], v[30:31], v[72:73], v[4:7]
  ds_read_b128 v[68:71], v76 offset:13824
  v_rcp_f32 v10, v8
  v_rcp_f32 v11, v9
  v_mul_f32 v0, v10, v0
  v_mul_f32 v1, v11, v1
  s_nop 0
  v_mul_f32 v4, v10, v4
  v_mul_f32 v5, v11, v5
  v_cvt_pk_bf16_f32 v2, v0, v4
  ds_write_b32 v79, v2 offset:8704
  v_cvt_pk_bf16_f32 v3, v1, v5
  ds_write_b32 v79, v3 offset:9280
  v_mov_b64 v[16:17], 0
  v_mov_b64 v[18:19], 0
  v_mov_b64 v[20:21], 0
  v_mov_b64 v[22:23], 0
  v_mov_b64 v[24:25], 0
  v_mov_b64 v[26:27], 0
  s_branch Cs1_mxok
Cs1_last:
  ds_read_b128 v[4:7], v76 offset:5632
  ds_read_b128 v[12:15], v76 offset:7680
  ds_read_b128 v[44:47], v76 offset:36864
  ds_read_b128 v[48:51], v76 offset:37888
  s_nop 5
  v_mov_b64 v[20:21], 0
  v_mov_b64 v[22:23], 0
  v_mov_b64 v[24:25], 0
  v_mov_b64 v[26:27], 0
  s_waitcnt lgkmcnt(4)
  v_smfmac_f32_16x16x64_bf16 v[28:31], v[0:3], v[36:43], v74
  ds_read_b128 v[36:39], v76 offset:38912
  ds_read_b128 v[40:43], v76 offset:39936
  v_smfmac_f32_16x16x64_bf16 v[32:35], v[0:3], v[60:67], v74
  s_waitcnt lgkmcnt(5)
  v_smfmac_f32_16x16x64_bf16 v[20:23], v[0:3], a[32:39], v74
  ds_read_b128 v[60:63], v76 offset:53248
  ds_read_b128 v[64:67], v76 offset:54272
  v_smfmac_f32_16x16x64_bf16 v[24:27], v[0:3], a[40:47], v74
  s_waitcnt lgkmcnt(4)
  v_smfmac_f32_16x16x64_bf16 v[20:23], v[4:7], a[48:55], v74
  buffer_store_dwordx4 v[16:19], v76, s[8:11], s68 offen sc1
  v_smfmac_f32_16x16x64_bf16 v[24:27], v[4:7], a[56:63], v74
  v_smfmac_f32_16x16x64_bf16 v[28:31], v[4:7], v[44:51], v74
  s_waitcnt lgkmcnt(2)
  v_smfmac_f32_16x16x64_bf16 v[20:23], v[8:11], a[64:71], v74
  ds_read_b128 v[44:47], v76 offset:55296
  ds_read_b128 v[48:51], v76 offset:56320
  v_smfmac_f32_16x16x64_bf16 v[24:27], v[8:11], a[72:79], v74
  v_smfmac_f32_16x16x64_bf16 v[32:35], v[4:7], v[36:43], v74
  v_smfmac_f32_16x16x64_bf16 v[28:31], v[8:11], v[208:215], v74
  ds_read_b128 v[36:39], v75 offset:20480
  ds_read_b128 v[40:43], v75 offset:21504
  v_smfmac_f32_16x16x64_bf16 v[32:35], v[8:11], v[216:223], v74
  v_smfmac_f32_16x16x64_bf16 v[20:23], v[12:15], a[80:87], v74
  v_smfmac_f32_16x16x64_bf16 v[24:27], v[12:15], a[88:95], v74
  v_smfmac_f32_16x16x64_bf16 v[28:31], v[12:15], v[224:231], v74
  v_smfmac_f32_16x16x64_bf16 v[32:35], v[12:15], v[232:239], v74
  s_waitcnt vmcnt(1)
  s_barrier
Cs1_lastr:
  ds_read_b128 v[8:11], v76 offset:8704
  ds_read_b128 v[0:3], v76 offset:9728
  ds_read_b128 v[16:19], v76 offset:10752
  ds_read_b128 v[4:7], v76 offset:11776
  ds_read_b128 v[12:15], v76 offset:12800
  s_waitcnt lgkmcnt(3)
  v_max3_u32 v72, v0, v1, v2
  s_waitcnt lgkmcnt(1)
  v_max3_u32 v72, v72, v3, v4
  v_max3_u32 v72, v72, v5, v6
  v_max3_u32 v72, v72, v7, v8
  v_max3_u32 v72, v72, v9, v10
  s_waitcnt lgkmcnt(0)
  v_max3_u32 v72, v72, v11, v12
  v_max3_u32 v72, v72, v13, v14
  v_max3_u32 v72, v72, v15, v16
  v_max3_u32 v72, v72, v17, v18
  v_max_u32 v72, v72, v19
  v_cmp_eq_u32 vcc, -1, v72
  s_cbranch_vccnz Cs1_lastp
Cs1_lastg:
  v_smfmac_f32_16x16x64_bf16 v[28:31], v[8:11], v[60:67], v74
  ds_read_b128 v[60:63], v75 offset:22528
  ds_read_b128 v[64:67], v75 offset:23552
  v_smfmac_f32_16x16x64_bf16 v[32:35], v[8:11], v[44:51], v74
  v_smfmac_f32_16x16x64_bf16 v[28:31], v[0:3], v[36:43], v74
  v_smfmac_f32_16x16x64_bf16 v[28:31], v[16:19], v[240:247], v74
  v_smfmac_f32_16x16x64_bf16 v[28:31], v[4:7], a[0:7], v74
  v_smfmac_f32_16x16x64_bf16 v[28:31], v[12:15], a[16:23], v74
  v_smfmac_f32_16x16x64_bf16 v[32:35], v[16:19], v[248:255], v74
  v_smfmac_f32_16x16x64_bf16 v[32:35], v[4:7], a[8:15], v74
  s_waitcnt lgkmcnt(0)
  v_smfmac_f32_16x16x64_bf16 v[32:35], v[12:15], a[24:31], v74
  v_smfmac_f32_16x16x64_bf16 v[32:35], v[0:3], v[60:67], v74
  v_smfmac_f32_16x16x64_bf16 v[20:23], v[8:11], a[96:103], v74
  v_smfmac_f32_16x16x64_bf16 v[20:23], v[0:3], a[112:119], v74
  v_add_f32 v28, v28, v30
  v_add_f32 v32, v32, v34
  v_cvt_pk_bf16_f32 v30, v28, v32
  v_smfmac_f32_16x16x64_bf16 v[20:23], v[16:19], a[128:135], v74
  ds_write_b32 v79, v30 offset:256
  v_add_f32 v29, v29, v31
  v_add_f32 v33, v33, v35
  v_cvt_pk_bf16_f32 v31, v29, v33
  v_smfmac_f32_16x16x64_bf16 v[20:23], v[4:7], a[144:151], v74
  ds_write_b32 v79, v31 offset:832
  v_smfmac_f32_16x16x64_bf16 v[20:23], v[12:15], a[160:167], v74
  v_smfmac_f32_16x16x64_bf16 v[24:27], v[8:11], a[104:111], v74
  v_smfmac_f32_16x16x64_bf16 v[24:27], v[0:3], a[120:127], v74
  v_smfmac_f32_16x16x64_bf16 v[24:27], v[16:19], a[136:143], v74
  s_waitcnt lgkmcnt(0)
  s_barrier
  ds_read_b64 v[52:53], v77 offset:264
  v_add_f32 v20, v20, v22
  v_smfmac_f32_16x16x64_bf16 v[24:27], v[4:7], a[152:159], v74
  v_add_f32 v21, v21, v23
  v_smfmac_f32_16x16x64_bf16 v[24:27], v[12:15], a[168:175], v74
  v_cvt_pk_bf16_f32 v54, v20, v21
  s_add_u32 s68, s68, 655360
  s_nop 3
  v_add_f32 v24, v24, v26
  v_add_f32 v25, v25, v27
  v_cvt_pk_bf16_f32 v55, v24, v25
  s_waitcnt lgkmcnt(0)
  buffer_store_dwordx4 v[52:55], v76, s[8:11], s68 offen sc1
  s_branch Cs1_done
Cs1_lastp:
  s_add_u32 s72, s72, 2
  s_cmp_ge_u32 s72, 131072
  s_cbranch_scc1 Cs1_lastg
  s_barrier
  buffer_load_dwordx4 v76, s[8:11], s85 offen offset:0 sc1 lds
  s_waitcnt vmcnt(0)
  s_barrier
  s_branch Cs1_lastr
Cs1_done:
  s_branch L_cexit
L_w6:
  v_mov_b64 v[20:21], 0
  v_mov_b64 v[22:23], 0
  v_mov_b64 v[24:25], 0
  v_mov_b64 v[26:27], 0
  v_mov_b64 v[28:29], 0
  v_mov_b64 v[30:31], 0
  v_mov_b64 v[32:33], 0
  v_mov_b64 v[34:35], 0
  s_mov_b32 s78, 0x3f803f80
  s_mov_b32 s79, s78
  s_mov_b32 s65, 360448
  s_mov_b32 m0, 15872
  s_lshl_b32 s71, s53, 2
  s_add_u32 s71, s71, 128
  s_movk_i32 s56, 0x1000
  v_lshlrev_b32 v73, 2, v76
  v_mov_b32 v72, 0
  s_mov_b64 s[16:17], s[8:9]
  s_mov_b32 s18, 268435456
  s_mov_b32 s19, 0x20000
  s_getpc_b64 s[20:21]
Cs2_pc:
  s_add_u32 s20, s20, (Cs2_last - Cs2_pc)
  s_addc_u32 s21, s21, 0
  v_mov_b32 v68, 14880
  buffer_load_dwordx4 v[52:55], v76, s[8:11], s59 offen offset:0 sc1
  buffer_load_dwordx4 v[56:59], v76, s[8:11], s59 offen offset:1024 sc1
  ds_read_b128 v[36:39], v76 offset:24576
  ds_read_b128 v[40:43], v76 offset:25600
  ds_read_b128 v[60:63], v76 offset:26624
  ds_read_b128 v[64:67], v76 offset:27648
  ds_read_b128 v[0:3], v76 offset:4608
  ds_read_b128 v[4:7], v76 offset:5632
  ds_read_b128 v[8:11], v76 offset:6656
  ds_read_b128 v[12:15], v76 offset:7680
  s_waitcnt lgkmcnt(0)
  s_cmp_eq_u32 s66, 1
  s_branch Cs2_top2
.p2align 6
Cs2_h2:
  s_cmp_eq_u32 s66, 62
  s_cselect_b64 s[16:17], s[20:21], s[16:17]
  s_cselect_b32 s18, (Cs2_done - Cs2_last), s18
  s_cselect_b32 s70, 0, s70
  s_cmp_eq_u32 s66, 63
  s_cselect_b32 s59, 268435456, s59
  s_cselect_b32 s58, 268435456, s58
  ds_read_b128 v[36:39], v76 offset:24576
  v_mov_b64 v[28:29], 0
  v_mov_b64 v[30:31], 0
  v_mov_b64 v[32:33], 0
  v_mov_b64 v[34:35], 0
  v_lshlrev_b32 v73, 2, v76
  ds_read_b128 v[40:43], v76 offset:25600
  v_mov_b64 v[20:21], 0
  v_mov_b64 v[22:23], 0
  v_mov_b64 v[24:25], 0
  v_mov_b64 v[26:27], 0
  v_mov_b32 v68, 14880
  buffer_load_dwordx4 v[52:55], v76, s[8:11], s59 offen offset:0 sc1
  buffer_load_dwordx4 v[56:59], v76, s[8:11], s59 offen offset:1024 sc1
  s_waitcnt vmcnt(0)
  s_mov_b64 vcc, -1
Cs2_h2r:
  s_mov_b64 exec, vcc
  buffer_load_dwordx4 v[12:15], v76, s[8:11], s65 offen offset:3072 sc1
  buffer_load_dwordx4 v[0:3], v76, s[8:11], s85 offen offset:0 sc1
  s_mov_b64 exec, -1
  s_add_u32 s67, s67, 1
  s_cmp_lt_u32 s67, 131072
  s_cselect_b32 s54, -2, -1
  s_waitcnt vmcnt(1)
  v_max3_u32 v72, v12, v13, v14
  s_waitcnt vmcnt(0)
  v_max3_u32 v72, v72, v15, v0
  v_max3_u32 v72, v72, v1, v2
  v_max_u32 v72, v72, v3
  v_cmp_lt_u32 vcc, s54, v72
  s_cbranch_vccnz Cs2_h2r
  ds_write_b128 v76, v[12:15] offset:7680
  ds_write_b128 v76, v[0:3] offset:12800
Cs2_h2w:
  s_cmp_eq_u32 s66, 63
  s_waitcnt lgkmcnt(0)
  s_barrier
  ds_read_b128 v[0:3], v76 offset:4608
Cs2_top2:
  v_smfmac_f32_16x16x64_bf16 v[20:23], v[12:15], v[128:135], v74
  s_cbranch_scc1 Cs2_last
  v_smfmac_f32_16x16x64_bf16 v[24:27], v[12:15], v[136:143], v74
  buffer_load_dwordx4 v[44:47], v76, s[8:11], s58 offen offset:0 sc1
  s_mov_b32 m0, 15872
  v_smfmac_f32_16x16x64_bf16 v[28:31], v[12:15], v[224:231], v74
  buffer_load_dwordx4 v[48:51], v76, s[8:11], s58 offen offset:1024 sc1
  v_smfmac_f32_16x16x64_bf16 v[32:35], v[12:15], v[232:239], v74
  ds_read_b128 v[4:7], v76 offset:5632
  s_waitcnt lgkmcnt(1)
  v_smfmac_f32_16x16x64_bf16 v[20:23], v[0:3], v[80:87], v74
  ds_read_b128 v[8:11], v76 offset:6656
  v_smfmac_f32_16x16x64_bf16 v[28:31], v[0:3], v[36:43], v74
  ds_read_b128 v[36:39], v76 offset:40960
  v_smfmac_f32_16x16x64_bf16 v[24:27], v[0:3], v[88:95], v74
  buffer_store_dwordx4 v[16:19], v76, s[8:11], s68 offen sc1
  ds_read_b128 v[40:43], v76 offset:41984
  v_smfmac_f32_16x16x64_bf16 v[32:35], v[0:3], v[60:67], v74
  buffer_load_dword v73, s[16:19], s70 offen lds
  ds_read_b128 v[60:63], v76 offset:43008
  s_waitcnt lgkmcnt(4)
  v_smfmac_f32_16x16x64_bf16 v[20:23], v[4:7], v[96:103], v74
  ds_read_b128 v[64:67], v76 offset:44032
  v_smfmac_f32_16x16x64_bf16 v[24:27], v[4:7], v[104:111], v74
  s_waitcnt vmcnt(4)
  s_waitcnt lgkmcnt(4)
  v_smfmac_f32_16x16x64_bf16 v[20:23], v[8:11], v[112:119], v74
  s_barrier
  ds_read_b128 v[12:15], v76 offset:8704
  s_waitcnt lgkmcnt(3)
  v_smfmac_f32_16x16x64_bf16 v[28:31], v[4:7], v[36:43], v74
  ds_read_b128 v[36:39], v76 offset:57344
  v_smfmac_f32_16x16x64_bf16 v[24:27], v[8:11], v[120:127], v74
  ds_read_b128 v[40:43], v76 offset:58368
  s_waitcnt lgkmcnt(3)
  v_smfmac_f32_16x16x64_bf16 v[32:35], v[4:7], v[60:67], v74
  ds_read_b128 v[0:3], v76 offset:9728
  v_smfmac_f32_16x16x64_bf16 v[28:31], v[8:11], v[208:215], v74
  ds_read_b128 v[60:63], v76 offset:59392
  v_smfmac_f32_16x16x64_bf16 v[32:35], v[8:11], v[216:223], v74
  ds_read_b128 v[64:67], v76 offset:60416
  s_waitcnt lgkmcnt(5)
  v_smfmac_f32_16x16x64_bf16 v[20:23], v[12:15], v[144:151], v74
  s_barrier
  ds_read_b128 v[4:7], v76 offset:11776
  s_waitcnt lgkmcnt(4)
  v_smfmac_f32_16x16x64_bf16 v[28:31], v[12:15], v[36:43], v74
  ds_read_b128 v[8:11], v76 offset:12800
  ds_read_b128 v[36:39], v75 offset:8192
  v_smfmac_f32_16x16x64_bf16 v[24:27], v[12:15], v[152:159], v74
  ds_read_b128 v[16:19], v76 offset:10752
  s_waitcnt lgkmcnt(6)
  v_smfmac_f32_16x16x64_bf16 v[20:23], v[0:3], v[160:167], v74
  ds_read_b128 v[40:43], v75 offset:9216
  s_waitcnt lgkmcnt(5)
  v_smfmac_f32_16x16x64_bf16 v[32:35], v[12:15], v[60:67], v74
  ds_read_b128 v[60:63], v75 offset:10240
  v_smfmac_f32_16x16x64_bf16 v[24:27], v[0:3], v[168:175], v74
  ds_read_b128 v[64:67], v75 offset:11264
  s_waitcnt lgkmcnt(6)
  v_smfmac_f32_16x16x64_bf16 v[20:23], v[4:7], v[176:183], v74
  s_waitcnt lgkmcnt(5)
  v_smfmac_f32_16x16x64_bf16 v[20:23], v[8:11], v[192:199], v74
  s_waitcnt lgkmcnt(2)
  v_smfmac_f32_16x16x64_bf16 v[20:23], v[16:19], v[36:43], v74
  ds_read_b128 v[36:39], v75 offset:24576
  v_smfmac_f32_16x16x64_bf16 v[24:27], v[4:7], v[184:191], v74
  ds_read_b128 v[40:43], v75 offset:25600
  s_waitcnt lgkmcnt(2)
  v_smfmac_f32_16x16x64_bf16 v[24:27], v[16:19], v[60:67], v74
  ds_read_b128 v[60:63], v75 offset:26624
  v_add_f32 v20, v20, v22
  v_smfmac_f32_16x16x64_bf16 v[24:27], v[8:11], v[200:207], v74
  ds_read_b128 v[64:67], v75 offset:27648
  v_add_f32 v21, v21, v23
  v_smfmac_f32_16x16x64_bf16 v[28:31], v[16:19], v[240:247], v74
  v_mov_b64 v[70:71], s[78:79]
  v_smfmac_f32_16x16x64_bf16 v[28:31], v[4:7], a[0:7], v74
  s_waitcnt lgkmcnt(2)
  v_add_f32 v24, v24, v26
  v_smfmac_f32_16x16x64_bf16 v[28:31], v[0:3], v[36:43], v74
  ds_read_b128 v[36:39], v68
  v_cvt_pk_bf16_f32 v22, v20, v24
  v_smfmac_f32_16x16x64_bf16 v[28:31], v[8:11], a[16:23], v74
  ds_read_b128 v[40:43], v68
  ds_write_b32 v79, v22 offset:0
  s_waitcnt lgkmcnt(3)
  v_add_f32 v25, v25, v27
  v_cvt_pk_bf16_f32 v23, v21, v25
  v_smfmac_f32_16x16x64_bf16 v[32:35], v[0:3], v[60:67], v74
  ds_write_b32 v79, v23 offset:576
  v_cmp_u_f32 vcc, v20, v21
  v_smfmac_f32_16x16x64_bf16 v[32:35], v[16:19], v[248:255], v74
  v_add_f32 v28, v28, v30
  v_smfmac_f32_16x16x64_bf16 v[32:35], v[4:7], a[8:15], v74
  v_add_f32 v29, v29, v31
  v_smfmac_f32_16x16x64_bf16 v[32:35], v[8:11], a[24:31], v74
  s_cbranch_vccnz Cs2_rec
Cs2_recok:
  s_waitcnt lgkmcnt(3)
  v_smfmac_f32_16x16x64_bf16 v[36:39], v[16:19], a[128:135], v74
  s_waitcnt lgkmcnt(0)
  s_barrier
  ds_read_b128 v[60:63], v77
  v_smfmac_f32_16x16x64_bf16 v[40:43], v[16:19], a[136:143], v74
  ds_read_b128 v[64:67], v77 offset:128
  v_add_f32 v32, v32, v34
  v_cvt_pk_bf16_f32 v30, v28, v32
  v_smfmac_f32_16x16x64_bf16 v[36:39], v[0:3], a[112:119], v74
  ds_write_b32 v79, v30 offset:256
  v_add_f32 v33, v33, v35
  v_cvt_pk_bf16_f32 v31, v29, v33
  v_smfmac_f32_16x16x64_bf16 v[40:43], v[0:3], a[120:127], v74
  ds_write_b32 v79, v31 offset:832
  v_xor_b32 v75, 0x8000, v75
  v_smfmac_f32_16x16x64_bf16 v[36:39], v[4:7], a[144:151], v74
  ds_read_b128 v[0:3], v76 offset:4608
  v_mov_b32 v29, 0
  v_smfmac_f32_16x16x64_bf16 v[40:43], v[4:7], a[152:159], v74
  s_waitcnt vmcnt(2) lgkmcnt(3)
  v_mov_b32 v30, 0
  v_mfma_f32_16x16x32_bf16 v[44:47], v[44:47], v[60:63], 0
  ds_read_b128 v[4:7], v76 offset:5632
  s_waitcnt lgkmcnt(2)
  v_mfma_f32_16x16x32_bf16 v[44:47], v[48:51], v[64:67], v[44:47]
  s_barrier
  v_smfmac_f32_16x16x64_bf16 v[36:39], v[8:11], a[160:167], v74
  ds_read_b128 v[20:23], v77 offset:256
  ds_read_b128 v[24:27], v77 offset:384
  v_smfmac_f32_16x16x64_bf16 v[40:43], v[8:11], a[168:175], v74
  ds_read_b128 v[8:11], v76 offset:6656
  v_add_f32_dpp v72, v46, v44 quad_perm:[2,3,0,1] row_mask:0xf bank_mask:0xf
  v_add_f32_dpp v73, v47, v45 quad_perm:[2,3,0,1] row_mask:0xf bank_mask:0xf
  v_smfmac_f32_16x16x64_bf16 v[36:39], v[12:15], a[96:103], v74
  s_waitcnt lgkmcnt(4)
  v_exp_f32_dpp v72, v72 quad_perm:[0,1,0,1] row_mask:0xf bank_mask:0xf
  v_smfmac_f32_16x16x64_bf16 v[40:43], v[12:15], a[104:111], v74
  ds_read_b128 v[12:15], v76 offset:7680
  v_exp_f32_dpp v73, v73 quad_perm:[0,1,0,1] row_mask:0xf bank_mask:0xf
  v_smfmac_f32_16x16x64_bf16 v[36:39], v[0:3], a[32:39], v74
  s_waitcnt lgkmcnt(2)
  v_cvt_pk_bf16_f32 v72, v72, v73
  v_mfma_f32_16x16x32_bf16 v[20:23], v[20:23], v[60:63], 0
  ds_write_b32 v78, v72 offset:520
  v_mov_b64 v[16:17], 0
  v_mfma_f32_16x16x32_bf16 v[20:23], v[24:27], v[64:67], v[20:23]
  ds_read_b128 v[44:47], v75 offset:24576
  v_mov_b64 v[18:19], 0
  v_smfmac_f32_16x16x64_bf16 v[40:43], v[0:3], a[40:47], v74
  ds_read_b128 v[48:51], v75 offset:25600
  v_mov_b64 v[68:69], s[78:79]
  v_smfmac_f32_16x16x64_bf16 v[36:39], v[4:7], a[48:55], v74
  s_waitcnt lgkmcnt(4)
  v_add_f32_dpp v24, v22, v20 quad_perm:[2,3,0,1] row_mask:0xf bank_mask:0xf
  v_add_f32_dpp v25, v23, v21 quad_perm:[2,3,0,1] row_mask:0xf bank_mask:0xf
  v_smfmac_f32_16x16x64_bf16 v[36:39], v[8:11], a[64:71], v74
  s_waitcnt lgkmcnt(2)
  s_barrier
  ds_read_b128 v[32:35], v78 offset:512
  v_smfmac_f32_16x16x64_bf16 v[36:39], v[12:15], a[80:87], v74
  ds_read_b128 v[60:63], v75 offset:26624
  v_mul_f32 v24, s69, v24
  v_smfmac_f32_16x16x64_bf16 v[40:43], v[4:7], a[56:63], v74
  ds_read_b128 v[64:67], v75 offset:27648
  v_mul_f32 v25, s69, v25
  v_smfmac_f32_16x16x64_bf16 v[40:43], v[8:11], a[72:79], v74
  v_exp_f32_dpp v24, v24 quad_perm:[0,1,0,1] row_mask:0xf bank_mask:0xf
  v_smfmac_f32_16x16x64_bf16 v[40:43], v[12:15], a[88:95], v74
  s_waitcnt lgkmcnt(2)
  v_exp_f32_dpp v25, v25 quad_perm:[0,1,0,1] row_mask:0xf bank_mask:0xf
  v_mfma_f32_16x16x32_bf16 v[8:11], v[32:35], v[68:71], 0
  v_add_f32 v36, v36, v38
  v_add_f32 v37, v37, v39
  v_mfma_f32_16x16x32_bf16 v[0:3], v[32:35], v[52:55], 0
  v_add_f32 v40, v40, v42
  v_add_f32 v41, v41, v43
  v_mfma_f32_16x16x32_bf16 v[4:7], v[32:35], v[56:59], 0
  v_cvt_pk_bf16_f32 v28, v24, v25
  v_cvt_pk_bf16_f32 v72, v36, v37
  v_cvt_pk_bf16_f32 v73, v40, v41
  v_mfma_f32_16x16x16_bf16 v[8:11], v[28:29], v[68:69], v[8:11]
  v_cvt_pk_bf16_f32 v31, v24, v25
  v_mov_b64 v[20:21], 0
  v_mfma_f32_16x16x16_bf16 v[0:3], v[28:29], v[72:73], v[0:3]
  ds_read_b128 v[68:71], v76 offset:13824
  v_mov_b64 v[22:23], 0
  v_mfma_f32_16x16x16_bf16 v[4:7], v[30:31], v[72:73], v[4:7]
  v_rcp_f32 v10, v8
  v_rcp_f32 v11, v9
  v_mul_f32 v0, v10, v0
  v_mul_f32 v1, v11, v1
  s_nop 0
  v_mul_f32 v4, v10, v4
  v_mul_f32 v5, v11, v5
  v_cvt_pk_bf16_f32 v2, v0, v4
  ds_write_b32 v79, v2 offset:8704
  v_cvt_pk_bf16_f32 v3, v1, v5
  ds_write_b32 v79, v3 offset:9280
  v_max3_f32 v8, v8, v9, v10
  v_max_f32 v8, v8, v11
  v_cmp_le_f32 vcc, 1317011456, v8
  v_mov_b64 v[24:25], 0
  v_mov_b64 v[26:27], 0
  s_cbranch_vccnz Cs2_mx
Cs2_mxok:
  s_waitcnt lgkmcnt(0)
  s_barrier
  ds_read_b128 v[0:3], v78 offset:8704
  ds_read_b128 v[4:7], v78 offset:8768
  ds_read_b128 v[8:11], v78 offset:8832
  ds_read_b128 v[12:15], v78 offset:8896
  s_waitcnt lgkmcnt(3)
  v_smfmac_f32_16x16x64_bf16 v[16:19], v[0:3], v[44:51], v74
  ds_read_b128 v[52:55], v75 offset:40960
  s_waitcnt lgkmcnt(3)
  v_smfmac_f32_16x16x64_bf16 v[16:19], v[4:7], v[60:67], v74
  ds_read_b128 v[56:59], v75 offset:41984
  s_waitcnt lgkmcnt(3)
  v_smfmac_f32_16x16x64_bf16 v[16:19], v[8:11], a[176:183], v74
  ds_read_b128 v[36:39], v75 offset:43008
  s_waitcnt lgkmcnt(3)
  v_smfmac_f32_16x16x64_bf16 v[16:19], v[12:15], a[184:191], v74
  ds_read_b128 v[40:43], v75 offset:44032
  ds_read_b128 v[44:47], v75 offset:57344
  v_smfmac_f32_16x16x64_bf16 v[20:23], v[0:3], a[192:199], v74
  ds_read_b128 v[48:51], v75 offset:58368
  ds_read_b128 v[60:63], v75 offset:59392
  v_smfmac_f32_16x16x64_bf16 v[20:23], v[4:7], a[200:207], v74
  ds_read_b128 v[64:67], v75 offset:60416
  s_waitcnt lgkmcnt(6)
  v_cvt_pk_bf16_f32 v16, v16, v17
  v_cvt_pk_bf16_f32 v17, v18, v19
  v_bfi_b32 v16, 1, s72, v16
  v_smfmac_f32_16x16x64_bf16 v[20:23], v[8:11], v[52:59], v74
  buffer_store_dwordx2 v[16:17], v68, s[8:11], s73 offen sc1
  s_waitcnt lgkmcnt(4)
  v_smfmac_f32_16x16x64_bf16 v[20:23], v[12:15], v[36:43], v74
  ds_read_b128 v[52:55], v75 offset:0
  v_mov_b64 v[32:33], 0
  v_smfmac_f32_16x16x64_bf16 v[24:27], v[0:3], a[208:215], v74
  ds_read_b128 v[56:59], v75 offset:1024
  v_mov_b64 v[34:35], 0
  v_smfmac_f32_16x16x64_bf16 v[24:27], v[4:7], a[216:223], v74
  ds_read_b128 v[36:39], v75 offset:2048
  s_waitcnt lgkmcnt(5)
  v_cvt_pk_bf16_f32 v20, v20, v21
  v_cvt_pk_bf16_f32 v21, v22, v23
  v_bfi_b32 v20, 1, s72, v20
  v_smfmac_f32_16x16x64_bf16 v[24:27], v[8:11], v[44:51], v74
  buffer_store_dwordx2 v[20:21], v68, s[8:11], s74 offen sc1
  s_waitcnt lgkmcnt(3)
  v_smfmac_f32_16x16x64_bf16 v[24:27], v[12:15], v[60:67], v74
  ds_read_b128 v[40:43], v75 offset:3072
  v_mov_b64 v[28:29], 0
  v_smfmac_f32_16x16x64_bf16 v[32:35], v[0:3], a[224:231], v74
  ds_read_b128 v[44:47], v75 offset:4096
  ds_read_b128 v[48:51], v75 offset:5120
  v_smfmac_f32_16x16x64_bf16 v[32:35], v[4:7], a[232:239], v74
  ds_read_b128 v[60:63], v75 offset:6144
  v_cvt_pk_bf16_f32 v24, v24, v25
  v_cvt_pk_bf16_f32 v25, v26, v27
  v_bfi_b32 v24, 1, s72, v24
  v_smfmac_f32_16x16x64_bf16 v[32:35], v[8:11], a[240:247], v74
  buffer_store_dwordx2 v[24:25], v68, s[8:11], s75 offen sc1
  v_mov_b64 v[30:31], 0
  v_smfmac_f32_16x16x64_bf16 v[32:35], v[12:15], a[248:255], v74
  ds_read_b128 v[64:67], v75 offset:7168
  s_waitcnt lgkmcnt(6)
  v_smfmac_f32_16x16x64_bf16 v[28:31], v[0:3], v[52:59], v74
  s_waitcnt lgkmcnt(4)
  v_smfmac_f32_16x16x64_bf16 v[28:31], v[4:7], v[36:43], v74
  s_waitcnt lgkmcnt(2)
  v_cvt_pk_bf16_f32 v32, v32, v33
  v_cvt_pk_bf16_f32 v33, v34, v35
  v_bfi_b32 v32, 1, s72, v32
  v_smfmac_f32_16x16x64_bf16 v[28:31], v[8:11], v[44:51], v74
  buffer_store_dwordx2 v[32:33], v68, s[8:11], s76 offen sc1
  s_waitcnt lgkmcnt(0)
  v_smfmac_f32_16x16x64_bf16 v[28:31], v[12:15], v[60:67], v74
  v_mov_b64 v[18:19], v[72:73]
  s_nop 4
  v_cvt_pk_bf16_f32 v28, v28, v29
  v_cvt_pk_bf16_f32 v29, v30, v31
  v_bfi_b32 v28, 1, s72, v28
  buffer_store_dwordx2 v[28:29], v68, s[8:11], s77 offen sc1
  ds_read_b128 v[0:3], v76 offset:14848
  s_waitcnt lgkmcnt(0)
  ds_read_b64 v[16:17], v77 offset:384
  s_waitcnt lgkmcnt(0)
  ds_read_b128 v[64:67], v76 offset:27648
  s_waitcnt lgkmcnt(0)
  ds_read_b128 v[60:63], v76 offset:26624
  s_waitcnt lgkmcnt(0)
  s_waitcnt vmcnt(0)
  buffer_load_dwordx4 v[52:55], v76, s[8:11], s60 offen offset:0 sc1
  buffer_load_dwordx4 v[56:59], v76, s[8:11], s60 offen offset:1024 sc1
  s_add_u32 s66, s66, 1
  s_xor_b32 s64, s64, 16384
  s_xor_b32 s65, s65, 16384
  s_add_u32 s58, s58, 655360
  s_add_u32 s59, s59, 655360
  s_add_u32 s70, s70, 655360
  s_add_u32 s68, s68, 655360
  s_mov_b32 m0, 12800
  s_add_u32 s85, s65, 8192
  v_xor_b32 v75, 0x8000, v75
  s_waitcnt lgkmcnt(0)
  s_waitcnt vmcnt(1)
  v_mfma_f32_16x16x32_bf16 v[4:7], v[0:3], v[52:55], 0
  v_bitop3_b32 v72, v52, v54, s72 bitop3:0x7e
  s_waitcnt vmcnt(0)
  v_mfma_f32_16x16x32_bf16 v[4:7], v[0:3], v[56:59], v[4:7]
  v_bitop3_b32 v73, v56, v58, s72 bitop3:0x7e
  v_bitop3_b32 v72, v72, v73, 1 bitop3:0xa8
  v_cmp_ne_u32 vcc, 0, v72
  s_cbranch_vccnz Cs2_h1r
  s_nop 2
  v_add_f32_dpp v4, v4, v4 row_ror:4 row_mask:0xf bank_mask:0xf
  v_add_f32_dpp v5, v5, v5 row_ror:4 row_mask:0xf bank_mask:0xf
  s_nop 0
  v_add_f32_dpp v4, v4, v4 row_ror:8 row_mask:0xf bank_mask:0xf
  v_add_f32_dpp v5, v5, v5 row_ror:8 row_mask:0xf bank_mask:0xf
  v_cvt_pk_bf16_f32 v4, v4, v5
  buffer_store_dword v4, v69, s[8:11], s62 offen sc1
  s_xor_b32 s62, s62, 16384
  buffer_store_dword v71, v69, s[8:11], s62 offen sc1
  s_xor_b32 s72, s72, 1
  s_branch Cs2_h2
Cs2_h1r:
  s_mov_b64 exec, vcc
  buffer_load_dwordx4 v[52:55], v76, s[8:11], s60 offen offset:0 sc1
  buffer_load_dwordx4 v[56:59], v76, s[8:11], s60 offen offset:1024 sc1
  s_mov_b64 exec, -1
  s_add_u32 s67, s67, 1
  s_waitcnt vmcnt(1)
  v_mfma_f32_16x16x32_bf16 v[4:7], v[0:3], v[52:55], 0
  v_bitop3_b32 v72, v52, v54, s72 bitop3:0x7e
  s_waitcnt vmcnt(0)
  v_mfma_f32_16x16x32_bf16 v[4:7], v[0:3], v[56:59], v[4:7]
  v_bitop3_b32 v73, v56, v58, s72 bitop3:0x7e
  v_bitop3_b32 v72, v72, v73, 1 bitop3:0xa8
  v_cmp_ne_u32 vcc, 0, v72
  s_cbranch_vccz Cs2_h1p
Cs2_h1s:
  s_mov_b64 exec, vcc
  buffer_load_dwordx4 v[52:55], v76, s[8:11], s60 offen offset:0 sc1
  buffer_load_dwordx4 v[56:59], v76, s[8:11], s60 offen offset:1024 sc1
  s_mov_b64 exec, -1
  s_add_u32 s67, s67, 1
  s_waitcnt vmcnt(1)
  v_mfma_f32_16x16x32_bf16 v[4:7], v[0:3], v[52:55], 0
  v_bitop3_b32 v72, v52, v54, s72 bitop3:0x7e
  s_waitcnt vmcnt(0)
  v_mfma_f32_16x16x32_bf16 v[4:7], v[0:3], v[56:59], v[4:7]
  v_bitop3_b32 v73, v56, v58, s72 bitop3:0x7e
  v_bitop3_b32 v72, v72, v73, 1 bitop3:0xa8
  v_cmp_ne_u32 vcc, 0, v72
  s_cbranch_vccz Cs2_h1p
  s_cmp_lt_u32 s67, 131072
  s_cbranch_scc1 Cs2_h1s
Cs2_h1p:
  s_nop 2
  v_add_f32_dpp v4, v4, v4 row_ror:4 row_mask:0xf bank_mask:0xf
  v_add_f32_dpp v5, v5, v5 row_ror:4 row_mask:0xf bank_mask:0xf
  s_nop 0
  v_add_f32_dpp v4, v4, v4 row_ror:8 row_mask:0xf bank_mask:0xf
  v_add_f32_dpp v5, v5, v5 row_ror:8 row_mask:0xf bank_mask:0xf
  v_cvt_pk_bf16_f32 v4, v4, v5
  buffer_store_dword v4, v69, s[8:11], s62 offen sc1
  s_xor_b32 s62, s62, 16384
  buffer_store_dword v71, v69, s[8:11], s62 offen sc1
  s_xor_b32 s72, s72, 1
  s_branch Cs2_h2
Cs2_rec:
  s_nop 7
  s_waitcnt vmcnt(0) lgkmcnt(0)
  v_max3_u32 v72, v0, v1, v2
  v_max3_u32 v72, v72, v3, v4
  v_max3_u32 v72, v72, v5, v6
  v_max3_u32 v72, v72, v7, v8
  v_max3_u32 v72, v72, v9, v10
  v_max3_u32 v72, v72, v11, v12
  v_max3_u32 v72, v72, v13, v14
  v_max3_u32 v72, v72, v15, v16
  v_max3_u32 v72, v72, v17, v18
  v_max_u32 v72, v72, v19
  v_cmp_eq_u32 vcc, -1, v72
  s_cbranch_vccz Cs2_recok
  s_barrier
Cs2_recp:
  buffer_load_dwordx4 v[0:3], v76, s[8:11], s64 offen offset:0 sc1
  buffer_load_dwordx4 v[4:7], v76, s[8:11], s64 offen offset:1024 sc1
  s_add_u32 s67, s67, 1
  s_cmp_lt_u32 s67, 131072
  s_cselect_b32 s54, -2, -1
  s_waitcnt vmcnt(1)
  v_max3_u32 v72, v0, v1, v2
  s_waitcnt vmcnt(0)
  v_max3_u32 v72, v72, v3, v4
  v_max3_u32 v72, v72, v5, v6
  v_max_u32 v72, v72, v7
  v_cmp_lt_u32 vcc, s54, v72
  s_cbranch_vccnz Cs2_recp
  ds_write_b128 v76, v[0:3] offset:8704
  ds_write_b128 v76, v[4:7] offset:9728
  v_mov_b64 v[20:21], 0
  v_mov_b64 v[22:23], 0
  v_mov_b64 v[24:25], 0
  v_mov_b64 v[26:27], 0
  v_mov_b64 v[28:29], 0
  v_mov_b64 v[30:31], 0
  v_mov_b64 v[32:33], 0
  v_mov_b64 v[34:35], 0
  s_waitcnt lgkmcnt(0)
  s_barrier
  ds_read_b128 v[0:3], v76 offset:4608
  s_waitcnt lgkmcnt(0)
  v_smfmac_f32_16x16x64_bf16 v[20:23], v[0:3], v[80:87], v74
  v_smfmac_f32_16x16x64_bf16 v[24:27], v[0:3], v[88:95], v74
  ds_read_b128 v[60:63], v76 offset:24576
  ds_read_b128 v[64:67], v76 offset:25600
  s_waitcnt lgkmcnt(0)
  v_smfmac_f32_16x16x64_bf16 v[28:31], v[0:3], v[60:67], v74
  ds_read_b128 v[60:63], v76 offset:26624
  ds_read_b128 v[64:67], v76 offset:27648
  s_waitcnt lgkmcnt(0)
  v_smfmac_f32_16x16x64_bf16 v[32:35], v[0:3], v[60:67], v74
  ds_read_b128 v[4:7], v76 offset:5632
  s_waitcnt lgkmcnt(0)
  v_smfmac_f32_16x16x64_bf16 v[20:23], v[4:7], v[96:103], v74
  v_smfmac_f32_16x16x64_bf16 v[24:27], v[4:7], v[104:111], v74
  ds_read_b128 v[60:63], v76 offset:40960
  ds_read_b128 v[64:67], v76 offset:41984
  s_waitcnt lgkmcnt(0)
  v_smfmac_f32_16x16x64_bf16 v[28:31], v[4:7], v[60:67], v74
  ds_read_b128 v[60:63], v76 offset:43008
  ds_read_b128 v[64:67], v76 offset:44032
  s_waitcnt lgkmcnt(0)
  v_smfmac_f32_16x16x64_bf16 v[32:35], v[4:7], v[60:67], v74
  ds_read_b128 v[8:11], v76 offset:6656
  s_waitcnt lgkmcnt(0)
  v_smfmac_f32_16x16x64_bf16 v[20:23], v[8:11], v[112:119], v74
  v_smfmac_f32_16x16x64_bf16 v[24:27], v[8:11], v[120:127], v74
  v_smfmac_f32_16x16x64_bf16 v[28:31], v[8:11], v[208:215], v74
  v_smfmac_f32_16x16x64_bf16 v[32:35], v[8:11], v[216:223], v74
  ds_read_b128 v[12:15], v76 offset:7680
  s_waitcnt lgkmcnt(0)
  v_smfmac_f32_16x16x64_bf16 v[20:23], v[12:15], v[128:135], v74
  v_smfmac_f32_16x16x64_bf16 v[24:27], v[12:15], v[136:143], v74
  v_smfmac_f32_16x16x64_bf16 v[28:31], v[12:15], v[224:231], v74
  v_smfmac_f32_16x16x64_bf16 v[32:35], v[12:15], v[232:239], v74
  ds_read_b128 v[12:15], v76 offset:8704
  s_waitcnt lgkmcnt(0)
  v_smfmac_f32_16x16x64_bf16 v[20:23], v[12:15], v[144:151], v74
  v_smfmac_f32_16x16x64_bf16 v[24:27], v[12:15], v[152:159], v74
  ds_read_b128 v[60:63], v76 offset:57344
  ds_read_b128 v[64:67], v76 offset:58368
  s_waitcnt lgkmcnt(0)
  v_smfmac_f32_16x16x64_bf16 v[28:31], v[12:15], v[60:67], v74
  ds_read_b128 v[60:63], v76 offset:59392
  ds_read_b128 v[64:67], v76 offset:60416
  s_waitcnt lgkmcnt(0)
  v_smfmac_f32_16x16x64_bf16 v[32:35], v[12:15], v[60:67], v74
  ds_read_b128 v[0:3], v76 offset:9728
  s_waitcnt lgkmcnt(0)
  v_smfmac_f32_16x16x64_bf16 v[20:23], v[0:3], v[160:167], v74
  v_smfmac_f32_16x16x64_bf16 v[24:27], v[0:3], v[168:175], v74
  ds_read_b128 v[60:63], v75 offset:24576
  ds_read_b128 v[64:67], v75 offset:25600
  s_waitcnt lgkmcnt(0)
  v_smfmac_f32_16x16x64_bf16 v[28:31], v[0:3], v[60:67], v74
  ds_read_b128 v[60:63], v75 offset:26624
  ds_read_b128 v[64:67], v75 offset:27648
  s_waitcnt lgkmcnt(0)
  v_smfmac_f32_16x16x64_bf16 v[32:35], v[0:3], v[60:67], v74
  ds_read_b128 v[16:19], v76 offset:10752
  ds_read_b128 v[60:63], v75 offset:8192
  ds_read_b128 v[64:67], v75 offset:9216
  s_waitcnt lgkmcnt(0)
  v_smfmac_f32_16x16x64_bf16 v[20:23], v[16:19], v[60:67], v74
  ds_read_b128 v[60:63], v75 offset:10240
  ds_read_b128 v[64:67], v75 offset:11264
  s_waitcnt lgkmcnt(0)
  v_smfmac_f32_16x16x64_bf16 v[24:27], v[16:19], v[60:67], v74
  v_smfmac_f32_16x16x64_bf16 v[28:31], v[16:19], v[240:247], v74
  v_smfmac_f32_16x16x64_bf16 v[32:35], v[16:19], v[248:255], v74
  ds_read_b128 v[4:7], v76 offset:11776
  s_waitcnt lgkmcnt(0)
  v_smfmac_f32_16x16x64_bf16 v[20:23], v[4:7], v[176:183], v74
  v_smfmac_f32_16x16x64_bf16 v[24:27], v[4:7], v[184:191], v74
  v_smfmac_f32_16x16x64_bf16 v[28:31], v[4:7], a[0:7], v74
  v_smfmac_f32_16x16x64_bf16 v[32:35], v[4:7], a[8:15], v74
  ds_read_b128 v[8:11], v76 offset:12800
  s_waitcnt lgkmcnt(0)
  v_smfmac_f32_16x16x64_bf16 v[20:23], v[8:11], v[192:199], v74
  v_smfmac_f32_16x16x64_bf16 v[24:27], v[8:11], v[200:207], v74
  v_smfmac_f32_16x16x64_bf16 v[28:31], v[8:11], a[16:23], v74
  v_smfmac_f32_16x16x64_bf16 v[32:35], v[8:11], a[24:31], v74
  v_add_f32 v20, v20, v22
  v_add_f32 v21, v21, v23
  v_add_f32 v24, v24, v26
  v_cvt_pk_bf16_f32 v22, v20, v24
  ds_write_b32 v79, v22 offset:0
  v_add_f32 v25, v25, v27
  v_cvt_pk_bf16_f32 v23, v21, v25
  ds_write_b32 v79, v23 offset:576
  v_add_f32 v28, v28, v30
  v_add_f32 v29, v29, v31
  s_waitcnt lgkmcnt(0)
  s_nop 1
  s_branch Cs2_recok
Cs2_mx:
  s_waitcnt lgkmcnt(0)
  s_barrier
  buffer_load_dwordx4 v[0:3], v76, s[8:11], s58 offen offset:0 sc1
  ds_read_b128 v[20:23], v77 offset:0
  ds_read_b128 v[28:31], v77 offset:256
  buffer_load_dwordx4 v[4:7], v76, s[8:11], s58 offen offset:1024 sc1
  ds_read_b128 v[24:27], v77 offset:128
  ds_read_b128 v[32:35], v77 offset:384
  s_waitcnt vmcnt(1) lgkmcnt(3)
  v_mfma_f32_16x16x32_bf16 v[8:11], v[0:3], v[20:23], 0
  s_waitcnt vmcnt(0) lgkmcnt(1)
  v_mfma_f32_16x16x32_bf16 v[8:11], v[4:7], v[24:27], v[8:11]
  v_mfma_f32_16x16x32_bf16 v[12:15], v[28:31], v[20:23], 0
  s_waitcnt lgkmcnt(0)
  v_mfma_f32_16x16x32_bf16 v[12:15], v[32:35], v[24:27], v[12:15]
  v_add_f32_dpp v8, v10, v8 quad_perm:[2,3,0,1] row_mask:0xf bank_mask:0xf
  v_add_f32_dpp v9, v11, v9 quad_perm:[2,3,0,1] row_mask:0xf bank_mask:0xf
  s_nop 0
  v_mov_b32_dpp v8, v8 quad_perm:[0,1,0,1] row_mask:0xf bank_mask:0xf
  v_mov_b32_dpp v9, v9 quad_perm:[0,1,0,1] row_mask:0xf bank_mask:0xf
  s_nop 1
  v_add_f32_dpp v12, v14, v12 quad_perm:[2,3,0,1] row_mask:0xf bank_mask:0xf
  v_add_f32_dpp v13, v15, v13 quad_perm:[2,3,0,1] row_mask:0xf bank_mask:0xf
  s_nop 0
  v_mov_b32_dpp v12, v12 quad_perm:[0,1,0,1] row_mask:0xf bank_mask:0xf
  v_mov_b32_dpp v13, v13 quad_perm:[0,1,0,1] row_mask:0xf bank_mask:0xf
  v_mul_f32 v12, s69, v12
  ds_write_b32 v78, v8 offset:8712
  v_mul_f32 v13, s69, v13
  ds_write_b32 v78, v9 offset:8776
  s_waitcnt lgkmcnt(0)
  s_barrier
  ds_read_b128 v[36:39], v78 offset:8704
  ds_read_b128 v[40:43], v78 offset:8768
  s_waitcnt lgkmcnt(0)
  s_barrier
  v_max_f32 v16, v36, v37
  v_max3_f32 v16, v16, v38, v39
  v_max3_f32 v16, v16, v40, v41
  v_max3_f32 v16, v16, v42, v43
  v_max3_f32 v16, v16, v12, v13
  v_mov_b32 v17, v16
  s_nop 1
  v_permlane16_swap_b32 v16, v17
  v_max_f32 v16, v16, v17
  v_mov_b32 v17, v16
  s_nop 1
  v_permlane32_swap_b32 v16, v17
  v_max_f32 v16, v16, v17
  v_sub_f32 v36, v36, v16
  v_sub_f32 v37, v37, v16
  v_sub_f32 v38, v38, v16
  v_sub_f32 v39, v39, v16
  v_sub_f32 v40, v40, v16
  v_sub_f32 v41, v41, v16
  v_sub_f32 v42, v42, v16
  v_sub_f32 v43, v43, v16
  v_sub_f32 v12, v12, v16
  v_sub_f32 v13, v13, v16
  v_exp_f32 v36, v36
  v_exp_f32 v37, v37
  v_exp_f32 v38, v38
  v_exp_f32 v39, v39
  v_exp_f32 v40, v40
  v_exp_f32 v41, v41
  v_exp_f32 v42, v42
  v_exp_f32 v43, v43
  v_exp_f32 v12, v12
  v_exp_f32 v13, v13
  v_cvt_pk_bf16_f32 v32, v36, v40
  v_cvt_pk_bf16_f32 v33, v37, v41
  v_cvt_pk_bf16_f32 v34, v38, v42
  v_cvt_pk_bf16_f32 v35, v39, v43
  v_cvt_pk_bf16_f32 v28, v12, v13
  v_cvt_pk_bf16_f32 v31, v12, v13
  v_mov_b32 v29, 0
  v_mov_b32 v30, 0
  v_mov_b32 v68, 0x3f803f80
  v_mov_b32 v69, 0x3f803f80
  v_mov_b32 v70, 0x3f803f80
  v_mov_b32 v71, 0x3f803f80
  s_nop 1
  v_mfma_f32_16x16x32_bf16 v[8:11], v[32:35], v[68:71], 0
  v_mfma_f32_16x16x32_bf16 v[0:3], v[32:35], v[52:55], 0
  v_mfma_f32_16x16x32_bf16 v[4:7], v[32:35], v[56:59], 0
  v_mfma_f32_16x16x16_bf16 v[8:11], v[28:29], v[68:69], v[8:11]
  v_mfma_f32_16x16x16_bf16 v[0:3], v[28:29], v[72:73], v[0:3]
  v_mfma_f32_16x16x16_bf16 v[4:7], v[30:31], v[72:73], v[4:7]
  ds_read_b128 v[68:71], v76 offset:13824
  v_rcp_f32 v10, v8
  v_rcp_f32 v11, v9
  v_mul_f32 v0, v10, v0
  v_mul_f32 v1, v11, v1
  s_nop 0
  v_mul_f32 v4, v10, v4
  v_mul_f32 v5, v11, v5
  v_cvt_pk_bf16_f32 v2, v0, v4
  ds_write_b32 v79, v2 offset:8704
  v_cvt_pk_bf16_f32 v3, v1, v5
  ds_write_b32 v79, v3 offset:9280
  v_mov_b64 v[16:17], 0
  v_mov_b64 v[18:19], 0
  v_mov_b64 v[20:21], 0
  v_mov_b64 v[22:23], 0
  v_mov_b64 v[24:25], 0
  v_mov_b64 v[26:27], 0
  s_branch Cs2_mxok
Cs2_last:
  ds_read_b128 v[4:7], v76 offset:5632
  ds_read_b128 v[8:11], v76 offset:6656
  ds_read_b128 v[44:47], v76 offset:40960
  ds_read_b128 v[48:51], v76 offset:41984
  s_nop 5
  v_mov_b64 v[20:21], 0
  v_mov_b64 v[22:23], 0
  v_mov_b64 v[24:25], 0
  v_mov_b64 v[26:27], 0
  s_waitcnt lgkmcnt(4)
  v_smfmac_f32_16x16x64_bf16 v[28:31], v[0:3], v[36:43], v74
  ds_read_b128 v[36:39], v76 offset:43008
  ds_read_b128 v[40:43], v76 offset:44032
  v_smfmac_f32_16x16x64_bf16 v[32:35], v[0:3], v[60:67], v74
  s_waitcnt lgkmcnt(5)
  v_smfmac_f32_16x16x64_bf16 v[20:23], v[0:3], a[32:39], v74
  ds_read_b128 v[60:63], v76 offset:57344
  ds_read_b128 v[64:67], v76 offset:58368
  v_smfmac_f32_16x16x64_bf16 v[24:27], v[0:3], a[40:47], v74
  s_waitcnt lgkmcnt(4)
  v_smfmac_f32_16x16x64_bf16 v[20:23], v[4:7], a[48:55], v74
  buffer_store_dwordx4 v[16:19], v76, s[8:11], s68 offen sc1
  v_smfmac_f32_16x16x64_bf16 v[24:27], v[4:7], a[56:63], v74
  v_smfmac_f32_16x16x64_bf16 v[28:31], v[4:7], v[44:51], v74
  s_waitcnt lgkmcnt(2)
  v_smfmac_f32_16x16x64_bf16 v[20:23], v[8:11], a[64:71], v74
  ds_read_b128 v[44:47], v76 offset:59392
  ds_read_b128 v[48:51], v76 offset:60416
  v_smfmac_f32_16x16x64_bf16 v[24:27], v[8:11], a[72:79], v74
  v_smfmac_f32_16x16x64_bf16 v[32:35], v[4:7], v[36:43], v74
  v_smfmac_f32_16x16x64_bf16 v[28:31], v[8:11], v[208:215], v74
  ds_read_b128 v[36:39], v75 offset:24576
  ds_read_b128 v[40:43], v75 offset:25600
  v_smfmac_f32_16x16x64_bf16 v[32:35], v[8:11], v[216:223], v74
  v_smfmac_f32_16x16x64_bf16 v[20:23], v[12:15], a[80:87], v74
  v_smfmac_f32_16x16x64_bf16 v[24:27], v[12:15], a[88:95], v74
  v_smfmac_f32_16x16x64_bf16 v[28:31], v[12:15], v[224:231], v74
  v_smfmac_f32_16x16x64_bf16 v[32:35], v[12:15], v[232:239], v74
  s_waitcnt vmcnt(1)
  s_barrier
Cs2_lastr:
  ds_read_b128 v[12:15], v76 offset:8704
  ds_read_b128 v[0:3], v76 offset:9728
  ds_read_b128 v[16:19], v76 offset:10752
  ds_read_b128 v[4:7], v76 offset:11776
  ds_read_b128 v[8:11], v76 offset:12800
  s_waitcnt lgkmcnt(3)
  v_max3_u32 v72, v0, v1, v2
  s_waitcnt lgkmcnt(1)
  v_max3_u32 v72, v72, v3, v4
  v_max3_u32 v72, v72, v5, v6
  s_waitcnt lgkmcnt(0)
  v_max3_u32 v72, v72, v7, v8
  v_max3_u32 v72, v72, v9, v10
  v_max3_u32 v72, v72, v11, v12
  v_max3_u32 v72, v72, v13, v14
  v_max3_u32 v72, v72, v15, v16
  v_max3_u32 v72, v72, v17, v18
  v_max_u32 v72, v72, v19
  v_cmp_eq_u32 vcc, -1, v72
  s_cbranch_vccnz Cs2_lastp
Cs2_lastg:
  v_smfmac_f32_16x16x64_bf16 v[28:31], v[12:15], v[60:67], v74
  ds_read_b128 v[60:63], v75 offset:26624
  ds_read_b128 v[64:67], v75 offset:27648
  v_smfmac_f32_16x16x64_bf16 v[32:35], v[12:15], v[44:51], v74
  v_smfmac_f32_16x16x64_bf16 v[28:31], v[0:3], v[36:43], v74
  v_smfmac_f32_16x16x64_bf16 v[28:31], v[16:19], v[240:247], v74
  v_smfmac_f32_16x16x64_bf16 v[28:31], v[4:7], a[0:7], v74
  v_smfmac_f32_16x16x64_bf16 v[28:31], v[8:11], a[16:23], v74
  v_smfmac_f32_16x16x64_bf16 v[32:35], v[16:19], v[248:255], v74
  v_smfmac_f32_16x16x64_bf16 v[32:35], v[4:7], a[8:15], v74
  s_waitcnt lgkmcnt(0)
  v_smfmac_f32_16x16x64_bf16 v[32:35], v[8:11], a[24:31], v74
  v_smfmac_f32_16x16x64_bf16 v[32:35], v[0:3], v[60:67], v74
  v_smfmac_f32_16x16x64_bf16 v[20:23], v[12:15], a[96:103], v74
  v_smfmac_f32_16x16x64_bf16 v[20:23], v[0:3], a[112:119], v74
  v_add_f32 v28, v28, v30
  v_add_f32 v32, v32, v34
  v_cvt_pk_bf16_f32 v30, v28, v32
  v_smfmac_f32_16x16x64_bf16 v[20:23], v[16:19], a[128:135], v74
  ds_write_b32 v79, v30 offset:256
  v_add_f32 v29, v29, v31
  v_add_f32 v33, v33, v35
  v_cvt_pk_bf16_f32 v31, v29, v33
  v_smfmac_f32_16x16x64_bf16 v[20:23], v[4:7], a[144:151], v74
  ds_write_b32 v79, v31 offset:832
  v_smfmac_f32_16x16x64_bf16 v[20:23], v[8:11], a[160:167], v74
  v_smfmac_f32_16x16x64_bf16 v[24:27], v[12:15], a[104:111], v74
  v_smfmac_f32_16x16x64_bf16 v[24:27], v[0:3], a[120:127], v74
  v_smfmac_f32_16x16x64_bf16 v[24:27], v[16:19], a[136:143], v74
  s_waitcnt lgkmcnt(0)
  s_barrier
  ds_read_b64 v[52:53], v77 offset:384
  v_add_f32 v20, v20, v22
  v_smfmac_f32_16x16x64_bf16 v[24:27], v[4:7], a[152:159], v74
  v_add_f32 v21, v21, v23
  v_smfmac_f32_16x16x64_bf16 v[24:27], v[8:11], a[168:175], v74
  v_cvt_pk_bf16_f32 v54, v20, v21
  s_add_u32 s68, s68, 655360
  s_nop 3
  v_add_f32 v24, v24, v26
  v_add_f32 v25, v25, v27
  v_cvt_pk_bf16_f32 v55, v24, v25
  s_waitcnt lgkmcnt(0)
  buffer_store_dwordx4 v[52:55], v76, s[8:11], s68 offen sc1
  s_branch Cs2_done
Cs2_lastp:
  s_add_u32 s72, s72, 2
  s_cmp_ge_u32 s72, 131072
  s_cbranch_scc1 Cs2_lastg
  s_barrier
  buffer_load_dwordx4 v76, s[8:11], s85 offen offset:0 sc1 lds
  s_waitcnt vmcnt(0)
  s_barrier
  s_branch Cs2_lastr
Cs2_done:
  s_branch L_cexit
L_w7:
  v_mov_b64 v[20:21], 0
  v_mov_b64 v[22:23], 0
  v_mov_b64 v[24:25], 0
  v_mov_b64 v[26:27], 0
  v_mov_b64 v[28:29], 0
  v_mov_b64 v[30:31], 0
  v_mov_b64 v[32:33], 0
  v_mov_b64 v[34:35], 0
  s_mov_b32 s78, 0x3f803f80
  s_mov_b32 s79, s78
  s_mov_b32 s65, 360448
  s_mov_b32 m0, 15872
  s_lshl_b32 s71, s53, 2
  s_add_u32 s71, s71, 128
  s_movk_i32 s56, 0x1000
  v_lshlrev_b32 v73, 2, v76
  v_mov_b32 v72, 0
  s_mov_b64 s[16:17], s[8:9]
  s_mov_b32 s18, 268435456
  s_mov_b32 s19, 0x20000
  s_getpc_b64 s[20:21]
Cs3_pc:
  s_add_u32 s20, s20, (Cs3_last - Cs3_pc)
  s_addc_u32 s21, s21, 0
  v_mov_b32 v68, 14880
  buffer_load_dwordx4 v[52:55], v76, s[8:11], s59 offen offset:0 sc1
  buffer_load_dwordx4 v[56:59], v76, s[8:11], s59 offen offset:1024 sc1
  ds_read_b128 v[36:39], v76 offset:45056
  ds_read_b128 v[40:43], v76 offset:46080
  ds_read_b128 v[60:63], v76 offset:47104
  ds_read_b128 v[64:67], v76 offset:48128
  ds_read_b128 v[0:3], v76 offset:4608
  ds_read_b128 v[4:7], v76 offset:5632
  ds_read_b128 v[8:11], v76 offset:6656
  ds_read_b128 v[12:15], v76 offset:7680
  s_waitcnt lgkmcnt(0)
  s_cmp_eq_u32 s66, 1
  s_branch Cs3_top2
.p2align 6
Cs3_h2:
  v_lshlrev_b32 v73, 2, v76
  ds_read_b128 v[36:39], v76 offset:45056
  ds_read_b128 v[40:43], v76 offset:46080
  buffer_load_dwordx4 v[52:55], v76, s[8:11], s59 offen offset:0 sc1
  buffer_load_dwordx4 v[56:59], v76, s[8:11], s59 offen offset:1024 sc1
  s_waitcnt vmcnt(0)
  s_mov_b64 vcc, -1
Cs3_h2r:
  s_mov_b64 exec, vcc
  buffer_load_dwordx4 v[4:7], v76, s[8:11], s65 offen offset:1024 sc1
  buffer_load_dwordx4 v[0:3], v76, s[8:11], s85 offen offset:0 sc1
  buffer_load_dwordx4 v[8:11], v76, s[8:11], s85 offen offset:1024 sc1
  s_mov_b64 exec, -1
  s_add_u32 s67, s67, 1
  s_cmp_lt_u32 s67, 131072
  s_cselect_b32 s54, -2, -1
  s_waitcnt vmcnt(2)
  v_max3_u32 v72, v4, v5, v6
  s_waitcnt vmcnt(1)
  v_max3_u32 v72, v72, v7, v0
  v_max3_u32 v72, v72, v1, v2
  s_waitcnt vmcnt(0)
  v_max3_u32 v72, v72, v3, v8
  v_max3_u32 v72, v72, v9, v10
  v_max_u32 v72, v72, v11
  v_cmp_lt_u32 vcc, s54, v72
  s_cbranch_vccnz Cs3_h2r
  ds_write_b128 v76, v[4:7] offset:5632
  ds_write_b128 v76, v[0:3] offset:8704
  ds_write_b128 v76, v[8:11] offset:9728
Cs3_h2w:
  s_cmp_eq_u32 s66, 63
  s_waitcnt lgkmcnt(0)
  s_barrier
  ds_read_b128 v[8:11], v76 offset:6656
Cs3_top2:
  v_smfmac_f32_16x16x64_bf16 v[20:23], v[4:7], v[96:103], v74
  s_cbranch_scc1 Cs3_last
  v_smfmac_f32_16x16x64_bf16 v[28:31], v[4:7], v[36:43], v74
  buffer_load_dwordx4 v[44:47], v76, s[8:11], s58 offen offset:0 sc1
  s_mov_b32 m0, 15872
  v_smfmac_f32_16x16x64_bf16 v[24:27], v[4:7], v[104:111], v74
  buffer_load_dwordx4 v[48:51], v76, s[8:11], s58 offen offset:1024 sc1
  v_smfmac_f32_16x16x64_bf16 v[32:35], v[4:7], v[60:67], v74
  ds_read_b128 v[0:3], v76 offset:4608
  s_waitcnt lgkmcnt(1)
  v_smfmac_f32_16x16x64_bf16 v[20:23], v[8:11], v[112:119], v74
  ds_read_b128 v[12:15], v76 offset:7680
  v_smfmac_f32_16x16x64_bf16 v[24:27], v[8:11], v[120:127], v74
  ds_read_b128 v[36:39], v76 offset:28672
  v_smfmac_f32_16x16x64_bf16 v[28:31], v[8:11], v[208:215], v74
  buffer_store_dwordx4 v[16:19], v76, s[8:11], s68 offen sc1
  ds_read_b128 v[40:43], v76 offset:29696
  v_smfmac_f32_16x16x64_bf16 v[32:35], v[8:11], v[216:223], v74
  buffer_load_dword v73, s[16:19], s70 offen lds
  ds_read_b128 v[60:63], v76 offset:30720
  s_waitcnt lgkmcnt(4)
  v_smfmac_f32_16x16x64_bf16 v[20:23], v[0:3], v[80:87], v74
  ds_read_b128 v[64:67], v76 offset:31744
  v_smfmac_f32_16x16x64_bf16 v[24:27], v[0:3], v[88:95], v74
  s_waitcnt vmcnt(4)
  s_waitcnt lgkmcnt(4)
  v_smfmac_f32_16x16x64_bf16 v[20:23], v[12:15], v[128:135], v74
  s_barrier
  ds_read_b128 v[4:7], v76 offset:8704
  s_waitcnt lgkmcnt(3)
  v_smfmac_f32_16x16x64_bf16 v[28:31], v[0:3], v[36:43], v74
  ds_read_b128 v[36:39], v76 offset:61440
  v_smfmac_f32_16x16x64_bf16 v[24:27], v[12:15], v[136:143], v74
  ds_read_b128 v[40:43], v76 offset:62464
  s_waitcnt lgkmcnt(3)
  v_smfmac_f32_16x16x64_bf16 v[32:35], v[0:3], v[60:67], v74
  ds_read_b128 v[8:11], v76 offset:9728
  v_smfmac_f32_16x16x64_bf16 v[28:31], v[12:15], v[224:231], v74
  ds_read_b128 v[60:63], v76 offset:63488
  v_smfmac_f32_16x16x64_bf16 v[32:35], v[12:15], v[232:239], v74
  ds_read_b128 v[64:67], v76 offset:64512
  s_waitcnt lgkmcnt(5)
  v_smfmac_f32_16x16x64_bf16 v[20:23], v[4:7], v[144:151], v74
  s_barrier
  ds_read_b128 v[0:3], v76 offset:11776
  s_waitcnt lgkmcnt(4)
  v_smfmac_f32_16x16x64_bf16 v[28:31], v[4:7], v[36:43], v74
  ds_read_b128 v[12:15], v76 offset:12800
  ds_read_b128 v[36:39], v75 offset:12288
  v_smfmac_f32_16x16x64_bf16 v[24:27], v[4:7], v[152:159], v74
  ds_read_b128 v[16:19], v76 offset:10752
  s_waitcnt lgkmcnt(6)
  v_smfmac_f32_16x16x64_bf16 v[20:23], v[8:11], v[160:167], v74
  ds_read_b128 v[40:43], v75 offset:13312
  s_waitcnt lgkmcnt(5)
  v_smfmac_f32_16x16x64_bf16 v[32:35], v[4:7], v[60:67], v74
  ds_read_b128 v[60:63], v75 offset:14336
  v_smfmac_f32_16x16x64_bf16 v[24:27], v[8:11], v[168:175], v74
  ds_read_b128 v[64:67], v75 offset:15360
  s_waitcnt lgkmcnt(6)
  v_smfmac_f32_16x16x64_bf16 v[20:23], v[0:3], v[176:183], v74
  s_waitcnt lgkmcnt(5)
  v_smfmac_f32_16x16x64_bf16 v[20:23], v[12:15], v[192:199], v74
  s_waitcnt lgkmcnt(2)
  v_smfmac_f32_16x16x64_bf16 v[20:23], v[16:19], v[36:43], v74
  ds_read_b128 v[36:39], v75 offset:28672
  v_smfmac_f32_16x16x64_bf16 v[24:27], v[0:3], v[184:191], v74
  ds_read_b128 v[40:43], v75 offset:29696
  s_waitcnt lgkmcnt(2)
  v_smfmac_f32_16x16x64_bf16 v[24:27], v[16:19], v[60:67], v74
  ds_read_b128 v[60:63], v75 offset:30720
  v_add_f32 v20, v20, v22
  v_smfmac_f32_16x16x64_bf16 v[24:27], v[12:15], v[200:207], v74
  ds_read_b128 v[64:67], v75 offset:31744
  v_add_f32 v21, v21, v23
  v_smfmac_f32_16x16x64_bf16 v[28:31], v[16:19], v[240:247], v74
  v_mov_b64 v[70:71], s[78:79]
  v_smfmac_f32_16x16x64_bf16 v[28:31], v[0:3], a[0:7], v74
  s_waitcnt lgkmcnt(2)
  v_add_f32 v24, v24, v26
  v_smfmac_f32_16x16x64_bf16 v[28:31], v[8:11], v[36:43], v74
  ds_read_b128 v[36:39], v68
  v_cvt_pk_bf16_f32 v22, v20, v24
  v_smfmac_f32_16x16x64_bf16 v[28:31], v[12:15], a[16:23], v74
  ds_read_b128 v[40:43], v68
  ds_write_b32 v79, v22 offset:0
  s_waitcnt lgkmcnt(3)
  v_add_f32 v25, v25, v27
  v_cvt_pk_bf16_f32 v23, v21, v25
  v_smfmac_f32_16x16x64_bf16 v[32:35], v[8:11], v[60:67], v74
  ds_write_b32 v79, v23 offset:576
  v_cmp_u_f32 vcc, v20, v21
  v_smfmac_f32_16x16x64_bf16 v[32:35], v[16:19], v[248:255], v74
  v_add_f32 v28, v28, v30
  v_smfmac_f32_16x16x64_bf16 v[32:35], v[0:3], a[8:15], v74
  v_add_f32 v29, v29, v31
  v_smfmac_f32_16x16x64_bf16 v[32:35], v[12:15], a[24:31], v74
  s_cbranch_vccnz Cs3_rec
Cs3_recok:
  s_waitcnt lgkmcnt(3)
  v_smfmac_f32_16x16x64_bf16 v[36:39], v[16:19], a[128:135], v74
  s_waitcnt lgkmcnt(0)
  s_barrier
  ds_read_b128 v[60:63], v77
  v_smfmac_f32_16x16x64_bf16 v[40:43], v[16:19], a[136:143], v74
  ds_read_b128 v[64:67], v77 offset:128
  v_add_f32 v32, v32, v34
  v_cvt_pk_bf16_f32 v30, v28, v32
  v_smfmac_f32_16x16x64_bf16 v[36:39], v[0:3], a[144:151], v74
  ds_write_b32 v79, v30 offset:256
  v_add_f32 v33, v33, v35
  v_cvt_pk_bf16_f32 v31, v29, v33
  v_smfmac_f32_16x16x64_bf16 v[40:43], v[0:3], a[152:159], v74
  ds_write_b32 v79, v31 offset:832
  v_xor_b32 v75, 0x8000, v75
  v_smfmac_f32_16x16x64_bf16 v[36:39], v[4:7], a[96:103], v74
  ds_read_b128 v[0:3], v76 offset:4608
  v_mov_b32 v29, 0
  v_smfmac_f32_16x16x64_bf16 v[40:43], v[4:7], a[104:111], v74
  s_waitcnt vmcnt(2) lgkmcnt(3)
  v_mov_b32 v30, 0
  v_mfma_f32_16x16x32_bf16 v[44:47], v[44:47], v[60:63], 0
  ds_read_b128 v[4:7], v76 offset:5632
  s_waitcnt lgkmcnt(2)
  v_mfma_f32_16x16x32_bf16 v[44:47], v[48:51], v[64:67], v[44:47]
  s_barrier
  v_smfmac_f32_16x16x64_bf16 v[36:39], v[8:11], a[112:119], v74
  ds_read_b128 v[20:23], v77 offset:256
  ds_read_b128 v[24:27], v77 offset:384
  v_smfmac_f32_16x16x64_bf16 v[40:43], v[8:11], a[120:127], v74
  ds_read_b128 v[8:11], v76 offset:6656
  v_add_f32_dpp v72, v46, v44 quad_perm:[2,3,0,1] row_mask:0xf bank_mask:0xf
  v_add_f32_dpp v73, v47, v45 quad_perm:[2,3,0,1] row_mask:0xf bank_mask:0xf
  v_smfmac_f32_16x16x64_bf16 v[36:39], v[12:15], a[160:167], v74
  s_waitcnt lgkmcnt(4)
  v_exp_f32_dpp v72, v72 quad_perm:[0,1,0,1] row_mask:0xf bank_mask:0xf
  v_smfmac_f32_16x16x64_bf16 v[40:43], v[12:15], a[168:175], v74
  ds_read_b128 v[12:15], v76 offset:7680
  v_exp_f32_dpp v73, v73 quad_perm:[0,1,0,1] row_mask:0xf bank_mask:0xf
  v_smfmac_f32_16x16x64_bf16 v[36:39], v[0:3], a[32:39], v74
  s_waitcnt lgkmcnt(2)
  v_cvt_pk_bf16_f32 v72, v72, v73
  v_mfma_f32_16x16x32_bf16 v[20:23], v[20:23], v[60:63], 0
  ds_write_b32 v78, v72 offset:524
  v_mov_b64 v[16:17], 0
  v_mfma_f32_16x16x32_bf16 v[20:23], v[24:27], v[64:67], v[20:23]
  ds_read_b128 v[44:47], v75 offset:28672
  v_mov_b64 v[18:19], 0
  v_smfmac_f32_16x16x64_bf16 v[40:43], v[0:3], a[40:47], v74
  ds_read_b128 v[48:51], v75 offset:29696
  v_mov_b64 v[68:69], s[78:79]
  v_smfmac_f32_16x16x64_bf16 v[36:39], v[4:7], a[48:55], v74
  s_waitcnt lgkmcnt(4)
  v_add_f32_dpp v24, v22, v20 quad_perm:[2,3,0,1] row_mask:0xf bank_mask:0xf
  v_add_f32_dpp v25, v23, v21 quad_perm:[2,3,0,1] row_mask:0xf bank_mask:0xf
  v_smfmac_f32_16x16x64_bf16 v[36:39], v[8:11], a[64:71], v74
  s_waitcnt lgkmcnt(2)
  s_barrier
  ds_read_b128 v[32:35], v78 offset:512
  v_smfmac_f32_16x16x64_bf16 v[36:39], v[12:15], a[80:87], v74
  ds_read_b128 v[60:63], v75 offset:30720
  v_mul_f32 v24, s69, v24
  v_smfmac_f32_16x16x64_bf16 v[40:43], v[4:7], a[56:63], v74
  ds_read_b128 v[64:67], v75 offset:31744
  v_mul_f32 v25, s69, v25
  v_smfmac_f32_16x16x64_bf16 v[40:43], v[8:11], a[72:79], v74
  v_exp_f32_dpp v24, v24 quad_perm:[0,1,0,1] row_mask:0xf bank_mask:0xf
  v_smfmac_f32_16x16x64_bf16 v[40:43], v[12:15], a[88:95], v74
  s_waitcnt lgkmcnt(2)
  v_exp_f32_dpp v25, v25 quad_perm:[0,1,0,1] row_mask:0xf bank_mask:0xf
  v_mfma_f32_16x16x32_bf16 v[8:11], v[32:35], v[68:71], 0
  v_add_f32 v36, v36, v38
  v_add_f32 v37, v37, v39
  v_mfma_f32_16x16x32_bf16 v[0:3], v[32:35], v[52:55], 0
  v_add_f32 v40, v40, v42
  v_add_f32 v41, v41, v43
  v_mfma_f32_16x16x32_bf16 v[4:7], v[32:35], v[56:59], 0
  v_cvt_pk_bf16_f32 v28, v24, v25
  v_cvt_pk_bf16_f32 v72, v36, v37
  v_cvt_pk_bf16_f32 v73, v40, v41
  v_mfma_f32_16x16x16_bf16 v[8:11], v[28:29], v[68:69], v[8:11]
  v_cvt_pk_bf16_f32 v31, v24, v25
  v_mov_b64 v[20:21], 0
  v_mfma_f32_16x16x16_bf16 v[0:3], v[28:29], v[72:73], v[0:3]
  ds_read_b128 v[68:71], v76 offset:13824
  v_mov_b64 v[22:23], 0
  v_mfma_f32_16x16x16_bf16 v[4:7], v[30:31], v[72:73], v[4:7]
  v_rcp_f32 v10, v8
  v_rcp_f32 v11, v9
  v_mul_f32 v0, v10, v0
  v_mul_f32 v1, v11, v1
  s_nop 0
  v_mul_f32 v4, v10, v4
  v_mul_f32 v5, v11, v5
  v_cvt_pk_bf16_f32 v2, v0, v4
  ds_write_b32 v79, v2 offset:8704
  v_cvt_pk_bf16_f32 v3, v1, v5
  ds_write_b32 v79, v3 offset:9280
  v_max3_f32 v8, v8, v9, v10
  v_max_f32 v8, v8, v11
  v_cmp_le_f32 vcc, 1317011456, v8
  v_mov_b64 v[24:25], 0
  v_mov_b64 v[26:27], 0
  s_cbranch_vccnz Cs3_mx
Cs3_mxok:
  s_waitcnt lgkmcnt(0)
  s_barrier
  ds_read_b128 v[0:3], v78 offset:8704
  ds_read_b128 v[4:7], v78 offset:8768
  ds_read_b128 v[8:11], v78 offset:8832
  ds_read_b128 v[12:15], v78 offset:8896
  s_waitcnt lgkmcnt(3)
  v_smfmac_f32_16x16x64_bf16 v[16:19], v[0:3], v[44:51], v74
  ds_read_b128 v[52:55], v75 offset:45056
  s_waitcnt lgkmcnt(3)
  v_smfmac_f32_16x16x64_bf16 v[16:19], v[4:7], v[60:67], v74
  ds_read_b128 v[56:59], v75 offset:46080
  s_waitcnt lgkmcnt(3)
  v_smfmac_f32_16x16x64_bf16 v[16:19], v[8:11], a[176:183], v74
  ds_read_b128 v[36:39], v75 offset:47104
  s_waitcnt lgkmcnt(3)
  v_smfmac_f32_16x16x64_bf16 v[16:19], v[12:15], a[184:191], v74
  ds_read_b128 v[40:43], v75 offset:48128
  ds_read_b128 v[44:47], v75 offset:61440
  v_smfmac_f32_16x16x64_bf16 v[20:23], v[0:3], a[192:199], v74
  ds_read_b128 v[48:51], v75 offset:62464
  ds_read_b128 v[60:63], v75 offset:63488
  v_smfmac_f32_16x16x64_bf16 v[20:23], v[4:7], a[200:207], v74
  ds_read_b128 v[64:67], v75 offset:64512
  s_waitcnt lgkmcnt(6)
  v_cvt_pk_bf16_f32 v16, v16, v17
  v_cvt_pk_bf16_f32 v17, v18, v19
  v_bfi_b32 v16, 1, s72, v16
  v_smfmac_f32_16x16x64_bf16 v[20:23], v[8:11], v[52:59], v74
  buffer_store_dwordx2 v[16:17], v68, s[8:11], s73 offen sc1
  s_waitcnt lgkmcnt(4)
  v_smfmac_f32_16x16x64_bf16 v[20:23], v[12:15], v[36:43], v74
  ds_read_b128 v[52:55], v75 offset:8192
  v_mov_b64 v[32:33], 0
  v_smfmac_f32_16x16x64_bf16 v[24:27], v[0:3], a[208:215], v74
  ds_read_b128 v[56:59], v75 offset:9216
  v_mov_b64 v[34:35], 0
  v_smfmac_f32_16x16x64_bf16 v[24:27], v[4:7], a[216:223], v74
  ds_read_b128 v[36:39], v75 offset:10240
  s_waitcnt lgkmcnt(5)
  v_cvt_pk_bf16_f32 v20, v20, v21
  v_cvt_pk_bf16_f32 v21, v22, v23
  v_bfi_b32 v20, 1, s72, v20
  v_smfmac_f32_16x16x64_bf16 v[24:27], v[8:11], v[44:51], v74
  buffer_store_dwordx2 v[20:21], v68, s[8:11], s74 offen sc1
  s_waitcnt lgkmcnt(3)
  v_smfmac_f32_16x16x64_bf16 v[24:27], v[12:15], v[60:67], v74
  ds_read_b128 v[40:43], v75 offset:11264
  v_mov_b64 v[28:29], 0
  v_smfmac_f32_16x16x64_bf16 v[32:35], v[0:3], a[224:231], v74
  ds_read_b128 v[44:47], v75 offset:12288
  ds_read_b128 v[48:51], v75 offset:13312
  v_smfmac_f32_16x16x64_bf16 v[32:35], v[4:7], a[232:239], v74
  ds_read_b128 v[60:63], v75 offset:14336
  v_cvt_pk_bf16_f32 v24, v24, v25
  v_cvt_pk_bf16_f32 v25, v26, v27
  v_bfi_b32 v24, 1, s72, v24
  v_smfmac_f32_16x16x64_bf16 v[32:35], v[8:11], a[240:247], v74
  buffer_store_dwordx2 v[24:25], v68, s[8:11], s75 offen sc1
  v_mov_b64 v[30:31], 0
  v_smfmac_f32_16x16x64_bf16 v[32:35], v[12:15], a[248:255], v74
  ds_read_b128 v[64:67], v75 offset:15360
  s_waitcnt lgkmcnt(6)
  v_smfmac_f32_16x16x64_bf16 v[28:31], v[0:3], v[52:59], v74
  s_waitcnt lgkmcnt(4)
  v_smfmac_f32_16x16x64_bf16 v[28:31], v[4:7], v[36:43], v74
  s_waitcnt lgkmcnt(2)
  v_cvt_pk_bf16_f32 v32, v32, v33
  v_cvt_pk_bf16_f32 v33, v34, v35
  v_bfi_b32 v32, 1, s72, v32
  v_smfmac_f32_16x16x64_bf16 v[28:31], v[8:11], v[44:51], v74
  buffer_store_dwordx2 v[32:33], v68, s[8:11], s76 offen sc1
  s_waitcnt lgkmcnt(0)
  v_smfmac_f32_16x16x64_bf16 v[28:31], v[12:15], v[60:67], v74
  v_mov_b64 v[18:19], v[72:73]
  s_nop 4
  v_cvt_pk_bf16_f32 v28, v28, v29
  v_cvt_pk_bf16_f32 v29, v30, v31
  v_bfi_b32 v28, 1, s72, v28
  buffer_store_dwordx2 v[28:29], v68, s[8:11], s77 offen sc1
  ds_read_b128 v[52:55], v76 offset:14848
  s_waitcnt lgkmcnt(0)
  ds_read_b64 v[16:17], v77 offset:392
  s_waitcnt lgkmcnt(0)
  ds_read_b128 v[60:63], v76 offset:47104
  s_waitcnt lgkmcnt(0)
  ds_read_b128 v[64:67], v76 offset:48128
  s_waitcnt lgkmcnt(0)
  s_add_u32 s66, s66, 1
  s_xor_b32 s64, s64, 16384
  s_xor_b32 s65, s65, 16384
  s_add_u32 s58, s58, 655360
  s_add_u32 s59, s59, 655360
  s_add_u32 s70, s70, 655360
  s_add_u32 s68, s68, 655360
  s_mov_b32 m0, 8704
  s_add_u32 s85, s65, 4096
  v_xor_b32 v75, 0x8000, v75
  s_waitcnt vmcnt(0)
  buffer_load_dwordx4 v[0:3], v76, s[8:11], s60 offen offset:0 sc1
  buffer_load_dwordx4 v[4:7], v76, s[8:11], s60 offen offset:1024 sc1
  buffer_load_dwordx4 v[8:11], v76, s[8:11], s61 offen offset:0 sc1
  buffer_load_dwordx4 v[12:15], v76, s[8:11], s61 offen offset:1024 sc1
  v_mov_b64 v[20:21], 0
  v_mov_b64 v[22:23], 0
  v_mov_b64 v[24:25], 0
  v_mov_b64 v[26:27], 0
  v_mov_b32 v68, 14880
  v_mov_b64 v[28:29], 0
  v_mov_b64 v[30:31], 0
  v_mov_b64 v[32:33], 0
  v_mov_b64 v[34:35], 0
  s_cmp_eq_u32 s66, 62
  s_cselect_b64 s[16:17], s[20:21], s[16:17]
  s_cselect_b32 s18, (Cs3_done - Cs3_last), s18
  s_cselect_b32 s70, 0, s70
  s_cmp_eq_u32 s66, 63
  s_cselect_b32 s59, 268435456, s59
  s_cselect_b32 s58, 268435456, s58
  s_waitcnt lgkmcnt(0)
  s_waitcnt vmcnt(3)
  v_mfma_f32_16x16x32_bf16 v[56:59], v[52:55], v[0:3], 0
  v_bitop3_b32 v72, v0, v2, s72 bitop3:0x7e
  s_waitcnt vmcnt(2)
  v_mfma_f32_16x16x32_bf16 v[56:59], v[52:55], v[4:7], v[56:59]
  v_bitop3_b32 v73, v4, v6, s72 bitop3:0x7e
  v_or_b32 v72, v72, v73
  s_waitcnt vmcnt(1)
  v_mfma_f32_16x16x32_bf16 v[36:39], v[52:55], v[8:11], 0
  v_bitop3_b32 v73, v8, v10, s72 bitop3:0x7e
  v_or_b32 v72, v72, v73
  s_waitcnt vmcnt(0)
  v_mfma_f32_16x16x32_bf16 v[36:39], v[52:55], v[12:15], v[36:39]
  v_bitop3_b32 v73, v12, v14, s72 bitop3:0x7e
  v_bitop3_b32 v72, v72, v73, 1 bitop3:0xa8
  v_cmp_ne_u32 vcc, 0, v72
  s_cbranch_vccnz Cs3_h1r
  v_add_f32_dpp v56, v56, v56 row_ror:4 row_mask:0xf bank_mask:0xf
  v_add_f32_dpp v57, v57, v57 row_ror:4 row_mask:0xf bank_mask:0xf
  s_nop 0
  v_add_f32_dpp v36, v36, v36 row_ror:4 row_mask:0xf bank_mask:0xf
  v_add_f32_dpp v37, v37, v37 row_ror:4 row_mask:0xf bank_mask:0xf
  v_add_f32_dpp v56, v56, v56 row_ror:8 row_mask:0xf bank_mask:0xf
  v_add_f32_dpp v57, v57, v57 row_ror:8 row_mask:0xf bank_mask:0xf
  v_add_f32_dpp v36, v36, v36 row_ror:8 row_mask:0xf bank_mask:0xf
  v_add_f32_dpp v37, v37, v37 row_ror:8 row_mask:0xf bank_mask:0xf
  v_cvt_pk_bf16_f32 v56, v56, v57
  buffer_store_dword v56, v69, s[8:11], s62 offen sc1
  v_cvt_pk_bf16_f32 v36, v36, v37
  buffer_store_dword v36, v70, s[8:11], s63 offen sc1
  s_xor_b32 s62, s62, 16384
  buffer_store_dword v71, v69, s[8:11], s62 offen sc1
  s_xor_b32 s63, s63, 16384
  buffer_store_dword v71, v70, s[8:11], s63 offen sc1
  s_xor_b32 s72, s72, 1
  s_branch Cs3_h2
Cs3_h1r:
  s_mov_b64 exec, vcc
  buffer_load_dwordx4 v[0:3], v76, s[8:11], s60 offen offset:0 sc1
  buffer_load_dwordx4 v[4:7], v76, s[8:11], s60 offen offset:1024 sc1
  buffer_load_dwordx4 v[8:11], v76, s[8:11], s61 offen offset:0 sc1
  buffer_load_dwordx4 v[12:15], v76, s[8:11], s61 offen offset:1024 sc1
  s_mov_b64 exec, -1
  s_add_u32 s67, s67, 1
  s_waitcnt vmcnt(3)
  v_mfma_f32_16x16x32_bf16 v[56:59], v[52:55], v[0:3], 0
  v_bitop3_b32 v72, v0, v2, s72 bitop3:0x7e
  s_waitcnt vmcnt(2)
  v_mfma_f32_16x16x32_bf16 v[56:59], v[52:55], v[4:7], v[56:59]
  v_bitop3_b32 v73, v4, v6, s72 bitop3:0x7e
  v_or_b32 v72, v72, v73
  s_waitcnt vmcnt(1)
  v_mfma_f32_16x16x32_bf16 v[36:39], v[52:55], v[8:11], 0
  v_bitop3_b32 v73, v8, v10, s72 bitop3:0x7e
  v_or_b32 v72, v72, v73
  s_waitcnt vmcnt(0)
  v_mfma_f32_16x16x32_bf16 v[36:39], v[52:55], v[12:15], v[36:39]
  v_bitop3_b32 v73, v12, v14, s72 bitop3:0x7e
  v_bitop3_b32 v72, v72, v73, 1 bitop3:0xa8
  v_cmp_ne_u32 vcc, 0, v72
  s_cbranch_vccz Cs3_h1p
Cs3_h1s:
  s_mov_b64 exec, vcc
  buffer_load_dwordx4 v[0:3], v76, s[8:11], s60 offen offset:0 sc1
  buffer_load_dwordx4 v[4:7], v76, s[8:11], s60 offen offset:1024 sc1
  buffer_load_dwordx4 v[8:11], v76, s[8:11], s61 offen offset:0 sc1
  buffer_load_dwordx4 v[12:15], v76, s[8:11], s61 offen offset:1024 sc1
  s_mov_b64 exec, -1
  s_add_u32 s67, s67, 1
  s_waitcnt vmcnt(3)
  v_mfma_f32_16x16x32_bf16 v[56:59], v[52:55], v[0:3], 0
  v_bitop3_b32 v72, v0, v2, s72 bitop3:0x7e
  s_waitcnt vmcnt(2)
  v_mfma_f32_16x16x32_bf16 v[56:59], v[52:55], v[4:7], v[56:59]
  v_bitop3_b32 v73, v4, v6, s72 bitop3:0x7e
  v_or_b32 v72, v72, v73
  s_waitcnt vmcnt(1)
  v_mfma_f32_16x16x32_bf16 v[36:39], v[52:55], v[8:11], 0
  v_bitop3_b32 v73, v8, v10, s72 bitop3:0x7e
  v_or_b32 v72, v72, v73
  s_waitcnt vmcnt(0)
  v_mfma_f32_16x16x32_bf16 v[36:39], v[52:55], v[12:15], v[36:39]
  v_bitop3_b32 v73, v12, v14, s72 bitop3:0x7e
  v_bitop3_b32 v72, v72, v73, 1 bitop3:0xa8
  v_cmp_ne_u32 vcc, 0, v72
  s_cbranch_vccz Cs3_h1p
  s_cmp_lt_u32 s67, 131072
  s_cbranch_scc1 Cs3_h1s
Cs3_h1p:
  s_nop 2
  v_add_f32_dpp v56, v56, v56 row_ror:4 row_mask:0xf bank_mask:0xf
  v_add_f32_dpp v57, v57, v57 row_ror:4 row_mask:0xf bank_mask:0xf
  v_add_f32_dpp v36, v36, v36 row_ror:4 row_mask:0xf bank_mask:0xf
  v_add_f32_dpp v37, v37, v37 row_ror:4 row_mask:0xf bank_mask:0xf
  v_add_f32_dpp v56, v56, v56 row_ror:8 row_mask:0xf bank_mask:0xf
  v_add_f32_dpp v57, v57, v57 row_ror:8 row_mask:0xf bank_mask:0xf
  v_add_f32_dpp v36, v36, v36 row_ror:8 row_mask:0xf bank_mask:0xf
  v_add_f32_dpp v37, v37, v37 row_ror:8 row_mask:0xf bank_mask:0xf
  v_cvt_pk_bf16_f32 v56, v56, v57
  buffer_store_dword v56, v69, s[8:11], s62 offen sc1
  v_cvt_pk_bf16_f32 v36, v36, v37
  buffer_store_dword v36, v70, s[8:11], s63 offen sc1
  s_xor_b32 s62, s62, 16384
  buffer_store_dword v71, v69, s[8:11], s62 offen sc1
  s_xor_b32 s63, s63, 16384
  buffer_store_dword v71, v70, s[8:11], s63 offen sc1
  s_xor_b32 s72, s72, 1
  s_branch Cs3_h2
Cs3_rec:
  s_nop 7
  s_waitcnt vmcnt(0) lgkmcnt(0)
  v_max3_u32 v72, v0, v1, v2
  v_max3_u32 v72, v72, v3, v4
  v_max3_u32 v72, v72, v5, v6
  v_max3_u32 v72, v72, v7, v8
  v_max3_u32 v72, v72, v9, v10
  v_max3_u32 v72, v72, v11, v12
  v_max3_u32 v72, v72, v13, v14
  v_max3_u32 v72, v72, v15, v16
  v_max3_u32 v72, v72, v17, v18
  v_max_u32 v72, v72, v19
  v_cmp_eq_u32 vcc, -1, v72
  s_cbranch_vccz Cs3_recok
  s_barrier
Cs3_recp:
  buffer_load_dwordx4 v[0:3], v76, s[8:11], s64 offen offset:0 sc1
  buffer_load_dwordx4 v[4:7], v76, s[8:11], s64 offen offset:1024 sc1
  buffer_load_dwordx4 v[8:11], v76, s[8:11], s64 offen offset:2048 sc1
  s_add_u32 s67, s67, 1
  s_cmp_lt_u32 s67, 131072
  s_cselect_b32 s54, -2, -1
  s_waitcnt vmcnt(2)
  v_max3_u32 v72, v0, v1, v2
  s_waitcnt vmcnt(1)
  v_max3_u32 v72, v72, v3, v4
  v_max3_u32 v72, v72, v5, v6
  s_waitcnt vmcnt(0)
  v_max3_u32 v72, v72, v7, v8
  v_max3_u32 v72, v72, v9, v10
  v_max_u32 v72, v72, v11
  v_cmp_lt_u32 vcc, s54, v72
  s_cbranch_vccnz Cs3_recp
  ds_write_b128 v76, v[0:3] offset:10752
  ds_write_b128 v76, v[4:7] offset:11776
  ds_write_b128 v76, v[8:11] offset:12800
  v_mov_b64 v[20:21], 0
  v_mov_b64 v[22:23], 0
  v_mov_b64 v[24:25], 0
  v_mov_b64 v[26:27], 0
  v_mov_b64 v[28:29], 0
  v_mov_b64 v[30:31], 0
  v_mov_b64 v[32:33], 0
  v_mov_b64 v[34:35], 0
  s_waitcnt lgkmcnt(0)
  s_barrier
  ds_read_b128 v[0:3], v76 offset:4608
  s_waitcnt lgkmcnt(0)
  v_smfmac_f32_16x16x64_bf16 v[20:23], v[0:3], v[80:87], v74
  v_smfmac_f32_16x16x64_bf16 v[24:27], v[0:3], v[88:95], v74
  ds_read_b128 v[60:63], v76 offset:28672
  ds_read_b128 v[64:67], v76 offset:29696
  s_waitcnt lgkmcnt(0)
  v_smfmac_f32_16x16x64_bf16 v[28:31], v[0:3], v[60:67], v74
  ds_read_b128 v[60:63], v76 offset:30720
  ds_read_b128 v[64:67], v76 offset:31744
  s_waitcnt lgkmcnt(0)
  v_smfmac_f32_16x16x64_bf16 v[32:35], v[0:3], v[60:67], v74
  ds_read_b128 v[4:7], v76 offset:5632
  s_waitcnt lgkmcnt(0)
  v_smfmac_f32_16x16x64_bf16 v[20:23], v[4:7], v[96:103], v74
  v_smfmac_f32_16x16x64_bf16 v[24:27], v[4:7], v[104:111], v74
  ds_read_b128 v[60:63], v76 offset:45056
  ds_read_b128 v[64:67], v76 offset:46080
  s_waitcnt lgkmcnt(0)
  v_smfmac_f32_16x16x64_bf16 v[28:31], v[4:7], v[60:67], v74
  ds_read_b128 v[60:63], v76 offset:47104
  ds_read_b128 v[64:67], v76 offset:48128
  s_waitcnt lgkmcnt(0)
  v_smfmac_f32_16x16x64_bf16 v[32:35], v[4:7], v[60:67], v74
  ds_read_b128 v[8:11], v76 offset:6656
  s_waitcnt lgkmcnt(0)
  v_smfmac_f32_16x16x64_bf16 v[20:23], v[8:11], v[112:119], v74
  v_smfmac_f32_16x16x64_bf16 v[24:27], v[8:11], v[120:127], v74
  v_smfmac_f32_16x16x64_bf16 v[28:31], v[8:11], v[208:215], v74
  v_smfmac_f32_16x16x64_bf16 v[32:35], v[8:11], v[216:223], v74
  ds_read_b128 v[12:15], v76 offset:7680
  s_waitcnt lgkmcnt(0)
  v_smfmac_f32_16x16x64_bf16 v[20:23], v[12:15], v[128:135], v74
  v_smfmac_f32_16x16x64_bf16 v[24:27], v[12:15], v[136:143], v74
  v_smfmac_f32_16x16x64_bf16 v[28:31], v[12:15], v[224:231], v74
  v_smfmac_f32_16x16x64_bf16 v[32:35], v[12:15], v[232:239], v74
  ds_read_b128 v[4:7], v76 offset:8704
  s_waitcnt lgkmcnt(0)
  v_smfmac_f32_16x16x64_bf16 v[20:23], v[4:7], v[144:151], v74
  v_smfmac_f32_16x16x64_bf16 v[24:27], v[4:7], v[152:159], v74
  ds_read_b128 v[60:63], v76 offset:61440
  ds_read_b128 v[64:67], v76 offset:62464
  s_waitcnt lgkmcnt(0)
  v_smfmac_f32_16x16x64_bf16 v[28:31], v[4:7], v[60:67], v74
  ds_read_b128 v[60:63], v76 offset:63488
  ds_read_b128 v[64:67], v76 offset:64512
  s_waitcnt lgkmcnt(0)
  v_smfmac_f32_16x16x64_bf16 v[32:35], v[4:7], v[60:67], v74
  ds_read_b128 v[8:11], v76 offset:9728
  s_waitcnt lgkmcnt(0)
  v_smfmac_f32_16x16x64_bf16 v[20:23], v[8:11], v[160:167], v74
  v_smfmac_f32_16x16x64_bf16 v[24:27], v[8:11], v[168:175], v74
  ds_read_b128 v[60:63], v75 offset:28672
  ds_read_b128 v[64:67], v75 offset:29696
  s_waitcnt lgkmcnt(0)
  v_smfmac_f32_16x16x64_bf16 v[28:31], v[8:11], v[60:67], v74
  ds_read_b128 v[60:63], v75 offset:30720
  ds_read_b128 v[64:67], v75 offset:31744
  s_waitcnt lgkmcnt(0)
  v_smfmac_f32_16x16x64_bf16 v[32:35], v[8:11], v[60:67], v74
  ds_read_b128 v[16:19], v76 offset:10752
  ds_read_b128 v[60:63], v75 offset:12288
  ds_read_b128 v[64:67], v75 offset:13312
  s_waitcnt lgkmcnt(0)
  v_smfmac_f32_16x16x64_bf16 v[20:23], v[16:19], v[60:67], v74
  ds_read_b128 v[60:63], v75 offset:14336
  ds_read_b128 v[64:67], v75 offset:15360
  s_waitcnt lgkmcnt(0)
  v_smfmac_f32_16x16x64_bf16 v[24:27], v[16:19], v[60:67], v74
  v_smfmac_f32_16x16x64_bf16 v[28:31], v[16:19], v[240:247], v74
  v_smfmac_f32_16x16x64_bf16 v[32:35], v[16:19], v[248:255], v74
  ds_read_b128 v[0:3], v76 offset:11776
  s_waitcnt lgkmcnt(0)
  v_smfmac_f32_16x16x64_bf16 v[20:23], v[0:3], v[176:183], v74
  v_smfmac_f32_16x16x64_bf16 v[24:27], v[0:3], v[184:191], v74
  v_smfmac_f32_16x16x64_bf16 v[28:31], v[0:3], a[0:7], v74
  v_smfmac_f32_16x16x64_bf16 v[32:35], v[0:3], a[8:15], v74
  ds_read_b128 v[12:15], v76 offset:12800
  s_waitcnt lgkmcnt(0)
  v_smfmac_f32_16x16x64_bf16 v[20:23], v[12:15], v[192:199], v74
  v_smfmac_f32_16x16x64_bf16 v[24:27], v[12:15], v[200:207], v74
  v_smfmac_f32_16x16x64_bf16 v[28:31], v[12:15], a[16:23], v74
  v_smfmac_f32_16x16x64_bf16 v[32:35], v[12:15], a[24:31], v74
  v_add_f32 v20, v20, v22
  v_add_f32 v21, v21, v23
  v_add_f32 v24, v24, v26
  v_cvt_pk_bf16_f32 v22, v20, v24
  ds_write_b32 v79, v22 offset:0
  v_add_f32 v25, v25, v27
  v_cvt_pk_bf16_f32 v23, v21, v25
  ds_write_b32 v79, v23 offset:576
  v_add_f32 v28, v28, v30
  v_add_f32 v29, v29, v31
  s_waitcnt lgkmcnt(0)
  s_nop 1
  s_branch Cs3_recok
Cs3_mx:
  s_waitcnt lgkmcnt(0)
  s_barrier
  buffer_load_dwordx4 v[0:3], v76, s[8:11], s58 offen offset:0 sc1
  ds_read_b128 v[20:23], v77 offset:0
  ds_read_b128 v[28:31], v77 offset:256
  buffer_load_dwordx4 v[4:7], v76, s[8:11], s58 offen offset:1024 sc1
  ds_read_b128 v[24:27], v77 offset:128
  ds_read_b128 v[32:35], v77 offset:384
  s_waitcnt vmcnt(1) lgkmcnt(3)
  v_mfma_f32_16x16x32_bf16 v[8:11], v[0:3], v[20:23], 0
  s_waitcnt vmcnt(0) lgkmcnt(1)
  v_mfma_f32_16x16x32_bf16 v[8:11], v[4:7], v[24:27], v[8:11]
  v_mfma_f32_16x16x32_bf16 v[12:15], v[28:31], v[20:23], 0
  s_waitcnt lgkmcnt(0)
  v_mfma_f32_16x16x32_bf16 v[12:15], v[32:35], v[24:27], v[12:15]
  v_add_f32_dpp v8, v10, v8 quad_perm:[2,3,0,1] row_mask:0xf bank_mask:0xf
  v_add_f32_dpp v9, v11, v9 quad_perm:[2,3,0,1] row_mask:0xf bank_mask:0xf
  s_nop 0
  v_mov_b32_dpp v8, v8 quad_perm:[0,1,0,1] row_mask:0xf bank_mask:0xf
  v_mov_b32_dpp v9, v9 quad_perm:[0,1,0,1] row_mask:0xf bank_mask:0xf
  s_nop 1
  v_add_f32_dpp v12, v14, v12 quad_perm:[2,3,0,1] row_mask:0xf bank_mask:0xf
  v_add_f32_dpp v13, v15, v13 quad_perm:[2,3,0,1] row_mask:0xf bank_mask:0xf
  s_nop 0
  v_mov_b32_dpp v12, v12 quad_perm:[0,1,0,1] row_mask:0xf bank_mask:0xf
  v_mov_b32_dpp v13, v13 quad_perm:[0,1,0,1] row_mask:0xf bank_mask:0xf
  v_mul_f32 v12, s69, v12
  ds_write_b32 v78, v8 offset:8716
  v_mul_f32 v13, s69, v13
  ds_write_b32 v78, v9 offset:8780
  s_waitcnt lgkmcnt(0)
  s_barrier
  ds_read_b128 v[36:39], v78 offset:8704
  ds_read_b128 v[40:43], v78 offset:8768
  s_waitcnt lgkmcnt(0)
  s_barrier
  v_max_f32 v16, v36, v37
  v_max3_f32 v16, v16, v38, v39
  v_max3_f32 v16, v16, v40, v41
  v_max3_f32 v16, v16, v42, v43
  v_max3_f32 v16, v16, v12, v13
  v_mov_b32 v17, v16
  s_nop 1
  v_permlane16_swap_b32 v16, v17
  v_max_f32 v16, v16, v17
  v_mov_b32 v17, v16
  s_nop 1
  v_permlane32_swap_b32 v16, v17
  v_max_f32 v16, v16, v17
  v_sub_f32 v36, v36, v16
  v_sub_f32 v37, v37, v16
  v_sub_f32 v38, v38, v16
  v_sub_f32 v39, v39, v16
  v_sub_f32 v40, v40, v16
  v_sub_f32 v41, v41, v16
  v_sub_f32 v42, v42, v16
  v_sub_f32 v43, v43, v16
  v_sub_f32 v12, v12, v16
  v_sub_f32 v13, v13, v16
  v_exp_f32 v36, v36
  v_exp_f32 v37, v37
  v_exp_f32 v38, v38
  v_exp_f32 v39, v39
  v_exp_f32 v40, v40
  v_exp_f32 v41, v41
  v_exp_f32 v42, v42
  v_exp_f32 v43, v43
  v_exp_f32 v12, v12
  v_exp_f32 v13, v13
  v_cvt_pk_bf16_f32 v32, v36, v40
  v_cvt_pk_bf16_f32 v33, v37, v41
  v_cvt_pk_bf16_f32 v34, v38, v42
  v_cvt_pk_bf16_f32 v35, v39, v43
  v_cvt_pk_bf16_f32 v28, v12, v13
  v_cvt_pk_bf16_f32 v31, v12, v13
  v_mov_b32 v29, 0
  v_mov_b32 v30, 0
  v_mov_b32 v68, 0x3f803f80
  v_mov_b32 v69, 0x3f803f80
  v_mov_b32 v70, 0x3f803f80
  v_mov_b32 v71, 0x3f803f80
  s_nop 1
  v_mfma_f32_16x16x32_bf16 v[8:11], v[32:35], v[68:71], 0
  v_mfma_f32_16x16x32_bf16 v[0:3], v[32:35], v[52:55], 0
  v_mfma_f32_16x16x32_bf16 v[4:7], v[32:35], v[56:59], 0
  v_mfma_f32_16x16x16_bf16 v[8:11], v[28:29], v[68:69], v[8:11]
  v_mfma_f32_16x16x16_bf16 v[0:3], v[28:29], v[72:73], v[0:3]
  v_mfma_f32_16x16x16_bf16 v[4:7], v[30:31], v[72:73], v[4:7]
  ds_read_b128 v[68:71], v76 offset:13824
  v_rcp_f32 v10, v8
  v_rcp_f32 v11, v9
  v_mul_f32 v0, v10, v0
  v_mul_f32 v1, v11, v1
  s_nop 0
  v_mul_f32 v4, v10, v4
  v_mul_f32 v5, v11, v5
  v_cvt_pk_bf16_f32 v2, v0, v4
  ds_write_b32 v79, v2 offset:8704
  v_cvt_pk_bf16_f32 v3, v1, v5
  ds_write_b32 v79, v3 offset:9280
  v_mov_b64 v[16:17], 0
  v_mov_b64 v[18:19], 0
  v_mov_b64 v[20:21], 0
  v_mov_b64 v[22:23], 0
  v_mov_b64 v[24:25], 0
  v_mov_b64 v[26:27], 0
  s_branch Cs3_mxok
Cs3_last:
  ds_read_b128 v[0:3], v76 offset:4608
  ds_read_b128 v[12:15], v76 offset:7680
  ds_read_b128 v[44:47], v76 offset:28672
  ds_read_b128 v[48:51], v76 offset:29696
  s_nop 5
  v_mov_b64 v[20:21], 0
  v_mov_b64 v[22:23], 0
  v_mov_b64 v[24:25], 0
  v_mov_b64 v[26:27], 0
  v_smfmac_f32_16x16x64_bf16 v[28:31], v[4:7], v[36:43], v74
  ds_read_b128 v[36:39], v76 offset:30720
  ds_read_b128 v[40:43], v76 offset:31744
  v_smfmac_f32_16x16x64_bf16 v[32:35], v[4:7], v[60:67], v74
  s_waitcnt lgkmcnt(5)
  v_smfmac_f32_16x16x64_bf16 v[20:23], v[0:3], a[32:39], v74
  ds_read_b128 v[60:63], v76 offset:61440
  ds_read_b128 v[64:67], v76 offset:62464
  v_smfmac_f32_16x16x64_bf16 v[24:27], v[0:3], a[40:47], v74
  s_waitcnt lgkmcnt(4)
  v_smfmac_f32_16x16x64_bf16 v[20:23], v[4:7], a[48:55], v74
  buffer_store_dwordx4 v[16:19], v76, s[8:11], s68 offen sc1
  v_smfmac_f32_16x16x64_bf16 v[24:27], v[4:7], a[56:63], v74
  v_smfmac_f32_16x16x64_bf16 v[28:31], v[0:3], v[44:51], v74
  s_waitcnt lgkmcnt(2)
  v_smfmac_f32_16x16x64_bf16 v[20:23], v[8:11], a[64:71], v74
  ds_read_b128 v[44:47], v76 offset:63488
  ds_read_b128 v[48:51], v76 offset:64512
  v_smfmac_f32_16x16x64_bf16 v[24:27], v[8:11], a[72:79], v74
  v_smfmac_f32_16x16x64_bf16 v[32:35], v[0:3], v[36:43], v74
  v_smfmac_f32_16x16x64_bf16 v[28:31], v[8:11], v[208:215], v74
  ds_read_b128 v[36:39], v75 offset:28672
  ds_read_b128 v[40:43], v75 offset:29696
  v_smfmac_f32_16x16x64_bf16 v[32:35], v[8:11], v[216:223], v74
  v_smfmac_f32_16x16x64_bf16 v[20:23], v[12:15], a[80:87], v74
  v_smfmac_f32_16x16x64_bf16 v[24:27], v[12:15], a[88:95], v74
  v_smfmac_f32_16x16x64_bf16 v[28:31], v[12:15], v[224:231], v74
  v_smfmac_f32_16x16x64_bf16 v[32:35], v[12:15], v[232:239], v74
  s_waitcnt vmcnt(1)
  s_barrier
Cs3_lastr:
  ds_read_b128 v[4:7], v76 offset:8704
  ds_read_b128 v[8:11], v76 offset:9728
  ds_read_b128 v[16:19], v76 offset:10752
  ds_read_b128 v[0:3], v76 offset:11776
  ds_read_b128 v[12:15], v76 offset:12800
  s_waitcnt lgkmcnt(1)
  v_max3_u32 v72, v0, v1, v2
  v_max3_u32 v72, v72, v3, v4
  v_max3_u32 v72, v72, v5, v6
  v_max3_u32 v72, v72, v7, v8
  v_max3_u32 v72, v72, v9, v10
  s_waitcnt lgkmcnt(0)
  v_max3_u32 v72, v72, v11, v12
  v_max3_u32 v72, v72, v13, v14
  v_max3_u32 v72, v72, v15, v16
  v_max3_u32 v72, v72, v17, v18
  v_max_u32 v72, v72, v19
  v_cmp_eq_u32 vcc, -1, v72
  s_cbranch_vccnz Cs3_lastp
Cs3_lastg:
  v_smfmac_f32_16x16x64_bf16 v[28:31], v[4:7], v[60:67], v74
  ds_read_b128 v[60:63], v75 offset:30720
  ds_read_b128 v[64:67], v75 offset:31744
  v_smfmac_f32_16x16x64_bf16 v[32:35], v[4:7], v[44:51], v74
  v_smfmac_f32_16x16x64_bf16 v[28:31], v[8:11], v[36:43], v74
  v_smfmac_f32_16x16x64_bf16 v[28:31], v[16:19], v[240:247], v74
  v_smfmac_f32_16x16x64_bf16 v[28:31], v[0:3], a[0:7], v74
  v_smfmac_f32_16x16x64_bf16 v[28:31], v[12:15], a[16:23], v74
  v_smfmac_f32_16x16x64_bf16 v[32:35], v[16:19], v[248:255], v74
  v_smfmac_f32_16x16x64_bf16 v[32:35], v[0:3], a[8:15], v74
  s_waitcnt lgkmcnt(0)
  v_smfmac_f32_16x16x64_bf16 v[32:35], v[12:15], a[24:31], v74
  v_smfmac_f32_16x16x64_bf16 v[32:35], v[8:11], v[60:67], v74
  v_smfmac_f32_16x16x64_bf16 v[20:23], v[4:7], a[96:103], v74
  v_smfmac_f32_16x16x64_bf16 v[20:23], v[8:11], a[112:119], v74
  v_add_f32 v28, v28, v30
  v_add_f32 v32, v32, v34
  v_cvt_pk_bf16_f32 v30, v28, v32
  v_smfmac_f32_16x16x64_bf16 v[20:23], v[16:19], a[128:135], v74
  ds_write_b32 v79, v30 offset:256
  v_add_f32 v29, v29, v31
  v_add_f32 v33, v33, v35
  v_cvt_pk_bf16_f32 v31, v29, v33
  v_smfmac_f32_16x16x64_bf16 v[20:23], v[0:3], a[144:151], v74
  ds_write_b32 v79, v31 offset:832
  v_smfmac_f32_16x16x64_bf16 v[20:23], v[12:15], a[160:167], v74
  v_smfmac_f32_16x16x64_bf16 v[24:27], v[4:7], a[104:111], v74
  v_smfmac_f32_16x16x64_bf16 v[24:27], v[8:11], a[120:127], v74
  v_smfmac_f32_16x16x64_bf16 v[24:27], v[16:19], a[136:143], v74
  s_waitcnt lgkmcnt(0)
  s_barrier
  ds_read_b64 v[52:53], v77 offset:392
  v_add_f32 v20, v20, v22
  v_smfmac_f32_16x16x64_bf16 v[24:27], v[0:3], a[152:159], v74
  v_add_f32 v21, v21, v23
  v_smfmac_f32_16x16x64_bf16 v[24:27], v[12:15], a[168:175], v74
  v_cvt_pk_bf16_f32 v54, v20, v21
  s_add_u32 s68, s68, 655360
  s_nop 3
  v_add_f32 v24, v24, v26
  v_add_f32 v25, v25, v27
  v_cvt_pk_bf16_f32 v55, v24, v25
  s_waitcnt lgkmcnt(0)
  buffer_store_dwordx4 v[52:55], v76, s[8:11], s68 offen sc1
  s_branch Cs3_done
Cs3_lastp:
  s_add_u32 s72, s72, 2
  s_cmp_ge_u32 s72, 131072
  s_cbranch_scc1 Cs3_lastg
  s_barrier
  buffer_load_dwordx4 v76, s[8:11], s85 offen offset:0 sc1 lds
  buffer_load_dwordx4 v76, s[8:11], s85 offen offset:1024 sc1 lds
  s_waitcnt vmcnt(0)
  s_barrier
  s_branch Cs3_lastr
Cs3_done:
  s_branch L_cexit
L_conf:
  s_nop 11
  s_waitcnt vmcnt(0) lgkmcnt(0)
  s_barrier
  s_cmp_eq_u32 s52, 0
  s_cbranch_scc0 L_cf2
  s_mov_b64 exec, 1
  s_lshl_b32 s57, s2, 2
  v_mov_b32 v1, 0
L_cf0:
  s_cmp_eq_u32 s54, -1
  s_cbranch_scc1 L_cf1
  s_mov_b32 s55, s54
  s_lshr_b64 s[54:55], s[54:55], s0
  s_ff0_i32_b32 s56, s54
  s_add_u32 s0, s0, s56
  s_and_b32 s0, s0, 31
  s_lshl_b32 s56, 1, s0
  v_mov_b32 v35, s56
  buffer_atomic_or v35, v1, s[12:15], s57 offen sc0
  s_waitcnt vmcnt(0)
  v_readfirstlane_b32 s54, v35
  s_nop 0
  s_bitcmp1_b32 s54, s0
  s_cbranch_scc1 L_cf0
  v_mov_b32 v35, s0
  s_branch L_cf3
L_cf1:
  v_mov_b32 v35, 1
  buffer_atomic_add v35, v1, s[12:15], 0 offen offset:40 sc0
  s_waitcnt vmcnt(0)
  v_add_u32 v35, 32, v35
L_cf3:
  ds_write_b32 v33, v35
  s_mov_b64 exec, -1
  s_waitcnt lgkmcnt(0)
L_cf2:
  s_barrier
  ds_read_b32 v32, v33
  s_waitcnt lgkmcnt(0)
  v_readfirstlane_b32 s0, v32
  v_mbcnt_lo_u32_b32 v0, -1, 0
  v_mbcnt_hi_u32_b32 v0, -1, v0
  s_mov_b32 s1, 1
  s_cmp_lt_u32 s0, 32
  s_cbranch_scc1 L_role
  s_sub_u32 s53, s0, 32
  s_mov_b32 s57, 0
L_sur:
  s_load_dwordx16 s[60:75], s[12:13], 0 glc
  s_add_u32 s57, s57, 1
  s_waitcnt lgkmcnt(0)
  s_mov_b32 s55, s70
  s_bcnt1_i32_b32 s56, s60
  s_add_u32 s55, s55, s56
  s_bcnt1_i32_b32 s56, s61
  s_add_u32 s55, s55, s56
  s_bcnt1_i32_b32 s56, s62
  s_add_u32 s55, s55, s56
  s_bcnt1_i32_b32 s56, s63
  s_add_u32 s55, s55, s56
  s_bcnt1_i32_b32 s56, s64
  s_add_u32 s55, s55, s56
  s_bcnt1_i32_b32 s56, s65
  s_add_u32 s55, s55, s56
  s_bcnt1_i32_b32 s56, s66
  s_add_u32 s55, s55, s56
  s_bcnt1_i32_b32 s56, s67
  s_add_u32 s55, s55, s56
  s_cmp_ge_u32 s57, 131072
  s_cbranch_scc1 L_end
  s_cmp_lt_u32 s55, 256
  s_cbranch_scc1 L_sur
  s_mov_b32 s2, 0
  s_mov_b32 s54, s60
  s_bcnt0_i32_b32 s56, s54
  s_cmp_lt_u32 s53, s56
  s_cbranch_scc1 L_sur2
  s_sub_u32 s53, s53, s56
  s_mov_b32 s2, 1
  s_mov_b32 s54, s61
  s_bcnt0_i32_b32 s56, s54
  s_cmp_lt_u32 s53, s56
  s_cbranch_scc1 L_sur2
  s_sub_u32 s53, s53, s56
  s_mov_b32 s2, 2
  s_mov_b32 s54, s62
  s_bcnt0_i32_b32 s56, s54
  s_cmp_lt_u32 s53, s56
  s_cbranch_scc1 L_sur2
  s_sub_u32 s53, s53, s56
  s_mov_b32 s2, 3
  s_mov_b32 s54, s63
  s_bcnt0_i32_b32 s56, s54
  s_cmp_lt_u32 s53, s56
  s_cbranch_scc1 L_sur2
  s_sub_u32 s53, s53, s56
  s_mov_b32 s2, 4
  s_mov_b32 s54, s64
  s_bcnt0_i32_b32 s56, s54
  s_cmp_lt_u32 s53, s56
  s_cbranch_scc1 L_sur2
  s_sub_u32 s53, s53, s56
  s_mov_b32 s2, 5
  s_mov_b32 s54, s65
  s_bcnt0_i32_b32 s56, s54
  s_cmp_lt_u32 s53, s56
  s_cbranch_scc1 L_sur2
  s_sub_u32 s53, s53, s56
  s_mov_b32 s2, 6
  s_mov_b32 s54, s66
  s_bcnt0_i32_b32 s56, s54
  s_cmp_lt_u32 s53, s56
  s_cbranch_scc1 L_sur2
  s_sub_u32 s53, s53, s56
  s_mov_b32 s2, 7
  s_mov_b32 s54, s67
  s_bcnt0_i32_b32 s56, s54
  s_cmp_lt_u32 s53, s56
  s_cbranch_scc1 L_sur2
  s_sub_u32 s53, s53, s56
  s_branch L_end
L_sur2:
  s_ff0_i32_b32 s0, s54
  s_bitset1_b32 s54, s0
  s_sub_u32 s53, s53, 1
  s_cbranch_scc0 L_sur2
  s_branch L_role
L_worker:
  s_lshl_b32 s54, s2, 2
  s_lshr_b32 s54, 1412567136, s54
  s_and_b32 s54, s54, 7
  s_lshl_b32 s54, s54, 5
  s_add_u32 s53, s53, s54
  s_getpc_b64 s[80:81]
L_pc_2:
  s_and_b32 s55, s0, 1
  s_lshl_b32 s55, s55, 2
  s_add_u32 s55, s55, s52
  s_lshl_b32 s55, s55, 13
  v_and_b32 v199, 63, v0
  v_lshl_add_u32 v199, v199, 7, s55
  s_sub_u32 s82, s80, (L_pc_2 - L_w0)
  s_subb_u32 s83, s81, 0
  v_min_u32 v198, (L_w4 - L_w0), v199
  global_load_dword v196, v198, s[82:83]
  v_min_u32 v199, (L_end - L_pc_2), v199
  global_load_dword v196, v199, s[80:81]
  v_and_b32 v200, 63, v0
  v_lshlrev_b32 v201, 4, v200
  v_lshrrev_b32 v211, 3, v200
  s_lshl_b32 s54, s52, 3
  v_add_u32 v211, s54, v211
  v_bfe_u32 v212, v211, 1, 3
  v_and_b32 v213, 7, v200
  v_xor_b32 v212, v212, v213
  v_mul_u32_u24 v211, 1152, v211
  v_lshl_add_u32 v202, v212, 4, v211
  s_mul_i32 s67, s52, 9216
  v_and_b32 v211, 31, v200
  v_lshrrev_b32 v212, 3, v211
  v_mul_u32_u24 v212, 9216, v212
  v_and_b32 v213, 7, v211
  v_lshl_add_u32 v212, v213, 7, v212
  v_bfe_u32 v213, v211, 1, 3
  v_lshrrev_b32 v214, 5, v200
  v_xor_b32 v213, v213, v214
  v_lshl_add_u32 v203, v213, 4, v212
  v_xor_b32 v204, 32, v203
  v_xor_b32 v205, 64, v203
  v_xor_b32 v206, 0x60, v203
  v_bfe_u32 v211, v200, 2, 2
  v_lshl_add_u32 v212, v214, 3, v211
  v_lshlrev_b32 v212, 8, v212
  v_xor_b32 v211, s52, v211
  v_lshl_add_u32 v212, v211, 6, v212
  v_bfe_u32 v213, v200, 4, 1
  v_and_b32 v211, 3, v200
  v_lshl_add_u32 v210, v213, 5, v212
  v_lshl_add_u32 v210, v211, 3, v210
  v_lshl_add_u32 v209, v213, 4, v212
  v_and_b32 v213, 1, v211
  v_lshl_add_u32 v209, v213, 3, v209
  v_lshrrev_b32 v213, 1, v211
  v_lshl_add_u32 v209, v213, 5, v209
  s_mov_b32 s65, 0
  s_mul_i32 s58, s53, 9363
  s_lshr_b32 s58, s58, 16
  s_mul_i32 s54, s58, 7
  s_sub_u32 s59, s53, s54
  s_mul_i32 s60, s59, 36864
  s_add_u32 m0, s67, 0
  s_nop 0
  buffer_load_dwordx4 v202, s[4:7], s60 offen offset:0 lds
  s_add_u32 m0, s67, 896
  s_nop 0
  buffer_load_dwordx4 v202, s[4:7], s60 offen offset:128 lds
  s_add_u32 m0, s67, 1792
  s_nop 0
  buffer_load_dwordx4 v202, s[4:7], s60 offen offset:256 lds
  s_add_u32 m0, s67, 2688
  s_nop 0
  buffer_load_dwordx4 v202, s[4:7], s60 offen offset:384 lds
  s_add_u32 m0, s67, 3584
  s_nop 0
  buffer_load_dwordx4 v202, s[4:7], s60 offen offset:512 lds
  s_add_u32 m0, s67, 4480
  s_nop 0
  buffer_load_dwordx4 v202, s[4:7], s60 offen offset:640 lds
  s_add_u32 m0, s67, 5376
  s_nop 0
  buffer_load_dwordx4 v202, s[4:7], s60 offen offset:768 lds
  s_add_u32 m0, s67, 6272
  s_nop 0
  buffer_load_dwordx4 v202, s[4:7], s60 offen offset:896 lds
  s_add_u32 m0, s67, 7168
  s_nop 0
  buffer_load_dwordx4 v202, s[4:7], s60 offen offset:1024 lds
  v_lshrrev_b32 v211, 4, v200
  v_lshlrev_b32 v212, 2, v211
  v_and_b32 v213, 15, v200
  v_xor_b32 v212, v212, v213
  v_lshlrev_b32 v212, 4, v212
  v_lshl_add_u32 v207, v211, 13, v212
  s_lshl_b32 s62, s58, 8
  s_lshl_b32 s54, s52, 15
  s_add_u32 s62, s62, s54
  s_lshl_b32 s61, s52, 10
  s_add_u32 s61, s61, 36864
  s_add_u32 m0, s61, 0
  s_add_u32 s54, s62, 0
  buffer_load_dwordx4 v207, s[20:23], s54 offen lds
  s_add_u32 m0, s61, 4096
  s_add_u32 s54, s62, 131072
  buffer_load_dwordx4 v207, s[20:23], s54 offen lds
  s_add_u32 m0, s61, 8192
  s_add_u32 s54, s62, 262144
  buffer_load_dwordx4 v207, s[20:23], s54 offen lds
  s_add_u32 m0, s61, 12288
  s_add_u32 s54, s62, 393216
  buffer_load_dwordx4 v207, s[20:23], s54 offen lds
  s_add_u32 m0, s61, 16384
  s_add_u32 s54, s62, 0
  buffer_load_dwordx4 v207, s[24:27], s54 offen lds
  s_add_u32 m0, s61, 20480
  s_add_u32 s54, s62, 131072
  buffer_load_dwordx4 v207, s[24:27], s54 offen lds
  s_add_u32 m0, s61, 24576
  s_add_u32 s54, s62, 262144
  buffer_load_dwordx4 v207, s[24:27], s54 offen lds
  s_add_u32 m0, s61, 28672
  s_add_u32 s54, s62, 393216
  buffer_load_dwordx4 v207, s[24:27], s54 offen lds
  s_add_u32 m0, s61, 32768
  s_add_u32 s54, s62, 524288
  buffer_load_dwordx4 v207, s[20:23], s54 offen lds
  s_add_u32 m0, s61, 36864
  s_add_u32 s54, s62, 655360
  buffer_load_dwordx4 v207, s[20:23], s54 offen lds
  s_add_u32 m0, s61, 40960
  s_add_u32 s54, s62, 786432
  buffer_load_dwordx4 v207, s[20:23], s54 offen lds
  s_add_u32 m0, s61, 45056
  s_add_u32 s54, s62, 917504
  buffer_load_dwordx4 v207, s[20:23], s54 offen lds
  s_add_u32 m0, s61, 49152
  s_add_u32 s54, s62, 524288
  buffer_load_dwordx4 v207, s[24:27], s54 offen lds
  s_add_u32 m0, s61, 53248
  s_add_u32 s54, s62, 655360
  buffer_load_dwordx4 v207, s[24:27], s54 offen lds
  s_add_u32 m0, s61, 57344
  s_add_u32 s54, s62, 786432
  buffer_load_dwordx4 v207, s[24:27], s54 offen lds
  s_add_u32 m0, s61, 61440
  s_add_u32 s54, s62, 917504
  buffer_load_dwordx4 v207, s[24:27], s54 offen lds
  s_add_u32 m0, s61, 65536
  s_add_u32 s54, s62, 1048576
  buffer_load_dwordx4 v207, s[20:23], s54 offen lds
  s_add_u32 m0, s61, 69632
  s_add_u32 s54, s62, 1179648
  buffer_load_dwordx4 v207, s[20:23], s54 offen lds
  s_add_u32 m0, s61, 73728
  s_add_u32 s54, s62, 1310720
  buffer_load_dwordx4 v207, s[20:23], s54 offen lds
  s_add_u32 m0, s61, 77824
  s_add_u32 s54, s62, 1441792
  buffer_load_dwordx4 v207, s[20:23], s54 offen lds
  s_add_u32 m0, s61, 81920
  s_add_u32 s54, s62, 1048576
  buffer_load_dwordx4 v207, s[24:27], s54 offen lds
  s_add_u32 m0, s61, 86016
  s_add_u32 s54, s62, 1179648
  buffer_load_dwordx4 v207, s[24:27], s54 offen lds
  s_add_u32 m0, s61, 90112
  s_add_u32 s54, s62, 1310720
  buffer_load_dwordx4 v207, s[24:27], s54 offen lds
  s_add_u32 m0, s61, 94208
  s_add_u32 s54, s62, 1441792
  buffer_load_dwordx4 v207, s[24:27], s54 offen lds
  v_bfe_u32 v211, v200, 3, 2
  v_lshlrev_b32 v216, 11, v211
  v_bfe_u32 v211, v200, 1, 2
  v_lshl_add_u32 v216, v211, 6, v216
  v_lshrrev_b32 v212, 5, v200
  v_lshl_add_u32 v216, v212, 5, v216
  v_and_b32 v211, 1, v200
  v_lshl_add_u32 v216, v211, 4, v216
  v_bfe_u32 v211, v200, 4, 1
  v_lshlrev_b32 v217, 10, v211
  v_lshl_add_u32 v217, v212, 9, v217
  v_and_b32 v211, 15, v200
  v_lshl_add_u32 v217, v211, 4, v217
  s_lshl_b32 s54, s52, 11
  s_add_u32 s54, s54, 8192
  v_add_u32 v217, s54, v217
  s_waitcnt vmcnt(20) lgkmcnt(0)
  s_barrier
  s_add_u32 m0, s61, 98304
  s_add_u32 s54, s62, 1572864
  buffer_load_dwordx4 v207, s[20:23], s54 offen lds
  s_add_u32 m0, s61, 102400
  s_add_u32 s54, s62, 1703936
  buffer_load_dwordx4 v207, s[20:23], s54 offen lds
  s_add_u32 m0, s61, 106496
  s_add_u32 s54, s62, 1835008
  buffer_load_dwordx4 v207, s[20:23], s54 offen lds
  s_add_u32 m0, s61, 110592
  s_add_u32 s54, s62, 1966080
  buffer_load_dwordx4 v207, s[20:23], s54 offen lds
  v_add_u32 v215, 36864, v209
  ds_read_b64_tr_b16 a[0:1], v215 offset:0
  ds_read_b64_tr_b16 a[2:3], v215 offset:1024
  ds_read_b64_tr_b16 a[4:5], v215 offset:4096
  ds_read_b64_tr_b16 a[6:7], v215 offset:5120
  ds_read_b64_tr_b16 a[8:9], v215 offset:8192
  ds_read_b64_tr_b16 a[10:11], v215 offset:9216
  ds_read_b64_tr_b16 a[12:13], v215 offset:12288
  ds_read_b64_tr_b16 a[14:15], v215 offset:13312
  s_waitcnt vmcnt(20) lgkmcnt(0)
  s_barrier
  s_add_u32 m0, s61, 0
  s_add_u32 s54, s62, 1572864
  buffer_load_dwordx4 v207, s[24:27], s54 offen lds
  s_add_u32 m0, s61, 4096
  s_add_u32 s54, s62, 1703936
  buffer_load_dwordx4 v207, s[24:27], s54 offen lds
  s_add_u32 m0, s61, 8192
  s_add_u32 s54, s62, 1835008
  buffer_load_dwordx4 v207, s[24:27], s54 offen lds
  s_add_u32 m0, s61, 12288
  s_add_u32 s54, s62, 1966080
  buffer_load_dwordx4 v207, s[24:27], s54 offen lds
  v_add_u32 v215, 53248, v210
  ds_read_b64_tr_b16 a[144:145], v215 offset:0
  ds_read_b64_tr_b16 a[146:147], v215 offset:1024
  ds_read_b64_tr_b16 a[148:149], v215 offset:4096
  ds_read_b64_tr_b16 a[150:151], v215 offset:5120
  ds_read_b64_tr_b16 a[152:153], v215 offset:8192
  ds_read_b64_tr_b16 a[154:155], v215 offset:9216
  ds_read_b64_tr_b16 a[156:157], v215 offset:12288
  ds_read_b64_tr_b16 a[158:159], v215 offset:13312
  s_waitcnt vmcnt(20) lgkmcnt(0)
  s_barrier
  s_add_u32 m0, s61, 16384
  s_add_u32 s54, s62, 2097152
  buffer_load_dwordx4 v207, s[20:23], s54 offen lds
  s_add_u32 m0, s61, 20480
  s_add_u32 s54, s62, 2228224
  buffer_load_dwordx4 v207, s[20:23], s54 offen lds
  s_add_u32 m0, s61, 24576
  s_add_u32 s54, s62, 2359296
  buffer_load_dwordx4 v207, s[20:23], s54 offen lds
  s_add_u32 m0, s61, 28672
  s_add_u32 s54, s62, 2490368
  buffer_load_dwordx4 v207, s[20:23], s54 offen lds
  v_add_u32 v215, 69632, v209
  ds_read_b64_tr_b16 a[16:17], v215 offset:0
  ds_read_b64_tr_b16 a[18:19], v215 offset:1024
  ds_read_b64_tr_b16 a[20:21], v215 offset:4096
  ds_read_b64_tr_b16 a[22:23], v215 offset:5120
  ds_read_b64_tr_b16 a[24:25], v215 offset:8192
  ds_read_b64_tr_b16 a[26:27], v215 offset:9216
  ds_read_b64_tr_b16 a[28:29], v215 offset:12288
  ds_read_b64_tr_b16 a[30:31], v215 offset:13312
  s_waitcnt vmcnt(20) lgkmcnt(0)
  s_barrier
  s_add_u32 m0, s61, 32768
  s_add_u32 s54, s62, 2097152
  buffer_load_dwordx4 v207, s[24:27], s54 offen lds
  s_add_u32 m0, s61, 36864
  s_add_u32 s54, s62, 2228224
  buffer_load_dwordx4 v207, s[24:27], s54 offen lds
  s_add_u32 m0, s61, 40960
  s_add_u32 s54, s62, 2359296
  buffer_load_dwordx4 v207, s[24:27], s54 offen lds
  s_add_u32 m0, s61, 45056
  s_add_u32 s54, s62, 2490368
  buffer_load_dwordx4 v207, s[24:27], s54 offen lds
  v_add_u32 v215, 86016, v210
  ds_read_b64_tr_b16 a[160:161], v215 offset:0
  ds_read_b64_tr_b16 a[162:163], v215 offset:1024
  ds_read_b64_tr_b16 a[164:165], v215 offset:4096
  ds_read_b64_tr_b16 a[166:167], v215 offset:5120
  ds_read_b64_tr_b16 a[168:169], v215 offset:8192
  ds_read_b64_tr_b16 a[170:171], v215 offset:9216
  ds_read_b64_tr_b16 a[172:173], v215 offset:12288
  ds_read_b64_tr_b16 a[174:175], v215 offset:13312
  s_waitcnt vmcnt(20) lgkmcnt(0)
  s_barrier
  s_add_u32 m0, s61, 49152
  s_add_u32 s54, s62, 2621440
  buffer_load_dwordx4 v207, s[20:23], s54 offen lds
  s_add_u32 m0, s61, 53248
  s_add_u32 s54, s62, 2752512
  buffer_load_dwordx4 v207, s[20:23], s54 offen lds
  s_add_u32 m0, s61, 57344
  s_add_u32 s54, s62, 2883584
  buffer_load_dwordx4 v207, s[20:23], s54 offen lds
  s_add_u32 m0, s61, 61440
  s_add_u32 s54, s62, 3014656
  buffer_load_dwordx4 v207, s[20:23], s54 offen lds
  v_add_u32 v215, 102400, v209
  ds_read_b64_tr_b16 a[32:33], v215 offset:0
  ds_read_b64_tr_b16 a[34:35], v215 offset:1024
  ds_read_b64_tr_b16 a[36:37], v215 offset:4096
  ds_read_b64_tr_b16 a[38:39], v215 offset:5120
  ds_read_b64_tr_b16 a[40:41], v215 offset:8192
  ds_read_b64_tr_b16 a[42:43], v215 offset:9216
  ds_read_b64_tr_b16 a[44:45], v215 offset:12288
  ds_read_b64_tr_b16 a[46:47], v215 offset:13312
  s_waitcnt vmcnt(20) lgkmcnt(0)
  s_barrier
  s_add_u32 m0, s61, 65536
  s_add_u32 s54, s62, 2621440
  buffer_load_dwordx4 v207, s[24:27], s54 offen lds
  s_add_u32 m0, s61, 69632
  s_add_u32 s54, s62, 2752512
  buffer_load_dwordx4 v207, s[24:27], s54 offen lds
  s_add_u32 m0, s61, 73728
  s_add_u32 s54, s62, 2883584
  buffer_load_dwordx4 v207, s[24:27], s54 offen lds
  s_add_u32 m0, s61, 77824
  s_add_u32 s54, s62, 3014656
  buffer_load_dwordx4 v207, s[24:27], s54 offen lds
  v_add_u32 v215, 118784, v210
  ds_read_b64_tr_b16 a[176:177], v215 offset:0
  ds_read_b64_tr_b16 a[178:179], v215 offset:1024
  ds_read_b64_tr_b16 a[180:181], v215 offset:4096
  ds_read_b64_tr_b16 a[182:183], v215 offset:5120
  ds_read_b64_tr_b16 a[184:185], v215 offset:8192
  ds_read_b64_tr_b16 a[186:187], v215 offset:9216
  ds_read_b64_tr_b16 a[188:189], v215 offset:12288
  ds_read_b64_tr_b16 a[190:191], v215 offset:13312
  s_waitcnt vmcnt(20) lgkmcnt(0)
  s_barrier
  s_add_u32 m0, s61, 81920
  s_add_u32 s54, s62, 3145728
  buffer_load_dwordx4 v207, s[20:23], s54 offen lds
  s_add_u32 m0, s61, 86016
  s_add_u32 s54, s62, 3276800
  buffer_load_dwordx4 v207, s[20:23], s54 offen lds
  s_add_u32 m0, s61, 90112
  s_add_u32 s54, s62, 3407872
  buffer_load_dwordx4 v207, s[20:23], s54 offen lds
  s_add_u32 m0, s61, 94208
  s_add_u32 s54, s62, 3538944
  buffer_load_dwordx4 v207, s[20:23], s54 offen lds
  v_add_u32 v215, 135168, v209
  ds_read_b64_tr_b16 a[48:49], v215 offset:0
  ds_read_b64_tr_b16 a[50:51], v215 offset:1024
  ds_read_b64_tr_b16 a[52:53], v215 offset:4096
  ds_read_b64_tr_b16 a[54:55], v215 offset:5120
  ds_read_b64_tr_b16 a[56:57], v215 offset:8192
  ds_read_b64_tr_b16 a[58:59], v215 offset:9216
  ds_read_b64_tr_b16 a[60:61], v215 offset:12288
  ds_read_b64_tr_b16 a[62:63], v215 offset:13312
  s_waitcnt vmcnt(20) lgkmcnt(0)
  s_barrier
  s_add_u32 m0, s61, 98304
  s_add_u32 s54, s62, 3145728
  buffer_load_dwordx4 v207, s[24:27], s54 offen lds
  s_add_u32 m0, s61, 102400
  s_add_u32 s54, s62, 3276800
  buffer_load_dwordx4 v207, s[24:27], s54 offen lds
  s_add_u32 m0, s61, 106496
  s_add_u32 s54, s62, 3407872
  buffer_load_dwordx4 v207, s[24:27], s54 offen lds
  s_add_u32 m0, s61, 110592
  s_add_u32 s54, s62, 3538944
  buffer_load_dwordx4 v207, s[24:27], s54 offen lds
  v_add_u32 v215, 36864, v210
  ds_read_b64_tr_b16 a[192:193], v215 offset:0
  ds_read_b64_tr_b16 a[194:195], v215 offset:1024
  ds_read_b64_tr_b16 a[196:197], v215 offset:4096
  ds_read_b64_tr_b16 a[198:199], v215 offset:5120
  ds_read_b64_tr_b16 a[200:201], v215 offset:8192
  ds_read_b64_tr_b16 a[202:203], v215 offset:9216
  ds_read_b64_tr_b16 a[204:205], v215 offset:12288
  ds_read_b64_tr_b16 a[206:207], v215 offset:13312
  s_waitcnt vmcnt(20) lgkmcnt(0)
  s_barrier
  s_add_u32 m0, s61, 0
  s_add_u32 s54, s62, 3670016
  buffer_load_dwordx4 v207, s[20:23], s54 offen lds
  s_add_u32 m0, s61, 4096
  s_add_u32 s54, s62, 3801088
  buffer_load_dwordx4 v207, s[20:23], s54 offen lds
  s_add_u32 m0, s61, 8192
  s_add_u32 s54, s62, 3932160
  buffer_load_dwordx4 v207, s[20:23], s54 offen lds
  s_add_u32 m0, s61, 12288
  s_add_u32 s54, s62, 4063232
  buffer_load_dwordx4 v207, s[20:23], s54 offen lds
  v_add_u32 v215, 53248, v209
  ds_read_b64_tr_b16 a[64:65], v215 offset:0
  ds_read_b64_tr_b16 a[66:67], v215 offset:1024
  ds_read_b64_tr_b16 a[68:69], v215 offset:4096
  ds_read_b64_tr_b16 a[70:71], v215 offset:5120
  ds_read_b64_tr_b16 a[72:73], v215 offset:8192
  ds_read_b64_tr_b16 a[74:75], v215 offset:9216
  ds_read_b64_tr_b16 a[76:77], v215 offset:12288
  ds_read_b64_tr_b16 a[78:79], v215 offset:13312
  s_waitcnt vmcnt(20) lgkmcnt(0)
  s_barrier
  s_add_u32 m0, s61, 16384
  s_add_u32 s54, s62, 3670016
  buffer_load_dwordx4 v207, s[24:27], s54 offen lds
  s_add_u32 m0, s61, 20480
  s_add_u32 s54, s62, 3801088
  buffer_load_dwordx4 v207, s[24:27], s54 offen lds
  s_add_u32 m0, s61, 24576
  s_add_u32 s54, s62, 3932160
  buffer_load_dwordx4 v207, s[24:27], s54 offen lds
  s_add_u32 m0, s61, 28672
  s_add_u32 s54, s62, 4063232
  buffer_load_dwordx4 v207, s[24:27], s54 offen lds
  v_add_u32 v215, 69632, v210
  ds_read_b64_tr_b16 a[208:209], v215 offset:0
  ds_read_b64_tr_b16 a[210:211], v215 offset:1024
  ds_read_b64_tr_b16 a[212:213], v215 offset:4096
  ds_read_b64_tr_b16 a[214:215], v215 offset:5120
  ds_read_b64_tr_b16 a[216:217], v215 offset:8192
  ds_read_b64_tr_b16 a[218:219], v215 offset:9216
  ds_read_b64_tr_b16 a[220:221], v215 offset:12288
  ds_read_b64_tr_b16 a[222:223], v215 offset:13312
  s_waitcnt vmcnt(20) lgkmcnt(0)
  s_barrier
  s_add_u32 m0, s61, 32768
  s_add_u32 s54, s62, 4194304
  buffer_load_dwordx4 v207, s[20:23], s54 offen lds
  s_add_u32 m0, s61, 36864
  s_add_u32 s54, s62, 4325376
  buffer_load_dwordx4 v207, s[20:23], s54 offen lds
  s_add_u32 m0, s61, 40960
  s_add_u32 s54, s62, 4456448
  buffer_load_dwordx4 v207, s[20:23], s54 offen lds
  s_add_u32 m0, s61, 45056
  s_add_u32 s54, s62, 4587520
  buffer_load_dwordx4 v207, s[20:23], s54 offen lds
  v_add_u32 v215, 86016, v209
  ds_read_b64_tr_b16 a[80:81], v215 offset:0
  ds_read_b64_tr_b16 a[82:83], v215 offset:1024
  ds_read_b64_tr_b16 a[84:85], v215 offset:4096
  ds_read_b64_tr_b16 a[86:87], v215 offset:5120
  ds_read_b64_tr_b16 a[88:89], v215 offset:8192
  ds_read_b64_tr_b16 a[90:91], v215 offset:9216
  ds_read_b64_tr_b16 a[92:93], v215 offset:12288
  ds_read_b64_tr_b16 a[94:95], v215 offset:13312
  s_waitcnt vmcnt(20) lgkmcnt(0)
  s_barrier
  s_add_u32 m0, s61, 49152
  s_add_u32 s54, s62, 4194304
  buffer_load_dwordx4 v207, s[24:27], s54 offen lds
  s_add_u32 m0, s61, 53248
  s_add_u32 s54, s62, 4325376
  buffer_load_dwordx4 v207, s[24:27], s54 offen lds
  s_add_u32 m0, s61, 57344
  s_add_u32 s54, s62, 4456448
  buffer_load_dwordx4 v207, s[24:27], s54 offen lds
  s_add_u32 m0, s61, 61440
  s_add_u32 s54, s62, 4587520
  buffer_load_dwordx4 v207, s[24:27], s54 offen lds
  s_mul_i32 s54, s53, 21120
  s_lshl_b32 s55, s52, 13
  s_add_u32 s54, s54, s55
  s_cmp_eq_u32 s52, 3
  s_cselect_b32 s54, 0x10000000, s54
  v_lshlrev_b32 v211, 3, v201
  buffer_load_dword v196, v211, s[28:31], s54 offen
  v_add_u32 v215, 102400, v210
  ds_read_b64_tr_b16 a[224:225], v215 offset:0
  ds_read_b64_tr_b16 a[226:227], v215 offset:1024
  ds_read_b64_tr_b16 a[228:229], v215 offset:4096
  ds_read_b64_tr_b16 a[230:231], v215 offset:5120
  ds_read_b64_tr_b16 a[232:233], v215 offset:8192
  ds_read_b64_tr_b16 a[234:235], v215 offset:9216
  ds_read_b64_tr_b16 a[236:237], v215 offset:12288
  ds_read_b64_tr_b16 a[238:239], v215 offset:13312
  s_waitcnt vmcnt(21) lgkmcnt(0)
  s_barrier
  s_lshl_b32 s54, s53, 13
  s_lshr_b32 s55, s53, 6
  s_or_b32 s55, s55, s52
  s_cmp_eq_u32 s55, 0
  s_cselect_b32 s54, s54, 0x10000000
  v_lshlrev_b32 v211, 3, v201
  s_add_u32 s54, s54, 3145728
  buffer_load_dword v196, v211, s[16:19], s54 offen
  v_add_u32 v215, 118784, v209
  ds_read_b64_tr_b16 a[96:97], v215 offset:0
  ds_read_b64_tr_b16 a[98:99], v215 offset:1024
  ds_read_b64_tr_b16 a[100:101], v215 offset:4096
  ds_read_b64_tr_b16 a[102:103], v215 offset:5120
  ds_read_b64_tr_b16 a[104:105], v215 offset:8192
  ds_read_b64_tr_b16 a[106:107], v215 offset:9216
  ds_read_b64_tr_b16 a[108:109], v215 offset:12288
  ds_read_b64_tr_b16 a[110:111], v215 offset:13312
  s_waitcnt vmcnt(18) lgkmcnt(0)
  s_barrier
  s_lshl_b32 s55, s2, 2
  s_or_b32 s56, s52, s1
  s_cmp_eq_u32 s56, 0
  s_cselect_b32 s55, s55, 0x1000
  s_lshl_b32 s56, 1, s0
  v_mov_b32 v197, s56
  s_mov_b64 exec, 1
  buffer_atomic_or v197, off, s[12:15], s55 sc0
  s_mov_b64 exec, -1
  v_add_u32 v215, 135168, v210
  ds_read_b64_tr_b16 a[240:241], v215 offset:0
  ds_read_b64_tr_b16 a[242:243], v215 offset:1024
  ds_read_b64_tr_b16 a[244:245], v215 offset:4096
  ds_read_b64_tr_b16 a[246:247], v215 offset:5120
  ds_read_b64_tr_b16 a[248:249], v215 offset:8192
  ds_read_b64_tr_b16 a[250:251], v215 offset:9216
  ds_read_b64_tr_b16 a[252:253], v215 offset:12288
  ds_read_b64_tr_b16 a[254:255], v215 offset:13312
  s_waitcnt vmcnt(15) lgkmcnt(0)
  s_barrier
  v_add_u32 v215, 36864, v209
  ds_read_b64_tr_b16 a[112:113], v215 offset:0
  ds_read_b64_tr_b16 a[114:115], v215 offset:1024
  ds_read_b64_tr_b16 a[116:117], v215 offset:4096
  ds_read_b64_tr_b16 a[118:119], v215 offset:5120
  ds_read_b64_tr_b16 a[120:121], v215 offset:8192
  ds_read_b64_tr_b16 a[122:123], v215 offset:9216
  ds_read_b64_tr_b16 a[124:125], v215 offset:12288
  ds_read_b64_tr_b16 a[126:127], v215 offset:13312
  s_waitcnt vmcnt(11) lgkmcnt(0)
  s_barrier
  v_add_u32 v215, 53248, v210
  ds_read_b64_tr_b16 v[224:225], v215 offset:0
  ds_read_b64_tr_b16 v[226:227], v215 offset:1024
  ds_read_b64_tr_b16 v[228:229], v215 offset:4096
  ds_read_b64_tr_b16 v[230:231], v215 offset:5120
  ds_read_b64_tr_b16 v[232:233], v215 offset:8192
  ds_read_b64_tr_b16 v[234:235], v215 offset:9216
  ds_read_b64_tr_b16 v[236:237], v215 offset:12288
  ds_read_b64_tr_b16 v[238:239], v215 offset:13312
  s_waitcnt vmcnt(7) lgkmcnt(0)
  s_barrier
  v_add_u32 v215, 69632, v209
  ds_read_b64_tr_b16 a[128:129], v215 offset:0
  ds_read_b64_tr_b16 a[130:131], v215 offset:1024
  ds_read_b64_tr_b16 a[132:133], v215 offset:4096
  ds_read_b64_tr_b16 a[134:135], v215 offset:5120
  ds_read_b64_tr_b16 a[136:137], v215 offset:8192
  ds_read_b64_tr_b16 a[138:139], v215 offset:9216
  ds_read_b64_tr_b16 a[140:141], v215 offset:12288
  ds_read_b64_tr_b16 a[142:143], v215 offset:13312
  s_waitcnt vmcnt(3) lgkmcnt(0)
  s_barrier
  v_add_u32 v215, 86016, v210
  ds_read_b64_tr_b16 v[240:241], v215 offset:0
  ds_read_b64_tr_b16 v[242:243], v215 offset:1024
  ds_read_b64_tr_b16 v[244:245], v215 offset:4096
  ds_read_b64_tr_b16 v[246:247], v215 offset:5120
  ds_read_b64_tr_b16 v[248:249], v215 offset:8192
  ds_read_b64_tr_b16 v[250:251], v215 offset:9216
  ds_read_b64_tr_b16 v[252:253], v215 offset:12288
  ds_read_b64_tr_b16 v[254:255], v215 offset:13312
  s_waitcnt lgkmcnt(0)
  s_barrier
  s_mov_b32 s68, 1040356334
  s_lshl_b32 s69, s52, 9
  s_lshl_b32 s70, s58, 2
  s_add_u32 s70, s70, 128
  s_mul_i32 s66, s58, -12288
  s_lshl_b32 s54, s52, 10
  s_add_u32 s66, s66, s54
  s_add_u32 s66, s66, 524288
  v_mov_b32 v64, -1
  v_mov_b32 v65, -1
  v_mov_b32 v66, -1
  v_mov_b32 v67, -1
  s_add_u32 s60, s60, 258048
  ds_read_b128 v[32:35], v203 offset:0
  ds_read_b128 v[36:39], v204 offset:0
  ds_read_b128 v[40:43], v205 offset:0
  s_waitcnt lgkmcnt(2)
  v_mfma_f32_32x32x16_bf16 v[0:15], a[0:3], v[32:35], 0
  ds_read_b128 v[44:47], v206 offset:0
  s_add_u32 m0, s67, 36864
  s_nop 0
  buffer_load_dwordx4 v202, s[4:7], s60 offen offset:0 lds
  v_mfma_f32_32x32x16_bf16 v[16:31], v[32:35], a[144:147], 0
  s_waitcnt lgkmcnt(2)
  v_mfma_f32_32x32x16_bf16 v[0:15], a[4:7], v[36:39], v[0:15]
  ds_read_b128 v[32:35], v203 offset:1024
  s_add_u32 m0, s67, 37760
  s_nop 0
  buffer_load_dwordx4 v202, s[4:7], s60 offen offset:128 lds
  v_mfma_f32_32x32x16_bf16 v[16:31], v[36:39], a[148:151], v[16:31]
  s_waitcnt lgkmcnt(2)
  v_mfma_f32_32x32x16_bf16 v[0:15], a[8:11], v[40:43], v[0:15]
  ds_read_b128 v[36:39], v204 offset:1024
  s_add_u32 m0, s67, 38656
  s_nop 0
  buffer_load_dwordx4 v202, s[4:7], s60 offen offset:256 lds
  v_mfma_f32_32x32x16_bf16 v[16:31], v[40:43], a[152:155], v[16:31]
  s_waitcnt lgkmcnt(2)
  v_mfma_f32_32x32x16_bf16 v[0:15], a[12:15], v[44:47], v[0:15]
  ds_read_b128 v[40:43], v205 offset:1024
  s_add_u32 m0, s67, 39552
  s_nop 0
  buffer_load_dwordx4 v202, s[4:7], s60 offen offset:384 lds
  v_mfma_f32_32x32x16_bf16 v[16:31], v[44:47], a[156:159], v[16:31]
  s_waitcnt lgkmcnt(2)
  v_mfma_f32_32x32x16_bf16 v[0:15], a[16:19], v[32:35], v[0:15]
  ds_read_b128 v[44:47], v206 offset:1024
  s_add_u32 m0, s67, 40448
  s_nop 0
  buffer_load_dwordx4 v202, s[4:7], s60 offen offset:512 lds
  v_mfma_f32_32x32x16_bf16 v[16:31], v[32:35], a[160:163], v[16:31]
  s_waitcnt lgkmcnt(2)
  v_mfma_f32_32x32x16_bf16 v[0:15], a[20:23], v[36:39], v[0:15]
  ds_read_b128 v[32:35], v203 offset:2048
  s_add_u32 m0, s67, 41344
  s_nop 0
  buffer_load_dwordx4 v202, s[4:7], s60 offen offset:640 lds
  v_mfma_f32_32x32x16_bf16 v[16:31], v[36:39], a[164:167], v[16:31]
  s_waitcnt lgkmcnt(2)
  v_mfma_f32_32x32x16_bf16 v[0:15], a[24:27], v[40:43], v[0:15]
  ds_read_b128 v[36:39], v204 offset:2048
  s_add_u32 m0, s67, 42240
  s_nop 0
  buffer_load_dwordx4 v202, s[4:7], s60 offen offset:768 lds
  v_mfma_f32_32x32x16_bf16 v[16:31], v[40:43], a[168:171], v[16:31]
  s_waitcnt lgkmcnt(2)
  v_mfma_f32_32x32x16_bf16 v[0:15], a[28:31], v[44:47], v[0:15]
  ds_read_b128 v[40:43], v205 offset:2048
  s_add_u32 m0, s67, 43136
  s_nop 0
  buffer_load_dwordx4 v202, s[4:7], s60 offen offset:896 lds
  v_mfma_f32_32x32x16_bf16 v[16:31], v[44:47], a[172:175], v[16:31]
  s_waitcnt lgkmcnt(2)
  v_mfma_f32_32x32x16_bf16 v[0:15], a[32:35], v[32:35], v[0:15]
  ds_read_b128 v[44:47], v206 offset:2048
  s_add_u32 m0, s67, 44032
  s_nop 0
  buffer_load_dwordx4 v202, s[4:7], s60 offen offset:1024 lds
  v_mfma_f32_32x32x16_bf16 v[16:31], v[32:35], a[176:179], v[16:31]
  s_waitcnt lgkmcnt(2)
  v_mfma_f32_32x32x16_bf16 v[0:15], a[36:39], v[36:39], v[0:15]
  ds_read_b128 v[32:35], v203 offset:3072
  v_mfma_f32_32x32x16_bf16 v[16:31], v[36:39], a[180:183], v[16:31]
  s_waitcnt lgkmcnt(2)
  v_mfma_f32_32x32x16_bf16 v[0:15], a[40:43], v[40:43], v[0:15]
  ds_read_b128 v[36:39], v204 offset:3072
  v_mfma_f32_32x32x16_bf16 v[16:31], v[40:43], a[184:187], v[16:31]
  s_waitcnt lgkmcnt(2)
  v_mfma_f32_32x32x16_bf16 v[0:15], a[44:47], v[44:47], v[0:15]
  ds_read_b128 v[40:43], v205 offset:3072
  v_mfma_f32_32x32x16_bf16 v[16:31], v[44:47], a[188:191], v[16:31]
  s_waitcnt lgkmcnt(2)
  v_mfma_f32_32x32x16_bf16 v[0:15], a[48:51], v[32:35], v[0:15]
  ds_read_b128 v[44:47], v206 offset:3072
  v_mfma_f32_32x32x16_bf16 v[16:31], v[32:35], a[192:195], v[16:31]
  s_waitcnt lgkmcnt(2)
  v_mfma_f32_32x32x16_bf16 v[0:15], a[52:55], v[36:39], v[0:15]
  ds_read_b128 v[32:35], v203 offset:4096
  v_mfma_f32_32x32x16_bf16 v[16:31], v[36:39], a[196:199], v[16:31]
  s_waitcnt lgkmcnt(2)
  v_mfma_f32_32x32x16_bf16 v[0:15], a[56:59], v[40:43], v[0:15]
  ds_read_b128 v[36:39], v204 offset:4096
  v_mfma_f32_32x32x16_bf16 v[16:31], v[40:43], a[200:203], v[16:31]
  s_waitcnt lgkmcnt(2)
  v_mfma_f32_32x32x16_bf16 v[0:15], a[60:63], v[44:47], v[0:15]
  ds_read_b128 v[40:43], v205 offset:4096
  v_mfma_f32_32x32x16_bf16 v[16:31], v[44:47], a[204:207], v[16:31]
  s_waitcnt lgkmcnt(2)
  v_mfma_f32_32x32x16_bf16 v[0:15], a[64:67], v[32:35], v[0:15]
  ds_read_b128 v[44:47], v206 offset:4096
  v_mfma_f32_32x32x16_bf16 v[16:31], v[32:35], a[208:211], v[16:31]
  s_waitcnt lgkmcnt(2)
  v_mfma_f32_32x32x16_bf16 v[0:15], a[68:71], v[36:39], v[0:15]
  ds_read_b128 v[32:35], v203 offset:5120
  v_mfma_f32_32x32x16_bf16 v[16:31], v[36:39], a[212:215], v[16:31]
  s_waitcnt lgkmcnt(2)
  v_mfma_f32_32x32x16_bf16 v[0:15], a[72:75], v[40:43], v[0:15]
  ds_read_b128 v[36:39], v204 offset:5120
  v_mfma_f32_32x32x16_bf16 v[16:31], v[40:43], a[216:219], v[16:31]
  s_waitcnt lgkmcnt(2)
  v_mfma_f32_32x32x16_bf16 v[0:15], a[76:79], v[44:47], v[0:15]
  ds_read_b128 v[40:43], v205 offset:5120
  v_mfma_f32_32x32x16_bf16 v[16:31], v[44:47], a[220:223], v[16:31]
  s_waitcnt lgkmcnt(2)
  v_mfma_f32_32x32x16_bf16 v[0:15], a[80:83], v[32:35], v[0:15]
  ds_read_b128 v[44:47], v206 offset:5120
  v_mfma_f32_32x32x16_bf16 v[16:31], v[32:35], a[224:227], v[16:31]
  s_waitcnt lgkmcnt(2)
  v_mfma_f32_32x32x16_bf16 v[0:15], a[84:87], v[36:39], v[0:15]
  ds_read_b128 v[32:35], v203 offset:6144
  v_mfma_f32_32x32x16_bf16 v[16:31], v[36:39], a[228:231], v[16:31]
  s_waitcnt lgkmcnt(2)
  v_mfma_f32_32x32x16_bf16 v[0:15], a[88:91], v[40:43], v[0:15]
  ds_read_b128 v[36:39], v204 offset:6144
  v_mfma_f32_32x32x16_bf16 v[16:31], v[40:43], a[232:235], v[16:31]
  s_waitcnt lgkmcnt(2)
  v_mfma_f32_32x32x16_bf16 v[0:15], a[92:95], v[44:47], v[0:15]
  ds_read_b128 v[40:43], v205 offset:6144
  v_mfma_f32_32x32x16_bf16 v[16:31], v[44:47], a[236:239], v[16:31]
  s_waitcnt lgkmcnt(2)
  v_mfma_f32_32x32x16_bf16 v[0:15], a[96:99], v[32:35], v[0:15]
  ds_read_b128 v[44:47], v206 offset:6144
  v_mfma_f32_32x32x16_bf16 v[16:31], v[32:35], a[240:243], v[16:31]
  s_waitcnt lgkmcnt(2)
  v_mfma_f32_32x32x16_bf16 v[0:15], a[100:103], v[36:39], v[0:15]
  ds_read_b128 v[32:35], v203 offset:7168
  v_mfma_f32_32x32x16_bf16 v[16:31], v[36:39], a[244:247], v[16:31]
  s_waitcnt lgkmcnt(2)
  v_mfma_f32_32x32x16_bf16 v[0:15], a[104:107], v[40:43], v[0:15]
  ds_read_b128 v[36:39], v204 offset:7168
  v_mfma_f32_32x32x16_bf16 v[16:31], v[40:43], a[248:251], v[16:31]
  s_waitcnt lgkmcnt(2)
  v_mfma_f32_32x32x16_bf16 v[0:15], a[108:111], v[44:47], v[0:15]
  ds_read_b128 v[40:43], v205 offset:7168
  v_mfma_f32_32x32x16_bf16 v[16:31], v[44:47], a[252:255], v[16:31]
  s_waitcnt lgkmcnt(2)
  v_mfma_f32_32x32x16_bf16 v[0:15], a[112:115], v[32:35], v[0:15]
  ds_read_b128 v[44:47], v206 offset:7168
  v_mfma_f32_32x32x16_bf16 v[16:31], v[32:35], v[224:227], v[16:31]
  s_waitcnt lgkmcnt(2)
  v_mfma_f32_32x32x16_bf16 v[0:15], a[116:119], v[36:39], v[0:15]
  ds_read_b128 v[32:35], v203 offset:8192
  v_mfma_f32_32x32x16_bf16 v[16:31], v[36:39], v[228:231], v[16:31]
  s_waitcnt lgkmcnt(2)
  v_mfma_f32_32x32x16_bf16 v[0:15], a[120:123], v[40:43], v[0:15]
  ds_read_b128 v[36:39], v204 offset:8192
  v_mfma_f32_32x32x16_bf16 v[16:31], v[40:43], v[232:235], v[16:31]
  s_waitcnt lgkmcnt(2)
  v_mfma_f32_32x32x16_bf16 v[0:15], a[124:127], v[44:47], v[0:15]
  ds_read_b128 v[40:43], v205 offset:8192
  v_mfma_f32_32x32x16_bf16 v[16:31], v[44:47], v[236:239], v[16:31]
  s_waitcnt lgkmcnt(2)
  v_mfma_f32_32x32x16_bf16 v[0:15], a[128:131], v[32:35], v[0:15]
  ds_read_b128 v[44:47], v206 offset:8192
  v_mfma_f32_32x32x16_bf16 v[16:31], v[32:35], v[240:243], v[16:31]
  s_waitcnt lgkmcnt(2)
  v_mfma_f32_32x32x16_bf16 v[0:15], a[132:135], v[36:39], v[0:15]
  v_mfma_f32_32x32x16_bf16 v[16:31], v[36:39], v[244:247], v[16:31]
  s_waitcnt lgkmcnt(1)
  v_mfma_f32_32x32x16_bf16 v[0:15], a[136:139], v[40:43], v[0:15]
  v_mfma_f32_32x32x16_bf16 v[16:31], v[40:43], v[248:251], v[16:31]
  s_waitcnt lgkmcnt(0)
  v_mfma_f32_32x32x16_bf16 v[0:15], a[140:143], v[44:47], v[0:15]
  v_mfma_f32_32x32x16_bf16 v[16:31], v[44:47], v[252:255], v[16:31]
  s_mul_i32 s64, s59, 655360
  s_lshl_b32 s55, s58, 14
  s_add_u32 s64, s64, s55
  s_add_u32 s64, s64, 1048576
  s_add_u32 s72, s64, s69
  s_add_u32 s73, s64, s66
  s_add_u32 s59, s59, 7
  s_waitcnt vmcnt(0)
  s_barrier
  s_cmp_eq_u32 s1, 1
  s_cbranch_scc1 W_ver_ok
  v_mov_b32 v33, 163832
  s_cmp_eq_u32 s52, 0
  s_cbranch_scc0 W_ver_b
  s_waitcnt vmcnt(0)
  s_mov_b64 exec, 1
  ds_write_b32 v33, v197
  s_mov_b64 exec, -1
  s_waitcnt lgkmcnt(0)
W_ver_b:
  s_barrier
  ds_read_b32 v32, v33
  s_waitcnt lgkmcnt(0)
  v_readfirstlane_b32 s54, v32
  s_nop 0
  s_bitcmp1_b32 s54, s0
  s_cbranch_scc1 L_conf
W_ver_ok:
  s_lshr_b32 s55, s53, 1
  s_and_b32 s56, s53, 1
  s_lshl_b32 s56, s56, 7
  s_lshl_b32 s55, s55, 2
  s_add_u32 s55, s55, s56
  s_add_u32 s55, s55, 356352
  s_cmp_lt_u32 s53, 64
  s_cselect_b32 s71, s55, 268435456
  v_mov_b32 v211, 0
  s_mov_b64 exec, 1
  buffer_store_dword v211, v211, s[8:11], s71 offen sc1
  s_mov_b64 exec, -1
  s_cmp_eq_u32 s59, 7
  s_cbranch_scc0 KV_na
  s_mul_i32 s54, s58, 2176
  s_mul_i32 s55, s52, 69632
  s_add_u32 s55, s55, s54
  s_add_u32 s55, s55, 0
  s_add_u32 s54, s54, 278528
  s_and_b32 s56, s58, 7
  s_lshl_b32 s56, s56, 12
  s_bfe_u32 s57, s58, 0x10003
  s_lshl_b32 s57, s57, 11
  s_add_u32 s56, s56, s57
  s_add_u32 s54, s56, 262144
  s_lshr_b32 s57, s58, 4
  s_lshl_b32 s57, s57, 15
  s_add_u32 s56, s56, s57
  s_lshl_b32 s57, s52, 16
  s_add_u32 s56, s56, s57
  s_add_u32 s55, s56, 0
  s_lshl_b32 s56, s58, 14
  s_mul_i32 s57, s52, 3072
  s_add_u32 s56, s56, s57
  s_add_u32 s56, s56, 360448
  s_cmp_lt_u32 s58, 2
  s_cselect_b32 s56, s56, 268435456
  s_cmp_eq_u32 s52, 0
  s_cselect_b32 s54, s54, 268435456
  buffer_store_dwordx4 v[64:67], v201, s[8:11], s55 offen offset:0 sc1
  buffer_store_dwordx4 v[64:67], v201, s[8:11], s55 offen offset:1024 sc1
  buffer_store_dwordx4 v[64:67], v201, s[8:11], s54 offen offset:0 sc1
  buffer_store_dwordx4 v[64:67], v201, s[8:11], s54 offen offset:1024 sc1
  buffer_store_dwordx4 v[64:67], v201, s[8:11], s56 offen offset:0 sc1
  buffer_store_dwordx4 v[64:67], v201, s[8:11], s56 offen offset:1024 sc1
  buffer_store_dwordx4 v[64:67], v201, s[8:11], s56 offen offset:2048 sc1
KV_na:
KV_loop:
  s_add_u32 s60, s60, 258048
  ds_read_b128 v[32:35], v203 offset:36864
  ds_read_b128 v[36:39], v204 offset:36864
  ds_read_b128 v[40:43], v205 offset:36864
  s_waitcnt lgkmcnt(2)
  v_mfma_f32_32x32x16_bf16 v[68:83], a[0:3], v[32:35], 0
  ds_read_b128 v[44:47], v206 offset:36864
  s_add_u32 m0, s67, 0
  s_nop 0
  buffer_load_dwordx4 v202, s[4:7], s60 offen offset:0 lds
  v_mfma_f32_32x32x16_bf16 v[84:99], v[32:35], a[144:147], 0
  s_waitcnt lgkmcnt(2)
  v_mfma_f32_32x32x16_bf16 v[68:83], a[4:7], v[36:39], v[68:83]
  ds_read_b128 v[32:35], v203 offset:37888
  s_add_u32 m0, s67, 896
  s_nop 0
  buffer_load_dwordx4 v202, s[4:7], s60 offen offset:128 lds
  v_mfma_f32_32x32x16_bf16 v[84:99], v[36:39], a[148:151], v[84:99]
  s_waitcnt lgkmcnt(2)
  v_mfma_f32_32x32x16_bf16 v[68:83], a[8:11], v[40:43], v[68:83]
  ds_read_b128 v[36:39], v204 offset:37888
  s_add_u32 m0, s67, 1792
  s_nop 0
  buffer_load_dwordx4 v202, s[4:7], s60 offen offset:256 lds
  v_mfma_f32_32x32x16_bf16 v[84:99], v[40:43], a[152:155], v[84:99]
  s_waitcnt lgkmcnt(2)
  v_mfma_f32_32x32x16_bf16 v[68:83], a[12:15], v[44:47], v[68:83]
  ds_read_b128 v[40:43], v205 offset:37888
  s_add_u32 m0, s67, 2688
  s_nop 0
  buffer_load_dwordx4 v202, s[4:7], s60 offen offset:384 lds
  v_mfma_f32_32x32x16_bf16 v[84:99], v[44:47], a[156:159], v[84:99]
  s_waitcnt lgkmcnt(2)
  v_mfma_f32_32x32x16_bf16 v[68:83], a[16:19], v[32:35], v[68:83]
  ds_read_b128 v[44:47], v206 offset:37888
  s_add_u32 m0, s67, 3584
  s_nop 0
  buffer_load_dwordx4 v202, s[4:7], s60 offen offset:512 lds
  v_mfma_f32_32x32x16_bf16 v[84:99], v[32:35], a[160:163], v[84:99]
  s_waitcnt lgkmcnt(2)
  v_mfma_f32_32x32x16_bf16 v[68:83], a[20:23], v[36:39], v[68:83]
  ds_read_b128 v[32:35], v203 offset:38912
  s_add_u32 m0, s67, 4480
  s_nop 0
  buffer_load_dwordx4 v202, s[4:7], s60 offen offset:640 lds
  v_mfma_f32_32x32x16_bf16 v[84:99], v[36:39], a[164:167], v[84:99]
  s_waitcnt lgkmcnt(2)
  v_mfma_f32_32x32x16_bf16 v[68:83], a[24:27], v[40:43], v[68:83]
  ds_read_b128 v[36:39], v204 offset:38912
  s_add_u32 m0, s67, 5376
  s_nop 0
  buffer_load_dwordx4 v202, s[4:7], s60 offen offset:768 lds
  v_mfma_f32_32x32x16_bf16 v[84:99], v[40:43], a[168:171], v[84:99]
  s_waitcnt lgkmcnt(2)
  v_mfma_f32_32x32x16_bf16 v[68:83], a[28:31], v[44:47], v[68:83]
  ds_read_b128 v[40:43], v205 offset:38912
  s_add_u32 m0, s67, 6272
  s_nop 0
  buffer_load_dwordx4 v202, s[4:7], s60 offen offset:896 lds
  v_mfma_f32_32x32x16_bf16 v[84:99], v[44:47], a[172:175], v[84:99]
  s_waitcnt lgkmcnt(2)
  v_mfma_f32_32x32x16_bf16 v[68:83], a[32:35], v[32:35], v[68:83]
  ds_read_b128 v[44:47], v206 offset:38912
  s_add_u32 m0, s67, 7168
  s_nop 0
  buffer_load_dwordx4 v202, s[4:7], s60 offen offset:1024 lds
  v_mfma_f32_32x32x16_bf16 v[84:99], v[32:35], a[176:179], v[84:99]
  s_waitcnt lgkmcnt(2)
  v_mfma_f32_32x32x16_bf16 v[68:83], a[36:39], v[36:39], v[68:83]
  ds_read_b128 v[32:35], v203 offset:39936
  v_mul_f32 v0, s68, v0
  v_mul_f32 v1, s68, v1
  v_mul_f32 v2, s68, v2
  v_mul_f32 v3, s68, v3
  v_mfma_f32_32x32x16_bf16 v[84:99], v[36:39], a[180:183], v[84:99]
  v_mul_f32 v4, s68, v4
  v_mul_f32 v5, s68, v5
  v_mul_f32 v6, s68, v6
  v_mul_f32 v7, s68, v7
  s_waitcnt lgkmcnt(2)
  v_mfma_f32_32x32x16_bf16 v[68:83], a[40:43], v[40:43], v[68:83]
  ds_read_b128 v[36:39], v204 offset:39936
  v_cvt_pk_bf16_f32 v48, v0, v4
  v_cvt_pk_bf16_f32 v49, v1, v5
  v_cvt_pk_bf16_f32 v50, v2, v6
  v_cvt_pk_bf16_f32 v51, v3, v7
  v_mfma_f32_32x32x16_bf16 v[84:99], v[40:43], a[184:187], v[84:99]
  buffer_store_dwordx4 v[48:51], v216, s[8:11], s72 offen offset:0 sc1
  s_waitcnt lgkmcnt(2)
  v_mfma_f32_32x32x16_bf16 v[68:83], a[44:47], v[44:47], v[68:83]
  ds_read_b128 v[40:43], v205 offset:39936
  v_mfma_f32_32x32x16_bf16 v[84:99], v[44:47], a[188:191], v[84:99]
  s_waitcnt lgkmcnt(2)
  v_mfma_f32_32x32x16_bf16 v[68:83], a[48:51], v[32:35], v[68:83]
  ds_read_b128 v[44:47], v206 offset:39936
  v_mul_f32 v8, s68, v8
  v_mul_f32 v9, s68, v9
  v_mul_f32 v10, s68, v10
  v_mul_f32 v11, s68, v11
  v_mfma_f32_32x32x16_bf16 v[84:99], v[32:35], a[192:195], v[84:99]
  v_mul_f32 v12, s68, v12
  v_mul_f32 v13, s68, v13
  v_mul_f32 v14, s68, v14
  v_mul_f32 v15, s68, v15
  s_waitcnt lgkmcnt(2)
  v_mfma_f32_32x32x16_bf16 v[68:83], a[52:55], v[36:39], v[68:83]
  ds_read_b128 v[32:35], v203 offset:40960
  v_cvt_pk_bf16_f32 v52, v8, v12
  v_cvt_pk_bf16_f32 v53, v9, v13
  v_cvt_pk_bf16_f32 v54, v10, v14
  v_cvt_pk_bf16_f32 v55, v11, v15
  v_mfma_f32_32x32x16_bf16 v[84:99], v[36:39], a[196:199], v[84:99]
  buffer_store_dwordx4 v[52:55], v216, s[8:11], s72 offen offset:256 sc1
  s_waitcnt lgkmcnt(2)
  v_mfma_f32_32x32x16_bf16 v[68:83], a[56:59], v[40:43], v[68:83]
  ds_read_b128 v[36:39], v204 offset:40960
  v_mfma_f32_32x32x16_bf16 v[84:99], v[40:43], a[200:203], v[84:99]
  s_waitcnt lgkmcnt(2)
  v_mfma_f32_32x32x16_bf16 v[68:83], a[60:63], v[44:47], v[68:83]
  ds_read_b128 v[40:43], v205 offset:40960
  v_cvt_pk_bf16_f32 v56, v16, v17
  v_cvt_pk_bf16_f32 v57, v20, v21
  v_cvt_pk_bf16_f32 v58, v24, v25
  v_cvt_pk_bf16_f32 v59, v28, v29
  v_mfma_f32_32x32x16_bf16 v[84:99], v[44:47], a[204:207], v[84:99]
  buffer_store_dwordx4 v[56:59], v217, s[8:11], s64 offen offset:0 sc1
  s_waitcnt lgkmcnt(2)
  v_mfma_f32_32x32x16_bf16 v[68:83], a[64:67], v[32:35], v[68:83]
  ds_read_b128 v[44:47], v206 offset:40960
  v_mfma_f32_32x32x16_bf16 v[84:99], v[32:35], a[208:211], v[84:99]
  s_waitcnt lgkmcnt(2)
  v_mfma_f32_32x32x16_bf16 v[68:83], a[68:71], v[36:39], v[68:83]
  ds_read_b128 v[32:35], v203 offset:41984
  v_cvt_pk_bf16_f32 v60, v18, v19
  v_cvt_pk_bf16_f32 v61, v22, v23
  v_cvt_pk_bf16_f32 v62, v26, v27
  v_cvt_pk_bf16_f32 v63, v30, v31
  v_mfma_f32_32x32x16_bf16 v[84:99], v[36:39], a[212:215], v[84:99]
  buffer_store_dwordx4 v[60:63], v217, s[8:11], s64 offen offset:256 sc1
  s_waitcnt lgkmcnt(2)
  v_mfma_f32_32x32x16_bf16 v[68:83], a[72:75], v[40:43], v[68:83]
  ds_read_b128 v[36:39], v204 offset:41984
  v_mfma_f32_32x32x16_bf16 v[84:99], v[40:43], a[216:219], v[84:99]
  s_waitcnt lgkmcnt(2)
  v_mfma_f32_32x32x16_bf16 v[68:83], a[76:79], v[44:47], v[68:83]
  ds_read_b128 v[40:43], v205 offset:41984
  buffer_store_dwordx4 v[64:67], v201, s[8:11], s73 offen sc1
  v_mfma_f32_32x32x16_bf16 v[84:99], v[44:47], a[220:223], v[84:99]
  s_waitcnt lgkmcnt(2)
  v_mfma_f32_32x32x16_bf16 v[68:83], a[80:83], v[32:35], v[68:83]
  ds_read_b128 v[44:47], v206 offset:41984
  v_mfma_f32_32x32x16_bf16 v[84:99], v[32:35], a[224:227], v[84:99]
  s_waitcnt lgkmcnt(2)
  v_mfma_f32_32x32x16_bf16 v[68:83], a[84:87], v[36:39], v[68:83]
  ds_read_b128 v[32:35], v203 offset:43008
  v_mfma_f32_32x32x16_bf16 v[84:99], v[36:39], a[228:231], v[84:99]
  s_waitcnt lgkmcnt(2)
  v_mfma_f32_32x32x16_bf16 v[68:83], a[88:91], v[40:43], v[68:83]
  ds_read_b128 v[36:39], v204 offset:43008
  v_mfma_f32_32x32x16_bf16 v[84:99], v[40:43], a[232:235], v[84:99]
  s_waitcnt lgkmcnt(2)
  v_mfma_f32_32x32x16_bf16 v[68:83], a[92:95], v[44:47], v[68:83]
  ds_read_b128 v[40:43], v205 offset:43008
  v_mfma_f32_32x32x16_bf16 v[84:99], v[44:47], a[236:239], v[84:99]
  s_waitcnt lgkmcnt(2)
  v_mfma_f32_32x32x16_bf16 v[68:83], a[96:99], v[32:35], v[68:83]
  ds_read_b128 v[44:47], v206 offset:43008
  v_mfma_f32_32x32x16_bf16 v[84:99], v[32:35], a[240:243], v[84:99]
  s_waitcnt lgkmcnt(2)
  v_mfma_f32_32x32x16_bf16 v[68:83], a[100:103], v[36:39], v[68:83]
  ds_read_b128 v[32:35], v203 offset:44032
  v_mfma_f32_32x32x16_bf16 v[84:99], v[36:39], a[244:247], v[84:99]
  s_waitcnt lgkmcnt(2)
  v_mfma_f32_32x32x16_bf16 v[68:83], a[104:107], v[40:43], v[68:83]
  ds_read_b128 v[36:39], v204 offset:44032
  v_mfma_f32_32x32x16_bf16 v[84:99], v[40:43], a[248:251], v[84:99]
  s_waitcnt lgkmcnt(2)
  v_mfma_f32_32x32x16_bf16 v[68:83], a[108:111], v[44:47], v[68:83]
  ds_read_b128 v[40:43], v205 offset:44032
  v_mfma_f32_32x32x16_bf16 v[84:99], v[44:47], a[252:255], v[84:99]
  s_waitcnt lgkmcnt(2)
  v_mfma_f32_32x32x16_bf16 v[68:83], a[112:115], v[32:35], v[68:83]
  ds_read_b128 v[44:47], v206 offset:44032
  v_mfma_f32_32x32x16_bf16 v[84:99], v[32:35], v[224:227], v[84:99]
  s_waitcnt lgkmcnt(2)
  v_mfma_f32_32x32x16_bf16 v[68:83], a[116:119], v[36:39], v[68:83]
  ds_read_b128 v[32:35], v203 offset:45056
  v_mfma_f32_32x32x16_bf16 v[84:99], v[36:39], v[228:231], v[84:99]
  s_waitcnt lgkmcnt(2)
  v_mfma_f32_32x32x16_bf16 v[68:83], a[120:123], v[40:43], v[68:83]
  ds_read_b128 v[36:39], v204 offset:45056
  v_mfma_f32_32x32x16_bf16 v[84:99], v[40:43], v[232:235], v[84:99]
  s_waitcnt lgkmcnt(2)
  v_mfma_f32_32x32x16_bf16 v[68:83], a[124:127], v[44:47], v[68:83]
  ds_read_b128 v[40:43], v205 offset:45056
  v_mfma_f32_32x32x16_bf16 v[84:99], v[44:47], v[236:239], v[84:99]
  s_waitcnt lgkmcnt(2)
  v_mfma_f32_32x32x16_bf16 v[68:83], a[128:131], v[32:35], v[68:83]
  ds_read_b128 v[44:47], v206 offset:45056
  v_mfma_f32_32x32x16_bf16 v[84:99], v[32:35], v[240:243], v[84:99]
  s_waitcnt lgkmcnt(2)
  v_mfma_f32_32x32x16_bf16 v[68:83], a[132:135], v[36:39], v[68:83]
  v_mfma_f32_32x32x16_bf16 v[84:99], v[36:39], v[244:247], v[84:99]
  s_waitcnt lgkmcnt(1)
  v_mfma_f32_32x32x16_bf16 v[68:83], a[136:139], v[40:43], v[68:83]
  v_mfma_f32_32x32x16_bf16 v[84:99], v[40:43], v[248:251], v[84:99]
  s_waitcnt lgkmcnt(0)
  v_mfma_f32_32x32x16_bf16 v[68:83], a[140:143], v[44:47], v[68:83]
  v_mfma_f32_32x32x16_bf16 v[84:99], v[44:47], v[252:255], v[84:99]
  s_mul_i32 s64, s59, 655360
  s_lshl_b32 s55, s58, 14
  s_add_u32 s64, s64, s55
  s_add_u32 s64, s64, 1048576
  s_add_u32 s72, s64, s69
  s_add_u32 s73, s64, s66
  s_add_u32 s59, s59, 7
  s_cmp_ge_u32 s59, 64
  s_cbranch_scc1 KV_done1
  s_waitcnt vmcnt(5)
  s_barrier
  s_add_u32 s60, s60, 258048
  ds_read_b128 v[32:35], v203 offset:0
  ds_read_b128 v[36:39], v204 offset:0
  ds_read_b128 v[40:43], v205 offset:0
  s_waitcnt lgkmcnt(2)
  v_mfma_f32_32x32x16_bf16 v[0:15], a[0:3], v[32:35], 0
  ds_read_b128 v[44:47], v206 offset:0
  s_add_u32 m0, s67, 36864
  s_nop 0
  buffer_load_dwordx4 v202, s[4:7], s60 offen offset:0 lds
  v_mfma_f32_32x32x16_bf16 v[16:31], v[32:35], a[144:147], 0
  s_waitcnt lgkmcnt(2)
  v_mfma_f32_32x32x16_bf16 v[0:15], a[4:7], v[36:39], v[0:15]
  ds_read_b128 v[32:35], v203 offset:1024
  s_add_u32 m0, s67, 37760
  s_nop 0
  buffer_load_dwordx4 v202, s[4:7], s60 offen offset:128 lds
  v_mfma_f32_32x32x16_bf16 v[16:31], v[36:39], a[148:151], v[16:31]
  s_waitcnt lgkmcnt(2)
  v_mfma_f32_32x32x16_bf16 v[0:15], a[8:11], v[40:43], v[0:15]
  ds_read_b128 v[36:39], v204 offset:1024
  s_add_u32 m0, s67, 38656
  s_nop 0
  buffer_load_dwordx4 v202, s[4:7], s60 offen offset:256 lds
  v_mfma_f32_32x32x16_bf16 v[16:31], v[40:43], a[152:155], v[16:31]
  s_waitcnt lgkmcnt(2)
  v_mfma_f32_32x32x16_bf16 v[0:15], a[12:15], v[44:47], v[0:15]
  ds_read_b128 v[40:43], v205 offset:1024
  s_add_u32 m0, s67, 39552
  s_nop 0
  buffer_load_dwordx4 v202, s[4:7], s60 offen offset:384 lds
  v_mfma_f32_32x32x16_bf16 v[16:31], v[44:47], a[156:159], v[16:31]
  s_waitcnt lgkmcnt(2)
  v_mfma_f32_32x32x16_bf16 v[0:15], a[16:19], v[32:35], v[0:15]
  ds_read_b128 v[44:47], v206 offset:1024
  s_add_u32 m0, s67, 40448
  s_nop 0
  buffer_load_dwordx4 v202, s[4:7], s60 offen offset:512 lds
  v_mfma_f32_32x32x16_bf16 v[16:31], v[32:35], a[160:163], v[16:31]
  s_waitcnt lgkmcnt(2)
  v_mfma_f32_32x32x16_bf16 v[0:15], a[20:23], v[36:39], v[0:15]
  ds_read_b128 v[32:35], v203 offset:2048
  s_add_u32 m0, s67, 41344
  s_nop 0
  buffer_load_dwordx4 v202, s[4:7], s60 offen offset:640 lds
  v_mfma_f32_32x32x16_bf16 v[16:31], v[36:39], a[164:167], v[16:31]
  s_waitcnt lgkmcnt(2)
  v_mfma_f32_32x32x16_bf16 v[0:15], a[24:27], v[40:43], v[0:15]
  ds_read_b128 v[36:39], v204 offset:2048
  s_add_u32 m0, s67, 42240
  s_nop 0
  buffer_load_dwordx4 v202, s[4:7], s60 offen offset:768 lds
  v_mfma_f32_32x32x16_bf16 v[16:31], v[40:43], a[168:171], v[16:31]
  s_waitcnt lgkmcnt(2)
  v_mfma_f32_32x32x16_bf16 v[0:15], a[28:31], v[44:47], v[0:15]
  ds_read_b128 v[40:43], v205 offset:2048
  s_add_u32 m0, s67, 43136
  s_nop 0
  buffer_load_dwordx4 v202, s[4:7], s60 offen offset:896 lds
  v_mfma_f32_32x32x16_bf16 v[16:31], v[44:47], a[172:175], v[16:31]
  s_waitcnt lgkmcnt(2)
  v_mfma_f32_32x32x16_bf16 v[0:15], a[32:35], v[32:35], v[0:15]
  ds_read_b128 v[44:47], v206 offset:2048
  s_add_u32 m0, s67, 44032
  s_nop 0
  buffer_load_dwordx4 v202, s[4:7], s60 offen offset:1024 lds
  v_mfma_f32_32x32x16_bf16 v[16:31], v[32:35], a[176:179], v[16:31]
  s_waitcnt lgkmcnt(2)
  v_mfma_f32_32x32x16_bf16 v[0:15], a[36:39], v[36:39], v[0:15]
  ds_read_b128 v[32:35], v203 offset:3072
  v_mul_f32 v68, s68, v68
  v_mul_f32 v69, s68, v69
  v_mul_f32 v70, s68, v70
  v_mul_f32 v71, s68, v71
  v_mfma_f32_32x32x16_bf16 v[16:31], v[36:39], a[180:183], v[16:31]
  v_mul_f32 v72, s68, v72
  v_mul_f32 v73, s68, v73
  v_mul_f32 v74, s68, v74
  v_mul_f32 v75, s68, v75
  s_waitcnt lgkmcnt(2)
  v_mfma_f32_32x32x16_bf16 v[0:15], a[40:43], v[40:43], v[0:15]
  ds_read_b128 v[36:39], v204 offset:3072
  v_cvt_pk_bf16_f32 v48, v68, v72
  v_cvt_pk_bf16_f32 v49, v69, v73
  v_cvt_pk_bf16_f32 v50, v70, v74
  v_cvt_pk_bf16_f32 v51, v71, v75
  v_mfma_f32_32x32x16_bf16 v[16:31], v[40:43], a[184:187], v[16:31]
  buffer_store_dwordx4 v[48:51], v216, s[8:11], s72 offen offset:0 sc1
  s_waitcnt lgkmcnt(2)
  v_mfma_f32_32x32x16_bf16 v[0:15], a[44:47], v[44:47], v[0:15]
  ds_read_b128 v[40:43], v205 offset:3072
  v_mfma_f32_32x32x16_bf16 v[16:31], v[44:47], a[188:191], v[16:31]
  s_waitcnt lgkmcnt(2)
  v_mfma_f32_32x32x16_bf16 v[0:15], a[48:51], v[32:35], v[0:15]
  ds_read_b128 v[44:47], v206 offset:3072
  v_mul_f32 v76, s68, v76
  v_mul_f32 v77, s68, v77
  v_mul_f32 v78, s68, v78
  v_mul_f32 v79, s68, v79
  v_mfma_f32_32x32x16_bf16 v[16:31], v[32:35], a[192:195], v[16:31]
  v_mul_f32 v80, s68, v80
  v_mul_f32 v81, s68, v81
  v_mul_f32 v82, s68, v82
  v_mul_f32 v83, s68, v83
  s_waitcnt lgkmcnt(2)
  v_mfma_f32_32x32x16_bf16 v[0:15], a[52:55], v[36:39], v[0:15]
  ds_read_b128 v[32:35], v203 offset:4096
  v_cvt_pk_bf16_f32 v52, v76, v80
  v_cvt_pk_bf16_f32 v53, v77, v81
  v_cvt_pk_bf16_f32 v54, v78, v82
  v_cvt_pk_bf16_f32 v55, v79, v83
  v_mfma_f32_32x32x16_bf16 v[16:31], v[36:39], a[196:199], v[16:31]
  buffer_store_dwordx4 v[52:55], v216, s[8:11], s72 offen offset:256 sc1
  s_waitcnt lgkmcnt(2)
  v_mfma_f32_32x32x16_bf16 v[0:15], a[56:59], v[40:43], v[0:15]
  ds_read_b128 v[36:39], v204 offset:4096
  v_mfma_f32_32x32x16_bf16 v[16:31], v[40:43], a[200:203], v[16:31]
  s_waitcnt lgkmcnt(2)
  v_mfma_f32_32x32x16_bf16 v[0:15], a[60:63], v[44:47], v[0:15]
  ds_read_b128 v[40:43], v205 offset:4096
  v_cvt_pk_bf16_f32 v56, v84, v85
  v_cvt_pk_bf16_f32 v57, v88, v89
  v_cvt_pk_bf16_f32 v58, v92, v93
  v_cvt_pk_bf16_f32 v59, v96, v97
  v_mfma_f32_32x32x16_bf16 v[16:31], v[44:47], a[204:207], v[16:31]
  buffer_store_dwordx4 v[56:59], v217, s[8:11], s64 offen offset:0 sc1
  s_waitcnt lgkmcnt(2)
  v_mfma_f32_32x32x16_bf16 v[0:15], a[64:67], v[32:35], v[0:15]
  ds_read_b128 v[44:47], v206 offset:4096
  v_mfma_f32_32x32x16_bf16 v[16:31], v[32:35], a[208:211], v[16:31]
  s_waitcnt lgkmcnt(2)
  v_mfma_f32_32x32x16_bf16 v[0:15], a[68:71], v[36:39], v[0:15]
  ds_read_b128 v[32:35], v203 offset:5120
  v_cvt_pk_bf16_f32 v60, v86, v87
  v_cvt_pk_bf16_f32 v61, v90, v91
  v_cvt_pk_bf16_f32 v62, v94, v95
  v_cvt_pk_bf16_f32 v63, v98, v99
  v_mfma_f32_32x32x16_bf16 v[16:31], v[36:39], a[212:215], v[16:31]
  buffer_store_dwordx4 v[60:63], v217, s[8:11], s64 offen offset:256 sc1
  s_waitcnt lgkmcnt(2)
  v_mfma_f32_32x32x16_bf16 v[0:15], a[72:75], v[40:43], v[0:15]
  ds_read_b128 v[36:39], v204 offset:5120
  v_mfma_f32_32x32x16_bf16 v[16:31], v[40:43], a[216:219], v[16:31]
  s_waitcnt lgkmcnt(2)
  v_mfma_f32_32x32x16_bf16 v[0:15], a[76:79], v[44:47], v[0:15]
  ds_read_b128 v[40:43], v205 offset:5120
  buffer_store_dwordx4 v[64:67], v201, s[8:11], s73 offen sc1
  v_mfma_f32_32x32x16_bf16 v[16:31], v[44:47], a[220:223], v[16:31]
  s_waitcnt lgkmcnt(2)
  v_mfma_f32_32x32x16_bf16 v[0:15], a[80:83], v[32:35], v[0:15]
  ds_read_b128 v[44:47], v206 offset:5120
  v_mfma_f32_32x32x16_bf16 v[16:31], v[32:35], a[224:227], v[16:31]
  s_waitcnt lgkmcnt(2)
  v_mfma_f32_32x32x16_bf16 v[0:15], a[84:87], v[36:39], v[0:15]
  ds_read_b128 v[32:35], v203 offset:6144
  v_mfma_f32_32x32x16_bf16 v[16:31], v[36:39], a[228:231], v[16:31]
  s_waitcnt lgkmcnt(2)
  v_mfma_f32_32x32x16_bf16 v[0:15], a[88:91], v[40:43], v[0:15]
  ds_read_b128 v[36:39], v204 offset:6144
  v_mfma_f32_32x32x16_bf16 v[16:31], v[40:43], a[232:235], v[16:31]
  s_waitcnt lgkmcnt(2)
  v_mfma_f32_32x32x16_bf16 v[0:15], a[92:95], v[44:47], v[0:15]
  ds_read_b128 v[40:43], v205 offset:6144
  v_mfma_f32_32x32x16_bf16 v[16:31], v[44:47], a[236:239], v[16:31]
  s_waitcnt lgkmcnt(2)
  v_mfma_f32_32x32x16_bf16 v[0:15], a[96:99], v[32:35], v[0:15]
  ds_read_b128 v[44:47], v206 offset:6144
  v_mfma_f32_32x32x16_bf16 v[16:31], v[32:35], a[240:243], v[16:31]
  s_waitcnt lgkmcnt(2)
  v_mfma_f32_32x32x16_bf16 v[0:15], a[100:103], v[36:39], v[0:15]
  ds_read_b128 v[32:35], v203 offset:7168
  v_mfma_f32_32x32x16_bf16 v[16:31], v[36:39], a[244:247], v[16:31]
  s_waitcnt lgkmcnt(2)
  v_mfma_f32_32x32x16_bf16 v[0:15], a[104:107], v[40:43], v[0:15]
  ds_read_b128 v[36:39], v204 offset:7168
  v_mfma_f32_32x32x16_bf16 v[16:31], v[40:43], a[248:251], v[16:31]
  s_waitcnt lgkmcnt(2)
  v_mfma_f32_32x32x16_bf16 v[0:15], a[108:111], v[44:47], v[0:15]
  ds_read_b128 v[40:43], v205 offset:7168
  v_mfma_f32_32x32x16_bf16 v[16:31], v[44:47], a[252:255], v[16:31]
  s_waitcnt lgkmcnt(2)
  v_mfma_f32_32x32x16_bf16 v[0:15], a[112:115], v[32:35], v[0:15]
  ds_read_b128 v[44:47], v206 offset:7168
  v_mfma_f32_32x32x16_bf16 v[16:31], v[32:35], v[224:227], v[16:31]
  s_waitcnt lgkmcnt(2)
  v_mfma_f32_32x32x16_bf16 v[0:15], a[116:119], v[36:39], v[0:15]
  ds_read_b128 v[32:35], v203 offset:8192
  v_mfma_f32_32x32x16_bf16 v[16:31], v[36:39], v[228:231], v[16:31]
  s_waitcnt lgkmcnt(2)
  v_mfma_f32_32x32x16_bf16 v[0:15], a[120:123], v[40:43], v[0:15]
  ds_read_b128 v[36:39], v204 offset:8192
  v_mfma_f32_32x32x16_bf16 v[16:31], v[40:43], v[232:235], v[16:31]
  s_waitcnt lgkmcnt(2)
  v_mfma_f32_32x32x16_bf16 v[0:15], a[124:127], v[44:47], v[0:15]
  ds_read_b128 v[40:43], v205 offset:8192
  v_mfma_f32_32x32x16_bf16 v[16:31], v[44:47], v[236:239], v[16:31]
  s_waitcnt lgkmcnt(2)
  v_mfma_f32_32x32x16_bf16 v[0:15], a[128:131], v[32:35], v[0:15]
  ds_read_b128 v[44:47], v206 offset:8192
  v_mfma_f32_32x32x16_bf16 v[16:31], v[32:35], v[240:243], v[16:31]
  s_waitcnt lgkmcnt(2)
  v_mfma_f32_32x32x16_bf16 v[0:15], a[132:135], v[36:39], v[0:15]
  v_mfma_f32_32x32x16_bf16 v[16:31], v[36:39], v[244:247], v[16:31]
  s_waitcnt lgkmcnt(1)
  v_mfma_f32_32x32x16_bf16 v[0:15], a[136:139], v[40:43], v[0:15]
  v_mfma_f32_32x32x16_bf16 v[16:31], v[40:43], v[248:251], v[16:31]
  s_waitcnt lgkmcnt(0)
  v_mfma_f32_32x32x16_bf16 v[0:15], a[140:143], v[44:47], v[0:15]
  v_mfma_f32_32x32x16_bf16 v[16:31], v[44:47], v[252:255], v[16:31]
  s_mul_i32 s64, s59, 655360
  s_lshl_b32 s55, s58, 14
  s_add_u32 s64, s64, s55
  s_add_u32 s64, s64, 1048576
  s_add_u32 s72, s64, s69
  s_add_u32 s73, s64, s66
  s_add_u32 s59, s59, 7
  s_cmp_ge_u32 s59, 64
  s_cbranch_scc1 KV_done0
  s_sub_u32 s54, s59, 21
  s_cmp_lt_u32 s54, 7
  s_cbranch_scc1 KV_early
  s_waitcnt vmcnt(5)
  s_barrier
KV_cont:
  s_branch KV_loop
KV_early:
  s_waitcnt vmcnt(0)
  s_barrier
  s_cmp_eq_u32 s52, 0
  s_cbranch_scc0 KV_sig0
  v_mov_b32 v211, 1
  v_mov_b32 v212, 0
  s_mov_b64 exec, 1
  buffer_atomic_add v211, v212, s[12:15], s70 offen
  s_mov_b64 exec, -1
KV_sig0:
  s_branch KV_cont
KV_done1:
  s_nop 11
  v_mul_f32 v68, s68, v68
  v_mul_f32 v69, s68, v69
  v_mul_f32 v70, s68, v70
  v_mul_f32 v71, s68, v71
  v_mul_f32 v72, s68, v72
  v_mul_f32 v73, s68, v73
  v_mul_f32 v74, s68, v74
  v_mul_f32 v75, s68, v75
  v_cvt_pk_bf16_f32 v48, v68, v72
  v_cvt_pk_bf16_f32 v49, v69, v73
  v_cvt_pk_bf16_f32 v50, v70, v74
  v_cvt_pk_bf16_f32 v51, v71, v75
  buffer_store_dwordx4 v[48:51], v216, s[8:11], s72 offen offset:0 sc1
  v_mul_f32 v76, s68, v76
  v_mul_f32 v77, s68, v77
  v_mul_f32 v78, s68, v78
  v_mul_f32 v79, s68, v79
  v_mul_f32 v80, s68, v80
  v_mul_f32 v81, s68, v81
  v_mul_f32 v82, s68, v82
  v_mul_f32 v83, s68, v83
  v_cvt_pk_bf16_f32 v52, v76, v80
  v_cvt_pk_bf16_f32 v53, v77, v81
  v_cvt_pk_bf16_f32 v54, v78, v82
  v_cvt_pk_bf16_f32 v55, v79, v83
  buffer_store_dwordx4 v[52:55], v216, s[8:11], s72 offen offset:256 sc1
  v_cvt_pk_bf16_f32 v56, v84, v85
  v_cvt_pk_bf16_f32 v57, v88, v89
  v_cvt_pk_bf16_f32 v58, v92, v93
  v_cvt_pk_bf16_f32 v59, v96, v97
  buffer_store_dwordx4 v[56:59], v217, s[8:11], s64 offen offset:0 sc1
  v_cvt_pk_bf16_f32 v60, v86, v87
  v_cvt_pk_bf16_f32 v61, v90, v91
  v_cvt_pk_bf16_f32 v62, v94, v95
  v_cvt_pk_bf16_f32 v63, v98, v99
  buffer_store_dwordx4 v[60:63], v217, s[8:11], s64 offen offset:256 sc1
  buffer_store_dwordx4 v[64:67], v201, s[8:11], s73 offen sc1
  s_branch KV_fin
KV_done0:
  s_nop 11
  v_mul_f32 v0, s68, v0
  v_mul_f32 v1, s68, v1
  v_mul_f32 v2, s68, v2
  v_mul_f32 v3, s68, v3
  v_mul_f32 v4, s68, v4
  v_mul_f32 v5, s68, v5
  v_mul_f32 v6, s68, v6
  v_mul_f32 v7, s68, v7
  v_cvt_pk_bf16_f32 v48, v0, v4
  v_cvt_pk_bf16_f32 v49, v1, v5
  v_cvt_pk_bf16_f32 v50, v2, v6
  v_cvt_pk_bf16_f32 v51, v3, v7
  buffer_store_dwordx4 v[48:51], v216, s[8:11], s72 offen offset:0 sc1
  v_mul_f32 v8, s68, v8
  v_mul_f32 v9, s68, v9
  v_mul_f32 v10, s68, v10
  v_mul_f32 v11, s68, v11
  v_mul_f32 v12, s68, v12
  v_mul_f32 v13, s68, v13
  v_mul_f32 v14, s68, v14
  v_mul_f32 v15, s68, v15
  v_cvt_pk_bf16_f32 v52, v8, v12
  v_cvt_pk_bf16_f32 v53, v9, v13
  v_cvt_pk_bf16_f32 v54, v10, v14
  v_cvt_pk_bf16_f32 v55, v11, v15
  buffer_store_dwordx4 v[52:55], v216, s[8:11], s72 offen offset:256 sc1
  v_cvt_pk_bf16_f32 v56, v16, v17
  v_cvt_pk_bf16_f32 v57, v20, v21
  v_cvt_pk_bf16_f32 v58, v24, v25
  v_cvt_pk_bf16_f32 v59, v28, v29
  buffer_store_dwordx4 v[56:59], v217, s[8:11], s64 offen offset:0 sc1
  v_cvt_pk_bf16_f32 v60, v18, v19
  v_cvt_pk_bf16_f32 v61, v22, v23
  v_cvt_pk_bf16_f32 v62, v26, v27
  v_cvt_pk_bf16_f32 v63, v30, v31
  buffer_store_dwordx4 v[60:63], v217, s[8:11], s64 offen offset:256 sc1
  buffer_store_dwordx4 v[64:67], v201, s[8:11], s73 offen sc1
KV_fin:
  s_waitcnt vmcnt(0)
  s_barrier
  s_cmp_eq_u32 s52, 0
  s_cbranch_scc0 KV_sig
  v_mov_b32 v211, 256
  v_mov_b32 v212, 0
  s_mov_b64 exec, 1
  buffer_atomic_add v211, v212, s[12:15], s70 offen
  s_mov_b64 exec, -1
KV_sig:
  s_cmp_ge_u32 s53, 192
  s_cbranch_scc1 L_exit
  s_cmp_lt_u32 s53, 64
  s_cbranch_scc1 W_h
  s_sub_u32 s54, s53, 64
  s_lshr_b32 s68, s54, 4
  s_and_b32 s69, s54, 15
  s_lshl_b32 s60, s69, 2
  s_sub_u32 s60, s60, 1
  s_max_i32 s60, s60, 0
  s_mul_i32 s60, s60, 36864
  s_add_u32 m0, s67, 0
  s_nop 0
  buffer_load_dwordx4 v202, s[4:7], s60 offen offset:0 lds
  s_add_u32 m0, s67, 896
  s_nop 0
  buffer_load_dwordx4 v202, s[4:7], s60 offen offset:128 lds
  s_add_u32 m0, s67, 1792
  s_nop 0
  buffer_load_dwordx4 v202, s[4:7], s60 offen offset:256 lds
  s_add_u32 m0, s67, 2688
  s_nop 0
  buffer_load_dwordx4 v202, s[4:7], s60 offen offset:384 lds
  s_add_u32 m0, s67, 3584
  s_nop 0
  buffer_load_dwordx4 v202, s[4:7], s60 offen offset:512 lds
  s_add_u32 m0, s67, 4480
  s_nop 0
  buffer_load_dwordx4 v202, s[4:7], s60 offen offset:640 lds
  s_add_u32 m0, s67, 5376
  s_nop 0
  buffer_load_dwordx4 v202, s[4:7], s60 offen offset:768 lds
  s_add_u32 m0, s67, 6272
  s_nop 0
  buffer_load_dwordx4 v202, s[4:7], s60 offen offset:896 lds
  s_add_u32 m0, s67, 7168
  s_nop 0
  buffer_load_dwordx4 v202, s[4:7], s60 offen offset:1024 lds
  v_and_b32 v211, 15, v200
  v_mul_u32_u24 v211, 72, v211
  v_lshrrev_b32 v212, 4, v200
  v_mul_u32_u24 v213, 1152, v212
  v_add_u32 v213, v213, v211
  s_lshl_b32 s54, s54, 2
  s_add_u32 s70, s54, s52
  s_mul_i32 s55, s70, 4608
  buffer_load_dwordx4 v[48:51], v213, s[4:7], s55 offen offset:0
  buffer_load_dwordx4 v[52:55], v213, s[4:7], s55 offen offset:16
  buffer_load_dwordx4 v[56:59], v213, s[4:7], s55 offen offset:32
  buffer_load_dwordx4 v[60:63], v213, s[4:7], s55 offen offset:48
  buffer_load_dwordx2 v[64:65], v213, s[4:7], s55 offen offset:64
  buffer_load_dwordx4 v[68:71], v211, s[44:47], 0 offen offset:0
  buffer_load_dwordx4 v[72:75], v211, s[44:47], 0 offen offset:16
  buffer_load_dwordx4 v[76:79], v211, s[44:47], 0 offen offset:32
  buffer_load_dwordx4 v[80:83], v211, s[44:47], 0 offen offset:48
  buffer_load_dwordx2 v[84:85], v211, s[44:47], 0 offen offset:64
  v_mov_b32 v0, 0
  v_mov_b32 v1, 0x3f803f80
  s_waitcnt vmcnt(9)
  v_lshlrev_b32 v2, 16, v48
  s_waitcnt vmcnt(4)
  v_lshlrev_b32 v3, 16, v68
  v_and_b32 v4, 0xffff0000, v48
  v_and_b32 v5, 0xffff0000, v68
  v_mul_f32 v2, v2, v3
  v_mul_f32 v4, v4, v5
  v_cvt_pk_bf16_f32 v2, v2, v4
  v_lshlrev_b32 v3, 16, v2
  v_and_b32 v4, 0xffff0000, v2
  v_add_f32 v0, v0, v3
  v_add_f32 v0, v0, v4
  v_lshlrev_b32 v2, 16, v49
  v_lshlrev_b32 v3, 16, v69
  v_and_b32 v4, 0xffff0000, v49
  v_and_b32 v5, 0xffff0000, v69
  v_mul_f32 v2, v2, v3
  v_mul_f32 v4, v4, v5
  v_cvt_pk_bf16_f32 v2, v2, v4
  v_lshlrev_b32 v3, 16, v2
  v_and_b32 v4, 0xffff0000, v2
  v_add_f32 v0, v0, v3
  v_add_f32 v0, v0, v4
  v_lshlrev_b32 v2, 16, v50
  v_lshlrev_b32 v3, 16, v70
  v_and_b32 v4, 0xffff0000, v50
  v_and_b32 v5, 0xffff0000, v70
  v_mul_f32 v2, v2, v3
  v_mul_f32 v4, v4, v5
  v_cvt_pk_bf16_f32 v2, v2, v4
  v_lshlrev_b32 v3, 16, v2
  v_and_b32 v4, 0xffff0000, v2
  v_add_f32 v0, v0, v3
  v_add_f32 v0, v0, v4
  v_lshlrev_b32 v2, 16, v51
  v_lshlrev_b32 v3, 16, v71
  v_and_b32 v4, 0xffff0000, v51
  v_and_b32 v5, 0xffff0000, v71
  v_mul_f32 v2, v2, v3
  v_mul_f32 v4, v4, v5
  v_cvt_pk_bf16_f32 v2, v2, v4
  v_lshlrev_b32 v3, 16, v2
  v_and_b32 v4, 0xffff0000, v2
  v_add_f32 v0, v0, v3
  v_add_f32 v0, v0, v4
  v_lshlrev_b32 v2, 16, v52
  s_waitcnt vmcnt(3)
  v_lshlrev_b32 v3, 16, v72
  v_and_b32 v4, 0xffff0000, v52
  v_and_b32 v5, 0xffff0000, v72
  v_mul_f32 v2, v2, v3
  v_mul_f32 v4, v4, v5
  v_cvt_pk_bf16_f32 v2, v2, v4
  v_lshlrev_b32 v3, 16, v2
  v_and_b32 v4, 0xffff0000, v2
  v_add_f32 v0, v0, v3
  v_add_f32 v0, v0, v4
  v_lshlrev_b32 v2, 16, v53
  v_lshlrev_b32 v3, 16, v73
  v_and_b32 v4, 0xffff0000, v53
  v_and_b32 v5, 0xffff0000, v73
  v_mul_f32 v2, v2, v3
  v_mul_f32 v4, v4, v5
  v_cvt_pk_bf16_f32 v2, v2, v4
  v_lshlrev_b32 v3, 16, v2
  v_and_b32 v4, 0xffff0000, v2
  v_add_f32 v0, v0, v3
  v_add_f32 v0, v0, v4
  v_lshlrev_b32 v2, 16, v54
  v_lshlrev_b32 v3, 16, v74
  v_and_b32 v4, 0xffff0000, v54
  v_and_b32 v5, 0xffff0000, v74
  v_mul_f32 v2, v2, v3
  v_mul_f32 v4, v4, v5
  v_cvt_pk_bf16_f32 v2, v2, v4
  v_lshlrev_b32 v3, 16, v2
  v_and_b32 v4, 0xffff0000, v2
  v_add_f32 v0, v0, v3
  v_add_f32 v0, v0, v4
  v_lshlrev_b32 v2, 16, v55
  v_lshlrev_b32 v3, 16, v75
  v_and_b32 v4, 0xffff0000, v55
  v_and_b32 v5, 0xffff0000, v75
  v_mul_f32 v2, v2, v3
  v_mul_f32 v4, v4, v5
  v_cvt_pk_bf16_f32 v2, v2, v4
  v_lshlrev_b32 v3, 16, v2
  v_and_b32 v4, 0xffff0000, v2
  v_add_f32 v0, v0, v3
  v_add_f32 v0, v0, v4
  v_lshlrev_b32 v2, 16, v56
  s_waitcnt vmcnt(2)
  v_lshlrev_b32 v3, 16, v76
  v_and_b32 v4, 0xffff0000, v56
  v_and_b32 v5, 0xffff0000, v76
  v_mul_f32 v2, v2, v3
  v_mul_f32 v4, v4, v5
  v_cvt_pk_bf16_f32 v2, v2, v4
  v_lshlrev_b32 v3, 16, v2
  v_and_b32 v4, 0xffff0000, v2
  v_add_f32 v0, v0, v3
  v_add_f32 v0, v0, v4
  v_lshlrev_b32 v2, 16, v57
  v_lshlrev_b32 v3, 16, v77
  v_and_b32 v4, 0xffff0000, v57
  v_and_b32 v5, 0xffff0000, v77
  v_mul_f32 v2, v2, v3
  v_mul_f32 v4, v4, v5
  v_cvt_pk_bf16_f32 v2, v2, v4
  v_lshlrev_b32 v3, 16, v2
  v_and_b32 v4, 0xffff0000, v2
  v_add_f32 v0, v0, v3
  v_add_f32 v0, v0, v4
  v_lshlrev_b32 v2, 16, v58
  v_lshlrev_b32 v3, 16, v78
  v_and_b32 v4, 0xffff0000, v58
  v_and_b32 v5, 0xffff0000, v78
  v_mul_f32 v2, v2, v3
  v_mul_f32 v4, v4, v5
  v_cvt_pk_bf16_f32 v2, v2, v4
  v_lshlrev_b32 v3, 16, v2
  v_and_b32 v4, 0xffff0000, v2
  v_add_f32 v0, v0, v3
  v_add_f32 v0, v0, v4
  v_lshlrev_b32 v2, 16, v59
  v_lshlrev_b32 v3, 16, v79
  v_and_b32 v4, 0xffff0000, v59
  v_and_b32 v5, 0xffff0000, v79
  v_mul_f32 v2, v2, v3
  v_mul_f32 v4, v4, v5
  v_cvt_pk_bf16_f32 v2, v2, v4
  v_lshlrev_b32 v3, 16, v2
  v_and_b32 v4, 0xffff0000, v2
  v_add_f32 v0, v0, v3
  v_add_f32 v0, v0, v4
  v_lshlrev_b32 v2, 16, v60
  s_waitcnt vmcnt(1)
  v_lshlrev_b32 v3, 16, v80
  v_and_b32 v4, 0xffff0000, v60
  v_and_b32 v5, 0xffff0000, v80
  v_mul_f32 v2, v2, v3
  v_mul_f32 v4, v4, v5
  v_cvt_pk_bf16_f32 v2, v2, v4
  v_lshlrev_b32 v3, 16, v2
  v_and_b32 v4, 0xffff0000, v2
  v_add_f32 v0, v0, v3
  v_add_f32 v0, v0, v4
  v_lshlrev_b32 v2, 16, v61
  v_lshlrev_b32 v3, 16, v81
  v_and_b32 v4, 0xffff0000, v61
  v_and_b32 v5, 0xffff0000, v81
  v_mul_f32 v2, v2, v3
  v_mul_f32 v4, v4, v5
  v_cvt_pk_bf16_f32 v2, v2, v4
  v_lshlrev_b32 v3, 16, v2
  v_and_b32 v4, 0xffff0000, v2
  v_add_f32 v0, v0, v3
  v_add_f32 v0, v0, v4
  v_lshlrev_b32 v2, 16, v62
  v_lshlrev_b32 v3, 16, v82
  v_and_b32 v4, 0xffff0000, v62
  v_and_b32 v5, 0xffff0000, v82
  v_mul_f32 v2, v2, v3
  v_mul_f32 v4, v4, v5
  v_cvt_pk_bf16_f32 v2, v2, v4
  v_lshlrev_b32 v3, 16, v2
  v_and_b32 v4, 0xffff0000, v2
  v_add_f32 v0, v0, v3
  v_add_f32 v0, v0, v4
  v_lshlrev_b32 v2, 16, v63
  v_lshlrev_b32 v3, 16, v83
  v_and_b32 v4, 0xffff0000, v63
  v_and_b32 v5, 0xffff0000, v83
  v_mul_f32 v2, v2, v3
  v_mul_f32 v4, v4, v5
  v_cvt_pk_bf16_f32 v2, v2, v4
  v_lshlrev_b32 v3, 16, v2
  v_and_b32 v4, 0xffff0000, v2
  v_add_f32 v0, v0, v3
  v_add_f32 v0, v0, v4
  v_lshlrev_b32 v2, 16, v64
  s_waitcnt vmcnt(0)
  v_lshlrev_b32 v3, 16, v84
  v_and_b32 v4, 0xffff0000, v64
  v_and_b32 v5, 0xffff0000, v84
  v_mul_f32 v2, v2, v3
  v_mul_f32 v4, v4, v5
  v_cvt_pk_bf16_f32 v2, v2, v4
  v_lshlrev_b32 v3, 16, v2
  v_and_b32 v4, 0xffff0000, v2
  v_add_f32 v0, v0, v3
  v_add_f32 v0, v0, v4
  v_lshlrev_b32 v2, 16, v65
  v_lshlrev_b32 v3, 16, v85
  v_and_b32 v4, 0xffff0000, v65
  v_and_b32 v5, 0xffff0000, v85
  v_mul_f32 v2, v2, v3
  v_mul_f32 v4, v4, v5
  v_cvt_pk_bf16_f32 v2, v2, v4
  v_lshlrev_b32 v3, 16, v2
  v_and_b32 v4, 0xffff0000, v2
  v_add_f32 v0, v0, v3
  v_add_f32 v0, v0, v4
  s_nop 1
  v_add_f32_dpp v0, v0, v0 row_ror:1 row_mask:0xf bank_mask:0xf
  s_nop 1
  v_add_f32_dpp v0, v0, v0 row_ror:2 row_mask:0xf bank_mask:0xf
  s_nop 1
  v_add_f32_dpp v0, v0, v0 row_ror:4 row_mask:0xf bank_mask:0xf
  s_nop 1
  v_add_f32_dpp v0, v0, v0 row_ror:8 row_mask:0xf bank_mask:0xf
  v_cvt_pk_bf16_f32 v0, v0, v0
  v_lshlrev_b32 v0, 16, v0
  v_mul_f32 v0, 3216550459, v0
  v_exp_f32 v0, v0
  s_nop 0
  v_add_f32 v0, 1.0, v0
  v_rcp_f32 v0, v0
  s_nop 0
  v_cvt_pk_bf16_f32 v0, v0, v0
  v_lshlrev_b32 v0, 16, v0
  v_lshlrev_b32 v212, 2, v212
  s_lshl_b32 s55, s70, 4
  s_add_u32 s55, s55, 66060288
  s_mov_b32 exec_lo, 0x00010001
  s_mov_b32 exec_hi, 0x00010001
  buffer_store_dword v0, v212, s[8:11], s55 offen sc1
  s_mov_b64 exec, -1
  v_lshrrev_b32 v211, 4, v200
  v_lshlrev_b32 v212, 2, v211
  v_and_b32 v213, 15, v200
  v_xor_b32 v212, v212, v213
  v_mul_u32_u24 v211, 3456, v211
  v_mov_b32 v2, 0x40000000
  v_add_u32 v213, 0, v212
  v_mul_u32_u24 v214, 57, v213
  v_lshrrev_b32 v214, 9, v214
  v_mul_u32_u24 v214, 1008, v214
  v_lshl_add_u32 v214, v213, 4, v214
  v_add_u32 v214, v214, v211
  v_cmp_lt_u32 vcc, 26, v213
  s_nop 1
  v_cndmask_b32 v207, v214, v2, vcc
  v_add_u32 v213, 16, v212
  v_mul_u32_u24 v214, 57, v213
  v_lshrrev_b32 v214, 9, v214
  v_mul_u32_u24 v214, 1008, v214
  v_lshl_add_u32 v214, v213, 4, v214
  v_add_u32 v214, v214, v211
  v_cmp_lt_u32 vcc, 26, v213
  s_nop 1
  v_cndmask_b32 v208, v214, v2, vcc
  s_mul_i32 s62, s68, 144
  s_mul_i32 s54, s52, 13824
  s_add_u32 s62, s62, s54
  s_waitcnt vmcnt(0)
  s_lshl_b32 s61, s52, 10
  s_add_u32 s61, s61, 36864
  s_add_u32 m0, s61, 0
  s_add_u32 s54, s62, 0
  buffer_load_dwordx4 v207, s[36:39], s54 offen lds
  s_add_u32 m0, s61, 4096
  s_add_u32 s54, s62, 55296
  buffer_load_dwordx4 v207, s[36:39], s54 offen lds
  s_add_u32 m0, s61, 8192
  s_add_u32 s54, s62, 110592
  buffer_load_dwordx4 v207, s[36:39], s54 offen lds
  s_add_u32 m0, s61, 12288
  s_add_u32 s54, s62, 165888
  buffer_load_dwordx4 v207, s[36:39], s54 offen lds
  s_add_u32 m0, s61, 16384
  s_add_u32 s54, s62, 0
  buffer_load_dwordx4 v208, s[36:39], s54 offen lds
  s_add_u32 m0, s61, 20480
  s_add_u32 s54, s62, 55296
  buffer_load_dwordx4 v208, s[36:39], s54 offen lds
  s_add_u32 m0, s61, 24576
  s_add_u32 s54, s62, 110592
  buffer_load_dwordx4 v208, s[36:39], s54 offen lds
  s_add_u32 m0, s61, 28672
  s_add_u32 s54, s62, 165888
  buffer_load_dwordx4 v208, s[36:39], s54 offen lds
  s_add_u32 m0, s61, 32768
  s_add_u32 s54, s62, 221184
  buffer_load_dwordx4 v207, s[36:39], s54 offen lds
  s_add_u32 m0, s61, 36864
  s_add_u32 s54, s62, 276480
  buffer_load_dwordx4 v207, s[36:39], s54 offen lds
  s_add_u32 m0, s61, 40960
  s_add_u32 s54, s62, 331776
  buffer_load_dwordx4 v207, s[36:39], s54 offen lds
  s_add_u32 m0, s61, 45056
  s_add_u32 s54, s62, 387072
  buffer_load_dwordx4 v207, s[36:39], s54 offen lds
  s_add_u32 m0, s61, 49152
  s_add_u32 s54, s62, 221184
  buffer_load_dwordx4 v208, s[36:39], s54 offen lds
  s_add_u32 m0, s61, 53248
  s_add_u32 s54, s62, 276480
  buffer_load_dwordx4 v208, s[36:39], s54 offen lds
  s_add_u32 m0, s61, 57344
  s_add_u32 s54, s62, 331776
  buffer_load_dwordx4 v208, s[36:39], s54 offen lds
  s_add_u32 m0, s61, 61440
  s_add_u32 s54, s62, 387072
  buffer_load_dwordx4 v208, s[36:39], s54 offen lds
  s_add_u32 m0, s61, 65536
  s_add_u32 s54, s62, 442368
  buffer_load_dwordx4 v207, s[36:39], s54 offen lds
  s_add_u32 m0, s61, 69632
  s_add_u32 s54, s62, 497664
  buffer_load_dwordx4 v207, s[36:39], s54 offen lds
  s_add_u32 m0, s61, 73728
  s_add_u32 s54, s62, 552960
  buffer_load_dwordx4 v207, s[36:39], s54 offen lds
  s_add_u32 m0, s61, 77824
  s_add_u32 s54, s62, 608256
  buffer_load_dwordx4 v207, s[36:39], s54 offen lds
  s_add_u32 m0, s61, 81920
  s_add_u32 s54, s62, 442368
  buffer_load_dwordx4 v208, s[36:39], s54 offen lds
  s_add_u32 m0, s61, 86016
  s_add_u32 s54, s62, 497664
  buffer_load_dwordx4 v208, s[36:39], s54 offen lds
  s_add_u32 m0, s61, 90112
  s_add_u32 s54, s62, 552960
  buffer_load_dwordx4 v208, s[36:39], s54 offen lds
  s_add_u32 m0, s61, 94208
  s_add_u32 s54, s62, 608256
  buffer_load_dwordx4 v208, s[36:39], s54 offen lds
  s_waitcnt vmcnt(20) lgkmcnt(0)
  s_barrier
  s_add_u32 m0, s61, 98304
  s_add_u32 s54, s62, 663552
  buffer_load_dwordx4 v207, s[36:39], s54 offen lds
  s_add_u32 m0, s61, 102400
  s_add_u32 s54, s62, 718848
  buffer_load_dwordx4 v207, s[36:39], s54 offen lds
  s_add_u32 m0, s61, 106496
  s_add_u32 s54, s62, 774144
  buffer_load_dwordx4 v207, s[36:39], s54 offen lds
  s_add_u32 m0, s61, 110592
  s_add_u32 s54, s62, 829440
  buffer_load_dwordx4 v207, s[36:39], s54 offen lds
  v_add_u32 v215, 36864, v210
  ds_read_b64_tr_b16 a[0:1], v215 offset:0
  ds_read_b64_tr_b16 a[2:3], v215 offset:1024
  ds_read_b64_tr_b16 a[4:5], v215 offset:4096
  ds_read_b64_tr_b16 a[6:7], v215 offset:5120
  ds_read_b64_tr_b16 a[8:9], v215 offset:8192
  ds_read_b64_tr_b16 a[10:11], v215 offset:9216
  ds_read_b64_tr_b16 a[12:13], v215 offset:12288
  ds_read_b64_tr_b16 a[14:15], v215 offset:13312
  s_waitcnt vmcnt(20) lgkmcnt(0)
  s_barrier
  s_add_u32 m0, s61, 0
  s_add_u32 s54, s62, 663552
  buffer_load_dwordx4 v208, s[36:39], s54 offen lds
  s_add_u32 m0, s61, 4096
  s_add_u32 s54, s62, 718848
  buffer_load_dwordx4 v208, s[36:39], s54 offen lds
  s_add_u32 m0, s61, 8192
  s_add_u32 s54, s62, 774144
  buffer_load_dwordx4 v208, s[36:39], s54 offen lds
  s_add_u32 m0, s61, 12288
  s_add_u32 s54, s62, 829440
  buffer_load_dwordx4 v208, s[36:39], s54 offen lds
  v_add_u32 v215, 53248, v210
  ds_read_b64_tr_b16 a[144:145], v215 offset:0
  ds_read_b64_tr_b16 a[146:147], v215 offset:1024
  ds_read_b64_tr_b16 a[148:149], v215 offset:4096
  ds_read_b64_tr_b16 a[150:151], v215 offset:5120
  ds_read_b64_tr_b16 a[152:153], v215 offset:8192
  ds_read_b64_tr_b16 a[154:155], v215 offset:9216
  ds_read_b64_tr_b16 a[156:157], v215 offset:12288
  ds_read_b64_tr_b16 a[158:159], v215 offset:13312
  s_waitcnt vmcnt(20) lgkmcnt(0)
  s_barrier
  s_add_u32 m0, s61, 16384
  s_add_u32 s54, s62, 884736
  buffer_load_dwordx4 v207, s[36:39], s54 offen lds
  s_add_u32 m0, s61, 20480
  s_add_u32 s54, s62, 940032
  buffer_load_dwordx4 v207, s[36:39], s54 offen lds
  s_add_u32 m0, s61, 24576
  s_add_u32 s54, s62, 995328
  buffer_load_dwordx4 v207, s[36:39], s54 offen lds
  s_add_u32 m0, s61, 28672
  s_add_u32 s54, s62, 1050624
  buffer_load_dwordx4 v207, s[36:39], s54 offen lds
  v_add_u32 v215, 69632, v210
  ds_read_b64_tr_b16 a[16:17], v215 offset:0
  ds_read_b64_tr_b16 a[18:19], v215 offset:1024
  ds_read_b64_tr_b16 a[20:21], v215 offset:4096
  ds_read_b64_tr_b16 a[22:23], v215 offset:5120
  ds_read_b64_tr_b16 a[24:25], v215 offset:8192
  ds_read_b64_tr_b16 a[26:27], v215 offset:9216
  ds_read_b64_tr_b16 a[28:29], v215 offset:12288
  ds_read_b64_tr_b16 a[30:31], v215 offset:13312
  s_waitcnt vmcnt(20) lgkmcnt(0)
  s_barrier
  s_add_u32 m0, s61, 32768
  s_add_u32 s54, s62, 884736
  buffer_load_dwordx4 v208, s[36:39], s54 offen lds
  s_add_u32 m0, s61, 36864
  s_add_u32 s54, s62, 940032
  buffer_load_dwordx4 v208, s[36:39], s54 offen lds
  s_add_u32 m0, s61, 40960
  s_add_u32 s54, s62, 995328
  buffer_load_dwordx4 v208, s[36:39], s54 offen lds
  s_add_u32 m0, s61, 45056
  s_add_u32 s54, s62, 1050624
  buffer_load_dwordx4 v208, s[36:39], s54 offen lds
  v_add_u32 v215, 86016, v210
  ds_read_b64_tr_b16 a[160:161], v215 offset:0
  ds_read_b64_tr_b16 a[162:163], v215 offset:1024
  ds_read_b64_tr_b16 a[164:165], v215 offset:4096
  ds_read_b64_tr_b16 a[166:167], v215 offset:5120
  ds_read_b64_tr_b16 a[168:169], v215 offset:8192
  ds_read_b64_tr_b16 a[170:171], v215 offset:9216
  ds_read_b64_tr_b16 a[172:173], v215 offset:12288
  ds_read_b64_tr_b16 a[174:175], v215 offset:13312
  s_waitcnt vmcnt(20) lgkmcnt(0)
  s_barrier
  s_add_u32 m0, s61, 49152
  s_add_u32 s54, s62, 1105920
  buffer_load_dwordx4 v207, s[36:39], s54 offen lds
  s_add_u32 m0, s61, 53248
  s_add_u32 s54, s62, 1161216
  buffer_load_dwordx4 v207, s[36:39], s54 offen lds
  s_add_u32 m0, s61, 57344
  s_add_u32 s54, s62, 1216512
  buffer_load_dwordx4 v207, s[36:39], s54 offen lds
  s_add_u32 m0, s61, 61440
  s_add_u32 s54, s62, 1271808
  buffer_load_dwordx4 v207, s[36:39], s54 offen lds
  v_add_u32 v215, 102400, v210
  ds_read_b64_tr_b16 a[32:33], v215 offset:0
  ds_read_b64_tr_b16 a[34:35], v215 offset:1024
  ds_read_b64_tr_b16 a[36:37], v215 offset:4096
  ds_read_b64_tr_b16 a[38:39], v215 offset:5120
  ds_read_b64_tr_b16 a[40:41], v215 offset:8192
  ds_read_b64_tr_b16 a[42:43], v215 offset:9216
  ds_read_b64_tr_b16 a[44:45], v215 offset:12288
  ds_read_b64_tr_b16 a[46:47], v215 offset:13312
  s_waitcnt vmcnt(20) lgkmcnt(0)
  s_barrier
  s_add_u32 m0, s61, 65536
  s_add_u32 s54, s62, 1105920
  buffer_load_dwordx4 v208, s[36:39], s54 offen lds
  s_add_u32 m0, s61, 69632
  s_add_u32 s54, s62, 1161216
  buffer_load_dwordx4 v208, s[36:39], s54 offen lds
  s_add_u32 m0, s61, 73728
  s_add_u32 s54, s62, 1216512
  buffer_load_dwordx4 v208, s[36:39], s54 offen lds
  s_add_u32 m0, s61, 77824
  s_add_u32 s54, s62, 1271808
  buffer_load_dwordx4 v208, s[36:39], s54 offen lds
  v_add_u32 v215, 118784, v210
  ds_read_b64_tr_b16 a[176:177], v215 offset:0
  ds_read_b64_tr_b16 a[178:179], v215 offset:1024
  ds_read_b64_tr_b16 a[180:181], v215 offset:4096
  ds_read_b64_tr_b16 a[182:183], v215 offset:5120
  ds_read_b64_tr_b16 a[184:185], v215 offset:8192
  ds_read_b64_tr_b16 a[186:187], v215 offset:9216
  ds_read_b64_tr_b16 a[188:189], v215 offset:12288
  ds_read_b64_tr_b16 a[190:191], v215 offset:13312
  s_waitcnt vmcnt(20) lgkmcnt(0)
  s_barrier
  s_add_u32 m0, s61, 81920
  s_add_u32 s54, s62, 1327104
  buffer_load_dwordx4 v207, s[36:39], s54 offen lds
  s_add_u32 m0, s61, 86016
  s_add_u32 s54, s62, 1382400
  buffer_load_dwordx4 v207, s[36:39], s54 offen lds
  s_add_u32 m0, s61, 90112
  s_add_u32 s54, s62, 1437696
  buffer_load_dwordx4 v207, s[36:39], s54 offen lds
  s_add_u32 m0, s61, 94208
  s_add_u32 s54, s62, 1492992
  buffer_load_dwordx4 v207, s[36:39], s54 offen lds
  v_add_u32 v215, 135168, v210
  ds_read_b64_tr_b16 a[48:49], v215 offset:0
  ds_read_b64_tr_b16 a[50:51], v215 offset:1024
  ds_read_b64_tr_b16 a[52:53], v215 offset:4096
  ds_read_b64_tr_b16 a[54:55], v215 offset:5120
  ds_read_b64_tr_b16 a[56:57], v215 offset:8192
  ds_read_b64_tr_b16 a[58:59], v215 offset:9216
  ds_read_b64_tr_b16 a[60:61], v215 offset:12288
  ds_read_b64_tr_b16 a[62:63], v215 offset:13312
  s_waitcnt vmcnt(20) lgkmcnt(0)
  s_barrier
  s_add_u32 m0, s61, 98304
  s_add_u32 s54, s62, 1327104
  buffer_load_dwordx4 v208, s[36:39], s54 offen lds
  s_add_u32 m0, s61, 102400
  s_add_u32 s54, s62, 1382400
  buffer_load_dwordx4 v208, s[36:39], s54 offen lds
  s_add_u32 m0, s61, 106496
  s_add_u32 s54, s62, 1437696
  buffer_load_dwordx4 v208, s[36:39], s54 offen lds
  s_add_u32 m0, s61, 110592
  s_add_u32 s54, s62, 1492992
  buffer_load_dwordx4 v208, s[36:39], s54 offen lds
  v_add_u32 v215, 36864, v210
  ds_read_b64_tr_b16 a[192:193], v215 offset:0
  ds_read_b64_tr_b16 a[194:195], v215 offset:1024
  ds_read_b64_tr_b16 a[196:197], v215 offset:4096
  ds_read_b64_tr_b16 a[198:199], v215 offset:5120
  ds_read_b64_tr_b16 a[200:201], v215 offset:8192
  ds_read_b64_tr_b16 a[202:203], v215 offset:9216
  ds_read_b64_tr_b16 a[204:205], v215 offset:12288
  ds_read_b64_tr_b16 a[206:207], v215 offset:13312
  s_waitcnt vmcnt(20) lgkmcnt(0)
  s_barrier
  s_add_u32 m0, s61, 0
  s_add_u32 s54, s62, 1548288
  buffer_load_dwordx4 v207, s[36:39], s54 offen lds
  s_add_u32 m0, s61, 4096
  s_add_u32 s54, s62, 1603584
  buffer_load_dwordx4 v207, s[36:39], s54 offen lds
  s_add_u32 m0, s61, 8192
  s_add_u32 s54, s62, 1658880
  buffer_load_dwordx4 v207, s[36:39], s54 offen lds
  s_add_u32 m0, s61, 12288
  s_add_u32 s54, s62, 1714176
  buffer_load_dwordx4 v207, s[36:39], s54 offen lds
  v_add_u32 v215, 53248, v210
  ds_read_b64_tr_b16 a[64:65], v215 offset:0
  ds_read_b64_tr_b16 a[66:67], v215 offset:1024
  ds_read_b64_tr_b16 a[68:69], v215 offset:4096
  ds_read_b64_tr_b16 a[70:71], v215 offset:5120
  ds_read_b64_tr_b16 a[72:73], v215 offset:8192
  ds_read_b64_tr_b16 a[74:75], v215 offset:9216
  ds_read_b64_tr_b16 a[76:77], v215 offset:12288
  ds_read_b64_tr_b16 a[78:79], v215 offset:13312
  s_waitcnt vmcnt(20) lgkmcnt(0)
  s_barrier
  s_add_u32 m0, s61, 16384
  s_add_u32 s54, s62, 1548288
  buffer_load_dwordx4 v208, s[36:39], s54 offen lds
  s_add_u32 m0, s61, 20480
  s_add_u32 s54, s62, 1603584
  buffer_load_dwordx4 v208, s[36:39], s54 offen lds
  s_add_u32 m0, s61, 24576
  s_add_u32 s54, s62, 1658880
  buffer_load_dwordx4 v208, s[36:39], s54 offen lds
  s_add_u32 m0, s61, 28672
  s_add_u32 s54, s62, 1714176
  buffer_load_dwordx4 v208, s[36:39], s54 offen lds
  v_add_u32 v215, 69632, v210
  ds_read_b64_tr_b16 a[208:209], v215 offset:0
  ds_read_b64_tr_b16 a[210:211], v215 offset:1024
  ds_read_b64_tr_b16 a[212:213], v215 offset:4096
  ds_read_b64_tr_b16 a[214:215], v215 offset:5120
  ds_read_b64_tr_b16 a[216:217], v215 offset:8192
  ds_read_b64_tr_b16 a[218:219], v215 offset:9216
  ds_read_b64_tr_b16 a[220:221], v215 offset:12288
  ds_read_b64_tr_b16 a[222:223], v215 offset:13312
  s_waitcnt vmcnt(20) lgkmcnt(0)
  s_barrier
  s_add_u32 m0, s61, 32768
  s_add_u32 s54, s62, 1769472
  buffer_load_dwordx4 v207, s[36:39], s54 offen lds
  s_add_u32 m0, s61, 36864
  s_add_u32 s54, s62, 1824768
  buffer_load_dwordx4 v207, s[36:39], s54 offen lds
  s_add_u32 m0, s61, 40960
  s_add_u32 s54, s62, 1880064
  buffer_load_dwordx4 v207, s[36:39], s54 offen lds
  s_add_u32 m0, s61, 45056
  s_add_u32 s54, s62, 1935360
  buffer_load_dwordx4 v207, s[36:39], s54 offen lds
  v_add_u32 v215, 86016, v210
  ds_read_b64_tr_b16 a[80:81], v215 offset:0
  ds_read_b64_tr_b16 a[82:83], v215 offset:1024
  ds_read_b64_tr_b16 a[84:85], v215 offset:4096
  ds_read_b64_tr_b16 a[86:87], v215 offset:5120
  ds_read_b64_tr_b16 a[88:89], v215 offset:8192
  ds_read_b64_tr_b16 a[90:91], v215 offset:9216
  ds_read_b64_tr_b16 a[92:93], v215 offset:12288
  ds_read_b64_tr_b16 a[94:95], v215 offset:13312
  s_waitcnt vmcnt(20) lgkmcnt(0)
  s_barrier
  s_add_u32 m0, s61, 49152
  s_add_u32 s54, s62, 1769472
  buffer_load_dwordx4 v208, s[36:39], s54 offen lds
  s_add_u32 m0, s61, 53248
  s_add_u32 s54, s62, 1824768
  buffer_load_dwordx4 v208, s[36:39], s54 offen lds
  s_add_u32 m0, s61, 57344
  s_add_u32 s54, s62, 1880064
  buffer_load_dwordx4 v208, s[36:39], s54 offen lds
  s_add_u32 m0, s61, 61440
  s_add_u32 s54, s62, 1935360
  buffer_load_dwordx4 v208, s[36:39], s54 offen lds
  v_add_u32 v215, 102400, v210
  ds_read_b64_tr_b16 a[224:225], v215 offset:0
  ds_read_b64_tr_b16 a[226:227], v215 offset:1024
  ds_read_b64_tr_b16 a[228:229], v215 offset:4096
  ds_read_b64_tr_b16 a[230:231], v215 offset:5120
  ds_read_b64_tr_b16 a[232:233], v215 offset:8192
  ds_read_b64_tr_b16 a[234:235], v215 offset:9216
  ds_read_b64_tr_b16 a[236:237], v215 offset:12288
  ds_read_b64_tr_b16 a[238:239], v215 offset:13312
  s_waitcnt vmcnt(20) lgkmcnt(0)
  s_barrier
  v_add_u32 v215, 118784, v210
  ds_read_b64_tr_b16 a[96:97], v215 offset:0
  ds_read_b64_tr_b16 a[98:99], v215 offset:1024
  ds_read_b64_tr_b16 a[100:101], v215 offset:4096
  ds_read_b64_tr_b16 a[102:103], v215 offset:5120
  ds_read_b64_tr_b16 a[104:105], v215 offset:8192
  ds_read_b64_tr_b16 a[106:107], v215 offset:9216
  ds_read_b64_tr_b16 a[108:109], v215 offset:12288
  ds_read_b64_tr_b16 a[110:111], v215 offset:13312
  s_waitcnt vmcnt(16) lgkmcnt(0)
  s_barrier
  v_add_u32 v215, 135168, v210
  ds_read_b64_tr_b16 a[240:241], v215 offset:0
  ds_read_b64_tr_b16 a[242:243], v215 offset:1024
  ds_read_b64_tr_b16 a[244:245], v215 offset:4096
  ds_read_b64_tr_b16 a[246:247], v215 offset:5120
  ds_read_b64_tr_b16 a[248:249], v215 offset:8192
  ds_read_b64_tr_b16 a[250:251], v215 offset:9216
  ds_read_b64_tr_b16 a[252:253], v215 offset:12288
  ds_read_b64_tr_b16 a[254:255], v215 offset:13312
  s_waitcnt vmcnt(12) lgkmcnt(0)
  s_barrier
  v_add_u32 v215, 36864, v210
  ds_read_b64_tr_b16 a[112:113], v215 offset:0
  ds_read_b64_tr_b16 a[114:115], v215 offset:1024
  ds_read_b64_tr_b16 a[116:117], v215 offset:4096
  ds_read_b64_tr_b16 a[118:119], v215 offset:5120
  ds_read_b64_tr_b16 a[120:121], v215 offset:8192
  ds_read_b64_tr_b16 a[122:123], v215 offset:9216
  ds_read_b64_tr_b16 a[124:125], v215 offset:12288
  ds_read_b64_tr_b16 a[126:127], v215 offset:13312
  s_waitcnt vmcnt(8) lgkmcnt(0)
  s_barrier
  v_add_u32 v215, 53248, v210
  ds_read_b64_tr_b16 v[224:225], v215 offset:0
  ds_read_b64_tr_b16 v[226:227], v215 offset:1024
  ds_read_b64_tr_b16 v[228:229], v215 offset:4096
  ds_read_b64_tr_b16 v[230:231], v215 offset:5120
  ds_read_b64_tr_b16 v[232:233], v215 offset:8192
  ds_read_b64_tr_b16 v[234:235], v215 offset:9216
  ds_read_b64_tr_b16 v[236:237], v215 offset:12288
  ds_read_b64_tr_b16 v[238:239], v215 offset:13312
  s_waitcnt vmcnt(4) lgkmcnt(0)
  s_barrier
  v_add_u32 v215, 69632, v210
  ds_read_b64_tr_b16 a[128:129], v215 offset:0
  ds_read_b64_tr_b16 a[130:131], v215 offset:1024
  ds_read_b64_tr_b16 a[132:133], v215 offset:4096
  ds_read_b64_tr_b16 a[134:135], v215 offset:5120
  ds_read_b64_tr_b16 a[136:137], v215 offset:8192
  ds_read_b64_tr_b16 a[138:139], v215 offset:9216
  ds_read_b64_tr_b16 a[140:141], v215 offset:12288
  ds_read_b64_tr_b16 a[142:143], v215 offset:13312
  s_waitcnt vmcnt(0) lgkmcnt(0)
  s_barrier
  v_add_u32 v215, 86016, v210
  ds_read_b64_tr_b16 v[240:241], v215 offset:0
  ds_read_b64_tr_b16 v[242:243], v215 offset:1024
  ds_read_b64_tr_b16 v[244:245], v215 offset:4096
  ds_read_b64_tr_b16 v[246:247], v215 offset:5120
  ds_read_b64_tr_b16 v[248:249], v215 offset:8192
  ds_read_b64_tr_b16 v[250:251], v215 offset:9216
  ds_read_b64_tr_b16 v[252:253], v215 offset:12288
  ds_read_b64_tr_b16 v[254:255], v215 offset:13312
  s_waitcnt lgkmcnt(0)
  s_barrier
  v_and_b32 v211, 31, v200
  v_mul_u32_u24 v218, 516, v211
  v_lshrrev_b32 v212, 5, v200
  v_lshl_add_u32 v218, v212, 3, v218
  s_lshl_b32 s54, s52, 6
  s_add_u32 s54, s54, 73728
  v_add_u32 v218, s54, v218
  s_lshl_b32 s60, s69, 2
  s_mul_i32 s60, s60, 36864
  ds_read_b128 v[32:35], v203 offset:0
  ds_read_b128 v[36:39], v204 offset:0
  ds_read_b128 v[40:43], v205 offset:0
  s_waitcnt lgkmcnt(2)
  v_mfma_f32_32x32x16_bf16 v[0:15], a[0:3], v[32:35], 0
  ds_read_b128 v[44:47], v206 offset:0
  s_add_u32 m0, s67, 36864
  s_nop 0
  buffer_load_dwordx4 v202, s[4:7], s60 offen offset:0 lds
  v_mfma_f32_32x32x16_bf16 v[16:31], a[144:147], v[32:35], 0
  s_waitcnt lgkmcnt(2)
  v_mfma_f32_32x32x16_bf16 v[0:15], a[4:7], v[36:39], v[0:15]
  ds_read_b128 v[32:35], v203 offset:1024
  s_add_u32 m0, s67, 37760
  s_nop 0
  buffer_load_dwordx4 v202, s[4:7], s60 offen offset:128 lds
  v_mfma_f32_32x32x16_bf16 v[16:31], a[148:151], v[36:39], v[16:31]
  s_waitcnt lgkmcnt(2)
  v_mfma_f32_32x32x16_bf16 v[0:15], a[8:11], v[40:43], v[0:15]
  ds_read_b128 v[36:39], v204 offset:1024
  s_add_u32 m0, s67, 38656
  s_nop 0
  buffer_load_dwordx4 v202, s[4:7], s60 offen offset:256 lds
  v_mfma_f32_32x32x16_bf16 v[16:31], a[152:155], v[40:43], v[16:31]
  s_waitcnt lgkmcnt(2)
  v_mfma_f32_32x32x16_bf16 v[0:15], a[12:15], v[44:47], v[0:15]
  ds_read_b128 v[40:43], v205 offset:1024
  s_add_u32 m0, s67, 39552
  s_nop 0
  buffer_load_dwordx4 v202, s[4:7], s60 offen offset:384 lds
  v_mfma_f32_32x32x16_bf16 v[16:31], a[156:159], v[44:47], v[16:31]
  s_waitcnt lgkmcnt(2)
  v_mfma_f32_32x32x16_bf16 v[0:15], a[16:19], v[32:35], v[0:15]
  ds_read_b128 v[44:47], v206 offset:1024
  s_add_u32 m0, s67, 40448
  s_nop 0
  buffer_load_dwordx4 v202, s[4:7], s60 offen offset:512 lds
  v_mfma_f32_32x32x16_bf16 v[16:31], a[160:163], v[32:35], v[16:31]
  s_waitcnt lgkmcnt(2)
  v_mfma_f32_32x32x16_bf16 v[0:15], a[20:23], v[36:39], v[0:15]
  ds_read_b128 v[32:35], v203 offset:2048
  s_add_u32 m0, s67, 41344
  s_nop 0
  buffer_load_dwordx4 v202, s[4:7], s60 offen offset:640 lds
  v_mfma_f32_32x32x16_bf16 v[16:31], a[164:167], v[36:39], v[16:31]
  s_waitcnt lgkmcnt(2)
  v_mfma_f32_32x32x16_bf16 v[0:15], a[24:27], v[40:43], v[0:15]
  ds_read_b128 v[36:39], v204 offset:2048
  s_add_u32 m0, s67, 42240
  s_nop 0
  buffer_load_dwordx4 v202, s[4:7], s60 offen offset:768 lds
  v_mfma_f32_32x32x16_bf16 v[16:31], a[168:171], v[40:43], v[16:31]
  s_waitcnt lgkmcnt(2)
  v_mfma_f32_32x32x16_bf16 v[0:15], a[28:31], v[44:47], v[0:15]
  ds_read_b128 v[40:43], v205 offset:2048
  s_add_u32 m0, s67, 43136
  s_nop 0
  buffer_load_dwordx4 v202, s[4:7], s60 offen offset:896 lds
  v_mfma_f32_32x32x16_bf16 v[16:31], a[172:175], v[44:47], v[16:31]
  s_waitcnt lgkmcnt(2)
  v_mfma_f32_32x32x16_bf16 v[0:15], a[32:35], v[32:35], v[0:15]
  ds_read_b128 v[44:47], v206 offset:2048
  s_add_u32 m0, s67, 44032
  s_nop 0
  buffer_load_dwordx4 v202, s[4:7], s60 offen offset:1024 lds
  v_mfma_f32_32x32x16_bf16 v[16:31], a[176:179], v[32:35], v[16:31]
  s_waitcnt lgkmcnt(2)
  v_mfma_f32_32x32x16_bf16 v[0:15], a[36:39], v[36:39], v[0:15]
  ds_read_b128 v[32:35], v203 offset:3072
  v_mfma_f32_32x32x16_bf16 v[16:31], a[180:183], v[36:39], v[16:31]
  s_waitcnt lgkmcnt(2)
  v_mfma_f32_32x32x16_bf16 v[0:15], a[40:43], v[40:43], v[0:15]
  ds_read_b128 v[36:39], v204 offset:3072
  v_mfma_f32_32x32x16_bf16 v[16:31], a[184:187], v[40:43], v[16:31]
  s_waitcnt lgkmcnt(2)
  v_mfma_f32_32x32x16_bf16 v[0:15], a[44:47], v[44:47], v[0:15]
  ds_read_b128 v[40:43], v205 offset:3072
  v_mfma_f32_32x32x16_bf16 v[16:31], a[188:191], v[44:47], v[16:31]
  s_waitcnt lgkmcnt(2)
  v_mfma_f32_32x32x16_bf16 v[0:15], a[48:51], v[32:35], v[0:15]
  ds_read_b128 v[44:47], v206 offset:3072
  v_mfma_f32_32x32x16_bf16 v[16:31], a[192:195], v[32:35], v[16:31]
  s_waitcnt lgkmcnt(2)
  v_mfma_f32_32x32x16_bf16 v[0:15], a[52:55], v[36:39], v[0:15]
  ds_read_b128 v[32:35], v203 offset:4096
  v_mfma_f32_32x32x16_bf16 v[16:31], a[196:199], v[36:39], v[16:31]
  s_waitcnt lgkmcnt(2)
  v_mfma_f32_32x32x16_bf16 v[0:15], a[56:59], v[40:43], v[0:15]
  ds_read_b128 v[36:39], v204 offset:4096
  v_mfma_f32_32x32x16_bf16 v[16:31], a[200:203], v[40:43], v[16:31]
  s_waitcnt lgkmcnt(2)
  v_mfma_f32_32x32x16_bf16 v[0:15], a[60:63], v[44:47], v[0:15]
  ds_read_b128 v[40:43], v205 offset:4096
  v_mfma_f32_32x32x16_bf16 v[16:31], a[204:207], v[44:47], v[16:31]
  s_waitcnt lgkmcnt(2)
  v_mfma_f32_32x32x16_bf16 v[0:15], a[64:67], v[32:35], v[0:15]
  ds_read_b128 v[44:47], v206 offset:4096
  v_mfma_f32_32x32x16_bf16 v[16:31], a[208:211], v[32:35], v[16:31]
  s_waitcnt lgkmcnt(2)
  v_mfma_f32_32x32x16_bf16 v[0:15], a[68:71], v[36:39], v[0:15]
  ds_read_b128 v[32:35], v203 offset:5120
  v_mfma_f32_32x32x16_bf16 v[16:31], a[212:215], v[36:39], v[16:31]
  s_waitcnt lgkmcnt(2)
  v_mfma_f32_32x32x16_bf16 v[0:15], a[72:75], v[40:43], v[0:15]
  ds_read_b128 v[36:39], v204 offset:5120
  v_mfma_f32_32x32x16_bf16 v[16:31], a[216:219], v[40:43], v[16:31]
  s_waitcnt lgkmcnt(2)
  v_mfma_f32_32x32x16_bf16 v[0:15], a[76:79], v[44:47], v[0:15]
  ds_read_b128 v[40:43], v205 offset:5120
  v_mfma_f32_32x32x16_bf16 v[16:31], a[220:223], v[44:47], v[16:31]
  s_waitcnt lgkmcnt(2)
  v_mfma_f32_32x32x16_bf16 v[0:15], a[80:83], v[32:35], v[0:15]
  ds_read_b128 v[44:47], v206 offset:5120
  v_mfma_f32_32x32x16_bf16 v[16:31], a[224:227], v[32:35], v[16:31]
  s_waitcnt lgkmcnt(2)
  v_mfma_f32_32x32x16_bf16 v[0:15], a[84:87], v[36:39], v[0:15]
  ds_read_b128 v[32:35], v203 offset:6144
  v_mfma_f32_32x32x16_bf16 v[16:31], a[228:231], v[36:39], v[16:31]
  s_waitcnt lgkmcnt(2)
  v_mfma_f32_32x32x16_bf16 v[0:15], a[88:91], v[40:43], v[0:15]
  ds_read_b128 v[36:39], v204 offset:6144
  v_mfma_f32_32x32x16_bf16 v[16:31], a[232:235], v[40:43], v[16:31]
  s_waitcnt lgkmcnt(2)
  v_mfma_f32_32x32x16_bf16 v[0:15], a[92:95], v[44:47], v[0:15]
  ds_read_b128 v[40:43], v205 offset:6144
  v_mfma_f32_32x32x16_bf16 v[16:31], a[236:239], v[44:47], v[16:31]
  s_waitcnt lgkmcnt(2)
  v_mfma_f32_32x32x16_bf16 v[0:15], a[96:99], v[32:35], v[0:15]
  ds_read_b128 v[44:47], v206 offset:6144
  v_mfma_f32_32x32x16_bf16 v[16:31], a[240:243], v[32:35], v[16:31]
  s_waitcnt lgkmcnt(2)
  v_mfma_f32_32x32x16_bf16 v[0:15], a[100:103], v[36:39], v[0:15]
  ds_read_b128 v[32:35], v203 offset:7168
  v_mfma_f32_32x32x16_bf16 v[16:31], a[244:247], v[36:39], v[16:31]
  s_waitcnt lgkmcnt(2)
  v_mfma_f32_32x32x16_bf16 v[0:15], a[104:107], v[40:43], v[0:15]
  ds_read_b128 v[36:39], v204 offset:7168
  v_mfma_f32_32x32x16_bf16 v[16:31], a[248:251], v[40:43], v[16:31]
  s_waitcnt lgkmcnt(2)
  v_mfma_f32_32x32x16_bf16 v[0:15], a[108:111], v[44:47], v[0:15]
  ds_read_b128 v[40:43], v205 offset:7168
  v_mfma_f32_32x32x16_bf16 v[16:31], a[252:255], v[44:47], v[16:31]
  s_waitcnt lgkmcnt(2)
  v_mfma_f32_32x32x16_bf16 v[0:15], a[112:115], v[32:35], v[0:15]
  ds_read_b128 v[44:47], v206 offset:7168
  v_mfma_f32_32x32x16_bf16 v[16:31], v[224:227], v[32:35], v[16:31]
  s_waitcnt lgkmcnt(2)
  v_mfma_f32_32x32x16_bf16 v[0:15], a[116:119], v[36:39], v[0:15]
  ds_read_b128 v[32:35], v203 offset:8192
  v_mfma_f32_32x32x16_bf16 v[16:31], v[228:231], v[36:39], v[16:31]
  s_waitcnt lgkmcnt(2)
  v_mfma_f32_32x32x16_bf16 v[0:15], a[120:123], v[40:43], v[0:15]
  ds_read_b128 v[36:39], v204 offset:8192
  v_mfma_f32_32x32x16_bf16 v[16:31], v[232:235], v[40:43], v[16:31]
  s_waitcnt lgkmcnt(2)
  v_mfma_f32_32x32x16_bf16 v[0:15], a[124:127], v[44:47], v[0:15]
  ds_read_b128 v[40:43], v205 offset:8192
  v_mfma_f32_32x32x16_bf16 v[16:31], v[236:239], v[44:47], v[16:31]
  s_waitcnt lgkmcnt(2)
  v_mfma_f32_32x32x16_bf16 v[0:15], a[128:131], v[32:35], v[0:15]
  ds_read_b128 v[44:47], v206 offset:8192
  v_mfma_f32_32x32x16_bf16 v[16:31], v[240:243], v[32:35], v[16:31]
  s_waitcnt lgkmcnt(2)
  v_mfma_f32_32x32x16_bf16 v[0:15], a[132:135], v[36:39], v[0:15]
  v_mfma_f32_32x32x16_bf16 v[16:31], v[244:247], v[36:39], v[16:31]
  s_waitcnt lgkmcnt(1)
  v_mfma_f32_32x32x16_bf16 v[0:15], a[136:139], v[40:43], v[0:15]
  v_mfma_f32_32x32x16_bf16 v[16:31], v[248:251], v[40:43], v[16:31]
  s_waitcnt lgkmcnt(0)
  v_mfma_f32_32x32x16_bf16 v[0:15], a[140:143], v[44:47], v[0:15]
  v_mfma_f32_32x32x16_bf16 v[16:31], v[252:255], v[44:47], v[16:31]
  s_add_u32 s60, s60, 36864
  s_nop 2
  v_cvt_pk_bf16_f32 v48, v0, v1
  v_cvt_pk_bf16_f32 v49, v2, v3
  ds_write2_b32 v218, v48, v49 offset0:0 offset1:1
  v_cvt_pk_bf16_f32 v48, v4, v5
  v_cvt_pk_bf16_f32 v49, v6, v7
  ds_write2_b32 v218, v48, v49 offset0:4 offset1:5
  v_cvt_pk_bf16_f32 v48, v8, v9
  v_cvt_pk_bf16_f32 v49, v10, v11
  ds_write2_b32 v218, v48, v49 offset0:8 offset1:9
  v_cvt_pk_bf16_f32 v48, v12, v13
  v_cvt_pk_bf16_f32 v49, v14, v15
  ds_write2_b32 v218, v48, v49 offset0:12 offset1:13
  v_cvt_pk_bf16_f32 v48, v16, v17
  v_cvt_pk_bf16_f32 v49, v18, v19
  ds_write2_b32 v218, v48, v49 offset0:64 offset1:65
  v_cvt_pk_bf16_f32 v48, v20, v21
  v_cvt_pk_bf16_f32 v49, v22, v23
  ds_write2_b32 v218, v48, v49 offset0:68 offset1:69
  v_cvt_pk_bf16_f32 v48, v24, v25
  v_cvt_pk_bf16_f32 v49, v26, v27
  ds_write2_b32 v218, v48, v49 offset0:72 offset1:73
  v_cvt_pk_bf16_f32 v48, v28, v29
  v_cvt_pk_bf16_f32 v49, v30, v31
  ds_write2_b32 v218, v48, v49 offset0:76 offset1:77
  v_add_u32 v218, 16512, v218
  s_waitcnt vmcnt(0) lgkmcnt(0)
  s_barrier
  ds_read_b128 v[32:35], v203 offset:36864
  ds_read_b128 v[36:39], v204 offset:36864
  ds_read_b128 v[40:43], v205 offset:36864
  s_waitcnt lgkmcnt(2)
  v_mfma_f32_32x32x16_bf16 v[0:15], a[0:3], v[32:35], 0
  ds_read_b128 v[44:47], v206 offset:36864
  s_add_u32 m0, s67, 0
  s_nop 0
  buffer_load_dwordx4 v202, s[4:7], s60 offen offset:0 lds
  v_mfma_f32_32x32x16_bf16 v[16:31], a[144:147], v[32:35], 0
  s_waitcnt lgkmcnt(2)
  v_mfma_f32_32x32x16_bf16 v[0:15], a[4:7], v[36:39], v[0:15]
  ds_read_b128 v[32:35], v203 offset:37888
  s_add_u32 m0, s67, 896
  s_nop 0
  buffer_load_dwordx4 v202, s[4:7], s60 offen offset:128 lds
  v_mfma_f32_32x32x16_bf16 v[16:31], a[148:151], v[36:39], v[16:31]
  s_waitcnt lgkmcnt(2)
  v_mfma_f32_32x32x16_bf16 v[0:15], a[8:11], v[40:43], v[0:15]
  ds_read_b128 v[36:39], v204 offset:37888
  s_add_u32 m0, s67, 1792
  s_nop 0
  buffer_load_dwordx4 v202, s[4:7], s60 offen offset:256 lds
  v_mfma_f32_32x32x16_bf16 v[16:31], a[152:155], v[40:43], v[16:31]
  s_waitcnt lgkmcnt(2)
  v_mfma_f32_32x32x16_bf16 v[0:15], a[12:15], v[44:47], v[0:15]
  ds_read_b128 v[40:43], v205 offset:37888
  s_add_u32 m0, s67, 2688
  s_nop 0
  buffer_load_dwordx4 v202, s[4:7], s60 offen offset:384 lds
  v_mfma_f32_32x32x16_bf16 v[16:31], a[156:159], v[44:47], v[16:31]
  s_waitcnt lgkmcnt(2)
  v_mfma_f32_32x32x16_bf16 v[0:15], a[16:19], v[32:35], v[0:15]
  ds_read_b128 v[44:47], v206 offset:37888
  s_add_u32 m0, s67, 3584
  s_nop 0
  buffer_load_dwordx4 v202, s[4:7], s60 offen offset:512 lds
  v_mfma_f32_32x32x16_bf16 v[16:31], a[160:163], v[32:35], v[16:31]
  s_waitcnt lgkmcnt(2)
  v_mfma_f32_32x32x16_bf16 v[0:15], a[20:23], v[36:39], v[0:15]
  ds_read_b128 v[32:35], v203 offset:38912
  s_add_u32 m0, s67, 4480
  s_nop 0
  buffer_load_dwordx4 v202, s[4:7], s60 offen offset:640 lds
  v_mfma_f32_32x32x16_bf16 v[16:31], a[164:167], v[36:39], v[16:31]
  s_waitcnt lgkmcnt(2)
  v_mfma_f32_32x32x16_bf16 v[0:15], a[24:27], v[40:43], v[0:15]
  ds_read_b128 v[36:39], v204 offset:38912
  s_add_u32 m0, s67, 5376
  s_nop 0
  buffer_load_dwordx4 v202, s[4:7], s60 offen offset:768 lds
  v_mfma_f32_32x32x16_bf16 v[16:31], a[168:171], v[40:43], v[16:31]
  s_waitcnt lgkmcnt(2)
  v_mfma_f32_32x32x16_bf16 v[0:15], a[28:31], v[44:47], v[0:15]
  ds_read_b128 v[40:43], v205 offset:38912
  s_add_u32 m0, s67, 6272
  s_nop 0
  buffer_load_dwordx4 v202, s[4:7], s60 offen offset:896 lds
  v_mfma_f32_32x32x16_bf16 v[16:31], a[172:175], v[44:47], v[16:31]
  s_waitcnt lgkmcnt(2)
  v_mfma_f32_32x32x16_bf16 v[0:15], a[32:35], v[32:35], v[0:15]
  ds_read_b128 v[44:47], v206 offset:38912
  s_add_u32 m0, s67, 7168
  s_nop 0
  buffer_load_dwordx4 v202, s[4:7], s60 offen offset:1024 lds
  v_mfma_f32_32x32x16_bf16 v[16:31], a[176:179], v[32:35], v[16:31]
  s_waitcnt lgkmcnt(2)
  v_mfma_f32_32x32x16_bf16 v[0:15], a[36:39], v[36:39], v[0:15]
  ds_read_b128 v[32:35], v203 offset:39936
  v_mfma_f32_32x32x16_bf16 v[16:31], a[180:183], v[36:39], v[16:31]
  s_waitcnt lgkmcnt(2)
  v_mfma_f32_32x32x16_bf16 v[0:15], a[40:43], v[40:43], v[0:15]
  ds_read_b128 v[36:39], v204 offset:39936
  v_mfma_f32_32x32x16_bf16 v[16:31], a[184:187], v[40:43], v[16:31]
  s_waitcnt lgkmcnt(2)
  v_mfma_f32_32x32x16_bf16 v[0:15], a[44:47], v[44:47], v[0:15]
  ds_read_b128 v[40:43], v205 offset:39936
  v_mfma_f32_32x32x16_bf16 v[16:31], a[188:191], v[44:47], v[16:31]
  s_waitcnt lgkmcnt(2)
  v_mfma_f32_32x32x16_bf16 v[0:15], a[48:51], v[32:35], v[0:15]
  ds_read_b128 v[44:47], v206 offset:39936
  v_mfma_f32_32x32x16_bf16 v[16:31], a[192:195], v[32:35], v[16:31]
  s_waitcnt lgkmcnt(2)
  v_mfma_f32_32x32x16_bf16 v[0:15], a[52:55], v[36:39], v[0:15]
  ds_read_b128 v[32:35], v203 offset:40960
  v_mfma_f32_32x32x16_bf16 v[16:31], a[196:199], v[36:39], v[16:31]
  s_waitcnt lgkmcnt(2)
  v_mfma_f32_32x32x16_bf16 v[0:15], a[56:59], v[40:43], v[0:15]
  ds_read_b128 v[36:39], v204 offset:40960
  v_mfma_f32_32x32x16_bf16 v[16:31], a[200:203], v[40:43], v[16:31]
  s_waitcnt lgkmcnt(2)
  v_mfma_f32_32x32x16_bf16 v[0:15], a[60:63], v[44:47], v[0:15]
  ds_read_b128 v[40:43], v205 offset:40960
  v_mfma_f32_32x32x16_bf16 v[16:31], a[204:207], v[44:47], v[16:31]
  s_waitcnt lgkmcnt(2)
  v_mfma_f32_32x32x16_bf16 v[0:15], a[64:67], v[32:35], v[0:15]
  ds_read_b128 v[44:47], v206 offset:40960
  v_mfma_f32_32x32x16_bf16 v[16:31], a[208:211], v[32:35], v[16:31]
  s_waitcnt lgkmcnt(2)
  v_mfma_f32_32x32x16_bf16 v[0:15], a[68:71], v[36:39], v[0:15]
  ds_read_b128 v[32:35], v203 offset:41984
  v_mfma_f32_32x32x16_bf16 v[16:31], a[212:215], v[36:39], v[16:31]
  s_waitcnt lgkmcnt(2)
  v_mfma_f32_32x32x16_bf16 v[0:15], a[72:75], v[40:43], v[0:15]
  ds_read_b128 v[36:39], v204 offset:41984
  v_mfma_f32_32x32x16_bf16 v[16:31], a[216:219], v[40:43], v[16:31]
  s_waitcnt lgkmcnt(2)
  v_mfma_f32_32x32x16_bf16 v[0:15], a[76:79], v[44:47], v[0:15]
  ds_read_b128 v[40:43], v205 offset:41984
  v_mfma_f32_32x32x16_bf16 v[16:31], a[220:223], v[44:47], v[16:31]
  s_waitcnt lgkmcnt(2)
  v_mfma_f32_32x32x16_bf16 v[0:15], a[80:83], v[32:35], v[0:15]
  ds_read_b128 v[44:47], v206 offset:41984
  v_mfma_f32_32x32x16_bf16 v[16:31], a[224:227], v[32:35], v[16:31]
  s_waitcnt lgkmcnt(2)
  v_mfma_f32_32x32x16_bf16 v[0:15], a[84:87], v[36:39], v[0:15]
  ds_read_b128 v[32:35], v203 offset:43008
  v_mfma_f32_32x32x16_bf16 v[16:31], a[228:231], v[36:39], v[16:31]
  s_waitcnt lgkmcnt(2)
  v_mfma_f32_32x32x16_bf16 v[0:15], a[88:91], v[40:43], v[0:15]
  ds_read_b128 v[36:39], v204 offset:43008
  v_mfma_f32_32x32x16_bf16 v[16:31], a[232:235], v[40:43], v[16:31]
  s_waitcnt lgkmcnt(2)
  v_mfma_f32_32x32x16_bf16 v[0:15], a[92:95], v[44:47], v[0:15]
  ds_read_b128 v[40:43], v205 offset:43008
  v_mfma_f32_32x32x16_bf16 v[16:31], a[236:239], v[44:47], v[16:31]
  s_waitcnt lgkmcnt(2)
  v_mfma_f32_32x32x16_bf16 v[0:15], a[96:99], v[32:35], v[0:15]
  ds_read_b128 v[44:47], v206 offset:43008
  v_mfma_f32_32x32x16_bf16 v[16:31], a[240:243], v[32:35], v[16:31]
  s_waitcnt lgkmcnt(2)
  v_mfma_f32_32x32x16_bf16 v[0:15], a[100:103], v[36:39], v[0:15]
  ds_read_b128 v[32:35], v203 offset:44032
  v_mfma_f32_32x32x16_bf16 v[16:31], a[244:247], v[36:39], v[16:31]
  s_waitcnt lgkmcnt(2)
  v_mfma_f32_32x32x16_bf16 v[0:15], a[104:107], v[40:43], v[0:15]
  ds_read_b128 v[36:39], v204 offset:44032
  v_mfma_f32_32x32x16_bf16 v[16:31], a[248:251], v[40:43], v[16:31]
  s_waitcnt lgkmcnt(2)
  v_mfma_f32_32x32x16_bf16 v[0:15], a[108:111], v[44:47], v[0:15]
  ds_read_b128 v[40:43], v205 offset:44032
  v_mfma_f32_32x32x16_bf16 v[16:31], a[252:255], v[44:47], v[16:31]
  s_waitcnt lgkmcnt(2)
  v_mfma_f32_32x32x16_bf16 v[0:15], a[112:115], v[32:35], v[0:15]
  ds_read_b128 v[44:47], v206 offset:44032
  v_mfma_f32_32x32x16_bf16 v[16:31], v[224:227], v[32:35], v[16:31]
  s_waitcnt lgkmcnt(2)
  v_mfma_f32_32x32x16_bf16 v[0:15], a[116:119], v[36:39], v[0:15]
  ds_read_b128 v[32:35], v203 offset:45056
  v_mfma_f32_32x32x16_bf16 v[16:31], v[228:231], v[36:39], v[16:31]
  s_waitcnt lgkmcnt(2)
  v_mfma_f32_32x32x16_bf16 v[0:15], a[120:123], v[40:43], v[0:15]
  ds_read_b128 v[36:39], v204 offset:45056
  v_mfma_f32_32x32x16_bf16 v[16:31], v[232:235], v[40:43], v[16:31]
  s_waitcnt lgkmcnt(2)
  v_mfma_f32_32x32x16_bf16 v[0:15], a[124:127], v[44:47], v[0:15]
  ds_read_b128 v[40:43], v205 offset:45056
  v_mfma_f32_32x32x16_bf16 v[16:31], v[236:239], v[44:47], v[16:31]
  s_waitcnt lgkmcnt(2)
  v_mfma_f32_32x32x16_bf16 v[0:15], a[128:131], v[32:35], v[0:15]
  ds_read_b128 v[44:47], v206 offset:45056
  v_mfma_f32_32x32x16_bf16 v[16:31], v[240:243], v[32:35], v[16:31]
  s_waitcnt lgkmcnt(2)
  v_mfma_f32_32x32x16_bf16 v[0:15], a[132:135], v[36:39], v[0:15]
  v_mfma_f32_32x32x16_bf16 v[16:31], v[244:247], v[36:39], v[16:31]
  s_waitcnt lgkmcnt(1)
  v_mfma_f32_32x32x16_bf16 v[0:15], a[136:139], v[40:43], v[0:15]
  v_mfma_f32_32x32x16_bf16 v[16:31], v[248:251], v[40:43], v[16:31]
  s_waitcnt lgkmcnt(0)
  v_mfma_f32_32x32x16_bf16 v[0:15], a[140:143], v[44:47], v[0:15]
  v_mfma_f32_32x32x16_bf16 v[16:31], v[252:255], v[44:47], v[16:31]
  s_add_u32 s60, s60, 36864
  s_nop 2
  v_cvt_pk_bf16_f32 v48, v0, v1
  v_cvt_pk_bf16_f32 v49, v2, v3
  ds_write2_b32 v218, v48, v49 offset0:0 offset1:1
  v_cvt_pk_bf16_f32 v48, v4, v5
  v_cvt_pk_bf16_f32 v49, v6, v7
  ds_write2_b32 v218, v48, v49 offset0:4 offset1:5
  v_cvt_pk_bf16_f32 v48, v8, v9
  v_cvt_pk_bf16_f32 v49, v10, v11
  ds_write2_b32 v218, v48, v49 offset0:8 offset1:9
  v_cvt_pk_bf16_f32 v48, v12, v13
  v_cvt_pk_bf16_f32 v49, v14, v15
  ds_write2_b32 v218, v48, v49 offset0:12 offset1:13
  v_cvt_pk_bf16_f32 v48, v16, v17
  v_cvt_pk_bf16_f32 v49, v18, v19
  ds_write2_b32 v218, v48, v49 offset0:64 offset1:65
  v_cvt_pk_bf16_f32 v48, v20, v21
  v_cvt_pk_bf16_f32 v49, v22, v23
  ds_write2_b32 v218, v48, v49 offset0:68 offset1:69
  v_cvt_pk_bf16_f32 v48, v24, v25
  v_cvt_pk_bf16_f32 v49, v26, v27
  ds_write2_b32 v218, v48, v49 offset0:72 offset1:73
  v_cvt_pk_bf16_f32 v48, v28, v29
  v_cvt_pk_bf16_f32 v49, v30, v31
  ds_write2_b32 v218, v48, v49 offset0:76 offset1:77
  v_add_u32 v218, 16512, v218
  s_waitcnt vmcnt(0) lgkmcnt(0)
  s_barrier
  ds_read_b128 v[32:35], v203 offset:0
  ds_read_b128 v[36:39], v204 offset:0
  ds_read_b128 v[40:43], v205 offset:0
  s_waitcnt lgkmcnt(2)
  v_mfma_f32_32x32x16_bf16 v[0:15], a[0:3], v[32:35], 0
  ds_read_b128 v[44:47], v206 offset:0
  s_add_u32 m0, s67, 36864
  s_nop 0
  buffer_load_dwordx4 v202, s[4:7], s60 offen offset:0 lds
  v_mfma_f32_32x32x16_bf16 v[16:31], a[144:147], v[32:35], 0
  s_waitcnt lgkmcnt(2)
  v_mfma_f32_32x32x16_bf16 v[0:15], a[4:7], v[36:39], v[0:15]
  ds_read_b128 v[32:35], v203 offset:1024
  s_add_u32 m0, s67, 37760
  s_nop 0
  buffer_load_dwordx4 v202, s[4:7], s60 offen offset:128 lds
  v_mfma_f32_32x32x16_bf16 v[16:31], a[148:151], v[36:39], v[16:31]
  s_waitcnt lgkmcnt(2)
  v_mfma_f32_32x32x16_bf16 v[0:15], a[8:11], v[40:43], v[0:15]
  ds_read_b128 v[36:39], v204 offset:1024
  s_add_u32 m0, s67, 38656
  s_nop 0
  buffer_load_dwordx4 v202, s[4:7], s60 offen offset:256 lds
  v_mfma_f32_32x32x16_bf16 v[16:31], a[152:155], v[40:43], v[16:31]
  s_waitcnt lgkmcnt(2)
  v_mfma_f32_32x32x16_bf16 v[0:15], a[12:15], v[44:47], v[0:15]
  ds_read_b128 v[40:43], v205 offset:1024
  s_add_u32 m0, s67, 39552
  s_nop 0
  buffer_load_dwordx4 v202, s[4:7], s60 offen offset:384 lds
  v_mfma_f32_32x32x16_bf16 v[16:31], a[156:159], v[44:47], v[16:31]
  s_waitcnt lgkmcnt(2)
  v_mfma_f32_32x32x16_bf16 v[0:15], a[16:19], v[32:35], v[0:15]
  ds_read_b128 v[44:47], v206 offset:1024
  s_add_u32 m0, s67, 40448
  s_nop 0
  buffer_load_dwordx4 v202, s[4:7], s60 offen offset:512 lds
  v_mfma_f32_32x32x16_bf16 v[16:31], a[160:163], v[32:35], v[16:31]
  s_waitcnt lgkmcnt(2)
  v_mfma_f32_32x32x16_bf16 v[0:15], a[20:23], v[36:39], v[0:15]
  ds_read_b128 v[32:35], v203 offset:2048
  s_add_u32 m0, s67, 41344
  s_nop 0
  buffer_load_dwordx4 v202, s[4:7], s60 offen offset:640 lds
  v_mfma_f32_32x32x16_bf16 v[16:31], a[164:167], v[36:39], v[16:31]
  s_waitcnt lgkmcnt(2)
  v_mfma_f32_32x32x16_bf16 v[0:15], a[24:27], v[40:43], v[0:15]
  ds_read_b128 v[36:39], v204 offset:2048
  s_add_u32 m0, s67, 42240
  s_nop 0
  buffer_load_dwordx4 v202, s[4:7], s60 offen offset:768 lds
  v_mfma_f32_32x32x16_bf16 v[16:31], a[168:171], v[40:43], v[16:31]
  s_waitcnt lgkmcnt(2)
  v_mfma_f32_32x32x16_bf16 v[0:15], a[28:31], v[44:47], v[0:15]
  ds_read_b128 v[40:43], v205 offset:2048
  s_add_u32 m0, s67, 43136
  s_nop 0
  buffer_load_dwordx4 v202, s[4:7], s60 offen offset:896 lds
  v_mfma_f32_32x32x16_bf16 v[16:31], a[172:175], v[44:47], v[16:31]
  s_waitcnt lgkmcnt(2)
  v_mfma_f32_32x32x16_bf16 v[0:15], a[32:35], v[32:35], v[0:15]
  ds_read_b128 v[44:47], v206 offset:2048
  s_add_u32 m0, s67, 44032
  s_nop 0
  buffer_load_dwordx4 v202, s[4:7], s60 offen offset:1024 lds
  v_mfma_f32_32x32x16_bf16 v[16:31], a[176:179], v[32:35], v[16:31]
  s_waitcnt lgkmcnt(2)
  v_mfma_f32_32x32x16_bf16 v[0:15], a[36:39], v[36:39], v[0:15]
  ds_read_b128 v[32:35], v203 offset:3072
  v_mfma_f32_32x32x16_bf16 v[16:31], a[180:183], v[36:39], v[16:31]
  s_waitcnt lgkmcnt(2)
  v_mfma_f32_32x32x16_bf16 v[0:15], a[40:43], v[40:43], v[0:15]
  ds_read_b128 v[36:39], v204 offset:3072
  v_mfma_f32_32x32x16_bf16 v[16:31], a[184:187], v[40:43], v[16:31]
  s_waitcnt lgkmcnt(2)
  v_mfma_f32_32x32x16_bf16 v[0:15], a[44:47], v[44:47], v[0:15]
  ds_read_b128 v[40:43], v205 offset:3072
  v_mfma_f32_32x32x16_bf16 v[16:31], a[188:191], v[44:47], v[16:31]
  s_waitcnt lgkmcnt(2)
  v_mfma_f32_32x32x16_bf16 v[0:15], a[48:51], v[32:35], v[0:15]
  ds_read_b128 v[44:47], v206 offset:3072
  v_mfma_f32_32x32x16_bf16 v[16:31], a[192:195], v[32:35], v[16:31]
  s_waitcnt lgkmcnt(2)
  v_mfma_f32_32x32x16_bf16 v[0:15], a[52:55], v[36:39], v[0:15]
  ds_read_b128 v[32:35], v203 offset:4096
  v_mfma_f32_32x32x16_bf16 v[16:31], a[196:199], v[36:39], v[16:31]
  s_waitcnt lgkmcnt(2)
  v_mfma_f32_32x32x16_bf16 v[0:15], a[56:59], v[40:43], v[0:15]
  ds_read_b128 v[36:39], v204 offset:4096
  v_mfma_f32_32x32x16_bf16 v[16:31], a[200:203], v[40:43], v[16:31]
  s_waitcnt lgkmcnt(2)
  v_mfma_f32_32x32x16_bf16 v[0:15], a[60:63], v[44:47], v[0:15]
  ds_read_b128 v[40:43], v205 offset:4096
  v_mfma_f32_32x32x16_bf16 v[16:31], a[204:207], v[44:47], v[16:31]
  s_waitcnt lgkmcnt(2)
  v_mfma_f32_32x32x16_bf16 v[0:15], a[64:67], v[32:35], v[0:15]
  ds_read_b128 v[44:47], v206 offset:4096
  v_mfma_f32_32x32x16_bf16 v[16:31], a[208:211], v[32:35], v[16:31]
  s_waitcnt lgkmcnt(2)
  v_mfma_f32_32x32x16_bf16 v[0:15], a[68:71], v[36:39], v[0:15]
  ds_read_b128 v[32:35], v203 offset:5120
  v_mfma_f32_32x32x16_bf16 v[16:31], a[212:215], v[36:39], v[16:31]
  s_waitcnt lgkmcnt(2)
  v_mfma_f32_32x32x16_bf16 v[0:15], a[72:75], v[40:43], v[0:15]
  ds_read_b128 v[36:39], v204 offset:5120
  v_mfma_f32_32x32x16_bf16 v[16:31], a[216:219], v[40:43], v[16:31]
  s_waitcnt lgkmcnt(2)
  v_mfma_f32_32x32x16_bf16 v[0:15], a[76:79], v[44:47], v[0:15]
  ds_read_b128 v[40:43], v205 offset:5120
  v_mfma_f32_32x32x16_bf16 v[16:31], a[220:223], v[44:47], v[16:31]
  s_waitcnt lgkmcnt(2)
  v_mfma_f32_32x32x16_bf16 v[0:15], a[80:83], v[32:35], v[0:15]
  ds_read_b128 v[44:47], v206 offset:5120
  v_mfma_f32_32x32x16_bf16 v[16:31], a[224:227], v[32:35], v[16:31]
  s_waitcnt lgkmcnt(2)
  v_mfma_f32_32x32x16_bf16 v[0:15], a[84:87], v[36:39], v[0:15]
  ds_read_b128 v[32:35], v203 offset:6144
  v_mfma_f32_32x32x16_bf16 v[16:31], a[228:231], v[36:39], v[16:31]
  s_waitcnt lgkmcnt(2)
  v_mfma_f32_32x32x16_bf16 v[0:15], a[88:91], v[40:43], v[0:15]
  ds_read_b128 v[36:39], v204 offset:6144
  v_mfma_f32_32x32x16_bf16 v[16:31], a[232:235], v[40:43], v[16:31]
  s_waitcnt lgkmcnt(2)
  v_mfma_f32_32x32x16_bf16 v[0:15], a[92:95], v[44:47], v[0:15]
  ds_read_b128 v[40:43], v205 offset:6144
  v_mfma_f32_32x32x16_bf16 v[16:31], a[236:239], v[44:47], v[16:31]
  s_waitcnt lgkmcnt(2)
  v_mfma_f32_32x32x16_bf16 v[0:15], a[96:99], v[32:35], v[0:15]
  ds_read_b128 v[44:47], v206 offset:6144
  v_mfma_f32_32x32x16_bf16 v[16:31], a[240:243], v[32:35], v[16:31]
  s_waitcnt lgkmcnt(2)
  v_mfma_f32_32x32x16_bf16 v[0:15], a[100:103], v[36:39], v[0:15]
  ds_read_b128 v[32:35], v203 offset:7168
  v_mfma_f32_32x32x16_bf16 v[16:31], a[244:247], v[36:39], v[16:31]
  s_waitcnt lgkmcnt(2)
  v_mfma_f32_32x32x16_bf16 v[0:15], a[104:107], v[40:43], v[0:15]
  ds_read_b128 v[36:39], v204 offset:7168
  v_mfma_f32_32x32x16_bf16 v[16:31], a[248:251], v[40:43], v[16:31]
  s_waitcnt lgkmcnt(2)
  v_mfma_f32_32x32x16_bf16 v[0:15], a[108:111], v[44:47], v[0:15]
  ds_read_b128 v[40:43], v205 offset:7168
  v_mfma_f32_32x32x16_bf16 v[16:31], a[252:255], v[44:47], v[16:31]
  s_waitcnt lgkmcnt(2)
  v_mfma_f32_32x32x16_bf16 v[0:15], a[112:115], v[32:35], v[0:15]
  ds_read_b128 v[44:47], v206 offset:7168
  v_mfma_f32_32x32x16_bf16 v[16:31], v[224:227], v[32:35], v[16:31]
  s_waitcnt lgkmcnt(2)
  v_mfma_f32_32x32x16_bf16 v[0:15], a[116:119], v[36:39], v[0:15]
  ds_read_b128 v[32:35], v203 offset:8192
  v_mfma_f32_32x32x16_bf16 v[16:31], v[228:231], v[36:39], v[16:31]
  s_waitcnt lgkmcnt(2)
  v_mfma_f32_32x32x16_bf16 v[0:15], a[120:123], v[40:43], v[0:15]
  ds_read_b128 v[36:39], v204 offset:8192
  v_mfma_f32_32x32x16_bf16 v[16:31], v[232:235], v[40:43], v[16:31]
  s_waitcnt lgkmcnt(2)
  v_mfma_f32_32x32x16_bf16 v[0:15], a[124:127], v[44:47], v[0:15]
  ds_read_b128 v[40:43], v205 offset:8192
  v_mfma_f32_32x32x16_bf16 v[16:31], v[236:239], v[44:47], v[16:31]
  s_waitcnt lgkmcnt(2)
  v_mfma_f32_32x32x16_bf16 v[0:15], a[128:131], v[32:35], v[0:15]
  ds_read_b128 v[44:47], v206 offset:8192
  v_mfma_f32_32x32x16_bf16 v[16:31], v[240:243], v[32:35], v[16:31]
  s_waitcnt lgkmcnt(2)
  v_mfma_f32_32x32x16_bf16 v[0:15], a[132:135], v[36:39], v[0:15]
  v_mfma_f32_32x32x16_bf16 v[16:31], v[244:247], v[36:39], v[16:31]
  s_waitcnt lgkmcnt(1)
  v_mfma_f32_32x32x16_bf16 v[0:15], a[136:139], v[40:43], v[0:15]
  v_mfma_f32_32x32x16_bf16 v[16:31], v[248:251], v[40:43], v[16:31]
  s_waitcnt lgkmcnt(0)
  v_mfma_f32_32x32x16_bf16 v[0:15], a[140:143], v[44:47], v[0:15]
  v_mfma_f32_32x32x16_bf16 v[16:31], v[252:255], v[44:47], v[16:31]
  s_add_u32 s60, s60, 36864
  s_nop 2
  v_cvt_pk_bf16_f32 v48, v0, v1
  v_cvt_pk_bf16_f32 v49, v2, v3
  ds_write2_b32 v218, v48, v49 offset0:0 offset1:1
  v_cvt_pk_bf16_f32 v48, v4, v5
  v_cvt_pk_bf16_f32 v49, v6, v7
  ds_write2_b32 v218, v48, v49 offset0:4 offset1:5
  v_cvt_pk_bf16_f32 v48, v8, v9
  v_cvt_pk_bf16_f32 v49, v10, v11
  ds_write2_b32 v218, v48, v49 offset0:8 offset1:9
  v_cvt_pk_bf16_f32 v48, v12, v13
  v_cvt_pk_bf16_f32 v49, v14, v15
  ds_write2_b32 v218, v48, v49 offset0:12 offset1:13
  v_cvt_pk_bf16_f32 v48, v16, v17
  v_cvt_pk_bf16_f32 v49, v18, v19
  ds_write2_b32 v218, v48, v49 offset0:64 offset1:65
  v_cvt_pk_bf16_f32 v48, v20, v21
  v_cvt_pk_bf16_f32 v49, v22, v23
  ds_write2_b32 v218, v48, v49 offset0:68 offset1:69
  v_cvt_pk_bf16_f32 v48, v24, v25
  v_cvt_pk_bf16_f32 v49, v26, v27
  ds_write2_b32 v218, v48, v49 offset0:72 offset1:73
  v_cvt_pk_bf16_f32 v48, v28, v29
  v_cvt_pk_bf16_f32 v49, v30, v31
  ds_write2_b32 v218, v48, v49 offset0:76 offset1:77
  v_add_u32 v218, 16512, v218
  s_waitcnt vmcnt(0) lgkmcnt(0)
  s_barrier
  ds_read_b128 v[32:35], v203 offset:36864
  ds_read_b128 v[36:39], v204 offset:36864
  ds_read_b128 v[40:43], v205 offset:36864
  s_waitcnt lgkmcnt(2)
  v_mfma_f32_32x32x16_bf16 v[0:15], a[0:3], v[32:35], 0
  ds_read_b128 v[44:47], v206 offset:36864
  s_add_u32 m0, s67, 0
  s_nop 0
  buffer_load_dwordx4 v202, s[4:7], s60 offen offset:0 lds
  v_mfma_f32_32x32x16_bf16 v[16:31], a[144:147], v[32:35], 0
  s_waitcnt lgkmcnt(2)
  v_mfma_f32_32x32x16_bf16 v[0:15], a[4:7], v[36:39], v[0:15]
  ds_read_b128 v[32:35], v203 offset:37888
  s_add_u32 m0, s67, 896
  s_nop 0
  buffer_load_dwordx4 v202, s[4:7], s60 offen offset:128 lds
  v_mfma_f32_32x32x16_bf16 v[16:31], a[148:151], v[36:39], v[16:31]
  s_waitcnt lgkmcnt(2)
  v_mfma_f32_32x32x16_bf16 v[0:15], a[8:11], v[40:43], v[0:15]
  ds_read_b128 v[36:39], v204 offset:37888
  s_add_u32 m0, s67, 1792
  s_nop 0
  buffer_load_dwordx4 v202, s[4:7], s60 offen offset:256 lds
  v_mfma_f32_32x32x16_bf16 v[16:31], a[152:155], v[40:43], v[16:31]
  s_waitcnt lgkmcnt(2)
  v_mfma_f32_32x32x16_bf16 v[0:15], a[12:15], v[44:47], v[0:15]
  ds_read_b128 v[40:43], v205 offset:37888
  s_add_u32 m0, s67, 2688
  s_nop 0
  buffer_load_dwordx4 v202, s[4:7], s60 offen offset:384 lds
  v_mfma_f32_32x32x16_bf16 v[16:31], a[156:159], v[44:47], v[16:31]
  s_waitcnt lgkmcnt(2)
  v_mfma_f32_32x32x16_bf16 v[0:15], a[16:19], v[32:35], v[0:15]
  ds_read_b128 v[44:47], v206 offset:37888
  s_add_u32 m0, s67, 3584
  s_nop 0
  buffer_load_dwordx4 v202, s[4:7], s60 offen offset:512 lds
  v_mfma_f32_32x32x16_bf16 v[16:31], a[160:163], v[32:35], v[16:31]
  s_waitcnt lgkmcnt(2)
  v_mfma_f32_32x32x16_bf16 v[0:15], a[20:23], v[36:39], v[0:15]
  ds_read_b128 v[32:35], v203 offset:38912
  s_add_u32 m0, s67, 4480
  s_nop 0
  buffer_load_dwordx4 v202, s[4:7], s60 offen offset:640 lds
  v_mfma_f32_32x32x16_bf16 v[16:31], a[164:167], v[36:39], v[16:31]
  s_waitcnt lgkmcnt(2)
  v_mfma_f32_32x32x16_bf16 v[0:15], a[24:27], v[40:43], v[0:15]
  ds_read_b128 v[36:39], v204 offset:38912
  s_add_u32 m0, s67, 5376
  s_nop 0
  buffer_load_dwordx4 v202, s[4:7], s60 offen offset:768 lds
  v_mfma_f32_32x32x16_bf16 v[16:31], a[168:171], v[40:43], v[16:31]
  s_waitcnt lgkmcnt(2)
  v_mfma_f32_32x32x16_bf16 v[0:15], a[28:31], v[44:47], v[0:15]
  ds_read_b128 v[40:43], v205 offset:38912
  s_add_u32 m0, s67, 6272
  s_nop 0
  buffer_load_dwordx4 v202, s[4:7], s60 offen offset:896 lds
  v_mfma_f32_32x32x16_bf16 v[16:31], a[172:175], v[44:47], v[16:31]
  s_waitcnt lgkmcnt(2)
  v_mfma_f32_32x32x16_bf16 v[0:15], a[32:35], v[32:35], v[0:15]
  ds_read_b128 v[44:47], v206 offset:38912
  s_add_u32 m0, s67, 7168
  s_nop 0
  buffer_load_dwordx4 v202, s[4:7], s60 offen offset:1024 lds
  v_mfma_f32_32x32x16_bf16 v[16:31], a[176:179], v[32:35], v[16:31]
  s_waitcnt lgkmcnt(2)
  v_mfma_f32_32x32x16_bf16 v[0:15], a[36:39], v[36:39], v[0:15]
  ds_read_b128 v[32:35], v203 offset:39936
  v_mfma_f32_32x32x16_bf16 v[16:31], a[180:183], v[36:39], v[16:31]
  s_waitcnt lgkmcnt(2)
  v_mfma_f32_32x32x16_bf16 v[0:15], a[40:43], v[40:43], v[0:15]
  ds_read_b128 v[36:39], v204 offset:39936
  v_mfma_f32_32x32x16_bf16 v[16:31], a[184:187], v[40:43], v[16:31]
  s_waitcnt lgkmcnt(2)
  v_mfma_f32_32x32x16_bf16 v[0:15], a[44:47], v[44:47], v[0:15]
  ds_read_b128 v[40:43], v205 offset:39936
  v_mfma_f32_32x32x16_bf16 v[16:31], a[188:191], v[44:47], v[16:31]
  s_waitcnt lgkmcnt(2)
  v_mfma_f32_32x32x16_bf16 v[0:15], a[48:51], v[32:35], v[0:15]
  ds_read_b128 v[44:47], v206 offset:39936
  v_mfma_f32_32x32x16_bf16 v[16:31], a[192:195], v[32:35], v[16:31]
  s_waitcnt lgkmcnt(2)
  v_mfma_f32_32x32x16_bf16 v[0:15], a[52:55], v[36:39], v[0:15]
  ds_read_b128 v[32:35], v203 offset:40960
  v_mfma_f32_32x32x16_bf16 v[16:31], a[196:199], v[36:39], v[16:31]
  s_waitcnt lgkmcnt(2)
  v_mfma_f32_32x32x16_bf16 v[0:15], a[56:59], v[40:43], v[0:15]
  ds_read_b128 v[36:39], v204 offset:40960
  v_mfma_f32_32x32x16_bf16 v[16:31], a[200:203], v[40:43], v[16:31]
  s_waitcnt lgkmcnt(2)
  v_mfma_f32_32x32x16_bf16 v[0:15], a[60:63], v[44:47], v[0:15]
  ds_read_b128 v[40:43], v205 offset:40960
  v_mfma_f32_32x32x16_bf16 v[16:31], a[204:207], v[44:47], v[16:31]
  s_waitcnt lgkmcnt(2)
  v_mfma_f32_32x32x16_bf16 v[0:15], a[64:67], v[32:35], v[0:15]
  ds_read_b128 v[44:47], v206 offset:40960
  v_mfma_f32_32x32x16_bf16 v[16:31], a[208:211], v[32:35], v[16:31]
  s_waitcnt lgkmcnt(2)
  v_mfma_f32_32x32x16_bf16 v[0:15], a[68:71], v[36:39], v[0:15]
  ds_read_b128 v[32:35], v203 offset:41984
  v_mfma_f32_32x32x16_bf16 v[16:31], a[212:215], v[36:39], v[16:31]
  s_waitcnt lgkmcnt(2)
  v_mfma_f32_32x32x16_bf16 v[0:15], a[72:75], v[40:43], v[0:15]
  ds_read_b128 v[36:39], v204 offset:41984
  v_mfma_f32_32x32x16_bf16 v[16:31], a[216:219], v[40:43], v[16:31]
  s_waitcnt lgkmcnt(2)
  v_mfma_f32_32x32x16_bf16 v[0:15], a[76:79], v[44:47], v[0:15]
  ds_read_b128 v[40:43], v205 offset:41984
  v_mfma_f32_32x32x16_bf16 v[16:31], a[220:223], v[44:47], v[16:31]
  s_waitcnt lgkmcnt(2)
  v_mfma_f32_32x32x16_bf16 v[0:15], a[80:83], v[32:35], v[0:15]
  ds_read_b128 v[44:47], v206 offset:41984
  v_mfma_f32_32x32x16_bf16 v[16:31], a[224:227], v[32:35], v[16:31]
  s_waitcnt lgkmcnt(2)
  v_mfma_f32_32x32x16_bf16 v[0:15], a[84:87], v[36:39], v[0:15]
  ds_read_b128 v[32:35], v203 offset:43008
  v_mfma_f32_32x32x16_bf16 v[16:31], a[228:231], v[36:39], v[16:31]
  s_waitcnt lgkmcnt(2)
  v_mfma_f32_32x32x16_bf16 v[0:15], a[88:91], v[40:43], v[0:15]
  ds_read_b128 v[36:39], v204 offset:43008
  v_mfma_f32_32x32x16_bf16 v[16:31], a[232:235], v[40:43], v[16:31]
  s_waitcnt lgkmcnt(2)
  v_mfma_f32_32x32x16_bf16 v[0:15], a[92:95], v[44:47], v[0:15]
  ds_read_b128 v[40:43], v205 offset:43008
  v_mfma_f32_32x32x16_bf16 v[16:31], a[236:239], v[44:47], v[16:31]
  s_waitcnt lgkmcnt(2)
  v_mfma_f32_32x32x16_bf16 v[0:15], a[96:99], v[32:35], v[0:15]
  ds_read_b128 v[44:47], v206 offset:43008
  v_mfma_f32_32x32x16_bf16 v[16:31], a[240:243], v[32:35], v[16:31]
  s_waitcnt lgkmcnt(2)
  v_mfma_f32_32x32x16_bf16 v[0:15], a[100:103], v[36:39], v[0:15]
  ds_read_b128 v[32:35], v203 offset:44032
  v_mfma_f32_32x32x16_bf16 v[16:31], a[244:247], v[36:39], v[16:31]
  s_waitcnt lgkmcnt(2)
  v_mfma_f32_32x32x16_bf16 v[0:15], a[104:107], v[40:43], v[0:15]
  ds_read_b128 v[36:39], v204 offset:44032
  v_mfma_f32_32x32x16_bf16 v[16:31], a[248:251], v[40:43], v[16:31]
  s_waitcnt lgkmcnt(2)
  v_mfma_f32_32x32x16_bf16 v[0:15], a[108:111], v[44:47], v[0:15]
  ds_read_b128 v[40:43], v205 offset:44032
  v_mfma_f32_32x32x16_bf16 v[16:31], a[252:255], v[44:47], v[16:31]
  s_waitcnt lgkmcnt(2)
  v_mfma_f32_32x32x16_bf16 v[0:15], a[112:115], v[32:35], v[0:15]
  ds_read_b128 v[44:47], v206 offset:44032
  v_mfma_f32_32x32x16_bf16 v[16:31], v[224:227], v[32:35], v[16:31]
  s_waitcnt lgkmcnt(2)
  v_mfma_f32_32x32x16_bf16 v[0:15], a[116:119], v[36:39], v[0:15]
  ds_read_b128 v[32:35], v203 offset:45056
  v_mfma_f32_32x32x16_bf16 v[16:31], v[228:231], v[36:39], v[16:31]
  s_waitcnt lgkmcnt(2)
  v_mfma_f32_32x32x16_bf16 v[0:15], a[120:123], v[40:43], v[0:15]
  ds_read_b128 v[36:39], v204 offset:45056
  v_mfma_f32_32x32x16_bf16 v[16:31], v[232:235], v[40:43], v[16:31]
  s_waitcnt lgkmcnt(2)
  v_mfma_f32_32x32x16_bf16 v[0:15], a[124:127], v[44:47], v[0:15]
  ds_read_b128 v[40:43], v205 offset:45056
  v_mfma_f32_32x32x16_bf16 v[16:31], v[236:239], v[44:47], v[16:31]
  s_waitcnt lgkmcnt(2)
  v_mfma_f32_32x32x16_bf16 v[0:15], a[128:131], v[32:35], v[0:15]
  ds_read_b128 v[44:47], v206 offset:45056
  v_mfma_f32_32x32x16_bf16 v[16:31], v[240:243], v[32:35], v[16:31]
  s_waitcnt lgkmcnt(2)
  v_mfma_f32_32x32x16_bf16 v[0:15], a[132:135], v[36:39], v[0:15]
  v_mfma_f32_32x32x16_bf16 v[16:31], v[244:247], v[36:39], v[16:31]
  s_waitcnt lgkmcnt(1)
  v_mfma_f32_32x32x16_bf16 v[0:15], a[136:139], v[40:43], v[0:15]
  v_mfma_f32_32x32x16_bf16 v[16:31], v[248:251], v[40:43], v[16:31]
  s_waitcnt lgkmcnt(0)
  v_mfma_f32_32x32x16_bf16 v[0:15], a[140:143], v[44:47], v[0:15]
  v_mfma_f32_32x32x16_bf16 v[16:31], v[252:255], v[44:47], v[16:31]
  s_add_u32 s60, s60, 36864
  s_nop 2
  v_cvt_pk_bf16_f32 v48, v0, v1
  v_cvt_pk_bf16_f32 v49, v2, v3
  ds_write2_b32 v218, v48, v49 offset0:0 offset1:1
  v_cvt_pk_bf16_f32 v48, v4, v5
  v_cvt_pk_bf16_f32 v49, v6, v7
  ds_write2_b32 v218, v48, v49 offset0:4 offset1:5
  v_cvt_pk_bf16_f32 v48, v8, v9
  v_cvt_pk_bf16_f32 v49, v10, v11
  ds_write2_b32 v218, v48, v49 offset0:8 offset1:9
  v_cvt_pk_bf16_f32 v48, v12, v13
  v_cvt_pk_bf16_f32 v49, v14, v15
  ds_write2_b32 v218, v48, v49 offset0:12 offset1:13
  v_cvt_pk_bf16_f32 v48, v16, v17
  v_cvt_pk_bf16_f32 v49, v18, v19
  ds_write2_b32 v218, v48, v49 offset0:64 offset1:65
  v_cvt_pk_bf16_f32 v48, v20, v21
  v_cvt_pk_bf16_f32 v49, v22, v23
  ds_write2_b32 v218, v48, v49 offset0:68 offset1:69
  v_cvt_pk_bf16_f32 v48, v24, v25
  v_cvt_pk_bf16_f32 v49, v26, v27
  ds_write2_b32 v218, v48, v49 offset0:72 offset1:73
  v_cvt_pk_bf16_f32 v48, v28, v29
  v_cvt_pk_bf16_f32 v49, v30, v31
  ds_write2_b32 v218, v48, v49 offset0:76 offset1:77
  v_add_u32 v218, 16512, v218
  s_waitcnt vmcnt(0) lgkmcnt(0)
  s_barrier
  ds_read_b128 v[32:35], v203 offset:0
  ds_read_b128 v[36:39], v204 offset:0
  ds_read_b128 v[40:43], v205 offset:0
  s_waitcnt lgkmcnt(2)
  v_mfma_f32_32x32x16_bf16 v[0:15], a[0:3], v[32:35], 0
  ds_read_b128 v[44:47], v206 offset:0
  v_mfma_f32_32x32x16_bf16 v[16:31], a[144:147], v[32:35], 0
  s_waitcnt lgkmcnt(2)
  v_mfma_f32_32x32x16_bf16 v[0:15], a[4:7], v[36:39], v[0:15]
  ds_read_b128 v[32:35], v203 offset:1024
  v_mfma_f32_32x32x16_bf16 v[16:31], a[148:151], v[36:39], v[16:31]
  s_waitcnt lgkmcnt(2)
  v_mfma_f32_32x32x16_bf16 v[0:15], a[8:11], v[40:43], v[0:15]
  ds_read_b128 v[36:39], v204 offset:1024
  v_mfma_f32_32x32x16_bf16 v[16:31], a[152:155], v[40:43], v[16:31]
  s_waitcnt lgkmcnt(2)
  v_mfma_f32_32x32x16_bf16 v[0:15], a[12:15], v[44:47], v[0:15]
  ds_read_b128 v[40:43], v205 offset:1024
  v_mfma_f32_32x32x16_bf16 v[16:31], a[156:159], v[44:47], v[16:31]
  s_waitcnt lgkmcnt(2)
  v_mfma_f32_32x32x16_bf16 v[0:15], a[16:19], v[32:35], v[0:15]
  ds_read_b128 v[44:47], v206 offset:1024
  v_mfma_f32_32x32x16_bf16 v[16:31], a[160:163], v[32:35], v[16:31]
  s_waitcnt lgkmcnt(2)
  v_mfma_f32_32x32x16_bf16 v[0:15], a[20:23], v[36:39], v[0:15]
  ds_read_b128 v[32:35], v203 offset:2048
  v_mfma_f32_32x32x16_bf16 v[16:31], a[164:167], v[36:39], v[16:31]
  s_waitcnt lgkmcnt(2)
  v_mfma_f32_32x32x16_bf16 v[0:15], a[24:27], v[40:43], v[0:15]
  ds_read_b128 v[36:39], v204 offset:2048
  v_mfma_f32_32x32x16_bf16 v[16:31], a[168:171], v[40:43], v[16:31]
  s_waitcnt lgkmcnt(2)
  v_mfma_f32_32x32x16_bf16 v[0:15], a[28:31], v[44:47], v[0:15]
  ds_read_b128 v[40:43], v205 offset:2048
  v_mfma_f32_32x32x16_bf16 v[16:31], a[172:175], v[44:47], v[16:31]
  s_waitcnt lgkmcnt(2)
  v_mfma_f32_32x32x16_bf16 v[0:15], a[32:35], v[32:35], v[0:15]
  ds_read_b128 v[44:47], v206 offset:2048
  v_mfma_f32_32x32x16_bf16 v[16:31], a[176:179], v[32:35], v[16:31]
  s_waitcnt lgkmcnt(2)
  v_mfma_f32_32x32x16_bf16 v[0:15], a[36:39], v[36:39], v[0:15]
  ds_read_b128 v[32:35], v203 offset:3072
  v_mfma_f32_32x32x16_bf16 v[16:31], a[180:183], v[36:39], v[16:31]
  s_waitcnt lgkmcnt(2)
  v_mfma_f32_32x32x16_bf16 v[0:15], a[40:43], v[40:43], v[0:15]
  ds_read_b128 v[36:39], v204 offset:3072
  v_mfma_f32_32x32x16_bf16 v[16:31], a[184:187], v[40:43], v[16:31]
  s_waitcnt lgkmcnt(2)
  v_mfma_f32_32x32x16_bf16 v[0:15], a[44:47], v[44:47], v[0:15]
  ds_read_b128 v[40:43], v205 offset:3072
  v_mfma_f32_32x32x16_bf16 v[16:31], a[188:191], v[44:47], v[16:31]
  s_waitcnt lgkmcnt(2)
  v_mfma_f32_32x32x16_bf16 v[0:15], a[48:51], v[32:35], v[0:15]
  ds_read_b128 v[44:47], v206 offset:3072
  v_mfma_f32_32x32x16_bf16 v[16:31], a[192:195], v[32:35], v[16:31]
  s_waitcnt lgkmcnt(2)
  v_mfma_f32_32x32x16_bf16 v[0:15], a[52:55], v[36:39], v[0:15]
  ds_read_b128 v[32:35], v203 offset:4096
  v_mfma_f32_32x32x16_bf16 v[16:31], a[196:199], v[36:39], v[16:31]
  s_waitcnt lgkmcnt(2)
  v_mfma_f32_32x32x16_bf16 v[0:15], a[56:59], v[40:43], v[0:15]
  ds_read_b128 v[36:39], v204 offset:4096
  v_mfma_f32_32x32x16_bf16 v[16:31], a[200:203], v[40:43], v[16:31]
  s_waitcnt lgkmcnt(2)
  v_mfma_f32_32x32x16_bf16 v[0:15], a[60:63], v[44:47], v[0:15]
  ds_read_b128 v[40:43], v205 offset:4096
  v_mfma_f32_32x32x16_bf16 v[16:31], a[204:207], v[44:47], v[16:31]
  s_waitcnt lgkmcnt(2)
  v_mfma_f32_32x32x16_bf16 v[0:15], a[64:67], v[32:35], v[0:15]
  ds_read_b128 v[44:47], v206 offset:4096
  v_mfma_f32_32x32x16_bf16 v[16:31], a[208:211], v[32:35], v[16:31]
  s_waitcnt lgkmcnt(2)
  v_mfma_f32_32x32x16_bf16 v[0:15], a[68:71], v[36:39], v[0:15]
  ds_read_b128 v[32:35], v203 offset:5120
  v_mfma_f32_32x32x16_bf16 v[16:31], a[212:215], v[36:39], v[16:31]
  s_waitcnt lgkmcnt(2)
  v_mfma_f32_32x32x16_bf16 v[0:15], a[72:75], v[40:43], v[0:15]
  ds_read_b128 v[36:39], v204 offset:5120
  v_mfma_f32_32x32x16_bf16 v[16:31], a[216:219], v[40:43], v[16:31]
  s_waitcnt lgkmcnt(2)
  v_mfma_f32_32x32x16_bf16 v[0:15], a[76:79], v[44:47], v[0:15]
  ds_read_b128 v[40:43], v205 offset:5120
  v_mfma_f32_32x32x16_bf16 v[16:31], a[220:223], v[44:47], v[16:31]
  s_waitcnt lgkmcnt(2)
  v_mfma_f32_32x32x16_bf16 v[0:15], a[80:83], v[32:35], v[0:15]
  ds_read_b128 v[44:47], v206 offset:5120
  v_mfma_f32_32x32x16_bf16 v[16:31], a[224:227], v[32:35], v[16:31]
  s_waitcnt lgkmcnt(2)
  v_mfma_f32_32x32x16_bf16 v[0:15], a[84:87], v[36:39], v[0:15]
  ds_read_b128 v[32:35], v203 offset:6144
  v_mfma_f32_32x32x16_bf16 v[16:31], a[228:231], v[36:39], v[16:31]
  s_waitcnt lgkmcnt(2)
  v_mfma_f32_32x32x16_bf16 v[0:15], a[88:91], v[40:43], v[0:15]
  ds_read_b128 v[36:39], v204 offset:6144
  v_mfma_f32_32x32x16_bf16 v[16:31], a[232:235], v[40:43], v[16:31]
  s_waitcnt lgkmcnt(2)
  v_mfma_f32_32x32x16_bf16 v[0:15], a[92:95], v[44:47], v[0:15]
  ds_read_b128 v[40:43], v205 offset:6144
  v_mfma_f32_32x32x16_bf16 v[16:31], a[236:239], v[44:47], v[16:31]
  s_waitcnt lgkmcnt(2)
  v_mfma_f32_32x32x16_bf16 v[0:15], a[96:99], v[32:35], v[0:15]
  ds_read_b128 v[44:47], v206 offset:6144
  v_mfma_f32_32x32x16_bf16 v[16:31], a[240:243], v[32:35], v[16:31]
  s_waitcnt lgkmcnt(2)
  v_mfma_f32_32x32x16_bf16 v[0:15], a[100:103], v[36:39], v[0:15]
  ds_read_b128 v[32:35], v203 offset:7168
  v_mfma_f32_32x32x16_bf16 v[16:31], a[244:247], v[36:39], v[16:31]
  s_waitcnt lgkmcnt(2)
  v_mfma_f32_32x32x16_bf16 v[0:15], a[104:107], v[40:43], v[0:15]
  ds_read_b128 v[36:39], v204 offset:7168
  v_mfma_f32_32x32x16_bf16 v[16:31], a[248:251], v[40:43], v[16:31]
  s_waitcnt lgkmcnt(2)
  v_mfma_f32_32x32x16_bf16 v[0:15], a[108:111], v[44:47], v[0:15]
  ds_read_b128 v[40:43], v205 offset:7168
  v_mfma_f32_32x32x16_bf16 v[16:31], a[252:255], v[44:47], v[16:31]
  s_waitcnt lgkmcnt(2)
  v_mfma_f32_32x32x16_bf16 v[0:15], a[112:115], v[32:35], v[0:15]
  ds_read_b128 v[44:47], v206 offset:7168
  v_mfma_f32_32x32x16_bf16 v[16:31], v[224:227], v[32:35], v[16:31]
  s_waitcnt lgkmcnt(2)
  v_mfma_f32_32x32x16_bf16 v[0:15], a[116:119], v[36:39], v[0:15]
  ds_read_b128 v[32:35], v203 offset:8192
  v_mfma_f32_32x32x16_bf16 v[16:31], v[228:231], v[36:39], v[16:31]
  s_waitcnt lgkmcnt(2)
  v_mfma_f32_32x32x16_bf16 v[0:15], a[120:123], v[40:43], v[0:15]
  ds_read_b128 v[36:39], v204 offset:8192
  v_mfma_f32_32x32x16_bf16 v[16:31], v[232:235], v[40:43], v[16:31]
  s_waitcnt lgkmcnt(2)
  v_mfma_f32_32x32x16_bf16 v[0:15], a[124:127], v[44:47], v[0:15]
  ds_read_b128 v[40:43], v205 offset:8192
  v_mfma_f32_32x32x16_bf16 v[16:31], v[236:239], v[44:47], v[16:31]
  s_waitcnt lgkmcnt(2)
  v_mfma_f32_32x32x16_bf16 v[0:15], a[128:131], v[32:35], v[0:15]
  ds_read_b128 v[44:47], v206 offset:8192
  v_mfma_f32_32x32x16_bf16 v[16:31], v[240:243], v[32:35], v[16:31]
  s_waitcnt lgkmcnt(2)
  v_mfma_f32_32x32x16_bf16 v[0:15], a[132:135], v[36:39], v[0:15]
  v_mfma_f32_32x32x16_bf16 v[16:31], v[244:247], v[36:39], v[16:31]
  s_waitcnt lgkmcnt(1)
  v_mfma_f32_32x32x16_bf16 v[0:15], a[136:139], v[40:43], v[0:15]
  v_mfma_f32_32x32x16_bf16 v[16:31], v[248:251], v[40:43], v[16:31]
  s_waitcnt lgkmcnt(0)
  v_mfma_f32_32x32x16_bf16 v[0:15], a[140:143], v[44:47], v[0:15]
  v_mfma_f32_32x32x16_bf16 v[16:31], v[252:255], v[44:47], v[16:31]
  s_add_u32 s60, s60, 36864
  s_nop 2
  v_cvt_pk_bf16_f32 v48, v0, v1
  v_cvt_pk_bf16_f32 v49, v2, v3
  ds_write2_b32 v218, v48, v49 offset0:0 offset1:1
  v_cvt_pk_bf16_f32 v48, v4, v5
  v_cvt_pk_bf16_f32 v49, v6, v7
  ds_write2_b32 v218, v48, v49 offset0:4 offset1:5
  v_cvt_pk_bf16_f32 v48, v8, v9
  v_cvt_pk_bf16_f32 v49, v10, v11
  ds_write2_b32 v218, v48, v49 offset0:8 offset1:9
  v_cvt_pk_bf16_f32 v48, v12, v13
  v_cvt_pk_bf16_f32 v49, v14, v15
  ds_write2_b32 v218, v48, v49 offset0:12 offset1:13
  v_cvt_pk_bf16_f32 v48, v16, v17
  v_cvt_pk_bf16_f32 v49, v18, v19
  ds_write2_b32 v218, v48, v49 offset0:64 offset1:65
  v_cvt_pk_bf16_f32 v48, v20, v21
  v_cvt_pk_bf16_f32 v49, v22, v23
  ds_write2_b32 v218, v48, v49 offset0:68 offset1:69
  v_cvt_pk_bf16_f32 v48, v24, v25
  v_cvt_pk_bf16_f32 v49, v26, v27
  ds_write2_b32 v218, v48, v49 offset0:72 offset1:73
  v_cvt_pk_bf16_f32 v48, v28, v29
  v_cvt_pk_bf16_f32 v49, v30, v31
  ds_write2_b32 v218, v48, v49 offset0:76 offset1:77
  v_add_u32 v218, 16512, v218
  s_waitcnt vmcnt(0) lgkmcnt(0)
  s_barrier
  v_mul_u32_u24 v219, 516, v200
  s_mul_i32 s54, s52, 36
  s_add_u32 s55, s54, 83016
  v_add_u32 v219, s55, v219
  v_mul_u32_u24 v220, 1152, v200
  s_mul_i32 s55, s68, 144
  s_add_u32 s54, s54, s55
  s_mul_i32 s55, s69, 147456
  s_add_u32 s64, s54, s55
  s_add_u32 s64, s64, 62914560
  s_lshl_b32 s66, s69, 7
  s_mov_b32 s57, 1051597459
  ds_read_b32 v0, v219 offset:7224
  ds_read_b32 v1, v219 offset:7228
  ds_read_b32 v2, v219 offset:7232
  ds_read_b32 v3, v219 offset:7236
  ds_read_b32 v4, v219 offset:7240
  ds_read_b32 v5, v219 offset:7244
  ds_read_b32 v6, v219 offset:7248
  ds_read_b32 v7, v219 offset:7252
  ds_read_b32 v8, v219 offset:7256
  ds_read_b32 v16, v219 offset:7368
  ds_read_b32 v17, v219 offset:7372
  ds_read_b32 v18, v219 offset:7376
  ds_read_b32 v19, v219 offset:7380
  ds_read_b32 v20, v219 offset:7384
  ds_read_b32 v21, v219 offset:7388
  ds_read_b32 v22, v219 offset:7392
  ds_read_b32 v23, v219 offset:7396
  ds_read_b32 v24, v219 offset:7400
  ds_read_b32 v25, v219 offset:6336
  ds_read_b32 v26, v219 offset:6340
  ds_read_b32 v27, v219 offset:6344
  ds_read_b32 v28, v219 offset:6348
  ds_read_b32 v29, v219 offset:6352
  ds_read_b32 v30, v219 offset:6356
  ds_read_b32 v31, v219 offset:6360
  ds_read_b32 v32, v219 offset:6364
  ds_read_b32 v33, v219 offset:6368
  ds_read_b32 v34, v219 offset:5304
  ds_read_b32 v35, v219 offset:5308
  ds_read_b32 v36, v219 offset:5312
  ds_read_b32 v37, v219 offset:5316
  ds_read_b32 v38, v219 offset:5320
  ds_read_b32 v39, v219 offset:5324
  ds_read_b32 v40, v219 offset:5328
  ds_read_b32 v41, v219 offset:5332
  ds_read_b32 v42, v219 offset:5336
  ds_read_b32 v43, v219 offset:4272
  ds_read_b32 v44, v219 offset:4276
  ds_read_b32 v45, v219 offset:4280
  ds_read_b32 v46, v219 offset:4284
  ds_read_b32 v47, v219 offset:4288
  ds_read_b32 v48, v219 offset:4292
  ds_read_b32 v49, v219 offset:4296
  ds_read_b32 v50, v219 offset:4300
  ds_read_b32 v51, v219 offset:4304
  ds_read_b32 v52, v219 offset:3240
  ds_read_b32 v53, v219 offset:3244
  ds_read_b32 v54, v219 offset:3248
  ds_read_b32 v55, v219 offset:3252
  ds_read_b32 v56, v219 offset:3256
  ds_read_b32 v57, v219 offset:3260
  ds_read_b32 v58, v219 offset:3264
  ds_read_b32 v59, v219 offset:3268
  ds_read_b32 v60, v219 offset:3272
  ds_read_b32 v61, v219 offset:2208
  ds_read_b32 v62, v219 offset:2212
  ds_read_b32 v63, v219 offset:2216
  ds_read_b32 v64, v219 offset:2220
  ds_read_b32 v65, v219 offset:2224
  ds_read_b32 v66, v219 offset:2228
  ds_read_b32 v67, v219 offset:2232
  ds_read_b32 v68, v219 offset:2236
  ds_read_b32 v69, v219 offset:2240
  ds_read_b32 v70, v219 offset:1176
  ds_read_b32 v71, v219 offset:1180
  ds_read_b32 v72, v219 offset:1184
  ds_read_b32 v73, v219 offset:1188
  ds_read_b32 v74, v219 offset:1192
  ds_read_b32 v75, v219 offset:1196
  ds_read_b32 v76, v219 offset:1200
  ds_read_b32 v77, v219 offset:1204
  ds_read_b32 v78, v219 offset:1208
  ds_read_b32 v79, v219 offset:144
  ds_read_b32 v80, v219 offset:148
  ds_read_b32 v81, v219 offset:152
  ds_read_b32 v82, v219 offset:156
  ds_read_b32 v83, v219 offset:160
  ds_read_b32 v84, v219 offset:164
  ds_read_b32 v85, v219 offset:168
  ds_read_b32 v86, v219 offset:172
  ds_read_b32 v87, v219 offset:176
  v_mov_b32 v100, 0
  v_mov_b32 v101, 0
  v_mov_b32 v102, 0
  v_mov_b32 v103, 0
  v_mov_b32 v104, 0
  v_mov_b32 v105, 0
  v_mov_b32 v106, 0
  v_mov_b32 v107, 0
  s_waitcnt lgkmcnt(15)
  v_dot2c_f32_bf16 v100, v0, v16
  v_dot2c_f32_bf16 v101, v0, v25
  v_dot2c_f32_bf16 v102, v0, v34
  v_dot2c_f32_bf16 v103, v0, v43
  v_dot2c_f32_bf16 v104, v0, v52
  v_dot2c_f32_bf16 v105, v0, v61
  v_dot2c_f32_bf16 v106, v0, v70
  s_waitcnt lgkmcnt(8)
  v_dot2c_f32_bf16 v107, v0, v79
  v_dot2c_f32_bf16 v100, v1, v17
  v_dot2c_f32_bf16 v101, v1, v26
  v_dot2c_f32_bf16 v102, v1, v35
  v_dot2c_f32_bf16 v103, v1, v44
  v_dot2c_f32_bf16 v104, v1, v53
  v_dot2c_f32_bf16 v105, v1, v62
  v_dot2c_f32_bf16 v106, v1, v71
  s_waitcnt lgkmcnt(7)
  v_dot2c_f32_bf16 v107, v1, v80
  v_dot2c_f32_bf16 v100, v2, v18
  v_dot2c_f32_bf16 v101, v2, v27
  v_dot2c_f32_bf16 v102, v2, v36
  v_dot2c_f32_bf16 v103, v2, v45
  v_dot2c_f32_bf16 v104, v2, v54
  v_dot2c_f32_bf16 v105, v2, v63
  v_dot2c_f32_bf16 v106, v2, v72
  s_waitcnt lgkmcnt(6)
  v_dot2c_f32_bf16 v107, v2, v81
  v_dot2c_f32_bf16 v100, v3, v19
  v_dot2c_f32_bf16 v101, v3, v28
  v_dot2c_f32_bf16 v102, v3, v37
  v_dot2c_f32_bf16 v103, v3, v46
  v_dot2c_f32_bf16 v104, v3, v55
  v_dot2c_f32_bf16 v105, v3, v64
  v_dot2c_f32_bf16 v106, v3, v73
  s_waitcnt lgkmcnt(5)
  v_dot2c_f32_bf16 v107, v3, v82
  v_dot2c_f32_bf16 v100, v4, v20
  v_dot2c_f32_bf16 v101, v4, v29
  v_dot2c_f32_bf16 v102, v4, v38
  v_dot2c_f32_bf16 v103, v4, v47
  v_dot2c_f32_bf16 v104, v4, v56
  v_dot2c_f32_bf16 v105, v4, v65
  v_dot2c_f32_bf16 v106, v4, v74
  s_waitcnt lgkmcnt(4)
  v_dot2c_f32_bf16 v107, v4, v83
  v_dot2c_f32_bf16 v100, v5, v21
  v_dot2c_f32_bf16 v101, v5, v30
  v_dot2c_f32_bf16 v102, v5, v39
  v_dot2c_f32_bf16 v103, v5, v48
  v_dot2c_f32_bf16 v104, v5, v57
  v_dot2c_f32_bf16 v105, v5, v66
  v_dot2c_f32_bf16 v106, v5, v75
  s_waitcnt lgkmcnt(3)
  v_dot2c_f32_bf16 v107, v5, v84
  v_dot2c_f32_bf16 v100, v6, v22
  v_dot2c_f32_bf16 v101, v6, v31
  v_dot2c_f32_bf16 v102, v6, v40
  v_dot2c_f32_bf16 v103, v6, v49
  v_dot2c_f32_bf16 v104, v6, v58
  v_dot2c_f32_bf16 v105, v6, v67
  v_dot2c_f32_bf16 v106, v6, v76
  s_waitcnt lgkmcnt(2)
  v_dot2c_f32_bf16 v107, v6, v85
  v_dot2c_f32_bf16 v100, v7, v23
  v_dot2c_f32_bf16 v101, v7, v32
  v_dot2c_f32_bf16 v102, v7, v41
  v_dot2c_f32_bf16 v103, v7, v50
  v_dot2c_f32_bf16 v104, v7, v59
  v_dot2c_f32_bf16 v105, v7, v68
  v_dot2c_f32_bf16 v106, v7, v77
  s_waitcnt lgkmcnt(1)
  v_dot2c_f32_bf16 v107, v7, v86
  v_dot2c_f32_bf16 v100, v8, v24
  v_dot2c_f32_bf16 v101, v8, v33
  v_dot2c_f32_bf16 v102, v8, v42
  v_dot2c_f32_bf16 v103, v8, v51
  v_dot2c_f32_bf16 v104, v8, v60
  v_dot2c_f32_bf16 v105, v8, v69
  v_dot2c_f32_bf16 v106, v8, v78
  s_waitcnt lgkmcnt(0)
  v_dot2c_f32_bf16 v107, v8, v87
  ds_read_b32 v16, v219 offset:7512
  ds_read_b32 v17, v219 offset:7516
  ds_read_b32 v18, v219 offset:7520
  ds_read_b32 v19, v219 offset:7524
  ds_read_b32 v20, v219 offset:7528
  ds_read_b32 v21, v219 offset:7532
  ds_read_b32 v22, v219 offset:7536
  ds_read_b32 v23, v219 offset:7540
  ds_read_b32 v24, v219 offset:7544
  ds_read_b32 v25, v219 offset:6480
  ds_read_b32 v26, v219 offset:6484
  ds_read_b32 v27, v219 offset:6488
  ds_read_b32 v28, v219 offset:6492
  ds_read_b32 v29, v219 offset:6496
  ds_read_b32 v30, v219 offset:6500
  ds_read_b32 v31, v219 offset:6504
  ds_read_b32 v32, v219 offset:6508
  ds_read_b32 v33, v219 offset:6512
  ds_read_b32 v34, v219 offset:5448
  ds_read_b32 v35, v219 offset:5452
  ds_read_b32 v36, v219 offset:5456
  ds_read_b32 v37, v219 offset:5460
  ds_read_b32 v38, v219 offset:5464
  ds_read_b32 v39, v219 offset:5468
  ds_read_b32 v40, v219 offset:5472
  ds_read_b32 v41, v219 offset:5476
  ds_read_b32 v42, v219 offset:5480
  ds_read_b32 v43, v219 offset:4416
  ds_read_b32 v44, v219 offset:4420
  ds_read_b32 v45, v219 offset:4424
  ds_read_b32 v46, v219 offset:4428
  ds_read_b32 v47, v219 offset:4432
  ds_read_b32 v48, v219 offset:4436
  ds_read_b32 v49, v219 offset:4440
  ds_read_b32 v50, v219 offset:4444
  ds_read_b32 v51, v219 offset:4448
  ds_read_b32 v52, v219 offset:3384
  ds_read_b32 v53, v219 offset:3388
  ds_read_b32 v54, v219 offset:3392
  ds_read_b32 v55, v219 offset:3396
  ds_read_b32 v56, v219 offset:3400
  ds_read_b32 v57, v219 offset:3404
  ds_read_b32 v58, v219 offset:3408
  ds_read_b32 v59, v219 offset:3412
  ds_read_b32 v60, v219 offset:3416
  ds_read_b32 v61, v219 offset:2352
  ds_read_b32 v62, v219 offset:2356
  ds_read_b32 v63, v219 offset:2360
  ds_read_b32 v64, v219 offset:2364
  ds_read_b32 v65, v219 offset:2368
  ds_read_b32 v66, v219 offset:2372
  ds_read_b32 v67, v219 offset:2376
  ds_read_b32 v68, v219 offset:2380
  ds_read_b32 v69, v219 offset:2384
  ds_read_b32 v70, v219 offset:1320
  ds_read_b32 v71, v219 offset:1324
  ds_read_b32 v72, v219 offset:1328
  ds_read_b32 v73, v219 offset:1332
  ds_read_b32 v74, v219 offset:1336
  ds_read_b32 v75, v219 offset:1340
  ds_read_b32 v76, v219 offset:1344
  ds_read_b32 v77, v219 offset:1348
  ds_read_b32 v78, v219 offset:1352
  ds_read_b32 v79, v219 offset:288
  ds_read_b32 v80, v219 offset:292
  ds_read_b32 v81, v219 offset:296
  ds_read_b32 v82, v219 offset:300
  ds_read_b32 v83, v219 offset:304
  ds_read_b32 v84, v219 offset:308
  ds_read_b32 v85, v219 offset:312
  ds_read_b32 v86, v219 offset:316
  ds_read_b32 v87, v219 offset:320
  v_add_u32 v211, s66, v200
  v_mov_b32 v212, 0xf149f2ca
  v_mul_f32 v100, s57, v100
  v_mul_f32 v101, s57, v101
  v_mul_f32 v102, s57, v102
  v_mul_f32 v103, s57, v103
  v_mul_f32 v104, s57, v104
  v_mul_f32 v105, s57, v105
  v_mul_f32 v106, s57, v106
  v_mul_f32 v107, s57, v107
  v_cmp_gt_u32 vcc, 2, v211
  s_nop 1
  v_cndmask_b32 v101, v101, v212, vcc
  v_cmp_gt_u32 vcc, 4, v211
  s_nop 1
  v_cndmask_b32 v102, v102, v212, vcc
  v_cmp_gt_u32 vcc, 6, v211
  s_nop 1
  v_cndmask_b32 v103, v103, v212, vcc
  v_cmp_gt_u32 vcc, 8, v211
  s_nop 1
  v_cndmask_b32 v104, v104, v212, vcc
  v_cmp_gt_u32 vcc, 10, v211
  s_nop 1
  v_cndmask_b32 v105, v105, v212, vcc
  v_cmp_gt_u32 vcc, 12, v211
  s_nop 1
  v_cndmask_b32 v106, v106, v212, vcc
  v_cmp_gt_u32 vcc, 14, v211
  s_nop 1
  v_cndmask_b32 v107, v107, v212, vcc
  v_max3_f32 v213, v100, v101, v102
  v_max3_f32 v213, v213, v103, v104
  v_max3_f32 v213, v213, v105, v106
  v_max_f32 v213, v213, v107
  v_sub_f32 v100, v100, v213
  v_sub_f32 v101, v101, v213
  v_sub_f32 v102, v102, v213
  v_sub_f32 v103, v103, v213
  v_sub_f32 v104, v104, v213
  v_sub_f32 v105, v105, v213
  v_sub_f32 v106, v106, v213
  v_sub_f32 v107, v107, v213
  v_exp_f32 v100, v100
  v_exp_f32 v101, v101
  v_exp_f32 v102, v102
  v_exp_f32 v103, v103
  v_exp_f32 v104, v104
  v_exp_f32 v105, v105
  v_exp_f32 v106, v106
  v_exp_f32 v107, v107
  v_add_f32 v213, v100, v101
  v_add_f32 v213, v213, v102
  v_add_f32 v213, v213, v103
  v_add_f32 v213, v213, v104
  v_add_f32 v213, v213, v105
  v_add_f32 v213, v213, v106
  v_add_f32 v213, v213, v107
  v_rcp_f32 v213, v213
  v_mov_b32 v214, 0
  v_mul_f32 v100, v213, v100
  v_mul_f32 v101, v213, v101
  v_mul_f32 v102, v213, v102
  v_mul_f32 v103, v213, v103
  v_mul_f32 v104, v213, v104
  v_mul_f32 v105, v213, v105
  v_mul_f32 v106, v213, v106
  v_mul_f32 v107, v213, v107
  v_mov_b32 v112, 0
  v_mov_b32 v113, 0
  v_mov_b32 v114, 0
  v_mov_b32 v115, 0
  v_mov_b32 v116, 0
  v_mov_b32 v117, 0
  v_mov_b32 v118, 0
  v_mov_b32 v119, 0
  v_mov_b32 v120, 0
  v_mov_b32 v121, 0
  v_mov_b32 v122, 0
  v_mov_b32 v123, 0
  v_mov_b32 v124, 0
  v_mov_b32 v125, 0
  v_mov_b32 v126, 0
  v_mov_b32 v127, 0
  v_mov_b32 v128, 0
  v_mov_b32 v129, 0
  v_cvt_pk_bf16_f32 v0, v100, v214
  v_cvt_pk_bf16_f32 v1, v214, v100
  s_waitcnt lgkmcnt(15)
  v_dot2c_f32_bf16 v112, v16, v0
  v_dot2c_f32_bf16 v113, v16, v1
  v_dot2c_f32_bf16 v114, v17, v0
  v_dot2c_f32_bf16 v115, v17, v1
  v_dot2c_f32_bf16 v116, v18, v0
  v_dot2c_f32_bf16 v117, v18, v1
  v_dot2c_f32_bf16 v118, v19, v0
  v_dot2c_f32_bf16 v119, v19, v1
  v_dot2c_f32_bf16 v120, v20, v0
  v_dot2c_f32_bf16 v121, v20, v1
  v_dot2c_f32_bf16 v122, v21, v0
  v_dot2c_f32_bf16 v123, v21, v1
  v_dot2c_f32_bf16 v124, v22, v0
  v_dot2c_f32_bf16 v125, v22, v1
  v_dot2c_f32_bf16 v126, v23, v0
  v_dot2c_f32_bf16 v127, v23, v1
  v_dot2c_f32_bf16 v128, v24, v0
  v_dot2c_f32_bf16 v129, v24, v1
  v_cvt_pk_bf16_f32 v2, v101, v214
  v_cvt_pk_bf16_f32 v3, v214, v101
  v_dot2c_f32_bf16 v112, v25, v2
  v_dot2c_f32_bf16 v113, v25, v3
  v_dot2c_f32_bf16 v114, v26, v2
  v_dot2c_f32_bf16 v115, v26, v3
  v_dot2c_f32_bf16 v116, v27, v2
  v_dot2c_f32_bf16 v117, v27, v3
  v_dot2c_f32_bf16 v118, v28, v2
  v_dot2c_f32_bf16 v119, v28, v3
  v_dot2c_f32_bf16 v120, v29, v2
  v_dot2c_f32_bf16 v121, v29, v3
  v_dot2c_f32_bf16 v122, v30, v2
  v_dot2c_f32_bf16 v123, v30, v3
  v_dot2c_f32_bf16 v124, v31, v2
  v_dot2c_f32_bf16 v125, v31, v3
  v_dot2c_f32_bf16 v126, v32, v2
  v_dot2c_f32_bf16 v127, v32, v3
  v_dot2c_f32_bf16 v128, v33, v2
  v_dot2c_f32_bf16 v129, v33, v3
  v_cvt_pk_bf16_f32 v0, v102, v214
  v_cvt_pk_bf16_f32 v1, v214, v102
  v_dot2c_f32_bf16 v112, v34, v0
  v_dot2c_f32_bf16 v113, v34, v1
  v_dot2c_f32_bf16 v114, v35, v0
  v_dot2c_f32_bf16 v115, v35, v1
  v_dot2c_f32_bf16 v116, v36, v0
  v_dot2c_f32_bf16 v117, v36, v1
  v_dot2c_f32_bf16 v118, v37, v0
  v_dot2c_f32_bf16 v119, v37, v1
  v_dot2c_f32_bf16 v120, v38, v0
  v_dot2c_f32_bf16 v121, v38, v1
  v_dot2c_f32_bf16 v122, v39, v0
  v_dot2c_f32_bf16 v123, v39, v1
  v_dot2c_f32_bf16 v124, v40, v0
  v_dot2c_f32_bf16 v125, v40, v1
  v_dot2c_f32_bf16 v126, v41, v0
  v_dot2c_f32_bf16 v127, v41, v1
  v_dot2c_f32_bf16 v128, v42, v0
  v_dot2c_f32_bf16 v129, v42, v1
  v_cvt_pk_bf16_f32 v2, v103, v214
  v_cvt_pk_bf16_f32 v3, v214, v103
  v_dot2c_f32_bf16 v112, v43, v2
  v_dot2c_f32_bf16 v113, v43, v3
  v_dot2c_f32_bf16 v114, v44, v2
  v_dot2c_f32_bf16 v115, v44, v3
  v_dot2c_f32_bf16 v116, v45, v2
  v_dot2c_f32_bf16 v117, v45, v3
  v_dot2c_f32_bf16 v118, v46, v2
  v_dot2c_f32_bf16 v119, v46, v3
  v_dot2c_f32_bf16 v120, v47, v2
  v_dot2c_f32_bf16 v121, v47, v3
  v_dot2c_f32_bf16 v122, v48, v2
  v_dot2c_f32_bf16 v123, v48, v3
  v_dot2c_f32_bf16 v124, v49, v2
  v_dot2c_f32_bf16 v125, v49, v3
  v_dot2c_f32_bf16 v126, v50, v2
  v_dot2c_f32_bf16 v127, v50, v3
  v_dot2c_f32_bf16 v128, v51, v2
  v_dot2c_f32_bf16 v129, v51, v3
  v_cvt_pk_bf16_f32 v0, v104, v214
  v_cvt_pk_bf16_f32 v1, v214, v104
  v_dot2c_f32_bf16 v112, v52, v0
  v_dot2c_f32_bf16 v113, v52, v1
  v_dot2c_f32_bf16 v114, v53, v0
  v_dot2c_f32_bf16 v115, v53, v1
  v_dot2c_f32_bf16 v116, v54, v0
  v_dot2c_f32_bf16 v117, v54, v1
  v_dot2c_f32_bf16 v118, v55, v0
  v_dot2c_f32_bf16 v119, v55, v1
  v_dot2c_f32_bf16 v120, v56, v0
  v_dot2c_f32_bf16 v121, v56, v1
  v_dot2c_f32_bf16 v122, v57, v0
  v_dot2c_f32_bf16 v123, v57, v1
  v_dot2c_f32_bf16 v124, v58, v0
  v_dot2c_f32_bf16 v125, v58, v1
  v_dot2c_f32_bf16 v126, v59, v0
  v_dot2c_f32_bf16 v127, v59, v1
  v_dot2c_f32_bf16 v128, v60, v0
  v_dot2c_f32_bf16 v129, v60, v1
  v_cvt_pk_bf16_f32 v2, v105, v214
  v_cvt_pk_bf16_f32 v3, v214, v105
  v_dot2c_f32_bf16 v112, v61, v2
  v_dot2c_f32_bf16 v113, v61, v3
  v_dot2c_f32_bf16 v114, v62, v2
  v_dot2c_f32_bf16 v115, v62, v3
  v_dot2c_f32_bf16 v116, v63, v2
  v_dot2c_f32_bf16 v117, v63, v3
  v_dot2c_f32_bf16 v118, v64, v2
  v_dot2c_f32_bf16 v119, v64, v3
  v_dot2c_f32_bf16 v120, v65, v2
  v_dot2c_f32_bf16 v121, v65, v3
  v_dot2c_f32_bf16 v122, v66, v2
  v_dot2c_f32_bf16 v123, v66, v3
  v_dot2c_f32_bf16 v124, v67, v2
  v_dot2c_f32_bf16 v125, v67, v3
  v_dot2c_f32_bf16 v126, v68, v2
  v_dot2c_f32_bf16 v127, v68, v3
  v_dot2c_f32_bf16 v128, v69, v2
  v_dot2c_f32_bf16 v129, v69, v3
  v_cvt_pk_bf16_f32 v0, v106, v214
  v_cvt_pk_bf16_f32 v1, v214, v106
  v_dot2c_f32_bf16 v112, v70, v0
  v_dot2c_f32_bf16 v113, v70, v1
  v_dot2c_f32_bf16 v114, v71, v0
  v_dot2c_f32_bf16 v115, v71, v1
  v_dot2c_f32_bf16 v116, v72, v0
  v_dot2c_f32_bf16 v117, v72, v1
  s_waitcnt lgkmcnt(14)
  v_dot2c_f32_bf16 v118, v73, v0
  v_dot2c_f32_bf16 v119, v73, v1
  s_waitcnt lgkmcnt(13)
  v_dot2c_f32_bf16 v120, v74, v0
  v_dot2c_f32_bf16 v121, v74, v1
  s_waitcnt lgkmcnt(12)
  v_dot2c_f32_bf16 v122, v75, v0
  v_dot2c_f32_bf16 v123, v75, v1
  s_waitcnt lgkmcnt(11)
  v_dot2c_f32_bf16 v124, v76, v0
  v_dot2c_f32_bf16 v125, v76, v1
  s_waitcnt lgkmcnt(10)
  v_dot2c_f32_bf16 v126, v77, v0
  v_dot2c_f32_bf16 v127, v77, v1
  s_waitcnt lgkmcnt(9)
  v_dot2c_f32_bf16 v128, v78, v0
  v_dot2c_f32_bf16 v129, v78, v1
  v_cvt_pk_bf16_f32 v2, v107, v214
  v_cvt_pk_bf16_f32 v3, v214, v107
  s_waitcnt lgkmcnt(8)
  v_dot2c_f32_bf16 v112, v79, v2
  v_dot2c_f32_bf16 v113, v79, v3
  s_waitcnt lgkmcnt(7)
  v_dot2c_f32_bf16 v114, v80, v2
  v_dot2c_f32_bf16 v115, v80, v3
  s_waitcnt lgkmcnt(6)
  v_dot2c_f32_bf16 v116, v81, v2
  v_dot2c_f32_bf16 v117, v81, v3
  s_waitcnt lgkmcnt(5)
  v_dot2c_f32_bf16 v118, v82, v2
  v_dot2c_f32_bf16 v119, v82, v3
  s_waitcnt lgkmcnt(4)
  v_dot2c_f32_bf16 v120, v83, v2
  v_dot2c_f32_bf16 v121, v83, v3
  s_waitcnt lgkmcnt(3)
  v_dot2c_f32_bf16 v122, v84, v2
  v_dot2c_f32_bf16 v123, v84, v3
  s_waitcnt lgkmcnt(2)
  v_dot2c_f32_bf16 v124, v85, v2
  v_dot2c_f32_bf16 v125, v85, v3
  s_waitcnt lgkmcnt(1)
  v_dot2c_f32_bf16 v126, v86, v2
  v_dot2c_f32_bf16 v127, v86, v3
  s_waitcnt lgkmcnt(0)
  v_dot2c_f32_bf16 v128, v87, v2
  v_dot2c_f32_bf16 v129, v87, v3
  v_cvt_pk_bf16_f32 v132, v112, v113
  v_cvt_pk_bf16_f32 v133, v114, v115
  v_cvt_pk_bf16_f32 v134, v116, v117
  v_cvt_pk_bf16_f32 v135, v118, v119
  v_cvt_pk_bf16_f32 v136, v120, v121
  v_cvt_pk_bf16_f32 v137, v122, v123
  v_cvt_pk_bf16_f32 v138, v124, v125
  v_cvt_pk_bf16_f32 v139, v126, v127
  v_cvt_pk_bf16_f32 v140, v128, v129
  buffer_store_dwordx4 v[132:135], v220, s[8:11], s64 offen sc1
  buffer_store_dwordx4 v[136:139], v220, s[8:11], s64 offen offset:16 sc1
  buffer_store_dword v140, v220, s[8:11], s64 offen offset:32 sc1
  v_add_u32 v219, 33024, v219
  s_add_u32 s66, s66, 64
  s_add_u32 s64, s64, 73728
  ds_read_b32 v0, v219 offset:7224
  ds_read_b32 v1, v219 offset:7228
  ds_read_b32 v2, v219 offset:7232
  ds_read_b32 v3, v219 offset:7236
  ds_read_b32 v4, v219 offset:7240
  ds_read_b32 v5, v219 offset:7244
  ds_read_b32 v6, v219 offset:7248
  ds_read_b32 v7, v219 offset:7252
  ds_read_b32 v8, v219 offset:7256
  ds_read_b32 v16, v219 offset:7368
  ds_read_b32 v17, v219 offset:7372
  ds_read_b32 v18, v219 offset:7376
  ds_read_b32 v19, v219 offset:7380
  ds_read_b32 v20, v219 offset:7384
  ds_read_b32 v21, v219 offset:7388
  ds_read_b32 v22, v219 offset:7392
  ds_read_b32 v23, v219 offset:7396
  ds_read_b32 v24, v219 offset:7400
  ds_read_b32 v25, v219 offset:6336
  ds_read_b32 v26, v219 offset:6340
  ds_read_b32 v27, v219 offset:6344
  ds_read_b32 v28, v219 offset:6348
  ds_read_b32 v29, v219 offset:6352
  ds_read_b32 v30, v219 offset:6356
  ds_read_b32 v31, v219 offset:6360
  ds_read_b32 v32, v219 offset:6364
  ds_read_b32 v33, v219 offset:6368
  ds_read_b32 v34, v219 offset:5304
  ds_read_b32 v35, v219 offset:5308
  ds_read_b32 v36, v219 offset:5312
  ds_read_b32 v37, v219 offset:5316
  ds_read_b32 v38, v219 offset:5320
  ds_read_b32 v39, v219 offset:5324
  ds_read_b32 v40, v219 offset:5328
  ds_read_b32 v41, v219 offset:5332
  ds_read_b32 v42, v219 offset:5336
  ds_read_b32 v43, v219 offset:4272
  ds_read_b32 v44, v219 offset:4276
  ds_read_b32 v45, v219 offset:4280
  ds_read_b32 v46, v219 offset:4284
  ds_read_b32 v47, v219 offset:4288
  ds_read_b32 v48, v219 offset:4292
  ds_read_b32 v49, v219 offset:4296
  ds_read_b32 v50, v219 offset:4300
  ds_read_b32 v51, v219 offset:4304
  ds_read_b32 v52, v219 offset:3240
  ds_read_b32 v53, v219 offset:3244
  ds_read_b32 v54, v219 offset:3248
  ds_read_b32 v55, v219 offset:3252
  ds_read_b32 v56, v219 offset:3256
  ds_read_b32 v57, v219 offset:3260
  ds_read_b32 v58, v219 offset:3264
  ds_read_b32 v59, v219 offset:3268
  ds_read_b32 v60, v219 offset:3272
  ds_read_b32 v61, v219 offset:2208
  ds_read_b32 v62, v219 offset:2212
  ds_read_b32 v63, v219 offset:2216
  ds_read_b32 v64, v219 offset:2220
  ds_read_b32 v65, v219 offset:2224
  ds_read_b32 v66, v219 offset:2228
  ds_read_b32 v67, v219 offset:2232
  ds_read_b32 v68, v219 offset:2236
  ds_read_b32 v69, v219 offset:2240
  ds_read_b32 v70, v219 offset:1176
  ds_read_b32 v71, v219 offset:1180
  ds_read_b32 v72, v219 offset:1184
  ds_read_b32 v73, v219 offset:1188
  ds_read_b32 v74, v219 offset:1192
  ds_read_b32 v75, v219 offset:1196
  ds_read_b32 v76, v219 offset:1200
  ds_read_b32 v77, v219 offset:1204
  ds_read_b32 v78, v219 offset:1208
  ds_read_b32 v79, v219 offset:144
  ds_read_b32 v80, v219 offset:148
  ds_read_b32 v81, v219 offset:152
  ds_read_b32 v82, v219 offset:156
  ds_read_b32 v83, v219 offset:160
  ds_read_b32 v84, v219 offset:164
  ds_read_b32 v85, v219 offset:168
  ds_read_b32 v86, v219 offset:172
  ds_read_b32 v87, v219 offset:176
  v_mov_b32 v100, 0
  v_mov_b32 v101, 0
  v_mov_b32 v102, 0
  v_mov_b32 v103, 0
  v_mov_b32 v104, 0
  v_mov_b32 v105, 0
  v_mov_b32 v106, 0
  v_mov_b32 v107, 0
  s_waitcnt lgkmcnt(15)
  v_dot2c_f32_bf16 v100, v0, v16
  v_dot2c_f32_bf16 v101, v0, v25
  v_dot2c_f32_bf16 v102, v0, v34
  v_dot2c_f32_bf16 v103, v0, v43
  v_dot2c_f32_bf16 v104, v0, v52
  v_dot2c_f32_bf16 v105, v0, v61
  v_dot2c_f32_bf16 v106, v0, v70
  s_waitcnt lgkmcnt(8)
  v_dot2c_f32_bf16 v107, v0, v79
  v_dot2c_f32_bf16 v100, v1, v17
  v_dot2c_f32_bf16 v101, v1, v26
  v_dot2c_f32_bf16 v102, v1, v35
  v_dot2c_f32_bf16 v103, v1, v44
  v_dot2c_f32_bf16 v104, v1, v53
  v_dot2c_f32_bf16 v105, v1, v62
  v_dot2c_f32_bf16 v106, v1, v71
  s_waitcnt lgkmcnt(7)
  v_dot2c_f32_bf16 v107, v1, v80
  v_dot2c_f32_bf16 v100, v2, v18
  v_dot2c_f32_bf16 v101, v2, v27
  v_dot2c_f32_bf16 v102, v2, v36
  v_dot2c_f32_bf16 v103, v2, v45
  v_dot2c_f32_bf16 v104, v2, v54
  v_dot2c_f32_bf16 v105, v2, v63
  v_dot2c_f32_bf16 v106, v2, v72
  s_waitcnt lgkmcnt(6)
  v_dot2c_f32_bf16 v107, v2, v81
  v_dot2c_f32_bf16 v100, v3, v19
  v_dot2c_f32_bf16 v101, v3, v28
  v_dot2c_f32_bf16 v102, v3, v37
  v_dot2c_f32_bf16 v103, v3, v46
  v_dot2c_f32_bf16 v104, v3, v55
  v_dot2c_f32_bf16 v105, v3, v64
  v_dot2c_f32_bf16 v106, v3, v73
  s_waitcnt lgkmcnt(5)
  v_dot2c_f32_bf16 v107, v3, v82
  v_dot2c_f32_bf16 v100, v4, v20
  v_dot2c_f32_bf16 v101, v4, v29
  v_dot2c_f32_bf16 v102, v4, v38
  v_dot2c_f32_bf16 v103, v4, v47
  v_dot2c_f32_bf16 v104, v4, v56
  v_dot2c_f32_bf16 v105, v4, v65
  v_dot2c_f32_bf16 v106, v4, v74
  s_waitcnt lgkmcnt(4)
  v_dot2c_f32_bf16 v107, v4, v83
  v_dot2c_f32_bf16 v100, v5, v21
  v_dot2c_f32_bf16 v101, v5, v30
  v_dot2c_f32_bf16 v102, v5, v39
  v_dot2c_f32_bf16 v103, v5, v48
  v_dot2c_f32_bf16 v104, v5, v57
  v_dot2c_f32_bf16 v105, v5, v66
  v_dot2c_f32_bf16 v106, v5, v75
  s_waitcnt lgkmcnt(3)
  v_dot2c_f32_bf16 v107, v5, v84
  v_dot2c_f32_bf16 v100, v6, v22
  v_dot2c_f32_bf16 v101, v6, v31
  v_dot2c_f32_bf16 v102, v6, v40
  v_dot2c_f32_bf16 v103, v6, v49
  v_dot2c_f32_bf16 v104, v6, v58
  v_dot2c_f32_bf16 v105, v6, v67
  v_dot2c_f32_bf16 v106, v6, v76
  s_waitcnt lgkmcnt(2)
  v_dot2c_f32_bf16 v107, v6, v85
  v_dot2c_f32_bf16 v100, v7, v23
  v_dot2c_f32_bf16 v101, v7, v32
  v_dot2c_f32_bf16 v102, v7, v41
  v_dot2c_f32_bf16 v103, v7, v50
  v_dot2c_f32_bf16 v104, v7, v59
  v_dot2c_f32_bf16 v105, v7, v68
  v_dot2c_f32_bf16 v106, v7, v77
  s_waitcnt lgkmcnt(1)
  v_dot2c_f32_bf16 v107, v7, v86
  v_dot2c_f32_bf16 v100, v8, v24
  v_dot2c_f32_bf16 v101, v8, v33
  v_dot2c_f32_bf16 v102, v8, v42
  v_dot2c_f32_bf16 v103, v8, v51
  v_dot2c_f32_bf16 v104, v8, v60
  v_dot2c_f32_bf16 v105, v8, v69
  v_dot2c_f32_bf16 v106, v8, v78
  s_waitcnt lgkmcnt(0)
  v_dot2c_f32_bf16 v107, v8, v87
  ds_read_b32 v16, v219 offset:7512
  ds_read_b32 v17, v219 offset:7516
  ds_read_b32 v18, v219 offset:7520
  ds_read_b32 v19, v219 offset:7524
  ds_read_b32 v20, v219 offset:7528
  ds_read_b32 v21, v219 offset:7532
  ds_read_b32 v22, v219 offset:7536
  ds_read_b32 v23, v219 offset:7540
  ds_read_b32 v24, v219 offset:7544
  ds_read_b32 v25, v219 offset:6480
  ds_read_b32 v26, v219 offset:6484
  ds_read_b32 v27, v219 offset:6488
  ds_read_b32 v28, v219 offset:6492
  ds_read_b32 v29, v219 offset:6496
  ds_read_b32 v30, v219 offset:6500
  ds_read_b32 v31, v219 offset:6504
  ds_read_b32 v32, v219 offset:6508
  ds_read_b32 v33, v219 offset:6512
  ds_read_b32 v34, v219 offset:5448
  ds_read_b32 v35, v219 offset:5452
  ds_read_b32 v36, v219 offset:5456
  ds_read_b32 v37, v219 offset:5460
  ds_read_b32 v38, v219 offset:5464
  ds_read_b32 v39, v219 offset:5468
  ds_read_b32 v40, v219 offset:5472
  ds_read_b32 v41, v219 offset:5476
  ds_read_b32 v42, v219 offset:5480
  ds_read_b32 v43, v219 offset:4416
  ds_read_b32 v44, v219 offset:4420
  ds_read_b32 v45, v219 offset:4424
  ds_read_b32 v46, v219 offset:4428
  ds_read_b32 v47, v219 offset:4432
  ds_read_b32 v48, v219 offset:4436
  ds_read_b32 v49, v219 offset:4440
  ds_read_b32 v50, v219 offset:4444
  ds_read_b32 v51, v219 offset:4448
  ds_read_b32 v52, v219 offset:3384
  ds_read_b32 v53, v219 offset:3388
  ds_read_b32 v54, v219 offset:3392
  ds_read_b32 v55, v219 offset:3396
  ds_read_b32 v56, v219 offset:3400
  ds_read_b32 v57, v219 offset:3404
  ds_read_b32 v58, v219 offset:3408
  ds_read_b32 v59, v219 offset:3412
  ds_read_b32 v60, v219 offset:3416
  ds_read_b32 v61, v219 offset:2352
  ds_read_b32 v62, v219 offset:2356
  ds_read_b32 v63, v219 offset:2360
  ds_read_b32 v64, v219 offset:2364
  ds_read_b32 v65, v219 offset:2368
  ds_read_b32 v66, v219 offset:2372
  ds_read_b32 v67, v219 offset:2376
  ds_read_b32 v68, v219 offset:2380
  ds_read_b32 v69, v219 offset:2384
  ds_read_b32 v70, v219 offset:1320
  ds_read_b32 v71, v219 offset:1324
  ds_read_b32 v72, v219 offset:1328
  ds_read_b32 v73, v219 offset:1332
  ds_read_b32 v74, v219 offset:1336
  ds_read_b32 v75, v219 offset:1340
  ds_read_b32 v76, v219 offset:1344
  ds_read_b32 v77, v219 offset:1348
  ds_read_b32 v78, v219 offset:1352
  ds_read_b32 v79, v219 offset:288
  ds_read_b32 v80, v219 offset:292
  ds_read_b32 v81, v219 offset:296
  ds_read_b32 v82, v219 offset:300
  ds_read_b32 v83, v219 offset:304
  ds_read_b32 v84, v219 offset:308
  ds_read_b32 v85, v219 offset:312
  ds_read_b32 v86, v219 offset:316
  ds_read_b32 v87, v219 offset:320
  v_add_u32 v211, s66, v200
  v_mov_b32 v212, 0xf149f2ca
  v_mul_f32 v100, s57, v100
  v_mul_f32 v101, s57, v101
  v_mul_f32 v102, s57, v102
  v_mul_f32 v103, s57, v103
  v_mul_f32 v104, s57, v104
  v_mul_f32 v105, s57, v105
  v_mul_f32 v106, s57, v106
  v_mul_f32 v107, s57, v107
  v_cmp_gt_u32 vcc, 2, v211
  s_nop 1
  v_cndmask_b32 v101, v101, v212, vcc
  v_cmp_gt_u32 vcc, 4, v211
  s_nop 1
  v_cndmask_b32 v102, v102, v212, vcc
  v_cmp_gt_u32 vcc, 6, v211
  s_nop 1
  v_cndmask_b32 v103, v103, v212, vcc
  v_cmp_gt_u32 vcc, 8, v211
  s_nop 1
  v_cndmask_b32 v104, v104, v212, vcc
  v_cmp_gt_u32 vcc, 10, v211
  s_nop 1
  v_cndmask_b32 v105, v105, v212, vcc
  v_cmp_gt_u32 vcc, 12, v211
  s_nop 1
  v_cndmask_b32 v106, v106, v212, vcc
  v_cmp_gt_u32 vcc, 14, v211
  s_nop 1
  v_cndmask_b32 v107, v107, v212, vcc
  v_max3_f32 v213, v100, v101, v102
  v_max3_f32 v213, v213, v103, v104
  v_max3_f32 v213, v213, v105, v106
  v_max_f32 v213, v213, v107
  v_sub_f32 v100, v100, v213
  v_sub_f32 v101, v101, v213
  v_sub_f32 v102, v102, v213
  v_sub_f32 v103, v103, v213
  v_sub_f32 v104, v104, v213
  v_sub_f32 v105, v105, v213
  v_sub_f32 v106, v106, v213
  v_sub_f32 v107, v107, v213
  v_exp_f32 v100, v100
  v_exp_f32 v101, v101
  v_exp_f32 v102, v102
  v_exp_f32 v103, v103
  v_exp_f32 v104, v104
  v_exp_f32 v105, v105
  v_exp_f32 v106, v106
  v_exp_f32 v107, v107
  v_add_f32 v213, v100, v101
  v_add_f32 v213, v213, v102
  v_add_f32 v213, v213, v103
  v_add_f32 v213, v213, v104
  v_add_f32 v213, v213, v105
  v_add_f32 v213, v213, v106
  v_add_f32 v213, v213, v107
  v_rcp_f32 v213, v213
  v_mov_b32 v214, 0
  v_mul_f32 v100, v213, v100
  v_mul_f32 v101, v213, v101
  v_mul_f32 v102, v213, v102
  v_mul_f32 v103, v213, v103
  v_mul_f32 v104, v213, v104
  v_mul_f32 v105, v213, v105
  v_mul_f32 v106, v213, v106
  v_mul_f32 v107, v213, v107
  v_mov_b32 v112, 0
  v_mov_b32 v113, 0
  v_mov_b32 v114, 0
  v_mov_b32 v115, 0
  v_mov_b32 v116, 0
  v_mov_b32 v117, 0
  v_mov_b32 v118, 0
  v_mov_b32 v119, 0
  v_mov_b32 v120, 0
  v_mov_b32 v121, 0
  v_mov_b32 v122, 0
  v_mov_b32 v123, 0
  v_mov_b32 v124, 0
  v_mov_b32 v125, 0
  v_mov_b32 v126, 0
  v_mov_b32 v127, 0
  v_mov_b32 v128, 0
  v_mov_b32 v129, 0
  v_cvt_pk_bf16_f32 v0, v100, v214
  v_cvt_pk_bf16_f32 v1, v214, v100
  s_waitcnt lgkmcnt(15)
  v_dot2c_f32_bf16 v112, v16, v0
  v_dot2c_f32_bf16 v113, v16, v1
  v_dot2c_f32_bf16 v114, v17, v0
  v_dot2c_f32_bf16 v115, v17, v1
  v_dot2c_f32_bf16 v116, v18, v0
  v_dot2c_f32_bf16 v117, v18, v1
  v_dot2c_f32_bf16 v118, v19, v0
  v_dot2c_f32_bf16 v119, v19, v1
  v_dot2c_f32_bf16 v120, v20, v0
  v_dot2c_f32_bf16 v121, v20, v1
  v_dot2c_f32_bf16 v122, v21, v0
  v_dot2c_f32_bf16 v123, v21, v1
  v_dot2c_f32_bf16 v124, v22, v0
  v_dot2c_f32_bf16 v125, v22, v1
  v_dot2c_f32_bf16 v126, v23, v0
  v_dot2c_f32_bf16 v127, v23, v1
  v_dot2c_f32_bf16 v128, v24, v0
  v_dot2c_f32_bf16 v129, v24, v1
  v_cvt_pk_bf16_f32 v2, v101, v214
  v_cvt_pk_bf16_f32 v3, v214, v101
  v_dot2c_f32_bf16 v112, v25, v2
  v_dot2c_f32_bf16 v113, v25, v3
  v_dot2c_f32_bf16 v114, v26, v2
  v_dot2c_f32_bf16 v115, v26, v3
  v_dot2c_f32_bf16 v116, v27, v2
  v_dot2c_f32_bf16 v117, v27, v3
  v_dot2c_f32_bf16 v118, v28, v2
  v_dot2c_f32_bf16 v119, v28, v3
  v_dot2c_f32_bf16 v120, v29, v2
  v_dot2c_f32_bf16 v121, v29, v3
  v_dot2c_f32_bf16 v122, v30, v2
  v_dot2c_f32_bf16 v123, v30, v3
  v_dot2c_f32_bf16 v124, v31, v2
  v_dot2c_f32_bf16 v125, v31, v3
  v_dot2c_f32_bf16 v126, v32, v2
  v_dot2c_f32_bf16 v127, v32, v3
  v_dot2c_f32_bf16 v128, v33, v2
  v_dot2c_f32_bf16 v129, v33, v3
  v_cvt_pk_bf16_f32 v0, v102, v214
  v_cvt_pk_bf16_f32 v1, v214, v102
  v_dot2c_f32_bf16 v112, v34, v0
  v_dot2c_f32_bf16 v113, v34, v1
  v_dot2c_f32_bf16 v114, v35, v0
  v_dot2c_f32_bf16 v115, v35, v1
  v_dot2c_f32_bf16 v116, v36, v0
  v_dot2c_f32_bf16 v117, v36, v1
  v_dot2c_f32_bf16 v118, v37, v0
  v_dot2c_f32_bf16 v119, v37, v1
  v_dot2c_f32_bf16 v120, v38, v0
  v_dot2c_f32_bf16 v121, v38, v1
  v_dot2c_f32_bf16 v122, v39, v0
  v_dot2c_f32_bf16 v123, v39, v1
  v_dot2c_f32_bf16 v124, v40, v0
  v_dot2c_f32_bf16 v125, v40, v1
  v_dot2c_f32_bf16 v126, v41, v0
  v_dot2c_f32_bf16 v127, v41, v1
  v_dot2c_f32_bf16 v128, v42, v0
  v_dot2c_f32_bf16 v129, v42, v1
  v_cvt_pk_bf16_f32 v2, v103, v214
  v_cvt_pk_bf16_f32 v3, v214, v103
  v_dot2c_f32_bf16 v112, v43, v2
  v_dot2c_f32_bf16 v113, v43, v3
  v_dot2c_f32_bf16 v114, v44, v2
  v_dot2c_f32_bf16 v115, v44, v3
  v_dot2c_f32_bf16 v116, v45, v2
  v_dot2c_f32_bf16 v117, v45, v3
  v_dot2c_f32_bf16 v118, v46, v2
  v_dot2c_f32_bf16 v119, v46, v3
  v_dot2c_f32_bf16 v120, v47, v2
  v_dot2c_f32_bf16 v121, v47, v3
  v_dot2c_f32_bf16 v122, v48, v2
  v_dot2c_f32_bf16 v123, v48, v3
  v_dot2c_f32_bf16 v124, v49, v2
  v_dot2c_f32_bf16 v125, v49, v3
  v_dot2c_f32_bf16 v126, v50, v2
  v_dot2c_f32_bf16 v127, v50, v3
  v_dot2c_f32_bf16 v128, v51, v2
  v_dot2c_f32_bf16 v129, v51, v3
  v_cvt_pk_bf16_f32 v0, v104, v214
  v_cvt_pk_bf16_f32 v1, v214, v104
  v_dot2c_f32_bf16 v112, v52, v0
  v_dot2c_f32_bf16 v113, v52, v1
  v_dot2c_f32_bf16 v114, v53, v0
  v_dot2c_f32_bf16 v115, v53, v1
  v_dot2c_f32_bf16 v116, v54, v0
  v_dot2c_f32_bf16 v117, v54, v1
  v_dot2c_f32_bf16 v118, v55, v0
  v_dot2c_f32_bf16 v119, v55, v1
  v_dot2c_f32_bf16 v120, v56, v0
  v_dot2c_f32_bf16 v121, v56, v1
  v_dot2c_f32_bf16 v122, v57, v0
  v_dot2c_f32_bf16 v123, v57, v1
  v_dot2c_f32_bf16 v124, v58, v0
  v_dot2c_f32_bf16 v125, v58, v1
  v_dot2c_f32_bf16 v126, v59, v0
  v_dot2c_f32_bf16 v127, v59, v1
  v_dot2c_f32_bf16 v128, v60, v0
  v_dot2c_f32_bf16 v129, v60, v1
  v_cvt_pk_bf16_f32 v2, v105, v214
  v_cvt_pk_bf16_f32 v3, v214, v105
  v_dot2c_f32_bf16 v112, v61, v2
  v_dot2c_f32_bf16 v113, v61, v3
  v_dot2c_f32_bf16 v114, v62, v2
  v_dot2c_f32_bf16 v115, v62, v3
  v_dot2c_f32_bf16 v116, v63, v2
  v_dot2c_f32_bf16 v117, v63, v3
  v_dot2c_f32_bf16 v118, v64, v2
  v_dot2c_f32_bf16 v119, v64, v3
  v_dot2c_f32_bf16 v120, v65, v2
  v_dot2c_f32_bf16 v121, v65, v3
  v_dot2c_f32_bf16 v122, v66, v2
  v_dot2c_f32_bf16 v123, v66, v3
  v_dot2c_f32_bf16 v124, v67, v2
  v_dot2c_f32_bf16 v125, v67, v3
  v_dot2c_f32_bf16 v126, v68, v2
  v_dot2c_f32_bf16 v127, v68, v3
  v_dot2c_f32_bf16 v128, v69, v2
  v_dot2c_f32_bf16 v129, v69, v3
  v_cvt_pk_bf16_f32 v0, v106, v214
  v_cvt_pk_bf16_f32 v1, v214, v106
  v_dot2c_f32_bf16 v112, v70, v0
  v_dot2c_f32_bf16 v113, v70, v1
  v_dot2c_f32_bf16 v114, v71, v0
  v_dot2c_f32_bf16 v115, v71, v1
  v_dot2c_f32_bf16 v116, v72, v0
  v_dot2c_f32_bf16 v117, v72, v1
  s_waitcnt lgkmcnt(14)
  v_dot2c_f32_bf16 v118, v73, v0
  v_dot2c_f32_bf16 v119, v73, v1
  s_waitcnt lgkmcnt(13)
  v_dot2c_f32_bf16 v120, v74, v0
  v_dot2c_f32_bf16 v121, v74, v1
  s_waitcnt lgkmcnt(12)
  v_dot2c_f32_bf16 v122, v75, v0
  v_dot2c_f32_bf16 v123, v75, v1
  s_waitcnt lgkmcnt(11)
  v_dot2c_f32_bf16 v124, v76, v0
  v_dot2c_f32_bf16 v125, v76, v1
  s_waitcnt lgkmcnt(10)
  v_dot2c_f32_bf16 v126, v77, v0
  v_dot2c_f32_bf16 v127, v77, v1
  s_waitcnt lgkmcnt(9)
  v_dot2c_f32_bf16 v128, v78, v0
  v_dot2c_f32_bf16 v129, v78, v1
  v_cvt_pk_bf16_f32 v2, v107, v214
  v_cvt_pk_bf16_f32 v3, v214, v107
  s_waitcnt lgkmcnt(8)
  v_dot2c_f32_bf16 v112, v79, v2
  v_dot2c_f32_bf16 v113, v79, v3
  s_waitcnt lgkmcnt(7)
  v_dot2c_f32_bf16 v114, v80, v2
  v_dot2c_f32_bf16 v115, v80, v3
  s_waitcnt lgkmcnt(6)
  v_dot2c_f32_bf16 v116, v81, v2
  v_dot2c_f32_bf16 v117, v81, v3
  s_waitcnt lgkmcnt(5)
  v_dot2c_f32_bf16 v118, v82, v2
  v_dot2c_f32_bf16 v119, v82, v3
  s_waitcnt lgkmcnt(4)
  v_dot2c_f32_bf16 v120, v83, v2
  v_dot2c_f32_bf16 v121, v83, v3
  s_waitcnt lgkmcnt(3)
  v_dot2c_f32_bf16 v122, v84, v2
  v_dot2c_f32_bf16 v123, v84, v3
  s_waitcnt lgkmcnt(2)
  v_dot2c_f32_bf16 v124, v85, v2
  v_dot2c_f32_bf16 v125, v85, v3
  s_waitcnt lgkmcnt(1)
  v_dot2c_f32_bf16 v126, v86, v2
  v_dot2c_f32_bf16 v127, v86, v3
  s_waitcnt lgkmcnt(0)
  v_dot2c_f32_bf16 v128, v87, v2
  v_dot2c_f32_bf16 v129, v87, v3
  v_cvt_pk_bf16_f32 v132, v112, v113
  v_cvt_pk_bf16_f32 v133, v114, v115
  v_cvt_pk_bf16_f32 v134, v116, v117
  v_cvt_pk_bf16_f32 v135, v118, v119
  v_cvt_pk_bf16_f32 v136, v120, v121
  v_cvt_pk_bf16_f32 v137, v122, v123
  v_cvt_pk_bf16_f32 v138, v124, v125
  v_cvt_pk_bf16_f32 v139, v126, v127
  v_cvt_pk_bf16_f32 v140, v128, v129
  buffer_store_dwordx4 v[132:135], v220, s[8:11], s64 offen sc1
  buffer_store_dwordx4 v[136:139], v220, s[8:11], s64 offen offset:16 sc1
  buffer_store_dword v140, v220, s[8:11], s64 offen offset:32 sc1
  s_mov_b32 s56, 36
  s_waitcnt vmcnt(0)
  s_barrier
  s_cmp_eq_u32 s52, 0
  s_cbranch_scc0 A_sig
  v_mov_b32 v211, 1
  v_mov_b32 v212, 0
  s_mov_b64 exec, 1
  buffer_atomic_add v211, v212, s[12:15], s56 offen
  s_mov_b64 exec, -1
A_sig:
  s_and_b32 s54, s53, 31
  s_cmp_lt_u32 s54, 27
  s_cbranch_scc0 L_exit
  s_and_b32 s54, s53, 31
  s_mul_i32 s68, s54, 57
  s_lshr_b32 s68, s68, 9
  s_mul_i32 s56, s68, 9
  s_sub_u32 s70, s54, s56
  s_bfe_u32 s55, s53, 0x10005
  s_mul_i32 s55, s55, 9
  s_add_u32 s70, s70, s55
  s_bfe_u32 s69, s53, 0x10006
  v_lshrrev_b32 v211, 2, v200
  v_mul_u32_u24 v211, 1152, v211
  v_and_b32 v212, 3, v200
  v_lshl_add_u32 v207, v212, 4, v211
  s_lshl_b32 s54, s70, 6
  s_mul_i32 s55, s52, 1179648
  s_add_u32 s62, s54, s55
  s_mul_i32 s55, s52, 184320
  s_add_u32 s63, s54, s55
  s_mul_i32 s61, s52, 40960
  v_bfe_u32 v211, v200, 2, 2
  v_lshlrev_b32 v212, 4, v212
  v_add_u32 v212, s61, v212
  v_lshl_add_u32 v212, v211, 6, v212
  v_lshrrev_b32 v213, 4, v200
  v_lshl_add_u32 v210, v213, 9, v212
  v_lshrrev_b32 v214, 5, v200
  v_lshl_add_u32 v209, v214, 10, v212
  v_and_b32 v214, 1, v213
  v_lshl_add_u32 v209, v214, 8, v209
  s_add_u32 m0, s61, 0
  s_add_u32 s54, s62, 0
  buffer_load_dwordx4 v207, s[28:31], s54 offen lds
  s_add_u32 m0, s61, 1024
  s_add_u32 s54, s62, 18432
  buffer_load_dwordx4 v207, s[28:31], s54 offen lds
  s_add_u32 m0, s61, 2048
  s_add_u32 s54, s62, 36864
  buffer_load_dwordx4 v207, s[28:31], s54 offen lds
  s_add_u32 m0, s61, 3072
  s_add_u32 s54, s62, 55296
  buffer_load_dwordx4 v207, s[28:31], s54 offen lds
  s_add_u32 m0, s61, 4096
  s_add_u32 s54, s62, 73728
  buffer_load_dwordx4 v207, s[28:31], s54 offen lds
  s_add_u32 m0, s61, 5120
  s_add_u32 s54, s62, 92160
  buffer_load_dwordx4 v207, s[28:31], s54 offen lds
  s_add_u32 m0, s61, 6144
  s_add_u32 s54, s62, 110592
  buffer_load_dwordx4 v207, s[28:31], s54 offen lds
  s_add_u32 m0, s61, 7168
  s_add_u32 s54, s62, 129024
  buffer_load_dwordx4 v207, s[28:31], s54 offen lds
  s_add_u32 m0, s61, 8192
  s_add_u32 s54, s62, 147456
  buffer_load_dwordx4 v207, s[28:31], s54 offen lds
  s_add_u32 m0, s61, 9216
  s_add_u32 s54, s62, 165888
  buffer_load_dwordx4 v207, s[28:31], s54 offen lds
  s_add_u32 m0, s61, 10240
  s_add_u32 s54, s62, 184320
  buffer_load_dwordx4 v207, s[28:31], s54 offen lds
  s_add_u32 m0, s61, 11264
  s_add_u32 s54, s62, 202752
  buffer_load_dwordx4 v207, s[28:31], s54 offen lds
  s_add_u32 m0, s61, 12288
  s_add_u32 s54, s62, 221184
  buffer_load_dwordx4 v207, s[28:31], s54 offen lds
  s_add_u32 m0, s61, 13312
  s_add_u32 s54, s62, 239616
  buffer_load_dwordx4 v207, s[28:31], s54 offen lds
  s_add_u32 m0, s61, 14336
  s_add_u32 s54, s62, 258048
  buffer_load_dwordx4 v207, s[28:31], s54 offen lds
  s_add_u32 m0, s61, 15360
  s_add_u32 s54, s62, 276480
  buffer_load_dwordx4 v207, s[28:31], s54 offen lds
  s_add_u32 m0, s61, 16384
  s_add_u32 s54, s62, 294912
  buffer_load_dwordx4 v207, s[28:31], s54 offen lds
  s_add_u32 m0, s61, 17408
  s_add_u32 s54, s62, 313344
  buffer_load_dwordx4 v207, s[28:31], s54 offen lds
  s_add_u32 m0, s61, 18432
  s_add_u32 s54, s62, 331776
  buffer_load_dwordx4 v207, s[28:31], s54 offen lds
  s_add_u32 m0, s61, 19456
  s_add_u32 s54, s62, 350208
  buffer_load_dwordx4 v207, s[28:31], s54 offen lds
  s_add_u32 m0, s61, 20480
  s_add_u32 s54, s62, 368640
  buffer_load_dwordx4 v207, s[28:31], s54 offen lds
  s_add_u32 m0, s61, 21504
  s_add_u32 s54, s62, 387072
  buffer_load_dwordx4 v207, s[28:31], s54 offen lds
  s_add_u32 m0, s61, 22528
  s_add_u32 s54, s62, 405504
  buffer_load_dwordx4 v207, s[28:31], s54 offen lds
  s_add_u32 m0, s61, 23552
  s_add_u32 s54, s62, 423936
  buffer_load_dwordx4 v207, s[28:31], s54 offen lds
  s_add_u32 m0, s61, 24576
  s_add_u32 s54, s62, 442368
  buffer_load_dwordx4 v207, s[28:31], s54 offen lds
  s_add_u32 m0, s61, 25600
  s_add_u32 s54, s62, 460800
  buffer_load_dwordx4 v207, s[28:31], s54 offen lds
  s_add_u32 m0, s61, 26624
  s_add_u32 s54, s62, 479232
  buffer_load_dwordx4 v207, s[28:31], s54 offen lds
  s_add_u32 m0, s61, 27648
  s_add_u32 s54, s62, 497664
  buffer_load_dwordx4 v207, s[28:31], s54 offen lds
  s_add_u32 m0, s61, 28672
  s_add_u32 s54, s62, 516096
  buffer_load_dwordx4 v207, s[28:31], s54 offen lds
  s_add_u32 m0, s61, 29696
  s_add_u32 s54, s62, 534528
  buffer_load_dwordx4 v207, s[28:31], s54 offen lds
  s_add_u32 m0, s61, 30720
  s_add_u32 s54, s62, 552960
  buffer_load_dwordx4 v207, s[28:31], s54 offen lds
  s_add_u32 m0, s61, 31744
  s_add_u32 s54, s62, 571392
  buffer_load_dwordx4 v207, s[28:31], s54 offen lds
  s_add_u32 m0, s61, 32768
  s_add_u32 s54, s62, 589824
  buffer_load_dwordx4 v207, s[28:31], s54 offen lds
  s_add_u32 m0, s61, 33792
  s_add_u32 s54, s62, 608256
  buffer_load_dwordx4 v207, s[28:31], s54 offen lds
  s_add_u32 m0, s61, 34816
  s_add_u32 s54, s62, 626688
  buffer_load_dwordx4 v207, s[28:31], s54 offen lds
  s_add_u32 m0, s61, 35840
  s_add_u32 s54, s62, 645120
  buffer_load_dwordx4 v207, s[28:31], s54 offen lds
  s_add_u32 m0, s61, 36864
  s_add_u32 s54, s62, 663552
  buffer_load_dwordx4 v207, s[28:31], s54 offen lds
  s_add_u32 m0, s61, 37888
  s_add_u32 s54, s62, 681984
  buffer_load_dwordx4 v207, s[28:31], s54 offen lds
  s_waitcnt vmcnt(36) lgkmcnt(0)
  s_add_u32 m0, s61, 38912
  s_add_u32 s54, s62, 700416
  buffer_load_dwordx4 v207, s[28:31], s54 offen lds
  s_add_u32 m0, s61, 39936
  s_add_u32 s54, s62, 718848
  buffer_load_dwordx4 v207, s[28:31], s54 offen lds
  ds_read_b64_tr_b16 a[0:1], v209 offset:0
  ds_read_b64_tr_b16 a[2:3], v209 offset:512
  ds_read_b64_tr_b16 a[4:5], v209 offset:8
  ds_read_b64_tr_b16 a[6:7], v209 offset:520
  s_waitcnt vmcnt(36) lgkmcnt(0)
  s_add_u32 m0, s61, 0
  s_add_u32 s54, s62, 737280
  buffer_load_dwordx4 v207, s[28:31], s54 offen lds
  s_add_u32 m0, s61, 1024
  s_add_u32 s54, s62, 755712
  buffer_load_dwordx4 v207, s[28:31], s54 offen lds
  ds_read_b64_tr_b16 a[8:9], v209 offset:2048
  ds_read_b64_tr_b16 a[10:11], v209 offset:2560
  ds_read_b64_tr_b16 a[12:13], v209 offset:2056
  ds_read_b64_tr_b16 a[14:15], v209 offset:2568
  s_waitcnt vmcnt(36) lgkmcnt(0)
  s_add_u32 m0, s61, 2048
  s_add_u32 s54, s62, 774144
  buffer_load_dwordx4 v207, s[28:31], s54 offen lds
  s_add_u32 m0, s61, 3072
  s_add_u32 s54, s62, 792576
  buffer_load_dwordx4 v207, s[28:31], s54 offen lds
  ds_read_b64_tr_b16 a[16:17], v209 offset:4096
  ds_read_b64_tr_b16 a[18:19], v209 offset:4608
  ds_read_b64_tr_b16 a[20:21], v209 offset:4104
  ds_read_b64_tr_b16 a[22:23], v209 offset:4616
  s_waitcnt vmcnt(36) lgkmcnt(0)
  s_add_u32 m0, s61, 4096
  s_add_u32 s54, s62, 811008
  buffer_load_dwordx4 v207, s[28:31], s54 offen lds
  s_add_u32 m0, s61, 5120
  s_add_u32 s54, s62, 829440
  buffer_load_dwordx4 v207, s[28:31], s54 offen lds
  ds_read_b64_tr_b16 a[24:25], v209 offset:6144
  ds_read_b64_tr_b16 a[26:27], v209 offset:6656
  ds_read_b64_tr_b16 a[28:29], v209 offset:6152
  ds_read_b64_tr_b16 a[30:31], v209 offset:6664
  s_waitcnt vmcnt(36) lgkmcnt(0)
  s_add_u32 m0, s61, 6144
  s_add_u32 s54, s62, 847872
  buffer_load_dwordx4 v207, s[28:31], s54 offen lds
  s_add_u32 m0, s61, 7168
  s_add_u32 s54, s62, 866304
  buffer_load_dwordx4 v207, s[28:31], s54 offen lds
  ds_read_b64_tr_b16 a[32:33], v209 offset:8192
  ds_read_b64_tr_b16 a[34:35], v209 offset:8704
  ds_read_b64_tr_b16 a[36:37], v209 offset:8200
  ds_read_b64_tr_b16 a[38:39], v209 offset:8712
  s_waitcnt vmcnt(36) lgkmcnt(0)
  s_add_u32 m0, s61, 8192
  s_add_u32 s54, s62, 884736
  buffer_load_dwordx4 v207, s[28:31], s54 offen lds
  s_add_u32 m0, s61, 9216
  s_add_u32 s54, s62, 903168
  buffer_load_dwordx4 v207, s[28:31], s54 offen lds
  ds_read_b64_tr_b16 a[40:41], v209 offset:10240
  ds_read_b64_tr_b16 a[42:43], v209 offset:10752
  ds_read_b64_tr_b16 a[44:45], v209 offset:10248
  ds_read_b64_tr_b16 a[46:47], v209 offset:10760
  s_waitcnt vmcnt(36) lgkmcnt(0)
  s_add_u32 m0, s61, 10240
  s_add_u32 s54, s62, 921600
  buffer_load_dwordx4 v207, s[28:31], s54 offen lds
  s_add_u32 m0, s61, 11264
  s_add_u32 s54, s62, 940032
  buffer_load_dwordx4 v207, s[28:31], s54 offen lds
  ds_read_b64_tr_b16 a[48:49], v209 offset:12288
  ds_read_b64_tr_b16 a[50:51], v209 offset:12800
  ds_read_b64_tr_b16 a[52:53], v209 offset:12296
  ds_read_b64_tr_b16 a[54:55], v209 offset:12808
  s_waitcnt vmcnt(36) lgkmcnt(0)
  s_add_u32 m0, s61, 12288
  s_add_u32 s54, s62, 958464
  buffer_load_dwordx4 v207, s[28:31], s54 offen lds
  s_add_u32 m0, s61, 13312
  s_add_u32 s54, s62, 976896
  buffer_load_dwordx4 v207, s[28:31], s54 offen lds
  ds_read_b64_tr_b16 a[56:57], v209 offset:14336
  ds_read_b64_tr_b16 a[58:59], v209 offset:14848
  ds_read_b64_tr_b16 a[60:61], v209 offset:14344
  ds_read_b64_tr_b16 a[62:63], v209 offset:14856
  s_waitcnt vmcnt(36) lgkmcnt(0)
  s_add_u32 m0, s61, 14336
  s_add_u32 s54, s62, 995328
  buffer_load_dwordx4 v207, s[28:31], s54 offen lds
  s_add_u32 m0, s61, 15360
  s_add_u32 s54, s62, 1013760
  buffer_load_dwordx4 v207, s[28:31], s54 offen lds
  ds_read_b64_tr_b16 a[64:65], v209 offset:16384
  ds_read_b64_tr_b16 a[66:67], v209 offset:16896
  ds_read_b64_tr_b16 a[68:69], v209 offset:16392
  ds_read_b64_tr_b16 a[70:71], v209 offset:16904
  s_waitcnt vmcnt(36) lgkmcnt(0)
  s_add_u32 m0, s61, 16384
  s_add_u32 s54, s62, 1032192
  buffer_load_dwordx4 v207, s[28:31], s54 offen lds
  s_add_u32 m0, s61, 17408
  s_add_u32 s54, s62, 1050624
  buffer_load_dwordx4 v207, s[28:31], s54 offen lds
  ds_read_b64_tr_b16 a[72:73], v209 offset:18432
  ds_read_b64_tr_b16 a[74:75], v209 offset:18944
  ds_read_b64_tr_b16 a[76:77], v209 offset:18440
  ds_read_b64_tr_b16 a[78:79], v209 offset:18952
  s_waitcnt vmcnt(36) lgkmcnt(0)
  s_add_u32 m0, s61, 18432
  s_add_u32 s54, s62, 1069056
  buffer_load_dwordx4 v207, s[28:31], s54 offen lds
  s_add_u32 m0, s61, 19456
  s_add_u32 s54, s62, 1087488
  buffer_load_dwordx4 v207, s[28:31], s54 offen lds
  ds_read_b64_tr_b16 a[80:81], v209 offset:20480
  ds_read_b64_tr_b16 a[82:83], v209 offset:20992
  ds_read_b64_tr_b16 a[84:85], v209 offset:20488
  ds_read_b64_tr_b16 a[86:87], v209 offset:21000
  s_waitcnt vmcnt(36) lgkmcnt(0)
  s_add_u32 m0, s61, 20480
  s_add_u32 s54, s62, 1105920
  buffer_load_dwordx4 v207, s[28:31], s54 offen lds
  s_add_u32 m0, s61, 21504
  s_add_u32 s54, s62, 1124352
  buffer_load_dwordx4 v207, s[28:31], s54 offen lds
  ds_read_b64_tr_b16 a[88:89], v209 offset:22528
  ds_read_b64_tr_b16 a[90:91], v209 offset:23040
  ds_read_b64_tr_b16 a[92:93], v209 offset:22536
  ds_read_b64_tr_b16 a[94:95], v209 offset:23048
  s_waitcnt vmcnt(36) lgkmcnt(0)
  s_add_u32 m0, s61, 22528
  s_add_u32 s54, s62, 1142784
  buffer_load_dwordx4 v207, s[28:31], s54 offen lds
  s_add_u32 m0, s61, 23552
  s_add_u32 s54, s62, 1161216
  buffer_load_dwordx4 v207, s[28:31], s54 offen lds
  ds_read_b64_tr_b16 a[96:97], v209 offset:24576
  ds_read_b64_tr_b16 a[98:99], v209 offset:25088
  ds_read_b64_tr_b16 a[100:101], v209 offset:24584
  ds_read_b64_tr_b16 a[102:103], v209 offset:25096
  s_waitcnt vmcnt(36) lgkmcnt(0)
  s_add_u32 m0, s61, 24576
  s_add_u32 s54, s63, 0
  buffer_load_dwordx4 v207, s[40:43], s54 offen lds
  s_add_u32 m0, s61, 25600
  s_add_u32 s54, s63, 18432
  buffer_load_dwordx4 v207, s[40:43], s54 offen lds
  ds_read_b64_tr_b16 a[104:105], v209 offset:26624
  ds_read_b64_tr_b16 a[106:107], v209 offset:27136
  ds_read_b64_tr_b16 a[108:109], v209 offset:26632
  ds_read_b64_tr_b16 a[110:111], v209 offset:27144
  s_waitcnt vmcnt(36) lgkmcnt(0)
  s_add_u32 m0, s61, 26624
  s_add_u32 s54, s63, 36864
  buffer_load_dwordx4 v207, s[40:43], s54 offen lds
  s_add_u32 m0, s61, 27648
  s_add_u32 s54, s63, 55296
  buffer_load_dwordx4 v207, s[40:43], s54 offen lds
  ds_read_b64_tr_b16 a[112:113], v209 offset:28672
  ds_read_b64_tr_b16 a[114:115], v209 offset:29184
  ds_read_b64_tr_b16 a[116:117], v209 offset:28680
  ds_read_b64_tr_b16 a[118:119], v209 offset:29192
  s_waitcnt vmcnt(36) lgkmcnt(0)
  s_add_u32 m0, s61, 28672
  s_add_u32 s54, s63, 73728
  buffer_load_dwordx4 v207, s[40:43], s54 offen lds
  s_add_u32 m0, s61, 29696
  s_add_u32 s54, s63, 92160
  buffer_load_dwordx4 v207, s[40:43], s54 offen lds
  ds_read_b64_tr_b16 a[120:121], v209 offset:30720
  ds_read_b64_tr_b16 a[122:123], v209 offset:31232
  ds_read_b64_tr_b16 a[124:125], v209 offset:30728
  ds_read_b64_tr_b16 a[126:127], v209 offset:31240
  s_waitcnt vmcnt(36) lgkmcnt(0)
  s_add_u32 m0, s61, 30720
  s_add_u32 s54, s63, 110592
  buffer_load_dwordx4 v207, s[40:43], s54 offen lds
  s_add_u32 m0, s61, 31744
  s_add_u32 s54, s63, 129024
  buffer_load_dwordx4 v207, s[40:43], s54 offen lds
  ds_read_b64_tr_b16 a[128:129], v209 offset:32768
  ds_read_b64_tr_b16 a[130:131], v209 offset:33280
  ds_read_b64_tr_b16 a[132:133], v209 offset:32776
  ds_read_b64_tr_b16 a[134:135], v209 offset:33288
  s_waitcnt vmcnt(36) lgkmcnt(0)
  s_add_u32 m0, s61, 32768
  s_add_u32 s54, s63, 147456
  buffer_load_dwordx4 v207, s[40:43], s54 offen lds
  s_add_u32 m0, s61, 33792
  s_add_u32 s54, s63, 165888
  buffer_load_dwordx4 v207, s[40:43], s54 offen lds
  ds_read_b64_tr_b16 a[136:137], v209 offset:34816
  ds_read_b64_tr_b16 a[138:139], v209 offset:35328
  ds_read_b64_tr_b16 a[140:141], v209 offset:34824
  ds_read_b64_tr_b16 a[142:143], v209 offset:35336
  s_waitcnt vmcnt(36) lgkmcnt(0)
  ds_read_b64_tr_b16 a[144:145], v209 offset:36864
  ds_read_b64_tr_b16 a[146:147], v209 offset:37376
  ds_read_b64_tr_b16 a[148:149], v209 offset:36872
  ds_read_b64_tr_b16 a[150:151], v209 offset:37384
  s_waitcnt vmcnt(34) lgkmcnt(0)
  ds_read_b64_tr_b16 a[152:153], v209 offset:38912
  ds_read_b64_tr_b16 a[154:155], v209 offset:39424
  ds_read_b64_tr_b16 a[156:157], v209 offset:38920
  ds_read_b64_tr_b16 a[158:159], v209 offset:39432
  s_waitcnt vmcnt(32) lgkmcnt(0)
  ds_read_b64_tr_b16 a[160:161], v209 offset:0
  ds_read_b64_tr_b16 a[162:163], v209 offset:512
  ds_read_b64_tr_b16 a[164:165], v209 offset:8
  ds_read_b64_tr_b16 a[166:167], v209 offset:520
  s_waitcnt vmcnt(30) lgkmcnt(0)
  ds_read_b64_tr_b16 a[168:169], v209 offset:2048
  ds_read_b64_tr_b16 a[170:171], v209 offset:2560
  ds_read_b64_tr_b16 a[172:173], v209 offset:2056
  ds_read_b64_tr_b16 a[174:175], v209 offset:2568
  s_waitcnt vmcnt(28) lgkmcnt(0)
  ds_read_b64_tr_b16 a[176:177], v209 offset:4096
  ds_read_b64_tr_b16 a[178:179], v209 offset:4608
  ds_read_b64_tr_b16 a[180:181], v209 offset:4104
  ds_read_b64_tr_b16 a[182:183], v209 offset:4616
  s_waitcnt vmcnt(26) lgkmcnt(0)
  ds_read_b64_tr_b16 a[184:185], v209 offset:6144
  ds_read_b64_tr_b16 a[186:187], v209 offset:6656
  ds_read_b64_tr_b16 a[188:189], v209 offset:6152
  ds_read_b64_tr_b16 a[190:191], v209 offset:6664
  s_waitcnt vmcnt(24) lgkmcnt(0)
  ds_read_b64_tr_b16 a[192:193], v209 offset:8192
  ds_read_b64_tr_b16 a[194:195], v209 offset:8704
  ds_read_b64_tr_b16 a[196:197], v209 offset:8200
  ds_read_b64_tr_b16 a[198:199], v209 offset:8712
  s_waitcnt vmcnt(22) lgkmcnt(0)
  ds_read_b64_tr_b16 a[200:201], v209 offset:10240
  ds_read_b64_tr_b16 a[202:203], v209 offset:10752
  ds_read_b64_tr_b16 a[204:205], v209 offset:10248
  ds_read_b64_tr_b16 a[206:207], v209 offset:10760
  s_waitcnt vmcnt(20) lgkmcnt(0)
  ds_read_b64_tr_b16 a[208:209], v209 offset:12288
  ds_read_b64_tr_b16 a[210:211], v209 offset:12800
  ds_read_b64_tr_b16 a[212:213], v209 offset:12296
  ds_read_b64_tr_b16 a[214:215], v209 offset:12808
  s_waitcnt vmcnt(18) lgkmcnt(0)
  ds_read_b64_tr_b16 a[216:217], v209 offset:14336
  ds_read_b64_tr_b16 a[218:219], v209 offset:14848
  ds_read_b64_tr_b16 a[220:221], v209 offset:14344
  ds_read_b64_tr_b16 a[222:223], v209 offset:14856
  s_waitcnt vmcnt(16) lgkmcnt(0)
  ds_read_b64_tr_b16 a[224:225], v209 offset:16384
  ds_read_b64_tr_b16 a[226:227], v209 offset:16896
  ds_read_b64_tr_b16 a[228:229], v209 offset:16392
  ds_read_b64_tr_b16 a[230:231], v209 offset:16904
  s_waitcnt vmcnt(14) lgkmcnt(0)
  ds_read_b64_tr_b16 a[232:233], v209 offset:18432
  ds_read_b64_tr_b16 a[234:235], v209 offset:18944
  ds_read_b64_tr_b16 a[236:237], v209 offset:18440
  ds_read_b64_tr_b16 a[238:239], v209 offset:18952
  s_waitcnt vmcnt(12) lgkmcnt(0)
  ds_read_b64_tr_b16 a[240:241], v209 offset:20480
  ds_read_b64_tr_b16 a[242:243], v209 offset:20992
  ds_read_b64_tr_b16 a[244:245], v209 offset:20488
  ds_read_b64_tr_b16 a[246:247], v209 offset:21000
  s_waitcnt vmcnt(10) lgkmcnt(0)
  ds_read_b64_tr_b16 a[248:249], v209 offset:22528
  ds_read_b64_tr_b16 a[250:251], v209 offset:23040
  ds_read_b64_tr_b16 a[252:253], v209 offset:22536
  ds_read_b64_tr_b16 a[254:255], v209 offset:23048
  s_waitcnt vmcnt(8) lgkmcnt(0)
  ds_read_b64_tr_b16 v[216:217], v210 offset:24576
  ds_read_b64_tr_b16 v[218:219], v210 offset:24832
  ds_read_b64_tr_b16 v[220:221], v210 offset:24584
  ds_read_b64_tr_b16 v[222:223], v210 offset:24840
  s_waitcnt vmcnt(6) lgkmcnt(0)
  ds_read_b64_tr_b16 v[224:225], v210 offset:26624
  ds_read_b64_tr_b16 v[226:227], v210 offset:26880
  ds_read_b64_tr_b16 v[228:229], v210 offset:26632
  ds_read_b64_tr_b16 v[230:231], v210 offset:26888
  s_waitcnt vmcnt(4) lgkmcnt(0)
  ds_read_b64_tr_b16 v[232:233], v210 offset:28672
  ds_read_b64_tr_b16 v[234:235], v210 offset:28928
  ds_read_b64_tr_b16 v[236:237], v210 offset:28680
  ds_read_b64_tr_b16 v[238:239], v210 offset:28936
  s_waitcnt vmcnt(2) lgkmcnt(0)
  ds_read_b64_tr_b16 v[240:241], v210 offset:30720
  ds_read_b64_tr_b16 v[242:243], v210 offset:30976
  ds_read_b64_tr_b16 v[244:245], v210 offset:30728
  ds_read_b64_tr_b16 v[246:247], v210 offset:30984
  s_waitcnt vmcnt(0) lgkmcnt(0)
  ds_read_b64_tr_b16 v[248:249], v210 offset:32768
  ds_read_b64_tr_b16 v[250:251], v210 offset:33024
  ds_read_b64_tr_b16 v[252:253], v210 offset:32776
  ds_read_b64_tr_b16 v[254:255], v210 offset:33032
  v_and_b32 v211, 15, v200
  s_lshl_b32 s54, s69, 4
  v_add_u32 v211, s54, v211
  v_lshl_add_u32 v212, v214, 5, v211
  v_lshlrev_b32 v164, 4, v212
  v_lshrrev_b32 v212, 5, v200
  v_lshl_add_u32 v164, v212, 10, v164
  v_mul_u32_u24 v167, 1152, v211
  v_lshl_add_u32 v167, v213, 4, v167
  v_lshlrev_b32 v166, 2, v211
  v_lshlrev_b32 v208, 2, v200
  s_lshl_b32 s54, s52, 11
  v_add_u32 v168, s54, v201
  s_mov_b32 s59, s68
  s_mov_b32 s56, 128
  s_mov_b32 s57, 36
  s_waitcnt lgkmcnt(0)
  s_cmp_eq_u32 s52, 0
  s_cbranch_scc0 O_p1_d
  s_mov_b32 exec_hi, 0
  s_mov_b32 exec_lo, -1
O_p1:
  buffer_load_dword v211, v208, s[12:15], s56 offen sc1
  s_add_u32 s65, s65, 1
  s_waitcnt vmcnt(0)
  v_cmp_gt_u32 vcc, 0x700, v211
  s_cbranch_vccz O_p1_x
  s_sleep 16
  s_cmp_lt_u32 s65, 131072
  s_cbranch_scc1 O_p1
O_p1_x:
  s_mov_b64 exec, -1
O_p1_d:
  s_barrier
  s_cmp_eq_u32 s52, 0
  s_cbranch_scc0 O_a_d
  s_mov_b32 exec_hi, 0
  s_mov_b32 exec_lo, 1
O_a:
  buffer_load_dword v211, v208, s[12:15], s57 offen sc1
  s_add_u32 s65, s65, 1
  s_waitcnt vmcnt(0)
  v_cmp_gt_u32 vcc, 0x80, v211
  s_cbranch_vccz O_a_x
  s_sleep 16
  s_cmp_lt_u32 s65, 131072
  s_cbranch_scc1 O_a
O_a_x:
  s_mov_b64 exec, -1
O_a_d:
  s_barrier
  s_cmp_ge_u32 s70, 9
  s_cselect_b32 s54, 9, 0
  s_sub_u32 s54, s70, s54
  s_and_b32 s54, s54, 7
  s_lshl_b32 s54, s54, 13
  s_lshl_b32 s55, s69, 8
  s_add_u32 s54, s54, s55
  v_lshrrev_b32 v211, 2, v200
  v_lshl_add_u32 v172, v211, 9, s54
  v_and_b32 v211, 3, v200
  v_lshl_add_u32 v172, v211, 6, v172
  s_mul_i32 s55, s59, 36864
  s_mul_i32 s54, s52, 320
  s_add_u32 s55, s55, s54
  s_add_u32 s55, s55, 62914560
  s_cmp_eq_u32 s52, 3
  s_cselect_b32 s56, 268435456, s55
  buffer_load_dwordx4 v[128:131], v167, s[8:11], s55 offen offset:0 sc1
  buffer_load_dwordx4 v[132:135], v167, s[8:11], s55 offen offset:64 sc1
  buffer_load_dwordx4 v[136:139], v167, s[8:11], s55 offen offset:128 sc1
  buffer_load_dwordx4 v[140:143], v167, s[8:11], s56 offen offset:192 sc1
  buffer_load_dwordx4 v[144:147], v167, s[8:11], s56 offen offset:256 sc1
  s_lshl_b32 s55, s59, 7
  s_add_u32 s55, s55, 66060288
  buffer_load_dword v171, v166, s[8:11], s55 offen sc1
  v_mov_b32 v169, 0
  s_mov_b32 s66, 356352
  s_waitcnt vmcnt(0)
O_loop:
  v_mfma_f32_16x16x32_bf16 v[156:159], v[216:219], v[128:131], 0
  v_mfma_f32_16x16x32_bf16 v[160:163], v[220:223], v[128:131], 0
  v_mfma_f32_16x16x32_bf16 v[156:159], v[224:227], v[132:135], v[156:159]
  v_mfma_f32_16x16x32_bf16 v[160:163], v[228:231], v[132:135], v[160:163]
  v_mfma_f32_16x16x32_bf16 v[156:159], v[232:235], v[136:139], v[156:159]
  v_mfma_f32_16x16x32_bf16 v[160:163], v[236:239], v[136:139], v[160:163]
  v_mfma_f32_16x16x32_bf16 v[156:159], v[240:243], v[140:143], v[156:159]
  v_mfma_f32_16x16x32_bf16 v[160:163], v[244:247], v[140:143], v[160:163]
  v_mfma_f32_16x16x32_bf16 v[156:159], v[248:251], v[144:147], v[156:159]
  v_mfma_f32_16x16x32_bf16 v[160:163], v[252:255], v[144:147], v[160:163]
  s_mul_i32 s64, s59, 36864
  s_lshl_b32 s54, s70, 6
  s_add_u32 s64, s64, s54
  s_add_u32 s71, s59, 2
  s_lshl_b32 s55, s59, 18
  s_lshl_b32 s54, s52, 16
  s_add_u32 s55, s55, s54
  s_add_u32 s63, s55, 46137344
  s_and_b32 s54, s59, 1
  s_lshl_b32 s54, s54, 2
  s_add_u32 s54, s54, s52
  s_lshl_b32 s54, s54, 3
  s_lshl_b64 s[72:73], 0xff, s54
  v_sub_f32 v165, 1.0, v171
  v_cvt_pk_bf16_f32 v165, v165, v165
  v_lshlrev_b32 v165, 16, v165
  v_mul_f32 v156, v171, v156
  v_mul_f32 v157, v171, v157
  v_mul_f32 v158, v171, v158
  v_mul_f32 v159, v171, v159
  v_mul_f32 v160, v171, v160
  v_mul_f32 v161, v171, v161
  v_mul_f32 v162, v171, v162
  v_mul_f32 v163, v171, v163
  s_branch O_pc
O_pl:
  s_sleep 1
  buffer_load_dword v169, v208, s[8:11], s66 offen sc1
  s_add_u32 s65, s65, 1
  s_cmp_ge_u32 s65, 131072
  s_cbranch_scc1 O_ld
  s_waitcnt vmcnt(0)
O_pc:
  v_cmp_gt_u32 vcc, s71, v169
  s_nop 0
  s_and_b64 vcc, vcc, s[72:73]
  s_cbranch_scc1 O_pl
O_ld:
  s_mov_b32 s62, s63
  buffer_load_dword v173, v172, s[8:11], s63 offen sc1
  buffer_load_dwordx4 v[0:3], v164, s[8:11], s62 offen offset:0 sc1
  buffer_load_dwordx4 v[4:7], v164, s[8:11], s62 offen offset:2048 sc1
  s_add_u32 s62, s62, 4096
  buffer_load_dwordx4 v[8:11], v164, s[8:11], s62 offen offset:0 sc1
  buffer_load_dwordx4 v[12:15], v164, s[8:11], s62 offen offset:2048 sc1
  s_add_u32 s62, s62, 4096
  buffer_load_dwordx4 v[16:19], v164, s[8:11], s62 offen offset:0 sc1
  buffer_load_dwordx4 v[20:23], v164, s[8:11], s62 offen offset:2048 sc1
  s_add_u32 s62, s62, 4096
  buffer_load_dwordx4 v[24:27], v164, s[8:11], s62 offen offset:0 sc1
  buffer_load_dwordx4 v[28:31], v164, s[8:11], s62 offen offset:2048 sc1
  s_add_u32 s62, s62, 4096
  buffer_load_dwordx4 v[32:35], v164, s[8:11], s62 offen offset:0 sc1
  buffer_load_dwordx4 v[36:39], v164, s[8:11], s62 offen offset:2048 sc1
  s_add_u32 s62, s62, 4096
  buffer_load_dwordx4 v[40:43], v164, s[8:11], s62 offen offset:0 sc1
  buffer_load_dwordx4 v[44:47], v164, s[8:11], s62 offen offset:2048 sc1
  s_add_u32 s62, s62, 4096
  buffer_load_dwordx4 v[48:51], v164, s[8:11], s62 offen offset:0 sc1
  buffer_load_dwordx4 v[52:55], v164, s[8:11], s62 offen offset:2048 sc1
  s_add_u32 s62, s62, 4096
  buffer_load_dwordx4 v[56:59], v164, s[8:11], s62 offen offset:0 sc1
  buffer_load_dwordx4 v[60:63], v164, s[8:11], s62 offen offset:2048 sc1
  s_add_u32 s62, s62, 4096
  buffer_load_dwordx4 v[64:67], v164, s[8:11], s62 offen offset:0 sc1
  buffer_load_dwordx4 v[68:71], v164, s[8:11], s62 offen offset:2048 sc1
  s_add_u32 s62, s62, 4096
  buffer_load_dwordx4 v[72:75], v164, s[8:11], s62 offen offset:0 sc1
  buffer_load_dwordx4 v[76:79], v164, s[8:11], s62 offen offset:2048 sc1
  s_add_u32 s62, s62, 4096
  buffer_load_dwordx4 v[80:83], v164, s[8:11], s62 offen offset:0 sc1
  buffer_load_dwordx4 v[84:87], v164, s[8:11], s62 offen offset:2048 sc1
  s_add_u32 s62, s62, 4096
  buffer_load_dwordx4 v[88:91], v164, s[8:11], s62 offen offset:0 sc1
  buffer_load_dwordx4 v[92:95], v164, s[8:11], s62 offen offset:2048 sc1
  s_add_u32 s62, s62, 4096
  buffer_load_dwordx4 v[96:99], v164, s[8:11], s62 offen offset:0 sc1
  buffer_load_dwordx4 v[100:103], v164, s[8:11], s62 offen offset:2048 sc1
  s_add_u32 s62, s62, 4096
  buffer_load_dwordx4 v[104:107], v164, s[8:11], s62 offen offset:0 sc1
  buffer_load_dwordx4 v[108:111], v164, s[8:11], s62 offen offset:2048 sc1
  s_add_u32 s62, s62, 4096
  buffer_load_dwordx4 v[112:115], v164, s[8:11], s62 offen offset:0 sc1
  buffer_load_dwordx4 v[116:119], v164, s[8:11], s62 offen offset:2048 sc1
  s_add_u32 s62, s62, 4096
  buffer_load_dwordx4 v[120:123], v164, s[8:11], s62 offen offset:0 sc1
  buffer_load_dwordx4 v[124:127], v164, s[8:11], s62 offen offset:2048 sc1
  s_add_u32 s62, s62, 4096
  s_add_u32 s57, s59, 3
  s_min_u32 s74, s57, 63
  s_mul_i32 s55, s74, 36864
  s_mul_i32 s54, s52, 320
  s_add_u32 s55, s55, s54
  s_add_u32 s55, s55, 62914560
  s_cmp_eq_u32 s52, 3
  s_cselect_b32 s56, 268435456, s55
  buffer_load_dwordx4 v[128:131], v167, s[8:11], s55 offen offset:0 sc1
  buffer_load_dwordx4 v[132:135], v167, s[8:11], s55 offen offset:64 sc1
  buffer_load_dwordx4 v[136:139], v167, s[8:11], s55 offen offset:128 sc1
  buffer_load_dwordx4 v[140:143], v167, s[8:11], s56 offen offset:192 sc1
  buffer_load_dwordx4 v[144:147], v167, s[8:11], s56 offen offset:256 sc1
  s_lshl_b32 s55, s74, 7
  s_add_u32 s55, s55, 66060288
  buffer_load_dword v171, v166, s[8:11], s55 offen sc1
  s_add_u32 s65, s65, 1
  s_cmp_lt_u32 s65, 131072
  s_cselect_b32 s54, -2, -1
  s_waitcnt vmcnt(37)
  v_mfma_f32_16x16x32_bf16 v[148:151], a[0:3], v[0:3], 0
  v_mfma_f32_16x16x32_bf16 v[152:155], a[4:7], v[0:3], 0
  v_max3_u32 v170, v0, v1, v0
  v_max3_u32 v170, v2, v3, v170
  s_waitcnt vmcnt(36)
  v_mfma_f32_16x16x32_bf16 v[148:151], a[8:11], v[4:7], v[148:151]
  v_mfma_f32_16x16x32_bf16 v[152:155], a[12:15], v[4:7], v[152:155]
  v_max3_u32 v170, v4, v5, v170
  v_max3_u32 v170, v6, v7, v170
  s_waitcnt vmcnt(35)
  v_mfma_f32_16x16x32_bf16 v[148:151], a[16:19], v[8:11], v[148:151]
  v_mfma_f32_16x16x32_bf16 v[152:155], a[20:23], v[8:11], v[152:155]
  v_max3_u32 v170, v8, v9, v170
  v_max3_u32 v170, v10, v11, v170
  s_waitcnt vmcnt(34)
  v_mfma_f32_16x16x32_bf16 v[148:151], a[24:27], v[12:15], v[148:151]
  v_mfma_f32_16x16x32_bf16 v[152:155], a[28:31], v[12:15], v[152:155]
  v_max3_u32 v170, v12, v13, v170
  v_max3_u32 v170, v14, v15, v170
  s_waitcnt vmcnt(33)
  v_mfma_f32_16x16x32_bf16 v[148:151], a[32:35], v[16:19], v[148:151]
  v_mfma_f32_16x16x32_bf16 v[152:155], a[36:39], v[16:19], v[152:155]
  v_max3_u32 v170, v16, v17, v170
  v_max3_u32 v170, v18, v19, v170
  s_waitcnt vmcnt(32)
  v_mfma_f32_16x16x32_bf16 v[148:151], a[40:43], v[20:23], v[148:151]
  v_mfma_f32_16x16x32_bf16 v[152:155], a[44:47], v[20:23], v[152:155]
  v_max3_u32 v170, v20, v21, v170
  v_max3_u32 v170, v22, v23, v170
  s_waitcnt vmcnt(31)
  v_mfma_f32_16x16x32_bf16 v[148:151], a[48:51], v[24:27], v[148:151]
  v_mfma_f32_16x16x32_bf16 v[152:155], a[52:55], v[24:27], v[152:155]
  v_max3_u32 v170, v24, v25, v170
  v_max3_u32 v170, v26, v27, v170
  s_waitcnt vmcnt(30)
  v_mfma_f32_16x16x32_bf16 v[148:151], a[56:59], v[28:31], v[148:151]
  v_mfma_f32_16x16x32_bf16 v[152:155], a[60:63], v[28:31], v[152:155]
  v_max3_u32 v170, v28, v29, v170
  v_max3_u32 v170, v30, v31, v170
  s_waitcnt vmcnt(29)
  v_mfma_f32_16x16x32_bf16 v[148:151], a[64:67], v[32:35], v[148:151]
  v_mfma_f32_16x16x32_bf16 v[152:155], a[68:71], v[32:35], v[152:155]
  v_max3_u32 v170, v32, v33, v170
  v_max3_u32 v170, v34, v35, v170
  s_waitcnt vmcnt(28)
  v_mfma_f32_16x16x32_bf16 v[148:151], a[72:75], v[36:39], v[148:151]
  v_mfma_f32_16x16x32_bf16 v[152:155], a[76:79], v[36:39], v[152:155]
  v_max3_u32 v170, v36, v37, v170
  v_max3_u32 v170, v38, v39, v170
  s_waitcnt vmcnt(27)
  v_mfma_f32_16x16x32_bf16 v[148:151], a[80:83], v[40:43], v[148:151]
  v_mfma_f32_16x16x32_bf16 v[152:155], a[84:87], v[40:43], v[152:155]
  v_max3_u32 v170, v40, v41, v170
  v_max3_u32 v170, v42, v43, v170
  s_waitcnt vmcnt(26)
  v_mfma_f32_16x16x32_bf16 v[148:151], a[88:91], v[44:47], v[148:151]
  v_mfma_f32_16x16x32_bf16 v[152:155], a[92:95], v[44:47], v[152:155]
  v_max3_u32 v170, v44, v45, v170
  v_max3_u32 v170, v46, v47, v170
  s_waitcnt vmcnt(25)
  v_mfma_f32_16x16x32_bf16 v[148:151], a[96:99], v[48:51], v[148:151]
  v_mfma_f32_16x16x32_bf16 v[152:155], a[100:103], v[48:51], v[152:155]
  v_max3_u32 v170, v48, v49, v170
  v_max3_u32 v170, v50, v51, v170
  s_waitcnt vmcnt(24)
  v_mfma_f32_16x16x32_bf16 v[148:151], a[104:107], v[52:55], v[148:151]
  v_mfma_f32_16x16x32_bf16 v[152:155], a[108:111], v[52:55], v[152:155]
  v_max3_u32 v170, v52, v53, v170
  v_max3_u32 v170, v54, v55, v170
  s_waitcnt vmcnt(23)
  v_mfma_f32_16x16x32_bf16 v[148:151], a[112:115], v[56:59], v[148:151]
  v_mfma_f32_16x16x32_bf16 v[152:155], a[116:119], v[56:59], v[152:155]
  v_max3_u32 v170, v56, v57, v170
  v_max3_u32 v170, v58, v59, v170
  s_waitcnt vmcnt(22)
  v_mfma_f32_16x16x32_bf16 v[148:151], a[120:123], v[60:63], v[148:151]
  v_mfma_f32_16x16x32_bf16 v[152:155], a[124:127], v[60:63], v[152:155]
  v_max3_u32 v170, v60, v61, v170
  v_max3_u32 v170, v62, v63, v170
  s_waitcnt vmcnt(21)
  v_mfma_f32_16x16x32_bf16 v[148:151], a[128:131], v[64:67], v[148:151]
  v_mfma_f32_16x16x32_bf16 v[152:155], a[132:135], v[64:67], v[152:155]
  v_max3_u32 v170, v64, v65, v170
  v_max3_u32 v170, v66, v67, v170
  s_waitcnt vmcnt(20)
  v_mfma_f32_16x16x32_bf16 v[148:151], a[136:139], v[68:71], v[148:151]
  v_mfma_f32_16x16x32_bf16 v[152:155], a[140:143], v[68:71], v[152:155]
  v_max3_u32 v170, v68, v69, v170
  v_max3_u32 v170, v70, v71, v170
  s_waitcnt vmcnt(19)
  v_mfma_f32_16x16x32_bf16 v[148:151], a[144:147], v[72:75], v[148:151]
  v_mfma_f32_16x16x32_bf16 v[152:155], a[148:151], v[72:75], v[152:155]
  v_max3_u32 v170, v72, v73, v170
  v_max3_u32 v170, v74, v75, v170
  s_waitcnt vmcnt(18)
  v_mfma_f32_16x16x32_bf16 v[148:151], a[152:155], v[76:79], v[148:151]
  v_mfma_f32_16x16x32_bf16 v[152:155], a[156:159], v[76:79], v[152:155]
  v_max3_u32 v170, v76, v77, v170
  v_max3_u32 v170, v78, v79, v170
  s_waitcnt vmcnt(17)
  v_mfma_f32_16x16x32_bf16 v[148:151], a[160:163], v[80:83], v[148:151]
  v_mfma_f32_16x16x32_bf16 v[152:155], a[164:167], v[80:83], v[152:155]
  v_max3_u32 v170, v80, v81, v170
  v_max3_u32 v170, v82, v83, v170
  s_waitcnt vmcnt(16)
  v_mfma_f32_16x16x32_bf16 v[148:151], a[168:171], v[84:87], v[148:151]
  v_mfma_f32_16x16x32_bf16 v[152:155], a[172:175], v[84:87], v[152:155]
  v_max3_u32 v170, v84, v85, v170
  v_max3_u32 v170, v86, v87, v170
  s_waitcnt vmcnt(15)
  v_mfma_f32_16x16x32_bf16 v[148:151], a[176:179], v[88:91], v[148:151]
  v_mfma_f32_16x16x32_bf16 v[152:155], a[180:183], v[88:91], v[152:155]
  v_max3_u32 v170, v88, v89, v170
  v_max3_u32 v170, v90, v91, v170
  s_waitcnt vmcnt(14)
  v_mfma_f32_16x16x32_bf16 v[148:151], a[184:187], v[92:95], v[148:151]
  v_mfma_f32_16x16x32_bf16 v[152:155], a[188:191], v[92:95], v[152:155]
  v_max3_u32 v170, v92, v93, v170
  v_max3_u32 v170, v94, v95, v170
  s_waitcnt vmcnt(13)
  v_mfma_f32_16x16x32_bf16 v[148:151], a[192:195], v[96:99], v[148:151]
  v_mfma_f32_16x16x32_bf16 v[152:155], a[196:199], v[96:99], v[152:155]
  v_max3_u32 v170, v96, v97, v170
  v_max3_u32 v170, v98, v99, v170
  s_waitcnt vmcnt(12)
  v_mfma_f32_16x16x32_bf16 v[148:151], a[200:203], v[100:103], v[148:151]
  v_mfma_f32_16x16x32_bf16 v[152:155], a[204:207], v[100:103], v[152:155]
  v_max3_u32 v170, v100, v101, v170
  v_max3_u32 v170, v102, v103, v170
  s_waitcnt vmcnt(11)
  v_mfma_f32_16x16x32_bf16 v[148:151], a[208:211], v[104:107], v[148:151]
  v_mfma_f32_16x16x32_bf16 v[152:155], a[212:215], v[104:107], v[152:155]
  v_max3_u32 v170, v104, v105, v170
  v_max3_u32 v170, v106, v107, v170
  s_waitcnt vmcnt(10)
  v_mfma_f32_16x16x32_bf16 v[148:151], a[216:219], v[108:111], v[148:151]
  v_mfma_f32_16x16x32_bf16 v[152:155], a[220:223], v[108:111], v[152:155]
  v_max3_u32 v170, v108, v109, v170
  v_max3_u32 v170, v110, v111, v170
  s_waitcnt vmcnt(9)
  v_mfma_f32_16x16x32_bf16 v[148:151], a[224:227], v[112:115], v[148:151]
  v_mfma_f32_16x16x32_bf16 v[152:155], a[228:231], v[112:115], v[152:155]
  v_max3_u32 v170, v112, v113, v170
  v_max3_u32 v170, v114, v115, v170
  s_waitcnt vmcnt(8)
  v_mfma_f32_16x16x32_bf16 v[148:151], a[232:235], v[116:119], v[148:151]
  v_mfma_f32_16x16x32_bf16 v[152:155], a[236:239], v[116:119], v[152:155]
  v_max3_u32 v170, v116, v117, v170
  v_max3_u32 v170, v118, v119, v170
  s_waitcnt vmcnt(7)
  v_mfma_f32_16x16x32_bf16 v[148:151], a[240:243], v[120:123], v[148:151]
  v_mfma_f32_16x16x32_bf16 v[152:155], a[244:247], v[120:123], v[152:155]
  v_max3_u32 v170, v120, v121, v170
  v_max3_u32 v170, v122, v123, v170
  s_waitcnt vmcnt(6)
  v_mfma_f32_16x16x32_bf16 v[148:151], a[248:251], v[124:127], v[148:151]
  v_mfma_f32_16x16x32_bf16 v[152:155], a[252:255], v[124:127], v[152:155]
  v_max3_u32 v170, v124, v125, v170
  v_max3_u32 v170, v126, v127, v170
  v_cmp_lt_u32 vcc, s54, v170
  s_cbranch_vccnz O_ld
  v_fmac_f32 v156, v165, v148
  v_fmac_f32 v157, v165, v149
  v_fmac_f32 v158, v165, v150
  v_fmac_f32 v159, v165, v151
  v_fmac_f32 v160, v165, v152
  v_fmac_f32 v161, v165, v153
  v_fmac_f32 v162, v165, v154
  v_fmac_f32 v163, v165, v155
  ds_write_b128 v168, v[156:159]
  ds_write_b128 v168, v[160:163] offset:1024
  v_xor_b32 v168, 0x2000, v168
  s_mov_b32 s59, s57
  s_waitcnt lgkmcnt(0)
  s_barrier
  s_cmp_eq_u32 s52, 0
  s_cbranch_scc0 O_next
  v_xor_b32 v211, 0x2000, v168
  ds_read_b128 v[0:3], v211 offset:2048
  ds_read_b128 v[4:7], v211 offset:3072
  ds_read_b128 v[8:11], v211 offset:4096
  ds_read_b128 v[12:15], v211 offset:5120
  ds_read_b128 v[16:19], v211 offset:6144
  ds_read_b128 v[20:23], v211 offset:7168
  s_waitcnt lgkmcnt(5)
  v_add_f32 v156, v156, v0
  v_add_f32 v157, v157, v1
  v_add_f32 v158, v158, v2
  v_add_f32 v159, v159, v3
  s_waitcnt lgkmcnt(4)
  v_add_f32 v160, v160, v4
  v_add_f32 v161, v161, v5
  v_add_f32 v162, v162, v6
  v_add_f32 v163, v163, v7
  s_waitcnt lgkmcnt(3)
  v_add_f32 v156, v156, v8
  v_add_f32 v157, v157, v9
  v_add_f32 v158, v158, v10
  v_add_f32 v159, v159, v11
  s_waitcnt lgkmcnt(2)
  v_add_f32 v160, v160, v12
  v_add_f32 v161, v161, v13
  v_add_f32 v162, v162, v14
  v_add_f32 v163, v163, v15
  s_waitcnt lgkmcnt(1)
  v_add_f32 v156, v156, v16
  v_add_f32 v157, v157, v17
  v_add_f32 v158, v158, v18
  v_add_f32 v159, v159, v19
  s_waitcnt lgkmcnt(0)
  v_add_f32 v160, v160, v20
  v_add_f32 v161, v161, v21
  v_add_f32 v162, v162, v22
  v_add_f32 v163, v163, v23
  v_cvt_pk_bf16_f32 v148, v156, v157
  v_cvt_pk_bf16_f32 v149, v158, v159
  v_cvt_pk_bf16_f32 v150, v160, v161
  v_cvt_pk_bf16_f32 v151, v162, v163
  buffer_store_dwordx4 v[148:151], v167, s[48:51], s64 offen sc1
  s_waitcnt vmcnt(1)
  s_branch O_nx2
O_next:
  s_waitcnt vmcnt(0)
O_nx2:
  s_cmp_lt_u32 s59, 64
  s_cbranch_scc1 O_loop
  s_branch L_exit
W_h:
  s_lshr_b32 s58, s53, 1
  s_and_b32 s59, s53, 1
  s_mul_i32 s60, s59, 36864
  s_add_u32 m0, s67, 0
  s_nop 0
  buffer_load_dwordx4 v202, s[4:7], s60 offen offset:0 lds
  s_add_u32 m0, s67, 896
  s_nop 0
  buffer_load_dwordx4 v202, s[4:7], s60 offen offset:128 lds
  s_add_u32 m0, s67, 1792
  s_nop 0
  buffer_load_dwordx4 v202, s[4:7], s60 offen offset:256 lds
  s_add_u32 m0, s67, 2688
  s_nop 0
  buffer_load_dwordx4 v202, s[4:7], s60 offen offset:384 lds
  s_add_u32 m0, s67, 3584
  s_nop 0
  buffer_load_dwordx4 v202, s[4:7], s60 offen offset:512 lds
  s_add_u32 m0, s67, 4480
  s_nop 0
  buffer_load_dwordx4 v202, s[4:7], s60 offen offset:640 lds
  s_add_u32 m0, s67, 5376
  s_nop 0
  buffer_load_dwordx4 v202, s[4:7], s60 offen offset:768 lds
  s_add_u32 m0, s67, 6272
  s_nop 0
  buffer_load_dwordx4 v202, s[4:7], s60 offen offset:896 lds
  s_add_u32 m0, s67, 7168
  s_nop 0
  buffer_load_dwordx4 v202, s[4:7], s60 offen offset:1024 lds
  v_lshrrev_b32 v211, 4, v200
  v_lshlrev_b32 v212, 2, v211
  v_and_b32 v213, 15, v200
  v_xor_b32 v212, v212, v213
  v_lshlrev_b32 v212, 4, v212
  v_lshl_add_u32 v207, v211, 13, v212
  s_lshl_b32 s62, s58, 8
  s_lshl_b32 s54, s52, 15
  s_add_u32 s62, s62, s54
  s_lshl_b32 s61, s52, 10
  s_add_u32 s61, s61, 36864
  s_add_u32 m0, s61, 0
  s_add_u32 s54, s62, 0
  buffer_load_dwordx4 v207, s[16:19], s54 offen lds
  s_add_u32 m0, s61, 4096
  s_add_u32 s54, s62, 131072
  buffer_load_dwordx4 v207, s[16:19], s54 offen lds
  s_add_u32 m0, s61, 8192
  s_add_u32 s54, s62, 262144
  buffer_load_dwordx4 v207, s[16:19], s54 offen lds
  s_add_u32 m0, s61, 12288
  s_add_u32 s54, s62, 393216
  buffer_load_dwordx4 v207, s[16:19], s54 offen lds
  s_add_u32 m0, s61, 16384
  s_add_u32 s54, s62, 524288
  buffer_load_dwordx4 v207, s[16:19], s54 offen lds
  s_add_u32 m0, s61, 20480
  s_add_u32 s54, s62, 655360
  buffer_load_dwordx4 v207, s[16:19], s54 offen lds
  s_add_u32 m0, s61, 24576
  s_add_u32 s54, s62, 786432
  buffer_load_dwordx4 v207, s[16:19], s54 offen lds
  s_add_u32 m0, s61, 28672
  s_add_u32 s54, s62, 917504
  buffer_load_dwordx4 v207, s[16:19], s54 offen lds
  s_add_u32 m0, s61, 32768
  s_add_u32 s54, s62, 1048576
  buffer_load_dwordx4 v207, s[16:19], s54 offen lds
  s_add_u32 m0, s61, 36864
  s_add_u32 s54, s62, 1179648
  buffer_load_dwordx4 v207, s[16:19], s54 offen lds
  s_add_u32 m0, s61, 40960
  s_add_u32 s54, s62, 1310720
  buffer_load_dwordx4 v207, s[16:19], s54 offen lds
  s_add_u32 m0, s61, 45056
  s_add_u32 s54, s62, 1441792
  buffer_load_dwordx4 v207, s[16:19], s54 offen lds
  s_add_u32 m0, s61, 49152
  s_add_u32 s54, s62, 1572864
  buffer_load_dwordx4 v207, s[16:19], s54 offen lds
  s_add_u32 m0, s61, 53248
  s_add_u32 s54, s62, 1703936
  buffer_load_dwordx4 v207, s[16:19], s54 offen lds
  s_add_u32 m0, s61, 57344
  s_add_u32 s54, s62, 1835008
  buffer_load_dwordx4 v207, s[16:19], s54 offen lds
  s_add_u32 m0, s61, 61440
  s_add_u32 s54, s62, 1966080
  buffer_load_dwordx4 v207, s[16:19], s54 offen lds
  s_add_u32 m0, s61, 65536
  s_add_u32 s54, s62, 2097152
  buffer_load_dwordx4 v207, s[16:19], s54 offen lds
  s_add_u32 m0, s61, 69632
  s_add_u32 s54, s62, 2228224
  buffer_load_dwordx4 v207, s[16:19], s54 offen lds
  s_add_u32 m0, s61, 73728
  s_add_u32 s54, s62, 2359296
  buffer_load_dwordx4 v207, s[16:19], s54 offen lds
  s_add_u32 m0, s61, 77824
  s_add_u32 s54, s62, 2490368
  buffer_load_dwordx4 v207, s[16:19], s54 offen lds
  s_add_u32 m0, s61, 81920
  s_add_u32 s54, s62, 2621440
  buffer_load_dwordx4 v207, s[16:19], s54 offen lds
  s_add_u32 m0, s61, 86016
  s_add_u32 s54, s62, 2752512
  buffer_load_dwordx4 v207, s[16:19], s54 offen lds
  s_add_u32 m0, s61, 90112
  s_add_u32 s54, s62, 2883584
  buffer_load_dwordx4 v207, s[16:19], s54 offen lds
  s_add_u32 m0, s61, 94208
  s_add_u32 s54, s62, 3014656
  buffer_load_dwordx4 v207, s[16:19], s54 offen lds
  s_waitcnt vmcnt(20) lgkmcnt(0)
  s_barrier
  s_add_u32 m0, s61, 98304
  s_add_u32 s54, s62, 3145728
  buffer_load_dwordx4 v207, s[16:19], s54 offen lds
  s_add_u32 m0, s61, 102400
  s_add_u32 s54, s62, 3276800
  buffer_load_dwordx4 v207, s[16:19], s54 offen lds
  s_add_u32 m0, s61, 106496
  s_add_u32 s54, s62, 3407872
  buffer_load_dwordx4 v207, s[16:19], s54 offen lds
  s_add_u32 m0, s61, 110592
  s_add_u32 s54, s62, 3538944
  buffer_load_dwordx4 v207, s[16:19], s54 offen lds
  v_add_u32 v215, 36864, v209
  ds_read_b64_tr_b16 a[0:1], v215 offset:0
  ds_read_b64_tr_b16 a[2:3], v215 offset:1024
  ds_read_b64_tr_b16 a[4:5], v215 offset:4096
  ds_read_b64_tr_b16 a[6:7], v215 offset:5120
  ds_read_b64_tr_b16 a[8:9], v215 offset:8192
  ds_read_b64_tr_b16 a[10:11], v215 offset:9216
  ds_read_b64_tr_b16 a[12:13], v215 offset:12288
  ds_read_b64_tr_b16 a[14:15], v215 offset:13312
  s_waitcnt vmcnt(20) lgkmcnt(0)
  s_barrier
  s_add_u32 m0, s61, 0
  s_add_u32 s54, s62, 3670016
  buffer_load_dwordx4 v207, s[16:19], s54 offen lds
  s_add_u32 m0, s61, 4096
  s_add_u32 s54, s62, 3801088
  buffer_load_dwordx4 v207, s[16:19], s54 offen lds
  s_add_u32 m0, s61, 8192
  s_add_u32 s54, s62, 3932160
  buffer_load_dwordx4 v207, s[16:19], s54 offen lds
  s_add_u32 m0, s61, 12288
  s_add_u32 s54, s62, 4063232
  buffer_load_dwordx4 v207, s[16:19], s54 offen lds
  v_add_u32 v215, 53248, v209
  ds_read_b64_tr_b16 a[16:17], v215 offset:0
  ds_read_b64_tr_b16 a[18:19], v215 offset:1024
  ds_read_b64_tr_b16 a[20:21], v215 offset:4096
  ds_read_b64_tr_b16 a[22:23], v215 offset:5120
  ds_read_b64_tr_b16 a[24:25], v215 offset:8192
  ds_read_b64_tr_b16 a[26:27], v215 offset:9216
  ds_read_b64_tr_b16 a[28:29], v215 offset:12288
  ds_read_b64_tr_b16 a[30:31], v215 offset:13312
  s_waitcnt vmcnt(20) lgkmcnt(0)
  s_barrier
  s_add_u32 m0, s61, 16384
  s_add_u32 s54, s62, 4194304
  buffer_load_dwordx4 v207, s[16:19], s54 offen lds
  s_add_u32 m0, s61, 20480
  s_add_u32 s54, s62, 4325376
  buffer_load_dwordx4 v207, s[16:19], s54 offen lds
  s_add_u32 m0, s61, 24576
  s_add_u32 s54, s62, 4456448
  buffer_load_dwordx4 v207, s[16:19], s54 offen lds
  s_add_u32 m0, s61, 28672
  s_add_u32 s54, s62, 4587520
  buffer_load_dwordx4 v207, s[16:19], s54 offen lds
  v_add_u32 v215, 69632, v209
  ds_read_b64_tr_b16 a[32:33], v215 offset:0
  ds_read_b64_tr_b16 a[34:35], v215 offset:1024
  ds_read_b64_tr_b16 a[36:37], v215 offset:4096
  ds_read_b64_tr_b16 a[38:39], v215 offset:5120
  ds_read_b64_tr_b16 a[40:41], v215 offset:8192
  ds_read_b64_tr_b16 a[42:43], v215 offset:9216
  ds_read_b64_tr_b16 a[44:45], v215 offset:12288
  ds_read_b64_tr_b16 a[46:47], v215 offset:13312
  s_waitcnt vmcnt(20) lgkmcnt(0)
  s_barrier
  v_add_u32 v215, 86016, v209
  ds_read_b64_tr_b16 a[48:49], v215 offset:0
  ds_read_b64_tr_b16 a[50:51], v215 offset:1024
  ds_read_b64_tr_b16 a[52:53], v215 offset:4096
  ds_read_b64_tr_b16 a[54:55], v215 offset:5120
  ds_read_b64_tr_b16 a[56:57], v215 offset:8192
  ds_read_b64_tr_b16 a[58:59], v215 offset:9216
  ds_read_b64_tr_b16 a[60:61], v215 offset:12288
  ds_read_b64_tr_b16 a[62:63], v215 offset:13312
  s_waitcnt vmcnt(16) lgkmcnt(0)
  s_barrier
  v_add_u32 v215, 102400, v209
  ds_read_b64_tr_b16 a[64:65], v215 offset:0
  ds_read_b64_tr_b16 a[66:67], v215 offset:1024
  ds_read_b64_tr_b16 a[68:69], v215 offset:4096
  ds_read_b64_tr_b16 a[70:71], v215 offset:5120
  ds_read_b64_tr_b16 a[72:73], v215 offset:8192
  ds_read_b64_tr_b16 a[74:75], v215 offset:9216
  ds_read_b64_tr_b16 a[76:77], v215 offset:12288
  ds_read_b64_tr_b16 a[78:79], v215 offset:13312
  s_waitcnt vmcnt(12) lgkmcnt(0)
  s_barrier
  v_add_u32 v215, 118784, v209
  ds_read_b64_tr_b16 a[80:81], v215 offset:0
  ds_read_b64_tr_b16 a[82:83], v215 offset:1024
  ds_read_b64_tr_b16 a[84:85], v215 offset:4096
  ds_read_b64_tr_b16 a[86:87], v215 offset:5120
  ds_read_b64_tr_b16 a[88:89], v215 offset:8192
  ds_read_b64_tr_b16 a[90:91], v215 offset:9216
  ds_read_b64_tr_b16 a[92:93], v215 offset:12288
  ds_read_b64_tr_b16 a[94:95], v215 offset:13312
  s_waitcnt vmcnt(8) lgkmcnt(0)
  s_barrier
  v_add_u32 v215, 135168, v209
  ds_read_b64_tr_b16 a[96:97], v215 offset:0
  ds_read_b64_tr_b16 a[98:99], v215 offset:1024
  ds_read_b64_tr_b16 a[100:101], v215 offset:4096
  ds_read_b64_tr_b16 a[102:103], v215 offset:5120
  ds_read_b64_tr_b16 a[104:105], v215 offset:8192
  ds_read_b64_tr_b16 a[106:107], v215 offset:9216
  ds_read_b64_tr_b16 a[108:109], v215 offset:12288
  ds_read_b64_tr_b16 a[110:111], v215 offset:13312
  s_waitcnt vmcnt(4) lgkmcnt(0)
  s_barrier
  v_add_u32 v215, 36864, v209
  ds_read_b64_tr_b16 a[112:113], v215 offset:0
  ds_read_b64_tr_b16 a[114:115], v215 offset:1024
  ds_read_b64_tr_b16 a[116:117], v215 offset:4096
  ds_read_b64_tr_b16 a[118:119], v215 offset:5120
  ds_read_b64_tr_b16 a[120:121], v215 offset:8192
  ds_read_b64_tr_b16 a[122:123], v215 offset:9216
  ds_read_b64_tr_b16 a[124:125], v215 offset:12288
  ds_read_b64_tr_b16 a[126:127], v215 offset:13312
  s_waitcnt vmcnt(0) lgkmcnt(0)
  s_barrier
  v_add_u32 v215, 53248, v209
  ds_read_b64_tr_b16 a[128:129], v215 offset:0
  ds_read_b64_tr_b16 a[130:131], v215 offset:1024
  ds_read_b64_tr_b16 a[132:133], v215 offset:4096
  ds_read_b64_tr_b16 a[134:135], v215 offset:5120
  ds_read_b64_tr_b16 a[136:137], v215 offset:8192
  ds_read_b64_tr_b16 a[138:139], v215 offset:9216
  ds_read_b64_tr_b16 a[140:141], v215 offset:12288
  ds_read_b64_tr_b16 a[142:143], v215 offset:13312
  s_waitcnt lgkmcnt(0)
  s_barrier
  v_and_b32 v211, 31, v200
  v_lshrrev_b32 v212, 5, v200
  v_lshlrev_b32 v213, 2, v212
  v_sub_u32 v211, v211, v213
  v_mov_b32 v214, 0xf149f2ca
  v_cmp_gt_i32 vcc, 0, v211
  s_nop 1
  v_cndmask_b32 v48, 0, v214, vcc
  v_cmp_gt_i32 vcc, 1, v211
  s_nop 1
  v_cndmask_b32 v49, 0, v214, vcc
  v_cmp_gt_i32 vcc, 2, v211
  s_nop 1
  v_cndmask_b32 v50, 0, v214, vcc
  v_cmp_gt_i32 vcc, 3, v211
  s_nop 1
  v_cndmask_b32 v51, 0, v214, vcc
  v_cmp_gt_i32 vcc, 8, v211
  s_nop 1
  v_cndmask_b32 v52, 0, v214, vcc
  v_cmp_gt_i32 vcc, 9, v211
  s_nop 1
  v_cndmask_b32 v53, 0, v214, vcc
  v_cmp_gt_i32 vcc, 10, v211
  s_nop 1
  v_cndmask_b32 v54, 0, v214, vcc
  v_cmp_gt_i32 vcc, 11, v211
  s_nop 1
  v_cndmask_b32 v55, 0, v214, vcc
  v_cmp_gt_i32 vcc, 16, v211
  s_nop 1
  v_cndmask_b32 v56, 0, v214, vcc
  v_cmp_gt_i32 vcc, 17, v211
  s_nop 1
  v_cndmask_b32 v57, 0, v214, vcc
  v_cmp_gt_i32 vcc, 18, v211
  s_nop 1
  v_cndmask_b32 v58, 0, v214, vcc
  v_cmp_gt_i32 vcc, 19, v211
  s_nop 1
  v_cndmask_b32 v59, 0, v214, vcc
  v_cmp_gt_i32 vcc, 24, v211
  s_nop 1
  v_cndmask_b32 v60, 0, v214, vcc
  v_cmp_gt_i32 vcc, 25, v211
  s_nop 1
  v_cndmask_b32 v61, 0, v214, vcc
  v_cmp_gt_i32 vcc, 26, v211
  s_nop 1
  v_cndmask_b32 v62, 0, v214, vcc
  v_cmp_gt_i32 vcc, 27, v211
  s_nop 1
  v_cndmask_b32 v63, 0, v214, vcc
  v_and_b32 v218, 0xff, v216
  v_add_u32 v218, 81920, v218
  v_and_b32 v211, 15, v200
  v_lshl_add_u32 v211, v212, 5, v211
  v_lshlrev_b32 v219, 3, v211
  v_bfe_u32 v211, v200, 4, 1
  v_lshl_add_u32 v219, v211, 2, v219
  s_lshl_b32 s54, s52, 9
  s_add_u32 s54, s54, 83968
  v_add_u32 v219, s54, v219
  v_lshl_add_u32 v221, v200, 3, s54
  s_lshr_b32 s54, s52, 1
  s_lshl_b32 s54, s54, 10
  s_and_b32 s55, s52, 1
  s_lshl_b32 s55, s55, 3
  s_add_u32 s54, s54, s55
  s_add_u32 s54, s54, 81920
  v_add_u32 v220, s54, v201
  s_lshl_b32 s54, s52, 11
  s_add_u32 s54, s54, 73728
  v_add_u32 v215, s54, v201
  v_add_u32 v208, 73728, v201
  s_mov_b32 s68, 1040356334
  s_cmp_eq_u32 s52, 0
  s_cselect_b32 s71, s71, 268435456
  s_lshl_b32 s56, s58, 2
  s_add_u32 s56, s56, 128
  v_mov_b32 v176, -1
  v_mov_b32 v177, -1
  v_mov_b32 v178, -1
  v_mov_b32 v179, -1
  s_cmp_eq_u32 s52, 0
  s_cbranch_scc0 AT_p1_d
  s_mov_b32 exec_hi, 0
  s_mov_b32 exec_lo, 1
AT_p1:
  buffer_load_dword v211, v201, s[12:15], s56 offen sc1
  s_add_u32 s65, s65, 1
  s_waitcnt vmcnt(0)
  v_cmp_gt_u32 vcc, 0x700, v211
  s_cbranch_vccz AT_p1_x
  s_sleep 8
  s_cmp_lt_u32 s65, 131072
  s_cbranch_scc1 AT_p1
AT_p1_x:
  s_mov_b64 exec, -1
AT_p1_d:
  s_barrier
  s_mov_b32 s74, s59
  s_mul_i32 s66, s59, 655360
  s_lshl_b32 s55, s58, 14
  s_add_u32 s55, s55, s66
  s_add_u32 s55, s55, 1048576
  s_lshl_b32 s73, s58, 2
  s_add_u32 s73, s73, s52
  s_lshl_b32 s72, s59, 7
  s_add_u32 s72, s72, s73
  s_lshl_b32 s72, s72, 11
  s_add_u32 s72, s72, 46137344
  s_lshl_b32 s73, s73, 10
  s_add_u32 s73, s73, s66
  s_add_u32 s73, s73, 1572864
  s_add_u32 s59, s59, 2
  buffer_load_dwordx4 v[128:131], v216, s[8:11], s55 offen offset:0 sc1
  buffer_load_dwordx4 v[132:135], v216, s[8:11], s55 offen offset:256 sc1
  buffer_load_dwordx4 v[136:139], v216, s[8:11], s55 offen offset:512 sc1
  buffer_load_dwordx4 v[140:143], v216, s[8:11], s55 offen offset:768 sc1
  buffer_load_dwordx4 v[144:147], v216, s[8:11], s55 offen offset:1024 sc1
  buffer_load_dwordx4 v[148:151], v216, s[8:11], s55 offen offset:1280 sc1
  buffer_load_dwordx4 v[152:155], v216, s[8:11], s55 offen offset:1536 sc1
  buffer_load_dwordx4 v[156:159], v216, s[8:11], s55 offen offset:1792 sc1
  buffer_load_dwordx4 v[160:163], v217, s[8:11], s55 offen offset:0 sc1
  buffer_load_dwordx4 v[164:167], v217, s[8:11], s55 offen offset:256 sc1
  s_add_u32 s60, s60, 73728
  ds_read_b128 v[32:35], v203 offset:0
  ds_read_b128 v[36:39], v204 offset:0
  ds_read_b128 v[40:43], v205 offset:0
  s_waitcnt lgkmcnt(2)
  v_mfma_f32_32x32x16_bf16 v[240:255], a[0:3], v[32:35], 0
  ds_read_b128 v[44:47], v206 offset:0
  s_add_u32 m0, s67, 36864
  s_nop 0
  buffer_load_dwordx4 v202, s[4:7], s60 offen offset:0 lds
  s_waitcnt lgkmcnt(2)
  v_mfma_f32_32x32x16_bf16 v[240:255], a[4:7], v[36:39], v[240:255]
  ds_read_b128 v[32:35], v203 offset:1024
  s_waitcnt lgkmcnt(2)
  v_mfma_f32_32x32x16_bf16 v[240:255], a[8:11], v[40:43], v[240:255]
  ds_read_b128 v[36:39], v204 offset:1024
  s_add_u32 m0, s67, 37760
  s_nop 0
  buffer_load_dwordx4 v202, s[4:7], s60 offen offset:128 lds
  s_waitcnt lgkmcnt(2)
  v_mfma_f32_32x32x16_bf16 v[240:255], a[12:15], v[44:47], v[240:255]
  ds_read_b128 v[40:43], v205 offset:1024
  s_waitcnt lgkmcnt(2)
  v_mfma_f32_32x32x16_bf16 v[240:255], a[16:19], v[32:35], v[240:255]
  ds_read_b128 v[44:47], v206 offset:1024
  s_add_u32 m0, s67, 38656
  s_nop 0
  buffer_load_dwordx4 v202, s[4:7], s60 offen offset:256 lds
  s_waitcnt lgkmcnt(2)
  v_mfma_f32_32x32x16_bf16 v[240:255], a[20:23], v[36:39], v[240:255]
  ds_read_b128 v[32:35], v203 offset:2048
  s_waitcnt lgkmcnt(2)
  v_mfma_f32_32x32x16_bf16 v[240:255], a[24:27], v[40:43], v[240:255]
  ds_read_b128 v[36:39], v204 offset:2048
  s_add_u32 m0, s67, 39552
  s_nop 0
  buffer_load_dwordx4 v202, s[4:7], s60 offen offset:384 lds
  s_waitcnt lgkmcnt(2)
  v_mfma_f32_32x32x16_bf16 v[240:255], a[28:31], v[44:47], v[240:255]
  ds_read_b128 v[40:43], v205 offset:2048
  s_waitcnt lgkmcnt(2)
  v_mfma_f32_32x32x16_bf16 v[240:255], a[32:35], v[32:35], v[240:255]
  ds_read_b128 v[44:47], v206 offset:2048
  s_add_u32 m0, s67, 40448
  s_nop 0
  buffer_load_dwordx4 v202, s[4:7], s60 offen offset:512 lds
  s_waitcnt lgkmcnt(2)
  v_mfma_f32_32x32x16_bf16 v[240:255], a[36:39], v[36:39], v[240:255]
  ds_read_b128 v[32:35], v203 offset:3072
  s_waitcnt lgkmcnt(2)
  v_mfma_f32_32x32x16_bf16 v[240:255], a[40:43], v[40:43], v[240:255]
  ds_read_b128 v[36:39], v204 offset:3072
  s_add_u32 m0, s67, 41344
  s_nop 0
  buffer_load_dwordx4 v202, s[4:7], s60 offen offset:640 lds
  s_waitcnt lgkmcnt(2)
  v_mfma_f32_32x32x16_bf16 v[240:255], a[44:47], v[44:47], v[240:255]
  ds_read_b128 v[40:43], v205 offset:3072
  s_waitcnt lgkmcnt(2)
  v_mfma_f32_32x32x16_bf16 v[240:255], a[48:51], v[32:35], v[240:255]
  ds_read_b128 v[44:47], v206 offset:3072
  s_add_u32 m0, s67, 42240
  s_nop 0
  buffer_load_dwordx4 v202, s[4:7], s60 offen offset:768 lds
  s_waitcnt lgkmcnt(2)
  v_mfma_f32_32x32x16_bf16 v[240:255], a[52:55], v[36:39], v[240:255]
  ds_read_b128 v[32:35], v203 offset:4096
  s_waitcnt lgkmcnt(2)
  v_mfma_f32_32x32x16_bf16 v[240:255], a[56:59], v[40:43], v[240:255]
  ds_read_b128 v[36:39], v204 offset:4096
  s_add_u32 m0, s67, 43136
  s_nop 0
  buffer_load_dwordx4 v202, s[4:7], s60 offen offset:896 lds
  s_waitcnt lgkmcnt(2)
  v_mfma_f32_32x32x16_bf16 v[240:255], a[60:63], v[44:47], v[240:255]
  ds_read_b128 v[40:43], v205 offset:4096
  s_waitcnt lgkmcnt(2)
  v_mfma_f32_32x32x16_bf16 v[240:255], a[64:67], v[32:35], v[240:255]
  ds_read_b128 v[44:47], v206 offset:4096
  s_add_u32 m0, s67, 44032
  s_nop 0
  buffer_load_dwordx4 v202, s[4:7], s60 offen offset:1024 lds
  s_waitcnt lgkmcnt(2)
  v_mfma_f32_32x32x16_bf16 v[240:255], a[68:71], v[36:39], v[240:255]
  ds_read_b128 v[32:35], v203 offset:5120
  s_waitcnt lgkmcnt(2)
  v_mfma_f32_32x32x16_bf16 v[240:255], a[72:75], v[40:43], v[240:255]
  ds_read_b128 v[36:39], v204 offset:5120
  buffer_store_dwordx4 v[176:179], v201, s[8:11], s72 offen offset:0 sc1
  s_waitcnt lgkmcnt(2)
  v_mfma_f32_32x32x16_bf16 v[240:255], a[76:79], v[44:47], v[240:255]
  ds_read_b128 v[40:43], v205 offset:5120
  s_waitcnt lgkmcnt(2)
  v_mfma_f32_32x32x16_bf16 v[240:255], a[80:83], v[32:35], v[240:255]
  ds_read_b128 v[44:47], v206 offset:5120
  buffer_store_dwordx4 v[176:179], v201, s[8:11], s72 offen offset:1024 sc1
  s_waitcnt lgkmcnt(2)
  v_mfma_f32_32x32x16_bf16 v[240:255], a[84:87], v[36:39], v[240:255]
  ds_read_b128 v[32:35], v203 offset:6144
  s_waitcnt lgkmcnt(2)
  v_mfma_f32_32x32x16_bf16 v[240:255], a[88:91], v[40:43], v[240:255]
  ds_read_b128 v[36:39], v204 offset:6144
  s_waitcnt lgkmcnt(2)
  v_mfma_f32_32x32x16_bf16 v[240:255], a[92:95], v[44:47], v[240:255]
  ds_read_b128 v[40:43], v205 offset:6144
  s_waitcnt lgkmcnt(2)
  v_mfma_f32_32x32x16_bf16 v[240:255], a[96:99], v[32:35], v[240:255]
  ds_read_b128 v[44:47], v206 offset:6144
  s_waitcnt lgkmcnt(2)
  v_mfma_f32_32x32x16_bf16 v[240:255], a[100:103], v[36:39], v[240:255]
  ds_read_b128 v[32:35], v203 offset:7168
  s_waitcnt lgkmcnt(2)
  v_mfma_f32_32x32x16_bf16 v[240:255], a[104:107], v[40:43], v[240:255]
  ds_read_b128 v[36:39], v204 offset:7168
  s_waitcnt lgkmcnt(2)
  v_mfma_f32_32x32x16_bf16 v[240:255], a[108:111], v[44:47], v[240:255]
  ds_read_b128 v[40:43], v205 offset:7168
  s_waitcnt lgkmcnt(2)
  v_mfma_f32_32x32x16_bf16 v[240:255], a[112:115], v[32:35], v[240:255]
  ds_read_b128 v[44:47], v206 offset:7168
  s_waitcnt lgkmcnt(2)
  v_mfma_f32_32x32x16_bf16 v[240:255], a[116:119], v[36:39], v[240:255]
  ds_read_b128 v[32:35], v203 offset:8192
  s_waitcnt lgkmcnt(2)
  v_mfma_f32_32x32x16_bf16 v[240:255], a[120:123], v[40:43], v[240:255]
  ds_read_b128 v[36:39], v204 offset:8192
  s_waitcnt lgkmcnt(2)
  v_mfma_f32_32x32x16_bf16 v[240:255], a[124:127], v[44:47], v[240:255]
  ds_read_b128 v[40:43], v205 offset:8192
  s_waitcnt lgkmcnt(2)
  v_mfma_f32_32x32x16_bf16 v[240:255], a[128:131], v[32:35], v[240:255]
  ds_read_b128 v[44:47], v206 offset:8192
  s_waitcnt lgkmcnt(2)
  v_mfma_f32_32x32x16_bf16 v[240:255], a[132:135], v[36:39], v[240:255]
  s_waitcnt lgkmcnt(1)
  v_mfma_f32_32x32x16_bf16 v[240:255], a[136:139], v[40:43], v[240:255]
  s_waitcnt lgkmcnt(0)
  v_mfma_f32_32x32x16_bf16 v[240:255], a[140:143], v[44:47], v[240:255]
  s_nop 11
  v_cvt_pk_bf16_f32 v16, v240, v244
  v_cvt_pk_bf16_f32 v17, v241, v245
  v_cvt_pk_bf16_f32 v18, v242, v246
  v_cvt_pk_bf16_f32 v19, v243, v247
  ds_write_b128 v215, v[16:19] offset:0
  v_cvt_pk_bf16_f32 v20, v248, v252
  v_cvt_pk_bf16_f32 v21, v249, v253
  v_cvt_pk_bf16_f32 v22, v250, v254
  v_cvt_pk_bf16_f32 v23, v251, v255
  ds_write_b128 v215, v[20:23] offset:1024
  s_waitcnt lgkmcnt(0)
  s_barrier
  ds_read_b128 v[96:99], v208 offset:0
  ds_read_b128 v[100:103], v208 offset:1024
  ds_read_b128 v[104:107], v208 offset:2048
  ds_read_b128 v[108:111], v208 offset:3072
  ds_read_b128 v[112:115], v208 offset:4096
  ds_read_b128 v[116:119], v208 offset:5120
  ds_read_b128 v[120:123], v208 offset:6144
  ds_read_b128 v[124:127], v208 offset:7168
  s_waitcnt vmcnt(20) lgkmcnt(7)
  v_mfma_f32_32x32x16_bf16 v[64:79], v[128:131], v[96:99], v[48:63]
  s_waitcnt vmcnt(19) lgkmcnt(6)
  v_mfma_f32_32x32x16_bf16 v[64:79], v[132:135], v[100:103], v[64:79]
  s_waitcnt vmcnt(18) lgkmcnt(5)
  v_mfma_f32_32x32x16_bf16 v[64:79], v[136:139], v[104:107], v[64:79]
  s_waitcnt vmcnt(17) lgkmcnt(4)
  v_mfma_f32_32x32x16_bf16 v[64:79], v[140:143], v[108:111], v[64:79]
  s_waitcnt vmcnt(16) lgkmcnt(3)
  v_mfma_f32_32x32x16_bf16 v[64:79], v[144:147], v[112:115], v[64:79]
  s_waitcnt vmcnt(15) lgkmcnt(2)
  v_mfma_f32_32x32x16_bf16 v[64:79], v[148:151], v[116:119], v[64:79]
  s_waitcnt vmcnt(14) lgkmcnt(1)
  v_mfma_f32_32x32x16_bf16 v[64:79], v[152:155], v[120:123], v[64:79]
  s_waitcnt vmcnt(13) lgkmcnt(0)
  v_mfma_f32_32x32x16_bf16 v[64:79], v[156:159], v[124:127], v[64:79]
  s_nop 11
  v_max3_f32 v180, v64, v65, v66
  v_max3_f32 v180, v180, v67, v68
  v_max3_f32 v180, v180, v69, v70
  v_max3_f32 v180, v180, v71, v72
  v_max3_f32 v180, v180, v73, v74
  v_max3_f32 v180, v180, v75, v76
  v_max3_f32 v180, v180, v77, v78
  v_max_f32 v180, v180, v79
  v_mov_b32 v181, v180
  s_nop 1
  v_permlane32_swap_b32 v180, v181
  v_max_f32 v180, v180, v181
  v_sub_f32 v64, v64, v180
  v_sub_f32 v65, v65, v180
  v_sub_f32 v66, v66, v180
  v_sub_f32 v67, v67, v180
  v_sub_f32 v68, v68, v180
  v_sub_f32 v69, v69, v180
  v_sub_f32 v70, v70, v180
  v_sub_f32 v71, v71, v180
  v_sub_f32 v72, v72, v180
  v_sub_f32 v73, v73, v180
  v_sub_f32 v74, v74, v180
  v_sub_f32 v75, v75, v180
  v_sub_f32 v76, v76, v180
  v_sub_f32 v77, v77, v180
  v_sub_f32 v78, v78, v180
  v_sub_f32 v79, v79, v180
  v_exp_f32 v64, v64
  v_exp_f32 v65, v65
  v_exp_f32 v66, v66
  v_exp_f32 v67, v67
  v_exp_f32 v68, v68
  v_exp_f32 v69, v69
  v_exp_f32 v70, v70
  v_exp_f32 v71, v71
  v_exp_f32 v72, v72
  v_exp_f32 v73, v73
  v_exp_f32 v74, v74
  v_exp_f32 v75, v75
  v_exp_f32 v76, v76
  v_exp_f32 v77, v77
  v_exp_f32 v78, v78
  v_exp_f32 v79, v79
  v_cvt_pk_bf16_f32 v20, v64, v65
  v_cvt_pk_bf16_f32 v21, v68, v69
  v_cvt_pk_bf16_f32 v22, v72, v73
  v_cvt_pk_bf16_f32 v23, v76, v77
  v_cvt_pk_bf16_f32 v24, v66, v67
  v_cvt_pk_bf16_f32 v25, v70, v71
  v_cvt_pk_bf16_f32 v26, v74, v75
  v_cvt_pk_bf16_f32 v27, v78, v79
  s_waitcnt vmcnt(12)
  v_mfma_f32_32x32x16_bf16 v[0:15], v[160:163], v[20:23], 0
  v_add_f32 v182, v64, v65
  v_add_f32 v182, v182, v66
  v_add_f32 v182, v182, v67
  v_add_f32 v182, v182, v68
  v_add_f32 v182, v182, v69
  v_add_f32 v182, v182, v70
  v_add_f32 v182, v182, v71
  s_waitcnt vmcnt(11)
  v_mfma_f32_32x32x16_bf16 v[0:15], v[164:167], v[24:27], v[0:15]
  v_add_f32 v182, v182, v72
  v_add_f32 v182, v182, v73
  v_add_f32 v182, v182, v74
  v_add_f32 v182, v182, v75
  v_add_f32 v182, v182, v76
  v_add_f32 v182, v182, v77
  v_add_f32 v182, v182, v78
  v_add_f32 v182, v182, v79
  s_waitcnt vmcnt(0)
  s_barrier
AT_loop:
  s_cmp_ge_u32 s59, 64
  s_cbranch_scc1 AT_l0
  s_mov_b32 s77, s59
  s_mul_i32 s66, s59, 655360
  s_lshl_b32 s55, s58, 14
  s_add_u32 s55, s55, s66
  s_add_u32 s55, s55, 1048576
  s_lshl_b32 s76, s58, 2
  s_add_u32 s76, s76, s52
  s_lshl_b32 s75, s59, 7
  s_add_u32 s75, s75, s76
  s_lshl_b32 s75, s75, 11
  s_add_u32 s75, s75, 46137344
  s_lshl_b32 s76, s76, 10
  s_add_u32 s76, s76, s66
  s_add_u32 s76, s76, 1572864
  s_add_u32 s59, s59, 2
  buffer_load_dwordx4 v[128:131], v216, s[8:11], s55 offen offset:0 sc1
  buffer_load_dwordx4 v[132:135], v216, s[8:11], s55 offen offset:256 sc1
  buffer_load_dwordx4 v[136:139], v216, s[8:11], s55 offen offset:512 sc1
  buffer_load_dwordx4 v[140:143], v216, s[8:11], s55 offen offset:768 sc1
  buffer_load_dwordx4 v[144:147], v216, s[8:11], s55 offen offset:1024 sc1
  buffer_load_dwordx4 v[148:151], v216, s[8:11], s55 offen offset:1280 sc1
  buffer_load_dwordx4 v[152:155], v216, s[8:11], s55 offen offset:1536 sc1
  buffer_load_dwordx4 v[156:159], v216, s[8:11], s55 offen offset:1792 sc1
  buffer_load_dwordx4 v[160:163], v217, s[8:11], s55 offen offset:0 sc1
  buffer_load_dwordx4 v[164:167], v217, s[8:11], s55 offen offset:256 sc1
  s_or_b32 s70, s73, 0xc00
  buffer_load_dword v172, off, s[8:11], s70 sc1
  s_add_u32 s60, s60, 73728
  ds_read_b128 v[32:35], v203 offset:36864
  ds_read_b128 v[36:39], v204 offset:36864
  ds_read_b128 v[40:43], v205 offset:36864
  s_waitcnt lgkmcnt(2)
  v_mfma_f32_32x32x16_bf16 v[240:255], a[0:3], v[32:35], 0
  ds_read_b128 v[44:47], v206 offset:36864
  s_add_u32 m0, s67, 0
  s_nop 0
  buffer_load_dwordx4 v202, s[4:7], s60 offen offset:0 lds
  s_waitcnt lgkmcnt(2)
  v_mfma_f32_32x32x16_bf16 v[240:255], a[4:7], v[36:39], v[240:255]
  ds_read_b128 v[32:35], v203 offset:37888
  s_waitcnt lgkmcnt(2)
  v_mfma_f32_32x32x16_bf16 v[240:255], a[8:11], v[40:43], v[240:255]
  ds_read_b128 v[36:39], v204 offset:37888
  s_add_u32 m0, s67, 896
  s_nop 0
  buffer_load_dwordx4 v202, s[4:7], s60 offen offset:128 lds
  s_waitcnt lgkmcnt(2)
  v_mfma_f32_32x32x16_bf16 v[240:255], a[12:15], v[44:47], v[240:255]
  ds_read_b128 v[40:43], v205 offset:37888
  s_waitcnt lgkmcnt(2)
  v_mfma_f32_32x32x16_bf16 v[240:255], a[16:19], v[32:35], v[240:255]
  ds_read_b128 v[44:47], v206 offset:37888
  s_add_u32 m0, s67, 1792
  s_nop 0
  buffer_load_dwordx4 v202, s[4:7], s60 offen offset:256 lds
  s_waitcnt lgkmcnt(2)
  v_mfma_f32_32x32x16_bf16 v[240:255], a[20:23], v[36:39], v[240:255]
  ds_read_b128 v[32:35], v203 offset:38912
  s_waitcnt lgkmcnt(2)
  v_mfma_f32_32x32x16_bf16 v[240:255], a[24:27], v[40:43], v[240:255]
  ds_read_b128 v[36:39], v204 offset:38912
  s_add_u32 m0, s67, 2688
  s_nop 0
  buffer_load_dwordx4 v202, s[4:7], s60 offen offset:384 lds
  s_waitcnt lgkmcnt(2)
  v_mfma_f32_32x32x16_bf16 v[240:255], a[28:31], v[44:47], v[240:255]
  ds_read_b128 v[40:43], v205 offset:38912
  s_waitcnt lgkmcnt(2)
  v_mfma_f32_32x32x16_bf16 v[240:255], a[32:35], v[32:35], v[240:255]
  ds_read_b128 v[44:47], v206 offset:38912
  s_add_u32 m0, s67, 3584
  s_nop 0
  buffer_load_dwordx4 v202, s[4:7], s60 offen offset:512 lds
  s_waitcnt lgkmcnt(2)
  v_mfma_f32_32x32x16_bf16 v[240:255], a[36:39], v[36:39], v[240:255]
  ds_read_b128 v[32:35], v203 offset:39936
  s_waitcnt lgkmcnt(2)
  v_mfma_f32_32x32x16_bf16 v[240:255], a[40:43], v[40:43], v[240:255]
  ds_read_b128 v[36:39], v204 offset:39936
  s_add_u32 m0, s67, 4480
  s_nop 0
  buffer_load_dwordx4 v202, s[4:7], s60 offen offset:640 lds
  s_waitcnt lgkmcnt(2)
  v_mfma_f32_32x32x16_bf16 v[240:255], a[44:47], v[44:47], v[240:255]
  ds_read_b128 v[40:43], v205 offset:39936
  s_waitcnt lgkmcnt(2)
  v_mfma_f32_32x32x16_bf16 v[240:255], a[48:51], v[32:35], v[240:255]
  ds_read_b128 v[44:47], v206 offset:39936
  s_add_u32 m0, s67, 5376
  s_nop 0
  buffer_load_dwordx4 v202, s[4:7], s60 offen offset:768 lds
  s_waitcnt lgkmcnt(2)
  v_mfma_f32_32x32x16_bf16 v[240:255], a[52:55], v[36:39], v[240:255]
  ds_read_b128 v[32:35], v203 offset:40960
  s_waitcnt lgkmcnt(2)
  v_mfma_f32_32x32x16_bf16 v[240:255], a[56:59], v[40:43], v[240:255]
  ds_read_b128 v[36:39], v204 offset:40960
  s_add_u32 m0, s67, 6272
  s_nop 0
  buffer_load_dwordx4 v202, s[4:7], s60 offen offset:896 lds
  s_waitcnt lgkmcnt(2)
  v_mfma_f32_32x32x16_bf16 v[240:255], a[60:63], v[44:47], v[240:255]
  ds_read_b128 v[40:43], v205 offset:40960
  s_waitcnt lgkmcnt(2)
  v_mfma_f32_32x32x16_bf16 v[240:255], a[64:67], v[32:35], v[240:255]
  ds_read_b128 v[44:47], v206 offset:40960
  s_add_u32 m0, s67, 7168
  s_nop 0
  buffer_load_dwordx4 v202, s[4:7], s60 offen offset:1024 lds
  s_waitcnt lgkmcnt(2)
  v_mfma_f32_32x32x16_bf16 v[240:255], a[68:71], v[36:39], v[240:255]
  ds_read_b128 v[32:35], v203 offset:41984
  s_waitcnt lgkmcnt(2)
  v_mfma_f32_32x32x16_bf16 v[240:255], a[72:75], v[40:43], v[240:255]
  ds_read_b128 v[36:39], v204 offset:41984
  buffer_store_dwordx4 v[176:179], v201, s[8:11], s75 offen offset:0 sc1
  s_waitcnt lgkmcnt(2)
  v_mfma_f32_32x32x16_bf16 v[240:255], a[76:79], v[44:47], v[240:255]
  ds_read_b128 v[40:43], v205 offset:41984
  s_waitcnt lgkmcnt(2)
  v_mfma_f32_32x32x16_bf16 v[240:255], a[80:83], v[32:35], v[240:255]
  ds_read_b128 v[44:47], v206 offset:41984
  buffer_store_dwordx4 v[176:179], v201, s[8:11], s75 offen offset:1024 sc1
  s_waitcnt lgkmcnt(2)
  v_mfma_f32_32x32x16_bf16 v[240:255], a[84:87], v[36:39], v[240:255]
  ds_read_b128 v[32:35], v203 offset:43008
  s_waitcnt lgkmcnt(2)
  v_mfma_f32_32x32x16_bf16 v[240:255], a[88:91], v[40:43], v[240:255]
  ds_read_b128 v[36:39], v204 offset:43008
  s_waitcnt lgkmcnt(2)
  v_mfma_f32_32x32x16_bf16 v[240:255], a[92:95], v[44:47], v[240:255]
  ds_read_b128 v[40:43], v205 offset:43008
  s_waitcnt lgkmcnt(2)
  v_mfma_f32_32x32x16_bf16 v[240:255], a[96:99], v[32:35], v[240:255]
  ds_read_b128 v[44:47], v206 offset:43008
  s_waitcnt lgkmcnt(2)
  v_mfma_f32_32x32x16_bf16 v[240:255], a[100:103], v[36:39], v[240:255]
  ds_read_b128 v[32:35], v203 offset:44032
  s_waitcnt lgkmcnt(2)
  v_mfma_f32_32x32x16_bf16 v[240:255], a[104:107], v[40:43], v[240:255]
  ds_read_b128 v[36:39], v204 offset:44032
  s_waitcnt lgkmcnt(2)
  v_mfma_f32_32x32x16_bf16 v[240:255], a[108:111], v[44:47], v[240:255]
  ds_read_b128 v[40:43], v205 offset:44032
  s_waitcnt lgkmcnt(2)
  v_mfma_f32_32x32x16_bf16 v[240:255], a[112:115], v[32:35], v[240:255]
  ds_read_b128 v[44:47], v206 offset:44032
  s_waitcnt lgkmcnt(2)
  v_mfma_f32_32x32x16_bf16 v[240:255], a[116:119], v[36:39], v[240:255]
  ds_read_b128 v[32:35], v203 offset:45056
  s_waitcnt lgkmcnt(2)
  v_mfma_f32_32x32x16_bf16 v[240:255], a[120:123], v[40:43], v[240:255]
  ds_read_b128 v[36:39], v204 offset:45056
  s_waitcnt lgkmcnt(2)
  v_mfma_f32_32x32x16_bf16 v[240:255], a[124:127], v[44:47], v[240:255]
  ds_read_b128 v[40:43], v205 offset:45056
  s_waitcnt lgkmcnt(2)
  v_mfma_f32_32x32x16_bf16 v[240:255], a[128:131], v[32:35], v[240:255]
  ds_read_b128 v[44:47], v206 offset:45056
  s_waitcnt lgkmcnt(2)
  v_mfma_f32_32x32x16_bf16 v[240:255], a[132:135], v[36:39], v[240:255]
  s_waitcnt lgkmcnt(1)
  v_mfma_f32_32x32x16_bf16 v[240:255], a[136:139], v[40:43], v[240:255]
  s_waitcnt lgkmcnt(0)
  v_mfma_f32_32x32x16_bf16 v[240:255], a[140:143], v[44:47], v[240:255]
  s_nop 11
  v_cvt_pk_bf16_f32 v16, v240, v244
  v_cvt_pk_bf16_f32 v17, v241, v245
  v_cvt_pk_bf16_f32 v18, v242, v246
  v_cvt_pk_bf16_f32 v19, v243, v247
  ds_write_b128 v215, v[16:19] offset:0
  v_cvt_pk_bf16_f32 v20, v248, v252
  v_cvt_pk_bf16_f32 v21, v249, v253
  v_cvt_pk_bf16_f32 v22, v250, v254
  v_cvt_pk_bf16_f32 v23, v251, v255
  ds_write_b128 v215, v[20:23] offset:1024
  s_waitcnt lgkmcnt(0)
  s_barrier
  ds_read_b128 a[144:147], v208 offset:0
  ds_read_b128 a[148:151], v208 offset:1024
  ds_read_b128 a[152:155], v208 offset:2048
  ds_read_b128 a[156:159], v208 offset:3072
  ds_read_b128 a[160:163], v208 offset:4096
  ds_read_b128 a[164:167], v208 offset:5120
  ds_read_b128 a[168:171], v208 offset:6144
  ds_read_b128 a[172:175], v208 offset:7168
  s_waitcnt vmcnt(11)
  v_cmp_eq_u32 vcc, -1, v172
  s_mov_b32 s69, 0
  s_cbranch_vccnz AT_e1
  s_mov_b32 s69, 1
  buffer_load_dwordx4 v[172:175], v201, s[8:11], s73 offen sc1
AT_e1:
  s_waitcnt lgkmcnt(7)
  v_mfma_f32_32x32x16_bf16 v[64:79], v[128:131], a[144:147], v[48:63]
  s_waitcnt lgkmcnt(6)
  v_mfma_f32_32x32x16_bf16 v[64:79], v[132:135], a[148:151], v[64:79]
  s_waitcnt lgkmcnt(5)
  v_mfma_f32_32x32x16_bf16 v[64:79], v[136:139], a[152:155], v[64:79]
  s_waitcnt lgkmcnt(4)
  v_mfma_f32_32x32x16_bf16 v[64:79], v[140:143], a[156:159], v[64:79]
  s_waitcnt lgkmcnt(3)
  v_mfma_f32_32x32x16_bf16 v[64:79], v[144:147], a[160:163], v[64:79]
  s_waitcnt lgkmcnt(2)
  v_mfma_f32_32x32x16_bf16 v[64:79], v[148:151], a[164:167], v[64:79]
  s_waitcnt lgkmcnt(1)
  v_mfma_f32_32x32x16_bf16 v[64:79], v[152:155], a[168:171], v[64:79]
  s_waitcnt lgkmcnt(0)
  v_mfma_f32_32x32x16_bf16 v[64:79], v[156:159], a[172:175], v[64:79]
  s_nop 11
  v_max3_f32 v184, v64, v65, v66
  v_max3_f32 v184, v184, v67, v68
  v_max3_f32 v184, v184, v69, v70
  v_max3_f32 v184, v184, v71, v72
  v_max3_f32 v184, v184, v73, v74
  v_max3_f32 v184, v184, v75, v76
  v_max3_f32 v184, v184, v77, v78
  v_max_f32 v184, v184, v79
  v_mov_b32 v185, v184
  s_nop 1
  v_permlane32_swap_b32 v184, v185
  v_max_f32 v184, v184, v185
  v_sub_f32 v64, v64, v184
  v_sub_f32 v65, v65, v184
  v_sub_f32 v66, v66, v184
  v_sub_f32 v67, v67, v184
  v_sub_f32 v68, v68, v184
  v_sub_f32 v69, v69, v184
  v_sub_f32 v70, v70, v184
  v_sub_f32 v71, v71, v184
  v_sub_f32 v72, v72, v184
  v_sub_f32 v73, v73, v184
  v_sub_f32 v74, v74, v184
  v_sub_f32 v75, v75, v184
  v_sub_f32 v76, v76, v184
  v_sub_f32 v77, v77, v184
  v_sub_f32 v78, v78, v184
  v_sub_f32 v79, v79, v184
  v_exp_f32 v64, v64
  v_exp_f32 v65, v65
  v_exp_f32 v66, v66
  v_exp_f32 v67, v67
  v_exp_f32 v68, v68
  v_exp_f32 v69, v69
  v_exp_f32 v70, v70
  v_exp_f32 v71, v71
  v_exp_f32 v72, v72
  v_exp_f32 v73, v73
  v_exp_f32 v74, v74
  v_exp_f32 v75, v75
  v_exp_f32 v76, v76
  v_exp_f32 v77, v77
  v_exp_f32 v78, v78
  v_exp_f32 v79, v79
  v_cvt_pk_bf16_f32 v20, v64, v65
  v_cvt_pk_bf16_f32 v21, v68, v69
  v_cvt_pk_bf16_f32 v22, v72, v73
  v_cvt_pk_bf16_f32 v23, v76, v77
  v_cvt_pk_bf16_f32 v24, v66, v67
  v_cvt_pk_bf16_f32 v25, v70, v71
  v_cvt_pk_bf16_f32 v26, v74, v75
  v_cvt_pk_bf16_f32 v27, v78, v79
  v_mfma_f32_32x32x16_bf16 v[224:239], v[160:163], v[20:23], 0
  v_add_f32 v186, v64, v65
  v_add_f32 v186, v186, v66
  v_add_f32 v186, v186, v67
  v_add_f32 v186, v186, v68
  v_add_f32 v186, v186, v69
  v_add_f32 v186, v186, v70
  v_add_f32 v186, v186, v71
  v_mfma_f32_32x32x16_bf16 v[224:239], v[164:167], v[24:27], v[224:239]
  v_add_f32 v186, v186, v72
  v_add_f32 v186, v186, v73
  v_add_f32 v186, v186, v74
  v_add_f32 v186, v186, v75
  v_add_f32 v186, v186, v76
  v_add_f32 v186, v186, v77
  v_add_f32 v186, v186, v78
  v_add_f32 v186, v186, v79
AT_l0:
  s_cmp_eq_u32 s69, 1
  s_cbranch_scc1 AT_v0
  s_cmp_ge_u32 s74, 62
  s_cbranch_scc1 AT_k0
  s_branch AT_c0
AT_h0:
  s_sleep 2
AT_c0:
  buffer_load_dword v172, off, s[8:11], s70 sc1
  s_add_u32 s65, s65, 1
  s_cmp_lt_u32 s65, 131072
  s_cselect_b32 s54, -2, -1
  s_waitcnt vmcnt(0)
  v_cmp_lt_u32 vcc, s54, v172
  s_cbranch_vccnz AT_h0
AT_k0:
  buffer_load_dwordx4 v[172:175], v201, s[8:11], s73 offen sc1
AT_v0:
  s_mov_b32 s69, 0
  s_add_u32 s65, s65, 1
  s_cmp_lt_u32 s65, 131072
  s_cselect_b32 s54, -2, -1
  s_waitcnt vmcnt(0)
  ds_write_b64 v220, v[172:173] offset:0
  ds_write_b64 v221, v[174:175] offset:0
  v_max3_u32 v213, v172, v173, v174
  v_max_u32 v213, v213, v175
  v_cmp_lt_u32 vcc, s54, v213
  s_cbranch_vccnz AT_k0
  s_waitcnt lgkmcnt(0)
  s_barrier
  ds_read_b128 v[128:131], v218 offset:0
  ds_read_b128 v[132:135], v218 offset:256
  ds_read_b128 v[136:139], v218 offset:512
  ds_read_b128 v[140:143], v218 offset:768
  ds_read_b128 v[144:147], v218 offset:1024
  ds_read_b128 v[148:151], v218 offset:1280
  ds_read_b128 v[152:155], v218 offset:1536
  ds_read_b128 v[156:159], v218 offset:1792
  ds_read_b32 v168, v219 offset:0
  ds_read_b32 v169, v219 offset:128
  s_waitcnt lgkmcnt(9)
  v_mfma_f32_32x32x16_bf16 v[80:95], v[128:131], v[96:99], 0
  s_waitcnt lgkmcnt(8)
  v_mfma_f32_32x32x16_bf16 v[80:95], v[132:135], v[100:103], v[80:95]
  s_waitcnt lgkmcnt(7)
  v_mfma_f32_32x32x16_bf16 v[80:95], v[136:139], v[104:107], v[80:95]
  s_waitcnt lgkmcnt(6)
  v_mfma_f32_32x32x16_bf16 v[80:95], v[140:143], v[108:111], v[80:95]
  s_waitcnt lgkmcnt(5)
  v_mfma_f32_32x32x16_bf16 v[80:95], v[144:147], v[112:115], v[80:95]
  s_waitcnt lgkmcnt(4)
  v_mfma_f32_32x32x16_bf16 v[80:95], v[148:151], v[116:119], v[80:95]
  s_waitcnt lgkmcnt(3)
  v_mfma_f32_32x32x16_bf16 v[80:95], v[152:155], v[120:123], v[80:95]
  s_waitcnt lgkmcnt(2)
  v_mfma_f32_32x32x16_bf16 v[80:95], v[156:159], v[124:127], v[80:95]
  s_add_u32 s74, s74, 2
  v_mov_b32 v212, s74
  s_nop 9
  v_mul_f32 v80, s68, v80
  v_mul_f32 v81, s68, v81
  v_mul_f32 v82, s68, v82
  v_mul_f32 v83, s68, v83
  v_max3_f32 v84, v180, v80, v81
  v_max3_f32 v84, v84, v82, v83
  v_mov_b32 v85, v84
  s_nop 1
  v_permlane32_swap_b32 v84, v85
  v_max_f32 v84, v84, v85
  v_sub_f32 v86, v180, v84
  v_sub_f32 v80, v80, v84
  v_sub_f32 v81, v81, v84
  v_sub_f32 v82, v82, v84
  v_sub_f32 v83, v83, v84
  v_exp_f32 v86, v86
  v_exp_f32 v80, v80
  v_exp_f32 v81, v81
  v_exp_f32 v82, v82
  v_exp_f32 v83, v83
  v_fma_f32 v182, v182, v86, v80
  v_add_f32 v84, v81, v82
  v_add_f32 v182, v182, v83
  v_add_f32 v182, v182, v84
  v_mov_b32 v183, v182
  s_nop 1
  v_permlane32_swap_b32 v182, v183
  v_add_f32 v182, v182, v183
  v_rcp_f32 v182, v182
  s_nop 0
  v_mul_f32 v86, v86, v182
  v_mul_f32 v80, v182, v80
  v_mul_f32 v81, v182, v81
  v_mul_f32 v82, v182, v82
  v_mul_f32 v83, v182, v83
  v_cvt_pk_bf16_f32 v28, v80, v81
  v_cvt_pk_bf16_f32 v29, v82, v83
  v_mul_f32 v0, v86, v0
  v_mul_f32 v1, v86, v1
  v_mul_f32 v2, v86, v2
  v_mul_f32 v3, v86, v3
  v_mul_f32 v4, v86, v4
  v_mul_f32 v5, v86, v5
  v_mul_f32 v6, v86, v6
  v_mul_f32 v7, v86, v7
  v_mul_f32 v8, v86, v8
  v_mul_f32 v9, v86, v9
  v_mul_f32 v10, v86, v10
  v_mul_f32 v11, v86, v11
  v_mul_f32 v12, v86, v12
  v_mul_f32 v13, v86, v13
  v_mul_f32 v14, v86, v14
  v_mul_f32 v15, v86, v15
  s_waitcnt lgkmcnt(0)
  s_nop 0
  v_mfma_f32_32x32x8_bf16 v[0:15], v[168:169], v[28:29], v[0:15]
  s_nop 11
  v_cvt_pk_bf16_f32 v20, v0, v1
  v_cvt_pk_bf16_f32 v21, v2, v3
  v_cvt_pk_bf16_f32 v22, v4, v5
  v_cvt_pk_bf16_f32 v23, v6, v7
  buffer_store_dwordx4 v[20:23], v201, s[8:11], s72 offen offset:0 sc1
  v_cvt_pk_bf16_f32 v24, v8, v9
  v_cvt_pk_bf16_f32 v25, v10, v11
  v_cvt_pk_bf16_f32 v26, v12, v13
  v_cvt_pk_bf16_f32 v27, v14, v15
  buffer_store_dwordx4 v[24:27], v201, s[8:11], s72 offen offset:1024 sc1
  s_mov_b64 exec, 1
  buffer_store_dword v212, v201, s[8:11], s71 offen sc1
  s_mov_b64 exec, -1
  s_cmp_ge_u32 s74, 64
  s_cbranch_scc1 L_exit
  s_cmp_ge_u32 s59, 64
  s_cbranch_scc1 AT_l1
  s_mov_b32 s74, s59
  s_mul_i32 s66, s59, 655360
  s_lshl_b32 s55, s58, 14
  s_add_u32 s55, s55, s66
  s_add_u32 s55, s55, 1048576
  s_lshl_b32 s73, s58, 2
  s_add_u32 s73, s73, s52
  s_lshl_b32 s72, s59, 7
  s_add_u32 s72, s72, s73
  s_lshl_b32 s72, s72, 11
  s_add_u32 s72, s72, 46137344
  s_lshl_b32 s73, s73, 10
  s_add_u32 s73, s73, s66
  s_add_u32 s73, s73, 1572864
  s_add_u32 s59, s59, 2
  buffer_load_dwordx4 v[128:131], v216, s[8:11], s55 offen offset:0 sc1
  buffer_load_dwordx4 v[132:135], v216, s[8:11], s55 offen offset:256 sc1
  buffer_load_dwordx4 v[136:139], v216, s[8:11], s55 offen offset:512 sc1
  buffer_load_dwordx4 v[140:143], v216, s[8:11], s55 offen offset:768 sc1
  buffer_load_dwordx4 v[144:147], v216, s[8:11], s55 offen offset:1024 sc1
  buffer_load_dwordx4 v[148:151], v216, s[8:11], s55 offen offset:1280 sc1
  buffer_load_dwordx4 v[152:155], v216, s[8:11], s55 offen offset:1536 sc1
  buffer_load_dwordx4 v[156:159], v216, s[8:11], s55 offen offset:1792 sc1
  buffer_load_dwordx4 v[160:163], v217, s[8:11], s55 offen offset:0 sc1
  buffer_load_dwordx4 v[164:167], v217, s[8:11], s55 offen offset:256 sc1
  s_or_b32 s70, s76, 0xc00
  buffer_load_dword v172, off, s[8:11], s70 sc1
  s_add_u32 s60, s60, 73728
  ds_read_b128 v[32:35], v203 offset:0
  ds_read_b128 v[36:39], v204 offset:0
  ds_read_b128 v[40:43], v205 offset:0
  s_waitcnt lgkmcnt(2)
  v_mfma_f32_32x32x16_bf16 v[240:255], a[0:3], v[32:35], 0
  ds_read_b128 v[44:47], v206 offset:0
  s_add_u32 m0, s67, 36864
  s_nop 0
  buffer_load_dwordx4 v202, s[4:7], s60 offen offset:0 lds
  s_waitcnt lgkmcnt(2)
  v_mfma_f32_32x32x16_bf16 v[240:255], a[4:7], v[36:39], v[240:255]
  ds_read_b128 v[32:35], v203 offset:1024
  s_waitcnt lgkmcnt(2)
  v_mfma_f32_32x32x16_bf16 v[240:255], a[8:11], v[40:43], v[240:255]
  ds_read_b128 v[36:39], v204 offset:1024
  s_add_u32 m0, s67, 37760
  s_nop 0
  buffer_load_dwordx4 v202, s[4:7], s60 offen offset:128 lds
  s_waitcnt lgkmcnt(2)
  v_mfma_f32_32x32x16_bf16 v[240:255], a[12:15], v[44:47], v[240:255]
  ds_read_b128 v[40:43], v205 offset:1024
  s_waitcnt lgkmcnt(2)
  v_mfma_f32_32x32x16_bf16 v[240:255], a[16:19], v[32:35], v[240:255]
  ds_read_b128 v[44:47], v206 offset:1024
  s_add_u32 m0, s67, 38656
  s_nop 0
  buffer_load_dwordx4 v202, s[4:7], s60 offen offset:256 lds
  s_waitcnt lgkmcnt(2)
  v_mfma_f32_32x32x16_bf16 v[240:255], a[20:23], v[36:39], v[240:255]
  ds_read_b128 v[32:35], v203 offset:2048
  s_waitcnt lgkmcnt(2)
  v_mfma_f32_32x32x16_bf16 v[240:255], a[24:27], v[40:43], v[240:255]
  ds_read_b128 v[36:39], v204 offset:2048
  s_add_u32 m0, s67, 39552
  s_nop 0
  buffer_load_dwordx4 v202, s[4:7], s60 offen offset:384 lds
  s_waitcnt lgkmcnt(2)
  v_mfma_f32_32x32x16_bf16 v[240:255], a[28:31], v[44:47], v[240:255]
  ds_read_b128 v[40:43], v205 offset:2048
  s_waitcnt lgkmcnt(2)
  v_mfma_f32_32x32x16_bf16 v[240:255], a[32:35], v[32:35], v[240:255]
  ds_read_b128 v[44:47], v206 offset:2048
  s_add_u32 m0, s67, 40448
  s_nop 0
  buffer_load_dwordx4 v202, s[4:7], s60 offen offset:512 lds
  s_waitcnt lgkmcnt(2)
  v_mfma_f32_32x32x16_bf16 v[240:255], a[36:39], v[36:39], v[240:255]
  ds_read_b128 v[32:35], v203 offset:3072
  s_waitcnt lgkmcnt(2)
  v_mfma_f32_32x32x16_bf16 v[240:255], a[40:43], v[40:43], v[240:255]
  ds_read_b128 v[36:39], v204 offset:3072
  s_add_u32 m0, s67, 41344
  s_nop 0
  buffer_load_dwordx4 v202, s[4:7], s60 offen offset:640 lds
  s_waitcnt lgkmcnt(2)
  v_mfma_f32_32x32x16_bf16 v[240:255], a[44:47], v[44:47], v[240:255]
  ds_read_b128 v[40:43], v205 offset:3072
  s_waitcnt lgkmcnt(2)
  v_mfma_f32_32x32x16_bf16 v[240:255], a[48:51], v[32:35], v[240:255]
  ds_read_b128 v[44:47], v206 offset:3072
  s_add_u32 m0, s67, 42240
  s_nop 0
  buffer_load_dwordx4 v202, s[4:7], s60 offen offset:768 lds
  s_waitcnt lgkmcnt(2)
  v_mfma_f32_32x32x16_bf16 v[240:255], a[52:55], v[36:39], v[240:255]
  ds_read_b128 v[32:35], v203 offset:4096
  s_waitcnt lgkmcnt(2)
  v_mfma_f32_32x32x16_bf16 v[240:255], a[56:59], v[40:43], v[240:255]
  ds_read_b128 v[36:39], v204 offset:4096
  s_add_u32 m0, s67, 43136
  s_nop 0
  buffer_load_dwordx4 v202, s[4:7], s60 offen offset:896 lds
  s_waitcnt lgkmcnt(2)
  v_mfma_f32_32x32x16_bf16 v[240:255], a[60:63], v[44:47], v[240:255]
  ds_read_b128 v[40:43], v205 offset:4096
  s_waitcnt lgkmcnt(2)
  v_mfma_f32_32x32x16_bf16 v[240:255], a[64:67], v[32:35], v[240:255]
  ds_read_b128 v[44:47], v206 offset:4096
  s_add_u32 m0, s67, 44032
  s_nop 0
  buffer_load_dwordx4 v202, s[4:7], s60 offen offset:1024 lds
  s_waitcnt lgkmcnt(2)
  v_mfma_f32_32x32x16_bf16 v[240:255], a[68:71], v[36:39], v[240:255]
  ds_read_b128 v[32:35], v203 offset:5120
  s_waitcnt lgkmcnt(2)
  v_mfma_f32_32x32x16_bf16 v[240:255], a[72:75], v[40:43], v[240:255]
  ds_read_b128 v[36:39], v204 offset:5120
  buffer_store_dwordx4 v[176:179], v201, s[8:11], s72 offen offset:0 sc1
  s_waitcnt lgkmcnt(2)
  v_mfma_f32_32x32x16_bf16 v[240:255], a[76:79], v[44:47], v[240:255]
  ds_read_b128 v[40:43], v205 offset:5120
  s_waitcnt lgkmcnt(2)
  v_mfma_f32_32x32x16_bf16 v[240:255], a[80:83], v[32:35], v[240:255]
  ds_read_b128 v[44:47], v206 offset:5120
  buffer_store_dwordx4 v[176:179], v201, s[8:11], s72 offen offset:1024 sc1
  s_waitcnt lgkmcnt(2)
  v_mfma_f32_32x32x16_bf16 v[240:255], a[84:87], v[36:39], v[240:255]
  ds_read_b128 v[32:35], v203 offset:6144
  s_waitcnt lgkmcnt(2)
  v_mfma_f32_32x32x16_bf16 v[240:255], a[88:91], v[40:43], v[240:255]
  ds_read_b128 v[36:39], v204 offset:6144
  s_waitcnt lgkmcnt(2)
  v_mfma_f32_32x32x16_bf16 v[240:255], a[92:95], v[44:47], v[240:255]
  ds_read_b128 v[40:43], v205 offset:6144
  s_waitcnt lgkmcnt(2)
  v_mfma_f32_32x32x16_bf16 v[240:255], a[96:99], v[32:35], v[240:255]
  ds_read_b128 v[44:47], v206 offset:6144
  s_waitcnt lgkmcnt(2)
  v_mfma_f32_32x32x16_bf16 v[240:255], a[100:103], v[36:39], v[240:255]
  ds_read_b128 v[32:35], v203 offset:7168
  s_waitcnt lgkmcnt(2)
  v_mfma_f32_32x32x16_bf16 v[240:255], a[104:107], v[40:43], v[240:255]
  ds_read_b128 v[36:39], v204 offset:7168
  s_waitcnt lgkmcnt(2)
  v_mfma_f32_32x32x16_bf16 v[240:255], a[108:111], v[44:47], v[240:255]
  ds_read_b128 v[40:43], v205 offset:7168
  s_waitcnt lgkmcnt(2)
  v_mfma_f32_32x32x16_bf16 v[240:255], a[112:115], v[32:35], v[240:255]
  ds_read_b128 v[44:47], v206 offset:7168
  s_waitcnt lgkmcnt(2)
  v_mfma_f32_32x32x16_bf16 v[240:255], a[116:119], v[36:39], v[240:255]
  ds_read_b128 v[32:35], v203 offset:8192
  s_waitcnt lgkmcnt(2)
  v_mfma_f32_32x32x16_bf16 v[240:255], a[120:123], v[40:43], v[240:255]
  ds_read_b128 v[36:39], v204 offset:8192
  s_waitcnt lgkmcnt(2)
  v_mfma_f32_32x32x16_bf16 v[240:255], a[124:127], v[44:47], v[240:255]
  ds_read_b128 v[40:43], v205 offset:8192
  s_waitcnt lgkmcnt(2)
  v_mfma_f32_32x32x16_bf16 v[240:255], a[128:131], v[32:35], v[240:255]
  ds_read_b128 v[44:47], v206 offset:8192
  s_waitcnt lgkmcnt(2)
  v_mfma_f32_32x32x16_bf16 v[240:255], a[132:135], v[36:39], v[240:255]
  s_waitcnt lgkmcnt(1)
  v_mfma_f32_32x32x16_bf16 v[240:255], a[136:139], v[40:43], v[240:255]
  s_waitcnt lgkmcnt(0)
  v_mfma_f32_32x32x16_bf16 v[240:255], a[140:143], v[44:47], v[240:255]
  s_nop 11
  v_cvt_pk_bf16_f32 v16, v240, v244
  v_cvt_pk_bf16_f32 v17, v241, v245
  v_cvt_pk_bf16_f32 v18, v242, v246
  v_cvt_pk_bf16_f32 v19, v243, v247
  ds_write_b128 v215, v[16:19] offset:0
  v_cvt_pk_bf16_f32 v20, v248, v252
  v_cvt_pk_bf16_f32 v21, v249, v253
  v_cvt_pk_bf16_f32 v22, v250, v254
  v_cvt_pk_bf16_f32 v23, v251, v255
  ds_write_b128 v215, v[20:23] offset:1024
  s_waitcnt lgkmcnt(0)
  s_barrier
  ds_read_b128 v[96:99], v208 offset:0
  ds_read_b128 v[100:103], v208 offset:1024
  ds_read_b128 v[104:107], v208 offset:2048
  ds_read_b128 v[108:111], v208 offset:3072
  ds_read_b128 v[112:115], v208 offset:4096
  ds_read_b128 v[116:119], v208 offset:5120
  ds_read_b128 v[120:123], v208 offset:6144
  ds_read_b128 v[124:127], v208 offset:7168
  s_waitcnt vmcnt(11)
  v_cmp_eq_u32 vcc, -1, v172
  s_mov_b32 s69, 0
  s_cbranch_vccnz AT_e0
  s_mov_b32 s69, 1
  buffer_load_dwordx4 v[172:175], v201, s[8:11], s76 offen sc1
AT_e0:
  s_waitcnt lgkmcnt(7)
  v_mfma_f32_32x32x16_bf16 v[64:79], v[128:131], v[96:99], v[48:63]
  s_waitcnt lgkmcnt(6)
  v_mfma_f32_32x32x16_bf16 v[64:79], v[132:135], v[100:103], v[64:79]
  s_waitcnt lgkmcnt(5)
  v_mfma_f32_32x32x16_bf16 v[64:79], v[136:139], v[104:107], v[64:79]
  s_waitcnt lgkmcnt(4)
  v_mfma_f32_32x32x16_bf16 v[64:79], v[140:143], v[108:111], v[64:79]
  s_waitcnt lgkmcnt(3)
  v_mfma_f32_32x32x16_bf16 v[64:79], v[144:147], v[112:115], v[64:79]
  s_waitcnt lgkmcnt(2)
  v_mfma_f32_32x32x16_bf16 v[64:79], v[148:151], v[116:119], v[64:79]
  s_waitcnt lgkmcnt(1)
  v_mfma_f32_32x32x16_bf16 v[64:79], v[152:155], v[120:123], v[64:79]
  s_waitcnt lgkmcnt(0)
  v_mfma_f32_32x32x16_bf16 v[64:79], v[156:159], v[124:127], v[64:79]
  s_nop 11
  v_max3_f32 v180, v64, v65, v66
  v_max3_f32 v180, v180, v67, v68
  v_max3_f32 v180, v180, v69, v70
  v_max3_f32 v180, v180, v71, v72
  v_max3_f32 v180, v180, v73, v74
  v_max3_f32 v180, v180, v75, v76
  v_max3_f32 v180, v180, v77, v78
  v_max_f32 v180, v180, v79
  v_mov_b32 v181, v180
  s_nop 1
  v_permlane32_swap_b32 v180, v181
  v_max_f32 v180, v180, v181
  v_sub_f32 v64, v64, v180
  v_sub_f32 v65, v65, v180
  v_sub_f32 v66, v66, v180
  v_sub_f32 v67, v67, v180
  v_sub_f32 v68, v68, v180
  v_sub_f32 v69, v69, v180
  v_sub_f32 v70, v70, v180
  v_sub_f32 v71, v71, v180
  v_sub_f32 v72, v72, v180
  v_sub_f32 v73, v73, v180
  v_sub_f32 v74, v74, v180
  v_sub_f32 v75, v75, v180
  v_sub_f32 v76, v76, v180
  v_sub_f32 v77, v77, v180
  v_sub_f32 v78, v78, v180
  v_sub_f32 v79, v79, v180
  v_exp_f32 v64, v64
  v_exp_f32 v65, v65
  v_exp_f32 v66, v66
  v_exp_f32 v67, v67
  v_exp_f32 v68, v68
  v_exp_f32 v69, v69
  v_exp_f32 v70, v70
  v_exp_f32 v71, v71
  v_exp_f32 v72, v72
  v_exp_f32 v73, v73
  v_exp_f32 v74, v74
  v_exp_f32 v75, v75
  v_exp_f32 v76, v76
  v_exp_f32 v77, v77
  v_exp_f32 v78, v78
  v_exp_f32 v79, v79
  v_cvt_pk_bf16_f32 v20, v64, v65
  v_cvt_pk_bf16_f32 v21, v68, v69
  v_cvt_pk_bf16_f32 v22, v72, v73
  v_cvt_pk_bf16_f32 v23, v76, v77
  v_cvt_pk_bf16_f32 v24, v66, v67
  v_cvt_pk_bf16_f32 v25, v70, v71
  v_cvt_pk_bf16_f32 v26, v74, v75
  v_cvt_pk_bf16_f32 v27, v78, v79
  v_mfma_f32_32x32x16_bf16 v[0:15], v[160:163], v[20:23], 0
  v_add_f32 v182, v64, v65
  v_add_f32 v182, v182, v66
  v_add_f32 v182, v182, v67
  v_add_f32 v182, v182, v68
  v_add_f32 v182, v182, v69
  v_add_f32 v182, v182, v70
  v_add_f32 v182, v182, v71
  v_mfma_f32_32x32x16_bf16 v[0:15], v[164:167], v[24:27], v[0:15]
  v_add_f32 v182, v182, v72
  v_add_f32 v182, v182, v73
  v_add_f32 v182, v182, v74
  v_add_f32 v182, v182, v75
  v_add_f32 v182, v182, v76
  v_add_f32 v182, v182, v77
  v_add_f32 v182, v182, v78
  v_add_f32 v182, v182, v79
AT_l1:
  s_cmp_eq_u32 s69, 1
  s_cbranch_scc1 AT_v1
  s_cmp_ge_u32 s77, 62
  s_cbranch_scc1 AT_k1
  s_branch AT_c1
AT_h1:
  s_sleep 2
AT_c1:
  buffer_load_dword v172, off, s[8:11], s70 sc1
  s_add_u32 s65, s65, 1
  s_cmp_lt_u32 s65, 131072
  s_cselect_b32 s54, -2, -1
  s_waitcnt vmcnt(0)
  v_cmp_lt_u32 vcc, s54, v172
  s_cbranch_vccnz AT_h1
AT_k1:
  buffer_load_dwordx4 v[172:175], v201, s[8:11], s76 offen sc1
AT_v1:
  s_mov_b32 s69, 0
  s_add_u32 s65, s65, 1
  s_cmp_lt_u32 s65, 131072
  s_cselect_b32 s54, -2, -1
  s_waitcnt vmcnt(0)
  ds_write_b64 v220, v[172:173] offset:4096
  ds_write_b64 v221, v[174:175] offset:4096
  v_max3_u32 v213, v172, v173, v174
  v_max_u32 v213, v213, v175
  v_cmp_lt_u32 vcc, s54, v213
  s_cbranch_vccnz AT_k1
  s_waitcnt lgkmcnt(0)
  s_barrier
  ds_read_b128 v[128:131], v218 offset:4096
  ds_read_b128 v[132:135], v218 offset:4352
  ds_read_b128 v[136:139], v218 offset:4608
  ds_read_b128 v[140:143], v218 offset:4864
  ds_read_b128 v[144:147], v218 offset:5120
  ds_read_b128 v[148:151], v218 offset:5376
  ds_read_b128 v[152:155], v218 offset:5632
  ds_read_b128 v[156:159], v218 offset:5888
  ds_read_b32 v168, v219 offset:4096
  ds_read_b32 v169, v219 offset:4224
  s_waitcnt lgkmcnt(9)
  v_mfma_f32_32x32x16_bf16 v[80:95], v[128:131], a[144:147], 0
  s_waitcnt lgkmcnt(8)
  v_mfma_f32_32x32x16_bf16 v[80:95], v[132:135], a[148:151], v[80:95]
  s_waitcnt lgkmcnt(7)
  v_mfma_f32_32x32x16_bf16 v[80:95], v[136:139], a[152:155], v[80:95]
  s_waitcnt lgkmcnt(6)
  v_mfma_f32_32x32x16_bf16 v[80:95], v[140:143], a[156:159], v[80:95]
  s_waitcnt lgkmcnt(5)
  v_mfma_f32_32x32x16_bf16 v[80:95], v[144:147], a[160:163], v[80:95]
  s_waitcnt lgkmcnt(4)
  v_mfma_f32_32x32x16_bf16 v[80:95], v[148:151], a[164:167], v[80:95]
  s_waitcnt lgkmcnt(3)
  v_mfma_f32_32x32x16_bf16 v[80:95], v[152:155], a[168:171], v[80:95]
  s_waitcnt lgkmcnt(2)
  v_mfma_f32_32x32x16_bf16 v[80:95], v[156:159], a[172:175], v[80:95]
  s_add_u32 s77, s77, 2
  v_mov_b32 v212, s77
  s_nop 9
  v_mul_f32 v80, s68, v80
  v_mul_f32 v81, s68, v81
  v_mul_f32 v82, s68, v82
  v_mul_f32 v83, s68, v83
  v_max3_f32 v84, v184, v80, v81
  v_max3_f32 v84, v84, v82, v83
  v_mov_b32 v85, v84
  s_nop 1
  v_permlane32_swap_b32 v84, v85
  v_max_f32 v84, v84, v85
  v_sub_f32 v86, v184, v84
  v_sub_f32 v80, v80, v84
  v_sub_f32 v81, v81, v84
  v_sub_f32 v82, v82, v84
  v_sub_f32 v83, v83, v84
  v_exp_f32 v86, v86
  v_exp_f32 v80, v80
  v_exp_f32 v81, v81
  v_exp_f32 v82, v82
  v_exp_f32 v83, v83
  v_fma_f32 v186, v186, v86, v80
  v_add_f32 v84, v81, v82
  v_add_f32 v186, v186, v83
  v_add_f32 v186, v186, v84
  v_mov_b32 v187, v186
  s_nop 1
  v_permlane32_swap_b32 v186, v187
  v_add_f32 v186, v186, v187
  v_rcp_f32 v186, v186
  s_nop 0
  v_mul_f32 v86, v86, v186
  v_mul_f32 v80, v186, v80
  v_mul_f32 v81, v186, v81
  v_mul_f32 v82, v186, v82
  v_mul_f32 v83, v186, v83
  v_cvt_pk_bf16_f32 v28, v80, v81
  v_cvt_pk_bf16_f32 v29, v82, v83
  v_mul_f32 v224, v86, v224
  v_mul_f32 v225, v86, v225
  v_mul_f32 v226, v86, v226
  v_mul_f32 v227, v86, v227
  v_mul_f32 v228, v86, v228
  v_mul_f32 v229, v86, v229
  v_mul_f32 v230, v86, v230
  v_mul_f32 v231, v86, v231
  v_mul_f32 v232, v86, v232
  v_mul_f32 v233, v86, v233
  v_mul_f32 v234, v86, v234
  v_mul_f32 v235, v86, v235
  v_mul_f32 v236, v86, v236
  v_mul_f32 v237, v86, v237
  v_mul_f32 v238, v86, v238
  v_mul_f32 v239, v86, v239
  s_waitcnt lgkmcnt(0)
  s_nop 0
  v_mfma_f32_32x32x8_bf16 v[224:239], v[168:169], v[28:29], v[224:239]
  s_nop 11
  v_cvt_pk_bf16_f32 v20, v224, v225
  v_cvt_pk_bf16_f32 v21, v226, v227
  v_cvt_pk_bf16_f32 v22, v228, v229
  v_cvt_pk_bf16_f32 v23, v230, v231
  buffer_store_dwordx4 v[20:23], v201, s[8:11], s75 offen offset:0 sc1
  v_cvt_pk_bf16_f32 v24, v232, v233
  v_cvt_pk_bf16_f32 v25, v234, v235
  v_cvt_pk_bf16_f32 v26, v236, v237
  v_cvt_pk_bf16_f32 v27, v238, v239
  buffer_store_dwordx4 v[24:27], v201, s[8:11], s75 offen offset:1024 sc1
  s_mov_b64 exec, 1
  buffer_store_dword v212, v201, s[8:11], s71 offen sc1
  s_mov_b64 exec, -1
  s_cmp_ge_u32 s77, 64
  s_cbranch_scc1 L_exit
  s_branch AT_loop
L_cexit:
L_exit:
L_end:
s_endpgm
.section .rodata,"a"
.p2align 6
.amdhsa_kernel gated_mix__sliding_local_dilated__memory_aug_recurrent_mem_tr__prompt_kernel
  .amdhsa_next_free_vgpr 512
  .amdhsa_next_free_sgpr 102
  .amdhsa_accum_offset 256
  .amdhsa_group_segment_fixed_size 0
  .amdhsa_kernarg_size 112
  .amdhsa_user_sgpr_count 2
  .amdhsa_user_sgpr_kernarg_segment_ptr 1
  .amdhsa_system_sgpr_workgroup_id_x 1
.end_amdhsa_kernel
```

```asm
; @launch grid=(256,1,1) block=(256,1,1) lds=163840
.amdgcn_target "amdgcn-amd-amdhsa--gfx950"
.text
.globl gated_mix__sliding_local_dilated__memory_aug_recurrent_mem_tr__prompt_kernel
.p2align 8
.type gated_mix__sliding_local_dilated__memory_aug_recurrent_mem_tr__prompt_kernel,@function
gated_mix__sliding_local_dilated__memory_aug_recurrent_mem_tr__prompt_kernel:
  s_cmp_ge_u32 s2, 256
  s_cbranch_scc1 L_end
  s_load_dwordx2 s[4:5], s[0:1], 0
  s_load_dwordx2 s[8:9], s[0:1], 104
  s_load_dwordx2 s[12:13], s[0:1], 96
  s_load_dwordx2 s[16:17], s[0:1], 40
  s_load_dwordx2 s[20:21], s[0:1], 48
  s_load_dwordx2 s[24:25], s[0:1], 56
  s_load_dwordx2 s[28:29], s[0:1], 64
  s_load_dwordx2 s[32:33], s[0:1], 32
  s_load_dwordx2 s[36:37], s[0:1], 8
  s_load_dwordx2 s[40:41], s[0:1], 16
  s_load_dwordx2 s[44:45], s[0:1], 80
  s_load_dwordx2 s[48:49], s[0:1], 88
  s_getreg_b32 s54, hwreg(HW_REG_XCC_ID, 0, 3)
  v_lshrrev_b32 v1, 6, v0
  s_nop 0
  v_readfirstlane_b32 s52, v1
  s_mov_b32 s6, 2359296
  s_mov_b32 s7, 0x20000
  s_mov_b32 s10, 268435456
  s_mov_b32 s11, 0x20000
  s_mov_b32 s14, 256
  s_mov_b32 s15, 0x20000
  s_mov_b32 s18, 4718592
  s_mov_b32 s19, 0x20000
  s_mov_b32 s22, 4718592
  s_mov_b32 s23, 0x20000
  s_mov_b32 s26, 4718592
  s_mov_b32 s27, 0x20000
  s_mov_b32 s30, 4718592
  s_mov_b32 s31, 0x20000
  s_mov_b32 s34, 9216
  s_mov_b32 s35, 0x20000
  s_mov_b32 s38, 1990656
  s_mov_b32 s39, 0x20000
  s_mov_b32 s42, 663552
  s_mov_b32 s43, 0x20000
  s_mov_b32 s46, 1152
  s_mov_b32 s47, 0x20000
  s_mov_b32 s50, 2359296
  s_mov_b32 s51, 0x20000
  s_waitcnt lgkmcnt(0)
  s_lshr_b32 s0, s2, 3
  s_mov_b32 s2, s54
  s_mov_b32 s1, 0
L_role:
  s_mov_b32 s53, s0
  s_cmp_eq_u32 s2, 0
  s_cbranch_scc0 L_worker
  v_and_b32 v0, 63, v0
  v_and_b32 v1, 15, v0
  v_lshrrev_b32 v2, 4, v0
  v_and_b32 v3, 1, v2
  s_lshl_b32 s54, s52, 1
  v_add_u32 v3, s54, v3
  v_lshlrev_b32 v3, 1, v3
  v_xor_b32 v3, v3, v1
  v_lshlrev_b32 v3, 4, v3
  v_lshl_add_u32 v8, v2, 13, v3
  s_lshl_b32 s78, s53, 8
  s_lshl_b32 s54, s52, 15
  s_add_u32 s78, s78, s54
  s_mul_i32 s79, s53, 147456
  s_lshl_b32 s57, s52, 10
  s_add_u32 s57, s57, 16384
  s_getpc_b64 s[80:81]
L_pc_1:
  s_and_b32 s55, s0, 1
  s_lshl_b32 s55, s55, 2
  s_add_u32 s55, s55, s52
  s_lshl_b32 s55, s55, 10
  v_and_b32 v199, 63, v0
  v_lshl_add_u32 v199, v199, 4, s55
  v_min_u32 v199, (L_w0 - L_pc_1), v199
  global_load_dword v196, v199, s[80:81]
  s_add_u32 m0, s57, 0
  s_add_u32 s54, s78, 0
  buffer_load_dwordx4 v8, s[16:19], s54 offen  lds
  s_add_u32 m0, s57, 4096
  s_add_u32 s54, s78, 131072
  buffer_load_dwordx4 v8, s[16:19], s54 offen  lds
  s_add_u32 m0, s57, 8192
  s_add_u32 s54, s78, 262144
  buffer_load_dwordx4 v8, s[16:19], s54 offen  lds
  s_add_u32 m0, s57, 12288
  s_add_u32 s54, s78, 393216
  buffer_load_dwordx4 v8, s[16:19], s54 offen  lds
  s_add_u32 m0, s57, 16384
  s_add_u32 s54, s78, 524288
  buffer_load_dwordx4 v8, s[16:19], s54 offen  lds
  s_add_u32 m0, s57, 20480
  s_add_u32 s54, s78, 655360
  buffer_load_dwordx4 v8, s[16:19], s54 offen  lds
  s_add_u32 m0, s57, 24576
  s_add_u32 s54, s78, 786432
  buffer_load_dwordx4 v8, s[16:19], s54 offen  lds
  s_add_u32 m0, s57, 28672
  s_add_u32 s54, s78, 917504
  buffer_load_dwordx4 v8, s[16:19], s54 offen  lds
  s_add_u32 m0, s57, 32768
  s_add_u32 s54, s78, 1048576
  buffer_load_dwordx4 v8, s[16:19], s54 offen  lds
  s_add_u32 m0, s57, 36864
  s_add_u32 s54, s78, 1179648
  buffer_load_dwordx4 v8, s[16:19], s54 offen  lds
  s_add_u32 m0, s57, 40960
  s_add_u32 s54, s78, 1310720
  buffer_load_dwordx4 v8, s[16:19], s54 offen  lds
  s_add_u32 m0, s57, 45056
  s_add_u32 s54, s78, 1441792
  buffer_load_dwordx4 v8, s[16:19], s54 offen  lds
  s_add_u32 m0, s57, 49152
  s_add_u32 s54, s78, 1572864
  buffer_load_dwordx4 v8, s[16:19], s54 offen  lds
  s_add_u32 m0, s57, 53248
  s_add_u32 s54, s78, 1703936
  buffer_load_dwordx4 v8, s[16:19], s54 offen  lds
  s_add_u32 m0, s57, 57344
  s_add_u32 s54, s78, 1835008
  buffer_load_dwordx4 v8, s[16:19], s54 offen  lds
  s_add_u32 m0, s57, 61440
  s_add_u32 s54, s78, 1966080
  buffer_load_dwordx4 v8, s[16:19], s54 offen  lds
  v_lshlrev_b32 v76, 4, v0
  v_add_u32 v75, 0x10000, v76
  v_lshrrev_b32 v3, 2, v1
  v_and_b32 v4, 1, v1
  v_lshl_add_u32 v3, v3, 1, v4
  v_bfe_u32 v4, v1, 1, 1
  v_mul_u32_u24 v74, 0xaaaa, v4
  v_add_u32 v74, 0x4444, v74
  v_mul_u32_u24 v5, 576, v3
  v_add_u32 v5, 0, v5
  v_lshl_add_u32 v78, v2, 4, v5
  v_lshl_add_u32 v77, v2, 5, v5
  v_lshl_add_u32 v77, v4, 4, v77
  v_mul_u32_u24 v15, 1152, v3
  v_lshl_add_u32 v15, v2, 5, v15
  v_lshl_add_u32 v15, v4, 4, v15
  s_lshl_b32 s54, s52, 8
  buffer_load_dwordx4 v[20:23], v15, s[32:35], s54 offen
  buffer_load_dwordx4 v[24:27], v15, s[32:35], s54 offen offset:128
  buffer_load_dwordx4 v[28:31], v15, s[32:35], 0 offen offset:1024
  v_mul_u32_u24 v79, 1152, v2
  v_lshl_add_u32 v79, v1, 2, v79
  s_lshl_b32 s54, s52, 6
  s_add_u32 s54, s54, 0
  v_add_u32 v79, s54, v79
  v_lshrrev_b32 v5, 3, v0
  v_mul_u32_u24 v68, 2176, v5
  v_and_b32 v5, 7, v0
  v_lshl_add_u32 v68, v5, 3, v68
  v_lshrrev_b32 v6, 3, v0
  s_lshr_b32 s54, s53, 2
  v_add_u32 v68, s54, v6
  v_and_b32 v68, 7, v68
  v_xor_b32 v68, v68, v6
  v_lshlrev_b32 v68, 8, v68
  v_lshl_add_u32 v68, v6, 12, v68
  v_lshl_add_u32 v68, v5, 3, v68
  s_and_b32 s54, s53, 3
  s_lshl_b32 s54, s54, 6
  v_add_u32 v68, s54, v68
  v_and_b32 v5, 1, v2
  v_lshlrev_b32 v5, 4, v5
  v_lshl_add_u32 v5, v1, 2, v5
  v_mov_b32 v6, 0x40000000
  v_cmp_lt_u32 vcc, 3, v1
  s_nop 1
  v_cndmask_b32 v5, v5, v6, vcc
  v_lshrrev_b32 v6, 1, v2
  v_lshl_add_u32 v69, v6, 10, v5
  v_lshl_add_u32 v70, v6, 8, v5
  v_mov_b32 v71, -1
  ds_write_b128 v76, v[68:71] offset:13824
  v_and_b32 v5, 3, v1
  v_lshrrev_b32 v6, 2, v1
  v_lshl_add_u32 v5, v5, 2, v6
  v_and_b32 v6, 1, v5
  v_lshlrev_b32 v6, 4, v6
  v_mov_b32 v7, 0x3f80
  v_lshlrev_b32 v6, v6, v7
  v_lshrrev_b32 v5, 1, v5
  v_cmp_eq_u32 vcc, 0, v5
  s_nop 1
  v_cndmask_b32 v40, 0, v6, vcc
  v_cmp_eq_u32 vcc, 1, v5
  s_nop 1
  v_cndmask_b32 v41, 0, v6, vcc
  v_cmp_eq_u32 vcc, 2, v5
  s_nop 1
  v_cndmask_b32 v42, 0, v6, vcc
  v_cmp_eq_u32 vcc, 3, v5
  s_nop 1
  v_cndmask_b32 v43, 0, v6, vcc
  ds_write_b128 v76, v[40:43] offset:14848
  s_and_b32 s54, s52, 1
  s_lshr_b32 s55, s52, 1
  v_lshrrev_b32 v3, 3, v0
  v_and_b32 v4, 1, v3
  v_lshlrev_b32 v4, 4, v4
  v_and_b32 v5, 6, v3
  v_add_u32 v4, v4, v5
  s_lshl_b32 s56, s55, 3
  s_add_u32 s56, s56, s54
  v_add_u32 v4, s56, v4
  v_mul_u32_u24 v4, 1152, v4
  v_and_b32 v5, 2, v3
  v_lshlrev_b32 v5, 1, v5
  v_and_b32 v6, 7, v0
  v_xor_b32 v6, v6, v5
  v_lshl_add_u32 v9, v6, 4, v4
  v_and_b32 v4, 1, v2
  v_lshlrev_b32 v4, 4, v4
  v_and_b32 v5, 2, v2
  v_add_u32 v4, v4, v5
  s_lshl_b32 s56, s55, 2
  s_add_u32 s56, s56, s54
  v_add_u32 v4, s56, v4
  v_mul_u32_u24 v4, 1152, v4
  v_lshlrev_b32 v6, 1, v2
  v_xor_b32 v6, v6, v1
  v_lshl_add_u32 v10, v6, 4, v4
  v_bfe_u32 v17, v1, 2, 1
  v_bfe_u32 v18, v1, 3, 1
  v_and_b32 v19, 1, v2
  v_lshrrev_b32 v72, 1, v2
  v_and_b32 v73, 3, v1
  v_lshl_add_u32 v3, v19, 1, v17
  v_lshl_add_u32 v6, v18, 2, v3
  v_lshl_add_u32 v4, v72, 4, v17
  v_lshl_add_u32 v4, v19, 2, v4
  v_lshl_add_u32 v4, v18, 3, v4
  v_lshlrev_b32 v4, 8, v4
  s_lshl_b32 s54, s52, 6
  v_lshl_add_u32 v5, v73, 3, s54
  v_lshlrev_b32 v7, 5, v6
  v_xor_b32 v5, v5, v7
  v_add_u32 v11, v4, v5
  v_xor_b32 v12, 32, v11
  v_lshl_add_u32 v4, v72, 2, v3
  v_lshlrev_b32 v4, 7, v4
  v_lshl_add_u32 v4, v73, 3, v4
  s_and_b32 s54, s52, 1
  v_xor_b32 v7, s54, v19
  v_lshl_add_u32 v7, v7, 1, v18
  v_lshl_add_u32 v13, v7, 5, v4
  v_lshlrev_b32 v4, 11, v72
  v_lshl_add_u32 v4, v73, 3, v4
  v_lshl_add_u32 v5, v3, 8, v4
  v_lshl_add_u32 v7, v18, 2, s52
  v_xor_b32 v7, v7, v3
  v_lshl_add_u32 v14, v7, 5, v5
  s_lshl_b32 s54, s53, 14
  s_lshl_b32 s55, s52, 11
  s_add_u32 s54, s54, 1048576
  s_add_u32 s58, s54, s55
  s_add_u32 s59, s58, 8192
  s_lshl_b32 s55, s52, 12
  s_add_u32 s70, s54, s55
  s_add_u32 s70, s70, 655360
  s_lshl_b32 s54, s53, 12
  s_lshl_b32 s55, s52, 10
  s_add_u32 s54, s54, s55
  s_add_u32 s68, s54, 917504
  s_lshl_b32 s54, s53, 6
  s_mul_i32 s55, s52, 17408
  s_add_u32 s55, s54, s55
  s_add_u32 s73, s55, 0
  s_add_u32 s74, s55, 69632
  s_add_u32 s75, s55, 139264
  s_add_u32 s76, s55, 208896
  s_and_b32 s56, s52, 1
  s_mul_i32 s55, s56, 17408
  s_add_u32 s55, s54, s55
  s_add_u32 s77, s55, 278528
  s_mul_i32 s54, s52, 69632
  s_mul_i32 s55, s53, 2176
  s_add_u32 s54, s54, s55
  s_add_u32 s60, s54, 0
  s_and_b32 s56, s53, 15
  s_mul_i32 s55, s56, 2176
  s_add_u32 s61, s55, 278528
  s_lshr_b32 s54, s52, 1
  s_lshl_b32 s54, s54, 15
  s_and_b32 s55, s52, 1
  s_lshl_b32 s55, s55, 11
  s_add_u32 s54, s54, s55
  s_add_u32 s73, s54, 0
  s_add_u32 s74, s54, 65536
  s_add_u32 s75, s54, 131072
  s_add_u32 s76, s54, 196608
  s_add_u32 s77, s55, 262144
  s_and_b32 s54, s53, 7
  s_lshl_b32 s54, s54, 12
  s_bfe_u32 s55, s53, 0x10003
  s_lshl_b32 s55, s55, 11
  s_add_u32 s54, s54, s55
  s_add_u32 s61, s54, 262144
  s_lshr_b32 s55, s53, 4
  s_lshl_b32 s55, s55, 15
  s_add_u32 s54, s54, s55
  s_lshl_b32 s55, s52, 16
  s_add_u32 s54, s54, s55
  s_add_u32 s60, s54, 0
  s_lshl_b32 s54, s52, 11
  s_add_u32 s64, s54, 360448
  s_mov_b32 s65, 368640
  s_lshl_b32 s55, s53, 5
  s_add_u32 s54, s54, s55
  s_add_u32 s62, s54, 376832
  s_lshr_b32 s54, s56, 3
  s_lshl_b32 s54, s54, 9
  s_and_b32 s55, s56, 7
  s_lshl_b32 s55, s55, 5
  s_add_u32 s54, s54, s55
  s_add_u32 s63, s54, 385024
  s_mov_b32 s66, 0
  s_mov_b32 s67, 0
  s_mov_b32 s72, 0
  s_mov_b32 s69, 1040356334
  s_waitcnt vmcnt(15) lgkmcnt(0)
  s_barrier
  s_add_u32 m0, s57, 65536
  s_add_u32 s54, s78, 2097152
  buffer_load_dwordx4 v8, s[16:19], s54 offen  lds
  s_add_u32 m0, s57, 69632
  s_add_u32 s54, s78, 2228224
  buffer_load_dwordx4 v8, s[16:19], s54 offen  lds
  s_add_u32 m0, s57, 73728
  s_add_u32 s54, s78, 2359296
  buffer_load_dwordx4 v8, s[16:19], s54 offen  lds
  s_add_u32 m0, s57, 77824
  s_add_u32 s54, s78, 2490368
  buffer_load_dwordx4 v8, s[16:19], s54 offen  lds
  s_lshl_b32 s55, s2, 2
  s_or_b32 s56, s52, s1
  s_cmp_eq_u32 s56, 0
  s_cselect_b32 s55, s55, 0x1000
  s_lshl_b32 s56, 1, s0
  v_mov_b32 v35, s56
  s_mov_b64 exec, 1
  buffer_atomic_or v35, off, s[12:15], s55 sc0
  s_mov_b64 exec, -1
  v_add_u32 v15, 16384, v11
  v_add_u32 v16, 16384, v12
  ds_read_b64_tr_b16 v[80:81], v15 offset:0
  ds_read_b64_tr_b16 v[82:83], v15 offset:512
  ds_read_b64_tr_b16 v[84:85], v15 offset:8192
  ds_read_b64_tr_b16 v[86:87], v15 offset:8704
  ds_read_b64_tr_b16 v[88:89], v16 offset:0
  ds_read_b64_tr_b16 v[90:91], v16 offset:512
  ds_read_b64_tr_b16 v[92:93], v16 offset:8192
  ds_read_b64_tr_b16 v[94:95], v16 offset:8704
  s_waitcnt vmcnt(16) lgkmcnt(0)
  s_barrier
  s_add_u32 m0, s57, 81920
  s_add_u32 s54, s78, 2621440
  buffer_load_dwordx4 v8, s[16:19], s54 offen  lds
  s_add_u32 m0, s57, 86016
  s_add_u32 s54, s78, 2752512
  buffer_load_dwordx4 v8, s[16:19], s54 offen  lds
  s_add_u32 m0, s57, 90112
  s_add_u32 s54, s78, 2883584
  buffer_load_dwordx4 v8, s[16:19], s54 offen  lds
  s_add_u32 m0, s57, 94208
  s_add_u32 s54, s78, 3014656
  buffer_load_dwordx4 v8, s[16:19], s54 offen  lds
  v_add_u32 v15, 32768, v11
  v_add_u32 v16, 32768, v12
  ds_read_b64_tr_b16 v[96:97], v15 offset:0
  ds_read_b64_tr_b16 v[98:99], v15 offset:512
  ds_read_b64_tr_b16 v[100:101], v15 offset:8192
  ds_read_b64_tr_b16 v[102:103], v15 offset:8704
  ds_read_b64_tr_b16 v[104:105], v16 offset:0
  ds_read_b64_tr_b16 v[106:107], v16 offset:512
  ds_read_b64_tr_b16 v[108:109], v16 offset:8192
  ds_read_b64_tr_b16 v[110:111], v16 offset:8704
  s_waitcnt vmcnt(16) lgkmcnt(0)
  s_barrier
  s_add_u32 m0, s57, 98304
  s_add_u32 s54, s78, 3670016
  buffer_load_dwordx4 v8, s[16:19], s54 offen  lds
  s_add_u32 m0, s57, 102400
  s_add_u32 s54, s78, 3801088
  buffer_load_dwordx4 v8, s[16:19], s54 offen  lds
  s_add_u32 m0, s57, 106496
  s_add_u32 s54, s78, 3932160
  buffer_load_dwordx4 v8, s[16:19], s54 offen  lds
  s_add_u32 m0, s57, 110592
  s_add_u32 s54, s78, 4063232
  buffer_load_dwordx4 v8, s[16:19], s54 offen  lds
  v_add_u32 v15, 49152, v11
  v_add_u32 v16, 49152, v12
  ds_read_b64_tr_b16 v[112:113], v15 offset:0
  ds_read_b64_tr_b16 v[114:115], v15 offset:512
  ds_read_b64_tr_b16 v[116:117], v15 offset:8192
  ds_read_b64_tr_b16 v[118:119], v15 offset:8704
  ds_read_b64_tr_b16 v[120:121], v16 offset:0
  ds_read_b64_tr_b16 v[122:123], v16 offset:512
  ds_read_b64_tr_b16 v[124:125], v16 offset:8192
  ds_read_b64_tr_b16 v[126:127], v16 offset:8704
  s_waitcnt vmcnt(16) lgkmcnt(0)
  s_barrier
  s_add_u32 m0, s57, 114688
  s_add_u32 s54, s78, 4194304
  buffer_load_dwordx4 v8, s[16:19], s54 offen  lds
  s_add_u32 m0, s57, 118784
  s_add_u32 s54, s78, 4325376
  buffer_load_dwordx4 v8, s[16:19], s54 offen  lds
  s_add_u32 m0, s57, 122880
  s_add_u32 s54, s78, 4456448
  buffer_load_dwordx4 v8, s[16:19], s54 offen  lds
  s_add_u32 m0, s57, 126976
  s_add_u32 s54, s78, 4587520
  buffer_load_dwordx4 v8, s[16:19], s54 offen  lds
  v_add_u32 v15, 65536, v11
  v_add_u32 v16, 65536, v12
  ds_read_b64_tr_b16 v[128:129], v15 offset:0
  ds_read_b64_tr_b16 v[130:131], v15 offset:512
  ds_read_b64_tr_b16 v[132:133], v15 offset:8192
  ds_read_b64_tr_b16 v[134:135], v15 offset:8704
  ds_read_b64_tr_b16 v[136:137], v16 offset:0
  ds_read_b64_tr_b16 v[138:139], v16 offset:512
  ds_read_b64_tr_b16 v[140:141], v16 offset:8192
  ds_read_b64_tr_b16 v[142:143], v16 offset:8704
  s_waitcnt vmcnt(13) lgkmcnt(0)
  s_barrier
  s_add_u32 m0, s57, 131072
  s_add_u32 s54, s78, 1048576
  buffer_load_dwordx4 v8, s[20:23], s54 offen  lds
  s_add_u32 m0, s57, 135168
  s_add_u32 s54, s78, 1179648
  buffer_load_dwordx4 v8, s[20:23], s54 offen  lds
  s_add_u32 m0, s57, 139264
  s_add_u32 s54, s78, 1310720
  buffer_load_dwordx4 v8, s[20:23], s54 offen  lds
  s_add_u32 m0, s57, 143360
  s_add_u32 s54, s78, 1441792
  buffer_load_dwordx4 v8, s[20:23], s54 offen  lds
  v_add_u32 v15, 81920, v11
  v_add_u32 v16, 81920, v12
  ds_read_b64_tr_b16 v[144:145], v15 offset:0
  ds_read_b64_tr_b16 v[146:147], v15 offset:512
  ds_read_b64_tr_b16 v[148:149], v15 offset:8192
  ds_read_b64_tr_b16 v[150:151], v15 offset:8704
  ds_read_b64_tr_b16 v[152:153], v16 offset:0
  ds_read_b64_tr_b16 v[154:155], v16 offset:512
  ds_read_b64_tr_b16 v[156:157], v16 offset:8192
  ds_read_b64_tr_b16 v[158:159], v16 offset:8704
  s_waitcnt vmcnt(12) lgkmcnt(0)
  s_barrier
  s_add_u32 m0, s57, 0
  s_add_u32 s54, s78, 1572864
  buffer_load_dwordx4 v8, s[20:23], s54 offen  lds
  s_add_u32 m0, s57, 4096
  s_add_u32 s54, s78, 1703936
  buffer_load_dwordx4 v8, s[20:23], s54 offen  lds
  s_add_u32 m0, s57, 8192
  s_add_u32 s54, s78, 1835008
  buffer_load_dwordx4 v8, s[20:23], s54 offen  lds
  s_add_u32 m0, s57, 12288
  s_add_u32 s54, s78, 1966080
  buffer_load_dwordx4 v8, s[20:23], s54 offen  lds
  v_add_u32 v15, 98304, v11
  v_add_u32 v16, 98304, v12
  ds_read_b64_tr_b16 v[160:161], v15 offset:0
  ds_read_b64_tr_b16 v[162:163], v15 offset:512
  ds_read_b64_tr_b16 v[164:165], v15 offset:8192
  ds_read_b64_tr_b16 v[166:167], v15 offset:8704
  ds_read_b64_tr_b16 v[168:169], v16 offset:0
  ds_read_b64_tr_b16 v[170:171], v16 offset:512
  ds_read_b64_tr_b16 v[172:173], v16 offset:8192
  ds_read_b64_tr_b16 v[174:175], v16 offset:8704
  s_waitcnt vmcnt(12) lgkmcnt(0)
  s_barrier
  s_add_u32 m0, s57, 16384
  s_add_u32 s54, s78, 3145728
  buffer_load_dwordx4 v8, s[20:23], s54 offen  lds
  s_add_u32 m0, s57, 20480
  s_add_u32 s54, s78, 3276800
  buffer_load_dwordx4 v8, s[20:23], s54 offen  lds
  s_add_u32 m0, s57, 24576
  s_add_u32 s54, s78, 3407872
  buffer_load_dwordx4 v8, s[20:23], s54 offen  lds
  s_add_u32 m0, s57, 28672
  s_add_u32 s54, s78, 3538944
  buffer_load_dwordx4 v8, s[20:23], s54 offen  lds
  v_add_u32 v15, 114688, v11
  v_add_u32 v16, 114688, v12
  ds_read_b64_tr_b16 v[176:177], v15 offset:0
  ds_read_b64_tr_b16 v[178:179], v15 offset:512
  ds_read_b64_tr_b16 v[180:181], v15 offset:8192
  ds_read_b64_tr_b16 v[182:183], v15 offset:8704
  ds_read_b64_tr_b16 v[184:185], v16 offset:0
  ds_read_b64_tr_b16 v[186:187], v16 offset:512
  ds_read_b64_tr_b16 v[188:189], v16 offset:8192
  ds_read_b64_tr_b16 v[190:191], v16 offset:8704
  s_waitcnt vmcnt(12) lgkmcnt(0)
  s_barrier
  s_add_u32 m0, s57, 32768
  s_add_u32 s54, s78, 3670016
  buffer_load_dwordx4 v8, s[20:23], s54 offen  lds
  s_add_u32 m0, s57, 36864
  s_add_u32 s54, s78, 3801088
  buffer_load_dwordx4 v8, s[20:23], s54 offen  lds
  s_add_u32 m0, s57, 40960
  s_add_u32 s54, s78, 3932160
  buffer_load_dwordx4 v8, s[20:23], s54 offen  lds
  s_add_u32 m0, s57, 45056
  s_add_u32 s54, s78, 4063232
  buffer_load_dwordx4 v8, s[20:23], s54 offen  lds
  v_add_u32 v15, 131072, v11
  v_add_u32 v16, 131072, v12
  ds_read_b64_tr_b16 v[192:193], v15 offset:0
  ds_read_b64_tr_b16 v[194:195], v15 offset:512
  ds_read_b64_tr_b16 v[196:197], v15 offset:8192
  ds_read_b64_tr_b16 v[198:199], v15 offset:8704
  ds_read_b64_tr_b16 v[200:201], v16 offset:0
  ds_read_b64_tr_b16 v[202:203], v16 offset:512
  ds_read_b64_tr_b16 v[204:205], v16 offset:8192
  ds_read_b64_tr_b16 v[206:207], v16 offset:8704
  s_waitcnt vmcnt(12) lgkmcnt(0)
  s_barrier
  s_add_u32 m0, s57, 49152
  s_add_u32 s54, s78, 4194304
  buffer_load_dwordx4 v8, s[20:23], s54 offen  lds
  s_add_u32 m0, s57, 53248
  s_add_u32 s54, s78, 4325376
  buffer_load_dwordx4 v8, s[20:23], s54 offen  lds
  s_add_u32 m0, s57, 57344
  s_add_u32 s54, s78, 4456448
  buffer_load_dwordx4 v8, s[20:23], s54 offen  lds
  s_add_u32 m0, s57, 61440
  s_add_u32 s54, s78, 4587520
  buffer_load_dwordx4 v8, s[20:23], s54 offen  lds
  s_getpc_b64 s[80:81]
  v_lshlrev_b32 v7, 2, v76
  global_load_dword v19, v7, s[80:81] offset:1024
  s_cmp_eq_u32 s1, 1
  s_cbranch_scc1 C_ver_ok
  v_mov_b32 v33, 16320
  s_cmp_eq_u32 s52, 0
  s_cbranch_scc0 C_ver_b
  s_waitcnt vmcnt(33)
  s_mov_b64 exec, 1
  ds_write_b32 v33, v35
  s_mov_b64 exec, -1
  s_waitcnt lgkmcnt(0)
C_ver_b:
  s_barrier
  ds_read_b32 v32, v33
  s_waitcnt lgkmcnt(0)
  v_readfirstlane_b32 s54, v32
  s_nop 0
  s_bitcmp1_b32 s54, s0
  s_cbranch_scc1 L_conf
C_ver_ok:
  v_min_u32 v20, -2, v20
  v_min_u32 v21, -2, v21
  v_min_u32 v22, -2, v22
  v_min_u32 v23, -2, v23
  v_min_u32 v24, -2, v24
  v_min_u32 v25, -2, v25
  v_min_u32 v26, -2, v26
  v_min_u32 v27, -2, v27
  v_min_u32 v28, -2, v28
  v_min_u32 v29, -2, v29
  v_min_u32 v30, -2, v30
  v_min_u32 v31, -2, v31
  s_lshl_b32 s54, s52, 11
  v_add_u32 v3, s54, v76
  ds_write_b128 v3, v[20:23] offset:4608
  ds_write_b128 v3, v[24:27] offset:5632
  ds_write_b128 v76, v[28:31] offset:12800
  v_add_u32 v15, 147456, v11
  v_add_u32 v16, 147456, v12
  ds_read_b64_tr_b16 v[208:209], v15 offset:0
  ds_read_b64_tr_b16 v[210:211], v15 offset:512
  ds_read_b64_tr_b16 v[212:213], v15 offset:8192
  ds_read_b64_tr_b16 v[214:215], v15 offset:8704
  ds_read_b64_tr_b16 v[216:217], v16 offset:0
  ds_read_b64_tr_b16 v[218:219], v16 offset:512
  ds_read_b64_tr_b16 v[220:221], v16 offset:8192
  ds_read_b64_tr_b16 v[222:223], v16 offset:8704
  s_waitcnt vmcnt(13) lgkmcnt(0)
  s_barrier
  s_add_u32 m0, s57, 65536
  s_add_u32 s54, s78, 0
  buffer_load_dwordx4 v8, s[24:27], s54 offen  lds
  s_add_u32 m0, s57, 69632
  s_add_u32 s54, s78, 131072
  buffer_load_dwordx4 v8, s[24:27], s54 offen  lds
  s_add_u32 m0, s57, 73728
  s_add_u32 s54, s78, 262144
  buffer_load_dwordx4 v8, s[24:27], s54 offen  lds
  s_add_u32 m0, s57, 77824
  s_add_u32 s54, s78, 393216
  buffer_load_dwordx4 v8, s[24:27], s54 offen  lds
  v_add_u32 v15, 16384, v11
  v_add_u32 v16, 16384, v12
  ds_read_b64_tr_b16 v[224:225], v15 offset:0
  ds_read_b64_tr_b16 v[226:227], v15 offset:512
  ds_read_b64_tr_b16 v[228:229], v15 offset:8192
  ds_read_b64_tr_b16 v[230:231], v15 offset:8704
  ds_read_b64_tr_b16 v[232:233], v16 offset:0
  ds_read_b64_tr_b16 v[234:235], v16 offset:512
  ds_read_b64_tr_b16 v[236:237], v16 offset:8192
  ds_read_b64_tr_b16 v[238:239], v16 offset:8704
  s_waitcnt vmcnt(13) lgkmcnt(0)
  s_barrier
  s_add_u32 m0, s57, 81920
  s_add_u32 s54, s78, 524288
  buffer_load_dwordx4 v8, s[24:27], s54 offen  lds
  s_add_u32 m0, s57, 86016
  s_add_u32 s54, s78, 655360
  buffer_load_dwordx4 v8, s[24:27], s54 offen  lds
  s_add_u32 m0, s57, 90112
  s_add_u32 s54, s78, 786432
  buffer_load_dwordx4 v8, s[24:27], s54 offen  lds
  s_add_u32 m0, s57, 94208
  s_add_u32 s54, s78, 917504
  buffer_load_dwordx4 v8, s[24:27], s54 offen  lds
  v_add_u32 v15, 32768, v11
  v_add_u32 v16, 32768, v12
  ds_read_b64_tr_b16 v[240:241], v15 offset:0
  ds_read_b64_tr_b16 v[242:243], v15 offset:512
  ds_read_b64_tr_b16 v[244:245], v15 offset:8192
  ds_read_b64_tr_b16 v[246:247], v15 offset:8704
  ds_read_b64_tr_b16 v[248:249], v16 offset:0
  ds_read_b64_tr_b16 v[250:251], v16 offset:512
  ds_read_b64_tr_b16 v[252:253], v16 offset:8192
  ds_read_b64_tr_b16 v[254:255], v16 offset:8704
  s_waitcnt vmcnt(13) lgkmcnt(0)
  s_barrier
  s_add_u32 m0, s57, 98304
  s_add_u32 s54, s78, 1048576
  buffer_load_dwordx4 v8, s[24:27], s54 offen  lds
  s_add_u32 m0, s57, 102400
  s_add_u32 s54, s78, 1179648
  buffer_load_dwordx4 v8, s[24:27], s54 offen  lds
  s_add_u32 m0, s57, 106496
  s_add_u32 s54, s78, 1310720
  buffer_load_dwordx4 v8, s[24:27], s54 offen  lds
  s_add_u32 m0, s57, 110592
  s_add_u32 s54, s78, 1441792
  buffer_load_dwordx4 v8, s[24:27], s54 offen  lds
  v_add_u32 v15, 49152, v11
  v_add_u32 v16, 49152, v12
  ds_read_b64_tr_b16 a[0:1], v15 offset:0
  ds_read_b64_tr_b16 a[2:3], v15 offset:512
  ds_read_b64_tr_b16 a[4:5], v15 offset:8192
  ds_read_b64_tr_b16 a[6:7], v15 offset:8704
  ds_read_b64_tr_b16 a[8:9], v16 offset:0
  ds_read_b64_tr_b16 a[10:11], v16 offset:512
  ds_read_b64_tr_b16 a[12:13], v16 offset:8192
  ds_read_b64_tr_b16 a[14:15], v16 offset:8704
  s_waitcnt vmcnt(13) lgkmcnt(0)
  s_barrier
  s_add_u32 m0, s57, 114688
  s_add_u32 s54, s78, 1572864
  buffer_load_dwordx4 v8, s[24:27], s54 offen  lds
  s_add_u32 m0, s57, 118784
  s_add_u32 s54, s78, 1703936
  buffer_load_dwordx4 v8, s[24:27], s54 offen  lds
  s_add_u32 m0, s57, 122880
  s_add_u32 s54, s78, 1835008
  buffer_load_dwordx4 v8, s[24:27], s54 offen  lds
  s_add_u32 m0, s57, 126976
  s_add_u32 s54, s78, 1966080
  buffer_load_dwordx4 v8, s[24:27], s54 offen  lds
  v_add_u32 v15, 65536, v11
  v_add_u32 v16, 65536, v12
  ds_read_b64_tr_b16 a[16:17], v15 offset:0
  ds_read_b64_tr_b16 a[18:19], v15 offset:512
  ds_read_b64_tr_b16 a[20:21], v15 offset:8192
  ds_read_b64_tr_b16 a[22:23], v15 offset:8704
  ds_read_b64_tr_b16 a[24:25], v16 offset:0
  ds_read_b64_tr_b16 a[26:27], v16 offset:512
  ds_read_b64_tr_b16 a[28:29], v16 offset:8192
  ds_read_b64_tr_b16 a[30:31], v16 offset:8704
  s_waitcnt vmcnt(12) lgkmcnt(0)
  s_barrier
  s_add_u32 m0, s57, 131072
  s_add_u32 s54, s78, 2097152
  buffer_load_dwordx4 v8, s[24:27], s54 offen  lds
  s_add_u32 m0, s57, 135168
  s_add_u32 s54, s78, 2228224
  buffer_load_dwordx4 v8, s[24:27], s54 offen  lds
  s_add_u32 m0, s57, 139264
  s_add_u32 s54, s78, 2359296
  buffer_load_dwordx4 v8, s[24:27], s54 offen  lds
  s_add_u32 m0, s57, 143360
  s_add_u32 s54, s78, 2490368
  buffer_load_dwordx4 v8, s[24:27], s54 offen  lds
  v_add_u32 v15, 81920, v11
  v_add_u32 v16, 81920, v12
  ds_read_b64_tr_b16 a[32:33], v15 offset:0
  ds_read_b64_tr_b16 a[34:35], v15 offset:512
  ds_read_b64_tr_b16 a[36:37], v15 offset:8192
  ds_read_b64_tr_b16 a[38:39], v15 offset:8704
  ds_read_b64_tr_b16 a[40:41], v16 offset:0
  ds_read_b64_tr_b16 a[42:43], v16 offset:512
  ds_read_b64_tr_b16 a[44:45], v16 offset:8192
  ds_read_b64_tr_b16 a[46:47], v16 offset:8704
  s_waitcnt vmcnt(12) lgkmcnt(0)
  s_barrier
  s_add_u32 m0, s57, 0
  s_add_u32 s54, s78, 2621440
  buffer_load_dwordx4 v8, s[24:27], s54 offen  lds
  s_add_u32 m0, s57, 4096
  s_add_u32 s54, s78, 2752512
  buffer_load_dwordx4 v8, s[24:27], s54 offen  lds
  s_add_u32 m0, s57, 8192
  s_add_u32 s54, s78, 2883584
  buffer_load_dwordx4 v8, s[24:27], s54 offen  lds
  s_add_u32 m0, s57, 12288
  s_add_u32 s54, s78, 3014656
  buffer_load_dwordx4 v8, s[24:27], s54 offen  lds
  s_getpc_b64 s[80:81]
  v_lshlrev_b32 v7, 2, v76
  global_load_dword v19, v7, s[80:81] offset:1024
  v_add_u32 v15, 98304, v11
  v_add_u32 v16, 98304, v12
  ds_read_b64_tr_b16 a[48:49], v15 offset:0
  ds_read_b64_tr_b16 a[50:51], v15 offset:512
  ds_read_b64_tr_b16 a[52:53], v15 offset:8192
  ds_read_b64_tr_b16 a[54:55], v15 offset:8704
  ds_read_b64_tr_b16 a[56:57], v16 offset:0
  ds_read_b64_tr_b16 a[58:59], v16 offset:512
  ds_read_b64_tr_b16 a[60:61], v16 offset:8192
  ds_read_b64_tr_b16 a[62:63], v16 offset:8704
  s_waitcnt vmcnt(13) lgkmcnt(0)
  s_barrier
  s_add_u32 m0, s57, 16384
  s_add_u32 s54, s78, 3145728
  buffer_load_dwordx4 v8, s[24:27], s54 offen  lds
  s_add_u32 m0, s57, 20480
  s_add_u32 s54, s78, 3276800
  buffer_load_dwordx4 v8, s[24:27], s54 offen  lds
  s_add_u32 m0, s57, 24576
  s_add_u32 s54, s78, 3407872
  buffer_load_dwordx4 v8, s[24:27], s54 offen  lds
  s_add_u32 m0, s57, 28672
  s_add_u32 s54, s78, 3538944
  buffer_load_dwordx4 v8, s[24:27], s54 offen  lds
  v_add_u32 v15, 114688, v11
  v_add_u32 v16, 114688, v12
  ds_read_b64_tr_b16 a[64:65], v15 offset:0
  ds_read_b64_tr_b16 a[66:67], v15 offset:512
  ds_read_b64_tr_b16 a[68:69], v15 offset:8192
  ds_read_b64_tr_b16 a[70:71], v15 offset:8704
  ds_read_b64_tr_b16 a[72:73], v16 offset:0
  ds_read_b64_tr_b16 a[74:75], v16 offset:512
  ds_read_b64_tr_b16 a[76:77], v16 offset:8192
  ds_read_b64_tr_b16 a[78:79], v16 offset:8704
  s_waitcnt vmcnt(13) lgkmcnt(0)
  s_barrier
  s_add_u32 m0, s57, 32768
  s_add_u32 s54, s78, 3670016
  buffer_load_dwordx4 v8, s[24:27], s54 offen  lds
  s_add_u32 m0, s57, 36864
  s_add_u32 s54, s78, 3801088
  buffer_load_dwordx4 v8, s[24:27], s54 offen  lds
  s_add_u32 m0, s57, 40960
  s_add_u32 s54, s78, 3932160
  buffer_load_dwordx4 v8, s[24:27], s54 offen  lds
  s_add_u32 m0, s57, 45056
  s_add_u32 s54, s78, 4063232
  buffer_load_dwordx4 v8, s[24:27], s54 offen  lds
  v_add_u32 v15, 131072, v11
  v_add_u32 v16, 131072, v12
  ds_read_b64_tr_b16 a[80:81], v15 offset:0
  ds_read_b64_tr_b16 a[82:83], v15 offset:512
  ds_read_b64_tr_b16 a[84:85], v15 offset:8192
  ds_read_b64_tr_b16 a[86:87], v15 offset:8704
  ds_read_b64_tr_b16 a[88:89], v16 offset:0
  ds_read_b64_tr_b16 a[90:91], v16 offset:512
  ds_read_b64_tr_b16 a[92:93], v16 offset:8192
  ds_read_b64_tr_b16 a[94:95], v16 offset:8704
  s_waitcnt vmcnt(13) lgkmcnt(0)
  s_barrier
  s_add_u32 m0, s57, 49152
  s_add_u32 s54, s78, 4194304
  buffer_load_dwordx4 v8, s[24:27], s54 offen  lds
  s_add_u32 m0, s57, 53248
  s_add_u32 s54, s78, 4325376
  buffer_load_dwordx4 v8, s[24:27], s54 offen  lds
  s_add_u32 m0, s57, 57344
  s_add_u32 s54, s78, 4456448
  buffer_load_dwordx4 v8, s[24:27], s54 offen  lds
  s_add_u32 m0, s57, 61440
  s_add_u32 s54, s78, 4587520
  buffer_load_dwordx4 v8, s[24:27], s54 offen  lds
  v_add_u32 v15, 147456, v11
  v_add_u32 v16, 147456, v12
  ds_read_b64_tr_b16 a[96:97], v15 offset:0
  ds_read_b64_tr_b16 a[98:99], v15 offset:512
  ds_read_b64_tr_b16 a[100:101], v15 offset:8192
  ds_read_b64_tr_b16 a[102:103], v15 offset:8704
  ds_read_b64_tr_b16 a[104:105], v16 offset:0
  ds_read_b64_tr_b16 a[106:107], v16 offset:512
  ds_read_b64_tr_b16 a[108:109], v16 offset:8192
  ds_read_b64_tr_b16 a[110:111], v16 offset:8704
  s_waitcnt vmcnt(13) lgkmcnt(0)
  s_barrier
  s_add_u32 m0, s57, 65536
  s_add_u32 s54, s79, 73728
  buffer_load_dwordx4 v10, s[28:31], s54 offen  lds
  s_add_u32 m0, s57, 69632
  s_add_u32 s54, s79, 82944
  buffer_load_dwordx4 v10, s[28:31], s54 offen  lds
  s_add_u32 m0, s57, 73728
  s_add_u32 s54, s79, 110592
  buffer_load_dwordx4 v10, s[28:31], s54 offen  lds
  s_add_u32 m0, s57, 77824
  s_add_u32 s54, s79, 119808
  buffer_load_dwordx4 v10, s[28:31], s54 offen  lds
  v_add_u32 v15, 16384, v11
  v_add_u32 v16, 16384, v12
  ds_read_b64_tr_b16 a[112:113], v15 offset:0
  ds_read_b64_tr_b16 a[114:115], v15 offset:512
  ds_read_b64_tr_b16 a[116:117], v15 offset:8192
  ds_read_b64_tr_b16 a[118:119], v15 offset:8704
  ds_read_b64_tr_b16 a[120:121], v16 offset:0
  ds_read_b64_tr_b16 a[122:123], v16 offset:512
  ds_read_b64_tr_b16 a[124:125], v16 offset:8192
  ds_read_b64_tr_b16 a[126:127], v16 offset:8704
  s_waitcnt vmcnt(12) lgkmcnt(0)
  s_barrier
  s_add_u32 m0, s57, 81920
  s_add_u32 s54, s79, 256
  buffer_load_dwordx4 v10, s[28:31], s54 offen  lds
  s_add_u32 m0, s57, 86016
  s_add_u32 s54, s79, 9472
  buffer_load_dwordx4 v10, s[28:31], s54 offen  lds
  s_add_u32 m0, s57, 90112
  s_add_u32 s54, s79, 37120
  buffer_load_dwordx4 v10, s[28:31], s54 offen  lds
  s_add_u32 m0, s57, 94208
  s_add_u32 s54, s79, 46336
  buffer_load_dwordx4 v10, s[28:31], s54 offen  lds
  v_add_u32 v15, 32768, v11
  v_add_u32 v16, 32768, v12
  ds_read_b64_tr_b16 a[128:129], v15 offset:0
  ds_read_b64_tr_b16 a[130:131], v15 offset:512
  ds_read_b64_tr_b16 a[132:133], v15 offset:8192
  ds_read_b64_tr_b16 a[134:135], v15 offset:8704
  ds_read_b64_tr_b16 a[136:137], v16 offset:0
  ds_read_b64_tr_b16 a[138:139], v16 offset:512
  ds_read_b64_tr_b16 a[140:141], v16 offset:8192
  ds_read_b64_tr_b16 a[142:143], v16 offset:8704
  s_waitcnt vmcnt(12) lgkmcnt(0)
  s_barrier
  s_add_u32 m0, s57, 98304
  s_add_u32 s54, s79, 512
  buffer_load_dwordx4 v10, s[28:31], s54 offen  lds
  s_add_u32 m0, s57, 102400
  s_add_u32 s54, s79, 9728
  buffer_load_dwordx4 v10, s[28:31], s54 offen  lds
  s_add_u32 m0, s57, 106496
  s_add_u32 s54, s79, 37376
  buffer_load_dwordx4 v10, s[28:31], s54 offen  lds
  s_add_u32 m0, s57, 110592
  s_add_u32 s54, s79, 46592
  buffer_load_dwordx4 v10, s[28:31], s54 offen  lds
  s_getpc_b64 s[80:81]
  v_lshlrev_b32 v7, 2, v76
  global_load_dword v19, v7, s[80:81] offset:1024
  v_add_u32 v15, 49152, v11
  v_add_u32 v16, 49152, v12
  ds_read_b64_tr_b16 a[144:145], v15 offset:0
  ds_read_b64_tr_b16 a[146:147], v15 offset:512
  ds_read_b64_tr_b16 a[148:149], v15 offset:8192
  ds_read_b64_tr_b16 a[150:151], v15 offset:8704
  ds_read_b64_tr_b16 a[152:153], v16 offset:0
  ds_read_b64_tr_b16 a[154:155], v16 offset:512
  ds_read_b64_tr_b16 a[156:157], v16 offset:8192
  ds_read_b64_tr_b16 a[158:159], v16 offset:8704
  s_waitcnt vmcnt(13) lgkmcnt(0)
  s_barrier
  s_add_u32 m0, s57, 114688
  s_add_u32 s54, s79, 74240
  buffer_load_dwordx4 v10, s[28:31], s54 offen  lds
  s_add_u32 m0, s57, 118784
  s_add_u32 s54, s79, 83456
  buffer_load_dwordx4 v10, s[28:31], s54 offen  lds
  s_add_u32 m0, s57, 122880
  s_add_u32 s54, s79, 111104
  buffer_load_dwordx4 v10, s[28:31], s54 offen  lds
  s_add_u32 m0, s57, 126976
  s_add_u32 s54, s79, 120320
  buffer_load_dwordx4 v10, s[28:31], s54 offen  lds
  v_add_u32 v15, 65536, v11
  v_add_u32 v16, 65536, v12
  ds_read_b64_tr_b16 a[160:161], v15 offset:0
  ds_read_b64_tr_b16 a[162:163], v15 offset:512
  ds_read_b64_tr_b16 a[164:165], v15 offset:8192
  ds_read_b64_tr_b16 a[166:167], v15 offset:8704
  ds_read_b64_tr_b16 a[168:169], v16 offset:0
  ds_read_b64_tr_b16 a[170:171], v16 offset:512
  ds_read_b64_tr_b16 a[172:173], v16 offset:8192
  ds_read_b64_tr_b16 a[174:175], v16 offset:8704
  s_waitcnt vmcnt(13) lgkmcnt(0)
  s_barrier
  s_add_u32 m0, s57, 131072
  s_add_u32 s54, s79, 74496
  buffer_load_dwordx4 v10, s[28:31], s54 offen  lds
  s_add_u32 m0, s57, 135168
  s_add_u32 s54, s79, 83712
  buffer_load_dwordx4 v10, s[28:31], s54 offen  lds
  s_add_u32 m0, s57, 139264
  s_add_u32 s54, s79, 111360
  buffer_load_dwordx4 v10, s[28:31], s54 offen  lds
  s_add_u32 m0, s57, 143360
  s_add_u32 s54, s79, 120576
  buffer_load_dwordx4 v10, s[28:31], s54 offen  lds
  v_add_u32 v15, 81920, v14
  ds_read_b64_tr_b16 a[176:177], v15 offset:0
  ds_read_b64_tr_b16 a[178:179], v15 offset:1024
  ds_read_b64_tr_b16 a[180:181], v15 offset:4096
  ds_read_b64_tr_b16 a[182:183], v15 offset:5120
  ds_read_b64_tr_b16 a[184:185], v15 offset:8192
  ds_read_b64_tr_b16 a[186:187], v15 offset:9216
  ds_read_b64_tr_b16 a[188:189], v15 offset:12288
  ds_read_b64_tr_b16 a[190:191], v15 offset:13312
  s_waitcnt vmcnt(13) lgkmcnt(0)
  s_barrier
  s_add_u32 m0, s57, 0
  s_add_u32 s54, s78, 0
  buffer_load_dwordx4 v8, s[20:23], s54 offen  lds
  s_add_u32 m0, s57, 4096
  s_add_u32 s54, s78, 131072
  buffer_load_dwordx4 v8, s[20:23], s54 offen  lds
  s_add_u32 m0, s57, 8192
  s_add_u32 s54, s78, 262144
  buffer_load_dwordx4 v8, s[20:23], s54 offen  lds
  s_add_u32 m0, s57, 12288
  s_add_u32 s54, s78, 393216
  buffer_load_dwordx4 v8, s[20:23], s54 offen  lds
  v_add_u32 v15, 98304, v14
  ds_read_b64_tr_b16 a[192:193], v15 offset:0
  ds_read_b64_tr_b16 a[194:195], v15 offset:1024
  ds_read_b64_tr_b16 a[196:197], v15 offset:4096
  ds_read_b64_tr_b16 a[198:199], v15 offset:5120
  ds_read_b64_tr_b16 a[200:201], v15 offset:8192
  ds_read_b64_tr_b16 a[202:203], v15 offset:9216
  ds_read_b64_tr_b16 a[204:205], v15 offset:12288
  ds_read_b64_tr_b16 a[206:207], v15 offset:13312
  s_waitcnt vmcnt(13) lgkmcnt(0)
  s_barrier
  s_add_u32 m0, s57, 16384
  s_add_u32 s54, s78, 524288
  buffer_load_dwordx4 v8, s[20:23], s54 offen  lds
  s_add_u32 m0, s57, 20480
  s_add_u32 s54, s78, 655360
  buffer_load_dwordx4 v8, s[20:23], s54 offen  lds
  s_add_u32 m0, s57, 24576
  s_add_u32 s54, s78, 786432
  buffer_load_dwordx4 v8, s[20:23], s54 offen  lds
  s_add_u32 m0, s57, 28672
  s_add_u32 s54, s78, 917504
  buffer_load_dwordx4 v8, s[20:23], s54 offen  lds
  v_add_u32 v15, 114688, v14
  ds_read_b64_tr_b16 a[208:209], v15 offset:0
  ds_read_b64_tr_b16 a[210:211], v15 offset:1024
  ds_read_b64_tr_b16 a[212:213], v15 offset:4096
  ds_read_b64_tr_b16 a[214:215], v15 offset:5120
  ds_read_b64_tr_b16 a[216:217], v15 offset:8192
  ds_read_b64_tr_b16 a[218:219], v15 offset:9216
  ds_read_b64_tr_b16 a[220:221], v15 offset:12288
  ds_read_b64_tr_b16 a[222:223], v15 offset:13312
  s_waitcnt vmcnt(12) lgkmcnt(0)
  s_barrier
  s_add_u32 m0, s57, 32768
  s_add_u32 s54, s78, 2097152
  buffer_load_dwordx4 v8, s[20:23], s54 offen  lds
  s_add_u32 m0, s57, 36864
  s_add_u32 s54, s78, 2228224
  buffer_load_dwordx4 v8, s[20:23], s54 offen  lds
  s_add_u32 m0, s57, 40960
  s_add_u32 s54, s78, 2359296
  buffer_load_dwordx4 v8, s[20:23], s54 offen  lds
  s_add_u32 m0, s57, 45056
  s_add_u32 s54, s78, 2490368
  buffer_load_dwordx4 v8, s[20:23], s54 offen  lds
  v_add_u32 v15, 131072, v14
  ds_read_b64_tr_b16 a[224:225], v15 offset:0
  ds_read_b64_tr_b16 a[226:227], v15 offset:1024
  ds_read_b64_tr_b16 a[228:229], v15 offset:4096
  ds_read_b64_tr_b16 a[230:231], v15 offset:5120
  ds_read_b64_tr_b16 a[232:233], v15 offset:8192
  ds_read_b64_tr_b16 a[234:235], v15 offset:9216
  ds_read_b64_tr_b16 a[236:237], v15 offset:12288
  ds_read_b64_tr_b16 a[238:239], v15 offset:13312
  s_waitcnt vmcnt(12) lgkmcnt(0)
  s_barrier
  s_add_u32 m0, s57, 49152
  s_add_u32 s54, s78, 3145728
  buffer_load_dwordx4 v8, s[16:19], s54 offen  lds
  s_add_u32 m0, s57, 53248
  s_add_u32 s54, s78, 3276800
  buffer_load_dwordx4 v8, s[16:19], s54 offen  lds
  s_add_u32 m0, s57, 57344
  s_add_u32 s54, s78, 3407872
  buffer_load_dwordx4 v8, s[16:19], s54 offen  lds
  s_add_u32 m0, s57, 61440
  s_add_u32 s54, s78, 3538944
  buffer_load_dwordx4 v8, s[16:19], s54 offen  lds
  v_add_u32 v15, 147456, v14
  ds_read_b64_tr_b16 a[240:241], v15 offset:0
  ds_read_b64_tr_b16 a[242:243], v15 offset:1024
  ds_read_b64_tr_b16 a[244:245], v15 offset:4096
  ds_read_b64_tr_b16 a[246:247], v15 offset:5120
  ds_read_b64_tr_b16 a[248:249], v15 offset:8192
  ds_read_b64_tr_b16 a[250:251], v15 offset:9216
  ds_read_b64_tr_b16 a[252:253], v15 offset:12288
  ds_read_b64_tr_b16 a[254:255], v15 offset:13312
  s_waitcnt vmcnt(12) lgkmcnt(0)
  s_barrier
  s_add_u32 m0, s57, 65536
  s_add_u32 s54, s78, 2621440
  buffer_load_dwordx4 v8, s[20:23], s54 offen  lds
  s_add_u32 m0, s57, 69632
  s_add_u32 s54, s78, 2752512
  buffer_load_dwordx4 v8, s[20:23], s54 offen  lds
  s_add_u32 m0, s57, 73728
  s_add_u32 s54, s78, 2883584
  buffer_load_dwordx4 v8, s[20:23], s54 offen  lds
  s_add_u32 m0, s57, 77824
  s_add_u32 s54, s78, 3014656
  buffer_load_dwordx4 v8, s[20:23], s54 offen  lds
  v_add_u32 v15, 16384, v11
  v_add_u32 v16, 16384, v12
  ds_read_b64_tr_b16 v[52:53], v15 offset:0
  ds_read_b64_tr_b16 v[54:55], v15 offset:512
  ds_read_b64_tr_b16 v[56:57], v15 offset:8192
  ds_read_b64_tr_b16 v[58:59], v15 offset:8704
  ds_read_b64_tr_b16 v[60:61], v16 offset:0
  ds_read_b64_tr_b16 v[62:63], v16 offset:512
  ds_read_b64_tr_b16 v[64:65], v16 offset:8192
  ds_read_b64_tr_b16 v[66:67], v16 offset:8704
  s_waitcnt vmcnt(12) lgkmcnt(0)
  s_barrier
  s_lshl_b32 s54, s52, 12
  s_add_u32 s54, s54, 16384
  v_add_u32 v7, s54, v76
  ds_write_b128 v7, v[52:55] offset:0
  ds_write_b128 v7, v[56:59] offset:1024
  ds_write_b128 v7, v[60:63] offset:2048
  ds_write_b128 v7, v[64:67] offset:3072
  s_add_u32 m0, s57, 81920
  s_add_u32 s54, s79, 1024
  buffer_load_dwordx4 v9, s[28:31], s54 offen  lds
  s_add_u32 m0, s57, 86016
  s_add_u32 s54, s79, 37888
  buffer_load_dwordx4 v9, s[28:31], s54 offen  lds
  s_add_u32 m0, s57, 90112
  s_add_u32 s54, s79, 74752
  buffer_load_dwordx4 v9, s[28:31], s54 offen  lds
  s_add_u32 m0, s57, 94208
  s_add_u32 s54, s79, 111616
  buffer_load_dwordx4 v9, s[28:31], s54 offen  lds
  v_add_u32 v15, 32768, v11
  v_add_u32 v16, 32768, v12
  ds_read_b64_tr_b16 v[36:37], v15 offset:0
  ds_read_b64_tr_b16 v[38:39], v15 offset:512
  ds_read_b64_tr_b16 v[40:41], v15 offset:8192
  ds_read_b64_tr_b16 v[42:43], v15 offset:8704
  ds_read_b64_tr_b16 v[44:45], v16 offset:0
  ds_read_b64_tr_b16 v[46:47], v16 offset:512
  ds_read_b64_tr_b16 v[48:49], v16 offset:8192
  ds_read_b64_tr_b16 v[50:51], v16 offset:8704
  s_waitcnt vmcnt(12) lgkmcnt(0)
  s_barrier
  s_lshl_b32 s54, s52, 12
  s_add_u32 s54, s54, 32768
  v_add_u32 v7, s54, v76
  ds_write_b128 v7, v[36:39] offset:0
  ds_write_b128 v7, v[40:43] offset:1024
  ds_write_b128 v7, v[44:47] offset:2048
  ds_write_b128 v7, v[48:51] offset:3072
  s_add_u32 m0, s57, 98304
  s_add_u32 s54, s79, 0
  buffer_load_dwordx4 v10, s[28:31], s54 offen  lds
  s_add_u32 m0, s57, 102400
  s_add_u32 s54, s79, 9216
  buffer_load_dwordx4 v10, s[28:31], s54 offen  lds
  s_add_u32 m0, s57, 106496
  s_add_u32 s54, s79, 36864
  buffer_load_dwordx4 v10, s[28:31], s54 offen  lds
  s_add_u32 m0, s57, 110592
  s_add_u32 s54, s79, 46080
  buffer_load_dwordx4 v10, s[28:31], s54 offen  lds
  v_add_u32 v15, 49152, v11
  v_add_u32 v16, 49152, v12
  ds_read_b64_tr_b16 v[52:53], v15 offset:0
  ds_read_b64_tr_b16 v[54:55], v15 offset:512
  ds_read_b64_tr_b16 v[56:57], v15 offset:8192
  ds_read_b64_tr_b16 v[58:59], v15 offset:8704
  ds_read_b64_tr_b16 v[60:61], v16 offset:0
  ds_read_b64_tr_b16 v[62:63], v16 offset:512
  ds_read_b64_tr_b16 v[64:65], v16 offset:8192
  ds_read_b64_tr_b16 v[66:67], v16 offset:8704
  s_waitcnt vmcnt(12) lgkmcnt(0)
  s_barrier
  s_lshl_b32 s54, s52, 12
  s_add_u32 s54, s54, 49152
  v_add_u32 v7, s54, v76
  ds_write_b128 v7, v[52:55] offset:0
  ds_write_b128 v7, v[56:59] offset:1024
  ds_write_b128 v7, v[60:63] offset:2048
  ds_write_b128 v7, v[64:67] offset:3072
  s_add_u32 m0, s57, 114688
  s_add_u32 s54, s79, 73984
  buffer_load_dwordx4 v10, s[28:31], s54 offen  lds
  s_add_u32 m0, s57, 118784
  s_add_u32 s54, s79, 83200
  buffer_load_dwordx4 v10, s[28:31], s54 offen  lds
  s_add_u32 m0, s57, 122880
  s_add_u32 s54, s79, 110848
  buffer_load_dwordx4 v10, s[28:31], s54 offen  lds
  s_add_u32 m0, s57, 126976
  s_add_u32 s54, s79, 120064
  buffer_load_dwordx4 v10, s[28:31], s54 offen  lds
  v_add_u32 v15, 65536, v11
  v_add_u32 v16, 65536, v12
  ds_read_b64_tr_b16 v[36:37], v15 offset:0
  ds_read_b64_tr_b16 v[38:39], v15 offset:512
  ds_read_b64_tr_b16 v[40:41], v15 offset:8192
  ds_read_b64_tr_b16 v[42:43], v15 offset:8704
  ds_read_b64_tr_b16 v[44:45], v16 offset:0
  ds_read_b64_tr_b16 v[46:47], v16 offset:512
  ds_read_b64_tr_b16 v[48:49], v16 offset:8192
  ds_read_b64_tr_b16 v[50:51], v16 offset:8704
  s_waitcnt vmcnt(12) lgkmcnt(0)
  s_barrier
  s_lshl_b32 s54, s52, 12
  s_add_u32 s54, s54, 65536
  v_add_u32 v7, s54, v76
  ds_write_b128 v7, v[36:39] offset:0
  ds_write_b128 v7, v[40:43] offset:1024
  ds_write_b128 v7, v[44:47] offset:2048
  ds_write_b128 v7, v[48:51] offset:3072
  s_add_u32 m0, s57, 131072
  s_add_u32 s54, s79, 768
  buffer_load_dwordx4 v10, s[28:31], s54 offen  lds
  s_add_u32 m0, s57, 135168
  s_add_u32 s54, s79, 9984
  buffer_load_dwordx4 v10, s[28:31], s54 offen  lds
  s_add_u32 m0, s57, 139264
  s_add_u32 s54, s79, 37632
  buffer_load_dwordx4 v10, s[28:31], s54 offen  lds
  s_add_u32 m0, s57, 143360
  s_add_u32 s54, s79, 46848
  buffer_load_dwordx4 v10, s[28:31], s54 offen  lds
  v_lshlrev_b32 v7, 3, v76
  s_lshl_b32 s54, s52, 13
  s_add_u32 s54, s54, 360448
  s_bitcmp1_b32 s52, 0
  s_cselect_b64 exec, 0xff, -1
  buffer_load_dword v35, v7, s[8:11], s54 offen sc1
  s_mov_b64 exec, -1
  s_getpc_b64 s[80:81]
C_pc:
  s_mov_b32 s55, (L_w0 - C_pc)
  s_cmp_eq_u32 s52, 1
  s_cselect_b32 s55, (L_w1 - C_pc), s55
  s_cmp_eq_u32 s52, 2
  s_cselect_b32 s55, (L_w2 - C_pc), s55
  s_cmp_eq_u32 s52, 3
  s_cselect_b32 s55, (L_w3 - C_pc), s55
  v_lshl_add_u32 v7, v76, 3, s55
  global_load_dword v35, v7, s[80:81]
  v_add_u32 v15, 81920, v11
  v_add_u32 v16, 81920, v12
  ds_read_b64_tr_b16 v[52:53], v15 offset:0
  ds_read_b64_tr_b16 v[54:55], v15 offset:512
  ds_read_b64_tr_b16 v[56:57], v15 offset:8192
  ds_read_b64_tr_b16 v[58:59], v15 offset:8704
  ds_read_b64_tr_b16 v[60:61], v16 offset:0
  ds_read_b64_tr_b16 v[62:63], v16 offset:512
  ds_read_b64_tr_b16 v[64:65], v16 offset:8192
  ds_read_b64_tr_b16 v[66:67], v16 offset:8704
  s_waitcnt vmcnt(14) lgkmcnt(0)
  s_barrier
  s_lshl_b32 s54, s52, 12
  s_add_u32 s54, s54, 81920
  v_add_u32 v7, s54, v76
  ds_write_b128 v7, v[52:55] offset:0
  ds_write_b128 v7, v[56:59] offset:1024
  ds_write_b128 v7, v[60:63] offset:2048
  ds_write_b128 v7, v[64:67] offset:3072
  v_lshrrev_b32 v20, 2, v76
  buffer_load_dword v21, v20, s[12:15], 0 offen sc1
  v_add_u32 v15, 98304, v13
  s_waitcnt lgkmcnt(0)
  ds_read_b64_tr_b16 v[36:37], v15 offset:0
  ds_read_b64_tr_b16 v[38:39], v15 offset:1024
  ds_read_b64_tr_b16 v[40:41], v15 offset:2048
  ds_read_b64_tr_b16 v[42:43], v15 offset:3072
  ds_read_b64_tr_b16 v[44:45], v15 offset:4096
  ds_read_b64_tr_b16 v[46:47], v15 offset:5120
  ds_read_b64_tr_b16 v[48:49], v15 offset:6144
  ds_read_b64_tr_b16 v[50:51], v15 offset:7168
  ds_read_b64_tr_b16 v[52:53], v15 offset:8192
  ds_read_b64_tr_b16 v[54:55], v15 offset:9216
  ds_read_b64_tr_b16 v[56:57], v15 offset:10240
  ds_read_b64_tr_b16 v[58:59], v15 offset:11264
  ds_read_b64_tr_b16 v[60:61], v15 offset:12288
  ds_read_b64_tr_b16 v[62:63], v15 offset:13312
  ds_read_b64_tr_b16 v[64:65], v15 offset:14336
  ds_read_b64_tr_b16 v[66:67], v15 offset:15360
  s_waitcnt vmcnt(11) lgkmcnt(0)
  s_barrier
  s_and_b32 s54, s52, 1
  s_lshl_b32 s54, s54, 13
  s_add_u32 s54, s54, 98304
  v_add_u32 v7, s54, v76
  ds_write_b128 v7, v[36:39] offset:0
  ds_write_b128 v7, v[40:43] offset:1024
  ds_write_b128 v7, v[44:47] offset:2048
  ds_write_b128 v7, v[48:51] offset:3072
  ds_write_b128 v7, v[52:55] offset:4096
  ds_write_b128 v7, v[56:59] offset:5120
  ds_write_b128 v7, v[60:63] offset:6144
  ds_write_b128 v7, v[64:67] offset:7168
  v_add_u32 v15, 114688, v14
  ds_read_b64_tr_b16 v[52:53], v15 offset:0
  ds_read_b64_tr_b16 v[54:55], v15 offset:1024
  ds_read_b64_tr_b16 v[56:57], v15 offset:4096
  ds_read_b64_tr_b16 v[58:59], v15 offset:5120
  ds_read_b64_tr_b16 v[60:61], v15 offset:8192
  ds_read_b64_tr_b16 v[62:63], v15 offset:9216
  ds_read_b64_tr_b16 v[64:65], v15 offset:12288
  ds_read_b64_tr_b16 v[66:67], v15 offset:13312
  s_waitcnt vmcnt(7) lgkmcnt(0)
  s_barrier
  s_lshl_b32 s54, s52, 12
  s_add_u32 s54, s54, 114688
  v_add_u32 v7, s54, v76
  ds_write_b128 v7, v[52:55] offset:0
  ds_write_b128 v7, v[56:59] offset:1024
  ds_write_b128 v7, v[60:63] offset:2048
  ds_write_b128 v7, v[64:67] offset:3072
  v_add_u32 v15, 131072, v14
  ds_read_b64_tr_b16 v[36:37], v15 offset:0
  ds_read_b64_tr_b16 v[38:39], v15 offset:1024
  ds_read_b64_tr_b16 v[40:41], v15 offset:4096
  ds_read_b64_tr_b16 v[42:43], v15 offset:5120
  ds_read_b64_tr_b16 v[44:45], v15 offset:8192
  ds_read_b64_tr_b16 v[46:47], v15 offset:9216
  ds_read_b64_tr_b16 v[48:49], v15 offset:12288
  ds_read_b64_tr_b16 v[50:51], v15 offset:13312
  s_waitcnt vmcnt(3) lgkmcnt(0)
  s_barrier
  s_lshl_b32 s54, s52, 12
  s_add_u32 s54, s54, 131072
  v_add_u32 v7, s54, v76
  ds_write_b128 v7, v[36:39] offset:0
  ds_write_b128 v7, v[40:43] offset:1024
  ds_write_b128 v7, v[44:47] offset:2048
  ds_write_b128 v7, v[48:51] offset:3072
  v_add_u32 v15, 147456, v14
  ds_read_b64_tr_b16 v[52:53], v15 offset:0
  ds_read_b64_tr_b16 v[54:55], v15 offset:1024
  ds_read_b64_tr_b16 v[56:57], v15 offset:4096
  ds_read_b64_tr_b16 v[58:59], v15 offset:5120
  ds_read_b64_tr_b16 v[60:61], v15 offset:8192
  ds_read_b64_tr_b16 v[62:63], v15 offset:9216
  ds_read_b64_tr_b16 v[64:65], v15 offset:12288
  ds_read_b64_tr_b16 v[66:67], v15 offset:13312
  s_waitcnt vmcnt(0) lgkmcnt(0)
  s_barrier
  s_lshl_b32 s54, s52, 12
  s_add_u32 s54, s54, 147456
  v_add_u32 v7, s54, v76
  ds_write_b128 v7, v[52:55] offset:0
  ds_write_b128 v7, v[56:59] offset:1024
  ds_write_b128 v7, v[60:63] offset:2048
  ds_write_b128 v7, v[64:67] offset:3072
  s_waitcnt lgkmcnt(0)
  s_branch C_rd1
C_rd0:
  s_sleep 2
  buffer_load_dword v21, v20, s[12:15], 0 offen sc1
  s_waitcnt vmcnt(0)
C_rd1:
  v_and_b32 v22, 0xff, v21
  v_cmp_gt_u32 vcc, 7, v22
  v_readlane_b32 s56, v21, 0
  s_mov_b32 s3, 1
  s_add_u32 s67, s67, 1
  s_cmp_ge_u32 s67, 131072
  s_cbranch_scc1 C_rd2
  s_cmp_lg_u32 vcc_hi, 0
  s_cbranch_scc1 C_rd0
  s_mov_b32 s3, 0
  s_cmp_eq_u32 s56, -1
  s_cbranch_scc1 C_rd2
  s_mov_b32 s3, 1
  v_readlane_b32 s54, v21, 10
  v_readlane_b32 s55, v21, 0
  s_nop 0
  s_bcnt1_i32_b32 s55, s55
  s_add_u32 s54, s54, s55
  v_readlane_b32 s55, v21, 1
  s_nop 0
  s_bcnt1_i32_b32 s55, s55
  s_add_u32 s54, s54, s55
  v_readlane_b32 s55, v21, 2
  s_nop 0
  s_bcnt1_i32_b32 s55, s55
  s_add_u32 s54, s54, s55
  v_readlane_b32 s55, v21, 3
  s_nop 0
  s_bcnt1_i32_b32 s55, s55
  s_add_u32 s54, s54, s55
  v_readlane_b32 s55, v21, 4
  s_nop 0
  s_bcnt1_i32_b32 s55, s55
  s_add_u32 s54, s54, s55
  v_readlane_b32 s55, v21, 5
  s_nop 0
  s_bcnt1_i32_b32 s55, s55
  s_add_u32 s54, s54, s55
  v_readlane_b32 s55, v21, 6
  s_nop 0
  s_bcnt1_i32_b32 s55, s55
  s_add_u32 s54, s54, s55
  v_readlane_b32 s55, v21, 7
  s_nop 0
  s_bcnt1_i32_b32 s55, s55
  s_add_u32 s54, s54, s55
  s_cmp_lt_u32 s54, 256
  s_cbranch_scc1 C_rd0
C_rd2:
  s_lshl_b32 s54, s3, 2
  s_add_u32 s54, s54, s52
  s_cmp_eq_u32 s54, 1
  s_cbranch_scc1 L_w1
  s_cmp_eq_u32 s54, 2
  s_cbranch_scc1 L_w2
  s_cmp_eq_u32 s54, 3
  s_cbranch_scc1 L_w3
  s_cmp_eq_u32 s54, 4
  s_cbranch_scc1 L_w4
  s_cmp_eq_u32 s54, 5
  s_cbranch_scc1 L_w5
  s_cmp_eq_u32 s54, 6
  s_cbranch_scc1 L_w6
  s_cmp_eq_u32 s54, 7
  s_cbranch_scc1 L_w7
L_w0:
  v_mov_b64 v[20:21], 0
  v_mov_b64 v[22:23], 0
  v_mov_b64 v[24:25], 0
  v_mov_b64 v[26:27], 0
  v_mov_b64 v[28:29], 0
  v_mov_b64 v[30:31], 0
  v_mov_b64 v[32:33], 0
  v_mov_b64 v[34:35], 0
  s_mov_b32 s78, 0x3f803f80
  s_mov_b32 s79, s78
  s_mov_b32 s65, 360448
  s_mov_b32 m0, 16128
  s_lshl_b32 s71, s53, 2
  s_add_u32 s71, s71, 128
  s_movk_i32 s56, 0x1000
  v_lshlrev_b32 v73, 2, v76
  v_mov_b32 v72, 0
  s_mov_b64 s[16:17], s[8:9]
  s_mov_b32 s18, 268435456
  s_mov_b32 s19, 0x20000
  s_getpc_b64 s[20:21]
Cf0_pc:
  s_add_u32 s20, s20, (Cf0_last - Cf0_pc)
  s_addc_u32 s21, s21, 0
  v_mov_b32 v68, 14880
  buffer_load_dwordx4 v[52:55], v76, s[8:11], s59 offen offset:0 sc1
  buffer_load_dwordx4 v[56:59], v76, s[8:11], s59 offen offset:1024 sc1
  ds_read_b128 v[36:39], v76 offset:16384
  ds_read_b128 v[40:43], v76 offset:17408
  ds_read_b128 v[60:63], v76 offset:18432
  ds_read_b128 v[64:67], v76 offset:19456
  ds_read_b128 v[0:3], v76 offset:4608
  ds_read_b128 v[4:7], v76 offset:5632
  ds_read_b128 v[8:11], v76 offset:6656
  ds_read_b128 v[12:15], v76 offset:7680
  s_waitcnt lgkmcnt(0)
  s_cmp_eq_u32 s66, 1
  s_branch Cf0_top2
.p2align 6
Cf0_h2:
  s_cmp_eq_u32 s66, 12
  s_cselect_b32 s56, s71, 0x1000
  ds_read_b32 v72, v76 offset:16128
  s_cmp_eq_u32 s66, 13
  s_cselect_b32 s54, 0x700, 0
  s_waitcnt lgkmcnt(0)
  v_readfirstlane_b32 s57, v72
  s_nop 0
  s_cmp_lt_u32 s57, s54
  s_cbranch_scc1 Cf0_kv3
Cf0_kvb:
  buffer_load_dwordx4 v[0:3], v76, s[8:11], s65 offen offset:0 sc1
  ds_read_b128 v[36:39], v76 offset:16384
  s_waitcnt lgkmcnt(0)
  v_mov_b64 v[20:21], 0
  v_mov_b64 v[22:23], 0
  v_mov_b64 v[24:25], 0
  v_mov_b64 v[26:27], 0
  v_mov_b32 v68, 14880
  buffer_load_dwordx4 v[0:3], v76, s[8:11], s65 offen offset:0 sc1
  ds_read_b128 v[40:43], v76 offset:17408
  s_waitcnt lgkmcnt(0)
  s_cmp_eq_u32 s66, 62
  s_cselect_b64 s[16:17], s[20:21], s[16:17]
  s_cselect_b32 s18, (Cf0_done - Cf0_last), s18
  s_cselect_b32 s70, 0, s70
  s_cmp_eq_u32 s66, 63
  s_cselect_b32 s59, 268435456, s59
  s_cselect_b32 s58, 268435456, s58
  buffer_load_dwordx4 v[0:3], v76, s[8:11], s65 offen offset:0 sc1
  ds_read_b128 v[60:63], v76 offset:18432
  s_waitcnt lgkmcnt(0)
  v_lshlrev_b32 v73, 2, v76
  buffer_load_dwordx4 v[52:55], v76, s[8:11], s59 offen offset:0 sc1
  buffer_load_dwordx4 v[56:59], v76, s[8:11], s59 offen offset:1024 sc1
  s_waitcnt vmcnt(4)
  v_max3_u32 v72, v0, v1, v2
  v_max_u32 v72, v72, v3
  ds_write_b128 v76, v[0:3] offset:4608
  v_cmp_eq_u32 vcc, -1, v72
  s_cbranch_vccnz Cf0_h2r
Cf0_h2w:
  s_cmp_eq_u32 s66, 63
  s_waitcnt lgkmcnt(0)
  s_barrier
  ds_read_b128 v[8:11], v76 offset:6656
  buffer_load_dwordx4 v76, s[8:11], s85 offen offset:0 sc1 lds
Cf0_top2:
  v_smfmac_f32_16x16x64_bf16 v[20:23], v[0:3], v[80:87], v74
  s_cbranch_scc1 Cf0_last
  v_smfmac_f32_16x16x64_bf16 v[28:31], v[0:3], v[36:43], v74
  buffer_load_dwordx4 v[44:47], v76, s[8:11], s58 offen offset:0 sc1
  s_mov_b32 m0, 16128
  v_smfmac_f32_16x16x64_bf16 v[24:27], v[0:3], v[88:95], v74
  buffer_load_dwordx4 v[48:51], v76, s[8:11], s58 offen offset:1024 sc1
  v_smfmac_f32_16x16x64_bf16 v[32:35], v[0:3], v[60:67], v74
  ds_read_b128 v[4:7], v76 offset:5632
  s_waitcnt lgkmcnt(1)
  v_smfmac_f32_16x16x64_bf16 v[20:23], v[8:11], v[112:119], v74
  ds_read_b128 v[12:15], v76 offset:7680
  v_smfmac_f32_16x16x64_bf16 v[24:27], v[8:11], v[120:127], v74
  ds_read_b128 v[36:39], v76 offset:32768
  v_smfmac_f32_16x16x64_bf16 v[28:31], v[8:11], v[208:215], v74
  buffer_store_dwordx4 v[16:19], v76, s[8:11], s68 offen sc1
  ds_read_b128 v[40:43], v76 offset:33792
  v_smfmac_f32_16x16x64_bf16 v[32:35], v[8:11], v[216:223], v74
  buffer_load_dword v73, s[16:19], s70 offen lds
  ds_read_b128 v[60:63], v76 offset:34816
  s_waitcnt lgkmcnt(4)
  v_smfmac_f32_16x16x64_bf16 v[20:23], v[4:7], v[96:103], v74
  ds_read_b128 v[64:67], v76 offset:35840
  v_smfmac_f32_16x16x64_bf16 v[24:27], v[4:7], v[104:111], v74
  s_waitcnt vmcnt(5)
  s_waitcnt lgkmcnt(4)
  v_smfmac_f32_16x16x64_bf16 v[20:23], v[12:15], v[128:135], v74
  s_barrier
  ds_read_b128 v[0:3], v76 offset:8704
  s_waitcnt lgkmcnt(3)
  v_smfmac_f32_16x16x64_bf16 v[28:31], v[4:7], v[36:43], v74
  ds_read_b128 v[36:39], v76 offset:49152
  v_smfmac_f32_16x16x64_bf16 v[24:27], v[12:15], v[136:143], v74
  ds_read_b128 v[40:43], v76 offset:50176
  s_waitcnt lgkmcnt(3)
  v_smfmac_f32_16x16x64_bf16 v[32:35], v[4:7], v[60:67], v74
  ds_read_b128 v[8:11], v76 offset:9728
  v_smfmac_f32_16x16x64_bf16 v[28:31], v[12:15], v[224:231], v74
  ds_read_b128 v[60:63], v76 offset:51200
  v_smfmac_f32_16x16x64_bf16 v[32:35], v[12:15], v[232:239], v74
  s_waitcnt vmcnt(4)
  ds_read_b128 v[64:67], v76 offset:52224
  s_waitcnt lgkmcnt(5)
  v_smfmac_f32_16x16x64_bf16 v[20:23], v[0:3], v[144:151], v74
  s_barrier
  ds_read_b128 v[4:7], v76 offset:11776
  s_waitcnt lgkmcnt(4)
  v_smfmac_f32_16x16x64_bf16 v[28:31], v[0:3], v[36:43], v74
  ds_read_b128 v[12:15], v76 offset:12800
  ds_read_b128 v[36:39], v75 offset:0
  v_smfmac_f32_16x16x64_bf16 v[24:27], v[0:3], v[152:159], v74
  ds_read_b128 v[16:19], v76 offset:10752
  s_waitcnt lgkmcnt(6)
  v_smfmac_f32_16x16x64_bf16 v[20:23], v[8:11], v[160:167], v74
  ds_read_b128 v[40:43], v75 offset:1024
  s_waitcnt lgkmcnt(5)
  v_smfmac_f32_16x16x64_bf16 v[32:35], v[0:3], v[60:67], v74
  ds_read_b128 v[60:63], v75 offset:2048
  v_smfmac_f32_16x16x64_bf16 v[24:27], v[8:11], v[168:175], v74
  ds_read_b128 v[64:67], v75 offset:3072
  s_waitcnt lgkmcnt(6)
  v_smfmac_f32_16x16x64_bf16 v[20:23], v[4:7], v[176:183], v74
  buffer_load_dword off, s[12:15], s56 sc1 lds
  s_waitcnt lgkmcnt(5)
  v_smfmac_f32_16x16x64_bf16 v[20:23], v[12:15], v[192:199], v74
  s_waitcnt lgkmcnt(2)
  v_smfmac_f32_16x16x64_bf16 v[20:23], v[16:19], v[36:43], v74
  ds_read_b128 v[36:39], v75 offset:16384
  v_smfmac_f32_16x16x64_bf16 v[24:27], v[4:7], v[184:191], v74
  ds_read_b128 v[40:43], v75 offset:17408
  s_waitcnt lgkmcnt(2)
  v_smfmac_f32_16x16x64_bf16 v[24:27], v[16:19], v[60:67], v74
  ds_read_b128 v[60:63], v75 offset:18432
  v_add_f32 v20, v20, v22
  v_smfmac_f32_16x16x64_bf16 v[24:27], v[12:15], v[200:207], v74
  ds_read_b128 v[64:67], v75 offset:19456
  v_add_f32 v21, v21, v23
  v_smfmac_f32_16x16x64_bf16 v[28:31], v[16:19], v[240:247], v74
  v_mov_b64 v[70:71], s[78:79]
  v_smfmac_f32_16x16x64_bf16 v[28:31], v[4:7], a[0:7], v74
  s_waitcnt lgkmcnt(2)
  v_add_f32 v24, v24, v26
  v_smfmac_f32_16x16x64_bf16 v[28:31], v[8:11], v[36:43], v74
  ds_read_b128 v[36:39], v68
  v_cvt_pk_bf16_f32 v22, v20, v24
  v_smfmac_f32_16x16x64_bf16 v[28:31], v[12:15], a[16:23], v74
  ds_read_b128 v[40:43], v68
  ds_write_b32 v79, v22 offset:0
  s_waitcnt lgkmcnt(3)
  v_add_f32 v25, v25, v27
  v_cvt_pk_bf16_f32 v23, v21, v25
  v_smfmac_f32_16x16x64_bf16 v[32:35], v[8:11], v[60:67], v74
  ds_write_b32 v79, v23 offset:576
  v_cmp_u_f32 vcc, v20, v21
  v_smfmac_f32_16x16x64_bf16 v[32:35], v[16:19], v[248:255], v74
  v_add_f32 v28, v28, v30
  v_smfmac_f32_16x16x64_bf16 v[32:35], v[4:7], a[8:15], v74
  v_add_f32 v29, v29, v31
  v_smfmac_f32_16x16x64_bf16 v[32:35], v[12:15], a[24:31], v74
  s_cbranch_vccnz Cf0_rec
Cf0_recok:
  s_waitcnt lgkmcnt(3)
  v_smfmac_f32_16x16x64_bf16 v[36:39], v[16:19], a[128:135], v74
  s_waitcnt lgkmcnt(0)
  s_barrier
  ds_read_b128 v[60:63], v77
  v_smfmac_f32_16x16x64_bf16 v[40:43], v[16:19], a[136:143], v74
  ds_read_b128 v[64:67], v77 offset:128
  v_add_f32 v32, v32, v34
  v_cvt_pk_bf16_f32 v30, v28, v32
  v_smfmac_f32_16x16x64_bf16 v[36:39], v[0:3], a[96:103], v74
  ds_write_b32 v79, v30 offset:256
  v_add_f32 v33, v33, v35
  v_cvt_pk_bf16_f32 v31, v29, v33
  v_smfmac_f32_16x16x64_bf16 v[40:43], v[0:3], a[104:111], v74
  ds_write_b32 v79, v31 offset:832
  v_xor_b32 v75, 0x8000, v75
  v_smfmac_f32_16x16x64_bf16 v[36:39], v[4:7], a[144:151], v74
  ds_read_b128 v[0:3], v76 offset:4608
  v_mov_b32 v29, 0
  v_smfmac_f32_16x16x64_bf16 v[40:43], v[4:7], a[152:159], v74
  s_waitcnt vmcnt(3) lgkmcnt(3)
  v_mov_b32 v30, 0
  v_mfma_f32_16x16x32_bf16 v[44:47], v[44:47], v[60:63], 0
  ds_read_b128 v[4:7], v76 offset:5632
  s_waitcnt lgkmcnt(2)
  v_mfma_f32_16x16x32_bf16 v[44:47], v[48:51], v[64:67], v[44:47]
  s_barrier
  v_smfmac_f32_16x16x64_bf16 v[36:39], v[8:11], a[112:119], v74
  ds_read_b128 v[20:23], v77 offset:256
  ds_read_b128 v[24:27], v77 offset:384
  v_smfmac_f32_16x16x64_bf16 v[40:43], v[8:11], a[120:127], v74
  ds_read_b128 v[8:11], v76 offset:6656
  v_add_f32_dpp v72, v46, v44 quad_perm:[2,3,0,1] row_mask:0xf bank_mask:0xf
  v_add_f32_dpp v73, v47, v45 quad_perm:[2,3,0,1] row_mask:0xf bank_mask:0xf
  v_smfmac_f32_16x16x64_bf16 v[36:39], v[12:15], a[160:167], v74
  s_waitcnt lgkmcnt(4)
  v_exp_f32_dpp v72, v72 quad_perm:[0,1,0,1] row_mask:0xf bank_mask:0xf
  v_smfmac_f32_16x16x64_bf16 v[40:43], v[12:15], a[168:175], v74
  ds_read_b128 v[12:15], v76 offset:7680
  v_exp_f32_dpp v73, v73 quad_perm:[0,1,0,1] row_mask:0xf bank_mask:0xf
  v_smfmac_f32_16x16x64_bf16 v[36:39], v[0:3], a[32:39], v74
  s_waitcnt lgkmcnt(2)
  v_cvt_pk_bf16_f32 v72, v72, v73
  v_mfma_f32_16x16x32_bf16 v[20:23], v[20:23], v[60:63], 0
  ds_write_b32 v78, v72 offset:512
  v_mov_b64 v[16:17], 0
  v_mfma_f32_16x16x32_bf16 v[20:23], v[24:27], v[64:67], v[20:23]
  ds_read_b128 v[44:47], v75 offset:16384
  v_mov_b64 v[18:19], 0
  v_smfmac_f32_16x16x64_bf16 v[40:43], v[0:3], a[40:47], v74
  ds_read_b128 v[48:51], v75 offset:17408
  v_mov_b64 v[68:69], s[78:79]
  v_smfmac_f32_16x16x64_bf16 v[36:39], v[4:7], a[48:55], v74
  s_waitcnt lgkmcnt(4)
  v_add_f32_dpp v24, v22, v20 quad_perm:[2,3,0,1] row_mask:0xf bank_mask:0xf
  v_add_f32_dpp v25, v23, v21 quad_perm:[2,3,0,1] row_mask:0xf bank_mask:0xf
  v_smfmac_f32_16x16x64_bf16 v[36:39], v[8:11], a[64:71], v74
  s_waitcnt lgkmcnt(2)
  s_barrier
  ds_read_b128 v[32:35], v78 offset:512
  v_smfmac_f32_16x16x64_bf16 v[36:39], v[12:15], a[80:87], v74
  ds_read_b128 v[60:63], v75 offset:18432
  v_mul_f32 v24, s69, v24
  v_smfmac_f32_16x16x64_bf16 v[40:43], v[4:7], a[56:63], v74
  ds_read_b128 v[64:67], v75 offset:19456
  v_mul_f32 v25, s69, v25
  v_smfmac_f32_16x16x64_bf16 v[40:43], v[8:11], a[72:79], v74
  v_exp_f32_dpp v24, v24 quad_perm:[0,1,0,1] row_mask:0xf bank_mask:0xf
  v_smfmac_f32_16x16x64_bf16 v[40:43], v[12:15], a[88:95], v74
  s_waitcnt lgkmcnt(2)
  v_exp_f32_dpp v25, v25 quad_perm:[0,1,0,1] row_mask:0xf bank_mask:0xf
  v_mfma_f32_16x16x32_bf16 v[8:11], v[32:35], v[68:71], 0
  v_add_f32 v36, v36, v38
  v_add_f32 v37, v37, v39
  v_mfma_f32_16x16x32_bf16 v[0:3], v[32:35], v[52:55], 0
  v_add_f32 v40, v40, v42
  v_add_f32 v41, v41, v43
  v_mfma_f32_16x16x32_bf16 v[4:7], v[32:35], v[56:59], 0
  v_cvt_pk_bf16_f32 v28, v24, v25
  v_cvt_pk_bf16_f32 v72, v36, v37
  v_cvt_pk_bf16_f32 v73, v40, v41
  v_mfma_f32_16x16x16_bf16 v[8:11], v[28:29], v[68:69], v[8:11]
  v_cvt_pk_bf16_f32 v31, v24, v25
  v_mov_b64 v[20:21], 0
  v_mfma_f32_16x16x16_bf16 v[0:3], v[28:29], v[72:73], v[0:3]
  ds_read_b128 v[52:55], v75 offset:32768
  v_mov_b64 v[22:23], 0
  v_mfma_f32_16x16x16_bf16 v[4:7], v[30:31], v[72:73], v[4:7]
  v_rcp_f32 v10, v8
  v_rcp_f32 v11, v9
  v_mul_f32 v0, v10, v0
  v_mul_f32 v1, v11, v1
  v_max3_f32 v8, v8, v9, v10
  v_mul_f32 v4, v10, v4
  v_mul_f32 v5, v11, v5
  v_cvt_pk_bf16_f32 v2, v0, v4
  ds_write_b32 v79, v2 offset:8704
  v_cvt_pk_bf16_f32 v3, v1, v5
  ds_write_b32 v79, v3 offset:9280
  ds_read_b128 v[12:15], v78 offset:8704
  v_max_f32 v8, v8, v11
  v_cmp_le_f32 vcc, 1317011456, v8
  v_mov_b64 v[24:25], 0
  v_mov_b64 v[26:27], 0
  ds_read_b128 v[56:59], v75 offset:33792
  s_cbranch_vccnz Cf0_mx
Cf0_mxok:
  s_waitcnt lgkmcnt(2)
  s_barrier
  ds_read_b128 v[0:3], v78 offset:8768
  s_waitcnt lgkmcnt(2)
  v_smfmac_f32_16x16x64_bf16 v[16:19], v[12:15], v[44:51], v74
  ds_read_b128 v[4:7], v78 offset:8832
  v_smfmac_f32_16x16x64_bf16 v[20:23], v[12:15], a[192:199], v74
  ds_read_b128 v[8:11], v78 offset:8896
  v_smfmac_f32_16x16x64_bf16 v[24:27], v[12:15], a[208:215], v74
  ds_read_b128 v[36:39], v75 offset:34816
  s_waitcnt lgkmcnt(3)
  v_smfmac_f32_16x16x64_bf16 v[16:19], v[0:3], v[60:67], v74
  ds_read_b128 v[40:43], v75 offset:35840
  s_waitcnt lgkmcnt(3)
  v_smfmac_f32_16x16x64_bf16 v[16:19], v[4:7], a[176:183], v74
  ds_read_b128 v[68:71], v76 offset:13824
  s_waitcnt lgkmcnt(3)
  v_smfmac_f32_16x16x64_bf16 v[16:19], v[8:11], a[184:191], v74
  ds_read_b128 v[44:47], v75 offset:49152
  v_smfmac_f32_16x16x64_bf16 v[20:23], v[0:3], a[200:207], v74
  ds_read_b128 v[48:51], v75 offset:50176
  v_smfmac_f32_16x16x64_bf16 v[20:23], v[4:7], v[52:59], v74
  ds_read_b128 v[60:63], v75 offset:51200
  s_waitcnt lgkmcnt(4)
  v_cvt_pk_bf16_f32 v16, v16, v17
  v_cvt_pk_bf16_f32 v17, v18, v19
  v_bfi_b32 v16, 1, s72, v16
  v_smfmac_f32_16x16x64_bf16 v[20:23], v[8:11], v[36:43], v74
  s_waitcnt lgkmcnt(3)
  buffer_store_dwordx2 v[16:17], v68, s[8:11], s73 offen
  v_mov_b64 v[32:33], 0
  v_smfmac_f32_16x16x64_bf16 v[24:27], v[0:3], a[216:223], v74
  ds_read_b128 v[64:67], v75 offset:52224
  v_mov_b64 v[34:35], 0
  v_smfmac_f32_16x16x64_bf16 v[24:27], v[4:7], a[224:231], v74
  v_cvt_pk_bf16_f32 v20, v20, v21
  v_cvt_pk_bf16_f32 v21, v22, v23
  v_bfi_b32 v20, 1, s72, v20
  v_smfmac_f32_16x16x64_bf16 v[24:27], v[8:11], a[232:239], v74
  buffer_store_dwordx2 v[20:21], v68, s[8:11], s74 offen
  s_waitcnt lgkmcnt(2)
  v_smfmac_f32_16x16x64_bf16 v[32:35], v[12:15], v[44:51], v74
  s_waitcnt lgkmcnt(0)
  v_smfmac_f32_16x16x64_bf16 v[32:35], v[0:3], v[60:67], v74
  v_cvt_pk_bf16_f32 v24, v24, v25
  v_cvt_pk_bf16_f32 v25, v26, v27
  v_bfi_b32 v24, 1, s72, v24
  v_smfmac_f32_16x16x64_bf16 v[32:35], v[4:7], a[240:247], v74
  buffer_store_dwordx2 v[24:25], v68, s[8:11], s75 offen
  v_smfmac_f32_16x16x64_bf16 v[32:35], v[8:11], a[248:255], v74
  v_mov_b64 v[18:19], v[72:73]
  s_nop 4
  v_cvt_pk_bf16_f32 v32, v32, v33
  v_cvt_pk_bf16_f32 v33, v34, v35
  v_bfi_b32 v32, 1, s72, v32
  buffer_store_dwordx2 v[32:33], v68, s[8:11], s76 offen
  ds_read_b128 v[0:3], v76 offset:14848
  s_waitcnt lgkmcnt(0)
  ds_read_b64 v[16:17], v77 offset:256
  s_waitcnt lgkmcnt(0)
  ds_read_b128 v[64:67], v76 offset:19456
  s_waitcnt lgkmcnt(0)
  v_xor_b32 v75, 0x8000, v75
  v_mov_b64 v[28:29], 0
  v_mov_b64 v[30:31], 0
  v_mov_b64 v[32:33], 0
  v_mov_b64 v[34:35], 0
  buffer_load_dwordx4 v[52:55], v76, s[8:11], s60 offen offset:0 sc1
  buffer_load_dwordx4 v[56:59], v76, s[8:11], s60 offen offset:1024 sc1
  s_add_u32 s66, s66, 1
  s_xor_b32 s64, s64, 16384
  s_xor_b32 s65, s65, 16384
  s_add_u32 s58, s58, 655360
  s_add_u32 s59, s59, 655360
  s_add_u32 s70, s70, 655360
  s_add_u32 s68, s68, 655360
  s_mov_b32 m0, 10752
  s_add_u32 s85, s65, 6144
  s_waitcnt lgkmcnt(0)
  s_waitcnt vmcnt(1)
  v_mfma_f32_16x16x32_bf16 v[4:7], v[0:3], v[52:55], 0
  v_bitop3_b32 v72, v52, v54, s72 bitop3:0x7e
  s_waitcnt vmcnt(0)
  v_mfma_f32_16x16x32_bf16 v[4:7], v[0:3], v[56:59], v[4:7]
  v_bitop3_b32 v73, v56, v58, s72 bitop3:0x7e
  v_bitop3_b32 v72, v72, v73, 1 bitop3:0xa8
  v_cmp_ne_u32 vcc, 0, v72
  s_nop 3
  v_add_f32_dpp v4, v4, v4 row_ror:4 row_mask:0xf bank_mask:0xf
  v_add_f32_dpp v5, v5, v5 row_ror:4 row_mask:0xf bank_mask:0xf
  s_cmp_eq_u64 vcc, 0
  v_add_f32_dpp v4, v4, v4 row_ror:8 row_mask:0xf bank_mask:0xf
  v_add_f32_dpp v5, v5, v5 row_ror:8 row_mask:0xf bank_mask:0xf
  s_cselect_b32 s54, s62, 268435456
  v_cvt_pk_bf16_f32 v4, v4, v5
  buffer_store_dword v4, v69, s[8:11], s54 offen
  s_cbranch_vccnz Cf0_h1r
  s_xor_b32 s62, s62, 16384
  buffer_store_dword v71, v69, s[8:11], s62 offen
  s_xor_b32 s72, s72, 1
  s_branch Cf0_h2
Cf0_h1r:
  s_mov_b64 exec, vcc
  buffer_load_dwordx4 v[52:55], v76, s[8:11], s60 offen offset:0 sc1
  buffer_load_dwordx4 v[56:59], v76, s[8:11], s60 offen offset:1024 sc1
  s_mov_b64 exec, -1
  s_add_u32 s67, s67, 1
  s_waitcnt vmcnt(1)
  v_mfma_f32_16x16x32_bf16 v[4:7], v[0:3], v[52:55], 0
  v_bitop3_b32 v72, v52, v54, s72 bitop3:0x7e
  s_waitcnt vmcnt(0)
  v_mfma_f32_16x16x32_bf16 v[4:7], v[0:3], v[56:59], v[4:7]
  v_bitop3_b32 v73, v56, v58, s72 bitop3:0x7e
  v_bitop3_b32 v72, v72, v73, 1 bitop3:0xa8
  v_cmp_ne_u32 vcc, 0, v72
  s_cbranch_vccz Cf0_h1p
Cf0_h1s:
  s_mov_b64 exec, vcc
  buffer_load_dwordx4 v[52:55], v76, s[8:11], s60 offen offset:0 sc1
  buffer_load_dwordx4 v[56:59], v76, s[8:11], s60 offen offset:1024 sc1
  s_mov_b64 exec, -1
  s_add_u32 s67, s67, 1
  s_waitcnt vmcnt(1)
  v_mfma_f32_16x16x32_bf16 v[4:7], v[0:3], v[52:55], 0
  v_bitop3_b32 v72, v52, v54, s72 bitop3:0x7e
  s_waitcnt vmcnt(0)
  v_mfma_f32_16x16x32_bf16 v[4:7], v[0:3], v[56:59], v[4:7]
  v_bitop3_b32 v73, v56, v58, s72 bitop3:0x7e
  v_bitop3_b32 v72, v72, v73, 1 bitop3:0xa8
  v_cmp_ne_u32 vcc, 0, v72
  s_cbranch_vccz Cf0_h1p
  s_cmp_lt_u32 s67, 131072
  s_cbranch_scc1 Cf0_h1s
Cf0_h1p:
  s_nop 2
  v_add_f32_dpp v4, v4, v4 row_ror:4 row_mask:0xf bank_mask:0xf
  v_add_f32_dpp v5, v5, v5 row_ror:4 row_mask:0xf bank_mask:0xf
  s_nop 0
  v_add_f32_dpp v4, v4, v4 row_ror:8 row_mask:0xf bank_mask:0xf
  v_add_f32_dpp v5, v5, v5 row_ror:8 row_mask:0xf bank_mask:0xf
  v_cvt_pk_bf16_f32 v4, v4, v5
  buffer_store_dword v4, v69, s[8:11], s62 offen
  s_xor_b32 s62, s62, 16384
  buffer_store_dword v71, v69, s[8:11], s62 offen
  s_xor_b32 s72, s72, 1
  s_branch Cf0_h2
Cf0_h2r:
  s_mov_b64 exec, vcc
  buffer_load_dwordx4 v[0:3], v76, s[8:11], s65 offen offset:0 sc1
  s_mov_b64 exec, -1
  s_add_u32 s67, s67, 1
  s_waitcnt vmcnt(4)
  v_max3_u32 v72, v0, v1, v2
  v_max_u32 v72, v72, v3
  ds_write_b128 v76, v[0:3] offset:4608
  v_cmp_eq_u32 vcc, -1, v72
  s_cbranch_vccz Cf0_h2w
  s_mov_b64 exec, vcc
  buffer_load_dwordx4 v[0:3], v76, s[8:11], s65 offen offset:0 sc1
  s_mov_b64 exec, -1
  s_add_u32 s67, s67, 1
  s_waitcnt vmcnt(4)
  v_max3_u32 v72, v0, v1, v2
  v_max_u32 v72, v72, v3
  ds_write_b128 v76, v[0:3] offset:4608
  v_cmp_eq_u32 vcc, -1, v72
  s_cbranch_vccz Cf0_h2w
Cf0_h2s:
  s_mov_b64 exec, vcc
  buffer_load_dwordx4 v[0:3], v76, s[8:11], s65 offen offset:0 sc1
  s_mov_b64 exec, -1
  s_add_u32 s67, s67, 1
  s_waitcnt vmcnt(2)
  v_max3_u32 v72, v0, v1, v2
  v_max_u32 v72, v72, v3
  ds_write_b128 v76, v[0:3] offset:4608
  v_cmp_eq_u32 vcc, -1, v72
  s_cbranch_vccz Cf0_h2w
  s_mov_b64 exec, vcc
  buffer_load_dwordx4 v[0:3], v76, s[8:11], s65 offen offset:0 sc1
  s_mov_b64 exec, -1
  s_add_u32 s67, s67, 1
  s_waitcnt vmcnt(2)
  v_max3_u32 v72, v0, v1, v2
  v_max_u32 v72, v72, v3
  ds_write_b128 v76, v[0:3] offset:4608
  v_cmp_eq_u32 vcc, -1, v72
  s_cbranch_vccz Cf0_h2w
  s_mov_b64 exec, vcc
  buffer_load_dwordx4 v[0:3], v76, s[8:11], s65 offen offset:0 sc1
  s_mov_b64 exec, -1
  s_add_u32 s67, s67, 1
  s_waitcnt vmcnt(2)
  v_max3_u32 v72, v0, v1, v2
  v_max_u32 v72, v72, v3
  ds_write_b128 v76, v[0:3] offset:4608
  v_cmp_eq_u32 vcc, -1, v72
  s_cbranch_vccz Cf0_h2w
  s_cmp_lt_u32 s67, 131072
  s_cbranch_scc1 Cf0_h2s
  s_branch Cf0_h2w
Cf0_rec:
  s_nop 7
  s_waitcnt vmcnt(0) lgkmcnt(0)
  v_max3_u32 v72, v0, v1, v2
  v_max3_u32 v72, v72, v3, v4
  v_max3_u32 v72, v72, v5, v6
  v_max3_u32 v72, v72, v7, v8
  v_max3_u32 v72, v72, v9, v10
  v_max3_u32 v72, v72, v11, v12
  v_max3_u32 v72, v72, v13, v14
  v_max3_u32 v72, v72, v15, v16
  v_max3_u32 v72, v72, v17, v18
  v_max_u32 v72, v72, v19
  v_cmp_eq_u32 vcc, -1, v72
  s_cbranch_vccz Cf0_recok
  s_barrier
  v_mov_b64 v[20:21], 0
  v_mov_b64 v[22:23], 0
  v_mov_b64 v[24:25], 0
  v_mov_b64 v[26:27], 0
  v_mov_b64 v[28:29], 0
  v_mov_b64 v[30:31], 0
  v_mov_b64 v[32:33], 0
  v_mov_b64 v[34:35], 0
  s_waitcnt lgkmcnt(0)
  s_barrier
  ds_read_b128 v[0:3], v76 offset:4608
  s_waitcnt lgkmcnt(0)
  v_smfmac_f32_16x16x64_bf16 v[20:23], v[0:3], v[80:87], v74
  v_smfmac_f32_16x16x64_bf16 v[24:27], v[0:3], v[88:95], v74
  ds_read_b128 v[60:63], v76 offset:16384
  ds_read_b128 v[64:67], v76 offset:17408
  s_waitcnt lgkmcnt(0)
  v_smfmac_f32_16x16x64_bf16 v[28:31], v[0:3], v[60:67], v74
  ds_read_b128 v[60:63], v76 offset:18432
  ds_read_b128 v[64:67], v76 offset:19456
  s_waitcnt lgkmcnt(0)
  v_smfmac_f32_16x16x64_bf16 v[32:35], v[0:3], v[60:67], v74
  ds_read_b128 v[4:7], v76 offset:5632
  s_waitcnt lgkmcnt(0)
  v_smfmac_f32_16x16x64_bf16 v[20:23], v[4:7], v[96:103], v74
  v_smfmac_f32_16x16x64_bf16 v[24:27], v[4:7], v[104:111], v74
  ds_read_b128 v[60:63], v76 offset:32768
  ds_read_b128 v[64:67], v76 offset:33792
  s_waitcnt lgkmcnt(0)
  v_smfmac_f32_16x16x64_bf16 v[28:31], v[4:7], v[60:67], v74
  ds_read_b128 v[60:63], v76 offset:34816
  ds_read_b128 v[64:67], v76 offset:35840
  s_waitcnt lgkmcnt(0)
  v_smfmac_f32_16x16x64_bf16 v[32:35], v[4:7], v[60:67], v74
  ds_read_b128 v[8:11], v76 offset:6656
  s_waitcnt lgkmcnt(0)
  v_smfmac_f32_16x16x64_bf16 v[20:23], v[8:11], v[112:119], v74
  v_smfmac_f32_16x16x64_bf16 v[24:27], v[8:11], v[120:127], v74
  v_smfmac_f32_16x16x64_bf16 v[28:31], v[8:11], v[208:215], v74
  v_smfmac_f32_16x16x64_bf16 v[32:35], v[8:11], v[216:223], v74
  ds_read_b128 v[12:15], v76 offset:7680
  s_waitcnt lgkmcnt(0)
  v_smfmac_f32_16x16x64_bf16 v[20:23], v[12:15], v[128:135], v74
  v_smfmac_f32_16x16x64_bf16 v[24:27], v[12:15], v[136:143], v74
  v_smfmac_f32_16x16x64_bf16 v[28:31], v[12:15], v[224:231], v74
  v_smfmac_f32_16x16x64_bf16 v[32:35], v[12:15], v[232:239], v74
  ds_read_b128 v[0:3], v76 offset:8704
  s_waitcnt lgkmcnt(0)
  v_smfmac_f32_16x16x64_bf16 v[20:23], v[0:3], v[144:151], v74
  v_smfmac_f32_16x16x64_bf16 v[24:27], v[0:3], v[152:159], v74
  ds_read_b128 v[60:63], v76 offset:49152
  ds_read_b128 v[64:67], v76 offset:50176
  s_waitcnt lgkmcnt(0)
  v_smfmac_f32_16x16x64_bf16 v[28:31], v[0:3], v[60:67], v74
  ds_read_b128 v[60:63], v76 offset:51200
  ds_read_b128 v[64:67], v76 offset:52224
  s_waitcnt lgkmcnt(0)
  v_smfmac_f32_16x16x64_bf16 v[32:35], v[0:3], v[60:67], v74
  ds_read_b128 v[8:11], v76 offset:9728
  s_waitcnt lgkmcnt(0)
  v_smfmac_f32_16x16x64_bf16 v[20:23], v[8:11], v[160:167], v74
  v_smfmac_f32_16x16x64_bf16 v[24:27], v[8:11], v[168:175], v74
  ds_read_b128 v[60:63], v75 offset:16384
  ds_read_b128 v[64:67], v75 offset:17408
  s_waitcnt lgkmcnt(0)
  v_smfmac_f32_16x16x64_bf16 v[28:31], v[8:11], v[60:67], v74
  ds_read_b128 v[60:63], v75 offset:18432
  ds_read_b128 v[64:67], v75 offset:19456
  s_waitcnt lgkmcnt(0)
  v_smfmac_f32_16x16x64_bf16 v[32:35], v[8:11], v[60:67], v74
  ds_read_b128 v[16:19], v76 offset:10752
  ds_read_b128 v[60:63], v75 offset:0
  ds_read_b128 v[64:67], v75 offset:1024
  s_waitcnt lgkmcnt(0)
  v_smfmac_f32_16x16x64_bf16 v[20:23], v[16:19], v[60:67], v74
  ds_read_b128 v[60:63], v75 offset:2048
  ds_read_b128 v[64:67], v75 offset:3072
  s_waitcnt lgkmcnt(0)
  v_smfmac_f32_16x16x64_bf16 v[24:27], v[16:19], v[60:67], v74
  v_smfmac_f32_16x16x64_bf16 v[28:31], v[16:19], v[240:247], v74
  v_smfmac_f32_16x16x64_bf16 v[32:35], v[16:19], v[248:255], v74
  ds_read_b128 v[4:7], v76 offset:11776
  s_waitcnt lgkmcnt(0)
  v_smfmac_f32_16x16x64_bf16 v[20:23], v[4:7], v[176:183], v74
  v_smfmac_f32_16x16x64_bf16 v[24:27], v[4:7], v[184:191], v74
  v_smfmac_f32_16x16x64_bf16 v[28:31], v[4:7], a[0:7], v74
  v_smfmac_f32_16x16x64_bf16 v[32:35], v[4:7], a[8:15], v74
  ds_read_b128 v[12:15], v76 offset:12800
  s_waitcnt lgkmcnt(0)
  v_smfmac_f32_16x16x64_bf16 v[20:23], v[12:15], v[192:199], v74
  v_smfmac_f32_16x16x64_bf16 v[24:27], v[12:15], v[200:207], v74
  v_smfmac_f32_16x16x64_bf16 v[28:31], v[12:15], a[16:23], v74
  v_smfmac_f32_16x16x64_bf16 v[32:35], v[12:15], a[24:31], v74
  v_add_f32 v20, v20, v22
  v_add_f32 v21, v21, v23
  v_add_f32 v24, v24, v26
  v_cvt_pk_bf16_f32 v22, v20, v24
  ds_write_b32 v79, v22 offset:0
  v_add_f32 v25, v25, v27
  v_cvt_pk_bf16_f32 v23, v21, v25
  ds_write_b32 v79, v23 offset:576
  v_add_f32 v28, v28, v30
  v_add_f32 v29, v29, v31
  s_waitcnt lgkmcnt(0)
  s_nop 1
  s_branch Cf0_recok
Cf0_mx:
  s_waitcnt lgkmcnt(0)
  s_barrier
  buffer_load_dwordx4 v[52:55], v76, s[8:11], s59 offen offset:0 sc1
  buffer_load_dwordx4 v[0:3], v76, s[8:11], s58 offen offset:0 sc1
  ds_read_b128 v[20:23], v77 offset:0
  ds_read_b128 v[28:31], v77 offset:256
  buffer_load_dwordx4 v[56:59], v76, s[8:11], s59 offen offset:1024 sc1
  buffer_load_dwordx4 v[4:7], v76, s[8:11], s58 offen offset:1024 sc1
  ds_read_b128 v[24:27], v77 offset:128
  ds_read_b128 v[32:35], v77 offset:384
  s_waitcnt vmcnt(2) lgkmcnt(3)
  v_mfma_f32_16x16x32_bf16 v[8:11], v[0:3], v[20:23], 0
  s_waitcnt vmcnt(0) lgkmcnt(1)
  v_mfma_f32_16x16x32_bf16 v[8:11], v[4:7], v[24:27], v[8:11]
  v_mfma_f32_16x16x32_bf16 v[12:15], v[28:31], v[20:23], 0
  s_waitcnt lgkmcnt(0)
  v_mfma_f32_16x16x32_bf16 v[12:15], v[32:35], v[24:27], v[12:15]
  v_add_f32_dpp v8, v10, v8 quad_perm:[2,3,0,1] row_mask:0xf bank_mask:0xf
  v_add_f32_dpp v9, v11, v9 quad_perm:[2,3,0,1] row_mask:0xf bank_mask:0xf
  s_nop 0
  v_mov_b32_dpp v8, v8 quad_perm:[0,1,0,1] row_mask:0xf bank_mask:0xf
  v_mov_b32_dpp v9, v9 quad_perm:[0,1,0,1] row_mask:0xf bank_mask:0xf
  s_nop 1
  v_add_f32_dpp v12, v14, v12 quad_perm:[2,3,0,1] row_mask:0xf bank_mask:0xf
  v_add_f32_dpp v13, v15, v13 quad_perm:[2,3,0,1] row_mask:0xf bank_mask:0xf
  s_nop 0
  v_mov_b32_dpp v12, v12 quad_perm:[0,1,0,1] row_mask:0xf bank_mask:0xf
  v_mov_b32_dpp v13, v13 quad_perm:[0,1,0,1] row_mask:0xf bank_mask:0xf
  v_mul_f32 v12, s69, v12
  ds_write_b32 v78, v8 offset:8704
  v_mul_f32 v13, s69, v13
  ds_write_b32 v78, v9 offset:8768
  s_waitcnt lgkmcnt(0)
  s_barrier
  ds_read_b128 v[36:39], v78 offset:8704
  ds_read_b128 v[40:43], v78 offset:8768
  s_waitcnt lgkmcnt(0)
  s_barrier
  v_max_f32 v16, v36, v37
  v_max3_f32 v16, v16, v38, v39
  v_max3_f32 v16, v16, v40, v41
  v_max3_f32 v16, v16, v42, v43
  v_max3_f32 v16, v16, v12, v13
  v_mov_b32 v17, v16
  s_nop 1
  v_permlane16_swap_b32 v16, v17
  v_max_f32 v16, v16, v17
  v_mov_b32 v17, v16
  s_nop 1
  v_permlane32_swap_b32 v16, v17
  v_max_f32 v16, v16, v17
  v_sub_f32 v36, v36, v16
  v_sub_f32 v37, v37, v16
  v_sub_f32 v38, v38, v16
  v_sub_f32 v39, v39, v16
  v_sub_f32 v40, v40, v16
  v_sub_f32 v41, v41, v16
  v_sub_f32 v42, v42, v16
  v_sub_f32 v43, v43, v16
  v_sub_f32 v12, v12, v16
  v_sub_f32 v13, v13, v16
  v_exp_f32 v36, v36
  v_exp_f32 v37, v37
  v_exp_f32 v38, v38
  v_exp_f32 v39, v39
  v_exp_f32 v40, v40
  v_exp_f32 v41, v41
  v_exp_f32 v42, v42
  v_exp_f32 v43, v43
  v_exp_f32 v12, v12
  v_exp_f32 v13, v13
  v_cvt_pk_bf16_f32 v32, v36, v40
  v_cvt_pk_bf16_f32 v33, v37, v41
  v_cvt_pk_bf16_f32 v34, v38, v42
  v_cvt_pk_bf16_f32 v35, v39, v43
  v_cvt_pk_bf16_f32 v28, v12, v13
  v_cvt_pk_bf16_f32 v31, v12, v13
  v_mov_b32 v29, 0
  v_mov_b32 v30, 0
  v_mfma_f32_16x16x32_bf16 v[8:11], v[32:35], v[68:71], 0
  v_mfma_f32_16x16x32_bf16 v[0:3], v[32:35], v[52:55], 0
  v_mfma_f32_16x16x32_bf16 v[4:7], v[32:35], v[56:59], 0
  v_mfma_f32_16x16x16_bf16 v[8:11], v[28:29], v[68:69], v[8:11]
  v_mfma_f32_16x16x16_bf16 v[0:3], v[28:29], v[72:73], v[0:3]
  v_mfma_f32_16x16x16_bf16 v[4:7], v[30:31], v[72:73], v[4:7]
  ds_read_b128 v[52:55], v75 offset:32768
  v_rcp_f32 v10, v8
  v_rcp_f32 v11, v9
  v_mul_f32 v0, v10, v0
  v_mul_f32 v1, v11, v1
  v_max3_f32 v8, v8, v9, v10
  v_mul_f32 v4, v10, v4
  v_mul_f32 v5, v11, v5
  v_cvt_pk_bf16_f32 v2, v0, v4
  ds_write_b32 v79, v2 offset:8704
  v_cvt_pk_bf16_f32 v3, v1, v5
  ds_write_b32 v79, v3 offset:9280
  ds_read_b128 v[12:15], v78 offset:8704
  ds_read_b128 v[56:59], v75 offset:33792
  v_mov_b64 v[16:17], 0
  v_mov_b64 v[18:19], 0
  v_mov_b64 v[20:21], 0
  v_mov_b64 v[22:23], 0
  v_mov_b64 v[24:25], 0
  v_mov_b64 v[26:27], 0
  s_branch Cf0_mxok
Cf0_kv3:
  s_waitcnt lgkmcnt(0)
  s_cmp_ge_u32 s57, 0x700
  s_cbranch_scc1 Cf0_kvb
  s_load_dword s57, s[12:13], s71 glc
  s_add_u32 s67, s67, 1
  s_cmp_lt_u32 s67, 131072
  s_cbranch_scc1 Cf0_kv3
  s_waitcnt lgkmcnt(0)
  s_branch Cf0_kvb
Cf0_last:
  ds_read_b128 v[4:7], v76 offset:5632
  ds_read_b128 v[12:15], v76 offset:7680
  ds_read_b128 v[44:47], v76 offset:32768
  ds_read_b128 v[48:51], v76 offset:33792
  s_nop 5
  v_mov_b64 v[20:21], 0
  v_mov_b64 v[22:23], 0
  v_mov_b64 v[24:25], 0
  v_mov_b64 v[26:27], 0
  v_smfmac_f32_16x16x64_bf16 v[28:31], v[0:3], v[36:43], v74
  ds_read_b128 v[36:39], v76 offset:34816
  ds_read_b128 v[40:43], v76 offset:35840
  v_smfmac_f32_16x16x64_bf16 v[32:35], v[0:3], v[60:67], v74
  s_waitcnt lgkmcnt(5)
  v_smfmac_f32_16x16x64_bf16 v[20:23], v[0:3], a[32:39], v74
  ds_read_b128 v[60:63], v76 offset:49152
  ds_read_b128 v[64:67], v76 offset:50176
  v_smfmac_f32_16x16x64_bf16 v[24:27], v[0:3], a[40:47], v74
  s_waitcnt lgkmcnt(4)
  v_smfmac_f32_16x16x64_bf16 v[20:23], v[4:7], a[48:55], v74
  buffer_store_dwordx4 v[16:19], v76, s[8:11], s68 offen sc1
  v_smfmac_f32_16x16x64_bf16 v[24:27], v[4:7], a[56:63], v74
  v_smfmac_f32_16x16x64_bf16 v[28:31], v[4:7], v[44:51], v74
  s_waitcnt lgkmcnt(2)
  v_smfmac_f32_16x16x64_bf16 v[20:23], v[8:11], a[64:71], v74
  ds_read_b128 v[44:47], v76 offset:51200
  ds_read_b128 v[48:51], v76 offset:52224
  v_smfmac_f32_16x16x64_bf16 v[24:27], v[8:11], a[72:79], v74
  v_smfmac_f32_16x16x64_bf16 v[32:35], v[4:7], v[36:43], v74
  v_smfmac_f32_16x16x64_bf16 v[28:31], v[8:11], v[208:215], v74
  ds_read_b128 v[36:39], v75 offset:16384
  ds_read_b128 v[40:43], v75 offset:17408
  v_smfmac_f32_16x16x64_bf16 v[32:35], v[8:11], v[216:223], v74
  v_smfmac_f32_16x16x64_bf16 v[20:23], v[12:15], a[80:87], v74
  v_smfmac_f32_16x16x64_bf16 v[24:27], v[12:15], a[88:95], v74
  v_smfmac_f32_16x16x64_bf16 v[28:31], v[12:15], v[224:231], v74
  v_smfmac_f32_16x16x64_bf16 v[32:35], v[12:15], v[232:239], v74
  s_waitcnt vmcnt(2)
  s_waitcnt vmcnt(1)
  s_barrier
Cf0_lastr:
  ds_read_b128 v[0:3], v76 offset:8704
  ds_read_b128 v[8:11], v76 offset:9728
  ds_read_b128 v[16:19], v76 offset:10752
  ds_read_b128 v[4:7], v76 offset:11776
  ds_read_b128 v[12:15], v76 offset:12800
  s_waitcnt lgkmcnt(4)
  v_max3_u32 v72, v0, v1, v2
  s_waitcnt lgkmcnt(1)
  v_max3_u32 v72, v72, v3, v4
  v_max3_u32 v72, v72, v5, v6
  v_max3_u32 v72, v72, v7, v8
  v_max3_u32 v72, v72, v9, v10
  s_waitcnt lgkmcnt(0)
  v_max3_u32 v72, v72, v11, v12
  v_max3_u32 v72, v72, v13, v14
  v_max3_u32 v72, v72, v15, v16
  v_max3_u32 v72, v72, v17, v18
  v_max_u32 v72, v72, v19
  v_cmp_eq_u32 vcc, -1, v72
  s_cbranch_vccnz Cf0_lastp
Cf0_lastg:
  v_smfmac_f32_16x16x64_bf16 v[28:31], v[0:3], v[60:67], v74
  ds_read_b128 v[60:63], v75 offset:18432
  ds_read_b128 v[64:67], v75 offset:19456
  v_smfmac_f32_16x16x64_bf16 v[32:35], v[0:3], v[44:51], v74
  v_smfmac_f32_16x16x64_bf16 v[28:31], v[8:11], v[36:43], v74
  v_smfmac_f32_16x16x64_bf16 v[28:31], v[16:19], v[240:247], v74
  v_smfmac_f32_16x16x64_bf16 v[28:31], v[4:7], a[0:7], v74
  v_smfmac_f32_16x16x64_bf16 v[28:31], v[12:15], a[16:23], v74
  v_smfmac_f32_16x16x64_bf16 v[32:35], v[16:19], v[248:255], v74
  v_smfmac_f32_16x16x64_bf16 v[32:35], v[4:7], a[8:15], v74
  s_waitcnt lgkmcnt(0)
  v_smfmac_f32_16x16x64_bf16 v[32:35], v[12:15], a[24:31], v74
  v_smfmac_f32_16x16x64_bf16 v[32:35], v[8:11], v[60:67], v74
  v_smfmac_f32_16x16x64_bf16 v[20:23], v[0:3], a[96:103], v74
  v_smfmac_f32_16x16x64_bf16 v[20:23], v[8:11], a[112:119], v74
  v_add_f32 v28, v28, v30
  v_add_f32 v32, v32, v34
  v_cvt_pk_bf16_f32 v30, v28, v32
  v_smfmac_f32_16x16x64_bf16 v[20:23], v[16:19], a[128:135], v74
  ds_write_b32 v79, v30 offset:256
  v_add_f32 v29, v29, v31
  v_add_f32 v33, v33, v35
  v_cvt_pk_bf16_f32 v31, v29, v33
  v_smfmac_f32_16x16x64_bf16 v[20:23], v[4:7], a[144:151], v74
  ds_write_b32 v79, v31 offset:832
  v_smfmac_f32_16x16x64_bf16 v[20:23], v[12:15], a[160:167], v74
  v_smfmac_f32_16x16x64_bf16 v[24:27], v[0:3], a[104:111], v74
  v_smfmac_f32_16x16x64_bf16 v[24:27], v[8:11], a[120:127], v74
  v_smfmac_f32_16x16x64_bf16 v[24:27], v[16:19], a[136:143], v74
  s_waitcnt lgkmcnt(0)
  s_barrier
  ds_read_b64 v[52:53], v77 offset:256
  v_add_f32 v20, v20, v22
  v_smfmac_f32_16x16x64_bf16 v[24:27], v[4:7], a[152:159], v74
  v_add_f32 v21, v21, v23
  v_smfmac_f32_16x16x64_bf16 v[24:27], v[12:15], a[168:175], v74
  v_cvt_pk_bf16_f32 v54, v20, v21
  s_add_u32 s68, s68, 655360
  s_nop 3
  v_add_f32 v24, v24, v26
  v_add_f32 v25, v25, v27
  v_cvt_pk_bf16_f32 v55, v24, v25
  s_waitcnt lgkmcnt(0)
  buffer_store_dwordx4 v[52:55], v76, s[8:11], s68 offen sc1
  s_branch Cf0_done
Cf0_lastp:
  s_add_u32 s72, s72, 2
  s_cmp_ge_u32 s72, 131072
  s_cbranch_scc1 Cf0_lastg
  s_barrier
  buffer_load_dwordx4 v76, s[8:11], s85 offen offset:0 sc1 lds
  s_waitcnt vmcnt(0)
  s_barrier
  s_branch Cf0_lastr
Cf0_done:
  s_branch L_cexit
L_w1:
  v_mov_b64 v[20:21], 0
  v_mov_b64 v[22:23], 0
  v_mov_b64 v[24:25], 0
  v_mov_b64 v[26:27], 0
  v_mov_b64 v[28:29], 0
  v_mov_b64 v[30:31], 0
  v_mov_b64 v[32:33], 0
  v_mov_b64 v[34:35], 0
  s_mov_b32 s78, 0x3f803f80
  s_mov_b32 s79, s78
  s_mov_b32 s65, 360448
  s_mov_b32 m0, 15872
  s_lshl_b32 s71, s53, 2
  s_add_u32 s71, s71, 128
  s_movk_i32 s56, 0x1000
  v_lshlrev_b32 v73, 2, v76
  v_mov_b32 v72, 0
  s_mov_b64 s[16:17], s[8:9]
  s_mov_b32 s18, 268435456
  s_mov_b32 s19, 0x20000
  s_getpc_b64 s[20:21]
Cf1_pc:
  s_add_u32 s20, s20, (Cf1_last - Cf1_pc)
  s_addc_u32 s21, s21, 0
  v_mov_b32 v68, 14880
  buffer_load_dwordx4 v[52:55], v76, s[8:11], s59 offen offset:0 sc1
  buffer_load_dwordx4 v[56:59], v76, s[8:11], s59 offen offset:1024 sc1
  ds_read_b128 v[36:39], v76 offset:20480
  ds_read_b128 v[40:43], v76 offset:21504
  ds_read_b128 v[60:63], v76 offset:22528
  ds_read_b128 v[64:67], v76 offset:23552
  ds_read_b128 v[0:3], v76 offset:4608
  ds_read_b128 v[4:7], v76 offset:5632
  ds_read_b128 v[8:11], v76 offset:6656
  ds_read_b128 v[12:15], v76 offset:7680
  s_waitcnt lgkmcnt(0)
  s_cmp_eq_u32 s66, 1
  s_branch Cf1_top2
.p2align 6
Cf1_h2:
  ds_read_b128 v[36:39], v76 offset:20480
  s_waitcnt lgkmcnt(0)
  v_lshlrev_b32 v73, 2, v76
  buffer_load_dwordx4 v[8:11], v76, s[8:11], s65 offen offset:2048 sc1
  ds_read_b128 v[40:43], v76 offset:21504
  s_waitcnt lgkmcnt(0)
  v_mov_b64 v[20:21], 0
  v_mov_b64 v[22:23], 0
  v_mov_b64 v[24:25], 0
  v_mov_b64 v[26:27], 0
  v_mov_b32 v68, 14880
  buffer_load_dwordx4 v[8:11], v76, s[8:11], s65 offen offset:2048 sc1
  ds_read_b128 v[60:63], v76 offset:22528
  s_waitcnt lgkmcnt(0)
  s_cmp_eq_u32 s66, 62
  s_cselect_b64 s[16:17], s[20:21], s[16:17]
  s_cselect_b32 s18, (Cf1_done - Cf1_last), s18
  s_cselect_b32 s70, 0, s70
  s_cmp_eq_u32 s66, 63
  s_cselect_b32 s59, 268435456, s59
  s_cselect_b32 s58, 268435456, s58
  buffer_load_dwordx4 v[8:11], v76, s[8:11], s65 offen offset:2048 sc1
  buffer_load_dwordx4 v[52:55], v76, s[8:11], s59 offen offset:0 sc1
  buffer_load_dwordx4 v[56:59], v76, s[8:11], s59 offen offset:1024 sc1
  s_waitcnt vmcnt(4)
  v_max3_u32 v72, v8, v9, v10
  v_max_u32 v72, v72, v11
  ds_write_b128 v76, v[8:11] offset:6656
  v_cmp_eq_u32 vcc, -1, v72
  s_cbranch_vccnz Cf1_h2r
Cf1_h2w:
  s_cmp_eq_u32 s66, 63
  s_waitcnt lgkmcnt(0)
  s_barrier
  ds_read_b128 v[0:3], v76 offset:4608
  buffer_load_dwordx4 v76, s[8:11], s85 offen offset:0 sc1 lds
Cf1_top2:
  v_smfmac_f32_16x16x64_bf16 v[20:23], v[8:11], v[112:119], v74
  s_cbranch_scc1 Cf1_last
  v_smfmac_f32_16x16x64_bf16 v[24:27], v[8:11], v[120:127], v74
  buffer_load_dwordx4 v[44:47], v76, s[8:11], s58 offen offset:0 sc1
  s_mov_b32 m0, 15872
  v_smfmac_f32_16x16x64_bf16 v[28:31], v[8:11], v[208:215], v74
  buffer_load_dwordx4 v[48:51], v76, s[8:11], s58 offen offset:1024 sc1
  v_smfmac_f32_16x16x64_bf16 v[32:35], v[8:11], v[216:223], v74
  ds_read_b128 v[4:7], v76 offset:5632
  s_waitcnt lgkmcnt(1)
  v_smfmac_f32_16x16x64_bf16 v[20:23], v[0:3], v[80:87], v74
  ds_read_b128 v[12:15], v76 offset:7680
  v_smfmac_f32_16x16x64_bf16 v[28:31], v[0:3], v[36:43], v74
  ds_read_b128 v[36:39], v76 offset:36864
  v_smfmac_f32_16x16x64_bf16 v[24:27], v[0:3], v[88:95], v74
  buffer_store_dwordx4 v[16:19], v76, s[8:11], s68 offen sc1
  ds_read_b128 v[40:43], v76 offset:37888
  v_smfmac_f32_16x16x64_bf16 v[32:35], v[0:3], v[60:67], v74
  buffer_load_dword v73, s[16:19], s70 offen lds
  ds_read_b128 v[60:63], v76 offset:38912
  s_waitcnt lgkmcnt(4)
  v_smfmac_f32_16x16x64_bf16 v[20:23], v[4:7], v[96:103], v74
  ds_read_b128 v[64:67], v76 offset:39936
  v_smfmac_f32_16x16x64_bf16 v[24:27], v[4:7], v[104:111], v74
  s_waitcnt vmcnt(5)
  s_waitcnt lgkmcnt(4)
  v_smfmac_f32_16x16x64_bf16 v[20:23], v[12:15], v[128:135], v74
  s_barrier
  ds_read_b128 v[8:11], v76 offset:8704
  s_waitcnt lgkmcnt(3)
  v_smfmac_f32_16x16x64_bf16 v[28:31], v[4:7], v[36:43], v74
  ds_read_b128 v[36:39], v76 offset:53248
  v_smfmac_f32_16x16x64_bf16 v[24:27], v[12:15], v[136:143], v74
  ds_read_b128 v[40:43], v76 offset:54272
  s_waitcnt lgkmcnt(3)
  v_smfmac_f32_16x16x64_bf16 v[32:35], v[4:7], v[60:67], v74
  ds_read_b128 v[0:3], v76 offset:9728
  v_smfmac_f32_16x16x64_bf16 v[28:31], v[12:15], v[224:231], v74
  ds_read_b128 v[60:63], v76 offset:55296
  v_smfmac_f32_16x16x64_bf16 v[32:35], v[12:15], v[232:239], v74
  s_waitcnt vmcnt(4)
  ds_read_b128 v[64:67], v76 offset:56320
  s_waitcnt lgkmcnt(5)
  v_smfmac_f32_16x16x64_bf16 v[20:23], v[8:11], v[144:151], v74
  s_barrier
  ds_read_b128 v[4:7], v76 offset:11776
  s_waitcnt lgkmcnt(4)
  v_smfmac_f32_16x16x64_bf16 v[28:31], v[8:11], v[36:43], v74
  ds_read_b128 v[12:15], v76 offset:12800
  ds_read_b128 v[36:39], v75 offset:4096
  v_smfmac_f32_16x16x64_bf16 v[24:27], v[8:11], v[152:159], v74
  ds_read_b128 v[16:19], v76 offset:10752
  s_waitcnt lgkmcnt(6)
  v_smfmac_f32_16x16x64_bf16 v[20:23], v[0:3], v[160:167], v74
  ds_read_b128 v[40:43], v75 offset:5120
  s_waitcnt lgkmcnt(5)
  v_smfmac_f32_16x16x64_bf16 v[32:35], v[8:11], v[60:67], v74
  ds_read_b128 v[60:63], v75 offset:6144
  v_smfmac_f32_16x16x64_bf16 v[24:27], v[0:3], v[168:175], v74
  ds_read_b128 v[64:67], v75 offset:7168
  s_waitcnt lgkmcnt(6)
  v_smfmac_f32_16x16x64_bf16 v[20:23], v[4:7], v[176:183], v74
  s_waitcnt lgkmcnt(5)
  v_smfmac_f32_16x16x64_bf16 v[20:23], v[12:15], v[192:199], v74
  s_waitcnt lgkmcnt(2)
  v_smfmac_f32_16x16x64_bf16 v[20:23], v[16:19], v[36:43], v74
  ds_read_b128 v[36:39], v75 offset:20480
  v_smfmac_f32_16x16x64_bf16 v[24:27], v[4:7], v[184:191], v74
  ds_read_b128 v[40:43], v75 offset:21504
  s_waitcnt lgkmcnt(2)
  v_smfmac_f32_16x16x64_bf16 v[24:27], v[16:19], v[60:67], v74
  ds_read_b128 v[60:63], v75 offset:22528
  v_add_f32 v20, v20, v22
  v_smfmac_f32_16x16x64_bf16 v[24:27], v[12:15], v[200:207], v74
  ds_read_b128 v[64:67], v75 offset:23552
  v_add_f32 v21, v21, v23
  v_smfmac_f32_16x16x64_bf16 v[28:31], v[16:19], v[240:247], v74
  v_mov_b64 v[70:71], s[78:79]
  v_smfmac_f32_16x16x64_bf16 v[28:31], v[4:7], a[0:7], v74
  s_waitcnt lgkmcnt(2)
  v_add_f32 v24, v24, v26
  v_smfmac_f32_16x16x64_bf16 v[28:31], v[0:3], v[36:43], v74
  ds_read_b128 v[36:39], v68
  v_cvt_pk_bf16_f32 v22, v20, v24
  v_smfmac_f32_16x16x64_bf16 v[28:31], v[12:15], a[16:23], v74
  ds_read_b128 v[40:43], v68
  ds_write_b32 v79, v22 offset:0
  s_waitcnt lgkmcnt(3)
  v_add_f32 v25, v25, v27
  v_cvt_pk_bf16_f32 v23, v21, v25
  v_smfmac_f32_16x16x64_bf16 v[32:35], v[0:3], v[60:67], v74
  ds_write_b32 v79, v23 offset:576
  v_cmp_u_f32 vcc, v20, v21
  v_smfmac_f32_16x16x64_bf16 v[32:35], v[16:19], v[248:255], v74
  v_add_f32 v28, v28, v30
  v_smfmac_f32_16x16x64_bf16 v[32:35], v[4:7], a[8:15], v74
  v_add_f32 v29, v29, v31
  v_smfmac_f32_16x16x64_bf16 v[32:35], v[12:15], a[24:31], v74
  s_cbranch_vccnz Cf1_rec
Cf1_recok:
  s_waitcnt lgkmcnt(3)
  v_smfmac_f32_16x16x64_bf16 v[36:39], v[16:19], a[128:135], v74
  s_waitcnt lgkmcnt(0)
  s_barrier
  ds_read_b128 v[60:63], v77
  v_smfmac_f32_16x16x64_bf16 v[40:43], v[16:19], a[136:143], v74
  ds_read_b128 v[64:67], v77 offset:128
  v_add_f32 v32, v32, v34
  v_cvt_pk_bf16_f32 v30, v28, v32
  v_smfmac_f32_16x16x64_bf16 v[36:39], v[0:3], a[112:119], v74
  ds_write_b32 v79, v30 offset:256
  v_add_f32 v33, v33, v35
  v_cvt_pk_bf16_f32 v31, v29, v33
  v_smfmac_f32_16x16x64_bf16 v[40:43], v[0:3], a[120:127], v74
  ds_write_b32 v79, v31 offset:832
  v_xor_b32 v75, 0x8000, v75
  v_smfmac_f32_16x16x64_bf16 v[36:39], v[4:7], a[144:151], v74
  ds_read_b128 v[0:3], v76 offset:4608
  v_mov_b32 v29, 0
  v_smfmac_f32_16x16x64_bf16 v[40:43], v[4:7], a[152:159], v74
  s_waitcnt vmcnt(2) lgkmcnt(3)
  v_mov_b32 v30, 0
  v_mfma_f32_16x16x32_bf16 v[44:47], v[44:47], v[60:63], 0
  ds_read_b128 v[4:7], v76 offset:5632
  s_waitcnt lgkmcnt(2)
  v_mfma_f32_16x16x32_bf16 v[44:47], v[48:51], v[64:67], v[44:47]
  s_barrier
  v_smfmac_f32_16x16x64_bf16 v[36:39], v[8:11], a[96:103], v74
  ds_read_b128 v[20:23], v77 offset:256
  ds_read_b128 v[24:27], v77 offset:384
  v_smfmac_f32_16x16x64_bf16 v[40:43], v[8:11], a[104:111], v74
  ds_read_b128 v[8:11], v76 offset:6656
  v_add_f32_dpp v72, v46, v44 quad_perm:[2,3,0,1] row_mask:0xf bank_mask:0xf
  v_add_f32_dpp v73, v47, v45 quad_perm:[2,3,0,1] row_mask:0xf bank_mask:0xf
  v_smfmac_f32_16x16x64_bf16 v[36:39], v[12:15], a[160:167], v74
  s_waitcnt lgkmcnt(4)
  v_exp_f32_dpp v72, v72 quad_perm:[0,1,0,1] row_mask:0xf bank_mask:0xf
  v_smfmac_f32_16x16x64_bf16 v[40:43], v[12:15], a[168:175], v74
  ds_read_b128 v[12:15], v76 offset:7680
  v_exp_f32_dpp v73, v73 quad_perm:[0,1,0,1] row_mask:0xf bank_mask:0xf
  v_smfmac_f32_16x16x64_bf16 v[36:39], v[0:3], a[32:39], v74
  s_waitcnt lgkmcnt(2)
  v_cvt_pk_bf16_f32 v72, v72, v73
  v_mfma_f32_16x16x32_bf16 v[20:23], v[20:23], v[60:63], 0
  ds_write_b32 v78, v72 offset:516
  v_mov_b64 v[16:17], 0
  v_mfma_f32_16x16x32_bf16 v[20:23], v[24:27], v[64:67], v[20:23]
  ds_read_b128 v[44:47], v75 offset:22528
  v_mov_b64 v[18:19], 0
  v_smfmac_f32_16x16x64_bf16 v[40:43], v[0:3], a[40:47], v74
  ds_read_b128 v[48:51], v75 offset:23552
  v_mov_b64 v[68:69], s[78:79]
  v_smfmac_f32_16x16x64_bf16 v[36:39], v[4:7], a[48:55], v74
  s_waitcnt lgkmcnt(4)
  v_add_f32_dpp v24, v22, v20 quad_perm:[2,3,0,1] row_mask:0xf bank_mask:0xf
  v_add_f32_dpp v25, v23, v21 quad_perm:[2,3,0,1] row_mask:0xf bank_mask:0xf
  v_smfmac_f32_16x16x64_bf16 v[36:39], v[8:11], a[64:71], v74
  s_waitcnt lgkmcnt(2)
  s_barrier
  ds_read_b128 v[32:35], v78 offset:512
  v_smfmac_f32_16x16x64_bf16 v[36:39], v[12:15], a[80:87], v74
  ds_read_b128 v[60:63], v75 offset:20480
  v_mul_f32 v24, s69, v24
  v_smfmac_f32_16x16x64_bf16 v[40:43], v[4:7], a[56:63], v74
  ds_read_b128 v[64:67], v75 offset:21504
  v_mul_f32 v25, s69, v25
  v_smfmac_f32_16x16x64_bf16 v[40:43], v[8:11], a[72:79], v74
  v_exp_f32_dpp v24, v24 quad_perm:[0,1,0,1] row_mask:0xf bank_mask:0xf
  v_smfmac_f32_16x16x64_bf16 v[40:43], v[12:15], a[88:95], v74
  s_waitcnt lgkmcnt(2)
  v_exp_f32_dpp v25, v25 quad_perm:[0,1,0,1] row_mask:0xf bank_mask:0xf
  v_mfma_f32_16x16x32_bf16 v[8:11], v[32:35], v[68:71], 0
  v_add_f32 v36, v36, v38
  v_add_f32 v37, v37, v39
  v_mfma_f32_16x16x32_bf16 v[0:3], v[32:35], v[52:55], 0
  v_add_f32 v40, v40, v42
  v_add_f32 v41, v41, v43
  v_mfma_f32_16x16x32_bf16 v[4:7], v[32:35], v[56:59], 0
  v_cvt_pk_bf16_f32 v28, v24, v25
  v_cvt_pk_bf16_f32 v72, v36, v37
  v_cvt_pk_bf16_f32 v73, v40, v41
  v_mfma_f32_16x16x16_bf16 v[8:11], v[28:29], v[68:69], v[8:11]
  v_cvt_pk_bf16_f32 v31, v24, v25
  v_mov_b64 v[20:21], 0
  v_mfma_f32_16x16x16_bf16 v[0:3], v[28:29], v[72:73], v[0:3]
  ds_read_b128 v[52:55], v75 offset:36864
  v_mov_b64 v[22:23], 0
  v_mfma_f32_16x16x16_bf16 v[4:7], v[30:31], v[72:73], v[4:7]
  v_rcp_f32 v10, v8
  v_rcp_f32 v11, v9
  v_mul_f32 v0, v10, v0
  v_mul_f32 v1, v11, v1
  v_max3_f32 v8, v8, v9, v10
  v_mul_f32 v4, v10, v4
  v_mul_f32 v5, v11, v5
  v_cvt_pk_bf16_f32 v2, v0, v4
  ds_write_b32 v79, v2 offset:8704
  v_cvt_pk_bf16_f32 v3, v1, v5
  ds_write_b32 v79, v3 offset:9280
  ds_read_b128 v[12:15], v78 offset:8768
  v_max_f32 v8, v8, v11
  v_cmp_le_f32 vcc, 1317011456, v8
  v_mov_b64 v[24:25], 0
  v_mov_b64 v[26:27], 0
  ds_read_b128 v[56:59], v75 offset:37888
  s_cbranch_vccnz Cf1_mx
Cf1_mxok:
  s_waitcnt lgkmcnt(2)
  s_barrier
  ds_read_b128 v[0:3], v78 offset:8704
  s_waitcnt lgkmcnt(2)
  v_smfmac_f32_16x16x64_bf16 v[16:19], v[12:15], v[44:51], v74
  ds_read_b128 v[4:7], v78 offset:8832
  v_smfmac_f32_16x16x64_bf16 v[20:23], v[12:15], a[200:207], v74
  ds_read_b128 v[8:11], v78 offset:8896
  v_smfmac_f32_16x16x64_bf16 v[24:27], v[12:15], a[216:223], v74
  ds_read_b128 v[36:39], v75 offset:38912
  s_waitcnt lgkmcnt(3)
  v_smfmac_f32_16x16x64_bf16 v[16:19], v[0:3], v[60:67], v74
  ds_read_b128 v[40:43], v75 offset:39936
  s_waitcnt lgkmcnt(3)
  v_smfmac_f32_16x16x64_bf16 v[16:19], v[4:7], a[176:183], v74
  ds_read_b128 v[68:71], v76 offset:13824
  s_waitcnt lgkmcnt(3)
  v_smfmac_f32_16x16x64_bf16 v[16:19], v[8:11], a[184:191], v74
  ds_read_b128 v[44:47], v75 offset:53248
  v_smfmac_f32_16x16x64_bf16 v[20:23], v[0:3], a[192:199], v74
  ds_read_b128 v[48:51], v75 offset:54272
  v_smfmac_f32_16x16x64_bf16 v[20:23], v[4:7], v[52:59], v74
  ds_read_b128 v[60:63], v75 offset:55296
  s_waitcnt lgkmcnt(4)
  v_cvt_pk_bf16_f32 v16, v16, v17
  v_cvt_pk_bf16_f32 v17, v18, v19
  v_bfi_b32 v16, 1, s72, v16
  v_smfmac_f32_16x16x64_bf16 v[20:23], v[8:11], v[36:43], v74
  s_waitcnt lgkmcnt(3)
  buffer_store_dwordx2 v[16:17], v68, s[8:11], s73 offen
  v_mov_b64 v[32:33], 0
  v_smfmac_f32_16x16x64_bf16 v[24:27], v[0:3], a[208:215], v74
  ds_read_b128 v[64:67], v75 offset:56320
  v_mov_b64 v[34:35], 0
  v_smfmac_f32_16x16x64_bf16 v[24:27], v[4:7], a[224:231], v74
  v_cvt_pk_bf16_f32 v20, v20, v21
  v_cvt_pk_bf16_f32 v21, v22, v23
  v_bfi_b32 v20, 1, s72, v20
  v_smfmac_f32_16x16x64_bf16 v[24:27], v[8:11], a[232:239], v74
  buffer_store_dwordx2 v[20:21], v68, s[8:11], s74 offen
  s_waitcnt lgkmcnt(2)
  v_smfmac_f32_16x16x64_bf16 v[32:35], v[0:3], v[44:51], v74
  s_waitcnt lgkmcnt(0)
  v_smfmac_f32_16x16x64_bf16 v[32:35], v[12:15], v[60:67], v74
  v_cvt_pk_bf16_f32 v24, v24, v25
  v_cvt_pk_bf16_f32 v25, v26, v27
  v_bfi_b32 v24, 1, s72, v24
  v_smfmac_f32_16x16x64_bf16 v[32:35], v[4:7], a[240:247], v74
  buffer_store_dwordx2 v[24:25], v68, s[8:11], s75 offen
  v_smfmac_f32_16x16x64_bf16 v[32:35], v[8:11], a[248:255], v74
  v_mov_b64 v[18:19], v[72:73]
  s_nop 4
  v_cvt_pk_bf16_f32 v32, v32, v33
  v_cvt_pk_bf16_f32 v33, v34, v35
  v_bfi_b32 v32, 1, s72, v32
  buffer_store_dwordx2 v[32:33], v68, s[8:11], s76 offen
  ds_read_b128 v[0:3], v76 offset:14848
  s_waitcnt lgkmcnt(0)
  ds_read_b64 v[16:17], v77 offset:264
  s_waitcnt lgkmcnt(0)
  ds_read_b128 v[64:67], v76 offset:23552
  s_waitcnt lgkmcnt(0)
  s_add_u32 s66, s66, 1
  s_xor_b32 s64, s64, 16384
  s_xor_b32 s65, s65, 16384
  s_add_u32 s58, s58, 655360
  s_add_u32 s59, s59, 655360
  s_add_u32 s70, s70, 655360
  s_add_u32 s68, s68, 655360
  s_mov_b32 m0, 11776
  s_add_u32 s85, s65, 7168
  v_xor_b32 v75, 0x8000, v75
  v_mov_b64 v[28:29], 0
  v_mov_b64 v[30:31], 0
  v_mov_b64 v[32:33], 0
  v_mov_b64 v[34:35], 0
  buffer_load_dwordx4 v[52:55], v76, s[8:11], s60 offen offset:0 sc1
  buffer_load_dwordx4 v[56:59], v76, s[8:11], s60 offen offset:1024 sc1
  s_waitcnt lgkmcnt(0)
  s_waitcnt vmcnt(1)
  v_mfma_f32_16x16x32_bf16 v[4:7], v[0:3], v[52:55], 0
  v_bitop3_b32 v72, v52, v54, s72 bitop3:0x7e
  s_waitcnt vmcnt(0)
  v_mfma_f32_16x16x32_bf16 v[4:7], v[0:3], v[56:59], v[4:7]
  v_bitop3_b32 v73, v56, v58, s72 bitop3:0x7e
  v_bitop3_b32 v72, v72, v73, 1 bitop3:0xa8
  v_cmp_ne_u32 vcc, 0, v72
  s_nop 3
  v_add_f32_dpp v4, v4, v4 row_ror:4 row_mask:0xf bank_mask:0xf
  v_add_f32_dpp v5, v5, v5 row_ror:4 row_mask:0xf bank_mask:0xf
  s_cmp_eq_u64 vcc, 0
  v_add_f32_dpp v4, v4, v4 row_ror:8 row_mask:0xf bank_mask:0xf
  v_add_f32_dpp v5, v5, v5 row_ror:8 row_mask:0xf bank_mask:0xf
  s_cselect_b32 s54, s62, 268435456
  v_cvt_pk_bf16_f32 v4, v4, v5
  buffer_store_dword v4, v69, s[8:11], s54 offen
  s_cbranch_vccnz Cf1_h1r
  s_xor_b32 s62, s62, 16384
  buffer_store_dword v71, v69, s[8:11], s62 offen
  s_xor_b32 s72, s72, 1
  s_branch Cf1_h2
Cf1_h1r:
  s_mov_b64 exec, vcc
  buffer_load_dwordx4 v[52:55], v76, s[8:11], s60 offen offset:0 sc1
  buffer_load_dwordx4 v[56:59], v76, s[8:11], s60 offen offset:1024 sc1
  s_mov_b64 exec, -1
  s_add_u32 s67, s67, 1
  s_waitcnt vmcnt(1)
  v_mfma_f32_16x16x32_bf16 v[4:7], v[0:3], v[52:55], 0
  v_bitop3_b32 v72, v52, v54, s72 bitop3:0x7e
  s_waitcnt vmcnt(0)
  v_mfma_f32_16x16x32_bf16 v[4:7], v[0:3], v[56:59], v[4:7]
  v_bitop3_b32 v73, v56, v58, s72 bitop3:0x7e
  v_bitop3_b32 v72, v72, v73, 1 bitop3:0xa8
  v_cmp_ne_u32 vcc, 0, v72
  s_cbranch_vccz Cf1_h1p
Cf1_h1s:
  s_mov_b64 exec, vcc
  buffer_load_dwordx4 v[52:55], v76, s[8:11], s60 offen offset:0 sc1
  buffer_load_dwordx4 v[56:59], v76, s[8:11], s60 offen offset:1024 sc1
  s_mov_b64 exec, -1
  s_add_u32 s67, s67, 1
  s_waitcnt vmcnt(1)
  v_mfma_f32_16x16x32_bf16 v[4:7], v[0:3], v[52:55], 0
  v_bitop3_b32 v72, v52, v54, s72 bitop3:0x7e
  s_waitcnt vmcnt(0)
  v_mfma_f32_16x16x32_bf16 v[4:7], v[0:3], v[56:59], v[4:7]
  v_bitop3_b32 v73, v56, v58, s72 bitop3:0x7e
  v_bitop3_b32 v72, v72, v73, 1 bitop3:0xa8
  v_cmp_ne_u32 vcc, 0, v72
  s_cbranch_vccz Cf1_h1p
  s_cmp_lt_u32 s67, 131072
  s_cbranch_scc1 Cf1_h1s
Cf1_h1p:
  s_nop 2
  v_add_f32_dpp v4, v4, v4 row_ror:4 row_mask:0xf bank_mask:0xf
  v_add_f32_dpp v5, v5, v5 row_ror:4 row_mask:0xf bank_mask:0xf
  s_nop 0
  v_add_f32_dpp v4, v4, v4 row_ror:8 row_mask:0xf bank_mask:0xf
  v_add_f32_dpp v5, v5, v5 row_ror:8 row_mask:0xf bank_mask:0xf
  v_cvt_pk_bf16_f32 v4, v4, v5
  buffer_store_dword v4, v69, s[8:11], s62 offen
  s_xor_b32 s62, s62, 16384
  buffer_store_dword v71, v69, s[8:11], s62 offen
  s_xor_b32 s72, s72, 1
  s_branch Cf1_h2
Cf1_h2r:
  s_mov_b64 exec, vcc
  buffer_load_dwordx4 v[8:11], v76, s[8:11], s65 offen offset:2048 sc1
  s_mov_b64 exec, -1
  s_add_u32 s67, s67, 1
  s_waitcnt vmcnt(4)
  v_max3_u32 v72, v8, v9, v10
  v_max_u32 v72, v72, v11
  ds_write_b128 v76, v[8:11] offset:6656
  v_cmp_eq_u32 vcc, -1, v72
  s_cbranch_vccz Cf1_h2w
  s_mov_b64 exec, vcc
  buffer_load_dwordx4 v[8:11], v76, s[8:11], s65 offen offset:2048 sc1
  s_mov_b64 exec, -1
  s_add_u32 s67, s67, 1
  s_waitcnt vmcnt(4)
  v_max3_u32 v72, v8, v9, v10
  v_max_u32 v72, v72, v11
  ds_write_b128 v76, v[8:11] offset:6656
  v_cmp_eq_u32 vcc, -1, v72
  s_cbranch_vccz Cf1_h2w
Cf1_h2s:
  s_mov_b64 exec, vcc
  buffer_load_dwordx4 v[8:11], v76, s[8:11], s65 offen offset:2048 sc1
  s_mov_b64 exec, -1
  s_add_u32 s67, s67, 1
  s_waitcnt vmcnt(2)
  v_max3_u32 v72, v8, v9, v10
  v_max_u32 v72, v72, v11
  ds_write_b128 v76, v[8:11] offset:6656
  v_cmp_eq_u32 vcc, -1, v72
  s_cbranch_vccz Cf1_h2w
  s_mov_b64 exec, vcc
  buffer_load_dwordx4 v[8:11], v76, s[8:11], s65 offen offset:2048 sc1
  s_mov_b64 exec, -1
  s_add_u32 s67, s67, 1
  s_waitcnt vmcnt(2)
  v_max3_u32 v72, v8, v9, v10
  v_max_u32 v72, v72, v11
  ds_write_b128 v76, v[8:11] offset:6656
  v_cmp_eq_u32 vcc, -1, v72
  s_cbranch_vccz Cf1_h2w
  s_mov_b64 exec, vcc
  buffer_load_dwordx4 v[8:11], v76, s[8:11], s65 offen offset:2048 sc1
  s_mov_b64 exec, -1
  s_add_u32 s67, s67, 1
  s_waitcnt vmcnt(2)
  v_max3_u32 v72, v8, v9, v10
  v_max_u32 v72, v72, v11
  ds_write_b128 v76, v[8:11] offset:6656
  v_cmp_eq_u32 vcc, -1, v72
  s_cbranch_vccz Cf1_h2w
  s_cmp_lt_u32 s67, 131072
  s_cbranch_scc1 Cf1_h2s
  s_branch Cf1_h2w
Cf1_rec:
  s_nop 7
  s_waitcnt vmcnt(0) lgkmcnt(0)
  v_max3_u32 v72, v0, v1, v2
  v_max3_u32 v72, v72, v3, v4
  v_max3_u32 v72, v72, v5, v6
  v_max3_u32 v72, v72, v7, v8
  v_max3_u32 v72, v72, v9, v10
  v_max3_u32 v72, v72, v11, v12
  v_max3_u32 v72, v72, v13, v14
  v_max3_u32 v72, v72, v15, v16
  v_max3_u32 v72, v72, v17, v18
  v_max_u32 v72, v72, v19
  v_cmp_eq_u32 vcc, -1, v72
  s_cbranch_vccz Cf1_recok
  s_barrier
  v_mov_b64 v[20:21], 0
  v_mov_b64 v[22:23], 0
  v_mov_b64 v[24:25], 0
  v_mov_b64 v[26:27], 0
  v_mov_b64 v[28:29], 0
  v_mov_b64 v[30:31], 0
  v_mov_b64 v[32:33], 0
  v_mov_b64 v[34:35], 0
  s_waitcnt lgkmcnt(0)
  s_barrier
  ds_read_b128 v[0:3], v76 offset:4608
  s_waitcnt lgkmcnt(0)
  v_smfmac_f32_16x16x64_bf16 v[20:23], v[0:3], v[80:87], v74
  v_smfmac_f32_16x16x64_bf16 v[24:27], v[0:3], v[88:95], v74
  ds_read_b128 v[60:63], v76 offset:20480
  ds_read_b128 v[64:67], v76 offset:21504
  s_waitcnt lgkmcnt(0)
  v_smfmac_f32_16x16x64_bf16 v[28:31], v[0:3], v[60:67], v74
  ds_read_b128 v[60:63], v76 offset:22528
  ds_read_b128 v[64:67], v76 offset:23552
  s_waitcnt lgkmcnt(0)
  v_smfmac_f32_16x16x64_bf16 v[32:35], v[0:3], v[60:67], v74
  ds_read_b128 v[4:7], v76 offset:5632
  s_waitcnt lgkmcnt(0)
  v_smfmac_f32_16x16x64_bf16 v[20:23], v[4:7], v[96:103], v74
  v_smfmac_f32_16x16x64_bf16 v[24:27], v[4:7], v[104:111], v74
  ds_read_b128 v[60:63], v76 offset:36864
  ds_read_b128 v[64:67], v76 offset:37888
  s_waitcnt lgkmcnt(0)
  v_smfmac_f32_16x16x64_bf16 v[28:31], v[4:7], v[60:67], v74
  ds_read_b128 v[60:63], v76 offset:38912
  ds_read_b128 v[64:67], v76 offset:39936
  s_waitcnt lgkmcnt(0)
  v_smfmac_f32_16x16x64_bf16 v[32:35], v[4:7], v[60:67], v74
  ds_read_b128 v[8:11], v76 offset:6656
  s_waitcnt lgkmcnt(0)
  v_smfmac_f32_16x16x64_bf16 v[20:23], v[8:11], v[112:119], v74
  v_smfmac_f32_16x16x64_bf16 v[24:27], v[8:11], v[120:127], v74
  v_smfmac_f32_16x16x64_bf16 v[28:31], v[8:11], v[208:215], v74
  v_smfmac_f32_16x16x64_bf16 v[32:35], v[8:11], v[216:223], v74
  ds_read_b128 v[12:15], v76 offset:7680
  s_waitcnt lgkmcnt(0)
  v_smfmac_f32_16x16x64_bf16 v[20:23], v[12:15], v[128:135], v74
  v_smfmac_f32_16x16x64_bf16 v[24:27], v[12:15], v[136:143], v74
  v_smfmac_f32_16x16x64_bf16 v[28:31], v[12:15], v[224:231], v74
  v_smfmac_f32_16x16x64_bf16 v[32:35], v[12:15], v[232:239], v74
  ds_read_b128 v[8:11], v76 offset:8704
  s_waitcnt lgkmcnt(0)
  v_smfmac_f32_16x16x64_bf16 v[20:23], v[8:11], v[144:151], v74
  v_smfmac_f32_16x16x64_bf16 v[24:27], v[8:11], v[152:159], v74
  ds_read_b128 v[60:63], v76 offset:53248
  ds_read_b128 v[64:67], v76 offset:54272
  s_waitcnt lgkmcnt(0)
  v_smfmac_f32_16x16x64_bf16 v[28:31], v[8:11], v[60:67], v74
  ds_read_b128 v[60:63], v76 offset:55296
  ds_read_b128 v[64:67], v76 offset:56320
  s_waitcnt lgkmcnt(0)
  v_smfmac_f32_16x16x64_bf16 v[32:35], v[8:11], v[60:67], v74
  ds_read_b128 v[0:3], v76 offset:9728
  s_waitcnt lgkmcnt(0)
  v_smfmac_f32_16x16x64_bf16 v[20:23], v[0:3], v[160:167], v74
  v_smfmac_f32_16x16x64_bf16 v[24:27], v[0:3], v[168:175], v74
  ds_read_b128 v[60:63], v75 offset:20480
  ds_read_b128 v[64:67], v75 offset:21504
  s_waitcnt lgkmcnt(0)
  v_smfmac_f32_16x16x64_bf16 v[28:31], v[0:3], v[60:67], v74
  ds_read_b128 v[60:63], v75 offset:22528
  ds_read_b128 v[64:67], v75 offset:23552
  s_waitcnt lgkmcnt(0)
  v_smfmac_f32_16x16x64_bf16 v[32:35], v[0:3], v[60:67], v74
  ds_read_b128 v[16:19], v76 offset:10752
  ds_read_b128 v[60:63], v75 offset:4096
  ds_read_b128 v[64:67], v75 offset:5120
  s_waitcnt lgkmcnt(0)
  v_smfmac_f32_16x16x64_bf16 v[20:23], v[16:19], v[60:67], v74
  ds_read_b128 v[60:63], v75 offset:6144
  ds_read_b128 v[64:67], v75 offset:7168
  s_waitcnt lgkmcnt(0)
  v_smfmac_f32_16x16x64_bf16 v[24:27], v[16:19], v[60:67], v74
  v_smfmac_f32_16x16x64_bf16 v[28:31], v[16:19], v[240:247], v74
  v_smfmac_f32_16x16x64_bf16 v[32:35], v[16:19], v[248:255], v74
  ds_read_b128 v[4:7], v76 offset:11776
  s_waitcnt lgkmcnt(0)
  v_smfmac_f32_16x16x64_bf16 v[20:23], v[4:7], v[176:183], v74
  v_smfmac_f32_16x16x64_bf16 v[24:27], v[4:7], v[184:191], v74
  v_smfmac_f32_16x16x64_bf16 v[28:31], v[4:7], a[0:7], v74
  v_smfmac_f32_16x16x64_bf16 v[32:35], v[4:7], a[8:15], v74
  ds_read_b128 v[12:15], v76 offset:12800
  s_waitcnt lgkmcnt(0)
  v_smfmac_f32_16x16x64_bf16 v[20:23], v[12:15], v[192:199], v74
  v_smfmac_f32_16x16x64_bf16 v[24:27], v[12:15], v[200:207], v74
  v_smfmac_f32_16x16x64_bf16 v[28:31], v[12:15], a[16:23], v74
  v_smfmac_f32_16x16x64_bf16 v[32:35], v[12:15], a[24:31], v74
  v_add_f32 v20, v20, v22
  v_add_f32 v21, v21, v23
  v_add_f32 v24, v24, v26
  v_cvt_pk_bf16_f32 v22, v20, v24
  ds_write_b32 v79, v22 offset:0
  v_add_f32 v25, v25, v27
  v_cvt_pk_bf16_f32 v23, v21, v25
  ds_write_b32 v79, v23 offset:576
  v_add_f32 v28, v28, v30
  v_add_f32 v29, v29, v31
  s_waitcnt lgkmcnt(0)
  s_nop 1
  s_branch Cf1_recok
Cf1_mx:
  s_waitcnt lgkmcnt(0)
  s_barrier
  buffer_load_dwordx4 v[52:55], v76, s[8:11], s59 offen offset:0 sc1
  buffer_load_dwordx4 v[0:3], v76, s[8:11], s58 offen offset:0 sc1
  ds_read_b128 v[20:23], v77 offset:0
  ds_read_b128 v[28:31], v77 offset:256
  buffer_load_dwordx4 v[56:59], v76, s[8:11], s59 offen offset:1024 sc1
  buffer_load_dwordx4 v[4:7], v76, s[8:11], s58 offen offset:1024 sc1
  ds_read_b128 v[24:27], v77 offset:128
  ds_read_b128 v[32:35], v77 offset:384
  s_waitcnt vmcnt(2) lgkmcnt(3)
  v_mfma_f32_16x16x32_bf16 v[8:11], v[0:3], v[20:23], 0
  s_waitcnt vmcnt(0) lgkmcnt(1)
  v_mfma_f32_16x16x32_bf16 v[8:11], v[4:7], v[24:27], v[8:11]
  v_mfma_f32_16x16x32_bf16 v[12:15], v[28:31], v[20:23], 0
  s_waitcnt lgkmcnt(0)
  v_mfma_f32_16x16x32_bf16 v[12:15], v[32:35], v[24:27], v[12:15]
  v_add_f32_dpp v8, v10, v8 quad_perm:[2,3,0,1] row_mask:0xf bank_mask:0xf
  v_add_f32_dpp v9, v11, v9 quad_perm:[2,3,0,1] row_mask:0xf bank_mask:0xf
  s_nop 0
  v_mov_b32_dpp v8, v8 quad_perm:[0,1,0,1] row_mask:0xf bank_mask:0xf
  v_mov_b32_dpp v9, v9 quad_perm:[0,1,0,1] row_mask:0xf bank_mask:0xf
  s_nop 1
  v_add_f32_dpp v12, v14, v12 quad_perm:[2,3,0,1] row_mask:0xf bank_mask:0xf
  v_add_f32_dpp v13, v15, v13 quad_perm:[2,3,0,1] row_mask:0xf bank_mask:0xf
  s_nop 0
  v_mov_b32_dpp v12, v12 quad_perm:[0,1,0,1] row_mask:0xf bank_mask:0xf
  v_mov_b32_dpp v13, v13 quad_perm:[0,1,0,1] row_mask:0xf bank_mask:0xf
  v_mul_f32 v12, s69, v12
  ds_write_b32 v78, v8 offset:8708
  v_mul_f32 v13, s69, v13
  ds_write_b32 v78, v9 offset:8772
  s_waitcnt lgkmcnt(0)
  s_barrier
  ds_read_b128 v[36:39], v78 offset:8704
  ds_read_b128 v[40:43], v78 offset:8768
  s_waitcnt lgkmcnt(0)
  s_barrier
  v_max_f32 v16, v36, v37
  v_max3_f32 v16, v16, v38, v39
  v_max3_f32 v16, v16, v40, v41
  v_max3_f32 v16, v16, v42, v43
  v_max3_f32 v16, v16, v12, v13
  v_mov_b32 v17, v16
  s_nop 1
  v_permlane16_swap_b32 v16, v17
  v_max_f32 v16, v16, v17
  v_mov_b32 v17, v16
  s_nop 1
  v_permlane32_swap_b32 v16, v17
  v_max_f32 v16, v16, v17
  v_sub_f32 v36, v36, v16
  v_sub_f32 v37, v37, v16
  v_sub_f32 v38, v38, v16
  v_sub_f32 v39, v39, v16
  v_sub_f32 v40, v40, v16
  v_sub_f32 v41, v41, v16
  v_sub_f32 v42, v42, v16
  v_sub_f32 v43, v43, v16
  v_sub_f32 v12, v12, v16
  v_sub_f32 v13, v13, v16
  v_exp_f32 v36, v36
  v_exp_f32 v37, v37
  v_exp_f32 v38, v38
  v_exp_f32 v39, v39
  v_exp_f32 v40, v40
  v_exp_f32 v41, v41
  v_exp_f32 v42, v42
  v_exp_f32 v43, v43
  v_exp_f32 v12, v12
  v_exp_f32 v13, v13
  v_cvt_pk_bf16_f32 v32, v36, v40
  v_cvt_pk_bf16_f32 v33, v37, v41
  v_cvt_pk_bf16_f32 v34, v38, v42
  v_cvt_pk_bf16_f32 v35, v39, v43
  v_cvt_pk_bf16_f32 v28, v12, v13
  v_cvt_pk_bf16_f32 v31, v12, v13
  v_mov_b32 v29, 0
  v_mov_b32 v30, 0
  v_mfma_f32_16x16x32_bf16 v[8:11], v[32:35], v[68:71], 0
  v_mfma_f32_16x16x32_bf16 v[0:3], v[32:35], v[52:55], 0
  v_mfma_f32_16x16x32_bf16 v[4:7], v[32:35], v[56:59], 0
  v_mfma_f32_16x16x16_bf16 v[8:11], v[28:29], v[68:69], v[8:11]
  v_mfma_f32_16x16x16_bf16 v[0:3], v[28:29], v[72:73], v[0:3]
  v_mfma_f32_16x16x16_bf16 v[4:7], v[30:31], v[72:73], v[4:7]
  ds_read_b128 v[52:55], v75 offset:36864
  v_rcp_f32 v10, v8
  v_rcp_f32 v11, v9
  v_mul_f32 v0, v10, v0
  v_mul_f32 v1, v11, v1
  v_max3_f32 v8, v8, v9, v10
  v_mul_f32 v4, v10, v4
  v_mul_f32 v5, v11, v5
  v_cvt_pk_bf16_f32 v2, v0, v4
  ds_write_b32 v79, v2 offset:8704
  v_cvt_pk_bf16_f32 v3, v1, v5
  ds_write_b32 v79, v3 offset:9280
  ds_read_b128 v[12:15], v78 offset:8768
  ds_read_b128 v[56:59], v75 offset:37888
  v_mov_b64 v[16:17], 0
  v_mov_b64 v[18:19], 0
  v_mov_b64 v[20:21], 0
  v_mov_b64 v[22:23], 0
  v_mov_b64 v[24:25], 0
  v_mov_b64 v[26:27], 0
  s_branch Cf1_mxok
Cf1_last:
  ds_read_b128 v[4:7], v76 offset:5632
  ds_read_b128 v[12:15], v76 offset:7680
  ds_read_b128 v[44:47], v76 offset:36864
  ds_read_b128 v[48:51], v76 offset:37888
  s_nop 5
  v_mov_b64 v[20:21], 0
  v_mov_b64 v[22:23], 0
  v_mov_b64 v[24:25], 0
  v_mov_b64 v[26:27], 0
  s_waitcnt lgkmcnt(4)
  v_smfmac_f32_16x16x64_bf16 v[28:31], v[0:3], v[36:43], v74
  ds_read_b128 v[36:39], v76 offset:38912
  ds_read_b128 v[40:43], v76 offset:39936
  v_smfmac_f32_16x16x64_bf16 v[32:35], v[0:3], v[60:67], v74
  s_waitcnt lgkmcnt(5)
  v_smfmac_f32_16x16x64_bf16 v[20:23], v[0:3], a[32:39], v74
  ds_read_b128 v[60:63], v76 offset:53248
  ds_read_b128 v[64:67], v76 offset:54272
  v_smfmac_f32_16x16x64_bf16 v[24:27], v[0:3], a[40:47], v74
  s_waitcnt lgkmcnt(4)
  v_smfmac_f32_16x16x64_bf16 v[20:23], v[4:7], a[48:55], v74
  buffer_store_dwordx4 v[16:19], v76, s[8:11], s68 offen sc1
  v_smfmac_f32_16x16x64_bf16 v[24:27], v[4:7], a[56:63], v74
  v_smfmac_f32_16x16x64_bf16 v[28:31], v[4:7], v[44:51], v74
  s_waitcnt lgkmcnt(2)
  v_smfmac_f32_16x16x64_bf16 v[20:23], v[8:11], a[64:71], v74
  ds_read_b128 v[44:47], v76 offset:55296
  ds_read_b128 v[48:51], v76 offset:56320
  v_smfmac_f32_16x16x64_bf16 v[24:27], v[8:11], a[72:79], v74
  v_smfmac_f32_16x16x64_bf16 v[32:35], v[4:7], v[36:43], v74
  v_smfmac_f32_16x16x64_bf16 v[28:31], v[8:11], v[208:215], v74
  ds_read_b128 v[36:39], v75 offset:20480
  ds_read_b128 v[40:43], v75 offset:21504
  v_smfmac_f32_16x16x64_bf16 v[32:35], v[8:11], v[216:223], v74
  v_smfmac_f32_16x16x64_bf16 v[20:23], v[12:15], a[80:87], v74
  v_smfmac_f32_16x16x64_bf16 v[24:27], v[12:15], a[88:95], v74
  v_smfmac_f32_16x16x64_bf16 v[28:31], v[12:15], v[224:231], v74
  v_smfmac_f32_16x16x64_bf16 v[32:35], v[12:15], v[232:239], v74
  s_waitcnt vmcnt(2)
  s_waitcnt vmcnt(1)
  s_barrier
Cf1_lastr:
  ds_read_b128 v[8:11], v76 offset:8704
  ds_read_b128 v[0:3], v76 offset:9728
  ds_read_b128 v[16:19], v76 offset:10752
  ds_read_b128 v[4:7], v76 offset:11776
  ds_read_b128 v[12:15], v76 offset:12800
  s_waitcnt lgkmcnt(3)
  v_max3_u32 v72, v0, v1, v2
  s_waitcnt lgkmcnt(1)
  v_max3_u32 v72, v72, v3, v4
  v_max3_u32 v72, v72, v5, v6
  v_max3_u32 v72, v72, v7, v8
  v_max3_u32 v72, v72, v9, v10
  s_waitcnt lgkmcnt(0)
  v_max3_u32 v72, v72, v11, v12
  v_max3_u32 v72, v72, v13, v14
  v_max3_u32 v72, v72, v15, v16
  v_max3_u32 v72, v72, v17, v18
  v_max_u32 v72, v72, v19
  v_cmp_eq_u32 vcc, -1, v72
  s_cbranch_vccnz Cf1_lastp
Cf1_lastg:
  v_smfmac_f32_16x16x64_bf16 v[28:31], v[8:11], v[60:67], v74
  ds_read_b128 v[60:63], v75 offset:22528
  ds_read_b128 v[64:67], v75 offset:23552
  v_smfmac_f32_16x16x64_bf16 v[32:35], v[8:11], v[44:51], v74
  v_smfmac_f32_16x16x64_bf16 v[28:31], v[0:3], v[36:43], v74
  v_smfmac_f32_16x16x64_bf16 v[28:31], v[16:19], v[240:247], v74
  v_smfmac_f32_16x16x64_bf16 v[28:31], v[4:7], a[0:7], v74
  v_smfmac_f32_16x16x64_bf16 v[28:31], v[12:15], a[16:23], v74
  v_smfmac_f32_16x16x64_bf16 v[32:35], v[16:19], v[248:255], v74
  v_smfmac_f32_16x16x64_bf16 v[32:35], v[4:7], a[8:15], v74
  s_waitcnt lgkmcnt(0)
  v_smfmac_f32_16x16x64_bf16 v[32:35], v[12:15], a[24:31], v74
  v_smfmac_f32_16x16x64_bf16 v[32:35], v[0:3], v[60:67], v74
  v_smfmac_f32_16x16x64_bf16 v[20:23], v[8:11], a[96:103], v74
  v_smfmac_f32_16x16x64_bf16 v[20:23], v[0:3], a[112:119], v74
  v_add_f32 v28, v28, v30
  v_add_f32 v32, v32, v34
  v_cvt_pk_bf16_f32 v30, v28, v32
  v_smfmac_f32_16x16x64_bf16 v[20:23], v[16:19], a[128:135], v74
  ds_write_b32 v79, v30 offset:256
  v_add_f32 v29, v29, v31
  v_add_f32 v33, v33, v35
  v_cvt_pk_bf16_f32 v31, v29, v33
  v_smfmac_f32_16x16x64_bf16 v[20:23], v[4:7], a[144:151], v74
  ds_write_b32 v79, v31 offset:832
  v_smfmac_f32_16x16x64_bf16 v[20:23], v[12:15], a[160:167], v74
  v_smfmac_f32_16x16x64_bf16 v[24:27], v[8:11], a[104:111], v74
  v_smfmac_f32_16x16x64_bf16 v[24:27], v[0:3], a[120:127], v74
  v_smfmac_f32_16x16x64_bf16 v[24:27], v[16:19], a[136:143], v74
  s_waitcnt lgkmcnt(0)
  s_barrier
  ds_read_b64 v[52:53], v77 offset:264
  v_add_f32 v20, v20, v22
  v_smfmac_f32_16x16x64_bf16 v[24:27], v[4:7], a[152:159], v74
  v_add_f32 v21, v21, v23
  v_smfmac_f32_16x16x64_bf16 v[24:27], v[12:15], a[168:175], v74
  v_cvt_pk_bf16_f32 v54, v20, v21
  s_add_u32 s68, s68, 655360
  s_nop 3
  v_add_f32 v24, v24, v26
  v_add_f32 v25, v25, v27
  v_cvt_pk_bf16_f32 v55, v24, v25
  s_waitcnt lgkmcnt(0)
  buffer_store_dwordx4 v[52:55], v76, s[8:11], s68 offen sc1
  s_branch Cf1_done
Cf1_lastp:
  s_add_u32 s72, s72, 2
  s_cmp_ge_u32 s72, 131072
  s_cbranch_scc1 Cf1_lastg
  s_barrier
  buffer_load_dwordx4 v76, s[8:11], s85 offen offset:0 sc1 lds
  s_waitcnt vmcnt(0)
  s_barrier
  s_branch Cf1_lastr
Cf1_done:
  s_branch L_cexit
L_w2:
  v_mov_b64 v[20:21], 0
  v_mov_b64 v[22:23], 0
  v_mov_b64 v[24:25], 0
  v_mov_b64 v[26:27], 0
  v_mov_b64 v[28:29], 0
  v_mov_b64 v[30:31], 0
  v_mov_b64 v[32:33], 0
  v_mov_b64 v[34:35], 0
  s_mov_b32 s78, 0x3f803f80
  s_mov_b32 s79, s78
  s_mov_b32 s65, 360448
  s_mov_b32 m0, 15872
  s_lshl_b32 s71, s53, 2
  s_add_u32 s71, s71, 128
  s_movk_i32 s56, 0x1000
  v_lshlrev_b32 v73, 2, v76
  v_mov_b32 v72, 0
  s_mov_b64 s[16:17], s[8:9]
  s_mov_b32 s18, 268435456
  s_mov_b32 s19, 0x20000
  s_getpc_b64 s[20:21]
Cf2_pc:
  s_add_u32 s20, s20, (Cf2_last - Cf2_pc)
  s_addc_u32 s21, s21, 0
  v_mov_b32 v68, 14880
  buffer_load_dwordx4 v[52:55], v76, s[8:11], s59 offen offset:0 sc1
  buffer_load_dwordx4 v[56:59], v76, s[8:11], s59 offen offset:1024 sc1
  ds_read_b128 v[36:39], v76 offset:24576
  ds_read_b128 v[40:43], v76 offset:25600
  ds_read_b128 v[60:63], v76 offset:26624
  ds_read_b128 v[64:67], v76 offset:27648
  ds_read_b128 v[0:3], v76 offset:4608
  ds_read_b128 v[4:7], v76 offset:5632
  ds_read_b128 v[8:11], v76 offset:6656
  ds_read_b128 v[12:15], v76 offset:7680
  s_waitcnt lgkmcnt(0)
  s_cmp_eq_u32 s66, 1
  s_branch Cf2_top2
.p2align 6
Cf2_h2:
  buffer_load_dwordx4 v[12:15], v76, s[8:11], s65 offen offset:3072 sc1
  ds_read_b128 v[36:39], v76 offset:24576
  s_waitcnt lgkmcnt(0)
  s_cmp_eq_u32 s66, 62
  s_cselect_b64 s[16:17], s[20:21], s[16:17]
  s_cselect_b32 s18, (Cf2_done - Cf2_last), s18
  s_cselect_b32 s70, 0, s70
  s_cmp_eq_u32 s66, 63
  s_cselect_b32 s59, 268435456, s59
  s_cselect_b32 s58, 268435456, s58
  buffer_load_dwordx4 v[12:15], v76, s[8:11], s65 offen offset:3072 sc1
  ds_read_b128 v[40:43], v76 offset:25600
  s_waitcnt lgkmcnt(0)
  v_mov_b64 v[20:21], 0
  v_mov_b64 v[22:23], 0
  v_mov_b64 v[24:25], 0
  v_mov_b64 v[26:27], 0
  v_mov_b32 v68, 14880
  v_lshlrev_b32 v73, 2, v76
  buffer_load_dwordx4 v[12:15], v76, s[8:11], s65 offen offset:3072 sc1
  buffer_load_dwordx4 v[52:55], v76, s[8:11], s59 offen offset:0 sc1
  buffer_load_dwordx4 v[56:59], v76, s[8:11], s59 offen offset:1024 sc1
  s_waitcnt vmcnt(4)
  v_max3_u32 v72, v12, v13, v14
  v_max_u32 v72, v72, v15
  ds_write_b128 v76, v[12:15] offset:7680
  v_cmp_eq_u32 vcc, -1, v72
  s_cbranch_vccnz Cf2_h2r
Cf2_h2w:
  s_cmp_eq_u32 s66, 63
  s_waitcnt lgkmcnt(0)
  s_barrier
  ds_read_b128 v[0:3], v76 offset:4608
  buffer_load_dwordx4 v76, s[8:11], s85 offen offset:0 sc1 lds
Cf2_top2:
  v_smfmac_f32_16x16x64_bf16 v[20:23], v[12:15], v[128:135], v74
  s_cbranch_scc1 Cf2_last
  v_smfmac_f32_16x16x64_bf16 v[24:27], v[12:15], v[136:143], v74
  buffer_load_dwordx4 v[44:47], v76, s[8:11], s58 offen offset:0 sc1
  s_mov_b32 m0, 15872
  v_smfmac_f32_16x16x64_bf16 v[28:31], v[12:15], v[224:231], v74
  buffer_load_dwordx4 v[48:51], v76, s[8:11], s58 offen offset:1024 sc1
  v_smfmac_f32_16x16x64_bf16 v[32:35], v[12:15], v[232:239], v74
  ds_read_b128 v[4:7], v76 offset:5632
  s_waitcnt lgkmcnt(1)
  v_smfmac_f32_16x16x64_bf16 v[20:23], v[0:3], v[80:87], v74
  ds_read_b128 v[8:11], v76 offset:6656
  v_smfmac_f32_16x16x64_bf16 v[28:31], v[0:3], v[36:43], v74
  ds_read_b128 v[36:39], v76 offset:40960
  v_smfmac_f32_16x16x64_bf16 v[24:27], v[0:3], v[88:95], v74
  buffer_store_dwordx4 v[16:19], v76, s[8:11], s68 offen sc1
  ds_read_b128 v[40:43], v76 offset:41984
  v_smfmac_f32_16x16x64_bf16 v[32:35], v[0:3], v[60:67], v74
  buffer_load_dword v73, s[16:19], s70 offen lds
  ds_read_b128 v[60:63], v76 offset:43008
  s_waitcnt lgkmcnt(4)
  v_smfmac_f32_16x16x64_bf16 v[20:23], v[4:7], v[96:103], v74
  ds_read_b128 v[64:67], v76 offset:44032
  v_smfmac_f32_16x16x64_bf16 v[24:27], v[4:7], v[104:111], v74
  s_waitcnt vmcnt(5)
  s_waitcnt lgkmcnt(4)
  v_smfmac_f32_16x16x64_bf16 v[20:23], v[8:11], v[112:119], v74
  s_barrier
  ds_read_b128 v[12:15], v76 offset:8704
  s_waitcnt lgkmcnt(3)
  v_smfmac_f32_16x16x64_bf16 v[28:31], v[4:7], v[36:43], v74
  ds_read_b128 v[36:39], v76 offset:57344
  v_smfmac_f32_16x16x64_bf16 v[24:27], v[8:11], v[120:127], v74
  ds_read_b128 v[40:43], v76 offset:58368
  s_waitcnt lgkmcnt(3)
  v_smfmac_f32_16x16x64_bf16 v[32:35], v[4:7], v[60:67], v74
  ds_read_b128 v[0:3], v76 offset:9728
  v_smfmac_f32_16x16x64_bf16 v[28:31], v[8:11], v[208:215], v74
  ds_read_b128 v[60:63], v76 offset:59392
  v_smfmac_f32_16x16x64_bf16 v[32:35], v[8:11], v[216:223], v74
  s_waitcnt vmcnt(4)
  ds_read_b128 v[64:67], v76 offset:60416
  s_waitcnt lgkmcnt(5)
  v_smfmac_f32_16x16x64_bf16 v[20:23], v[12:15], v[144:151], v74
  s_barrier
  ds_read_b128 v[4:7], v76 offset:11776
  s_waitcnt lgkmcnt(4)
  v_smfmac_f32_16x16x64_bf16 v[28:31], v[12:15], v[36:43], v74
  ds_read_b128 v[8:11], v76 offset:12800
  ds_read_b128 v[36:39], v75 offset:8192
  v_smfmac_f32_16x16x64_bf16 v[24:27], v[12:15], v[152:159], v74
  ds_read_b128 v[16:19], v76 offset:10752
  s_waitcnt lgkmcnt(6)
  v_smfmac_f32_16x16x64_bf16 v[20:23], v[0:3], v[160:167], v74
  ds_read_b128 v[40:43], v75 offset:9216
  s_waitcnt lgkmcnt(5)
  v_smfmac_f32_16x16x64_bf16 v[32:35], v[12:15], v[60:67], v74
  ds_read_b128 v[60:63], v75 offset:10240
  v_smfmac_f32_16x16x64_bf16 v[24:27], v[0:3], v[168:175], v74
  ds_read_b128 v[64:67], v75 offset:11264
  s_waitcnt lgkmcnt(6)
  v_smfmac_f32_16x16x64_bf16 v[20:23], v[4:7], v[176:183], v74
  s_waitcnt lgkmcnt(5)
  v_smfmac_f32_16x16x64_bf16 v[20:23], v[8:11], v[192:199], v74
  s_waitcnt lgkmcnt(2)
  v_smfmac_f32_16x16x64_bf16 v[20:23], v[16:19], v[36:43], v74
  ds_read_b128 v[36:39], v75 offset:24576
  v_smfmac_f32_16x16x64_bf16 v[24:27], v[4:7], v[184:191], v74
  ds_read_b128 v[40:43], v75 offset:25600
  s_waitcnt lgkmcnt(2)
  v_smfmac_f32_16x16x64_bf16 v[24:27], v[16:19], v[60:67], v74
  ds_read_b128 v[60:63], v75 offset:26624
  v_add_f32 v20, v20, v22
  v_smfmac_f32_16x16x64_bf16 v[24:27], v[8:11], v[200:207], v74
  ds_read_b128 v[64:67], v75 offset:27648
  v_add_f32 v21, v21, v23
  v_smfmac_f32_16x16x64_bf16 v[28:31], v[16:19], v[240:247], v74
  v_mov_b64 v[70:71], s[78:79]
  v_smfmac_f32_16x16x64_bf16 v[28:31], v[4:7], a[0:7], v74
  s_waitcnt lgkmcnt(2)
  v_add_f32 v24, v24, v26
  v_smfmac_f32_16x16x64_bf16 v[28:31], v[0:3], v[36:43], v74
  ds_read_b128 v[36:39], v68
  v_cvt_pk_bf16_f32 v22, v20, v24
  v_smfmac_f32_16x16x64_bf16 v[28:31], v[8:11], a[16:23], v74
  ds_read_b128 v[40:43], v68
  ds_write_b32 v79, v22 offset:0
  s_waitcnt lgkmcnt(3)
  v_add_f32 v25, v25, v27
  v_cvt_pk_bf16_f32 v23, v21, v25
  v_smfmac_f32_16x16x64_bf16 v[32:35], v[0:3], v[60:67], v74
  ds_write_b32 v79, v23 offset:576
  v_cmp_u_f32 vcc, v20, v21
  v_smfmac_f32_16x16x64_bf16 v[32:35], v[16:19], v[248:255], v74
  v_add_f32 v28, v28, v30
  v_smfmac_f32_16x16x64_bf16 v[32:35], v[4:7], a[8:15], v74
  v_add_f32 v29, v29, v31
  v_smfmac_f32_16x16x64_bf16 v[32:35], v[8:11], a[24:31], v74
  s_cbranch_vccnz Cf2_rec
Cf2_recok:
  s_waitcnt lgkmcnt(3)
  v_smfmac_f32_16x16x64_bf16 v[36:39], v[16:19], a[128:135], v74
  s_waitcnt lgkmcnt(0)
  s_barrier
  ds_read_b128 v[60:63], v77
  v_smfmac_f32_16x16x64_bf16 v[40:43], v[16:19], a[136:143], v74
  ds_read_b128 v[64:67], v77 offset:128
  v_add_f32 v32, v32, v34
  v_cvt_pk_bf16_f32 v30, v28, v32
  v_smfmac_f32_16x16x64_bf16 v[36:39], v[0:3], a[112:119], v74
  ds_write_b32 v79, v30 offset:256
  v_add_f32 v33, v33, v35
  v_cvt_pk_bf16_f32 v31, v29, v33
  v_smfmac_f32_16x16x64_bf16 v[40:43], v[0:3], a[120:127], v74
  ds_write_b32 v79, v31 offset:832
  v_xor_b32 v75, 0x8000, v75
  v_smfmac_f32_16x16x64_bf16 v[36:39], v[4:7], a[144:151], v74
  ds_read_b128 v[0:3], v76 offset:4608
  v_mov_b32 v29, 0
  v_smfmac_f32_16x16x64_bf16 v[40:43], v[4:7], a[152:159], v74
  s_waitcnt vmcnt(2) lgkmcnt(3)
  v_mov_b32 v30, 0
  v_mfma_f32_16x16x32_bf16 v[44:47], v[44:47], v[60:63], 0
  ds_read_b128 v[4:7], v76 offset:5632
  s_waitcnt lgkmcnt(2)
  v_mfma_f32_16x16x32_bf16 v[44:47], v[48:51], v[64:67], v[44:47]
  s_barrier
  v_smfmac_f32_16x16x64_bf16 v[36:39], v[8:11], a[160:167], v74
  ds_read_b128 v[20:23], v77 offset:256
  ds_read_b128 v[24:27], v77 offset:384
  v_smfmac_f32_16x16x64_bf16 v[40:43], v[8:11], a[168:175], v74
  ds_read_b128 v[8:11], v76 offset:6656
  v_add_f32_dpp v72, v46, v44 quad_perm:[2,3,0,1] row_mask:0xf bank_mask:0xf
  v_add_f32_dpp v73, v47, v45 quad_perm:[2,3,0,1] row_mask:0xf bank_mask:0xf
  v_smfmac_f32_16x16x64_bf16 v[36:39], v[12:15], a[96:103], v74
  s_waitcnt lgkmcnt(4)
  v_exp_f32_dpp v72, v72 quad_perm:[0,1,0,1] row_mask:0xf bank_mask:0xf
  v_smfmac_f32_16x16x64_bf16 v[40:43], v[12:15], a[104:111], v74
  ds_read_b128 v[12:15], v76 offset:7680
  v_exp_f32_dpp v73, v73 quad_perm:[0,1,0,1] row_mask:0xf bank_mask:0xf
  v_smfmac_f32_16x16x64_bf16 v[36:39], v[0:3], a[32:39], v74
  s_waitcnt lgkmcnt(2)
  v_cvt_pk_bf16_f32 v72, v72, v73
  v_mfma_f32_16x16x32_bf16 v[20:23], v[20:23], v[60:63], 0
  ds_write_b32 v78, v72 offset:520
  v_mov_b64 v[16:17], 0
  v_mfma_f32_16x16x32_bf16 v[20:23], v[24:27], v[64:67], v[20:23]
  ds_read_b128 v[44:47], v75 offset:40960
  v_mov_b64 v[18:19], 0
  v_smfmac_f32_16x16x64_bf16 v[40:43], v[0:3], a[40:47], v74
  ds_read_b128 v[48:51], v75 offset:41984
  v_mov_b64 v[68:69], s[78:79]
  v_smfmac_f32_16x16x64_bf16 v[36:39], v[4:7], a[48:55], v74
  s_waitcnt lgkmcnt(4)
  v_add_f32_dpp v24, v22, v20 quad_perm:[2,3,0,1] row_mask:0xf bank_mask:0xf
  v_add_f32_dpp v25, v23, v21 quad_perm:[2,3,0,1] row_mask:0xf bank_mask:0xf
  v_smfmac_f32_16x16x64_bf16 v[36:39], v[8:11], a[64:71], v74
  s_waitcnt lgkmcnt(2)
  s_barrier
  ds_read_b128 v[32:35], v78 offset:512
  v_smfmac_f32_16x16x64_bf16 v[36:39], v[12:15], a[80:87], v74
  ds_read_b128 v[60:63], v75 offset:24576
  v_mul_f32 v24, s69, v24
  v_smfmac_f32_16x16x64_bf16 v[40:43], v[4:7], a[56:63], v74
  ds_read_b128 v[64:67], v75 offset:25600
  v_mul_f32 v25, s69, v25
  v_smfmac_f32_16x16x64_bf16 v[40:43], v[8:11], a[72:79], v74
  v_exp_f32_dpp v24, v24 quad_perm:[0,1,0,1] row_mask:0xf bank_mask:0xf
  v_smfmac_f32_16x16x64_bf16 v[40:43], v[12:15], a[88:95], v74
  s_waitcnt lgkmcnt(2)
  v_exp_f32_dpp v25, v25 quad_perm:[0,1,0,1] row_mask:0xf bank_mask:0xf
  v_mfma_f32_16x16x32_bf16 v[8:11], v[32:35], v[68:71], 0
  v_add_f32 v36, v36, v38
  v_add_f32 v37, v37, v39
  v_mfma_f32_16x16x32_bf16 v[0:3], v[32:35], v[52:55], 0
  v_add_f32 v40, v40, v42
  v_add_f32 v41, v41, v43
  v_mfma_f32_16x16x32_bf16 v[4:7], v[32:35], v[56:59], 0
  v_cvt_pk_bf16_f32 v28, v24, v25
  v_cvt_pk_bf16_f32 v72, v36, v37
  v_cvt_pk_bf16_f32 v73, v40, v41
  v_mfma_f32_16x16x16_bf16 v[8:11], v[28:29], v[68:69], v[8:11]
  v_cvt_pk_bf16_f32 v31, v24, v25
  v_mov_b64 v[20:21], 0
  v_mfma_f32_16x16x16_bf16 v[0:3], v[28:29], v[72:73], v[0:3]
  ds_read_b128 v[52:55], v75 offset:26624
  v_mov_b64 v[22:23], 0
  v_mfma_f32_16x16x16_bf16 v[4:7], v[30:31], v[72:73], v[4:7]
  v_rcp_f32 v10, v8
  v_rcp_f32 v11, v9
  v_mul_f32 v0, v10, v0
  v_mul_f32 v1, v11, v1
  v_max3_f32 v8, v8, v9, v10
  v_mul_f32 v4, v10, v4
  v_mul_f32 v5, v11, v5
  v_cvt_pk_bf16_f32 v2, v0, v4
  ds_write_b32 v79, v2 offset:8704
  v_cvt_pk_bf16_f32 v3, v1, v5
  ds_write_b32 v79, v3 offset:9280
  ds_read_b128 v[12:15], v78 offset:8832
  v_max_f32 v8, v8, v11
  v_cmp_le_f32 vcc, 1317011456, v8
  v_mov_b64 v[24:25], 0
  v_mov_b64 v[26:27], 0
  ds_read_b128 v[56:59], v75 offset:27648
  s_cbranch_vccnz Cf2_mx
Cf2_mxok:
  s_waitcnt lgkmcnt(2)
  s_barrier
  ds_read_b128 v[0:3], v78 offset:8896
  s_waitcnt lgkmcnt(2)
  v_smfmac_f32_16x16x64_bf16 v[16:19], v[12:15], a[176:183], v74
  ds_read_b128 v[4:7], v78 offset:8704
  v_smfmac_f32_16x16x64_bf16 v[20:23], v[12:15], v[44:51], v74
  ds_read_b128 v[8:11], v78 offset:8768
  v_smfmac_f32_16x16x64_bf16 v[24:27], v[12:15], a[224:231], v74
  ds_read_b128 v[36:39], v75 offset:43008
  s_waitcnt lgkmcnt(3)
  v_smfmac_f32_16x16x64_bf16 v[16:19], v[0:3], a[184:191], v74
  ds_read_b128 v[40:43], v75 offset:44032
  s_waitcnt lgkmcnt(3)
  v_smfmac_f32_16x16x64_bf16 v[16:19], v[4:7], v[60:67], v74
  ds_read_b128 v[68:71], v76 offset:13824
  s_waitcnt lgkmcnt(3)
  v_smfmac_f32_16x16x64_bf16 v[16:19], v[8:11], v[52:59], v74
  ds_read_b128 v[44:47], v75 offset:57344
  v_smfmac_f32_16x16x64_bf16 v[20:23], v[4:7], a[192:199], v74
  ds_read_b128 v[48:51], v75 offset:58368
  v_smfmac_f32_16x16x64_bf16 v[20:23], v[8:11], a[200:207], v74
  ds_read_b128 v[60:63], v75 offset:59392
  s_waitcnt lgkmcnt(4)
  v_cvt_pk_bf16_f32 v16, v16, v17
  v_cvt_pk_bf16_f32 v17, v18, v19
  v_bfi_b32 v16, 1, s72, v16
  v_smfmac_f32_16x16x64_bf16 v[20:23], v[0:3], v[36:43], v74
  s_waitcnt lgkmcnt(3)
  buffer_store_dwordx2 v[16:17], v68, s[8:11], s73 offen
  v_mov_b64 v[32:33], 0
  v_smfmac_f32_16x16x64_bf16 v[24:27], v[4:7], a[208:215], v74
  ds_read_b128 v[64:67], v75 offset:60416
  v_mov_b64 v[34:35], 0
  v_smfmac_f32_16x16x64_bf16 v[24:27], v[8:11], a[216:223], v74
  ds_read_b128 v[52:55], v75 offset:0
  v_cvt_pk_bf16_f32 v20, v20, v21
  v_cvt_pk_bf16_f32 v21, v22, v23
  v_bfi_b32 v20, 1, s72, v20
  v_smfmac_f32_16x16x64_bf16 v[24:27], v[0:3], a[232:239], v74
  ds_read_b128 v[56:59], v75 offset:1024
  buffer_store_dwordx2 v[20:21], v68, s[8:11], s74 offen
  s_waitcnt lgkmcnt(4)
  v_mov_b64 v[28:29], 0
  v_smfmac_f32_16x16x64_bf16 v[32:35], v[4:7], v[44:51], v74
  ds_read_b128 v[36:39], v75 offset:2048
  ds_read_b128 v[40:43], v75 offset:3072
  s_waitcnt lgkmcnt(4)
  v_smfmac_f32_16x16x64_bf16 v[32:35], v[8:11], v[60:67], v74
  ds_read_b128 v[44:47], v75 offset:4096
  v_cvt_pk_bf16_f32 v24, v24, v25
  v_cvt_pk_bf16_f32 v25, v26, v27
  v_bfi_b32 v24, 1, s72, v24
  v_smfmac_f32_16x16x64_bf16 v[32:35], v[12:15], a[240:247], v74
  ds_read_b128 v[48:51], v75 offset:5120
  buffer_store_dwordx2 v[24:25], v68, s[8:11], s75 offen
  v_mov_b64 v[30:31], 0
  v_smfmac_f32_16x16x64_bf16 v[32:35], v[0:3], a[248:255], v74
  ds_read_b128 v[60:63], v75 offset:6144
  ds_read_b128 v[64:67], v75 offset:7168
  s_waitcnt lgkmcnt(6)
  v_smfmac_f32_16x16x64_bf16 v[28:31], v[4:7], v[52:59], v74
  s_waitcnt lgkmcnt(4)
  v_smfmac_f32_16x16x64_bf16 v[28:31], v[8:11], v[36:43], v74
  s_waitcnt lgkmcnt(2)
  v_cvt_pk_bf16_f32 v32, v32, v33
  v_cvt_pk_bf16_f32 v33, v34, v35
  v_bfi_b32 v32, 1, s72, v32
  v_smfmac_f32_16x16x64_bf16 v[28:31], v[12:15], v[44:51], v74
  buffer_store_dwordx2 v[32:33], v68, s[8:11], s76 offen
  s_waitcnt lgkmcnt(0)
  v_smfmac_f32_16x16x64_bf16 v[28:31], v[0:3], v[60:67], v74
  v_mov_b64 v[18:19], v[72:73]
  s_nop 4
  v_cvt_pk_bf16_f32 v28, v28, v29
  v_cvt_pk_bf16_f32 v29, v30, v31
  v_bfi_b32 v28, 1, s72, v28
  buffer_store_dwordx2 v[28:29], v68, s[8:11], s77 offen
  ds_read_b128 v[0:3], v76 offset:14848
  s_waitcnt lgkmcnt(0)
  ds_read_b64 v[16:17], v77 offset:384
  s_waitcnt lgkmcnt(0)
  ds_read_b128 v[64:67], v76 offset:27648
  s_waitcnt lgkmcnt(0)
  ds_read_b128 v[60:63], v76 offset:26624
  s_waitcnt lgkmcnt(0)
  v_xor_b32 v75, 0x8000, v75
  v_mov_b64 v[28:29], 0
  v_mov_b64 v[30:31], 0
  v_mov_b64 v[32:33], 0
  v_mov_b64 v[34:35], 0
  buffer_load_dwordx4 v[52:55], v76, s[8:11], s60 offen offset:0 sc1
  buffer_load_dwordx4 v[56:59], v76, s[8:11], s60 offen offset:1024 sc1
  s_add_u32 s66, s66, 1
  s_xor_b32 s64, s64, 16384
  s_xor_b32 s65, s65, 16384
  s_add_u32 s58, s58, 655360
  s_add_u32 s59, s59, 655360
  s_add_u32 s70, s70, 655360
  s_add_u32 s68, s68, 655360
  s_mov_b32 m0, 12800
  s_add_u32 s85, s65, 8192
  s_waitcnt lgkmcnt(0)
  s_waitcnt vmcnt(1)
  v_mfma_f32_16x16x32_bf16 v[4:7], v[0:3], v[52:55], 0
  v_bitop3_b32 v72, v52, v54, s72 bitop3:0x7e
  s_waitcnt vmcnt(0)
  v_mfma_f32_16x16x32_bf16 v[4:7], v[0:3], v[56:59], v[4:7]
  v_bitop3_b32 v73, v56, v58, s72 bitop3:0x7e
  v_bitop3_b32 v72, v72, v73, 1 bitop3:0xa8
  v_cmp_ne_u32 vcc, 0, v72
  s_nop 3
  v_add_f32_dpp v4, v4, v4 row_ror:4 row_mask:0xf bank_mask:0xf
  v_add_f32_dpp v5, v5, v5 row_ror:4 row_mask:0xf bank_mask:0xf
  s_cmp_eq_u64 vcc, 0
  v_add_f32_dpp v4, v4, v4 row_ror:8 row_mask:0xf bank_mask:0xf
  v_add_f32_dpp v5, v5, v5 row_ror:8 row_mask:0xf bank_mask:0xf
  s_cselect_b32 s54, s62, 268435456
  v_cvt_pk_bf16_f32 v4, v4, v5
  buffer_store_dword v4, v69, s[8:11], s54 offen
  s_cbranch_vccnz Cf2_h1r
  s_xor_b32 s62, s62, 16384
  buffer_store_dword v71, v69, s[8:11], s62 offen
  s_xor_b32 s72, s72, 1
  s_branch Cf2_h2
Cf2_h1r:
  s_mov_b64 exec, vcc
  buffer_load_dwordx4 v[52:55], v76, s[8:11], s60 offen offset:0 sc1
  buffer_load_dwordx4 v[56:59], v76, s[8:11], s60 offen offset:1024 sc1
  s_mov_b64 exec, -1
  s_add_u32 s67, s67, 1
  s_waitcnt vmcnt(1)
  v_mfma_f32_16x16x32_bf16 v[4:7], v[0:3], v[52:55], 0
  v_bitop3_b32 v72, v52, v54, s72 bitop3:0x7e
  s_waitcnt vmcnt(0)
  v_mfma_f32_16x16x32_bf16 v[4:7], v[0:3], v[56:59], v[4:7]
  v_bitop3_b32 v73, v56, v58, s72 bitop3:0x7e
  v_bitop3_b32 v72, v72, v73, 1 bitop3:0xa8
  v_cmp_ne_u32 vcc, 0, v72
  s_cbranch_vccz Cf2_h1p
Cf2_h1s:
  s_mov_b64 exec, vcc
  buffer_load_dwordx4 v[52:55], v76, s[8:11], s60 offen offset:0 sc1
  buffer_load_dwordx4 v[56:59], v76, s[8:11], s60 offen offset:1024 sc1
  s_mov_b64 exec, -1
  s_add_u32 s67, s67, 1
  s_waitcnt vmcnt(1)
  v_mfma_f32_16x16x32_bf16 v[4:7], v[0:3], v[52:55], 0
  v_bitop3_b32 v72, v52, v54, s72 bitop3:0x7e
  s_waitcnt vmcnt(0)
  v_mfma_f32_16x16x32_bf16 v[4:7], v[0:3], v[56:59], v[4:7]
  v_bitop3_b32 v73, v56, v58, s72 bitop3:0x7e
  v_bitop3_b32 v72, v72, v73, 1 bitop3:0xa8
  v_cmp_ne_u32 vcc, 0, v72
  s_cbranch_vccz Cf2_h1p
  s_cmp_lt_u32 s67, 131072
  s_cbranch_scc1 Cf2_h1s
Cf2_h1p:
  s_nop 2
  v_add_f32_dpp v4, v4, v4 row_ror:4 row_mask:0xf bank_mask:0xf
  v_add_f32_dpp v5, v5, v5 row_ror:4 row_mask:0xf bank_mask:0xf
  s_nop 0
  v_add_f32_dpp v4, v4, v4 row_ror:8 row_mask:0xf bank_mask:0xf
  v_add_f32_dpp v5, v5, v5 row_ror:8 row_mask:0xf bank_mask:0xf
  v_cvt_pk_bf16_f32 v4, v4, v5
  buffer_store_dword v4, v69, s[8:11], s62 offen
  s_xor_b32 s62, s62, 16384
  buffer_store_dword v71, v69, s[8:11], s62 offen
  s_xor_b32 s72, s72, 1
  s_branch Cf2_h2
Cf2_h2r:
  s_mov_b64 exec, vcc
  buffer_load_dwordx4 v[12:15], v76, s[8:11], s65 offen offset:3072 sc1
  s_mov_b64 exec, -1
  s_add_u32 s67, s67, 1
  s_waitcnt vmcnt(4)
  v_max3_u32 v72, v12, v13, v14
  v_max_u32 v72, v72, v15
  ds_write_b128 v76, v[12:15] offset:7680
  v_cmp_eq_u32 vcc, -1, v72
  s_cbranch_vccz Cf2_h2w
  s_mov_b64 exec, vcc
  buffer_load_dwordx4 v[12:15], v76, s[8:11], s65 offen offset:3072 sc1
  s_mov_b64 exec, -1
  s_add_u32 s67, s67, 1
  s_waitcnt vmcnt(4)
  v_max3_u32 v72, v12, v13, v14
  v_max_u32 v72, v72, v15
  ds_write_b128 v76, v[12:15] offset:7680
  v_cmp_eq_u32 vcc, -1, v72
  s_cbranch_vccz Cf2_h2w
Cf2_h2s:
  s_mov_b64 exec, vcc
  buffer_load_dwordx4 v[12:15], v76, s[8:11], s65 offen offset:3072 sc1
  s_mov_b64 exec, -1
  s_add_u32 s67, s67, 1
  s_waitcnt vmcnt(2)
  v_max3_u32 v72, v12, v13, v14
  v_max_u32 v72, v72, v15
  ds_write_b128 v76, v[12:15] offset:7680
  v_cmp_eq_u32 vcc, -1, v72
  s_cbranch_vccz Cf2_h2w
  s_mov_b64 exec, vcc
  buffer_load_dwordx4 v[12:15], v76, s[8:11], s65 offen offset:3072 sc1
  s_mov_b64 exec, -1
  s_add_u32 s67, s67, 1
  s_waitcnt vmcnt(2)
  v_max3_u32 v72, v12, v13, v14
  v_max_u32 v72, v72, v15
  ds_write_b128 v76, v[12:15] offset:7680
  v_cmp_eq_u32 vcc, -1, v72
  s_cbranch_vccz Cf2_h2w
  s_mov_b64 exec, vcc
  buffer_load_dwordx4 v[12:15], v76, s[8:11], s65 offen offset:3072 sc1
  s_mov_b64 exec, -1
  s_add_u32 s67, s67, 1
  s_waitcnt vmcnt(2)
  v_max3_u32 v72, v12, v13, v14
  v_max_u32 v72, v72, v15
  ds_write_b128 v76, v[12:15] offset:7680
  v_cmp_eq_u32 vcc, -1, v72
  s_cbranch_vccz Cf2_h2w
  s_cmp_lt_u32 s67, 131072
  s_cbranch_scc1 Cf2_h2s
  s_branch Cf2_h2w
Cf2_rec:
  s_nop 7
  s_waitcnt vmcnt(0) lgkmcnt(0)
  v_max3_u32 v72, v0, v1, v2
  v_max3_u32 v72, v72, v3, v4
  v_max3_u32 v72, v72, v5, v6
  v_max3_u32 v72, v72, v7, v8
  v_max3_u32 v72, v72, v9, v10
  v_max3_u32 v72, v72, v11, v12
  v_max3_u32 v72, v72, v13, v14
  v_max3_u32 v72, v72, v15, v16
  v_max3_u32 v72, v72, v17, v18
  v_max_u32 v72, v72, v19
  v_cmp_eq_u32 vcc, -1, v72
  s_cbranch_vccz Cf2_recok
  s_barrier
Cf2_recp:
  buffer_load_dwordx4 v[0:3], v76, s[8:11], s64 offen offset:0 sc1
  buffer_load_dwordx4 v[4:7], v76, s[8:11], s64 offen offset:1024 sc1
  s_add_u32 s67, s67, 1
  s_cmp_lt_u32 s67, 131072
  s_cselect_b32 s54, -2, -1
  s_waitcnt vmcnt(1)
  v_max3_u32 v72, v0, v1, v2
  s_waitcnt vmcnt(0)
  v_max3_u32 v72, v72, v3, v4
  v_max3_u32 v72, v72, v5, v6
  v_max_u32 v72, v72, v7
  v_cmp_lt_u32 vcc, s54, v72
  s_cbranch_vccnz Cf2_recp
  ds_write_b128 v76, v[0:3] offset:8704
  ds_write_b128 v76, v[4:7] offset:9728
  v_mov_b64 v[20:21], 0
  v_mov_b64 v[22:23], 0
  v_mov_b64 v[24:25], 0
  v_mov_b64 v[26:27], 0
  v_mov_b64 v[28:29], 0
  v_mov_b64 v[30:31], 0
  v_mov_b64 v[32:33], 0
  v_mov_b64 v[34:35], 0
  s_waitcnt lgkmcnt(0)
  s_barrier
  ds_read_b128 v[0:3], v76 offset:4608
  s_waitcnt lgkmcnt(0)
  v_smfmac_f32_16x16x64_bf16 v[20:23], v[0:3], v[80:87], v74
  v_smfmac_f32_16x16x64_bf16 v[24:27], v[0:3], v[88:95], v74
  ds_read_b128 v[60:63], v76 offset:24576
  ds_read_b128 v[64:67], v76 offset:25600
  s_waitcnt lgkmcnt(0)
  v_smfmac_f32_16x16x64_bf16 v[28:31], v[0:3], v[60:67], v74
  ds_read_b128 v[60:63], v76 offset:26624
  ds_read_b128 v[64:67], v76 offset:27648
  s_waitcnt lgkmcnt(0)
  v_smfmac_f32_16x16x64_bf16 v[32:35], v[0:3], v[60:67], v74
  ds_read_b128 v[4:7], v76 offset:5632
  s_waitcnt lgkmcnt(0)
  v_smfmac_f32_16x16x64_bf16 v[20:23], v[4:7], v[96:103], v74
  v_smfmac_f32_16x16x64_bf16 v[24:27], v[4:7], v[104:111], v74
  ds_read_b128 v[60:63], v76 offset:40960
  ds_read_b128 v[64:67], v76 offset:41984
  s_waitcnt lgkmcnt(0)
  v_smfmac_f32_16x16x64_bf16 v[28:31], v[4:7], v[60:67], v74
  ds_read_b128 v[60:63], v76 offset:43008
  ds_read_b128 v[64:67], v76 offset:44032
  s_waitcnt lgkmcnt(0)
  v_smfmac_f32_16x16x64_bf16 v[32:35], v[4:7], v[60:67], v74
  ds_read_b128 v[8:11], v76 offset:6656
  s_waitcnt lgkmcnt(0)
  v_smfmac_f32_16x16x64_bf16 v[20:23], v[8:11], v[112:119], v74
  v_smfmac_f32_16x16x64_bf16 v[24:27], v[8:11], v[120:127], v74
  v_smfmac_f32_16x16x64_bf16 v[28:31], v[8:11], v[208:215], v74
  v_smfmac_f32_16x16x64_bf16 v[32:35], v[8:11], v[216:223], v74
  ds_read_b128 v[12:15], v76 offset:7680
  s_waitcnt lgkmcnt(0)
  v_smfmac_f32_16x16x64_bf16 v[20:23], v[12:15], v[128:135], v74
  v_smfmac_f32_16x16x64_bf16 v[24:27], v[12:15], v[136:143], v74
  v_smfmac_f32_16x16x64_bf16 v[28:31], v[12:15], v[224:231], v74
  v_smfmac_f32_16x16x64_bf16 v[32:35], v[12:15], v[232:239], v74
  ds_read_b128 v[12:15], v76 offset:8704
  s_waitcnt lgkmcnt(0)
  v_smfmac_f32_16x16x64_bf16 v[20:23], v[12:15], v[144:151], v74
  v_smfmac_f32_16x16x64_bf16 v[24:27], v[12:15], v[152:159], v74
  ds_read_b128 v[60:63], v76 offset:57344
  ds_read_b128 v[64:67], v76 offset:58368
  s_waitcnt lgkmcnt(0)
  v_smfmac_f32_16x16x64_bf16 v[28:31], v[12:15], v[60:67], v74
  ds_read_b128 v[60:63], v76 offset:59392
  ds_read_b128 v[64:67], v76 offset:60416
  s_waitcnt lgkmcnt(0)
  v_smfmac_f32_16x16x64_bf16 v[32:35], v[12:15], v[60:67], v74
  ds_read_b128 v[0:3], v76 offset:9728
  s_waitcnt lgkmcnt(0)
  v_smfmac_f32_16x16x64_bf16 v[20:23], v[0:3], v[160:167], v74
  v_smfmac_f32_16x16x64_bf16 v[24:27], v[0:3], v[168:175], v74
  ds_read_b128 v[60:63], v75 offset:24576
  ds_read_b128 v[64:67], v75 offset:25600
  s_waitcnt lgkmcnt(0)
  v_smfmac_f32_16x16x64_bf16 v[28:31], v[0:3], v[60:67], v74
  ds_read_b128 v[60:63], v75 offset:26624
  ds_read_b128 v[64:67], v75 offset:27648
  s_waitcnt lgkmcnt(0)
  v_smfmac_f32_16x16x64_bf16 v[32:35], v[0:3], v[60:67], v74
  ds_read_b128 v[16:19], v76 offset:10752
  ds_read_b128 v[60:63], v75 offset:8192
  ds_read_b128 v[64:67], v75 offset:9216
  s_waitcnt lgkmcnt(0)
  v_smfmac_f32_16x16x64_bf16 v[20:23], v[16:19], v[60:67], v74
  ds_read_b128 v[60:63], v75 offset:10240
  ds_read_b128 v[64:67], v75 offset:11264
  s_waitcnt lgkmcnt(0)
  v_smfmac_f32_16x16x64_bf16 v[24:27], v[16:19], v[60:67], v74
  v_smfmac_f32_16x16x64_bf16 v[28:31], v[16:19], v[240:247], v74
  v_smfmac_f32_16x16x64_bf16 v[32:35], v[16:19], v[248:255], v74
  ds_read_b128 v[4:7], v76 offset:11776
  s_waitcnt lgkmcnt(0)
  v_smfmac_f32_16x16x64_bf16 v[20:23], v[4:7], v[176:183], v74
  v_smfmac_f32_16x16x64_bf16 v[24:27], v[4:7], v[184:191], v74
  v_smfmac_f32_16x16x64_bf16 v[28:31], v[4:7], a[0:7], v74
  v_smfmac_f32_16x16x64_bf16 v[32:35], v[4:7], a[8:15], v74
  ds_read_b128 v[8:11], v76 offset:12800
  s_waitcnt lgkmcnt(0)
  v_smfmac_f32_16x16x64_bf16 v[20:23], v[8:11], v[192:199], v74
  v_smfmac_f32_16x16x64_bf16 v[24:27], v[8:11], v[200:207], v74
  v_smfmac_f32_16x16x64_bf16 v[28:31], v[8:11], a[16:23], v74
  v_smfmac_f32_16x16x64_bf16 v[32:35], v[8:11], a[24:31], v74
  v_add_f32 v20, v20, v22
  v_add_f32 v21, v21, v23
  v_add_f32 v24, v24, v26
  v_cvt_pk_bf16_f32 v22, v20, v24
  ds_write_b32 v79, v22 offset:0
  v_add_f32 v25, v25, v27
  v_cvt_pk_bf16_f32 v23, v21, v25
  ds_write_b32 v79, v23 offset:576
  v_add_f32 v28, v28, v30
  v_add_f32 v29, v29, v31
  s_waitcnt lgkmcnt(0)
  s_nop 1
  s_branch Cf2_recok
Cf2_mx:
  s_waitcnt lgkmcnt(0)
  s_barrier
  buffer_load_dwordx4 v[52:55], v76, s[8:11], s59 offen offset:0 sc1
  buffer_load_dwordx4 v[0:3], v76, s[8:11], s58 offen offset:0 sc1
  ds_read_b128 v[20:23], v77 offset:0
  ds_read_b128 v[28:31], v77 offset:256
  buffer_load_dwordx4 v[56:59], v76, s[8:11], s59 offen offset:1024 sc1
  buffer_load_dwordx4 v[4:7], v76, s[8:11], s58 offen offset:1024 sc1
  ds_read_b128 v[24:27], v77 offset:128
  ds_read_b128 v[32:35], v77 offset:384
  s_waitcnt vmcnt(2) lgkmcnt(3)
  v_mfma_f32_16x16x32_bf16 v[8:11], v[0:3], v[20:23], 0
  s_waitcnt vmcnt(0) lgkmcnt(1)
  v_mfma_f32_16x16x32_bf16 v[8:11], v[4:7], v[24:27], v[8:11]
  v_mfma_f32_16x16x32_bf16 v[12:15], v[28:31], v[20:23], 0
  s_waitcnt lgkmcnt(0)
  v_mfma_f32_16x16x32_bf16 v[12:15], v[32:35], v[24:27], v[12:15]
  v_add_f32_dpp v8, v10, v8 quad_perm:[2,3,0,1] row_mask:0xf bank_mask:0xf
  v_add_f32_dpp v9, v11, v9 quad_perm:[2,3,0,1] row_mask:0xf bank_mask:0xf
  s_nop 0
  v_mov_b32_dpp v8, v8 quad_perm:[0,1,0,1] row_mask:0xf bank_mask:0xf
  v_mov_b32_dpp v9, v9 quad_perm:[0,1,0,1] row_mask:0xf bank_mask:0xf
  s_nop 1
  v_add_f32_dpp v12, v14, v12 quad_perm:[2,3,0,1] row_mask:0xf bank_mask:0xf
  v_add_f32_dpp v13, v15, v13 quad_perm:[2,3,0,1] row_mask:0xf bank_mask:0xf
  s_nop 0
  v_mov_b32_dpp v12, v12 quad_perm:[0,1,0,1] row_mask:0xf bank_mask:0xf
  v_mov_b32_dpp v13, v13 quad_perm:[0,1,0,1] row_mask:0xf bank_mask:0xf
  v_mul_f32 v12, s69, v12
  ds_write_b32 v78, v8 offset:8712
  v_mul_f32 v13, s69, v13
  ds_write_b32 v78, v9 offset:8776
  s_waitcnt lgkmcnt(0)
  s_barrier
  ds_read_b128 v[36:39], v78 offset:8704
  ds_read_b128 v[40:43], v78 offset:8768
  s_waitcnt lgkmcnt(0)
  s_barrier
  v_max_f32 v16, v36, v37
  v_max3_f32 v16, v16, v38, v39
  v_max3_f32 v16, v16, v40, v41
  v_max3_f32 v16, v16, v42, v43
  v_max3_f32 v16, v16, v12, v13
  v_mov_b32 v17, v16
  s_nop 1
  v_permlane16_swap_b32 v16, v17
  v_max_f32 v16, v16, v17
  v_mov_b32 v17, v16
  s_nop 1
  v_permlane32_swap_b32 v16, v17
  v_max_f32 v16, v16, v17
  v_sub_f32 v36, v36, v16
  v_sub_f32 v37, v37, v16
  v_sub_f32 v38, v38, v16
  v_sub_f32 v39, v39, v16
  v_sub_f32 v40, v40, v16
  v_sub_f32 v41, v41, v16
  v_sub_f32 v42, v42, v16
  v_sub_f32 v43, v43, v16
  v_sub_f32 v12, v12, v16
  v_sub_f32 v13, v13, v16
  v_exp_f32 v36, v36
  v_exp_f32 v37, v37
  v_exp_f32 v38, v38
  v_exp_f32 v39, v39
  v_exp_f32 v40, v40
  v_exp_f32 v41, v41
  v_exp_f32 v42, v42
  v_exp_f32 v43, v43
  v_exp_f32 v12, v12
  v_exp_f32 v13, v13
  v_cvt_pk_bf16_f32 v32, v36, v40
  v_cvt_pk_bf16_f32 v33, v37, v41
  v_cvt_pk_bf16_f32 v34, v38, v42
  v_cvt_pk_bf16_f32 v35, v39, v43
  v_cvt_pk_bf16_f32 v28, v12, v13
  v_cvt_pk_bf16_f32 v31, v12, v13
  v_mov_b32 v29, 0
  v_mov_b32 v30, 0
  v_mfma_f32_16x16x32_bf16 v[8:11], v[32:35], v[68:71], 0
  v_mfma_f32_16x16x32_bf16 v[0:3], v[32:35], v[52:55], 0
  v_mfma_f32_16x16x32_bf16 v[4:7], v[32:35], v[56:59], 0
  v_mfma_f32_16x16x16_bf16 v[8:11], v[28:29], v[68:69], v[8:11]
  v_mfma_f32_16x16x16_bf16 v[0:3], v[28:29], v[72:73], v[0:3]
  v_mfma_f32_16x16x16_bf16 v[4:7], v[30:31], v[72:73], v[4:7]
  ds_read_b128 v[52:55], v75 offset:26624
  v_rcp_f32 v10, v8
  v_rcp_f32 v11, v9
  v_mul_f32 v0, v10, v0
  v_mul_f32 v1, v11, v1
  v_max3_f32 v8, v8, v9, v10
  v_mul_f32 v4, v10, v4
  v_mul_f32 v5, v11, v5
  v_cvt_pk_bf16_f32 v2, v0, v4
  ds_write_b32 v79, v2 offset:8704
  v_cvt_pk_bf16_f32 v3, v1, v5
  ds_write_b32 v79, v3 offset:9280
  ds_read_b128 v[12:15], v78 offset:8832
  ds_read_b128 v[56:59], v75 offset:27648
  v_mov_b64 v[16:17], 0
  v_mov_b64 v[18:19], 0
  v_mov_b64 v[20:21], 0
  v_mov_b64 v[22:23], 0
  v_mov_b64 v[24:25], 0
  v_mov_b64 v[26:27], 0
  s_branch Cf2_mxok
Cf2_last:
  ds_read_b128 v[4:7], v76 offset:5632
  ds_read_b128 v[8:11], v76 offset:6656
  ds_read_b128 v[44:47], v76 offset:40960
  ds_read_b128 v[48:51], v76 offset:41984
  s_nop 5
  v_mov_b64 v[20:21], 0
  v_mov_b64 v[22:23], 0
  v_mov_b64 v[24:25], 0
  v_mov_b64 v[26:27], 0
  s_waitcnt lgkmcnt(4)
  v_smfmac_f32_16x16x64_bf16 v[28:31], v[0:3], v[36:43], v74
  ds_read_b128 v[36:39], v76 offset:43008
  ds_read_b128 v[40:43], v76 offset:44032
  v_smfmac_f32_16x16x64_bf16 v[32:35], v[0:3], v[60:67], v74
  s_waitcnt lgkmcnt(5)
  v_smfmac_f32_16x16x64_bf16 v[20:23], v[0:3], a[32:39], v74
  ds_read_b128 v[60:63], v76 offset:57344
  ds_read_b128 v[64:67], v76 offset:58368
  v_smfmac_f32_16x16x64_bf16 v[24:27], v[0:3], a[40:47], v74
  s_waitcnt lgkmcnt(4)
  v_smfmac_f32_16x16x64_bf16 v[20:23], v[4:7], a[48:55], v74
  buffer_store_dwordx4 v[16:19], v76, s[8:11], s68 offen sc1
  v_smfmac_f32_16x16x64_bf16 v[24:27], v[4:7], a[56:63], v74
  v_smfmac_f32_16x16x64_bf16 v[28:31], v[4:7], v[44:51], v74
  s_waitcnt lgkmcnt(2)
  v_smfmac_f32_16x16x64_bf16 v[20:23], v[8:11], a[64:71], v74
  ds_read_b128 v[44:47], v76 offset:59392
  ds_read_b128 v[48:51], v76 offset:60416
  v_smfmac_f32_16x16x64_bf16 v[24:27], v[8:11], a[72:79], v74
  v_smfmac_f32_16x16x64_bf16 v[32:35], v[4:7], v[36:43], v74
  v_smfmac_f32_16x16x64_bf16 v[28:31], v[8:11], v[208:215], v74
  ds_read_b128 v[36:39], v75 offset:24576
  ds_read_b128 v[40:43], v75 offset:25600
  v_smfmac_f32_16x16x64_bf16 v[32:35], v[8:11], v[216:223], v74
  v_smfmac_f32_16x16x64_bf16 v[20:23], v[12:15], a[80:87], v74
  v_smfmac_f32_16x16x64_bf16 v[24:27], v[12:15], a[88:95], v74
  v_smfmac_f32_16x16x64_bf16 v[28:31], v[12:15], v[224:231], v74
  v_smfmac_f32_16x16x64_bf16 v[32:35], v[12:15], v[232:239], v74
  s_waitcnt vmcnt(2)
  s_waitcnt vmcnt(1)
  s_barrier
Cf2_lastr:
  ds_read_b128 v[12:15], v76 offset:8704
  ds_read_b128 v[0:3], v76 offset:9728
  ds_read_b128 v[16:19], v76 offset:10752
  ds_read_b128 v[4:7], v76 offset:11776
  ds_read_b128 v[8:11], v76 offset:12800
  s_waitcnt lgkmcnt(3)
  v_max3_u32 v72, v0, v1, v2
  s_waitcnt lgkmcnt(1)
  v_max3_u32 v72, v72, v3, v4
  v_max3_u32 v72, v72, v5, v6
  s_waitcnt lgkmcnt(0)
  v_max3_u32 v72, v72, v7, v8
  v_max3_u32 v72, v72, v9, v10
  v_max3_u32 v72, v72, v11, v12
  v_max3_u32 v72, v72, v13, v14
  v_max3_u32 v72, v72, v15, v16
  v_max3_u32 v72, v72, v17, v18
  v_max_u32 v72, v72, v19
  v_cmp_eq_u32 vcc, -1, v72
  s_cbranch_vccnz Cf2_lastp
Cf2_lastg:
  v_smfmac_f32_16x16x64_bf16 v[28:31], v[12:15], v[60:67], v74
  ds_read_b128 v[60:63], v75 offset:26624
  ds_read_b128 v[64:67], v75 offset:27648
  v_smfmac_f32_16x16x64_bf16 v[32:35], v[12:15], v[44:51], v74
  v_smfmac_f32_16x16x64_bf16 v[28:31], v[0:3], v[36:43], v74
  v_smfmac_f32_16x16x64_bf16 v[28:31], v[16:19], v[240:247], v74
  v_smfmac_f32_16x16x64_bf16 v[28:31], v[4:7], a[0:7], v74
  v_smfmac_f32_16x16x64_bf16 v[28:31], v[8:11], a[16:23], v74
  v_smfmac_f32_16x16x64_bf16 v[32:35], v[16:19], v[248:255], v74
  v_smfmac_f32_16x16x64_bf16 v[32:35], v[4:7], a[8:15], v74
  s_waitcnt lgkmcnt(0)
  v_smfmac_f32_16x16x64_bf16 v[32:35], v[8:11], a[24:31], v74
  v_smfmac_f32_16x16x64_bf16 v[32:35], v[0:3], v[60:67], v74
  v_smfmac_f32_16x16x64_bf16 v[20:23], v[12:15], a[96:103], v74
  v_smfmac_f32_16x16x64_bf16 v[20:23], v[0:3], a[112:119], v74
  v_add_f32 v28, v28, v30
  v_add_f32 v32, v32, v34
  v_cvt_pk_bf16_f32 v30, v28, v32
  v_smfmac_f32_16x16x64_bf16 v[20:23], v[16:19], a[128:135], v74
  ds_write_b32 v79, v30 offset:256
  v_add_f32 v29, v29, v31
  v_add_f32 v33, v33, v35
  v_cvt_pk_bf16_f32 v31, v29, v33
  v_smfmac_f32_16x16x64_bf16 v[20:23], v[4:7], a[144:151], v74
  ds_write_b32 v79, v31 offset:832
  v_smfmac_f32_16x16x64_bf16 v[20:23], v[8:11], a[160:167], v74
  v_smfmac_f32_16x16x64_bf16 v[24:27], v[12:15], a[104:111], v74
  v_smfmac_f32_16x16x64_bf16 v[24:27], v[0:3], a[120:127], v74
  v_smfmac_f32_16x16x64_bf16 v[24:27], v[16:19], a[136:143], v74
  s_waitcnt lgkmcnt(0)
  s_barrier
  ds_read_b64 v[52:53], v77 offset:384
  v_add_f32 v20, v20, v22
  v_smfmac_f32_16x16x64_bf16 v[24:27], v[4:7], a[152:159], v74
  v_add_f32 v21, v21, v23
  v_smfmac_f32_16x16x64_bf16 v[24:27], v[8:11], a[168:175], v74
  v_cvt_pk_bf16_f32 v54, v20, v21
  s_add_u32 s68, s68, 655360
  s_nop 3
  v_add_f32 v24, v24, v26
  v_add_f32 v25, v25, v27
  v_cvt_pk_bf16_f32 v55, v24, v25
  s_waitcnt lgkmcnt(0)
  buffer_store_dwordx4 v[52:55], v76, s[8:11], s68 offen sc1
  s_branch Cf2_done
Cf2_lastp:
  s_add_u32 s72, s72, 2
  s_cmp_ge_u32 s72, 131072
  s_cbranch_scc1 Cf2_lastg
  s_barrier
  buffer_load_dwordx4 v76, s[8:11], s85 offen offset:0 sc1 lds
  s_waitcnt vmcnt(0)
  s_barrier
  s_branch Cf2_lastr
Cf2_done:
  s_branch L_cexit
L_w3:
  v_mov_b64 v[20:21], 0
  v_mov_b64 v[22:23], 0
  v_mov_b64 v[24:25], 0
  v_mov_b64 v[26:27], 0
  v_mov_b64 v[28:29], 0
  v_mov_b64 v[30:31], 0
  v_mov_b64 v[32:33], 0
  v_mov_b64 v[34:35], 0
  s_mov_b32 s78, 0x3f803f80
  s_mov_b32 s79, s78
  s_mov_b32 s65, 360448
  s_mov_b32 m0, 15872
  s_lshl_b32 s71, s53, 2
  s_add_u32 s71, s71, 128
  s_movk_i32 s56, 0x1000
  v_lshlrev_b32 v73, 2, v76
  v_mov_b32 v72, 0
  s_mov_b64 s[16:17], s[8:9]
  s_mov_b32 s18, 268435456
  s_mov_b32 s19, 0x20000
  s_getpc_b64 s[20:21]
Cf3_pc:
  s_add_u32 s20, s20, (Cf3_last - Cf3_pc)
  s_addc_u32 s21, s21, 0
  v_mov_b32 v68, 14880
  buffer_load_dwordx4 v[52:55], v76, s[8:11], s59 offen offset:0 sc1
  buffer_load_dwordx4 v[56:59], v76, s[8:11], s59 offen offset:1024 sc1
  ds_read_b128 v[36:39], v76 offset:45056
  ds_read_b128 v[40:43], v76 offset:46080
  ds_read_b128 v[60:63], v76 offset:47104
  ds_read_b128 v[64:67], v76 offset:48128
  ds_read_b128 v[0:3], v76 offset:4608
  ds_read_b128 v[4:7], v76 offset:5632
  ds_read_b128 v[8:11], v76 offset:6656
  ds_read_b128 v[12:15], v76 offset:7680
  s_waitcnt lgkmcnt(0)
  s_cmp_eq_u32 s66, 1
  s_branch Cf3_top2
.p2align 6
Cf3_h2:
  v_lshlrev_b32 v73, 2, v76
  buffer_load_dwordx4 v[4:7], v76, s[8:11], s65 offen offset:1024 sc1
  ds_read_b128 v[36:39], v76 offset:45056
  ds_read_b128 v[40:43], v76 offset:46080
  buffer_load_dwordx4 v[52:55], v76, s[8:11], s59 offen offset:0 sc1
  buffer_load_dwordx4 v[56:59], v76, s[8:11], s59 offen offset:1024 sc1
  s_waitcnt vmcnt(7)
  v_max3_u32 v72, v4, v5, v6
  v_max_u32 v72, v72, v7
  ds_write_b128 v76, v[4:7] offset:5632
  v_cmp_eq_u32 vcc, -1, v72
  s_cbranch_vccnz Cf3_h2r
Cf3_h2w:
  buffer_load_dwordx4 v76, s[8:11], s85 offen offset:0 sc1 lds
  buffer_load_dwordx4 v76, s[8:11], s85 offen offset:1024 sc1 lds
  s_cmp_eq_u32 s66, 63
  s_waitcnt lgkmcnt(0)
  s_barrier
  ds_read_b128 v[8:11], v76 offset:6656
Cf3_top2:
  v_smfmac_f32_16x16x64_bf16 v[20:23], v[4:7], v[96:103], v74
  s_cbranch_scc1 Cf3_last
  v_smfmac_f32_16x16x64_bf16 v[28:31], v[4:7], v[36:43], v74
  buffer_load_dwordx4 v[44:47], v76, s[8:11], s58 offen offset:0 sc1
  s_mov_b32 m0, 15872
  v_smfmac_f32_16x16x64_bf16 v[24:27], v[4:7], v[104:111], v74
  buffer_load_dwordx4 v[48:51], v76, s[8:11], s58 offen offset:1024 sc1
  v_smfmac_f32_16x16x64_bf16 v[32:35], v[4:7], v[60:67], v74
  ds_read_b128 v[0:3], v76 offset:4608
  s_waitcnt lgkmcnt(1)
  v_smfmac_f32_16x16x64_bf16 v[20:23], v[8:11], v[112:119], v74
  ds_read_b128 v[12:15], v76 offset:7680
  v_smfmac_f32_16x16x64_bf16 v[24:27], v[8:11], v[120:127], v74
  ds_read_b128 v[36:39], v76 offset:28672
  v_smfmac_f32_16x16x64_bf16 v[28:31], v[8:11], v[208:215], v74
  buffer_store_dwordx4 v[16:19], v76, s[8:11], s68 offen sc1
  ds_read_b128 v[40:43], v76 offset:29696
  v_smfmac_f32_16x16x64_bf16 v[32:35], v[8:11], v[216:223], v74
  buffer_load_dword v73, s[16:19], s70 offen lds
  ds_read_b128 v[60:63], v76 offset:30720
  s_waitcnt lgkmcnt(4)
  v_smfmac_f32_16x16x64_bf16 v[20:23], v[0:3], v[80:87], v74
  ds_read_b128 v[64:67], v76 offset:31744
  v_smfmac_f32_16x16x64_bf16 v[24:27], v[0:3], v[88:95], v74
  s_waitcnt vmcnt(4)
  s_waitcnt lgkmcnt(4)
  v_smfmac_f32_16x16x64_bf16 v[20:23], v[12:15], v[128:135], v74
  s_barrier
  ds_read_b128 v[4:7], v76 offset:8704
  s_waitcnt lgkmcnt(3)
  v_smfmac_f32_16x16x64_bf16 v[28:31], v[0:3], v[36:43], v74
  ds_read_b128 v[36:39], v76 offset:61440
  v_smfmac_f32_16x16x64_bf16 v[24:27], v[12:15], v[136:143], v74
  ds_read_b128 v[40:43], v76 offset:62464
  s_waitcnt lgkmcnt(3)
  v_smfmac_f32_16x16x64_bf16 v[32:35], v[0:3], v[60:67], v74
  ds_read_b128 v[8:11], v76 offset:9728
  v_smfmac_f32_16x16x64_bf16 v[28:31], v[12:15], v[224:231], v74
  ds_read_b128 v[60:63], v76 offset:63488
  v_smfmac_f32_16x16x64_bf16 v[32:35], v[12:15], v[232:239], v74
  ds_read_b128 v[64:67], v76 offset:64512
  s_waitcnt lgkmcnt(5)
  v_smfmac_f32_16x16x64_bf16 v[20:23], v[4:7], v[144:151], v74
  s_barrier
  ds_read_b128 v[0:3], v76 offset:11776
  s_waitcnt lgkmcnt(4)
  v_smfmac_f32_16x16x64_bf16 v[28:31], v[4:7], v[36:43], v74
  ds_read_b128 v[12:15], v76 offset:12800
  ds_read_b128 v[36:39], v75 offset:12288
  v_smfmac_f32_16x16x64_bf16 v[24:27], v[4:7], v[152:159], v74
  ds_read_b128 v[16:19], v76 offset:10752
  s_waitcnt lgkmcnt(6)
  v_smfmac_f32_16x16x64_bf16 v[20:23], v[8:11], v[160:167], v74
  ds_read_b128 v[40:43], v75 offset:13312
  s_waitcnt lgkmcnt(5)
  v_smfmac_f32_16x16x64_bf16 v[32:35], v[4:7], v[60:67], v74
  ds_read_b128 v[60:63], v75 offset:14336
  v_smfmac_f32_16x16x64_bf16 v[24:27], v[8:11], v[168:175], v74
  ds_read_b128 v[64:67], v75 offset:15360
  s_waitcnt lgkmcnt(6)
  v_smfmac_f32_16x16x64_bf16 v[20:23], v[0:3], v[176:183], v74
  s_waitcnt lgkmcnt(5)
  v_smfmac_f32_16x16x64_bf16 v[20:23], v[12:15], v[192:199], v74
  s_waitcnt lgkmcnt(2)
  v_smfmac_f32_16x16x64_bf16 v[20:23], v[16:19], v[36:43], v74
  ds_read_b128 v[36:39], v75 offset:28672
  v_smfmac_f32_16x16x64_bf16 v[24:27], v[0:3], v[184:191], v74
  ds_read_b128 v[40:43], v75 offset:29696
  s_waitcnt lgkmcnt(2)
  v_smfmac_f32_16x16x64_bf16 v[24:27], v[16:19], v[60:67], v74
  ds_read_b128 v[60:63], v75 offset:30720
  v_add_f32 v20, v20, v22
  v_smfmac_f32_16x16x64_bf16 v[24:27], v[12:15], v[200:207], v74
  ds_read_b128 v[64:67], v75 offset:31744
  v_add_f32 v21, v21, v23
  v_smfmac_f32_16x16x64_bf16 v[28:31], v[16:19], v[240:247], v74
  v_mov_b64 v[70:71], s[78:79]
  v_smfmac_f32_16x16x64_bf16 v[28:31], v[0:3], a[0:7], v74
  s_waitcnt lgkmcnt(2)
  v_add_f32 v24, v24, v26
  v_smfmac_f32_16x16x64_bf16 v[28:31], v[8:11], v[36:43], v74
  ds_read_b128 v[36:39], v68
  v_cvt_pk_bf16_f32 v22, v20, v24
  v_smfmac_f32_16x16x64_bf16 v[28:31], v[12:15], a[16:23], v74
  ds_read_b128 v[40:43], v68
  ds_write_b32 v79, v22 offset:0
  s_waitcnt lgkmcnt(3)
  v_add_f32 v25, v25, v27
  v_cvt_pk_bf16_f32 v23, v21, v25
  v_smfmac_f32_16x16x64_bf16 v[32:35], v[8:11], v[60:67], v74
  ds_write_b32 v79, v23 offset:576
  v_cmp_u_f32 vcc, v20, v21
  v_smfmac_f32_16x16x64_bf16 v[32:35], v[16:19], v[248:255], v74
  v_add_f32 v28, v28, v30
  v_smfmac_f32_16x16x64_bf16 v[32:35], v[0:3], a[8:15], v74
  v_add_f32 v29, v29, v31
  v_smfmac_f32_16x16x64_bf16 v[32:35], v[12:15], a[24:31], v74
  s_cbranch_vccnz Cf3_rec
Cf3_recok:
  s_waitcnt lgkmcnt(3)
  v_smfmac_f32_16x16x64_bf16 v[36:39], v[16:19], a[128:135], v74
  s_waitcnt lgkmcnt(0)
  s_barrier
  ds_read_b128 v[60:63], v77
  v_smfmac_f32_16x16x64_bf16 v[40:43], v[16:19], a[136:143], v74
  ds_read_b128 v[64:67], v77 offset:128
  v_add_f32 v32, v32, v34
  v_cvt_pk_bf16_f32 v30, v28, v32
  v_smfmac_f32_16x16x64_bf16 v[36:39], v[0:3], a[144:151], v74
  ds_write_b32 v79, v30 offset:256
  v_add_f32 v33, v33, v35
  v_cvt_pk_bf16_f32 v31, v29, v33
  v_smfmac_f32_16x16x64_bf16 v[40:43], v[0:3], a[152:159], v74
  ds_write_b32 v79, v31 offset:832
  v_xor_b32 v75, 0x8000, v75
  v_smfmac_f32_16x16x64_bf16 v[36:39], v[4:7], a[96:103], v74
  ds_read_b128 v[0:3], v76 offset:4608
  v_mov_b32 v29, 0
  v_smfmac_f32_16x16x64_bf16 v[40:43], v[4:7], a[104:111], v74
  s_waitcnt vmcnt(2) lgkmcnt(3)
  v_mov_b32 v30, 0
  v_mfma_f32_16x16x32_bf16 v[44:47], v[44:47], v[60:63], 0
  ds_read_b128 v[4:7], v76 offset:5632
  s_waitcnt lgkmcnt(2)
  v_mfma_f32_16x16x32_bf16 v[44:47], v[48:51], v[64:67], v[44:47]
  s_barrier
  v_smfmac_f32_16x16x64_bf16 v[36:39], v[8:11], a[112:119], v74
  ds_read_b128 v[20:23], v77 offset:256
  ds_read_b128 v[24:27], v77 offset:384
  v_smfmac_f32_16x16x64_bf16 v[40:43], v[8:11], a[120:127], v74
  ds_read_b128 v[8:11], v76 offset:6656
  v_add_f32_dpp v72, v46, v44 quad_perm:[2,3,0,1] row_mask:0xf bank_mask:0xf
  v_add_f32_dpp v73, v47, v45 quad_perm:[2,3,0,1] row_mask:0xf bank_mask:0xf
  v_smfmac_f32_16x16x64_bf16 v[36:39], v[12:15], a[160:167], v74
  s_waitcnt lgkmcnt(4)
  v_exp_f32_dpp v72, v72 quad_perm:[0,1,0,1] row_mask:0xf bank_mask:0xf
  v_smfmac_f32_16x16x64_bf16 v[40:43], v[12:15], a[168:175], v74
  ds_read_b128 v[12:15], v76 offset:7680
  v_exp_f32_dpp v73, v73 quad_perm:[0,1,0,1] row_mask:0xf bank_mask:0xf
  v_smfmac_f32_16x16x64_bf16 v[36:39], v[0:3], a[32:39], v74
  s_waitcnt lgkmcnt(2)
  v_cvt_pk_bf16_f32 v72, v72, v73
  v_mfma_f32_16x16x32_bf16 v[20:23], v[20:23], v[60:63], 0
  ds_write_b32 v78, v72 offset:524
  v_mov_b64 v[16:17], 0
  v_mfma_f32_16x16x32_bf16 v[20:23], v[24:27], v[64:67], v[20:23]
  ds_read_b128 v[44:47], v75 offset:47104
  v_mov_b64 v[18:19], 0
  v_smfmac_f32_16x16x64_bf16 v[40:43], v[0:3], a[40:47], v74
  ds_read_b128 v[48:51], v75 offset:48128
  v_mov_b64 v[68:69], s[78:79]
  v_smfmac_f32_16x16x64_bf16 v[36:39], v[4:7], a[48:55], v74
  s_waitcnt lgkmcnt(4)
  v_add_f32_dpp v24, v22, v20 quad_perm:[2,3,0,1] row_mask:0xf bank_mask:0xf
  v_add_f32_dpp v25, v23, v21 quad_perm:[2,3,0,1] row_mask:0xf bank_mask:0xf
  v_smfmac_f32_16x16x64_bf16 v[36:39], v[8:11], a[64:71], v74
  s_waitcnt lgkmcnt(2)
  s_barrier
  ds_read_b128 v[32:35], v78 offset:512
  v_smfmac_f32_16x16x64_bf16 v[36:39], v[12:15], a[80:87], v74
  ds_read_b128 v[60:63], v75 offset:28672
  v_mul_f32 v24, s69, v24
  v_smfmac_f32_16x16x64_bf16 v[40:43], v[4:7], a[56:63], v74
  ds_read_b128 v[64:67], v75 offset:29696
  v_mul_f32 v25, s69, v25
  v_smfmac_f32_16x16x64_bf16 v[40:43], v[8:11], a[72:79], v74
  v_exp_f32_dpp v24, v24 quad_perm:[0,1,0,1] row_mask:0xf bank_mask:0xf
  v_smfmac_f32_16x16x64_bf16 v[40:43], v[12:15], a[88:95], v74
  s_waitcnt lgkmcnt(2)
  v_exp_f32_dpp v25, v25 quad_perm:[0,1,0,1] row_mask:0xf bank_mask:0xf
  v_mfma_f32_16x16x32_bf16 v[8:11], v[32:35], v[68:71], 0
  v_add_f32 v36, v36, v38
  v_add_f32 v37, v37, v39
  v_mfma_f32_16x16x32_bf16 v[0:3], v[32:35], v[52:55], 0
  v_add_f32 v40, v40, v42
  v_add_f32 v41, v41, v43
  v_mfma_f32_16x16x32_bf16 v[4:7], v[32:35], v[56:59], 0
  v_cvt_pk_bf16_f32 v28, v24, v25
  v_cvt_pk_bf16_f32 v72, v36, v37
  v_cvt_pk_bf16_f32 v73, v40, v41
  v_mfma_f32_16x16x16_bf16 v[8:11], v[28:29], v[68:69], v[8:11]
  v_cvt_pk_bf16_f32 v31, v24, v25
  v_mov_b64 v[20:21], 0
  v_mfma_f32_16x16x16_bf16 v[0:3], v[28:29], v[72:73], v[0:3]
  ds_read_b128 v[52:55], v75 offset:30720
  v_mov_b64 v[22:23], 0
  v_mfma_f32_16x16x16_bf16 v[4:7], v[30:31], v[72:73], v[4:7]
  v_rcp_f32 v10, v8
  v_rcp_f32 v11, v9
  v_mul_f32 v0, v10, v0
  v_mul_f32 v1, v11, v1
  v_max3_f32 v8, v8, v9, v10
  v_mul_f32 v4, v10, v4
  v_mul_f32 v5, v11, v5
  v_cvt_pk_bf16_f32 v2, v0, v4
  ds_write_b32 v79, v2 offset:8704
  v_cvt_pk_bf16_f32 v3, v1, v5
  ds_write_b32 v79, v3 offset:9280
  ds_read_b128 v[12:15], v78 offset:8896
  v_max_f32 v8, v8, v11
  v_cmp_le_f32 vcc, 1317011456, v8
  v_mov_b64 v[24:25], 0
  v_mov_b64 v[26:27], 0
  ds_read_b128 v[56:59], v75 offset:31744
  s_cbranch_vccnz Cf3_mx
Cf3_mxok:
  s_waitcnt lgkmcnt(2)
  s_barrier
  ds_read_b128 v[0:3], v78 offset:8832
  s_waitcnt lgkmcnt(2)
  v_smfmac_f32_16x16x64_bf16 v[16:19], v[12:15], a[184:191], v74
  ds_read_b128 v[4:7], v78 offset:8704
  v_smfmac_f32_16x16x64_bf16 v[20:23], v[12:15], v[44:51], v74
  ds_read_b128 v[8:11], v78 offset:8768
  v_smfmac_f32_16x16x64_bf16 v[24:27], v[12:15], a[232:239], v74
  ds_read_b128 v[36:39], v75 offset:45056
  s_waitcnt lgkmcnt(3)
  v_smfmac_f32_16x16x64_bf16 v[16:19], v[0:3], a[176:183], v74
  ds_read_b128 v[40:43], v75 offset:46080
  s_waitcnt lgkmcnt(3)
  v_smfmac_f32_16x16x64_bf16 v[16:19], v[4:7], v[60:67], v74
  ds_read_b128 v[68:71], v76 offset:13824
  s_waitcnt lgkmcnt(3)
  v_smfmac_f32_16x16x64_bf16 v[16:19], v[8:11], v[52:59], v74
  ds_read_b128 v[44:47], v75 offset:61440
  v_smfmac_f32_16x16x64_bf16 v[20:23], v[4:7], a[192:199], v74
  ds_read_b128 v[48:51], v75 offset:62464
  v_smfmac_f32_16x16x64_bf16 v[20:23], v[8:11], a[200:207], v74
  ds_read_b128 v[60:63], v75 offset:63488
  s_waitcnt lgkmcnt(4)
  v_cvt_pk_bf16_f32 v16, v16, v17
  v_cvt_pk_bf16_f32 v17, v18, v19
  v_bfi_b32 v16, 1, s72, v16
  v_smfmac_f32_16x16x64_bf16 v[20:23], v[0:3], v[36:43], v74
  s_waitcnt lgkmcnt(3)
  buffer_store_dwordx2 v[16:17], v68, s[8:11], s73 offen
  v_mov_b64 v[32:33], 0
  v_smfmac_f32_16x16x64_bf16 v[24:27], v[4:7], a[208:215], v74
  ds_read_b128 v[64:67], v75 offset:64512
  v_mov_b64 v[34:35], 0
  v_smfmac_f32_16x16x64_bf16 v[24:27], v[8:11], a[216:223], v74
  ds_read_b128 v[52:55], v75 offset:8192
  v_cvt_pk_bf16_f32 v20, v20, v21
  v_cvt_pk_bf16_f32 v21, v22, v23
  v_bfi_b32 v20, 1, s72, v20
  v_smfmac_f32_16x16x64_bf16 v[24:27], v[0:3], a[224:231], v74
  ds_read_b128 v[56:59], v75 offset:9216
  buffer_store_dwordx2 v[20:21], v68, s[8:11], s74 offen
  s_waitcnt lgkmcnt(4)
  v_mov_b64 v[28:29], 0
  v_smfmac_f32_16x16x64_bf16 v[32:35], v[4:7], v[44:51], v74
  ds_read_b128 v[36:39], v75 offset:10240
  ds_read_b128 v[40:43], v75 offset:11264
  s_waitcnt lgkmcnt(4)
  v_smfmac_f32_16x16x64_bf16 v[32:35], v[8:11], v[60:67], v74
  ds_read_b128 v[44:47], v75 offset:12288
  v_cvt_pk_bf16_f32 v24, v24, v25
  v_cvt_pk_bf16_f32 v25, v26, v27
  v_bfi_b32 v24, 1, s72, v24
  v_smfmac_f32_16x16x64_bf16 v[32:35], v[0:3], a[240:247], v74
  ds_read_b128 v[48:51], v75 offset:13312
  buffer_store_dwordx2 v[24:25], v68, s[8:11], s75 offen
  v_mov_b64 v[30:31], 0
  v_smfmac_f32_16x16x64_bf16 v[32:35], v[12:15], a[248:255], v74
  ds_read_b128 v[60:63], v75 offset:14336
  ds_read_b128 v[64:67], v75 offset:15360
  s_waitcnt lgkmcnt(6)
  v_smfmac_f32_16x16x64_bf16 v[28:31], v[4:7], v[52:59], v74
  s_waitcnt lgkmcnt(4)
  v_smfmac_f32_16x16x64_bf16 v[28:31], v[8:11], v[36:43], v74
  s_waitcnt lgkmcnt(2)
  v_cvt_pk_bf16_f32 v32, v32, v33
  v_cvt_pk_bf16_f32 v33, v34, v35
  v_bfi_b32 v32, 1, s72, v32
  v_smfmac_f32_16x16x64_bf16 v[28:31], v[0:3], v[44:51], v74
  buffer_store_dwordx2 v[32:33], v68, s[8:11], s76 offen
  s_waitcnt lgkmcnt(0)
  v_smfmac_f32_16x16x64_bf16 v[28:31], v[12:15], v[60:67], v74
  v_mov_b64 v[18:19], v[72:73]
  s_nop 4
  v_cvt_pk_bf16_f32 v28, v28, v29
  v_cvt_pk_bf16_f32 v29, v30, v31
  v_bfi_b32 v28, 1, s72, v28
  buffer_store_dwordx2 v[28:29], v68, s[8:11], s77 offen
  ds_read_b128 v[52:55], v76 offset:14848
  s_waitcnt lgkmcnt(0)
  ds_read_b64 v[16:17], v77 offset:392
  s_waitcnt lgkmcnt(0)
  ds_read_b128 v[60:63], v76 offset:47104
  s_waitcnt lgkmcnt(0)
  ds_read_b128 v[64:67], v76 offset:48128
  s_waitcnt lgkmcnt(0)
  s_add_u32 s66, s66, 1
  s_xor_b32 s64, s64, 16384
  s_xor_b32 s65, s65, 16384
  s_add_u32 s58, s58, 655360
  s_add_u32 s59, s59, 655360
  s_add_u32 s70, s70, 655360
  s_add_u32 s68, s68, 655360
  s_mov_b32 m0, 8704
  s_add_u32 s85, s65, 4096
  v_xor_b32 v75, 0x8000, v75
  v_mov_b64 v[28:29], 0
  v_mov_b64 v[30:31], 0
  v_mov_b64 v[32:33], 0
  v_mov_b64 v[34:35], 0
  buffer_load_dwordx4 v[0:3], v76, s[8:11], s60 offen offset:0 sc1
  buffer_load_dwordx4 v[4:7], v76, s[8:11], s60 offen offset:1024 sc1
  buffer_load_dwordx4 v[8:11], v76, s[8:11], s61 offen offset:0 sc1
  buffer_load_dwordx4 v[12:15], v76, s[8:11], s61 offen offset:1024 sc1
  v_mov_b64 v[20:21], 0
  v_mov_b64 v[22:23], 0
  v_mov_b64 v[24:25], 0
  v_mov_b64 v[26:27], 0
  v_mov_b32 v68, 14880
  s_cmp_eq_u32 s66, 62
  s_cselect_b64 s[16:17], s[20:21], s[16:17]
  s_cselect_b32 s18, (Cf3_done - Cf3_last), s18
  s_cselect_b32 s70, 0, s70
  s_cmp_eq_u32 s66, 63
  s_cselect_b32 s59, 268435456, s59
  s_cselect_b32 s58, 268435456, s58
  s_waitcnt lgkmcnt(0)
  s_waitcnt vmcnt(3)
  v_mfma_f32_16x16x32_bf16 v[56:59], v[52:55], v[0:3], 0
  v_bitop3_b32 v72, v0, v2, s72 bitop3:0x7e
  s_waitcnt vmcnt(2)
  v_mfma_f32_16x16x32_bf16 v[56:59], v[52:55], v[4:7], v[56:59]
  v_bitop3_b32 v73, v4, v6, s72 bitop3:0x7e
  v_or_b32 v72, v72, v73
  s_waitcnt vmcnt(1)
  v_mfma_f32_16x16x32_bf16 v[36:39], v[52:55], v[8:11], 0
  v_bitop3_b32 v73, v8, v10, s72 bitop3:0x7e
  v_or_b32 v72, v72, v73
  s_waitcnt vmcnt(0)
  v_mfma_f32_16x16x32_bf16 v[36:39], v[52:55], v[12:15], v[36:39]
  v_bitop3_b32 v73, v12, v14, s72 bitop3:0x7e
  v_bitop3_b32 v72, v72, v73, 1 bitop3:0xa8
  v_cmp_ne_u32 vcc, 0, v72
  s_cbranch_vccnz Cf3_h1r
  buffer_load_dwordx4 v[4:7], v76, s[8:11], s65 offen offset:1024 sc1
  v_add_f32_dpp v56, v56, v56 row_ror:4 row_mask:0xf bank_mask:0xf
  v_add_f32_dpp v57, v57, v57 row_ror:4 row_mask:0xf bank_mask:0xf
  v_add_f32_dpp v36, v36, v36 row_ror:4 row_mask:0xf bank_mask:0xf
  v_add_f32_dpp v37, v37, v37 row_ror:4 row_mask:0xf bank_mask:0xf
  v_add_f32_dpp v56, v56, v56 row_ror:8 row_mask:0xf bank_mask:0xf
  v_add_f32_dpp v57, v57, v57 row_ror:8 row_mask:0xf bank_mask:0xf
  v_add_f32_dpp v36, v36, v36 row_ror:8 row_mask:0xf bank_mask:0xf
  v_add_f32_dpp v37, v37, v37 row_ror:8 row_mask:0xf bank_mask:0xf
  v_cvt_pk_bf16_f32 v56, v56, v57
  buffer_store_dword v56, v69, s[8:11], s62 offen
  v_cvt_pk_bf16_f32 v36, v36, v37
  buffer_store_dword v36, v70, s[8:11], s63 offen
  s_xor_b32 s62, s62, 16384
  buffer_store_dword v71, v69, s[8:11], s62 offen
  s_xor_b32 s63, s63, 16384
  buffer_store_dword v71, v70, s[8:11], s63 offen
  s_xor_b32 s72, s72, 1
  s_branch Cf3_h2
Cf3_h1r:
  s_mov_b64 exec, vcc
  buffer_load_dwordx4 v[0:3], v76, s[8:11], s60 offen offset:0 sc1
  buffer_load_dwordx4 v[4:7], v76, s[8:11], s60 offen offset:1024 sc1
  buffer_load_dwordx4 v[8:11], v76, s[8:11], s61 offen offset:0 sc1
  buffer_load_dwordx4 v[12:15], v76, s[8:11], s61 offen offset:1024 sc1
  s_mov_b64 exec, -1
  s_add_u32 s67, s67, 1
  s_waitcnt vmcnt(3)
  v_mfma_f32_16x16x32_bf16 v[56:59], v[52:55], v[0:3], 0
  v_bitop3_b32 v72, v0, v2, s72 bitop3:0x7e
  s_waitcnt vmcnt(2)
  v_mfma_f32_16x16x32_bf16 v[56:59], v[52:55], v[4:7], v[56:59]
  v_bitop3_b32 v73, v4, v6, s72 bitop3:0x7e
  v_or_b32 v72, v72, v73
  s_waitcnt vmcnt(1)
  v_mfma_f32_16x16x32_bf16 v[36:39], v[52:55], v[8:11], 0
  v_bitop3_b32 v73, v8, v10, s72 bitop3:0x7e
  v_or_b32 v72, v72, v73
  s_waitcnt vmcnt(0)
  v_mfma_f32_16x16x32_bf16 v[36:39], v[52:55], v[12:15], v[36:39]
  v_bitop3_b32 v73, v12, v14, s72 bitop3:0x7e
  v_bitop3_b32 v72, v72, v73, 1 bitop3:0xa8
  v_cmp_ne_u32 vcc, 0, v72
  s_cbranch_vccz Cf3_h1p
Cf3_h1s:
  s_mov_b64 exec, vcc
  buffer_load_dwordx4 v[0:3], v76, s[8:11], s60 offen offset:0 sc1
  buffer_load_dwordx4 v[4:7], v76, s[8:11], s60 offen offset:1024 sc1
  buffer_load_dwordx4 v[8:11], v76, s[8:11], s61 offen offset:0 sc1
  buffer_load_dwordx4 v[12:15], v76, s[8:11], s61 offen offset:1024 sc1
  s_mov_b64 exec, -1
  s_add_u32 s67, s67, 1
  s_waitcnt vmcnt(3)
  v_mfma_f32_16x16x32_bf16 v[56:59], v[52:55], v[0:3], 0
  v_bitop3_b32 v72, v0, v2, s72 bitop3:0x7e
  s_waitcnt vmcnt(2)
  v_mfma_f32_16x16x32_bf16 v[56:59], v[52:55], v[4:7], v[56:59]
  v_bitop3_b32 v73, v4, v6, s72 bitop3:0x7e
  v_or_b32 v72, v72, v73
  s_waitcnt vmcnt(1)
  v_mfma_f32_16x16x32_bf16 v[36:39], v[52:55], v[8:11], 0
  v_bitop3_b32 v73, v8, v10, s72 bitop3:0x7e
  v_or_b32 v72, v72, v73
  s_waitcnt vmcnt(0)
  v_mfma_f32_16x16x32_bf16 v[36:39], v[52:55], v[12:15], v[36:39]
  v_bitop3_b32 v73, v12, v14, s72 bitop3:0x7e
  v_bitop3_b32 v72, v72, v73, 1 bitop3:0xa8
  v_cmp_ne_u32 vcc, 0, v72
  s_cbranch_vccz Cf3_h1p
  s_cmp_lt_u32 s67, 131072
  s_cbranch_scc1 Cf3_h1s
Cf3_h1p:
  s_nop 2
  buffer_load_dwordx4 v[4:7], v76, s[8:11], s65 offen offset:1024 sc1
  v_add_f32_dpp v56, v56, v56 row_ror:4 row_mask:0xf bank_mask:0xf
  v_add_f32_dpp v57, v57, v57 row_ror:4 row_mask:0xf bank_mask:0xf
  v_add_f32_dpp v36, v36, v36 row_ror:4 row_mask:0xf bank_mask:0xf
  v_add_f32_dpp v37, v37, v37 row_ror:4 row_mask:0xf bank_mask:0xf
  v_add_f32_dpp v56, v56, v56 row_ror:8 row_mask:0xf bank_mask:0xf
  v_add_f32_dpp v57, v57, v57 row_ror:8 row_mask:0xf bank_mask:0xf
  v_add_f32_dpp v36, v36, v36 row_ror:8 row_mask:0xf bank_mask:0xf
  v_add_f32_dpp v37, v37, v37 row_ror:8 row_mask:0xf bank_mask:0xf
  v_cvt_pk_bf16_f32 v56, v56, v57
  buffer_store_dword v56, v69, s[8:11], s62 offen
  v_cvt_pk_bf16_f32 v36, v36, v37
  buffer_store_dword v36, v70, s[8:11], s63 offen
  s_xor_b32 s62, s62, 16384
  buffer_store_dword v71, v69, s[8:11], s62 offen
  s_xor_b32 s63, s63, 16384
  buffer_store_dword v71, v70, s[8:11], s63 offen
  s_xor_b32 s72, s72, 1
  s_branch Cf3_h2
Cf3_h2r:
  s_mov_b64 exec, vcc
  buffer_load_dwordx4 v[4:7], v76, s[8:11], s65 offen offset:1024 sc1
  s_mov_b64 exec, -1
  s_add_u32 s67, s67, 1
  s_waitcnt vmcnt(3)
  v_max3_u32 v72, v4, v5, v6
  v_max_u32 v72, v72, v7
  ds_write_b128 v76, v[4:7] offset:5632
  v_cmp_eq_u32 vcc, -1, v72
  s_cbranch_vccz Cf3_h2w
Cf3_h2s:
  s_mov_b64 exec, vcc
  buffer_load_dwordx4 v[4:7], v76, s[8:11], s65 offen offset:1024 sc1
  s_mov_b64 exec, -1
  s_add_u32 s67, s67, 1
  s_waitcnt vmcnt(1)
  v_max3_u32 v72, v4, v5, v6
  v_max_u32 v72, v72, v7
  ds_write_b128 v76, v[4:7] offset:5632
  v_cmp_eq_u32 vcc, -1, v72
  s_cbranch_vccz Cf3_h2w
  s_mov_b64 exec, vcc
  buffer_load_dwordx4 v[4:7], v76, s[8:11], s65 offen offset:1024 sc1
  s_mov_b64 exec, -1
  s_add_u32 s67, s67, 1
  s_waitcnt vmcnt(1)
  v_max3_u32 v72, v4, v5, v6
  v_max_u32 v72, v72, v7
  ds_write_b128 v76, v[4:7] offset:5632
  v_cmp_eq_u32 vcc, -1, v72
  s_cbranch_vccz Cf3_h2w
  s_mov_b64 exec, vcc
  buffer_load_dwordx4 v[4:7], v76, s[8:11], s65 offen offset:1024 sc1
  s_mov_b64 exec, -1
  s_add_u32 s67, s67, 1
  s_waitcnt vmcnt(1)
  v_max3_u32 v72, v4, v5, v6
  v_max_u32 v72, v72, v7
  ds_write_b128 v76, v[4:7] offset:5632
  v_cmp_eq_u32 vcc, -1, v72
  s_cbranch_vccz Cf3_h2w
  s_cmp_lt_u32 s67, 131072
  s_cbranch_scc1 Cf3_h2s
  s_branch Cf3_h2w
Cf3_rec:
  s_nop 7
  s_waitcnt vmcnt(0) lgkmcnt(0)
  v_max3_u32 v72, v0, v1, v2
  v_max3_u32 v72, v72, v3, v4
  v_max3_u32 v72, v72, v5, v6
  v_max3_u32 v72, v72, v7, v8
  v_max3_u32 v72, v72, v9, v10
  v_max3_u32 v72, v72, v11, v12
  v_max3_u32 v72, v72, v13, v14
  v_max3_u32 v72, v72, v15, v16
  v_max3_u32 v72, v72, v17, v18
  v_max_u32 v72, v72, v19
  v_cmp_eq_u32 vcc, -1, v72
  s_cbranch_vccz Cf3_recok
  s_barrier
Cf3_recp:
  buffer_load_dwordx4 v[0:3], v76, s[8:11], s64 offen offset:0 sc1
  buffer_load_dwordx4 v[4:7], v76, s[8:11], s64 offen offset:1024 sc1
  buffer_load_dwordx4 v[8:11], v76, s[8:11], s64 offen offset:2048 sc1
  s_add_u32 s67, s67, 1
  s_cmp_lt_u32 s67, 131072
  s_cselect_b32 s54, -2, -1
  s_waitcnt vmcnt(2)
  v_max3_u32 v72, v0, v1, v2
  s_waitcnt vmcnt(1)
  v_max3_u32 v72, v72, v3, v4
  v_max3_u32 v72, v72, v5, v6
  s_waitcnt vmcnt(0)
  v_max3_u32 v72, v72, v7, v8
  v_max3_u32 v72, v72, v9, v10
  v_max_u32 v72, v72, v11
  v_cmp_lt_u32 vcc, s54, v72
  s_cbranch_vccnz Cf3_recp
  ds_write_b128 v76, v[0:3] offset:10752
  ds_write_b128 v76, v[4:7] offset:11776
  ds_write_b128 v76, v[8:11] offset:12800
  v_mov_b64 v[20:21], 0
  v_mov_b64 v[22:23], 0
  v_mov_b64 v[24:25], 0
  v_mov_b64 v[26:27], 0
  v_mov_b64 v[28:29], 0
  v_mov_b64 v[30:31], 0
  v_mov_b64 v[32:33], 0
  v_mov_b64 v[34:35], 0
  s_waitcnt lgkmcnt(0)
  s_barrier
  ds_read_b128 v[0:3], v76 offset:4608
  s_waitcnt lgkmcnt(0)
  v_smfmac_f32_16x16x64_bf16 v[20:23], v[0:3], v[80:87], v74
  v_smfmac_f32_16x16x64_bf16 v[24:27], v[0:3], v[88:95], v74
  ds_read_b128 v[60:63], v76 offset:28672
  ds_read_b128 v[64:67], v76 offset:29696
  s_waitcnt lgkmcnt(0)
  v_smfmac_f32_16x16x64_bf16 v[28:31], v[0:3], v[60:67], v74
  ds_read_b128 v[60:63], v76 offset:30720
  ds_read_b128 v[64:67], v76 offset:31744
  s_waitcnt lgkmcnt(0)
  v_smfmac_f32_16x16x64_bf16 v[32:35], v[0:3], v[60:67], v74
  ds_read_b128 v[4:7], v76 offset:5632
  s_waitcnt lgkmcnt(0)
  v_smfmac_f32_16x16x64_bf16 v[20:23], v[4:7], v[96:103], v74
  v_smfmac_f32_16x16x64_bf16 v[24:27], v[4:7], v[104:111], v74
  ds_read_b128 v[60:63], v76 offset:45056
  ds_read_b128 v[64:67], v76 offset:46080
  s_waitcnt lgkmcnt(0)
  v_smfmac_f32_16x16x64_bf16 v[28:31], v[4:7], v[60:67], v74
  ds_read_b128 v[60:63], v76 offset:47104
  ds_read_b128 v[64:67], v76 offset:48128
  s_waitcnt lgkmcnt(0)
  v_smfmac_f32_16x16x64_bf16 v[32:35], v[4:7], v[60:67], v74
  ds_read_b128 v[8:11], v76 offset:6656
  s_waitcnt lgkmcnt(0)
  v_smfmac_f32_16x16x64_bf16 v[20:23], v[8:11], v[112:119], v74
  v_smfmac_f32_16x16x64_bf16 v[24:27], v[8:11], v[120:127], v74
  v_smfmac_f32_16x16x64_bf16 v[28:31], v[8:11], v[208:215], v74
  v_smfmac_f32_16x16x64_bf16 v[32:35], v[8:11], v[216:223], v74
  ds_read_b128 v[12:15], v76 offset:7680
  s_waitcnt lgkmcnt(0)
  v_smfmac_f32_16x16x64_bf16 v[20:23], v[12:15], v[128:135], v74
  v_smfmac_f32_16x16x64_bf16 v[24:27], v[12:15], v[136:143], v74
  v_smfmac_f32_16x16x64_bf16 v[28:31], v[12:15], v[224:231], v74
  v_smfmac_f32_16x16x64_bf16 v[32:35], v[12:15], v[232:239], v74
  ds_read_b128 v[4:7], v76 offset:8704
  s_waitcnt lgkmcnt(0)
  v_smfmac_f32_16x16x64_bf16 v[20:23], v[4:7], v[144:151], v74
  v_smfmac_f32_16x16x64_bf16 v[24:27], v[4:7], v[152:159], v74
  ds_read_b128 v[60:63], v76 offset:61440
  ds_read_b128 v[64:67], v76 offset:62464
  s_waitcnt lgkmcnt(0)
  v_smfmac_f32_16x16x64_bf16 v[28:31], v[4:7], v[60:67], v74
  ds_read_b128 v[60:63], v76 offset:63488
  ds_read_b128 v[64:67], v76 offset:64512
  s_waitcnt lgkmcnt(0)
  v_smfmac_f32_16x16x64_bf16 v[32:35], v[4:7], v[60:67], v74
  ds_read_b128 v[8:11], v76 offset:9728
  s_waitcnt lgkmcnt(0)
  v_smfmac_f32_16x16x64_bf16 v[20:23], v[8:11], v[160:167], v74
  v_smfmac_f32_16x16x64_bf16 v[24:27], v[8:11], v[168:175], v74
  ds_read_b128 v[60:63], v75 offset:28672
  ds_read_b128 v[64:67], v75 offset:29696
  s_waitcnt lgkmcnt(0)
  v_smfmac_f32_16x16x64_bf16 v[28:31], v[8:11], v[60:67], v74
  ds_read_b128 v[60:63], v75 offset:30720
  ds_read_b128 v[64:67], v75 offset:31744
  s_waitcnt lgkmcnt(0)
  v_smfmac_f32_16x16x64_bf16 v[32:35], v[8:11], v[60:67], v74
  ds_read_b128 v[16:19], v76 offset:10752
  ds_read_b128 v[60:63], v75 offset:12288
  ds_read_b128 v[64:67], v75 offset:13312
  s_waitcnt lgkmcnt(0)
  v_smfmac_f32_16x16x64_bf16 v[20:23], v[16:19], v[60:67], v74
  ds_read_b128 v[60:63], v75 offset:14336
  ds_read_b128 v[64:67], v75 offset:15360
  s_waitcnt lgkmcnt(0)
  v_smfmac_f32_16x16x64_bf16 v[24:27], v[16:19], v[60:67], v74
  v_smfmac_f32_16x16x64_bf16 v[28:31], v[16:19], v[240:247], v74
  v_smfmac_f32_16x16x64_bf16 v[32:35], v[16:19], v[248:255], v74
  ds_read_b128 v[0:3], v76 offset:11776
  s_waitcnt lgkmcnt(0)
  v_smfmac_f32_16x16x64_bf16 v[20:23], v[0:3], v[176:183], v74
  v_smfmac_f32_16x16x64_bf16 v[24:27], v[0:3], v[184:191], v74
  v_smfmac_f32_16x16x64_bf16 v[28:31], v[0:3], a[0:7], v74
  v_smfmac_f32_16x16x64_bf16 v[32:35], v[0:3], a[8:15], v74
  ds_read_b128 v[12:15], v76 offset:12800
  s_waitcnt lgkmcnt(0)
  v_smfmac_f32_16x16x64_bf16 v[20:23], v[12:15], v[192:199], v74
  v_smfmac_f32_16x16x64_bf16 v[24:27], v[12:15], v[200:207], v74
  v_smfmac_f32_16x16x64_bf16 v[28:31], v[12:15], a[16:23], v74
  v_smfmac_f32_16x16x64_bf16 v[32:35], v[12:15], a[24:31], v74
  v_add_f32 v20, v20, v22
  v_add_f32 v21, v21, v23
  v_add_f32 v24, v24, v26
  v_cvt_pk_bf16_f32 v22, v20, v24
  ds_write_b32 v79, v22 offset:0
  v_add_f32 v25, v25, v27
  v_cvt_pk_bf16_f32 v23, v21, v25
  ds_write_b32 v79, v23 offset:576
  v_add_f32 v28, v28, v30
  v_add_f32 v29, v29, v31
  s_waitcnt lgkmcnt(0)
  s_nop 1
  s_branch Cf3_recok
Cf3_mx:
  s_waitcnt lgkmcnt(0)
  s_barrier
  buffer_load_dwordx4 v[52:55], v76, s[8:11], s59 offen offset:0 sc1
  buffer_load_dwordx4 v[0:3], v76, s[8:11], s58 offen offset:0 sc1
  ds_read_b128 v[20:23], v77 offset:0
  ds_read_b128 v[28:31], v77 offset:256
  buffer_load_dwordx4 v[56:59], v76, s[8:11], s59 offen offset:1024 sc1
  buffer_load_dwordx4 v[4:7], v76, s[8:11], s58 offen offset:1024 sc1
  ds_read_b128 v[24:27], v77 offset:128
  ds_read_b128 v[32:35], v77 offset:384
  s_waitcnt vmcnt(2) lgkmcnt(3)
  v_mfma_f32_16x16x32_bf16 v[8:11], v[0:3], v[20:23], 0
  s_waitcnt vmcnt(0) lgkmcnt(1)
  v_mfma_f32_16x16x32_bf16 v[8:11], v[4:7], v[24:27], v[8:11]
  v_mfma_f32_16x16x32_bf16 v[12:15], v[28:31], v[20:23], 0
  s_waitcnt lgkmcnt(0)
  v_mfma_f32_16x16x32_bf16 v[12:15], v[32:35], v[24:27], v[12:15]
  v_add_f32_dpp v8, v10, v8 quad_perm:[2,3,0,1] row_mask:0xf bank_mask:0xf
  v_add_f32_dpp v9, v11, v9 quad_perm:[2,3,0,1] row_mask:0xf bank_mask:0xf
  s_nop 0
  v_mov_b32_dpp v8, v8 quad_perm:[0,1,0,1] row_mask:0xf bank_mask:0xf
  v_mov_b32_dpp v9, v9 quad_perm:[0,1,0,1] row_mask:0xf bank_mask:0xf
  s_nop 1
  v_add_f32_dpp v12, v14, v12 quad_perm:[2,3,0,1] row_mask:0xf bank_mask:0xf
  v_add_f32_dpp v13, v15, v13 quad_perm:[2,3,0,1] row_mask:0xf bank_mask:0xf
  s_nop 0
  v_mov_b32_dpp v12, v12 quad_perm:[0,1,0,1] row_mask:0xf bank_mask:0xf
  v_mov_b32_dpp v13, v13 quad_perm:[0,1,0,1] row_mask:0xf bank_mask:0xf
  v_mul_f32 v12, s69, v12
  ds_write_b32 v78, v8 offset:8716
  v_mul_f32 v13, s69, v13
  ds_write_b32 v78, v9 offset:8780
  s_waitcnt lgkmcnt(0)
  s_barrier
  ds_read_b128 v[36:39], v78 offset:8704
  ds_read_b128 v[40:43], v78 offset:8768
  s_waitcnt lgkmcnt(0)
  s_barrier
  v_max_f32 v16, v36, v37
  v_max3_f32 v16, v16, v38, v39
  v_max3_f32 v16, v16, v40, v41
  v_max3_f32 v16, v16, v42, v43
  v_max3_f32 v16, v16, v12, v13
  v_mov_b32 v17, v16
  s_nop 1
  v_permlane16_swap_b32 v16, v17
  v_max_f32 v16, v16, v17
  v_mov_b32 v17, v16
  s_nop 1
  v_permlane32_swap_b32 v16, v17
  v_max_f32 v16, v16, v17
  v_sub_f32 v36, v36, v16
  v_sub_f32 v37, v37, v16
  v_sub_f32 v38, v38, v16
  v_sub_f32 v39, v39, v16
  v_sub_f32 v40, v40, v16
  v_sub_f32 v41, v41, v16
  v_sub_f32 v42, v42, v16
  v_sub_f32 v43, v43, v16
  v_sub_f32 v12, v12, v16
  v_sub_f32 v13, v13, v16
  v_exp_f32 v36, v36
  v_exp_f32 v37, v37
  v_exp_f32 v38, v38
  v_exp_f32 v39, v39
  v_exp_f32 v40, v40
  v_exp_f32 v41, v41
  v_exp_f32 v42, v42
  v_exp_f32 v43, v43
  v_exp_f32 v12, v12
  v_exp_f32 v13, v13
  v_cvt_pk_bf16_f32 v32, v36, v40
  v_cvt_pk_bf16_f32 v33, v37, v41
  v_cvt_pk_bf16_f32 v34, v38, v42
  v_cvt_pk_bf16_f32 v35, v39, v43
  v_cvt_pk_bf16_f32 v28, v12, v13
  v_cvt_pk_bf16_f32 v31, v12, v13
  v_mov_b32 v29, 0
  v_mov_b32 v30, 0
  v_mfma_f32_16x16x32_bf16 v[8:11], v[32:35], v[68:71], 0
  v_mfma_f32_16x16x32_bf16 v[0:3], v[32:35], v[52:55], 0
  v_mfma_f32_16x16x32_bf16 v[4:7], v[32:35], v[56:59], 0
  v_mfma_f32_16x16x16_bf16 v[8:11], v[28:29], v[68:69], v[8:11]
  v_mfma_f32_16x16x16_bf16 v[0:3], v[28:29], v[72:73], v[0:3]
  v_mfma_f32_16x16x16_bf16 v[4:7], v[30:31], v[72:73], v[4:7]
  ds_read_b128 v[52:55], v75 offset:30720
  v_rcp_f32 v10, v8
  v_rcp_f32 v11, v9
  v_mul_f32 v0, v10, v0
  v_mul_f32 v1, v11, v1
  v_max3_f32 v8, v8, v9, v10
  v_mul_f32 v4, v10, v4
  v_mul_f32 v5, v11, v5
  v_cvt_pk_bf16_f32 v2, v0, v4
  ds_write_b32 v79, v2 offset:8704
  v_cvt_pk_bf16_f32 v3, v1, v5
  ds_write_b32 v79, v3 offset:9280
  ds_read_b128 v[12:15], v78 offset:8896
  ds_read_b128 v[56:59], v75 offset:31744
  v_mov_b64 v[16:17], 0
  v_mov_b64 v[18:19], 0
  v_mov_b64 v[20:21], 0
  v_mov_b64 v[22:23], 0
  v_mov_b64 v[24:25], 0
  v_mov_b64 v[26:27], 0
  s_branch Cf3_mxok
Cf3_last:
  ds_read_b128 v[0:3], v76 offset:4608
  ds_read_b128 v[12:15], v76 offset:7680
  ds_read_b128 v[44:47], v76 offset:28672
  ds_read_b128 v[48:51], v76 offset:29696
  s_nop 5
  v_mov_b64 v[20:21], 0
  v_mov_b64 v[22:23], 0
  v_mov_b64 v[24:25], 0
  v_mov_b64 v[26:27], 0
  v_smfmac_f32_16x16x64_bf16 v[28:31], v[4:7], v[36:43], v74
  ds_read_b128 v[36:39], v76 offset:30720
  ds_read_b128 v[40:43], v76 offset:31744
  v_smfmac_f32_16x16x64_bf16 v[32:35], v[4:7], v[60:67], v74
  s_waitcnt lgkmcnt(5)
  v_smfmac_f32_16x16x64_bf16 v[20:23], v[0:3], a[32:39], v74
  ds_read_b128 v[60:63], v76 offset:61440
  ds_read_b128 v[64:67], v76 offset:62464
  v_smfmac_f32_16x16x64_bf16 v[24:27], v[0:3], a[40:47], v74
  s_waitcnt lgkmcnt(4)
  v_smfmac_f32_16x16x64_bf16 v[20:23], v[4:7], a[48:55], v74
  buffer_store_dwordx4 v[16:19], v76, s[8:11], s68 offen sc1
  v_smfmac_f32_16x16x64_bf16 v[24:27], v[4:7], a[56:63], v74
  v_smfmac_f32_16x16x64_bf16 v[28:31], v[0:3], v[44:51], v74
  s_waitcnt lgkmcnt(2)
  v_smfmac_f32_16x16x64_bf16 v[20:23], v[8:11], a[64:71], v74
  ds_read_b128 v[44:47], v76 offset:63488
  ds_read_b128 v[48:51], v76 offset:64512
  v_smfmac_f32_16x16x64_bf16 v[24:27], v[8:11], a[72:79], v74
  v_smfmac_f32_16x16x64_bf16 v[32:35], v[0:3], v[36:43], v74
  v_smfmac_f32_16x16x64_bf16 v[28:31], v[8:11], v[208:215], v74
  ds_read_b128 v[36:39], v75 offset:28672
  ds_read_b128 v[40:43], v75 offset:29696
  v_smfmac_f32_16x16x64_bf16 v[32:35], v[8:11], v[216:223], v74
  v_smfmac_f32_16x16x64_bf16 v[20:23], v[12:15], a[80:87], v74
  v_smfmac_f32_16x16x64_bf16 v[24:27], v[12:15], a[88:95], v74
  v_smfmac_f32_16x16x64_bf16 v[28:31], v[12:15], v[224:231], v74
  v_smfmac_f32_16x16x64_bf16 v[32:35], v[12:15], v[232:239], v74
  s_waitcnt vmcnt(1)
  s_barrier
Cf3_lastr:
  ds_read_b128 v[4:7], v76 offset:8704
  ds_read_b128 v[8:11], v76 offset:9728
  ds_read_b128 v[16:19], v76 offset:10752
  ds_read_b128 v[0:3], v76 offset:11776
  ds_read_b128 v[12:15], v76 offset:12800
  s_waitcnt lgkmcnt(1)
  v_max3_u32 v72, v0, v1, v2
  v_max3_u32 v72, v72, v3, v4
  v_max3_u32 v72, v72, v5, v6
  v_max3_u32 v72, v72, v7, v8
  v_max3_u32 v72, v72, v9, v10
  s_waitcnt lgkmcnt(0)
  v_max3_u32 v72, v72, v11, v12
  v_max3_u32 v72, v72, v13, v14
  v_max3_u32 v72, v72, v15, v16
  v_max3_u32 v72, v72, v17, v18
  v_max_u32 v72, v72, v19
  v_cmp_eq_u32 vcc, -1, v72
  s_cbranch_vccnz Cf3_lastp
Cf3_lastg:
  v_smfmac_f32_16x16x64_bf16 v[28:31], v[4:7], v[60:67], v74
  ds_read_b128 v[60:63], v75 offset:30720
  ds_read_b128 v[64:67], v75 offset:31744
  v_smfmac_f32_16x16x64_bf16 v[32:35], v[4:7], v[44:51], v74
  v_smfmac_f32_16x16x64_bf16 v[28:31], v[8:11], v[36:43], v74
  v_smfmac_f32_16x16x64_bf16 v[28:31], v[16:19], v[240:247], v74
  v_smfmac_f32_16x16x64_bf16 v[28:31], v[0:3], a[0:7], v74
  v_smfmac_f32_16x16x64_bf16 v[28:31], v[12:15], a[16:23], v74
  v_smfmac_f32_16x16x64_bf16 v[32:35], v[16:19], v[248:255], v74
  v_smfmac_f32_16x16x64_bf16 v[32:35], v[0:3], a[8:15], v74
  s_waitcnt lgkmcnt(0)
  v_smfmac_f32_16x16x64_bf16 v[32:35], v[12:15], a[24:31], v74
  v_smfmac_f32_16x16x64_bf16 v[32:35], v[8:11], v[60:67], v74
  v_smfmac_f32_16x16x64_bf16 v[20:23], v[4:7], a[96:103], v74
  v_smfmac_f32_16x16x64_bf16 v[20:23], v[8:11], a[112:119], v74
  v_add_f32 v28, v28, v30
  v_add_f32 v32, v32, v34
  v_cvt_pk_bf16_f32 v30, v28, v32
  v_smfmac_f32_16x16x64_bf16 v[20:23], v[16:19], a[128:135], v74
  ds_write_b32 v79, v30 offset:256
  v_add_f32 v29, v29, v31
  v_add_f32 v33, v33, v35
  v_cvt_pk_bf16_f32 v31, v29, v33
  v_smfmac_f32_16x16x64_bf16 v[20:23], v[0:3], a[144:151], v74
  ds_write_b32 v79, v31 offset:832
  v_smfmac_f32_16x16x64_bf16 v[20:23], v[12:15], a[160:167], v74
  v_smfmac_f32_16x16x64_bf16 v[24:27], v[4:7], a[104:111], v74
  v_smfmac_f32_16x16x64_bf16 v[24:27], v[8:11], a[120:127], v74
  v_smfmac_f32_16x16x64_bf16 v[24:27], v[16:19], a[136:143], v74
  s_waitcnt lgkmcnt(0)
  s_barrier
  ds_read_b64 v[52:53], v77 offset:392
  v_add_f32 v20, v20, v22
  v_smfmac_f32_16x16x64_bf16 v[24:27], v[0:3], a[152:159], v74
  v_add_f32 v21, v21, v23
  v_smfmac_f32_16x16x64_bf16 v[24:27], v[12:15], a[168:175], v74
  v_cvt_pk_bf16_f32 v54, v20, v21
  s_add_u32 s68, s68, 655360
  s_nop 3
  v_add_f32 v24, v24, v26
  v_add_f32 v25, v25, v27
  v_cvt_pk_bf16_f32 v55, v24, v25
  s_waitcnt lgkmcnt(0)
  buffer_store_dwordx4 v[52:55], v76, s[8:11], s68 offen sc1
  s_branch Cf3_done
Cf3_lastp:
  s_add_u32 s72, s72, 2
  s_cmp_ge_u32 s72, 131072
  s_cbranch_scc1 Cf3_lastg
  s_barrier
  buffer_load_dwordx4 v76, s[8:11], s85 offen offset:0 sc1 lds
  buffer_load_dwordx4 v76, s[8:11], s85 offen offset:1024 sc1 lds
  s_waitcnt vmcnt(0)
  s_barrier
  s_branch Cf3_lastr
Cf3_done:
  s_branch L_cexit
L_w4:
  v_mov_b64 v[20:21], 0
  v_mov_b64 v[22:23], 0
  v_mov_b64 v[24:25], 0
  v_mov_b64 v[26:27], 0
  v_mov_b64 v[28:29], 0
  v_mov_b64 v[30:31], 0
  v_mov_b64 v[32:33], 0
  v_mov_b64 v[34:35], 0
  s_mov_b32 s78, 0x3f803f80
  s_mov_b32 s79, s78
  s_mov_b32 s65, 360448
  s_mov_b32 m0, 16128
  s_lshl_b32 s71, s53, 2
  s_add_u32 s71, s71, 128
  s_movk_i32 s56, 0x1000
  v_lshlrev_b32 v73, 2, v76
  v_mov_b32 v72, 0
  s_mov_b64 s[16:17], s[8:9]
  s_mov_b32 s18, 268435456
  s_mov_b32 s19, 0x20000
  s_getpc_b64 s[20:21]
Cs0_pc:
  s_add_u32 s20, s20, (Cs0_last - Cs0_pc)
  s_addc_u32 s21, s21, 0
  v_mov_b32 v68, 14880
  buffer_load_dwordx4 v[52:55], v76, s[8:11], s59 offen offset:0 sc1
  buffer_load_dwordx4 v[56:59], v76, s[8:11], s59 offen offset:1024 sc1
  ds_read_b128 v[36:39], v76 offset:16384
  ds_read_b128 v[40:43], v76 offset:17408
  ds_read_b128 v[60:63], v76 offset:18432
  ds_read_b128 v[64:67], v76 offset:19456
  ds_read_b128 v[0:3], v76 offset:4608
  ds_read_b128 v[4:7], v76 offset:5632
  ds_read_b128 v[8:11], v76 offset:6656
  ds_read_b128 v[12:15], v76 offset:7680
  s_waitcnt lgkmcnt(0)
  s_cmp_eq_u32 s66, 1
  s_branch Cs0_top2
.p2align 6
Cs0_h2:
  ds_read_b128 v[36:39], v76 offset:16384
  v_mov_b64 v[20:21], 0
  v_mov_b64 v[22:23], 0
  v_mov_b64 v[24:25], 0
  v_mov_b64 v[26:27], 0
  v_mov_b32 v68, 14880
  ds_read_b128 v[40:43], v76 offset:17408
  s_cmp_eq_u32 s66, 62
  s_cselect_b64 s[16:17], s[20:21], s[16:17]
  s_cselect_b32 s18, (Cs0_done - Cs0_last), s18
  s_cselect_b32 s70, 0, s70
  s_cmp_eq_u32 s66, 63
  s_cselect_b32 s59, 268435456, s59
  s_cselect_b32 s58, 268435456, s58
  ds_read_b128 v[60:63], v76 offset:18432
  v_lshlrev_b32 v73, 2, v76
  s_cmp_eq_u32 s66, 12
  s_cselect_b32 s56, s71, 0x1000
  ds_read_b32 v72, v76 offset:16128
  s_cmp_eq_u32 s66, 13
  s_cselect_b32 s54, 0x700, 0
  s_waitcnt lgkmcnt(0)
  v_readfirstlane_b32 s57, v72
  s_nop 0
  s_cmp_lt_u32 s57, s54
  s_cbranch_scc1 Cs0_kv3
Cs0_kvb:
  buffer_load_dwordx4 v[52:55], v76, s[8:11], s59 offen offset:0 sc1
  buffer_load_dwordx4 v[56:59], v76, s[8:11], s59 offen offset:1024 sc1
  s_waitcnt vmcnt(0)
  s_mov_b64 vcc, -1
Cs0_h2r:
  s_mov_b64 exec, vcc
  buffer_load_dwordx4 v[0:3], v76, s[8:11], s65 offen offset:0 sc1
  buffer_load_dwordx4 v[4:7], v76, s[8:11], s85 offen offset:0 sc1
  s_mov_b64 exec, -1
  s_add_u32 s67, s67, 1
  s_cmp_lt_u32 s67, 131072
  s_cselect_b32 s54, -2, -1
  s_waitcnt vmcnt(1)
  v_max3_u32 v72, v0, v1, v2
  s_waitcnt vmcnt(0)
  v_max3_u32 v72, v72, v3, v4
  v_max3_u32 v72, v72, v5, v6
  v_max_u32 v72, v72, v7
  v_cmp_lt_u32 vcc, s54, v72
  s_cbranch_vccnz Cs0_h2r
  ds_write_b128 v76, v[0:3] offset:4608
  ds_write_b128 v76, v[4:7] offset:10752
Cs0_h2w:
  s_cmp_eq_u32 s66, 63
  s_waitcnt lgkmcnt(0)
  s_barrier
  ds_read_b128 v[8:11], v76 offset:6656
Cs0_top2:
  v_smfmac_f32_16x16x64_bf16 v[20:23], v[0:3], v[80:87], v74
  s_cbranch_scc1 Cs0_last
  v_smfmac_f32_16x16x64_bf16 v[28:31], v[0:3], v[36:43], v74
  buffer_load_dwordx4 v[44:47], v76, s[8:11], s58 offen offset:0 sc1
  s_mov_b32 m0, 16128
  v_smfmac_f32_16x16x64_bf16 v[24:27], v[0:3], v[88:95], v74
  buffer_load_dwordx4 v[48:51], v76, s[8:11], s58 offen offset:1024 sc1
  v_smfmac_f32_16x16x64_bf16 v[32:35], v[0:3], v[60:67], v74
  ds_read_b128 v[4:7], v76 offset:5632
  s_waitcnt lgkmcnt(1)
  v_smfmac_f32_16x16x64_bf16 v[20:23], v[8:11], v[112:119], v74
  ds_read_b128 v[12:15], v76 offset:7680
  v_smfmac_f32_16x16x64_bf16 v[24:27], v[8:11], v[120:127], v74
  ds_read_b128 v[36:39], v76 offset:32768
  v_smfmac_f32_16x16x64_bf16 v[28:31], v[8:11], v[208:215], v74
  buffer_store_dwordx4 v[16:19], v76, s[8:11], s68 offen sc1
  ds_read_b128 v[40:43], v76 offset:33792
  v_smfmac_f32_16x16x64_bf16 v[32:35], v[8:11], v[216:223], v74
  buffer_load_dword v73, s[16:19], s70 offen lds
  ds_read_b128 v[60:63], v76 offset:34816
  s_waitcnt lgkmcnt(4)
  v_smfmac_f32_16x16x64_bf16 v[20:23], v[4:7], v[96:103], v74
  ds_read_b128 v[64:67], v76 offset:35840
  v_smfmac_f32_16x16x64_bf16 v[24:27], v[4:7], v[104:111], v74
  s_waitcnt vmcnt(4)
  s_waitcnt lgkmcnt(4)
  v_smfmac_f32_16x16x64_bf16 v[20:23], v[12:15], v[128:135], v74
  s_barrier
  ds_read_b128 v[0:3], v76 offset:8704
  s_waitcnt lgkmcnt(3)
  v_smfmac_f32_16x16x64_bf16 v[28:31], v[4:7], v[36:43], v74
  ds_read_b128 v[36:39], v76 offset:49152
  v_smfmac_f32_16x16x64_bf16 v[24:27], v[12:15], v[136:143], v74
  ds_read_b128 v[40:43], v76 offset:50176
  s_waitcnt lgkmcnt(3)
  v_smfmac_f32_16x16x64_bf16 v[32:35], v[4:7], v[60:67], v74
  ds_read_b128 v[8:11], v76 offset:9728
  v_smfmac_f32_16x16x64_bf16 v[28:31], v[12:15], v[224:231], v74
  ds_read_b128 v[60:63], v76 offset:51200
  v_smfmac_f32_16x16x64_bf16 v[32:35], v[12:15], v[232:239], v74
  ds_read_b128 v[64:67], v76 offset:52224
  s_waitcnt lgkmcnt(5)
  v_smfmac_f32_16x16x64_bf16 v[20:23], v[0:3], v[144:151], v74
  s_barrier
  ds_read_b128 v[4:7], v76 offset:11776
  s_waitcnt lgkmcnt(4)
  v_smfmac_f32_16x16x64_bf16 v[28:31], v[0:3], v[36:43], v74
  ds_read_b128 v[12:15], v76 offset:12800
  ds_read_b128 v[36:39], v75 offset:0
  v_smfmac_f32_16x16x64_bf16 v[24:27], v[0:3], v[152:159], v74
  ds_read_b128 v[16:19], v76 offset:10752
  s_waitcnt lgkmcnt(6)
  v_smfmac_f32_16x16x64_bf16 v[20:23], v[8:11], v[160:167], v74
  ds_read_b128 v[40:43], v75 offset:1024
  s_waitcnt lgkmcnt(5)
  v_smfmac_f32_16x16x64_bf16 v[32:35], v[0:3], v[60:67], v74
  ds_read_b128 v[60:63], v75 offset:2048
  v_smfmac_f32_16x16x64_bf16 v[24:27], v[8:11], v[168:175], v74
  ds_read_b128 v[64:67], v75 offset:3072
  s_waitcnt lgkmcnt(6)
  v_smfmac_f32_16x16x64_bf16 v[20:23], v[4:7], v[176:183], v74
  buffer_load_dword off, s[12:15], s56 sc1 lds
  s_waitcnt lgkmcnt(5)
  v_smfmac_f32_16x16x64_bf16 v[20:23], v[12:15], v[192:199], v74
  s_waitcnt lgkmcnt(2)
  v_smfmac_f32_16x16x64_bf16 v[20:23], v[16:19], v[36:43], v74
  ds_read_b128 v[36:39], v75 offset:16384
  v_smfmac_f32_16x16x64_bf16 v[24:27], v[4:7], v[184:191], v74
  ds_read_b128 v[40:43], v75 offset:17408
  s_waitcnt lgkmcnt(2)
  v_smfmac_f32_16x16x64_bf16 v[24:27], v[16:19], v[60:67], v74
  ds_read_b128 v[60:63], v75 offset:18432
  v_add_f32 v20, v20, v22
  v_smfmac_f32_16x16x64_bf16 v[24:27], v[12:15], v[200:207], v74
  ds_read_b128 v[64:67], v75 offset:19456
  v_add_f32 v21, v21, v23
  v_smfmac_f32_16x16x64_bf16 v[28:31], v[16:19], v[240:247], v74
  v_mov_b64 v[70:71], s[78:79]
  v_smfmac_f32_16x16x64_bf16 v[28:31], v[4:7], a[0:7], v74
  s_waitcnt lgkmcnt(2)
  v_add_f32 v24, v24, v26
  v_smfmac_f32_16x16x64_bf16 v[28:31], v[8:11], v[36:43], v74
  ds_read_b128 v[36:39], v68
  v_cvt_pk_bf16_f32 v22, v20, v24
  v_smfmac_f32_16x16x64_bf16 v[28:31], v[12:15], a[16:23], v74
  ds_read_b128 v[40:43], v68
  ds_write_b32 v79, v22 offset:0
  s_waitcnt lgkmcnt(3)
  v_add_f32 v25, v25, v27
  v_cvt_pk_bf16_f32 v23, v21, v25
  v_smfmac_f32_16x16x64_bf16 v[32:35], v[8:11], v[60:67], v74
  ds_write_b32 v79, v23 offset:576
  v_cmp_u_f32 vcc, v20, v21
  v_smfmac_f32_16x16x64_bf16 v[32:35], v[16:19], v[248:255], v74
  v_add_f32 v28, v28, v30
  v_smfmac_f32_16x16x64_bf16 v[32:35], v[4:7], a[8:15], v74
  v_add_f32 v29, v29, v31
  v_smfmac_f32_16x16x64_bf16 v[32:35], v[12:15], a[24:31], v74
  s_cbranch_vccnz Cs0_rec
Cs0_recok:
  s_waitcnt lgkmcnt(3)
  v_smfmac_f32_16x16x64_bf16 v[36:39], v[16:19], a[128:135], v74
  s_waitcnt lgkmcnt(0)
  s_barrier
  ds_read_b128 v[60:63], v77
  v_smfmac_f32_16x16x64_bf16 v[40:43], v[16:19], a[136:143], v74
  ds_read_b128 v[64:67], v77 offset:128
  v_add_f32 v32, v32, v34
  v_cvt_pk_bf16_f32 v30, v28, v32
  v_smfmac_f32_16x16x64_bf16 v[36:39], v[0:3], a[96:103], v74
  ds_write_b32 v79, v30 offset:256
  v_add_f32 v33, v33, v35
  v_cvt_pk_bf16_f32 v31, v29, v33
  v_smfmac_f32_16x16x64_bf16 v[40:43], v[0:3], a[104:111], v74
  ds_write_b32 v79, v31 offset:832
  v_xor_b32 v75, 0x8000, v75
  v_smfmac_f32_16x16x64_bf16 v[36:39], v[4:7], a[144:151], v74
  ds_read_b128 v[0:3], v76 offset:4608
  v_mov_b32 v29, 0
  v_smfmac_f32_16x16x64_bf16 v[40:43], v[4:7], a[152:159], v74
  s_waitcnt vmcnt(3) lgkmcnt(3)
  v_mov_b32 v30, 0
  v_mfma_f32_16x16x32_bf16 v[44:47], v[44:47], v[60:63], 0
  ds_read_b128 v[4:7], v76 offset:5632
  s_waitcnt lgkmcnt(2)
  v_mfma_f32_16x16x32_bf16 v[44:47], v[48:51], v[64:67], v[44:47]
  s_barrier
  v_smfmac_f32_16x16x64_bf16 v[36:39], v[8:11], a[112:119], v74
  ds_read_b128 v[20:23], v77 offset:256
  ds_read_b128 v[24:27], v77 offset:384
  v_smfmac_f32_16x16x64_bf16 v[40:43], v[8:11], a[120:127], v74
  ds_read_b128 v[8:11], v76 offset:6656
  v_add_f32_dpp v72, v46, v44 quad_perm:[2,3,0,1] row_mask:0xf bank_mask:0xf
  v_add_f32_dpp v73, v47, v45 quad_perm:[2,3,0,1] row_mask:0xf bank_mask:0xf
  v_smfmac_f32_16x16x64_bf16 v[36:39], v[12:15], a[160:167], v74
  s_waitcnt lgkmcnt(4)
  v_exp_f32_dpp v72, v72 quad_perm:[0,1,0,1] row_mask:0xf bank_mask:0xf
  v_smfmac_f32_16x16x64_bf16 v[40:43], v[12:15], a[168:175], v74
  ds_read_b128 v[12:15], v76 offset:7680
  v_exp_f32_dpp v73, v73 quad_perm:[0,1,0,1] row_mask:0xf bank_mask:0xf
  v_smfmac_f32_16x16x64_bf16 v[36:39], v[0:3], a[32:39], v74
  s_waitcnt lgkmcnt(2)
  v_cvt_pk_bf16_f32 v72, v72, v73
  v_mfma_f32_16x16x32_bf16 v[20:23], v[20:23], v[60:63], 0
  ds_write_b32 v78, v72 offset:512
  v_mov_b64 v[16:17], 0
  v_mfma_f32_16x16x32_bf16 v[20:23], v[24:27], v[64:67], v[20:23]
  ds_read_b128 v[44:47], v75 offset:16384
  v_mov_b64 v[18:19], 0
  v_smfmac_f32_16x16x64_bf16 v[40:43], v[0:3], a[40:47], v74
  ds_read_b128 v[48:51], v75 offset:17408
  v_mov_b64 v[68:69], s[78:79]
  v_smfmac_f32_16x16x64_bf16 v[36:39], v[4:7], a[48:55], v74
  s_waitcnt lgkmcnt(4)
  v_add_f32_dpp v24, v22, v20 quad_perm:[2,3,0,1] row_mask:0xf bank_mask:0xf
  v_add_f32_dpp v25, v23, v21 quad_perm:[2,3,0,1] row_mask:0xf bank_mask:0xf
  v_smfmac_f32_16x16x64_bf16 v[36:39], v[8:11], a[64:71], v74
  s_waitcnt lgkmcnt(2)
  s_barrier
  ds_read_b128 v[32:35], v78 offset:512
  v_smfmac_f32_16x16x64_bf16 v[36:39], v[12:15], a[80:87], v74
  ds_read_b128 v[60:63], v75 offset:18432
  v_mul_f32 v24, s69, v24
  v_smfmac_f32_16x16x64_bf16 v[40:43], v[4:7], a[56:63], v74
  ds_read_b128 v[64:67], v75 offset:19456
  v_mul_f32 v25, s69, v25
  v_smfmac_f32_16x16x64_bf16 v[40:43], v[8:11], a[72:79], v74
  v_exp_f32_dpp v24, v24 quad_perm:[0,1,0,1] row_mask:0xf bank_mask:0xf
  v_smfmac_f32_16x16x64_bf16 v[40:43], v[12:15], a[88:95], v74
  s_waitcnt lgkmcnt(2)
  v_exp_f32_dpp v25, v25 quad_perm:[0,1,0,1] row_mask:0xf bank_mask:0xf
  v_mfma_f32_16x16x32_bf16 v[8:11], v[32:35], v[68:71], 0
  v_add_f32 v36, v36, v38
  v_add_f32 v37, v37, v39
  v_mfma_f32_16x16x32_bf16 v[0:3], v[32:35], v[52:55], 0
  v_add_f32 v40, v40, v42
  v_add_f32 v41, v41, v43
  v_mfma_f32_16x16x32_bf16 v[4:7], v[32:35], v[56:59], 0
  v_cvt_pk_bf16_f32 v28, v24, v25
  v_cvt_pk_bf16_f32 v72, v36, v37
  v_cvt_pk_bf16_f32 v73, v40, v41
  v_mfma_f32_16x16x16_bf16 v[8:11], v[28:29], v[68:69], v[8:11]
  v_cvt_pk_bf16_f32 v31, v24, v25
  v_mov_b64 v[20:21], 0
  v_mfma_f32_16x16x16_bf16 v[0:3], v[28:29], v[72:73], v[0:3]
  ds_read_b128 v[52:55], v75 offset:32768
  v_mov_b64 v[22:23], 0
  v_mfma_f32_16x16x16_bf16 v[4:7], v[30:31], v[72:73], v[4:7]
  v_rcp_f32 v10, v8
  v_rcp_f32 v11, v9
  v_mul_f32 v0, v10, v0
  v_mul_f32 v1, v11, v1
  v_max3_f32 v8, v8, v9, v10
  v_mul_f32 v4, v10, v4
  v_mul_f32 v5, v11, v5
  v_cvt_pk_bf16_f32 v2, v0, v4
  ds_write_b32 v79, v2 offset:8704
  v_cvt_pk_bf16_f32 v3, v1, v5
  ds_write_b32 v79, v3 offset:9280
  ds_read_b128 v[12:15], v78 offset:8704
  v_max_f32 v8, v8, v11
  v_cmp_le_f32 vcc, 1317011456, v8
  v_mov_b64 v[24:25], 0
  v_mov_b64 v[26:27], 0
  ds_read_b128 v[56:59], v75 offset:33792
  s_cbranch_vccnz Cs0_mx
Cs0_mxok:
  s_waitcnt lgkmcnt(2)
  s_barrier
  ds_read_b128 v[0:3], v78 offset:8768
  s_waitcnt lgkmcnt(2)
  v_smfmac_f32_16x16x64_bf16 v[16:19], v[12:15], v[44:51], v74
  ds_read_b128 v[4:7], v78 offset:8832
  v_smfmac_f32_16x16x64_bf16 v[20:23], v[12:15], a[192:199], v74
  ds_read_b128 v[8:11], v78 offset:8896
  v_smfmac_f32_16x16x64_bf16 v[24:27], v[12:15], a[208:215], v74
  ds_read_b128 v[36:39], v75 offset:34816
  s_waitcnt lgkmcnt(3)
  v_smfmac_f32_16x16x64_bf16 v[16:19], v[0:3], v[60:67], v74
  ds_read_b128 v[40:43], v75 offset:35840
  s_waitcnt lgkmcnt(3)
  v_smfmac_f32_16x16x64_bf16 v[16:19], v[4:7], a[176:183], v74
  ds_read_b128 v[68:71], v76 offset:13824
  s_waitcnt lgkmcnt(3)
  v_smfmac_f32_16x16x64_bf16 v[16:19], v[8:11], a[184:191], v74
  ds_read_b128 v[44:47], v75 offset:49152
  v_smfmac_f32_16x16x64_bf16 v[20:23], v[0:3], a[200:207], v74
  ds_read_b128 v[48:51], v75 offset:50176
  v_smfmac_f32_16x16x64_bf16 v[20:23], v[4:7], v[52:59], v74
  ds_read_b128 v[60:63], v75 offset:51200
  s_waitcnt lgkmcnt(4)
  v_cvt_pk_bf16_f32 v16, v16, v17
  v_cvt_pk_bf16_f32 v17, v18, v19
  v_bfi_b32 v16, 1, s72, v16
  v_smfmac_f32_16x16x64_bf16 v[20:23], v[8:11], v[36:43], v74
  s_waitcnt lgkmcnt(3)
  buffer_store_dwordx2 v[16:17], v68, s[8:11], s73 offen sc1
  v_mov_b64 v[32:33], 0
  v_smfmac_f32_16x16x64_bf16 v[24:27], v[0:3], a[216:223], v74
  ds_read_b128 v[64:67], v75 offset:52224
  v_mov_b64 v[34:35], 0
  v_smfmac_f32_16x16x64_bf16 v[24:27], v[4:7], a[224:231], v74
  v_cvt_pk_bf16_f32 v20, v20, v21
  v_cvt_pk_bf16_f32 v21, v22, v23
  v_bfi_b32 v20, 1, s72, v20
  v_smfmac_f32_16x16x64_bf16 v[24:27], v[8:11], a[232:239], v74
  buffer_store_dwordx2 v[20:21], v68, s[8:11], s74 offen sc1
  s_waitcnt lgkmcnt(2)
  v_smfmac_f32_16x16x64_bf16 v[32:35], v[12:15], v[44:51], v74
  s_waitcnt lgkmcnt(0)
  v_smfmac_f32_16x16x64_bf16 v[32:35], v[0:3], v[60:67], v74
  v_cvt_pk_bf16_f32 v24, v24, v25
  v_cvt_pk_bf16_f32 v25, v26, v27
  v_bfi_b32 v24, 1, s72, v24
  v_smfmac_f32_16x16x64_bf16 v[32:35], v[4:7], a[240:247], v74
  buffer_store_dwordx2 v[24:25], v68, s[8:11], s75 offen sc1
  v_smfmac_f32_16x16x64_bf16 v[32:35], v[8:11], a[248:255], v74
  v_mov_b64 v[18:19], v[72:73]
  s_nop 4
  v_cvt_pk_bf16_f32 v32, v32, v33
  v_cvt_pk_bf16_f32 v33, v34, v35
  v_bfi_b32 v32, 1, s72, v32
  buffer_store_dwordx2 v[32:33], v68, s[8:11], s76 offen sc1
  ds_read_b128 v[0:3], v76 offset:14848
  s_waitcnt lgkmcnt(0)
  ds_read_b64 v[16:17], v77 offset:256
  s_waitcnt lgkmcnt(0)
  ds_read_b128 v[64:67], v76 offset:19456
  s_waitcnt lgkmcnt(0)
  v_xor_b32 v75, 0x8000, v75
  v_mov_b64 v[28:29], 0
  v_mov_b64 v[30:31], 0
  v_mov_b64 v[32:33], 0
  v_mov_b64 v[34:35], 0
  s_waitcnt vmcnt(0)
  buffer_load_dwordx4 v[52:55], v76, s[8:11], s60 offen offset:0 sc1
  buffer_load_dwordx4 v[56:59], v76, s[8:11], s60 offen offset:1024 sc1
  s_add_u32 s66, s66, 1
  s_xor_b32 s64, s64, 16384
  s_xor_b32 s65, s65, 16384
  s_add_u32 s58, s58, 655360
  s_add_u32 s59, s59, 655360
  s_add_u32 s70, s70, 655360
  s_add_u32 s68, s68, 655360
  s_mov_b32 m0, 10752
  s_add_u32 s85, s65, 6144
  s_waitcnt lgkmcnt(0)
  s_waitcnt vmcnt(1)
  v_mfma_f32_16x16x32_bf16 v[4:7], v[0:3], v[52:55], 0
  v_bitop3_b32 v72, v52, v54, s72 bitop3:0x7e
  s_waitcnt vmcnt(0)
  v_mfma_f32_16x16x32_bf16 v[4:7], v[0:3], v[56:59], v[4:7]
  v_bitop3_b32 v73, v56, v58, s72 bitop3:0x7e
  v_bitop3_b32 v72, v72, v73, 1 bitop3:0xa8
  v_cmp_ne_u32 vcc, 0, v72
  s_cbranch_vccnz Cs0_h1r
  s_nop 2
  v_add_f32_dpp v4, v4, v4 row_ror:4 row_mask:0xf bank_mask:0xf
  v_add_f32_dpp v5, v5, v5 row_ror:4 row_mask:0xf bank_mask:0xf
  s_nop 0
  v_add_f32_dpp v4, v4, v4 row_ror:8 row_mask:0xf bank_mask:0xf
  v_add_f32_dpp v5, v5, v5 row_ror:8 row_mask:0xf bank_mask:0xf
  v_cvt_pk_bf16_f32 v4, v4, v5
  buffer_store_dword v4, v69, s[8:11], s62 offen sc1
  s_xor_b32 s62, s62, 16384
  buffer_store_dword v71, v69, s[8:11], s62 offen sc1
  s_xor_b32 s72, s72, 1
  s_branch Cs0_h2
Cs0_h1r:
  s_mov_b64 exec, vcc
  buffer_load_dwordx4 v[52:55], v76, s[8:11], s60 offen offset:0 sc1
  buffer_load_dwordx4 v[56:59], v76, s[8:11], s60 offen offset:1024 sc1
  s_mov_b64 exec, -1
  s_add_u32 s67, s67, 1
  s_waitcnt vmcnt(1)
  v_mfma_f32_16x16x32_bf16 v[4:7], v[0:3], v[52:55], 0
  v_bitop3_b32 v72, v52, v54, s72 bitop3:0x7e
  s_waitcnt vmcnt(0)
  v_mfma_f32_16x16x32_bf16 v[4:7], v[0:3], v[56:59], v[4:7]
  v_bitop3_b32 v73, v56, v58, s72 bitop3:0x7e
  v_bitop3_b32 v72, v72, v73, 1 bitop3:0xa8
  v_cmp_ne_u32 vcc, 0, v72
  s_cbranch_vccz Cs0_h1p
Cs0_h1s:
  s_mov_b64 exec, vcc
  buffer_load_dwordx4 v[52:55], v76, s[8:11], s60 offen offset:0 sc1
  buffer_load_dwordx4 v[56:59], v76, s[8:11], s60 offen offset:1024 sc1
  s_mov_b64 exec, -1
  s_add_u32 s67, s67, 1
  s_waitcnt vmcnt(1)
  v_mfma_f32_16x16x32_bf16 v[4:7], v[0:3], v[52:55], 0
  v_bitop3_b32 v72, v52, v54, s72 bitop3:0x7e
  s_waitcnt vmcnt(0)
  v_mfma_f32_16x16x32_bf16 v[4:7], v[0:3], v[56:59], v[4:7]
  v_bitop3_b32 v73, v56, v58, s72 bitop3:0x7e
  v_bitop3_b32 v72, v72, v73, 1 bitop3:0xa8
  v_cmp_ne_u32 vcc, 0, v72
  s_cbranch_vccz Cs0_h1p
  s_cmp_lt_u32 s67, 131072
  s_cbranch_scc1 Cs0_h1s
Cs0_h1p:
  s_nop 2
  v_add_f32_dpp v4, v4, v4 row_ror:4 row_mask:0xf bank_mask:0xf
  v_add_f32_dpp v5, v5, v5 row_ror:4 row_mask:0xf bank_mask:0xf
  s_nop 0
  v_add_f32_dpp v4, v4, v4 row_ror:8 row_mask:0xf bank_mask:0xf
  v_add_f32_dpp v5, v5, v5 row_ror:8 row_mask:0xf bank_mask:0xf
  v_cvt_pk_bf16_f32 v4, v4, v5
  buffer_store_dword v4, v69, s[8:11], s62 offen sc1
  s_xor_b32 s62, s62, 16384
  buffer_store_dword v71, v69, s[8:11], s62 offen sc1
  s_xor_b32 s72, s72, 1
  s_branch Cs0_h2
Cs0_rec:
  s_nop 7
  s_waitcnt vmcnt(0) lgkmcnt(0)
  v_max3_u32 v72, v0, v1, v2
  v_max3_u32 v72, v72, v3, v4
  v_max3_u32 v72, v72, v5, v6
  v_max3_u32 v72, v72, v7, v8
  v_max3_u32 v72, v72, v9, v10
  v_max3_u32 v72, v72, v11, v12
  v_max3_u32 v72, v72, v13, v14
  v_max3_u32 v72, v72, v15, v16
  v_max3_u32 v72, v72, v17, v18
  v_max_u32 v72, v72, v19
  v_cmp_eq_u32 vcc, -1, v72
  s_cbranch_vccz Cs0_recok
  s_barrier
  v_mov_b64 v[20:21], 0
  v_mov_b64 v[22:23], 0
  v_mov_b64 v[24:25], 0
  v_mov_b64 v[26:27], 0
  v_mov_b64 v[28:29], 0
  v_mov_b64 v[30:31], 0
  v_mov_b64 v[32:33], 0
  v_mov_b64 v[34:35], 0
  s_waitcnt lgkmcnt(0)
  s_barrier
  ds_read_b128 v[0:3], v76 offset:4608
  s_waitcnt lgkmcnt(0)
  v_smfmac_f32_16x16x64_bf16 v[20:23], v[0:3], v[80:87], v74
  v_smfmac_f32_16x16x64_bf16 v[24:27], v[0:3], v[88:95], v74
  ds_read_b128 v[60:63], v76 offset:16384
  ds_read_b128 v[64:67], v76 offset:17408
  s_waitcnt lgkmcnt(0)
  v_smfmac_f32_16x16x64_bf16 v[28:31], v[0:3], v[60:67], v74
  ds_read_b128 v[60:63], v76 offset:18432
  ds_read_b128 v[64:67], v76 offset:19456
  s_waitcnt lgkmcnt(0)
  v_smfmac_f32_16x16x64_bf16 v[32:35], v[0:3], v[60:67], v74
  ds_read_b128 v[4:7], v76 offset:5632
  s_waitcnt lgkmcnt(0)
  v_smfmac_f32_16x16x64_bf16 v[20:23], v[4:7], v[96:103], v74
  v_smfmac_f32_16x16x64_bf16 v[24:27], v[4:7], v[104:111], v74
  ds_read_b128 v[60:63], v76 offset:32768
  ds_read_b128 v[64:67], v76 offset:33792
  s_waitcnt lgkmcnt(0)
  v_smfmac_f32_16x16x64_bf16 v[28:31], v[4:7], v[60:67], v74
  ds_read_b128 v[60:63], v76 offset:34816
  ds_read_b128 v[64:67], v76 offset:35840
  s_waitcnt lgkmcnt(0)
  v_smfmac_f32_16x16x64_bf16 v[32:35], v[4:7], v[60:67], v74
  ds_read_b128 v[8:11], v76 offset:6656
  s_waitcnt lgkmcnt(0)
  v_smfmac_f32_16x16x64_bf16 v[20:23], v[8:11], v[112:119], v74
  v_smfmac_f32_16x16x64_bf16 v[24:27], v[8:11], v[120:127], v74
  v_smfmac_f32_16x16x64_bf16 v[28:31], v[8:11], v[208:215], v74
  v_smfmac_f32_16x16x64_bf16 v[32:35], v[8:11], v[216:223], v74
  ds_read_b128 v[12:15], v76 offset:7680
  s_waitcnt lgkmcnt(0)
  v_smfmac_f32_16x16x64_bf16 v[20:23], v[12:15], v[128:135], v74
  v_smfmac_f32_16x16x64_bf16 v[24:27], v[12:15], v[136:143], v74
  v_smfmac_f32_16x16x64_bf16 v[28:31], v[12:15], v[224:231], v74
  v_smfmac_f32_16x16x64_bf16 v[32:35], v[12:15], v[232:239], v74
  ds_read_b128 v[0:3], v76 offset:8704
  s_waitcnt lgkmcnt(0)
  v_smfmac_f32_16x16x64_bf16 v[20:23], v[0:3], v[144:151], v74
  v_smfmac_f32_16x16x64_bf16 v[24:27], v[0:3], v[152:159], v74
  ds_read_b128 v[60:63], v76 offset:49152
  ds_read_b128 v[64:67], v76 offset:50176
  s_waitcnt lgkmcnt(0)
  v_smfmac_f32_16x16x64_bf16 v[28:31], v[0:3], v[60:67], v74
  ds_read_b128 v[60:63], v76 offset:51200
  ds_read_b128 v[64:67], v76 offset:52224
  s_waitcnt lgkmcnt(0)
  v_smfmac_f32_16x16x64_bf16 v[32:35], v[0:3], v[60:67], v74
  ds_read_b128 v[8:11], v76 offset:9728
  s_waitcnt lgkmcnt(0)
  v_smfmac_f32_16x16x64_bf16 v[20:23], v[8:11], v[160:167], v74
  v_smfmac_f32_16x16x64_bf16 v[24:27], v[8:11], v[168:175], v74
  ds_read_b128 v[60:63], v75 offset:16384
  ds_read_b128 v[64:67], v75 offset:17408
  s_waitcnt lgkmcnt(0)
  v_smfmac_f32_16x16x64_bf16 v[28:31], v[8:11], v[60:67], v74
  ds_read_b128 v[60:63], v75 offset:18432
  ds_read_b128 v[64:67], v75 offset:19456
  s_waitcnt lgkmcnt(0)
  v_smfmac_f32_16x16x64_bf16 v[32:35], v[8:11], v[60:67], v74
  ds_read_b128 v[16:19], v76 offset:10752
  ds_read_b128 v[60:63], v75 offset:0
  ds_read_b128 v[64:67], v75 offset:1024
  s_waitcnt lgkmcnt(0)
  v_smfmac_f32_16x16x64_bf16 v[20:23], v[16:19], v[60:67], v74
  ds_read_b128 v[60:63], v75 offset:2048
  ds_read_b128 v[64:67], v75 offset:3072
  s_waitcnt lgkmcnt(0)
  v_smfmac_f32_16x16x64_bf16 v[24:27], v[16:19], v[60:67], v74
  v_smfmac_f32_16x16x64_bf16 v[28:31], v[16:19], v[240:247], v74
  v_smfmac_f32_16x16x64_bf16 v[32:35], v[16:19], v[248:255], v74
  ds_read_b128 v[4:7], v76 offset:11776
  s_waitcnt lgkmcnt(0)
  v_smfmac_f32_16x16x64_bf16 v[20:23], v[4:7], v[176:183], v74
  v_smfmac_f32_16x16x64_bf16 v[24:27], v[4:7], v[184:191], v74
  v_smfmac_f32_16x16x64_bf16 v[28:31], v[4:7], a[0:7], v74
  v_smfmac_f32_16x16x64_bf16 v[32:35], v[4:7], a[8:15], v74
  ds_read_b128 v[12:15], v76 offset:12800
  s_waitcnt lgkmcnt(0)
  v_smfmac_f32_16x16x64_bf16 v[20:23], v[12:15], v[192:199], v74
  v_smfmac_f32_16x16x64_bf16 v[24:27], v[12:15], v[200:207], v74
  v_smfmac_f32_16x16x64_bf16 v[28:31], v[12:15], a[16:23], v74
  v_smfmac_f32_16x16x64_bf16 v[32:35], v[12:15], a[24:31], v74
  v_add_f32 v20, v20, v22
  v_add_f32 v21, v21, v23
  v_add_f32 v24, v24, v26
  v_cvt_pk_bf16_f32 v22, v20, v24
  ds_write_b32 v79, v22 offset:0
  v_add_f32 v25, v25, v27
  v_cvt_pk_bf16_f32 v23, v21, v25
  ds_write_b32 v79, v23 offset:576
  v_add_f32 v28, v28, v30
  v_add_f32 v29, v29, v31
  s_waitcnt lgkmcnt(0)
  s_nop 1
  s_branch Cs0_recok
Cs0_mx:
  s_waitcnt lgkmcnt(0)
  s_barrier
  buffer_load_dwordx4 v[52:55], v76, s[8:11], s59 offen offset:0 sc1
  buffer_load_dwordx4 v[0:3], v76, s[8:11], s58 offen offset:0 sc1
  ds_read_b128 v[20:23], v77 offset:0
  ds_read_b128 v[28:31], v77 offset:256
  buffer_load_dwordx4 v[56:59], v76, s[8:11], s59 offen offset:1024 sc1
  buffer_load_dwordx4 v[4:7], v76, s[8:11], s58 offen offset:1024 sc1
  ds_read_b128 v[24:27], v77 offset:128
  ds_read_b128 v[32:35], v77 offset:384
  s_waitcnt vmcnt(2) lgkmcnt(3)
  v_mfma_f32_16x16x32_bf16 v[8:11], v[0:3], v[20:23], 0
  s_waitcnt vmcnt(0) lgkmcnt(1)
  v_mfma_f32_16x16x32_bf16 v[8:11], v[4:7], v[24:27], v[8:11]
  v_mfma_f32_16x16x32_bf16 v[12:15], v[28:31], v[20:23], 0
  s_waitcnt lgkmcnt(0)
  v_mfma_f32_16x16x32_bf16 v[12:15], v[32:35], v[24:27], v[12:15]
  v_add_f32_dpp v8, v10, v8 quad_perm:[2,3,0,1] row_mask:0xf bank_mask:0xf
  v_add_f32_dpp v9, v11, v9 quad_perm:[2,3,0,1] row_mask:0xf bank_mask:0xf
  s_nop 0
  v_mov_b32_dpp v8, v8 quad_perm:[0,1,0,1] row_mask:0xf bank_mask:0xf
  v_mov_b32_dpp v9, v9 quad_perm:[0,1,0,1] row_mask:0xf bank_mask:0xf
  s_nop 1
  v_add_f32_dpp v12, v14, v12 quad_perm:[2,3,0,1] row_mask:0xf bank_mask:0xf
  v_add_f32_dpp v13, v15, v13 quad_perm:[2,3,0,1] row_mask:0xf bank_mask:0xf
  s_nop 0
  v_mov_b32_dpp v12, v12 quad_perm:[0,1,0,1] row_mask:0xf bank_mask:0xf
  v_mov_b32_dpp v13, v13 quad_perm:[0,1,0,1] row_mask:0xf bank_mask:0xf
  v_mul_f32 v12, s69, v12
  ds_write_b32 v78, v8 offset:8704
  v_mul_f32 v13, s69, v13
  ds_write_b32 v78, v9 offset:8768
  s_waitcnt lgkmcnt(0)
  s_barrier
  ds_read_b128 v[36:39], v78 offset:8704
  ds_read_b128 v[40:43], v78 offset:8768
  s_waitcnt lgkmcnt(0)
  s_barrier
  v_max_f32 v16, v36, v37
  v_max3_f32 v16, v16, v38, v39
  v_max3_f32 v16, v16, v40, v41
  v_max3_f32 v16, v16, v42, v43
  v_max3_f32 v16, v16, v12, v13
  v_mov_b32 v17, v16
  s_nop 1
  v_permlane16_swap_b32 v16, v17
  v_max_f32 v16, v16, v17
  v_mov_b32 v17, v16
  s_nop 1
  v_permlane32_swap_b32 v16, v17
  v_max_f32 v16, v16, v17
  v_sub_f32 v36, v36, v16
  v_sub_f32 v37, v37, v16
  v_sub_f32 v38, v38, v16
  v_sub_f32 v39, v39, v16
  v_sub_f32 v40, v40, v16
  v_sub_f32 v41, v41, v16
  v_sub_f32 v42, v42, v16
  v_sub_f32 v43, v43, v16
  v_sub_f32 v12, v12, v16
  v_sub_f32 v13, v13, v16
  v_exp_f32 v36, v36
  v_exp_f32 v37, v37
  v_exp_f32 v38, v38
  v_exp_f32 v39, v39
  v_exp_f32 v40, v40
  v_exp_f32 v41, v41
  v_exp_f32 v42, v42
  v_exp_f32 v43, v43
  v_exp_f32 v12, v12
  v_exp_f32 v13, v13
  v_cvt_pk_bf16_f32 v32, v36, v40
  v_cvt_pk_bf16_f32 v33, v37, v41
  v_cvt_pk_bf16_f32 v34, v38, v42
  v_cvt_pk_bf16_f32 v35, v39, v43
  v_cvt_pk_bf16_f32 v28, v12, v13
  v_cvt_pk_bf16_f32 v31, v12, v13
  v_mov_b32 v29, 0
  v_mov_b32 v30, 0
  v_mfma_f32_16x16x32_bf16 v[8:11], v[32:35], v[68:71], 0
  v_mfma_f32_16x16x32_bf16 v[0:3], v[32:35], v[52:55], 0
  v_mfma_f32_16x16x32_bf16 v[4:7], v[32:35], v[56:59], 0
  v_mfma_f32_16x16x16_bf16 v[8:11], v[28:29], v[68:69], v[8:11]
  v_mfma_f32_16x16x16_bf16 v[0:3], v[28:29], v[72:73], v[0:3]
  v_mfma_f32_16x16x16_bf16 v[4:7], v[30:31], v[72:73], v[4:7]
  ds_read_b128 v[52:55], v75 offset:32768
  v_rcp_f32 v10, v8
  v_rcp_f32 v11, v9
  v_mul_f32 v0, v10, v0
  v_mul_f32 v1, v11, v1
  v_max3_f32 v8, v8, v9, v10
  v_mul_f32 v4, v10, v4
  v_mul_f32 v5, v11, v5
  v_cvt_pk_bf16_f32 v2, v0, v4
  ds_write_b32 v79, v2 offset:8704
  v_cvt_pk_bf16_f32 v3, v1, v5
  ds_write_b32 v79, v3 offset:9280
  ds_read_b128 v[12:15], v78 offset:8704
  ds_read_b128 v[56:59], v75 offset:33792
  v_mov_b64 v[16:17], 0
  v_mov_b64 v[18:19], 0
  v_mov_b64 v[20:21], 0
  v_mov_b64 v[22:23], 0
  v_mov_b64 v[24:25], 0
  v_mov_b64 v[26:27], 0
  s_branch Cs0_mxok
Cs0_kv3:
  s_waitcnt lgkmcnt(0)
  s_cmp_ge_u32 s57, 0x700
  s_cbranch_scc1 Cs0_kvb
  s_load_dword s57, s[12:13], s71 glc
  s_add_u32 s67, s67, 1
  s_cmp_lt_u32 s67, 131072
  s_cbranch_scc1 Cs0_kv3
  s_waitcnt lgkmcnt(0)
  s_branch Cs0_kvb
Cs0_last:
  ds_read_b128 v[4:7], v76 offset:5632
  ds_read_b128 v[12:15], v76 offset:7680
  ds_read_b128 v[44:47], v76 offset:32768
  ds_read_b128 v[48:51], v76 offset:33792
  s_nop 5
  v_mov_b64 v[20:21], 0
  v_mov_b64 v[22:23], 0
  v_mov_b64 v[24:25], 0
  v_mov_b64 v[26:27], 0
  v_smfmac_f32_16x16x64_bf16 v[28:31], v[0:3], v[36:43], v74
  ds_read_b128 v[36:39], v76 offset:34816
  ds_read_b128 v[40:43], v76 offset:35840
  v_smfmac_f32_16x16x64_bf16 v[32:35], v[0:3], v[60:67], v74
  s_waitcnt lgkmcnt(5)
  v_smfmac_f32_16x16x64_bf16 v[20:23], v[0:3], a[32:39], v74
  ds_read_b128 v[60:63], v76 offset:49152
  ds_read_b128 v[64:67], v76 offset:50176
  v_smfmac_f32_16x16x64_bf16 v[24:27], v[0:3], a[40:47], v74
  s_waitcnt lgkmcnt(4)
  v_smfmac_f32_16x16x64_bf16 v[20:23], v[4:7], a[48:55], v74
  buffer_store_dwordx4 v[16:19], v76, s[8:11], s68 offen sc1
  v_smfmac_f32_16x16x64_bf16 v[24:27], v[4:7], a[56:63], v74
  v_smfmac_f32_16x16x64_bf16 v[28:31], v[4:7], v[44:51], v74
  s_waitcnt lgkmcnt(2)
  v_smfmac_f32_16x16x64_bf16 v[20:23], v[8:11], a[64:71], v74
  ds_read_b128 v[44:47], v76 offset:51200
  ds_read_b128 v[48:51], v76 offset:52224
  v_smfmac_f32_16x16x64_bf16 v[24:27], v[8:11], a[72:79], v74
  v_smfmac_f32_16x16x64_bf16 v[32:35], v[4:7], v[36:43], v74
  v_smfmac_f32_16x16x64_bf16 v[28:31], v[8:11], v[208:215], v74
  ds_read_b128 v[36:39], v75 offset:16384
  ds_read_b128 v[40:43], v75 offset:17408
  v_smfmac_f32_16x16x64_bf16 v[32:35], v[8:11], v[216:223], v74
  v_smfmac_f32_16x16x64_bf16 v[20:23], v[12:15], a[80:87], v74
  v_smfmac_f32_16x16x64_bf16 v[24:27], v[12:15], a[88:95], v74
  v_smfmac_f32_16x16x64_bf16 v[28:31], v[12:15], v[224:231], v74
  v_smfmac_f32_16x16x64_bf16 v[32:35], v[12:15], v[232:239], v74
  s_waitcnt vmcnt(1)
  s_barrier
Cs0_lastr:
  ds_read_b128 v[0:3], v76 offset:8704
  ds_read_b128 v[8:11], v76 offset:9728
  ds_read_b128 v[16:19], v76 offset:10752
  ds_read_b128 v[4:7], v76 offset:11776
  ds_read_b128 v[12:15], v76 offset:12800
  s_waitcnt lgkmcnt(4)
  v_max3_u32 v72, v0, v1, v2
  s_waitcnt lgkmcnt(1)
  v_max3_u32 v72, v72, v3, v4
  v_max3_u32 v72, v72, v5, v6
  v_max3_u32 v72, v72, v7, v8
  v_max3_u32 v72, v72, v9, v10
  s_waitcnt lgkmcnt(0)
  v_max3_u32 v72, v72, v11, v12
  v_max3_u32 v72, v72, v13, v14
  v_max3_u32 v72, v72, v15, v16
  v_max3_u32 v72, v72, v17, v18
  v_max_u32 v72, v72, v19
  v_cmp_eq_u32 vcc, -1, v72
  s_cbranch_vccnz Cs0_lastp
Cs0_lastg:
  v_smfmac_f32_16x16x64_bf16 v[28:31], v[0:3], v[60:67], v74
  ds_read_b128 v[60:63], v75 offset:18432
  ds_read_b128 v[64:67], v75 offset:19456
  v_smfmac_f32_16x16x64_bf16 v[32:35], v[0:3], v[44:51], v74
  v_smfmac_f32_16x16x64_bf16 v[28:31], v[8:11], v[36:43], v74
  v_smfmac_f32_16x16x64_bf16 v[28:31], v[16:19], v[240:247], v74
  v_smfmac_f32_16x16x64_bf16 v[28:31], v[4:7], a[0:7], v74
  v_smfmac_f32_16x16x64_bf16 v[28:31], v[12:15], a[16:23], v74
  v_smfmac_f32_16x16x64_bf16 v[32:35], v[16:19], v[248:255], v74
  v_smfmac_f32_16x16x64_bf16 v[32:35], v[4:7], a[8:15], v74
  s_waitcnt lgkmcnt(0)
  v_smfmac_f32_16x16x64_bf16 v[32:35], v[12:15], a[24:31], v74
  v_smfmac_f32_16x16x64_bf16 v[32:35], v[8:11], v[60:67], v74
  v_smfmac_f32_16x16x64_bf16 v[20:23], v[0:3], a[96:103], v74
  v_smfmac_f32_16x16x64_bf16 v[20:23], v[8:11], a[112:119], v74
  v_add_f32 v28, v28, v30
  v_add_f32 v32, v32, v34
  v_cvt_pk_bf16_f32 v30, v28, v32
  v_smfmac_f32_16x16x64_bf16 v[20:23], v[16:19], a[128:135], v74
  ds_write_b32 v79, v30 offset:256
  v_add_f32 v29, v29, v31
  v_add_f32 v33, v33, v35
  v_cvt_pk_bf16_f32 v31, v29, v33
  v_smfmac_f32_16x16x64_bf16 v[20:23], v[4:7], a[144:151], v74
  ds_write_b32 v79, v31 offset:832
  v_smfmac_f32_16x16x64_bf16 v[20:23], v[12:15], a[160:167], v74
  v_smfmac_f32_16x16x64_bf16 v[24:27], v[0:3], a[104:111], v74
  v_smfmac_f32_16x16x64_bf16 v[24:27], v[8:11], a[120:127], v74
  v_smfmac_f32_16x16x64_bf16 v[24:27], v[16:19], a[136:143], v74
  s_waitcnt lgkmcnt(0)
  s_barrier
  ds_read_b64 v[52:53], v77 offset:256
  v_add_f32 v20, v20, v22
  v_smfmac_f32_16x16x64_bf16 v[24:27], v[4:7], a[152:159], v74
  v_add_f32 v21, v21, v23
  v_smfmac_f32_16x16x64_bf16 v[24:27], v[12:15], a[168:175], v74
  v_cvt_pk_bf16_f32 v54, v20, v21
  s_add_u32 s68, s68, 655360
  s_nop 3
  v_add_f32 v24, v24, v26
  v_add_f32 v25, v25, v27
  v_cvt_pk_bf16_f32 v55, v24, v25
  s_waitcnt lgkmcnt(0)
  buffer_store_dwordx4 v[52:55], v76, s[8:11], s68 offen sc1
  s_branch Cs0_done
Cs0_lastp:
  s_add_u32 s72, s72, 2
  s_cmp_ge_u32 s72, 131072
  s_cbranch_scc1 Cs0_lastg
  s_barrier
  buffer_load_dwordx4 v76, s[8:11], s85 offen offset:0 sc1 lds
  s_waitcnt vmcnt(0)
  s_barrier
  s_branch Cs0_lastr
Cs0_done:
  s_branch L_cexit
L_w5:
  v_mov_b64 v[20:21], 0
  v_mov_b64 v[22:23], 0
  v_mov_b64 v[24:25], 0
  v_mov_b64 v[26:27], 0
  v_mov_b64 v[28:29], 0
  v_mov_b64 v[30:31], 0
  v_mov_b64 v[32:33], 0
  v_mov_b64 v[34:35], 0
  s_mov_b32 s78, 0x3f803f80
  s_mov_b32 s79, s78
  s_mov_b32 s65, 360448
  s_mov_b32 m0, 15872
  s_lshl_b32 s71, s53, 2
  s_add_u32 s71, s71, 128
  s_movk_i32 s56, 0x1000
  v_lshlrev_b32 v73, 2, v76
  v_mov_b32 v72, 0
  s_mov_b64 s[16:17], s[8:9]
  s_mov_b32 s18, 268435456
  s_mov_b32 s19, 0x20000
  s_getpc_b64 s[20:21]
Cs1_pc:
  s_add_u32 s20, s20, (Cs1_last - Cs1_pc)
  s_addc_u32 s21, s21, 0
  v_mov_b32 v68, 14880
  buffer_load_dwordx4 v[52:55], v76, s[8:11], s59 offen offset:0 sc1
  buffer_load_dwordx4 v[56:59], v76, s[8:11], s59 offen offset:1024 sc1
  ds_read_b128 v[36:39], v76 offset:20480
  ds_read_b128 v[40:43], v76 offset:21504
  ds_read_b128 v[60:63], v76 offset:22528
  ds_read_b128 v[64:67], v76 offset:23552
  ds_read_b128 v[0:3], v76 offset:4608
  ds_read_b128 v[4:7], v76 offset:5632
  ds_read_b128 v[8:11], v76 offset:6656
  ds_read_b128 v[12:15], v76 offset:7680
  s_waitcnt lgkmcnt(0)
  s_cmp_eq_u32 s66, 1
  s_branch Cs1_top2
.p2align 6
Cs1_h2:
  ds_read_b128 v[36:39], v76 offset:20480
  v_lshlrev_b32 v73, 2, v76
  ds_read_b128 v[40:43], v76 offset:21504
  v_mov_b64 v[20:21], 0
  v_mov_b64 v[22:23], 0
  v_mov_b64 v[24:25], 0
  v_mov_b64 v[26:27], 0
  v_mov_b32 v68, 14880
  ds_read_b128 v[60:63], v76 offset:22528
  s_cmp_eq_u32 s66, 62
  s_cselect_b64 s[16:17], s[20:21], s[16:17]
  s_cselect_b32 s18, (Cs1_done - Cs1_last), s18
  s_cselect_b32 s70, 0, s70
  s_cmp_eq_u32 s66, 63
  s_cselect_b32 s59, 268435456, s59
  s_cselect_b32 s58, 268435456, s58
  buffer_load_dwordx4 v[52:55], v76, s[8:11], s59 offen offset:0 sc1
  buffer_load_dwordx4 v[56:59], v76, s[8:11], s59 offen offset:1024 sc1
  s_waitcnt vmcnt(0)
  s_mov_b64 vcc, -1
Cs1_h2r:
  s_mov_b64 exec, vcc
  buffer_load_dwordx4 v[8:11], v76, s[8:11], s65 offen offset:2048 sc1
  buffer_load_dwordx4 v[0:3], v76, s[8:11], s85 offen offset:0 sc1
  s_mov_b64 exec, -1
  s_add_u32 s67, s67, 1
  s_cmp_lt_u32 s67, 131072
  s_cselect_b32 s54, -2, -1
  s_waitcnt vmcnt(1)
  v_max3_u32 v72, v8, v9, v10
  s_waitcnt vmcnt(0)
  v_max3_u32 v72, v72, v11, v0
  v_max3_u32 v72, v72, v1, v2
  v_max_u32 v72, v72, v3
  v_cmp_lt_u32 vcc, s54, v72
  s_cbranch_vccnz Cs1_h2r
  ds_write_b128 v76, v[8:11] offset:6656
  ds_write_b128 v76, v[0:3] offset:11776
Cs1_h2w:
  s_cmp_eq_u32 s66, 63
  s_waitcnt lgkmcnt(0)
  s_barrier
  ds_read_b128 v[0:3], v76 offset:4608
Cs1_top2:
  v_smfmac_f32_16x16x64_bf16 v[20:23], v[8:11], v[112:119], v74
  s_cbranch_scc1 Cs1_last
  v_smfmac_f32_16x16x64_bf16 v[24:27], v[8:11], v[120:127], v74
  buffer_load_dwordx4 v[44:47], v76, s[8:11], s58 offen offset:0 sc1
  s_mov_b32 m0, 15872
  v_smfmac_f32_16x16x64_bf16 v[28:31], v[8:11], v[208:215], v74
  buffer_load_dwordx4 v[48:51], v76, s[8:11], s58 offen offset:1024 sc1
  v_smfmac_f32_16x16x64_bf16 v[32:35], v[8:11], v[216:223], v74
  ds_read_b128 v[4:7], v76 offset:5632
  s_waitcnt lgkmcnt(1)
  v_smfmac_f32_16x16x64_bf16 v[20:23], v[0:3], v[80:87], v74
  ds_read_b128 v[12:15], v76 offset:7680
  v_smfmac_f32_16x16x64_bf16 v[28:31], v[0:3], v[36:43], v74
  ds_read_b128 v[36:39], v76 offset:36864
  v_smfmac_f32_16x16x64_bf16 v[24:27], v[0:3], v[88:95], v74
  buffer_store_dwordx4 v[16:19], v76, s[8:11], s68 offen sc1
  ds_read_b128 v[40:43], v76 offset:37888
  v_smfmac_f32_16x16x64_bf16 v[32:35], v[0:3], v[60:67], v74
  buffer_load_dword v73, s[16:19], s70 offen lds
  ds_read_b128 v[60:63], v76 offset:38912
  s_waitcnt lgkmcnt(4)
  v_smfmac_f32_16x16x64_bf16 v[20:23], v[4:7], v[96:103], v74
  ds_read_b128 v[64:67], v76 offset:39936
  v_smfmac_f32_16x16x64_bf16 v[24:27], v[4:7], v[104:111], v74
  s_waitcnt vmcnt(4)
  s_waitcnt lgkmcnt(4)
  v_smfmac_f32_16x16x64_bf16 v[20:23], v[12:15], v[128:135], v74
  s_barrier
  ds_read_b128 v[8:11], v76 offset:8704
  s_waitcnt lgkmcnt(3)
  v_smfmac_f32_16x16x64_bf16 v[28:31], v[4:7], v[36:43], v74
  ds_read_b128 v[36:39], v76 offset:53248
  v_smfmac_f32_16x16x64_bf16 v[24:27], v[12:15], v[136:143], v74
  ds_read_b128 v[40:43], v76 offset:54272
  s_waitcnt lgkmcnt(3)
  v_smfmac_f32_16x16x64_bf16 v[32:35], v[4:7], v[60:67], v74
  ds_read_b128 v[0:3], v76 offset:9728
  v_smfmac_f32_16x16x64_bf16 v[28:31], v[12:15], v[224:231], v74
  ds_read_b128 v[60:63], v76 offset:55296
  v_smfmac_f32_16x16x64_bf16 v[32:35], v[12:15], v[232:239], v74
  ds_read_b128 v[64:67], v76 offset:56320
  s_waitcnt lgkmcnt(5)
  v_smfmac_f32_16x16x64_bf16 v[20:23], v[8:11], v[144:151], v74
  s_barrier
  ds_read_b128 v[4:7], v76 offset:11776
  s_waitcnt lgkmcnt(4)
  v_smfmac_f32_16x16x64_bf16 v[28:31], v[8:11], v[36:43], v74
  ds_read_b128 v[12:15], v76 offset:12800
  ds_read_b128 v[36:39], v75 offset:4096
  v_smfmac_f32_16x16x64_bf16 v[24:27], v[8:11], v[152:159], v74
  ds_read_b128 v[16:19], v76 offset:10752
  s_waitcnt lgkmcnt(6)
  v_smfmac_f32_16x16x64_bf16 v[20:23], v[0:3], v[160:167], v74
  ds_read_b128 v[40:43], v75 offset:5120
  s_waitcnt lgkmcnt(5)
  v_smfmac_f32_16x16x64_bf16 v[32:35], v[8:11], v[60:67], v74
  ds_read_b128 v[60:63], v75 offset:6144
  v_smfmac_f32_16x16x64_bf16 v[24:27], v[0:3], v[168:175], v74
  ds_read_b128 v[64:67], v75 offset:7168
  s_waitcnt lgkmcnt(6)
  v_smfmac_f32_16x16x64_bf16 v[20:23], v[4:7], v[176:183], v74
  s_waitcnt lgkmcnt(5)
  v_smfmac_f32_16x16x64_bf16 v[20:23], v[12:15], v[192:199], v74
  s_waitcnt lgkmcnt(2)
  v_smfmac_f32_16x16x64_bf16 v[20:23], v[16:19], v[36:43], v74
  ds_read_b128 v[36:39], v75 offset:20480
  v_smfmac_f32_16x16x64_bf16 v[24:27], v[4:7], v[184:191], v74
  ds_read_b128 v[40:43], v75 offset:21504
  s_waitcnt lgkmcnt(2)
  v_smfmac_f32_16x16x64_bf16 v[24:27], v[16:19], v[60:67], v74
  ds_read_b128 v[60:63], v75 offset:22528
  v_add_f32 v20, v20, v22
  v_smfmac_f32_16x16x64_bf16 v[24:27], v[12:15], v[200:207], v74
  ds_read_b128 v[64:67], v75 offset:23552
  v_add_f32 v21, v21, v23
  v_smfmac_f32_16x16x64_bf16 v[28:31], v[16:19], v[240:247], v74
  v_mov_b64 v[70:71], s[78:79]
  v_smfmac_f32_16x16x64_bf16 v[28:31], v[4:7], a[0:7], v74
  s_waitcnt lgkmcnt(2)
  v_add_f32 v24, v24, v26
  v_smfmac_f32_16x16x64_bf16 v[28:31], v[0:3], v[36:43], v74
  ds_read_b128 v[36:39], v68
  v_cvt_pk_bf16_f32 v22, v20, v24
  v_smfmac_f32_16x16x64_bf16 v[28:31], v[12:15], a[16:23], v74
  ds_read_b128 v[40:43], v68
  ds_write_b32 v79, v22 offset:0
  s_waitcnt lgkmcnt(3)
  v_add_f32 v25, v25, v27
  v_cvt_pk_bf16_f32 v23, v21, v25
  v_smfmac_f32_16x16x64_bf16 v[32:35], v[0:3], v[60:67], v74
  ds_write_b32 v79, v23 offset:576
  v_cmp_u_f32 vcc, v20, v21
  v_smfmac_f32_16x16x64_bf16 v[32:35], v[16:19], v[248:255], v74
  v_add_f32 v28, v28, v30
  v_smfmac_f32_16x16x64_bf16 v[32:35], v[4:7], a[8:15], v74
  v_add_f32 v29, v29, v31
  v_smfmac_f32_16x16x64_bf16 v[32:35], v[12:15], a[24:31], v74
  s_cbranch_vccnz Cs1_rec
Cs1_recok:
  s_waitcnt lgkmcnt(3)
  v_smfmac_f32_16x16x64_bf16 v[36:39], v[16:19], a[128:135], v74
  s_waitcnt lgkmcnt(0)
  s_barrier
  ds_read_b128 v[60:63], v77
  v_smfmac_f32_16x16x64_bf16 v[40:43], v[16:19], a[136:143], v74
  ds_read_b128 v[64:67], v77 offset:128
  v_add_f32 v32, v32, v34
  v_cvt_pk_bf16_f32 v30, v28, v32
  v_smfmac_f32_16x16x64_bf16 v[36:39], v[0:3], a[112:119], v74
  ds_write_b32 v79, v30 offset:256
  v_add_f32 v33, v33, v35
  v_cvt_pk_bf16_f32 v31, v29, v33
  v_smfmac_f32_16x16x64_bf16 v[40:43], v[0:3], a[120:127], v74
  ds_write_b32 v79, v31 offset:832
  v_xor_b32 v75, 0x8000, v75
  v_smfmac_f32_16x16x64_bf16 v[36:39], v[4:7], a[144:151], v74
  ds_read_b128 v[0:3], v76 offset:4608
  v_mov_b32 v29, 0
  v_smfmac_f32_16x16x64_bf16 v[40:43], v[4:7], a[152:159], v74
  s_waitcnt vmcnt(2) lgkmcnt(3)
  v_mov_b32 v30, 0
  v_mfma_f32_16x16x32_bf16 v[44:47], v[44:47], v[60:63], 0
  ds_read_b128 v[4:7], v76 offset:5632
  s_waitcnt lgkmcnt(2)
  v_mfma_f32_16x16x32_bf16 v[44:47], v[48:51], v[64:67], v[44:47]
  s_barrier
  v_smfmac_f32_16x16x64_bf16 v[36:39], v[8:11], a[96:103], v74
  ds_read_b128 v[20:23], v77 offset:256
  ds_read_b128 v[24:27], v77 offset:384
  v_smfmac_f32_16x16x64_bf16 v[40:43], v[8:11], a[104:111], v74
  ds_read_b128 v[8:11], v76 offset:6656
  v_add_f32_dpp v72, v46, v44 quad_perm:[2,3,0,1] row_mask:0xf bank_mask:0xf
  v_add_f32_dpp v73, v47, v45 quad_perm:[2,3,0,1] row_mask:0xf bank_mask:0xf
  v_smfmac_f32_16x16x64_bf16 v[36:39], v[12:15], a[160:167], v74
  s_waitcnt lgkmcnt(4)
  v_exp_f32_dpp v72, v72 quad_perm:[0,1,0,1] row_mask:0xf bank_mask:0xf
  v_smfmac_f32_16x16x64_bf16 v[40:43], v[12:15], a[168:175], v74
  ds_read_b128 v[12:15], v76 offset:7680
  v_exp_f32_dpp v73, v73 quad_perm:[0,1,0,1] row_mask:0xf bank_mask:0xf
  v_smfmac_f32_16x16x64_bf16 v[36:39], v[0:3], a[32:39], v74
  s_waitcnt lgkmcnt(2)
  v_cvt_pk_bf16_f32 v72, v72, v73
  v_mfma_f32_16x16x32_bf16 v[20:23], v[20:23], v[60:63], 0
  ds_write_b32 v78, v72 offset:516
  v_mov_b64 v[16:17], 0
  v_mfma_f32_16x16x32_bf16 v[20:23], v[24:27], v[64:67], v[20:23]
  ds_read_b128 v[44:47], v75 offset:22528
  v_mov_b64 v[18:19], 0
  v_smfmac_f32_16x16x64_bf16 v[40:43], v[0:3], a[40:47], v74
  ds_read_b128 v[48:51], v75 offset:23552
  v_mov_b64 v[68:69], s[78:79]
  v_smfmac_f32_16x16x64_bf16 v[36:39], v[4:7], a[48:55], v74
  s_waitcnt lgkmcnt(4)
  v_add_f32_dpp v24, v22, v20 quad_perm:[2,3,0,1] row_mask:0xf bank_mask:0xf
  v_add_f32_dpp v25, v23, v21 quad_perm:[2,3,0,1] row_mask:0xf bank_mask:0xf
  v_smfmac_f32_16x16x64_bf16 v[36:39], v[8:11], a[64:71], v74
  s_waitcnt lgkmcnt(2)
  s_barrier
  ds_read_b128 v[32:35], v78 offset:512
  v_smfmac_f32_16x16x64_bf16 v[36:39], v[12:15], a[80:87], v74
  ds_read_b128 v[60:63], v75 offset:20480
  v_mul_f32 v24, s69, v24
  v_smfmac_f32_16x16x64_bf16 v[40:43], v[4:7], a[56:63], v74
  ds_read_b128 v[64:67], v75 offset:21504
  v_mul_f32 v25, s69, v25
  v_smfmac_f32_16x16x64_bf16 v[40:43], v[8:11], a[72:79], v74
  v_exp_f32_dpp v24, v24 quad_perm:[0,1,0,1] row_mask:0xf bank_mask:0xf
  v_smfmac_f32_16x16x64_bf16 v[40:43], v[12:15], a[88:95], v74
  s_waitcnt lgkmcnt(2)
  v_exp_f32_dpp v25, v25 quad_perm:[0,1,0,1] row_mask:0xf bank_mask:0xf
  v_mfma_f32_16x16x32_bf16 v[8:11], v[32:35], v[68:71], 0
  v_add_f32 v36, v36, v38
  v_add_f32 v37, v37, v39
  v_mfma_f32_16x16x32_bf16 v[0:3], v[32:35], v[52:55], 0
  v_add_f32 v40, v40, v42
  v_add_f32 v41, v41, v43
  v_mfma_f32_16x16x32_bf16 v[4:7], v[32:35], v[56:59], 0
  v_cvt_pk_bf16_f32 v28, v24, v25
  v_cvt_pk_bf16_f32 v72, v36, v37
  v_cvt_pk_bf16_f32 v73, v40, v41
  v_mfma_f32_16x16x16_bf16 v[8:11], v[28:29], v[68:69], v[8:11]
  v_cvt_pk_bf16_f32 v31, v24, v25
  v_mov_b64 v[20:21], 0
  v_mfma_f32_16x16x16_bf16 v[0:3], v[28:29], v[72:73], v[0:3]
  ds_read_b128 v[52:55], v75 offset:36864
  v_mov_b64 v[22:23], 0
  v_mfma_f32_16x16x16_bf16 v[4:7], v[30:31], v[72:73], v[4:7]
  v_rcp_f32 v10, v8
  v_rcp_f32 v11, v9
  v_mul_f32 v0, v10, v0
  v_mul_f32 v1, v11, v1
  v_max3_f32 v8, v8, v9, v10
  v_mul_f32 v4, v10, v4
  v_mul_f32 v5, v11, v5
  v_cvt_pk_bf16_f32 v2, v0, v4
  ds_write_b32 v79, v2 offset:8704
  v_cvt_pk_bf16_f32 v3, v1, v5
  ds_write_b32 v79, v3 offset:9280
  ds_read_b128 v[12:15], v78 offset:8768
  v_max_f32 v8, v8, v11
  v_cmp_le_f32 vcc, 1317011456, v8
  v_mov_b64 v[24:25], 0
  v_mov_b64 v[26:27], 0
  ds_read_b128 v[56:59], v75 offset:37888
  s_cbranch_vccnz Cs1_mx
Cs1_mxok:
  s_waitcnt lgkmcnt(2)
  s_barrier
  ds_read_b128 v[0:3], v78 offset:8704
  s_waitcnt lgkmcnt(2)
  v_smfmac_f32_16x16x64_bf16 v[16:19], v[12:15], v[44:51], v74
  ds_read_b128 v[4:7], v78 offset:8832
  v_smfmac_f32_16x16x64_bf16 v[20:23], v[12:15], a[200:207], v74
  ds_read_b128 v[8:11], v78 offset:8896
  v_smfmac_f32_16x16x64_bf16 v[24:27], v[12:15], a[216:223], v74
  ds_read_b128 v[36:39], v75 offset:38912
  s_waitcnt lgkmcnt(3)
  v_smfmac_f32_16x16x64_bf16 v[16:19], v[0:3], v[60:67], v74
  ds_read_b128 v[40:43], v75 offset:39936
  s_waitcnt lgkmcnt(3)
  v_smfmac_f32_16x16x64_bf16 v[16:19], v[4:7], a[176:183], v74
  ds_read_b128 v[68:71], v76 offset:13824
  s_waitcnt lgkmcnt(3)
  v_smfmac_f32_16x16x64_bf16 v[16:19], v[8:11], a[184:191], v74
  ds_read_b128 v[44:47], v75 offset:53248
  v_smfmac_f32_16x16x64_bf16 v[20:23], v[0:3], a[192:199], v74
  ds_read_b128 v[48:51], v75 offset:54272
  v_smfmac_f32_16x16x64_bf16 v[20:23], v[4:7], v[52:59], v74
  ds_read_b128 v[60:63], v75 offset:55296
  s_waitcnt lgkmcnt(4)
  v_cvt_pk_bf16_f32 v16, v16, v17
  v_cvt_pk_bf16_f32 v17, v18, v19
  v_bfi_b32 v16, 1, s72, v16
  v_smfmac_f32_16x16x64_bf16 v[20:23], v[8:11], v[36:43], v74
  s_waitcnt lgkmcnt(3)
  buffer_store_dwordx2 v[16:17], v68, s[8:11], s73 offen sc1
  v_mov_b64 v[32:33], 0
  v_smfmac_f32_16x16x64_bf16 v[24:27], v[0:3], a[208:215], v74
  ds_read_b128 v[64:67], v75 offset:56320
  v_mov_b64 v[34:35], 0
  v_smfmac_f32_16x16x64_bf16 v[24:27], v[4:7], a[224:231], v74
  v_cvt_pk_bf16_f32 v20, v20, v21
  v_cvt_pk_bf16_f32 v21, v22, v23
  v_bfi_b32 v20, 1, s72, v20
  v_smfmac_f32_16x16x64_bf16 v[24:27], v[8:11], a[232:239], v74
  buffer_store_dwordx2 v[20:21], v68, s[8:11], s74 offen sc1
  s_waitcnt lgkmcnt(2)
  v_smfmac_f32_16x16x64_bf16 v[32:35], v[0:3], v[44:51], v74
  s_waitcnt lgkmcnt(0)
  v_smfmac_f32_16x16x64_bf16 v[32:35], v[12:15], v[60:67], v74
  v_cvt_pk_bf16_f32 v24, v24, v25
  v_cvt_pk_bf16_f32 v25, v26, v27
  v_bfi_b32 v24, 1, s72, v24
  v_smfmac_f32_16x16x64_bf16 v[32:35], v[4:7], a[240:247], v74
  buffer_store_dwordx2 v[24:25], v68, s[8:11], s75 offen sc1
  v_smfmac_f32_16x16x64_bf16 v[32:35], v[8:11], a[248:255], v74
  v_mov_b64 v[18:19], v[72:73]
  s_nop 4
  v_cvt_pk_bf16_f32 v32, v32, v33
  v_cvt_pk_bf16_f32 v33, v34, v35
  v_bfi_b32 v32, 1, s72, v32
  buffer_store_dwordx2 v[32:33], v68, s[8:11], s76 offen sc1
  ds_read_b128 v[0:3], v76 offset:14848
  s_waitcnt lgkmcnt(0)
  ds_read_b64 v[16:17], v77 offset:264
  s_waitcnt lgkmcnt(0)
  ds_read_b128 v[64:67], v76 offset:23552
  s_waitcnt lgkmcnt(0)
  s_add_u32 s66, s66, 1
  s_xor_b32 s64, s64, 16384
  s_xor_b32 s65, s65, 16384
  s_add_u32 s58, s58, 655360
  s_add_u32 s59, s59, 655360
  s_add_u32 s70, s70, 655360
  s_add_u32 s68, s68, 655360
  s_mov_b32 m0, 11776
  s_add_u32 s85, s65, 7168
  v_xor_b32 v75, 0x8000, v75
  v_mov_b64 v[28:29], 0
  v_mov_b64 v[30:31], 0
  v_mov_b64 v[32:33], 0
  v_mov_b64 v[34:35], 0
  s_waitcnt vmcnt(0)
  buffer_load_dwordx4 v[52:55], v76, s[8:11], s60 offen offset:0 sc1
  buffer_load_dwordx4 v[56:59], v76, s[8:11], s60 offen offset:1024 sc1
  s_waitcnt lgkmcnt(0)
  s_waitcnt vmcnt(1)
  v_mfma_f32_16x16x32_bf16 v[4:7], v[0:3], v[52:55], 0
  v_bitop3_b32 v72, v52, v54, s72 bitop3:0x7e
  s_waitcnt vmcnt(0)
  v_mfma_f32_16x16x32_bf16 v[4:7], v[0:3], v[56:59], v[4:7]
  v_bitop3_b32 v73, v56, v58, s72 bitop3:0x7e
  v_bitop3_b32 v72, v72, v73, 1 bitop3:0xa8
  v_cmp_ne_u32 vcc, 0, v72
  s_cbranch_vccnz Cs1_h1r
  s_nop 2
  v_add_f32_dpp v4, v4, v4 row_ror:4 row_mask:0xf bank_mask:0xf
  v_add_f32_dpp v5, v5, v5 row_ror:4 row_mask:0xf bank_mask:0xf
  s_nop 0
  v_add_f32_dpp v4, v4, v4 row_ror:8 row_mask:0xf bank_mask:0xf
  v_add_f32_dpp v5, v5, v5 row_ror:8 row_mask:0xf bank_mask:0xf
  v_cvt_pk_bf16_f32 v4, v4, v5
  buffer_store_dword v4, v69, s[8:11], s62 offen sc1
  s_xor_b32 s62, s62, 16384
  buffer_store_dword v71, v69, s[8:11], s62 offen sc1
  s_xor_b32 s72, s72, 1
  s_branch Cs1_h2
Cs1_h1r:
  s_mov_b64 exec, vcc
  buffer_load_dwordx4 v[52:55], v76, s[8:11], s60 offen offset:0 sc1
  buffer_load_dwordx4 v[56:59], v76, s[8:11], s60 offen offset:1024 sc1
  s_mov_b64 exec, -1
  s_add_u32 s67, s67, 1
  s_waitcnt vmcnt(1)
  v_mfma_f32_16x16x32_bf16 v[4:7], v[0:3], v[52:55], 0
  v_bitop3_b32 v72, v52, v54, s72 bitop3:0x7e
  s_waitcnt vmcnt(0)
  v_mfma_f32_16x16x32_bf16 v[4:7], v[0:3], v[56:59], v[4:7]
  v_bitop3_b32 v73, v56, v58, s72 bitop3:0x7e
  v_bitop3_b32 v72, v72, v73, 1 bitop3:0xa8
  v_cmp_ne_u32 vcc, 0, v72
  s_cbranch_vccz Cs1_h1p
Cs1_h1s:
  s_mov_b64 exec, vcc
  buffer_load_dwordx4 v[52:55], v76, s[8:11], s60 offen offset:0 sc1
  buffer_load_dwordx4 v[56:59], v76, s[8:11], s60 offen offset:1024 sc1
  s_mov_b64 exec, -1
  s_add_u32 s67, s67, 1
  s_waitcnt vmcnt(1)
  v_mfma_f32_16x16x32_bf16 v[4:7], v[0:3], v[52:55], 0
  v_bitop3_b32 v72, v52, v54, s72 bitop3:0x7e
  s_waitcnt vmcnt(0)
  v_mfma_f32_16x16x32_bf16 v[4:7], v[0:3], v[56:59], v[4:7]
  v_bitop3_b32 v73, v56, v58, s72 bitop3:0x7e
  v_bitop3_b32 v72, v72, v73, 1 bitop3:0xa8
  v_cmp_ne_u32 vcc, 0, v72
  s_cbranch_vccz Cs1_h1p
  s_cmp_lt_u32 s67, 131072
  s_cbranch_scc1 Cs1_h1s
Cs1_h1p:
  s_nop 2
  v_add_f32_dpp v4, v4, v4 row_ror:4 row_mask:0xf bank_mask:0xf
  v_add_f32_dpp v5, v5, v5 row_ror:4 row_mask:0xf bank_mask:0xf
  s_nop 0
  v_add_f32_dpp v4, v4, v4 row_ror:8 row_mask:0xf bank_mask:0xf
  v_add_f32_dpp v5, v5, v5 row_ror:8 row_mask:0xf bank_mask:0xf
  v_cvt_pk_bf16_f32 v4, v4, v5
  buffer_store_dword v4, v69, s[8:11], s62 offen sc1
  s_xor_b32 s62, s62, 16384
  buffer_store_dword v71, v69, s[8:11], s62 offen sc1
  s_xor_b32 s72, s72, 1
  s_branch Cs1_h2
Cs1_rec:
  s_nop 7
  s_waitcnt vmcnt(0) lgkmcnt(0)
  v_max3_u32 v72, v0, v1, v2
  v_max3_u32 v72, v72, v3, v4
  v_max3_u32 v72, v72, v5, v6
  v_max3_u32 v72, v72, v7, v8
  v_max3_u32 v72, v72, v9, v10
  v_max3_u32 v72, v72, v11, v12
  v_max3_u32 v72, v72, v13, v14
  v_max3_u32 v72, v72, v15, v16
  v_max3_u32 v72, v72, v17, v18
  v_max_u32 v72, v72, v19
  v_cmp_eq_u32 vcc, -1, v72
  s_cbranch_vccz Cs1_recok
  s_barrier
  v_mov_b64 v[20:21], 0
  v_mov_b64 v[22:23], 0
  v_mov_b64 v[24:25], 0
  v_mov_b64 v[26:27], 0
  v_mov_b64 v[28:29], 0
  v_mov_b64 v[30:31], 0
  v_mov_b64 v[32:33], 0
  v_mov_b64 v[34:35], 0
  s_waitcnt lgkmcnt(0)
  s_barrier
  ds_read_b128 v[0:3], v76 offset:4608
  s_waitcnt lgkmcnt(0)
  v_smfmac_f32_16x16x64_bf16 v[20:23], v[0:3], v[80:87], v74
  v_smfmac_f32_16x16x64_bf16 v[24:27], v[0:3], v[88:95], v74
  ds_read_b128 v[60:63], v76 offset:20480
  ds_read_b128 v[64:67], v76 offset:21504
  s_waitcnt lgkmcnt(0)
  v_smfmac_f32_16x16x64_bf16 v[28:31], v[0:3], v[60:67], v74
  ds_read_b128 v[60:63], v76 offset:22528
  ds_read_b128 v[64:67], v76 offset:23552
  s_waitcnt lgkmcnt(0)
  v_smfmac_f32_16x16x64_bf16 v[32:35], v[0:3], v[60:67], v74
  ds_read_b128 v[4:7], v76 offset:5632
  s_waitcnt lgkmcnt(0)
  v_smfmac_f32_16x16x64_bf16 v[20:23], v[4:7], v[96:103], v74
  v_smfmac_f32_16x16x64_bf16 v[24:27], v[4:7], v[104:111], v74
  ds_read_b128 v[60:63], v76 offset:36864
  ds_read_b128 v[64:67], v76 offset:37888
  s_waitcnt lgkmcnt(0)
  v_smfmac_f32_16x16x64_bf16 v[28:31], v[4:7], v[60:67], v74
  ds_read_b128 v[60:63], v76 offset:38912
  ds_read_b128 v[64:67], v76 offset:39936
  s_waitcnt lgkmcnt(0)
  v_smfmac_f32_16x16x64_bf16 v[32:35], v[4:7], v[60:67], v74
  ds_read_b128 v[8:11], v76 offset:6656
  s_waitcnt lgkmcnt(0)
  v_smfmac_f32_16x16x64_bf16 v[20:23], v[8:11], v[112:119], v74
  v_smfmac_f32_16x16x64_bf16 v[24:27], v[8:11], v[120:127], v74
  v_smfmac_f32_16x16x64_bf16 v[28:31], v[8:11], v[208:215], v74
  v_smfmac_f32_16x16x64_bf16 v[32:35], v[8:11], v[216:223], v74
  ds_read_b128 v[12:15], v76 offset:7680
  s_waitcnt lgkmcnt(0)
  v_smfmac_f32_16x16x64_bf16 v[20:23], v[12:15], v[128:135], v74
  v_smfmac_f32_16x16x64_bf16 v[24:27], v[12:15], v[136:143], v74
  v_smfmac_f32_16x16x64_bf16 v[28:31], v[12:15], v[224:231], v74
  v_smfmac_f32_16x16x64_bf16 v[32:35], v[12:15], v[232:239], v74
  ds_read_b128 v[8:11], v76 offset:8704
  s_waitcnt lgkmcnt(0)
  v_smfmac_f32_16x16x64_bf16 v[20:23], v[8:11], v[144:151], v74
  v_smfmac_f32_16x16x64_bf16 v[24:27], v[8:11], v[152:159], v74
  ds_read_b128 v[60:63], v76 offset:53248
  ds_read_b128 v[64:67], v76 offset:54272
  s_waitcnt lgkmcnt(0)
  v_smfmac_f32_16x16x64_bf16 v[28:31], v[8:11], v[60:67], v74
  ds_read_b128 v[60:63], v76 offset:55296
  ds_read_b128 v[64:67], v76 offset:56320
  s_waitcnt lgkmcnt(0)
  v_smfmac_f32_16x16x64_bf16 v[32:35], v[8:11], v[60:67], v74
  ds_read_b128 v[0:3], v76 offset:9728
  s_waitcnt lgkmcnt(0)
  v_smfmac_f32_16x16x64_bf16 v[20:23], v[0:3], v[160:167], v74
  v_smfmac_f32_16x16x64_bf16 v[24:27], v[0:3], v[168:175], v74
  ds_read_b128 v[60:63], v75 offset:20480
  ds_read_b128 v[64:67], v75 offset:21504
  s_waitcnt lgkmcnt(0)
  v_smfmac_f32_16x16x64_bf16 v[28:31], v[0:3], v[60:67], v74
  ds_read_b128 v[60:63], v75 offset:22528
  ds_read_b128 v[64:67], v75 offset:23552
  s_waitcnt lgkmcnt(0)
  v_smfmac_f32_16x16x64_bf16 v[32:35], v[0:3], v[60:67], v74
  ds_read_b128 v[16:19], v76 offset:10752
  ds_read_b128 v[60:63], v75 offset:4096
  ds_read_b128 v[64:67], v75 offset:5120
  s_waitcnt lgkmcnt(0)
  v_smfmac_f32_16x16x64_bf16 v[20:23], v[16:19], v[60:67], v74
  ds_read_b128 v[60:63], v75 offset:6144
  ds_read_b128 v[64:67], v75 offset:7168
  s_waitcnt lgkmcnt(0)
  v_smfmac_f32_16x16x64_bf16 v[24:27], v[16:19], v[60:67], v74
  v_smfmac_f32_16x16x64_bf16 v[28:31], v[16:19], v[240:247], v74
  v_smfmac_f32_16x16x64_bf16 v[32:35], v[16:19], v[248:255], v74
  ds_read_b128 v[4:7], v76 offset:11776
  s_waitcnt lgkmcnt(0)
  v_smfmac_f32_16x16x64_bf16 v[20:23], v[4:7], v[176:183], v74
  v_smfmac_f32_16x16x64_bf16 v[24:27], v[4:7], v[184:191], v74
  v_smfmac_f32_16x16x64_bf16 v[28:31], v[4:7], a[0:7], v74
  v_smfmac_f32_16x16x64_bf16 v[32:35], v[4:7], a[8:15], v74
  ds_read_b128 v[12:15], v76 offset:12800
  s_waitcnt lgkmcnt(0)
  v_smfmac_f32_16x16x64_bf16 v[20:23], v[12:15], v[192:199], v74
  v_smfmac_f32_16x16x64_bf16 v[24:27], v[12:15], v[200:207], v74
  v_smfmac_f32_16x16x64_bf16 v[28:31], v[12:15], a[16:23], v74
  v_smfmac_f32_16x16x64_bf16 v[32:35], v[12:15], a[24:31], v74
  v_add_f32 v20, v20, v22
  v_add_f32 v21, v21, v23
  v_add_f32 v24, v24, v26
  v_cvt_pk_bf16_f32 v22, v20, v24
  ds_write_b32 v79, v22 offset:0
  v_add_f32 v25, v25, v27
  v_cvt_pk_bf16_f32 v23, v21, v25
  ds_write_b32 v79, v23 offset:576
  v_add_f32 v28, v28, v30
  v_add_f32 v29, v29, v31
  s_waitcnt lgkmcnt(0)
  s_nop 1
  s_branch Cs1_recok
Cs1_mx:
  s_waitcnt lgkmcnt(0)
  s_barrier
  buffer_load_dwordx4 v[52:55], v76, s[8:11], s59 offen offset:0 sc1
  buffer_load_dwordx4 v[0:3], v76, s[8:11], s58 offen offset:0 sc1
  ds_read_b128 v[20:23], v77 offset:0
  ds_read_b128 v[28:31], v77 offset:256
  buffer_load_dwordx4 v[56:59], v76, s[8:11], s59 offen offset:1024 sc1
  buffer_load_dwordx4 v[4:7], v76, s[8:11], s58 offen offset:1024 sc1
  ds_read_b128 v[24:27], v77 offset:128
  ds_read_b128 v[32:35], v77 offset:384
  s_waitcnt vmcnt(2) lgkmcnt(3)
  v_mfma_f32_16x16x32_bf16 v[8:11], v[0:3], v[20:23], 0
  s_waitcnt vmcnt(0) lgkmcnt(1)
  v_mfma_f32_16x16x32_bf16 v[8:11], v[4:7], v[24:27], v[8:11]
  v_mfma_f32_16x16x32_bf16 v[12:15], v[28:31], v[20:23], 0
  s_waitcnt lgkmcnt(0)
  v_mfma_f32_16x16x32_bf16 v[12:15], v[32:35], v[24:27], v[12:15]
  v_add_f32_dpp v8, v10, v8 quad_perm:[2,3,0,1] row_mask:0xf bank_mask:0xf
  v_add_f32_dpp v9, v11, v9 quad_perm:[2,3,0,1] row_mask:0xf bank_mask:0xf
  s_nop 0
  v_mov_b32_dpp v8, v8 quad_perm:[0,1,0,1] row_mask:0xf bank_mask:0xf
  v_mov_b32_dpp v9, v9 quad_perm:[0,1,0,1] row_mask:0xf bank_mask:0xf
  s_nop 1
  v_add_f32_dpp v12, v14, v12 quad_perm:[2,3,0,1] row_mask:0xf bank_mask:0xf
  v_add_f32_dpp v13, v15, v13 quad_perm:[2,3,0,1] row_mask:0xf bank_mask:0xf
  s_nop 0
  v_mov_b32_dpp v12, v12 quad_perm:[0,1,0,1] row_mask:0xf bank_mask:0xf
  v_mov_b32_dpp v13, v13 quad_perm:[0,1,0,1] row_mask:0xf bank_mask:0xf
  v_mul_f32 v12, s69, v12
  ds_write_b32 v78, v8 offset:8708
  v_mul_f32 v13, s69, v13
  ds_write_b32 v78, v9 offset:8772
  s_waitcnt lgkmcnt(0)
  s_barrier
  ds_read_b128 v[36:39], v78 offset:8704
  ds_read_b128 v[40:43], v78 offset:8768
  s_waitcnt lgkmcnt(0)
  s_barrier
  v_max_f32 v16, v36, v37
  v_max3_f32 v16, v16, v38, v39
  v_max3_f32 v16, v16, v40, v41
  v_max3_f32 v16, v16, v42, v43
  v_max3_f32 v16, v16, v12, v13
  v_mov_b32 v17, v16
  s_nop 1
  v_permlane16_swap_b32 v16, v17
  v_max_f32 v16, v16, v17
  v_mov_b32 v17, v16
  s_nop 1
  v_permlane32_swap_b32 v16, v17
  v_max_f32 v16, v16, v17
  v_sub_f32 v36, v36, v16
  v_sub_f32 v37, v37, v16
  v_sub_f32 v38, v38, v16
  v_sub_f32 v39, v39, v16
  v_sub_f32 v40, v40, v16
  v_sub_f32 v41, v41, v16
  v_sub_f32 v42, v42, v16
  v_sub_f32 v43, v43, v16
  v_sub_f32 v12, v12, v16
  v_sub_f32 v13, v13, v16
  v_exp_f32 v36, v36
  v_exp_f32 v37, v37
  v_exp_f32 v38, v38
  v_exp_f32 v39, v39
  v_exp_f32 v40, v40
  v_exp_f32 v41, v41
  v_exp_f32 v42, v42
  v_exp_f32 v43, v43
  v_exp_f32 v12, v12
  v_exp_f32 v13, v13
  v_cvt_pk_bf16_f32 v32, v36, v40
  v_cvt_pk_bf16_f32 v33, v37, v41
  v_cvt_pk_bf16_f32 v34, v38, v42
  v_cvt_pk_bf16_f32 v35, v39, v43
  v_cvt_pk_bf16_f32 v28, v12, v13
  v_cvt_pk_bf16_f32 v31, v12, v13
  v_mov_b32 v29, 0
  v_mov_b32 v30, 0
  v_mfma_f32_16x16x32_bf16 v[8:11], v[32:35], v[68:71], 0
  v_mfma_f32_16x16x32_bf16 v[0:3], v[32:35], v[52:55], 0
  v_mfma_f32_16x16x32_bf16 v[4:7], v[32:35], v[56:59], 0
  v_mfma_f32_16x16x16_bf16 v[8:11], v[28:29], v[68:69], v[8:11]
  v_mfma_f32_16x16x16_bf16 v[0:3], v[28:29], v[72:73], v[0:3]
  v_mfma_f32_16x16x16_bf16 v[4:7], v[30:31], v[72:73], v[4:7]
  ds_read_b128 v[52:55], v75 offset:36864
  v_rcp_f32 v10, v8
  v_rcp_f32 v11, v9
  v_mul_f32 v0, v10, v0
  v_mul_f32 v1, v11, v1
  v_max3_f32 v8, v8, v9, v10
  v_mul_f32 v4, v10, v4
  v_mul_f32 v5, v11, v5
  v_cvt_pk_bf16_f32 v2, v0, v4
  ds_write_b32 v79, v2 offset:8704
  v_cvt_pk_bf16_f32 v3, v1, v5
  ds_write_b32 v79, v3 offset:9280
  ds_read_b128 v[12:15], v78 offset:8768
  ds_read_b128 v[56:59], v75 offset:37888
  v_mov_b64 v[16:17], 0
  v_mov_b64 v[18:19], 0
  v_mov_b64 v[20:21], 0
  v_mov_b64 v[22:23], 0
  v_mov_b64 v[24:25], 0
  v_mov_b64 v[26:27], 0
  s_branch Cs1_mxok
Cs1_last:
  ds_read_b128 v[4:7], v76 offset:5632
  ds_read_b128 v[12:15], v76 offset:7680
  ds_read_b128 v[44:47], v76 offset:36864
  ds_read_b128 v[48:51], v76 offset:37888
  s_nop 5
  v_mov_b64 v[20:21], 0
  v_mov_b64 v[22:23], 0
  v_mov_b64 v[24:25], 0
  v_mov_b64 v[26:27], 0
  s_waitcnt lgkmcnt(4)
  v_smfmac_f32_16x16x64_bf16 v[28:31], v[0:3], v[36:43], v74
  ds_read_b128 v[36:39], v76 offset:38912
  ds_read_b128 v[40:43], v76 offset:39936
  v_smfmac_f32_16x16x64_bf16 v[32:35], v[0:3], v[60:67], v74
  s_waitcnt lgkmcnt(5)
  v_smfmac_f32_16x16x64_bf16 v[20:23], v[0:3], a[32:39], v74
  ds_read_b128 v[60:63], v76 offset:53248
  ds_read_b128 v[64:67], v76 offset:54272
  v_smfmac_f32_16x16x64_bf16 v[24:27], v[0:3], a[40:47], v74
  s_waitcnt lgkmcnt(4)
  v_smfmac_f32_16x16x64_bf16 v[20:23], v[4:7], a[48:55], v74
  buffer_store_dwordx4 v[16:19], v76, s[8:11], s68 offen sc1
  v_smfmac_f32_16x16x64_bf16 v[24:27], v[4:7], a[56:63], v74
  v_smfmac_f32_16x16x64_bf16 v[28:31], v[4:7], v[44:51], v74
  s_waitcnt lgkmcnt(2)
  v_smfmac_f32_16x16x64_bf16 v[20:23], v[8:11], a[64:71], v74
  ds_read_b128 v[44:47], v76 offset:55296
  ds_read_b128 v[48:51], v76 offset:56320
  v_smfmac_f32_16x16x64_bf16 v[24:27], v[8:11], a[72:79], v74
  v_smfmac_f32_16x16x64_bf16 v[32:35], v[4:7], v[36:43], v74
  v_smfmac_f32_16x16x64_bf16 v[28:31], v[8:11], v[208:215], v74
  ds_read_b128 v[36:39], v75 offset:20480
  ds_read_b128 v[40:43], v75 offset:21504
  v_smfmac_f32_16x16x64_bf16 v[32:35], v[8:11], v[216:223], v74
  v_smfmac_f32_16x16x64_bf16 v[20:23], v[12:15], a[80:87], v74
  v_smfmac_f32_16x16x64_bf16 v[24:27], v[12:15], a[88:95], v74
  v_smfmac_f32_16x16x64_bf16 v[28:31], v[12:15], v[224:231], v74
  v_smfmac_f32_16x16x64_bf16 v[32:35], v[12:15], v[232:239], v74
  s_waitcnt vmcnt(1)
  s_barrier
Cs1_lastr:
  ds_read_b128 v[8:11], v76 offset:8704
  ds_read_b128 v[0:3], v76 offset:9728
  ds_read_b128 v[16:19], v76 offset:10752
  ds_read_b128 v[4:7], v76 offset:11776
  ds_read_b128 v[12:15], v76 offset:12800
  s_waitcnt lgkmcnt(3)
  v_max3_u32 v72, v0, v1, v2
  s_waitcnt lgkmcnt(1)
  v_max3_u32 v72, v72, v3, v4
  v_max3_u32 v72, v72, v5, v6
  v_max3_u32 v72, v72, v7, v8
  v_max3_u32 v72, v72, v9, v10
  s_waitcnt lgkmcnt(0)
  v_max3_u32 v72, v72, v11, v12
  v_max3_u32 v72, v72, v13, v14
  v_max3_u32 v72, v72, v15, v16
  v_max3_u32 v72, v72, v17, v18
  v_max_u32 v72, v72, v19
  v_cmp_eq_u32 vcc, -1, v72
  s_cbranch_vccnz Cs1_lastp
Cs1_lastg:
  v_smfmac_f32_16x16x64_bf16 v[28:31], v[8:11], v[60:67], v74
  ds_read_b128 v[60:63], v75 offset:22528
  ds_read_b128 v[64:67], v75 offset:23552
  v_smfmac_f32_16x16x64_bf16 v[32:35], v[8:11], v[44:51], v74
  v_smfmac_f32_16x16x64_bf16 v[28:31], v[0:3], v[36:43], v74
  v_smfmac_f32_16x16x64_bf16 v[28:31], v[16:19], v[240:247], v74
  v_smfmac_f32_16x16x64_bf16 v[28:31], v[4:7], a[0:7], v74
  v_smfmac_f32_16x16x64_bf16 v[28:31], v[12:15], a[16:23], v74
  v_smfmac_f32_16x16x64_bf16 v[32:35], v[16:19], v[248:255], v74
  v_smfmac_f32_16x16x64_bf16 v[32:35], v[4:7], a[8:15], v74
  s_waitcnt lgkmcnt(0)
  v_smfmac_f32_16x16x64_bf16 v[32:35], v[12:15], a[24:31], v74
  v_smfmac_f32_16x16x64_bf16 v[32:35], v[0:3], v[60:67], v74
  v_smfmac_f32_16x16x64_bf16 v[20:23], v[8:11], a[96:103], v74
  v_smfmac_f32_16x16x64_bf16 v[20:23], v[0:3], a[112:119], v74
  v_add_f32 v28, v28, v30
  v_add_f32 v32, v32, v34
  v_cvt_pk_bf16_f32 v30, v28, v32
  v_smfmac_f32_16x16x64_bf16 v[20:23], v[16:19], a[128:135], v74
  ds_write_b32 v79, v30 offset:256
  v_add_f32 v29, v29, v31
  v_add_f32 v33, v33, v35
  v_cvt_pk_bf16_f32 v31, v29, v33
  v_smfmac_f32_16x16x64_bf16 v[20:23], v[4:7], a[144:151], v74
  ds_write_b32 v79, v31 offset:832
  v_smfmac_f32_16x16x64_bf16 v[20:23], v[12:15], a[160:167], v74
  v_smfmac_f32_16x16x64_bf16 v[24:27], v[8:11], a[104:111], v74
  v_smfmac_f32_16x16x64_bf16 v[24:27], v[0:3], a[120:127], v74
  v_smfmac_f32_16x16x64_bf16 v[24:27], v[16:19], a[136:143], v74
  s_waitcnt lgkmcnt(0)
  s_barrier
  ds_read_b64 v[52:53], v77 offset:264
  v_add_f32 v20, v20, v22
  v_smfmac_f32_16x16x64_bf16 v[24:27], v[4:7], a[152:159], v74
  v_add_f32 v21, v21, v23
  v_smfmac_f32_16x16x64_bf16 v[24:27], v[12:15], a[168:175], v74
  v_cvt_pk_bf16_f32 v54, v20, v21
  s_add_u32 s68, s68, 655360
  s_nop 3
  v_add_f32 v24, v24, v26
  v_add_f32 v25, v25, v27
  v_cvt_pk_bf16_f32 v55, v24, v25
  s_waitcnt lgkmcnt(0)
  buffer_store_dwordx4 v[52:55], v76, s[8:11], s68 offen sc1
  s_branch Cs1_done
Cs1_lastp:
  s_add_u32 s72, s72, 2
  s_cmp_ge_u32 s72, 131072
  s_cbranch_scc1 Cs1_lastg
  s_barrier
  buffer_load_dwordx4 v76, s[8:11], s85 offen offset:0 sc1 lds
  s_waitcnt vmcnt(0)
  s_barrier
  s_branch Cs1_lastr
Cs1_done:
  s_branch L_cexit
L_w6:
  v_mov_b64 v[20:21], 0
  v_mov_b64 v[22:23], 0
  v_mov_b64 v[24:25], 0
  v_mov_b64 v[26:27], 0
  v_mov_b64 v[28:29], 0
  v_mov_b64 v[30:31], 0
  v_mov_b64 v[32:33], 0
  v_mov_b64 v[34:35], 0
  s_mov_b32 s78, 0x3f803f80
  s_mov_b32 s79, s78
  s_mov_b32 s65, 360448
  s_mov_b32 m0, 15872
  s_lshl_b32 s71, s53, 2
  s_add_u32 s71, s71, 128
  s_movk_i32 s56, 0x1000
  v_lshlrev_b32 v73, 2, v76
  v_mov_b32 v72, 0
  s_mov_b64 s[16:17], s[8:9]
  s_mov_b32 s18, 268435456
  s_mov_b32 s19, 0x20000
  s_getpc_b64 s[20:21]
Cs2_pc:
  s_add_u32 s20, s20, (Cs2_last - Cs2_pc)
  s_addc_u32 s21, s21, 0
  v_mov_b32 v68, 14880
  buffer_load_dwordx4 v[52:55], v76, s[8:11], s59 offen offset:0 sc1
  buffer_load_dwordx4 v[56:59], v76, s[8:11], s59 offen offset:1024 sc1
  ds_read_b128 v[36:39], v76 offset:24576
  ds_read_b128 v[40:43], v76 offset:25600
  ds_read_b128 v[60:63], v76 offset:26624
  ds_read_b128 v[64:67], v76 offset:27648
  ds_read_b128 v[0:3], v76 offset:4608
  ds_read_b128 v[4:7], v76 offset:5632
  ds_read_b128 v[8:11], v76 offset:6656
  ds_read_b128 v[12:15], v76 offset:7680
  s_waitcnt lgkmcnt(0)
  s_cmp_eq_u32 s66, 1
  s_branch Cs2_top2
.p2align 6
Cs2_h2:
  ds_read_b128 v[36:39], v76 offset:24576
  s_cmp_eq_u32 s66, 62
  s_cselect_b64 s[16:17], s[20:21], s[16:17]
  s_cselect_b32 s18, (Cs2_done - Cs2_last), s18
  s_cselect_b32 s70, 0, s70
  s_cmp_eq_u32 s66, 63
  s_cselect_b32 s59, 268435456, s59
  s_cselect_b32 s58, 268435456, s58
  ds_read_b128 v[40:43], v76 offset:25600
  v_mov_b64 v[20:21], 0
  v_mov_b64 v[22:23], 0
  v_mov_b64 v[24:25], 0
  v_mov_b64 v[26:27], 0
  v_mov_b32 v68, 14880
  v_lshlrev_b32 v73, 2, v76
  buffer_load_dwordx4 v[52:55], v76, s[8:11], s59 offen offset:0 sc1
  buffer_load_dwordx4 v[56:59], v76, s[8:11], s59 offen offset:1024 sc1
  s_waitcnt vmcnt(0)
  s_mov_b64 vcc, -1
Cs2_h2r:
  s_mov_b64 exec, vcc
  buffer_load_dwordx4 v[12:15], v76, s[8:11], s65 offen offset:3072 sc1
  buffer_load_dwordx4 v[0:3], v76, s[8:11], s85 offen offset:0 sc1
  s_mov_b64 exec, -1
  s_add_u32 s67, s67, 1
  s_cmp_lt_u32 s67, 131072
  s_cselect_b32 s54, -2, -1
  s_waitcnt vmcnt(1)
  v_max3_u32 v72, v12, v13, v14
  s_waitcnt vmcnt(0)
  v_max3_u32 v72, v72, v15, v0
  v_max3_u32 v72, v72, v1, v2
  v_max_u32 v72, v72, v3
  v_cmp_lt_u32 vcc, s54, v72
  s_cbranch_vccnz Cs2_h2r
  ds_write_b128 v76, v[12:15] offset:7680
  ds_write_b128 v76, v[0:3] offset:12800
Cs2_h2w:
  s_cmp_eq_u32 s66, 63
  s_waitcnt lgkmcnt(0)
  s_barrier
  ds_read_b128 v[0:3], v76 offset:4608
Cs2_top2:
  v_smfmac_f32_16x16x64_bf16 v[20:23], v[12:15], v[128:135], v74
  s_cbranch_scc1 Cs2_last
  v_smfmac_f32_16x16x64_bf16 v[24:27], v[12:15], v[136:143], v74
  buffer_load_dwordx4 v[44:47], v76, s[8:11], s58 offen offset:0 sc1
  s_mov_b32 m0, 15872
  v_smfmac_f32_16x16x64_bf16 v[28:31], v[12:15], v[224:231], v74
  buffer_load_dwordx4 v[48:51], v76, s[8:11], s58 offen offset:1024 sc1
  v_smfmac_f32_16x16x64_bf16 v[32:35], v[12:15], v[232:239], v74
  ds_read_b128 v[4:7], v76 offset:5632
  s_waitcnt lgkmcnt(1)
  v_smfmac_f32_16x16x64_bf16 v[20:23], v[0:3], v[80:87], v74
  ds_read_b128 v[8:11], v76 offset:6656
  v_smfmac_f32_16x16x64_bf16 v[28:31], v[0:3], v[36:43], v74
  ds_read_b128 v[36:39], v76 offset:40960
  v_smfmac_f32_16x16x64_bf16 v[24:27], v[0:3], v[88:95], v74
  buffer_store_dwordx4 v[16:19], v76, s[8:11], s68 offen sc1
  ds_read_b128 v[40:43], v76 offset:41984
  v_smfmac_f32_16x16x64_bf16 v[32:35], v[0:3], v[60:67], v74
  buffer_load_dword v73, s[16:19], s70 offen lds
  ds_read_b128 v[60:63], v76 offset:43008
  s_waitcnt lgkmcnt(4)
  v_smfmac_f32_16x16x64_bf16 v[20:23], v[4:7], v[96:103], v74
  ds_read_b128 v[64:67], v76 offset:44032
  v_smfmac_f32_16x16x64_bf16 v[24:27], v[4:7], v[104:111], v74
  s_waitcnt vmcnt(4)
  s_waitcnt lgkmcnt(4)
  v_smfmac_f32_16x16x64_bf16 v[20:23], v[8:11], v[112:119], v74
  s_barrier
  ds_read_b128 v[12:15], v76 offset:8704
  s_waitcnt lgkmcnt(3)
  v_smfmac_f32_16x16x64_bf16 v[28:31], v[4:7], v[36:43], v74
  ds_read_b128 v[36:39], v76 offset:57344
  v_smfmac_f32_16x16x64_bf16 v[24:27], v[8:11], v[120:127], v74
  ds_read_b128 v[40:43], v76 offset:58368
  s_waitcnt lgkmcnt(3)
  v_smfmac_f32_16x16x64_bf16 v[32:35], v[4:7], v[60:67], v74
  ds_read_b128 v[0:3], v76 offset:9728
  v_smfmac_f32_16x16x64_bf16 v[28:31], v[8:11], v[208:215], v74
  ds_read_b128 v[60:63], v76 offset:59392
  v_smfmac_f32_16x16x64_bf16 v[32:35], v[8:11], v[216:223], v74
  ds_read_b128 v[64:67], v76 offset:60416
  s_waitcnt lgkmcnt(5)
  v_smfmac_f32_16x16x64_bf16 v[20:23], v[12:15], v[144:151], v74
  s_barrier
  ds_read_b128 v[4:7], v76 offset:11776
  s_waitcnt lgkmcnt(4)
  v_smfmac_f32_16x16x64_bf16 v[28:31], v[12:15], v[36:43], v74
  ds_read_b128 v[8:11], v76 offset:12800
  ds_read_b128 v[36:39], v75 offset:8192
  v_smfmac_f32_16x16x64_bf16 v[24:27], v[12:15], v[152:159], v74
  ds_read_b128 v[16:19], v76 offset:10752
  s_waitcnt lgkmcnt(6)
  v_smfmac_f32_16x16x64_bf16 v[20:23], v[0:3], v[160:167], v74
  ds_read_b128 v[40:43], v75 offset:9216
  s_waitcnt lgkmcnt(5)
  v_smfmac_f32_16x16x64_bf16 v[32:35], v[12:15], v[60:67], v74
  ds_read_b128 v[60:63], v75 offset:10240
  v_smfmac_f32_16x16x64_bf16 v[24:27], v[0:3], v[168:175], v74
  ds_read_b128 v[64:67], v75 offset:11264
  s_waitcnt lgkmcnt(6)
  v_smfmac_f32_16x16x64_bf16 v[20:23], v[4:7], v[176:183], v74
  s_waitcnt lgkmcnt(5)
  v_smfmac_f32_16x16x64_bf16 v[20:23], v[8:11], v[192:199], v74
  s_waitcnt lgkmcnt(2)
  v_smfmac_f32_16x16x64_bf16 v[20:23], v[16:19], v[36:43], v74
  ds_read_b128 v[36:39], v75 offset:24576
  v_smfmac_f32_16x16x64_bf16 v[24:27], v[4:7], v[184:191], v74
  ds_read_b128 v[40:43], v75 offset:25600
  s_waitcnt lgkmcnt(2)
  v_smfmac_f32_16x16x64_bf16 v[24:27], v[16:19], v[60:67], v74
  ds_read_b128 v[60:63], v75 offset:26624
  v_add_f32 v20, v20, v22
  v_smfmac_f32_16x16x64_bf16 v[24:27], v[8:11], v[200:207], v74
  ds_read_b128 v[64:67], v75 offset:27648
  v_add_f32 v21, v21, v23
  v_smfmac_f32_16x16x64_bf16 v[28:31], v[16:19], v[240:247], v74
  v_mov_b64 v[70:71], s[78:79]
  v_smfmac_f32_16x16x64_bf16 v[28:31], v[4:7], a[0:7], v74
  s_waitcnt lgkmcnt(2)
  v_add_f32 v24, v24, v26
  v_smfmac_f32_16x16x64_bf16 v[28:31], v[0:3], v[36:43], v74
  ds_read_b128 v[36:39], v68
  v_cvt_pk_bf16_f32 v22, v20, v24
  v_smfmac_f32_16x16x64_bf16 v[28:31], v[8:11], a[16:23], v74
  ds_read_b128 v[40:43], v68
  ds_write_b32 v79, v22 offset:0
  s_waitcnt lgkmcnt(3)
  v_add_f32 v25, v25, v27
  v_cvt_pk_bf16_f32 v23, v21, v25
  v_smfmac_f32_16x16x64_bf16 v[32:35], v[0:3], v[60:67], v74
  ds_write_b32 v79, v23 offset:576
  v_cmp_u_f32 vcc, v20, v21
  v_smfmac_f32_16x16x64_bf16 v[32:35], v[16:19], v[248:255], v74
  v_add_f32 v28, v28, v30
  v_smfmac_f32_16x16x64_bf16 v[32:35], v[4:7], a[8:15], v74
  v_add_f32 v29, v29, v31
  v_smfmac_f32_16x16x64_bf16 v[32:35], v[8:11], a[24:31], v74
  s_cbranch_vccnz Cs2_rec
Cs2_recok:
  s_waitcnt lgkmcnt(3)
  v_smfmac_f32_16x16x64_bf16 v[36:39], v[16:19], a[128:135], v74
  s_waitcnt lgkmcnt(0)
  s_barrier
  ds_read_b128 v[60:63], v77
  v_smfmac_f32_16x16x64_bf16 v[40:43], v[16:19], a[136:143], v74
  ds_read_b128 v[64:67], v77 offset:128
  v_add_f32 v32, v32, v34
  v_cvt_pk_bf16_f32 v30, v28, v32
  v_smfmac_f32_16x16x64_bf16 v[36:39], v[0:3], a[112:119], v74
  ds_write_b32 v79, v30 offset:256
  v_add_f32 v33, v33, v35
  v_cvt_pk_bf16_f32 v31, v29, v33
  v_smfmac_f32_16x16x64_bf16 v[40:43], v[0:3], a[120:127], v74
  ds_write_b32 v79, v31 offset:832
  v_xor_b32 v75, 0x8000, v75
  v_smfmac_f32_16x16x64_bf16 v[36:39], v[4:7], a[144:151], v74
  ds_read_b128 v[0:3], v76 offset:4608
  v_mov_b32 v29, 0
  v_smfmac_f32_16x16x64_bf16 v[40:43], v[4:7], a[152:159], v74
  s_waitcnt vmcnt(2) lgkmcnt(3)
  v_mov_b32 v30, 0
  v_mfma_f32_16x16x32_bf16 v[44:47], v[44:47], v[60:63], 0
  ds_read_b128 v[4:7], v76 offset:5632
  s_waitcnt lgkmcnt(2)
  v_mfma_f32_16x16x32_bf16 v[44:47], v[48:51], v[64:67], v[44:47]
  s_barrier
  v_smfmac_f32_16x16x64_bf16 v[36:39], v[8:11], a[160:167], v74
  ds_read_b128 v[20:23], v77 offset:256
  ds_read_b128 v[24:27], v77 offset:384
  v_smfmac_f32_16x16x64_bf16 v[40:43], v[8:11], a[168:175], v74
  ds_read_b128 v[8:11], v76 offset:6656
  v_add_f32_dpp v72, v46, v44 quad_perm:[2,3,0,1] row_mask:0xf bank_mask:0xf
  v_add_f32_dpp v73, v47, v45 quad_perm:[2,3,0,1] row_mask:0xf bank_mask:0xf
  v_smfmac_f32_16x16x64_bf16 v[36:39], v[12:15], a[96:103], v74
  s_waitcnt lgkmcnt(4)
  v_exp_f32_dpp v72, v72 quad_perm:[0,1,0,1] row_mask:0xf bank_mask:0xf
  v_smfmac_f32_16x16x64_bf16 v[40:43], v[12:15], a[104:111], v74
  ds_read_b128 v[12:15], v76 offset:7680
  v_exp_f32_dpp v73, v73 quad_perm:[0,1,0,1] row_mask:0xf bank_mask:0xf
  v_smfmac_f32_16x16x64_bf16 v[36:39], v[0:3], a[32:39], v74
  s_waitcnt lgkmcnt(2)
  v_cvt_pk_bf16_f32 v72, v72, v73
  v_mfma_f32_16x16x32_bf16 v[20:23], v[20:23], v[60:63], 0
  ds_write_b32 v78, v72 offset:520
  v_mov_b64 v[16:17], 0
  v_mfma_f32_16x16x32_bf16 v[20:23], v[24:27], v[64:67], v[20:23]
  ds_read_b128 v[44:47], v75 offset:40960
  v_mov_b64 v[18:19], 0
  v_smfmac_f32_16x16x64_bf16 v[40:43], v[0:3], a[40:47], v74
  ds_read_b128 v[48:51], v75 offset:41984
  v_mov_b64 v[68:69], s[78:79]
  v_smfmac_f32_16x16x64_bf16 v[36:39], v[4:7], a[48:55], v74
  s_waitcnt lgkmcnt(4)
  v_add_f32_dpp v24, v22, v20 quad_perm:[2,3,0,1] row_mask:0xf bank_mask:0xf
  v_add_f32_dpp v25, v23, v21 quad_perm:[2,3,0,1] row_mask:0xf bank_mask:0xf
  v_smfmac_f32_16x16x64_bf16 v[36:39], v[8:11], a[64:71], v74
  s_waitcnt lgkmcnt(2)
  s_barrier
  ds_read_b128 v[32:35], v78 offset:512
  v_smfmac_f32_16x16x64_bf16 v[36:39], v[12:15], a[80:87], v74
  ds_read_b128 v[60:63], v75 offset:24576
  v_mul_f32 v24, s69, v24
  v_smfmac_f32_16x16x64_bf16 v[40:43], v[4:7], a[56:63], v74
  ds_read_b128 v[64:67], v75 offset:25600
  v_mul_f32 v25, s69, v25
  v_smfmac_f32_16x16x64_bf16 v[40:43], v[8:11], a[72:79], v74
  v_exp_f32_dpp v24, v24 quad_perm:[0,1,0,1] row_mask:0xf bank_mask:0xf
  v_smfmac_f32_16x16x64_bf16 v[40:43], v[12:15], a[88:95], v74
  s_waitcnt lgkmcnt(2)
  v_exp_f32_dpp v25, v25 quad_perm:[0,1,0,1] row_mask:0xf bank_mask:0xf
  v_mfma_f32_16x16x32_bf16 v[8:11], v[32:35], v[68:71], 0
  v_add_f32 v36, v36, v38
  v_add_f32 v37, v37, v39
  v_mfma_f32_16x16x32_bf16 v[0:3], v[32:35], v[52:55], 0
  v_add_f32 v40, v40, v42
  v_add_f32 v41, v41, v43
  v_mfma_f32_16x16x32_bf16 v[4:7], v[32:35], v[56:59], 0
  v_cvt_pk_bf16_f32 v28, v24, v25
  v_cvt_pk_bf16_f32 v72, v36, v37
  v_cvt_pk_bf16_f32 v73, v40, v41
  v_mfma_f32_16x16x16_bf16 v[8:11], v[28:29], v[68:69], v[8:11]
  v_cvt_pk_bf16_f32 v31, v24, v25
  v_mov_b64 v[20:21], 0
  v_mfma_f32_16x16x16_bf16 v[0:3], v[28:29], v[72:73], v[0:3]
  ds_read_b128 v[52:55], v75 offset:26624
  v_mov_b64 v[22:23], 0
  v_mfma_f32_16x16x16_bf16 v[4:7], v[30:31], v[72:73], v[4:7]
  v_rcp_f32 v10, v8
  v_rcp_f32 v11, v9
  v_mul_f32 v0, v10, v0
  v_mul_f32 v1, v11, v1
  v_max3_f32 v8, v8, v9, v10
  v_mul_f32 v4, v10, v4
  v_mul_f32 v5, v11, v5
  v_cvt_pk_bf16_f32 v2, v0, v4
  ds_write_b32 v79, v2 offset:8704
  v_cvt_pk_bf16_f32 v3, v1, v5
  ds_write_b32 v79, v3 offset:9280
  ds_read_b128 v[12:15], v78 offset:8832
  v_max_f32 v8, v8, v11
  v_cmp_le_f32 vcc, 1317011456, v8
  v_mov_b64 v[24:25], 0
  v_mov_b64 v[26:27], 0
  ds_read_b128 v[56:59], v75 offset:27648
  s_cbranch_vccnz Cs2_mx
Cs2_mxok:
  s_waitcnt lgkmcnt(2)
  s_barrier
  ds_read_b128 v[0:3], v78 offset:8896
  s_waitcnt lgkmcnt(2)
  v_smfmac_f32_16x16x64_bf16 v[16:19], v[12:15], a[176:183], v74
  ds_read_b128 v[4:7], v78 offset:8704
  v_smfmac_f32_16x16x64_bf16 v[20:23], v[12:15], v[44:51], v74
  ds_read_b128 v[8:11], v78 offset:8768
  v_smfmac_f32_16x16x64_bf16 v[24:27], v[12:15], a[224:231], v74
  ds_read_b128 v[36:39], v75 offset:43008
  s_waitcnt lgkmcnt(3)
  v_smfmac_f32_16x16x64_bf16 v[16:19], v[0:3], a[184:191], v74
  ds_read_b128 v[40:43], v75 offset:44032
  s_waitcnt lgkmcnt(3)
  v_smfmac_f32_16x16x64_bf16 v[16:19], v[4:7], v[60:67], v74
  ds_read_b128 v[68:71], v76 offset:13824
  s_waitcnt lgkmcnt(3)
  v_smfmac_f32_16x16x64_bf16 v[16:19], v[8:11], v[52:59], v74
  ds_read_b128 v[44:47], v75 offset:57344
  v_smfmac_f32_16x16x64_bf16 v[20:23], v[4:7], a[192:199], v74
  ds_read_b128 v[48:51], v75 offset:58368
  v_smfmac_f32_16x16x64_bf16 v[20:23], v[8:11], a[200:207], v74
  ds_read_b128 v[60:63], v75 offset:59392
  s_waitcnt lgkmcnt(4)
  v_cvt_pk_bf16_f32 v16, v16, v17
  v_cvt_pk_bf16_f32 v17, v18, v19
  v_bfi_b32 v16, 1, s72, v16
  v_smfmac_f32_16x16x64_bf16 v[20:23], v[0:3], v[36:43], v74
  s_waitcnt lgkmcnt(3)
  buffer_store_dwordx2 v[16:17], v68, s[8:11], s73 offen sc1
  v_mov_b64 v[32:33], 0
  v_smfmac_f32_16x16x64_bf16 v[24:27], v[4:7], a[208:215], v74
  ds_read_b128 v[64:67], v75 offset:60416
  v_mov_b64 v[34:35], 0
  v_smfmac_f32_16x16x64_bf16 v[24:27], v[8:11], a[216:223], v74
  ds_read_b128 v[52:55], v75 offset:0
  v_cvt_pk_bf16_f32 v20, v20, v21
  v_cvt_pk_bf16_f32 v21, v22, v23
  v_bfi_b32 v20, 1, s72, v20
  v_smfmac_f32_16x16x64_bf16 v[24:27], v[0:3], a[232:239], v74
  ds_read_b128 v[56:59], v75 offset:1024
  buffer_store_dwordx2 v[20:21], v68, s[8:11], s74 offen sc1
  s_waitcnt lgkmcnt(4)
  v_mov_b64 v[28:29], 0
  v_smfmac_f32_16x16x64_bf16 v[32:35], v[4:7], v[44:51], v74
  ds_read_b128 v[36:39], v75 offset:2048
  ds_read_b128 v[40:43], v75 offset:3072
  s_waitcnt lgkmcnt(4)
  v_smfmac_f32_16x16x64_bf16 v[32:35], v[8:11], v[60:67], v74
  ds_read_b128 v[44:47], v75 offset:4096
  v_cvt_pk_bf16_f32 v24, v24, v25
  v_cvt_pk_bf16_f32 v25, v26, v27
  v_bfi_b32 v24, 1, s72, v24
  v_smfmac_f32_16x16x64_bf16 v[32:35], v[12:15], a[240:247], v74
  ds_read_b128 v[48:51], v75 offset:5120
  buffer_store_dwordx2 v[24:25], v68, s[8:11], s75 offen sc1
  v_mov_b64 v[30:31], 0
  v_smfmac_f32_16x16x64_bf16 v[32:35], v[0:3], a[248:255], v74
  ds_read_b128 v[60:63], v75 offset:6144
  ds_read_b128 v[64:67], v75 offset:7168
  s_waitcnt lgkmcnt(6)
  v_smfmac_f32_16x16x64_bf16 v[28:31], v[4:7], v[52:59], v74
  s_waitcnt lgkmcnt(4)
  v_smfmac_f32_16x16x64_bf16 v[28:31], v[8:11], v[36:43], v74
  s_waitcnt lgkmcnt(2)
  v_cvt_pk_bf16_f32 v32, v32, v33
  v_cvt_pk_bf16_f32 v33, v34, v35
  v_bfi_b32 v32, 1, s72, v32
  v_smfmac_f32_16x16x64_bf16 v[28:31], v[12:15], v[44:51], v74
  buffer_store_dwordx2 v[32:33], v68, s[8:11], s76 offen sc1
  s_waitcnt lgkmcnt(0)
  v_smfmac_f32_16x16x64_bf16 v[28:31], v[0:3], v[60:67], v74
  v_mov_b64 v[18:19], v[72:73]
  s_nop 4
  v_cvt_pk_bf16_f32 v28, v28, v29
  v_cvt_pk_bf16_f32 v29, v30, v31
  v_bfi_b32 v28, 1, s72, v28
  buffer_store_dwordx2 v[28:29], v68, s[8:11], s77 offen sc1
  ds_read_b128 v[0:3], v76 offset:14848
  s_waitcnt lgkmcnt(0)
  ds_read_b64 v[16:17], v77 offset:384
  s_waitcnt lgkmcnt(0)
  ds_read_b128 v[64:67], v76 offset:27648
  s_waitcnt lgkmcnt(0)
  ds_read_b128 v[60:63], v76 offset:26624
  s_waitcnt lgkmcnt(0)
  v_xor_b32 v75, 0x8000, v75
  v_mov_b64 v[28:29], 0
  v_mov_b64 v[30:31], 0
  v_mov_b64 v[32:33], 0
  v_mov_b64 v[34:35], 0
  s_waitcnt vmcnt(0)
  buffer_load_dwordx4 v[52:55], v76, s[8:11], s60 offen offset:0 sc1
  buffer_load_dwordx4 v[56:59], v76, s[8:11], s60 offen offset:1024 sc1
  s_add_u32 s66, s66, 1
  s_xor_b32 s64, s64, 16384
  s_xor_b32 s65, s65, 16384
  s_add_u32 s58, s58, 655360
  s_add_u32 s59, s59, 655360
  s_add_u32 s70, s70, 655360
  s_add_u32 s68, s68, 655360
  s_mov_b32 m0, 12800
  s_add_u32 s85, s65, 8192
  s_waitcnt lgkmcnt(0)
  s_waitcnt vmcnt(1)
  v_mfma_f32_16x16x32_bf16 v[4:7], v[0:3], v[52:55], 0
  v_bitop3_b32 v72, v52, v54, s72 bitop3:0x7e
  s_waitcnt vmcnt(0)
  v_mfma_f32_16x16x32_bf16 v[4:7], v[0:3], v[56:59], v[4:7]
  v_bitop3_b32 v73, v56, v58, s72 bitop3:0x7e
  v_bitop3_b32 v72, v72, v73, 1 bitop3:0xa8
  v_cmp_ne_u32 vcc, 0, v72
  s_cbranch_vccnz Cs2_h1r
  s_nop 2
  v_add_f32_dpp v4, v4, v4 row_ror:4 row_mask:0xf bank_mask:0xf
  v_add_f32_dpp v5, v5, v5 row_ror:4 row_mask:0xf bank_mask:0xf
  s_nop 0
  v_add_f32_dpp v4, v4, v4 row_ror:8 row_mask:0xf bank_mask:0xf
  v_add_f32_dpp v5, v5, v5 row_ror:8 row_mask:0xf bank_mask:0xf
  v_cvt_pk_bf16_f32 v4, v4, v5
  buffer_store_dword v4, v69, s[8:11], s62 offen sc1
  s_xor_b32 s62, s62, 16384
  buffer_store_dword v71, v69, s[8:11], s62 offen sc1
  s_xor_b32 s72, s72, 1
  s_branch Cs2_h2
Cs2_h1r:
  s_mov_b64 exec, vcc
  buffer_load_dwordx4 v[52:55], v76, s[8:11], s60 offen offset:0 sc1
  buffer_load_dwordx4 v[56:59], v76, s[8:11], s60 offen offset:1024 sc1
  s_mov_b64 exec, -1
  s_add_u32 s67, s67, 1
  s_waitcnt vmcnt(1)
  v_mfma_f32_16x16x32_bf16 v[4:7], v[0:3], v[52:55], 0
  v_bitop3_b32 v72, v52, v54, s72 bitop3:0x7e
  s_waitcnt vmcnt(0)
  v_mfma_f32_16x16x32_bf16 v[4:7], v[0:3], v[56:59], v[4:7]
  v_bitop3_b32 v73, v56, v58, s72 bitop3:0x7e
  v_bitop3_b32 v72, v72, v73, 1 bitop3:0xa8
  v_cmp_ne_u32 vcc, 0, v72
  s_cbranch_vccz Cs2_h1p
Cs2_h1s:
  s_mov_b64 exec, vcc
  buffer_load_dwordx4 v[52:55], v76, s[8:11], s60 offen offset:0 sc1
  buffer_load_dwordx4 v[56:59], v76, s[8:11], s60 offen offset:1024 sc1
  s_mov_b64 exec, -1
  s_add_u32 s67, s67, 1
  s_waitcnt vmcnt(1)
  v_mfma_f32_16x16x32_bf16 v[4:7], v[0:3], v[52:55], 0
  v_bitop3_b32 v72, v52, v54, s72 bitop3:0x7e
  s_waitcnt vmcnt(0)
  v_mfma_f32_16x16x32_bf16 v[4:7], v[0:3], v[56:59], v[4:7]
  v_bitop3_b32 v73, v56, v58, s72 bitop3:0x7e
  v_bitop3_b32 v72, v72, v73, 1 bitop3:0xa8
  v_cmp_ne_u32 vcc, 0, v72
  s_cbranch_vccz Cs2_h1p
  s_cmp_lt_u32 s67, 131072
  s_cbranch_scc1 Cs2_h1s
Cs2_h1p:
  s_nop 2
  v_add_f32_dpp v4, v4, v4 row_ror:4 row_mask:0xf bank_mask:0xf
  v_add_f32_dpp v5, v5, v5 row_ror:4 row_mask:0xf bank_mask:0xf
  s_nop 0
  v_add_f32_dpp v4, v4, v4 row_ror:8 row_mask:0xf bank_mask:0xf
  v_add_f32_dpp v5, v5, v5 row_ror:8 row_mask:0xf bank_mask:0xf
  v_cvt_pk_bf16_f32 v4, v4, v5
  buffer_store_dword v4, v69, s[8:11], s62 offen sc1
  s_xor_b32 s62, s62, 16384
  buffer_store_dword v71, v69, s[8:11], s62 offen sc1
  s_xor_b32 s72, s72, 1
  s_branch Cs2_h2
Cs2_rec:
  s_nop 7
  s_waitcnt vmcnt(0) lgkmcnt(0)
  v_max3_u32 v72, v0, v1, v2
  v_max3_u32 v72, v72, v3, v4
  v_max3_u32 v72, v72, v5, v6
  v_max3_u32 v72, v72, v7, v8
  v_max3_u32 v72, v72, v9, v10
  v_max3_u32 v72, v72, v11, v12
  v_max3_u32 v72, v72, v13, v14
  v_max3_u32 v72, v72, v15, v16
  v_max3_u32 v72, v72, v17, v18
  v_max_u32 v72, v72, v19
  v_cmp_eq_u32 vcc, -1, v72
  s_cbranch_vccz Cs2_recok
  s_barrier
Cs2_recp:
  buffer_load_dwordx4 v[0:3], v76, s[8:11], s64 offen offset:0 sc1
  buffer_load_dwordx4 v[4:7], v76, s[8:11], s64 offen offset:1024 sc1
  s_add_u32 s67, s67, 1
  s_cmp_lt_u32 s67, 131072
  s_cselect_b32 s54, -2, -1
  s_waitcnt vmcnt(1)
  v_max3_u32 v72, v0, v1, v2
  s_waitcnt vmcnt(0)
  v_max3_u32 v72, v72, v3, v4
  v_max3_u32 v72, v72, v5, v6
  v_max_u32 v72, v72, v7
  v_cmp_lt_u32 vcc, s54, v72
  s_cbranch_vccnz Cs2_recp
  ds_write_b128 v76, v[0:3] offset:8704
  ds_write_b128 v76, v[4:7] offset:9728
  v_mov_b64 v[20:21], 0
  v_mov_b64 v[22:23], 0
  v_mov_b64 v[24:25], 0
  v_mov_b64 v[26:27], 0
  v_mov_b64 v[28:29], 0
  v_mov_b64 v[30:31], 0
  v_mov_b64 v[32:33], 0
  v_mov_b64 v[34:35], 0
  s_waitcnt lgkmcnt(0)
  s_barrier
  ds_read_b128 v[0:3], v76 offset:4608
  s_waitcnt lgkmcnt(0)
  v_smfmac_f32_16x16x64_bf16 v[20:23], v[0:3], v[80:87], v74
  v_smfmac_f32_16x16x64_bf16 v[24:27], v[0:3], v[88:95], v74
  ds_read_b128 v[60:63], v76 offset:24576
  ds_read_b128 v[64:67], v76 offset:25600
  s_waitcnt lgkmcnt(0)
  v_smfmac_f32_16x16x64_bf16 v[28:31], v[0:3], v[60:67], v74
  ds_read_b128 v[60:63], v76 offset:26624
  ds_read_b128 v[64:67], v76 offset:27648
  s_waitcnt lgkmcnt(0)
  v_smfmac_f32_16x16x64_bf16 v[32:35], v[0:3], v[60:67], v74
  ds_read_b128 v[4:7], v76 offset:5632
  s_waitcnt lgkmcnt(0)
  v_smfmac_f32_16x16x64_bf16 v[20:23], v[4:7], v[96:103], v74
  v_smfmac_f32_16x16x64_bf16 v[24:27], v[4:7], v[104:111], v74
  ds_read_b128 v[60:63], v76 offset:40960
  ds_read_b128 v[64:67], v76 offset:41984
  s_waitcnt lgkmcnt(0)
  v_smfmac_f32_16x16x64_bf16 v[28:31], v[4:7], v[60:67], v74
  ds_read_b128 v[60:63], v76 offset:43008
  ds_read_b128 v[64:67], v76 offset:44032
  s_waitcnt lgkmcnt(0)
  v_smfmac_f32_16x16x64_bf16 v[32:35], v[4:7], v[60:67], v74
  ds_read_b128 v[8:11], v76 offset:6656
  s_waitcnt lgkmcnt(0)
  v_smfmac_f32_16x16x64_bf16 v[20:23], v[8:11], v[112:119], v74
  v_smfmac_f32_16x16x64_bf16 v[24:27], v[8:11], v[120:127], v74
  v_smfmac_f32_16x16x64_bf16 v[28:31], v[8:11], v[208:215], v74
  v_smfmac_f32_16x16x64_bf16 v[32:35], v[8:11], v[216:223], v74
  ds_read_b128 v[12:15], v76 offset:7680
  s_waitcnt lgkmcnt(0)
  v_smfmac_f32_16x16x64_bf16 v[20:23], v[12:15], v[128:135], v74
  v_smfmac_f32_16x16x64_bf16 v[24:27], v[12:15], v[136:143], v74
  v_smfmac_f32_16x16x64_bf16 v[28:31], v[12:15], v[224:231], v74
  v_smfmac_f32_16x16x64_bf16 v[32:35], v[12:15], v[232:239], v74
  ds_read_b128 v[12:15], v76 offset:8704
  s_waitcnt lgkmcnt(0)
  v_smfmac_f32_16x16x64_bf16 v[20:23], v[12:15], v[144:151], v74
  v_smfmac_f32_16x16x64_bf16 v[24:27], v[12:15], v[152:159], v74
  ds_read_b128 v[60:63], v76 offset:57344
  ds_read_b128 v[64:67], v76 offset:58368
  s_waitcnt lgkmcnt(0)
  v_smfmac_f32_16x16x64_bf16 v[28:31], v[12:15], v[60:67], v74
  ds_read_b128 v[60:63], v76 offset:59392
  ds_read_b128 v[64:67], v76 offset:60416
  s_waitcnt lgkmcnt(0)
  v_smfmac_f32_16x16x64_bf16 v[32:35], v[12:15], v[60:67], v74
  ds_read_b128 v[0:3], v76 offset:9728
  s_waitcnt lgkmcnt(0)
  v_smfmac_f32_16x16x64_bf16 v[20:23], v[0:3], v[160:167], v74
  v_smfmac_f32_16x16x64_bf16 v[24:27], v[0:3], v[168:175], v74
  ds_read_b128 v[60:63], v75 offset:24576
  ds_read_b128 v[64:67], v75 offset:25600
  s_waitcnt lgkmcnt(0)
  v_smfmac_f32_16x16x64_bf16 v[28:31], v[0:3], v[60:67], v74
  ds_read_b128 v[60:63], v75 offset:26624
  ds_read_b128 v[64:67], v75 offset:27648
  s_waitcnt lgkmcnt(0)
  v_smfmac_f32_16x16x64_bf16 v[32:35], v[0:3], v[60:67], v74
  ds_read_b128 v[16:19], v76 offset:10752
  ds_read_b128 v[60:63], v75 offset:8192
  ds_read_b128 v[64:67], v75 offset:9216
  s_waitcnt lgkmcnt(0)
  v_smfmac_f32_16x16x64_bf16 v[20:23], v[16:19], v[60:67], v74
  ds_read_b128 v[60:63], v75 offset:10240
  ds_read_b128 v[64:67], v75 offset:11264
  s_waitcnt lgkmcnt(0)
  v_smfmac_f32_16x16x64_bf16 v[24:27], v[16:19], v[60:67], v74
  v_smfmac_f32_16x16x64_bf16 v[28:31], v[16:19], v[240:247], v74
  v_smfmac_f32_16x16x64_bf16 v[32:35], v[16:19], v[248:255], v74
  ds_read_b128 v[4:7], v76 offset:11776
  s_waitcnt lgkmcnt(0)
  v_smfmac_f32_16x16x64_bf16 v[20:23], v[4:7], v[176:183], v74
  v_smfmac_f32_16x16x64_bf16 v[24:27], v[4:7], v[184:191], v74
  v_smfmac_f32_16x16x64_bf16 v[28:31], v[4:7], a[0:7], v74
  v_smfmac_f32_16x16x64_bf16 v[32:35], v[4:7], a[8:15], v74
  ds_read_b128 v[8:11], v76 offset:12800
  s_waitcnt lgkmcnt(0)
  v_smfmac_f32_16x16x64_bf16 v[20:23], v[8:11], v[192:199], v74
  v_smfmac_f32_16x16x64_bf16 v[24:27], v[8:11], v[200:207], v74
  v_smfmac_f32_16x16x64_bf16 v[28:31], v[8:11], a[16:23], v74
  v_smfmac_f32_16x16x64_bf16 v[32:35], v[8:11], a[24:31], v74
  v_add_f32 v20, v20, v22
  v_add_f32 v21, v21, v23
  v_add_f32 v24, v24, v26
  v_cvt_pk_bf16_f32 v22, v20, v24
  ds_write_b32 v79, v22 offset:0
  v_add_f32 v25, v25, v27
  v_cvt_pk_bf16_f32 v23, v21, v25
  ds_write_b32 v79, v23 offset:576
  v_add_f32 v28, v28, v30
  v_add_f32 v29, v29, v31
  s_waitcnt lgkmcnt(0)
  s_nop 1
  s_branch Cs2_recok
Cs2_mx:
  s_waitcnt lgkmcnt(0)
  s_barrier
  buffer_load_dwordx4 v[52:55], v76, s[8:11], s59 offen offset:0 sc1
  buffer_load_dwordx4 v[0:3], v76, s[8:11], s58 offen offset:0 sc1
  ds_read_b128 v[20:23], v77 offset:0
  ds_read_b128 v[28:31], v77 offset:256
  buffer_load_dwordx4 v[56:59], v76, s[8:11], s59 offen offset:1024 sc1
  buffer_load_dwordx4 v[4:7], v76, s[8:11], s58 offen offset:1024 sc1
  ds_read_b128 v[24:27], v77 offset:128
  ds_read_b128 v[32:35], v77 offset:384
  s_waitcnt vmcnt(2) lgkmcnt(3)
  v_mfma_f32_16x16x32_bf16 v[8:11], v[0:3], v[20:23], 0
  s_waitcnt vmcnt(0) lgkmcnt(1)
  v_mfma_f32_16x16x32_bf16 v[8:11], v[4:7], v[24:27], v[8:11]
  v_mfma_f32_16x16x32_bf16 v[12:15], v[28:31], v[20:23], 0
  s_waitcnt lgkmcnt(0)
  v_mfma_f32_16x16x32_bf16 v[12:15], v[32:35], v[24:27], v[12:15]
  v_add_f32_dpp v8, v10, v8 quad_perm:[2,3,0,1] row_mask:0xf bank_mask:0xf
  v_add_f32_dpp v9, v11, v9 quad_perm:[2,3,0,1] row_mask:0xf bank_mask:0xf
  s_nop 0
  v_mov_b32_dpp v8, v8 quad_perm:[0,1,0,1] row_mask:0xf bank_mask:0xf
  v_mov_b32_dpp v9, v9 quad_perm:[0,1,0,1] row_mask:0xf bank_mask:0xf
  s_nop 1
  v_add_f32_dpp v12, v14, v12 quad_perm:[2,3,0,1] row_mask:0xf bank_mask:0xf
  v_add_f32_dpp v13, v15, v13 quad_perm:[2,3,0,1] row_mask:0xf bank_mask:0xf
  s_nop 0
  v_mov_b32_dpp v12, v12 quad_perm:[0,1,0,1] row_mask:0xf bank_mask:0xf
  v_mov_b32_dpp v13, v13 quad_perm:[0,1,0,1] row_mask:0xf bank_mask:0xf
  v_mul_f32 v12, s69, v12
  ds_write_b32 v78, v8 offset:8712
  v_mul_f32 v13, s69, v13
  ds_write_b32 v78, v9 offset:8776
  s_waitcnt lgkmcnt(0)
  s_barrier
  ds_read_b128 v[36:39], v78 offset:8704
  ds_read_b128 v[40:43], v78 offset:8768
  s_waitcnt lgkmcnt(0)
  s_barrier
  v_max_f32 v16, v36, v37
  v_max3_f32 v16, v16, v38, v39
  v_max3_f32 v16, v16, v40, v41
  v_max3_f32 v16, v16, v42, v43
  v_max3_f32 v16, v16, v12, v13
  v_mov_b32 v17, v16
  s_nop 1
  v_permlane16_swap_b32 v16, v17
  v_max_f32 v16, v16, v17
  v_mov_b32 v17, v16
  s_nop 1
  v_permlane32_swap_b32 v16, v17
  v_max_f32 v16, v16, v17
  v_sub_f32 v36, v36, v16
  v_sub_f32 v37, v37, v16
  v_sub_f32 v38, v38, v16
  v_sub_f32 v39, v39, v16
  v_sub_f32 v40, v40, v16
  v_sub_f32 v41, v41, v16
  v_sub_f32 v42, v42, v16
  v_sub_f32 v43, v43, v16
  v_sub_f32 v12, v12, v16
  v_sub_f32 v13, v13, v16
  v_exp_f32 v36, v36
  v_exp_f32 v37, v37
  v_exp_f32 v38, v38
  v_exp_f32 v39, v39
  v_exp_f32 v40, v40
  v_exp_f32 v41, v41
  v_exp_f32 v42, v42
  v_exp_f32 v43, v43
  v_exp_f32 v12, v12
  v_exp_f32 v13, v13
  v_cvt_pk_bf16_f32 v32, v36, v40
  v_cvt_pk_bf16_f32 v33, v37, v41
  v_cvt_pk_bf16_f32 v34, v38, v42
  v_cvt_pk_bf16_f32 v35, v39, v43
  v_cvt_pk_bf16_f32 v28, v12, v13
  v_cvt_pk_bf16_f32 v31, v12, v13
  v_mov_b32 v29, 0
  v_mov_b32 v30, 0
  v_mfma_f32_16x16x32_bf16 v[8:11], v[32:35], v[68:71], 0
  v_mfma_f32_16x16x32_bf16 v[0:3], v[32:35], v[52:55], 0
  v_mfma_f32_16x16x32_bf16 v[4:7], v[32:35], v[56:59], 0
  v_mfma_f32_16x16x16_bf16 v[8:11], v[28:29], v[68:69], v[8:11]
  v_mfma_f32_16x16x16_bf16 v[0:3], v[28:29], v[72:73], v[0:3]
  v_mfma_f32_16x16x16_bf16 v[4:7], v[30:31], v[72:73], v[4:7]
  ds_read_b128 v[52:55], v75 offset:26624
  v_rcp_f32 v10, v8
  v_rcp_f32 v11, v9
  v_mul_f32 v0, v10, v0
  v_mul_f32 v1, v11, v1
  v_max3_f32 v8, v8, v9, v10
  v_mul_f32 v4, v10, v4
  v_mul_f32 v5, v11, v5
  v_cvt_pk_bf16_f32 v2, v0, v4
  ds_write_b32 v79, v2 offset:8704
  v_cvt_pk_bf16_f32 v3, v1, v5
  ds_write_b32 v79, v3 offset:9280
  ds_read_b128 v[12:15], v78 offset:8832
  ds_read_b128 v[56:59], v75 offset:27648
  v_mov_b64 v[16:17], 0
  v_mov_b64 v[18:19], 0
  v_mov_b64 v[20:21], 0
  v_mov_b64 v[22:23], 0
  v_mov_b64 v[24:25], 0
  v_mov_b64 v[26:27], 0
  s_branch Cs2_mxok
Cs2_last:
  ds_read_b128 v[4:7], v76 offset:5632
  ds_read_b128 v[8:11], v76 offset:6656
  ds_read_b128 v[44:47], v76 offset:40960
  ds_read_b128 v[48:51], v76 offset:41984
  s_nop 5
  v_mov_b64 v[20:21], 0
  v_mov_b64 v[22:23], 0
  v_mov_b64 v[24:25], 0
  v_mov_b64 v[26:27], 0
  s_waitcnt lgkmcnt(4)
  v_smfmac_f32_16x16x64_bf16 v[28:31], v[0:3], v[36:43], v74
  ds_read_b128 v[36:39], v76 offset:43008
  ds_read_b128 v[40:43], v76 offset:44032
  v_smfmac_f32_16x16x64_bf16 v[32:35], v[0:3], v[60:67], v74
  s_waitcnt lgkmcnt(5)
  v_smfmac_f32_16x16x64_bf16 v[20:23], v[0:3], a[32:39], v74
  ds_read_b128 v[60:63], v76 offset:57344
  ds_read_b128 v[64:67], v76 offset:58368
  v_smfmac_f32_16x16x64_bf16 v[24:27], v[0:3], a[40:47], v74
  s_waitcnt lgkmcnt(4)
  v_smfmac_f32_16x16x64_bf16 v[20:23], v[4:7], a[48:55], v74
  buffer_store_dwordx4 v[16:19], v76, s[8:11], s68 offen sc1
  v_smfmac_f32_16x16x64_bf16 v[24:27], v[4:7], a[56:63], v74
  v_smfmac_f32_16x16x64_bf16 v[28:31], v[4:7], v[44:51], v74
  s_waitcnt lgkmcnt(2)
  v_smfmac_f32_16x16x64_bf16 v[20:23], v[8:11], a[64:71], v74
  ds_read_b128 v[44:47], v76 offset:59392
  ds_read_b128 v[48:51], v76 offset:60416
  v_smfmac_f32_16x16x64_bf16 v[24:27], v[8:11], a[72:79], v74
  v_smfmac_f32_16x16x64_bf16 v[32:35], v[4:7], v[36:43], v74
  v_smfmac_f32_16x16x64_bf16 v[28:31], v[8:11], v[208:215], v74
  ds_read_b128 v[36:39], v75 offset:24576
  ds_read_b128 v[40:43], v75 offset:25600
  v_smfmac_f32_16x16x64_bf16 v[32:35], v[8:11], v[216:223], v74
  v_smfmac_f32_16x16x64_bf16 v[20:23], v[12:15], a[80:87], v74
  v_smfmac_f32_16x16x64_bf16 v[24:27], v[12:15], a[88:95], v74
  v_smfmac_f32_16x16x64_bf16 v[28:31], v[12:15], v[224:231], v74
  v_smfmac_f32_16x16x64_bf16 v[32:35], v[12:15], v[232:239], v74
  s_waitcnt vmcnt(1)
  s_barrier
Cs2_lastr:
  ds_read_b128 v[12:15], v76 offset:8704
  ds_read_b128 v[0:3], v76 offset:9728
  ds_read_b128 v[16:19], v76 offset:10752
  ds_read_b128 v[4:7], v76 offset:11776
  ds_read_b128 v[8:11], v76 offset:12800
  s_waitcnt lgkmcnt(3)
  v_max3_u32 v72, v0, v1, v2
  s_waitcnt lgkmcnt(1)
  v_max3_u32 v72, v72, v3, v4
  v_max3_u32 v72, v72, v5, v6
  s_waitcnt lgkmcnt(0)
  v_max3_u32 v72, v72, v7, v8
  v_max3_u32 v72, v72, v9, v10
  v_max3_u32 v72, v72, v11, v12
  v_max3_u32 v72, v72, v13, v14
  v_max3_u32 v72, v72, v15, v16
  v_max3_u32 v72, v72, v17, v18
  v_max_u32 v72, v72, v19
  v_cmp_eq_u32 vcc, -1, v72
  s_cbranch_vccnz Cs2_lastp
Cs2_lastg:
  v_smfmac_f32_16x16x64_bf16 v[28:31], v[12:15], v[60:67], v74
  ds_read_b128 v[60:63], v75 offset:26624
  ds_read_b128 v[64:67], v75 offset:27648
  v_smfmac_f32_16x16x64_bf16 v[32:35], v[12:15], v[44:51], v74
  v_smfmac_f32_16x16x64_bf16 v[28:31], v[0:3], v[36:43], v74
  v_smfmac_f32_16x16x64_bf16 v[28:31], v[16:19], v[240:247], v74
  v_smfmac_f32_16x16x64_bf16 v[28:31], v[4:7], a[0:7], v74
  v_smfmac_f32_16x16x64_bf16 v[28:31], v[8:11], a[16:23], v74
  v_smfmac_f32_16x16x64_bf16 v[32:35], v[16:19], v[248:255], v74
  v_smfmac_f32_16x16x64_bf16 v[32:35], v[4:7], a[8:15], v74
  s_waitcnt lgkmcnt(0)
  v_smfmac_f32_16x16x64_bf16 v[32:35], v[8:11], a[24:31], v74
  v_smfmac_f32_16x16x64_bf16 v[32:35], v[0:3], v[60:67], v74
  v_smfmac_f32_16x16x64_bf16 v[20:23], v[12:15], a[96:103], v74
  v_smfmac_f32_16x16x64_bf16 v[20:23], v[0:3], a[112:119], v74
  v_add_f32 v28, v28, v30
  v_add_f32 v32, v32, v34
  v_cvt_pk_bf16_f32 v30, v28, v32
  v_smfmac_f32_16x16x64_bf16 v[20:23], v[16:19], a[128:135], v74
  ds_write_b32 v79, v30 offset:256
  v_add_f32 v29, v29, v31
  v_add_f32 v33, v33, v35
  v_cvt_pk_bf16_f32 v31, v29, v33
  v_smfmac_f32_16x16x64_bf16 v[20:23], v[4:7], a[144:151], v74
  ds_write_b32 v79, v31 offset:832
  v_smfmac_f32_16x16x64_bf16 v[20:23], v[8:11], a[160:167], v74
  v_smfmac_f32_16x16x64_bf16 v[24:27], v[12:15], a[104:111], v74
  v_smfmac_f32_16x16x64_bf16 v[24:27], v[0:3], a[120:127], v74
  v_smfmac_f32_16x16x64_bf16 v[24:27], v[16:19], a[136:143], v74
  s_waitcnt lgkmcnt(0)
  s_barrier
  ds_read_b64 v[52:53], v77 offset:384
  v_add_f32 v20, v20, v22
  v_smfmac_f32_16x16x64_bf16 v[24:27], v[4:7], a[152:159], v74
  v_add_f32 v21, v21, v23
  v_smfmac_f32_16x16x64_bf16 v[24:27], v[8:11], a[168:175], v74
  v_cvt_pk_bf16_f32 v54, v20, v21
  s_add_u32 s68, s68, 655360
  s_nop 3
  v_add_f32 v24, v24, v26
  v_add_f32 v25, v25, v27
  v_cvt_pk_bf16_f32 v55, v24, v25
  s_waitcnt lgkmcnt(0)
  buffer_store_dwordx4 v[52:55], v76, s[8:11], s68 offen sc1
  s_branch Cs2_done
Cs2_lastp:
  s_add_u32 s72, s72, 2
  s_cmp_ge_u32 s72, 131072
  s_cbranch_scc1 Cs2_lastg
  s_barrier
  buffer_load_dwordx4 v76, s[8:11], s85 offen offset:0 sc1 lds
  s_waitcnt vmcnt(0)
  s_barrier
  s_branch Cs2_lastr
Cs2_done:
  s_branch L_cexit
L_w7:
  v_mov_b64 v[20:21], 0
  v_mov_b64 v[22:23], 0
  v_mov_b64 v[24:25], 0
  v_mov_b64 v[26:27], 0
  v_mov_b64 v[28:29], 0
  v_mov_b64 v[30:31], 0
  v_mov_b64 v[32:33], 0
  v_mov_b64 v[34:35], 0
  s_mov_b32 s78, 0x3f803f80
  s_mov_b32 s79, s78
  s_mov_b32 s65, 360448
  s_mov_b32 m0, 15872
  s_lshl_b32 s71, s53, 2
  s_add_u32 s71, s71, 128
  s_movk_i32 s56, 0x1000
  v_lshlrev_b32 v73, 2, v76
  v_mov_b32 v72, 0
  s_mov_b64 s[16:17], s[8:9]
  s_mov_b32 s18, 268435456
  s_mov_b32 s19, 0x20000
  s_getpc_b64 s[20:21]
Cs3_pc:
  s_add_u32 s20, s20, (Cs3_last - Cs3_pc)
  s_addc_u32 s21, s21, 0
  v_mov_b32 v68, 14880
  buffer_load_dwordx4 v[52:55], v76, s[8:11], s59 offen offset:0 sc1
  buffer_load_dwordx4 v[56:59], v76, s[8:11], s59 offen offset:1024 sc1
  ds_read_b128 v[36:39], v76 offset:45056
  ds_read_b128 v[40:43], v76 offset:46080
  ds_read_b128 v[60:63], v76 offset:47104
  ds_read_b128 v[64:67], v76 offset:48128
  ds_read_b128 v[0:3], v76 offset:4608
  ds_read_b128 v[4:7], v76 offset:5632
  ds_read_b128 v[8:11], v76 offset:6656
  ds_read_b128 v[12:15], v76 offset:7680
  s_waitcnt lgkmcnt(0)
  s_cmp_eq_u32 s66, 1
  s_branch Cs3_top2
.p2align 6
Cs3_h2:
  v_lshlrev_b32 v73, 2, v76
  ds_read_b128 v[36:39], v76 offset:45056
  ds_read_b128 v[40:43], v76 offset:46080
  buffer_load_dwordx4 v[52:55], v76, s[8:11], s59 offen offset:0 sc1
  buffer_load_dwordx4 v[56:59], v76, s[8:11], s59 offen offset:1024 sc1
  s_waitcnt vmcnt(0)
  s_mov_b64 vcc, -1
Cs3_h2r:
  s_mov_b64 exec, vcc
  buffer_load_dwordx4 v[4:7], v76, s[8:11], s65 offen offset:1024 sc1
  buffer_load_dwordx4 v[0:3], v76, s[8:11], s85 offen offset:0 sc1
  buffer_load_dwordx4 v[8:11], v76, s[8:11], s85 offen offset:1024 sc1
  s_mov_b64 exec, -1
  s_add_u32 s67, s67, 1
  s_cmp_lt_u32 s67, 131072
  s_cselect_b32 s54, -2, -1
  s_waitcnt vmcnt(2)
  v_max3_u32 v72, v4, v5, v6
  s_waitcnt vmcnt(1)
  v_max3_u32 v72, v72, v7, v0
  v_max3_u32 v72, v72, v1, v2
  s_waitcnt vmcnt(0)
  v_max3_u32 v72, v72, v3, v8
  v_max3_u32 v72, v72, v9, v10
  v_max_u32 v72, v72, v11
  v_cmp_lt_u32 vcc, s54, v72
  s_cbranch_vccnz Cs3_h2r
  ds_write_b128 v76, v[4:7] offset:5632
  ds_write_b128 v76, v[0:3] offset:8704
  ds_write_b128 v76, v[8:11] offset:9728
Cs3_h2w:
  s_cmp_eq_u32 s66, 63
  s_waitcnt lgkmcnt(0)
  s_barrier
  ds_read_b128 v[8:11], v76 offset:6656
Cs3_top2:
  v_smfmac_f32_16x16x64_bf16 v[20:23], v[4:7], v[96:103], v74
  s_cbranch_scc1 Cs3_last
  v_smfmac_f32_16x16x64_bf16 v[28:31], v[4:7], v[36:43], v74
  buffer_load_dwordx4 v[44:47], v76, s[8:11], s58 offen offset:0 sc1
  s_mov_b32 m0, 15872
  v_smfmac_f32_16x16x64_bf16 v[24:27], v[4:7], v[104:111], v74
  buffer_load_dwordx4 v[48:51], v76, s[8:11], s58 offen offset:1024 sc1
  v_smfmac_f32_16x16x64_bf16 v[32:35], v[4:7], v[60:67], v74
  ds_read_b128 v[0:3], v76 offset:4608
  s_waitcnt lgkmcnt(1)
  v_smfmac_f32_16x16x64_bf16 v[20:23], v[8:11], v[112:119], v74
  ds_read_b128 v[12:15], v76 offset:7680
  v_smfmac_f32_16x16x64_bf16 v[24:27], v[8:11], v[120:127], v74
  ds_read_b128 v[36:39], v76 offset:28672
  v_smfmac_f32_16x16x64_bf16 v[28:31], v[8:11], v[208:215], v74
  buffer_store_dwordx4 v[16:19], v76, s[8:11], s68 offen sc1
  ds_read_b128 v[40:43], v76 offset:29696
  v_smfmac_f32_16x16x64_bf16 v[32:35], v[8:11], v[216:223], v74
  buffer_load_dword v73, s[16:19], s70 offen lds
  ds_read_b128 v[60:63], v76 offset:30720
  s_waitcnt lgkmcnt(4)
  v_smfmac_f32_16x16x64_bf16 v[20:23], v[0:3], v[80:87], v74
  ds_read_b128 v[64:67], v76 offset:31744
  v_smfmac_f32_16x16x64_bf16 v[24:27], v[0:3], v[88:95], v74
  s_waitcnt vmcnt(4)
  s_waitcnt lgkmcnt(4)
  v_smfmac_f32_16x16x64_bf16 v[20:23], v[12:15], v[128:135], v74
  s_barrier
  ds_read_b128 v[4:7], v76 offset:8704
  s_waitcnt lgkmcnt(3)
  v_smfmac_f32_16x16x64_bf16 v[28:31], v[0:3], v[36:43], v74
  ds_read_b128 v[36:39], v76 offset:61440
  v_smfmac_f32_16x16x64_bf16 v[24:27], v[12:15], v[136:143], v74
  ds_read_b128 v[40:43], v76 offset:62464
  s_waitcnt lgkmcnt(3)
  v_smfmac_f32_16x16x64_bf16 v[32:35], v[0:3], v[60:67], v74
  ds_read_b128 v[8:11], v76 offset:9728
  v_smfmac_f32_16x16x64_bf16 v[28:31], v[12:15], v[224:231], v74
  ds_read_b128 v[60:63], v76 offset:63488
  v_smfmac_f32_16x16x64_bf16 v[32:35], v[12:15], v[232:239], v74
  ds_read_b128 v[64:67], v76 offset:64512
  s_waitcnt lgkmcnt(5)
  v_smfmac_f32_16x16x64_bf16 v[20:23], v[4:7], v[144:151], v74
  s_barrier
  ds_read_b128 v[0:3], v76 offset:11776
  s_waitcnt lgkmcnt(4)
  v_smfmac_f32_16x16x64_bf16 v[28:31], v[4:7], v[36:43], v74
  ds_read_b128 v[12:15], v76 offset:12800
  ds_read_b128 v[36:39], v75 offset:12288
  v_smfmac_f32_16x16x64_bf16 v[24:27], v[4:7], v[152:159], v74
  ds_read_b128 v[16:19], v76 offset:10752
  s_waitcnt lgkmcnt(6)
  v_smfmac_f32_16x16x64_bf16 v[20:23], v[8:11], v[160:167], v74
  ds_read_b128 v[40:43], v75 offset:13312
  s_waitcnt lgkmcnt(5)
  v_smfmac_f32_16x16x64_bf16 v[32:35], v[4:7], v[60:67], v74
  ds_read_b128 v[60:63], v75 offset:14336
  v_smfmac_f32_16x16x64_bf16 v[24:27], v[8:11], v[168:175], v74
  ds_read_b128 v[64:67], v75 offset:15360
  s_waitcnt lgkmcnt(6)
  v_smfmac_f32_16x16x64_bf16 v[20:23], v[0:3], v[176:183], v74
  s_waitcnt lgkmcnt(5)
  v_smfmac_f32_16x16x64_bf16 v[20:23], v[12:15], v[192:199], v74
  s_waitcnt lgkmcnt(2)
  v_smfmac_f32_16x16x64_bf16 v[20:23], v[16:19], v[36:43], v74
  ds_read_b128 v[36:39], v75 offset:28672
  v_smfmac_f32_16x16x64_bf16 v[24:27], v[0:3], v[184:191], v74
  ds_read_b128 v[40:43], v75 offset:29696
  s_waitcnt lgkmcnt(2)
  v_smfmac_f32_16x16x64_bf16 v[24:27], v[16:19], v[60:67], v74
  ds_read_b128 v[60:63], v75 offset:30720
  v_add_f32 v20, v20, v22
  v_smfmac_f32_16x16x64_bf16 v[24:27], v[12:15], v[200:207], v74
  ds_read_b128 v[64:67], v75 offset:31744
  v_add_f32 v21, v21, v23
  v_smfmac_f32_16x16x64_bf16 v[28:31], v[16:19], v[240:247], v74
  v_mov_b64 v[70:71], s[78:79]
  v_smfmac_f32_16x16x64_bf16 v[28:31], v[0:3], a[0:7], v74
  s_waitcnt lgkmcnt(2)
  v_add_f32 v24, v24, v26
  v_smfmac_f32_16x16x64_bf16 v[28:31], v[8:11], v[36:43], v74
  ds_read_b128 v[36:39], v68
  v_cvt_pk_bf16_f32 v22, v20, v24
  v_smfmac_f32_16x16x64_bf16 v[28:31], v[12:15], a[16:23], v74
  ds_read_b128 v[40:43], v68
  ds_write_b32 v79, v22 offset:0
  s_waitcnt lgkmcnt(3)
  v_add_f32 v25, v25, v27
  v_cvt_pk_bf16_f32 v23, v21, v25
  v_smfmac_f32_16x16x64_bf16 v[32:35], v[8:11], v[60:67], v74
  ds_write_b32 v79, v23 offset:576
  v_cmp_u_f32 vcc, v20, v21
  v_smfmac_f32_16x16x64_bf16 v[32:35], v[16:19], v[248:255], v74
  v_add_f32 v28, v28, v30
  v_smfmac_f32_16x16x64_bf16 v[32:35], v[0:3], a[8:15], v74
  v_add_f32 v29, v29, v31
  v_smfmac_f32_16x16x64_bf16 v[32:35], v[12:15], a[24:31], v74
  s_cbranch_vccnz Cs3_rec
Cs3_recok:
  s_waitcnt lgkmcnt(3)
  v_smfmac_f32_16x16x64_bf16 v[36:39], v[16:19], a[128:135], v74
  s_waitcnt lgkmcnt(0)
  s_barrier
  ds_read_b128 v[60:63], v77
  v_smfmac_f32_16x16x64_bf16 v[40:43], v[16:19], a[136:143], v74
  ds_read_b128 v[64:67], v77 offset:128
  v_add_f32 v32, v32, v34
  v_cvt_pk_bf16_f32 v30, v28, v32
  v_smfmac_f32_16x16x64_bf16 v[36:39], v[0:3], a[144:151], v74
  ds_write_b32 v79, v30 offset:256
  v_add_f32 v33, v33, v35
  v_cvt_pk_bf16_f32 v31, v29, v33
  v_smfmac_f32_16x16x64_bf16 v[40:43], v[0:3], a[152:159], v74
  ds_write_b32 v79, v31 offset:832
  v_xor_b32 v75, 0x8000, v75
  v_smfmac_f32_16x16x64_bf16 v[36:39], v[4:7], a[96:103], v74
  ds_read_b128 v[0:3], v76 offset:4608
  v_mov_b32 v29, 0
  v_smfmac_f32_16x16x64_bf16 v[40:43], v[4:7], a[104:111], v74
  s_waitcnt vmcnt(2) lgkmcnt(3)
  v_mov_b32 v30, 0
  v_mfma_f32_16x16x32_bf16 v[44:47], v[44:47], v[60:63], 0
  ds_read_b128 v[4:7], v76 offset:5632
  s_waitcnt lgkmcnt(2)
  v_mfma_f32_16x16x32_bf16 v[44:47], v[48:51], v[64:67], v[44:47]
  s_barrier
  v_smfmac_f32_16x16x64_bf16 v[36:39], v[8:11], a[112:119], v74
  ds_read_b128 v[20:23], v77 offset:256
  ds_read_b128 v[24:27], v77 offset:384
  v_smfmac_f32_16x16x64_bf16 v[40:43], v[8:11], a[120:127], v74
  ds_read_b128 v[8:11], v76 offset:6656
  v_add_f32_dpp v72, v46, v44 quad_perm:[2,3,0,1] row_mask:0xf bank_mask:0xf
  v_add_f32_dpp v73, v47, v45 quad_perm:[2,3,0,1] row_mask:0xf bank_mask:0xf
  v_smfmac_f32_16x16x64_bf16 v[36:39], v[12:15], a[160:167], v74
  s_waitcnt lgkmcnt(4)
  v_exp_f32_dpp v72, v72 quad_perm:[0,1,0,1] row_mask:0xf bank_mask:0xf
  v_smfmac_f32_16x16x64_bf16 v[40:43], v[12:15], a[168:175], v74
  ds_read_b128 v[12:15], v76 offset:7680
  v_exp_f32_dpp v73, v73 quad_perm:[0,1,0,1] row_mask:0xf bank_mask:0xf
  v_smfmac_f32_16x16x64_bf16 v[36:39], v[0:3], a[32:39], v74
  s_waitcnt lgkmcnt(2)
  v_cvt_pk_bf16_f32 v72, v72, v73
  v_mfma_f32_16x16x32_bf16 v[20:23], v[20:23], v[60:63], 0
  ds_write_b32 v78, v72 offset:524
  v_mov_b64 v[16:17], 0
  v_mfma_f32_16x16x32_bf16 v[20:23], v[24:27], v[64:67], v[20:23]
  ds_read_b128 v[44:47], v75 offset:47104
  v_mov_b64 v[18:19], 0
  v_smfmac_f32_16x16x64_bf16 v[40:43], v[0:3], a[40:47], v74
  ds_read_b128 v[48:51], v75 offset:48128
  v_mov_b64 v[68:69], s[78:79]
  v_smfmac_f32_16x16x64_bf16 v[36:39], v[4:7], a[48:55], v74
  s_waitcnt lgkmcnt(4)
  v_add_f32_dpp v24, v22, v20 quad_perm:[2,3,0,1] row_mask:0xf bank_mask:0xf
  v_add_f32_dpp v25, v23, v21 quad_perm:[2,3,0,1] row_mask:0xf bank_mask:0xf
  v_smfmac_f32_16x16x64_bf16 v[36:39], v[8:11], a[64:71], v74
  s_waitcnt lgkmcnt(2)
  s_barrier
  ds_read_b128 v[32:35], v78 offset:512
  v_smfmac_f32_16x16x64_bf16 v[36:39], v[12:15], a[80:87], v74
  ds_read_b128 v[60:63], v75 offset:28672
  v_mul_f32 v24, s69, v24
  v_smfmac_f32_16x16x64_bf16 v[40:43], v[4:7], a[56:63], v74
  ds_read_b128 v[64:67], v75 offset:29696
  v_mul_f32 v25, s69, v25
  v_smfmac_f32_16x16x64_bf16 v[40:43], v[8:11], a[72:79], v74
  v_exp_f32_dpp v24, v24 quad_perm:[0,1,0,1] row_mask:0xf bank_mask:0xf
  v_smfmac_f32_16x16x64_bf16 v[40:43], v[12:15], a[88:95], v74
  s_waitcnt lgkmcnt(2)
  v_exp_f32_dpp v25, v25 quad_perm:[0,1,0,1] row_mask:0xf bank_mask:0xf
  v_mfma_f32_16x16x32_bf16 v[8:11], v[32:35], v[68:71], 0
  v_add_f32 v36, v36, v38
  v_add_f32 v37, v37, v39
  v_mfma_f32_16x16x32_bf16 v[0:3], v[32:35], v[52:55], 0
  v_add_f32 v40, v40, v42
  v_add_f32 v41, v41, v43
  v_mfma_f32_16x16x32_bf16 v[4:7], v[32:35], v[56:59], 0
  v_cvt_pk_bf16_f32 v28, v24, v25
  v_cvt_pk_bf16_f32 v72, v36, v37
  v_cvt_pk_bf16_f32 v73, v40, v41
  v_mfma_f32_16x16x16_bf16 v[8:11], v[28:29], v[68:69], v[8:11]
  v_cvt_pk_bf16_f32 v31, v24, v25
  v_mov_b64 v[20:21], 0
  v_mfma_f32_16x16x16_bf16 v[0:3], v[28:29], v[72:73], v[0:3]
  ds_read_b128 v[52:55], v75 offset:30720
  v_mov_b64 v[22:23], 0
  v_mfma_f32_16x16x16_bf16 v[4:7], v[30:31], v[72:73], v[4:7]
  v_rcp_f32 v10, v8
  v_rcp_f32 v11, v9
  v_mul_f32 v0, v10, v0
  v_mul_f32 v1, v11, v1
  v_max3_f32 v8, v8, v9, v10
  v_mul_f32 v4, v10, v4
  v_mul_f32 v5, v11, v5
  v_cvt_pk_bf16_f32 v2, v0, v4
  ds_write_b32 v79, v2 offset:8704
  v_cvt_pk_bf16_f32 v3, v1, v5
  ds_write_b32 v79, v3 offset:9280
  ds_read_b128 v[12:15], v78 offset:8896
  v_max_f32 v8, v8, v11
  v_cmp_le_f32 vcc, 1317011456, v8
  v_mov_b64 v[24:25], 0
  v_mov_b64 v[26:27], 0
  ds_read_b128 v[56:59], v75 offset:31744
  s_cbranch_vccnz Cs3_mx
Cs3_mxok:
  s_waitcnt lgkmcnt(2)
  s_barrier
  ds_read_b128 v[0:3], v78 offset:8832
  s_waitcnt lgkmcnt(2)
  v_smfmac_f32_16x16x64_bf16 v[16:19], v[12:15], a[184:191], v74
  ds_read_b128 v[4:7], v78 offset:8704
  v_smfmac_f32_16x16x64_bf16 v[20:23], v[12:15], v[44:51], v74
  ds_read_b128 v[8:11], v78 offset:8768
  v_smfmac_f32_16x16x64_bf16 v[24:27], v[12:15], a[232:239], v74
  ds_read_b128 v[36:39], v75 offset:45056
  s_waitcnt lgkmcnt(3)
  v_smfmac_f32_16x16x64_bf16 v[16:19], v[0:3], a[176:183], v74
  ds_read_b128 v[40:43], v75 offset:46080
  s_waitcnt lgkmcnt(3)
  v_smfmac_f32_16x16x64_bf16 v[16:19], v[4:7], v[60:67], v74
  ds_read_b128 v[68:71], v76 offset:13824
  s_waitcnt lgkmcnt(3)
  v_smfmac_f32_16x16x64_bf16 v[16:19], v[8:11], v[52:59], v74
  ds_read_b128 v[44:47], v75 offset:61440
  v_smfmac_f32_16x16x64_bf16 v[20:23], v[4:7], a[192:199], v74
  ds_read_b128 v[48:51], v75 offset:62464
  v_smfmac_f32_16x16x64_bf16 v[20:23], v[8:11], a[200:207], v74
  ds_read_b128 v[60:63], v75 offset:63488
  s_waitcnt lgkmcnt(4)
  v_cvt_pk_bf16_f32 v16, v16, v17
  v_cvt_pk_bf16_f32 v17, v18, v19
  v_bfi_b32 v16, 1, s72, v16
  v_smfmac_f32_16x16x64_bf16 v[20:23], v[0:3], v[36:43], v74
  s_waitcnt lgkmcnt(3)
  buffer_store_dwordx2 v[16:17], v68, s[8:11], s73 offen sc1
  v_mov_b64 v[32:33], 0
  v_smfmac_f32_16x16x64_bf16 v[24:27], v[4:7], a[208:215], v74
  ds_read_b128 v[64:67], v75 offset:64512
  v_mov_b64 v[34:35], 0
  v_smfmac_f32_16x16x64_bf16 v[24:27], v[8:11], a[216:223], v74
  ds_read_b128 v[52:55], v75 offset:8192
  v_cvt_pk_bf16_f32 v20, v20, v21
  v_cvt_pk_bf16_f32 v21, v22, v23
  v_bfi_b32 v20, 1, s72, v20
  v_smfmac_f32_16x16x64_bf16 v[24:27], v[0:3], a[224:231], v74
  ds_read_b128 v[56:59], v75 offset:9216
  buffer_store_dwordx2 v[20:21], v68, s[8:11], s74 offen sc1
  s_waitcnt lgkmcnt(4)
  v_mov_b64 v[28:29], 0
  v_smfmac_f32_16x16x64_bf16 v[32:35], v[4:7], v[44:51], v74
  ds_read_b128 v[36:39], v75 offset:10240
  ds_read_b128 v[40:43], v75 offset:11264
  s_waitcnt lgkmcnt(4)
  v_smfmac_f32_16x16x64_bf16 v[32:35], v[8:11], v[60:67], v74
  ds_read_b128 v[44:47], v75 offset:12288
  v_cvt_pk_bf16_f32 v24, v24, v25
  v_cvt_pk_bf16_f32 v25, v26, v27
  v_bfi_b32 v24, 1, s72, v24
  v_smfmac_f32_16x16x64_bf16 v[32:35], v[0:3], a[240:247], v74
  ds_read_b128 v[48:51], v75 offset:13312
  buffer_store_dwordx2 v[24:25], v68, s[8:11], s75 offen sc1
  v_mov_b64 v[30:31], 0
  v_smfmac_f32_16x16x64_bf16 v[32:35], v[12:15], a[248:255], v74
  ds_read_b128 v[60:63], v75 offset:14336
  ds_read_b128 v[64:67], v75 offset:15360
  s_waitcnt lgkmcnt(6)
  v_smfmac_f32_16x16x64_bf16 v[28:31], v[4:7], v[52:59], v74
  s_waitcnt lgkmcnt(4)
  v_smfmac_f32_16x16x64_bf16 v[28:31], v[8:11], v[36:43], v74
  s_waitcnt lgkmcnt(2)
  v_cvt_pk_bf16_f32 v32, v32, v33
  v_cvt_pk_bf16_f32 v33, v34, v35
  v_bfi_b32 v32, 1, s72, v32
  v_smfmac_f32_16x16x64_bf16 v[28:31], v[0:3], v[44:51], v74
  buffer_store_dwordx2 v[32:33], v68, s[8:11], s76 offen sc1
  s_waitcnt lgkmcnt(0)
  v_smfmac_f32_16x16x64_bf16 v[28:31], v[12:15], v[60:67], v74
  v_mov_b64 v[18:19], v[72:73]
  s_nop 4
  v_cvt_pk_bf16_f32 v28, v28, v29
  v_cvt_pk_bf16_f32 v29, v30, v31
  v_bfi_b32 v28, 1, s72, v28
  buffer_store_dwordx2 v[28:29], v68, s[8:11], s77 offen sc1
  ds_read_b128 v[52:55], v76 offset:14848
  s_waitcnt lgkmcnt(0)
  ds_read_b64 v[16:17], v77 offset:392
  s_waitcnt lgkmcnt(0)
  ds_read_b128 v[60:63], v76 offset:47104
  s_waitcnt lgkmcnt(0)
  ds_read_b128 v[64:67], v76 offset:48128
  s_waitcnt lgkmcnt(0)
  s_add_u32 s66, s66, 1
  s_xor_b32 s64, s64, 16384
  s_xor_b32 s65, s65, 16384
  s_add_u32 s58, s58, 655360
  s_add_u32 s59, s59, 655360
  s_add_u32 s70, s70, 655360
  s_add_u32 s68, s68, 655360
  s_mov_b32 m0, 8704
  s_add_u32 s85, s65, 4096
  v_xor_b32 v75, 0x8000, v75
  v_mov_b64 v[28:29], 0
  v_mov_b64 v[30:31], 0
  v_mov_b64 v[32:33], 0
  v_mov_b64 v[34:35], 0
  s_waitcnt vmcnt(0)
  buffer_load_dwordx4 v[0:3], v76, s[8:11], s60 offen offset:0 sc1
  buffer_load_dwordx4 v[4:7], v76, s[8:11], s60 offen offset:1024 sc1
  buffer_load_dwordx4 v[8:11], v76, s[8:11], s61 offen offset:0 sc1
  buffer_load_dwordx4 v[12:15], v76, s[8:11], s61 offen offset:1024 sc1
  v_mov_b64 v[20:21], 0
  v_mov_b64 v[22:23], 0
  v_mov_b64 v[24:25], 0
  v_mov_b64 v[26:27], 0
  v_mov_b32 v68, 14880
  s_cmp_eq_u32 s66, 62
  s_cselect_b64 s[16:17], s[20:21], s[16:17]
  s_cselect_b32 s18, (Cs3_done - Cs3_last), s18
  s_cselect_b32 s70, 0, s70
  s_cmp_eq_u32 s66, 63
  s_cselect_b32 s59, 268435456, s59
  s_cselect_b32 s58, 268435456, s58
  s_waitcnt lgkmcnt(0)
  s_waitcnt vmcnt(3)
  v_mfma_f32_16x16x32_bf16 v[56:59], v[52:55], v[0:3], 0
  v_bitop3_b32 v72, v0, v2, s72 bitop3:0x7e
  s_waitcnt vmcnt(2)
  v_mfma_f32_16x16x32_bf16 v[56:59], v[52:55], v[4:7], v[56:59]
  v_bitop3_b32 v73, v4, v6, s72 bitop3:0x7e
  v_or_b32 v72, v72, v73
  s_waitcnt vmcnt(1)
  v_mfma_f32_16x16x32_bf16 v[36:39], v[52:55], v[8:11], 0
  v_bitop3_b32 v73, v8, v10, s72 bitop3:0x7e
  v_or_b32 v72, v72, v73
  s_waitcnt vmcnt(0)
  v_mfma_f32_16x16x32_bf16 v[36:39], v[52:55], v[12:15], v[36:39]
  v_bitop3_b32 v73, v12, v14, s72 bitop3:0x7e
  v_bitop3_b32 v72, v72, v73, 1 bitop3:0xa8
  v_cmp_ne_u32 vcc, 0, v72
  s_cbranch_vccnz Cs3_h1r
  v_add_f32_dpp v56, v56, v56 row_ror:4 row_mask:0xf bank_mask:0xf
  v_add_f32_dpp v57, v57, v57 row_ror:4 row_mask:0xf bank_mask:0xf
  s_nop 0
  v_add_f32_dpp v36, v36, v36 row_ror:4 row_mask:0xf bank_mask:0xf
  v_add_f32_dpp v37, v37, v37 row_ror:4 row_mask:0xf bank_mask:0xf
  v_add_f32_dpp v56, v56, v56 row_ror:8 row_mask:0xf bank_mask:0xf
  v_add_f32_dpp v57, v57, v57 row_ror:8 row_mask:0xf bank_mask:0xf
  v_add_f32_dpp v36, v36, v36 row_ror:8 row_mask:0xf bank_mask:0xf
  v_add_f32_dpp v37, v37, v37 row_ror:8 row_mask:0xf bank_mask:0xf
  v_cvt_pk_bf16_f32 v56, v56, v57
  buffer_store_dword v56, v69, s[8:11], s62 offen sc1
  v_cvt_pk_bf16_f32 v36, v36, v37
  buffer_store_dword v36, v70, s[8:11], s63 offen sc1
  s_xor_b32 s62, s62, 16384
  buffer_store_dword v71, v69, s[8:11], s62 offen sc1
  s_xor_b32 s63, s63, 16384
  buffer_store_dword v71, v70, s[8:11], s63 offen sc1
  s_xor_b32 s72, s72, 1
  s_branch Cs3_h2
Cs3_h1r:
  s_mov_b64 exec, vcc
  buffer_load_dwordx4 v[0:3], v76, s[8:11], s60 offen offset:0 sc1
  buffer_load_dwordx4 v[4:7], v76, s[8:11], s60 offen offset:1024 sc1
  buffer_load_dwordx4 v[8:11], v76, s[8:11], s61 offen offset:0 sc1
  buffer_load_dwordx4 v[12:15], v76, s[8:11], s61 offen offset:1024 sc1
  s_mov_b64 exec, -1
  s_add_u32 s67, s67, 1
  s_waitcnt vmcnt(3)
  v_mfma_f32_16x16x32_bf16 v[56:59], v[52:55], v[0:3], 0
  v_bitop3_b32 v72, v0, v2, s72 bitop3:0x7e
  s_waitcnt vmcnt(2)
  v_mfma_f32_16x16x32_bf16 v[56:59], v[52:55], v[4:7], v[56:59]
  v_bitop3_b32 v73, v4, v6, s72 bitop3:0x7e
  v_or_b32 v72, v72, v73
  s_waitcnt vmcnt(1)
  v_mfma_f32_16x16x32_bf16 v[36:39], v[52:55], v[8:11], 0
  v_bitop3_b32 v73, v8, v10, s72 bitop3:0x7e
  v_or_b32 v72, v72, v73
  s_waitcnt vmcnt(0)
  v_mfma_f32_16x16x32_bf16 v[36:39], v[52:55], v[12:15], v[36:39]
  v_bitop3_b32 v73, v12, v14, s72 bitop3:0x7e
  v_bitop3_b32 v72, v72, v73, 1 bitop3:0xa8
  v_cmp_ne_u32 vcc, 0, v72
  s_cbranch_vccz Cs3_h1p
Cs3_h1s:
  s_mov_b64 exec, vcc
  buffer_load_dwordx4 v[0:3], v76, s[8:11], s60 offen offset:0 sc1
  buffer_load_dwordx4 v[4:7], v76, s[8:11], s60 offen offset:1024 sc1
  buffer_load_dwordx4 v[8:11], v76, s[8:11], s61 offen offset:0 sc1
  buffer_load_dwordx4 v[12:15], v76, s[8:11], s61 offen offset:1024 sc1
  s_mov_b64 exec, -1
  s_add_u32 s67, s67, 1
  s_waitcnt vmcnt(3)
  v_mfma_f32_16x16x32_bf16 v[56:59], v[52:55], v[0:3], 0
  v_bitop3_b32 v72, v0, v2, s72 bitop3:0x7e
  s_waitcnt vmcnt(2)
  v_mfma_f32_16x16x32_bf16 v[56:59], v[52:55], v[4:7], v[56:59]
  v_bitop3_b32 v73, v4, v6, s72 bitop3:0x7e
  v_or_b32 v72, v72, v73
  s_waitcnt vmcnt(1)
  v_mfma_f32_16x16x32_bf16 v[36:39], v[52:55], v[8:11], 0
  v_bitop3_b32 v73, v8, v10, s72 bitop3:0x7e
  v_or_b32 v72, v72, v73
  s_waitcnt vmcnt(0)
  v_mfma_f32_16x16x32_bf16 v[36:39], v[52:55], v[12:15], v[36:39]
  v_bitop3_b32 v73, v12, v14, s72 bitop3:0x7e
  v_bitop3_b32 v72, v72, v73, 1 bitop3:0xa8
  v_cmp_ne_u32 vcc, 0, v72
  s_cbranch_vccz Cs3_h1p
  s_cmp_lt_u32 s67, 131072
  s_cbranch_scc1 Cs3_h1s
Cs3_h1p:
  s_nop 2
  v_add_f32_dpp v56, v56, v56 row_ror:4 row_mask:0xf bank_mask:0xf
  v_add_f32_dpp v57, v57, v57 row_ror:4 row_mask:0xf bank_mask:0xf
  v_add_f32_dpp v36, v36, v36 row_ror:4 row_mask:0xf bank_mask:0xf
  v_add_f32_dpp v37, v37, v37 row_ror:4 row_mask:0xf bank_mask:0xf
  v_add_f32_dpp v56, v56, v56 row_ror:8 row_mask:0xf bank_mask:0xf
  v_add_f32_dpp v57, v57, v57 row_ror:8 row_mask:0xf bank_mask:0xf
  v_add_f32_dpp v36, v36, v36 row_ror:8 row_mask:0xf bank_mask:0xf
  v_add_f32_dpp v37, v37, v37 row_ror:8 row_mask:0xf bank_mask:0xf
  v_cvt_pk_bf16_f32 v56, v56, v57
  buffer_store_dword v56, v69, s[8:11], s62 offen sc1
  v_cvt_pk_bf16_f32 v36, v36, v37
  buffer_store_dword v36, v70, s[8:11], s63 offen sc1
  s_xor_b32 s62, s62, 16384
  buffer_store_dword v71, v69, s[8:11], s62 offen sc1
  s_xor_b32 s63, s63, 16384
  buffer_store_dword v71, v70, s[8:11], s63 offen sc1
  s_xor_b32 s72, s72, 1
  s_branch Cs3_h2
Cs3_rec:
  s_nop 7
  s_waitcnt vmcnt(0) lgkmcnt(0)
  v_max3_u32 v72, v0, v1, v2
  v_max3_u32 v72, v72, v3, v4
  v_max3_u32 v72, v72, v5, v6
  v_max3_u32 v72, v72, v7, v8
  v_max3_u32 v72, v72, v9, v10
  v_max3_u32 v72, v72, v11, v12
  v_max3_u32 v72, v72, v13, v14
  v_max3_u32 v72, v72, v15, v16
  v_max3_u32 v72, v72, v17, v18
  v_max_u32 v72, v72, v19
  v_cmp_eq_u32 vcc, -1, v72
  s_cbranch_vccz Cs3_recok
  s_barrier
Cs3_recp:
  buffer_load_dwordx4 v[0:3], v76, s[8:11], s64 offen offset:0 sc1
  buffer_load_dwordx4 v[4:7], v76, s[8:11], s64 offen offset:1024 sc1
  buffer_load_dwordx4 v[8:11], v76, s[8:11], s64 offen offset:2048 sc1
  s_add_u32 s67, s67, 1
  s_cmp_lt_u32 s67, 131072
  s_cselect_b32 s54, -2, -1
  s_waitcnt vmcnt(2)
  v_max3_u32 v72, v0, v1, v2
  s_waitcnt vmcnt(1)
  v_max3_u32 v72, v72, v3, v4
  v_max3_u32 v72, v72, v5, v6
  s_waitcnt vmcnt(0)
  v_max3_u32 v72, v72, v7, v8
  v_max3_u32 v72, v72, v9, v10
  v_max_u32 v72, v72, v11
  v_cmp_lt_u32 vcc, s54, v72
  s_cbranch_vccnz Cs3_recp
  ds_write_b128 v76, v[0:3] offset:10752
  ds_write_b128 v76, v[4:7] offset:11776
  ds_write_b128 v76, v[8:11] offset:12800
  v_mov_b64 v[20:21], 0
  v_mov_b64 v[22:23], 0
  v_mov_b64 v[24:25], 0
  v_mov_b64 v[26:27], 0
  v_mov_b64 v[28:29], 0
  v_mov_b64 v[30:31], 0
  v_mov_b64 v[32:33], 0
  v_mov_b64 v[34:35], 0
  s_waitcnt lgkmcnt(0)
  s_barrier
  ds_read_b128 v[0:3], v76 offset:4608
  s_waitcnt lgkmcnt(0)
  v_smfmac_f32_16x16x64_bf16 v[20:23], v[0:3], v[80:87], v74
  v_smfmac_f32_16x16x64_bf16 v[24:27], v[0:3], v[88:95], v74
  ds_read_b128 v[60:63], v76 offset:28672
  ds_read_b128 v[64:67], v76 offset:29696
  s_waitcnt lgkmcnt(0)
  v_smfmac_f32_16x16x64_bf16 v[28:31], v[0:3], v[60:67], v74
  ds_read_b128 v[60:63], v76 offset:30720
  ds_read_b128 v[64:67], v76 offset:31744
  s_waitcnt lgkmcnt(0)
  v_smfmac_f32_16x16x64_bf16 v[32:35], v[0:3], v[60:67], v74
  ds_read_b128 v[4:7], v76 offset:5632
  s_waitcnt lgkmcnt(0)
  v_smfmac_f32_16x16x64_bf16 v[20:23], v[4:7], v[96:103], v74
  v_smfmac_f32_16x16x64_bf16 v[24:27], v[4:7], v[104:111], v74
  ds_read_b128 v[60:63], v76 offset:45056
  ds_read_b128 v[64:67], v76 offset:46080
  s_waitcnt lgkmcnt(0)
  v_smfmac_f32_16x16x64_bf16 v[28:31], v[4:7], v[60:67], v74
  ds_read_b128 v[60:63], v76 offset:47104
  ds_read_b128 v[64:67], v76 offset:48128
  s_waitcnt lgkmcnt(0)
  v_smfmac_f32_16x16x64_bf16 v[32:35], v[4:7], v[60:67], v74
  ds_read_b128 v[8:11], v76 offset:6656
  s_waitcnt lgkmcnt(0)
  v_smfmac_f32_16x16x64_bf16 v[20:23], v[8:11], v[112:119], v74
  v_smfmac_f32_16x16x64_bf16 v[24:27], v[8:11], v[120:127], v74
  v_smfmac_f32_16x16x64_bf16 v[28:31], v[8:11], v[208:215], v74
  v_smfmac_f32_16x16x64_bf16 v[32:35], v[8:11], v[216:223], v74
  ds_read_b128 v[12:15], v76 offset:7680
  s_waitcnt lgkmcnt(0)
  v_smfmac_f32_16x16x64_bf16 v[20:23], v[12:15], v[128:135], v74
  v_smfmac_f32_16x16x64_bf16 v[24:27], v[12:15], v[136:143], v74
  v_smfmac_f32_16x16x64_bf16 v[28:31], v[12:15], v[224:231], v74
  v_smfmac_f32_16x16x64_bf16 v[32:35], v[12:15], v[232:239], v74
  ds_read_b128 v[4:7], v76 offset:8704
  s_waitcnt lgkmcnt(0)
  v_smfmac_f32_16x16x64_bf16 v[20:23], v[4:7], v[144:151], v74
  v_smfmac_f32_16x16x64_bf16 v[24:27], v[4:7], v[152:159], v74
  ds_read_b128 v[60:63], v76 offset:61440
  ds_read_b128 v[64:67], v76 offset:62464
  s_waitcnt lgkmcnt(0)
  v_smfmac_f32_16x16x64_bf16 v[28:31], v[4:7], v[60:67], v74
  ds_read_b128 v[60:63], v76 offset:63488
  ds_read_b128 v[64:67], v76 offset:64512
  s_waitcnt lgkmcnt(0)
  v_smfmac_f32_16x16x64_bf16 v[32:35], v[4:7], v[60:67], v74
  ds_read_b128 v[8:11], v76 offset:9728
  s_waitcnt lgkmcnt(0)
  v_smfmac_f32_16x16x64_bf16 v[20:23], v[8:11], v[160:167], v74
  v_smfmac_f32_16x16x64_bf16 v[24:27], v[8:11], v[168:175], v74
  ds_read_b128 v[60:63], v75 offset:28672
  ds_read_b128 v[64:67], v75 offset:29696
  s_waitcnt lgkmcnt(0)
  v_smfmac_f32_16x16x64_bf16 v[28:31], v[8:11], v[60:67], v74
  ds_read_b128 v[60:63], v75 offset:30720
  ds_read_b128 v[64:67], v75 offset:31744
  s_waitcnt lgkmcnt(0)
  v_smfmac_f32_16x16x64_bf16 v[32:35], v[8:11], v[60:67], v74
  ds_read_b128 v[16:19], v76 offset:10752
  ds_read_b128 v[60:63], v75 offset:12288
  ds_read_b128 v[64:67], v75 offset:13312
  s_waitcnt lgkmcnt(0)
  v_smfmac_f32_16x16x64_bf16 v[20:23], v[16:19], v[60:67], v74
  ds_read_b128 v[60:63], v75 offset:14336
  ds_read_b128 v[64:67], v75 offset:15360
  s_waitcnt lgkmcnt(0)
  v_smfmac_f32_16x16x64_bf16 v[24:27], v[16:19], v[60:67], v74
  v_smfmac_f32_16x16x64_bf16 v[28:31], v[16:19], v[240:247], v74
  v_smfmac_f32_16x16x64_bf16 v[32:35], v[16:19], v[248:255], v74
  ds_read_b128 v[0:3], v76 offset:11776
  s_waitcnt lgkmcnt(0)
  v_smfmac_f32_16x16x64_bf16 v[20:23], v[0:3], v[176:183], v74
  v_smfmac_f32_16x16x64_bf16 v[24:27], v[0:3], v[184:191], v74
  v_smfmac_f32_16x16x64_bf16 v[28:31], v[0:3], a[0:7], v74
  v_smfmac_f32_16x16x64_bf16 v[32:35], v[0:3], a[8:15], v74
  ds_read_b128 v[12:15], v76 offset:12800
  s_waitcnt lgkmcnt(0)
  v_smfmac_f32_16x16x64_bf16 v[20:23], v[12:15], v[192:199], v74
  v_smfmac_f32_16x16x64_bf16 v[24:27], v[12:15], v[200:207], v74
  v_smfmac_f32_16x16x64_bf16 v[28:31], v[12:15], a[16:23], v74
  v_smfmac_f32_16x16x64_bf16 v[32:35], v[12:15], a[24:31], v74
  v_add_f32 v20, v20, v22
  v_add_f32 v21, v21, v23
  v_add_f32 v24, v24, v26
  v_cvt_pk_bf16_f32 v22, v20, v24
  ds_write_b32 v79, v22 offset:0
  v_add_f32 v25, v25, v27
  v_cvt_pk_bf16_f32 v23, v21, v25
  ds_write_b32 v79, v23 offset:576
  v_add_f32 v28, v28, v30
  v_add_f32 v29, v29, v31
  s_waitcnt lgkmcnt(0)
  s_nop 1
  s_branch Cs3_recok
Cs3_mx:
  s_waitcnt lgkmcnt(0)
  s_barrier
  buffer_load_dwordx4 v[52:55], v76, s[8:11], s59 offen offset:0 sc1
  buffer_load_dwordx4 v[0:3], v76, s[8:11], s58 offen offset:0 sc1
  ds_read_b128 v[20:23], v77 offset:0
  ds_read_b128 v[28:31], v77 offset:256
  buffer_load_dwordx4 v[56:59], v76, s[8:11], s59 offen offset:1024 sc1
  buffer_load_dwordx4 v[4:7], v76, s[8:11], s58 offen offset:1024 sc1
  ds_read_b128 v[24:27], v77 offset:128
  ds_read_b128 v[32:35], v77 offset:384
  s_waitcnt vmcnt(2) lgkmcnt(3)
  v_mfma_f32_16x16x32_bf16 v[8:11], v[0:3], v[20:23], 0
  s_waitcnt vmcnt(0) lgkmcnt(1)
  v_mfma_f32_16x16x32_bf16 v[8:11], v[4:7], v[24:27], v[8:11]
  v_mfma_f32_16x16x32_bf16 v[12:15], v[28:31], v[20:23], 0
  s_waitcnt lgkmcnt(0)
  v_mfma_f32_16x16x32_bf16 v[12:15], v[32:35], v[24:27], v[12:15]
  v_add_f32_dpp v8, v10, v8 quad_perm:[2,3,0,1] row_mask:0xf bank_mask:0xf
  v_add_f32_dpp v9, v11, v9 quad_perm:[2,3,0,1] row_mask:0xf bank_mask:0xf
  s_nop 0
  v_mov_b32_dpp v8, v8 quad_perm:[0,1,0,1] row_mask:0xf bank_mask:0xf
  v_mov_b32_dpp v9, v9 quad_perm:[0,1,0,1] row_mask:0xf bank_mask:0xf
  s_nop 1
  v_add_f32_dpp v12, v14, v12 quad_perm:[2,3,0,1] row_mask:0xf bank_mask:0xf
  v_add_f32_dpp v13, v15, v13 quad_perm:[2,3,0,1] row_mask:0xf bank_mask:0xf
  s_nop 0
  v_mov_b32_dpp v12, v12 quad_perm:[0,1,0,1] row_mask:0xf bank_mask:0xf
  v_mov_b32_dpp v13, v13 quad_perm:[0,1,0,1] row_mask:0xf bank_mask:0xf
  v_mul_f32 v12, s69, v12
  ds_write_b32 v78, v8 offset:8716
  v_mul_f32 v13, s69, v13
  ds_write_b32 v78, v9 offset:8780
  s_waitcnt lgkmcnt(0)
  s_barrier
  ds_read_b128 v[36:39], v78 offset:8704
  ds_read_b128 v[40:43], v78 offset:8768
  s_waitcnt lgkmcnt(0)
  s_barrier
  v_max_f32 v16, v36, v37
  v_max3_f32 v16, v16, v38, v39
  v_max3_f32 v16, v16, v40, v41
  v_max3_f32 v16, v16, v42, v43
  v_max3_f32 v16, v16, v12, v13
  v_mov_b32 v17, v16
  s_nop 1
  v_permlane16_swap_b32 v16, v17
  v_max_f32 v16, v16, v17
  v_mov_b32 v17, v16
  s_nop 1
  v_permlane32_swap_b32 v16, v17
  v_max_f32 v16, v16, v17
  v_sub_f32 v36, v36, v16
  v_sub_f32 v37, v37, v16
  v_sub_f32 v38, v38, v16
  v_sub_f32 v39, v39, v16
  v_sub_f32 v40, v40, v16
  v_sub_f32 v41, v41, v16
  v_sub_f32 v42, v42, v16
  v_sub_f32 v43, v43, v16
  v_sub_f32 v12, v12, v16
  v_sub_f32 v13, v13, v16
  v_exp_f32 v36, v36
  v_exp_f32 v37, v37
  v_exp_f32 v38, v38
  v_exp_f32 v39, v39
  v_exp_f32 v40, v40
  v_exp_f32 v41, v41
  v_exp_f32 v42, v42
  v_exp_f32 v43, v43
  v_exp_f32 v12, v12
  v_exp_f32 v13, v13
  v_cvt_pk_bf16_f32 v32, v36, v40
  v_cvt_pk_bf16_f32 v33, v37, v41
  v_cvt_pk_bf16_f32 v34, v38, v42
  v_cvt_pk_bf16_f32 v35, v39, v43
  v_cvt_pk_bf16_f32 v28, v12, v13
  v_cvt_pk_bf16_f32 v31, v12, v13
  v_mov_b32 v29, 0
  v_mov_b32 v30, 0
  v_mfma_f32_16x16x32_bf16 v[8:11], v[32:35], v[68:71], 0
  v_mfma_f32_16x16x32_bf16 v[0:3], v[32:35], v[52:55], 0
  v_mfma_f32_16x16x32_bf16 v[4:7], v[32:35], v[56:59], 0
  v_mfma_f32_16x16x16_bf16 v[8:11], v[28:29], v[68:69], v[8:11]
  v_mfma_f32_16x16x16_bf16 v[0:3], v[28:29], v[72:73], v[0:3]
  v_mfma_f32_16x16x16_bf16 v[4:7], v[30:31], v[72:73], v[4:7]
  ds_read_b128 v[52:55], v75 offset:30720
  v_rcp_f32 v10, v8
  v_rcp_f32 v11, v9
  v_mul_f32 v0, v10, v0
  v_mul_f32 v1, v11, v1
  v_max3_f32 v8, v8, v9, v10
  v_mul_f32 v4, v10, v4
  v_mul_f32 v5, v11, v5
  v_cvt_pk_bf16_f32 v2, v0, v4
  ds_write_b32 v79, v2 offset:8704
  v_cvt_pk_bf16_f32 v3, v1, v5
  ds_write_b32 v79, v3 offset:9280
  ds_read_b128 v[12:15], v78 offset:8896
  ds_read_b128 v[56:59], v75 offset:31744
  v_mov_b64 v[16:17], 0
  v_mov_b64 v[18:19], 0
  v_mov_b64 v[20:21], 0
  v_mov_b64 v[22:23], 0
  v_mov_b64 v[24:25], 0
  v_mov_b64 v[26:27], 0
  s_branch Cs3_mxok
Cs3_last:
  ds_read_b128 v[0:3], v76 offset:4608
  ds_read_b128 v[12:15], v76 offset:7680
  ds_read_b128 v[44:47], v76 offset:28672
  ds_read_b128 v[48:51], v76 offset:29696
  s_nop 5
  v_mov_b64 v[20:21], 0
  v_mov_b64 v[22:23], 0
  v_mov_b64 v[24:25], 0
  v_mov_b64 v[26:27], 0
  v_smfmac_f32_16x16x64_bf16 v[28:31], v[4:7], v[36:43], v74
  ds_read_b128 v[36:39], v76 offset:30720
  ds_read_b128 v[40:43], v76 offset:31744
  v_smfmac_f32_16x16x64_bf16 v[32:35], v[4:7], v[60:67], v74
  s_waitcnt lgkmcnt(5)
  v_smfmac_f32_16x16x64_bf16 v[20:23], v[0:3], a[32:39], v74
  ds_read_b128 v[60:63], v76 offset:61440
  ds_read_b128 v[64:67], v76 offset:62464
  v_smfmac_f32_16x16x64_bf16 v[24:27], v[0:3], a[40:47], v74
  s_waitcnt lgkmcnt(4)
  v_smfmac_f32_16x16x64_bf16 v[20:23], v[4:7], a[48:55], v74
  buffer_store_dwordx4 v[16:19], v76, s[8:11], s68 offen sc1
  v_smfmac_f32_16x16x64_bf16 v[24:27], v[4:7], a[56:63], v74
  v_smfmac_f32_16x16x64_bf16 v[28:31], v[0:3], v[44:51], v74
  s_waitcnt lgkmcnt(2)
  v_smfmac_f32_16x16x64_bf16 v[20:23], v[8:11], a[64:71], v74
  ds_read_b128 v[44:47], v76 offset:63488
  ds_read_b128 v[48:51], v76 offset:64512
  v_smfmac_f32_16x16x64_bf16 v[24:27], v[8:11], a[72:79], v74
  v_smfmac_f32_16x16x64_bf16 v[32:35], v[0:3], v[36:43], v74
  v_smfmac_f32_16x16x64_bf16 v[28:31], v[8:11], v[208:215], v74
  ds_read_b128 v[36:39], v75 offset:28672
  ds_read_b128 v[40:43], v75 offset:29696
  v_smfmac_f32_16x16x64_bf16 v[32:35], v[8:11], v[216:223], v74
  v_smfmac_f32_16x16x64_bf16 v[20:23], v[12:15], a[80:87], v74
  v_smfmac_f32_16x16x64_bf16 v[24:27], v[12:15], a[88:95], v74
  v_smfmac_f32_16x16x64_bf16 v[28:31], v[12:15], v[224:231], v74
  v_smfmac_f32_16x16x64_bf16 v[32:35], v[12:15], v[232:239], v74
  s_waitcnt vmcnt(1)
  s_barrier
Cs3_lastr:
  ds_read_b128 v[4:7], v76 offset:8704
  ds_read_b128 v[8:11], v76 offset:9728
  ds_read_b128 v[16:19], v76 offset:10752
  ds_read_b128 v[0:3], v76 offset:11776
  ds_read_b128 v[12:15], v76 offset:12800
  s_waitcnt lgkmcnt(1)
  v_max3_u32 v72, v0, v1, v2
  v_max3_u32 v72, v72, v3, v4
  v_max3_u32 v72, v72, v5, v6
  v_max3_u32 v72, v72, v7, v8
  v_max3_u32 v72, v72, v9, v10
  s_waitcnt lgkmcnt(0)
  v_max3_u32 v72, v72, v11, v12
  v_max3_u32 v72, v72, v13, v14
  v_max3_u32 v72, v72, v15, v16
  v_max3_u32 v72, v72, v17, v18
  v_max_u32 v72, v72, v19
  v_cmp_eq_u32 vcc, -1, v72
  s_cbranch_vccnz Cs3_lastp
Cs3_lastg:
  v_smfmac_f32_16x16x64_bf16 v[28:31], v[4:7], v[60:67], v74
  ds_read_b128 v[60:63], v75 offset:30720
  ds_read_b128 v[64:67], v75 offset:31744
  v_smfmac_f32_16x16x64_bf16 v[32:35], v[4:7], v[44:51], v74
  v_smfmac_f32_16x16x64_bf16 v[28:31], v[8:11], v[36:43], v74
  v_smfmac_f32_16x16x64_bf16 v[28:31], v[16:19], v[240:247], v74
  v_smfmac_f32_16x16x64_bf16 v[28:31], v[0:3], a[0:7], v74
  v_smfmac_f32_16x16x64_bf16 v[28:31], v[12:15], a[16:23], v74
  v_smfmac_f32_16x16x64_bf16 v[32:35], v[16:19], v[248:255], v74
  v_smfmac_f32_16x16x64_bf16 v[32:35], v[0:3], a[8:15], v74
  s_waitcnt lgkmcnt(0)
  v_smfmac_f32_16x16x64_bf16 v[32:35], v[12:15], a[24:31], v74
  v_smfmac_f32_16x16x64_bf16 v[32:35], v[8:11], v[60:67], v74
  v_smfmac_f32_16x16x64_bf16 v[20:23], v[4:7], a[96:103], v74
  v_smfmac_f32_16x16x64_bf16 v[20:23], v[8:11], a[112:119], v74
  v_add_f32 v28, v28, v30
  v_add_f32 v32, v32, v34
  v_cvt_pk_bf16_f32 v30, v28, v32
  v_smfmac_f32_16x16x64_bf16 v[20:23], v[16:19], a[128:135], v74
  ds_write_b32 v79, v30 offset:256
  v_add_f32 v29, v29, v31
  v_add_f32 v33, v33, v35
  v_cvt_pk_bf16_f32 v31, v29, v33
  v_smfmac_f32_16x16x64_bf16 v[20:23], v[0:3], a[144:151], v74
  ds_write_b32 v79, v31 offset:832
  v_smfmac_f32_16x16x64_bf16 v[20:23], v[12:15], a[160:167], v74
  v_smfmac_f32_16x16x64_bf16 v[24:27], v[4:7], a[104:111], v74
  v_smfmac_f32_16x16x64_bf16 v[24:27], v[8:11], a[120:127], v74
  v_smfmac_f32_16x16x64_bf16 v[24:27], v[16:19], a[136:143], v74
  s_waitcnt lgkmcnt(0)
  s_barrier
  ds_read_b64 v[52:53], v77 offset:392
  v_add_f32 v20, v20, v22
  v_smfmac_f32_16x16x64_bf16 v[24:27], v[0:3], a[152:159], v74
  v_add_f32 v21, v21, v23
  v_smfmac_f32_16x16x64_bf16 v[24:27], v[12:15], a[168:175], v74
  v_cvt_pk_bf16_f32 v54, v20, v21
  s_add_u32 s68, s68, 655360
  s_nop 3
  v_add_f32 v24, v24, v26
  v_add_f32 v25, v25, v27
  v_cvt_pk_bf16_f32 v55, v24, v25
  s_waitcnt lgkmcnt(0)
  buffer_store_dwordx4 v[52:55], v76, s[8:11], s68 offen sc1
  s_branch Cs3_done
Cs3_lastp:
  s_add_u32 s72, s72, 2
  s_cmp_ge_u32 s72, 131072
  s_cbranch_scc1 Cs3_lastg
  s_barrier
  buffer_load_dwordx4 v76, s[8:11], s85 offen offset:0 sc1 lds
  buffer_load_dwordx4 v76, s[8:11], s85 offen offset:1024 sc1 lds
  s_waitcnt vmcnt(0)
  s_barrier
  s_branch Cs3_lastr
Cs3_done:
  s_branch L_cexit
L_conf:
  s_nop 11
  s_waitcnt vmcnt(0) lgkmcnt(0)
  s_barrier
  s_cmp_eq_u32 s52, 0
  s_cbranch_scc0 L_cf2
  s_mov_b64 exec, 1
  s_lshl_b32 s57, s2, 2
  v_mov_b32 v1, 0
L_cf0:
  s_cmp_eq_u32 s54, -1
  s_cbranch_scc1 L_cf1
  s_mov_b32 s55, s54
  s_lshr_b64 s[54:55], s[54:55], s0
  s_ff0_i32_b32 s56, s54
  s_add_u32 s0, s0, s56
  s_and_b32 s0, s0, 31
  s_lshl_b32 s56, 1, s0
  v_mov_b32 v35, s56
  buffer_atomic_or v35, v1, s[12:15], s57 offen sc0
  s_waitcnt vmcnt(0)
  v_readfirstlane_b32 s54, v35
  s_nop 0
  s_bitcmp1_b32 s54, s0
  s_cbranch_scc1 L_cf0
  v_mov_b32 v35, s0
  s_branch L_cf3
L_cf1:
  v_mov_b32 v35, 1
  buffer_atomic_add v35, v1, s[12:15], 0 offen offset:40 sc0
  s_waitcnt vmcnt(0)
  v_add_u32 v35, 32, v35
L_cf3:
  ds_write_b32 v33, v35
  s_mov_b64 exec, -1
  s_waitcnt lgkmcnt(0)
L_cf2:
  s_barrier
  ds_read_b32 v32, v33
  s_waitcnt lgkmcnt(0)
  v_readfirstlane_b32 s0, v32
  v_mbcnt_lo_u32_b32 v0, -1, 0
  v_mbcnt_hi_u32_b32 v0, -1, v0
  s_mov_b32 s1, 1
  s_cmp_lt_u32 s0, 32
  s_cbranch_scc1 L_role
  s_sub_u32 s53, s0, 32
  s_mov_b32 s57, 0
L_sur:
  s_load_dwordx16 s[60:75], s[12:13], 0 glc
  s_add_u32 s57, s57, 1
  s_waitcnt lgkmcnt(0)
  s_mov_b32 s55, s70
  s_bcnt1_i32_b32 s56, s60
  s_add_u32 s55, s55, s56
  s_bcnt1_i32_b32 s56, s61
  s_add_u32 s55, s55, s56
  s_bcnt1_i32_b32 s56, s62
  s_add_u32 s55, s55, s56
  s_bcnt1_i32_b32 s56, s63
  s_add_u32 s55, s55, s56
  s_bcnt1_i32_b32 s56, s64
  s_add_u32 s55, s55, s56
  s_bcnt1_i32_b32 s56, s65
  s_add_u32 s55, s55, s56
  s_bcnt1_i32_b32 s56, s66
  s_add_u32 s55, s55, s56
  s_bcnt1_i32_b32 s56, s67
  s_add_u32 s55, s55, s56
  s_cmp_ge_u32 s57, 131072
  s_cbranch_scc1 L_end
  s_cmp_lt_u32 s55, 256
  s_cbranch_scc1 L_sur
  s_mov_b32 s2, 0
  s_mov_b32 s54, s60
  s_bcnt0_i32_b32 s56, s54
  s_cmp_lt_u32 s53, s56
  s_cbranch_scc1 L_sur2
  s_sub_u32 s53, s53, s56
  s_mov_b32 s2, 1
  s_mov_b32 s54, s61
  s_bcnt0_i32_b32 s56, s54
  s_cmp_lt_u32 s53, s56
  s_cbranch_scc1 L_sur2
  s_sub_u32 s53, s53, s56
  s_mov_b32 s2, 2
  s_mov_b32 s54, s62
  s_bcnt0_i32_b32 s56, s54
  s_cmp_lt_u32 s53, s56
  s_cbranch_scc1 L_sur2
  s_sub_u32 s53, s53, s56
  s_mov_b32 s2, 3
  s_mov_b32 s54, s63
  s_bcnt0_i32_b32 s56, s54
  s_cmp_lt_u32 s53, s56
  s_cbranch_scc1 L_sur2
  s_sub_u32 s53, s53, s56
  s_mov_b32 s2, 4
  s_mov_b32 s54, s64
  s_bcnt0_i32_b32 s56, s54
  s_cmp_lt_u32 s53, s56
  s_cbranch_scc1 L_sur2
  s_sub_u32 s53, s53, s56
  s_mov_b32 s2, 5
  s_mov_b32 s54, s65
  s_bcnt0_i32_b32 s56, s54
  s_cmp_lt_u32 s53, s56
  s_cbranch_scc1 L_sur2
  s_sub_u32 s53, s53, s56
  s_mov_b32 s2, 6
  s_mov_b32 s54, s66
  s_bcnt0_i32_b32 s56, s54
  s_cmp_lt_u32 s53, s56
  s_cbranch_scc1 L_sur2
  s_sub_u32 s53, s53, s56
  s_mov_b32 s2, 7
  s_mov_b32 s54, s67
  s_bcnt0_i32_b32 s56, s54
  s_cmp_lt_u32 s53, s56
  s_cbranch_scc1 L_sur2
  s_sub_u32 s53, s53, s56
  s_branch L_end
L_sur2:
  s_ff0_i32_b32 s0, s54
  s_bitset1_b32 s54, s0
  s_sub_u32 s53, s53, 1
  s_cbranch_scc0 L_sur2
  s_branch L_role
L_worker:
  s_lshl_b32 s54, s2, 2
  s_lshr_b32 s54, 1412567136, s54
  s_and_b32 s54, s54, 7
  s_lshl_b32 s54, s54, 5
  s_add_u32 s53, s53, s54
  s_getpc_b64 s[80:81]
L_pc_2:
  s_and_b32 s55, s0, 1
  s_lshl_b32 s55, s55, 2
  s_add_u32 s55, s55, s52
  s_lshl_b32 s55, s55, 13
  v_and_b32 v199, 63, v0
  v_lshl_add_u32 v199, v199, 7, s55
  s_sub_u32 s82, s80, (L_pc_2 - L_w0)
  s_subb_u32 s83, s81, 0
  v_min_u32 v198, (L_w4 - L_w0), v199
  global_load_dword v196, v198, s[82:83]
  v_min_u32 v199, (L_end - L_pc_2), v199
  global_load_dword v196, v199, s[80:81]
  v_and_b32 v200, 63, v0
  v_lshlrev_b32 v201, 4, v200
  v_lshrrev_b32 v211, 3, v200
  s_lshl_b32 s54, s52, 3
  v_add_u32 v211, s54, v211
  v_bfe_u32 v212, v211, 1, 3
  v_and_b32 v213, 7, v200
  v_xor_b32 v212, v212, v213
  v_mul_u32_u24 v211, 1152, v211
  v_lshl_add_u32 v202, v212, 4, v211
  s_mul_i32 s67, s52, 9216
  v_and_b32 v211, 31, v200
  v_lshrrev_b32 v212, 3, v211
  v_mul_u32_u24 v212, 9216, v212
  v_and_b32 v213, 7, v211
  v_lshl_add_u32 v212, v213, 7, v212
  v_bfe_u32 v213, v211, 1, 3
  v_lshrrev_b32 v214, 5, v200
  v_xor_b32 v213, v213, v214
  v_lshl_add_u32 v203, v213, 4, v212
  v_xor_b32 v204, 32, v203
  v_xor_b32 v205, 64, v203
  v_xor_b32 v206, 0x60, v203
  v_bfe_u32 v211, v200, 2, 2
  v_lshl_add_u32 v212, v214, 3, v211
  v_lshlrev_b32 v212, 8, v212
  v_xor_b32 v211, s52, v211
  v_lshl_add_u32 v212, v211, 6, v212
  v_bfe_u32 v213, v200, 4, 1
  v_and_b32 v211, 3, v200
  v_lshl_add_u32 v210, v213, 5, v212
  v_lshl_add_u32 v210, v211, 3, v210
  v_lshl_add_u32 v209, v213, 4, v212
  v_and_b32 v213, 1, v211
  v_lshl_add_u32 v209, v213, 3, v209
  v_lshrrev_b32 v213, 1, v211
  v_lshl_add_u32 v209, v213, 5, v209
  s_mov_b32 s65, 0
  s_mul_i32 s58, s53, 9363
  s_lshr_b32 s58, s58, 16
  s_mul_i32 s54, s58, 7
  s_sub_u32 s59, s53, s54
  s_mul_i32 s60, s59, 36864
  s_add_u32 m0, s67, 0
  s_nop 0
  buffer_load_dwordx4 v202, s[4:7], s60 offen offset:0 lds
  s_add_u32 m0, s67, 896
  s_nop 0
  buffer_load_dwordx4 v202, s[4:7], s60 offen offset:128 lds
  s_add_u32 m0, s67, 1792
  s_nop 0
  buffer_load_dwordx4 v202, s[4:7], s60 offen offset:256 lds
  s_add_u32 m0, s67, 2688
  s_nop 0
  buffer_load_dwordx4 v202, s[4:7], s60 offen offset:384 lds
  s_add_u32 m0, s67, 3584
  s_nop 0
  buffer_load_dwordx4 v202, s[4:7], s60 offen offset:512 lds
  s_add_u32 m0, s67, 4480
  s_nop 0
  buffer_load_dwordx4 v202, s[4:7], s60 offen offset:640 lds
  s_add_u32 m0, s67, 5376
  s_nop 0
  buffer_load_dwordx4 v202, s[4:7], s60 offen offset:768 lds
  s_add_u32 m0, s67, 6272
  s_nop 0
  buffer_load_dwordx4 v202, s[4:7], s60 offen offset:896 lds
  s_add_u32 m0, s67, 7168
  s_nop 0
  buffer_load_dwordx4 v202, s[4:7], s60 offen offset:1024 lds
  v_lshrrev_b32 v211, 4, v200
  v_lshlrev_b32 v212, 2, v211
  v_and_b32 v213, 15, v200
  v_xor_b32 v212, v212, v213
  v_lshlrev_b32 v212, 4, v212
  v_lshl_add_u32 v207, v211, 13, v212
  s_lshl_b32 s62, s58, 8
  s_lshl_b32 s54, s52, 15
  s_add_u32 s62, s62, s54
  s_lshl_b32 s61, s52, 10
  s_add_u32 s61, s61, 36864
  s_add_u32 m0, s61, 0
  s_add_u32 s54, s62, 0
  buffer_load_dwordx4 v207, s[20:23], s54 offen lds
  s_add_u32 m0, s61, 4096
  s_add_u32 s54, s62, 131072
  buffer_load_dwordx4 v207, s[20:23], s54 offen lds
  s_add_u32 m0, s61, 8192
  s_add_u32 s54, s62, 262144
  buffer_load_dwordx4 v207, s[20:23], s54 offen lds
  s_add_u32 m0, s61, 12288
  s_add_u32 s54, s62, 393216
  buffer_load_dwordx4 v207, s[20:23], s54 offen lds
  s_add_u32 m0, s61, 16384
  s_add_u32 s54, s62, 0
  buffer_load_dwordx4 v207, s[24:27], s54 offen lds
  s_add_u32 m0, s61, 20480
  s_add_u32 s54, s62, 131072
  buffer_load_dwordx4 v207, s[24:27], s54 offen lds
  s_add_u32 m0, s61, 24576
  s_add_u32 s54, s62, 262144
  buffer_load_dwordx4 v207, s[24:27], s54 offen lds
  s_add_u32 m0, s61, 28672
  s_add_u32 s54, s62, 393216
  buffer_load_dwordx4 v207, s[24:27], s54 offen lds
  s_add_u32 m0, s61, 32768
  s_add_u32 s54, s62, 524288
  buffer_load_dwordx4 v207, s[20:23], s54 offen lds
  s_add_u32 m0, s61, 36864
  s_add_u32 s54, s62, 655360
  buffer_load_dwordx4 v207, s[20:23], s54 offen lds
  s_add_u32 m0, s61, 40960
  s_add_u32 s54, s62, 786432
  buffer_load_dwordx4 v207, s[20:23], s54 offen lds
  s_add_u32 m0, s61, 45056
  s_add_u32 s54, s62, 917504
  buffer_load_dwordx4 v207, s[20:23], s54 offen lds
  s_add_u32 m0, s61, 49152
  s_add_u32 s54, s62, 524288
  buffer_load_dwordx4 v207, s[24:27], s54 offen lds
  s_add_u32 m0, s61, 53248
  s_add_u32 s54, s62, 655360
  buffer_load_dwordx4 v207, s[24:27], s54 offen lds
  s_add_u32 m0, s61, 57344
  s_add_u32 s54, s62, 786432
  buffer_load_dwordx4 v207, s[24:27], s54 offen lds
  s_add_u32 m0, s61, 61440
  s_add_u32 s54, s62, 917504
  buffer_load_dwordx4 v207, s[24:27], s54 offen lds
  s_add_u32 m0, s61, 65536
  s_add_u32 s54, s62, 1048576
  buffer_load_dwordx4 v207, s[20:23], s54 offen lds
  s_add_u32 m0, s61, 69632
  s_add_u32 s54, s62, 1179648
  buffer_load_dwordx4 v207, s[20:23], s54 offen lds
  s_add_u32 m0, s61, 73728
  s_add_u32 s54, s62, 1310720
  buffer_load_dwordx4 v207, s[20:23], s54 offen lds
  s_add_u32 m0, s61, 77824
  s_add_u32 s54, s62, 1441792
  buffer_load_dwordx4 v207, s[20:23], s54 offen lds
  s_add_u32 m0, s61, 81920
  s_add_u32 s54, s62, 1048576
  buffer_load_dwordx4 v207, s[24:27], s54 offen lds
  s_add_u32 m0, s61, 86016
  s_add_u32 s54, s62, 1179648
  buffer_load_dwordx4 v207, s[24:27], s54 offen lds
  s_add_u32 m0, s61, 90112
  s_add_u32 s54, s62, 1310720
  buffer_load_dwordx4 v207, s[24:27], s54 offen lds
  s_add_u32 m0, s61, 94208
  s_add_u32 s54, s62, 1441792
  buffer_load_dwordx4 v207, s[24:27], s54 offen lds
  v_bfe_u32 v211, v200, 3, 2
  v_lshlrev_b32 v216, 11, v211
  v_bfe_u32 v211, v200, 1, 2
  v_lshl_add_u32 v216, v211, 6, v216
  v_lshrrev_b32 v212, 5, v200
  v_lshl_add_u32 v216, v212, 5, v216
  v_and_b32 v211, 1, v200
  v_lshl_add_u32 v216, v211, 4, v216
  v_bfe_u32 v211, v200, 4, 1
  v_lshlrev_b32 v217, 10, v211
  v_lshl_add_u32 v217, v212, 9, v217
  v_and_b32 v211, 15, v200
  v_lshl_add_u32 v217, v211, 4, v217
  s_lshl_b32 s54, s52, 11
  s_add_u32 s54, s54, 8192
  v_add_u32 v217, s54, v217
  s_waitcnt vmcnt(20) lgkmcnt(0)
  s_barrier
  s_add_u32 m0, s61, 98304
  s_add_u32 s54, s62, 1572864
  buffer_load_dwordx4 v207, s[20:23], s54 offen lds
  s_add_u32 m0, s61, 102400
  s_add_u32 s54, s62, 1703936
  buffer_load_dwordx4 v207, s[20:23], s54 offen lds
  s_add_u32 m0, s61, 106496
  s_add_u32 s54, s62, 1835008
  buffer_load_dwordx4 v207, s[20:23], s54 offen lds
  s_add_u32 m0, s61, 110592
  s_add_u32 s54, s62, 1966080
  buffer_load_dwordx4 v207, s[20:23], s54 offen lds
  v_add_u32 v215, 36864, v209
  ds_read_b64_tr_b16 a[0:1], v215 offset:0
  ds_read_b64_tr_b16 a[2:3], v215 offset:1024
  ds_read_b64_tr_b16 a[4:5], v215 offset:4096
  ds_read_b64_tr_b16 a[6:7], v215 offset:5120
  ds_read_b64_tr_b16 a[8:9], v215 offset:8192
  ds_read_b64_tr_b16 a[10:11], v215 offset:9216
  ds_read_b64_tr_b16 a[12:13], v215 offset:12288
  ds_read_b64_tr_b16 a[14:15], v215 offset:13312
  s_waitcnt vmcnt(20) lgkmcnt(0)
  s_barrier
  s_add_u32 m0, s61, 0
  s_add_u32 s54, s62, 1572864
  buffer_load_dwordx4 v207, s[24:27], s54 offen lds
  s_add_u32 m0, s61, 4096
  s_add_u32 s54, s62, 1703936
  buffer_load_dwordx4 v207, s[24:27], s54 offen lds
  s_add_u32 m0, s61, 8192
  s_add_u32 s54, s62, 1835008
  buffer_load_dwordx4 v207, s[24:27], s54 offen lds
  s_add_u32 m0, s61, 12288
  s_add_u32 s54, s62, 1966080
  buffer_load_dwordx4 v207, s[24:27], s54 offen lds
  v_add_u32 v215, 53248, v210
  ds_read_b64_tr_b16 a[144:145], v215 offset:0
  ds_read_b64_tr_b16 a[146:147], v215 offset:1024
  ds_read_b64_tr_b16 a[148:149], v215 offset:4096
  ds_read_b64_tr_b16 a[150:151], v215 offset:5120
  ds_read_b64_tr_b16 a[152:153], v215 offset:8192
  ds_read_b64_tr_b16 a[154:155], v215 offset:9216
  ds_read_b64_tr_b16 a[156:157], v215 offset:12288
  ds_read_b64_tr_b16 a[158:159], v215 offset:13312
  s_waitcnt vmcnt(20) lgkmcnt(0)
  s_barrier
  s_add_u32 m0, s61, 16384
  s_add_u32 s54, s62, 2097152
  buffer_load_dwordx4 v207, s[20:23], s54 offen lds
  s_add_u32 m0, s61, 20480
  s_add_u32 s54, s62, 2228224
  buffer_load_dwordx4 v207, s[20:23], s54 offen lds
  s_add_u32 m0, s61, 24576
  s_add_u32 s54, s62, 2359296
  buffer_load_dwordx4 v207, s[20:23], s54 offen lds
  s_add_u32 m0, s61, 28672
  s_add_u32 s54, s62, 2490368
  buffer_load_dwordx4 v207, s[20:23], s54 offen lds
  v_add_u32 v215, 69632, v209
  ds_read_b64_tr_b16 a[16:17], v215 offset:0
  ds_read_b64_tr_b16 a[18:19], v215 offset:1024
  ds_read_b64_tr_b16 a[20:21], v215 offset:4096
  ds_read_b64_tr_b16 a[22:23], v215 offset:5120
  ds_read_b64_tr_b16 a[24:25], v215 offset:8192
  ds_read_b64_tr_b16 a[26:27], v215 offset:9216
  ds_read_b64_tr_b16 a[28:29], v215 offset:12288
  ds_read_b64_tr_b16 a[30:31], v215 offset:13312
  s_waitcnt vmcnt(20) lgkmcnt(0)
  s_barrier
  s_add_u32 m0, s61, 32768
  s_add_u32 s54, s62, 2097152
  buffer_load_dwordx4 v207, s[24:27], s54 offen lds
  s_add_u32 m0, s61, 36864
  s_add_u32 s54, s62, 2228224
  buffer_load_dwordx4 v207, s[24:27], s54 offen lds
  s_add_u32 m0, s61, 40960
  s_add_u32 s54, s62, 2359296
  buffer_load_dwordx4 v207, s[24:27], s54 offen lds
  s_add_u32 m0, s61, 45056
  s_add_u32 s54, s62, 2490368
  buffer_load_dwordx4 v207, s[24:27], s54 offen lds
  v_add_u32 v215, 86016, v210
  ds_read_b64_tr_b16 a[160:161], v215 offset:0
  ds_read_b64_tr_b16 a[162:163], v215 offset:1024
  ds_read_b64_tr_b16 a[164:165], v215 offset:4096
  ds_read_b64_tr_b16 a[166:167], v215 offset:5120
  ds_read_b64_tr_b16 a[168:169], v215 offset:8192
  ds_read_b64_tr_b16 a[170:171], v215 offset:9216
  ds_read_b64_tr_b16 a[172:173], v215 offset:12288
  ds_read_b64_tr_b16 a[174:175], v215 offset:13312
  s_waitcnt vmcnt(20) lgkmcnt(0)
  s_barrier
  s_add_u32 m0, s61, 49152
  s_add_u32 s54, s62, 2621440
  buffer_load_dwordx4 v207, s[20:23], s54 offen lds
  s_add_u32 m0, s61, 53248
  s_add_u32 s54, s62, 2752512
  buffer_load_dwordx4 v207, s[20:23], s54 offen lds
  s_add_u32 m0, s61, 57344
  s_add_u32 s54, s62, 2883584
  buffer_load_dwordx4 v207, s[20:23], s54 offen lds
  s_add_u32 m0, s61, 61440
  s_add_u32 s54, s62, 3014656
  buffer_load_dwordx4 v207, s[20:23], s54 offen lds
  v_add_u32 v215, 102400, v209
  ds_read_b64_tr_b16 a[32:33], v215 offset:0
  ds_read_b64_tr_b16 a[34:35], v215 offset:1024
  ds_read_b64_tr_b16 a[36:37], v215 offset:4096
  ds_read_b64_tr_b16 a[38:39], v215 offset:5120
  ds_read_b64_tr_b16 a[40:41], v215 offset:8192
  ds_read_b64_tr_b16 a[42:43], v215 offset:9216
  ds_read_b64_tr_b16 a[44:45], v215 offset:12288
  ds_read_b64_tr_b16 a[46:47], v215 offset:13312
  s_waitcnt vmcnt(20) lgkmcnt(0)
  s_barrier
  s_add_u32 m0, s61, 65536
  s_add_u32 s54, s62, 2621440
  buffer_load_dwordx4 v207, s[24:27], s54 offen lds
  s_add_u32 m0, s61, 69632
  s_add_u32 s54, s62, 2752512
  buffer_load_dwordx4 v207, s[24:27], s54 offen lds
  s_add_u32 m0, s61, 73728
  s_add_u32 s54, s62, 2883584
  buffer_load_dwordx4 v207, s[24:27], s54 offen lds
  s_add_u32 m0, s61, 77824
  s_add_u32 s54, s62, 3014656
  buffer_load_dwordx4 v207, s[24:27], s54 offen lds
  v_add_u32 v215, 118784, v210
  ds_read_b64_tr_b16 a[176:177], v215 offset:0
  ds_read_b64_tr_b16 a[178:179], v215 offset:1024
  ds_read_b64_tr_b16 a[180:181], v215 offset:4096
  ds_read_b64_tr_b16 a[182:183], v215 offset:5120
  ds_read_b64_tr_b16 a[184:185], v215 offset:8192
  ds_read_b64_tr_b16 a[186:187], v215 offset:9216
  ds_read_b64_tr_b16 a[188:189], v215 offset:12288
  ds_read_b64_tr_b16 a[190:191], v215 offset:13312
  s_waitcnt vmcnt(20) lgkmcnt(0)
  s_barrier
  s_add_u32 m0, s61, 81920
  s_add_u32 s54, s62, 3145728
  buffer_load_dwordx4 v207, s[20:23], s54 offen lds
  s_add_u32 m0, s61, 86016
  s_add_u32 s54, s62, 3276800
  buffer_load_dwordx4 v207, s[20:23], s54 offen lds
  s_add_u32 m0, s61, 90112
  s_add_u32 s54, s62, 3407872
  buffer_load_dwordx4 v207, s[20:23], s54 offen lds
  s_add_u32 m0, s61, 94208
  s_add_u32 s54, s62, 3538944
  buffer_load_dwordx4 v207, s[20:23], s54 offen lds
  v_add_u32 v215, 135168, v209
  ds_read_b64_tr_b16 a[48:49], v215 offset:0
  ds_read_b64_tr_b16 a[50:51], v215 offset:1024
  ds_read_b64_tr_b16 a[52:53], v215 offset:4096
  ds_read_b64_tr_b16 a[54:55], v215 offset:5120
  ds_read_b64_tr_b16 a[56:57], v215 offset:8192
  ds_read_b64_tr_b16 a[58:59], v215 offset:9216
  ds_read_b64_tr_b16 a[60:61], v215 offset:12288
  ds_read_b64_tr_b16 a[62:63], v215 offset:13312
  s_waitcnt vmcnt(20) lgkmcnt(0)
  s_barrier
  s_add_u32 m0, s61, 98304
  s_add_u32 s54, s62, 3145728
  buffer_load_dwordx4 v207, s[24:27], s54 offen lds
  s_add_u32 m0, s61, 102400
  s_add_u32 s54, s62, 3276800
  buffer_load_dwordx4 v207, s[24:27], s54 offen lds
  s_add_u32 m0, s61, 106496
  s_add_u32 s54, s62, 3407872
  buffer_load_dwordx4 v207, s[24:27], s54 offen lds
  s_add_u32 m0, s61, 110592
  s_add_u32 s54, s62, 3538944
  buffer_load_dwordx4 v207, s[24:27], s54 offen lds
  v_add_u32 v215, 36864, v210
  ds_read_b64_tr_b16 a[192:193], v215 offset:0
  ds_read_b64_tr_b16 a[194:195], v215 offset:1024
  ds_read_b64_tr_b16 a[196:197], v215 offset:4096
  ds_read_b64_tr_b16 a[198:199], v215 offset:5120
  ds_read_b64_tr_b16 a[200:201], v215 offset:8192
  ds_read_b64_tr_b16 a[202:203], v215 offset:9216
  ds_read_b64_tr_b16 a[204:205], v215 offset:12288
  ds_read_b64_tr_b16 a[206:207], v215 offset:13312
  s_waitcnt vmcnt(20) lgkmcnt(0)
  s_barrier
  s_add_u32 m0, s61, 0
  s_add_u32 s54, s62, 3670016
  buffer_load_dwordx4 v207, s[20:23], s54 offen lds
  s_add_u32 m0, s61, 4096
  s_add_u32 s54, s62, 3801088
  buffer_load_dwordx4 v207, s[20:23], s54 offen lds
  s_add_u32 m0, s61, 8192
  s_add_u32 s54, s62, 3932160
  buffer_load_dwordx4 v207, s[20:23], s54 offen lds
  s_add_u32 m0, s61, 12288
  s_add_u32 s54, s62, 4063232
  buffer_load_dwordx4 v207, s[20:23], s54 offen lds
  v_add_u32 v215, 53248, v209
  ds_read_b64_tr_b16 a[64:65], v215 offset:0
  ds_read_b64_tr_b16 a[66:67], v215 offset:1024
  ds_read_b64_tr_b16 a[68:69], v215 offset:4096
  ds_read_b64_tr_b16 a[70:71], v215 offset:5120
  ds_read_b64_tr_b16 a[72:73], v215 offset:8192
  ds_read_b64_tr_b16 a[74:75], v215 offset:9216
  ds_read_b64_tr_b16 a[76:77], v215 offset:12288
  ds_read_b64_tr_b16 a[78:79], v215 offset:13312
  s_waitcnt vmcnt(20) lgkmcnt(0)
  s_barrier
  s_add_u32 m0, s61, 16384
  s_add_u32 s54, s62, 3670016
  buffer_load_dwordx4 v207, s[24:27], s54 offen lds
  s_add_u32 m0, s61, 20480
  s_add_u32 s54, s62, 3801088
  buffer_load_dwordx4 v207, s[24:27], s54 offen lds
  s_add_u32 m0, s61, 24576
  s_add_u32 s54, s62, 3932160
  buffer_load_dwordx4 v207, s[24:27], s54 offen lds
  s_add_u32 m0, s61, 28672
  s_add_u32 s54, s62, 4063232
  buffer_load_dwordx4 v207, s[24:27], s54 offen lds
  v_add_u32 v215, 69632, v210
  ds_read_b64_tr_b16 a[208:209], v215 offset:0
  ds_read_b64_tr_b16 a[210:211], v215 offset:1024
  ds_read_b64_tr_b16 a[212:213], v215 offset:4096
  ds_read_b64_tr_b16 a[214:215], v215 offset:5120
  ds_read_b64_tr_b16 a[216:217], v215 offset:8192
  ds_read_b64_tr_b16 a[218:219], v215 offset:9216
  ds_read_b64_tr_b16 a[220:221], v215 offset:12288
  ds_read_b64_tr_b16 a[222:223], v215 offset:13312
  s_waitcnt vmcnt(20) lgkmcnt(0)
  s_barrier
  s_add_u32 m0, s61, 32768
  s_add_u32 s54, s62, 4194304
  buffer_load_dwordx4 v207, s[20:23], s54 offen lds
  s_add_u32 m0, s61, 36864
  s_add_u32 s54, s62, 4325376
  buffer_load_dwordx4 v207, s[20:23], s54 offen lds
  s_add_u32 m0, s61, 40960
  s_add_u32 s54, s62, 4456448
  buffer_load_dwordx4 v207, s[20:23], s54 offen lds
  s_add_u32 m0, s61, 45056
  s_add_u32 s54, s62, 4587520
  buffer_load_dwordx4 v207, s[20:23], s54 offen lds
  v_add_u32 v215, 86016, v209
  ds_read_b64_tr_b16 a[80:81], v215 offset:0
  ds_read_b64_tr_b16 a[82:83], v215 offset:1024
  ds_read_b64_tr_b16 a[84:85], v215 offset:4096
  ds_read_b64_tr_b16 a[86:87], v215 offset:5120
  ds_read_b64_tr_b16 a[88:89], v215 offset:8192
  ds_read_b64_tr_b16 a[90:91], v215 offset:9216
  ds_read_b64_tr_b16 a[92:93], v215 offset:12288
  ds_read_b64_tr_b16 a[94:95], v215 offset:13312
  s_waitcnt vmcnt(20) lgkmcnt(0)
  s_barrier
  s_add_u32 m0, s61, 49152
  s_add_u32 s54, s62, 4194304
  buffer_load_dwordx4 v207, s[24:27], s54 offen lds
  s_add_u32 m0, s61, 53248
  s_add_u32 s54, s62, 4325376
  buffer_load_dwordx4 v207, s[24:27], s54 offen lds
  s_add_u32 m0, s61, 57344
  s_add_u32 s54, s62, 4456448
  buffer_load_dwordx4 v207, s[24:27], s54 offen lds
  s_add_u32 m0, s61, 61440
  s_add_u32 s54, s62, 4587520
  buffer_load_dwordx4 v207, s[24:27], s54 offen lds
  s_mul_i32 s54, s53, 21120
  s_lshl_b32 s55, s52, 13
  s_add_u32 s54, s54, s55
  s_cmp_eq_u32 s52, 3
  s_cselect_b32 s54, 0x10000000, s54
  v_lshlrev_b32 v211, 3, v201
  buffer_load_dword v196, v211, s[28:31], s54 offen
  v_add_u32 v215, 102400, v210
  ds_read_b64_tr_b16 a[224:225], v215 offset:0
  ds_read_b64_tr_b16 a[226:227], v215 offset:1024
  ds_read_b64_tr_b16 a[228:229], v215 offset:4096
  ds_read_b64_tr_b16 a[230:231], v215 offset:5120
  ds_read_b64_tr_b16 a[232:233], v215 offset:8192
  ds_read_b64_tr_b16 a[234:235], v215 offset:9216
  ds_read_b64_tr_b16 a[236:237], v215 offset:12288
  ds_read_b64_tr_b16 a[238:239], v215 offset:13312
  s_waitcnt vmcnt(21) lgkmcnt(0)
  s_barrier
  s_lshl_b32 s54, s53, 13
  s_lshr_b32 s55, s53, 6
  s_or_b32 s55, s55, s52
  s_cmp_eq_u32 s55, 0
  s_cselect_b32 s54, s54, 0x10000000
  v_lshlrev_b32 v211, 3, v201
  s_add_u32 s54, s54, 3145728
  buffer_load_dword v196, v211, s[16:19], s54 offen
  v_add_u32 v215, 118784, v209
  ds_read_b64_tr_b16 a[96:97], v215 offset:0
  ds_read_b64_tr_b16 a[98:99], v215 offset:1024
  ds_read_b64_tr_b16 a[100:101], v215 offset:4096
  ds_read_b64_tr_b16 a[102:103], v215 offset:5120
  ds_read_b64_tr_b16 a[104:105], v215 offset:8192
  ds_read_b64_tr_b16 a[106:107], v215 offset:9216
  ds_read_b64_tr_b16 a[108:109], v215 offset:12288
  ds_read_b64_tr_b16 a[110:111], v215 offset:13312
  s_waitcnt vmcnt(18) lgkmcnt(0)
  s_barrier
  s_lshl_b32 s55, s2, 2
  s_or_b32 s56, s52, s1
  s_cmp_eq_u32 s56, 0
  s_cselect_b32 s55, s55, 0x1000
  s_lshl_b32 s56, 1, s0
  v_mov_b32 v197, s56
  s_mov_b64 exec, 1
  buffer_atomic_or v197, off, s[12:15], s55 sc0
  s_mov_b64 exec, -1
  v_add_u32 v215, 135168, v210
  ds_read_b64_tr_b16 a[240:241], v215 offset:0
  ds_read_b64_tr_b16 a[242:243], v215 offset:1024
  ds_read_b64_tr_b16 a[244:245], v215 offset:4096
  ds_read_b64_tr_b16 a[246:247], v215 offset:5120
  ds_read_b64_tr_b16 a[248:249], v215 offset:8192
  ds_read_b64_tr_b16 a[250:251], v215 offset:9216
  ds_read_b64_tr_b16 a[252:253], v215 offset:12288
  ds_read_b64_tr_b16 a[254:255], v215 offset:13312
  s_waitcnt vmcnt(15) lgkmcnt(0)
  s_barrier
  v_add_u32 v215, 36864, v209
  ds_read_b64_tr_b16 a[112:113], v215 offset:0
  ds_read_b64_tr_b16 a[114:115], v215 offset:1024
  ds_read_b64_tr_b16 a[116:117], v215 offset:4096
  ds_read_b64_tr_b16 a[118:119], v215 offset:5120
  ds_read_b64_tr_b16 a[120:121], v215 offset:8192
  ds_read_b64_tr_b16 a[122:123], v215 offset:9216
  ds_read_b64_tr_b16 a[124:125], v215 offset:12288
  ds_read_b64_tr_b16 a[126:127], v215 offset:13312
  s_waitcnt vmcnt(11) lgkmcnt(0)
  s_barrier
  v_add_u32 v215, 53248, v210
  ds_read_b64_tr_b16 v[224:225], v215 offset:0
  ds_read_b64_tr_b16 v[226:227], v215 offset:1024
  ds_read_b64_tr_b16 v[228:229], v215 offset:4096
  ds_read_b64_tr_b16 v[230:231], v215 offset:5120
  ds_read_b64_tr_b16 v[232:233], v215 offset:8192
  ds_read_b64_tr_b16 v[234:235], v215 offset:9216
  ds_read_b64_tr_b16 v[236:237], v215 offset:12288
  ds_read_b64_tr_b16 v[238:239], v215 offset:13312
  s_waitcnt vmcnt(7) lgkmcnt(0)
  s_barrier
  v_add_u32 v215, 69632, v209
  ds_read_b64_tr_b16 a[128:129], v215 offset:0
  ds_read_b64_tr_b16 a[130:131], v215 offset:1024
  ds_read_b64_tr_b16 a[132:133], v215 offset:4096
  ds_read_b64_tr_b16 a[134:135], v215 offset:5120
  ds_read_b64_tr_b16 a[136:137], v215 offset:8192
  ds_read_b64_tr_b16 a[138:139], v215 offset:9216
  ds_read_b64_tr_b16 a[140:141], v215 offset:12288
  ds_read_b64_tr_b16 a[142:143], v215 offset:13312
  s_waitcnt vmcnt(3) lgkmcnt(0)
  s_barrier
  v_add_u32 v215, 86016, v210
  ds_read_b64_tr_b16 v[240:241], v215 offset:0
  ds_read_b64_tr_b16 v[242:243], v215 offset:1024
  ds_read_b64_tr_b16 v[244:245], v215 offset:4096
  ds_read_b64_tr_b16 v[246:247], v215 offset:5120
  ds_read_b64_tr_b16 v[248:249], v215 offset:8192
  ds_read_b64_tr_b16 v[250:251], v215 offset:9216
  ds_read_b64_tr_b16 v[252:253], v215 offset:12288
  ds_read_b64_tr_b16 v[254:255], v215 offset:13312
  s_waitcnt lgkmcnt(0)
  s_barrier
  s_mov_b32 s68, 1040356334
  s_lshl_b32 s69, s52, 9
  s_lshl_b32 s70, s58, 2
  s_add_u32 s70, s70, 128
  s_mul_i32 s66, s58, -12288
  s_lshl_b32 s54, s52, 10
  s_add_u32 s66, s66, s54
  s_add_u32 s66, s66, 524288
  v_mov_b32 v64, -1
  v_mov_b32 v65, -1
  v_mov_b32 v66, -1
  v_mov_b32 v67, -1
  s_add_u32 s60, s60, 258048
  ds_read_b128 v[32:35], v203 offset:0
  ds_read_b128 v[36:39], v204 offset:0
  ds_read_b128 v[40:43], v205 offset:0
  s_waitcnt lgkmcnt(2)
  v_mfma_f32_32x32x16_bf16 v[0:15], a[0:3], v[32:35], 0
  ds_read_b128 v[44:47], v206 offset:0
  s_add_u32 m0, s67, 36864
  s_nop 0
  buffer_load_dwordx4 v202, s[4:7], s60 offen offset:0 lds
  v_mfma_f32_32x32x16_bf16 v[16:31], v[32:35], a[144:147], 0
  s_waitcnt lgkmcnt(2)
  v_mfma_f32_32x32x16_bf16 v[0:15], a[4:7], v[36:39], v[0:15]
  ds_read_b128 v[32:35], v203 offset:1024
  s_add_u32 m0, s67, 37760
  s_nop 0
  buffer_load_dwordx4 v202, s[4:7], s60 offen offset:128 lds
  v_mfma_f32_32x32x16_bf16 v[16:31], v[36:39], a[148:151], v[16:31]
  s_waitcnt lgkmcnt(2)
  v_mfma_f32_32x32x16_bf16 v[0:15], a[8:11], v[40:43], v[0:15]
  ds_read_b128 v[36:39], v204 offset:1024
  s_add_u32 m0, s67, 38656
  s_nop 0
  buffer_load_dwordx4 v202, s[4:7], s60 offen offset:256 lds
  v_mfma_f32_32x32x16_bf16 v[16:31], v[40:43], a[152:155], v[16:31]
  s_waitcnt lgkmcnt(2)
  v_mfma_f32_32x32x16_bf16 v[0:15], a[12:15], v[44:47], v[0:15]
  ds_read_b128 v[40:43], v205 offset:1024
  s_add_u32 m0, s67, 39552
  s_nop 0
  buffer_load_dwordx4 v202, s[4:7], s60 offen offset:384 lds
  v_mfma_f32_32x32x16_bf16 v[16:31], v[44:47], a[156:159], v[16:31]
  s_waitcnt lgkmcnt(2)
  v_mfma_f32_32x32x16_bf16 v[0:15], a[16:19], v[32:35], v[0:15]
  ds_read_b128 v[44:47], v206 offset:1024
  s_add_u32 m0, s67, 40448
  s_nop 0
  buffer_load_dwordx4 v202, s[4:7], s60 offen offset:512 lds
  v_mfma_f32_32x32x16_bf16 v[16:31], v[32:35], a[160:163], v[16:31]
  s_waitcnt lgkmcnt(2)
  v_mfma_f32_32x32x16_bf16 v[0:15], a[20:23], v[36:39], v[0:15]
  ds_read_b128 v[32:35], v203 offset:2048
  s_add_u32 m0, s67, 41344
  s_nop 0
  buffer_load_dwordx4 v202, s[4:7], s60 offen offset:640 lds
  v_mfma_f32_32x32x16_bf16 v[16:31], v[36:39], a[164:167], v[16:31]
  s_waitcnt lgkmcnt(2)
  v_mfma_f32_32x32x16_bf16 v[0:15], a[24:27], v[40:43], v[0:15]
  ds_read_b128 v[36:39], v204 offset:2048
  s_add_u32 m0, s67, 42240
  s_nop 0
  buffer_load_dwordx4 v202, s[4:7], s60 offen offset:768 lds
  v_mfma_f32_32x32x16_bf16 v[16:31], v[40:43], a[168:171], v[16:31]
  s_waitcnt lgkmcnt(2)
  v_mfma_f32_32x32x16_bf16 v[0:15], a[28:31], v[44:47], v[0:15]
  ds_read_b128 v[40:43], v205 offset:2048
  s_add_u32 m0, s67, 43136
  s_nop 0
  buffer_load_dwordx4 v202, s[4:7], s60 offen offset:896 lds
  v_mfma_f32_32x32x16_bf16 v[16:31], v[44:47], a[172:175], v[16:31]
  s_waitcnt lgkmcnt(2)
  v_mfma_f32_32x32x16_bf16 v[0:15], a[32:35], v[32:35], v[0:15]
  ds_read_b128 v[44:47], v206 offset:2048
  s_add_u32 m0, s67, 44032
  s_nop 0
  buffer_load_dwordx4 v202, s[4:7], s60 offen offset:1024 lds
  v_mfma_f32_32x32x16_bf16 v[16:31], v[32:35], a[176:179], v[16:31]
  s_waitcnt lgkmcnt(2)
  v_mfma_f32_32x32x16_bf16 v[0:15], a[36:39], v[36:39], v[0:15]
  ds_read_b128 v[32:35], v203 offset:3072
  v_mfma_f32_32x32x16_bf16 v[16:31], v[36:39], a[180:183], v[16:31]
  s_waitcnt lgkmcnt(2)
  v_mfma_f32_32x32x16_bf16 v[0:15], a[40:43], v[40:43], v[0:15]
  ds_read_b128 v[36:39], v204 offset:3072
  v_mfma_f32_32x32x16_bf16 v[16:31], v[40:43], a[184:187], v[16:31]
  s_waitcnt lgkmcnt(2)
  v_mfma_f32_32x32x16_bf16 v[0:15], a[44:47], v[44:47], v[0:15]
  ds_read_b128 v[40:43], v205 offset:3072
  v_mfma_f32_32x32x16_bf16 v[16:31], v[44:47], a[188:191], v[16:31]
  s_waitcnt lgkmcnt(2)
  v_mfma_f32_32x32x16_bf16 v[0:15], a[48:51], v[32:35], v[0:15]
  ds_read_b128 v[44:47], v206 offset:3072
  v_mfma_f32_32x32x16_bf16 v[16:31], v[32:35], a[192:195], v[16:31]
  s_waitcnt lgkmcnt(2)
  v_mfma_f32_32x32x16_bf16 v[0:15], a[52:55], v[36:39], v[0:15]
  ds_read_b128 v[32:35], v203 offset:4096
  v_mfma_f32_32x32x16_bf16 v[16:31], v[36:39], a[196:199], v[16:31]
  s_waitcnt lgkmcnt(2)
  v_mfma_f32_32x32x16_bf16 v[0:15], a[56:59], v[40:43], v[0:15]
  ds_read_b128 v[36:39], v204 offset:4096
  v_mfma_f32_32x32x16_bf16 v[16:31], v[40:43], a[200:203], v[16:31]
  s_waitcnt lgkmcnt(2)
  v_mfma_f32_32x32x16_bf16 v[0:15], a[60:63], v[44:47], v[0:15]
  ds_read_b128 v[40:43], v205 offset:4096
  v_mfma_f32_32x32x16_bf16 v[16:31], v[44:47], a[204:207], v[16:31]
  s_waitcnt lgkmcnt(2)
  v_mfma_f32_32x32x16_bf16 v[0:15], a[64:67], v[32:35], v[0:15]
  ds_read_b128 v[44:47], v206 offset:4096
  v_mfma_f32_32x32x16_bf16 v[16:31], v[32:35], a[208:211], v[16:31]
  s_waitcnt lgkmcnt(2)
  v_mfma_f32_32x32x16_bf16 v[0:15], a[68:71], v[36:39], v[0:15]
  ds_read_b128 v[32:35], v203 offset:5120
  v_mfma_f32_32x32x16_bf16 v[16:31], v[36:39], a[212:215], v[16:31]
  s_waitcnt lgkmcnt(2)
  v_mfma_f32_32x32x16_bf16 v[0:15], a[72:75], v[40:43], v[0:15]
  ds_read_b128 v[36:39], v204 offset:5120
  v_mfma_f32_32x32x16_bf16 v[16:31], v[40:43], a[216:219], v[16:31]
  s_waitcnt lgkmcnt(2)
  v_mfma_f32_32x32x16_bf16 v[0:15], a[76:79], v[44:47], v[0:15]
  ds_read_b128 v[40:43], v205 offset:5120
  v_mfma_f32_32x32x16_bf16 v[16:31], v[44:47], a[220:223], v[16:31]
  s_waitcnt lgkmcnt(2)
  v_mfma_f32_32x32x16_bf16 v[0:15], a[80:83], v[32:35], v[0:15]
  ds_read_b128 v[44:47], v206 offset:5120
  v_mfma_f32_32x32x16_bf16 v[16:31], v[32:35], a[224:227], v[16:31]
  s_waitcnt lgkmcnt(2)
  v_mfma_f32_32x32x16_bf16 v[0:15], a[84:87], v[36:39], v[0:15]
  ds_read_b128 v[32:35], v203 offset:6144
  v_mfma_f32_32x32x16_bf16 v[16:31], v[36:39], a[228:231], v[16:31]
  s_waitcnt lgkmcnt(2)
  v_mfma_f32_32x32x16_bf16 v[0:15], a[88:91], v[40:43], v[0:15]
  ds_read_b128 v[36:39], v204 offset:6144
  v_mfma_f32_32x32x16_bf16 v[16:31], v[40:43], a[232:235], v[16:31]
  s_waitcnt lgkmcnt(2)
  v_mfma_f32_32x32x16_bf16 v[0:15], a[92:95], v[44:47], v[0:15]
  ds_read_b128 v[40:43], v205 offset:6144
  v_mfma_f32_32x32x16_bf16 v[16:31], v[44:47], a[236:239], v[16:31]
  s_waitcnt lgkmcnt(2)
  v_mfma_f32_32x32x16_bf16 v[0:15], a[96:99], v[32:35], v[0:15]
  ds_read_b128 v[44:47], v206 offset:6144
  v_mfma_f32_32x32x16_bf16 v[16:31], v[32:35], a[240:243], v[16:31]
  s_waitcnt lgkmcnt(2)
  v_mfma_f32_32x32x16_bf16 v[0:15], a[100:103], v[36:39], v[0:15]
  ds_read_b128 v[32:35], v203 offset:7168
  v_mfma_f32_32x32x16_bf16 v[16:31], v[36:39], a[244:247], v[16:31]
  s_waitcnt lgkmcnt(2)
  v_mfma_f32_32x32x16_bf16 v[0:15], a[104:107], v[40:43], v[0:15]
  ds_read_b128 v[36:39], v204 offset:7168
  v_mfma_f32_32x32x16_bf16 v[16:31], v[40:43], a[248:251], v[16:31]
  s_waitcnt lgkmcnt(2)
  v_mfma_f32_32x32x16_bf16 v[0:15], a[108:111], v[44:47], v[0:15]
  ds_read_b128 v[40:43], v205 offset:7168
  v_mfma_f32_32x32x16_bf16 v[16:31], v[44:47], a[252:255], v[16:31]
  s_waitcnt lgkmcnt(2)
  v_mfma_f32_32x32x16_bf16 v[0:15], a[112:115], v[32:35], v[0:15]
  ds_read_b128 v[44:47], v206 offset:7168
  v_mfma_f32_32x32x16_bf16 v[16:31], v[32:35], v[224:227], v[16:31]
  s_waitcnt lgkmcnt(2)
  v_mfma_f32_32x32x16_bf16 v[0:15], a[116:119], v[36:39], v[0:15]
  ds_read_b128 v[32:35], v203 offset:8192
  v_mfma_f32_32x32x16_bf16 v[16:31], v[36:39], v[228:231], v[16:31]
  s_waitcnt lgkmcnt(2)
  v_mfma_f32_32x32x16_bf16 v[0:15], a[120:123], v[40:43], v[0:15]
  ds_read_b128 v[36:39], v204 offset:8192
  v_mfma_f32_32x32x16_bf16 v[16:31], v[40:43], v[232:235], v[16:31]
  s_waitcnt lgkmcnt(2)
  v_mfma_f32_32x32x16_bf16 v[0:15], a[124:127], v[44:47], v[0:15]
  ds_read_b128 v[40:43], v205 offset:8192
  v_mfma_f32_32x32x16_bf16 v[16:31], v[44:47], v[236:239], v[16:31]
  s_waitcnt lgkmcnt(2)
  v_mfma_f32_32x32x16_bf16 v[0:15], a[128:131], v[32:35], v[0:15]
  ds_read_b128 v[44:47], v206 offset:8192
  v_mfma_f32_32x32x16_bf16 v[16:31], v[32:35], v[240:243], v[16:31]
  s_waitcnt lgkmcnt(2)
  v_mfma_f32_32x32x16_bf16 v[0:15], a[132:135], v[36:39], v[0:15]
  v_mfma_f32_32x32x16_bf16 v[16:31], v[36:39], v[244:247], v[16:31]
  s_waitcnt lgkmcnt(1)
  v_mfma_f32_32x32x16_bf16 v[0:15], a[136:139], v[40:43], v[0:15]
  v_mfma_f32_32x32x16_bf16 v[16:31], v[40:43], v[248:251], v[16:31]
  s_waitcnt lgkmcnt(0)
  v_mfma_f32_32x32x16_bf16 v[0:15], a[140:143], v[44:47], v[0:15]
  v_mfma_f32_32x32x16_bf16 v[16:31], v[44:47], v[252:255], v[16:31]
  s_mul_i32 s64, s59, 655360
  s_lshl_b32 s55, s58, 14
  s_add_u32 s64, s64, s55
  s_add_u32 s64, s64, 1048576
  s_add_u32 s72, s64, s69
  s_add_u32 s73, s64, s66
  s_add_u32 s59, s59, 7
  s_waitcnt vmcnt(0)
  s_barrier
  s_cmp_eq_u32 s1, 1
  s_cbranch_scc1 W_ver_ok
  v_mov_b32 v33, 163832
  s_cmp_eq_u32 s52, 0
  s_cbranch_scc0 W_ver_b
  s_waitcnt vmcnt(0)
  s_mov_b64 exec, 1
  ds_write_b32 v33, v197
  s_mov_b64 exec, -1
  s_waitcnt lgkmcnt(0)
W_ver_b:
  s_barrier
  ds_read_b32 v32, v33
  s_waitcnt lgkmcnt(0)
  v_readfirstlane_b32 s54, v32
  s_nop 0
  s_bitcmp1_b32 s54, s0
  s_cbranch_scc1 L_conf
W_ver_ok:
  s_lshr_b32 s55, s53, 1
  s_and_b32 s56, s53, 1
  s_lshl_b32 s56, s56, 7
  s_lshl_b32 s55, s55, 2
  s_add_u32 s55, s55, s56
  s_add_u32 s55, s55, 356352
  s_cmp_lt_u32 s53, 64
  s_cselect_b32 s71, s55, 268435456
  v_mov_b32 v211, 0
  s_mov_b64 exec, 1
  buffer_store_dword v211, v211, s[8:11], s71 offen sc1
  s_mov_b64 exec, -1
  s_cmp_eq_u32 s59, 7
  s_cbranch_scc0 KV_na
  s_mul_i32 s54, s58, 2176
  s_mul_i32 s55, s52, 69632
  s_add_u32 s55, s55, s54
  s_add_u32 s55, s55, 0
  s_add_u32 s54, s54, 278528
  s_and_b32 s56, s58, 7
  s_lshl_b32 s56, s56, 12
  s_bfe_u32 s57, s58, 0x10003
  s_lshl_b32 s57, s57, 11
  s_add_u32 s56, s56, s57
  s_add_u32 s54, s56, 262144
  s_lshr_b32 s57, s58, 4
  s_lshl_b32 s57, s57, 15
  s_add_u32 s56, s56, s57
  s_lshl_b32 s57, s52, 16
  s_add_u32 s56, s56, s57
  s_add_u32 s55, s56, 0
  s_lshl_b32 s56, s58, 14
  s_mul_i32 s57, s52, 3072
  s_add_u32 s56, s56, s57
  s_add_u32 s56, s56, 360448
  s_cmp_lt_u32 s58, 2
  s_cselect_b32 s56, s56, 268435456
  s_cmp_eq_u32 s52, 0
  s_cselect_b32 s54, s54, 268435456
  buffer_store_dwordx4 v[64:67], v201, s[8:11], s55 offen offset:0 sc1
  buffer_store_dwordx4 v[64:67], v201, s[8:11], s55 offen offset:1024 sc1
  buffer_store_dwordx4 v[64:67], v201, s[8:11], s54 offen offset:0 sc1
  buffer_store_dwordx4 v[64:67], v201, s[8:11], s54 offen offset:1024 sc1
  buffer_store_dwordx4 v[64:67], v201, s[8:11], s56 offen offset:0 sc1
  buffer_store_dwordx4 v[64:67], v201, s[8:11], s56 offen offset:1024 sc1
  buffer_store_dwordx4 v[64:67], v201, s[8:11], s56 offen offset:2048 sc1
KV_na:
KV_loop:
  s_add_u32 s60, s60, 258048
  ds_read_b128 v[32:35], v203 offset:36864
  ds_read_b128 v[36:39], v204 offset:36864
  ds_read_b128 v[40:43], v205 offset:36864
  s_waitcnt lgkmcnt(2)
  v_mfma_f32_32x32x16_bf16 v[68:83], a[0:3], v[32:35], 0
  ds_read_b128 v[44:47], v206 offset:36864
  s_add_u32 m0, s67, 0
  s_nop 0
  buffer_load_dwordx4 v202, s[4:7], s60 offen offset:0 lds
  v_mfma_f32_32x32x16_bf16 v[84:99], v[32:35], a[144:147], 0
  s_waitcnt lgkmcnt(2)
  v_mfma_f32_32x32x16_bf16 v[68:83], a[4:7], v[36:39], v[68:83]
  ds_read_b128 v[32:35], v203 offset:37888
  s_add_u32 m0, s67, 896
  s_nop 0
  buffer_load_dwordx4 v202, s[4:7], s60 offen offset:128 lds
  v_mfma_f32_32x32x16_bf16 v[84:99], v[36:39], a[148:151], v[84:99]
  s_waitcnt lgkmcnt(2)
  v_mfma_f32_32x32x16_bf16 v[68:83], a[8:11], v[40:43], v[68:83]
  ds_read_b128 v[36:39], v204 offset:37888
  s_add_u32 m0, s67, 1792
  s_nop 0
  buffer_load_dwordx4 v202, s[4:7], s60 offen offset:256 lds
  v_mfma_f32_32x32x16_bf16 v[84:99], v[40:43], a[152:155], v[84:99]
  s_waitcnt lgkmcnt(2)
  v_mfma_f32_32x32x16_bf16 v[68:83], a[12:15], v[44:47], v[68:83]
  ds_read_b128 v[40:43], v205 offset:37888
  s_add_u32 m0, s67, 2688
  s_nop 0
  buffer_load_dwordx4 v202, s[4:7], s60 offen offset:384 lds
  v_mfma_f32_32x32x16_bf16 v[84:99], v[44:47], a[156:159], v[84:99]
  s_waitcnt lgkmcnt(2)
  v_mfma_f32_32x32x16_bf16 v[68:83], a[16:19], v[32:35], v[68:83]
  ds_read_b128 v[44:47], v206 offset:37888
  s_add_u32 m0, s67, 3584
  s_nop 0
  buffer_load_dwordx4 v202, s[4:7], s60 offen offset:512 lds
  v_mfma_f32_32x32x16_bf16 v[84:99], v[32:35], a[160:163], v[84:99]
  s_waitcnt lgkmcnt(2)
  v_mfma_f32_32x32x16_bf16 v[68:83], a[20:23], v[36:39], v[68:83]
  ds_read_b128 v[32:35], v203 offset:38912
  s_add_u32 m0, s67, 4480
  s_nop 0
  buffer_load_dwordx4 v202, s[4:7], s60 offen offset:640 lds
  v_mfma_f32_32x32x16_bf16 v[84:99], v[36:39], a[164:167], v[84:99]
  s_waitcnt lgkmcnt(2)
  v_mfma_f32_32x32x16_bf16 v[68:83], a[24:27], v[40:43], v[68:83]
  ds_read_b128 v[36:39], v204 offset:38912
  s_add_u32 m0, s67, 5376
  s_nop 0
  buffer_load_dwordx4 v202, s[4:7], s60 offen offset:768 lds
  v_mfma_f32_32x32x16_bf16 v[84:99], v[40:43], a[168:171], v[84:99]
  s_waitcnt lgkmcnt(2)
  v_mfma_f32_32x32x16_bf16 v[68:83], a[28:31], v[44:47], v[68:83]
  ds_read_b128 v[40:43], v205 offset:38912
  s_add_u32 m0, s67, 6272
  s_nop 0
  buffer_load_dwordx4 v202, s[4:7], s60 offen offset:896 lds
  v_mfma_f32_32x32x16_bf16 v[84:99], v[44:47], a[172:175], v[84:99]
  s_waitcnt lgkmcnt(2)
  v_mfma_f32_32x32x16_bf16 v[68:83], a[32:35], v[32:35], v[68:83]
  ds_read_b128 v[44:47], v206 offset:38912
  s_add_u32 m0, s67, 7168
  s_nop 0
  buffer_load_dwordx4 v202, s[4:7], s60 offen offset:1024 lds
  v_mfma_f32_32x32x16_bf16 v[84:99], v[32:35], a[176:179], v[84:99]
  s_waitcnt lgkmcnt(2)
  v_mfma_f32_32x32x16_bf16 v[68:83], a[36:39], v[36:39], v[68:83]
  ds_read_b128 v[32:35], v203 offset:39936
  v_mul_f32 v0, s68, v0
  v_mul_f32 v1, s68, v1
  v_mul_f32 v2, s68, v2
  v_mul_f32 v3, s68, v3
  v_mfma_f32_32x32x16_bf16 v[84:99], v[36:39], a[180:183], v[84:99]
  v_mul_f32 v4, s68, v4
  v_mul_f32 v5, s68, v5
  v_mul_f32 v6, s68, v6
  v_mul_f32 v7, s68, v7
  s_waitcnt lgkmcnt(2)
  v_mfma_f32_32x32x16_bf16 v[68:83], a[40:43], v[40:43], v[68:83]
  ds_read_b128 v[36:39], v204 offset:39936
  v_cvt_pk_bf16_f32 v48, v0, v4
  v_cvt_pk_bf16_f32 v49, v1, v5
  v_cvt_pk_bf16_f32 v50, v2, v6
  v_cvt_pk_bf16_f32 v51, v3, v7
  v_mfma_f32_32x32x16_bf16 v[84:99], v[40:43], a[184:187], v[84:99]
  buffer_store_dwordx4 v[48:51], v216, s[8:11], s72 offen offset:0 sc1
  s_waitcnt lgkmcnt(2)
  v_mfma_f32_32x32x16_bf16 v[68:83], a[44:47], v[44:47], v[68:83]
  ds_read_b128 v[40:43], v205 offset:39936
  v_mfma_f32_32x32x16_bf16 v[84:99], v[44:47], a[188:191], v[84:99]
  s_waitcnt lgkmcnt(2)
  v_mfma_f32_32x32x16_bf16 v[68:83], a[48:51], v[32:35], v[68:83]
  ds_read_b128 v[44:47], v206 offset:39936
  v_mul_f32 v8, s68, v8
  v_mul_f32 v9, s68, v9
  v_mul_f32 v10, s68, v10
  v_mul_f32 v11, s68, v11
  v_mfma_f32_32x32x16_bf16 v[84:99], v[32:35], a[192:195], v[84:99]
  v_mul_f32 v12, s68, v12
  v_mul_f32 v13, s68, v13
  v_mul_f32 v14, s68, v14
  v_mul_f32 v15, s68, v15
  s_waitcnt lgkmcnt(2)
  v_mfma_f32_32x32x16_bf16 v[68:83], a[52:55], v[36:39], v[68:83]
  ds_read_b128 v[32:35], v203 offset:40960
  v_cvt_pk_bf16_f32 v52, v8, v12
  v_cvt_pk_bf16_f32 v53, v9, v13
  v_cvt_pk_bf16_f32 v54, v10, v14
  v_cvt_pk_bf16_f32 v55, v11, v15
  v_mfma_f32_32x32x16_bf16 v[84:99], v[36:39], a[196:199], v[84:99]
  buffer_store_dwordx4 v[52:55], v216, s[8:11], s72 offen offset:256 sc1
  s_waitcnt lgkmcnt(2)
  v_mfma_f32_32x32x16_bf16 v[68:83], a[56:59], v[40:43], v[68:83]
  ds_read_b128 v[36:39], v204 offset:40960
  v_mfma_f32_32x32x16_bf16 v[84:99], v[40:43], a[200:203], v[84:99]
  s_waitcnt lgkmcnt(2)
  v_mfma_f32_32x32x16_bf16 v[68:83], a[60:63], v[44:47], v[68:83]
  ds_read_b128 v[40:43], v205 offset:40960
  v_cvt_pk_bf16_f32 v56, v16, v17
  v_cvt_pk_bf16_f32 v57, v20, v21
  v_cvt_pk_bf16_f32 v58, v24, v25
  v_cvt_pk_bf16_f32 v59, v28, v29
  v_mfma_f32_32x32x16_bf16 v[84:99], v[44:47], a[204:207], v[84:99]
  buffer_store_dwordx4 v[56:59], v217, s[8:11], s64 offen offset:0 sc1
  s_waitcnt lgkmcnt(2)
  v_mfma_f32_32x32x16_bf16 v[68:83], a[64:67], v[32:35], v[68:83]
  ds_read_b128 v[44:47], v206 offset:40960
  v_mfma_f32_32x32x16_bf16 v[84:99], v[32:35], a[208:211], v[84:99]
  s_waitcnt lgkmcnt(2)
  v_mfma_f32_32x32x16_bf16 v[68:83], a[68:71], v[36:39], v[68:83]
  ds_read_b128 v[32:35], v203 offset:41984
  v_cvt_pk_bf16_f32 v60, v18, v19
  v_cvt_pk_bf16_f32 v61, v22, v23
  v_cvt_pk_bf16_f32 v62, v26, v27
  v_cvt_pk_bf16_f32 v63, v30, v31
  v_mfma_f32_32x32x16_bf16 v[84:99], v[36:39], a[212:215], v[84:99]
  buffer_store_dwordx4 v[60:63], v217, s[8:11], s64 offen offset:256 sc1
  s_waitcnt lgkmcnt(2)
  v_mfma_f32_32x32x16_bf16 v[68:83], a[72:75], v[40:43], v[68:83]
  ds_read_b128 v[36:39], v204 offset:41984
  v_mfma_f32_32x32x16_bf16 v[84:99], v[40:43], a[216:219], v[84:99]
  s_waitcnt lgkmcnt(2)
  v_mfma_f32_32x32x16_bf16 v[68:83], a[76:79], v[44:47], v[68:83]
  ds_read_b128 v[40:43], v205 offset:41984
  buffer_store_dwordx4 v[64:67], v201, s[8:11], s73 offen sc1
  v_mfma_f32_32x32x16_bf16 v[84:99], v[44:47], a[220:223], v[84:99]
  s_waitcnt lgkmcnt(2)
  v_mfma_f32_32x32x16_bf16 v[68:83], a[80:83], v[32:35], v[68:83]
  ds_read_b128 v[44:47], v206 offset:41984
  v_mfma_f32_32x32x16_bf16 v[84:99], v[32:35], a[224:227], v[84:99]
  s_waitcnt lgkmcnt(2)
  v_mfma_f32_32x32x16_bf16 v[68:83], a[84:87], v[36:39], v[68:83]
  ds_read_b128 v[32:35], v203 offset:43008
  v_mfma_f32_32x32x16_bf16 v[84:99], v[36:39], a[228:231], v[84:99]
  s_waitcnt lgkmcnt(2)
  v_mfma_f32_32x32x16_bf16 v[68:83], a[88:91], v[40:43], v[68:83]
  ds_read_b128 v[36:39], v204 offset:43008
  v_mfma_f32_32x32x16_bf16 v[84:99], v[40:43], a[232:235], v[84:99]
  s_waitcnt lgkmcnt(2)
  v_mfma_f32_32x32x16_bf16 v[68:83], a[92:95], v[44:47], v[68:83]
  ds_read_b128 v[40:43], v205 offset:43008
  v_mfma_f32_32x32x16_bf16 v[84:99], v[44:47], a[236:239], v[84:99]
  s_waitcnt lgkmcnt(2)
  v_mfma_f32_32x32x16_bf16 v[68:83], a[96:99], v[32:35], v[68:83]
  ds_read_b128 v[44:47], v206 offset:43008
  v_mfma_f32_32x32x16_bf16 v[84:99], v[32:35], a[240:243], v[84:99]
  s_waitcnt lgkmcnt(2)
  v_mfma_f32_32x32x16_bf16 v[68:83], a[100:103], v[36:39], v[68:83]
  ds_read_b128 v[32:35], v203 offset:44032
  v_mfma_f32_32x32x16_bf16 v[84:99], v[36:39], a[244:247], v[84:99]
  s_waitcnt lgkmcnt(2)
  v_mfma_f32_32x32x16_bf16 v[68:83], a[104:107], v[40:43], v[68:83]
  ds_read_b128 v[36:39], v204 offset:44032
  v_mfma_f32_32x32x16_bf16 v[84:99], v[40:43], a[248:251], v[84:99]
  s_waitcnt lgkmcnt(2)
  v_mfma_f32_32x32x16_bf16 v[68:83], a[108:111], v[44:47], v[68:83]
  ds_read_b128 v[40:43], v205 offset:44032
  v_mfma_f32_32x32x16_bf16 v[84:99], v[44:47], a[252:255], v[84:99]
  s_waitcnt lgkmcnt(2)
  v_mfma_f32_32x32x16_bf16 v[68:83], a[112:115], v[32:35], v[68:83]
  ds_read_b128 v[44:47], v206 offset:44032
  v_mfma_f32_32x32x16_bf16 v[84:99], v[32:35], v[224:227], v[84:99]
  s_waitcnt lgkmcnt(2)
  v_mfma_f32_32x32x16_bf16 v[68:83], a[116:119], v[36:39], v[68:83]
  ds_read_b128 v[32:35], v203 offset:45056
  v_mfma_f32_32x32x16_bf16 v[84:99], v[36:39], v[228:231], v[84:99]
  s_waitcnt lgkmcnt(2)
  v_mfma_f32_32x32x16_bf16 v[68:83], a[120:123], v[40:43], v[68:83]
  ds_read_b128 v[36:39], v204 offset:45056
  v_mfma_f32_32x32x16_bf16 v[84:99], v[40:43], v[232:235], v[84:99]
  s_waitcnt lgkmcnt(2)
  v_mfma_f32_32x32x16_bf16 v[68:83], a[124:127], v[44:47], v[68:83]
  ds_read_b128 v[40:43], v205 offset:45056
  v_mfma_f32_32x32x16_bf16 v[84:99], v[44:47], v[236:239], v[84:99]
  s_waitcnt lgkmcnt(2)
  v_mfma_f32_32x32x16_bf16 v[68:83], a[128:131], v[32:35], v[68:83]
  ds_read_b128 v[44:47], v206 offset:45056
  v_mfma_f32_32x32x16_bf16 v[84:99], v[32:35], v[240:243], v[84:99]
  s_waitcnt lgkmcnt(2)
  v_mfma_f32_32x32x16_bf16 v[68:83], a[132:135], v[36:39], v[68:83]
  v_mfma_f32_32x32x16_bf16 v[84:99], v[36:39], v[244:247], v[84:99]
  s_waitcnt lgkmcnt(1)
  v_mfma_f32_32x32x16_bf16 v[68:83], a[136:139], v[40:43], v[68:83]
  v_mfma_f32_32x32x16_bf16 v[84:99], v[40:43], v[248:251], v[84:99]
  s_waitcnt lgkmcnt(0)
  v_mfma_f32_32x32x16_bf16 v[68:83], a[140:143], v[44:47], v[68:83]
  v_mfma_f32_32x32x16_bf16 v[84:99], v[44:47], v[252:255], v[84:99]
  s_mul_i32 s64, s59, 655360
  s_lshl_b32 s55, s58, 14
  s_add_u32 s64, s64, s55
  s_add_u32 s64, s64, 1048576
  s_add_u32 s72, s64, s69
  s_add_u32 s73, s64, s66
  s_add_u32 s59, s59, 7
  s_cmp_ge_u32 s59, 64
  s_cbranch_scc1 KV_done1
  s_waitcnt vmcnt(5)
  s_barrier
  s_add_u32 s60, s60, 258048
  ds_read_b128 v[32:35], v203 offset:0
  ds_read_b128 v[36:39], v204 offset:0
  ds_read_b128 v[40:43], v205 offset:0
  s_waitcnt lgkmcnt(2)
  v_mfma_f32_32x32x16_bf16 v[0:15], a[0:3], v[32:35], 0
  ds_read_b128 v[44:47], v206 offset:0
  s_add_u32 m0, s67, 36864
  s_nop 0
  buffer_load_dwordx4 v202, s[4:7], s60 offen offset:0 lds
  v_mfma_f32_32x32x16_bf16 v[16:31], v[32:35], a[144:147], 0
  s_waitcnt lgkmcnt(2)
  v_mfma_f32_32x32x16_bf16 v[0:15], a[4:7], v[36:39], v[0:15]
  ds_read_b128 v[32:35], v203 offset:1024
  s_add_u32 m0, s67, 37760
  s_nop 0
  buffer_load_dwordx4 v202, s[4:7], s60 offen offset:128 lds
  v_mfma_f32_32x32x16_bf16 v[16:31], v[36:39], a[148:151], v[16:31]
  s_waitcnt lgkmcnt(2)
  v_mfma_f32_32x32x16_bf16 v[0:15], a[8:11], v[40:43], v[0:15]
  ds_read_b128 v[36:39], v204 offset:1024
  s_add_u32 m0, s67, 38656
  s_nop 0
  buffer_load_dwordx4 v202, s[4:7], s60 offen offset:256 lds
  v_mfma_f32_32x32x16_bf16 v[16:31], v[40:43], a[152:155], v[16:31]
  s_waitcnt lgkmcnt(2)
  v_mfma_f32_32x32x16_bf16 v[0:15], a[12:15], v[44:47], v[0:15]
  ds_read_b128 v[40:43], v205 offset:1024
  s_add_u32 m0, s67, 39552
  s_nop 0
  buffer_load_dwordx4 v202, s[4:7], s60 offen offset:384 lds
  v_mfma_f32_32x32x16_bf16 v[16:31], v[44:47], a[156:159], v[16:31]
  s_waitcnt lgkmcnt(2)
  v_mfma_f32_32x32x16_bf16 v[0:15], a[16:19], v[32:35], v[0:15]
  ds_read_b128 v[44:47], v206 offset:1024
  s_add_u32 m0, s67, 40448
  s_nop 0
  buffer_load_dwordx4 v202, s[4:7], s60 offen offset:512 lds
  v_mfma_f32_32x32x16_bf16 v[16:31], v[32:35], a[160:163], v[16:31]
  s_waitcnt lgkmcnt(2)
  v_mfma_f32_32x32x16_bf16 v[0:15], a[20:23], v[36:39], v[0:15]
  ds_read_b128 v[32:35], v203 offset:2048
  s_add_u32 m0, s67, 41344
  s_nop 0
  buffer_load_dwordx4 v202, s[4:7], s60 offen offset:640 lds
  v_mfma_f32_32x32x16_bf16 v[16:31], v[36:39], a[164:167], v[16:31]
  s_waitcnt lgkmcnt(2)
  v_mfma_f32_32x32x16_bf16 v[0:15], a[24:27], v[40:43], v[0:15]
  ds_read_b128 v[36:39], v204 offset:2048
  s_add_u32 m0, s67, 42240
  s_nop 0
  buffer_load_dwordx4 v202, s[4:7], s60 offen offset:768 lds
  v_mfma_f32_32x32x16_bf16 v[16:31], v[40:43], a[168:171], v[16:31]
  s_waitcnt lgkmcnt(2)
  v_mfma_f32_32x32x16_bf16 v[0:15], a[28:31], v[44:47], v[0:15]
  ds_read_b128 v[40:43], v205 offset:2048
  s_add_u32 m0, s67, 43136
  s_nop 0
  buffer_load_dwordx4 v202, s[4:7], s60 offen offset:896 lds
  v_mfma_f32_32x32x16_bf16 v[16:31], v[44:47], a[172:175], v[16:31]
  s_waitcnt lgkmcnt(2)
  v_mfma_f32_32x32x16_bf16 v[0:15], a[32:35], v[32:35], v[0:15]
  ds_read_b128 v[44:47], v206 offset:2048
  s_add_u32 m0, s67, 44032
  s_nop 0
  buffer_load_dwordx4 v202, s[4:7], s60 offen offset:1024 lds
  v_mfma_f32_32x32x16_bf16 v[16:31], v[32:35], a[176:179], v[16:31]
  s_waitcnt lgkmcnt(2)
  v_mfma_f32_32x32x16_bf16 v[0:15], a[36:39], v[36:39], v[0:15]
  ds_read_b128 v[32:35], v203 offset:3072
  v_mul_f32 v68, s68, v68
  v_mul_f32 v69, s68, v69
  v_mul_f32 v70, s68, v70
  v_mul_f32 v71, s68, v71
  v_mfma_f32_32x32x16_bf16 v[16:31], v[36:39], a[180:183], v[16:31]
  v_mul_f32 v72, s68, v72
  v_mul_f32 v73, s68, v73
  v_mul_f32 v74, s68, v74
  v_mul_f32 v75, s68, v75
  s_waitcnt lgkmcnt(2)
  v_mfma_f32_32x32x16_bf16 v[0:15], a[40:43], v[40:43], v[0:15]
  ds_read_b128 v[36:39], v204 offset:3072
  v_cvt_pk_bf16_f32 v48, v68, v72
  v_cvt_pk_bf16_f32 v49, v69, v73
  v_cvt_pk_bf16_f32 v50, v70, v74
  v_cvt_pk_bf16_f32 v51, v71, v75
  v_mfma_f32_32x32x16_bf16 v[16:31], v[40:43], a[184:187], v[16:31]
  buffer_store_dwordx4 v[48:51], v216, s[8:11], s72 offen offset:0 sc1
  s_waitcnt lgkmcnt(2)
  v_mfma_f32_32x32x16_bf16 v[0:15], a[44:47], v[44:47], v[0:15]
  ds_read_b128 v[40:43], v205 offset:3072
  v_mfma_f32_32x32x16_bf16 v[16:31], v[44:47], a[188:191], v[16:31]
  s_waitcnt lgkmcnt(2)
  v_mfma_f32_32x32x16_bf16 v[0:15], a[48:51], v[32:35], v[0:15]
  ds_read_b128 v[44:47], v206 offset:3072
  v_mul_f32 v76, s68, v76
  v_mul_f32 v77, s68, v77
  v_mul_f32 v78, s68, v78
  v_mul_f32 v79, s68, v79
  v_mfma_f32_32x32x16_bf16 v[16:31], v[32:35], a[192:195], v[16:31]
  v_mul_f32 v80, s68, v80
  v_mul_f32 v81, s68, v81
  v_mul_f32 v82, s68, v82
  v_mul_f32 v83, s68, v83
  s_waitcnt lgkmcnt(2)
  v_mfma_f32_32x32x16_bf16 v[0:15], a[52:55], v[36:39], v[0:15]
  ds_read_b128 v[32:35], v203 offset:4096
  v_cvt_pk_bf16_f32 v52, v76, v80
  v_cvt_pk_bf16_f32 v53, v77, v81
  v_cvt_pk_bf16_f32 v54, v78, v82
  v_cvt_pk_bf16_f32 v55, v79, v83
  v_mfma_f32_32x32x16_bf16 v[16:31], v[36:39], a[196:199], v[16:31]
  buffer_store_dwordx4 v[52:55], v216, s[8:11], s72 offen offset:256 sc1
  s_waitcnt lgkmcnt(2)
  v_mfma_f32_32x32x16_bf16 v[0:15], a[56:59], v[40:43], v[0:15]
  ds_read_b128 v[36:39], v204 offset:4096
  v_mfma_f32_32x32x16_bf16 v[16:31], v[40:43], a[200:203], v[16:31]
  s_waitcnt lgkmcnt(2)
  v_mfma_f32_32x32x16_bf16 v[0:15], a[60:63], v[44:47], v[0:15]
  ds_read_b128 v[40:43], v205 offset:4096
  v_cvt_pk_bf16_f32 v56, v84, v85
  v_cvt_pk_bf16_f32 v57, v88, v89
  v_cvt_pk_bf16_f32 v58, v92, v93
  v_cvt_pk_bf16_f32 v59, v96, v97
  v_mfma_f32_32x32x16_bf16 v[16:31], v[44:47], a[204:207], v[16:31]
  buffer_store_dwordx4 v[56:59], v217, s[8:11], s64 offen offset:0 sc1
  s_waitcnt lgkmcnt(2)
  v_mfma_f32_32x32x16_bf16 v[0:15], a[64:67], v[32:35], v[0:15]
  ds_read_b128 v[44:47], v206 offset:4096
  v_mfma_f32_32x32x16_bf16 v[16:31], v[32:35], a[208:211], v[16:31]
  s_waitcnt lgkmcnt(2)
  v_mfma_f32_32x32x16_bf16 v[0:15], a[68:71], v[36:39], v[0:15]
  ds_read_b128 v[32:35], v203 offset:5120
  v_cvt_pk_bf16_f32 v60, v86, v87
  v_cvt_pk_bf16_f32 v61, v90, v91
  v_cvt_pk_bf16_f32 v62, v94, v95
  v_cvt_pk_bf16_f32 v63, v98, v99
  v_mfma_f32_32x32x16_bf16 v[16:31], v[36:39], a[212:215], v[16:31]
  buffer_store_dwordx4 v[60:63], v217, s[8:11], s64 offen offset:256 sc1
  s_waitcnt lgkmcnt(2)
  v_mfma_f32_32x32x16_bf16 v[0:15], a[72:75], v[40:43], v[0:15]
  ds_read_b128 v[36:39], v204 offset:5120
  v_mfma_f32_32x32x16_bf16 v[16:31], v[40:43], a[216:219], v[16:31]
  s_waitcnt lgkmcnt(2)
  v_mfma_f32_32x32x16_bf16 v[0:15], a[76:79], v[44:47], v[0:15]
  ds_read_b128 v[40:43], v205 offset:5120
  buffer_store_dwordx4 v[64:67], v201, s[8:11], s73 offen sc1
  v_mfma_f32_32x32x16_bf16 v[16:31], v[44:47], a[220:223], v[16:31]
  s_waitcnt lgkmcnt(2)
  v_mfma_f32_32x32x16_bf16 v[0:15], a[80:83], v[32:35], v[0:15]
  ds_read_b128 v[44:47], v206 offset:5120
  v_mfma_f32_32x32x16_bf16 v[16:31], v[32:35], a[224:227], v[16:31]
  s_waitcnt lgkmcnt(2)
  v_mfma_f32_32x32x16_bf16 v[0:15], a[84:87], v[36:39], v[0:15]
  ds_read_b128 v[32:35], v203 offset:6144
  v_mfma_f32_32x32x16_bf16 v[16:31], v[36:39], a[228:231], v[16:31]
  s_waitcnt lgkmcnt(2)
  v_mfma_f32_32x32x16_bf16 v[0:15], a[88:91], v[40:43], v[0:15]
  ds_read_b128 v[36:39], v204 offset:6144
  v_mfma_f32_32x32x16_bf16 v[16:31], v[40:43], a[232:235], v[16:31]
  s_waitcnt lgkmcnt(2)
  v_mfma_f32_32x32x16_bf16 v[0:15], a[92:95], v[44:47], v[0:15]
  ds_read_b128 v[40:43], v205 offset:6144
  v_mfma_f32_32x32x16_bf16 v[16:31], v[44:47], a[236:239], v[16:31]
  s_waitcnt lgkmcnt(2)
  v_mfma_f32_32x32x16_bf16 v[0:15], a[96:99], v[32:35], v[0:15]
  ds_read_b128 v[44:47], v206 offset:6144
  v_mfma_f32_32x32x16_bf16 v[16:31], v[32:35], a[240:243], v[16:31]
  s_waitcnt lgkmcnt(2)
  v_mfma_f32_32x32x16_bf16 v[0:15], a[100:103], v[36:39], v[0:15]
  ds_read_b128 v[32:35], v203 offset:7168
  v_mfma_f32_32x32x16_bf16 v[16:31], v[36:39], a[244:247], v[16:31]
  s_waitcnt lgkmcnt(2)
  v_mfma_f32_32x32x16_bf16 v[0:15], a[104:107], v[40:43], v[0:15]
  ds_read_b128 v[36:39], v204 offset:7168
  v_mfma_f32_32x32x16_bf16 v[16:31], v[40:43], a[248:251], v[16:31]
  s_waitcnt lgkmcnt(2)
  v_mfma_f32_32x32x16_bf16 v[0:15], a[108:111], v[44:47], v[0:15]
  ds_read_b128 v[40:43], v205 offset:7168
  v_mfma_f32_32x32x16_bf16 v[16:31], v[44:47], a[252:255], v[16:31]
  s_waitcnt lgkmcnt(2)
  v_mfma_f32_32x32x16_bf16 v[0:15], a[112:115], v[32:35], v[0:15]
  ds_read_b128 v[44:47], v206 offset:7168
  v_mfma_f32_32x32x16_bf16 v[16:31], v[32:35], v[224:227], v[16:31]
  s_waitcnt lgkmcnt(2)
  v_mfma_f32_32x32x16_bf16 v[0:15], a[116:119], v[36:39], v[0:15]
  ds_read_b128 v[32:35], v203 offset:8192
  v_mfma_f32_32x32x16_bf16 v[16:31], v[36:39], v[228:231], v[16:31]
  s_waitcnt lgkmcnt(2)
  v_mfma_f32_32x32x16_bf16 v[0:15], a[120:123], v[40:43], v[0:15]
  ds_read_b128 v[36:39], v204 offset:8192
  v_mfma_f32_32x32x16_bf16 v[16:31], v[40:43], v[232:235], v[16:31]
  s_waitcnt lgkmcnt(2)
  v_mfma_f32_32x32x16_bf16 v[0:15], a[124:127], v[44:47], v[0:15]
  ds_read_b128 v[40:43], v205 offset:8192
  v_mfma_f32_32x32x16_bf16 v[16:31], v[44:47], v[236:239], v[16:31]
  s_waitcnt lgkmcnt(2)
  v_mfma_f32_32x32x16_bf16 v[0:15], a[128:131], v[32:35], v[0:15]
  ds_read_b128 v[44:47], v206 offset:8192
  v_mfma_f32_32x32x16_bf16 v[16:31], v[32:35], v[240:243], v[16:31]
  s_waitcnt lgkmcnt(2)
  v_mfma_f32_32x32x16_bf16 v[0:15], a[132:135], v[36:39], v[0:15]
  v_mfma_f32_32x32x16_bf16 v[16:31], v[36:39], v[244:247], v[16:31]
  s_waitcnt lgkmcnt(1)
  v_mfma_f32_32x32x16_bf16 v[0:15], a[136:139], v[40:43], v[0:15]
  v_mfma_f32_32x32x16_bf16 v[16:31], v[40:43], v[248:251], v[16:31]
  s_waitcnt lgkmcnt(0)
  v_mfma_f32_32x32x16_bf16 v[0:15], a[140:143], v[44:47], v[0:15]
  v_mfma_f32_32x32x16_bf16 v[16:31], v[44:47], v[252:255], v[16:31]
  s_mul_i32 s64, s59, 655360
  s_lshl_b32 s55, s58, 14
  s_add_u32 s64, s64, s55
  s_add_u32 s64, s64, 1048576
  s_add_u32 s72, s64, s69
  s_add_u32 s73, s64, s66
  s_add_u32 s59, s59, 7
  s_cmp_ge_u32 s59, 64
  s_cbranch_scc1 KV_done0
  s_sub_u32 s54, s59, 21
  s_cmp_lt_u32 s54, 7
  s_cbranch_scc1 KV_early
  s_waitcnt vmcnt(5)
  s_barrier
KV_cont:
  s_branch KV_loop
KV_early:
  s_waitcnt vmcnt(0)
  s_barrier
  s_cmp_eq_u32 s52, 0
  s_cbranch_scc0 KV_sig0
  v_mov_b32 v211, 1
  v_mov_b32 v212, 0
  s_mov_b64 exec, 1
  buffer_atomic_add v211, v212, s[12:15], s70 offen
  s_mov_b64 exec, -1
KV_sig0:
  s_branch KV_cont
KV_done1:
  s_nop 11
  v_mul_f32 v68, s68, v68
  v_mul_f32 v69, s68, v69
  v_mul_f32 v70, s68, v70
  v_mul_f32 v71, s68, v71
  v_mul_f32 v72, s68, v72
  v_mul_f32 v73, s68, v73
  v_mul_f32 v74, s68, v74
  v_mul_f32 v75, s68, v75
  v_cvt_pk_bf16_f32 v48, v68, v72
  v_cvt_pk_bf16_f32 v49, v69, v73
  v_cvt_pk_bf16_f32 v50, v70, v74
  v_cvt_pk_bf16_f32 v51, v71, v75
  buffer_store_dwordx4 v[48:51], v216, s[8:11], s72 offen offset:0 sc1
  v_mul_f32 v76, s68, v76
  v_mul_f32 v77, s68, v77
  v_mul_f32 v78, s68, v78
  v_mul_f32 v79, s68, v79
  v_mul_f32 v80, s68, v80
  v_mul_f32 v81, s68, v81
  v_mul_f32 v82, s68, v82
  v_mul_f32 v83, s68, v83
  v_cvt_pk_bf16_f32 v52, v76, v80
  v_cvt_pk_bf16_f32 v53, v77, v81
  v_cvt_pk_bf16_f32 v54, v78, v82
  v_cvt_pk_bf16_f32 v55, v79, v83
  buffer_store_dwordx4 v[52:55], v216, s[8:11], s72 offen offset:256 sc1
  v_cvt_pk_bf16_f32 v56, v84, v85
  v_cvt_pk_bf16_f32 v57, v88, v89
  v_cvt_pk_bf16_f32 v58, v92, v93
  v_cvt_pk_bf16_f32 v59, v96, v97
  buffer_store_dwordx4 v[56:59], v217, s[8:11], s64 offen offset:0 sc1
  v_cvt_pk_bf16_f32 v60, v86, v87
  v_cvt_pk_bf16_f32 v61, v90, v91
  v_cvt_pk_bf16_f32 v62, v94, v95
  v_cvt_pk_bf16_f32 v63, v98, v99
  buffer_store_dwordx4 v[60:63], v217, s[8:11], s64 offen offset:256 sc1
  buffer_store_dwordx4 v[64:67], v201, s[8:11], s73 offen sc1
  s_branch KV_fin
KV_done0:
  s_nop 11
  v_mul_f32 v0, s68, v0
  v_mul_f32 v1, s68, v1
  v_mul_f32 v2, s68, v2
  v_mul_f32 v3, s68, v3
  v_mul_f32 v4, s68, v4
  v_mul_f32 v5, s68, v5
  v_mul_f32 v6, s68, v6
  v_mul_f32 v7, s68, v7
  v_cvt_pk_bf16_f32 v48, v0, v4
  v_cvt_pk_bf16_f32 v49, v1, v5
  v_cvt_pk_bf16_f32 v50, v2, v6
  v_cvt_pk_bf16_f32 v51, v3, v7
  buffer_store_dwordx4 v[48:51], v216, s[8:11], s72 offen offset:0 sc1
  v_mul_f32 v8, s68, v8
  v_mul_f32 v9, s68, v9
  v_mul_f32 v10, s68, v10
  v_mul_f32 v11, s68, v11
  v_mul_f32 v12, s68, v12
  v_mul_f32 v13, s68, v13
  v_mul_f32 v14, s68, v14
  v_mul_f32 v15, s68, v15
  v_cvt_pk_bf16_f32 v52, v8, v12
  v_cvt_pk_bf16_f32 v53, v9, v13
  v_cvt_pk_bf16_f32 v54, v10, v14
  v_cvt_pk_bf16_f32 v55, v11, v15
  buffer_store_dwordx4 v[52:55], v216, s[8:11], s72 offen offset:256 sc1
  v_cvt_pk_bf16_f32 v56, v16, v17
  v_cvt_pk_bf16_f32 v57, v20, v21
  v_cvt_pk_bf16_f32 v58, v24, v25
  v_cvt_pk_bf16_f32 v59, v28, v29
  buffer_store_dwordx4 v[56:59], v217, s[8:11], s64 offen offset:0 sc1
  v_cvt_pk_bf16_f32 v60, v18, v19
  v_cvt_pk_bf16_f32 v61, v22, v23
  v_cvt_pk_bf16_f32 v62, v26, v27
  v_cvt_pk_bf16_f32 v63, v30, v31
  buffer_store_dwordx4 v[60:63], v217, s[8:11], s64 offen offset:256 sc1
  buffer_store_dwordx4 v[64:67], v201, s[8:11], s73 offen sc1
KV_fin:
  s_waitcnt vmcnt(0)
  s_barrier
  s_cmp_eq_u32 s52, 0
  s_cbranch_scc0 KV_sig
  v_mov_b32 v211, 256
  v_mov_b32 v212, 0
  s_mov_b64 exec, 1
  buffer_atomic_add v211, v212, s[12:15], s70 offen
  s_mov_b64 exec, -1
KV_sig:
  s_cmp_ge_u32 s53, 192
  s_cbranch_scc1 L_exit
  s_cmp_lt_u32 s53, 64
  s_cbranch_scc1 W_h
  s_sub_u32 s54, s53, 64
  s_lshr_b32 s68, s54, 4
  s_and_b32 s69, s54, 15
  s_lshl_b32 s60, s69, 2
  s_sub_u32 s60, s60, 1
  s_max_i32 s60, s60, 0
  s_mul_i32 s60, s60, 36864
  s_add_u32 m0, s67, 0
  s_nop 0
  buffer_load_dwordx4 v202, s[4:7], s60 offen offset:0 lds
  s_add_u32 m0, s67, 896
  s_nop 0
  buffer_load_dwordx4 v202, s[4:7], s60 offen offset:128 lds
  s_add_u32 m0, s67, 1792
  s_nop 0
  buffer_load_dwordx4 v202, s[4:7], s60 offen offset:256 lds
  s_add_u32 m0, s67, 2688
  s_nop 0
  buffer_load_dwordx4 v202, s[4:7], s60 offen offset:384 lds
  s_add_u32 m0, s67, 3584
  s_nop 0
  buffer_load_dwordx4 v202, s[4:7], s60 offen offset:512 lds
  s_add_u32 m0, s67, 4480
  s_nop 0
  buffer_load_dwordx4 v202, s[4:7], s60 offen offset:640 lds
  s_add_u32 m0, s67, 5376
  s_nop 0
  buffer_load_dwordx4 v202, s[4:7], s60 offen offset:768 lds
  s_add_u32 m0, s67, 6272
  s_nop 0
  buffer_load_dwordx4 v202, s[4:7], s60 offen offset:896 lds
  s_add_u32 m0, s67, 7168
  s_nop 0
  buffer_load_dwordx4 v202, s[4:7], s60 offen offset:1024 lds
  v_and_b32 v211, 15, v200
  v_mul_u32_u24 v211, 72, v211
  v_lshrrev_b32 v212, 4, v200
  v_mul_u32_u24 v213, 1152, v212
  v_add_u32 v213, v213, v211
  s_lshl_b32 s54, s54, 2
  s_add_u32 s70, s54, s52
  s_mul_i32 s55, s70, 4608
  buffer_load_dwordx4 v[48:51], v213, s[4:7], s55 offen offset:0
  buffer_load_dwordx4 v[52:55], v213, s[4:7], s55 offen offset:16
  buffer_load_dwordx4 v[56:59], v213, s[4:7], s55 offen offset:32
  buffer_load_dwordx4 v[60:63], v213, s[4:7], s55 offen offset:48
  buffer_load_dwordx2 v[64:65], v213, s[4:7], s55 offen offset:64
  buffer_load_dwordx4 v[68:71], v211, s[44:47], 0 offen offset:0
  buffer_load_dwordx4 v[72:75], v211, s[44:47], 0 offen offset:16
  buffer_load_dwordx4 v[76:79], v211, s[44:47], 0 offen offset:32
  buffer_load_dwordx4 v[80:83], v211, s[44:47], 0 offen offset:48
  buffer_load_dwordx2 v[84:85], v211, s[44:47], 0 offen offset:64
  v_mov_b32 v0, 0
  v_mov_b32 v1, 0x3f803f80
  s_waitcnt vmcnt(9)
  v_lshlrev_b32 v2, 16, v48
  s_waitcnt vmcnt(4)
  v_lshlrev_b32 v3, 16, v68
  v_and_b32 v4, 0xffff0000, v48
  v_and_b32 v5, 0xffff0000, v68
  v_mul_f32 v2, v2, v3
  v_mul_f32 v4, v4, v5
  v_cvt_pk_bf16_f32 v2, v2, v4
  v_lshlrev_b32 v3, 16, v2
  v_and_b32 v4, 0xffff0000, v2
  v_add_f32 v0, v0, v3
  v_add_f32 v0, v0, v4
  v_lshlrev_b32 v2, 16, v49
  v_lshlrev_b32 v3, 16, v69
  v_and_b32 v4, 0xffff0000, v49
  v_and_b32 v5, 0xffff0000, v69
  v_mul_f32 v2, v2, v3
  v_mul_f32 v4, v4, v5
  v_cvt_pk_bf16_f32 v2, v2, v4
  v_lshlrev_b32 v3, 16, v2
  v_and_b32 v4, 0xffff0000, v2
  v_add_f32 v0, v0, v3
  v_add_f32 v0, v0, v4
  v_lshlrev_b32 v2, 16, v50
  v_lshlrev_b32 v3, 16, v70
  v_and_b32 v4, 0xffff0000, v50
  v_and_b32 v5, 0xffff0000, v70
  v_mul_f32 v2, v2, v3
  v_mul_f32 v4, v4, v5
  v_cvt_pk_bf16_f32 v2, v2, v4
  v_lshlrev_b32 v3, 16, v2
  v_and_b32 v4, 0xffff0000, v2
  v_add_f32 v0, v0, v3
  v_add_f32 v0, v0, v4
  v_lshlrev_b32 v2, 16, v51
  v_lshlrev_b32 v3, 16, v71
  v_and_b32 v4, 0xffff0000, v51
  v_and_b32 v5, 0xffff0000, v71
  v_mul_f32 v2, v2, v3
  v_mul_f32 v4, v4, v5
  v_cvt_pk_bf16_f32 v2, v2, v4
  v_lshlrev_b32 v3, 16, v2
  v_and_b32 v4, 0xffff0000, v2
  v_add_f32 v0, v0, v3
  v_add_f32 v0, v0, v4
  v_lshlrev_b32 v2, 16, v52
  s_waitcnt vmcnt(3)
  v_lshlrev_b32 v3, 16, v72
  v_and_b32 v4, 0xffff0000, v52
  v_and_b32 v5, 0xffff0000, v72
  v_mul_f32 v2, v2, v3
  v_mul_f32 v4, v4, v5
  v_cvt_pk_bf16_f32 v2, v2, v4
  v_lshlrev_b32 v3, 16, v2
  v_and_b32 v4, 0xffff0000, v2
  v_add_f32 v0, v0, v3
  v_add_f32 v0, v0, v4
  v_lshlrev_b32 v2, 16, v53
  v_lshlrev_b32 v3, 16, v73
  v_and_b32 v4, 0xffff0000, v53
  v_and_b32 v5, 0xffff0000, v73
  v_mul_f32 v2, v2, v3
  v_mul_f32 v4, v4, v5
  v_cvt_pk_bf16_f32 v2, v2, v4
  v_lshlrev_b32 v3, 16, v2
  v_and_b32 v4, 0xffff0000, v2
  v_add_f32 v0, v0, v3
  v_add_f32 v0, v0, v4
  v_lshlrev_b32 v2, 16, v54
  v_lshlrev_b32 v3, 16, v74
  v_and_b32 v4, 0xffff0000, v54
  v_and_b32 v5, 0xffff0000, v74
  v_mul_f32 v2, v2, v3
  v_mul_f32 v4, v4, v5
  v_cvt_pk_bf16_f32 v2, v2, v4
  v_lshlrev_b32 v3, 16, v2
  v_and_b32 v4, 0xffff0000, v2
  v_add_f32 v0, v0, v3
  v_add_f32 v0, v0, v4
  v_lshlrev_b32 v2, 16, v55
  v_lshlrev_b32 v3, 16, v75
  v_and_b32 v4, 0xffff0000, v55
  v_and_b32 v5, 0xffff0000, v75
  v_mul_f32 v2, v2, v3
  v_mul_f32 v4, v4, v5
  v_cvt_pk_bf16_f32 v2, v2, v4
  v_lshlrev_b32 v3, 16, v2
  v_and_b32 v4, 0xffff0000, v2
  v_add_f32 v0, v0, v3
  v_add_f32 v0, v0, v4
  v_lshlrev_b32 v2, 16, v56
  s_waitcnt vmcnt(2)
  v_lshlrev_b32 v3, 16, v76
  v_and_b32 v4, 0xffff0000, v56
  v_and_b32 v5, 0xffff0000, v76
  v_mul_f32 v2, v2, v3
  v_mul_f32 v4, v4, v5
  v_cvt_pk_bf16_f32 v2, v2, v4
  v_lshlrev_b32 v3, 16, v2
  v_and_b32 v4, 0xffff0000, v2
  v_add_f32 v0, v0, v3
  v_add_f32 v0, v0, v4
  v_lshlrev_b32 v2, 16, v57
  v_lshlrev_b32 v3, 16, v77
  v_and_b32 v4, 0xffff0000, v57
  v_and_b32 v5, 0xffff0000, v77
  v_mul_f32 v2, v2, v3
  v_mul_f32 v4, v4, v5
  v_cvt_pk_bf16_f32 v2, v2, v4
  v_lshlrev_b32 v3, 16, v2
  v_and_b32 v4, 0xffff0000, v2
  v_add_f32 v0, v0, v3
  v_add_f32 v0, v0, v4
  v_lshlrev_b32 v2, 16, v58
  v_lshlrev_b32 v3, 16, v78
  v_and_b32 v4, 0xffff0000, v58
  v_and_b32 v5, 0xffff0000, v78
  v_mul_f32 v2, v2, v3
  v_mul_f32 v4, v4, v5
  v_cvt_pk_bf16_f32 v2, v2, v4
  v_lshlrev_b32 v3, 16, v2
  v_and_b32 v4, 0xffff0000, v2
  v_add_f32 v0, v0, v3
  v_add_f32 v0, v0, v4
  v_lshlrev_b32 v2, 16, v59
  v_lshlrev_b32 v3, 16, v79
  v_and_b32 v4, 0xffff0000, v59
  v_and_b32 v5, 0xffff0000, v79
  v_mul_f32 v2, v2, v3
  v_mul_f32 v4, v4, v5
  v_cvt_pk_bf16_f32 v2, v2, v4
  v_lshlrev_b32 v3, 16, v2
  v_and_b32 v4, 0xffff0000, v2
  v_add_f32 v0, v0, v3
  v_add_f32 v0, v0, v4
  v_lshlrev_b32 v2, 16, v60
  s_waitcnt vmcnt(1)
  v_lshlrev_b32 v3, 16, v80
  v_and_b32 v4, 0xffff0000, v60
  v_and_b32 v5, 0xffff0000, v80
  v_mul_f32 v2, v2, v3
  v_mul_f32 v4, v4, v5
  v_cvt_pk_bf16_f32 v2, v2, v4
  v_lshlrev_b32 v3, 16, v2
  v_and_b32 v4, 0xffff0000, v2
  v_add_f32 v0, v0, v3
  v_add_f32 v0, v0, v4
  v_lshlrev_b32 v2, 16, v61
  v_lshlrev_b32 v3, 16, v81
  v_and_b32 v4, 0xffff0000, v61
  v_and_b32 v5, 0xffff0000, v81
  v_mul_f32 v2, v2, v3
  v_mul_f32 v4, v4, v5
  v_cvt_pk_bf16_f32 v2, v2, v4
  v_lshlrev_b32 v3, 16, v2
  v_and_b32 v4, 0xffff0000, v2
  v_add_f32 v0, v0, v3
  v_add_f32 v0, v0, v4
  v_lshlrev_b32 v2, 16, v62
  v_lshlrev_b32 v3, 16, v82
  v_and_b32 v4, 0xffff0000, v62
  v_and_b32 v5, 0xffff0000, v82
  v_mul_f32 v2, v2, v3
  v_mul_f32 v4, v4, v5
  v_cvt_pk_bf16_f32 v2, v2, v4
  v_lshlrev_b32 v3, 16, v2
  v_and_b32 v4, 0xffff0000, v2
  v_add_f32 v0, v0, v3
  v_add_f32 v0, v0, v4
  v_lshlrev_b32 v2, 16, v63
  v_lshlrev_b32 v3, 16, v83
  v_and_b32 v4, 0xffff0000, v63
  v_and_b32 v5, 0xffff0000, v83
  v_mul_f32 v2, v2, v3
  v_mul_f32 v4, v4, v5
  v_cvt_pk_bf16_f32 v2, v2, v4
  v_lshlrev_b32 v3, 16, v2
  v_and_b32 v4, 0xffff0000, v2
  v_add_f32 v0, v0, v3
  v_add_f32 v0, v0, v4
  v_lshlrev_b32 v2, 16, v64
  s_waitcnt vmcnt(0)
  v_lshlrev_b32 v3, 16, v84
  v_and_b32 v4, 0xffff0000, v64
  v_and_b32 v5, 0xffff0000, v84
  v_mul_f32 v2, v2, v3
  v_mul_f32 v4, v4, v5
  v_cvt_pk_bf16_f32 v2, v2, v4
  v_lshlrev_b32 v3, 16, v2
  v_and_b32 v4, 0xffff0000, v2
  v_add_f32 v0, v0, v3
  v_add_f32 v0, v0, v4
  v_lshlrev_b32 v2, 16, v65
  v_lshlrev_b32 v3, 16, v85
  v_and_b32 v4, 0xffff0000, v65
  v_and_b32 v5, 0xffff0000, v85
  v_mul_f32 v2, v2, v3
  v_mul_f32 v4, v4, v5
  v_cvt_pk_bf16_f32 v2, v2, v4
  v_lshlrev_b32 v3, 16, v2
  v_and_b32 v4, 0xffff0000, v2
  v_add_f32 v0, v0, v3
  v_add_f32 v0, v0, v4
  s_nop 1
  v_add_f32_dpp v0, v0, v0 row_ror:1 row_mask:0xf bank_mask:0xf
  s_nop 1
  v_add_f32_dpp v0, v0, v0 row_ror:2 row_mask:0xf bank_mask:0xf
  s_nop 1
  v_add_f32_dpp v0, v0, v0 row_ror:4 row_mask:0xf bank_mask:0xf
  s_nop 1
  v_add_f32_dpp v0, v0, v0 row_ror:8 row_mask:0xf bank_mask:0xf
  v_cvt_pk_bf16_f32 v0, v0, v0
  v_lshlrev_b32 v0, 16, v0
  v_mul_f32 v0, 3216550459, v0
  v_exp_f32 v0, v0
  s_nop 0
  v_add_f32 v0, 1.0, v0
  v_rcp_f32 v0, v0
  s_nop 0
  v_cvt_pk_bf16_f32 v0, v0, v0
  v_lshlrev_b32 v0, 16, v0
  v_lshlrev_b32 v212, 2, v212
  s_lshl_b32 s55, s70, 4
  s_add_u32 s55, s55, 66060288
  s_mov_b32 exec_lo, 0x00010001
  s_mov_b32 exec_hi, 0x00010001
  buffer_store_dword v0, v212, s[8:11], s55 offen sc1
  s_mov_b64 exec, -1
  v_lshrrev_b32 v211, 4, v200
  v_lshlrev_b32 v212, 2, v211
  v_and_b32 v213, 15, v200
  v_xor_b32 v212, v212, v213
  v_mul_u32_u24 v211, 3456, v211
  v_mov_b32 v2, 0x40000000
  v_add_u32 v213, 0, v212
  v_mul_u32_u24 v214, 57, v213
  v_lshrrev_b32 v214, 9, v214
  v_mul_u32_u24 v214, 1008, v214
  v_lshl_add_u32 v214, v213, 4, v214
  v_add_u32 v214, v214, v211
  v_cmp_lt_u32 vcc, 26, v213
  s_nop 1
  v_cndmask_b32 v207, v214, v2, vcc
  v_add_u32 v213, 16, v212
  v_mul_u32_u24 v214, 57, v213
  v_lshrrev_b32 v214, 9, v214
  v_mul_u32_u24 v214, 1008, v214
  v_lshl_add_u32 v214, v213, 4, v214
  v_add_u32 v214, v214, v211
  v_cmp_lt_u32 vcc, 26, v213
  s_nop 1
  v_cndmask_b32 v208, v214, v2, vcc
  s_mul_i32 s62, s68, 144
  s_mul_i32 s54, s52, 13824
  s_add_u32 s62, s62, s54
  s_waitcnt vmcnt(0)
  s_lshl_b32 s61, s52, 10
  s_add_u32 s61, s61, 36864
  s_add_u32 m0, s61, 0
  s_add_u32 s54, s62, 0
  buffer_load_dwordx4 v207, s[36:39], s54 offen lds
  s_add_u32 m0, s61, 4096
  s_add_u32 s54, s62, 55296
  buffer_load_dwordx4 v207, s[36:39], s54 offen lds
  s_add_u32 m0, s61, 8192
  s_add_u32 s54, s62, 110592
  buffer_load_dwordx4 v207, s[36:39], s54 offen lds
  s_add_u32 m0, s61, 12288
  s_add_u32 s54, s62, 165888
  buffer_load_dwordx4 v207, s[36:39], s54 offen lds
  s_add_u32 m0, s61, 16384
  s_add_u32 s54, s62, 0
  buffer_load_dwordx4 v208, s[36:39], s54 offen lds
  s_add_u32 m0, s61, 20480
  s_add_u32 s54, s62, 55296
  buffer_load_dwordx4 v208, s[36:39], s54 offen lds
  s_add_u32 m0, s61, 24576
  s_add_u32 s54, s62, 110592
  buffer_load_dwordx4 v208, s[36:39], s54 offen lds
  s_add_u32 m0, s61, 28672
  s_add_u32 s54, s62, 165888
  buffer_load_dwordx4 v208, s[36:39], s54 offen lds
  s_add_u32 m0, s61, 32768
  s_add_u32 s54, s62, 221184
  buffer_load_dwordx4 v207, s[36:39], s54 offen lds
  s_add_u32 m0, s61, 36864
  s_add_u32 s54, s62, 276480
  buffer_load_dwordx4 v207, s[36:39], s54 offen lds
  s_add_u32 m0, s61, 40960
  s_add_u32 s54, s62, 331776
  buffer_load_dwordx4 v207, s[36:39], s54 offen lds
  s_add_u32 m0, s61, 45056
  s_add_u32 s54, s62, 387072
  buffer_load_dwordx4 v207, s[36:39], s54 offen lds
  s_add_u32 m0, s61, 49152
  s_add_u32 s54, s62, 221184
  buffer_load_dwordx4 v208, s[36:39], s54 offen lds
  s_add_u32 m0, s61, 53248
  s_add_u32 s54, s62, 276480
  buffer_load_dwordx4 v208, s[36:39], s54 offen lds
  s_add_u32 m0, s61, 57344
  s_add_u32 s54, s62, 331776
  buffer_load_dwordx4 v208, s[36:39], s54 offen lds
  s_add_u32 m0, s61, 61440
  s_add_u32 s54, s62, 387072
  buffer_load_dwordx4 v208, s[36:39], s54 offen lds
  s_add_u32 m0, s61, 65536
  s_add_u32 s54, s62, 442368
  buffer_load_dwordx4 v207, s[36:39], s54 offen lds
  s_add_u32 m0, s61, 69632
  s_add_u32 s54, s62, 497664
  buffer_load_dwordx4 v207, s[36:39], s54 offen lds
  s_add_u32 m0, s61, 73728
  s_add_u32 s54, s62, 552960
  buffer_load_dwordx4 v207, s[36:39], s54 offen lds
  s_add_u32 m0, s61, 77824
  s_add_u32 s54, s62, 608256
  buffer_load_dwordx4 v207, s[36:39], s54 offen lds
  s_add_u32 m0, s61, 81920
  s_add_u32 s54, s62, 442368
  buffer_load_dwordx4 v208, s[36:39], s54 offen lds
  s_add_u32 m0, s61, 86016
  s_add_u32 s54, s62, 497664
  buffer_load_dwordx4 v208, s[36:39], s54 offen lds
  s_add_u32 m0, s61, 90112
  s_add_u32 s54, s62, 552960
  buffer_load_dwordx4 v208, s[36:39], s54 offen lds
  s_add_u32 m0, s61, 94208
  s_add_u32 s54, s62, 608256
  buffer_load_dwordx4 v208, s[36:39], s54 offen lds
  s_waitcnt vmcnt(20) lgkmcnt(0)
  s_barrier
  s_add_u32 m0, s61, 98304
  s_add_u32 s54, s62, 663552
  buffer_load_dwordx4 v207, s[36:39], s54 offen lds
  s_add_u32 m0, s61, 102400
  s_add_u32 s54, s62, 718848
  buffer_load_dwordx4 v207, s[36:39], s54 offen lds
  s_add_u32 m0, s61, 106496
  s_add_u32 s54, s62, 774144
  buffer_load_dwordx4 v207, s[36:39], s54 offen lds
  s_add_u32 m0, s61, 110592
  s_add_u32 s54, s62, 829440
  buffer_load_dwordx4 v207, s[36:39], s54 offen lds
  v_add_u32 v215, 36864, v210
  ds_read_b64_tr_b16 a[0:1], v215 offset:0
  ds_read_b64_tr_b16 a[2:3], v215 offset:1024
  ds_read_b64_tr_b16 a[4:5], v215 offset:4096
  ds_read_b64_tr_b16 a[6:7], v215 offset:5120
  ds_read_b64_tr_b16 a[8:9], v215 offset:8192
  ds_read_b64_tr_b16 a[10:11], v215 offset:9216
  ds_read_b64_tr_b16 a[12:13], v215 offset:12288
  ds_read_b64_tr_b16 a[14:15], v215 offset:13312
  s_waitcnt vmcnt(20) lgkmcnt(0)
  s_barrier
  s_add_u32 m0, s61, 0
  s_add_u32 s54, s62, 663552
  buffer_load_dwordx4 v208, s[36:39], s54 offen lds
  s_add_u32 m0, s61, 4096
  s_add_u32 s54, s62, 718848
  buffer_load_dwordx4 v208, s[36:39], s54 offen lds
  s_add_u32 m0, s61, 8192
  s_add_u32 s54, s62, 774144
  buffer_load_dwordx4 v208, s[36:39], s54 offen lds
  s_add_u32 m0, s61, 12288
  s_add_u32 s54, s62, 829440
  buffer_load_dwordx4 v208, s[36:39], s54 offen lds
  v_add_u32 v215, 53248, v210
  ds_read_b64_tr_b16 a[144:145], v215 offset:0
  ds_read_b64_tr_b16 a[146:147], v215 offset:1024
  ds_read_b64_tr_b16 a[148:149], v215 offset:4096
  ds_read_b64_tr_b16 a[150:151], v215 offset:5120
  ds_read_b64_tr_b16 a[152:153], v215 offset:8192
  ds_read_b64_tr_b16 a[154:155], v215 offset:9216
  ds_read_b64_tr_b16 a[156:157], v215 offset:12288
  ds_read_b64_tr_b16 a[158:159], v215 offset:13312
  s_waitcnt vmcnt(20) lgkmcnt(0)
  s_barrier
  s_add_u32 m0, s61, 16384
  s_add_u32 s54, s62, 884736
  buffer_load_dwordx4 v207, s[36:39], s54 offen lds
  s_add_u32 m0, s61, 20480
  s_add_u32 s54, s62, 940032
  buffer_load_dwordx4 v207, s[36:39], s54 offen lds
  s_add_u32 m0, s61, 24576
  s_add_u32 s54, s62, 995328
  buffer_load_dwordx4 v207, s[36:39], s54 offen lds
  s_add_u32 m0, s61, 28672
  s_add_u32 s54, s62, 1050624
  buffer_load_dwordx4 v207, s[36:39], s54 offen lds
  v_add_u32 v215, 69632, v210
  ds_read_b64_tr_b16 a[16:17], v215 offset:0
  ds_read_b64_tr_b16 a[18:19], v215 offset:1024
  ds_read_b64_tr_b16 a[20:21], v215 offset:4096
  ds_read_b64_tr_b16 a[22:23], v215 offset:5120
  ds_read_b64_tr_b16 a[24:25], v215 offset:8192
  ds_read_b64_tr_b16 a[26:27], v215 offset:9216
  ds_read_b64_tr_b16 a[28:29], v215 offset:12288
  ds_read_b64_tr_b16 a[30:31], v215 offset:13312
  s_waitcnt vmcnt(20) lgkmcnt(0)
  s_barrier
  s_add_u32 m0, s61, 32768
  s_add_u32 s54, s62, 884736
  buffer_load_dwordx4 v208, s[36:39], s54 offen lds
  s_add_u32 m0, s61, 36864
  s_add_u32 s54, s62, 940032
  buffer_load_dwordx4 v208, s[36:39], s54 offen lds
  s_add_u32 m0, s61, 40960
  s_add_u32 s54, s62, 995328
  buffer_load_dwordx4 v208, s[36:39], s54 offen lds
  s_add_u32 m0, s61, 45056
  s_add_u32 s54, s62, 1050624
  buffer_load_dwordx4 v208, s[36:39], s54 offen lds
  v_add_u32 v215, 86016, v210
  ds_read_b64_tr_b16 a[160:161], v215 offset:0
  ds_read_b64_tr_b16 a[162:163], v215 offset:1024
  ds_read_b64_tr_b16 a[164:165], v215 offset:4096
  ds_read_b64_tr_b16 a[166:167], v215 offset:5120
  ds_read_b64_tr_b16 a[168:169], v215 offset:8192
  ds_read_b64_tr_b16 a[170:171], v215 offset:9216
  ds_read_b64_tr_b16 a[172:173], v215 offset:12288
  ds_read_b64_tr_b16 a[174:175], v215 offset:13312
  s_waitcnt vmcnt(20) lgkmcnt(0)
  s_barrier
  s_add_u32 m0, s61, 49152
  s_add_u32 s54, s62, 1105920
  buffer_load_dwordx4 v207, s[36:39], s54 offen lds
  s_add_u32 m0, s61, 53248
  s_add_u32 s54, s62, 1161216
  buffer_load_dwordx4 v207, s[36:39], s54 offen lds
  s_add_u32 m0, s61, 57344
  s_add_u32 s54, s62, 1216512
  buffer_load_dwordx4 v207, s[36:39], s54 offen lds
  s_add_u32 m0, s61, 61440
  s_add_u32 s54, s62, 1271808
  buffer_load_dwordx4 v207, s[36:39], s54 offen lds
  v_add_u32 v215, 102400, v210
  ds_read_b64_tr_b16 a[32:33], v215 offset:0
  ds_read_b64_tr_b16 a[34:35], v215 offset:1024
  ds_read_b64_tr_b16 a[36:37], v215 offset:4096
  ds_read_b64_tr_b16 a[38:39], v215 offset:5120
  ds_read_b64_tr_b16 a[40:41], v215 offset:8192
  ds_read_b64_tr_b16 a[42:43], v215 offset:9216
  ds_read_b64_tr_b16 a[44:45], v215 offset:12288
  ds_read_b64_tr_b16 a[46:47], v215 offset:13312
  s_waitcnt vmcnt(20) lgkmcnt(0)
  s_barrier
  s_add_u32 m0, s61, 65536
  s_add_u32 s54, s62, 1105920
  buffer_load_dwordx4 v208, s[36:39], s54 offen lds
  s_add_u32 m0, s61, 69632
  s_add_u32 s54, s62, 1161216
  buffer_load_dwordx4 v208, s[36:39], s54 offen lds
  s_add_u32 m0, s61, 73728
  s_add_u32 s54, s62, 1216512
  buffer_load_dwordx4 v208, s[36:39], s54 offen lds
  s_add_u32 m0, s61, 77824
  s_add_u32 s54, s62, 1271808
  buffer_load_dwordx4 v208, s[36:39], s54 offen lds
  v_add_u32 v215, 118784, v210
  ds_read_b64_tr_b16 a[176:177], v215 offset:0
  ds_read_b64_tr_b16 a[178:179], v215 offset:1024
  ds_read_b64_tr_b16 a[180:181], v215 offset:4096
  ds_read_b64_tr_b16 a[182:183], v215 offset:5120
  ds_read_b64_tr_b16 a[184:185], v215 offset:8192
  ds_read_b64_tr_b16 a[186:187], v215 offset:9216
  ds_read_b64_tr_b16 a[188:189], v215 offset:12288
  ds_read_b64_tr_b16 a[190:191], v215 offset:13312
  s_waitcnt vmcnt(20) lgkmcnt(0)
  s_barrier
  s_add_u32 m0, s61, 81920
  s_add_u32 s54, s62, 1327104
  buffer_load_dwordx4 v207, s[36:39], s54 offen lds
  s_add_u32 m0, s61, 86016
  s_add_u32 s54, s62, 1382400
  buffer_load_dwordx4 v207, s[36:39], s54 offen lds
  s_add_u32 m0, s61, 90112
  s_add_u32 s54, s62, 1437696
  buffer_load_dwordx4 v207, s[36:39], s54 offen lds
  s_add_u32 m0, s61, 94208
  s_add_u32 s54, s62, 1492992
  buffer_load_dwordx4 v207, s[36:39], s54 offen lds
  v_add_u32 v215, 135168, v210
  ds_read_b64_tr_b16 a[48:49], v215 offset:0
  ds_read_b64_tr_b16 a[50:51], v215 offset:1024
  ds_read_b64_tr_b16 a[52:53], v215 offset:4096
  ds_read_b64_tr_b16 a[54:55], v215 offset:5120
  ds_read_b64_tr_b16 a[56:57], v215 offset:8192
  ds_read_b64_tr_b16 a[58:59], v215 offset:9216
  ds_read_b64_tr_b16 a[60:61], v215 offset:12288
  ds_read_b64_tr_b16 a[62:63], v215 offset:13312
  s_waitcnt vmcnt(20) lgkmcnt(0)
  s_barrier
  s_add_u32 m0, s61, 98304
  s_add_u32 s54, s62, 1327104
  buffer_load_dwordx4 v208, s[36:39], s54 offen lds
  s_add_u32 m0, s61, 102400
  s_add_u32 s54, s62, 1382400
  buffer_load_dwordx4 v208, s[36:39], s54 offen lds
  s_add_u32 m0, s61, 106496
  s_add_u32 s54, s62, 1437696
  buffer_load_dwordx4 v208, s[36:39], s54 offen lds
  s_add_u32 m0, s61, 110592
  s_add_u32 s54, s62, 1492992
  buffer_load_dwordx4 v208, s[36:39], s54 offen lds
  v_add_u32 v215, 36864, v210
  ds_read_b64_tr_b16 a[192:193], v215 offset:0
  ds_read_b64_tr_b16 a[194:195], v215 offset:1024
  ds_read_b64_tr_b16 a[196:197], v215 offset:4096
  ds_read_b64_tr_b16 a[198:199], v215 offset:5120
  ds_read_b64_tr_b16 a[200:201], v215 offset:8192
  ds_read_b64_tr_b16 a[202:203], v215 offset:9216
  ds_read_b64_tr_b16 a[204:205], v215 offset:12288
  ds_read_b64_tr_b16 a[206:207], v215 offset:13312
  s_waitcnt vmcnt(20) lgkmcnt(0)
  s_barrier
  s_add_u32 m0, s61, 0
  s_add_u32 s54, s62, 1548288
  buffer_load_dwordx4 v207, s[36:39], s54 offen lds
  s_add_u32 m0, s61, 4096
  s_add_u32 s54, s62, 1603584
  buffer_load_dwordx4 v207, s[36:39], s54 offen lds
  s_add_u32 m0, s61, 8192
  s_add_u32 s54, s62, 1658880
  buffer_load_dwordx4 v207, s[36:39], s54 offen lds
  s_add_u32 m0, s61, 12288
  s_add_u32 s54, s62, 1714176
  buffer_load_dwordx4 v207, s[36:39], s54 offen lds
  v_add_u32 v215, 53248, v210
  ds_read_b64_tr_b16 a[64:65], v215 offset:0
  ds_read_b64_tr_b16 a[66:67], v215 offset:1024
  ds_read_b64_tr_b16 a[68:69], v215 offset:4096
  ds_read_b64_tr_b16 a[70:71], v215 offset:5120
  ds_read_b64_tr_b16 a[72:73], v215 offset:8192
  ds_read_b64_tr_b16 a[74:75], v215 offset:9216
  ds_read_b64_tr_b16 a[76:77], v215 offset:12288
  ds_read_b64_tr_b16 a[78:79], v215 offset:13312
  s_waitcnt vmcnt(20) lgkmcnt(0)
  s_barrier
  s_add_u32 m0, s61, 16384
  s_add_u32 s54, s62, 1548288
  buffer_load_dwordx4 v208, s[36:39], s54 offen lds
  s_add_u32 m0, s61, 20480
  s_add_u32 s54, s62, 1603584
  buffer_load_dwordx4 v208, s[36:39], s54 offen lds
  s_add_u32 m0, s61, 24576
  s_add_u32 s54, s62, 1658880
  buffer_load_dwordx4 v208, s[36:39], s54 offen lds
  s_add_u32 m0, s61, 28672
  s_add_u32 s54, s62, 1714176
  buffer_load_dwordx4 v208, s[36:39], s54 offen lds
  v_add_u32 v215, 69632, v210
  ds_read_b64_tr_b16 a[208:209], v215 offset:0
  ds_read_b64_tr_b16 a[210:211], v215 offset:1024
  ds_read_b64_tr_b16 a[212:213], v215 offset:4096
  ds_read_b64_tr_b16 a[214:215], v215 offset:5120
  ds_read_b64_tr_b16 a[216:217], v215 offset:8192
  ds_read_b64_tr_b16 a[218:219], v215 offset:9216
  ds_read_b64_tr_b16 a[220:221], v215 offset:12288
  ds_read_b64_tr_b16 a[222:223], v215 offset:13312
  s_waitcnt vmcnt(20) lgkmcnt(0)
  s_barrier
  s_add_u32 m0, s61, 32768
  s_add_u32 s54, s62, 1769472
  buffer_load_dwordx4 v207, s[36:39], s54 offen lds
  s_add_u32 m0, s61, 36864
  s_add_u32 s54, s62, 1824768
  buffer_load_dwordx4 v207, s[36:39], s54 offen lds
  s_add_u32 m0, s61, 40960
  s_add_u32 s54, s62, 1880064
  buffer_load_dwordx4 v207, s[36:39], s54 offen lds
  s_add_u32 m0, s61, 45056
  s_add_u32 s54, s62, 1935360
  buffer_load_dwordx4 v207, s[36:39], s54 offen lds
  v_add_u32 v215, 86016, v210
  ds_read_b64_tr_b16 a[80:81], v215 offset:0
  ds_read_b64_tr_b16 a[82:83], v215 offset:1024
  ds_read_b64_tr_b16 a[84:85], v215 offset:4096
  ds_read_b64_tr_b16 a[86:87], v215 offset:5120
  ds_read_b64_tr_b16 a[88:89], v215 offset:8192
  ds_read_b64_tr_b16 a[90:91], v215 offset:9216
  ds_read_b64_tr_b16 a[92:93], v215 offset:12288
  ds_read_b64_tr_b16 a[94:95], v215 offset:13312
  s_waitcnt vmcnt(20) lgkmcnt(0)
  s_barrier
  s_add_u32 m0, s61, 49152
  s_add_u32 s54, s62, 1769472
  buffer_load_dwordx4 v208, s[36:39], s54 offen lds
  s_add_u32 m0, s61, 53248
  s_add_u32 s54, s62, 1824768
  buffer_load_dwordx4 v208, s[36:39], s54 offen lds
  s_add_u32 m0, s61, 57344
  s_add_u32 s54, s62, 1880064
  buffer_load_dwordx4 v208, s[36:39], s54 offen lds
  s_add_u32 m0, s61, 61440
  s_add_u32 s54, s62, 1935360
  buffer_load_dwordx4 v208, s[36:39], s54 offen lds
  v_add_u32 v215, 102400, v210
  ds_read_b64_tr_b16 a[224:225], v215 offset:0
  ds_read_b64_tr_b16 a[226:227], v215 offset:1024
  ds_read_b64_tr_b16 a[228:229], v215 offset:4096
  ds_read_b64_tr_b16 a[230:231], v215 offset:5120
  ds_read_b64_tr_b16 a[232:233], v215 offset:8192
  ds_read_b64_tr_b16 a[234:235], v215 offset:9216
  ds_read_b64_tr_b16 a[236:237], v215 offset:12288
  ds_read_b64_tr_b16 a[238:239], v215 offset:13312
  s_waitcnt vmcnt(20) lgkmcnt(0)
  s_barrier
  v_add_u32 v215, 118784, v210
  ds_read_b64_tr_b16 a[96:97], v215 offset:0
  ds_read_b64_tr_b16 a[98:99], v215 offset:1024
  ds_read_b64_tr_b16 a[100:101], v215 offset:4096
  ds_read_b64_tr_b16 a[102:103], v215 offset:5120
  ds_read_b64_tr_b16 a[104:105], v215 offset:8192
  ds_read_b64_tr_b16 a[106:107], v215 offset:9216
  ds_read_b64_tr_b16 a[108:109], v215 offset:12288
  ds_read_b64_tr_b16 a[110:111], v215 offset:13312
  s_waitcnt vmcnt(16) lgkmcnt(0)
  s_barrier
  v_add_u32 v215, 135168, v210
  ds_read_b64_tr_b16 a[240:241], v215 offset:0
  ds_read_b64_tr_b16 a[242:243], v215 offset:1024
  ds_read_b64_tr_b16 a[244:245], v215 offset:4096
  ds_read_b64_tr_b16 a[246:247], v215 offset:5120
  ds_read_b64_tr_b16 a[248:249], v215 offset:8192
  ds_read_b64_tr_b16 a[250:251], v215 offset:9216
  ds_read_b64_tr_b16 a[252:253], v215 offset:12288
  ds_read_b64_tr_b16 a[254:255], v215 offset:13312
  s_waitcnt vmcnt(12) lgkmcnt(0)
  s_barrier
  v_add_u32 v215, 36864, v210
  ds_read_b64_tr_b16 a[112:113], v215 offset:0
  ds_read_b64_tr_b16 a[114:115], v215 offset:1024
  ds_read_b64_tr_b16 a[116:117], v215 offset:4096
  ds_read_b64_tr_b16 a[118:119], v215 offset:5120
  ds_read_b64_tr_b16 a[120:121], v215 offset:8192
  ds_read_b64_tr_b16 a[122:123], v215 offset:9216
  ds_read_b64_tr_b16 a[124:125], v215 offset:12288
  ds_read_b64_tr_b16 a[126:127], v215 offset:13312
  s_waitcnt vmcnt(8) lgkmcnt(0)
  s_barrier
  v_add_u32 v215, 53248, v210
  ds_read_b64_tr_b16 v[224:225], v215 offset:0
  ds_read_b64_tr_b16 v[226:227], v215 offset:1024
  ds_read_b64_tr_b16 v[228:229], v215 offset:4096
  ds_read_b64_tr_b16 v[230:231], v215 offset:5120
  ds_read_b64_tr_b16 v[232:233], v215 offset:8192
  ds_read_b64_tr_b16 v[234:235], v215 offset:9216
  ds_read_b64_tr_b16 v[236:237], v215 offset:12288
  ds_read_b64_tr_b16 v[238:239], v215 offset:13312
  s_waitcnt vmcnt(4) lgkmcnt(0)
  s_barrier
  v_add_u32 v215, 69632, v210
  ds_read_b64_tr_b16 a[128:129], v215 offset:0
  ds_read_b64_tr_b16 a[130:131], v215 offset:1024
  ds_read_b64_tr_b16 a[132:133], v215 offset:4096
  ds_read_b64_tr_b16 a[134:135], v215 offset:5120
  ds_read_b64_tr_b16 a[136:137], v215 offset:8192
  ds_read_b64_tr_b16 a[138:139], v215 offset:9216
  ds_read_b64_tr_b16 a[140:141], v215 offset:12288
  ds_read_b64_tr_b16 a[142:143], v215 offset:13312
  s_waitcnt vmcnt(0) lgkmcnt(0)
  s_barrier
  v_add_u32 v215, 86016, v210
  ds_read_b64_tr_b16 v[240:241], v215 offset:0
  ds_read_b64_tr_b16 v[242:243], v215 offset:1024
  ds_read_b64_tr_b16 v[244:245], v215 offset:4096
  ds_read_b64_tr_b16 v[246:247], v215 offset:5120
  ds_read_b64_tr_b16 v[248:249], v215 offset:8192
  ds_read_b64_tr_b16 v[250:251], v215 offset:9216
  ds_read_b64_tr_b16 v[252:253], v215 offset:12288
  ds_read_b64_tr_b16 v[254:255], v215 offset:13312
  s_waitcnt lgkmcnt(0)
  s_barrier
  v_and_b32 v211, 31, v200
  v_mul_u32_u24 v218, 516, v211
  v_lshrrev_b32 v212, 5, v200
  v_lshl_add_u32 v218, v212, 3, v218
  s_lshl_b32 s54, s52, 6
  s_add_u32 s54, s54, 73728
  v_add_u32 v218, s54, v218
  s_lshl_b32 s60, s69, 2
  s_mul_i32 s60, s60, 36864
  ds_read_b128 v[32:35], v203 offset:0
  ds_read_b128 v[36:39], v204 offset:0
  ds_read_b128 v[40:43], v205 offset:0
  s_waitcnt lgkmcnt(2)
  v_mfma_f32_32x32x16_bf16 v[0:15], a[0:3], v[32:35], 0
  ds_read_b128 v[44:47], v206 offset:0
  s_add_u32 m0, s67, 36864
  s_nop 0
  buffer_load_dwordx4 v202, s[4:7], s60 offen offset:0 lds
  v_mfma_f32_32x32x16_bf16 v[16:31], a[144:147], v[32:35], 0
  s_waitcnt lgkmcnt(2)
  v_mfma_f32_32x32x16_bf16 v[0:15], a[4:7], v[36:39], v[0:15]
  ds_read_b128 v[32:35], v203 offset:1024
  s_add_u32 m0, s67, 37760
  s_nop 0
  buffer_load_dwordx4 v202, s[4:7], s60 offen offset:128 lds
  v_mfma_f32_32x32x16_bf16 v[16:31], a[148:151], v[36:39], v[16:31]
  s_waitcnt lgkmcnt(2)
  v_mfma_f32_32x32x16_bf16 v[0:15], a[8:11], v[40:43], v[0:15]
  ds_read_b128 v[36:39], v204 offset:1024
  s_add_u32 m0, s67, 38656
  s_nop 0
  buffer_load_dwordx4 v202, s[4:7], s60 offen offset:256 lds
  v_mfma_f32_32x32x16_bf16 v[16:31], a[152:155], v[40:43], v[16:31]
  s_waitcnt lgkmcnt(2)
  v_mfma_f32_32x32x16_bf16 v[0:15], a[12:15], v[44:47], v[0:15]
  ds_read_b128 v[40:43], v205 offset:1024
  s_add_u32 m0, s67, 39552
  s_nop 0
  buffer_load_dwordx4 v202, s[4:7], s60 offen offset:384 lds
  v_mfma_f32_32x32x16_bf16 v[16:31], a[156:159], v[44:47], v[16:31]
  s_waitcnt lgkmcnt(2)
  v_mfma_f32_32x32x16_bf16 v[0:15], a[16:19], v[32:35], v[0:15]
  ds_read_b128 v[44:47], v206 offset:1024
  s_add_u32 m0, s67, 40448
  s_nop 0
  buffer_load_dwordx4 v202, s[4:7], s60 offen offset:512 lds
  v_mfma_f32_32x32x16_bf16 v[16:31], a[160:163], v[32:35], v[16:31]
  s_waitcnt lgkmcnt(2)
  v_mfma_f32_32x32x16_bf16 v[0:15], a[20:23], v[36:39], v[0:15]
  ds_read_b128 v[32:35], v203 offset:2048
  s_add_u32 m0, s67, 41344
  s_nop 0
  buffer_load_dwordx4 v202, s[4:7], s60 offen offset:640 lds
  v_mfma_f32_32x32x16_bf16 v[16:31], a[164:167], v[36:39], v[16:31]
  s_waitcnt lgkmcnt(2)
  v_mfma_f32_32x32x16_bf16 v[0:15], a[24:27], v[40:43], v[0:15]
  ds_read_b128 v[36:39], v204 offset:2048
  s_add_u32 m0, s67, 42240
  s_nop 0
  buffer_load_dwordx4 v202, s[4:7], s60 offen offset:768 lds
  v_mfma_f32_32x32x16_bf16 v[16:31], a[168:171], v[40:43], v[16:31]
  s_waitcnt lgkmcnt(2)
  v_mfma_f32_32x32x16_bf16 v[0:15], a[28:31], v[44:47], v[0:15]
  ds_read_b128 v[40:43], v205 offset:2048
  s_add_u32 m0, s67, 43136
  s_nop 0
  buffer_load_dwordx4 v202, s[4:7], s60 offen offset:896 lds
  v_mfma_f32_32x32x16_bf16 v[16:31], a[172:175], v[44:47], v[16:31]
  s_waitcnt lgkmcnt(2)
  v_mfma_f32_32x32x16_bf16 v[0:15], a[32:35], v[32:35], v[0:15]
  ds_read_b128 v[44:47], v206 offset:2048
  s_add_u32 m0, s67, 44032
  s_nop 0
  buffer_load_dwordx4 v202, s[4:7], s60 offen offset:1024 lds
  v_mfma_f32_32x32x16_bf16 v[16:31], a[176:179], v[32:35], v[16:31]
  s_waitcnt lgkmcnt(2)
  v_mfma_f32_32x32x16_bf16 v[0:15], a[36:39], v[36:39], v[0:15]
  ds_read_b128 v[32:35], v203 offset:3072
  v_mfma_f32_32x32x16_bf16 v[16:31], a[180:183], v[36:39], v[16:31]
  s_waitcnt lgkmcnt(2)
  v_mfma_f32_32x32x16_bf16 v[0:15], a[40:43], v[40:43], v[0:15]
  ds_read_b128 v[36:39], v204 offset:3072
  v_mfma_f32_32x32x16_bf16 v[16:31], a[184:187], v[40:43], v[16:31]
  s_waitcnt lgkmcnt(2)
  v_mfma_f32_32x32x16_bf16 v[0:15], a[44:47], v[44:47], v[0:15]
  ds_read_b128 v[40:43], v205 offset:3072
  v_mfma_f32_32x32x16_bf16 v[16:31], a[188:191], v[44:47], v[16:31]
  s_waitcnt lgkmcnt(2)
  v_mfma_f32_32x32x16_bf16 v[0:15], a[48:51], v[32:35], v[0:15]
  ds_read_b128 v[44:47], v206 offset:3072
  v_mfma_f32_32x32x16_bf16 v[16:31], a[192:195], v[32:35], v[16:31]
  s_waitcnt lgkmcnt(2)
  v_mfma_f32_32x32x16_bf16 v[0:15], a[52:55], v[36:39], v[0:15]
  ds_read_b128 v[32:35], v203 offset:4096
  v_mfma_f32_32x32x16_bf16 v[16:31], a[196:199], v[36:39], v[16:31]
  s_waitcnt lgkmcnt(2)
  v_mfma_f32_32x32x16_bf16 v[0:15], a[56:59], v[40:43], v[0:15]
  ds_read_b128 v[36:39], v204 offset:4096
  v_mfma_f32_32x32x16_bf16 v[16:31], a[200:203], v[40:43], v[16:31]
  s_waitcnt lgkmcnt(2)
  v_mfma_f32_32x32x16_bf16 v[0:15], a[60:63], v[44:47], v[0:15]
  ds_read_b128 v[40:43], v205 offset:4096
  v_mfma_f32_32x32x16_bf16 v[16:31], a[204:207], v[44:47], v[16:31]
  s_waitcnt lgkmcnt(2)
  v_mfma_f32_32x32x16_bf16 v[0:15], a[64:67], v[32:35], v[0:15]
  ds_read_b128 v[44:47], v206 offset:4096
  v_mfma_f32_32x32x16_bf16 v[16:31], a[208:211], v[32:35], v[16:31]
  s_waitcnt lgkmcnt(2)
  v_mfma_f32_32x32x16_bf16 v[0:15], a[68:71], v[36:39], v[0:15]
  ds_read_b128 v[32:35], v203 offset:5120
  v_mfma_f32_32x32x16_bf16 v[16:31], a[212:215], v[36:39], v[16:31]
  s_waitcnt lgkmcnt(2)
  v_mfma_f32_32x32x16_bf16 v[0:15], a[72:75], v[40:43], v[0:15]
  ds_read_b128 v[36:39], v204 offset:5120
  v_mfma_f32_32x32x16_bf16 v[16:31], a[216:219], v[40:43], v[16:31]
  s_waitcnt lgkmcnt(2)
  v_mfma_f32_32x32x16_bf16 v[0:15], a[76:79], v[44:47], v[0:15]
  ds_read_b128 v[40:43], v205 offset:5120
  v_mfma_f32_32x32x16_bf16 v[16:31], a[220:223], v[44:47], v[16:31]
  s_waitcnt lgkmcnt(2)
  v_mfma_f32_32x32x16_bf16 v[0:15], a[80:83], v[32:35], v[0:15]
  ds_read_b128 v[44:47], v206 offset:5120
  v_mfma_f32_32x32x16_bf16 v[16:31], a[224:227], v[32:35], v[16:31]
  s_waitcnt lgkmcnt(2)
  v_mfma_f32_32x32x16_bf16 v[0:15], a[84:87], v[36:39], v[0:15]
  ds_read_b128 v[32:35], v203 offset:6144
  v_mfma_f32_32x32x16_bf16 v[16:31], a[228:231], v[36:39], v[16:31]
  s_waitcnt lgkmcnt(2)
  v_mfma_f32_32x32x16_bf16 v[0:15], a[88:91], v[40:43], v[0:15]
  ds_read_b128 v[36:39], v204 offset:6144
  v_mfma_f32_32x32x16_bf16 v[16:31], a[232:235], v[40:43], v[16:31]
  s_waitcnt lgkmcnt(2)
  v_mfma_f32_32x32x16_bf16 v[0:15], a[92:95], v[44:47], v[0:15]
  ds_read_b128 v[40:43], v205 offset:6144
  v_mfma_f32_32x32x16_bf16 v[16:31], a[236:239], v[44:47], v[16:31]
  s_waitcnt lgkmcnt(2)
  v_mfma_f32_32x32x16_bf16 v[0:15], a[96:99], v[32:35], v[0:15]
  ds_read_b128 v[44:47], v206 offset:6144
  v_mfma_f32_32x32x16_bf16 v[16:31], a[240:243], v[32:35], v[16:31]
  s_waitcnt lgkmcnt(2)
  v_mfma_f32_32x32x16_bf16 v[0:15], a[100:103], v[36:39], v[0:15]
  ds_read_b128 v[32:35], v203 offset:7168
  v_mfma_f32_32x32x16_bf16 v[16:31], a[244:247], v[36:39], v[16:31]
  s_waitcnt lgkmcnt(2)
  v_mfma_f32_32x32x16_bf16 v[0:15], a[104:107], v[40:43], v[0:15]
  ds_read_b128 v[36:39], v204 offset:7168
  v_mfma_f32_32x32x16_bf16 v[16:31], a[248:251], v[40:43], v[16:31]
  s_waitcnt lgkmcnt(2)
  v_mfma_f32_32x32x16_bf16 v[0:15], a[108:111], v[44:47], v[0:15]
  ds_read_b128 v[40:43], v205 offset:7168
  v_mfma_f32_32x32x16_bf16 v[16:31], a[252:255], v[44:47], v[16:31]
  s_waitcnt lgkmcnt(2)
  v_mfma_f32_32x32x16_bf16 v[0:15], a[112:115], v[32:35], v[0:15]
  ds_read_b128 v[44:47], v206 offset:7168
  v_mfma_f32_32x32x16_bf16 v[16:31], v[224:227], v[32:35], v[16:31]
  s_waitcnt lgkmcnt(2)
  v_mfma_f32_32x32x16_bf16 v[0:15], a[116:119], v[36:39], v[0:15]
  ds_read_b128 v[32:35], v203 offset:8192
  v_mfma_f32_32x32x16_bf16 v[16:31], v[228:231], v[36:39], v[16:31]
  s_waitcnt lgkmcnt(2)
  v_mfma_f32_32x32x16_bf16 v[0:15], a[120:123], v[40:43], v[0:15]
  ds_read_b128 v[36:39], v204 offset:8192
  v_mfma_f32_32x32x16_bf16 v[16:31], v[232:235], v[40:43], v[16:31]
  s_waitcnt lgkmcnt(2)
  v_mfma_f32_32x32x16_bf16 v[0:15], a[124:127], v[44:47], v[0:15]
  ds_read_b128 v[40:43], v205 offset:8192
  v_mfma_f32_32x32x16_bf16 v[16:31], v[236:239], v[44:47], v[16:31]
  s_waitcnt lgkmcnt(2)
  v_mfma_f32_32x32x16_bf16 v[0:15], a[128:131], v[32:35], v[0:15]
  ds_read_b128 v[44:47], v206 offset:8192
  v_mfma_f32_32x32x16_bf16 v[16:31], v[240:243], v[32:35], v[16:31]
  s_waitcnt lgkmcnt(2)
  v_mfma_f32_32x32x16_bf16 v[0:15], a[132:135], v[36:39], v[0:15]
  v_mfma_f32_32x32x16_bf16 v[16:31], v[244:247], v[36:39], v[16:31]
  s_waitcnt lgkmcnt(1)
  v_mfma_f32_32x32x16_bf16 v[0:15], a[136:139], v[40:43], v[0:15]
  v_mfma_f32_32x32x16_bf16 v[16:31], v[248:251], v[40:43], v[16:31]
  s_waitcnt lgkmcnt(0)
  v_mfma_f32_32x32x16_bf16 v[0:15], a[140:143], v[44:47], v[0:15]
  v_mfma_f32_32x32x16_bf16 v[16:31], v[252:255], v[44:47], v[16:31]
  s_add_u32 s60, s60, 36864
  s_nop 2
  v_cvt_pk_bf16_f32 v48, v0, v1
  v_cvt_pk_bf16_f32 v49, v2, v3
  ds_write2_b32 v218, v48, v49 offset0:0 offset1:1
  v_cvt_pk_bf16_f32 v48, v4, v5
  v_cvt_pk_bf16_f32 v49, v6, v7
  ds_write2_b32 v218, v48, v49 offset0:4 offset1:5
  v_cvt_pk_bf16_f32 v48, v8, v9
  v_cvt_pk_bf16_f32 v49, v10, v11
  ds_write2_b32 v218, v48, v49 offset0:8 offset1:9
  v_cvt_pk_bf16_f32 v48, v12, v13
  v_cvt_pk_bf16_f32 v49, v14, v15
  ds_write2_b32 v218, v48, v49 offset0:12 offset1:13
  v_cvt_pk_bf16_f32 v48, v16, v17
  v_cvt_pk_bf16_f32 v49, v18, v19
  ds_write2_b32 v218, v48, v49 offset0:64 offset1:65
  v_cvt_pk_bf16_f32 v48, v20, v21
  v_cvt_pk_bf16_f32 v49, v22, v23
  ds_write2_b32 v218, v48, v49 offset0:68 offset1:69
  v_cvt_pk_bf16_f32 v48, v24, v25
  v_cvt_pk_bf16_f32 v49, v26, v27
  ds_write2_b32 v218, v48, v49 offset0:72 offset1:73
  v_cvt_pk_bf16_f32 v48, v28, v29
  v_cvt_pk_bf16_f32 v49, v30, v31
  ds_write2_b32 v218, v48, v49 offset0:76 offset1:77
  v_add_u32 v218, 16512, v218
  s_waitcnt vmcnt(0) lgkmcnt(0)
  s_barrier
  ds_read_b128 v[32:35], v203 offset:36864
  ds_read_b128 v[36:39], v204 offset:36864
  ds_read_b128 v[40:43], v205 offset:36864
  s_waitcnt lgkmcnt(2)
  v_mfma_f32_32x32x16_bf16 v[0:15], a[0:3], v[32:35], 0
  ds_read_b128 v[44:47], v206 offset:36864
  s_add_u32 m0, s67, 0
  s_nop 0
  buffer_load_dwordx4 v202, s[4:7], s60 offen offset:0 lds
  v_mfma_f32_32x32x16_bf16 v[16:31], a[144:147], v[32:35], 0
  s_waitcnt lgkmcnt(2)
  v_mfma_f32_32x32x16_bf16 v[0:15], a[4:7], v[36:39], v[0:15]
  ds_read_b128 v[32:35], v203 offset:37888
  s_add_u32 m0, s67, 896
  s_nop 0
  buffer_load_dwordx4 v202, s[4:7], s60 offen offset:128 lds
  v_mfma_f32_32x32x16_bf16 v[16:31], a[148:151], v[36:39], v[16:31]
  s_waitcnt lgkmcnt(2)
  v_mfma_f32_32x32x16_bf16 v[0:15], a[8:11], v[40:43], v[0:15]
  ds_read_b128 v[36:39], v204 offset:37888
  s_add_u32 m0, s67, 1792
  s_nop 0
  buffer_load_dwordx4 v202, s[4:7], s60 offen offset:256 lds
  v_mfma_f32_32x32x16_bf16 v[16:31], a[152:155], v[40:43], v[16:31]
  s_waitcnt lgkmcnt(2)
  v_mfma_f32_32x32x16_bf16 v[0:15], a[12:15], v[44:47], v[0:15]
  ds_read_b128 v[40:43], v205 offset:37888
  s_add_u32 m0, s67, 2688
  s_nop 0
  buffer_load_dwordx4 v202, s[4:7], s60 offen offset:384 lds
  v_mfma_f32_32x32x16_bf16 v[16:31], a[156:159], v[44:47], v[16:31]
  s_waitcnt lgkmcnt(2)
  v_mfma_f32_32x32x16_bf16 v[0:15], a[16:19], v[32:35], v[0:15]
  ds_read_b128 v[44:47], v206 offset:37888
  s_add_u32 m0, s67, 3584
  s_nop 0
  buffer_load_dwordx4 v202, s[4:7], s60 offen offset:512 lds
  v_mfma_f32_32x32x16_bf16 v[16:31], a[160:163], v[32:35], v[16:31]
  s_waitcnt lgkmcnt(2)
  v_mfma_f32_32x32x16_bf16 v[0:15], a[20:23], v[36:39], v[0:15]
  ds_read_b128 v[32:35], v203 offset:38912
  s_add_u32 m0, s67, 4480
  s_nop 0
  buffer_load_dwordx4 v202, s[4:7], s60 offen offset:640 lds
  v_mfma_f32_32x32x16_bf16 v[16:31], a[164:167], v[36:39], v[16:31]
  s_waitcnt lgkmcnt(2)
  v_mfma_f32_32x32x16_bf16 v[0:15], a[24:27], v[40:43], v[0:15]
  ds_read_b128 v[36:39], v204 offset:38912
  s_add_u32 m0, s67, 5376
  s_nop 0
  buffer_load_dwordx4 v202, s[4:7], s60 offen offset:768 lds
  v_mfma_f32_32x32x16_bf16 v[16:31], a[168:171], v[40:43], v[16:31]
  s_waitcnt lgkmcnt(2)
  v_mfma_f32_32x32x16_bf16 v[0:15], a[28:31], v[44:47], v[0:15]
  ds_read_b128 v[40:43], v205 offset:38912
  s_add_u32 m0, s67, 6272
  s_nop 0
  buffer_load_dwordx4 v202, s[4:7], s60 offen offset:896 lds
  v_mfma_f32_32x32x16_bf16 v[16:31], a[172:175], v[44:47], v[16:31]
  s_waitcnt lgkmcnt(2)
  v_mfma_f32_32x32x16_bf16 v[0:15], a[32:35], v[32:35], v[0:15]
  ds_read_b128 v[44:47], v206 offset:38912
  s_add_u32 m0, s67, 7168
  s_nop 0
  buffer_load_dwordx4 v202, s[4:7], s60 offen offset:1024 lds
  v_mfma_f32_32x32x16_bf16 v[16:31], a[176:179], v[32:35], v[16:31]
  s_waitcnt lgkmcnt(2)
  v_mfma_f32_32x32x16_bf16 v[0:15], a[36:39], v[36:39], v[0:15]
  ds_read_b128 v[32:35], v203 offset:39936
  v_mfma_f32_32x32x16_bf16 v[16:31], a[180:183], v[36:39], v[16:31]
  s_waitcnt lgkmcnt(2)
  v_mfma_f32_32x32x16_bf16 v[0:15], a[40:43], v[40:43], v[0:15]
  ds_read_b128 v[36:39], v204 offset:39936
  v_mfma_f32_32x32x16_bf16 v[16:31], a[184:187], v[40:43], v[16:31]
  s_waitcnt lgkmcnt(2)
  v_mfma_f32_32x32x16_bf16 v[0:15], a[44:47], v[44:47], v[0:15]
  ds_read_b128 v[40:43], v205 offset:39936
  v_mfma_f32_32x32x16_bf16 v[16:31], a[188:191], v[44:47], v[16:31]
  s_waitcnt lgkmcnt(2)
  v_mfma_f32_32x32x16_bf16 v[0:15], a[48:51], v[32:35], v[0:15]
  ds_read_b128 v[44:47], v206 offset:39936
  v_mfma_f32_32x32x16_bf16 v[16:31], a[192:195], v[32:35], v[16:31]
  s_waitcnt lgkmcnt(2)
  v_mfma_f32_32x32x16_bf16 v[0:15], a[52:55], v[36:39], v[0:15]
  ds_read_b128 v[32:35], v203 offset:40960
  v_mfma_f32_32x32x16_bf16 v[16:31], a[196:199], v[36:39], v[16:31]
  s_waitcnt lgkmcnt(2)
  v_mfma_f32_32x32x16_bf16 v[0:15], a[56:59], v[40:43], v[0:15]
  ds_read_b128 v[36:39], v204 offset:40960
  v_mfma_f32_32x32x16_bf16 v[16:31], a[200:203], v[40:43], v[16:31]
  s_waitcnt lgkmcnt(2)
  v_mfma_f32_32x32x16_bf16 v[0:15], a[60:63], v[44:47], v[0:15]
  ds_read_b128 v[40:43], v205 offset:40960
  v_mfma_f32_32x32x16_bf16 v[16:31], a[204:207], v[44:47], v[16:31]
  s_waitcnt lgkmcnt(2)
  v_mfma_f32_32x32x16_bf16 v[0:15], a[64:67], v[32:35], v[0:15]
  ds_read_b128 v[44:47], v206 offset:40960
  v_mfma_f32_32x32x16_bf16 v[16:31], a[208:211], v[32:35], v[16:31]
  s_waitcnt lgkmcnt(2)
  v_mfma_f32_32x32x16_bf16 v[0:15], a[68:71], v[36:39], v[0:15]
  ds_read_b128 v[32:35], v203 offset:41984
  v_mfma_f32_32x32x16_bf16 v[16:31], a[212:215], v[36:39], v[16:31]
  s_waitcnt lgkmcnt(2)
  v_mfma_f32_32x32x16_bf16 v[0:15], a[72:75], v[40:43], v[0:15]
  ds_read_b128 v[36:39], v204 offset:41984
  v_mfma_f32_32x32x16_bf16 v[16:31], a[216:219], v[40:43], v[16:31]
  s_waitcnt lgkmcnt(2)
  v_mfma_f32_32x32x16_bf16 v[0:15], a[76:79], v[44:47], v[0:15]
  ds_read_b128 v[40:43], v205 offset:41984
  v_mfma_f32_32x32x16_bf16 v[16:31], a[220:223], v[44:47], v[16:31]
  s_waitcnt lgkmcnt(2)
  v_mfma_f32_32x32x16_bf16 v[0:15], a[80:83], v[32:35], v[0:15]
  ds_read_b128 v[44:47], v206 offset:41984
  v_mfma_f32_32x32x16_bf16 v[16:31], a[224:227], v[32:35], v[16:31]
  s_waitcnt lgkmcnt(2)
  v_mfma_f32_32x32x16_bf16 v[0:15], a[84:87], v[36:39], v[0:15]
  ds_read_b128 v[32:35], v203 offset:43008
  v_mfma_f32_32x32x16_bf16 v[16:31], a[228:231], v[36:39], v[16:31]
  s_waitcnt lgkmcnt(2)
  v_mfma_f32_32x32x16_bf16 v[0:15], a[88:91], v[40:43], v[0:15]
  ds_read_b128 v[36:39], v204 offset:43008
  v_mfma_f32_32x32x16_bf16 v[16:31], a[232:235], v[40:43], v[16:31]
  s_waitcnt lgkmcnt(2)
  v_mfma_f32_32x32x16_bf16 v[0:15], a[92:95], v[44:47], v[0:15]
  ds_read_b128 v[40:43], v205 offset:43008
  v_mfma_f32_32x32x16_bf16 v[16:31], a[236:239], v[44:47], v[16:31]
  s_waitcnt lgkmcnt(2)
  v_mfma_f32_32x32x16_bf16 v[0:15], a[96:99], v[32:35], v[0:15]
  ds_read_b128 v[44:47], v206 offset:43008
  v_mfma_f32_32x32x16_bf16 v[16:31], a[240:243], v[32:35], v[16:31]
  s_waitcnt lgkmcnt(2)
  v_mfma_f32_32x32x16_bf16 v[0:15], a[100:103], v[36:39], v[0:15]
  ds_read_b128 v[32:35], v203 offset:44032
  v_mfma_f32_32x32x16_bf16 v[16:31], a[244:247], v[36:39], v[16:31]
  s_waitcnt lgkmcnt(2)
  v_mfma_f32_32x32x16_bf16 v[0:15], a[104:107], v[40:43], v[0:15]
  ds_read_b128 v[36:39], v204 offset:44032
  v_mfma_f32_32x32x16_bf16 v[16:31], a[248:251], v[40:43], v[16:31]
  s_waitcnt lgkmcnt(2)
  v_mfma_f32_32x32x16_bf16 v[0:15], a[108:111], v[44:47], v[0:15]
  ds_read_b128 v[40:43], v205 offset:44032
  v_mfma_f32_32x32x16_bf16 v[16:31], a[252:255], v[44:47], v[16:31]
  s_waitcnt lgkmcnt(2)
  v_mfma_f32_32x32x16_bf16 v[0:15], a[112:115], v[32:35], v[0:15]
  ds_read_b128 v[44:47], v206 offset:44032
  v_mfma_f32_32x32x16_bf16 v[16:31], v[224:227], v[32:35], v[16:31]
  s_waitcnt lgkmcnt(2)
  v_mfma_f32_32x32x16_bf16 v[0:15], a[116:119], v[36:39], v[0:15]
  ds_read_b128 v[32:35], v203 offset:45056
  v_mfma_f32_32x32x16_bf16 v[16:31], v[228:231], v[36:39], v[16:31]
  s_waitcnt lgkmcnt(2)
  v_mfma_f32_32x32x16_bf16 v[0:15], a[120:123], v[40:43], v[0:15]
  ds_read_b128 v[36:39], v204 offset:45056
  v_mfma_f32_32x32x16_bf16 v[16:31], v[232:235], v[40:43], v[16:31]
  s_waitcnt lgkmcnt(2)
  v_mfma_f32_32x32x16_bf16 v[0:15], a[124:127], v[44:47], v[0:15]
  ds_read_b128 v[40:43], v205 offset:45056
  v_mfma_f32_32x32x16_bf16 v[16:31], v[236:239], v[44:47], v[16:31]
  s_waitcnt lgkmcnt(2)
  v_mfma_f32_32x32x16_bf16 v[0:15], a[128:131], v[32:35], v[0:15]
  ds_read_b128 v[44:47], v206 offset:45056
  v_mfma_f32_32x32x16_bf16 v[16:31], v[240:243], v[32:35], v[16:31]
  s_waitcnt lgkmcnt(2)
  v_mfma_f32_32x32x16_bf16 v[0:15], a[132:135], v[36:39], v[0:15]
  v_mfma_f32_32x32x16_bf16 v[16:31], v[244:247], v[36:39], v[16:31]
  s_waitcnt lgkmcnt(1)
  v_mfma_f32_32x32x16_bf16 v[0:15], a[136:139], v[40:43], v[0:15]
  v_mfma_f32_32x32x16_bf16 v[16:31], v[248:251], v[40:43], v[16:31]
  s_waitcnt lgkmcnt(0)
  v_mfma_f32_32x32x16_bf16 v[0:15], a[140:143], v[44:47], v[0:15]
  v_mfma_f32_32x32x16_bf16 v[16:31], v[252:255], v[44:47], v[16:31]
  s_add_u32 s60, s60, 36864
  s_nop 2
  v_cvt_pk_bf16_f32 v48, v0, v1
  v_cvt_pk_bf16_f32 v49, v2, v3
  ds_write2_b32 v218, v48, v49 offset0:0 offset1:1
  v_cvt_pk_bf16_f32 v48, v4, v5
  v_cvt_pk_bf16_f32 v49, v6, v7
  ds_write2_b32 v218, v48, v49 offset0:4 offset1:5
  v_cvt_pk_bf16_f32 v48, v8, v9
  v_cvt_pk_bf16_f32 v49, v10, v11
  ds_write2_b32 v218, v48, v49 offset0:8 offset1:9
  v_cvt_pk_bf16_f32 v48, v12, v13
  v_cvt_pk_bf16_f32 v49, v14, v15
  ds_write2_b32 v218, v48, v49 offset0:12 offset1:13
  v_cvt_pk_bf16_f32 v48, v16, v17
  v_cvt_pk_bf16_f32 v49, v18, v19
  ds_write2_b32 v218, v48, v49 offset0:64 offset1:65
  v_cvt_pk_bf16_f32 v48, v20, v21
  v_cvt_pk_bf16_f32 v49, v22, v23
  ds_write2_b32 v218, v48, v49 offset0:68 offset1:69
  v_cvt_pk_bf16_f32 v48, v24, v25
  v_cvt_pk_bf16_f32 v49, v26, v27
  ds_write2_b32 v218, v48, v49 offset0:72 offset1:73
  v_cvt_pk_bf16_f32 v48, v28, v29
  v_cvt_pk_bf16_f32 v49, v30, v31
  ds_write2_b32 v218, v48, v49 offset0:76 offset1:77
  v_add_u32 v218, 16512, v218
  s_waitcnt vmcnt(0) lgkmcnt(0)
  s_barrier
  ds_read_b128 v[32:35], v203 offset:0
  ds_read_b128 v[36:39], v204 offset:0
  ds_read_b128 v[40:43], v205 offset:0
  s_waitcnt lgkmcnt(2)
  v_mfma_f32_32x32x16_bf16 v[0:15], a[0:3], v[32:35], 0
  ds_read_b128 v[44:47], v206 offset:0
  s_add_u32 m0, s67, 36864
  s_nop 0
  buffer_load_dwordx4 v202, s[4:7], s60 offen offset:0 lds
  v_mfma_f32_32x32x16_bf16 v[16:31], a[144:147], v[32:35], 0
  s_waitcnt lgkmcnt(2)
  v_mfma_f32_32x32x16_bf16 v[0:15], a[4:7], v[36:39], v[0:15]
  ds_read_b128 v[32:35], v203 offset:1024
  s_add_u32 m0, s67, 37760
  s_nop 0
  buffer_load_dwordx4 v202, s[4:7], s60 offen offset:128 lds
  v_mfma_f32_32x32x16_bf16 v[16:31], a[148:151], v[36:39], v[16:31]
  s_waitcnt lgkmcnt(2)
  v_mfma_f32_32x32x16_bf16 v[0:15], a[8:11], v[40:43], v[0:15]
  ds_read_b128 v[36:39], v204 offset:1024
  s_add_u32 m0, s67, 38656
  s_nop 0
  buffer_load_dwordx4 v202, s[4:7], s60 offen offset:256 lds
  v_mfma_f32_32x32x16_bf16 v[16:31], a[152:155], v[40:43], v[16:31]
  s_waitcnt lgkmcnt(2)
  v_mfma_f32_32x32x16_bf16 v[0:15], a[12:15], v[44:47], v[0:15]
  ds_read_b128 v[40:43], v205 offset:1024
  s_add_u32 m0, s67, 39552
  s_nop 0
  buffer_load_dwordx4 v202, s[4:7], s60 offen offset:384 lds
  v_mfma_f32_32x32x16_bf16 v[16:31], a[156:159], v[44:47], v[16:31]
  s_waitcnt lgkmcnt(2)
  v_mfma_f32_32x32x16_bf16 v[0:15], a[16:19], v[32:35], v[0:15]
  ds_read_b128 v[44:47], v206 offset:1024
  s_add_u32 m0, s67, 40448
  s_nop 0
  buffer_load_dwordx4 v202, s[4:7], s60 offen offset:512 lds
  v_mfma_f32_32x32x16_bf16 v[16:31], a[160:163], v[32:35], v[16:31]
  s_waitcnt lgkmcnt(2)
  v_mfma_f32_32x32x16_bf16 v[0:15], a[20:23], v[36:39], v[0:15]
  ds_read_b128 v[32:35], v203 offset:2048
  s_add_u32 m0, s67, 41344
  s_nop 0
  buffer_load_dwordx4 v202, s[4:7], s60 offen offset:640 lds
  v_mfma_f32_32x32x16_bf16 v[16:31], a[164:167], v[36:39], v[16:31]
  s_waitcnt lgkmcnt(2)
  v_mfma_f32_32x32x16_bf16 v[0:15], a[24:27], v[40:43], v[0:15]
  ds_read_b128 v[36:39], v204 offset:2048
  s_add_u32 m0, s67, 42240
  s_nop 0
  buffer_load_dwordx4 v202, s[4:7], s60 offen offset:768 lds
  v_mfma_f32_32x32x16_bf16 v[16:31], a[168:171], v[40:43], v[16:31]
  s_waitcnt lgkmcnt(2)
  v_mfma_f32_32x32x16_bf16 v[0:15], a[28:31], v[44:47], v[0:15]
  ds_read_b128 v[40:43], v205 offset:2048
  s_add_u32 m0, s67, 43136
  s_nop 0
  buffer_load_dwordx4 v202, s[4:7], s60 offen offset:896 lds
  v_mfma_f32_32x32x16_bf16 v[16:31], a[172:175], v[44:47], v[16:31]
  s_waitcnt lgkmcnt(2)
  v_mfma_f32_32x32x16_bf16 v[0:15], a[32:35], v[32:35], v[0:15]
  ds_read_b128 v[44:47], v206 offset:2048
  s_add_u32 m0, s67, 44032
  s_nop 0
  buffer_load_dwordx4 v202, s[4:7], s60 offen offset:1024 lds
  v_mfma_f32_32x32x16_bf16 v[16:31], a[176:179], v[32:35], v[16:31]
  s_waitcnt lgkmcnt(2)
  v_mfma_f32_32x32x16_bf16 v[0:15], a[36:39], v[36:39], v[0:15]
  ds_read_b128 v[32:35], v203 offset:3072
  v_mfma_f32_32x32x16_bf16 v[16:31], a[180:183], v[36:39], v[16:31]
  s_waitcnt lgkmcnt(2)
  v_mfma_f32_32x32x16_bf16 v[0:15], a[40:43], v[40:43], v[0:15]
  ds_read_b128 v[36:39], v204 offset:3072
  v_mfma_f32_32x32x16_bf16 v[16:31], a[184:187], v[40:43], v[16:31]
  s_waitcnt lgkmcnt(2)
  v_mfma_f32_32x32x16_bf16 v[0:15], a[44:47], v[44:47], v[0:15]
  ds_read_b128 v[40:43], v205 offset:3072
  v_mfma_f32_32x32x16_bf16 v[16:31], a[188:191], v[44:47], v[16:31]
  s_waitcnt lgkmcnt(2)
  v_mfma_f32_32x32x16_bf16 v[0:15], a[48:51], v[32:35], v[0:15]
  ds_read_b128 v[44:47], v206 offset:3072
  v_mfma_f32_32x32x16_bf16 v[16:31], a[192:195], v[32:35], v[16:31]
  s_waitcnt lgkmcnt(2)
  v_mfma_f32_32x32x16_bf16 v[0:15], a[52:55], v[36:39], v[0:15]
  ds_read_b128 v[32:35], v203 offset:4096
  v_mfma_f32_32x32x16_bf16 v[16:31], a[196:199], v[36:39], v[16:31]
  s_waitcnt lgkmcnt(2)
  v_mfma_f32_32x32x16_bf16 v[0:15], a[56:59], v[40:43], v[0:15]
  ds_read_b128 v[36:39], v204 offset:4096
  v_mfma_f32_32x32x16_bf16 v[16:31], a[200:203], v[40:43], v[16:31]
  s_waitcnt lgkmcnt(2)
  v_mfma_f32_32x32x16_bf16 v[0:15], a[60:63], v[44:47], v[0:15]
  ds_read_b128 v[40:43], v205 offset:4096
  v_mfma_f32_32x32x16_bf16 v[16:31], a[204:207], v[44:47], v[16:31]
  s_waitcnt lgkmcnt(2)
  v_mfma_f32_32x32x16_bf16 v[0:15], a[64:67], v[32:35], v[0:15]
  ds_read_b128 v[44:47], v206 offset:4096
  v_mfma_f32_32x32x16_bf16 v[16:31], a[208:211], v[32:35], v[16:31]
  s_waitcnt lgkmcnt(2)
  v_mfma_f32_32x32x16_bf16 v[0:15], a[68:71], v[36:39], v[0:15]
  ds_read_b128 v[32:35], v203 offset:5120
  v_mfma_f32_32x32x16_bf16 v[16:31], a[212:215], v[36:39], v[16:31]
  s_waitcnt lgkmcnt(2)
  v_mfma_f32_32x32x16_bf16 v[0:15], a[72:75], v[40:43], v[0:15]
  ds_read_b128 v[36:39], v204 offset:5120
  v_mfma_f32_32x32x16_bf16 v[16:31], a[216:219], v[40:43], v[16:31]
  s_waitcnt lgkmcnt(2)
  v_mfma_f32_32x32x16_bf16 v[0:15], a[76:79], v[44:47], v[0:15]
  ds_read_b128 v[40:43], v205 offset:5120
  v_mfma_f32_32x32x16_bf16 v[16:31], a[220:223], v[44:47], v[16:31]
  s_waitcnt lgkmcnt(2)
  v_mfma_f32_32x32x16_bf16 v[0:15], a[80:83], v[32:35], v[0:15]
  ds_read_b128 v[44:47], v206 offset:5120
  v_mfma_f32_32x32x16_bf16 v[16:31], a[224:227], v[32:35], v[16:31]
  s_waitcnt lgkmcnt(2)
  v_mfma_f32_32x32x16_bf16 v[0:15], a[84:87], v[36:39], v[0:15]
  ds_read_b128 v[32:35], v203 offset:6144
  v_mfma_f32_32x32x16_bf16 v[16:31], a[228:231], v[36:39], v[16:31]
  s_waitcnt lgkmcnt(2)
  v_mfma_f32_32x32x16_bf16 v[0:15], a[88:91], v[40:43], v[0:15]
  ds_read_b128 v[36:39], v204 offset:6144
  v_mfma_f32_32x32x16_bf16 v[16:31], a[232:235], v[40:43], v[16:31]
  s_waitcnt lgkmcnt(2)
  v_mfma_f32_32x32x16_bf16 v[0:15], a[92:95], v[44:47], v[0:15]
  ds_read_b128 v[40:43], v205 offset:6144
  v_mfma_f32_32x32x16_bf16 v[16:31], a[236:239], v[44:47], v[16:31]
  s_waitcnt lgkmcnt(2)
  v_mfma_f32_32x32x16_bf16 v[0:15], a[96:99], v[32:35], v[0:15]
  ds_read_b128 v[44:47], v206 offset:6144
  v_mfma_f32_32x32x16_bf16 v[16:31], a[240:243], v[32:35], v[16:31]
  s_waitcnt lgkmcnt(2)
  v_mfma_f32_32x32x16_bf16 v[0:15], a[100:103], v[36:39], v[0:15]
  ds_read_b128 v[32:35], v203 offset:7168
  v_mfma_f32_32x32x16_bf16 v[16:31], a[244:247], v[36:39], v[16:31]
  s_waitcnt lgkmcnt(2)
  v_mfma_f32_32x32x16_bf16 v[0:15], a[104:107], v[40:43], v[0:15]
  ds_read_b128 v[36:39], v204 offset:7168
  v_mfma_f32_32x32x16_bf16 v[16:31], a[248:251], v[40:43], v[16:31]
  s_waitcnt lgkmcnt(2)
  v_mfma_f32_32x32x16_bf16 v[0:15], a[108:111], v[44:47], v[0:15]
  ds_read_b128 v[40:43], v205 offset:7168
  v_mfma_f32_32x32x16_bf16 v[16:31], a[252:255], v[44:47], v[16:31]
  s_waitcnt lgkmcnt(2)
  v_mfma_f32_32x32x16_bf16 v[0:15], a[112:115], v[32:35], v[0:15]
  ds_read_b128 v[44:47], v206 offset:7168
  v_mfma_f32_32x32x16_bf16 v[16:31], v[224:227], v[32:35], v[16:31]
  s_waitcnt lgkmcnt(2)
  v_mfma_f32_32x32x16_bf16 v[0:15], a[116:119], v[36:39], v[0:15]
  ds_read_b128 v[32:35], v203 offset:8192
  v_mfma_f32_32x32x16_bf16 v[16:31], v[228:231], v[36:39], v[16:31]
  s_waitcnt lgkmcnt(2)
  v_mfma_f32_32x32x16_bf16 v[0:15], a[120:123], v[40:43], v[0:15]
  ds_read_b128 v[36:39], v204 offset:8192
  v_mfma_f32_32x32x16_bf16 v[16:31], v[232:235], v[40:43], v[16:31]
  s_waitcnt lgkmcnt(2)
  v_mfma_f32_32x32x16_bf16 v[0:15], a[124:127], v[44:47], v[0:15]
  ds_read_b128 v[40:43], v205 offset:8192
  v_mfma_f32_32x32x16_bf16 v[16:31], v[236:239], v[44:47], v[16:31]
  s_waitcnt lgkmcnt(2)
  v_mfma_f32_32x32x16_bf16 v[0:15], a[128:131], v[32:35], v[0:15]
  ds_read_b128 v[44:47], v206 offset:8192
  v_mfma_f32_32x32x16_bf16 v[16:31], v[240:243], v[32:35], v[16:31]
  s_waitcnt lgkmcnt(2)
  v_mfma_f32_32x32x16_bf16 v[0:15], a[132:135], v[36:39], v[0:15]
  v_mfma_f32_32x32x16_bf16 v[16:31], v[244:247], v[36:39], v[16:31]
  s_waitcnt lgkmcnt(1)
  v_mfma_f32_32x32x16_bf16 v[0:15], a[136:139], v[40:43], v[0:15]
  v_mfma_f32_32x32x16_bf16 v[16:31], v[248:251], v[40:43], v[16:31]
  s_waitcnt lgkmcnt(0)
  v_mfma_f32_32x32x16_bf16 v[0:15], a[140:143], v[44:47], v[0:15]
  v_mfma_f32_32x32x16_bf16 v[16:31], v[252:255], v[44:47], v[16:31]
  s_add_u32 s60, s60, 36864
  s_nop 2
  v_cvt_pk_bf16_f32 v48, v0, v1
  v_cvt_pk_bf16_f32 v49, v2, v3
  ds_write2_b32 v218, v48, v49 offset0:0 offset1:1
  v_cvt_pk_bf16_f32 v48, v4, v5
  v_cvt_pk_bf16_f32 v49, v6, v7
  ds_write2_b32 v218, v48, v49 offset0:4 offset1:5
  v_cvt_pk_bf16_f32 v48, v8, v9
  v_cvt_pk_bf16_f32 v49, v10, v11
  ds_write2_b32 v218, v48, v49 offset0:8 offset1:9
  v_cvt_pk_bf16_f32 v48, v12, v13
  v_cvt_pk_bf16_f32 v49, v14, v15
  ds_write2_b32 v218, v48, v49 offset0:12 offset1:13
  v_cvt_pk_bf16_f32 v48, v16, v17
  v_cvt_pk_bf16_f32 v49, v18, v19
  ds_write2_b32 v218, v48, v49 offset0:64 offset1:65
  v_cvt_pk_bf16_f32 v48, v20, v21
  v_cvt_pk_bf16_f32 v49, v22, v23
  ds_write2_b32 v218, v48, v49 offset0:68 offset1:69
  v_cvt_pk_bf16_f32 v48, v24, v25
  v_cvt_pk_bf16_f32 v49, v26, v27
  ds_write2_b32 v218, v48, v49 offset0:72 offset1:73
  v_cvt_pk_bf16_f32 v48, v28, v29
  v_cvt_pk_bf16_f32 v49, v30, v31
  ds_write2_b32 v218, v48, v49 offset0:76 offset1:77
  v_add_u32 v218, 16512, v218
  s_waitcnt vmcnt(0) lgkmcnt(0)
  s_barrier
  ds_read_b128 v[32:35], v203 offset:36864
  ds_read_b128 v[36:39], v204 offset:36864
  ds_read_b128 v[40:43], v205 offset:36864
  s_waitcnt lgkmcnt(2)
  v_mfma_f32_32x32x16_bf16 v[0:15], a[0:3], v[32:35], 0
  ds_read_b128 v[44:47], v206 offset:36864
  s_add_u32 m0, s67, 0
  s_nop 0
  buffer_load_dwordx4 v202, s[4:7], s60 offen offset:0 lds
  v_mfma_f32_32x32x16_bf16 v[16:31], a[144:147], v[32:35], 0
  s_waitcnt lgkmcnt(2)
  v_mfma_f32_32x32x16_bf16 v[0:15], a[4:7], v[36:39], v[0:15]
  ds_read_b128 v[32:35], v203 offset:37888
  s_add_u32 m0, s67, 896
  s_nop 0
  buffer_load_dwordx4 v202, s[4:7], s60 offen offset:128 lds
  v_mfma_f32_32x32x16_bf16 v[16:31], a[148:151], v[36:39], v[16:31]
  s_waitcnt lgkmcnt(2)
  v_mfma_f32_32x32x16_bf16 v[0:15], a[8:11], v[40:43], v[0:15]
  ds_read_b128 v[36:39], v204 offset:37888
  s_add_u32 m0, s67, 1792
  s_nop 0
  buffer_load_dwordx4 v202, s[4:7], s60 offen offset:256 lds
  v_mfma_f32_32x32x16_bf16 v[16:31], a[152:155], v[40:43], v[16:31]
  s_waitcnt lgkmcnt(2)
  v_mfma_f32_32x32x16_bf16 v[0:15], a[12:15], v[44:47], v[0:15]
  ds_read_b128 v[40:43], v205 offset:37888
  s_add_u32 m0, s67, 2688
  s_nop 0
  buffer_load_dwordx4 v202, s[4:7], s60 offen offset:384 lds
  v_mfma_f32_32x32x16_bf16 v[16:31], a[156:159], v[44:47], v[16:31]
  s_waitcnt lgkmcnt(2)
  v_mfma_f32_32x32x16_bf16 v[0:15], a[16:19], v[32:35], v[0:15]
  ds_read_b128 v[44:47], v206 offset:37888
  s_add_u32 m0, s67, 3584
  s_nop 0
  buffer_load_dwordx4 v202, s[4:7], s60 offen offset:512 lds
  v_mfma_f32_32x32x16_bf16 v[16:31], a[160:163], v[32:35], v[16:31]
  s_waitcnt lgkmcnt(2)
  v_mfma_f32_32x32x16_bf16 v[0:15], a[20:23], v[36:39], v[0:15]
  ds_read_b128 v[32:35], v203 offset:38912
  s_add_u32 m0, s67, 4480
  s_nop 0
  buffer_load_dwordx4 v202, s[4:7], s60 offen offset:640 lds
  v_mfma_f32_32x32x16_bf16 v[16:31], a[164:167], v[36:39], v[16:31]
  s_waitcnt lgkmcnt(2)
  v_mfma_f32_32x32x16_bf16 v[0:15], a[24:27], v[40:43], v[0:15]
  ds_read_b128 v[36:39], v204 offset:38912
  s_add_u32 m0, s67, 5376
  s_nop 0
  buffer_load_dwordx4 v202, s[4:7], s60 offen offset:768 lds
  v_mfma_f32_32x32x16_bf16 v[16:31], a[168:171], v[40:43], v[16:31]
  s_waitcnt lgkmcnt(2)
  v_mfma_f32_32x32x16_bf16 v[0:15], a[28:31], v[44:47], v[0:15]
  ds_read_b128 v[40:43], v205 offset:38912
  s_add_u32 m0, s67, 6272
  s_nop 0
  buffer_load_dwordx4 v202, s[4:7], s60 offen offset:896 lds
  v_mfma_f32_32x32x16_bf16 v[16:31], a[172:175], v[44:47], v[16:31]
  s_waitcnt lgkmcnt(2)
  v_mfma_f32_32x32x16_bf16 v[0:15], a[32:35], v[32:35], v[0:15]
  ds_read_b128 v[44:47], v206 offset:38912
  s_add_u32 m0, s67, 7168
  s_nop 0
  buffer_load_dwordx4 v202, s[4:7], s60 offen offset:1024 lds
  v_mfma_f32_32x32x16_bf16 v[16:31], a[176:179], v[32:35], v[16:31]
  s_waitcnt lgkmcnt(2)
  v_mfma_f32_32x32x16_bf16 v[0:15], a[36:39], v[36:39], v[0:15]
  ds_read_b128 v[32:35], v203 offset:39936
  v_mfma_f32_32x32x16_bf16 v[16:31], a[180:183], v[36:39], v[16:31]
  s_waitcnt lgkmcnt(2)
  v_mfma_f32_32x32x16_bf16 v[0:15], a[40:43], v[40:43], v[0:15]
  ds_read_b128 v[36:39], v204 offset:39936
  v_mfma_f32_32x32x16_bf16 v[16:31], a[184:187], v[40:43], v[16:31]
  s_waitcnt lgkmcnt(2)
  v_mfma_f32_32x32x16_bf16 v[0:15], a[44:47], v[44:47], v[0:15]
  ds_read_b128 v[40:43], v205 offset:39936
  v_mfma_f32_32x32x16_bf16 v[16:31], a[188:191], v[44:47], v[16:31]
  s_waitcnt lgkmcnt(2)
  v_mfma_f32_32x32x16_bf16 v[0:15], a[48:51], v[32:35], v[0:15]
  ds_read_b128 v[44:47], v206 offset:39936
  v_mfma_f32_32x32x16_bf16 v[16:31], a[192:195], v[32:35], v[16:31]
  s_waitcnt lgkmcnt(2)
  v_mfma_f32_32x32x16_bf16 v[0:15], a[52:55], v[36:39], v[0:15]
  ds_read_b128 v[32:35], v203 offset:40960
  v_mfma_f32_32x32x16_bf16 v[16:31], a[196:199], v[36:39], v[16:31]
  s_waitcnt lgkmcnt(2)
  v_mfma_f32_32x32x16_bf16 v[0:15], a[56:59], v[40:43], v[0:15]
  ds_read_b128 v[36:39], v204 offset:40960
  v_mfma_f32_32x32x16_bf16 v[16:31], a[200:203], v[40:43], v[16:31]
  s_waitcnt lgkmcnt(2)
  v_mfma_f32_32x32x16_bf16 v[0:15], a[60:63], v[44:47], v[0:15]
  ds_read_b128 v[40:43], v205 offset:40960
  v_mfma_f32_32x32x16_bf16 v[16:31], a[204:207], v[44:47], v[16:31]
  s_waitcnt lgkmcnt(2)
  v_mfma_f32_32x32x16_bf16 v[0:15], a[64:67], v[32:35], v[0:15]
  ds_read_b128 v[44:47], v206 offset:40960
  v_mfma_f32_32x32x16_bf16 v[16:31], a[208:211], v[32:35], v[16:31]
  s_waitcnt lgkmcnt(2)
  v_mfma_f32_32x32x16_bf16 v[0:15], a[68:71], v[36:39], v[0:15]
  ds_read_b128 v[32:35], v203 offset:41984
  v_mfma_f32_32x32x16_bf16 v[16:31], a[212:215], v[36:39], v[16:31]
  s_waitcnt lgkmcnt(2)
  v_mfma_f32_32x32x16_bf16 v[0:15], a[72:75], v[40:43], v[0:15]
  ds_read_b128 v[36:39], v204 offset:41984
  v_mfma_f32_32x32x16_bf16 v[16:31], a[216:219], v[40:43], v[16:31]
  s_waitcnt lgkmcnt(2)
  v_mfma_f32_32x32x16_bf16 v[0:15], a[76:79], v[44:47], v[0:15]
  ds_read_b128 v[40:43], v205 offset:41984
  v_mfma_f32_32x32x16_bf16 v[16:31], a[220:223], v[44:47], v[16:31]
  s_waitcnt lgkmcnt(2)
  v_mfma_f32_32x32x16_bf16 v[0:15], a[80:83], v[32:35], v[0:15]
  ds_read_b128 v[44:47], v206 offset:41984
  v_mfma_f32_32x32x16_bf16 v[16:31], a[224:227], v[32:35], v[16:31]
  s_waitcnt lgkmcnt(2)
  v_mfma_f32_32x32x16_bf16 v[0:15], a[84:87], v[36:39], v[0:15]
  ds_read_b128 v[32:35], v203 offset:43008
  v_mfma_f32_32x32x16_bf16 v[16:31], a[228:231], v[36:39], v[16:31]
  s_waitcnt lgkmcnt(2)
  v_mfma_f32_32x32x16_bf16 v[0:15], a[88:91], v[40:43], v[0:15]
  ds_read_b128 v[36:39], v204 offset:43008
  v_mfma_f32_32x32x16_bf16 v[16:31], a[232:235], v[40:43], v[16:31]
  s_waitcnt lgkmcnt(2)
  v_mfma_f32_32x32x16_bf16 v[0:15], a[92:95], v[44:47], v[0:15]
  ds_read_b128 v[40:43], v205 offset:43008
  v_mfma_f32_32x32x16_bf16 v[16:31], a[236:239], v[44:47], v[16:31]
  s_waitcnt lgkmcnt(2)
  v_mfma_f32_32x32x16_bf16 v[0:15], a[96:99], v[32:35], v[0:15]
  ds_read_b128 v[44:47], v206 offset:43008
  v_mfma_f32_32x32x16_bf16 v[16:31], a[240:243], v[32:35], v[16:31]
  s_waitcnt lgkmcnt(2)
  v_mfma_f32_32x32x16_bf16 v[0:15], a[100:103], v[36:39], v[0:15]
  ds_read_b128 v[32:35], v203 offset:44032
  v_mfma_f32_32x32x16_bf16 v[16:31], a[244:247], v[36:39], v[16:31]
  s_waitcnt lgkmcnt(2)
  v_mfma_f32_32x32x16_bf16 v[0:15], a[104:107], v[40:43], v[0:15]
  ds_read_b128 v[36:39], v204 offset:44032
  v_mfma_f32_32x32x16_bf16 v[16:31], a[248:251], v[40:43], v[16:31]
  s_waitcnt lgkmcnt(2)
  v_mfma_f32_32x32x16_bf16 v[0:15], a[108:111], v[44:47], v[0:15]
  ds_read_b128 v[40:43], v205 offset:44032
  v_mfma_f32_32x32x16_bf16 v[16:31], a[252:255], v[44:47], v[16:31]
  s_waitcnt lgkmcnt(2)
  v_mfma_f32_32x32x16_bf16 v[0:15], a[112:115], v[32:35], v[0:15]
  ds_read_b128 v[44:47], v206 offset:44032
  v_mfma_f32_32x32x16_bf16 v[16:31], v[224:227], v[32:35], v[16:31]
  s_waitcnt lgkmcnt(2)
  v_mfma_f32_32x32x16_bf16 v[0:15], a[116:119], v[36:39], v[0:15]
  ds_read_b128 v[32:35], v203 offset:45056
  v_mfma_f32_32x32x16_bf16 v[16:31], v[228:231], v[36:39], v[16:31]
  s_waitcnt lgkmcnt(2)
  v_mfma_f32_32x32x16_bf16 v[0:15], a[120:123], v[40:43], v[0:15]
  ds_read_b128 v[36:39], v204 offset:45056
  v_mfma_f32_32x32x16_bf16 v[16:31], v[232:235], v[40:43], v[16:31]
  s_waitcnt lgkmcnt(2)
  v_mfma_f32_32x32x16_bf16 v[0:15], a[124:127], v[44:47], v[0:15]
  ds_read_b128 v[40:43], v205 offset:45056
  v_mfma_f32_32x32x16_bf16 v[16:31], v[236:239], v[44:47], v[16:31]
  s_waitcnt lgkmcnt(2)
  v_mfma_f32_32x32x16_bf16 v[0:15], a[128:131], v[32:35], v[0:15]
  ds_read_b128 v[44:47], v206 offset:45056
  v_mfma_f32_32x32x16_bf16 v[16:31], v[240:243], v[32:35], v[16:31]
  s_waitcnt lgkmcnt(2)
  v_mfma_f32_32x32x16_bf16 v[0:15], a[132:135], v[36:39], v[0:15]
  v_mfma_f32_32x32x16_bf16 v[16:31], v[244:247], v[36:39], v[16:31]
  s_waitcnt lgkmcnt(1)
  v_mfma_f32_32x32x16_bf16 v[0:15], a[136:139], v[40:43], v[0:15]
  v_mfma_f32_32x32x16_bf16 v[16:31], v[248:251], v[40:43], v[16:31]
  s_waitcnt lgkmcnt(0)
  v_mfma_f32_32x32x16_bf16 v[0:15], a[140:143], v[44:47], v[0:15]
  v_mfma_f32_32x32x16_bf16 v[16:31], v[252:255], v[44:47], v[16:31]
  s_add_u32 s60, s60, 36864
  s_nop 2
  v_cvt_pk_bf16_f32 v48, v0, v1
  v_cvt_pk_bf16_f32 v49, v2, v3
  ds_write2_b32 v218, v48, v49 offset0:0 offset1:1
  v_cvt_pk_bf16_f32 v48, v4, v5
  v_cvt_pk_bf16_f32 v49, v6, v7
  ds_write2_b32 v218, v48, v49 offset0:4 offset1:5
  v_cvt_pk_bf16_f32 v48, v8, v9
  v_cvt_pk_bf16_f32 v49, v10, v11
  ds_write2_b32 v218, v48, v49 offset0:8 offset1:9
  v_cvt_pk_bf16_f32 v48, v12, v13
  v_cvt_pk_bf16_f32 v49, v14, v15
  ds_write2_b32 v218, v48, v49 offset0:12 offset1:13
  v_cvt_pk_bf16_f32 v48, v16, v17
  v_cvt_pk_bf16_f32 v49, v18, v19
  ds_write2_b32 v218, v48, v49 offset0:64 offset1:65
  v_cvt_pk_bf16_f32 v48, v20, v21
  v_cvt_pk_bf16_f32 v49, v22, v23
  ds_write2_b32 v218, v48, v49 offset0:68 offset1:69
  v_cvt_pk_bf16_f32 v48, v24, v25
  v_cvt_pk_bf16_f32 v49, v26, v27
  ds_write2_b32 v218, v48, v49 offset0:72 offset1:73
  v_cvt_pk_bf16_f32 v48, v28, v29
  v_cvt_pk_bf16_f32 v49, v30, v31
  ds_write2_b32 v218, v48, v49 offset0:76 offset1:77
  v_add_u32 v218, 16512, v218
  s_waitcnt vmcnt(0) lgkmcnt(0)
  s_barrier
  ds_read_b128 v[32:35], v203 offset:0
  ds_read_b128 v[36:39], v204 offset:0
  ds_read_b128 v[40:43], v205 offset:0
  s_waitcnt lgkmcnt(2)
  v_mfma_f32_32x32x16_bf16 v[0:15], a[0:3], v[32:35], 0
  ds_read_b128 v[44:47], v206 offset:0
  v_mfma_f32_32x32x16_bf16 v[16:31], a[144:147], v[32:35], 0
  s_waitcnt lgkmcnt(2)
  v_mfma_f32_32x32x16_bf16 v[0:15], a[4:7], v[36:39], v[0:15]
  ds_read_b128 v[32:35], v203 offset:1024
  v_mfma_f32_32x32x16_bf16 v[16:31], a[148:151], v[36:39], v[16:31]
  s_waitcnt lgkmcnt(2)
  v_mfma_f32_32x32x16_bf16 v[0:15], a[8:11], v[40:43], v[0:15]
  ds_read_b128 v[36:39], v204 offset:1024
  v_mfma_f32_32x32x16_bf16 v[16:31], a[152:155], v[40:43], v[16:31]
  s_waitcnt lgkmcnt(2)
  v_mfma_f32_32x32x16_bf16 v[0:15], a[12:15], v[44:47], v[0:15]
  ds_read_b128 v[40:43], v205 offset:1024
  v_mfma_f32_32x32x16_bf16 v[16:31], a[156:159], v[44:47], v[16:31]
  s_waitcnt lgkmcnt(2)
  v_mfma_f32_32x32x16_bf16 v[0:15], a[16:19], v[32:35], v[0:15]
  ds_read_b128 v[44:47], v206 offset:1024
  v_mfma_f32_32x32x16_bf16 v[16:31], a[160:163], v[32:35], v[16:31]
  s_waitcnt lgkmcnt(2)
  v_mfma_f32_32x32x16_bf16 v[0:15], a[20:23], v[36:39], v[0:15]
  ds_read_b128 v[32:35], v203 offset:2048
  v_mfma_f32_32x32x16_bf16 v[16:31], a[164:167], v[36:39], v[16:31]
  s_waitcnt lgkmcnt(2)
  v_mfma_f32_32x32x16_bf16 v[0:15], a[24:27], v[40:43], v[0:15]
  ds_read_b128 v[36:39], v204 offset:2048
  v_mfma_f32_32x32x16_bf16 v[16:31], a[168:171], v[40:43], v[16:31]
  s_waitcnt lgkmcnt(2)
  v_mfma_f32_32x32x16_bf16 v[0:15], a[28:31], v[44:47], v[0:15]
  ds_read_b128 v[40:43], v205 offset:2048
  v_mfma_f32_32x32x16_bf16 v[16:31], a[172:175], v[44:47], v[16:31]
  s_waitcnt lgkmcnt(2)
  v_mfma_f32_32x32x16_bf16 v[0:15], a[32:35], v[32:35], v[0:15]
  ds_read_b128 v[44:47], v206 offset:2048
  v_mfma_f32_32x32x16_bf16 v[16:31], a[176:179], v[32:35], v[16:31]
  s_waitcnt lgkmcnt(2)
  v_mfma_f32_32x32x16_bf16 v[0:15], a[36:39], v[36:39], v[0:15]
  ds_read_b128 v[32:35], v203 offset:3072
  v_mfma_f32_32x32x16_bf16 v[16:31], a[180:183], v[36:39], v[16:31]
  s_waitcnt lgkmcnt(2)
  v_mfma_f32_32x32x16_bf16 v[0:15], a[40:43], v[40:43], v[0:15]
  ds_read_b128 v[36:39], v204 offset:3072
  v_mfma_f32_32x32x16_bf16 v[16:31], a[184:187], v[40:43], v[16:31]
  s_waitcnt lgkmcnt(2)
  v_mfma_f32_32x32x16_bf16 v[0:15], a[44:47], v[44:47], v[0:15]
  ds_read_b128 v[40:43], v205 offset:3072
  v_mfma_f32_32x32x16_bf16 v[16:31], a[188:191], v[44:47], v[16:31]
  s_waitcnt lgkmcnt(2)
  v_mfma_f32_32x32x16_bf16 v[0:15], a[48:51], v[32:35], v[0:15]
  ds_read_b128 v[44:47], v206 offset:3072
  v_mfma_f32_32x32x16_bf16 v[16:31], a[192:195], v[32:35], v[16:31]
  s_waitcnt lgkmcnt(2)
  v_mfma_f32_32x32x16_bf16 v[0:15], a[52:55], v[36:39], v[0:15]
  ds_read_b128 v[32:35], v203 offset:4096
  v_mfma_f32_32x32x16_bf16 v[16:31], a[196:199], v[36:39], v[16:31]
  s_waitcnt lgkmcnt(2)
  v_mfma_f32_32x32x16_bf16 v[0:15], a[56:59], v[40:43], v[0:15]
  ds_read_b128 v[36:39], v204 offset:4096
  v_mfma_f32_32x32x16_bf16 v[16:31], a[200:203], v[40:43], v[16:31]
  s_waitcnt lgkmcnt(2)
  v_mfma_f32_32x32x16_bf16 v[0:15], a[60:63], v[44:47], v[0:15]
  ds_read_b128 v[40:43], v205 offset:4096
  v_mfma_f32_32x32x16_bf16 v[16:31], a[204:207], v[44:47], v[16:31]
  s_waitcnt lgkmcnt(2)
  v_mfma_f32_32x32x16_bf16 v[0:15], a[64:67], v[32:35], v[0:15]
  ds_read_b128 v[44:47], v206 offset:4096
  v_mfma_f32_32x32x16_bf16 v[16:31], a[208:211], v[32:35], v[16:31]
  s_waitcnt lgkmcnt(2)
  v_mfma_f32_32x32x16_bf16 v[0:15], a[68:71], v[36:39], v[0:15]
  ds_read_b128 v[32:35], v203 offset:5120
  v_mfma_f32_32x32x16_bf16 v[16:31], a[212:215], v[36:39], v[16:31]
  s_waitcnt lgkmcnt(2)
  v_mfma_f32_32x32x16_bf16 v[0:15], a[72:75], v[40:43], v[0:15]
  ds_read_b128 v[36:39], v204 offset:5120
  v_mfma_f32_32x32x16_bf16 v[16:31], a[216:219], v[40:43], v[16:31]
  s_waitcnt lgkmcnt(2)
  v_mfma_f32_32x32x16_bf16 v[0:15], a[76:79], v[44:47], v[0:15]
  ds_read_b128 v[40:43], v205 offset:5120
  v_mfma_f32_32x32x16_bf16 v[16:31], a[220:223], v[44:47], v[16:31]
  s_waitcnt lgkmcnt(2)
  v_mfma_f32_32x32x16_bf16 v[0:15], a[80:83], v[32:35], v[0:15]
  ds_read_b128 v[44:47], v206 offset:5120
  v_mfma_f32_32x32x16_bf16 v[16:31], a[224:227], v[32:35], v[16:31]
  s_waitcnt lgkmcnt(2)
  v_mfma_f32_32x32x16_bf16 v[0:15], a[84:87], v[36:39], v[0:15]
  ds_read_b128 v[32:35], v203 offset:6144
  v_mfma_f32_32x32x16_bf16 v[16:31], a[228:231], v[36:39], v[16:31]
  s_waitcnt lgkmcnt(2)
  v_mfma_f32_32x32x16_bf16 v[0:15], a[88:91], v[40:43], v[0:15]
  ds_read_b128 v[36:39], v204 offset:6144
  v_mfma_f32_32x32x16_bf16 v[16:31], a[232:235], v[40:43], v[16:31]
  s_waitcnt lgkmcnt(2)
  v_mfma_f32_32x32x16_bf16 v[0:15], a[92:95], v[44:47], v[0:15]
  ds_read_b128 v[40:43], v205 offset:6144
  v_mfma_f32_32x32x16_bf16 v[16:31], a[236:239], v[44:47], v[16:31]
  s_waitcnt lgkmcnt(2)
  v_mfma_f32_32x32x16_bf16 v[0:15], a[96:99], v[32:35], v[0:15]
  ds_read_b128 v[44:47], v206 offset:6144
  v_mfma_f32_32x32x16_bf16 v[16:31], a[240:243], v[32:35], v[16:31]
  s_waitcnt lgkmcnt(2)
  v_mfma_f32_32x32x16_bf16 v[0:15], a[100:103], v[36:39], v[0:15]
  ds_read_b128 v[32:35], v203 offset:7168
  v_mfma_f32_32x32x16_bf16 v[16:31], a[244:247], v[36:39], v[16:31]
  s_waitcnt lgkmcnt(2)
  v_mfma_f32_32x32x16_bf16 v[0:15], a[104:107], v[40:43], v[0:15]
  ds_read_b128 v[36:39], v204 offset:7168
  v_mfma_f32_32x32x16_bf16 v[16:31], a[248:251], v[40:43], v[16:31]
  s_waitcnt lgkmcnt(2)
  v_mfma_f32_32x32x16_bf16 v[0:15], a[108:111], v[44:47], v[0:15]
  ds_read_b128 v[40:43], v205 offset:7168
  v_mfma_f32_32x32x16_bf16 v[16:31], a[252:255], v[44:47], v[16:31]
  s_waitcnt lgkmcnt(2)
  v_mfma_f32_32x32x16_bf16 v[0:15], a[112:115], v[32:35], v[0:15]
  ds_read_b128 v[44:47], v206 offset:7168
  v_mfma_f32_32x32x16_bf16 v[16:31], v[224:227], v[32:35], v[16:31]
  s_waitcnt lgkmcnt(2)
  v_mfma_f32_32x32x16_bf16 v[0:15], a[116:119], v[36:39], v[0:15]
  ds_read_b128 v[32:35], v203 offset:8192
  v_mfma_f32_32x32x16_bf16 v[16:31], v[228:231], v[36:39], v[16:31]
  s_waitcnt lgkmcnt(2)
  v_mfma_f32_32x32x16_bf16 v[0:15], a[120:123], v[40:43], v[0:15]
  ds_read_b128 v[36:39], v204 offset:8192
  v_mfma_f32_32x32x16_bf16 v[16:31], v[232:235], v[40:43], v[16:31]
  s_waitcnt lgkmcnt(2)
  v_mfma_f32_32x32x16_bf16 v[0:15], a[124:127], v[44:47], v[0:15]
  ds_read_b128 v[40:43], v205 offset:8192
  v_mfma_f32_32x32x16_bf16 v[16:31], v[236:239], v[44:47], v[16:31]
  s_waitcnt lgkmcnt(2)
  v_mfma_f32_32x32x16_bf16 v[0:15], a[128:131], v[32:35], v[0:15]
  ds_read_b128 v[44:47], v206 offset:8192
  v_mfma_f32_32x32x16_bf16 v[16:31], v[240:243], v[32:35], v[16:31]
  s_waitcnt lgkmcnt(2)
  v_mfma_f32_32x32x16_bf16 v[0:15], a[132:135], v[36:39], v[0:15]
  v_mfma_f32_32x32x16_bf16 v[16:31], v[244:247], v[36:39], v[16:31]
  s_waitcnt lgkmcnt(1)
  v_mfma_f32_32x32x16_bf16 v[0:15], a[136:139], v[40:43], v[0:15]
  v_mfma_f32_32x32x16_bf16 v[16:31], v[248:251], v[40:43], v[16:31]
  s_waitcnt lgkmcnt(0)
  v_mfma_f32_32x32x16_bf16 v[0:15], a[140:143], v[44:47], v[0:15]
  v_mfma_f32_32x32x16_bf16 v[16:31], v[252:255], v[44:47], v[16:31]
  s_add_u32 s60, s60, 36864
  s_nop 2
  v_cvt_pk_bf16_f32 v48, v0, v1
  v_cvt_pk_bf16_f32 v49, v2, v3
  ds_write2_b32 v218, v48, v49 offset0:0 offset1:1
  v_cvt_pk_bf16_f32 v48, v4, v5
  v_cvt_pk_bf16_f32 v49, v6, v7
  ds_write2_b32 v218, v48, v49 offset0:4 offset1:5
  v_cvt_pk_bf16_f32 v48, v8, v9
  v_cvt_pk_bf16_f32 v49, v10, v11
  ds_write2_b32 v218, v48, v49 offset0:8 offset1:9
  v_cvt_pk_bf16_f32 v48, v12, v13
  v_cvt_pk_bf16_f32 v49, v14, v15
  ds_write2_b32 v218, v48, v49 offset0:12 offset1:13
  v_cvt_pk_bf16_f32 v48, v16, v17
  v_cvt_pk_bf16_f32 v49, v18, v19
  ds_write2_b32 v218, v48, v49 offset0:64 offset1:65
  v_cvt_pk_bf16_f32 v48, v20, v21
  v_cvt_pk_bf16_f32 v49, v22, v23
  ds_write2_b32 v218, v48, v49 offset0:68 offset1:69
  v_cvt_pk_bf16_f32 v48, v24, v25
  v_cvt_pk_bf16_f32 v49, v26, v27
  ds_write2_b32 v218, v48, v49 offset0:72 offset1:73
  v_cvt_pk_bf16_f32 v48, v28, v29
  v_cvt_pk_bf16_f32 v49, v30, v31
  ds_write2_b32 v218, v48, v49 offset0:76 offset1:77
  v_add_u32 v218, 16512, v218
  s_waitcnt vmcnt(0) lgkmcnt(0)
  s_barrier
  v_mul_u32_u24 v219, 516, v200
  s_mul_i32 s54, s52, 36
  s_add_u32 s55, s54, 83016
  v_add_u32 v219, s55, v219
  v_mul_u32_u24 v220, 1152, v200
  s_mul_i32 s55, s68, 144
  s_add_u32 s54, s54, s55
  s_mul_i32 s55, s69, 147456
  s_add_u32 s64, s54, s55
  s_add_u32 s64, s64, 62914560
  s_lshl_b32 s66, s69, 7
  s_mov_b32 s57, 1051597459
  ds_read_b32 v0, v219 offset:7224
  ds_read_b32 v1, v219 offset:7228
  ds_read_b32 v2, v219 offset:7232
  ds_read_b32 v3, v219 offset:7236
  ds_read_b32 v4, v219 offset:7240
  ds_read_b32 v5, v219 offset:7244
  ds_read_b32 v6, v219 offset:7248
  ds_read_b32 v7, v219 offset:7252
  ds_read_b32 v8, v219 offset:7256
  ds_read_b32 v16, v219 offset:7368
  ds_read_b32 v17, v219 offset:7372
  ds_read_b32 v18, v219 offset:7376
  ds_read_b32 v19, v219 offset:7380
  ds_read_b32 v20, v219 offset:7384
  ds_read_b32 v21, v219 offset:7388
  ds_read_b32 v22, v219 offset:7392
  ds_read_b32 v23, v219 offset:7396
  ds_read_b32 v24, v219 offset:7400
  ds_read_b32 v25, v219 offset:6336
  ds_read_b32 v26, v219 offset:6340
  ds_read_b32 v27, v219 offset:6344
  ds_read_b32 v28, v219 offset:6348
  ds_read_b32 v29, v219 offset:6352
  ds_read_b32 v30, v219 offset:6356
  ds_read_b32 v31, v219 offset:6360
  ds_read_b32 v32, v219 offset:6364
  ds_read_b32 v33, v219 offset:6368
  ds_read_b32 v34, v219 offset:5304
  ds_read_b32 v35, v219 offset:5308
  ds_read_b32 v36, v219 offset:5312
  ds_read_b32 v37, v219 offset:5316
  ds_read_b32 v38, v219 offset:5320
  ds_read_b32 v39, v219 offset:5324
  ds_read_b32 v40, v219 offset:5328
  ds_read_b32 v41, v219 offset:5332
  ds_read_b32 v42, v219 offset:5336
  ds_read_b32 v43, v219 offset:4272
  ds_read_b32 v44, v219 offset:4276
  ds_read_b32 v45, v219 offset:4280
  ds_read_b32 v46, v219 offset:4284
  ds_read_b32 v47, v219 offset:4288
  ds_read_b32 v48, v219 offset:4292
  ds_read_b32 v49, v219 offset:4296
  ds_read_b32 v50, v219 offset:4300
  ds_read_b32 v51, v219 offset:4304
  ds_read_b32 v52, v219 offset:3240
  ds_read_b32 v53, v219 offset:3244
  ds_read_b32 v54, v219 offset:3248
  ds_read_b32 v55, v219 offset:3252
  ds_read_b32 v56, v219 offset:3256
  ds_read_b32 v57, v219 offset:3260
  ds_read_b32 v58, v219 offset:3264
  ds_read_b32 v59, v219 offset:3268
  ds_read_b32 v60, v219 offset:3272
  ds_read_b32 v61, v219 offset:2208
  ds_read_b32 v62, v219 offset:2212
  ds_read_b32 v63, v219 offset:2216
  ds_read_b32 v64, v219 offset:2220
  ds_read_b32 v65, v219 offset:2224
  ds_read_b32 v66, v219 offset:2228
  ds_read_b32 v67, v219 offset:2232
  ds_read_b32 v68, v219 offset:2236
  ds_read_b32 v69, v219 offset:2240
  ds_read_b32 v70, v219 offset:1176
  ds_read_b32 v71, v219 offset:1180
  ds_read_b32 v72, v219 offset:1184
  ds_read_b32 v73, v219 offset:1188
  ds_read_b32 v74, v219 offset:1192
  ds_read_b32 v75, v219 offset:1196
  ds_read_b32 v76, v219 offset:1200
  ds_read_b32 v77, v219 offset:1204
  ds_read_b32 v78, v219 offset:1208
  ds_read_b32 v79, v219 offset:144
  ds_read_b32 v80, v219 offset:148
  ds_read_b32 v81, v219 offset:152
  ds_read_b32 v82, v219 offset:156
  ds_read_b32 v83, v219 offset:160
  ds_read_b32 v84, v219 offset:164
  ds_read_b32 v85, v219 offset:168
  ds_read_b32 v86, v219 offset:172
  ds_read_b32 v87, v219 offset:176
  v_mov_b32 v100, 0
  v_mov_b32 v101, 0
  v_mov_b32 v102, 0
  v_mov_b32 v103, 0
  v_mov_b32 v104, 0
  v_mov_b32 v105, 0
  v_mov_b32 v106, 0
  v_mov_b32 v107, 0
  s_waitcnt lgkmcnt(15)
  v_dot2c_f32_bf16 v100, v0, v16
  v_dot2c_f32_bf16 v101, v0, v25
  v_dot2c_f32_bf16 v102, v0, v34
  v_dot2c_f32_bf16 v103, v0, v43
  v_dot2c_f32_bf16 v104, v0, v52
  v_dot2c_f32_bf16 v105, v0, v61
  v_dot2c_f32_bf16 v106, v0, v70
  s_waitcnt lgkmcnt(8)
  v_dot2c_f32_bf16 v107, v0, v79
  v_dot2c_f32_bf16 v100, v1, v17
  v_dot2c_f32_bf16 v101, v1, v26
  v_dot2c_f32_bf16 v102, v1, v35
  v_dot2c_f32_bf16 v103, v1, v44
  v_dot2c_f32_bf16 v104, v1, v53
  v_dot2c_f32_bf16 v105, v1, v62
  v_dot2c_f32_bf16 v106, v1, v71
  s_waitcnt lgkmcnt(7)
  v_dot2c_f32_bf16 v107, v1, v80
  v_dot2c_f32_bf16 v100, v2, v18
  v_dot2c_f32_bf16 v101, v2, v27
  v_dot2c_f32_bf16 v102, v2, v36
  v_dot2c_f32_bf16 v103, v2, v45
  v_dot2c_f32_bf16 v104, v2, v54
  v_dot2c_f32_bf16 v105, v2, v63
  v_dot2c_f32_bf16 v106, v2, v72
  s_waitcnt lgkmcnt(6)
  v_dot2c_f32_bf16 v107, v2, v81
  v_dot2c_f32_bf16 v100, v3, v19
  v_dot2c_f32_bf16 v101, v3, v28
  v_dot2c_f32_bf16 v102, v3, v37
  v_dot2c_f32_bf16 v103, v3, v46
  v_dot2c_f32_bf16 v104, v3, v55
  v_dot2c_f32_bf16 v105, v3, v64
  v_dot2c_f32_bf16 v106, v3, v73
  s_waitcnt lgkmcnt(5)
  v_dot2c_f32_bf16 v107, v3, v82
  v_dot2c_f32_bf16 v100, v4, v20
  v_dot2c_f32_bf16 v101, v4, v29
  v_dot2c_f32_bf16 v102, v4, v38
  v_dot2c_f32_bf16 v103, v4, v47
  v_dot2c_f32_bf16 v104, v4, v56
  v_dot2c_f32_bf16 v105, v4, v65
  v_dot2c_f32_bf16 v106, v4, v74
  s_waitcnt lgkmcnt(4)
  v_dot2c_f32_bf16 v107, v4, v83
  v_dot2c_f32_bf16 v100, v5, v21
  v_dot2c_f32_bf16 v101, v5, v30
  v_dot2c_f32_bf16 v102, v5, v39
  v_dot2c_f32_bf16 v103, v5, v48
  v_dot2c_f32_bf16 v104, v5, v57
  v_dot2c_f32_bf16 v105, v5, v66
  v_dot2c_f32_bf16 v106, v5, v75
  s_waitcnt lgkmcnt(3)
  v_dot2c_f32_bf16 v107, v5, v84
  v_dot2c_f32_bf16 v100, v6, v22
  v_dot2c_f32_bf16 v101, v6, v31
  v_dot2c_f32_bf16 v102, v6, v40
  v_dot2c_f32_bf16 v103, v6, v49
  v_dot2c_f32_bf16 v104, v6, v58
  v_dot2c_f32_bf16 v105, v6, v67
  v_dot2c_f32_bf16 v106, v6, v76
  s_waitcnt lgkmcnt(2)
  v_dot2c_f32_bf16 v107, v6, v85
  v_dot2c_f32_bf16 v100, v7, v23
  v_dot2c_f32_bf16 v101, v7, v32
  v_dot2c_f32_bf16 v102, v7, v41
  v_dot2c_f32_bf16 v103, v7, v50
  v_dot2c_f32_bf16 v104, v7, v59
  v_dot2c_f32_bf16 v105, v7, v68
  v_dot2c_f32_bf16 v106, v7, v77
  s_waitcnt lgkmcnt(1)
  v_dot2c_f32_bf16 v107, v7, v86
  v_dot2c_f32_bf16 v100, v8, v24
  v_dot2c_f32_bf16 v101, v8, v33
  v_dot2c_f32_bf16 v102, v8, v42
  v_dot2c_f32_bf16 v103, v8, v51
  v_dot2c_f32_bf16 v104, v8, v60
  v_dot2c_f32_bf16 v105, v8, v69
  v_dot2c_f32_bf16 v106, v8, v78
  s_waitcnt lgkmcnt(0)
  v_dot2c_f32_bf16 v107, v8, v87
  ds_read_b32 v16, v219 offset:7512
  ds_read_b32 v17, v219 offset:7516
  ds_read_b32 v18, v219 offset:7520
  ds_read_b32 v19, v219 offset:7524
  ds_read_b32 v20, v219 offset:7528
  ds_read_b32 v21, v219 offset:7532
  ds_read_b32 v22, v219 offset:7536
  ds_read_b32 v23, v219 offset:7540
  ds_read_b32 v24, v219 offset:7544
  ds_read_b32 v25, v219 offset:6480
  ds_read_b32 v26, v219 offset:6484
  ds_read_b32 v27, v219 offset:6488
  ds_read_b32 v28, v219 offset:6492
  ds_read_b32 v29, v219 offset:6496
  ds_read_b32 v30, v219 offset:6500
  ds_read_b32 v31, v219 offset:6504
  ds_read_b32 v32, v219 offset:6508
  ds_read_b32 v33, v219 offset:6512
  ds_read_b32 v34, v219 offset:5448
  ds_read_b32 v35, v219 offset:5452
  ds_read_b32 v36, v219 offset:5456
  ds_read_b32 v37, v219 offset:5460
  ds_read_b32 v38, v219 offset:5464
  ds_read_b32 v39, v219 offset:5468
  ds_read_b32 v40, v219 offset:5472
  ds_read_b32 v41, v219 offset:5476
  ds_read_b32 v42, v219 offset:5480
  ds_read_b32 v43, v219 offset:4416
  ds_read_b32 v44, v219 offset:4420
  ds_read_b32 v45, v219 offset:4424
  ds_read_b32 v46, v219 offset:4428
  ds_read_b32 v47, v219 offset:4432
  ds_read_b32 v48, v219 offset:4436
  ds_read_b32 v49, v219 offset:4440
  ds_read_b32 v50, v219 offset:4444
  ds_read_b32 v51, v219 offset:4448
  ds_read_b32 v52, v219 offset:3384
  ds_read_b32 v53, v219 offset:3388
  ds_read_b32 v54, v219 offset:3392
  ds_read_b32 v55, v219 offset:3396
  ds_read_b32 v56, v219 offset:3400
  ds_read_b32 v57, v219 offset:3404
  ds_read_b32 v58, v219 offset:3408
  ds_read_b32 v59, v219 offset:3412
  ds_read_b32 v60, v219 offset:3416
  ds_read_b32 v61, v219 offset:2352
  ds_read_b32 v62, v219 offset:2356
  ds_read_b32 v63, v219 offset:2360
  ds_read_b32 v64, v219 offset:2364
  ds_read_b32 v65, v219 offset:2368
  ds_read_b32 v66, v219 offset:2372
  ds_read_b32 v67, v219 offset:2376
  ds_read_b32 v68, v219 offset:2380
  ds_read_b32 v69, v219 offset:2384
  ds_read_b32 v70, v219 offset:1320
  ds_read_b32 v71, v219 offset:1324
  ds_read_b32 v72, v219 offset:1328
  ds_read_b32 v73, v219 offset:1332
  ds_read_b32 v74, v219 offset:1336
  ds_read_b32 v75, v219 offset:1340
  ds_read_b32 v76, v219 offset:1344
  ds_read_b32 v77, v219 offset:1348
  ds_read_b32 v78, v219 offset:1352
  ds_read_b32 v79, v219 offset:288
  ds_read_b32 v80, v219 offset:292
  ds_read_b32 v81, v219 offset:296
  ds_read_b32 v82, v219 offset:300
  ds_read_b32 v83, v219 offset:304
  ds_read_b32 v84, v219 offset:308
  ds_read_b32 v85, v219 offset:312
  ds_read_b32 v86, v219 offset:316
  ds_read_b32 v87, v219 offset:320
  v_add_u32 v211, s66, v200
  v_mov_b32 v212, 0xf149f2ca
  v_mul_f32 v100, s57, v100
  v_mul_f32 v101, s57, v101
  v_mul_f32 v102, s57, v102
  v_mul_f32 v103, s57, v103
  v_mul_f32 v104, s57, v104
  v_mul_f32 v105, s57, v105
  v_mul_f32 v106, s57, v106
  v_mul_f32 v107, s57, v107
  v_cmp_gt_u32 vcc, 2, v211
  s_nop 1
  v_cndmask_b32 v101, v101, v212, vcc
  v_cmp_gt_u32 vcc, 4, v211
  s_nop 1
  v_cndmask_b32 v102, v102, v212, vcc
  v_cmp_gt_u32 vcc, 6, v211
  s_nop 1
  v_cndmask_b32 v103, v103, v212, vcc
  v_cmp_gt_u32 vcc, 8, v211
  s_nop 1
  v_cndmask_b32 v104, v104, v212, vcc
  v_cmp_gt_u32 vcc, 10, v211
  s_nop 1
  v_cndmask_b32 v105, v105, v212, vcc
  v_cmp_gt_u32 vcc, 12, v211
  s_nop 1
  v_cndmask_b32 v106, v106, v212, vcc
  v_cmp_gt_u32 vcc, 14, v211
  s_nop 1
  v_cndmask_b32 v107, v107, v212, vcc
  v_max3_f32 v213, v100, v101, v102
  v_max3_f32 v213, v213, v103, v104
  v_max3_f32 v213, v213, v105, v106
  v_max_f32 v213, v213, v107
  v_sub_f32 v100, v100, v213
  v_sub_f32 v101, v101, v213
  v_sub_f32 v102, v102, v213
  v_sub_f32 v103, v103, v213
  v_sub_f32 v104, v104, v213
  v_sub_f32 v105, v105, v213
  v_sub_f32 v106, v106, v213
  v_sub_f32 v107, v107, v213
  v_exp_f32 v100, v100
  v_exp_f32 v101, v101
  v_exp_f32 v102, v102
  v_exp_f32 v103, v103
  v_exp_f32 v104, v104
  v_exp_f32 v105, v105
  v_exp_f32 v106, v106
  v_exp_f32 v107, v107
  v_add_f32 v213, v100, v101
  v_add_f32 v213, v213, v102
  v_add_f32 v213, v213, v103
  v_add_f32 v213, v213, v104
  v_add_f32 v213, v213, v105
  v_add_f32 v213, v213, v106
  v_add_f32 v213, v213, v107
  v_rcp_f32 v213, v213
  v_mov_b32 v214, 0
  v_mul_f32 v100, v213, v100
  v_mul_f32 v101, v213, v101
  v_mul_f32 v102, v213, v102
  v_mul_f32 v103, v213, v103
  v_mul_f32 v104, v213, v104
  v_mul_f32 v105, v213, v105
  v_mul_f32 v106, v213, v106
  v_mul_f32 v107, v213, v107
  v_mov_b32 v112, 0
  v_mov_b32 v113, 0
  v_mov_b32 v114, 0
  v_mov_b32 v115, 0
  v_mov_b32 v116, 0
  v_mov_b32 v117, 0
  v_mov_b32 v118, 0
  v_mov_b32 v119, 0
  v_mov_b32 v120, 0
  v_mov_b32 v121, 0
  v_mov_b32 v122, 0
  v_mov_b32 v123, 0
  v_mov_b32 v124, 0
  v_mov_b32 v125, 0
  v_mov_b32 v126, 0
  v_mov_b32 v127, 0
  v_mov_b32 v128, 0
  v_mov_b32 v129, 0
  v_cvt_pk_bf16_f32 v0, v100, v214
  v_cvt_pk_bf16_f32 v1, v214, v100
  s_waitcnt lgkmcnt(15)
  v_dot2c_f32_bf16 v112, v16, v0
  v_dot2c_f32_bf16 v113, v16, v1
  v_dot2c_f32_bf16 v114, v17, v0
  v_dot2c_f32_bf16 v115, v17, v1
  v_dot2c_f32_bf16 v116, v18, v0
  v_dot2c_f32_bf16 v117, v18, v1
  v_dot2c_f32_bf16 v118, v19, v0
  v_dot2c_f32_bf16 v119, v19, v1
  v_dot2c_f32_bf16 v120, v20, v0
  v_dot2c_f32_bf16 v121, v20, v1
  v_dot2c_f32_bf16 v122, v21, v0
  v_dot2c_f32_bf16 v123, v21, v1
  v_dot2c_f32_bf16 v124, v22, v0
  v_dot2c_f32_bf16 v125, v22, v1
  v_dot2c_f32_bf16 v126, v23, v0
  v_dot2c_f32_bf16 v127, v23, v1
  v_dot2c_f32_bf16 v128, v24, v0
  v_dot2c_f32_bf16 v129, v24, v1
  v_cvt_pk_bf16_f32 v2, v101, v214
  v_cvt_pk_bf16_f32 v3, v214, v101
  v_dot2c_f32_bf16 v112, v25, v2
  v_dot2c_f32_bf16 v113, v25, v3
  v_dot2c_f32_bf16 v114, v26, v2
  v_dot2c_f32_bf16 v115, v26, v3
  v_dot2c_f32_bf16 v116, v27, v2
  v_dot2c_f32_bf16 v117, v27, v3
  v_dot2c_f32_bf16 v118, v28, v2
  v_dot2c_f32_bf16 v119, v28, v3
  v_dot2c_f32_bf16 v120, v29, v2
  v_dot2c_f32_bf16 v121, v29, v3
  v_dot2c_f32_bf16 v122, v30, v2
  v_dot2c_f32_bf16 v123, v30, v3
  v_dot2c_f32_bf16 v124, v31, v2
  v_dot2c_f32_bf16 v125, v31, v3
  v_dot2c_f32_bf16 v126, v32, v2
  v_dot2c_f32_bf16 v127, v32, v3
  v_dot2c_f32_bf16 v128, v33, v2
  v_dot2c_f32_bf16 v129, v33, v3
  v_cvt_pk_bf16_f32 v0, v102, v214
  v_cvt_pk_bf16_f32 v1, v214, v102
  v_dot2c_f32_bf16 v112, v34, v0
  v_dot2c_f32_bf16 v113, v34, v1
  v_dot2c_f32_bf16 v114, v35, v0
  v_dot2c_f32_bf16 v115, v35, v1
  v_dot2c_f32_bf16 v116, v36, v0
  v_dot2c_f32_bf16 v117, v36, v1
  v_dot2c_f32_bf16 v118, v37, v0
  v_dot2c_f32_bf16 v119, v37, v1
  v_dot2c_f32_bf16 v120, v38, v0
  v_dot2c_f32_bf16 v121, v38, v1
  v_dot2c_f32_bf16 v122, v39, v0
  v_dot2c_f32_bf16 v123, v39, v1
  v_dot2c_f32_bf16 v124, v40, v0
  v_dot2c_f32_bf16 v125, v40, v1
  v_dot2c_f32_bf16 v126, v41, v0
  v_dot2c_f32_bf16 v127, v41, v1
  v_dot2c_f32_bf16 v128, v42, v0
  v_dot2c_f32_bf16 v129, v42, v1
  v_cvt_pk_bf16_f32 v2, v103, v214
  v_cvt_pk_bf16_f32 v3, v214, v103
  v_dot2c_f32_bf16 v112, v43, v2
  v_dot2c_f32_bf16 v113, v43, v3
  v_dot2c_f32_bf16 v114, v44, v2
  v_dot2c_f32_bf16 v115, v44, v3
  v_dot2c_f32_bf16 v116, v45, v2
  v_dot2c_f32_bf16 v117, v45, v3
  v_dot2c_f32_bf16 v118, v46, v2
  v_dot2c_f32_bf16 v119, v46, v3
  v_dot2c_f32_bf16 v120, v47, v2
  v_dot2c_f32_bf16 v121, v47, v3
  v_dot2c_f32_bf16 v122, v48, v2
  v_dot2c_f32_bf16 v123, v48, v3
  v_dot2c_f32_bf16 v124, v49, v2
  v_dot2c_f32_bf16 v125, v49, v3
  v_dot2c_f32_bf16 v126, v50, v2
  v_dot2c_f32_bf16 v127, v50, v3
  v_dot2c_f32_bf16 v128, v51, v2
  v_dot2c_f32_bf16 v129, v51, v3
  v_cvt_pk_bf16_f32 v0, v104, v214
  v_cvt_pk_bf16_f32 v1, v214, v104
  v_dot2c_f32_bf16 v112, v52, v0
  v_dot2c_f32_bf16 v113, v52, v1
  v_dot2c_f32_bf16 v114, v53, v0
  v_dot2c_f32_bf16 v115, v53, v1
  v_dot2c_f32_bf16 v116, v54, v0
  v_dot2c_f32_bf16 v117, v54, v1
  v_dot2c_f32_bf16 v118, v55, v0
  v_dot2c_f32_bf16 v119, v55, v1
  v_dot2c_f32_bf16 v120, v56, v0
  v_dot2c_f32_bf16 v121, v56, v1
  v_dot2c_f32_bf16 v122, v57, v0
  v_dot2c_f32_bf16 v123, v57, v1
  v_dot2c_f32_bf16 v124, v58, v0
  v_dot2c_f32_bf16 v125, v58, v1
  v_dot2c_f32_bf16 v126, v59, v0
  v_dot2c_f32_bf16 v127, v59, v1
  v_dot2c_f32_bf16 v128, v60, v0
  v_dot2c_f32_bf16 v129, v60, v1
  v_cvt_pk_bf16_f32 v2, v105, v214
  v_cvt_pk_bf16_f32 v3, v214, v105
  v_dot2c_f32_bf16 v112, v61, v2
  v_dot2c_f32_bf16 v113, v61, v3
  v_dot2c_f32_bf16 v114, v62, v2
  v_dot2c_f32_bf16 v115, v62, v3
  v_dot2c_f32_bf16 v116, v63, v2
  v_dot2c_f32_bf16 v117, v63, v3
  v_dot2c_f32_bf16 v118, v64, v2
  v_dot2c_f32_bf16 v119, v64, v3
  v_dot2c_f32_bf16 v120, v65, v2
  v_dot2c_f32_bf16 v121, v65, v3
  v_dot2c_f32_bf16 v122, v66, v2
  v_dot2c_f32_bf16 v123, v66, v3
  v_dot2c_f32_bf16 v124, v67, v2
  v_dot2c_f32_bf16 v125, v67, v3
  v_dot2c_f32_bf16 v126, v68, v2
  v_dot2c_f32_bf16 v127, v68, v3
  v_dot2c_f32_bf16 v128, v69, v2
  v_dot2c_f32_bf16 v129, v69, v3
  v_cvt_pk_bf16_f32 v0, v106, v214
  v_cvt_pk_bf16_f32 v1, v214, v106
  v_dot2c_f32_bf16 v112, v70, v0
  v_dot2c_f32_bf16 v113, v70, v1
  v_dot2c_f32_bf16 v114, v71, v0
  v_dot2c_f32_bf16 v115, v71, v1
  v_dot2c_f32_bf16 v116, v72, v0
  v_dot2c_f32_bf16 v117, v72, v1
  s_waitcnt lgkmcnt(14)
  v_dot2c_f32_bf16 v118, v73, v0
  v_dot2c_f32_bf16 v119, v73, v1
  s_waitcnt lgkmcnt(13)
  v_dot2c_f32_bf16 v120, v74, v0
  v_dot2c_f32_bf16 v121, v74, v1
  s_waitcnt lgkmcnt(12)
  v_dot2c_f32_bf16 v122, v75, v0
  v_dot2c_f32_bf16 v123, v75, v1
  s_waitcnt lgkmcnt(11)
  v_dot2c_f32_bf16 v124, v76, v0
  v_dot2c_f32_bf16 v125, v76, v1
  s_waitcnt lgkmcnt(10)
  v_dot2c_f32_bf16 v126, v77, v0
  v_dot2c_f32_bf16 v127, v77, v1
  s_waitcnt lgkmcnt(9)
  v_dot2c_f32_bf16 v128, v78, v0
  v_dot2c_f32_bf16 v129, v78, v1
  v_cvt_pk_bf16_f32 v2, v107, v214
  v_cvt_pk_bf16_f32 v3, v214, v107
  s_waitcnt lgkmcnt(8)
  v_dot2c_f32_bf16 v112, v79, v2
  v_dot2c_f32_bf16 v113, v79, v3
  s_waitcnt lgkmcnt(7)
  v_dot2c_f32_bf16 v114, v80, v2
  v_dot2c_f32_bf16 v115, v80, v3
  s_waitcnt lgkmcnt(6)
  v_dot2c_f32_bf16 v116, v81, v2
  v_dot2c_f32_bf16 v117, v81, v3
  s_waitcnt lgkmcnt(5)
  v_dot2c_f32_bf16 v118, v82, v2
  v_dot2c_f32_bf16 v119, v82, v3
  s_waitcnt lgkmcnt(4)
  v_dot2c_f32_bf16 v120, v83, v2
  v_dot2c_f32_bf16 v121, v83, v3
  s_waitcnt lgkmcnt(3)
  v_dot2c_f32_bf16 v122, v84, v2
  v_dot2c_f32_bf16 v123, v84, v3
  s_waitcnt lgkmcnt(2)
  v_dot2c_f32_bf16 v124, v85, v2
  v_dot2c_f32_bf16 v125, v85, v3
  s_waitcnt lgkmcnt(1)
  v_dot2c_f32_bf16 v126, v86, v2
  v_dot2c_f32_bf16 v127, v86, v3
  s_waitcnt lgkmcnt(0)
  v_dot2c_f32_bf16 v128, v87, v2
  v_dot2c_f32_bf16 v129, v87, v3
  v_cvt_pk_bf16_f32 v132, v112, v113
  v_cvt_pk_bf16_f32 v133, v114, v115
  v_cvt_pk_bf16_f32 v134, v116, v117
  v_cvt_pk_bf16_f32 v135, v118, v119
  v_cvt_pk_bf16_f32 v136, v120, v121
  v_cvt_pk_bf16_f32 v137, v122, v123
  v_cvt_pk_bf16_f32 v138, v124, v125
  v_cvt_pk_bf16_f32 v139, v126, v127
  v_cvt_pk_bf16_f32 v140, v128, v129
  buffer_store_dwordx4 v[132:135], v220, s[8:11], s64 offen sc1
  buffer_store_dwordx4 v[136:139], v220, s[8:11], s64 offen offset:16 sc1
  buffer_store_dword v140, v220, s[8:11], s64 offen offset:32 sc1
  v_add_u32 v219, 33024, v219
  s_add_u32 s66, s66, 64
  s_add_u32 s64, s64, 73728
  ds_read_b32 v0, v219 offset:7224
  ds_read_b32 v1, v219 offset:7228
  ds_read_b32 v2, v219 offset:7232
  ds_read_b32 v3, v219 offset:7236
  ds_read_b32 v4, v219 offset:7240
  ds_read_b32 v5, v219 offset:7244
  ds_read_b32 v6, v219 offset:7248
  ds_read_b32 v7, v219 offset:7252
  ds_read_b32 v8, v219 offset:7256
  ds_read_b32 v16, v219 offset:7368
  ds_read_b32 v17, v219 offset:7372
  ds_read_b32 v18, v219 offset:7376
  ds_read_b32 v19, v219 offset:7380
  ds_read_b32 v20, v219 offset:7384
  ds_read_b32 v21, v219 offset:7388
  ds_read_b32 v22, v219 offset:7392
  ds_read_b32 v23, v219 offset:7396
  ds_read_b32 v24, v219 offset:7400
  ds_read_b32 v25, v219 offset:6336
  ds_read_b32 v26, v219 offset:6340
  ds_read_b32 v27, v219 offset:6344
  ds_read_b32 v28, v219 offset:6348
  ds_read_b32 v29, v219 offset:6352
  ds_read_b32 v30, v219 offset:6356
  ds_read_b32 v31, v219 offset:6360
  ds_read_b32 v32, v219 offset:6364
  ds_read_b32 v33, v219 offset:6368
  ds_read_b32 v34, v219 offset:5304
  ds_read_b32 v35, v219 offset:5308
  ds_read_b32 v36, v219 offset:5312
  ds_read_b32 v37, v219 offset:5316
  ds_read_b32 v38, v219 offset:5320
  ds_read_b32 v39, v219 offset:5324
  ds_read_b32 v40, v219 offset:5328
  ds_read_b32 v41, v219 offset:5332
  ds_read_b32 v42, v219 offset:5336
  ds_read_b32 v43, v219 offset:4272
  ds_read_b32 v44, v219 offset:4276
  ds_read_b32 v45, v219 offset:4280
  ds_read_b32 v46, v219 offset:4284
  ds_read_b32 v47, v219 offset:4288
  ds_read_b32 v48, v219 offset:4292
  ds_read_b32 v49, v219 offset:4296
  ds_read_b32 v50, v219 offset:4300
  ds_read_b32 v51, v219 offset:4304
  ds_read_b32 v52, v219 offset:3240
  ds_read_b32 v53, v219 offset:3244
  ds_read_b32 v54, v219 offset:3248
  ds_read_b32 v55, v219 offset:3252
  ds_read_b32 v56, v219 offset:3256
  ds_read_b32 v57, v219 offset:3260
  ds_read_b32 v58, v219 offset:3264
  ds_read_b32 v59, v219 offset:3268
  ds_read_b32 v60, v219 offset:3272
  ds_read_b32 v61, v219 offset:2208
  ds_read_b32 v62, v219 offset:2212
  ds_read_b32 v63, v219 offset:2216
  ds_read_b32 v64, v219 offset:2220
  ds_read_b32 v65, v219 offset:2224
  ds_read_b32 v66, v219 offset:2228
  ds_read_b32 v67, v219 offset:2232
  ds_read_b32 v68, v219 offset:2236
  ds_read_b32 v69, v219 offset:2240
  ds_read_b32 v70, v219 offset:1176
  ds_read_b32 v71, v219 offset:1180
  ds_read_b32 v72, v219 offset:1184
  ds_read_b32 v73, v219 offset:1188
  ds_read_b32 v74, v219 offset:1192
  ds_read_b32 v75, v219 offset:1196
  ds_read_b32 v76, v219 offset:1200
  ds_read_b32 v77, v219 offset:1204
  ds_read_b32 v78, v219 offset:1208
  ds_read_b32 v79, v219 offset:144
  ds_read_b32 v80, v219 offset:148
  ds_read_b32 v81, v219 offset:152
  ds_read_b32 v82, v219 offset:156
  ds_read_b32 v83, v219 offset:160
  ds_read_b32 v84, v219 offset:164
  ds_read_b32 v85, v219 offset:168
  ds_read_b32 v86, v219 offset:172
  ds_read_b32 v87, v219 offset:176
  v_mov_b32 v100, 0
  v_mov_b32 v101, 0
  v_mov_b32 v102, 0
  v_mov_b32 v103, 0
  v_mov_b32 v104, 0
  v_mov_b32 v105, 0
  v_mov_b32 v106, 0
  v_mov_b32 v107, 0
  s_waitcnt lgkmcnt(15)
  v_dot2c_f32_bf16 v100, v0, v16
  v_dot2c_f32_bf16 v101, v0, v25
  v_dot2c_f32_bf16 v102, v0, v34
  v_dot2c_f32_bf16 v103, v0, v43
  v_dot2c_f32_bf16 v104, v0, v52
  v_dot2c_f32_bf16 v105, v0, v61
  v_dot2c_f32_bf16 v106, v0, v70
  s_waitcnt lgkmcnt(8)
  v_dot2c_f32_bf16 v107, v0, v79
  v_dot2c_f32_bf16 v100, v1, v17
  v_dot2c_f32_bf16 v101, v1, v26
  v_dot2c_f32_bf16 v102, v1, v35
  v_dot2c_f32_bf16 v103, v1, v44
  v_dot2c_f32_bf16 v104, v1, v53
  v_dot2c_f32_bf16 v105, v1, v62
  v_dot2c_f32_bf16 v106, v1, v71
  s_waitcnt lgkmcnt(7)
  v_dot2c_f32_bf16 v107, v1, v80
  v_dot2c_f32_bf16 v100, v2, v18
  v_dot2c_f32_bf16 v101, v2, v27
  v_dot2c_f32_bf16 v102, v2, v36
  v_dot2c_f32_bf16 v103, v2, v45
  v_dot2c_f32_bf16 v104, v2, v54
  v_dot2c_f32_bf16 v105, v2, v63
  v_dot2c_f32_bf16 v106, v2, v72
  s_waitcnt lgkmcnt(6)
  v_dot2c_f32_bf16 v107, v2, v81
  v_dot2c_f32_bf16 v100, v3, v19
  v_dot2c_f32_bf16 v101, v3, v28
  v_dot2c_f32_bf16 v102, v3, v37
  v_dot2c_f32_bf16 v103, v3, v46
  v_dot2c_f32_bf16 v104, v3, v55
  v_dot2c_f32_bf16 v105, v3, v64
  v_dot2c_f32_bf16 v106, v3, v73
  s_waitcnt lgkmcnt(5)
  v_dot2c_f32_bf16 v107, v3, v82
  v_dot2c_f32_bf16 v100, v4, v20
  v_dot2c_f32_bf16 v101, v4, v29
  v_dot2c_f32_bf16 v102, v4, v38
  v_dot2c_f32_bf16 v103, v4, v47
  v_dot2c_f32_bf16 v104, v4, v56
  v_dot2c_f32_bf16 v105, v4, v65
  v_dot2c_f32_bf16 v106, v4, v74
  s_waitcnt lgkmcnt(4)
  v_dot2c_f32_bf16 v107, v4, v83
  v_dot2c_f32_bf16 v100, v5, v21
  v_dot2c_f32_bf16 v101, v5, v30
  v_dot2c_f32_bf16 v102, v5, v39
  v_dot2c_f32_bf16 v103, v5, v48
  v_dot2c_f32_bf16 v104, v5, v57
  v_dot2c_f32_bf16 v105, v5, v66
  v_dot2c_f32_bf16 v106, v5, v75
  s_waitcnt lgkmcnt(3)
  v_dot2c_f32_bf16 v107, v5, v84
  v_dot2c_f32_bf16 v100, v6, v22
  v_dot2c_f32_bf16 v101, v6, v31
  v_dot2c_f32_bf16 v102, v6, v40
  v_dot2c_f32_bf16 v103, v6, v49
  v_dot2c_f32_bf16 v104, v6, v58
  v_dot2c_f32_bf16 v105, v6, v67
  v_dot2c_f32_bf16 v106, v6, v76
  s_waitcnt lgkmcnt(2)
  v_dot2c_f32_bf16 v107, v6, v85
  v_dot2c_f32_bf16 v100, v7, v23
  v_dot2c_f32_bf16 v101, v7, v32
  v_dot2c_f32_bf16 v102, v7, v41
  v_dot2c_f32_bf16 v103, v7, v50
  v_dot2c_f32_bf16 v104, v7, v59
  v_dot2c_f32_bf16 v105, v7, v68
  v_dot2c_f32_bf16 v106, v7, v77
  s_waitcnt lgkmcnt(1)
  v_dot2c_f32_bf16 v107, v7, v86
  v_dot2c_f32_bf16 v100, v8, v24
  v_dot2c_f32_bf16 v101, v8, v33
  v_dot2c_f32_bf16 v102, v8, v42
  v_dot2c_f32_bf16 v103, v8, v51
  v_dot2c_f32_bf16 v104, v8, v60
  v_dot2c_f32_bf16 v105, v8, v69
  v_dot2c_f32_bf16 v106, v8, v78
  s_waitcnt lgkmcnt(0)
  v_dot2c_f32_bf16 v107, v8, v87
  ds_read_b32 v16, v219 offset:7512
  ds_read_b32 v17, v219 offset:7516
  ds_read_b32 v18, v219 offset:7520
  ds_read_b32 v19, v219 offset:7524
  ds_read_b32 v20, v219 offset:7528
  ds_read_b32 v21, v219 offset:7532
  ds_read_b32 v22, v219 offset:7536
  ds_read_b32 v23, v219 offset:7540
  ds_read_b32 v24, v219 offset:7544
  ds_read_b32 v25, v219 offset:6480
  ds_read_b32 v26, v219 offset:6484
  ds_read_b32 v27, v219 offset:6488
  ds_read_b32 v28, v219 offset:6492
  ds_read_b32 v29, v219 offset:6496
  ds_read_b32 v30, v219 offset:6500
  ds_read_b32 v31, v219 offset:6504
  ds_read_b32 v32, v219 offset:6508
  ds_read_b32 v33, v219 offset:6512
  ds_read_b32 v34, v219 offset:5448
  ds_read_b32 v35, v219 offset:5452
  ds_read_b32 v36, v219 offset:5456
  ds_read_b32 v37, v219 offset:5460
  ds_read_b32 v38, v219 offset:5464
  ds_read_b32 v39, v219 offset:5468
  ds_read_b32 v40, v219 offset:5472
  ds_read_b32 v41, v219 offset:5476
  ds_read_b32 v42, v219 offset:5480
  ds_read_b32 v43, v219 offset:4416
  ds_read_b32 v44, v219 offset:4420
  ds_read_b32 v45, v219 offset:4424
  ds_read_b32 v46, v219 offset:4428
  ds_read_b32 v47, v219 offset:4432
  ds_read_b32 v48, v219 offset:4436
  ds_read_b32 v49, v219 offset:4440
  ds_read_b32 v50, v219 offset:4444
  ds_read_b32 v51, v219 offset:4448
  ds_read_b32 v52, v219 offset:3384
  ds_read_b32 v53, v219 offset:3388
  ds_read_b32 v54, v219 offset:3392
  ds_read_b32 v55, v219 offset:3396
  ds_read_b32 v56, v219 offset:3400
  ds_read_b32 v57, v219 offset:3404
  ds_read_b32 v58, v219 offset:3408
  ds_read_b32 v59, v219 offset:3412
  ds_read_b32 v60, v219 offset:3416
  ds_read_b32 v61, v219 offset:2352
  ds_read_b32 v62, v219 offset:2356
  ds_read_b32 v63, v219 offset:2360
  ds_read_b32 v64, v219 offset:2364
  ds_read_b32 v65, v219 offset:2368
  ds_read_b32 v66, v219 offset:2372
  ds_read_b32 v67, v219 offset:2376
  ds_read_b32 v68, v219 offset:2380
  ds_read_b32 v69, v219 offset:2384
  ds_read_b32 v70, v219 offset:1320
  ds_read_b32 v71, v219 offset:1324
  ds_read_b32 v72, v219 offset:1328
  ds_read_b32 v73, v219 offset:1332
  ds_read_b32 v74, v219 offset:1336
  ds_read_b32 v75, v219 offset:1340
  ds_read_b32 v76, v219 offset:1344
  ds_read_b32 v77, v219 offset:1348
  ds_read_b32 v78, v219 offset:1352
  ds_read_b32 v79, v219 offset:288
  ds_read_b32 v80, v219 offset:292
  ds_read_b32 v81, v219 offset:296
  ds_read_b32 v82, v219 offset:300
  ds_read_b32 v83, v219 offset:304
  ds_read_b32 v84, v219 offset:308
  ds_read_b32 v85, v219 offset:312
  ds_read_b32 v86, v219 offset:316
  ds_read_b32 v87, v219 offset:320
  v_add_u32 v211, s66, v200
  v_mov_b32 v212, 0xf149f2ca
  v_mul_f32 v100, s57, v100
  v_mul_f32 v101, s57, v101
  v_mul_f32 v102, s57, v102
  v_mul_f32 v103, s57, v103
  v_mul_f32 v104, s57, v104
  v_mul_f32 v105, s57, v105
  v_mul_f32 v106, s57, v106
  v_mul_f32 v107, s57, v107
  v_cmp_gt_u32 vcc, 2, v211
  s_nop 1
  v_cndmask_b32 v101, v101, v212, vcc
  v_cmp_gt_u32 vcc, 4, v211
  s_nop 1
  v_cndmask_b32 v102, v102, v212, vcc
  v_cmp_gt_u32 vcc, 6, v211
  s_nop 1
  v_cndmask_b32 v103, v103, v212, vcc
  v_cmp_gt_u32 vcc, 8, v211
  s_nop 1
  v_cndmask_b32 v104, v104, v212, vcc
  v_cmp_gt_u32 vcc, 10, v211
  s_nop 1
  v_cndmask_b32 v105, v105, v212, vcc
  v_cmp_gt_u32 vcc, 12, v211
  s_nop 1
  v_cndmask_b32 v106, v106, v212, vcc
  v_cmp_gt_u32 vcc, 14, v211
  s_nop 1
  v_cndmask_b32 v107, v107, v212, vcc
  v_max3_f32 v213, v100, v101, v102
  v_max3_f32 v213, v213, v103, v104
  v_max3_f32 v213, v213, v105, v106
  v_max_f32 v213, v213, v107
  v_sub_f32 v100, v100, v213
  v_sub_f32 v101, v101, v213
  v_sub_f32 v102, v102, v213
  v_sub_f32 v103, v103, v213
  v_sub_f32 v104, v104, v213
  v_sub_f32 v105, v105, v213
  v_sub_f32 v106, v106, v213
  v_sub_f32 v107, v107, v213
  v_exp_f32 v100, v100
  v_exp_f32 v101, v101
  v_exp_f32 v102, v102
  v_exp_f32 v103, v103
  v_exp_f32 v104, v104
  v_exp_f32 v105, v105
  v_exp_f32 v106, v106
  v_exp_f32 v107, v107
  v_add_f32 v213, v100, v101
  v_add_f32 v213, v213, v102
  v_add_f32 v213, v213, v103
  v_add_f32 v213, v213, v104
  v_add_f32 v213, v213, v105
  v_add_f32 v213, v213, v106
  v_add_f32 v213, v213, v107
  v_rcp_f32 v213, v213
  v_mov_b32 v214, 0
  v_mul_f32 v100, v213, v100
  v_mul_f32 v101, v213, v101
  v_mul_f32 v102, v213, v102
  v_mul_f32 v103, v213, v103
  v_mul_f32 v104, v213, v104
  v_mul_f32 v105, v213, v105
  v_mul_f32 v106, v213, v106
  v_mul_f32 v107, v213, v107
  v_mov_b32 v112, 0
  v_mov_b32 v113, 0
  v_mov_b32 v114, 0
  v_mov_b32 v115, 0
  v_mov_b32 v116, 0
  v_mov_b32 v117, 0
  v_mov_b32 v118, 0
  v_mov_b32 v119, 0
  v_mov_b32 v120, 0
  v_mov_b32 v121, 0
  v_mov_b32 v122, 0
  v_mov_b32 v123, 0
  v_mov_b32 v124, 0
  v_mov_b32 v125, 0
  v_mov_b32 v126, 0
  v_mov_b32 v127, 0
  v_mov_b32 v128, 0
  v_mov_b32 v129, 0
  v_cvt_pk_bf16_f32 v0, v100, v214
  v_cvt_pk_bf16_f32 v1, v214, v100
  s_waitcnt lgkmcnt(15)
  v_dot2c_f32_bf16 v112, v16, v0
  v_dot2c_f32_bf16 v113, v16, v1
  v_dot2c_f32_bf16 v114, v17, v0
  v_dot2c_f32_bf16 v115, v17, v1
  v_dot2c_f32_bf16 v116, v18, v0
  v_dot2c_f32_bf16 v117, v18, v1
  v_dot2c_f32_bf16 v118, v19, v0
  v_dot2c_f32_bf16 v119, v19, v1
  v_dot2c_f32_bf16 v120, v20, v0
  v_dot2c_f32_bf16 v121, v20, v1
  v_dot2c_f32_bf16 v122, v21, v0
  v_dot2c_f32_bf16 v123, v21, v1
  v_dot2c_f32_bf16 v124, v22, v0
  v_dot2c_f32_bf16 v125, v22, v1
  v_dot2c_f32_bf16 v126, v23, v0
  v_dot2c_f32_bf16 v127, v23, v1
  v_dot2c_f32_bf16 v128, v24, v0
  v_dot2c_f32_bf16 v129, v24, v1
  v_cvt_pk_bf16_f32 v2, v101, v214
  v_cvt_pk_bf16_f32 v3, v214, v101
  v_dot2c_f32_bf16 v112, v25, v2
  v_dot2c_f32_bf16 v113, v25, v3
  v_dot2c_f32_bf16 v114, v26, v2
  v_dot2c_f32_bf16 v115, v26, v3
  v_dot2c_f32_bf16 v116, v27, v2
  v_dot2c_f32_bf16 v117, v27, v3
  v_dot2c_f32_bf16 v118, v28, v2
  v_dot2c_f32_bf16 v119, v28, v3
  v_dot2c_f32_bf16 v120, v29, v2
  v_dot2c_f32_bf16 v121, v29, v3
  v_dot2c_f32_bf16 v122, v30, v2
  v_dot2c_f32_bf16 v123, v30, v3
  v_dot2c_f32_bf16 v124, v31, v2
  v_dot2c_f32_bf16 v125, v31, v3
  v_dot2c_f32_bf16 v126, v32, v2
  v_dot2c_f32_bf16 v127, v32, v3
  v_dot2c_f32_bf16 v128, v33, v2
  v_dot2c_f32_bf16 v129, v33, v3
  v_cvt_pk_bf16_f32 v0, v102, v214
  v_cvt_pk_bf16_f32 v1, v214, v102
  v_dot2c_f32_bf16 v112, v34, v0
  v_dot2c_f32_bf16 v113, v34, v1
  v_dot2c_f32_bf16 v114, v35, v0
  v_dot2c_f32_bf16 v115, v35, v1
  v_dot2c_f32_bf16 v116, v36, v0
  v_dot2c_f32_bf16 v117, v36, v1
  v_dot2c_f32_bf16 v118, v37, v0
  v_dot2c_f32_bf16 v119, v37, v1
  v_dot2c_f32_bf16 v120, v38, v0
  v_dot2c_f32_bf16 v121, v38, v1
  v_dot2c_f32_bf16 v122, v39, v0
  v_dot2c_f32_bf16 v123, v39, v1
  v_dot2c_f32_bf16 v124, v40, v0
  v_dot2c_f32_bf16 v125, v40, v1
  v_dot2c_f32_bf16 v126, v41, v0
  v_dot2c_f32_bf16 v127, v41, v1
  v_dot2c_f32_bf16 v128, v42, v0
  v_dot2c_f32_bf16 v129, v42, v1
  v_cvt_pk_bf16_f32 v2, v103, v214
  v_cvt_pk_bf16_f32 v3, v214, v103
  v_dot2c_f32_bf16 v112, v43, v2
  v_dot2c_f32_bf16 v113, v43, v3
  v_dot2c_f32_bf16 v114, v44, v2
  v_dot2c_f32_bf16 v115, v44, v3
  v_dot2c_f32_bf16 v116, v45, v2
  v_dot2c_f32_bf16 v117, v45, v3
  v_dot2c_f32_bf16 v118, v46, v2
  v_dot2c_f32_bf16 v119, v46, v3
  v_dot2c_f32_bf16 v120, v47, v2
  v_dot2c_f32_bf16 v121, v47, v3
  v_dot2c_f32_bf16 v122, v48, v2
  v_dot2c_f32_bf16 v123, v48, v3
  v_dot2c_f32_bf16 v124, v49, v2
  v_dot2c_f32_bf16 v125, v49, v3
  v_dot2c_f32_bf16 v126, v50, v2
  v_dot2c_f32_bf16 v127, v50, v3
  v_dot2c_f32_bf16 v128, v51, v2
  v_dot2c_f32_bf16 v129, v51, v3
  v_cvt_pk_bf16_f32 v0, v104, v214
  v_cvt_pk_bf16_f32 v1, v214, v104
  v_dot2c_f32_bf16 v112, v52, v0
  v_dot2c_f32_bf16 v113, v52, v1
  v_dot2c_f32_bf16 v114, v53, v0
  v_dot2c_f32_bf16 v115, v53, v1
  v_dot2c_f32_bf16 v116, v54, v0
  v_dot2c_f32_bf16 v117, v54, v1
  v_dot2c_f32_bf16 v118, v55, v0
  v_dot2c_f32_bf16 v119, v55, v1
  v_dot2c_f32_bf16 v120, v56, v0
  v_dot2c_f32_bf16 v121, v56, v1
  v_dot2c_f32_bf16 v122, v57, v0
  v_dot2c_f32_bf16 v123, v57, v1
  v_dot2c_f32_bf16 v124, v58, v0
  v_dot2c_f32_bf16 v125, v58, v1
  v_dot2c_f32_bf16 v126, v59, v0
  v_dot2c_f32_bf16 v127, v59, v1
  v_dot2c_f32_bf16 v128, v60, v0
  v_dot2c_f32_bf16 v129, v60, v1
  v_cvt_pk_bf16_f32 v2, v105, v214
  v_cvt_pk_bf16_f32 v3, v214, v105
  v_dot2c_f32_bf16 v112, v61, v2
  v_dot2c_f32_bf16 v113, v61, v3
  v_dot2c_f32_bf16 v114, v62, v2
  v_dot2c_f32_bf16 v115, v62, v3
  v_dot2c_f32_bf16 v116, v63, v2
  v_dot2c_f32_bf16 v117, v63, v3
  v_dot2c_f32_bf16 v118, v64, v2
  v_dot2c_f32_bf16 v119, v64, v3
  v_dot2c_f32_bf16 v120, v65, v2
  v_dot2c_f32_bf16 v121, v65, v3
  v_dot2c_f32_bf16 v122, v66, v2
  v_dot2c_f32_bf16 v123, v66, v3
  v_dot2c_f32_bf16 v124, v67, v2
  v_dot2c_f32_bf16 v125, v67, v3
  v_dot2c_f32_bf16 v126, v68, v2
  v_dot2c_f32_bf16 v127, v68, v3
  v_dot2c_f32_bf16 v128, v69, v2
  v_dot2c_f32_bf16 v129, v69, v3
  v_cvt_pk_bf16_f32 v0, v106, v214
  v_cvt_pk_bf16_f32 v1, v214, v106
  v_dot2c_f32_bf16 v112, v70, v0
  v_dot2c_f32_bf16 v113, v70, v1
  v_dot2c_f32_bf16 v114, v71, v0
  v_dot2c_f32_bf16 v115, v71, v1
  v_dot2c_f32_bf16 v116, v72, v0
  v_dot2c_f32_bf16 v117, v72, v1
  s_waitcnt lgkmcnt(14)
  v_dot2c_f32_bf16 v118, v73, v0
  v_dot2c_f32_bf16 v119, v73, v1
  s_waitcnt lgkmcnt(13)
  v_dot2c_f32_bf16 v120, v74, v0
  v_dot2c_f32_bf16 v121, v74, v1
  s_waitcnt lgkmcnt(12)
  v_dot2c_f32_bf16 v122, v75, v0
  v_dot2c_f32_bf16 v123, v75, v1
  s_waitcnt lgkmcnt(11)
  v_dot2c_f32_bf16 v124, v76, v0
  v_dot2c_f32_bf16 v125, v76, v1
  s_waitcnt lgkmcnt(10)
  v_dot2c_f32_bf16 v126, v77, v0
  v_dot2c_f32_bf16 v127, v77, v1
  s_waitcnt lgkmcnt(9)
  v_dot2c_f32_bf16 v128, v78, v0
  v_dot2c_f32_bf16 v129, v78, v1
  v_cvt_pk_bf16_f32 v2, v107, v214
  v_cvt_pk_bf16_f32 v3, v214, v107
  s_waitcnt lgkmcnt(8)
  v_dot2c_f32_bf16 v112, v79, v2
  v_dot2c_f32_bf16 v113, v79, v3
  s_waitcnt lgkmcnt(7)
  v_dot2c_f32_bf16 v114, v80, v2
  v_dot2c_f32_bf16 v115, v80, v3
  s_waitcnt lgkmcnt(6)
  v_dot2c_f32_bf16 v116, v81, v2
  v_dot2c_f32_bf16 v117, v81, v3
  s_waitcnt lgkmcnt(5)
  v_dot2c_f32_bf16 v118, v82, v2
  v_dot2c_f32_bf16 v119, v82, v3
  s_waitcnt lgkmcnt(4)
  v_dot2c_f32_bf16 v120, v83, v2
  v_dot2c_f32_bf16 v121, v83, v3
  s_waitcnt lgkmcnt(3)
  v_dot2c_f32_bf16 v122, v84, v2
  v_dot2c_f32_bf16 v123, v84, v3
  s_waitcnt lgkmcnt(2)
  v_dot2c_f32_bf16 v124, v85, v2
  v_dot2c_f32_bf16 v125, v85, v3
  s_waitcnt lgkmcnt(1)
  v_dot2c_f32_bf16 v126, v86, v2
  v_dot2c_f32_bf16 v127, v86, v3
  s_waitcnt lgkmcnt(0)
  v_dot2c_f32_bf16 v128, v87, v2
  v_dot2c_f32_bf16 v129, v87, v3
  v_cvt_pk_bf16_f32 v132, v112, v113
  v_cvt_pk_bf16_f32 v133, v114, v115
  v_cvt_pk_bf16_f32 v134, v116, v117
  v_cvt_pk_bf16_f32 v135, v118, v119
  v_cvt_pk_bf16_f32 v136, v120, v121
  v_cvt_pk_bf16_f32 v137, v122, v123
  v_cvt_pk_bf16_f32 v138, v124, v125
  v_cvt_pk_bf16_f32 v139, v126, v127
  v_cvt_pk_bf16_f32 v140, v128, v129
  buffer_store_dwordx4 v[132:135], v220, s[8:11], s64 offen sc1
  buffer_store_dwordx4 v[136:139], v220, s[8:11], s64 offen offset:16 sc1
  buffer_store_dword v140, v220, s[8:11], s64 offen offset:32 sc1
  s_mov_b32 s56, 36
  s_waitcnt vmcnt(0)
  s_barrier
  s_cmp_eq_u32 s52, 0
  s_cbranch_scc0 A_sig
  v_mov_b32 v211, 1
  v_mov_b32 v212, 0
  s_mov_b64 exec, 1
  buffer_atomic_add v211, v212, s[12:15], s56 offen
  s_mov_b64 exec, -1
A_sig:
  s_and_b32 s54, s53, 31
  s_cmp_lt_u32 s54, 27
  s_cbranch_scc0 L_exit
  s_and_b32 s54, s53, 31
  s_mul_i32 s68, s54, 57
  s_lshr_b32 s68, s68, 9
  s_mul_i32 s56, s68, 9
  s_sub_u32 s70, s54, s56
  s_bfe_u32 s55, s53, 0x10005
  s_mul_i32 s55, s55, 9
  s_add_u32 s70, s70, s55
  s_bfe_u32 s69, s53, 0x10006
  v_lshrrev_b32 v211, 2, v200
  v_mul_u32_u24 v211, 1152, v211
  v_and_b32 v212, 3, v200
  v_lshl_add_u32 v207, v212, 4, v211
  s_lshl_b32 s54, s70, 6
  s_mul_i32 s55, s52, 1179648
  s_add_u32 s62, s54, s55
  s_mul_i32 s55, s52, 184320
  s_add_u32 s63, s54, s55
  s_mul_i32 s61, s52, 40960
  v_bfe_u32 v211, v200, 2, 2
  v_lshlrev_b32 v212, 4, v212
  v_add_u32 v212, s61, v212
  v_lshl_add_u32 v212, v211, 6, v212
  v_lshrrev_b32 v213, 4, v200
  v_lshl_add_u32 v210, v213, 9, v212
  v_lshrrev_b32 v214, 5, v200
  v_lshl_add_u32 v209, v214, 10, v212
  v_and_b32 v214, 1, v213
  v_lshl_add_u32 v209, v214, 8, v209
  s_add_u32 m0, s61, 0
  s_add_u32 s54, s62, 0
  buffer_load_dwordx4 v207, s[28:31], s54 offen lds
  s_add_u32 m0, s61, 1024
  s_add_u32 s54, s62, 18432
  buffer_load_dwordx4 v207, s[28:31], s54 offen lds
  s_add_u32 m0, s61, 2048
  s_add_u32 s54, s62, 36864
  buffer_load_dwordx4 v207, s[28:31], s54 offen lds
  s_add_u32 m0, s61, 3072
  s_add_u32 s54, s62, 55296
  buffer_load_dwordx4 v207, s[28:31], s54 offen lds
  s_add_u32 m0, s61, 4096
  s_add_u32 s54, s62, 73728
  buffer_load_dwordx4 v207, s[28:31], s54 offen lds
  s_add_u32 m0, s61, 5120
  s_add_u32 s54, s62, 92160
  buffer_load_dwordx4 v207, s[28:31], s54 offen lds
  s_add_u32 m0, s61, 6144
  s_add_u32 s54, s62, 110592
  buffer_load_dwordx4 v207, s[28:31], s54 offen lds
  s_add_u32 m0, s61, 7168
  s_add_u32 s54, s62, 129024
  buffer_load_dwordx4 v207, s[28:31], s54 offen lds
  s_add_u32 m0, s61, 8192
  s_add_u32 s54, s62, 147456
  buffer_load_dwordx4 v207, s[28:31], s54 offen lds
  s_add_u32 m0, s61, 9216
  s_add_u32 s54, s62, 165888
  buffer_load_dwordx4 v207, s[28:31], s54 offen lds
  s_add_u32 m0, s61, 10240
  s_add_u32 s54, s62, 184320
  buffer_load_dwordx4 v207, s[28:31], s54 offen lds
  s_add_u32 m0, s61, 11264
  s_add_u32 s54, s62, 202752
  buffer_load_dwordx4 v207, s[28:31], s54 offen lds
  s_add_u32 m0, s61, 12288
  s_add_u32 s54, s62, 221184
  buffer_load_dwordx4 v207, s[28:31], s54 offen lds
  s_add_u32 m0, s61, 13312
  s_add_u32 s54, s62, 239616
  buffer_load_dwordx4 v207, s[28:31], s54 offen lds
  s_add_u32 m0, s61, 14336
  s_add_u32 s54, s62, 258048
  buffer_load_dwordx4 v207, s[28:31], s54 offen lds
  s_add_u32 m0, s61, 15360
  s_add_u32 s54, s62, 276480
  buffer_load_dwordx4 v207, s[28:31], s54 offen lds
  s_add_u32 m0, s61, 16384
  s_add_u32 s54, s62, 294912
  buffer_load_dwordx4 v207, s[28:31], s54 offen lds
  s_add_u32 m0, s61, 17408
  s_add_u32 s54, s62, 313344
  buffer_load_dwordx4 v207, s[28:31], s54 offen lds
  s_add_u32 m0, s61, 18432
  s_add_u32 s54, s62, 331776
  buffer_load_dwordx4 v207, s[28:31], s54 offen lds
  s_add_u32 m0, s61, 19456
  s_add_u32 s54, s62, 350208
  buffer_load_dwordx4 v207, s[28:31], s54 offen lds
  s_add_u32 m0, s61, 20480
  s_add_u32 s54, s62, 368640
  buffer_load_dwordx4 v207, s[28:31], s54 offen lds
  s_add_u32 m0, s61, 21504
  s_add_u32 s54, s62, 387072
  buffer_load_dwordx4 v207, s[28:31], s54 offen lds
  s_add_u32 m0, s61, 22528
  s_add_u32 s54, s62, 405504
  buffer_load_dwordx4 v207, s[28:31], s54 offen lds
  s_add_u32 m0, s61, 23552
  s_add_u32 s54, s62, 423936
  buffer_load_dwordx4 v207, s[28:31], s54 offen lds
  s_add_u32 m0, s61, 24576
  s_add_u32 s54, s62, 442368
  buffer_load_dwordx4 v207, s[28:31], s54 offen lds
  s_add_u32 m0, s61, 25600
  s_add_u32 s54, s62, 460800
  buffer_load_dwordx4 v207, s[28:31], s54 offen lds
  s_add_u32 m0, s61, 26624
  s_add_u32 s54, s62, 479232
  buffer_load_dwordx4 v207, s[28:31], s54 offen lds
  s_add_u32 m0, s61, 27648
  s_add_u32 s54, s62, 497664
  buffer_load_dwordx4 v207, s[28:31], s54 offen lds
  s_add_u32 m0, s61, 28672
  s_add_u32 s54, s62, 516096
  buffer_load_dwordx4 v207, s[28:31], s54 offen lds
  s_add_u32 m0, s61, 29696
  s_add_u32 s54, s62, 534528
  buffer_load_dwordx4 v207, s[28:31], s54 offen lds
  s_add_u32 m0, s61, 30720
  s_add_u32 s54, s62, 552960
  buffer_load_dwordx4 v207, s[28:31], s54 offen lds
  s_add_u32 m0, s61, 31744
  s_add_u32 s54, s62, 571392
  buffer_load_dwordx4 v207, s[28:31], s54 offen lds
  s_add_u32 m0, s61, 32768
  s_add_u32 s54, s62, 589824
  buffer_load_dwordx4 v207, s[28:31], s54 offen lds
  s_add_u32 m0, s61, 33792
  s_add_u32 s54, s62, 608256
  buffer_load_dwordx4 v207, s[28:31], s54 offen lds
  s_add_u32 m0, s61, 34816
  s_add_u32 s54, s62, 626688
  buffer_load_dwordx4 v207, s[28:31], s54 offen lds
  s_add_u32 m0, s61, 35840
  s_add_u32 s54, s62, 645120
  buffer_load_dwordx4 v207, s[28:31], s54 offen lds
  s_add_u32 m0, s61, 36864
  s_add_u32 s54, s62, 663552
  buffer_load_dwordx4 v207, s[28:31], s54 offen lds
  s_add_u32 m0, s61, 37888
  s_add_u32 s54, s62, 681984
  buffer_load_dwordx4 v207, s[28:31], s54 offen lds
  s_waitcnt vmcnt(36) lgkmcnt(0)
  s_add_u32 m0, s61, 38912
  s_add_u32 s54, s62, 700416
  buffer_load_dwordx4 v207, s[28:31], s54 offen lds
  s_add_u32 m0, s61, 39936
  s_add_u32 s54, s62, 718848
  buffer_load_dwordx4 v207, s[28:31], s54 offen lds
  ds_read_b64_tr_b16 a[0:1], v209 offset:0
  ds_read_b64_tr_b16 a[2:3], v209 offset:512
  ds_read_b64_tr_b16 a[4:5], v209 offset:8
  ds_read_b64_tr_b16 a[6:7], v209 offset:520
  s_waitcnt vmcnt(36) lgkmcnt(0)
  s_add_u32 m0, s61, 0
  s_add_u32 s54, s62, 737280
  buffer_load_dwordx4 v207, s[28:31], s54 offen lds
  s_add_u32 m0, s61, 1024
  s_add_u32 s54, s62, 755712
  buffer_load_dwordx4 v207, s[28:31], s54 offen lds
  ds_read_b64_tr_b16 a[8:9], v209 offset:2048
  ds_read_b64_tr_b16 a[10:11], v209 offset:2560
  ds_read_b64_tr_b16 a[12:13], v209 offset:2056
  ds_read_b64_tr_b16 a[14:15], v209 offset:2568
  s_waitcnt vmcnt(36) lgkmcnt(0)
  s_add_u32 m0, s61, 2048
  s_add_u32 s54, s62, 774144
  buffer_load_dwordx4 v207, s[28:31], s54 offen lds
  s_add_u32 m0, s61, 3072
  s_add_u32 s54, s62, 792576
  buffer_load_dwordx4 v207, s[28:31], s54 offen lds
  ds_read_b64_tr_b16 a[16:17], v209 offset:4096
  ds_read_b64_tr_b16 a[18:19], v209 offset:4608
  ds_read_b64_tr_b16 a[20:21], v209 offset:4104
  ds_read_b64_tr_b16 a[22:23], v209 offset:4616
  s_waitcnt vmcnt(36) lgkmcnt(0)
  s_add_u32 m0, s61, 4096
  s_add_u32 s54, s62, 811008
  buffer_load_dwordx4 v207, s[28:31], s54 offen lds
  s_add_u32 m0, s61, 5120
  s_add_u32 s54, s62, 829440
  buffer_load_dwordx4 v207, s[28:31], s54 offen lds
  ds_read_b64_tr_b16 a[24:25], v209 offset:6144
  ds_read_b64_tr_b16 a[26:27], v209 offset:6656
  ds_read_b64_tr_b16 a[28:29], v209 offset:6152
  ds_read_b64_tr_b16 a[30:31], v209 offset:6664
  s_waitcnt vmcnt(36) lgkmcnt(0)
  s_add_u32 m0, s61, 6144
  s_add_u32 s54, s62, 847872
  buffer_load_dwordx4 v207, s[28:31], s54 offen lds
  s_add_u32 m0, s61, 7168
  s_add_u32 s54, s62, 866304
  buffer_load_dwordx4 v207, s[28:31], s54 offen lds
  ds_read_b64_tr_b16 a[32:33], v209 offset:8192
  ds_read_b64_tr_b16 a[34:35], v209 offset:8704
  ds_read_b64_tr_b16 a[36:37], v209 offset:8200
  ds_read_b64_tr_b16 a[38:39], v209 offset:8712
  s_waitcnt vmcnt(36) lgkmcnt(0)
  s_add_u32 m0, s61, 8192
  s_add_u32 s54, s62, 884736
  buffer_load_dwordx4 v207, s[28:31], s54 offen lds
  s_add_u32 m0, s61, 9216
  s_add_u32 s54, s62, 903168
  buffer_load_dwordx4 v207, s[28:31], s54 offen lds
  ds_read_b64_tr_b16 a[40:41], v209 offset:10240
  ds_read_b64_tr_b16 a[42:43], v209 offset:10752
  ds_read_b64_tr_b16 a[44:45], v209 offset:10248
  ds_read_b64_tr_b16 a[46:47], v209 offset:10760
  s_waitcnt vmcnt(36) lgkmcnt(0)
  s_add_u32 m0, s61, 10240
  s_add_u32 s54, s62, 921600
  buffer_load_dwordx4 v207, s[28:31], s54 offen lds
  s_add_u32 m0, s61, 11264
  s_add_u32 s54, s62, 940032
  buffer_load_dwordx4 v207, s[28:31], s54 offen lds
  ds_read_b64_tr_b16 a[48:49], v209 offset:12288
  ds_read_b64_tr_b16 a[50:51], v209 offset:12800
  ds_read_b64_tr_b16 a[52:53], v209 offset:12296
  ds_read_b64_tr_b16 a[54:55], v209 offset:12808
  s_waitcnt vmcnt(36) lgkmcnt(0)
  s_add_u32 m0, s61, 12288
  s_add_u32 s54, s62, 958464
  buffer_load_dwordx4 v207, s[28:31], s54 offen lds
  s_add_u32 m0, s61, 13312
  s_add_u32 s54, s62, 976896
  buffer_load_dwordx4 v207, s[28:31], s54 offen lds
  ds_read_b64_tr_b16 a[56:57], v209 offset:14336
  ds_read_b64_tr_b16 a[58:59], v209 offset:14848
  ds_read_b64_tr_b16 a[60:61], v209 offset:14344
  ds_read_b64_tr_b16 a[62:63], v209 offset:14856
  s_waitcnt vmcnt(36) lgkmcnt(0)
  s_add_u32 m0, s61, 14336
  s_add_u32 s54, s62, 995328
  buffer_load_dwordx4 v207, s[28:31], s54 offen lds
  s_add_u32 m0, s61, 15360
  s_add_u32 s54, s62, 1013760
  buffer_load_dwordx4 v207, s[28:31], s54 offen lds
  ds_read_b64_tr_b16 a[64:65], v209 offset:16384
  ds_read_b64_tr_b16 a[66:67], v209 offset:16896
  ds_read_b64_tr_b16 a[68:69], v209 offset:16392
  ds_read_b64_tr_b16 a[70:71], v209 offset:16904
  s_waitcnt vmcnt(36) lgkmcnt(0)
  s_add_u32 m0, s61, 16384
  s_add_u32 s54, s62, 1032192
  buffer_load_dwordx4 v207, s[28:31], s54 offen lds
  s_add_u32 m0, s61, 17408
  s_add_u32 s54, s62, 1050624
  buffer_load_dwordx4 v207, s[28:31], s54 offen lds
  ds_read_b64_tr_b16 a[72:73], v209 offset:18432
  ds_read_b64_tr_b16 a[74:75], v209 offset:18944
  ds_read_b64_tr_b16 a[76:77], v209 offset:18440
  ds_read_b64_tr_b16 a[78:79], v209 offset:18952
  s_waitcnt vmcnt(36) lgkmcnt(0)
  s_add_u32 m0, s61, 18432
  s_add_u32 s54, s62, 1069056
  buffer_load_dwordx4 v207, s[28:31], s54 offen lds
  s_add_u32 m0, s61, 19456
  s_add_u32 s54, s62, 1087488
  buffer_load_dwordx4 v207, s[28:31], s54 offen lds
  ds_read_b64_tr_b16 a[80:81], v209 offset:20480
  ds_read_b64_tr_b16 a[82:83], v209 offset:20992
  ds_read_b64_tr_b16 a[84:85], v209 offset:20488
  ds_read_b64_tr_b16 a[86:87], v209 offset:21000
  s_waitcnt vmcnt(36) lgkmcnt(0)
  s_add_u32 m0, s61, 20480
  s_add_u32 s54, s62, 1105920
  buffer_load_dwordx4 v207, s[28:31], s54 offen lds
  s_add_u32 m0, s61, 21504
  s_add_u32 s54, s62, 1124352
  buffer_load_dwordx4 v207, s[28:31], s54 offen lds
  ds_read_b64_tr_b16 a[88:89], v209 offset:22528
  ds_read_b64_tr_b16 a[90:91], v209 offset:23040
  ds_read_b64_tr_b16 a[92:93], v209 offset:22536
  ds_read_b64_tr_b16 a[94:95], v209 offset:23048
  s_waitcnt vmcnt(36) lgkmcnt(0)
  s_add_u32 m0, s61, 22528
  s_add_u32 s54, s62, 1142784
  buffer_load_dwordx4 v207, s[28:31], s54 offen lds
  s_add_u32 m0, s61, 23552
  s_add_u32 s54, s62, 1161216
  buffer_load_dwordx4 v207, s[28:31], s54 offen lds
  ds_read_b64_tr_b16 a[96:97], v209 offset:24576
  ds_read_b64_tr_b16 a[98:99], v209 offset:25088
  ds_read_b64_tr_b16 a[100:101], v209 offset:24584
  ds_read_b64_tr_b16 a[102:103], v209 offset:25096
  s_waitcnt vmcnt(36) lgkmcnt(0)
  s_add_u32 m0, s61, 24576
  s_add_u32 s54, s63, 0
  buffer_load_dwordx4 v207, s[40:43], s54 offen lds
  s_add_u32 m0, s61, 25600
  s_add_u32 s54, s63, 18432
  buffer_load_dwordx4 v207, s[40:43], s54 offen lds
  ds_read_b64_tr_b16 a[104:105], v209 offset:26624
  ds_read_b64_tr_b16 a[106:107], v209 offset:27136
  ds_read_b64_tr_b16 a[108:109], v209 offset:26632
  ds_read_b64_tr_b16 a[110:111], v209 offset:27144
  s_waitcnt vmcnt(36) lgkmcnt(0)
  s_add_u32 m0, s61, 26624
  s_add_u32 s54, s63, 36864
  buffer_load_dwordx4 v207, s[40:43], s54 offen lds
  s_add_u32 m0, s61, 27648
  s_add_u32 s54, s63, 55296
  buffer_load_dwordx4 v207, s[40:43], s54 offen lds
  ds_read_b64_tr_b16 a[112:113], v209 offset:28672
  ds_read_b64_tr_b16 a[114:115], v209 offset:29184
  ds_read_b64_tr_b16 a[116:117], v209 offset:28680
  ds_read_b64_tr_b16 a[118:119], v209 offset:29192
  s_waitcnt vmcnt(36) lgkmcnt(0)
  s_add_u32 m0, s61, 28672
  s_add_u32 s54, s63, 73728
  buffer_load_dwordx4 v207, s[40:43], s54 offen lds
  s_add_u32 m0, s61, 29696
  s_add_u32 s54, s63, 92160
  buffer_load_dwordx4 v207, s[40:43], s54 offen lds
  ds_read_b64_tr_b16 a[120:121], v209 offset:30720
  ds_read_b64_tr_b16 a[122:123], v209 offset:31232
  ds_read_b64_tr_b16 a[124:125], v209 offset:30728
  ds_read_b64_tr_b16 a[126:127], v209 offset:31240
  s_waitcnt vmcnt(36) lgkmcnt(0)
  s_add_u32 m0, s61, 30720
  s_add_u32 s54, s63, 110592
  buffer_load_dwordx4 v207, s[40:43], s54 offen lds
  s_add_u32 m0, s61, 31744
  s_add_u32 s54, s63, 129024
  buffer_load_dwordx4 v207, s[40:43], s54 offen lds
  ds_read_b64_tr_b16 a[128:129], v209 offset:32768
  ds_read_b64_tr_b16 a[130:131], v209 offset:33280
  ds_read_b64_tr_b16 a[132:133], v209 offset:32776
  ds_read_b64_tr_b16 a[134:135], v209 offset:33288
  s_waitcnt vmcnt(36) lgkmcnt(0)
  s_add_u32 m0, s61, 32768
  s_add_u32 s54, s63, 147456
  buffer_load_dwordx4 v207, s[40:43], s54 offen lds
  s_add_u32 m0, s61, 33792
  s_add_u32 s54, s63, 165888
  buffer_load_dwordx4 v207, s[40:43], s54 offen lds
  ds_read_b64_tr_b16 a[136:137], v209 offset:34816
  ds_read_b64_tr_b16 a[138:139], v209 offset:35328
  ds_read_b64_tr_b16 a[140:141], v209 offset:34824
  ds_read_b64_tr_b16 a[142:143], v209 offset:35336
  s_waitcnt vmcnt(36) lgkmcnt(0)
  ds_read_b64_tr_b16 a[144:145], v209 offset:36864
  ds_read_b64_tr_b16 a[146:147], v209 offset:37376
  ds_read_b64_tr_b16 a[148:149], v209 offset:36872
  ds_read_b64_tr_b16 a[150:151], v209 offset:37384
  s_waitcnt vmcnt(34) lgkmcnt(0)
  ds_read_b64_tr_b16 a[152:153], v209 offset:38912
  ds_read_b64_tr_b16 a[154:155], v209 offset:39424
  ds_read_b64_tr_b16 a[156:157], v209 offset:38920
  ds_read_b64_tr_b16 a[158:159], v209 offset:39432
  s_waitcnt vmcnt(32) lgkmcnt(0)
  ds_read_b64_tr_b16 a[160:161], v209 offset:0
  ds_read_b64_tr_b16 a[162:163], v209 offset:512
  ds_read_b64_tr_b16 a[164:165], v209 offset:8
  ds_read_b64_tr_b16 a[166:167], v209 offset:520
  s_waitcnt vmcnt(30) lgkmcnt(0)
  ds_read_b64_tr_b16 a[168:169], v209 offset:2048
  ds_read_b64_tr_b16 a[170:171], v209 offset:2560
  ds_read_b64_tr_b16 a[172:173], v209 offset:2056
  ds_read_b64_tr_b16 a[174:175], v209 offset:2568
  s_waitcnt vmcnt(28) lgkmcnt(0)
  ds_read_b64_tr_b16 a[176:177], v209 offset:4096
  ds_read_b64_tr_b16 a[178:179], v209 offset:4608
  ds_read_b64_tr_b16 a[180:181], v209 offset:4104
  ds_read_b64_tr_b16 a[182:183], v209 offset:4616
  s_waitcnt vmcnt(26) lgkmcnt(0)
  ds_read_b64_tr_b16 a[184:185], v209 offset:6144
  ds_read_b64_tr_b16 a[186:187], v209 offset:6656
  ds_read_b64_tr_b16 a[188:189], v209 offset:6152
  ds_read_b64_tr_b16 a[190:191], v209 offset:6664
  s_waitcnt vmcnt(24) lgkmcnt(0)
  ds_read_b64_tr_b16 a[192:193], v209 offset:8192
  ds_read_b64_tr_b16 a[194:195], v209 offset:8704
  ds_read_b64_tr_b16 a[196:197], v209 offset:8200
  ds_read_b64_tr_b16 a[198:199], v209 offset:8712
  s_waitcnt vmcnt(22) lgkmcnt(0)
  ds_read_b64_tr_b16 a[200:201], v209 offset:10240
  ds_read_b64_tr_b16 a[202:203], v209 offset:10752
  ds_read_b64_tr_b16 a[204:205], v209 offset:10248
  ds_read_b64_tr_b16 a[206:207], v209 offset:10760
  s_waitcnt vmcnt(20) lgkmcnt(0)
  ds_read_b64_tr_b16 a[208:209], v209 offset:12288
  ds_read_b64_tr_b16 a[210:211], v209 offset:12800
  ds_read_b64_tr_b16 a[212:213], v209 offset:12296
  ds_read_b64_tr_b16 a[214:215], v209 offset:12808
  s_waitcnt vmcnt(18) lgkmcnt(0)
  ds_read_b64_tr_b16 a[216:217], v209 offset:14336
  ds_read_b64_tr_b16 a[218:219], v209 offset:14848
  ds_read_b64_tr_b16 a[220:221], v209 offset:14344
  ds_read_b64_tr_b16 a[222:223], v209 offset:14856
  s_waitcnt vmcnt(16) lgkmcnt(0)
  ds_read_b64_tr_b16 a[224:225], v209 offset:16384
  ds_read_b64_tr_b16 a[226:227], v209 offset:16896
  ds_read_b64_tr_b16 a[228:229], v209 offset:16392
  ds_read_b64_tr_b16 a[230:231], v209 offset:16904
  s_waitcnt vmcnt(14) lgkmcnt(0)
  ds_read_b64_tr_b16 a[232:233], v209 offset:18432
  ds_read_b64_tr_b16 a[234:235], v209 offset:18944
  ds_read_b64_tr_b16 a[236:237], v209 offset:18440
  ds_read_b64_tr_b16 a[238:239], v209 offset:18952
  s_waitcnt vmcnt(12) lgkmcnt(0)
  ds_read_b64_tr_b16 a[240:241], v209 offset:20480
  ds_read_b64_tr_b16 a[242:243], v209 offset:20992
  ds_read_b64_tr_b16 a[244:245], v209 offset:20488
  ds_read_b64_tr_b16 a[246:247], v209 offset:21000
  s_waitcnt vmcnt(10) lgkmcnt(0)
  ds_read_b64_tr_b16 a[248:249], v209 offset:22528
  ds_read_b64_tr_b16 a[250:251], v209 offset:23040
  ds_read_b64_tr_b16 a[252:253], v209 offset:22536
  ds_read_b64_tr_b16 a[254:255], v209 offset:23048
  s_waitcnt vmcnt(8) lgkmcnt(0)
  ds_read_b64_tr_b16 v[216:217], v210 offset:24576
  ds_read_b64_tr_b16 v[218:219], v210 offset:24832
  ds_read_b64_tr_b16 v[220:221], v210 offset:24584
  ds_read_b64_tr_b16 v[222:223], v210 offset:24840
  s_waitcnt vmcnt(6) lgkmcnt(0)
  ds_read_b64_tr_b16 v[224:225], v210 offset:26624
  ds_read_b64_tr_b16 v[226:227], v210 offset:26880
  ds_read_b64_tr_b16 v[228:229], v210 offset:26632
  ds_read_b64_tr_b16 v[230:231], v210 offset:26888
  s_waitcnt vmcnt(4) lgkmcnt(0)
  ds_read_b64_tr_b16 v[232:233], v210 offset:28672
  ds_read_b64_tr_b16 v[234:235], v210 offset:28928
  ds_read_b64_tr_b16 v[236:237], v210 offset:28680
  ds_read_b64_tr_b16 v[238:239], v210 offset:28936
  s_waitcnt vmcnt(2) lgkmcnt(0)
  ds_read_b64_tr_b16 v[240:241], v210 offset:30720
  ds_read_b64_tr_b16 v[242:243], v210 offset:30976
  ds_read_b64_tr_b16 v[244:245], v210 offset:30728
  ds_read_b64_tr_b16 v[246:247], v210 offset:30984
  s_waitcnt vmcnt(0) lgkmcnt(0)
  ds_read_b64_tr_b16 v[248:249], v210 offset:32768
  ds_read_b64_tr_b16 v[250:251], v210 offset:33024
  ds_read_b64_tr_b16 v[252:253], v210 offset:32776
  ds_read_b64_tr_b16 v[254:255], v210 offset:33032
  v_and_b32 v211, 15, v200
  s_lshl_b32 s54, s69, 4
  v_add_u32 v211, s54, v211
  v_lshl_add_u32 v212, v214, 5, v211
  v_lshlrev_b32 v164, 4, v212
  v_lshrrev_b32 v212, 5, v200
  v_lshl_add_u32 v164, v212, 10, v164
  v_mul_u32_u24 v167, 1152, v211
  v_lshl_add_u32 v167, v213, 4, v167
  v_lshlrev_b32 v166, 2, v211
  v_lshlrev_b32 v208, 2, v200
  s_lshl_b32 s54, s52, 11
  v_add_u32 v168, s54, v201
  s_mov_b32 s59, s68
  s_mov_b32 s56, 128
  s_mov_b32 s57, 36
  s_waitcnt lgkmcnt(0)
  s_cmp_eq_u32 s52, 0
  s_cbranch_scc0 O_p1_d
  s_mov_b32 exec_hi, 0
  s_mov_b32 exec_lo, -1
O_p1:
  buffer_load_dword v211, v208, s[12:15], s56 offen sc1
  s_add_u32 s65, s65, 1
  s_waitcnt vmcnt(0)
  v_cmp_gt_u32 vcc, 0x700, v211
  s_cbranch_vccz O_p1_x
  s_sleep 16
  s_cmp_lt_u32 s65, 131072
  s_cbranch_scc1 O_p1
O_p1_x:
  s_mov_b64 exec, -1
O_p1_d:
  s_barrier
  s_cmp_eq_u32 s52, 0
  s_cbranch_scc0 O_a_d
  s_mov_b32 exec_hi, 0
  s_mov_b32 exec_lo, 1
O_a:
  buffer_load_dword v211, v208, s[12:15], s57 offen sc1
  s_add_u32 s65, s65, 1
  s_waitcnt vmcnt(0)
  v_cmp_gt_u32 vcc, 0x80, v211
  s_cbranch_vccz O_a_x
  s_sleep 16
  s_cmp_lt_u32 s65, 131072
  s_cbranch_scc1 O_a
O_a_x:
  s_mov_b64 exec, -1
O_a_d:
  s_barrier
  s_cmp_ge_u32 s70, 9
  s_cselect_b32 s54, 9, 0
  s_sub_u32 s54, s70, s54
  s_and_b32 s54, s54, 7
  s_lshl_b32 s54, s54, 13
  s_lshl_b32 s55, s69, 8
  s_add_u32 s54, s54, s55
  v_lshrrev_b32 v211, 2, v200
  v_lshl_add_u32 v172, v211, 9, s54
  v_and_b32 v211, 3, v200
  v_lshl_add_u32 v172, v211, 6, v172
  s_mul_i32 s55, s59, 36864
  s_mul_i32 s54, s52, 320
  s_add_u32 s55, s55, s54
  s_add_u32 s55, s55, 62914560
  s_cmp_eq_u32 s52, 3
  s_cselect_b32 s56, 268435456, s55
  buffer_load_dwordx4 v[128:131], v167, s[8:11], s55 offen offset:0 sc1
  buffer_load_dwordx4 v[132:135], v167, s[8:11], s55 offen offset:64 sc1
  buffer_load_dwordx4 v[136:139], v167, s[8:11], s55 offen offset:128 sc1
  buffer_load_dwordx4 v[140:143], v167, s[8:11], s56 offen offset:192 sc1
  buffer_load_dwordx4 v[144:147], v167, s[8:11], s56 offen offset:256 sc1
  s_lshl_b32 s55, s59, 7
  s_add_u32 s55, s55, 66060288
  buffer_load_dword v171, v166, s[8:11], s55 offen sc1
  v_mov_b32 v169, 0
  s_mov_b32 s66, 356352
  s_waitcnt vmcnt(0)
O_loop:
  v_mfma_f32_16x16x32_bf16 v[156:159], v[216:219], v[128:131], 0
  v_mfma_f32_16x16x32_bf16 v[160:163], v[220:223], v[128:131], 0
  v_mfma_f32_16x16x32_bf16 v[156:159], v[224:227], v[132:135], v[156:159]
  v_mfma_f32_16x16x32_bf16 v[160:163], v[228:231], v[132:135], v[160:163]
  v_mfma_f32_16x16x32_bf16 v[156:159], v[232:235], v[136:139], v[156:159]
  v_mfma_f32_16x16x32_bf16 v[160:163], v[236:239], v[136:139], v[160:163]
  v_mfma_f32_16x16x32_bf16 v[156:159], v[240:243], v[140:143], v[156:159]
  v_mfma_f32_16x16x32_bf16 v[160:163], v[244:247], v[140:143], v[160:163]
  v_mfma_f32_16x16x32_bf16 v[156:159], v[248:251], v[144:147], v[156:159]
  v_mfma_f32_16x16x32_bf16 v[160:163], v[252:255], v[144:147], v[160:163]
  s_mul_i32 s64, s59, 36864
  s_lshl_b32 s54, s70, 6
  s_add_u32 s64, s64, s54
  s_add_u32 s71, s59, 2
  s_lshl_b32 s55, s59, 18
  s_lshl_b32 s54, s52, 16
  s_add_u32 s55, s55, s54
  s_add_u32 s63, s55, 46137344
  s_and_b32 s54, s59, 1
  s_lshl_b32 s54, s54, 2
  s_add_u32 s54, s54, s52
  s_lshl_b32 s54, s54, 3
  s_lshl_b64 s[72:73], 0xff, s54
  v_sub_f32 v165, 1.0, v171
  v_cvt_pk_bf16_f32 v165, v165, v165
  v_lshlrev_b32 v165, 16, v165
  v_mul_f32 v156, v171, v156
  v_mul_f32 v157, v171, v157
  v_mul_f32 v158, v171, v158
  v_mul_f32 v159, v171, v159
  v_mul_f32 v160, v171, v160
  v_mul_f32 v161, v171, v161
  v_mul_f32 v162, v171, v162
  v_mul_f32 v163, v171, v163
  s_branch O_pc
O_pl:
  s_sleep 1
  buffer_load_dword v169, v208, s[8:11], s66 offen sc1
  s_add_u32 s65, s65, 1
  s_cmp_ge_u32 s65, 131072
  s_cbranch_scc1 O_ld
  s_waitcnt vmcnt(0)
O_pc:
  v_cmp_gt_u32 vcc, s71, v169
  s_nop 0
  s_and_b64 vcc, vcc, s[72:73]
  s_cbranch_scc1 O_pl
O_ld:
  s_mov_b32 s62, s63
  buffer_load_dword v173, v172, s[8:11], s63 offen sc1
  buffer_load_dwordx4 v[0:3], v164, s[8:11], s62 offen offset:0 sc1
  buffer_load_dwordx4 v[4:7], v164, s[8:11], s62 offen offset:2048 sc1
  s_add_u32 s62, s62, 4096
  buffer_load_dwordx4 v[8:11], v164, s[8:11], s62 offen offset:0 sc1
  buffer_load_dwordx4 v[12:15], v164, s[8:11], s62 offen offset:2048 sc1
  s_add_u32 s62, s62, 4096
  buffer_load_dwordx4 v[16:19], v164, s[8:11], s62 offen offset:0 sc1
  buffer_load_dwordx4 v[20:23], v164, s[8:11], s62 offen offset:2048 sc1
  s_add_u32 s62, s62, 4096
  buffer_load_dwordx4 v[24:27], v164, s[8:11], s62 offen offset:0 sc1
  buffer_load_dwordx4 v[28:31], v164, s[8:11], s62 offen offset:2048 sc1
  s_add_u32 s62, s62, 4096
  buffer_load_dwordx4 v[32:35], v164, s[8:11], s62 offen offset:0 sc1
  buffer_load_dwordx4 v[36:39], v164, s[8:11], s62 offen offset:2048 sc1
  s_add_u32 s62, s62, 4096
  buffer_load_dwordx4 v[40:43], v164, s[8:11], s62 offen offset:0 sc1
  buffer_load_dwordx4 v[44:47], v164, s[8:11], s62 offen offset:2048 sc1
  s_add_u32 s62, s62, 4096
  buffer_load_dwordx4 v[48:51], v164, s[8:11], s62 offen offset:0 sc1
  buffer_load_dwordx4 v[52:55], v164, s[8:11], s62 offen offset:2048 sc1
  s_add_u32 s62, s62, 4096
  buffer_load_dwordx4 v[56:59], v164, s[8:11], s62 offen offset:0 sc1
  buffer_load_dwordx4 v[60:63], v164, s[8:11], s62 offen offset:2048 sc1
  s_add_u32 s62, s62, 4096
  buffer_load_dwordx4 v[64:67], v164, s[8:11], s62 offen offset:0 sc1
  buffer_load_dwordx4 v[68:71], v164, s[8:11], s62 offen offset:2048 sc1
  s_add_u32 s62, s62, 4096
  buffer_load_dwordx4 v[72:75], v164, s[8:11], s62 offen offset:0 sc1
  buffer_load_dwordx4 v[76:79], v164, s[8:11], s62 offen offset:2048 sc1
  s_add_u32 s62, s62, 4096
  buffer_load_dwordx4 v[80:83], v164, s[8:11], s62 offen offset:0 sc1
  buffer_load_dwordx4 v[84:87], v164, s[8:11], s62 offen offset:2048 sc1
  s_add_u32 s62, s62, 4096
  buffer_load_dwordx4 v[88:91], v164, s[8:11], s62 offen offset:0 sc1
  buffer_load_dwordx4 v[92:95], v164, s[8:11], s62 offen offset:2048 sc1
  s_add_u32 s62, s62, 4096
  buffer_load_dwordx4 v[96:99], v164, s[8:11], s62 offen offset:0 sc1
  buffer_load_dwordx4 v[100:103], v164, s[8:11], s62 offen offset:2048 sc1
  s_add_u32 s62, s62, 4096
  buffer_load_dwordx4 v[104:107], v164, s[8:11], s62 offen offset:0 sc1
  buffer_load_dwordx4 v[108:111], v164, s[8:11], s62 offen offset:2048 sc1
  s_add_u32 s62, s62, 4096
  buffer_load_dwordx4 v[112:115], v164, s[8:11], s62 offen offset:0 sc1
  buffer_load_dwordx4 v[116:119], v164, s[8:11], s62 offen offset:2048 sc1
  s_add_u32 s62, s62, 4096
  buffer_load_dwordx4 v[120:123], v164, s[8:11], s62 offen offset:0 sc1
  buffer_load_dwordx4 v[124:127], v164, s[8:11], s62 offen offset:2048 sc1
  s_add_u32 s62, s62, 4096
  s_add_u32 s57, s59, 3
  s_min_u32 s74, s57, 63
  s_mul_i32 s55, s74, 36864
  s_mul_i32 s54, s52, 320
  s_add_u32 s55, s55, s54
  s_add_u32 s55, s55, 62914560
  s_cmp_eq_u32 s52, 3
  s_cselect_b32 s56, 268435456, s55
  buffer_load_dwordx4 v[128:131], v167, s[8:11], s55 offen offset:0 sc1
  buffer_load_dwordx4 v[132:135], v167, s[8:11], s55 offen offset:64 sc1
  buffer_load_dwordx4 v[136:139], v167, s[8:11], s55 offen offset:128 sc1
  buffer_load_dwordx4 v[140:143], v167, s[8:11], s56 offen offset:192 sc1
  buffer_load_dwordx4 v[144:147], v167, s[8:11], s56 offen offset:256 sc1
  s_lshl_b32 s55, s74, 7
  s_add_u32 s55, s55, 66060288
  buffer_load_dword v171, v166, s[8:11], s55 offen sc1
  s_add_u32 s65, s65, 1
  s_cmp_lt_u32 s65, 131072
  s_cselect_b32 s54, -2, -1
  s_waitcnt vmcnt(37)
  v_mfma_f32_16x16x32_bf16 v[148:151], a[0:3], v[0:3], 0
  v_mfma_f32_16x16x32_bf16 v[152:155], a[4:7], v[0:3], 0
  v_max3_u32 v170, v0, v1, v0
  v_max3_u32 v170, v2, v3, v170
  s_waitcnt vmcnt(36)
  v_mfma_f32_16x16x32_bf16 v[148:151], a[8:11], v[4:7], v[148:151]
  v_mfma_f32_16x16x32_bf16 v[152:155], a[12:15], v[4:7], v[152:155]
  v_max3_u32 v170, v4, v5, v170
  v_max3_u32 v170, v6, v7, v170
  s_waitcnt vmcnt(35)
  v_mfma_f32_16x16x32_bf16 v[148:151], a[16:19], v[8:11], v[148:151]
  v_mfma_f32_16x16x32_bf16 v[152:155], a[20:23], v[8:11], v[152:155]
  v_max3_u32 v170, v8, v9, v170
  v_max3_u32 v170, v10, v11, v170
  s_waitcnt vmcnt(34)
  v_mfma_f32_16x16x32_bf16 v[148:151], a[24:27], v[12:15], v[148:151]
  v_mfma_f32_16x16x32_bf16 v[152:155], a[28:31], v[12:15], v[152:155]
  v_max3_u32 v170, v12, v13, v170
  v_max3_u32 v170, v14, v15, v170
  s_waitcnt vmcnt(33)
  v_mfma_f32_16x16x32_bf16 v[148:151], a[32:35], v[16:19], v[148:151]
  v_mfma_f32_16x16x32_bf16 v[152:155], a[36:39], v[16:19], v[152:155]
  v_max3_u32 v170, v16, v17, v170
  v_max3_u32 v170, v18, v19, v170
  s_waitcnt vmcnt(32)
  v_mfma_f32_16x16x32_bf16 v[148:151], a[40:43], v[20:23], v[148:151]
  v_mfma_f32_16x16x32_bf16 v[152:155], a[44:47], v[20:23], v[152:155]
  v_max3_u32 v170, v20, v21, v170
  v_max3_u32 v170, v22, v23, v170
  s_waitcnt vmcnt(31)
  v_mfma_f32_16x16x32_bf16 v[148:151], a[48:51], v[24:27], v[148:151]
  v_mfma_f32_16x16x32_bf16 v[152:155], a[52:55], v[24:27], v[152:155]
  v_max3_u32 v170, v24, v25, v170
  v_max3_u32 v170, v26, v27, v170
  s_waitcnt vmcnt(30)
  v_mfma_f32_16x16x32_bf16 v[148:151], a[56:59], v[28:31], v[148:151]
  v_mfma_f32_16x16x32_bf16 v[152:155], a[60:63], v[28:31], v[152:155]
  v_max3_u32 v170, v28, v29, v170
  v_max3_u32 v170, v30, v31, v170
  s_waitcnt vmcnt(29)
  v_mfma_f32_16x16x32_bf16 v[148:151], a[64:67], v[32:35], v[148:151]
  v_mfma_f32_16x16x32_bf16 v[152:155], a[68:71], v[32:35], v[152:155]
  v_max3_u32 v170, v32, v33, v170
  v_max3_u32 v170, v34, v35, v170
  s_waitcnt vmcnt(28)
  v_mfma_f32_16x16x32_bf16 v[148:151], a[72:75], v[36:39], v[148:151]
  v_mfma_f32_16x16x32_bf16 v[152:155], a[76:79], v[36:39], v[152:155]
  v_max3_u32 v170, v36, v37, v170
  v_max3_u32 v170, v38, v39, v170
  s_waitcnt vmcnt(27)
  v_mfma_f32_16x16x32_bf16 v[148:151], a[80:83], v[40:43], v[148:151]
  v_mfma_f32_16x16x32_bf16 v[152:155], a[84:87], v[40:43], v[152:155]
  v_max3_u32 v170, v40, v41, v170
  v_max3_u32 v170, v42, v43, v170
  s_waitcnt vmcnt(26)
  v_mfma_f32_16x16x32_bf16 v[148:151], a[88:91], v[44:47], v[148:151]
  v_mfma_f32_16x16x32_bf16 v[152:155], a[92:95], v[44:47], v[152:155]
  v_max3_u32 v170, v44, v45, v170
  v_max3_u32 v170, v46, v47, v170
  s_waitcnt vmcnt(25)
  v_mfma_f32_16x16x32_bf16 v[148:151], a[96:99], v[48:51], v[148:151]
  v_mfma_f32_16x16x32_bf16 v[152:155], a[100:103], v[48:51], v[152:155]
  v_max3_u32 v170, v48, v49, v170
  v_max3_u32 v170, v50, v51, v170
  s_waitcnt vmcnt(24)
  v_mfma_f32_16x16x32_bf16 v[148:151], a[104:107], v[52:55], v[148:151]
  v_mfma_f32_16x16x32_bf16 v[152:155], a[108:111], v[52:55], v[152:155]
  v_max3_u32 v170, v52, v53, v170
  v_max3_u32 v170, v54, v55, v170
  s_waitcnt vmcnt(23)
  v_mfma_f32_16x16x32_bf16 v[148:151], a[112:115], v[56:59], v[148:151]
  v_mfma_f32_16x16x32_bf16 v[152:155], a[116:119], v[56:59], v[152:155]
  v_max3_u32 v170, v56, v57, v170
  v_max3_u32 v170, v58, v59, v170
  s_waitcnt vmcnt(22)
  v_mfma_f32_16x16x32_bf16 v[148:151], a[120:123], v[60:63], v[148:151]
  v_mfma_f32_16x16x32_bf16 v[152:155], a[124:127], v[60:63], v[152:155]
  v_max3_u32 v170, v60, v61, v170
  v_max3_u32 v170, v62, v63, v170
  s_waitcnt vmcnt(21)
  v_mfma_f32_16x16x32_bf16 v[148:151], a[128:131], v[64:67], v[148:151]
  v_mfma_f32_16x16x32_bf16 v[152:155], a[132:135], v[64:67], v[152:155]
  v_max3_u32 v170, v64, v65, v170
  v_max3_u32 v170, v66, v67, v170
  s_waitcnt vmcnt(20)
  v_mfma_f32_16x16x32_bf16 v[148:151], a[136:139], v[68:71], v[148:151]
  v_mfma_f32_16x16x32_bf16 v[152:155], a[140:143], v[68:71], v[152:155]
  v_max3_u32 v170, v68, v69, v170
  v_max3_u32 v170, v70, v71, v170
  s_waitcnt vmcnt(19)
  v_mfma_f32_16x16x32_bf16 v[148:151], a[144:147], v[72:75], v[148:151]
  v_mfma_f32_16x16x32_bf16 v[152:155], a[148:151], v[72:75], v[152:155]
  v_max3_u32 v170, v72, v73, v170
  v_max3_u32 v170, v74, v75, v170
  s_waitcnt vmcnt(18)
  v_mfma_f32_16x16x32_bf16 v[148:151], a[152:155], v[76:79], v[148:151]
  v_mfma_f32_16x16x32_bf16 v[152:155], a[156:159], v[76:79], v[152:155]
  v_max3_u32 v170, v76, v77, v170
  v_max3_u32 v170, v78, v79, v170
  s_waitcnt vmcnt(17)
  v_mfma_f32_16x16x32_bf16 v[148:151], a[160:163], v[80:83], v[148:151]
  v_mfma_f32_16x16x32_bf16 v[152:155], a[164:167], v[80:83], v[152:155]
  v_max3_u32 v170, v80, v81, v170
  v_max3_u32 v170, v82, v83, v170
  s_waitcnt vmcnt(16)
  v_mfma_f32_16x16x32_bf16 v[148:151], a[168:171], v[84:87], v[148:151]
  v_mfma_f32_16x16x32_bf16 v[152:155], a[172:175], v[84:87], v[152:155]
  v_max3_u32 v170, v84, v85, v170
  v_max3_u32 v170, v86, v87, v170
  s_waitcnt vmcnt(15)
  v_mfma_f32_16x16x32_bf16 v[148:151], a[176:179], v[88:91], v[148:151]
  v_mfma_f32_16x16x32_bf16 v[152:155], a[180:183], v[88:91], v[152:155]
  v_max3_u32 v170, v88, v89, v170
  v_max3_u32 v170, v90, v91, v170
  s_waitcnt vmcnt(14)
  v_mfma_f32_16x16x32_bf16 v[148:151], a[184:187], v[92:95], v[148:151]
  v_mfma_f32_16x16x32_bf16 v[152:155], a[188:191], v[92:95], v[152:155]
  v_max3_u32 v170, v92, v93, v170
  v_max3_u32 v170, v94, v95, v170
  s_waitcnt vmcnt(13)
  v_mfma_f32_16x16x32_bf16 v[148:151], a[192:195], v[96:99], v[148:151]
  v_mfma_f32_16x16x32_bf16 v[152:155], a[196:199], v[96:99], v[152:155]
  v_max3_u32 v170, v96, v97, v170
  v_max3_u32 v170, v98, v99, v170
  s_waitcnt vmcnt(12)
  v_mfma_f32_16x16x32_bf16 v[148:151], a[200:203], v[100:103], v[148:151]
  v_mfma_f32_16x16x32_bf16 v[152:155], a[204:207], v[100:103], v[152:155]
  v_max3_u32 v170, v100, v101, v170
  v_max3_u32 v170, v102, v103, v170
  s_waitcnt vmcnt(11)
  v_mfma_f32_16x16x32_bf16 v[148:151], a[208:211], v[104:107], v[148:151]
  v_mfma_f32_16x16x32_bf16 v[152:155], a[212:215], v[104:107], v[152:155]
  v_max3_u32 v170, v104, v105, v170
  v_max3_u32 v170, v106, v107, v170
  s_waitcnt vmcnt(10)
  v_mfma_f32_16x16x32_bf16 v[148:151], a[216:219], v[108:111], v[148:151]
  v_mfma_f32_16x16x32_bf16 v[152:155], a[220:223], v[108:111], v[152:155]
  v_max3_u32 v170, v108, v109, v170
  v_max3_u32 v170, v110, v111, v170
  s_waitcnt vmcnt(9)
  v_mfma_f32_16x16x32_bf16 v[148:151], a[224:227], v[112:115], v[148:151]
  v_mfma_f32_16x16x32_bf16 v[152:155], a[228:231], v[112:115], v[152:155]
  v_max3_u32 v170, v112, v113, v170
  v_max3_u32 v170, v114, v115, v170
  s_waitcnt vmcnt(8)
  v_mfma_f32_16x16x32_bf16 v[148:151], a[232:235], v[116:119], v[148:151]
  v_mfma_f32_16x16x32_bf16 v[152:155], a[236:239], v[116:119], v[152:155]
  v_max3_u32 v170, v116, v117, v170
  v_max3_u32 v170, v118, v119, v170
  s_waitcnt vmcnt(7)
  v_mfma_f32_16x16x32_bf16 v[148:151], a[240:243], v[120:123], v[148:151]
  v_mfma_f32_16x16x32_bf16 v[152:155], a[244:247], v[120:123], v[152:155]
  v_max3_u32 v170, v120, v121, v170
  v_max3_u32 v170, v122, v123, v170
  s_waitcnt vmcnt(6)
  v_mfma_f32_16x16x32_bf16 v[148:151], a[248:251], v[124:127], v[148:151]
  v_mfma_f32_16x16x32_bf16 v[152:155], a[252:255], v[124:127], v[152:155]
  v_max3_u32 v170, v124, v125, v170
  v_max3_u32 v170, v126, v127, v170
  v_cmp_lt_u32 vcc, s54, v170
  s_cbranch_vccnz O_ld
  v_fmac_f32 v156, v165, v148
  v_fmac_f32 v157, v165, v149
  v_fmac_f32 v158, v165, v150
  v_fmac_f32 v159, v165, v151
  v_fmac_f32 v160, v165, v152
  v_fmac_f32 v161, v165, v153
  v_fmac_f32 v162, v165, v154
  v_fmac_f32 v163, v165, v155
  ds_write_b128 v168, v[156:159]
  ds_write_b128 v168, v[160:163] offset:1024
  v_xor_b32 v168, 0x2000, v168
  s_mov_b32 s59, s57
  s_waitcnt lgkmcnt(0)
  s_barrier
  s_cmp_eq_u32 s52, 0
  s_cbranch_scc0 O_next
  v_xor_b32 v211, 0x2000, v168
  ds_read_b128 v[0:3], v211 offset:2048
  ds_read_b128 v[4:7], v211 offset:3072
  ds_read_b128 v[8:11], v211 offset:4096
  ds_read_b128 v[12:15], v211 offset:5120
  ds_read_b128 v[16:19], v211 offset:6144
  ds_read_b128 v[20:23], v211 offset:7168
  s_waitcnt lgkmcnt(5)
  v_add_f32 v156, v156, v0
  v_add_f32 v157, v157, v1
  v_add_f32 v158, v158, v2
  v_add_f32 v159, v159, v3
  s_waitcnt lgkmcnt(4)
  v_add_f32 v160, v160, v4
  v_add_f32 v161, v161, v5
  v_add_f32 v162, v162, v6
  v_add_f32 v163, v163, v7
  s_waitcnt lgkmcnt(3)
  v_add_f32 v156, v156, v8
  v_add_f32 v157, v157, v9
  v_add_f32 v158, v158, v10
  v_add_f32 v159, v159, v11
  s_waitcnt lgkmcnt(2)
  v_add_f32 v160, v160, v12
  v_add_f32 v161, v161, v13
  v_add_f32 v162, v162, v14
  v_add_f32 v163, v163, v15
  s_waitcnt lgkmcnt(1)
  v_add_f32 v156, v156, v16
  v_add_f32 v157, v157, v17
  v_add_f32 v158, v158, v18
  v_add_f32 v159, v159, v19
  s_waitcnt lgkmcnt(0)
  v_add_f32 v160, v160, v20
  v_add_f32 v161, v161, v21
  v_add_f32 v162, v162, v22
  v_add_f32 v163, v163, v23
  v_cvt_pk_bf16_f32 v148, v156, v157
  v_cvt_pk_bf16_f32 v149, v158, v159
  v_cvt_pk_bf16_f32 v150, v160, v161
  v_cvt_pk_bf16_f32 v151, v162, v163
  buffer_store_dwordx4 v[148:151], v167, s[48:51], s64 offen sc1
  s_waitcnt vmcnt(1)
  s_branch O_nx2
O_next:
  s_waitcnt vmcnt(0)
O_nx2:
  s_cmp_lt_u32 s59, 64
  s_cbranch_scc1 O_loop
  s_branch L_exit
W_h:
  s_lshr_b32 s58, s53, 1
  s_and_b32 s59, s53, 1
  s_mul_i32 s60, s59, 36864
  s_add_u32 m0, s67, 0
  s_nop 0
  buffer_load_dwordx4 v202, s[4:7], s60 offen offset:0 lds
  s_add_u32 m0, s67, 896
  s_nop 0
  buffer_load_dwordx4 v202, s[4:7], s60 offen offset:128 lds
  s_add_u32 m0, s67, 1792
  s_nop 0
  buffer_load_dwordx4 v202, s[4:7], s60 offen offset:256 lds
  s_add_u32 m0, s67, 2688
  s_nop 0
  buffer_load_dwordx4 v202, s[4:7], s60 offen offset:384 lds
  s_add_u32 m0, s67, 3584
  s_nop 0
  buffer_load_dwordx4 v202, s[4:7], s60 offen offset:512 lds
  s_add_u32 m0, s67, 4480
  s_nop 0
  buffer_load_dwordx4 v202, s[4:7], s60 offen offset:640 lds
  s_add_u32 m0, s67, 5376
  s_nop 0
  buffer_load_dwordx4 v202, s[4:7], s60 offen offset:768 lds
  s_add_u32 m0, s67, 6272
  s_nop 0
  buffer_load_dwordx4 v202, s[4:7], s60 offen offset:896 lds
  s_add_u32 m0, s67, 7168
  s_nop 0
  buffer_load_dwordx4 v202, s[4:7], s60 offen offset:1024 lds
  v_lshrrev_b32 v211, 4, v200
  v_lshlrev_b32 v212, 2, v211
  v_and_b32 v213, 15, v200
  v_xor_b32 v212, v212, v213
  v_lshlrev_b32 v212, 4, v212
  v_lshl_add_u32 v207, v211, 13, v212
  s_lshl_b32 s62, s58, 8
  s_lshl_b32 s54, s52, 15
  s_add_u32 s62, s62, s54
  s_lshl_b32 s61, s52, 10
  s_add_u32 s61, s61, 36864
  s_add_u32 m0, s61, 0
  s_add_u32 s54, s62, 0
  buffer_load_dwordx4 v207, s[16:19], s54 offen lds
  s_add_u32 m0, s61, 4096
  s_add_u32 s54, s62, 131072
  buffer_load_dwordx4 v207, s[16:19], s54 offen lds
  s_add_u32 m0, s61, 8192
  s_add_u32 s54, s62, 262144
  buffer_load_dwordx4 v207, s[16:19], s54 offen lds
  s_add_u32 m0, s61, 12288
  s_add_u32 s54, s62, 393216
  buffer_load_dwordx4 v207, s[16:19], s54 offen lds
  s_add_u32 m0, s61, 16384
  s_add_u32 s54, s62, 524288
  buffer_load_dwordx4 v207, s[16:19], s54 offen lds
  s_add_u32 m0, s61, 20480
  s_add_u32 s54, s62, 655360
  buffer_load_dwordx4 v207, s[16:19], s54 offen lds
  s_add_u32 m0, s61, 24576
  s_add_u32 s54, s62, 786432
  buffer_load_dwordx4 v207, s[16:19], s54 offen lds
  s_add_u32 m0, s61, 28672
  s_add_u32 s54, s62, 917504
  buffer_load_dwordx4 v207, s[16:19], s54 offen lds
  s_add_u32 m0, s61, 32768
  s_add_u32 s54, s62, 1048576
  buffer_load_dwordx4 v207, s[16:19], s54 offen lds
  s_add_u32 m0, s61, 36864
  s_add_u32 s54, s62, 1179648
  buffer_load_dwordx4 v207, s[16:19], s54 offen lds
  s_add_u32 m0, s61, 40960
  s_add_u32 s54, s62, 1310720
  buffer_load_dwordx4 v207, s[16:19], s54 offen lds
  s_add_u32 m0, s61, 45056
  s_add_u32 s54, s62, 1441792
  buffer_load_dwordx4 v207, s[16:19], s54 offen lds
  s_add_u32 m0, s61, 49152
  s_add_u32 s54, s62, 1572864
  buffer_load_dwordx4 v207, s[16:19], s54 offen lds
  s_add_u32 m0, s61, 53248
  s_add_u32 s54, s62, 1703936
  buffer_load_dwordx4 v207, s[16:19], s54 offen lds
  s_add_u32 m0, s61, 57344
  s_add_u32 s54, s62, 1835008
  buffer_load_dwordx4 v207, s[16:19], s54 offen lds
  s_add_u32 m0, s61, 61440
  s_add_u32 s54, s62, 1966080
  buffer_load_dwordx4 v207, s[16:19], s54 offen lds
  s_add_u32 m0, s61, 65536
  s_add_u32 s54, s62, 2097152
  buffer_load_dwordx4 v207, s[16:19], s54 offen lds
  s_add_u32 m0, s61, 69632
  s_add_u32 s54, s62, 2228224
  buffer_load_dwordx4 v207, s[16:19], s54 offen lds
  s_add_u32 m0, s61, 73728
  s_add_u32 s54, s62, 2359296
  buffer_load_dwordx4 v207, s[16:19], s54 offen lds
  s_add_u32 m0, s61, 77824
  s_add_u32 s54, s62, 2490368
  buffer_load_dwordx4 v207, s[16:19], s54 offen lds
  s_add_u32 m0, s61, 81920
  s_add_u32 s54, s62, 2621440
  buffer_load_dwordx4 v207, s[16:19], s54 offen lds
  s_add_u32 m0, s61, 86016
  s_add_u32 s54, s62, 2752512
  buffer_load_dwordx4 v207, s[16:19], s54 offen lds
  s_add_u32 m0, s61, 90112
  s_add_u32 s54, s62, 2883584
  buffer_load_dwordx4 v207, s[16:19], s54 offen lds
  s_add_u32 m0, s61, 94208
  s_add_u32 s54, s62, 3014656
  buffer_load_dwordx4 v207, s[16:19], s54 offen lds
  s_waitcnt vmcnt(20) lgkmcnt(0)
  s_barrier
  s_add_u32 m0, s61, 98304
  s_add_u32 s54, s62, 3145728
  buffer_load_dwordx4 v207, s[16:19], s54 offen lds
  s_add_u32 m0, s61, 102400
  s_add_u32 s54, s62, 3276800
  buffer_load_dwordx4 v207, s[16:19], s54 offen lds
  s_add_u32 m0, s61, 106496
  s_add_u32 s54, s62, 3407872
  buffer_load_dwordx4 v207, s[16:19], s54 offen lds
  s_add_u32 m0, s61, 110592
  s_add_u32 s54, s62, 3538944
  buffer_load_dwordx4 v207, s[16:19], s54 offen lds
  v_add_u32 v215, 36864, v209
  ds_read_b64_tr_b16 a[0:1], v215 offset:0
  ds_read_b64_tr_b16 a[2:3], v215 offset:1024
  ds_read_b64_tr_b16 a[4:5], v215 offset:4096
  ds_read_b64_tr_b16 a[6:7], v215 offset:5120
  ds_read_b64_tr_b16 a[8:9], v215 offset:8192
  ds_read_b64_tr_b16 a[10:11], v215 offset:9216
  ds_read_b64_tr_b16 a[12:13], v215 offset:12288
  ds_read_b64_tr_b16 a[14:15], v215 offset:13312
  s_waitcnt vmcnt(20) lgkmcnt(0)
  s_barrier
  s_add_u32 m0, s61, 0
  s_add_u32 s54, s62, 3670016
  buffer_load_dwordx4 v207, s[16:19], s54 offen lds
  s_add_u32 m0, s61, 4096
  s_add_u32 s54, s62, 3801088
  buffer_load_dwordx4 v207, s[16:19], s54 offen lds
  s_add_u32 m0, s61, 8192
  s_add_u32 s54, s62, 3932160
  buffer_load_dwordx4 v207, s[16:19], s54 offen lds
  s_add_u32 m0, s61, 12288
  s_add_u32 s54, s62, 4063232
  buffer_load_dwordx4 v207, s[16:19], s54 offen lds
  v_add_u32 v215, 53248, v209
  ds_read_b64_tr_b16 a[16:17], v215 offset:0
  ds_read_b64_tr_b16 a[18:19], v215 offset:1024
  ds_read_b64_tr_b16 a[20:21], v215 offset:4096
  ds_read_b64_tr_b16 a[22:23], v215 offset:5120
  ds_read_b64_tr_b16 a[24:25], v215 offset:8192
  ds_read_b64_tr_b16 a[26:27], v215 offset:9216
  ds_read_b64_tr_b16 a[28:29], v215 offset:12288
  ds_read_b64_tr_b16 a[30:31], v215 offset:13312
  s_waitcnt vmcnt(20) lgkmcnt(0)
  s_barrier
  s_add_u32 m0, s61, 16384
  s_add_u32 s54, s62, 4194304
  buffer_load_dwordx4 v207, s[16:19], s54 offen lds
  s_add_u32 m0, s61, 20480
  s_add_u32 s54, s62, 4325376
  buffer_load_dwordx4 v207, s[16:19], s54 offen lds
  s_add_u32 m0, s61, 24576
  s_add_u32 s54, s62, 4456448
  buffer_load_dwordx4 v207, s[16:19], s54 offen lds
  s_add_u32 m0, s61, 28672
  s_add_u32 s54, s62, 4587520
  buffer_load_dwordx4 v207, s[16:19], s54 offen lds
  v_add_u32 v215, 69632, v209
  ds_read_b64_tr_b16 a[32:33], v215 offset:0
  ds_read_b64_tr_b16 a[34:35], v215 offset:1024
  ds_read_b64_tr_b16 a[36:37], v215 offset:4096
  ds_read_b64_tr_b16 a[38:39], v215 offset:5120
  ds_read_b64_tr_b16 a[40:41], v215 offset:8192
  ds_read_b64_tr_b16 a[42:43], v215 offset:9216
  ds_read_b64_tr_b16 a[44:45], v215 offset:12288
  ds_read_b64_tr_b16 a[46:47], v215 offset:13312
  s_waitcnt vmcnt(20) lgkmcnt(0)
  s_barrier
  v_add_u32 v215, 86016, v209
  ds_read_b64_tr_b16 a[48:49], v215 offset:0
  ds_read_b64_tr_b16 a[50:51], v215 offset:1024
  ds_read_b64_tr_b16 a[52:53], v215 offset:4096
  ds_read_b64_tr_b16 a[54:55], v215 offset:5120
  ds_read_b64_tr_b16 a[56:57], v215 offset:8192
  ds_read_b64_tr_b16 a[58:59], v215 offset:9216
  ds_read_b64_tr_b16 a[60:61], v215 offset:12288
  ds_read_b64_tr_b16 a[62:63], v215 offset:13312
  s_waitcnt vmcnt(16) lgkmcnt(0)
  s_barrier
  v_add_u32 v215, 102400, v209
  ds_read_b64_tr_b16 a[64:65], v215 offset:0
  ds_read_b64_tr_b16 a[66:67], v215 offset:1024
  ds_read_b64_tr_b16 a[68:69], v215 offset:4096
  ds_read_b64_tr_b16 a[70:71], v215 offset:5120
  ds_read_b64_tr_b16 a[72:73], v215 offset:8192
  ds_read_b64_tr_b16 a[74:75], v215 offset:9216
  ds_read_b64_tr_b16 a[76:77], v215 offset:12288
  ds_read_b64_tr_b16 a[78:79], v215 offset:13312
  s_waitcnt vmcnt(12) lgkmcnt(0)
  s_barrier
  v_add_u32 v215, 118784, v209
  ds_read_b64_tr_b16 a[80:81], v215 offset:0
  ds_read_b64_tr_b16 a[82:83], v215 offset:1024
  ds_read_b64_tr_b16 a[84:85], v215 offset:4096
  ds_read_b64_tr_b16 a[86:87], v215 offset:5120
  ds_read_b64_tr_b16 a[88:89], v215 offset:8192
  ds_read_b64_tr_b16 a[90:91], v215 offset:9216
  ds_read_b64_tr_b16 a[92:93], v215 offset:12288
  ds_read_b64_tr_b16 a[94:95], v215 offset:13312
  s_waitcnt vmcnt(8) lgkmcnt(0)
  s_barrier
  v_add_u32 v215, 135168, v209
  ds_read_b64_tr_b16 a[96:97], v215 offset:0
  ds_read_b64_tr_b16 a[98:99], v215 offset:1024
  ds_read_b64_tr_b16 a[100:101], v215 offset:4096
  ds_read_b64_tr_b16 a[102:103], v215 offset:5120
  ds_read_b64_tr_b16 a[104:105], v215 offset:8192
  ds_read_b64_tr_b16 a[106:107], v215 offset:9216
  ds_read_b64_tr_b16 a[108:109], v215 offset:12288
  ds_read_b64_tr_b16 a[110:111], v215 offset:13312
  s_waitcnt vmcnt(4) lgkmcnt(0)
  s_barrier
  v_add_u32 v215, 36864, v209
  ds_read_b64_tr_b16 a[112:113], v215 offset:0
  ds_read_b64_tr_b16 a[114:115], v215 offset:1024
  ds_read_b64_tr_b16 a[116:117], v215 offset:4096
  ds_read_b64_tr_b16 a[118:119], v215 offset:5120
  ds_read_b64_tr_b16 a[120:121], v215 offset:8192
  ds_read_b64_tr_b16 a[122:123], v215 offset:9216
  ds_read_b64_tr_b16 a[124:125], v215 offset:12288
  ds_read_b64_tr_b16 a[126:127], v215 offset:13312
  s_waitcnt vmcnt(0) lgkmcnt(0)
  s_barrier
  v_add_u32 v215, 53248, v209
  ds_read_b64_tr_b16 a[128:129], v215 offset:0
  ds_read_b64_tr_b16 a[130:131], v215 offset:1024
  ds_read_b64_tr_b16 a[132:133], v215 offset:4096
  ds_read_b64_tr_b16 a[134:135], v215 offset:5120
  ds_read_b64_tr_b16 a[136:137], v215 offset:8192
  ds_read_b64_tr_b16 a[138:139], v215 offset:9216
  ds_read_b64_tr_b16 a[140:141], v215 offset:12288
  ds_read_b64_tr_b16 a[142:143], v215 offset:13312
  s_waitcnt lgkmcnt(0)
  s_barrier
  v_and_b32 v211, 31, v200
  v_lshrrev_b32 v212, 5, v200
  v_lshlrev_b32 v213, 2, v212
  v_sub_u32 v211, v211, v213
  v_mov_b32 v214, 0xf149f2ca
  v_cmp_gt_i32 vcc, 0, v211
  s_nop 1
  v_cndmask_b32 v48, 0, v214, vcc
  v_cmp_gt_i32 vcc, 1, v211
  s_nop 1
  v_cndmask_b32 v49, 0, v214, vcc
  v_cmp_gt_i32 vcc, 2, v211
  s_nop 1
  v_cndmask_b32 v50, 0, v214, vcc
  v_cmp_gt_i32 vcc, 3, v211
  s_nop 1
  v_cndmask_b32 v51, 0, v214, vcc
  v_cmp_gt_i32 vcc, 8, v211
  s_nop 1
  v_cndmask_b32 v52, 0, v214, vcc
  v_cmp_gt_i32 vcc, 9, v211
  s_nop 1
  v_cndmask_b32 v53, 0, v214, vcc
  v_cmp_gt_i32 vcc, 10, v211
  s_nop 1
  v_cndmask_b32 v54, 0, v214, vcc
  v_cmp_gt_i32 vcc, 11, v211
  s_nop 1
  v_cndmask_b32 v55, 0, v214, vcc
  v_cmp_gt_i32 vcc, 16, v211
  s_nop 1
  v_cndmask_b32 v56, 0, v214, vcc
  v_cmp_gt_i32 vcc, 17, v211
  s_nop 1
  v_cndmask_b32 v57, 0, v214, vcc
  v_cmp_gt_i32 vcc, 18, v211
  s_nop 1
  v_cndmask_b32 v58, 0, v214, vcc
  v_cmp_gt_i32 vcc, 19, v211
  s_nop 1
  v_cndmask_b32 v59, 0, v214, vcc
  v_cmp_gt_i32 vcc, 24, v211
  s_nop 1
  v_cndmask_b32 v60, 0, v214, vcc
  v_cmp_gt_i32 vcc, 25, v211
  s_nop 1
  v_cndmask_b32 v61, 0, v214, vcc
  v_cmp_gt_i32 vcc, 26, v211
  s_nop 1
  v_cndmask_b32 v62, 0, v214, vcc
  v_cmp_gt_i32 vcc, 27, v211
  s_nop 1
  v_cndmask_b32 v63, 0, v214, vcc
  v_and_b32 v218, 0xff, v216
  v_add_u32 v218, 81920, v218
  v_and_b32 v211, 15, v200
  v_lshl_add_u32 v211, v212, 5, v211
  v_lshlrev_b32 v219, 3, v211
  v_bfe_u32 v211, v200, 4, 1
  v_lshl_add_u32 v219, v211, 2, v219
  s_lshl_b32 s54, s52, 9
  s_add_u32 s54, s54, 83968
  v_add_u32 v219, s54, v219
  v_lshl_add_u32 v221, v200, 3, s54
  s_lshr_b32 s54, s52, 1
  s_lshl_b32 s54, s54, 10
  s_and_b32 s55, s52, 1
  s_lshl_b32 s55, s55, 3
  s_add_u32 s54, s54, s55
  s_add_u32 s54, s54, 81920
  v_add_u32 v220, s54, v201
  s_lshl_b32 s54, s52, 11
  s_add_u32 s54, s54, 73728
  v_add_u32 v215, s54, v201
  v_add_u32 v208, 73728, v201
  s_mov_b32 s68, 1040356334
  s_cmp_eq_u32 s52, 0
  s_cselect_b32 s71, s71, 268435456
  s_lshl_b32 s56, s58, 2
  s_add_u32 s56, s56, 128
  v_mov_b32 v176, -1
  v_mov_b32 v177, -1
  v_mov_b32 v178, -1
  v_mov_b32 v179, -1
  s_cmp_eq_u32 s52, 0
  s_cbranch_scc0 AT_p1_d
  s_mov_b32 exec_hi, 0
  s_mov_b32 exec_lo, 1
AT_p1:
  buffer_load_dword v211, v201, s[12:15], s56 offen sc1
  s_add_u32 s65, s65, 1
  s_waitcnt vmcnt(0)
  v_cmp_gt_u32 vcc, 0x700, v211
  s_cbranch_vccz AT_p1_x
  s_sleep 8
  s_cmp_lt_u32 s65, 131072
  s_cbranch_scc1 AT_p1
AT_p1_x:
  s_mov_b64 exec, -1
AT_p1_d:
  s_barrier
  s_mov_b32 s74, s59
  s_mul_i32 s66, s59, 655360
  s_lshl_b32 s55, s58, 14
  s_add_u32 s55, s55, s66
  s_add_u32 s55, s55, 1048576
  s_lshl_b32 s73, s58, 2
  s_add_u32 s73, s73, s52
  s_lshl_b32 s72, s59, 7
  s_add_u32 s72, s72, s73
  s_lshl_b32 s72, s72, 11
  s_add_u32 s72, s72, 46137344
  s_lshl_b32 s73, s73, 10
  s_add_u32 s73, s73, s66
  s_add_u32 s73, s73, 1572864
  s_add_u32 s59, s59, 2
  buffer_load_dwordx4 v[128:131], v216, s[8:11], s55 offen offset:0 sc1
  buffer_load_dwordx4 v[132:135], v216, s[8:11], s55 offen offset:256 sc1
  buffer_load_dwordx4 v[136:139], v216, s[8:11], s55 offen offset:512 sc1
  buffer_load_dwordx4 v[140:143], v216, s[8:11], s55 offen offset:768 sc1
  buffer_load_dwordx4 v[144:147], v216, s[8:11], s55 offen offset:1024 sc1
  buffer_load_dwordx4 v[148:151], v216, s[8:11], s55 offen offset:1280 sc1
  buffer_load_dwordx4 v[152:155], v216, s[8:11], s55 offen offset:1536 sc1
  buffer_load_dwordx4 v[156:159], v216, s[8:11], s55 offen offset:1792 sc1
  buffer_load_dwordx4 v[160:163], v217, s[8:11], s55 offen offset:0 sc1
  buffer_load_dwordx4 v[164:167], v217, s[8:11], s55 offen offset:256 sc1
  s_add_u32 s60, s60, 73728
  ds_read_b128 v[32:35], v203 offset:0
  ds_read_b128 v[36:39], v204 offset:0
  ds_read_b128 v[40:43], v205 offset:0
  s_waitcnt lgkmcnt(2)
  v_mfma_f32_32x32x16_bf16 v[240:255], a[0:3], v[32:35], 0
  ds_read_b128 v[44:47], v206 offset:0
  s_add_u32 m0, s67, 36864
  s_nop 0
  buffer_load_dwordx4 v202, s[4:7], s60 offen offset:0 lds
  s_waitcnt lgkmcnt(2)
  v_mfma_f32_32x32x16_bf16 v[240:255], a[4:7], v[36:39], v[240:255]
  ds_read_b128 v[32:35], v203 offset:1024
  s_waitcnt lgkmcnt(2)
  v_mfma_f32_32x32x16_bf16 v[240:255], a[8:11], v[40:43], v[240:255]
  ds_read_b128 v[36:39], v204 offset:1024
  s_add_u32 m0, s67, 37760
  s_nop 0
  buffer_load_dwordx4 v202, s[4:7], s60 offen offset:128 lds
  s_waitcnt lgkmcnt(2)
  v_mfma_f32_32x32x16_bf16 v[240:255], a[12:15], v[44:47], v[240:255]
  ds_read_b128 v[40:43], v205 offset:1024
  s_waitcnt lgkmcnt(2)
  v_mfma_f32_32x32x16_bf16 v[240:255], a[16:19], v[32:35], v[240:255]
  ds_read_b128 v[44:47], v206 offset:1024
  s_add_u32 m0, s67, 38656
  s_nop 0
  buffer_load_dwordx4 v202, s[4:7], s60 offen offset:256 lds
  s_waitcnt lgkmcnt(2)
  v_mfma_f32_32x32x16_bf16 v[240:255], a[20:23], v[36:39], v[240:255]
  ds_read_b128 v[32:35], v203 offset:2048
  s_waitcnt lgkmcnt(2)
  v_mfma_f32_32x32x16_bf16 v[240:255], a[24:27], v[40:43], v[240:255]
  ds_read_b128 v[36:39], v204 offset:2048
  s_add_u32 m0, s67, 39552
  s_nop 0
  buffer_load_dwordx4 v202, s[4:7], s60 offen offset:384 lds
  s_waitcnt lgkmcnt(2)
  v_mfma_f32_32x32x16_bf16 v[240:255], a[28:31], v[44:47], v[240:255]
  ds_read_b128 v[40:43], v205 offset:2048
  s_waitcnt lgkmcnt(2)
  v_mfma_f32_32x32x16_bf16 v[240:255], a[32:35], v[32:35], v[240:255]
  ds_read_b128 v[44:47], v206 offset:2048
  s_add_u32 m0, s67, 40448
  s_nop 0
  buffer_load_dwordx4 v202, s[4:7], s60 offen offset:512 lds
  s_waitcnt lgkmcnt(2)
  v_mfma_f32_32x32x16_bf16 v[240:255], a[36:39], v[36:39], v[240:255]
  ds_read_b128 v[32:35], v203 offset:3072
  s_waitcnt lgkmcnt(2)
  v_mfma_f32_32x32x16_bf16 v[240:255], a[40:43], v[40:43], v[240:255]
  ds_read_b128 v[36:39], v204 offset:3072
  s_add_u32 m0, s67, 41344
  s_nop 0
  buffer_load_dwordx4 v202, s[4:7], s60 offen offset:640 lds
  s_waitcnt lgkmcnt(2)
  v_mfma_f32_32x32x16_bf16 v[240:255], a[44:47], v[44:47], v[240:255]
  ds_read_b128 v[40:43], v205 offset:3072
  s_waitcnt lgkmcnt(2)
  v_mfma_f32_32x32x16_bf16 v[240:255], a[48:51], v[32:35], v[240:255]
  ds_read_b128 v[44:47], v206 offset:3072
  s_add_u32 m0, s67, 42240
  s_nop 0
  buffer_load_dwordx4 v202, s[4:7], s60 offen offset:768 lds
  s_waitcnt lgkmcnt(2)
  v_mfma_f32_32x32x16_bf16 v[240:255], a[52:55], v[36:39], v[240:255]
  ds_read_b128 v[32:35], v203 offset:4096
  s_waitcnt lgkmcnt(2)
  v_mfma_f32_32x32x16_bf16 v[240:255], a[56:59], v[40:43], v[240:255]
  ds_read_b128 v[36:39], v204 offset:4096
  s_add_u32 m0, s67, 43136
  s_nop 0
  buffer_load_dwordx4 v202, s[4:7], s60 offen offset:896 lds
  s_waitcnt lgkmcnt(2)
  v_mfma_f32_32x32x16_bf16 v[240:255], a[60:63], v[44:47], v[240:255]
  ds_read_b128 v[40:43], v205 offset:4096
  s_waitcnt lgkmcnt(2)
  v_mfma_f32_32x32x16_bf16 v[240:255], a[64:67], v[32:35], v[240:255]
  ds_read_b128 v[44:47], v206 offset:4096
  s_add_u32 m0, s67, 44032
  s_nop 0
  buffer_load_dwordx4 v202, s[4:7], s60 offen offset:1024 lds
  s_waitcnt lgkmcnt(2)
  v_mfma_f32_32x32x16_bf16 v[240:255], a[68:71], v[36:39], v[240:255]
  ds_read_b128 v[32:35], v203 offset:5120
  s_waitcnt lgkmcnt(2)
  v_mfma_f32_32x32x16_bf16 v[240:255], a[72:75], v[40:43], v[240:255]
  ds_read_b128 v[36:39], v204 offset:5120
  buffer_store_dwordx4 v[176:179], v201, s[8:11], s72 offen offset:0 sc1
  s_waitcnt lgkmcnt(2)
  v_mfma_f32_32x32x16_bf16 v[240:255], a[76:79], v[44:47], v[240:255]
  ds_read_b128 v[40:43], v205 offset:5120
  s_waitcnt lgkmcnt(2)
  v_mfma_f32_32x32x16_bf16 v[240:255], a[80:83], v[32:35], v[240:255]
  ds_read_b128 v[44:47], v206 offset:5120
  buffer_store_dwordx4 v[176:179], v201, s[8:11], s72 offen offset:1024 sc1
  s_waitcnt lgkmcnt(2)
  v_mfma_f32_32x32x16_bf16 v[240:255], a[84:87], v[36:39], v[240:255]
  ds_read_b128 v[32:35], v203 offset:6144
  s_waitcnt lgkmcnt(2)
  v_mfma_f32_32x32x16_bf16 v[240:255], a[88:91], v[40:43], v[240:255]
  ds_read_b128 v[36:39], v204 offset:6144
  s_waitcnt lgkmcnt(2)
  v_mfma_f32_32x32x16_bf16 v[240:255], a[92:95], v[44:47], v[240:255]
  ds_read_b128 v[40:43], v205 offset:6144
  s_waitcnt lgkmcnt(2)
  v_mfma_f32_32x32x16_bf16 v[240:255], a[96:99], v[32:35], v[240:255]
  ds_read_b128 v[44:47], v206 offset:6144
  s_waitcnt lgkmcnt(2)
  v_mfma_f32_32x32x16_bf16 v[240:255], a[100:103], v[36:39], v[240:255]
  ds_read_b128 v[32:35], v203 offset:7168
  s_waitcnt lgkmcnt(2)
  v_mfma_f32_32x32x16_bf16 v[240:255], a[104:107], v[40:43], v[240:255]
  ds_read_b128 v[36:39], v204 offset:7168
  s_waitcnt lgkmcnt(2)
  v_mfma_f32_32x32x16_bf16 v[240:255], a[108:111], v[44:47], v[240:255]
  ds_read_b128 v[40:43], v205 offset:7168
  s_waitcnt lgkmcnt(2)
  v_mfma_f32_32x32x16_bf16 v[240:255], a[112:115], v[32:35], v[240:255]
  ds_read_b128 v[44:47], v206 offset:7168
  s_waitcnt lgkmcnt(2)
  v_mfma_f32_32x32x16_bf16 v[240:255], a[116:119], v[36:39], v[240:255]
  ds_read_b128 v[32:35], v203 offset:8192
  s_waitcnt lgkmcnt(2)
  v_mfma_f32_32x32x16_bf16 v[240:255], a[120:123], v[40:43], v[240:255]
  ds_read_b128 v[36:39], v204 offset:8192
  s_waitcnt lgkmcnt(2)
  v_mfma_f32_32x32x16_bf16 v[240:255], a[124:127], v[44:47], v[240:255]
  ds_read_b128 v[40:43], v205 offset:8192
  s_waitcnt lgkmcnt(2)
  v_mfma_f32_32x32x16_bf16 v[240:255], a[128:131], v[32:35], v[240:255]
  ds_read_b128 v[44:47], v206 offset:8192
  s_waitcnt lgkmcnt(2)
  v_mfma_f32_32x32x16_bf16 v[240:255], a[132:135], v[36:39], v[240:255]
  s_waitcnt lgkmcnt(1)
  v_mfma_f32_32x32x16_bf16 v[240:255], a[136:139], v[40:43], v[240:255]
  s_waitcnt lgkmcnt(0)
  v_mfma_f32_32x32x16_bf16 v[240:255], a[140:143], v[44:47], v[240:255]
  s_nop 11
  v_cvt_pk_bf16_f32 v16, v240, v244
  v_cvt_pk_bf16_f32 v17, v241, v245
  v_cvt_pk_bf16_f32 v18, v242, v246
  v_cvt_pk_bf16_f32 v19, v243, v247
  ds_write_b128 v215, v[16:19] offset:0
  v_cvt_pk_bf16_f32 v20, v248, v252
  v_cvt_pk_bf16_f32 v21, v249, v253
  v_cvt_pk_bf16_f32 v22, v250, v254
  v_cvt_pk_bf16_f32 v23, v251, v255
  ds_write_b128 v215, v[20:23] offset:1024
  s_waitcnt lgkmcnt(0)
  s_barrier
  ds_read_b128 v[96:99], v208 offset:0
  ds_read_b128 v[100:103], v208 offset:1024
  ds_read_b128 v[104:107], v208 offset:2048
  ds_read_b128 v[108:111], v208 offset:3072
  ds_read_b128 v[112:115], v208 offset:4096
  ds_read_b128 v[116:119], v208 offset:5120
  ds_read_b128 v[120:123], v208 offset:6144
  ds_read_b128 v[124:127], v208 offset:7168
  s_waitcnt vmcnt(20) lgkmcnt(7)
  v_mfma_f32_32x32x16_bf16 v[64:79], v[128:131], v[96:99], v[48:63]
  s_waitcnt vmcnt(19) lgkmcnt(6)
  v_mfma_f32_32x32x16_bf16 v[64:79], v[132:135], v[100:103], v[64:79]
  s_waitcnt vmcnt(18) lgkmcnt(5)
  v_mfma_f32_32x32x16_bf16 v[64:79], v[136:139], v[104:107], v[64:79]
  s_waitcnt vmcnt(17) lgkmcnt(4)
  v_mfma_f32_32x32x16_bf16 v[64:79], v[140:143], v[108:111], v[64:79]
  s_waitcnt vmcnt(16) lgkmcnt(3)
  v_mfma_f32_32x32x16_bf16 v[64:79], v[144:147], v[112:115], v[64:79]
  s_waitcnt vmcnt(15) lgkmcnt(2)
  v_mfma_f32_32x32x16_bf16 v[64:79], v[148:151], v[116:119], v[64:79]
  s_waitcnt vmcnt(14) lgkmcnt(1)
  v_mfma_f32_32x32x16_bf16 v[64:79], v[152:155], v[120:123], v[64:79]
  s_waitcnt vmcnt(13) lgkmcnt(0)
  v_mfma_f32_32x32x16_bf16 v[64:79], v[156:159], v[124:127], v[64:79]
  s_nop 11
  v_max3_f32 v180, v64, v65, v66
  v_max3_f32 v180, v180, v67, v68
  v_max3_f32 v180, v180, v69, v70
  v_max3_f32 v180, v180, v71, v72
  v_max3_f32 v180, v180, v73, v74
  v_max3_f32 v180, v180, v75, v76
  v_max3_f32 v180, v180, v77, v78
  v_max_f32 v180, v180, v79
  v_mov_b32 v181, v180
  s_nop 1
  v_permlane32_swap_b32 v180, v181
  v_max_f32 v180, v180, v181
  v_sub_f32 v64, v64, v180
  v_sub_f32 v65, v65, v180
  v_sub_f32 v66, v66, v180
  v_sub_f32 v67, v67, v180
  v_sub_f32 v68, v68, v180
  v_sub_f32 v69, v69, v180
  v_sub_f32 v70, v70, v180
  v_sub_f32 v71, v71, v180
  v_sub_f32 v72, v72, v180
  v_sub_f32 v73, v73, v180
  v_sub_f32 v74, v74, v180
  v_sub_f32 v75, v75, v180
  v_sub_f32 v76, v76, v180
  v_sub_f32 v77, v77, v180
  v_sub_f32 v78, v78, v180
  v_sub_f32 v79, v79, v180
  v_exp_f32 v64, v64
  v_exp_f32 v65, v65
  v_exp_f32 v66, v66
  v_exp_f32 v67, v67
  v_exp_f32 v68, v68
  v_exp_f32 v69, v69
  v_exp_f32 v70, v70
  v_exp_f32 v71, v71
  v_exp_f32 v72, v72
  v_exp_f32 v73, v73
  v_exp_f32 v74, v74
  v_exp_f32 v75, v75
  v_exp_f32 v76, v76
  v_exp_f32 v77, v77
  v_exp_f32 v78, v78
  v_exp_f32 v79, v79
  v_cvt_pk_bf16_f32 v20, v64, v65
  v_cvt_pk_bf16_f32 v21, v68, v69
  v_cvt_pk_bf16_f32 v22, v72, v73
  v_cvt_pk_bf16_f32 v23, v76, v77
  v_cvt_pk_bf16_f32 v24, v66, v67
  v_cvt_pk_bf16_f32 v25, v70, v71
  v_cvt_pk_bf16_f32 v26, v74, v75
  v_cvt_pk_bf16_f32 v27, v78, v79
  s_waitcnt vmcnt(12)
  v_mfma_f32_32x32x16_bf16 v[0:15], v[160:163], v[20:23], 0
  v_add_f32 v182, v64, v65
  v_add_f32 v182, v182, v66
  v_add_f32 v182, v182, v67
  v_add_f32 v182, v182, v68
  v_add_f32 v182, v182, v69
  v_add_f32 v182, v182, v70
  v_add_f32 v182, v182, v71
  s_waitcnt vmcnt(11)
  v_mfma_f32_32x32x16_bf16 v[0:15], v[164:167], v[24:27], v[0:15]
  v_add_f32 v182, v182, v72
  v_add_f32 v182, v182, v73
  v_add_f32 v182, v182, v74
  v_add_f32 v182, v182, v75
  v_add_f32 v182, v182, v76
  v_add_f32 v182, v182, v77
  v_add_f32 v182, v182, v78
  v_add_f32 v182, v182, v79
  s_waitcnt vmcnt(0)
  s_barrier
AT_loop:
  s_cmp_ge_u32 s59, 64
  s_cbranch_scc1 AT_l0
  s_mov_b32 s77, s59
  s_mul_i32 s66, s59, 655360
  s_lshl_b32 s55, s58, 14
  s_add_u32 s55, s55, s66
  s_add_u32 s55, s55, 1048576
  s_lshl_b32 s76, s58, 2
  s_add_u32 s76, s76, s52
  s_lshl_b32 s75, s59, 7
  s_add_u32 s75, s75, s76
  s_lshl_b32 s75, s75, 11
  s_add_u32 s75, s75, 46137344
  s_lshl_b32 s76, s76, 10
  s_add_u32 s76, s76, s66
  s_add_u32 s76, s76, 1572864
  s_add_u32 s59, s59, 2
  buffer_load_dwordx4 v[128:131], v216, s[8:11], s55 offen offset:0 sc1
  buffer_load_dwordx4 v[132:135], v216, s[8:11], s55 offen offset:256 sc1
  buffer_load_dwordx4 v[136:139], v216, s[8:11], s55 offen offset:512 sc1
  buffer_load_dwordx4 v[140:143], v216, s[8:11], s55 offen offset:768 sc1
  buffer_load_dwordx4 v[144:147], v216, s[8:11], s55 offen offset:1024 sc1
  buffer_load_dwordx4 v[148:151], v216, s[8:11], s55 offen offset:1280 sc1
  buffer_load_dwordx4 v[152:155], v216, s[8:11], s55 offen offset:1536 sc1
  buffer_load_dwordx4 v[156:159], v216, s[8:11], s55 offen offset:1792 sc1
  buffer_load_dwordx4 v[160:163], v217, s[8:11], s55 offen offset:0 sc1
  buffer_load_dwordx4 v[164:167], v217, s[8:11], s55 offen offset:256 sc1
  s_or_b32 s70, s73, 0xc00
  buffer_load_dword v172, off, s[8:11], s70 sc1
  s_add_u32 s60, s60, 73728
  ds_read_b128 v[32:35], v203 offset:36864
  ds_read_b128 v[36:39], v204 offset:36864
  ds_read_b128 v[40:43], v205 offset:36864
  s_waitcnt lgkmcnt(2)
  v_mfma_f32_32x32x16_bf16 v[240:255], a[0:3], v[32:35], 0
  ds_read_b128 v[44:47], v206 offset:36864
  s_add_u32 m0, s67, 0
  s_nop 0
  buffer_load_dwordx4 v202, s[4:7], s60 offen offset:0 lds
  s_waitcnt lgkmcnt(2)
  v_mfma_f32_32x32x16_bf16 v[240:255], a[4:7], v[36:39], v[240:255]
  ds_read_b128 v[32:35], v203 offset:37888
  s_waitcnt lgkmcnt(2)
  v_mfma_f32_32x32x16_bf16 v[240:255], a[8:11], v[40:43], v[240:255]
  ds_read_b128 v[36:39], v204 offset:37888
  s_add_u32 m0, s67, 896
  s_nop 0
  buffer_load_dwordx4 v202, s[4:7], s60 offen offset:128 lds
  s_waitcnt lgkmcnt(2)
  v_mfma_f32_32x32x16_bf16 v[240:255], a[12:15], v[44:47], v[240:255]
  ds_read_b128 v[40:43], v205 offset:37888
  s_waitcnt lgkmcnt(2)
  v_mfma_f32_32x32x16_bf16 v[240:255], a[16:19], v[32:35], v[240:255]
  ds_read_b128 v[44:47], v206 offset:37888
  s_add_u32 m0, s67, 1792
  s_nop 0
  buffer_load_dwordx4 v202, s[4:7], s60 offen offset:256 lds
  s_waitcnt lgkmcnt(2)
  v_mfma_f32_32x32x16_bf16 v[240:255], a[20:23], v[36:39], v[240:255]
  ds_read_b128 v[32:35], v203 offset:38912
  s_waitcnt lgkmcnt(2)
  v_mfma_f32_32x32x16_bf16 v[240:255], a[24:27], v[40:43], v[240:255]
  ds_read_b128 v[36:39], v204 offset:38912
  s_add_u32 m0, s67, 2688
  s_nop 0
  buffer_load_dwordx4 v202, s[4:7], s60 offen offset:384 lds
  s_waitcnt lgkmcnt(2)
  v_mfma_f32_32x32x16_bf16 v[240:255], a[28:31], v[44:47], v[240:255]
  ds_read_b128 v[40:43], v205 offset:38912
  s_waitcnt lgkmcnt(2)
  v_mfma_f32_32x32x16_bf16 v[240:255], a[32:35], v[32:35], v[240:255]
  ds_read_b128 v[44:47], v206 offset:38912
  s_add_u32 m0, s67, 3584
  s_nop 0
  buffer_load_dwordx4 v202, s[4:7], s60 offen offset:512 lds
  s_waitcnt lgkmcnt(2)
  v_mfma_f32_32x32x16_bf16 v[240:255], a[36:39], v[36:39], v[240:255]
  ds_read_b128 v[32:35], v203 offset:39936
  s_waitcnt lgkmcnt(2)
  v_mfma_f32_32x32x16_bf16 v[240:255], a[40:43], v[40:43], v[240:255]
  ds_read_b128 v[36:39], v204 offset:39936
  s_add_u32 m0, s67, 4480
  s_nop 0
  buffer_load_dwordx4 v202, s[4:7], s60 offen offset:640 lds
  s_waitcnt lgkmcnt(2)
  v_mfma_f32_32x32x16_bf16 v[240:255], a[44:47], v[44:47], v[240:255]
  ds_read_b128 v[40:43], v205 offset:39936
  s_waitcnt lgkmcnt(2)
  v_mfma_f32_32x32x16_bf16 v[240:255], a[48:51], v[32:35], v[240:255]
  ds_read_b128 v[44:47], v206 offset:39936
  s_add_u32 m0, s67, 5376
  s_nop 0
  buffer_load_dwordx4 v202, s[4:7], s60 offen offset:768 lds
  s_waitcnt lgkmcnt(2)
  v_mfma_f32_32x32x16_bf16 v[240:255], a[52:55], v[36:39], v[240:255]
  ds_read_b128 v[32:35], v203 offset:40960
  s_waitcnt lgkmcnt(2)
  v_mfma_f32_32x32x16_bf16 v[240:255], a[56:59], v[40:43], v[240:255]
  ds_read_b128 v[36:39], v204 offset:40960
  s_add_u32 m0, s67, 6272
  s_nop 0
  buffer_load_dwordx4 v202, s[4:7], s60 offen offset:896 lds
  s_waitcnt lgkmcnt(2)
  v_mfma_f32_32x32x16_bf16 v[240:255], a[60:63], v[44:47], v[240:255]
  ds_read_b128 v[40:43], v205 offset:40960
  s_waitcnt lgkmcnt(2)
  v_mfma_f32_32x32x16_bf16 v[240:255], a[64:67], v[32:35], v[240:255]
  ds_read_b128 v[44:47], v206 offset:40960
  s_add_u32 m0, s67, 7168
  s_nop 0
  buffer_load_dwordx4 v202, s[4:7], s60 offen offset:1024 lds
  s_waitcnt lgkmcnt(2)
  v_mfma_f32_32x32x16_bf16 v[240:255], a[68:71], v[36:39], v[240:255]
  ds_read_b128 v[32:35], v203 offset:41984
  s_waitcnt lgkmcnt(2)
  v_mfma_f32_32x32x16_bf16 v[240:255], a[72:75], v[40:43], v[240:255]
  ds_read_b128 v[36:39], v204 offset:41984
  buffer_store_dwordx4 v[176:179], v201, s[8:11], s75 offen offset:0 sc1
  s_waitcnt lgkmcnt(2)
  v_mfma_f32_32x32x16_bf16 v[240:255], a[76:79], v[44:47], v[240:255]
  ds_read_b128 v[40:43], v205 offset:41984
  s_waitcnt lgkmcnt(2)
  v_mfma_f32_32x32x16_bf16 v[240:255], a[80:83], v[32:35], v[240:255]
  ds_read_b128 v[44:47], v206 offset:41984
  buffer_store_dwordx4 v[176:179], v201, s[8:11], s75 offen offset:1024 sc1
  s_waitcnt lgkmcnt(2)
  v_mfma_f32_32x32x16_bf16 v[240:255], a[84:87], v[36:39], v[240:255]
  ds_read_b128 v[32:35], v203 offset:43008
  s_waitcnt lgkmcnt(2)
  v_mfma_f32_32x32x16_bf16 v[240:255], a[88:91], v[40:43], v[240:255]
  ds_read_b128 v[36:39], v204 offset:43008
  s_waitcnt lgkmcnt(2)
  v_mfma_f32_32x32x16_bf16 v[240:255], a[92:95], v[44:47], v[240:255]
  ds_read_b128 v[40:43], v205 offset:43008
  s_waitcnt lgkmcnt(2)
  v_mfma_f32_32x32x16_bf16 v[240:255], a[96:99], v[32:35], v[240:255]
  ds_read_b128 v[44:47], v206 offset:43008
  s_waitcnt lgkmcnt(2)
  v_mfma_f32_32x32x16_bf16 v[240:255], a[100:103], v[36:39], v[240:255]
  ds_read_b128 v[32:35], v203 offset:44032
  s_waitcnt lgkmcnt(2)
  v_mfma_f32_32x32x16_bf16 v[240:255], a[104:107], v[40:43], v[240:255]
  ds_read_b128 v[36:39], v204 offset:44032
  s_waitcnt lgkmcnt(2)
  v_mfma_f32_32x32x16_bf16 v[240:255], a[108:111], v[44:47], v[240:255]
  ds_read_b128 v[40:43], v205 offset:44032
  s_waitcnt lgkmcnt(2)
  v_mfma_f32_32x32x16_bf16 v[240:255], a[112:115], v[32:35], v[240:255]
  ds_read_b128 v[44:47], v206 offset:44032
  s_waitcnt lgkmcnt(2)
  v_mfma_f32_32x32x16_bf16 v[240:255], a[116:119], v[36:39], v[240:255]
  ds_read_b128 v[32:35], v203 offset:45056
  s_waitcnt lgkmcnt(2)
  v_mfma_f32_32x32x16_bf16 v[240:255], a[120:123], v[40:43], v[240:255]
  ds_read_b128 v[36:39], v204 offset:45056
  s_waitcnt lgkmcnt(2)
  v_mfma_f32_32x32x16_bf16 v[240:255], a[124:127], v[44:47], v[240:255]
  ds_read_b128 v[40:43], v205 offset:45056
  s_waitcnt lgkmcnt(2)
  v_mfma_f32_32x32x16_bf16 v[240:255], a[128:131], v[32:35], v[240:255]
  ds_read_b128 v[44:47], v206 offset:45056
  s_waitcnt lgkmcnt(2)
  v_mfma_f32_32x32x16_bf16 v[240:255], a[132:135], v[36:39], v[240:255]
  s_waitcnt lgkmcnt(1)
  v_mfma_f32_32x32x16_bf16 v[240:255], a[136:139], v[40:43], v[240:255]
  s_waitcnt lgkmcnt(0)
  v_mfma_f32_32x32x16_bf16 v[240:255], a[140:143], v[44:47], v[240:255]
  s_nop 11
  v_cvt_pk_bf16_f32 v16, v240, v244
  v_cvt_pk_bf16_f32 v17, v241, v245
  v_cvt_pk_bf16_f32 v18, v242, v246
  v_cvt_pk_bf16_f32 v19, v243, v247
  ds_write_b128 v215, v[16:19] offset:0
  v_cvt_pk_bf16_f32 v20, v248, v252
  v_cvt_pk_bf16_f32 v21, v249, v253
  v_cvt_pk_bf16_f32 v22, v250, v254
  v_cvt_pk_bf16_f32 v23, v251, v255
  ds_write_b128 v215, v[20:23] offset:1024
  s_waitcnt lgkmcnt(0)
  s_barrier
  ds_read_b128 a[144:147], v208 offset:0
  ds_read_b128 a[148:151], v208 offset:1024
  ds_read_b128 a[152:155], v208 offset:2048
  ds_read_b128 a[156:159], v208 offset:3072
  ds_read_b128 a[160:163], v208 offset:4096
  ds_read_b128 a[164:167], v208 offset:5120
  ds_read_b128 a[168:171], v208 offset:6144
  ds_read_b128 a[172:175], v208 offset:7168
  s_waitcnt vmcnt(11)
  v_cmp_eq_u32 vcc, -1, v172
  s_mov_b32 s69, 0
  s_cbranch_vccnz AT_e1
  s_mov_b32 s69, 1
  buffer_load_dwordx4 v[172:175], v201, s[8:11], s73 offen sc1
AT_e1:
  s_waitcnt lgkmcnt(7)
  v_mfma_f32_32x32x16_bf16 v[64:79], v[128:131], a[144:147], v[48:63]
  s_waitcnt lgkmcnt(6)
  v_mfma_f32_32x32x16_bf16 v[64:79], v[132:135], a[148:151], v[64:79]
  s_waitcnt lgkmcnt(5)
  v_mfma_f32_32x32x16_bf16 v[64:79], v[136:139], a[152:155], v[64:79]
  s_waitcnt lgkmcnt(4)
  v_mfma_f32_32x32x16_bf16 v[64:79], v[140:143], a[156:159], v[64:79]
  s_waitcnt lgkmcnt(3)
  v_mfma_f32_32x32x16_bf16 v[64:79], v[144:147], a[160:163], v[64:79]
  s_waitcnt lgkmcnt(2)
  v_mfma_f32_32x32x16_bf16 v[64:79], v[148:151], a[164:167], v[64:79]
  s_waitcnt lgkmcnt(1)
  v_mfma_f32_32x32x16_bf16 v[64:79], v[152:155], a[168:171], v[64:79]
  s_waitcnt lgkmcnt(0)
  v_mfma_f32_32x32x16_bf16 v[64:79], v[156:159], a[172:175], v[64:79]
  s_nop 11
  v_max3_f32 v184, v64, v65, v66
  v_max3_f32 v184, v184, v67, v68
  v_max3_f32 v184, v184, v69, v70
  v_max3_f32 v184, v184, v71, v72
  v_max3_f32 v184, v184, v73, v74
  v_max3_f32 v184, v184, v75, v76
  v_max3_f32 v184, v184, v77, v78
  v_max_f32 v184, v184, v79
  v_mov_b32 v185, v184
  s_nop 1
  v_permlane32_swap_b32 v184, v185
  v_max_f32 v184, v184, v185
  v_sub_f32 v64, v64, v184
  v_sub_f32 v65, v65, v184
  v_sub_f32 v66, v66, v184
  v_sub_f32 v67, v67, v184
  v_sub_f32 v68, v68, v184
  v_sub_f32 v69, v69, v184
  v_sub_f32 v70, v70, v184
  v_sub_f32 v71, v71, v184
  v_sub_f32 v72, v72, v184
  v_sub_f32 v73, v73, v184
  v_sub_f32 v74, v74, v184
  v_sub_f32 v75, v75, v184
  v_sub_f32 v76, v76, v184
  v_sub_f32 v77, v77, v184
  v_sub_f32 v78, v78, v184
  v_sub_f32 v79, v79, v184
  v_exp_f32 v64, v64
  v_exp_f32 v65, v65
  v_exp_f32 v66, v66
  v_exp_f32 v67, v67
  v_exp_f32 v68, v68
  v_exp_f32 v69, v69
  v_exp_f32 v70, v70
  v_exp_f32 v71, v71
  v_exp_f32 v72, v72
  v_exp_f32 v73, v73
  v_exp_f32 v74, v74
  v_exp_f32 v75, v75
  v_exp_f32 v76, v76
  v_exp_f32 v77, v77
  v_exp_f32 v78, v78
  v_exp_f32 v79, v79
  v_cvt_pk_bf16_f32 v20, v64, v65
  v_cvt_pk_bf16_f32 v21, v68, v69
  v_cvt_pk_bf16_f32 v22, v72, v73
  v_cvt_pk_bf16_f32 v23, v76, v77
  v_cvt_pk_bf16_f32 v24, v66, v67
  v_cvt_pk_bf16_f32 v25, v70, v71
  v_cvt_pk_bf16_f32 v26, v74, v75
  v_cvt_pk_bf16_f32 v27, v78, v79
  v_mfma_f32_32x32x16_bf16 v[224:239], v[160:163], v[20:23], 0
  v_add_f32 v186, v64, v65
  v_add_f32 v186, v186, v66
  v_add_f32 v186, v186, v67
  v_add_f32 v186, v186, v68
  v_add_f32 v186, v186, v69
  v_add_f32 v186, v186, v70
  v_add_f32 v186, v186, v71
  v_mfma_f32_32x32x16_bf16 v[224:239], v[164:167], v[24:27], v[224:239]
  v_add_f32 v186, v186, v72
  v_add_f32 v186, v186, v73
  v_add_f32 v186, v186, v74
  v_add_f32 v186, v186, v75
  v_add_f32 v186, v186, v76
  v_add_f32 v186, v186, v77
  v_add_f32 v186, v186, v78
  v_add_f32 v186, v186, v79
AT_l0:
  s_cmp_eq_u32 s69, 1
  s_cbranch_scc1 AT_v0
  s_cmp_ge_u32 s74, 62
  s_cbranch_scc1 AT_k0
  s_branch AT_c0
AT_h0:
  s_sleep 2
AT_c0:
  buffer_load_dword v172, off, s[8:11], s70 sc1
  s_add_u32 s65, s65, 1
  s_cmp_lt_u32 s65, 131072
  s_cselect_b32 s54, -2, -1
  s_waitcnt vmcnt(0)
  v_cmp_lt_u32 vcc, s54, v172
  s_cbranch_vccnz AT_h0
AT_k0:
  buffer_load_dwordx4 v[172:175], v201, s[8:11], s73 offen sc1
AT_v0:
  s_mov_b32 s69, 0
  s_add_u32 s65, s65, 1
  s_cmp_lt_u32 s65, 131072
  s_cselect_b32 s54, -2, -1
  s_waitcnt vmcnt(0)
  ds_write_b64 v220, v[172:173] offset:0
  ds_write_b64 v221, v[174:175] offset:0
  v_max3_u32 v213, v172, v173, v174
  v_max_u32 v213, v213, v175
  v_cmp_lt_u32 vcc, s54, v213
  s_cbranch_vccnz AT_k0
  s_waitcnt lgkmcnt(0)
  s_barrier
  ds_read_b128 v[128:131], v218 offset:0
  ds_read_b128 v[132:135], v218 offset:256
  ds_read_b128 v[136:139], v218 offset:512
  ds_read_b128 v[140:143], v218 offset:768
  ds_read_b128 v[144:147], v218 offset:1024
  ds_read_b128 v[148:151], v218 offset:1280
  ds_read_b128 v[152:155], v218 offset:1536
  ds_read_b128 v[156:159], v218 offset:1792
  ds_read_b32 v168, v219 offset:0
  ds_read_b32 v169, v219 offset:128
  s_waitcnt lgkmcnt(9)
  v_mfma_f32_32x32x16_bf16 v[80:95], v[128:131], v[96:99], 0
  s_waitcnt lgkmcnt(8)
  v_mfma_f32_32x32x16_bf16 v[80:95], v[132:135], v[100:103], v[80:95]
  s_waitcnt lgkmcnt(7)
  v_mfma_f32_32x32x16_bf16 v[80:95], v[136:139], v[104:107], v[80:95]
  s_waitcnt lgkmcnt(6)
  v_mfma_f32_32x32x16_bf16 v[80:95], v[140:143], v[108:111], v[80:95]
  s_waitcnt lgkmcnt(5)
  v_mfma_f32_32x32x16_bf16 v[80:95], v[144:147], v[112:115], v[80:95]
  s_waitcnt lgkmcnt(4)
  v_mfma_f32_32x32x16_bf16 v[80:95], v[148:151], v[116:119], v[80:95]
  s_waitcnt lgkmcnt(3)
  v_mfma_f32_32x32x16_bf16 v[80:95], v[152:155], v[120:123], v[80:95]
  s_waitcnt lgkmcnt(2)
  v_mfma_f32_32x32x16_bf16 v[80:95], v[156:159], v[124:127], v[80:95]
  s_add_u32 s74, s74, 2
  v_mov_b32 v212, s74
  s_nop 9
  v_mul_f32 v80, s68, v80
  v_mul_f32 v81, s68, v81
  v_mul_f32 v82, s68, v82
  v_mul_f32 v83, s68, v83
  v_max3_f32 v84, v180, v80, v81
  v_max3_f32 v84, v84, v82, v83
  v_mov_b32 v85, v84
  s_nop 1
  v_permlane32_swap_b32 v84, v85
  v_max_f32 v84, v84, v85
  v_sub_f32 v86, v180, v84
  v_sub_f32 v80, v80, v84
  v_sub_f32 v81, v81, v84
  v_sub_f32 v82, v82, v84
  v_sub_f32 v83, v83, v84
  v_exp_f32 v86, v86
  v_exp_f32 v80, v80
  v_exp_f32 v81, v81
  v_exp_f32 v82, v82
  v_exp_f32 v83, v83
  v_fma_f32 v182, v182, v86, v80
  v_add_f32 v84, v81, v82
  v_add_f32 v182, v182, v83
  v_add_f32 v182, v182, v84
  v_mov_b32 v183, v182
  s_nop 1
  v_permlane32_swap_b32 v182, v183
  v_add_f32 v182, v182, v183
  v_rcp_f32 v182, v182
  s_nop 0
  v_mul_f32 v86, v86, v182
  v_mul_f32 v80, v182, v80
  v_mul_f32 v81, v182, v81
  v_mul_f32 v82, v182, v82
  v_mul_f32 v83, v182, v83
  v_cvt_pk_bf16_f32 v28, v80, v81
  v_cvt_pk_bf16_f32 v29, v82, v83
  v_mul_f32 v0, v86, v0
  v_mul_f32 v1, v86, v1
  v_mul_f32 v2, v86, v2
  v_mul_f32 v3, v86, v3
  v_mul_f32 v4, v86, v4
  v_mul_f32 v5, v86, v5
  v_mul_f32 v6, v86, v6
  v_mul_f32 v7, v86, v7
  v_mul_f32 v8, v86, v8
  v_mul_f32 v9, v86, v9
  v_mul_f32 v10, v86, v10
  v_mul_f32 v11, v86, v11
  v_mul_f32 v12, v86, v12
  v_mul_f32 v13, v86, v13
  v_mul_f32 v14, v86, v14
  v_mul_f32 v15, v86, v15
  s_waitcnt lgkmcnt(0)
  s_nop 0
  v_mfma_f32_32x32x8_bf16 v[0:15], v[168:169], v[28:29], v[0:15]
  s_nop 11
  v_cvt_pk_bf16_f32 v20, v0, v1
  v_cvt_pk_bf16_f32 v21, v2, v3
  v_cvt_pk_bf16_f32 v22, v4, v5
  v_cvt_pk_bf16_f32 v23, v6, v7
  buffer_store_dwordx4 v[20:23], v201, s[8:11], s72 offen offset:0 sc1
  v_cvt_pk_bf16_f32 v24, v8, v9
  v_cvt_pk_bf16_f32 v25, v10, v11
  v_cvt_pk_bf16_f32 v26, v12, v13
  v_cvt_pk_bf16_f32 v27, v14, v15
  buffer_store_dwordx4 v[24:27], v201, s[8:11], s72 offen offset:1024 sc1
  s_mov_b64 exec, 1
  buffer_store_dword v212, v201, s[8:11], s71 offen sc1
  s_mov_b64 exec, -1
  s_cmp_ge_u32 s74, 64
  s_cbranch_scc1 L_exit
  s_cmp_ge_u32 s59, 64
  s_cbranch_scc1 AT_l1
  s_mov_b32 s74, s59
  s_mul_i32 s66, s59, 655360
  s_lshl_b32 s55, s58, 14
  s_add_u32 s55, s55, s66
  s_add_u32 s55, s55, 1048576
  s_lshl_b32 s73, s58, 2
  s_add_u32 s73, s73, s52
  s_lshl_b32 s72, s59, 7
  s_add_u32 s72, s72, s73
  s_lshl_b32 s72, s72, 11
  s_add_u32 s72, s72, 46137344
  s_lshl_b32 s73, s73, 10
  s_add_u32 s73, s73, s66
  s_add_u32 s73, s73, 1572864
  s_add_u32 s59, s59, 2
  buffer_load_dwordx4 v[128:131], v216, s[8:11], s55 offen offset:0 sc1
  buffer_load_dwordx4 v[132:135], v216, s[8:11], s55 offen offset:256 sc1
  buffer_load_dwordx4 v[136:139], v216, s[8:11], s55 offen offset:512 sc1
  buffer_load_dwordx4 v[140:143], v216, s[8:11], s55 offen offset:768 sc1
  buffer_load_dwordx4 v[144:147], v216, s[8:11], s55 offen offset:1024 sc1
  buffer_load_dwordx4 v[148:151], v216, s[8:11], s55 offen offset:1280 sc1
  buffer_load_dwordx4 v[152:155], v216, s[8:11], s55 offen offset:1536 sc1
  buffer_load_dwordx4 v[156:159], v216, s[8:11], s55 offen offset:1792 sc1
  buffer_load_dwordx4 v[160:163], v217, s[8:11], s55 offen offset:0 sc1
  buffer_load_dwordx4 v[164:167], v217, s[8:11], s55 offen offset:256 sc1
  s_or_b32 s70, s76, 0xc00
  buffer_load_dword v172, off, s[8:11], s70 sc1
  s_add_u32 s60, s60, 73728
  ds_read_b128 v[32:35], v203 offset:0
  ds_read_b128 v[36:39], v204 offset:0
  ds_read_b128 v[40:43], v205 offset:0
  s_waitcnt lgkmcnt(2)
  v_mfma_f32_32x32x16_bf16 v[240:255], a[0:3], v[32:35], 0
  ds_read_b128 v[44:47], v206 offset:0
  s_add_u32 m0, s67, 36864
  s_nop 0
  buffer_load_dwordx4 v202, s[4:7], s60 offen offset:0 lds
  s_waitcnt lgkmcnt(2)
  v_mfma_f32_32x32x16_bf16 v[240:255], a[4:7], v[36:39], v[240:255]
  ds_read_b128 v[32:35], v203 offset:1024
  s_waitcnt lgkmcnt(2)
  v_mfma_f32_32x32x16_bf16 v[240:255], a[8:11], v[40:43], v[240:255]
  ds_read_b128 v[36:39], v204 offset:1024
  s_add_u32 m0, s67, 37760
  s_nop 0
  buffer_load_dwordx4 v202, s[4:7], s60 offen offset:128 lds
  s_waitcnt lgkmcnt(2)
  v_mfma_f32_32x32x16_bf16 v[240:255], a[12:15], v[44:47], v[240:255]
  ds_read_b128 v[40:43], v205 offset:1024
  s_waitcnt lgkmcnt(2)
  v_mfma_f32_32x32x16_bf16 v[240:255], a[16:19], v[32:35], v[240:255]
  ds_read_b128 v[44:47], v206 offset:1024
  s_add_u32 m0, s67, 38656
  s_nop 0
  buffer_load_dwordx4 v202, s[4:7], s60 offen offset:256 lds
  s_waitcnt lgkmcnt(2)
  v_mfma_f32_32x32x16_bf16 v[240:255], a[20:23], v[36:39], v[240:255]
  ds_read_b128 v[32:35], v203 offset:2048
  s_waitcnt lgkmcnt(2)
  v_mfma_f32_32x32x16_bf16 v[240:255], a[24:27], v[40:43], v[240:255]
  ds_read_b128 v[36:39], v204 offset:2048
  s_add_u32 m0, s67, 39552
  s_nop 0
  buffer_load_dwordx4 v202, s[4:7], s60 offen offset:384 lds
  s_waitcnt lgkmcnt(2)
  v_mfma_f32_32x32x16_bf16 v[240:255], a[28:31], v[44:47], v[240:255]
  ds_read_b128 v[40:43], v205 offset:2048
  s_waitcnt lgkmcnt(2)
  v_mfma_f32_32x32x16_bf16 v[240:255], a[32:35], v[32:35], v[240:255]
  ds_read_b128 v[44:47], v206 offset:2048
  s_add_u32 m0, s67, 40448
  s_nop 0
  buffer_load_dwordx4 v202, s[4:7], s60 offen offset:512 lds
  s_waitcnt lgkmcnt(2)
  v_mfma_f32_32x32x16_bf16 v[240:255], a[36:39], v[36:39], v[240:255]
  ds_read_b128 v[32:35], v203 offset:3072
  s_waitcnt lgkmcnt(2)
  v_mfma_f32_32x32x16_bf16 v[240:255], a[40:43], v[40:43], v[240:255]
  ds_read_b128 v[36:39], v204 offset:3072
  s_add_u32 m0, s67, 41344
  s_nop 0
  buffer_load_dwordx4 v202, s[4:7], s60 offen offset:640 lds
  s_waitcnt lgkmcnt(2)
  v_mfma_f32_32x32x16_bf16 v[240:255], a[44:47], v[44:47], v[240:255]
  ds_read_b128 v[40:43], v205 offset:3072
  s_waitcnt lgkmcnt(2)
  v_mfma_f32_32x32x16_bf16 v[240:255], a[48:51], v[32:35], v[240:255]
  ds_read_b128 v[44:47], v206 offset:3072
  s_add_u32 m0, s67, 42240
  s_nop 0
  buffer_load_dwordx4 v202, s[4:7], s60 offen offset:768 lds
  s_waitcnt lgkmcnt(2)
  v_mfma_f32_32x32x16_bf16 v[240:255], a[52:55], v[36:39], v[240:255]
  ds_read_b128 v[32:35], v203 offset:4096
  s_waitcnt lgkmcnt(2)
  v_mfma_f32_32x32x16_bf16 v[240:255], a[56:59], v[40:43], v[240:255]
  ds_read_b128 v[36:39], v204 offset:4096
  s_add_u32 m0, s67, 43136
  s_nop 0
  buffer_load_dwordx4 v202, s[4:7], s60 offen offset:896 lds
  s_waitcnt lgkmcnt(2)
  v_mfma_f32_32x32x16_bf16 v[240:255], a[60:63], v[44:47], v[240:255]
  ds_read_b128 v[40:43], v205 offset:4096
  s_waitcnt lgkmcnt(2)
  v_mfma_f32_32x32x16_bf16 v[240:255], a[64:67], v[32:35], v[240:255]
  ds_read_b128 v[44:47], v206 offset:4096
  s_add_u32 m0, s67, 44032
  s_nop 0
  buffer_load_dwordx4 v202, s[4:7], s60 offen offset:1024 lds
  s_waitcnt lgkmcnt(2)
  v_mfma_f32_32x32x16_bf16 v[240:255], a[68:71], v[36:39], v[240:255]
  ds_read_b128 v[32:35], v203 offset:5120
  s_waitcnt lgkmcnt(2)
  v_mfma_f32_32x32x16_bf16 v[240:255], a[72:75], v[40:43], v[240:255]
  ds_read_b128 v[36:39], v204 offset:5120
  buffer_store_dwordx4 v[176:179], v201, s[8:11], s72 offen offset:0 sc1
  s_waitcnt lgkmcnt(2)
  v_mfma_f32_32x32x16_bf16 v[240:255], a[76:79], v[44:47], v[240:255]
  ds_read_b128 v[40:43], v205 offset:5120
  s_waitcnt lgkmcnt(2)
  v_mfma_f32_32x32x16_bf16 v[240:255], a[80:83], v[32:35], v[240:255]
  ds_read_b128 v[44:47], v206 offset:5120
  buffer_store_dwordx4 v[176:179], v201, s[8:11], s72 offen offset:1024 sc1
  s_waitcnt lgkmcnt(2)
  v_mfma_f32_32x32x16_bf16 v[240:255], a[84:87], v[36:39], v[240:255]
  ds_read_b128 v[32:35], v203 offset:6144
  s_waitcnt lgkmcnt(2)
  v_mfma_f32_32x32x16_bf16 v[240:255], a[88:91], v[40:43], v[240:255]
  ds_read_b128 v[36:39], v204 offset:6144
  s_waitcnt lgkmcnt(2)
  v_mfma_f32_32x32x16_bf16 v[240:255], a[92:95], v[44:47], v[240:255]
  ds_read_b128 v[40:43], v205 offset:6144
  s_waitcnt lgkmcnt(2)
  v_mfma_f32_32x32x16_bf16 v[240:255], a[96:99], v[32:35], v[240:255]
  ds_read_b128 v[44:47], v206 offset:6144
  s_waitcnt lgkmcnt(2)
  v_mfma_f32_32x32x16_bf16 v[240:255], a[100:103], v[36:39], v[240:255]
  ds_read_b128 v[32:35], v203 offset:7168
  s_waitcnt lgkmcnt(2)
  v_mfma_f32_32x32x16_bf16 v[240:255], a[104:107], v[40:43], v[240:255]
  ds_read_b128 v[36:39], v204 offset:7168
  s_waitcnt lgkmcnt(2)
  v_mfma_f32_32x32x16_bf16 v[240:255], a[108:111], v[44:47], v[240:255]
  ds_read_b128 v[40:43], v205 offset:7168
  s_waitcnt lgkmcnt(2)
  v_mfma_f32_32x32x16_bf16 v[240:255], a[112:115], v[32:35], v[240:255]
  ds_read_b128 v[44:47], v206 offset:7168
  s_waitcnt lgkmcnt(2)
  v_mfma_f32_32x32x16_bf16 v[240:255], a[116:119], v[36:39], v[240:255]
  ds_read_b128 v[32:35], v203 offset:8192
  s_waitcnt lgkmcnt(2)
  v_mfma_f32_32x32x16_bf16 v[240:255], a[120:123], v[40:43], v[240:255]
  ds_read_b128 v[36:39], v204 offset:8192
  s_waitcnt lgkmcnt(2)
  v_mfma_f32_32x32x16_bf16 v[240:255], a[124:127], v[44:47], v[240:255]
  ds_read_b128 v[40:43], v205 offset:8192
  s_waitcnt lgkmcnt(2)
  v_mfma_f32_32x32x16_bf16 v[240:255], a[128:131], v[32:35], v[240:255]
  ds_read_b128 v[44:47], v206 offset:8192
  s_waitcnt lgkmcnt(2)
  v_mfma_f32_32x32x16_bf16 v[240:255], a[132:135], v[36:39], v[240:255]
  s_waitcnt lgkmcnt(1)
  v_mfma_f32_32x32x16_bf16 v[240:255], a[136:139], v[40:43], v[240:255]
  s_waitcnt lgkmcnt(0)
  v_mfma_f32_32x32x16_bf16 v[240:255], a[140:143], v[44:47], v[240:255]
  s_nop 11
  v_cvt_pk_bf16_f32 v16, v240, v244
  v_cvt_pk_bf16_f32 v17, v241, v245
  v_cvt_pk_bf16_f32 v18, v242, v246
  v_cvt_pk_bf16_f32 v19, v243, v247
  ds_write_b128 v215, v[16:19] offset:0
  v_cvt_pk_bf16_f32 v20, v248, v252
  v_cvt_pk_bf16_f32 v21, v249, v253
  v_cvt_pk_bf16_f32 v22, v250, v254
  v_cvt_pk_bf16_f32 v23, v251, v255
  ds_write_b128 v215, v[20:23] offset:1024
  s_waitcnt lgkmcnt(0)
  s_barrier
  ds_read_b128 v[96:99], v208 offset:0
  ds_read_b128 v[100:103], v208 offset:1024
  ds_read_b128 v[104:107], v208 offset:2048
  ds_read_b128 v[108:111], v208 offset:3072
  ds_read_b128 v[112:115], v208 offset:4096
  ds_read_b128 v[116:119], v208 offset:5120
  ds_read_b128 v[120:123], v208 offset:6144
  ds_read_b128 v[124:127], v208 offset:7168
  s_waitcnt vmcnt(11)
  v_cmp_eq_u32 vcc, -1, v172
  s_mov_b32 s69, 0
  s_cbranch_vccnz AT_e0
  s_mov_b32 s69, 1
  buffer_load_dwordx4 v[172:175], v201, s[8:11], s76 offen sc1
AT_e0:
  s_waitcnt lgkmcnt(7)
  v_mfma_f32_32x32x16_bf16 v[64:79], v[128:131], v[96:99], v[48:63]
  s_waitcnt lgkmcnt(6)
  v_mfma_f32_32x32x16_bf16 v[64:79], v[132:135], v[100:103], v[64:79]
  s_waitcnt lgkmcnt(5)
  v_mfma_f32_32x32x16_bf16 v[64:79], v[136:139], v[104:107], v[64:79]
  s_waitcnt lgkmcnt(4)
  v_mfma_f32_32x32x16_bf16 v[64:79], v[140:143], v[108:111], v[64:79]
  s_waitcnt lgkmcnt(3)
  v_mfma_f32_32x32x16_bf16 v[64:79], v[144:147], v[112:115], v[64:79]
  s_waitcnt lgkmcnt(2)
  v_mfma_f32_32x32x16_bf16 v[64:79], v[148:151], v[116:119], v[64:79]
  s_waitcnt lgkmcnt(1)
  v_mfma_f32_32x32x16_bf16 v[64:79], v[152:155], v[120:123], v[64:79]
  s_waitcnt lgkmcnt(0)
  v_mfma_f32_32x32x16_bf16 v[64:79], v[156:159], v[124:127], v[64:79]
  s_nop 11
  v_max3_f32 v180, v64, v65, v66
  v_max3_f32 v180, v180, v67, v68
  v_max3_f32 v180, v180, v69, v70
  v_max3_f32 v180, v180, v71, v72
  v_max3_f32 v180, v180, v73, v74
  v_max3_f32 v180, v180, v75, v76
  v_max3_f32 v180, v180, v77, v78
  v_max_f32 v180, v180, v79
  v_mov_b32 v181, v180
  s_nop 1
  v_permlane32_swap_b32 v180, v181
  v_max_f32 v180, v180, v181
  v_sub_f32 v64, v64, v180
  v_sub_f32 v65, v65, v180
  v_sub_f32 v66, v66, v180
  v_sub_f32 v67, v67, v180
  v_sub_f32 v68, v68, v180
  v_sub_f32 v69, v69, v180
  v_sub_f32 v70, v70, v180
  v_sub_f32 v71, v71, v180
  v_sub_f32 v72, v72, v180
  v_sub_f32 v73, v73, v180
  v_sub_f32 v74, v74, v180
  v_sub_f32 v75, v75, v180
  v_sub_f32 v76, v76, v180
  v_sub_f32 v77, v77, v180
  v_sub_f32 v78, v78, v180
  v_sub_f32 v79, v79, v180
  v_exp_f32 v64, v64
  v_exp_f32 v65, v65
  v_exp_f32 v66, v66
  v_exp_f32 v67, v67
  v_exp_f32 v68, v68
  v_exp_f32 v69, v69
  v_exp_f32 v70, v70
  v_exp_f32 v71, v71
  v_exp_f32 v72, v72
  v_exp_f32 v73, v73
  v_exp_f32 v74, v74
  v_exp_f32 v75, v75
  v_exp_f32 v76, v76
  v_exp_f32 v77, v77
  v_exp_f32 v78, v78
  v_exp_f32 v79, v79
  v_cvt_pk_bf16_f32 v20, v64, v65
  v_cvt_pk_bf16_f32 v21, v68, v69
  v_cvt_pk_bf16_f32 v22, v72, v73
  v_cvt_pk_bf16_f32 v23, v76, v77
  v_cvt_pk_bf16_f32 v24, v66, v67
  v_cvt_pk_bf16_f32 v25, v70, v71
  v_cvt_pk_bf16_f32 v26, v74, v75
  v_cvt_pk_bf16_f32 v27, v78, v79
  v_mfma_f32_32x32x16_bf16 v[0:15], v[160:163], v[20:23], 0
  v_add_f32 v182, v64, v65
  v_add_f32 v182, v182, v66
  v_add_f32 v182, v182, v67
  v_add_f32 v182, v182, v68
  v_add_f32 v182, v182, v69
  v_add_f32 v182, v182, v70
  v_add_f32 v182, v182, v71
  v_mfma_f32_32x32x16_bf16 v[0:15], v[164:167], v[24:27], v[0:15]
  v_add_f32 v182, v182, v72
  v_add_f32 v182, v182, v73
  v_add_f32 v182, v182, v74
  v_add_f32 v182, v182, v75
  v_add_f32 v182, v182, v76
  v_add_f32 v182, v182, v77
  v_add_f32 v182, v182, v78
  v_add_f32 v182, v182, v79
AT_l1:
  s_cmp_eq_u32 s69, 1
  s_cbranch_scc1 AT_v1
  s_cmp_ge_u32 s77, 62
  s_cbranch_scc1 AT_k1
  s_branch AT_c1
AT_h1:
  s_sleep 2
AT_c1:
  buffer_load_dword v172, off, s[8:11], s70 sc1
  s_add_u32 s65, s65, 1
  s_cmp_lt_u32 s65, 131072
  s_cselect_b32 s54, -2, -1
  s_waitcnt vmcnt(0)
  v_cmp_lt_u32 vcc, s54, v172
  s_cbranch_vccnz AT_h1
AT_k1:
  buffer_load_dwordx4 v[172:175], v201, s[8:11], s76 offen sc1
AT_v1:
  s_mov_b32 s69, 0
  s_add_u32 s65, s65, 1
  s_cmp_lt_u32 s65, 131072
  s_cselect_b32 s54, -2, -1
  s_waitcnt vmcnt(0)
  ds_write_b64 v220, v[172:173] offset:4096
  ds_write_b64 v221, v[174:175] offset:4096
  v_max3_u32 v213, v172, v173, v174
  v_max_u32 v213, v213, v175
  v_cmp_lt_u32 vcc, s54, v213
  s_cbranch_vccnz AT_k1
  s_waitcnt lgkmcnt(0)
  s_barrier
  ds_read_b128 v[128:131], v218 offset:4096
  ds_read_b128 v[132:135], v218 offset:4352
  ds_read_b128 v[136:139], v218 offset:4608
  ds_read_b128 v[140:143], v218 offset:4864
  ds_read_b128 v[144:147], v218 offset:5120
  ds_read_b128 v[148:151], v218 offset:5376
  ds_read_b128 v[152:155], v218 offset:5632
  ds_read_b128 v[156:159], v218 offset:5888
  ds_read_b32 v168, v219 offset:4096
  ds_read_b32 v169, v219 offset:4224
  s_waitcnt lgkmcnt(9)
  v_mfma_f32_32x32x16_bf16 v[80:95], v[128:131], a[144:147], 0
  s_waitcnt lgkmcnt(8)
  v_mfma_f32_32x32x16_bf16 v[80:95], v[132:135], a[148:151], v[80:95]
  s_waitcnt lgkmcnt(7)
  v_mfma_f32_32x32x16_bf16 v[80:95], v[136:139], a[152:155], v[80:95]
  s_waitcnt lgkmcnt(6)
  v_mfma_f32_32x32x16_bf16 v[80:95], v[140:143], a[156:159], v[80:95]
  s_waitcnt lgkmcnt(5)
  v_mfma_f32_32x32x16_bf16 v[80:95], v[144:147], a[160:163], v[80:95]
  s_waitcnt lgkmcnt(4)
  v_mfma_f32_32x32x16_bf16 v[80:95], v[148:151], a[164:167], v[80:95]
  s_waitcnt lgkmcnt(3)
  v_mfma_f32_32x32x16_bf16 v[80:95], v[152:155], a[168:171], v[80:95]
  s_waitcnt lgkmcnt(2)
  v_mfma_f32_32x32x16_bf16 v[80:95], v[156:159], a[172:175], v[80:95]
  s_add_u32 s77, s77, 2
  v_mov_b32 v212, s77
  s_nop 9
  v_mul_f32 v80, s68, v80
  v_mul_f32 v81, s68, v81
  v_mul_f32 v82, s68, v82
  v_mul_f32 v83, s68, v83
  v_max3_f32 v84, v184, v80, v81
  v_max3_f32 v84, v84, v82, v83
  v_mov_b32 v85, v84
  s_nop 1
  v_permlane32_swap_b32 v84, v85
  v_max_f32 v84, v84, v85
  v_sub_f32 v86, v184, v84
  v_sub_f32 v80, v80, v84
  v_sub_f32 v81, v81, v84
  v_sub_f32 v82, v82, v84
  v_sub_f32 v83, v83, v84
  v_exp_f32 v86, v86
  v_exp_f32 v80, v80
  v_exp_f32 v81, v81
  v_exp_f32 v82, v82
  v_exp_f32 v83, v83
  v_fma_f32 v186, v186, v86, v80
  v_add_f32 v84, v81, v82
  v_add_f32 v186, v186, v83
  v_add_f32 v186, v186, v84
  v_mov_b32 v187, v186
  s_nop 1
  v_permlane32_swap_b32 v186, v187
  v_add_f32 v186, v186, v187
  v_rcp_f32 v186, v186
  s_nop 0
  v_mul_f32 v86, v86, v186
  v_mul_f32 v80, v186, v80
  v_mul_f32 v81, v186, v81
  v_mul_f32 v82, v186, v82
  v_mul_f32 v83, v186, v83
  v_cvt_pk_bf16_f32 v28, v80, v81
  v_cvt_pk_bf16_f32 v29, v82, v83
  v_mul_f32 v224, v86, v224
  v_mul_f32 v225, v86, v225
  v_mul_f32 v226, v86, v226
  v_mul_f32 v227, v86, v227
  v_mul_f32 v228, v86, v228
  v_mul_f32 v229, v86, v229
  v_mul_f32 v230, v86, v230
  v_mul_f32 v231, v86, v231
  v_mul_f32 v232, v86, v232
  v_mul_f32 v233, v86, v233
  v_mul_f32 v234, v86, v234
  v_mul_f32 v235, v86, v235
  v_mul_f32 v236, v86, v236
  v_mul_f32 v237, v86, v237
  v_mul_f32 v238, v86, v238
  v_mul_f32 v239, v86, v239
  s_waitcnt lgkmcnt(0)
  s_nop 0
  v_mfma_f32_32x32x8_bf16 v[224:239], v[168:169], v[28:29], v[224:239]
  s_nop 11
  v_cvt_pk_bf16_f32 v20, v224, v225
  v_cvt_pk_bf16_f32 v21, v226, v227
  v_cvt_pk_bf16_f32 v22, v228, v229
  v_cvt_pk_bf16_f32 v23, v230, v231
  buffer_store_dwordx4 v[20:23], v201, s[8:11], s75 offen offset:0 sc1
  v_cvt_pk_bf16_f32 v24, v232, v233
  v_cvt_pk_bf16_f32 v25, v234, v235
  v_cvt_pk_bf16_f32 v26, v236, v237
  v_cvt_pk_bf16_f32 v27, v238, v239
  buffer_store_dwordx4 v[24:27], v201, s[8:11], s75 offen offset:1024 sc1
  s_mov_b64 exec, 1
  buffer_store_dword v212, v201, s[8:11], s71 offen sc1
  s_mov_b64 exec, -1
  s_cmp_ge_u32 s77, 64
  s_cbranch_scc1 L_exit
  s_branch AT_loop
L_cexit:
L_exit:
L_end:
s_endpgm
.section .rodata,"a"
.p2align 6
.amdhsa_kernel gated_mix__sliding_local_dilated__memory_aug_recurrent_mem_tr__prompt_kernel
  .amdhsa_next_free_vgpr 512
  .amdhsa_next_free_sgpr 102
  .amdhsa_accum_offset 256
  .amdhsa_group_segment_fixed_size 0
  .amdhsa_kernarg_size 112
  .amdhsa_user_sgpr_count 2
  .amdhsa_user_sgpr_kernarg_segment_ptr 1
  .amdhsa_system_sgpr_workgroup_id_x 1
.end_amdhsa_kernel
```

```asm
; @launch grid=(256,1,1) block=(256,1,1) lds=163840
.amdgcn_target "amdgcn-amd-amdhsa--gfx950"
.text
.globl gated_mix__sliding_local_dilated__memory_aug_recurrent_mem_tr__prompt_kernel
.p2align 8
.type gated_mix__sliding_local_dilated__memory_aug_recurrent_mem_tr__prompt_kernel,@function
gated_mix__sliding_local_dilated__memory_aug_recurrent_mem_tr__prompt_kernel:
  s_cmp_ge_u32 s2, 256
  s_cbranch_scc1 L_end
  s_load_dwordx2 s[4:5], s[0:1], 0
  s_load_dwordx2 s[8:9], s[0:1], 104
  s_load_dwordx2 s[12:13], s[0:1], 96
  s_load_dwordx2 s[16:17], s[0:1], 40
  s_load_dwordx2 s[20:21], s[0:1], 48
  s_load_dwordx2 s[24:25], s[0:1], 56
  s_load_dwordx2 s[28:29], s[0:1], 64
  s_load_dwordx2 s[32:33], s[0:1], 32
  s_load_dwordx2 s[36:37], s[0:1], 8
  s_load_dwordx2 s[40:41], s[0:1], 16
  s_load_dwordx2 s[44:45], s[0:1], 80
  s_load_dwordx2 s[48:49], s[0:1], 88
  s_getreg_b32 s54, hwreg(HW_REG_XCC_ID, 0, 3)
  v_lshrrev_b32 v1, 6, v0
  s_nop 0
  v_readfirstlane_b32 s52, v1
  s_mov_b32 s6, 2359296
  s_mov_b32 s7, 0x20000
  s_mov_b32 s10, 268435456
  s_mov_b32 s11, 0x20000
  s_mov_b32 s14, 256
  s_mov_b32 s15, 0x20000
  s_mov_b32 s18, 4718592
  s_mov_b32 s19, 0x20000
  s_mov_b32 s22, 4718592
  s_mov_b32 s23, 0x20000
  s_mov_b32 s26, 4718592
  s_mov_b32 s27, 0x20000
  s_mov_b32 s30, 4718592
  s_mov_b32 s31, 0x20000
  s_mov_b32 s34, 9216
  s_mov_b32 s35, 0x20000
  s_mov_b32 s38, 1990656
  s_mov_b32 s39, 0x20000
  s_mov_b32 s42, 663552
  s_mov_b32 s43, 0x20000
  s_mov_b32 s46, 1152
  s_mov_b32 s47, 0x20000
  s_mov_b32 s50, 2359296
  s_mov_b32 s51, 0x20000
  s_waitcnt lgkmcnt(0)
  s_lshr_b32 s0, s2, 3
  s_mov_b32 s2, s54
  s_mov_b32 s1, 0
L_role:
  s_mov_b32 s53, s0
  s_cmp_eq_u32 s2, 0
  s_cbranch_scc0 L_worker
  v_and_b32 v0, 63, v0
  v_and_b32 v1, 15, v0
  v_lshrrev_b32 v2, 4, v0
  v_and_b32 v3, 1, v2
  s_lshl_b32 s54, s52, 1
  v_add_u32 v3, s54, v3
  v_lshlrev_b32 v3, 1, v3
  v_xor_b32 v3, v3, v1
  v_lshlrev_b32 v3, 4, v3
  v_lshl_add_u32 v8, v2, 13, v3
  s_lshl_b32 s78, s53, 8
  s_lshl_b32 s54, s52, 15
  s_add_u32 s78, s78, s54
  s_mul_i32 s79, s53, 147456
  s_lshl_b32 s57, s52, 10
  s_add_u32 s57, s57, 16384
  s_getpc_b64 s[80:81]
L_pc_1:
  s_and_b32 s55, s0, 1
  s_lshl_b32 s55, s55, 2
  s_add_u32 s55, s55, s52
  s_lshl_b32 s55, s55, 10
  v_and_b32 v199, 63, v0
  v_lshl_add_u32 v199, v199, 4, s55
  v_min_u32 v199, (L_w0 - L_pc_1), v199
  global_load_dword v196, v199, s[80:81]
  s_add_u32 m0, s57, 0
  s_add_u32 s54, s78, 0
  buffer_load_dwordx4 v8, s[16:19], s54 offen  lds
  s_add_u32 m0, s57, 4096
  s_add_u32 s54, s78, 131072
  buffer_load_dwordx4 v8, s[16:19], s54 offen  lds
  s_add_u32 m0, s57, 8192
  s_add_u32 s54, s78, 262144
  buffer_load_dwordx4 v8, s[16:19], s54 offen  lds
  s_add_u32 m0, s57, 12288
  s_add_u32 s54, s78, 393216
  buffer_load_dwordx4 v8, s[16:19], s54 offen  lds
  s_add_u32 m0, s57, 16384
  s_add_u32 s54, s78, 524288
  buffer_load_dwordx4 v8, s[16:19], s54 offen  lds
  s_add_u32 m0, s57, 20480
  s_add_u32 s54, s78, 655360
  buffer_load_dwordx4 v8, s[16:19], s54 offen  lds
  s_add_u32 m0, s57, 24576
  s_add_u32 s54, s78, 786432
  buffer_load_dwordx4 v8, s[16:19], s54 offen  lds
  s_add_u32 m0, s57, 28672
  s_add_u32 s54, s78, 917504
  buffer_load_dwordx4 v8, s[16:19], s54 offen  lds
  s_add_u32 m0, s57, 32768
  s_add_u32 s54, s78, 1048576
  buffer_load_dwordx4 v8, s[16:19], s54 offen  lds
  s_add_u32 m0, s57, 36864
  s_add_u32 s54, s78, 1179648
  buffer_load_dwordx4 v8, s[16:19], s54 offen  lds
  s_add_u32 m0, s57, 40960
  s_add_u32 s54, s78, 1310720
  buffer_load_dwordx4 v8, s[16:19], s54 offen  lds
  s_add_u32 m0, s57, 45056
  s_add_u32 s54, s78, 1441792
  buffer_load_dwordx4 v8, s[16:19], s54 offen  lds
  s_add_u32 m0, s57, 49152
  s_add_u32 s54, s78, 1572864
  buffer_load_dwordx4 v8, s[16:19], s54 offen  lds
  s_add_u32 m0, s57, 53248
  s_add_u32 s54, s78, 1703936
  buffer_load_dwordx4 v8, s[16:19], s54 offen  lds
  s_add_u32 m0, s57, 57344
  s_add_u32 s54, s78, 1835008
  buffer_load_dwordx4 v8, s[16:19], s54 offen  lds
  s_add_u32 m0, s57, 61440
  s_add_u32 s54, s78, 1966080
  buffer_load_dwordx4 v8, s[16:19], s54 offen  lds
  v_lshlrev_b32 v76, 4, v0
  v_add_u32 v75, 0x10000, v76
  v_lshrrev_b32 v3, 2, v1
  v_and_b32 v4, 1, v1
  v_lshl_add_u32 v3, v3, 1, v4
  v_bfe_u32 v4, v1, 1, 1
  v_mul_u32_u24 v74, 0xaaaa, v4
  v_add_u32 v74, 0x4444, v74
  v_mul_u32_u24 v5, 576, v3
  v_add_u32 v5, 0, v5
  v_lshl_add_u32 v78, v2, 4, v5
  v_lshl_add_u32 v77, v2, 5, v5
  v_lshl_add_u32 v77, v4, 4, v77
  v_mul_u32_u24 v15, 1152, v3
  v_lshl_add_u32 v15, v2, 5, v15
  v_lshl_add_u32 v15, v4, 4, v15
  s_lshl_b32 s54, s52, 8
  buffer_load_dwordx4 v[20:23], v15, s[32:35], s54 offen
  buffer_load_dwordx4 v[24:27], v15, s[32:35], s54 offen offset:128
  buffer_load_dwordx4 v[28:31], v15, s[32:35], 0 offen offset:1024
  v_mul_u32_u24 v79, 1152, v2
  v_lshl_add_u32 v79, v1, 2, v79
  s_lshl_b32 s54, s52, 6
  s_add_u32 s54, s54, 0
  v_add_u32 v79, s54, v79
  v_lshrrev_b32 v5, 3, v0
  v_mul_u32_u24 v68, 2176, v5
  v_and_b32 v5, 7, v0
  v_lshl_add_u32 v68, v5, 3, v68
  v_lshrrev_b32 v6, 3, v0
  s_lshr_b32 s54, s53, 2
  v_add_u32 v68, s54, v6
  v_and_b32 v68, 7, v68
  v_xor_b32 v68, v68, v6
  v_lshlrev_b32 v68, 8, v68
  v_lshl_add_u32 v68, v6, 12, v68
  v_lshl_add_u32 v68, v5, 3, v68
  s_and_b32 s54, s53, 3
  s_lshl_b32 s54, s54, 6
  v_add_u32 v68, s54, v68
  v_and_b32 v5, 1, v2
  v_lshlrev_b32 v5, 4, v5
  v_lshl_add_u32 v5, v1, 2, v5
  v_mov_b32 v6, 0x40000000
  v_cmp_lt_u32 vcc, 3, v1
  s_nop 1
  v_cndmask_b32 v5, v5, v6, vcc
  v_lshrrev_b32 v6, 1, v2
  v_lshl_add_u32 v69, v6, 10, v5
  v_lshl_add_u32 v70, v6, 8, v5
  v_mov_b32 v71, -1
  ds_write_b128 v76, v[68:71] offset:13824
  v_and_b32 v5, 3, v1
  v_lshrrev_b32 v6, 2, v1
  v_lshl_add_u32 v5, v5, 2, v6
  v_and_b32 v6, 1, v5
  v_lshlrev_b32 v6, 4, v6
  v_mov_b32 v7, 0x3f80
  v_lshlrev_b32 v6, v6, v7
  v_lshrrev_b32 v5, 1, v5
  v_cmp_eq_u32 vcc, 0, v5
  s_nop 1
  v_cndmask_b32 v40, 0, v6, vcc
  v_cmp_eq_u32 vcc, 1, v5
  s_nop 1
  v_cndmask_b32 v41, 0, v6, vcc
  v_cmp_eq_u32 vcc, 2, v5
  s_nop 1
  v_cndmask_b32 v42, 0, v6, vcc
  v_cmp_eq_u32 vcc, 3, v5
  s_nop 1
  v_cndmask_b32 v43, 0, v6, vcc
  ds_write_b128 v76, v[40:43] offset:14848
  s_and_b32 s54, s52, 1
  s_lshr_b32 s55, s52, 1
  v_lshrrev_b32 v3, 3, v0
  v_and_b32 v4, 1, v3
  v_lshlrev_b32 v4, 4, v4
  v_and_b32 v5, 6, v3
  v_add_u32 v4, v4, v5
  s_lshl_b32 s56, s55, 3
  s_add_u32 s56, s56, s54
  v_add_u32 v4, s56, v4
  v_mul_u32_u24 v4, 1152, v4
  v_and_b32 v5, 2, v3
  v_lshlrev_b32 v5, 1, v5
  v_and_b32 v6, 7, v0
  v_xor_b32 v6, v6, v5
  v_lshl_add_u32 v9, v6, 4, v4
  v_and_b32 v4, 1, v2
  v_lshlrev_b32 v4, 4, v4
  v_and_b32 v5, 2, v2
  v_add_u32 v4, v4, v5
  s_lshl_b32 s56, s55, 2
  s_add_u32 s56, s56, s54
  v_add_u32 v4, s56, v4
  v_mul_u32_u24 v4, 1152, v4
  v_lshlrev_b32 v6, 1, v2
  v_xor_b32 v6, v6, v1
  v_lshl_add_u32 v10, v6, 4, v4
  v_bfe_u32 v17, v1, 2, 1
  v_bfe_u32 v18, v1, 3, 1
  v_and_b32 v19, 1, v2
  v_lshrrev_b32 v72, 1, v2
  v_and_b32 v73, 3, v1
  v_lshl_add_u32 v3, v19, 1, v17
  v_lshl_add_u32 v6, v18, 2, v3
  v_lshl_add_u32 v4, v72, 4, v17
  v_lshl_add_u32 v4, v19, 2, v4
  v_lshl_add_u32 v4, v18, 3, v4
  v_lshlrev_b32 v4, 8, v4
  s_lshl_b32 s54, s52, 6
  v_lshl_add_u32 v5, v73, 3, s54
  v_lshlrev_b32 v7, 5, v6
  v_xor_b32 v5, v5, v7
  v_add_u32 v11, v4, v5
  v_xor_b32 v12, 32, v11
  v_lshl_add_u32 v4, v72, 2, v3
  v_lshlrev_b32 v4, 7, v4
  v_lshl_add_u32 v4, v73, 3, v4
  s_and_b32 s54, s52, 1
  v_xor_b32 v7, s54, v19
  v_lshl_add_u32 v7, v7, 1, v18
  v_lshl_add_u32 v13, v7, 5, v4
  v_lshlrev_b32 v4, 11, v72
  v_lshl_add_u32 v4, v73, 3, v4
  v_lshl_add_u32 v5, v3, 8, v4
  v_lshl_add_u32 v7, v18, 2, s52
  v_xor_b32 v7, v7, v3
  v_lshl_add_u32 v14, v7, 5, v5
  s_lshl_b32 s54, s53, 14
  s_lshl_b32 s55, s52, 11
  s_add_u32 s54, s54, 1048576
  s_add_u32 s58, s54, s55
  s_add_u32 s59, s58, 8192
  s_lshl_b32 s55, s52, 12
  s_add_u32 s70, s54, s55
  s_add_u32 s70, s70, 655360
  s_lshl_b32 s54, s53, 12
  s_lshl_b32 s55, s52, 10
  s_add_u32 s54, s54, s55
  s_add_u32 s68, s54, 917504
  s_lshl_b32 s54, s53, 6
  s_mul_i32 s55, s52, 17408
  s_add_u32 s55, s54, s55
  s_add_u32 s73, s55, 0
  s_add_u32 s74, s55, 69632
  s_add_u32 s75, s55, 139264
  s_add_u32 s76, s55, 208896
  s_and_b32 s56, s52, 1
  s_mul_i32 s55, s56, 17408
  s_add_u32 s55, s54, s55
  s_add_u32 s77, s55, 278528
  s_mul_i32 s54, s52, 69632
  s_mul_i32 s55, s53, 2176
  s_add_u32 s54, s54, s55
  s_add_u32 s60, s54, 0
  s_and_b32 s56, s53, 15
  s_mul_i32 s55, s56, 2176
  s_add_u32 s61, s55, 278528
  s_lshr_b32 s54, s52, 1
  s_lshl_b32 s54, s54, 15
  s_and_b32 s55, s52, 1
  s_lshl_b32 s55, s55, 11
  s_add_u32 s54, s54, s55
  s_add_u32 s73, s54, 0
  s_add_u32 s74, s54, 65536
  s_add_u32 s75, s54, 131072
  s_add_u32 s76, s54, 196608
  s_add_u32 s77, s55, 262144
  s_and_b32 s54, s53, 7
  s_lshl_b32 s54, s54, 12
  s_bfe_u32 s55, s53, 0x10003
  s_lshl_b32 s55, s55, 11
  s_add_u32 s54, s54, s55
  s_add_u32 s61, s54, 262144
  s_lshr_b32 s55, s53, 4
  s_lshl_b32 s55, s55, 15
  s_add_u32 s54, s54, s55
  s_lshl_b32 s55, s52, 16
  s_add_u32 s54, s54, s55
  s_add_u32 s60, s54, 0
  s_lshl_b32 s54, s52, 11
  s_add_u32 s64, s54, 360448
  s_mov_b32 s65, 368640
  s_lshl_b32 s55, s53, 5
  s_add_u32 s54, s54, s55
  s_add_u32 s62, s54, 376832
  s_lshr_b32 s54, s56, 3
  s_lshl_b32 s54, s54, 9
  s_and_b32 s55, s56, 7
  s_lshl_b32 s55, s55, 5
  s_add_u32 s54, s54, s55
  s_add_u32 s63, s54, 385024
  s_mov_b32 s66, 0
  s_mov_b32 s67, 0
  s_mov_b32 s72, 0
  s_mov_b32 s69, 1040356334
  s_waitcnt vmcnt(15) lgkmcnt(0)
  s_barrier
  s_add_u32 m0, s57, 65536
  s_add_u32 s54, s78, 2097152
  buffer_load_dwordx4 v8, s[16:19], s54 offen  lds
  s_add_u32 m0, s57, 69632
  s_add_u32 s54, s78, 2228224
  buffer_load_dwordx4 v8, s[16:19], s54 offen  lds
  s_add_u32 m0, s57, 73728
  s_add_u32 s54, s78, 2359296
  buffer_load_dwordx4 v8, s[16:19], s54 offen  lds
  s_add_u32 m0, s57, 77824
  s_add_u32 s54, s78, 2490368
  buffer_load_dwordx4 v8, s[16:19], s54 offen  lds
  s_lshl_b32 s55, s2, 2
  s_or_b32 s56, s52, s1
  s_cmp_eq_u32 s56, 0
  s_cselect_b32 s55, s55, 0x1000
  s_lshl_b32 s56, 1, s0
  v_mov_b32 v35, s56
  s_mov_b64 exec, 1
  buffer_atomic_or v35, off, s[12:15], s55 sc0
  s_mov_b64 exec, -1
  v_add_u32 v15, 16384, v11
  v_add_u32 v16, 16384, v12
  ds_read_b64_tr_b16 v[80:81], v15 offset:0
  ds_read_b64_tr_b16 v[82:83], v15 offset:512
  ds_read_b64_tr_b16 v[84:85], v15 offset:8192
  ds_read_b64_tr_b16 v[86:87], v15 offset:8704
  ds_read_b64_tr_b16 v[88:89], v16 offset:0
  ds_read_b64_tr_b16 v[90:91], v16 offset:512
  ds_read_b64_tr_b16 v[92:93], v16 offset:8192
  ds_read_b64_tr_b16 v[94:95], v16 offset:8704
  s_waitcnt vmcnt(16) lgkmcnt(0)
  s_barrier
  s_add_u32 m0, s57, 81920
  s_add_u32 s54, s78, 2621440
  buffer_load_dwordx4 v8, s[16:19], s54 offen  lds
  s_add_u32 m0, s57, 86016
  s_add_u32 s54, s78, 2752512
  buffer_load_dwordx4 v8, s[16:19], s54 offen  lds
  s_add_u32 m0, s57, 90112
  s_add_u32 s54, s78, 2883584
  buffer_load_dwordx4 v8, s[16:19], s54 offen  lds
  s_add_u32 m0, s57, 94208
  s_add_u32 s54, s78, 3014656
  buffer_load_dwordx4 v8, s[16:19], s54 offen  lds
  v_add_u32 v15, 32768, v11
  v_add_u32 v16, 32768, v12
  ds_read_b64_tr_b16 v[96:97], v15 offset:0
  ds_read_b64_tr_b16 v[98:99], v15 offset:512
  ds_read_b64_tr_b16 v[100:101], v15 offset:8192
  ds_read_b64_tr_b16 v[102:103], v15 offset:8704
  ds_read_b64_tr_b16 v[104:105], v16 offset:0
  ds_read_b64_tr_b16 v[106:107], v16 offset:512
  ds_read_b64_tr_b16 v[108:109], v16 offset:8192
  ds_read_b64_tr_b16 v[110:111], v16 offset:8704
  s_waitcnt vmcnt(16) lgkmcnt(0)
  s_barrier
  s_add_u32 m0, s57, 98304
  s_add_u32 s54, s78, 3670016
  buffer_load_dwordx4 v8, s[16:19], s54 offen  lds
  s_add_u32 m0, s57, 102400
  s_add_u32 s54, s78, 3801088
  buffer_load_dwordx4 v8, s[16:19], s54 offen  lds
  s_add_u32 m0, s57, 106496
  s_add_u32 s54, s78, 3932160
  buffer_load_dwordx4 v8, s[16:19], s54 offen  lds
  s_add_u32 m0, s57, 110592
  s_add_u32 s54, s78, 4063232
  buffer_load_dwordx4 v8, s[16:19], s54 offen  lds
  v_add_u32 v15, 49152, v11
  v_add_u32 v16, 49152, v12
  ds_read_b64_tr_b16 v[112:113], v15 offset:0
  ds_read_b64_tr_b16 v[114:115], v15 offset:512
  ds_read_b64_tr_b16 v[116:117], v15 offset:8192
  ds_read_b64_tr_b16 v[118:119], v15 offset:8704
  ds_read_b64_tr_b16 v[120:121], v16 offset:0
  ds_read_b64_tr_b16 v[122:123], v16 offset:512
  ds_read_b64_tr_b16 v[124:125], v16 offset:8192
  ds_read_b64_tr_b16 v[126:127], v16 offset:8704
  s_waitcnt vmcnt(16) lgkmcnt(0)
  s_barrier
  s_add_u32 m0, s57, 114688
  s_add_u32 s54, s78, 4194304
  buffer_load_dwordx4 v8, s[16:19], s54 offen  lds
  s_add_u32 m0, s57, 118784
  s_add_u32 s54, s78, 4325376
  buffer_load_dwordx4 v8, s[16:19], s54 offen  lds
  s_add_u32 m0, s57, 122880
  s_add_u32 s54, s78, 4456448
  buffer_load_dwordx4 v8, s[16:19], s54 offen  lds
  s_add_u32 m0, s57, 126976
  s_add_u32 s54, s78, 4587520
  buffer_load_dwordx4 v8, s[16:19], s54 offen  lds
  v_add_u32 v15, 65536, v11
  v_add_u32 v16, 65536, v12
  ds_read_b64_tr_b16 v[128:129], v15 offset:0
  ds_read_b64_tr_b16 v[130:131], v15 offset:512
  ds_read_b64_tr_b16 v[132:133], v15 offset:8192
  ds_read_b64_tr_b16 v[134:135], v15 offset:8704
  ds_read_b64_tr_b16 v[136:137], v16 offset:0
  ds_read_b64_tr_b16 v[138:139], v16 offset:512
  ds_read_b64_tr_b16 v[140:141], v16 offset:8192
  ds_read_b64_tr_b16 v[142:143], v16 offset:8704
  s_waitcnt vmcnt(13) lgkmcnt(0)
  s_barrier
  s_add_u32 m0, s57, 131072
  s_add_u32 s54, s78, 1048576
  buffer_load_dwordx4 v8, s[20:23], s54 offen  lds
  s_add_u32 m0, s57, 135168
  s_add_u32 s54, s78, 1179648
  buffer_load_dwordx4 v8, s[20:23], s54 offen  lds
  s_add_u32 m0, s57, 139264
  s_add_u32 s54, s78, 1310720
  buffer_load_dwordx4 v8, s[20:23], s54 offen  lds
  s_add_u32 m0, s57, 143360
  s_add_u32 s54, s78, 1441792
  buffer_load_dwordx4 v8, s[20:23], s54 offen  lds
  v_add_u32 v15, 81920, v11
  v_add_u32 v16, 81920, v12
  ds_read_b64_tr_b16 v[144:145], v15 offset:0
  ds_read_b64_tr_b16 v[146:147], v15 offset:512
  ds_read_b64_tr_b16 v[148:149], v15 offset:8192
  ds_read_b64_tr_b16 v[150:151], v15 offset:8704
  ds_read_b64_tr_b16 v[152:153], v16 offset:0
  ds_read_b64_tr_b16 v[154:155], v16 offset:512
  ds_read_b64_tr_b16 v[156:157], v16 offset:8192
  ds_read_b64_tr_b16 v[158:159], v16 offset:8704
  s_waitcnt vmcnt(12) lgkmcnt(0)
  s_barrier
  s_add_u32 m0, s57, 0
  s_add_u32 s54, s78, 1572864
  buffer_load_dwordx4 v8, s[20:23], s54 offen  lds
  s_add_u32 m0, s57, 4096
  s_add_u32 s54, s78, 1703936
  buffer_load_dwordx4 v8, s[20:23], s54 offen  lds
  s_add_u32 m0, s57, 8192
  s_add_u32 s54, s78, 1835008
  buffer_load_dwordx4 v8, s[20:23], s54 offen  lds
  s_add_u32 m0, s57, 12288
  s_add_u32 s54, s78, 1966080
  buffer_load_dwordx4 v8, s[20:23], s54 offen  lds
  v_add_u32 v15, 98304, v11
  v_add_u32 v16, 98304, v12
  ds_read_b64_tr_b16 v[160:161], v15 offset:0
  ds_read_b64_tr_b16 v[162:163], v15 offset:512
  ds_read_b64_tr_b16 v[164:165], v15 offset:8192
  ds_read_b64_tr_b16 v[166:167], v15 offset:8704
  ds_read_b64_tr_b16 v[168:169], v16 offset:0
  ds_read_b64_tr_b16 v[170:171], v16 offset:512
  ds_read_b64_tr_b16 v[172:173], v16 offset:8192
  ds_read_b64_tr_b16 v[174:175], v16 offset:8704
  s_waitcnt vmcnt(12) lgkmcnt(0)
  s_barrier
  s_add_u32 m0, s57, 16384
  s_add_u32 s54, s78, 3145728
  buffer_load_dwordx4 v8, s[20:23], s54 offen  lds
  s_add_u32 m0, s57, 20480
  s_add_u32 s54, s78, 3276800
  buffer_load_dwordx4 v8, s[20:23], s54 offen  lds
  s_add_u32 m0, s57, 24576
  s_add_u32 s54, s78, 3407872
  buffer_load_dwordx4 v8, s[20:23], s54 offen  lds
  s_add_u32 m0, s57, 28672
  s_add_u32 s54, s78, 3538944
  buffer_load_dwordx4 v8, s[20:23], s54 offen  lds
  v_add_u32 v15, 114688, v11
  v_add_u32 v16, 114688, v12
  ds_read_b64_tr_b16 v[176:177], v15 offset:0
  ds_read_b64_tr_b16 v[178:179], v15 offset:512
  ds_read_b64_tr_b16 v[180:181], v15 offset:8192
  ds_read_b64_tr_b16 v[182:183], v15 offset:8704
  ds_read_b64_tr_b16 v[184:185], v16 offset:0
  ds_read_b64_tr_b16 v[186:187], v16 offset:512
  ds_read_b64_tr_b16 v[188:189], v16 offset:8192
  ds_read_b64_tr_b16 v[190:191], v16 offset:8704
  s_waitcnt vmcnt(12) lgkmcnt(0)
  s_barrier
  s_add_u32 m0, s57, 32768
  s_add_u32 s54, s78, 3670016
  buffer_load_dwordx4 v8, s[20:23], s54 offen  lds
  s_add_u32 m0, s57, 36864
  s_add_u32 s54, s78, 3801088
  buffer_load_dwordx4 v8, s[20:23], s54 offen  lds
  s_add_u32 m0, s57, 40960
  s_add_u32 s54, s78, 3932160
  buffer_load_dwordx4 v8, s[20:23], s54 offen  lds
  s_add_u32 m0, s57, 45056
  s_add_u32 s54, s78, 4063232
  buffer_load_dwordx4 v8, s[20:23], s54 offen  lds
  v_add_u32 v15, 131072, v11
  v_add_u32 v16, 131072, v12
  ds_read_b64_tr_b16 v[192:193], v15 offset:0
  ds_read_b64_tr_b16 v[194:195], v15 offset:512
  ds_read_b64_tr_b16 v[196:197], v15 offset:8192
  ds_read_b64_tr_b16 v[198:199], v15 offset:8704
  ds_read_b64_tr_b16 v[200:201], v16 offset:0
  ds_read_b64_tr_b16 v[202:203], v16 offset:512
  ds_read_b64_tr_b16 v[204:205], v16 offset:8192
  ds_read_b64_tr_b16 v[206:207], v16 offset:8704
  s_waitcnt vmcnt(12) lgkmcnt(0)
  s_barrier
  s_add_u32 m0, s57, 49152
  s_add_u32 s54, s78, 4194304
  buffer_load_dwordx4 v8, s[20:23], s54 offen  lds
  s_add_u32 m0, s57, 53248
  s_add_u32 s54, s78, 4325376
  buffer_load_dwordx4 v8, s[20:23], s54 offen  lds
  s_add_u32 m0, s57, 57344
  s_add_u32 s54, s78, 4456448
  buffer_load_dwordx4 v8, s[20:23], s54 offen  lds
  s_add_u32 m0, s57, 61440
  s_add_u32 s54, s78, 4587520
  buffer_load_dwordx4 v8, s[20:23], s54 offen  lds
  s_getpc_b64 s[80:81]
  v_lshlrev_b32 v7, 2, v76
  global_load_dword v19, v7, s[80:81] offset:1024
  s_cmp_eq_u32 s1, 1
  s_cbranch_scc1 C_ver_ok
  v_mov_b32 v33, 16320
  s_cmp_eq_u32 s52, 0
  s_cbranch_scc0 C_ver_b
  s_waitcnt vmcnt(33)
  s_mov_b64 exec, 1
  ds_write_b32 v33, v35
  s_mov_b64 exec, -1
  s_waitcnt lgkmcnt(0)
C_ver_b:
  s_barrier
  ds_read_b32 v32, v33
  s_waitcnt lgkmcnt(0)
  v_readfirstlane_b32 s54, v32
  s_nop 0
  s_bitcmp1_b32 s54, s0
  s_cbranch_scc1 L_conf
C_ver_ok:
  v_min_u32 v20, -2, v20
  v_min_u32 v21, -2, v21
  v_min_u32 v22, -2, v22
  v_min_u32 v23, -2, v23
  v_min_u32 v24, -2, v24
  v_min_u32 v25, -2, v25
  v_min_u32 v26, -2, v26
  v_min_u32 v27, -2, v27
  v_min_u32 v28, -2, v28
  v_min_u32 v29, -2, v29
  v_min_u32 v30, -2, v30
  v_min_u32 v31, -2, v31
  s_lshl_b32 s54, s52, 11
  v_add_u32 v3, s54, v76
  ds_write_b128 v3, v[20:23] offset:4608
  ds_write_b128 v3, v[24:27] offset:5632
  ds_write_b128 v76, v[28:31] offset:12800
  v_add_u32 v15, 147456, v11
  v_add_u32 v16, 147456, v12
  ds_read_b64_tr_b16 v[208:209], v15 offset:0
  ds_read_b64_tr_b16 v[210:211], v15 offset:512
  ds_read_b64_tr_b16 v[212:213], v15 offset:8192
  ds_read_b64_tr_b16 v[214:215], v15 offset:8704
  ds_read_b64_tr_b16 v[216:217], v16 offset:0
  ds_read_b64_tr_b16 v[218:219], v16 offset:512
  ds_read_b64_tr_b16 v[220:221], v16 offset:8192
  ds_read_b64_tr_b16 v[222:223], v16 offset:8704
  s_waitcnt vmcnt(13) lgkmcnt(0)
  s_barrier
  s_add_u32 m0, s57, 65536
  s_add_u32 s54, s78, 0
  buffer_load_dwordx4 v8, s[24:27], s54 offen  lds
  s_add_u32 m0, s57, 69632
  s_add_u32 s54, s78, 131072
  buffer_load_dwordx4 v8, s[24:27], s54 offen  lds
  s_add_u32 m0, s57, 73728
  s_add_u32 s54, s78, 262144
  buffer_load_dwordx4 v8, s[24:27], s54 offen  lds
  s_add_u32 m0, s57, 77824
  s_add_u32 s54, s78, 393216
  buffer_load_dwordx4 v8, s[24:27], s54 offen  lds
  v_add_u32 v15, 16384, v11
  v_add_u32 v16, 16384, v12
  ds_read_b64_tr_b16 v[224:225], v15 offset:0
  ds_read_b64_tr_b16 v[226:227], v15 offset:512
  ds_read_b64_tr_b16 v[228:229], v15 offset:8192
  ds_read_b64_tr_b16 v[230:231], v15 offset:8704
  ds_read_b64_tr_b16 v[232:233], v16 offset:0
  ds_read_b64_tr_b16 v[234:235], v16 offset:512
  ds_read_b64_tr_b16 v[236:237], v16 offset:8192
  ds_read_b64_tr_b16 v[238:239], v16 offset:8704
  s_waitcnt vmcnt(13) lgkmcnt(0)
  s_barrier
  s_add_u32 m0, s57, 81920
  s_add_u32 s54, s78, 524288
  buffer_load_dwordx4 v8, s[24:27], s54 offen  lds
  s_add_u32 m0, s57, 86016
  s_add_u32 s54, s78, 655360
  buffer_load_dwordx4 v8, s[24:27], s54 offen  lds
  s_add_u32 m0, s57, 90112
  s_add_u32 s54, s78, 786432
  buffer_load_dwordx4 v8, s[24:27], s54 offen  lds
  s_add_u32 m0, s57, 94208
  s_add_u32 s54, s78, 917504
  buffer_load_dwordx4 v8, s[24:27], s54 offen  lds
  v_add_u32 v15, 32768, v11
  v_add_u32 v16, 32768, v12
  ds_read_b64_tr_b16 v[240:241], v15 offset:0
  ds_read_b64_tr_b16 v[242:243], v15 offset:512
  ds_read_b64_tr_b16 v[244:245], v15 offset:8192
  ds_read_b64_tr_b16 v[246:247], v15 offset:8704
  ds_read_b64_tr_b16 v[248:249], v16 offset:0
  ds_read_b64_tr_b16 v[250:251], v16 offset:512
  ds_read_b64_tr_b16 v[252:253], v16 offset:8192
  ds_read_b64_tr_b16 v[254:255], v16 offset:8704
  s_waitcnt vmcnt(13) lgkmcnt(0)
  s_barrier
  s_add_u32 m0, s57, 98304
  s_add_u32 s54, s78, 1048576
  buffer_load_dwordx4 v8, s[24:27], s54 offen  lds
  s_add_u32 m0, s57, 102400
  s_add_u32 s54, s78, 1179648
  buffer_load_dwordx4 v8, s[24:27], s54 offen  lds
  s_add_u32 m0, s57, 106496
  s_add_u32 s54, s78, 1310720
  buffer_load_dwordx4 v8, s[24:27], s54 offen  lds
  s_add_u32 m0, s57, 110592
  s_add_u32 s54, s78, 1441792
  buffer_load_dwordx4 v8, s[24:27], s54 offen  lds
  v_add_u32 v15, 49152, v11
  v_add_u32 v16, 49152, v12
  ds_read_b64_tr_b16 a[0:1], v15 offset:0
  ds_read_b64_tr_b16 a[2:3], v15 offset:512
  ds_read_b64_tr_b16 a[4:5], v15 offset:8192
  ds_read_b64_tr_b16 a[6:7], v15 offset:8704
  ds_read_b64_tr_b16 a[8:9], v16 offset:0
  ds_read_b64_tr_b16 a[10:11], v16 offset:512
  ds_read_b64_tr_b16 a[12:13], v16 offset:8192
  ds_read_b64_tr_b16 a[14:15], v16 offset:8704
  s_waitcnt vmcnt(13) lgkmcnt(0)
  s_barrier
  s_add_u32 m0, s57, 114688
  s_add_u32 s54, s78, 1572864
  buffer_load_dwordx4 v8, s[24:27], s54 offen  lds
  s_add_u32 m0, s57, 118784
  s_add_u32 s54, s78, 1703936
  buffer_load_dwordx4 v8, s[24:27], s54 offen  lds
  s_add_u32 m0, s57, 122880
  s_add_u32 s54, s78, 1835008
  buffer_load_dwordx4 v8, s[24:27], s54 offen  lds
  s_add_u32 m0, s57, 126976
  s_add_u32 s54, s78, 1966080
  buffer_load_dwordx4 v8, s[24:27], s54 offen  lds
  v_add_u32 v15, 65536, v11
  v_add_u32 v16, 65536, v12
  ds_read_b64_tr_b16 a[16:17], v15 offset:0
  ds_read_b64_tr_b16 a[18:19], v15 offset:512
  ds_read_b64_tr_b16 a[20:21], v15 offset:8192
  ds_read_b64_tr_b16 a[22:23], v15 offset:8704
  ds_read_b64_tr_b16 a[24:25], v16 offset:0
  ds_read_b64_tr_b16 a[26:27], v16 offset:512
  ds_read_b64_tr_b16 a[28:29], v16 offset:8192
  ds_read_b64_tr_b16 a[30:31], v16 offset:8704
  s_waitcnt vmcnt(12) lgkmcnt(0)
  s_barrier
  s_add_u32 m0, s57, 131072
  s_add_u32 s54, s78, 2097152
  buffer_load_dwordx4 v8, s[24:27], s54 offen  lds
  s_add_u32 m0, s57, 135168
  s_add_u32 s54, s78, 2228224
  buffer_load_dwordx4 v8, s[24:27], s54 offen  lds
  s_add_u32 m0, s57, 139264
  s_add_u32 s54, s78, 2359296
  buffer_load_dwordx4 v8, s[24:27], s54 offen  lds
  s_add_u32 m0, s57, 143360
  s_add_u32 s54, s78, 2490368
  buffer_load_dwordx4 v8, s[24:27], s54 offen  lds
  v_add_u32 v15, 81920, v11
  v_add_u32 v16, 81920, v12
  ds_read_b64_tr_b16 a[32:33], v15 offset:0
  ds_read_b64_tr_b16 a[34:35], v15 offset:512
  ds_read_b64_tr_b16 a[36:37], v15 offset:8192
  ds_read_b64_tr_b16 a[38:39], v15 offset:8704
  ds_read_b64_tr_b16 a[40:41], v16 offset:0
  ds_read_b64_tr_b16 a[42:43], v16 offset:512
  ds_read_b64_tr_b16 a[44:45], v16 offset:8192
  ds_read_b64_tr_b16 a[46:47], v16 offset:8704
  s_waitcnt vmcnt(12) lgkmcnt(0)
  s_barrier
  s_add_u32 m0, s57, 0
  s_add_u32 s54, s78, 2621440
  buffer_load_dwordx4 v8, s[24:27], s54 offen  lds
  s_add_u32 m0, s57, 4096
  s_add_u32 s54, s78, 2752512
  buffer_load_dwordx4 v8, s[24:27], s54 offen  lds
  s_add_u32 m0, s57, 8192
  s_add_u32 s54, s78, 2883584
  buffer_load_dwordx4 v8, s[24:27], s54 offen  lds
  s_add_u32 m0, s57, 12288
  s_add_u32 s54, s78, 3014656
  buffer_load_dwordx4 v8, s[24:27], s54 offen  lds
  s_getpc_b64 s[80:81]
  v_lshlrev_b32 v7, 2, v76
  global_load_dword v19, v7, s[80:81] offset:1024
  v_add_u32 v15, 98304, v11
  v_add_u32 v16, 98304, v12
  ds_read_b64_tr_b16 a[48:49], v15 offset:0
  ds_read_b64_tr_b16 a[50:51], v15 offset:512
  ds_read_b64_tr_b16 a[52:53], v15 offset:8192
  ds_read_b64_tr_b16 a[54:55], v15 offset:8704
  ds_read_b64_tr_b16 a[56:57], v16 offset:0
  ds_read_b64_tr_b16 a[58:59], v16 offset:512
  ds_read_b64_tr_b16 a[60:61], v16 offset:8192
  ds_read_b64_tr_b16 a[62:63], v16 offset:8704
  s_waitcnt vmcnt(13) lgkmcnt(0)
  s_barrier
  s_add_u32 m0, s57, 16384
  s_add_u32 s54, s78, 3145728
  buffer_load_dwordx4 v8, s[24:27], s54 offen  lds
  s_add_u32 m0, s57, 20480
  s_add_u32 s54, s78, 3276800
  buffer_load_dwordx4 v8, s[24:27], s54 offen  lds
  s_add_u32 m0, s57, 24576
  s_add_u32 s54, s78, 3407872
  buffer_load_dwordx4 v8, s[24:27], s54 offen  lds
  s_add_u32 m0, s57, 28672
  s_add_u32 s54, s78, 3538944
  buffer_load_dwordx4 v8, s[24:27], s54 offen  lds
  v_add_u32 v15, 114688, v11
  v_add_u32 v16, 114688, v12
  ds_read_b64_tr_b16 a[64:65], v15 offset:0
  ds_read_b64_tr_b16 a[66:67], v15 offset:512
  ds_read_b64_tr_b16 a[68:69], v15 offset:8192
  ds_read_b64_tr_b16 a[70:71], v15 offset:8704
  ds_read_b64_tr_b16 a[72:73], v16 offset:0
  ds_read_b64_tr_b16 a[74:75], v16 offset:512
  ds_read_b64_tr_b16 a[76:77], v16 offset:8192
  ds_read_b64_tr_b16 a[78:79], v16 offset:8704
  s_waitcnt vmcnt(13) lgkmcnt(0)
  s_barrier
  s_add_u32 m0, s57, 32768
  s_add_u32 s54, s78, 3670016
  buffer_load_dwordx4 v8, s[24:27], s54 offen  lds
  s_add_u32 m0, s57, 36864
  s_add_u32 s54, s78, 3801088
  buffer_load_dwordx4 v8, s[24:27], s54 offen  lds
  s_add_u32 m0, s57, 40960
  s_add_u32 s54, s78, 3932160
  buffer_load_dwordx4 v8, s[24:27], s54 offen  lds
  s_add_u32 m0, s57, 45056
  s_add_u32 s54, s78, 4063232
  buffer_load_dwordx4 v8, s[24:27], s54 offen  lds
  v_add_u32 v15, 131072, v11
  v_add_u32 v16, 131072, v12
  ds_read_b64_tr_b16 a[80:81], v15 offset:0
  ds_read_b64_tr_b16 a[82:83], v15 offset:512
  ds_read_b64_tr_b16 a[84:85], v15 offset:8192
  ds_read_b64_tr_b16 a[86:87], v15 offset:8704
  ds_read_b64_tr_b16 a[88:89], v16 offset:0
  ds_read_b64_tr_b16 a[90:91], v16 offset:512
  ds_read_b64_tr_b16 a[92:93], v16 offset:8192
  ds_read_b64_tr_b16 a[94:95], v16 offset:8704
  s_waitcnt vmcnt(13) lgkmcnt(0)
  s_barrier
  s_add_u32 m0, s57, 49152
  s_add_u32 s54, s78, 4194304
  buffer_load_dwordx4 v8, s[24:27], s54 offen  lds
  s_add_u32 m0, s57, 53248
  s_add_u32 s54, s78, 4325376
  buffer_load_dwordx4 v8, s[24:27], s54 offen  lds
  s_add_u32 m0, s57, 57344
  s_add_u32 s54, s78, 4456448
  buffer_load_dwordx4 v8, s[24:27], s54 offen  lds
  s_add_u32 m0, s57, 61440
  s_add_u32 s54, s78, 4587520
  buffer_load_dwordx4 v8, s[24:27], s54 offen  lds
  v_add_u32 v15, 147456, v11
  v_add_u32 v16, 147456, v12
  ds_read_b64_tr_b16 a[96:97], v15 offset:0
  ds_read_b64_tr_b16 a[98:99], v15 offset:512
  ds_read_b64_tr_b16 a[100:101], v15 offset:8192
  ds_read_b64_tr_b16 a[102:103], v15 offset:8704
  ds_read_b64_tr_b16 a[104:105], v16 offset:0
  ds_read_b64_tr_b16 a[106:107], v16 offset:512
  ds_read_b64_tr_b16 a[108:109], v16 offset:8192
  ds_read_b64_tr_b16 a[110:111], v16 offset:8704
  s_waitcnt vmcnt(13) lgkmcnt(0)
  s_barrier
  s_add_u32 m0, s57, 65536
  s_add_u32 s54, s79, 73728
  buffer_load_dwordx4 v10, s[28:31], s54 offen  lds
  s_add_u32 m0, s57, 69632
  s_add_u32 s54, s79, 82944
  buffer_load_dwordx4 v10, s[28:31], s54 offen  lds
  s_add_u32 m0, s57, 73728
  s_add_u32 s54, s79, 110592
  buffer_load_dwordx4 v10, s[28:31], s54 offen  lds
  s_add_u32 m0, s57, 77824
  s_add_u32 s54, s79, 119808
  buffer_load_dwordx4 v10, s[28:31], s54 offen  lds
  v_add_u32 v15, 16384, v11
  v_add_u32 v16, 16384, v12
  ds_read_b64_tr_b16 a[112:113], v15 offset:0
  ds_read_b64_tr_b16 a[114:115], v15 offset:512
  ds_read_b64_tr_b16 a[116:117], v15 offset:8192
  ds_read_b64_tr_b16 a[118:119], v15 offset:8704
  ds_read_b64_tr_b16 a[120:121], v16 offset:0
  ds_read_b64_tr_b16 a[122:123], v16 offset:512
  ds_read_b64_tr_b16 a[124:125], v16 offset:8192
  ds_read_b64_tr_b16 a[126:127], v16 offset:8704
  s_waitcnt vmcnt(12) lgkmcnt(0)
  s_barrier
  s_add_u32 m0, s57, 81920
  s_add_u32 s54, s79, 256
  buffer_load_dwordx4 v10, s[28:31], s54 offen  lds
  s_add_u32 m0, s57, 86016
  s_add_u32 s54, s79, 9472
  buffer_load_dwordx4 v10, s[28:31], s54 offen  lds
  s_add_u32 m0, s57, 90112
  s_add_u32 s54, s79, 37120
  buffer_load_dwordx4 v10, s[28:31], s54 offen  lds
  s_add_u32 m0, s57, 94208
  s_add_u32 s54, s79, 46336
  buffer_load_dwordx4 v10, s[28:31], s54 offen  lds
  v_add_u32 v15, 32768, v11
  v_add_u32 v16, 32768, v12
  ds_read_b64_tr_b16 a[128:129], v15 offset:0
  ds_read_b64_tr_b16 a[130:131], v15 offset:512
  ds_read_b64_tr_b16 a[132:133], v15 offset:8192
  ds_read_b64_tr_b16 a[134:135], v15 offset:8704
  ds_read_b64_tr_b16 a[136:137], v16 offset:0
  ds_read_b64_tr_b16 a[138:139], v16 offset:512
  ds_read_b64_tr_b16 a[140:141], v16 offset:8192
  ds_read_b64_tr_b16 a[142:143], v16 offset:8704
  s_waitcnt vmcnt(12) lgkmcnt(0)
  s_barrier
  s_add_u32 m0, s57, 98304
  s_add_u32 s54, s79, 512
  buffer_load_dwordx4 v10, s[28:31], s54 offen  lds
  s_add_u32 m0, s57, 102400
  s_add_u32 s54, s79, 9728
  buffer_load_dwordx4 v10, s[28:31], s54 offen  lds
  s_add_u32 m0, s57, 106496
  s_add_u32 s54, s79, 37376
  buffer_load_dwordx4 v10, s[28:31], s54 offen  lds
  s_add_u32 m0, s57, 110592
  s_add_u32 s54, s79, 46592
  buffer_load_dwordx4 v10, s[28:31], s54 offen  lds
  s_getpc_b64 s[80:81]
  v_lshlrev_b32 v7, 2, v76
  global_load_dword v19, v7, s[80:81] offset:1024
  v_add_u32 v15, 49152, v11
  v_add_u32 v16, 49152, v12
  ds_read_b64_tr_b16 a[144:145], v15 offset:0
  ds_read_b64_tr_b16 a[146:147], v15 offset:512
  ds_read_b64_tr_b16 a[148:149], v15 offset:8192
  ds_read_b64_tr_b16 a[150:151], v15 offset:8704
  ds_read_b64_tr_b16 a[152:153], v16 offset:0
  ds_read_b64_tr_b16 a[154:155], v16 offset:512
  ds_read_b64_tr_b16 a[156:157], v16 offset:8192
  ds_read_b64_tr_b16 a[158:159], v16 offset:8704
  s_waitcnt vmcnt(13) lgkmcnt(0)
  s_barrier
  s_add_u32 m0, s57, 114688
  s_add_u32 s54, s79, 74240
  buffer_load_dwordx4 v10, s[28:31], s54 offen  lds
  s_add_u32 m0, s57, 118784
  s_add_u32 s54, s79, 83456
  buffer_load_dwordx4 v10, s[28:31], s54 offen  lds
  s_add_u32 m0, s57, 122880
  s_add_u32 s54, s79, 111104
  buffer_load_dwordx4 v10, s[28:31], s54 offen  lds
  s_add_u32 m0, s57, 126976
  s_add_u32 s54, s79, 120320
  buffer_load_dwordx4 v10, s[28:31], s54 offen  lds
  v_add_u32 v15, 65536, v11
  v_add_u32 v16, 65536, v12
  ds_read_b64_tr_b16 a[160:161], v15 offset:0
  ds_read_b64_tr_b16 a[162:163], v15 offset:512
  ds_read_b64_tr_b16 a[164:165], v15 offset:8192
  ds_read_b64_tr_b16 a[166:167], v15 offset:8704
  ds_read_b64_tr_b16 a[168:169], v16 offset:0
  ds_read_b64_tr_b16 a[170:171], v16 offset:512
  ds_read_b64_tr_b16 a[172:173], v16 offset:8192
  ds_read_b64_tr_b16 a[174:175], v16 offset:8704
  s_waitcnt vmcnt(13) lgkmcnt(0)
  s_barrier
  s_add_u32 m0, s57, 131072
  s_add_u32 s54, s79, 74496
  buffer_load_dwordx4 v10, s[28:31], s54 offen  lds
  s_add_u32 m0, s57, 135168
  s_add_u32 s54, s79, 83712
  buffer_load_dwordx4 v10, s[28:31], s54 offen  lds
  s_add_u32 m0, s57, 139264
  s_add_u32 s54, s79, 111360
  buffer_load_dwordx4 v10, s[28:31], s54 offen  lds
  s_add_u32 m0, s57, 143360
  s_add_u32 s54, s79, 120576
  buffer_load_dwordx4 v10, s[28:31], s54 offen  lds
  v_add_u32 v15, 81920, v14
  ds_read_b64_tr_b16 a[176:177], v15 offset:0
  ds_read_b64_tr_b16 a[178:179], v15 offset:1024
  ds_read_b64_tr_b16 a[180:181], v15 offset:4096
  ds_read_b64_tr_b16 a[182:183], v15 offset:5120
  ds_read_b64_tr_b16 a[184:185], v15 offset:8192
  ds_read_b64_tr_b16 a[186:187], v15 offset:9216
  ds_read_b64_tr_b16 a[188:189], v15 offset:12288
  ds_read_b64_tr_b16 a[190:191], v15 offset:13312
  s_waitcnt vmcnt(13) lgkmcnt(0)
  s_barrier
  s_add_u32 m0, s57, 0
  s_add_u32 s54, s78, 0
  buffer_load_dwordx4 v8, s[20:23], s54 offen  lds
  s_add_u32 m0, s57, 4096
  s_add_u32 s54, s78, 131072
  buffer_load_dwordx4 v8, s[20:23], s54 offen  lds
  s_add_u32 m0, s57, 8192
  s_add_u32 s54, s78, 262144
  buffer_load_dwordx4 v8, s[20:23], s54 offen  lds
  s_add_u32 m0, s57, 12288
  s_add_u32 s54, s78, 393216
  buffer_load_dwordx4 v8, s[20:23], s54 offen  lds
  v_add_u32 v15, 98304, v14
  ds_read_b64_tr_b16 a[192:193], v15 offset:0
  ds_read_b64_tr_b16 a[194:195], v15 offset:1024
  ds_read_b64_tr_b16 a[196:197], v15 offset:4096
  ds_read_b64_tr_b16 a[198:199], v15 offset:5120
  ds_read_b64_tr_b16 a[200:201], v15 offset:8192
  ds_read_b64_tr_b16 a[202:203], v15 offset:9216
  ds_read_b64_tr_b16 a[204:205], v15 offset:12288
  ds_read_b64_tr_b16 a[206:207], v15 offset:13312
  s_waitcnt vmcnt(13) lgkmcnt(0)
  s_barrier
  s_add_u32 m0, s57, 16384
  s_add_u32 s54, s78, 524288
  buffer_load_dwordx4 v8, s[20:23], s54 offen  lds
  s_add_u32 m0, s57, 20480
  s_add_u32 s54, s78, 655360
  buffer_load_dwordx4 v8, s[20:23], s54 offen  lds
  s_add_u32 m0, s57, 24576
  s_add_u32 s54, s78, 786432
  buffer_load_dwordx4 v8, s[20:23], s54 offen  lds
  s_add_u32 m0, s57, 28672
  s_add_u32 s54, s78, 917504
  buffer_load_dwordx4 v8, s[20:23], s54 offen  lds
  v_add_u32 v15, 114688, v14
  ds_read_b64_tr_b16 a[208:209], v15 offset:0
  ds_read_b64_tr_b16 a[210:211], v15 offset:1024
  ds_read_b64_tr_b16 a[212:213], v15 offset:4096
  ds_read_b64_tr_b16 a[214:215], v15 offset:5120
  ds_read_b64_tr_b16 a[216:217], v15 offset:8192
  ds_read_b64_tr_b16 a[218:219], v15 offset:9216
  ds_read_b64_tr_b16 a[220:221], v15 offset:12288
  ds_read_b64_tr_b16 a[222:223], v15 offset:13312
  s_waitcnt vmcnt(12) lgkmcnt(0)
  s_barrier
  s_add_u32 m0, s57, 32768
  s_add_u32 s54, s78, 2097152
  buffer_load_dwordx4 v8, s[20:23], s54 offen  lds
  s_add_u32 m0, s57, 36864
  s_add_u32 s54, s78, 2228224
  buffer_load_dwordx4 v8, s[20:23], s54 offen  lds
  s_add_u32 m0, s57, 40960
  s_add_u32 s54, s78, 2359296
  buffer_load_dwordx4 v8, s[20:23], s54 offen  lds
  s_add_u32 m0, s57, 45056
  s_add_u32 s54, s78, 2490368
  buffer_load_dwordx4 v8, s[20:23], s54 offen  lds
  v_add_u32 v15, 131072, v14
  ds_read_b64_tr_b16 a[224:225], v15 offset:0
  ds_read_b64_tr_b16 a[226:227], v15 offset:1024
  ds_read_b64_tr_b16 a[228:229], v15 offset:4096
  ds_read_b64_tr_b16 a[230:231], v15 offset:5120
  ds_read_b64_tr_b16 a[232:233], v15 offset:8192
  ds_read_b64_tr_b16 a[234:235], v15 offset:9216
  ds_read_b64_tr_b16 a[236:237], v15 offset:12288
  ds_read_b64_tr_b16 a[238:239], v15 offset:13312
  s_waitcnt vmcnt(12) lgkmcnt(0)
  s_barrier
  s_add_u32 m0, s57, 49152
  s_add_u32 s54, s78, 3145728
  buffer_load_dwordx4 v8, s[16:19], s54 offen  lds
  s_add_u32 m0, s57, 53248
  s_add_u32 s54, s78, 3276800
  buffer_load_dwordx4 v8, s[16:19], s54 offen  lds
  s_add_u32 m0, s57, 57344
  s_add_u32 s54, s78, 3407872
  buffer_load_dwordx4 v8, s[16:19], s54 offen  lds
  s_add_u32 m0, s57, 61440
  s_add_u32 s54, s78, 3538944
  buffer_load_dwordx4 v8, s[16:19], s54 offen  lds
  v_add_u32 v15, 147456, v14
  ds_read_b64_tr_b16 a[240:241], v15 offset:0
  ds_read_b64_tr_b16 a[242:243], v15 offset:1024
  ds_read_b64_tr_b16 a[244:245], v15 offset:4096
  ds_read_b64_tr_b16 a[246:247], v15 offset:5120
  ds_read_b64_tr_b16 a[248:249], v15 offset:8192
  ds_read_b64_tr_b16 a[250:251], v15 offset:9216
  ds_read_b64_tr_b16 a[252:253], v15 offset:12288
  ds_read_b64_tr_b16 a[254:255], v15 offset:13312
  s_waitcnt vmcnt(12) lgkmcnt(0)
  s_barrier
  s_add_u32 m0, s57, 65536
  s_add_u32 s54, s78, 2621440
  buffer_load_dwordx4 v8, s[20:23], s54 offen  lds
  s_add_u32 m0, s57, 69632
  s_add_u32 s54, s78, 2752512
  buffer_load_dwordx4 v8, s[20:23], s54 offen  lds
  s_add_u32 m0, s57, 73728
  s_add_u32 s54, s78, 2883584
  buffer_load_dwordx4 v8, s[20:23], s54 offen  lds
  s_add_u32 m0, s57, 77824
  s_add_u32 s54, s78, 3014656
  buffer_load_dwordx4 v8, s[20:23], s54 offen  lds
  v_add_u32 v15, 16384, v11
  v_add_u32 v16, 16384, v12
  ds_read_b64_tr_b16 v[52:53], v15 offset:0
  ds_read_b64_tr_b16 v[54:55], v15 offset:512
  ds_read_b64_tr_b16 v[56:57], v15 offset:8192
  ds_read_b64_tr_b16 v[58:59], v15 offset:8704
  ds_read_b64_tr_b16 v[60:61], v16 offset:0
  ds_read_b64_tr_b16 v[62:63], v16 offset:512
  ds_read_b64_tr_b16 v[64:65], v16 offset:8192
  ds_read_b64_tr_b16 v[66:67], v16 offset:8704
  s_waitcnt vmcnt(12) lgkmcnt(0)
  s_barrier
  s_lshl_b32 s54, s52, 12
  s_add_u32 s54, s54, 16384
  v_add_u32 v7, s54, v76
  ds_write_b128 v7, v[52:55] offset:0
  ds_write_b128 v7, v[56:59] offset:1024
  ds_write_b128 v7, v[60:63] offset:2048
  ds_write_b128 v7, v[64:67] offset:3072
  s_add_u32 m0, s57, 81920
  s_add_u32 s54, s79, 1024
  buffer_load_dwordx4 v9, s[28:31], s54 offen  lds
  s_add_u32 m0, s57, 86016
  s_add_u32 s54, s79, 37888
  buffer_load_dwordx4 v9, s[28:31], s54 offen  lds
  s_add_u32 m0, s57, 90112
  s_add_u32 s54, s79, 74752
  buffer_load_dwordx4 v9, s[28:31], s54 offen  lds
  s_add_u32 m0, s57, 94208
  s_add_u32 s54, s79, 111616
  buffer_load_dwordx4 v9, s[28:31], s54 offen  lds
  v_add_u32 v15, 32768, v11
  v_add_u32 v16, 32768, v12
  ds_read_b64_tr_b16 v[36:37], v15 offset:0
  ds_read_b64_tr_b16 v[38:39], v15 offset:512
  ds_read_b64_tr_b16 v[40:41], v15 offset:8192
  ds_read_b64_tr_b16 v[42:43], v15 offset:8704
  ds_read_b64_tr_b16 v[44:45], v16 offset:0
  ds_read_b64_tr_b16 v[46:47], v16 offset:512
  ds_read_b64_tr_b16 v[48:49], v16 offset:8192
  ds_read_b64_tr_b16 v[50:51], v16 offset:8704
  s_waitcnt vmcnt(12) lgkmcnt(0)
  s_barrier
  s_lshl_b32 s54, s52, 12
  s_add_u32 s54, s54, 32768
  v_add_u32 v7, s54, v76
  ds_write_b128 v7, v[36:39] offset:0
  ds_write_b128 v7, v[40:43] offset:1024
  ds_write_b128 v7, v[44:47] offset:2048
  ds_write_b128 v7, v[48:51] offset:3072
  s_add_u32 m0, s57, 98304
  s_add_u32 s54, s79, 0
  buffer_load_dwordx4 v10, s[28:31], s54 offen  lds
  s_add_u32 m0, s57, 102400
  s_add_u32 s54, s79, 9216
  buffer_load_dwordx4 v10, s[28:31], s54 offen  lds
  s_add_u32 m0, s57, 106496
  s_add_u32 s54, s79, 36864
  buffer_load_dwordx4 v10, s[28:31], s54 offen  lds
  s_add_u32 m0, s57, 110592
  s_add_u32 s54, s79, 46080
  buffer_load_dwordx4 v10, s[28:31], s54 offen  lds
  v_add_u32 v15, 49152, v11
  v_add_u32 v16, 49152, v12
  ds_read_b64_tr_b16 v[52:53], v15 offset:0
  ds_read_b64_tr_b16 v[54:55], v15 offset:512
  ds_read_b64_tr_b16 v[56:57], v15 offset:8192
  ds_read_b64_tr_b16 v[58:59], v15 offset:8704
  ds_read_b64_tr_b16 v[60:61], v16 offset:0
  ds_read_b64_tr_b16 v[62:63], v16 offset:512
  ds_read_b64_tr_b16 v[64:65], v16 offset:8192
  ds_read_b64_tr_b16 v[66:67], v16 offset:8704
  s_waitcnt vmcnt(12) lgkmcnt(0)
  s_barrier
  s_lshl_b32 s54, s52, 12
  s_add_u32 s54, s54, 49152
  v_add_u32 v7, s54, v76
  ds_write_b128 v7, v[52:55] offset:0
  ds_write_b128 v7, v[56:59] offset:1024
  ds_write_b128 v7, v[60:63] offset:2048
  ds_write_b128 v7, v[64:67] offset:3072
  s_add_u32 m0, s57, 114688
  s_add_u32 s54, s79, 73984
  buffer_load_dwordx4 v10, s[28:31], s54 offen  lds
  s_add_u32 m0, s57, 118784
  s_add_u32 s54, s79, 83200
  buffer_load_dwordx4 v10, s[28:31], s54 offen  lds
  s_add_u32 m0, s57, 122880
  s_add_u32 s54, s79, 110848
  buffer_load_dwordx4 v10, s[28:31], s54 offen  lds
  s_add_u32 m0, s57, 126976
  s_add_u32 s54, s79, 120064
  buffer_load_dwordx4 v10, s[28:31], s54 offen  lds
  v_add_u32 v15, 65536, v11
  v_add_u32 v16, 65536, v12
  ds_read_b64_tr_b16 v[36:37], v15 offset:0
  ds_read_b64_tr_b16 v[38:39], v15 offset:512
  ds_read_b64_tr_b16 v[40:41], v15 offset:8192
  ds_read_b64_tr_b16 v[42:43], v15 offset:8704
  ds_read_b64_tr_b16 v[44:45], v16 offset:0
  ds_read_b64_tr_b16 v[46:47], v16 offset:512
  ds_read_b64_tr_b16 v[48:49], v16 offset:8192
  ds_read_b64_tr_b16 v[50:51], v16 offset:8704
  s_waitcnt vmcnt(12) lgkmcnt(0)
  s_barrier
  s_lshl_b32 s54, s52, 12
  s_add_u32 s54, s54, 65536
  v_add_u32 v7, s54, v76
  ds_write_b128 v7, v[36:39] offset:0
  ds_write_b128 v7, v[40:43] offset:1024
  ds_write_b128 v7, v[44:47] offset:2048
  ds_write_b128 v7, v[48:51] offset:3072
  s_add_u32 m0, s57, 131072
  s_add_u32 s54, s79, 768
  buffer_load_dwordx4 v10, s[28:31], s54 offen  lds
  s_add_u32 m0, s57, 135168
  s_add_u32 s54, s79, 9984
  buffer_load_dwordx4 v10, s[28:31], s54 offen  lds
  s_add_u32 m0, s57, 139264
  s_add_u32 s54, s79, 37632
  buffer_load_dwordx4 v10, s[28:31], s54 offen  lds
  s_add_u32 m0, s57, 143360
  s_add_u32 s54, s79, 46848
  buffer_load_dwordx4 v10, s[28:31], s54 offen  lds
  v_lshlrev_b32 v7, 3, v76
  s_lshl_b32 s54, s52, 13
  s_add_u32 s54, s54, 360448
  s_bitcmp1_b32 s52, 0
  s_cselect_b64 exec, 0xff, -1
  buffer_load_dword v35, v7, s[8:11], s54 offen sc1
  s_mov_b64 exec, -1
  s_getpc_b64 s[80:81]
C_pc:
  s_mov_b32 s55, (L_w0 - C_pc)
  s_cmp_eq_u32 s52, 1
  s_cselect_b32 s55, (L_w1 - C_pc), s55
  s_cmp_eq_u32 s52, 2
  s_cselect_b32 s55, (L_w2 - C_pc), s55
  s_cmp_eq_u32 s52, 3
  s_cselect_b32 s55, (L_w3 - C_pc), s55
  v_lshl_add_u32 v7, v76, 3, s55
  global_load_dword v35, v7, s[80:81]
  v_add_u32 v15, 81920, v11
  v_add_u32 v16, 81920, v12
  ds_read_b64_tr_b16 v[52:53], v15 offset:0
  ds_read_b64_tr_b16 v[54:55], v15 offset:512
  ds_read_b64_tr_b16 v[56:57], v15 offset:8192
  ds_read_b64_tr_b16 v[58:59], v15 offset:8704
  ds_read_b64_tr_b16 v[60:61], v16 offset:0
  ds_read_b64_tr_b16 v[62:63], v16 offset:512
  ds_read_b64_tr_b16 v[64:65], v16 offset:8192
  ds_read_b64_tr_b16 v[66:67], v16 offset:8704
  s_waitcnt vmcnt(14) lgkmcnt(0)
  s_barrier
  s_lshl_b32 s54, s52, 12
  s_add_u32 s54, s54, 81920
  v_add_u32 v7, s54, v76
  ds_write_b128 v7, v[52:55] offset:0
  ds_write_b128 v7, v[56:59] offset:1024
  ds_write_b128 v7, v[60:63] offset:2048
  ds_write_b128 v7, v[64:67] offset:3072
  v_lshrrev_b32 v20, 2, v76
  buffer_load_dword v21, v20, s[12:15], 0 offen sc1
  v_add_u32 v15, 98304, v13
  s_waitcnt lgkmcnt(0)
  ds_read_b64_tr_b16 v[36:37], v15 offset:0
  ds_read_b64_tr_b16 v[38:39], v15 offset:1024
  ds_read_b64_tr_b16 v[40:41], v15 offset:2048
  ds_read_b64_tr_b16 v[42:43], v15 offset:3072
  ds_read_b64_tr_b16 v[44:45], v15 offset:4096
  ds_read_b64_tr_b16 v[46:47], v15 offset:5120
  ds_read_b64_tr_b16 v[48:49], v15 offset:6144
  ds_read_b64_tr_b16 v[50:51], v15 offset:7168
  ds_read_b64_tr_b16 v[52:53], v15 offset:8192
  ds_read_b64_tr_b16 v[54:55], v15 offset:9216
  ds_read_b64_tr_b16 v[56:57], v15 offset:10240
  ds_read_b64_tr_b16 v[58:59], v15 offset:11264
  ds_read_b64_tr_b16 v[60:61], v15 offset:12288
  ds_read_b64_tr_b16 v[62:63], v15 offset:13312
  ds_read_b64_tr_b16 v[64:65], v15 offset:14336
  ds_read_b64_tr_b16 v[66:67], v15 offset:15360
  s_waitcnt vmcnt(11) lgkmcnt(0)
  s_barrier
  s_and_b32 s54, s52, 1
  s_lshl_b32 s54, s54, 13
  s_add_u32 s54, s54, 98304
  v_add_u32 v7, s54, v76
  ds_write_b128 v7, v[36:39] offset:0
  ds_write_b128 v7, v[40:43] offset:1024
  ds_write_b128 v7, v[44:47] offset:2048
  ds_write_b128 v7, v[48:51] offset:3072
  ds_write_b128 v7, v[52:55] offset:4096
  ds_write_b128 v7, v[56:59] offset:5120
  ds_write_b128 v7, v[60:63] offset:6144
  ds_write_b128 v7, v[64:67] offset:7168
  v_add_u32 v15, 114688, v14
  ds_read_b64_tr_b16 v[52:53], v15 offset:0
  ds_read_b64_tr_b16 v[54:55], v15 offset:1024
  ds_read_b64_tr_b16 v[56:57], v15 offset:4096
  ds_read_b64_tr_b16 v[58:59], v15 offset:5120
  ds_read_b64_tr_b16 v[60:61], v15 offset:8192
  ds_read_b64_tr_b16 v[62:63], v15 offset:9216
  ds_read_b64_tr_b16 v[64:65], v15 offset:12288
  ds_read_b64_tr_b16 v[66:67], v15 offset:13312
  s_waitcnt vmcnt(7) lgkmcnt(0)
  s_barrier
  s_lshl_b32 s54, s52, 12
  s_add_u32 s54, s54, 114688
  v_add_u32 v7, s54, v76
  ds_write_b128 v7, v[52:55] offset:0
  ds_write_b128 v7, v[56:59] offset:1024
  ds_write_b128 v7, v[60:63] offset:2048
  ds_write_b128 v7, v[64:67] offset:3072
  v_add_u32 v15, 131072, v14
  ds_read_b64_tr_b16 v[36:37], v15 offset:0
  ds_read_b64_tr_b16 v[38:39], v15 offset:1024
  ds_read_b64_tr_b16 v[40:41], v15 offset:4096
  ds_read_b64_tr_b16 v[42:43], v15 offset:5120
  ds_read_b64_tr_b16 v[44:45], v15 offset:8192
  ds_read_b64_tr_b16 v[46:47], v15 offset:9216
  ds_read_b64_tr_b16 v[48:49], v15 offset:12288
  ds_read_b64_tr_b16 v[50:51], v15 offset:13312
  s_waitcnt vmcnt(3) lgkmcnt(0)
  s_barrier
  s_lshl_b32 s54, s52, 12
  s_add_u32 s54, s54, 131072
  v_add_u32 v7, s54, v76
  ds_write_b128 v7, v[36:39] offset:0
  ds_write_b128 v7, v[40:43] offset:1024
  ds_write_b128 v7, v[44:47] offset:2048
  ds_write_b128 v7, v[48:51] offset:3072
  v_add_u32 v15, 147456, v14
  ds_read_b64_tr_b16 v[52:53], v15 offset:0
  ds_read_b64_tr_b16 v[54:55], v15 offset:1024
  ds_read_b64_tr_b16 v[56:57], v15 offset:4096
  ds_read_b64_tr_b16 v[58:59], v15 offset:5120
  ds_read_b64_tr_b16 v[60:61], v15 offset:8192
  ds_read_b64_tr_b16 v[62:63], v15 offset:9216
  ds_read_b64_tr_b16 v[64:65], v15 offset:12288
  ds_read_b64_tr_b16 v[66:67], v15 offset:13312
  s_waitcnt vmcnt(0) lgkmcnt(0)
  s_barrier
  s_lshl_b32 s54, s52, 12
  s_add_u32 s54, s54, 147456
  v_add_u32 v7, s54, v76
  ds_write_b128 v7, v[52:55] offset:0
  ds_write_b128 v7, v[56:59] offset:1024
  ds_write_b128 v7, v[60:63] offset:2048
  ds_write_b128 v7, v[64:67] offset:3072
  s_waitcnt lgkmcnt(0)
  s_branch C_rd1
C_rd0:
  s_sleep 2
  buffer_load_dword v21, v20, s[12:15], 0 offen sc1
  s_waitcnt vmcnt(0)
C_rd1:
  v_and_b32 v22, 0xff, v21
  v_cmp_gt_u32 vcc, 7, v22
  v_readlane_b32 s56, v21, 0
  s_mov_b32 s3, 1
  s_add_u32 s67, s67, 1
  s_cmp_ge_u32 s67, 131072
  s_cbranch_scc1 C_rd2
  s_cmp_lg_u32 vcc_hi, 0
  s_cbranch_scc1 C_rd0
  s_mov_b32 s3, 0
  s_cmp_eq_u32 s56, -1
  s_cbranch_scc1 C_rd2
  s_mov_b32 s3, 1
  v_readlane_b32 s54, v21, 10
  v_readlane_b32 s55, v21, 0
  s_nop 0
  s_bcnt1_i32_b32 s55, s55
  s_add_u32 s54, s54, s55
  v_readlane_b32 s55, v21, 1
  s_nop 0
  s_bcnt1_i32_b32 s55, s55
  s_add_u32 s54, s54, s55
  v_readlane_b32 s55, v21, 2
  s_nop 0
  s_bcnt1_i32_b32 s55, s55
  s_add_u32 s54, s54, s55
  v_readlane_b32 s55, v21, 3
  s_nop 0
  s_bcnt1_i32_b32 s55, s55
  s_add_u32 s54, s54, s55
  v_readlane_b32 s55, v21, 4
  s_nop 0
  s_bcnt1_i32_b32 s55, s55
  s_add_u32 s54, s54, s55
  v_readlane_b32 s55, v21, 5
  s_nop 0
  s_bcnt1_i32_b32 s55, s55
  s_add_u32 s54, s54, s55
  v_readlane_b32 s55, v21, 6
  s_nop 0
  s_bcnt1_i32_b32 s55, s55
  s_add_u32 s54, s54, s55
  v_readlane_b32 s55, v21, 7
  s_nop 0
  s_bcnt1_i32_b32 s55, s55
  s_add_u32 s54, s54, s55
  s_cmp_lt_u32 s54, 256
  s_cbranch_scc1 C_rd0
C_rd2:
  s_lshl_b32 s54, s3, 2
  s_add_u32 s54, s54, s52
  s_cmp_eq_u32 s54, 1
  s_cbranch_scc1 L_w1
  s_cmp_eq_u32 s54, 2
  s_cbranch_scc1 L_w2
  s_cmp_eq_u32 s54, 3
  s_cbranch_scc1 L_w3
  s_cmp_eq_u32 s54, 4
  s_cbranch_scc1 L_w4
  s_cmp_eq_u32 s54, 5
  s_cbranch_scc1 L_w5
  s_cmp_eq_u32 s54, 6
  s_cbranch_scc1 L_w6
  s_cmp_eq_u32 s54, 7
  s_cbranch_scc1 L_w7
L_w0:
  v_mov_b64 v[20:21], 0
  v_mov_b64 v[22:23], 0
  v_mov_b64 v[24:25], 0
  v_mov_b64 v[26:27], 0
  v_mov_b64 v[28:29], 0
  v_mov_b64 v[30:31], 0
  v_mov_b64 v[32:33], 0
  v_mov_b64 v[34:35], 0
  s_mov_b32 s78, 0x3f803f80
  s_mov_b32 s79, s78
  s_mov_b32 s65, 360448
  s_mov_b32 m0, 16128
  s_lshl_b32 s71, s53, 2
  s_add_u32 s71, s71, 128
  s_movk_i32 s56, 0x1000
  v_lshlrev_b32 v73, 2, v76
  v_mov_b32 v72, 0
  s_mov_b64 s[16:17], s[8:9]
  s_mov_b32 s18, 268435456
  s_mov_b32 s19, 0x20000
  s_getpc_b64 s[20:21]
Cf0_pc:
  s_add_u32 s20, s20, (Cf0_last - Cf0_pc)
  s_addc_u32 s21, s21, 0
  v_mov_b32 v68, 14880
  buffer_load_dwordx4 v[52:55], v76, s[8:11], s59 offen offset:0 sc1
  buffer_load_dwordx4 v[56:59], v76, s[8:11], s59 offen offset:1024 sc1
  ds_read_b128 v[36:39], v76 offset:16384
  ds_read_b128 v[40:43], v76 offset:17408
  ds_read_b128 v[60:63], v76 offset:18432
  ds_read_b128 v[64:67], v76 offset:19456
  ds_read_b128 v[0:3], v76 offset:4608
  ds_read_b128 v[4:7], v76 offset:5632
  ds_read_b128 v[8:11], v76 offset:6656
  ds_read_b128 v[12:15], v76 offset:7680
  s_waitcnt lgkmcnt(0)
  s_cmp_eq_u32 s66, 1
  s_branch Cf0_top2
.p2align 6
Cf0_h2:
  s_cmp_eq_u32 s66, 12
  s_cselect_b32 s56, s71, 0x1000
  ds_read_b32 v72, v76 offset:16128
  s_cmp_eq_u32 s66, 13
  s_cselect_b32 s54, 0x700, 0
  s_waitcnt lgkmcnt(0)
  v_readfirstlane_b32 s57, v72
  s_nop 0
  s_cmp_lt_u32 s57, s54
  s_cbranch_scc1 Cf0_kv3
Cf0_kvb:
  buffer_load_dwordx4 v[0:3], v76, s[8:11], s65 offen offset:0 sc1
  ds_read_b128 v[36:39], v76 offset:16384
  s_waitcnt lgkmcnt(0)
  v_mov_b64 v[20:21], 0
  v_mov_b64 v[22:23], 0
  v_mov_b64 v[24:25], 0
  v_mov_b64 v[26:27], 0
  v_mov_b32 v68, 14880
  buffer_load_dwordx4 v[0:3], v76, s[8:11], s65 offen offset:0 sc1
  ds_read_b128 v[40:43], v76 offset:17408
  s_waitcnt lgkmcnt(0)
  s_cmp_eq_u32 s66, 62
  s_cselect_b64 s[16:17], s[20:21], s[16:17]
  s_cselect_b32 s18, (Cf0_done - Cf0_last), s18
  s_cselect_b32 s70, 0, s70
  s_cmp_eq_u32 s66, 63
  s_cselect_b32 s59, 268435456, s59
  s_cselect_b32 s58, 268435456, s58
  buffer_load_dwordx4 v[0:3], v76, s[8:11], s65 offen offset:0 sc1
  ds_read_b128 v[60:63], v76 offset:18432
  s_waitcnt lgkmcnt(0)
  v_lshlrev_b32 v73, 2, v76
  buffer_load_dwordx4 v[52:55], v76, s[8:11], s59 offen offset:0 sc1
  buffer_load_dwordx4 v[56:59], v76, s[8:11], s59 offen offset:1024 sc1
  s_waitcnt vmcnt(4)
  v_max3_u32 v72, v0, v1, v2
  v_max_u32 v72, v72, v3
  ds_write_b128 v76, v[0:3] offset:4608
  v_cmp_eq_u32 vcc, -1, v72
  s_cbranch_vccnz Cf0_h2r
Cf0_h2w:
  s_cmp_eq_u32 s66, 63
  s_waitcnt lgkmcnt(0)
  s_barrier
  ds_read_b128 v[8:11], v76 offset:6656
  buffer_load_dwordx4 v76, s[8:11], s85 offen offset:0 sc1 lds
Cf0_top2:
  v_smfmac_f32_16x16x64_bf16 v[20:23], v[0:3], v[80:87], v74
  s_cbranch_scc1 Cf0_last
  v_smfmac_f32_16x16x64_bf16 v[28:31], v[0:3], v[36:43], v74
  buffer_load_dwordx4 v[44:47], v76, s[8:11], s58 offen offset:0 sc1
  s_mov_b32 m0, 16128
  v_smfmac_f32_16x16x64_bf16 v[24:27], v[0:3], v[88:95], v74
  buffer_load_dwordx4 v[48:51], v76, s[8:11], s58 offen offset:1024 sc1
  v_smfmac_f32_16x16x64_bf16 v[32:35], v[0:3], v[60:67], v74
  ds_read_b128 v[4:7], v76 offset:5632
  s_waitcnt lgkmcnt(1)
  v_smfmac_f32_16x16x64_bf16 v[20:23], v[8:11], v[112:119], v74
  ds_read_b128 v[12:15], v76 offset:7680
  v_smfmac_f32_16x16x64_bf16 v[24:27], v[8:11], v[120:127], v74
  ds_read_b128 v[36:39], v76 offset:32768
  v_smfmac_f32_16x16x64_bf16 v[28:31], v[8:11], v[208:215], v74
  buffer_store_dwordx4 v[16:19], v76, s[8:11], s68 offen sc1
  ds_read_b128 v[40:43], v76 offset:33792
  v_smfmac_f32_16x16x64_bf16 v[32:35], v[8:11], v[216:223], v74
  buffer_load_dword v73, s[16:19], s70 offen lds
  ds_read_b128 v[60:63], v76 offset:34816
  s_waitcnt lgkmcnt(4)
  v_smfmac_f32_16x16x64_bf16 v[20:23], v[4:7], v[96:103], v74
  ds_read_b128 v[64:67], v76 offset:35840
  v_smfmac_f32_16x16x64_bf16 v[24:27], v[4:7], v[104:111], v74
  s_waitcnt vmcnt(5)
  s_waitcnt lgkmcnt(4)
  v_smfmac_f32_16x16x64_bf16 v[20:23], v[12:15], v[128:135], v74
  s_barrier
  ds_read_b128 v[0:3], v76 offset:8704
  s_waitcnt lgkmcnt(3)
  v_smfmac_f32_16x16x64_bf16 v[28:31], v[4:7], v[36:43], v74
  ds_read_b128 v[36:39], v76 offset:49152
  v_smfmac_f32_16x16x64_bf16 v[24:27], v[12:15], v[136:143], v74
  ds_read_b128 v[40:43], v76 offset:50176
  s_waitcnt lgkmcnt(3)
  v_smfmac_f32_16x16x64_bf16 v[32:35], v[4:7], v[60:67], v74
  ds_read_b128 v[8:11], v76 offset:9728
  v_smfmac_f32_16x16x64_bf16 v[28:31], v[12:15], v[224:231], v74
  ds_read_b128 v[60:63], v76 offset:51200
  v_smfmac_f32_16x16x64_bf16 v[32:35], v[12:15], v[232:239], v74
  s_waitcnt vmcnt(4)
  ds_read_b128 v[64:67], v76 offset:52224
  s_waitcnt lgkmcnt(5)
  v_smfmac_f32_16x16x64_bf16 v[20:23], v[0:3], v[144:151], v74
  s_barrier
  ds_read_b128 v[4:7], v76 offset:11776
  s_waitcnt lgkmcnt(4)
  v_smfmac_f32_16x16x64_bf16 v[28:31], v[0:3], v[36:43], v74
  ds_read_b128 v[12:15], v76 offset:12800
  ds_read_b128 v[36:39], v75 offset:0
  v_smfmac_f32_16x16x64_bf16 v[24:27], v[0:3], v[152:159], v74
  ds_read_b128 v[16:19], v76 offset:10752
  s_waitcnt lgkmcnt(6)
  v_smfmac_f32_16x16x64_bf16 v[20:23], v[8:11], v[160:167], v74
  ds_read_b128 v[40:43], v75 offset:1024
  s_waitcnt lgkmcnt(5)
  v_smfmac_f32_16x16x64_bf16 v[32:35], v[0:3], v[60:67], v74
  ds_read_b128 v[60:63], v75 offset:2048
  v_smfmac_f32_16x16x64_bf16 v[24:27], v[8:11], v[168:175], v74
  ds_read_b128 v[64:67], v75 offset:3072
  s_waitcnt lgkmcnt(6)
  v_smfmac_f32_16x16x64_bf16 v[20:23], v[4:7], v[176:183], v74
  buffer_load_dword off, s[12:15], s56 sc1 lds
  s_waitcnt lgkmcnt(5)
  v_smfmac_f32_16x16x64_bf16 v[20:23], v[12:15], v[192:199], v74
  s_waitcnt lgkmcnt(2)
  v_smfmac_f32_16x16x64_bf16 v[20:23], v[16:19], v[36:43], v74
  ds_read_b128 v[36:39], v75 offset:16384
  v_smfmac_f32_16x16x64_bf16 v[24:27], v[4:7], v[184:191], v74
  ds_read_b128 v[40:43], v75 offset:17408
  s_waitcnt lgkmcnt(2)
  v_smfmac_f32_16x16x64_bf16 v[24:27], v[16:19], v[60:67], v74
  ds_read_b128 v[60:63], v75 offset:18432
  v_add_f32 v20, v20, v22
  v_smfmac_f32_16x16x64_bf16 v[24:27], v[12:15], v[200:207], v74
  ds_read_b128 v[64:67], v75 offset:19456
  v_add_f32 v21, v21, v23
  v_smfmac_f32_16x16x64_bf16 v[28:31], v[16:19], v[240:247], v74
  v_mov_b64 v[70:71], s[78:79]
  v_smfmac_f32_16x16x64_bf16 v[28:31], v[4:7], a[0:7], v74
  s_waitcnt lgkmcnt(2)
  v_add_f32 v24, v24, v26
  v_smfmac_f32_16x16x64_bf16 v[28:31], v[8:11], v[36:43], v74
  ds_read_b128 v[36:39], v68
  v_cvt_pk_bf16_f32 v22, v20, v24
  v_smfmac_f32_16x16x64_bf16 v[28:31], v[12:15], a[16:23], v74
  ds_read_b128 v[40:43], v68
  ds_write_b32 v79, v22 offset:0
  s_waitcnt lgkmcnt(3)
  v_add_f32 v25, v25, v27
  v_cvt_pk_bf16_f32 v23, v21, v25
  v_smfmac_f32_16x16x64_bf16 v[32:35], v[8:11], v[60:67], v74
  ds_write_b32 v79, v23 offset:576
  v_cmp_u_f32 vcc, v20, v21
  v_smfmac_f32_16x16x64_bf16 v[32:35], v[16:19], v[248:255], v74
  v_add_f32 v28, v28, v30
  v_smfmac_f32_16x16x64_bf16 v[32:35], v[4:7], a[8:15], v74
  v_add_f32 v29, v29, v31
  v_smfmac_f32_16x16x64_bf16 v[32:35], v[12:15], a[24:31], v74
  s_cbranch_vccnz Cf0_rec
Cf0_recok:
  s_waitcnt lgkmcnt(3)
  v_smfmac_f32_16x16x64_bf16 v[36:39], v[16:19], a[128:135], v74
  s_waitcnt lgkmcnt(0)
  s_barrier
  ds_read_b128 v[60:63], v77
  v_smfmac_f32_16x16x64_bf16 v[40:43], v[16:19], a[136:143], v74
  ds_read_b128 v[64:67], v77 offset:128
  v_add_f32 v32, v32, v34
  v_cvt_pk_bf16_f32 v30, v28, v32
  v_smfmac_f32_16x16x64_bf16 v[36:39], v[0:3], a[96:103], v74
  ds_write_b32 v79, v30 offset:256
  v_add_f32 v33, v33, v35
  v_cvt_pk_bf16_f32 v31, v29, v33
  v_smfmac_f32_16x16x64_bf16 v[40:43], v[0:3], a[104:111], v74
  ds_write_b32 v79, v31 offset:832
  v_xor_b32 v75, 0x8000, v75
  v_smfmac_f32_16x16x64_bf16 v[36:39], v[4:7], a[144:151], v74
  ds_read_b128 v[0:3], v76 offset:4608
  v_mov_b32 v29, 0
  v_smfmac_f32_16x16x64_bf16 v[40:43], v[4:7], a[152:159], v74
  s_waitcnt vmcnt(3) lgkmcnt(3)
  v_mov_b32 v30, 0
  v_mfma_f32_16x16x32_bf16 v[44:47], v[44:47], v[60:63], 0
  ds_read_b128 v[4:7], v76 offset:5632
  s_waitcnt lgkmcnt(2)
  v_mfma_f32_16x16x32_bf16 v[44:47], v[48:51], v[64:67], v[44:47]
  s_barrier
  v_smfmac_f32_16x16x64_bf16 v[36:39], v[8:11], a[112:119], v74
  ds_read_b128 v[20:23], v77 offset:256
  ds_read_b128 v[24:27], v77 offset:384
  v_smfmac_f32_16x16x64_bf16 v[40:43], v[8:11], a[120:127], v74
  ds_read_b128 v[8:11], v76 offset:6656
  v_add_f32_dpp v72, v46, v44 quad_perm:[2,3,0,1] row_mask:0xf bank_mask:0xf
  v_add_f32_dpp v73, v47, v45 quad_perm:[2,3,0,1] row_mask:0xf bank_mask:0xf
  v_smfmac_f32_16x16x64_bf16 v[36:39], v[12:15], a[160:167], v74
  s_waitcnt lgkmcnt(4)
  v_exp_f32_dpp v72, v72 quad_perm:[0,1,0,1] row_mask:0xf bank_mask:0xf
  v_smfmac_f32_16x16x64_bf16 v[40:43], v[12:15], a[168:175], v74
  ds_read_b128 v[12:15], v76 offset:7680
  v_exp_f32_dpp v73, v73 quad_perm:[0,1,0,1] row_mask:0xf bank_mask:0xf
  v_smfmac_f32_16x16x64_bf16 v[36:39], v[0:3], a[32:39], v74
  s_waitcnt lgkmcnt(2)
  v_cvt_pk_bf16_f32 v72, v72, v73
  v_mfma_f32_16x16x32_bf16 v[20:23], v[20:23], v[60:63], 0
  ds_write_b32 v78, v72 offset:512
  v_mov_b64 v[16:17], 0
  v_mfma_f32_16x16x32_bf16 v[20:23], v[24:27], v[64:67], v[20:23]
  ds_read_b128 v[44:47], v75 offset:16384
  v_mov_b64 v[18:19], 0
  v_smfmac_f32_16x16x64_bf16 v[40:43], v[0:3], a[40:47], v74
  ds_read_b128 v[48:51], v75 offset:17408
  v_mov_b64 v[68:69], s[78:79]
  v_smfmac_f32_16x16x64_bf16 v[36:39], v[4:7], a[48:55], v74
  s_waitcnt lgkmcnt(4)
  v_add_f32_dpp v24, v22, v20 quad_perm:[2,3,0,1] row_mask:0xf bank_mask:0xf
  v_add_f32_dpp v25, v23, v21 quad_perm:[2,3,0,1] row_mask:0xf bank_mask:0xf
  v_smfmac_f32_16x16x64_bf16 v[36:39], v[8:11], a[64:71], v74
  s_waitcnt lgkmcnt(2)
  s_barrier
  ds_read_b128 v[32:35], v78 offset:512
  v_smfmac_f32_16x16x64_bf16 v[36:39], v[12:15], a[80:87], v74
  ds_read_b128 v[60:63], v75 offset:18432
  v_mul_f32 v24, s69, v24
  v_smfmac_f32_16x16x64_bf16 v[40:43], v[4:7], a[56:63], v74
  ds_read_b128 v[64:67], v75 offset:19456
  v_mul_f32 v25, s69, v25
  v_smfmac_f32_16x16x64_bf16 v[40:43], v[8:11], a[72:79], v74
  v_exp_f32_dpp v24, v24 quad_perm:[0,1,0,1] row_mask:0xf bank_mask:0xf
  v_smfmac_f32_16x16x64_bf16 v[40:43], v[12:15], a[88:95], v74
  s_waitcnt lgkmcnt(2)
  v_exp_f32_dpp v25, v25 quad_perm:[0,1,0,1] row_mask:0xf bank_mask:0xf
  v_mfma_f32_16x16x32_bf16 v[8:11], v[32:35], v[68:71], 0
  v_add_f32 v36, v36, v38
  v_add_f32 v37, v37, v39
  v_mfma_f32_16x16x32_bf16 v[0:3], v[32:35], v[52:55], 0
  v_add_f32 v40, v40, v42
  v_add_f32 v41, v41, v43
  v_mfma_f32_16x16x32_bf16 v[4:7], v[32:35], v[56:59], 0
  v_cvt_pk_bf16_f32 v28, v24, v25
  v_cvt_pk_bf16_f32 v72, v36, v37
  v_cvt_pk_bf16_f32 v73, v40, v41
  v_mfma_f32_16x16x16_bf16 v[8:11], v[28:29], v[68:69], v[8:11]
  v_cvt_pk_bf16_f32 v31, v24, v25
  v_mov_b64 v[20:21], 0
  v_mfma_f32_16x16x16_bf16 v[0:3], v[28:29], v[72:73], v[0:3]
  ds_read_b128 v[52:55], v75 offset:32768
  v_mov_b64 v[22:23], 0
  v_mfma_f32_16x16x16_bf16 v[4:7], v[30:31], v[72:73], v[4:7]
  v_rcp_f32 v10, v8
  v_rcp_f32 v11, v9
  v_mul_f32 v0, v10, v0
  v_mul_f32 v1, v11, v1
  v_max3_f32 v8, v8, v9, v10
  v_mul_f32 v4, v10, v4
  v_mul_f32 v5, v11, v5
  v_cvt_pk_bf16_f32 v2, v0, v4
  ds_write_b32 v79, v2 offset:8704
  v_cvt_pk_bf16_f32 v3, v1, v5
  ds_write_b32 v79, v3 offset:9280
  ds_read_b128 v[12:15], v78 offset:8704
  v_max_f32 v8, v8, v11
  v_cmp_le_f32 vcc, 1317011456, v8
  v_mov_b64 v[24:25], 0
  v_mov_b64 v[26:27], 0
  ds_read_b128 v[56:59], v75 offset:33792
  s_cbranch_vccnz Cf0_mx
Cf0_mxok:
  s_waitcnt lgkmcnt(2)
  s_barrier
  ds_read_b128 v[0:3], v78 offset:8768
  s_waitcnt lgkmcnt(2)
  v_smfmac_f32_16x16x64_bf16 v[16:19], v[12:15], v[44:51], v74
  ds_read_b128 v[4:7], v78 offset:8832
  v_smfmac_f32_16x16x64_bf16 v[20:23], v[12:15], a[192:199], v74
  ds_read_b128 v[8:11], v78 offset:8896
  v_smfmac_f32_16x16x64_bf16 v[24:27], v[12:15], a[208:215], v74
  ds_read_b128 v[36:39], v75 offset:34816
  s_waitcnt lgkmcnt(3)
  v_smfmac_f32_16x16x64_bf16 v[16:19], v[0:3], v[60:67], v74
  ds_read_b128 v[40:43], v75 offset:35840
  s_waitcnt lgkmcnt(3)
  v_smfmac_f32_16x16x64_bf16 v[16:19], v[4:7], a[176:183], v74
  ds_read_b128 v[68:71], v76 offset:13824
  s_waitcnt lgkmcnt(3)
  v_smfmac_f32_16x16x64_bf16 v[16:19], v[8:11], a[184:191], v74
  ds_read_b128 v[44:47], v75 offset:49152
  v_smfmac_f32_16x16x64_bf16 v[20:23], v[0:3], a[200:207], v74
  ds_read_b128 v[48:51], v75 offset:50176
  v_smfmac_f32_16x16x64_bf16 v[20:23], v[4:7], v[52:59], v74
  ds_read_b128 v[60:63], v75 offset:51200
  s_waitcnt lgkmcnt(4)
  v_cvt_pk_bf16_f32 v16, v16, v17
  v_cvt_pk_bf16_f32 v17, v18, v19
  v_bfi_b32 v16, 1, s72, v16
  v_smfmac_f32_16x16x64_bf16 v[20:23], v[8:11], v[36:43], v74
  s_waitcnt lgkmcnt(3)
  buffer_store_dwordx2 v[16:17], v68, s[8:11], s73 offen
  v_mov_b64 v[32:33], 0
  v_smfmac_f32_16x16x64_bf16 v[24:27], v[0:3], a[216:223], v74
  ds_read_b128 v[64:67], v75 offset:52224
  v_mov_b64 v[34:35], 0
  v_smfmac_f32_16x16x64_bf16 v[24:27], v[4:7], a[224:231], v74
  v_cvt_pk_bf16_f32 v20, v20, v21
  v_cvt_pk_bf16_f32 v21, v22, v23
  v_bfi_b32 v20, 1, s72, v20
  v_smfmac_f32_16x16x64_bf16 v[24:27], v[8:11], a[232:239], v74
  buffer_store_dwordx2 v[20:21], v68, s[8:11], s74 offen
  s_waitcnt lgkmcnt(2)
  v_smfmac_f32_16x16x64_bf16 v[32:35], v[12:15], v[44:51], v74
  s_waitcnt lgkmcnt(0)
  v_smfmac_f32_16x16x64_bf16 v[32:35], v[0:3], v[60:67], v74
  v_cvt_pk_bf16_f32 v24, v24, v25
  v_cvt_pk_bf16_f32 v25, v26, v27
  v_bfi_b32 v24, 1, s72, v24
  v_smfmac_f32_16x16x64_bf16 v[32:35], v[4:7], a[240:247], v74
  buffer_store_dwordx2 v[24:25], v68, s[8:11], s75 offen
  v_smfmac_f32_16x16x64_bf16 v[32:35], v[8:11], a[248:255], v74
  v_mov_b64 v[18:19], v[72:73]
  s_nop 4
  v_cvt_pk_bf16_f32 v32, v32, v33
  v_cvt_pk_bf16_f32 v33, v34, v35
  v_bfi_b32 v32, 1, s72, v32
  buffer_store_dwordx2 v[32:33], v68, s[8:11], s76 offen
  ds_read_b128 v[0:3], v76 offset:14848
  s_waitcnt lgkmcnt(0)
  ds_read_b64 v[16:17], v77 offset:256
  s_waitcnt lgkmcnt(0)
  ds_read_b128 v[64:67], v76 offset:19456
  s_waitcnt lgkmcnt(0)
  v_xor_b32 v75, 0x8000, v75
  v_mov_b64 v[28:29], 0
  v_mov_b64 v[30:31], 0
  v_mov_b64 v[32:33], 0
  v_mov_b64 v[34:35], 0
  buffer_load_dwordx4 v[52:55], v76, s[8:11], s60 offen offset:0 sc1
  buffer_load_dwordx4 v[56:59], v76, s[8:11], s60 offen offset:1024 sc1
  s_add_u32 s66, s66, 1
  s_xor_b32 s64, s64, 16384
  s_xor_b32 s65, s65, 16384
  s_add_u32 s58, s58, 655360
  s_add_u32 s59, s59, 655360
  s_add_u32 s70, s70, 655360
  s_add_u32 s68, s68, 655360
  s_mov_b32 m0, 10752
  s_add_u32 s85, s65, 6144
  s_waitcnt lgkmcnt(0)
  s_waitcnt vmcnt(1)
  v_mfma_f32_16x16x32_bf16 v[4:7], v[0:3], v[52:55], 0
  v_bitop3_b32 v72, v52, v54, s72 bitop3:0x7e
  s_waitcnt vmcnt(0)
  v_mfma_f32_16x16x32_bf16 v[4:7], v[0:3], v[56:59], v[4:7]
  v_bitop3_b32 v73, v56, v58, s72 bitop3:0x7e
  v_bitop3_b32 v72, v72, v73, 1 bitop3:0xa8
  v_cmp_ne_u32 vcc, 0, v72
  s_nop 3
  v_add_f32_dpp v4, v4, v4 row_ror:4 row_mask:0xf bank_mask:0xf
  v_add_f32_dpp v5, v5, v5 row_ror:4 row_mask:0xf bank_mask:0xf
  s_cmp_eq_u64 vcc, 0
  v_add_f32_dpp v4, v4, v4 row_ror:8 row_mask:0xf bank_mask:0xf
  v_add_f32_dpp v5, v5, v5 row_ror:8 row_mask:0xf bank_mask:0xf
  s_cselect_b32 s54, s62, 268435456
  v_cvt_pk_bf16_f32 v4, v4, v5
  buffer_store_dword v4, v69, s[8:11], s54 offen
  s_cbranch_vccnz Cf0_h1r
  s_xor_b32 s62, s62, 16384
  buffer_store_dword v71, v69, s[8:11], s62 offen
  s_xor_b32 s72, s72, 1
  s_branch Cf0_h2
Cf0_h1r:
  s_mov_b64 exec, vcc
  buffer_load_dwordx4 v[52:55], v76, s[8:11], s60 offen offset:0 sc1
  buffer_load_dwordx4 v[56:59], v76, s[8:11], s60 offen offset:1024 sc1
  s_mov_b64 exec, -1
  s_add_u32 s67, s67, 1
  s_waitcnt vmcnt(1)
  v_mfma_f32_16x16x32_bf16 v[4:7], v[0:3], v[52:55], 0
  v_bitop3_b32 v72, v52, v54, s72 bitop3:0x7e
  s_waitcnt vmcnt(0)
  v_mfma_f32_16x16x32_bf16 v[4:7], v[0:3], v[56:59], v[4:7]
  v_bitop3_b32 v73, v56, v58, s72 bitop3:0x7e
  v_bitop3_b32 v72, v72, v73, 1 bitop3:0xa8
  v_cmp_ne_u32 vcc, 0, v72
  s_cbranch_vccz Cf0_h1p
Cf0_h1s:
  s_mov_b64 exec, vcc
  buffer_load_dwordx4 v[52:55], v76, s[8:11], s60 offen offset:0 sc1
  buffer_load_dwordx4 v[56:59], v76, s[8:11], s60 offen offset:1024 sc1
  s_mov_b64 exec, -1
  s_add_u32 s67, s67, 1
  s_waitcnt vmcnt(1)
  v_mfma_f32_16x16x32_bf16 v[4:7], v[0:3], v[52:55], 0
  v_bitop3_b32 v72, v52, v54, s72 bitop3:0x7e
  s_waitcnt vmcnt(0)
  v_mfma_f32_16x16x32_bf16 v[4:7], v[0:3], v[56:59], v[4:7]
  v_bitop3_b32 v73, v56, v58, s72 bitop3:0x7e
  v_bitop3_b32 v72, v72, v73, 1 bitop3:0xa8
  v_cmp_ne_u32 vcc, 0, v72
  s_cbranch_vccz Cf0_h1p
  s_cmp_lt_u32 s67, 131072
  s_cbranch_scc1 Cf0_h1s
Cf0_h1p:
  s_nop 2
  v_add_f32_dpp v4, v4, v4 row_ror:4 row_mask:0xf bank_mask:0xf
  v_add_f32_dpp v5, v5, v5 row_ror:4 row_mask:0xf bank_mask:0xf
  s_nop 0
  v_add_f32_dpp v4, v4, v4 row_ror:8 row_mask:0xf bank_mask:0xf
  v_add_f32_dpp v5, v5, v5 row_ror:8 row_mask:0xf bank_mask:0xf
  v_cvt_pk_bf16_f32 v4, v4, v5
  buffer_store_dword v4, v69, s[8:11], s62 offen
  s_xor_b32 s62, s62, 16384
  buffer_store_dword v71, v69, s[8:11], s62 offen
  s_xor_b32 s72, s72, 1
  s_branch Cf0_h2
Cf0_h2r:
  s_mov_b64 exec, vcc
  buffer_load_dwordx4 v[0:3], v76, s[8:11], s65 offen offset:0 sc1
  s_mov_b64 exec, -1
  s_add_u32 s67, s67, 1
  s_waitcnt vmcnt(4)
  v_max3_u32 v72, v0, v1, v2
  v_max_u32 v72, v72, v3
  ds_write_b128 v76, v[0:3] offset:4608
  v_cmp_eq_u32 vcc, -1, v72
  s_cbranch_vccz Cf0_h2w
  s_mov_b64 exec, vcc
  buffer_load_dwordx4 v[0:3], v76, s[8:11], s65 offen offset:0 sc1
  s_mov_b64 exec, -1
  s_add_u32 s67, s67, 1
  s_waitcnt vmcnt(4)
  v_max3_u32 v72, v0, v1, v2
  v_max_u32 v72, v72, v3
  ds_write_b128 v76, v[0:3] offset:4608
  v_cmp_eq_u32 vcc, -1, v72
  s_cbranch_vccz Cf0_h2w
Cf0_h2s:
  s_mov_b64 exec, vcc
  buffer_load_dwordx4 v[0:3], v76, s[8:11], s65 offen offset:0 sc1
  s_mov_b64 exec, -1
  s_add_u32 s67, s67, 1
  s_waitcnt vmcnt(2)
  v_max3_u32 v72, v0, v1, v2
  v_max_u32 v72, v72, v3
  ds_write_b128 v76, v[0:3] offset:4608
  v_cmp_eq_u32 vcc, -1, v72
  s_cbranch_vccz Cf0_h2w
  s_mov_b64 exec, vcc
  buffer_load_dwordx4 v[0:3], v76, s[8:11], s65 offen offset:0 sc1
  s_mov_b64 exec, -1
  s_add_u32 s67, s67, 1
  s_waitcnt vmcnt(2)
  v_max3_u32 v72, v0, v1, v2
  v_max_u32 v72, v72, v3
  ds_write_b128 v76, v[0:3] offset:4608
  v_cmp_eq_u32 vcc, -1, v72
  s_cbranch_vccz Cf0_h2w
  s_mov_b64 exec, vcc
  buffer_load_dwordx4 v[0:3], v76, s[8:11], s65 offen offset:0 sc1
  s_mov_b64 exec, -1
  s_add_u32 s67, s67, 1
  s_waitcnt vmcnt(2)
  v_max3_u32 v72, v0, v1, v2
  v_max_u32 v72, v72, v3
  ds_write_b128 v76, v[0:3] offset:4608
  v_cmp_eq_u32 vcc, -1, v72
  s_cbranch_vccz Cf0_h2w
  s_cmp_lt_u32 s67, 131072
  s_cbranch_scc1 Cf0_h2s
  s_branch Cf0_h2w
Cf0_rec:
  s_nop 7
  s_waitcnt vmcnt(0) lgkmcnt(0)
  v_max3_u32 v72, v0, v1, v2
  v_max3_u32 v72, v72, v3, v4
  v_max3_u32 v72, v72, v5, v6
  v_max3_u32 v72, v72, v7, v8
  v_max3_u32 v72, v72, v9, v10
  v_max3_u32 v72, v72, v11, v12
  v_max3_u32 v72, v72, v13, v14
  v_max3_u32 v72, v72, v15, v16
  v_max3_u32 v72, v72, v17, v18
  v_max_u32 v72, v72, v19
  v_cmp_eq_u32 vcc, -1, v72
  s_cbranch_vccz Cf0_recok
  s_barrier
  v_mov_b64 v[20:21], 0
  v_mov_b64 v[22:23], 0
  v_mov_b64 v[24:25], 0
  v_mov_b64 v[26:27], 0
  v_mov_b64 v[28:29], 0
  v_mov_b64 v[30:31], 0
  v_mov_b64 v[32:33], 0
  v_mov_b64 v[34:35], 0
  s_waitcnt lgkmcnt(0)
  s_barrier
  ds_read_b128 v[0:3], v76 offset:4608
  s_waitcnt lgkmcnt(0)
  v_smfmac_f32_16x16x64_bf16 v[20:23], v[0:3], v[80:87], v74
  v_smfmac_f32_16x16x64_bf16 v[24:27], v[0:3], v[88:95], v74
  ds_read_b128 v[60:63], v76 offset:16384
  ds_read_b128 v[64:67], v76 offset:17408
  s_waitcnt lgkmcnt(0)
  v_smfmac_f32_16x16x64_bf16 v[28:31], v[0:3], v[60:67], v74
  ds_read_b128 v[60:63], v76 offset:18432
  ds_read_b128 v[64:67], v76 offset:19456
  s_waitcnt lgkmcnt(0)
  v_smfmac_f32_16x16x64_bf16 v[32:35], v[0:3], v[60:67], v74
  ds_read_b128 v[4:7], v76 offset:5632
  s_waitcnt lgkmcnt(0)
  v_smfmac_f32_16x16x64_bf16 v[20:23], v[4:7], v[96:103], v74
  v_smfmac_f32_16x16x64_bf16 v[24:27], v[4:7], v[104:111], v74
  ds_read_b128 v[60:63], v76 offset:32768
  ds_read_b128 v[64:67], v76 offset:33792
  s_waitcnt lgkmcnt(0)
  v_smfmac_f32_16x16x64_bf16 v[28:31], v[4:7], v[60:67], v74
  ds_read_b128 v[60:63], v76 offset:34816
  ds_read_b128 v[64:67], v76 offset:35840
  s_waitcnt lgkmcnt(0)
  v_smfmac_f32_16x16x64_bf16 v[32:35], v[4:7], v[60:67], v74
  ds_read_b128 v[8:11], v76 offset:6656
  s_waitcnt lgkmcnt(0)
  v_smfmac_f32_16x16x64_bf16 v[20:23], v[8:11], v[112:119], v74
  v_smfmac_f32_16x16x64_bf16 v[24:27], v[8:11], v[120:127], v74
  v_smfmac_f32_16x16x64_bf16 v[28:31], v[8:11], v[208:215], v74
  v_smfmac_f32_16x16x64_bf16 v[32:35], v[8:11], v[216:223], v74
  ds_read_b128 v[12:15], v76 offset:7680
  s_waitcnt lgkmcnt(0)
  v_smfmac_f32_16x16x64_bf16 v[20:23], v[12:15], v[128:135], v74
  v_smfmac_f32_16x16x64_bf16 v[24:27], v[12:15], v[136:143], v74
  v_smfmac_f32_16x16x64_bf16 v[28:31], v[12:15], v[224:231], v74
  v_smfmac_f32_16x16x64_bf16 v[32:35], v[12:15], v[232:239], v74
  ds_read_b128 v[0:3], v76 offset:8704
  s_waitcnt lgkmcnt(0)
  v_smfmac_f32_16x16x64_bf16 v[20:23], v[0:3], v[144:151], v74
  v_smfmac_f32_16x16x64_bf16 v[24:27], v[0:3], v[152:159], v74
  ds_read_b128 v[60:63], v76 offset:49152
  ds_read_b128 v[64:67], v76 offset:50176
  s_waitcnt lgkmcnt(0)
  v_smfmac_f32_16x16x64_bf16 v[28:31], v[0:3], v[60:67], v74
  ds_read_b128 v[60:63], v76 offset:51200
  ds_read_b128 v[64:67], v76 offset:52224
  s_waitcnt lgkmcnt(0)
  v_smfmac_f32_16x16x64_bf16 v[32:35], v[0:3], v[60:67], v74
  ds_read_b128 v[8:11], v76 offset:9728
  s_waitcnt lgkmcnt(0)
  v_smfmac_f32_16x16x64_bf16 v[20:23], v[8:11], v[160:167], v74
  v_smfmac_f32_16x16x64_bf16 v[24:27], v[8:11], v[168:175], v74
  ds_read_b128 v[60:63], v75 offset:16384
  ds_read_b128 v[64:67], v75 offset:17408
  s_waitcnt lgkmcnt(0)
  v_smfmac_f32_16x16x64_bf16 v[28:31], v[8:11], v[60:67], v74
  ds_read_b128 v[60:63], v75 offset:18432
  ds_read_b128 v[64:67], v75 offset:19456
  s_waitcnt lgkmcnt(0)
  v_smfmac_f32_16x16x64_bf16 v[32:35], v[8:11], v[60:67], v74
  ds_read_b128 v[16:19], v76 offset:10752
  ds_read_b128 v[60:63], v75 offset:0
  ds_read_b128 v[64:67], v75 offset:1024
  s_waitcnt lgkmcnt(0)
  v_smfmac_f32_16x16x64_bf16 v[20:23], v[16:19], v[60:67], v74
  ds_read_b128 v[60:63], v75 offset:2048
  ds_read_b128 v[64:67], v75 offset:3072
  s_waitcnt lgkmcnt(0)
  v_smfmac_f32_16x16x64_bf16 v[24:27], v[16:19], v[60:67], v74
  v_smfmac_f32_16x16x64_bf16 v[28:31], v[16:19], v[240:247], v74
  v_smfmac_f32_16x16x64_bf16 v[32:35], v[16:19], v[248:255], v74
  ds_read_b128 v[4:7], v76 offset:11776
  s_waitcnt lgkmcnt(0)
  v_smfmac_f32_16x16x64_bf16 v[20:23], v[4:7], v[176:183], v74
  v_smfmac_f32_16x16x64_bf16 v[24:27], v[4:7], v[184:191], v74
  v_smfmac_f32_16x16x64_bf16 v[28:31], v[4:7], a[0:7], v74
  v_smfmac_f32_16x16x64_bf16 v[32:35], v[4:7], a[8:15], v74
  ds_read_b128 v[12:15], v76 offset:12800
  s_waitcnt lgkmcnt(0)
  v_smfmac_f32_16x16x64_bf16 v[20:23], v[12:15], v[192:199], v74
  v_smfmac_f32_16x16x64_bf16 v[24:27], v[12:15], v[200:207], v74
  v_smfmac_f32_16x16x64_bf16 v[28:31], v[12:15], a[16:23], v74
  v_smfmac_f32_16x16x64_bf16 v[32:35], v[12:15], a[24:31], v74
  v_add_f32 v20, v20, v22
  v_add_f32 v21, v21, v23
  v_add_f32 v24, v24, v26
  v_cvt_pk_bf16_f32 v22, v20, v24
  ds_write_b32 v79, v22 offset:0
  v_add_f32 v25, v25, v27
  v_cvt_pk_bf16_f32 v23, v21, v25
  ds_write_b32 v79, v23 offset:576
  v_add_f32 v28, v28, v30
  v_add_f32 v29, v29, v31
  s_waitcnt lgkmcnt(0)
  s_nop 1
  s_branch Cf0_recok
Cf0_mx:
  s_waitcnt lgkmcnt(0)
  s_barrier
  buffer_load_dwordx4 v[52:55], v76, s[8:11], s59 offen offset:0 sc1
  buffer_load_dwordx4 v[0:3], v76, s[8:11], s58 offen offset:0 sc1
  ds_read_b128 v[20:23], v77 offset:0
  ds_read_b128 v[28:31], v77 offset:256
  buffer_load_dwordx4 v[56:59], v76, s[8:11], s59 offen offset:1024 sc1
  buffer_load_dwordx4 v[4:7], v76, s[8:11], s58 offen offset:1024 sc1
  ds_read_b128 v[24:27], v77 offset:128
  ds_read_b128 v[32:35], v77 offset:384
  s_waitcnt vmcnt(2) lgkmcnt(3)
  v_mfma_f32_16x16x32_bf16 v[8:11], v[0:3], v[20:23], 0
  s_waitcnt vmcnt(0) lgkmcnt(1)
  v_mfma_f32_16x16x32_bf16 v[8:11], v[4:7], v[24:27], v[8:11]
  v_mfma_f32_16x16x32_bf16 v[12:15], v[28:31], v[20:23], 0
  s_waitcnt lgkmcnt(0)
  v_mfma_f32_16x16x32_bf16 v[12:15], v[32:35], v[24:27], v[12:15]
  v_add_f32_dpp v8, v10, v8 quad_perm:[2,3,0,1] row_mask:0xf bank_mask:0xf
  v_add_f32_dpp v9, v11, v9 quad_perm:[2,3,0,1] row_mask:0xf bank_mask:0xf
  s_nop 0
  v_mov_b32_dpp v8, v8 quad_perm:[0,1,0,1] row_mask:0xf bank_mask:0xf
  v_mov_b32_dpp v9, v9 quad_perm:[0,1,0,1] row_mask:0xf bank_mask:0xf
  s_nop 1
  v_add_f32_dpp v12, v14, v12 quad_perm:[2,3,0,1] row_mask:0xf bank_mask:0xf
  v_add_f32_dpp v13, v15, v13 quad_perm:[2,3,0,1] row_mask:0xf bank_mask:0xf
  s_nop 0
  v_mov_b32_dpp v12, v12 quad_perm:[0,1,0,1] row_mask:0xf bank_mask:0xf
  v_mov_b32_dpp v13, v13 quad_perm:[0,1,0,1] row_mask:0xf bank_mask:0xf
  v_mul_f32 v12, s69, v12
  ds_write_b32 v78, v8 offset:8704
  v_mul_f32 v13, s69, v13
  ds_write_b32 v78, v9 offset:8768
  s_waitcnt lgkmcnt(0)
  s_barrier
  ds_read_b128 v[36:39], v78 offset:8704
  ds_read_b128 v[40:43], v78 offset:8768
  s_waitcnt lgkmcnt(0)
  s_barrier
  v_max_f32 v16, v36, v37
  v_max3_f32 v16, v16, v38, v39
  v_max3_f32 v16, v16, v40, v41
  v_max3_f32 v16, v16, v42, v43
  v_max3_f32 v16, v16, v12, v13
  v_mov_b32 v17, v16
  s_nop 1
  v_permlane16_swap_b32 v16, v17
  v_max_f32 v16, v16, v17
  v_mov_b32 v17, v16
  s_nop 1
  v_permlane32_swap_b32 v16, v17
  v_max_f32 v16, v16, v17
  v_sub_f32 v36, v36, v16
  v_sub_f32 v37, v37, v16
  v_sub_f32 v38, v38, v16
  v_sub_f32 v39, v39, v16
  v_sub_f32 v40, v40, v16
  v_sub_f32 v41, v41, v16
  v_sub_f32 v42, v42, v16
  v_sub_f32 v43, v43, v16
  v_sub_f32 v12, v12, v16
  v_sub_f32 v13, v13, v16
  v_exp_f32 v36, v36
  v_exp_f32 v37, v37
  v_exp_f32 v38, v38
  v_exp_f32 v39, v39
  v_exp_f32 v40, v40
  v_exp_f32 v41, v41
  v_exp_f32 v42, v42
  v_exp_f32 v43, v43
  v_exp_f32 v12, v12
  v_exp_f32 v13, v13
  v_cvt_pk_bf16_f32 v32, v36, v40
  v_cvt_pk_bf16_f32 v33, v37, v41
  v_cvt_pk_bf16_f32 v34, v38, v42
  v_cvt_pk_bf16_f32 v35, v39, v43
  v_cvt_pk_bf16_f32 v28, v12, v13
  v_cvt_pk_bf16_f32 v31, v12, v13
  v_mov_b32 v29, 0
  v_mov_b32 v30, 0
  v_mfma_f32_16x16x32_bf16 v[8:11], v[32:35], v[68:71], 0
  v_mfma_f32_16x16x32_bf16 v[0:3], v[32:35], v[52:55], 0
  v_mfma_f32_16x16x32_bf16 v[4:7], v[32:35], v[56:59], 0
  v_mfma_f32_16x16x16_bf16 v[8:11], v[28:29], v[68:69], v[8:11]
  v_mfma_f32_16x16x16_bf16 v[0:3], v[28:29], v[72:73], v[0:3]
  v_mfma_f32_16x16x16_bf16 v[4:7], v[30:31], v[72:73], v[4:7]
  ds_read_b128 v[52:55], v75 offset:32768
  v_rcp_f32 v10, v8
  v_rcp_f32 v11, v9
  v_mul_f32 v0, v10, v0
  v_mul_f32 v1, v11, v1
  v_max3_f32 v8, v8, v9, v10
  v_mul_f32 v4, v10, v4
  v_mul_f32 v5, v11, v5
  v_cvt_pk_bf16_f32 v2, v0, v4
  ds_write_b32 v79, v2 offset:8704
  v_cvt_pk_bf16_f32 v3, v1, v5
  ds_write_b32 v79, v3 offset:9280
  ds_read_b128 v[12:15], v78 offset:8704
  ds_read_b128 v[56:59], v75 offset:33792
  v_mov_b64 v[16:17], 0
  v_mov_b64 v[18:19], 0
  v_mov_b64 v[20:21], 0
  v_mov_b64 v[22:23], 0
  v_mov_b64 v[24:25], 0
  v_mov_b64 v[26:27], 0
  s_branch Cf0_mxok
Cf0_kv3:
  s_waitcnt lgkmcnt(0)
  s_cmp_ge_u32 s57, 0x700
  s_cbranch_scc1 Cf0_kvb
  s_load_dword s57, s[12:13], s71 glc
  s_add_u32 s67, s67, 1
  s_cmp_lt_u32 s67, 131072
  s_cbranch_scc1 Cf0_kv3
  s_waitcnt lgkmcnt(0)
  s_branch Cf0_kvb
Cf0_last:
  ds_read_b128 v[4:7], v76 offset:5632
  ds_read_b128 v[12:15], v76 offset:7680
  ds_read_b128 v[44:47], v76 offset:32768
  ds_read_b128 v[48:51], v76 offset:33792
  s_nop 5
  v_mov_b64 v[20:21], 0
  v_mov_b64 v[22:23], 0
  v_mov_b64 v[24:25], 0
  v_mov_b64 v[26:27], 0
  v_smfmac_f32_16x16x64_bf16 v[28:31], v[0:3], v[36:43], v74
  ds_read_b128 v[36:39], v76 offset:34816
  ds_read_b128 v[40:43], v76 offset:35840
  v_smfmac_f32_16x16x64_bf16 v[32:35], v[0:3], v[60:67], v74
  s_waitcnt lgkmcnt(5)
  v_smfmac_f32_16x16x64_bf16 v[20:23], v[0:3], a[32:39], v74
  ds_read_b128 v[60:63], v76 offset:49152
  ds_read_b128 v[64:67], v76 offset:50176
  v_smfmac_f32_16x16x64_bf16 v[24:27], v[0:3], a[40:47], v74
  s_waitcnt lgkmcnt(4)
  v_smfmac_f32_16x16x64_bf16 v[20:23], v[4:7], a[48:55], v74
  buffer_store_dwordx4 v[16:19], v76, s[8:11], s68 offen sc1
  v_smfmac_f32_16x16x64_bf16 v[24:27], v[4:7], a[56:63], v74
  v_smfmac_f32_16x16x64_bf16 v[28:31], v[4:7], v[44:51], v74
  s_waitcnt lgkmcnt(2)
  v_smfmac_f32_16x16x64_bf16 v[20:23], v[8:11], a[64:71], v74
  ds_read_b128 v[44:47], v76 offset:51200
  ds_read_b128 v[48:51], v76 offset:52224
  v_smfmac_f32_16x16x64_bf16 v[24:27], v[8:11], a[72:79], v74
  v_smfmac_f32_16x16x64_bf16 v[32:35], v[4:7], v[36:43], v74
  v_smfmac_f32_16x16x64_bf16 v[28:31], v[8:11], v[208:215], v74
  ds_read_b128 v[36:39], v75 offset:16384
  ds_read_b128 v[40:43], v75 offset:17408
  v_smfmac_f32_16x16x64_bf16 v[32:35], v[8:11], v[216:223], v74
  v_smfmac_f32_16x16x64_bf16 v[20:23], v[12:15], a[80:87], v74
  v_smfmac_f32_16x16x64_bf16 v[24:27], v[12:15], a[88:95], v74
  v_smfmac_f32_16x16x64_bf16 v[28:31], v[12:15], v[224:231], v74
  v_smfmac_f32_16x16x64_bf16 v[32:35], v[12:15], v[232:239], v74
  s_waitcnt vmcnt(2)
  s_waitcnt vmcnt(1)
  s_barrier
Cf0_lastr:
  ds_read_b128 v[0:3], v76 offset:8704
  ds_read_b128 v[8:11], v76 offset:9728
  ds_read_b128 v[16:19], v76 offset:10752
  ds_read_b128 v[4:7], v76 offset:11776
  ds_read_b128 v[12:15], v76 offset:12800
  s_waitcnt lgkmcnt(4)
  v_max3_u32 v72, v0, v1, v2
  s_waitcnt lgkmcnt(1)
  v_max3_u32 v72, v72, v3, v4
  v_max3_u32 v72, v72, v5, v6
  v_max3_u32 v72, v72, v7, v8
  v_max3_u32 v72, v72, v9, v10
  s_waitcnt lgkmcnt(0)
  v_max3_u32 v72, v72, v11, v12
  v_max3_u32 v72, v72, v13, v14
  v_max3_u32 v72, v72, v15, v16
  v_max3_u32 v72, v72, v17, v18
  v_max_u32 v72, v72, v19
  v_cmp_eq_u32 vcc, -1, v72
  s_cbranch_vccnz Cf0_lastp
Cf0_lastg:
  v_smfmac_f32_16x16x64_bf16 v[28:31], v[0:3], v[60:67], v74
  ds_read_b128 v[60:63], v75 offset:18432
  ds_read_b128 v[64:67], v75 offset:19456
  v_smfmac_f32_16x16x64_bf16 v[32:35], v[0:3], v[44:51], v74
  v_smfmac_f32_16x16x64_bf16 v[28:31], v[8:11], v[36:43], v74
  v_smfmac_f32_16x16x64_bf16 v[28:31], v[16:19], v[240:247], v74
  v_smfmac_f32_16x16x64_bf16 v[28:31], v[4:7], a[0:7], v74
  v_smfmac_f32_16x16x64_bf16 v[28:31], v[12:15], a[16:23], v74
  v_smfmac_f32_16x16x64_bf16 v[32:35], v[16:19], v[248:255], v74
  v_smfmac_f32_16x16x64_bf16 v[32:35], v[4:7], a[8:15], v74
  s_waitcnt lgkmcnt(0)
  v_smfmac_f32_16x16x64_bf16 v[32:35], v[12:15], a[24:31], v74
  v_smfmac_f32_16x16x64_bf16 v[32:35], v[8:11], v[60:67], v74
  v_smfmac_f32_16x16x64_bf16 v[20:23], v[0:3], a[96:103], v74
  v_smfmac_f32_16x16x64_bf16 v[20:23], v[8:11], a[112:119], v74
  v_add_f32 v28, v28, v30
  v_add_f32 v32, v32, v34
  v_cvt_pk_bf16_f32 v30, v28, v32
  v_smfmac_f32_16x16x64_bf16 v[20:23], v[16:19], a[128:135], v74
  ds_write_b32 v79, v30 offset:256
  v_add_f32 v29, v29, v31
  v_add_f32 v33, v33, v35
  v_cvt_pk_bf16_f32 v31, v29, v33
  v_smfmac_f32_16x16x64_bf16 v[20:23], v[4:7], a[144:151], v74
  ds_write_b32 v79, v31 offset:832
  v_smfmac_f32_16x16x64_bf16 v[20:23], v[12:15], a[160:167], v74
  v_smfmac_f32_16x16x64_bf16 v[24:27], v[0:3], a[104:111], v74
  v_smfmac_f32_16x16x64_bf16 v[24:27], v[8:11], a[120:127], v74
  v_smfmac_f32_16x16x64_bf16 v[24:27], v[16:19], a[136:143], v74
  s_waitcnt lgkmcnt(0)
  s_barrier
  ds_read_b64 v[52:53], v77 offset:256
  v_add_f32 v20, v20, v22
  v_smfmac_f32_16x16x64_bf16 v[24:27], v[4:7], a[152:159], v74
  v_add_f32 v21, v21, v23
  v_smfmac_f32_16x16x64_bf16 v[24:27], v[12:15], a[168:175], v74
  v_cvt_pk_bf16_f32 v54, v20, v21
  s_add_u32 s68, s68, 655360
  s_nop 3
  v_add_f32 v24, v24, v26
  v_add_f32 v25, v25, v27
  v_cvt_pk_bf16_f32 v55, v24, v25
  s_waitcnt lgkmcnt(0)
  buffer_store_dwordx4 v[52:55], v76, s[8:11], s68 offen sc1
  s_branch Cf0_done
Cf0_lastp:
  s_add_u32 s72, s72, 2
  s_cmp_ge_u32 s72, 131072
  s_cbranch_scc1 Cf0_lastg
  s_barrier
  buffer_load_dwordx4 v76, s[8:11], s85 offen offset:0 sc1 lds
  s_waitcnt vmcnt(0)
  s_barrier
  s_branch Cf0_lastr
Cf0_done:
  s_branch L_cexit
L_w1:
  v_mov_b64 v[20:21], 0
  v_mov_b64 v[22:23], 0
  v_mov_b64 v[24:25], 0
  v_mov_b64 v[26:27], 0
  v_mov_b64 v[28:29], 0
  v_mov_b64 v[30:31], 0
  v_mov_b64 v[32:33], 0
  v_mov_b64 v[34:35], 0
  s_mov_b32 s78, 0x3f803f80
  s_mov_b32 s79, s78
  s_mov_b32 s65, 360448
  s_mov_b32 m0, 15872
  s_lshl_b32 s71, s53, 2
  s_add_u32 s71, s71, 128
  s_movk_i32 s56, 0x1000
  v_lshlrev_b32 v73, 2, v76
  v_mov_b32 v72, 0
  s_mov_b64 s[16:17], s[8:9]
  s_mov_b32 s18, 268435456
  s_mov_b32 s19, 0x20000
  s_getpc_b64 s[20:21]
Cf1_pc:
  s_add_u32 s20, s20, (Cf1_last - Cf1_pc)
  s_addc_u32 s21, s21, 0
  v_mov_b32 v68, 14880
  buffer_load_dwordx4 v[52:55], v76, s[8:11], s59 offen offset:0 sc1
  buffer_load_dwordx4 v[56:59], v76, s[8:11], s59 offen offset:1024 sc1
  ds_read_b128 v[36:39], v76 offset:20480
  ds_read_b128 v[40:43], v76 offset:21504
  ds_read_b128 v[60:63], v76 offset:22528
  ds_read_b128 v[64:67], v76 offset:23552
  ds_read_b128 v[0:3], v76 offset:4608
  ds_read_b128 v[4:7], v76 offset:5632
  ds_read_b128 v[8:11], v76 offset:6656
  ds_read_b128 v[12:15], v76 offset:7680
  s_waitcnt lgkmcnt(0)
  s_cmp_eq_u32 s66, 1
  s_branch Cf1_top2
.p2align 6
Cf1_h2:
  ds_read_b128 v[36:39], v76 offset:20480
  s_waitcnt lgkmcnt(0)
  v_lshlrev_b32 v73, 2, v76
  buffer_load_dwordx4 v[8:11], v76, s[8:11], s65 offen offset:2048 sc1
  ds_read_b128 v[40:43], v76 offset:21504
  s_waitcnt lgkmcnt(0)
  v_mov_b64 v[20:21], 0
  v_mov_b64 v[22:23], 0
  v_mov_b64 v[24:25], 0
  v_mov_b64 v[26:27], 0
  v_mov_b32 v68, 14880
  buffer_load_dwordx4 v[8:11], v76, s[8:11], s65 offen offset:2048 sc1
  ds_read_b128 v[60:63], v76 offset:22528
  s_waitcnt lgkmcnt(0)
  s_cmp_eq_u32 s66, 62
  s_cselect_b64 s[16:17], s[20:21], s[16:17]
  s_cselect_b32 s18, (Cf1_done - Cf1_last), s18
  s_cselect_b32 s70, 0, s70
  s_cmp_eq_u32 s66, 63
  s_cselect_b32 s59, 268435456, s59
  s_cselect_b32 s58, 268435456, s58
  buffer_load_dwordx4 v[8:11], v76, s[8:11], s65 offen offset:2048 sc1
  buffer_load_dwordx4 v[52:55], v76, s[8:11], s59 offen offset:0 sc1
  buffer_load_dwordx4 v[56:59], v76, s[8:11], s59 offen offset:1024 sc1
  s_waitcnt vmcnt(4)
  v_max3_u32 v72, v8, v9, v10
  v_max_u32 v72, v72, v11
  ds_write_b128 v76, v[8:11] offset:6656
  v_cmp_eq_u32 vcc, -1, v72
  s_cbranch_vccnz Cf1_h2r
Cf1_h2w:
  s_cmp_eq_u32 s66, 63
  s_waitcnt lgkmcnt(0)
  s_barrier
  ds_read_b128 v[0:3], v76 offset:4608
  buffer_load_dwordx4 v76, s[8:11], s85 offen offset:0 sc1 lds
Cf1_top2:
  v_smfmac_f32_16x16x64_bf16 v[20:23], v[8:11], v[112:119], v74
  s_cbranch_scc1 Cf1_last
  v_smfmac_f32_16x16x64_bf16 v[24:27], v[8:11], v[120:127], v74
  buffer_load_dwordx4 v[44:47], v76, s[8:11], s58 offen offset:0 sc1
  s_mov_b32 m0, 15872
  v_smfmac_f32_16x16x64_bf16 v[28:31], v[8:11], v[208:215], v74
  buffer_load_dwordx4 v[48:51], v76, s[8:11], s58 offen offset:1024 sc1
  v_smfmac_f32_16x16x64_bf16 v[32:35], v[8:11], v[216:223], v74
  ds_read_b128 v[4:7], v76 offset:5632
  s_waitcnt lgkmcnt(1)
  v_smfmac_f32_16x16x64_bf16 v[20:23], v[0:3], v[80:87], v74
  ds_read_b128 v[12:15], v76 offset:7680
  v_smfmac_f32_16x16x64_bf16 v[28:31], v[0:3], v[36:43], v74
  ds_read_b128 v[36:39], v76 offset:36864
  v_smfmac_f32_16x16x64_bf16 v[24:27], v[0:3], v[88:95], v74
  buffer_store_dwordx4 v[16:19], v76, s[8:11], s68 offen sc1
  ds_read_b128 v[40:43], v76 offset:37888
  v_smfmac_f32_16x16x64_bf16 v[32:35], v[0:3], v[60:67], v74
  buffer_load_dword v73, s[16:19], s70 offen lds
  ds_read_b128 v[60:63], v76 offset:38912
  s_waitcnt lgkmcnt(4)
  v_smfmac_f32_16x16x64_bf16 v[20:23], v[4:7], v[96:103], v74
  ds_read_b128 v[64:67], v76 offset:39936
  v_smfmac_f32_16x16x64_bf16 v[24:27], v[4:7], v[104:111], v74
  s_waitcnt vmcnt(5)
  s_waitcnt lgkmcnt(4)
  v_smfmac_f32_16x16x64_bf16 v[20:23], v[12:15], v[128:135], v74
  s_barrier
  ds_read_b128 v[8:11], v76 offset:8704
  s_waitcnt lgkmcnt(3)
  v_smfmac_f32_16x16x64_bf16 v[28:31], v[4:7], v[36:43], v74
  ds_read_b128 v[36:39], v76 offset:53248
  v_smfmac_f32_16x16x64_bf16 v[24:27], v[12:15], v[136:143], v74
  ds_read_b128 v[40:43], v76 offset:54272
  s_waitcnt lgkmcnt(3)
  v_smfmac_f32_16x16x64_bf16 v[32:35], v[4:7], v[60:67], v74
  ds_read_b128 v[0:3], v76 offset:9728
  v_smfmac_f32_16x16x64_bf16 v[28:31], v[12:15], v[224:231], v74
  ds_read_b128 v[60:63], v76 offset:55296
  v_smfmac_f32_16x16x64_bf16 v[32:35], v[12:15], v[232:239], v74
  s_waitcnt vmcnt(4)
  ds_read_b128 v[64:67], v76 offset:56320
  s_waitcnt lgkmcnt(5)
  v_smfmac_f32_16x16x64_bf16 v[20:23], v[8:11], v[144:151], v74
  s_barrier
  ds_read_b128 v[4:7], v76 offset:11776
  s_waitcnt lgkmcnt(4)
  v_smfmac_f32_16x16x64_bf16 v[28:31], v[8:11], v[36:43], v74
  ds_read_b128 v[12:15], v76 offset:12800
  ds_read_b128 v[36:39], v75 offset:4096
  v_smfmac_f32_16x16x64_bf16 v[24:27], v[8:11], v[152:159], v74
  ds_read_b128 v[16:19], v76 offset:10752
  s_waitcnt lgkmcnt(6)
  v_smfmac_f32_16x16x64_bf16 v[20:23], v[0:3], v[160:167], v74
  ds_read_b128 v[40:43], v75 offset:5120
  s_waitcnt lgkmcnt(5)
  v_smfmac_f32_16x16x64_bf16 v[32:35], v[8:11], v[60:67], v74
  ds_read_b128 v[60:63], v75 offset:6144
  v_smfmac_f32_16x16x64_bf16 v[24:27], v[0:3], v[168:175], v74
  ds_read_b128 v[64:67], v75 offset:7168
  s_waitcnt lgkmcnt(6)
  v_smfmac_f32_16x16x64_bf16 v[20:23], v[4:7], v[176:183], v74
  s_waitcnt lgkmcnt(5)
  v_smfmac_f32_16x16x64_bf16 v[20:23], v[12:15], v[192:199], v74
  s_waitcnt lgkmcnt(2)
  v_smfmac_f32_16x16x64_bf16 v[20:23], v[16:19], v[36:43], v74
  ds_read_b128 v[36:39], v75 offset:20480
  v_smfmac_f32_16x16x64_bf16 v[24:27], v[4:7], v[184:191], v74
  ds_read_b128 v[40:43], v75 offset:21504
  s_waitcnt lgkmcnt(2)
  v_smfmac_f32_16x16x64_bf16 v[24:27], v[16:19], v[60:67], v74
  ds_read_b128 v[60:63], v75 offset:22528
  v_add_f32 v20, v20, v22
  v_smfmac_f32_16x16x64_bf16 v[24:27], v[12:15], v[200:207], v74
  ds_read_b128 v[64:67], v75 offset:23552
  v_add_f32 v21, v21, v23
  v_smfmac_f32_16x16x64_bf16 v[28:31], v[16:19], v[240:247], v74
  v_mov_b64 v[70:71], s[78:79]
  v_smfmac_f32_16x16x64_bf16 v[28:31], v[4:7], a[0:7], v74
  s_waitcnt lgkmcnt(2)
  v_add_f32 v24, v24, v26
  v_smfmac_f32_16x16x64_bf16 v[28:31], v[0:3], v[36:43], v74
  ds_read_b128 v[36:39], v68
  v_cvt_pk_bf16_f32 v22, v20, v24
  v_smfmac_f32_16x16x64_bf16 v[28:31], v[12:15], a[16:23], v74
  ds_read_b128 v[40:43], v68
  ds_write_b32 v79, v22 offset:0
  s_waitcnt lgkmcnt(3)
  v_add_f32 v25, v25, v27
  v_cvt_pk_bf16_f32 v23, v21, v25
  v_smfmac_f32_16x16x64_bf16 v[32:35], v[0:3], v[60:67], v74
  ds_write_b32 v79, v23 offset:576
  v_cmp_u_f32 vcc, v20, v21
  v_smfmac_f32_16x16x64_bf16 v[32:35], v[16:19], v[248:255], v74
  v_add_f32 v28, v28, v30
  v_smfmac_f32_16x16x64_bf16 v[32:35], v[4:7], a[8:15], v74
  v_add_f32 v29, v29, v31
  v_smfmac_f32_16x16x64_bf16 v[32:35], v[12:15], a[24:31], v74
  s_cbranch_vccnz Cf1_rec
Cf1_recok:
  s_waitcnt lgkmcnt(3)
  v_smfmac_f32_16x16x64_bf16 v[36:39], v[16:19], a[128:135], v74
  s_waitcnt lgkmcnt(0)
  s_barrier
  ds_read_b128 v[60:63], v77
  v_smfmac_f32_16x16x64_bf16 v[40:43], v[16:19], a[136:143], v74
  ds_read_b128 v[64:67], v77 offset:128
  v_add_f32 v32, v32, v34
  v_cvt_pk_bf16_f32 v30, v28, v32
  v_smfmac_f32_16x16x64_bf16 v[36:39], v[0:3], a[112:119], v74
  ds_write_b32 v79, v30 offset:256
  v_add_f32 v33, v33, v35
  v_cvt_pk_bf16_f32 v31, v29, v33
  v_smfmac_f32_16x16x64_bf16 v[40:43], v[0:3], a[120:127], v74
  ds_write_b32 v79, v31 offset:832
  v_xor_b32 v75, 0x8000, v75
  v_smfmac_f32_16x16x64_bf16 v[36:39], v[4:7], a[144:151], v74
  ds_read_b128 v[0:3], v76 offset:4608
  v_mov_b32 v29, 0
  v_smfmac_f32_16x16x64_bf16 v[40:43], v[4:7], a[152:159], v74
  s_waitcnt vmcnt(2) lgkmcnt(3)
  v_mov_b32 v30, 0
  v_mfma_f32_16x16x32_bf16 v[44:47], v[44:47], v[60:63], 0
  ds_read_b128 v[4:7], v76 offset:5632
  s_waitcnt lgkmcnt(2)
  v_mfma_f32_16x16x32_bf16 v[44:47], v[48:51], v[64:67], v[44:47]
  s_barrier
  v_smfmac_f32_16x16x64_bf16 v[36:39], v[8:11], a[96:103], v74
  ds_read_b128 v[20:23], v77 offset:256
  ds_read_b128 v[24:27], v77 offset:384
  v_smfmac_f32_16x16x64_bf16 v[40:43], v[8:11], a[104:111], v74
  ds_read_b128 v[8:11], v76 offset:6656
  v_add_f32_dpp v72, v46, v44 quad_perm:[2,3,0,1] row_mask:0xf bank_mask:0xf
  v_add_f32_dpp v73, v47, v45 quad_perm:[2,3,0,1] row_mask:0xf bank_mask:0xf
  v_smfmac_f32_16x16x64_bf16 v[36:39], v[12:15], a[160:167], v74
  s_waitcnt lgkmcnt(4)
  v_exp_f32_dpp v72, v72 quad_perm:[0,1,0,1] row_mask:0xf bank_mask:0xf
  v_smfmac_f32_16x16x64_bf16 v[40:43], v[12:15], a[168:175], v74
  ds_read_b128 v[12:15], v76 offset:7680
  v_exp_f32_dpp v73, v73 quad_perm:[0,1,0,1] row_mask:0xf bank_mask:0xf
  v_smfmac_f32_16x16x64_bf16 v[36:39], v[0:3], a[32:39], v74
  s_waitcnt lgkmcnt(2)
  v_cvt_pk_bf16_f32 v72, v72, v73
  v_mfma_f32_16x16x32_bf16 v[20:23], v[20:23], v[60:63], 0
  ds_write_b32 v78, v72 offset:516
  v_mov_b64 v[16:17], 0
  v_mfma_f32_16x16x32_bf16 v[20:23], v[24:27], v[64:67], v[20:23]
  ds_read_b128 v[44:47], v75 offset:22528
  v_mov_b64 v[18:19], 0
  v_smfmac_f32_16x16x64_bf16 v[40:43], v[0:3], a[40:47], v74
  ds_read_b128 v[48:51], v75 offset:23552
  v_mov_b64 v[68:69], s[78:79]
  v_smfmac_f32_16x16x64_bf16 v[36:39], v[4:7], a[48:55], v74
  s_waitcnt lgkmcnt(4)
  v_add_f32_dpp v24, v22, v20 quad_perm:[2,3,0,1] row_mask:0xf bank_mask:0xf
  v_add_f32_dpp v25, v23, v21 quad_perm:[2,3,0,1] row_mask:0xf bank_mask:0xf
  v_smfmac_f32_16x16x64_bf16 v[36:39], v[8:11], a[64:71], v74
  s_waitcnt lgkmcnt(2)
  s_barrier
  ds_read_b128 v[32:35], v78 offset:512
  v_smfmac_f32_16x16x64_bf16 v[36:39], v[12:15], a[80:87], v74
  ds_read_b128 v[60:63], v75 offset:20480
  v_mul_f32 v24, s69, v24
  v_smfmac_f32_16x16x64_bf16 v[40:43], v[4:7], a[56:63], v74
  ds_read_b128 v[64:67], v75 offset:21504
  v_mul_f32 v25, s69, v25
  v_smfmac_f32_16x16x64_bf16 v[40:43], v[8:11], a[72:79], v74
  v_exp_f32_dpp v24, v24 quad_perm:[0,1,0,1] row_mask:0xf bank_mask:0xf
  v_smfmac_f32_16x16x64_bf16 v[40:43], v[12:15], a[88:95], v74
  s_waitcnt lgkmcnt(2)
  v_exp_f32_dpp v25, v25 quad_perm:[0,1,0,1] row_mask:0xf bank_mask:0xf
  v_mfma_f32_16x16x32_bf16 v[8:11], v[32:35], v[68:71], 0
  v_add_f32 v36, v36, v38
  v_add_f32 v37, v37, v39
  v_mfma_f32_16x16x32_bf16 v[0:3], v[32:35], v[52:55], 0
  v_add_f32 v40, v40, v42
  v_add_f32 v41, v41, v43
  v_mfma_f32_16x16x32_bf16 v[4:7], v[32:35], v[56:59], 0
  v_cvt_pk_bf16_f32 v28, v24, v25
  v_cvt_pk_bf16_f32 v72, v36, v37
  v_cvt_pk_bf16_f32 v73, v40, v41
  v_mfma_f32_16x16x16_bf16 v[8:11], v[28:29], v[68:69], v[8:11]
  v_cvt_pk_bf16_f32 v31, v24, v25
  v_mov_b64 v[20:21], 0
  v_mfma_f32_16x16x16_bf16 v[0:3], v[28:29], v[72:73], v[0:3]
  ds_read_b128 v[52:55], v75 offset:36864
  v_mov_b64 v[22:23], 0
  v_mfma_f32_16x16x16_bf16 v[4:7], v[30:31], v[72:73], v[4:7]
  v_rcp_f32 v10, v8
  v_rcp_f32 v11, v9
  v_mul_f32 v0, v10, v0
  v_mul_f32 v1, v11, v1
  v_max3_f32 v8, v8, v9, v10
  v_mul_f32 v4, v10, v4
  v_mul_f32 v5, v11, v5
  v_cvt_pk_bf16_f32 v2, v0, v4
  ds_write_b32 v79, v2 offset:8704
  v_cvt_pk_bf16_f32 v3, v1, v5
  ds_write_b32 v79, v3 offset:9280
  ds_read_b128 v[12:15], v78 offset:8768
  v_max_f32 v8, v8, v11
  v_cmp_le_f32 vcc, 1317011456, v8
  v_mov_b64 v[24:25], 0
  v_mov_b64 v[26:27], 0
  ds_read_b128 v[56:59], v75 offset:37888
  s_cbranch_vccnz Cf1_mx
Cf1_mxok:
  s_waitcnt lgkmcnt(2)
  s_barrier
  ds_read_b128 v[0:3], v78 offset:8704
  s_waitcnt lgkmcnt(2)
  v_smfmac_f32_16x16x64_bf16 v[16:19], v[12:15], v[44:51], v74
  ds_read_b128 v[4:7], v78 offset:8832
  v_smfmac_f32_16x16x64_bf16 v[20:23], v[12:15], a[200:207], v74
  ds_read_b128 v[8:11], v78 offset:8896
  v_smfmac_f32_16x16x64_bf16 v[24:27], v[12:15], a[216:223], v74
  ds_read_b128 v[36:39], v75 offset:38912
  s_waitcnt lgkmcnt(3)
  v_smfmac_f32_16x16x64_bf16 v[16:19], v[0:3], v[60:67], v74
  ds_read_b128 v[40:43], v75 offset:39936
  s_waitcnt lgkmcnt(3)
  v_smfmac_f32_16x16x64_bf16 v[16:19], v[4:7], a[176:183], v74
  ds_read_b128 v[68:71], v76 offset:13824
  s_waitcnt lgkmcnt(3)
  v_smfmac_f32_16x16x64_bf16 v[16:19], v[8:11], a[184:191], v74
  ds_read_b128 v[44:47], v75 offset:53248
  v_smfmac_f32_16x16x64_bf16 v[20:23], v[0:3], a[192:199], v74
  ds_read_b128 v[48:51], v75 offset:54272
  v_smfmac_f32_16x16x64_bf16 v[20:23], v[4:7], v[52:59], v74
  ds_read_b128 v[60:63], v75 offset:55296
  s_waitcnt lgkmcnt(4)
  v_cvt_pk_bf16_f32 v16, v16, v17
  v_cvt_pk_bf16_f32 v17, v18, v19
  v_bfi_b32 v16, 1, s72, v16
  v_smfmac_f32_16x16x64_bf16 v[20:23], v[8:11], v[36:43], v74
  s_waitcnt lgkmcnt(3)
  buffer_store_dwordx2 v[16:17], v68, s[8:11], s73 offen
  v_mov_b64 v[32:33], 0
  v_smfmac_f32_16x16x64_bf16 v[24:27], v[0:3], a[208:215], v74
  ds_read_b128 v[64:67], v75 offset:56320
  v_mov_b64 v[34:35], 0
  v_smfmac_f32_16x16x64_bf16 v[24:27], v[4:7], a[224:231], v74
  v_cvt_pk_bf16_f32 v20, v20, v21
  v_cvt_pk_bf16_f32 v21, v22, v23
  v_bfi_b32 v20, 1, s72, v20
  v_smfmac_f32_16x16x64_bf16 v[24:27], v[8:11], a[232:239], v74
  buffer_store_dwordx2 v[20:21], v68, s[8:11], s74 offen
  s_waitcnt lgkmcnt(2)
  v_smfmac_f32_16x16x64_bf16 v[32:35], v[0:3], v[44:51], v74
  s_waitcnt lgkmcnt(0)
  v_smfmac_f32_16x16x64_bf16 v[32:35], v[12:15], v[60:67], v74
  v_cvt_pk_bf16_f32 v24, v24, v25
  v_cvt_pk_bf16_f32 v25, v26, v27
  v_bfi_b32 v24, 1, s72, v24
  v_smfmac_f32_16x16x64_bf16 v[32:35], v[4:7], a[240:247], v74
  buffer_store_dwordx2 v[24:25], v68, s[8:11], s75 offen
  v_smfmac_f32_16x16x64_bf16 v[32:35], v[8:11], a[248:255], v74
  v_mov_b64 v[18:19], v[72:73]
  s_nop 4
  v_cvt_pk_bf16_f32 v32, v32, v33
  v_cvt_pk_bf16_f32 v33, v34, v35
  v_bfi_b32 v32, 1, s72, v32
  buffer_store_dwordx2 v[32:33], v68, s[8:11], s76 offen
  ds_read_b128 v[0:3], v76 offset:14848
  s_waitcnt lgkmcnt(0)
  ds_read_b64 v[16:17], v77 offset:264
  s_waitcnt lgkmcnt(0)
  ds_read_b128 v[64:67], v76 offset:23552
  s_waitcnt lgkmcnt(0)
  s_add_u32 s66, s66, 1
  s_xor_b32 s64, s64, 16384
  s_xor_b32 s65, s65, 16384
  s_add_u32 s58, s58, 655360
  s_add_u32 s59, s59, 655360
  s_add_u32 s70, s70, 655360
  s_add_u32 s68, s68, 655360
  s_mov_b32 m0, 11776
  s_add_u32 s85, s65, 7168
  v_xor_b32 v75, 0x8000, v75
  v_mov_b64 v[28:29], 0
  v_mov_b64 v[30:31], 0
  v_mov_b64 v[32:33], 0
  v_mov_b64 v[34:35], 0
  buffer_load_dwordx4 v[52:55], v76, s[8:11], s60 offen offset:0 sc1
  buffer_load_dwordx4 v[56:59], v76, s[8:11], s60 offen offset:1024 sc1
  s_waitcnt lgkmcnt(0)
  s_waitcnt vmcnt(1)
  v_mfma_f32_16x16x32_bf16 v[4:7], v[0:3], v[52:55], 0
  v_bitop3_b32 v72, v52, v54, s72 bitop3:0x7e
  s_waitcnt vmcnt(0)
  v_mfma_f32_16x16x32_bf16 v[4:7], v[0:3], v[56:59], v[4:7]
  v_bitop3_b32 v73, v56, v58, s72 bitop3:0x7e
  v_bitop3_b32 v72, v72, v73, 1 bitop3:0xa8
  v_cmp_ne_u32 vcc, 0, v72
  s_nop 3
  v_add_f32_dpp v4, v4, v4 row_ror:4 row_mask:0xf bank_mask:0xf
  v_add_f32_dpp v5, v5, v5 row_ror:4 row_mask:0xf bank_mask:0xf
  s_cmp_eq_u64 vcc, 0
  v_add_f32_dpp v4, v4, v4 row_ror:8 row_mask:0xf bank_mask:0xf
  v_add_f32_dpp v5, v5, v5 row_ror:8 row_mask:0xf bank_mask:0xf
  s_cselect_b32 s54, s62, 268435456
  v_cvt_pk_bf16_f32 v4, v4, v5
  buffer_store_dword v4, v69, s[8:11], s54 offen
  s_cbranch_vccnz Cf1_h1r
  s_xor_b32 s62, s62, 16384
  buffer_store_dword v71, v69, s[8:11], s62 offen
  s_xor_b32 s72, s72, 1
  s_branch Cf1_h2
Cf1_h1r:
  s_mov_b64 exec, vcc
  buffer_load_dwordx4 v[52:55], v76, s[8:11], s60 offen offset:0 sc1
  buffer_load_dwordx4 v[56:59], v76, s[8:11], s60 offen offset:1024 sc1
  s_mov_b64 exec, -1
  s_add_u32 s67, s67, 1
  s_waitcnt vmcnt(1)
  v_mfma_f32_16x16x32_bf16 v[4:7], v[0:3], v[52:55], 0
  v_bitop3_b32 v72, v52, v54, s72 bitop3:0x7e
  s_waitcnt vmcnt(0)
  v_mfma_f32_16x16x32_bf16 v[4:7], v[0:3], v[56:59], v[4:7]
  v_bitop3_b32 v73, v56, v58, s72 bitop3:0x7e
  v_bitop3_b32 v72, v72, v73, 1 bitop3:0xa8
  v_cmp_ne_u32 vcc, 0, v72
  s_cbranch_vccz Cf1_h1p
Cf1_h1s:
  s_mov_b64 exec, vcc
  buffer_load_dwordx4 v[52:55], v76, s[8:11], s60 offen offset:0 sc1
  buffer_load_dwordx4 v[56:59], v76, s[8:11], s60 offen offset:1024 sc1
  s_mov_b64 exec, -1
  s_add_u32 s67, s67, 1
  s_waitcnt vmcnt(1)
  v_mfma_f32_16x16x32_bf16 v[4:7], v[0:3], v[52:55], 0
  v_bitop3_b32 v72, v52, v54, s72 bitop3:0x7e
  s_waitcnt vmcnt(0)
  v_mfma_f32_16x16x32_bf16 v[4:7], v[0:3], v[56:59], v[4:7]
  v_bitop3_b32 v73, v56, v58, s72 bitop3:0x7e
  v_bitop3_b32 v72, v72, v73, 1 bitop3:0xa8
  v_cmp_ne_u32 vcc, 0, v72
  s_cbranch_vccz Cf1_h1p
  s_cmp_lt_u32 s67, 131072
  s_cbranch_scc1 Cf1_h1s
Cf1_h1p:
  s_nop 2
  v_add_f32_dpp v4, v4, v4 row_ror:4 row_mask:0xf bank_mask:0xf
  v_add_f32_dpp v5, v5, v5 row_ror:4 row_mask:0xf bank_mask:0xf
  s_nop 0
  v_add_f32_dpp v4, v4, v4 row_ror:8 row_mask:0xf bank_mask:0xf
  v_add_f32_dpp v5, v5, v5 row_ror:8 row_mask:0xf bank_mask:0xf
  v_cvt_pk_bf16_f32 v4, v4, v5
  buffer_store_dword v4, v69, s[8:11], s62 offen
  s_xor_b32 s62, s62, 16384
  buffer_store_dword v71, v69, s[8:11], s62 offen
  s_xor_b32 s72, s72, 1
  s_branch Cf1_h2
Cf1_h2r:
  s_mov_b64 exec, vcc
  buffer_load_dwordx4 v[8:11], v76, s[8:11], s65 offen offset:2048 sc1
  s_mov_b64 exec, -1
  s_add_u32 s67, s67, 1
  s_waitcnt vmcnt(4)
  v_max3_u32 v72, v8, v9, v10
  v_max_u32 v72, v72, v11
  ds_write_b128 v76, v[8:11] offset:6656
  v_cmp_eq_u32 vcc, -1, v72
  s_cbranch_vccz Cf1_h2w
  s_mov_b64 exec, vcc
  buffer_load_dwordx4 v[8:11], v76, s[8:11], s65 offen offset:2048 sc1
  s_mov_b64 exec, -1
  s_add_u32 s67, s67, 1
  s_waitcnt vmcnt(4)
  v_max3_u32 v72, v8, v9, v10
  v_max_u32 v72, v72, v11
  ds_write_b128 v76, v[8:11] offset:6656
  v_cmp_eq_u32 vcc, -1, v72
  s_cbranch_vccz Cf1_h2w
Cf1_h2s:
  s_mov_b64 exec, vcc
  buffer_load_dwordx4 v[8:11], v76, s[8:11], s65 offen offset:2048 sc1
  s_mov_b64 exec, -1
  s_add_u32 s67, s67, 1
  s_waitcnt vmcnt(2)
  v_max3_u32 v72, v8, v9, v10
  v_max_u32 v72, v72, v11
  ds_write_b128 v76, v[8:11] offset:6656
  v_cmp_eq_u32 vcc, -1, v72
  s_cbranch_vccz Cf1_h2w
  s_mov_b64 exec, vcc
  buffer_load_dwordx4 v[8:11], v76, s[8:11], s65 offen offset:2048 sc1
  s_mov_b64 exec, -1
  s_add_u32 s67, s67, 1
  s_waitcnt vmcnt(2)
  v_max3_u32 v72, v8, v9, v10
  v_max_u32 v72, v72, v11
  ds_write_b128 v76, v[8:11] offset:6656
  v_cmp_eq_u32 vcc, -1, v72
  s_cbranch_vccz Cf1_h2w
  s_mov_b64 exec, vcc
  buffer_load_dwordx4 v[8:11], v76, s[8:11], s65 offen offset:2048 sc1
  s_mov_b64 exec, -1
  s_add_u32 s67, s67, 1
  s_waitcnt vmcnt(2)
  v_max3_u32 v72, v8, v9, v10
  v_max_u32 v72, v72, v11
  ds_write_b128 v76, v[8:11] offset:6656
  v_cmp_eq_u32 vcc, -1, v72
  s_cbranch_vccz Cf1_h2w
  s_cmp_lt_u32 s67, 131072
  s_cbranch_scc1 Cf1_h2s
  s_branch Cf1_h2w
Cf1_rec:
  s_nop 7
  s_waitcnt vmcnt(0) lgkmcnt(0)
  v_max3_u32 v72, v0, v1, v2
  v_max3_u32 v72, v72, v3, v4
  v_max3_u32 v72, v72, v5, v6
  v_max3_u32 v72, v72, v7, v8
  v_max3_u32 v72, v72, v9, v10
  v_max3_u32 v72, v72, v11, v12
  v_max3_u32 v72, v72, v13, v14
  v_max3_u32 v72, v72, v15, v16
  v_max3_u32 v72, v72, v17, v18
  v_max_u32 v72, v72, v19
  v_cmp_eq_u32 vcc, -1, v72
  s_cbranch_vccz Cf1_recok
  s_barrier
  v_mov_b64 v[20:21], 0
  v_mov_b64 v[22:23], 0
  v_mov_b64 v[24:25], 0
  v_mov_b64 v[26:27], 0
  v_mov_b64 v[28:29], 0
  v_mov_b64 v[30:31], 0
  v_mov_b64 v[32:33], 0
  v_mov_b64 v[34:35], 0
  s_waitcnt lgkmcnt(0)
  s_barrier
  ds_read_b128 v[0:3], v76 offset:4608
  s_waitcnt lgkmcnt(0)
  v_smfmac_f32_16x16x64_bf16 v[20:23], v[0:3], v[80:87], v74
  v_smfmac_f32_16x16x64_bf16 v[24:27], v[0:3], v[88:95], v74
  ds_read_b128 v[60:63], v76 offset:20480
  ds_read_b128 v[64:67], v76 offset:21504
  s_waitcnt lgkmcnt(0)
  v_smfmac_f32_16x16x64_bf16 v[28:31], v[0:3], v[60:67], v74
  ds_read_b128 v[60:63], v76 offset:22528
  ds_read_b128 v[64:67], v76 offset:23552
  s_waitcnt lgkmcnt(0)
  v_smfmac_f32_16x16x64_bf16 v[32:35], v[0:3], v[60:67], v74
  ds_read_b128 v[4:7], v76 offset:5632
  s_waitcnt lgkmcnt(0)
  v_smfmac_f32_16x16x64_bf16 v[20:23], v[4:7], v[96:103], v74
  v_smfmac_f32_16x16x64_bf16 v[24:27], v[4:7], v[104:111], v74
  ds_read_b128 v[60:63], v76 offset:36864
  ds_read_b128 v[64:67], v76 offset:37888
  s_waitcnt lgkmcnt(0)
  v_smfmac_f32_16x16x64_bf16 v[28:31], v[4:7], v[60:67], v74
  ds_read_b128 v[60:63], v76 offset:38912
  ds_read_b128 v[64:67], v76 offset:39936
  s_waitcnt lgkmcnt(0)
  v_smfmac_f32_16x16x64_bf16 v[32:35], v[4:7], v[60:67], v74
  ds_read_b128 v[8:11], v76 offset:6656
  s_waitcnt lgkmcnt(0)
  v_smfmac_f32_16x16x64_bf16 v[20:23], v[8:11], v[112:119], v74
  v_smfmac_f32_16x16x64_bf16 v[24:27], v[8:11], v[120:127], v74
  v_smfmac_f32_16x16x64_bf16 v[28:31], v[8:11], v[208:215], v74
  v_smfmac_f32_16x16x64_bf16 v[32:35], v[8:11], v[216:223], v74
  ds_read_b128 v[12:15], v76 offset:7680
  s_waitcnt lgkmcnt(0)
  v_smfmac_f32_16x16x64_bf16 v[20:23], v[12:15], v[128:135], v74
  v_smfmac_f32_16x16x64_bf16 v[24:27], v[12:15], v[136:143], v74
  v_smfmac_f32_16x16x64_bf16 v[28:31], v[12:15], v[224:231], v74
  v_smfmac_f32_16x16x64_bf16 v[32:35], v[12:15], v[232:239], v74
  ds_read_b128 v[8:11], v76 offset:8704
  s_waitcnt lgkmcnt(0)
  v_smfmac_f32_16x16x64_bf16 v[20:23], v[8:11], v[144:151], v74
  v_smfmac_f32_16x16x64_bf16 v[24:27], v[8:11], v[152:159], v74
  ds_read_b128 v[60:63], v76 offset:53248
  ds_read_b128 v[64:67], v76 offset:54272
  s_waitcnt lgkmcnt(0)
  v_smfmac_f32_16x16x64_bf16 v[28:31], v[8:11], v[60:67], v74
  ds_read_b128 v[60:63], v76 offset:55296
  ds_read_b128 v[64:67], v76 offset:56320
  s_waitcnt lgkmcnt(0)
  v_smfmac_f32_16x16x64_bf16 v[32:35], v[8:11], v[60:67], v74
  ds_read_b128 v[0:3], v76 offset:9728
  s_waitcnt lgkmcnt(0)
  v_smfmac_f32_16x16x64_bf16 v[20:23], v[0:3], v[160:167], v74
  v_smfmac_f32_16x16x64_bf16 v[24:27], v[0:3], v[168:175], v74
  ds_read_b128 v[60:63], v75 offset:20480
  ds_read_b128 v[64:67], v75 offset:21504
  s_waitcnt lgkmcnt(0)
  v_smfmac_f32_16x16x64_bf16 v[28:31], v[0:3], v[60:67], v74
  ds_read_b128 v[60:63], v75 offset:22528
  ds_read_b128 v[64:67], v75 offset:23552
  s_waitcnt lgkmcnt(0)
  v_smfmac_f32_16x16x64_bf16 v[32:35], v[0:3], v[60:67], v74
  ds_read_b128 v[16:19], v76 offset:10752
  ds_read_b128 v[60:63], v75 offset:4096
  ds_read_b128 v[64:67], v75 offset:5120
  s_waitcnt lgkmcnt(0)
  v_smfmac_f32_16x16x64_bf16 v[20:23], v[16:19], v[60:67], v74
  ds_read_b128 v[60:63], v75 offset:6144
  ds_read_b128 v[64:67], v75 offset:7168
  s_waitcnt lgkmcnt(0)
  v_smfmac_f32_16x16x64_bf16 v[24:27], v[16:19], v[60:67], v74
  v_smfmac_f32_16x16x64_bf16 v[28:31], v[16:19], v[240:247], v74
  v_smfmac_f32_16x16x64_bf16 v[32:35], v[16:19], v[248:255], v74
  ds_read_b128 v[4:7], v76 offset:11776
  s_waitcnt lgkmcnt(0)
  v_smfmac_f32_16x16x64_bf16 v[20:23], v[4:7], v[176:183], v74
  v_smfmac_f32_16x16x64_bf16 v[24:27], v[4:7], v[184:191], v74
  v_smfmac_f32_16x16x64_bf16 v[28:31], v[4:7], a[0:7], v74
  v_smfmac_f32_16x16x64_bf16 v[32:35], v[4:7], a[8:15], v74
  ds_read_b128 v[12:15], v76 offset:12800
  s_waitcnt lgkmcnt(0)
  v_smfmac_f32_16x16x64_bf16 v[20:23], v[12:15], v[192:199], v74
  v_smfmac_f32_16x16x64_bf16 v[24:27], v[12:15], v[200:207], v74
  v_smfmac_f32_16x16x64_bf16 v[28:31], v[12:15], a[16:23], v74
  v_smfmac_f32_16x16x64_bf16 v[32:35], v[12:15], a[24:31], v74
  v_add_f32 v20, v20, v22
  v_add_f32 v21, v21, v23
  v_add_f32 v24, v24, v26
  v_cvt_pk_bf16_f32 v22, v20, v24
  ds_write_b32 v79, v22 offset:0
  v_add_f32 v25, v25, v27
  v_cvt_pk_bf16_f32 v23, v21, v25
  ds_write_b32 v79, v23 offset:576
  v_add_f32 v28, v28, v30
  v_add_f32 v29, v29, v31
  s_waitcnt lgkmcnt(0)
  s_nop 1
  s_branch Cf1_recok
Cf1_mx:
  s_waitcnt lgkmcnt(0)
  s_barrier
  buffer_load_dwordx4 v[52:55], v76, s[8:11], s59 offen offset:0 sc1
  buffer_load_dwordx4 v[0:3], v76, s[8:11], s58 offen offset:0 sc1
  ds_read_b128 v[20:23], v77 offset:0
  ds_read_b128 v[28:31], v77 offset:256
  buffer_load_dwordx4 v[56:59], v76, s[8:11], s59 offen offset:1024 sc1
  buffer_load_dwordx4 v[4:7], v76, s[8:11], s58 offen offset:1024 sc1
  ds_read_b128 v[24:27], v77 offset:128
  ds_read_b128 v[32:35], v77 offset:384
  s_waitcnt vmcnt(2) lgkmcnt(3)
  v_mfma_f32_16x16x32_bf16 v[8:11], v[0:3], v[20:23], 0
  s_waitcnt vmcnt(0) lgkmcnt(1)
  v_mfma_f32_16x16x32_bf16 v[8:11], v[4:7], v[24:27], v[8:11]
  v_mfma_f32_16x16x32_bf16 v[12:15], v[28:31], v[20:23], 0
  s_waitcnt lgkmcnt(0)
  v_mfma_f32_16x16x32_bf16 v[12:15], v[32:35], v[24:27], v[12:15]
  v_add_f32_dpp v8, v10, v8 quad_perm:[2,3,0,1] row_mask:0xf bank_mask:0xf
  v_add_f32_dpp v9, v11, v9 quad_perm:[2,3,0,1] row_mask:0xf bank_mask:0xf
  s_nop 0
  v_mov_b32_dpp v8, v8 quad_perm:[0,1,0,1] row_mask:0xf bank_mask:0xf
  v_mov_b32_dpp v9, v9 quad_perm:[0,1,0,1] row_mask:0xf bank_mask:0xf
  s_nop 1
  v_add_f32_dpp v12, v14, v12 quad_perm:[2,3,0,1] row_mask:0xf bank_mask:0xf
  v_add_f32_dpp v13, v15, v13 quad_perm:[2,3,0,1] row_mask:0xf bank_mask:0xf
  s_nop 0
  v_mov_b32_dpp v12, v12 quad_perm:[0,1,0,1] row_mask:0xf bank_mask:0xf
  v_mov_b32_dpp v13, v13 quad_perm:[0,1,0,1] row_mask:0xf bank_mask:0xf
  v_mul_f32 v12, s69, v12
  ds_write_b32 v78, v8 offset:8708
  v_mul_f32 v13, s69, v13
  ds_write_b32 v78, v9 offset:8772
  s_waitcnt lgkmcnt(0)
  s_barrier
  ds_read_b128 v[36:39], v78 offset:8704
  ds_read_b128 v[40:43], v78 offset:8768
  s_waitcnt lgkmcnt(0)
  s_barrier
  v_max_f32 v16, v36, v37
  v_max3_f32 v16, v16, v38, v39
  v_max3_f32 v16, v16, v40, v41
  v_max3_f32 v16, v16, v42, v43
  v_max3_f32 v16, v16, v12, v13
  v_mov_b32 v17, v16
  s_nop 1
  v_permlane16_swap_b32 v16, v17
  v_max_f32 v16, v16, v17
  v_mov_b32 v17, v16
  s_nop 1
  v_permlane32_swap_b32 v16, v17
  v_max_f32 v16, v16, v17
  v_sub_f32 v36, v36, v16
  v_sub_f32 v37, v37, v16
  v_sub_f32 v38, v38, v16
  v_sub_f32 v39, v39, v16
  v_sub_f32 v40, v40, v16
  v_sub_f32 v41, v41, v16
  v_sub_f32 v42, v42, v16
  v_sub_f32 v43, v43, v16
  v_sub_f32 v12, v12, v16
  v_sub_f32 v13, v13, v16
  v_exp_f32 v36, v36
  v_exp_f32 v37, v37
  v_exp_f32 v38, v38
  v_exp_f32 v39, v39
  v_exp_f32 v40, v40
  v_exp_f32 v41, v41
  v_exp_f32 v42, v42
  v_exp_f32 v43, v43
  v_exp_f32 v12, v12
  v_exp_f32 v13, v13
  v_cvt_pk_bf16_f32 v32, v36, v40
  v_cvt_pk_bf16_f32 v33, v37, v41
  v_cvt_pk_bf16_f32 v34, v38, v42
  v_cvt_pk_bf16_f32 v35, v39, v43
  v_cvt_pk_bf16_f32 v28, v12, v13
  v_cvt_pk_bf16_f32 v31, v12, v13
  v_mov_b32 v29, 0
  v_mov_b32 v30, 0
  v_mfma_f32_16x16x32_bf16 v[8:11], v[32:35], v[68:71], 0
  v_mfma_f32_16x16x32_bf16 v[0:3], v[32:35], v[52:55], 0
  v_mfma_f32_16x16x32_bf16 v[4:7], v[32:35], v[56:59], 0
  v_mfma_f32_16x16x16_bf16 v[8:11], v[28:29], v[68:69], v[8:11]
  v_mfma_f32_16x16x16_bf16 v[0:3], v[28:29], v[72:73], v[0:3]
  v_mfma_f32_16x16x16_bf16 v[4:7], v[30:31], v[72:73], v[4:7]
  ds_read_b128 v[52:55], v75 offset:36864
  v_rcp_f32 v10, v8
  v_rcp_f32 v11, v9
  v_mul_f32 v0, v10, v0
  v_mul_f32 v1, v11, v1
  v_max3_f32 v8, v8, v9, v10
  v_mul_f32 v4, v10, v4
  v_mul_f32 v5, v11, v5
  v_cvt_pk_bf16_f32 v2, v0, v4
  ds_write_b32 v79, v2 offset:8704
  v_cvt_pk_bf16_f32 v3, v1, v5
  ds_write_b32 v79, v3 offset:9280
  ds_read_b128 v[12:15], v78 offset:8768
  ds_read_b128 v[56:59], v75 offset:37888
  v_mov_b64 v[16:17], 0
  v_mov_b64 v[18:19], 0
  v_mov_b64 v[20:21], 0
  v_mov_b64 v[22:23], 0
  v_mov_b64 v[24:25], 0
  v_mov_b64 v[26:27], 0
  s_branch Cf1_mxok
Cf1_last:
  ds_read_b128 v[4:7], v76 offset:5632
  ds_read_b128 v[12:15], v76 offset:7680
  ds_read_b128 v[44:47], v76 offset:36864
  ds_read_b128 v[48:51], v76 offset:37888
  s_nop 5
  v_mov_b64 v[20:21], 0
  v_mov_b64 v[22:23], 0
  v_mov_b64 v[24:25], 0
  v_mov_b64 v[26:27], 0
  s_waitcnt lgkmcnt(4)
  v_smfmac_f32_16x16x64_bf16 v[28:31], v[0:3], v[36:43], v74
  ds_read_b128 v[36:39], v76 offset:38912
  ds_read_b128 v[40:43], v76 offset:39936
  v_smfmac_f32_16x16x64_bf16 v[32:35], v[0:3], v[60:67], v74
  s_waitcnt lgkmcnt(5)
  v_smfmac_f32_16x16x64_bf16 v[20:23], v[0:3], a[32:39], v74
  ds_read_b128 v[60:63], v76 offset:53248
  ds_read_b128 v[64:67], v76 offset:54272
  v_smfmac_f32_16x16x64_bf16 v[24:27], v[0:3], a[40:47], v74
  s_waitcnt lgkmcnt(4)
  v_smfmac_f32_16x16x64_bf16 v[20:23], v[4:7], a[48:55], v74
  buffer_store_dwordx4 v[16:19], v76, s[8:11], s68 offen sc1
  v_smfmac_f32_16x16x64_bf16 v[24:27], v[4:7], a[56:63], v74
  v_smfmac_f32_16x16x64_bf16 v[28:31], v[4:7], v[44:51], v74
  s_waitcnt lgkmcnt(2)
  v_smfmac_f32_16x16x64_bf16 v[20:23], v[8:11], a[64:71], v74
  ds_read_b128 v[44:47], v76 offset:55296
  ds_read_b128 v[48:51], v76 offset:56320
  v_smfmac_f32_16x16x64_bf16 v[24:27], v[8:11], a[72:79], v74
  v_smfmac_f32_16x16x64_bf16 v[32:35], v[4:7], v[36:43], v74
  v_smfmac_f32_16x16x64_bf16 v[28:31], v[8:11], v[208:215], v74
  ds_read_b128 v[36:39], v75 offset:20480
  ds_read_b128 v[40:43], v75 offset:21504
  v_smfmac_f32_16x16x64_bf16 v[32:35], v[8:11], v[216:223], v74
  v_smfmac_f32_16x16x64_bf16 v[20:23], v[12:15], a[80:87], v74
  v_smfmac_f32_16x16x64_bf16 v[24:27], v[12:15], a[88:95], v74
  v_smfmac_f32_16x16x64_bf16 v[28:31], v[12:15], v[224:231], v74
  v_smfmac_f32_16x16x64_bf16 v[32:35], v[12:15], v[232:239], v74
  s_waitcnt vmcnt(2)
  s_waitcnt vmcnt(1)
  s_barrier
Cf1_lastr:
  ds_read_b128 v[8:11], v76 offset:8704
  ds_read_b128 v[0:3], v76 offset:9728
  ds_read_b128 v[16:19], v76 offset:10752
  ds_read_b128 v[4:7], v76 offset:11776
  ds_read_b128 v[12:15], v76 offset:12800
  s_waitcnt lgkmcnt(3)
  v_max3_u32 v72, v0, v1, v2
  s_waitcnt lgkmcnt(1)
  v_max3_u32 v72, v72, v3, v4
  v_max3_u32 v72, v72, v5, v6
  v_max3_u32 v72, v72, v7, v8
  v_max3_u32 v72, v72, v9, v10
  s_waitcnt lgkmcnt(0)
  v_max3_u32 v72, v72, v11, v12
  v_max3_u32 v72, v72, v13, v14
  v_max3_u32 v72, v72, v15, v16
  v_max3_u32 v72, v72, v17, v18
  v_max_u32 v72, v72, v19
  v_cmp_eq_u32 vcc, -1, v72
  s_cbranch_vccnz Cf1_lastp
Cf1_lastg:
  v_smfmac_f32_16x16x64_bf16 v[28:31], v[8:11], v[60:67], v74
  ds_read_b128 v[60:63], v75 offset:22528
  ds_read_b128 v[64:67], v75 offset:23552
  v_smfmac_f32_16x16x64_bf16 v[32:35], v[8:11], v[44:51], v74
  v_smfmac_f32_16x16x64_bf16 v[28:31], v[0:3], v[36:43], v74
  v_smfmac_f32_16x16x64_bf16 v[28:31], v[16:19], v[240:247], v74
  v_smfmac_f32_16x16x64_bf16 v[28:31], v[4:7], a[0:7], v74
  v_smfmac_f32_16x16x64_bf16 v[28:31], v[12:15], a[16:23], v74
  v_smfmac_f32_16x16x64_bf16 v[32:35], v[16:19], v[248:255], v74
  v_smfmac_f32_16x16x64_bf16 v[32:35], v[4:7], a[8:15], v74
  s_waitcnt lgkmcnt(0)
  v_smfmac_f32_16x16x64_bf16 v[32:35], v[12:15], a[24:31], v74
  v_smfmac_f32_16x16x64_bf16 v[32:35], v[0:3], v[60:67], v74
  v_smfmac_f32_16x16x64_bf16 v[20:23], v[8:11], a[96:103], v74
  v_smfmac_f32_16x16x64_bf16 v[20:23], v[0:3], a[112:119], v74
  v_add_f32 v28, v28, v30
  v_add_f32 v32, v32, v34
  v_cvt_pk_bf16_f32 v30, v28, v32
  v_smfmac_f32_16x16x64_bf16 v[20:23], v[16:19], a[128:135], v74
  ds_write_b32 v79, v30 offset:256
  v_add_f32 v29, v29, v31
  v_add_f32 v33, v33, v35
  v_cvt_pk_bf16_f32 v31, v29, v33
  v_smfmac_f32_16x16x64_bf16 v[20:23], v[4:7], a[144:151], v74
  ds_write_b32 v79, v31 offset:832
  v_smfmac_f32_16x16x64_bf16 v[20:23], v[12:15], a[160:167], v74
  v_smfmac_f32_16x16x64_bf16 v[24:27], v[8:11], a[104:111], v74
  v_smfmac_f32_16x16x64_bf16 v[24:27], v[0:3], a[120:127], v74
  v_smfmac_f32_16x16x64_bf16 v[24:27], v[16:19], a[136:143], v74
  s_waitcnt lgkmcnt(0)
  s_barrier
  ds_read_b64 v[52:53], v77 offset:264
  v_add_f32 v20, v20, v22
  v_smfmac_f32_16x16x64_bf16 v[24:27], v[4:7], a[152:159], v74
  v_add_f32 v21, v21, v23
  v_smfmac_f32_16x16x64_bf16 v[24:27], v[12:15], a[168:175], v74
  v_cvt_pk_bf16_f32 v54, v20, v21
  s_add_u32 s68, s68, 655360
  s_nop 3
  v_add_f32 v24, v24, v26
  v_add_f32 v25, v25, v27
  v_cvt_pk_bf16_f32 v55, v24, v25
  s_waitcnt lgkmcnt(0)
  buffer_store_dwordx4 v[52:55], v76, s[8:11], s68 offen sc1
  s_branch Cf1_done
Cf1_lastp:
  s_add_u32 s72, s72, 2
  s_cmp_ge_u32 s72, 131072
  s_cbranch_scc1 Cf1_lastg
  s_barrier
  buffer_load_dwordx4 v76, s[8:11], s85 offen offset:0 sc1 lds
  s_waitcnt vmcnt(0)
  s_barrier
  s_branch Cf1_lastr
Cf1_done:
  s_branch L_cexit
L_w2:
  v_mov_b64 v[20:21], 0
  v_mov_b64 v[22:23], 0
  v_mov_b64 v[24:25], 0
  v_mov_b64 v[26:27], 0
  v_mov_b64 v[28:29], 0
  v_mov_b64 v[30:31], 0
  v_mov_b64 v[32:33], 0
  v_mov_b64 v[34:35], 0
  s_mov_b32 s78, 0x3f803f80
  s_mov_b32 s79, s78
  s_mov_b32 s65, 360448
  s_mov_b32 m0, 15872
  s_lshl_b32 s71, s53, 2
  s_add_u32 s71, s71, 128
  s_movk_i32 s56, 0x1000
  v_lshlrev_b32 v73, 2, v76
  v_mov_b32 v72, 0
  s_mov_b64 s[16:17], s[8:9]
  s_mov_b32 s18, 268435456
  s_mov_b32 s19, 0x20000
  s_getpc_b64 s[20:21]
Cf2_pc:
  s_add_u32 s20, s20, (Cf2_last - Cf2_pc)
  s_addc_u32 s21, s21, 0
  v_mov_b32 v68, 14880
  buffer_load_dwordx4 v[52:55], v76, s[8:11], s59 offen offset:0 sc1
  buffer_load_dwordx4 v[56:59], v76, s[8:11], s59 offen offset:1024 sc1
  ds_read_b128 v[36:39], v76 offset:24576
  ds_read_b128 v[40:43], v76 offset:25600
  ds_read_b128 v[60:63], v76 offset:26624
  ds_read_b128 v[64:67], v76 offset:27648
  ds_read_b128 v[0:3], v76 offset:4608
  ds_read_b128 v[4:7], v76 offset:5632
  ds_read_b128 v[8:11], v76 offset:6656
  ds_read_b128 v[12:15], v76 offset:7680
  s_waitcnt lgkmcnt(0)
  s_cmp_eq_u32 s66, 1
  s_branch Cf2_top2
.p2align 6
Cf2_h2:
  buffer_load_dwordx4 v[12:15], v76, s[8:11], s65 offen offset:3072 sc1
  ds_read_b128 v[36:39], v76 offset:24576
  s_waitcnt lgkmcnt(0)
  s_cmp_eq_u32 s66, 62
  s_cselect_b64 s[16:17], s[20:21], s[16:17]
  s_cselect_b32 s18, (Cf2_done - Cf2_last), s18
  s_cselect_b32 s70, 0, s70
  s_cmp_eq_u32 s66, 63
  s_cselect_b32 s59, 268435456, s59
  s_cselect_b32 s58, 268435456, s58
  buffer_load_dwordx4 v[12:15], v76, s[8:11], s65 offen offset:3072 sc1
  ds_read_b128 v[40:43], v76 offset:25600
  s_waitcnt lgkmcnt(0)
  v_mov_b64 v[20:21], 0
  v_mov_b64 v[22:23], 0
  v_mov_b64 v[24:25], 0
  v_mov_b64 v[26:27], 0
  v_mov_b32 v68, 14880
  v_lshlrev_b32 v73, 2, v76
  buffer_load_dwordx4 v[12:15], v76, s[8:11], s65 offen offset:3072 sc1
  buffer_load_dwordx4 v[52:55], v76, s[8:11], s59 offen offset:0 sc1
  buffer_load_dwordx4 v[56:59], v76, s[8:11], s59 offen offset:1024 sc1
  s_waitcnt vmcnt(4)
  v_max3_u32 v72, v12, v13, v14
  v_max_u32 v72, v72, v15
  ds_write_b128 v76, v[12:15] offset:7680
  v_cmp_eq_u32 vcc, -1, v72
  s_cbranch_vccnz Cf2_h2r
Cf2_h2w:
  s_cmp_eq_u32 s66, 63
  s_waitcnt lgkmcnt(0)
  s_barrier
  ds_read_b128 v[0:3], v76 offset:4608
  buffer_load_dwordx4 v76, s[8:11], s85 offen offset:0 sc1 lds
Cf2_top2:
  v_smfmac_f32_16x16x64_bf16 v[20:23], v[12:15], v[128:135], v74
  s_cbranch_scc1 Cf2_last
  v_smfmac_f32_16x16x64_bf16 v[24:27], v[12:15], v[136:143], v74
  buffer_load_dwordx4 v[44:47], v76, s[8:11], s58 offen offset:0 sc1
  s_mov_b32 m0, 15872
  v_smfmac_f32_16x16x64_bf16 v[28:31], v[12:15], v[224:231], v74
  buffer_load_dwordx4 v[48:51], v76, s[8:11], s58 offen offset:1024 sc1
  v_smfmac_f32_16x16x64_bf16 v[32:35], v[12:15], v[232:239], v74
  ds_read_b128 v[4:7], v76 offset:5632
  s_waitcnt lgkmcnt(1)
  v_smfmac_f32_16x16x64_bf16 v[20:23], v[0:3], v[80:87], v74
  ds_read_b128 v[8:11], v76 offset:6656
  v_smfmac_f32_16x16x64_bf16 v[28:31], v[0:3], v[36:43], v74
  ds_read_b128 v[36:39], v76 offset:40960
  v_smfmac_f32_16x16x64_bf16 v[24:27], v[0:3], v[88:95], v74
  buffer_store_dwordx4 v[16:19], v76, s[8:11], s68 offen sc1
  ds_read_b128 v[40:43], v76 offset:41984
  v_smfmac_f32_16x16x64_bf16 v[32:35], v[0:3], v[60:67], v74
  buffer_load_dword v73, s[16:19], s70 offen lds
  ds_read_b128 v[60:63], v76 offset:43008
  s_waitcnt lgkmcnt(4)
  v_smfmac_f32_16x16x64_bf16 v[20:23], v[4:7], v[96:103], v74
  ds_read_b128 v[64:67], v76 offset:44032
  v_smfmac_f32_16x16x64_bf16 v[24:27], v[4:7], v[104:111], v74
  s_waitcnt vmcnt(5)
  s_waitcnt lgkmcnt(4)
  v_smfmac_f32_16x16x64_bf16 v[20:23], v[8:11], v[112:119], v74
  s_barrier
  ds_read_b128 v[12:15], v76 offset:8704
  s_waitcnt lgkmcnt(3)
  v_smfmac_f32_16x16x64_bf16 v[28:31], v[4:7], v[36:43], v74
  ds_read_b128 v[36:39], v76 offset:57344
  v_smfmac_f32_16x16x64_bf16 v[24:27], v[8:11], v[120:127], v74
  ds_read_b128 v[40:43], v76 offset:58368
  s_waitcnt lgkmcnt(3)
  v_smfmac_f32_16x16x64_bf16 v[32:35], v[4:7], v[60:67], v74
  ds_read_b128 v[0:3], v76 offset:9728
  v_smfmac_f32_16x16x64_bf16 v[28:31], v[8:11], v[208:215], v74
  ds_read_b128 v[60:63], v76 offset:59392
  v_smfmac_f32_16x16x64_bf16 v[32:35], v[8:11], v[216:223], v74
  s_waitcnt vmcnt(4)
  ds_read_b128 v[64:67], v76 offset:60416
  s_waitcnt lgkmcnt(5)
  v_smfmac_f32_16x16x64_bf16 v[20:23], v[12:15], v[144:151], v74
  s_barrier
  ds_read_b128 v[4:7], v76 offset:11776
  s_waitcnt lgkmcnt(4)
  v_smfmac_f32_16x16x64_bf16 v[28:31], v[12:15], v[36:43], v74
  ds_read_b128 v[8:11], v76 offset:12800
  ds_read_b128 v[36:39], v75 offset:8192
  v_smfmac_f32_16x16x64_bf16 v[24:27], v[12:15], v[152:159], v74
  ds_read_b128 v[16:19], v76 offset:10752
  s_waitcnt lgkmcnt(6)
  v_smfmac_f32_16x16x64_bf16 v[20:23], v[0:3], v[160:167], v74
  ds_read_b128 v[40:43], v75 offset:9216
  s_waitcnt lgkmcnt(5)
  v_smfmac_f32_16x16x64_bf16 v[32:35], v[12:15], v[60:67], v74
  ds_read_b128 v[60:63], v75 offset:10240
  v_smfmac_f32_16x16x64_bf16 v[24:27], v[0:3], v[168:175], v74
  ds_read_b128 v[64:67], v75 offset:11264
  s_waitcnt lgkmcnt(6)
  v_smfmac_f32_16x16x64_bf16 v[20:23], v[4:7], v[176:183], v74
  s_waitcnt lgkmcnt(5)
  v_smfmac_f32_16x16x64_bf16 v[20:23], v[8:11], v[192:199], v74
  s_waitcnt lgkmcnt(2)
  v_smfmac_f32_16x16x64_bf16 v[20:23], v[16:19], v[36:43], v74
  ds_read_b128 v[36:39], v75 offset:24576
  v_smfmac_f32_16x16x64_bf16 v[24:27], v[4:7], v[184:191], v74
  ds_read_b128 v[40:43], v75 offset:25600
  s_waitcnt lgkmcnt(2)
  v_smfmac_f32_16x16x64_bf16 v[24:27], v[16:19], v[60:67], v74
  ds_read_b128 v[60:63], v75 offset:26624
  v_add_f32 v20, v20, v22
  v_smfmac_f32_16x16x64_bf16 v[24:27], v[8:11], v[200:207], v74
  ds_read_b128 v[64:67], v75 offset:27648
  v_add_f32 v21, v21, v23
  v_smfmac_f32_16x16x64_bf16 v[28:31], v[16:19], v[240:247], v74
  v_mov_b64 v[70:71], s[78:79]
  v_smfmac_f32_16x16x64_bf16 v[28:31], v[4:7], a[0:7], v74
  s_waitcnt lgkmcnt(2)
  v_add_f32 v24, v24, v26
  v_smfmac_f32_16x16x64_bf16 v[28:31], v[0:3], v[36:43], v74
  ds_read_b128 v[36:39], v68
  v_cvt_pk_bf16_f32 v22, v20, v24
  v_smfmac_f32_16x16x64_bf16 v[28:31], v[8:11], a[16:23], v74
  ds_read_b128 v[40:43], v68
  ds_write_b32 v79, v22 offset:0
  s_waitcnt lgkmcnt(3)
  v_add_f32 v25, v25, v27
  v_cvt_pk_bf16_f32 v23, v21, v25
  v_smfmac_f32_16x16x64_bf16 v[32:35], v[0:3], v[60:67], v74
  ds_write_b32 v79, v23 offset:576
  v_cmp_u_f32 vcc, v20, v21
  v_smfmac_f32_16x16x64_bf16 v[32:35], v[16:19], v[248:255], v74
  v_add_f32 v28, v28, v30
  v_smfmac_f32_16x16x64_bf16 v[32:35], v[4:7], a[8:15], v74
  v_add_f32 v29, v29, v31
  v_smfmac_f32_16x16x64_bf16 v[32:35], v[8:11], a[24:31], v74
  s_cbranch_vccnz Cf2_rec
Cf2_recok:
  s_waitcnt lgkmcnt(3)
  v_smfmac_f32_16x16x64_bf16 v[36:39], v[16:19], a[128:135], v74
  s_waitcnt lgkmcnt(0)
  s_barrier
  ds_read_b128 v[60:63], v77
  v_smfmac_f32_16x16x64_bf16 v[40:43], v[16:19], a[136:143], v74
  ds_read_b128 v[64:67], v77 offset:128
  v_add_f32 v32, v32, v34
  v_cvt_pk_bf16_f32 v30, v28, v32
  v_smfmac_f32_16x16x64_bf16 v[36:39], v[0:3], a[112:119], v74
  ds_write_b32 v79, v30 offset:256
  v_add_f32 v33, v33, v35
  v_cvt_pk_bf16_f32 v31, v29, v33
  v_smfmac_f32_16x16x64_bf16 v[40:43], v[0:3], a[120:127], v74
  ds_write_b32 v79, v31 offset:832
  v_xor_b32 v75, 0x8000, v75
  v_smfmac_f32_16x16x64_bf16 v[36:39], v[4:7], a[144:151], v74
  ds_read_b128 v[0:3], v76 offset:4608
  v_mov_b32 v29, 0
  v_smfmac_f32_16x16x64_bf16 v[40:43], v[4:7], a[152:159], v74
  s_waitcnt vmcnt(2) lgkmcnt(3)
  v_mov_b32 v30, 0
  v_mfma_f32_16x16x32_bf16 v[44:47], v[44:47], v[60:63], 0
  ds_read_b128 v[4:7], v76 offset:5632
  s_waitcnt lgkmcnt(2)
  v_mfma_f32_16x16x32_bf16 v[44:47], v[48:51], v[64:67], v[44:47]
  s_barrier
  v_smfmac_f32_16x16x64_bf16 v[36:39], v[8:11], a[160:167], v74
  ds_read_b128 v[20:23], v77 offset:256
  ds_read_b128 v[24:27], v77 offset:384
  v_smfmac_f32_16x16x64_bf16 v[40:43], v[8:11], a[168:175], v74
  ds_read_b128 v[8:11], v76 offset:6656
  v_add_f32_dpp v72, v46, v44 quad_perm:[2,3,0,1] row_mask:0xf bank_mask:0xf
  v_add_f32_dpp v73, v47, v45 quad_perm:[2,3,0,1] row_mask:0xf bank_mask:0xf
  v_smfmac_f32_16x16x64_bf16 v[36:39], v[12:15], a[96:103], v74
  s_waitcnt lgkmcnt(4)
  v_exp_f32_dpp v72, v72 quad_perm:[0,1,0,1] row_mask:0xf bank_mask:0xf
  v_smfmac_f32_16x16x64_bf16 v[40:43], v[12:15], a[104:111], v74
  ds_read_b128 v[12:15], v76 offset:7680
  v_exp_f32_dpp v73, v73 quad_perm:[0,1,0,1] row_mask:0xf bank_mask:0xf
  v_smfmac_f32_16x16x64_bf16 v[36:39], v[0:3], a[32:39], v74
  s_waitcnt lgkmcnt(2)
  v_cvt_pk_bf16_f32 v72, v72, v73
  v_mfma_f32_16x16x32_bf16 v[20:23], v[20:23], v[60:63], 0
  ds_write_b32 v78, v72 offset:520
  v_mov_b64 v[16:17], 0
  v_mfma_f32_16x16x32_bf16 v[20:23], v[24:27], v[64:67], v[20:23]
  ds_read_b128 v[44:47], v75 offset:40960
  v_mov_b64 v[18:19], 0
  v_smfmac_f32_16x16x64_bf16 v[40:43], v[0:3], a[40:47], v74
  ds_read_b128 v[48:51], v75 offset:41984
  v_mov_b64 v[68:69], s[78:79]
  v_smfmac_f32_16x16x64_bf16 v[36:39], v[4:7], a[48:55], v74
  s_waitcnt lgkmcnt(4)
  v_add_f32_dpp v24, v22, v20 quad_perm:[2,3,0,1] row_mask:0xf bank_mask:0xf
  v_add_f32_dpp v25, v23, v21 quad_perm:[2,3,0,1] row_mask:0xf bank_mask:0xf
  v_smfmac_f32_16x16x64_bf16 v[36:39], v[8:11], a[64:71], v74
  s_waitcnt lgkmcnt(2)
  s_barrier
  ds_read_b128 v[32:35], v78 offset:512
  v_smfmac_f32_16x16x64_bf16 v[36:39], v[12:15], a[80:87], v74
  ds_read_b128 v[60:63], v75 offset:24576
  v_mul_f32 v24, s69, v24
  v_smfmac_f32_16x16x64_bf16 v[40:43], v[4:7], a[56:63], v74
  ds_read_b128 v[64:67], v75 offset:25600
  v_mul_f32 v25, s69, v25
  v_smfmac_f32_16x16x64_bf16 v[40:43], v[8:11], a[72:79], v74
  v_exp_f32_dpp v24, v24 quad_perm:[0,1,0,1] row_mask:0xf bank_mask:0xf
  v_smfmac_f32_16x16x64_bf16 v[40:43], v[12:15], a[88:95], v74
  s_waitcnt lgkmcnt(2)
  v_exp_f32_dpp v25, v25 quad_perm:[0,1,0,1] row_mask:0xf bank_mask:0xf
  v_mfma_f32_16x16x32_bf16 v[8:11], v[32:35], v[68:71], 0
  v_add_f32 v36, v36, v38
  v_add_f32 v37, v37, v39
  v_mfma_f32_16x16x32_bf16 v[0:3], v[32:35], v[52:55], 0
  v_add_f32 v40, v40, v42
  v_add_f32 v41, v41, v43
  v_mfma_f32_16x16x32_bf16 v[4:7], v[32:35], v[56:59], 0
  v_cvt_pk_bf16_f32 v28, v24, v25
  v_cvt_pk_bf16_f32 v72, v36, v37
  v_cvt_pk_bf16_f32 v73, v40, v41
  v_mfma_f32_16x16x16_bf16 v[8:11], v[28:29], v[68:69], v[8:11]
  v_cvt_pk_bf16_f32 v31, v24, v25
  v_mov_b64 v[20:21], 0
  v_mfma_f32_16x16x16_bf16 v[0:3], v[28:29], v[72:73], v[0:3]
  ds_read_b128 v[52:55], v75 offset:26624
  v_mov_b64 v[22:23], 0
  v_mfma_f32_16x16x16_bf16 v[4:7], v[30:31], v[72:73], v[4:7]
  v_rcp_f32 v10, v8
  v_rcp_f32 v11, v9
  v_mul_f32 v0, v10, v0
  v_mul_f32 v1, v11, v1
  v_max3_f32 v8, v8, v9, v10
  v_mul_f32 v4, v10, v4
  v_mul_f32 v5, v11, v5
  v_cvt_pk_bf16_f32 v2, v0, v4
  ds_write_b32 v79, v2 offset:8704
  v_cvt_pk_bf16_f32 v3, v1, v5
  ds_write_b32 v79, v3 offset:9280
  ds_read_b128 v[12:15], v78 offset:8832
  v_max_f32 v8, v8, v11
  v_cmp_le_f32 vcc, 1317011456, v8
  v_mov_b64 v[24:25], 0
  v_mov_b64 v[26:27], 0
  ds_read_b128 v[56:59], v75 offset:27648
  s_cbranch_vccnz Cf2_mx
Cf2_mxok:
  s_waitcnt lgkmcnt(2)
  s_barrier
  ds_read_b128 v[0:3], v78 offset:8896
  s_waitcnt lgkmcnt(2)
  v_smfmac_f32_16x16x64_bf16 v[16:19], v[12:15], a[176:183], v74
  ds_read_b128 v[4:7], v78 offset:8704
  v_smfmac_f32_16x16x64_bf16 v[20:23], v[12:15], v[44:51], v74
  ds_read_b128 v[8:11], v78 offset:8768
  v_smfmac_f32_16x16x64_bf16 v[24:27], v[12:15], a[224:231], v74
  ds_read_b128 v[36:39], v75 offset:43008
  s_waitcnt lgkmcnt(3)
  v_smfmac_f32_16x16x64_bf16 v[16:19], v[0:3], a[184:191], v74
  ds_read_b128 v[40:43], v75 offset:44032
  s_waitcnt lgkmcnt(3)
  v_smfmac_f32_16x16x64_bf16 v[16:19], v[4:7], v[60:67], v74
  ds_read_b128 v[68:71], v76 offset:13824
  s_waitcnt lgkmcnt(3)
  v_smfmac_f32_16x16x64_bf16 v[16:19], v[8:11], v[52:59], v74
  ds_read_b128 v[44:47], v75 offset:57344
  v_smfmac_f32_16x16x64_bf16 v[20:23], v[4:7], a[192:199], v74
  ds_read_b128 v[48:51], v75 offset:58368
  v_smfmac_f32_16x16x64_bf16 v[20:23], v[8:11], a[200:207], v74
  ds_read_b128 v[60:63], v75 offset:59392
  s_waitcnt lgkmcnt(4)
  v_cvt_pk_bf16_f32 v16, v16, v17
  v_cvt_pk_bf16_f32 v17, v18, v19
  v_bfi_b32 v16, 1, s72, v16
  v_smfmac_f32_16x16x64_bf16 v[20:23], v[0:3], v[36:43], v74
  s_waitcnt lgkmcnt(3)
  buffer_store_dwordx2 v[16:17], v68, s[8:11], s73 offen
  v_mov_b64 v[32:33], 0
  v_smfmac_f32_16x16x64_bf16 v[24:27], v[4:7], a[208:215], v74
  ds_read_b128 v[64:67], v75 offset:60416
  v_mov_b64 v[34:35], 0
  v_smfmac_f32_16x16x64_bf16 v[24:27], v[8:11], a[216:223], v74
  ds_read_b128 v[52:55], v75 offset:0
  v_cvt_pk_bf16_f32 v20, v20, v21
  v_cvt_pk_bf16_f32 v21, v22, v23
  v_bfi_b32 v20, 1, s72, v20
  v_smfmac_f32_16x16x64_bf16 v[24:27], v[0:3], a[232:239], v74
  ds_read_b128 v[56:59], v75 offset:1024
  buffer_store_dwordx2 v[20:21], v68, s[8:11], s74 offen
  s_waitcnt lgkmcnt(4)
  v_mov_b64 v[28:29], 0
  v_smfmac_f32_16x16x64_bf16 v[32:35], v[4:7], v[44:51], v74
  ds_read_b128 v[36:39], v75 offset:2048
  ds_read_b128 v[40:43], v75 offset:3072
  s_waitcnt lgkmcnt(4)
  v_smfmac_f32_16x16x64_bf16 v[32:35], v[8:11], v[60:67], v74
  ds_read_b128 v[44:47], v75 offset:4096
  v_cvt_pk_bf16_f32 v24, v24, v25
  v_cvt_pk_bf16_f32 v25, v26, v27
  v_bfi_b32 v24, 1, s72, v24
  v_smfmac_f32_16x16x64_bf16 v[32:35], v[12:15], a[240:247], v74
  ds_read_b128 v[48:51], v75 offset:5120
  buffer_store_dwordx2 v[24:25], v68, s[8:11], s75 offen
  v_mov_b64 v[30:31], 0
  v_smfmac_f32_16x16x64_bf16 v[32:35], v[0:3], a[248:255], v74
  ds_read_b128 v[60:63], v75 offset:6144
  ds_read_b128 v[64:67], v75 offset:7168
  s_waitcnt lgkmcnt(6)
  v_smfmac_f32_16x16x64_bf16 v[28:31], v[4:7], v[52:59], v74
  s_waitcnt lgkmcnt(4)
  v_smfmac_f32_16x16x64_bf16 v[28:31], v[8:11], v[36:43], v74
  s_waitcnt lgkmcnt(2)
  v_cvt_pk_bf16_f32 v32, v32, v33
  v_cvt_pk_bf16_f32 v33, v34, v35
  v_bfi_b32 v32, 1, s72, v32
  v_smfmac_f32_16x16x64_bf16 v[28:31], v[12:15], v[44:51], v74
  buffer_store_dwordx2 v[32:33], v68, s[8:11], s76 offen
  s_waitcnt lgkmcnt(0)
  v_smfmac_f32_16x16x64_bf16 v[28:31], v[0:3], v[60:67], v74
  v_mov_b64 v[18:19], v[72:73]
  s_nop 4
  v_cvt_pk_bf16_f32 v28, v28, v29
  v_cvt_pk_bf16_f32 v29, v30, v31
  v_bfi_b32 v28, 1, s72, v28
  buffer_store_dwordx2 v[28:29], v68, s[8:11], s77 offen
  ds_read_b128 v[0:3], v76 offset:14848
  s_waitcnt lgkmcnt(0)
  ds_read_b64 v[16:17], v77 offset:384
  s_waitcnt lgkmcnt(0)
  ds_read_b128 v[64:67], v76 offset:27648
  s_waitcnt lgkmcnt(0)
  ds_read_b128 v[60:63], v76 offset:26624
  s_waitcnt lgkmcnt(0)
  v_xor_b32 v75, 0x8000, v75
  v_mov_b64 v[28:29], 0
  v_mov_b64 v[30:31], 0
  v_mov_b64 v[32:33], 0
  v_mov_b64 v[34:35], 0
  buffer_load_dwordx4 v[52:55], v76, s[8:11], s60 offen offset:0 sc1
  buffer_load_dwordx4 v[56:59], v76, s[8:11], s60 offen offset:1024 sc1
  s_add_u32 s66, s66, 1
  s_xor_b32 s64, s64, 16384
  s_xor_b32 s65, s65, 16384
  s_add_u32 s58, s58, 655360
  s_add_u32 s59, s59, 655360
  s_add_u32 s70, s70, 655360
  s_add_u32 s68, s68, 655360
  s_mov_b32 m0, 12800
  s_add_u32 s85, s65, 8192
  s_waitcnt lgkmcnt(0)
  s_waitcnt vmcnt(1)
  v_mfma_f32_16x16x32_bf16 v[4:7], v[0:3], v[52:55], 0
  v_bitop3_b32 v72, v52, v54, s72 bitop3:0x7e
  s_waitcnt vmcnt(0)
  v_mfma_f32_16x16x32_bf16 v[4:7], v[0:3], v[56:59], v[4:7]
  v_bitop3_b32 v73, v56, v58, s72 bitop3:0x7e
  v_bitop3_b32 v72, v72, v73, 1 bitop3:0xa8
  v_cmp_ne_u32 vcc, 0, v72
  s_nop 3
  v_add_f32_dpp v4, v4, v4 row_ror:4 row_mask:0xf bank_mask:0xf
  v_add_f32_dpp v5, v5, v5 row_ror:4 row_mask:0xf bank_mask:0xf
  s_cmp_eq_u64 vcc, 0
  v_add_f32_dpp v4, v4, v4 row_ror:8 row_mask:0xf bank_mask:0xf
  v_add_f32_dpp v5, v5, v5 row_ror:8 row_mask:0xf bank_mask:0xf
  s_cselect_b32 s54, s62, 268435456
  v_cvt_pk_bf16_f32 v4, v4, v5
  buffer_store_dword v4, v69, s[8:11], s54 offen
  s_cbranch_vccnz Cf2_h1r
  s_xor_b32 s62, s62, 16384
  buffer_store_dword v71, v69, s[8:11], s62 offen
  s_xor_b32 s72, s72, 1
  s_branch Cf2_h2
Cf2_h1r:
  s_mov_b64 exec, vcc
  buffer_load_dwordx4 v[52:55], v76, s[8:11], s60 offen offset:0 sc1
  buffer_load_dwordx4 v[56:59], v76, s[8:11], s60 offen offset:1024 sc1
  s_mov_b64 exec, -1
  s_add_u32 s67, s67, 1
  s_waitcnt vmcnt(1)
  v_mfma_f32_16x16x32_bf16 v[4:7], v[0:3], v[52:55], 0
  v_bitop3_b32 v72, v52, v54, s72 bitop3:0x7e
  s_waitcnt vmcnt(0)
  v_mfma_f32_16x16x32_bf16 v[4:7], v[0:3], v[56:59], v[4:7]
  v_bitop3_b32 v73, v56, v58, s72 bitop3:0x7e
  v_bitop3_b32 v72, v72, v73, 1 bitop3:0xa8
  v_cmp_ne_u32 vcc, 0, v72
  s_cbranch_vccz Cf2_h1p
Cf2_h1s:
  s_mov_b64 exec, vcc
  buffer_load_dwordx4 v[52:55], v76, s[8:11], s60 offen offset:0 sc1
  buffer_load_dwordx4 v[56:59], v76, s[8:11], s60 offen offset:1024 sc1
  s_mov_b64 exec, -1
  s_add_u32 s67, s67, 1
  s_waitcnt vmcnt(1)
  v_mfma_f32_16x16x32_bf16 v[4:7], v[0:3], v[52:55], 0
  v_bitop3_b32 v72, v52, v54, s72 bitop3:0x7e
  s_waitcnt vmcnt(0)
  v_mfma_f32_16x16x32_bf16 v[4:7], v[0:3], v[56:59], v[4:7]
  v_bitop3_b32 v73, v56, v58, s72 bitop3:0x7e
  v_bitop3_b32 v72, v72, v73, 1 bitop3:0xa8
  v_cmp_ne_u32 vcc, 0, v72
  s_cbranch_vccz Cf2_h1p
  s_cmp_lt_u32 s67, 131072
  s_cbranch_scc1 Cf2_h1s
Cf2_h1p:
  s_nop 2
  v_add_f32_dpp v4, v4, v4 row_ror:4 row_mask:0xf bank_mask:0xf
  v_add_f32_dpp v5, v5, v5 row_ror:4 row_mask:0xf bank_mask:0xf
  s_nop 0
  v_add_f32_dpp v4, v4, v4 row_ror:8 row_mask:0xf bank_mask:0xf
  v_add_f32_dpp v5, v5, v5 row_ror:8 row_mask:0xf bank_mask:0xf
  v_cvt_pk_bf16_f32 v4, v4, v5
  buffer_store_dword v4, v69, s[8:11], s62 offen
  s_xor_b32 s62, s62, 16384
  buffer_store_dword v71, v69, s[8:11], s62 offen
  s_xor_b32 s72, s72, 1
  s_branch Cf2_h2
Cf2_h2r:
  s_mov_b64 exec, vcc
  buffer_load_dwordx4 v[12:15], v76, s[8:11], s65 offen offset:3072 sc1
  s_mov_b64 exec, -1
  s_add_u32 s67, s67, 1
  s_waitcnt vmcnt(4)
  v_max3_u32 v72, v12, v13, v14
  v_max_u32 v72, v72, v15
  ds_write_b128 v76, v[12:15] offset:7680
  v_cmp_eq_u32 vcc, -1, v72
  s_cbranch_vccz Cf2_h2w
  s_mov_b64 exec, vcc
  buffer_load_dwordx4 v[12:15], v76, s[8:11], s65 offen offset:3072 sc1
  s_mov_b64 exec, -1
  s_add_u32 s67, s67, 1
  s_waitcnt vmcnt(4)
  v_max3_u32 v72, v12, v13, v14
  v_max_u32 v72, v72, v15
  ds_write_b128 v76, v[12:15] offset:7680
  v_cmp_eq_u32 vcc, -1, v72
  s_cbranch_vccz Cf2_h2w
Cf2_h2s:
  s_mov_b64 exec, vcc
  buffer_load_dwordx4 v[12:15], v76, s[8:11], s65 offen offset:3072 sc1
  s_mov_b64 exec, -1
  s_add_u32 s67, s67, 1
  s_waitcnt vmcnt(2)
  v_max3_u32 v72, v12, v13, v14
  v_max_u32 v72, v72, v15
  ds_write_b128 v76, v[12:15] offset:7680
  v_cmp_eq_u32 vcc, -1, v72
  s_cbranch_vccz Cf2_h2w
  s_mov_b64 exec, vcc
  buffer_load_dwordx4 v[12:15], v76, s[8:11], s65 offen offset:3072 sc1
  s_mov_b64 exec, -1
  s_add_u32 s67, s67, 1
  s_waitcnt vmcnt(2)
  v_max3_u32 v72, v12, v13, v14
  v_max_u32 v72, v72, v15
  ds_write_b128 v76, v[12:15] offset:7680
  v_cmp_eq_u32 vcc, -1, v72
  s_cbranch_vccz Cf2_h2w
  s_mov_b64 exec, vcc
  buffer_load_dwordx4 v[12:15], v76, s[8:11], s65 offen offset:3072 sc1
  s_mov_b64 exec, -1
  s_add_u32 s67, s67, 1
  s_waitcnt vmcnt(2)
  v_max3_u32 v72, v12, v13, v14
  v_max_u32 v72, v72, v15
  ds_write_b128 v76, v[12:15] offset:7680
  v_cmp_eq_u32 vcc, -1, v72
  s_cbranch_vccz Cf2_h2w
  s_cmp_lt_u32 s67, 131072
  s_cbranch_scc1 Cf2_h2s
  s_branch Cf2_h2w
Cf2_rec:
  s_nop 7
  s_waitcnt vmcnt(0) lgkmcnt(0)
  v_max3_u32 v72, v0, v1, v2
  v_max3_u32 v72, v72, v3, v4
  v_max3_u32 v72, v72, v5, v6
  v_max3_u32 v72, v72, v7, v8
  v_max3_u32 v72, v72, v9, v10
  v_max3_u32 v72, v72, v11, v12
  v_max3_u32 v72, v72, v13, v14
  v_max3_u32 v72, v72, v15, v16
  v_max3_u32 v72, v72, v17, v18
  v_max_u32 v72, v72, v19
  v_cmp_eq_u32 vcc, -1, v72
  s_cbranch_vccz Cf2_recok
  s_barrier
Cf2_recp:
  buffer_load_dwordx4 v[0:3], v76, s[8:11], s64 offen offset:0 sc1
  buffer_load_dwordx4 v[4:7], v76, s[8:11], s64 offen offset:1024 sc1
  s_add_u32 s67, s67, 1
  s_cmp_lt_u32 s67, 131072
  s_cselect_b32 s54, -2, -1
  s_waitcnt vmcnt(1)
  v_max3_u32 v72, v0, v1, v2
  s_waitcnt vmcnt(0)
  v_max3_u32 v72, v72, v3, v4
  v_max3_u32 v72, v72, v5, v6
  v_max_u32 v72, v72, v7
  v_cmp_lt_u32 vcc, s54, v72
  s_cbranch_vccnz Cf2_recp
  ds_write_b128 v76, v[0:3] offset:8704
  ds_write_b128 v76, v[4:7] offset:9728
  v_mov_b64 v[20:21], 0
  v_mov_b64 v[22:23], 0
  v_mov_b64 v[24:25], 0
  v_mov_b64 v[26:27], 0
  v_mov_b64 v[28:29], 0
  v_mov_b64 v[30:31], 0
  v_mov_b64 v[32:33], 0
  v_mov_b64 v[34:35], 0
  s_waitcnt lgkmcnt(0)
  s_barrier
  ds_read_b128 v[0:3], v76 offset:4608
  s_waitcnt lgkmcnt(0)
  v_smfmac_f32_16x16x64_bf16 v[20:23], v[0:3], v[80:87], v74
  v_smfmac_f32_16x16x64_bf16 v[24:27], v[0:3], v[88:95], v74
  ds_read_b128 v[60:63], v76 offset:24576
  ds_read_b128 v[64:67], v76 offset:25600
  s_waitcnt lgkmcnt(0)
  v_smfmac_f32_16x16x64_bf16 v[28:31], v[0:3], v[60:67], v74
  ds_read_b128 v[60:63], v76 offset:26624
  ds_read_b128 v[64:67], v76 offset:27648
  s_waitcnt lgkmcnt(0)
  v_smfmac_f32_16x16x64_bf16 v[32:35], v[0:3], v[60:67], v74
  ds_read_b128 v[4:7], v76 offset:5632
  s_waitcnt lgkmcnt(0)
  v_smfmac_f32_16x16x64_bf16 v[20:23], v[4:7], v[96:103], v74
  v_smfmac_f32_16x16x64_bf16 v[24:27], v[4:7], v[104:111], v74
  ds_read_b128 v[60:63], v76 offset:40960
  ds_read_b128 v[64:67], v76 offset:41984
  s_waitcnt lgkmcnt(0)
  v_smfmac_f32_16x16x64_bf16 v[28:31], v[4:7], v[60:67], v74
  ds_read_b128 v[60:63], v76 offset:43008
  ds_read_b128 v[64:67], v76 offset:44032
  s_waitcnt lgkmcnt(0)
  v_smfmac_f32_16x16x64_bf16 v[32:35], v[4:7], v[60:67], v74
  ds_read_b128 v[8:11], v76 offset:6656
  s_waitcnt lgkmcnt(0)
  v_smfmac_f32_16x16x64_bf16 v[20:23], v[8:11], v[112:119], v74
  v_smfmac_f32_16x16x64_bf16 v[24:27], v[8:11], v[120:127], v74
  v_smfmac_f32_16x16x64_bf16 v[28:31], v[8:11], v[208:215], v74
  v_smfmac_f32_16x16x64_bf16 v[32:35], v[8:11], v[216:223], v74
  ds_read_b128 v[12:15], v76 offset:7680
  s_waitcnt lgkmcnt(0)
  v_smfmac_f32_16x16x64_bf16 v[20:23], v[12:15], v[128:135], v74
  v_smfmac_f32_16x16x64_bf16 v[24:27], v[12:15], v[136:143], v74
  v_smfmac_f32_16x16x64_bf16 v[28:31], v[12:15], v[224:231], v74
  v_smfmac_f32_16x16x64_bf16 v[32:35], v[12:15], v[232:239], v74
  ds_read_b128 v[12:15], v76 offset:8704
  s_waitcnt lgkmcnt(0)
  v_smfmac_f32_16x16x64_bf16 v[20:23], v[12:15], v[144:151], v74
  v_smfmac_f32_16x16x64_bf16 v[24:27], v[12:15], v[152:159], v74
  ds_read_b128 v[60:63], v76 offset:57344
  ds_read_b128 v[64:67], v76 offset:58368
  s_waitcnt lgkmcnt(0)
  v_smfmac_f32_16x16x64_bf16 v[28:31], v[12:15], v[60:67], v74
  ds_read_b128 v[60:63], v76 offset:59392
  ds_read_b128 v[64:67], v76 offset:60416
  s_waitcnt lgkmcnt(0)
  v_smfmac_f32_16x16x64_bf16 v[32:35], v[12:15], v[60:67], v74
  ds_read_b128 v[0:3], v76 offset:9728
  s_waitcnt lgkmcnt(0)
  v_smfmac_f32_16x16x64_bf16 v[20:23], v[0:3], v[160:167], v74
  v_smfmac_f32_16x16x64_bf16 v[24:27], v[0:3], v[168:175], v74
  ds_read_b128 v[60:63], v75 offset:24576
  ds_read_b128 v[64:67], v75 offset:25600
  s_waitcnt lgkmcnt(0)
  v_smfmac_f32_16x16x64_bf16 v[28:31], v[0:3], v[60:67], v74
  ds_read_b128 v[60:63], v75 offset:26624
  ds_read_b128 v[64:67], v75 offset:27648
  s_waitcnt lgkmcnt(0)
  v_smfmac_f32_16x16x64_bf16 v[32:35], v[0:3], v[60:67], v74
  ds_read_b128 v[16:19], v76 offset:10752
  ds_read_b128 v[60:63], v75 offset:8192
  ds_read_b128 v[64:67], v75 offset:9216
  s_waitcnt lgkmcnt(0)
  v_smfmac_f32_16x16x64_bf16 v[20:23], v[16:19], v[60:67], v74
  ds_read_b128 v[60:63], v75 offset:10240
  ds_read_b128 v[64:67], v75 offset:11264
  s_waitcnt lgkmcnt(0)
  v_smfmac_f32_16x16x64_bf16 v[24:27], v[16:19], v[60:67], v74
  v_smfmac_f32_16x16x64_bf16 v[28:31], v[16:19], v[240:247], v74
  v_smfmac_f32_16x16x64_bf16 v[32:35], v[16:19], v[248:255], v74
  ds_read_b128 v[4:7], v76 offset:11776
  s_waitcnt lgkmcnt(0)
  v_smfmac_f32_16x16x64_bf16 v[20:23], v[4:7], v[176:183], v74
  v_smfmac_f32_16x16x64_bf16 v[24:27], v[4:7], v[184:191], v74
  v_smfmac_f32_16x16x64_bf16 v[28:31], v[4:7], a[0:7], v74
  v_smfmac_f32_16x16x64_bf16 v[32:35], v[4:7], a[8:15], v74
  ds_read_b128 v[8:11], v76 offset:12800
  s_waitcnt lgkmcnt(0)
  v_smfmac_f32_16x16x64_bf16 v[20:23], v[8:11], v[192:199], v74
  v_smfmac_f32_16x16x64_bf16 v[24:27], v[8:11], v[200:207], v74
  v_smfmac_f32_16x16x64_bf16 v[28:31], v[8:11], a[16:23], v74
  v_smfmac_f32_16x16x64_bf16 v[32:35], v[8:11], a[24:31], v74
  v_add_f32 v20, v20, v22
  v_add_f32 v21, v21, v23
  v_add_f32 v24, v24, v26
  v_cvt_pk_bf16_f32 v22, v20, v24
  ds_write_b32 v79, v22 offset:0
  v_add_f32 v25, v25, v27
  v_cvt_pk_bf16_f32 v23, v21, v25
  ds_write_b32 v79, v23 offset:576
  v_add_f32 v28, v28, v30
  v_add_f32 v29, v29, v31
  s_waitcnt lgkmcnt(0)
  s_nop 1
  s_branch Cf2_recok
Cf2_mx:
  s_waitcnt lgkmcnt(0)
  s_barrier
  buffer_load_dwordx4 v[52:55], v76, s[8:11], s59 offen offset:0 sc1
  buffer_load_dwordx4 v[0:3], v76, s[8:11], s58 offen offset:0 sc1
  ds_read_b128 v[20:23], v77 offset:0
  ds_read_b128 v[28:31], v77 offset:256
  buffer_load_dwordx4 v[56:59], v76, s[8:11], s59 offen offset:1024 sc1
  buffer_load_dwordx4 v[4:7], v76, s[8:11], s58 offen offset:1024 sc1
  ds_read_b128 v[24:27], v77 offset:128
  ds_read_b128 v[32:35], v77 offset:384
  s_waitcnt vmcnt(2) lgkmcnt(3)
  v_mfma_f32_16x16x32_bf16 v[8:11], v[0:3], v[20:23], 0
  s_waitcnt vmcnt(0) lgkmcnt(1)
  v_mfma_f32_16x16x32_bf16 v[8:11], v[4:7], v[24:27], v[8:11]
  v_mfma_f32_16x16x32_bf16 v[12:15], v[28:31], v[20:23], 0
  s_waitcnt lgkmcnt(0)
  v_mfma_f32_16x16x32_bf16 v[12:15], v[32:35], v[24:27], v[12:15]
  v_add_f32_dpp v8, v10, v8 quad_perm:[2,3,0,1] row_mask:0xf bank_mask:0xf
  v_add_f32_dpp v9, v11, v9 quad_perm:[2,3,0,1] row_mask:0xf bank_mask:0xf
  s_nop 0
  v_mov_b32_dpp v8, v8 quad_perm:[0,1,0,1] row_mask:0xf bank_mask:0xf
  v_mov_b32_dpp v9, v9 quad_perm:[0,1,0,1] row_mask:0xf bank_mask:0xf
  s_nop 1
  v_add_f32_dpp v12, v14, v12 quad_perm:[2,3,0,1] row_mask:0xf bank_mask:0xf
  v_add_f32_dpp v13, v15, v13 quad_perm:[2,3,0,1] row_mask:0xf bank_mask:0xf
  s_nop 0
  v_mov_b32_dpp v12, v12 quad_perm:[0,1,0,1] row_mask:0xf bank_mask:0xf
  v_mov_b32_dpp v13, v13 quad_perm:[0,1,0,1] row_mask:0xf bank_mask:0xf
  v_mul_f32 v12, s69, v12
  ds_write_b32 v78, v8 offset:8712
  v_mul_f32 v13, s69, v13
  ds_write_b32 v78, v9 offset:8776
  s_waitcnt lgkmcnt(0)
  s_barrier
  ds_read_b128 v[36:39], v78 offset:8704
  ds_read_b128 v[40:43], v78 offset:8768
  s_waitcnt lgkmcnt(0)
  s_barrier
  v_max_f32 v16, v36, v37
  v_max3_f32 v16, v16, v38, v39
  v_max3_f32 v16, v16, v40, v41
  v_max3_f32 v16, v16, v42, v43
  v_max3_f32 v16, v16, v12, v13
  v_mov_b32 v17, v16
  s_nop 1
  v_permlane16_swap_b32 v16, v17
  v_max_f32 v16, v16, v17
  v_mov_b32 v17, v16
  s_nop 1
  v_permlane32_swap_b32 v16, v17
  v_max_f32 v16, v16, v17
  v_sub_f32 v36, v36, v16
  v_sub_f32 v37, v37, v16
  v_sub_f32 v38, v38, v16
  v_sub_f32 v39, v39, v16
  v_sub_f32 v40, v40, v16
  v_sub_f32 v41, v41, v16
  v_sub_f32 v42, v42, v16
  v_sub_f32 v43, v43, v16
  v_sub_f32 v12, v12, v16
  v_sub_f32 v13, v13, v16
  v_exp_f32 v36, v36
  v_exp_f32 v37, v37
  v_exp_f32 v38, v38
  v_exp_f32 v39, v39
  v_exp_f32 v40, v40
  v_exp_f32 v41, v41
  v_exp_f32 v42, v42
  v_exp_f32 v43, v43
  v_exp_f32 v12, v12
  v_exp_f32 v13, v13
  v_cvt_pk_bf16_f32 v32, v36, v40
  v_cvt_pk_bf16_f32 v33, v37, v41
  v_cvt_pk_bf16_f32 v34, v38, v42
  v_cvt_pk_bf16_f32 v35, v39, v43
  v_cvt_pk_bf16_f32 v28, v12, v13
  v_cvt_pk_bf16_f32 v31, v12, v13
  v_mov_b32 v29, 0
  v_mov_b32 v30, 0
  v_mfma_f32_16x16x32_bf16 v[8:11], v[32:35], v[68:71], 0
  v_mfma_f32_16x16x32_bf16 v[0:3], v[32:35], v[52:55], 0
  v_mfma_f32_16x16x32_bf16 v[4:7], v[32:35], v[56:59], 0
  v_mfma_f32_16x16x16_bf16 v[8:11], v[28:29], v[68:69], v[8:11]
  v_mfma_f32_16x16x16_bf16 v[0:3], v[28:29], v[72:73], v[0:3]
  v_mfma_f32_16x16x16_bf16 v[4:7], v[30:31], v[72:73], v[4:7]
  ds_read_b128 v[52:55], v75 offset:26624
  v_rcp_f32 v10, v8
  v_rcp_f32 v11, v9
  v_mul_f32 v0, v10, v0
  v_mul_f32 v1, v11, v1
  v_max3_f32 v8, v8, v9, v10
  v_mul_f32 v4, v10, v4
  v_mul_f32 v5, v11, v5
  v_cvt_pk_bf16_f32 v2, v0, v4
  ds_write_b32 v79, v2 offset:8704
  v_cvt_pk_bf16_f32 v3, v1, v5
  ds_write_b32 v79, v3 offset:9280
  ds_read_b128 v[12:15], v78 offset:8832
  ds_read_b128 v[56:59], v75 offset:27648
  v_mov_b64 v[16:17], 0
  v_mov_b64 v[18:19], 0
  v_mov_b64 v[20:21], 0
  v_mov_b64 v[22:23], 0
  v_mov_b64 v[24:25], 0
  v_mov_b64 v[26:27], 0
  s_branch Cf2_mxok
Cf2_last:
  ds_read_b128 v[4:7], v76 offset:5632
  ds_read_b128 v[8:11], v76 offset:6656
  ds_read_b128 v[44:47], v76 offset:40960
  ds_read_b128 v[48:51], v76 offset:41984
  s_nop 5
  v_mov_b64 v[20:21], 0
  v_mov_b64 v[22:23], 0
  v_mov_b64 v[24:25], 0
  v_mov_b64 v[26:27], 0
  s_waitcnt lgkmcnt(4)
  v_smfmac_f32_16x16x64_bf16 v[28:31], v[0:3], v[36:43], v74
  ds_read_b128 v[36:39], v76 offset:43008
  ds_read_b128 v[40:43], v76 offset:44032
  v_smfmac_f32_16x16x64_bf16 v[32:35], v[0:3], v[60:67], v74
  s_waitcnt lgkmcnt(5)
  v_smfmac_f32_16x16x64_bf16 v[20:23], v[0:3], a[32:39], v74
  ds_read_b128 v[60:63], v76 offset:57344
  ds_read_b128 v[64:67], v76 offset:58368
  v_smfmac_f32_16x16x64_bf16 v[24:27], v[0:3], a[40:47], v74
  s_waitcnt lgkmcnt(4)
  v_smfmac_f32_16x16x64_bf16 v[20:23], v[4:7], a[48:55], v74
  buffer_store_dwordx4 v[16:19], v76, s[8:11], s68 offen sc1
  v_smfmac_f32_16x16x64_bf16 v[24:27], v[4:7], a[56:63], v74
  v_smfmac_f32_16x16x64_bf16 v[28:31], v[4:7], v[44:51], v74
  s_waitcnt lgkmcnt(2)
  v_smfmac_f32_16x16x64_bf16 v[20:23], v[8:11], a[64:71], v74
  ds_read_b128 v[44:47], v76 offset:59392
  ds_read_b128 v[48:51], v76 offset:60416
  v_smfmac_f32_16x16x64_bf16 v[24:27], v[8:11], a[72:79], v74
  v_smfmac_f32_16x16x64_bf16 v[32:35], v[4:7], v[36:43], v74
  v_smfmac_f32_16x16x64_bf16 v[28:31], v[8:11], v[208:215], v74
  ds_read_b128 v[36:39], v75 offset:24576
  ds_read_b128 v[40:43], v75 offset:25600
  v_smfmac_f32_16x16x64_bf16 v[32:35], v[8:11], v[216:223], v74
  v_smfmac_f32_16x16x64_bf16 v[20:23], v[12:15], a[80:87], v74
  v_smfmac_f32_16x16x64_bf16 v[24:27], v[12:15], a[88:95], v74
  v_smfmac_f32_16x16x64_bf16 v[28:31], v[12:15], v[224:231], v74
  v_smfmac_f32_16x16x64_bf16 v[32:35], v[12:15], v[232:239], v74
  s_waitcnt vmcnt(2)
  s_waitcnt vmcnt(1)
  s_barrier
Cf2_lastr:
  ds_read_b128 v[12:15], v76 offset:8704
  ds_read_b128 v[0:3], v76 offset:9728
  ds_read_b128 v[16:19], v76 offset:10752
  ds_read_b128 v[4:7], v76 offset:11776
  ds_read_b128 v[8:11], v76 offset:12800
  s_waitcnt lgkmcnt(3)
  v_max3_u32 v72, v0, v1, v2
  s_waitcnt lgkmcnt(1)
  v_max3_u32 v72, v72, v3, v4
  v_max3_u32 v72, v72, v5, v6
  s_waitcnt lgkmcnt(0)
  v_max3_u32 v72, v72, v7, v8
  v_max3_u32 v72, v72, v9, v10
  v_max3_u32 v72, v72, v11, v12
  v_max3_u32 v72, v72, v13, v14
  v_max3_u32 v72, v72, v15, v16
  v_max3_u32 v72, v72, v17, v18
  v_max_u32 v72, v72, v19
  v_cmp_eq_u32 vcc, -1, v72
  s_cbranch_vccnz Cf2_lastp
Cf2_lastg:
  v_smfmac_f32_16x16x64_bf16 v[28:31], v[12:15], v[60:67], v74
  ds_read_b128 v[60:63], v75 offset:26624
  ds_read_b128 v[64:67], v75 offset:27648
  v_smfmac_f32_16x16x64_bf16 v[32:35], v[12:15], v[44:51], v74
  v_smfmac_f32_16x16x64_bf16 v[28:31], v[0:3], v[36:43], v74
  v_smfmac_f32_16x16x64_bf16 v[28:31], v[16:19], v[240:247], v74
  v_smfmac_f32_16x16x64_bf16 v[28:31], v[4:7], a[0:7], v74
  v_smfmac_f32_16x16x64_bf16 v[28:31], v[8:11], a[16:23], v74
  v_smfmac_f32_16x16x64_bf16 v[32:35], v[16:19], v[248:255], v74
  v_smfmac_f32_16x16x64_bf16 v[32:35], v[4:7], a[8:15], v74
  s_waitcnt lgkmcnt(0)
  v_smfmac_f32_16x16x64_bf16 v[32:35], v[8:11], a[24:31], v74
  v_smfmac_f32_16x16x64_bf16 v[32:35], v[0:3], v[60:67], v74
  v_smfmac_f32_16x16x64_bf16 v[20:23], v[12:15], a[96:103], v74
  v_smfmac_f32_16x16x64_bf16 v[20:23], v[0:3], a[112:119], v74
  v_add_f32 v28, v28, v30
  v_add_f32 v32, v32, v34
  v_cvt_pk_bf16_f32 v30, v28, v32
  v_smfmac_f32_16x16x64_bf16 v[20:23], v[16:19], a[128:135], v74
  ds_write_b32 v79, v30 offset:256
  v_add_f32 v29, v29, v31
  v_add_f32 v33, v33, v35
  v_cvt_pk_bf16_f32 v31, v29, v33
  v_smfmac_f32_16x16x64_bf16 v[20:23], v[4:7], a[144:151], v74
  ds_write_b32 v79, v31 offset:832
  v_smfmac_f32_16x16x64_bf16 v[20:23], v[8:11], a[160:167], v74
  v_smfmac_f32_16x16x64_bf16 v[24:27], v[12:15], a[104:111], v74
  v_smfmac_f32_16x16x64_bf16 v[24:27], v[0:3], a[120:127], v74
  v_smfmac_f32_16x16x64_bf16 v[24:27], v[16:19], a[136:143], v74
  s_waitcnt lgkmcnt(0)
  s_barrier
  ds_read_b64 v[52:53], v77 offset:384
  v_add_f32 v20, v20, v22
  v_smfmac_f32_16x16x64_bf16 v[24:27], v[4:7], a[152:159], v74
  v_add_f32 v21, v21, v23
  v_smfmac_f32_16x16x64_bf16 v[24:27], v[8:11], a[168:175], v74
  v_cvt_pk_bf16_f32 v54, v20, v21
  s_add_u32 s68, s68, 655360
  s_nop 3
  v_add_f32 v24, v24, v26
  v_add_f32 v25, v25, v27
  v_cvt_pk_bf16_f32 v55, v24, v25
  s_waitcnt lgkmcnt(0)
  buffer_store_dwordx4 v[52:55], v76, s[8:11], s68 offen sc1
  s_branch Cf2_done
Cf2_lastp:
  s_add_u32 s72, s72, 2
  s_cmp_ge_u32 s72, 131072
  s_cbranch_scc1 Cf2_lastg
  s_barrier
  buffer_load_dwordx4 v76, s[8:11], s85 offen offset:0 sc1 lds
  s_waitcnt vmcnt(0)
  s_barrier
  s_branch Cf2_lastr
Cf2_done:
  s_branch L_cexit
L_w3:
  v_mov_b64 v[20:21], 0
  v_mov_b64 v[22:23], 0
  v_mov_b64 v[24:25], 0
  v_mov_b64 v[26:27], 0
  v_mov_b64 v[28:29], 0
  v_mov_b64 v[30:31], 0
  v_mov_b64 v[32:33], 0
  v_mov_b64 v[34:35], 0
  s_mov_b32 s78, 0x3f803f80
  s_mov_b32 s79, s78
  s_mov_b32 s65, 360448
  s_mov_b32 m0, 15872
  s_lshl_b32 s71, s53, 2
  s_add_u32 s71, s71, 128
  s_movk_i32 s56, 0x1000
  v_lshlrev_b32 v73, 2, v76
  v_mov_b32 v72, 0
  s_mov_b64 s[16:17], s[8:9]
  s_mov_b32 s18, 268435456
  s_mov_b32 s19, 0x20000
  s_getpc_b64 s[20:21]
Cf3_pc:
  s_add_u32 s20, s20, (Cf3_last - Cf3_pc)
  s_addc_u32 s21, s21, 0
  v_mov_b32 v68, 14880
  buffer_load_dwordx4 v[52:55], v76, s[8:11], s59 offen offset:0 sc1
  buffer_load_dwordx4 v[56:59], v76, s[8:11], s59 offen offset:1024 sc1
  ds_read_b128 v[36:39], v76 offset:45056
  ds_read_b128 v[40:43], v76 offset:46080
  ds_read_b128 v[60:63], v76 offset:47104
  ds_read_b128 v[64:67], v76 offset:48128
  ds_read_b128 v[0:3], v76 offset:4608
  ds_read_b128 v[4:7], v76 offset:5632
  ds_read_b128 v[8:11], v76 offset:6656
  ds_read_b128 v[12:15], v76 offset:7680
  s_waitcnt lgkmcnt(0)
  s_cmp_eq_u32 s66, 1
  s_branch Cf3_top2
.p2align 6
Cf3_h2:
  v_lshlrev_b32 v73, 2, v76
  buffer_load_dwordx4 v[4:7], v76, s[8:11], s65 offen offset:1024 sc1
  ds_read_b128 v[36:39], v76 offset:45056
  ds_read_b128 v[40:43], v76 offset:46080
  buffer_load_dwordx4 v[52:55], v76, s[8:11], s59 offen offset:0 sc1
  buffer_load_dwordx4 v[56:59], v76, s[8:11], s59 offen offset:1024 sc1
  s_waitcnt vmcnt(7)
  v_max3_u32 v72, v4, v5, v6
  v_max_u32 v72, v72, v7
  ds_write_b128 v76, v[4:7] offset:5632
  v_cmp_eq_u32 vcc, -1, v72
  s_cbranch_vccnz Cf3_h2r
Cf3_h2w:
  buffer_load_dwordx4 v76, s[8:11], s85 offen offset:0 sc1 lds
  buffer_load_dwordx4 v76, s[8:11], s85 offen offset:1024 sc1 lds
  s_cmp_eq_u32 s66, 63
  s_waitcnt lgkmcnt(0)
  s_barrier
  ds_read_b128 v[8:11], v76 offset:6656
Cf3_top2:
  v_smfmac_f32_16x16x64_bf16 v[20:23], v[4:7], v[96:103], v74
  s_cbranch_scc1 Cf3_last
  v_smfmac_f32_16x16x64_bf16 v[28:31], v[4:7], v[36:43], v74
  buffer_load_dwordx4 v[44:47], v76, s[8:11], s58 offen offset:0 sc1
  s_mov_b32 m0, 15872
  v_smfmac_f32_16x16x64_bf16 v[24:27], v[4:7], v[104:111], v74
  buffer_load_dwordx4 v[48:51], v76, s[8:11], s58 offen offset:1024 sc1
  v_smfmac_f32_16x16x64_bf16 v[32:35], v[4:7], v[60:67], v74
  ds_read_b128 v[0:3], v76 offset:4608
  s_waitcnt lgkmcnt(1)
  v_smfmac_f32_16x16x64_bf16 v[20:23], v[8:11], v[112:119], v74
  ds_read_b128 v[12:15], v76 offset:7680
  v_smfmac_f32_16x16x64_bf16 v[24:27], v[8:11], v[120:127], v74
  ds_read_b128 v[36:39], v76 offset:28672
  v_smfmac_f32_16x16x64_bf16 v[28:31], v[8:11], v[208:215], v74
  buffer_store_dwordx4 v[16:19], v76, s[8:11], s68 offen sc1
  ds_read_b128 v[40:43], v76 offset:29696
  v_smfmac_f32_16x16x64_bf16 v[32:35], v[8:11], v[216:223], v74
  buffer_load_dword v73, s[16:19], s70 offen lds
  ds_read_b128 v[60:63], v76 offset:30720
  s_waitcnt lgkmcnt(4)
  v_smfmac_f32_16x16x64_bf16 v[20:23], v[0:3], v[80:87], v74
  ds_read_b128 v[64:67], v76 offset:31744
  v_smfmac_f32_16x16x64_bf16 v[24:27], v[0:3], v[88:95], v74
  s_waitcnt vmcnt(4)
  s_waitcnt lgkmcnt(4)
  v_smfmac_f32_16x16x64_bf16 v[20:23], v[12:15], v[128:135], v74
  s_barrier
  ds_read_b128 v[4:7], v76 offset:8704
  s_waitcnt lgkmcnt(3)
  v_smfmac_f32_16x16x64_bf16 v[28:31], v[0:3], v[36:43], v74
  ds_read_b128 v[36:39], v76 offset:61440
  v_smfmac_f32_16x16x64_bf16 v[24:27], v[12:15], v[136:143], v74
  ds_read_b128 v[40:43], v76 offset:62464
  s_waitcnt lgkmcnt(3)
  v_smfmac_f32_16x16x64_bf16 v[32:35], v[0:3], v[60:67], v74
  ds_read_b128 v[8:11], v76 offset:9728
  v_smfmac_f32_16x16x64_bf16 v[28:31], v[12:15], v[224:231], v74
  ds_read_b128 v[60:63], v76 offset:63488
  v_smfmac_f32_16x16x64_bf16 v[32:35], v[12:15], v[232:239], v74
  ds_read_b128 v[64:67], v76 offset:64512
  s_waitcnt lgkmcnt(5)
  v_smfmac_f32_16x16x64_bf16 v[20:23], v[4:7], v[144:151], v74
  s_barrier
  ds_read_b128 v[0:3], v76 offset:11776
  s_waitcnt lgkmcnt(4)
  v_smfmac_f32_16x16x64_bf16 v[28:31], v[4:7], v[36:43], v74
  ds_read_b128 v[12:15], v76 offset:12800
  ds_read_b128 v[36:39], v75 offset:12288
  v_smfmac_f32_16x16x64_bf16 v[24:27], v[4:7], v[152:159], v74
  ds_read_b128 v[16:19], v76 offset:10752
  s_waitcnt lgkmcnt(6)
  v_smfmac_f32_16x16x64_bf16 v[20:23], v[8:11], v[160:167], v74
  ds_read_b128 v[40:43], v75 offset:13312
  s_waitcnt lgkmcnt(5)
  v_smfmac_f32_16x16x64_bf16 v[32:35], v[4:7], v[60:67], v74
  ds_read_b128 v[60:63], v75 offset:14336
  v_smfmac_f32_16x16x64_bf16 v[24:27], v[8:11], v[168:175], v74
  ds_read_b128 v[64:67], v75 offset:15360
  s_waitcnt lgkmcnt(6)
  v_smfmac_f32_16x16x64_bf16 v[20:23], v[0:3], v[176:183], v74
  s_waitcnt lgkmcnt(5)
  v_smfmac_f32_16x16x64_bf16 v[20:23], v[12:15], v[192:199], v74
  s_waitcnt lgkmcnt(2)
  v_smfmac_f32_16x16x64_bf16 v[20:23], v[16:19], v[36:43], v74
  ds_read_b128 v[36:39], v75 offset:28672
  v_smfmac_f32_16x16x64_bf16 v[24:27], v[0:3], v[184:191], v74
  ds_read_b128 v[40:43], v75 offset:29696
  s_waitcnt lgkmcnt(2)
  v_smfmac_f32_16x16x64_bf16 v[24:27], v[16:19], v[60:67], v74
  ds_read_b128 v[60:63], v75 offset:30720
  v_add_f32 v20, v20, v22
  v_smfmac_f32_16x16x64_bf16 v[24:27], v[12:15], v[200:207], v74
  ds_read_b128 v[64:67], v75 offset:31744
  v_add_f32 v21, v21, v23
  v_smfmac_f32_16x16x64_bf16 v[28:31], v[16:19], v[240:247], v74
  v_mov_b64 v[70:71], s[78:79]
  v_smfmac_f32_16x16x64_bf16 v[28:31], v[0:3], a[0:7], v74
  s_waitcnt lgkmcnt(2)
  v_add_f32 v24, v24, v26
  v_smfmac_f32_16x16x64_bf16 v[28:31], v[8:11], v[36:43], v74
  ds_read_b128 v[36:39], v68
  v_cvt_pk_bf16_f32 v22, v20, v24
  v_smfmac_f32_16x16x64_bf16 v[28:31], v[12:15], a[16:23], v74
  ds_read_b128 v[40:43], v68
  ds_write_b32 v79, v22 offset:0
  s_waitcnt lgkmcnt(3)
  v_add_f32 v25, v25, v27
  v_cvt_pk_bf16_f32 v23, v21, v25
  v_smfmac_f32_16x16x64_bf16 v[32:35], v[8:11], v[60:67], v74
  ds_write_b32 v79, v23 offset:576
  v_cmp_u_f32 vcc, v20, v21
  v_smfmac_f32_16x16x64_bf16 v[32:35], v[16:19], v[248:255], v74
  v_add_f32 v28, v28, v30
  v_smfmac_f32_16x16x64_bf16 v[32:35], v[0:3], a[8:15], v74
  v_add_f32 v29, v29, v31
  v_smfmac_f32_16x16x64_bf16 v[32:35], v[12:15], a[24:31], v74
  s_cbranch_vccnz Cf3_rec
Cf3_recok:
  s_waitcnt lgkmcnt(3)
  v_smfmac_f32_16x16x64_bf16 v[36:39], v[16:19], a[128:135], v74
  s_waitcnt lgkmcnt(0)
  s_barrier
  ds_read_b128 v[60:63], v77
  v_smfmac_f32_16x16x64_bf16 v[40:43], v[16:19], a[136:143], v74
  ds_read_b128 v[64:67], v77 offset:128
  v_add_f32 v32, v32, v34
  v_cvt_pk_bf16_f32 v30, v28, v32
  v_smfmac_f32_16x16x64_bf16 v[36:39], v[0:3], a[144:151], v74
  ds_write_b32 v79, v30 offset:256
  v_add_f32 v33, v33, v35
  v_cvt_pk_bf16_f32 v31, v29, v33
  v_smfmac_f32_16x16x64_bf16 v[40:43], v[0:3], a[152:159], v74
  ds_write_b32 v79, v31 offset:832
  v_xor_b32 v75, 0x8000, v75
  v_smfmac_f32_16x16x64_bf16 v[36:39], v[4:7], a[96:103], v74
  ds_read_b128 v[0:3], v76 offset:4608
  v_mov_b32 v29, 0
  v_smfmac_f32_16x16x64_bf16 v[40:43], v[4:7], a[104:111], v74
  s_waitcnt vmcnt(2) lgkmcnt(3)
  v_mov_b32 v30, 0
  v_mfma_f32_16x16x32_bf16 v[44:47], v[44:47], v[60:63], 0
  ds_read_b128 v[4:7], v76 offset:5632
  s_waitcnt lgkmcnt(2)
  v_mfma_f32_16x16x32_bf16 v[44:47], v[48:51], v[64:67], v[44:47]
  s_barrier
  v_smfmac_f32_16x16x64_bf16 v[36:39], v[8:11], a[112:119], v74
  ds_read_b128 v[20:23], v77 offset:256
  ds_read_b128 v[24:27], v77 offset:384
  v_smfmac_f32_16x16x64_bf16 v[40:43], v[8:11], a[120:127], v74
  ds_read_b128 v[8:11], v76 offset:6656
  v_add_f32_dpp v72, v46, v44 quad_perm:[2,3,0,1] row_mask:0xf bank_mask:0xf
  v_add_f32_dpp v73, v47, v45 quad_perm:[2,3,0,1] row_mask:0xf bank_mask:0xf
  v_smfmac_f32_16x16x64_bf16 v[36:39], v[12:15], a[160:167], v74
  s_waitcnt lgkmcnt(4)
  v_exp_f32_dpp v72, v72 quad_perm:[0,1,0,1] row_mask:0xf bank_mask:0xf
  v_smfmac_f32_16x16x64_bf16 v[40:43], v[12:15], a[168:175], v74
  ds_read_b128 v[12:15], v76 offset:7680
  v_exp_f32_dpp v73, v73 quad_perm:[0,1,0,1] row_mask:0xf bank_mask:0xf
  v_smfmac_f32_16x16x64_bf16 v[36:39], v[0:3], a[32:39], v74
  s_waitcnt lgkmcnt(2)
  v_cvt_pk_bf16_f32 v72, v72, v73
  v_mfma_f32_16x16x32_bf16 v[20:23], v[20:23], v[60:63], 0
  ds_write_b32 v78, v72 offset:524
  v_mov_b64 v[16:17], 0
  v_mfma_f32_16x16x32_bf16 v[20:23], v[24:27], v[64:67], v[20:23]
  ds_read_b128 v[44:47], v75 offset:47104
  v_mov_b64 v[18:19], 0
  v_smfmac_f32_16x16x64_bf16 v[40:43], v[0:3], a[40:47], v74
  ds_read_b128 v[48:51], v75 offset:48128
  v_mov_b64 v[68:69], s[78:79]
  v_smfmac_f32_16x16x64_bf16 v[36:39], v[4:7], a[48:55], v74
  s_waitcnt lgkmcnt(4)
  v_add_f32_dpp v24, v22, v20 quad_perm:[2,3,0,1] row_mask:0xf bank_mask:0xf
  v_add_f32_dpp v25, v23, v21 quad_perm:[2,3,0,1] row_mask:0xf bank_mask:0xf
  v_smfmac_f32_16x16x64_bf16 v[36:39], v[8:11], a[64:71], v74
  s_waitcnt lgkmcnt(2)
  s_barrier
  ds_read_b128 v[32:35], v78 offset:512
  v_smfmac_f32_16x16x64_bf16 v[36:39], v[12:15], a[80:87], v74
  ds_read_b128 v[60:63], v75 offset:28672
  v_mul_f32 v24, s69, v24
  v_smfmac_f32_16x16x64_bf16 v[40:43], v[4:7], a[56:63], v74
  ds_read_b128 v[64:67], v75 offset:29696
  v_mul_f32 v25, s69, v25
  v_smfmac_f32_16x16x64_bf16 v[40:43], v[8:11], a[72:79], v74
  v_exp_f32_dpp v24, v24 quad_perm:[0,1,0,1] row_mask:0xf bank_mask:0xf
  v_smfmac_f32_16x16x64_bf16 v[40:43], v[12:15], a[88:95], v74
  s_waitcnt lgkmcnt(2)
  v_exp_f32_dpp v25, v25 quad_perm:[0,1,0,1] row_mask:0xf bank_mask:0xf
  v_mfma_f32_16x16x32_bf16 v[8:11], v[32:35], v[68:71], 0
  v_add_f32 v36, v36, v38
  v_add_f32 v37, v37, v39
  v_mfma_f32_16x16x32_bf16 v[0:3], v[32:35], v[52:55], 0
  v_add_f32 v40, v40, v42
  v_add_f32 v41, v41, v43
  v_mfma_f32_16x16x32_bf16 v[4:7], v[32:35], v[56:59], 0
  v_cvt_pk_bf16_f32 v28, v24, v25
  v_cvt_pk_bf16_f32 v72, v36, v37
  v_cvt_pk_bf16_f32 v73, v40, v41
  v_mfma_f32_16x16x16_bf16 v[8:11], v[28:29], v[68:69], v[8:11]
  v_cvt_pk_bf16_f32 v31, v24, v25
  v_mov_b64 v[20:21], 0
  v_mfma_f32_16x16x16_bf16 v[0:3], v[28:29], v[72:73], v[0:3]
  ds_read_b128 v[52:55], v75 offset:30720
  v_mov_b64 v[22:23], 0
  v_mfma_f32_16x16x16_bf16 v[4:7], v[30:31], v[72:73], v[4:7]
  v_rcp_f32 v10, v8
  v_rcp_f32 v11, v9
  v_mul_f32 v0, v10, v0
  v_mul_f32 v1, v11, v1
  v_max3_f32 v8, v8, v9, v10
  v_mul_f32 v4, v10, v4
  v_mul_f32 v5, v11, v5
  v_cvt_pk_bf16_f32 v2, v0, v4
  ds_write_b32 v79, v2 offset:8704
  v_cvt_pk_bf16_f32 v3, v1, v5
  ds_write_b32 v79, v3 offset:9280
  ds_read_b128 v[12:15], v78 offset:8896
  v_max_f32 v8, v8, v11
  v_cmp_le_f32 vcc, 1317011456, v8
  v_mov_b64 v[24:25], 0
  v_mov_b64 v[26:27], 0
  ds_read_b128 v[56:59], v75 offset:31744
  s_cbranch_vccnz Cf3_mx
Cf3_mxok:
  s_waitcnt lgkmcnt(2)
  s_barrier
  ds_read_b128 v[0:3], v78 offset:8832
  s_waitcnt lgkmcnt(2)
  v_smfmac_f32_16x16x64_bf16 v[16:19], v[12:15], a[184:191], v74
  ds_read_b128 v[4:7], v78 offset:8704
  v_smfmac_f32_16x16x64_bf16 v[20:23], v[12:15], v[44:51], v74
  ds_read_b128 v[8:11], v78 offset:8768
  v_smfmac_f32_16x16x64_bf16 v[24:27], v[12:15], a[232:239], v74
  ds_read_b128 v[36:39], v75 offset:45056
  s_waitcnt lgkmcnt(3)
  v_smfmac_f32_16x16x64_bf16 v[16:19], v[0:3], a[176:183], v74
  ds_read_b128 v[40:43], v75 offset:46080
  s_waitcnt lgkmcnt(3)
  v_smfmac_f32_16x16x64_bf16 v[16:19], v[4:7], v[60:67], v74
  ds_read_b128 v[68:71], v76 offset:13824
  s_waitcnt lgkmcnt(3)
  v_smfmac_f32_16x16x64_bf16 v[16:19], v[8:11], v[52:59], v74
  ds_read_b128 v[44:47], v75 offset:61440
  v_smfmac_f32_16x16x64_bf16 v[20:23], v[4:7], a[192:199], v74
  ds_read_b128 v[48:51], v75 offset:62464
  v_smfmac_f32_16x16x64_bf16 v[20:23], v[8:11], a[200:207], v74
  ds_read_b128 v[60:63], v75 offset:63488
  s_waitcnt lgkmcnt(4)
  v_cvt_pk_bf16_f32 v16, v16, v17
  v_cvt_pk_bf16_f32 v17, v18, v19
  v_bfi_b32 v16, 1, s72, v16
  v_smfmac_f32_16x16x64_bf16 v[20:23], v[0:3], v[36:43], v74
  s_waitcnt lgkmcnt(3)
  buffer_store_dwordx2 v[16:17], v68, s[8:11], s73 offen
  v_mov_b64 v[32:33], 0
  v_smfmac_f32_16x16x64_bf16 v[24:27], v[4:7], a[208:215], v74
  ds_read_b128 v[64:67], v75 offset:64512
  v_mov_b64 v[34:35], 0
  v_smfmac_f32_16x16x64_bf16 v[24:27], v[8:11], a[216:223], v74
  ds_read_b128 v[52:55], v75 offset:8192
  v_cvt_pk_bf16_f32 v20, v20, v21
  v_cvt_pk_bf16_f32 v21, v22, v23
  v_bfi_b32 v20, 1, s72, v20
  v_smfmac_f32_16x16x64_bf16 v[24:27], v[0:3], a[224:231], v74
  ds_read_b128 v[56:59], v75 offset:9216
  buffer_store_dwordx2 v[20:21], v68, s[8:11], s74 offen
  s_waitcnt lgkmcnt(4)
  v_mov_b64 v[28:29], 0
  v_smfmac_f32_16x16x64_bf16 v[32:35], v[4:7], v[44:51], v74
  ds_read_b128 v[36:39], v75 offset:10240
  ds_read_b128 v[40:43], v75 offset:11264
  s_waitcnt lgkmcnt(4)
  v_smfmac_f32_16x16x64_bf16 v[32:35], v[8:11], v[60:67], v74
  ds_read_b128 v[44:47], v75 offset:12288
  v_cvt_pk_bf16_f32 v24, v24, v25
  v_cvt_pk_bf16_f32 v25, v26, v27
  v_bfi_b32 v24, 1, s72, v24
  v_smfmac_f32_16x16x64_bf16 v[32:35], v[0:3], a[240:247], v74
  ds_read_b128 v[48:51], v75 offset:13312
  buffer_store_dwordx2 v[24:25], v68, s[8:11], s75 offen
  v_mov_b64 v[30:31], 0
  v_smfmac_f32_16x16x64_bf16 v[32:35], v[12:15], a[248:255], v74
  ds_read_b128 v[60:63], v75 offset:14336
  ds_read_b128 v[64:67], v75 offset:15360
  s_waitcnt lgkmcnt(6)
  v_smfmac_f32_16x16x64_bf16 v[28:31], v[4:7], v[52:59], v74
  s_waitcnt lgkmcnt(4)
  v_smfmac_f32_16x16x64_bf16 v[28:31], v[8:11], v[36:43], v74
  s_waitcnt lgkmcnt(2)
  v_cvt_pk_bf16_f32 v32, v32, v33
  v_cvt_pk_bf16_f32 v33, v34, v35
  v_bfi_b32 v32, 1, s72, v32
  v_smfmac_f32_16x16x64_bf16 v[28:31], v[0:3], v[44:51], v74
  buffer_store_dwordx2 v[32:33], v68, s[8:11], s76 offen
  s_waitcnt lgkmcnt(0)
  v_smfmac_f32_16x16x64_bf16 v[28:31], v[12:15], v[60:67], v74
  v_mov_b64 v[18:19], v[72:73]
  s_nop 4
  v_cvt_pk_bf16_f32 v28, v28, v29
  v_cvt_pk_bf16_f32 v29, v30, v31
  v_bfi_b32 v28, 1, s72, v28
  buffer_store_dwordx2 v[28:29], v68, s[8:11], s77 offen
  ds_read_b128 v[52:55], v76 offset:14848
  s_waitcnt lgkmcnt(0)
  ds_read_b64 v[16:17], v77 offset:392
  s_waitcnt lgkmcnt(0)
  ds_read_b128 v[60:63], v76 offset:47104
  s_waitcnt lgkmcnt(0)
  ds_read_b128 v[64:67], v76 offset:48128
  s_waitcnt lgkmcnt(0)
  s_add_u32 s66, s66, 1
  s_xor_b32 s64, s64, 16384
  s_xor_b32 s65, s65, 16384
  s_add_u32 s58, s58, 655360
  s_add_u32 s59, s59, 655360
  s_add_u32 s70, s70, 655360
  s_add_u32 s68, s68, 655360
  s_mov_b32 m0, 8704
  s_add_u32 s85, s65, 4096
  v_xor_b32 v75, 0x8000, v75
  v_mov_b64 v[28:29], 0
  v_mov_b64 v[30:31], 0
  v_mov_b64 v[32:33], 0
  v_mov_b64 v[34:35], 0
  buffer_load_dwordx4 v[0:3], v76, s[8:11], s60 offen offset:0 sc1
  buffer_load_dwordx4 v[4:7], v76, s[8:11], s60 offen offset:1024 sc1
  buffer_load_dwordx4 v[8:11], v76, s[8:11], s61 offen offset:0 sc1
  buffer_load_dwordx4 v[12:15], v76, s[8:11], s61 offen offset:1024 sc1
  v_mov_b64 v[20:21], 0
  v_mov_b64 v[22:23], 0
  v_mov_b64 v[24:25], 0
  v_mov_b64 v[26:27], 0
  v_mov_b32 v68, 14880
  s_cmp_eq_u32 s66, 62
  s_cselect_b64 s[16:17], s[20:21], s[16:17]
  s_cselect_b32 s18, (Cf3_done - Cf3_last), s18
  s_cselect_b32 s70, 0, s70
  s_cmp_eq_u32 s66, 63
  s_cselect_b32 s59, 268435456, s59
  s_cselect_b32 s58, 268435456, s58
  s_waitcnt lgkmcnt(0)
  s_waitcnt vmcnt(3)
  v_mfma_f32_16x16x32_bf16 v[56:59], v[52:55], v[0:3], 0
  v_bitop3_b32 v72, v0, v2, s72 bitop3:0x7e
  s_waitcnt vmcnt(2)
  v_mfma_f32_16x16x32_bf16 v[56:59], v[52:55], v[4:7], v[56:59]
  v_bitop3_b32 v73, v4, v6, s72 bitop3:0x7e
  v_or_b32 v72, v72, v73
  s_waitcnt vmcnt(1)
  v_mfma_f32_16x16x32_bf16 v[36:39], v[52:55], v[8:11], 0
  v_bitop3_b32 v73, v8, v10, s72 bitop3:0x7e
  v_or_b32 v72, v72, v73
  s_waitcnt vmcnt(0)
  v_mfma_f32_16x16x32_bf16 v[36:39], v[52:55], v[12:15], v[36:39]
  v_bitop3_b32 v73, v12, v14, s72 bitop3:0x7e
  v_bitop3_b32 v72, v72, v73, 1 bitop3:0xa8
  v_cmp_ne_u32 vcc, 0, v72
  s_cbranch_vccnz Cf3_h1r
  buffer_load_dwordx4 v[4:7], v76, s[8:11], s65 offen offset:1024 sc1
  v_add_f32_dpp v56, v56, v56 row_ror:4 row_mask:0xf bank_mask:0xf
  v_add_f32_dpp v57, v57, v57 row_ror:4 row_mask:0xf bank_mask:0xf
  v_add_f32_dpp v36, v36, v36 row_ror:4 row_mask:0xf bank_mask:0xf
  v_add_f32_dpp v37, v37, v37 row_ror:4 row_mask:0xf bank_mask:0xf
  v_add_f32_dpp v56, v56, v56 row_ror:8 row_mask:0xf bank_mask:0xf
  v_add_f32_dpp v57, v57, v57 row_ror:8 row_mask:0xf bank_mask:0xf
  v_add_f32_dpp v36, v36, v36 row_ror:8 row_mask:0xf bank_mask:0xf
  v_add_f32_dpp v37, v37, v37 row_ror:8 row_mask:0xf bank_mask:0xf
  v_cvt_pk_bf16_f32 v56, v56, v57
  buffer_store_dword v56, v69, s[8:11], s62 offen
  v_cvt_pk_bf16_f32 v36, v36, v37
  buffer_store_dword v36, v70, s[8:11], s63 offen
  s_xor_b32 s62, s62, 16384
  buffer_store_dword v71, v69, s[8:11], s62 offen
  s_xor_b32 s63, s63, 16384
  buffer_store_dword v71, v70, s[8:11], s63 offen
  s_xor_b32 s72, s72, 1
  s_branch Cf3_h2
Cf3_h1r:
  s_mov_b64 exec, vcc
  buffer_load_dwordx4 v[0:3], v76, s[8:11], s60 offen offset:0 sc1
  buffer_load_dwordx4 v[4:7], v76, s[8:11], s60 offen offset:1024 sc1
  buffer_load_dwordx4 v[8:11], v76, s[8:11], s61 offen offset:0 sc1
  buffer_load_dwordx4 v[12:15], v76, s[8:11], s61 offen offset:1024 sc1
  s_mov_b64 exec, -1
  s_add_u32 s67, s67, 1
  s_waitcnt vmcnt(3)
  v_mfma_f32_16x16x32_bf16 v[56:59], v[52:55], v[0:3], 0
  v_bitop3_b32 v72, v0, v2, s72 bitop3:0x7e
  s_waitcnt vmcnt(2)
  v_mfma_f32_16x16x32_bf16 v[56:59], v[52:55], v[4:7], v[56:59]
  v_bitop3_b32 v73, v4, v6, s72 bitop3:0x7e
  v_or_b32 v72, v72, v73
  s_waitcnt vmcnt(1)
  v_mfma_f32_16x16x32_bf16 v[36:39], v[52:55], v[8:11], 0
  v_bitop3_b32 v73, v8, v10, s72 bitop3:0x7e
  v_or_b32 v72, v72, v73
  s_waitcnt vmcnt(0)
  v_mfma_f32_16x16x32_bf16 v[36:39], v[52:55], v[12:15], v[36:39]
  v_bitop3_b32 v73, v12, v14, s72 bitop3:0x7e
  v_bitop3_b32 v72, v72, v73, 1 bitop3:0xa8
  v_cmp_ne_u32 vcc, 0, v72
  s_cbranch_vccz Cf3_h1p
Cf3_h1s:
  s_mov_b64 exec, vcc
  buffer_load_dwordx4 v[0:3], v76, s[8:11], s60 offen offset:0 sc1
  buffer_load_dwordx4 v[4:7], v76, s[8:11], s60 offen offset:1024 sc1
  buffer_load_dwordx4 v[8:11], v76, s[8:11], s61 offen offset:0 sc1
  buffer_load_dwordx4 v[12:15], v76, s[8:11], s61 offen offset:1024 sc1
  s_mov_b64 exec, -1
  s_add_u32 s67, s67, 1
  s_waitcnt vmcnt(3)
  v_mfma_f32_16x16x32_bf16 v[56:59], v[52:55], v[0:3], 0
  v_bitop3_b32 v72, v0, v2, s72 bitop3:0x7e
  s_waitcnt vmcnt(2)
  v_mfma_f32_16x16x32_bf16 v[56:59], v[52:55], v[4:7], v[56:59]
  v_bitop3_b32 v73, v4, v6, s72 bitop3:0x7e
  v_or_b32 v72, v72, v73
  s_waitcnt vmcnt(1)
  v_mfma_f32_16x16x32_bf16 v[36:39], v[52:55], v[8:11], 0
  v_bitop3_b32 v73, v8, v10, s72 bitop3:0x7e
  v_or_b32 v72, v72, v73
  s_waitcnt vmcnt(0)
  v_mfma_f32_16x16x32_bf16 v[36:39], v[52:55], v[12:15], v[36:39]
  v_bitop3_b32 v73, v12, v14, s72 bitop3:0x7e
  v_bitop3_b32 v72, v72, v73, 1 bitop3:0xa8
  v_cmp_ne_u32 vcc, 0, v72
  s_cbranch_vccz Cf3_h1p
  s_cmp_lt_u32 s67, 131072
  s_cbranch_scc1 Cf3_h1s
Cf3_h1p:
  s_nop 2
  buffer_load_dwordx4 v[4:7], v76, s[8:11], s65 offen offset:1024 sc1
  v_add_f32_dpp v56, v56, v56 row_ror:4 row_mask:0xf bank_mask:0xf
  v_add_f32_dpp v57, v57, v57 row_ror:4 row_mask:0xf bank_mask:0xf
  v_add_f32_dpp v36, v36, v36 row_ror:4 row_mask:0xf bank_mask:0xf
  v_add_f32_dpp v37, v37, v37 row_ror:4 row_mask:0xf bank_mask:0xf
  v_add_f32_dpp v56, v56, v56 row_ror:8 row_mask:0xf bank_mask:0xf
  v_add_f32_dpp v57, v57, v57 row_ror:8 row_mask:0xf bank_mask:0xf
  v_add_f32_dpp v36, v36, v36 row_ror:8 row_mask:0xf bank_mask:0xf
  v_add_f32_dpp v37, v37, v37 row_ror:8 row_mask:0xf bank_mask:0xf
  v_cvt_pk_bf16_f32 v56, v56, v57
  buffer_store_dword v56, v69, s[8:11], s62 offen
  v_cvt_pk_bf16_f32 v36, v36, v37
  buffer_store_dword v36, v70, s[8:11], s63 offen
  s_xor_b32 s62, s62, 16384
  buffer_store_dword v71, v69, s[8:11], s62 offen
  s_xor_b32 s63, s63, 16384
  buffer_store_dword v71, v70, s[8:11], s63 offen
  s_xor_b32 s72, s72, 1
  s_branch Cf3_h2
Cf3_h2r:
  s_mov_b64 exec, vcc
  buffer_load_dwordx4 v[4:7], v76, s[8:11], s65 offen offset:1024 sc1
  s_mov_b64 exec, -1
  s_add_u32 s67, s67, 1
  s_waitcnt vmcnt(3)
  v_max3_u32 v72, v4, v5, v6
  v_max_u32 v72, v72, v7
  ds_write_b128 v76, v[4:7] offset:5632
  v_cmp_eq_u32 vcc, -1, v72
  s_cbranch_vccz Cf3_h2w
Cf3_h2s:
  s_mov_b64 exec, vcc
  buffer_load_dwordx4 v[4:7], v76, s[8:11], s65 offen offset:1024 sc1
  s_mov_b64 exec, -1
  s_add_u32 s67, s67, 1
  s_waitcnt vmcnt(1)
  v_max3_u32 v72, v4, v5, v6
  v_max_u32 v72, v72, v7
  ds_write_b128 v76, v[4:7] offset:5632
  v_cmp_eq_u32 vcc, -1, v72
  s_cbranch_vccz Cf3_h2w
  s_mov_b64 exec, vcc
  buffer_load_dwordx4 v[4:7], v76, s[8:11], s65 offen offset:1024 sc1
  s_mov_b64 exec, -1
  s_add_u32 s67, s67, 1
  s_waitcnt vmcnt(1)
  v_max3_u32 v72, v4, v5, v6
  v_max_u32 v72, v72, v7
  ds_write_b128 v76, v[4:7] offset:5632
  v_cmp_eq_u32 vcc, -1, v72
  s_cbranch_vccz Cf3_h2w
  s_mov_b64 exec, vcc
  buffer_load_dwordx4 v[4:7], v76, s[8:11], s65 offen offset:1024 sc1
  s_mov_b64 exec, -1
  s_add_u32 s67, s67, 1
  s_waitcnt vmcnt(1)
  v_max3_u32 v72, v4, v5, v6
  v_max_u32 v72, v72, v7
  ds_write_b128 v76, v[4:7] offset:5632
  v_cmp_eq_u32 vcc, -1, v72
  s_cbranch_vccz Cf3_h2w
  s_cmp_lt_u32 s67, 131072
  s_cbranch_scc1 Cf3_h2s
  s_branch Cf3_h2w
Cf3_rec:
  s_nop 7
  s_waitcnt vmcnt(0) lgkmcnt(0)
  v_max3_u32 v72, v0, v1, v2
  v_max3_u32 v72, v72, v3, v4
  v_max3_u32 v72, v72, v5, v6
  v_max3_u32 v72, v72, v7, v8
  v_max3_u32 v72, v72, v9, v10
  v_max3_u32 v72, v72, v11, v12
  v_max3_u32 v72, v72, v13, v14
  v_max3_u32 v72, v72, v15, v16
  v_max3_u32 v72, v72, v17, v18
  v_max_u32 v72, v72, v19
  v_cmp_eq_u32 vcc, -1, v72
  s_cbranch_vccz Cf3_recok
  s_barrier
Cf3_recp:
  buffer_load_dwordx4 v[0:3], v76, s[8:11], s64 offen offset:0 sc1
  buffer_load_dwordx4 v[4:7], v76, s[8:11], s64 offen offset:1024 sc1
  buffer_load_dwordx4 v[8:11], v76, s[8:11], s64 offen offset:2048 sc1
  s_add_u32 s67, s67, 1
  s_cmp_lt_u32 s67, 131072
  s_cselect_b32 s54, -2, -1
  s_waitcnt vmcnt(2)
  v_max3_u32 v72, v0, v1, v2
  s_waitcnt vmcnt(1)
  v_max3_u32 v72, v72, v3, v4
  v_max3_u32 v72, v72, v5, v6
  s_waitcnt vmcnt(0)
  v_max3_u32 v72, v72, v7, v8
  v_max3_u32 v72, v72, v9, v10
  v_max_u32 v72, v72, v11
  v_cmp_lt_u32 vcc, s54, v72
  s_cbranch_vccnz Cf3_recp
  ds_write_b128 v76, v[0:3] offset:10752
  ds_write_b128 v76, v[4:7] offset:11776
  ds_write_b128 v76, v[8:11] offset:12800
  v_mov_b64 v[20:21], 0
  v_mov_b64 v[22:23], 0
  v_mov_b64 v[24:25], 0
  v_mov_b64 v[26:27], 0
  v_mov_b64 v[28:29], 0
  v_mov_b64 v[30:31], 0
  v_mov_b64 v[32:33], 0
  v_mov_b64 v[34:35], 0
  s_waitcnt lgkmcnt(0)
  s_barrier
  ds_read_b128 v[0:3], v76 offset:4608
  s_waitcnt lgkmcnt(0)
  v_smfmac_f32_16x16x64_bf16 v[20:23], v[0:3], v[80:87], v74
  v_smfmac_f32_16x16x64_bf16 v[24:27], v[0:3], v[88:95], v74
  ds_read_b128 v[60:63], v76 offset:28672
  ds_read_b128 v[64:67], v76 offset:29696
  s_waitcnt lgkmcnt(0)
  v_smfmac_f32_16x16x64_bf16 v[28:31], v[0:3], v[60:67], v74
  ds_read_b128 v[60:63], v76 offset:30720
  ds_read_b128 v[64:67], v76 offset:31744
  s_waitcnt lgkmcnt(0)
  v_smfmac_f32_16x16x64_bf16 v[32:35], v[0:3], v[60:67], v74
  ds_read_b128 v[4:7], v76 offset:5632
  s_waitcnt lgkmcnt(0)
  v_smfmac_f32_16x16x64_bf16 v[20:23], v[4:7], v[96:103], v74
  v_smfmac_f32_16x16x64_bf16 v[24:27], v[4:7], v[104:111], v74
  ds_read_b128 v[60:63], v76 offset:45056
  ds_read_b128 v[64:67], v76 offset:46080
  s_waitcnt lgkmcnt(0)
  v_smfmac_f32_16x16x64_bf16 v[28:31], v[4:7], v[60:67], v74
  ds_read_b128 v[60:63], v76 offset:47104
  ds_read_b128 v[64:67], v76 offset:48128
  s_waitcnt lgkmcnt(0)
  v_smfmac_f32_16x16x64_bf16 v[32:35], v[4:7], v[60:67], v74
  ds_read_b128 v[8:11], v76 offset:6656
  s_waitcnt lgkmcnt(0)
  v_smfmac_f32_16x16x64_bf16 v[20:23], v[8:11], v[112:119], v74
  v_smfmac_f32_16x16x64_bf16 v[24:27], v[8:11], v[120:127], v74
  v_smfmac_f32_16x16x64_bf16 v[28:31], v[8:11], v[208:215], v74
  v_smfmac_f32_16x16x64_bf16 v[32:35], v[8:11], v[216:223], v74
  ds_read_b128 v[12:15], v76 offset:7680
  s_waitcnt lgkmcnt(0)
  v_smfmac_f32_16x16x64_bf16 v[20:23], v[12:15], v[128:135], v74
  v_smfmac_f32_16x16x64_bf16 v[24:27], v[12:15], v[136:143], v74
  v_smfmac_f32_16x16x64_bf16 v[28:31], v[12:15], v[224:231], v74
  v_smfmac_f32_16x16x64_bf16 v[32:35], v[12:15], v[232:239], v74
  ds_read_b128 v[4:7], v76 offset:8704
  s_waitcnt lgkmcnt(0)
  v_smfmac_f32_16x16x64_bf16 v[20:23], v[4:7], v[144:151], v74
  v_smfmac_f32_16x16x64_bf16 v[24:27], v[4:7], v[152:159], v74
  ds_read_b128 v[60:63], v76 offset:61440
  ds_read_b128 v[64:67], v76 offset:62464
  s_waitcnt lgkmcnt(0)
  v_smfmac_f32_16x16x64_bf16 v[28:31], v[4:7], v[60:67], v74
  ds_read_b128 v[60:63], v76 offset:63488
  ds_read_b128 v[64:67], v76 offset:64512
  s_waitcnt lgkmcnt(0)
  v_smfmac_f32_16x16x64_bf16 v[32:35], v[4:7], v[60:67], v74
  ds_read_b128 v[8:11], v76 offset:9728
  s_waitcnt lgkmcnt(0)
  v_smfmac_f32_16x16x64_bf16 v[20:23], v[8:11], v[160:167], v74
  v_smfmac_f32_16x16x64_bf16 v[24:27], v[8:11], v[168:175], v74
  ds_read_b128 v[60:63], v75 offset:28672
  ds_read_b128 v[64:67], v75 offset:29696
  s_waitcnt lgkmcnt(0)
  v_smfmac_f32_16x16x64_bf16 v[28:31], v[8:11], v[60:67], v74
  ds_read_b128 v[60:63], v75 offset:30720
  ds_read_b128 v[64:67], v75 offset:31744
  s_waitcnt lgkmcnt(0)
  v_smfmac_f32_16x16x64_bf16 v[32:35], v[8:11], v[60:67], v74
  ds_read_b128 v[16:19], v76 offset:10752
  ds_read_b128 v[60:63], v75 offset:12288
  ds_read_b128 v[64:67], v75 offset:13312
  s_waitcnt lgkmcnt(0)
  v_smfmac_f32_16x16x64_bf16 v[20:23], v[16:19], v[60:67], v74
  ds_read_b128 v[60:63], v75 offset:14336
  ds_read_b128 v[64:67], v75 offset:15360
  s_waitcnt lgkmcnt(0)
  v_smfmac_f32_16x16x64_bf16 v[24:27], v[16:19], v[60:67], v74
  v_smfmac_f32_16x16x64_bf16 v[28:31], v[16:19], v[240:247], v74
  v_smfmac_f32_16x16x64_bf16 v[32:35], v[16:19], v[248:255], v74
  ds_read_b128 v[0:3], v76 offset:11776
  s_waitcnt lgkmcnt(0)
  v_smfmac_f32_16x16x64_bf16 v[20:23], v[0:3], v[176:183], v74
  v_smfmac_f32_16x16x64_bf16 v[24:27], v[0:3], v[184:191], v74
  v_smfmac_f32_16x16x64_bf16 v[28:31], v[0:3], a[0:7], v74
  v_smfmac_f32_16x16x64_bf16 v[32:35], v[0:3], a[8:15], v74
  ds_read_b128 v[12:15], v76 offset:12800
  s_waitcnt lgkmcnt(0)
  v_smfmac_f32_16x16x64_bf16 v[20:23], v[12:15], v[192:199], v74
  v_smfmac_f32_16x16x64_bf16 v[24:27], v[12:15], v[200:207], v74
  v_smfmac_f32_16x16x64_bf16 v[28:31], v[12:15], a[16:23], v74
  v_smfmac_f32_16x16x64_bf16 v[32:35], v[12:15], a[24:31], v74
  v_add_f32 v20, v20, v22
  v_add_f32 v21, v21, v23
  v_add_f32 v24, v24, v26
  v_cvt_pk_bf16_f32 v22, v20, v24
  ds_write_b32 v79, v22 offset:0
  v_add_f32 v25, v25, v27
  v_cvt_pk_bf16_f32 v23, v21, v25
  ds_write_b32 v79, v23 offset:576
  v_add_f32 v28, v28, v30
  v_add_f32 v29, v29, v31
  s_waitcnt lgkmcnt(0)
  s_nop 1
  s_branch Cf3_recok
Cf3_mx:
  s_waitcnt lgkmcnt(0)
  s_barrier
  buffer_load_dwordx4 v[52:55], v76, s[8:11], s59 offen offset:0 sc1
  buffer_load_dwordx4 v[0:3], v76, s[8:11], s58 offen offset:0 sc1
  ds_read_b128 v[20:23], v77 offset:0
  ds_read_b128 v[28:31], v77 offset:256
  buffer_load_dwordx4 v[56:59], v76, s[8:11], s59 offen offset:1024 sc1
  buffer_load_dwordx4 v[4:7], v76, s[8:11], s58 offen offset:1024 sc1
  ds_read_b128 v[24:27], v77 offset:128
  ds_read_b128 v[32:35], v77 offset:384
  s_waitcnt vmcnt(2) lgkmcnt(3)
  v_mfma_f32_16x16x32_bf16 v[8:11], v[0:3], v[20:23], 0
  s_waitcnt vmcnt(0) lgkmcnt(1)
  v_mfma_f32_16x16x32_bf16 v[8:11], v[4:7], v[24:27], v[8:11]
  v_mfma_f32_16x16x32_bf16 v[12:15], v[28:31], v[20:23], 0
  s_waitcnt lgkmcnt(0)
  v_mfma_f32_16x16x32_bf16 v[12:15], v[32:35], v[24:27], v[12:15]
  v_add_f32_dpp v8, v10, v8 quad_perm:[2,3,0,1] row_mask:0xf bank_mask:0xf
  v_add_f32_dpp v9, v11, v9 quad_perm:[2,3,0,1] row_mask:0xf bank_mask:0xf
  s_nop 0
  v_mov_b32_dpp v8, v8 quad_perm:[0,1,0,1] row_mask:0xf bank_mask:0xf
  v_mov_b32_dpp v9, v9 quad_perm:[0,1,0,1] row_mask:0xf bank_mask:0xf
  s_nop 1
  v_add_f32_dpp v12, v14, v12 quad_perm:[2,3,0,1] row_mask:0xf bank_mask:0xf
  v_add_f32_dpp v13, v15, v13 quad_perm:[2,3,0,1] row_mask:0xf bank_mask:0xf
  s_nop 0
  v_mov_b32_dpp v12, v12 quad_perm:[0,1,0,1] row_mask:0xf bank_mask:0xf
  v_mov_b32_dpp v13, v13 quad_perm:[0,1,0,1] row_mask:0xf bank_mask:0xf
  v_mul_f32 v12, s69, v12
  ds_write_b32 v78, v8 offset:8716
  v_mul_f32 v13, s69, v13
  ds_write_b32 v78, v9 offset:8780
  s_waitcnt lgkmcnt(0)
  s_barrier
  ds_read_b128 v[36:39], v78 offset:8704
  ds_read_b128 v[40:43], v78 offset:8768
  s_waitcnt lgkmcnt(0)
  s_barrier
  v_max_f32 v16, v36, v37
  v_max3_f32 v16, v16, v38, v39
  v_max3_f32 v16, v16, v40, v41
  v_max3_f32 v16, v16, v42, v43
  v_max3_f32 v16, v16, v12, v13
  v_mov_b32 v17, v16
  s_nop 1
  v_permlane16_swap_b32 v16, v17
  v_max_f32 v16, v16, v17
  v_mov_b32 v17, v16
  s_nop 1
  v_permlane32_swap_b32 v16, v17
  v_max_f32 v16, v16, v17
  v_sub_f32 v36, v36, v16
  v_sub_f32 v37, v37, v16
  v_sub_f32 v38, v38, v16
  v_sub_f32 v39, v39, v16
  v_sub_f32 v40, v40, v16
  v_sub_f32 v41, v41, v16
  v_sub_f32 v42, v42, v16
  v_sub_f32 v43, v43, v16
  v_sub_f32 v12, v12, v16
  v_sub_f32 v13, v13, v16
  v_exp_f32 v36, v36
  v_exp_f32 v37, v37
  v_exp_f32 v38, v38
  v_exp_f32 v39, v39
  v_exp_f32 v40, v40
  v_exp_f32 v41, v41
  v_exp_f32 v42, v42
  v_exp_f32 v43, v43
  v_exp_f32 v12, v12
  v_exp_f32 v13, v13
  v_cvt_pk_bf16_f32 v32, v36, v40
  v_cvt_pk_bf16_f32 v33, v37, v41
  v_cvt_pk_bf16_f32 v34, v38, v42
  v_cvt_pk_bf16_f32 v35, v39, v43
  v_cvt_pk_bf16_f32 v28, v12, v13
  v_cvt_pk_bf16_f32 v31, v12, v13
  v_mov_b32 v29, 0
  v_mov_b32 v30, 0
  v_mfma_f32_16x16x32_bf16 v[8:11], v[32:35], v[68:71], 0
  v_mfma_f32_16x16x32_bf16 v[0:3], v[32:35], v[52:55], 0
  v_mfma_f32_16x16x32_bf16 v[4:7], v[32:35], v[56:59], 0
  v_mfma_f32_16x16x16_bf16 v[8:11], v[28:29], v[68:69], v[8:11]
  v_mfma_f32_16x16x16_bf16 v[0:3], v[28:29], v[72:73], v[0:3]
  v_mfma_f32_16x16x16_bf16 v[4:7], v[30:31], v[72:73], v[4:7]
  ds_read_b128 v[52:55], v75 offset:30720
  v_rcp_f32 v10, v8
  v_rcp_f32 v11, v9
  v_mul_f32 v0, v10, v0
  v_mul_f32 v1, v11, v1
  v_max3_f32 v8, v8, v9, v10
  v_mul_f32 v4, v10, v4
  v_mul_f32 v5, v11, v5
  v_cvt_pk_bf16_f32 v2, v0, v4
  ds_write_b32 v79, v2 offset:8704
  v_cvt_pk_bf16_f32 v3, v1, v5
  ds_write_b32 v79, v3 offset:9280
  ds_read_b128 v[12:15], v78 offset:8896
  ds_read_b128 v[56:59], v75 offset:31744
  v_mov_b64 v[16:17], 0
  v_mov_b64 v[18:19], 0
  v_mov_b64 v[20:21], 0
  v_mov_b64 v[22:23], 0
  v_mov_b64 v[24:25], 0
  v_mov_b64 v[26:27], 0
  s_branch Cf3_mxok
Cf3_last:
  ds_read_b128 v[0:3], v76 offset:4608
  ds_read_b128 v[12:15], v76 offset:7680
  ds_read_b128 v[44:47], v76 offset:28672
  ds_read_b128 v[48:51], v76 offset:29696
  s_nop 5
  v_mov_b64 v[20:21], 0
  v_mov_b64 v[22:23], 0
  v_mov_b64 v[24:25], 0
  v_mov_b64 v[26:27], 0
  v_smfmac_f32_16x16x64_bf16 v[28:31], v[4:7], v[36:43], v74
  ds_read_b128 v[36:39], v76 offset:30720
  ds_read_b128 v[40:43], v76 offset:31744
  v_smfmac_f32_16x16x64_bf16 v[32:35], v[4:7], v[60:67], v74
  s_waitcnt lgkmcnt(5)
  v_smfmac_f32_16x16x64_bf16 v[20:23], v[0:3], a[32:39], v74
  ds_read_b128 v[60:63], v76 offset:61440
  ds_read_b128 v[64:67], v76 offset:62464
  v_smfmac_f32_16x16x64_bf16 v[24:27], v[0:3], a[40:47], v74
  s_waitcnt lgkmcnt(4)
  v_smfmac_f32_16x16x64_bf16 v[20:23], v[4:7], a[48:55], v74
  buffer_store_dwordx4 v[16:19], v76, s[8:11], s68 offen sc1
  v_smfmac_f32_16x16x64_bf16 v[24:27], v[4:7], a[56:63], v74
  v_smfmac_f32_16x16x64_bf16 v[28:31], v[0:3], v[44:51], v74
  s_waitcnt lgkmcnt(2)
  v_smfmac_f32_16x16x64_bf16 v[20:23], v[8:11], a[64:71], v74
  ds_read_b128 v[44:47], v76 offset:63488
  ds_read_b128 v[48:51], v76 offset:64512
  v_smfmac_f32_16x16x64_bf16 v[24:27], v[8:11], a[72:79], v74
  v_smfmac_f32_16x16x64_bf16 v[32:35], v[0:3], v[36:43], v74
  v_smfmac_f32_16x16x64_bf16 v[28:31], v[8:11], v[208:215], v74
  ds_read_b128 v[36:39], v75 offset:28672
  ds_read_b128 v[40:43], v75 offset:29696
  v_smfmac_f32_16x16x64_bf16 v[32:35], v[8:11], v[216:223], v74
  v_smfmac_f32_16x16x64_bf16 v[20:23], v[12:15], a[80:87], v74
  v_smfmac_f32_16x16x64_bf16 v[24:27], v[12:15], a[88:95], v74
  v_smfmac_f32_16x16x64_bf16 v[28:31], v[12:15], v[224:231], v74
  v_smfmac_f32_16x16x64_bf16 v[32:35], v[12:15], v[232:239], v74
  s_waitcnt vmcnt(1)
  s_barrier
Cf3_lastr:
  ds_read_b128 v[4:7], v76 offset:8704
  ds_read_b128 v[8:11], v76 offset:9728
  ds_read_b128 v[16:19], v76 offset:10752
  ds_read_b128 v[0:3], v76 offset:11776
  ds_read_b128 v[12:15], v76 offset:12800
  s_waitcnt lgkmcnt(1)
  v_max3_u32 v72, v0, v1, v2
  v_max3_u32 v72, v72, v3, v4
  v_max3_u32 v72, v72, v5, v6
  v_max3_u32 v72, v72, v7, v8
  v_max3_u32 v72, v72, v9, v10
  s_waitcnt lgkmcnt(0)
  v_max3_u32 v72, v72, v11, v12
  v_max3_u32 v72, v72, v13, v14
  v_max3_u32 v72, v72, v15, v16
  v_max3_u32 v72, v72, v17, v18
  v_max_u32 v72, v72, v19
  v_cmp_eq_u32 vcc, -1, v72
  s_cbranch_vccnz Cf3_lastp
Cf3_lastg:
  v_smfmac_f32_16x16x64_bf16 v[28:31], v[4:7], v[60:67], v74
  ds_read_b128 v[60:63], v75 offset:30720
  ds_read_b128 v[64:67], v75 offset:31744
  v_smfmac_f32_16x16x64_bf16 v[32:35], v[4:7], v[44:51], v74
  v_smfmac_f32_16x16x64_bf16 v[28:31], v[8:11], v[36:43], v74
  v_smfmac_f32_16x16x64_bf16 v[28:31], v[16:19], v[240:247], v74
  v_smfmac_f32_16x16x64_bf16 v[28:31], v[0:3], a[0:7], v74
  v_smfmac_f32_16x16x64_bf16 v[28:31], v[12:15], a[16:23], v74
  v_smfmac_f32_16x16x64_bf16 v[32:35], v[16:19], v[248:255], v74
  v_smfmac_f32_16x16x64_bf16 v[32:35], v[0:3], a[8:15], v74
  s_waitcnt lgkmcnt(0)
  v_smfmac_f32_16x16x64_bf16 v[32:35], v[12:15], a[24:31], v74
  v_smfmac_f32_16x16x64_bf16 v[32:35], v[8:11], v[60:67], v74
  v_smfmac_f32_16x16x64_bf16 v[20:23], v[4:7], a[96:103], v74
  v_smfmac_f32_16x16x64_bf16 v[20:23], v[8:11], a[112:119], v74
  v_add_f32 v28, v28, v30
  v_add_f32 v32, v32, v34
  v_cvt_pk_bf16_f32 v30, v28, v32
  v_smfmac_f32_16x16x64_bf16 v[20:23], v[16:19], a[128:135], v74
  ds_write_b32 v79, v30 offset:256
  v_add_f32 v29, v29, v31
  v_add_f32 v33, v33, v35
  v_cvt_pk_bf16_f32 v31, v29, v33
  v_smfmac_f32_16x16x64_bf16 v[20:23], v[0:3], a[144:151], v74
  ds_write_b32 v79, v31 offset:832
  v_smfmac_f32_16x16x64_bf16 v[20:23], v[12:15], a[160:167], v74
  v_smfmac_f32_16x16x64_bf16 v[24:27], v[4:7], a[104:111], v74
  v_smfmac_f32_16x16x64_bf16 v[24:27], v[8:11], a[120:127], v74
  v_smfmac_f32_16x16x64_bf16 v[24:27], v[16:19], a[136:143], v74
  s_waitcnt lgkmcnt(0)
  s_barrier
  ds_read_b64 v[52:53], v77 offset:392
  v_add_f32 v20, v20, v22
  v_smfmac_f32_16x16x64_bf16 v[24:27], v[0:3], a[152:159], v74
  v_add_f32 v21, v21, v23
  v_smfmac_f32_16x16x64_bf16 v[24:27], v[12:15], a[168:175], v74
  v_cvt_pk_bf16_f32 v54, v20, v21
  s_add_u32 s68, s68, 655360
  s_nop 3
  v_add_f32 v24, v24, v26
  v_add_f32 v25, v25, v27
  v_cvt_pk_bf16_f32 v55, v24, v25
  s_waitcnt lgkmcnt(0)
  buffer_store_dwordx4 v[52:55], v76, s[8:11], s68 offen sc1
  s_branch Cf3_done
Cf3_lastp:
  s_add_u32 s72, s72, 2
  s_cmp_ge_u32 s72, 131072
  s_cbranch_scc1 Cf3_lastg
  s_barrier
  buffer_load_dwordx4 v76, s[8:11], s85 offen offset:0 sc1 lds
  buffer_load_dwordx4 v76, s[8:11], s85 offen offset:1024 sc1 lds
  s_waitcnt vmcnt(0)
  s_barrier
  s_branch Cf3_lastr
Cf3_done:
  s_branch L_cexit
L_w4:
  v_mov_b64 v[20:21], 0
  v_mov_b64 v[22:23], 0
  v_mov_b64 v[24:25], 0
  v_mov_b64 v[26:27], 0
  v_mov_b64 v[28:29], 0
  v_mov_b64 v[30:31], 0
  v_mov_b64 v[32:33], 0
  v_mov_b64 v[34:35], 0
  s_mov_b32 s78, 0x3f803f80
  s_mov_b32 s79, s78
  s_mov_b32 s65, 360448
  s_mov_b32 m0, 16128
  s_lshl_b32 s71, s53, 2
  s_add_u32 s71, s71, 128
  s_movk_i32 s56, 0x1000
  v_lshlrev_b32 v73, 2, v76
  v_mov_b32 v72, 0
  s_mov_b64 s[16:17], s[8:9]
  s_mov_b32 s18, 268435456
  s_mov_b32 s19, 0x20000
  s_getpc_b64 s[20:21]
Cs0_pc:
  s_add_u32 s20, s20, (Cs0_last - Cs0_pc)
  s_addc_u32 s21, s21, 0
  v_mov_b32 v68, 14880
  buffer_load_dwordx4 v[52:55], v76, s[8:11], s59 offen offset:0 sc1
  buffer_load_dwordx4 v[56:59], v76, s[8:11], s59 offen offset:1024 sc1
  ds_read_b128 v[36:39], v76 offset:16384
  ds_read_b128 v[40:43], v76 offset:17408
  ds_read_b128 v[60:63], v76 offset:18432
  ds_read_b128 v[64:67], v76 offset:19456
  ds_read_b128 v[0:3], v76 offset:4608
  ds_read_b128 v[4:7], v76 offset:5632
  ds_read_b128 v[8:11], v76 offset:6656
  ds_read_b128 v[12:15], v76 offset:7680
  s_waitcnt lgkmcnt(0)
  s_cmp_eq_u32 s66, 1
  s_branch Cs0_top2
.p2align 6
Cs0_h2:
  ds_read_b128 v[36:39], v76 offset:16384
  v_mov_b64 v[20:21], 0
  v_mov_b64 v[22:23], 0
  v_mov_b64 v[24:25], 0
  v_mov_b64 v[26:27], 0
  v_mov_b32 v68, 14880
  ds_read_b128 v[40:43], v76 offset:17408
  s_cmp_eq_u32 s66, 62
  s_cselect_b64 s[16:17], s[20:21], s[16:17]
  s_cselect_b32 s18, (Cs0_done - Cs0_last), s18
  s_cselect_b32 s70, 0, s70
  s_cmp_eq_u32 s66, 63
  s_cselect_b32 s59, 268435456, s59
  s_cselect_b32 s58, 268435456, s58
  ds_read_b128 v[60:63], v76 offset:18432
  v_lshlrev_b32 v73, 2, v76
  s_cmp_eq_u32 s66, 12
  s_cselect_b32 s56, s71, 0x1000
  ds_read_b32 v72, v76 offset:16128
  s_cmp_eq_u32 s66, 13
  s_cselect_b32 s54, 0x700, 0
  s_waitcnt lgkmcnt(0)
  v_readfirstlane_b32 s57, v72
  s_nop 0
  s_cmp_lt_u32 s57, s54
  s_cbranch_scc1 Cs0_kv3
Cs0_kvb:
  buffer_load_dwordx4 v[52:55], v76, s[8:11], s59 offen offset:0 sc1
  buffer_load_dwordx4 v[56:59], v76, s[8:11], s59 offen offset:1024 sc1
  s_waitcnt vmcnt(0)
  s_mov_b64 vcc, -1
Cs0_h2r:
  s_mov_b64 exec, vcc
  buffer_load_dwordx4 v[0:3], v76, s[8:11], s65 offen offset:0 sc1
  buffer_load_dwordx4 v[4:7], v76, s[8:11], s85 offen offset:0 sc1
  s_mov_b64 exec, -1
  s_add_u32 s67, s67, 1
  s_cmp_lt_u32 s67, 131072
  s_cselect_b32 s54, -2, -1
  s_waitcnt vmcnt(1)
  v_max3_u32 v72, v0, v1, v2
  s_waitcnt vmcnt(0)
  v_max3_u32 v72, v72, v3, v4
  v_max3_u32 v72, v72, v5, v6
  v_max_u32 v72, v72, v7
  v_cmp_lt_u32 vcc, s54, v72
  s_cbranch_vccnz Cs0_h2r
  ds_write_b128 v76, v[0:3] offset:4608
  ds_write_b128 v76, v[4:7] offset:10752
Cs0_h2w:
  s_cmp_eq_u32 s66, 63
  s_waitcnt lgkmcnt(0)
  s_barrier
  ds_read_b128 v[8:11], v76 offset:6656
Cs0_top2:
  v_smfmac_f32_16x16x64_bf16 v[20:23], v[0:3], v[80:87], v74
  s_cbranch_scc1 Cs0_last
  v_smfmac_f32_16x16x64_bf16 v[28:31], v[0:3], v[36:43], v74
  buffer_load_dwordx4 v[44:47], v76, s[8:11], s58 offen offset:0 sc1
  s_mov_b32 m0, 16128
  v_smfmac_f32_16x16x64_bf16 v[24:27], v[0:3], v[88:95], v74
  buffer_load_dwordx4 v[48:51], v76, s[8:11], s58 offen offset:1024 sc1
  v_smfmac_f32_16x16x64_bf16 v[32:35], v[0:3], v[60:67], v74
  ds_read_b128 v[4:7], v76 offset:5632
  s_waitcnt lgkmcnt(1)
  v_smfmac_f32_16x16x64_bf16 v[20:23], v[8:11], v[112:119], v74
  ds_read_b128 v[12:15], v76 offset:7680
  v_smfmac_f32_16x16x64_bf16 v[24:27], v[8:11], v[120:127], v74
  ds_read_b128 v[36:39], v76 offset:32768
  v_smfmac_f32_16x16x64_bf16 v[28:31], v[8:11], v[208:215], v74
  buffer_store_dwordx4 v[16:19], v76, s[8:11], s68 offen sc1
  ds_read_b128 v[40:43], v76 offset:33792
  v_smfmac_f32_16x16x64_bf16 v[32:35], v[8:11], v[216:223], v74
  buffer_load_dword v73, s[16:19], s70 offen lds
  ds_read_b128 v[60:63], v76 offset:34816
  s_waitcnt lgkmcnt(4)
  v_smfmac_f32_16x16x64_bf16 v[20:23], v[4:7], v[96:103], v74
  ds_read_b128 v[64:67], v76 offset:35840
  v_smfmac_f32_16x16x64_bf16 v[24:27], v[4:7], v[104:111], v74
  s_waitcnt vmcnt(4)
  s_waitcnt lgkmcnt(4)
  v_smfmac_f32_16x16x64_bf16 v[20:23], v[12:15], v[128:135], v74
  s_barrier
  ds_read_b128 v[0:3], v76 offset:8704
  s_waitcnt lgkmcnt(3)
  v_smfmac_f32_16x16x64_bf16 v[28:31], v[4:7], v[36:43], v74
  ds_read_b128 v[36:39], v76 offset:49152
  v_smfmac_f32_16x16x64_bf16 v[24:27], v[12:15], v[136:143], v74
  ds_read_b128 v[40:43], v76 offset:50176
  s_waitcnt lgkmcnt(3)
  v_smfmac_f32_16x16x64_bf16 v[32:35], v[4:7], v[60:67], v74
  ds_read_b128 v[8:11], v76 offset:9728
  v_smfmac_f32_16x16x64_bf16 v[28:31], v[12:15], v[224:231], v74
  ds_read_b128 v[60:63], v76 offset:51200
  v_smfmac_f32_16x16x64_bf16 v[32:35], v[12:15], v[232:239], v74
  ds_read_b128 v[64:67], v76 offset:52224
  s_waitcnt lgkmcnt(5)
  v_smfmac_f32_16x16x64_bf16 v[20:23], v[0:3], v[144:151], v74
  s_barrier
  ds_read_b128 v[4:7], v76 offset:11776
  s_waitcnt lgkmcnt(4)
  v_smfmac_f32_16x16x64_bf16 v[28:31], v[0:3], v[36:43], v74
  ds_read_b128 v[12:15], v76 offset:12800
  ds_read_b128 v[36:39], v75 offset:0
  v_smfmac_f32_16x16x64_bf16 v[24:27], v[0:3], v[152:159], v74
  ds_read_b128 v[16:19], v76 offset:10752
  s_waitcnt lgkmcnt(6)
  v_smfmac_f32_16x16x64_bf16 v[20:23], v[8:11], v[160:167], v74
  ds_read_b128 v[40:43], v75 offset:1024
  s_waitcnt lgkmcnt(5)
  v_smfmac_f32_16x16x64_bf16 v[32:35], v[0:3], v[60:67], v74
  ds_read_b128 v[60:63], v75 offset:2048
  v_smfmac_f32_16x16x64_bf16 v[24:27], v[8:11], v[168:175], v74
  ds_read_b128 v[64:67], v75 offset:3072
  s_waitcnt lgkmcnt(6)
  v_smfmac_f32_16x16x64_bf16 v[20:23], v[4:7], v[176:183], v74
  buffer_load_dword off, s[12:15], s56 sc1 lds
  s_waitcnt lgkmcnt(5)
  v_smfmac_f32_16x16x64_bf16 v[20:23], v[12:15], v[192:199], v74
  s_waitcnt lgkmcnt(2)
  v_smfmac_f32_16x16x64_bf16 v[20:23], v[16:19], v[36:43], v74
  ds_read_b128 v[36:39], v75 offset:16384
  v_smfmac_f32_16x16x64_bf16 v[24:27], v[4:7], v[184:191], v74
  ds_read_b128 v[40:43], v75 offset:17408
  s_waitcnt lgkmcnt(2)
  v_smfmac_f32_16x16x64_bf16 v[24:27], v[16:19], v[60:67], v74
  ds_read_b128 v[60:63], v75 offset:18432
  v_add_f32 v20, v20, v22
  v_smfmac_f32_16x16x64_bf16 v[24:27], v[12:15], v[200:207], v74
  ds_read_b128 v[64:67], v75 offset:19456
  v_add_f32 v21, v21, v23
  v_smfmac_f32_16x16x64_bf16 v[28:31], v[16:19], v[240:247], v74
  v_mov_b64 v[70:71], s[78:79]
  v_smfmac_f32_16x16x64_bf16 v[28:31], v[4:7], a[0:7], v74
  s_waitcnt lgkmcnt(2)
  v_add_f32 v24, v24, v26
  v_smfmac_f32_16x16x64_bf16 v[28:31], v[8:11], v[36:43], v74
  ds_read_b128 v[36:39], v68
  v_cvt_pk_bf16_f32 v22, v20, v24
  v_smfmac_f32_16x16x64_bf16 v[28:31], v[12:15], a[16:23], v74
  ds_read_b128 v[40:43], v68
  ds_write_b32 v79, v22 offset:0
  s_waitcnt lgkmcnt(3)
  v_add_f32 v25, v25, v27
  v_cvt_pk_bf16_f32 v23, v21, v25
  v_smfmac_f32_16x16x64_bf16 v[32:35], v[8:11], v[60:67], v74
  ds_write_b32 v79, v23 offset:576
  v_cmp_u_f32 vcc, v20, v21
  v_smfmac_f32_16x16x64_bf16 v[32:35], v[16:19], v[248:255], v74
  v_add_f32 v28, v28, v30
  v_smfmac_f32_16x16x64_bf16 v[32:35], v[4:7], a[8:15], v74
  v_add_f32 v29, v29, v31
  v_smfmac_f32_16x16x64_bf16 v[32:35], v[12:15], a[24:31], v74
  s_cbranch_vccnz Cs0_rec
Cs0_recok:
  s_waitcnt lgkmcnt(3)
  v_smfmac_f32_16x16x64_bf16 v[36:39], v[16:19], a[128:135], v74
  s_waitcnt lgkmcnt(0)
  s_barrier
  ds_read_b128 v[60:63], v77
  v_smfmac_f32_16x16x64_bf16 v[40:43], v[16:19], a[136:143], v74
  ds_read_b128 v[64:67], v77 offset:128
  v_add_f32 v32, v32, v34
  v_cvt_pk_bf16_f32 v30, v28, v32
  v_smfmac_f32_16x16x64_bf16 v[36:39], v[0:3], a[96:103], v74
  ds_write_b32 v79, v30 offset:256
  v_add_f32 v33, v33, v35
  v_cvt_pk_bf16_f32 v31, v29, v33
  v_smfmac_f32_16x16x64_bf16 v[40:43], v[0:3], a[104:111], v74
  ds_write_b32 v79, v31 offset:832
  v_xor_b32 v75, 0x8000, v75
  v_smfmac_f32_16x16x64_bf16 v[36:39], v[4:7], a[144:151], v74
  ds_read_b128 v[0:3], v76 offset:4608
  v_mov_b32 v29, 0
  v_smfmac_f32_16x16x64_bf16 v[40:43], v[4:7], a[152:159], v74
  s_waitcnt vmcnt(3) lgkmcnt(3)
  v_mov_b32 v30, 0
  v_mfma_f32_16x16x32_bf16 v[44:47], v[44:47], v[60:63], 0
  ds_read_b128 v[4:7], v76 offset:5632
  s_waitcnt lgkmcnt(2)
  v_mfma_f32_16x16x32_bf16 v[44:47], v[48:51], v[64:67], v[44:47]
  s_barrier
  v_smfmac_f32_16x16x64_bf16 v[36:39], v[8:11], a[112:119], v74
  ds_read_b128 v[20:23], v77 offset:256
  ds_read_b128 v[24:27], v77 offset:384
  v_smfmac_f32_16x16x64_bf16 v[40:43], v[8:11], a[120:127], v74
  ds_read_b128 v[8:11], v76 offset:6656
  v_add_f32_dpp v72, v46, v44 quad_perm:[2,3,0,1] row_mask:0xf bank_mask:0xf
  v_add_f32_dpp v73, v47, v45 quad_perm:[2,3,0,1] row_mask:0xf bank_mask:0xf
  v_smfmac_f32_16x16x64_bf16 v[36:39], v[12:15], a[160:167], v74
  s_waitcnt lgkmcnt(4)
  v_exp_f32_dpp v72, v72 quad_perm:[0,1,0,1] row_mask:0xf bank_mask:0xf
  v_smfmac_f32_16x16x64_bf16 v[40:43], v[12:15], a[168:175], v74
  ds_read_b128 v[12:15], v76 offset:7680
  v_exp_f32_dpp v73, v73 quad_perm:[0,1,0,1] row_mask:0xf bank_mask:0xf
  v_smfmac_f32_16x16x64_bf16 v[36:39], v[0:3], a[32:39], v74
  s_waitcnt lgkmcnt(2)
  v_cvt_pk_bf16_f32 v72, v72, v73
  v_mfma_f32_16x16x32_bf16 v[20:23], v[20:23], v[60:63], 0
  ds_write_b32 v78, v72 offset:512
  v_mov_b64 v[16:17], 0
  v_mfma_f32_16x16x32_bf16 v[20:23], v[24:27], v[64:67], v[20:23]
  ds_read_b128 v[44:47], v75 offset:16384
  v_mov_b64 v[18:19], 0
  v_smfmac_f32_16x16x64_bf16 v[40:43], v[0:3], a[40:47], v74
  ds_read_b128 v[48:51], v75 offset:17408
  v_mov_b64 v[68:69], s[78:79]
  v_smfmac_f32_16x16x64_bf16 v[36:39], v[4:7], a[48:55], v74
  s_waitcnt lgkmcnt(4)
  v_add_f32_dpp v24, v22, v20 quad_perm:[2,3,0,1] row_mask:0xf bank_mask:0xf
  v_add_f32_dpp v25, v23, v21 quad_perm:[2,3,0,1] row_mask:0xf bank_mask:0xf
  v_smfmac_f32_16x16x64_bf16 v[36:39], v[8:11], a[64:71], v74
  s_waitcnt lgkmcnt(2)
  s_barrier
  ds_read_b128 v[32:35], v78 offset:512
  v_smfmac_f32_16x16x64_bf16 v[36:39], v[12:15], a[80:87], v74
  ds_read_b128 v[60:63], v75 offset:18432
  v_mul_f32 v24, s69, v24
  v_smfmac_f32_16x16x64_bf16 v[40:43], v[4:7], a[56:63], v74
  ds_read_b128 v[64:67], v75 offset:19456
  v_mul_f32 v25, s69, v25
  v_smfmac_f32_16x16x64_bf16 v[40:43], v[8:11], a[72:79], v74
  v_exp_f32_dpp v24, v24 quad_perm:[0,1,0,1] row_mask:0xf bank_mask:0xf
  v_smfmac_f32_16x16x64_bf16 v[40:43], v[12:15], a[88:95], v74
  s_waitcnt lgkmcnt(2)
  v_exp_f32_dpp v25, v25 quad_perm:[0,1,0,1] row_mask:0xf bank_mask:0xf
  v_mfma_f32_16x16x32_bf16 v[8:11], v[32:35], v[68:71], 0
  v_add_f32 v36, v36, v38
  v_add_f32 v37, v37, v39
  v_mfma_f32_16x16x32_bf16 v[0:3], v[32:35], v[52:55], 0
  v_add_f32 v40, v40, v42
  v_add_f32 v41, v41, v43
  v_mfma_f32_16x16x32_bf16 v[4:7], v[32:35], v[56:59], 0
  v_cvt_pk_bf16_f32 v28, v24, v25
  v_cvt_pk_bf16_f32 v72, v36, v37
  v_cvt_pk_bf16_f32 v73, v40, v41
  v_mfma_f32_16x16x16_bf16 v[8:11], v[28:29], v[68:69], v[8:11]
  v_cvt_pk_bf16_f32 v31, v24, v25
  v_mov_b64 v[20:21], 0
  v_mfma_f32_16x16x16_bf16 v[0:3], v[28:29], v[72:73], v[0:3]
  ds_read_b128 v[52:55], v75 offset:32768
  v_mov_b64 v[22:23], 0
  v_mfma_f32_16x16x16_bf16 v[4:7], v[30:31], v[72:73], v[4:7]
  v_rcp_f32 v10, v8
  v_rcp_f32 v11, v9
  v_mul_f32 v0, v10, v0
  v_mul_f32 v1, v11, v1
  v_max3_f32 v8, v8, v9, v10
  v_mul_f32 v4, v10, v4
  v_mul_f32 v5, v11, v5
  v_cvt_pk_bf16_f32 v2, v0, v4
  ds_write_b32 v79, v2 offset:8704
  v_cvt_pk_bf16_f32 v3, v1, v5
  ds_write_b32 v79, v3 offset:9280
  ds_read_b128 v[12:15], v78 offset:8704
  v_max_f32 v8, v8, v11
  v_cmp_le_f32 vcc, 1317011456, v8
  v_mov_b64 v[24:25], 0
  v_mov_b64 v[26:27], 0
  ds_read_b128 v[56:59], v75 offset:33792
  s_cbranch_vccnz Cs0_mx
Cs0_mxok:
  s_waitcnt lgkmcnt(2)
  s_barrier
  ds_read_b128 v[0:3], v78 offset:8768
  s_waitcnt lgkmcnt(2)
  v_smfmac_f32_16x16x64_bf16 v[16:19], v[12:15], v[44:51], v74
  ds_read_b128 v[4:7], v78 offset:8832
  v_smfmac_f32_16x16x64_bf16 v[20:23], v[12:15], a[192:199], v74
  ds_read_b128 v[8:11], v78 offset:8896
  v_smfmac_f32_16x16x64_bf16 v[24:27], v[12:15], a[208:215], v74
  ds_read_b128 v[36:39], v75 offset:34816
  s_waitcnt lgkmcnt(3)
  v_smfmac_f32_16x16x64_bf16 v[16:19], v[0:3], v[60:67], v74
  ds_read_b128 v[40:43], v75 offset:35840
  s_waitcnt lgkmcnt(3)
  v_smfmac_f32_16x16x64_bf16 v[16:19], v[4:7], a[176:183], v74
  ds_read_b128 v[68:71], v76 offset:13824
  s_waitcnt lgkmcnt(3)
  v_smfmac_f32_16x16x64_bf16 v[16:19], v[8:11], a[184:191], v74
  ds_read_b128 v[44:47], v75 offset:49152
  v_smfmac_f32_16x16x64_bf16 v[20:23], v[0:3], a[200:207], v74
  ds_read_b128 v[48:51], v75 offset:50176
  v_smfmac_f32_16x16x64_bf16 v[20:23], v[4:7], v[52:59], v74
  ds_read_b128 v[60:63], v75 offset:51200
  s_waitcnt lgkmcnt(4)
  v_cvt_pk_bf16_f32 v16, v16, v17
  v_cvt_pk_bf16_f32 v17, v18, v19
  v_bfi_b32 v16, 1, s72, v16
  v_smfmac_f32_16x16x64_bf16 v[20:23], v[8:11], v[36:43], v74
  s_waitcnt lgkmcnt(3)
  buffer_store_dwordx2 v[16:17], v68, s[8:11], s73 offen sc1
  v_mov_b64 v[32:33], 0
  v_smfmac_f32_16x16x64_bf16 v[24:27], v[0:3], a[216:223], v74
  ds_read_b128 v[64:67], v75 offset:52224
  v_mov_b64 v[34:35], 0
  v_smfmac_f32_16x16x64_bf16 v[24:27], v[4:7], a[224:231], v74
  v_cvt_pk_bf16_f32 v20, v20, v21
  v_cvt_pk_bf16_f32 v21, v22, v23
  v_bfi_b32 v20, 1, s72, v20
  v_smfmac_f32_16x16x64_bf16 v[24:27], v[8:11], a[232:239], v74
  buffer_store_dwordx2 v[20:21], v68, s[8:11], s74 offen sc1
  s_waitcnt lgkmcnt(2)
  v_smfmac_f32_16x16x64_bf16 v[32:35], v[12:15], v[44:51], v74
  s_waitcnt lgkmcnt(0)
  v_smfmac_f32_16x16x64_bf16 v[32:35], v[0:3], v[60:67], v74
  v_cvt_pk_bf16_f32 v24, v24, v25
  v_cvt_pk_bf16_f32 v25, v26, v27
  v_bfi_b32 v24, 1, s72, v24
  v_smfmac_f32_16x16x64_bf16 v[32:35], v[4:7], a[240:247], v74
  buffer_store_dwordx2 v[24:25], v68, s[8:11], s75 offen sc1
  v_smfmac_f32_16x16x64_bf16 v[32:35], v[8:11], a[248:255], v74
  v_mov_b64 v[18:19], v[72:73]
  s_nop 4
  v_cvt_pk_bf16_f32 v32, v32, v33
  v_cvt_pk_bf16_f32 v33, v34, v35
  v_bfi_b32 v32, 1, s72, v32
  buffer_store_dwordx2 v[32:33], v68, s[8:11], s76 offen sc1
  ds_read_b128 v[0:3], v76 offset:14848
  s_waitcnt lgkmcnt(0)
  ds_read_b64 v[16:17], v77 offset:256
  s_waitcnt lgkmcnt(0)
  ds_read_b128 v[64:67], v76 offset:19456
  s_waitcnt lgkmcnt(0)
  v_xor_b32 v75, 0x8000, v75
  v_mov_b64 v[28:29], 0
  v_mov_b64 v[30:31], 0
  v_mov_b64 v[32:33], 0
  v_mov_b64 v[34:35], 0
  s_waitcnt vmcnt(0)
  buffer_load_dwordx4 v[52:55], v76, s[8:11], s60 offen offset:0 sc1
  buffer_load_dwordx4 v[56:59], v76, s[8:11], s60 offen offset:1024 sc1
  s_add_u32 s66, s66, 1
  s_xor_b32 s64, s64, 16384
  s_xor_b32 s65, s65, 16384
  s_add_u32 s58, s58, 655360
  s_add_u32 s59, s59, 655360
  s_add_u32 s70, s70, 655360
  s_add_u32 s68, s68, 655360
  s_mov_b32 m0, 10752
  s_add_u32 s85, s65, 6144
  s_waitcnt lgkmcnt(0)
  s_waitcnt vmcnt(1)
  v_mfma_f32_16x16x32_bf16 v[4:7], v[0:3], v[52:55], 0
  v_bitop3_b32 v72, v52, v54, s72 bitop3:0x7e
  s_waitcnt vmcnt(0)
  v_mfma_f32_16x16x32_bf16 v[4:7], v[0:3], v[56:59], v[4:7]
  v_bitop3_b32 v73, v56, v58, s72 bitop3:0x7e
  v_bitop3_b32 v72, v72, v73, 1 bitop3:0xa8
  v_cmp_ne_u32 vcc, 0, v72
  s_cbranch_vccnz Cs0_h1r
  s_nop 2
  v_add_f32_dpp v4, v4, v4 row_ror:4 row_mask:0xf bank_mask:0xf
  v_add_f32_dpp v5, v5, v5 row_ror:4 row_mask:0xf bank_mask:0xf
  s_nop 0
  v_add_f32_dpp v4, v4, v4 row_ror:8 row_mask:0xf bank_mask:0xf
  v_add_f32_dpp v5, v5, v5 row_ror:8 row_mask:0xf bank_mask:0xf
  v_cvt_pk_bf16_f32 v4, v4, v5
  buffer_store_dword v4, v69, s[8:11], s62 offen sc1
  s_xor_b32 s62, s62, 16384
  buffer_store_dword v71, v69, s[8:11], s62 offen sc1
  s_xor_b32 s72, s72, 1
  s_branch Cs0_h2
Cs0_h1r:
  s_mov_b64 exec, vcc
  buffer_load_dwordx4 v[52:55], v76, s[8:11], s60 offen offset:0 sc1
  buffer_load_dwordx4 v[56:59], v76, s[8:11], s60 offen offset:1024 sc1
  s_mov_b64 exec, -1
  s_add_u32 s67, s67, 1
  s_waitcnt vmcnt(1)
  v_mfma_f32_16x16x32_bf16 v[4:7], v[0:3], v[52:55], 0
  v_bitop3_b32 v72, v52, v54, s72 bitop3:0x7e
  s_waitcnt vmcnt(0)
  v_mfma_f32_16x16x32_bf16 v[4:7], v[0:3], v[56:59], v[4:7]
  v_bitop3_b32 v73, v56, v58, s72 bitop3:0x7e
  v_bitop3_b32 v72, v72, v73, 1 bitop3:0xa8
  v_cmp_ne_u32 vcc, 0, v72
  s_cbranch_vccz Cs0_h1p
Cs0_h1s:
  s_mov_b64 exec, vcc
  buffer_load_dwordx4 v[52:55], v76, s[8:11], s60 offen offset:0 sc1
  buffer_load_dwordx4 v[56:59], v76, s[8:11], s60 offen offset:1024 sc1
  s_mov_b64 exec, -1
  s_add_u32 s67, s67, 1
  s_waitcnt vmcnt(1)
  v_mfma_f32_16x16x32_bf16 v[4:7], v[0:3], v[52:55], 0
  v_bitop3_b32 v72, v52, v54, s72 bitop3:0x7e
  s_waitcnt vmcnt(0)
  v_mfma_f32_16x16x32_bf16 v[4:7], v[0:3], v[56:59], v[4:7]
  v_bitop3_b32 v73, v56, v58, s72 bitop3:0x7e
  v_bitop3_b32 v72, v72, v73, 1 bitop3:0xa8
  v_cmp_ne_u32 vcc, 0, v72
  s_cbranch_vccz Cs0_h1p
  s_cmp_lt_u32 s67, 131072
  s_cbranch_scc1 Cs0_h1s
Cs0_h1p:
  s_nop 2
  v_add_f32_dpp v4, v4, v4 row_ror:4 row_mask:0xf bank_mask:0xf
  v_add_f32_dpp v5, v5, v5 row_ror:4 row_mask:0xf bank_mask:0xf
  s_nop 0
  v_add_f32_dpp v4, v4, v4 row_ror:8 row_mask:0xf bank_mask:0xf
  v_add_f32_dpp v5, v5, v5 row_ror:8 row_mask:0xf bank_mask:0xf
  v_cvt_pk_bf16_f32 v4, v4, v5
  buffer_store_dword v4, v69, s[8:11], s62 offen sc1
  s_xor_b32 s62, s62, 16384
  buffer_store_dword v71, v69, s[8:11], s62 offen sc1
  s_xor_b32 s72, s72, 1
  s_branch Cs0_h2
Cs0_rec:
  s_nop 7
  s_waitcnt vmcnt(0) lgkmcnt(0)
  v_max3_u32 v72, v0, v1, v2
  v_max3_u32 v72, v72, v3, v4
  v_max3_u32 v72, v72, v5, v6
  v_max3_u32 v72, v72, v7, v8
  v_max3_u32 v72, v72, v9, v10
  v_max3_u32 v72, v72, v11, v12
  v_max3_u32 v72, v72, v13, v14
  v_max3_u32 v72, v72, v15, v16
  v_max3_u32 v72, v72, v17, v18
  v_max_u32 v72, v72, v19
  v_cmp_eq_u32 vcc, -1, v72
  s_cbranch_vccz Cs0_recok
  s_barrier
  v_mov_b64 v[20:21], 0
  v_mov_b64 v[22:23], 0
  v_mov_b64 v[24:25], 0
  v_mov_b64 v[26:27], 0
  v_mov_b64 v[28:29], 0
  v_mov_b64 v[30:31], 0
  v_mov_b64 v[32:33], 0
  v_mov_b64 v[34:35], 0
  s_waitcnt lgkmcnt(0)
  s_barrier
  ds_read_b128 v[0:3], v76 offset:4608
  s_waitcnt lgkmcnt(0)
  v_smfmac_f32_16x16x64_bf16 v[20:23], v[0:3], v[80:87], v74
  v_smfmac_f32_16x16x64_bf16 v[24:27], v[0:3], v[88:95], v74
  ds_read_b128 v[60:63], v76 offset:16384
  ds_read_b128 v[64:67], v76 offset:17408
  s_waitcnt lgkmcnt(0)
  v_smfmac_f32_16x16x64_bf16 v[28:31], v[0:3], v[60:67], v74
  ds_read_b128 v[60:63], v76 offset:18432
  ds_read_b128 v[64:67], v76 offset:19456
  s_waitcnt lgkmcnt(0)
  v_smfmac_f32_16x16x64_bf16 v[32:35], v[0:3], v[60:67], v74
  ds_read_b128 v[4:7], v76 offset:5632
  s_waitcnt lgkmcnt(0)
  v_smfmac_f32_16x16x64_bf16 v[20:23], v[4:7], v[96:103], v74
  v_smfmac_f32_16x16x64_bf16 v[24:27], v[4:7], v[104:111], v74
  ds_read_b128 v[60:63], v76 offset:32768
  ds_read_b128 v[64:67], v76 offset:33792
  s_waitcnt lgkmcnt(0)
  v_smfmac_f32_16x16x64_bf16 v[28:31], v[4:7], v[60:67], v74
  ds_read_b128 v[60:63], v76 offset:34816
  ds_read_b128 v[64:67], v76 offset:35840
  s_waitcnt lgkmcnt(0)
  v_smfmac_f32_16x16x64_bf16 v[32:35], v[4:7], v[60:67], v74
  ds_read_b128 v[8:11], v76 offset:6656
  s_waitcnt lgkmcnt(0)
  v_smfmac_f32_16x16x64_bf16 v[20:23], v[8:11], v[112:119], v74
  v_smfmac_f32_16x16x64_bf16 v[24:27], v[8:11], v[120:127], v74
  v_smfmac_f32_16x16x64_bf16 v[28:31], v[8:11], v[208:215], v74
  v_smfmac_f32_16x16x64_bf16 v[32:35], v[8:11], v[216:223], v74
  ds_read_b128 v[12:15], v76 offset:7680
  s_waitcnt lgkmcnt(0)
  v_smfmac_f32_16x16x64_bf16 v[20:23], v[12:15], v[128:135], v74
  v_smfmac_f32_16x16x64_bf16 v[24:27], v[12:15], v[136:143], v74
  v_smfmac_f32_16x16x64_bf16 v[28:31], v[12:15], v[224:231], v74
  v_smfmac_f32_16x16x64_bf16 v[32:35], v[12:15], v[232:239], v74
  ds_read_b128 v[0:3], v76 offset:8704
  s_waitcnt lgkmcnt(0)
  v_smfmac_f32_16x16x64_bf16 v[20:23], v[0:3], v[144:151], v74
  v_smfmac_f32_16x16x64_bf16 v[24:27], v[0:3], v[152:159], v74
  ds_read_b128 v[60:63], v76 offset:49152
  ds_read_b128 v[64:67], v76 offset:50176
  s_waitcnt lgkmcnt(0)
  v_smfmac_f32_16x16x64_bf16 v[28:31], v[0:3], v[60:67], v74
  ds_read_b128 v[60:63], v76 offset:51200
  ds_read_b128 v[64:67], v76 offset:52224
  s_waitcnt lgkmcnt(0)
  v_smfmac_f32_16x16x64_bf16 v[32:35], v[0:3], v[60:67], v74
  ds_read_b128 v[8:11], v76 offset:9728
  s_waitcnt lgkmcnt(0)
  v_smfmac_f32_16x16x64_bf16 v[20:23], v[8:11], v[160:167], v74
  v_smfmac_f32_16x16x64_bf16 v[24:27], v[8:11], v[168:175], v74
  ds_read_b128 v[60:63], v75 offset:16384
  ds_read_b128 v[64:67], v75 offset:17408
  s_waitcnt lgkmcnt(0)
  v_smfmac_f32_16x16x64_bf16 v[28:31], v[8:11], v[60:67], v74
  ds_read_b128 v[60:63], v75 offset:18432
  ds_read_b128 v[64:67], v75 offset:19456
  s_waitcnt lgkmcnt(0)
  v_smfmac_f32_16x16x64_bf16 v[32:35], v[8:11], v[60:67], v74
  ds_read_b128 v[16:19], v76 offset:10752
  ds_read_b128 v[60:63], v75 offset:0
  ds_read_b128 v[64:67], v75 offset:1024
  s_waitcnt lgkmcnt(0)
  v_smfmac_f32_16x16x64_bf16 v[20:23], v[16:19], v[60:67], v74
  ds_read_b128 v[60:63], v75 offset:2048
  ds_read_b128 v[64:67], v75 offset:3072
  s_waitcnt lgkmcnt(0)
  v_smfmac_f32_16x16x64_bf16 v[24:27], v[16:19], v[60:67], v74
  v_smfmac_f32_16x16x64_bf16 v[28:31], v[16:19], v[240:247], v74
  v_smfmac_f32_16x16x64_bf16 v[32:35], v[16:19], v[248:255], v74
  ds_read_b128 v[4:7], v76 offset:11776
  s_waitcnt lgkmcnt(0)
  v_smfmac_f32_16x16x64_bf16 v[20:23], v[4:7], v[176:183], v74
  v_smfmac_f32_16x16x64_bf16 v[24:27], v[4:7], v[184:191], v74
  v_smfmac_f32_16x16x64_bf16 v[28:31], v[4:7], a[0:7], v74
  v_smfmac_f32_16x16x64_bf16 v[32:35], v[4:7], a[8:15], v74
  ds_read_b128 v[12:15], v76 offset:12800
  s_waitcnt lgkmcnt(0)
  v_smfmac_f32_16x16x64_bf16 v[20:23], v[12:15], v[192:199], v74
  v_smfmac_f32_16x16x64_bf16 v[24:27], v[12:15], v[200:207], v74
  v_smfmac_f32_16x16x64_bf16 v[28:31], v[12:15], a[16:23], v74
  v_smfmac_f32_16x16x64_bf16 v[32:35], v[12:15], a[24:31], v74
  v_add_f32 v20, v20, v22
  v_add_f32 v21, v21, v23
  v_add_f32 v24, v24, v26
  v_cvt_pk_bf16_f32 v22, v20, v24
  ds_write_b32 v79, v22 offset:0
  v_add_f32 v25, v25, v27
  v_cvt_pk_bf16_f32 v23, v21, v25
  ds_write_b32 v79, v23 offset:576
  v_add_f32 v28, v28, v30
  v_add_f32 v29, v29, v31
  s_waitcnt lgkmcnt(0)
  s_nop 1
  s_branch Cs0_recok
Cs0_mx:
  s_waitcnt lgkmcnt(0)
  s_barrier
  buffer_load_dwordx4 v[52:55], v76, s[8:11], s59 offen offset:0 sc1
  buffer_load_dwordx4 v[0:3], v76, s[8:11], s58 offen offset:0 sc1
  ds_read_b128 v[20:23], v77 offset:0
  ds_read_b128 v[28:31], v77 offset:256
  buffer_load_dwordx4 v[56:59], v76, s[8:11], s59 offen offset:1024 sc1
  buffer_load_dwordx4 v[4:7], v76, s[8:11], s58 offen offset:1024 sc1
  ds_read_b128 v[24:27], v77 offset:128
  ds_read_b128 v[32:35], v77 offset:384
  s_waitcnt vmcnt(2) lgkmcnt(3)
  v_mfma_f32_16x16x32_bf16 v[8:11], v[0:3], v[20:23], 0
  s_waitcnt vmcnt(0) lgkmcnt(1)
  v_mfma_f32_16x16x32_bf16 v[8:11], v[4:7], v[24:27], v[8:11]
  v_mfma_f32_16x16x32_bf16 v[12:15], v[28:31], v[20:23], 0
  s_waitcnt lgkmcnt(0)
  v_mfma_f32_16x16x32_bf16 v[12:15], v[32:35], v[24:27], v[12:15]
  v_add_f32_dpp v8, v10, v8 quad_perm:[2,3,0,1] row_mask:0xf bank_mask:0xf
  v_add_f32_dpp v9, v11, v9 quad_perm:[2,3,0,1] row_mask:0xf bank_mask:0xf
  s_nop 0
  v_mov_b32_dpp v8, v8 quad_perm:[0,1,0,1] row_mask:0xf bank_mask:0xf
  v_mov_b32_dpp v9, v9 quad_perm:[0,1,0,1] row_mask:0xf bank_mask:0xf
  s_nop 1
  v_add_f32_dpp v12, v14, v12 quad_perm:[2,3,0,1] row_mask:0xf bank_mask:0xf
  v_add_f32_dpp v13, v15, v13 quad_perm:[2,3,0,1] row_mask:0xf bank_mask:0xf
  s_nop 0
  v_mov_b32_dpp v12, v12 quad_perm:[0,1,0,1] row_mask:0xf bank_mask:0xf
  v_mov_b32_dpp v13, v13 quad_perm:[0,1,0,1] row_mask:0xf bank_mask:0xf
  v_mul_f32 v12, s69, v12
  ds_write_b32 v78, v8 offset:8704
  v_mul_f32 v13, s69, v13
  ds_write_b32 v78, v9 offset:8768
  s_waitcnt lgkmcnt(0)
  s_barrier
  ds_read_b128 v[36:39], v78 offset:8704
  ds_read_b128 v[40:43], v78 offset:8768
  s_waitcnt lgkmcnt(0)
  s_barrier
  v_max_f32 v16, v36, v37
  v_max3_f32 v16, v16, v38, v39
  v_max3_f32 v16, v16, v40, v41
  v_max3_f32 v16, v16, v42, v43
  v_max3_f32 v16, v16, v12, v13
  v_mov_b32 v17, v16
  s_nop 1
  v_permlane16_swap_b32 v16, v17
  v_max_f32 v16, v16, v17
  v_mov_b32 v17, v16
  s_nop 1
  v_permlane32_swap_b32 v16, v17
  v_max_f32 v16, v16, v17
  v_sub_f32 v36, v36, v16
  v_sub_f32 v37, v37, v16
  v_sub_f32 v38, v38, v16
  v_sub_f32 v39, v39, v16
  v_sub_f32 v40, v40, v16
  v_sub_f32 v41, v41, v16
  v_sub_f32 v42, v42, v16
  v_sub_f32 v43, v43, v16
  v_sub_f32 v12, v12, v16
  v_sub_f32 v13, v13, v16
  v_exp_f32 v36, v36
  v_exp_f32 v37, v37
  v_exp_f32 v38, v38
  v_exp_f32 v39, v39
  v_exp_f32 v40, v40
  v_exp_f32 v41, v41
  v_exp_f32 v42, v42
  v_exp_f32 v43, v43
  v_exp_f32 v12, v12
  v_exp_f32 v13, v13
  v_cvt_pk_bf16_f32 v32, v36, v40
  v_cvt_pk_bf16_f32 v33, v37, v41
  v_cvt_pk_bf16_f32 v34, v38, v42
  v_cvt_pk_bf16_f32 v35, v39, v43
  v_cvt_pk_bf16_f32 v28, v12, v13
  v_cvt_pk_bf16_f32 v31, v12, v13
  v_mov_b32 v29, 0
  v_mov_b32 v30, 0
  v_mfma_f32_16x16x32_bf16 v[8:11], v[32:35], v[68:71], 0
  v_mfma_f32_16x16x32_bf16 v[0:3], v[32:35], v[52:55], 0
  v_mfma_f32_16x16x32_bf16 v[4:7], v[32:35], v[56:59], 0
  v_mfma_f32_16x16x16_bf16 v[8:11], v[28:29], v[68:69], v[8:11]
  v_mfma_f32_16x16x16_bf16 v[0:3], v[28:29], v[72:73], v[0:3]
  v_mfma_f32_16x16x16_bf16 v[4:7], v[30:31], v[72:73], v[4:7]
  ds_read_b128 v[52:55], v75 offset:32768
  v_rcp_f32 v10, v8
  v_rcp_f32 v11, v9
  v_mul_f32 v0, v10, v0
  v_mul_f32 v1, v11, v1
  v_max3_f32 v8, v8, v9, v10
  v_mul_f32 v4, v10, v4
  v_mul_f32 v5, v11, v5
  v_cvt_pk_bf16_f32 v2, v0, v4
  ds_write_b32 v79, v2 offset:8704
  v_cvt_pk_bf16_f32 v3, v1, v5
  ds_write_b32 v79, v3 offset:9280
  ds_read_b128 v[12:15], v78 offset:8704
  ds_read_b128 v[56:59], v75 offset:33792
  v_mov_b64 v[16:17], 0
  v_mov_b64 v[18:19], 0
  v_mov_b64 v[20:21], 0
  v_mov_b64 v[22:23], 0
  v_mov_b64 v[24:25], 0
  v_mov_b64 v[26:27], 0
  s_branch Cs0_mxok
Cs0_kv3:
  s_waitcnt lgkmcnt(0)
  s_cmp_ge_u32 s57, 0x700
  s_cbranch_scc1 Cs0_kvb
  s_load_dword s57, s[12:13], s71 glc
  s_add_u32 s67, s67, 1
  s_cmp_lt_u32 s67, 131072
  s_cbranch_scc1 Cs0_kv3
  s_waitcnt lgkmcnt(0)
  s_branch Cs0_kvb
Cs0_last:
  ds_read_b128 v[4:7], v76 offset:5632
  ds_read_b128 v[12:15], v76 offset:7680
  ds_read_b128 v[44:47], v76 offset:32768
  ds_read_b128 v[48:51], v76 offset:33792
  s_nop 5
  v_mov_b64 v[20:21], 0
  v_mov_b64 v[22:23], 0
  v_mov_b64 v[24:25], 0
  v_mov_b64 v[26:27], 0
  v_smfmac_f32_16x16x64_bf16 v[28:31], v[0:3], v[36:43], v74
  ds_read_b128 v[36:39], v76 offset:34816
  ds_read_b128 v[40:43], v76 offset:35840
  v_smfmac_f32_16x16x64_bf16 v[32:35], v[0:3], v[60:67], v74
  s_waitcnt lgkmcnt(5)
  v_smfmac_f32_16x16x64_bf16 v[20:23], v[0:3], a[32:39], v74
  ds_read_b128 v[60:63], v76 offset:49152
  ds_read_b128 v[64:67], v76 offset:50176
  v_smfmac_f32_16x16x64_bf16 v[24:27], v[0:3], a[40:47], v74
  s_waitcnt lgkmcnt(4)
  v_smfmac_f32_16x16x64_bf16 v[20:23], v[4:7], a[48:55], v74
  buffer_store_dwordx4 v[16:19], v76, s[8:11], s68 offen sc1
  v_smfmac_f32_16x16x64_bf16 v[24:27], v[4:7], a[56:63], v74
  v_smfmac_f32_16x16x64_bf16 v[28:31], v[4:7], v[44:51], v74
  s_waitcnt lgkmcnt(2)
  v_smfmac_f32_16x16x64_bf16 v[20:23], v[8:11], a[64:71], v74
  ds_read_b128 v[44:47], v76 offset:51200
  ds_read_b128 v[48:51], v76 offset:52224
  v_smfmac_f32_16x16x64_bf16 v[24:27], v[8:11], a[72:79], v74
  v_smfmac_f32_16x16x64_bf16 v[32:35], v[4:7], v[36:43], v74
  v_smfmac_f32_16x16x64_bf16 v[28:31], v[8:11], v[208:215], v74
  ds_read_b128 v[36:39], v75 offset:16384
  ds_read_b128 v[40:43], v75 offset:17408
  v_smfmac_f32_16x16x64_bf16 v[32:35], v[8:11], v[216:223], v74
  v_smfmac_f32_16x16x64_bf16 v[20:23], v[12:15], a[80:87], v74
  v_smfmac_f32_16x16x64_bf16 v[24:27], v[12:15], a[88:95], v74
  v_smfmac_f32_16x16x64_bf16 v[28:31], v[12:15], v[224:231], v74
  v_smfmac_f32_16x16x64_bf16 v[32:35], v[12:15], v[232:239], v74
  s_waitcnt vmcnt(1)
  s_barrier
Cs0_lastr:
  ds_read_b128 v[0:3], v76 offset:8704
  ds_read_b128 v[8:11], v76 offset:9728
  ds_read_b128 v[16:19], v76 offset:10752
  ds_read_b128 v[4:7], v76 offset:11776
  ds_read_b128 v[12:15], v76 offset:12800
  s_waitcnt lgkmcnt(4)
  v_max3_u32 v72, v0, v1, v2
  s_waitcnt lgkmcnt(1)
  v_max3_u32 v72, v72, v3, v4
  v_max3_u32 v72, v72, v5, v6
  v_max3_u32 v72, v72, v7, v8
  v_max3_u32 v72, v72, v9, v10
  s_waitcnt lgkmcnt(0)
  v_max3_u32 v72, v72, v11, v12
  v_max3_u32 v72, v72, v13, v14
  v_max3_u32 v72, v72, v15, v16
  v_max3_u32 v72, v72, v17, v18
  v_max_u32 v72, v72, v19
  v_cmp_eq_u32 vcc, -1, v72
  s_cbranch_vccnz Cs0_lastp
Cs0_lastg:
  v_smfmac_f32_16x16x64_bf16 v[28:31], v[0:3], v[60:67], v74
  ds_read_b128 v[60:63], v75 offset:18432
  ds_read_b128 v[64:67], v75 offset:19456
  v_smfmac_f32_16x16x64_bf16 v[32:35], v[0:3], v[44:51], v74
  v_smfmac_f32_16x16x64_bf16 v[28:31], v[8:11], v[36:43], v74
  v_smfmac_f32_16x16x64_bf16 v[28:31], v[16:19], v[240:247], v74
  v_smfmac_f32_16x16x64_bf16 v[28:31], v[4:7], a[0:7], v74
  v_smfmac_f32_16x16x64_bf16 v[28:31], v[12:15], a[16:23], v74
  v_smfmac_f32_16x16x64_bf16 v[32:35], v[16:19], v[248:255], v74
  v_smfmac_f32_16x16x64_bf16 v[32:35], v[4:7], a[8:15], v74
  s_waitcnt lgkmcnt(0)
  v_smfmac_f32_16x16x64_bf16 v[32:35], v[12:15], a[24:31], v74
  v_smfmac_f32_16x16x64_bf16 v[32:35], v[8:11], v[60:67], v74
  v_smfmac_f32_16x16x64_bf16 v[20:23], v[0:3], a[96:103], v74
  v_smfmac_f32_16x16x64_bf16 v[20:23], v[8:11], a[112:119], v74
  v_add_f32 v28, v28, v30
  v_add_f32 v32, v32, v34
  v_cvt_pk_bf16_f32 v30, v28, v32
  v_smfmac_f32_16x16x64_bf16 v[20:23], v[16:19], a[128:135], v74
  ds_write_b32 v79, v30 offset:256
  v_add_f32 v29, v29, v31
  v_add_f32 v33, v33, v35
  v_cvt_pk_bf16_f32 v31, v29, v33
  v_smfmac_f32_16x16x64_bf16 v[20:23], v[4:7], a[144:151], v74
  ds_write_b32 v79, v31 offset:832
  v_smfmac_f32_16x16x64_bf16 v[20:23], v[12:15], a[160:167], v74
  v_smfmac_f32_16x16x64_bf16 v[24:27], v[0:3], a[104:111], v74
  v_smfmac_f32_16x16x64_bf16 v[24:27], v[8:11], a[120:127], v74
  v_smfmac_f32_16x16x64_bf16 v[24:27], v[16:19], a[136:143], v74
  s_waitcnt lgkmcnt(0)
  s_barrier
  ds_read_b64 v[52:53], v77 offset:256
  v_add_f32 v20, v20, v22
  v_smfmac_f32_16x16x64_bf16 v[24:27], v[4:7], a[152:159], v74
  v_add_f32 v21, v21, v23
  v_smfmac_f32_16x16x64_bf16 v[24:27], v[12:15], a[168:175], v74
  v_cvt_pk_bf16_f32 v54, v20, v21
  s_add_u32 s68, s68, 655360
  s_nop 3
  v_add_f32 v24, v24, v26
  v_add_f32 v25, v25, v27
  v_cvt_pk_bf16_f32 v55, v24, v25
  s_waitcnt lgkmcnt(0)
  buffer_store_dwordx4 v[52:55], v76, s[8:11], s68 offen sc1
  s_branch Cs0_done
Cs0_lastp:
  s_add_u32 s72, s72, 2
  s_cmp_ge_u32 s72, 131072
  s_cbranch_scc1 Cs0_lastg
  s_barrier
  buffer_load_dwordx4 v76, s[8:11], s85 offen offset:0 sc1 lds
  s_waitcnt vmcnt(0)
  s_barrier
  s_branch Cs0_lastr
Cs0_done:
  s_branch L_cexit
L_w5:
  v_mov_b64 v[20:21], 0
  v_mov_b64 v[22:23], 0
  v_mov_b64 v[24:25], 0
  v_mov_b64 v[26:27], 0
  v_mov_b64 v[28:29], 0
  v_mov_b64 v[30:31], 0
  v_mov_b64 v[32:33], 0
  v_mov_b64 v[34:35], 0
  s_mov_b32 s78, 0x3f803f80
  s_mov_b32 s79, s78
  s_mov_b32 s65, 360448
  s_mov_b32 m0, 15872
  s_lshl_b32 s71, s53, 2
  s_add_u32 s71, s71, 128
  s_movk_i32 s56, 0x1000
  v_lshlrev_b32 v73, 2, v76
  v_mov_b32 v72, 0
  s_mov_b64 s[16:17], s[8:9]
  s_mov_b32 s18, 268435456
  s_mov_b32 s19, 0x20000
  s_getpc_b64 s[20:21]
Cs1_pc:
  s_add_u32 s20, s20, (Cs1_last - Cs1_pc)
  s_addc_u32 s21, s21, 0
  v_mov_b32 v68, 14880
  buffer_load_dwordx4 v[52:55], v76, s[8:11], s59 offen offset:0 sc1
  buffer_load_dwordx4 v[56:59], v76, s[8:11], s59 offen offset:1024 sc1
  ds_read_b128 v[36:39], v76 offset:20480
  ds_read_b128 v[40:43], v76 offset:21504
  ds_read_b128 v[60:63], v76 offset:22528
  ds_read_b128 v[64:67], v76 offset:23552
  ds_read_b128 v[0:3], v76 offset:4608
  ds_read_b128 v[4:7], v76 offset:5632
  ds_read_b128 v[8:11], v76 offset:6656
  ds_read_b128 v[12:15], v76 offset:7680
  s_waitcnt lgkmcnt(0)
  s_cmp_eq_u32 s66, 1
  s_branch Cs1_top2
.p2align 6
Cs1_h2:
  ds_read_b128 v[36:39], v76 offset:20480
  v_lshlrev_b32 v73, 2, v76
  ds_read_b128 v[40:43], v76 offset:21504
  v_mov_b64 v[20:21], 0
  v_mov_b64 v[22:23], 0
  v_mov_b64 v[24:25], 0
  v_mov_b64 v[26:27], 0
  v_mov_b32 v68, 14880
  ds_read_b128 v[60:63], v76 offset:22528
  s_cmp_eq_u32 s66, 62
  s_cselect_b64 s[16:17], s[20:21], s[16:17]
  s_cselect_b32 s18, (Cs1_done - Cs1_last), s18
  s_cselect_b32 s70, 0, s70
  s_cmp_eq_u32 s66, 63
  s_cselect_b32 s59, 268435456, s59
  s_cselect_b32 s58, 268435456, s58
  buffer_load_dwordx4 v[52:55], v76, s[8:11], s59 offen offset:0 sc1
  buffer_load_dwordx4 v[56:59], v76, s[8:11], s59 offen offset:1024 sc1
  s_waitcnt vmcnt(0)
  s_mov_b64 vcc, -1
Cs1_h2r:
  s_mov_b64 exec, vcc
  buffer_load_dwordx4 v[8:11], v76, s[8:11], s65 offen offset:2048 sc1
  buffer_load_dwordx4 v[0:3], v76, s[8:11], s85 offen offset:0 sc1
  s_mov_b64 exec, -1
  s_add_u32 s67, s67, 1
  s_cmp_lt_u32 s67, 131072
  s_cselect_b32 s54, -2, -1
  s_waitcnt vmcnt(1)
  v_max3_u32 v72, v8, v9, v10
  s_waitcnt vmcnt(0)
  v_max3_u32 v72, v72, v11, v0
  v_max3_u32 v72, v72, v1, v2
  v_max_u32 v72, v72, v3
  v_cmp_lt_u32 vcc, s54, v72
  s_cbranch_vccnz Cs1_h2r
  ds_write_b128 v76, v[8:11] offset:6656
  ds_write_b128 v76, v[0:3] offset:11776
Cs1_h2w:
  s_cmp_eq_u32 s66, 63
  s_waitcnt lgkmcnt(0)
  s_barrier
  ds_read_b128 v[0:3], v76 offset:4608
Cs1_top2:
  v_smfmac_f32_16x16x64_bf16 v[20:23], v[8:11], v[112:119], v74
  s_cbranch_scc1 Cs1_last
  v_smfmac_f32_16x16x64_bf16 v[24:27], v[8:11], v[120:127], v74
  buffer_load_dwordx4 v[44:47], v76, s[8:11], s58 offen offset:0 sc1
  s_mov_b32 m0, 15872
  v_smfmac_f32_16x16x64_bf16 v[28:31], v[8:11], v[208:215], v74
  buffer_load_dwordx4 v[48:51], v76, s[8:11], s58 offen offset:1024 sc1
  v_smfmac_f32_16x16x64_bf16 v[32:35], v[8:11], v[216:223], v74
  ds_read_b128 v[4:7], v76 offset:5632
  s_waitcnt lgkmcnt(1)
  v_smfmac_f32_16x16x64_bf16 v[20:23], v[0:3], v[80:87], v74
  ds_read_b128 v[12:15], v76 offset:7680
  v_smfmac_f32_16x16x64_bf16 v[28:31], v[0:3], v[36:43], v74
  ds_read_b128 v[36:39], v76 offset:36864
  v_smfmac_f32_16x16x64_bf16 v[24:27], v[0:3], v[88:95], v74
  buffer_store_dwordx4 v[16:19], v76, s[8:11], s68 offen sc1
  ds_read_b128 v[40:43], v76 offset:37888
  v_smfmac_f32_16x16x64_bf16 v[32:35], v[0:3], v[60:67], v74
  buffer_load_dword v73, s[16:19], s70 offen lds
  ds_read_b128 v[60:63], v76 offset:38912
  s_waitcnt lgkmcnt(4)
  v_smfmac_f32_16x16x64_bf16 v[20:23], v[4:7], v[96:103], v74
  ds_read_b128 v[64:67], v76 offset:39936
  v_smfmac_f32_16x16x64_bf16 v[24:27], v[4:7], v[104:111], v74
  s_waitcnt vmcnt(4)
  s_waitcnt lgkmcnt(4)
  v_smfmac_f32_16x16x64_bf16 v[20:23], v[12:15], v[128:135], v74
  s_barrier
  ds_read_b128 v[8:11], v76 offset:8704
  s_waitcnt lgkmcnt(3)
  v_smfmac_f32_16x16x64_bf16 v[28:31], v[4:7], v[36:43], v74
  ds_read_b128 v[36:39], v76 offset:53248
  v_smfmac_f32_16x16x64_bf16 v[24:27], v[12:15], v[136:143], v74
  ds_read_b128 v[40:43], v76 offset:54272
  s_waitcnt lgkmcnt(3)
  v_smfmac_f32_16x16x64_bf16 v[32:35], v[4:7], v[60:67], v74
  ds_read_b128 v[0:3], v76 offset:9728
  v_smfmac_f32_16x16x64_bf16 v[28:31], v[12:15], v[224:231], v74
  ds_read_b128 v[60:63], v76 offset:55296
  v_smfmac_f32_16x16x64_bf16 v[32:35], v[12:15], v[232:239], v74
  ds_read_b128 v[64:67], v76 offset:56320
  s_waitcnt lgkmcnt(5)
  v_smfmac_f32_16x16x64_bf16 v[20:23], v[8:11], v[144:151], v74
  s_barrier
  ds_read_b128 v[4:7], v76 offset:11776
  s_waitcnt lgkmcnt(4)
  v_smfmac_f32_16x16x64_bf16 v[28:31], v[8:11], v[36:43], v74
  ds_read_b128 v[12:15], v76 offset:12800
  ds_read_b128 v[36:39], v75 offset:4096
  v_smfmac_f32_16x16x64_bf16 v[24:27], v[8:11], v[152:159], v74
  ds_read_b128 v[16:19], v76 offset:10752
  s_waitcnt lgkmcnt(6)
  v_smfmac_f32_16x16x64_bf16 v[20:23], v[0:3], v[160:167], v74
  ds_read_b128 v[40:43], v75 offset:5120
  s_waitcnt lgkmcnt(5)
  v_smfmac_f32_16x16x64_bf16 v[32:35], v[8:11], v[60:67], v74
  ds_read_b128 v[60:63], v75 offset:6144
  v_smfmac_f32_16x16x64_bf16 v[24:27], v[0:3], v[168:175], v74
  ds_read_b128 v[64:67], v75 offset:7168
  s_waitcnt lgkmcnt(6)
  v_smfmac_f32_16x16x64_bf16 v[20:23], v[4:7], v[176:183], v74
  s_waitcnt lgkmcnt(5)
  v_smfmac_f32_16x16x64_bf16 v[20:23], v[12:15], v[192:199], v74
  s_waitcnt lgkmcnt(2)
  v_smfmac_f32_16x16x64_bf16 v[20:23], v[16:19], v[36:43], v74
  ds_read_b128 v[36:39], v75 offset:20480
  v_smfmac_f32_16x16x64_bf16 v[24:27], v[4:7], v[184:191], v74
  ds_read_b128 v[40:43], v75 offset:21504
  s_waitcnt lgkmcnt(2)
  v_smfmac_f32_16x16x64_bf16 v[24:27], v[16:19], v[60:67], v74
  ds_read_b128 v[60:63], v75 offset:22528
  v_add_f32 v20, v20, v22
  v_smfmac_f32_16x16x64_bf16 v[24:27], v[12:15], v[200:207], v74
  ds_read_b128 v[64:67], v75 offset:23552
  v_add_f32 v21, v21, v23
  v_smfmac_f32_16x16x64_bf16 v[28:31], v[16:19], v[240:247], v74
  v_mov_b64 v[70:71], s[78:79]
  v_smfmac_f32_16x16x64_bf16 v[28:31], v[4:7], a[0:7], v74
  s_waitcnt lgkmcnt(2)
  v_add_f32 v24, v24, v26
  v_smfmac_f32_16x16x64_bf16 v[28:31], v[0:3], v[36:43], v74
  ds_read_b128 v[36:39], v68
  v_cvt_pk_bf16_f32 v22, v20, v24
  v_smfmac_f32_16x16x64_bf16 v[28:31], v[12:15], a[16:23], v74
  ds_read_b128 v[40:43], v68
  ds_write_b32 v79, v22 offset:0
  s_waitcnt lgkmcnt(3)
  v_add_f32 v25, v25, v27
  v_cvt_pk_bf16_f32 v23, v21, v25
  v_smfmac_f32_16x16x64_bf16 v[32:35], v[0:3], v[60:67], v74
  ds_write_b32 v79, v23 offset:576
  v_cmp_u_f32 vcc, v20, v21
  v_smfmac_f32_16x16x64_bf16 v[32:35], v[16:19], v[248:255], v74
  v_add_f32 v28, v28, v30
  v_smfmac_f32_16x16x64_bf16 v[32:35], v[4:7], a[8:15], v74
  v_add_f32 v29, v29, v31
  v_smfmac_f32_16x16x64_bf16 v[32:35], v[12:15], a[24:31], v74
  s_cbranch_vccnz Cs1_rec
Cs1_recok:
  s_waitcnt lgkmcnt(3)
  v_smfmac_f32_16x16x64_bf16 v[36:39], v[16:19], a[128:135], v74
  s_waitcnt lgkmcnt(0)
  s_barrier
  ds_read_b128 v[60:63], v77
  v_smfmac_f32_16x16x64_bf16 v[40:43], v[16:19], a[136:143], v74
  ds_read_b128 v[64:67], v77 offset:128
  v_add_f32 v32, v32, v34
  v_cvt_pk_bf16_f32 v30, v28, v32
  v_smfmac_f32_16x16x64_bf16 v[36:39], v[0:3], a[112:119], v74
  ds_write_b32 v79, v30 offset:256
  v_add_f32 v33, v33, v35
  v_cvt_pk_bf16_f32 v31, v29, v33
  v_smfmac_f32_16x16x64_bf16 v[40:43], v[0:3], a[120:127], v74
  ds_write_b32 v79, v31 offset:832
  v_xor_b32 v75, 0x8000, v75
  v_smfmac_f32_16x16x64_bf16 v[36:39], v[4:7], a[144:151], v74
  ds_read_b128 v[0:3], v76 offset:4608
  v_mov_b32 v29, 0
  v_smfmac_f32_16x16x64_bf16 v[40:43], v[4:7], a[152:159], v74
  s_waitcnt vmcnt(2) lgkmcnt(3)
  v_mov_b32 v30, 0
  v_mfma_f32_16x16x32_bf16 v[44:47], v[44:47], v[60:63], 0
  ds_read_b128 v[4:7], v76 offset:5632
  s_waitcnt lgkmcnt(2)
  v_mfma_f32_16x16x32_bf16 v[44:47], v[48:51], v[64:67], v[44:47]
  s_barrier
  v_smfmac_f32_16x16x64_bf16 v[36:39], v[8:11], a[96:103], v74
  ds_read_b128 v[20:23], v77 offset:256
  ds_read_b128 v[24:27], v77 offset:384
  v_smfmac_f32_16x16x64_bf16 v[40:43], v[8:11], a[104:111], v74
  ds_read_b128 v[8:11], v76 offset:6656
  v_add_f32_dpp v72, v46, v44 quad_perm:[2,3,0,1] row_mask:0xf bank_mask:0xf
  v_add_f32_dpp v73, v47, v45 quad_perm:[2,3,0,1] row_mask:0xf bank_mask:0xf
  v_smfmac_f32_16x16x64_bf16 v[36:39], v[12:15], a[160:167], v74
  s_waitcnt lgkmcnt(4)
  v_exp_f32_dpp v72, v72 quad_perm:[0,1,0,1] row_mask:0xf bank_mask:0xf
  v_smfmac_f32_16x16x64_bf16 v[40:43], v[12:15], a[168:175], v74
  ds_read_b128 v[12:15], v76 offset:7680
  v_exp_f32_dpp v73, v73 quad_perm:[0,1,0,1] row_mask:0xf bank_mask:0xf
  v_smfmac_f32_16x16x64_bf16 v[36:39], v[0:3], a[32:39], v74
  s_waitcnt lgkmcnt(2)
  v_cvt_pk_bf16_f32 v72, v72, v73
  v_mfma_f32_16x16x32_bf16 v[20:23], v[20:23], v[60:63], 0
  ds_write_b32 v78, v72 offset:516
  v_mov_b64 v[16:17], 0
  v_mfma_f32_16x16x32_bf16 v[20:23], v[24:27], v[64:67], v[20:23]
  ds_read_b128 v[44:47], v75 offset:22528
  v_mov_b64 v[18:19], 0
  v_smfmac_f32_16x16x64_bf16 v[40:43], v[0:3], a[40:47], v74
  ds_read_b128 v[48:51], v75 offset:23552
  v_mov_b64 v[68:69], s[78:79]
  v_smfmac_f32_16x16x64_bf16 v[36:39], v[4:7], a[48:55], v74
  s_waitcnt lgkmcnt(4)
  v_add_f32_dpp v24, v22, v20 quad_perm:[2,3,0,1] row_mask:0xf bank_mask:0xf
  v_add_f32_dpp v25, v23, v21 quad_perm:[2,3,0,1] row_mask:0xf bank_mask:0xf
  v_smfmac_f32_16x16x64_bf16 v[36:39], v[8:11], a[64:71], v74
  s_waitcnt lgkmcnt(2)
  s_barrier
  ds_read_b128 v[32:35], v78 offset:512
  v_smfmac_f32_16x16x64_bf16 v[36:39], v[12:15], a[80:87], v74
  ds_read_b128 v[60:63], v75 offset:20480
  v_mul_f32 v24, s69, v24
  v_smfmac_f32_16x16x64_bf16 v[40:43], v[4:7], a[56:63], v74
  ds_read_b128 v[64:67], v75 offset:21504
  v_mul_f32 v25, s69, v25
  v_smfmac_f32_16x16x64_bf16 v[40:43], v[8:11], a[72:79], v74
  v_exp_f32_dpp v24, v24 quad_perm:[0,1,0,1] row_mask:0xf bank_mask:0xf
  v_smfmac_f32_16x16x64_bf16 v[40:43], v[12:15], a[88:95], v74
  s_waitcnt lgkmcnt(2)
  v_exp_f32_dpp v25, v25 quad_perm:[0,1,0,1] row_mask:0xf bank_mask:0xf
  v_mfma_f32_16x16x32_bf16 v[8:11], v[32:35], v[68:71], 0
  v_add_f32 v36, v36, v38
  v_add_f32 v37, v37, v39
  v_mfma_f32_16x16x32_bf16 v[0:3], v[32:35], v[52:55], 0
  v_add_f32 v40, v40, v42
  v_add_f32 v41, v41, v43
  v_mfma_f32_16x16x32_bf16 v[4:7], v[32:35], v[56:59], 0
  v_cvt_pk_bf16_f32 v28, v24, v25
  v_cvt_pk_bf16_f32 v72, v36, v37
  v_cvt_pk_bf16_f32 v73, v40, v41
  v_mfma_f32_16x16x16_bf16 v[8:11], v[28:29], v[68:69], v[8:11]
  v_cvt_pk_bf16_f32 v31, v24, v25
  v_mov_b64 v[20:21], 0
  v_mfma_f32_16x16x16_bf16 v[0:3], v[28:29], v[72:73], v[0:3]
  ds_read_b128 v[52:55], v75 offset:36864
  v_mov_b64 v[22:23], 0
  v_mfma_f32_16x16x16_bf16 v[4:7], v[30:31], v[72:73], v[4:7]
  v_rcp_f32 v10, v8
  v_rcp_f32 v11, v9
  v_mul_f32 v0, v10, v0
  v_mul_f32 v1, v11, v1
  v_max3_f32 v8, v8, v9, v10
  v_mul_f32 v4, v10, v4
  v_mul_f32 v5, v11, v5
  v_cvt_pk_bf16_f32 v2, v0, v4
  ds_write_b32 v79, v2 offset:8704
  v_cvt_pk_bf16_f32 v3, v1, v5
  ds_write_b32 v79, v3 offset:9280
  ds_read_b128 v[12:15], v78 offset:8768
  v_max_f32 v8, v8, v11
  v_cmp_le_f32 vcc, 1317011456, v8
  v_mov_b64 v[24:25], 0
  v_mov_b64 v[26:27], 0
  ds_read_b128 v[56:59], v75 offset:37888
  s_cbranch_vccnz Cs1_mx
Cs1_mxok:
  s_waitcnt lgkmcnt(2)
  s_barrier
  ds_read_b128 v[0:3], v78 offset:8704
  s_waitcnt lgkmcnt(2)
  v_smfmac_f32_16x16x64_bf16 v[16:19], v[12:15], v[44:51], v74
  ds_read_b128 v[4:7], v78 offset:8832
  v_smfmac_f32_16x16x64_bf16 v[20:23], v[12:15], a[200:207], v74
  ds_read_b128 v[8:11], v78 offset:8896
  v_smfmac_f32_16x16x64_bf16 v[24:27], v[12:15], a[216:223], v74
  ds_read_b128 v[36:39], v75 offset:38912
  s_waitcnt lgkmcnt(3)
  v_smfmac_f32_16x16x64_bf16 v[16:19], v[0:3], v[60:67], v74
  ds_read_b128 v[40:43], v75 offset:39936
  s_waitcnt lgkmcnt(3)
  v_smfmac_f32_16x16x64_bf16 v[16:19], v[4:7], a[176:183], v74
  ds_read_b128 v[68:71], v76 offset:13824
  s_waitcnt lgkmcnt(3)
  v_smfmac_f32_16x16x64_bf16 v[16:19], v[8:11], a[184:191], v74
  ds_read_b128 v[44:47], v75 offset:53248
  v_smfmac_f32_16x16x64_bf16 v[20:23], v[0:3], a[192:199], v74
  ds_read_b128 v[48:51], v75 offset:54272
  v_smfmac_f32_16x16x64_bf16 v[20:23], v[4:7], v[52:59], v74
  ds_read_b128 v[60:63], v75 offset:55296
  s_waitcnt lgkmcnt(4)
  v_cvt_pk_bf16_f32 v16, v16, v17
  v_cvt_pk_bf16_f32 v17, v18, v19
  v_bfi_b32 v16, 1, s72, v16
  v_smfmac_f32_16x16x64_bf16 v[20:23], v[8:11], v[36:43], v74
  s_waitcnt lgkmcnt(3)
  buffer_store_dwordx2 v[16:17], v68, s[8:11], s73 offen sc1
  v_mov_b64 v[32:33], 0
  v_smfmac_f32_16x16x64_bf16 v[24:27], v[0:3], a[208:215], v74
  ds_read_b128 v[64:67], v75 offset:56320
  v_mov_b64 v[34:35], 0
  v_smfmac_f32_16x16x64_bf16 v[24:27], v[4:7], a[224:231], v74
  v_cvt_pk_bf16_f32 v20, v20, v21
  v_cvt_pk_bf16_f32 v21, v22, v23
  v_bfi_b32 v20, 1, s72, v20
  v_smfmac_f32_16x16x64_bf16 v[24:27], v[8:11], a[232:239], v74
  buffer_store_dwordx2 v[20:21], v68, s[8:11], s74 offen sc1
  s_waitcnt lgkmcnt(2)
  v_smfmac_f32_16x16x64_bf16 v[32:35], v[0:3], v[44:51], v74
  s_waitcnt lgkmcnt(0)
  v_smfmac_f32_16x16x64_bf16 v[32:35], v[12:15], v[60:67], v74
  v_cvt_pk_bf16_f32 v24, v24, v25
  v_cvt_pk_bf16_f32 v25, v26, v27
  v_bfi_b32 v24, 1, s72, v24
  v_smfmac_f32_16x16x64_bf16 v[32:35], v[4:7], a[240:247], v74
  buffer_store_dwordx2 v[24:25], v68, s[8:11], s75 offen sc1
  v_smfmac_f32_16x16x64_bf16 v[32:35], v[8:11], a[248:255], v74
  v_mov_b64 v[18:19], v[72:73]
  s_nop 4
  v_cvt_pk_bf16_f32 v32, v32, v33
  v_cvt_pk_bf16_f32 v33, v34, v35
  v_bfi_b32 v32, 1, s72, v32
  buffer_store_dwordx2 v[32:33], v68, s[8:11], s76 offen sc1
  ds_read_b128 v[0:3], v76 offset:14848
  s_waitcnt lgkmcnt(0)
  ds_read_b64 v[16:17], v77 offset:264
  s_waitcnt lgkmcnt(0)
  ds_read_b128 v[64:67], v76 offset:23552
  s_waitcnt lgkmcnt(0)
  s_add_u32 s66, s66, 1
  s_xor_b32 s64, s64, 16384
  s_xor_b32 s65, s65, 16384
  s_add_u32 s58, s58, 655360
  s_add_u32 s59, s59, 655360
  s_add_u32 s70, s70, 655360
  s_add_u32 s68, s68, 655360
  s_mov_b32 m0, 11776
  s_add_u32 s85, s65, 7168
  v_xor_b32 v75, 0x8000, v75
  v_mov_b64 v[28:29], 0
  v_mov_b64 v[30:31], 0
  v_mov_b64 v[32:33], 0
  v_mov_b64 v[34:35], 0
  s_waitcnt vmcnt(0)
  buffer_load_dwordx4 v[52:55], v76, s[8:11], s60 offen offset:0 sc1
  buffer_load_dwordx4 v[56:59], v76, s[8:11], s60 offen offset:1024 sc1
  s_waitcnt lgkmcnt(0)
  s_waitcnt vmcnt(1)
  v_mfma_f32_16x16x32_bf16 v[4:7], v[0:3], v[52:55], 0
  v_bitop3_b32 v72, v52, v54, s72 bitop3:0x7e
  s_waitcnt vmcnt(0)
  v_mfma_f32_16x16x32_bf16 v[4:7], v[0:3], v[56:59], v[4:7]
  v_bitop3_b32 v73, v56, v58, s72 bitop3:0x7e
  v_bitop3_b32 v72, v72, v73, 1 bitop3:0xa8
  v_cmp_ne_u32 vcc, 0, v72
  s_cbranch_vccnz Cs1_h1r
  s_nop 2
  v_add_f32_dpp v4, v4, v4 row_ror:4 row_mask:0xf bank_mask:0xf
  v_add_f32_dpp v5, v5, v5 row_ror:4 row_mask:0xf bank_mask:0xf
  s_nop 0
  v_add_f32_dpp v4, v4, v4 row_ror:8 row_mask:0xf bank_mask:0xf
  v_add_f32_dpp v5, v5, v5 row_ror:8 row_mask:0xf bank_mask:0xf
  v_cvt_pk_bf16_f32 v4, v4, v5
  buffer_store_dword v4, v69, s[8:11], s62 offen sc1
  s_xor_b32 s62, s62, 16384
  buffer_store_dword v71, v69, s[8:11], s62 offen sc1
  s_xor_b32 s72, s72, 1
  s_branch Cs1_h2
Cs1_h1r:
  s_mov_b64 exec, vcc
  buffer_load_dwordx4 v[52:55], v76, s[8:11], s60 offen offset:0 sc1
  buffer_load_dwordx4 v[56:59], v76, s[8:11], s60 offen offset:1024 sc1
  s_mov_b64 exec, -1
  s_add_u32 s67, s67, 1
  s_waitcnt vmcnt(1)
  v_mfma_f32_16x16x32_bf16 v[4:7], v[0:3], v[52:55], 0
  v_bitop3_b32 v72, v52, v54, s72 bitop3:0x7e
  s_waitcnt vmcnt(0)
  v_mfma_f32_16x16x32_bf16 v[4:7], v[0:3], v[56:59], v[4:7]
  v_bitop3_b32 v73, v56, v58, s72 bitop3:0x7e
  v_bitop3_b32 v72, v72, v73, 1 bitop3:0xa8
  v_cmp_ne_u32 vcc, 0, v72
  s_cbranch_vccz Cs1_h1p
Cs1_h1s:
  s_mov_b64 exec, vcc
  buffer_load_dwordx4 v[52:55], v76, s[8:11], s60 offen offset:0 sc1
  buffer_load_dwordx4 v[56:59], v76, s[8:11], s60 offen offset:1024 sc1
  s_mov_b64 exec, -1
  s_add_u32 s67, s67, 1
  s_waitcnt vmcnt(1)
  v_mfma_f32_16x16x32_bf16 v[4:7], v[0:3], v[52:55], 0
  v_bitop3_b32 v72, v52, v54, s72 bitop3:0x7e
  s_waitcnt vmcnt(0)
  v_mfma_f32_16x16x32_bf16 v[4:7], v[0:3], v[56:59], v[4:7]
  v_bitop3_b32 v73, v56, v58, s72 bitop3:0x7e
  v_bitop3_b32 v72, v72, v73, 1 bitop3:0xa8
  v_cmp_ne_u32 vcc, 0, v72
  s_cbranch_vccz Cs1_h1p
  s_cmp_lt_u32 s67, 131072
  s_cbranch_scc1 Cs1_h1s
Cs1_h1p:
  s_nop 2
  v_add_f32_dpp v4, v4, v4 row_ror:4 row_mask:0xf bank_mask:0xf
  v_add_f32_dpp v5, v5, v5 row_ror:4 row_mask:0xf bank_mask:0xf
  s_nop 0
  v_add_f32_dpp v4, v4, v4 row_ror:8 row_mask:0xf bank_mask:0xf
  v_add_f32_dpp v5, v5, v5 row_ror:8 row_mask:0xf bank_mask:0xf
  v_cvt_pk_bf16_f32 v4, v4, v5
  buffer_store_dword v4, v69, s[8:11], s62 offen sc1
  s_xor_b32 s62, s62, 16384
  buffer_store_dword v71, v69, s[8:11], s62 offen sc1
  s_xor_b32 s72, s72, 1
  s_branch Cs1_h2
Cs1_rec:
  s_nop 7
  s_waitcnt vmcnt(0) lgkmcnt(0)
  v_max3_u32 v72, v0, v1, v2
  v_max3_u32 v72, v72, v3, v4
  v_max3_u32 v72, v72, v5, v6
  v_max3_u32 v72, v72, v7, v8
  v_max3_u32 v72, v72, v9, v10
  v_max3_u32 v72, v72, v11, v12
  v_max3_u32 v72, v72, v13, v14
  v_max3_u32 v72, v72, v15, v16
  v_max3_u32 v72, v72, v17, v18
  v_max_u32 v72, v72, v19
  v_cmp_eq_u32 vcc, -1, v72
  s_cbranch_vccz Cs1_recok
  s_barrier
  v_mov_b64 v[20:21], 0
  v_mov_b64 v[22:23], 0
  v_mov_b64 v[24:25], 0
  v_mov_b64 v[26:27], 0
  v_mov_b64 v[28:29], 0
  v_mov_b64 v[30:31], 0
  v_mov_b64 v[32:33], 0
  v_mov_b64 v[34:35], 0
  s_waitcnt lgkmcnt(0)
  s_barrier
  ds_read_b128 v[0:3], v76 offset:4608
  s_waitcnt lgkmcnt(0)
  v_smfmac_f32_16x16x64_bf16 v[20:23], v[0:3], v[80:87], v74
  v_smfmac_f32_16x16x64_bf16 v[24:27], v[0:3], v[88:95], v74
  ds_read_b128 v[60:63], v76 offset:20480
  ds_read_b128 v[64:67], v76 offset:21504
  s_waitcnt lgkmcnt(0)
  v_smfmac_f32_16x16x64_bf16 v[28:31], v[0:3], v[60:67], v74
  ds_read_b128 v[60:63], v76 offset:22528
  ds_read_b128 v[64:67], v76 offset:23552
  s_waitcnt lgkmcnt(0)
  v_smfmac_f32_16x16x64_bf16 v[32:35], v[0:3], v[60:67], v74
  ds_read_b128 v[4:7], v76 offset:5632
  s_waitcnt lgkmcnt(0)
  v_smfmac_f32_16x16x64_bf16 v[20:23], v[4:7], v[96:103], v74
  v_smfmac_f32_16x16x64_bf16 v[24:27], v[4:7], v[104:111], v74
  ds_read_b128 v[60:63], v76 offset:36864
  ds_read_b128 v[64:67], v76 offset:37888
  s_waitcnt lgkmcnt(0)
  v_smfmac_f32_16x16x64_bf16 v[28:31], v[4:7], v[60:67], v74
  ds_read_b128 v[60:63], v76 offset:38912
  ds_read_b128 v[64:67], v76 offset:39936
  s_waitcnt lgkmcnt(0)
  v_smfmac_f32_16x16x64_bf16 v[32:35], v[4:7], v[60:67], v74
  ds_read_b128 v[8:11], v76 offset:6656
  s_waitcnt lgkmcnt(0)
  v_smfmac_f32_16x16x64_bf16 v[20:23], v[8:11], v[112:119], v74
  v_smfmac_f32_16x16x64_bf16 v[24:27], v[8:11], v[120:127], v74
  v_smfmac_f32_16x16x64_bf16 v[28:31], v[8:11], v[208:215], v74
  v_smfmac_f32_16x16x64_bf16 v[32:35], v[8:11], v[216:223], v74
  ds_read_b128 v[12:15], v76 offset:7680
  s_waitcnt lgkmcnt(0)
  v_smfmac_f32_16x16x64_bf16 v[20:23], v[12:15], v[128:135], v74
  v_smfmac_f32_16x16x64_bf16 v[24:27], v[12:15], v[136:143], v74
  v_smfmac_f32_16x16x64_bf16 v[28:31], v[12:15], v[224:231], v74
  v_smfmac_f32_16x16x64_bf16 v[32:35], v[12:15], v[232:239], v74
  ds_read_b128 v[8:11], v76 offset:8704
  s_waitcnt lgkmcnt(0)
  v_smfmac_f32_16x16x64_bf16 v[20:23], v[8:11], v[144:151], v74
  v_smfmac_f32_16x16x64_bf16 v[24:27], v[8:11], v[152:159], v74
  ds_read_b128 v[60:63], v76 offset:53248
  ds_read_b128 v[64:67], v76 offset:54272
  s_waitcnt lgkmcnt(0)
  v_smfmac_f32_16x16x64_bf16 v[28:31], v[8:11], v[60:67], v74
  ds_read_b128 v[60:63], v76 offset:55296
  ds_read_b128 v[64:67], v76 offset:56320
  s_waitcnt lgkmcnt(0)
  v_smfmac_f32_16x16x64_bf16 v[32:35], v[8:11], v[60:67], v74
  ds_read_b128 v[0:3], v76 offset:9728
  s_waitcnt lgkmcnt(0)
  v_smfmac_f32_16x16x64_bf16 v[20:23], v[0:3], v[160:167], v74
  v_smfmac_f32_16x16x64_bf16 v[24:27], v[0:3], v[168:175], v74
  ds_read_b128 v[60:63], v75 offset:20480
  ds_read_b128 v[64:67], v75 offset:21504
  s_waitcnt lgkmcnt(0)
  v_smfmac_f32_16x16x64_bf16 v[28:31], v[0:3], v[60:67], v74
  ds_read_b128 v[60:63], v75 offset:22528
  ds_read_b128 v[64:67], v75 offset:23552
  s_waitcnt lgkmcnt(0)
  v_smfmac_f32_16x16x64_bf16 v[32:35], v[0:3], v[60:67], v74
  ds_read_b128 v[16:19], v76 offset:10752
  ds_read_b128 v[60:63], v75 offset:4096
  ds_read_b128 v[64:67], v75 offset:5120
  s_waitcnt lgkmcnt(0)
  v_smfmac_f32_16x16x64_bf16 v[20:23], v[16:19], v[60:67], v74
  ds_read_b128 v[60:63], v75 offset:6144
  ds_read_b128 v[64:67], v75 offset:7168
  s_waitcnt lgkmcnt(0)
  v_smfmac_f32_16x16x64_bf16 v[24:27], v[16:19], v[60:67], v74
  v_smfmac_f32_16x16x64_bf16 v[28:31], v[16:19], v[240:247], v74
  v_smfmac_f32_16x16x64_bf16 v[32:35], v[16:19], v[248:255], v74
  ds_read_b128 v[4:7], v76 offset:11776
  s_waitcnt lgkmcnt(0)
  v_smfmac_f32_16x16x64_bf16 v[20:23], v[4:7], v[176:183], v74
  v_smfmac_f32_16x16x64_bf16 v[24:27], v[4:7], v[184:191], v74
  v_smfmac_f32_16x16x64_bf16 v[28:31], v[4:7], a[0:7], v74
  v_smfmac_f32_16x16x64_bf16 v[32:35], v[4:7], a[8:15], v74
  ds_read_b128 v[12:15], v76 offset:12800
  s_waitcnt lgkmcnt(0)
  v_smfmac_f32_16x16x64_bf16 v[20:23], v[12:15], v[192:199], v74
  v_smfmac_f32_16x16x64_bf16 v[24:27], v[12:15], v[200:207], v74
  v_smfmac_f32_16x16x64_bf16 v[28:31], v[12:15], a[16:23], v74
  v_smfmac_f32_16x16x64_bf16 v[32:35], v[12:15], a[24:31], v74
  v_add_f32 v20, v20, v22
  v_add_f32 v21, v21, v23
  v_add_f32 v24, v24, v26
  v_cvt_pk_bf16_f32 v22, v20, v24
  ds_write_b32 v79, v22 offset:0
  v_add_f32 v25, v25, v27
  v_cvt_pk_bf16_f32 v23, v21, v25
  ds_write_b32 v79, v23 offset:576
  v_add_f32 v28, v28, v30
  v_add_f32 v29, v29, v31
  s_waitcnt lgkmcnt(0)
  s_nop 1
  s_branch Cs1_recok
Cs1_mx:
  s_waitcnt lgkmcnt(0)
  s_barrier
  buffer_load_dwordx4 v[52:55], v76, s[8:11], s59 offen offset:0 sc1
  buffer_load_dwordx4 v[0:3], v76, s[8:11], s58 offen offset:0 sc1
  ds_read_b128 v[20:23], v77 offset:0
  ds_read_b128 v[28:31], v77 offset:256
  buffer_load_dwordx4 v[56:59], v76, s[8:11], s59 offen offset:1024 sc1
  buffer_load_dwordx4 v[4:7], v76, s[8:11], s58 offen offset:1024 sc1
  ds_read_b128 v[24:27], v77 offset:128
  ds_read_b128 v[32:35], v77 offset:384
  s_waitcnt vmcnt(2) lgkmcnt(3)
  v_mfma_f32_16x16x32_bf16 v[8:11], v[0:3], v[20:23], 0
  s_waitcnt vmcnt(0) lgkmcnt(1)
  v_mfma_f32_16x16x32_bf16 v[8:11], v[4:7], v[24:27], v[8:11]
  v_mfma_f32_16x16x32_bf16 v[12:15], v[28:31], v[20:23], 0
  s_waitcnt lgkmcnt(0)
  v_mfma_f32_16x16x32_bf16 v[12:15], v[32:35], v[24:27], v[12:15]
  v_add_f32_dpp v8, v10, v8 quad_perm:[2,3,0,1] row_mask:0xf bank_mask:0xf
  v_add_f32_dpp v9, v11, v9 quad_perm:[2,3,0,1] row_mask:0xf bank_mask:0xf
  s_nop 0
  v_mov_b32_dpp v8, v8 quad_perm:[0,1,0,1] row_mask:0xf bank_mask:0xf
  v_mov_b32_dpp v9, v9 quad_perm:[0,1,0,1] row_mask:0xf bank_mask:0xf
  s_nop 1
  v_add_f32_dpp v12, v14, v12 quad_perm:[2,3,0,1] row_mask:0xf bank_mask:0xf
  v_add_f32_dpp v13, v15, v13 quad_perm:[2,3,0,1] row_mask:0xf bank_mask:0xf
  s_nop 0
  v_mov_b32_dpp v12, v12 quad_perm:[0,1,0,1] row_mask:0xf bank_mask:0xf
  v_mov_b32_dpp v13, v13 quad_perm:[0,1,0,1] row_mask:0xf bank_mask:0xf
  v_mul_f32 v12, s69, v12
  ds_write_b32 v78, v8 offset:8708
  v_mul_f32 v13, s69, v13
  ds_write_b32 v78, v9 offset:8772
  s_waitcnt lgkmcnt(0)
  s_barrier
  ds_read_b128 v[36:39], v78 offset:8704
  ds_read_b128 v[40:43], v78 offset:8768
  s_waitcnt lgkmcnt(0)
  s_barrier
  v_max_f32 v16, v36, v37
  v_max3_f32 v16, v16, v38, v39
  v_max3_f32 v16, v16, v40, v41
  v_max3_f32 v16, v16, v42, v43
  v_max3_f32 v16, v16, v12, v13
  v_mov_b32 v17, v16
  s_nop 1
  v_permlane16_swap_b32 v16, v17
  v_max_f32 v16, v16, v17
  v_mov_b32 v17, v16
  s_nop 1
  v_permlane32_swap_b32 v16, v17
  v_max_f32 v16, v16, v17
  v_sub_f32 v36, v36, v16
  v_sub_f32 v37, v37, v16
  v_sub_f32 v38, v38, v16
  v_sub_f32 v39, v39, v16
  v_sub_f32 v40, v40, v16
  v_sub_f32 v41, v41, v16
  v_sub_f32 v42, v42, v16
  v_sub_f32 v43, v43, v16
  v_sub_f32 v12, v12, v16
  v_sub_f32 v13, v13, v16
  v_exp_f32 v36, v36
  v_exp_f32 v37, v37
  v_exp_f32 v38, v38
  v_exp_f32 v39, v39
  v_exp_f32 v40, v40
  v_exp_f32 v41, v41
  v_exp_f32 v42, v42
  v_exp_f32 v43, v43
  v_exp_f32 v12, v12
  v_exp_f32 v13, v13
  v_cvt_pk_bf16_f32 v32, v36, v40
  v_cvt_pk_bf16_f32 v33, v37, v41
  v_cvt_pk_bf16_f32 v34, v38, v42
  v_cvt_pk_bf16_f32 v35, v39, v43
  v_cvt_pk_bf16_f32 v28, v12, v13
  v_cvt_pk_bf16_f32 v31, v12, v13
  v_mov_b32 v29, 0
  v_mov_b32 v30, 0
  v_mfma_f32_16x16x32_bf16 v[8:11], v[32:35], v[68:71], 0
  v_mfma_f32_16x16x32_bf16 v[0:3], v[32:35], v[52:55], 0
  v_mfma_f32_16x16x32_bf16 v[4:7], v[32:35], v[56:59], 0
  v_mfma_f32_16x16x16_bf16 v[8:11], v[28:29], v[68:69], v[8:11]
  v_mfma_f32_16x16x16_bf16 v[0:3], v[28:29], v[72:73], v[0:3]
  v_mfma_f32_16x16x16_bf16 v[4:7], v[30:31], v[72:73], v[4:7]
  ds_read_b128 v[52:55], v75 offset:36864
  v_rcp_f32 v10, v8
  v_rcp_f32 v11, v9
  v_mul_f32 v0, v10, v0
  v_mul_f32 v1, v11, v1
  v_max3_f32 v8, v8, v9, v10
  v_mul_f32 v4, v10, v4
  v_mul_f32 v5, v11, v5
  v_cvt_pk_bf16_f32 v2, v0, v4
  ds_write_b32 v79, v2 offset:8704
  v_cvt_pk_bf16_f32 v3, v1, v5
  ds_write_b32 v79, v3 offset:9280
  ds_read_b128 v[12:15], v78 offset:8768
  ds_read_b128 v[56:59], v75 offset:37888
  v_mov_b64 v[16:17], 0
  v_mov_b64 v[18:19], 0
  v_mov_b64 v[20:21], 0
  v_mov_b64 v[22:23], 0
  v_mov_b64 v[24:25], 0
  v_mov_b64 v[26:27], 0
  s_branch Cs1_mxok
Cs1_last:
  ds_read_b128 v[4:7], v76 offset:5632
  ds_read_b128 v[12:15], v76 offset:7680
  ds_read_b128 v[44:47], v76 offset:36864
  ds_read_b128 v[48:51], v76 offset:37888
  s_nop 5
  v_mov_b64 v[20:21], 0
  v_mov_b64 v[22:23], 0
  v_mov_b64 v[24:25], 0
  v_mov_b64 v[26:27], 0
  s_waitcnt lgkmcnt(4)
  v_smfmac_f32_16x16x64_bf16 v[28:31], v[0:3], v[36:43], v74
  ds_read_b128 v[36:39], v76 offset:38912
  ds_read_b128 v[40:43], v76 offset:39936
  v_smfmac_f32_16x16x64_bf16 v[32:35], v[0:3], v[60:67], v74
  s_waitcnt lgkmcnt(5)
  v_smfmac_f32_16x16x64_bf16 v[20:23], v[0:3], a[32:39], v74
  ds_read_b128 v[60:63], v76 offset:53248
  ds_read_b128 v[64:67], v76 offset:54272
  v_smfmac_f32_16x16x64_bf16 v[24:27], v[0:3], a[40:47], v74
  s_waitcnt lgkmcnt(4)
  v_smfmac_f32_16x16x64_bf16 v[20:23], v[4:7], a[48:55], v74
  buffer_store_dwordx4 v[16:19], v76, s[8:11], s68 offen sc1
  v_smfmac_f32_16x16x64_bf16 v[24:27], v[4:7], a[56:63], v74
  v_smfmac_f32_16x16x64_bf16 v[28:31], v[4:7], v[44:51], v74
  s_waitcnt lgkmcnt(2)
  v_smfmac_f32_16x16x64_bf16 v[20:23], v[8:11], a[64:71], v74
  ds_read_b128 v[44:47], v76 offset:55296
  ds_read_b128 v[48:51], v76 offset:56320
  v_smfmac_f32_16x16x64_bf16 v[24:27], v[8:11], a[72:79], v74
  v_smfmac_f32_16x16x64_bf16 v[32:35], v[4:7], v[36:43], v74
  v_smfmac_f32_16x16x64_bf16 v[28:31], v[8:11], v[208:215], v74
  ds_read_b128 v[36:39], v75 offset:20480
  ds_read_b128 v[40:43], v75 offset:21504
  v_smfmac_f32_16x16x64_bf16 v[32:35], v[8:11], v[216:223], v74
  v_smfmac_f32_16x16x64_bf16 v[20:23], v[12:15], a[80:87], v74
  v_smfmac_f32_16x16x64_bf16 v[24:27], v[12:15], a[88:95], v74
  v_smfmac_f32_16x16x64_bf16 v[28:31], v[12:15], v[224:231], v74
  v_smfmac_f32_16x16x64_bf16 v[32:35], v[12:15], v[232:239], v74
  s_waitcnt vmcnt(1)
  s_barrier
Cs1_lastr:
  ds_read_b128 v[8:11], v76 offset:8704
  ds_read_b128 v[0:3], v76 offset:9728
  ds_read_b128 v[16:19], v76 offset:10752
  ds_read_b128 v[4:7], v76 offset:11776
  ds_read_b128 v[12:15], v76 offset:12800
  s_waitcnt lgkmcnt(3)
  v_max3_u32 v72, v0, v1, v2
  s_waitcnt lgkmcnt(1)
  v_max3_u32 v72, v72, v3, v4
  v_max3_u32 v72, v72, v5, v6
  v_max3_u32 v72, v72, v7, v8
  v_max3_u32 v72, v72, v9, v10
  s_waitcnt lgkmcnt(0)
  v_max3_u32 v72, v72, v11, v12
  v_max3_u32 v72, v72, v13, v14
  v_max3_u32 v72, v72, v15, v16
  v_max3_u32 v72, v72, v17, v18
  v_max_u32 v72, v72, v19
  v_cmp_eq_u32 vcc, -1, v72
  s_cbranch_vccnz Cs1_lastp
Cs1_lastg:
  v_smfmac_f32_16x16x64_bf16 v[28:31], v[8:11], v[60:67], v74
  ds_read_b128 v[60:63], v75 offset:22528
  ds_read_b128 v[64:67], v75 offset:23552
  v_smfmac_f32_16x16x64_bf16 v[32:35], v[8:11], v[44:51], v74
  v_smfmac_f32_16x16x64_bf16 v[28:31], v[0:3], v[36:43], v74
  v_smfmac_f32_16x16x64_bf16 v[28:31], v[16:19], v[240:247], v74
  v_smfmac_f32_16x16x64_bf16 v[28:31], v[4:7], a[0:7], v74
  v_smfmac_f32_16x16x64_bf16 v[28:31], v[12:15], a[16:23], v74
  v_smfmac_f32_16x16x64_bf16 v[32:35], v[16:19], v[248:255], v74
  v_smfmac_f32_16x16x64_bf16 v[32:35], v[4:7], a[8:15], v74
  s_waitcnt lgkmcnt(0)
  v_smfmac_f32_16x16x64_bf16 v[32:35], v[12:15], a[24:31], v74
  v_smfmac_f32_16x16x64_bf16 v[32:35], v[0:3], v[60:67], v74
  v_smfmac_f32_16x16x64_bf16 v[20:23], v[8:11], a[96:103], v74
  v_smfmac_f32_16x16x64_bf16 v[20:23], v[0:3], a[112:119], v74
  v_add_f32 v28, v28, v30
  v_add_f32 v32, v32, v34
  v_cvt_pk_bf16_f32 v30, v28, v32
  v_smfmac_f32_16x16x64_bf16 v[20:23], v[16:19], a[128:135], v74
  ds_write_b32 v79, v30 offset:256
  v_add_f32 v29, v29, v31
  v_add_f32 v33, v33, v35
  v_cvt_pk_bf16_f32 v31, v29, v33
  v_smfmac_f32_16x16x64_bf16 v[20:23], v[4:7], a[144:151], v74
  ds_write_b32 v79, v31 offset:832
  v_smfmac_f32_16x16x64_bf16 v[20:23], v[12:15], a[160:167], v74
  v_smfmac_f32_16x16x64_bf16 v[24:27], v[8:11], a[104:111], v74
  v_smfmac_f32_16x16x64_bf16 v[24:27], v[0:3], a[120:127], v74
  v_smfmac_f32_16x16x64_bf16 v[24:27], v[16:19], a[136:143], v74
  s_waitcnt lgkmcnt(0)
  s_barrier
  ds_read_b64 v[52:53], v77 offset:264
  v_add_f32 v20, v20, v22
  v_smfmac_f32_16x16x64_bf16 v[24:27], v[4:7], a[152:159], v74
  v_add_f32 v21, v21, v23
  v_smfmac_f32_16x16x64_bf16 v[24:27], v[12:15], a[168:175], v74
  v_cvt_pk_bf16_f32 v54, v20, v21
  s_add_u32 s68, s68, 655360
  s_nop 3
  v_add_f32 v24, v24, v26
  v_add_f32 v25, v25, v27
  v_cvt_pk_bf16_f32 v55, v24, v25
  s_waitcnt lgkmcnt(0)
  buffer_store_dwordx4 v[52:55], v76, s[8:11], s68 offen sc1
  s_branch Cs1_done
Cs1_lastp:
  s_add_u32 s72, s72, 2
  s_cmp_ge_u32 s72, 131072
  s_cbranch_scc1 Cs1_lastg
  s_barrier
  buffer_load_dwordx4 v76, s[8:11], s85 offen offset:0 sc1 lds
  s_waitcnt vmcnt(0)
  s_barrier
  s_branch Cs1_lastr
Cs1_done:
  s_branch L_cexit
L_w6:
  v_mov_b64 v[20:21], 0
  v_mov_b64 v[22:23], 0
  v_mov_b64 v[24:25], 0
  v_mov_b64 v[26:27], 0
  v_mov_b64 v[28:29], 0
  v_mov_b64 v[30:31], 0
  v_mov_b64 v[32:33], 0
  v_mov_b64 v[34:35], 0
  s_mov_b32 s78, 0x3f803f80
  s_mov_b32 s79, s78
  s_mov_b32 s65, 360448
  s_mov_b32 m0, 15872
  s_lshl_b32 s71, s53, 2
  s_add_u32 s71, s71, 128
  s_movk_i32 s56, 0x1000
  v_lshlrev_b32 v73, 2, v76
  v_mov_b32 v72, 0
  s_mov_b64 s[16:17], s[8:9]
  s_mov_b32 s18, 268435456
  s_mov_b32 s19, 0x20000
  s_getpc_b64 s[20:21]
Cs2_pc:
  s_add_u32 s20, s20, (Cs2_last - Cs2_pc)
  s_addc_u32 s21, s21, 0
  v_mov_b32 v68, 14880
  buffer_load_dwordx4 v[52:55], v76, s[8:11], s59 offen offset:0 sc1
  buffer_load_dwordx4 v[56:59], v76, s[8:11], s59 offen offset:1024 sc1
  ds_read_b128 v[36:39], v76 offset:24576
  ds_read_b128 v[40:43], v76 offset:25600
  ds_read_b128 v[60:63], v76 offset:26624
  ds_read_b128 v[64:67], v76 offset:27648
  ds_read_b128 v[0:3], v76 offset:4608
  ds_read_b128 v[4:7], v76 offset:5632
  ds_read_b128 v[8:11], v76 offset:6656
  ds_read_b128 v[12:15], v76 offset:7680
  s_waitcnt lgkmcnt(0)
  s_cmp_eq_u32 s66, 1
  s_branch Cs2_top2
.p2align 6
Cs2_h2:
  ds_read_b128 v[36:39], v76 offset:24576
  s_cmp_eq_u32 s66, 62
  s_cselect_b64 s[16:17], s[20:21], s[16:17]
  s_cselect_b32 s18, (Cs2_done - Cs2_last), s18
  s_cselect_b32 s70, 0, s70
  s_cmp_eq_u32 s66, 63
  s_cselect_b32 s59, 268435456, s59
  s_cselect_b32 s58, 268435456, s58
  ds_read_b128 v[40:43], v76 offset:25600
  v_mov_b64 v[20:21], 0
  v_mov_b64 v[22:23], 0
  v_mov_b64 v[24:25], 0
  v_mov_b64 v[26:27], 0
  v_mov_b32 v68, 14880
  v_lshlrev_b32 v73, 2, v76
  buffer_load_dwordx4 v[52:55], v76, s[8:11], s59 offen offset:0 sc1
  buffer_load_dwordx4 v[56:59], v76, s[8:11], s59 offen offset:1024 sc1
  s_waitcnt vmcnt(0)
  s_mov_b64 vcc, -1
Cs2_h2r:
  s_mov_b64 exec, vcc
  buffer_load_dwordx4 v[12:15], v76, s[8:11], s65 offen offset:3072 sc1
  buffer_load_dwordx4 v[0:3], v76, s[8:11], s85 offen offset:0 sc1
  s_mov_b64 exec, -1
  s_add_u32 s67, s67, 1
  s_cmp_lt_u32 s67, 131072
  s_cselect_b32 s54, -2, -1
  s_waitcnt vmcnt(1)
  v_max3_u32 v72, v12, v13, v14
  s_waitcnt vmcnt(0)
  v_max3_u32 v72, v72, v15, v0
  v_max3_u32 v72, v72, v1, v2
  v_max_u32 v72, v72, v3
  v_cmp_lt_u32 vcc, s54, v72
  s_cbranch_vccnz Cs2_h2r
  ds_write_b128 v76, v[12:15] offset:7680
  ds_write_b128 v76, v[0:3] offset:12800
Cs2_h2w:
  s_cmp_eq_u32 s66, 63
  s_waitcnt lgkmcnt(0)
  s_barrier
  ds_read_b128 v[0:3], v76 offset:4608
Cs2_top2:
  v_smfmac_f32_16x16x64_bf16 v[20:23], v[12:15], v[128:135], v74
  s_cbranch_scc1 Cs2_last
  v_smfmac_f32_16x16x64_bf16 v[24:27], v[12:15], v[136:143], v74
  buffer_load_dwordx4 v[44:47], v76, s[8:11], s58 offen offset:0 sc1
  s_mov_b32 m0, 15872
  v_smfmac_f32_16x16x64_bf16 v[28:31], v[12:15], v[224:231], v74
  buffer_load_dwordx4 v[48:51], v76, s[8:11], s58 offen offset:1024 sc1
  v_smfmac_f32_16x16x64_bf16 v[32:35], v[12:15], v[232:239], v74
  ds_read_b128 v[4:7], v76 offset:5632
  s_waitcnt lgkmcnt(1)
  v_smfmac_f32_16x16x64_bf16 v[20:23], v[0:3], v[80:87], v74
  ds_read_b128 v[8:11], v76 offset:6656
  v_smfmac_f32_16x16x64_bf16 v[28:31], v[0:3], v[36:43], v74
  ds_read_b128 v[36:39], v76 offset:40960
  v_smfmac_f32_16x16x64_bf16 v[24:27], v[0:3], v[88:95], v74
  buffer_store_dwordx4 v[16:19], v76, s[8:11], s68 offen sc1
  ds_read_b128 v[40:43], v76 offset:41984
  v_smfmac_f32_16x16x64_bf16 v[32:35], v[0:3], v[60:67], v74
  buffer_load_dword v73, s[16:19], s70 offen lds
  ds_read_b128 v[60:63], v76 offset:43008
  s_waitcnt lgkmcnt(4)
  v_smfmac_f32_16x16x64_bf16 v[20:23], v[4:7], v[96:103], v74
  ds_read_b128 v[64:67], v76 offset:44032
  v_smfmac_f32_16x16x64_bf16 v[24:27], v[4:7], v[104:111], v74
  s_waitcnt vmcnt(4)
  s_waitcnt lgkmcnt(4)
  v_smfmac_f32_16x16x64_bf16 v[20:23], v[8:11], v[112:119], v74
  s_barrier
  ds_read_b128 v[12:15], v76 offset:8704
  s_waitcnt lgkmcnt(3)
  v_smfmac_f32_16x16x64_bf16 v[28:31], v[4:7], v[36:43], v74
  ds_read_b128 v[36:39], v76 offset:57344
  v_smfmac_f32_16x16x64_bf16 v[24:27], v[8:11], v[120:127], v74
  ds_read_b128 v[40:43], v76 offset:58368
  s_waitcnt lgkmcnt(3)
  v_smfmac_f32_16x16x64_bf16 v[32:35], v[4:7], v[60:67], v74
  ds_read_b128 v[0:3], v76 offset:9728
  v_smfmac_f32_16x16x64_bf16 v[28:31], v[8:11], v[208:215], v74
  ds_read_b128 v[60:63], v76 offset:59392
  v_smfmac_f32_16x16x64_bf16 v[32:35], v[8:11], v[216:223], v74
  ds_read_b128 v[64:67], v76 offset:60416
  s_waitcnt lgkmcnt(5)
  v_smfmac_f32_16x16x64_bf16 v[20:23], v[12:15], v[144:151], v74
  s_barrier
  ds_read_b128 v[4:7], v76 offset:11776
  s_waitcnt lgkmcnt(4)
  v_smfmac_f32_16x16x64_bf16 v[28:31], v[12:15], v[36:43], v74
  ds_read_b128 v[8:11], v76 offset:12800
  ds_read_b128 v[36:39], v75 offset:8192
  v_smfmac_f32_16x16x64_bf16 v[24:27], v[12:15], v[152:159], v74
  ds_read_b128 v[16:19], v76 offset:10752
  s_waitcnt lgkmcnt(6)
  v_smfmac_f32_16x16x64_bf16 v[20:23], v[0:3], v[160:167], v74
  ds_read_b128 v[40:43], v75 offset:9216
  s_waitcnt lgkmcnt(5)
  v_smfmac_f32_16x16x64_bf16 v[32:35], v[12:15], v[60:67], v74
  ds_read_b128 v[60:63], v75 offset:10240
  v_smfmac_f32_16x16x64_bf16 v[24:27], v[0:3], v[168:175], v74
  ds_read_b128 v[64:67], v75 offset:11264
  s_waitcnt lgkmcnt(6)
  v_smfmac_f32_16x16x64_bf16 v[20:23], v[4:7], v[176:183], v74
  s_waitcnt lgkmcnt(5)
  v_smfmac_f32_16x16x64_bf16 v[20:23], v[8:11], v[192:199], v74
  s_waitcnt lgkmcnt(2)
  v_smfmac_f32_16x16x64_bf16 v[20:23], v[16:19], v[36:43], v74
  ds_read_b128 v[36:39], v75 offset:24576
  v_smfmac_f32_16x16x64_bf16 v[24:27], v[4:7], v[184:191], v74
  ds_read_b128 v[40:43], v75 offset:25600
  s_waitcnt lgkmcnt(2)
  v_smfmac_f32_16x16x64_bf16 v[24:27], v[16:19], v[60:67], v74
  ds_read_b128 v[60:63], v75 offset:26624
  v_add_f32 v20, v20, v22
  v_smfmac_f32_16x16x64_bf16 v[24:27], v[8:11], v[200:207], v74
  ds_read_b128 v[64:67], v75 offset:27648
  v_add_f32 v21, v21, v23
  v_smfmac_f32_16x16x64_bf16 v[28:31], v[16:19], v[240:247], v74
  v_mov_b64 v[70:71], s[78:79]
  v_smfmac_f32_16x16x64_bf16 v[28:31], v[4:7], a[0:7], v74
  s_waitcnt lgkmcnt(2)
  v_add_f32 v24, v24, v26
  v_smfmac_f32_16x16x64_bf16 v[28:31], v[0:3], v[36:43], v74
  ds_read_b128 v[36:39], v68
  v_cvt_pk_bf16_f32 v22, v20, v24
  v_smfmac_f32_16x16x64_bf16 v[28:31], v[8:11], a[16:23], v74
  ds_read_b128 v[40:43], v68
  ds_write_b32 v79, v22 offset:0
  s_waitcnt lgkmcnt(3)
  v_add_f32 v25, v25, v27
  v_cvt_pk_bf16_f32 v23, v21, v25
  v_smfmac_f32_16x16x64_bf16 v[32:35], v[0:3], v[60:67], v74
  ds_write_b32 v79, v23 offset:576
  v_cmp_u_f32 vcc, v20, v21
  v_smfmac_f32_16x16x64_bf16 v[32:35], v[16:19], v[248:255], v74
  v_add_f32 v28, v28, v30
  v_smfmac_f32_16x16x64_bf16 v[32:35], v[4:7], a[8:15], v74
  v_add_f32 v29, v29, v31
  v_smfmac_f32_16x16x64_bf16 v[32:35], v[8:11], a[24:31], v74
  s_cbranch_vccnz Cs2_rec
Cs2_recok:
  s_waitcnt lgkmcnt(3)
  v_smfmac_f32_16x16x64_bf16 v[36:39], v[16:19], a[128:135], v74
  s_waitcnt lgkmcnt(0)
  s_barrier
  ds_read_b128 v[60:63], v77
  v_smfmac_f32_16x16x64_bf16 v[40:43], v[16:19], a[136:143], v74
  ds_read_b128 v[64:67], v77 offset:128
  v_add_f32 v32, v32, v34
  v_cvt_pk_bf16_f32 v30, v28, v32
  v_smfmac_f32_16x16x64_bf16 v[36:39], v[0:3], a[112:119], v74
  ds_write_b32 v79, v30 offset:256
  v_add_f32 v33, v33, v35
  v_cvt_pk_bf16_f32 v31, v29, v33
  v_smfmac_f32_16x16x64_bf16 v[40:43], v[0:3], a[120:127], v74
  ds_write_b32 v79, v31 offset:832
  v_xor_b32 v75, 0x8000, v75
  v_smfmac_f32_16x16x64_bf16 v[36:39], v[4:7], a[144:151], v74
  ds_read_b128 v[0:3], v76 offset:4608
  v_mov_b32 v29, 0
  v_smfmac_f32_16x16x64_bf16 v[40:43], v[4:7], a[152:159], v74
  s_waitcnt vmcnt(2) lgkmcnt(3)
  v_mov_b32 v30, 0
  v_mfma_f32_16x16x32_bf16 v[44:47], v[44:47], v[60:63], 0
  ds_read_b128 v[4:7], v76 offset:5632
  s_waitcnt lgkmcnt(2)
  v_mfma_f32_16x16x32_bf16 v[44:47], v[48:51], v[64:67], v[44:47]
  s_barrier
  v_smfmac_f32_16x16x64_bf16 v[36:39], v[8:11], a[160:167], v74
  ds_read_b128 v[20:23], v77 offset:256
  ds_read_b128 v[24:27], v77 offset:384
  v_smfmac_f32_16x16x64_bf16 v[40:43], v[8:11], a[168:175], v74
  ds_read_b128 v[8:11], v76 offset:6656
  v_add_f32_dpp v72, v46, v44 quad_perm:[2,3,0,1] row_mask:0xf bank_mask:0xf
  v_add_f32_dpp v73, v47, v45 quad_perm:[2,3,0,1] row_mask:0xf bank_mask:0xf
  v_smfmac_f32_16x16x64_bf16 v[36:39], v[12:15], a[96:103], v74
  s_waitcnt lgkmcnt(4)
  v_exp_f32_dpp v72, v72 quad_perm:[0,1,0,1] row_mask:0xf bank_mask:0xf
  v_smfmac_f32_16x16x64_bf16 v[40:43], v[12:15], a[104:111], v74
  ds_read_b128 v[12:15], v76 offset:7680
  v_exp_f32_dpp v73, v73 quad_perm:[0,1,0,1] row_mask:0xf bank_mask:0xf
  v_smfmac_f32_16x16x64_bf16 v[36:39], v[0:3], a[32:39], v74
  s_waitcnt lgkmcnt(2)
  v_cvt_pk_bf16_f32 v72, v72, v73
  v_mfma_f32_16x16x32_bf16 v[20:23], v[20:23], v[60:63], 0
  ds_write_b32 v78, v72 offset:520
  v_mov_b64 v[16:17], 0
  v_mfma_f32_16x16x32_bf16 v[20:23], v[24:27], v[64:67], v[20:23]
  ds_read_b128 v[44:47], v75 offset:40960
  v_mov_b64 v[18:19], 0
  v_smfmac_f32_16x16x64_bf16 v[40:43], v[0:3], a[40:47], v74
  ds_read_b128 v[48:51], v75 offset:41984
  v_mov_b64 v[68:69], s[78:79]
  v_smfmac_f32_16x16x64_bf16 v[36:39], v[4:7], a[48:55], v74
  s_waitcnt lgkmcnt(4)
  v_add_f32_dpp v24, v22, v20 quad_perm:[2,3,0,1] row_mask:0xf bank_mask:0xf
  v_add_f32_dpp v25, v23, v21 quad_perm:[2,3,0,1] row_mask:0xf bank_mask:0xf
  v_smfmac_f32_16x16x64_bf16 v[36:39], v[8:11], a[64:71], v74
  s_waitcnt lgkmcnt(2)
  s_barrier
  ds_read_b128 v[32:35], v78 offset:512
  v_smfmac_f32_16x16x64_bf16 v[36:39], v[12:15], a[80:87], v74
  ds_read_b128 v[60:63], v75 offset:24576
  v_mul_f32 v24, s69, v24
  v_smfmac_f32_16x16x64_bf16 v[40:43], v[4:7], a[56:63], v74
  ds_read_b128 v[64:67], v75 offset:25600
  v_mul_f32 v25, s69, v25
  v_smfmac_f32_16x16x64_bf16 v[40:43], v[8:11], a[72:79], v74
  v_exp_f32_dpp v24, v24 quad_perm:[0,1,0,1] row_mask:0xf bank_mask:0xf
  v_smfmac_f32_16x16x64_bf16 v[40:43], v[12:15], a[88:95], v74
  s_waitcnt lgkmcnt(2)
  v_exp_f32_dpp v25, v25 quad_perm:[0,1,0,1] row_mask:0xf bank_mask:0xf
  v_mfma_f32_16x16x32_bf16 v[8:11], v[32:35], v[68:71], 0
  v_add_f32 v36, v36, v38
  v_add_f32 v37, v37, v39
  v_mfma_f32_16x16x32_bf16 v[0:3], v[32:35], v[52:55], 0
  v_add_f32 v40, v40, v42
  v_add_f32 v41, v41, v43
  v_mfma_f32_16x16x32_bf16 v[4:7], v[32:35], v[56:59], 0
  v_cvt_pk_bf16_f32 v28, v24, v25
  v_cvt_pk_bf16_f32 v72, v36, v37
  v_cvt_pk_bf16_f32 v73, v40, v41
  v_mfma_f32_16x16x16_bf16 v[8:11], v[28:29], v[68:69], v[8:11]
  v_cvt_pk_bf16_f32 v31, v24, v25
  v_mov_b64 v[20:21], 0
  v_mfma_f32_16x16x16_bf16 v[0:3], v[28:29], v[72:73], v[0:3]
  ds_read_b128 v[52:55], v75 offset:26624
  v_mov_b64 v[22:23], 0
  v_mfma_f32_16x16x16_bf16 v[4:7], v[30:31], v[72:73], v[4:7]
  v_rcp_f32 v10, v8
  v_rcp_f32 v11, v9
  v_mul_f32 v0, v10, v0
  v_mul_f32 v1, v11, v1
  v_max3_f32 v8, v8, v9, v10
  v_mul_f32 v4, v10, v4
  v_mul_f32 v5, v11, v5
  v_cvt_pk_bf16_f32 v2, v0, v4
  ds_write_b32 v79, v2 offset:8704
  v_cvt_pk_bf16_f32 v3, v1, v5
  ds_write_b32 v79, v3 offset:9280
  ds_read_b128 v[12:15], v78 offset:8832
  v_max_f32 v8, v8, v11
  v_cmp_le_f32 vcc, 1317011456, v8
  v_mov_b64 v[24:25], 0
  v_mov_b64 v[26:27], 0
  ds_read_b128 v[56:59], v75 offset:27648
  s_cbranch_vccnz Cs2_mx
Cs2_mxok:
  s_waitcnt lgkmcnt(2)
  s_barrier
  ds_read_b128 v[0:3], v78 offset:8896
  s_waitcnt lgkmcnt(2)
  v_smfmac_f32_16x16x64_bf16 v[16:19], v[12:15], a[176:183], v74
  ds_read_b128 v[4:7], v78 offset:8704
  v_smfmac_f32_16x16x64_bf16 v[20:23], v[12:15], v[44:51], v74
  ds_read_b128 v[8:11], v78 offset:8768
  v_smfmac_f32_16x16x64_bf16 v[24:27], v[12:15], a[224:231], v74
  ds_read_b128 v[36:39], v75 offset:43008
  s_waitcnt lgkmcnt(3)
  v_smfmac_f32_16x16x64_bf16 v[16:19], v[0:3], a[184:191], v74
  ds_read_b128 v[40:43], v75 offset:44032
  s_waitcnt lgkmcnt(3)
  v_smfmac_f32_16x16x64_bf16 v[16:19], v[4:7], v[60:67], v74
  ds_read_b128 v[68:71], v76 offset:13824
  s_waitcnt lgkmcnt(3)
  v_smfmac_f32_16x16x64_bf16 v[16:19], v[8:11], v[52:59], v74
  ds_read_b128 v[44:47], v75 offset:57344
  v_smfmac_f32_16x16x64_bf16 v[20:23], v[4:7], a[192:199], v74
  ds_read_b128 v[48:51], v75 offset:58368
  v_smfmac_f32_16x16x64_bf16 v[20:23], v[8:11], a[200:207], v74
  ds_read_b128 v[60:63], v75 offset:59392
  s_waitcnt lgkmcnt(4)
  v_cvt_pk_bf16_f32 v16, v16, v17
  v_cvt_pk_bf16_f32 v17, v18, v19
  v_bfi_b32 v16, 1, s72, v16
  v_smfmac_f32_16x16x64_bf16 v[20:23], v[0:3], v[36:43], v74
  s_waitcnt lgkmcnt(3)
  buffer_store_dwordx2 v[16:17], v68, s[8:11], s73 offen sc1
  v_mov_b64 v[32:33], 0
  v_smfmac_f32_16x16x64_bf16 v[24:27], v[4:7], a[208:215], v74
  ds_read_b128 v[64:67], v75 offset:60416
  v_mov_b64 v[34:35], 0
  v_smfmac_f32_16x16x64_bf16 v[24:27], v[8:11], a[216:223], v74
  ds_read_b128 v[52:55], v75 offset:0
  v_cvt_pk_bf16_f32 v20, v20, v21
  v_cvt_pk_bf16_f32 v21, v22, v23
  v_bfi_b32 v20, 1, s72, v20
  v_smfmac_f32_16x16x64_bf16 v[24:27], v[0:3], a[232:239], v74
  ds_read_b128 v[56:59], v75 offset:1024
  buffer_store_dwordx2 v[20:21], v68, s[8:11], s74 offen sc1
  s_waitcnt lgkmcnt(4)
  v_mov_b64 v[28:29], 0
  v_smfmac_f32_16x16x64_bf16 v[32:35], v[4:7], v[44:51], v74
  ds_read_b128 v[36:39], v75 offset:2048
  ds_read_b128 v[40:43], v75 offset:3072
  s_waitcnt lgkmcnt(4)
  v_smfmac_f32_16x16x64_bf16 v[32:35], v[8:11], v[60:67], v74
  ds_read_b128 v[44:47], v75 offset:4096
  v_cvt_pk_bf16_f32 v24, v24, v25
  v_cvt_pk_bf16_f32 v25, v26, v27
  v_bfi_b32 v24, 1, s72, v24
  v_smfmac_f32_16x16x64_bf16 v[32:35], v[12:15], a[240:247], v74
  ds_read_b128 v[48:51], v75 offset:5120
  buffer_store_dwordx2 v[24:25], v68, s[8:11], s75 offen sc1
  v_mov_b64 v[30:31], 0
  v_smfmac_f32_16x16x64_bf16 v[32:35], v[0:3], a[248:255], v74
  ds_read_b128 v[60:63], v75 offset:6144
  ds_read_b128 v[64:67], v75 offset:7168
  s_waitcnt lgkmcnt(6)
  v_smfmac_f32_16x16x64_bf16 v[28:31], v[4:7], v[52:59], v74
  s_waitcnt lgkmcnt(4)
  v_smfmac_f32_16x16x64_bf16 v[28:31], v[8:11], v[36:43], v74
  s_waitcnt lgkmcnt(2)
  v_cvt_pk_bf16_f32 v32, v32, v33
  v_cvt_pk_bf16_f32 v33, v34, v35
  v_bfi_b32 v32, 1, s72, v32
  v_smfmac_f32_16x16x64_bf16 v[28:31], v[12:15], v[44:51], v74
  buffer_store_dwordx2 v[32:33], v68, s[8:11], s76 offen sc1
  s_waitcnt lgkmcnt(0)
  v_smfmac_f32_16x16x64_bf16 v[28:31], v[0:3], v[60:67], v74
  v_mov_b64 v[18:19], v[72:73]
  s_nop 4
  v_cvt_pk_bf16_f32 v28, v28, v29
  v_cvt_pk_bf16_f32 v29, v30, v31
  v_bfi_b32 v28, 1, s72, v28
  buffer_store_dwordx2 v[28:29], v68, s[8:11], s77 offen sc1
  ds_read_b128 v[0:3], v76 offset:14848
  s_waitcnt lgkmcnt(0)
  ds_read_b64 v[16:17], v77 offset:384
  s_waitcnt lgkmcnt(0)
  ds_read_b128 v[64:67], v76 offset:27648
  s_waitcnt lgkmcnt(0)
  ds_read_b128 v[60:63], v76 offset:26624
  s_waitcnt lgkmcnt(0)
  v_xor_b32 v75, 0x8000, v75
  v_mov_b64 v[28:29], 0
  v_mov_b64 v[30:31], 0
  v_mov_b64 v[32:33], 0
  v_mov_b64 v[34:35], 0
  s_waitcnt vmcnt(0)
  buffer_load_dwordx4 v[52:55], v76, s[8:11], s60 offen offset:0 sc1
  buffer_load_dwordx4 v[56:59], v76, s[8:11], s60 offen offset:1024 sc1
  s_add_u32 s66, s66, 1
  s_xor_b32 s64, s64, 16384
  s_xor_b32 s65, s65, 16384
  s_add_u32 s58, s58, 655360
  s_add_u32 s59, s59, 655360
  s_add_u32 s70, s70, 655360
  s_add_u32 s68, s68, 655360
  s_mov_b32 m0, 12800
  s_add_u32 s85, s65, 8192
  s_waitcnt lgkmcnt(0)
  s_waitcnt vmcnt(1)
  v_mfma_f32_16x16x32_bf16 v[4:7], v[0:3], v[52:55], 0
  v_bitop3_b32 v72, v52, v54, s72 bitop3:0x7e
  s_waitcnt vmcnt(0)
  v_mfma_f32_16x16x32_bf16 v[4:7], v[0:3], v[56:59], v[4:7]
  v_bitop3_b32 v73, v56, v58, s72 bitop3:0x7e
  v_bitop3_b32 v72, v72, v73, 1 bitop3:0xa8
  v_cmp_ne_u32 vcc, 0, v72
  s_cbranch_vccnz Cs2_h1r
  s_nop 2
  v_add_f32_dpp v4, v4, v4 row_ror:4 row_mask:0xf bank_mask:0xf
  v_add_f32_dpp v5, v5, v5 row_ror:4 row_mask:0xf bank_mask:0xf
  s_nop 0
  v_add_f32_dpp v4, v4, v4 row_ror:8 row_mask:0xf bank_mask:0xf
  v_add_f32_dpp v5, v5, v5 row_ror:8 row_mask:0xf bank_mask:0xf
  v_cvt_pk_bf16_f32 v4, v4, v5
  buffer_store_dword v4, v69, s[8:11], s62 offen sc1
  s_xor_b32 s62, s62, 16384
  buffer_store_dword v71, v69, s[8:11], s62 offen sc1
  s_xor_b32 s72, s72, 1
  s_branch Cs2_h2
Cs2_h1r:
  s_mov_b64 exec, vcc
  buffer_load_dwordx4 v[52:55], v76, s[8:11], s60 offen offset:0 sc1
  buffer_load_dwordx4 v[56:59], v76, s[8:11], s60 offen offset:1024 sc1
  s_mov_b64 exec, -1
  s_add_u32 s67, s67, 1
  s_waitcnt vmcnt(1)
  v_mfma_f32_16x16x32_bf16 v[4:7], v[0:3], v[52:55], 0
  v_bitop3_b32 v72, v52, v54, s72 bitop3:0x7e
  s_waitcnt vmcnt(0)
  v_mfma_f32_16x16x32_bf16 v[4:7], v[0:3], v[56:59], v[4:7]
  v_bitop3_b32 v73, v56, v58, s72 bitop3:0x7e
  v_bitop3_b32 v72, v72, v73, 1 bitop3:0xa8
  v_cmp_ne_u32 vcc, 0, v72
  s_cbranch_vccz Cs2_h1p
Cs2_h1s:
  s_mov_b64 exec, vcc
  buffer_load_dwordx4 v[52:55], v76, s[8:11], s60 offen offset:0 sc1
  buffer_load_dwordx4 v[56:59], v76, s[8:11], s60 offen offset:1024 sc1
  s_mov_b64 exec, -1
  s_add_u32 s67, s67, 1
  s_waitcnt vmcnt(1)
  v_mfma_f32_16x16x32_bf16 v[4:7], v[0:3], v[52:55], 0
  v_bitop3_b32 v72, v52, v54, s72 bitop3:0x7e
  s_waitcnt vmcnt(0)
  v_mfma_f32_16x16x32_bf16 v[4:7], v[0:3], v[56:59], v[4:7]
  v_bitop3_b32 v73, v56, v58, s72 bitop3:0x7e
  v_bitop3_b32 v72, v72, v73, 1 bitop3:0xa8
  v_cmp_ne_u32 vcc, 0, v72
  s_cbranch_vccz Cs2_h1p
  s_cmp_lt_u32 s67, 131072
  s_cbranch_scc1 Cs2_h1s
Cs2_h1p:
  s_nop 2
  v_add_f32_dpp v4, v4, v4 row_ror:4 row_mask:0xf bank_mask:0xf
  v_add_f32_dpp v5, v5, v5 row_ror:4 row_mask:0xf bank_mask:0xf
  s_nop 0
  v_add_f32_dpp v4, v4, v4 row_ror:8 row_mask:0xf bank_mask:0xf
  v_add_f32_dpp v5, v5, v5 row_ror:8 row_mask:0xf bank_mask:0xf
  v_cvt_pk_bf16_f32 v4, v4, v5
  buffer_store_dword v4, v69, s[8:11], s62 offen sc1
  s_xor_b32 s62, s62, 16384
  buffer_store_dword v71, v69, s[8:11], s62 offen sc1
  s_xor_b32 s72, s72, 1
  s_branch Cs2_h2
Cs2_rec:
  s_nop 7
  s_waitcnt vmcnt(0) lgkmcnt(0)
  v_max3_u32 v72, v0, v1, v2
  v_max3_u32 v72, v72, v3, v4
  v_max3_u32 v72, v72, v5, v6
  v_max3_u32 v72, v72, v7, v8
  v_max3_u32 v72, v72, v9, v10
  v_max3_u32 v72, v72, v11, v12
  v_max3_u32 v72, v72, v13, v14
  v_max3_u32 v72, v72, v15, v16
  v_max3_u32 v72, v72, v17, v18
  v_max_u32 v72, v72, v19
  v_cmp_eq_u32 vcc, -1, v72
  s_cbranch_vccz Cs2_recok
  s_barrier
Cs2_recp:
  buffer_load_dwordx4 v[0:3], v76, s[8:11], s64 offen offset:0 sc1
  buffer_load_dwordx4 v[4:7], v76, s[8:11], s64 offen offset:1024 sc1
  s_add_u32 s67, s67, 1
  s_cmp_lt_u32 s67, 131072
  s_cselect_b32 s54, -2, -1
  s_waitcnt vmcnt(1)
  v_max3_u32 v72, v0, v1, v2
  s_waitcnt vmcnt(0)
  v_max3_u32 v72, v72, v3, v4
  v_max3_u32 v72, v72, v5, v6
  v_max_u32 v72, v72, v7
  v_cmp_lt_u32 vcc, s54, v72
  s_cbranch_vccnz Cs2_recp
  ds_write_b128 v76, v[0:3] offset:8704
  ds_write_b128 v76, v[4:7] offset:9728
  v_mov_b64 v[20:21], 0
  v_mov_b64 v[22:23], 0
  v_mov_b64 v[24:25], 0
  v_mov_b64 v[26:27], 0
  v_mov_b64 v[28:29], 0
  v_mov_b64 v[30:31], 0
  v_mov_b64 v[32:33], 0
  v_mov_b64 v[34:35], 0
  s_waitcnt lgkmcnt(0)
  s_barrier
  ds_read_b128 v[0:3], v76 offset:4608
  s_waitcnt lgkmcnt(0)
  v_smfmac_f32_16x16x64_bf16 v[20:23], v[0:3], v[80:87], v74
  v_smfmac_f32_16x16x64_bf16 v[24:27], v[0:3], v[88:95], v74
  ds_read_b128 v[60:63], v76 offset:24576
  ds_read_b128 v[64:67], v76 offset:25600
  s_waitcnt lgkmcnt(0)
  v_smfmac_f32_16x16x64_bf16 v[28:31], v[0:3], v[60:67], v74
  ds_read_b128 v[60:63], v76 offset:26624
  ds_read_b128 v[64:67], v76 offset:27648
  s_waitcnt lgkmcnt(0)
  v_smfmac_f32_16x16x64_bf16 v[32:35], v[0:3], v[60:67], v74
  ds_read_b128 v[4:7], v76 offset:5632
  s_waitcnt lgkmcnt(0)
  v_smfmac_f32_16x16x64_bf16 v[20:23], v[4:7], v[96:103], v74
  v_smfmac_f32_16x16x64_bf16 v[24:27], v[4:7], v[104:111], v74
  ds_read_b128 v[60:63], v76 offset:40960
  ds_read_b128 v[64:67], v76 offset:41984
  s_waitcnt lgkmcnt(0)
  v_smfmac_f32_16x16x64_bf16 v[28:31], v[4:7], v[60:67], v74
  ds_read_b128 v[60:63], v76 offset:43008
  ds_read_b128 v[64:67], v76 offset:44032
  s_waitcnt lgkmcnt(0)
  v_smfmac_f32_16x16x64_bf16 v[32:35], v[4:7], v[60:67], v74
  ds_read_b128 v[8:11], v76 offset:6656
  s_waitcnt lgkmcnt(0)
  v_smfmac_f32_16x16x64_bf16 v[20:23], v[8:11], v[112:119], v74
  v_smfmac_f32_16x16x64_bf16 v[24:27], v[8:11], v[120:127], v74
  v_smfmac_f32_16x16x64_bf16 v[28:31], v[8:11], v[208:215], v74
  v_smfmac_f32_16x16x64_bf16 v[32:35], v[8:11], v[216:223], v74
  ds_read_b128 v[12:15], v76 offset:7680
  s_waitcnt lgkmcnt(0)
  v_smfmac_f32_16x16x64_bf16 v[20:23], v[12:15], v[128:135], v74
  v_smfmac_f32_16x16x64_bf16 v[24:27], v[12:15], v[136:143], v74
  v_smfmac_f32_16x16x64_bf16 v[28:31], v[12:15], v[224:231], v74
  v_smfmac_f32_16x16x64_bf16 v[32:35], v[12:15], v[232:239], v74
  ds_read_b128 v[12:15], v76 offset:8704
  s_waitcnt lgkmcnt(0)
  v_smfmac_f32_16x16x64_bf16 v[20:23], v[12:15], v[144:151], v74
  v_smfmac_f32_16x16x64_bf16 v[24:27], v[12:15], v[152:159], v74
  ds_read_b128 v[60:63], v76 offset:57344
  ds_read_b128 v[64:67], v76 offset:58368
  s_waitcnt lgkmcnt(0)
  v_smfmac_f32_16x16x64_bf16 v[28:31], v[12:15], v[60:67], v74
  ds_read_b128 v[60:63], v76 offset:59392
  ds_read_b128 v[64:67], v76 offset:60416
  s_waitcnt lgkmcnt(0)
  v_smfmac_f32_16x16x64_bf16 v[32:35], v[12:15], v[60:67], v74
  ds_read_b128 v[0:3], v76 offset:9728
  s_waitcnt lgkmcnt(0)
  v_smfmac_f32_16x16x64_bf16 v[20:23], v[0:3], v[160:167], v74
  v_smfmac_f32_16x16x64_bf16 v[24:27], v[0:3], v[168:175], v74
  ds_read_b128 v[60:63], v75 offset:24576
  ds_read_b128 v[64:67], v75 offset:25600
  s_waitcnt lgkmcnt(0)
  v_smfmac_f32_16x16x64_bf16 v[28:31], v[0:3], v[60:67], v74
  ds_read_b128 v[60:63], v75 offset:26624
  ds_read_b128 v[64:67], v75 offset:27648
  s_waitcnt lgkmcnt(0)
  v_smfmac_f32_16x16x64_bf16 v[32:35], v[0:3], v[60:67], v74
  ds_read_b128 v[16:19], v76 offset:10752
  ds_read_b128 v[60:63], v75 offset:8192
  ds_read_b128 v[64:67], v75 offset:9216
  s_waitcnt lgkmcnt(0)
  v_smfmac_f32_16x16x64_bf16 v[20:23], v[16:19], v[60:67], v74
  ds_read_b128 v[60:63], v75 offset:10240
  ds_read_b128 v[64:67], v75 offset:11264
  s_waitcnt lgkmcnt(0)
  v_smfmac_f32_16x16x64_bf16 v[24:27], v[16:19], v[60:67], v74
  v_smfmac_f32_16x16x64_bf16 v[28:31], v[16:19], v[240:247], v74
  v_smfmac_f32_16x16x64_bf16 v[32:35], v[16:19], v[248:255], v74
  ds_read_b128 v[4:7], v76 offset:11776
  s_waitcnt lgkmcnt(0)
  v_smfmac_f32_16x16x64_bf16 v[20:23], v[4:7], v[176:183], v74
  v_smfmac_f32_16x16x64_bf16 v[24:27], v[4:7], v[184:191], v74
  v_smfmac_f32_16x16x64_bf16 v[28:31], v[4:7], a[0:7], v74
  v_smfmac_f32_16x16x64_bf16 v[32:35], v[4:7], a[8:15], v74
  ds_read_b128 v[8:11], v76 offset:12800
  s_waitcnt lgkmcnt(0)
  v_smfmac_f32_16x16x64_bf16 v[20:23], v[8:11], v[192:199], v74
  v_smfmac_f32_16x16x64_bf16 v[24:27], v[8:11], v[200:207], v74
  v_smfmac_f32_16x16x64_bf16 v[28:31], v[8:11], a[16:23], v74
  v_smfmac_f32_16x16x64_bf16 v[32:35], v[8:11], a[24:31], v74
  v_add_f32 v20, v20, v22
  v_add_f32 v21, v21, v23
  v_add_f32 v24, v24, v26
  v_cvt_pk_bf16_f32 v22, v20, v24
  ds_write_b32 v79, v22 offset:0
  v_add_f32 v25, v25, v27
  v_cvt_pk_bf16_f32 v23, v21, v25
  ds_write_b32 v79, v23 offset:576
  v_add_f32 v28, v28, v30
  v_add_f32 v29, v29, v31
  s_waitcnt lgkmcnt(0)
  s_nop 1
  s_branch Cs2_recok
Cs2_mx:
  s_waitcnt lgkmcnt(0)
  s_barrier
  buffer_load_dwordx4 v[52:55], v76, s[8:11], s59 offen offset:0 sc1
  buffer_load_dwordx4 v[0:3], v76, s[8:11], s58 offen offset:0 sc1
  ds_read_b128 v[20:23], v77 offset:0
  ds_read_b128 v[28:31], v77 offset:256
  buffer_load_dwordx4 v[56:59], v76, s[8:11], s59 offen offset:1024 sc1
  buffer_load_dwordx4 v[4:7], v76, s[8:11], s58 offen offset:1024 sc1
  ds_read_b128 v[24:27], v77 offset:128
  ds_read_b128 v[32:35], v77 offset:384
  s_waitcnt vmcnt(2) lgkmcnt(3)
  v_mfma_f32_16x16x32_bf16 v[8:11], v[0:3], v[20:23], 0
  s_waitcnt vmcnt(0) lgkmcnt(1)
  v_mfma_f32_16x16x32_bf16 v[8:11], v[4:7], v[24:27], v[8:11]
  v_mfma_f32_16x16x32_bf16 v[12:15], v[28:31], v[20:23], 0
  s_waitcnt lgkmcnt(0)
  v_mfma_f32_16x16x32_bf16 v[12:15], v[32:35], v[24:27], v[12:15]
  v_add_f32_dpp v8, v10, v8 quad_perm:[2,3,0,1] row_mask:0xf bank_mask:0xf
  v_add_f32_dpp v9, v11, v9 quad_perm:[2,3,0,1] row_mask:0xf bank_mask:0xf
  s_nop 0
  v_mov_b32_dpp v8, v8 quad_perm:[0,1,0,1] row_mask:0xf bank_mask:0xf
  v_mov_b32_dpp v9, v9 quad_perm:[0,1,0,1] row_mask:0xf bank_mask:0xf
  s_nop 1
  v_add_f32_dpp v12, v14, v12 quad_perm:[2,3,0,1] row_mask:0xf bank_mask:0xf
  v_add_f32_dpp v13, v15, v13 quad_perm:[2,3,0,1] row_mask:0xf bank_mask:0xf
  s_nop 0
  v_mov_b32_dpp v12, v12 quad_perm:[0,1,0,1] row_mask:0xf bank_mask:0xf
  v_mov_b32_dpp v13, v13 quad_perm:[0,1,0,1] row_mask:0xf bank_mask:0xf
  v_mul_f32 v12, s69, v12
  ds_write_b32 v78, v8 offset:8712
  v_mul_f32 v13, s69, v13
  ds_write_b32 v78, v9 offset:8776
  s_waitcnt lgkmcnt(0)
  s_barrier
  ds_read_b128 v[36:39], v78 offset:8704
  ds_read_b128 v[40:43], v78 offset:8768
  s_waitcnt lgkmcnt(0)
  s_barrier
  v_max_f32 v16, v36, v37
  v_max3_f32 v16, v16, v38, v39
  v_max3_f32 v16, v16, v40, v41
  v_max3_f32 v16, v16, v42, v43
  v_max3_f32 v16, v16, v12, v13
  v_mov_b32 v17, v16
  s_nop 1
  v_permlane16_swap_b32 v16, v17
  v_max_f32 v16, v16, v17
  v_mov_b32 v17, v16
  s_nop 1
  v_permlane32_swap_b32 v16, v17
  v_max_f32 v16, v16, v17
  v_sub_f32 v36, v36, v16
  v_sub_f32 v37, v37, v16
  v_sub_f32 v38, v38, v16
  v_sub_f32 v39, v39, v16
  v_sub_f32 v40, v40, v16
  v_sub_f32 v41, v41, v16
  v_sub_f32 v42, v42, v16
  v_sub_f32 v43, v43, v16
  v_sub_f32 v12, v12, v16
  v_sub_f32 v13, v13, v16
  v_exp_f32 v36, v36
  v_exp_f32 v37, v37
  v_exp_f32 v38, v38
  v_exp_f32 v39, v39
  v_exp_f32 v40, v40
  v_exp_f32 v41, v41
  v_exp_f32 v42, v42
  v_exp_f32 v43, v43
  v_exp_f32 v12, v12
  v_exp_f32 v13, v13
  v_cvt_pk_bf16_f32 v32, v36, v40
  v_cvt_pk_bf16_f32 v33, v37, v41
  v_cvt_pk_bf16_f32 v34, v38, v42
  v_cvt_pk_bf16_f32 v35, v39, v43
  v_cvt_pk_bf16_f32 v28, v12, v13
  v_cvt_pk_bf16_f32 v31, v12, v13
  v_mov_b32 v29, 0
  v_mov_b32 v30, 0
  v_mfma_f32_16x16x32_bf16 v[8:11], v[32:35], v[68:71], 0
  v_mfma_f32_16x16x32_bf16 v[0:3], v[32:35], v[52:55], 0
  v_mfma_f32_16x16x32_bf16 v[4:7], v[32:35], v[56:59], 0
  v_mfma_f32_16x16x16_bf16 v[8:11], v[28:29], v[68:69], v[8:11]
  v_mfma_f32_16x16x16_bf16 v[0:3], v[28:29], v[72:73], v[0:3]
  v_mfma_f32_16x16x16_bf16 v[4:7], v[30:31], v[72:73], v[4:7]
  ds_read_b128 v[52:55], v75 offset:26624
  v_rcp_f32 v10, v8
  v_rcp_f32 v11, v9
  v_mul_f32 v0, v10, v0
  v_mul_f32 v1, v11, v1
  v_max3_f32 v8, v8, v9, v10
  v_mul_f32 v4, v10, v4
  v_mul_f32 v5, v11, v5
  v_cvt_pk_bf16_f32 v2, v0, v4
  ds_write_b32 v79, v2 offset:8704
  v_cvt_pk_bf16_f32 v3, v1, v5
  ds_write_b32 v79, v3 offset:9280
  ds_read_b128 v[12:15], v78 offset:8832
  ds_read_b128 v[56:59], v75 offset:27648
  v_mov_b64 v[16:17], 0
  v_mov_b64 v[18:19], 0
  v_mov_b64 v[20:21], 0
  v_mov_b64 v[22:23], 0
  v_mov_b64 v[24:25], 0
  v_mov_b64 v[26:27], 0
  s_branch Cs2_mxok
Cs2_last:
  ds_read_b128 v[4:7], v76 offset:5632
  ds_read_b128 v[8:11], v76 offset:6656
  ds_read_b128 v[44:47], v76 offset:40960
  ds_read_b128 v[48:51], v76 offset:41984
  s_nop 5
  v_mov_b64 v[20:21], 0
  v_mov_b64 v[22:23], 0
  v_mov_b64 v[24:25], 0
  v_mov_b64 v[26:27], 0
  s_waitcnt lgkmcnt(4)
  v_smfmac_f32_16x16x64_bf16 v[28:31], v[0:3], v[36:43], v74
  ds_read_b128 v[36:39], v76 offset:43008
  ds_read_b128 v[40:43], v76 offset:44032
  v_smfmac_f32_16x16x64_bf16 v[32:35], v[0:3], v[60:67], v74
  s_waitcnt lgkmcnt(5)
  v_smfmac_f32_16x16x64_bf16 v[20:23], v[0:3], a[32:39], v74
  ds_read_b128 v[60:63], v76 offset:57344
  ds_read_b128 v[64:67], v76 offset:58368
  v_smfmac_f32_16x16x64_bf16 v[24:27], v[0:3], a[40:47], v74
  s_waitcnt lgkmcnt(4)
  v_smfmac_f32_16x16x64_bf16 v[20:23], v[4:7], a[48:55], v74
  buffer_store_dwordx4 v[16:19], v76, s[8:11], s68 offen sc1
  v_smfmac_f32_16x16x64_bf16 v[24:27], v[4:7], a[56:63], v74
  v_smfmac_f32_16x16x64_bf16 v[28:31], v[4:7], v[44:51], v74
  s_waitcnt lgkmcnt(2)
  v_smfmac_f32_16x16x64_bf16 v[20:23], v[8:11], a[64:71], v74
  ds_read_b128 v[44:47], v76 offset:59392
  ds_read_b128 v[48:51], v76 offset:60416
  v_smfmac_f32_16x16x64_bf16 v[24:27], v[8:11], a[72:79], v74
  v_smfmac_f32_16x16x64_bf16 v[32:35], v[4:7], v[36:43], v74
  v_smfmac_f32_16x16x64_bf16 v[28:31], v[8:11], v[208:215], v74
  ds_read_b128 v[36:39], v75 offset:24576
  ds_read_b128 v[40:43], v75 offset:25600
  v_smfmac_f32_16x16x64_bf16 v[32:35], v[8:11], v[216:223], v74
  v_smfmac_f32_16x16x64_bf16 v[20:23], v[12:15], a[80:87], v74
  v_smfmac_f32_16x16x64_bf16 v[24:27], v[12:15], a[88:95], v74
  v_smfmac_f32_16x16x64_bf16 v[28:31], v[12:15], v[224:231], v74
  v_smfmac_f32_16x16x64_bf16 v[32:35], v[12:15], v[232:239], v74
  s_waitcnt vmcnt(1)
  s_barrier
Cs2_lastr:
  ds_read_b128 v[12:15], v76 offset:8704
  ds_read_b128 v[0:3], v76 offset:9728
  ds_read_b128 v[16:19], v76 offset:10752
  ds_read_b128 v[4:7], v76 offset:11776
  ds_read_b128 v[8:11], v76 offset:12800
  s_waitcnt lgkmcnt(3)
  v_max3_u32 v72, v0, v1, v2
  s_waitcnt lgkmcnt(1)
  v_max3_u32 v72, v72, v3, v4
  v_max3_u32 v72, v72, v5, v6
  s_waitcnt lgkmcnt(0)
  v_max3_u32 v72, v72, v7, v8
  v_max3_u32 v72, v72, v9, v10
  v_max3_u32 v72, v72, v11, v12
  v_max3_u32 v72, v72, v13, v14
  v_max3_u32 v72, v72, v15, v16
  v_max3_u32 v72, v72, v17, v18
  v_max_u32 v72, v72, v19
  v_cmp_eq_u32 vcc, -1, v72
  s_cbranch_vccnz Cs2_lastp
Cs2_lastg:
  v_smfmac_f32_16x16x64_bf16 v[28:31], v[12:15], v[60:67], v74
  ds_read_b128 v[60:63], v75 offset:26624
  ds_read_b128 v[64:67], v75 offset:27648
  v_smfmac_f32_16x16x64_bf16 v[32:35], v[12:15], v[44:51], v74
  v_smfmac_f32_16x16x64_bf16 v[28:31], v[0:3], v[36:43], v74
  v_smfmac_f32_16x16x64_bf16 v[28:31], v[16:19], v[240:247], v74
  v_smfmac_f32_16x16x64_bf16 v[28:31], v[4:7], a[0:7], v74
  v_smfmac_f32_16x16x64_bf16 v[28:31], v[8:11], a[16:23], v74
  v_smfmac_f32_16x16x64_bf16 v[32:35], v[16:19], v[248:255], v74
  v_smfmac_f32_16x16x64_bf16 v[32:35], v[4:7], a[8:15], v74
  s_waitcnt lgkmcnt(0)
  v_smfmac_f32_16x16x64_bf16 v[32:35], v[8:11], a[24:31], v74
  v_smfmac_f32_16x16x64_bf16 v[32:35], v[0:3], v[60:67], v74
  v_smfmac_f32_16x16x64_bf16 v[20:23], v[12:15], a[96:103], v74
  v_smfmac_f32_16x16x64_bf16 v[20:23], v[0:3], a[112:119], v74
  v_add_f32 v28, v28, v30
  v_add_f32 v32, v32, v34
  v_cvt_pk_bf16_f32 v30, v28, v32
  v_smfmac_f32_16x16x64_bf16 v[20:23], v[16:19], a[128:135], v74
  ds_write_b32 v79, v30 offset:256
  v_add_f32 v29, v29, v31
  v_add_f32 v33, v33, v35
  v_cvt_pk_bf16_f32 v31, v29, v33
  v_smfmac_f32_16x16x64_bf16 v[20:23], v[4:7], a[144:151], v74
  ds_write_b32 v79, v31 offset:832
  v_smfmac_f32_16x16x64_bf16 v[20:23], v[8:11], a[160:167], v74
  v_smfmac_f32_16x16x64_bf16 v[24:27], v[12:15], a[104:111], v74
  v_smfmac_f32_16x16x64_bf16 v[24:27], v[0:3], a[120:127], v74
  v_smfmac_f32_16x16x64_bf16 v[24:27], v[16:19], a[136:143], v74
  s_waitcnt lgkmcnt(0)
  s_barrier
  ds_read_b64 v[52:53], v77 offset:384
  v_add_f32 v20, v20, v22
  v_smfmac_f32_16x16x64_bf16 v[24:27], v[4:7], a[152:159], v74
  v_add_f32 v21, v21, v23
  v_smfmac_f32_16x16x64_bf16 v[24:27], v[8:11], a[168:175], v74
  v_cvt_pk_bf16_f32 v54, v20, v21
  s_add_u32 s68, s68, 655360
  s_nop 3
  v_add_f32 v24, v24, v26
  v_add_f32 v25, v25, v27
  v_cvt_pk_bf16_f32 v55, v24, v25
  s_waitcnt lgkmcnt(0)
  buffer_store_dwordx4 v[52:55], v76, s[8:11], s68 offen sc1
  s_branch Cs2_done
Cs2_lastp:
  s_add_u32 s72, s72, 2
  s_cmp_ge_u32 s72, 131072
  s_cbranch_scc1 Cs2_lastg
  s_barrier
  buffer_load_dwordx4 v76, s[8:11], s85 offen offset:0 sc1 lds
  s_waitcnt vmcnt(0)
  s_barrier
  s_branch Cs2_lastr
Cs2_done:
  s_branch L_cexit
L_w7:
  v_mov_b64 v[20:21], 0
  v_mov_b64 v[22:23], 0
  v_mov_b64 v[24:25], 0
  v_mov_b64 v[26:27], 0
  v_mov_b64 v[28:29], 0
  v_mov_b64 v[30:31], 0
  v_mov_b64 v[32:33], 0
  v_mov_b64 v[34:35], 0
  s_mov_b32 s78, 0x3f803f80
  s_mov_b32 s79, s78
  s_mov_b32 s65, 360448
  s_mov_b32 m0, 15872
  s_lshl_b32 s71, s53, 2
  s_add_u32 s71, s71, 128
  s_movk_i32 s56, 0x1000
  v_lshlrev_b32 v73, 2, v76
  v_mov_b32 v72, 0
  s_mov_b64 s[16:17], s[8:9]
  s_mov_b32 s18, 268435456
  s_mov_b32 s19, 0x20000
  s_getpc_b64 s[20:21]
Cs3_pc:
  s_add_u32 s20, s20, (Cs3_last - Cs3_pc)
  s_addc_u32 s21, s21, 0
  v_mov_b32 v68, 14880
  buffer_load_dwordx4 v[52:55], v76, s[8:11], s59 offen offset:0 sc1
  buffer_load_dwordx4 v[56:59], v76, s[8:11], s59 offen offset:1024 sc1
  ds_read_b128 v[36:39], v76 offset:45056
  ds_read_b128 v[40:43], v76 offset:46080
  ds_read_b128 v[60:63], v76 offset:47104
  ds_read_b128 v[64:67], v76 offset:48128
  ds_read_b128 v[0:3], v76 offset:4608
  ds_read_b128 v[4:7], v76 offset:5632
  ds_read_b128 v[8:11], v76 offset:6656
  ds_read_b128 v[12:15], v76 offset:7680
  s_waitcnt lgkmcnt(0)
  s_cmp_eq_u32 s66, 1
  s_branch Cs3_top2
.p2align 6
Cs3_h2:
  v_lshlrev_b32 v73, 2, v76
  ds_read_b128 v[36:39], v76 offset:45056
  ds_read_b128 v[40:43], v76 offset:46080
  buffer_load_dwordx4 v[52:55], v76, s[8:11], s59 offen offset:0 sc1
  buffer_load_dwordx4 v[56:59], v76, s[8:11], s59 offen offset:1024 sc1
  s_waitcnt vmcnt(0)
  s_mov_b64 vcc, -1
Cs3_h2r:
  s_mov_b64 exec, vcc
  buffer_load_dwordx4 v[4:7], v76, s[8:11], s65 offen offset:1024 sc1
  buffer_load_dwordx4 v[0:3], v76, s[8:11], s85 offen offset:0 sc1
  buffer_load_dwordx4 v[8:11], v76, s[8:11], s85 offen offset:1024 sc1
  s_mov_b64 exec, -1
  s_add_u32 s67, s67, 1
  s_cmp_lt_u32 s67, 131072
  s_cselect_b32 s54, -2, -1
  s_waitcnt vmcnt(2)
  v_max3_u32 v72, v4, v5, v6
  s_waitcnt vmcnt(1)
  v_max3_u32 v72, v72, v7, v0
  v_max3_u32 v72, v72, v1, v2
  s_waitcnt vmcnt(0)
  v_max3_u32 v72, v72, v3, v8
  v_max3_u32 v72, v72, v9, v10
  v_max_u32 v72, v72, v11
  v_cmp_lt_u32 vcc, s54, v72
  s_cbranch_vccnz Cs3_h2r
  ds_write_b128 v76, v[4:7] offset:5632
  ds_write_b128 v76, v[0:3] offset:8704
  ds_write_b128 v76, v[8:11] offset:9728
Cs3_h2w:
  s_cmp_eq_u32 s66, 63
  s_waitcnt lgkmcnt(0)
  s_barrier
  ds_read_b128 v[8:11], v76 offset:6656
Cs3_top2:
  v_smfmac_f32_16x16x64_bf16 v[20:23], v[4:7], v[96:103], v74
  s_cbranch_scc1 Cs3_last
  v_smfmac_f32_16x16x64_bf16 v[28:31], v[4:7], v[36:43], v74
  buffer_load_dwordx4 v[44:47], v76, s[8:11], s58 offen offset:0 sc1
  s_mov_b32 m0, 15872
  v_smfmac_f32_16x16x64_bf16 v[24:27], v[4:7], v[104:111], v74
  buffer_load_dwordx4 v[48:51], v76, s[8:11], s58 offen offset:1024 sc1
  v_smfmac_f32_16x16x64_bf16 v[32:35], v[4:7], v[60:67], v74
  ds_read_b128 v[0:3], v76 offset:4608
  s_waitcnt lgkmcnt(1)
  v_smfmac_f32_16x16x64_bf16 v[20:23], v[8:11], v[112:119], v74
  ds_read_b128 v[12:15], v76 offset:7680
  v_smfmac_f32_16x16x64_bf16 v[24:27], v[8:11], v[120:127], v74
  ds_read_b128 v[36:39], v76 offset:28672
  v_smfmac_f32_16x16x64_bf16 v[28:31], v[8:11], v[208:215], v74
  buffer_store_dwordx4 v[16:19], v76, s[8:11], s68 offen sc1
  ds_read_b128 v[40:43], v76 offset:29696
  v_smfmac_f32_16x16x64_bf16 v[32:35], v[8:11], v[216:223], v74
  buffer_load_dword v73, s[16:19], s70 offen lds
  ds_read_b128 v[60:63], v76 offset:30720
  s_waitcnt lgkmcnt(4)
  v_smfmac_f32_16x16x64_bf16 v[20:23], v[0:3], v[80:87], v74
  ds_read_b128 v[64:67], v76 offset:31744
  v_smfmac_f32_16x16x64_bf16 v[24:27], v[0:3], v[88:95], v74
  s_waitcnt vmcnt(4)
  s_waitcnt lgkmcnt(4)
  v_smfmac_f32_16x16x64_bf16 v[20:23], v[12:15], v[128:135], v74
  s_barrier
  ds_read_b128 v[4:7], v76 offset:8704
  s_waitcnt lgkmcnt(3)
  v_smfmac_f32_16x16x64_bf16 v[28:31], v[0:3], v[36:43], v74
  ds_read_b128 v[36:39], v76 offset:61440
  v_smfmac_f32_16x16x64_bf16 v[24:27], v[12:15], v[136:143], v74
  ds_read_b128 v[40:43], v76 offset:62464
  s_waitcnt lgkmcnt(3)
  v_smfmac_f32_16x16x64_bf16 v[32:35], v[0:3], v[60:67], v74
  ds_read_b128 v[8:11], v76 offset:9728
  v_smfmac_f32_16x16x64_bf16 v[28:31], v[12:15], v[224:231], v74
  ds_read_b128 v[60:63], v76 offset:63488
  v_smfmac_f32_16x16x64_bf16 v[32:35], v[12:15], v[232:239], v74
  ds_read_b128 v[64:67], v76 offset:64512
  s_waitcnt lgkmcnt(5)
  v_smfmac_f32_16x16x64_bf16 v[20:23], v[4:7], v[144:151], v74
  s_barrier
  ds_read_b128 v[0:3], v76 offset:11776
  s_waitcnt lgkmcnt(4)
  v_smfmac_f32_16x16x64_bf16 v[28:31], v[4:7], v[36:43], v74
  ds_read_b128 v[12:15], v76 offset:12800
  ds_read_b128 v[36:39], v75 offset:12288
  v_smfmac_f32_16x16x64_bf16 v[24:27], v[4:7], v[152:159], v74
  ds_read_b128 v[16:19], v76 offset:10752
  s_waitcnt lgkmcnt(6)
  v_smfmac_f32_16x16x64_bf16 v[20:23], v[8:11], v[160:167], v74
  ds_read_b128 v[40:43], v75 offset:13312
  s_waitcnt lgkmcnt(5)
  v_smfmac_f32_16x16x64_bf16 v[32:35], v[4:7], v[60:67], v74
  ds_read_b128 v[60:63], v75 offset:14336
  v_smfmac_f32_16x16x64_bf16 v[24:27], v[8:11], v[168:175], v74
  ds_read_b128 v[64:67], v75 offset:15360
  s_waitcnt lgkmcnt(6)
  v_smfmac_f32_16x16x64_bf16 v[20:23], v[0:3], v[176:183], v74
  s_waitcnt lgkmcnt(5)
  v_smfmac_f32_16x16x64_bf16 v[20:23], v[12:15], v[192:199], v74
  s_waitcnt lgkmcnt(2)
  v_smfmac_f32_16x16x64_bf16 v[20:23], v[16:19], v[36:43], v74
  ds_read_b128 v[36:39], v75 offset:28672
  v_smfmac_f32_16x16x64_bf16 v[24:27], v[0:3], v[184:191], v74
  ds_read_b128 v[40:43], v75 offset:29696
  s_waitcnt lgkmcnt(2)
  v_smfmac_f32_16x16x64_bf16 v[24:27], v[16:19], v[60:67], v74
  ds_read_b128 v[60:63], v75 offset:30720
  v_add_f32 v20, v20, v22
  v_smfmac_f32_16x16x64_bf16 v[24:27], v[12:15], v[200:207], v74
  ds_read_b128 v[64:67], v75 offset:31744
  v_add_f32 v21, v21, v23
  v_smfmac_f32_16x16x64_bf16 v[28:31], v[16:19], v[240:247], v74
  v_mov_b64 v[70:71], s[78:79]
  v_smfmac_f32_16x16x64_bf16 v[28:31], v[0:3], a[0:7], v74
  s_waitcnt lgkmcnt(2)
  v_add_f32 v24, v24, v26
  v_smfmac_f32_16x16x64_bf16 v[28:31], v[8:11], v[36:43], v74
  ds_read_b128 v[36:39], v68
  v_cvt_pk_bf16_f32 v22, v20, v24
  v_smfmac_f32_16x16x64_bf16 v[28:31], v[12:15], a[16:23], v74
  ds_read_b128 v[40:43], v68
  ds_write_b32 v79, v22 offset:0
  s_waitcnt lgkmcnt(3)
  v_add_f32 v25, v25, v27
  v_cvt_pk_bf16_f32 v23, v21, v25
  v_smfmac_f32_16x16x64_bf16 v[32:35], v[8:11], v[60:67], v74
  ds_write_b32 v79, v23 offset:576
  v_cmp_u_f32 vcc, v20, v21
  v_smfmac_f32_16x16x64_bf16 v[32:35], v[16:19], v[248:255], v74
  v_add_f32 v28, v28, v30
  v_smfmac_f32_16x16x64_bf16 v[32:35], v[0:3], a[8:15], v74
  v_add_f32 v29, v29, v31
  v_smfmac_f32_16x16x64_bf16 v[32:35], v[12:15], a[24:31], v74
  s_cbranch_vccnz Cs3_rec
Cs3_recok:
  s_waitcnt lgkmcnt(3)
  v_smfmac_f32_16x16x64_bf16 v[36:39], v[16:19], a[128:135], v74
  s_waitcnt lgkmcnt(0)
  s_barrier
  ds_read_b128 v[60:63], v77
  v_smfmac_f32_16x16x64_bf16 v[40:43], v[16:19], a[136:143], v74
  ds_read_b128 v[64:67], v77 offset:128
  v_add_f32 v32, v32, v34
  v_cvt_pk_bf16_f32 v30, v28, v32
  v_smfmac_f32_16x16x64_bf16 v[36:39], v[0:3], a[144:151], v74
  ds_write_b32 v79, v30 offset:256
  v_add_f32 v33, v33, v35
  v_cvt_pk_bf16_f32 v31, v29, v33
  v_smfmac_f32_16x16x64_bf16 v[40:43], v[0:3], a[152:159], v74
  ds_write_b32 v79, v31 offset:832
  v_xor_b32 v75, 0x8000, v75
  v_smfmac_f32_16x16x64_bf16 v[36:39], v[4:7], a[96:103], v74
  ds_read_b128 v[0:3], v76 offset:4608
  v_mov_b32 v29, 0
  v_smfmac_f32_16x16x64_bf16 v[40:43], v[4:7], a[104:111], v74
  s_waitcnt vmcnt(2) lgkmcnt(3)
  v_mov_b32 v30, 0
  v_mfma_f32_16x16x32_bf16 v[44:47], v[44:47], v[60:63], 0
  ds_read_b128 v[4:7], v76 offset:5632
  s_waitcnt lgkmcnt(2)
  v_mfma_f32_16x16x32_bf16 v[44:47], v[48:51], v[64:67], v[44:47]
  s_barrier
  v_smfmac_f32_16x16x64_bf16 v[36:39], v[8:11], a[112:119], v74
  ds_read_b128 v[20:23], v77 offset:256
  ds_read_b128 v[24:27], v77 offset:384
  v_smfmac_f32_16x16x64_bf16 v[40:43], v[8:11], a[120:127], v74
  ds_read_b128 v[8:11], v76 offset:6656
  v_add_f32_dpp v72, v46, v44 quad_perm:[2,3,0,1] row_mask:0xf bank_mask:0xf
  v_add_f32_dpp v73, v47, v45 quad_perm:[2,3,0,1] row_mask:0xf bank_mask:0xf
  v_smfmac_f32_16x16x64_bf16 v[36:39], v[12:15], a[160:167], v74
  s_waitcnt lgkmcnt(4)
  v_exp_f32_dpp v72, v72 quad_perm:[0,1,0,1] row_mask:0xf bank_mask:0xf
  v_smfmac_f32_16x16x64_bf16 v[40:43], v[12:15], a[168:175], v74
  ds_read_b128 v[12:15], v76 offset:7680
  v_exp_f32_dpp v73, v73 quad_perm:[0,1,0,1] row_mask:0xf bank_mask:0xf
  v_smfmac_f32_16x16x64_bf16 v[36:39], v[0:3], a[32:39], v74
  s_waitcnt lgkmcnt(2)
  v_cvt_pk_bf16_f32 v72, v72, v73
  v_mfma_f32_16x16x32_bf16 v[20:23], v[20:23], v[60:63], 0
  ds_write_b32 v78, v72 offset:524
  v_mov_b64 v[16:17], 0
  v_mfma_f32_16x16x32_bf16 v[20:23], v[24:27], v[64:67], v[20:23]
  ds_read_b128 v[44:47], v75 offset:47104
  v_mov_b64 v[18:19], 0
  v_smfmac_f32_16x16x64_bf16 v[40:43], v[0:3], a[40:47], v74
  ds_read_b128 v[48:51], v75 offset:48128
  v_mov_b64 v[68:69], s[78:79]
  v_smfmac_f32_16x16x64_bf16 v[36:39], v[4:7], a[48:55], v74
  s_waitcnt lgkmcnt(4)
  v_add_f32_dpp v24, v22, v20 quad_perm:[2,3,0,1] row_mask:0xf bank_mask:0xf
  v_add_f32_dpp v25, v23, v21 quad_perm:[2,3,0,1] row_mask:0xf bank_mask:0xf
  v_smfmac_f32_16x16x64_bf16 v[36:39], v[8:11], a[64:71], v74
  s_waitcnt lgkmcnt(2)
  s_barrier
  ds_read_b128 v[32:35], v78 offset:512
  v_smfmac_f32_16x16x64_bf16 v[36:39], v[12:15], a[80:87], v74
  ds_read_b128 v[60:63], v75 offset:28672
  v_mul_f32 v24, s69, v24
  v_smfmac_f32_16x16x64_bf16 v[40:43], v[4:7], a[56:63], v74
  ds_read_b128 v[64:67], v75 offset:29696
  v_mul_f32 v25, s69, v25
  v_smfmac_f32_16x16x64_bf16 v[40:43], v[8:11], a[72:79], v74
  v_exp_f32_dpp v24, v24 quad_perm:[0,1,0,1] row_mask:0xf bank_mask:0xf
  v_smfmac_f32_16x16x64_bf16 v[40:43], v[12:15], a[88:95], v74
  s_waitcnt lgkmcnt(2)
  v_exp_f32_dpp v25, v25 quad_perm:[0,1,0,1] row_mask:0xf bank_mask:0xf
  v_mfma_f32_16x16x32_bf16 v[8:11], v[32:35], v[68:71], 0
  v_add_f32 v36, v36, v38
  v_add_f32 v37, v37, v39
  v_mfma_f32_16x16x32_bf16 v[0:3], v[32:35], v[52:55], 0
  v_add_f32 v40, v40, v42
  v_add_f32 v41, v41, v43
  v_mfma_f32_16x16x32_bf16 v[4:7], v[32:35], v[56:59], 0
  v_cvt_pk_bf16_f32 v28, v24, v25
  v_cvt_pk_bf16_f32 v72, v36, v37
  v_cvt_pk_bf16_f32 v73, v40, v41
  v_mfma_f32_16x16x16_bf16 v[8:11], v[28:29], v[68:69], v[8:11]
  v_cvt_pk_bf16_f32 v31, v24, v25
  v_mov_b64 v[20:21], 0
  v_mfma_f32_16x16x16_bf16 v[0:3], v[28:29], v[72:73], v[0:3]
  ds_read_b128 v[52:55], v75 offset:30720
  v_mov_b64 v[22:23], 0
  v_mfma_f32_16x16x16_bf16 v[4:7], v[30:31], v[72:73], v[4:7]
  v_rcp_f32 v10, v8
  v_rcp_f32 v11, v9
  v_mul_f32 v0, v10, v0
  v_mul_f32 v1, v11, v1
  v_max3_f32 v8, v8, v9, v10
  v_mul_f32 v4, v10, v4
  v_mul_f32 v5, v11, v5
  v_cvt_pk_bf16_f32 v2, v0, v4
  ds_write_b32 v79, v2 offset:8704
  v_cvt_pk_bf16_f32 v3, v1, v5
  ds_write_b32 v79, v3 offset:9280
  ds_read_b128 v[12:15], v78 offset:8896
  v_max_f32 v8, v8, v11
  v_cmp_le_f32 vcc, 1317011456, v8
  v_mov_b64 v[24:25], 0
  v_mov_b64 v[26:27], 0
  ds_read_b128 v[56:59], v75 offset:31744
  s_cbranch_vccnz Cs3_mx
Cs3_mxok:
  s_waitcnt lgkmcnt(2)
  s_barrier
  ds_read_b128 v[0:3], v78 offset:8832
  s_waitcnt lgkmcnt(2)
  v_smfmac_f32_16x16x64_bf16 v[16:19], v[12:15], a[184:191], v74
  ds_read_b128 v[4:7], v78 offset:8704
  v_smfmac_f32_16x16x64_bf16 v[20:23], v[12:15], v[44:51], v74
  ds_read_b128 v[8:11], v78 offset:8768
  v_smfmac_f32_16x16x64_bf16 v[24:27], v[12:15], a[232:239], v74
  ds_read_b128 v[36:39], v75 offset:45056
  s_waitcnt lgkmcnt(3)
  v_smfmac_f32_16x16x64_bf16 v[16:19], v[0:3], a[176:183], v74
  ds_read_b128 v[40:43], v75 offset:46080
  s_waitcnt lgkmcnt(3)
  v_smfmac_f32_16x16x64_bf16 v[16:19], v[4:7], v[60:67], v74
  ds_read_b128 v[68:71], v76 offset:13824
  s_waitcnt lgkmcnt(3)
  v_smfmac_f32_16x16x64_bf16 v[16:19], v[8:11], v[52:59], v74
  ds_read_b128 v[44:47], v75 offset:61440
  v_smfmac_f32_16x16x64_bf16 v[20:23], v[4:7], a[192:199], v74
  ds_read_b128 v[48:51], v75 offset:62464
  v_smfmac_f32_16x16x64_bf16 v[20:23], v[8:11], a[200:207], v74
  ds_read_b128 v[60:63], v75 offset:63488
  s_waitcnt lgkmcnt(4)
  v_cvt_pk_bf16_f32 v16, v16, v17
  v_cvt_pk_bf16_f32 v17, v18, v19
  v_bfi_b32 v16, 1, s72, v16
  v_smfmac_f32_16x16x64_bf16 v[20:23], v[0:3], v[36:43], v74
  s_waitcnt lgkmcnt(3)
  buffer_store_dwordx2 v[16:17], v68, s[8:11], s73 offen sc1
  v_mov_b64 v[32:33], 0
  v_smfmac_f32_16x16x64_bf16 v[24:27], v[4:7], a[208:215], v74
  ds_read_b128 v[64:67], v75 offset:64512
  v_mov_b64 v[34:35], 0
  v_smfmac_f32_16x16x64_bf16 v[24:27], v[8:11], a[216:223], v74
  ds_read_b128 v[52:55], v75 offset:8192
  v_cvt_pk_bf16_f32 v20, v20, v21
  v_cvt_pk_bf16_f32 v21, v22, v23
  v_bfi_b32 v20, 1, s72, v20
  v_smfmac_f32_16x16x64_bf16 v[24:27], v[0:3], a[224:231], v74
  ds_read_b128 v[56:59], v75 offset:9216
  buffer_store_dwordx2 v[20:21], v68, s[8:11], s74 offen sc1
  s_waitcnt lgkmcnt(4)
  v_mov_b64 v[28:29], 0
  v_smfmac_f32_16x16x64_bf16 v[32:35], v[4:7], v[44:51], v74
  ds_read_b128 v[36:39], v75 offset:10240
  ds_read_b128 v[40:43], v75 offset:11264
  s_waitcnt lgkmcnt(4)
  v_smfmac_f32_16x16x64_bf16 v[32:35], v[8:11], v[60:67], v74
  ds_read_b128 v[44:47], v75 offset:12288
  v_cvt_pk_bf16_f32 v24, v24, v25
  v_cvt_pk_bf16_f32 v25, v26, v27
  v_bfi_b32 v24, 1, s72, v24
  v_smfmac_f32_16x16x64_bf16 v[32:35], v[0:3], a[240:247], v74
  ds_read_b128 v[48:51], v75 offset:13312
  buffer_store_dwordx2 v[24:25], v68, s[8:11], s75 offen sc1
  v_mov_b64 v[30:31], 0
  v_smfmac_f32_16x16x64_bf16 v[32:35], v[12:15], a[248:255], v74
  ds_read_b128 v[60:63], v75 offset:14336
  ds_read_b128 v[64:67], v75 offset:15360
  s_waitcnt lgkmcnt(6)
  v_smfmac_f32_16x16x64_bf16 v[28:31], v[4:7], v[52:59], v74
  s_waitcnt lgkmcnt(4)
  v_smfmac_f32_16x16x64_bf16 v[28:31], v[8:11], v[36:43], v74
  s_waitcnt lgkmcnt(2)
  v_cvt_pk_bf16_f32 v32, v32, v33
  v_cvt_pk_bf16_f32 v33, v34, v35
  v_bfi_b32 v32, 1, s72, v32
  v_smfmac_f32_16x16x64_bf16 v[28:31], v[0:3], v[44:51], v74
  buffer_store_dwordx2 v[32:33], v68, s[8:11], s76 offen sc1
  s_waitcnt lgkmcnt(0)
  v_smfmac_f32_16x16x64_bf16 v[28:31], v[12:15], v[60:67], v74
  v_mov_b64 v[18:19], v[72:73]
  s_nop 4
  v_cvt_pk_bf16_f32 v28, v28, v29
  v_cvt_pk_bf16_f32 v29, v30, v31
  v_bfi_b32 v28, 1, s72, v28
  buffer_store_dwordx2 v[28:29], v68, s[8:11], s77 offen sc1
  ds_read_b128 v[52:55], v76 offset:14848
  s_waitcnt lgkmcnt(0)
  ds_read_b64 v[16:17], v77 offset:392
  s_waitcnt lgkmcnt(0)
  ds_read_b128 v[60:63], v76 offset:47104
  s_waitcnt lgkmcnt(0)
  ds_read_b128 v[64:67], v76 offset:48128
  s_waitcnt lgkmcnt(0)
  s_add_u32 s66, s66, 1
  s_xor_b32 s64, s64, 16384
  s_xor_b32 s65, s65, 16384
  s_add_u32 s58, s58, 655360
  s_add_u32 s59, s59, 655360
  s_add_u32 s70, s70, 655360
  s_add_u32 s68, s68, 655360
  s_mov_b32 m0, 8704
  s_add_u32 s85, s65, 4096
  v_xor_b32 v75, 0x8000, v75
  v_mov_b64 v[28:29], 0
  v_mov_b64 v[30:31], 0
  v_mov_b64 v[32:33], 0
  v_mov_b64 v[34:35], 0
  s_waitcnt vmcnt(0)
  buffer_load_dwordx4 v[0:3], v76, s[8:11], s60 offen offset:0 sc1
  buffer_load_dwordx4 v[4:7], v76, s[8:11], s60 offen offset:1024 sc1
  buffer_load_dwordx4 v[8:11], v76, s[8:11], s61 offen offset:0 sc1
  buffer_load_dwordx4 v[12:15], v76, s[8:11], s61 offen offset:1024 sc1
  v_mov_b64 v[20:21], 0
  v_mov_b64 v[22:23], 0
  v_mov_b64 v[24:25], 0
  v_mov_b64 v[26:27], 0
  v_mov_b32 v68, 14880
  s_cmp_eq_u32 s66, 62
  s_cselect_b64 s[16:17], s[20:21], s[16:17]
  s_cselect_b32 s18, (Cs3_done - Cs3_last), s18
  s_cselect_b32 s70, 0, s70
  s_cmp_eq_u32 s66, 63
  s_cselect_b32 s59, 268435456, s59
  s_cselect_b32 s58, 268435456, s58
  s_waitcnt lgkmcnt(0)
  s_waitcnt vmcnt(3)
  v_mfma_f32_16x16x32_bf16 v[56:59], v[52:55], v[0:3], 0
  v_bitop3_b32 v72, v0, v2, s72 bitop3:0x7e
  s_waitcnt vmcnt(2)
  v_mfma_f32_16x16x32_bf16 v[56:59], v[52:55], v[4:7], v[56:59]
  v_bitop3_b32 v73, v4, v6, s72 bitop3:0x7e
  v_or_b32 v72, v72, v73
  s_waitcnt vmcnt(1)
  v_mfma_f32_16x16x32_bf16 v[36:39], v[52:55], v[8:11], 0
  v_bitop3_b32 v73, v8, v10, s72 bitop3:0x7e
  v_or_b32 v72, v72, v73
  s_waitcnt vmcnt(0)
  v_mfma_f32_16x16x32_bf16 v[36:39], v[52:55], v[12:15], v[36:39]
  v_bitop3_b32 v73, v12, v14, s72 bitop3:0x7e
  v_bitop3_b32 v72, v72, v73, 1 bitop3:0xa8
  v_cmp_ne_u32 vcc, 0, v72
  s_cbranch_vccnz Cs3_h1r
  v_add_f32_dpp v56, v56, v56 row_ror:4 row_mask:0xf bank_mask:0xf
  v_add_f32_dpp v57, v57, v57 row_ror:4 row_mask:0xf bank_mask:0xf
  s_nop 0
  v_add_f32_dpp v36, v36, v36 row_ror:4 row_mask:0xf bank_mask:0xf
  v_add_f32_dpp v37, v37, v37 row_ror:4 row_mask:0xf bank_mask:0xf
  v_add_f32_dpp v56, v56, v56 row_ror:8 row_mask:0xf bank_mask:0xf
  v_add_f32_dpp v57, v57, v57 row_ror:8 row_mask:0xf bank_mask:0xf
  v_add_f32_dpp v36, v36, v36 row_ror:8 row_mask:0xf bank_mask:0xf
  v_add_f32_dpp v37, v37, v37 row_ror:8 row_mask:0xf bank_mask:0xf
  v_cvt_pk_bf16_f32 v56, v56, v57
  buffer_store_dword v56, v69, s[8:11], s62 offen sc1
  v_cvt_pk_bf16_f32 v36, v36, v37
  buffer_store_dword v36, v70, s[8:11], s63 offen sc1
  s_xor_b32 s62, s62, 16384
  buffer_store_dword v71, v69, s[8:11], s62 offen sc1
  s_xor_b32 s63, s63, 16384
  buffer_store_dword v71, v70, s[8:11], s63 offen sc1
  s_xor_b32 s72, s72, 1
  s_branch Cs3_h2
Cs3_h1r:
  s_mov_b64 exec, vcc
  buffer_load_dwordx4 v[0:3], v76, s[8:11], s60 offen offset:0 sc1
  buffer_load_dwordx4 v[4:7], v76, s[8:11], s60 offen offset:1024 sc1
  buffer_load_dwordx4 v[8:11], v76, s[8:11], s61 offen offset:0 sc1
  buffer_load_dwordx4 v[12:15], v76, s[8:11], s61 offen offset:1024 sc1
  s_mov_b64 exec, -1
  s_add_u32 s67, s67, 1
  s_waitcnt vmcnt(3)
  v_mfma_f32_16x16x32_bf16 v[56:59], v[52:55], v[0:3], 0
  v_bitop3_b32 v72, v0, v2, s72 bitop3:0x7e
  s_waitcnt vmcnt(2)
  v_mfma_f32_16x16x32_bf16 v[56:59], v[52:55], v[4:7], v[56:59]
  v_bitop3_b32 v73, v4, v6, s72 bitop3:0x7e
  v_or_b32 v72, v72, v73
  s_waitcnt vmcnt(1)
  v_mfma_f32_16x16x32_bf16 v[36:39], v[52:55], v[8:11], 0
  v_bitop3_b32 v73, v8, v10, s72 bitop3:0x7e
  v_or_b32 v72, v72, v73
  s_waitcnt vmcnt(0)
  v_mfma_f32_16x16x32_bf16 v[36:39], v[52:55], v[12:15], v[36:39]
  v_bitop3_b32 v73, v12, v14, s72 bitop3:0x7e
  v_bitop3_b32 v72, v72, v73, 1 bitop3:0xa8
  v_cmp_ne_u32 vcc, 0, v72
  s_cbranch_vccz Cs3_h1p
Cs3_h1s:
  s_mov_b64 exec, vcc
  buffer_load_dwordx4 v[0:3], v76, s[8:11], s60 offen offset:0 sc1
  buffer_load_dwordx4 v[4:7], v76, s[8:11], s60 offen offset:1024 sc1
  buffer_load_dwordx4 v[8:11], v76, s[8:11], s61 offen offset:0 sc1
  buffer_load_dwordx4 v[12:15], v76, s[8:11], s61 offen offset:1024 sc1
  s_mov_b64 exec, -1
  s_add_u32 s67, s67, 1
  s_waitcnt vmcnt(3)
  v_mfma_f32_16x16x32_bf16 v[56:59], v[52:55], v[0:3], 0
  v_bitop3_b32 v72, v0, v2, s72 bitop3:0x7e
  s_waitcnt vmcnt(2)
  v_mfma_f32_16x16x32_bf16 v[56:59], v[52:55], v[4:7], v[56:59]
  v_bitop3_b32 v73, v4, v6, s72 bitop3:0x7e
  v_or_b32 v72, v72, v73
  s_waitcnt vmcnt(1)
  v_mfma_f32_16x16x32_bf16 v[36:39], v[52:55], v[8:11], 0
  v_bitop3_b32 v73, v8, v10, s72 bitop3:0x7e
  v_or_b32 v72, v72, v73
  s_waitcnt vmcnt(0)
  v_mfma_f32_16x16x32_bf16 v[36:39], v[52:55], v[12:15], v[36:39]
  v_bitop3_b32 v73, v12, v14, s72 bitop3:0x7e
  v_bitop3_b32 v72, v72, v73, 1 bitop3:0xa8
  v_cmp_ne_u32 vcc, 0, v72
  s_cbranch_vccz Cs3_h1p
  s_cmp_lt_u32 s67, 131072
  s_cbranch_scc1 Cs3_h1s
Cs3_h1p:
  s_nop 2
  v_add_f32_dpp v56, v56, v56 row_ror:4 row_mask:0xf bank_mask:0xf
  v_add_f32_dpp v57, v57, v57 row_ror:4 row_mask:0xf bank_mask:0xf
  v_add_f32_dpp v36, v36, v36 row_ror:4 row_mask:0xf bank_mask:0xf
  v_add_f32_dpp v37, v37, v37 row_ror:4 row_mask:0xf bank_mask:0xf
  v_add_f32_dpp v56, v56, v56 row_ror:8 row_mask:0xf bank_mask:0xf
  v_add_f32_dpp v57, v57, v57 row_ror:8 row_mask:0xf bank_mask:0xf
  v_add_f32_dpp v36, v36, v36 row_ror:8 row_mask:0xf bank_mask:0xf
  v_add_f32_dpp v37, v37, v37 row_ror:8 row_mask:0xf bank_mask:0xf
  v_cvt_pk_bf16_f32 v56, v56, v57
  buffer_store_dword v56, v69, s[8:11], s62 offen sc1
  v_cvt_pk_bf16_f32 v36, v36, v37
  buffer_store_dword v36, v70, s[8:11], s63 offen sc1
  s_xor_b32 s62, s62, 16384
  buffer_store_dword v71, v69, s[8:11], s62 offen sc1
  s_xor_b32 s63, s63, 16384
  buffer_store_dword v71, v70, s[8:11], s63 offen sc1
  s_xor_b32 s72, s72, 1
  s_branch Cs3_h2
Cs3_rec:
  s_nop 7
  s_waitcnt vmcnt(0) lgkmcnt(0)
  v_max3_u32 v72, v0, v1, v2
  v_max3_u32 v72, v72, v3, v4
  v_max3_u32 v72, v72, v5, v6
  v_max3_u32 v72, v72, v7, v8
  v_max3_u32 v72, v72, v9, v10
  v_max3_u32 v72, v72, v11, v12
  v_max3_u32 v72, v72, v13, v14
  v_max3_u32 v72, v72, v15, v16
  v_max3_u32 v72, v72, v17, v18
  v_max_u32 v72, v72, v19
  v_cmp_eq_u32 vcc, -1, v72
  s_cbranch_vccz Cs3_recok
  s_barrier
Cs3_recp:
  buffer_load_dwordx4 v[0:3], v76, s[8:11], s64 offen offset:0 sc1
  buffer_load_dwordx4 v[4:7], v76, s[8:11], s64 offen offset:1024 sc1
  buffer_load_dwordx4 v[8:11], v76, s[8:11], s64 offen offset:2048 sc1
  s_add_u32 s67, s67, 1
  s_cmp_lt_u32 s67, 131072
  s_cselect_b32 s54, -2, -1
  s_waitcnt vmcnt(2)
  v_max3_u32 v72, v0, v1, v2
  s_waitcnt vmcnt(1)
  v_max3_u32 v72, v72, v3, v4
  v_max3_u32 v72, v72, v5, v6
  s_waitcnt vmcnt(0)
  v_max3_u32 v72, v72, v7, v8
  v_max3_u32 v72, v72, v9, v10
  v_max_u32 v72, v72, v11
  v_cmp_lt_u32 vcc, s54, v72
  s_cbranch_vccnz Cs3_recp
  ds_write_b128 v76, v[0:3] offset:10752
  ds_write_b128 v76, v[4:7] offset:11776
  ds_write_b128 v76, v[8:11] offset:12800
  v_mov_b64 v[20:21], 0
  v_mov_b64 v[22:23], 0
  v_mov_b64 v[24:25], 0
  v_mov_b64 v[26:27], 0
  v_mov_b64 v[28:29], 0
  v_mov_b64 v[30:31], 0
  v_mov_b64 v[32:33], 0
  v_mov_b64 v[34:35], 0
  s_waitcnt lgkmcnt(0)
  s_barrier
  ds_read_b128 v[0:3], v76 offset:4608
  s_waitcnt lgkmcnt(0)
  v_smfmac_f32_16x16x64_bf16 v[20:23], v[0:3], v[80:87], v74
  v_smfmac_f32_16x16x64_bf16 v[24:27], v[0:3], v[88:95], v74
  ds_read_b128 v[60:63], v76 offset:28672
  ds_read_b128 v[64:67], v76 offset:29696
  s_waitcnt lgkmcnt(0)
  v_smfmac_f32_16x16x64_bf16 v[28:31], v[0:3], v[60:67], v74
  ds_read_b128 v[60:63], v76 offset:30720
  ds_read_b128 v[64:67], v76 offset:31744
  s_waitcnt lgkmcnt(0)
  v_smfmac_f32_16x16x64_bf16 v[32:35], v[0:3], v[60:67], v74
  ds_read_b128 v[4:7], v76 offset:5632
  s_waitcnt lgkmcnt(0)
  v_smfmac_f32_16x16x64_bf16 v[20:23], v[4:7], v[96:103], v74
  v_smfmac_f32_16x16x64_bf16 v[24:27], v[4:7], v[104:111], v74
  ds_read_b128 v[60:63], v76 offset:45056
  ds_read_b128 v[64:67], v76 offset:46080
  s_waitcnt lgkmcnt(0)
  v_smfmac_f32_16x16x64_bf16 v[28:31], v[4:7], v[60:67], v74
  ds_read_b128 v[60:63], v76 offset:47104
  ds_read_b128 v[64:67], v76 offset:48128
  s_waitcnt lgkmcnt(0)
  v_smfmac_f32_16x16x64_bf16 v[32:35], v[4:7], v[60:67], v74
  ds_read_b128 v[8:11], v76 offset:6656
  s_waitcnt lgkmcnt(0)
  v_smfmac_f32_16x16x64_bf16 v[20:23], v[8:11], v[112:119], v74
  v_smfmac_f32_16x16x64_bf16 v[24:27], v[8:11], v[120:127], v74
  v_smfmac_f32_16x16x64_bf16 v[28:31], v[8:11], v[208:215], v74
  v_smfmac_f32_16x16x64_bf16 v[32:35], v[8:11], v[216:223], v74
  ds_read_b128 v[12:15], v76 offset:7680
  s_waitcnt lgkmcnt(0)
  v_smfmac_f32_16x16x64_bf16 v[20:23], v[12:15], v[128:135], v74
  v_smfmac_f32_16x16x64_bf16 v[24:27], v[12:15], v[136:143], v74
  v_smfmac_f32_16x16x64_bf16 v[28:31], v[12:15], v[224:231], v74
  v_smfmac_f32_16x16x64_bf16 v[32:35], v[12:15], v[232:239], v74
  ds_read_b128 v[4:7], v76 offset:8704
  s_waitcnt lgkmcnt(0)
  v_smfmac_f32_16x16x64_bf16 v[20:23], v[4:7], v[144:151], v74
  v_smfmac_f32_16x16x64_bf16 v[24:27], v[4:7], v[152:159], v74
  ds_read_b128 v[60:63], v76 offset:61440
  ds_read_b128 v[64:67], v76 offset:62464
  s_waitcnt lgkmcnt(0)
  v_smfmac_f32_16x16x64_bf16 v[28:31], v[4:7], v[60:67], v74
  ds_read_b128 v[60:63], v76 offset:63488
  ds_read_b128 v[64:67], v76 offset:64512
  s_waitcnt lgkmcnt(0)
  v_smfmac_f32_16x16x64_bf16 v[32:35], v[4:7], v[60:67], v74
  ds_read_b128 v[8:11], v76 offset:9728
  s_waitcnt lgkmcnt(0)
  v_smfmac_f32_16x16x64_bf16 v[20:23], v[8:11], v[160:167], v74
  v_smfmac_f32_16x16x64_bf16 v[24:27], v[8:11], v[168:175], v74
  ds_read_b128 v[60:63], v75 offset:28672
  ds_read_b128 v[64:67], v75 offset:29696
  s_waitcnt lgkmcnt(0)
  v_smfmac_f32_16x16x64_bf16 v[28:31], v[8:11], v[60:67], v74
  ds_read_b128 v[60:63], v75 offset:30720
  ds_read_b128 v[64:67], v75 offset:31744
  s_waitcnt lgkmcnt(0)
  v_smfmac_f32_16x16x64_bf16 v[32:35], v[8:11], v[60:67], v74
  ds_read_b128 v[16:19], v76 offset:10752
  ds_read_b128 v[60:63], v75 offset:12288
  ds_read_b128 v[64:67], v75 offset:13312
  s_waitcnt lgkmcnt(0)
  v_smfmac_f32_16x16x64_bf16 v[20:23], v[16:19], v[60:67], v74
  ds_read_b128 v[60:63], v75 offset:14336
  ds_read_b128 v[64:67], v75 offset:15360
  s_waitcnt lgkmcnt(0)
  v_smfmac_f32_16x16x64_bf16 v[24:27], v[16:19], v[60:67], v74
  v_smfmac_f32_16x16x64_bf16 v[28:31], v[16:19], v[240:247], v74
  v_smfmac_f32_16x16x64_bf16 v[32:35], v[16:19], v[248:255], v74
  ds_read_b128 v[0:3], v76 offset:11776
  s_waitcnt lgkmcnt(0)
  v_smfmac_f32_16x16x64_bf16 v[20:23], v[0:3], v[176:183], v74
  v_smfmac_f32_16x16x64_bf16 v[24:27], v[0:3], v[184:191], v74
  v_smfmac_f32_16x16x64_bf16 v[28:31], v[0:3], a[0:7], v74
  v_smfmac_f32_16x16x64_bf16 v[32:35], v[0:3], a[8:15], v74
  ds_read_b128 v[12:15], v76 offset:12800
  s_waitcnt lgkmcnt(0)
  v_smfmac_f32_16x16x64_bf16 v[20:23], v[12:15], v[192:199], v74
  v_smfmac_f32_16x16x64_bf16 v[24:27], v[12:15], v[200:207], v74
  v_smfmac_f32_16x16x64_bf16 v[28:31], v[12:15], a[16:23], v74
  v_smfmac_f32_16x16x64_bf16 v[32:35], v[12:15], a[24:31], v74
  v_add_f32 v20, v20, v22
  v_add_f32 v21, v21, v23
  v_add_f32 v24, v24, v26
  v_cvt_pk_bf16_f32 v22, v20, v24
  ds_write_b32 v79, v22 offset:0
  v_add_f32 v25, v25, v27
  v_cvt_pk_bf16_f32 v23, v21, v25
  ds_write_b32 v79, v23 offset:576
  v_add_f32 v28, v28, v30
  v_add_f32 v29, v29, v31
  s_waitcnt lgkmcnt(0)
  s_nop 1
  s_branch Cs3_recok
Cs3_mx:
  s_waitcnt lgkmcnt(0)
  s_barrier
  buffer_load_dwordx4 v[52:55], v76, s[8:11], s59 offen offset:0 sc1
  buffer_load_dwordx4 v[0:3], v76, s[8:11], s58 offen offset:0 sc1
  ds_read_b128 v[20:23], v77 offset:0
  ds_read_b128 v[28:31], v77 offset:256
  buffer_load_dwordx4 v[56:59], v76, s[8:11], s59 offen offset:1024 sc1
  buffer_load_dwordx4 v[4:7], v76, s[8:11], s58 offen offset:1024 sc1
  ds_read_b128 v[24:27], v77 offset:128
  ds_read_b128 v[32:35], v77 offset:384
  s_waitcnt vmcnt(2) lgkmcnt(3)
  v_mfma_f32_16x16x32_bf16 v[8:11], v[0:3], v[20:23], 0
  s_waitcnt vmcnt(0) lgkmcnt(1)
  v_mfma_f32_16x16x32_bf16 v[8:11], v[4:7], v[24:27], v[8:11]
  v_mfma_f32_16x16x32_bf16 v[12:15], v[28:31], v[20:23], 0
  s_waitcnt lgkmcnt(0)
  v_mfma_f32_16x16x32_bf16 v[12:15], v[32:35], v[24:27], v[12:15]
  v_add_f32_dpp v8, v10, v8 quad_perm:[2,3,0,1] row_mask:0xf bank_mask:0xf
  v_add_f32_dpp v9, v11, v9 quad_perm:[2,3,0,1] row_mask:0xf bank_mask:0xf
  s_nop 0
  v_mov_b32_dpp v8, v8 quad_perm:[0,1,0,1] row_mask:0xf bank_mask:0xf
  v_mov_b32_dpp v9, v9 quad_perm:[0,1,0,1] row_mask:0xf bank_mask:0xf
  s_nop 1
  v_add_f32_dpp v12, v14, v12 quad_perm:[2,3,0,1] row_mask:0xf bank_mask:0xf
  v_add_f32_dpp v13, v15, v13 quad_perm:[2,3,0,1] row_mask:0xf bank_mask:0xf
  s_nop 0
  v_mov_b32_dpp v12, v12 quad_perm:[0,1,0,1] row_mask:0xf bank_mask:0xf
  v_mov_b32_dpp v13, v13 quad_perm:[0,1,0,1] row_mask:0xf bank_mask:0xf
  v_mul_f32 v12, s69, v12
  ds_write_b32 v78, v8 offset:8716
  v_mul_f32 v13, s69, v13
  ds_write_b32 v78, v9 offset:8780
  s_waitcnt lgkmcnt(0)
  s_barrier
  ds_read_b128 v[36:39], v78 offset:8704
  ds_read_b128 v[40:43], v78 offset:8768
  s_waitcnt lgkmcnt(0)
  s_barrier
  v_max_f32 v16, v36, v37
  v_max3_f32 v16, v16, v38, v39
  v_max3_f32 v16, v16, v40, v41
  v_max3_f32 v16, v16, v42, v43
  v_max3_f32 v16, v16, v12, v13
  v_mov_b32 v17, v16
  s_nop 1
  v_permlane16_swap_b32 v16, v17
  v_max_f32 v16, v16, v17
  v_mov_b32 v17, v16
  s_nop 1
  v_permlane32_swap_b32 v16, v17
  v_max_f32 v16, v16, v17
  v_sub_f32 v36, v36, v16
  v_sub_f32 v37, v37, v16
  v_sub_f32 v38, v38, v16
  v_sub_f32 v39, v39, v16
  v_sub_f32 v40, v40, v16
  v_sub_f32 v41, v41, v16
  v_sub_f32 v42, v42, v16
  v_sub_f32 v43, v43, v16
  v_sub_f32 v12, v12, v16
  v_sub_f32 v13, v13, v16
  v_exp_f32 v36, v36
  v_exp_f32 v37, v37
  v_exp_f32 v38, v38
  v_exp_f32 v39, v39
  v_exp_f32 v40, v40
  v_exp_f32 v41, v41
  v_exp_f32 v42, v42
  v_exp_f32 v43, v43
  v_exp_f32 v12, v12
  v_exp_f32 v13, v13
  v_cvt_pk_bf16_f32 v32, v36, v40
  v_cvt_pk_bf16_f32 v33, v37, v41
  v_cvt_pk_bf16_f32 v34, v38, v42
  v_cvt_pk_bf16_f32 v35, v39, v43
  v_cvt_pk_bf16_f32 v28, v12, v13
  v_cvt_pk_bf16_f32 v31, v12, v13
  v_mov_b32 v29, 0
  v_mov_b32 v30, 0
  v_mfma_f32_16x16x32_bf16 v[8:11], v[32:35], v[68:71], 0
  v_mfma_f32_16x16x32_bf16 v[0:3], v[32:35], v[52:55], 0
  v_mfma_f32_16x16x32_bf16 v[4:7], v[32:35], v[56:59], 0
  v_mfma_f32_16x16x16_bf16 v[8:11], v[28:29], v[68:69], v[8:11]
  v_mfma_f32_16x16x16_bf16 v[0:3], v[28:29], v[72:73], v[0:3]
  v_mfma_f32_16x16x16_bf16 v[4:7], v[30:31], v[72:73], v[4:7]
  ds_read_b128 v[52:55], v75 offset:30720
  v_rcp_f32 v10, v8
  v_rcp_f32 v11, v9
  v_mul_f32 v0, v10, v0
  v_mul_f32 v1, v11, v1
  v_max3_f32 v8, v8, v9, v10
  v_mul_f32 v4, v10, v4
  v_mul_f32 v5, v11, v5
  v_cvt_pk_bf16_f32 v2, v0, v4
  ds_write_b32 v79, v2 offset:8704
  v_cvt_pk_bf16_f32 v3, v1, v5
  ds_write_b32 v79, v3 offset:9280
  ds_read_b128 v[12:15], v78 offset:8896
  ds_read_b128 v[56:59], v75 offset:31744
  v_mov_b64 v[16:17], 0
  v_mov_b64 v[18:19], 0
  v_mov_b64 v[20:21], 0
  v_mov_b64 v[22:23], 0
  v_mov_b64 v[24:25], 0
  v_mov_b64 v[26:27], 0
  s_branch Cs3_mxok
Cs3_last:
  ds_read_b128 v[0:3], v76 offset:4608
  ds_read_b128 v[12:15], v76 offset:7680
  ds_read_b128 v[44:47], v76 offset:28672
  ds_read_b128 v[48:51], v76 offset:29696
  s_nop 5
  v_mov_b64 v[20:21], 0
  v_mov_b64 v[22:23], 0
  v_mov_b64 v[24:25], 0
  v_mov_b64 v[26:27], 0
  v_smfmac_f32_16x16x64_bf16 v[28:31], v[4:7], v[36:43], v74
  ds_read_b128 v[36:39], v76 offset:30720
  ds_read_b128 v[40:43], v76 offset:31744
  v_smfmac_f32_16x16x64_bf16 v[32:35], v[4:7], v[60:67], v74
  s_waitcnt lgkmcnt(5)
  v_smfmac_f32_16x16x64_bf16 v[20:23], v[0:3], a[32:39], v74
  ds_read_b128 v[60:63], v76 offset:61440
  ds_read_b128 v[64:67], v76 offset:62464
  v_smfmac_f32_16x16x64_bf16 v[24:27], v[0:3], a[40:47], v74
  s_waitcnt lgkmcnt(4)
  v_smfmac_f32_16x16x64_bf16 v[20:23], v[4:7], a[48:55], v74
  buffer_store_dwordx4 v[16:19], v76, s[8:11], s68 offen sc1
  v_smfmac_f32_16x16x64_bf16 v[24:27], v[4:7], a[56:63], v74
  v_smfmac_f32_16x16x64_bf16 v[28:31], v[0:3], v[44:51], v74
  s_waitcnt lgkmcnt(2)
  v_smfmac_f32_16x16x64_bf16 v[20:23], v[8:11], a[64:71], v74
  ds_read_b128 v[44:47], v76 offset:63488
  ds_read_b128 v[48:51], v76 offset:64512
  v_smfmac_f32_16x16x64_bf16 v[24:27], v[8:11], a[72:79], v74
  v_smfmac_f32_16x16x64_bf16 v[32:35], v[0:3], v[36:43], v74
  v_smfmac_f32_16x16x64_bf16 v[28:31], v[8:11], v[208:215], v74
  ds_read_b128 v[36:39], v75 offset:28672
  ds_read_b128 v[40:43], v75 offset:29696
  v_smfmac_f32_16x16x64_bf16 v[32:35], v[8:11], v[216:223], v74
  v_smfmac_f32_16x16x64_bf16 v[20:23], v[12:15], a[80:87], v74
  v_smfmac_f32_16x16x64_bf16 v[24:27], v[12:15], a[88:95], v74
  v_smfmac_f32_16x16x64_bf16 v[28:31], v[12:15], v[224:231], v74
  v_smfmac_f32_16x16x64_bf16 v[32:35], v[12:15], v[232:239], v74
  s_waitcnt vmcnt(1)
  s_barrier
Cs3_lastr:
  ds_read_b128 v[4:7], v76 offset:8704
  ds_read_b128 v[8:11], v76 offset:9728
  ds_read_b128 v[16:19], v76 offset:10752
  ds_read_b128 v[0:3], v76 offset:11776
  ds_read_b128 v[12:15], v76 offset:12800
  s_waitcnt lgkmcnt(1)
  v_max3_u32 v72, v0, v1, v2
  v_max3_u32 v72, v72, v3, v4
  v_max3_u32 v72, v72, v5, v6
  v_max3_u32 v72, v72, v7, v8
  v_max3_u32 v72, v72, v9, v10
  s_waitcnt lgkmcnt(0)
  v_max3_u32 v72, v72, v11, v12
  v_max3_u32 v72, v72, v13, v14
  v_max3_u32 v72, v72, v15, v16
  v_max3_u32 v72, v72, v17, v18
  v_max_u32 v72, v72, v19
  v_cmp_eq_u32 vcc, -1, v72
  s_cbranch_vccnz Cs3_lastp
Cs3_lastg:
  v_smfmac_f32_16x16x64_bf16 v[28:31], v[4:7], v[60:67], v74
  ds_read_b128 v[60:63], v75 offset:30720
  ds_read_b128 v[64:67], v75 offset:31744
  v_smfmac_f32_16x16x64_bf16 v[32:35], v[4:7], v[44:51], v74
  v_smfmac_f32_16x16x64_bf16 v[28:31], v[8:11], v[36:43], v74
  v_smfmac_f32_16x16x64_bf16 v[28:31], v[16:19], v[240:247], v74
  v_smfmac_f32_16x16x64_bf16 v[28:31], v[0:3], a[0:7], v74
  v_smfmac_f32_16x16x64_bf16 v[28:31], v[12:15], a[16:23], v74
  v_smfmac_f32_16x16x64_bf16 v[32:35], v[16:19], v[248:255], v74
  v_smfmac_f32_16x16x64_bf16 v[32:35], v[0:3], a[8:15], v74
  s_waitcnt lgkmcnt(0)
  v_smfmac_f32_16x16x64_bf16 v[32:35], v[12:15], a[24:31], v74
  v_smfmac_f32_16x16x64_bf16 v[32:35], v[8:11], v[60:67], v74
  v_smfmac_f32_16x16x64_bf16 v[20:23], v[4:7], a[96:103], v74
  v_smfmac_f32_16x16x64_bf16 v[20:23], v[8:11], a[112:119], v74
  v_add_f32 v28, v28, v30
  v_add_f32 v32, v32, v34
  v_cvt_pk_bf16_f32 v30, v28, v32
  v_smfmac_f32_16x16x64_bf16 v[20:23], v[16:19], a[128:135], v74
  ds_write_b32 v79, v30 offset:256
  v_add_f32 v29, v29, v31
  v_add_f32 v33, v33, v35
  v_cvt_pk_bf16_f32 v31, v29, v33
  v_smfmac_f32_16x16x64_bf16 v[20:23], v[0:3], a[144:151], v74
  ds_write_b32 v79, v31 offset:832
  v_smfmac_f32_16x16x64_bf16 v[20:23], v[12:15], a[160:167], v74
  v_smfmac_f32_16x16x64_bf16 v[24:27], v[4:7], a[104:111], v74
  v_smfmac_f32_16x16x64_bf16 v[24:27], v[8:11], a[120:127], v74
  v_smfmac_f32_16x16x64_bf16 v[24:27], v[16:19], a[136:143], v74
  s_waitcnt lgkmcnt(0)
  s_barrier
  ds_read_b64 v[52:53], v77 offset:392
  v_add_f32 v20, v20, v22
  v_smfmac_f32_16x16x64_bf16 v[24:27], v[0:3], a[152:159], v74
  v_add_f32 v21, v21, v23
  v_smfmac_f32_16x16x64_bf16 v[24:27], v[12:15], a[168:175], v74
  v_cvt_pk_bf16_f32 v54, v20, v21
  s_add_u32 s68, s68, 655360
  s_nop 3
  v_add_f32 v24, v24, v26
  v_add_f32 v25, v25, v27
  v_cvt_pk_bf16_f32 v55, v24, v25
  s_waitcnt lgkmcnt(0)
  buffer_store_dwordx4 v[52:55], v76, s[8:11], s68 offen sc1
  s_branch Cs3_done
Cs3_lastp:
  s_add_u32 s72, s72, 2
  s_cmp_ge_u32 s72, 131072
  s_cbranch_scc1 Cs3_lastg
  s_barrier
  buffer_load_dwordx4 v76, s[8:11], s85 offen offset:0 sc1 lds
  buffer_load_dwordx4 v76, s[8:11], s85 offen offset:1024 sc1 lds
  s_waitcnt vmcnt(0)
  s_barrier
  s_branch Cs3_lastr
Cs3_done:
  s_branch L_cexit
L_conf:
  s_nop 11
  s_waitcnt vmcnt(0) lgkmcnt(0)
  s_barrier
  s_cmp_eq_u32 s52, 0
  s_cbranch_scc0 L_cf2
  s_mov_b64 exec, 1
  s_lshl_b32 s57, s2, 2
  v_mov_b32 v1, 0
L_cf0:
  s_cmp_eq_u32 s54, -1
  s_cbranch_scc1 L_cf1
  s_mov_b32 s55, s54
  s_lshr_b64 s[54:55], s[54:55], s0
  s_ff0_i32_b32 s56, s54
  s_add_u32 s0, s0, s56
  s_and_b32 s0, s0, 31
  s_lshl_b32 s56, 1, s0
  v_mov_b32 v35, s56
  buffer_atomic_or v35, v1, s[12:15], s57 offen sc0
  s_waitcnt vmcnt(0)
  v_readfirstlane_b32 s54, v35
  s_nop 0
  s_bitcmp1_b32 s54, s0
  s_cbranch_scc1 L_cf0
  v_mov_b32 v35, s0
  s_branch L_cf3
L_cf1:
  v_mov_b32 v35, 1
  buffer_atomic_add v35, v1, s[12:15], 0 offen offset:40 sc0
  s_waitcnt vmcnt(0)
  v_add_u32 v35, 32, v35
L_cf3:
  ds_write_b32 v33, v35
  s_mov_b64 exec, -1
  s_waitcnt lgkmcnt(0)
L_cf2:
  s_barrier
  ds_read_b32 v32, v33
  s_waitcnt lgkmcnt(0)
  v_readfirstlane_b32 s0, v32
  v_mbcnt_lo_u32_b32 v0, -1, 0
  v_mbcnt_hi_u32_b32 v0, -1, v0
  s_mov_b32 s1, 1
  s_cmp_lt_u32 s0, 32
  s_cbranch_scc1 L_role
  s_sub_u32 s53, s0, 32
  s_mov_b32 s57, 0
L_sur:
  s_load_dwordx16 s[60:75], s[12:13], 0 glc
  s_add_u32 s57, s57, 1
  s_waitcnt lgkmcnt(0)
  s_mov_b32 s55, s70
  s_bcnt1_i32_b32 s56, s60
  s_add_u32 s55, s55, s56
  s_bcnt1_i32_b32 s56, s61
  s_add_u32 s55, s55, s56
  s_bcnt1_i32_b32 s56, s62
  s_add_u32 s55, s55, s56
  s_bcnt1_i32_b32 s56, s63
  s_add_u32 s55, s55, s56
  s_bcnt1_i32_b32 s56, s64
  s_add_u32 s55, s55, s56
  s_bcnt1_i32_b32 s56, s65
  s_add_u32 s55, s55, s56
  s_bcnt1_i32_b32 s56, s66
  s_add_u32 s55, s55, s56
  s_bcnt1_i32_b32 s56, s67
  s_add_u32 s55, s55, s56
  s_cmp_ge_u32 s57, 131072
  s_cbranch_scc1 L_end
  s_cmp_lt_u32 s55, 256
  s_cbranch_scc1 L_sur
  s_mov_b32 s2, 0
  s_mov_b32 s54, s60
  s_bcnt0_i32_b32 s56, s54
  s_cmp_lt_u32 s53, s56
  s_cbranch_scc1 L_sur2
  s_sub_u32 s53, s53, s56
  s_mov_b32 s2, 1
  s_mov_b32 s54, s61
  s_bcnt0_i32_b32 s56, s54
  s_cmp_lt_u32 s53, s56
  s_cbranch_scc1 L_sur2
  s_sub_u32 s53, s53, s56
  s_mov_b32 s2, 2
  s_mov_b32 s54, s62
  s_bcnt0_i32_b32 s56, s54
  s_cmp_lt_u32 s53, s56
  s_cbranch_scc1 L_sur2
  s_sub_u32 s53, s53, s56
  s_mov_b32 s2, 3
  s_mov_b32 s54, s63
  s_bcnt0_i32_b32 s56, s54
  s_cmp_lt_u32 s53, s56
  s_cbranch_scc1 L_sur2
  s_sub_u32 s53, s53, s56
  s_mov_b32 s2, 4
  s_mov_b32 s54, s64
  s_bcnt0_i32_b32 s56, s54
  s_cmp_lt_u32 s53, s56
  s_cbranch_scc1 L_sur2
  s_sub_u32 s53, s53, s56
  s_mov_b32 s2, 5
  s_mov_b32 s54, s65
  s_bcnt0_i32_b32 s56, s54
  s_cmp_lt_u32 s53, s56
  s_cbranch_scc1 L_sur2
  s_sub_u32 s53, s53, s56
  s_mov_b32 s2, 6
  s_mov_b32 s54, s66
  s_bcnt0_i32_b32 s56, s54
  s_cmp_lt_u32 s53, s56
  s_cbranch_scc1 L_sur2
  s_sub_u32 s53, s53, s56
  s_mov_b32 s2, 7
  s_mov_b32 s54, s67
  s_bcnt0_i32_b32 s56, s54
  s_cmp_lt_u32 s53, s56
  s_cbranch_scc1 L_sur2
  s_sub_u32 s53, s53, s56
  s_branch L_end
L_sur2:
  s_ff0_i32_b32 s0, s54
  s_bitset1_b32 s54, s0
  s_sub_u32 s53, s53, 1
  s_cbranch_scc0 L_sur2
  s_branch L_role
L_worker:
  s_lshl_b32 s54, s2, 2
  s_lshr_b32 s54, 1412567136, s54
  s_and_b32 s54, s54, 7
  s_lshl_b32 s54, s54, 5
  s_add_u32 s53, s53, s54
  s_getpc_b64 s[80:81]
L_pc_2:
  s_and_b32 s55, s0, 1
  s_lshl_b32 s55, s55, 2
  s_add_u32 s55, s55, s52
  s_lshl_b32 s55, s55, 13
  v_and_b32 v199, 63, v0
  v_lshl_add_u32 v199, v199, 7, s55
  s_sub_u32 s82, s80, (L_pc_2 - L_w0)
  s_subb_u32 s83, s81, 0
  v_min_u32 v198, (L_w4 - L_w0), v199
  global_load_dword v196, v198, s[82:83]
  v_min_u32 v199, (L_end - L_pc_2), v199
  global_load_dword v196, v199, s[80:81]
  v_and_b32 v200, 63, v0
  v_lshlrev_b32 v201, 4, v200
  v_lshrrev_b32 v211, 3, v200
  s_lshl_b32 s54, s52, 3
  v_add_u32 v211, s54, v211
  v_bfe_u32 v212, v211, 1, 3
  v_and_b32 v213, 7, v200
  v_xor_b32 v212, v212, v213
  v_mul_u32_u24 v211, 1152, v211
  v_lshl_add_u32 v202, v212, 4, v211
  s_mul_i32 s67, s52, 9216
  v_and_b32 v211, 31, v200
  v_lshrrev_b32 v212, 3, v211
  v_mul_u32_u24 v212, 9216, v212
  v_and_b32 v213, 7, v211
  v_lshl_add_u32 v212, v213, 7, v212
  v_bfe_u32 v213, v211, 1, 3
  v_lshrrev_b32 v214, 5, v200
  v_xor_b32 v213, v213, v214
  v_lshl_add_u32 v203, v213, 4, v212
  v_xor_b32 v204, 32, v203
  v_xor_b32 v205, 64, v203
  v_xor_b32 v206, 0x60, v203
  v_bfe_u32 v211, v200, 2, 2
  v_lshl_add_u32 v212, v214, 3, v211
  v_lshlrev_b32 v212, 8, v212
  v_xor_b32 v211, s52, v211
  v_lshl_add_u32 v212, v211, 6, v212
  v_bfe_u32 v213, v200, 4, 1
  v_and_b32 v211, 3, v200
  v_lshl_add_u32 v210, v213, 5, v212
  v_lshl_add_u32 v210, v211, 3, v210
  v_lshl_add_u32 v209, v213, 4, v212
  v_and_b32 v213, 1, v211
  v_lshl_add_u32 v209, v213, 3, v209
  v_lshrrev_b32 v213, 1, v211
  v_lshl_add_u32 v209, v213, 5, v209
  s_mov_b32 s65, 0
  s_mul_i32 s58, s53, 9363
  s_lshr_b32 s58, s58, 16
  s_mul_i32 s54, s58, 7
  s_sub_u32 s59, s53, s54
  s_mul_i32 s60, s59, 36864
  s_add_u32 m0, s67, 0
  s_nop 0
  buffer_load_dwordx4 v202, s[4:7], s60 offen offset:0 lds
  s_add_u32 m0, s67, 896
  s_nop 0
  buffer_load_dwordx4 v202, s[4:7], s60 offen offset:128 lds
  s_add_u32 m0, s67, 1792
  s_nop 0
  buffer_load_dwordx4 v202, s[4:7], s60 offen offset:256 lds
  s_add_u32 m0, s67, 2688
  s_nop 0
  buffer_load_dwordx4 v202, s[4:7], s60 offen offset:384 lds
  s_add_u32 m0, s67, 3584
  s_nop 0
  buffer_load_dwordx4 v202, s[4:7], s60 offen offset:512 lds
  s_add_u32 m0, s67, 4480
  s_nop 0
  buffer_load_dwordx4 v202, s[4:7], s60 offen offset:640 lds
  s_add_u32 m0, s67, 5376
  s_nop 0
  buffer_load_dwordx4 v202, s[4:7], s60 offen offset:768 lds
  s_add_u32 m0, s67, 6272
  s_nop 0
  buffer_load_dwordx4 v202, s[4:7], s60 offen offset:896 lds
  s_add_u32 m0, s67, 7168
  s_nop 0
  buffer_load_dwordx4 v202, s[4:7], s60 offen offset:1024 lds
  v_lshrrev_b32 v211, 4, v200
  v_lshlrev_b32 v212, 2, v211
  v_and_b32 v213, 15, v200
  v_xor_b32 v212, v212, v213
  v_lshlrev_b32 v212, 4, v212
  v_lshl_add_u32 v207, v211, 13, v212
  s_lshl_b32 s62, s58, 8
  s_lshl_b32 s54, s52, 15
  s_add_u32 s62, s62, s54
  s_lshl_b32 s61, s52, 10
  s_add_u32 s61, s61, 36864
  s_add_u32 m0, s61, 0
  s_add_u32 s54, s62, 0
  buffer_load_dwordx4 v207, s[20:23], s54 offen lds
  s_add_u32 m0, s61, 4096
  s_add_u32 s54, s62, 131072
  buffer_load_dwordx4 v207, s[20:23], s54 offen lds
  s_add_u32 m0, s61, 8192
  s_add_u32 s54, s62, 262144
  buffer_load_dwordx4 v207, s[20:23], s54 offen lds
  s_add_u32 m0, s61, 12288
  s_add_u32 s54, s62, 393216
  buffer_load_dwordx4 v207, s[20:23], s54 offen lds
  s_add_u32 m0, s61, 16384
  s_add_u32 s54, s62, 0
  buffer_load_dwordx4 v207, s[24:27], s54 offen lds
  s_add_u32 m0, s61, 20480
  s_add_u32 s54, s62, 131072
  buffer_load_dwordx4 v207, s[24:27], s54 offen lds
  s_add_u32 m0, s61, 24576
  s_add_u32 s54, s62, 262144
  buffer_load_dwordx4 v207, s[24:27], s54 offen lds
  s_add_u32 m0, s61, 28672
  s_add_u32 s54, s62, 393216
  buffer_load_dwordx4 v207, s[24:27], s54 offen lds
  s_add_u32 m0, s61, 32768
  s_add_u32 s54, s62, 524288
  buffer_load_dwordx4 v207, s[20:23], s54 offen lds
  s_add_u32 m0, s61, 36864
  s_add_u32 s54, s62, 655360
  buffer_load_dwordx4 v207, s[20:23], s54 offen lds
  s_add_u32 m0, s61, 40960
  s_add_u32 s54, s62, 786432
  buffer_load_dwordx4 v207, s[20:23], s54 offen lds
  s_add_u32 m0, s61, 45056
  s_add_u32 s54, s62, 917504
  buffer_load_dwordx4 v207, s[20:23], s54 offen lds
  s_add_u32 m0, s61, 49152
  s_add_u32 s54, s62, 524288
  buffer_load_dwordx4 v207, s[24:27], s54 offen lds
  s_add_u32 m0, s61, 53248
  s_add_u32 s54, s62, 655360
  buffer_load_dwordx4 v207, s[24:27], s54 offen lds
  s_add_u32 m0, s61, 57344
  s_add_u32 s54, s62, 786432
  buffer_load_dwordx4 v207, s[24:27], s54 offen lds
  s_add_u32 m0, s61, 61440
  s_add_u32 s54, s62, 917504
  buffer_load_dwordx4 v207, s[24:27], s54 offen lds
  s_add_u32 m0, s61, 65536
  s_add_u32 s54, s62, 1048576
  buffer_load_dwordx4 v207, s[20:23], s54 offen lds
  s_add_u32 m0, s61, 69632
  s_add_u32 s54, s62, 1179648
  buffer_load_dwordx4 v207, s[20:23], s54 offen lds
  s_add_u32 m0, s61, 73728
  s_add_u32 s54, s62, 1310720
  buffer_load_dwordx4 v207, s[20:23], s54 offen lds
  s_add_u32 m0, s61, 77824
  s_add_u32 s54, s62, 1441792
  buffer_load_dwordx4 v207, s[20:23], s54 offen lds
  s_add_u32 m0, s61, 81920
  s_add_u32 s54, s62, 1048576
  buffer_load_dwordx4 v207, s[24:27], s54 offen lds
  s_add_u32 m0, s61, 86016
  s_add_u32 s54, s62, 1179648
  buffer_load_dwordx4 v207, s[24:27], s54 offen lds
  s_add_u32 m0, s61, 90112
  s_add_u32 s54, s62, 1310720
  buffer_load_dwordx4 v207, s[24:27], s54 offen lds
  s_add_u32 m0, s61, 94208
  s_add_u32 s54, s62, 1441792
  buffer_load_dwordx4 v207, s[24:27], s54 offen lds
  v_bfe_u32 v211, v200, 3, 2
  v_lshlrev_b32 v216, 11, v211
  v_bfe_u32 v211, v200, 1, 2
  v_lshl_add_u32 v216, v211, 6, v216
  v_lshrrev_b32 v212, 5, v200
  v_lshl_add_u32 v216, v212, 5, v216
  v_and_b32 v211, 1, v200
  v_lshl_add_u32 v216, v211, 4, v216
  v_bfe_u32 v211, v200, 4, 1
  v_lshlrev_b32 v217, 10, v211
  v_lshl_add_u32 v217, v212, 9, v217
  v_and_b32 v211, 15, v200
  v_lshl_add_u32 v217, v211, 4, v217
  s_lshl_b32 s54, s52, 11
  s_add_u32 s54, s54, 8192
  v_add_u32 v217, s54, v217
  s_waitcnt vmcnt(20) lgkmcnt(0)
  s_barrier
  s_add_u32 m0, s61, 98304
  s_add_u32 s54, s62, 1572864
  buffer_load_dwordx4 v207, s[20:23], s54 offen lds
  s_add_u32 m0, s61, 102400
  s_add_u32 s54, s62, 1703936
  buffer_load_dwordx4 v207, s[20:23], s54 offen lds
  s_add_u32 m0, s61, 106496
  s_add_u32 s54, s62, 1835008
  buffer_load_dwordx4 v207, s[20:23], s54 offen lds
  s_add_u32 m0, s61, 110592
  s_add_u32 s54, s62, 1966080
  buffer_load_dwordx4 v207, s[20:23], s54 offen lds
  v_add_u32 v215, 36864, v209
  ds_read_b64_tr_b16 a[0:1], v215 offset:0
  ds_read_b64_tr_b16 a[2:3], v215 offset:1024
  ds_read_b64_tr_b16 a[4:5], v215 offset:4096
  ds_read_b64_tr_b16 a[6:7], v215 offset:5120
  ds_read_b64_tr_b16 a[8:9], v215 offset:8192
  ds_read_b64_tr_b16 a[10:11], v215 offset:9216
  ds_read_b64_tr_b16 a[12:13], v215 offset:12288
  ds_read_b64_tr_b16 a[14:15], v215 offset:13312
  s_waitcnt vmcnt(20) lgkmcnt(0)
  s_barrier
  s_add_u32 m0, s61, 0
  s_add_u32 s54, s62, 1572864
  buffer_load_dwordx4 v207, s[24:27], s54 offen lds
  s_add_u32 m0, s61, 4096
  s_add_u32 s54, s62, 1703936
  buffer_load_dwordx4 v207, s[24:27], s54 offen lds
  s_add_u32 m0, s61, 8192
  s_add_u32 s54, s62, 1835008
  buffer_load_dwordx4 v207, s[24:27], s54 offen lds
  s_add_u32 m0, s61, 12288
  s_add_u32 s54, s62, 1966080
  buffer_load_dwordx4 v207, s[24:27], s54 offen lds
  v_add_u32 v215, 53248, v210
  ds_read_b64_tr_b16 a[144:145], v215 offset:0
  ds_read_b64_tr_b16 a[146:147], v215 offset:1024
  ds_read_b64_tr_b16 a[148:149], v215 offset:4096
  ds_read_b64_tr_b16 a[150:151], v215 offset:5120
  ds_read_b64_tr_b16 a[152:153], v215 offset:8192
  ds_read_b64_tr_b16 a[154:155], v215 offset:9216
  ds_read_b64_tr_b16 a[156:157], v215 offset:12288
  ds_read_b64_tr_b16 a[158:159], v215 offset:13312
  s_waitcnt vmcnt(20) lgkmcnt(0)
  s_barrier
  s_add_u32 m0, s61, 16384
  s_add_u32 s54, s62, 2097152
  buffer_load_dwordx4 v207, s[20:23], s54 offen lds
  s_add_u32 m0, s61, 20480
  s_add_u32 s54, s62, 2228224
  buffer_load_dwordx4 v207, s[20:23], s54 offen lds
  s_add_u32 m0, s61, 24576
  s_add_u32 s54, s62, 2359296
  buffer_load_dwordx4 v207, s[20:23], s54 offen lds
  s_add_u32 m0, s61, 28672
  s_add_u32 s54, s62, 2490368
  buffer_load_dwordx4 v207, s[20:23], s54 offen lds
  v_add_u32 v215, 69632, v209
  ds_read_b64_tr_b16 a[16:17], v215 offset:0
  ds_read_b64_tr_b16 a[18:19], v215 offset:1024
  ds_read_b64_tr_b16 a[20:21], v215 offset:4096
  ds_read_b64_tr_b16 a[22:23], v215 offset:5120
  ds_read_b64_tr_b16 a[24:25], v215 offset:8192
  ds_read_b64_tr_b16 a[26:27], v215 offset:9216
  ds_read_b64_tr_b16 a[28:29], v215 offset:12288
  ds_read_b64_tr_b16 a[30:31], v215 offset:13312
  s_waitcnt vmcnt(20) lgkmcnt(0)
  s_barrier
  s_add_u32 m0, s61, 32768
  s_add_u32 s54, s62, 2097152
  buffer_load_dwordx4 v207, s[24:27], s54 offen lds
  s_add_u32 m0, s61, 36864
  s_add_u32 s54, s62, 2228224
  buffer_load_dwordx4 v207, s[24:27], s54 offen lds
  s_add_u32 m0, s61, 40960
  s_add_u32 s54, s62, 2359296
  buffer_load_dwordx4 v207, s[24:27], s54 offen lds
  s_add_u32 m0, s61, 45056
  s_add_u32 s54, s62, 2490368
  buffer_load_dwordx4 v207, s[24:27], s54 offen lds
  v_add_u32 v215, 86016, v210
  ds_read_b64_tr_b16 a[160:161], v215 offset:0
  ds_read_b64_tr_b16 a[162:163], v215 offset:1024
  ds_read_b64_tr_b16 a[164:165], v215 offset:4096
  ds_read_b64_tr_b16 a[166:167], v215 offset:5120
  ds_read_b64_tr_b16 a[168:169], v215 offset:8192
  ds_read_b64_tr_b16 a[170:171], v215 offset:9216
  ds_read_b64_tr_b16 a[172:173], v215 offset:12288
  ds_read_b64_tr_b16 a[174:175], v215 offset:13312
  s_waitcnt vmcnt(20) lgkmcnt(0)
  s_barrier
  s_add_u32 m0, s61, 49152
  s_add_u32 s54, s62, 2621440
  buffer_load_dwordx4 v207, s[20:23], s54 offen lds
  s_add_u32 m0, s61, 53248
  s_add_u32 s54, s62, 2752512
  buffer_load_dwordx4 v207, s[20:23], s54 offen lds
  s_add_u32 m0, s61, 57344
  s_add_u32 s54, s62, 2883584
  buffer_load_dwordx4 v207, s[20:23], s54 offen lds
  s_add_u32 m0, s61, 61440
  s_add_u32 s54, s62, 3014656
  buffer_load_dwordx4 v207, s[20:23], s54 offen lds
  v_add_u32 v215, 102400, v209
  ds_read_b64_tr_b16 a[32:33], v215 offset:0
  ds_read_b64_tr_b16 a[34:35], v215 offset:1024
  ds_read_b64_tr_b16 a[36:37], v215 offset:4096
  ds_read_b64_tr_b16 a[38:39], v215 offset:5120
  ds_read_b64_tr_b16 a[40:41], v215 offset:8192
  ds_read_b64_tr_b16 a[42:43], v215 offset:9216
  ds_read_b64_tr_b16 a[44:45], v215 offset:12288
  ds_read_b64_tr_b16 a[46:47], v215 offset:13312
  s_waitcnt vmcnt(20) lgkmcnt(0)
  s_barrier
  s_add_u32 m0, s61, 65536
  s_add_u32 s54, s62, 2621440
  buffer_load_dwordx4 v207, s[24:27], s54 offen lds
  s_add_u32 m0, s61, 69632
  s_add_u32 s54, s62, 2752512
  buffer_load_dwordx4 v207, s[24:27], s54 offen lds
  s_add_u32 m0, s61, 73728
  s_add_u32 s54, s62, 2883584
  buffer_load_dwordx4 v207, s[24:27], s54 offen lds
  s_add_u32 m0, s61, 77824
  s_add_u32 s54, s62, 3014656
  buffer_load_dwordx4 v207, s[24:27], s54 offen lds
  v_add_u32 v215, 118784, v210
  ds_read_b64_tr_b16 a[176:177], v215 offset:0
  ds_read_b64_tr_b16 a[178:179], v215 offset:1024
  ds_read_b64_tr_b16 a[180:181], v215 offset:4096
  ds_read_b64_tr_b16 a[182:183], v215 offset:5120
  ds_read_b64_tr_b16 a[184:185], v215 offset:8192
  ds_read_b64_tr_b16 a[186:187], v215 offset:9216
  ds_read_b64_tr_b16 a[188:189], v215 offset:12288
  ds_read_b64_tr_b16 a[190:191], v215 offset:13312
  s_waitcnt vmcnt(20) lgkmcnt(0)
  s_barrier
  s_add_u32 m0, s61, 81920
  s_add_u32 s54, s62, 3145728
  buffer_load_dwordx4 v207, s[20:23], s54 offen lds
  s_add_u32 m0, s61, 86016
  s_add_u32 s54, s62, 3276800
  buffer_load_dwordx4 v207, s[20:23], s54 offen lds
  s_add_u32 m0, s61, 90112
  s_add_u32 s54, s62, 3407872
  buffer_load_dwordx4 v207, s[20:23], s54 offen lds
  s_add_u32 m0, s61, 94208
  s_add_u32 s54, s62, 3538944
  buffer_load_dwordx4 v207, s[20:23], s54 offen lds
  v_add_u32 v215, 135168, v209
  ds_read_b64_tr_b16 a[48:49], v215 offset:0
  ds_read_b64_tr_b16 a[50:51], v215 offset:1024
  ds_read_b64_tr_b16 a[52:53], v215 offset:4096
  ds_read_b64_tr_b16 a[54:55], v215 offset:5120
  ds_read_b64_tr_b16 a[56:57], v215 offset:8192
  ds_read_b64_tr_b16 a[58:59], v215 offset:9216
  ds_read_b64_tr_b16 a[60:61], v215 offset:12288
  ds_read_b64_tr_b16 a[62:63], v215 offset:13312
  s_waitcnt vmcnt(20) lgkmcnt(0)
  s_barrier
  s_add_u32 m0, s61, 98304
  s_add_u32 s54, s62, 3145728
  buffer_load_dwordx4 v207, s[24:27], s54 offen lds
  s_add_u32 m0, s61, 102400
  s_add_u32 s54, s62, 3276800
  buffer_load_dwordx4 v207, s[24:27], s54 offen lds
  s_add_u32 m0, s61, 106496
  s_add_u32 s54, s62, 3407872
  buffer_load_dwordx4 v207, s[24:27], s54 offen lds
  s_add_u32 m0, s61, 110592
  s_add_u32 s54, s62, 3538944
  buffer_load_dwordx4 v207, s[24:27], s54 offen lds
  v_add_u32 v215, 36864, v210
  ds_read_b64_tr_b16 a[192:193], v215 offset:0
  ds_read_b64_tr_b16 a[194:195], v215 offset:1024
  ds_read_b64_tr_b16 a[196:197], v215 offset:4096
  ds_read_b64_tr_b16 a[198:199], v215 offset:5120
  ds_read_b64_tr_b16 a[200:201], v215 offset:8192
  ds_read_b64_tr_b16 a[202:203], v215 offset:9216
  ds_read_b64_tr_b16 a[204:205], v215 offset:12288
  ds_read_b64_tr_b16 a[206:207], v215 offset:13312
  s_waitcnt vmcnt(20) lgkmcnt(0)
  s_barrier
  s_add_u32 m0, s61, 0
  s_add_u32 s54, s62, 3670016
  buffer_load_dwordx4 v207, s[20:23], s54 offen lds
  s_add_u32 m0, s61, 4096
  s_add_u32 s54, s62, 3801088
  buffer_load_dwordx4 v207, s[20:23], s54 offen lds
  s_add_u32 m0, s61, 8192
  s_add_u32 s54, s62, 3932160
  buffer_load_dwordx4 v207, s[20:23], s54 offen lds
  s_add_u32 m0, s61, 12288
  s_add_u32 s54, s62, 4063232
  buffer_load_dwordx4 v207, s[20:23], s54 offen lds
  v_add_u32 v215, 53248, v209
  ds_read_b64_tr_b16 a[64:65], v215 offset:0
  ds_read_b64_tr_b16 a[66:67], v215 offset:1024
  ds_read_b64_tr_b16 a[68:69], v215 offset:4096
  ds_read_b64_tr_b16 a[70:71], v215 offset:5120
  ds_read_b64_tr_b16 a[72:73], v215 offset:8192
  ds_read_b64_tr_b16 a[74:75], v215 offset:9216
  ds_read_b64_tr_b16 a[76:77], v215 offset:12288
  ds_read_b64_tr_b16 a[78:79], v215 offset:13312
  s_waitcnt vmcnt(20) lgkmcnt(0)
  s_barrier
  s_add_u32 m0, s61, 16384
  s_add_u32 s54, s62, 3670016
  buffer_load_dwordx4 v207, s[24:27], s54 offen lds
  s_add_u32 m0, s61, 20480
  s_add_u32 s54, s62, 3801088
  buffer_load_dwordx4 v207, s[24:27], s54 offen lds
  s_add_u32 m0, s61, 24576
  s_add_u32 s54, s62, 3932160
  buffer_load_dwordx4 v207, s[24:27], s54 offen lds
  s_add_u32 m0, s61, 28672
  s_add_u32 s54, s62, 4063232
  buffer_load_dwordx4 v207, s[24:27], s54 offen lds
  v_add_u32 v215, 69632, v210
  ds_read_b64_tr_b16 a[208:209], v215 offset:0
  ds_read_b64_tr_b16 a[210:211], v215 offset:1024
  ds_read_b64_tr_b16 a[212:213], v215 offset:4096
  ds_read_b64_tr_b16 a[214:215], v215 offset:5120
  ds_read_b64_tr_b16 a[216:217], v215 offset:8192
  ds_read_b64_tr_b16 a[218:219], v215 offset:9216
  ds_read_b64_tr_b16 a[220:221], v215 offset:12288
  ds_read_b64_tr_b16 a[222:223], v215 offset:13312
  s_waitcnt vmcnt(20) lgkmcnt(0)
  s_barrier
  s_add_u32 m0, s61, 32768
  s_add_u32 s54, s62, 4194304
  buffer_load_dwordx4 v207, s[20:23], s54 offen lds
  s_add_u32 m0, s61, 36864
  s_add_u32 s54, s62, 4325376
  buffer_load_dwordx4 v207, s[20:23], s54 offen lds
  s_add_u32 m0, s61, 40960
  s_add_u32 s54, s62, 4456448
  buffer_load_dwordx4 v207, s[20:23], s54 offen lds
  s_add_u32 m0, s61, 45056
  s_add_u32 s54, s62, 4587520
  buffer_load_dwordx4 v207, s[20:23], s54 offen lds
  v_add_u32 v215, 86016, v209
  ds_read_b64_tr_b16 a[80:81], v215 offset:0
  ds_read_b64_tr_b16 a[82:83], v215 offset:1024
  ds_read_b64_tr_b16 a[84:85], v215 offset:4096
  ds_read_b64_tr_b16 a[86:87], v215 offset:5120
  ds_read_b64_tr_b16 a[88:89], v215 offset:8192
  ds_read_b64_tr_b16 a[90:91], v215 offset:9216
  ds_read_b64_tr_b16 a[92:93], v215 offset:12288
  ds_read_b64_tr_b16 a[94:95], v215 offset:13312
  s_waitcnt vmcnt(20) lgkmcnt(0)
  s_barrier
  s_add_u32 m0, s61, 49152
  s_add_u32 s54, s62, 4194304
  buffer_load_dwordx4 v207, s[24:27], s54 offen lds
  s_add_u32 m0, s61, 53248
  s_add_u32 s54, s62, 4325376
  buffer_load_dwordx4 v207, s[24:27], s54 offen lds
  s_add_u32 m0, s61, 57344
  s_add_u32 s54, s62, 4456448
  buffer_load_dwordx4 v207, s[24:27], s54 offen lds
  s_add_u32 m0, s61, 61440
  s_add_u32 s54, s62, 4587520
  buffer_load_dwordx4 v207, s[24:27], s54 offen lds
  s_mul_i32 s54, s53, 21120
  s_lshl_b32 s55, s52, 13
  s_add_u32 s54, s54, s55
  s_cmp_eq_u32 s52, 3
  s_cselect_b32 s54, 0x10000000, s54
  v_lshlrev_b32 v211, 3, v201
  buffer_load_dword v196, v211, s[28:31], s54 offen
  v_add_u32 v215, 102400, v210
  ds_read_b64_tr_b16 a[224:225], v215 offset:0
  ds_read_b64_tr_b16 a[226:227], v215 offset:1024
  ds_read_b64_tr_b16 a[228:229], v215 offset:4096
  ds_read_b64_tr_b16 a[230:231], v215 offset:5120
  ds_read_b64_tr_b16 a[232:233], v215 offset:8192
  ds_read_b64_tr_b16 a[234:235], v215 offset:9216
  ds_read_b64_tr_b16 a[236:237], v215 offset:12288
  ds_read_b64_tr_b16 a[238:239], v215 offset:13312
  s_waitcnt vmcnt(21) lgkmcnt(0)
  s_barrier
  s_lshl_b32 s54, s53, 13
  s_lshr_b32 s55, s53, 6
  s_or_b32 s55, s55, s52
  s_cmp_eq_u32 s55, 0
  s_cselect_b32 s54, s54, 0x10000000
  v_lshlrev_b32 v211, 3, v201
  s_add_u32 s54, s54, 3145728
  buffer_load_dword v196, v211, s[16:19], s54 offen
  v_add_u32 v215, 118784, v209
  ds_read_b64_tr_b16 a[96:97], v215 offset:0
  ds_read_b64_tr_b16 a[98:99], v215 offset:1024
  ds_read_b64_tr_b16 a[100:101], v215 offset:4096
  ds_read_b64_tr_b16 a[102:103], v215 offset:5120
  ds_read_b64_tr_b16 a[104:105], v215 offset:8192
  ds_read_b64_tr_b16 a[106:107], v215 offset:9216
  ds_read_b64_tr_b16 a[108:109], v215 offset:12288
  ds_read_b64_tr_b16 a[110:111], v215 offset:13312
  s_waitcnt vmcnt(18) lgkmcnt(0)
  s_barrier
  s_lshl_b32 s55, s2, 2
  s_or_b32 s56, s52, s1
  s_cmp_eq_u32 s56, 0
  s_cselect_b32 s55, s55, 0x1000
  s_lshl_b32 s56, 1, s0
  v_mov_b32 v197, s56
  s_mov_b64 exec, 1
  buffer_atomic_or v197, off, s[12:15], s55 sc0
  s_mov_b64 exec, -1
  v_add_u32 v215, 135168, v210
  ds_read_b64_tr_b16 a[240:241], v215 offset:0
  ds_read_b64_tr_b16 a[242:243], v215 offset:1024
  ds_read_b64_tr_b16 a[244:245], v215 offset:4096
  ds_read_b64_tr_b16 a[246:247], v215 offset:5120
  ds_read_b64_tr_b16 a[248:249], v215 offset:8192
  ds_read_b64_tr_b16 a[250:251], v215 offset:9216
  ds_read_b64_tr_b16 a[252:253], v215 offset:12288
  ds_read_b64_tr_b16 a[254:255], v215 offset:13312
  s_waitcnt vmcnt(15) lgkmcnt(0)
  s_barrier
  v_add_u32 v215, 36864, v209
  ds_read_b64_tr_b16 a[112:113], v215 offset:0
  ds_read_b64_tr_b16 a[114:115], v215 offset:1024
  ds_read_b64_tr_b16 a[116:117], v215 offset:4096
  ds_read_b64_tr_b16 a[118:119], v215 offset:5120
  ds_read_b64_tr_b16 a[120:121], v215 offset:8192
  ds_read_b64_tr_b16 a[122:123], v215 offset:9216
  ds_read_b64_tr_b16 a[124:125], v215 offset:12288
  ds_read_b64_tr_b16 a[126:127], v215 offset:13312
  s_waitcnt vmcnt(11) lgkmcnt(0)
  s_barrier
  v_add_u32 v215, 53248, v210
  ds_read_b64_tr_b16 v[224:225], v215 offset:0
  ds_read_b64_tr_b16 v[226:227], v215 offset:1024
  ds_read_b64_tr_b16 v[228:229], v215 offset:4096
  ds_read_b64_tr_b16 v[230:231], v215 offset:5120
  ds_read_b64_tr_b16 v[232:233], v215 offset:8192
  ds_read_b64_tr_b16 v[234:235], v215 offset:9216
  ds_read_b64_tr_b16 v[236:237], v215 offset:12288
  ds_read_b64_tr_b16 v[238:239], v215 offset:13312
  s_waitcnt vmcnt(7) lgkmcnt(0)
  s_barrier
  v_add_u32 v215, 69632, v209
  ds_read_b64_tr_b16 a[128:129], v215 offset:0
  ds_read_b64_tr_b16 a[130:131], v215 offset:1024
  ds_read_b64_tr_b16 a[132:133], v215 offset:4096
  ds_read_b64_tr_b16 a[134:135], v215 offset:5120
  ds_read_b64_tr_b16 a[136:137], v215 offset:8192
  ds_read_b64_tr_b16 a[138:139], v215 offset:9216
  ds_read_b64_tr_b16 a[140:141], v215 offset:12288
  ds_read_b64_tr_b16 a[142:143], v215 offset:13312
  s_waitcnt vmcnt(3) lgkmcnt(0)
  s_barrier
  v_add_u32 v215, 86016, v210
  ds_read_b64_tr_b16 v[240:241], v215 offset:0
  ds_read_b64_tr_b16 v[242:243], v215 offset:1024
  ds_read_b64_tr_b16 v[244:245], v215 offset:4096
  ds_read_b64_tr_b16 v[246:247], v215 offset:5120
  ds_read_b64_tr_b16 v[248:249], v215 offset:8192
  ds_read_b64_tr_b16 v[250:251], v215 offset:9216
  ds_read_b64_tr_b16 v[252:253], v215 offset:12288
  ds_read_b64_tr_b16 v[254:255], v215 offset:13312
  s_waitcnt lgkmcnt(0)
  s_barrier
  s_mov_b32 s68, 1040356334
  s_lshl_b32 s69, s52, 9
  s_lshl_b32 s70, s58, 2
  s_add_u32 s70, s70, 128
  s_mul_i32 s66, s58, -12288
  s_lshl_b32 s54, s52, 10
  s_add_u32 s66, s66, s54
  s_add_u32 s66, s66, 524288
  v_mov_b32 v64, -1
  v_mov_b32 v65, -1
  v_mov_b32 v66, -1
  v_mov_b32 v67, -1
  s_add_u32 s60, s60, 258048
  ds_read_b128 v[32:35], v203 offset:0
  ds_read_b128 v[36:39], v204 offset:0
  ds_read_b128 v[40:43], v205 offset:0
  s_waitcnt lgkmcnt(2)
  v_mfma_f32_32x32x16_bf16 v[0:15], a[0:3], v[32:35], 0
  ds_read_b128 v[44:47], v206 offset:0
  s_add_u32 m0, s67, 36864
  s_nop 0
  buffer_load_dwordx4 v202, s[4:7], s60 offen offset:0 lds
  v_mfma_f32_32x32x16_bf16 v[16:31], v[32:35], a[144:147], 0
  s_waitcnt lgkmcnt(2)
  v_mfma_f32_32x32x16_bf16 v[0:15], a[4:7], v[36:39], v[0:15]
  ds_read_b128 v[32:35], v203 offset:1024
  s_add_u32 m0, s67, 37760
  s_nop 0
  buffer_load_dwordx4 v202, s[4:7], s60 offen offset:128 lds
  v_mfma_f32_32x32x16_bf16 v[16:31], v[36:39], a[148:151], v[16:31]
  s_waitcnt lgkmcnt(2)
  v_mfma_f32_32x32x16_bf16 v[0:15], a[8:11], v[40:43], v[0:15]
  ds_read_b128 v[36:39], v204 offset:1024
  s_add_u32 m0, s67, 38656
  s_nop 0
  buffer_load_dwordx4 v202, s[4:7], s60 offen offset:256 lds
  v_mfma_f32_32x32x16_bf16 v[16:31], v[40:43], a[152:155], v[16:31]
  s_waitcnt lgkmcnt(2)
  v_mfma_f32_32x32x16_bf16 v[0:15], a[12:15], v[44:47], v[0:15]
  ds_read_b128 v[40:43], v205 offset:1024
  s_add_u32 m0, s67, 39552
  s_nop 0
  buffer_load_dwordx4 v202, s[4:7], s60 offen offset:384 lds
  v_mfma_f32_32x32x16_bf16 v[16:31], v[44:47], a[156:159], v[16:31]
  s_waitcnt lgkmcnt(2)
  v_mfma_f32_32x32x16_bf16 v[0:15], a[16:19], v[32:35], v[0:15]
  ds_read_b128 v[44:47], v206 offset:1024
  s_add_u32 m0, s67, 40448
  s_nop 0
  buffer_load_dwordx4 v202, s[4:7], s60 offen offset:512 lds
  v_mfma_f32_32x32x16_bf16 v[16:31], v[32:35], a[160:163], v[16:31]
  s_waitcnt lgkmcnt(2)
  v_mfma_f32_32x32x16_bf16 v[0:15], a[20:23], v[36:39], v[0:15]
  ds_read_b128 v[32:35], v203 offset:2048
  s_add_u32 m0, s67, 41344
  s_nop 0
  buffer_load_dwordx4 v202, s[4:7], s60 offen offset:640 lds
  v_mfma_f32_32x32x16_bf16 v[16:31], v[36:39], a[164:167], v[16:31]
  s_waitcnt lgkmcnt(2)
  v_mfma_f32_32x32x16_bf16 v[0:15], a[24:27], v[40:43], v[0:15]
  ds_read_b128 v[36:39], v204 offset:2048
  s_add_u32 m0, s67, 42240
  s_nop 0
  buffer_load_dwordx4 v202, s[4:7], s60 offen offset:768 lds
  v_mfma_f32_32x32x16_bf16 v[16:31], v[40:43], a[168:171], v[16:31]
  s_waitcnt lgkmcnt(2)
  v_mfma_f32_32x32x16_bf16 v[0:15], a[28:31], v[44:47], v[0:15]
  ds_read_b128 v[40:43], v205 offset:2048
  s_add_u32 m0, s67, 43136
  s_nop 0
  buffer_load_dwordx4 v202, s[4:7], s60 offen offset:896 lds
  v_mfma_f32_32x32x16_bf16 v[16:31], v[44:47], a[172:175], v[16:31]
  s_waitcnt lgkmcnt(2)
  v_mfma_f32_32x32x16_bf16 v[0:15], a[32:35], v[32:35], v[0:15]
  ds_read_b128 v[44:47], v206 offset:2048
  s_add_u32 m0, s67, 44032
  s_nop 0
  buffer_load_dwordx4 v202, s[4:7], s60 offen offset:1024 lds
  v_mfma_f32_32x32x16_bf16 v[16:31], v[32:35], a[176:179], v[16:31]
  s_waitcnt lgkmcnt(2)
  v_mfma_f32_32x32x16_bf16 v[0:15], a[36:39], v[36:39], v[0:15]
  ds_read_b128 v[32:35], v203 offset:3072
  v_mfma_f32_32x32x16_bf16 v[16:31], v[36:39], a[180:183], v[16:31]
  s_waitcnt lgkmcnt(2)
  v_mfma_f32_32x32x16_bf16 v[0:15], a[40:43], v[40:43], v[0:15]
  ds_read_b128 v[36:39], v204 offset:3072
  v_mfma_f32_32x32x16_bf16 v[16:31], v[40:43], a[184:187], v[16:31]
  s_waitcnt lgkmcnt(2)
  v_mfma_f32_32x32x16_bf16 v[0:15], a[44:47], v[44:47], v[0:15]
  ds_read_b128 v[40:43], v205 offset:3072
  v_mfma_f32_32x32x16_bf16 v[16:31], v[44:47], a[188:191], v[16:31]
  s_waitcnt lgkmcnt(2)
  v_mfma_f32_32x32x16_bf16 v[0:15], a[48:51], v[32:35], v[0:15]
  ds_read_b128 v[44:47], v206 offset:3072
  v_mfma_f32_32x32x16_bf16 v[16:31], v[32:35], a[192:195], v[16:31]
  s_waitcnt lgkmcnt(2)
  v_mfma_f32_32x32x16_bf16 v[0:15], a[52:55], v[36:39], v[0:15]
  ds_read_b128 v[32:35], v203 offset:4096
  v_mfma_f32_32x32x16_bf16 v[16:31], v[36:39], a[196:199], v[16:31]
  s_waitcnt lgkmcnt(2)
  v_mfma_f32_32x32x16_bf16 v[0:15], a[56:59], v[40:43], v[0:15]
  ds_read_b128 v[36:39], v204 offset:4096
  v_mfma_f32_32x32x16_bf16 v[16:31], v[40:43], a[200:203], v[16:31]
  s_waitcnt lgkmcnt(2)
  v_mfma_f32_32x32x16_bf16 v[0:15], a[60:63], v[44:47], v[0:15]
  ds_read_b128 v[40:43], v205 offset:4096
  v_mfma_f32_32x32x16_bf16 v[16:31], v[44:47], a[204:207], v[16:31]
  s_waitcnt lgkmcnt(2)
  v_mfma_f32_32x32x16_bf16 v[0:15], a[64:67], v[32:35], v[0:15]
  ds_read_b128 v[44:47], v206 offset:4096
  v_mfma_f32_32x32x16_bf16 v[16:31], v[32:35], a[208:211], v[16:31]
  s_waitcnt lgkmcnt(2)
  v_mfma_f32_32x32x16_bf16 v[0:15], a[68:71], v[36:39], v[0:15]
  ds_read_b128 v[32:35], v203 offset:5120
  v_mfma_f32_32x32x16_bf16 v[16:31], v[36:39], a[212:215], v[16:31]
  s_waitcnt lgkmcnt(2)
  v_mfma_f32_32x32x16_bf16 v[0:15], a[72:75], v[40:43], v[0:15]
  ds_read_b128 v[36:39], v204 offset:5120
  v_mfma_f32_32x32x16_bf16 v[16:31], v[40:43], a[216:219], v[16:31]
  s_waitcnt lgkmcnt(2)
  v_mfma_f32_32x32x16_bf16 v[0:15], a[76:79], v[44:47], v[0:15]
  ds_read_b128 v[40:43], v205 offset:5120
  v_mfma_f32_32x32x16_bf16 v[16:31], v[44:47], a[220:223], v[16:31]
  s_waitcnt lgkmcnt(2)
  v_mfma_f32_32x32x16_bf16 v[0:15], a[80:83], v[32:35], v[0:15]
  ds_read_b128 v[44:47], v206 offset:5120
  v_mfma_f32_32x32x16_bf16 v[16:31], v[32:35], a[224:227], v[16:31]
  s_waitcnt lgkmcnt(2)
  v_mfma_f32_32x32x16_bf16 v[0:15], a[84:87], v[36:39], v[0:15]
  ds_read_b128 v[32:35], v203 offset:6144
  v_mfma_f32_32x32x16_bf16 v[16:31], v[36:39], a[228:231], v[16:31]
  s_waitcnt lgkmcnt(2)
  v_mfma_f32_32x32x16_bf16 v[0:15], a[88:91], v[40:43], v[0:15]
  ds_read_b128 v[36:39], v204 offset:6144
  v_mfma_f32_32x32x16_bf16 v[16:31], v[40:43], a[232:235], v[16:31]
  s_waitcnt lgkmcnt(2)
  v_mfma_f32_32x32x16_bf16 v[0:15], a[92:95], v[44:47], v[0:15]
  ds_read_b128 v[40:43], v205 offset:6144
  v_mfma_f32_32x32x16_bf16 v[16:31], v[44:47], a[236:239], v[16:31]
  s_waitcnt lgkmcnt(2)
  v_mfma_f32_32x32x16_bf16 v[0:15], a[96:99], v[32:35], v[0:15]
  ds_read_b128 v[44:47], v206 offset:6144
  v_mfma_f32_32x32x16_bf16 v[16:31], v[32:35], a[240:243], v[16:31]
  s_waitcnt lgkmcnt(2)
  v_mfma_f32_32x32x16_bf16 v[0:15], a[100:103], v[36:39], v[0:15]
  ds_read_b128 v[32:35], v203 offset:7168
  v_mfma_f32_32x32x16_bf16 v[16:31], v[36:39], a[244:247], v[16:31]
  s_waitcnt lgkmcnt(2)
  v_mfma_f32_32x32x16_bf16 v[0:15], a[104:107], v[40:43], v[0:15]
  ds_read_b128 v[36:39], v204 offset:7168
  v_mfma_f32_32x32x16_bf16 v[16:31], v[40:43], a[248:251], v[16:31]
  s_waitcnt lgkmcnt(2)
  v_mfma_f32_32x32x16_bf16 v[0:15], a[108:111], v[44:47], v[0:15]
  ds_read_b128 v[40:43], v205 offset:7168
  v_mfma_f32_32x32x16_bf16 v[16:31], v[44:47], a[252:255], v[16:31]
  s_waitcnt lgkmcnt(2)
  v_mfma_f32_32x32x16_bf16 v[0:15], a[112:115], v[32:35], v[0:15]
  ds_read_b128 v[44:47], v206 offset:7168
  v_mfma_f32_32x32x16_bf16 v[16:31], v[32:35], v[224:227], v[16:31]
  s_waitcnt lgkmcnt(2)
  v_mfma_f32_32x32x16_bf16 v[0:15], a[116:119], v[36:39], v[0:15]
  ds_read_b128 v[32:35], v203 offset:8192
  v_mfma_f32_32x32x16_bf16 v[16:31], v[36:39], v[228:231], v[16:31]
  s_waitcnt lgkmcnt(2)
  v_mfma_f32_32x32x16_bf16 v[0:15], a[120:123], v[40:43], v[0:15]
  ds_read_b128 v[36:39], v204 offset:8192
  v_mfma_f32_32x32x16_bf16 v[16:31], v[40:43], v[232:235], v[16:31]
  s_waitcnt lgkmcnt(2)
  v_mfma_f32_32x32x16_bf16 v[0:15], a[124:127], v[44:47], v[0:15]
  ds_read_b128 v[40:43], v205 offset:8192
  v_mfma_f32_32x32x16_bf16 v[16:31], v[44:47], v[236:239], v[16:31]
  s_waitcnt lgkmcnt(2)
  v_mfma_f32_32x32x16_bf16 v[0:15], a[128:131], v[32:35], v[0:15]
  ds_read_b128 v[44:47], v206 offset:8192
  v_mfma_f32_32x32x16_bf16 v[16:31], v[32:35], v[240:243], v[16:31]
  s_waitcnt lgkmcnt(2)
  v_mfma_f32_32x32x16_bf16 v[0:15], a[132:135], v[36:39], v[0:15]
  v_mfma_f32_32x32x16_bf16 v[16:31], v[36:39], v[244:247], v[16:31]
  s_waitcnt lgkmcnt(1)
  v_mfma_f32_32x32x16_bf16 v[0:15], a[136:139], v[40:43], v[0:15]
  v_mfma_f32_32x32x16_bf16 v[16:31], v[40:43], v[248:251], v[16:31]
  s_waitcnt lgkmcnt(0)
  v_mfma_f32_32x32x16_bf16 v[0:15], a[140:143], v[44:47], v[0:15]
  v_mfma_f32_32x32x16_bf16 v[16:31], v[44:47], v[252:255], v[16:31]
  s_mul_i32 s64, s59, 655360
  s_lshl_b32 s55, s58, 14
  s_add_u32 s64, s64, s55
  s_add_u32 s64, s64, 1048576
  s_add_u32 s72, s64, s69
  s_add_u32 s73, s64, s66
  s_add_u32 s59, s59, 7
  s_waitcnt vmcnt(0)
  s_barrier
  s_cmp_eq_u32 s1, 1
  s_cbranch_scc1 W_ver_ok
  v_mov_b32 v33, 163832
  s_cmp_eq_u32 s52, 0
  s_cbranch_scc0 W_ver_b
  s_waitcnt vmcnt(0)
  s_mov_b64 exec, 1
  ds_write_b32 v33, v197
  s_mov_b64 exec, -1
  s_waitcnt lgkmcnt(0)
W_ver_b:
  s_barrier
  ds_read_b32 v32, v33
  s_waitcnt lgkmcnt(0)
  v_readfirstlane_b32 s54, v32
  s_nop 0
  s_bitcmp1_b32 s54, s0
  s_cbranch_scc1 L_conf
W_ver_ok:
  s_lshr_b32 s55, s53, 1
  s_and_b32 s56, s53, 1
  s_lshl_b32 s56, s56, 7
  s_lshl_b32 s55, s55, 2
  s_add_u32 s55, s55, s56
  s_add_u32 s55, s55, 356352
  s_cmp_lt_u32 s53, 64
  s_cselect_b32 s71, s55, 268435456
  v_mov_b32 v211, 0
  s_mov_b64 exec, 1
  buffer_store_dword v211, v211, s[8:11], s71 offen sc1
  s_mov_b64 exec, -1
  s_cmp_eq_u32 s59, 7
  s_cbranch_scc0 KV_na
  s_mul_i32 s54, s58, 2176
  s_mul_i32 s55, s52, 69632
  s_add_u32 s55, s55, s54
  s_add_u32 s55, s55, 0
  s_add_u32 s54, s54, 278528
  s_and_b32 s56, s58, 7
  s_lshl_b32 s56, s56, 12
  s_bfe_u32 s57, s58, 0x10003
  s_lshl_b32 s57, s57, 11
  s_add_u32 s56, s56, s57
  s_add_u32 s54, s56, 262144
  s_lshr_b32 s57, s58, 4
  s_lshl_b32 s57, s57, 15
  s_add_u32 s56, s56, s57
  s_lshl_b32 s57, s52, 16
  s_add_u32 s56, s56, s57
  s_add_u32 s55, s56, 0
  s_lshl_b32 s56, s58, 14
  s_mul_i32 s57, s52, 3072
  s_add_u32 s56, s56, s57
  s_add_u32 s56, s56, 360448
  s_cmp_lt_u32 s58, 2
  s_cselect_b32 s56, s56, 268435456
  s_cmp_eq_u32 s52, 0
  s_cselect_b32 s54, s54, 268435456
  buffer_store_dwordx4 v[64:67], v201, s[8:11], s55 offen offset:0 sc1
  buffer_store_dwordx4 v[64:67], v201, s[8:11], s55 offen offset:1024 sc1
  buffer_store_dwordx4 v[64:67], v201, s[8:11], s54 offen offset:0 sc1
  buffer_store_dwordx4 v[64:67], v201, s[8:11], s54 offen offset:1024 sc1
  buffer_store_dwordx4 v[64:67], v201, s[8:11], s56 offen offset:0 sc1
  buffer_store_dwordx4 v[64:67], v201, s[8:11], s56 offen offset:1024 sc1
  buffer_store_dwordx4 v[64:67], v201, s[8:11], s56 offen offset:2048 sc1
KV_na:
KV_loop:
  s_add_u32 s60, s60, 258048
  ds_read_b128 v[32:35], v203 offset:36864
  ds_read_b128 v[36:39], v204 offset:36864
  ds_read_b128 v[40:43], v205 offset:36864
  s_waitcnt lgkmcnt(2)
  v_mfma_f32_32x32x16_bf16 v[68:83], a[0:3], v[32:35], 0
  ds_read_b128 v[44:47], v206 offset:36864
  s_add_u32 m0, s67, 0
  s_nop 0
  buffer_load_dwordx4 v202, s[4:7], s60 offen offset:0 lds
  v_mfma_f32_32x32x16_bf16 v[84:99], v[32:35], a[144:147], 0
  s_waitcnt lgkmcnt(2)
  v_mfma_f32_32x32x16_bf16 v[68:83], a[4:7], v[36:39], v[68:83]
  ds_read_b128 v[32:35], v203 offset:37888
  s_add_u32 m0, s67, 896
  s_nop 0
  buffer_load_dwordx4 v202, s[4:7], s60 offen offset:128 lds
  v_mfma_f32_32x32x16_bf16 v[84:99], v[36:39], a[148:151], v[84:99]
  s_waitcnt lgkmcnt(2)
  v_mfma_f32_32x32x16_bf16 v[68:83], a[8:11], v[40:43], v[68:83]
  ds_read_b128 v[36:39], v204 offset:37888
  s_add_u32 m0, s67, 1792
  s_nop 0
  buffer_load_dwordx4 v202, s[4:7], s60 offen offset:256 lds
  v_mfma_f32_32x32x16_bf16 v[84:99], v[40:43], a[152:155], v[84:99]
  s_waitcnt lgkmcnt(2)
  v_mfma_f32_32x32x16_bf16 v[68:83], a[12:15], v[44:47], v[68:83]
  ds_read_b128 v[40:43], v205 offset:37888
  s_add_u32 m0, s67, 2688
  s_nop 0
  buffer_load_dwordx4 v202, s[4:7], s60 offen offset:384 lds
  v_mfma_f32_32x32x16_bf16 v[84:99], v[44:47], a[156:159], v[84:99]
  s_waitcnt lgkmcnt(2)
  v_mfma_f32_32x32x16_bf16 v[68:83], a[16:19], v[32:35], v[68:83]
  ds_read_b128 v[44:47], v206 offset:37888
  s_add_u32 m0, s67, 3584
  s_nop 0
  buffer_load_dwordx4 v202, s[4:7], s60 offen offset:512 lds
  v_mfma_f32_32x32x16_bf16 v[84:99], v[32:35], a[160:163], v[84:99]
  s_waitcnt lgkmcnt(2)
  v_mfma_f32_32x32x16_bf16 v[68:83], a[20:23], v[36:39], v[68:83]
  ds_read_b128 v[32:35], v203 offset:38912
  s_add_u32 m0, s67, 4480
  s_nop 0
  buffer_load_dwordx4 v202, s[4:7], s60 offen offset:640 lds
  v_mfma_f32_32x32x16_bf16 v[84:99], v[36:39], a[164:167], v[84:99]
  s_waitcnt lgkmcnt(2)
  v_mfma_f32_32x32x16_bf16 v[68:83], a[24:27], v[40:43], v[68:83]
  ds_read_b128 v[36:39], v204 offset:38912
  s_add_u32 m0, s67, 5376
  s_nop 0
  buffer_load_dwordx4 v202, s[4:7], s60 offen offset:768 lds
  v_mfma_f32_32x32x16_bf16 v[84:99], v[40:43], a[168:171], v[84:99]
  s_waitcnt lgkmcnt(2)
  v_mfma_f32_32x32x16_bf16 v[68:83], a[28:31], v[44:47], v[68:83]
  ds_read_b128 v[40:43], v205 offset:38912
  s_add_u32 m0, s67, 6272
  s_nop 0
  buffer_load_dwordx4 v202, s[4:7], s60 offen offset:896 lds
  v_mfma_f32_32x32x16_bf16 v[84:99], v[44:47], a[172:175], v[84:99]
  s_waitcnt lgkmcnt(2)
  v_mfma_f32_32x32x16_bf16 v[68:83], a[32:35], v[32:35], v[68:83]
  ds_read_b128 v[44:47], v206 offset:38912
  s_add_u32 m0, s67, 7168
  s_nop 0
  buffer_load_dwordx4 v202, s[4:7], s60 offen offset:1024 lds
  v_mfma_f32_32x32x16_bf16 v[84:99], v[32:35], a[176:179], v[84:99]
  s_waitcnt lgkmcnt(2)
  v_mfma_f32_32x32x16_bf16 v[68:83], a[36:39], v[36:39], v[68:83]
  ds_read_b128 v[32:35], v203 offset:39936
  v_mul_f32 v0, s68, v0
  v_mul_f32 v1, s68, v1
  v_mul_f32 v2, s68, v2
  v_mul_f32 v3, s68, v3
  v_mfma_f32_32x32x16_bf16 v[84:99], v[36:39], a[180:183], v[84:99]
  v_mul_f32 v4, s68, v4
  v_mul_f32 v5, s68, v5
  v_mul_f32 v6, s68, v6
  v_mul_f32 v7, s68, v7
  s_waitcnt lgkmcnt(2)
  v_mfma_f32_32x32x16_bf16 v[68:83], a[40:43], v[40:43], v[68:83]
  ds_read_b128 v[36:39], v204 offset:39936
  v_cvt_pk_bf16_f32 v48, v0, v4
  v_cvt_pk_bf16_f32 v49, v1, v5
  v_cvt_pk_bf16_f32 v50, v2, v6
  v_cvt_pk_bf16_f32 v51, v3, v7
  v_mfma_f32_32x32x16_bf16 v[84:99], v[40:43], a[184:187], v[84:99]
  buffer_store_dwordx4 v[48:51], v216, s[8:11], s72 offen offset:0 sc1
  s_waitcnt lgkmcnt(2)
  v_mfma_f32_32x32x16_bf16 v[68:83], a[44:47], v[44:47], v[68:83]
  ds_read_b128 v[40:43], v205 offset:39936
  v_mfma_f32_32x32x16_bf16 v[84:99], v[44:47], a[188:191], v[84:99]
  s_waitcnt lgkmcnt(2)
  v_mfma_f32_32x32x16_bf16 v[68:83], a[48:51], v[32:35], v[68:83]
  ds_read_b128 v[44:47], v206 offset:39936
  v_mul_f32 v8, s68, v8
  v_mul_f32 v9, s68, v9
  v_mul_f32 v10, s68, v10
  v_mul_f32 v11, s68, v11
  v_mfma_f32_32x32x16_bf16 v[84:99], v[32:35], a[192:195], v[84:99]
  v_mul_f32 v12, s68, v12
  v_mul_f32 v13, s68, v13
  v_mul_f32 v14, s68, v14
  v_mul_f32 v15, s68, v15
  s_waitcnt lgkmcnt(2)
  v_mfma_f32_32x32x16_bf16 v[68:83], a[52:55], v[36:39], v[68:83]
  ds_read_b128 v[32:35], v203 offset:40960
  v_cvt_pk_bf16_f32 v52, v8, v12
  v_cvt_pk_bf16_f32 v53, v9, v13
  v_cvt_pk_bf16_f32 v54, v10, v14
  v_cvt_pk_bf16_f32 v55, v11, v15
  v_mfma_f32_32x32x16_bf16 v[84:99], v[36:39], a[196:199], v[84:99]
  buffer_store_dwordx4 v[52:55], v216, s[8:11], s72 offen offset:256 sc1
  s_waitcnt lgkmcnt(2)
  v_mfma_f32_32x32x16_bf16 v[68:83], a[56:59], v[40:43], v[68:83]
  ds_read_b128 v[36:39], v204 offset:40960
  v_mfma_f32_32x32x16_bf16 v[84:99], v[40:43], a[200:203], v[84:99]
  s_waitcnt lgkmcnt(2)
  v_mfma_f32_32x32x16_bf16 v[68:83], a[60:63], v[44:47], v[68:83]
  ds_read_b128 v[40:43], v205 offset:40960
  v_cvt_pk_bf16_f32 v56, v16, v17
  v_cvt_pk_bf16_f32 v57, v20, v21
  v_cvt_pk_bf16_f32 v58, v24, v25
  v_cvt_pk_bf16_f32 v59, v28, v29
  v_mfma_f32_32x32x16_bf16 v[84:99], v[44:47], a[204:207], v[84:99]
  buffer_store_dwordx4 v[56:59], v217, s[8:11], s64 offen offset:0 sc1
  s_waitcnt lgkmcnt(2)
  v_mfma_f32_32x32x16_bf16 v[68:83], a[64:67], v[32:35], v[68:83]
  ds_read_b128 v[44:47], v206 offset:40960
  v_mfma_f32_32x32x16_bf16 v[84:99], v[32:35], a[208:211], v[84:99]
  s_waitcnt lgkmcnt(2)
  v_mfma_f32_32x32x16_bf16 v[68:83], a[68:71], v[36:39], v[68:83]
  ds_read_b128 v[32:35], v203 offset:41984
  v_cvt_pk_bf16_f32 v60, v18, v19
  v_cvt_pk_bf16_f32 v61, v22, v23
  v_cvt_pk_bf16_f32 v62, v26, v27
  v_cvt_pk_bf16_f32 v63, v30, v31
  v_mfma_f32_32x32x16_bf16 v[84:99], v[36:39], a[212:215], v[84:99]
  buffer_store_dwordx4 v[60:63], v217, s[8:11], s64 offen offset:256 sc1
  s_waitcnt lgkmcnt(2)
  v_mfma_f32_32x32x16_bf16 v[68:83], a[72:75], v[40:43], v[68:83]
  ds_read_b128 v[36:39], v204 offset:41984
  v_mfma_f32_32x32x16_bf16 v[84:99], v[40:43], a[216:219], v[84:99]
  s_waitcnt lgkmcnt(2)
  v_mfma_f32_32x32x16_bf16 v[68:83], a[76:79], v[44:47], v[68:83]
  ds_read_b128 v[40:43], v205 offset:41984
  buffer_store_dwordx4 v[64:67], v201, s[8:11], s73 offen sc1
  v_mfma_f32_32x32x16_bf16 v[84:99], v[44:47], a[220:223], v[84:99]
  s_waitcnt lgkmcnt(2)
  v_mfma_f32_32x32x16_bf16 v[68:83], a[80:83], v[32:35], v[68:83]
  ds_read_b128 v[44:47], v206 offset:41984
  v_mfma_f32_32x32x16_bf16 v[84:99], v[32:35], a[224:227], v[84:99]
  s_waitcnt lgkmcnt(2)
  v_mfma_f32_32x32x16_bf16 v[68:83], a[84:87], v[36:39], v[68:83]
  ds_read_b128 v[32:35], v203 offset:43008
  v_mfma_f32_32x32x16_bf16 v[84:99], v[36:39], a[228:231], v[84:99]
  s_waitcnt lgkmcnt(2)
  v_mfma_f32_32x32x16_bf16 v[68:83], a[88:91], v[40:43], v[68:83]
  ds_read_b128 v[36:39], v204 offset:43008
  v_mfma_f32_32x32x16_bf16 v[84:99], v[40:43], a[232:235], v[84:99]
  s_waitcnt lgkmcnt(2)
  v_mfma_f32_32x32x16_bf16 v[68:83], a[92:95], v[44:47], v[68:83]
  ds_read_b128 v[40:43], v205 offset:43008
  v_mfma_f32_32x32x16_bf16 v[84:99], v[44:47], a[236:239], v[84:99]
  s_waitcnt lgkmcnt(2)
  v_mfma_f32_32x32x16_bf16 v[68:83], a[96:99], v[32:35], v[68:83]
  ds_read_b128 v[44:47], v206 offset:43008
  v_mfma_f32_32x32x16_bf16 v[84:99], v[32:35], a[240:243], v[84:99]
  s_waitcnt lgkmcnt(2)
  v_mfma_f32_32x32x16_bf16 v[68:83], a[100:103], v[36:39], v[68:83]
  ds_read_b128 v[32:35], v203 offset:44032
  v_mfma_f32_32x32x16_bf16 v[84:99], v[36:39], a[244:247], v[84:99]
  s_waitcnt lgkmcnt(2)
  v_mfma_f32_32x32x16_bf16 v[68:83], a[104:107], v[40:43], v[68:83]
  ds_read_b128 v[36:39], v204 offset:44032
  v_mfma_f32_32x32x16_bf16 v[84:99], v[40:43], a[248:251], v[84:99]
  s_waitcnt lgkmcnt(2)
  v_mfma_f32_32x32x16_bf16 v[68:83], a[108:111], v[44:47], v[68:83]
  ds_read_b128 v[40:43], v205 offset:44032
  v_mfma_f32_32x32x16_bf16 v[84:99], v[44:47], a[252:255], v[84:99]
  s_waitcnt lgkmcnt(2)
  v_mfma_f32_32x32x16_bf16 v[68:83], a[112:115], v[32:35], v[68:83]
  ds_read_b128 v[44:47], v206 offset:44032
  v_mfma_f32_32x32x16_bf16 v[84:99], v[32:35], v[224:227], v[84:99]
  s_waitcnt lgkmcnt(2)
  v_mfma_f32_32x32x16_bf16 v[68:83], a[116:119], v[36:39], v[68:83]
  ds_read_b128 v[32:35], v203 offset:45056
  v_mfma_f32_32x32x16_bf16 v[84:99], v[36:39], v[228:231], v[84:99]
  s_waitcnt lgkmcnt(2)
  v_mfma_f32_32x32x16_bf16 v[68:83], a[120:123], v[40:43], v[68:83]
  ds_read_b128 v[36:39], v204 offset:45056
  v_mfma_f32_32x32x16_bf16 v[84:99], v[40:43], v[232:235], v[84:99]
  s_waitcnt lgkmcnt(2)
  v_mfma_f32_32x32x16_bf16 v[68:83], a[124:127], v[44:47], v[68:83]
  ds_read_b128 v[40:43], v205 offset:45056
  v_mfma_f32_32x32x16_bf16 v[84:99], v[44:47], v[236:239], v[84:99]
  s_waitcnt lgkmcnt(2)
  v_mfma_f32_32x32x16_bf16 v[68:83], a[128:131], v[32:35], v[68:83]
  ds_read_b128 v[44:47], v206 offset:45056
  v_mfma_f32_32x32x16_bf16 v[84:99], v[32:35], v[240:243], v[84:99]
  s_waitcnt lgkmcnt(2)
  v_mfma_f32_32x32x16_bf16 v[68:83], a[132:135], v[36:39], v[68:83]
  v_mfma_f32_32x32x16_bf16 v[84:99], v[36:39], v[244:247], v[84:99]
  s_waitcnt lgkmcnt(1)
  v_mfma_f32_32x32x16_bf16 v[68:83], a[136:139], v[40:43], v[68:83]
  v_mfma_f32_32x32x16_bf16 v[84:99], v[40:43], v[248:251], v[84:99]
  s_waitcnt lgkmcnt(0)
  v_mfma_f32_32x32x16_bf16 v[68:83], a[140:143], v[44:47], v[68:83]
  v_mfma_f32_32x32x16_bf16 v[84:99], v[44:47], v[252:255], v[84:99]
  s_mul_i32 s64, s59, 655360
  s_lshl_b32 s55, s58, 14
  s_add_u32 s64, s64, s55
  s_add_u32 s64, s64, 1048576
  s_add_u32 s72, s64, s69
  s_add_u32 s73, s64, s66
  s_add_u32 s59, s59, 7
  s_cmp_ge_u32 s59, 64
  s_cbranch_scc1 KV_done1
  s_waitcnt vmcnt(5)
  s_barrier
  s_add_u32 s60, s60, 258048
  ds_read_b128 v[32:35], v203 offset:0
  ds_read_b128 v[36:39], v204 offset:0
  ds_read_b128 v[40:43], v205 offset:0
  s_waitcnt lgkmcnt(2)
  v_mfma_f32_32x32x16_bf16 v[0:15], a[0:3], v[32:35], 0
  ds_read_b128 v[44:47], v206 offset:0
  s_add_u32 m0, s67, 36864
  s_nop 0
  buffer_load_dwordx4 v202, s[4:7], s60 offen offset:0 lds
  v_mfma_f32_32x32x16_bf16 v[16:31], v[32:35], a[144:147], 0
  s_waitcnt lgkmcnt(2)
  v_mfma_f32_32x32x16_bf16 v[0:15], a[4:7], v[36:39], v[0:15]
  ds_read_b128 v[32:35], v203 offset:1024
  s_add_u32 m0, s67, 37760
  s_nop 0
  buffer_load_dwordx4 v202, s[4:7], s60 offen offset:128 lds
  v_mfma_f32_32x32x16_bf16 v[16:31], v[36:39], a[148:151], v[16:31]
  s_waitcnt lgkmcnt(2)
  v_mfma_f32_32x32x16_bf16 v[0:15], a[8:11], v[40:43], v[0:15]
  ds_read_b128 v[36:39], v204 offset:1024
  s_add_u32 m0, s67, 38656
  s_nop 0
  buffer_load_dwordx4 v202, s[4:7], s60 offen offset:256 lds
  v_mfma_f32_32x32x16_bf16 v[16:31], v[40:43], a[152:155], v[16:31]
  s_waitcnt lgkmcnt(2)
  v_mfma_f32_32x32x16_bf16 v[0:15], a[12:15], v[44:47], v[0:15]
  ds_read_b128 v[40:43], v205 offset:1024
  s_add_u32 m0, s67, 39552
  s_nop 0
  buffer_load_dwordx4 v202, s[4:7], s60 offen offset:384 lds
  v_mfma_f32_32x32x16_bf16 v[16:31], v[44:47], a[156:159], v[16:31]
  s_waitcnt lgkmcnt(2)
  v_mfma_f32_32x32x16_bf16 v[0:15], a[16:19], v[32:35], v[0:15]
  ds_read_b128 v[44:47], v206 offset:1024
  s_add_u32 m0, s67, 40448
  s_nop 0
  buffer_load_dwordx4 v202, s[4:7], s60 offen offset:512 lds
  v_mfma_f32_32x32x16_bf16 v[16:31], v[32:35], a[160:163], v[16:31]
  s_waitcnt lgkmcnt(2)
  v_mfma_f32_32x32x16_bf16 v[0:15], a[20:23], v[36:39], v[0:15]
  ds_read_b128 v[32:35], v203 offset:2048
  s_add_u32 m0, s67, 41344
  s_nop 0
  buffer_load_dwordx4 v202, s[4:7], s60 offen offset:640 lds
  v_mfma_f32_32x32x16_bf16 v[16:31], v[36:39], a[164:167], v[16:31]
  s_waitcnt lgkmcnt(2)
  v_mfma_f32_32x32x16_bf16 v[0:15], a[24:27], v[40:43], v[0:15]
  ds_read_b128 v[36:39], v204 offset:2048
  s_add_u32 m0, s67, 42240
  s_nop 0
  buffer_load_dwordx4 v202, s[4:7], s60 offen offset:768 lds
  v_mfma_f32_32x32x16_bf16 v[16:31], v[40:43], a[168:171], v[16:31]
  s_waitcnt lgkmcnt(2)
  v_mfma_f32_32x32x16_bf16 v[0:15], a[28:31], v[44:47], v[0:15]
  ds_read_b128 v[40:43], v205 offset:2048
  s_add_u32 m0, s67, 43136
  s_nop 0
  buffer_load_dwordx4 v202, s[4:7], s60 offen offset:896 lds
  v_mfma_f32_32x32x16_bf16 v[16:31], v[44:47], a[172:175], v[16:31]
  s_waitcnt lgkmcnt(2)
  v_mfma_f32_32x32x16_bf16 v[0:15], a[32:35], v[32:35], v[0:15]
  ds_read_b128 v[44:47], v206 offset:2048
  s_add_u32 m0, s67, 44032
  s_nop 0
  buffer_load_dwordx4 v202, s[4:7], s60 offen offset:1024 lds
  v_mfma_f32_32x32x16_bf16 v[16:31], v[32:35], a[176:179], v[16:31]
  s_waitcnt lgkmcnt(2)
  v_mfma_f32_32x32x16_bf16 v[0:15], a[36:39], v[36:39], v[0:15]
  ds_read_b128 v[32:35], v203 offset:3072
  v_mul_f32 v68, s68, v68
  v_mul_f32 v69, s68, v69
  v_mul_f32 v70, s68, v70
  v_mul_f32 v71, s68, v71
  v_mfma_f32_32x32x16_bf16 v[16:31], v[36:39], a[180:183], v[16:31]
  v_mul_f32 v72, s68, v72
  v_mul_f32 v73, s68, v73
  v_mul_f32 v74, s68, v74
  v_mul_f32 v75, s68, v75
  s_waitcnt lgkmcnt(2)
  v_mfma_f32_32x32x16_bf16 v[0:15], a[40:43], v[40:43], v[0:15]
  ds_read_b128 v[36:39], v204 offset:3072
  v_cvt_pk_bf16_f32 v48, v68, v72
  v_cvt_pk_bf16_f32 v49, v69, v73
  v_cvt_pk_bf16_f32 v50, v70, v74
  v_cvt_pk_bf16_f32 v51, v71, v75
  v_mfma_f32_32x32x16_bf16 v[16:31], v[40:43], a[184:187], v[16:31]
  buffer_store_dwordx4 v[48:51], v216, s[8:11], s72 offen offset:0 sc1
  s_waitcnt lgkmcnt(2)
  v_mfma_f32_32x32x16_bf16 v[0:15], a[44:47], v[44:47], v[0:15]
  ds_read_b128 v[40:43], v205 offset:3072
  v_mfma_f32_32x32x16_bf16 v[16:31], v[44:47], a[188:191], v[16:31]
  s_waitcnt lgkmcnt(2)
  v_mfma_f32_32x32x16_bf16 v[0:15], a[48:51], v[32:35], v[0:15]
  ds_read_b128 v[44:47], v206 offset:3072
  v_mul_f32 v76, s68, v76
  v_mul_f32 v77, s68, v77
  v_mul_f32 v78, s68, v78
  v_mul_f32 v79, s68, v79
  v_mfma_f32_32x32x16_bf16 v[16:31], v[32:35], a[192:195], v[16:31]
  v_mul_f32 v80, s68, v80
  v_mul_f32 v81, s68, v81
  v_mul_f32 v82, s68, v82
  v_mul_f32 v83, s68, v83
  s_waitcnt lgkmcnt(2)
  v_mfma_f32_32x32x16_bf16 v[0:15], a[52:55], v[36:39], v[0:15]
  ds_read_b128 v[32:35], v203 offset:4096
  v_cvt_pk_bf16_f32 v52, v76, v80
  v_cvt_pk_bf16_f32 v53, v77, v81
  v_cvt_pk_bf16_f32 v54, v78, v82
  v_cvt_pk_bf16_f32 v55, v79, v83
  v_mfma_f32_32x32x16_bf16 v[16:31], v[36:39], a[196:199], v[16:31]
  buffer_store_dwordx4 v[52:55], v216, s[8:11], s72 offen offset:256 sc1
  s_waitcnt lgkmcnt(2)
  v_mfma_f32_32x32x16_bf16 v[0:15], a[56:59], v[40:43], v[0:15]
  ds_read_b128 v[36:39], v204 offset:4096
  v_mfma_f32_32x32x16_bf16 v[16:31], v[40:43], a[200:203], v[16:31]
  s_waitcnt lgkmcnt(2)
  v_mfma_f32_32x32x16_bf16 v[0:15], a[60:63], v[44:47], v[0:15]
  ds_read_b128 v[40:43], v205 offset:4096
  v_cvt_pk_bf16_f32 v56, v84, v85
  v_cvt_pk_bf16_f32 v57, v88, v89
  v_cvt_pk_bf16_f32 v58, v92, v93
  v_cvt_pk_bf16_f32 v59, v96, v97
  v_mfma_f32_32x32x16_bf16 v[16:31], v[44:47], a[204:207], v[16:31]
  buffer_store_dwordx4 v[56:59], v217, s[8:11], s64 offen offset:0 sc1
  s_waitcnt lgkmcnt(2)
  v_mfma_f32_32x32x16_bf16 v[0:15], a[64:67], v[32:35], v[0:15]
  ds_read_b128 v[44:47], v206 offset:4096
  v_mfma_f32_32x32x16_bf16 v[16:31], v[32:35], a[208:211], v[16:31]
  s_waitcnt lgkmcnt(2)
  v_mfma_f32_32x32x16_bf16 v[0:15], a[68:71], v[36:39], v[0:15]
  ds_read_b128 v[32:35], v203 offset:5120
  v_cvt_pk_bf16_f32 v60, v86, v87
  v_cvt_pk_bf16_f32 v61, v90, v91
  v_cvt_pk_bf16_f32 v62, v94, v95
  v_cvt_pk_bf16_f32 v63, v98, v99
  v_mfma_f32_32x32x16_bf16 v[16:31], v[36:39], a[212:215], v[16:31]
  buffer_store_dwordx4 v[60:63], v217, s[8:11], s64 offen offset:256 sc1
  s_waitcnt lgkmcnt(2)
  v_mfma_f32_32x32x16_bf16 v[0:15], a[72:75], v[40:43], v[0:15]
  ds_read_b128 v[36:39], v204 offset:5120
  v_mfma_f32_32x32x16_bf16 v[16:31], v[40:43], a[216:219], v[16:31]
  s_waitcnt lgkmcnt(2)
  v_mfma_f32_32x32x16_bf16 v[0:15], a[76:79], v[44:47], v[0:15]
  ds_read_b128 v[40:43], v205 offset:5120
  buffer_store_dwordx4 v[64:67], v201, s[8:11], s73 offen sc1
  v_mfma_f32_32x32x16_bf16 v[16:31], v[44:47], a[220:223], v[16:31]
  s_waitcnt lgkmcnt(2)
  v_mfma_f32_32x32x16_bf16 v[0:15], a[80:83], v[32:35], v[0:15]
  ds_read_b128 v[44:47], v206 offset:5120
  v_mfma_f32_32x32x16_bf16 v[16:31], v[32:35], a[224:227], v[16:31]
  s_waitcnt lgkmcnt(2)
  v_mfma_f32_32x32x16_bf16 v[0:15], a[84:87], v[36:39], v[0:15]
  ds_read_b128 v[32:35], v203 offset:6144
  v_mfma_f32_32x32x16_bf16 v[16:31], v[36:39], a[228:231], v[16:31]
  s_waitcnt lgkmcnt(2)
  v_mfma_f32_32x32x16_bf16 v[0:15], a[88:91], v[40:43], v[0:15]
  ds_read_b128 v[36:39], v204 offset:6144
  v_mfma_f32_32x32x16_bf16 v[16:31], v[40:43], a[232:235], v[16:31]
  s_waitcnt lgkmcnt(2)
  v_mfma_f32_32x32x16_bf16 v[0:15], a[92:95], v[44:47], v[0:15]
  ds_read_b128 v[40:43], v205 offset:6144
  v_mfma_f32_32x32x16_bf16 v[16:31], v[44:47], a[236:239], v[16:31]
  s_waitcnt lgkmcnt(2)
  v_mfma_f32_32x32x16_bf16 v[0:15], a[96:99], v[32:35], v[0:15]
  ds_read_b128 v[44:47], v206 offset:6144
  v_mfma_f32_32x32x16_bf16 v[16:31], v[32:35], a[240:243], v[16:31]
  s_waitcnt lgkmcnt(2)
  v_mfma_f32_32x32x16_bf16 v[0:15], a[100:103], v[36:39], v[0:15]
  ds_read_b128 v[32:35], v203 offset:7168
  v_mfma_f32_32x32x16_bf16 v[16:31], v[36:39], a[244:247], v[16:31]
  s_waitcnt lgkmcnt(2)
  v_mfma_f32_32x32x16_bf16 v[0:15], a[104:107], v[40:43], v[0:15]
  ds_read_b128 v[36:39], v204 offset:7168
  v_mfma_f32_32x32x16_bf16 v[16:31], v[40:43], a[248:251], v[16:31]
  s_waitcnt lgkmcnt(2)
  v_mfma_f32_32x32x16_bf16 v[0:15], a[108:111], v[44:47], v[0:15]
  ds_read_b128 v[40:43], v205 offset:7168
  v_mfma_f32_32x32x16_bf16 v[16:31], v[44:47], a[252:255], v[16:31]
  s_waitcnt lgkmcnt(2)
  v_mfma_f32_32x32x16_bf16 v[0:15], a[112:115], v[32:35], v[0:15]
  ds_read_b128 v[44:47], v206 offset:7168
  v_mfma_f32_32x32x16_bf16 v[16:31], v[32:35], v[224:227], v[16:31]
  s_waitcnt lgkmcnt(2)
  v_mfma_f32_32x32x16_bf16 v[0:15], a[116:119], v[36:39], v[0:15]
  ds_read_b128 v[32:35], v203 offset:8192
  v_mfma_f32_32x32x16_bf16 v[16:31], v[36:39], v[228:231], v[16:31]
  s_waitcnt lgkmcnt(2)
  v_mfma_f32_32x32x16_bf16 v[0:15], a[120:123], v[40:43], v[0:15]
  ds_read_b128 v[36:39], v204 offset:8192
  v_mfma_f32_32x32x16_bf16 v[16:31], v[40:43], v[232:235], v[16:31]
  s_waitcnt lgkmcnt(2)
  v_mfma_f32_32x32x16_bf16 v[0:15], a[124:127], v[44:47], v[0:15]
  ds_read_b128 v[40:43], v205 offset:8192
  v_mfma_f32_32x32x16_bf16 v[16:31], v[44:47], v[236:239], v[16:31]
  s_waitcnt lgkmcnt(2)
  v_mfma_f32_32x32x16_bf16 v[0:15], a[128:131], v[32:35], v[0:15]
  ds_read_b128 v[44:47], v206 offset:8192
  v_mfma_f32_32x32x16_bf16 v[16:31], v[32:35], v[240:243], v[16:31]
  s_waitcnt lgkmcnt(2)
  v_mfma_f32_32x32x16_bf16 v[0:15], a[132:135], v[36:39], v[0:15]
  v_mfma_f32_32x32x16_bf16 v[16:31], v[36:39], v[244:247], v[16:31]
  s_waitcnt lgkmcnt(1)
  v_mfma_f32_32x32x16_bf16 v[0:15], a[136:139], v[40:43], v[0:15]
  v_mfma_f32_32x32x16_bf16 v[16:31], v[40:43], v[248:251], v[16:31]
  s_waitcnt lgkmcnt(0)
  v_mfma_f32_32x32x16_bf16 v[0:15], a[140:143], v[44:47], v[0:15]
  v_mfma_f32_32x32x16_bf16 v[16:31], v[44:47], v[252:255], v[16:31]
  s_mul_i32 s64, s59, 655360
  s_lshl_b32 s55, s58, 14
  s_add_u32 s64, s64, s55
  s_add_u32 s64, s64, 1048576
  s_add_u32 s72, s64, s69
  s_add_u32 s73, s64, s66
  s_add_u32 s59, s59, 7
  s_cmp_ge_u32 s59, 64
  s_cbranch_scc1 KV_done0
  s_sub_u32 s54, s59, 21
  s_cmp_lt_u32 s54, 7
  s_cbranch_scc1 KV_early
  s_waitcnt vmcnt(5)
  s_barrier
KV_cont:
  s_branch KV_loop
KV_early:
  s_waitcnt vmcnt(0)
  s_barrier
  s_cmp_eq_u32 s52, 0
  s_cbranch_scc0 KV_sig0
  v_mov_b32 v211, 1
  v_mov_b32 v212, 0
  s_mov_b64 exec, 1
  buffer_atomic_add v211, v212, s[12:15], s70 offen
  s_mov_b64 exec, -1
KV_sig0:
  s_branch KV_cont
KV_done1:
  s_nop 11
  v_mul_f32 v68, s68, v68
  v_mul_f32 v69, s68, v69
  v_mul_f32 v70, s68, v70
  v_mul_f32 v71, s68, v71
  v_mul_f32 v72, s68, v72
  v_mul_f32 v73, s68, v73
  v_mul_f32 v74, s68, v74
  v_mul_f32 v75, s68, v75
  v_cvt_pk_bf16_f32 v48, v68, v72
  v_cvt_pk_bf16_f32 v49, v69, v73
  v_cvt_pk_bf16_f32 v50, v70, v74
  v_cvt_pk_bf16_f32 v51, v71, v75
  buffer_store_dwordx4 v[48:51], v216, s[8:11], s72 offen offset:0 sc1
  v_mul_f32 v76, s68, v76
  v_mul_f32 v77, s68, v77
  v_mul_f32 v78, s68, v78
  v_mul_f32 v79, s68, v79
  v_mul_f32 v80, s68, v80
  v_mul_f32 v81, s68, v81
  v_mul_f32 v82, s68, v82
  v_mul_f32 v83, s68, v83
  v_cvt_pk_bf16_f32 v52, v76, v80
  v_cvt_pk_bf16_f32 v53, v77, v81
  v_cvt_pk_bf16_f32 v54, v78, v82
  v_cvt_pk_bf16_f32 v55, v79, v83
  buffer_store_dwordx4 v[52:55], v216, s[8:11], s72 offen offset:256 sc1
  v_cvt_pk_bf16_f32 v56, v84, v85
  v_cvt_pk_bf16_f32 v57, v88, v89
  v_cvt_pk_bf16_f32 v58, v92, v93
  v_cvt_pk_bf16_f32 v59, v96, v97
  buffer_store_dwordx4 v[56:59], v217, s[8:11], s64 offen offset:0 sc1
  v_cvt_pk_bf16_f32 v60, v86, v87
  v_cvt_pk_bf16_f32 v61, v90, v91
  v_cvt_pk_bf16_f32 v62, v94, v95
  v_cvt_pk_bf16_f32 v63, v98, v99
  buffer_store_dwordx4 v[60:63], v217, s[8:11], s64 offen offset:256 sc1
  buffer_store_dwordx4 v[64:67], v201, s[8:11], s73 offen sc1
  s_branch KV_fin
KV_done0:
  s_nop 11
  v_mul_f32 v0, s68, v0
  v_mul_f32 v1, s68, v1
  v_mul_f32 v2, s68, v2
  v_mul_f32 v3, s68, v3
  v_mul_f32 v4, s68, v4
  v_mul_f32 v5, s68, v5
  v_mul_f32 v6, s68, v6
  v_mul_f32 v7, s68, v7
  v_cvt_pk_bf16_f32 v48, v0, v4
  v_cvt_pk_bf16_f32 v49, v1, v5
  v_cvt_pk_bf16_f32 v50, v2, v6
  v_cvt_pk_bf16_f32 v51, v3, v7
  buffer_store_dwordx4 v[48:51], v216, s[8:11], s72 offen offset:0 sc1
  v_mul_f32 v8, s68, v8
  v_mul_f32 v9, s68, v9
  v_mul_f32 v10, s68, v10
  v_mul_f32 v11, s68, v11
  v_mul_f32 v12, s68, v12
  v_mul_f32 v13, s68, v13
  v_mul_f32 v14, s68, v14
  v_mul_f32 v15, s68, v15
  v_cvt_pk_bf16_f32 v52, v8, v12
  v_cvt_pk_bf16_f32 v53, v9, v13
  v_cvt_pk_bf16_f32 v54, v10, v14
  v_cvt_pk_bf16_f32 v55, v11, v15
  buffer_store_dwordx4 v[52:55], v216, s[8:11], s72 offen offset:256 sc1
  v_cvt_pk_bf16_f32 v56, v16, v17
  v_cvt_pk_bf16_f32 v57, v20, v21
  v_cvt_pk_bf16_f32 v58, v24, v25
  v_cvt_pk_bf16_f32 v59, v28, v29
  buffer_store_dwordx4 v[56:59], v217, s[8:11], s64 offen offset:0 sc1
  v_cvt_pk_bf16_f32 v60, v18, v19
  v_cvt_pk_bf16_f32 v61, v22, v23
  v_cvt_pk_bf16_f32 v62, v26, v27
  v_cvt_pk_bf16_f32 v63, v30, v31
  buffer_store_dwordx4 v[60:63], v217, s[8:11], s64 offen offset:256 sc1
  buffer_store_dwordx4 v[64:67], v201, s[8:11], s73 offen sc1
KV_fin:
  s_waitcnt vmcnt(0)
  s_barrier
  s_cmp_eq_u32 s52, 0
  s_cbranch_scc0 KV_sig
  v_mov_b32 v211, 256
  v_mov_b32 v212, 0
  s_mov_b64 exec, 1
  buffer_atomic_add v211, v212, s[12:15], s70 offen
  s_mov_b64 exec, -1
KV_sig:
  s_cmp_ge_u32 s53, 192
  s_cbranch_scc1 L_exit
  s_cmp_lt_u32 s53, 64
  s_cbranch_scc1 W_h
  s_sub_u32 s54, s53, 64
  s_lshr_b32 s68, s54, 4
  s_and_b32 s69, s54, 15
  s_lshl_b32 s60, s69, 2
  s_sub_u32 s60, s60, 1
  s_max_i32 s60, s60, 0
  s_mul_i32 s60, s60, 36864
  s_add_u32 m0, s67, 0
  s_nop 0
  buffer_load_dwordx4 v202, s[4:7], s60 offen offset:0 lds
  s_add_u32 m0, s67, 896
  s_nop 0
  buffer_load_dwordx4 v202, s[4:7], s60 offen offset:128 lds
  s_add_u32 m0, s67, 1792
  s_nop 0
  buffer_load_dwordx4 v202, s[4:7], s60 offen offset:256 lds
  s_add_u32 m0, s67, 2688
  s_nop 0
  buffer_load_dwordx4 v202, s[4:7], s60 offen offset:384 lds
  s_add_u32 m0, s67, 3584
  s_nop 0
  buffer_load_dwordx4 v202, s[4:7], s60 offen offset:512 lds
  s_add_u32 m0, s67, 4480
  s_nop 0
  buffer_load_dwordx4 v202, s[4:7], s60 offen offset:640 lds
  s_add_u32 m0, s67, 5376
  s_nop 0
  buffer_load_dwordx4 v202, s[4:7], s60 offen offset:768 lds
  s_add_u32 m0, s67, 6272
  s_nop 0
  buffer_load_dwordx4 v202, s[4:7], s60 offen offset:896 lds
  s_add_u32 m0, s67, 7168
  s_nop 0
  buffer_load_dwordx4 v202, s[4:7], s60 offen offset:1024 lds
  v_and_b32 v211, 15, v200
  v_mul_u32_u24 v211, 72, v211
  v_lshrrev_b32 v212, 4, v200
  v_mul_u32_u24 v213, 1152, v212
  v_add_u32 v213, v213, v211
  s_lshl_b32 s54, s54, 2
  s_add_u32 s70, s54, s52
  s_mul_i32 s55, s70, 4608
  buffer_load_dwordx4 v[48:51], v213, s[4:7], s55 offen offset:0
  buffer_load_dwordx4 v[52:55], v213, s[4:7], s55 offen offset:16
  buffer_load_dwordx4 v[56:59], v213, s[4:7], s55 offen offset:32
  buffer_load_dwordx4 v[60:63], v213, s[4:7], s55 offen offset:48
  buffer_load_dwordx2 v[64:65], v213, s[4:7], s55 offen offset:64
  buffer_load_dwordx4 v[68:71], v211, s[44:47], 0 offen offset:0
  buffer_load_dwordx4 v[72:75], v211, s[44:47], 0 offen offset:16
  buffer_load_dwordx4 v[76:79], v211, s[44:47], 0 offen offset:32
  buffer_load_dwordx4 v[80:83], v211, s[44:47], 0 offen offset:48
  buffer_load_dwordx2 v[84:85], v211, s[44:47], 0 offen offset:64
  v_mov_b32 v0, 0
  v_mov_b32 v1, 0x3f803f80
  s_waitcnt vmcnt(9)
  v_lshlrev_b32 v2, 16, v48
  s_waitcnt vmcnt(4)
  v_lshlrev_b32 v3, 16, v68
  v_and_b32 v4, 0xffff0000, v48
  v_and_b32 v5, 0xffff0000, v68
  v_mul_f32 v2, v2, v3
  v_mul_f32 v4, v4, v5
  v_cvt_pk_bf16_f32 v2, v2, v4
  v_lshlrev_b32 v3, 16, v2
  v_and_b32 v4, 0xffff0000, v2
  v_add_f32 v0, v0, v3
  v_add_f32 v0, v0, v4
  v_lshlrev_b32 v2, 16, v49
  v_lshlrev_b32 v3, 16, v69
  v_and_b32 v4, 0xffff0000, v49
  v_and_b32 v5, 0xffff0000, v69
  v_mul_f32 v2, v2, v3
  v_mul_f32 v4, v4, v5
  v_cvt_pk_bf16_f32 v2, v2, v4
  v_lshlrev_b32 v3, 16, v2
  v_and_b32 v4, 0xffff0000, v2
  v_add_f32 v0, v0, v3
  v_add_f32 v0, v0, v4
  v_lshlrev_b32 v2, 16, v50
  v_lshlrev_b32 v3, 16, v70
  v_and_b32 v4, 0xffff0000, v50
  v_and_b32 v5, 0xffff0000, v70
  v_mul_f32 v2, v2, v3
  v_mul_f32 v4, v4, v5
  v_cvt_pk_bf16_f32 v2, v2, v4
  v_lshlrev_b32 v3, 16, v2
  v_and_b32 v4, 0xffff0000, v2
  v_add_f32 v0, v0, v3
  v_add_f32 v0, v0, v4
  v_lshlrev_b32 v2, 16, v51
  v_lshlrev_b32 v3, 16, v71
  v_and_b32 v4, 0xffff0000, v51
  v_and_b32 v5, 0xffff0000, v71
  v_mul_f32 v2, v2, v3
  v_mul_f32 v4, v4, v5
  v_cvt_pk_bf16_f32 v2, v2, v4
  v_lshlrev_b32 v3, 16, v2
  v_and_b32 v4, 0xffff0000, v2
  v_add_f32 v0, v0, v3
  v_add_f32 v0, v0, v4
  v_lshlrev_b32 v2, 16, v52
  s_waitcnt vmcnt(3)
  v_lshlrev_b32 v3, 16, v72
  v_and_b32 v4, 0xffff0000, v52
  v_and_b32 v5, 0xffff0000, v72
  v_mul_f32 v2, v2, v3
  v_mul_f32 v4, v4, v5
  v_cvt_pk_bf16_f32 v2, v2, v4
  v_lshlrev_b32 v3, 16, v2
  v_and_b32 v4, 0xffff0000, v2
  v_add_f32 v0, v0, v3
  v_add_f32 v0, v0, v4
  v_lshlrev_b32 v2, 16, v53
  v_lshlrev_b32 v3, 16, v73
  v_and_b32 v4, 0xffff0000, v53
  v_and_b32 v5, 0xffff0000, v73
  v_mul_f32 v2, v2, v3
  v_mul_f32 v4, v4, v5
  v_cvt_pk_bf16_f32 v2, v2, v4
  v_lshlrev_b32 v3, 16, v2
  v_and_b32 v4, 0xffff0000, v2
  v_add_f32 v0, v0, v3
  v_add_f32 v0, v0, v4
  v_lshlrev_b32 v2, 16, v54
  v_lshlrev_b32 v3, 16, v74
  v_and_b32 v4, 0xffff0000, v54
  v_and_b32 v5, 0xffff0000, v74
  v_mul_f32 v2, v2, v3
  v_mul_f32 v4, v4, v5
  v_cvt_pk_bf16_f32 v2, v2, v4
  v_lshlrev_b32 v3, 16, v2
  v_and_b32 v4, 0xffff0000, v2
  v_add_f32 v0, v0, v3
  v_add_f32 v0, v0, v4
  v_lshlrev_b32 v2, 16, v55
  v_lshlrev_b32 v3, 16, v75
  v_and_b32 v4, 0xffff0000, v55
  v_and_b32 v5, 0xffff0000, v75
  v_mul_f32 v2, v2, v3
  v_mul_f32 v4, v4, v5
  v_cvt_pk_bf16_f32 v2, v2, v4
  v_lshlrev_b32 v3, 16, v2
  v_and_b32 v4, 0xffff0000, v2
  v_add_f32 v0, v0, v3
  v_add_f32 v0, v0, v4
  v_lshlrev_b32 v2, 16, v56
  s_waitcnt vmcnt(2)
  v_lshlrev_b32 v3, 16, v76
  v_and_b32 v4, 0xffff0000, v56
  v_and_b32 v5, 0xffff0000, v76
  v_mul_f32 v2, v2, v3
  v_mul_f32 v4, v4, v5
  v_cvt_pk_bf16_f32 v2, v2, v4
  v_lshlrev_b32 v3, 16, v2
  v_and_b32 v4, 0xffff0000, v2
  v_add_f32 v0, v0, v3
  v_add_f32 v0, v0, v4
  v_lshlrev_b32 v2, 16, v57
  v_lshlrev_b32 v3, 16, v77
  v_and_b32 v4, 0xffff0000, v57
  v_and_b32 v5, 0xffff0000, v77
  v_mul_f32 v2, v2, v3
  v_mul_f32 v4, v4, v5
  v_cvt_pk_bf16_f32 v2, v2, v4
  v_lshlrev_b32 v3, 16, v2
  v_and_b32 v4, 0xffff0000, v2
  v_add_f32 v0, v0, v3
  v_add_f32 v0, v0, v4
  v_lshlrev_b32 v2, 16, v58
  v_lshlrev_b32 v3, 16, v78
  v_and_b32 v4, 0xffff0000, v58
  v_and_b32 v5, 0xffff0000, v78
  v_mul_f32 v2, v2, v3
  v_mul_f32 v4, v4, v5
  v_cvt_pk_bf16_f32 v2, v2, v4
  v_lshlrev_b32 v3, 16, v2
  v_and_b32 v4, 0xffff0000, v2
  v_add_f32 v0, v0, v3
  v_add_f32 v0, v0, v4
  v_lshlrev_b32 v2, 16, v59
  v_lshlrev_b32 v3, 16, v79
  v_and_b32 v4, 0xffff0000, v59
  v_and_b32 v5, 0xffff0000, v79
  v_mul_f32 v2, v2, v3
  v_mul_f32 v4, v4, v5
  v_cvt_pk_bf16_f32 v2, v2, v4
  v_lshlrev_b32 v3, 16, v2
  v_and_b32 v4, 0xffff0000, v2
  v_add_f32 v0, v0, v3
  v_add_f32 v0, v0, v4
  v_lshlrev_b32 v2, 16, v60
  s_waitcnt vmcnt(1)
  v_lshlrev_b32 v3, 16, v80
  v_and_b32 v4, 0xffff0000, v60
  v_and_b32 v5, 0xffff0000, v80
  v_mul_f32 v2, v2, v3
  v_mul_f32 v4, v4, v5
  v_cvt_pk_bf16_f32 v2, v2, v4
  v_lshlrev_b32 v3, 16, v2
  v_and_b32 v4, 0xffff0000, v2
  v_add_f32 v0, v0, v3
  v_add_f32 v0, v0, v4
  v_lshlrev_b32 v2, 16, v61
  v_lshlrev_b32 v3, 16, v81
  v_and_b32 v4, 0xffff0000, v61
  v_and_b32 v5, 0xffff0000, v81
  v_mul_f32 v2, v2, v3
  v_mul_f32 v4, v4, v5
  v_cvt_pk_bf16_f32 v2, v2, v4
  v_lshlrev_b32 v3, 16, v2
  v_and_b32 v4, 0xffff0000, v2
  v_add_f32 v0, v0, v3
  v_add_f32 v0, v0, v4
  v_lshlrev_b32 v2, 16, v62
  v_lshlrev_b32 v3, 16, v82
  v_and_b32 v4, 0xffff0000, v62
  v_and_b32 v5, 0xffff0000, v82
  v_mul_f32 v2, v2, v3
  v_mul_f32 v4, v4, v5
  v_cvt_pk_bf16_f32 v2, v2, v4
  v_lshlrev_b32 v3, 16, v2
  v_and_b32 v4, 0xffff0000, v2
  v_add_f32 v0, v0, v3
  v_add_f32 v0, v0, v4
  v_lshlrev_b32 v2, 16, v63
  v_lshlrev_b32 v3, 16, v83
  v_and_b32 v4, 0xffff0000, v63
  v_and_b32 v5, 0xffff0000, v83
  v_mul_f32 v2, v2, v3
  v_mul_f32 v4, v4, v5
  v_cvt_pk_bf16_f32 v2, v2, v4
  v_lshlrev_b32 v3, 16, v2
  v_and_b32 v4, 0xffff0000, v2
  v_add_f32 v0, v0, v3
  v_add_f32 v0, v0, v4
  v_lshlrev_b32 v2, 16, v64
  s_waitcnt vmcnt(0)
  v_lshlrev_b32 v3, 16, v84
  v_and_b32 v4, 0xffff0000, v64
  v_and_b32 v5, 0xffff0000, v84
  v_mul_f32 v2, v2, v3
  v_mul_f32 v4, v4, v5
  v_cvt_pk_bf16_f32 v2, v2, v4
  v_lshlrev_b32 v3, 16, v2
  v_and_b32 v4, 0xffff0000, v2
  v_add_f32 v0, v0, v3
  v_add_f32 v0, v0, v4
  v_lshlrev_b32 v2, 16, v65
  v_lshlrev_b32 v3, 16, v85
  v_and_b32 v4, 0xffff0000, v65
  v_and_b32 v5, 0xffff0000, v85
  v_mul_f32 v2, v2, v3
  v_mul_f32 v4, v4, v5
  v_cvt_pk_bf16_f32 v2, v2, v4
  v_lshlrev_b32 v3, 16, v2
  v_and_b32 v4, 0xffff0000, v2
  v_add_f32 v0, v0, v3
  v_add_f32 v0, v0, v4
  s_nop 1
  v_add_f32_dpp v0, v0, v0 row_ror:1 row_mask:0xf bank_mask:0xf
  s_nop 1
  v_add_f32_dpp v0, v0, v0 row_ror:2 row_mask:0xf bank_mask:0xf
  s_nop 1
  v_add_f32_dpp v0, v0, v0 row_ror:4 row_mask:0xf bank_mask:0xf
  s_nop 1
  v_add_f32_dpp v0, v0, v0 row_ror:8 row_mask:0xf bank_mask:0xf
  v_cvt_pk_bf16_f32 v0, v0, v0
  v_lshlrev_b32 v0, 16, v0
  v_mul_f32 v0, 3216550459, v0
  v_exp_f32 v0, v0
  s_nop 0
  v_add_f32 v0, 1.0, v0
  v_rcp_f32 v0, v0
  s_nop 0
  v_cvt_pk_bf16_f32 v0, v0, v0
  v_lshlrev_b32 v0, 16, v0
  v_lshlrev_b32 v212, 2, v212
  s_lshl_b32 s55, s70, 4
  s_add_u32 s55, s55, 66060288
  s_mov_b32 exec_lo, 0x00010001
  s_mov_b32 exec_hi, 0x00010001
  buffer_store_dword v0, v212, s[8:11], s55 offen sc1
  s_mov_b64 exec, -1
  v_lshrrev_b32 v211, 4, v200
  v_lshlrev_b32 v212, 2, v211
  v_and_b32 v213, 15, v200
  v_xor_b32 v212, v212, v213
  v_mul_u32_u24 v211, 3456, v211
  v_mov_b32 v2, 0x40000000
  v_add_u32 v213, 0, v212
  v_mul_u32_u24 v214, 57, v213
  v_lshrrev_b32 v214, 9, v214
  v_mul_u32_u24 v214, 1008, v214
  v_lshl_add_u32 v214, v213, 4, v214
  v_add_u32 v214, v214, v211
  v_cmp_lt_u32 vcc, 26, v213
  s_nop 1
  v_cndmask_b32 v207, v214, v2, vcc
  v_add_u32 v213, 16, v212
  v_mul_u32_u24 v214, 57, v213
  v_lshrrev_b32 v214, 9, v214
  v_mul_u32_u24 v214, 1008, v214
  v_lshl_add_u32 v214, v213, 4, v214
  v_add_u32 v214, v214, v211
  v_cmp_lt_u32 vcc, 26, v213
  s_nop 1
  v_cndmask_b32 v208, v214, v2, vcc
  s_mul_i32 s62, s68, 144
  s_mul_i32 s54, s52, 13824
  s_add_u32 s62, s62, s54
  s_waitcnt vmcnt(0)
  s_lshl_b32 s61, s52, 10
  s_add_u32 s61, s61, 36864
  s_add_u32 m0, s61, 0
  s_add_u32 s54, s62, 0
  buffer_load_dwordx4 v207, s[36:39], s54 offen lds
  s_add_u32 m0, s61, 4096
  s_add_u32 s54, s62, 55296
  buffer_load_dwordx4 v207, s[36:39], s54 offen lds
  s_add_u32 m0, s61, 8192
  s_add_u32 s54, s62, 110592
  buffer_load_dwordx4 v207, s[36:39], s54 offen lds
  s_add_u32 m0, s61, 12288
  s_add_u32 s54, s62, 165888
  buffer_load_dwordx4 v207, s[36:39], s54 offen lds
  s_add_u32 m0, s61, 16384
  s_add_u32 s54, s62, 0
  buffer_load_dwordx4 v208, s[36:39], s54 offen lds
  s_add_u32 m0, s61, 20480
  s_add_u32 s54, s62, 55296
  buffer_load_dwordx4 v208, s[36:39], s54 offen lds
  s_add_u32 m0, s61, 24576
  s_add_u32 s54, s62, 110592
  buffer_load_dwordx4 v208, s[36:39], s54 offen lds
  s_add_u32 m0, s61, 28672
  s_add_u32 s54, s62, 165888
  buffer_load_dwordx4 v208, s[36:39], s54 offen lds
  s_add_u32 m0, s61, 32768
  s_add_u32 s54, s62, 221184
  buffer_load_dwordx4 v207, s[36:39], s54 offen lds
  s_add_u32 m0, s61, 36864
  s_add_u32 s54, s62, 276480
  buffer_load_dwordx4 v207, s[36:39], s54 offen lds
  s_add_u32 m0, s61, 40960
  s_add_u32 s54, s62, 331776
  buffer_load_dwordx4 v207, s[36:39], s54 offen lds
  s_add_u32 m0, s61, 45056
  s_add_u32 s54, s62, 387072
  buffer_load_dwordx4 v207, s[36:39], s54 offen lds
  s_add_u32 m0, s61, 49152
  s_add_u32 s54, s62, 221184
  buffer_load_dwordx4 v208, s[36:39], s54 offen lds
  s_add_u32 m0, s61, 53248
  s_add_u32 s54, s62, 276480
  buffer_load_dwordx4 v208, s[36:39], s54 offen lds
  s_add_u32 m0, s61, 57344
  s_add_u32 s54, s62, 331776
  buffer_load_dwordx4 v208, s[36:39], s54 offen lds
  s_add_u32 m0, s61, 61440
  s_add_u32 s54, s62, 387072
  buffer_load_dwordx4 v208, s[36:39], s54 offen lds
  s_add_u32 m0, s61, 65536
  s_add_u32 s54, s62, 442368
  buffer_load_dwordx4 v207, s[36:39], s54 offen lds
  s_add_u32 m0, s61, 69632
  s_add_u32 s54, s62, 497664
  buffer_load_dwordx4 v207, s[36:39], s54 offen lds
  s_add_u32 m0, s61, 73728
  s_add_u32 s54, s62, 552960
  buffer_load_dwordx4 v207, s[36:39], s54 offen lds
  s_add_u32 m0, s61, 77824
  s_add_u32 s54, s62, 608256
  buffer_load_dwordx4 v207, s[36:39], s54 offen lds
  s_add_u32 m0, s61, 81920
  s_add_u32 s54, s62, 442368
  buffer_load_dwordx4 v208, s[36:39], s54 offen lds
  s_add_u32 m0, s61, 86016
  s_add_u32 s54, s62, 497664
  buffer_load_dwordx4 v208, s[36:39], s54 offen lds
  s_add_u32 m0, s61, 90112
  s_add_u32 s54, s62, 552960
  buffer_load_dwordx4 v208, s[36:39], s54 offen lds
  s_add_u32 m0, s61, 94208
  s_add_u32 s54, s62, 608256
  buffer_load_dwordx4 v208, s[36:39], s54 offen lds
  s_waitcnt vmcnt(20) lgkmcnt(0)
  s_barrier
  s_add_u32 m0, s61, 98304
  s_add_u32 s54, s62, 663552
  buffer_load_dwordx4 v207, s[36:39], s54 offen lds
  s_add_u32 m0, s61, 102400
  s_add_u32 s54, s62, 718848
  buffer_load_dwordx4 v207, s[36:39], s54 offen lds
  s_add_u32 m0, s61, 106496
  s_add_u32 s54, s62, 774144
  buffer_load_dwordx4 v207, s[36:39], s54 offen lds
  s_add_u32 m0, s61, 110592
  s_add_u32 s54, s62, 829440
  buffer_load_dwordx4 v207, s[36:39], s54 offen lds
  v_add_u32 v215, 36864, v210
  ds_read_b64_tr_b16 a[0:1], v215 offset:0
  ds_read_b64_tr_b16 a[2:3], v215 offset:1024
  ds_read_b64_tr_b16 a[4:5], v215 offset:4096
  ds_read_b64_tr_b16 a[6:7], v215 offset:5120
  ds_read_b64_tr_b16 a[8:9], v215 offset:8192
  ds_read_b64_tr_b16 a[10:11], v215 offset:9216
  ds_read_b64_tr_b16 a[12:13], v215 offset:12288
  ds_read_b64_tr_b16 a[14:15], v215 offset:13312
  s_waitcnt vmcnt(20) lgkmcnt(0)
  s_barrier
  s_add_u32 m0, s61, 0
  s_add_u32 s54, s62, 663552
  buffer_load_dwordx4 v208, s[36:39], s54 offen lds
  s_add_u32 m0, s61, 4096
  s_add_u32 s54, s62, 718848
  buffer_load_dwordx4 v208, s[36:39], s54 offen lds
  s_add_u32 m0, s61, 8192
  s_add_u32 s54, s62, 774144
  buffer_load_dwordx4 v208, s[36:39], s54 offen lds
  s_add_u32 m0, s61, 12288
  s_add_u32 s54, s62, 829440
  buffer_load_dwordx4 v208, s[36:39], s54 offen lds
  v_add_u32 v215, 53248, v210
  ds_read_b64_tr_b16 a[144:145], v215 offset:0
  ds_read_b64_tr_b16 a[146:147], v215 offset:1024
  ds_read_b64_tr_b16 a[148:149], v215 offset:4096
  ds_read_b64_tr_b16 a[150:151], v215 offset:5120
  ds_read_b64_tr_b16 a[152:153], v215 offset:8192
  ds_read_b64_tr_b16 a[154:155], v215 offset:9216
  ds_read_b64_tr_b16 a[156:157], v215 offset:12288
  ds_read_b64_tr_b16 a[158:159], v215 offset:13312
  s_waitcnt vmcnt(20) lgkmcnt(0)
  s_barrier
  s_add_u32 m0, s61, 16384
  s_add_u32 s54, s62, 884736
  buffer_load_dwordx4 v207, s[36:39], s54 offen lds
  s_add_u32 m0, s61, 20480
  s_add_u32 s54, s62, 940032
  buffer_load_dwordx4 v207, s[36:39], s54 offen lds
  s_add_u32 m0, s61, 24576
  s_add_u32 s54, s62, 995328
  buffer_load_dwordx4 v207, s[36:39], s54 offen lds
  s_add_u32 m0, s61, 28672
  s_add_u32 s54, s62, 1050624
  buffer_load_dwordx4 v207, s[36:39], s54 offen lds
  v_add_u32 v215, 69632, v210
  ds_read_b64_tr_b16 a[16:17], v215 offset:0
  ds_read_b64_tr_b16 a[18:19], v215 offset:1024
  ds_read_b64_tr_b16 a[20:21], v215 offset:4096
  ds_read_b64_tr_b16 a[22:23], v215 offset:5120
  ds_read_b64_tr_b16 a[24:25], v215 offset:8192
  ds_read_b64_tr_b16 a[26:27], v215 offset:9216
  ds_read_b64_tr_b16 a[28:29], v215 offset:12288
  ds_read_b64_tr_b16 a[30:31], v215 offset:13312
  s_waitcnt vmcnt(20) lgkmcnt(0)
  s_barrier
  s_add_u32 m0, s61, 32768
  s_add_u32 s54, s62, 884736
  buffer_load_dwordx4 v208, s[36:39], s54 offen lds
  s_add_u32 m0, s61, 36864
  s_add_u32 s54, s62, 940032
  buffer_load_dwordx4 v208, s[36:39], s54 offen lds
  s_add_u32 m0, s61, 40960
  s_add_u32 s54, s62, 995328
  buffer_load_dwordx4 v208, s[36:39], s54 offen lds
  s_add_u32 m0, s61, 45056
  s_add_u32 s54, s62, 1050624
  buffer_load_dwordx4 v208, s[36:39], s54 offen lds
  v_add_u32 v215, 86016, v210
  ds_read_b64_tr_b16 a[160:161], v215 offset:0
  ds_read_b64_tr_b16 a[162:163], v215 offset:1024
  ds_read_b64_tr_b16 a[164:165], v215 offset:4096
  ds_read_b64_tr_b16 a[166:167], v215 offset:5120
  ds_read_b64_tr_b16 a[168:169], v215 offset:8192
  ds_read_b64_tr_b16 a[170:171], v215 offset:9216
  ds_read_b64_tr_b16 a[172:173], v215 offset:12288
  ds_read_b64_tr_b16 a[174:175], v215 offset:13312
  s_waitcnt vmcnt(20) lgkmcnt(0)
  s_barrier
  s_add_u32 m0, s61, 49152
  s_add_u32 s54, s62, 1105920
  buffer_load_dwordx4 v207, s[36:39], s54 offen lds
  s_add_u32 m0, s61, 53248
  s_add_u32 s54, s62, 1161216
  buffer_load_dwordx4 v207, s[36:39], s54 offen lds
  s_add_u32 m0, s61, 57344
  s_add_u32 s54, s62, 1216512
  buffer_load_dwordx4 v207, s[36:39], s54 offen lds
  s_add_u32 m0, s61, 61440
  s_add_u32 s54, s62, 1271808
  buffer_load_dwordx4 v207, s[36:39], s54 offen lds
  v_add_u32 v215, 102400, v210
  ds_read_b64_tr_b16 a[32:33], v215 offset:0
  ds_read_b64_tr_b16 a[34:35], v215 offset:1024
  ds_read_b64_tr_b16 a[36:37], v215 offset:4096
  ds_read_b64_tr_b16 a[38:39], v215 offset:5120
  ds_read_b64_tr_b16 a[40:41], v215 offset:8192
  ds_read_b64_tr_b16 a[42:43], v215 offset:9216
  ds_read_b64_tr_b16 a[44:45], v215 offset:12288
  ds_read_b64_tr_b16 a[46:47], v215 offset:13312
  s_waitcnt vmcnt(20) lgkmcnt(0)
  s_barrier
  s_add_u32 m0, s61, 65536
  s_add_u32 s54, s62, 1105920
  buffer_load_dwordx4 v208, s[36:39], s54 offen lds
  s_add_u32 m0, s61, 69632
  s_add_u32 s54, s62, 1161216
  buffer_load_dwordx4 v208, s[36:39], s54 offen lds
  s_add_u32 m0, s61, 73728
  s_add_u32 s54, s62, 1216512
  buffer_load_dwordx4 v208, s[36:39], s54 offen lds
  s_add_u32 m0, s61, 77824
  s_add_u32 s54, s62, 1271808
  buffer_load_dwordx4 v208, s[36:39], s54 offen lds
  v_add_u32 v215, 118784, v210
  ds_read_b64_tr_b16 a[176:177], v215 offset:0
  ds_read_b64_tr_b16 a[178:179], v215 offset:1024
  ds_read_b64_tr_b16 a[180:181], v215 offset:4096
  ds_read_b64_tr_b16 a[182:183], v215 offset:5120
  ds_read_b64_tr_b16 a[184:185], v215 offset:8192
  ds_read_b64_tr_b16 a[186:187], v215 offset:9216
  ds_read_b64_tr_b16 a[188:189], v215 offset:12288
  ds_read_b64_tr_b16 a[190:191], v215 offset:13312
  s_waitcnt vmcnt(20) lgkmcnt(0)
  s_barrier
  s_add_u32 m0, s61, 81920
  s_add_u32 s54, s62, 1327104
  buffer_load_dwordx4 v207, s[36:39], s54 offen lds
  s_add_u32 m0, s61, 86016
  s_add_u32 s54, s62, 1382400
  buffer_load_dwordx4 v207, s[36:39], s54 offen lds
  s_add_u32 m0, s61, 90112
  s_add_u32 s54, s62, 1437696
  buffer_load_dwordx4 v207, s[36:39], s54 offen lds
  s_add_u32 m0, s61, 94208
  s_add_u32 s54, s62, 1492992
  buffer_load_dwordx4 v207, s[36:39], s54 offen lds
  v_add_u32 v215, 135168, v210
  ds_read_b64_tr_b16 a[48:49], v215 offset:0
  ds_read_b64_tr_b16 a[50:51], v215 offset:1024
  ds_read_b64_tr_b16 a[52:53], v215 offset:4096
  ds_read_b64_tr_b16 a[54:55], v215 offset:5120
  ds_read_b64_tr_b16 a[56:57], v215 offset:8192
  ds_read_b64_tr_b16 a[58:59], v215 offset:9216
  ds_read_b64_tr_b16 a[60:61], v215 offset:12288
  ds_read_b64_tr_b16 a[62:63], v215 offset:13312
  s_waitcnt vmcnt(20) lgkmcnt(0)
  s_barrier
  s_add_u32 m0, s61, 98304
  s_add_u32 s54, s62, 1327104
  buffer_load_dwordx4 v208, s[36:39], s54 offen lds
  s_add_u32 m0, s61, 102400
  s_add_u32 s54, s62, 1382400
  buffer_load_dwordx4 v208, s[36:39], s54 offen lds
  s_add_u32 m0, s61, 106496
  s_add_u32 s54, s62, 1437696
  buffer_load_dwordx4 v208, s[36:39], s54 offen lds
  s_add_u32 m0, s61, 110592
  s_add_u32 s54, s62, 1492992
  buffer_load_dwordx4 v208, s[36:39], s54 offen lds
  v_add_u32 v215, 36864, v210
  ds_read_b64_tr_b16 a[192:193], v215 offset:0
  ds_read_b64_tr_b16 a[194:195], v215 offset:1024
  ds_read_b64_tr_b16 a[196:197], v215 offset:4096
  ds_read_b64_tr_b16 a[198:199], v215 offset:5120
  ds_read_b64_tr_b16 a[200:201], v215 offset:8192
  ds_read_b64_tr_b16 a[202:203], v215 offset:9216
  ds_read_b64_tr_b16 a[204:205], v215 offset:12288
  ds_read_b64_tr_b16 a[206:207], v215 offset:13312
  s_waitcnt vmcnt(20) lgkmcnt(0)
  s_barrier
  s_add_u32 m0, s61, 0
  s_add_u32 s54, s62, 1548288
  buffer_load_dwordx4 v207, s[36:39], s54 offen lds
  s_add_u32 m0, s61, 4096
  s_add_u32 s54, s62, 1603584
  buffer_load_dwordx4 v207, s[36:39], s54 offen lds
  s_add_u32 m0, s61, 8192
  s_add_u32 s54, s62, 1658880
  buffer_load_dwordx4 v207, s[36:39], s54 offen lds
  s_add_u32 m0, s61, 12288
  s_add_u32 s54, s62, 1714176
  buffer_load_dwordx4 v207, s[36:39], s54 offen lds
  v_add_u32 v215, 53248, v210
  ds_read_b64_tr_b16 a[64:65], v215 offset:0
  ds_read_b64_tr_b16 a[66:67], v215 offset:1024
  ds_read_b64_tr_b16 a[68:69], v215 offset:4096
  ds_read_b64_tr_b16 a[70:71], v215 offset:5120
  ds_read_b64_tr_b16 a[72:73], v215 offset:8192
  ds_read_b64_tr_b16 a[74:75], v215 offset:9216
  ds_read_b64_tr_b16 a[76:77], v215 offset:12288
  ds_read_b64_tr_b16 a[78:79], v215 offset:13312
  s_waitcnt vmcnt(20) lgkmcnt(0)
  s_barrier
  s_add_u32 m0, s61, 16384
  s_add_u32 s54, s62, 1548288
  buffer_load_dwordx4 v208, s[36:39], s54 offen lds
  s_add_u32 m0, s61, 20480
  s_add_u32 s54, s62, 1603584
  buffer_load_dwordx4 v208, s[36:39], s54 offen lds
  s_add_u32 m0, s61, 24576
  s_add_u32 s54, s62, 1658880
  buffer_load_dwordx4 v208, s[36:39], s54 offen lds
  s_add_u32 m0, s61, 28672
  s_add_u32 s54, s62, 1714176
  buffer_load_dwordx4 v208, s[36:39], s54 offen lds
  v_add_u32 v215, 69632, v210
  ds_read_b64_tr_b16 a[208:209], v215 offset:0
  ds_read_b64_tr_b16 a[210:211], v215 offset:1024
  ds_read_b64_tr_b16 a[212:213], v215 offset:4096
  ds_read_b64_tr_b16 a[214:215], v215 offset:5120
  ds_read_b64_tr_b16 a[216:217], v215 offset:8192
  ds_read_b64_tr_b16 a[218:219], v215 offset:9216
  ds_read_b64_tr_b16 a[220:221], v215 offset:12288
  ds_read_b64_tr_b16 a[222:223], v215 offset:13312
  s_waitcnt vmcnt(20) lgkmcnt(0)
  s_barrier
  s_add_u32 m0, s61, 32768
  s_add_u32 s54, s62, 1769472
  buffer_load_dwordx4 v207, s[36:39], s54 offen lds
  s_add_u32 m0, s61, 36864
  s_add_u32 s54, s62, 1824768
  buffer_load_dwordx4 v207, s[36:39], s54 offen lds
  s_add_u32 m0, s61, 40960
  s_add_u32 s54, s62, 1880064
  buffer_load_dwordx4 v207, s[36:39], s54 offen lds
  s_add_u32 m0, s61, 45056
  s_add_u32 s54, s62, 1935360
  buffer_load_dwordx4 v207, s[36:39], s54 offen lds
  v_add_u32 v215, 86016, v210
  ds_read_b64_tr_b16 a[80:81], v215 offset:0
  ds_read_b64_tr_b16 a[82:83], v215 offset:1024
  ds_read_b64_tr_b16 a[84:85], v215 offset:4096
  ds_read_b64_tr_b16 a[86:87], v215 offset:5120
  ds_read_b64_tr_b16 a[88:89], v215 offset:8192
  ds_read_b64_tr_b16 a[90:91], v215 offset:9216
  ds_read_b64_tr_b16 a[92:93], v215 offset:12288
  ds_read_b64_tr_b16 a[94:95], v215 offset:13312
  s_waitcnt vmcnt(20) lgkmcnt(0)
  s_barrier
  s_add_u32 m0, s61, 49152
  s_add_u32 s54, s62, 1769472
  buffer_load_dwordx4 v208, s[36:39], s54 offen lds
  s_add_u32 m0, s61, 53248
  s_add_u32 s54, s62, 1824768
  buffer_load_dwordx4 v208, s[36:39], s54 offen lds
  s_add_u32 m0, s61, 57344
  s_add_u32 s54, s62, 1880064
  buffer_load_dwordx4 v208, s[36:39], s54 offen lds
  s_add_u32 m0, s61, 61440
  s_add_u32 s54, s62, 1935360
  buffer_load_dwordx4 v208, s[36:39], s54 offen lds
  v_add_u32 v215, 102400, v210
  ds_read_b64_tr_b16 a[224:225], v215 offset:0
  ds_read_b64_tr_b16 a[226:227], v215 offset:1024
  ds_read_b64_tr_b16 a[228:229], v215 offset:4096
  ds_read_b64_tr_b16 a[230:231], v215 offset:5120
  ds_read_b64_tr_b16 a[232:233], v215 offset:8192
  ds_read_b64_tr_b16 a[234:235], v215 offset:9216
  ds_read_b64_tr_b16 a[236:237], v215 offset:12288
  ds_read_b64_tr_b16 a[238:239], v215 offset:13312
  s_waitcnt vmcnt(20) lgkmcnt(0)
  s_barrier
  v_add_u32 v215, 118784, v210
  ds_read_b64_tr_b16 a[96:97], v215 offset:0
  ds_read_b64_tr_b16 a[98:99], v215 offset:1024
  ds_read_b64_tr_b16 a[100:101], v215 offset:4096
  ds_read_b64_tr_b16 a[102:103], v215 offset:5120
  ds_read_b64_tr_b16 a[104:105], v215 offset:8192
  ds_read_b64_tr_b16 a[106:107], v215 offset:9216
  ds_read_b64_tr_b16 a[108:109], v215 offset:12288
  ds_read_b64_tr_b16 a[110:111], v215 offset:13312
  s_waitcnt vmcnt(16) lgkmcnt(0)
  s_barrier
  v_add_u32 v215, 135168, v210
  ds_read_b64_tr_b16 a[240:241], v215 offset:0
  ds_read_b64_tr_b16 a[242:243], v215 offset:1024
  ds_read_b64_tr_b16 a[244:245], v215 offset:4096
  ds_read_b64_tr_b16 a[246:247], v215 offset:5120
  ds_read_b64_tr_b16 a[248:249], v215 offset:8192
  ds_read_b64_tr_b16 a[250:251], v215 offset:9216
  ds_read_b64_tr_b16 a[252:253], v215 offset:12288
  ds_read_b64_tr_b16 a[254:255], v215 offset:13312
  s_waitcnt vmcnt(12) lgkmcnt(0)
  s_barrier
  v_add_u32 v215, 36864, v210
  ds_read_b64_tr_b16 a[112:113], v215 offset:0
  ds_read_b64_tr_b16 a[114:115], v215 offset:1024
  ds_read_b64_tr_b16 a[116:117], v215 offset:4096
  ds_read_b64_tr_b16 a[118:119], v215 offset:5120
  ds_read_b64_tr_b16 a[120:121], v215 offset:8192
  ds_read_b64_tr_b16 a[122:123], v215 offset:9216
  ds_read_b64_tr_b16 a[124:125], v215 offset:12288
  ds_read_b64_tr_b16 a[126:127], v215 offset:13312
  s_waitcnt vmcnt(8) lgkmcnt(0)
  s_barrier
  v_add_u32 v215, 53248, v210
  ds_read_b64_tr_b16 v[224:225], v215 offset:0
  ds_read_b64_tr_b16 v[226:227], v215 offset:1024
  ds_read_b64_tr_b16 v[228:229], v215 offset:4096
  ds_read_b64_tr_b16 v[230:231], v215 offset:5120
  ds_read_b64_tr_b16 v[232:233], v215 offset:8192
  ds_read_b64_tr_b16 v[234:235], v215 offset:9216
  ds_read_b64_tr_b16 v[236:237], v215 offset:12288
  ds_read_b64_tr_b16 v[238:239], v215 offset:13312
  s_waitcnt vmcnt(4) lgkmcnt(0)
  s_barrier
  v_add_u32 v215, 69632, v210
  ds_read_b64_tr_b16 a[128:129], v215 offset:0
  ds_read_b64_tr_b16 a[130:131], v215 offset:1024
  ds_read_b64_tr_b16 a[132:133], v215 offset:4096
  ds_read_b64_tr_b16 a[134:135], v215 offset:5120
  ds_read_b64_tr_b16 a[136:137], v215 offset:8192
  ds_read_b64_tr_b16 a[138:139], v215 offset:9216
  ds_read_b64_tr_b16 a[140:141], v215 offset:12288
  ds_read_b64_tr_b16 a[142:143], v215 offset:13312
  s_waitcnt vmcnt(0) lgkmcnt(0)
  s_barrier
  v_add_u32 v215, 86016, v210
  ds_read_b64_tr_b16 v[240:241], v215 offset:0
  ds_read_b64_tr_b16 v[242:243], v215 offset:1024
  ds_read_b64_tr_b16 v[244:245], v215 offset:4096
  ds_read_b64_tr_b16 v[246:247], v215 offset:5120
  ds_read_b64_tr_b16 v[248:249], v215 offset:8192
  ds_read_b64_tr_b16 v[250:251], v215 offset:9216
  ds_read_b64_tr_b16 v[252:253], v215 offset:12288
  ds_read_b64_tr_b16 v[254:255], v215 offset:13312
  s_waitcnt lgkmcnt(0)
  s_barrier
  v_and_b32 v211, 31, v200
  v_mul_u32_u24 v218, 516, v211
  v_lshrrev_b32 v212, 5, v200
  v_lshl_add_u32 v218, v212, 3, v218
  s_lshl_b32 s54, s52, 6
  s_add_u32 s54, s54, 73728
  v_add_u32 v218, s54, v218
  s_lshl_b32 s60, s69, 2
  s_mul_i32 s60, s60, 36864
  ds_read_b128 v[32:35], v203 offset:0
  ds_read_b128 v[36:39], v204 offset:0
  ds_read_b128 v[40:43], v205 offset:0
  s_waitcnt lgkmcnt(2)
  v_mfma_f32_32x32x16_bf16 v[0:15], a[0:3], v[32:35], 0
  ds_read_b128 v[44:47], v206 offset:0
  s_add_u32 m0, s67, 36864
  s_nop 0
  buffer_load_dwordx4 v202, s[4:7], s60 offen offset:0 lds
  v_mfma_f32_32x32x16_bf16 v[16:31], a[144:147], v[32:35], 0
  s_waitcnt lgkmcnt(2)
  v_mfma_f32_32x32x16_bf16 v[0:15], a[4:7], v[36:39], v[0:15]
  ds_read_b128 v[32:35], v203 offset:1024
  s_add_u32 m0, s67, 37760
  s_nop 0
  buffer_load_dwordx4 v202, s[4:7], s60 offen offset:128 lds
  v_mfma_f32_32x32x16_bf16 v[16:31], a[148:151], v[36:39], v[16:31]
  s_waitcnt lgkmcnt(2)
  v_mfma_f32_32x32x16_bf16 v[0:15], a[8:11], v[40:43], v[0:15]
  ds_read_b128 v[36:39], v204 offset:1024
  s_add_u32 m0, s67, 38656
  s_nop 0
  buffer_load_dwordx4 v202, s[4:7], s60 offen offset:256 lds
  v_mfma_f32_32x32x16_bf16 v[16:31], a[152:155], v[40:43], v[16:31]
  s_waitcnt lgkmcnt(2)
  v_mfma_f32_32x32x16_bf16 v[0:15], a[12:15], v[44:47], v[0:15]
  ds_read_b128 v[40:43], v205 offset:1024
  s_add_u32 m0, s67, 39552
  s_nop 0
  buffer_load_dwordx4 v202, s[4:7], s60 offen offset:384 lds
  v_mfma_f32_32x32x16_bf16 v[16:31], a[156:159], v[44:47], v[16:31]
  s_waitcnt lgkmcnt(2)
  v_mfma_f32_32x32x16_bf16 v[0:15], a[16:19], v[32:35], v[0:15]
  ds_read_b128 v[44:47], v206 offset:1024
  s_add_u32 m0, s67, 40448
  s_nop 0
  buffer_load_dwordx4 v202, s[4:7], s60 offen offset:512 lds
  v_mfma_f32_32x32x16_bf16 v[16:31], a[160:163], v[32:35], v[16:31]
  s_waitcnt lgkmcnt(2)
  v_mfma_f32_32x32x16_bf16 v[0:15], a[20:23], v[36:39], v[0:15]
  ds_read_b128 v[32:35], v203 offset:2048
  s_add_u32 m0, s67, 41344
  s_nop 0
  buffer_load_dwordx4 v202, s[4:7], s60 offen offset:640 lds
  v_mfma_f32_32x32x16_bf16 v[16:31], a[164:167], v[36:39], v[16:31]
  s_waitcnt lgkmcnt(2)
  v_mfma_f32_32x32x16_bf16 v[0:15], a[24:27], v[40:43], v[0:15]
  ds_read_b128 v[36:39], v204 offset:2048
  s_add_u32 m0, s67, 42240
  s_nop 0
  buffer_load_dwordx4 v202, s[4:7], s60 offen offset:768 lds
  v_mfma_f32_32x32x16_bf16 v[16:31], a[168:171], v[40:43], v[16:31]
  s_waitcnt lgkmcnt(2)
  v_mfma_f32_32x32x16_bf16 v[0:15], a[28:31], v[44:47], v[0:15]
  ds_read_b128 v[40:43], v205 offset:2048
  s_add_u32 m0, s67, 43136
  s_nop 0
  buffer_load_dwordx4 v202, s[4:7], s60 offen offset:896 lds
  v_mfma_f32_32x32x16_bf16 v[16:31], a[172:175], v[44:47], v[16:31]
  s_waitcnt lgkmcnt(2)
  v_mfma_f32_32x32x16_bf16 v[0:15], a[32:35], v[32:35], v[0:15]
  ds_read_b128 v[44:47], v206 offset:2048
  s_add_u32 m0, s67, 44032
  s_nop 0
  buffer_load_dwordx4 v202, s[4:7], s60 offen offset:1024 lds
  v_mfma_f32_32x32x16_bf16 v[16:31], a[176:179], v[32:35], v[16:31]
  s_waitcnt lgkmcnt(2)
  v_mfma_f32_32x32x16_bf16 v[0:15], a[36:39], v[36:39], v[0:15]
  ds_read_b128 v[32:35], v203 offset:3072
  v_mfma_f32_32x32x16_bf16 v[16:31], a[180:183], v[36:39], v[16:31]
  s_waitcnt lgkmcnt(2)
  v_mfma_f32_32x32x16_bf16 v[0:15], a[40:43], v[40:43], v[0:15]
  ds_read_b128 v[36:39], v204 offset:3072
  v_mfma_f32_32x32x16_bf16 v[16:31], a[184:187], v[40:43], v[16:31]
  s_waitcnt lgkmcnt(2)
  v_mfma_f32_32x32x16_bf16 v[0:15], a[44:47], v[44:47], v[0:15]
  ds_read_b128 v[40:43], v205 offset:3072
  v_mfma_f32_32x32x16_bf16 v[16:31], a[188:191], v[44:47], v[16:31]
  s_waitcnt lgkmcnt(2)
  v_mfma_f32_32x32x16_bf16 v[0:15], a[48:51], v[32:35], v[0:15]
  ds_read_b128 v[44:47], v206 offset:3072
  v_mfma_f32_32x32x16_bf16 v[16:31], a[192:195], v[32:35], v[16:31]
  s_waitcnt lgkmcnt(2)
  v_mfma_f32_32x32x16_bf16 v[0:15], a[52:55], v[36:39], v[0:15]
  ds_read_b128 v[32:35], v203 offset:4096
  v_mfma_f32_32x32x16_bf16 v[16:31], a[196:199], v[36:39], v[16:31]
  s_waitcnt lgkmcnt(2)
  v_mfma_f32_32x32x16_bf16 v[0:15], a[56:59], v[40:43], v[0:15]
  ds_read_b128 v[36:39], v204 offset:4096
  v_mfma_f32_32x32x16_bf16 v[16:31], a[200:203], v[40:43], v[16:31]
  s_waitcnt lgkmcnt(2)
  v_mfma_f32_32x32x16_bf16 v[0:15], a[60:63], v[44:47], v[0:15]
  ds_read_b128 v[40:43], v205 offset:4096
  v_mfma_f32_32x32x16_bf16 v[16:31], a[204:207], v[44:47], v[16:31]
  s_waitcnt lgkmcnt(2)
  v_mfma_f32_32x32x16_bf16 v[0:15], a[64:67], v[32:35], v[0:15]
  ds_read_b128 v[44:47], v206 offset:4096
  v_mfma_f32_32x32x16_bf16 v[16:31], a[208:211], v[32:35], v[16:31]
  s_waitcnt lgkmcnt(2)
  v_mfma_f32_32x32x16_bf16 v[0:15], a[68:71], v[36:39], v[0:15]
  ds_read_b128 v[32:35], v203 offset:5120
  v_mfma_f32_32x32x16_bf16 v[16:31], a[212:215], v[36:39], v[16:31]
  s_waitcnt lgkmcnt(2)
  v_mfma_f32_32x32x16_bf16 v[0:15], a[72:75], v[40:43], v[0:15]
  ds_read_b128 v[36:39], v204 offset:5120
  v_mfma_f32_32x32x16_bf16 v[16:31], a[216:219], v[40:43], v[16:31]
  s_waitcnt lgkmcnt(2)
  v_mfma_f32_32x32x16_bf16 v[0:15], a[76:79], v[44:47], v[0:15]
  ds_read_b128 v[40:43], v205 offset:5120
  v_mfma_f32_32x32x16_bf16 v[16:31], a[220:223], v[44:47], v[16:31]
  s_waitcnt lgkmcnt(2)
  v_mfma_f32_32x32x16_bf16 v[0:15], a[80:83], v[32:35], v[0:15]
  ds_read_b128 v[44:47], v206 offset:5120
  v_mfma_f32_32x32x16_bf16 v[16:31], a[224:227], v[32:35], v[16:31]
  s_waitcnt lgkmcnt(2)
  v_mfma_f32_32x32x16_bf16 v[0:15], a[84:87], v[36:39], v[0:15]
  ds_read_b128 v[32:35], v203 offset:6144
  v_mfma_f32_32x32x16_bf16 v[16:31], a[228:231], v[36:39], v[16:31]
  s_waitcnt lgkmcnt(2)
  v_mfma_f32_32x32x16_bf16 v[0:15], a[88:91], v[40:43], v[0:15]
  ds_read_b128 v[36:39], v204 offset:6144
  v_mfma_f32_32x32x16_bf16 v[16:31], a[232:235], v[40:43], v[16:31]
  s_waitcnt lgkmcnt(2)
  v_mfma_f32_32x32x16_bf16 v[0:15], a[92:95], v[44:47], v[0:15]
  ds_read_b128 v[40:43], v205 offset:6144
  v_mfma_f32_32x32x16_bf16 v[16:31], a[236:239], v[44:47], v[16:31]
  s_waitcnt lgkmcnt(2)
  v_mfma_f32_32x32x16_bf16 v[0:15], a[96:99], v[32:35], v[0:15]
  ds_read_b128 v[44:47], v206 offset:6144
  v_mfma_f32_32x32x16_bf16 v[16:31], a[240:243], v[32:35], v[16:31]
  s_waitcnt lgkmcnt(2)
  v_mfma_f32_32x32x16_bf16 v[0:15], a[100:103], v[36:39], v[0:15]
  ds_read_b128 v[32:35], v203 offset:7168
  v_mfma_f32_32x32x16_bf16 v[16:31], a[244:247], v[36:39], v[16:31]
  s_waitcnt lgkmcnt(2)
  v_mfma_f32_32x32x16_bf16 v[0:15], a[104:107], v[40:43], v[0:15]
  ds_read_b128 v[36:39], v204 offset:7168
  v_mfma_f32_32x32x16_bf16 v[16:31], a[248:251], v[40:43], v[16:31]
  s_waitcnt lgkmcnt(2)
  v_mfma_f32_32x32x16_bf16 v[0:15], a[108:111], v[44:47], v[0:15]
  ds_read_b128 v[40:43], v205 offset:7168
  v_mfma_f32_32x32x16_bf16 v[16:31], a[252:255], v[44:47], v[16:31]
  s_waitcnt lgkmcnt(2)
  v_mfma_f32_32x32x16_bf16 v[0:15], a[112:115], v[32:35], v[0:15]
  ds_read_b128 v[44:47], v206 offset:7168
  v_mfma_f32_32x32x16_bf16 v[16:31], v[224:227], v[32:35], v[16:31]
  s_waitcnt lgkmcnt(2)
  v_mfma_f32_32x32x16_bf16 v[0:15], a[116:119], v[36:39], v[0:15]
  ds_read_b128 v[32:35], v203 offset:8192
  v_mfma_f32_32x32x16_bf16 v[16:31], v[228:231], v[36:39], v[16:31]
  s_waitcnt lgkmcnt(2)
  v_mfma_f32_32x32x16_bf16 v[0:15], a[120:123], v[40:43], v[0:15]
  ds_read_b128 v[36:39], v204 offset:8192
  v_mfma_f32_32x32x16_bf16 v[16:31], v[232:235], v[40:43], v[16:31]
  s_waitcnt lgkmcnt(2)
  v_mfma_f32_32x32x16_bf16 v[0:15], a[124:127], v[44:47], v[0:15]
  ds_read_b128 v[40:43], v205 offset:8192
  v_mfma_f32_32x32x16_bf16 v[16:31], v[236:239], v[44:47], v[16:31]
  s_waitcnt lgkmcnt(2)
  v_mfma_f32_32x32x16_bf16 v[0:15], a[128:131], v[32:35], v[0:15]
  ds_read_b128 v[44:47], v206 offset:8192
  v_mfma_f32_32x32x16_bf16 v[16:31], v[240:243], v[32:35], v[16:31]
  s_waitcnt lgkmcnt(2)
  v_mfma_f32_32x32x16_bf16 v[0:15], a[132:135], v[36:39], v[0:15]
  v_mfma_f32_32x32x16_bf16 v[16:31], v[244:247], v[36:39], v[16:31]
  s_waitcnt lgkmcnt(1)
  v_mfma_f32_32x32x16_bf16 v[0:15], a[136:139], v[40:43], v[0:15]
  v_mfma_f32_32x32x16_bf16 v[16:31], v[248:251], v[40:43], v[16:31]
  s_waitcnt lgkmcnt(0)
  v_mfma_f32_32x32x16_bf16 v[0:15], a[140:143], v[44:47], v[0:15]
  v_mfma_f32_32x32x16_bf16 v[16:31], v[252:255], v[44:47], v[16:31]
  s_add_u32 s60, s60, 36864
  s_nop 2
  v_cvt_pk_bf16_f32 v48, v0, v1
  v_cvt_pk_bf16_f32 v49, v2, v3
  ds_write2_b32 v218, v48, v49 offset0:0 offset1:1
  v_cvt_pk_bf16_f32 v48, v4, v5
  v_cvt_pk_bf16_f32 v49, v6, v7
  ds_write2_b32 v218, v48, v49 offset0:4 offset1:5
  v_cvt_pk_bf16_f32 v48, v8, v9
  v_cvt_pk_bf16_f32 v49, v10, v11
  ds_write2_b32 v218, v48, v49 offset0:8 offset1:9
  v_cvt_pk_bf16_f32 v48, v12, v13
  v_cvt_pk_bf16_f32 v49, v14, v15
  ds_write2_b32 v218, v48, v49 offset0:12 offset1:13
  v_cvt_pk_bf16_f32 v48, v16, v17
  v_cvt_pk_bf16_f32 v49, v18, v19
  ds_write2_b32 v218, v48, v49 offset0:64 offset1:65
  v_cvt_pk_bf16_f32 v48, v20, v21
  v_cvt_pk_bf16_f32 v49, v22, v23
  ds_write2_b32 v218, v48, v49 offset0:68 offset1:69
  v_cvt_pk_bf16_f32 v48, v24, v25
  v_cvt_pk_bf16_f32 v49, v26, v27
  ds_write2_b32 v218, v48, v49 offset0:72 offset1:73
  v_cvt_pk_bf16_f32 v48, v28, v29
  v_cvt_pk_bf16_f32 v49, v30, v31
  ds_write2_b32 v218, v48, v49 offset0:76 offset1:77
  v_add_u32 v218, 16512, v218
  s_waitcnt vmcnt(0) lgkmcnt(0)
  s_barrier
  ds_read_b128 v[32:35], v203 offset:36864
  ds_read_b128 v[36:39], v204 offset:36864
  ds_read_b128 v[40:43], v205 offset:36864
  s_waitcnt lgkmcnt(2)
  v_mfma_f32_32x32x16_bf16 v[0:15], a[0:3], v[32:35], 0
  ds_read_b128 v[44:47], v206 offset:36864
  s_add_u32 m0, s67, 0
  s_nop 0
  buffer_load_dwordx4 v202, s[4:7], s60 offen offset:0 lds
  v_mfma_f32_32x32x16_bf16 v[16:31], a[144:147], v[32:35], 0
  s_waitcnt lgkmcnt(2)
  v_mfma_f32_32x32x16_bf16 v[0:15], a[4:7], v[36:39], v[0:15]
  ds_read_b128 v[32:35], v203 offset:37888
  s_add_u32 m0, s67, 896
  s_nop 0
  buffer_load_dwordx4 v202, s[4:7], s60 offen offset:128 lds
  v_mfma_f32_32x32x16_bf16 v[16:31], a[148:151], v[36:39], v[16:31]
  s_waitcnt lgkmcnt(2)
  v_mfma_f32_32x32x16_bf16 v[0:15], a[8:11], v[40:43], v[0:15]
  ds_read_b128 v[36:39], v204 offset:37888
  s_add_u32 m0, s67, 1792
  s_nop 0
  buffer_load_dwordx4 v202, s[4:7], s60 offen offset:256 lds
  v_mfma_f32_32x32x16_bf16 v[16:31], a[152:155], v[40:43], v[16:31]
  s_waitcnt lgkmcnt(2)
  v_mfma_f32_32x32x16_bf16 v[0:15], a[12:15], v[44:47], v[0:15]
  ds_read_b128 v[40:43], v205 offset:37888
  s_add_u32 m0, s67, 2688
  s_nop 0
  buffer_load_dwordx4 v202, s[4:7], s60 offen offset:384 lds
  v_mfma_f32_32x32x16_bf16 v[16:31], a[156:159], v[44:47], v[16:31]
  s_waitcnt lgkmcnt(2)
  v_mfma_f32_32x32x16_bf16 v[0:15], a[16:19], v[32:35], v[0:15]
  ds_read_b128 v[44:47], v206 offset:37888
  s_add_u32 m0, s67, 3584
  s_nop 0
  buffer_load_dwordx4 v202, s[4:7], s60 offen offset:512 lds
  v_mfma_f32_32x32x16_bf16 v[16:31], a[160:163], v[32:35], v[16:31]
  s_waitcnt lgkmcnt(2)
  v_mfma_f32_32x32x16_bf16 v[0:15], a[20:23], v[36:39], v[0:15]
  ds_read_b128 v[32:35], v203 offset:38912
  s_add_u32 m0, s67, 4480
  s_nop 0
  buffer_load_dwordx4 v202, s[4:7], s60 offen offset:640 lds
  v_mfma_f32_32x32x16_bf16 v[16:31], a[164:167], v[36:39], v[16:31]
  s_waitcnt lgkmcnt(2)
  v_mfma_f32_32x32x16_bf16 v[0:15], a[24:27], v[40:43], v[0:15]
  ds_read_b128 v[36:39], v204 offset:38912
  s_add_u32 m0, s67, 5376
  s_nop 0
  buffer_load_dwordx4 v202, s[4:7], s60 offen offset:768 lds
  v_mfma_f32_32x32x16_bf16 v[16:31], a[168:171], v[40:43], v[16:31]
  s_waitcnt lgkmcnt(2)
  v_mfma_f32_32x32x16_bf16 v[0:15], a[28:31], v[44:47], v[0:15]
  ds_read_b128 v[40:43], v205 offset:38912
  s_add_u32 m0, s67, 6272
  s_nop 0
  buffer_load_dwordx4 v202, s[4:7], s60 offen offset:896 lds
  v_mfma_f32_32x32x16_bf16 v[16:31], a[172:175], v[44:47], v[16:31]
  s_waitcnt lgkmcnt(2)
  v_mfma_f32_32x32x16_bf16 v[0:15], a[32:35], v[32:35], v[0:15]
  ds_read_b128 v[44:47], v206 offset:38912
  s_add_u32 m0, s67, 7168
  s_nop 0
  buffer_load_dwordx4 v202, s[4:7], s60 offen offset:1024 lds
  v_mfma_f32_32x32x16_bf16 v[16:31], a[176:179], v[32:35], v[16:31]
  s_waitcnt lgkmcnt(2)
  v_mfma_f32_32x32x16_bf16 v[0:15], a[36:39], v[36:39], v[0:15]
  ds_read_b128 v[32:35], v203 offset:39936
  v_mfma_f32_32x32x16_bf16 v[16:31], a[180:183], v[36:39], v[16:31]
  s_waitcnt lgkmcnt(2)
  v_mfma_f32_32x32x16_bf16 v[0:15], a[40:43], v[40:43], v[0:15]
  ds_read_b128 v[36:39], v204 offset:39936
  v_mfma_f32_32x32x16_bf16 v[16:31], a[184:187], v[40:43], v[16:31]
  s_waitcnt lgkmcnt(2)
  v_mfma_f32_32x32x16_bf16 v[0:15], a[44:47], v[44:47], v[0:15]
  ds_read_b128 v[40:43], v205 offset:39936
  v_mfma_f32_32x32x16_bf16 v[16:31], a[188:191], v[44:47], v[16:31]
  s_waitcnt lgkmcnt(2)
  v_mfma_f32_32x32x16_bf16 v[0:15], a[48:51], v[32:35], v[0:15]
  ds_read_b128 v[44:47], v206 offset:39936
  v_mfma_f32_32x32x16_bf16 v[16:31], a[192:195], v[32:35], v[16:31]
  s_waitcnt lgkmcnt(2)
  v_mfma_f32_32x32x16_bf16 v[0:15], a[52:55], v[36:39], v[0:15]
  ds_read_b128 v[32:35], v203 offset:40960
  v_mfma_f32_32x32x16_bf16 v[16:31], a[196:199], v[36:39], v[16:31]
  s_waitcnt lgkmcnt(2)
  v_mfma_f32_32x32x16_bf16 v[0:15], a[56:59], v[40:43], v[0:15]
  ds_read_b128 v[36:39], v204 offset:40960
  v_mfma_f32_32x32x16_bf16 v[16:31], a[200:203], v[40:43], v[16:31]
  s_waitcnt lgkmcnt(2)
  v_mfma_f32_32x32x16_bf16 v[0:15], a[60:63], v[44:47], v[0:15]
  ds_read_b128 v[40:43], v205 offset:40960
  v_mfma_f32_32x32x16_bf16 v[16:31], a[204:207], v[44:47], v[16:31]
  s_waitcnt lgkmcnt(2)
  v_mfma_f32_32x32x16_bf16 v[0:15], a[64:67], v[32:35], v[0:15]
  ds_read_b128 v[44:47], v206 offset:40960
  v_mfma_f32_32x32x16_bf16 v[16:31], a[208:211], v[32:35], v[16:31]
  s_waitcnt lgkmcnt(2)
  v_mfma_f32_32x32x16_bf16 v[0:15], a[68:71], v[36:39], v[0:15]
  ds_read_b128 v[32:35], v203 offset:41984
  v_mfma_f32_32x32x16_bf16 v[16:31], a[212:215], v[36:39], v[16:31]
  s_waitcnt lgkmcnt(2)
  v_mfma_f32_32x32x16_bf16 v[0:15], a[72:75], v[40:43], v[0:15]
  ds_read_b128 v[36:39], v204 offset:41984
  v_mfma_f32_32x32x16_bf16 v[16:31], a[216:219], v[40:43], v[16:31]
  s_waitcnt lgkmcnt(2)
  v_mfma_f32_32x32x16_bf16 v[0:15], a[76:79], v[44:47], v[0:15]
  ds_read_b128 v[40:43], v205 offset:41984
  v_mfma_f32_32x32x16_bf16 v[16:31], a[220:223], v[44:47], v[16:31]
  s_waitcnt lgkmcnt(2)
  v_mfma_f32_32x32x16_bf16 v[0:15], a[80:83], v[32:35], v[0:15]
  ds_read_b128 v[44:47], v206 offset:41984
  v_mfma_f32_32x32x16_bf16 v[16:31], a[224:227], v[32:35], v[16:31]
  s_waitcnt lgkmcnt(2)
  v_mfma_f32_32x32x16_bf16 v[0:15], a[84:87], v[36:39], v[0:15]
  ds_read_b128 v[32:35], v203 offset:43008
  v_mfma_f32_32x32x16_bf16 v[16:31], a[228:231], v[36:39], v[16:31]
  s_waitcnt lgkmcnt(2)
  v_mfma_f32_32x32x16_bf16 v[0:15], a[88:91], v[40:43], v[0:15]
  ds_read_b128 v[36:39], v204 offset:43008
  v_mfma_f32_32x32x16_bf16 v[16:31], a[232:235], v[40:43], v[16:31]
  s_waitcnt lgkmcnt(2)
  v_mfma_f32_32x32x16_bf16 v[0:15], a[92:95], v[44:47], v[0:15]
  ds_read_b128 v[40:43], v205 offset:43008
  v_mfma_f32_32x32x16_bf16 v[16:31], a[236:239], v[44:47], v[16:31]
  s_waitcnt lgkmcnt(2)
  v_mfma_f32_32x32x16_bf16 v[0:15], a[96:99], v[32:35], v[0:15]
  ds_read_b128 v[44:47], v206 offset:43008
  v_mfma_f32_32x32x16_bf16 v[16:31], a[240:243], v[32:35], v[16:31]
  s_waitcnt lgkmcnt(2)
  v_mfma_f32_32x32x16_bf16 v[0:15], a[100:103], v[36:39], v[0:15]
  ds_read_b128 v[32:35], v203 offset:44032
  v_mfma_f32_32x32x16_bf16 v[16:31], a[244:247], v[36:39], v[16:31]
  s_waitcnt lgkmcnt(2)
  v_mfma_f32_32x32x16_bf16 v[0:15], a[104:107], v[40:43], v[0:15]
  ds_read_b128 v[36:39], v204 offset:44032
  v_mfma_f32_32x32x16_bf16 v[16:31], a[248:251], v[40:43], v[16:31]
  s_waitcnt lgkmcnt(2)
  v_mfma_f32_32x32x16_bf16 v[0:15], a[108:111], v[44:47], v[0:15]
  ds_read_b128 v[40:43], v205 offset:44032
  v_mfma_f32_32x32x16_bf16 v[16:31], a[252:255], v[44:47], v[16:31]
  s_waitcnt lgkmcnt(2)
  v_mfma_f32_32x32x16_bf16 v[0:15], a[112:115], v[32:35], v[0:15]
  ds_read_b128 v[44:47], v206 offset:44032
  v_mfma_f32_32x32x16_bf16 v[16:31], v[224:227], v[32:35], v[16:31]
  s_waitcnt lgkmcnt(2)
  v_mfma_f32_32x32x16_bf16 v[0:15], a[116:119], v[36:39], v[0:15]
  ds_read_b128 v[32:35], v203 offset:45056
  v_mfma_f32_32x32x16_bf16 v[16:31], v[228:231], v[36:39], v[16:31]
  s_waitcnt lgkmcnt(2)
  v_mfma_f32_32x32x16_bf16 v[0:15], a[120:123], v[40:43], v[0:15]
  ds_read_b128 v[36:39], v204 offset:45056
  v_mfma_f32_32x32x16_bf16 v[16:31], v[232:235], v[40:43], v[16:31]
  s_waitcnt lgkmcnt(2)
  v_mfma_f32_32x32x16_bf16 v[0:15], a[124:127], v[44:47], v[0:15]
  ds_read_b128 v[40:43], v205 offset:45056
  v_mfma_f32_32x32x16_bf16 v[16:31], v[236:239], v[44:47], v[16:31]
  s_waitcnt lgkmcnt(2)
  v_mfma_f32_32x32x16_bf16 v[0:15], a[128:131], v[32:35], v[0:15]
  ds_read_b128 v[44:47], v206 offset:45056
  v_mfma_f32_32x32x16_bf16 v[16:31], v[240:243], v[32:35], v[16:31]
  s_waitcnt lgkmcnt(2)
  v_mfma_f32_32x32x16_bf16 v[0:15], a[132:135], v[36:39], v[0:15]
  v_mfma_f32_32x32x16_bf16 v[16:31], v[244:247], v[36:39], v[16:31]
  s_waitcnt lgkmcnt(1)
  v_mfma_f32_32x32x16_bf16 v[0:15], a[136:139], v[40:43], v[0:15]
  v_mfma_f32_32x32x16_bf16 v[16:31], v[248:251], v[40:43], v[16:31]
  s_waitcnt lgkmcnt(0)
  v_mfma_f32_32x32x16_bf16 v[0:15], a[140:143], v[44:47], v[0:15]
  v_mfma_f32_32x32x16_bf16 v[16:31], v[252:255], v[44:47], v[16:31]
  s_add_u32 s60, s60, 36864
  s_nop 2
  v_cvt_pk_bf16_f32 v48, v0, v1
  v_cvt_pk_bf16_f32 v49, v2, v3
  ds_write2_b32 v218, v48, v49 offset0:0 offset1:1
  v_cvt_pk_bf16_f32 v48, v4, v5
  v_cvt_pk_bf16_f32 v49, v6, v7
  ds_write2_b32 v218, v48, v49 offset0:4 offset1:5
  v_cvt_pk_bf16_f32 v48, v8, v9
  v_cvt_pk_bf16_f32 v49, v10, v11
  ds_write2_b32 v218, v48, v49 offset0:8 offset1:9
  v_cvt_pk_bf16_f32 v48, v12, v13
  v_cvt_pk_bf16_f32 v49, v14, v15
  ds_write2_b32 v218, v48, v49 offset0:12 offset1:13
  v_cvt_pk_bf16_f32 v48, v16, v17
  v_cvt_pk_bf16_f32 v49, v18, v19
  ds_write2_b32 v218, v48, v49 offset0:64 offset1:65
  v_cvt_pk_bf16_f32 v48, v20, v21
  v_cvt_pk_bf16_f32 v49, v22, v23
  ds_write2_b32 v218, v48, v49 offset0:68 offset1:69
  v_cvt_pk_bf16_f32 v48, v24, v25
  v_cvt_pk_bf16_f32 v49, v26, v27
  ds_write2_b32 v218, v48, v49 offset0:72 offset1:73
  v_cvt_pk_bf16_f32 v48, v28, v29
  v_cvt_pk_bf16_f32 v49, v30, v31
  ds_write2_b32 v218, v48, v49 offset0:76 offset1:77
  v_add_u32 v218, 16512, v218
  s_waitcnt vmcnt(0) lgkmcnt(0)
  s_barrier
  ds_read_b128 v[32:35], v203 offset:0
  ds_read_b128 v[36:39], v204 offset:0
  ds_read_b128 v[40:43], v205 offset:0
  s_waitcnt lgkmcnt(2)
  v_mfma_f32_32x32x16_bf16 v[0:15], a[0:3], v[32:35], 0
  ds_read_b128 v[44:47], v206 offset:0
  s_add_u32 m0, s67, 36864
  s_nop 0
  buffer_load_dwordx4 v202, s[4:7], s60 offen offset:0 lds
  v_mfma_f32_32x32x16_bf16 v[16:31], a[144:147], v[32:35], 0
  s_waitcnt lgkmcnt(2)
  v_mfma_f32_32x32x16_bf16 v[0:15], a[4:7], v[36:39], v[0:15]
  ds_read_b128 v[32:35], v203 offset:1024
  s_add_u32 m0, s67, 37760
  s_nop 0
  buffer_load_dwordx4 v202, s[4:7], s60 offen offset:128 lds
  v_mfma_f32_32x32x16_bf16 v[16:31], a[148:151], v[36:39], v[16:31]
  s_waitcnt lgkmcnt(2)
  v_mfma_f32_32x32x16_bf16 v[0:15], a[8:11], v[40:43], v[0:15]
  ds_read_b128 v[36:39], v204 offset:1024
  s_add_u32 m0, s67, 38656
  s_nop 0
  buffer_load_dwordx4 v202, s[4:7], s60 offen offset:256 lds
  v_mfma_f32_32x32x16_bf16 v[16:31], a[152:155], v[40:43], v[16:31]
  s_waitcnt lgkmcnt(2)
  v_mfma_f32_32x32x16_bf16 v[0:15], a[12:15], v[44:47], v[0:15]
  ds_read_b128 v[40:43], v205 offset:1024
  s_add_u32 m0, s67, 39552
  s_nop 0
  buffer_load_dwordx4 v202, s[4:7], s60 offen offset:384 lds
  v_mfma_f32_32x32x16_bf16 v[16:31], a[156:159], v[44:47], v[16:31]
  s_waitcnt lgkmcnt(2)
  v_mfma_f32_32x32x16_bf16 v[0:15], a[16:19], v[32:35], v[0:15]
  ds_read_b128 v[44:47], v206 offset:1024
  s_add_u32 m0, s67, 40448
  s_nop 0
  buffer_load_dwordx4 v202, s[4:7], s60 offen offset:512 lds
  v_mfma_f32_32x32x16_bf16 v[16:31], a[160:163], v[32:35], v[16:31]
  s_waitcnt lgkmcnt(2)
  v_mfma_f32_32x32x16_bf16 v[0:15], a[20:23], v[36:39], v[0:15]
  ds_read_b128 v[32:35], v203 offset:2048
  s_add_u32 m0, s67, 41344
  s_nop 0
  buffer_load_dwordx4 v202, s[4:7], s60 offen offset:640 lds
  v_mfma_f32_32x32x16_bf16 v[16:31], a[164:167], v[36:39], v[16:31]
  s_waitcnt lgkmcnt(2)
  v_mfma_f32_32x32x16_bf16 v[0:15], a[24:27], v[40:43], v[0:15]
  ds_read_b128 v[36:39], v204 offset:2048
  s_add_u32 m0, s67, 42240
  s_nop 0
  buffer_load_dwordx4 v202, s[4:7], s60 offen offset:768 lds
  v_mfma_f32_32x32x16_bf16 v[16:31], a[168:171], v[40:43], v[16:31]
  s_waitcnt lgkmcnt(2)
  v_mfma_f32_32x32x16_bf16 v[0:15], a[28:31], v[44:47], v[0:15]
  ds_read_b128 v[40:43], v205 offset:2048
  s_add_u32 m0, s67, 43136
  s_nop 0
  buffer_load_dwordx4 v202, s[4:7], s60 offen offset:896 lds
  v_mfma_f32_32x32x16_bf16 v[16:31], a[172:175], v[44:47], v[16:31]
  s_waitcnt lgkmcnt(2)
  v_mfma_f32_32x32x16_bf16 v[0:15], a[32:35], v[32:35], v[0:15]
  ds_read_b128 v[44:47], v206 offset:2048
  s_add_u32 m0, s67, 44032
  s_nop 0
  buffer_load_dwordx4 v202, s[4:7], s60 offen offset:1024 lds
  v_mfma_f32_32x32x16_bf16 v[16:31], a[176:179], v[32:35], v[16:31]
  s_waitcnt lgkmcnt(2)
  v_mfma_f32_32x32x16_bf16 v[0:15], a[36:39], v[36:39], v[0:15]
  ds_read_b128 v[32:35], v203 offset:3072
  v_mfma_f32_32x32x16_bf16 v[16:31], a[180:183], v[36:39], v[16:31]
  s_waitcnt lgkmcnt(2)
  v_mfma_f32_32x32x16_bf16 v[0:15], a[40:43], v[40:43], v[0:15]
  ds_read_b128 v[36:39], v204 offset:3072
  v_mfma_f32_32x32x16_bf16 v[16:31], a[184:187], v[40:43], v[16:31]
  s_waitcnt lgkmcnt(2)
  v_mfma_f32_32x32x16_bf16 v[0:15], a[44:47], v[44:47], v[0:15]
  ds_read_b128 v[40:43], v205 offset:3072
  v_mfma_f32_32x32x16_bf16 v[16:31], a[188:191], v[44:47], v[16:31]
  s_waitcnt lgkmcnt(2)
  v_mfma_f32_32x32x16_bf16 v[0:15], a[48:51], v[32:35], v[0:15]
  ds_read_b128 v[44:47], v206 offset:3072
  v_mfma_f32_32x32x16_bf16 v[16:31], a[192:195], v[32:35], v[16:31]
  s_waitcnt lgkmcnt(2)
  v_mfma_f32_32x32x16_bf16 v[0:15], a[52:55], v[36:39], v[0:15]
  ds_read_b128 v[32:35], v203 offset:4096
  v_mfma_f32_32x32x16_bf16 v[16:31], a[196:199], v[36:39], v[16:31]
  s_waitcnt lgkmcnt(2)
  v_mfma_f32_32x32x16_bf16 v[0:15], a[56:59], v[40:43], v[0:15]
  ds_read_b128 v[36:39], v204 offset:4096
  v_mfma_f32_32x32x16_bf16 v[16:31], a[200:203], v[40:43], v[16:31]
  s_waitcnt lgkmcnt(2)
  v_mfma_f32_32x32x16_bf16 v[0:15], a[60:63], v[44:47], v[0:15]
  ds_read_b128 v[40:43], v205 offset:4096
  v_mfma_f32_32x32x16_bf16 v[16:31], a[204:207], v[44:47], v[16:31]
  s_waitcnt lgkmcnt(2)
  v_mfma_f32_32x32x16_bf16 v[0:15], a[64:67], v[32:35], v[0:15]
  ds_read_b128 v[44:47], v206 offset:4096
  v_mfma_f32_32x32x16_bf16 v[16:31], a[208:211], v[32:35], v[16:31]
  s_waitcnt lgkmcnt(2)
  v_mfma_f32_32x32x16_bf16 v[0:15], a[68:71], v[36:39], v[0:15]
  ds_read_b128 v[32:35], v203 offset:5120
  v_mfma_f32_32x32x16_bf16 v[16:31], a[212:215], v[36:39], v[16:31]
  s_waitcnt lgkmcnt(2)
  v_mfma_f32_32x32x16_bf16 v[0:15], a[72:75], v[40:43], v[0:15]
  ds_read_b128 v[36:39], v204 offset:5120
  v_mfma_f32_32x32x16_bf16 v[16:31], a[216:219], v[40:43], v[16:31]
  s_waitcnt lgkmcnt(2)
  v_mfma_f32_32x32x16_bf16 v[0:15], a[76:79], v[44:47], v[0:15]
  ds_read_b128 v[40:43], v205 offset:5120
  v_mfma_f32_32x32x16_bf16 v[16:31], a[220:223], v[44:47], v[16:31]
  s_waitcnt lgkmcnt(2)
  v_mfma_f32_32x32x16_bf16 v[0:15], a[80:83], v[32:35], v[0:15]
  ds_read_b128 v[44:47], v206 offset:5120
  v_mfma_f32_32x32x16_bf16 v[16:31], a[224:227], v[32:35], v[16:31]
  s_waitcnt lgkmcnt(2)
  v_mfma_f32_32x32x16_bf16 v[0:15], a[84:87], v[36:39], v[0:15]
  ds_read_b128 v[32:35], v203 offset:6144
  v_mfma_f32_32x32x16_bf16 v[16:31], a[228:231], v[36:39], v[16:31]
  s_waitcnt lgkmcnt(2)
  v_mfma_f32_32x32x16_bf16 v[0:15], a[88:91], v[40:43], v[0:15]
  ds_read_b128 v[36:39], v204 offset:6144
  v_mfma_f32_32x32x16_bf16 v[16:31], a[232:235], v[40:43], v[16:31]
  s_waitcnt lgkmcnt(2)
  v_mfma_f32_32x32x16_bf16 v[0:15], a[92:95], v[44:47], v[0:15]
  ds_read_b128 v[40:43], v205 offset:6144
  v_mfma_f32_32x32x16_bf16 v[16:31], a[236:239], v[44:47], v[16:31]
  s_waitcnt lgkmcnt(2)
  v_mfma_f32_32x32x16_bf16 v[0:15], a[96:99], v[32:35], v[0:15]
  ds_read_b128 v[44:47], v206 offset:6144
  v_mfma_f32_32x32x16_bf16 v[16:31], a[240:243], v[32:35], v[16:31]
  s_waitcnt lgkmcnt(2)
  v_mfma_f32_32x32x16_bf16 v[0:15], a[100:103], v[36:39], v[0:15]
  ds_read_b128 v[32:35], v203 offset:7168
  v_mfma_f32_32x32x16_bf16 v[16:31], a[244:247], v[36:39], v[16:31]
  s_waitcnt lgkmcnt(2)
  v_mfma_f32_32x32x16_bf16 v[0:15], a[104:107], v[40:43], v[0:15]
  ds_read_b128 v[36:39], v204 offset:7168
  v_mfma_f32_32x32x16_bf16 v[16:31], a[248:251], v[40:43], v[16:31]
  s_waitcnt lgkmcnt(2)
  v_mfma_f32_32x32x16_bf16 v[0:15], a[108:111], v[44:47], v[0:15]
  ds_read_b128 v[40:43], v205 offset:7168
  v_mfma_f32_32x32x16_bf16 v[16:31], a[252:255], v[44:47], v[16:31]
  s_waitcnt lgkmcnt(2)
  v_mfma_f32_32x32x16_bf16 v[0:15], a[112:115], v[32:35], v[0:15]
  ds_read_b128 v[44:47], v206 offset:7168
  v_mfma_f32_32x32x16_bf16 v[16:31], v[224:227], v[32:35], v[16:31]
  s_waitcnt lgkmcnt(2)
  v_mfma_f32_32x32x16_bf16 v[0:15], a[116:119], v[36:39], v[0:15]
  ds_read_b128 v[32:35], v203 offset:8192
  v_mfma_f32_32x32x16_bf16 v[16:31], v[228:231], v[36:39], v[16:31]
  s_waitcnt lgkmcnt(2)
  v_mfma_f32_32x32x16_bf16 v[0:15], a[120:123], v[40:43], v[0:15]
  ds_read_b128 v[36:39], v204 offset:8192
  v_mfma_f32_32x32x16_bf16 v[16:31], v[232:235], v[40:43], v[16:31]
  s_waitcnt lgkmcnt(2)
  v_mfma_f32_32x32x16_bf16 v[0:15], a[124:127], v[44:47], v[0:15]
  ds_read_b128 v[40:43], v205 offset:8192
  v_mfma_f32_32x32x16_bf16 v[16:31], v[236:239], v[44:47], v[16:31]
  s_waitcnt lgkmcnt(2)
  v_mfma_f32_32x32x16_bf16 v[0:15], a[128:131], v[32:35], v[0:15]
  ds_read_b128 v[44:47], v206 offset:8192
  v_mfma_f32_32x32x16_bf16 v[16:31], v[240:243], v[32:35], v[16:31]
  s_waitcnt lgkmcnt(2)
  v_mfma_f32_32x32x16_bf16 v[0:15], a[132:135], v[36:39], v[0:15]
  v_mfma_f32_32x32x16_bf16 v[16:31], v[244:247], v[36:39], v[16:31]
  s_waitcnt lgkmcnt(1)
  v_mfma_f32_32x32x16_bf16 v[0:15], a[136:139], v[40:43], v[0:15]
  v_mfma_f32_32x32x16_bf16 v[16:31], v[248:251], v[40:43], v[16:31]
  s_waitcnt lgkmcnt(0)
  v_mfma_f32_32x32x16_bf16 v[0:15], a[140:143], v[44:47], v[0:15]
  v_mfma_f32_32x32x16_bf16 v[16:31], v[252:255], v[44:47], v[16:31]
  s_add_u32 s60, s60, 36864
  s_nop 2
  v_cvt_pk_bf16_f32 v48, v0, v1
  v_cvt_pk_bf16_f32 v49, v2, v3
  ds_write2_b32 v218, v48, v49 offset0:0 offset1:1
  v_cvt_pk_bf16_f32 v48, v4, v5
  v_cvt_pk_bf16_f32 v49, v6, v7
  ds_write2_b32 v218, v48, v49 offset0:4 offset1:5
  v_cvt_pk_bf16_f32 v48, v8, v9
  v_cvt_pk_bf16_f32 v49, v10, v11
  ds_write2_b32 v218, v48, v49 offset0:8 offset1:9
  v_cvt_pk_bf16_f32 v48, v12, v13
  v_cvt_pk_bf16_f32 v49, v14, v15
  ds_write2_b32 v218, v48, v49 offset0:12 offset1:13
  v_cvt_pk_bf16_f32 v48, v16, v17
  v_cvt_pk_bf16_f32 v49, v18, v19
  ds_write2_b32 v218, v48, v49 offset0:64 offset1:65
  v_cvt_pk_bf16_f32 v48, v20, v21
  v_cvt_pk_bf16_f32 v49, v22, v23
  ds_write2_b32 v218, v48, v49 offset0:68 offset1:69
  v_cvt_pk_bf16_f32 v48, v24, v25
  v_cvt_pk_bf16_f32 v49, v26, v27
  ds_write2_b32 v218, v48, v49 offset0:72 offset1:73
  v_cvt_pk_bf16_f32 v48, v28, v29
  v_cvt_pk_bf16_f32 v49, v30, v31
  ds_write2_b32 v218, v48, v49 offset0:76 offset1:77
  v_add_u32 v218, 16512, v218
  s_waitcnt vmcnt(0) lgkmcnt(0)
  s_barrier
  ds_read_b128 v[32:35], v203 offset:36864
  ds_read_b128 v[36:39], v204 offset:36864
  ds_read_b128 v[40:43], v205 offset:36864
  s_waitcnt lgkmcnt(2)
  v_mfma_f32_32x32x16_bf16 v[0:15], a[0:3], v[32:35], 0
  ds_read_b128 v[44:47], v206 offset:36864
  s_add_u32 m0, s67, 0
  s_nop 0
  buffer_load_dwordx4 v202, s[4:7], s60 offen offset:0 lds
  v_mfma_f32_32x32x16_bf16 v[16:31], a[144:147], v[32:35], 0
  s_waitcnt lgkmcnt(2)
  v_mfma_f32_32x32x16_bf16 v[0:15], a[4:7], v[36:39], v[0:15]
  ds_read_b128 v[32:35], v203 offset:37888
  s_add_u32 m0, s67, 896
  s_nop 0
  buffer_load_dwordx4 v202, s[4:7], s60 offen offset:128 lds
  v_mfma_f32_32x32x16_bf16 v[16:31], a[148:151], v[36:39], v[16:31]
  s_waitcnt lgkmcnt(2)
  v_mfma_f32_32x32x16_bf16 v[0:15], a[8:11], v[40:43], v[0:15]
  ds_read_b128 v[36:39], v204 offset:37888
  s_add_u32 m0, s67, 1792
  s_nop 0
  buffer_load_dwordx4 v202, s[4:7], s60 offen offset:256 lds
  v_mfma_f32_32x32x16_bf16 v[16:31], a[152:155], v[40:43], v[16:31]
  s_waitcnt lgkmcnt(2)
  v_mfma_f32_32x32x16_bf16 v[0:15], a[12:15], v[44:47], v[0:15]
  ds_read_b128 v[40:43], v205 offset:37888
  s_add_u32 m0, s67, 2688
  s_nop 0
  buffer_load_dwordx4 v202, s[4:7], s60 offen offset:384 lds
  v_mfma_f32_32x32x16_bf16 v[16:31], a[156:159], v[44:47], v[16:31]
  s_waitcnt lgkmcnt(2)
  v_mfma_f32_32x32x16_bf16 v[0:15], a[16:19], v[32:35], v[0:15]
  ds_read_b128 v[44:47], v206 offset:37888
  s_add_u32 m0, s67, 3584
  s_nop 0
  buffer_load_dwordx4 v202, s[4:7], s60 offen offset:512 lds
  v_mfma_f32_32x32x16_bf16 v[16:31], a[160:163], v[32:35], v[16:31]
  s_waitcnt lgkmcnt(2)
  v_mfma_f32_32x32x16_bf16 v[0:15], a[20:23], v[36:39], v[0:15]
  ds_read_b128 v[32:35], v203 offset:38912
  s_add_u32 m0, s67, 4480
  s_nop 0
  buffer_load_dwordx4 v202, s[4:7], s60 offen offset:640 lds
  v_mfma_f32_32x32x16_bf16 v[16:31], a[164:167], v[36:39], v[16:31]
  s_waitcnt lgkmcnt(2)
  v_mfma_f32_32x32x16_bf16 v[0:15], a[24:27], v[40:43], v[0:15]
  ds_read_b128 v[36:39], v204 offset:38912
  s_add_u32 m0, s67, 5376
  s_nop 0
  buffer_load_dwordx4 v202, s[4:7], s60 offen offset:768 lds
  v_mfma_f32_32x32x16_bf16 v[16:31], a[168:171], v[40:43], v[16:31]
  s_waitcnt lgkmcnt(2)
  v_mfma_f32_32x32x16_bf16 v[0:15], a[28:31], v[44:47], v[0:15]
  ds_read_b128 v[40:43], v205 offset:38912
  s_add_u32 m0, s67, 6272
  s_nop 0
  buffer_load_dwordx4 v202, s[4:7], s60 offen offset:896 lds
  v_mfma_f32_32x32x16_bf16 v[16:31], a[172:175], v[44:47], v[16:31]
  s_waitcnt lgkmcnt(2)
  v_mfma_f32_32x32x16_bf16 v[0:15], a[32:35], v[32:35], v[0:15]
  ds_read_b128 v[44:47], v206 offset:38912
  s_add_u32 m0, s67, 7168
  s_nop 0
  buffer_load_dwordx4 v202, s[4:7], s60 offen offset:1024 lds
  v_mfma_f32_32x32x16_bf16 v[16:31], a[176:179], v[32:35], v[16:31]
  s_waitcnt lgkmcnt(2)
  v_mfma_f32_32x32x16_bf16 v[0:15], a[36:39], v[36:39], v[0:15]
  ds_read_b128 v[32:35], v203 offset:39936
  v_mfma_f32_32x32x16_bf16 v[16:31], a[180:183], v[36:39], v[16:31]
  s_waitcnt lgkmcnt(2)
  v_mfma_f32_32x32x16_bf16 v[0:15], a[40:43], v[40:43], v[0:15]
  ds_read_b128 v[36:39], v204 offset:39936
  v_mfma_f32_32x32x16_bf16 v[16:31], a[184:187], v[40:43], v[16:31]
  s_waitcnt lgkmcnt(2)
  v_mfma_f32_32x32x16_bf16 v[0:15], a[44:47], v[44:47], v[0:15]
  ds_read_b128 v[40:43], v205 offset:39936
  v_mfma_f32_32x32x16_bf16 v[16:31], a[188:191], v[44:47], v[16:31]
  s_waitcnt lgkmcnt(2)
  v_mfma_f32_32x32x16_bf16 v[0:15], a[48:51], v[32:35], v[0:15]
  ds_read_b128 v[44:47], v206 offset:39936
  v_mfma_f32_32x32x16_bf16 v[16:31], a[192:195], v[32:35], v[16:31]
  s_waitcnt lgkmcnt(2)
  v_mfma_f32_32x32x16_bf16 v[0:15], a[52:55], v[36:39], v[0:15]
  ds_read_b128 v[32:35], v203 offset:40960
  v_mfma_f32_32x32x16_bf16 v[16:31], a[196:199], v[36:39], v[16:31]
  s_waitcnt lgkmcnt(2)
  v_mfma_f32_32x32x16_bf16 v[0:15], a[56:59], v[40:43], v[0:15]
  ds_read_b128 v[36:39], v204 offset:40960
  v_mfma_f32_32x32x16_bf16 v[16:31], a[200:203], v[40:43], v[16:31]
  s_waitcnt lgkmcnt(2)
  v_mfma_f32_32x32x16_bf16 v[0:15], a[60:63], v[44:47], v[0:15]
  ds_read_b128 v[40:43], v205 offset:40960
  v_mfma_f32_32x32x16_bf16 v[16:31], a[204:207], v[44:47], v[16:31]
  s_waitcnt lgkmcnt(2)
  v_mfma_f32_32x32x16_bf16 v[0:15], a[64:67], v[32:35], v[0:15]
  ds_read_b128 v[44:47], v206 offset:40960
  v_mfma_f32_32x32x16_bf16 v[16:31], a[208:211], v[32:35], v[16:31]
  s_waitcnt lgkmcnt(2)
  v_mfma_f32_32x32x16_bf16 v[0:15], a[68:71], v[36:39], v[0:15]
  ds_read_b128 v[32:35], v203 offset:41984
  v_mfma_f32_32x32x16_bf16 v[16:31], a[212:215], v[36:39], v[16:31]
  s_waitcnt lgkmcnt(2)
  v_mfma_f32_32x32x16_bf16 v[0:15], a[72:75], v[40:43], v[0:15]
  ds_read_b128 v[36:39], v204 offset:41984
  v_mfma_f32_32x32x16_bf16 v[16:31], a[216:219], v[40:43], v[16:31]
  s_waitcnt lgkmcnt(2)
  v_mfma_f32_32x32x16_bf16 v[0:15], a[76:79], v[44:47], v[0:15]
  ds_read_b128 v[40:43], v205 offset:41984
  v_mfma_f32_32x32x16_bf16 v[16:31], a[220:223], v[44:47], v[16:31]
  s_waitcnt lgkmcnt(2)
  v_mfma_f32_32x32x16_bf16 v[0:15], a[80:83], v[32:35], v[0:15]
  ds_read_b128 v[44:47], v206 offset:41984
  v_mfma_f32_32x32x16_bf16 v[16:31], a[224:227], v[32:35], v[16:31]
  s_waitcnt lgkmcnt(2)
  v_mfma_f32_32x32x16_bf16 v[0:15], a[84:87], v[36:39], v[0:15]
  ds_read_b128 v[32:35], v203 offset:43008
  v_mfma_f32_32x32x16_bf16 v[16:31], a[228:231], v[36:39], v[16:31]
  s_waitcnt lgkmcnt(2)
  v_mfma_f32_32x32x16_bf16 v[0:15], a[88:91], v[40:43], v[0:15]
  ds_read_b128 v[36:39], v204 offset:43008
  v_mfma_f32_32x32x16_bf16 v[16:31], a[232:235], v[40:43], v[16:31]
  s_waitcnt lgkmcnt(2)
  v_mfma_f32_32x32x16_bf16 v[0:15], a[92:95], v[44:47], v[0:15]
  ds_read_b128 v[40:43], v205 offset:43008
  v_mfma_f32_32x32x16_bf16 v[16:31], a[236:239], v[44:47], v[16:31]
  s_waitcnt lgkmcnt(2)
  v_mfma_f32_32x32x16_bf16 v[0:15], a[96:99], v[32:35], v[0:15]
  ds_read_b128 v[44:47], v206 offset:43008
  v_mfma_f32_32x32x16_bf16 v[16:31], a[240:243], v[32:35], v[16:31]
  s_waitcnt lgkmcnt(2)
  v_mfma_f32_32x32x16_bf16 v[0:15], a[100:103], v[36:39], v[0:15]
  ds_read_b128 v[32:35], v203 offset:44032
  v_mfma_f32_32x32x16_bf16 v[16:31], a[244:247], v[36:39], v[16:31]
  s_waitcnt lgkmcnt(2)
  v_mfma_f32_32x32x16_bf16 v[0:15], a[104:107], v[40:43], v[0:15]
  ds_read_b128 v[36:39], v204 offset:44032
  v_mfma_f32_32x32x16_bf16 v[16:31], a[248:251], v[40:43], v[16:31]
  s_waitcnt lgkmcnt(2)
  v_mfma_f32_32x32x16_bf16 v[0:15], a[108:111], v[44:47], v[0:15]
  ds_read_b128 v[40:43], v205 offset:44032
  v_mfma_f32_32x32x16_bf16 v[16:31], a[252:255], v[44:47], v[16:31]
  s_waitcnt lgkmcnt(2)
  v_mfma_f32_32x32x16_bf16 v[0:15], a[112:115], v[32:35], v[0:15]
  ds_read_b128 v[44:47], v206 offset:44032
  v_mfma_f32_32x32x16_bf16 v[16:31], v[224:227], v[32:35], v[16:31]
  s_waitcnt lgkmcnt(2)
  v_mfma_f32_32x32x16_bf16 v[0:15], a[116:119], v[36:39], v[0:15]
  ds_read_b128 v[32:35], v203 offset:45056
  v_mfma_f32_32x32x16_bf16 v[16:31], v[228:231], v[36:39], v[16:31]
  s_waitcnt lgkmcnt(2)
  v_mfma_f32_32x32x16_bf16 v[0:15], a[120:123], v[40:43], v[0:15]
  ds_read_b128 v[36:39], v204 offset:45056
  v_mfma_f32_32x32x16_bf16 v[16:31], v[232:235], v[40:43], v[16:31]
  s_waitcnt lgkmcnt(2)
  v_mfma_f32_32x32x16_bf16 v[0:15], a[124:127], v[44:47], v[0:15]
  ds_read_b128 v[40:43], v205 offset:45056
  v_mfma_f32_32x32x16_bf16 v[16:31], v[236:239], v[44:47], v[16:31]
  s_waitcnt lgkmcnt(2)
  v_mfma_f32_32x32x16_bf16 v[0:15], a[128:131], v[32:35], v[0:15]
  ds_read_b128 v[44:47], v206 offset:45056
  v_mfma_f32_32x32x16_bf16 v[16:31], v[240:243], v[32:35], v[16:31]
  s_waitcnt lgkmcnt(2)
  v_mfma_f32_32x32x16_bf16 v[0:15], a[132:135], v[36:39], v[0:15]
  v_mfma_f32_32x32x16_bf16 v[16:31], v[244:247], v[36:39], v[16:31]
  s_waitcnt lgkmcnt(1)
  v_mfma_f32_32x32x16_bf16 v[0:15], a[136:139], v[40:43], v[0:15]
  v_mfma_f32_32x32x16_bf16 v[16:31], v[248:251], v[40:43], v[16:31]
  s_waitcnt lgkmcnt(0)
  v_mfma_f32_32x32x16_bf16 v[0:15], a[140:143], v[44:47], v[0:15]
  v_mfma_f32_32x32x16_bf16 v[16:31], v[252:255], v[44:47], v[16:31]
  s_add_u32 s60, s60, 36864
  s_nop 2
  v_cvt_pk_bf16_f32 v48, v0, v1
  v_cvt_pk_bf16_f32 v49, v2, v3
  ds_write2_b32 v218, v48, v49 offset0:0 offset1:1
  v_cvt_pk_bf16_f32 v48, v4, v5
  v_cvt_pk_bf16_f32 v49, v6, v7
  ds_write2_b32 v218, v48, v49 offset0:4 offset1:5
  v_cvt_pk_bf16_f32 v48, v8, v9
  v_cvt_pk_bf16_f32 v49, v10, v11
  ds_write2_b32 v218, v48, v49 offset0:8 offset1:9
  v_cvt_pk_bf16_f32 v48, v12, v13
  v_cvt_pk_bf16_f32 v49, v14, v15
  ds_write2_b32 v218, v48, v49 offset0:12 offset1:13
  v_cvt_pk_bf16_f32 v48, v16, v17
  v_cvt_pk_bf16_f32 v49, v18, v19
  ds_write2_b32 v218, v48, v49 offset0:64 offset1:65
  v_cvt_pk_bf16_f32 v48, v20, v21
  v_cvt_pk_bf16_f32 v49, v22, v23
  ds_write2_b32 v218, v48, v49 offset0:68 offset1:69
  v_cvt_pk_bf16_f32 v48, v24, v25
  v_cvt_pk_bf16_f32 v49, v26, v27
  ds_write2_b32 v218, v48, v49 offset0:72 offset1:73
  v_cvt_pk_bf16_f32 v48, v28, v29
  v_cvt_pk_bf16_f32 v49, v30, v31
  ds_write2_b32 v218, v48, v49 offset0:76 offset1:77
  v_add_u32 v218, 16512, v218
  s_waitcnt vmcnt(0) lgkmcnt(0)
  s_barrier
  ds_read_b128 v[32:35], v203 offset:0
  ds_read_b128 v[36:39], v204 offset:0
  ds_read_b128 v[40:43], v205 offset:0
  s_waitcnt lgkmcnt(2)
  v_mfma_f32_32x32x16_bf16 v[0:15], a[0:3], v[32:35], 0
  ds_read_b128 v[44:47], v206 offset:0
  v_mfma_f32_32x32x16_bf16 v[16:31], a[144:147], v[32:35], 0
  s_waitcnt lgkmcnt(2)
  v_mfma_f32_32x32x16_bf16 v[0:15], a[4:7], v[36:39], v[0:15]
  ds_read_b128 v[32:35], v203 offset:1024
  v_mfma_f32_32x32x16_bf16 v[16:31], a[148:151], v[36:39], v[16:31]
  s_waitcnt lgkmcnt(2)
  v_mfma_f32_32x32x16_bf16 v[0:15], a[8:11], v[40:43], v[0:15]
  ds_read_b128 v[36:39], v204 offset:1024
  v_mfma_f32_32x32x16_bf16 v[16:31], a[152:155], v[40:43], v[16:31]
  s_waitcnt lgkmcnt(2)
  v_mfma_f32_32x32x16_bf16 v[0:15], a[12:15], v[44:47], v[0:15]
  ds_read_b128 v[40:43], v205 offset:1024
  v_mfma_f32_32x32x16_bf16 v[16:31], a[156:159], v[44:47], v[16:31]
  s_waitcnt lgkmcnt(2)
  v_mfma_f32_32x32x16_bf16 v[0:15], a[16:19], v[32:35], v[0:15]
  ds_read_b128 v[44:47], v206 offset:1024
  v_mfma_f32_32x32x16_bf16 v[16:31], a[160:163], v[32:35], v[16:31]
  s_waitcnt lgkmcnt(2)
  v_mfma_f32_32x32x16_bf16 v[0:15], a[20:23], v[36:39], v[0:15]
  ds_read_b128 v[32:35], v203 offset:2048
  v_mfma_f32_32x32x16_bf16 v[16:31], a[164:167], v[36:39], v[16:31]
  s_waitcnt lgkmcnt(2)
  v_mfma_f32_32x32x16_bf16 v[0:15], a[24:27], v[40:43], v[0:15]
  ds_read_b128 v[36:39], v204 offset:2048
  v_mfma_f32_32x32x16_bf16 v[16:31], a[168:171], v[40:43], v[16:31]
  s_waitcnt lgkmcnt(2)
  v_mfma_f32_32x32x16_bf16 v[0:15], a[28:31], v[44:47], v[0:15]
  ds_read_b128 v[40:43], v205 offset:2048
  v_mfma_f32_32x32x16_bf16 v[16:31], a[172:175], v[44:47], v[16:31]
  s_waitcnt lgkmcnt(2)
  v_mfma_f32_32x32x16_bf16 v[0:15], a[32:35], v[32:35], v[0:15]
  ds_read_b128 v[44:47], v206 offset:2048
  v_mfma_f32_32x32x16_bf16 v[16:31], a[176:179], v[32:35], v[16:31]
  s_waitcnt lgkmcnt(2)
  v_mfma_f32_32x32x16_bf16 v[0:15], a[36:39], v[36:39], v[0:15]
  ds_read_b128 v[32:35], v203 offset:3072
  v_mfma_f32_32x32x16_bf16 v[16:31], a[180:183], v[36:39], v[16:31]
  s_waitcnt lgkmcnt(2)
  v_mfma_f32_32x32x16_bf16 v[0:15], a[40:43], v[40:43], v[0:15]
  ds_read_b128 v[36:39], v204 offset:3072
  v_mfma_f32_32x32x16_bf16 v[16:31], a[184:187], v[40:43], v[16:31]
  s_waitcnt lgkmcnt(2)
  v_mfma_f32_32x32x16_bf16 v[0:15], a[44:47], v[44:47], v[0:15]
  ds_read_b128 v[40:43], v205 offset:3072
  v_mfma_f32_32x32x16_bf16 v[16:31], a[188:191], v[44:47], v[16:31]
  s_waitcnt lgkmcnt(2)
  v_mfma_f32_32x32x16_bf16 v[0:15], a[48:51], v[32:35], v[0:15]
  ds_read_b128 v[44:47], v206 offset:3072
  v_mfma_f32_32x32x16_bf16 v[16:31], a[192:195], v[32:35], v[16:31]
  s_waitcnt lgkmcnt(2)
  v_mfma_f32_32x32x16_bf16 v[0:15], a[52:55], v[36:39], v[0:15]
  ds_read_b128 v[32:35], v203 offset:4096
  v_mfma_f32_32x32x16_bf16 v[16:31], a[196:199], v[36:39], v[16:31]
  s_waitcnt lgkmcnt(2)
  v_mfma_f32_32x32x16_bf16 v[0:15], a[56:59], v[40:43], v[0:15]
  ds_read_b128 v[36:39], v204 offset:4096
  v_mfma_f32_32x32x16_bf16 v[16:31], a[200:203], v[40:43], v[16:31]
  s_waitcnt lgkmcnt(2)
  v_mfma_f32_32x32x16_bf16 v[0:15], a[60:63], v[44:47], v[0:15]
  ds_read_b128 v[40:43], v205 offset:4096
  v_mfma_f32_32x32x16_bf16 v[16:31], a[204:207], v[44:47], v[16:31]
  s_waitcnt lgkmcnt(2)
  v_mfma_f32_32x32x16_bf16 v[0:15], a[64:67], v[32:35], v[0:15]
  ds_read_b128 v[44:47], v206 offset:4096
  v_mfma_f32_32x32x16_bf16 v[16:31], a[208:211], v[32:35], v[16:31]
  s_waitcnt lgkmcnt(2)
  v_mfma_f32_32x32x16_bf16 v[0:15], a[68:71], v[36:39], v[0:15]
  ds_read_b128 v[32:35], v203 offset:5120
  v_mfma_f32_32x32x16_bf16 v[16:31], a[212:215], v[36:39], v[16:31]
  s_waitcnt lgkmcnt(2)
  v_mfma_f32_32x32x16_bf16 v[0:15], a[72:75], v[40:43], v[0:15]
  ds_read_b128 v[36:39], v204 offset:5120
  v_mfma_f32_32x32x16_bf16 v[16:31], a[216:219], v[40:43], v[16:31]
  s_waitcnt lgkmcnt(2)
  v_mfma_f32_32x32x16_bf16 v[0:15], a[76:79], v[44:47], v[0:15]
  ds_read_b128 v[40:43], v205 offset:5120
  v_mfma_f32_32x32x16_bf16 v[16:31], a[220:223], v[44:47], v[16:31]
  s_waitcnt lgkmcnt(2)
  v_mfma_f32_32x32x16_bf16 v[0:15], a[80:83], v[32:35], v[0:15]
  ds_read_b128 v[44:47], v206 offset:5120
  v_mfma_f32_32x32x16_bf16 v[16:31], a[224:227], v[32:35], v[16:31]
  s_waitcnt lgkmcnt(2)
  v_mfma_f32_32x32x16_bf16 v[0:15], a[84:87], v[36:39], v[0:15]
  ds_read_b128 v[32:35], v203 offset:6144
  v_mfma_f32_32x32x16_bf16 v[16:31], a[228:231], v[36:39], v[16:31]
  s_waitcnt lgkmcnt(2)
  v_mfma_f32_32x32x16_bf16 v[0:15], a[88:91], v[40:43], v[0:15]
  ds_read_b128 v[36:39], v204 offset:6144
  v_mfma_f32_32x32x16_bf16 v[16:31], a[232:235], v[40:43], v[16:31]
  s_waitcnt lgkmcnt(2)
  v_mfma_f32_32x32x16_bf16 v[0:15], a[92:95], v[44:47], v[0:15]
  ds_read_b128 v[40:43], v205 offset:6144
  v_mfma_f32_32x32x16_bf16 v[16:31], a[236:239], v[44:47], v[16:31]
  s_waitcnt lgkmcnt(2)
  v_mfma_f32_32x32x16_bf16 v[0:15], a[96:99], v[32:35], v[0:15]
  ds_read_b128 v[44:47], v206 offset:6144
  v_mfma_f32_32x32x16_bf16 v[16:31], a[240:243], v[32:35], v[16:31]
  s_waitcnt lgkmcnt(2)
  v_mfma_f32_32x32x16_bf16 v[0:15], a[100:103], v[36:39], v[0:15]
  ds_read_b128 v[32:35], v203 offset:7168
  v_mfma_f32_32x32x16_bf16 v[16:31], a[244:247], v[36:39], v[16:31]
  s_waitcnt lgkmcnt(2)
  v_mfma_f32_32x32x16_bf16 v[0:15], a[104:107], v[40:43], v[0:15]
  ds_read_b128 v[36:39], v204 offset:7168
  v_mfma_f32_32x32x16_bf16 v[16:31], a[248:251], v[40:43], v[16:31]
  s_waitcnt lgkmcnt(2)
  v_mfma_f32_32x32x16_bf16 v[0:15], a[108:111], v[44:47], v[0:15]
  ds_read_b128 v[40:43], v205 offset:7168
  v_mfma_f32_32x32x16_bf16 v[16:31], a[252:255], v[44:47], v[16:31]
  s_waitcnt lgkmcnt(2)
  v_mfma_f32_32x32x16_bf16 v[0:15], a[112:115], v[32:35], v[0:15]
  ds_read_b128 v[44:47], v206 offset:7168
  v_mfma_f32_32x32x16_bf16 v[16:31], v[224:227], v[32:35], v[16:31]
  s_waitcnt lgkmcnt(2)
  v_mfma_f32_32x32x16_bf16 v[0:15], a[116:119], v[36:39], v[0:15]
  ds_read_b128 v[32:35], v203 offset:8192
  v_mfma_f32_32x32x16_bf16 v[16:31], v[228:231], v[36:39], v[16:31]
  s_waitcnt lgkmcnt(2)
  v_mfma_f32_32x32x16_bf16 v[0:15], a[120:123], v[40:43], v[0:15]
  ds_read_b128 v[36:39], v204 offset:8192
  v_mfma_f32_32x32x16_bf16 v[16:31], v[232:235], v[40:43], v[16:31]
  s_waitcnt lgkmcnt(2)
  v_mfma_f32_32x32x16_bf16 v[0:15], a[124:127], v[44:47], v[0:15]
  ds_read_b128 v[40:43], v205 offset:8192
  v_mfma_f32_32x32x16_bf16 v[16:31], v[236:239], v[44:47], v[16:31]
  s_waitcnt lgkmcnt(2)
  v_mfma_f32_32x32x16_bf16 v[0:15], a[128:131], v[32:35], v[0:15]
  ds_read_b128 v[44:47], v206 offset:8192
  v_mfma_f32_32x32x16_bf16 v[16:31], v[240:243], v[32:35], v[16:31]
  s_waitcnt lgkmcnt(2)
  v_mfma_f32_32x32x16_bf16 v[0:15], a[132:135], v[36:39], v[0:15]
  v_mfma_f32_32x32x16_bf16 v[16:31], v[244:247], v[36:39], v[16:31]
  s_waitcnt lgkmcnt(1)
  v_mfma_f32_32x32x16_bf16 v[0:15], a[136:139], v[40:43], v[0:15]
  v_mfma_f32_32x32x16_bf16 v[16:31], v[248:251], v[40:43], v[16:31]
  s_waitcnt lgkmcnt(0)
  v_mfma_f32_32x32x16_bf16 v[0:15], a[140:143], v[44:47], v[0:15]
  v_mfma_f32_32x32x16_bf16 v[16:31], v[252:255], v[44:47], v[16:31]
  s_add_u32 s60, s60, 36864
  s_nop 2
  v_cvt_pk_bf16_f32 v48, v0, v1
  v_cvt_pk_bf16_f32 v49, v2, v3
  ds_write2_b32 v218, v48, v49 offset0:0 offset1:1
  v_cvt_pk_bf16_f32 v48, v4, v5
  v_cvt_pk_bf16_f32 v49, v6, v7
  ds_write2_b32 v218, v48, v49 offset0:4 offset1:5
  v_cvt_pk_bf16_f32 v48, v8, v9
  v_cvt_pk_bf16_f32 v49, v10, v11
  ds_write2_b32 v218, v48, v49 offset0:8 offset1:9
  v_cvt_pk_bf16_f32 v48, v12, v13
  v_cvt_pk_bf16_f32 v49, v14, v15
  ds_write2_b32 v218, v48, v49 offset0:12 offset1:13
  v_cvt_pk_bf16_f32 v48, v16, v17
  v_cvt_pk_bf16_f32 v49, v18, v19
  ds_write2_b32 v218, v48, v49 offset0:64 offset1:65
  v_cvt_pk_bf16_f32 v48, v20, v21
  v_cvt_pk_bf16_f32 v49, v22, v23
  ds_write2_b32 v218, v48, v49 offset0:68 offset1:69
  v_cvt_pk_bf16_f32 v48, v24, v25
  v_cvt_pk_bf16_f32 v49, v26, v27
  ds_write2_b32 v218, v48, v49 offset0:72 offset1:73
  v_cvt_pk_bf16_f32 v48, v28, v29
  v_cvt_pk_bf16_f32 v49, v30, v31
  ds_write2_b32 v218, v48, v49 offset0:76 offset1:77
  v_add_u32 v218, 16512, v218
  s_waitcnt vmcnt(0) lgkmcnt(0)
  s_barrier
  v_mul_u32_u24 v219, 516, v200
  s_mul_i32 s54, s52, 36
  s_add_u32 s55, s54, 83016
  v_add_u32 v219, s55, v219
  v_mul_u32_u24 v220, 144, v200
  v_add_u32 v220, s54, v220
  s_mul_i32 s54, s52, 3072
  v_add_u32 v218, s54, v201
  s_lshl_b32 s55, s68, 4
  s_add_u32 s55, s55, s69
  s_mul_i32 s64, s55, 18432
  s_add_u32 s64, s64, 62914560
  s_cmp_eq_u32 s52, 3
  s_cselect_b32 s64, 268435456, s64
  s_lshl_b32 s66, s69, 7
  s_mov_b32 s57, 1051597459
  ds_read_b32 v0, v219 offset:7224
  ds_read_b32 v1, v219 offset:7228
  ds_read_b32 v2, v219 offset:7232
  ds_read_b32 v3, v219 offset:7236
  ds_read_b32 v4, v219 offset:7240
  ds_read_b32 v5, v219 offset:7244
  ds_read_b32 v6, v219 offset:7248
  ds_read_b32 v7, v219 offset:7252
  ds_read_b32 v8, v219 offset:7256
  ds_read_b32 v16, v219 offset:7368
  ds_read_b32 v17, v219 offset:7372
  ds_read_b32 v18, v219 offset:7376
  ds_read_b32 v19, v219 offset:7380
  ds_read_b32 v20, v219 offset:7384
  ds_read_b32 v21, v219 offset:7388
  ds_read_b32 v22, v219 offset:7392
  ds_read_b32 v23, v219 offset:7396
  ds_read_b32 v24, v219 offset:7400
  ds_read_b32 v25, v219 offset:6336
  ds_read_b32 v26, v219 offset:6340
  ds_read_b32 v27, v219 offset:6344
  ds_read_b32 v28, v219 offset:6348
  ds_read_b32 v29, v219 offset:6352
  ds_read_b32 v30, v219 offset:6356
  ds_read_b32 v31, v219 offset:6360
  ds_read_b32 v32, v219 offset:6364
  ds_read_b32 v33, v219 offset:6368
  ds_read_b32 v34, v219 offset:5304
  ds_read_b32 v35, v219 offset:5308
  ds_read_b32 v36, v219 offset:5312
  ds_read_b32 v37, v219 offset:5316
  ds_read_b32 v38, v219 offset:5320
  ds_read_b32 v39, v219 offset:5324
  ds_read_b32 v40, v219 offset:5328
  ds_read_b32 v41, v219 offset:5332
  ds_read_b32 v42, v219 offset:5336
  ds_read_b32 v43, v219 offset:4272
  ds_read_b32 v44, v219 offset:4276
  ds_read_b32 v45, v219 offset:4280
  ds_read_b32 v46, v219 offset:4284
  ds_read_b32 v47, v219 offset:4288
  ds_read_b32 v48, v219 offset:4292
  ds_read_b32 v49, v219 offset:4296
  ds_read_b32 v50, v219 offset:4300
  ds_read_b32 v51, v219 offset:4304
  ds_read_b32 v52, v219 offset:3240
  ds_read_b32 v53, v219 offset:3244
  ds_read_b32 v54, v219 offset:3248
  ds_read_b32 v55, v219 offset:3252
  ds_read_b32 v56, v219 offset:3256
  ds_read_b32 v57, v219 offset:3260
  ds_read_b32 v58, v219 offset:3264
  ds_read_b32 v59, v219 offset:3268
  ds_read_b32 v60, v219 offset:3272
  ds_read_b32 v61, v219 offset:2208
  ds_read_b32 v62, v219 offset:2212
  ds_read_b32 v63, v219 offset:2216
  ds_read_b32 v64, v219 offset:2220
  ds_read_b32 v65, v219 offset:2224
  ds_read_b32 v66, v219 offset:2228
  ds_read_b32 v67, v219 offset:2232
  ds_read_b32 v68, v219 offset:2236
  ds_read_b32 v69, v219 offset:2240
  ds_read_b32 v70, v219 offset:1176
  ds_read_b32 v71, v219 offset:1180
  ds_read_b32 v72, v219 offset:1184
  ds_read_b32 v73, v219 offset:1188
  ds_read_b32 v74, v219 offset:1192
  ds_read_b32 v75, v219 offset:1196
  ds_read_b32 v76, v219 offset:1200
  ds_read_b32 v77, v219 offset:1204
  ds_read_b32 v78, v219 offset:1208
  ds_read_b32 v79, v219 offset:144
  ds_read_b32 v80, v219 offset:148
  ds_read_b32 v81, v219 offset:152
  ds_read_b32 v82, v219 offset:156
  ds_read_b32 v83, v219 offset:160
  ds_read_b32 v84, v219 offset:164
  ds_read_b32 v85, v219 offset:168
  ds_read_b32 v86, v219 offset:172
  ds_read_b32 v87, v219 offset:176
  v_mov_b32 v100, 0
  v_mov_b32 v101, 0
  v_mov_b32 v102, 0
  v_mov_b32 v103, 0
  v_mov_b32 v104, 0
  v_mov_b32 v105, 0
  v_mov_b32 v106, 0
  v_mov_b32 v107, 0
  s_waitcnt lgkmcnt(15)
  v_dot2c_f32_bf16 v100, v0, v16
  v_dot2c_f32_bf16 v101, v0, v25
  v_dot2c_f32_bf16 v102, v0, v34
  v_dot2c_f32_bf16 v103, v0, v43
  v_dot2c_f32_bf16 v104, v0, v52
  v_dot2c_f32_bf16 v105, v0, v61
  v_dot2c_f32_bf16 v106, v0, v70
  s_waitcnt lgkmcnt(8)
  v_dot2c_f32_bf16 v107, v0, v79
  v_dot2c_f32_bf16 v100, v1, v17
  v_dot2c_f32_bf16 v101, v1, v26
  v_dot2c_f32_bf16 v102, v1, v35
  v_dot2c_f32_bf16 v103, v1, v44
  v_dot2c_f32_bf16 v104, v1, v53
  v_dot2c_f32_bf16 v105, v1, v62
  v_dot2c_f32_bf16 v106, v1, v71
  s_waitcnt lgkmcnt(7)
  v_dot2c_f32_bf16 v107, v1, v80
  v_dot2c_f32_bf16 v100, v2, v18
  v_dot2c_f32_bf16 v101, v2, v27
  v_dot2c_f32_bf16 v102, v2, v36
  v_dot2c_f32_bf16 v103, v2, v45
  v_dot2c_f32_bf16 v104, v2, v54
  v_dot2c_f32_bf16 v105, v2, v63
  v_dot2c_f32_bf16 v106, v2, v72
  s_waitcnt lgkmcnt(6)
  v_dot2c_f32_bf16 v107, v2, v81
  v_dot2c_f32_bf16 v100, v3, v19
  v_dot2c_f32_bf16 v101, v3, v28
  v_dot2c_f32_bf16 v102, v3, v37
  v_dot2c_f32_bf16 v103, v3, v46
  v_dot2c_f32_bf16 v104, v3, v55
  v_dot2c_f32_bf16 v105, v3, v64
  v_dot2c_f32_bf16 v106, v3, v73
  s_waitcnt lgkmcnt(5)
  v_dot2c_f32_bf16 v107, v3, v82
  v_dot2c_f32_bf16 v100, v4, v20
  v_dot2c_f32_bf16 v101, v4, v29
  v_dot2c_f32_bf16 v102, v4, v38
  v_dot2c_f32_bf16 v103, v4, v47
  v_dot2c_f32_bf16 v104, v4, v56
  v_dot2c_f32_bf16 v105, v4, v65
  v_dot2c_f32_bf16 v106, v4, v74
  s_waitcnt lgkmcnt(4)
  v_dot2c_f32_bf16 v107, v4, v83
  v_dot2c_f32_bf16 v100, v5, v21
  v_dot2c_f32_bf16 v101, v5, v30
  v_dot2c_f32_bf16 v102, v5, v39
  v_dot2c_f32_bf16 v103, v5, v48
  v_dot2c_f32_bf16 v104, v5, v57
  v_dot2c_f32_bf16 v105, v5, v66
  v_dot2c_f32_bf16 v106, v5, v75
  s_waitcnt lgkmcnt(3)
  v_dot2c_f32_bf16 v107, v5, v84
  v_dot2c_f32_bf16 v100, v6, v22
  v_dot2c_f32_bf16 v101, v6, v31
  v_dot2c_f32_bf16 v102, v6, v40
  v_dot2c_f32_bf16 v103, v6, v49
  v_dot2c_f32_bf16 v104, v6, v58
  v_dot2c_f32_bf16 v105, v6, v67
  v_dot2c_f32_bf16 v106, v6, v76
  s_waitcnt lgkmcnt(2)
  v_dot2c_f32_bf16 v107, v6, v85
  v_dot2c_f32_bf16 v100, v7, v23
  v_dot2c_f32_bf16 v101, v7, v32
  v_dot2c_f32_bf16 v102, v7, v41
  v_dot2c_f32_bf16 v103, v7, v50
  v_dot2c_f32_bf16 v104, v7, v59
  v_dot2c_f32_bf16 v105, v7, v68
  v_dot2c_f32_bf16 v106, v7, v77
  s_waitcnt lgkmcnt(1)
  v_dot2c_f32_bf16 v107, v7, v86
  v_dot2c_f32_bf16 v100, v8, v24
  v_dot2c_f32_bf16 v101, v8, v33
  v_dot2c_f32_bf16 v102, v8, v42
  v_dot2c_f32_bf16 v103, v8, v51
  v_dot2c_f32_bf16 v104, v8, v60
  v_dot2c_f32_bf16 v105, v8, v69
  v_dot2c_f32_bf16 v106, v8, v78
  s_waitcnt lgkmcnt(0)
  v_dot2c_f32_bf16 v107, v8, v87
  ds_read_b32 v16, v219 offset:7512
  ds_read_b32 v17, v219 offset:7516
  ds_read_b32 v18, v219 offset:7520
  ds_read_b32 v19, v219 offset:7524
  ds_read_b32 v20, v219 offset:7528
  ds_read_b32 v21, v219 offset:7532
  ds_read_b32 v22, v219 offset:7536
  ds_read_b32 v23, v219 offset:7540
  ds_read_b32 v24, v219 offset:7544
  ds_read_b32 v25, v219 offset:6480
  ds_read_b32 v26, v219 offset:6484
  ds_read_b32 v27, v219 offset:6488
  ds_read_b32 v28, v219 offset:6492
  ds_read_b32 v29, v219 offset:6496
  ds_read_b32 v30, v219 offset:6500
  ds_read_b32 v31, v219 offset:6504
  ds_read_b32 v32, v219 offset:6508
  ds_read_b32 v33, v219 offset:6512
  ds_read_b32 v34, v219 offset:5448
  ds_read_b32 v35, v219 offset:5452
  ds_read_b32 v36, v219 offset:5456
  ds_read_b32 v37, v219 offset:5460
  ds_read_b32 v38, v219 offset:5464
  ds_read_b32 v39, v219 offset:5468
  ds_read_b32 v40, v219 offset:5472
  ds_read_b32 v41, v219 offset:5476
  ds_read_b32 v42, v219 offset:5480
  ds_read_b32 v43, v219 offset:4416
  ds_read_b32 v44, v219 offset:4420
  ds_read_b32 v45, v219 offset:4424
  ds_read_b32 v46, v219 offset:4428
  ds_read_b32 v47, v219 offset:4432
  ds_read_b32 v48, v219 offset:4436
  ds_read_b32 v49, v219 offset:4440
  ds_read_b32 v50, v219 offset:4444
  ds_read_b32 v51, v219 offset:4448
  ds_read_b32 v52, v219 offset:3384
  ds_read_b32 v53, v219 offset:3388
  ds_read_b32 v54, v219 offset:3392
  ds_read_b32 v55, v219 offset:3396
  ds_read_b32 v56, v219 offset:3400
  ds_read_b32 v57, v219 offset:3404
  ds_read_b32 v58, v219 offset:3408
  ds_read_b32 v59, v219 offset:3412
  ds_read_b32 v60, v219 offset:3416
  ds_read_b32 v61, v219 offset:2352
  ds_read_b32 v62, v219 offset:2356
  ds_read_b32 v63, v219 offset:2360
  ds_read_b32 v64, v219 offset:2364
  ds_read_b32 v65, v219 offset:2368
  ds_read_b32 v66, v219 offset:2372
  ds_read_b32 v67, v219 offset:2376
  ds_read_b32 v68, v219 offset:2380
  ds_read_b32 v69, v219 offset:2384
  ds_read_b32 v70, v219 offset:1320
  ds_read_b32 v71, v219 offset:1324
  ds_read_b32 v72, v219 offset:1328
  ds_read_b32 v73, v219 offset:1332
  ds_read_b32 v74, v219 offset:1336
  ds_read_b32 v75, v219 offset:1340
  ds_read_b32 v76, v219 offset:1344
  ds_read_b32 v77, v219 offset:1348
  ds_read_b32 v78, v219 offset:1352
  ds_read_b32 v79, v219 offset:288
  ds_read_b32 v80, v219 offset:292
  ds_read_b32 v81, v219 offset:296
  ds_read_b32 v82, v219 offset:300
  ds_read_b32 v83, v219 offset:304
  ds_read_b32 v84, v219 offset:308
  ds_read_b32 v85, v219 offset:312
  ds_read_b32 v86, v219 offset:316
  ds_read_b32 v87, v219 offset:320
  v_add_u32 v211, s66, v200
  v_mov_b32 v212, 0xf149f2ca
  v_mul_f32 v100, s57, v100
  v_mul_f32 v101, s57, v101
  v_mul_f32 v102, s57, v102
  v_mul_f32 v103, s57, v103
  v_mul_f32 v104, s57, v104
  v_mul_f32 v105, s57, v105
  v_mul_f32 v106, s57, v106
  v_mul_f32 v107, s57, v107
  v_cmp_gt_u32 vcc, 2, v211
  s_nop 1
  v_cndmask_b32 v101, v101, v212, vcc
  v_cmp_gt_u32 vcc, 4, v211
  s_nop 1
  v_cndmask_b32 v102, v102, v212, vcc
  v_cmp_gt_u32 vcc, 6, v211
  s_nop 1
  v_cndmask_b32 v103, v103, v212, vcc
  v_cmp_gt_u32 vcc, 8, v211
  s_nop 1
  v_cndmask_b32 v104, v104, v212, vcc
  v_cmp_gt_u32 vcc, 10, v211
  s_nop 1
  v_cndmask_b32 v105, v105, v212, vcc
  v_cmp_gt_u32 vcc, 12, v211
  s_nop 1
  v_cndmask_b32 v106, v106, v212, vcc
  v_cmp_gt_u32 vcc, 14, v211
  s_nop 1
  v_cndmask_b32 v107, v107, v212, vcc
  v_max3_f32 v213, v100, v101, v102
  v_max3_f32 v213, v213, v103, v104
  v_max3_f32 v213, v213, v105, v106
  v_max_f32 v213, v213, v107
  v_sub_f32 v100, v100, v213
  v_sub_f32 v101, v101, v213
  v_sub_f32 v102, v102, v213
  v_sub_f32 v103, v103, v213
  v_sub_f32 v104, v104, v213
  v_sub_f32 v105, v105, v213
  v_sub_f32 v106, v106, v213
  v_sub_f32 v107, v107, v213
  v_exp_f32 v100, v100
  v_exp_f32 v101, v101
  v_exp_f32 v102, v102
  v_exp_f32 v103, v103
  v_exp_f32 v104, v104
  v_exp_f32 v105, v105
  v_exp_f32 v106, v106
  v_exp_f32 v107, v107
  v_add_f32 v213, v100, v101
  v_add_f32 v213, v213, v102
  v_add_f32 v213, v213, v103
  v_add_f32 v213, v213, v104
  v_add_f32 v213, v213, v105
  v_add_f32 v213, v213, v106
  v_add_f32 v213, v213, v107
  v_rcp_f32 v213, v213
  v_mov_b32 v214, 0
  v_mul_f32 v100, v213, v100
  v_mul_f32 v101, v213, v101
  v_mul_f32 v102, v213, v102
  v_mul_f32 v103, v213, v103
  v_mul_f32 v104, v213, v104
  v_mul_f32 v105, v213, v105
  v_mul_f32 v106, v213, v106
  v_mul_f32 v107, v213, v107
  v_mov_b32 v112, 0
  v_mov_b32 v113, 0
  v_mov_b32 v114, 0
  v_mov_b32 v115, 0
  v_mov_b32 v116, 0
  v_mov_b32 v117, 0
  v_mov_b32 v118, 0
  v_mov_b32 v119, 0
  v_mov_b32 v120, 0
  v_mov_b32 v121, 0
  v_mov_b32 v122, 0
  v_mov_b32 v123, 0
  v_mov_b32 v124, 0
  v_mov_b32 v125, 0
  v_mov_b32 v126, 0
  v_mov_b32 v127, 0
  v_mov_b32 v128, 0
  v_mov_b32 v129, 0
  v_cvt_pk_bf16_f32 v0, v100, v214
  v_cvt_pk_bf16_f32 v1, v214, v100
  s_waitcnt lgkmcnt(15)
  v_dot2c_f32_bf16 v112, v16, v0
  v_dot2c_f32_bf16 v113, v16, v1
  v_dot2c_f32_bf16 v114, v17, v0
  v_dot2c_f32_bf16 v115, v17, v1
  v_dot2c_f32_bf16 v116, v18, v0
  v_dot2c_f32_bf16 v117, v18, v1
  v_dot2c_f32_bf16 v118, v19, v0
  v_dot2c_f32_bf16 v119, v19, v1
  v_dot2c_f32_bf16 v120, v20, v0
  v_dot2c_f32_bf16 v121, v20, v1
  v_dot2c_f32_bf16 v122, v21, v0
  v_dot2c_f32_bf16 v123, v21, v1
  v_dot2c_f32_bf16 v124, v22, v0
  v_dot2c_f32_bf16 v125, v22, v1
  v_dot2c_f32_bf16 v126, v23, v0
  v_dot2c_f32_bf16 v127, v23, v1
  v_dot2c_f32_bf16 v128, v24, v0
  v_dot2c_f32_bf16 v129, v24, v1
  v_cvt_pk_bf16_f32 v2, v101, v214
  v_cvt_pk_bf16_f32 v3, v214, v101
  v_dot2c_f32_bf16 v112, v25, v2
  v_dot2c_f32_bf16 v113, v25, v3
  v_dot2c_f32_bf16 v114, v26, v2
  v_dot2c_f32_bf16 v115, v26, v3
  v_dot2c_f32_bf16 v116, v27, v2
  v_dot2c_f32_bf16 v117, v27, v3
  v_dot2c_f32_bf16 v118, v28, v2
  v_dot2c_f32_bf16 v119, v28, v3
  v_dot2c_f32_bf16 v120, v29, v2
  v_dot2c_f32_bf16 v121, v29, v3
  v_dot2c_f32_bf16 v122, v30, v2
  v_dot2c_f32_bf16 v123, v30, v3
  v_dot2c_f32_bf16 v124, v31, v2
  v_dot2c_f32_bf16 v125, v31, v3
  v_dot2c_f32_bf16 v126, v32, v2
  v_dot2c_f32_bf16 v127, v32, v3
  v_dot2c_f32_bf16 v128, v33, v2
  v_dot2c_f32_bf16 v129, v33, v3
  v_cvt_pk_bf16_f32 v0, v102, v214
  v_cvt_pk_bf16_f32 v1, v214, v102
  v_dot2c_f32_bf16 v112, v34, v0
  v_dot2c_f32_bf16 v113, v34, v1
  v_dot2c_f32_bf16 v114, v35, v0
  v_dot2c_f32_bf16 v115, v35, v1
  v_dot2c_f32_bf16 v116, v36, v0
  v_dot2c_f32_bf16 v117, v36, v1
  v_dot2c_f32_bf16 v118, v37, v0
  v_dot2c_f32_bf16 v119, v37, v1
  v_dot2c_f32_bf16 v120, v38, v0
  v_dot2c_f32_bf16 v121, v38, v1
  v_dot2c_f32_bf16 v122, v39, v0
  v_dot2c_f32_bf16 v123, v39, v1
  v_dot2c_f32_bf16 v124, v40, v0
  v_dot2c_f32_bf16 v125, v40, v1
  v_dot2c_f32_bf16 v126, v41, v0
  v_dot2c_f32_bf16 v127, v41, v1
  v_dot2c_f32_bf16 v128, v42, v0
  v_dot2c_f32_bf16 v129, v42, v1
  v_cvt_pk_bf16_f32 v2, v103, v214
  v_cvt_pk_bf16_f32 v3, v214, v103
  v_dot2c_f32_bf16 v112, v43, v2
  v_dot2c_f32_bf16 v113, v43, v3
  v_dot2c_f32_bf16 v114, v44, v2
  v_dot2c_f32_bf16 v115, v44, v3
  v_dot2c_f32_bf16 v116, v45, v2
  v_dot2c_f32_bf16 v117, v45, v3
  v_dot2c_f32_bf16 v118, v46, v2
  v_dot2c_f32_bf16 v119, v46, v3
  v_dot2c_f32_bf16 v120, v47, v2
  v_dot2c_f32_bf16 v121, v47, v3
  v_dot2c_f32_bf16 v122, v48, v2
  v_dot2c_f32_bf16 v123, v48, v3
  v_dot2c_f32_bf16 v124, v49, v2
  v_dot2c_f32_bf16 v125, v49, v3
  v_dot2c_f32_bf16 v126, v50, v2
  v_dot2c_f32_bf16 v127, v50, v3
  v_dot2c_f32_bf16 v128, v51, v2
  v_dot2c_f32_bf16 v129, v51, v3
  v_cvt_pk_bf16_f32 v0, v104, v214
  v_cvt_pk_bf16_f32 v1, v214, v104
  v_dot2c_f32_bf16 v112, v52, v0
  v_dot2c_f32_bf16 v113, v52, v1
  v_dot2c_f32_bf16 v114, v53, v0
  v_dot2c_f32_bf16 v115, v53, v1
  v_dot2c_f32_bf16 v116, v54, v0
  v_dot2c_f32_bf16 v117, v54, v1
  v_dot2c_f32_bf16 v118, v55, v0
  v_dot2c_f32_bf16 v119, v55, v1
  v_dot2c_f32_bf16 v120, v56, v0
  v_dot2c_f32_bf16 v121, v56, v1
  v_dot2c_f32_bf16 v122, v57, v0
  v_dot2c_f32_bf16 v123, v57, v1
  v_dot2c_f32_bf16 v124, v58, v0
  v_dot2c_f32_bf16 v125, v58, v1
  v_dot2c_f32_bf16 v126, v59, v0
  v_dot2c_f32_bf16 v127, v59, v1
  v_dot2c_f32_bf16 v128, v60, v0
  v_dot2c_f32_bf16 v129, v60, v1
  v_cvt_pk_bf16_f32 v2, v105, v214
  v_cvt_pk_bf16_f32 v3, v214, v105
  v_dot2c_f32_bf16 v112, v61, v2
  v_dot2c_f32_bf16 v113, v61, v3
  v_dot2c_f32_bf16 v114, v62, v2
  v_dot2c_f32_bf16 v115, v62, v3
  v_dot2c_f32_bf16 v116, v63, v2
  v_dot2c_f32_bf16 v117, v63, v3
  v_dot2c_f32_bf16 v118, v64, v2
  v_dot2c_f32_bf16 v119, v64, v3
  v_dot2c_f32_bf16 v120, v65, v2
  v_dot2c_f32_bf16 v121, v65, v3
  v_dot2c_f32_bf16 v122, v66, v2
  v_dot2c_f32_bf16 v123, v66, v3
  v_dot2c_f32_bf16 v124, v67, v2
  v_dot2c_f32_bf16 v125, v67, v3
  v_dot2c_f32_bf16 v126, v68, v2
  v_dot2c_f32_bf16 v127, v68, v3
  v_dot2c_f32_bf16 v128, v69, v2
  v_dot2c_f32_bf16 v129, v69, v3
  v_cvt_pk_bf16_f32 v0, v106, v214
  v_cvt_pk_bf16_f32 v1, v214, v106
  v_dot2c_f32_bf16 v112, v70, v0
  v_dot2c_f32_bf16 v113, v70, v1
  v_dot2c_f32_bf16 v114, v71, v0
  v_dot2c_f32_bf16 v115, v71, v1
  v_dot2c_f32_bf16 v116, v72, v0
  v_dot2c_f32_bf16 v117, v72, v1
  s_waitcnt lgkmcnt(14)
  v_dot2c_f32_bf16 v118, v73, v0
  v_dot2c_f32_bf16 v119, v73, v1
  s_waitcnt lgkmcnt(13)
  v_dot2c_f32_bf16 v120, v74, v0
  v_dot2c_f32_bf16 v121, v74, v1
  s_waitcnt lgkmcnt(12)
  v_dot2c_f32_bf16 v122, v75, v0
  v_dot2c_f32_bf16 v123, v75, v1
  s_waitcnt lgkmcnt(11)
  v_dot2c_f32_bf16 v124, v76, v0
  v_dot2c_f32_bf16 v125, v76, v1
  s_waitcnt lgkmcnt(10)
  v_dot2c_f32_bf16 v126, v77, v0
  v_dot2c_f32_bf16 v127, v77, v1
  s_waitcnt lgkmcnt(9)
  v_dot2c_f32_bf16 v128, v78, v0
  v_dot2c_f32_bf16 v129, v78, v1
  v_cvt_pk_bf16_f32 v2, v107, v214
  v_cvt_pk_bf16_f32 v3, v214, v107
  s_waitcnt lgkmcnt(8)
  v_dot2c_f32_bf16 v112, v79, v2
  v_dot2c_f32_bf16 v113, v79, v3
  s_waitcnt lgkmcnt(7)
  v_dot2c_f32_bf16 v114, v80, v2
  v_dot2c_f32_bf16 v115, v80, v3
  s_waitcnt lgkmcnt(6)
  v_dot2c_f32_bf16 v116, v81, v2
  v_dot2c_f32_bf16 v117, v81, v3
  s_waitcnt lgkmcnt(5)
  v_dot2c_f32_bf16 v118, v82, v2
  v_dot2c_f32_bf16 v119, v82, v3
  s_waitcnt lgkmcnt(4)
  v_dot2c_f32_bf16 v120, v83, v2
  v_dot2c_f32_bf16 v121, v83, v3
  s_waitcnt lgkmcnt(3)
  v_dot2c_f32_bf16 v122, v84, v2
  v_dot2c_f32_bf16 v123, v84, v3
  s_waitcnt lgkmcnt(2)
  v_dot2c_f32_bf16 v124, v85, v2
  v_dot2c_f32_bf16 v125, v85, v3
  s_waitcnt lgkmcnt(1)
  v_dot2c_f32_bf16 v126, v86, v2
  v_dot2c_f32_bf16 v127, v86, v3
  s_waitcnt lgkmcnt(0)
  v_dot2c_f32_bf16 v128, v87, v2
  v_dot2c_f32_bf16 v129, v87, v3
  v_cvt_pk_bf16_f32 v132, v112, v113
  v_cvt_pk_bf16_f32 v133, v114, v115
  v_cvt_pk_bf16_f32 v134, v116, v117
  v_cvt_pk_bf16_f32 v135, v118, v119
  v_cvt_pk_bf16_f32 v136, v120, v121
  v_cvt_pk_bf16_f32 v137, v122, v123
  v_cvt_pk_bf16_f32 v138, v124, v125
  v_cvt_pk_bf16_f32 v139, v126, v127
  v_cvt_pk_bf16_f32 v140, v128, v129
  ds_write_b32 v220, v132 offset:0
  ds_write_b32 v220, v133 offset:4
  ds_write_b32 v220, v134 offset:8
  ds_write_b32 v220, v135 offset:12
  ds_write_b32 v220, v136 offset:16
  ds_write_b32 v220, v137 offset:20
  ds_write_b32 v220, v138 offset:24
  ds_write_b32 v220, v139 offset:28
  ds_write_b32 v220, v140 offset:32
  s_waitcnt lgkmcnt(0)
  s_barrier
  ds_read_b128 v[144:147], v218 offset:0
  ds_read_b128 v[148:151], v218 offset:1024
  ds_read_b128 v[152:155], v218 offset:2048
  s_waitcnt lgkmcnt(2)
  buffer_store_dwordx4 v[144:147], v218, s[8:11], s64 offen offset:0 sc1
  s_waitcnt lgkmcnt(1)
  buffer_store_dwordx4 v[148:151], v218, s[8:11], s64 offen offset:1024 sc1
  s_waitcnt lgkmcnt(0)
  buffer_store_dwordx4 v[152:155], v218, s[8:11], s64 offen offset:2048 sc1
  v_add_u32 v219, 33024, v219
  s_add_u32 s66, s66, 64
  s_add_u32 s64, s64, 9216
  ds_read_b32 v0, v219 offset:7224
  ds_read_b32 v1, v219 offset:7228
  ds_read_b32 v2, v219 offset:7232
  ds_read_b32 v3, v219 offset:7236
  ds_read_b32 v4, v219 offset:7240
  ds_read_b32 v5, v219 offset:7244
  ds_read_b32 v6, v219 offset:7248
  ds_read_b32 v7, v219 offset:7252
  ds_read_b32 v8, v219 offset:7256
  ds_read_b32 v16, v219 offset:7368
  ds_read_b32 v17, v219 offset:7372
  ds_read_b32 v18, v219 offset:7376
  ds_read_b32 v19, v219 offset:7380
  ds_read_b32 v20, v219 offset:7384
  ds_read_b32 v21, v219 offset:7388
  ds_read_b32 v22, v219 offset:7392
  ds_read_b32 v23, v219 offset:7396
  ds_read_b32 v24, v219 offset:7400
  ds_read_b32 v25, v219 offset:6336
  ds_read_b32 v26, v219 offset:6340
  ds_read_b32 v27, v219 offset:6344
  ds_read_b32 v28, v219 offset:6348
  ds_read_b32 v29, v219 offset:6352
  ds_read_b32 v30, v219 offset:6356
  ds_read_b32 v31, v219 offset:6360
  ds_read_b32 v32, v219 offset:6364
  ds_read_b32 v33, v219 offset:6368
  ds_read_b32 v34, v219 offset:5304
  ds_read_b32 v35, v219 offset:5308
  ds_read_b32 v36, v219 offset:5312
  ds_read_b32 v37, v219 offset:5316
  ds_read_b32 v38, v219 offset:5320
  ds_read_b32 v39, v219 offset:5324
  ds_read_b32 v40, v219 offset:5328
  ds_read_b32 v41, v219 offset:5332
  ds_read_b32 v42, v219 offset:5336
  ds_read_b32 v43, v219 offset:4272
  ds_read_b32 v44, v219 offset:4276
  ds_read_b32 v45, v219 offset:4280
  ds_read_b32 v46, v219 offset:4284
  ds_read_b32 v47, v219 offset:4288
  ds_read_b32 v48, v219 offset:4292
  ds_read_b32 v49, v219 offset:4296
  ds_read_b32 v50, v219 offset:4300
  ds_read_b32 v51, v219 offset:4304
  ds_read_b32 v52, v219 offset:3240
  ds_read_b32 v53, v219 offset:3244
  ds_read_b32 v54, v219 offset:3248
  ds_read_b32 v55, v219 offset:3252
  ds_read_b32 v56, v219 offset:3256
  ds_read_b32 v57, v219 offset:3260
  ds_read_b32 v58, v219 offset:3264
  ds_read_b32 v59, v219 offset:3268
  ds_read_b32 v60, v219 offset:3272
  ds_read_b32 v61, v219 offset:2208
  ds_read_b32 v62, v219 offset:2212
  ds_read_b32 v63, v219 offset:2216
  ds_read_b32 v64, v219 offset:2220
  ds_read_b32 v65, v219 offset:2224
  ds_read_b32 v66, v219 offset:2228
  ds_read_b32 v67, v219 offset:2232
  ds_read_b32 v68, v219 offset:2236
  ds_read_b32 v69, v219 offset:2240
  ds_read_b32 v70, v219 offset:1176
  ds_read_b32 v71, v219 offset:1180
  ds_read_b32 v72, v219 offset:1184
  ds_read_b32 v73, v219 offset:1188
  ds_read_b32 v74, v219 offset:1192
  ds_read_b32 v75, v219 offset:1196
  ds_read_b32 v76, v219 offset:1200
  ds_read_b32 v77, v219 offset:1204
  ds_read_b32 v78, v219 offset:1208
  ds_read_b32 v79, v219 offset:144
  ds_read_b32 v80, v219 offset:148
  ds_read_b32 v81, v219 offset:152
  ds_read_b32 v82, v219 offset:156
  ds_read_b32 v83, v219 offset:160
  ds_read_b32 v84, v219 offset:164
  ds_read_b32 v85, v219 offset:168
  ds_read_b32 v86, v219 offset:172
  ds_read_b32 v87, v219 offset:176
  v_mov_b32 v100, 0
  v_mov_b32 v101, 0
  v_mov_b32 v102, 0
  v_mov_b32 v103, 0
  v_mov_b32 v104, 0
  v_mov_b32 v105, 0
  v_mov_b32 v106, 0
  v_mov_b32 v107, 0
  s_waitcnt lgkmcnt(15)
  v_dot2c_f32_bf16 v100, v0, v16
  v_dot2c_f32_bf16 v101, v0, v25
  v_dot2c_f32_bf16 v102, v0, v34
  v_dot2c_f32_bf16 v103, v0, v43
  v_dot2c_f32_bf16 v104, v0, v52
  v_dot2c_f32_bf16 v105, v0, v61
  v_dot2c_f32_bf16 v106, v0, v70
  s_waitcnt lgkmcnt(8)
  v_dot2c_f32_bf16 v107, v0, v79
  v_dot2c_f32_bf16 v100, v1, v17
  v_dot2c_f32_bf16 v101, v1, v26
  v_dot2c_f32_bf16 v102, v1, v35
  v_dot2c_f32_bf16 v103, v1, v44
  v_dot2c_f32_bf16 v104, v1, v53
  v_dot2c_f32_bf16 v105, v1, v62
  v_dot2c_f32_bf16 v106, v1, v71
  s_waitcnt lgkmcnt(7)
  v_dot2c_f32_bf16 v107, v1, v80
  v_dot2c_f32_bf16 v100, v2, v18
  v_dot2c_f32_bf16 v101, v2, v27
  v_dot2c_f32_bf16 v102, v2, v36
  v_dot2c_f32_bf16 v103, v2, v45
  v_dot2c_f32_bf16 v104, v2, v54
  v_dot2c_f32_bf16 v105, v2, v63
  v_dot2c_f32_bf16 v106, v2, v72
  s_waitcnt lgkmcnt(6)
  v_dot2c_f32_bf16 v107, v2, v81
  v_dot2c_f32_bf16 v100, v3, v19
  v_dot2c_f32_bf16 v101, v3, v28
  v_dot2c_f32_bf16 v102, v3, v37
  v_dot2c_f32_bf16 v103, v3, v46
  v_dot2c_f32_bf16 v104, v3, v55
  v_dot2c_f32_bf16 v105, v3, v64
  v_dot2c_f32_bf16 v106, v3, v73
  s_waitcnt lgkmcnt(5)
  v_dot2c_f32_bf16 v107, v3, v82
  v_dot2c_f32_bf16 v100, v4, v20
  v_dot2c_f32_bf16 v101, v4, v29
  v_dot2c_f32_bf16 v102, v4, v38
  v_dot2c_f32_bf16 v103, v4, v47
  v_dot2c_f32_bf16 v104, v4, v56
  v_dot2c_f32_bf16 v105, v4, v65
  v_dot2c_f32_bf16 v106, v4, v74
  s_waitcnt lgkmcnt(4)
  v_dot2c_f32_bf16 v107, v4, v83
  v_dot2c_f32_bf16 v100, v5, v21
  v_dot2c_f32_bf16 v101, v5, v30
  v_dot2c_f32_bf16 v102, v5, v39
  v_dot2c_f32_bf16 v103, v5, v48
  v_dot2c_f32_bf16 v104, v5, v57
  v_dot2c_f32_bf16 v105, v5, v66
  v_dot2c_f32_bf16 v106, v5, v75
  s_waitcnt lgkmcnt(3)
  v_dot2c_f32_bf16 v107, v5, v84
  v_dot2c_f32_bf16 v100, v6, v22
  v_dot2c_f32_bf16 v101, v6, v31
  v_dot2c_f32_bf16 v102, v6, v40
  v_dot2c_f32_bf16 v103, v6, v49
  v_dot2c_f32_bf16 v104, v6, v58
  v_dot2c_f32_bf16 v105, v6, v67
  v_dot2c_f32_bf16 v106, v6, v76
  s_waitcnt lgkmcnt(2)
  v_dot2c_f32_bf16 v107, v6, v85
  v_dot2c_f32_bf16 v100, v7, v23
  v_dot2c_f32_bf16 v101, v7, v32
  v_dot2c_f32_bf16 v102, v7, v41
  v_dot2c_f32_bf16 v103, v7, v50
  v_dot2c_f32_bf16 v104, v7, v59
  v_dot2c_f32_bf16 v105, v7, v68
  v_dot2c_f32_bf16 v106, v7, v77
  s_waitcnt lgkmcnt(1)
  v_dot2c_f32_bf16 v107, v7, v86
  v_dot2c_f32_bf16 v100, v8, v24
  v_dot2c_f32_bf16 v101, v8, v33
  v_dot2c_f32_bf16 v102, v8, v42
  v_dot2c_f32_bf16 v103, v8, v51
  v_dot2c_f32_bf16 v104, v8, v60
  v_dot2c_f32_bf16 v105, v8, v69
  v_dot2c_f32_bf16 v106, v8, v78
  s_waitcnt lgkmcnt(0)
  v_dot2c_f32_bf16 v107, v8, v87
  ds_read_b32 v16, v219 offset:7512
  ds_read_b32 v17, v219 offset:7516
  ds_read_b32 v18, v219 offset:7520
  ds_read_b32 v19, v219 offset:7524
  ds_read_b32 v20, v219 offset:7528
  ds_read_b32 v21, v219 offset:7532
  ds_read_b32 v22, v219 offset:7536
  ds_read_b32 v23, v219 offset:7540
  ds_read_b32 v24, v219 offset:7544
  ds_read_b32 v25, v219 offset:6480
  ds_read_b32 v26, v219 offset:6484
  ds_read_b32 v27, v219 offset:6488
  ds_read_b32 v28, v219 offset:6492
  ds_read_b32 v29, v219 offset:6496
  ds_read_b32 v30, v219 offset:6500
  ds_read_b32 v31, v219 offset:6504
  ds_read_b32 v32, v219 offset:6508
  ds_read_b32 v33, v219 offset:6512
  ds_read_b32 v34, v219 offset:5448
  ds_read_b32 v35, v219 offset:5452
  ds_read_b32 v36, v219 offset:5456
  ds_read_b32 v37, v219 offset:5460
  ds_read_b32 v38, v219 offset:5464
  ds_read_b32 v39, v219 offset:5468
  ds_read_b32 v40, v219 offset:5472
  ds_read_b32 v41, v219 offset:5476
  ds_read_b32 v42, v219 offset:5480
  ds_read_b32 v43, v219 offset:4416
  ds_read_b32 v44, v219 offset:4420
  ds_read_b32 v45, v219 offset:4424
  ds_read_b32 v46, v219 offset:4428
  ds_read_b32 v47, v219 offset:4432
  ds_read_b32 v48, v219 offset:4436
  ds_read_b32 v49, v219 offset:4440
  ds_read_b32 v50, v219 offset:4444
  ds_read_b32 v51, v219 offset:4448
  ds_read_b32 v52, v219 offset:3384
  ds_read_b32 v53, v219 offset:3388
  ds_read_b32 v54, v219 offset:3392
  ds_read_b32 v55, v219 offset:3396
  ds_read_b32 v56, v219 offset:3400
  ds_read_b32 v57, v219 offset:3404
  ds_read_b32 v58, v219 offset:3408
  ds_read_b32 v59, v219 offset:3412
  ds_read_b32 v60, v219 offset:3416
  ds_read_b32 v61, v219 offset:2352
  ds_read_b32 v62, v219 offset:2356
  ds_read_b32 v63, v219 offset:2360
  ds_read_b32 v64, v219 offset:2364
  ds_read_b32 v65, v219 offset:2368
  ds_read_b32 v66, v219 offset:2372
  ds_read_b32 v67, v219 offset:2376
  ds_read_b32 v68, v219 offset:2380
  ds_read_b32 v69, v219 offset:2384
  ds_read_b32 v70, v219 offset:1320
  ds_read_b32 v71, v219 offset:1324
  ds_read_b32 v72, v219 offset:1328
  ds_read_b32 v73, v219 offset:1332
  ds_read_b32 v74, v219 offset:1336
  ds_read_b32 v75, v219 offset:1340
  ds_read_b32 v76, v219 offset:1344
  ds_read_b32 v77, v219 offset:1348
  ds_read_b32 v78, v219 offset:1352
  ds_read_b32 v79, v219 offset:288
  ds_read_b32 v80, v219 offset:292
  ds_read_b32 v81, v219 offset:296
  ds_read_b32 v82, v219 offset:300
  ds_read_b32 v83, v219 offset:304
  ds_read_b32 v84, v219 offset:308
  ds_read_b32 v85, v219 offset:312
  ds_read_b32 v86, v219 offset:316
  ds_read_b32 v87, v219 offset:320
  v_add_u32 v211, s66, v200
  v_mov_b32 v212, 0xf149f2ca
  v_mul_f32 v100, s57, v100
  v_mul_f32 v101, s57, v101
  v_mul_f32 v102, s57, v102
  v_mul_f32 v103, s57, v103
  v_mul_f32 v104, s57, v104
  v_mul_f32 v105, s57, v105
  v_mul_f32 v106, s57, v106
  v_mul_f32 v107, s57, v107
  v_cmp_gt_u32 vcc, 2, v211
  s_nop 1
  v_cndmask_b32 v101, v101, v212, vcc
  v_cmp_gt_u32 vcc, 4, v211
  s_nop 1
  v_cndmask_b32 v102, v102, v212, vcc
  v_cmp_gt_u32 vcc, 6, v211
  s_nop 1
  v_cndmask_b32 v103, v103, v212, vcc
  v_cmp_gt_u32 vcc, 8, v211
  s_nop 1
  v_cndmask_b32 v104, v104, v212, vcc
  v_cmp_gt_u32 vcc, 10, v211
  s_nop 1
  v_cndmask_b32 v105, v105, v212, vcc
  v_cmp_gt_u32 vcc, 12, v211
  s_nop 1
  v_cndmask_b32 v106, v106, v212, vcc
  v_cmp_gt_u32 vcc, 14, v211
  s_nop 1
  v_cndmask_b32 v107, v107, v212, vcc
  v_max3_f32 v213, v100, v101, v102
  v_max3_f32 v213, v213, v103, v104
  v_max3_f32 v213, v213, v105, v106
  v_max_f32 v213, v213, v107
  v_sub_f32 v100, v100, v213
  v_sub_f32 v101, v101, v213
  v_sub_f32 v102, v102, v213
  v_sub_f32 v103, v103, v213
  v_sub_f32 v104, v104, v213
  v_sub_f32 v105, v105, v213
  v_sub_f32 v106, v106, v213
  v_sub_f32 v107, v107, v213
  v_exp_f32 v100, v100
  v_exp_f32 v101, v101
  v_exp_f32 v102, v102
  v_exp_f32 v103, v103
  v_exp_f32 v104, v104
  v_exp_f32 v105, v105
  v_exp_f32 v106, v106
  v_exp_f32 v107, v107
  v_add_f32 v213, v100, v101
  v_add_f32 v213, v213, v102
  v_add_f32 v213, v213, v103
  v_add_f32 v213, v213, v104
  v_add_f32 v213, v213, v105
  v_add_f32 v213, v213, v106
  v_add_f32 v213, v213, v107
  v_rcp_f32 v213, v213
  v_mov_b32 v214, 0
  v_mul_f32 v100, v213, v100
  v_mul_f32 v101, v213, v101
  v_mul_f32 v102, v213, v102
  v_mul_f32 v103, v213, v103
  v_mul_f32 v104, v213, v104
  v_mul_f32 v105, v213, v105
  v_mul_f32 v106, v213, v106
  v_mul_f32 v107, v213, v107
  v_mov_b32 v112, 0
  v_mov_b32 v113, 0
  v_mov_b32 v114, 0
  v_mov_b32 v115, 0
  v_mov_b32 v116, 0
  v_mov_b32 v117, 0
  v_mov_b32 v118, 0
  v_mov_b32 v119, 0
  v_mov_b32 v120, 0
  v_mov_b32 v121, 0
  v_mov_b32 v122, 0
  v_mov_b32 v123, 0
  v_mov_b32 v124, 0
  v_mov_b32 v125, 0
  v_mov_b32 v126, 0
  v_mov_b32 v127, 0
  v_mov_b32 v128, 0
  v_mov_b32 v129, 0
  v_cvt_pk_bf16_f32 v0, v100, v214
  v_cvt_pk_bf16_f32 v1, v214, v100
  s_waitcnt lgkmcnt(15)
  v_dot2c_f32_bf16 v112, v16, v0
  v_dot2c_f32_bf16 v113, v16, v1
  v_dot2c_f32_bf16 v114, v17, v0
  v_dot2c_f32_bf16 v115, v17, v1
  v_dot2c_f32_bf16 v116, v18, v0
  v_dot2c_f32_bf16 v117, v18, v1
  v_dot2c_f32_bf16 v118, v19, v0
  v_dot2c_f32_bf16 v119, v19, v1
  v_dot2c_f32_bf16 v120, v20, v0
  v_dot2c_f32_bf16 v121, v20, v1
  v_dot2c_f32_bf16 v122, v21, v0
  v_dot2c_f32_bf16 v123, v21, v1
  v_dot2c_f32_bf16 v124, v22, v0
  v_dot2c_f32_bf16 v125, v22, v1
  v_dot2c_f32_bf16 v126, v23, v0
  v_dot2c_f32_bf16 v127, v23, v1
  v_dot2c_f32_bf16 v128, v24, v0
  v_dot2c_f32_bf16 v129, v24, v1
  v_cvt_pk_bf16_f32 v2, v101, v214
  v_cvt_pk_bf16_f32 v3, v214, v101
  v_dot2c_f32_bf16 v112, v25, v2
  v_dot2c_f32_bf16 v113, v25, v3
  v_dot2c_f32_bf16 v114, v26, v2
  v_dot2c_f32_bf16 v115, v26, v3
  v_dot2c_f32_bf16 v116, v27, v2
  v_dot2c_f32_bf16 v117, v27, v3
  v_dot2c_f32_bf16 v118, v28, v2
  v_dot2c_f32_bf16 v119, v28, v3
  v_dot2c_f32_bf16 v120, v29, v2
  v_dot2c_f32_bf16 v121, v29, v3
  v_dot2c_f32_bf16 v122, v30, v2
  v_dot2c_f32_bf16 v123, v30, v3
  v_dot2c_f32_bf16 v124, v31, v2
  v_dot2c_f32_bf16 v125, v31, v3
  v_dot2c_f32_bf16 v126, v32, v2
  v_dot2c_f32_bf16 v127, v32, v3
  v_dot2c_f32_bf16 v128, v33, v2
  v_dot2c_f32_bf16 v129, v33, v3
  v_cvt_pk_bf16_f32 v0, v102, v214
  v_cvt_pk_bf16_f32 v1, v214, v102
  v_dot2c_f32_bf16 v112, v34, v0
  v_dot2c_f32_bf16 v113, v34, v1
  v_dot2c_f32_bf16 v114, v35, v0
  v_dot2c_f32_bf16 v115, v35, v1
  v_dot2c_f32_bf16 v116, v36, v0
  v_dot2c_f32_bf16 v117, v36, v1
  v_dot2c_f32_bf16 v118, v37, v0
  v_dot2c_f32_bf16 v119, v37, v1
  v_dot2c_f32_bf16 v120, v38, v0
  v_dot2c_f32_bf16 v121, v38, v1
  v_dot2c_f32_bf16 v122, v39, v0
  v_dot2c_f32_bf16 v123, v39, v1
  v_dot2c_f32_bf16 v124, v40, v0
  v_dot2c_f32_bf16 v125, v40, v1
  v_dot2c_f32_bf16 v126, v41, v0
  v_dot2c_f32_bf16 v127, v41, v1
  v_dot2c_f32_bf16 v128, v42, v0
  v_dot2c_f32_bf16 v129, v42, v1
  v_cvt_pk_bf16_f32 v2, v103, v214
  v_cvt_pk_bf16_f32 v3, v214, v103
  v_dot2c_f32_bf16 v112, v43, v2
  v_dot2c_f32_bf16 v113, v43, v3
  v_dot2c_f32_bf16 v114, v44, v2
  v_dot2c_f32_bf16 v115, v44, v3
  v_dot2c_f32_bf16 v116, v45, v2
  v_dot2c_f32_bf16 v117, v45, v3
  v_dot2c_f32_bf16 v118, v46, v2
  v_dot2c_f32_bf16 v119, v46, v3
  v_dot2c_f32_bf16 v120, v47, v2
  v_dot2c_f32_bf16 v121, v47, v3
  v_dot2c_f32_bf16 v122, v48, v2
  v_dot2c_f32_bf16 v123, v48, v3
  v_dot2c_f32_bf16 v124, v49, v2
  v_dot2c_f32_bf16 v125, v49, v3
  v_dot2c_f32_bf16 v126, v50, v2
  v_dot2c_f32_bf16 v127, v50, v3
  v_dot2c_f32_bf16 v128, v51, v2
  v_dot2c_f32_bf16 v129, v51, v3
  v_cvt_pk_bf16_f32 v0, v104, v214
  v_cvt_pk_bf16_f32 v1, v214, v104
  v_dot2c_f32_bf16 v112, v52, v0
  v_dot2c_f32_bf16 v113, v52, v1
  v_dot2c_f32_bf16 v114, v53, v0
  v_dot2c_f32_bf16 v115, v53, v1
  v_dot2c_f32_bf16 v116, v54, v0
  v_dot2c_f32_bf16 v117, v54, v1
  v_dot2c_f32_bf16 v118, v55, v0
  v_dot2c_f32_bf16 v119, v55, v1
  v_dot2c_f32_bf16 v120, v56, v0
  v_dot2c_f32_bf16 v121, v56, v1
  v_dot2c_f32_bf16 v122, v57, v0
  v_dot2c_f32_bf16 v123, v57, v1
  v_dot2c_f32_bf16 v124, v58, v0
  v_dot2c_f32_bf16 v125, v58, v1
  v_dot2c_f32_bf16 v126, v59, v0
  v_dot2c_f32_bf16 v127, v59, v1
  v_dot2c_f32_bf16 v128, v60, v0
  v_dot2c_f32_bf16 v129, v60, v1
  v_cvt_pk_bf16_f32 v2, v105, v214
  v_cvt_pk_bf16_f32 v3, v214, v105
  v_dot2c_f32_bf16 v112, v61, v2
  v_dot2c_f32_bf16 v113, v61, v3
  v_dot2c_f32_bf16 v114, v62, v2
  v_dot2c_f32_bf16 v115, v62, v3
  v_dot2c_f32_bf16 v116, v63, v2
  v_dot2c_f32_bf16 v117, v63, v3
  v_dot2c_f32_bf16 v118, v64, v2
  v_dot2c_f32_bf16 v119, v64, v3
  v_dot2c_f32_bf16 v120, v65, v2
  v_dot2c_f32_bf16 v121, v65, v3
  v_dot2c_f32_bf16 v122, v66, v2
  v_dot2c_f32_bf16 v123, v66, v3
  v_dot2c_f32_bf16 v124, v67, v2
  v_dot2c_f32_bf16 v125, v67, v3
  v_dot2c_f32_bf16 v126, v68, v2
  v_dot2c_f32_bf16 v127, v68, v3
  v_dot2c_f32_bf16 v128, v69, v2
  v_dot2c_f32_bf16 v129, v69, v3
  v_cvt_pk_bf16_f32 v0, v106, v214
  v_cvt_pk_bf16_f32 v1, v214, v106
  v_dot2c_f32_bf16 v112, v70, v0
  v_dot2c_f32_bf16 v113, v70, v1
  v_dot2c_f32_bf16 v114, v71, v0
  v_dot2c_f32_bf16 v115, v71, v1
  v_dot2c_f32_bf16 v116, v72, v0
  v_dot2c_f32_bf16 v117, v72, v1
  s_waitcnt lgkmcnt(14)
  v_dot2c_f32_bf16 v118, v73, v0
  v_dot2c_f32_bf16 v119, v73, v1
  s_waitcnt lgkmcnt(13)
  v_dot2c_f32_bf16 v120, v74, v0
  v_dot2c_f32_bf16 v121, v74, v1
  s_waitcnt lgkmcnt(12)
  v_dot2c_f32_bf16 v122, v75, v0
  v_dot2c_f32_bf16 v123, v75, v1
  s_waitcnt lgkmcnt(11)
  v_dot2c_f32_bf16 v124, v76, v0
  v_dot2c_f32_bf16 v125, v76, v1
  s_waitcnt lgkmcnt(10)
  v_dot2c_f32_bf16 v126, v77, v0
  v_dot2c_f32_bf16 v127, v77, v1
  s_waitcnt lgkmcnt(9)
  v_dot2c_f32_bf16 v128, v78, v0
  v_dot2c_f32_bf16 v129, v78, v1
  v_cvt_pk_bf16_f32 v2, v107, v214
  v_cvt_pk_bf16_f32 v3, v214, v107
  s_waitcnt lgkmcnt(8)
  v_dot2c_f32_bf16 v112, v79, v2
  v_dot2c_f32_bf16 v113, v79, v3
  s_waitcnt lgkmcnt(7)
  v_dot2c_f32_bf16 v114, v80, v2
  v_dot2c_f32_bf16 v115, v80, v3
  s_waitcnt lgkmcnt(6)
  v_dot2c_f32_bf16 v116, v81, v2
  v_dot2c_f32_bf16 v117, v81, v3
  s_waitcnt lgkmcnt(5)
  v_dot2c_f32_bf16 v118, v82, v2
  v_dot2c_f32_bf16 v119, v82, v3
  s_waitcnt lgkmcnt(4)
  v_dot2c_f32_bf16 v120, v83, v2
  v_dot2c_f32_bf16 v121, v83, v3
  s_waitcnt lgkmcnt(3)
  v_dot2c_f32_bf16 v122, v84, v2
  v_dot2c_f32_bf16 v123, v84, v3
  s_waitcnt lgkmcnt(2)
  v_dot2c_f32_bf16 v124, v85, v2
  v_dot2c_f32_bf16 v125, v85, v3
  s_waitcnt lgkmcnt(1)
  v_dot2c_f32_bf16 v126, v86, v2
  v_dot2c_f32_bf16 v127, v86, v3
  s_waitcnt lgkmcnt(0)
  v_dot2c_f32_bf16 v128, v87, v2
  v_dot2c_f32_bf16 v129, v87, v3
  v_cvt_pk_bf16_f32 v132, v112, v113
  v_cvt_pk_bf16_f32 v133, v114, v115
  v_cvt_pk_bf16_f32 v134, v116, v117
  v_cvt_pk_bf16_f32 v135, v118, v119
  v_cvt_pk_bf16_f32 v136, v120, v121
  v_cvt_pk_bf16_f32 v137, v122, v123
  v_cvt_pk_bf16_f32 v138, v124, v125
  v_cvt_pk_bf16_f32 v139, v126, v127
  v_cvt_pk_bf16_f32 v140, v128, v129
  ds_write_b32 v220, v132 offset:16384
  ds_write_b32 v220, v133 offset:16388
  ds_write_b32 v220, v134 offset:16392
  ds_write_b32 v220, v135 offset:16396
  ds_write_b32 v220, v136 offset:16400
  ds_write_b32 v220, v137 offset:16404
  ds_write_b32 v220, v138 offset:16408
  ds_write_b32 v220, v139 offset:16412
  ds_write_b32 v220, v140 offset:16416
  s_waitcnt lgkmcnt(0)
  s_barrier
  ds_read_b128 v[144:147], v218 offset:16384
  ds_read_b128 v[148:151], v218 offset:17408
  ds_read_b128 v[152:155], v218 offset:18432
  s_waitcnt lgkmcnt(2)
  buffer_store_dwordx4 v[144:147], v218, s[8:11], s64 offen offset:0 sc1
  s_waitcnt lgkmcnt(1)
  buffer_store_dwordx4 v[148:151], v218, s[8:11], s64 offen offset:1024 sc1
  s_waitcnt lgkmcnt(0)
  buffer_store_dwordx4 v[152:155], v218, s[8:11], s64 offen offset:2048 sc1
  s_mov_b32 s56, 36
  s_waitcnt vmcnt(0)
  s_barrier
  s_cmp_eq_u32 s52, 0
  s_cbranch_scc0 A_sig
  v_mov_b32 v211, 1
  v_mov_b32 v212, 0
  s_mov_b64 exec, 1
  buffer_atomic_add v211, v212, s[12:15], s56 offen
  s_mov_b64 exec, -1
A_sig:
  s_and_b32 s54, s53, 31
  s_cmp_lt_u32 s54, 27
  s_cbranch_scc0 L_exit
  s_and_b32 s54, s53, 31
  s_mul_i32 s68, s54, 57
  s_lshr_b32 s68, s68, 9
  s_mul_i32 s56, s68, 9
  s_sub_u32 s70, s54, s56
  s_bfe_u32 s55, s53, 0x10005
  s_mul_i32 s55, s55, 9
  s_add_u32 s70, s70, s55
  s_bfe_u32 s69, s53, 0x10006
  v_lshrrev_b32 v211, 2, v200
  v_mul_u32_u24 v211, 1152, v211
  v_and_b32 v212, 3, v200
  v_lshl_add_u32 v207, v212, 4, v211
  s_lshl_b32 s54, s70, 6
  s_mul_i32 s55, s52, 1179648
  s_add_u32 s62, s54, s55
  s_mul_i32 s55, s52, 184320
  s_add_u32 s63, s54, s55
  s_mul_i32 s61, s52, 40960
  v_bfe_u32 v211, v200, 2, 2
  v_lshlrev_b32 v212, 4, v212
  v_add_u32 v212, s61, v212
  v_lshl_add_u32 v212, v211, 6, v212
  v_lshrrev_b32 v213, 4, v200
  v_lshl_add_u32 v210, v213, 9, v212
  v_lshrrev_b32 v214, 5, v200
  v_lshl_add_u32 v209, v214, 10, v212
  v_and_b32 v214, 1, v213
  v_lshl_add_u32 v209, v214, 8, v209
  s_add_u32 m0, s61, 0
  s_add_u32 s54, s62, 0
  buffer_load_dwordx4 v207, s[28:31], s54 offen lds
  s_add_u32 m0, s61, 1024
  s_add_u32 s54, s62, 18432
  buffer_load_dwordx4 v207, s[28:31], s54 offen lds
  s_add_u32 m0, s61, 2048
  s_add_u32 s54, s62, 36864
  buffer_load_dwordx4 v207, s[28:31], s54 offen lds
  s_add_u32 m0, s61, 3072
  s_add_u32 s54, s62, 55296
  buffer_load_dwordx4 v207, s[28:31], s54 offen lds
  s_add_u32 m0, s61, 4096
  s_add_u32 s54, s62, 73728
  buffer_load_dwordx4 v207, s[28:31], s54 offen lds
  s_add_u32 m0, s61, 5120
  s_add_u32 s54, s62, 92160
  buffer_load_dwordx4 v207, s[28:31], s54 offen lds
  s_add_u32 m0, s61, 6144
  s_add_u32 s54, s62, 110592
  buffer_load_dwordx4 v207, s[28:31], s54 offen lds
  s_add_u32 m0, s61, 7168
  s_add_u32 s54, s62, 129024
  buffer_load_dwordx4 v207, s[28:31], s54 offen lds
  s_add_u32 m0, s61, 8192
  s_add_u32 s54, s62, 147456
  buffer_load_dwordx4 v207, s[28:31], s54 offen lds
  s_add_u32 m0, s61, 9216
  s_add_u32 s54, s62, 165888
  buffer_load_dwordx4 v207, s[28:31], s54 offen lds
  s_add_u32 m0, s61, 10240
  s_add_u32 s54, s62, 184320
  buffer_load_dwordx4 v207, s[28:31], s54 offen lds
  s_add_u32 m0, s61, 11264
  s_add_u32 s54, s62, 202752
  buffer_load_dwordx4 v207, s[28:31], s54 offen lds
  s_add_u32 m0, s61, 12288
  s_add_u32 s54, s62, 221184
  buffer_load_dwordx4 v207, s[28:31], s54 offen lds
  s_add_u32 m0, s61, 13312
  s_add_u32 s54, s62, 239616
  buffer_load_dwordx4 v207, s[28:31], s54 offen lds
  s_add_u32 m0, s61, 14336
  s_add_u32 s54, s62, 258048
  buffer_load_dwordx4 v207, s[28:31], s54 offen lds
  s_add_u32 m0, s61, 15360
  s_add_u32 s54, s62, 276480
  buffer_load_dwordx4 v207, s[28:31], s54 offen lds
  s_add_u32 m0, s61, 16384
  s_add_u32 s54, s62, 294912
  buffer_load_dwordx4 v207, s[28:31], s54 offen lds
  s_add_u32 m0, s61, 17408
  s_add_u32 s54, s62, 313344
  buffer_load_dwordx4 v207, s[28:31], s54 offen lds
  s_add_u32 m0, s61, 18432
  s_add_u32 s54, s62, 331776
  buffer_load_dwordx4 v207, s[28:31], s54 offen lds
  s_add_u32 m0, s61, 19456
  s_add_u32 s54, s62, 350208
  buffer_load_dwordx4 v207, s[28:31], s54 offen lds
  s_add_u32 m0, s61, 20480
  s_add_u32 s54, s62, 368640
  buffer_load_dwordx4 v207, s[28:31], s54 offen lds
  s_add_u32 m0, s61, 21504
  s_add_u32 s54, s62, 387072
  buffer_load_dwordx4 v207, s[28:31], s54 offen lds
  s_add_u32 m0, s61, 22528
  s_add_u32 s54, s62, 405504
  buffer_load_dwordx4 v207, s[28:31], s54 offen lds
  s_add_u32 m0, s61, 23552
  s_add_u32 s54, s62, 423936
  buffer_load_dwordx4 v207, s[28:31], s54 offen lds
  s_add_u32 m0, s61, 24576
  s_add_u32 s54, s62, 442368
  buffer_load_dwordx4 v207, s[28:31], s54 offen lds
  s_add_u32 m0, s61, 25600
  s_add_u32 s54, s62, 460800
  buffer_load_dwordx4 v207, s[28:31], s54 offen lds
  s_add_u32 m0, s61, 26624
  s_add_u32 s54, s62, 479232
  buffer_load_dwordx4 v207, s[28:31], s54 offen lds
  s_add_u32 m0, s61, 27648
  s_add_u32 s54, s62, 497664
  buffer_load_dwordx4 v207, s[28:31], s54 offen lds
  s_add_u32 m0, s61, 28672
  s_add_u32 s54, s62, 516096
  buffer_load_dwordx4 v207, s[28:31], s54 offen lds
  s_add_u32 m0, s61, 29696
  s_add_u32 s54, s62, 534528
  buffer_load_dwordx4 v207, s[28:31], s54 offen lds
  s_add_u32 m0, s61, 30720
  s_add_u32 s54, s62, 552960
  buffer_load_dwordx4 v207, s[28:31], s54 offen lds
  s_add_u32 m0, s61, 31744
  s_add_u32 s54, s62, 571392
  buffer_load_dwordx4 v207, s[28:31], s54 offen lds
  s_add_u32 m0, s61, 32768
  s_add_u32 s54, s62, 589824
  buffer_load_dwordx4 v207, s[28:31], s54 offen lds
  s_add_u32 m0, s61, 33792
  s_add_u32 s54, s62, 608256
  buffer_load_dwordx4 v207, s[28:31], s54 offen lds
  s_add_u32 m0, s61, 34816
  s_add_u32 s54, s62, 626688
  buffer_load_dwordx4 v207, s[28:31], s54 offen lds
  s_add_u32 m0, s61, 35840
  s_add_u32 s54, s62, 645120
  buffer_load_dwordx4 v207, s[28:31], s54 offen lds
  s_add_u32 m0, s61, 36864
  s_add_u32 s54, s62, 663552
  buffer_load_dwordx4 v207, s[28:31], s54 offen lds
  s_add_u32 m0, s61, 37888
  s_add_u32 s54, s62, 681984
  buffer_load_dwordx4 v207, s[28:31], s54 offen lds
  s_waitcnt vmcnt(36) lgkmcnt(0)
  s_add_u32 m0, s61, 38912
  s_add_u32 s54, s62, 700416
  buffer_load_dwordx4 v207, s[28:31], s54 offen lds
  s_add_u32 m0, s61, 39936
  s_add_u32 s54, s62, 718848
  buffer_load_dwordx4 v207, s[28:31], s54 offen lds
  ds_read_b64_tr_b16 a[0:1], v209 offset:0
  ds_read_b64_tr_b16 a[2:3], v209 offset:512
  ds_read_b64_tr_b16 a[4:5], v209 offset:8
  ds_read_b64_tr_b16 a[6:7], v209 offset:520
  s_waitcnt vmcnt(36) lgkmcnt(0)
  s_add_u32 m0, s61, 0
  s_add_u32 s54, s62, 737280
  buffer_load_dwordx4 v207, s[28:31], s54 offen lds
  s_add_u32 m0, s61, 1024
  s_add_u32 s54, s62, 755712
  buffer_load_dwordx4 v207, s[28:31], s54 offen lds
  ds_read_b64_tr_b16 a[8:9], v209 offset:2048
  ds_read_b64_tr_b16 a[10:11], v209 offset:2560
  ds_read_b64_tr_b16 a[12:13], v209 offset:2056
  ds_read_b64_tr_b16 a[14:15], v209 offset:2568
  s_waitcnt vmcnt(36) lgkmcnt(0)
  s_add_u32 m0, s61, 2048
  s_add_u32 s54, s62, 774144
  buffer_load_dwordx4 v207, s[28:31], s54 offen lds
  s_add_u32 m0, s61, 3072
  s_add_u32 s54, s62, 792576
  buffer_load_dwordx4 v207, s[28:31], s54 offen lds
  ds_read_b64_tr_b16 a[16:17], v209 offset:4096
  ds_read_b64_tr_b16 a[18:19], v209 offset:4608
  ds_read_b64_tr_b16 a[20:21], v209 offset:4104
  ds_read_b64_tr_b16 a[22:23], v209 offset:4616
  s_waitcnt vmcnt(36) lgkmcnt(0)
  s_add_u32 m0, s61, 4096
  s_add_u32 s54, s62, 811008
  buffer_load_dwordx4 v207, s[28:31], s54 offen lds
  s_add_u32 m0, s61, 5120
  s_add_u32 s54, s62, 829440
  buffer_load_dwordx4 v207, s[28:31], s54 offen lds
  ds_read_b64_tr_b16 a[24:25], v209 offset:6144
  ds_read_b64_tr_b16 a[26:27], v209 offset:6656
  ds_read_b64_tr_b16 a[28:29], v209 offset:6152
  ds_read_b64_tr_b16 a[30:31], v209 offset:6664
  s_waitcnt vmcnt(36) lgkmcnt(0)
  s_add_u32 m0, s61, 6144
  s_add_u32 s54, s62, 847872
  buffer_load_dwordx4 v207, s[28:31], s54 offen lds
  s_add_u32 m0, s61, 7168
  s_add_u32 s54, s62, 866304
  buffer_load_dwordx4 v207, s[28:31], s54 offen lds
  ds_read_b64_tr_b16 a[32:33], v209 offset:8192
  ds_read_b64_tr_b16 a[34:35], v209 offset:8704
  ds_read_b64_tr_b16 a[36:37], v209 offset:8200
  ds_read_b64_tr_b16 a[38:39], v209 offset:8712
  s_waitcnt vmcnt(36) lgkmcnt(0)
  s_add_u32 m0, s61, 8192
  s_add_u32 s54, s62, 884736
  buffer_load_dwordx4 v207, s[28:31], s54 offen lds
  s_add_u32 m0, s61, 9216
  s_add_u32 s54, s62, 903168
  buffer_load_dwordx4 v207, s[28:31], s54 offen lds
  ds_read_b64_tr_b16 a[40:41], v209 offset:10240
  ds_read_b64_tr_b16 a[42:43], v209 offset:10752
  ds_read_b64_tr_b16 a[44:45], v209 offset:10248
  ds_read_b64_tr_b16 a[46:47], v209 offset:10760
  s_waitcnt vmcnt(36) lgkmcnt(0)
  s_add_u32 m0, s61, 10240
  s_add_u32 s54, s62, 921600
  buffer_load_dwordx4 v207, s[28:31], s54 offen lds
  s_add_u32 m0, s61, 11264
  s_add_u32 s54, s62, 940032
  buffer_load_dwordx4 v207, s[28:31], s54 offen lds
  ds_read_b64_tr_b16 a[48:49], v209 offset:12288
  ds_read_b64_tr_b16 a[50:51], v209 offset:12800
  ds_read_b64_tr_b16 a[52:53], v209 offset:12296
  ds_read_b64_tr_b16 a[54:55], v209 offset:12808
  s_waitcnt vmcnt(36) lgkmcnt(0)
  s_add_u32 m0, s61, 12288
  s_add_u32 s54, s62, 958464
  buffer_load_dwordx4 v207, s[28:31], s54 offen lds
  s_add_u32 m0, s61, 13312
  s_add_u32 s54, s62, 976896
  buffer_load_dwordx4 v207, s[28:31], s54 offen lds
  ds_read_b64_tr_b16 a[56:57], v209 offset:14336
  ds_read_b64_tr_b16 a[58:59], v209 offset:14848
  ds_read_b64_tr_b16 a[60:61], v209 offset:14344
  ds_read_b64_tr_b16 a[62:63], v209 offset:14856
  s_waitcnt vmcnt(36) lgkmcnt(0)
  s_add_u32 m0, s61, 14336
  s_add_u32 s54, s62, 995328
  buffer_load_dwordx4 v207, s[28:31], s54 offen lds
  s_add_u32 m0, s61, 15360
  s_add_u32 s54, s62, 1013760
  buffer_load_dwordx4 v207, s[28:31], s54 offen lds
  ds_read_b64_tr_b16 a[64:65], v209 offset:16384
  ds_read_b64_tr_b16 a[66:67], v209 offset:16896
  ds_read_b64_tr_b16 a[68:69], v209 offset:16392
  ds_read_b64_tr_b16 a[70:71], v209 offset:16904
  s_waitcnt vmcnt(36) lgkmcnt(0)
  s_add_u32 m0, s61, 16384
  s_add_u32 s54, s62, 1032192
  buffer_load_dwordx4 v207, s[28:31], s54 offen lds
  s_add_u32 m0, s61, 17408
  s_add_u32 s54, s62, 1050624
  buffer_load_dwordx4 v207, s[28:31], s54 offen lds
  ds_read_b64_tr_b16 a[72:73], v209 offset:18432
  ds_read_b64_tr_b16 a[74:75], v209 offset:18944
  ds_read_b64_tr_b16 a[76:77], v209 offset:18440
  ds_read_b64_tr_b16 a[78:79], v209 offset:18952
  s_waitcnt vmcnt(36) lgkmcnt(0)
  s_add_u32 m0, s61, 18432
  s_add_u32 s54, s62, 1069056
  buffer_load_dwordx4 v207, s[28:31], s54 offen lds
  s_add_u32 m0, s61, 19456
  s_add_u32 s54, s62, 1087488
  buffer_load_dwordx4 v207, s[28:31], s54 offen lds
  ds_read_b64_tr_b16 a[80:81], v209 offset:20480
  ds_read_b64_tr_b16 a[82:83], v209 offset:20992
  ds_read_b64_tr_b16 a[84:85], v209 offset:20488
  ds_read_b64_tr_b16 a[86:87], v209 offset:21000
  s_waitcnt vmcnt(36) lgkmcnt(0)
  s_add_u32 m0, s61, 20480
  s_add_u32 s54, s62, 1105920
  buffer_load_dwordx4 v207, s[28:31], s54 offen lds
  s_add_u32 m0, s61, 21504
  s_add_u32 s54, s62, 1124352
  buffer_load_dwordx4 v207, s[28:31], s54 offen lds
  ds_read_b64_tr_b16 a[88:89], v209 offset:22528
  ds_read_b64_tr_b16 a[90:91], v209 offset:23040
  ds_read_b64_tr_b16 a[92:93], v209 offset:22536
  ds_read_b64_tr_b16 a[94:95], v209 offset:23048
  s_waitcnt vmcnt(36) lgkmcnt(0)
  s_add_u32 m0, s61, 22528
  s_add_u32 s54, s62, 1142784
  buffer_load_dwordx4 v207, s[28:31], s54 offen lds
  s_add_u32 m0, s61, 23552
  s_add_u32 s54, s62, 1161216
  buffer_load_dwordx4 v207, s[28:31], s54 offen lds
  ds_read_b64_tr_b16 a[96:97], v209 offset:24576
  ds_read_b64_tr_b16 a[98:99], v209 offset:25088
  ds_read_b64_tr_b16 a[100:101], v209 offset:24584
  ds_read_b64_tr_b16 a[102:103], v209 offset:25096
  s_waitcnt vmcnt(36) lgkmcnt(0)
  s_add_u32 m0, s61, 24576
  s_add_u32 s54, s63, 0
  buffer_load_dwordx4 v207, s[40:43], s54 offen lds
  s_add_u32 m0, s61, 25600
  s_add_u32 s54, s63, 18432
  buffer_load_dwordx4 v207, s[40:43], s54 offen lds
  ds_read_b64_tr_b16 a[104:105], v209 offset:26624
  ds_read_b64_tr_b16 a[106:107], v209 offset:27136
  ds_read_b64_tr_b16 a[108:109], v209 offset:26632
  ds_read_b64_tr_b16 a[110:111], v209 offset:27144
  s_waitcnt vmcnt(36) lgkmcnt(0)
  s_add_u32 m0, s61, 26624
  s_add_u32 s54, s63, 36864
  buffer_load_dwordx4 v207, s[40:43], s54 offen lds
  s_add_u32 m0, s61, 27648
  s_add_u32 s54, s63, 55296
  buffer_load_dwordx4 v207, s[40:43], s54 offen lds
  ds_read_b64_tr_b16 a[112:113], v209 offset:28672
  ds_read_b64_tr_b16 a[114:115], v209 offset:29184
  ds_read_b64_tr_b16 a[116:117], v209 offset:28680
  ds_read_b64_tr_b16 a[118:119], v209 offset:29192
  s_waitcnt vmcnt(36) lgkmcnt(0)
  s_add_u32 m0, s61, 28672
  s_add_u32 s54, s63, 73728
  buffer_load_dwordx4 v207, s[40:43], s54 offen lds
  s_add_u32 m0, s61, 29696
  s_add_u32 s54, s63, 92160
  buffer_load_dwordx4 v207, s[40:43], s54 offen lds
  ds_read_b64_tr_b16 a[120:121], v209 offset:30720
  ds_read_b64_tr_b16 a[122:123], v209 offset:31232
  ds_read_b64_tr_b16 a[124:125], v209 offset:30728
  ds_read_b64_tr_b16 a[126:127], v209 offset:31240
  s_waitcnt vmcnt(36) lgkmcnt(0)
  s_add_u32 m0, s61, 30720
  s_add_u32 s54, s63, 110592
  buffer_load_dwordx4 v207, s[40:43], s54 offen lds
  s_add_u32 m0, s61, 31744
  s_add_u32 s54, s63, 129024
  buffer_load_dwordx4 v207, s[40:43], s54 offen lds
  ds_read_b64_tr_b16 a[128:129], v209 offset:32768
  ds_read_b64_tr_b16 a[130:131], v209 offset:33280
  ds_read_b64_tr_b16 a[132:133], v209 offset:32776
  ds_read_b64_tr_b16 a[134:135], v209 offset:33288
  s_waitcnt vmcnt(36) lgkmcnt(0)
  s_add_u32 m0, s61, 32768
  s_add_u32 s54, s63, 147456
  buffer_load_dwordx4 v207, s[40:43], s54 offen lds
  s_add_u32 m0, s61, 33792
  s_add_u32 s54, s63, 165888
  buffer_load_dwordx4 v207, s[40:43], s54 offen lds
  ds_read_b64_tr_b16 a[136:137], v209 offset:34816
  ds_read_b64_tr_b16 a[138:139], v209 offset:35328
  ds_read_b64_tr_b16 a[140:141], v209 offset:34824
  ds_read_b64_tr_b16 a[142:143], v209 offset:35336
  s_waitcnt vmcnt(36) lgkmcnt(0)
  ds_read_b64_tr_b16 a[144:145], v209 offset:36864
  ds_read_b64_tr_b16 a[146:147], v209 offset:37376
  ds_read_b64_tr_b16 a[148:149], v209 offset:36872
  ds_read_b64_tr_b16 a[150:151], v209 offset:37384
  s_waitcnt vmcnt(34) lgkmcnt(0)
  ds_read_b64_tr_b16 a[152:153], v209 offset:38912
  ds_read_b64_tr_b16 a[154:155], v209 offset:39424
  ds_read_b64_tr_b16 a[156:157], v209 offset:38920
  ds_read_b64_tr_b16 a[158:159], v209 offset:39432
  s_waitcnt vmcnt(32) lgkmcnt(0)
  ds_read_b64_tr_b16 a[160:161], v209 offset:0
  ds_read_b64_tr_b16 a[162:163], v209 offset:512
  ds_read_b64_tr_b16 a[164:165], v209 offset:8
  ds_read_b64_tr_b16 a[166:167], v209 offset:520
  s_waitcnt vmcnt(30) lgkmcnt(0)
  ds_read_b64_tr_b16 a[168:169], v209 offset:2048
  ds_read_b64_tr_b16 a[170:171], v209 offset:2560
  ds_read_b64_tr_b16 a[172:173], v209 offset:2056
  ds_read_b64_tr_b16 a[174:175], v209 offset:2568
  s_waitcnt vmcnt(28) lgkmcnt(0)
  ds_read_b64_tr_b16 a[176:177], v209 offset:4096
  ds_read_b64_tr_b16 a[178:179], v209 offset:4608
  ds_read_b64_tr_b16 a[180:181], v209 offset:4104
  ds_read_b64_tr_b16 a[182:183], v209 offset:4616
  s_waitcnt vmcnt(26) lgkmcnt(0)
  ds_read_b64_tr_b16 a[184:185], v209 offset:6144
  ds_read_b64_tr_b16 a[186:187], v209 offset:6656
  ds_read_b64_tr_b16 a[188:189], v209 offset:6152
  ds_read_b64_tr_b16 a[190:191], v209 offset:6664
  s_waitcnt vmcnt(24) lgkmcnt(0)
  ds_read_b64_tr_b16 a[192:193], v209 offset:8192
  ds_read_b64_tr_b16 a[194:195], v209 offset:8704
  ds_read_b64_tr_b16 a[196:197], v209 offset:8200
  ds_read_b64_tr_b16 a[198:199], v209 offset:8712
  s_waitcnt vmcnt(22) lgkmcnt(0)
  ds_read_b64_tr_b16 a[200:201], v209 offset:10240
  ds_read_b64_tr_b16 a[202:203], v209 offset:10752
  ds_read_b64_tr_b16 a[204:205], v209 offset:10248
  ds_read_b64_tr_b16 a[206:207], v209 offset:10760
  s_waitcnt vmcnt(20) lgkmcnt(0)
  ds_read_b64_tr_b16 a[208:209], v209 offset:12288
  ds_read_b64_tr_b16 a[210:211], v209 offset:12800
  ds_read_b64_tr_b16 a[212:213], v209 offset:12296
  ds_read_b64_tr_b16 a[214:215], v209 offset:12808
  s_waitcnt vmcnt(18) lgkmcnt(0)
  ds_read_b64_tr_b16 a[216:217], v209 offset:14336
  ds_read_b64_tr_b16 a[218:219], v209 offset:14848
  ds_read_b64_tr_b16 a[220:221], v209 offset:14344
  ds_read_b64_tr_b16 a[222:223], v209 offset:14856
  s_waitcnt vmcnt(16) lgkmcnt(0)
  ds_read_b64_tr_b16 a[224:225], v209 offset:16384
  ds_read_b64_tr_b16 a[226:227], v209 offset:16896
  ds_read_b64_tr_b16 a[228:229], v209 offset:16392
  ds_read_b64_tr_b16 a[230:231], v209 offset:16904
  s_waitcnt vmcnt(14) lgkmcnt(0)
  ds_read_b64_tr_b16 a[232:233], v209 offset:18432
  ds_read_b64_tr_b16 a[234:235], v209 offset:18944
  ds_read_b64_tr_b16 a[236:237], v209 offset:18440
  ds_read_b64_tr_b16 a[238:239], v209 offset:18952
  s_waitcnt vmcnt(12) lgkmcnt(0)
  ds_read_b64_tr_b16 a[240:241], v209 offset:20480
  ds_read_b64_tr_b16 a[242:243], v209 offset:20992
  ds_read_b64_tr_b16 a[244:245], v209 offset:20488
  ds_read_b64_tr_b16 a[246:247], v209 offset:21000
  s_waitcnt vmcnt(10) lgkmcnt(0)
  ds_read_b64_tr_b16 a[248:249], v209 offset:22528
  ds_read_b64_tr_b16 a[250:251], v209 offset:23040
  ds_read_b64_tr_b16 a[252:253], v209 offset:22536
  ds_read_b64_tr_b16 a[254:255], v209 offset:23048
  s_waitcnt vmcnt(8) lgkmcnt(0)
  ds_read_b64_tr_b16 v[216:217], v210 offset:24576
  ds_read_b64_tr_b16 v[218:219], v210 offset:24832
  ds_read_b64_tr_b16 v[220:221], v210 offset:24584
  ds_read_b64_tr_b16 v[222:223], v210 offset:24840
  s_waitcnt vmcnt(6) lgkmcnt(0)
  ds_read_b64_tr_b16 v[224:225], v210 offset:26624
  ds_read_b64_tr_b16 v[226:227], v210 offset:26880
  ds_read_b64_tr_b16 v[228:229], v210 offset:26632
  ds_read_b64_tr_b16 v[230:231], v210 offset:26888
  s_waitcnt vmcnt(4) lgkmcnt(0)
  ds_read_b64_tr_b16 v[232:233], v210 offset:28672
  ds_read_b64_tr_b16 v[234:235], v210 offset:28928
  ds_read_b64_tr_b16 v[236:237], v210 offset:28680
  ds_read_b64_tr_b16 v[238:239], v210 offset:28936
  s_waitcnt vmcnt(2) lgkmcnt(0)
  ds_read_b64_tr_b16 v[240:241], v210 offset:30720
  ds_read_b64_tr_b16 v[242:243], v210 offset:30976
  ds_read_b64_tr_b16 v[244:245], v210 offset:30728
  ds_read_b64_tr_b16 v[246:247], v210 offset:30984
  s_waitcnt vmcnt(0) lgkmcnt(0)
  ds_read_b64_tr_b16 v[248:249], v210 offset:32768
  ds_read_b64_tr_b16 v[250:251], v210 offset:33024
  ds_read_b64_tr_b16 v[252:253], v210 offset:32776
  ds_read_b64_tr_b16 v[254:255], v210 offset:33032
  v_and_b32 v211, 15, v200
  s_lshl_b32 s54, s69, 4
  v_add_u32 v211, s54, v211
  v_lshl_add_u32 v212, v214, 5, v211
  v_lshlrev_b32 v164, 4, v212
  v_lshrrev_b32 v212, 5, v200
  v_lshl_add_u32 v164, v212, 10, v164
  v_mul_u32_u24 v167, 1152, v211
  v_lshl_add_u32 v167, v213, 4, v167
  v_lshlrev_b32 v166, 2, v211
  v_mul_u32_u24 v211, 144, v211
  s_mul_i32 s54, s52, 20
  s_mov_b32 s55, 294768
  v_mov_b32 v214, 0x40000000
  v_add_u32 v212, s54, v213
  v_add_u32 v212, 0, v212
  v_mul_u32_u24 v176, 57, v212
  v_lshrrev_b32 v176, 9, v176
  v_mul_lo_u32 v176, v176, s55
  v_lshl_add_u32 v176, v212, 4, v176
  v_add_u32 v176, v176, v211
  v_cmp_lt_u32 vcc, 71, v212
  s_nop 1
  v_cndmask_b32 v176, v176, v214, vcc
  v_add_u32 v212, s54, v213
  v_add_u32 v212, 4, v212
  v_mul_u32_u24 v177, 57, v212
  v_lshrrev_b32 v177, 9, v177
  v_mul_lo_u32 v177, v177, s55
  v_lshl_add_u32 v177, v212, 4, v177
  v_add_u32 v177, v177, v211
  v_cmp_lt_u32 vcc, 71, v212
  s_nop 1
  v_cndmask_b32 v177, v177, v214, vcc
  v_add_u32 v212, s54, v213
  v_add_u32 v212, 8, v212
  v_mul_u32_u24 v178, 57, v212
  v_lshrrev_b32 v178, 9, v178
  v_mul_lo_u32 v178, v178, s55
  v_lshl_add_u32 v178, v212, 4, v178
  v_add_u32 v178, v178, v211
  v_cmp_lt_u32 vcc, 71, v212
  s_nop 1
  v_cndmask_b32 v178, v178, v214, vcc
  v_add_u32 v212, s54, v213
  v_add_u32 v212, 12, v212
  v_mul_u32_u24 v179, 57, v212
  v_lshrrev_b32 v179, 9, v179
  v_mul_lo_u32 v179, v179, s55
  v_lshl_add_u32 v179, v212, 4, v179
  v_add_u32 v179, v179, v211
  v_cmp_lt_u32 vcc, 71, v212
  s_nop 1
  v_cndmask_b32 v179, v179, v214, vcc
  v_add_u32 v212, s54, v213
  v_add_u32 v212, 16, v212
  v_mul_u32_u24 v180, 57, v212
  v_lshrrev_b32 v180, 9, v180
  v_mul_lo_u32 v180, v180, s55
  v_lshl_add_u32 v180, v212, 4, v180
  v_add_u32 v180, v180, v211
  v_cmp_lt_u32 vcc, 71, v212
  s_nop 1
  v_cndmask_b32 v180, v180, v214, vcc
  v_lshlrev_b32 v208, 2, v200
  s_lshl_b32 s54, s52, 11
  v_add_u32 v168, s54, v201
  s_mov_b32 s59, s68
  s_mov_b32 s56, 128
  s_mov_b32 s57, 36
  s_waitcnt lgkmcnt(0)
  s_cmp_eq_u32 s52, 0
  s_cbranch_scc0 O_p1_d
  s_mov_b32 exec_hi, 0
  s_mov_b32 exec_lo, -1
O_p1:
  buffer_load_dword v211, v208, s[12:15], s56 offen sc1
  s_add_u32 s65, s65, 1
  s_waitcnt vmcnt(0)
  v_cmp_gt_u32 vcc, 0x700, v211
  s_cbranch_vccz O_p1_x
  s_sleep 16
  s_cmp_lt_u32 s65, 131072
  s_cbranch_scc1 O_p1
O_p1_x:
  s_mov_b64 exec, -1
O_p1_d:
  s_barrier
  s_cmp_eq_u32 s52, 0
  s_cbranch_scc0 O_a_d
  s_mov_b32 exec_hi, 0
  s_mov_b32 exec_lo, 1
O_a:
  buffer_load_dword v211, v208, s[12:15], s57 offen sc1
  s_add_u32 s65, s65, 1
  s_waitcnt vmcnt(0)
  v_cmp_gt_u32 vcc, 0x80, v211
  s_cbranch_vccz O_a_x
  s_sleep 16
  s_cmp_lt_u32 s65, 131072
  s_cbranch_scc1 O_a
O_a_x:
  s_mov_b64 exec, -1
O_a_d:
  s_barrier
  s_cmp_ge_u32 s70, 9
  s_cselect_b32 s54, 9, 0
  s_sub_u32 s54, s70, s54
  s_and_b32 s54, s54, 7
  s_lshl_b32 s54, s54, 13
  s_lshl_b32 s55, s69, 8
  s_add_u32 s54, s54, s55
  v_lshrrev_b32 v211, 2, v200
  v_lshl_add_u32 v172, v211, 9, s54
  v_and_b32 v211, 3, v200
  v_lshl_add_u32 v172, v211, 6, v172
  s_mul_i32 s55, s59, 4608
  s_add_u32 s55, s55, 62914560
  buffer_load_dwordx4 v[128:131], v176, s[8:11], s55 offen sc1
  buffer_load_dwordx4 v[132:135], v177, s[8:11], s55 offen sc1
  buffer_load_dwordx4 v[136:139], v178, s[8:11], s55 offen sc1
  buffer_load_dwordx4 v[140:143], v179, s[8:11], s55 offen sc1
  buffer_load_dwordx4 v[144:147], v180, s[8:11], s55 offen sc1
  s_lshl_b32 s55, s59, 7
  s_add_u32 s55, s55, 66060288
  buffer_load_dword v171, v166, s[8:11], s55 offen sc1
  v_mov_b32 v169, 0
  s_mov_b32 s66, 356352
  s_waitcnt vmcnt(0)
O_loop:
  v_mfma_f32_16x16x32_bf16 v[156:159], v[216:219], v[128:131], 0
  v_mfma_f32_16x16x32_bf16 v[160:163], v[220:223], v[128:131], 0
  v_mfma_f32_16x16x32_bf16 v[156:159], v[224:227], v[132:135], v[156:159]
  v_mfma_f32_16x16x32_bf16 v[160:163], v[228:231], v[132:135], v[160:163]
  v_mfma_f32_16x16x32_bf16 v[156:159], v[232:235], v[136:139], v[156:159]
  v_mfma_f32_16x16x32_bf16 v[160:163], v[236:239], v[136:139], v[160:163]
  v_mfma_f32_16x16x32_bf16 v[156:159], v[240:243], v[140:143], v[156:159]
  v_mfma_f32_16x16x32_bf16 v[160:163], v[244:247], v[140:143], v[160:163]
  v_mfma_f32_16x16x32_bf16 v[156:159], v[248:251], v[144:147], v[156:159]
  v_mfma_f32_16x16x32_bf16 v[160:163], v[252:255], v[144:147], v[160:163]
  s_mul_i32 s64, s59, 36864
  s_lshl_b32 s54, s70, 6
  s_add_u32 s64, s64, s54
  s_add_u32 s71, s59, 2
  s_lshl_b32 s55, s59, 18
  s_lshl_b32 s54, s52, 16
  s_add_u32 s55, s55, s54
  s_add_u32 s63, s55, 46137344
  s_and_b32 s54, s59, 1
  s_lshl_b32 s54, s54, 2
  s_add_u32 s54, s54, s52
  s_lshl_b32 s54, s54, 3
  s_lshl_b64 s[72:73], 0xff, s54
  v_sub_f32 v165, 1.0, v171
  v_cvt_pk_bf16_f32 v165, v165, v165
  v_lshlrev_b32 v165, 16, v165
  v_mul_f32 v156, v171, v156
  v_mul_f32 v157, v171, v157
  v_mul_f32 v158, v171, v158
  v_mul_f32 v159, v171, v159
  v_mul_f32 v160, v171, v160
  v_mul_f32 v161, v171, v161
  v_mul_f32 v162, v171, v162
  v_mul_f32 v163, v171, v163
  s_branch O_pc
O_pl:
  s_sleep 1
  buffer_load_dword v169, v208, s[8:11], s66 offen sc1
  s_add_u32 s65, s65, 1
  s_cmp_ge_u32 s65, 131072
  s_cbranch_scc1 O_ld
  s_waitcnt vmcnt(0)
O_pc:
  v_cmp_gt_u32 vcc, s71, v169
  s_nop 0
  s_and_b64 vcc, vcc, s[72:73]
  s_cbranch_scc1 O_pl
O_ld:
  s_mov_b32 s62, s63
  buffer_load_dword v173, v172, s[8:11], s63 offen sc1
  buffer_load_dwordx4 v[0:3], v164, s[8:11], s62 offen offset:0 sc1
  buffer_load_dwordx4 v[4:7], v164, s[8:11], s62 offen offset:2048 sc1
  s_add_u32 s62, s62, 4096
  buffer_load_dwordx4 v[8:11], v164, s[8:11], s62 offen offset:0 sc1
  buffer_load_dwordx4 v[12:15], v164, s[8:11], s62 offen offset:2048 sc1
  s_add_u32 s62, s62, 4096
  buffer_load_dwordx4 v[16:19], v164, s[8:11], s62 offen offset:0 sc1
  buffer_load_dwordx4 v[20:23], v164, s[8:11], s62 offen offset:2048 sc1
  s_add_u32 s62, s62, 4096
  buffer_load_dwordx4 v[24:27], v164, s[8:11], s62 offen offset:0 sc1
  buffer_load_dwordx4 v[28:31], v164, s[8:11], s62 offen offset:2048 sc1
  s_add_u32 s62, s62, 4096
  buffer_load_dwordx4 v[32:35], v164, s[8:11], s62 offen offset:0 sc1
  buffer_load_dwordx4 v[36:39], v164, s[8:11], s62 offen offset:2048 sc1
  s_add_u32 s62, s62, 4096
  buffer_load_dwordx4 v[40:43], v164, s[8:11], s62 offen offset:0 sc1
  buffer_load_dwordx4 v[44:47], v164, s[8:11], s62 offen offset:2048 sc1
  s_add_u32 s62, s62, 4096
  buffer_load_dwordx4 v[48:51], v164, s[8:11], s62 offen offset:0 sc1
  buffer_load_dwordx4 v[52:55], v164, s[8:11], s62 offen offset:2048 sc1
  s_add_u32 s62, s62, 4096
  buffer_load_dwordx4 v[56:59], v164, s[8:11], s62 offen offset:0 sc1
  buffer_load_dwordx4 v[60:63], v164, s[8:11], s62 offen offset:2048 sc1
  s_add_u32 s62, s62, 4096
  buffer_load_dwordx4 v[64:67], v164, s[8:11], s62 offen offset:0 sc1
  buffer_load_dwordx4 v[68:71], v164, s[8:11], s62 offen offset:2048 sc1
  s_add_u32 s62, s62, 4096
  buffer_load_dwordx4 v[72:75], v164, s[8:11], s62 offen offset:0 sc1
  buffer_load_dwordx4 v[76:79], v164, s[8:11], s62 offen offset:2048 sc1
  s_add_u32 s62, s62, 4096
  buffer_load_dwordx4 v[80:83], v164, s[8:11], s62 offen offset:0 sc1
  buffer_load_dwordx4 v[84:87], v164, s[8:11], s62 offen offset:2048 sc1
  s_add_u32 s62, s62, 4096
  buffer_load_dwordx4 v[88:91], v164, s[8:11], s62 offen offset:0 sc1
  buffer_load_dwordx4 v[92:95], v164, s[8:11], s62 offen offset:2048 sc1
  s_add_u32 s62, s62, 4096
  buffer_load_dwordx4 v[96:99], v164, s[8:11], s62 offen offset:0 sc1
  buffer_load_dwordx4 v[100:103], v164, s[8:11], s62 offen offset:2048 sc1
  s_add_u32 s62, s62, 4096
  buffer_load_dwordx4 v[104:107], v164, s[8:11], s62 offen offset:0 sc1
  buffer_load_dwordx4 v[108:111], v164, s[8:11], s62 offen offset:2048 sc1
  s_add_u32 s62, s62, 4096
  buffer_load_dwordx4 v[112:115], v164, s[8:11], s62 offen offset:0 sc1
  buffer_load_dwordx4 v[116:119], v164, s[8:11], s62 offen offset:2048 sc1
  s_add_u32 s62, s62, 4096
  buffer_load_dwordx4 v[120:123], v164, s[8:11], s62 offen offset:0 sc1
  buffer_load_dwordx4 v[124:127], v164, s[8:11], s62 offen offset:2048 sc1
  s_add_u32 s62, s62, 4096
  s_add_u32 s57, s59, 3
  s_min_u32 s74, s57, 63
  s_mul_i32 s55, s74, 4608
  s_add_u32 s55, s55, 62914560
  buffer_load_dwordx4 v[128:131], v176, s[8:11], s55 offen sc1
  buffer_load_dwordx4 v[132:135], v177, s[8:11], s55 offen sc1
  buffer_load_dwordx4 v[136:139], v178, s[8:11], s55 offen sc1
  buffer_load_dwordx4 v[140:143], v179, s[8:11], s55 offen sc1
  buffer_load_dwordx4 v[144:147], v180, s[8:11], s55 offen sc1
  s_lshl_b32 s55, s74, 7
  s_add_u32 s55, s55, 66060288
  buffer_load_dword v171, v166, s[8:11], s55 offen sc1
  s_add_u32 s65, s65, 1
  s_cmp_lt_u32 s65, 131072
  s_cselect_b32 s54, -2, -1
  s_waitcnt vmcnt(37)
  v_mfma_f32_16x16x32_bf16 v[148:151], a[0:3], v[0:3], 0
  v_mfma_f32_16x16x32_bf16 v[152:155], a[4:7], v[0:3], 0
  v_max3_u32 v170, v0, v1, v0
  v_max3_u32 v170, v2, v3, v170
  s_waitcnt vmcnt(36)
  v_mfma_f32_16x16x32_bf16 v[148:151], a[8:11], v[4:7], v[148:151]
  v_mfma_f32_16x16x32_bf16 v[152:155], a[12:15], v[4:7], v[152:155]
  v_max3_u32 v170, v4, v5, v170
  v_max3_u32 v170, v6, v7, v170
  s_waitcnt vmcnt(35)
  v_mfma_f32_16x16x32_bf16 v[148:151], a[16:19], v[8:11], v[148:151]
  v_mfma_f32_16x16x32_bf16 v[152:155], a[20:23], v[8:11], v[152:155]
  v_max3_u32 v170, v8, v9, v170
  v_max3_u32 v170, v10, v11, v170
  s_waitcnt vmcnt(34)
  v_mfma_f32_16x16x32_bf16 v[148:151], a[24:27], v[12:15], v[148:151]
  v_mfma_f32_16x16x32_bf16 v[152:155], a[28:31], v[12:15], v[152:155]
  v_max3_u32 v170, v12, v13, v170
  v_max3_u32 v170, v14, v15, v170
  s_waitcnt vmcnt(33)
  v_mfma_f32_16x16x32_bf16 v[148:151], a[32:35], v[16:19], v[148:151]
  v_mfma_f32_16x16x32_bf16 v[152:155], a[36:39], v[16:19], v[152:155]
  v_max3_u32 v170, v16, v17, v170
  v_max3_u32 v170, v18, v19, v170
  s_waitcnt vmcnt(32)
  v_mfma_f32_16x16x32_bf16 v[148:151], a[40:43], v[20:23], v[148:151]
  v_mfma_f32_16x16x32_bf16 v[152:155], a[44:47], v[20:23], v[152:155]
  v_max3_u32 v170, v20, v21, v170
  v_max3_u32 v170, v22, v23, v170
  s_waitcnt vmcnt(31)
  v_mfma_f32_16x16x32_bf16 v[148:151], a[48:51], v[24:27], v[148:151]
  v_mfma_f32_16x16x32_bf16 v[152:155], a[52:55], v[24:27], v[152:155]
  v_max3_u32 v170, v24, v25, v170
  v_max3_u32 v170, v26, v27, v170
  s_waitcnt vmcnt(30)
  v_mfma_f32_16x16x32_bf16 v[148:151], a[56:59], v[28:31], v[148:151]
  v_mfma_f32_16x16x32_bf16 v[152:155], a[60:63], v[28:31], v[152:155]
  v_max3_u32 v170, v28, v29, v170
  v_max3_u32 v170, v30, v31, v170
  s_waitcnt vmcnt(29)
  v_mfma_f32_16x16x32_bf16 v[148:151], a[64:67], v[32:35], v[148:151]
  v_mfma_f32_16x16x32_bf16 v[152:155], a[68:71], v[32:35], v[152:155]
  v_max3_u32 v170, v32, v33, v170
  v_max3_u32 v170, v34, v35, v170
  s_waitcnt vmcnt(28)
  v_mfma_f32_16x16x32_bf16 v[148:151], a[72:75], v[36:39], v[148:151]
  v_mfma_f32_16x16x32_bf16 v[152:155], a[76:79], v[36:39], v[152:155]
  v_max3_u32 v170, v36, v37, v170
  v_max3_u32 v170, v38, v39, v170
  s_waitcnt vmcnt(27)
  v_mfma_f32_16x16x32_bf16 v[148:151], a[80:83], v[40:43], v[148:151]
  v_mfma_f32_16x16x32_bf16 v[152:155], a[84:87], v[40:43], v[152:155]
  v_max3_u32 v170, v40, v41, v170
  v_max3_u32 v170, v42, v43, v170
  s_waitcnt vmcnt(26)
  v_mfma_f32_16x16x32_bf16 v[148:151], a[88:91], v[44:47], v[148:151]
  v_mfma_f32_16x16x32_bf16 v[152:155], a[92:95], v[44:47], v[152:155]
  v_max3_u32 v170, v44, v45, v170
  v_max3_u32 v170, v46, v47, v170
  s_waitcnt vmcnt(25)
  v_mfma_f32_16x16x32_bf16 v[148:151], a[96:99], v[48:51], v[148:151]
  v_mfma_f32_16x16x32_bf16 v[152:155], a[100:103], v[48:51], v[152:155]
  v_max3_u32 v170, v48, v49, v170
  v_max3_u32 v170, v50, v51, v170
  s_waitcnt vmcnt(24)
  v_mfma_f32_16x16x32_bf16 v[148:151], a[104:107], v[52:55], v[148:151]
  v_mfma_f32_16x16x32_bf16 v[152:155], a[108:111], v[52:55], v[152:155]
  v_max3_u32 v170, v52, v53, v170
  v_max3_u32 v170, v54, v55, v170
  s_waitcnt vmcnt(23)
  v_mfma_f32_16x16x32_bf16 v[148:151], a[112:115], v[56:59], v[148:151]
  v_mfma_f32_16x16x32_bf16 v[152:155], a[116:119], v[56:59], v[152:155]
  v_max3_u32 v170, v56, v57, v170
  v_max3_u32 v170, v58, v59, v170
  s_waitcnt vmcnt(22)
  v_mfma_f32_16x16x32_bf16 v[148:151], a[120:123], v[60:63], v[148:151]
  v_mfma_f32_16x16x32_bf16 v[152:155], a[124:127], v[60:63], v[152:155]
  v_max3_u32 v170, v60, v61, v170
  v_max3_u32 v170, v62, v63, v170
  s_waitcnt vmcnt(21)
  v_mfma_f32_16x16x32_bf16 v[148:151], a[128:131], v[64:67], v[148:151]
  v_mfma_f32_16x16x32_bf16 v[152:155], a[132:135], v[64:67], v[152:155]
  v_max3_u32 v170, v64, v65, v170
  v_max3_u32 v170, v66, v67, v170
  s_waitcnt vmcnt(20)
  v_mfma_f32_16x16x32_bf16 v[148:151], a[136:139], v[68:71], v[148:151]
  v_mfma_f32_16x16x32_bf16 v[152:155], a[140:143], v[68:71], v[152:155]
  v_max3_u32 v170, v68, v69, v170
  v_max3_u32 v170, v70, v71, v170
  s_waitcnt vmcnt(19)
  v_mfma_f32_16x16x32_bf16 v[148:151], a[144:147], v[72:75], v[148:151]
  v_mfma_f32_16x16x32_bf16 v[152:155], a[148:151], v[72:75], v[152:155]
  v_max3_u32 v170, v72, v73, v170
  v_max3_u32 v170, v74, v75, v170
  s_waitcnt vmcnt(18)
  v_mfma_f32_16x16x32_bf16 v[148:151], a[152:155], v[76:79], v[148:151]
  v_mfma_f32_16x16x32_bf16 v[152:155], a[156:159], v[76:79], v[152:155]
  v_max3_u32 v170, v76, v77, v170
  v_max3_u32 v170, v78, v79, v170
  s_waitcnt vmcnt(17)
  v_mfma_f32_16x16x32_bf16 v[148:151], a[160:163], v[80:83], v[148:151]
  v_mfma_f32_16x16x32_bf16 v[152:155], a[164:167], v[80:83], v[152:155]
  v_max3_u32 v170, v80, v81, v170
  v_max3_u32 v170, v82, v83, v170
  s_waitcnt vmcnt(16)
  v_mfma_f32_16x16x32_bf16 v[148:151], a[168:171], v[84:87], v[148:151]
  v_mfma_f32_16x16x32_bf16 v[152:155], a[172:175], v[84:87], v[152:155]
  v_max3_u32 v170, v84, v85, v170
  v_max3_u32 v170, v86, v87, v170
  s_waitcnt vmcnt(15)
  v_mfma_f32_16x16x32_bf16 v[148:151], a[176:179], v[88:91], v[148:151]
  v_mfma_f32_16x16x32_bf16 v[152:155], a[180:183], v[88:91], v[152:155]
  v_max3_u32 v170, v88, v89, v170
  v_max3_u32 v170, v90, v91, v170
  s_waitcnt vmcnt(14)
  v_mfma_f32_16x16x32_bf16 v[148:151], a[184:187], v[92:95], v[148:151]
  v_mfma_f32_16x16x32_bf16 v[152:155], a[188:191], v[92:95], v[152:155]
  v_max3_u32 v170, v92, v93, v170
  v_max3_u32 v170, v94, v95, v170
  s_waitcnt vmcnt(13)
  v_mfma_f32_16x16x32_bf16 v[148:151], a[192:195], v[96:99], v[148:151]
  v_mfma_f32_16x16x32_bf16 v[152:155], a[196:199], v[96:99], v[152:155]
  v_max3_u32 v170, v96, v97, v170
  v_max3_u32 v170, v98, v99, v170
  s_waitcnt vmcnt(12)
  v_mfma_f32_16x16x32_bf16 v[148:151], a[200:203], v[100:103], v[148:151]
  v_mfma_f32_16x16x32_bf16 v[152:155], a[204:207], v[100:103], v[152:155]
  v_max3_u32 v170, v100, v101, v170
  v_max3_u32 v170, v102, v103, v170
  s_waitcnt vmcnt(11)
  v_mfma_f32_16x16x32_bf16 v[148:151], a[208:211], v[104:107], v[148:151]
  v_mfma_f32_16x16x32_bf16 v[152:155], a[212:215], v[104:107], v[152:155]
  v_max3_u32 v170, v104, v105, v170
  v_max3_u32 v170, v106, v107, v170
  s_waitcnt vmcnt(10)
  v_mfma_f32_16x16x32_bf16 v[148:151], a[216:219], v[108:111], v[148:151]
  v_mfma_f32_16x16x32_bf16 v[152:155], a[220:223], v[108:111], v[152:155]
  v_max3_u32 v170, v108, v109, v170
  v_max3_u32 v170, v110, v111, v170
  s_waitcnt vmcnt(9)
  v_mfma_f32_16x16x32_bf16 v[148:151], a[224:227], v[112:115], v[148:151]
  v_mfma_f32_16x16x32_bf16 v[152:155], a[228:231], v[112:115], v[152:155]
  v_max3_u32 v170, v112, v113, v170
  v_max3_u32 v170, v114, v115, v170
  s_waitcnt vmcnt(8)
  v_mfma_f32_16x16x32_bf16 v[148:151], a[232:235], v[116:119], v[148:151]
  v_mfma_f32_16x16x32_bf16 v[152:155], a[236:239], v[116:119], v[152:155]
  v_max3_u32 v170, v116, v117, v170
  v_max3_u32 v170, v118, v119, v170
  s_waitcnt vmcnt(7)
  v_mfma_f32_16x16x32_bf16 v[148:151], a[240:243], v[120:123], v[148:151]
  v_mfma_f32_16x16x32_bf16 v[152:155], a[244:247], v[120:123], v[152:155]
  v_max3_u32 v170, v120, v121, v170
  v_max3_u32 v170, v122, v123, v170
  s_waitcnt vmcnt(6)
  v_mfma_f32_16x16x32_bf16 v[148:151], a[248:251], v[124:127], v[148:151]
  v_mfma_f32_16x16x32_bf16 v[152:155], a[252:255], v[124:127], v[152:155]
  v_max3_u32 v170, v124, v125, v170
  v_max3_u32 v170, v126, v127, v170
  v_cmp_lt_u32 vcc, s54, v170
  s_cbranch_vccnz O_ld
  v_fmac_f32 v156, v165, v148
  v_fmac_f32 v157, v165, v149
  v_fmac_f32 v158, v165, v150
  v_fmac_f32 v159, v165, v151
  v_fmac_f32 v160, v165, v152
  v_fmac_f32 v161, v165, v153
  v_fmac_f32 v162, v165, v154
  v_fmac_f32 v163, v165, v155
  ds_write_b128 v168, v[156:159]
  ds_write_b128 v168, v[160:163] offset:1024
  v_xor_b32 v168, 0x2000, v168
  s_mov_b32 s59, s57
  s_waitcnt lgkmcnt(0)
  s_barrier
  s_cmp_eq_u32 s52, 0
  s_cbranch_scc0 O_next
  v_xor_b32 v211, 0x2000, v168
  ds_read_b128 v[0:3], v211 offset:2048
  ds_read_b128 v[4:7], v211 offset:3072
  ds_read_b128 v[8:11], v211 offset:4096
  ds_read_b128 v[12:15], v211 offset:5120
  ds_read_b128 v[16:19], v211 offset:6144
  ds_read_b128 v[20:23], v211 offset:7168
  s_waitcnt lgkmcnt(5)
  v_add_f32 v156, v156, v0
  v_add_f32 v157, v157, v1
  v_add_f32 v158, v158, v2
  v_add_f32 v159, v159, v3
  s_waitcnt lgkmcnt(4)
  v_add_f32 v160, v160, v4
  v_add_f32 v161, v161, v5
  v_add_f32 v162, v162, v6
  v_add_f32 v163, v163, v7
  s_waitcnt lgkmcnt(3)
  v_add_f32 v156, v156, v8
  v_add_f32 v157, v157, v9
  v_add_f32 v158, v158, v10
  v_add_f32 v159, v159, v11
  s_waitcnt lgkmcnt(2)
  v_add_f32 v160, v160, v12
  v_add_f32 v161, v161, v13
  v_add_f32 v162, v162, v14
  v_add_f32 v163, v163, v15
  s_waitcnt lgkmcnt(1)
  v_add_f32 v156, v156, v16
  v_add_f32 v157, v157, v17
  v_add_f32 v158, v158, v18
  v_add_f32 v159, v159, v19
  s_waitcnt lgkmcnt(0)
  v_add_f32 v160, v160, v20
  v_add_f32 v161, v161, v21
  v_add_f32 v162, v162, v22
  v_add_f32 v163, v163, v23
  v_cvt_pk_bf16_f32 v148, v156, v157
  v_cvt_pk_bf16_f32 v149, v158, v159
  v_cvt_pk_bf16_f32 v150, v160, v161
  v_cvt_pk_bf16_f32 v151, v162, v163
  buffer_store_dwordx4 v[148:151], v167, s[48:51], s64 offen sc1
  s_waitcnt vmcnt(1)
  s_branch O_nx2
O_next:
  s_waitcnt vmcnt(0)
O_nx2:
  s_cmp_lt_u32 s59, 64
  s_cbranch_scc1 O_loop
  s_branch L_exit
W_h:
  s_lshr_b32 s58, s53, 1
  s_and_b32 s59, s53, 1
  s_mul_i32 s60, s59, 36864
  s_add_u32 m0, s67, 0
  s_nop 0
  buffer_load_dwordx4 v202, s[4:7], s60 offen offset:0 lds
  s_add_u32 m0, s67, 896
  s_nop 0
  buffer_load_dwordx4 v202, s[4:7], s60 offen offset:128 lds
  s_add_u32 m0, s67, 1792
  s_nop 0
  buffer_load_dwordx4 v202, s[4:7], s60 offen offset:256 lds
  s_add_u32 m0, s67, 2688
  s_nop 0
  buffer_load_dwordx4 v202, s[4:7], s60 offen offset:384 lds
  s_add_u32 m0, s67, 3584
  s_nop 0
  buffer_load_dwordx4 v202, s[4:7], s60 offen offset:512 lds
  s_add_u32 m0, s67, 4480
  s_nop 0
  buffer_load_dwordx4 v202, s[4:7], s60 offen offset:640 lds
  s_add_u32 m0, s67, 5376
  s_nop 0
  buffer_load_dwordx4 v202, s[4:7], s60 offen offset:768 lds
  s_add_u32 m0, s67, 6272
  s_nop 0
  buffer_load_dwordx4 v202, s[4:7], s60 offen offset:896 lds
  s_add_u32 m0, s67, 7168
  s_nop 0
  buffer_load_dwordx4 v202, s[4:7], s60 offen offset:1024 lds
  v_lshrrev_b32 v211, 4, v200
  v_lshlrev_b32 v212, 2, v211
  v_and_b32 v213, 15, v200
  v_xor_b32 v212, v212, v213
  v_lshlrev_b32 v212, 4, v212
  v_lshl_add_u32 v207, v211, 13, v212
  s_lshl_b32 s62, s58, 8
  s_lshl_b32 s54, s52, 15
  s_add_u32 s62, s62, s54
  s_lshl_b32 s61, s52, 10
  s_add_u32 s61, s61, 36864
  s_add_u32 m0, s61, 0
  s_add_u32 s54, s62, 0
  buffer_load_dwordx4 v207, s[16:19], s54 offen lds
  s_add_u32 m0, s61, 4096
  s_add_u32 s54, s62, 131072
  buffer_load_dwordx4 v207, s[16:19], s54 offen lds
  s_add_u32 m0, s61, 8192
  s_add_u32 s54, s62, 262144
  buffer_load_dwordx4 v207, s[16:19], s54 offen lds
  s_add_u32 m0, s61, 12288
  s_add_u32 s54, s62, 393216
  buffer_load_dwordx4 v207, s[16:19], s54 offen lds
  s_add_u32 m0, s61, 16384
  s_add_u32 s54, s62, 524288
  buffer_load_dwordx4 v207, s[16:19], s54 offen lds
  s_add_u32 m0, s61, 20480
  s_add_u32 s54, s62, 655360
  buffer_load_dwordx4 v207, s[16:19], s54 offen lds
  s_add_u32 m0, s61, 24576
  s_add_u32 s54, s62, 786432
  buffer_load_dwordx4 v207, s[16:19], s54 offen lds
  s_add_u32 m0, s61, 28672
  s_add_u32 s54, s62, 917504
  buffer_load_dwordx4 v207, s[16:19], s54 offen lds
  s_add_u32 m0, s61, 32768
  s_add_u32 s54, s62, 1048576
  buffer_load_dwordx4 v207, s[16:19], s54 offen lds
  s_add_u32 m0, s61, 36864
  s_add_u32 s54, s62, 1179648
  buffer_load_dwordx4 v207, s[16:19], s54 offen lds
  s_add_u32 m0, s61, 40960
  s_add_u32 s54, s62, 1310720
  buffer_load_dwordx4 v207, s[16:19], s54 offen lds
  s_add_u32 m0, s61, 45056
  s_add_u32 s54, s62, 1441792
  buffer_load_dwordx4 v207, s[16:19], s54 offen lds
  s_add_u32 m0, s61, 49152
  s_add_u32 s54, s62, 1572864
  buffer_load_dwordx4 v207, s[16:19], s54 offen lds
  s_add_u32 m0, s61, 53248
  s_add_u32 s54, s62, 1703936
  buffer_load_dwordx4 v207, s[16:19], s54 offen lds
  s_add_u32 m0, s61, 57344
  s_add_u32 s54, s62, 1835008
  buffer_load_dwordx4 v207, s[16:19], s54 offen lds
  s_add_u32 m0, s61, 61440
  s_add_u32 s54, s62, 1966080
  buffer_load_dwordx4 v207, s[16:19], s54 offen lds
  s_add_u32 m0, s61, 65536
  s_add_u32 s54, s62, 2097152
  buffer_load_dwordx4 v207, s[16:19], s54 offen lds
  s_add_u32 m0, s61, 69632
  s_add_u32 s54, s62, 2228224
  buffer_load_dwordx4 v207, s[16:19], s54 offen lds
  s_add_u32 m0, s61, 73728
  s_add_u32 s54, s62, 2359296
  buffer_load_dwordx4 v207, s[16:19], s54 offen lds
  s_add_u32 m0, s61, 77824
  s_add_u32 s54, s62, 2490368
  buffer_load_dwordx4 v207, s[16:19], s54 offen lds
  s_add_u32 m0, s61, 81920
  s_add_u32 s54, s62, 2621440
  buffer_load_dwordx4 v207, s[16:19], s54 offen lds
  s_add_u32 m0, s61, 86016
  s_add_u32 s54, s62, 2752512
  buffer_load_dwordx4 v207, s[16:19], s54 offen lds
  s_add_u32 m0, s61, 90112
  s_add_u32 s54, s62, 2883584
  buffer_load_dwordx4 v207, s[16:19], s54 offen lds
  s_add_u32 m0, s61, 94208
  s_add_u32 s54, s62, 3014656
  buffer_load_dwordx4 v207, s[16:19], s54 offen lds
  s_waitcnt vmcnt(20) lgkmcnt(0)
  s_barrier
  s_add_u32 m0, s61, 98304
  s_add_u32 s54, s62, 3145728
  buffer_load_dwordx4 v207, s[16:19], s54 offen lds
  s_add_u32 m0, s61, 102400
  s_add_u32 s54, s62, 3276800
  buffer_load_dwordx4 v207, s[16:19], s54 offen lds
  s_add_u32 m0, s61, 106496
  s_add_u32 s54, s62, 3407872
  buffer_load_dwordx4 v207, s[16:19], s54 offen lds
  s_add_u32 m0, s61, 110592
  s_add_u32 s54, s62, 3538944
  buffer_load_dwordx4 v207, s[16:19], s54 offen lds
  v_add_u32 v215, 36864, v209
  ds_read_b64_tr_b16 a[0:1], v215 offset:0
  ds_read_b64_tr_b16 a[2:3], v215 offset:1024
  ds_read_b64_tr_b16 a[4:5], v215 offset:4096
  ds_read_b64_tr_b16 a[6:7], v215 offset:5120
  ds_read_b64_tr_b16 a[8:9], v215 offset:8192
  ds_read_b64_tr_b16 a[10:11], v215 offset:9216
  ds_read_b64_tr_b16 a[12:13], v215 offset:12288
  ds_read_b64_tr_b16 a[14:15], v215 offset:13312
  s_waitcnt vmcnt(20) lgkmcnt(0)
  s_barrier
  s_add_u32 m0, s61, 0
  s_add_u32 s54, s62, 3670016
  buffer_load_dwordx4 v207, s[16:19], s54 offen lds
  s_add_u32 m0, s61, 4096
  s_add_u32 s54, s62, 3801088
  buffer_load_dwordx4 v207, s[16:19], s54 offen lds
  s_add_u32 m0, s61, 8192
  s_add_u32 s54, s62, 3932160
  buffer_load_dwordx4 v207, s[16:19], s54 offen lds
  s_add_u32 m0, s61, 12288
  s_add_u32 s54, s62, 4063232
  buffer_load_dwordx4 v207, s[16:19], s54 offen lds
  v_add_u32 v215, 53248, v209
  ds_read_b64_tr_b16 a[16:17], v215 offset:0
  ds_read_b64_tr_b16 a[18:19], v215 offset:1024
  ds_read_b64_tr_b16 a[20:21], v215 offset:4096
  ds_read_b64_tr_b16 a[22:23], v215 offset:5120
  ds_read_b64_tr_b16 a[24:25], v215 offset:8192
  ds_read_b64_tr_b16 a[26:27], v215 offset:9216
  ds_read_b64_tr_b16 a[28:29], v215 offset:12288
  ds_read_b64_tr_b16 a[30:31], v215 offset:13312
  s_waitcnt vmcnt(20) lgkmcnt(0)
  s_barrier
  s_add_u32 m0, s61, 16384
  s_add_u32 s54, s62, 4194304
  buffer_load_dwordx4 v207, s[16:19], s54 offen lds
  s_add_u32 m0, s61, 20480
  s_add_u32 s54, s62, 4325376
  buffer_load_dwordx4 v207, s[16:19], s54 offen lds
  s_add_u32 m0, s61, 24576
  s_add_u32 s54, s62, 4456448
  buffer_load_dwordx4 v207, s[16:19], s54 offen lds
  s_add_u32 m0, s61, 28672
  s_add_u32 s54, s62, 4587520
  buffer_load_dwordx4 v207, s[16:19], s54 offen lds
  v_add_u32 v215, 69632, v209
  ds_read_b64_tr_b16 a[32:33], v215 offset:0
  ds_read_b64_tr_b16 a[34:35], v215 offset:1024
  ds_read_b64_tr_b16 a[36:37], v215 offset:4096
  ds_read_b64_tr_b16 a[38:39], v215 offset:5120
  ds_read_b64_tr_b16 a[40:41], v215 offset:8192
  ds_read_b64_tr_b16 a[42:43], v215 offset:9216
  ds_read_b64_tr_b16 a[44:45], v215 offset:12288
  ds_read_b64_tr_b16 a[46:47], v215 offset:13312
  s_waitcnt vmcnt(20) lgkmcnt(0)
  s_barrier
  v_add_u32 v215, 86016, v209
  ds_read_b64_tr_b16 a[48:49], v215 offset:0
  ds_read_b64_tr_b16 a[50:51], v215 offset:1024
  ds_read_b64_tr_b16 a[52:53], v215 offset:4096
  ds_read_b64_tr_b16 a[54:55], v215 offset:5120
  ds_read_b64_tr_b16 a[56:57], v215 offset:8192
  ds_read_b64_tr_b16 a[58:59], v215 offset:9216
  ds_read_b64_tr_b16 a[60:61], v215 offset:12288
  ds_read_b64_tr_b16 a[62:63], v215 offset:13312
  s_waitcnt vmcnt(16) lgkmcnt(0)
  s_barrier
  v_add_u32 v215, 102400, v209
  ds_read_b64_tr_b16 a[64:65], v215 offset:0
  ds_read_b64_tr_b16 a[66:67], v215 offset:1024
  ds_read_b64_tr_b16 a[68:69], v215 offset:4096
  ds_read_b64_tr_b16 a[70:71], v215 offset:5120
  ds_read_b64_tr_b16 a[72:73], v215 offset:8192
  ds_read_b64_tr_b16 a[74:75], v215 offset:9216
  ds_read_b64_tr_b16 a[76:77], v215 offset:12288
  ds_read_b64_tr_b16 a[78:79], v215 offset:13312
  s_waitcnt vmcnt(12) lgkmcnt(0)
  s_barrier
  v_add_u32 v215, 118784, v209
  ds_read_b64_tr_b16 a[80:81], v215 offset:0
  ds_read_b64_tr_b16 a[82:83], v215 offset:1024
  ds_read_b64_tr_b16 a[84:85], v215 offset:4096
  ds_read_b64_tr_b16 a[86:87], v215 offset:5120
  ds_read_b64_tr_b16 a[88:89], v215 offset:8192
  ds_read_b64_tr_b16 a[90:91], v215 offset:9216
  ds_read_b64_tr_b16 a[92:93], v215 offset:12288
  ds_read_b64_tr_b16 a[94:95], v215 offset:13312
  s_waitcnt vmcnt(8) lgkmcnt(0)
  s_barrier
  v_add_u32 v215, 135168, v209
  ds_read_b64_tr_b16 a[96:97], v215 offset:0
  ds_read_b64_tr_b16 a[98:99], v215 offset:1024
  ds_read_b64_tr_b16 a[100:101], v215 offset:4096
  ds_read_b64_tr_b16 a[102:103], v215 offset:5120
  ds_read_b64_tr_b16 a[104:105], v215 offset:8192
  ds_read_b64_tr_b16 a[106:107], v215 offset:9216
  ds_read_b64_tr_b16 a[108:109], v215 offset:12288
  ds_read_b64_tr_b16 a[110:111], v215 offset:13312
  s_waitcnt vmcnt(4) lgkmcnt(0)
  s_barrier
  v_add_u32 v215, 36864, v209
  ds_read_b64_tr_b16 a[112:113], v215 offset:0
  ds_read_b64_tr_b16 a[114:115], v215 offset:1024
  ds_read_b64_tr_b16 a[116:117], v215 offset:4096
  ds_read_b64_tr_b16 a[118:119], v215 offset:5120
  ds_read_b64_tr_b16 a[120:121], v215 offset:8192
  ds_read_b64_tr_b16 a[122:123], v215 offset:9216
  ds_read_b64_tr_b16 a[124:125], v215 offset:12288
  ds_read_b64_tr_b16 a[126:127], v215 offset:13312
  s_waitcnt vmcnt(0) lgkmcnt(0)
  s_barrier
  v_add_u32 v215, 53248, v209
  ds_read_b64_tr_b16 a[128:129], v215 offset:0
  ds_read_b64_tr_b16 a[130:131], v215 offset:1024
  ds_read_b64_tr_b16 a[132:133], v215 offset:4096
  ds_read_b64_tr_b16 a[134:135], v215 offset:5120
  ds_read_b64_tr_b16 a[136:137], v215 offset:8192
  ds_read_b64_tr_b16 a[138:139], v215 offset:9216
  ds_read_b64_tr_b16 a[140:141], v215 offset:12288
  ds_read_b64_tr_b16 a[142:143], v215 offset:13312
  s_waitcnt lgkmcnt(0)
  s_barrier
  v_and_b32 v211, 31, v200
  v_lshrrev_b32 v212, 5, v200
  v_lshlrev_b32 v213, 2, v212
  v_sub_u32 v211, v211, v213
  v_mov_b32 v214, 0xf149f2ca
  v_cmp_gt_i32 vcc, 0, v211
  s_nop 1
  v_cndmask_b32 v48, 0, v214, vcc
  v_cmp_gt_i32 vcc, 1, v211
  s_nop 1
  v_cndmask_b32 v49, 0, v214, vcc
  v_cmp_gt_i32 vcc, 2, v211
  s_nop 1
  v_cndmask_b32 v50, 0, v214, vcc
  v_cmp_gt_i32 vcc, 3, v211
  s_nop 1
  v_cndmask_b32 v51, 0, v214, vcc
  v_cmp_gt_i32 vcc, 8, v211
  s_nop 1
  v_cndmask_b32 v52, 0, v214, vcc
  v_cmp_gt_i32 vcc, 9, v211
  s_nop 1
  v_cndmask_b32 v53, 0, v214, vcc
  v_cmp_gt_i32 vcc, 10, v211
  s_nop 1
  v_cndmask_b32 v54, 0, v214, vcc
  v_cmp_gt_i32 vcc, 11, v211
  s_nop 1
  v_cndmask_b32 v55, 0, v214, vcc
  v_cmp_gt_i32 vcc, 16, v211
  s_nop 1
  v_cndmask_b32 v56, 0, v214, vcc
  v_cmp_gt_i32 vcc, 17, v211
  s_nop 1
  v_cndmask_b32 v57, 0, v214, vcc
  v_cmp_gt_i32 vcc, 18, v211
  s_nop 1
  v_cndmask_b32 v58, 0, v214, vcc
  v_cmp_gt_i32 vcc, 19, v211
  s_nop 1
  v_cndmask_b32 v59, 0, v214, vcc
  v_cmp_gt_i32 vcc, 24, v211
  s_nop 1
  v_cndmask_b32 v60, 0, v214, vcc
  v_cmp_gt_i32 vcc, 25, v211
  s_nop 1
  v_cndmask_b32 v61, 0, v214, vcc
  v_cmp_gt_i32 vcc, 26, v211
  s_nop 1
  v_cndmask_b32 v62, 0, v214, vcc
  v_cmp_gt_i32 vcc, 27, v211
  s_nop 1
  v_cndmask_b32 v63, 0, v214, vcc
  v_and_b32 v218, 0xff, v216
  v_add_u32 v218, 81920, v218
  v_and_b32 v211, 15, v200
  v_lshl_add_u32 v211, v212, 5, v211
  v_lshlrev_b32 v219, 3, v211
  v_bfe_u32 v211, v200, 4, 1
  v_lshl_add_u32 v219, v211, 2, v219
  s_lshl_b32 s54, s52, 9
  s_add_u32 s54, s54, 83968
  v_add_u32 v219, s54, v219
  v_lshl_add_u32 v221, v200, 3, s54
  s_lshr_b32 s54, s52, 1
  s_lshl_b32 s54, s54, 10
  s_and_b32 s55, s52, 1
  s_lshl_b32 s55, s55, 3
  s_add_u32 s54, s54, s55
  s_add_u32 s54, s54, 81920
  v_add_u32 v220, s54, v201
  s_lshl_b32 s54, s52, 11
  s_add_u32 s54, s54, 73728
  v_add_u32 v215, s54, v201
  v_add_u32 v208, 73728, v201
  s_mov_b32 s68, 1040356334
  s_cmp_eq_u32 s52, 0
  s_cselect_b32 s71, s71, 268435456
  s_lshl_b32 s56, s58, 2
  s_add_u32 s56, s56, 128
  v_mov_b32 v176, -1
  v_mov_b32 v177, -1
  v_mov_b32 v178, -1
  v_mov_b32 v179, -1
  s_cmp_eq_u32 s52, 0
  s_cbranch_scc0 AT_p1_d
  s_mov_b32 exec_hi, 0
  s_mov_b32 exec_lo, 1
AT_p1:
  buffer_load_dword v211, v201, s[12:15], s56 offen sc1
  s_add_u32 s65, s65, 1
  s_waitcnt vmcnt(0)
  v_cmp_gt_u32 vcc, 0x700, v211
  s_cbranch_vccz AT_p1_x
  s_sleep 8
  s_cmp_lt_u32 s65, 131072
  s_cbranch_scc1 AT_p1
AT_p1_x:
  s_mov_b64 exec, -1
AT_p1_d:
  s_barrier
  s_mov_b32 s74, s59
  s_mul_i32 s66, s59, 655360
  s_lshl_b32 s55, s58, 14
  s_add_u32 s55, s55, s66
  s_add_u32 s55, s55, 1048576
  s_lshl_b32 s73, s58, 2
  s_add_u32 s73, s73, s52
  s_lshl_b32 s72, s59, 7
  s_add_u32 s72, s72, s73
  s_lshl_b32 s72, s72, 11
  s_add_u32 s72, s72, 46137344
  s_lshl_b32 s73, s73, 10
  s_add_u32 s73, s73, s66
  s_add_u32 s73, s73, 1572864
  s_add_u32 s59, s59, 2
  buffer_load_dwordx4 v[128:131], v216, s[8:11], s55 offen offset:0 sc1
  buffer_load_dwordx4 v[132:135], v216, s[8:11], s55 offen offset:256 sc1
  buffer_load_dwordx4 v[136:139], v216, s[8:11], s55 offen offset:512 sc1
  buffer_load_dwordx4 v[140:143], v216, s[8:11], s55 offen offset:768 sc1
  buffer_load_dwordx4 v[144:147], v216, s[8:11], s55 offen offset:1024 sc1
  buffer_load_dwordx4 v[148:151], v216, s[8:11], s55 offen offset:1280 sc1
  buffer_load_dwordx4 v[152:155], v216, s[8:11], s55 offen offset:1536 sc1
  buffer_load_dwordx4 v[156:159], v216, s[8:11], s55 offen offset:1792 sc1
  buffer_load_dwordx4 v[160:163], v217, s[8:11], s55 offen offset:0 sc1
  buffer_load_dwordx4 v[164:167], v217, s[8:11], s55 offen offset:256 sc1
  s_add_u32 s60, s60, 73728
  ds_read_b128 v[32:35], v203 offset:0
  ds_read_b128 v[36:39], v204 offset:0
  ds_read_b128 v[40:43], v205 offset:0
  s_waitcnt lgkmcnt(2)
  v_mfma_f32_32x32x16_bf16 v[240:255], a[0:3], v[32:35], 0
  ds_read_b128 v[44:47], v206 offset:0
  s_add_u32 m0, s67, 36864
  s_nop 0
  buffer_load_dwordx4 v202, s[4:7], s60 offen offset:0 lds
  s_waitcnt lgkmcnt(2)
  v_mfma_f32_32x32x16_bf16 v[240:255], a[4:7], v[36:39], v[240:255]
  ds_read_b128 v[32:35], v203 offset:1024
  s_waitcnt lgkmcnt(2)
  v_mfma_f32_32x32x16_bf16 v[240:255], a[8:11], v[40:43], v[240:255]
  ds_read_b128 v[36:39], v204 offset:1024
  s_add_u32 m0, s67, 37760
  s_nop 0
  buffer_load_dwordx4 v202, s[4:7], s60 offen offset:128 lds
  s_waitcnt lgkmcnt(2)
  v_mfma_f32_32x32x16_bf16 v[240:255], a[12:15], v[44:47], v[240:255]
  ds_read_b128 v[40:43], v205 offset:1024
  s_waitcnt lgkmcnt(2)
  v_mfma_f32_32x32x16_bf16 v[240:255], a[16:19], v[32:35], v[240:255]
  ds_read_b128 v[44:47], v206 offset:1024
  s_add_u32 m0, s67, 38656
  s_nop 0
  buffer_load_dwordx4 v202, s[4:7], s60 offen offset:256 lds
  s_waitcnt lgkmcnt(2)
  v_mfma_f32_32x32x16_bf16 v[240:255], a[20:23], v[36:39], v[240:255]
  ds_read_b128 v[32:35], v203 offset:2048
  s_waitcnt lgkmcnt(2)
  v_mfma_f32_32x32x16_bf16 v[240:255], a[24:27], v[40:43], v[240:255]
  ds_read_b128 v[36:39], v204 offset:2048
  s_add_u32 m0, s67, 39552
  s_nop 0
  buffer_load_dwordx4 v202, s[4:7], s60 offen offset:384 lds
  s_waitcnt lgkmcnt(2)
  v_mfma_f32_32x32x16_bf16 v[240:255], a[28:31], v[44:47], v[240:255]
  ds_read_b128 v[40:43], v205 offset:2048
  s_waitcnt lgkmcnt(2)
  v_mfma_f32_32x32x16_bf16 v[240:255], a[32:35], v[32:35], v[240:255]
  ds_read_b128 v[44:47], v206 offset:2048
  s_add_u32 m0, s67, 40448
  s_nop 0
  buffer_load_dwordx4 v202, s[4:7], s60 offen offset:512 lds
  s_waitcnt lgkmcnt(2)
  v_mfma_f32_32x32x16_bf16 v[240:255], a[36:39], v[36:39], v[240:255]
  ds_read_b128 v[32:35], v203 offset:3072
  s_waitcnt lgkmcnt(2)
  v_mfma_f32_32x32x16_bf16 v[240:255], a[40:43], v[40:43], v[240:255]
  ds_read_b128 v[36:39], v204 offset:3072
  s_add_u32 m0, s67, 41344
  s_nop 0
  buffer_load_dwordx4 v202, s[4:7], s60 offen offset:640 lds
  s_waitcnt lgkmcnt(2)
  v_mfma_f32_32x32x16_bf16 v[240:255], a[44:47], v[44:47], v[240:255]
  ds_read_b128 v[40:43], v205 offset:3072
  s_waitcnt lgkmcnt(2)
  v_mfma_f32_32x32x16_bf16 v[240:255], a[48:51], v[32:35], v[240:255]
  ds_read_b128 v[44:47], v206 offset:3072
  s_add_u32 m0, s67, 42240
  s_nop 0
  buffer_load_dwordx4 v202, s[4:7], s60 offen offset:768 lds
  s_waitcnt lgkmcnt(2)
  v_mfma_f32_32x32x16_bf16 v[240:255], a[52:55], v[36:39], v[240:255]
  ds_read_b128 v[32:35], v203 offset:4096
  s_waitcnt lgkmcnt(2)
  v_mfma_f32_32x32x16_bf16 v[240:255], a[56:59], v[40:43], v[240:255]
  ds_read_b128 v[36:39], v204 offset:4096
  s_add_u32 m0, s67, 43136
  s_nop 0
  buffer_load_dwordx4 v202, s[4:7], s60 offen offset:896 lds
  s_waitcnt lgkmcnt(2)
  v_mfma_f32_32x32x16_bf16 v[240:255], a[60:63], v[44:47], v[240:255]
  ds_read_b128 v[40:43], v205 offset:4096
  s_waitcnt lgkmcnt(2)
  v_mfma_f32_32x32x16_bf16 v[240:255], a[64:67], v[32:35], v[240:255]
  ds_read_b128 v[44:47], v206 offset:4096
  s_add_u32 m0, s67, 44032
  s_nop 0
  buffer_load_dwordx4 v202, s[4:7], s60 offen offset:1024 lds
  s_waitcnt lgkmcnt(2)
  v_mfma_f32_32x32x16_bf16 v[240:255], a[68:71], v[36:39], v[240:255]
  ds_read_b128 v[32:35], v203 offset:5120
  s_waitcnt lgkmcnt(2)
  v_mfma_f32_32x32x16_bf16 v[240:255], a[72:75], v[40:43], v[240:255]
  ds_read_b128 v[36:39], v204 offset:5120
  buffer_store_dwordx4 v[176:179], v201, s[8:11], s72 offen offset:0 sc1
  s_waitcnt lgkmcnt(2)
  v_mfma_f32_32x32x16_bf16 v[240:255], a[76:79], v[44:47], v[240:255]
  ds_read_b128 v[40:43], v205 offset:5120
  s_waitcnt lgkmcnt(2)
  v_mfma_f32_32x32x16_bf16 v[240:255], a[80:83], v[32:35], v[240:255]
  ds_read_b128 v[44:47], v206 offset:5120
  buffer_store_dwordx4 v[176:179], v201, s[8:11], s72 offen offset:1024 sc1
  s_waitcnt lgkmcnt(2)
  v_mfma_f32_32x32x16_bf16 v[240:255], a[84:87], v[36:39], v[240:255]
  ds_read_b128 v[32:35], v203 offset:6144
  s_waitcnt lgkmcnt(2)
  v_mfma_f32_32x32x16_bf16 v[240:255], a[88:91], v[40:43], v[240:255]
  ds_read_b128 v[36:39], v204 offset:6144
  s_waitcnt lgkmcnt(2)
  v_mfma_f32_32x32x16_bf16 v[240:255], a[92:95], v[44:47], v[240:255]
  ds_read_b128 v[40:43], v205 offset:6144
  s_waitcnt lgkmcnt(2)
  v_mfma_f32_32x32x16_bf16 v[240:255], a[96:99], v[32:35], v[240:255]
  ds_read_b128 v[44:47], v206 offset:6144
  s_waitcnt lgkmcnt(2)
  v_mfma_f32_32x32x16_bf16 v[240:255], a[100:103], v[36:39], v[240:255]
  ds_read_b128 v[32:35], v203 offset:7168
  s_waitcnt lgkmcnt(2)
  v_mfma_f32_32x32x16_bf16 v[240:255], a[104:107], v[40:43], v[240:255]
  ds_read_b128 v[36:39], v204 offset:7168
  s_waitcnt lgkmcnt(2)
  v_mfma_f32_32x32x16_bf16 v[240:255], a[108:111], v[44:47], v[240:255]
  ds_read_b128 v[40:43], v205 offset:7168
  s_waitcnt lgkmcnt(2)
  v_mfma_f32_32x32x16_bf16 v[240:255], a[112:115], v[32:35], v[240:255]
  ds_read_b128 v[44:47], v206 offset:7168
  s_waitcnt lgkmcnt(2)
  v_mfma_f32_32x32x16_bf16 v[240:255], a[116:119], v[36:39], v[240:255]
  ds_read_b128 v[32:35], v203 offset:8192
  s_waitcnt lgkmcnt(2)
  v_mfma_f32_32x32x16_bf16 v[240:255], a[120:123], v[40:43], v[240:255]
  ds_read_b128 v[36:39], v204 offset:8192
  s_waitcnt lgkmcnt(2)
  v_mfma_f32_32x32x16_bf16 v[240:255], a[124:127], v[44:47], v[240:255]
  ds_read_b128 v[40:43], v205 offset:8192
  s_waitcnt lgkmcnt(2)
  v_mfma_f32_32x32x16_bf16 v[240:255], a[128:131], v[32:35], v[240:255]
  ds_read_b128 v[44:47], v206 offset:8192
  s_waitcnt lgkmcnt(2)
  v_mfma_f32_32x32x16_bf16 v[240:255], a[132:135], v[36:39], v[240:255]
  s_waitcnt lgkmcnt(1)
  v_mfma_f32_32x32x16_bf16 v[240:255], a[136:139], v[40:43], v[240:255]
  s_waitcnt lgkmcnt(0)
  v_mfma_f32_32x32x16_bf16 v[240:255], a[140:143], v[44:47], v[240:255]
  s_nop 11
  v_cvt_pk_bf16_f32 v16, v240, v244
  v_cvt_pk_bf16_f32 v17, v241, v245
  v_cvt_pk_bf16_f32 v18, v242, v246
  v_cvt_pk_bf16_f32 v19, v243, v247
  ds_write_b128 v215, v[16:19] offset:0
  v_cvt_pk_bf16_f32 v20, v248, v252
  v_cvt_pk_bf16_f32 v21, v249, v253
  v_cvt_pk_bf16_f32 v22, v250, v254
  v_cvt_pk_bf16_f32 v23, v251, v255
  ds_write_b128 v215, v[20:23] offset:1024
  s_waitcnt lgkmcnt(0)
  s_barrier
  ds_read_b128 v[96:99], v208 offset:0
  ds_read_b128 v[100:103], v208 offset:1024
  ds_read_b128 v[104:107], v208 offset:2048
  ds_read_b128 v[108:111], v208 offset:3072
  ds_read_b128 v[112:115], v208 offset:4096
  ds_read_b128 v[116:119], v208 offset:5120
  ds_read_b128 v[120:123], v208 offset:6144
  ds_read_b128 v[124:127], v208 offset:7168
  s_waitcnt vmcnt(20) lgkmcnt(7)
  v_mfma_f32_32x32x16_bf16 v[64:79], v[128:131], v[96:99], v[48:63]
  s_waitcnt vmcnt(19) lgkmcnt(6)
  v_mfma_f32_32x32x16_bf16 v[64:79], v[132:135], v[100:103], v[64:79]
  s_waitcnt vmcnt(18) lgkmcnt(5)
  v_mfma_f32_32x32x16_bf16 v[64:79], v[136:139], v[104:107], v[64:79]
  s_waitcnt vmcnt(17) lgkmcnt(4)
  v_mfma_f32_32x32x16_bf16 v[64:79], v[140:143], v[108:111], v[64:79]
  s_waitcnt vmcnt(16) lgkmcnt(3)
  v_mfma_f32_32x32x16_bf16 v[64:79], v[144:147], v[112:115], v[64:79]
  s_waitcnt vmcnt(15) lgkmcnt(2)
  v_mfma_f32_32x32x16_bf16 v[64:79], v[148:151], v[116:119], v[64:79]
  s_waitcnt vmcnt(14) lgkmcnt(1)
  v_mfma_f32_32x32x16_bf16 v[64:79], v[152:155], v[120:123], v[64:79]
  s_waitcnt vmcnt(13) lgkmcnt(0)
  v_mfma_f32_32x32x16_bf16 v[64:79], v[156:159], v[124:127], v[64:79]
  s_nop 11
  v_max3_f32 v180, v64, v65, v66
  v_max3_f32 v180, v180, v67, v68
  v_max3_f32 v180, v180, v69, v70
  v_max3_f32 v180, v180, v71, v72
  v_max3_f32 v180, v180, v73, v74
  v_max3_f32 v180, v180, v75, v76
  v_max3_f32 v180, v180, v77, v78
  v_max_f32 v180, v180, v79
  v_mov_b32 v181, v180
  s_nop 1
  v_permlane32_swap_b32 v180, v181
  v_max_f32 v180, v180, v181
  v_sub_f32 v64, v64, v180
  v_sub_f32 v65, v65, v180
  v_sub_f32 v66, v66, v180
  v_sub_f32 v67, v67, v180
  v_sub_f32 v68, v68, v180
  v_sub_f32 v69, v69, v180
  v_sub_f32 v70, v70, v180
  v_sub_f32 v71, v71, v180
  v_sub_f32 v72, v72, v180
  v_sub_f32 v73, v73, v180
  v_sub_f32 v74, v74, v180
  v_sub_f32 v75, v75, v180
  v_sub_f32 v76, v76, v180
  v_sub_f32 v77, v77, v180
  v_sub_f32 v78, v78, v180
  v_sub_f32 v79, v79, v180
  v_exp_f32 v64, v64
  v_exp_f32 v65, v65
  v_exp_f32 v66, v66
  v_exp_f32 v67, v67
  v_exp_f32 v68, v68
  v_exp_f32 v69, v69
  v_exp_f32 v70, v70
  v_exp_f32 v71, v71
  v_exp_f32 v72, v72
  v_exp_f32 v73, v73
  v_exp_f32 v74, v74
  v_exp_f32 v75, v75
  v_exp_f32 v76, v76
  v_exp_f32 v77, v77
  v_exp_f32 v78, v78
  v_exp_f32 v79, v79
  v_cvt_pk_bf16_f32 v20, v64, v65
  v_cvt_pk_bf16_f32 v21, v68, v69
  v_cvt_pk_bf16_f32 v22, v72, v73
  v_cvt_pk_bf16_f32 v23, v76, v77
  v_cvt_pk_bf16_f32 v24, v66, v67
  v_cvt_pk_bf16_f32 v25, v70, v71
  v_cvt_pk_bf16_f32 v26, v74, v75
  v_cvt_pk_bf16_f32 v27, v78, v79
  s_waitcnt vmcnt(12)
  v_mfma_f32_32x32x16_bf16 v[0:15], v[160:163], v[20:23], 0
  v_add_f32 v182, v64, v65
  v_add_f32 v182, v182, v66
  v_add_f32 v182, v182, v67
  v_add_f32 v182, v182, v68
  v_add_f32 v182, v182, v69
  v_add_f32 v182, v182, v70
  v_add_f32 v182, v182, v71
  s_waitcnt vmcnt(11)
  v_mfma_f32_32x32x16_bf16 v[0:15], v[164:167], v[24:27], v[0:15]
  v_add_f32 v182, v182, v72
  v_add_f32 v182, v182, v73
  v_add_f32 v182, v182, v74
  v_add_f32 v182, v182, v75
  v_add_f32 v182, v182, v76
  v_add_f32 v182, v182, v77
  v_add_f32 v182, v182, v78
  v_add_f32 v182, v182, v79
  s_waitcnt vmcnt(0)
  s_barrier
AT_loop:
  s_cmp_ge_u32 s59, 64
  s_cbranch_scc1 AT_l0
  s_mov_b32 s77, s59
  s_mul_i32 s66, s59, 655360
  s_lshl_b32 s55, s58, 14
  s_add_u32 s55, s55, s66
  s_add_u32 s55, s55, 1048576
  s_lshl_b32 s76, s58, 2
  s_add_u32 s76, s76, s52
  s_lshl_b32 s75, s59, 7
  s_add_u32 s75, s75, s76
  s_lshl_b32 s75, s75, 11
  s_add_u32 s75, s75, 46137344
  s_lshl_b32 s76, s76, 10
  s_add_u32 s76, s76, s66
  s_add_u32 s76, s76, 1572864
  s_add_u32 s59, s59, 2
  buffer_load_dwordx4 v[128:131], v216, s[8:11], s55 offen offset:0 sc1
  buffer_load_dwordx4 v[132:135], v216, s[8:11], s55 offen offset:256 sc1
  buffer_load_dwordx4 v[136:139], v216, s[8:11], s55 offen offset:512 sc1
  buffer_load_dwordx4 v[140:143], v216, s[8:11], s55 offen offset:768 sc1
  buffer_load_dwordx4 v[144:147], v216, s[8:11], s55 offen offset:1024 sc1
  buffer_load_dwordx4 v[148:151], v216, s[8:11], s55 offen offset:1280 sc1
  buffer_load_dwordx4 v[152:155], v216, s[8:11], s55 offen offset:1536 sc1
  buffer_load_dwordx4 v[156:159], v216, s[8:11], s55 offen offset:1792 sc1
  buffer_load_dwordx4 v[160:163], v217, s[8:11], s55 offen offset:0 sc1
  buffer_load_dwordx4 v[164:167], v217, s[8:11], s55 offen offset:256 sc1
  s_or_b32 s70, s73, 0xc00
  buffer_load_dword v172, off, s[8:11], s70 sc1
  s_add_u32 s60, s60, 73728
  ds_read_b128 v[32:35], v203 offset:36864
  ds_read_b128 v[36:39], v204 offset:36864
  ds_read_b128 v[40:43], v205 offset:36864
  s_waitcnt lgkmcnt(2)
  v_mfma_f32_32x32x16_bf16 v[240:255], a[0:3], v[32:35], 0
  ds_read_b128 v[44:47], v206 offset:36864
  s_add_u32 m0, s67, 0
  s_nop 0
  buffer_load_dwordx4 v202, s[4:7], s60 offen offset:0 lds
  s_waitcnt lgkmcnt(2)
  v_mfma_f32_32x32x16_bf16 v[240:255], a[4:7], v[36:39], v[240:255]
  ds_read_b128 v[32:35], v203 offset:37888
  s_waitcnt lgkmcnt(2)
  v_mfma_f32_32x32x16_bf16 v[240:255], a[8:11], v[40:43], v[240:255]
  ds_read_b128 v[36:39], v204 offset:37888
  s_add_u32 m0, s67, 896
  s_nop 0
  buffer_load_dwordx4 v202, s[4:7], s60 offen offset:128 lds
  s_waitcnt lgkmcnt(2)
  v_mfma_f32_32x32x16_bf16 v[240:255], a[12:15], v[44:47], v[240:255]
  ds_read_b128 v[40:43], v205 offset:37888
  s_waitcnt lgkmcnt(2)
  v_mfma_f32_32x32x16_bf16 v[240:255], a[16:19], v[32:35], v[240:255]
  ds_read_b128 v[44:47], v206 offset:37888
  s_add_u32 m0, s67, 1792
  s_nop 0
  buffer_load_dwordx4 v202, s[4:7], s60 offen offset:256 lds
  s_waitcnt lgkmcnt(2)
  v_mfma_f32_32x32x16_bf16 v[240:255], a[20:23], v[36:39], v[240:255]
  ds_read_b128 v[32:35], v203 offset:38912
  s_waitcnt lgkmcnt(2)
  v_mfma_f32_32x32x16_bf16 v[240:255], a[24:27], v[40:43], v[240:255]
  ds_read_b128 v[36:39], v204 offset:38912
  s_add_u32 m0, s67, 2688
  s_nop 0
  buffer_load_dwordx4 v202, s[4:7], s60 offen offset:384 lds
  s_waitcnt lgkmcnt(2)
  v_mfma_f32_32x32x16_bf16 v[240:255], a[28:31], v[44:47], v[240:255]
  ds_read_b128 v[40:43], v205 offset:38912
  s_waitcnt lgkmcnt(2)
  v_mfma_f32_32x32x16_bf16 v[240:255], a[32:35], v[32:35], v[240:255]
  ds_read_b128 v[44:47], v206 offset:38912
  s_add_u32 m0, s67, 3584
  s_nop 0
  buffer_load_dwordx4 v202, s[4:7], s60 offen offset:512 lds
  s_waitcnt lgkmcnt(2)
  v_mfma_f32_32x32x16_bf16 v[240:255], a[36:39], v[36:39], v[240:255]
  ds_read_b128 v[32:35], v203 offset:39936
  s_waitcnt lgkmcnt(2)
  v_mfma_f32_32x32x16_bf16 v[240:255], a[40:43], v[40:43], v[240:255]
  ds_read_b128 v[36:39], v204 offset:39936
  s_add_u32 m0, s67, 4480
  s_nop 0
  buffer_load_dwordx4 v202, s[4:7], s60 offen offset:640 lds
  s_waitcnt lgkmcnt(2)
  v_mfma_f32_32x32x16_bf16 v[240:255], a[44:47], v[44:47], v[240:255]
  ds_read_b128 v[40:43], v205 offset:39936
  s_waitcnt lgkmcnt(2)
  v_mfma_f32_32x32x16_bf16 v[240:255], a[48:51], v[32:35], v[240:255]
  ds_read_b128 v[44:47], v206 offset:39936
  s_add_u32 m0, s67, 5376
  s_nop 0
  buffer_load_dwordx4 v202, s[4:7], s60 offen offset:768 lds
  s_waitcnt lgkmcnt(2)
  v_mfma_f32_32x32x16_bf16 v[240:255], a[52:55], v[36:39], v[240:255]
  ds_read_b128 v[32:35], v203 offset:40960
  s_waitcnt lgkmcnt(2)
  v_mfma_f32_32x32x16_bf16 v[240:255], a[56:59], v[40:43], v[240:255]
  ds_read_b128 v[36:39], v204 offset:40960
  s_add_u32 m0, s67, 6272
  s_nop 0
  buffer_load_dwordx4 v202, s[4:7], s60 offen offset:896 lds
  s_waitcnt lgkmcnt(2)
  v_mfma_f32_32x32x16_bf16 v[240:255], a[60:63], v[44:47], v[240:255]
  ds_read_b128 v[40:43], v205 offset:40960
  s_waitcnt lgkmcnt(2)
  v_mfma_f32_32x32x16_bf16 v[240:255], a[64:67], v[32:35], v[240:255]
  ds_read_b128 v[44:47], v206 offset:40960
  s_add_u32 m0, s67, 7168
  s_nop 0
  buffer_load_dwordx4 v202, s[4:7], s60 offen offset:1024 lds
  s_waitcnt lgkmcnt(2)
  v_mfma_f32_32x32x16_bf16 v[240:255], a[68:71], v[36:39], v[240:255]
  ds_read_b128 v[32:35], v203 offset:41984
  s_waitcnt lgkmcnt(2)
  v_mfma_f32_32x32x16_bf16 v[240:255], a[72:75], v[40:43], v[240:255]
  ds_read_b128 v[36:39], v204 offset:41984
  buffer_store_dwordx4 v[176:179], v201, s[8:11], s75 offen offset:0 sc1
  s_waitcnt lgkmcnt(2)
  v_mfma_f32_32x32x16_bf16 v[240:255], a[76:79], v[44:47], v[240:255]
  ds_read_b128 v[40:43], v205 offset:41984
  s_waitcnt lgkmcnt(2)
  v_mfma_f32_32x32x16_bf16 v[240:255], a[80:83], v[32:35], v[240:255]
  ds_read_b128 v[44:47], v206 offset:41984
  buffer_store_dwordx4 v[176:179], v201, s[8:11], s75 offen offset:1024 sc1
  s_waitcnt lgkmcnt(2)
  v_mfma_f32_32x32x16_bf16 v[240:255], a[84:87], v[36:39], v[240:255]
  ds_read_b128 v[32:35], v203 offset:43008
  s_waitcnt lgkmcnt(2)
  v_mfma_f32_32x32x16_bf16 v[240:255], a[88:91], v[40:43], v[240:255]
  ds_read_b128 v[36:39], v204 offset:43008
  s_waitcnt lgkmcnt(2)
  v_mfma_f32_32x32x16_bf16 v[240:255], a[92:95], v[44:47], v[240:255]
  ds_read_b128 v[40:43], v205 offset:43008
  s_waitcnt lgkmcnt(2)
  v_mfma_f32_32x32x16_bf16 v[240:255], a[96:99], v[32:35], v[240:255]
  ds_read_b128 v[44:47], v206 offset:43008
  s_waitcnt lgkmcnt(2)
  v_mfma_f32_32x32x16_bf16 v[240:255], a[100:103], v[36:39], v[240:255]
  ds_read_b128 v[32:35], v203 offset:44032
  s_waitcnt lgkmcnt(2)
  v_mfma_f32_32x32x16_bf16 v[240:255], a[104:107], v[40:43], v[240:255]
  ds_read_b128 v[36:39], v204 offset:44032
  s_waitcnt lgkmcnt(2)
  v_mfma_f32_32x32x16_bf16 v[240:255], a[108:111], v[44:47], v[240:255]
  ds_read_b128 v[40:43], v205 offset:44032
  s_waitcnt lgkmcnt(2)
  v_mfma_f32_32x32x16_bf16 v[240:255], a[112:115], v[32:35], v[240:255]
  ds_read_b128 v[44:47], v206 offset:44032
  s_waitcnt lgkmcnt(2)
  v_mfma_f32_32x32x16_bf16 v[240:255], a[116:119], v[36:39], v[240:255]
  ds_read_b128 v[32:35], v203 offset:45056
  s_waitcnt lgkmcnt(2)
  v_mfma_f32_32x32x16_bf16 v[240:255], a[120:123], v[40:43], v[240:255]
  ds_read_b128 v[36:39], v204 offset:45056
  s_waitcnt lgkmcnt(2)
  v_mfma_f32_32x32x16_bf16 v[240:255], a[124:127], v[44:47], v[240:255]
  ds_read_b128 v[40:43], v205 offset:45056
  s_waitcnt lgkmcnt(2)
  v_mfma_f32_32x32x16_bf16 v[240:255], a[128:131], v[32:35], v[240:255]
  ds_read_b128 v[44:47], v206 offset:45056
  s_waitcnt lgkmcnt(2)
  v_mfma_f32_32x32x16_bf16 v[240:255], a[132:135], v[36:39], v[240:255]
  s_waitcnt lgkmcnt(1)
  v_mfma_f32_32x32x16_bf16 v[240:255], a[136:139], v[40:43], v[240:255]
  s_waitcnt lgkmcnt(0)
  v_mfma_f32_32x32x16_bf16 v[240:255], a[140:143], v[44:47], v[240:255]
  s_nop 11
  v_cvt_pk_bf16_f32 v16, v240, v244
  v_cvt_pk_bf16_f32 v17, v241, v245
  v_cvt_pk_bf16_f32 v18, v242, v246
  v_cvt_pk_bf16_f32 v19, v243, v247
  ds_write_b128 v215, v[16:19] offset:0
  v_cvt_pk_bf16_f32 v20, v248, v252
  v_cvt_pk_bf16_f32 v21, v249, v253
  v_cvt_pk_bf16_f32 v22, v250, v254
  v_cvt_pk_bf16_f32 v23, v251, v255
  ds_write_b128 v215, v[20:23] offset:1024
  s_waitcnt lgkmcnt(0)
  s_barrier
  ds_read_b128 a[144:147], v208 offset:0
  ds_read_b128 a[148:151], v208 offset:1024
  ds_read_b128 a[152:155], v208 offset:2048
  ds_read_b128 a[156:159], v208 offset:3072
  ds_read_b128 a[160:163], v208 offset:4096
  ds_read_b128 a[164:167], v208 offset:5120
  ds_read_b128 a[168:171], v208 offset:6144
  ds_read_b128 a[172:175], v208 offset:7168
  s_waitcnt vmcnt(11)
  v_cmp_eq_u32 vcc, -1, v172
  s_mov_b32 s69, 0
  s_cbranch_vccnz AT_e1
  s_mov_b32 s69, 1
  buffer_load_dwordx4 v[172:175], v201, s[8:11], s73 offen sc1
AT_e1:
  s_waitcnt lgkmcnt(7)
  v_mfma_f32_32x32x16_bf16 v[64:79], v[128:131], a[144:147], v[48:63]
  s_waitcnt lgkmcnt(6)
  v_mfma_f32_32x32x16_bf16 v[64:79], v[132:135], a[148:151], v[64:79]
  s_waitcnt lgkmcnt(5)
  v_mfma_f32_32x32x16_bf16 v[64:79], v[136:139], a[152:155], v[64:79]
  s_waitcnt lgkmcnt(4)
  v_mfma_f32_32x32x16_bf16 v[64:79], v[140:143], a[156:159], v[64:79]
  s_waitcnt lgkmcnt(3)
  v_mfma_f32_32x32x16_bf16 v[64:79], v[144:147], a[160:163], v[64:79]
  s_waitcnt lgkmcnt(2)
  v_mfma_f32_32x32x16_bf16 v[64:79], v[148:151], a[164:167], v[64:79]
  s_waitcnt lgkmcnt(1)
  v_mfma_f32_32x32x16_bf16 v[64:79], v[152:155], a[168:171], v[64:79]
  s_waitcnt lgkmcnt(0)
  v_mfma_f32_32x32x16_bf16 v[64:79], v[156:159], a[172:175], v[64:79]
  s_nop 11
  v_max3_f32 v184, v64, v65, v66
  v_max3_f32 v184, v184, v67, v68
  v_max3_f32 v184, v184, v69, v70
  v_max3_f32 v184, v184, v71, v72
  v_max3_f32 v184, v184, v73, v74
  v_max3_f32 v184, v184, v75, v76
  v_max3_f32 v184, v184, v77, v78
  v_max_f32 v184, v184, v79
  v_mov_b32 v185, v184
  s_nop 1
  v_permlane32_swap_b32 v184, v185
  v_max_f32 v184, v184, v185
  v_sub_f32 v64, v64, v184
  v_sub_f32 v65, v65, v184
  v_sub_f32 v66, v66, v184
  v_sub_f32 v67, v67, v184
  v_sub_f32 v68, v68, v184
  v_sub_f32 v69, v69, v184
  v_sub_f32 v70, v70, v184
  v_sub_f32 v71, v71, v184
  v_sub_f32 v72, v72, v184
  v_sub_f32 v73, v73, v184
  v_sub_f32 v74, v74, v184
  v_sub_f32 v75, v75, v184
  v_sub_f32 v76, v76, v184
  v_sub_f32 v77, v77, v184
  v_sub_f32 v78, v78, v184
  v_sub_f32 v79, v79, v184
  v_exp_f32 v64, v64
  v_exp_f32 v65, v65
  v_exp_f32 v66, v66
  v_exp_f32 v67, v67
  v_exp_f32 v68, v68
  v_exp_f32 v69, v69
  v_exp_f32 v70, v70
  v_exp_f32 v71, v71
  v_exp_f32 v72, v72
  v_exp_f32 v73, v73
  v_exp_f32 v74, v74
  v_exp_f32 v75, v75
  v_exp_f32 v76, v76
  v_exp_f32 v77, v77
  v_exp_f32 v78, v78
  v_exp_f32 v79, v79
  v_cvt_pk_bf16_f32 v20, v64, v65
  v_cvt_pk_bf16_f32 v21, v68, v69
  v_cvt_pk_bf16_f32 v22, v72, v73
  v_cvt_pk_bf16_f32 v23, v76, v77
  v_cvt_pk_bf16_f32 v24, v66, v67
  v_cvt_pk_bf16_f32 v25, v70, v71
  v_cvt_pk_bf16_f32 v26, v74, v75
  v_cvt_pk_bf16_f32 v27, v78, v79
  v_mfma_f32_32x32x16_bf16 v[224:239], v[160:163], v[20:23], 0
  v_add_f32 v186, v64, v65
  v_add_f32 v186, v186, v66
  v_add_f32 v186, v186, v67
  v_add_f32 v186, v186, v68
  v_add_f32 v186, v186, v69
  v_add_f32 v186, v186, v70
  v_add_f32 v186, v186, v71
  v_mfma_f32_32x32x16_bf16 v[224:239], v[164:167], v[24:27], v[224:239]
  v_add_f32 v186, v186, v72
  v_add_f32 v186, v186, v73
  v_add_f32 v186, v186, v74
  v_add_f32 v186, v186, v75
  v_add_f32 v186, v186, v76
  v_add_f32 v186, v186, v77
  v_add_f32 v186, v186, v78
  v_add_f32 v186, v186, v79
AT_l0:
  s_cmp_eq_u32 s69, 1
  s_cbranch_scc1 AT_v0
  s_cmp_ge_u32 s74, 62
  s_cbranch_scc1 AT_k0
  s_branch AT_c0
AT_h0:
  s_sleep 2
AT_c0:
  buffer_load_dword v172, off, s[8:11], s70 sc1
  s_add_u32 s65, s65, 1
  s_cmp_lt_u32 s65, 131072
  s_cselect_b32 s54, -2, -1
  s_waitcnt vmcnt(0)
  v_cmp_lt_u32 vcc, s54, v172
  s_cbranch_vccnz AT_h0
AT_k0:
  buffer_load_dwordx4 v[172:175], v201, s[8:11], s73 offen sc1
AT_v0:
  s_mov_b32 s69, 0
  s_add_u32 s65, s65, 1
  s_cmp_lt_u32 s65, 131072
  s_cselect_b32 s54, -2, -1
  s_waitcnt vmcnt(0)
  ds_write_b64 v220, v[172:173] offset:0
  ds_write_b64 v221, v[174:175] offset:0
  v_max3_u32 v213, v172, v173, v174
  v_max_u32 v213, v213, v175
  v_cmp_lt_u32 vcc, s54, v213
  s_cbranch_vccnz AT_k0
  s_waitcnt lgkmcnt(0)
  s_barrier
  ds_read_b128 v[128:131], v218 offset:0
  ds_read_b128 v[132:135], v218 offset:256
  ds_read_b128 v[136:139], v218 offset:512
  ds_read_b128 v[140:143], v218 offset:768
  ds_read_b128 v[144:147], v218 offset:1024
  ds_read_b128 v[148:151], v218 offset:1280
  ds_read_b128 v[152:155], v218 offset:1536
  ds_read_b128 v[156:159], v218 offset:1792
  ds_read_b32 v168, v219 offset:0
  ds_read_b32 v169, v219 offset:128
  s_waitcnt lgkmcnt(9)
  v_mfma_f32_32x32x16_bf16 v[80:95], v[128:131], v[96:99], 0
  s_waitcnt lgkmcnt(8)
  v_mfma_f32_32x32x16_bf16 v[80:95], v[132:135], v[100:103], v[80:95]
  s_waitcnt lgkmcnt(7)
  v_mfma_f32_32x32x16_bf16 v[80:95], v[136:139], v[104:107], v[80:95]
  s_waitcnt lgkmcnt(6)
  v_mfma_f32_32x32x16_bf16 v[80:95], v[140:143], v[108:111], v[80:95]
  s_waitcnt lgkmcnt(5)
  v_mfma_f32_32x32x16_bf16 v[80:95], v[144:147], v[112:115], v[80:95]
  s_waitcnt lgkmcnt(4)
  v_mfma_f32_32x32x16_bf16 v[80:95], v[148:151], v[116:119], v[80:95]
  s_waitcnt lgkmcnt(3)
  v_mfma_f32_32x32x16_bf16 v[80:95], v[152:155], v[120:123], v[80:95]
  s_waitcnt lgkmcnt(2)
  v_mfma_f32_32x32x16_bf16 v[80:95], v[156:159], v[124:127], v[80:95]
  s_add_u32 s74, s74, 2
  v_mov_b32 v212, s74
  s_nop 9
  v_mul_f32 v80, s68, v80
  v_mul_f32 v81, s68, v81
  v_mul_f32 v82, s68, v82
  v_mul_f32 v83, s68, v83
  v_max3_f32 v84, v180, v80, v81
  v_max3_f32 v84, v84, v82, v83
  v_mov_b32 v85, v84
  s_nop 1
  v_permlane32_swap_b32 v84, v85
  v_max_f32 v84, v84, v85
  v_sub_f32 v86, v180, v84
  v_sub_f32 v80, v80, v84
  v_sub_f32 v81, v81, v84
  v_sub_f32 v82, v82, v84
  v_sub_f32 v83, v83, v84
  v_exp_f32 v86, v86
  v_exp_f32 v80, v80
  v_exp_f32 v81, v81
  v_exp_f32 v82, v82
  v_exp_f32 v83, v83
  v_fma_f32 v182, v182, v86, v80
  v_add_f32 v84, v81, v82
  v_add_f32 v182, v182, v83
  v_add_f32 v182, v182, v84
  v_mov_b32 v183, v182
  s_nop 1
  v_permlane32_swap_b32 v182, v183
  v_add_f32 v182, v182, v183
  v_rcp_f32 v182, v182
  s_nop 0
  v_mul_f32 v86, v86, v182
  v_mul_f32 v80, v182, v80
  v_mul_f32 v81, v182, v81
  v_mul_f32 v82, v182, v82
  v_mul_f32 v83, v182, v83
  v_cvt_pk_bf16_f32 v28, v80, v81
  v_cvt_pk_bf16_f32 v29, v82, v83
  v_mul_f32 v0, v86, v0
  v_mul_f32 v1, v86, v1
  v_mul_f32 v2, v86, v2
  v_mul_f32 v3, v86, v3
  v_mul_f32 v4, v86, v4
  v_mul_f32 v5, v86, v5
  v_mul_f32 v6, v86, v6
  v_mul_f32 v7, v86, v7
  v_mul_f32 v8, v86, v8
  v_mul_f32 v9, v86, v9
  v_mul_f32 v10, v86, v10
  v_mul_f32 v11, v86, v11
  v_mul_f32 v12, v86, v12
  v_mul_f32 v13, v86, v13
  v_mul_f32 v14, v86, v14
  v_mul_f32 v15, v86, v15
  s_waitcnt lgkmcnt(0)
  s_nop 0
  v_mfma_f32_32x32x8_bf16 v[0:15], v[168:169], v[28:29], v[0:15]
  s_nop 11
  v_cvt_pk_bf16_f32 v20, v0, v1
  v_cvt_pk_bf16_f32 v21, v2, v3
  v_cvt_pk_bf16_f32 v22, v4, v5
  v_cvt_pk_bf16_f32 v23, v6, v7
  buffer_store_dwordx4 v[20:23], v201, s[8:11], s72 offen offset:0 sc1
  v_cvt_pk_bf16_f32 v24, v8, v9
  v_cvt_pk_bf16_f32 v25, v10, v11
  v_cvt_pk_bf16_f32 v26, v12, v13
  v_cvt_pk_bf16_f32 v27, v14, v15
  buffer_store_dwordx4 v[24:27], v201, s[8:11], s72 offen offset:1024 sc1
  s_mov_b64 exec, 1
  buffer_store_dword v212, v201, s[8:11], s71 offen sc1
  s_mov_b64 exec, -1
  s_cmp_ge_u32 s74, 64
  s_cbranch_scc1 L_exit
  s_cmp_ge_u32 s59, 64
  s_cbranch_scc1 AT_l1
  s_mov_b32 s74, s59
  s_mul_i32 s66, s59, 655360
  s_lshl_b32 s55, s58, 14
  s_add_u32 s55, s55, s66
  s_add_u32 s55, s55, 1048576
  s_lshl_b32 s73, s58, 2
  s_add_u32 s73, s73, s52
  s_lshl_b32 s72, s59, 7
  s_add_u32 s72, s72, s73
  s_lshl_b32 s72, s72, 11
  s_add_u32 s72, s72, 46137344
  s_lshl_b32 s73, s73, 10
  s_add_u32 s73, s73, s66
  s_add_u32 s73, s73, 1572864
  s_add_u32 s59, s59, 2
  buffer_load_dwordx4 v[128:131], v216, s[8:11], s55 offen offset:0 sc1
  buffer_load_dwordx4 v[132:135], v216, s[8:11], s55 offen offset:256 sc1
  buffer_load_dwordx4 v[136:139], v216, s[8:11], s55 offen offset:512 sc1
  buffer_load_dwordx4 v[140:143], v216, s[8:11], s55 offen offset:768 sc1
  buffer_load_dwordx4 v[144:147], v216, s[8:11], s55 offen offset:1024 sc1
  buffer_load_dwordx4 v[148:151], v216, s[8:11], s55 offen offset:1280 sc1
  buffer_load_dwordx4 v[152:155], v216, s[8:11], s55 offen offset:1536 sc1
  buffer_load_dwordx4 v[156:159], v216, s[8:11], s55 offen offset:1792 sc1
  buffer_load_dwordx4 v[160:163], v217, s[8:11], s55 offen offset:0 sc1
  buffer_load_dwordx4 v[164:167], v217, s[8:11], s55 offen offset:256 sc1
  s_or_b32 s70, s76, 0xc00
  buffer_load_dword v172, off, s[8:11], s70 sc1
  s_add_u32 s60, s60, 73728
  ds_read_b128 v[32:35], v203 offset:0
  ds_read_b128 v[36:39], v204 offset:0
  ds_read_b128 v[40:43], v205 offset:0
  s_waitcnt lgkmcnt(2)
  v_mfma_f32_32x32x16_bf16 v[240:255], a[0:3], v[32:35], 0
  ds_read_b128 v[44:47], v206 offset:0
  s_add_u32 m0, s67, 36864
  s_nop 0
  buffer_load_dwordx4 v202, s[4:7], s60 offen offset:0 lds
  s_waitcnt lgkmcnt(2)
  v_mfma_f32_32x32x16_bf16 v[240:255], a[4:7], v[36:39], v[240:255]
  ds_read_b128 v[32:35], v203 offset:1024
  s_waitcnt lgkmcnt(2)
  v_mfma_f32_32x32x16_bf16 v[240:255], a[8:11], v[40:43], v[240:255]
  ds_read_b128 v[36:39], v204 offset:1024
  s_add_u32 m0, s67, 37760
  s_nop 0
  buffer_load_dwordx4 v202, s[4:7], s60 offen offset:128 lds
  s_waitcnt lgkmcnt(2)
  v_mfma_f32_32x32x16_bf16 v[240:255], a[12:15], v[44:47], v[240:255]
  ds_read_b128 v[40:43], v205 offset:1024
  s_waitcnt lgkmcnt(2)
  v_mfma_f32_32x32x16_bf16 v[240:255], a[16:19], v[32:35], v[240:255]
  ds_read_b128 v[44:47], v206 offset:1024
  s_add_u32 m0, s67, 38656
  s_nop 0
  buffer_load_dwordx4 v202, s[4:7], s60 offen offset:256 lds
  s_waitcnt lgkmcnt(2)
  v_mfma_f32_32x32x16_bf16 v[240:255], a[20:23], v[36:39], v[240:255]
  ds_read_b128 v[32:35], v203 offset:2048
  s_waitcnt lgkmcnt(2)
  v_mfma_f32_32x32x16_bf16 v[240:255], a[24:27], v[40:43], v[240:255]
  ds_read_b128 v[36:39], v204 offset:2048
  s_add_u32 m0, s67, 39552
  s_nop 0
  buffer_load_dwordx4 v202, s[4:7], s60 offen offset:384 lds
  s_waitcnt lgkmcnt(2)
  v_mfma_f32_32x32x16_bf16 v[240:255], a[28:31], v[44:47], v[240:255]
  ds_read_b128 v[40:43], v205 offset:2048
  s_waitcnt lgkmcnt(2)
  v_mfma_f32_32x32x16_bf16 v[240:255], a[32:35], v[32:35], v[240:255]
  ds_read_b128 v[44:47], v206 offset:2048
  s_add_u32 m0, s67, 40448
  s_nop 0
  buffer_load_dwordx4 v202, s[4:7], s60 offen offset:512 lds
  s_waitcnt lgkmcnt(2)
  v_mfma_f32_32x32x16_bf16 v[240:255], a[36:39], v[36:39], v[240:255]
  ds_read_b128 v[32:35], v203 offset:3072
  s_waitcnt lgkmcnt(2)
  v_mfma_f32_32x32x16_bf16 v[240:255], a[40:43], v[40:43], v[240:255]
  ds_read_b128 v[36:39], v204 offset:3072
  s_add_u32 m0, s67, 41344
  s_nop 0
  buffer_load_dwordx4 v202, s[4:7], s60 offen offset:640 lds
  s_waitcnt lgkmcnt(2)
  v_mfma_f32_32x32x16_bf16 v[240:255], a[44:47], v[44:47], v[240:255]
  ds_read_b128 v[40:43], v205 offset:3072
  s_waitcnt lgkmcnt(2)
  v_mfma_f32_32x32x16_bf16 v[240:255], a[48:51], v[32:35], v[240:255]
  ds_read_b128 v[44:47], v206 offset:3072
  s_add_u32 m0, s67, 42240
  s_nop 0
  buffer_load_dwordx4 v202, s[4:7], s60 offen offset:768 lds
  s_waitcnt lgkmcnt(2)
  v_mfma_f32_32x32x16_bf16 v[240:255], a[52:55], v[36:39], v[240:255]
  ds_read_b128 v[32:35], v203 offset:4096
  s_waitcnt lgkmcnt(2)
  v_mfma_f32_32x32x16_bf16 v[240:255], a[56:59], v[40:43], v[240:255]
  ds_read_b128 v[36:39], v204 offset:4096
  s_add_u32 m0, s67, 43136
  s_nop 0
  buffer_load_dwordx4 v202, s[4:7], s60 offen offset:896 lds
  s_waitcnt lgkmcnt(2)
  v_mfma_f32_32x32x16_bf16 v[240:255], a[60:63], v[44:47], v[240:255]
  ds_read_b128 v[40:43], v205 offset:4096
  s_waitcnt lgkmcnt(2)
  v_mfma_f32_32x32x16_bf16 v[240:255], a[64:67], v[32:35], v[240:255]
  ds_read_b128 v[44:47], v206 offset:4096
  s_add_u32 m0, s67, 44032
  s_nop 0
  buffer_load_dwordx4 v202, s[4:7], s60 offen offset:1024 lds
  s_waitcnt lgkmcnt(2)
  v_mfma_f32_32x32x16_bf16 v[240:255], a[68:71], v[36:39], v[240:255]
  ds_read_b128 v[32:35], v203 offset:5120
  s_waitcnt lgkmcnt(2)
  v_mfma_f32_32x32x16_bf16 v[240:255], a[72:75], v[40:43], v[240:255]
  ds_read_b128 v[36:39], v204 offset:5120
  buffer_store_dwordx4 v[176:179], v201, s[8:11], s72 offen offset:0 sc1
  s_waitcnt lgkmcnt(2)
  v_mfma_f32_32x32x16_bf16 v[240:255], a[76:79], v[44:47], v[240:255]
  ds_read_b128 v[40:43], v205 offset:5120
  s_waitcnt lgkmcnt(2)
  v_mfma_f32_32x32x16_bf16 v[240:255], a[80:83], v[32:35], v[240:255]
  ds_read_b128 v[44:47], v206 offset:5120
  buffer_store_dwordx4 v[176:179], v201, s[8:11], s72 offen offset:1024 sc1
  s_waitcnt lgkmcnt(2)
  v_mfma_f32_32x32x16_bf16 v[240:255], a[84:87], v[36:39], v[240:255]
  ds_read_b128 v[32:35], v203 offset:6144
  s_waitcnt lgkmcnt(2)
  v_mfma_f32_32x32x16_bf16 v[240:255], a[88:91], v[40:43], v[240:255]
  ds_read_b128 v[36:39], v204 offset:6144
  s_waitcnt lgkmcnt(2)
  v_mfma_f32_32x32x16_bf16 v[240:255], a[92:95], v[44:47], v[240:255]
  ds_read_b128 v[40:43], v205 offset:6144
  s_waitcnt lgkmcnt(2)
  v_mfma_f32_32x32x16_bf16 v[240:255], a[96:99], v[32:35], v[240:255]
  ds_read_b128 v[44:47], v206 offset:6144
  s_waitcnt lgkmcnt(2)
  v_mfma_f32_32x32x16_bf16 v[240:255], a[100:103], v[36:39], v[240:255]
  ds_read_b128 v[32:35], v203 offset:7168
  s_waitcnt lgkmcnt(2)
  v_mfma_f32_32x32x16_bf16 v[240:255], a[104:107], v[40:43], v[240:255]
  ds_read_b128 v[36:39], v204 offset:7168
  s_waitcnt lgkmcnt(2)
  v_mfma_f32_32x32x16_bf16 v[240:255], a[108:111], v[44:47], v[240:255]
  ds_read_b128 v[40:43], v205 offset:7168
  s_waitcnt lgkmcnt(2)
  v_mfma_f32_32x32x16_bf16 v[240:255], a[112:115], v[32:35], v[240:255]
  ds_read_b128 v[44:47], v206 offset:7168
  s_waitcnt lgkmcnt(2)
  v_mfma_f32_32x32x16_bf16 v[240:255], a[116:119], v[36:39], v[240:255]
  ds_read_b128 v[32:35], v203 offset:8192
  s_waitcnt lgkmcnt(2)
  v_mfma_f32_32x32x16_bf16 v[240:255], a[120:123], v[40:43], v[240:255]
  ds_read_b128 v[36:39], v204 offset:8192
  s_waitcnt lgkmcnt(2)
  v_mfma_f32_32x32x16_bf16 v[240:255], a[124:127], v[44:47], v[240:255]
  ds_read_b128 v[40:43], v205 offset:8192
  s_waitcnt lgkmcnt(2)
  v_mfma_f32_32x32x16_bf16 v[240:255], a[128:131], v[32:35], v[240:255]
  ds_read_b128 v[44:47], v206 offset:8192
  s_waitcnt lgkmcnt(2)
  v_mfma_f32_32x32x16_bf16 v[240:255], a[132:135], v[36:39], v[240:255]
  s_waitcnt lgkmcnt(1)
  v_mfma_f32_32x32x16_bf16 v[240:255], a[136:139], v[40:43], v[240:255]
  s_waitcnt lgkmcnt(0)
  v_mfma_f32_32x32x16_bf16 v[240:255], a[140:143], v[44:47], v[240:255]
  s_nop 11
  v_cvt_pk_bf16_f32 v16, v240, v244
  v_cvt_pk_bf16_f32 v17, v241, v245
  v_cvt_pk_bf16_f32 v18, v242, v246
  v_cvt_pk_bf16_f32 v19, v243, v247
  ds_write_b128 v215, v[16:19] offset:0
  v_cvt_pk_bf16_f32 v20, v248, v252
  v_cvt_pk_bf16_f32 v21, v249, v253
  v_cvt_pk_bf16_f32 v22, v250, v254
  v_cvt_pk_bf16_f32 v23, v251, v255
  ds_write_b128 v215, v[20:23] offset:1024
  s_waitcnt lgkmcnt(0)
  s_barrier
  ds_read_b128 v[96:99], v208 offset:0
  ds_read_b128 v[100:103], v208 offset:1024
  ds_read_b128 v[104:107], v208 offset:2048
  ds_read_b128 v[108:111], v208 offset:3072
  ds_read_b128 v[112:115], v208 offset:4096
  ds_read_b128 v[116:119], v208 offset:5120
  ds_read_b128 v[120:123], v208 offset:6144
  ds_read_b128 v[124:127], v208 offset:7168
  s_waitcnt vmcnt(11)
  v_cmp_eq_u32 vcc, -1, v172
  s_mov_b32 s69, 0
  s_cbranch_vccnz AT_e0
  s_mov_b32 s69, 1
  buffer_load_dwordx4 v[172:175], v201, s[8:11], s76 offen sc1
AT_e0:
  s_waitcnt lgkmcnt(7)
  v_mfma_f32_32x32x16_bf16 v[64:79], v[128:131], v[96:99], v[48:63]
  s_waitcnt lgkmcnt(6)
  v_mfma_f32_32x32x16_bf16 v[64:79], v[132:135], v[100:103], v[64:79]
  s_waitcnt lgkmcnt(5)
  v_mfma_f32_32x32x16_bf16 v[64:79], v[136:139], v[104:107], v[64:79]
  s_waitcnt lgkmcnt(4)
  v_mfma_f32_32x32x16_bf16 v[64:79], v[140:143], v[108:111], v[64:79]
  s_waitcnt lgkmcnt(3)
  v_mfma_f32_32x32x16_bf16 v[64:79], v[144:147], v[112:115], v[64:79]
  s_waitcnt lgkmcnt(2)
  v_mfma_f32_32x32x16_bf16 v[64:79], v[148:151], v[116:119], v[64:79]
  s_waitcnt lgkmcnt(1)
  v_mfma_f32_32x32x16_bf16 v[64:79], v[152:155], v[120:123], v[64:79]
  s_waitcnt lgkmcnt(0)
  v_mfma_f32_32x32x16_bf16 v[64:79], v[156:159], v[124:127], v[64:79]
  s_nop 11
  v_max3_f32 v180, v64, v65, v66
  v_max3_f32 v180, v180, v67, v68
  v_max3_f32 v180, v180, v69, v70
  v_max3_f32 v180, v180, v71, v72
  v_max3_f32 v180, v180, v73, v74
  v_max3_f32 v180, v180, v75, v76
  v_max3_f32 v180, v180, v77, v78
  v_max_f32 v180, v180, v79
  v_mov_b32 v181, v180
  s_nop 1
  v_permlane32_swap_b32 v180, v181
  v_max_f32 v180, v180, v181
  v_sub_f32 v64, v64, v180
  v_sub_f32 v65, v65, v180
  v_sub_f32 v66, v66, v180
  v_sub_f32 v67, v67, v180
  v_sub_f32 v68, v68, v180
  v_sub_f32 v69, v69, v180
  v_sub_f32 v70, v70, v180
  v_sub_f32 v71, v71, v180
  v_sub_f32 v72, v72, v180
  v_sub_f32 v73, v73, v180
  v_sub_f32 v74, v74, v180
  v_sub_f32 v75, v75, v180
  v_sub_f32 v76, v76, v180
  v_sub_f32 v77, v77, v180
  v_sub_f32 v78, v78, v180
  v_sub_f32 v79, v79, v180
  v_exp_f32 v64, v64
  v_exp_f32 v65, v65
  v_exp_f32 v66, v66
  v_exp_f32 v67, v67
  v_exp_f32 v68, v68
  v_exp_f32 v69, v69
  v_exp_f32 v70, v70
  v_exp_f32 v71, v71
  v_exp_f32 v72, v72
  v_exp_f32 v73, v73
  v_exp_f32 v74, v74
  v_exp_f32 v75, v75
  v_exp_f32 v76, v76
  v_exp_f32 v77, v77
  v_exp_f32 v78, v78
  v_exp_f32 v79, v79
  v_cvt_pk_bf16_f32 v20, v64, v65
  v_cvt_pk_bf16_f32 v21, v68, v69
  v_cvt_pk_bf16_f32 v22, v72, v73
  v_cvt_pk_bf16_f32 v23, v76, v77
  v_cvt_pk_bf16_f32 v24, v66, v67
  v_cvt_pk_bf16_f32 v25, v70, v71
  v_cvt_pk_bf16_f32 v26, v74, v75
  v_cvt_pk_bf16_f32 v27, v78, v79
  v_mfma_f32_32x32x16_bf16 v[0:15], v[160:163], v[20:23], 0
  v_add_f32 v182, v64, v65
  v_add_f32 v182, v182, v66
  v_add_f32 v182, v182, v67
  v_add_f32 v182, v182, v68
  v_add_f32 v182, v182, v69
  v_add_f32 v182, v182, v70
  v_add_f32 v182, v182, v71
  v_mfma_f32_32x32x16_bf16 v[0:15], v[164:167], v[24:27], v[0:15]
  v_add_f32 v182, v182, v72
  v_add_f32 v182, v182, v73
  v_add_f32 v182, v182, v74
  v_add_f32 v182, v182, v75
  v_add_f32 v182, v182, v76
  v_add_f32 v182, v182, v77
  v_add_f32 v182, v182, v78
  v_add_f32 v182, v182, v79
AT_l1:
  s_cmp_eq_u32 s69, 1
  s_cbranch_scc1 AT_v1
  s_cmp_ge_u32 s77, 62
  s_cbranch_scc1 AT_k1
  s_branch AT_c1
AT_h1:
  s_sleep 2
AT_c1:
  buffer_load_dword v172, off, s[8:11], s70 sc1
  s_add_u32 s65, s65, 1
  s_cmp_lt_u32 s65, 131072
  s_cselect_b32 s54, -2, -1
  s_waitcnt vmcnt(0)
  v_cmp_lt_u32 vcc, s54, v172
  s_cbranch_vccnz AT_h1
AT_k1:
  buffer_load_dwordx4 v[172:175], v201, s[8:11], s76 offen sc1
AT_v1:
  s_mov_b32 s69, 0
  s_add_u32 s65, s65, 1
  s_cmp_lt_u32 s65, 131072
  s_cselect_b32 s54, -2, -1
  s_waitcnt vmcnt(0)
  ds_write_b64 v220, v[172:173] offset:4096
  ds_write_b64 v221, v[174:175] offset:4096
  v_max3_u32 v213, v172, v173, v174
  v_max_u32 v213, v213, v175
  v_cmp_lt_u32 vcc, s54, v213
  s_cbranch_vccnz AT_k1
  s_waitcnt lgkmcnt(0)
  s_barrier
  ds_read_b128 v[128:131], v218 offset:4096
  ds_read_b128 v[132:135], v218 offset:4352
  ds_read_b128 v[136:139], v218 offset:4608
  ds_read_b128 v[140:143], v218 offset:4864
  ds_read_b128 v[144:147], v218 offset:5120
  ds_read_b128 v[148:151], v218 offset:5376
  ds_read_b128 v[152:155], v218 offset:5632
  ds_read_b128 v[156:159], v218 offset:5888
  ds_read_b32 v168, v219 offset:4096
  ds_read_b32 v169, v219 offset:4224
  s_waitcnt lgkmcnt(9)
  v_mfma_f32_32x32x16_bf16 v[80:95], v[128:131], a[144:147], 0
  s_waitcnt lgkmcnt(8)
  v_mfma_f32_32x32x16_bf16 v[80:95], v[132:135], a[148:151], v[80:95]
  s_waitcnt lgkmcnt(7)
  v_mfma_f32_32x32x16_bf16 v[80:95], v[136:139], a[152:155], v[80:95]
  s_waitcnt lgkmcnt(6)
  v_mfma_f32_32x32x16_bf16 v[80:95], v[140:143], a[156:159], v[80:95]
  s_waitcnt lgkmcnt(5)
  v_mfma_f32_32x32x16_bf16 v[80:95], v[144:147], a[160:163], v[80:95]
  s_waitcnt lgkmcnt(4)
  v_mfma_f32_32x32x16_bf16 v[80:95], v[148:151], a[164:167], v[80:95]
  s_waitcnt lgkmcnt(3)
  v_mfma_f32_32x32x16_bf16 v[80:95], v[152:155], a[168:171], v[80:95]
  s_waitcnt lgkmcnt(2)
  v_mfma_f32_32x32x16_bf16 v[80:95], v[156:159], a[172:175], v[80:95]
  s_add_u32 s77, s77, 2
  v_mov_b32 v212, s77
  s_nop 9
  v_mul_f32 v80, s68, v80
  v_mul_f32 v81, s68, v81
  v_mul_f32 v82, s68, v82
  v_mul_f32 v83, s68, v83
  v_max3_f32 v84, v184, v80, v81
  v_max3_f32 v84, v84, v82, v83
  v_mov_b32 v85, v84
  s_nop 1
  v_permlane32_swap_b32 v84, v85
  v_max_f32 v84, v84, v85
  v_sub_f32 v86, v184, v84
  v_sub_f32 v80, v80, v84
  v_sub_f32 v81, v81, v84
  v_sub_f32 v82, v82, v84
  v_sub_f32 v83, v83, v84
  v_exp_f32 v86, v86
  v_exp_f32 v80, v80
  v_exp_f32 v81, v81
  v_exp_f32 v82, v82
  v_exp_f32 v83, v83
  v_fma_f32 v186, v186, v86, v80
  v_add_f32 v84, v81, v82
  v_add_f32 v186, v186, v83
  v_add_f32 v186, v186, v84
  v_mov_b32 v187, v186
  s_nop 1
  v_permlane32_swap_b32 v186, v187
  v_add_f32 v186, v186, v187
  v_rcp_f32 v186, v186
  s_nop 0
  v_mul_f32 v86, v86, v186
  v_mul_f32 v80, v186, v80
  v_mul_f32 v81, v186, v81
  v_mul_f32 v82, v186, v82
  v_mul_f32 v83, v186, v83
  v_cvt_pk_bf16_f32 v28, v80, v81
  v_cvt_pk_bf16_f32 v29, v82, v83
  v_mul_f32 v224, v86, v224
  v_mul_f32 v225, v86, v225
  v_mul_f32 v226, v86, v226
  v_mul_f32 v227, v86, v227
  v_mul_f32 v228, v86, v228
  v_mul_f32 v229, v86, v229
  v_mul_f32 v230, v86, v230
  v_mul_f32 v231, v86, v231
  v_mul_f32 v232, v86, v232
  v_mul_f32 v233, v86, v233
  v_mul_f32 v234, v86, v234
  v_mul_f32 v235, v86, v235
  v_mul_f32 v236, v86, v236
  v_mul_f32 v237, v86, v237
  v_mul_f32 v238, v86, v238
  v_mul_f32 v239, v86, v239
  s_waitcnt lgkmcnt(0)
  s_nop 0
  v_mfma_f32_32x32x8_bf16 v[224:239], v[168:169], v[28:29], v[224:239]
  s_nop 11
  v_cvt_pk_bf16_f32 v20, v224, v225
  v_cvt_pk_bf16_f32 v21, v226, v227
  v_cvt_pk_bf16_f32 v22, v228, v229
  v_cvt_pk_bf16_f32 v23, v230, v231
  buffer_store_dwordx4 v[20:23], v201, s[8:11], s75 offen offset:0 sc1
  v_cvt_pk_bf16_f32 v24, v232, v233
  v_cvt_pk_bf16_f32 v25, v234, v235
  v_cvt_pk_bf16_f32 v26, v236, v237
  v_cvt_pk_bf16_f32 v27, v238, v239
  buffer_store_dwordx4 v[24:27], v201, s[8:11], s75 offen offset:1024 sc1
  s_mov_b64 exec, 1
  buffer_store_dword v212, v201, s[8:11], s71 offen sc1
  s_mov_b64 exec, -1
  s_cmp_ge_u32 s77, 64
  s_cbranch_scc1 L_exit
  s_branch AT_loop
L_cexit:
L_exit:
L_end:
s_endpgm
.section .rodata,"a"
.p2align 6
.amdhsa_kernel gated_mix__sliding_local_dilated__memory_aug_recurrent_mem_tr__prompt_kernel
  .amdhsa_next_free_vgpr 512
  .amdhsa_next_free_sgpr 102
  .amdhsa_accum_offset 256
  .amdhsa_group_segment_fixed_size 0
  .amdhsa_kernarg_size 112
  .amdhsa_user_sgpr_count 2
  .amdhsa_user_sgpr_kernarg_segment_ptr 1
  .amdhsa_system_sgpr_workgroup_id_x 1
.end_amdhsa_kernel
```

```asm
; @launch grid=(256,1,1) block=(256,1,1) lds=163840
.amdgcn_target "amdgcn-amd-amdhsa--gfx950"
.text
.globl gated_mix__sliding_local_dilated__memory_aug_recurrent_mem_tr__prompt_kernel
.p2align 8
.type gated_mix__sliding_local_dilated__memory_aug_recurrent_mem_tr__prompt_kernel,@function
gated_mix__sliding_local_dilated__memory_aug_recurrent_mem_tr__prompt_kernel:
  s_cmp_ge_u32 s2, 256
  s_cbranch_scc1 L_end
  s_load_dwordx2 s[4:5], s[0:1], 0
  s_load_dwordx2 s[8:9], s[0:1], 104
  s_load_dwordx2 s[12:13], s[0:1], 96
  s_load_dwordx2 s[16:17], s[0:1], 40
  s_load_dwordx2 s[20:21], s[0:1], 48
  s_load_dwordx2 s[24:25], s[0:1], 56
  s_load_dwordx2 s[28:29], s[0:1], 64
  s_load_dwordx2 s[32:33], s[0:1], 32
  s_load_dwordx2 s[36:37], s[0:1], 8
  s_load_dwordx2 s[40:41], s[0:1], 16
  s_load_dwordx2 s[44:45], s[0:1], 80
  s_load_dwordx2 s[48:49], s[0:1], 88
  s_getreg_b32 s54, hwreg(HW_REG_XCC_ID, 0, 3)
  v_lshrrev_b32 v1, 6, v0
  s_nop 0
  v_readfirstlane_b32 s52, v1
  s_mov_b32 s6, 2359296
  s_mov_b32 s7, 0x20000
  s_mov_b32 s10, 268435456
  s_mov_b32 s11, 0x20000
  s_mov_b32 s14, 256
  s_mov_b32 s15, 0x20000
  s_mov_b32 s18, 4718592
  s_mov_b32 s19, 0x20000
  s_mov_b32 s22, 4718592
  s_mov_b32 s23, 0x20000
  s_mov_b32 s26, 4718592
  s_mov_b32 s27, 0x20000
  s_mov_b32 s30, 4718592
  s_mov_b32 s31, 0x20000
  s_mov_b32 s34, 9216
  s_mov_b32 s35, 0x20000
  s_mov_b32 s38, 1990656
  s_mov_b32 s39, 0x20000
  s_mov_b32 s42, 663552
  s_mov_b32 s43, 0x20000
  s_mov_b32 s46, 1152
  s_mov_b32 s47, 0x20000
  s_mov_b32 s50, 2359296
  s_mov_b32 s51, 0x20000
  s_waitcnt lgkmcnt(0)
  s_lshr_b32 s0, s2, 3
  s_mov_b32 s2, s54
  s_mov_b32 s1, 0
L_role:
  s_mov_b32 s53, s0
  s_cmp_eq_u32 s2, 0
  s_cbranch_scc0 L_worker
  v_and_b32 v0, 63, v0
  v_and_b32 v1, 15, v0
  v_lshrrev_b32 v2, 4, v0
  v_and_b32 v3, 1, v2
  s_lshl_b32 s54, s52, 1
  v_add_u32 v3, s54, v3
  v_lshlrev_b32 v3, 1, v3
  v_xor_b32 v3, v3, v1
  v_lshlrev_b32 v3, 4, v3
  v_lshl_add_u32 v8, v2, 13, v3
  s_lshl_b32 s78, s53, 8
  s_lshl_b32 s54, s52, 15
  s_add_u32 s78, s78, s54
  s_mul_i32 s79, s53, 147456
  s_lshl_b32 s57, s52, 10
  s_add_u32 s57, s57, 16384
  s_getpc_b64 s[80:81]
L_pc_1:
  s_and_b32 s55, s0, 1
  s_lshl_b32 s55, s55, 2
  s_add_u32 s55, s55, s52
  s_lshl_b32 s55, s55, 10
  v_and_b32 v199, 63, v0
  v_lshl_add_u32 v199, v199, 4, s55
  v_min_u32 v199, (L_w0 - L_pc_1), v199
  global_load_dword v196, v199, s[80:81]
  s_add_u32 m0, s57, 0
  s_add_u32 s54, s78, 0
  buffer_load_dwordx4 v8, s[16:19], s54 offen  lds
  s_add_u32 m0, s57, 4096
  s_add_u32 s54, s78, 131072
  buffer_load_dwordx4 v8, s[16:19], s54 offen  lds
  s_add_u32 m0, s57, 8192
  s_add_u32 s54, s78, 262144
  buffer_load_dwordx4 v8, s[16:19], s54 offen  lds
  s_add_u32 m0, s57, 12288
  s_add_u32 s54, s78, 393216
  buffer_load_dwordx4 v8, s[16:19], s54 offen  lds
  s_add_u32 m0, s57, 16384
  s_add_u32 s54, s78, 524288
  buffer_load_dwordx4 v8, s[16:19], s54 offen  lds
  s_add_u32 m0, s57, 20480
  s_add_u32 s54, s78, 655360
  buffer_load_dwordx4 v8, s[16:19], s54 offen  lds
  s_add_u32 m0, s57, 24576
  s_add_u32 s54, s78, 786432
  buffer_load_dwordx4 v8, s[16:19], s54 offen  lds
  s_add_u32 m0, s57, 28672
  s_add_u32 s54, s78, 917504
  buffer_load_dwordx4 v8, s[16:19], s54 offen  lds
  s_add_u32 m0, s57, 32768
  s_add_u32 s54, s78, 1048576
  buffer_load_dwordx4 v8, s[16:19], s54 offen  lds
  s_add_u32 m0, s57, 36864
  s_add_u32 s54, s78, 1179648
  buffer_load_dwordx4 v8, s[16:19], s54 offen  lds
  s_add_u32 m0, s57, 40960
  s_add_u32 s54, s78, 1310720
  buffer_load_dwordx4 v8, s[16:19], s54 offen  lds
  s_add_u32 m0, s57, 45056
  s_add_u32 s54, s78, 1441792
  buffer_load_dwordx4 v8, s[16:19], s54 offen  lds
  s_add_u32 m0, s57, 49152
  s_add_u32 s54, s78, 1572864
  buffer_load_dwordx4 v8, s[16:19], s54 offen  lds
  s_add_u32 m0, s57, 53248
  s_add_u32 s54, s78, 1703936
  buffer_load_dwordx4 v8, s[16:19], s54 offen  lds
  s_add_u32 m0, s57, 57344
  s_add_u32 s54, s78, 1835008
  buffer_load_dwordx4 v8, s[16:19], s54 offen  lds
  s_add_u32 m0, s57, 61440
  s_add_u32 s54, s78, 1966080
  buffer_load_dwordx4 v8, s[16:19], s54 offen  lds
  v_lshlrev_b32 v76, 4, v0
  v_add_u32 v75, 0x10000, v76
  v_lshrrev_b32 v3, 2, v1
  v_and_b32 v4, 1, v1
  v_lshl_add_u32 v3, v3, 1, v4
  v_bfe_u32 v4, v1, 1, 1
  v_mul_u32_u24 v74, 0xaaaa, v4
  v_add_u32 v74, 0x4444, v74
  v_mul_u32_u24 v5, 576, v3
  v_add_u32 v5, 0, v5
  v_lshl_add_u32 v78, v2, 4, v5
  v_lshl_add_u32 v77, v2, 5, v5
  v_lshl_add_u32 v77, v4, 4, v77
  v_mul_u32_u24 v15, 1152, v3
  v_lshl_add_u32 v15, v2, 5, v15
  v_lshl_add_u32 v15, v4, 4, v15
  s_lshl_b32 s54, s52, 8
  buffer_load_dwordx4 v[20:23], v15, s[32:35], s54 offen
  buffer_load_dwordx4 v[24:27], v15, s[32:35], s54 offen offset:128
  buffer_load_dwordx4 v[28:31], v15, s[32:35], 0 offen offset:1024
  v_mul_u32_u24 v79, 1152, v2
  v_lshl_add_u32 v79, v1, 2, v79
  s_lshl_b32 s54, s52, 6
  s_add_u32 s54, s54, 0
  v_add_u32 v79, s54, v79
  v_lshrrev_b32 v5, 3, v0
  v_mul_u32_u24 v68, 2176, v5
  v_and_b32 v5, 7, v0
  v_lshl_add_u32 v68, v5, 3, v68
  v_lshrrev_b32 v6, 3, v0
  s_lshr_b32 s54, s53, 2
  v_add_u32 v68, s54, v6
  v_and_b32 v68, 7, v68
  v_xor_b32 v68, v68, v6
  v_lshlrev_b32 v68, 8, v68
  v_lshl_add_u32 v68, v6, 12, v68
  v_lshl_add_u32 v68, v5, 3, v68
  s_and_b32 s54, s53, 3
  s_lshl_b32 s54, s54, 6
  v_add_u32 v68, s54, v68
  v_and_b32 v5, 1, v2
  v_lshlrev_b32 v5, 4, v5
  v_lshl_add_u32 v5, v1, 2, v5
  v_mov_b32 v6, 0x40000000
  v_cmp_lt_u32 vcc, 3, v1
  s_nop 1
  v_cndmask_b32 v5, v5, v6, vcc
  v_lshrrev_b32 v6, 1, v2
  v_lshl_add_u32 v69, v6, 10, v5
  v_lshl_add_u32 v70, v6, 8, v5
  v_mov_b32 v71, -1
  ds_write_b128 v76, v[68:71] offset:13824
  v_and_b32 v5, 3, v1
  v_lshrrev_b32 v6, 2, v1
  v_lshl_add_u32 v5, v5, 2, v6
  v_and_b32 v6, 1, v5
  v_lshlrev_b32 v6, 4, v6
  v_mov_b32 v7, 0x3f80
  v_lshlrev_b32 v6, v6, v7
  v_lshrrev_b32 v5, 1, v5
  v_cmp_eq_u32 vcc, 0, v5
  s_nop 1
  v_cndmask_b32 v40, 0, v6, vcc
  v_cmp_eq_u32 vcc, 1, v5
  s_nop 1
  v_cndmask_b32 v41, 0, v6, vcc
  v_cmp_eq_u32 vcc, 2, v5
  s_nop 1
  v_cndmask_b32 v42, 0, v6, vcc
  v_cmp_eq_u32 vcc, 3, v5
  s_nop 1
  v_cndmask_b32 v43, 0, v6, vcc
  ds_write_b128 v76, v[40:43] offset:14848
  s_and_b32 s54, s52, 1
  s_lshr_b32 s55, s52, 1
  v_lshrrev_b32 v3, 3, v0
  v_and_b32 v4, 1, v3
  v_lshlrev_b32 v4, 4, v4
  v_and_b32 v5, 6, v3
  v_add_u32 v4, v4, v5
  s_lshl_b32 s56, s55, 3
  s_add_u32 s56, s56, s54
  v_add_u32 v4, s56, v4
  v_mul_u32_u24 v4, 1152, v4
  v_and_b32 v5, 2, v3
  v_lshlrev_b32 v5, 1, v5
  v_and_b32 v6, 7, v0
  v_xor_b32 v6, v6, v5
  v_lshl_add_u32 v9, v6, 4, v4
  v_and_b32 v4, 1, v2
  v_lshlrev_b32 v4, 4, v4
  v_and_b32 v5, 2, v2
  v_add_u32 v4, v4, v5
  s_lshl_b32 s56, s55, 2
  s_add_u32 s56, s56, s54
  v_add_u32 v4, s56, v4
  v_mul_u32_u24 v4, 1152, v4
  v_lshlrev_b32 v6, 1, v2
  v_xor_b32 v6, v6, v1
  v_lshl_add_u32 v10, v6, 4, v4
  v_bfe_u32 v17, v1, 2, 1
  v_bfe_u32 v18, v1, 3, 1
  v_and_b32 v19, 1, v2
  v_lshrrev_b32 v72, 1, v2
  v_and_b32 v73, 3, v1
  v_lshl_add_u32 v3, v19, 1, v17
  v_lshl_add_u32 v6, v18, 2, v3
  v_lshl_add_u32 v4, v72, 4, v17
  v_lshl_add_u32 v4, v19, 2, v4
  v_lshl_add_u32 v4, v18, 3, v4
  v_lshlrev_b32 v4, 8, v4
  s_lshl_b32 s54, s52, 6
  v_lshl_add_u32 v5, v73, 3, s54
  v_lshlrev_b32 v7, 5, v6
  v_xor_b32 v5, v5, v7
  v_add_u32 v11, v4, v5
  v_xor_b32 v12, 32, v11
  v_lshl_add_u32 v4, v72, 2, v3
  v_lshlrev_b32 v4, 7, v4
  v_lshl_add_u32 v4, v73, 3, v4
  s_and_b32 s54, s52, 1
  v_xor_b32 v7, s54, v19
  v_lshl_add_u32 v7, v7, 1, v18
  v_lshl_add_u32 v13, v7, 5, v4
  v_lshlrev_b32 v4, 11, v72
  v_lshl_add_u32 v4, v73, 3, v4
  v_lshl_add_u32 v5, v3, 8, v4
  v_lshl_add_u32 v7, v18, 2, s52
  v_xor_b32 v7, v7, v3
  v_lshl_add_u32 v14, v7, 5, v5
  s_lshl_b32 s54, s53, 14
  s_lshl_b32 s55, s52, 11
  s_add_u32 s54, s54, 1048576
  s_add_u32 s58, s54, s55
  s_add_u32 s59, s58, 8192
  s_lshl_b32 s55, s52, 12
  s_add_u32 s70, s54, s55
  s_add_u32 s70, s70, 655360
  s_lshl_b32 s54, s53, 12
  s_lshl_b32 s55, s52, 10
  s_add_u32 s54, s54, s55
  s_add_u32 s68, s54, 917504
  s_lshl_b32 s54, s53, 6
  s_mul_i32 s55, s52, 17408
  s_add_u32 s55, s54, s55
  s_add_u32 s73, s55, 0
  s_add_u32 s74, s55, 69632
  s_add_u32 s75, s55, 139264
  s_add_u32 s76, s55, 208896
  s_and_b32 s56, s52, 1
  s_mul_i32 s55, s56, 17408
  s_add_u32 s55, s54, s55
  s_add_u32 s77, s55, 278528
  s_mul_i32 s54, s52, 69632
  s_mul_i32 s55, s53, 2176
  s_add_u32 s54, s54, s55
  s_add_u32 s60, s54, 0
  s_and_b32 s56, s53, 15
  s_mul_i32 s55, s56, 2176
  s_add_u32 s61, s55, 278528
  s_lshr_b32 s54, s52, 1
  s_lshl_b32 s54, s54, 15
  s_and_b32 s55, s52, 1
  s_lshl_b32 s55, s55, 11
  s_add_u32 s54, s54, s55
  s_add_u32 s73, s54, 0
  s_add_u32 s74, s54, 65536
  s_add_u32 s75, s54, 131072
  s_add_u32 s76, s54, 196608
  s_add_u32 s77, s55, 262144
  s_and_b32 s54, s53, 7
  s_lshl_b32 s54, s54, 12
  s_bfe_u32 s55, s53, 0x10003
  s_lshl_b32 s55, s55, 11
  s_add_u32 s54, s54, s55
  s_add_u32 s61, s54, 262144
  s_lshr_b32 s55, s53, 4
  s_lshl_b32 s55, s55, 15
  s_add_u32 s54, s54, s55
  s_lshl_b32 s55, s52, 16
  s_add_u32 s54, s54, s55
  s_add_u32 s60, s54, 0
  s_lshl_b32 s54, s52, 11
  s_add_u32 s64, s54, 360448
  s_mov_b32 s65, 368640
  s_lshl_b32 s55, s53, 5
  s_add_u32 s54, s54, s55
  s_add_u32 s62, s54, 376832
  s_lshr_b32 s54, s56, 3
  s_lshl_b32 s54, s54, 9
  s_and_b32 s55, s56, 7
  s_lshl_b32 s55, s55, 5
  s_add_u32 s54, s54, s55
  s_add_u32 s63, s54, 385024
  s_mov_b32 s66, 0
  s_mov_b32 s67, 0
  s_mov_b32 s72, 0
  s_mov_b32 s69, 1040356334
  s_waitcnt vmcnt(15) lgkmcnt(0)
  s_barrier
  s_add_u32 m0, s57, 65536
  s_add_u32 s54, s78, 2097152
  buffer_load_dwordx4 v8, s[16:19], s54 offen  lds
  s_add_u32 m0, s57, 69632
  s_add_u32 s54, s78, 2228224
  buffer_load_dwordx4 v8, s[16:19], s54 offen  lds
  s_add_u32 m0, s57, 73728
  s_add_u32 s54, s78, 2359296
  buffer_load_dwordx4 v8, s[16:19], s54 offen  lds
  s_add_u32 m0, s57, 77824
  s_add_u32 s54, s78, 2490368
  buffer_load_dwordx4 v8, s[16:19], s54 offen  lds
  s_lshl_b32 s55, s2, 2
  s_or_b32 s56, s52, s1
  s_cmp_eq_u32 s56, 0
  s_cselect_b32 s55, s55, 0x1000
  s_lshl_b32 s56, 1, s0
  v_mov_b32 v35, s56
  s_mov_b64 exec, 1
  buffer_atomic_or v35, off, s[12:15], s55 sc0
  s_mov_b64 exec, -1
  v_add_u32 v15, 16384, v11
  v_add_u32 v16, 16384, v12
  ds_read_b64_tr_b16 v[80:81], v15 offset:0
  ds_read_b64_tr_b16 v[82:83], v15 offset:512
  ds_read_b64_tr_b16 v[84:85], v15 offset:8192
  ds_read_b64_tr_b16 v[86:87], v15 offset:8704
  ds_read_b64_tr_b16 v[88:89], v16 offset:0
  ds_read_b64_tr_b16 v[90:91], v16 offset:512
  ds_read_b64_tr_b16 v[92:93], v16 offset:8192
  ds_read_b64_tr_b16 v[94:95], v16 offset:8704
  s_waitcnt vmcnt(16) lgkmcnt(0)
  s_barrier
  s_add_u32 m0, s57, 81920
  s_add_u32 s54, s78, 2621440
  buffer_load_dwordx4 v8, s[16:19], s54 offen  lds
  s_add_u32 m0, s57, 86016
  s_add_u32 s54, s78, 2752512
  buffer_load_dwordx4 v8, s[16:19], s54 offen  lds
  s_add_u32 m0, s57, 90112
  s_add_u32 s54, s78, 2883584
  buffer_load_dwordx4 v8, s[16:19], s54 offen  lds
  s_add_u32 m0, s57, 94208
  s_add_u32 s54, s78, 3014656
  buffer_load_dwordx4 v8, s[16:19], s54 offen  lds
  v_add_u32 v15, 32768, v11
  v_add_u32 v16, 32768, v12
  ds_read_b64_tr_b16 v[96:97], v15 offset:0
  ds_read_b64_tr_b16 v[98:99], v15 offset:512
  ds_read_b64_tr_b16 v[100:101], v15 offset:8192
  ds_read_b64_tr_b16 v[102:103], v15 offset:8704
  ds_read_b64_tr_b16 v[104:105], v16 offset:0
  ds_read_b64_tr_b16 v[106:107], v16 offset:512
  ds_read_b64_tr_b16 v[108:109], v16 offset:8192
  ds_read_b64_tr_b16 v[110:111], v16 offset:8704
  s_waitcnt vmcnt(16) lgkmcnt(0)
  s_barrier
  s_add_u32 m0, s57, 98304
  s_add_u32 s54, s78, 3670016
  buffer_load_dwordx4 v8, s[16:19], s54 offen  lds
  s_add_u32 m0, s57, 102400
  s_add_u32 s54, s78, 3801088
  buffer_load_dwordx4 v8, s[16:19], s54 offen  lds
  s_add_u32 m0, s57, 106496
  s_add_u32 s54, s78, 3932160
  buffer_load_dwordx4 v8, s[16:19], s54 offen  lds
  s_add_u32 m0, s57, 110592
  s_add_u32 s54, s78, 4063232
  buffer_load_dwordx4 v8, s[16:19], s54 offen  lds
  v_add_u32 v15, 49152, v11
  v_add_u32 v16, 49152, v12
  ds_read_b64_tr_b16 v[112:113], v15 offset:0
  ds_read_b64_tr_b16 v[114:115], v15 offset:512
  ds_read_b64_tr_b16 v[116:117], v15 offset:8192
  ds_read_b64_tr_b16 v[118:119], v15 offset:8704
  ds_read_b64_tr_b16 v[120:121], v16 offset:0
  ds_read_b64_tr_b16 v[122:123], v16 offset:512
  ds_read_b64_tr_b16 v[124:125], v16 offset:8192
  ds_read_b64_tr_b16 v[126:127], v16 offset:8704
  s_waitcnt vmcnt(16) lgkmcnt(0)
  s_barrier
  s_add_u32 m0, s57, 114688
  s_add_u32 s54, s78, 4194304
  buffer_load_dwordx4 v8, s[16:19], s54 offen  lds
  s_add_u32 m0, s57, 118784
  s_add_u32 s54, s78, 4325376
  buffer_load_dwordx4 v8, s[16:19], s54 offen  lds
  s_add_u32 m0, s57, 122880
  s_add_u32 s54, s78, 4456448
  buffer_load_dwordx4 v8, s[16:19], s54 offen  lds
  s_add_u32 m0, s57, 126976
  s_add_u32 s54, s78, 4587520
  buffer_load_dwordx4 v8, s[16:19], s54 offen  lds
  v_add_u32 v15, 65536, v11
  v_add_u32 v16, 65536, v12
  ds_read_b64_tr_b16 v[128:129], v15 offset:0
  ds_read_b64_tr_b16 v[130:131], v15 offset:512
  ds_read_b64_tr_b16 v[132:133], v15 offset:8192
  ds_read_b64_tr_b16 v[134:135], v15 offset:8704
  ds_read_b64_tr_b16 v[136:137], v16 offset:0
  ds_read_b64_tr_b16 v[138:139], v16 offset:512
  ds_read_b64_tr_b16 v[140:141], v16 offset:8192
  ds_read_b64_tr_b16 v[142:143], v16 offset:8704
  s_waitcnt vmcnt(13) lgkmcnt(0)
  s_barrier
  s_add_u32 m0, s57, 131072
  s_add_u32 s54, s78, 1048576
  buffer_load_dwordx4 v8, s[20:23], s54 offen  lds
  s_add_u32 m0, s57, 135168
  s_add_u32 s54, s78, 1179648
  buffer_load_dwordx4 v8, s[20:23], s54 offen  lds
  s_add_u32 m0, s57, 139264
  s_add_u32 s54, s78, 1310720
  buffer_load_dwordx4 v8, s[20:23], s54 offen  lds
  s_add_u32 m0, s57, 143360
  s_add_u32 s54, s78, 1441792
  buffer_load_dwordx4 v8, s[20:23], s54 offen  lds
  v_add_u32 v15, 81920, v11
  v_add_u32 v16, 81920, v12
  ds_read_b64_tr_b16 v[144:145], v15 offset:0
  ds_read_b64_tr_b16 v[146:147], v15 offset:512
  ds_read_b64_tr_b16 v[148:149], v15 offset:8192
  ds_read_b64_tr_b16 v[150:151], v15 offset:8704
  ds_read_b64_tr_b16 v[152:153], v16 offset:0
  ds_read_b64_tr_b16 v[154:155], v16 offset:512
  ds_read_b64_tr_b16 v[156:157], v16 offset:8192
  ds_read_b64_tr_b16 v[158:159], v16 offset:8704
  s_waitcnt vmcnt(12) lgkmcnt(0)
  s_barrier
  s_add_u32 m0, s57, 0
  s_add_u32 s54, s78, 1572864
  buffer_load_dwordx4 v8, s[20:23], s54 offen  lds
  s_add_u32 m0, s57, 4096
  s_add_u32 s54, s78, 1703936
  buffer_load_dwordx4 v8, s[20:23], s54 offen  lds
  s_add_u32 m0, s57, 8192
  s_add_u32 s54, s78, 1835008
  buffer_load_dwordx4 v8, s[20:23], s54 offen  lds
  s_add_u32 m0, s57, 12288
  s_add_u32 s54, s78, 1966080
  buffer_load_dwordx4 v8, s[20:23], s54 offen  lds
  v_add_u32 v15, 98304, v11
  v_add_u32 v16, 98304, v12
  ds_read_b64_tr_b16 v[160:161], v15 offset:0
  ds_read_b64_tr_b16 v[162:163], v15 offset:512
  ds_read_b64_tr_b16 v[164:165], v15 offset:8192
  ds_read_b64_tr_b16 v[166:167], v15 offset:8704
  ds_read_b64_tr_b16 v[168:169], v16 offset:0
  ds_read_b64_tr_b16 v[170:171], v16 offset:512
  ds_read_b64_tr_b16 v[172:173], v16 offset:8192
  ds_read_b64_tr_b16 v[174:175], v16 offset:8704
  s_waitcnt vmcnt(12) lgkmcnt(0)
  s_barrier
  s_add_u32 m0, s57, 16384
  s_add_u32 s54, s78, 3145728
  buffer_load_dwordx4 v8, s[20:23], s54 offen  lds
  s_add_u32 m0, s57, 20480
  s_add_u32 s54, s78, 3276800
  buffer_load_dwordx4 v8, s[20:23], s54 offen  lds
  s_add_u32 m0, s57, 24576
  s_add_u32 s54, s78, 3407872
  buffer_load_dwordx4 v8, s[20:23], s54 offen  lds
  s_add_u32 m0, s57, 28672
  s_add_u32 s54, s78, 3538944
  buffer_load_dwordx4 v8, s[20:23], s54 offen  lds
  v_add_u32 v15, 114688, v11
  v_add_u32 v16, 114688, v12
  ds_read_b64_tr_b16 v[176:177], v15 offset:0
  ds_read_b64_tr_b16 v[178:179], v15 offset:512
  ds_read_b64_tr_b16 v[180:181], v15 offset:8192
  ds_read_b64_tr_b16 v[182:183], v15 offset:8704
  ds_read_b64_tr_b16 v[184:185], v16 offset:0
  ds_read_b64_tr_b16 v[186:187], v16 offset:512
  ds_read_b64_tr_b16 v[188:189], v16 offset:8192
  ds_read_b64_tr_b16 v[190:191], v16 offset:8704
  s_waitcnt vmcnt(12) lgkmcnt(0)
  s_barrier
  s_add_u32 m0, s57, 32768
  s_add_u32 s54, s78, 3670016
  buffer_load_dwordx4 v8, s[20:23], s54 offen  lds
  s_add_u32 m0, s57, 36864
  s_add_u32 s54, s78, 3801088
  buffer_load_dwordx4 v8, s[20:23], s54 offen  lds
  s_add_u32 m0, s57, 40960
  s_add_u32 s54, s78, 3932160
  buffer_load_dwordx4 v8, s[20:23], s54 offen  lds
  s_add_u32 m0, s57, 45056
  s_add_u32 s54, s78, 4063232
  buffer_load_dwordx4 v8, s[20:23], s54 offen  lds
  v_add_u32 v15, 131072, v11
  v_add_u32 v16, 131072, v12
  ds_read_b64_tr_b16 v[192:193], v15 offset:0
  ds_read_b64_tr_b16 v[194:195], v15 offset:512
  ds_read_b64_tr_b16 v[196:197], v15 offset:8192
  ds_read_b64_tr_b16 v[198:199], v15 offset:8704
  ds_read_b64_tr_b16 v[200:201], v16 offset:0
  ds_read_b64_tr_b16 v[202:203], v16 offset:512
  ds_read_b64_tr_b16 v[204:205], v16 offset:8192
  ds_read_b64_tr_b16 v[206:207], v16 offset:8704
  s_waitcnt vmcnt(12) lgkmcnt(0)
  s_barrier
  s_add_u32 m0, s57, 49152
  s_add_u32 s54, s78, 4194304
  buffer_load_dwordx4 v8, s[20:23], s54 offen  lds
  s_add_u32 m0, s57, 53248
  s_add_u32 s54, s78, 4325376
  buffer_load_dwordx4 v8, s[20:23], s54 offen  lds
  s_add_u32 m0, s57, 57344
  s_add_u32 s54, s78, 4456448
  buffer_load_dwordx4 v8, s[20:23], s54 offen  lds
  s_add_u32 m0, s57, 61440
  s_add_u32 s54, s78, 4587520
  buffer_load_dwordx4 v8, s[20:23], s54 offen  lds
  s_getpc_b64 s[80:81]
  v_lshlrev_b32 v7, 2, v76
  global_load_dword v19, v7, s[80:81] offset:1024
  s_cmp_eq_u32 s1, 1
  s_cbranch_scc1 C_ver_ok
  v_mov_b32 v33, 16320
  s_cmp_eq_u32 s52, 0
  s_cbranch_scc0 C_ver_b
  s_waitcnt vmcnt(33)
  s_mov_b64 exec, 1
  ds_write_b32 v33, v35
  s_mov_b64 exec, -1
  s_waitcnt lgkmcnt(0)
C_ver_b:
  s_barrier
  ds_read_b32 v32, v33
  s_waitcnt lgkmcnt(0)
  v_readfirstlane_b32 s54, v32
  s_nop 0
  s_bitcmp1_b32 s54, s0
  s_cbranch_scc1 L_conf
C_ver_ok:
  v_min_u32 v20, -2, v20
  v_min_u32 v21, -2, v21
  v_min_u32 v22, -2, v22
  v_min_u32 v23, -2, v23
  v_min_u32 v24, -2, v24
  v_min_u32 v25, -2, v25
  v_min_u32 v26, -2, v26
  v_min_u32 v27, -2, v27
  v_min_u32 v28, -2, v28
  v_min_u32 v29, -2, v29
  v_min_u32 v30, -2, v30
  v_min_u32 v31, -2, v31
  s_lshl_b32 s54, s52, 11
  v_add_u32 v3, s54, v76
  ds_write_b128 v3, v[20:23] offset:4608
  ds_write_b128 v3, v[24:27] offset:5632
  ds_write_b128 v76, v[28:31] offset:12800
  v_add_u32 v15, 147456, v11
  v_add_u32 v16, 147456, v12
  ds_read_b64_tr_b16 v[208:209], v15 offset:0
  ds_read_b64_tr_b16 v[210:211], v15 offset:512
  ds_read_b64_tr_b16 v[212:213], v15 offset:8192
  ds_read_b64_tr_b16 v[214:215], v15 offset:8704
  ds_read_b64_tr_b16 v[216:217], v16 offset:0
  ds_read_b64_tr_b16 v[218:219], v16 offset:512
  ds_read_b64_tr_b16 v[220:221], v16 offset:8192
  ds_read_b64_tr_b16 v[222:223], v16 offset:8704
  s_waitcnt vmcnt(13) lgkmcnt(0)
  s_barrier
  s_add_u32 m0, s57, 65536
  s_add_u32 s54, s78, 0
  buffer_load_dwordx4 v8, s[24:27], s54 offen  lds
  s_add_u32 m0, s57, 69632
  s_add_u32 s54, s78, 131072
  buffer_load_dwordx4 v8, s[24:27], s54 offen  lds
  s_add_u32 m0, s57, 73728
  s_add_u32 s54, s78, 262144
  buffer_load_dwordx4 v8, s[24:27], s54 offen  lds
  s_add_u32 m0, s57, 77824
  s_add_u32 s54, s78, 393216
  buffer_load_dwordx4 v8, s[24:27], s54 offen  lds
  v_add_u32 v15, 16384, v11
  v_add_u32 v16, 16384, v12
  ds_read_b64_tr_b16 v[224:225], v15 offset:0
  ds_read_b64_tr_b16 v[226:227], v15 offset:512
  ds_read_b64_tr_b16 v[228:229], v15 offset:8192
  ds_read_b64_tr_b16 v[230:231], v15 offset:8704
  ds_read_b64_tr_b16 v[232:233], v16 offset:0
  ds_read_b64_tr_b16 v[234:235], v16 offset:512
  ds_read_b64_tr_b16 v[236:237], v16 offset:8192
  ds_read_b64_tr_b16 v[238:239], v16 offset:8704
  s_waitcnt vmcnt(13) lgkmcnt(0)
  s_barrier
  s_add_u32 m0, s57, 81920
  s_add_u32 s54, s78, 524288
  buffer_load_dwordx4 v8, s[24:27], s54 offen  lds
  s_add_u32 m0, s57, 86016
  s_add_u32 s54, s78, 655360
  buffer_load_dwordx4 v8, s[24:27], s54 offen  lds
  s_add_u32 m0, s57, 90112
  s_add_u32 s54, s78, 786432
  buffer_load_dwordx4 v8, s[24:27], s54 offen  lds
  s_add_u32 m0, s57, 94208
  s_add_u32 s54, s78, 917504
  buffer_load_dwordx4 v8, s[24:27], s54 offen  lds
  v_add_u32 v15, 32768, v11
  v_add_u32 v16, 32768, v12
  ds_read_b64_tr_b16 v[240:241], v15 offset:0
  ds_read_b64_tr_b16 v[242:243], v15 offset:512
  ds_read_b64_tr_b16 v[244:245], v15 offset:8192
  ds_read_b64_tr_b16 v[246:247], v15 offset:8704
  ds_read_b64_tr_b16 v[248:249], v16 offset:0
  ds_read_b64_tr_b16 v[250:251], v16 offset:512
  ds_read_b64_tr_b16 v[252:253], v16 offset:8192
  ds_read_b64_tr_b16 v[254:255], v16 offset:8704
  s_waitcnt vmcnt(13) lgkmcnt(0)
  s_barrier
  s_add_u32 m0, s57, 98304
  s_add_u32 s54, s78, 1048576
  buffer_load_dwordx4 v8, s[24:27], s54 offen  lds
  s_add_u32 m0, s57, 102400
  s_add_u32 s54, s78, 1179648
  buffer_load_dwordx4 v8, s[24:27], s54 offen  lds
  s_add_u32 m0, s57, 106496
  s_add_u32 s54, s78, 1310720
  buffer_load_dwordx4 v8, s[24:27], s54 offen  lds
  s_add_u32 m0, s57, 110592
  s_add_u32 s54, s78, 1441792
  buffer_load_dwordx4 v8, s[24:27], s54 offen  lds
  v_add_u32 v15, 49152, v11
  v_add_u32 v16, 49152, v12
  ds_read_b64_tr_b16 a[0:1], v15 offset:0
  ds_read_b64_tr_b16 a[2:3], v15 offset:512
  ds_read_b64_tr_b16 a[4:5], v15 offset:8192
  ds_read_b64_tr_b16 a[6:7], v15 offset:8704
  ds_read_b64_tr_b16 a[8:9], v16 offset:0
  ds_read_b64_tr_b16 a[10:11], v16 offset:512
  ds_read_b64_tr_b16 a[12:13], v16 offset:8192
  ds_read_b64_tr_b16 a[14:15], v16 offset:8704
  s_waitcnt vmcnt(13) lgkmcnt(0)
  s_barrier
  s_add_u32 m0, s57, 114688
  s_add_u32 s54, s78, 1572864
  buffer_load_dwordx4 v8, s[24:27], s54 offen  lds
  s_add_u32 m0, s57, 118784
  s_add_u32 s54, s78, 1703936
  buffer_load_dwordx4 v8, s[24:27], s54 offen  lds
  s_add_u32 m0, s57, 122880
  s_add_u32 s54, s78, 1835008
  buffer_load_dwordx4 v8, s[24:27], s54 offen  lds
  s_add_u32 m0, s57, 126976
  s_add_u32 s54, s78, 1966080
  buffer_load_dwordx4 v8, s[24:27], s54 offen  lds
  v_add_u32 v15, 65536, v11
  v_add_u32 v16, 65536, v12
  ds_read_b64_tr_b16 a[16:17], v15 offset:0
  ds_read_b64_tr_b16 a[18:19], v15 offset:512
  ds_read_b64_tr_b16 a[20:21], v15 offset:8192
  ds_read_b64_tr_b16 a[22:23], v15 offset:8704
  ds_read_b64_tr_b16 a[24:25], v16 offset:0
  ds_read_b64_tr_b16 a[26:27], v16 offset:512
  ds_read_b64_tr_b16 a[28:29], v16 offset:8192
  ds_read_b64_tr_b16 a[30:31], v16 offset:8704
  s_waitcnt vmcnt(12) lgkmcnt(0)
  s_barrier
  s_add_u32 m0, s57, 131072
  s_add_u32 s54, s78, 2097152
  buffer_load_dwordx4 v8, s[24:27], s54 offen  lds
  s_add_u32 m0, s57, 135168
  s_add_u32 s54, s78, 2228224
  buffer_load_dwordx4 v8, s[24:27], s54 offen  lds
  s_add_u32 m0, s57, 139264
  s_add_u32 s54, s78, 2359296
  buffer_load_dwordx4 v8, s[24:27], s54 offen  lds
  s_add_u32 m0, s57, 143360
  s_add_u32 s54, s78, 2490368
  buffer_load_dwordx4 v8, s[24:27], s54 offen  lds
  v_add_u32 v15, 81920, v11
  v_add_u32 v16, 81920, v12
  ds_read_b64_tr_b16 a[32:33], v15 offset:0
  ds_read_b64_tr_b16 a[34:35], v15 offset:512
  ds_read_b64_tr_b16 a[36:37], v15 offset:8192
  ds_read_b64_tr_b16 a[38:39], v15 offset:8704
  ds_read_b64_tr_b16 a[40:41], v16 offset:0
  ds_read_b64_tr_b16 a[42:43], v16 offset:512
  ds_read_b64_tr_b16 a[44:45], v16 offset:8192
  ds_read_b64_tr_b16 a[46:47], v16 offset:8704
  s_waitcnt vmcnt(12) lgkmcnt(0)
  s_barrier
  s_add_u32 m0, s57, 0
  s_add_u32 s54, s78, 2621440
  buffer_load_dwordx4 v8, s[24:27], s54 offen  lds
  s_add_u32 m0, s57, 4096
  s_add_u32 s54, s78, 2752512
  buffer_load_dwordx4 v8, s[24:27], s54 offen  lds
  s_add_u32 m0, s57, 8192
  s_add_u32 s54, s78, 2883584
  buffer_load_dwordx4 v8, s[24:27], s54 offen  lds
  s_add_u32 m0, s57, 12288
  s_add_u32 s54, s78, 3014656
  buffer_load_dwordx4 v8, s[24:27], s54 offen  lds
  s_getpc_b64 s[80:81]
  v_lshlrev_b32 v7, 2, v76
  global_load_dword v19, v7, s[80:81] offset:1024
  v_add_u32 v15, 98304, v11
  v_add_u32 v16, 98304, v12
  ds_read_b64_tr_b16 a[48:49], v15 offset:0
  ds_read_b64_tr_b16 a[50:51], v15 offset:512
  ds_read_b64_tr_b16 a[52:53], v15 offset:8192
  ds_read_b64_tr_b16 a[54:55], v15 offset:8704
  ds_read_b64_tr_b16 a[56:57], v16 offset:0
  ds_read_b64_tr_b16 a[58:59], v16 offset:512
  ds_read_b64_tr_b16 a[60:61], v16 offset:8192
  ds_read_b64_tr_b16 a[62:63], v16 offset:8704
  s_waitcnt vmcnt(13) lgkmcnt(0)
  s_barrier
  s_add_u32 m0, s57, 16384
  s_add_u32 s54, s78, 3145728
  buffer_load_dwordx4 v8, s[24:27], s54 offen  lds
  s_add_u32 m0, s57, 20480
  s_add_u32 s54, s78, 3276800
  buffer_load_dwordx4 v8, s[24:27], s54 offen  lds
  s_add_u32 m0, s57, 24576
  s_add_u32 s54, s78, 3407872
  buffer_load_dwordx4 v8, s[24:27], s54 offen  lds
  s_add_u32 m0, s57, 28672
  s_add_u32 s54, s78, 3538944
  buffer_load_dwordx4 v8, s[24:27], s54 offen  lds
  v_add_u32 v15, 114688, v11
  v_add_u32 v16, 114688, v12
  ds_read_b64_tr_b16 a[64:65], v15 offset:0
  ds_read_b64_tr_b16 a[66:67], v15 offset:512
  ds_read_b64_tr_b16 a[68:69], v15 offset:8192
  ds_read_b64_tr_b16 a[70:71], v15 offset:8704
  ds_read_b64_tr_b16 a[72:73], v16 offset:0
  ds_read_b64_tr_b16 a[74:75], v16 offset:512
  ds_read_b64_tr_b16 a[76:77], v16 offset:8192
  ds_read_b64_tr_b16 a[78:79], v16 offset:8704
  s_waitcnt vmcnt(13) lgkmcnt(0)
  s_barrier
  s_add_u32 m0, s57, 32768
  s_add_u32 s54, s78, 3670016
  buffer_load_dwordx4 v8, s[24:27], s54 offen  lds
  s_add_u32 m0, s57, 36864
  s_add_u32 s54, s78, 3801088
  buffer_load_dwordx4 v8, s[24:27], s54 offen  lds
  s_add_u32 m0, s57, 40960
  s_add_u32 s54, s78, 3932160
  buffer_load_dwordx4 v8, s[24:27], s54 offen  lds
  s_add_u32 m0, s57, 45056
  s_add_u32 s54, s78, 4063232
  buffer_load_dwordx4 v8, s[24:27], s54 offen  lds
  v_add_u32 v15, 131072, v11
  v_add_u32 v16, 131072, v12
  ds_read_b64_tr_b16 a[80:81], v15 offset:0
  ds_read_b64_tr_b16 a[82:83], v15 offset:512
  ds_read_b64_tr_b16 a[84:85], v15 offset:8192
  ds_read_b64_tr_b16 a[86:87], v15 offset:8704
  ds_read_b64_tr_b16 a[88:89], v16 offset:0
  ds_read_b64_tr_b16 a[90:91], v16 offset:512
  ds_read_b64_tr_b16 a[92:93], v16 offset:8192
  ds_read_b64_tr_b16 a[94:95], v16 offset:8704
  s_waitcnt vmcnt(13) lgkmcnt(0)
  s_barrier
  s_add_u32 m0, s57, 49152
  s_add_u32 s54, s78, 4194304
  buffer_load_dwordx4 v8, s[24:27], s54 offen  lds
  s_add_u32 m0, s57, 53248
  s_add_u32 s54, s78, 4325376
  buffer_load_dwordx4 v8, s[24:27], s54 offen  lds
  s_add_u32 m0, s57, 57344
  s_add_u32 s54, s78, 4456448
  buffer_load_dwordx4 v8, s[24:27], s54 offen  lds
  s_add_u32 m0, s57, 61440
  s_add_u32 s54, s78, 4587520
  buffer_load_dwordx4 v8, s[24:27], s54 offen  lds
  v_add_u32 v15, 147456, v11
  v_add_u32 v16, 147456, v12
  ds_read_b64_tr_b16 a[96:97], v15 offset:0
  ds_read_b64_tr_b16 a[98:99], v15 offset:512
  ds_read_b64_tr_b16 a[100:101], v15 offset:8192
  ds_read_b64_tr_b16 a[102:103], v15 offset:8704
  ds_read_b64_tr_b16 a[104:105], v16 offset:0
  ds_read_b64_tr_b16 a[106:107], v16 offset:512
  ds_read_b64_tr_b16 a[108:109], v16 offset:8192
  ds_read_b64_tr_b16 a[110:111], v16 offset:8704
  s_waitcnt vmcnt(13) lgkmcnt(0)
  s_barrier
  s_add_u32 m0, s57, 65536
  s_add_u32 s54, s79, 73728
  buffer_load_dwordx4 v10, s[28:31], s54 offen  lds
  s_add_u32 m0, s57, 69632
  s_add_u32 s54, s79, 82944
  buffer_load_dwordx4 v10, s[28:31], s54 offen  lds
  s_add_u32 m0, s57, 73728
  s_add_u32 s54, s79, 110592
  buffer_load_dwordx4 v10, s[28:31], s54 offen  lds
  s_add_u32 m0, s57, 77824
  s_add_u32 s54, s79, 119808
  buffer_load_dwordx4 v10, s[28:31], s54 offen  lds
  v_add_u32 v15, 16384, v11
  v_add_u32 v16, 16384, v12
  ds_read_b64_tr_b16 a[112:113], v15 offset:0
  ds_read_b64_tr_b16 a[114:115], v15 offset:512
  ds_read_b64_tr_b16 a[116:117], v15 offset:8192
  ds_read_b64_tr_b16 a[118:119], v15 offset:8704
  ds_read_b64_tr_b16 a[120:121], v16 offset:0
  ds_read_b64_tr_b16 a[122:123], v16 offset:512
  ds_read_b64_tr_b16 a[124:125], v16 offset:8192
  ds_read_b64_tr_b16 a[126:127], v16 offset:8704
  s_waitcnt vmcnt(12) lgkmcnt(0)
  s_barrier
  s_add_u32 m0, s57, 81920
  s_add_u32 s54, s79, 256
  buffer_load_dwordx4 v10, s[28:31], s54 offen  lds
  s_add_u32 m0, s57, 86016
  s_add_u32 s54, s79, 9472
  buffer_load_dwordx4 v10, s[28:31], s54 offen  lds
  s_add_u32 m0, s57, 90112
  s_add_u32 s54, s79, 37120
  buffer_load_dwordx4 v10, s[28:31], s54 offen  lds
  s_add_u32 m0, s57, 94208
  s_add_u32 s54, s79, 46336
  buffer_load_dwordx4 v10, s[28:31], s54 offen  lds
  v_add_u32 v15, 32768, v11
  v_add_u32 v16, 32768, v12
  ds_read_b64_tr_b16 a[128:129], v15 offset:0
  ds_read_b64_tr_b16 a[130:131], v15 offset:512
  ds_read_b64_tr_b16 a[132:133], v15 offset:8192
  ds_read_b64_tr_b16 a[134:135], v15 offset:8704
  ds_read_b64_tr_b16 a[136:137], v16 offset:0
  ds_read_b64_tr_b16 a[138:139], v16 offset:512
  ds_read_b64_tr_b16 a[140:141], v16 offset:8192
  ds_read_b64_tr_b16 a[142:143], v16 offset:8704
  s_waitcnt vmcnt(12) lgkmcnt(0)
  s_barrier
  s_add_u32 m0, s57, 98304
  s_add_u32 s54, s79, 512
  buffer_load_dwordx4 v10, s[28:31], s54 offen  lds
  s_add_u32 m0, s57, 102400
  s_add_u32 s54, s79, 9728
  buffer_load_dwordx4 v10, s[28:31], s54 offen  lds
  s_add_u32 m0, s57, 106496
  s_add_u32 s54, s79, 37376
  buffer_load_dwordx4 v10, s[28:31], s54 offen  lds
  s_add_u32 m0, s57, 110592
  s_add_u32 s54, s79, 46592
  buffer_load_dwordx4 v10, s[28:31], s54 offen  lds
  s_getpc_b64 s[80:81]
  v_lshlrev_b32 v7, 2, v76
  global_load_dword v19, v7, s[80:81] offset:1024
  v_add_u32 v15, 49152, v11
  v_add_u32 v16, 49152, v12
  ds_read_b64_tr_b16 a[144:145], v15 offset:0
  ds_read_b64_tr_b16 a[146:147], v15 offset:512
  ds_read_b64_tr_b16 a[148:149], v15 offset:8192
  ds_read_b64_tr_b16 a[150:151], v15 offset:8704
  ds_read_b64_tr_b16 a[152:153], v16 offset:0
  ds_read_b64_tr_b16 a[154:155], v16 offset:512
  ds_read_b64_tr_b16 a[156:157], v16 offset:8192
  ds_read_b64_tr_b16 a[158:159], v16 offset:8704
  s_waitcnt vmcnt(13) lgkmcnt(0)
  s_barrier
  s_add_u32 m0, s57, 114688
  s_add_u32 s54, s79, 74240
  buffer_load_dwordx4 v10, s[28:31], s54 offen  lds
  s_add_u32 m0, s57, 118784
  s_add_u32 s54, s79, 83456
  buffer_load_dwordx4 v10, s[28:31], s54 offen  lds
  s_add_u32 m0, s57, 122880
  s_add_u32 s54, s79, 111104
  buffer_load_dwordx4 v10, s[28:31], s54 offen  lds
  s_add_u32 m0, s57, 126976
  s_add_u32 s54, s79, 120320
  buffer_load_dwordx4 v10, s[28:31], s54 offen  lds
  v_add_u32 v15, 65536, v11
  v_add_u32 v16, 65536, v12
  ds_read_b64_tr_b16 a[160:161], v15 offset:0
  ds_read_b64_tr_b16 a[162:163], v15 offset:512
  ds_read_b64_tr_b16 a[164:165], v15 offset:8192
  ds_read_b64_tr_b16 a[166:167], v15 offset:8704
  ds_read_b64_tr_b16 a[168:169], v16 offset:0
  ds_read_b64_tr_b16 a[170:171], v16 offset:512
  ds_read_b64_tr_b16 a[172:173], v16 offset:8192
  ds_read_b64_tr_b16 a[174:175], v16 offset:8704
  s_waitcnt vmcnt(13) lgkmcnt(0)
  s_barrier
  s_add_u32 m0, s57, 131072
  s_add_u32 s54, s79, 74496
  buffer_load_dwordx4 v10, s[28:31], s54 offen  lds
  s_add_u32 m0, s57, 135168
  s_add_u32 s54, s79, 83712
  buffer_load_dwordx4 v10, s[28:31], s54 offen  lds
  s_add_u32 m0, s57, 139264
  s_add_u32 s54, s79, 111360
  buffer_load_dwordx4 v10, s[28:31], s54 offen  lds
  s_add_u32 m0, s57, 143360
  s_add_u32 s54, s79, 120576
  buffer_load_dwordx4 v10, s[28:31], s54 offen  lds
  v_add_u32 v15, 81920, v14
  ds_read_b64_tr_b16 a[176:177], v15 offset:0
  ds_read_b64_tr_b16 a[178:179], v15 offset:1024
  ds_read_b64_tr_b16 a[180:181], v15 offset:4096
  ds_read_b64_tr_b16 a[182:183], v15 offset:5120
  ds_read_b64_tr_b16 a[184:185], v15 offset:8192
  ds_read_b64_tr_b16 a[186:187], v15 offset:9216
  ds_read_b64_tr_b16 a[188:189], v15 offset:12288
  ds_read_b64_tr_b16 a[190:191], v15 offset:13312
  s_waitcnt vmcnt(13) lgkmcnt(0)
  s_barrier
  s_add_u32 m0, s57, 0
  s_add_u32 s54, s78, 0
  buffer_load_dwordx4 v8, s[20:23], s54 offen  lds
  s_add_u32 m0, s57, 4096
  s_add_u32 s54, s78, 131072
  buffer_load_dwordx4 v8, s[20:23], s54 offen  lds
  s_add_u32 m0, s57, 8192
  s_add_u32 s54, s78, 262144
  buffer_load_dwordx4 v8, s[20:23], s54 offen  lds
  s_add_u32 m0, s57, 12288
  s_add_u32 s54, s78, 393216
  buffer_load_dwordx4 v8, s[20:23], s54 offen  lds
  v_add_u32 v15, 98304, v14
  ds_read_b64_tr_b16 a[192:193], v15 offset:0
  ds_read_b64_tr_b16 a[194:195], v15 offset:1024
  ds_read_b64_tr_b16 a[196:197], v15 offset:4096
  ds_read_b64_tr_b16 a[198:199], v15 offset:5120
  ds_read_b64_tr_b16 a[200:201], v15 offset:8192
  ds_read_b64_tr_b16 a[202:203], v15 offset:9216
  ds_read_b64_tr_b16 a[204:205], v15 offset:12288
  ds_read_b64_tr_b16 a[206:207], v15 offset:13312
  s_waitcnt vmcnt(13) lgkmcnt(0)
  s_barrier
  s_add_u32 m0, s57, 16384
  s_add_u32 s54, s78, 524288
  buffer_load_dwordx4 v8, s[20:23], s54 offen  lds
  s_add_u32 m0, s57, 20480
  s_add_u32 s54, s78, 655360
  buffer_load_dwordx4 v8, s[20:23], s54 offen  lds
  s_add_u32 m0, s57, 24576
  s_add_u32 s54, s78, 786432
  buffer_load_dwordx4 v8, s[20:23], s54 offen  lds
  s_add_u32 m0, s57, 28672
  s_add_u32 s54, s78, 917504
  buffer_load_dwordx4 v8, s[20:23], s54 offen  lds
  v_add_u32 v15, 114688, v14
  ds_read_b64_tr_b16 a[208:209], v15 offset:0
  ds_read_b64_tr_b16 a[210:211], v15 offset:1024
  ds_read_b64_tr_b16 a[212:213], v15 offset:4096
  ds_read_b64_tr_b16 a[214:215], v15 offset:5120
  ds_read_b64_tr_b16 a[216:217], v15 offset:8192
  ds_read_b64_tr_b16 a[218:219], v15 offset:9216
  ds_read_b64_tr_b16 a[220:221], v15 offset:12288
  ds_read_b64_tr_b16 a[222:223], v15 offset:13312
  s_waitcnt vmcnt(12) lgkmcnt(0)
  s_barrier
  s_add_u32 m0, s57, 32768
  s_add_u32 s54, s78, 2097152
  buffer_load_dwordx4 v8, s[20:23], s54 offen  lds
  s_add_u32 m0, s57, 36864
  s_add_u32 s54, s78, 2228224
  buffer_load_dwordx4 v8, s[20:23], s54 offen  lds
  s_add_u32 m0, s57, 40960
  s_add_u32 s54, s78, 2359296
  buffer_load_dwordx4 v8, s[20:23], s54 offen  lds
  s_add_u32 m0, s57, 45056
  s_add_u32 s54, s78, 2490368
  buffer_load_dwordx4 v8, s[20:23], s54 offen  lds
  v_add_u32 v15, 131072, v14
  ds_read_b64_tr_b16 a[224:225], v15 offset:0
  ds_read_b64_tr_b16 a[226:227], v15 offset:1024
  ds_read_b64_tr_b16 a[228:229], v15 offset:4096
  ds_read_b64_tr_b16 a[230:231], v15 offset:5120
  ds_read_b64_tr_b16 a[232:233], v15 offset:8192
  ds_read_b64_tr_b16 a[234:235], v15 offset:9216
  ds_read_b64_tr_b16 a[236:237], v15 offset:12288
  ds_read_b64_tr_b16 a[238:239], v15 offset:13312
  s_waitcnt vmcnt(12) lgkmcnt(0)
  s_barrier
  s_add_u32 m0, s57, 49152
  s_add_u32 s54, s78, 3145728
  buffer_load_dwordx4 v8, s[16:19], s54 offen  lds
  s_add_u32 m0, s57, 53248
  s_add_u32 s54, s78, 3276800
  buffer_load_dwordx4 v8, s[16:19], s54 offen  lds
  s_add_u32 m0, s57, 57344
  s_add_u32 s54, s78, 3407872
  buffer_load_dwordx4 v8, s[16:19], s54 offen  lds
  s_add_u32 m0, s57, 61440
  s_add_u32 s54, s78, 3538944
  buffer_load_dwordx4 v8, s[16:19], s54 offen  lds
  v_add_u32 v15, 147456, v14
  ds_read_b64_tr_b16 a[240:241], v15 offset:0
  ds_read_b64_tr_b16 a[242:243], v15 offset:1024
  ds_read_b64_tr_b16 a[244:245], v15 offset:4096
  ds_read_b64_tr_b16 a[246:247], v15 offset:5120
  ds_read_b64_tr_b16 a[248:249], v15 offset:8192
  ds_read_b64_tr_b16 a[250:251], v15 offset:9216
  ds_read_b64_tr_b16 a[252:253], v15 offset:12288
  ds_read_b64_tr_b16 a[254:255], v15 offset:13312
  s_waitcnt vmcnt(12) lgkmcnt(0)
  s_barrier
  s_add_u32 m0, s57, 65536
  s_add_u32 s54, s78, 2621440
  buffer_load_dwordx4 v8, s[20:23], s54 offen  lds
  s_add_u32 m0, s57, 69632
  s_add_u32 s54, s78, 2752512
  buffer_load_dwordx4 v8, s[20:23], s54 offen  lds
  s_add_u32 m0, s57, 73728
  s_add_u32 s54, s78, 2883584
  buffer_load_dwordx4 v8, s[20:23], s54 offen  lds
  s_add_u32 m0, s57, 77824
  s_add_u32 s54, s78, 3014656
  buffer_load_dwordx4 v8, s[20:23], s54 offen  lds
  v_add_u32 v15, 16384, v11
  v_add_u32 v16, 16384, v12
  ds_read_b64_tr_b16 v[52:53], v15 offset:0
  ds_read_b64_tr_b16 v[54:55], v15 offset:512
  ds_read_b64_tr_b16 v[56:57], v15 offset:8192
  ds_read_b64_tr_b16 v[58:59], v15 offset:8704
  ds_read_b64_tr_b16 v[60:61], v16 offset:0
  ds_read_b64_tr_b16 v[62:63], v16 offset:512
  ds_read_b64_tr_b16 v[64:65], v16 offset:8192
  ds_read_b64_tr_b16 v[66:67], v16 offset:8704
  s_waitcnt vmcnt(12) lgkmcnt(0)
  s_barrier
  s_lshl_b32 s54, s52, 12
  s_add_u32 s54, s54, 16384
  v_add_u32 v7, s54, v76
  ds_write_b128 v7, v[52:55] offset:0
  ds_write_b128 v7, v[56:59] offset:1024
  ds_write_b128 v7, v[60:63] offset:2048
  ds_write_b128 v7, v[64:67] offset:3072
  s_add_u32 m0, s57, 81920
  s_add_u32 s54, s79, 1024
  buffer_load_dwordx4 v9, s[28:31], s54 offen  lds
  s_add_u32 m0, s57, 86016
  s_add_u32 s54, s79, 37888
  buffer_load_dwordx4 v9, s[28:31], s54 offen  lds
  s_add_u32 m0, s57, 90112
  s_add_u32 s54, s79, 74752
  buffer_load_dwordx4 v9, s[28:31], s54 offen  lds
  s_add_u32 m0, s57, 94208
  s_add_u32 s54, s79, 111616
  buffer_load_dwordx4 v9, s[28:31], s54 offen  lds
  v_add_u32 v15, 32768, v11
  v_add_u32 v16, 32768, v12
  ds_read_b64_tr_b16 v[36:37], v15 offset:0
  ds_read_b64_tr_b16 v[38:39], v15 offset:512
  ds_read_b64_tr_b16 v[40:41], v15 offset:8192
  ds_read_b64_tr_b16 v[42:43], v15 offset:8704
  ds_read_b64_tr_b16 v[44:45], v16 offset:0
  ds_read_b64_tr_b16 v[46:47], v16 offset:512
  ds_read_b64_tr_b16 v[48:49], v16 offset:8192
  ds_read_b64_tr_b16 v[50:51], v16 offset:8704
  s_waitcnt vmcnt(12) lgkmcnt(0)
  s_barrier
  s_lshl_b32 s54, s52, 12
  s_add_u32 s54, s54, 32768
  v_add_u32 v7, s54, v76
  ds_write_b128 v7, v[36:39] offset:0
  ds_write_b128 v7, v[40:43] offset:1024
  ds_write_b128 v7, v[44:47] offset:2048
  ds_write_b128 v7, v[48:51] offset:3072
  s_add_u32 m0, s57, 98304
  s_add_u32 s54, s79, 0
  buffer_load_dwordx4 v10, s[28:31], s54 offen  lds
  s_add_u32 m0, s57, 102400
  s_add_u32 s54, s79, 9216
  buffer_load_dwordx4 v10, s[28:31], s54 offen  lds
  s_add_u32 m0, s57, 106496
  s_add_u32 s54, s79, 36864
  buffer_load_dwordx4 v10, s[28:31], s54 offen  lds
  s_add_u32 m0, s57, 110592
  s_add_u32 s54, s79, 46080
  buffer_load_dwordx4 v10, s[28:31], s54 offen  lds
  v_add_u32 v15, 49152, v11
  v_add_u32 v16, 49152, v12
  ds_read_b64_tr_b16 v[52:53], v15 offset:0
  ds_read_b64_tr_b16 v[54:55], v15 offset:512
  ds_read_b64_tr_b16 v[56:57], v15 offset:8192
  ds_read_b64_tr_b16 v[58:59], v15 offset:8704
  ds_read_b64_tr_b16 v[60:61], v16 offset:0
  ds_read_b64_tr_b16 v[62:63], v16 offset:512
  ds_read_b64_tr_b16 v[64:65], v16 offset:8192
  ds_read_b64_tr_b16 v[66:67], v16 offset:8704
  s_waitcnt vmcnt(12) lgkmcnt(0)
  s_barrier
  s_lshl_b32 s54, s52, 12
  s_add_u32 s54, s54, 49152
  v_add_u32 v7, s54, v76
  ds_write_b128 v7, v[52:55] offset:0
  ds_write_b128 v7, v[56:59] offset:1024
  ds_write_b128 v7, v[60:63] offset:2048
  ds_write_b128 v7, v[64:67] offset:3072
  s_add_u32 m0, s57, 114688
  s_add_u32 s54, s79, 73984
  buffer_load_dwordx4 v10, s[28:31], s54 offen  lds
  s_add_u32 m0, s57, 118784
  s_add_u32 s54, s79, 83200
  buffer_load_dwordx4 v10, s[28:31], s54 offen  lds
  s_add_u32 m0, s57, 122880
  s_add_u32 s54, s79, 110848
  buffer_load_dwordx4 v10, s[28:31], s54 offen  lds
  s_add_u32 m0, s57, 126976
  s_add_u32 s54, s79, 120064
  buffer_load_dwordx4 v10, s[28:31], s54 offen  lds
  v_add_u32 v15, 65536, v11
  v_add_u32 v16, 65536, v12
  ds_read_b64_tr_b16 v[36:37], v15 offset:0
  ds_read_b64_tr_b16 v[38:39], v15 offset:512
  ds_read_b64_tr_b16 v[40:41], v15 offset:8192
  ds_read_b64_tr_b16 v[42:43], v15 offset:8704
  ds_read_b64_tr_b16 v[44:45], v16 offset:0
  ds_read_b64_tr_b16 v[46:47], v16 offset:512
  ds_read_b64_tr_b16 v[48:49], v16 offset:8192
  ds_read_b64_tr_b16 v[50:51], v16 offset:8704
  s_waitcnt vmcnt(12) lgkmcnt(0)
  s_barrier
  s_lshl_b32 s54, s52, 12
  s_add_u32 s54, s54, 65536
  v_add_u32 v7, s54, v76
  ds_write_b128 v7, v[36:39] offset:0
  ds_write_b128 v7, v[40:43] offset:1024
  ds_write_b128 v7, v[44:47] offset:2048
  ds_write_b128 v7, v[48:51] offset:3072
  s_add_u32 m0, s57, 131072
  s_add_u32 s54, s79, 768
  buffer_load_dwordx4 v10, s[28:31], s54 offen  lds
  s_add_u32 m0, s57, 135168
  s_add_u32 s54, s79, 9984
  buffer_load_dwordx4 v10, s[28:31], s54 offen  lds
  s_add_u32 m0, s57, 139264
  s_add_u32 s54, s79, 37632
  buffer_load_dwordx4 v10, s[28:31], s54 offen  lds
  s_add_u32 m0, s57, 143360
  s_add_u32 s54, s79, 46848
  buffer_load_dwordx4 v10, s[28:31], s54 offen  lds
  v_lshlrev_b32 v7, 3, v76
  s_lshl_b32 s54, s52, 13
  s_add_u32 s54, s54, 360448
  s_bitcmp1_b32 s52, 0
  s_cselect_b64 exec, 0xff, -1
  buffer_load_dword v35, v7, s[8:11], s54 offen sc1
  s_mov_b64 exec, -1
  s_getpc_b64 s[80:81]
C_pc:
  s_mov_b32 s55, (L_w0 - C_pc)
  s_cmp_eq_u32 s52, 1
  s_cselect_b32 s55, (L_w1 - C_pc), s55
  s_cmp_eq_u32 s52, 2
  s_cselect_b32 s55, (L_w2 - C_pc), s55
  s_cmp_eq_u32 s52, 3
  s_cselect_b32 s55, (L_w3 - C_pc), s55
  v_lshl_add_u32 v7, v76, 3, s55
  global_load_dword v35, v7, s[80:81]
  v_add_u32 v15, 81920, v11
  v_add_u32 v16, 81920, v12
  ds_read_b64_tr_b16 v[52:53], v15 offset:0
  ds_read_b64_tr_b16 v[54:55], v15 offset:512
  ds_read_b64_tr_b16 v[56:57], v15 offset:8192
  ds_read_b64_tr_b16 v[58:59], v15 offset:8704
  ds_read_b64_tr_b16 v[60:61], v16 offset:0
  ds_read_b64_tr_b16 v[62:63], v16 offset:512
  ds_read_b64_tr_b16 v[64:65], v16 offset:8192
  ds_read_b64_tr_b16 v[66:67], v16 offset:8704
  s_waitcnt vmcnt(14) lgkmcnt(0)
  s_barrier
  s_lshl_b32 s54, s52, 12
  s_add_u32 s54, s54, 81920
  v_add_u32 v7, s54, v76
  ds_write_b128 v7, v[52:55] offset:0
  ds_write_b128 v7, v[56:59] offset:1024
  ds_write_b128 v7, v[60:63] offset:2048
  ds_write_b128 v7, v[64:67] offset:3072
  v_lshrrev_b32 v20, 2, v76
  buffer_load_dword v21, v20, s[12:15], 0 offen sc1
  v_add_u32 v15, 98304, v13
  s_waitcnt lgkmcnt(0)
  ds_read_b64_tr_b16 v[36:37], v15 offset:0
  ds_read_b64_tr_b16 v[38:39], v15 offset:1024
  ds_read_b64_tr_b16 v[40:41], v15 offset:2048
  ds_read_b64_tr_b16 v[42:43], v15 offset:3072
  ds_read_b64_tr_b16 v[44:45], v15 offset:4096
  ds_read_b64_tr_b16 v[46:47], v15 offset:5120
  ds_read_b64_tr_b16 v[48:49], v15 offset:6144
  ds_read_b64_tr_b16 v[50:51], v15 offset:7168
  ds_read_b64_tr_b16 v[52:53], v15 offset:8192
  ds_read_b64_tr_b16 v[54:55], v15 offset:9216
  ds_read_b64_tr_b16 v[56:57], v15 offset:10240
  ds_read_b64_tr_b16 v[58:59], v15 offset:11264
  ds_read_b64_tr_b16 v[60:61], v15 offset:12288
  ds_read_b64_tr_b16 v[62:63], v15 offset:13312
  ds_read_b64_tr_b16 v[64:65], v15 offset:14336
  ds_read_b64_tr_b16 v[66:67], v15 offset:15360
  s_waitcnt vmcnt(11) lgkmcnt(0)
  s_barrier
  s_and_b32 s54, s52, 1
  s_lshl_b32 s54, s54, 13
  s_add_u32 s54, s54, 98304
  v_add_u32 v7, s54, v76
  ds_write_b128 v7, v[36:39] offset:0
  ds_write_b128 v7, v[40:43] offset:1024
  ds_write_b128 v7, v[44:47] offset:2048
  ds_write_b128 v7, v[48:51] offset:3072
  ds_write_b128 v7, v[52:55] offset:4096
  ds_write_b128 v7, v[56:59] offset:5120
  ds_write_b128 v7, v[60:63] offset:6144
  ds_write_b128 v7, v[64:67] offset:7168
  v_add_u32 v15, 114688, v14
  ds_read_b64_tr_b16 v[52:53], v15 offset:0
  ds_read_b64_tr_b16 v[54:55], v15 offset:1024
  ds_read_b64_tr_b16 v[56:57], v15 offset:4096
  ds_read_b64_tr_b16 v[58:59], v15 offset:5120
  ds_read_b64_tr_b16 v[60:61], v15 offset:8192
  ds_read_b64_tr_b16 v[62:63], v15 offset:9216
  ds_read_b64_tr_b16 v[64:65], v15 offset:12288
  ds_read_b64_tr_b16 v[66:67], v15 offset:13312
  s_waitcnt vmcnt(7) lgkmcnt(0)
  s_barrier
  s_lshl_b32 s54, s52, 12
  s_add_u32 s54, s54, 114688
  v_add_u32 v7, s54, v76
  ds_write_b128 v7, v[52:55] offset:0
  ds_write_b128 v7, v[56:59] offset:1024
  ds_write_b128 v7, v[60:63] offset:2048
  ds_write_b128 v7, v[64:67] offset:3072
  v_add_u32 v15, 131072, v14
  ds_read_b64_tr_b16 v[36:37], v15 offset:0
  ds_read_b64_tr_b16 v[38:39], v15 offset:1024
  ds_read_b64_tr_b16 v[40:41], v15 offset:4096
  ds_read_b64_tr_b16 v[42:43], v15 offset:5120
  ds_read_b64_tr_b16 v[44:45], v15 offset:8192
  ds_read_b64_tr_b16 v[46:47], v15 offset:9216
  ds_read_b64_tr_b16 v[48:49], v15 offset:12288
  ds_read_b64_tr_b16 v[50:51], v15 offset:13312
  s_waitcnt vmcnt(3) lgkmcnt(0)
  s_barrier
  s_lshl_b32 s54, s52, 12
  s_add_u32 s54, s54, 131072
  v_add_u32 v7, s54, v76
  ds_write_b128 v7, v[36:39] offset:0
  ds_write_b128 v7, v[40:43] offset:1024
  ds_write_b128 v7, v[44:47] offset:2048
  ds_write_b128 v7, v[48:51] offset:3072
  v_add_u32 v15, 147456, v14
  ds_read_b64_tr_b16 v[52:53], v15 offset:0
  ds_read_b64_tr_b16 v[54:55], v15 offset:1024
  ds_read_b64_tr_b16 v[56:57], v15 offset:4096
  ds_read_b64_tr_b16 v[58:59], v15 offset:5120
  ds_read_b64_tr_b16 v[60:61], v15 offset:8192
  ds_read_b64_tr_b16 v[62:63], v15 offset:9216
  ds_read_b64_tr_b16 v[64:65], v15 offset:12288
  ds_read_b64_tr_b16 v[66:67], v15 offset:13312
  s_waitcnt vmcnt(0) lgkmcnt(0)
  s_barrier
  s_lshl_b32 s54, s52, 12
  s_add_u32 s54, s54, 147456
  v_add_u32 v7, s54, v76
  ds_write_b128 v7, v[52:55] offset:0
  ds_write_b128 v7, v[56:59] offset:1024
  ds_write_b128 v7, v[60:63] offset:2048
  ds_write_b128 v7, v[64:67] offset:3072
  s_waitcnt lgkmcnt(0)
  s_branch C_rd1
C_rd0:
  s_sleep 2
  buffer_load_dword v21, v20, s[12:15], 0 offen sc1
  s_waitcnt vmcnt(0)
C_rd1:
  v_and_b32 v22, 0xff, v21
  v_cmp_gt_u32 vcc, 7, v22
  v_readlane_b32 s56, v21, 0
  s_mov_b32 s3, 1
  s_add_u32 s67, s67, 1
  s_cmp_ge_u32 s67, 131072
  s_cbranch_scc1 C_rd2
  s_cmp_lg_u32 vcc_hi, 0
  s_cbranch_scc1 C_rd0
  s_mov_b32 s3, 0
  s_cmp_eq_u32 s56, -1
  s_cbranch_scc1 C_rd2
  s_mov_b32 s3, 1
  v_readlane_b32 s54, v21, 10
  v_readlane_b32 s55, v21, 0
  s_nop 0
  s_bcnt1_i32_b32 s55, s55
  s_add_u32 s54, s54, s55
  v_readlane_b32 s55, v21, 1
  s_nop 0
  s_bcnt1_i32_b32 s55, s55
  s_add_u32 s54, s54, s55
  v_readlane_b32 s55, v21, 2
  s_nop 0
  s_bcnt1_i32_b32 s55, s55
  s_add_u32 s54, s54, s55
  v_readlane_b32 s55, v21, 3
  s_nop 0
  s_bcnt1_i32_b32 s55, s55
  s_add_u32 s54, s54, s55
  v_readlane_b32 s55, v21, 4
  s_nop 0
  s_bcnt1_i32_b32 s55, s55
  s_add_u32 s54, s54, s55
  v_readlane_b32 s55, v21, 5
  s_nop 0
  s_bcnt1_i32_b32 s55, s55
  s_add_u32 s54, s54, s55
  v_readlane_b32 s55, v21, 6
  s_nop 0
  s_bcnt1_i32_b32 s55, s55
  s_add_u32 s54, s54, s55
  v_readlane_b32 s55, v21, 7
  s_nop 0
  s_bcnt1_i32_b32 s55, s55
  s_add_u32 s54, s54, s55
  s_cmp_lt_u32 s54, 256
  s_cbranch_scc1 C_rd0
C_rd2:
  s_lshl_b32 s54, s3, 2
  s_add_u32 s54, s54, s52
  s_cmp_eq_u32 s54, 1
  s_cbranch_scc1 L_w1
  s_cmp_eq_u32 s54, 2
  s_cbranch_scc1 L_w2
  s_cmp_eq_u32 s54, 3
  s_cbranch_scc1 L_w3
  s_cmp_eq_u32 s54, 4
  s_cbranch_scc1 L_w4
  s_cmp_eq_u32 s54, 5
  s_cbranch_scc1 L_w5
  s_cmp_eq_u32 s54, 6
  s_cbranch_scc1 L_w6
  s_cmp_eq_u32 s54, 7
  s_cbranch_scc1 L_w7
L_w0:
  v_mov_b64 v[20:21], 0
  v_mov_b64 v[22:23], 0
  v_mov_b64 v[24:25], 0
  v_mov_b64 v[26:27], 0
  v_mov_b64 v[28:29], 0
  v_mov_b64 v[30:31], 0
  v_mov_b64 v[32:33], 0
  v_mov_b64 v[34:35], 0
  s_mov_b32 s78, 0x3f803f80
  s_mov_b32 s79, s78
  s_mov_b32 s65, 360448
  s_mov_b32 m0, 16128
  s_lshl_b32 s71, s53, 2
  s_add_u32 s71, s71, 128
  s_movk_i32 s56, 0x1000
  v_lshlrev_b32 v73, 2, v76
  v_mov_b32 v72, 0
  s_mov_b64 s[16:17], s[8:9]
  s_mov_b32 s18, 268435456
  s_mov_b32 s19, 0x20000
  s_getpc_b64 s[20:21]
Cf0_pc:
  s_add_u32 s20, s20, (Cf0_last - Cf0_pc)
  s_addc_u32 s21, s21, 0
  v_mov_b32 v68, 14880
  buffer_load_dwordx4 v[52:55], v76, s[8:11], s59 offen offset:0 sc1
  buffer_load_dwordx4 v[56:59], v76, s[8:11], s59 offen offset:1024 sc1
  ds_read_b128 v[36:39], v76 offset:16384
  ds_read_b128 v[40:43], v76 offset:17408
  ds_read_b128 v[60:63], v76 offset:18432
  ds_read_b128 v[64:67], v76 offset:19456
  ds_read_b128 v[0:3], v76 offset:4608
  ds_read_b128 v[4:7], v76 offset:5632
  ds_read_b128 v[8:11], v76 offset:6656
  ds_read_b128 v[12:15], v76 offset:7680
  s_waitcnt lgkmcnt(0)
  s_cmp_eq_u32 s66, 1
  s_branch Cf0_top2
.p2align 6
Cf0_h2:
  s_cmp_eq_u32 s66, 12
  s_cselect_b32 s56, s71, 0x1000
  ds_read_b32 v72, v76 offset:16128
  s_cmp_eq_u32 s66, 13
  s_cselect_b32 s54, 0x700, 0
  s_waitcnt lgkmcnt(0)
  v_readfirstlane_b32 s57, v72
  s_nop 0
  s_cmp_lt_u32 s57, s54
  s_cbranch_scc1 Cf0_kv3
Cf0_kvb:
  buffer_load_dwordx4 v[0:3], v76, s[8:11], s65 offen offset:0 sc1
  ds_read_b128 v[36:39], v76 offset:16384
  s_waitcnt lgkmcnt(0)
  v_mov_b64 v[20:21], 0
  v_mov_b64 v[22:23], 0
  v_mov_b64 v[24:25], 0
  v_mov_b64 v[26:27], 0
  v_mov_b32 v68, 14880
  buffer_load_dwordx4 v[0:3], v76, s[8:11], s65 offen offset:0 sc1
  ds_read_b128 v[40:43], v76 offset:17408
  s_waitcnt lgkmcnt(0)
  s_cmp_eq_u32 s66, 62
  s_cselect_b64 s[16:17], s[20:21], s[16:17]
  s_cselect_b32 s18, (Cf0_done - Cf0_last), s18
  s_cselect_b32 s70, 0, s70
  s_cmp_eq_u32 s66, 63
  s_cselect_b32 s59, 268435456, s59
  s_cselect_b32 s58, 268435456, s58
  buffer_load_dwordx4 v[0:3], v76, s[8:11], s65 offen offset:0 sc1
  ds_read_b128 v[60:63], v76 offset:18432
  s_waitcnt lgkmcnt(0)
  v_lshlrev_b32 v73, 2, v76
  buffer_load_dwordx4 v[52:55], v76, s[8:11], s59 offen offset:0 sc1
  buffer_load_dwordx4 v[56:59], v76, s[8:11], s59 offen offset:1024 sc1
  s_waitcnt vmcnt(4)
  v_max3_u32 v72, v0, v1, v2
  v_max_u32 v72, v72, v3
  ds_write_b128 v76, v[0:3] offset:4608
  v_cmp_eq_u32 vcc, -1, v72
  s_cbranch_vccnz Cf0_h2r
Cf0_h2w:
  s_cmp_eq_u32 s66, 63
  s_waitcnt lgkmcnt(0)
  s_barrier
  ds_read_b128 v[8:11], v76 offset:6656
  buffer_load_dwordx4 v76, s[8:11], s85 offen offset:0 sc1 lds
Cf0_top2:
  v_smfmac_f32_16x16x64_bf16 v[20:23], v[0:3], v[80:87], v74
  s_cbranch_scc1 Cf0_last
  v_smfmac_f32_16x16x64_bf16 v[28:31], v[0:3], v[36:43], v74
  buffer_load_dwordx4 v[44:47], v76, s[8:11], s58 offen offset:0 sc1
  s_mov_b32 m0, 16128
  v_smfmac_f32_16x16x64_bf16 v[24:27], v[0:3], v[88:95], v74
  buffer_load_dwordx4 v[48:51], v76, s[8:11], s58 offen offset:1024 sc1
  v_smfmac_f32_16x16x64_bf16 v[32:35], v[0:3], v[60:67], v74
  ds_read_b128 v[4:7], v76 offset:5632
  s_waitcnt lgkmcnt(1)
  v_smfmac_f32_16x16x64_bf16 v[20:23], v[8:11], v[112:119], v74
  ds_read_b128 v[12:15], v76 offset:7680
  v_smfmac_f32_16x16x64_bf16 v[24:27], v[8:11], v[120:127], v74
  ds_read_b128 v[36:39], v76 offset:32768
  v_smfmac_f32_16x16x64_bf16 v[28:31], v[8:11], v[208:215], v74
  buffer_store_dwordx4 v[16:19], v76, s[8:11], s68 offen sc1
  ds_read_b128 v[40:43], v76 offset:33792
  v_smfmac_f32_16x16x64_bf16 v[32:35], v[8:11], v[216:223], v74
  buffer_load_dword v73, s[16:19], s70 offen lds
  ds_read_b128 v[60:63], v76 offset:34816
  s_waitcnt lgkmcnt(4)
  v_smfmac_f32_16x16x64_bf16 v[20:23], v[4:7], v[96:103], v74
  ds_read_b128 v[64:67], v76 offset:35840
  v_smfmac_f32_16x16x64_bf16 v[24:27], v[4:7], v[104:111], v74
  s_waitcnt vmcnt(5)
  s_waitcnt lgkmcnt(4)
  v_smfmac_f32_16x16x64_bf16 v[20:23], v[12:15], v[128:135], v74
  s_barrier
  ds_read_b128 v[0:3], v76 offset:8704
  s_waitcnt lgkmcnt(3)
  v_smfmac_f32_16x16x64_bf16 v[28:31], v[4:7], v[36:43], v74
  ds_read_b128 v[36:39], v76 offset:49152
  v_smfmac_f32_16x16x64_bf16 v[24:27], v[12:15], v[136:143], v74
  ds_read_b128 v[40:43], v76 offset:50176
  s_waitcnt lgkmcnt(3)
  v_smfmac_f32_16x16x64_bf16 v[32:35], v[4:7], v[60:67], v74
  ds_read_b128 v[8:11], v76 offset:9728
  v_smfmac_f32_16x16x64_bf16 v[28:31], v[12:15], v[224:231], v74
  ds_read_b128 v[60:63], v76 offset:51200
  v_smfmac_f32_16x16x64_bf16 v[32:35], v[12:15], v[232:239], v74
  s_waitcnt vmcnt(4)
  ds_read_b128 v[64:67], v76 offset:52224
  s_waitcnt lgkmcnt(5)
  v_smfmac_f32_16x16x64_bf16 v[20:23], v[0:3], v[144:151], v74
  s_barrier
  ds_read_b128 v[4:7], v76 offset:11776
  s_waitcnt lgkmcnt(4)
  v_smfmac_f32_16x16x64_bf16 v[28:31], v[0:3], v[36:43], v74
  ds_read_b128 v[12:15], v76 offset:12800
  ds_read_b128 v[36:39], v75 offset:0
  v_smfmac_f32_16x16x64_bf16 v[24:27], v[0:3], v[152:159], v74
  ds_read_b128 v[16:19], v76 offset:10752
  s_waitcnt lgkmcnt(6)
  v_smfmac_f32_16x16x64_bf16 v[20:23], v[8:11], v[160:167], v74
  ds_read_b128 v[40:43], v75 offset:1024
  s_waitcnt lgkmcnt(5)
  v_smfmac_f32_16x16x64_bf16 v[32:35], v[0:3], v[60:67], v74
  ds_read_b128 v[60:63], v75 offset:2048
  v_smfmac_f32_16x16x64_bf16 v[24:27], v[8:11], v[168:175], v74
  ds_read_b128 v[64:67], v75 offset:3072
  s_waitcnt lgkmcnt(6)
  v_smfmac_f32_16x16x64_bf16 v[20:23], v[4:7], v[176:183], v74
  buffer_load_dword off, s[12:15], s56 sc1 lds
  s_waitcnt lgkmcnt(5)
  v_smfmac_f32_16x16x64_bf16 v[20:23], v[12:15], v[192:199], v74
  s_waitcnt lgkmcnt(2)
  v_smfmac_f32_16x16x64_bf16 v[20:23], v[16:19], v[36:43], v74
  ds_read_b128 v[36:39], v75 offset:16384
  v_smfmac_f32_16x16x64_bf16 v[24:27], v[4:7], v[184:191], v74
  ds_read_b128 v[40:43], v75 offset:17408
  s_waitcnt lgkmcnt(2)
  v_smfmac_f32_16x16x64_bf16 v[24:27], v[16:19], v[60:67], v74
  ds_read_b128 v[60:63], v75 offset:18432
  v_add_f32 v20, v20, v22
  v_smfmac_f32_16x16x64_bf16 v[24:27], v[12:15], v[200:207], v74
  ds_read_b128 v[64:67], v75 offset:19456
  v_add_f32 v21, v21, v23
  v_smfmac_f32_16x16x64_bf16 v[28:31], v[16:19], v[240:247], v74
  v_mov_b64 v[70:71], s[78:79]
  v_smfmac_f32_16x16x64_bf16 v[28:31], v[4:7], a[0:7], v74
  s_waitcnt lgkmcnt(2)
  v_add_f32 v24, v24, v26
  v_smfmac_f32_16x16x64_bf16 v[28:31], v[8:11], v[36:43], v74
  ds_read_b128 v[36:39], v68
  v_cvt_pk_bf16_f32 v22, v20, v24
  v_smfmac_f32_16x16x64_bf16 v[28:31], v[12:15], a[16:23], v74
  ds_read_b128 v[40:43], v68
  ds_write_b32 v79, v22 offset:0
  s_waitcnt lgkmcnt(3)
  v_add_f32 v25, v25, v27
  v_cvt_pk_bf16_f32 v23, v21, v25
  v_smfmac_f32_16x16x64_bf16 v[32:35], v[8:11], v[60:67], v74
  ds_write_b32 v79, v23 offset:576
  v_cmp_u_f32 vcc, v20, v21
  v_smfmac_f32_16x16x64_bf16 v[32:35], v[16:19], v[248:255], v74
  v_add_f32 v28, v28, v30
  v_smfmac_f32_16x16x64_bf16 v[32:35], v[4:7], a[8:15], v74
  v_add_f32 v29, v29, v31
  v_smfmac_f32_16x16x64_bf16 v[32:35], v[12:15], a[24:31], v74
  s_cbranch_vccnz Cf0_rec
Cf0_recok:
  s_waitcnt lgkmcnt(3)
  v_smfmac_f32_16x16x64_bf16 v[36:39], v[16:19], a[128:135], v74
  s_waitcnt lgkmcnt(0)
  s_barrier
  ds_read_b128 v[60:63], v77
  v_smfmac_f32_16x16x64_bf16 v[40:43], v[16:19], a[136:143], v74
  ds_read_b128 v[64:67], v77 offset:128
  v_add_f32 v32, v32, v34
  v_cvt_pk_bf16_f32 v30, v28, v32
  v_smfmac_f32_16x16x64_bf16 v[36:39], v[0:3], a[96:103], v74
  ds_write_b32 v79, v30 offset:256
  v_add_f32 v33, v33, v35
  v_cvt_pk_bf16_f32 v31, v29, v33
  v_smfmac_f32_16x16x64_bf16 v[40:43], v[0:3], a[104:111], v74
  ds_write_b32 v79, v31 offset:832
  v_xor_b32 v75, 0x8000, v75
  v_smfmac_f32_16x16x64_bf16 v[36:39], v[4:7], a[144:151], v74
  ds_read_b128 v[0:3], v76 offset:4608
  v_mov_b32 v29, 0
  v_smfmac_f32_16x16x64_bf16 v[40:43], v[4:7], a[152:159], v74
  s_waitcnt vmcnt(3) lgkmcnt(3)
  v_mov_b32 v30, 0
  v_mfma_f32_16x16x32_bf16 v[44:47], v[44:47], v[60:63], 0
  ds_read_b128 v[4:7], v76 offset:5632
  s_waitcnt lgkmcnt(2)
  v_mfma_f32_16x16x32_bf16 v[44:47], v[48:51], v[64:67], v[44:47]
  s_barrier
  v_smfmac_f32_16x16x64_bf16 v[36:39], v[8:11], a[112:119], v74
  ds_read_b128 v[20:23], v77 offset:256
  ds_read_b128 v[24:27], v77 offset:384
  v_smfmac_f32_16x16x64_bf16 v[40:43], v[8:11], a[120:127], v74
  ds_read_b128 v[8:11], v76 offset:6656
  v_add_f32_dpp v72, v46, v44 quad_perm:[2,3,0,1] row_mask:0xf bank_mask:0xf
  v_add_f32_dpp v73, v47, v45 quad_perm:[2,3,0,1] row_mask:0xf bank_mask:0xf
  v_smfmac_f32_16x16x64_bf16 v[36:39], v[12:15], a[160:167], v74
  s_waitcnt lgkmcnt(4)
  v_exp_f32_dpp v72, v72 quad_perm:[0,1,0,1] row_mask:0xf bank_mask:0xf
  v_smfmac_f32_16x16x64_bf16 v[40:43], v[12:15], a[168:175], v74
  ds_read_b128 v[12:15], v76 offset:7680
  v_exp_f32_dpp v73, v73 quad_perm:[0,1,0,1] row_mask:0xf bank_mask:0xf
  v_smfmac_f32_16x16x64_bf16 v[36:39], v[0:3], a[32:39], v74
  s_waitcnt lgkmcnt(2)
  v_cvt_pk_bf16_f32 v72, v72, v73
  v_mfma_f32_16x16x32_bf16 v[20:23], v[20:23], v[60:63], 0
  ds_write_b32 v78, v72 offset:512
  v_mov_b64 v[16:17], 0
  v_mfma_f32_16x16x32_bf16 v[20:23], v[24:27], v[64:67], v[20:23]
  ds_read_b128 v[44:47], v75 offset:16384
  v_mov_b64 v[18:19], 0
  v_smfmac_f32_16x16x64_bf16 v[40:43], v[0:3], a[40:47], v74
  ds_read_b128 v[48:51], v75 offset:17408
  v_mov_b64 v[68:69], s[78:79]
  v_smfmac_f32_16x16x64_bf16 v[36:39], v[4:7], a[48:55], v74
  s_waitcnt lgkmcnt(4)
  v_add_f32_dpp v24, v22, v20 quad_perm:[2,3,0,1] row_mask:0xf bank_mask:0xf
  v_add_f32_dpp v25, v23, v21 quad_perm:[2,3,0,1] row_mask:0xf bank_mask:0xf
  v_smfmac_f32_16x16x64_bf16 v[36:39], v[8:11], a[64:71], v74
  s_waitcnt lgkmcnt(2)
  s_barrier
  ds_read_b128 v[32:35], v78 offset:512
  v_smfmac_f32_16x16x64_bf16 v[36:39], v[12:15], a[80:87], v74
  ds_read_b128 v[60:63], v75 offset:18432
  v_mul_f32 v24, s69, v24
  v_smfmac_f32_16x16x64_bf16 v[40:43], v[4:7], a[56:63], v74
  ds_read_b128 v[64:67], v75 offset:19456
  v_mul_f32 v25, s69, v25
  v_smfmac_f32_16x16x64_bf16 v[40:43], v[8:11], a[72:79], v74
  v_exp_f32_dpp v24, v24 quad_perm:[0,1,0,1] row_mask:0xf bank_mask:0xf
  v_smfmac_f32_16x16x64_bf16 v[40:43], v[12:15], a[88:95], v74
  s_waitcnt lgkmcnt(2)
  v_exp_f32_dpp v25, v25 quad_perm:[0,1,0,1] row_mask:0xf bank_mask:0xf
  v_mfma_f32_16x16x32_bf16 v[8:11], v[32:35], v[68:71], 0
  v_add_f32 v36, v36, v38
  v_add_f32 v37, v37, v39
  v_mfma_f32_16x16x32_bf16 v[0:3], v[32:35], v[52:55], 0
  v_add_f32 v40, v40, v42
  v_add_f32 v41, v41, v43
  v_mfma_f32_16x16x32_bf16 v[4:7], v[32:35], v[56:59], 0
  v_cvt_pk_bf16_f32 v28, v24, v25
  v_cvt_pk_bf16_f32 v72, v36, v37
  v_cvt_pk_bf16_f32 v73, v40, v41
  v_mfma_f32_16x16x16_bf16 v[8:11], v[28:29], v[68:69], v[8:11]
  v_cvt_pk_bf16_f32 v31, v24, v25
  v_mov_b64 v[20:21], 0
  v_mfma_f32_16x16x16_bf16 v[0:3], v[28:29], v[72:73], v[0:3]
  ds_read_b128 v[52:55], v75 offset:32768
  v_mov_b64 v[22:23], 0
  v_mfma_f32_16x16x16_bf16 v[4:7], v[30:31], v[72:73], v[4:7]
  v_rcp_f32 v10, v8
  v_rcp_f32 v11, v9
  v_mul_f32 v0, v10, v0
  v_mul_f32 v1, v11, v1
  v_max3_f32 v8, v8, v9, v10
  v_mul_f32 v4, v10, v4
  v_mul_f32 v5, v11, v5
  v_cvt_pk_bf16_f32 v2, v0, v4
  ds_write_b32 v79, v2 offset:8704
  v_cvt_pk_bf16_f32 v3, v1, v5
  ds_write_b32 v79, v3 offset:9280
  ds_read_b128 v[12:15], v78 offset:8704
  v_max_f32 v8, v8, v11
  v_cmp_le_f32 vcc, 1317011456, v8
  v_mov_b64 v[24:25], 0
  v_mov_b64 v[26:27], 0
  ds_read_b128 v[56:59], v75 offset:33792
  s_cbranch_vccnz Cf0_mx
Cf0_mxok:
  s_waitcnt lgkmcnt(2)
  s_barrier
  ds_read_b128 v[0:3], v78 offset:8768
  s_waitcnt lgkmcnt(2)
  v_smfmac_f32_16x16x64_bf16 v[16:19], v[12:15], v[44:51], v74
  ds_read_b128 v[4:7], v78 offset:8832
  v_smfmac_f32_16x16x64_bf16 v[20:23], v[12:15], a[192:199], v74
  ds_read_b128 v[8:11], v78 offset:8896
  v_smfmac_f32_16x16x64_bf16 v[24:27], v[12:15], a[208:215], v74
  ds_read_b128 v[36:39], v75 offset:34816
  s_waitcnt lgkmcnt(3)
  v_smfmac_f32_16x16x64_bf16 v[16:19], v[0:3], v[60:67], v74
  ds_read_b128 v[40:43], v75 offset:35840
  s_waitcnt lgkmcnt(3)
  v_smfmac_f32_16x16x64_bf16 v[16:19], v[4:7], a[176:183], v74
  ds_read_b128 v[68:71], v76 offset:13824
  s_waitcnt lgkmcnt(3)
  v_smfmac_f32_16x16x64_bf16 v[16:19], v[8:11], a[184:191], v74
  ds_read_b128 v[44:47], v75 offset:49152
  v_smfmac_f32_16x16x64_bf16 v[20:23], v[0:3], a[200:207], v74
  ds_read_b128 v[48:51], v75 offset:50176
  v_smfmac_f32_16x16x64_bf16 v[20:23], v[4:7], v[52:59], v74
  ds_read_b128 v[60:63], v75 offset:51200
  s_waitcnt lgkmcnt(4)
  v_cvt_pk_bf16_f32 v16, v16, v17
  v_cvt_pk_bf16_f32 v17, v18, v19
  v_bfi_b32 v16, 1, s72, v16
  v_smfmac_f32_16x16x64_bf16 v[20:23], v[8:11], v[36:43], v74
  s_waitcnt lgkmcnt(3)
  buffer_store_dwordx2 v[16:17], v68, s[8:11], s73 offen
  v_mov_b64 v[32:33], 0
  v_smfmac_f32_16x16x64_bf16 v[24:27], v[0:3], a[216:223], v74
  ds_read_b128 v[64:67], v75 offset:52224
  v_mov_b64 v[34:35], 0
  v_smfmac_f32_16x16x64_bf16 v[24:27], v[4:7], a[224:231], v74
  v_cvt_pk_bf16_f32 v20, v20, v21
  v_cvt_pk_bf16_f32 v21, v22, v23
  v_bfi_b32 v20, 1, s72, v20
  v_smfmac_f32_16x16x64_bf16 v[24:27], v[8:11], a[232:239], v74
  buffer_store_dwordx2 v[20:21], v68, s[8:11], s74 offen
  s_waitcnt lgkmcnt(2)
  v_smfmac_f32_16x16x64_bf16 v[32:35], v[12:15], v[44:51], v74
  s_waitcnt lgkmcnt(0)
  v_smfmac_f32_16x16x64_bf16 v[32:35], v[0:3], v[60:67], v74
  v_cvt_pk_bf16_f32 v24, v24, v25
  v_cvt_pk_bf16_f32 v25, v26, v27
  v_bfi_b32 v24, 1, s72, v24
  v_smfmac_f32_16x16x64_bf16 v[32:35], v[4:7], a[240:247], v74
  buffer_store_dwordx2 v[24:25], v68, s[8:11], s75 offen
  v_smfmac_f32_16x16x64_bf16 v[32:35], v[8:11], a[248:255], v74
  v_mov_b64 v[18:19], v[72:73]
  s_nop 4
  v_cvt_pk_bf16_f32 v32, v32, v33
  v_cvt_pk_bf16_f32 v33, v34, v35
  v_bfi_b32 v32, 1, s72, v32
  buffer_store_dwordx2 v[32:33], v68, s[8:11], s76 offen
  ds_read_b128 v[0:3], v76 offset:14848
  s_waitcnt lgkmcnt(0)
  ds_read_b64 v[16:17], v77 offset:256
  s_waitcnt lgkmcnt(0)
  ds_read_b128 v[64:67], v76 offset:19456
  s_waitcnt lgkmcnt(0)
  v_xor_b32 v75, 0x8000, v75
  v_mov_b64 v[28:29], 0
  v_mov_b64 v[30:31], 0
  v_mov_b64 v[32:33], 0
  v_mov_b64 v[34:35], 0
  buffer_load_dwordx4 v[52:55], v76, s[8:11], s60 offen offset:0 sc1
  buffer_load_dwordx4 v[56:59], v76, s[8:11], s60 offen offset:1024 sc1
  s_add_u32 s66, s66, 1
  s_xor_b32 s64, s64, 16384
  s_xor_b32 s65, s65, 16384
  s_add_u32 s58, s58, 655360
  s_add_u32 s59, s59, 655360
  s_add_u32 s70, s70, 655360
  s_add_u32 s68, s68, 655360
  s_mov_b32 m0, 10752
  s_add_u32 s85, s65, 6144
  s_waitcnt lgkmcnt(0)
  s_waitcnt vmcnt(1)
  v_mfma_f32_16x16x32_bf16 v[4:7], v[0:3], v[52:55], 0
  v_bitop3_b32 v72, v52, v54, s72 bitop3:0x7e
  s_waitcnt vmcnt(0)
  v_mfma_f32_16x16x32_bf16 v[4:7], v[0:3], v[56:59], v[4:7]
  v_bitop3_b32 v73, v56, v58, s72 bitop3:0x7e
  v_bitop3_b32 v72, v72, v73, 1 bitop3:0xa8
  v_cmp_ne_u32 vcc, 0, v72
  s_nop 3
  v_add_f32_dpp v4, v4, v4 row_ror:4 row_mask:0xf bank_mask:0xf
  v_add_f32_dpp v5, v5, v5 row_ror:4 row_mask:0xf bank_mask:0xf
  s_cmp_eq_u64 vcc, 0
  v_add_f32_dpp v4, v4, v4 row_ror:8 row_mask:0xf bank_mask:0xf
  v_add_f32_dpp v5, v5, v5 row_ror:8 row_mask:0xf bank_mask:0xf
  s_cselect_b32 s54, s62, 268435456
  v_cvt_pk_bf16_f32 v4, v4, v5
  buffer_store_dword v4, v69, s[8:11], s54 offen
  s_cbranch_vccnz Cf0_h1r
  s_xor_b32 s62, s62, 16384
  buffer_store_dword v71, v69, s[8:11], s62 offen
  s_xor_b32 s72, s72, 1
  s_branch Cf0_h2
Cf0_h1r:
  s_mov_b64 exec, vcc
  buffer_load_dwordx4 v[52:55], v76, s[8:11], s60 offen offset:0 sc1
  buffer_load_dwordx4 v[56:59], v76, s[8:11], s60 offen offset:1024 sc1
  s_mov_b64 exec, -1
  s_add_u32 s67, s67, 1
  s_waitcnt vmcnt(1)
  v_mfma_f32_16x16x32_bf16 v[4:7], v[0:3], v[52:55], 0
  v_bitop3_b32 v72, v52, v54, s72 bitop3:0x7e
  s_waitcnt vmcnt(0)
  v_mfma_f32_16x16x32_bf16 v[4:7], v[0:3], v[56:59], v[4:7]
  v_bitop3_b32 v73, v56, v58, s72 bitop3:0x7e
  v_bitop3_b32 v72, v72, v73, 1 bitop3:0xa8
  v_cmp_ne_u32 vcc, 0, v72
  s_cbranch_vccz Cf0_h1p
Cf0_h1s:
  s_mov_b64 exec, vcc
  buffer_load_dwordx4 v[52:55], v76, s[8:11], s60 offen offset:0 sc1
  buffer_load_dwordx4 v[56:59], v76, s[8:11], s60 offen offset:1024 sc1
  s_mov_b64 exec, -1
  s_add_u32 s67, s67, 1
  s_waitcnt vmcnt(1)
  v_mfma_f32_16x16x32_bf16 v[4:7], v[0:3], v[52:55], 0
  v_bitop3_b32 v72, v52, v54, s72 bitop3:0x7e
  s_waitcnt vmcnt(0)
  v_mfma_f32_16x16x32_bf16 v[4:7], v[0:3], v[56:59], v[4:7]
  v_bitop3_b32 v73, v56, v58, s72 bitop3:0x7e
  v_bitop3_b32 v72, v72, v73, 1 bitop3:0xa8
  v_cmp_ne_u32 vcc, 0, v72
  s_cbranch_vccz Cf0_h1p
  s_cmp_lt_u32 s67, 131072
  s_cbranch_scc1 Cf0_h1s
Cf0_h1p:
  s_nop 2
  v_add_f32_dpp v4, v4, v4 row_ror:4 row_mask:0xf bank_mask:0xf
  v_add_f32_dpp v5, v5, v5 row_ror:4 row_mask:0xf bank_mask:0xf
  s_nop 0
  v_add_f32_dpp v4, v4, v4 row_ror:8 row_mask:0xf bank_mask:0xf
  v_add_f32_dpp v5, v5, v5 row_ror:8 row_mask:0xf bank_mask:0xf
  v_cvt_pk_bf16_f32 v4, v4, v5
  buffer_store_dword v4, v69, s[8:11], s62 offen
  s_xor_b32 s62, s62, 16384
  buffer_store_dword v71, v69, s[8:11], s62 offen
  s_xor_b32 s72, s72, 1
  s_branch Cf0_h2
Cf0_h2r:
  s_mov_b64 exec, vcc
  buffer_load_dwordx4 v[0:3], v76, s[8:11], s65 offen offset:0 sc1
  s_mov_b64 exec, -1
  s_add_u32 s67, s67, 1
  s_waitcnt vmcnt(4)
  v_max3_u32 v72, v0, v1, v2
  v_max_u32 v72, v72, v3
  ds_write_b128 v76, v[0:3] offset:4608
  v_cmp_eq_u32 vcc, -1, v72
  s_cbranch_vccz Cf0_h2w
  s_mov_b64 exec, vcc
  buffer_load_dwordx4 v[0:3], v76, s[8:11], s65 offen offset:0 sc1
  s_mov_b64 exec, -1
  s_add_u32 s67, s67, 1
  s_waitcnt vmcnt(4)
  v_max3_u32 v72, v0, v1, v2
  v_max_u32 v72, v72, v3
  ds_write_b128 v76, v[0:3] offset:4608
  v_cmp_eq_u32 vcc, -1, v72
  s_cbranch_vccz Cf0_h2w
Cf0_h2s:
  s_mov_b64 exec, vcc
  buffer_load_dwordx4 v[0:3], v76, s[8:11], s65 offen offset:0 sc1
  s_mov_b64 exec, -1
  s_add_u32 s67, s67, 1
  s_waitcnt vmcnt(2)
  v_max3_u32 v72, v0, v1, v2
  v_max_u32 v72, v72, v3
  ds_write_b128 v76, v[0:3] offset:4608
  v_cmp_eq_u32 vcc, -1, v72
  s_cbranch_vccz Cf0_h2w
  s_mov_b64 exec, vcc
  buffer_load_dwordx4 v[0:3], v76, s[8:11], s65 offen offset:0 sc1
  s_mov_b64 exec, -1
  s_add_u32 s67, s67, 1
  s_waitcnt vmcnt(2)
  v_max3_u32 v72, v0, v1, v2
  v_max_u32 v72, v72, v3
  ds_write_b128 v76, v[0:3] offset:4608
  v_cmp_eq_u32 vcc, -1, v72
  s_cbranch_vccz Cf0_h2w
  s_mov_b64 exec, vcc
  buffer_load_dwordx4 v[0:3], v76, s[8:11], s65 offen offset:0 sc1
  s_mov_b64 exec, -1
  s_add_u32 s67, s67, 1
  s_waitcnt vmcnt(2)
  v_max3_u32 v72, v0, v1, v2
  v_max_u32 v72, v72, v3
  ds_write_b128 v76, v[0:3] offset:4608
  v_cmp_eq_u32 vcc, -1, v72
  s_cbranch_vccz Cf0_h2w
  s_cmp_lt_u32 s67, 131072
  s_cbranch_scc1 Cf0_h2s
  s_branch Cf0_h2w
Cf0_rec:
  s_nop 7
  s_waitcnt vmcnt(0) lgkmcnt(0)
  v_max3_u32 v72, v0, v1, v2
  v_max3_u32 v72, v72, v3, v4
  v_max3_u32 v72, v72, v5, v6
  v_max3_u32 v72, v72, v7, v8
  v_max3_u32 v72, v72, v9, v10
  v_max3_u32 v72, v72, v11, v12
  v_max3_u32 v72, v72, v13, v14
  v_max3_u32 v72, v72, v15, v16
  v_max3_u32 v72, v72, v17, v18
  v_max_u32 v72, v72, v19
  v_cmp_eq_u32 vcc, -1, v72
  s_cbranch_vccz Cf0_recok
  s_barrier
  v_mov_b64 v[20:21], 0
  v_mov_b64 v[22:23], 0
  v_mov_b64 v[24:25], 0
  v_mov_b64 v[26:27], 0
  v_mov_b64 v[28:29], 0
  v_mov_b64 v[30:31], 0
  v_mov_b64 v[32:33], 0
  v_mov_b64 v[34:35], 0
  s_waitcnt lgkmcnt(0)
  s_barrier
  ds_read_b128 v[0:3], v76 offset:4608
  s_waitcnt lgkmcnt(0)
  v_smfmac_f32_16x16x64_bf16 v[20:23], v[0:3], v[80:87], v74
  v_smfmac_f32_16x16x64_bf16 v[24:27], v[0:3], v[88:95], v74
  ds_read_b128 v[60:63], v76 offset:16384
  ds_read_b128 v[64:67], v76 offset:17408
  s_waitcnt lgkmcnt(0)
  v_smfmac_f32_16x16x64_bf16 v[28:31], v[0:3], v[60:67], v74
  ds_read_b128 v[60:63], v76 offset:18432
  ds_read_b128 v[64:67], v76 offset:19456
  s_waitcnt lgkmcnt(0)
  v_smfmac_f32_16x16x64_bf16 v[32:35], v[0:3], v[60:67], v74
  ds_read_b128 v[4:7], v76 offset:5632
  s_waitcnt lgkmcnt(0)
  v_smfmac_f32_16x16x64_bf16 v[20:23], v[4:7], v[96:103], v74
  v_smfmac_f32_16x16x64_bf16 v[24:27], v[4:7], v[104:111], v74
  ds_read_b128 v[60:63], v76 offset:32768
  ds_read_b128 v[64:67], v76 offset:33792
  s_waitcnt lgkmcnt(0)
  v_smfmac_f32_16x16x64_bf16 v[28:31], v[4:7], v[60:67], v74
  ds_read_b128 v[60:63], v76 offset:34816
  ds_read_b128 v[64:67], v76 offset:35840
  s_waitcnt lgkmcnt(0)
  v_smfmac_f32_16x16x64_bf16 v[32:35], v[4:7], v[60:67], v74
  ds_read_b128 v[8:11], v76 offset:6656
  s_waitcnt lgkmcnt(0)
  v_smfmac_f32_16x16x64_bf16 v[20:23], v[8:11], v[112:119], v74
  v_smfmac_f32_16x16x64_bf16 v[24:27], v[8:11], v[120:127], v74
  v_smfmac_f32_16x16x64_bf16 v[28:31], v[8:11], v[208:215], v74
  v_smfmac_f32_16x16x64_bf16 v[32:35], v[8:11], v[216:223], v74
  ds_read_b128 v[12:15], v76 offset:7680
  s_waitcnt lgkmcnt(0)
  v_smfmac_f32_16x16x64_bf16 v[20:23], v[12:15], v[128:135], v74
  v_smfmac_f32_16x16x64_bf16 v[24:27], v[12:15], v[136:143], v74
  v_smfmac_f32_16x16x64_bf16 v[28:31], v[12:15], v[224:231], v74
  v_smfmac_f32_16x16x64_bf16 v[32:35], v[12:15], v[232:239], v74
  ds_read_b128 v[0:3], v76 offset:8704
  s_waitcnt lgkmcnt(0)
  v_smfmac_f32_16x16x64_bf16 v[20:23], v[0:3], v[144:151], v74
  v_smfmac_f32_16x16x64_bf16 v[24:27], v[0:3], v[152:159], v74
  ds_read_b128 v[60:63], v76 offset:49152
  ds_read_b128 v[64:67], v76 offset:50176
  s_waitcnt lgkmcnt(0)
  v_smfmac_f32_16x16x64_bf16 v[28:31], v[0:3], v[60:67], v74
  ds_read_b128 v[60:63], v76 offset:51200
  ds_read_b128 v[64:67], v76 offset:52224
  s_waitcnt lgkmcnt(0)
  v_smfmac_f32_16x16x64_bf16 v[32:35], v[0:3], v[60:67], v74
  ds_read_b128 v[8:11], v76 offset:9728
  s_waitcnt lgkmcnt(0)
  v_smfmac_f32_16x16x64_bf16 v[20:23], v[8:11], v[160:167], v74
  v_smfmac_f32_16x16x64_bf16 v[24:27], v[8:11], v[168:175], v74
  ds_read_b128 v[60:63], v75 offset:16384
  ds_read_b128 v[64:67], v75 offset:17408
  s_waitcnt lgkmcnt(0)
  v_smfmac_f32_16x16x64_bf16 v[28:31], v[8:11], v[60:67], v74
  ds_read_b128 v[60:63], v75 offset:18432
  ds_read_b128 v[64:67], v75 offset:19456
  s_waitcnt lgkmcnt(0)
  v_smfmac_f32_16x16x64_bf16 v[32:35], v[8:11], v[60:67], v74
  ds_read_b128 v[16:19], v76 offset:10752
  ds_read_b128 v[60:63], v75 offset:0
  ds_read_b128 v[64:67], v75 offset:1024
  s_waitcnt lgkmcnt(0)
  v_smfmac_f32_16x16x64_bf16 v[20:23], v[16:19], v[60:67], v74
  ds_read_b128 v[60:63], v75 offset:2048
  ds_read_b128 v[64:67], v75 offset:3072
  s_waitcnt lgkmcnt(0)
  v_smfmac_f32_16x16x64_bf16 v[24:27], v[16:19], v[60:67], v74
  v_smfmac_f32_16x16x64_bf16 v[28:31], v[16:19], v[240:247], v74
  v_smfmac_f32_16x16x64_bf16 v[32:35], v[16:19], v[248:255], v74
  ds_read_b128 v[4:7], v76 offset:11776
  s_waitcnt lgkmcnt(0)
  v_smfmac_f32_16x16x64_bf16 v[20:23], v[4:7], v[176:183], v74
  v_smfmac_f32_16x16x64_bf16 v[24:27], v[4:7], v[184:191], v74
  v_smfmac_f32_16x16x64_bf16 v[28:31], v[4:7], a[0:7], v74
  v_smfmac_f32_16x16x64_bf16 v[32:35], v[4:7], a[8:15], v74
  ds_read_b128 v[12:15], v76 offset:12800
  s_waitcnt lgkmcnt(0)
  v_smfmac_f32_16x16x64_bf16 v[20:23], v[12:15], v[192:199], v74
  v_smfmac_f32_16x16x64_bf16 v[24:27], v[12:15], v[200:207], v74
  v_smfmac_f32_16x16x64_bf16 v[28:31], v[12:15], a[16:23], v74
  v_smfmac_f32_16x16x64_bf16 v[32:35], v[12:15], a[24:31], v74
  v_add_f32 v20, v20, v22
  v_add_f32 v21, v21, v23
  v_add_f32 v24, v24, v26
  v_cvt_pk_bf16_f32 v22, v20, v24
  ds_write_b32 v79, v22 offset:0
  v_add_f32 v25, v25, v27
  v_cvt_pk_bf16_f32 v23, v21, v25
  ds_write_b32 v79, v23 offset:576
  v_add_f32 v28, v28, v30
  v_add_f32 v29, v29, v31
  s_waitcnt lgkmcnt(0)
  s_nop 1
  s_branch Cf0_recok
Cf0_mx:
  s_waitcnt lgkmcnt(0)
  s_barrier
  buffer_load_dwordx4 v[52:55], v76, s[8:11], s59 offen offset:0 sc1
  buffer_load_dwordx4 v[0:3], v76, s[8:11], s58 offen offset:0 sc1
  ds_read_b128 v[20:23], v77 offset:0
  ds_read_b128 v[28:31], v77 offset:256
  buffer_load_dwordx4 v[56:59], v76, s[8:11], s59 offen offset:1024 sc1
  buffer_load_dwordx4 v[4:7], v76, s[8:11], s58 offen offset:1024 sc1
  ds_read_b128 v[24:27], v77 offset:128
  ds_read_b128 v[32:35], v77 offset:384
  s_waitcnt vmcnt(2) lgkmcnt(3)
  v_mfma_f32_16x16x32_bf16 v[8:11], v[0:3], v[20:23], 0
  s_waitcnt vmcnt(0) lgkmcnt(1)
  v_mfma_f32_16x16x32_bf16 v[8:11], v[4:7], v[24:27], v[8:11]
  v_mfma_f32_16x16x32_bf16 v[12:15], v[28:31], v[20:23], 0
  s_waitcnt lgkmcnt(0)
  v_mfma_f32_16x16x32_bf16 v[12:15], v[32:35], v[24:27], v[12:15]
  v_add_f32_dpp v8, v10, v8 quad_perm:[2,3,0,1] row_mask:0xf bank_mask:0xf
  v_add_f32_dpp v9, v11, v9 quad_perm:[2,3,0,1] row_mask:0xf bank_mask:0xf
  s_nop 0
  v_mov_b32_dpp v8, v8 quad_perm:[0,1,0,1] row_mask:0xf bank_mask:0xf
  v_mov_b32_dpp v9, v9 quad_perm:[0,1,0,1] row_mask:0xf bank_mask:0xf
  s_nop 1
  v_add_f32_dpp v12, v14, v12 quad_perm:[2,3,0,1] row_mask:0xf bank_mask:0xf
  v_add_f32_dpp v13, v15, v13 quad_perm:[2,3,0,1] row_mask:0xf bank_mask:0xf
  s_nop 0
  v_mov_b32_dpp v12, v12 quad_perm:[0,1,0,1] row_mask:0xf bank_mask:0xf
  v_mov_b32_dpp v13, v13 quad_perm:[0,1,0,1] row_mask:0xf bank_mask:0xf
  v_mul_f32 v12, s69, v12
  ds_write_b32 v78, v8 offset:8704
  v_mul_f32 v13, s69, v13
  ds_write_b32 v78, v9 offset:8768
  s_waitcnt lgkmcnt(0)
  s_barrier
  ds_read_b128 v[36:39], v78 offset:8704
  ds_read_b128 v[40:43], v78 offset:8768
  s_waitcnt lgkmcnt(0)
  s_barrier
  v_max_f32 v16, v36, v37
  v_max3_f32 v16, v16, v38, v39
  v_max3_f32 v16, v16, v40, v41
  v_max3_f32 v16, v16, v42, v43
  v_max3_f32 v16, v16, v12, v13
  v_mov_b32 v17, v16
  s_nop 1
  v_permlane16_swap_b32 v16, v17
  v_max_f32 v16, v16, v17
  v_mov_b32 v17, v16
  s_nop 1
  v_permlane32_swap_b32 v16, v17
  v_max_f32 v16, v16, v17
  v_sub_f32 v36, v36, v16
  v_sub_f32 v37, v37, v16
  v_sub_f32 v38, v38, v16
  v_sub_f32 v39, v39, v16
  v_sub_f32 v40, v40, v16
  v_sub_f32 v41, v41, v16
  v_sub_f32 v42, v42, v16
  v_sub_f32 v43, v43, v16
  v_sub_f32 v12, v12, v16
  v_sub_f32 v13, v13, v16
  v_exp_f32 v36, v36
  v_exp_f32 v37, v37
  v_exp_f32 v38, v38
  v_exp_f32 v39, v39
  v_exp_f32 v40, v40
  v_exp_f32 v41, v41
  v_exp_f32 v42, v42
  v_exp_f32 v43, v43
  v_exp_f32 v12, v12
  v_exp_f32 v13, v13
  v_cvt_pk_bf16_f32 v32, v36, v40
  v_cvt_pk_bf16_f32 v33, v37, v41
  v_cvt_pk_bf16_f32 v34, v38, v42
  v_cvt_pk_bf16_f32 v35, v39, v43
  v_cvt_pk_bf16_f32 v28, v12, v13
  v_cvt_pk_bf16_f32 v31, v12, v13
  v_mov_b32 v29, 0
  v_mov_b32 v30, 0
  v_mfma_f32_16x16x32_bf16 v[8:11], v[32:35], v[68:71], 0
  v_mfma_f32_16x16x32_bf16 v[0:3], v[32:35], v[52:55], 0
  v_mfma_f32_16x16x32_bf16 v[4:7], v[32:35], v[56:59], 0
  v_mfma_f32_16x16x16_bf16 v[8:11], v[28:29], v[68:69], v[8:11]
  v_mfma_f32_16x16x16_bf16 v[0:3], v[28:29], v[72:73], v[0:3]
  v_mfma_f32_16x16x16_bf16 v[4:7], v[30:31], v[72:73], v[4:7]
  ds_read_b128 v[52:55], v75 offset:32768
  v_rcp_f32 v10, v8
  v_rcp_f32 v11, v9
  v_mul_f32 v0, v10, v0
  v_mul_f32 v1, v11, v1
  v_max3_f32 v8, v8, v9, v10
  v_mul_f32 v4, v10, v4
  v_mul_f32 v5, v11, v5
  v_cvt_pk_bf16_f32 v2, v0, v4
  ds_write_b32 v79, v2 offset:8704
  v_cvt_pk_bf16_f32 v3, v1, v5
  ds_write_b32 v79, v3 offset:9280
  ds_read_b128 v[12:15], v78 offset:8704
  ds_read_b128 v[56:59], v75 offset:33792
  v_mov_b64 v[16:17], 0
  v_mov_b64 v[18:19], 0
  v_mov_b64 v[20:21], 0
  v_mov_b64 v[22:23], 0
  v_mov_b64 v[24:25], 0
  v_mov_b64 v[26:27], 0
  s_branch Cf0_mxok
Cf0_kv3:
  s_waitcnt lgkmcnt(0)
  s_cmp_ge_u32 s57, 0x700
  s_cbranch_scc1 Cf0_kvb
  s_load_dword s57, s[12:13], s71 glc
  s_add_u32 s67, s67, 1
  s_cmp_lt_u32 s67, 131072
  s_cbranch_scc1 Cf0_kv3
  s_waitcnt lgkmcnt(0)
  s_branch Cf0_kvb
Cf0_last:
  ds_read_b128 v[4:7], v76 offset:5632
  ds_read_b128 v[12:15], v76 offset:7680
  ds_read_b128 v[44:47], v76 offset:32768
  ds_read_b128 v[48:51], v76 offset:33792
  s_nop 5
  v_mov_b64 v[20:21], 0
  v_mov_b64 v[22:23], 0
  v_mov_b64 v[24:25], 0
  v_mov_b64 v[26:27], 0
  v_smfmac_f32_16x16x64_bf16 v[28:31], v[0:3], v[36:43], v74
  ds_read_b128 v[36:39], v76 offset:34816
  ds_read_b128 v[40:43], v76 offset:35840
  v_smfmac_f32_16x16x64_bf16 v[32:35], v[0:3], v[60:67], v74
  s_waitcnt lgkmcnt(5)
  v_smfmac_f32_16x16x64_bf16 v[20:23], v[0:3], a[32:39], v74
  ds_read_b128 v[60:63], v76 offset:49152
  ds_read_b128 v[64:67], v76 offset:50176
  v_smfmac_f32_16x16x64_bf16 v[24:27], v[0:3], a[40:47], v74
  s_waitcnt lgkmcnt(4)
  v_smfmac_f32_16x16x64_bf16 v[20:23], v[4:7], a[48:55], v74
  buffer_store_dwordx4 v[16:19], v76, s[8:11], s68 offen sc1
  v_smfmac_f32_16x16x64_bf16 v[24:27], v[4:7], a[56:63], v74
  v_smfmac_f32_16x16x64_bf16 v[28:31], v[4:7], v[44:51], v74
  s_waitcnt lgkmcnt(2)
  v_smfmac_f32_16x16x64_bf16 v[20:23], v[8:11], a[64:71], v74
  ds_read_b128 v[44:47], v76 offset:51200
  ds_read_b128 v[48:51], v76 offset:52224
  v_smfmac_f32_16x16x64_bf16 v[24:27], v[8:11], a[72:79], v74
  v_smfmac_f32_16x16x64_bf16 v[32:35], v[4:7], v[36:43], v74
  v_smfmac_f32_16x16x64_bf16 v[28:31], v[8:11], v[208:215], v74
  ds_read_b128 v[36:39], v75 offset:16384
  ds_read_b128 v[40:43], v75 offset:17408
  v_smfmac_f32_16x16x64_bf16 v[32:35], v[8:11], v[216:223], v74
  v_smfmac_f32_16x16x64_bf16 v[20:23], v[12:15], a[80:87], v74
  v_smfmac_f32_16x16x64_bf16 v[24:27], v[12:15], a[88:95], v74
  v_smfmac_f32_16x16x64_bf16 v[28:31], v[12:15], v[224:231], v74
  v_smfmac_f32_16x16x64_bf16 v[32:35], v[12:15], v[232:239], v74
  s_waitcnt vmcnt(2)
  s_waitcnt vmcnt(1)
  s_barrier
Cf0_lastr:
  ds_read_b128 v[0:3], v76 offset:8704
  ds_read_b128 v[8:11], v76 offset:9728
  ds_read_b128 v[16:19], v76 offset:10752
  ds_read_b128 v[4:7], v76 offset:11776
  ds_read_b128 v[12:15], v76 offset:12800
  s_waitcnt lgkmcnt(4)
  v_max3_u32 v72, v0, v1, v2
  s_waitcnt lgkmcnt(1)
  v_max3_u32 v72, v72, v3, v4
  v_max3_u32 v72, v72, v5, v6
  v_max3_u32 v72, v72, v7, v8
  v_max3_u32 v72, v72, v9, v10
  s_waitcnt lgkmcnt(0)
  v_max3_u32 v72, v72, v11, v12
  v_max3_u32 v72, v72, v13, v14
  v_max3_u32 v72, v72, v15, v16
  v_max3_u32 v72, v72, v17, v18
  v_max_u32 v72, v72, v19
  v_cmp_eq_u32 vcc, -1, v72
  s_cbranch_vccnz Cf0_lastp
Cf0_lastg:
  v_smfmac_f32_16x16x64_bf16 v[28:31], v[0:3], v[60:67], v74
  ds_read_b128 v[60:63], v75 offset:18432
  ds_read_b128 v[64:67], v75 offset:19456
  v_smfmac_f32_16x16x64_bf16 v[32:35], v[0:3], v[44:51], v74
  v_smfmac_f32_16x16x64_bf16 v[28:31], v[8:11], v[36:43], v74
  v_smfmac_f32_16x16x64_bf16 v[28:31], v[16:19], v[240:247], v74
  v_smfmac_f32_16x16x64_bf16 v[28:31], v[4:7], a[0:7], v74
  v_smfmac_f32_16x16x64_bf16 v[28:31], v[12:15], a[16:23], v74
  v_smfmac_f32_16x16x64_bf16 v[32:35], v[16:19], v[248:255], v74
  v_smfmac_f32_16x16x64_bf16 v[32:35], v[4:7], a[8:15], v74
  s_waitcnt lgkmcnt(0)
  v_smfmac_f32_16x16x64_bf16 v[32:35], v[12:15], a[24:31], v74
  v_smfmac_f32_16x16x64_bf16 v[32:35], v[8:11], v[60:67], v74
  v_smfmac_f32_16x16x64_bf16 v[20:23], v[0:3], a[96:103], v74
  v_smfmac_f32_16x16x64_bf16 v[20:23], v[8:11], a[112:119], v74
  v_add_f32 v28, v28, v30
  v_add_f32 v32, v32, v34
  v_cvt_pk_bf16_f32 v30, v28, v32
  v_smfmac_f32_16x16x64_bf16 v[20:23], v[16:19], a[128:135], v74
  ds_write_b32 v79, v30 offset:256
  v_add_f32 v29, v29, v31
  v_add_f32 v33, v33, v35
  v_cvt_pk_bf16_f32 v31, v29, v33
  v_smfmac_f32_16x16x64_bf16 v[20:23], v[4:7], a[144:151], v74
  ds_write_b32 v79, v31 offset:832
  v_smfmac_f32_16x16x64_bf16 v[20:23], v[12:15], a[160:167], v74
  v_smfmac_f32_16x16x64_bf16 v[24:27], v[0:3], a[104:111], v74
  v_smfmac_f32_16x16x64_bf16 v[24:27], v[8:11], a[120:127], v74
  v_smfmac_f32_16x16x64_bf16 v[24:27], v[16:19], a[136:143], v74
  s_waitcnt lgkmcnt(0)
  s_barrier
  ds_read_b64 v[52:53], v77 offset:256
  v_add_f32 v20, v20, v22
  v_smfmac_f32_16x16x64_bf16 v[24:27], v[4:7], a[152:159], v74
  v_add_f32 v21, v21, v23
  v_smfmac_f32_16x16x64_bf16 v[24:27], v[12:15], a[168:175], v74
  v_cvt_pk_bf16_f32 v54, v20, v21
  s_add_u32 s68, s68, 655360
  s_nop 3
  v_add_f32 v24, v24, v26
  v_add_f32 v25, v25, v27
  v_cvt_pk_bf16_f32 v55, v24, v25
  s_waitcnt lgkmcnt(0)
  buffer_store_dwordx4 v[52:55], v76, s[8:11], s68 offen sc1
  s_branch Cf0_done
Cf0_lastp:
  s_add_u32 s72, s72, 2
  s_cmp_ge_u32 s72, 131072
  s_cbranch_scc1 Cf0_lastg
  s_barrier
  buffer_load_dwordx4 v76, s[8:11], s85 offen offset:0 sc1 lds
  s_waitcnt vmcnt(0)
  s_barrier
  s_branch Cf0_lastr
Cf0_done:
  s_branch L_cexit
L_w1:
  v_mov_b64 v[20:21], 0
  v_mov_b64 v[22:23], 0
  v_mov_b64 v[24:25], 0
  v_mov_b64 v[26:27], 0
  v_mov_b64 v[28:29], 0
  v_mov_b64 v[30:31], 0
  v_mov_b64 v[32:33], 0
  v_mov_b64 v[34:35], 0
  s_mov_b32 s78, 0x3f803f80
  s_mov_b32 s79, s78
  s_mov_b32 s65, 360448
  s_mov_b32 m0, 15872
  s_lshl_b32 s71, s53, 2
  s_add_u32 s71, s71, 128
  s_movk_i32 s56, 0x1000
  v_lshlrev_b32 v73, 2, v76
  v_mov_b32 v72, 0
  s_mov_b64 s[16:17], s[8:9]
  s_mov_b32 s18, 268435456
  s_mov_b32 s19, 0x20000
  s_getpc_b64 s[20:21]
Cf1_pc:
  s_add_u32 s20, s20, (Cf1_last - Cf1_pc)
  s_addc_u32 s21, s21, 0
  v_mov_b32 v68, 14880
  buffer_load_dwordx4 v[52:55], v76, s[8:11], s59 offen offset:0 sc1
  buffer_load_dwordx4 v[56:59], v76, s[8:11], s59 offen offset:1024 sc1
  ds_read_b128 v[36:39], v76 offset:20480
  ds_read_b128 v[40:43], v76 offset:21504
  ds_read_b128 v[60:63], v76 offset:22528
  ds_read_b128 v[64:67], v76 offset:23552
  ds_read_b128 v[0:3], v76 offset:4608
  ds_read_b128 v[4:7], v76 offset:5632
  ds_read_b128 v[8:11], v76 offset:6656
  ds_read_b128 v[12:15], v76 offset:7680
  s_waitcnt lgkmcnt(0)
  s_cmp_eq_u32 s66, 1
  s_branch Cf1_top2
.p2align 6
Cf1_h2:
  ds_read_b128 v[36:39], v76 offset:20480
  s_waitcnt lgkmcnt(0)
  v_lshlrev_b32 v73, 2, v76
  buffer_load_dwordx4 v[8:11], v76, s[8:11], s65 offen offset:2048 sc1
  ds_read_b128 v[40:43], v76 offset:21504
  s_waitcnt lgkmcnt(0)
  v_mov_b64 v[20:21], 0
  v_mov_b64 v[22:23], 0
  v_mov_b64 v[24:25], 0
  v_mov_b64 v[26:27], 0
  v_mov_b32 v68, 14880
  buffer_load_dwordx4 v[8:11], v76, s[8:11], s65 offen offset:2048 sc1
  ds_read_b128 v[60:63], v76 offset:22528
  s_waitcnt lgkmcnt(0)
  s_cmp_eq_u32 s66, 62
  s_cselect_b64 s[16:17], s[20:21], s[16:17]
  s_cselect_b32 s18, (Cf1_done - Cf1_last), s18
  s_cselect_b32 s70, 0, s70
  s_cmp_eq_u32 s66, 63
  s_cselect_b32 s59, 268435456, s59
  s_cselect_b32 s58, 268435456, s58
  buffer_load_dwordx4 v[8:11], v76, s[8:11], s65 offen offset:2048 sc1
  buffer_load_dwordx4 v[52:55], v76, s[8:11], s59 offen offset:0 sc1
  buffer_load_dwordx4 v[56:59], v76, s[8:11], s59 offen offset:1024 sc1
  s_waitcnt vmcnt(4)
  v_max3_u32 v72, v8, v9, v10
  v_max_u32 v72, v72, v11
  ds_write_b128 v76, v[8:11] offset:6656
  v_cmp_eq_u32 vcc, -1, v72
  s_cbranch_vccnz Cf1_h2r
Cf1_h2w:
  s_cmp_eq_u32 s66, 63
  s_waitcnt lgkmcnt(0)
  s_barrier
  ds_read_b128 v[0:3], v76 offset:4608
  buffer_load_dwordx4 v76, s[8:11], s85 offen offset:0 sc1 lds
Cf1_top2:
  v_smfmac_f32_16x16x64_bf16 v[20:23], v[8:11], v[112:119], v74
  s_cbranch_scc1 Cf1_last
  v_smfmac_f32_16x16x64_bf16 v[24:27], v[8:11], v[120:127], v74
  buffer_load_dwordx4 v[44:47], v76, s[8:11], s58 offen offset:0 sc1
  s_mov_b32 m0, 15872
  v_smfmac_f32_16x16x64_bf16 v[28:31], v[8:11], v[208:215], v74
  buffer_load_dwordx4 v[48:51], v76, s[8:11], s58 offen offset:1024 sc1
  v_smfmac_f32_16x16x64_bf16 v[32:35], v[8:11], v[216:223], v74
  ds_read_b128 v[4:7], v76 offset:5632
  s_waitcnt lgkmcnt(1)
  v_smfmac_f32_16x16x64_bf16 v[20:23], v[0:3], v[80:87], v74
  ds_read_b128 v[12:15], v76 offset:7680
  v_smfmac_f32_16x16x64_bf16 v[28:31], v[0:3], v[36:43], v74
  ds_read_b128 v[36:39], v76 offset:36864
  v_smfmac_f32_16x16x64_bf16 v[24:27], v[0:3], v[88:95], v74
  buffer_store_dwordx4 v[16:19], v76, s[8:11], s68 offen sc1
  ds_read_b128 v[40:43], v76 offset:37888
  v_smfmac_f32_16x16x64_bf16 v[32:35], v[0:3], v[60:67], v74
  buffer_load_dword v73, s[16:19], s70 offen lds
  ds_read_b128 v[60:63], v76 offset:38912
  s_waitcnt lgkmcnt(4)
  v_smfmac_f32_16x16x64_bf16 v[20:23], v[4:7], v[96:103], v74
  ds_read_b128 v[64:67], v76 offset:39936
  v_smfmac_f32_16x16x64_bf16 v[24:27], v[4:7], v[104:111], v74
  s_waitcnt vmcnt(5)
  s_waitcnt lgkmcnt(4)
  v_smfmac_f32_16x16x64_bf16 v[20:23], v[12:15], v[128:135], v74
  s_barrier
  ds_read_b128 v[8:11], v76 offset:8704
  s_waitcnt lgkmcnt(3)
  v_smfmac_f32_16x16x64_bf16 v[28:31], v[4:7], v[36:43], v74
  ds_read_b128 v[36:39], v76 offset:53248
  v_smfmac_f32_16x16x64_bf16 v[24:27], v[12:15], v[136:143], v74
  ds_read_b128 v[40:43], v76 offset:54272
  s_waitcnt lgkmcnt(3)
  v_smfmac_f32_16x16x64_bf16 v[32:35], v[4:7], v[60:67], v74
  ds_read_b128 v[0:3], v76 offset:9728
  v_smfmac_f32_16x16x64_bf16 v[28:31], v[12:15], v[224:231], v74
  ds_read_b128 v[60:63], v76 offset:55296
  v_smfmac_f32_16x16x64_bf16 v[32:35], v[12:15], v[232:239], v74
  s_waitcnt vmcnt(4)
  ds_read_b128 v[64:67], v76 offset:56320
  s_waitcnt lgkmcnt(5)
  v_smfmac_f32_16x16x64_bf16 v[20:23], v[8:11], v[144:151], v74
  s_barrier
  ds_read_b128 v[4:7], v76 offset:11776
  s_waitcnt lgkmcnt(4)
  v_smfmac_f32_16x16x64_bf16 v[28:31], v[8:11], v[36:43], v74
  ds_read_b128 v[12:15], v76 offset:12800
  ds_read_b128 v[36:39], v75 offset:4096
  v_smfmac_f32_16x16x64_bf16 v[24:27], v[8:11], v[152:159], v74
  ds_read_b128 v[16:19], v76 offset:10752
  s_waitcnt lgkmcnt(6)
  v_smfmac_f32_16x16x64_bf16 v[20:23], v[0:3], v[160:167], v74
  ds_read_b128 v[40:43], v75 offset:5120
  s_waitcnt lgkmcnt(5)
  v_smfmac_f32_16x16x64_bf16 v[32:35], v[8:11], v[60:67], v74
  ds_read_b128 v[60:63], v75 offset:6144
  v_smfmac_f32_16x16x64_bf16 v[24:27], v[0:3], v[168:175], v74
  ds_read_b128 v[64:67], v75 offset:7168
  s_waitcnt lgkmcnt(6)
  v_smfmac_f32_16x16x64_bf16 v[20:23], v[4:7], v[176:183], v74
  s_waitcnt lgkmcnt(5)
  v_smfmac_f32_16x16x64_bf16 v[20:23], v[12:15], v[192:199], v74
  s_waitcnt lgkmcnt(2)
  v_smfmac_f32_16x16x64_bf16 v[20:23], v[16:19], v[36:43], v74
  ds_read_b128 v[36:39], v75 offset:20480
  v_smfmac_f32_16x16x64_bf16 v[24:27], v[4:7], v[184:191], v74
  ds_read_b128 v[40:43], v75 offset:21504
  s_waitcnt lgkmcnt(2)
  v_smfmac_f32_16x16x64_bf16 v[24:27], v[16:19], v[60:67], v74
  ds_read_b128 v[60:63], v75 offset:22528
  v_add_f32 v20, v20, v22
  v_smfmac_f32_16x16x64_bf16 v[24:27], v[12:15], v[200:207], v74
  ds_read_b128 v[64:67], v75 offset:23552
  v_add_f32 v21, v21, v23
  v_smfmac_f32_16x16x64_bf16 v[28:31], v[16:19], v[240:247], v74
  v_mov_b64 v[70:71], s[78:79]
  v_smfmac_f32_16x16x64_bf16 v[28:31], v[4:7], a[0:7], v74
  s_waitcnt lgkmcnt(2)
  v_add_f32 v24, v24, v26
  v_smfmac_f32_16x16x64_bf16 v[28:31], v[0:3], v[36:43], v74
  ds_read_b128 v[36:39], v68
  v_cvt_pk_bf16_f32 v22, v20, v24
  v_smfmac_f32_16x16x64_bf16 v[28:31], v[12:15], a[16:23], v74
  ds_read_b128 v[40:43], v68
  ds_write_b32 v79, v22 offset:0
  s_waitcnt lgkmcnt(3)
  v_add_f32 v25, v25, v27
  v_cvt_pk_bf16_f32 v23, v21, v25
  v_smfmac_f32_16x16x64_bf16 v[32:35], v[0:3], v[60:67], v74
  ds_write_b32 v79, v23 offset:576
  v_cmp_u_f32 vcc, v20, v21
  v_smfmac_f32_16x16x64_bf16 v[32:35], v[16:19], v[248:255], v74
  v_add_f32 v28, v28, v30
  v_smfmac_f32_16x16x64_bf16 v[32:35], v[4:7], a[8:15], v74
  v_add_f32 v29, v29, v31
  v_smfmac_f32_16x16x64_bf16 v[32:35], v[12:15], a[24:31], v74
  s_cbranch_vccnz Cf1_rec
Cf1_recok:
  s_waitcnt lgkmcnt(3)
  v_smfmac_f32_16x16x64_bf16 v[36:39], v[16:19], a[128:135], v74
  s_waitcnt lgkmcnt(0)
  s_barrier
  ds_read_b128 v[60:63], v77
  v_smfmac_f32_16x16x64_bf16 v[40:43], v[16:19], a[136:143], v74
  ds_read_b128 v[64:67], v77 offset:128
  v_add_f32 v32, v32, v34
  v_cvt_pk_bf16_f32 v30, v28, v32
  v_smfmac_f32_16x16x64_bf16 v[36:39], v[0:3], a[112:119], v74
  ds_write_b32 v79, v30 offset:256
  v_add_f32 v33, v33, v35
  v_cvt_pk_bf16_f32 v31, v29, v33
  v_smfmac_f32_16x16x64_bf16 v[40:43], v[0:3], a[120:127], v74
  ds_write_b32 v79, v31 offset:832
  v_xor_b32 v75, 0x8000, v75
  v_smfmac_f32_16x16x64_bf16 v[36:39], v[4:7], a[144:151], v74
  ds_read_b128 v[0:3], v76 offset:4608
  v_mov_b32 v29, 0
  v_smfmac_f32_16x16x64_bf16 v[40:43], v[4:7], a[152:159], v74
  s_waitcnt vmcnt(2) lgkmcnt(3)
  v_mov_b32 v30, 0
  v_mfma_f32_16x16x32_bf16 v[44:47], v[44:47], v[60:63], 0
  ds_read_b128 v[4:7], v76 offset:5632
  s_waitcnt lgkmcnt(2)
  v_mfma_f32_16x16x32_bf16 v[44:47], v[48:51], v[64:67], v[44:47]
  s_barrier
  v_smfmac_f32_16x16x64_bf16 v[36:39], v[8:11], a[96:103], v74
  ds_read_b128 v[20:23], v77 offset:256
  ds_read_b128 v[24:27], v77 offset:384
  v_smfmac_f32_16x16x64_bf16 v[40:43], v[8:11], a[104:111], v74
  ds_read_b128 v[8:11], v76 offset:6656
  v_add_f32_dpp v72, v46, v44 quad_perm:[2,3,0,1] row_mask:0xf bank_mask:0xf
  v_add_f32_dpp v73, v47, v45 quad_perm:[2,3,0,1] row_mask:0xf bank_mask:0xf
  v_smfmac_f32_16x16x64_bf16 v[36:39], v[12:15], a[160:167], v74
  s_waitcnt lgkmcnt(4)
  v_exp_f32_dpp v72, v72 quad_perm:[0,1,0,1] row_mask:0xf bank_mask:0xf
  v_smfmac_f32_16x16x64_bf16 v[40:43], v[12:15], a[168:175], v74
  ds_read_b128 v[12:15], v76 offset:7680
  v_exp_f32_dpp v73, v73 quad_perm:[0,1,0,1] row_mask:0xf bank_mask:0xf
  v_smfmac_f32_16x16x64_bf16 v[36:39], v[0:3], a[32:39], v74
  s_waitcnt lgkmcnt(2)
  v_cvt_pk_bf16_f32 v72, v72, v73
  v_mfma_f32_16x16x32_bf16 v[20:23], v[20:23], v[60:63], 0
  ds_write_b32 v78, v72 offset:516
  v_mov_b64 v[16:17], 0
  v_mfma_f32_16x16x32_bf16 v[20:23], v[24:27], v[64:67], v[20:23]
  ds_read_b128 v[44:47], v75 offset:22528
  v_mov_b64 v[18:19], 0
  v_smfmac_f32_16x16x64_bf16 v[40:43], v[0:3], a[40:47], v74
  ds_read_b128 v[48:51], v75 offset:23552
  v_mov_b64 v[68:69], s[78:79]
  v_smfmac_f32_16x16x64_bf16 v[36:39], v[4:7], a[48:55], v74
  s_waitcnt lgkmcnt(4)
  v_add_f32_dpp v24, v22, v20 quad_perm:[2,3,0,1] row_mask:0xf bank_mask:0xf
  v_add_f32_dpp v25, v23, v21 quad_perm:[2,3,0,1] row_mask:0xf bank_mask:0xf
  v_smfmac_f32_16x16x64_bf16 v[36:39], v[8:11], a[64:71], v74
  s_waitcnt lgkmcnt(2)
  s_barrier
  ds_read_b128 v[32:35], v78 offset:512
  v_smfmac_f32_16x16x64_bf16 v[36:39], v[12:15], a[80:87], v74
  ds_read_b128 v[60:63], v75 offset:20480
  v_mul_f32 v24, s69, v24
  v_smfmac_f32_16x16x64_bf16 v[40:43], v[4:7], a[56:63], v74
  ds_read_b128 v[64:67], v75 offset:21504
  v_mul_f32 v25, s69, v25
  v_smfmac_f32_16x16x64_bf16 v[40:43], v[8:11], a[72:79], v74
  v_exp_f32_dpp v24, v24 quad_perm:[0,1,0,1] row_mask:0xf bank_mask:0xf
  v_smfmac_f32_16x16x64_bf16 v[40:43], v[12:15], a[88:95], v74
  s_waitcnt lgkmcnt(2)
  v_exp_f32_dpp v25, v25 quad_perm:[0,1,0,1] row_mask:0xf bank_mask:0xf
  v_mfma_f32_16x16x32_bf16 v[8:11], v[32:35], v[68:71], 0
  v_add_f32 v36, v36, v38
  v_add_f32 v37, v37, v39
  v_mfma_f32_16x16x32_bf16 v[0:3], v[32:35], v[52:55], 0
  v_add_f32 v40, v40, v42
  v_add_f32 v41, v41, v43
  v_mfma_f32_16x16x32_bf16 v[4:7], v[32:35], v[56:59], 0
  v_cvt_pk_bf16_f32 v28, v24, v25
  v_cvt_pk_bf16_f32 v72, v36, v37
  v_cvt_pk_bf16_f32 v73, v40, v41
  v_mfma_f32_16x16x16_bf16 v[8:11], v[28:29], v[68:69], v[8:11]
  v_cvt_pk_bf16_f32 v31, v24, v25
  v_mov_b64 v[20:21], 0
  v_mfma_f32_16x16x16_bf16 v[0:3], v[28:29], v[72:73], v[0:3]
  ds_read_b128 v[52:55], v75 offset:36864
  v_mov_b64 v[22:23], 0
  v_mfma_f32_16x16x16_bf16 v[4:7], v[30:31], v[72:73], v[4:7]
  v_rcp_f32 v10, v8
  v_rcp_f32 v11, v9
  v_mul_f32 v0, v10, v0
  v_mul_f32 v1, v11, v1
  v_max3_f32 v8, v8, v9, v10
  v_mul_f32 v4, v10, v4
  v_mul_f32 v5, v11, v5
  v_cvt_pk_bf16_f32 v2, v0, v4
  ds_write_b32 v79, v2 offset:8704
  v_cvt_pk_bf16_f32 v3, v1, v5
  ds_write_b32 v79, v3 offset:9280
  ds_read_b128 v[12:15], v78 offset:8768
  v_max_f32 v8, v8, v11
  v_cmp_le_f32 vcc, 1317011456, v8
  v_mov_b64 v[24:25], 0
  v_mov_b64 v[26:27], 0
  ds_read_b128 v[56:59], v75 offset:37888
  s_cbranch_vccnz Cf1_mx
Cf1_mxok:
  s_waitcnt lgkmcnt(2)
  s_barrier
  ds_read_b128 v[0:3], v78 offset:8704
  s_waitcnt lgkmcnt(2)
  v_smfmac_f32_16x16x64_bf16 v[16:19], v[12:15], v[44:51], v74
  ds_read_b128 v[4:7], v78 offset:8832
  v_smfmac_f32_16x16x64_bf16 v[20:23], v[12:15], a[200:207], v74
  ds_read_b128 v[8:11], v78 offset:8896
  v_smfmac_f32_16x16x64_bf16 v[24:27], v[12:15], a[216:223], v74
  ds_read_b128 v[36:39], v75 offset:38912
  s_waitcnt lgkmcnt(3)
  v_smfmac_f32_16x16x64_bf16 v[16:19], v[0:3], v[60:67], v74
  ds_read_b128 v[40:43], v75 offset:39936
  s_waitcnt lgkmcnt(3)
  v_smfmac_f32_16x16x64_bf16 v[16:19], v[4:7], a[176:183], v74
  ds_read_b128 v[68:71], v76 offset:13824
  s_waitcnt lgkmcnt(3)
  v_smfmac_f32_16x16x64_bf16 v[16:19], v[8:11], a[184:191], v74
  ds_read_b128 v[44:47], v75 offset:53248
  v_smfmac_f32_16x16x64_bf16 v[20:23], v[0:3], a[192:199], v74
  ds_read_b128 v[48:51], v75 offset:54272
  v_smfmac_f32_16x16x64_bf16 v[20:23], v[4:7], v[52:59], v74
  ds_read_b128 v[60:63], v75 offset:55296
  s_waitcnt lgkmcnt(4)
  v_cvt_pk_bf16_f32 v16, v16, v17
  v_cvt_pk_bf16_f32 v17, v18, v19
  v_bfi_b32 v16, 1, s72, v16
  v_smfmac_f32_16x16x64_bf16 v[20:23], v[8:11], v[36:43], v74
  s_waitcnt lgkmcnt(3)
  buffer_store_dwordx2 v[16:17], v68, s[8:11], s73 offen
  v_mov_b64 v[32:33], 0
  v_smfmac_f32_16x16x64_bf16 v[24:27], v[0:3], a[208:215], v74
  ds_read_b128 v[64:67], v75 offset:56320
  v_mov_b64 v[34:35], 0
  v_smfmac_f32_16x16x64_bf16 v[24:27], v[4:7], a[224:231], v74
  v_cvt_pk_bf16_f32 v20, v20, v21
  v_cvt_pk_bf16_f32 v21, v22, v23
  v_bfi_b32 v20, 1, s72, v20
  v_smfmac_f32_16x16x64_bf16 v[24:27], v[8:11], a[232:239], v74
  buffer_store_dwordx2 v[20:21], v68, s[8:11], s74 offen
  s_waitcnt lgkmcnt(2)
  v_smfmac_f32_16x16x64_bf16 v[32:35], v[0:3], v[44:51], v74
  s_waitcnt lgkmcnt(0)
  v_smfmac_f32_16x16x64_bf16 v[32:35], v[12:15], v[60:67], v74
  v_cvt_pk_bf16_f32 v24, v24, v25
  v_cvt_pk_bf16_f32 v25, v26, v27
  v_bfi_b32 v24, 1, s72, v24
  v_smfmac_f32_16x16x64_bf16 v[32:35], v[4:7], a[240:247], v74
  buffer_store_dwordx2 v[24:25], v68, s[8:11], s75 offen
  v_smfmac_f32_16x16x64_bf16 v[32:35], v[8:11], a[248:255], v74
  v_mov_b64 v[18:19], v[72:73]
  s_nop 4
  v_cvt_pk_bf16_f32 v32, v32, v33
  v_cvt_pk_bf16_f32 v33, v34, v35
  v_bfi_b32 v32, 1, s72, v32
  buffer_store_dwordx2 v[32:33], v68, s[8:11], s76 offen
  ds_read_b128 v[0:3], v76 offset:14848
  s_waitcnt lgkmcnt(0)
  ds_read_b64 v[16:17], v77 offset:264
  s_waitcnt lgkmcnt(0)
  ds_read_b128 v[64:67], v76 offset:23552
  s_waitcnt lgkmcnt(0)
  s_add_u32 s66, s66, 1
  s_xor_b32 s64, s64, 16384
  s_xor_b32 s65, s65, 16384
  s_add_u32 s58, s58, 655360
  s_add_u32 s59, s59, 655360
  s_add_u32 s70, s70, 655360
  s_add_u32 s68, s68, 655360
  s_mov_b32 m0, 11776
  s_add_u32 s85, s65, 7168
  v_xor_b32 v75, 0x8000, v75
  v_mov_b64 v[28:29], 0
  v_mov_b64 v[30:31], 0
  v_mov_b64 v[32:33], 0
  v_mov_b64 v[34:35], 0
  buffer_load_dwordx4 v[52:55], v76, s[8:11], s60 offen offset:0 sc1
  buffer_load_dwordx4 v[56:59], v76, s[8:11], s60 offen offset:1024 sc1
  s_waitcnt lgkmcnt(0)
  s_waitcnt vmcnt(1)
  v_mfma_f32_16x16x32_bf16 v[4:7], v[0:3], v[52:55], 0
  v_bitop3_b32 v72, v52, v54, s72 bitop3:0x7e
  s_waitcnt vmcnt(0)
  v_mfma_f32_16x16x32_bf16 v[4:7], v[0:3], v[56:59], v[4:7]
  v_bitop3_b32 v73, v56, v58, s72 bitop3:0x7e
  v_bitop3_b32 v72, v72, v73, 1 bitop3:0xa8
  v_cmp_ne_u32 vcc, 0, v72
  s_nop 3
  v_add_f32_dpp v4, v4, v4 row_ror:4 row_mask:0xf bank_mask:0xf
  v_add_f32_dpp v5, v5, v5 row_ror:4 row_mask:0xf bank_mask:0xf
  s_cmp_eq_u64 vcc, 0
  v_add_f32_dpp v4, v4, v4 row_ror:8 row_mask:0xf bank_mask:0xf
  v_add_f32_dpp v5, v5, v5 row_ror:8 row_mask:0xf bank_mask:0xf
  s_cselect_b32 s54, s62, 268435456
  v_cvt_pk_bf16_f32 v4, v4, v5
  buffer_store_dword v4, v69, s[8:11], s54 offen
  s_cbranch_vccnz Cf1_h1r
  s_xor_b32 s62, s62, 16384
  buffer_store_dword v71, v69, s[8:11], s62 offen
  s_xor_b32 s72, s72, 1
  s_branch Cf1_h2
Cf1_h1r:
  s_mov_b64 exec, vcc
  buffer_load_dwordx4 v[52:55], v76, s[8:11], s60 offen offset:0 sc1
  buffer_load_dwordx4 v[56:59], v76, s[8:11], s60 offen offset:1024 sc1
  s_mov_b64 exec, -1
  s_add_u32 s67, s67, 1
  s_waitcnt vmcnt(1)
  v_mfma_f32_16x16x32_bf16 v[4:7], v[0:3], v[52:55], 0
  v_bitop3_b32 v72, v52, v54, s72 bitop3:0x7e
  s_waitcnt vmcnt(0)
  v_mfma_f32_16x16x32_bf16 v[4:7], v[0:3], v[56:59], v[4:7]
  v_bitop3_b32 v73, v56, v58, s72 bitop3:0x7e
  v_bitop3_b32 v72, v72, v73, 1 bitop3:0xa8
  v_cmp_ne_u32 vcc, 0, v72
  s_cbranch_vccz Cf1_h1p
Cf1_h1s:
  s_mov_b64 exec, vcc
  buffer_load_dwordx4 v[52:55], v76, s[8:11], s60 offen offset:0 sc1
  buffer_load_dwordx4 v[56:59], v76, s[8:11], s60 offen offset:1024 sc1
  s_mov_b64 exec, -1
  s_add_u32 s67, s67, 1
  s_waitcnt vmcnt(1)
  v_mfma_f32_16x16x32_bf16 v[4:7], v[0:3], v[52:55], 0
  v_bitop3_b32 v72, v52, v54, s72 bitop3:0x7e
  s_waitcnt vmcnt(0)
  v_mfma_f32_16x16x32_bf16 v[4:7], v[0:3], v[56:59], v[4:7]
  v_bitop3_b32 v73, v56, v58, s72 bitop3:0x7e
  v_bitop3_b32 v72, v72, v73, 1 bitop3:0xa8
  v_cmp_ne_u32 vcc, 0, v72
  s_cbranch_vccz Cf1_h1p
  s_cmp_lt_u32 s67, 131072
  s_cbranch_scc1 Cf1_h1s
Cf1_h1p:
  s_nop 2
  v_add_f32_dpp v4, v4, v4 row_ror:4 row_mask:0xf bank_mask:0xf
  v_add_f32_dpp v5, v5, v5 row_ror:4 row_mask:0xf bank_mask:0xf
  s_nop 0
  v_add_f32_dpp v4, v4, v4 row_ror:8 row_mask:0xf bank_mask:0xf
  v_add_f32_dpp v5, v5, v5 row_ror:8 row_mask:0xf bank_mask:0xf
  v_cvt_pk_bf16_f32 v4, v4, v5
  buffer_store_dword v4, v69, s[8:11], s62 offen
  s_xor_b32 s62, s62, 16384
  buffer_store_dword v71, v69, s[8:11], s62 offen
  s_xor_b32 s72, s72, 1
  s_branch Cf1_h2
Cf1_h2r:
  s_mov_b64 exec, vcc
  buffer_load_dwordx4 v[8:11], v76, s[8:11], s65 offen offset:2048 sc1
  s_mov_b64 exec, -1
  s_add_u32 s67, s67, 1
  s_waitcnt vmcnt(4)
  v_max3_u32 v72, v8, v9, v10
  v_max_u32 v72, v72, v11
  ds_write_b128 v76, v[8:11] offset:6656
  v_cmp_eq_u32 vcc, -1, v72
  s_cbranch_vccz Cf1_h2w
  s_mov_b64 exec, vcc
  buffer_load_dwordx4 v[8:11], v76, s[8:11], s65 offen offset:2048 sc1
  s_mov_b64 exec, -1
  s_add_u32 s67, s67, 1
  s_waitcnt vmcnt(4)
  v_max3_u32 v72, v8, v9, v10
  v_max_u32 v72, v72, v11
  ds_write_b128 v76, v[8:11] offset:6656
  v_cmp_eq_u32 vcc, -1, v72
  s_cbranch_vccz Cf1_h2w
Cf1_h2s:
  s_mov_b64 exec, vcc
  buffer_load_dwordx4 v[8:11], v76, s[8:11], s65 offen offset:2048 sc1
  s_mov_b64 exec, -1
  s_add_u32 s67, s67, 1
  s_waitcnt vmcnt(2)
  v_max3_u32 v72, v8, v9, v10
  v_max_u32 v72, v72, v11
  ds_write_b128 v76, v[8:11] offset:6656
  v_cmp_eq_u32 vcc, -1, v72
  s_cbranch_vccz Cf1_h2w
  s_mov_b64 exec, vcc
  buffer_load_dwordx4 v[8:11], v76, s[8:11], s65 offen offset:2048 sc1
  s_mov_b64 exec, -1
  s_add_u32 s67, s67, 1
  s_waitcnt vmcnt(2)
  v_max3_u32 v72, v8, v9, v10
  v_max_u32 v72, v72, v11
  ds_write_b128 v76, v[8:11] offset:6656
  v_cmp_eq_u32 vcc, -1, v72
  s_cbranch_vccz Cf1_h2w
  s_mov_b64 exec, vcc
  buffer_load_dwordx4 v[8:11], v76, s[8:11], s65 offen offset:2048 sc1
  s_mov_b64 exec, -1
  s_add_u32 s67, s67, 1
  s_waitcnt vmcnt(2)
  v_max3_u32 v72, v8, v9, v10
  v_max_u32 v72, v72, v11
  ds_write_b128 v76, v[8:11] offset:6656
  v_cmp_eq_u32 vcc, -1, v72
  s_cbranch_vccz Cf1_h2w
  s_cmp_lt_u32 s67, 131072
  s_cbranch_scc1 Cf1_h2s
  s_branch Cf1_h2w
Cf1_rec:
  s_nop 7
  s_waitcnt vmcnt(0) lgkmcnt(0)
  v_max3_u32 v72, v0, v1, v2
  v_max3_u32 v72, v72, v3, v4
  v_max3_u32 v72, v72, v5, v6
  v_max3_u32 v72, v72, v7, v8
  v_max3_u32 v72, v72, v9, v10
  v_max3_u32 v72, v72, v11, v12
  v_max3_u32 v72, v72, v13, v14
  v_max3_u32 v72, v72, v15, v16
  v_max3_u32 v72, v72, v17, v18
  v_max_u32 v72, v72, v19
  v_cmp_eq_u32 vcc, -1, v72
  s_cbranch_vccz Cf1_recok
  s_barrier
  v_mov_b64 v[20:21], 0
  v_mov_b64 v[22:23], 0
  v_mov_b64 v[24:25], 0
  v_mov_b64 v[26:27], 0
  v_mov_b64 v[28:29], 0
  v_mov_b64 v[30:31], 0
  v_mov_b64 v[32:33], 0
  v_mov_b64 v[34:35], 0
  s_waitcnt lgkmcnt(0)
  s_barrier
  ds_read_b128 v[0:3], v76 offset:4608
  s_waitcnt lgkmcnt(0)
  v_smfmac_f32_16x16x64_bf16 v[20:23], v[0:3], v[80:87], v74
  v_smfmac_f32_16x16x64_bf16 v[24:27], v[0:3], v[88:95], v74
  ds_read_b128 v[60:63], v76 offset:20480
  ds_read_b128 v[64:67], v76 offset:21504
  s_waitcnt lgkmcnt(0)
  v_smfmac_f32_16x16x64_bf16 v[28:31], v[0:3], v[60:67], v74
  ds_read_b128 v[60:63], v76 offset:22528
  ds_read_b128 v[64:67], v76 offset:23552
  s_waitcnt lgkmcnt(0)
  v_smfmac_f32_16x16x64_bf16 v[32:35], v[0:3], v[60:67], v74
  ds_read_b128 v[4:7], v76 offset:5632
  s_waitcnt lgkmcnt(0)
  v_smfmac_f32_16x16x64_bf16 v[20:23], v[4:7], v[96:103], v74
  v_smfmac_f32_16x16x64_bf16 v[24:27], v[4:7], v[104:111], v74
  ds_read_b128 v[60:63], v76 offset:36864
  ds_read_b128 v[64:67], v76 offset:37888
  s_waitcnt lgkmcnt(0)
  v_smfmac_f32_16x16x64_bf16 v[28:31], v[4:7], v[60:67], v74
  ds_read_b128 v[60:63], v76 offset:38912
  ds_read_b128 v[64:67], v76 offset:39936
  s_waitcnt lgkmcnt(0)
  v_smfmac_f32_16x16x64_bf16 v[32:35], v[4:7], v[60:67], v74
  ds_read_b128 v[8:11], v76 offset:6656
  s_waitcnt lgkmcnt(0)
  v_smfmac_f32_16x16x64_bf16 v[20:23], v[8:11], v[112:119], v74
  v_smfmac_f32_16x16x64_bf16 v[24:27], v[8:11], v[120:127], v74
  v_smfmac_f32_16x16x64_bf16 v[28:31], v[8:11], v[208:215], v74
  v_smfmac_f32_16x16x64_bf16 v[32:35], v[8:11], v[216:223], v74
  ds_read_b128 v[12:15], v76 offset:7680
  s_waitcnt lgkmcnt(0)
  v_smfmac_f32_16x16x64_bf16 v[20:23], v[12:15], v[128:135], v74
  v_smfmac_f32_16x16x64_bf16 v[24:27], v[12:15], v[136:143], v74
  v_smfmac_f32_16x16x64_bf16 v[28:31], v[12:15], v[224:231], v74
  v_smfmac_f32_16x16x64_bf16 v[32:35], v[12:15], v[232:239], v74
  ds_read_b128 v[8:11], v76 offset:8704
  s_waitcnt lgkmcnt(0)
  v_smfmac_f32_16x16x64_bf16 v[20:23], v[8:11], v[144:151], v74
  v_smfmac_f32_16x16x64_bf16 v[24:27], v[8:11], v[152:159], v74
  ds_read_b128 v[60:63], v76 offset:53248
  ds_read_b128 v[64:67], v76 offset:54272
  s_waitcnt lgkmcnt(0)
  v_smfmac_f32_16x16x64_bf16 v[28:31], v[8:11], v[60:67], v74
  ds_read_b128 v[60:63], v76 offset:55296
  ds_read_b128 v[64:67], v76 offset:56320
  s_waitcnt lgkmcnt(0)
  v_smfmac_f32_16x16x64_bf16 v[32:35], v[8:11], v[60:67], v74
  ds_read_b128 v[0:3], v76 offset:9728
  s_waitcnt lgkmcnt(0)
  v_smfmac_f32_16x16x64_bf16 v[20:23], v[0:3], v[160:167], v74
  v_smfmac_f32_16x16x64_bf16 v[24:27], v[0:3], v[168:175], v74
  ds_read_b128 v[60:63], v75 offset:20480
  ds_read_b128 v[64:67], v75 offset:21504
  s_waitcnt lgkmcnt(0)
  v_smfmac_f32_16x16x64_bf16 v[28:31], v[0:3], v[60:67], v74
  ds_read_b128 v[60:63], v75 offset:22528
  ds_read_b128 v[64:67], v75 offset:23552
  s_waitcnt lgkmcnt(0)
  v_smfmac_f32_16x16x64_bf16 v[32:35], v[0:3], v[60:67], v74
  ds_read_b128 v[16:19], v76 offset:10752
  ds_read_b128 v[60:63], v75 offset:4096
  ds_read_b128 v[64:67], v75 offset:5120
  s_waitcnt lgkmcnt(0)
  v_smfmac_f32_16x16x64_bf16 v[20:23], v[16:19], v[60:67], v74
  ds_read_b128 v[60:63], v75 offset:6144
  ds_read_b128 v[64:67], v75 offset:7168
  s_waitcnt lgkmcnt(0)
  v_smfmac_f32_16x16x64_bf16 v[24:27], v[16:19], v[60:67], v74
  v_smfmac_f32_16x16x64_bf16 v[28:31], v[16:19], v[240:247], v74
  v_smfmac_f32_16x16x64_bf16 v[32:35], v[16:19], v[248:255], v74
  ds_read_b128 v[4:7], v76 offset:11776
  s_waitcnt lgkmcnt(0)
  v_smfmac_f32_16x16x64_bf16 v[20:23], v[4:7], v[176:183], v74
  v_smfmac_f32_16x16x64_bf16 v[24:27], v[4:7], v[184:191], v74
  v_smfmac_f32_16x16x64_bf16 v[28:31], v[4:7], a[0:7], v74
  v_smfmac_f32_16x16x64_bf16 v[32:35], v[4:7], a[8:15], v74
  ds_read_b128 v[12:15], v76 offset:12800
  s_waitcnt lgkmcnt(0)
  v_smfmac_f32_16x16x64_bf16 v[20:23], v[12:15], v[192:199], v74
  v_smfmac_f32_16x16x64_bf16 v[24:27], v[12:15], v[200:207], v74
  v_smfmac_f32_16x16x64_bf16 v[28:31], v[12:15], a[16:23], v74
  v_smfmac_f32_16x16x64_bf16 v[32:35], v[12:15], a[24:31], v74
  v_add_f32 v20, v20, v22
  v_add_f32 v21, v21, v23
  v_add_f32 v24, v24, v26
  v_cvt_pk_bf16_f32 v22, v20, v24
  ds_write_b32 v79, v22 offset:0
  v_add_f32 v25, v25, v27
  v_cvt_pk_bf16_f32 v23, v21, v25
  ds_write_b32 v79, v23 offset:576
  v_add_f32 v28, v28, v30
  v_add_f32 v29, v29, v31
  s_waitcnt lgkmcnt(0)
  s_nop 1
  s_branch Cf1_recok
Cf1_mx:
  s_waitcnt lgkmcnt(0)
  s_barrier
  buffer_load_dwordx4 v[52:55], v76, s[8:11], s59 offen offset:0 sc1
  buffer_load_dwordx4 v[0:3], v76, s[8:11], s58 offen offset:0 sc1
  ds_read_b128 v[20:23], v77 offset:0
  ds_read_b128 v[28:31], v77 offset:256
  buffer_load_dwordx4 v[56:59], v76, s[8:11], s59 offen offset:1024 sc1
  buffer_load_dwordx4 v[4:7], v76, s[8:11], s58 offen offset:1024 sc1
  ds_read_b128 v[24:27], v77 offset:128
  ds_read_b128 v[32:35], v77 offset:384
  s_waitcnt vmcnt(2) lgkmcnt(3)
  v_mfma_f32_16x16x32_bf16 v[8:11], v[0:3], v[20:23], 0
  s_waitcnt vmcnt(0) lgkmcnt(1)
  v_mfma_f32_16x16x32_bf16 v[8:11], v[4:7], v[24:27], v[8:11]
  v_mfma_f32_16x16x32_bf16 v[12:15], v[28:31], v[20:23], 0
  s_waitcnt lgkmcnt(0)
  v_mfma_f32_16x16x32_bf16 v[12:15], v[32:35], v[24:27], v[12:15]
  v_add_f32_dpp v8, v10, v8 quad_perm:[2,3,0,1] row_mask:0xf bank_mask:0xf
  v_add_f32_dpp v9, v11, v9 quad_perm:[2,3,0,1] row_mask:0xf bank_mask:0xf
  s_nop 0
  v_mov_b32_dpp v8, v8 quad_perm:[0,1,0,1] row_mask:0xf bank_mask:0xf
  v_mov_b32_dpp v9, v9 quad_perm:[0,1,0,1] row_mask:0xf bank_mask:0xf
  s_nop 1
  v_add_f32_dpp v12, v14, v12 quad_perm:[2,3,0,1] row_mask:0xf bank_mask:0xf
  v_add_f32_dpp v13, v15, v13 quad_perm:[2,3,0,1] row_mask:0xf bank_mask:0xf
  s_nop 0
  v_mov_b32_dpp v12, v12 quad_perm:[0,1,0,1] row_mask:0xf bank_mask:0xf
  v_mov_b32_dpp v13, v13 quad_perm:[0,1,0,1] row_mask:0xf bank_mask:0xf
  v_mul_f32 v12, s69, v12
  ds_write_b32 v78, v8 offset:8708
  v_mul_f32 v13, s69, v13
  ds_write_b32 v78, v9 offset:8772
  s_waitcnt lgkmcnt(0)
  s_barrier
  ds_read_b128 v[36:39], v78 offset:8704
  ds_read_b128 v[40:43], v78 offset:8768
  s_waitcnt lgkmcnt(0)
  s_barrier
  v_max_f32 v16, v36, v37
  v_max3_f32 v16, v16, v38, v39
  v_max3_f32 v16, v16, v40, v41
  v_max3_f32 v16, v16, v42, v43
  v_max3_f32 v16, v16, v12, v13
  v_mov_b32 v17, v16
  s_nop 1
  v_permlane16_swap_b32 v16, v17
  v_max_f32 v16, v16, v17
  v_mov_b32 v17, v16
  s_nop 1
  v_permlane32_swap_b32 v16, v17
  v_max_f32 v16, v16, v17
  v_sub_f32 v36, v36, v16
  v_sub_f32 v37, v37, v16
  v_sub_f32 v38, v38, v16
  v_sub_f32 v39, v39, v16
  v_sub_f32 v40, v40, v16
  v_sub_f32 v41, v41, v16
  v_sub_f32 v42, v42, v16
  v_sub_f32 v43, v43, v16
  v_sub_f32 v12, v12, v16
  v_sub_f32 v13, v13, v16
  v_exp_f32 v36, v36
  v_exp_f32 v37, v37
  v_exp_f32 v38, v38
  v_exp_f32 v39, v39
  v_exp_f32 v40, v40
  v_exp_f32 v41, v41
  v_exp_f32 v42, v42
  v_exp_f32 v43, v43
  v_exp_f32 v12, v12
  v_exp_f32 v13, v13
  v_cvt_pk_bf16_f32 v32, v36, v40
  v_cvt_pk_bf16_f32 v33, v37, v41
  v_cvt_pk_bf16_f32 v34, v38, v42
  v_cvt_pk_bf16_f32 v35, v39, v43
  v_cvt_pk_bf16_f32 v28, v12, v13
  v_cvt_pk_bf16_f32 v31, v12, v13
  v_mov_b32 v29, 0
  v_mov_b32 v30, 0
  v_mfma_f32_16x16x32_bf16 v[8:11], v[32:35], v[68:71], 0
  v_mfma_f32_16x16x32_bf16 v[0:3], v[32:35], v[52:55], 0
  v_mfma_f32_16x16x32_bf16 v[4:7], v[32:35], v[56:59], 0
  v_mfma_f32_16x16x16_bf16 v[8:11], v[28:29], v[68:69], v[8:11]
  v_mfma_f32_16x16x16_bf16 v[0:3], v[28:29], v[72:73], v[0:3]
  v_mfma_f32_16x16x16_bf16 v[4:7], v[30:31], v[72:73], v[4:7]
  ds_read_b128 v[52:55], v75 offset:36864
  v_rcp_f32 v10, v8
  v_rcp_f32 v11, v9
  v_mul_f32 v0, v10, v0
  v_mul_f32 v1, v11, v1
  v_max3_f32 v8, v8, v9, v10
  v_mul_f32 v4, v10, v4
  v_mul_f32 v5, v11, v5
  v_cvt_pk_bf16_f32 v2, v0, v4
  ds_write_b32 v79, v2 offset:8704
  v_cvt_pk_bf16_f32 v3, v1, v5
  ds_write_b32 v79, v3 offset:9280
  ds_read_b128 v[12:15], v78 offset:8768
  ds_read_b128 v[56:59], v75 offset:37888
  v_mov_b64 v[16:17], 0
  v_mov_b64 v[18:19], 0
  v_mov_b64 v[20:21], 0
  v_mov_b64 v[22:23], 0
  v_mov_b64 v[24:25], 0
  v_mov_b64 v[26:27], 0
  s_branch Cf1_mxok
Cf1_last:
  ds_read_b128 v[4:7], v76 offset:5632
  ds_read_b128 v[12:15], v76 offset:7680
  ds_read_b128 v[44:47], v76 offset:36864
  ds_read_b128 v[48:51], v76 offset:37888
  s_nop 5
  v_mov_b64 v[20:21], 0
  v_mov_b64 v[22:23], 0
  v_mov_b64 v[24:25], 0
  v_mov_b64 v[26:27], 0
  s_waitcnt lgkmcnt(4)
  v_smfmac_f32_16x16x64_bf16 v[28:31], v[0:3], v[36:43], v74
  ds_read_b128 v[36:39], v76 offset:38912
  ds_read_b128 v[40:43], v76 offset:39936
  v_smfmac_f32_16x16x64_bf16 v[32:35], v[0:3], v[60:67], v74
  s_waitcnt lgkmcnt(5)
  v_smfmac_f32_16x16x64_bf16 v[20:23], v[0:3], a[32:39], v74
  ds_read_b128 v[60:63], v76 offset:53248
  ds_read_b128 v[64:67], v76 offset:54272
  v_smfmac_f32_16x16x64_bf16 v[24:27], v[0:3], a[40:47], v74
  s_waitcnt lgkmcnt(4)
  v_smfmac_f32_16x16x64_bf16 v[20:23], v[4:7], a[48:55], v74
  buffer_store_dwordx4 v[16:19], v76, s[8:11], s68 offen sc1
  v_smfmac_f32_16x16x64_bf16 v[24:27], v[4:7], a[56:63], v74
  v_smfmac_f32_16x16x64_bf16 v[28:31], v[4:7], v[44:51], v74
  s_waitcnt lgkmcnt(2)
  v_smfmac_f32_16x16x64_bf16 v[20:23], v[8:11], a[64:71], v74
  ds_read_b128 v[44:47], v76 offset:55296
  ds_read_b128 v[48:51], v76 offset:56320
  v_smfmac_f32_16x16x64_bf16 v[24:27], v[8:11], a[72:79], v74
  v_smfmac_f32_16x16x64_bf16 v[32:35], v[4:7], v[36:43], v74
  v_smfmac_f32_16x16x64_bf16 v[28:31], v[8:11], v[208:215], v74
  ds_read_b128 v[36:39], v75 offset:20480
  ds_read_b128 v[40:43], v75 offset:21504
  v_smfmac_f32_16x16x64_bf16 v[32:35], v[8:11], v[216:223], v74
  v_smfmac_f32_16x16x64_bf16 v[20:23], v[12:15], a[80:87], v74
  v_smfmac_f32_16x16x64_bf16 v[24:27], v[12:15], a[88:95], v74
  v_smfmac_f32_16x16x64_bf16 v[28:31], v[12:15], v[224:231], v74
  v_smfmac_f32_16x16x64_bf16 v[32:35], v[12:15], v[232:239], v74
  s_waitcnt vmcnt(2)
  s_waitcnt vmcnt(1)
  s_barrier
Cf1_lastr:
  ds_read_b128 v[8:11], v76 offset:8704
  ds_read_b128 v[0:3], v76 offset:9728
  ds_read_b128 v[16:19], v76 offset:10752
  ds_read_b128 v[4:7], v76 offset:11776
  ds_read_b128 v[12:15], v76 offset:12800
  s_waitcnt lgkmcnt(3)
  v_max3_u32 v72, v0, v1, v2
  s_waitcnt lgkmcnt(1)
  v_max3_u32 v72, v72, v3, v4
  v_max3_u32 v72, v72, v5, v6
  v_max3_u32 v72, v72, v7, v8
  v_max3_u32 v72, v72, v9, v10
  s_waitcnt lgkmcnt(0)
  v_max3_u32 v72, v72, v11, v12
  v_max3_u32 v72, v72, v13, v14
  v_max3_u32 v72, v72, v15, v16
  v_max3_u32 v72, v72, v17, v18
  v_max_u32 v72, v72, v19
  v_cmp_eq_u32 vcc, -1, v72
  s_cbranch_vccnz Cf1_lastp
Cf1_lastg:
  v_smfmac_f32_16x16x64_bf16 v[28:31], v[8:11], v[60:67], v74
  ds_read_b128 v[60:63], v75 offset:22528
  ds_read_b128 v[64:67], v75 offset:23552
  v_smfmac_f32_16x16x64_bf16 v[32:35], v[8:11], v[44:51], v74
  v_smfmac_f32_16x16x64_bf16 v[28:31], v[0:3], v[36:43], v74
  v_smfmac_f32_16x16x64_bf16 v[28:31], v[16:19], v[240:247], v74
  v_smfmac_f32_16x16x64_bf16 v[28:31], v[4:7], a[0:7], v74
  v_smfmac_f32_16x16x64_bf16 v[28:31], v[12:15], a[16:23], v74
  v_smfmac_f32_16x16x64_bf16 v[32:35], v[16:19], v[248:255], v74
  v_smfmac_f32_16x16x64_bf16 v[32:35], v[4:7], a[8:15], v74
  s_waitcnt lgkmcnt(0)
  v_smfmac_f32_16x16x64_bf16 v[32:35], v[12:15], a[24:31], v74
  v_smfmac_f32_16x16x64_bf16 v[32:35], v[0:3], v[60:67], v74
  v_smfmac_f32_16x16x64_bf16 v[20:23], v[8:11], a[96:103], v74
  v_smfmac_f32_16x16x64_bf16 v[20:23], v[0:3], a[112:119], v74
  v_add_f32 v28, v28, v30
  v_add_f32 v32, v32, v34
  v_cvt_pk_bf16_f32 v30, v28, v32
  v_smfmac_f32_16x16x64_bf16 v[20:23], v[16:19], a[128:135], v74
  ds_write_b32 v79, v30 offset:256
  v_add_f32 v29, v29, v31
  v_add_f32 v33, v33, v35
  v_cvt_pk_bf16_f32 v31, v29, v33
  v_smfmac_f32_16x16x64_bf16 v[20:23], v[4:7], a[144:151], v74
  ds_write_b32 v79, v31 offset:832
  v_smfmac_f32_16x16x64_bf16 v[20:23], v[12:15], a[160:167], v74
  v_smfmac_f32_16x16x64_bf16 v[24:27], v[8:11], a[104:111], v74
  v_smfmac_f32_16x16x64_bf16 v[24:27], v[0:3], a[120:127], v74
  v_smfmac_f32_16x16x64_bf16 v[24:27], v[16:19], a[136:143], v74
  s_waitcnt lgkmcnt(0)
  s_barrier
  ds_read_b64 v[52:53], v77 offset:264
  v_add_f32 v20, v20, v22
  v_smfmac_f32_16x16x64_bf16 v[24:27], v[4:7], a[152:159], v74
  v_add_f32 v21, v21, v23
  v_smfmac_f32_16x16x64_bf16 v[24:27], v[12:15], a[168:175], v74
  v_cvt_pk_bf16_f32 v54, v20, v21
  s_add_u32 s68, s68, 655360
  s_nop 3
  v_add_f32 v24, v24, v26
  v_add_f32 v25, v25, v27
  v_cvt_pk_bf16_f32 v55, v24, v25
  s_waitcnt lgkmcnt(0)
  buffer_store_dwordx4 v[52:55], v76, s[8:11], s68 offen sc1
  s_branch Cf1_done
Cf1_lastp:
  s_add_u32 s72, s72, 2
  s_cmp_ge_u32 s72, 131072
  s_cbranch_scc1 Cf1_lastg
  s_barrier
  buffer_load_dwordx4 v76, s[8:11], s85 offen offset:0 sc1 lds
  s_waitcnt vmcnt(0)
  s_barrier
  s_branch Cf1_lastr
Cf1_done:
  s_branch L_cexit
L_w2:
  v_mov_b64 v[20:21], 0
  v_mov_b64 v[22:23], 0
  v_mov_b64 v[24:25], 0
  v_mov_b64 v[26:27], 0
  v_mov_b64 v[28:29], 0
  v_mov_b64 v[30:31], 0
  v_mov_b64 v[32:33], 0
  v_mov_b64 v[34:35], 0
  s_mov_b32 s78, 0x3f803f80
  s_mov_b32 s79, s78
  s_mov_b32 s65, 360448
  s_mov_b32 m0, 15872
  s_lshl_b32 s71, s53, 2
  s_add_u32 s71, s71, 128
  s_movk_i32 s56, 0x1000
  v_lshlrev_b32 v73, 2, v76
  v_mov_b32 v72, 0
  s_mov_b64 s[16:17], s[8:9]
  s_mov_b32 s18, 268435456
  s_mov_b32 s19, 0x20000
  s_getpc_b64 s[20:21]
Cf2_pc:
  s_add_u32 s20, s20, (Cf2_last - Cf2_pc)
  s_addc_u32 s21, s21, 0
  v_mov_b32 v68, 14880
  buffer_load_dwordx4 v[52:55], v76, s[8:11], s59 offen offset:0 sc1
  buffer_load_dwordx4 v[56:59], v76, s[8:11], s59 offen offset:1024 sc1
  ds_read_b128 v[36:39], v76 offset:24576
  ds_read_b128 v[40:43], v76 offset:25600
  ds_read_b128 v[60:63], v76 offset:26624
  ds_read_b128 v[64:67], v76 offset:27648
  ds_read_b128 v[0:3], v76 offset:4608
  ds_read_b128 v[4:7], v76 offset:5632
  ds_read_b128 v[8:11], v76 offset:6656
  ds_read_b128 v[12:15], v76 offset:7680
  s_waitcnt lgkmcnt(0)
  s_cmp_eq_u32 s66, 1
  s_branch Cf2_top2
.p2align 6
Cf2_h2:
  buffer_load_dwordx4 v[12:15], v76, s[8:11], s65 offen offset:3072 sc1
  ds_read_b128 v[36:39], v76 offset:24576
  s_waitcnt lgkmcnt(0)
  s_cmp_eq_u32 s66, 62
  s_cselect_b64 s[16:17], s[20:21], s[16:17]
  s_cselect_b32 s18, (Cf2_done - Cf2_last), s18
  s_cselect_b32 s70, 0, s70
  s_cmp_eq_u32 s66, 63
  s_cselect_b32 s59, 268435456, s59
  s_cselect_b32 s58, 268435456, s58
  buffer_load_dwordx4 v[12:15], v76, s[8:11], s65 offen offset:3072 sc1
  ds_read_b128 v[40:43], v76 offset:25600
  s_waitcnt lgkmcnt(0)
  v_mov_b64 v[20:21], 0
  v_mov_b64 v[22:23], 0
  v_mov_b64 v[24:25], 0
  v_mov_b64 v[26:27], 0
  v_mov_b32 v68, 14880
  v_lshlrev_b32 v73, 2, v76
  buffer_load_dwordx4 v[12:15], v76, s[8:11], s65 offen offset:3072 sc1
  buffer_load_dwordx4 v[52:55], v76, s[8:11], s59 offen offset:0 sc1
  buffer_load_dwordx4 v[56:59], v76, s[8:11], s59 offen offset:1024 sc1
  s_waitcnt vmcnt(4)
  v_max3_u32 v72, v12, v13, v14
  v_max_u32 v72, v72, v15
  ds_write_b128 v76, v[12:15] offset:7680
  v_cmp_eq_u32 vcc, -1, v72
  s_cbranch_vccnz Cf2_h2r
Cf2_h2w:
  s_cmp_eq_u32 s66, 63
  s_waitcnt lgkmcnt(0)
  s_barrier
  ds_read_b128 v[0:3], v76 offset:4608
  buffer_load_dwordx4 v76, s[8:11], s85 offen offset:0 sc1 lds
Cf2_top2:
  v_smfmac_f32_16x16x64_bf16 v[20:23], v[12:15], v[128:135], v74
  s_cbranch_scc1 Cf2_last
  v_smfmac_f32_16x16x64_bf16 v[24:27], v[12:15], v[136:143], v74
  buffer_load_dwordx4 v[44:47], v76, s[8:11], s58 offen offset:0 sc1
  s_mov_b32 m0, 15872
  v_smfmac_f32_16x16x64_bf16 v[28:31], v[12:15], v[224:231], v74
  buffer_load_dwordx4 v[48:51], v76, s[8:11], s58 offen offset:1024 sc1
  v_smfmac_f32_16x16x64_bf16 v[32:35], v[12:15], v[232:239], v74
  ds_read_b128 v[4:7], v76 offset:5632
  s_waitcnt lgkmcnt(1)
  v_smfmac_f32_16x16x64_bf16 v[20:23], v[0:3], v[80:87], v74
  ds_read_b128 v[8:11], v76 offset:6656
  v_smfmac_f32_16x16x64_bf16 v[28:31], v[0:3], v[36:43], v74
  ds_read_b128 v[36:39], v76 offset:40960
  v_smfmac_f32_16x16x64_bf16 v[24:27], v[0:3], v[88:95], v74
  buffer_store_dwordx4 v[16:19], v76, s[8:11], s68 offen sc1
  ds_read_b128 v[40:43], v76 offset:41984
  v_smfmac_f32_16x16x64_bf16 v[32:35], v[0:3], v[60:67], v74
  buffer_load_dword v73, s[16:19], s70 offen lds
  ds_read_b128 v[60:63], v76 offset:43008
  s_waitcnt lgkmcnt(4)
  v_smfmac_f32_16x16x64_bf16 v[20:23], v[4:7], v[96:103], v74
  ds_read_b128 v[64:67], v76 offset:44032
  v_smfmac_f32_16x16x64_bf16 v[24:27], v[4:7], v[104:111], v74
  s_waitcnt vmcnt(5)
  s_waitcnt lgkmcnt(4)
  v_smfmac_f32_16x16x64_bf16 v[20:23], v[8:11], v[112:119], v74
  s_barrier
  ds_read_b128 v[12:15], v76 offset:8704
  s_waitcnt lgkmcnt(3)
  v_smfmac_f32_16x16x64_bf16 v[28:31], v[4:7], v[36:43], v74
  ds_read_b128 v[36:39], v76 offset:57344
  v_smfmac_f32_16x16x64_bf16 v[24:27], v[8:11], v[120:127], v74
  ds_read_b128 v[40:43], v76 offset:58368
  s_waitcnt lgkmcnt(3)
  v_smfmac_f32_16x16x64_bf16 v[32:35], v[4:7], v[60:67], v74
  ds_read_b128 v[0:3], v76 offset:9728
  v_smfmac_f32_16x16x64_bf16 v[28:31], v[8:11], v[208:215], v74
  ds_read_b128 v[60:63], v76 offset:59392
  v_smfmac_f32_16x16x64_bf16 v[32:35], v[8:11], v[216:223], v74
  s_waitcnt vmcnt(4)
  ds_read_b128 v[64:67], v76 offset:60416
  s_waitcnt lgkmcnt(5)
  v_smfmac_f32_16x16x64_bf16 v[20:23], v[12:15], v[144:151], v74
  s_barrier
  ds_read_b128 v[4:7], v76 offset:11776
  s_waitcnt lgkmcnt(4)
  v_smfmac_f32_16x16x64_bf16 v[28:31], v[12:15], v[36:43], v74
  ds_read_b128 v[8:11], v76 offset:12800
  ds_read_b128 v[36:39], v75 offset:8192
  v_smfmac_f32_16x16x64_bf16 v[24:27], v[12:15], v[152:159], v74
  ds_read_b128 v[16:19], v76 offset:10752
  s_waitcnt lgkmcnt(6)
  v_smfmac_f32_16x16x64_bf16 v[20:23], v[0:3], v[160:167], v74
  ds_read_b128 v[40:43], v75 offset:9216
  s_waitcnt lgkmcnt(5)
  v_smfmac_f32_16x16x64_bf16 v[32:35], v[12:15], v[60:67], v74
  ds_read_b128 v[60:63], v75 offset:10240
  v_smfmac_f32_16x16x64_bf16 v[24:27], v[0:3], v[168:175], v74
  ds_read_b128 v[64:67], v75 offset:11264
  s_waitcnt lgkmcnt(6)
  v_smfmac_f32_16x16x64_bf16 v[20:23], v[4:7], v[176:183], v74
  s_waitcnt lgkmcnt(5)
  v_smfmac_f32_16x16x64_bf16 v[20:23], v[8:11], v[192:199], v74
  s_waitcnt lgkmcnt(2)
  v_smfmac_f32_16x16x64_bf16 v[20:23], v[16:19], v[36:43], v74
  ds_read_b128 v[36:39], v75 offset:24576
  v_smfmac_f32_16x16x64_bf16 v[24:27], v[4:7], v[184:191], v74
  ds_read_b128 v[40:43], v75 offset:25600
  s_waitcnt lgkmcnt(2)
  v_smfmac_f32_16x16x64_bf16 v[24:27], v[16:19], v[60:67], v74
  ds_read_b128 v[60:63], v75 offset:26624
  v_add_f32 v20, v20, v22
  v_smfmac_f32_16x16x64_bf16 v[24:27], v[8:11], v[200:207], v74
  ds_read_b128 v[64:67], v75 offset:27648
  v_add_f32 v21, v21, v23
  v_smfmac_f32_16x16x64_bf16 v[28:31], v[16:19], v[240:247], v74
  v_mov_b64 v[70:71], s[78:79]
  v_smfmac_f32_16x16x64_bf16 v[28:31], v[4:7], a[0:7], v74
  s_waitcnt lgkmcnt(2)
  v_add_f32 v24, v24, v26
  v_smfmac_f32_16x16x64_bf16 v[28:31], v[0:3], v[36:43], v74
  ds_read_b128 v[36:39], v68
  v_cvt_pk_bf16_f32 v22, v20, v24
  v_smfmac_f32_16x16x64_bf16 v[28:31], v[8:11], a[16:23], v74
  ds_read_b128 v[40:43], v68
  ds_write_b32 v79, v22 offset:0
  s_waitcnt lgkmcnt(3)
  v_add_f32 v25, v25, v27
  v_cvt_pk_bf16_f32 v23, v21, v25
  v_smfmac_f32_16x16x64_bf16 v[32:35], v[0:3], v[60:67], v74
  ds_write_b32 v79, v23 offset:576
  v_cmp_u_f32 vcc, v20, v21
  v_smfmac_f32_16x16x64_bf16 v[32:35], v[16:19], v[248:255], v74
  v_add_f32 v28, v28, v30
  v_smfmac_f32_16x16x64_bf16 v[32:35], v[4:7], a[8:15], v74
  v_add_f32 v29, v29, v31
  v_smfmac_f32_16x16x64_bf16 v[32:35], v[8:11], a[24:31], v74
  s_cbranch_vccnz Cf2_rec
Cf2_recok:
  s_waitcnt lgkmcnt(3)
  v_smfmac_f32_16x16x64_bf16 v[36:39], v[16:19], a[128:135], v74
  s_waitcnt lgkmcnt(0)
  s_barrier
  ds_read_b128 v[60:63], v77
  v_smfmac_f32_16x16x64_bf16 v[40:43], v[16:19], a[136:143], v74
  ds_read_b128 v[64:67], v77 offset:128
  v_add_f32 v32, v32, v34
  v_cvt_pk_bf16_f32 v30, v28, v32
  v_smfmac_f32_16x16x64_bf16 v[36:39], v[0:3], a[112:119], v74
  ds_write_b32 v79, v30 offset:256
  v_add_f32 v33, v33, v35
  v_cvt_pk_bf16_f32 v31, v29, v33
  v_smfmac_f32_16x16x64_bf16 v[40:43], v[0:3], a[120:127], v74
  ds_write_b32 v79, v31 offset:832
  v_xor_b32 v75, 0x8000, v75
  v_smfmac_f32_16x16x64_bf16 v[36:39], v[4:7], a[144:151], v74
  ds_read_b128 v[0:3], v76 offset:4608
  v_mov_b32 v29, 0
  v_smfmac_f32_16x16x64_bf16 v[40:43], v[4:7], a[152:159], v74
  s_waitcnt vmcnt(2) lgkmcnt(3)
  v_mov_b32 v30, 0
  v_mfma_f32_16x16x32_bf16 v[44:47], v[44:47], v[60:63], 0
  ds_read_b128 v[4:7], v76 offset:5632
  s_waitcnt lgkmcnt(2)
  v_mfma_f32_16x16x32_bf16 v[44:47], v[48:51], v[64:67], v[44:47]
  s_barrier
  v_smfmac_f32_16x16x64_bf16 v[36:39], v[8:11], a[160:167], v74
  ds_read_b128 v[20:23], v77 offset:256
  ds_read_b128 v[24:27], v77 offset:384
  v_smfmac_f32_16x16x64_bf16 v[40:43], v[8:11], a[168:175], v74
  ds_read_b128 v[8:11], v76 offset:6656
  v_add_f32_dpp v72, v46, v44 quad_perm:[2,3,0,1] row_mask:0xf bank_mask:0xf
  v_add_f32_dpp v73, v47, v45 quad_perm:[2,3,0,1] row_mask:0xf bank_mask:0xf
  v_smfmac_f32_16x16x64_bf16 v[36:39], v[12:15], a[96:103], v74
  s_waitcnt lgkmcnt(4)
  v_exp_f32_dpp v72, v72 quad_perm:[0,1,0,1] row_mask:0xf bank_mask:0xf
  v_smfmac_f32_16x16x64_bf16 v[40:43], v[12:15], a[104:111], v74
  ds_read_b128 v[12:15], v76 offset:7680
  v_exp_f32_dpp v73, v73 quad_perm:[0,1,0,1] row_mask:0xf bank_mask:0xf
  v_smfmac_f32_16x16x64_bf16 v[36:39], v[0:3], a[32:39], v74
  s_waitcnt lgkmcnt(2)
  v_cvt_pk_bf16_f32 v72, v72, v73
  v_mfma_f32_16x16x32_bf16 v[20:23], v[20:23], v[60:63], 0
  ds_write_b32 v78, v72 offset:520
  v_mov_b64 v[16:17], 0
  v_mfma_f32_16x16x32_bf16 v[20:23], v[24:27], v[64:67], v[20:23]
  ds_read_b128 v[44:47], v75 offset:40960
  v_mov_b64 v[18:19], 0
  v_smfmac_f32_16x16x64_bf16 v[40:43], v[0:3], a[40:47], v74
  ds_read_b128 v[48:51], v75 offset:41984
  v_mov_b64 v[68:69], s[78:79]
  v_smfmac_f32_16x16x64_bf16 v[36:39], v[4:7], a[48:55], v74
  s_waitcnt lgkmcnt(4)
  v_add_f32_dpp v24, v22, v20 quad_perm:[2,3,0,1] row_mask:0xf bank_mask:0xf
  v_add_f32_dpp v25, v23, v21 quad_perm:[2,3,0,1] row_mask:0xf bank_mask:0xf
  v_smfmac_f32_16x16x64_bf16 v[36:39], v[8:11], a[64:71], v74
  s_waitcnt lgkmcnt(2)
  s_barrier
  ds_read_b128 v[32:35], v78 offset:512
  v_smfmac_f32_16x16x64_bf16 v[36:39], v[12:15], a[80:87], v74
  ds_read_b128 v[60:63], v75 offset:24576
  v_mul_f32 v24, s69, v24
  v_smfmac_f32_16x16x64_bf16 v[40:43], v[4:7], a[56:63], v74
  ds_read_b128 v[64:67], v75 offset:25600
  v_mul_f32 v25, s69, v25
  v_smfmac_f32_16x16x64_bf16 v[40:43], v[8:11], a[72:79], v74
  v_exp_f32_dpp v24, v24 quad_perm:[0,1,0,1] row_mask:0xf bank_mask:0xf
  v_smfmac_f32_16x16x64_bf16 v[40:43], v[12:15], a[88:95], v74
  s_waitcnt lgkmcnt(2)
  v_exp_f32_dpp v25, v25 quad_perm:[0,1,0,1] row_mask:0xf bank_mask:0xf
  v_mfma_f32_16x16x32_bf16 v[8:11], v[32:35], v[68:71], 0
  v_add_f32 v36, v36, v38
  v_add_f32 v37, v37, v39
  v_mfma_f32_16x16x32_bf16 v[0:3], v[32:35], v[52:55], 0
  v_add_f32 v40, v40, v42
  v_add_f32 v41, v41, v43
  v_mfma_f32_16x16x32_bf16 v[4:7], v[32:35], v[56:59], 0
  v_cvt_pk_bf16_f32 v28, v24, v25
  v_cvt_pk_bf16_f32 v72, v36, v37
  v_cvt_pk_bf16_f32 v73, v40, v41
  v_mfma_f32_16x16x16_bf16 v[8:11], v[28:29], v[68:69], v[8:11]
  v_cvt_pk_bf16_f32 v31, v24, v25
  v_mov_b64 v[20:21], 0
  v_mfma_f32_16x16x16_bf16 v[0:3], v[28:29], v[72:73], v[0:3]
  ds_read_b128 v[52:55], v75 offset:26624
  v_mov_b64 v[22:23], 0
  v_mfma_f32_16x16x16_bf16 v[4:7], v[30:31], v[72:73], v[4:7]
  v_rcp_f32 v10, v8
  v_rcp_f32 v11, v9
  v_mul_f32 v0, v10, v0
  v_mul_f32 v1, v11, v1
  v_max3_f32 v8, v8, v9, v10
  v_mul_f32 v4, v10, v4
  v_mul_f32 v5, v11, v5
  v_cvt_pk_bf16_f32 v2, v0, v4
  ds_write_b32 v79, v2 offset:8704
  v_cvt_pk_bf16_f32 v3, v1, v5
  ds_write_b32 v79, v3 offset:9280
  ds_read_b128 v[12:15], v78 offset:8832
  v_max_f32 v8, v8, v11
  v_cmp_le_f32 vcc, 1317011456, v8
  v_mov_b64 v[24:25], 0
  v_mov_b64 v[26:27], 0
  ds_read_b128 v[56:59], v75 offset:27648
  s_cbranch_vccnz Cf2_mx
Cf2_mxok:
  s_waitcnt lgkmcnt(2)
  s_barrier
  ds_read_b128 v[0:3], v78 offset:8896
  s_waitcnt lgkmcnt(2)
  v_smfmac_f32_16x16x64_bf16 v[16:19], v[12:15], a[176:183], v74
  ds_read_b128 v[4:7], v78 offset:8704
  v_smfmac_f32_16x16x64_bf16 v[20:23], v[12:15], v[44:51], v74
  ds_read_b128 v[8:11], v78 offset:8768
  v_smfmac_f32_16x16x64_bf16 v[24:27], v[12:15], a[224:231], v74
  ds_read_b128 v[36:39], v75 offset:43008
  s_waitcnt lgkmcnt(3)
  v_smfmac_f32_16x16x64_bf16 v[16:19], v[0:3], a[184:191], v74
  ds_read_b128 v[40:43], v75 offset:44032
  s_waitcnt lgkmcnt(3)
  v_smfmac_f32_16x16x64_bf16 v[16:19], v[4:7], v[60:67], v74
  ds_read_b128 v[68:71], v76 offset:13824
  s_waitcnt lgkmcnt(3)
  v_smfmac_f32_16x16x64_bf16 v[16:19], v[8:11], v[52:59], v74
  ds_read_b128 v[44:47], v75 offset:57344
  v_smfmac_f32_16x16x64_bf16 v[20:23], v[4:7], a[192:199], v74
  ds_read_b128 v[48:51], v75 offset:58368
  v_smfmac_f32_16x16x64_bf16 v[20:23], v[8:11], a[200:207], v74
  ds_read_b128 v[60:63], v75 offset:59392
  s_waitcnt lgkmcnt(4)
  v_cvt_pk_bf16_f32 v16, v16, v17
  v_cvt_pk_bf16_f32 v17, v18, v19
  v_bfi_b32 v16, 1, s72, v16
  v_smfmac_f32_16x16x64_bf16 v[20:23], v[0:3], v[36:43], v74
  s_waitcnt lgkmcnt(3)
  buffer_store_dwordx2 v[16:17], v68, s[8:11], s73 offen
  v_mov_b64 v[32:33], 0
  v_smfmac_f32_16x16x64_bf16 v[24:27], v[4:7], a[208:215], v74
  ds_read_b128 v[64:67], v75 offset:60416
  v_mov_b64 v[34:35], 0
  v_smfmac_f32_16x16x64_bf16 v[24:27], v[8:11], a[216:223], v74
  ds_read_b128 v[52:55], v75 offset:0
  v_cvt_pk_bf16_f32 v20, v20, v21
  v_cvt_pk_bf16_f32 v21, v22, v23
  v_bfi_b32 v20, 1, s72, v20
  v_smfmac_f32_16x16x64_bf16 v[24:27], v[0:3], a[232:239], v74
  ds_read_b128 v[56:59], v75 offset:1024
  buffer_store_dwordx2 v[20:21], v68, s[8:11], s74 offen
  s_waitcnt lgkmcnt(4)
  v_mov_b64 v[28:29], 0
  v_smfmac_f32_16x16x64_bf16 v[32:35], v[4:7], v[44:51], v74
  ds_read_b128 v[36:39], v75 offset:2048
  ds_read_b128 v[40:43], v75 offset:3072
  s_waitcnt lgkmcnt(4)
  v_smfmac_f32_16x16x64_bf16 v[32:35], v[8:11], v[60:67], v74
  ds_read_b128 v[44:47], v75 offset:4096
  v_cvt_pk_bf16_f32 v24, v24, v25
  v_cvt_pk_bf16_f32 v25, v26, v27
  v_bfi_b32 v24, 1, s72, v24
  v_smfmac_f32_16x16x64_bf16 v[32:35], v[12:15], a[240:247], v74
  ds_read_b128 v[48:51], v75 offset:5120
  buffer_store_dwordx2 v[24:25], v68, s[8:11], s75 offen
  v_mov_b64 v[30:31], 0
  v_smfmac_f32_16x16x64_bf16 v[32:35], v[0:3], a[248:255], v74
  ds_read_b128 v[60:63], v75 offset:6144
  ds_read_b128 v[64:67], v75 offset:7168
  s_waitcnt lgkmcnt(6)
  v_smfmac_f32_16x16x64_bf16 v[28:31], v[4:7], v[52:59], v74
  s_waitcnt lgkmcnt(4)
  v_smfmac_f32_16x16x64_bf16 v[28:31], v[8:11], v[36:43], v74
  s_waitcnt lgkmcnt(2)
  v_cvt_pk_bf16_f32 v32, v32, v33
  v_cvt_pk_bf16_f32 v33, v34, v35
  v_bfi_b32 v32, 1, s72, v32
  v_smfmac_f32_16x16x64_bf16 v[28:31], v[12:15], v[44:51], v74
  buffer_store_dwordx2 v[32:33], v68, s[8:11], s76 offen
  s_waitcnt lgkmcnt(0)
  v_smfmac_f32_16x16x64_bf16 v[28:31], v[0:3], v[60:67], v74
  v_mov_b64 v[18:19], v[72:73]
  s_nop 4
  v_cvt_pk_bf16_f32 v28, v28, v29
  v_cvt_pk_bf16_f32 v29, v30, v31
  v_bfi_b32 v28, 1, s72, v28
  buffer_store_dwordx2 v[28:29], v68, s[8:11], s77 offen
  ds_read_b128 v[0:3], v76 offset:14848
  s_waitcnt lgkmcnt(0)
  ds_read_b64 v[16:17], v77 offset:384
  s_waitcnt lgkmcnt(0)
  ds_read_b128 v[64:67], v76 offset:27648
  s_waitcnt lgkmcnt(0)
  ds_read_b128 v[60:63], v76 offset:26624
  s_waitcnt lgkmcnt(0)
  v_xor_b32 v75, 0x8000, v75
  v_mov_b64 v[28:29], 0
  v_mov_b64 v[30:31], 0
  v_mov_b64 v[32:33], 0
  v_mov_b64 v[34:35], 0
  buffer_load_dwordx4 v[52:55], v76, s[8:11], s60 offen offset:0 sc1
  buffer_load_dwordx4 v[56:59], v76, s[8:11], s60 offen offset:1024 sc1
  s_add_u32 s66, s66, 1
  s_xor_b32 s64, s64, 16384
  s_xor_b32 s65, s65, 16384
  s_add_u32 s58, s58, 655360
  s_add_u32 s59, s59, 655360
  s_add_u32 s70, s70, 655360
  s_add_u32 s68, s68, 655360
  s_mov_b32 m0, 12800
  s_add_u32 s85, s65, 8192
  s_waitcnt lgkmcnt(0)
  s_waitcnt vmcnt(1)
  v_mfma_f32_16x16x32_bf16 v[4:7], v[0:3], v[52:55], 0
  v_bitop3_b32 v72, v52, v54, s72 bitop3:0x7e
  s_waitcnt vmcnt(0)
  v_mfma_f32_16x16x32_bf16 v[4:7], v[0:3], v[56:59], v[4:7]
  v_bitop3_b32 v73, v56, v58, s72 bitop3:0x7e
  v_bitop3_b32 v72, v72, v73, 1 bitop3:0xa8
  v_cmp_ne_u32 vcc, 0, v72
  s_nop 3
  v_add_f32_dpp v4, v4, v4 row_ror:4 row_mask:0xf bank_mask:0xf
  v_add_f32_dpp v5, v5, v5 row_ror:4 row_mask:0xf bank_mask:0xf
  s_cmp_eq_u64 vcc, 0
  v_add_f32_dpp v4, v4, v4 row_ror:8 row_mask:0xf bank_mask:0xf
  v_add_f32_dpp v5, v5, v5 row_ror:8 row_mask:0xf bank_mask:0xf
  s_cselect_b32 s54, s62, 268435456
  v_cvt_pk_bf16_f32 v4, v4, v5
  buffer_store_dword v4, v69, s[8:11], s54 offen
  s_cbranch_vccnz Cf2_h1r
  s_xor_b32 s62, s62, 16384
  buffer_store_dword v71, v69, s[8:11], s62 offen
  s_xor_b32 s72, s72, 1
  s_branch Cf2_h2
Cf2_h1r:
  s_mov_b64 exec, vcc
  buffer_load_dwordx4 v[52:55], v76, s[8:11], s60 offen offset:0 sc1
  buffer_load_dwordx4 v[56:59], v76, s[8:11], s60 offen offset:1024 sc1
  s_mov_b64 exec, -1
  s_add_u32 s67, s67, 1
  s_waitcnt vmcnt(1)
  v_mfma_f32_16x16x32_bf16 v[4:7], v[0:3], v[52:55], 0
  v_bitop3_b32 v72, v52, v54, s72 bitop3:0x7e
  s_waitcnt vmcnt(0)
  v_mfma_f32_16x16x32_bf16 v[4:7], v[0:3], v[56:59], v[4:7]
  v_bitop3_b32 v73, v56, v58, s72 bitop3:0x7e
  v_bitop3_b32 v72, v72, v73, 1 bitop3:0xa8
  v_cmp_ne_u32 vcc, 0, v72
  s_cbranch_vccz Cf2_h1p
Cf2_h1s:
  s_mov_b64 exec, vcc
  buffer_load_dwordx4 v[52:55], v76, s[8:11], s60 offen offset:0 sc1
  buffer_load_dwordx4 v[56:59], v76, s[8:11], s60 offen offset:1024 sc1
  s_mov_b64 exec, -1
  s_add_u32 s67, s67, 1
  s_waitcnt vmcnt(1)
  v_mfma_f32_16x16x32_bf16 v[4:7], v[0:3], v[52:55], 0
  v_bitop3_b32 v72, v52, v54, s72 bitop3:0x7e
  s_waitcnt vmcnt(0)
  v_mfma_f32_16x16x32_bf16 v[4:7], v[0:3], v[56:59], v[4:7]
  v_bitop3_b32 v73, v56, v58, s72 bitop3:0x7e
  v_bitop3_b32 v72, v72, v73, 1 bitop3:0xa8
  v_cmp_ne_u32 vcc, 0, v72
  s_cbranch_vccz Cf2_h1p
  s_cmp_lt_u32 s67, 131072
  s_cbranch_scc1 Cf2_h1s
Cf2_h1p:
  s_nop 2
  v_add_f32_dpp v4, v4, v4 row_ror:4 row_mask:0xf bank_mask:0xf
  v_add_f32_dpp v5, v5, v5 row_ror:4 row_mask:0xf bank_mask:0xf
  s_nop 0
  v_add_f32_dpp v4, v4, v4 row_ror:8 row_mask:0xf bank_mask:0xf
  v_add_f32_dpp v5, v5, v5 row_ror:8 row_mask:0xf bank_mask:0xf
  v_cvt_pk_bf16_f32 v4, v4, v5
  buffer_store_dword v4, v69, s[8:11], s62 offen
  s_xor_b32 s62, s62, 16384
  buffer_store_dword v71, v69, s[8:11], s62 offen
  s_xor_b32 s72, s72, 1
  s_branch Cf2_h2
Cf2_h2r:
  s_mov_b64 exec, vcc
  buffer_load_dwordx4 v[12:15], v76, s[8:11], s65 offen offset:3072 sc1
  s_mov_b64 exec, -1
  s_add_u32 s67, s67, 1
  s_waitcnt vmcnt(4)
  v_max3_u32 v72, v12, v13, v14
  v_max_u32 v72, v72, v15
  ds_write_b128 v76, v[12:15] offset:7680
  v_cmp_eq_u32 vcc, -1, v72
  s_cbranch_vccz Cf2_h2w
  s_mov_b64 exec, vcc
  buffer_load_dwordx4 v[12:15], v76, s[8:11], s65 offen offset:3072 sc1
  s_mov_b64 exec, -1
  s_add_u32 s67, s67, 1
  s_waitcnt vmcnt(4)
  v_max3_u32 v72, v12, v13, v14
  v_max_u32 v72, v72, v15
  ds_write_b128 v76, v[12:15] offset:7680
  v_cmp_eq_u32 vcc, -1, v72
  s_cbranch_vccz Cf2_h2w
Cf2_h2s:
  s_mov_b64 exec, vcc
  buffer_load_dwordx4 v[12:15], v76, s[8:11], s65 offen offset:3072 sc1
  s_mov_b64 exec, -1
  s_add_u32 s67, s67, 1
  s_waitcnt vmcnt(2)
  v_max3_u32 v72, v12, v13, v14
  v_max_u32 v72, v72, v15
  ds_write_b128 v76, v[12:15] offset:7680
  v_cmp_eq_u32 vcc, -1, v72
  s_cbranch_vccz Cf2_h2w
  s_mov_b64 exec, vcc
  buffer_load_dwordx4 v[12:15], v76, s[8:11], s65 offen offset:3072 sc1
  s_mov_b64 exec, -1
  s_add_u32 s67, s67, 1
  s_waitcnt vmcnt(2)
  v_max3_u32 v72, v12, v13, v14
  v_max_u32 v72, v72, v15
  ds_write_b128 v76, v[12:15] offset:7680
  v_cmp_eq_u32 vcc, -1, v72
  s_cbranch_vccz Cf2_h2w
  s_mov_b64 exec, vcc
  buffer_load_dwordx4 v[12:15], v76, s[8:11], s65 offen offset:3072 sc1
  s_mov_b64 exec, -1
  s_add_u32 s67, s67, 1
  s_waitcnt vmcnt(2)
  v_max3_u32 v72, v12, v13, v14
  v_max_u32 v72, v72, v15
  ds_write_b128 v76, v[12:15] offset:7680
  v_cmp_eq_u32 vcc, -1, v72
  s_cbranch_vccz Cf2_h2w
  s_cmp_lt_u32 s67, 131072
  s_cbranch_scc1 Cf2_h2s
  s_branch Cf2_h2w
Cf2_rec:
  s_nop 7
  s_waitcnt vmcnt(0) lgkmcnt(0)
  v_max3_u32 v72, v0, v1, v2
  v_max3_u32 v72, v72, v3, v4
  v_max3_u32 v72, v72, v5, v6
  v_max3_u32 v72, v72, v7, v8
  v_max3_u32 v72, v72, v9, v10
  v_max3_u32 v72, v72, v11, v12
  v_max3_u32 v72, v72, v13, v14
  v_max3_u32 v72, v72, v15, v16
  v_max3_u32 v72, v72, v17, v18
  v_max_u32 v72, v72, v19
  v_cmp_eq_u32 vcc, -1, v72
  s_cbranch_vccz Cf2_recok
  s_barrier
Cf2_recp:
  buffer_load_dwordx4 v[0:3], v76, s[8:11], s64 offen offset:0 sc1
  buffer_load_dwordx4 v[4:7], v76, s[8:11], s64 offen offset:1024 sc1
  s_add_u32 s67, s67, 1
  s_cmp_lt_u32 s67, 131072
  s_cselect_b32 s54, -2, -1
  s_waitcnt vmcnt(1)
  v_max3_u32 v72, v0, v1, v2
  s_waitcnt vmcnt(0)
  v_max3_u32 v72, v72, v3, v4
  v_max3_u32 v72, v72, v5, v6
  v_max_u32 v72, v72, v7
  v_cmp_lt_u32 vcc, s54, v72
  s_cbranch_vccnz Cf2_recp
  ds_write_b128 v76, v[0:3] offset:8704
  ds_write_b128 v76, v[4:7] offset:9728
  v_mov_b64 v[20:21], 0
  v_mov_b64 v[22:23], 0
  v_mov_b64 v[24:25], 0
  v_mov_b64 v[26:27], 0
  v_mov_b64 v[28:29], 0
  v_mov_b64 v[30:31], 0
  v_mov_b64 v[32:33], 0
  v_mov_b64 v[34:35], 0
  s_waitcnt lgkmcnt(0)
  s_barrier
  ds_read_b128 v[0:3], v76 offset:4608
  s_waitcnt lgkmcnt(0)
  v_smfmac_f32_16x16x64_bf16 v[20:23], v[0:3], v[80:87], v74
  v_smfmac_f32_16x16x64_bf16 v[24:27], v[0:3], v[88:95], v74
  ds_read_b128 v[60:63], v76 offset:24576
  ds_read_b128 v[64:67], v76 offset:25600
  s_waitcnt lgkmcnt(0)
  v_smfmac_f32_16x16x64_bf16 v[28:31], v[0:3], v[60:67], v74
  ds_read_b128 v[60:63], v76 offset:26624
  ds_read_b128 v[64:67], v76 offset:27648
  s_waitcnt lgkmcnt(0)
  v_smfmac_f32_16x16x64_bf16 v[32:35], v[0:3], v[60:67], v74
  ds_read_b128 v[4:7], v76 offset:5632
  s_waitcnt lgkmcnt(0)
  v_smfmac_f32_16x16x64_bf16 v[20:23], v[4:7], v[96:103], v74
  v_smfmac_f32_16x16x64_bf16 v[24:27], v[4:7], v[104:111], v74
  ds_read_b128 v[60:63], v76 offset:40960
  ds_read_b128 v[64:67], v76 offset:41984
  s_waitcnt lgkmcnt(0)
  v_smfmac_f32_16x16x64_bf16 v[28:31], v[4:7], v[60:67], v74
  ds_read_b128 v[60:63], v76 offset:43008
  ds_read_b128 v[64:67], v76 offset:44032
  s_waitcnt lgkmcnt(0)
  v_smfmac_f32_16x16x64_bf16 v[32:35], v[4:7], v[60:67], v74
  ds_read_b128 v[8:11], v76 offset:6656
  s_waitcnt lgkmcnt(0)
  v_smfmac_f32_16x16x64_bf16 v[20:23], v[8:11], v[112:119], v74
  v_smfmac_f32_16x16x64_bf16 v[24:27], v[8:11], v[120:127], v74
  v_smfmac_f32_16x16x64_bf16 v[28:31], v[8:11], v[208:215], v74
  v_smfmac_f32_16x16x64_bf16 v[32:35], v[8:11], v[216:223], v74
  ds_read_b128 v[12:15], v76 offset:7680
  s_waitcnt lgkmcnt(0)
  v_smfmac_f32_16x16x64_bf16 v[20:23], v[12:15], v[128:135], v74
  v_smfmac_f32_16x16x64_bf16 v[24:27], v[12:15], v[136:143], v74
  v_smfmac_f32_16x16x64_bf16 v[28:31], v[12:15], v[224:231], v74
  v_smfmac_f32_16x16x64_bf16 v[32:35], v[12:15], v[232:239], v74
  ds_read_b128 v[12:15], v76 offset:8704
  s_waitcnt lgkmcnt(0)
  v_smfmac_f32_16x16x64_bf16 v[20:23], v[12:15], v[144:151], v74
  v_smfmac_f32_16x16x64_bf16 v[24:27], v[12:15], v[152:159], v74
  ds_read_b128 v[60:63], v76 offset:57344
  ds_read_b128 v[64:67], v76 offset:58368
  s_waitcnt lgkmcnt(0)
  v_smfmac_f32_16x16x64_bf16 v[28:31], v[12:15], v[60:67], v74
  ds_read_b128 v[60:63], v76 offset:59392
  ds_read_b128 v[64:67], v76 offset:60416
  s_waitcnt lgkmcnt(0)
  v_smfmac_f32_16x16x64_bf16 v[32:35], v[12:15], v[60:67], v74
  ds_read_b128 v[0:3], v76 offset:9728
  s_waitcnt lgkmcnt(0)
  v_smfmac_f32_16x16x64_bf16 v[20:23], v[0:3], v[160:167], v74
  v_smfmac_f32_16x16x64_bf16 v[24:27], v[0:3], v[168:175], v74
  ds_read_b128 v[60:63], v75 offset:24576
  ds_read_b128 v[64:67], v75 offset:25600
  s_waitcnt lgkmcnt(0)
  v_smfmac_f32_16x16x64_bf16 v[28:31], v[0:3], v[60:67], v74
  ds_read_b128 v[60:63], v75 offset:26624
  ds_read_b128 v[64:67], v75 offset:27648
  s_waitcnt lgkmcnt(0)
  v_smfmac_f32_16x16x64_bf16 v[32:35], v[0:3], v[60:67], v74
  ds_read_b128 v[16:19], v76 offset:10752
  ds_read_b128 v[60:63], v75 offset:8192
  ds_read_b128 v[64:67], v75 offset:9216
  s_waitcnt lgkmcnt(0)
  v_smfmac_f32_16x16x64_bf16 v[20:23], v[16:19], v[60:67], v74
  ds_read_b128 v[60:63], v75 offset:10240
  ds_read_b128 v[64:67], v75 offset:11264
  s_waitcnt lgkmcnt(0)
  v_smfmac_f32_16x16x64_bf16 v[24:27], v[16:19], v[60:67], v74
  v_smfmac_f32_16x16x64_bf16 v[28:31], v[16:19], v[240:247], v74
  v_smfmac_f32_16x16x64_bf16 v[32:35], v[16:19], v[248:255], v74
  ds_read_b128 v[4:7], v76 offset:11776
  s_waitcnt lgkmcnt(0)
  v_smfmac_f32_16x16x64_bf16 v[20:23], v[4:7], v[176:183], v74
  v_smfmac_f32_16x16x64_bf16 v[24:27], v[4:7], v[184:191], v74
  v_smfmac_f32_16x16x64_bf16 v[28:31], v[4:7], a[0:7], v74
  v_smfmac_f32_16x16x64_bf16 v[32:35], v[4:7], a[8:15], v74
  ds_read_b128 v[8:11], v76 offset:12800
  s_waitcnt lgkmcnt(0)
  v_smfmac_f32_16x16x64_bf16 v[20:23], v[8:11], v[192:199], v74
  v_smfmac_f32_16x16x64_bf16 v[24:27], v[8:11], v[200:207], v74
  v_smfmac_f32_16x16x64_bf16 v[28:31], v[8:11], a[16:23], v74
  v_smfmac_f32_16x16x64_bf16 v[32:35], v[8:11], a[24:31], v74
  v_add_f32 v20, v20, v22
  v_add_f32 v21, v21, v23
  v_add_f32 v24, v24, v26
  v_cvt_pk_bf16_f32 v22, v20, v24
  ds_write_b32 v79, v22 offset:0
  v_add_f32 v25, v25, v27
  v_cvt_pk_bf16_f32 v23, v21, v25
  ds_write_b32 v79, v23 offset:576
  v_add_f32 v28, v28, v30
  v_add_f32 v29, v29, v31
  s_waitcnt lgkmcnt(0)
  s_nop 1
  s_branch Cf2_recok
Cf2_mx:
  s_waitcnt lgkmcnt(0)
  s_barrier
  buffer_load_dwordx4 v[52:55], v76, s[8:11], s59 offen offset:0 sc1
  buffer_load_dwordx4 v[0:3], v76, s[8:11], s58 offen offset:0 sc1
  ds_read_b128 v[20:23], v77 offset:0
  ds_read_b128 v[28:31], v77 offset:256
  buffer_load_dwordx4 v[56:59], v76, s[8:11], s59 offen offset:1024 sc1
  buffer_load_dwordx4 v[4:7], v76, s[8:11], s58 offen offset:1024 sc1
  ds_read_b128 v[24:27], v77 offset:128
  ds_read_b128 v[32:35], v77 offset:384
  s_waitcnt vmcnt(2) lgkmcnt(3)
  v_mfma_f32_16x16x32_bf16 v[8:11], v[0:3], v[20:23], 0
  s_waitcnt vmcnt(0) lgkmcnt(1)
  v_mfma_f32_16x16x32_bf16 v[8:11], v[4:7], v[24:27], v[8:11]
  v_mfma_f32_16x16x32_bf16 v[12:15], v[28:31], v[20:23], 0
  s_waitcnt lgkmcnt(0)
  v_mfma_f32_16x16x32_bf16 v[12:15], v[32:35], v[24:27], v[12:15]
  v_add_f32_dpp v8, v10, v8 quad_perm:[2,3,0,1] row_mask:0xf bank_mask:0xf
  v_add_f32_dpp v9, v11, v9 quad_perm:[2,3,0,1] row_mask:0xf bank_mask:0xf
  s_nop 0
  v_mov_b32_dpp v8, v8 quad_perm:[0,1,0,1] row_mask:0xf bank_mask:0xf
  v_mov_b32_dpp v9, v9 quad_perm:[0,1,0,1] row_mask:0xf bank_mask:0xf
  s_nop 1
  v_add_f32_dpp v12, v14, v12 quad_perm:[2,3,0,1] row_mask:0xf bank_mask:0xf
  v_add_f32_dpp v13, v15, v13 quad_perm:[2,3,0,1] row_mask:0xf bank_mask:0xf
  s_nop 0
  v_mov_b32_dpp v12, v12 quad_perm:[0,1,0,1] row_mask:0xf bank_mask:0xf
  v_mov_b32_dpp v13, v13 quad_perm:[0,1,0,1] row_mask:0xf bank_mask:0xf
  v_mul_f32 v12, s69, v12
  ds_write_b32 v78, v8 offset:8712
  v_mul_f32 v13, s69, v13
  ds_write_b32 v78, v9 offset:8776
  s_waitcnt lgkmcnt(0)
  s_barrier
  ds_read_b128 v[36:39], v78 offset:8704
  ds_read_b128 v[40:43], v78 offset:8768
  s_waitcnt lgkmcnt(0)
  s_barrier
  v_max_f32 v16, v36, v37
  v_max3_f32 v16, v16, v38, v39
  v_max3_f32 v16, v16, v40, v41
  v_max3_f32 v16, v16, v42, v43
  v_max3_f32 v16, v16, v12, v13
  v_mov_b32 v17, v16
  s_nop 1
  v_permlane16_swap_b32 v16, v17
  v_max_f32 v16, v16, v17
  v_mov_b32 v17, v16
  s_nop 1
  v_permlane32_swap_b32 v16, v17
  v_max_f32 v16, v16, v17
  v_sub_f32 v36, v36, v16
  v_sub_f32 v37, v37, v16
  v_sub_f32 v38, v38, v16
  v_sub_f32 v39, v39, v16
  v_sub_f32 v40, v40, v16
  v_sub_f32 v41, v41, v16
  v_sub_f32 v42, v42, v16
  v_sub_f32 v43, v43, v16
  v_sub_f32 v12, v12, v16
  v_sub_f32 v13, v13, v16
  v_exp_f32 v36, v36
  v_exp_f32 v37, v37
  v_exp_f32 v38, v38
  v_exp_f32 v39, v39
  v_exp_f32 v40, v40
  v_exp_f32 v41, v41
  v_exp_f32 v42, v42
  v_exp_f32 v43, v43
  v_exp_f32 v12, v12
  v_exp_f32 v13, v13
  v_cvt_pk_bf16_f32 v32, v36, v40
  v_cvt_pk_bf16_f32 v33, v37, v41
  v_cvt_pk_bf16_f32 v34, v38, v42
  v_cvt_pk_bf16_f32 v35, v39, v43
  v_cvt_pk_bf16_f32 v28, v12, v13
  v_cvt_pk_bf16_f32 v31, v12, v13
  v_mov_b32 v29, 0
  v_mov_b32 v30, 0
  v_mfma_f32_16x16x32_bf16 v[8:11], v[32:35], v[68:71], 0
  v_mfma_f32_16x16x32_bf16 v[0:3], v[32:35], v[52:55], 0
  v_mfma_f32_16x16x32_bf16 v[4:7], v[32:35], v[56:59], 0
  v_mfma_f32_16x16x16_bf16 v[8:11], v[28:29], v[68:69], v[8:11]
  v_mfma_f32_16x16x16_bf16 v[0:3], v[28:29], v[72:73], v[0:3]
  v_mfma_f32_16x16x16_bf16 v[4:7], v[30:31], v[72:73], v[4:7]
  ds_read_b128 v[52:55], v75 offset:26624
  v_rcp_f32 v10, v8
  v_rcp_f32 v11, v9
  v_mul_f32 v0, v10, v0
  v_mul_f32 v1, v11, v1
  v_max3_f32 v8, v8, v9, v10
  v_mul_f32 v4, v10, v4
  v_mul_f32 v5, v11, v5
  v_cvt_pk_bf16_f32 v2, v0, v4
  ds_write_b32 v79, v2 offset:8704
  v_cvt_pk_bf16_f32 v3, v1, v5
  ds_write_b32 v79, v3 offset:9280
  ds_read_b128 v[12:15], v78 offset:8832
  ds_read_b128 v[56:59], v75 offset:27648
  v_mov_b64 v[16:17], 0
  v_mov_b64 v[18:19], 0
  v_mov_b64 v[20:21], 0
  v_mov_b64 v[22:23], 0
  v_mov_b64 v[24:25], 0
  v_mov_b64 v[26:27], 0
  s_branch Cf2_mxok
Cf2_last:
  ds_read_b128 v[4:7], v76 offset:5632
  ds_read_b128 v[8:11], v76 offset:6656
  ds_read_b128 v[44:47], v76 offset:40960
  ds_read_b128 v[48:51], v76 offset:41984
  s_nop 5
  v_mov_b64 v[20:21], 0
  v_mov_b64 v[22:23], 0
  v_mov_b64 v[24:25], 0
  v_mov_b64 v[26:27], 0
  s_waitcnt lgkmcnt(4)
  v_smfmac_f32_16x16x64_bf16 v[28:31], v[0:3], v[36:43], v74
  ds_read_b128 v[36:39], v76 offset:43008
  ds_read_b128 v[40:43], v76 offset:44032
  v_smfmac_f32_16x16x64_bf16 v[32:35], v[0:3], v[60:67], v74
  s_waitcnt lgkmcnt(5)
  v_smfmac_f32_16x16x64_bf16 v[20:23], v[0:3], a[32:39], v74
  ds_read_b128 v[60:63], v76 offset:57344
  ds_read_b128 v[64:67], v76 offset:58368
  v_smfmac_f32_16x16x64_bf16 v[24:27], v[0:3], a[40:47], v74
  s_waitcnt lgkmcnt(4)
  v_smfmac_f32_16x16x64_bf16 v[20:23], v[4:7], a[48:55], v74
  buffer_store_dwordx4 v[16:19], v76, s[8:11], s68 offen sc1
  v_smfmac_f32_16x16x64_bf16 v[24:27], v[4:7], a[56:63], v74
  v_smfmac_f32_16x16x64_bf16 v[28:31], v[4:7], v[44:51], v74
  s_waitcnt lgkmcnt(2)
  v_smfmac_f32_16x16x64_bf16 v[20:23], v[8:11], a[64:71], v74
  ds_read_b128 v[44:47], v76 offset:59392
  ds_read_b128 v[48:51], v76 offset:60416
  v_smfmac_f32_16x16x64_bf16 v[24:27], v[8:11], a[72:79], v74
  v_smfmac_f32_16x16x64_bf16 v[32:35], v[4:7], v[36:43], v74
  v_smfmac_f32_16x16x64_bf16 v[28:31], v[8:11], v[208:215], v74
  ds_read_b128 v[36:39], v75 offset:24576
  ds_read_b128 v[40:43], v75 offset:25600
  v_smfmac_f32_16x16x64_bf16 v[32:35], v[8:11], v[216:223], v74
  v_smfmac_f32_16x16x64_bf16 v[20:23], v[12:15], a[80:87], v74
  v_smfmac_f32_16x16x64_bf16 v[24:27], v[12:15], a[88:95], v74
  v_smfmac_f32_16x16x64_bf16 v[28:31], v[12:15], v[224:231], v74
  v_smfmac_f32_16x16x64_bf16 v[32:35], v[12:15], v[232:239], v74
  s_waitcnt vmcnt(2)
  s_waitcnt vmcnt(1)
  s_barrier
Cf2_lastr:
  ds_read_b128 v[12:15], v76 offset:8704
  ds_read_b128 v[0:3], v76 offset:9728
  ds_read_b128 v[16:19], v76 offset:10752
  ds_read_b128 v[4:7], v76 offset:11776
  ds_read_b128 v[8:11], v76 offset:12800
  s_waitcnt lgkmcnt(3)
  v_max3_u32 v72, v0, v1, v2
  s_waitcnt lgkmcnt(1)
  v_max3_u32 v72, v72, v3, v4
  v_max3_u32 v72, v72, v5, v6
  s_waitcnt lgkmcnt(0)
  v_max3_u32 v72, v72, v7, v8
  v_max3_u32 v72, v72, v9, v10
  v_max3_u32 v72, v72, v11, v12
  v_max3_u32 v72, v72, v13, v14
  v_max3_u32 v72, v72, v15, v16
  v_max3_u32 v72, v72, v17, v18
  v_max_u32 v72, v72, v19
  v_cmp_eq_u32 vcc, -1, v72
  s_cbranch_vccnz Cf2_lastp
Cf2_lastg:
  v_smfmac_f32_16x16x64_bf16 v[28:31], v[12:15], v[60:67], v74
  ds_read_b128 v[60:63], v75 offset:26624
  ds_read_b128 v[64:67], v75 offset:27648
  v_smfmac_f32_16x16x64_bf16 v[32:35], v[12:15], v[44:51], v74
  v_smfmac_f32_16x16x64_bf16 v[28:31], v[0:3], v[36:43], v74
  v_smfmac_f32_16x16x64_bf16 v[28:31], v[16:19], v[240:247], v74
  v_smfmac_f32_16x16x64_bf16 v[28:31], v[4:7], a[0:7], v74
  v_smfmac_f32_16x16x64_bf16 v[28:31], v[8:11], a[16:23], v74
  v_smfmac_f32_16x16x64_bf16 v[32:35], v[16:19], v[248:255], v74
  v_smfmac_f32_16x16x64_bf16 v[32:35], v[4:7], a[8:15], v74
  s_waitcnt lgkmcnt(0)
  v_smfmac_f32_16x16x64_bf16 v[32:35], v[8:11], a[24:31], v74
  v_smfmac_f32_16x16x64_bf16 v[32:35], v[0:3], v[60:67], v74
  v_smfmac_f32_16x16x64_bf16 v[20:23], v[12:15], a[96:103], v74
  v_smfmac_f32_16x16x64_bf16 v[20:23], v[0:3], a[112:119], v74
  v_add_f32 v28, v28, v30
  v_add_f32 v32, v32, v34
  v_cvt_pk_bf16_f32 v30, v28, v32
  v_smfmac_f32_16x16x64_bf16 v[20:23], v[16:19], a[128:135], v74
  ds_write_b32 v79, v30 offset:256
  v_add_f32 v29, v29, v31
  v_add_f32 v33, v33, v35
  v_cvt_pk_bf16_f32 v31, v29, v33
  v_smfmac_f32_16x16x64_bf16 v[20:23], v[4:7], a[144:151], v74
  ds_write_b32 v79, v31 offset:832
  v_smfmac_f32_16x16x64_bf16 v[20:23], v[8:11], a[160:167], v74
  v_smfmac_f32_16x16x64_bf16 v[24:27], v[12:15], a[104:111], v74
  v_smfmac_f32_16x16x64_bf16 v[24:27], v[0:3], a[120:127], v74
  v_smfmac_f32_16x16x64_bf16 v[24:27], v[16:19], a[136:143], v74
  s_waitcnt lgkmcnt(0)
  s_barrier
  ds_read_b64 v[52:53], v77 offset:384
  v_add_f32 v20, v20, v22
  v_smfmac_f32_16x16x64_bf16 v[24:27], v[4:7], a[152:159], v74
  v_add_f32 v21, v21, v23
  v_smfmac_f32_16x16x64_bf16 v[24:27], v[8:11], a[168:175], v74
  v_cvt_pk_bf16_f32 v54, v20, v21
  s_add_u32 s68, s68, 655360
  s_nop 3
  v_add_f32 v24, v24, v26
  v_add_f32 v25, v25, v27
  v_cvt_pk_bf16_f32 v55, v24, v25
  s_waitcnt lgkmcnt(0)
  buffer_store_dwordx4 v[52:55], v76, s[8:11], s68 offen sc1
  s_branch Cf2_done
Cf2_lastp:
  s_add_u32 s72, s72, 2
  s_cmp_ge_u32 s72, 131072
  s_cbranch_scc1 Cf2_lastg
  s_barrier
  buffer_load_dwordx4 v76, s[8:11], s85 offen offset:0 sc1 lds
  s_waitcnt vmcnt(0)
  s_barrier
  s_branch Cf2_lastr
Cf2_done:
  s_branch L_cexit
L_w3:
  v_mov_b64 v[20:21], 0
  v_mov_b64 v[22:23], 0
  v_mov_b64 v[24:25], 0
  v_mov_b64 v[26:27], 0
  v_mov_b64 v[28:29], 0
  v_mov_b64 v[30:31], 0
  v_mov_b64 v[32:33], 0
  v_mov_b64 v[34:35], 0
  s_mov_b32 s78, 0x3f803f80
  s_mov_b32 s79, s78
  s_mov_b32 s65, 360448
  s_mov_b32 m0, 15872
  s_lshl_b32 s71, s53, 2
  s_add_u32 s71, s71, 128
  s_movk_i32 s56, 0x1000
  v_lshlrev_b32 v73, 2, v76
  v_mov_b32 v72, 0
  s_mov_b64 s[16:17], s[8:9]
  s_mov_b32 s18, 268435456
  s_mov_b32 s19, 0x20000
  s_getpc_b64 s[20:21]
Cf3_pc:
  s_add_u32 s20, s20, (Cf3_last - Cf3_pc)
  s_addc_u32 s21, s21, 0
  v_mov_b32 v68, 14880
  buffer_load_dwordx4 v[52:55], v76, s[8:11], s59 offen offset:0 sc1
  buffer_load_dwordx4 v[56:59], v76, s[8:11], s59 offen offset:1024 sc1
  ds_read_b128 v[36:39], v76 offset:45056
  ds_read_b128 v[40:43], v76 offset:46080
  ds_read_b128 v[60:63], v76 offset:47104
  ds_read_b128 v[64:67], v76 offset:48128
  ds_read_b128 v[0:3], v76 offset:4608
  ds_read_b128 v[4:7], v76 offset:5632
  ds_read_b128 v[8:11], v76 offset:6656
  ds_read_b128 v[12:15], v76 offset:7680
  s_waitcnt lgkmcnt(0)
  s_cmp_eq_u32 s66, 1
  s_branch Cf3_top2
.p2align 6
Cf3_h2:
  v_lshlrev_b32 v73, 2, v76
  buffer_load_dwordx4 v[4:7], v76, s[8:11], s65 offen offset:1024 sc1
  ds_read_b128 v[36:39], v76 offset:45056
  ds_read_b128 v[40:43], v76 offset:46080
  buffer_load_dwordx4 v[52:55], v76, s[8:11], s59 offen offset:0 sc1
  buffer_load_dwordx4 v[56:59], v76, s[8:11], s59 offen offset:1024 sc1
  s_waitcnt vmcnt(7)
  v_max3_u32 v72, v4, v5, v6
  v_max_u32 v72, v72, v7
  ds_write_b128 v76, v[4:7] offset:5632
  v_cmp_eq_u32 vcc, -1, v72
  s_cbranch_vccnz Cf3_h2r
Cf3_h2w:
  buffer_load_dwordx4 v76, s[8:11], s85 offen offset:0 sc1 lds
  buffer_load_dwordx4 v76, s[8:11], s85 offen offset:1024 sc1 lds
  s_cmp_eq_u32 s66, 63
  s_waitcnt lgkmcnt(0)
  s_barrier
  ds_read_b128 v[8:11], v76 offset:6656
Cf3_top2:
  v_smfmac_f32_16x16x64_bf16 v[20:23], v[4:7], v[96:103], v74
  s_cbranch_scc1 Cf3_last
  v_smfmac_f32_16x16x64_bf16 v[28:31], v[4:7], v[36:43], v74
  buffer_load_dwordx4 v[44:47], v76, s[8:11], s58 offen offset:0 sc1
  s_mov_b32 m0, 15872
  v_smfmac_f32_16x16x64_bf16 v[24:27], v[4:7], v[104:111], v74
  buffer_load_dwordx4 v[48:51], v76, s[8:11], s58 offen offset:1024 sc1
  v_smfmac_f32_16x16x64_bf16 v[32:35], v[4:7], v[60:67], v74
  ds_read_b128 v[0:3], v76 offset:4608
  s_waitcnt lgkmcnt(1)
  v_smfmac_f32_16x16x64_bf16 v[20:23], v[8:11], v[112:119], v74
  ds_read_b128 v[12:15], v76 offset:7680
  v_smfmac_f32_16x16x64_bf16 v[24:27], v[8:11], v[120:127], v74
  ds_read_b128 v[36:39], v76 offset:28672
  v_smfmac_f32_16x16x64_bf16 v[28:31], v[8:11], v[208:215], v74
  buffer_store_dwordx4 v[16:19], v76, s[8:11], s68 offen sc1
  ds_read_b128 v[40:43], v76 offset:29696
  v_smfmac_f32_16x16x64_bf16 v[32:35], v[8:11], v[216:223], v74
  buffer_load_dword v73, s[16:19], s70 offen lds
  ds_read_b128 v[60:63], v76 offset:30720
  s_waitcnt lgkmcnt(4)
  v_smfmac_f32_16x16x64_bf16 v[20:23], v[0:3], v[80:87], v74
  ds_read_b128 v[64:67], v76 offset:31744
  v_smfmac_f32_16x16x64_bf16 v[24:27], v[0:3], v[88:95], v74
  s_waitcnt vmcnt(4)
  s_waitcnt lgkmcnt(4)
  v_smfmac_f32_16x16x64_bf16 v[20:23], v[12:15], v[128:135], v74
  s_barrier
  ds_read_b128 v[4:7], v76 offset:8704
  s_waitcnt lgkmcnt(3)
  v_smfmac_f32_16x16x64_bf16 v[28:31], v[0:3], v[36:43], v74
  ds_read_b128 v[36:39], v76 offset:61440
  v_smfmac_f32_16x16x64_bf16 v[24:27], v[12:15], v[136:143], v74
  ds_read_b128 v[40:43], v76 offset:62464
  s_waitcnt lgkmcnt(3)
  v_smfmac_f32_16x16x64_bf16 v[32:35], v[0:3], v[60:67], v74
  ds_read_b128 v[8:11], v76 offset:9728
  v_smfmac_f32_16x16x64_bf16 v[28:31], v[12:15], v[224:231], v74
  ds_read_b128 v[60:63], v76 offset:63488
  v_smfmac_f32_16x16x64_bf16 v[32:35], v[12:15], v[232:239], v74
  ds_read_b128 v[64:67], v76 offset:64512
  s_waitcnt lgkmcnt(5)
  v_smfmac_f32_16x16x64_bf16 v[20:23], v[4:7], v[144:151], v74
  s_barrier
  ds_read_b128 v[0:3], v76 offset:11776
  s_waitcnt lgkmcnt(4)
  v_smfmac_f32_16x16x64_bf16 v[28:31], v[4:7], v[36:43], v74
  ds_read_b128 v[12:15], v76 offset:12800
  ds_read_b128 v[36:39], v75 offset:12288
  v_smfmac_f32_16x16x64_bf16 v[24:27], v[4:7], v[152:159], v74
  ds_read_b128 v[16:19], v76 offset:10752
  s_waitcnt lgkmcnt(6)
  v_smfmac_f32_16x16x64_bf16 v[20:23], v[8:11], v[160:167], v74
  ds_read_b128 v[40:43], v75 offset:13312
  s_waitcnt lgkmcnt(5)
  v_smfmac_f32_16x16x64_bf16 v[32:35], v[4:7], v[60:67], v74
  ds_read_b128 v[60:63], v75 offset:14336
  v_smfmac_f32_16x16x64_bf16 v[24:27], v[8:11], v[168:175], v74
  ds_read_b128 v[64:67], v75 offset:15360
  s_waitcnt lgkmcnt(6)
  v_smfmac_f32_16x16x64_bf16 v[20:23], v[0:3], v[176:183], v74
  s_waitcnt lgkmcnt(5)
  v_smfmac_f32_16x16x64_bf16 v[20:23], v[12:15], v[192:199], v74
  s_waitcnt lgkmcnt(2)
  v_smfmac_f32_16x16x64_bf16 v[20:23], v[16:19], v[36:43], v74
  ds_read_b128 v[36:39], v75 offset:28672
  v_smfmac_f32_16x16x64_bf16 v[24:27], v[0:3], v[184:191], v74
  ds_read_b128 v[40:43], v75 offset:29696
  s_waitcnt lgkmcnt(2)
  v_smfmac_f32_16x16x64_bf16 v[24:27], v[16:19], v[60:67], v74
  ds_read_b128 v[60:63], v75 offset:30720
  v_add_f32 v20, v20, v22
  v_smfmac_f32_16x16x64_bf16 v[24:27], v[12:15], v[200:207], v74
  ds_read_b128 v[64:67], v75 offset:31744
  v_add_f32 v21, v21, v23
  v_smfmac_f32_16x16x64_bf16 v[28:31], v[16:19], v[240:247], v74
  v_mov_b64 v[70:71], s[78:79]
  v_smfmac_f32_16x16x64_bf16 v[28:31], v[0:3], a[0:7], v74
  s_waitcnt lgkmcnt(2)
  v_add_f32 v24, v24, v26
  v_smfmac_f32_16x16x64_bf16 v[28:31], v[8:11], v[36:43], v74
  ds_read_b128 v[36:39], v68
  v_cvt_pk_bf16_f32 v22, v20, v24
  v_smfmac_f32_16x16x64_bf16 v[28:31], v[12:15], a[16:23], v74
  ds_read_b128 v[40:43], v68
  ds_write_b32 v79, v22 offset:0
  s_waitcnt lgkmcnt(3)
  v_add_f32 v25, v25, v27
  v_cvt_pk_bf16_f32 v23, v21, v25
  v_smfmac_f32_16x16x64_bf16 v[32:35], v[8:11], v[60:67], v74
  ds_write_b32 v79, v23 offset:576
  v_cmp_u_f32 vcc, v20, v21
  v_smfmac_f32_16x16x64_bf16 v[32:35], v[16:19], v[248:255], v74
  v_add_f32 v28, v28, v30
  v_smfmac_f32_16x16x64_bf16 v[32:35], v[0:3], a[8:15], v74
  v_add_f32 v29, v29, v31
  v_smfmac_f32_16x16x64_bf16 v[32:35], v[12:15], a[24:31], v74
  s_cbranch_vccnz Cf3_rec
Cf3_recok:
  s_waitcnt lgkmcnt(3)
  v_smfmac_f32_16x16x64_bf16 v[36:39], v[16:19], a[128:135], v74
  s_waitcnt lgkmcnt(0)
  s_barrier
  ds_read_b128 v[60:63], v77
  v_smfmac_f32_16x16x64_bf16 v[40:43], v[16:19], a[136:143], v74
  ds_read_b128 v[64:67], v77 offset:128
  v_add_f32 v32, v32, v34
  v_cvt_pk_bf16_f32 v30, v28, v32
  v_smfmac_f32_16x16x64_bf16 v[36:39], v[0:3], a[144:151], v74
  ds_write_b32 v79, v30 offset:256
  v_add_f32 v33, v33, v35
  v_cvt_pk_bf16_f32 v31, v29, v33
  v_smfmac_f32_16x16x64_bf16 v[40:43], v[0:3], a[152:159], v74
  ds_write_b32 v79, v31 offset:832
  v_xor_b32 v75, 0x8000, v75
  v_smfmac_f32_16x16x64_bf16 v[36:39], v[4:7], a[96:103], v74
  ds_read_b128 v[0:3], v76 offset:4608
  v_mov_b32 v29, 0
  v_smfmac_f32_16x16x64_bf16 v[40:43], v[4:7], a[104:111], v74
  s_waitcnt vmcnt(2) lgkmcnt(3)
  v_mov_b32 v30, 0
  v_mfma_f32_16x16x32_bf16 v[44:47], v[44:47], v[60:63], 0
  ds_read_b128 v[4:7], v76 offset:5632
  s_waitcnt lgkmcnt(2)
  v_mfma_f32_16x16x32_bf16 v[44:47], v[48:51], v[64:67], v[44:47]
  s_barrier
  v_smfmac_f32_16x16x64_bf16 v[36:39], v[8:11], a[112:119], v74
  ds_read_b128 v[20:23], v77 offset:256
  ds_read_b128 v[24:27], v77 offset:384
  v_smfmac_f32_16x16x64_bf16 v[40:43], v[8:11], a[120:127], v74
  ds_read_b128 v[8:11], v76 offset:6656
  v_add_f32_dpp v72, v46, v44 quad_perm:[2,3,0,1] row_mask:0xf bank_mask:0xf
  v_add_f32_dpp v73, v47, v45 quad_perm:[2,3,0,1] row_mask:0xf bank_mask:0xf
  v_smfmac_f32_16x16x64_bf16 v[36:39], v[12:15], a[160:167], v74
  s_waitcnt lgkmcnt(4)
  v_exp_f32_dpp v72, v72 quad_perm:[0,1,0,1] row_mask:0xf bank_mask:0xf
  v_smfmac_f32_16x16x64_bf16 v[40:43], v[12:15], a[168:175], v74
  ds_read_b128 v[12:15], v76 offset:7680
  v_exp_f32_dpp v73, v73 quad_perm:[0,1,0,1] row_mask:0xf bank_mask:0xf
  v_smfmac_f32_16x16x64_bf16 v[36:39], v[0:3], a[32:39], v74
  s_waitcnt lgkmcnt(2)
  v_cvt_pk_bf16_f32 v72, v72, v73
  v_mfma_f32_16x16x32_bf16 v[20:23], v[20:23], v[60:63], 0
  ds_write_b32 v78, v72 offset:524
  v_mov_b64 v[16:17], 0
  v_mfma_f32_16x16x32_bf16 v[20:23], v[24:27], v[64:67], v[20:23]
  ds_read_b128 v[44:47], v75 offset:47104
  v_mov_b64 v[18:19], 0
  v_smfmac_f32_16x16x64_bf16 v[40:43], v[0:3], a[40:47], v74
  ds_read_b128 v[48:51], v75 offset:48128
  v_mov_b64 v[68:69], s[78:79]
  v_smfmac_f32_16x16x64_bf16 v[36:39], v[4:7], a[48:55], v74
  s_waitcnt lgkmcnt(4)
  v_add_f32_dpp v24, v22, v20 quad_perm:[2,3,0,1] row_mask:0xf bank_mask:0xf
  v_add_f32_dpp v25, v23, v21 quad_perm:[2,3,0,1] row_mask:0xf bank_mask:0xf
  v_smfmac_f32_16x16x64_bf16 v[36:39], v[8:11], a[64:71], v74
  s_waitcnt lgkmcnt(2)
  s_barrier
  ds_read_b128 v[32:35], v78 offset:512
  v_smfmac_f32_16x16x64_bf16 v[36:39], v[12:15], a[80:87], v74
  ds_read_b128 v[60:63], v75 offset:28672
  v_mul_f32 v24, s69, v24
  v_smfmac_f32_16x16x64_bf16 v[40:43], v[4:7], a[56:63], v74
  ds_read_b128 v[64:67], v75 offset:29696
  v_mul_f32 v25, s69, v25
  v_smfmac_f32_16x16x64_bf16 v[40:43], v[8:11], a[72:79], v74
  v_exp_f32_dpp v24, v24 quad_perm:[0,1,0,1] row_mask:0xf bank_mask:0xf
  v_smfmac_f32_16x16x64_bf16 v[40:43], v[12:15], a[88:95], v74
  s_waitcnt lgkmcnt(2)
  v_exp_f32_dpp v25, v25 quad_perm:[0,1,0,1] row_mask:0xf bank_mask:0xf
  v_mfma_f32_16x16x32_bf16 v[8:11], v[32:35], v[68:71], 0
  v_add_f32 v36, v36, v38
  v_add_f32 v37, v37, v39
  v_mfma_f32_16x16x32_bf16 v[0:3], v[32:35], v[52:55], 0
  v_add_f32 v40, v40, v42
  v_add_f32 v41, v41, v43
  v_mfma_f32_16x16x32_bf16 v[4:7], v[32:35], v[56:59], 0
  v_cvt_pk_bf16_f32 v28, v24, v25
  v_cvt_pk_bf16_f32 v72, v36, v37
  v_cvt_pk_bf16_f32 v73, v40, v41
  v_mfma_f32_16x16x16_bf16 v[8:11], v[28:29], v[68:69], v[8:11]
  v_cvt_pk_bf16_f32 v31, v24, v25
  v_mov_b64 v[20:21], 0
  v_mfma_f32_16x16x16_bf16 v[0:3], v[28:29], v[72:73], v[0:3]
  ds_read_b128 v[52:55], v75 offset:30720
  v_mov_b64 v[22:23], 0
  v_mfma_f32_16x16x16_bf16 v[4:7], v[30:31], v[72:73], v[4:7]
  v_rcp_f32 v10, v8
  v_rcp_f32 v11, v9
  v_mul_f32 v0, v10, v0
  v_mul_f32 v1, v11, v1
  v_max3_f32 v8, v8, v9, v10
  v_mul_f32 v4, v10, v4
  v_mul_f32 v5, v11, v5
  v_cvt_pk_bf16_f32 v2, v0, v4
  ds_write_b32 v79, v2 offset:8704
  v_cvt_pk_bf16_f32 v3, v1, v5
  ds_write_b32 v79, v3 offset:9280
  ds_read_b128 v[12:15], v78 offset:8896
  v_max_f32 v8, v8, v11
  v_cmp_le_f32 vcc, 1317011456, v8
  v_mov_b64 v[24:25], 0
  v_mov_b64 v[26:27], 0
  ds_read_b128 v[56:59], v75 offset:31744
  s_cbranch_vccnz Cf3_mx
Cf3_mxok:
  s_waitcnt lgkmcnt(2)
  s_barrier
  ds_read_b128 v[0:3], v78 offset:8832
  s_waitcnt lgkmcnt(2)
  v_smfmac_f32_16x16x64_bf16 v[16:19], v[12:15], a[184:191], v74
  ds_read_b128 v[4:7], v78 offset:8704
  v_smfmac_f32_16x16x64_bf16 v[20:23], v[12:15], v[44:51], v74
  ds_read_b128 v[8:11], v78 offset:8768
  v_smfmac_f32_16x16x64_bf16 v[24:27], v[12:15], a[232:239], v74
  ds_read_b128 v[36:39], v75 offset:45056
  s_waitcnt lgkmcnt(3)
  v_smfmac_f32_16x16x64_bf16 v[16:19], v[0:3], a[176:183], v74
  ds_read_b128 v[40:43], v75 offset:46080
  s_waitcnt lgkmcnt(3)
  v_smfmac_f32_16x16x64_bf16 v[16:19], v[4:7], v[60:67], v74
  ds_read_b128 v[68:71], v76 offset:13824
  s_waitcnt lgkmcnt(3)
  v_smfmac_f32_16x16x64_bf16 v[16:19], v[8:11], v[52:59], v74
  ds_read_b128 v[44:47], v75 offset:61440
  v_smfmac_f32_16x16x64_bf16 v[20:23], v[4:7], a[192:199], v74
  ds_read_b128 v[48:51], v75 offset:62464
  v_smfmac_f32_16x16x64_bf16 v[20:23], v[8:11], a[200:207], v74
  ds_read_b128 v[60:63], v75 offset:63488
  s_waitcnt lgkmcnt(4)
  v_cvt_pk_bf16_f32 v16, v16, v17
  v_cvt_pk_bf16_f32 v17, v18, v19
  v_bfi_b32 v16, 1, s72, v16
  v_smfmac_f32_16x16x64_bf16 v[20:23], v[0:3], v[36:43], v74
  s_waitcnt lgkmcnt(3)
  buffer_store_dwordx2 v[16:17], v68, s[8:11], s73 offen
  v_mov_b64 v[32:33], 0
  v_smfmac_f32_16x16x64_bf16 v[24:27], v[4:7], a[208:215], v74
  ds_read_b128 v[64:67], v75 offset:64512
  v_mov_b64 v[34:35], 0
  v_smfmac_f32_16x16x64_bf16 v[24:27], v[8:11], a[216:223], v74
  ds_read_b128 v[52:55], v75 offset:8192
  v_cvt_pk_bf16_f32 v20, v20, v21
  v_cvt_pk_bf16_f32 v21, v22, v23
  v_bfi_b32 v20, 1, s72, v20
  v_smfmac_f32_16x16x64_bf16 v[24:27], v[0:3], a[224:231], v74
  ds_read_b128 v[56:59], v75 offset:9216
  buffer_store_dwordx2 v[20:21], v68, s[8:11], s74 offen
  s_waitcnt lgkmcnt(4)
  v_mov_b64 v[28:29], 0
  v_smfmac_f32_16x16x64_bf16 v[32:35], v[4:7], v[44:51], v74
  ds_read_b128 v[36:39], v75 offset:10240
  ds_read_b128 v[40:43], v75 offset:11264
  s_waitcnt lgkmcnt(4)
  v_smfmac_f32_16x16x64_bf16 v[32:35], v[8:11], v[60:67], v74
  ds_read_b128 v[44:47], v75 offset:12288
  v_cvt_pk_bf16_f32 v24, v24, v25
  v_cvt_pk_bf16_f32 v25, v26, v27
  v_bfi_b32 v24, 1, s72, v24
  v_smfmac_f32_16x16x64_bf16 v[32:35], v[0:3], a[240:247], v74
  ds_read_b128 v[48:51], v75 offset:13312
  buffer_store_dwordx2 v[24:25], v68, s[8:11], s75 offen
  v_mov_b64 v[30:31], 0
  v_smfmac_f32_16x16x64_bf16 v[32:35], v[12:15], a[248:255], v74
  ds_read_b128 v[60:63], v75 offset:14336
  ds_read_b128 v[64:67], v75 offset:15360
  s_waitcnt lgkmcnt(6)
  v_smfmac_f32_16x16x64_bf16 v[28:31], v[4:7], v[52:59], v74
  s_waitcnt lgkmcnt(4)
  v_smfmac_f32_16x16x64_bf16 v[28:31], v[8:11], v[36:43], v74
  s_waitcnt lgkmcnt(2)
  v_cvt_pk_bf16_f32 v32, v32, v33
  v_cvt_pk_bf16_f32 v33, v34, v35
  v_bfi_b32 v32, 1, s72, v32
  v_smfmac_f32_16x16x64_bf16 v[28:31], v[0:3], v[44:51], v74
  buffer_store_dwordx2 v[32:33], v68, s[8:11], s76 offen
  s_waitcnt lgkmcnt(0)
  v_smfmac_f32_16x16x64_bf16 v[28:31], v[12:15], v[60:67], v74
  v_mov_b64 v[18:19], v[72:73]
  s_nop 4
  v_cvt_pk_bf16_f32 v28, v28, v29
  v_cvt_pk_bf16_f32 v29, v30, v31
  v_bfi_b32 v28, 1, s72, v28
  buffer_store_dwordx2 v[28:29], v68, s[8:11], s77 offen
  ds_read_b128 v[52:55], v76 offset:14848
  s_waitcnt lgkmcnt(0)
  ds_read_b64 v[16:17], v77 offset:392
  s_waitcnt lgkmcnt(0)
  ds_read_b128 v[60:63], v76 offset:47104
  s_waitcnt lgkmcnt(0)
  ds_read_b128 v[64:67], v76 offset:48128
  s_waitcnt lgkmcnt(0)
  s_add_u32 s66, s66, 1
  s_xor_b32 s64, s64, 16384
  s_xor_b32 s65, s65, 16384
  s_add_u32 s58, s58, 655360
  s_add_u32 s59, s59, 655360
  s_add_u32 s70, s70, 655360
  s_add_u32 s68, s68, 655360
  s_mov_b32 m0, 8704
  s_add_u32 s85, s65, 4096
  v_xor_b32 v75, 0x8000, v75
  v_mov_b64 v[28:29], 0
  v_mov_b64 v[30:31], 0
  v_mov_b64 v[32:33], 0
  v_mov_b64 v[34:35], 0
  buffer_load_dwordx4 v[0:3], v76, s[8:11], s60 offen offset:0 sc1
  buffer_load_dwordx4 v[4:7], v76, s[8:11], s60 offen offset:1024 sc1
  buffer_load_dwordx4 v[8:11], v76, s[8:11], s61 offen offset:0 sc1
  buffer_load_dwordx4 v[12:15], v76, s[8:11], s61 offen offset:1024 sc1
  v_mov_b64 v[20:21], 0
  v_mov_b64 v[22:23], 0
  v_mov_b64 v[24:25], 0
  v_mov_b64 v[26:27], 0
  v_mov_b32 v68, 14880
  s_cmp_eq_u32 s66, 62
  s_cselect_b64 s[16:17], s[20:21], s[16:17]
  s_cselect_b32 s18, (Cf3_done - Cf3_last), s18
  s_cselect_b32 s70, 0, s70
  s_cmp_eq_u32 s66, 63
  s_cselect_b32 s59, 268435456, s59
  s_cselect_b32 s58, 268435456, s58
  s_waitcnt lgkmcnt(0)
  s_waitcnt vmcnt(3)
  v_mfma_f32_16x16x32_bf16 v[56:59], v[52:55], v[0:3], 0
  v_bitop3_b32 v72, v0, v2, s72 bitop3:0x7e
  s_waitcnt vmcnt(2)
  v_mfma_f32_16x16x32_bf16 v[56:59], v[52:55], v[4:7], v[56:59]
  v_bitop3_b32 v73, v4, v6, s72 bitop3:0x7e
  v_or_b32 v72, v72, v73
  s_waitcnt vmcnt(1)
  v_mfma_f32_16x16x32_bf16 v[36:39], v[52:55], v[8:11], 0
  v_bitop3_b32 v73, v8, v10, s72 bitop3:0x7e
  v_or_b32 v72, v72, v73
  s_waitcnt vmcnt(0)
  v_mfma_f32_16x16x32_bf16 v[36:39], v[52:55], v[12:15], v[36:39]
  v_bitop3_b32 v73, v12, v14, s72 bitop3:0x7e
  v_bitop3_b32 v72, v72, v73, 1 bitop3:0xa8
  v_cmp_ne_u32 vcc, 0, v72
  s_cbranch_vccnz Cf3_h1r
  buffer_load_dwordx4 v[4:7], v76, s[8:11], s65 offen offset:1024 sc1
  v_add_f32_dpp v56, v56, v56 row_ror:4 row_mask:0xf bank_mask:0xf
  v_add_f32_dpp v57, v57, v57 row_ror:4 row_mask:0xf bank_mask:0xf
  v_add_f32_dpp v36, v36, v36 row_ror:4 row_mask:0xf bank_mask:0xf
  v_add_f32_dpp v37, v37, v37 row_ror:4 row_mask:0xf bank_mask:0xf
  v_add_f32_dpp v56, v56, v56 row_ror:8 row_mask:0xf bank_mask:0xf
  v_add_f32_dpp v57, v57, v57 row_ror:8 row_mask:0xf bank_mask:0xf
  v_add_f32_dpp v36, v36, v36 row_ror:8 row_mask:0xf bank_mask:0xf
  v_add_f32_dpp v37, v37, v37 row_ror:8 row_mask:0xf bank_mask:0xf
  v_cvt_pk_bf16_f32 v56, v56, v57
  buffer_store_dword v56, v69, s[8:11], s62 offen
  v_cvt_pk_bf16_f32 v36, v36, v37
  buffer_store_dword v36, v70, s[8:11], s63 offen
  s_xor_b32 s62, s62, 16384
  buffer_store_dword v71, v69, s[8:11], s62 offen
  s_xor_b32 s63, s63, 16384
  buffer_store_dword v71, v70, s[8:11], s63 offen
  s_xor_b32 s72, s72, 1
  s_branch Cf3_h2
Cf3_h1r:
  s_mov_b64 exec, vcc
  buffer_load_dwordx4 v[0:3], v76, s[8:11], s60 offen offset:0 sc1
  buffer_load_dwordx4 v[4:7], v76, s[8:11], s60 offen offset:1024 sc1
  buffer_load_dwordx4 v[8:11], v76, s[8:11], s61 offen offset:0 sc1
  buffer_load_dwordx4 v[12:15], v76, s[8:11], s61 offen offset:1024 sc1
  s_mov_b64 exec, -1
  s_add_u32 s67, s67, 1
  s_waitcnt vmcnt(3)
  v_mfma_f32_16x16x32_bf16 v[56:59], v[52:55], v[0:3], 0
  v_bitop3_b32 v72, v0, v2, s72 bitop3:0x7e
  s_waitcnt vmcnt(2)
  v_mfma_f32_16x16x32_bf16 v[56:59], v[52:55], v[4:7], v[56:59]
  v_bitop3_b32 v73, v4, v6, s72 bitop3:0x7e
  v_or_b32 v72, v72, v73
  s_waitcnt vmcnt(1)
  v_mfma_f32_16x16x32_bf16 v[36:39], v[52:55], v[8:11], 0
  v_bitop3_b32 v73, v8, v10, s72 bitop3:0x7e
  v_or_b32 v72, v72, v73
  s_waitcnt vmcnt(0)
  v_mfma_f32_16x16x32_bf16 v[36:39], v[52:55], v[12:15], v[36:39]
  v_bitop3_b32 v73, v12, v14, s72 bitop3:0x7e
  v_bitop3_b32 v72, v72, v73, 1 bitop3:0xa8
  v_cmp_ne_u32 vcc, 0, v72
  s_cbranch_vccz Cf3_h1p
Cf3_h1s:
  s_mov_b64 exec, vcc
  buffer_load_dwordx4 v[0:3], v76, s[8:11], s60 offen offset:0 sc1
  buffer_load_dwordx4 v[4:7], v76, s[8:11], s60 offen offset:1024 sc1
  buffer_load_dwordx4 v[8:11], v76, s[8:11], s61 offen offset:0 sc1
  buffer_load_dwordx4 v[12:15], v76, s[8:11], s61 offen offset:1024 sc1
  s_mov_b64 exec, -1
  s_add_u32 s67, s67, 1
  s_waitcnt vmcnt(3)
  v_mfma_f32_16x16x32_bf16 v[56:59], v[52:55], v[0:3], 0
  v_bitop3_b32 v72, v0, v2, s72 bitop3:0x7e
  s_waitcnt vmcnt(2)
  v_mfma_f32_16x16x32_bf16 v[56:59], v[52:55], v[4:7], v[56:59]
  v_bitop3_b32 v73, v4, v6, s72 bitop3:0x7e
  v_or_b32 v72, v72, v73
  s_waitcnt vmcnt(1)
  v_mfma_f32_16x16x32_bf16 v[36:39], v[52:55], v[8:11], 0
  v_bitop3_b32 v73, v8, v10, s72 bitop3:0x7e
  v_or_b32 v72, v72, v73
  s_waitcnt vmcnt(0)
  v_mfma_f32_16x16x32_bf16 v[36:39], v[52:55], v[12:15], v[36:39]
  v_bitop3_b32 v73, v12, v14, s72 bitop3:0x7e
  v_bitop3_b32 v72, v72, v73, 1 bitop3:0xa8
  v_cmp_ne_u32 vcc, 0, v72
  s_cbranch_vccz Cf3_h1p
  s_cmp_lt_u32 s67, 131072
  s_cbranch_scc1 Cf3_h1s
Cf3_h1p:
  s_nop 2
  buffer_load_dwordx4 v[4:7], v76, s[8:11], s65 offen offset:1024 sc1
  v_add_f32_dpp v56, v56, v56 row_ror:4 row_mask:0xf bank_mask:0xf
  v_add_f32_dpp v57, v57, v57 row_ror:4 row_mask:0xf bank_mask:0xf
  v_add_f32_dpp v36, v36, v36 row_ror:4 row_mask:0xf bank_mask:0xf
  v_add_f32_dpp v37, v37, v37 row_ror:4 row_mask:0xf bank_mask:0xf
  v_add_f32_dpp v56, v56, v56 row_ror:8 row_mask:0xf bank_mask:0xf
  v_add_f32_dpp v57, v57, v57 row_ror:8 row_mask:0xf bank_mask:0xf
  v_add_f32_dpp v36, v36, v36 row_ror:8 row_mask:0xf bank_mask:0xf
  v_add_f32_dpp v37, v37, v37 row_ror:8 row_mask:0xf bank_mask:0xf
  v_cvt_pk_bf16_f32 v56, v56, v57
  buffer_store_dword v56, v69, s[8:11], s62 offen
  v_cvt_pk_bf16_f32 v36, v36, v37
  buffer_store_dword v36, v70, s[8:11], s63 offen
  s_xor_b32 s62, s62, 16384
  buffer_store_dword v71, v69, s[8:11], s62 offen
  s_xor_b32 s63, s63, 16384
  buffer_store_dword v71, v70, s[8:11], s63 offen
  s_xor_b32 s72, s72, 1
  s_branch Cf3_h2
Cf3_h2r:
  s_mov_b64 exec, vcc
  buffer_load_dwordx4 v[4:7], v76, s[8:11], s65 offen offset:1024 sc1
  s_mov_b64 exec, -1
  s_add_u32 s67, s67, 1
  s_waitcnt vmcnt(3)
  v_max3_u32 v72, v4, v5, v6
  v_max_u32 v72, v72, v7
  ds_write_b128 v76, v[4:7] offset:5632
  v_cmp_eq_u32 vcc, -1, v72
  s_cbranch_vccz Cf3_h2w
Cf3_h2s:
  s_mov_b64 exec, vcc
  buffer_load_dwordx4 v[4:7], v76, s[8:11], s65 offen offset:1024 sc1
  s_mov_b64 exec, -1
  s_add_u32 s67, s67, 1
  s_waitcnt vmcnt(1)
  v_max3_u32 v72, v4, v5, v6
  v_max_u32 v72, v72, v7
  ds_write_b128 v76, v[4:7] offset:5632
  v_cmp_eq_u32 vcc, -1, v72
  s_cbranch_vccz Cf3_h2w
  s_mov_b64 exec, vcc
  buffer_load_dwordx4 v[4:7], v76, s[8:11], s65 offen offset:1024 sc1
  s_mov_b64 exec, -1
  s_add_u32 s67, s67, 1
  s_waitcnt vmcnt(1)
  v_max3_u32 v72, v4, v5, v6
  v_max_u32 v72, v72, v7
  ds_write_b128 v76, v[4:7] offset:5632
  v_cmp_eq_u32 vcc, -1, v72
  s_cbranch_vccz Cf3_h2w
  s_mov_b64 exec, vcc
  buffer_load_dwordx4 v[4:7], v76, s[8:11], s65 offen offset:1024 sc1
  s_mov_b64 exec, -1
  s_add_u32 s67, s67, 1
  s_waitcnt vmcnt(1)
  v_max3_u32 v72, v4, v5, v6
  v_max_u32 v72, v72, v7
  ds_write_b128 v76, v[4:7] offset:5632
  v_cmp_eq_u32 vcc, -1, v72
  s_cbranch_vccz Cf3_h2w
  s_cmp_lt_u32 s67, 131072
  s_cbranch_scc1 Cf3_h2s
  s_branch Cf3_h2w
Cf3_rec:
  s_nop 7
  s_waitcnt vmcnt(0) lgkmcnt(0)
  v_max3_u32 v72, v0, v1, v2
  v_max3_u32 v72, v72, v3, v4
  v_max3_u32 v72, v72, v5, v6
  v_max3_u32 v72, v72, v7, v8
  v_max3_u32 v72, v72, v9, v10
  v_max3_u32 v72, v72, v11, v12
  v_max3_u32 v72, v72, v13, v14
  v_max3_u32 v72, v72, v15, v16
  v_max3_u32 v72, v72, v17, v18
  v_max_u32 v72, v72, v19
  v_cmp_eq_u32 vcc, -1, v72
  s_cbranch_vccz Cf3_recok
  s_barrier
Cf3_recp:
  buffer_load_dwordx4 v[0:3], v76, s[8:11], s64 offen offset:0 sc1
  buffer_load_dwordx4 v[4:7], v76, s[8:11], s64 offen offset:1024 sc1
  buffer_load_dwordx4 v[8:11], v76, s[8:11], s64 offen offset:2048 sc1
  s_add_u32 s67, s67, 1
  s_cmp_lt_u32 s67, 131072
  s_cselect_b32 s54, -2, -1
  s_waitcnt vmcnt(2)
  v_max3_u32 v72, v0, v1, v2
  s_waitcnt vmcnt(1)
  v_max3_u32 v72, v72, v3, v4
  v_max3_u32 v72, v72, v5, v6
  s_waitcnt vmcnt(0)
  v_max3_u32 v72, v72, v7, v8
  v_max3_u32 v72, v72, v9, v10
  v_max_u32 v72, v72, v11
  v_cmp_lt_u32 vcc, s54, v72
  s_cbranch_vccnz Cf3_recp
  ds_write_b128 v76, v[0:3] offset:10752
  ds_write_b128 v76, v[4:7] offset:11776
  ds_write_b128 v76, v[8:11] offset:12800
  v_mov_b64 v[20:21], 0
  v_mov_b64 v[22:23], 0
  v_mov_b64 v[24:25], 0
  v_mov_b64 v[26:27], 0
  v_mov_b64 v[28:29], 0
  v_mov_b64 v[30:31], 0
  v_mov_b64 v[32:33], 0
  v_mov_b64 v[34:35], 0
  s_waitcnt lgkmcnt(0)
  s_barrier
  ds_read_b128 v[0:3], v76 offset:4608
  s_waitcnt lgkmcnt(0)
  v_smfmac_f32_16x16x64_bf16 v[20:23], v[0:3], v[80:87], v74
  v_smfmac_f32_16x16x64_bf16 v[24:27], v[0:3], v[88:95], v74
  ds_read_b128 v[60:63], v76 offset:28672
  ds_read_b128 v[64:67], v76 offset:29696
  s_waitcnt lgkmcnt(0)
  v_smfmac_f32_16x16x64_bf16 v[28:31], v[0:3], v[60:67], v74
  ds_read_b128 v[60:63], v76 offset:30720
  ds_read_b128 v[64:67], v76 offset:31744
  s_waitcnt lgkmcnt(0)
  v_smfmac_f32_16x16x64_bf16 v[32:35], v[0:3], v[60:67], v74
  ds_read_b128 v[4:7], v76 offset:5632
  s_waitcnt lgkmcnt(0)
  v_smfmac_f32_16x16x64_bf16 v[20:23], v[4:7], v[96:103], v74
  v_smfmac_f32_16x16x64_bf16 v[24:27], v[4:7], v[104:111], v74
  ds_read_b128 v[60:63], v76 offset:45056
  ds_read_b128 v[64:67], v76 offset:46080
  s_waitcnt lgkmcnt(0)
  v_smfmac_f32_16x16x64_bf16 v[28:31], v[4:7], v[60:67], v74
  ds_read_b128 v[60:63], v76 offset:47104
  ds_read_b128 v[64:67], v76 offset:48128
  s_waitcnt lgkmcnt(0)
  v_smfmac_f32_16x16x64_bf16 v[32:35], v[4:7], v[60:67], v74
  ds_read_b128 v[8:11], v76 offset:6656
  s_waitcnt lgkmcnt(0)
  v_smfmac_f32_16x16x64_bf16 v[20:23], v[8:11], v[112:119], v74
  v_smfmac_f32_16x16x64_bf16 v[24:27], v[8:11], v[120:127], v74
  v_smfmac_f32_16x16x64_bf16 v[28:31], v[8:11], v[208:215], v74
  v_smfmac_f32_16x16x64_bf16 v[32:35], v[8:11], v[216:223], v74
  ds_read_b128 v[12:15], v76 offset:7680
  s_waitcnt lgkmcnt(0)
  v_smfmac_f32_16x16x64_bf16 v[20:23], v[12:15], v[128:135], v74
  v_smfmac_f32_16x16x64_bf16 v[24:27], v[12:15], v[136:143], v74
  v_smfmac_f32_16x16x64_bf16 v[28:31], v[12:15], v[224:231], v74
  v_smfmac_f32_16x16x64_bf16 v[32:35], v[12:15], v[232:239], v74
  ds_read_b128 v[4:7], v76 offset:8704
  s_waitcnt lgkmcnt(0)
  v_smfmac_f32_16x16x64_bf16 v[20:23], v[4:7], v[144:151], v74
  v_smfmac_f32_16x16x64_bf16 v[24:27], v[4:7], v[152:159], v74
  ds_read_b128 v[60:63], v76 offset:61440
  ds_read_b128 v[64:67], v76 offset:62464
  s_waitcnt lgkmcnt(0)
  v_smfmac_f32_16x16x64_bf16 v[28:31], v[4:7], v[60:67], v74
  ds_read_b128 v[60:63], v76 offset:63488
  ds_read_b128 v[64:67], v76 offset:64512
  s_waitcnt lgkmcnt(0)
  v_smfmac_f32_16x16x64_bf16 v[32:35], v[4:7], v[60:67], v74
  ds_read_b128 v[8:11], v76 offset:9728
  s_waitcnt lgkmcnt(0)
  v_smfmac_f32_16x16x64_bf16 v[20:23], v[8:11], v[160:167], v74
  v_smfmac_f32_16x16x64_bf16 v[24:27], v[8:11], v[168:175], v74
  ds_read_b128 v[60:63], v75 offset:28672
  ds_read_b128 v[64:67], v75 offset:29696
  s_waitcnt lgkmcnt(0)
  v_smfmac_f32_16x16x64_bf16 v[28:31], v[8:11], v[60:67], v74
  ds_read_b128 v[60:63], v75 offset:30720
  ds_read_b128 v[64:67], v75 offset:31744
  s_waitcnt lgkmcnt(0)
  v_smfmac_f32_16x16x64_bf16 v[32:35], v[8:11], v[60:67], v74
  ds_read_b128 v[16:19], v76 offset:10752
  ds_read_b128 v[60:63], v75 offset:12288
  ds_read_b128 v[64:67], v75 offset:13312
  s_waitcnt lgkmcnt(0)
  v_smfmac_f32_16x16x64_bf16 v[20:23], v[16:19], v[60:67], v74
  ds_read_b128 v[60:63], v75 offset:14336
  ds_read_b128 v[64:67], v75 offset:15360
  s_waitcnt lgkmcnt(0)
  v_smfmac_f32_16x16x64_bf16 v[24:27], v[16:19], v[60:67], v74
  v_smfmac_f32_16x16x64_bf16 v[28:31], v[16:19], v[240:247], v74
  v_smfmac_f32_16x16x64_bf16 v[32:35], v[16:19], v[248:255], v74
  ds_read_b128 v[0:3], v76 offset:11776
  s_waitcnt lgkmcnt(0)
  v_smfmac_f32_16x16x64_bf16 v[20:23], v[0:3], v[176:183], v74
  v_smfmac_f32_16x16x64_bf16 v[24:27], v[0:3], v[184:191], v74
  v_smfmac_f32_16x16x64_bf16 v[28:31], v[0:3], a[0:7], v74
  v_smfmac_f32_16x16x64_bf16 v[32:35], v[0:3], a[8:15], v74
  ds_read_b128 v[12:15], v76 offset:12800
  s_waitcnt lgkmcnt(0)
  v_smfmac_f32_16x16x64_bf16 v[20:23], v[12:15], v[192:199], v74
  v_smfmac_f32_16x16x64_bf16 v[24:27], v[12:15], v[200:207], v74
  v_smfmac_f32_16x16x64_bf16 v[28:31], v[12:15], a[16:23], v74
  v_smfmac_f32_16x16x64_bf16 v[32:35], v[12:15], a[24:31], v74
  v_add_f32 v20, v20, v22
  v_add_f32 v21, v21, v23
  v_add_f32 v24, v24, v26
  v_cvt_pk_bf16_f32 v22, v20, v24
  ds_write_b32 v79, v22 offset:0
  v_add_f32 v25, v25, v27
  v_cvt_pk_bf16_f32 v23, v21, v25
  ds_write_b32 v79, v23 offset:576
  v_add_f32 v28, v28, v30
  v_add_f32 v29, v29, v31
  s_waitcnt lgkmcnt(0)
  s_nop 1
  s_branch Cf3_recok
Cf3_mx:
  s_waitcnt lgkmcnt(0)
  s_barrier
  buffer_load_dwordx4 v[52:55], v76, s[8:11], s59 offen offset:0 sc1
  buffer_load_dwordx4 v[0:3], v76, s[8:11], s58 offen offset:0 sc1
  ds_read_b128 v[20:23], v77 offset:0
  ds_read_b128 v[28:31], v77 offset:256
  buffer_load_dwordx4 v[56:59], v76, s[8:11], s59 offen offset:1024 sc1
  buffer_load_dwordx4 v[4:7], v76, s[8:11], s58 offen offset:1024 sc1
  ds_read_b128 v[24:27], v77 offset:128
  ds_read_b128 v[32:35], v77 offset:384
  s_waitcnt vmcnt(2) lgkmcnt(3)
  v_mfma_f32_16x16x32_bf16 v[8:11], v[0:3], v[20:23], 0
  s_waitcnt vmcnt(0) lgkmcnt(1)
  v_mfma_f32_16x16x32_bf16 v[8:11], v[4:7], v[24:27], v[8:11]
  v_mfma_f32_16x16x32_bf16 v[12:15], v[28:31], v[20:23], 0
  s_waitcnt lgkmcnt(0)
  v_mfma_f32_16x16x32_bf16 v[12:15], v[32:35], v[24:27], v[12:15]
  v_add_f32_dpp v8, v10, v8 quad_perm:[2,3,0,1] row_mask:0xf bank_mask:0xf
  v_add_f32_dpp v9, v11, v9 quad_perm:[2,3,0,1] row_mask:0xf bank_mask:0xf
  s_nop 0
  v_mov_b32_dpp v8, v8 quad_perm:[0,1,0,1] row_mask:0xf bank_mask:0xf
  v_mov_b32_dpp v9, v9 quad_perm:[0,1,0,1] row_mask:0xf bank_mask:0xf
  s_nop 1
  v_add_f32_dpp v12, v14, v12 quad_perm:[2,3,0,1] row_mask:0xf bank_mask:0xf
  v_add_f32_dpp v13, v15, v13 quad_perm:[2,3,0,1] row_mask:0xf bank_mask:0xf
  s_nop 0
  v_mov_b32_dpp v12, v12 quad_perm:[0,1,0,1] row_mask:0xf bank_mask:0xf
  v_mov_b32_dpp v13, v13 quad_perm:[0,1,0,1] row_mask:0xf bank_mask:0xf
  v_mul_f32 v12, s69, v12
  ds_write_b32 v78, v8 offset:8716
  v_mul_f32 v13, s69, v13
  ds_write_b32 v78, v9 offset:8780
  s_waitcnt lgkmcnt(0)
  s_barrier
  ds_read_b128 v[36:39], v78 offset:8704
  ds_read_b128 v[40:43], v78 offset:8768
  s_waitcnt lgkmcnt(0)
  s_barrier
  v_max_f32 v16, v36, v37
  v_max3_f32 v16, v16, v38, v39
  v_max3_f32 v16, v16, v40, v41
  v_max3_f32 v16, v16, v42, v43
  v_max3_f32 v16, v16, v12, v13
  v_mov_b32 v17, v16
  s_nop 1
  v_permlane16_swap_b32 v16, v17
  v_max_f32 v16, v16, v17
  v_mov_b32 v17, v16
  s_nop 1
  v_permlane32_swap_b32 v16, v17
  v_max_f32 v16, v16, v17
  v_sub_f32 v36, v36, v16
  v_sub_f32 v37, v37, v16
  v_sub_f32 v38, v38, v16
  v_sub_f32 v39, v39, v16
  v_sub_f32 v40, v40, v16
  v_sub_f32 v41, v41, v16
  v_sub_f32 v42, v42, v16
  v_sub_f32 v43, v43, v16
  v_sub_f32 v12, v12, v16
  v_sub_f32 v13, v13, v16
  v_exp_f32 v36, v36
  v_exp_f32 v37, v37
  v_exp_f32 v38, v38
  v_exp_f32 v39, v39
  v_exp_f32 v40, v40
  v_exp_f32 v41, v41
  v_exp_f32 v42, v42
  v_exp_f32 v43, v43
  v_exp_f32 v12, v12
  v_exp_f32 v13, v13
  v_cvt_pk_bf16_f32 v32, v36, v40
  v_cvt_pk_bf16_f32 v33, v37, v41
  v_cvt_pk_bf16_f32 v34, v38, v42
  v_cvt_pk_bf16_f32 v35, v39, v43
  v_cvt_pk_bf16_f32 v28, v12, v13
  v_cvt_pk_bf16_f32 v31, v12, v13
  v_mov_b32 v29, 0
  v_mov_b32 v30, 0
  v_mfma_f32_16x16x32_bf16 v[8:11], v[32:35], v[68:71], 0
  v_mfma_f32_16x16x32_bf16 v[0:3], v[32:35], v[52:55], 0
  v_mfma_f32_16x16x32_bf16 v[4:7], v[32:35], v[56:59], 0
  v_mfma_f32_16x16x16_bf16 v[8:11], v[28:29], v[68:69], v[8:11]
  v_mfma_f32_16x16x16_bf16 v[0:3], v[28:29], v[72:73], v[0:3]
  v_mfma_f32_16x16x16_bf16 v[4:7], v[30:31], v[72:73], v[4:7]
  ds_read_b128 v[52:55], v75 offset:30720
  v_rcp_f32 v10, v8
  v_rcp_f32 v11, v9
  v_mul_f32 v0, v10, v0
  v_mul_f32 v1, v11, v1
  v_max3_f32 v8, v8, v9, v10
  v_mul_f32 v4, v10, v4
  v_mul_f32 v5, v11, v5
  v_cvt_pk_bf16_f32 v2, v0, v4
  ds_write_b32 v79, v2 offset:8704
  v_cvt_pk_bf16_f32 v3, v1, v5
  ds_write_b32 v79, v3 offset:9280
  ds_read_b128 v[12:15], v78 offset:8896
  ds_read_b128 v[56:59], v75 offset:31744
  v_mov_b64 v[16:17], 0
  v_mov_b64 v[18:19], 0
  v_mov_b64 v[20:21], 0
  v_mov_b64 v[22:23], 0
  v_mov_b64 v[24:25], 0
  v_mov_b64 v[26:27], 0
  s_branch Cf3_mxok
Cf3_last:
  ds_read_b128 v[0:3], v76 offset:4608
  ds_read_b128 v[12:15], v76 offset:7680
  ds_read_b128 v[44:47], v76 offset:28672
  ds_read_b128 v[48:51], v76 offset:29696
  s_nop 5
  v_mov_b64 v[20:21], 0
  v_mov_b64 v[22:23], 0
  v_mov_b64 v[24:25], 0
  v_mov_b64 v[26:27], 0
  v_smfmac_f32_16x16x64_bf16 v[28:31], v[4:7], v[36:43], v74
  ds_read_b128 v[36:39], v76 offset:30720
  ds_read_b128 v[40:43], v76 offset:31744
  v_smfmac_f32_16x16x64_bf16 v[32:35], v[4:7], v[60:67], v74
  s_waitcnt lgkmcnt(5)
  v_smfmac_f32_16x16x64_bf16 v[20:23], v[0:3], a[32:39], v74
  ds_read_b128 v[60:63], v76 offset:61440
  ds_read_b128 v[64:67], v76 offset:62464
  v_smfmac_f32_16x16x64_bf16 v[24:27], v[0:3], a[40:47], v74
  s_waitcnt lgkmcnt(4)
  v_smfmac_f32_16x16x64_bf16 v[20:23], v[4:7], a[48:55], v74
  buffer_store_dwordx4 v[16:19], v76, s[8:11], s68 offen sc1
  v_smfmac_f32_16x16x64_bf16 v[24:27], v[4:7], a[56:63], v74
  v_smfmac_f32_16x16x64_bf16 v[28:31], v[0:3], v[44:51], v74
  s_waitcnt lgkmcnt(2)
  v_smfmac_f32_16x16x64_bf16 v[20:23], v[8:11], a[64:71], v74
  ds_read_b128 v[44:47], v76 offset:63488
  ds_read_b128 v[48:51], v76 offset:64512
  v_smfmac_f32_16x16x64_bf16 v[24:27], v[8:11], a[72:79], v74
  v_smfmac_f32_16x16x64_bf16 v[32:35], v[0:3], v[36:43], v74
  v_smfmac_f32_16x16x64_bf16 v[28:31], v[8:11], v[208:215], v74
  ds_read_b128 v[36:39], v75 offset:28672
  ds_read_b128 v[40:43], v75 offset:29696
  v_smfmac_f32_16x16x64_bf16 v[32:35], v[8:11], v[216:223], v74
  v_smfmac_f32_16x16x64_bf16 v[20:23], v[12:15], a[80:87], v74
  v_smfmac_f32_16x16x64_bf16 v[24:27], v[12:15], a[88:95], v74
  v_smfmac_f32_16x16x64_bf16 v[28:31], v[12:15], v[224:231], v74
  v_smfmac_f32_16x16x64_bf16 v[32:35], v[12:15], v[232:239], v74
  s_waitcnt vmcnt(1)
  s_barrier
Cf3_lastr:
  ds_read_b128 v[4:7], v76 offset:8704
  ds_read_b128 v[8:11], v76 offset:9728
  ds_read_b128 v[16:19], v76 offset:10752
  ds_read_b128 v[0:3], v76 offset:11776
  ds_read_b128 v[12:15], v76 offset:12800
  s_waitcnt lgkmcnt(1)
  v_max3_u32 v72, v0, v1, v2
  v_max3_u32 v72, v72, v3, v4
  v_max3_u32 v72, v72, v5, v6
  v_max3_u32 v72, v72, v7, v8
  v_max3_u32 v72, v72, v9, v10
  s_waitcnt lgkmcnt(0)
  v_max3_u32 v72, v72, v11, v12
  v_max3_u32 v72, v72, v13, v14
  v_max3_u32 v72, v72, v15, v16
  v_max3_u32 v72, v72, v17, v18
  v_max_u32 v72, v72, v19
  v_cmp_eq_u32 vcc, -1, v72
  s_cbranch_vccnz Cf3_lastp
Cf3_lastg:
  v_smfmac_f32_16x16x64_bf16 v[28:31], v[4:7], v[60:67], v74
  ds_read_b128 v[60:63], v75 offset:30720
  ds_read_b128 v[64:67], v75 offset:31744
  v_smfmac_f32_16x16x64_bf16 v[32:35], v[4:7], v[44:51], v74
  v_smfmac_f32_16x16x64_bf16 v[28:31], v[8:11], v[36:43], v74
  v_smfmac_f32_16x16x64_bf16 v[28:31], v[16:19], v[240:247], v74
  v_smfmac_f32_16x16x64_bf16 v[28:31], v[0:3], a[0:7], v74
  v_smfmac_f32_16x16x64_bf16 v[28:31], v[12:15], a[16:23], v74
  v_smfmac_f32_16x16x64_bf16 v[32:35], v[16:19], v[248:255], v74
  v_smfmac_f32_16x16x64_bf16 v[32:35], v[0:3], a[8:15], v74
  s_waitcnt lgkmcnt(0)
  v_smfmac_f32_16x16x64_bf16 v[32:35], v[12:15], a[24:31], v74
  v_smfmac_f32_16x16x64_bf16 v[32:35], v[8:11], v[60:67], v74
  v_smfmac_f32_16x16x64_bf16 v[20:23], v[4:7], a[96:103], v74
  v_smfmac_f32_16x16x64_bf16 v[20:23], v[8:11], a[112:119], v74
  v_add_f32 v28, v28, v30
  v_add_f32 v32, v32, v34
  v_cvt_pk_bf16_f32 v30, v28, v32
  v_smfmac_f32_16x16x64_bf16 v[20:23], v[16:19], a[128:135], v74
  ds_write_b32 v79, v30 offset:256
  v_add_f32 v29, v29, v31
  v_add_f32 v33, v33, v35
  v_cvt_pk_bf16_f32 v31, v29, v33
  v_smfmac_f32_16x16x64_bf16 v[20:23], v[0:3], a[144:151], v74
  ds_write_b32 v79, v31 offset:832
  v_smfmac_f32_16x16x64_bf16 v[20:23], v[12:15], a[160:167], v74
  v_smfmac_f32_16x16x64_bf16 v[24:27], v[4:7], a[104:111], v74
  v_smfmac_f32_16x16x64_bf16 v[24:27], v[8:11], a[120:127], v74
  v_smfmac_f32_16x16x64_bf16 v[24:27], v[16:19], a[136:143], v74
  s_waitcnt lgkmcnt(0)
  s_barrier
  ds_read_b64 v[52:53], v77 offset:392
  v_add_f32 v20, v20, v22
  v_smfmac_f32_16x16x64_bf16 v[24:27], v[0:3], a[152:159], v74
  v_add_f32 v21, v21, v23
  v_smfmac_f32_16x16x64_bf16 v[24:27], v[12:15], a[168:175], v74
  v_cvt_pk_bf16_f32 v54, v20, v21
  s_add_u32 s68, s68, 655360
  s_nop 3
  v_add_f32 v24, v24, v26
  v_add_f32 v25, v25, v27
  v_cvt_pk_bf16_f32 v55, v24, v25
  s_waitcnt lgkmcnt(0)
  buffer_store_dwordx4 v[52:55], v76, s[8:11], s68 offen sc1
  s_branch Cf3_done
Cf3_lastp:
  s_add_u32 s72, s72, 2
  s_cmp_ge_u32 s72, 131072
  s_cbranch_scc1 Cf3_lastg
  s_barrier
  buffer_load_dwordx4 v76, s[8:11], s85 offen offset:0 sc1 lds
  buffer_load_dwordx4 v76, s[8:11], s85 offen offset:1024 sc1 lds
  s_waitcnt vmcnt(0)
  s_barrier
  s_branch Cf3_lastr
Cf3_done:
  s_branch L_cexit
L_w4:
  v_mov_b64 v[20:21], 0
  v_mov_b64 v[22:23], 0
  v_mov_b64 v[24:25], 0
  v_mov_b64 v[26:27], 0
  v_mov_b64 v[28:29], 0
  v_mov_b64 v[30:31], 0
  v_mov_b64 v[32:33], 0
  v_mov_b64 v[34:35], 0
  s_mov_b32 s78, 0x3f803f80
  s_mov_b32 s79, s78
  s_mov_b32 s65, 360448
  s_mov_b32 m0, 16128
  s_lshl_b32 s71, s53, 2
  s_add_u32 s71, s71, 128
  s_movk_i32 s56, 0x1000
  v_lshlrev_b32 v73, 2, v76
  v_mov_b32 v72, 0
  s_mov_b64 s[16:17], s[8:9]
  s_mov_b32 s18, 268435456
  s_mov_b32 s19, 0x20000
  s_getpc_b64 s[20:21]
Cs0_pc:
  s_add_u32 s20, s20, (Cs0_last - Cs0_pc)
  s_addc_u32 s21, s21, 0
  v_mov_b32 v68, 14880
  buffer_load_dwordx4 v[52:55], v76, s[8:11], s59 offen offset:0 sc1
  buffer_load_dwordx4 v[56:59], v76, s[8:11], s59 offen offset:1024 sc1
  ds_read_b128 v[36:39], v76 offset:16384
  ds_read_b128 v[40:43], v76 offset:17408
  ds_read_b128 v[60:63], v76 offset:18432
  ds_read_b128 v[64:67], v76 offset:19456
  ds_read_b128 v[0:3], v76 offset:4608
  ds_read_b128 v[4:7], v76 offset:5632
  ds_read_b128 v[8:11], v76 offset:6656
  ds_read_b128 v[12:15], v76 offset:7680
  s_waitcnt lgkmcnt(0)
  s_cmp_eq_u32 s66, 1
  s_branch Cs0_top2
.p2align 6
Cs0_h2:
  ds_read_b128 v[36:39], v76 offset:16384
  v_mov_b64 v[20:21], 0
  v_mov_b64 v[22:23], 0
  v_mov_b64 v[24:25], 0
  v_mov_b64 v[26:27], 0
  v_mov_b32 v68, 14880
  ds_read_b128 v[40:43], v76 offset:17408
  s_cmp_eq_u32 s66, 62
  s_cselect_b64 s[16:17], s[20:21], s[16:17]
  s_cselect_b32 s18, (Cs0_done - Cs0_last), s18
  s_cselect_b32 s70, 0, s70
  s_cmp_eq_u32 s66, 63
  s_cselect_b32 s59, 268435456, s59
  s_cselect_b32 s58, 268435456, s58
  ds_read_b128 v[60:63], v76 offset:18432
  v_lshlrev_b32 v73, 2, v76
  s_cmp_eq_u32 s66, 12
  s_cselect_b32 s56, s71, 0x1000
  ds_read_b32 v72, v76 offset:16128
  s_cmp_eq_u32 s66, 13
  s_cselect_b32 s54, 0x700, 0
  s_waitcnt lgkmcnt(0)
  v_readfirstlane_b32 s57, v72
  s_nop 0
  s_cmp_lt_u32 s57, s54
  s_cbranch_scc1 Cs0_kv3
Cs0_kvb:
  buffer_load_dwordx4 v[52:55], v76, s[8:11], s59 offen offset:0 sc1
  buffer_load_dwordx4 v[56:59], v76, s[8:11], s59 offen offset:1024 sc1
  s_waitcnt vmcnt(0)
  s_mov_b64 vcc, -1
Cs0_h2r:
  s_mov_b64 exec, vcc
  buffer_load_dwordx4 v[0:3], v76, s[8:11], s65 offen offset:0 sc1
  buffer_load_dwordx4 v[4:7], v76, s[8:11], s85 offen offset:0 sc1
  s_mov_b64 exec, -1
  s_add_u32 s67, s67, 1
  s_cmp_lt_u32 s67, 131072
  s_cselect_b32 s54, -2, -1
  s_waitcnt vmcnt(1)
  v_max3_u32 v72, v0, v1, v2
  s_waitcnt vmcnt(0)
  v_max3_u32 v72, v72, v3, v4
  v_max3_u32 v72, v72, v5, v6
  v_max_u32 v72, v72, v7
  v_cmp_lt_u32 vcc, s54, v72
  s_cbranch_vccnz Cs0_h2r
  ds_write_b128 v76, v[0:3] offset:4608
  ds_write_b128 v76, v[4:7] offset:10752
Cs0_h2w:
  s_cmp_eq_u32 s66, 63
  s_waitcnt lgkmcnt(0)
  s_barrier
  ds_read_b128 v[8:11], v76 offset:6656
Cs0_top2:
  v_smfmac_f32_16x16x64_bf16 v[20:23], v[0:3], v[80:87], v74
  s_cbranch_scc1 Cs0_last
  v_smfmac_f32_16x16x64_bf16 v[28:31], v[0:3], v[36:43], v74
  buffer_load_dwordx4 v[44:47], v76, s[8:11], s58 offen offset:0 sc1
  s_mov_b32 m0, 16128
  v_smfmac_f32_16x16x64_bf16 v[24:27], v[0:3], v[88:95], v74
  buffer_load_dwordx4 v[48:51], v76, s[8:11], s58 offen offset:1024 sc1
  v_smfmac_f32_16x16x64_bf16 v[32:35], v[0:3], v[60:67], v74
  ds_read_b128 v[4:7], v76 offset:5632
  s_waitcnt lgkmcnt(1)
  v_smfmac_f32_16x16x64_bf16 v[20:23], v[8:11], v[112:119], v74
  ds_read_b128 v[12:15], v76 offset:7680
  v_smfmac_f32_16x16x64_bf16 v[24:27], v[8:11], v[120:127], v74
  ds_read_b128 v[36:39], v76 offset:32768
  v_smfmac_f32_16x16x64_bf16 v[28:31], v[8:11], v[208:215], v74
  buffer_store_dwordx4 v[16:19], v76, s[8:11], s68 offen sc1
  ds_read_b128 v[40:43], v76 offset:33792
  v_smfmac_f32_16x16x64_bf16 v[32:35], v[8:11], v[216:223], v74
  buffer_load_dword v73, s[16:19], s70 offen lds
  ds_read_b128 v[60:63], v76 offset:34816
  s_waitcnt lgkmcnt(4)
  v_smfmac_f32_16x16x64_bf16 v[20:23], v[4:7], v[96:103], v74
  ds_read_b128 v[64:67], v76 offset:35840
  v_smfmac_f32_16x16x64_bf16 v[24:27], v[4:7], v[104:111], v74
  s_waitcnt vmcnt(4)
  s_waitcnt lgkmcnt(4)
  v_smfmac_f32_16x16x64_bf16 v[20:23], v[12:15], v[128:135], v74
  s_barrier
  ds_read_b128 v[0:3], v76 offset:8704
  s_waitcnt lgkmcnt(3)
  v_smfmac_f32_16x16x64_bf16 v[28:31], v[4:7], v[36:43], v74
  ds_read_b128 v[36:39], v76 offset:49152
  v_smfmac_f32_16x16x64_bf16 v[24:27], v[12:15], v[136:143], v74
  ds_read_b128 v[40:43], v76 offset:50176
  s_waitcnt lgkmcnt(3)
  v_smfmac_f32_16x16x64_bf16 v[32:35], v[4:7], v[60:67], v74
  ds_read_b128 v[8:11], v76 offset:9728
  v_smfmac_f32_16x16x64_bf16 v[28:31], v[12:15], v[224:231], v74
  ds_read_b128 v[60:63], v76 offset:51200
  v_smfmac_f32_16x16x64_bf16 v[32:35], v[12:15], v[232:239], v74
  ds_read_b128 v[64:67], v76 offset:52224
  s_waitcnt lgkmcnt(5)
  v_smfmac_f32_16x16x64_bf16 v[20:23], v[0:3], v[144:151], v74
  s_barrier
  ds_read_b128 v[4:7], v76 offset:11776
  s_waitcnt lgkmcnt(4)
  v_smfmac_f32_16x16x64_bf16 v[28:31], v[0:3], v[36:43], v74
  ds_read_b128 v[12:15], v76 offset:12800
  ds_read_b128 v[36:39], v75 offset:0
  v_smfmac_f32_16x16x64_bf16 v[24:27], v[0:3], v[152:159], v74
  ds_read_b128 v[16:19], v76 offset:10752
  s_waitcnt lgkmcnt(6)
  v_smfmac_f32_16x16x64_bf16 v[20:23], v[8:11], v[160:167], v74
  ds_read_b128 v[40:43], v75 offset:1024
  s_waitcnt lgkmcnt(5)
  v_smfmac_f32_16x16x64_bf16 v[32:35], v[0:3], v[60:67], v74
  ds_read_b128 v[60:63], v75 offset:2048
  v_smfmac_f32_16x16x64_bf16 v[24:27], v[8:11], v[168:175], v74
  ds_read_b128 v[64:67], v75 offset:3072
  s_waitcnt lgkmcnt(6)
  v_smfmac_f32_16x16x64_bf16 v[20:23], v[4:7], v[176:183], v74
  buffer_load_dword off, s[12:15], s56 sc1 lds
  s_waitcnt lgkmcnt(5)
  v_smfmac_f32_16x16x64_bf16 v[20:23], v[12:15], v[192:199], v74
  s_waitcnt lgkmcnt(2)
  v_smfmac_f32_16x16x64_bf16 v[20:23], v[16:19], v[36:43], v74
  ds_read_b128 v[36:39], v75 offset:16384
  v_smfmac_f32_16x16x64_bf16 v[24:27], v[4:7], v[184:191], v74
  ds_read_b128 v[40:43], v75 offset:17408
  s_waitcnt lgkmcnt(2)
  v_smfmac_f32_16x16x64_bf16 v[24:27], v[16:19], v[60:67], v74
  ds_read_b128 v[60:63], v75 offset:18432
  v_add_f32 v20, v20, v22
  v_smfmac_f32_16x16x64_bf16 v[24:27], v[12:15], v[200:207], v74
  ds_read_b128 v[64:67], v75 offset:19456
  v_add_f32 v21, v21, v23
  v_smfmac_f32_16x16x64_bf16 v[28:31], v[16:19], v[240:247], v74
  v_mov_b64 v[70:71], s[78:79]
  v_smfmac_f32_16x16x64_bf16 v[28:31], v[4:7], a[0:7], v74
  s_waitcnt lgkmcnt(2)
  v_add_f32 v24, v24, v26
  v_smfmac_f32_16x16x64_bf16 v[28:31], v[8:11], v[36:43], v74
  ds_read_b128 v[36:39], v68
  v_cvt_pk_bf16_f32 v22, v20, v24
  v_smfmac_f32_16x16x64_bf16 v[28:31], v[12:15], a[16:23], v74
  ds_read_b128 v[40:43], v68
  ds_write_b32 v79, v22 offset:0
  s_waitcnt lgkmcnt(3)
  v_add_f32 v25, v25, v27
  v_cvt_pk_bf16_f32 v23, v21, v25
  v_smfmac_f32_16x16x64_bf16 v[32:35], v[8:11], v[60:67], v74
  ds_write_b32 v79, v23 offset:576
  v_cmp_u_f32 vcc, v20, v21
  v_smfmac_f32_16x16x64_bf16 v[32:35], v[16:19], v[248:255], v74
  v_add_f32 v28, v28, v30
  v_smfmac_f32_16x16x64_bf16 v[32:35], v[4:7], a[8:15], v74
  v_add_f32 v29, v29, v31
  v_smfmac_f32_16x16x64_bf16 v[32:35], v[12:15], a[24:31], v74
  s_cbranch_vccnz Cs0_rec
Cs0_recok:
  s_waitcnt lgkmcnt(3)
  v_smfmac_f32_16x16x64_bf16 v[36:39], v[16:19], a[128:135], v74
  s_waitcnt lgkmcnt(0)
  s_barrier
  ds_read_b128 v[60:63], v77
  v_smfmac_f32_16x16x64_bf16 v[40:43], v[16:19], a[136:143], v74
  ds_read_b128 v[64:67], v77 offset:128
  v_add_f32 v32, v32, v34
  v_cvt_pk_bf16_f32 v30, v28, v32
  v_smfmac_f32_16x16x64_bf16 v[36:39], v[0:3], a[96:103], v74
  ds_write_b32 v79, v30 offset:256
  v_add_f32 v33, v33, v35
  v_cvt_pk_bf16_f32 v31, v29, v33
  v_smfmac_f32_16x16x64_bf16 v[40:43], v[0:3], a[104:111], v74
  ds_write_b32 v79, v31 offset:832
  v_xor_b32 v75, 0x8000, v75
  v_smfmac_f32_16x16x64_bf16 v[36:39], v[4:7], a[144:151], v74
  ds_read_b128 v[0:3], v76 offset:4608
  v_mov_b32 v29, 0
  v_smfmac_f32_16x16x64_bf16 v[40:43], v[4:7], a[152:159], v74
  s_waitcnt vmcnt(3) lgkmcnt(3)
  v_mov_b32 v30, 0
  v_mfma_f32_16x16x32_bf16 v[44:47], v[44:47], v[60:63], 0
  ds_read_b128 v[4:7], v76 offset:5632
  s_waitcnt lgkmcnt(2)
  v_mfma_f32_16x16x32_bf16 v[44:47], v[48:51], v[64:67], v[44:47]
  s_barrier
  v_smfmac_f32_16x16x64_bf16 v[36:39], v[8:11], a[112:119], v74
  ds_read_b128 v[20:23], v77 offset:256
  ds_read_b128 v[24:27], v77 offset:384
  v_smfmac_f32_16x16x64_bf16 v[40:43], v[8:11], a[120:127], v74
  ds_read_b128 v[8:11], v76 offset:6656
  v_add_f32_dpp v72, v46, v44 quad_perm:[2,3,0,1] row_mask:0xf bank_mask:0xf
  v_add_f32_dpp v73, v47, v45 quad_perm:[2,3,0,1] row_mask:0xf bank_mask:0xf
  v_smfmac_f32_16x16x64_bf16 v[36:39], v[12:15], a[160:167], v74
  s_waitcnt lgkmcnt(4)
  v_exp_f32_dpp v72, v72 quad_perm:[0,1,0,1] row_mask:0xf bank_mask:0xf
  v_smfmac_f32_16x16x64_bf16 v[40:43], v[12:15], a[168:175], v74
  ds_read_b128 v[12:15], v76 offset:7680
  v_exp_f32_dpp v73, v73 quad_perm:[0,1,0,1] row_mask:0xf bank_mask:0xf
  v_smfmac_f32_16x16x64_bf16 v[36:39], v[0:3], a[32:39], v74
  s_waitcnt lgkmcnt(2)
  v_cvt_pk_bf16_f32 v72, v72, v73
  v_mfma_f32_16x16x32_bf16 v[20:23], v[20:23], v[60:63], 0
  ds_write_b32 v78, v72 offset:512
  v_mov_b64 v[16:17], 0
  v_mfma_f32_16x16x32_bf16 v[20:23], v[24:27], v[64:67], v[20:23]
  ds_read_b128 v[44:47], v75 offset:16384
  v_mov_b64 v[18:19], 0
  v_smfmac_f32_16x16x64_bf16 v[40:43], v[0:3], a[40:47], v74
  ds_read_b128 v[48:51], v75 offset:17408
  v_mov_b64 v[68:69], s[78:79]
  v_smfmac_f32_16x16x64_bf16 v[36:39], v[4:7], a[48:55], v74
  s_waitcnt lgkmcnt(4)
  v_add_f32_dpp v24, v22, v20 quad_perm:[2,3,0,1] row_mask:0xf bank_mask:0xf
  v_add_f32_dpp v25, v23, v21 quad_perm:[2,3,0,1] row_mask:0xf bank_mask:0xf
  v_smfmac_f32_16x16x64_bf16 v[36:39], v[8:11], a[64:71], v74
  s_waitcnt lgkmcnt(2)
  s_barrier
  ds_read_b128 v[32:35], v78 offset:512
  v_smfmac_f32_16x16x64_bf16 v[36:39], v[12:15], a[80:87], v74
  ds_read_b128 v[60:63], v75 offset:18432
  v_mul_f32 v24, s69, v24
  v_smfmac_f32_16x16x64_bf16 v[40:43], v[4:7], a[56:63], v74
  ds_read_b128 v[64:67], v75 offset:19456
  v_mul_f32 v25, s69, v25
  v_smfmac_f32_16x16x64_bf16 v[40:43], v[8:11], a[72:79], v74
  v_exp_f32_dpp v24, v24 quad_perm:[0,1,0,1] row_mask:0xf bank_mask:0xf
  v_smfmac_f32_16x16x64_bf16 v[40:43], v[12:15], a[88:95], v74
  s_waitcnt lgkmcnt(2)
  v_exp_f32_dpp v25, v25 quad_perm:[0,1,0,1] row_mask:0xf bank_mask:0xf
  v_mfma_f32_16x16x32_bf16 v[8:11], v[32:35], v[68:71], 0
  v_add_f32 v36, v36, v38
  v_add_f32 v37, v37, v39
  v_mfma_f32_16x16x32_bf16 v[0:3], v[32:35], v[52:55], 0
  v_add_f32 v40, v40, v42
  v_add_f32 v41, v41, v43
  v_mfma_f32_16x16x32_bf16 v[4:7], v[32:35], v[56:59], 0
  v_cvt_pk_bf16_f32 v28, v24, v25
  v_cvt_pk_bf16_f32 v72, v36, v37
  v_cvt_pk_bf16_f32 v73, v40, v41
  v_mfma_f32_16x16x16_bf16 v[8:11], v[28:29], v[68:69], v[8:11]
  v_cvt_pk_bf16_f32 v31, v24, v25
  v_mov_b64 v[20:21], 0
  v_mfma_f32_16x16x16_bf16 v[0:3], v[28:29], v[72:73], v[0:3]
  ds_read_b128 v[52:55], v75 offset:32768
  v_mov_b64 v[22:23], 0
  v_mfma_f32_16x16x16_bf16 v[4:7], v[30:31], v[72:73], v[4:7]
  v_rcp_f32 v10, v8
  v_rcp_f32 v11, v9
  v_mul_f32 v0, v10, v0
  v_mul_f32 v1, v11, v1
  v_max3_f32 v8, v8, v9, v10
  v_mul_f32 v4, v10, v4
  v_mul_f32 v5, v11, v5
  v_cvt_pk_bf16_f32 v2, v0, v4
  ds_write_b32 v79, v2 offset:8704
  v_cvt_pk_bf16_f32 v3, v1, v5
  ds_write_b32 v79, v3 offset:9280
  ds_read_b128 v[12:15], v78 offset:8704
  v_max_f32 v8, v8, v11
  v_cmp_le_f32 vcc, 1317011456, v8
  v_mov_b64 v[24:25], 0
  v_mov_b64 v[26:27], 0
  ds_read_b128 v[56:59], v75 offset:33792
  s_cbranch_vccnz Cs0_mx
Cs0_mxok:
  s_waitcnt lgkmcnt(2)
  s_barrier
  ds_read_b128 v[0:3], v78 offset:8768
  s_waitcnt lgkmcnt(2)
  v_smfmac_f32_16x16x64_bf16 v[16:19], v[12:15], v[44:51], v74
  ds_read_b128 v[4:7], v78 offset:8832
  v_smfmac_f32_16x16x64_bf16 v[20:23], v[12:15], a[192:199], v74
  ds_read_b128 v[8:11], v78 offset:8896
  v_smfmac_f32_16x16x64_bf16 v[24:27], v[12:15], a[208:215], v74
  ds_read_b128 v[36:39], v75 offset:34816
  s_waitcnt lgkmcnt(3)
  v_smfmac_f32_16x16x64_bf16 v[16:19], v[0:3], v[60:67], v74
  ds_read_b128 v[40:43], v75 offset:35840
  s_waitcnt lgkmcnt(3)
  v_smfmac_f32_16x16x64_bf16 v[16:19], v[4:7], a[176:183], v74
  ds_read_b128 v[68:71], v76 offset:13824
  s_waitcnt lgkmcnt(3)
  v_smfmac_f32_16x16x64_bf16 v[16:19], v[8:11], a[184:191], v74
  ds_read_b128 v[44:47], v75 offset:49152
  v_smfmac_f32_16x16x64_bf16 v[20:23], v[0:3], a[200:207], v74
  ds_read_b128 v[48:51], v75 offset:50176
  v_smfmac_f32_16x16x64_bf16 v[20:23], v[4:7], v[52:59], v74
  ds_read_b128 v[60:63], v75 offset:51200
  s_waitcnt lgkmcnt(4)
  v_cvt_pk_bf16_f32 v16, v16, v17
  v_cvt_pk_bf16_f32 v17, v18, v19
  v_bfi_b32 v16, 1, s72, v16
  v_smfmac_f32_16x16x64_bf16 v[20:23], v[8:11], v[36:43], v74
  s_waitcnt lgkmcnt(3)
  buffer_store_dwordx2 v[16:17], v68, s[8:11], s73 offen sc1
  v_mov_b64 v[32:33], 0
  v_smfmac_f32_16x16x64_bf16 v[24:27], v[0:3], a[216:223], v74
  ds_read_b128 v[64:67], v75 offset:52224
  v_mov_b64 v[34:35], 0
  v_smfmac_f32_16x16x64_bf16 v[24:27], v[4:7], a[224:231], v74
  v_cvt_pk_bf16_f32 v20, v20, v21
  v_cvt_pk_bf16_f32 v21, v22, v23
  v_bfi_b32 v20, 1, s72, v20
  v_smfmac_f32_16x16x64_bf16 v[24:27], v[8:11], a[232:239], v74
  buffer_store_dwordx2 v[20:21], v68, s[8:11], s74 offen sc1
  s_waitcnt lgkmcnt(2)
  v_smfmac_f32_16x16x64_bf16 v[32:35], v[12:15], v[44:51], v74
  s_waitcnt lgkmcnt(0)
  v_smfmac_f32_16x16x64_bf16 v[32:35], v[0:3], v[60:67], v74
  v_cvt_pk_bf16_f32 v24, v24, v25
  v_cvt_pk_bf16_f32 v25, v26, v27
  v_bfi_b32 v24, 1, s72, v24
  v_smfmac_f32_16x16x64_bf16 v[32:35], v[4:7], a[240:247], v74
  buffer_store_dwordx2 v[24:25], v68, s[8:11], s75 offen sc1
  v_smfmac_f32_16x16x64_bf16 v[32:35], v[8:11], a[248:255], v74
  v_mov_b64 v[18:19], v[72:73]
  s_nop 4
  v_cvt_pk_bf16_f32 v32, v32, v33
  v_cvt_pk_bf16_f32 v33, v34, v35
  v_bfi_b32 v32, 1, s72, v32
  buffer_store_dwordx2 v[32:33], v68, s[8:11], s76 offen sc1
  ds_read_b128 v[0:3], v76 offset:14848
  s_waitcnt lgkmcnt(0)
  ds_read_b64 v[16:17], v77 offset:256
  s_waitcnt lgkmcnt(0)
  ds_read_b128 v[64:67], v76 offset:19456
  s_waitcnt lgkmcnt(0)
  v_xor_b32 v75, 0x8000, v75
  v_mov_b64 v[28:29], 0
  v_mov_b64 v[30:31], 0
  v_mov_b64 v[32:33], 0
  v_mov_b64 v[34:35], 0
  s_waitcnt vmcnt(0)
  buffer_load_dwordx4 v[52:55], v76, s[8:11], s60 offen offset:0 sc1
  buffer_load_dwordx4 v[56:59], v76, s[8:11], s60 offen offset:1024 sc1
  s_add_u32 s66, s66, 1
  s_xor_b32 s64, s64, 16384
  s_xor_b32 s65, s65, 16384
  s_add_u32 s58, s58, 655360
  s_add_u32 s59, s59, 655360
  s_add_u32 s70, s70, 655360
  s_add_u32 s68, s68, 655360
  s_mov_b32 m0, 10752
  s_add_u32 s85, s65, 6144
  s_waitcnt lgkmcnt(0)
  s_waitcnt vmcnt(1)
  v_mfma_f32_16x16x32_bf16 v[4:7], v[0:3], v[52:55], 0
  v_bitop3_b32 v72, v52, v54, s72 bitop3:0x7e
  s_waitcnt vmcnt(0)
  v_mfma_f32_16x16x32_bf16 v[4:7], v[0:3], v[56:59], v[4:7]
  v_bitop3_b32 v73, v56, v58, s72 bitop3:0x7e
  v_bitop3_b32 v72, v72, v73, 1 bitop3:0xa8
  v_cmp_ne_u32 vcc, 0, v72
  s_cbranch_vccnz Cs0_h1r
  s_nop 2
  v_add_f32_dpp v4, v4, v4 row_ror:4 row_mask:0xf bank_mask:0xf
  v_add_f32_dpp v5, v5, v5 row_ror:4 row_mask:0xf bank_mask:0xf
  s_nop 0
  v_add_f32_dpp v4, v4, v4 row_ror:8 row_mask:0xf bank_mask:0xf
  v_add_f32_dpp v5, v5, v5 row_ror:8 row_mask:0xf bank_mask:0xf
  v_cvt_pk_bf16_f32 v4, v4, v5
  buffer_store_dword v4, v69, s[8:11], s62 offen sc1
  s_xor_b32 s62, s62, 16384
  buffer_store_dword v71, v69, s[8:11], s62 offen sc1
  s_xor_b32 s72, s72, 1
  s_branch Cs0_h2
Cs0_h1r:
  s_mov_b64 exec, vcc
  buffer_load_dwordx4 v[52:55], v76, s[8:11], s60 offen offset:0 sc1
  buffer_load_dwordx4 v[56:59], v76, s[8:11], s60 offen offset:1024 sc1
  s_mov_b64 exec, -1
  s_add_u32 s67, s67, 1
  s_waitcnt vmcnt(1)
  v_mfma_f32_16x16x32_bf16 v[4:7], v[0:3], v[52:55], 0
  v_bitop3_b32 v72, v52, v54, s72 bitop3:0x7e
  s_waitcnt vmcnt(0)
  v_mfma_f32_16x16x32_bf16 v[4:7], v[0:3], v[56:59], v[4:7]
  v_bitop3_b32 v73, v56, v58, s72 bitop3:0x7e
  v_bitop3_b32 v72, v72, v73, 1 bitop3:0xa8
  v_cmp_ne_u32 vcc, 0, v72
  s_cbranch_vccz Cs0_h1p
Cs0_h1s:
  s_mov_b64 exec, vcc
  buffer_load_dwordx4 v[52:55], v76, s[8:11], s60 offen offset:0 sc1
  buffer_load_dwordx4 v[56:59], v76, s[8:11], s60 offen offset:1024 sc1
  s_mov_b64 exec, -1
  s_add_u32 s67, s67, 1
  s_waitcnt vmcnt(1)
  v_mfma_f32_16x16x32_bf16 v[4:7], v[0:3], v[52:55], 0
  v_bitop3_b32 v72, v52, v54, s72 bitop3:0x7e
  s_waitcnt vmcnt(0)
  v_mfma_f32_16x16x32_bf16 v[4:7], v[0:3], v[56:59], v[4:7]
  v_bitop3_b32 v73, v56, v58, s72 bitop3:0x7e
  v_bitop3_b32 v72, v72, v73, 1 bitop3:0xa8
  v_cmp_ne_u32 vcc, 0, v72
  s_cbranch_vccz Cs0_h1p
  s_cmp_lt_u32 s67, 131072
  s_cbranch_scc1 Cs0_h1s
Cs0_h1p:
  s_nop 2
  v_add_f32_dpp v4, v4, v4 row_ror:4 row_mask:0xf bank_mask:0xf
  v_add_f32_dpp v5, v5, v5 row_ror:4 row_mask:0xf bank_mask:0xf
  s_nop 0
  v_add_f32_dpp v4, v4, v4 row_ror:8 row_mask:0xf bank_mask:0xf
  v_add_f32_dpp v5, v5, v5 row_ror:8 row_mask:0xf bank_mask:0xf
  v_cvt_pk_bf16_f32 v4, v4, v5
  buffer_store_dword v4, v69, s[8:11], s62 offen sc1
  s_xor_b32 s62, s62, 16384
  buffer_store_dword v71, v69, s[8:11], s62 offen sc1
  s_xor_b32 s72, s72, 1
  s_branch Cs0_h2
Cs0_rec:
  s_nop 7
  s_waitcnt vmcnt(0) lgkmcnt(0)
  v_max3_u32 v72, v0, v1, v2
  v_max3_u32 v72, v72, v3, v4
  v_max3_u32 v72, v72, v5, v6
  v_max3_u32 v72, v72, v7, v8
  v_max3_u32 v72, v72, v9, v10
  v_max3_u32 v72, v72, v11, v12
  v_max3_u32 v72, v72, v13, v14
  v_max3_u32 v72, v72, v15, v16
  v_max3_u32 v72, v72, v17, v18
  v_max_u32 v72, v72, v19
  v_cmp_eq_u32 vcc, -1, v72
  s_cbranch_vccz Cs0_recok
  s_barrier
  v_mov_b64 v[20:21], 0
  v_mov_b64 v[22:23], 0
  v_mov_b64 v[24:25], 0
  v_mov_b64 v[26:27], 0
  v_mov_b64 v[28:29], 0
  v_mov_b64 v[30:31], 0
  v_mov_b64 v[32:33], 0
  v_mov_b64 v[34:35], 0
  s_waitcnt lgkmcnt(0)
  s_barrier
  ds_read_b128 v[0:3], v76 offset:4608
  s_waitcnt lgkmcnt(0)
  v_smfmac_f32_16x16x64_bf16 v[20:23], v[0:3], v[80:87], v74
  v_smfmac_f32_16x16x64_bf16 v[24:27], v[0:3], v[88:95], v74
  ds_read_b128 v[60:63], v76 offset:16384
  ds_read_b128 v[64:67], v76 offset:17408
  s_waitcnt lgkmcnt(0)
  v_smfmac_f32_16x16x64_bf16 v[28:31], v[0:3], v[60:67], v74
  ds_read_b128 v[60:63], v76 offset:18432
  ds_read_b128 v[64:67], v76 offset:19456
  s_waitcnt lgkmcnt(0)
  v_smfmac_f32_16x16x64_bf16 v[32:35], v[0:3], v[60:67], v74
  ds_read_b128 v[4:7], v76 offset:5632
  s_waitcnt lgkmcnt(0)
  v_smfmac_f32_16x16x64_bf16 v[20:23], v[4:7], v[96:103], v74
  v_smfmac_f32_16x16x64_bf16 v[24:27], v[4:7], v[104:111], v74
  ds_read_b128 v[60:63], v76 offset:32768
  ds_read_b128 v[64:67], v76 offset:33792
  s_waitcnt lgkmcnt(0)
  v_smfmac_f32_16x16x64_bf16 v[28:31], v[4:7], v[60:67], v74
  ds_read_b128 v[60:63], v76 offset:34816
  ds_read_b128 v[64:67], v76 offset:35840
  s_waitcnt lgkmcnt(0)
  v_smfmac_f32_16x16x64_bf16 v[32:35], v[4:7], v[60:67], v74
  ds_read_b128 v[8:11], v76 offset:6656
  s_waitcnt lgkmcnt(0)
  v_smfmac_f32_16x16x64_bf16 v[20:23], v[8:11], v[112:119], v74
  v_smfmac_f32_16x16x64_bf16 v[24:27], v[8:11], v[120:127], v74
  v_smfmac_f32_16x16x64_bf16 v[28:31], v[8:11], v[208:215], v74
  v_smfmac_f32_16x16x64_bf16 v[32:35], v[8:11], v[216:223], v74
  ds_read_b128 v[12:15], v76 offset:7680
  s_waitcnt lgkmcnt(0)
  v_smfmac_f32_16x16x64_bf16 v[20:23], v[12:15], v[128:135], v74
  v_smfmac_f32_16x16x64_bf16 v[24:27], v[12:15], v[136:143], v74
  v_smfmac_f32_16x16x64_bf16 v[28:31], v[12:15], v[224:231], v74
  v_smfmac_f32_16x16x64_bf16 v[32:35], v[12:15], v[232:239], v74
  ds_read_b128 v[0:3], v76 offset:8704
  s_waitcnt lgkmcnt(0)
  v_smfmac_f32_16x16x64_bf16 v[20:23], v[0:3], v[144:151], v74
  v_smfmac_f32_16x16x64_bf16 v[24:27], v[0:3], v[152:159], v74
  ds_read_b128 v[60:63], v76 offset:49152
  ds_read_b128 v[64:67], v76 offset:50176
  s_waitcnt lgkmcnt(0)
  v_smfmac_f32_16x16x64_bf16 v[28:31], v[0:3], v[60:67], v74
  ds_read_b128 v[60:63], v76 offset:51200
  ds_read_b128 v[64:67], v76 offset:52224
  s_waitcnt lgkmcnt(0)
  v_smfmac_f32_16x16x64_bf16 v[32:35], v[0:3], v[60:67], v74
  ds_read_b128 v[8:11], v76 offset:9728
  s_waitcnt lgkmcnt(0)
  v_smfmac_f32_16x16x64_bf16 v[20:23], v[8:11], v[160:167], v74
  v_smfmac_f32_16x16x64_bf16 v[24:27], v[8:11], v[168:175], v74
  ds_read_b128 v[60:63], v75 offset:16384
  ds_read_b128 v[64:67], v75 offset:17408
  s_waitcnt lgkmcnt(0)
  v_smfmac_f32_16x16x64_bf16 v[28:31], v[8:11], v[60:67], v74
  ds_read_b128 v[60:63], v75 offset:18432
  ds_read_b128 v[64:67], v75 offset:19456
  s_waitcnt lgkmcnt(0)
  v_smfmac_f32_16x16x64_bf16 v[32:35], v[8:11], v[60:67], v74
  ds_read_b128 v[16:19], v76 offset:10752
  ds_read_b128 v[60:63], v75 offset:0
  ds_read_b128 v[64:67], v75 offset:1024
  s_waitcnt lgkmcnt(0)
  v_smfmac_f32_16x16x64_bf16 v[20:23], v[16:19], v[60:67], v74
  ds_read_b128 v[60:63], v75 offset:2048
  ds_read_b128 v[64:67], v75 offset:3072
  s_waitcnt lgkmcnt(0)
  v_smfmac_f32_16x16x64_bf16 v[24:27], v[16:19], v[60:67], v74
  v_smfmac_f32_16x16x64_bf16 v[28:31], v[16:19], v[240:247], v74
  v_smfmac_f32_16x16x64_bf16 v[32:35], v[16:19], v[248:255], v74
  ds_read_b128 v[4:7], v76 offset:11776
  s_waitcnt lgkmcnt(0)
  v_smfmac_f32_16x16x64_bf16 v[20:23], v[4:7], v[176:183], v74
  v_smfmac_f32_16x16x64_bf16 v[24:27], v[4:7], v[184:191], v74
  v_smfmac_f32_16x16x64_bf16 v[28:31], v[4:7], a[0:7], v74
  v_smfmac_f32_16x16x64_bf16 v[32:35], v[4:7], a[8:15], v74
  ds_read_b128 v[12:15], v76 offset:12800
  s_waitcnt lgkmcnt(0)
  v_smfmac_f32_16x16x64_bf16 v[20:23], v[12:15], v[192:199], v74
  v_smfmac_f32_16x16x64_bf16 v[24:27], v[12:15], v[200:207], v74
  v_smfmac_f32_16x16x64_bf16 v[28:31], v[12:15], a[16:23], v74
  v_smfmac_f32_16x16x64_bf16 v[32:35], v[12:15], a[24:31], v74
  v_add_f32 v20, v20, v22
  v_add_f32 v21, v21, v23
  v_add_f32 v24, v24, v26
  v_cvt_pk_bf16_f32 v22, v20, v24
  ds_write_b32 v79, v22 offset:0
  v_add_f32 v25, v25, v27
  v_cvt_pk_bf16_f32 v23, v21, v25
  ds_write_b32 v79, v23 offset:576
  v_add_f32 v28, v28, v30
  v_add_f32 v29, v29, v31
  s_waitcnt lgkmcnt(0)
  s_nop 1
  s_branch Cs0_recok
Cs0_mx:
  s_waitcnt lgkmcnt(0)
  s_barrier
  buffer_load_dwordx4 v[52:55], v76, s[8:11], s59 offen offset:0 sc1
  buffer_load_dwordx4 v[0:3], v76, s[8:11], s58 offen offset:0 sc1
  ds_read_b128 v[20:23], v77 offset:0
  ds_read_b128 v[28:31], v77 offset:256
  buffer_load_dwordx4 v[56:59], v76, s[8:11], s59 offen offset:1024 sc1
  buffer_load_dwordx4 v[4:7], v76, s[8:11], s58 offen offset:1024 sc1
  ds_read_b128 v[24:27], v77 offset:128
  ds_read_b128 v[32:35], v77 offset:384
  s_waitcnt vmcnt(2) lgkmcnt(3)
  v_mfma_f32_16x16x32_bf16 v[8:11], v[0:3], v[20:23], 0
  s_waitcnt vmcnt(0) lgkmcnt(1)
  v_mfma_f32_16x16x32_bf16 v[8:11], v[4:7], v[24:27], v[8:11]
  v_mfma_f32_16x16x32_bf16 v[12:15], v[28:31], v[20:23], 0
  s_waitcnt lgkmcnt(0)
  v_mfma_f32_16x16x32_bf16 v[12:15], v[32:35], v[24:27], v[12:15]
  v_add_f32_dpp v8, v10, v8 quad_perm:[2,3,0,1] row_mask:0xf bank_mask:0xf
  v_add_f32_dpp v9, v11, v9 quad_perm:[2,3,0,1] row_mask:0xf bank_mask:0xf
  s_nop 0
  v_mov_b32_dpp v8, v8 quad_perm:[0,1,0,1] row_mask:0xf bank_mask:0xf
  v_mov_b32_dpp v9, v9 quad_perm:[0,1,0,1] row_mask:0xf bank_mask:0xf
  s_nop 1
  v_add_f32_dpp v12, v14, v12 quad_perm:[2,3,0,1] row_mask:0xf bank_mask:0xf
  v_add_f32_dpp v13, v15, v13 quad_perm:[2,3,0,1] row_mask:0xf bank_mask:0xf
  s_nop 0
  v_mov_b32_dpp v12, v12 quad_perm:[0,1,0,1] row_mask:0xf bank_mask:0xf
  v_mov_b32_dpp v13, v13 quad_perm:[0,1,0,1] row_mask:0xf bank_mask:0xf
  v_mul_f32 v12, s69, v12
  ds_write_b32 v78, v8 offset:8704
  v_mul_f32 v13, s69, v13
  ds_write_b32 v78, v9 offset:8768
  s_waitcnt lgkmcnt(0)
  s_barrier
  ds_read_b128 v[36:39], v78 offset:8704
  ds_read_b128 v[40:43], v78 offset:8768
  s_waitcnt lgkmcnt(0)
  s_barrier
  v_max_f32 v16, v36, v37
  v_max3_f32 v16, v16, v38, v39
  v_max3_f32 v16, v16, v40, v41
  v_max3_f32 v16, v16, v42, v43
  v_max3_f32 v16, v16, v12, v13
  v_mov_b32 v17, v16
  s_nop 1
  v_permlane16_swap_b32 v16, v17
  v_max_f32 v16, v16, v17
  v_mov_b32 v17, v16
  s_nop 1
  v_permlane32_swap_b32 v16, v17
  v_max_f32 v16, v16, v17
  v_sub_f32 v36, v36, v16
  v_sub_f32 v37, v37, v16
  v_sub_f32 v38, v38, v16
  v_sub_f32 v39, v39, v16
  v_sub_f32 v40, v40, v16
  v_sub_f32 v41, v41, v16
  v_sub_f32 v42, v42, v16
  v_sub_f32 v43, v43, v16
  v_sub_f32 v12, v12, v16
  v_sub_f32 v13, v13, v16
  v_exp_f32 v36, v36
  v_exp_f32 v37, v37
  v_exp_f32 v38, v38
  v_exp_f32 v39, v39
  v_exp_f32 v40, v40
  v_exp_f32 v41, v41
  v_exp_f32 v42, v42
  v_exp_f32 v43, v43
  v_exp_f32 v12, v12
  v_exp_f32 v13, v13
  v_cvt_pk_bf16_f32 v32, v36, v40
  v_cvt_pk_bf16_f32 v33, v37, v41
  v_cvt_pk_bf16_f32 v34, v38, v42
  v_cvt_pk_bf16_f32 v35, v39, v43
  v_cvt_pk_bf16_f32 v28, v12, v13
  v_cvt_pk_bf16_f32 v31, v12, v13
  v_mov_b32 v29, 0
  v_mov_b32 v30, 0
  v_mfma_f32_16x16x32_bf16 v[8:11], v[32:35], v[68:71], 0
  v_mfma_f32_16x16x32_bf16 v[0:3], v[32:35], v[52:55], 0
  v_mfma_f32_16x16x32_bf16 v[4:7], v[32:35], v[56:59], 0
  v_mfma_f32_16x16x16_bf16 v[8:11], v[28:29], v[68:69], v[8:11]
  v_mfma_f32_16x16x16_bf16 v[0:3], v[28:29], v[72:73], v[0:3]
  v_mfma_f32_16x16x16_bf16 v[4:7], v[30:31], v[72:73], v[4:7]
  ds_read_b128 v[52:55], v75 offset:32768
  v_rcp_f32 v10, v8
  v_rcp_f32 v11, v9
  v_mul_f32 v0, v10, v0
  v_mul_f32 v1, v11, v1
  v_max3_f32 v8, v8, v9, v10
  v_mul_f32 v4, v10, v4
  v_mul_f32 v5, v11, v5
  v_cvt_pk_bf16_f32 v2, v0, v4
  ds_write_b32 v79, v2 offset:8704
  v_cvt_pk_bf16_f32 v3, v1, v5
  ds_write_b32 v79, v3 offset:9280
  ds_read_b128 v[12:15], v78 offset:8704
  ds_read_b128 v[56:59], v75 offset:33792
  v_mov_b64 v[16:17], 0
  v_mov_b64 v[18:19], 0
  v_mov_b64 v[20:21], 0
  v_mov_b64 v[22:23], 0
  v_mov_b64 v[24:25], 0
  v_mov_b64 v[26:27], 0
  s_branch Cs0_mxok
Cs0_kv3:
  s_waitcnt lgkmcnt(0)
  s_cmp_ge_u32 s57, 0x700
  s_cbranch_scc1 Cs0_kvb
  s_load_dword s57, s[12:13], s71 glc
  s_add_u32 s67, s67, 1
  s_cmp_lt_u32 s67, 131072
  s_cbranch_scc1 Cs0_kv3
  s_waitcnt lgkmcnt(0)
  s_branch Cs0_kvb
Cs0_last:
  ds_read_b128 v[4:7], v76 offset:5632
  ds_read_b128 v[12:15], v76 offset:7680
  ds_read_b128 v[44:47], v76 offset:32768
  ds_read_b128 v[48:51], v76 offset:33792
  s_nop 5
  v_mov_b64 v[20:21], 0
  v_mov_b64 v[22:23], 0
  v_mov_b64 v[24:25], 0
  v_mov_b64 v[26:27], 0
  v_smfmac_f32_16x16x64_bf16 v[28:31], v[0:3], v[36:43], v74
  ds_read_b128 v[36:39], v76 offset:34816
  ds_read_b128 v[40:43], v76 offset:35840
  v_smfmac_f32_16x16x64_bf16 v[32:35], v[0:3], v[60:67], v74
  s_waitcnt lgkmcnt(5)
  v_smfmac_f32_16x16x64_bf16 v[20:23], v[0:3], a[32:39], v74
  ds_read_b128 v[60:63], v76 offset:49152
  ds_read_b128 v[64:67], v76 offset:50176
  v_smfmac_f32_16x16x64_bf16 v[24:27], v[0:3], a[40:47], v74
  s_waitcnt lgkmcnt(4)
  v_smfmac_f32_16x16x64_bf16 v[20:23], v[4:7], a[48:55], v74
  buffer_store_dwordx4 v[16:19], v76, s[8:11], s68 offen sc1
  v_smfmac_f32_16x16x64_bf16 v[24:27], v[4:7], a[56:63], v74
  v_smfmac_f32_16x16x64_bf16 v[28:31], v[4:7], v[44:51], v74
  s_waitcnt lgkmcnt(2)
  v_smfmac_f32_16x16x64_bf16 v[20:23], v[8:11], a[64:71], v74
  ds_read_b128 v[44:47], v76 offset:51200
  ds_read_b128 v[48:51], v76 offset:52224
  v_smfmac_f32_16x16x64_bf16 v[24:27], v[8:11], a[72:79], v74
  v_smfmac_f32_16x16x64_bf16 v[32:35], v[4:7], v[36:43], v74
  v_smfmac_f32_16x16x64_bf16 v[28:31], v[8:11], v[208:215], v74
  ds_read_b128 v[36:39], v75 offset:16384
  ds_read_b128 v[40:43], v75 offset:17408
  v_smfmac_f32_16x16x64_bf16 v[32:35], v[8:11], v[216:223], v74
  v_smfmac_f32_16x16x64_bf16 v[20:23], v[12:15], a[80:87], v74
  v_smfmac_f32_16x16x64_bf16 v[24:27], v[12:15], a[88:95], v74
  v_smfmac_f32_16x16x64_bf16 v[28:31], v[12:15], v[224:231], v74
  v_smfmac_f32_16x16x64_bf16 v[32:35], v[12:15], v[232:239], v74
  s_waitcnt vmcnt(1)
  s_barrier
Cs0_lastr:
  ds_read_b128 v[0:3], v76 offset:8704
  ds_read_b128 v[8:11], v76 offset:9728
  ds_read_b128 v[16:19], v76 offset:10752
  ds_read_b128 v[4:7], v76 offset:11776
  ds_read_b128 v[12:15], v76 offset:12800
  s_waitcnt lgkmcnt(4)
  v_max3_u32 v72, v0, v1, v2
  s_waitcnt lgkmcnt(1)
  v_max3_u32 v72, v72, v3, v4
  v_max3_u32 v72, v72, v5, v6
  v_max3_u32 v72, v72, v7, v8
  v_max3_u32 v72, v72, v9, v10
  s_waitcnt lgkmcnt(0)
  v_max3_u32 v72, v72, v11, v12
  v_max3_u32 v72, v72, v13, v14
  v_max3_u32 v72, v72, v15, v16
  v_max3_u32 v72, v72, v17, v18
  v_max_u32 v72, v72, v19
  v_cmp_eq_u32 vcc, -1, v72
  s_cbranch_vccnz Cs0_lastp
Cs0_lastg:
  v_smfmac_f32_16x16x64_bf16 v[28:31], v[0:3], v[60:67], v74
  ds_read_b128 v[60:63], v75 offset:18432
  ds_read_b128 v[64:67], v75 offset:19456
  v_smfmac_f32_16x16x64_bf16 v[32:35], v[0:3], v[44:51], v74
  v_smfmac_f32_16x16x64_bf16 v[28:31], v[8:11], v[36:43], v74
  v_smfmac_f32_16x16x64_bf16 v[28:31], v[16:19], v[240:247], v74
  v_smfmac_f32_16x16x64_bf16 v[28:31], v[4:7], a[0:7], v74
  v_smfmac_f32_16x16x64_bf16 v[28:31], v[12:15], a[16:23], v74
  v_smfmac_f32_16x16x64_bf16 v[32:35], v[16:19], v[248:255], v74
  v_smfmac_f32_16x16x64_bf16 v[32:35], v[4:7], a[8:15], v74
  s_waitcnt lgkmcnt(0)
  v_smfmac_f32_16x16x64_bf16 v[32:35], v[12:15], a[24:31], v74
  v_smfmac_f32_16x16x64_bf16 v[32:35], v[8:11], v[60:67], v74
  v_smfmac_f32_16x16x64_bf16 v[20:23], v[0:3], a[96:103], v74
  v_smfmac_f32_16x16x64_bf16 v[20:23], v[8:11], a[112:119], v74
  v_add_f32 v28, v28, v30
  v_add_f32 v32, v32, v34
  v_cvt_pk_bf16_f32 v30, v28, v32
  v_smfmac_f32_16x16x64_bf16 v[20:23], v[16:19], a[128:135], v74
  ds_write_b32 v79, v30 offset:256
  v_add_f32 v29, v29, v31
  v_add_f32 v33, v33, v35
  v_cvt_pk_bf16_f32 v31, v29, v33
  v_smfmac_f32_16x16x64_bf16 v[20:23], v[4:7], a[144:151], v74
  ds_write_b32 v79, v31 offset:832
  v_smfmac_f32_16x16x64_bf16 v[20:23], v[12:15], a[160:167], v74
  v_smfmac_f32_16x16x64_bf16 v[24:27], v[0:3], a[104:111], v74
  v_smfmac_f32_16x16x64_bf16 v[24:27], v[8:11], a[120:127], v74
  v_smfmac_f32_16x16x64_bf16 v[24:27], v[16:19], a[136:143], v74
  s_waitcnt lgkmcnt(0)
  s_barrier
  ds_read_b64 v[52:53], v77 offset:256
  v_add_f32 v20, v20, v22
  v_smfmac_f32_16x16x64_bf16 v[24:27], v[4:7], a[152:159], v74
  v_add_f32 v21, v21, v23
  v_smfmac_f32_16x16x64_bf16 v[24:27], v[12:15], a[168:175], v74
  v_cvt_pk_bf16_f32 v54, v20, v21
  s_add_u32 s68, s68, 655360
  s_nop 3
  v_add_f32 v24, v24, v26
  v_add_f32 v25, v25, v27
  v_cvt_pk_bf16_f32 v55, v24, v25
  s_waitcnt lgkmcnt(0)
  buffer_store_dwordx4 v[52:55], v76, s[8:11], s68 offen sc1
  s_branch Cs0_done
Cs0_lastp:
  s_add_u32 s72, s72, 2
  s_cmp_ge_u32 s72, 131072
  s_cbranch_scc1 Cs0_lastg
  s_barrier
  buffer_load_dwordx4 v76, s[8:11], s85 offen offset:0 sc1 lds
  s_waitcnt vmcnt(0)
  s_barrier
  s_branch Cs0_lastr
Cs0_done:
  s_branch L_cexit
L_w5:
  v_mov_b64 v[20:21], 0
  v_mov_b64 v[22:23], 0
  v_mov_b64 v[24:25], 0
  v_mov_b64 v[26:27], 0
  v_mov_b64 v[28:29], 0
  v_mov_b64 v[30:31], 0
  v_mov_b64 v[32:33], 0
  v_mov_b64 v[34:35], 0
  s_mov_b32 s78, 0x3f803f80
  s_mov_b32 s79, s78
  s_mov_b32 s65, 360448
  s_mov_b32 m0, 15872
  s_lshl_b32 s71, s53, 2
  s_add_u32 s71, s71, 128
  s_movk_i32 s56, 0x1000
  v_lshlrev_b32 v73, 2, v76
  v_mov_b32 v72, 0
  s_mov_b64 s[16:17], s[8:9]
  s_mov_b32 s18, 268435456
  s_mov_b32 s19, 0x20000
  s_getpc_b64 s[20:21]
Cs1_pc:
  s_add_u32 s20, s20, (Cs1_last - Cs1_pc)
  s_addc_u32 s21, s21, 0
  v_mov_b32 v68, 14880
  buffer_load_dwordx4 v[52:55], v76, s[8:11], s59 offen offset:0 sc1
  buffer_load_dwordx4 v[56:59], v76, s[8:11], s59 offen offset:1024 sc1
  ds_read_b128 v[36:39], v76 offset:20480
  ds_read_b128 v[40:43], v76 offset:21504
  ds_read_b128 v[60:63], v76 offset:22528
  ds_read_b128 v[64:67], v76 offset:23552
  ds_read_b128 v[0:3], v76 offset:4608
  ds_read_b128 v[4:7], v76 offset:5632
  ds_read_b128 v[8:11], v76 offset:6656
  ds_read_b128 v[12:15], v76 offset:7680
  s_waitcnt lgkmcnt(0)
  s_cmp_eq_u32 s66, 1
  s_branch Cs1_top2
.p2align 6
Cs1_h2:
  ds_read_b128 v[36:39], v76 offset:20480
  v_lshlrev_b32 v73, 2, v76
  ds_read_b128 v[40:43], v76 offset:21504
  v_mov_b64 v[20:21], 0
  v_mov_b64 v[22:23], 0
  v_mov_b64 v[24:25], 0
  v_mov_b64 v[26:27], 0
  v_mov_b32 v68, 14880
  ds_read_b128 v[60:63], v76 offset:22528
  s_cmp_eq_u32 s66, 62
  s_cselect_b64 s[16:17], s[20:21], s[16:17]
  s_cselect_b32 s18, (Cs1_done - Cs1_last), s18
  s_cselect_b32 s70, 0, s70
  s_cmp_eq_u32 s66, 63
  s_cselect_b32 s59, 268435456, s59
  s_cselect_b32 s58, 268435456, s58
  buffer_load_dwordx4 v[52:55], v76, s[8:11], s59 offen offset:0 sc1
  buffer_load_dwordx4 v[56:59], v76, s[8:11], s59 offen offset:1024 sc1
  s_waitcnt vmcnt(0)
  s_mov_b64 vcc, -1
Cs1_h2r:
  s_mov_b64 exec, vcc
  buffer_load_dwordx4 v[8:11], v76, s[8:11], s65 offen offset:2048 sc1
  buffer_load_dwordx4 v[0:3], v76, s[8:11], s85 offen offset:0 sc1
  s_mov_b64 exec, -1
  s_add_u32 s67, s67, 1
  s_cmp_lt_u32 s67, 131072
  s_cselect_b32 s54, -2, -1
  s_waitcnt vmcnt(1)
  v_max3_u32 v72, v8, v9, v10
  s_waitcnt vmcnt(0)
  v_max3_u32 v72, v72, v11, v0
  v_max3_u32 v72, v72, v1, v2
  v_max_u32 v72, v72, v3
  v_cmp_lt_u32 vcc, s54, v72
  s_cbranch_vccnz Cs1_h2r
  ds_write_b128 v76, v[8:11] offset:6656
  ds_write_b128 v76, v[0:3] offset:11776
Cs1_h2w:
  s_cmp_eq_u32 s66, 63
  s_waitcnt lgkmcnt(0)
  s_barrier
  ds_read_b128 v[0:3], v76 offset:4608
Cs1_top2:
  v_smfmac_f32_16x16x64_bf16 v[20:23], v[8:11], v[112:119], v74
  s_cbranch_scc1 Cs1_last
  v_smfmac_f32_16x16x64_bf16 v[24:27], v[8:11], v[120:127], v74
  buffer_load_dwordx4 v[44:47], v76, s[8:11], s58 offen offset:0 sc1
  s_mov_b32 m0, 15872
  v_smfmac_f32_16x16x64_bf16 v[28:31], v[8:11], v[208:215], v74
  buffer_load_dwordx4 v[48:51], v76, s[8:11], s58 offen offset:1024 sc1
  v_smfmac_f32_16x16x64_bf16 v[32:35], v[8:11], v[216:223], v74
  ds_read_b128 v[4:7], v76 offset:5632
  s_waitcnt lgkmcnt(1)
  v_smfmac_f32_16x16x64_bf16 v[20:23], v[0:3], v[80:87], v74
  ds_read_b128 v[12:15], v76 offset:7680
  v_smfmac_f32_16x16x64_bf16 v[28:31], v[0:3], v[36:43], v74
  ds_read_b128 v[36:39], v76 offset:36864
  v_smfmac_f32_16x16x64_bf16 v[24:27], v[0:3], v[88:95], v74
  buffer_store_dwordx4 v[16:19], v76, s[8:11], s68 offen sc1
  ds_read_b128 v[40:43], v76 offset:37888
  v_smfmac_f32_16x16x64_bf16 v[32:35], v[0:3], v[60:67], v74
  buffer_load_dword v73, s[16:19], s70 offen lds
  ds_read_b128 v[60:63], v76 offset:38912
  s_waitcnt lgkmcnt(4)
  v_smfmac_f32_16x16x64_bf16 v[20:23], v[4:7], v[96:103], v74
  ds_read_b128 v[64:67], v76 offset:39936
  v_smfmac_f32_16x16x64_bf16 v[24:27], v[4:7], v[104:111], v74
  s_waitcnt vmcnt(4)
  s_waitcnt lgkmcnt(4)
  v_smfmac_f32_16x16x64_bf16 v[20:23], v[12:15], v[128:135], v74
  s_barrier
  ds_read_b128 v[8:11], v76 offset:8704
  s_waitcnt lgkmcnt(3)
  v_smfmac_f32_16x16x64_bf16 v[28:31], v[4:7], v[36:43], v74
  ds_read_b128 v[36:39], v76 offset:53248
  v_smfmac_f32_16x16x64_bf16 v[24:27], v[12:15], v[136:143], v74
  ds_read_b128 v[40:43], v76 offset:54272
  s_waitcnt lgkmcnt(3)
  v_smfmac_f32_16x16x64_bf16 v[32:35], v[4:7], v[60:67], v74
  ds_read_b128 v[0:3], v76 offset:9728
  v_smfmac_f32_16x16x64_bf16 v[28:31], v[12:15], v[224:231], v74
  ds_read_b128 v[60:63], v76 offset:55296
  v_smfmac_f32_16x16x64_bf16 v[32:35], v[12:15], v[232:239], v74
  ds_read_b128 v[64:67], v76 offset:56320
  s_waitcnt lgkmcnt(5)
  v_smfmac_f32_16x16x64_bf16 v[20:23], v[8:11], v[144:151], v74
  s_barrier
  ds_read_b128 v[4:7], v76 offset:11776
  s_waitcnt lgkmcnt(4)
  v_smfmac_f32_16x16x64_bf16 v[28:31], v[8:11], v[36:43], v74
  ds_read_b128 v[12:15], v76 offset:12800
  ds_read_b128 v[36:39], v75 offset:4096
  v_smfmac_f32_16x16x64_bf16 v[24:27], v[8:11], v[152:159], v74
  ds_read_b128 v[16:19], v76 offset:10752
  s_waitcnt lgkmcnt(6)
  v_smfmac_f32_16x16x64_bf16 v[20:23], v[0:3], v[160:167], v74
  ds_read_b128 v[40:43], v75 offset:5120
  s_waitcnt lgkmcnt(5)
  v_smfmac_f32_16x16x64_bf16 v[32:35], v[8:11], v[60:67], v74
  ds_read_b128 v[60:63], v75 offset:6144
  v_smfmac_f32_16x16x64_bf16 v[24:27], v[0:3], v[168:175], v74
  ds_read_b128 v[64:67], v75 offset:7168
  s_waitcnt lgkmcnt(6)
  v_smfmac_f32_16x16x64_bf16 v[20:23], v[4:7], v[176:183], v74
  s_waitcnt lgkmcnt(5)
  v_smfmac_f32_16x16x64_bf16 v[20:23], v[12:15], v[192:199], v74
  s_waitcnt lgkmcnt(2)
  v_smfmac_f32_16x16x64_bf16 v[20:23], v[16:19], v[36:43], v74
  ds_read_b128 v[36:39], v75 offset:20480
  v_smfmac_f32_16x16x64_bf16 v[24:27], v[4:7], v[184:191], v74
  ds_read_b128 v[40:43], v75 offset:21504
  s_waitcnt lgkmcnt(2)
  v_smfmac_f32_16x16x64_bf16 v[24:27], v[16:19], v[60:67], v74
  ds_read_b128 v[60:63], v75 offset:22528
  v_add_f32 v20, v20, v22
  v_smfmac_f32_16x16x64_bf16 v[24:27], v[12:15], v[200:207], v74
  ds_read_b128 v[64:67], v75 offset:23552
  v_add_f32 v21, v21, v23
  v_smfmac_f32_16x16x64_bf16 v[28:31], v[16:19], v[240:247], v74
  v_mov_b64 v[70:71], s[78:79]
  v_smfmac_f32_16x16x64_bf16 v[28:31], v[4:7], a[0:7], v74
  s_waitcnt lgkmcnt(2)
  v_add_f32 v24, v24, v26
  v_smfmac_f32_16x16x64_bf16 v[28:31], v[0:3], v[36:43], v74
  ds_read_b128 v[36:39], v68
  v_cvt_pk_bf16_f32 v22, v20, v24
  v_smfmac_f32_16x16x64_bf16 v[28:31], v[12:15], a[16:23], v74
  ds_read_b128 v[40:43], v68
  ds_write_b32 v79, v22 offset:0
  s_waitcnt lgkmcnt(3)
  v_add_f32 v25, v25, v27
  v_cvt_pk_bf16_f32 v23, v21, v25
  v_smfmac_f32_16x16x64_bf16 v[32:35], v[0:3], v[60:67], v74
  ds_write_b32 v79, v23 offset:576
  v_cmp_u_f32 vcc, v20, v21
  v_smfmac_f32_16x16x64_bf16 v[32:35], v[16:19], v[248:255], v74
  v_add_f32 v28, v28, v30
  v_smfmac_f32_16x16x64_bf16 v[32:35], v[4:7], a[8:15], v74
  v_add_f32 v29, v29, v31
  v_smfmac_f32_16x16x64_bf16 v[32:35], v[12:15], a[24:31], v74
  s_cbranch_vccnz Cs1_rec
Cs1_recok:
  s_waitcnt lgkmcnt(3)
  v_smfmac_f32_16x16x64_bf16 v[36:39], v[16:19], a[128:135], v74
  s_waitcnt lgkmcnt(0)
  s_barrier
  ds_read_b128 v[60:63], v77
  v_smfmac_f32_16x16x64_bf16 v[40:43], v[16:19], a[136:143], v74
  ds_read_b128 v[64:67], v77 offset:128
  v_add_f32 v32, v32, v34
  v_cvt_pk_bf16_f32 v30, v28, v32
  v_smfmac_f32_16x16x64_bf16 v[36:39], v[0:3], a[112:119], v74
  ds_write_b32 v79, v30 offset:256
  v_add_f32 v33, v33, v35
  v_cvt_pk_bf16_f32 v31, v29, v33
  v_smfmac_f32_16x16x64_bf16 v[40:43], v[0:3], a[120:127], v74
  ds_write_b32 v79, v31 offset:832
  v_xor_b32 v75, 0x8000, v75
  v_smfmac_f32_16x16x64_bf16 v[36:39], v[4:7], a[144:151], v74
  ds_read_b128 v[0:3], v76 offset:4608
  v_mov_b32 v29, 0
  v_smfmac_f32_16x16x64_bf16 v[40:43], v[4:7], a[152:159], v74
  s_waitcnt vmcnt(2) lgkmcnt(3)
  v_mov_b32 v30, 0
  v_mfma_f32_16x16x32_bf16 v[44:47], v[44:47], v[60:63], 0
  ds_read_b128 v[4:7], v76 offset:5632
  s_waitcnt lgkmcnt(2)
  v_mfma_f32_16x16x32_bf16 v[44:47], v[48:51], v[64:67], v[44:47]
  s_barrier
  v_smfmac_f32_16x16x64_bf16 v[36:39], v[8:11], a[96:103], v74
  ds_read_b128 v[20:23], v77 offset:256
  ds_read_b128 v[24:27], v77 offset:384
  v_smfmac_f32_16x16x64_bf16 v[40:43], v[8:11], a[104:111], v74
  ds_read_b128 v[8:11], v76 offset:6656
  v_add_f32_dpp v72, v46, v44 quad_perm:[2,3,0,1] row_mask:0xf bank_mask:0xf
  v_add_f32_dpp v73, v47, v45 quad_perm:[2,3,0,1] row_mask:0xf bank_mask:0xf
  v_smfmac_f32_16x16x64_bf16 v[36:39], v[12:15], a[160:167], v74
  s_waitcnt lgkmcnt(4)
  v_exp_f32_dpp v72, v72 quad_perm:[0,1,0,1] row_mask:0xf bank_mask:0xf
  v_smfmac_f32_16x16x64_bf16 v[40:43], v[12:15], a[168:175], v74
  ds_read_b128 v[12:15], v76 offset:7680
  v_exp_f32_dpp v73, v73 quad_perm:[0,1,0,1] row_mask:0xf bank_mask:0xf
  v_smfmac_f32_16x16x64_bf16 v[36:39], v[0:3], a[32:39], v74
  s_waitcnt lgkmcnt(2)
  v_cvt_pk_bf16_f32 v72, v72, v73
  v_mfma_f32_16x16x32_bf16 v[20:23], v[20:23], v[60:63], 0
  ds_write_b32 v78, v72 offset:516
  v_mov_b64 v[16:17], 0
  v_mfma_f32_16x16x32_bf16 v[20:23], v[24:27], v[64:67], v[20:23]
  ds_read_b128 v[44:47], v75 offset:22528
  v_mov_b64 v[18:19], 0
  v_smfmac_f32_16x16x64_bf16 v[40:43], v[0:3], a[40:47], v74
  ds_read_b128 v[48:51], v75 offset:23552
  v_mov_b64 v[68:69], s[78:79]
  v_smfmac_f32_16x16x64_bf16 v[36:39], v[4:7], a[48:55], v74
  s_waitcnt lgkmcnt(4)
  v_add_f32_dpp v24, v22, v20 quad_perm:[2,3,0,1] row_mask:0xf bank_mask:0xf
  v_add_f32_dpp v25, v23, v21 quad_perm:[2,3,0,1] row_mask:0xf bank_mask:0xf
  v_smfmac_f32_16x16x64_bf16 v[36:39], v[8:11], a[64:71], v74
  s_waitcnt lgkmcnt(2)
  s_barrier
  ds_read_b128 v[32:35], v78 offset:512
  v_smfmac_f32_16x16x64_bf16 v[36:39], v[12:15], a[80:87], v74
  ds_read_b128 v[60:63], v75 offset:20480
  v_mul_f32 v24, s69, v24
  v_smfmac_f32_16x16x64_bf16 v[40:43], v[4:7], a[56:63], v74
  ds_read_b128 v[64:67], v75 offset:21504
  v_mul_f32 v25, s69, v25
  v_smfmac_f32_16x16x64_bf16 v[40:43], v[8:11], a[72:79], v74
  v_exp_f32_dpp v24, v24 quad_perm:[0,1,0,1] row_mask:0xf bank_mask:0xf
  v_smfmac_f32_16x16x64_bf16 v[40:43], v[12:15], a[88:95], v74
  s_waitcnt lgkmcnt(2)
  v_exp_f32_dpp v25, v25 quad_perm:[0,1,0,1] row_mask:0xf bank_mask:0xf
  v_mfma_f32_16x16x32_bf16 v[8:11], v[32:35], v[68:71], 0
  v_add_f32 v36, v36, v38
  v_add_f32 v37, v37, v39
  v_mfma_f32_16x16x32_bf16 v[0:3], v[32:35], v[52:55], 0
  v_add_f32 v40, v40, v42
  v_add_f32 v41, v41, v43
  v_mfma_f32_16x16x32_bf16 v[4:7], v[32:35], v[56:59], 0
  v_cvt_pk_bf16_f32 v28, v24, v25
  v_cvt_pk_bf16_f32 v72, v36, v37
  v_cvt_pk_bf16_f32 v73, v40, v41
  v_mfma_f32_16x16x16_bf16 v[8:11], v[28:29], v[68:69], v[8:11]
  v_cvt_pk_bf16_f32 v31, v24, v25
  v_mov_b64 v[20:21], 0
  v_mfma_f32_16x16x16_bf16 v[0:3], v[28:29], v[72:73], v[0:3]
  ds_read_b128 v[52:55], v75 offset:36864
  v_mov_b64 v[22:23], 0
  v_mfma_f32_16x16x16_bf16 v[4:7], v[30:31], v[72:73], v[4:7]
  v_rcp_f32 v10, v8
  v_rcp_f32 v11, v9
  v_mul_f32 v0, v10, v0
  v_mul_f32 v1, v11, v1
  v_max3_f32 v8, v8, v9, v10
  v_mul_f32 v4, v10, v4
  v_mul_f32 v5, v11, v5
  v_cvt_pk_bf16_f32 v2, v0, v4
  ds_write_b32 v79, v2 offset:8704
  v_cvt_pk_bf16_f32 v3, v1, v5
  ds_write_b32 v79, v3 offset:9280
  ds_read_b128 v[12:15], v78 offset:8768
  v_max_f32 v8, v8, v11
  v_cmp_le_f32 vcc, 1317011456, v8
  v_mov_b64 v[24:25], 0
  v_mov_b64 v[26:27], 0
  ds_read_b128 v[56:59], v75 offset:37888
  s_cbranch_vccnz Cs1_mx
Cs1_mxok:
  s_waitcnt lgkmcnt(2)
  s_barrier
  ds_read_b128 v[0:3], v78 offset:8704
  s_waitcnt lgkmcnt(2)
  v_smfmac_f32_16x16x64_bf16 v[16:19], v[12:15], v[44:51], v74
  ds_read_b128 v[4:7], v78 offset:8832
  v_smfmac_f32_16x16x64_bf16 v[20:23], v[12:15], a[200:207], v74
  ds_read_b128 v[8:11], v78 offset:8896
  v_smfmac_f32_16x16x64_bf16 v[24:27], v[12:15], a[216:223], v74
  ds_read_b128 v[36:39], v75 offset:38912
  s_waitcnt lgkmcnt(3)
  v_smfmac_f32_16x16x64_bf16 v[16:19], v[0:3], v[60:67], v74
  ds_read_b128 v[40:43], v75 offset:39936
  s_waitcnt lgkmcnt(3)
  v_smfmac_f32_16x16x64_bf16 v[16:19], v[4:7], a[176:183], v74
  ds_read_b128 v[68:71], v76 offset:13824
  s_waitcnt lgkmcnt(3)
  v_smfmac_f32_16x16x64_bf16 v[16:19], v[8:11], a[184:191], v74
  ds_read_b128 v[44:47], v75 offset:53248
  v_smfmac_f32_16x16x64_bf16 v[20:23], v[0:3], a[192:199], v74
  ds_read_b128 v[48:51], v75 offset:54272
  v_smfmac_f32_16x16x64_bf16 v[20:23], v[4:7], v[52:59], v74
  ds_read_b128 v[60:63], v75 offset:55296
  s_waitcnt lgkmcnt(4)
  v_cvt_pk_bf16_f32 v16, v16, v17
  v_cvt_pk_bf16_f32 v17, v18, v19
  v_bfi_b32 v16, 1, s72, v16
  v_smfmac_f32_16x16x64_bf16 v[20:23], v[8:11], v[36:43], v74
  s_waitcnt lgkmcnt(3)
  buffer_store_dwordx2 v[16:17], v68, s[8:11], s73 offen sc1
  v_mov_b64 v[32:33], 0
  v_smfmac_f32_16x16x64_bf16 v[24:27], v[0:3], a[208:215], v74
  ds_read_b128 v[64:67], v75 offset:56320
  v_mov_b64 v[34:35], 0
  v_smfmac_f32_16x16x64_bf16 v[24:27], v[4:7], a[224:231], v74
  v_cvt_pk_bf16_f32 v20, v20, v21
  v_cvt_pk_bf16_f32 v21, v22, v23
  v_bfi_b32 v20, 1, s72, v20
  v_smfmac_f32_16x16x64_bf16 v[24:27], v[8:11], a[232:239], v74
  buffer_store_dwordx2 v[20:21], v68, s[8:11], s74 offen sc1
  s_waitcnt lgkmcnt(2)
  v_smfmac_f32_16x16x64_bf16 v[32:35], v[0:3], v[44:51], v74
  s_waitcnt lgkmcnt(0)
  v_smfmac_f32_16x16x64_bf16 v[32:35], v[12:15], v[60:67], v74
  v_cvt_pk_bf16_f32 v24, v24, v25
  v_cvt_pk_bf16_f32 v25, v26, v27
  v_bfi_b32 v24, 1, s72, v24
  v_smfmac_f32_16x16x64_bf16 v[32:35], v[4:7], a[240:247], v74
  buffer_store_dwordx2 v[24:25], v68, s[8:11], s75 offen sc1
  v_smfmac_f32_16x16x64_bf16 v[32:35], v[8:11], a[248:255], v74
  v_mov_b64 v[18:19], v[72:73]
  s_nop 4
  v_cvt_pk_bf16_f32 v32, v32, v33
  v_cvt_pk_bf16_f32 v33, v34, v35
  v_bfi_b32 v32, 1, s72, v32
  buffer_store_dwordx2 v[32:33], v68, s[8:11], s76 offen sc1
  ds_read_b128 v[0:3], v76 offset:14848
  s_waitcnt lgkmcnt(0)
  ds_read_b64 v[16:17], v77 offset:264
  s_waitcnt lgkmcnt(0)
  ds_read_b128 v[64:67], v76 offset:23552
  s_waitcnt lgkmcnt(0)
  s_add_u32 s66, s66, 1
  s_xor_b32 s64, s64, 16384
  s_xor_b32 s65, s65, 16384
  s_add_u32 s58, s58, 655360
  s_add_u32 s59, s59, 655360
  s_add_u32 s70, s70, 655360
  s_add_u32 s68, s68, 655360
  s_mov_b32 m0, 11776
  s_add_u32 s85, s65, 7168
  v_xor_b32 v75, 0x8000, v75
  v_mov_b64 v[28:29], 0
  v_mov_b64 v[30:31], 0
  v_mov_b64 v[32:33], 0
  v_mov_b64 v[34:35], 0
  s_waitcnt vmcnt(0)
  buffer_load_dwordx4 v[52:55], v76, s[8:11], s60 offen offset:0 sc1
  buffer_load_dwordx4 v[56:59], v76, s[8:11], s60 offen offset:1024 sc1
  s_waitcnt lgkmcnt(0)
  s_waitcnt vmcnt(1)
  v_mfma_f32_16x16x32_bf16 v[4:7], v[0:3], v[52:55], 0
  v_bitop3_b32 v72, v52, v54, s72 bitop3:0x7e
  s_waitcnt vmcnt(0)
  v_mfma_f32_16x16x32_bf16 v[4:7], v[0:3], v[56:59], v[4:7]
  v_bitop3_b32 v73, v56, v58, s72 bitop3:0x7e
  v_bitop3_b32 v72, v72, v73, 1 bitop3:0xa8
  v_cmp_ne_u32 vcc, 0, v72
  s_cbranch_vccnz Cs1_h1r
  s_nop 2
  v_add_f32_dpp v4, v4, v4 row_ror:4 row_mask:0xf bank_mask:0xf
  v_add_f32_dpp v5, v5, v5 row_ror:4 row_mask:0xf bank_mask:0xf
  s_nop 0
  v_add_f32_dpp v4, v4, v4 row_ror:8 row_mask:0xf bank_mask:0xf
  v_add_f32_dpp v5, v5, v5 row_ror:8 row_mask:0xf bank_mask:0xf
  v_cvt_pk_bf16_f32 v4, v4, v5
  buffer_store_dword v4, v69, s[8:11], s62 offen sc1
  s_xor_b32 s62, s62, 16384
  buffer_store_dword v71, v69, s[8:11], s62 offen sc1
  s_xor_b32 s72, s72, 1
  s_branch Cs1_h2
Cs1_h1r:
  s_mov_b64 exec, vcc
  buffer_load_dwordx4 v[52:55], v76, s[8:11], s60 offen offset:0 sc1
  buffer_load_dwordx4 v[56:59], v76, s[8:11], s60 offen offset:1024 sc1
  s_mov_b64 exec, -1
  s_add_u32 s67, s67, 1
  s_waitcnt vmcnt(1)
  v_mfma_f32_16x16x32_bf16 v[4:7], v[0:3], v[52:55], 0
  v_bitop3_b32 v72, v52, v54, s72 bitop3:0x7e
  s_waitcnt vmcnt(0)
  v_mfma_f32_16x16x32_bf16 v[4:7], v[0:3], v[56:59], v[4:7]
  v_bitop3_b32 v73, v56, v58, s72 bitop3:0x7e
  v_bitop3_b32 v72, v72, v73, 1 bitop3:0xa8
  v_cmp_ne_u32 vcc, 0, v72
  s_cbranch_vccz Cs1_h1p
Cs1_h1s:
  s_mov_b64 exec, vcc
  buffer_load_dwordx4 v[52:55], v76, s[8:11], s60 offen offset:0 sc1
  buffer_load_dwordx4 v[56:59], v76, s[8:11], s60 offen offset:1024 sc1
  s_mov_b64 exec, -1
  s_add_u32 s67, s67, 1
  s_waitcnt vmcnt(1)
  v_mfma_f32_16x16x32_bf16 v[4:7], v[0:3], v[52:55], 0
  v_bitop3_b32 v72, v52, v54, s72 bitop3:0x7e
  s_waitcnt vmcnt(0)
  v_mfma_f32_16x16x32_bf16 v[4:7], v[0:3], v[56:59], v[4:7]
  v_bitop3_b32 v73, v56, v58, s72 bitop3:0x7e
  v_bitop3_b32 v72, v72, v73, 1 bitop3:0xa8
  v_cmp_ne_u32 vcc, 0, v72
  s_cbranch_vccz Cs1_h1p
  s_cmp_lt_u32 s67, 131072
  s_cbranch_scc1 Cs1_h1s
Cs1_h1p:
  s_nop 2
  v_add_f32_dpp v4, v4, v4 row_ror:4 row_mask:0xf bank_mask:0xf
  v_add_f32_dpp v5, v5, v5 row_ror:4 row_mask:0xf bank_mask:0xf
  s_nop 0
  v_add_f32_dpp v4, v4, v4 row_ror:8 row_mask:0xf bank_mask:0xf
  v_add_f32_dpp v5, v5, v5 row_ror:8 row_mask:0xf bank_mask:0xf
  v_cvt_pk_bf16_f32 v4, v4, v5
  buffer_store_dword v4, v69, s[8:11], s62 offen sc1
  s_xor_b32 s62, s62, 16384
  buffer_store_dword v71, v69, s[8:11], s62 offen sc1
  s_xor_b32 s72, s72, 1
  s_branch Cs1_h2
Cs1_rec:
  s_nop 7
  s_waitcnt vmcnt(0) lgkmcnt(0)
  v_max3_u32 v72, v0, v1, v2
  v_max3_u32 v72, v72, v3, v4
  v_max3_u32 v72, v72, v5, v6
  v_max3_u32 v72, v72, v7, v8
  v_max3_u32 v72, v72, v9, v10
  v_max3_u32 v72, v72, v11, v12
  v_max3_u32 v72, v72, v13, v14
  v_max3_u32 v72, v72, v15, v16
  v_max3_u32 v72, v72, v17, v18
  v_max_u32 v72, v72, v19
  v_cmp_eq_u32 vcc, -1, v72
  s_cbranch_vccz Cs1_recok
  s_barrier
  v_mov_b64 v[20:21], 0
  v_mov_b64 v[22:23], 0
  v_mov_b64 v[24:25], 0
  v_mov_b64 v[26:27], 0
  v_mov_b64 v[28:29], 0
  v_mov_b64 v[30:31], 0
  v_mov_b64 v[32:33], 0
  v_mov_b64 v[34:35], 0
  s_waitcnt lgkmcnt(0)
  s_barrier
  ds_read_b128 v[0:3], v76 offset:4608
  s_waitcnt lgkmcnt(0)
  v_smfmac_f32_16x16x64_bf16 v[20:23], v[0:3], v[80:87], v74
  v_smfmac_f32_16x16x64_bf16 v[24:27], v[0:3], v[88:95], v74
  ds_read_b128 v[60:63], v76 offset:20480
  ds_read_b128 v[64:67], v76 offset:21504
  s_waitcnt lgkmcnt(0)
  v_smfmac_f32_16x16x64_bf16 v[28:31], v[0:3], v[60:67], v74
  ds_read_b128 v[60:63], v76 offset:22528
  ds_read_b128 v[64:67], v76 offset:23552
  s_waitcnt lgkmcnt(0)
  v_smfmac_f32_16x16x64_bf16 v[32:35], v[0:3], v[60:67], v74
  ds_read_b128 v[4:7], v76 offset:5632
  s_waitcnt lgkmcnt(0)
  v_smfmac_f32_16x16x64_bf16 v[20:23], v[4:7], v[96:103], v74
  v_smfmac_f32_16x16x64_bf16 v[24:27], v[4:7], v[104:111], v74
  ds_read_b128 v[60:63], v76 offset:36864
  ds_read_b128 v[64:67], v76 offset:37888
  s_waitcnt lgkmcnt(0)
  v_smfmac_f32_16x16x64_bf16 v[28:31], v[4:7], v[60:67], v74
  ds_read_b128 v[60:63], v76 offset:38912
  ds_read_b128 v[64:67], v76 offset:39936
  s_waitcnt lgkmcnt(0)
  v_smfmac_f32_16x16x64_bf16 v[32:35], v[4:7], v[60:67], v74
  ds_read_b128 v[8:11], v76 offset:6656
  s_waitcnt lgkmcnt(0)
  v_smfmac_f32_16x16x64_bf16 v[20:23], v[8:11], v[112:119], v74
  v_smfmac_f32_16x16x64_bf16 v[24:27], v[8:11], v[120:127], v74
  v_smfmac_f32_16x16x64_bf16 v[28:31], v[8:11], v[208:215], v74
  v_smfmac_f32_16x16x64_bf16 v[32:35], v[8:11], v[216:223], v74
  ds_read_b128 v[12:15], v76 offset:7680
  s_waitcnt lgkmcnt(0)
  v_smfmac_f32_16x16x64_bf16 v[20:23], v[12:15], v[128:135], v74
  v_smfmac_f32_16x16x64_bf16 v[24:27], v[12:15], v[136:143], v74
  v_smfmac_f32_16x16x64_bf16 v[28:31], v[12:15], v[224:231], v74
  v_smfmac_f32_16x16x64_bf16 v[32:35], v[12:15], v[232:239], v74
  ds_read_b128 v[8:11], v76 offset:8704
  s_waitcnt lgkmcnt(0)
  v_smfmac_f32_16x16x64_bf16 v[20:23], v[8:11], v[144:151], v74
  v_smfmac_f32_16x16x64_bf16 v[24:27], v[8:11], v[152:159], v74
  ds_read_b128 v[60:63], v76 offset:53248
  ds_read_b128 v[64:67], v76 offset:54272
  s_waitcnt lgkmcnt(0)
  v_smfmac_f32_16x16x64_bf16 v[28:31], v[8:11], v[60:67], v74
  ds_read_b128 v[60:63], v76 offset:55296
  ds_read_b128 v[64:67], v76 offset:56320
  s_waitcnt lgkmcnt(0)
  v_smfmac_f32_16x16x64_bf16 v[32:35], v[8:11], v[60:67], v74
  ds_read_b128 v[0:3], v76 offset:9728
  s_waitcnt lgkmcnt(0)
  v_smfmac_f32_16x16x64_bf16 v[20:23], v[0:3], v[160:167], v74
  v_smfmac_f32_16x16x64_bf16 v[24:27], v[0:3], v[168:175], v74
  ds_read_b128 v[60:63], v75 offset:20480
  ds_read_b128 v[64:67], v75 offset:21504
  s_waitcnt lgkmcnt(0)
  v_smfmac_f32_16x16x64_bf16 v[28:31], v[0:3], v[60:67], v74
  ds_read_b128 v[60:63], v75 offset:22528
  ds_read_b128 v[64:67], v75 offset:23552
  s_waitcnt lgkmcnt(0)
  v_smfmac_f32_16x16x64_bf16 v[32:35], v[0:3], v[60:67], v74
  ds_read_b128 v[16:19], v76 offset:10752
  ds_read_b128 v[60:63], v75 offset:4096
  ds_read_b128 v[64:67], v75 offset:5120
  s_waitcnt lgkmcnt(0)
  v_smfmac_f32_16x16x64_bf16 v[20:23], v[16:19], v[60:67], v74
  ds_read_b128 v[60:63], v75 offset:6144
  ds_read_b128 v[64:67], v75 offset:7168
  s_waitcnt lgkmcnt(0)
  v_smfmac_f32_16x16x64_bf16 v[24:27], v[16:19], v[60:67], v74
  v_smfmac_f32_16x16x64_bf16 v[28:31], v[16:19], v[240:247], v74
  v_smfmac_f32_16x16x64_bf16 v[32:35], v[16:19], v[248:255], v74
  ds_read_b128 v[4:7], v76 offset:11776
  s_waitcnt lgkmcnt(0)
  v_smfmac_f32_16x16x64_bf16 v[20:23], v[4:7], v[176:183], v74
  v_smfmac_f32_16x16x64_bf16 v[24:27], v[4:7], v[184:191], v74
  v_smfmac_f32_16x16x64_bf16 v[28:31], v[4:7], a[0:7], v74
  v_smfmac_f32_16x16x64_bf16 v[32:35], v[4:7], a[8:15], v74
  ds_read_b128 v[12:15], v76 offset:12800
  s_waitcnt lgkmcnt(0)
  v_smfmac_f32_16x16x64_bf16 v[20:23], v[12:15], v[192:199], v74
  v_smfmac_f32_16x16x64_bf16 v[24:27], v[12:15], v[200:207], v74
  v_smfmac_f32_16x16x64_bf16 v[28:31], v[12:15], a[16:23], v74
  v_smfmac_f32_16x16x64_bf16 v[32:35], v[12:15], a[24:31], v74
  v_add_f32 v20, v20, v22
  v_add_f32 v21, v21, v23
  v_add_f32 v24, v24, v26
  v_cvt_pk_bf16_f32 v22, v20, v24
  ds_write_b32 v79, v22 offset:0
  v_add_f32 v25, v25, v27
  v_cvt_pk_bf16_f32 v23, v21, v25
  ds_write_b32 v79, v23 offset:576
  v_add_f32 v28, v28, v30
  v_add_f32 v29, v29, v31
  s_waitcnt lgkmcnt(0)
  s_nop 1
  s_branch Cs1_recok
Cs1_mx:
  s_waitcnt lgkmcnt(0)
  s_barrier
  buffer_load_dwordx4 v[52:55], v76, s[8:11], s59 offen offset:0 sc1
  buffer_load_dwordx4 v[0:3], v76, s[8:11], s58 offen offset:0 sc1
  ds_read_b128 v[20:23], v77 offset:0
  ds_read_b128 v[28:31], v77 offset:256
  buffer_load_dwordx4 v[56:59], v76, s[8:11], s59 offen offset:1024 sc1
  buffer_load_dwordx4 v[4:7], v76, s[8:11], s58 offen offset:1024 sc1
  ds_read_b128 v[24:27], v77 offset:128
  ds_read_b128 v[32:35], v77 offset:384
  s_waitcnt vmcnt(2) lgkmcnt(3)
  v_mfma_f32_16x16x32_bf16 v[8:11], v[0:3], v[20:23], 0
  s_waitcnt vmcnt(0) lgkmcnt(1)
  v_mfma_f32_16x16x32_bf16 v[8:11], v[4:7], v[24:27], v[8:11]
  v_mfma_f32_16x16x32_bf16 v[12:15], v[28:31], v[20:23], 0
  s_waitcnt lgkmcnt(0)
  v_mfma_f32_16x16x32_bf16 v[12:15], v[32:35], v[24:27], v[12:15]
  v_add_f32_dpp v8, v10, v8 quad_perm:[2,3,0,1] row_mask:0xf bank_mask:0xf
  v_add_f32_dpp v9, v11, v9 quad_perm:[2,3,0,1] row_mask:0xf bank_mask:0xf
  s_nop 0
  v_mov_b32_dpp v8, v8 quad_perm:[0,1,0,1] row_mask:0xf bank_mask:0xf
  v_mov_b32_dpp v9, v9 quad_perm:[0,1,0,1] row_mask:0xf bank_mask:0xf
  s_nop 1
  v_add_f32_dpp v12, v14, v12 quad_perm:[2,3,0,1] row_mask:0xf bank_mask:0xf
  v_add_f32_dpp v13, v15, v13 quad_perm:[2,3,0,1] row_mask:0xf bank_mask:0xf
  s_nop 0
  v_mov_b32_dpp v12, v12 quad_perm:[0,1,0,1] row_mask:0xf bank_mask:0xf
  v_mov_b32_dpp v13, v13 quad_perm:[0,1,0,1] row_mask:0xf bank_mask:0xf
  v_mul_f32 v12, s69, v12
  ds_write_b32 v78, v8 offset:8708
  v_mul_f32 v13, s69, v13
  ds_write_b32 v78, v9 offset:8772
  s_waitcnt lgkmcnt(0)
  s_barrier
  ds_read_b128 v[36:39], v78 offset:8704
  ds_read_b128 v[40:43], v78 offset:8768
  s_waitcnt lgkmcnt(0)
  s_barrier
  v_max_f32 v16, v36, v37
  v_max3_f32 v16, v16, v38, v39
  v_max3_f32 v16, v16, v40, v41
  v_max3_f32 v16, v16, v42, v43
  v_max3_f32 v16, v16, v12, v13
  v_mov_b32 v17, v16
  s_nop 1
  v_permlane16_swap_b32 v16, v17
  v_max_f32 v16, v16, v17
  v_mov_b32 v17, v16
  s_nop 1
  v_permlane32_swap_b32 v16, v17
  v_max_f32 v16, v16, v17
  v_sub_f32 v36, v36, v16
  v_sub_f32 v37, v37, v16
  v_sub_f32 v38, v38, v16
  v_sub_f32 v39, v39, v16
  v_sub_f32 v40, v40, v16
  v_sub_f32 v41, v41, v16
  v_sub_f32 v42, v42, v16
  v_sub_f32 v43, v43, v16
  v_sub_f32 v12, v12, v16
  v_sub_f32 v13, v13, v16
  v_exp_f32 v36, v36
  v_exp_f32 v37, v37
  v_exp_f32 v38, v38
  v_exp_f32 v39, v39
  v_exp_f32 v40, v40
  v_exp_f32 v41, v41
  v_exp_f32 v42, v42
  v_exp_f32 v43, v43
  v_exp_f32 v12, v12
  v_exp_f32 v13, v13
  v_cvt_pk_bf16_f32 v32, v36, v40
  v_cvt_pk_bf16_f32 v33, v37, v41
  v_cvt_pk_bf16_f32 v34, v38, v42
  v_cvt_pk_bf16_f32 v35, v39, v43
  v_cvt_pk_bf16_f32 v28, v12, v13
  v_cvt_pk_bf16_f32 v31, v12, v13
  v_mov_b32 v29, 0
  v_mov_b32 v30, 0
  v_mfma_f32_16x16x32_bf16 v[8:11], v[32:35], v[68:71], 0
  v_mfma_f32_16x16x32_bf16 v[0:3], v[32:35], v[52:55], 0
  v_mfma_f32_16x16x32_bf16 v[4:7], v[32:35], v[56:59], 0
  v_mfma_f32_16x16x16_bf16 v[8:11], v[28:29], v[68:69], v[8:11]
  v_mfma_f32_16x16x16_bf16 v[0:3], v[28:29], v[72:73], v[0:3]
  v_mfma_f32_16x16x16_bf16 v[4:7], v[30:31], v[72:73], v[4:7]
  ds_read_b128 v[52:55], v75 offset:36864
  v_rcp_f32 v10, v8
  v_rcp_f32 v11, v9
  v_mul_f32 v0, v10, v0
  v_mul_f32 v1, v11, v1
  v_max3_f32 v8, v8, v9, v10
  v_mul_f32 v4, v10, v4
  v_mul_f32 v5, v11, v5
  v_cvt_pk_bf16_f32 v2, v0, v4
  ds_write_b32 v79, v2 offset:8704
  v_cvt_pk_bf16_f32 v3, v1, v5
  ds_write_b32 v79, v3 offset:9280
  ds_read_b128 v[12:15], v78 offset:8768
  ds_read_b128 v[56:59], v75 offset:37888
  v_mov_b64 v[16:17], 0
  v_mov_b64 v[18:19], 0
  v_mov_b64 v[20:21], 0
  v_mov_b64 v[22:23], 0
  v_mov_b64 v[24:25], 0
  v_mov_b64 v[26:27], 0
  s_branch Cs1_mxok
Cs1_last:
  ds_read_b128 v[4:7], v76 offset:5632
  ds_read_b128 v[12:15], v76 offset:7680
  ds_read_b128 v[44:47], v76 offset:36864
  ds_read_b128 v[48:51], v76 offset:37888
  s_nop 5
  v_mov_b64 v[20:21], 0
  v_mov_b64 v[22:23], 0
  v_mov_b64 v[24:25], 0
  v_mov_b64 v[26:27], 0
  s_waitcnt lgkmcnt(4)
  v_smfmac_f32_16x16x64_bf16 v[28:31], v[0:3], v[36:43], v74
  ds_read_b128 v[36:39], v76 offset:38912
  ds_read_b128 v[40:43], v76 offset:39936
  v_smfmac_f32_16x16x64_bf16 v[32:35], v[0:3], v[60:67], v74
  s_waitcnt lgkmcnt(5)
  v_smfmac_f32_16x16x64_bf16 v[20:23], v[0:3], a[32:39], v74
  ds_read_b128 v[60:63], v76 offset:53248
  ds_read_b128 v[64:67], v76 offset:54272
  v_smfmac_f32_16x16x64_bf16 v[24:27], v[0:3], a[40:47], v74
  s_waitcnt lgkmcnt(4)
  v_smfmac_f32_16x16x64_bf16 v[20:23], v[4:7], a[48:55], v74
  buffer_store_dwordx4 v[16:19], v76, s[8:11], s68 offen sc1
  v_smfmac_f32_16x16x64_bf16 v[24:27], v[4:7], a[56:63], v74
  v_smfmac_f32_16x16x64_bf16 v[28:31], v[4:7], v[44:51], v74
  s_waitcnt lgkmcnt(2)
  v_smfmac_f32_16x16x64_bf16 v[20:23], v[8:11], a[64:71], v74
  ds_read_b128 v[44:47], v76 offset:55296
  ds_read_b128 v[48:51], v76 offset:56320
  v_smfmac_f32_16x16x64_bf16 v[24:27], v[8:11], a[72:79], v74
  v_smfmac_f32_16x16x64_bf16 v[32:35], v[4:7], v[36:43], v74
  v_smfmac_f32_16x16x64_bf16 v[28:31], v[8:11], v[208:215], v74
  ds_read_b128 v[36:39], v75 offset:20480
  ds_read_b128 v[40:43], v75 offset:21504
  v_smfmac_f32_16x16x64_bf16 v[32:35], v[8:11], v[216:223], v74
  v_smfmac_f32_16x16x64_bf16 v[20:23], v[12:15], a[80:87], v74
  v_smfmac_f32_16x16x64_bf16 v[24:27], v[12:15], a[88:95], v74
  v_smfmac_f32_16x16x64_bf16 v[28:31], v[12:15], v[224:231], v74
  v_smfmac_f32_16x16x64_bf16 v[32:35], v[12:15], v[232:239], v74
  s_waitcnt vmcnt(1)
  s_barrier
Cs1_lastr:
  ds_read_b128 v[8:11], v76 offset:8704
  ds_read_b128 v[0:3], v76 offset:9728
  ds_read_b128 v[16:19], v76 offset:10752
  ds_read_b128 v[4:7], v76 offset:11776
  ds_read_b128 v[12:15], v76 offset:12800
  s_waitcnt lgkmcnt(3)
  v_max3_u32 v72, v0, v1, v2
  s_waitcnt lgkmcnt(1)
  v_max3_u32 v72, v72, v3, v4
  v_max3_u32 v72, v72, v5, v6
  v_max3_u32 v72, v72, v7, v8
  v_max3_u32 v72, v72, v9, v10
  s_waitcnt lgkmcnt(0)
  v_max3_u32 v72, v72, v11, v12
  v_max3_u32 v72, v72, v13, v14
  v_max3_u32 v72, v72, v15, v16
  v_max3_u32 v72, v72, v17, v18
  v_max_u32 v72, v72, v19
  v_cmp_eq_u32 vcc, -1, v72
  s_cbranch_vccnz Cs1_lastp
Cs1_lastg:
  v_smfmac_f32_16x16x64_bf16 v[28:31], v[8:11], v[60:67], v74
  ds_read_b128 v[60:63], v75 offset:22528
  ds_read_b128 v[64:67], v75 offset:23552
  v_smfmac_f32_16x16x64_bf16 v[32:35], v[8:11], v[44:51], v74
  v_smfmac_f32_16x16x64_bf16 v[28:31], v[0:3], v[36:43], v74
  v_smfmac_f32_16x16x64_bf16 v[28:31], v[16:19], v[240:247], v74
  v_smfmac_f32_16x16x64_bf16 v[28:31], v[4:7], a[0:7], v74
  v_smfmac_f32_16x16x64_bf16 v[28:31], v[12:15], a[16:23], v74
  v_smfmac_f32_16x16x64_bf16 v[32:35], v[16:19], v[248:255], v74
  v_smfmac_f32_16x16x64_bf16 v[32:35], v[4:7], a[8:15], v74
  s_waitcnt lgkmcnt(0)
  v_smfmac_f32_16x16x64_bf16 v[32:35], v[12:15], a[24:31], v74
  v_smfmac_f32_16x16x64_bf16 v[32:35], v[0:3], v[60:67], v74
  v_smfmac_f32_16x16x64_bf16 v[20:23], v[8:11], a[96:103], v74
  v_smfmac_f32_16x16x64_bf16 v[20:23], v[0:3], a[112:119], v74
  v_add_f32 v28, v28, v30
  v_add_f32 v32, v32, v34
  v_cvt_pk_bf16_f32 v30, v28, v32
  v_smfmac_f32_16x16x64_bf16 v[20:23], v[16:19], a[128:135], v74
  ds_write_b32 v79, v30 offset:256
  v_add_f32 v29, v29, v31
  v_add_f32 v33, v33, v35
  v_cvt_pk_bf16_f32 v31, v29, v33
  v_smfmac_f32_16x16x64_bf16 v[20:23], v[4:7], a[144:151], v74
  ds_write_b32 v79, v31 offset:832
  v_smfmac_f32_16x16x64_bf16 v[20:23], v[12:15], a[160:167], v74
  v_smfmac_f32_16x16x64_bf16 v[24:27], v[8:11], a[104:111], v74
  v_smfmac_f32_16x16x64_bf16 v[24:27], v[0:3], a[120:127], v74
  v_smfmac_f32_16x16x64_bf16 v[24:27], v[16:19], a[136:143], v74
  s_waitcnt lgkmcnt(0)
  s_barrier
  ds_read_b64 v[52:53], v77 offset:264
  v_add_f32 v20, v20, v22
  v_smfmac_f32_16x16x64_bf16 v[24:27], v[4:7], a[152:159], v74
  v_add_f32 v21, v21, v23
  v_smfmac_f32_16x16x64_bf16 v[24:27], v[12:15], a[168:175], v74
  v_cvt_pk_bf16_f32 v54, v20, v21
  s_add_u32 s68, s68, 655360
  s_nop 3
  v_add_f32 v24, v24, v26
  v_add_f32 v25, v25, v27
  v_cvt_pk_bf16_f32 v55, v24, v25
  s_waitcnt lgkmcnt(0)
  buffer_store_dwordx4 v[52:55], v76, s[8:11], s68 offen sc1
  s_branch Cs1_done
Cs1_lastp:
  s_add_u32 s72, s72, 2
  s_cmp_ge_u32 s72, 131072
  s_cbranch_scc1 Cs1_lastg
  s_barrier
  buffer_load_dwordx4 v76, s[8:11], s85 offen offset:0 sc1 lds
  s_waitcnt vmcnt(0)
  s_barrier
  s_branch Cs1_lastr
Cs1_done:
  s_branch L_cexit
L_w6:
  v_mov_b64 v[20:21], 0
  v_mov_b64 v[22:23], 0
  v_mov_b64 v[24:25], 0
  v_mov_b64 v[26:27], 0
  v_mov_b64 v[28:29], 0
  v_mov_b64 v[30:31], 0
  v_mov_b64 v[32:33], 0
  v_mov_b64 v[34:35], 0
  s_mov_b32 s78, 0x3f803f80
  s_mov_b32 s79, s78
  s_mov_b32 s65, 360448
  s_mov_b32 m0, 15872
  s_lshl_b32 s71, s53, 2
  s_add_u32 s71, s71, 128
  s_movk_i32 s56, 0x1000
  v_lshlrev_b32 v73, 2, v76
  v_mov_b32 v72, 0
  s_mov_b64 s[16:17], s[8:9]
  s_mov_b32 s18, 268435456
  s_mov_b32 s19, 0x20000
  s_getpc_b64 s[20:21]
Cs2_pc:
  s_add_u32 s20, s20, (Cs2_last - Cs2_pc)
  s_addc_u32 s21, s21, 0
  v_mov_b32 v68, 14880
  buffer_load_dwordx4 v[52:55], v76, s[8:11], s59 offen offset:0 sc1
  buffer_load_dwordx4 v[56:59], v76, s[8:11], s59 offen offset:1024 sc1
  ds_read_b128 v[36:39], v76 offset:24576
  ds_read_b128 v[40:43], v76 offset:25600
  ds_read_b128 v[60:63], v76 offset:26624
  ds_read_b128 v[64:67], v76 offset:27648
  ds_read_b128 v[0:3], v76 offset:4608
  ds_read_b128 v[4:7], v76 offset:5632
  ds_read_b128 v[8:11], v76 offset:6656
  ds_read_b128 v[12:15], v76 offset:7680
  s_waitcnt lgkmcnt(0)
  s_cmp_eq_u32 s66, 1
  s_branch Cs2_top2
.p2align 6
Cs2_h2:
  ds_read_b128 v[36:39], v76 offset:24576
  s_cmp_eq_u32 s66, 62
  s_cselect_b64 s[16:17], s[20:21], s[16:17]
  s_cselect_b32 s18, (Cs2_done - Cs2_last), s18
  s_cselect_b32 s70, 0, s70
  s_cmp_eq_u32 s66, 63
  s_cselect_b32 s59, 268435456, s59
  s_cselect_b32 s58, 268435456, s58
  ds_read_b128 v[40:43], v76 offset:25600
  v_mov_b64 v[20:21], 0
  v_mov_b64 v[22:23], 0
  v_mov_b64 v[24:25], 0
  v_mov_b64 v[26:27], 0
  v_mov_b32 v68, 14880
  v_lshlrev_b32 v73, 2, v76
  buffer_load_dwordx4 v[52:55], v76, s[8:11], s59 offen offset:0 sc1
  buffer_load_dwordx4 v[56:59], v76, s[8:11], s59 offen offset:1024 sc1
  s_waitcnt vmcnt(0)
  s_mov_b64 vcc, -1
Cs2_h2r:
  s_mov_b64 exec, vcc
  buffer_load_dwordx4 v[12:15], v76, s[8:11], s65 offen offset:3072 sc1
  buffer_load_dwordx4 v[0:3], v76, s[8:11], s85 offen offset:0 sc1
  s_mov_b64 exec, -1
  s_add_u32 s67, s67, 1
  s_cmp_lt_u32 s67, 131072
  s_cselect_b32 s54, -2, -1
  s_waitcnt vmcnt(1)
  v_max3_u32 v72, v12, v13, v14
  s_waitcnt vmcnt(0)
  v_max3_u32 v72, v72, v15, v0
  v_max3_u32 v72, v72, v1, v2
  v_max_u32 v72, v72, v3
  v_cmp_lt_u32 vcc, s54, v72
  s_cbranch_vccnz Cs2_h2r
  ds_write_b128 v76, v[12:15] offset:7680
  ds_write_b128 v76, v[0:3] offset:12800
Cs2_h2w:
  s_cmp_eq_u32 s66, 63
  s_waitcnt lgkmcnt(0)
  s_barrier
  ds_read_b128 v[0:3], v76 offset:4608
Cs2_top2:
  v_smfmac_f32_16x16x64_bf16 v[20:23], v[12:15], v[128:135], v74
  s_cbranch_scc1 Cs2_last
  v_smfmac_f32_16x16x64_bf16 v[24:27], v[12:15], v[136:143], v74
  buffer_load_dwordx4 v[44:47], v76, s[8:11], s58 offen offset:0 sc1
  s_mov_b32 m0, 15872
  v_smfmac_f32_16x16x64_bf16 v[28:31], v[12:15], v[224:231], v74
  buffer_load_dwordx4 v[48:51], v76, s[8:11], s58 offen offset:1024 sc1
  v_smfmac_f32_16x16x64_bf16 v[32:35], v[12:15], v[232:239], v74
  ds_read_b128 v[4:7], v76 offset:5632
  s_waitcnt lgkmcnt(1)
  v_smfmac_f32_16x16x64_bf16 v[20:23], v[0:3], v[80:87], v74
  ds_read_b128 v[8:11], v76 offset:6656
  v_smfmac_f32_16x16x64_bf16 v[28:31], v[0:3], v[36:43], v74
  ds_read_b128 v[36:39], v76 offset:40960
  v_smfmac_f32_16x16x64_bf16 v[24:27], v[0:3], v[88:95], v74
  buffer_store_dwordx4 v[16:19], v76, s[8:11], s68 offen sc1
  ds_read_b128 v[40:43], v76 offset:41984
  v_smfmac_f32_16x16x64_bf16 v[32:35], v[0:3], v[60:67], v74
  buffer_load_dword v73, s[16:19], s70 offen lds
  ds_read_b128 v[60:63], v76 offset:43008
  s_waitcnt lgkmcnt(4)
  v_smfmac_f32_16x16x64_bf16 v[20:23], v[4:7], v[96:103], v74
  ds_read_b128 v[64:67], v76 offset:44032
  v_smfmac_f32_16x16x64_bf16 v[24:27], v[4:7], v[104:111], v74
  s_waitcnt vmcnt(4)
  s_waitcnt lgkmcnt(4)
  v_smfmac_f32_16x16x64_bf16 v[20:23], v[8:11], v[112:119], v74
  s_barrier
  ds_read_b128 v[12:15], v76 offset:8704
  s_waitcnt lgkmcnt(3)
  v_smfmac_f32_16x16x64_bf16 v[28:31], v[4:7], v[36:43], v74
  ds_read_b128 v[36:39], v76 offset:57344
  v_smfmac_f32_16x16x64_bf16 v[24:27], v[8:11], v[120:127], v74
  ds_read_b128 v[40:43], v76 offset:58368
  s_waitcnt lgkmcnt(3)
  v_smfmac_f32_16x16x64_bf16 v[32:35], v[4:7], v[60:67], v74
  ds_read_b128 v[0:3], v76 offset:9728
  v_smfmac_f32_16x16x64_bf16 v[28:31], v[8:11], v[208:215], v74
  ds_read_b128 v[60:63], v76 offset:59392
  v_smfmac_f32_16x16x64_bf16 v[32:35], v[8:11], v[216:223], v74
  ds_read_b128 v[64:67], v76 offset:60416
  s_waitcnt lgkmcnt(5)
  v_smfmac_f32_16x16x64_bf16 v[20:23], v[12:15], v[144:151], v74
  s_barrier
  ds_read_b128 v[4:7], v76 offset:11776
  s_waitcnt lgkmcnt(4)
  v_smfmac_f32_16x16x64_bf16 v[28:31], v[12:15], v[36:43], v74
  ds_read_b128 v[8:11], v76 offset:12800
  ds_read_b128 v[36:39], v75 offset:8192
  v_smfmac_f32_16x16x64_bf16 v[24:27], v[12:15], v[152:159], v74
  ds_read_b128 v[16:19], v76 offset:10752
  s_waitcnt lgkmcnt(6)
  v_smfmac_f32_16x16x64_bf16 v[20:23], v[0:3], v[160:167], v74
  ds_read_b128 v[40:43], v75 offset:9216
  s_waitcnt lgkmcnt(5)
  v_smfmac_f32_16x16x64_bf16 v[32:35], v[12:15], v[60:67], v74
  ds_read_b128 v[60:63], v75 offset:10240
  v_smfmac_f32_16x16x64_bf16 v[24:27], v[0:3], v[168:175], v74
  ds_read_b128 v[64:67], v75 offset:11264
  s_waitcnt lgkmcnt(6)
  v_smfmac_f32_16x16x64_bf16 v[20:23], v[4:7], v[176:183], v74
  s_waitcnt lgkmcnt(5)
  v_smfmac_f32_16x16x64_bf16 v[20:23], v[8:11], v[192:199], v74
  s_waitcnt lgkmcnt(2)
  v_smfmac_f32_16x16x64_bf16 v[20:23], v[16:19], v[36:43], v74
  ds_read_b128 v[36:39], v75 offset:24576
  v_smfmac_f32_16x16x64_bf16 v[24:27], v[4:7], v[184:191], v74
  ds_read_b128 v[40:43], v75 offset:25600
  s_waitcnt lgkmcnt(2)
  v_smfmac_f32_16x16x64_bf16 v[24:27], v[16:19], v[60:67], v74
  ds_read_b128 v[60:63], v75 offset:26624
  v_add_f32 v20, v20, v22
  v_smfmac_f32_16x16x64_bf16 v[24:27], v[8:11], v[200:207], v74
  ds_read_b128 v[64:67], v75 offset:27648
  v_add_f32 v21, v21, v23
  v_smfmac_f32_16x16x64_bf16 v[28:31], v[16:19], v[240:247], v74
  v_mov_b64 v[70:71], s[78:79]
  v_smfmac_f32_16x16x64_bf16 v[28:31], v[4:7], a[0:7], v74
  s_waitcnt lgkmcnt(2)
  v_add_f32 v24, v24, v26
  v_smfmac_f32_16x16x64_bf16 v[28:31], v[0:3], v[36:43], v74
  ds_read_b128 v[36:39], v68
  v_cvt_pk_bf16_f32 v22, v20, v24
  v_smfmac_f32_16x16x64_bf16 v[28:31], v[8:11], a[16:23], v74
  ds_read_b128 v[40:43], v68
  ds_write_b32 v79, v22 offset:0
  s_waitcnt lgkmcnt(3)
  v_add_f32 v25, v25, v27
  v_cvt_pk_bf16_f32 v23, v21, v25
  v_smfmac_f32_16x16x64_bf16 v[32:35], v[0:3], v[60:67], v74
  ds_write_b32 v79, v23 offset:576
  v_cmp_u_f32 vcc, v20, v21
  v_smfmac_f32_16x16x64_bf16 v[32:35], v[16:19], v[248:255], v74
  v_add_f32 v28, v28, v30
  v_smfmac_f32_16x16x64_bf16 v[32:35], v[4:7], a[8:15], v74
  v_add_f32 v29, v29, v31
  v_smfmac_f32_16x16x64_bf16 v[32:35], v[8:11], a[24:31], v74
  s_cbranch_vccnz Cs2_rec
Cs2_recok:
  s_waitcnt lgkmcnt(3)
  v_smfmac_f32_16x16x64_bf16 v[36:39], v[16:19], a[128:135], v74
  s_waitcnt lgkmcnt(0)
  s_barrier
  ds_read_b128 v[60:63], v77
  v_smfmac_f32_16x16x64_bf16 v[40:43], v[16:19], a[136:143], v74
  ds_read_b128 v[64:67], v77 offset:128
  v_add_f32 v32, v32, v34
  v_cvt_pk_bf16_f32 v30, v28, v32
  v_smfmac_f32_16x16x64_bf16 v[36:39], v[0:3], a[112:119], v74
  ds_write_b32 v79, v30 offset:256
  v_add_f32 v33, v33, v35
  v_cvt_pk_bf16_f32 v31, v29, v33
  v_smfmac_f32_16x16x64_bf16 v[40:43], v[0:3], a[120:127], v74
  ds_write_b32 v79, v31 offset:832
  v_xor_b32 v75, 0x8000, v75
  v_smfmac_f32_16x16x64_bf16 v[36:39], v[4:7], a[144:151], v74
  ds_read_b128 v[0:3], v76 offset:4608
  v_mov_b32 v29, 0
  v_smfmac_f32_16x16x64_bf16 v[40:43], v[4:7], a[152:159], v74
  s_waitcnt vmcnt(2) lgkmcnt(3)
  v_mov_b32 v30, 0
  v_mfma_f32_16x16x32_bf16 v[44:47], v[44:47], v[60:63], 0
  ds_read_b128 v[4:7], v76 offset:5632
  s_waitcnt lgkmcnt(2)
  v_mfma_f32_16x16x32_bf16 v[44:47], v[48:51], v[64:67], v[44:47]
  s_barrier
  v_smfmac_f32_16x16x64_bf16 v[36:39], v[8:11], a[160:167], v74
  ds_read_b128 v[20:23], v77 offset:256
  ds_read_b128 v[24:27], v77 offset:384
  v_smfmac_f32_16x16x64_bf16 v[40:43], v[8:11], a[168:175], v74
  ds_read_b128 v[8:11], v76 offset:6656
  v_add_f32_dpp v72, v46, v44 quad_perm:[2,3,0,1] row_mask:0xf bank_mask:0xf
  v_add_f32_dpp v73, v47, v45 quad_perm:[2,3,0,1] row_mask:0xf bank_mask:0xf
  v_smfmac_f32_16x16x64_bf16 v[36:39], v[12:15], a[96:103], v74
  s_waitcnt lgkmcnt(4)
  v_exp_f32_dpp v72, v72 quad_perm:[0,1,0,1] row_mask:0xf bank_mask:0xf
  v_smfmac_f32_16x16x64_bf16 v[40:43], v[12:15], a[104:111], v74
  ds_read_b128 v[12:15], v76 offset:7680
  v_exp_f32_dpp v73, v73 quad_perm:[0,1,0,1] row_mask:0xf bank_mask:0xf
  v_smfmac_f32_16x16x64_bf16 v[36:39], v[0:3], a[32:39], v74
  s_waitcnt lgkmcnt(2)
  v_cvt_pk_bf16_f32 v72, v72, v73
  v_mfma_f32_16x16x32_bf16 v[20:23], v[20:23], v[60:63], 0
  ds_write_b32 v78, v72 offset:520
  v_mov_b64 v[16:17], 0
  v_mfma_f32_16x16x32_bf16 v[20:23], v[24:27], v[64:67], v[20:23]
  ds_read_b128 v[44:47], v75 offset:40960
  v_mov_b64 v[18:19], 0
  v_smfmac_f32_16x16x64_bf16 v[40:43], v[0:3], a[40:47], v74
  ds_read_b128 v[48:51], v75 offset:41984
  v_mov_b64 v[68:69], s[78:79]
  v_smfmac_f32_16x16x64_bf16 v[36:39], v[4:7], a[48:55], v74
  s_waitcnt lgkmcnt(4)
  v_add_f32_dpp v24, v22, v20 quad_perm:[2,3,0,1] row_mask:0xf bank_mask:0xf
  v_add_f32_dpp v25, v23, v21 quad_perm:[2,3,0,1] row_mask:0xf bank_mask:0xf
  v_smfmac_f32_16x16x64_bf16 v[36:39], v[8:11], a[64:71], v74
  s_waitcnt lgkmcnt(2)
  s_barrier
  ds_read_b128 v[32:35], v78 offset:512
  v_smfmac_f32_16x16x64_bf16 v[36:39], v[12:15], a[80:87], v74
  ds_read_b128 v[60:63], v75 offset:24576
  v_mul_f32 v24, s69, v24
  v_smfmac_f32_16x16x64_bf16 v[40:43], v[4:7], a[56:63], v74
  ds_read_b128 v[64:67], v75 offset:25600
  v_mul_f32 v25, s69, v25
  v_smfmac_f32_16x16x64_bf16 v[40:43], v[8:11], a[72:79], v74
  v_exp_f32_dpp v24, v24 quad_perm:[0,1,0,1] row_mask:0xf bank_mask:0xf
  v_smfmac_f32_16x16x64_bf16 v[40:43], v[12:15], a[88:95], v74
  s_waitcnt lgkmcnt(2)
  v_exp_f32_dpp v25, v25 quad_perm:[0,1,0,1] row_mask:0xf bank_mask:0xf
  v_mfma_f32_16x16x32_bf16 v[8:11], v[32:35], v[68:71], 0
  v_add_f32 v36, v36, v38
  v_add_f32 v37, v37, v39
  v_mfma_f32_16x16x32_bf16 v[0:3], v[32:35], v[52:55], 0
  v_add_f32 v40, v40, v42
  v_add_f32 v41, v41, v43
  v_mfma_f32_16x16x32_bf16 v[4:7], v[32:35], v[56:59], 0
  v_cvt_pk_bf16_f32 v28, v24, v25
  v_cvt_pk_bf16_f32 v72, v36, v37
  v_cvt_pk_bf16_f32 v73, v40, v41
  v_mfma_f32_16x16x16_bf16 v[8:11], v[28:29], v[68:69], v[8:11]
  v_cvt_pk_bf16_f32 v31, v24, v25
  v_mov_b64 v[20:21], 0
  v_mfma_f32_16x16x16_bf16 v[0:3], v[28:29], v[72:73], v[0:3]
  ds_read_b128 v[52:55], v75 offset:26624
  v_mov_b64 v[22:23], 0
  v_mfma_f32_16x16x16_bf16 v[4:7], v[30:31], v[72:73], v[4:7]
  v_rcp_f32 v10, v8
  v_rcp_f32 v11, v9
  v_mul_f32 v0, v10, v0
  v_mul_f32 v1, v11, v1
  v_max3_f32 v8, v8, v9, v10
  v_mul_f32 v4, v10, v4
  v_mul_f32 v5, v11, v5
  v_cvt_pk_bf16_f32 v2, v0, v4
  ds_write_b32 v79, v2 offset:8704
  v_cvt_pk_bf16_f32 v3, v1, v5
  ds_write_b32 v79, v3 offset:9280
  ds_read_b128 v[12:15], v78 offset:8832
  v_max_f32 v8, v8, v11
  v_cmp_le_f32 vcc, 1317011456, v8
  v_mov_b64 v[24:25], 0
  v_mov_b64 v[26:27], 0
  ds_read_b128 v[56:59], v75 offset:27648
  s_cbranch_vccnz Cs2_mx
Cs2_mxok:
  s_waitcnt lgkmcnt(2)
  s_barrier
  ds_read_b128 v[0:3], v78 offset:8896
  s_waitcnt lgkmcnt(2)
  v_smfmac_f32_16x16x64_bf16 v[16:19], v[12:15], a[176:183], v74
  ds_read_b128 v[4:7], v78 offset:8704
  v_smfmac_f32_16x16x64_bf16 v[20:23], v[12:15], v[44:51], v74
  ds_read_b128 v[8:11], v78 offset:8768
  v_smfmac_f32_16x16x64_bf16 v[24:27], v[12:15], a[224:231], v74
  ds_read_b128 v[36:39], v75 offset:43008
  s_waitcnt lgkmcnt(3)
  v_smfmac_f32_16x16x64_bf16 v[16:19], v[0:3], a[184:191], v74
  ds_read_b128 v[40:43], v75 offset:44032
  s_waitcnt lgkmcnt(3)
  v_smfmac_f32_16x16x64_bf16 v[16:19], v[4:7], v[60:67], v74
  ds_read_b128 v[68:71], v76 offset:13824
  s_waitcnt lgkmcnt(3)
  v_smfmac_f32_16x16x64_bf16 v[16:19], v[8:11], v[52:59], v74
  ds_read_b128 v[44:47], v75 offset:57344
  v_smfmac_f32_16x16x64_bf16 v[20:23], v[4:7], a[192:199], v74
  ds_read_b128 v[48:51], v75 offset:58368
  v_smfmac_f32_16x16x64_bf16 v[20:23], v[8:11], a[200:207], v74
  ds_read_b128 v[60:63], v75 offset:59392
  s_waitcnt lgkmcnt(4)
  v_cvt_pk_bf16_f32 v16, v16, v17
  v_cvt_pk_bf16_f32 v17, v18, v19
  v_bfi_b32 v16, 1, s72, v16
  v_smfmac_f32_16x16x64_bf16 v[20:23], v[0:3], v[36:43], v74
  s_waitcnt lgkmcnt(3)
  buffer_store_dwordx2 v[16:17], v68, s[8:11], s73 offen sc1
  v_mov_b64 v[32:33], 0
  v_smfmac_f32_16x16x64_bf16 v[24:27], v[4:7], a[208:215], v74
  ds_read_b128 v[64:67], v75 offset:60416
  v_mov_b64 v[34:35], 0
  v_smfmac_f32_16x16x64_bf16 v[24:27], v[8:11], a[216:223], v74
  ds_read_b128 v[52:55], v75 offset:0
  v_cvt_pk_bf16_f32 v20, v20, v21
  v_cvt_pk_bf16_f32 v21, v22, v23
  v_bfi_b32 v20, 1, s72, v20
  v_smfmac_f32_16x16x64_bf16 v[24:27], v[0:3], a[232:239], v74
  ds_read_b128 v[56:59], v75 offset:1024
  buffer_store_dwordx2 v[20:21], v68, s[8:11], s74 offen sc1
  s_waitcnt lgkmcnt(4)
  v_mov_b64 v[28:29], 0
  v_smfmac_f32_16x16x64_bf16 v[32:35], v[4:7], v[44:51], v74
  ds_read_b128 v[36:39], v75 offset:2048
  ds_read_b128 v[40:43], v75 offset:3072
  s_waitcnt lgkmcnt(4)
  v_smfmac_f32_16x16x64_bf16 v[32:35], v[8:11], v[60:67], v74
  ds_read_b128 v[44:47], v75 offset:4096
  v_cvt_pk_bf16_f32 v24, v24, v25
  v_cvt_pk_bf16_f32 v25, v26, v27
  v_bfi_b32 v24, 1, s72, v24
  v_smfmac_f32_16x16x64_bf16 v[32:35], v[12:15], a[240:247], v74
  ds_read_b128 v[48:51], v75 offset:5120
  buffer_store_dwordx2 v[24:25], v68, s[8:11], s75 offen sc1
  v_mov_b64 v[30:31], 0
  v_smfmac_f32_16x16x64_bf16 v[32:35], v[0:3], a[248:255], v74
  ds_read_b128 v[60:63], v75 offset:6144
  ds_read_b128 v[64:67], v75 offset:7168
  s_waitcnt lgkmcnt(6)
  v_smfmac_f32_16x16x64_bf16 v[28:31], v[4:7], v[52:59], v74
  s_waitcnt lgkmcnt(4)
  v_smfmac_f32_16x16x64_bf16 v[28:31], v[8:11], v[36:43], v74
  s_waitcnt lgkmcnt(2)
  v_cvt_pk_bf16_f32 v32, v32, v33
  v_cvt_pk_bf16_f32 v33, v34, v35
  v_bfi_b32 v32, 1, s72, v32
  v_smfmac_f32_16x16x64_bf16 v[28:31], v[12:15], v[44:51], v74
  buffer_store_dwordx2 v[32:33], v68, s[8:11], s76 offen sc1
  s_waitcnt lgkmcnt(0)
  v_smfmac_f32_16x16x64_bf16 v[28:31], v[0:3], v[60:67], v74
  v_mov_b64 v[18:19], v[72:73]
  s_nop 4
  v_cvt_pk_bf16_f32 v28, v28, v29
  v_cvt_pk_bf16_f32 v29, v30, v31
  v_bfi_b32 v28, 1, s72, v28
  buffer_store_dwordx2 v[28:29], v68, s[8:11], s77 offen sc1
  ds_read_b128 v[0:3], v76 offset:14848
  s_waitcnt lgkmcnt(0)
  ds_read_b64 v[16:17], v77 offset:384
  s_waitcnt lgkmcnt(0)
  ds_read_b128 v[64:67], v76 offset:27648
  s_waitcnt lgkmcnt(0)
  ds_read_b128 v[60:63], v76 offset:26624
  s_waitcnt lgkmcnt(0)
  v_xor_b32 v75, 0x8000, v75
  v_mov_b64 v[28:29], 0
  v_mov_b64 v[30:31], 0
  v_mov_b64 v[32:33], 0
  v_mov_b64 v[34:35], 0
  s_waitcnt vmcnt(0)
  buffer_load_dwordx4 v[52:55], v76, s[8:11], s60 offen offset:0 sc1
  buffer_load_dwordx4 v[56:59], v76, s[8:11], s60 offen offset:1024 sc1
  s_add_u32 s66, s66, 1
  s_xor_b32 s64, s64, 16384
  s_xor_b32 s65, s65, 16384
  s_add_u32 s58, s58, 655360
  s_add_u32 s59, s59, 655360
  s_add_u32 s70, s70, 655360
  s_add_u32 s68, s68, 655360
  s_mov_b32 m0, 12800
  s_add_u32 s85, s65, 8192
  s_waitcnt lgkmcnt(0)
  s_waitcnt vmcnt(1)
  v_mfma_f32_16x16x32_bf16 v[4:7], v[0:3], v[52:55], 0
  v_bitop3_b32 v72, v52, v54, s72 bitop3:0x7e
  s_waitcnt vmcnt(0)
  v_mfma_f32_16x16x32_bf16 v[4:7], v[0:3], v[56:59], v[4:7]
  v_bitop3_b32 v73, v56, v58, s72 bitop3:0x7e
  v_bitop3_b32 v72, v72, v73, 1 bitop3:0xa8
  v_cmp_ne_u32 vcc, 0, v72
  s_cbranch_vccnz Cs2_h1r
  s_nop 2
  v_add_f32_dpp v4, v4, v4 row_ror:4 row_mask:0xf bank_mask:0xf
  v_add_f32_dpp v5, v5, v5 row_ror:4 row_mask:0xf bank_mask:0xf
  s_nop 0
  v_add_f32_dpp v4, v4, v4 row_ror:8 row_mask:0xf bank_mask:0xf
  v_add_f32_dpp v5, v5, v5 row_ror:8 row_mask:0xf bank_mask:0xf
  v_cvt_pk_bf16_f32 v4, v4, v5
  buffer_store_dword v4, v69, s[8:11], s62 offen sc1
  s_xor_b32 s62, s62, 16384
  buffer_store_dword v71, v69, s[8:11], s62 offen sc1
  s_xor_b32 s72, s72, 1
  s_branch Cs2_h2
Cs2_h1r:
  s_mov_b64 exec, vcc
  buffer_load_dwordx4 v[52:55], v76, s[8:11], s60 offen offset:0 sc1
  buffer_load_dwordx4 v[56:59], v76, s[8:11], s60 offen offset:1024 sc1
  s_mov_b64 exec, -1
  s_add_u32 s67, s67, 1
  s_waitcnt vmcnt(1)
  v_mfma_f32_16x16x32_bf16 v[4:7], v[0:3], v[52:55], 0
  v_bitop3_b32 v72, v52, v54, s72 bitop3:0x7e
  s_waitcnt vmcnt(0)
  v_mfma_f32_16x16x32_bf16 v[4:7], v[0:3], v[56:59], v[4:7]
  v_bitop3_b32 v73, v56, v58, s72 bitop3:0x7e
  v_bitop3_b32 v72, v72, v73, 1 bitop3:0xa8
  v_cmp_ne_u32 vcc, 0, v72
  s_cbranch_vccz Cs2_h1p
Cs2_h1s:
  s_mov_b64 exec, vcc
  buffer_load_dwordx4 v[52:55], v76, s[8:11], s60 offen offset:0 sc1
  buffer_load_dwordx4 v[56:59], v76, s[8:11], s60 offen offset:1024 sc1
  s_mov_b64 exec, -1
  s_add_u32 s67, s67, 1
  s_waitcnt vmcnt(1)
  v_mfma_f32_16x16x32_bf16 v[4:7], v[0:3], v[52:55], 0
  v_bitop3_b32 v72, v52, v54, s72 bitop3:0x7e
  s_waitcnt vmcnt(0)
  v_mfma_f32_16x16x32_bf16 v[4:7], v[0:3], v[56:59], v[4:7]
  v_bitop3_b32 v73, v56, v58, s72 bitop3:0x7e
  v_bitop3_b32 v72, v72, v73, 1 bitop3:0xa8
  v_cmp_ne_u32 vcc, 0, v72
  s_cbranch_vccz Cs2_h1p
  s_cmp_lt_u32 s67, 131072
  s_cbranch_scc1 Cs2_h1s
Cs2_h1p:
  s_nop 2
  v_add_f32_dpp v4, v4, v4 row_ror:4 row_mask:0xf bank_mask:0xf
  v_add_f32_dpp v5, v5, v5 row_ror:4 row_mask:0xf bank_mask:0xf
  s_nop 0
  v_add_f32_dpp v4, v4, v4 row_ror:8 row_mask:0xf bank_mask:0xf
  v_add_f32_dpp v5, v5, v5 row_ror:8 row_mask:0xf bank_mask:0xf
  v_cvt_pk_bf16_f32 v4, v4, v5
  buffer_store_dword v4, v69, s[8:11], s62 offen sc1
  s_xor_b32 s62, s62, 16384
  buffer_store_dword v71, v69, s[8:11], s62 offen sc1
  s_xor_b32 s72, s72, 1
  s_branch Cs2_h2
Cs2_rec:
  s_nop 7
  s_waitcnt vmcnt(0) lgkmcnt(0)
  v_max3_u32 v72, v0, v1, v2
  v_max3_u32 v72, v72, v3, v4
  v_max3_u32 v72, v72, v5, v6
  v_max3_u32 v72, v72, v7, v8
  v_max3_u32 v72, v72, v9, v10
  v_max3_u32 v72, v72, v11, v12
  v_max3_u32 v72, v72, v13, v14
  v_max3_u32 v72, v72, v15, v16
  v_max3_u32 v72, v72, v17, v18
  v_max_u32 v72, v72, v19
  v_cmp_eq_u32 vcc, -1, v72
  s_cbranch_vccz Cs2_recok
  s_barrier
Cs2_recp:
  buffer_load_dwordx4 v[0:3], v76, s[8:11], s64 offen offset:0 sc1
  buffer_load_dwordx4 v[4:7], v76, s[8:11], s64 offen offset:1024 sc1
  s_add_u32 s67, s67, 1
  s_cmp_lt_u32 s67, 131072
  s_cselect_b32 s54, -2, -1
  s_waitcnt vmcnt(1)
  v_max3_u32 v72, v0, v1, v2
  s_waitcnt vmcnt(0)
  v_max3_u32 v72, v72, v3, v4
  v_max3_u32 v72, v72, v5, v6
  v_max_u32 v72, v72, v7
  v_cmp_lt_u32 vcc, s54, v72
  s_cbranch_vccnz Cs2_recp
  ds_write_b128 v76, v[0:3] offset:8704
  ds_write_b128 v76, v[4:7] offset:9728
  v_mov_b64 v[20:21], 0
  v_mov_b64 v[22:23], 0
  v_mov_b64 v[24:25], 0
  v_mov_b64 v[26:27], 0
  v_mov_b64 v[28:29], 0
  v_mov_b64 v[30:31], 0
  v_mov_b64 v[32:33], 0
  v_mov_b64 v[34:35], 0
  s_waitcnt lgkmcnt(0)
  s_barrier
  ds_read_b128 v[0:3], v76 offset:4608
  s_waitcnt lgkmcnt(0)
  v_smfmac_f32_16x16x64_bf16 v[20:23], v[0:3], v[80:87], v74
  v_smfmac_f32_16x16x64_bf16 v[24:27], v[0:3], v[88:95], v74
  ds_read_b128 v[60:63], v76 offset:24576
  ds_read_b128 v[64:67], v76 offset:25600
  s_waitcnt lgkmcnt(0)
  v_smfmac_f32_16x16x64_bf16 v[28:31], v[0:3], v[60:67], v74
  ds_read_b128 v[60:63], v76 offset:26624
  ds_read_b128 v[64:67], v76 offset:27648
  s_waitcnt lgkmcnt(0)
  v_smfmac_f32_16x16x64_bf16 v[32:35], v[0:3], v[60:67], v74
  ds_read_b128 v[4:7], v76 offset:5632
  s_waitcnt lgkmcnt(0)
  v_smfmac_f32_16x16x64_bf16 v[20:23], v[4:7], v[96:103], v74
  v_smfmac_f32_16x16x64_bf16 v[24:27], v[4:7], v[104:111], v74
  ds_read_b128 v[60:63], v76 offset:40960
  ds_read_b128 v[64:67], v76 offset:41984
  s_waitcnt lgkmcnt(0)
  v_smfmac_f32_16x16x64_bf16 v[28:31], v[4:7], v[60:67], v74
  ds_read_b128 v[60:63], v76 offset:43008
  ds_read_b128 v[64:67], v76 offset:44032
  s_waitcnt lgkmcnt(0)
  v_smfmac_f32_16x16x64_bf16 v[32:35], v[4:7], v[60:67], v74
  ds_read_b128 v[8:11], v76 offset:6656
  s_waitcnt lgkmcnt(0)
  v_smfmac_f32_16x16x64_bf16 v[20:23], v[8:11], v[112:119], v74
  v_smfmac_f32_16x16x64_bf16 v[24:27], v[8:11], v[120:127], v74
  v_smfmac_f32_16x16x64_bf16 v[28:31], v[8:11], v[208:215], v74
  v_smfmac_f32_16x16x64_bf16 v[32:35], v[8:11], v[216:223], v74
  ds_read_b128 v[12:15], v76 offset:7680
  s_waitcnt lgkmcnt(0)
  v_smfmac_f32_16x16x64_bf16 v[20:23], v[12:15], v[128:135], v74
  v_smfmac_f32_16x16x64_bf16 v[24:27], v[12:15], v[136:143], v74
  v_smfmac_f32_16x16x64_bf16 v[28:31], v[12:15], v[224:231], v74
  v_smfmac_f32_16x16x64_bf16 v[32:35], v[12:15], v[232:239], v74
  ds_read_b128 v[12:15], v76 offset:8704
  s_waitcnt lgkmcnt(0)
  v_smfmac_f32_16x16x64_bf16 v[20:23], v[12:15], v[144:151], v74
  v_smfmac_f32_16x16x64_bf16 v[24:27], v[12:15], v[152:159], v74
  ds_read_b128 v[60:63], v76 offset:57344
  ds_read_b128 v[64:67], v76 offset:58368
  s_waitcnt lgkmcnt(0)
  v_smfmac_f32_16x16x64_bf16 v[28:31], v[12:15], v[60:67], v74
  ds_read_b128 v[60:63], v76 offset:59392
  ds_read_b128 v[64:67], v76 offset:60416
  s_waitcnt lgkmcnt(0)
  v_smfmac_f32_16x16x64_bf16 v[32:35], v[12:15], v[60:67], v74
  ds_read_b128 v[0:3], v76 offset:9728
  s_waitcnt lgkmcnt(0)
  v_smfmac_f32_16x16x64_bf16 v[20:23], v[0:3], v[160:167], v74
  v_smfmac_f32_16x16x64_bf16 v[24:27], v[0:3], v[168:175], v74
  ds_read_b128 v[60:63], v75 offset:24576
  ds_read_b128 v[64:67], v75 offset:25600
  s_waitcnt lgkmcnt(0)
  v_smfmac_f32_16x16x64_bf16 v[28:31], v[0:3], v[60:67], v74
  ds_read_b128 v[60:63], v75 offset:26624
  ds_read_b128 v[64:67], v75 offset:27648
  s_waitcnt lgkmcnt(0)
  v_smfmac_f32_16x16x64_bf16 v[32:35], v[0:3], v[60:67], v74
  ds_read_b128 v[16:19], v76 offset:10752
  ds_read_b128 v[60:63], v75 offset:8192
  ds_read_b128 v[64:67], v75 offset:9216
  s_waitcnt lgkmcnt(0)
  v_smfmac_f32_16x16x64_bf16 v[20:23], v[16:19], v[60:67], v74
  ds_read_b128 v[60:63], v75 offset:10240
  ds_read_b128 v[64:67], v75 offset:11264
  s_waitcnt lgkmcnt(0)
  v_smfmac_f32_16x16x64_bf16 v[24:27], v[16:19], v[60:67], v74
  v_smfmac_f32_16x16x64_bf16 v[28:31], v[16:19], v[240:247], v74
  v_smfmac_f32_16x16x64_bf16 v[32:35], v[16:19], v[248:255], v74
  ds_read_b128 v[4:7], v76 offset:11776
  s_waitcnt lgkmcnt(0)
  v_smfmac_f32_16x16x64_bf16 v[20:23], v[4:7], v[176:183], v74
  v_smfmac_f32_16x16x64_bf16 v[24:27], v[4:7], v[184:191], v74
  v_smfmac_f32_16x16x64_bf16 v[28:31], v[4:7], a[0:7], v74
  v_smfmac_f32_16x16x64_bf16 v[32:35], v[4:7], a[8:15], v74
  ds_read_b128 v[8:11], v76 offset:12800
  s_waitcnt lgkmcnt(0)
  v_smfmac_f32_16x16x64_bf16 v[20:23], v[8:11], v[192:199], v74
  v_smfmac_f32_16x16x64_bf16 v[24:27], v[8:11], v[200:207], v74
  v_smfmac_f32_16x16x64_bf16 v[28:31], v[8:11], a[16:23], v74
  v_smfmac_f32_16x16x64_bf16 v[32:35], v[8:11], a[24:31], v74
  v_add_f32 v20, v20, v22
  v_add_f32 v21, v21, v23
  v_add_f32 v24, v24, v26
  v_cvt_pk_bf16_f32 v22, v20, v24
  ds_write_b32 v79, v22 offset:0
  v_add_f32 v25, v25, v27
  v_cvt_pk_bf16_f32 v23, v21, v25
  ds_write_b32 v79, v23 offset:576
  v_add_f32 v28, v28, v30
  v_add_f32 v29, v29, v31
  s_waitcnt lgkmcnt(0)
  s_nop 1
  s_branch Cs2_recok
Cs2_mx:
  s_waitcnt lgkmcnt(0)
  s_barrier
  buffer_load_dwordx4 v[52:55], v76, s[8:11], s59 offen offset:0 sc1
  buffer_load_dwordx4 v[0:3], v76, s[8:11], s58 offen offset:0 sc1
  ds_read_b128 v[20:23], v77 offset:0
  ds_read_b128 v[28:31], v77 offset:256
  buffer_load_dwordx4 v[56:59], v76, s[8:11], s59 offen offset:1024 sc1
  buffer_load_dwordx4 v[4:7], v76, s[8:11], s58 offen offset:1024 sc1
  ds_read_b128 v[24:27], v77 offset:128
  ds_read_b128 v[32:35], v77 offset:384
  s_waitcnt vmcnt(2) lgkmcnt(3)
  v_mfma_f32_16x16x32_bf16 v[8:11], v[0:3], v[20:23], 0
  s_waitcnt vmcnt(0) lgkmcnt(1)
  v_mfma_f32_16x16x32_bf16 v[8:11], v[4:7], v[24:27], v[8:11]
  v_mfma_f32_16x16x32_bf16 v[12:15], v[28:31], v[20:23], 0
  s_waitcnt lgkmcnt(0)
  v_mfma_f32_16x16x32_bf16 v[12:15], v[32:35], v[24:27], v[12:15]
  v_add_f32_dpp v8, v10, v8 quad_perm:[2,3,0,1] row_mask:0xf bank_mask:0xf
  v_add_f32_dpp v9, v11, v9 quad_perm:[2,3,0,1] row_mask:0xf bank_mask:0xf
  s_nop 0
  v_mov_b32_dpp v8, v8 quad_perm:[0,1,0,1] row_mask:0xf bank_mask:0xf
  v_mov_b32_dpp v9, v9 quad_perm:[0,1,0,1] row_mask:0xf bank_mask:0xf
  s_nop 1
  v_add_f32_dpp v12, v14, v12 quad_perm:[2,3,0,1] row_mask:0xf bank_mask:0xf
  v_add_f32_dpp v13, v15, v13 quad_perm:[2,3,0,1] row_mask:0xf bank_mask:0xf
  s_nop 0
  v_mov_b32_dpp v12, v12 quad_perm:[0,1,0,1] row_mask:0xf bank_mask:0xf
  v_mov_b32_dpp v13, v13 quad_perm:[0,1,0,1] row_mask:0xf bank_mask:0xf
  v_mul_f32 v12, s69, v12
  ds_write_b32 v78, v8 offset:8712
  v_mul_f32 v13, s69, v13
  ds_write_b32 v78, v9 offset:8776
  s_waitcnt lgkmcnt(0)
  s_barrier
  ds_read_b128 v[36:39], v78 offset:8704
  ds_read_b128 v[40:43], v78 offset:8768
  s_waitcnt lgkmcnt(0)
  s_barrier
  v_max_f32 v16, v36, v37
  v_max3_f32 v16, v16, v38, v39
  v_max3_f32 v16, v16, v40, v41
  v_max3_f32 v16, v16, v42, v43
  v_max3_f32 v16, v16, v12, v13
  v_mov_b32 v17, v16
  s_nop 1
  v_permlane16_swap_b32 v16, v17
  v_max_f32 v16, v16, v17
  v_mov_b32 v17, v16
  s_nop 1
  v_permlane32_swap_b32 v16, v17
  v_max_f32 v16, v16, v17
  v_sub_f32 v36, v36, v16
  v_sub_f32 v37, v37, v16
  v_sub_f32 v38, v38, v16
  v_sub_f32 v39, v39, v16
  v_sub_f32 v40, v40, v16
  v_sub_f32 v41, v41, v16
  v_sub_f32 v42, v42, v16
  v_sub_f32 v43, v43, v16
  v_sub_f32 v12, v12, v16
  v_sub_f32 v13, v13, v16
  v_exp_f32 v36, v36
  v_exp_f32 v37, v37
  v_exp_f32 v38, v38
  v_exp_f32 v39, v39
  v_exp_f32 v40, v40
  v_exp_f32 v41, v41
  v_exp_f32 v42, v42
  v_exp_f32 v43, v43
  v_exp_f32 v12, v12
  v_exp_f32 v13, v13
  v_cvt_pk_bf16_f32 v32, v36, v40
  v_cvt_pk_bf16_f32 v33, v37, v41
  v_cvt_pk_bf16_f32 v34, v38, v42
  v_cvt_pk_bf16_f32 v35, v39, v43
  v_cvt_pk_bf16_f32 v28, v12, v13
  v_cvt_pk_bf16_f32 v31, v12, v13
  v_mov_b32 v29, 0
  v_mov_b32 v30, 0
  v_mfma_f32_16x16x32_bf16 v[8:11], v[32:35], v[68:71], 0
  v_mfma_f32_16x16x32_bf16 v[0:3], v[32:35], v[52:55], 0
  v_mfma_f32_16x16x32_bf16 v[4:7], v[32:35], v[56:59], 0
  v_mfma_f32_16x16x16_bf16 v[8:11], v[28:29], v[68:69], v[8:11]
  v_mfma_f32_16x16x16_bf16 v[0:3], v[28:29], v[72:73], v[0:3]
  v_mfma_f32_16x16x16_bf16 v[4:7], v[30:31], v[72:73], v[4:7]
  ds_read_b128 v[52:55], v75 offset:26624
  v_rcp_f32 v10, v8
  v_rcp_f32 v11, v9
  v_mul_f32 v0, v10, v0
  v_mul_f32 v1, v11, v1
  v_max3_f32 v8, v8, v9, v10
  v_mul_f32 v4, v10, v4
  v_mul_f32 v5, v11, v5
  v_cvt_pk_bf16_f32 v2, v0, v4
  ds_write_b32 v79, v2 offset:8704
  v_cvt_pk_bf16_f32 v3, v1, v5
  ds_write_b32 v79, v3 offset:9280
  ds_read_b128 v[12:15], v78 offset:8832
  ds_read_b128 v[56:59], v75 offset:27648
  v_mov_b64 v[16:17], 0
  v_mov_b64 v[18:19], 0
  v_mov_b64 v[20:21], 0
  v_mov_b64 v[22:23], 0
  v_mov_b64 v[24:25], 0
  v_mov_b64 v[26:27], 0
  s_branch Cs2_mxok
Cs2_last:
  ds_read_b128 v[4:7], v76 offset:5632
  ds_read_b128 v[8:11], v76 offset:6656
  ds_read_b128 v[44:47], v76 offset:40960
  ds_read_b128 v[48:51], v76 offset:41984
  s_nop 5
  v_mov_b64 v[20:21], 0
  v_mov_b64 v[22:23], 0
  v_mov_b64 v[24:25], 0
  v_mov_b64 v[26:27], 0
  s_waitcnt lgkmcnt(4)
  v_smfmac_f32_16x16x64_bf16 v[28:31], v[0:3], v[36:43], v74
  ds_read_b128 v[36:39], v76 offset:43008
  ds_read_b128 v[40:43], v76 offset:44032
  v_smfmac_f32_16x16x64_bf16 v[32:35], v[0:3], v[60:67], v74
  s_waitcnt lgkmcnt(5)
  v_smfmac_f32_16x16x64_bf16 v[20:23], v[0:3], a[32:39], v74
  ds_read_b128 v[60:63], v76 offset:57344
  ds_read_b128 v[64:67], v76 offset:58368
  v_smfmac_f32_16x16x64_bf16 v[24:27], v[0:3], a[40:47], v74
  s_waitcnt lgkmcnt(4)
  v_smfmac_f32_16x16x64_bf16 v[20:23], v[4:7], a[48:55], v74
  buffer_store_dwordx4 v[16:19], v76, s[8:11], s68 offen sc1
  v_smfmac_f32_16x16x64_bf16 v[24:27], v[4:7], a[56:63], v74
  v_smfmac_f32_16x16x64_bf16 v[28:31], v[4:7], v[44:51], v74
  s_waitcnt lgkmcnt(2)
  v_smfmac_f32_16x16x64_bf16 v[20:23], v[8:11], a[64:71], v74
  ds_read_b128 v[44:47], v76 offset:59392
  ds_read_b128 v[48:51], v76 offset:60416
  v_smfmac_f32_16x16x64_bf16 v[24:27], v[8:11], a[72:79], v74
  v_smfmac_f32_16x16x64_bf16 v[32:35], v[4:7], v[36:43], v74
  v_smfmac_f32_16x16x64_bf16 v[28:31], v[8:11], v[208:215], v74
  ds_read_b128 v[36:39], v75 offset:24576
  ds_read_b128 v[40:43], v75 offset:25600
  v_smfmac_f32_16x16x64_bf16 v[32:35], v[8:11], v[216:223], v74
  v_smfmac_f32_16x16x64_bf16 v[20:23], v[12:15], a[80:87], v74
  v_smfmac_f32_16x16x64_bf16 v[24:27], v[12:15], a[88:95], v74
  v_smfmac_f32_16x16x64_bf16 v[28:31], v[12:15], v[224:231], v74
  v_smfmac_f32_16x16x64_bf16 v[32:35], v[12:15], v[232:239], v74
  s_waitcnt vmcnt(1)
  s_barrier
Cs2_lastr:
  ds_read_b128 v[12:15], v76 offset:8704
  ds_read_b128 v[0:3], v76 offset:9728
  ds_read_b128 v[16:19], v76 offset:10752
  ds_read_b128 v[4:7], v76 offset:11776
  ds_read_b128 v[8:11], v76 offset:12800
  s_waitcnt lgkmcnt(3)
  v_max3_u32 v72, v0, v1, v2
  s_waitcnt lgkmcnt(1)
  v_max3_u32 v72, v72, v3, v4
  v_max3_u32 v72, v72, v5, v6
  s_waitcnt lgkmcnt(0)
  v_max3_u32 v72, v72, v7, v8
  v_max3_u32 v72, v72, v9, v10
  v_max3_u32 v72, v72, v11, v12
  v_max3_u32 v72, v72, v13, v14
  v_max3_u32 v72, v72, v15, v16
  v_max3_u32 v72, v72, v17, v18
  v_max_u32 v72, v72, v19
  v_cmp_eq_u32 vcc, -1, v72
  s_cbranch_vccnz Cs2_lastp
Cs2_lastg:
  v_smfmac_f32_16x16x64_bf16 v[28:31], v[12:15], v[60:67], v74
  ds_read_b128 v[60:63], v75 offset:26624
  ds_read_b128 v[64:67], v75 offset:27648
  v_smfmac_f32_16x16x64_bf16 v[32:35], v[12:15], v[44:51], v74
  v_smfmac_f32_16x16x64_bf16 v[28:31], v[0:3], v[36:43], v74
  v_smfmac_f32_16x16x64_bf16 v[28:31], v[16:19], v[240:247], v74
  v_smfmac_f32_16x16x64_bf16 v[28:31], v[4:7], a[0:7], v74
  v_smfmac_f32_16x16x64_bf16 v[28:31], v[8:11], a[16:23], v74
  v_smfmac_f32_16x16x64_bf16 v[32:35], v[16:19], v[248:255], v74
  v_smfmac_f32_16x16x64_bf16 v[32:35], v[4:7], a[8:15], v74
  s_waitcnt lgkmcnt(0)
  v_smfmac_f32_16x16x64_bf16 v[32:35], v[8:11], a[24:31], v74
  v_smfmac_f32_16x16x64_bf16 v[32:35], v[0:3], v[60:67], v74
  v_smfmac_f32_16x16x64_bf16 v[20:23], v[12:15], a[96:103], v74
  v_smfmac_f32_16x16x64_bf16 v[20:23], v[0:3], a[112:119], v74
  v_add_f32 v28, v28, v30
  v_add_f32 v32, v32, v34
  v_cvt_pk_bf16_f32 v30, v28, v32
  v_smfmac_f32_16x16x64_bf16 v[20:23], v[16:19], a[128:135], v74
  ds_write_b32 v79, v30 offset:256
  v_add_f32 v29, v29, v31
  v_add_f32 v33, v33, v35
  v_cvt_pk_bf16_f32 v31, v29, v33
  v_smfmac_f32_16x16x64_bf16 v[20:23], v[4:7], a[144:151], v74
  ds_write_b32 v79, v31 offset:832
  v_smfmac_f32_16x16x64_bf16 v[20:23], v[8:11], a[160:167], v74
  v_smfmac_f32_16x16x64_bf16 v[24:27], v[12:15], a[104:111], v74
  v_smfmac_f32_16x16x64_bf16 v[24:27], v[0:3], a[120:127], v74
  v_smfmac_f32_16x16x64_bf16 v[24:27], v[16:19], a[136:143], v74
  s_waitcnt lgkmcnt(0)
  s_barrier
  ds_read_b64 v[52:53], v77 offset:384
  v_add_f32 v20, v20, v22
  v_smfmac_f32_16x16x64_bf16 v[24:27], v[4:7], a[152:159], v74
  v_add_f32 v21, v21, v23
  v_smfmac_f32_16x16x64_bf16 v[24:27], v[8:11], a[168:175], v74
  v_cvt_pk_bf16_f32 v54, v20, v21
  s_add_u32 s68, s68, 655360
  s_nop 3
  v_add_f32 v24, v24, v26
  v_add_f32 v25, v25, v27
  v_cvt_pk_bf16_f32 v55, v24, v25
  s_waitcnt lgkmcnt(0)
  buffer_store_dwordx4 v[52:55], v76, s[8:11], s68 offen sc1
  s_branch Cs2_done
Cs2_lastp:
  s_add_u32 s72, s72, 2
  s_cmp_ge_u32 s72, 131072
  s_cbranch_scc1 Cs2_lastg
  s_barrier
  buffer_load_dwordx4 v76, s[8:11], s85 offen offset:0 sc1 lds
  s_waitcnt vmcnt(0)
  s_barrier
  s_branch Cs2_lastr
Cs2_done:
  s_branch L_cexit
L_w7:
  v_mov_b64 v[20:21], 0
  v_mov_b64 v[22:23], 0
  v_mov_b64 v[24:25], 0
  v_mov_b64 v[26:27], 0
  v_mov_b64 v[28:29], 0
  v_mov_b64 v[30:31], 0
  v_mov_b64 v[32:33], 0
  v_mov_b64 v[34:35], 0
  s_mov_b32 s78, 0x3f803f80
  s_mov_b32 s79, s78
  s_mov_b32 s65, 360448
  s_mov_b32 m0, 15872
  s_lshl_b32 s71, s53, 2
  s_add_u32 s71, s71, 128
  s_movk_i32 s56, 0x1000
  v_lshlrev_b32 v73, 2, v76
  v_mov_b32 v72, 0
  s_mov_b64 s[16:17], s[8:9]
  s_mov_b32 s18, 268435456
  s_mov_b32 s19, 0x20000
  s_getpc_b64 s[20:21]
Cs3_pc:
  s_add_u32 s20, s20, (Cs3_last - Cs3_pc)
  s_addc_u32 s21, s21, 0
  v_mov_b32 v68, 14880
  buffer_load_dwordx4 v[52:55], v76, s[8:11], s59 offen offset:0 sc1
  buffer_load_dwordx4 v[56:59], v76, s[8:11], s59 offen offset:1024 sc1
  ds_read_b128 v[36:39], v76 offset:45056
  ds_read_b128 v[40:43], v76 offset:46080
  ds_read_b128 v[60:63], v76 offset:47104
  ds_read_b128 v[64:67], v76 offset:48128
  ds_read_b128 v[0:3], v76 offset:4608
  ds_read_b128 v[4:7], v76 offset:5632
  ds_read_b128 v[8:11], v76 offset:6656
  ds_read_b128 v[12:15], v76 offset:7680
  s_waitcnt lgkmcnt(0)
  s_cmp_eq_u32 s66, 1
  s_branch Cs3_top2
.p2align 6
Cs3_h2:
  v_lshlrev_b32 v73, 2, v76
  ds_read_b128 v[36:39], v76 offset:45056
  ds_read_b128 v[40:43], v76 offset:46080
  buffer_load_dwordx4 v[52:55], v76, s[8:11], s59 offen offset:0 sc1
  buffer_load_dwordx4 v[56:59], v76, s[8:11], s59 offen offset:1024 sc1
  s_waitcnt vmcnt(0)
  s_mov_b64 vcc, -1
Cs3_h2r:
  s_mov_b64 exec, vcc
  buffer_load_dwordx4 v[4:7], v76, s[8:11], s65 offen offset:1024 sc1
  buffer_load_dwordx4 v[0:3], v76, s[8:11], s85 offen offset:0 sc1
  buffer_load_dwordx4 v[8:11], v76, s[8:11], s85 offen offset:1024 sc1
  s_mov_b64 exec, -1
  s_add_u32 s67, s67, 1
  s_cmp_lt_u32 s67, 131072
  s_cselect_b32 s54, -2, -1
  s_waitcnt vmcnt(2)
  v_max3_u32 v72, v4, v5, v6
  s_waitcnt vmcnt(1)
  v_max3_u32 v72, v72, v7, v0
  v_max3_u32 v72, v72, v1, v2
  s_waitcnt vmcnt(0)
  v_max3_u32 v72, v72, v3, v8
  v_max3_u32 v72, v72, v9, v10
  v_max_u32 v72, v72, v11
  v_cmp_lt_u32 vcc, s54, v72
  s_cbranch_vccnz Cs3_h2r
  ds_write_b128 v76, v[4:7] offset:5632
  ds_write_b128 v76, v[0:3] offset:8704
  ds_write_b128 v76, v[8:11] offset:9728
Cs3_h2w:
  s_cmp_eq_u32 s66, 63
  s_waitcnt lgkmcnt(0)
  s_barrier
  ds_read_b128 v[8:11], v76 offset:6656
Cs3_top2:
  v_smfmac_f32_16x16x64_bf16 v[20:23], v[4:7], v[96:103], v74
  s_cbranch_scc1 Cs3_last
  v_smfmac_f32_16x16x64_bf16 v[28:31], v[4:7], v[36:43], v74
  buffer_load_dwordx4 v[44:47], v76, s[8:11], s58 offen offset:0 sc1
  s_mov_b32 m0, 15872
  v_smfmac_f32_16x16x64_bf16 v[24:27], v[4:7], v[104:111], v74
  buffer_load_dwordx4 v[48:51], v76, s[8:11], s58 offen offset:1024 sc1
  v_smfmac_f32_16x16x64_bf16 v[32:35], v[4:7], v[60:67], v74
  ds_read_b128 v[0:3], v76 offset:4608
  s_waitcnt lgkmcnt(1)
  v_smfmac_f32_16x16x64_bf16 v[20:23], v[8:11], v[112:119], v74
  ds_read_b128 v[12:15], v76 offset:7680
  v_smfmac_f32_16x16x64_bf16 v[24:27], v[8:11], v[120:127], v74
  ds_read_b128 v[36:39], v76 offset:28672
  v_smfmac_f32_16x16x64_bf16 v[28:31], v[8:11], v[208:215], v74
  buffer_store_dwordx4 v[16:19], v76, s[8:11], s68 offen sc1
  ds_read_b128 v[40:43], v76 offset:29696
  v_smfmac_f32_16x16x64_bf16 v[32:35], v[8:11], v[216:223], v74
  buffer_load_dword v73, s[16:19], s70 offen lds
  ds_read_b128 v[60:63], v76 offset:30720
  s_waitcnt lgkmcnt(4)
  v_smfmac_f32_16x16x64_bf16 v[20:23], v[0:3], v[80:87], v74
  ds_read_b128 v[64:67], v76 offset:31744
  v_smfmac_f32_16x16x64_bf16 v[24:27], v[0:3], v[88:95], v74
  s_waitcnt vmcnt(4)
  s_waitcnt lgkmcnt(4)
  v_smfmac_f32_16x16x64_bf16 v[20:23], v[12:15], v[128:135], v74
  s_barrier
  ds_read_b128 v[4:7], v76 offset:8704
  s_waitcnt lgkmcnt(3)
  v_smfmac_f32_16x16x64_bf16 v[28:31], v[0:3], v[36:43], v74
  ds_read_b128 v[36:39], v76 offset:61440
  v_smfmac_f32_16x16x64_bf16 v[24:27], v[12:15], v[136:143], v74
  ds_read_b128 v[40:43], v76 offset:62464
  s_waitcnt lgkmcnt(3)
  v_smfmac_f32_16x16x64_bf16 v[32:35], v[0:3], v[60:67], v74
  ds_read_b128 v[8:11], v76 offset:9728
  v_smfmac_f32_16x16x64_bf16 v[28:31], v[12:15], v[224:231], v74
  ds_read_b128 v[60:63], v76 offset:63488
  v_smfmac_f32_16x16x64_bf16 v[32:35], v[12:15], v[232:239], v74
  ds_read_b128 v[64:67], v76 offset:64512
  s_waitcnt lgkmcnt(5)
  v_smfmac_f32_16x16x64_bf16 v[20:23], v[4:7], v[144:151], v74
  s_barrier
  ds_read_b128 v[0:3], v76 offset:11776
  s_waitcnt lgkmcnt(4)
  v_smfmac_f32_16x16x64_bf16 v[28:31], v[4:7], v[36:43], v74
  ds_read_b128 v[12:15], v76 offset:12800
  ds_read_b128 v[36:39], v75 offset:12288
  v_smfmac_f32_16x16x64_bf16 v[24:27], v[4:7], v[152:159], v74
  ds_read_b128 v[16:19], v76 offset:10752
  s_waitcnt lgkmcnt(6)
  v_smfmac_f32_16x16x64_bf16 v[20:23], v[8:11], v[160:167], v74
  ds_read_b128 v[40:43], v75 offset:13312
  s_waitcnt lgkmcnt(5)
  v_smfmac_f32_16x16x64_bf16 v[32:35], v[4:7], v[60:67], v74
  ds_read_b128 v[60:63], v75 offset:14336
  v_smfmac_f32_16x16x64_bf16 v[24:27], v[8:11], v[168:175], v74
  ds_read_b128 v[64:67], v75 offset:15360
  s_waitcnt lgkmcnt(6)
  v_smfmac_f32_16x16x64_bf16 v[20:23], v[0:3], v[176:183], v74
  s_waitcnt lgkmcnt(5)
  v_smfmac_f32_16x16x64_bf16 v[20:23], v[12:15], v[192:199], v74
  s_waitcnt lgkmcnt(2)
  v_smfmac_f32_16x16x64_bf16 v[20:23], v[16:19], v[36:43], v74
  ds_read_b128 v[36:39], v75 offset:28672
  v_smfmac_f32_16x16x64_bf16 v[24:27], v[0:3], v[184:191], v74
  ds_read_b128 v[40:43], v75 offset:29696
  s_waitcnt lgkmcnt(2)
  v_smfmac_f32_16x16x64_bf16 v[24:27], v[16:19], v[60:67], v74
  ds_read_b128 v[60:63], v75 offset:30720
  v_add_f32 v20, v20, v22
  v_smfmac_f32_16x16x64_bf16 v[24:27], v[12:15], v[200:207], v74
  ds_read_b128 v[64:67], v75 offset:31744
  v_add_f32 v21, v21, v23
  v_smfmac_f32_16x16x64_bf16 v[28:31], v[16:19], v[240:247], v74
  v_mov_b64 v[70:71], s[78:79]
  v_smfmac_f32_16x16x64_bf16 v[28:31], v[0:3], a[0:7], v74
  s_waitcnt lgkmcnt(2)
  v_add_f32 v24, v24, v26
  v_smfmac_f32_16x16x64_bf16 v[28:31], v[8:11], v[36:43], v74
  ds_read_b128 v[36:39], v68
  v_cvt_pk_bf16_f32 v22, v20, v24
  v_smfmac_f32_16x16x64_bf16 v[28:31], v[12:15], a[16:23], v74
  ds_read_b128 v[40:43], v68
  ds_write_b32 v79, v22 offset:0
  s_waitcnt lgkmcnt(3)
  v_add_f32 v25, v25, v27
  v_cvt_pk_bf16_f32 v23, v21, v25
  v_smfmac_f32_16x16x64_bf16 v[32:35], v[8:11], v[60:67], v74
  ds_write_b32 v79, v23 offset:576
  v_cmp_u_f32 vcc, v20, v21
  v_smfmac_f32_16x16x64_bf16 v[32:35], v[16:19], v[248:255], v74
  v_add_f32 v28, v28, v30
  v_smfmac_f32_16x16x64_bf16 v[32:35], v[0:3], a[8:15], v74
  v_add_f32 v29, v29, v31
  v_smfmac_f32_16x16x64_bf16 v[32:35], v[12:15], a[24:31], v74
  s_cbranch_vccnz Cs3_rec
Cs3_recok:
  s_waitcnt lgkmcnt(3)
  v_smfmac_f32_16x16x64_bf16 v[36:39], v[16:19], a[128:135], v74
  s_waitcnt lgkmcnt(0)
  s_barrier
  ds_read_b128 v[60:63], v77
  v_smfmac_f32_16x16x64_bf16 v[40:43], v[16:19], a[136:143], v74
  ds_read_b128 v[64:67], v77 offset:128
  v_add_f32 v32, v32, v34
  v_cvt_pk_bf16_f32 v30, v28, v32
  v_smfmac_f32_16x16x64_bf16 v[36:39], v[0:3], a[144:151], v74
  ds_write_b32 v79, v30 offset:256
  v_add_f32 v33, v33, v35
  v_cvt_pk_bf16_f32 v31, v29, v33
  v_smfmac_f32_16x16x64_bf16 v[40:43], v[0:3], a[152:159], v74
  ds_write_b32 v79, v31 offset:832
  v_xor_b32 v75, 0x8000, v75
  v_smfmac_f32_16x16x64_bf16 v[36:39], v[4:7], a[96:103], v74
  ds_read_b128 v[0:3], v76 offset:4608
  v_mov_b32 v29, 0
  v_smfmac_f32_16x16x64_bf16 v[40:43], v[4:7], a[104:111], v74
  s_waitcnt vmcnt(2) lgkmcnt(3)
  v_mov_b32 v30, 0
  v_mfma_f32_16x16x32_bf16 v[44:47], v[44:47], v[60:63], 0
  ds_read_b128 v[4:7], v76 offset:5632
  s_waitcnt lgkmcnt(2)
  v_mfma_f32_16x16x32_bf16 v[44:47], v[48:51], v[64:67], v[44:47]
  s_barrier
  v_smfmac_f32_16x16x64_bf16 v[36:39], v[8:11], a[112:119], v74
  ds_read_b128 v[20:23], v77 offset:256
  ds_read_b128 v[24:27], v77 offset:384
  v_smfmac_f32_16x16x64_bf16 v[40:43], v[8:11], a[120:127], v74
  ds_read_b128 v[8:11], v76 offset:6656
  v_add_f32_dpp v72, v46, v44 quad_perm:[2,3,0,1] row_mask:0xf bank_mask:0xf
  v_add_f32_dpp v73, v47, v45 quad_perm:[2,3,0,1] row_mask:0xf bank_mask:0xf
  v_smfmac_f32_16x16x64_bf16 v[36:39], v[12:15], a[160:167], v74
  s_waitcnt lgkmcnt(4)
  v_exp_f32_dpp v72, v72 quad_perm:[0,1,0,1] row_mask:0xf bank_mask:0xf
  v_smfmac_f32_16x16x64_bf16 v[40:43], v[12:15], a[168:175], v74
  ds_read_b128 v[12:15], v76 offset:7680
  v_exp_f32_dpp v73, v73 quad_perm:[0,1,0,1] row_mask:0xf bank_mask:0xf
  v_smfmac_f32_16x16x64_bf16 v[36:39], v[0:3], a[32:39], v74
  s_waitcnt lgkmcnt(2)
  v_cvt_pk_bf16_f32 v72, v72, v73
  v_mfma_f32_16x16x32_bf16 v[20:23], v[20:23], v[60:63], 0
  ds_write_b32 v78, v72 offset:524
  v_mov_b64 v[16:17], 0
  v_mfma_f32_16x16x32_bf16 v[20:23], v[24:27], v[64:67], v[20:23]
  ds_read_b128 v[44:47], v75 offset:47104
  v_mov_b64 v[18:19], 0
  v_smfmac_f32_16x16x64_bf16 v[40:43], v[0:3], a[40:47], v74
  ds_read_b128 v[48:51], v75 offset:48128
  v_mov_b64 v[68:69], s[78:79]
  v_smfmac_f32_16x16x64_bf16 v[36:39], v[4:7], a[48:55], v74
  s_waitcnt lgkmcnt(4)
  v_add_f32_dpp v24, v22, v20 quad_perm:[2,3,0,1] row_mask:0xf bank_mask:0xf
  v_add_f32_dpp v25, v23, v21 quad_perm:[2,3,0,1] row_mask:0xf bank_mask:0xf
  v_smfmac_f32_16x16x64_bf16 v[36:39], v[8:11], a[64:71], v74
  s_waitcnt lgkmcnt(2)
  s_barrier
  ds_read_b128 v[32:35], v78 offset:512
  v_smfmac_f32_16x16x64_bf16 v[36:39], v[12:15], a[80:87], v74
  ds_read_b128 v[60:63], v75 offset:28672
  v_mul_f32 v24, s69, v24
  v_smfmac_f32_16x16x64_bf16 v[40:43], v[4:7], a[56:63], v74
  ds_read_b128 v[64:67], v75 offset:29696
  v_mul_f32 v25, s69, v25
  v_smfmac_f32_16x16x64_bf16 v[40:43], v[8:11], a[72:79], v74
  v_exp_f32_dpp v24, v24 quad_perm:[0,1,0,1] row_mask:0xf bank_mask:0xf
  v_smfmac_f32_16x16x64_bf16 v[40:43], v[12:15], a[88:95], v74
  s_waitcnt lgkmcnt(2)
  v_exp_f32_dpp v25, v25 quad_perm:[0,1,0,1] row_mask:0xf bank_mask:0xf
  v_mfma_f32_16x16x32_bf16 v[8:11], v[32:35], v[68:71], 0
  v_add_f32 v36, v36, v38
  v_add_f32 v37, v37, v39
  v_mfma_f32_16x16x32_bf16 v[0:3], v[32:35], v[52:55], 0
  v_add_f32 v40, v40, v42
  v_add_f32 v41, v41, v43
  v_mfma_f32_16x16x32_bf16 v[4:7], v[32:35], v[56:59], 0
  v_cvt_pk_bf16_f32 v28, v24, v25
  v_cvt_pk_bf16_f32 v72, v36, v37
  v_cvt_pk_bf16_f32 v73, v40, v41
  v_mfma_f32_16x16x16_bf16 v[8:11], v[28:29], v[68:69], v[8:11]
  v_cvt_pk_bf16_f32 v31, v24, v25
  v_mov_b64 v[20:21], 0
  v_mfma_f32_16x16x16_bf16 v[0:3], v[28:29], v[72:73], v[0:3]
  ds_read_b128 v[52:55], v75 offset:30720
  v_mov_b64 v[22:23], 0
  v_mfma_f32_16x16x16_bf16 v[4:7], v[30:31], v[72:73], v[4:7]
  v_rcp_f32 v10, v8
  v_rcp_f32 v11, v9
  v_mul_f32 v0, v10, v0
  v_mul_f32 v1, v11, v1
  v_max3_f32 v8, v8, v9, v10
  v_mul_f32 v4, v10, v4
  v_mul_f32 v5, v11, v5
  v_cvt_pk_bf16_f32 v2, v0, v4
  ds_write_b32 v79, v2 offset:8704
  v_cvt_pk_bf16_f32 v3, v1, v5
  ds_write_b32 v79, v3 offset:9280
  ds_read_b128 v[12:15], v78 offset:8896
  v_max_f32 v8, v8, v11
  v_cmp_le_f32 vcc, 1317011456, v8
  v_mov_b64 v[24:25], 0
  v_mov_b64 v[26:27], 0
  ds_read_b128 v[56:59], v75 offset:31744
  s_cbranch_vccnz Cs3_mx
Cs3_mxok:
  s_waitcnt lgkmcnt(2)
  s_barrier
  ds_read_b128 v[0:3], v78 offset:8832
  s_waitcnt lgkmcnt(2)
  v_smfmac_f32_16x16x64_bf16 v[16:19], v[12:15], a[184:191], v74
  ds_read_b128 v[4:7], v78 offset:8704
  v_smfmac_f32_16x16x64_bf16 v[20:23], v[12:15], v[44:51], v74
  ds_read_b128 v[8:11], v78 offset:8768
  v_smfmac_f32_16x16x64_bf16 v[24:27], v[12:15], a[232:239], v74
  ds_read_b128 v[36:39], v75 offset:45056
  s_waitcnt lgkmcnt(3)
  v_smfmac_f32_16x16x64_bf16 v[16:19], v[0:3], a[176:183], v74
  ds_read_b128 v[40:43], v75 offset:46080
  s_waitcnt lgkmcnt(3)
  v_smfmac_f32_16x16x64_bf16 v[16:19], v[4:7], v[60:67], v74
  ds_read_b128 v[68:71], v76 offset:13824
  s_waitcnt lgkmcnt(3)
  v_smfmac_f32_16x16x64_bf16 v[16:19], v[8:11], v[52:59], v74
  ds_read_b128 v[44:47], v75 offset:61440
  v_smfmac_f32_16x16x64_bf16 v[20:23], v[4:7], a[192:199], v74
  ds_read_b128 v[48:51], v75 offset:62464
  v_smfmac_f32_16x16x64_bf16 v[20:23], v[8:11], a[200:207], v74
  ds_read_b128 v[60:63], v75 offset:63488
  s_waitcnt lgkmcnt(4)
  v_cvt_pk_bf16_f32 v16, v16, v17
  v_cvt_pk_bf16_f32 v17, v18, v19
  v_bfi_b32 v16, 1, s72, v16
  v_smfmac_f32_16x16x64_bf16 v[20:23], v[0:3], v[36:43], v74
  s_waitcnt lgkmcnt(3)
  buffer_store_dwordx2 v[16:17], v68, s[8:11], s73 offen sc1
  v_mov_b64 v[32:33], 0
  v_smfmac_f32_16x16x64_bf16 v[24:27], v[4:7], a[208:215], v74
  ds_read_b128 v[64:67], v75 offset:64512
  v_mov_b64 v[34:35], 0
  v_smfmac_f32_16x16x64_bf16 v[24:27], v[8:11], a[216:223], v74
  ds_read_b128 v[52:55], v75 offset:8192
  v_cvt_pk_bf16_f32 v20, v20, v21
  v_cvt_pk_bf16_f32 v21, v22, v23
  v_bfi_b32 v20, 1, s72, v20
  v_smfmac_f32_16x16x64_bf16 v[24:27], v[0:3], a[224:231], v74
  ds_read_b128 v[56:59], v75 offset:9216
  buffer_store_dwordx2 v[20:21], v68, s[8:11], s74 offen sc1
  s_waitcnt lgkmcnt(4)
  v_mov_b64 v[28:29], 0
  v_smfmac_f32_16x16x64_bf16 v[32:35], v[4:7], v[44:51], v74
  ds_read_b128 v[36:39], v75 offset:10240
  ds_read_b128 v[40:43], v75 offset:11264
  s_waitcnt lgkmcnt(4)
  v_smfmac_f32_16x16x64_bf16 v[32:35], v[8:11], v[60:67], v74
  ds_read_b128 v[44:47], v75 offset:12288
  v_cvt_pk_bf16_f32 v24, v24, v25
  v_cvt_pk_bf16_f32 v25, v26, v27
  v_bfi_b32 v24, 1, s72, v24
  v_smfmac_f32_16x16x64_bf16 v[32:35], v[0:3], a[240:247], v74
  ds_read_b128 v[48:51], v75 offset:13312
  buffer_store_dwordx2 v[24:25], v68, s[8:11], s75 offen sc1
  v_mov_b64 v[30:31], 0
  v_smfmac_f32_16x16x64_bf16 v[32:35], v[12:15], a[248:255], v74
  ds_read_b128 v[60:63], v75 offset:14336
  ds_read_b128 v[64:67], v75 offset:15360
  s_waitcnt lgkmcnt(6)
  v_smfmac_f32_16x16x64_bf16 v[28:31], v[4:7], v[52:59], v74
  s_waitcnt lgkmcnt(4)
  v_smfmac_f32_16x16x64_bf16 v[28:31], v[8:11], v[36:43], v74
  s_waitcnt lgkmcnt(2)
  v_cvt_pk_bf16_f32 v32, v32, v33
  v_cvt_pk_bf16_f32 v33, v34, v35
  v_bfi_b32 v32, 1, s72, v32
  v_smfmac_f32_16x16x64_bf16 v[28:31], v[0:3], v[44:51], v74
  buffer_store_dwordx2 v[32:33], v68, s[8:11], s76 offen sc1
  s_waitcnt lgkmcnt(0)
  v_smfmac_f32_16x16x64_bf16 v[28:31], v[12:15], v[60:67], v74
  v_mov_b64 v[18:19], v[72:73]
  s_nop 4
  v_cvt_pk_bf16_f32 v28, v28, v29
  v_cvt_pk_bf16_f32 v29, v30, v31
  v_bfi_b32 v28, 1, s72, v28
  buffer_store_dwordx2 v[28:29], v68, s[8:11], s77 offen sc1
  ds_read_b128 v[52:55], v76 offset:14848
  s_waitcnt lgkmcnt(0)
  ds_read_b64 v[16:17], v77 offset:392
  s_waitcnt lgkmcnt(0)
  ds_read_b128 v[60:63], v76 offset:47104
  s_waitcnt lgkmcnt(0)
  ds_read_b128 v[64:67], v76 offset:48128
  s_waitcnt lgkmcnt(0)
  s_add_u32 s66, s66, 1
  s_xor_b32 s64, s64, 16384
  s_xor_b32 s65, s65, 16384
  s_add_u32 s58, s58, 655360
  s_add_u32 s59, s59, 655360
  s_add_u32 s70, s70, 655360
  s_add_u32 s68, s68, 655360
  s_mov_b32 m0, 8704
  s_add_u32 s85, s65, 4096
  v_xor_b32 v75, 0x8000, v75
  v_mov_b64 v[28:29], 0
  v_mov_b64 v[30:31], 0
  v_mov_b64 v[32:33], 0
  v_mov_b64 v[34:35], 0
  s_waitcnt vmcnt(0)
  buffer_load_dwordx4 v[0:3], v76, s[8:11], s60 offen offset:0 sc1
  buffer_load_dwordx4 v[4:7], v76, s[8:11], s60 offen offset:1024 sc1
  buffer_load_dwordx4 v[8:11], v76, s[8:11], s61 offen offset:0 sc1
  buffer_load_dwordx4 v[12:15], v76, s[8:11], s61 offen offset:1024 sc1
  v_mov_b64 v[20:21], 0
  v_mov_b64 v[22:23], 0
  v_mov_b64 v[24:25], 0
  v_mov_b64 v[26:27], 0
  v_mov_b32 v68, 14880
  s_cmp_eq_u32 s66, 62
  s_cselect_b64 s[16:17], s[20:21], s[16:17]
  s_cselect_b32 s18, (Cs3_done - Cs3_last), s18
  s_cselect_b32 s70, 0, s70
  s_cmp_eq_u32 s66, 63
  s_cselect_b32 s59, 268435456, s59
  s_cselect_b32 s58, 268435456, s58
  s_waitcnt lgkmcnt(0)
  s_waitcnt vmcnt(3)
  v_mfma_f32_16x16x32_bf16 v[56:59], v[52:55], v[0:3], 0
  v_bitop3_b32 v72, v0, v2, s72 bitop3:0x7e
  s_waitcnt vmcnt(2)
  v_mfma_f32_16x16x32_bf16 v[56:59], v[52:55], v[4:7], v[56:59]
  v_bitop3_b32 v73, v4, v6, s72 bitop3:0x7e
  v_or_b32 v72, v72, v73
  s_waitcnt vmcnt(1)
  v_mfma_f32_16x16x32_bf16 v[36:39], v[52:55], v[8:11], 0
  v_bitop3_b32 v73, v8, v10, s72 bitop3:0x7e
  v_or_b32 v72, v72, v73
  s_waitcnt vmcnt(0)
  v_mfma_f32_16x16x32_bf16 v[36:39], v[52:55], v[12:15], v[36:39]
  v_bitop3_b32 v73, v12, v14, s72 bitop3:0x7e
  v_bitop3_b32 v72, v72, v73, 1 bitop3:0xa8
  v_cmp_ne_u32 vcc, 0, v72
  s_cbranch_vccnz Cs3_h1r
  v_add_f32_dpp v56, v56, v56 row_ror:4 row_mask:0xf bank_mask:0xf
  v_add_f32_dpp v57, v57, v57 row_ror:4 row_mask:0xf bank_mask:0xf
  s_nop 0
  v_add_f32_dpp v36, v36, v36 row_ror:4 row_mask:0xf bank_mask:0xf
  v_add_f32_dpp v37, v37, v37 row_ror:4 row_mask:0xf bank_mask:0xf
  v_add_f32_dpp v56, v56, v56 row_ror:8 row_mask:0xf bank_mask:0xf
  v_add_f32_dpp v57, v57, v57 row_ror:8 row_mask:0xf bank_mask:0xf
  v_add_f32_dpp v36, v36, v36 row_ror:8 row_mask:0xf bank_mask:0xf
  v_add_f32_dpp v37, v37, v37 row_ror:8 row_mask:0xf bank_mask:0xf
  v_cvt_pk_bf16_f32 v56, v56, v57
  buffer_store_dword v56, v69, s[8:11], s62 offen sc1
  v_cvt_pk_bf16_f32 v36, v36, v37
  buffer_store_dword v36, v70, s[8:11], s63 offen sc1
  s_xor_b32 s62, s62, 16384
  buffer_store_dword v71, v69, s[8:11], s62 offen sc1
  s_xor_b32 s63, s63, 16384
  buffer_store_dword v71, v70, s[8:11], s63 offen sc1
  s_xor_b32 s72, s72, 1
  s_branch Cs3_h2
Cs3_h1r:
  s_mov_b64 exec, vcc
  buffer_load_dwordx4 v[0:3], v76, s[8:11], s60 offen offset:0 sc1
  buffer_load_dwordx4 v[4:7], v76, s[8:11], s60 offen offset:1024 sc1
  buffer_load_dwordx4 v[8:11], v76, s[8:11], s61 offen offset:0 sc1
  buffer_load_dwordx4 v[12:15], v76, s[8:11], s61 offen offset:1024 sc1
  s_mov_b64 exec, -1
  s_add_u32 s67, s67, 1
  s_waitcnt vmcnt(3)
  v_mfma_f32_16x16x32_bf16 v[56:59], v[52:55], v[0:3], 0
  v_bitop3_b32 v72, v0, v2, s72 bitop3:0x7e
  s_waitcnt vmcnt(2)
  v_mfma_f32_16x16x32_bf16 v[56:59], v[52:55], v[4:7], v[56:59]
  v_bitop3_b32 v73, v4, v6, s72 bitop3:0x7e
  v_or_b32 v72, v72, v73
  s_waitcnt vmcnt(1)
  v_mfma_f32_16x16x32_bf16 v[36:39], v[52:55], v[8:11], 0
  v_bitop3_b32 v73, v8, v10, s72 bitop3:0x7e
  v_or_b32 v72, v72, v73
  s_waitcnt vmcnt(0)
  v_mfma_f32_16x16x32_bf16 v[36:39], v[52:55], v[12:15], v[36:39]
  v_bitop3_b32 v73, v12, v14, s72 bitop3:0x7e
  v_bitop3_b32 v72, v72, v73, 1 bitop3:0xa8
  v_cmp_ne_u32 vcc, 0, v72
  s_cbranch_vccz Cs3_h1p
Cs3_h1s:
  s_mov_b64 exec, vcc
  buffer_load_dwordx4 v[0:3], v76, s[8:11], s60 offen offset:0 sc1
  buffer_load_dwordx4 v[4:7], v76, s[8:11], s60 offen offset:1024 sc1
  buffer_load_dwordx4 v[8:11], v76, s[8:11], s61 offen offset:0 sc1
  buffer_load_dwordx4 v[12:15], v76, s[8:11], s61 offen offset:1024 sc1
  s_mov_b64 exec, -1
  s_add_u32 s67, s67, 1
  s_waitcnt vmcnt(3)
  v_mfma_f32_16x16x32_bf16 v[56:59], v[52:55], v[0:3], 0
  v_bitop3_b32 v72, v0, v2, s72 bitop3:0x7e
  s_waitcnt vmcnt(2)
  v_mfma_f32_16x16x32_bf16 v[56:59], v[52:55], v[4:7], v[56:59]
  v_bitop3_b32 v73, v4, v6, s72 bitop3:0x7e
  v_or_b32 v72, v72, v73
  s_waitcnt vmcnt(1)
  v_mfma_f32_16x16x32_bf16 v[36:39], v[52:55], v[8:11], 0
  v_bitop3_b32 v73, v8, v10, s72 bitop3:0x7e
  v_or_b32 v72, v72, v73
  s_waitcnt vmcnt(0)
  v_mfma_f32_16x16x32_bf16 v[36:39], v[52:55], v[12:15], v[36:39]
  v_bitop3_b32 v73, v12, v14, s72 bitop3:0x7e
  v_bitop3_b32 v72, v72, v73, 1 bitop3:0xa8
  v_cmp_ne_u32 vcc, 0, v72
  s_cbranch_vccz Cs3_h1p
  s_cmp_lt_u32 s67, 131072
  s_cbranch_scc1 Cs3_h1s
Cs3_h1p:
  s_nop 2
  v_add_f32_dpp v56, v56, v56 row_ror:4 row_mask:0xf bank_mask:0xf
  v_add_f32_dpp v57, v57, v57 row_ror:4 row_mask:0xf bank_mask:0xf
  v_add_f32_dpp v36, v36, v36 row_ror:4 row_mask:0xf bank_mask:0xf
  v_add_f32_dpp v37, v37, v37 row_ror:4 row_mask:0xf bank_mask:0xf
  v_add_f32_dpp v56, v56, v56 row_ror:8 row_mask:0xf bank_mask:0xf
  v_add_f32_dpp v57, v57, v57 row_ror:8 row_mask:0xf bank_mask:0xf
  v_add_f32_dpp v36, v36, v36 row_ror:8 row_mask:0xf bank_mask:0xf
  v_add_f32_dpp v37, v37, v37 row_ror:8 row_mask:0xf bank_mask:0xf
  v_cvt_pk_bf16_f32 v56, v56, v57
  buffer_store_dword v56, v69, s[8:11], s62 offen sc1
  v_cvt_pk_bf16_f32 v36, v36, v37
  buffer_store_dword v36, v70, s[8:11], s63 offen sc1
  s_xor_b32 s62, s62, 16384
  buffer_store_dword v71, v69, s[8:11], s62 offen sc1
  s_xor_b32 s63, s63, 16384
  buffer_store_dword v71, v70, s[8:11], s63 offen sc1
  s_xor_b32 s72, s72, 1
  s_branch Cs3_h2
Cs3_rec:
  s_nop 7
  s_waitcnt vmcnt(0) lgkmcnt(0)
  v_max3_u32 v72, v0, v1, v2
  v_max3_u32 v72, v72, v3, v4
  v_max3_u32 v72, v72, v5, v6
  v_max3_u32 v72, v72, v7, v8
  v_max3_u32 v72, v72, v9, v10
  v_max3_u32 v72, v72, v11, v12
  v_max3_u32 v72, v72, v13, v14
  v_max3_u32 v72, v72, v15, v16
  v_max3_u32 v72, v72, v17, v18
  v_max_u32 v72, v72, v19
  v_cmp_eq_u32 vcc, -1, v72
  s_cbranch_vccz Cs3_recok
  s_barrier
Cs3_recp:
  buffer_load_dwordx4 v[0:3], v76, s[8:11], s64 offen offset:0 sc1
  buffer_load_dwordx4 v[4:7], v76, s[8:11], s64 offen offset:1024 sc1
  buffer_load_dwordx4 v[8:11], v76, s[8:11], s64 offen offset:2048 sc1
  s_add_u32 s67, s67, 1
  s_cmp_lt_u32 s67, 131072
  s_cselect_b32 s54, -2, -1
  s_waitcnt vmcnt(2)
  v_max3_u32 v72, v0, v1, v2
  s_waitcnt vmcnt(1)
  v_max3_u32 v72, v72, v3, v4
  v_max3_u32 v72, v72, v5, v6
  s_waitcnt vmcnt(0)
  v_max3_u32 v72, v72, v7, v8
  v_max3_u32 v72, v72, v9, v10
  v_max_u32 v72, v72, v11
  v_cmp_lt_u32 vcc, s54, v72
  s_cbranch_vccnz Cs3_recp
  ds_write_b128 v76, v[0:3] offset:10752
  ds_write_b128 v76, v[4:7] offset:11776
  ds_write_b128 v76, v[8:11] offset:12800
  v_mov_b64 v[20:21], 0
  v_mov_b64 v[22:23], 0
  v_mov_b64 v[24:25], 0
  v_mov_b64 v[26:27], 0
  v_mov_b64 v[28:29], 0
  v_mov_b64 v[30:31], 0
  v_mov_b64 v[32:33], 0
  v_mov_b64 v[34:35], 0
  s_waitcnt lgkmcnt(0)
  s_barrier
  ds_read_b128 v[0:3], v76 offset:4608
  s_waitcnt lgkmcnt(0)
  v_smfmac_f32_16x16x64_bf16 v[20:23], v[0:3], v[80:87], v74
  v_smfmac_f32_16x16x64_bf16 v[24:27], v[0:3], v[88:95], v74
  ds_read_b128 v[60:63], v76 offset:28672
  ds_read_b128 v[64:67], v76 offset:29696
  s_waitcnt lgkmcnt(0)
  v_smfmac_f32_16x16x64_bf16 v[28:31], v[0:3], v[60:67], v74
  ds_read_b128 v[60:63], v76 offset:30720
  ds_read_b128 v[64:67], v76 offset:31744
  s_waitcnt lgkmcnt(0)
  v_smfmac_f32_16x16x64_bf16 v[32:35], v[0:3], v[60:67], v74
  ds_read_b128 v[4:7], v76 offset:5632
  s_waitcnt lgkmcnt(0)
  v_smfmac_f32_16x16x64_bf16 v[20:23], v[4:7], v[96:103], v74
  v_smfmac_f32_16x16x64_bf16 v[24:27], v[4:7], v[104:111], v74
  ds_read_b128 v[60:63], v76 offset:45056
  ds_read_b128 v[64:67], v76 offset:46080
  s_waitcnt lgkmcnt(0)
  v_smfmac_f32_16x16x64_bf16 v[28:31], v[4:7], v[60:67], v74
  ds_read_b128 v[60:63], v76 offset:47104
  ds_read_b128 v[64:67], v76 offset:48128
  s_waitcnt lgkmcnt(0)
  v_smfmac_f32_16x16x64_bf16 v[32:35], v[4:7], v[60:67], v74
  ds_read_b128 v[8:11], v76 offset:6656
  s_waitcnt lgkmcnt(0)
  v_smfmac_f32_16x16x64_bf16 v[20:23], v[8:11], v[112:119], v74
  v_smfmac_f32_16x16x64_bf16 v[24:27], v[8:11], v[120:127], v74
  v_smfmac_f32_16x16x64_bf16 v[28:31], v[8:11], v[208:215], v74
  v_smfmac_f32_16x16x64_bf16 v[32:35], v[8:11], v[216:223], v74
  ds_read_b128 v[12:15], v76 offset:7680
  s_waitcnt lgkmcnt(0)
  v_smfmac_f32_16x16x64_bf16 v[20:23], v[12:15], v[128:135], v74
  v_smfmac_f32_16x16x64_bf16 v[24:27], v[12:15], v[136:143], v74
  v_smfmac_f32_16x16x64_bf16 v[28:31], v[12:15], v[224:231], v74
  v_smfmac_f32_16x16x64_bf16 v[32:35], v[12:15], v[232:239], v74
  ds_read_b128 v[4:7], v76 offset:8704
  s_waitcnt lgkmcnt(0)
  v_smfmac_f32_16x16x64_bf16 v[20:23], v[4:7], v[144:151], v74
  v_smfmac_f32_16x16x64_bf16 v[24:27], v[4:7], v[152:159], v74
  ds_read_b128 v[60:63], v76 offset:61440
  ds_read_b128 v[64:67], v76 offset:62464
  s_waitcnt lgkmcnt(0)
  v_smfmac_f32_16x16x64_bf16 v[28:31], v[4:7], v[60:67], v74
  ds_read_b128 v[60:63], v76 offset:63488
  ds_read_b128 v[64:67], v76 offset:64512
  s_waitcnt lgkmcnt(0)
  v_smfmac_f32_16x16x64_bf16 v[32:35], v[4:7], v[60:67], v74
  ds_read_b128 v[8:11], v76 offset:9728
  s_waitcnt lgkmcnt(0)
  v_smfmac_f32_16x16x64_bf16 v[20:23], v[8:11], v[160:167], v74
  v_smfmac_f32_16x16x64_bf16 v[24:27], v[8:11], v[168:175], v74
  ds_read_b128 v[60:63], v75 offset:28672
  ds_read_b128 v[64:67], v75 offset:29696
  s_waitcnt lgkmcnt(0)
  v_smfmac_f32_16x16x64_bf16 v[28:31], v[8:11], v[60:67], v74
  ds_read_b128 v[60:63], v75 offset:30720
  ds_read_b128 v[64:67], v75 offset:31744
  s_waitcnt lgkmcnt(0)
  v_smfmac_f32_16x16x64_bf16 v[32:35], v[8:11], v[60:67], v74
  ds_read_b128 v[16:19], v76 offset:10752
  ds_read_b128 v[60:63], v75 offset:12288
  ds_read_b128 v[64:67], v75 offset:13312
  s_waitcnt lgkmcnt(0)
  v_smfmac_f32_16x16x64_bf16 v[20:23], v[16:19], v[60:67], v74
  ds_read_b128 v[60:63], v75 offset:14336
  ds_read_b128 v[64:67], v75 offset:15360
  s_waitcnt lgkmcnt(0)
  v_smfmac_f32_16x16x64_bf16 v[24:27], v[16:19], v[60:67], v74
  v_smfmac_f32_16x16x64_bf16 v[28:31], v[16:19], v[240:247], v74
  v_smfmac_f32_16x16x64_bf16 v[32:35], v[16:19], v[248:255], v74
  ds_read_b128 v[0:3], v76 offset:11776
  s_waitcnt lgkmcnt(0)
  v_smfmac_f32_16x16x64_bf16 v[20:23], v[0:3], v[176:183], v74
  v_smfmac_f32_16x16x64_bf16 v[24:27], v[0:3], v[184:191], v74
  v_smfmac_f32_16x16x64_bf16 v[28:31], v[0:3], a[0:7], v74
  v_smfmac_f32_16x16x64_bf16 v[32:35], v[0:3], a[8:15], v74
  ds_read_b128 v[12:15], v76 offset:12800
  s_waitcnt lgkmcnt(0)
  v_smfmac_f32_16x16x64_bf16 v[20:23], v[12:15], v[192:199], v74
  v_smfmac_f32_16x16x64_bf16 v[24:27], v[12:15], v[200:207], v74
  v_smfmac_f32_16x16x64_bf16 v[28:31], v[12:15], a[16:23], v74
  v_smfmac_f32_16x16x64_bf16 v[32:35], v[12:15], a[24:31], v74
  v_add_f32 v20, v20, v22
  v_add_f32 v21, v21, v23
  v_add_f32 v24, v24, v26
  v_cvt_pk_bf16_f32 v22, v20, v24
  ds_write_b32 v79, v22 offset:0
  v_add_f32 v25, v25, v27
  v_cvt_pk_bf16_f32 v23, v21, v25
  ds_write_b32 v79, v23 offset:576
  v_add_f32 v28, v28, v30
  v_add_f32 v29, v29, v31
  s_waitcnt lgkmcnt(0)
  s_nop 1
  s_branch Cs3_recok
Cs3_mx:
  s_waitcnt lgkmcnt(0)
  s_barrier
  buffer_load_dwordx4 v[52:55], v76, s[8:11], s59 offen offset:0 sc1
  buffer_load_dwordx4 v[0:3], v76, s[8:11], s58 offen offset:0 sc1
  ds_read_b128 v[20:23], v77 offset:0
  ds_read_b128 v[28:31], v77 offset:256
  buffer_load_dwordx4 v[56:59], v76, s[8:11], s59 offen offset:1024 sc1
  buffer_load_dwordx4 v[4:7], v76, s[8:11], s58 offen offset:1024 sc1
  ds_read_b128 v[24:27], v77 offset:128
  ds_read_b128 v[32:35], v77 offset:384
  s_waitcnt vmcnt(2) lgkmcnt(3)
  v_mfma_f32_16x16x32_bf16 v[8:11], v[0:3], v[20:23], 0
  s_waitcnt vmcnt(0) lgkmcnt(1)
  v_mfma_f32_16x16x32_bf16 v[8:11], v[4:7], v[24:27], v[8:11]
  v_mfma_f32_16x16x32_bf16 v[12:15], v[28:31], v[20:23], 0
  s_waitcnt lgkmcnt(0)
  v_mfma_f32_16x16x32_bf16 v[12:15], v[32:35], v[24:27], v[12:15]
  v_add_f32_dpp v8, v10, v8 quad_perm:[2,3,0,1] row_mask:0xf bank_mask:0xf
  v_add_f32_dpp v9, v11, v9 quad_perm:[2,3,0,1] row_mask:0xf bank_mask:0xf
  s_nop 0
  v_mov_b32_dpp v8, v8 quad_perm:[0,1,0,1] row_mask:0xf bank_mask:0xf
  v_mov_b32_dpp v9, v9 quad_perm:[0,1,0,1] row_mask:0xf bank_mask:0xf
  s_nop 1
  v_add_f32_dpp v12, v14, v12 quad_perm:[2,3,0,1] row_mask:0xf bank_mask:0xf
  v_add_f32_dpp v13, v15, v13 quad_perm:[2,3,0,1] row_mask:0xf bank_mask:0xf
  s_nop 0
  v_mov_b32_dpp v12, v12 quad_perm:[0,1,0,1] row_mask:0xf bank_mask:0xf
  v_mov_b32_dpp v13, v13 quad_perm:[0,1,0,1] row_mask:0xf bank_mask:0xf
  v_mul_f32 v12, s69, v12
  ds_write_b32 v78, v8 offset:8716
  v_mul_f32 v13, s69, v13
  ds_write_b32 v78, v9 offset:8780
  s_waitcnt lgkmcnt(0)
  s_barrier
  ds_read_b128 v[36:39], v78 offset:8704
  ds_read_b128 v[40:43], v78 offset:8768
  s_waitcnt lgkmcnt(0)
  s_barrier
  v_max_f32 v16, v36, v37
  v_max3_f32 v16, v16, v38, v39
  v_max3_f32 v16, v16, v40, v41
  v_max3_f32 v16, v16, v42, v43
  v_max3_f32 v16, v16, v12, v13
  v_mov_b32 v17, v16
  s_nop 1
  v_permlane16_swap_b32 v16, v17
  v_max_f32 v16, v16, v17
  v_mov_b32 v17, v16
  s_nop 1
  v_permlane32_swap_b32 v16, v17
  v_max_f32 v16, v16, v17
  v_sub_f32 v36, v36, v16
  v_sub_f32 v37, v37, v16
  v_sub_f32 v38, v38, v16
  v_sub_f32 v39, v39, v16
  v_sub_f32 v40, v40, v16
  v_sub_f32 v41, v41, v16
  v_sub_f32 v42, v42, v16
  v_sub_f32 v43, v43, v16
  v_sub_f32 v12, v12, v16
  v_sub_f32 v13, v13, v16
  v_exp_f32 v36, v36
  v_exp_f32 v37, v37
  v_exp_f32 v38, v38
  v_exp_f32 v39, v39
  v_exp_f32 v40, v40
  v_exp_f32 v41, v41
  v_exp_f32 v42, v42
  v_exp_f32 v43, v43
  v_exp_f32 v12, v12
  v_exp_f32 v13, v13
  v_cvt_pk_bf16_f32 v32, v36, v40
  v_cvt_pk_bf16_f32 v33, v37, v41
  v_cvt_pk_bf16_f32 v34, v38, v42
  v_cvt_pk_bf16_f32 v35, v39, v43
  v_cvt_pk_bf16_f32 v28, v12, v13
  v_cvt_pk_bf16_f32 v31, v12, v13
  v_mov_b32 v29, 0
  v_mov_b32 v30, 0
  v_mfma_f32_16x16x32_bf16 v[8:11], v[32:35], v[68:71], 0
  v_mfma_f32_16x16x32_bf16 v[0:3], v[32:35], v[52:55], 0
  v_mfma_f32_16x16x32_bf16 v[4:7], v[32:35], v[56:59], 0
  v_mfma_f32_16x16x16_bf16 v[8:11], v[28:29], v[68:69], v[8:11]
  v_mfma_f32_16x16x16_bf16 v[0:3], v[28:29], v[72:73], v[0:3]
  v_mfma_f32_16x16x16_bf16 v[4:7], v[30:31], v[72:73], v[4:7]
  ds_read_b128 v[52:55], v75 offset:30720
  v_rcp_f32 v10, v8
  v_rcp_f32 v11, v9
  v_mul_f32 v0, v10, v0
  v_mul_f32 v1, v11, v1
  v_max3_f32 v8, v8, v9, v10
  v_mul_f32 v4, v10, v4
  v_mul_f32 v5, v11, v5
  v_cvt_pk_bf16_f32 v2, v0, v4
  ds_write_b32 v79, v2 offset:8704
  v_cvt_pk_bf16_f32 v3, v1, v5
  ds_write_b32 v79, v3 offset:9280
  ds_read_b128 v[12:15], v78 offset:8896
  ds_read_b128 v[56:59], v75 offset:31744
  v_mov_b64 v[16:17], 0
  v_mov_b64 v[18:19], 0
  v_mov_b64 v[20:21], 0
  v_mov_b64 v[22:23], 0
  v_mov_b64 v[24:25], 0
  v_mov_b64 v[26:27], 0
  s_branch Cs3_mxok
Cs3_last:
  ds_read_b128 v[0:3], v76 offset:4608
  ds_read_b128 v[12:15], v76 offset:7680
  ds_read_b128 v[44:47], v76 offset:28672
  ds_read_b128 v[48:51], v76 offset:29696
  s_nop 5
  v_mov_b64 v[20:21], 0
  v_mov_b64 v[22:23], 0
  v_mov_b64 v[24:25], 0
  v_mov_b64 v[26:27], 0
  v_smfmac_f32_16x16x64_bf16 v[28:31], v[4:7], v[36:43], v74
  ds_read_b128 v[36:39], v76 offset:30720
  ds_read_b128 v[40:43], v76 offset:31744
  v_smfmac_f32_16x16x64_bf16 v[32:35], v[4:7], v[60:67], v74
  s_waitcnt lgkmcnt(5)
  v_smfmac_f32_16x16x64_bf16 v[20:23], v[0:3], a[32:39], v74
  ds_read_b128 v[60:63], v76 offset:61440
  ds_read_b128 v[64:67], v76 offset:62464
  v_smfmac_f32_16x16x64_bf16 v[24:27], v[0:3], a[40:47], v74
  s_waitcnt lgkmcnt(4)
  v_smfmac_f32_16x16x64_bf16 v[20:23], v[4:7], a[48:55], v74
  buffer_store_dwordx4 v[16:19], v76, s[8:11], s68 offen sc1
  v_smfmac_f32_16x16x64_bf16 v[24:27], v[4:7], a[56:63], v74
  v_smfmac_f32_16x16x64_bf16 v[28:31], v[0:3], v[44:51], v74
  s_waitcnt lgkmcnt(2)
  v_smfmac_f32_16x16x64_bf16 v[20:23], v[8:11], a[64:71], v74
  ds_read_b128 v[44:47], v76 offset:63488
  ds_read_b128 v[48:51], v76 offset:64512
  v_smfmac_f32_16x16x64_bf16 v[24:27], v[8:11], a[72:79], v74
  v_smfmac_f32_16x16x64_bf16 v[32:35], v[0:3], v[36:43], v74
  v_smfmac_f32_16x16x64_bf16 v[28:31], v[8:11], v[208:215], v74
  ds_read_b128 v[36:39], v75 offset:28672
  ds_read_b128 v[40:43], v75 offset:29696
  v_smfmac_f32_16x16x64_bf16 v[32:35], v[8:11], v[216:223], v74
  v_smfmac_f32_16x16x64_bf16 v[20:23], v[12:15], a[80:87], v74
  v_smfmac_f32_16x16x64_bf16 v[24:27], v[12:15], a[88:95], v74
  v_smfmac_f32_16x16x64_bf16 v[28:31], v[12:15], v[224:231], v74
  v_smfmac_f32_16x16x64_bf16 v[32:35], v[12:15], v[232:239], v74
  s_waitcnt vmcnt(1)
  s_barrier
Cs3_lastr:
  ds_read_b128 v[4:7], v76 offset:8704
  ds_read_b128 v[8:11], v76 offset:9728
  ds_read_b128 v[16:19], v76 offset:10752
  ds_read_b128 v[0:3], v76 offset:11776
  ds_read_b128 v[12:15], v76 offset:12800
  s_waitcnt lgkmcnt(1)
  v_max3_u32 v72, v0, v1, v2
  v_max3_u32 v72, v72, v3, v4
  v_max3_u32 v72, v72, v5, v6
  v_max3_u32 v72, v72, v7, v8
  v_max3_u32 v72, v72, v9, v10
  s_waitcnt lgkmcnt(0)
  v_max3_u32 v72, v72, v11, v12
  v_max3_u32 v72, v72, v13, v14
  v_max3_u32 v72, v72, v15, v16
  v_max3_u32 v72, v72, v17, v18
  v_max_u32 v72, v72, v19
  v_cmp_eq_u32 vcc, -1, v72
  s_cbranch_vccnz Cs3_lastp
Cs3_lastg:
  v_smfmac_f32_16x16x64_bf16 v[28:31], v[4:7], v[60:67], v74
  ds_read_b128 v[60:63], v75 offset:30720
  ds_read_b128 v[64:67], v75 offset:31744
  v_smfmac_f32_16x16x64_bf16 v[32:35], v[4:7], v[44:51], v74
  v_smfmac_f32_16x16x64_bf16 v[28:31], v[8:11], v[36:43], v74
  v_smfmac_f32_16x16x64_bf16 v[28:31], v[16:19], v[240:247], v74
  v_smfmac_f32_16x16x64_bf16 v[28:31], v[0:3], a[0:7], v74
  v_smfmac_f32_16x16x64_bf16 v[28:31], v[12:15], a[16:23], v74
  v_smfmac_f32_16x16x64_bf16 v[32:35], v[16:19], v[248:255], v74
  v_smfmac_f32_16x16x64_bf16 v[32:35], v[0:3], a[8:15], v74
  s_waitcnt lgkmcnt(0)
  v_smfmac_f32_16x16x64_bf16 v[32:35], v[12:15], a[24:31], v74
  v_smfmac_f32_16x16x64_bf16 v[32:35], v[8:11], v[60:67], v74
  v_smfmac_f32_16x16x64_bf16 v[20:23], v[4:7], a[96:103], v74
  v_smfmac_f32_16x16x64_bf16 v[20:23], v[8:11], a[112:119], v74
  v_add_f32 v28, v28, v30
  v_add_f32 v32, v32, v34
  v_cvt_pk_bf16_f32 v30, v28, v32
  v_smfmac_f32_16x16x64_bf16 v[20:23], v[16:19], a[128:135], v74
  ds_write_b32 v79, v30 offset:256
  v_add_f32 v29, v29, v31
  v_add_f32 v33, v33, v35
  v_cvt_pk_bf16_f32 v31, v29, v33
  v_smfmac_f32_16x16x64_bf16 v[20:23], v[0:3], a[144:151], v74
  ds_write_b32 v79, v31 offset:832
  v_smfmac_f32_16x16x64_bf16 v[20:23], v[12:15], a[160:167], v74
  v_smfmac_f32_16x16x64_bf16 v[24:27], v[4:7], a[104:111], v74
  v_smfmac_f32_16x16x64_bf16 v[24:27], v[8:11], a[120:127], v74
  v_smfmac_f32_16x16x64_bf16 v[24:27], v[16:19], a[136:143], v74
  s_waitcnt lgkmcnt(0)
  s_barrier
  ds_read_b64 v[52:53], v77 offset:392
  v_add_f32 v20, v20, v22
  v_smfmac_f32_16x16x64_bf16 v[24:27], v[0:3], a[152:159], v74
  v_add_f32 v21, v21, v23
  v_smfmac_f32_16x16x64_bf16 v[24:27], v[12:15], a[168:175], v74
  v_cvt_pk_bf16_f32 v54, v20, v21
  s_add_u32 s68, s68, 655360
  s_nop 3
  v_add_f32 v24, v24, v26
  v_add_f32 v25, v25, v27
  v_cvt_pk_bf16_f32 v55, v24, v25
  s_waitcnt lgkmcnt(0)
  buffer_store_dwordx4 v[52:55], v76, s[8:11], s68 offen sc1
  s_branch Cs3_done
Cs3_lastp:
  s_add_u32 s72, s72, 2
  s_cmp_ge_u32 s72, 131072
  s_cbranch_scc1 Cs3_lastg
  s_barrier
  buffer_load_dwordx4 v76, s[8:11], s85 offen offset:0 sc1 lds
  buffer_load_dwordx4 v76, s[8:11], s85 offen offset:1024 sc1 lds
  s_waitcnt vmcnt(0)
  s_barrier
  s_branch Cs3_lastr
Cs3_done:
  s_branch L_cexit
L_conf:
  s_nop 11
  s_waitcnt vmcnt(0) lgkmcnt(0)
  s_barrier
  s_cmp_eq_u32 s52, 0
  s_cbranch_scc0 L_cf2
  s_mov_b64 exec, 1
  s_lshl_b32 s57, s2, 2
  v_mov_b32 v1, 0
L_cf0:
  s_cmp_eq_u32 s54, -1
  s_cbranch_scc1 L_cf1
  s_mov_b32 s55, s54
  s_lshr_b64 s[54:55], s[54:55], s0
  s_ff0_i32_b32 s56, s54
  s_add_u32 s0, s0, s56
  s_and_b32 s0, s0, 31
  s_lshl_b32 s56, 1, s0
  v_mov_b32 v35, s56
  buffer_atomic_or v35, v1, s[12:15], s57 offen sc0
  s_waitcnt vmcnt(0)
  v_readfirstlane_b32 s54, v35
  s_nop 0
  s_bitcmp1_b32 s54, s0
  s_cbranch_scc1 L_cf0
  v_mov_b32 v35, s0
  s_branch L_cf3
L_cf1:
  v_mov_b32 v35, 1
  buffer_atomic_add v35, v1, s[12:15], 0 offen offset:40 sc0
  s_waitcnt vmcnt(0)
  v_add_u32 v35, 32, v35
L_cf3:
  ds_write_b32 v33, v35
  s_mov_b64 exec, -1
  s_waitcnt lgkmcnt(0)
L_cf2:
  s_barrier
  ds_read_b32 v32, v33
  s_waitcnt lgkmcnt(0)
  v_readfirstlane_b32 s0, v32
  v_mbcnt_lo_u32_b32 v0, -1, 0
  v_mbcnt_hi_u32_b32 v0, -1, v0
  s_mov_b32 s1, 1
  s_cmp_lt_u32 s0, 32
  s_cbranch_scc1 L_role
  s_sub_u32 s53, s0, 32
  s_mov_b32 s57, 0
L_sur:
  s_load_dwordx16 s[60:75], s[12:13], 0 glc
  s_add_u32 s57, s57, 1
  s_waitcnt lgkmcnt(0)
  s_mov_b32 s55, s70
  s_bcnt1_i32_b32 s56, s60
  s_add_u32 s55, s55, s56
  s_bcnt1_i32_b32 s56, s61
  s_add_u32 s55, s55, s56
  s_bcnt1_i32_b32 s56, s62
  s_add_u32 s55, s55, s56
  s_bcnt1_i32_b32 s56, s63
  s_add_u32 s55, s55, s56
  s_bcnt1_i32_b32 s56, s64
  s_add_u32 s55, s55, s56
  s_bcnt1_i32_b32 s56, s65
  s_add_u32 s55, s55, s56
  s_bcnt1_i32_b32 s56, s66
  s_add_u32 s55, s55, s56
  s_bcnt1_i32_b32 s56, s67
  s_add_u32 s55, s55, s56
  s_cmp_ge_u32 s57, 131072
  s_cbranch_scc1 L_end
  s_cmp_lt_u32 s55, 256
  s_cbranch_scc1 L_sur
  s_mov_b32 s2, 0
  s_mov_b32 s54, s60
  s_bcnt0_i32_b32 s56, s54
  s_cmp_lt_u32 s53, s56
  s_cbranch_scc1 L_sur2
  s_sub_u32 s53, s53, s56
  s_mov_b32 s2, 1
  s_mov_b32 s54, s61
  s_bcnt0_i32_b32 s56, s54
  s_cmp_lt_u32 s53, s56
  s_cbranch_scc1 L_sur2
  s_sub_u32 s53, s53, s56
  s_mov_b32 s2, 2
  s_mov_b32 s54, s62
  s_bcnt0_i32_b32 s56, s54
  s_cmp_lt_u32 s53, s56
  s_cbranch_scc1 L_sur2
  s_sub_u32 s53, s53, s56
  s_mov_b32 s2, 3
  s_mov_b32 s54, s63
  s_bcnt0_i32_b32 s56, s54
  s_cmp_lt_u32 s53, s56
  s_cbranch_scc1 L_sur2
  s_sub_u32 s53, s53, s56
  s_mov_b32 s2, 4
  s_mov_b32 s54, s64
  s_bcnt0_i32_b32 s56, s54
  s_cmp_lt_u32 s53, s56
  s_cbranch_scc1 L_sur2
  s_sub_u32 s53, s53, s56
  s_mov_b32 s2, 5
  s_mov_b32 s54, s65
  s_bcnt0_i32_b32 s56, s54
  s_cmp_lt_u32 s53, s56
  s_cbranch_scc1 L_sur2
  s_sub_u32 s53, s53, s56
  s_mov_b32 s2, 6
  s_mov_b32 s54, s66
  s_bcnt0_i32_b32 s56, s54
  s_cmp_lt_u32 s53, s56
  s_cbranch_scc1 L_sur2
  s_sub_u32 s53, s53, s56
  s_mov_b32 s2, 7
  s_mov_b32 s54, s67
  s_bcnt0_i32_b32 s56, s54
  s_cmp_lt_u32 s53, s56
  s_cbranch_scc1 L_sur2
  s_sub_u32 s53, s53, s56
  s_branch L_end
L_sur2:
  s_ff0_i32_b32 s0, s54
  s_bitset1_b32 s54, s0
  s_sub_u32 s53, s53, 1
  s_cbranch_scc0 L_sur2
  s_branch L_role
L_worker:
  s_lshl_b32 s54, s2, 2
  s_lshr_b32 s54, 1412567136, s54
  s_and_b32 s54, s54, 7
  s_lshl_b32 s54, s54, 5
  s_add_u32 s53, s53, s54
  s_getpc_b64 s[80:81]
L_pc_2:
  s_and_b32 s55, s0, 1
  s_lshl_b32 s55, s55, 2
  s_add_u32 s55, s55, s52
  s_lshl_b32 s55, s55, 13
  v_and_b32 v199, 63, v0
  v_lshl_add_u32 v199, v199, 7, s55
  s_sub_u32 s82, s80, (L_pc_2 - L_w0)
  s_subb_u32 s83, s81, 0
  v_min_u32 v198, (L_w4 - L_w0), v199
  global_load_dword v196, v198, s[82:83]
  v_min_u32 v199, (L_end - L_pc_2), v199
  global_load_dword v196, v199, s[80:81]
  v_and_b32 v200, 63, v0
  v_lshlrev_b32 v201, 4, v200
  v_lshrrev_b32 v211, 3, v200
  s_lshl_b32 s54, s52, 3
  v_add_u32 v211, s54, v211
  v_bfe_u32 v212, v211, 1, 3
  v_and_b32 v213, 7, v200
  v_xor_b32 v212, v212, v213
  v_mul_u32_u24 v211, 1152, v211
  v_lshl_add_u32 v202, v212, 4, v211
  s_mul_i32 s67, s52, 9216
  v_and_b32 v211, 31, v200
  v_lshrrev_b32 v212, 3, v211
  v_mul_u32_u24 v212, 9216, v212
  v_and_b32 v213, 7, v211
  v_lshl_add_u32 v212, v213, 7, v212
  v_bfe_u32 v213, v211, 1, 3
  v_lshrrev_b32 v214, 5, v200
  v_xor_b32 v213, v213, v214
  v_lshl_add_u32 v203, v213, 4, v212
  v_xor_b32 v204, 32, v203
  v_xor_b32 v205, 64, v203
  v_xor_b32 v206, 0x60, v203
  v_bfe_u32 v211, v200, 2, 2
  v_lshl_add_u32 v212, v214, 3, v211
  v_lshlrev_b32 v212, 8, v212
  v_xor_b32 v211, s52, v211
  v_lshl_add_u32 v212, v211, 6, v212
  v_bfe_u32 v213, v200, 4, 1
  v_and_b32 v211, 3, v200
  v_lshl_add_u32 v210, v213, 5, v212
  v_lshl_add_u32 v210, v211, 3, v210
  v_lshl_add_u32 v209, v213, 4, v212
  v_and_b32 v213, 1, v211
  v_lshl_add_u32 v209, v213, 3, v209
  v_lshrrev_b32 v213, 1, v211
  v_lshl_add_u32 v209, v213, 5, v209
  s_mov_b32 s65, 0
  s_mul_i32 s58, s53, 9363
  s_lshr_b32 s58, s58, 16
  s_mul_i32 s54, s58, 7
  s_sub_u32 s59, s53, s54
  s_mul_i32 s60, s59, 36864
  s_add_u32 m0, s67, 0
  s_nop 0
  buffer_load_dwordx4 v202, s[4:7], s60 offen offset:0 lds
  s_add_u32 m0, s67, 896
  s_nop 0
  buffer_load_dwordx4 v202, s[4:7], s60 offen offset:128 lds
  s_add_u32 m0, s67, 1792
  s_nop 0
  buffer_load_dwordx4 v202, s[4:7], s60 offen offset:256 lds
  s_add_u32 m0, s67, 2688
  s_nop 0
  buffer_load_dwordx4 v202, s[4:7], s60 offen offset:384 lds
  s_add_u32 m0, s67, 3584
  s_nop 0
  buffer_load_dwordx4 v202, s[4:7], s60 offen offset:512 lds
  s_add_u32 m0, s67, 4480
  s_nop 0
  buffer_load_dwordx4 v202, s[4:7], s60 offen offset:640 lds
  s_add_u32 m0, s67, 5376
  s_nop 0
  buffer_load_dwordx4 v202, s[4:7], s60 offen offset:768 lds
  s_add_u32 m0, s67, 6272
  s_nop 0
  buffer_load_dwordx4 v202, s[4:7], s60 offen offset:896 lds
  s_add_u32 m0, s67, 7168
  s_nop 0
  buffer_load_dwordx4 v202, s[4:7], s60 offen offset:1024 lds
  v_lshrrev_b32 v211, 4, v200
  v_lshlrev_b32 v212, 2, v211
  v_and_b32 v213, 15, v200
  v_xor_b32 v212, v212, v213
  v_lshlrev_b32 v212, 4, v212
  v_lshl_add_u32 v207, v211, 13, v212
  s_lshl_b32 s62, s58, 8
  s_lshl_b32 s54, s52, 15
  s_add_u32 s62, s62, s54
  s_lshl_b32 s61, s52, 10
  s_add_u32 s61, s61, 36864
  s_add_u32 m0, s61, 0
  s_add_u32 s54, s62, 0
  buffer_load_dwordx4 v207, s[20:23], s54 offen lds
  s_add_u32 m0, s61, 4096
  s_add_u32 s54, s62, 131072
  buffer_load_dwordx4 v207, s[20:23], s54 offen lds
  s_add_u32 m0, s61, 8192
  s_add_u32 s54, s62, 262144
  buffer_load_dwordx4 v207, s[20:23], s54 offen lds
  s_add_u32 m0, s61, 12288
  s_add_u32 s54, s62, 393216
  buffer_load_dwordx4 v207, s[20:23], s54 offen lds
  s_add_u32 m0, s61, 16384
  s_add_u32 s54, s62, 0
  buffer_load_dwordx4 v207, s[24:27], s54 offen lds
  s_add_u32 m0, s61, 20480
  s_add_u32 s54, s62, 131072
  buffer_load_dwordx4 v207, s[24:27], s54 offen lds
  s_add_u32 m0, s61, 24576
  s_add_u32 s54, s62, 262144
  buffer_load_dwordx4 v207, s[24:27], s54 offen lds
  s_add_u32 m0, s61, 28672
  s_add_u32 s54, s62, 393216
  buffer_load_dwordx4 v207, s[24:27], s54 offen lds
  s_add_u32 m0, s61, 32768
  s_add_u32 s54, s62, 524288
  buffer_load_dwordx4 v207, s[20:23], s54 offen lds
  s_add_u32 m0, s61, 36864
  s_add_u32 s54, s62, 655360
  buffer_load_dwordx4 v207, s[20:23], s54 offen lds
  s_add_u32 m0, s61, 40960
  s_add_u32 s54, s62, 786432
  buffer_load_dwordx4 v207, s[20:23], s54 offen lds
  s_add_u32 m0, s61, 45056
  s_add_u32 s54, s62, 917504
  buffer_load_dwordx4 v207, s[20:23], s54 offen lds
  s_add_u32 m0, s61, 49152
  s_add_u32 s54, s62, 524288
  buffer_load_dwordx4 v207, s[24:27], s54 offen lds
  s_add_u32 m0, s61, 53248
  s_add_u32 s54, s62, 655360
  buffer_load_dwordx4 v207, s[24:27], s54 offen lds
  s_add_u32 m0, s61, 57344
  s_add_u32 s54, s62, 786432
  buffer_load_dwordx4 v207, s[24:27], s54 offen lds
  s_add_u32 m0, s61, 61440
  s_add_u32 s54, s62, 917504
  buffer_load_dwordx4 v207, s[24:27], s54 offen lds
  s_add_u32 m0, s61, 65536
  s_add_u32 s54, s62, 1048576
  buffer_load_dwordx4 v207, s[20:23], s54 offen lds
  s_add_u32 m0, s61, 69632
  s_add_u32 s54, s62, 1179648
  buffer_load_dwordx4 v207, s[20:23], s54 offen lds
  s_add_u32 m0, s61, 73728
  s_add_u32 s54, s62, 1310720
  buffer_load_dwordx4 v207, s[20:23], s54 offen lds
  s_add_u32 m0, s61, 77824
  s_add_u32 s54, s62, 1441792
  buffer_load_dwordx4 v207, s[20:23], s54 offen lds
  s_add_u32 m0, s61, 81920
  s_add_u32 s54, s62, 1048576
  buffer_load_dwordx4 v207, s[24:27], s54 offen lds
  s_add_u32 m0, s61, 86016
  s_add_u32 s54, s62, 1179648
  buffer_load_dwordx4 v207, s[24:27], s54 offen lds
  s_add_u32 m0, s61, 90112
  s_add_u32 s54, s62, 1310720
  buffer_load_dwordx4 v207, s[24:27], s54 offen lds
  s_add_u32 m0, s61, 94208
  s_add_u32 s54, s62, 1441792
  buffer_load_dwordx4 v207, s[24:27], s54 offen lds
  v_bfe_u32 v211, v200, 3, 2
  v_lshlrev_b32 v216, 11, v211
  v_bfe_u32 v211, v200, 1, 2
  v_lshl_add_u32 v216, v211, 6, v216
  v_lshrrev_b32 v212, 5, v200
  v_lshl_add_u32 v216, v212, 5, v216
  v_and_b32 v211, 1, v200
  v_lshl_add_u32 v216, v211, 4, v216
  v_bfe_u32 v211, v200, 4, 1
  v_lshlrev_b32 v217, 10, v211
  v_lshl_add_u32 v217, v212, 9, v217
  v_and_b32 v211, 15, v200
  v_lshl_add_u32 v217, v211, 4, v217
  s_lshl_b32 s54, s52, 11
  s_add_u32 s54, s54, 8192
  v_add_u32 v217, s54, v217
  s_waitcnt vmcnt(20) lgkmcnt(0)
  s_barrier
  s_add_u32 m0, s61, 98304
  s_add_u32 s54, s62, 1572864
  buffer_load_dwordx4 v207, s[20:23], s54 offen lds
  s_add_u32 m0, s61, 102400
  s_add_u32 s54, s62, 1703936
  buffer_load_dwordx4 v207, s[20:23], s54 offen lds
  s_add_u32 m0, s61, 106496
  s_add_u32 s54, s62, 1835008
  buffer_load_dwordx4 v207, s[20:23], s54 offen lds
  s_add_u32 m0, s61, 110592
  s_add_u32 s54, s62, 1966080
  buffer_load_dwordx4 v207, s[20:23], s54 offen lds
  v_add_u32 v215, 36864, v209
  ds_read_b64_tr_b16 a[0:1], v215 offset:0
  ds_read_b64_tr_b16 a[2:3], v215 offset:1024
  ds_read_b64_tr_b16 a[4:5], v215 offset:4096
  ds_read_b64_tr_b16 a[6:7], v215 offset:5120
  ds_read_b64_tr_b16 a[8:9], v215 offset:8192
  ds_read_b64_tr_b16 a[10:11], v215 offset:9216
  ds_read_b64_tr_b16 a[12:13], v215 offset:12288
  ds_read_b64_tr_b16 a[14:15], v215 offset:13312
  s_waitcnt vmcnt(20) lgkmcnt(0)
  s_barrier
  s_add_u32 m0, s61, 0
  s_add_u32 s54, s62, 1572864
  buffer_load_dwordx4 v207, s[24:27], s54 offen lds
  s_add_u32 m0, s61, 4096
  s_add_u32 s54, s62, 1703936
  buffer_load_dwordx4 v207, s[24:27], s54 offen lds
  s_add_u32 m0, s61, 8192
  s_add_u32 s54, s62, 1835008
  buffer_load_dwordx4 v207, s[24:27], s54 offen lds
  s_add_u32 m0, s61, 12288
  s_add_u32 s54, s62, 1966080
  buffer_load_dwordx4 v207, s[24:27], s54 offen lds
  v_add_u32 v215, 53248, v210
  ds_read_b64_tr_b16 a[144:145], v215 offset:0
  ds_read_b64_tr_b16 a[146:147], v215 offset:1024
  ds_read_b64_tr_b16 a[148:149], v215 offset:4096
  ds_read_b64_tr_b16 a[150:151], v215 offset:5120
  ds_read_b64_tr_b16 a[152:153], v215 offset:8192
  ds_read_b64_tr_b16 a[154:155], v215 offset:9216
  ds_read_b64_tr_b16 a[156:157], v215 offset:12288
  ds_read_b64_tr_b16 a[158:159], v215 offset:13312
  s_waitcnt vmcnt(20) lgkmcnt(0)
  s_barrier
  s_add_u32 m0, s61, 16384
  s_add_u32 s54, s62, 2097152
  buffer_load_dwordx4 v207, s[20:23], s54 offen lds
  s_add_u32 m0, s61, 20480
  s_add_u32 s54, s62, 2228224
  buffer_load_dwordx4 v207, s[20:23], s54 offen lds
  s_add_u32 m0, s61, 24576
  s_add_u32 s54, s62, 2359296
  buffer_load_dwordx4 v207, s[20:23], s54 offen lds
  s_add_u32 m0, s61, 28672
  s_add_u32 s54, s62, 2490368
  buffer_load_dwordx4 v207, s[20:23], s54 offen lds
  v_add_u32 v215, 69632, v209
  ds_read_b64_tr_b16 a[16:17], v215 offset:0
  ds_read_b64_tr_b16 a[18:19], v215 offset:1024
  ds_read_b64_tr_b16 a[20:21], v215 offset:4096
  ds_read_b64_tr_b16 a[22:23], v215 offset:5120
  ds_read_b64_tr_b16 a[24:25], v215 offset:8192
  ds_read_b64_tr_b16 a[26:27], v215 offset:9216
  ds_read_b64_tr_b16 a[28:29], v215 offset:12288
  ds_read_b64_tr_b16 a[30:31], v215 offset:13312
  s_waitcnt vmcnt(20) lgkmcnt(0)
  s_barrier
  s_add_u32 m0, s61, 32768
  s_add_u32 s54, s62, 2097152
  buffer_load_dwordx4 v207, s[24:27], s54 offen lds
  s_add_u32 m0, s61, 36864
  s_add_u32 s54, s62, 2228224
  buffer_load_dwordx4 v207, s[24:27], s54 offen lds
  s_add_u32 m0, s61, 40960
  s_add_u32 s54, s62, 2359296
  buffer_load_dwordx4 v207, s[24:27], s54 offen lds
  s_add_u32 m0, s61, 45056
  s_add_u32 s54, s62, 2490368
  buffer_load_dwordx4 v207, s[24:27], s54 offen lds
  v_add_u32 v215, 86016, v210
  ds_read_b64_tr_b16 a[160:161], v215 offset:0
  ds_read_b64_tr_b16 a[162:163], v215 offset:1024
  ds_read_b64_tr_b16 a[164:165], v215 offset:4096
  ds_read_b64_tr_b16 a[166:167], v215 offset:5120
  ds_read_b64_tr_b16 a[168:169], v215 offset:8192
  ds_read_b64_tr_b16 a[170:171], v215 offset:9216
  ds_read_b64_tr_b16 a[172:173], v215 offset:12288
  ds_read_b64_tr_b16 a[174:175], v215 offset:13312
  s_waitcnt vmcnt(20) lgkmcnt(0)
  s_barrier
  s_add_u32 m0, s61, 49152
  s_add_u32 s54, s62, 2621440
  buffer_load_dwordx4 v207, s[20:23], s54 offen lds
  s_add_u32 m0, s61, 53248
  s_add_u32 s54, s62, 2752512
  buffer_load_dwordx4 v207, s[20:23], s54 offen lds
  s_add_u32 m0, s61, 57344
  s_add_u32 s54, s62, 2883584
  buffer_load_dwordx4 v207, s[20:23], s54 offen lds
  s_add_u32 m0, s61, 61440
  s_add_u32 s54, s62, 3014656
  buffer_load_dwordx4 v207, s[20:23], s54 offen lds
  v_add_u32 v215, 102400, v209
  ds_read_b64_tr_b16 a[32:33], v215 offset:0
  ds_read_b64_tr_b16 a[34:35], v215 offset:1024
  ds_read_b64_tr_b16 a[36:37], v215 offset:4096
  ds_read_b64_tr_b16 a[38:39], v215 offset:5120
  ds_read_b64_tr_b16 a[40:41], v215 offset:8192
  ds_read_b64_tr_b16 a[42:43], v215 offset:9216
  ds_read_b64_tr_b16 a[44:45], v215 offset:12288
  ds_read_b64_tr_b16 a[46:47], v215 offset:13312
  s_waitcnt vmcnt(20) lgkmcnt(0)
  s_barrier
  s_add_u32 m0, s61, 65536
  s_add_u32 s54, s62, 2621440
  buffer_load_dwordx4 v207, s[24:27], s54 offen lds
  s_add_u32 m0, s61, 69632
  s_add_u32 s54, s62, 2752512
  buffer_load_dwordx4 v207, s[24:27], s54 offen lds
  s_add_u32 m0, s61, 73728
  s_add_u32 s54, s62, 2883584
  buffer_load_dwordx4 v207, s[24:27], s54 offen lds
  s_add_u32 m0, s61, 77824
  s_add_u32 s54, s62, 3014656
  buffer_load_dwordx4 v207, s[24:27], s54 offen lds
  v_add_u32 v215, 118784, v210
  ds_read_b64_tr_b16 a[176:177], v215 offset:0
  ds_read_b64_tr_b16 a[178:179], v215 offset:1024
  ds_read_b64_tr_b16 a[180:181], v215 offset:4096
  ds_read_b64_tr_b16 a[182:183], v215 offset:5120
  ds_read_b64_tr_b16 a[184:185], v215 offset:8192
  ds_read_b64_tr_b16 a[186:187], v215 offset:9216
  ds_read_b64_tr_b16 a[188:189], v215 offset:12288
  ds_read_b64_tr_b16 a[190:191], v215 offset:13312
  s_waitcnt vmcnt(20) lgkmcnt(0)
  s_barrier
  s_add_u32 m0, s61, 81920
  s_add_u32 s54, s62, 3145728
  buffer_load_dwordx4 v207, s[20:23], s54 offen lds
  s_add_u32 m0, s61, 86016
  s_add_u32 s54, s62, 3276800
  buffer_load_dwordx4 v207, s[20:23], s54 offen lds
  s_add_u32 m0, s61, 90112
  s_add_u32 s54, s62, 3407872
  buffer_load_dwordx4 v207, s[20:23], s54 offen lds
  s_add_u32 m0, s61, 94208
  s_add_u32 s54, s62, 3538944
  buffer_load_dwordx4 v207, s[20:23], s54 offen lds
  v_add_u32 v215, 135168, v209
  ds_read_b64_tr_b16 a[48:49], v215 offset:0
  ds_read_b64_tr_b16 a[50:51], v215 offset:1024
  ds_read_b64_tr_b16 a[52:53], v215 offset:4096
  ds_read_b64_tr_b16 a[54:55], v215 offset:5120
  ds_read_b64_tr_b16 a[56:57], v215 offset:8192
  ds_read_b64_tr_b16 a[58:59], v215 offset:9216
  ds_read_b64_tr_b16 a[60:61], v215 offset:12288
  ds_read_b64_tr_b16 a[62:63], v215 offset:13312
  s_waitcnt vmcnt(20) lgkmcnt(0)
  s_barrier
  s_add_u32 m0, s61, 98304
  s_add_u32 s54, s62, 3145728
  buffer_load_dwordx4 v207, s[24:27], s54 offen lds
  s_add_u32 m0, s61, 102400
  s_add_u32 s54, s62, 3276800
  buffer_load_dwordx4 v207, s[24:27], s54 offen lds
  s_add_u32 m0, s61, 106496
  s_add_u32 s54, s62, 3407872
  buffer_load_dwordx4 v207, s[24:27], s54 offen lds
  s_add_u32 m0, s61, 110592
  s_add_u32 s54, s62, 3538944
  buffer_load_dwordx4 v207, s[24:27], s54 offen lds
  v_add_u32 v215, 36864, v210
  ds_read_b64_tr_b16 a[192:193], v215 offset:0
  ds_read_b64_tr_b16 a[194:195], v215 offset:1024
  ds_read_b64_tr_b16 a[196:197], v215 offset:4096
  ds_read_b64_tr_b16 a[198:199], v215 offset:5120
  ds_read_b64_tr_b16 a[200:201], v215 offset:8192
  ds_read_b64_tr_b16 a[202:203], v215 offset:9216
  ds_read_b64_tr_b16 a[204:205], v215 offset:12288
  ds_read_b64_tr_b16 a[206:207], v215 offset:13312
  s_waitcnt vmcnt(20) lgkmcnt(0)
  s_barrier
  s_add_u32 m0, s61, 0
  s_add_u32 s54, s62, 3670016
  buffer_load_dwordx4 v207, s[20:23], s54 offen lds
  s_add_u32 m0, s61, 4096
  s_add_u32 s54, s62, 3801088
  buffer_load_dwordx4 v207, s[20:23], s54 offen lds
  s_add_u32 m0, s61, 8192
  s_add_u32 s54, s62, 3932160
  buffer_load_dwordx4 v207, s[20:23], s54 offen lds
  s_add_u32 m0, s61, 12288
  s_add_u32 s54, s62, 4063232
  buffer_load_dwordx4 v207, s[20:23], s54 offen lds
  v_add_u32 v215, 53248, v209
  ds_read_b64_tr_b16 a[64:65], v215 offset:0
  ds_read_b64_tr_b16 a[66:67], v215 offset:1024
  ds_read_b64_tr_b16 a[68:69], v215 offset:4096
  ds_read_b64_tr_b16 a[70:71], v215 offset:5120
  ds_read_b64_tr_b16 a[72:73], v215 offset:8192
  ds_read_b64_tr_b16 a[74:75], v215 offset:9216
  ds_read_b64_tr_b16 a[76:77], v215 offset:12288
  ds_read_b64_tr_b16 a[78:79], v215 offset:13312
  s_waitcnt vmcnt(20) lgkmcnt(0)
  s_barrier
  s_add_u32 m0, s61, 16384
  s_add_u32 s54, s62, 3670016
  buffer_load_dwordx4 v207, s[24:27], s54 offen lds
  s_add_u32 m0, s61, 20480
  s_add_u32 s54, s62, 3801088
  buffer_load_dwordx4 v207, s[24:27], s54 offen lds
  s_add_u32 m0, s61, 24576
  s_add_u32 s54, s62, 3932160
  buffer_load_dwordx4 v207, s[24:27], s54 offen lds
  s_add_u32 m0, s61, 28672
  s_add_u32 s54, s62, 4063232
  buffer_load_dwordx4 v207, s[24:27], s54 offen lds
  v_add_u32 v215, 69632, v210
  ds_read_b64_tr_b16 a[208:209], v215 offset:0
  ds_read_b64_tr_b16 a[210:211], v215 offset:1024
  ds_read_b64_tr_b16 a[212:213], v215 offset:4096
  ds_read_b64_tr_b16 a[214:215], v215 offset:5120
  ds_read_b64_tr_b16 a[216:217], v215 offset:8192
  ds_read_b64_tr_b16 a[218:219], v215 offset:9216
  ds_read_b64_tr_b16 a[220:221], v215 offset:12288
  ds_read_b64_tr_b16 a[222:223], v215 offset:13312
  s_waitcnt vmcnt(20) lgkmcnt(0)
  s_barrier
  s_add_u32 m0, s61, 32768
  s_add_u32 s54, s62, 4194304
  buffer_load_dwordx4 v207, s[20:23], s54 offen lds
  s_add_u32 m0, s61, 36864
  s_add_u32 s54, s62, 4325376
  buffer_load_dwordx4 v207, s[20:23], s54 offen lds
  s_add_u32 m0, s61, 40960
  s_add_u32 s54, s62, 4456448
  buffer_load_dwordx4 v207, s[20:23], s54 offen lds
  s_add_u32 m0, s61, 45056
  s_add_u32 s54, s62, 4587520
  buffer_load_dwordx4 v207, s[20:23], s54 offen lds
  v_add_u32 v215, 86016, v209
  ds_read_b64_tr_b16 a[80:81], v215 offset:0
  ds_read_b64_tr_b16 a[82:83], v215 offset:1024
  ds_read_b64_tr_b16 a[84:85], v215 offset:4096
  ds_read_b64_tr_b16 a[86:87], v215 offset:5120
  ds_read_b64_tr_b16 a[88:89], v215 offset:8192
  ds_read_b64_tr_b16 a[90:91], v215 offset:9216
  ds_read_b64_tr_b16 a[92:93], v215 offset:12288
  ds_read_b64_tr_b16 a[94:95], v215 offset:13312
  s_waitcnt vmcnt(20) lgkmcnt(0)
  s_barrier
  s_add_u32 m0, s61, 49152
  s_add_u32 s54, s62, 4194304
  buffer_load_dwordx4 v207, s[24:27], s54 offen lds
  s_add_u32 m0, s61, 53248
  s_add_u32 s54, s62, 4325376
  buffer_load_dwordx4 v207, s[24:27], s54 offen lds
  s_add_u32 m0, s61, 57344
  s_add_u32 s54, s62, 4456448
  buffer_load_dwordx4 v207, s[24:27], s54 offen lds
  s_add_u32 m0, s61, 61440
  s_add_u32 s54, s62, 4587520
  buffer_load_dwordx4 v207, s[24:27], s54 offen lds
  s_mul_i32 s54, s53, 21120
  s_lshl_b32 s55, s52, 13
  s_add_u32 s54, s54, s55
  s_cmp_eq_u32 s52, 3
  s_cselect_b32 s54, 0x10000000, s54
  v_lshlrev_b32 v211, 3, v201
  buffer_load_dword v196, v211, s[28:31], s54 offen
  v_add_u32 v215, 102400, v210
  ds_read_b64_tr_b16 a[224:225], v215 offset:0
  ds_read_b64_tr_b16 a[226:227], v215 offset:1024
  ds_read_b64_tr_b16 a[228:229], v215 offset:4096
  ds_read_b64_tr_b16 a[230:231], v215 offset:5120
  ds_read_b64_tr_b16 a[232:233], v215 offset:8192
  ds_read_b64_tr_b16 a[234:235], v215 offset:9216
  ds_read_b64_tr_b16 a[236:237], v215 offset:12288
  ds_read_b64_tr_b16 a[238:239], v215 offset:13312
  s_waitcnt vmcnt(21) lgkmcnt(0)
  s_barrier
  s_lshl_b32 s54, s53, 13
  s_lshr_b32 s55, s53, 6
  s_or_b32 s55, s55, s52
  s_cmp_eq_u32 s55, 0
  s_cselect_b32 s54, s54, 0x10000000
  v_lshlrev_b32 v211, 3, v201
  s_add_u32 s54, s54, 3145728
  buffer_load_dword v196, v211, s[16:19], s54 offen
  v_add_u32 v215, 118784, v209
  ds_read_b64_tr_b16 a[96:97], v215 offset:0
  ds_read_b64_tr_b16 a[98:99], v215 offset:1024
  ds_read_b64_tr_b16 a[100:101], v215 offset:4096
  ds_read_b64_tr_b16 a[102:103], v215 offset:5120
  ds_read_b64_tr_b16 a[104:105], v215 offset:8192
  ds_read_b64_tr_b16 a[106:107], v215 offset:9216
  ds_read_b64_tr_b16 a[108:109], v215 offset:12288
  ds_read_b64_tr_b16 a[110:111], v215 offset:13312
  s_waitcnt vmcnt(18) lgkmcnt(0)
  s_barrier
  s_lshl_b32 s55, s2, 2
  s_or_b32 s56, s52, s1
  s_cmp_eq_u32 s56, 0
  s_cselect_b32 s55, s55, 0x1000
  s_lshl_b32 s56, 1, s0
  v_mov_b32 v197, s56
  s_mov_b64 exec, 1
  buffer_atomic_or v197, off, s[12:15], s55 sc0
  s_mov_b64 exec, -1
  v_add_u32 v215, 135168, v210
  ds_read_b64_tr_b16 a[240:241], v215 offset:0
  ds_read_b64_tr_b16 a[242:243], v215 offset:1024
  ds_read_b64_tr_b16 a[244:245], v215 offset:4096
  ds_read_b64_tr_b16 a[246:247], v215 offset:5120
  ds_read_b64_tr_b16 a[248:249], v215 offset:8192
  ds_read_b64_tr_b16 a[250:251], v215 offset:9216
  ds_read_b64_tr_b16 a[252:253], v215 offset:12288
  ds_read_b64_tr_b16 a[254:255], v215 offset:13312
  s_waitcnt vmcnt(15) lgkmcnt(0)
  s_barrier
  v_add_u32 v215, 36864, v209
  ds_read_b64_tr_b16 a[112:113], v215 offset:0
  ds_read_b64_tr_b16 a[114:115], v215 offset:1024
  ds_read_b64_tr_b16 a[116:117], v215 offset:4096
  ds_read_b64_tr_b16 a[118:119], v215 offset:5120
  ds_read_b64_tr_b16 a[120:121], v215 offset:8192
  ds_read_b64_tr_b16 a[122:123], v215 offset:9216
  ds_read_b64_tr_b16 a[124:125], v215 offset:12288
  ds_read_b64_tr_b16 a[126:127], v215 offset:13312
  s_waitcnt vmcnt(11) lgkmcnt(0)
  s_barrier
  v_add_u32 v215, 53248, v210
  ds_read_b64_tr_b16 v[224:225], v215 offset:0
  ds_read_b64_tr_b16 v[226:227], v215 offset:1024
  ds_read_b64_tr_b16 v[228:229], v215 offset:4096
  ds_read_b64_tr_b16 v[230:231], v215 offset:5120
  ds_read_b64_tr_b16 v[232:233], v215 offset:8192
  ds_read_b64_tr_b16 v[234:235], v215 offset:9216
  ds_read_b64_tr_b16 v[236:237], v215 offset:12288
  ds_read_b64_tr_b16 v[238:239], v215 offset:13312
  s_waitcnt vmcnt(7) lgkmcnt(0)
  s_barrier
  v_add_u32 v215, 69632, v209
  ds_read_b64_tr_b16 a[128:129], v215 offset:0
  ds_read_b64_tr_b16 a[130:131], v215 offset:1024
  ds_read_b64_tr_b16 a[132:133], v215 offset:4096
  ds_read_b64_tr_b16 a[134:135], v215 offset:5120
  ds_read_b64_tr_b16 a[136:137], v215 offset:8192
  ds_read_b64_tr_b16 a[138:139], v215 offset:9216
  ds_read_b64_tr_b16 a[140:141], v215 offset:12288
  ds_read_b64_tr_b16 a[142:143], v215 offset:13312
  s_waitcnt vmcnt(3) lgkmcnt(0)
  s_barrier
  v_add_u32 v215, 86016, v210
  ds_read_b64_tr_b16 v[240:241], v215 offset:0
  ds_read_b64_tr_b16 v[242:243], v215 offset:1024
  ds_read_b64_tr_b16 v[244:245], v215 offset:4096
  ds_read_b64_tr_b16 v[246:247], v215 offset:5120
  ds_read_b64_tr_b16 v[248:249], v215 offset:8192
  ds_read_b64_tr_b16 v[250:251], v215 offset:9216
  ds_read_b64_tr_b16 v[252:253], v215 offset:12288
  ds_read_b64_tr_b16 v[254:255], v215 offset:13312
  s_waitcnt lgkmcnt(0)
  s_barrier
  s_mov_b32 s68, 1040356334
  s_lshl_b32 s69, s52, 9
  s_lshl_b32 s70, s58, 2
  s_add_u32 s70, s70, 128
  s_mul_i32 s66, s58, -12288
  s_lshl_b32 s54, s52, 10
  s_add_u32 s66, s66, s54
  s_add_u32 s66, s66, 524288
  v_mov_b32 v64, -1
  v_mov_b32 v65, -1
  v_mov_b32 v66, -1
  v_mov_b32 v67, -1
  s_add_u32 s60, s60, 258048
  ds_read_b128 v[32:35], v203 offset:0
  ds_read_b128 v[36:39], v204 offset:0
  ds_read_b128 v[40:43], v205 offset:0
  s_waitcnt lgkmcnt(2)
  v_mfma_f32_32x32x16_bf16 v[0:15], a[0:3], v[32:35], 0
  ds_read_b128 v[44:47], v206 offset:0
  s_add_u32 m0, s67, 36864
  s_nop 0
  buffer_load_dwordx4 v202, s[4:7], s60 offen offset:0 lds
  v_mfma_f32_32x32x16_bf16 v[16:31], v[32:35], a[144:147], 0
  s_waitcnt lgkmcnt(2)
  v_mfma_f32_32x32x16_bf16 v[0:15], a[4:7], v[36:39], v[0:15]
  ds_read_b128 v[32:35], v203 offset:1024
  s_add_u32 m0, s67, 37760
  s_nop 0
  buffer_load_dwordx4 v202, s[4:7], s60 offen offset:128 lds
  v_mfma_f32_32x32x16_bf16 v[16:31], v[36:39], a[148:151], v[16:31]
  s_waitcnt lgkmcnt(2)
  v_mfma_f32_32x32x16_bf16 v[0:15], a[8:11], v[40:43], v[0:15]
  ds_read_b128 v[36:39], v204 offset:1024
  s_add_u32 m0, s67, 38656
  s_nop 0
  buffer_load_dwordx4 v202, s[4:7], s60 offen offset:256 lds
  v_mfma_f32_32x32x16_bf16 v[16:31], v[40:43], a[152:155], v[16:31]
  s_waitcnt lgkmcnt(2)
  v_mfma_f32_32x32x16_bf16 v[0:15], a[12:15], v[44:47], v[0:15]
  ds_read_b128 v[40:43], v205 offset:1024
  s_add_u32 m0, s67, 39552
  s_nop 0
  buffer_load_dwordx4 v202, s[4:7], s60 offen offset:384 lds
  v_mfma_f32_32x32x16_bf16 v[16:31], v[44:47], a[156:159], v[16:31]
  s_waitcnt lgkmcnt(2)
  v_mfma_f32_32x32x16_bf16 v[0:15], a[16:19], v[32:35], v[0:15]
  ds_read_b128 v[44:47], v206 offset:1024
  s_add_u32 m0, s67, 40448
  s_nop 0
  buffer_load_dwordx4 v202, s[4:7], s60 offen offset:512 lds
  v_mfma_f32_32x32x16_bf16 v[16:31], v[32:35], a[160:163], v[16:31]
  s_waitcnt lgkmcnt(2)
  v_mfma_f32_32x32x16_bf16 v[0:15], a[20:23], v[36:39], v[0:15]
  ds_read_b128 v[32:35], v203 offset:2048
  s_add_u32 m0, s67, 41344
  s_nop 0
  buffer_load_dwordx4 v202, s[4:7], s60 offen offset:640 lds
  v_mfma_f32_32x32x16_bf16 v[16:31], v[36:39], a[164:167], v[16:31]
  s_waitcnt lgkmcnt(2)
  v_mfma_f32_32x32x16_bf16 v[0:15], a[24:27], v[40:43], v[0:15]
  ds_read_b128 v[36:39], v204 offset:2048
  s_add_u32 m0, s67, 42240
  s_nop 0
  buffer_load_dwordx4 v202, s[4:7], s60 offen offset:768 lds
  v_mfma_f32_32x32x16_bf16 v[16:31], v[40:43], a[168:171], v[16:31]
  s_waitcnt lgkmcnt(2)
  v_mfma_f32_32x32x16_bf16 v[0:15], a[28:31], v[44:47], v[0:15]
  ds_read_b128 v[40:43], v205 offset:2048
  s_add_u32 m0, s67, 43136
  s_nop 0
  buffer_load_dwordx4 v202, s[4:7], s60 offen offset:896 lds
  v_mfma_f32_32x32x16_bf16 v[16:31], v[44:47], a[172:175], v[16:31]
  s_waitcnt lgkmcnt(2)
  v_mfma_f32_32x32x16_bf16 v[0:15], a[32:35], v[32:35], v[0:15]
  ds_read_b128 v[44:47], v206 offset:2048
  s_add_u32 m0, s67, 44032
  s_nop 0
  buffer_load_dwordx4 v202, s[4:7], s60 offen offset:1024 lds
  v_mfma_f32_32x32x16_bf16 v[16:31], v[32:35], a[176:179], v[16:31]
  s_waitcnt lgkmcnt(2)
  v_mfma_f32_32x32x16_bf16 v[0:15], a[36:39], v[36:39], v[0:15]
  ds_read_b128 v[32:35], v203 offset:3072
  v_mfma_f32_32x32x16_bf16 v[16:31], v[36:39], a[180:183], v[16:31]
  s_waitcnt lgkmcnt(2)
  v_mfma_f32_32x32x16_bf16 v[0:15], a[40:43], v[40:43], v[0:15]
  ds_read_b128 v[36:39], v204 offset:3072
  v_mfma_f32_32x32x16_bf16 v[16:31], v[40:43], a[184:187], v[16:31]
  s_waitcnt lgkmcnt(2)
  v_mfma_f32_32x32x16_bf16 v[0:15], a[44:47], v[44:47], v[0:15]
  ds_read_b128 v[40:43], v205 offset:3072
  v_mfma_f32_32x32x16_bf16 v[16:31], v[44:47], a[188:191], v[16:31]
  s_waitcnt lgkmcnt(2)
  v_mfma_f32_32x32x16_bf16 v[0:15], a[48:51], v[32:35], v[0:15]
  ds_read_b128 v[44:47], v206 offset:3072
  v_mfma_f32_32x32x16_bf16 v[16:31], v[32:35], a[192:195], v[16:31]
  s_waitcnt lgkmcnt(2)
  v_mfma_f32_32x32x16_bf16 v[0:15], a[52:55], v[36:39], v[0:15]
  ds_read_b128 v[32:35], v203 offset:4096
  v_mfma_f32_32x32x16_bf16 v[16:31], v[36:39], a[196:199], v[16:31]
  s_waitcnt lgkmcnt(2)
  v_mfma_f32_32x32x16_bf16 v[0:15], a[56:59], v[40:43], v[0:15]
  ds_read_b128 v[36:39], v204 offset:4096
  v_mfma_f32_32x32x16_bf16 v[16:31], v[40:43], a[200:203], v[16:31]
  s_waitcnt lgkmcnt(2)
  v_mfma_f32_32x32x16_bf16 v[0:15], a[60:63], v[44:47], v[0:15]
  ds_read_b128 v[40:43], v205 offset:4096
  v_mfma_f32_32x32x16_bf16 v[16:31], v[44:47], a[204:207], v[16:31]
  s_waitcnt lgkmcnt(2)
  v_mfma_f32_32x32x16_bf16 v[0:15], a[64:67], v[32:35], v[0:15]
  ds_read_b128 v[44:47], v206 offset:4096
  v_mfma_f32_32x32x16_bf16 v[16:31], v[32:35], a[208:211], v[16:31]
  s_waitcnt lgkmcnt(2)
  v_mfma_f32_32x32x16_bf16 v[0:15], a[68:71], v[36:39], v[0:15]
  ds_read_b128 v[32:35], v203 offset:5120
  v_mfma_f32_32x32x16_bf16 v[16:31], v[36:39], a[212:215], v[16:31]
  s_waitcnt lgkmcnt(2)
  v_mfma_f32_32x32x16_bf16 v[0:15], a[72:75], v[40:43], v[0:15]
  ds_read_b128 v[36:39], v204 offset:5120
  v_mfma_f32_32x32x16_bf16 v[16:31], v[40:43], a[216:219], v[16:31]
  s_waitcnt lgkmcnt(2)
  v_mfma_f32_32x32x16_bf16 v[0:15], a[76:79], v[44:47], v[0:15]
  ds_read_b128 v[40:43], v205 offset:5120
  v_mfma_f32_32x32x16_bf16 v[16:31], v[44:47], a[220:223], v[16:31]
  s_waitcnt lgkmcnt(2)
  v_mfma_f32_32x32x16_bf16 v[0:15], a[80:83], v[32:35], v[0:15]
  ds_read_b128 v[44:47], v206 offset:5120
  v_mfma_f32_32x32x16_bf16 v[16:31], v[32:35], a[224:227], v[16:31]
  s_waitcnt lgkmcnt(2)
  v_mfma_f32_32x32x16_bf16 v[0:15], a[84:87], v[36:39], v[0:15]
  ds_read_b128 v[32:35], v203 offset:6144
  v_mfma_f32_32x32x16_bf16 v[16:31], v[36:39], a[228:231], v[16:31]
  s_waitcnt lgkmcnt(2)
  v_mfma_f32_32x32x16_bf16 v[0:15], a[88:91], v[40:43], v[0:15]
  ds_read_b128 v[36:39], v204 offset:6144
  v_mfma_f32_32x32x16_bf16 v[16:31], v[40:43], a[232:235], v[16:31]
  s_waitcnt lgkmcnt(2)
  v_mfma_f32_32x32x16_bf16 v[0:15], a[92:95], v[44:47], v[0:15]
  ds_read_b128 v[40:43], v205 offset:6144
  v_mfma_f32_32x32x16_bf16 v[16:31], v[44:47], a[236:239], v[16:31]
  s_waitcnt lgkmcnt(2)
  v_mfma_f32_32x32x16_bf16 v[0:15], a[96:99], v[32:35], v[0:15]
  ds_read_b128 v[44:47], v206 offset:6144
  v_mfma_f32_32x32x16_bf16 v[16:31], v[32:35], a[240:243], v[16:31]
  s_waitcnt lgkmcnt(2)
  v_mfma_f32_32x32x16_bf16 v[0:15], a[100:103], v[36:39], v[0:15]
  ds_read_b128 v[32:35], v203 offset:7168
  v_mfma_f32_32x32x16_bf16 v[16:31], v[36:39], a[244:247], v[16:31]
  s_waitcnt lgkmcnt(2)
  v_mfma_f32_32x32x16_bf16 v[0:15], a[104:107], v[40:43], v[0:15]
  ds_read_b128 v[36:39], v204 offset:7168
  v_mfma_f32_32x32x16_bf16 v[16:31], v[40:43], a[248:251], v[16:31]
  s_waitcnt lgkmcnt(2)
  v_mfma_f32_32x32x16_bf16 v[0:15], a[108:111], v[44:47], v[0:15]
  ds_read_b128 v[40:43], v205 offset:7168
  v_mfma_f32_32x32x16_bf16 v[16:31], v[44:47], a[252:255], v[16:31]
  s_waitcnt lgkmcnt(2)
  v_mfma_f32_32x32x16_bf16 v[0:15], a[112:115], v[32:35], v[0:15]
  ds_read_b128 v[44:47], v206 offset:7168
  v_mfma_f32_32x32x16_bf16 v[16:31], v[32:35], v[224:227], v[16:31]
  s_waitcnt lgkmcnt(2)
  v_mfma_f32_32x32x16_bf16 v[0:15], a[116:119], v[36:39], v[0:15]
  ds_read_b128 v[32:35], v203 offset:8192
  v_mfma_f32_32x32x16_bf16 v[16:31], v[36:39], v[228:231], v[16:31]
  s_waitcnt lgkmcnt(2)
  v_mfma_f32_32x32x16_bf16 v[0:15], a[120:123], v[40:43], v[0:15]
  ds_read_b128 v[36:39], v204 offset:8192
  v_mfma_f32_32x32x16_bf16 v[16:31], v[40:43], v[232:235], v[16:31]
  s_waitcnt lgkmcnt(2)
  v_mfma_f32_32x32x16_bf16 v[0:15], a[124:127], v[44:47], v[0:15]
  ds_read_b128 v[40:43], v205 offset:8192
  v_mfma_f32_32x32x16_bf16 v[16:31], v[44:47], v[236:239], v[16:31]
  s_waitcnt lgkmcnt(2)
  v_mfma_f32_32x32x16_bf16 v[0:15], a[128:131], v[32:35], v[0:15]
  ds_read_b128 v[44:47], v206 offset:8192
  v_mfma_f32_32x32x16_bf16 v[16:31], v[32:35], v[240:243], v[16:31]
  s_waitcnt lgkmcnt(2)
  v_mfma_f32_32x32x16_bf16 v[0:15], a[132:135], v[36:39], v[0:15]
  v_mfma_f32_32x32x16_bf16 v[16:31], v[36:39], v[244:247], v[16:31]
  s_waitcnt lgkmcnt(1)
  v_mfma_f32_32x32x16_bf16 v[0:15], a[136:139], v[40:43], v[0:15]
  v_mfma_f32_32x32x16_bf16 v[16:31], v[40:43], v[248:251], v[16:31]
  s_waitcnt lgkmcnt(0)
  v_mfma_f32_32x32x16_bf16 v[0:15], a[140:143], v[44:47], v[0:15]
  v_mfma_f32_32x32x16_bf16 v[16:31], v[44:47], v[252:255], v[16:31]
  s_mul_i32 s64, s59, 655360
  s_lshl_b32 s55, s58, 14
  s_add_u32 s64, s64, s55
  s_add_u32 s64, s64, 1048576
  s_add_u32 s72, s64, s69
  s_add_u32 s73, s64, s66
  s_add_u32 s59, s59, 7
  s_waitcnt vmcnt(0)
  s_barrier
  s_cmp_eq_u32 s1, 1
  s_cbranch_scc1 W_ver_ok
  v_mov_b32 v33, 163832
  s_cmp_eq_u32 s52, 0
  s_cbranch_scc0 W_ver_b
  s_waitcnt vmcnt(0)
  s_mov_b64 exec, 1
  ds_write_b32 v33, v197
  s_mov_b64 exec, -1
  s_waitcnt lgkmcnt(0)
W_ver_b:
  s_barrier
  ds_read_b32 v32, v33
  s_waitcnt lgkmcnt(0)
  v_readfirstlane_b32 s54, v32
  s_nop 0
  s_bitcmp1_b32 s54, s0
  s_cbranch_scc1 L_conf
W_ver_ok:
  s_lshr_b32 s55, s53, 1
  s_and_b32 s56, s53, 1
  s_lshl_b32 s56, s56, 13
  s_lshl_b32 s55, s55, 8
  s_add_u32 s55, s55, s56
  s_add_u32 s55, s55, 393216
  s_cmp_lt_u32 s53, 64
  s_cselect_b32 s71, s55, 268435456
  v_mov_b32 v211, 0
  s_mov_b64 exec, 1
  buffer_store_dword v211, v211, s[8:11], s71 offen sc1
  s_mov_b64 exec, -1
  s_cmp_eq_u32 s59, 7
  s_cbranch_scc0 KV_na
  s_mul_i32 s54, s58, 2176
  s_mul_i32 s55, s52, 69632
  s_add_u32 s55, s55, s54
  s_add_u32 s55, s55, 0
  s_add_u32 s54, s54, 278528
  s_and_b32 s56, s58, 7
  s_lshl_b32 s56, s56, 12
  s_bfe_u32 s57, s58, 0x10003
  s_lshl_b32 s57, s57, 11
  s_add_u32 s56, s56, s57
  s_add_u32 s54, s56, 262144
  s_lshr_b32 s57, s58, 4
  s_lshl_b32 s57, s57, 15
  s_add_u32 s56, s56, s57
  s_lshl_b32 s57, s52, 16
  s_add_u32 s56, s56, s57
  s_add_u32 s55, s56, 0
  s_lshl_b32 s56, s58, 14
  s_mul_i32 s57, s52, 3072
  s_add_u32 s56, s56, s57
  s_add_u32 s56, s56, 360448
  s_cmp_lt_u32 s58, 2
  s_cselect_b32 s56, s56, 268435456
  s_cmp_eq_u32 s52, 0
  s_cselect_b32 s54, s54, 268435456
  buffer_store_dwordx4 v[64:67], v201, s[8:11], s55 offen offset:0 sc1
  buffer_store_dwordx4 v[64:67], v201, s[8:11], s55 offen offset:1024 sc1
  buffer_store_dwordx4 v[64:67], v201, s[8:11], s54 offen offset:0 sc1
  buffer_store_dwordx4 v[64:67], v201, s[8:11], s54 offen offset:1024 sc1
  buffer_store_dwordx4 v[64:67], v201, s[8:11], s56 offen offset:0 sc1
  buffer_store_dwordx4 v[64:67], v201, s[8:11], s56 offen offset:1024 sc1
  buffer_store_dwordx4 v[64:67], v201, s[8:11], s56 offen offset:2048 sc1
KV_na:
KV_loop:
  s_add_u32 s60, s60, 258048
  ds_read_b128 v[32:35], v203 offset:36864
  ds_read_b128 v[36:39], v204 offset:36864
  ds_read_b128 v[40:43], v205 offset:36864
  s_waitcnt lgkmcnt(2)
  v_mfma_f32_32x32x16_bf16 v[68:83], a[0:3], v[32:35], 0
  ds_read_b128 v[44:47], v206 offset:36864
  s_add_u32 m0, s67, 0
  s_nop 0
  buffer_load_dwordx4 v202, s[4:7], s60 offen offset:0 lds
  v_mfma_f32_32x32x16_bf16 v[84:99], v[32:35], a[144:147], 0
  s_waitcnt lgkmcnt(2)
  v_mfma_f32_32x32x16_bf16 v[68:83], a[4:7], v[36:39], v[68:83]
  ds_read_b128 v[32:35], v203 offset:37888
  s_add_u32 m0, s67, 896
  s_nop 0
  buffer_load_dwordx4 v202, s[4:7], s60 offen offset:128 lds
  v_mfma_f32_32x32x16_bf16 v[84:99], v[36:39], a[148:151], v[84:99]
  s_waitcnt lgkmcnt(2)
  v_mfma_f32_32x32x16_bf16 v[68:83], a[8:11], v[40:43], v[68:83]
  ds_read_b128 v[36:39], v204 offset:37888
  s_add_u32 m0, s67, 1792
  s_nop 0
  buffer_load_dwordx4 v202, s[4:7], s60 offen offset:256 lds
  v_mfma_f32_32x32x16_bf16 v[84:99], v[40:43], a[152:155], v[84:99]
  s_waitcnt lgkmcnt(2)
  v_mfma_f32_32x32x16_bf16 v[68:83], a[12:15], v[44:47], v[68:83]
  ds_read_b128 v[40:43], v205 offset:37888
  s_add_u32 m0, s67, 2688
  s_nop 0
  buffer_load_dwordx4 v202, s[4:7], s60 offen offset:384 lds
  v_mfma_f32_32x32x16_bf16 v[84:99], v[44:47], a[156:159], v[84:99]
  s_waitcnt lgkmcnt(2)
  v_mfma_f32_32x32x16_bf16 v[68:83], a[16:19], v[32:35], v[68:83]
  ds_read_b128 v[44:47], v206 offset:37888
  s_add_u32 m0, s67, 3584
  s_nop 0
  buffer_load_dwordx4 v202, s[4:7], s60 offen offset:512 lds
  v_mfma_f32_32x32x16_bf16 v[84:99], v[32:35], a[160:163], v[84:99]
  s_waitcnt lgkmcnt(2)
  v_mfma_f32_32x32x16_bf16 v[68:83], a[20:23], v[36:39], v[68:83]
  ds_read_b128 v[32:35], v203 offset:38912
  s_add_u32 m0, s67, 4480
  s_nop 0
  buffer_load_dwordx4 v202, s[4:7], s60 offen offset:640 lds
  v_mfma_f32_32x32x16_bf16 v[84:99], v[36:39], a[164:167], v[84:99]
  s_waitcnt lgkmcnt(2)
  v_mfma_f32_32x32x16_bf16 v[68:83], a[24:27], v[40:43], v[68:83]
  ds_read_b128 v[36:39], v204 offset:38912
  s_add_u32 m0, s67, 5376
  s_nop 0
  buffer_load_dwordx4 v202, s[4:7], s60 offen offset:768 lds
  v_mfma_f32_32x32x16_bf16 v[84:99], v[40:43], a[168:171], v[84:99]
  s_waitcnt lgkmcnt(2)
  v_mfma_f32_32x32x16_bf16 v[68:83], a[28:31], v[44:47], v[68:83]
  ds_read_b128 v[40:43], v205 offset:38912
  s_add_u32 m0, s67, 6272
  s_nop 0
  buffer_load_dwordx4 v202, s[4:7], s60 offen offset:896 lds
  v_mfma_f32_32x32x16_bf16 v[84:99], v[44:47], a[172:175], v[84:99]
  s_waitcnt lgkmcnt(2)
  v_mfma_f32_32x32x16_bf16 v[68:83], a[32:35], v[32:35], v[68:83]
  ds_read_b128 v[44:47], v206 offset:38912
  s_add_u32 m0, s67, 7168
  s_nop 0
  buffer_load_dwordx4 v202, s[4:7], s60 offen offset:1024 lds
  v_mfma_f32_32x32x16_bf16 v[84:99], v[32:35], a[176:179], v[84:99]
  s_waitcnt lgkmcnt(2)
  v_mfma_f32_32x32x16_bf16 v[68:83], a[36:39], v[36:39], v[68:83]
  ds_read_b128 v[32:35], v203 offset:39936
  v_mul_f32 v0, s68, v0
  v_mul_f32 v1, s68, v1
  v_mul_f32 v2, s68, v2
  v_mul_f32 v3, s68, v3
  v_mfma_f32_32x32x16_bf16 v[84:99], v[36:39], a[180:183], v[84:99]
  v_mul_f32 v4, s68, v4
  v_mul_f32 v5, s68, v5
  v_mul_f32 v6, s68, v6
  v_mul_f32 v7, s68, v7
  s_waitcnt lgkmcnt(2)
  v_mfma_f32_32x32x16_bf16 v[68:83], a[40:43], v[40:43], v[68:83]
  ds_read_b128 v[36:39], v204 offset:39936
  v_cvt_pk_bf16_f32 v48, v0, v4
  v_cvt_pk_bf16_f32 v49, v1, v5
  v_cvt_pk_bf16_f32 v50, v2, v6
  v_cvt_pk_bf16_f32 v51, v3, v7
  v_mfma_f32_32x32x16_bf16 v[84:99], v[40:43], a[184:187], v[84:99]
  buffer_store_dwordx4 v[48:51], v216, s[8:11], s72 offen offset:0 sc1
  s_waitcnt lgkmcnt(2)
  v_mfma_f32_32x32x16_bf16 v[68:83], a[44:47], v[44:47], v[68:83]
  ds_read_b128 v[40:43], v205 offset:39936
  v_mfma_f32_32x32x16_bf16 v[84:99], v[44:47], a[188:191], v[84:99]
  s_waitcnt lgkmcnt(2)
  v_mfma_f32_32x32x16_bf16 v[68:83], a[48:51], v[32:35], v[68:83]
  ds_read_b128 v[44:47], v206 offset:39936
  v_mul_f32 v8, s68, v8
  v_mul_f32 v9, s68, v9
  v_mul_f32 v10, s68, v10
  v_mul_f32 v11, s68, v11
  v_mfma_f32_32x32x16_bf16 v[84:99], v[32:35], a[192:195], v[84:99]
  v_mul_f32 v12, s68, v12
  v_mul_f32 v13, s68, v13
  v_mul_f32 v14, s68, v14
  v_mul_f32 v15, s68, v15
  s_waitcnt lgkmcnt(2)
  v_mfma_f32_32x32x16_bf16 v[68:83], a[52:55], v[36:39], v[68:83]
  ds_read_b128 v[32:35], v203 offset:40960
  v_cvt_pk_bf16_f32 v52, v8, v12
  v_cvt_pk_bf16_f32 v53, v9, v13
  v_cvt_pk_bf16_f32 v54, v10, v14
  v_cvt_pk_bf16_f32 v55, v11, v15
  v_mfma_f32_32x32x16_bf16 v[84:99], v[36:39], a[196:199], v[84:99]
  buffer_store_dwordx4 v[52:55], v216, s[8:11], s72 offen offset:256 sc1
  s_waitcnt lgkmcnt(2)
  v_mfma_f32_32x32x16_bf16 v[68:83], a[56:59], v[40:43], v[68:83]
  ds_read_b128 v[36:39], v204 offset:40960
  v_mfma_f32_32x32x16_bf16 v[84:99], v[40:43], a[200:203], v[84:99]
  s_waitcnt lgkmcnt(2)
  v_mfma_f32_32x32x16_bf16 v[68:83], a[60:63], v[44:47], v[68:83]
  ds_read_b128 v[40:43], v205 offset:40960
  v_cvt_pk_bf16_f32 v56, v16, v17
  v_cvt_pk_bf16_f32 v57, v20, v21
  v_cvt_pk_bf16_f32 v58, v24, v25
  v_cvt_pk_bf16_f32 v59, v28, v29
  v_mfma_f32_32x32x16_bf16 v[84:99], v[44:47], a[204:207], v[84:99]
  buffer_store_dwordx4 v[56:59], v217, s[8:11], s64 offen offset:0 sc1
  s_waitcnt lgkmcnt(2)
  v_mfma_f32_32x32x16_bf16 v[68:83], a[64:67], v[32:35], v[68:83]
  ds_read_b128 v[44:47], v206 offset:40960
  v_mfma_f32_32x32x16_bf16 v[84:99], v[32:35], a[208:211], v[84:99]
  s_waitcnt lgkmcnt(2)
  v_mfma_f32_32x32x16_bf16 v[68:83], a[68:71], v[36:39], v[68:83]
  ds_read_b128 v[32:35], v203 offset:41984
  v_cvt_pk_bf16_f32 v60, v18, v19
  v_cvt_pk_bf16_f32 v61, v22, v23
  v_cvt_pk_bf16_f32 v62, v26, v27
  v_cvt_pk_bf16_f32 v63, v30, v31
  v_mfma_f32_32x32x16_bf16 v[84:99], v[36:39], a[212:215], v[84:99]
  buffer_store_dwordx4 v[60:63], v217, s[8:11], s64 offen offset:256 sc1
  s_waitcnt lgkmcnt(2)
  v_mfma_f32_32x32x16_bf16 v[68:83], a[72:75], v[40:43], v[68:83]
  ds_read_b128 v[36:39], v204 offset:41984
  v_mfma_f32_32x32x16_bf16 v[84:99], v[40:43], a[216:219], v[84:99]
  s_waitcnt lgkmcnt(2)
  v_mfma_f32_32x32x16_bf16 v[68:83], a[76:79], v[44:47], v[68:83]
  ds_read_b128 v[40:43], v205 offset:41984
  buffer_store_dwordx4 v[64:67], v201, s[8:11], s73 offen sc1
  v_mfma_f32_32x32x16_bf16 v[84:99], v[44:47], a[220:223], v[84:99]
  s_waitcnt lgkmcnt(2)
  v_mfma_f32_32x32x16_bf16 v[68:83], a[80:83], v[32:35], v[68:83]
  ds_read_b128 v[44:47], v206 offset:41984
  v_mfma_f32_32x32x16_bf16 v[84:99], v[32:35], a[224:227], v[84:99]
  s_waitcnt lgkmcnt(2)
  v_mfma_f32_32x32x16_bf16 v[68:83], a[84:87], v[36:39], v[68:83]
  ds_read_b128 v[32:35], v203 offset:43008
  v_mfma_f32_32x32x16_bf16 v[84:99], v[36:39], a[228:231], v[84:99]
  s_waitcnt lgkmcnt(2)
  v_mfma_f32_32x32x16_bf16 v[68:83], a[88:91], v[40:43], v[68:83]
  ds_read_b128 v[36:39], v204 offset:43008
  v_mfma_f32_32x32x16_bf16 v[84:99], v[40:43], a[232:235], v[84:99]
  s_waitcnt lgkmcnt(2)
  v_mfma_f32_32x32x16_bf16 v[68:83], a[92:95], v[44:47], v[68:83]
  ds_read_b128 v[40:43], v205 offset:43008
  v_mfma_f32_32x32x16_bf16 v[84:99], v[44:47], a[236:239], v[84:99]
  s_waitcnt lgkmcnt(2)
  v_mfma_f32_32x32x16_bf16 v[68:83], a[96:99], v[32:35], v[68:83]
  ds_read_b128 v[44:47], v206 offset:43008
  v_mfma_f32_32x32x16_bf16 v[84:99], v[32:35], a[240:243], v[84:99]
  s_waitcnt lgkmcnt(2)
  v_mfma_f32_32x32x16_bf16 v[68:83], a[100:103], v[36:39], v[68:83]
  ds_read_b128 v[32:35], v203 offset:44032
  v_mfma_f32_32x32x16_bf16 v[84:99], v[36:39], a[244:247], v[84:99]
  s_waitcnt lgkmcnt(2)
  v_mfma_f32_32x32x16_bf16 v[68:83], a[104:107], v[40:43], v[68:83]
  ds_read_b128 v[36:39], v204 offset:44032
  v_mfma_f32_32x32x16_bf16 v[84:99], v[40:43], a[248:251], v[84:99]
  s_waitcnt lgkmcnt(2)
  v_mfma_f32_32x32x16_bf16 v[68:83], a[108:111], v[44:47], v[68:83]
  ds_read_b128 v[40:43], v205 offset:44032
  v_mfma_f32_32x32x16_bf16 v[84:99], v[44:47], a[252:255], v[84:99]
  s_waitcnt lgkmcnt(2)
  v_mfma_f32_32x32x16_bf16 v[68:83], a[112:115], v[32:35], v[68:83]
  ds_read_b128 v[44:47], v206 offset:44032
  v_mfma_f32_32x32x16_bf16 v[84:99], v[32:35], v[224:227], v[84:99]
  s_waitcnt lgkmcnt(2)
  v_mfma_f32_32x32x16_bf16 v[68:83], a[116:119], v[36:39], v[68:83]
  ds_read_b128 v[32:35], v203 offset:45056
  v_mfma_f32_32x32x16_bf16 v[84:99], v[36:39], v[228:231], v[84:99]
  s_waitcnt lgkmcnt(2)
  v_mfma_f32_32x32x16_bf16 v[68:83], a[120:123], v[40:43], v[68:83]
  ds_read_b128 v[36:39], v204 offset:45056
  v_mfma_f32_32x32x16_bf16 v[84:99], v[40:43], v[232:235], v[84:99]
  s_waitcnt lgkmcnt(2)
  v_mfma_f32_32x32x16_bf16 v[68:83], a[124:127], v[44:47], v[68:83]
  ds_read_b128 v[40:43], v205 offset:45056
  v_mfma_f32_32x32x16_bf16 v[84:99], v[44:47], v[236:239], v[84:99]
  s_waitcnt lgkmcnt(2)
  v_mfma_f32_32x32x16_bf16 v[68:83], a[128:131], v[32:35], v[68:83]
  ds_read_b128 v[44:47], v206 offset:45056
  v_mfma_f32_32x32x16_bf16 v[84:99], v[32:35], v[240:243], v[84:99]
  s_waitcnt lgkmcnt(2)
  v_mfma_f32_32x32x16_bf16 v[68:83], a[132:135], v[36:39], v[68:83]
  v_mfma_f32_32x32x16_bf16 v[84:99], v[36:39], v[244:247], v[84:99]
  s_waitcnt lgkmcnt(1)
  v_mfma_f32_32x32x16_bf16 v[68:83], a[136:139], v[40:43], v[68:83]
  v_mfma_f32_32x32x16_bf16 v[84:99], v[40:43], v[248:251], v[84:99]
  s_waitcnt lgkmcnt(0)
  v_mfma_f32_32x32x16_bf16 v[68:83], a[140:143], v[44:47], v[68:83]
  v_mfma_f32_32x32x16_bf16 v[84:99], v[44:47], v[252:255], v[84:99]
  s_mul_i32 s64, s59, 655360
  s_lshl_b32 s55, s58, 14
  s_add_u32 s64, s64, s55
  s_add_u32 s64, s64, 1048576
  s_add_u32 s72, s64, s69
  s_add_u32 s73, s64, s66
  s_add_u32 s59, s59, 7
  s_cmp_ge_u32 s59, 64
  s_cbranch_scc1 KV_done1
  s_waitcnt vmcnt(5)
  s_barrier
  s_add_u32 s60, s60, 258048
  ds_read_b128 v[32:35], v203 offset:0
  ds_read_b128 v[36:39], v204 offset:0
  ds_read_b128 v[40:43], v205 offset:0
  s_waitcnt lgkmcnt(2)
  v_mfma_f32_32x32x16_bf16 v[0:15], a[0:3], v[32:35], 0
  ds_read_b128 v[44:47], v206 offset:0
  s_add_u32 m0, s67, 36864
  s_nop 0
  buffer_load_dwordx4 v202, s[4:7], s60 offen offset:0 lds
  v_mfma_f32_32x32x16_bf16 v[16:31], v[32:35], a[144:147], 0
  s_waitcnt lgkmcnt(2)
  v_mfma_f32_32x32x16_bf16 v[0:15], a[4:7], v[36:39], v[0:15]
  ds_read_b128 v[32:35], v203 offset:1024
  s_add_u32 m0, s67, 37760
  s_nop 0
  buffer_load_dwordx4 v202, s[4:7], s60 offen offset:128 lds
  v_mfma_f32_32x32x16_bf16 v[16:31], v[36:39], a[148:151], v[16:31]
  s_waitcnt lgkmcnt(2)
  v_mfma_f32_32x32x16_bf16 v[0:15], a[8:11], v[40:43], v[0:15]
  ds_read_b128 v[36:39], v204 offset:1024
  s_add_u32 m0, s67, 38656
  s_nop 0
  buffer_load_dwordx4 v202, s[4:7], s60 offen offset:256 lds
  v_mfma_f32_32x32x16_bf16 v[16:31], v[40:43], a[152:155], v[16:31]
  s_waitcnt lgkmcnt(2)
  v_mfma_f32_32x32x16_bf16 v[0:15], a[12:15], v[44:47], v[0:15]
  ds_read_b128 v[40:43], v205 offset:1024
  s_add_u32 m0, s67, 39552
  s_nop 0
  buffer_load_dwordx4 v202, s[4:7], s60 offen offset:384 lds
  v_mfma_f32_32x32x16_bf16 v[16:31], v[44:47], a[156:159], v[16:31]
  s_waitcnt lgkmcnt(2)
  v_mfma_f32_32x32x16_bf16 v[0:15], a[16:19], v[32:35], v[0:15]
  ds_read_b128 v[44:47], v206 offset:1024
  s_add_u32 m0, s67, 40448
  s_nop 0
  buffer_load_dwordx4 v202, s[4:7], s60 offen offset:512 lds
  v_mfma_f32_32x32x16_bf16 v[16:31], v[32:35], a[160:163], v[16:31]
  s_waitcnt lgkmcnt(2)
  v_mfma_f32_32x32x16_bf16 v[0:15], a[20:23], v[36:39], v[0:15]
  ds_read_b128 v[32:35], v203 offset:2048
  s_add_u32 m0, s67, 41344
  s_nop 0
  buffer_load_dwordx4 v202, s[4:7], s60 offen offset:640 lds
  v_mfma_f32_32x32x16_bf16 v[16:31], v[36:39], a[164:167], v[16:31]
  s_waitcnt lgkmcnt(2)
  v_mfma_f32_32x32x16_bf16 v[0:15], a[24:27], v[40:43], v[0:15]
  ds_read_b128 v[36:39], v204 offset:2048
  s_add_u32 m0, s67, 42240
  s_nop 0
  buffer_load_dwordx4 v202, s[4:7], s60 offen offset:768 lds
  v_mfma_f32_32x32x16_bf16 v[16:31], v[40:43], a[168:171], v[16:31]
  s_waitcnt lgkmcnt(2)
  v_mfma_f32_32x32x16_bf16 v[0:15], a[28:31], v[44:47], v[0:15]
  ds_read_b128 v[40:43], v205 offset:2048
  s_add_u32 m0, s67, 43136
  s_nop 0
  buffer_load_dwordx4 v202, s[4:7], s60 offen offset:896 lds
  v_mfma_f32_32x32x16_bf16 v[16:31], v[44:47], a[172:175], v[16:31]
  s_waitcnt lgkmcnt(2)
  v_mfma_f32_32x32x16_bf16 v[0:15], a[32:35], v[32:35], v[0:15]
  ds_read_b128 v[44:47], v206 offset:2048
  s_add_u32 m0, s67, 44032
  s_nop 0
  buffer_load_dwordx4 v202, s[4:7], s60 offen offset:1024 lds
  v_mfma_f32_32x32x16_bf16 v[16:31], v[32:35], a[176:179], v[16:31]
  s_waitcnt lgkmcnt(2)
  v_mfma_f32_32x32x16_bf16 v[0:15], a[36:39], v[36:39], v[0:15]
  ds_read_b128 v[32:35], v203 offset:3072
  v_mul_f32 v68, s68, v68
  v_mul_f32 v69, s68, v69
  v_mul_f32 v70, s68, v70
  v_mul_f32 v71, s68, v71
  v_mfma_f32_32x32x16_bf16 v[16:31], v[36:39], a[180:183], v[16:31]
  v_mul_f32 v72, s68, v72
  v_mul_f32 v73, s68, v73
  v_mul_f32 v74, s68, v74
  v_mul_f32 v75, s68, v75
  s_waitcnt lgkmcnt(2)
  v_mfma_f32_32x32x16_bf16 v[0:15], a[40:43], v[40:43], v[0:15]
  ds_read_b128 v[36:39], v204 offset:3072
  v_cvt_pk_bf16_f32 v48, v68, v72
  v_cvt_pk_bf16_f32 v49, v69, v73
  v_cvt_pk_bf16_f32 v50, v70, v74
  v_cvt_pk_bf16_f32 v51, v71, v75
  v_mfma_f32_32x32x16_bf16 v[16:31], v[40:43], a[184:187], v[16:31]
  buffer_store_dwordx4 v[48:51], v216, s[8:11], s72 offen offset:0 sc1
  s_waitcnt lgkmcnt(2)
  v_mfma_f32_32x32x16_bf16 v[0:15], a[44:47], v[44:47], v[0:15]
  ds_read_b128 v[40:43], v205 offset:3072
  v_mfma_f32_32x32x16_bf16 v[16:31], v[44:47], a[188:191], v[16:31]
  s_waitcnt lgkmcnt(2)
  v_mfma_f32_32x32x16_bf16 v[0:15], a[48:51], v[32:35], v[0:15]
  ds_read_b128 v[44:47], v206 offset:3072
  v_mul_f32 v76, s68, v76
  v_mul_f32 v77, s68, v77
  v_mul_f32 v78, s68, v78
  v_mul_f32 v79, s68, v79
  v_mfma_f32_32x32x16_bf16 v[16:31], v[32:35], a[192:195], v[16:31]
  v_mul_f32 v80, s68, v80
  v_mul_f32 v81, s68, v81
  v_mul_f32 v82, s68, v82
  v_mul_f32 v83, s68, v83
  s_waitcnt lgkmcnt(2)
  v_mfma_f32_32x32x16_bf16 v[0:15], a[52:55], v[36:39], v[0:15]
  ds_read_b128 v[32:35], v203 offset:4096
  v_cvt_pk_bf16_f32 v52, v76, v80
  v_cvt_pk_bf16_f32 v53, v77, v81
  v_cvt_pk_bf16_f32 v54, v78, v82
  v_cvt_pk_bf16_f32 v55, v79, v83
  v_mfma_f32_32x32x16_bf16 v[16:31], v[36:39], a[196:199], v[16:31]
  buffer_store_dwordx4 v[52:55], v216, s[8:11], s72 offen offset:256 sc1
  s_waitcnt lgkmcnt(2)
  v_mfma_f32_32x32x16_bf16 v[0:15], a[56:59], v[40:43], v[0:15]
  ds_read_b128 v[36:39], v204 offset:4096
  v_mfma_f32_32x32x16_bf16 v[16:31], v[40:43], a[200:203], v[16:31]
  s_waitcnt lgkmcnt(2)
  v_mfma_f32_32x32x16_bf16 v[0:15], a[60:63], v[44:47], v[0:15]
  ds_read_b128 v[40:43], v205 offset:4096
  v_cvt_pk_bf16_f32 v56, v84, v85
  v_cvt_pk_bf16_f32 v57, v88, v89
  v_cvt_pk_bf16_f32 v58, v92, v93
  v_cvt_pk_bf16_f32 v59, v96, v97
  v_mfma_f32_32x32x16_bf16 v[16:31], v[44:47], a[204:207], v[16:31]
  buffer_store_dwordx4 v[56:59], v217, s[8:11], s64 offen offset:0 sc1
  s_waitcnt lgkmcnt(2)
  v_mfma_f32_32x32x16_bf16 v[0:15], a[64:67], v[32:35], v[0:15]
  ds_read_b128 v[44:47], v206 offset:4096
  v_mfma_f32_32x32x16_bf16 v[16:31], v[32:35], a[208:211], v[16:31]
  s_waitcnt lgkmcnt(2)
  v_mfma_f32_32x32x16_bf16 v[0:15], a[68:71], v[36:39], v[0:15]
  ds_read_b128 v[32:35], v203 offset:5120
  v_cvt_pk_bf16_f32 v60, v86, v87
  v_cvt_pk_bf16_f32 v61, v90, v91
  v_cvt_pk_bf16_f32 v62, v94, v95
  v_cvt_pk_bf16_f32 v63, v98, v99
  v_mfma_f32_32x32x16_bf16 v[16:31], v[36:39], a[212:215], v[16:31]
  buffer_store_dwordx4 v[60:63], v217, s[8:11], s64 offen offset:256 sc1
  s_waitcnt lgkmcnt(2)
  v_mfma_f32_32x32x16_bf16 v[0:15], a[72:75], v[40:43], v[0:15]
  ds_read_b128 v[36:39], v204 offset:5120
  v_mfma_f32_32x32x16_bf16 v[16:31], v[40:43], a[216:219], v[16:31]
  s_waitcnt lgkmcnt(2)
  v_mfma_f32_32x32x16_bf16 v[0:15], a[76:79], v[44:47], v[0:15]
  ds_read_b128 v[40:43], v205 offset:5120
  buffer_store_dwordx4 v[64:67], v201, s[8:11], s73 offen sc1
  v_mfma_f32_32x32x16_bf16 v[16:31], v[44:47], a[220:223], v[16:31]
  s_waitcnt lgkmcnt(2)
  v_mfma_f32_32x32x16_bf16 v[0:15], a[80:83], v[32:35], v[0:15]
  ds_read_b128 v[44:47], v206 offset:5120
  v_mfma_f32_32x32x16_bf16 v[16:31], v[32:35], a[224:227], v[16:31]
  s_waitcnt lgkmcnt(2)
  v_mfma_f32_32x32x16_bf16 v[0:15], a[84:87], v[36:39], v[0:15]
  ds_read_b128 v[32:35], v203 offset:6144
  v_mfma_f32_32x32x16_bf16 v[16:31], v[36:39], a[228:231], v[16:31]
  s_waitcnt lgkmcnt(2)
  v_mfma_f32_32x32x16_bf16 v[0:15], a[88:91], v[40:43], v[0:15]
  ds_read_b128 v[36:39], v204 offset:6144
  v_mfma_f32_32x32x16_bf16 v[16:31], v[40:43], a[232:235], v[16:31]
  s_waitcnt lgkmcnt(2)
  v_mfma_f32_32x32x16_bf16 v[0:15], a[92:95], v[44:47], v[0:15]
  ds_read_b128 v[40:43], v205 offset:6144
  v_mfma_f32_32x32x16_bf16 v[16:31], v[44:47], a[236:239], v[16:31]
  s_waitcnt lgkmcnt(2)
  v_mfma_f32_32x32x16_bf16 v[0:15], a[96:99], v[32:35], v[0:15]
  ds_read_b128 v[44:47], v206 offset:6144
  v_mfma_f32_32x32x16_bf16 v[16:31], v[32:35], a[240:243], v[16:31]
  s_waitcnt lgkmcnt(2)
  v_mfma_f32_32x32x16_bf16 v[0:15], a[100:103], v[36:39], v[0:15]
  ds_read_b128 v[32:35], v203 offset:7168
  v_mfma_f32_32x32x16_bf16 v[16:31], v[36:39], a[244:247], v[16:31]
  s_waitcnt lgkmcnt(2)
  v_mfma_f32_32x32x16_bf16 v[0:15], a[104:107], v[40:43], v[0:15]
  ds_read_b128 v[36:39], v204 offset:7168
  v_mfma_f32_32x32x16_bf16 v[16:31], v[40:43], a[248:251], v[16:31]
  s_waitcnt lgkmcnt(2)
  v_mfma_f32_32x32x16_bf16 v[0:15], a[108:111], v[44:47], v[0:15]
  ds_read_b128 v[40:43], v205 offset:7168
  v_mfma_f32_32x32x16_bf16 v[16:31], v[44:47], a[252:255], v[16:31]
  s_waitcnt lgkmcnt(2)
  v_mfma_f32_32x32x16_bf16 v[0:15], a[112:115], v[32:35], v[0:15]
  ds_read_b128 v[44:47], v206 offset:7168
  v_mfma_f32_32x32x16_bf16 v[16:31], v[32:35], v[224:227], v[16:31]
  s_waitcnt lgkmcnt(2)
  v_mfma_f32_32x32x16_bf16 v[0:15], a[116:119], v[36:39], v[0:15]
  ds_read_b128 v[32:35], v203 offset:8192
  v_mfma_f32_32x32x16_bf16 v[16:31], v[36:39], v[228:231], v[16:31]
  s_waitcnt lgkmcnt(2)
  v_mfma_f32_32x32x16_bf16 v[0:15], a[120:123], v[40:43], v[0:15]
  ds_read_b128 v[36:39], v204 offset:8192
  v_mfma_f32_32x32x16_bf16 v[16:31], v[40:43], v[232:235], v[16:31]
  s_waitcnt lgkmcnt(2)
  v_mfma_f32_32x32x16_bf16 v[0:15], a[124:127], v[44:47], v[0:15]
  ds_read_b128 v[40:43], v205 offset:8192
  v_mfma_f32_32x32x16_bf16 v[16:31], v[44:47], v[236:239], v[16:31]
  s_waitcnt lgkmcnt(2)
  v_mfma_f32_32x32x16_bf16 v[0:15], a[128:131], v[32:35], v[0:15]
  ds_read_b128 v[44:47], v206 offset:8192
  v_mfma_f32_32x32x16_bf16 v[16:31], v[32:35], v[240:243], v[16:31]
  s_waitcnt lgkmcnt(2)
  v_mfma_f32_32x32x16_bf16 v[0:15], a[132:135], v[36:39], v[0:15]
  v_mfma_f32_32x32x16_bf16 v[16:31], v[36:39], v[244:247], v[16:31]
  s_waitcnt lgkmcnt(1)
  v_mfma_f32_32x32x16_bf16 v[0:15], a[136:139], v[40:43], v[0:15]
  v_mfma_f32_32x32x16_bf16 v[16:31], v[40:43], v[248:251], v[16:31]
  s_waitcnt lgkmcnt(0)
  v_mfma_f32_32x32x16_bf16 v[0:15], a[140:143], v[44:47], v[0:15]
  v_mfma_f32_32x32x16_bf16 v[16:31], v[44:47], v[252:255], v[16:31]
  s_mul_i32 s64, s59, 655360
  s_lshl_b32 s55, s58, 14
  s_add_u32 s64, s64, s55
  s_add_u32 s64, s64, 1048576
  s_add_u32 s72, s64, s69
  s_add_u32 s73, s64, s66
  s_add_u32 s59, s59, 7
  s_cmp_ge_u32 s59, 64
  s_cbranch_scc1 KV_done0
  s_sub_u32 s54, s59, 21
  s_cmp_lt_u32 s54, 7
  s_cbranch_scc1 KV_early
  s_waitcnt vmcnt(5)
  s_barrier
KV_cont:
  s_branch KV_loop
KV_early:
  s_waitcnt vmcnt(0)
  s_barrier
  s_cmp_eq_u32 s52, 0
  s_cbranch_scc0 KV_sig0
  v_mov_b32 v211, 1
  v_mov_b32 v212, 0
  s_mov_b64 exec, 1
  buffer_atomic_add v211, v212, s[12:15], s70 offen
  s_mov_b64 exec, -1
KV_sig0:
  s_branch KV_cont
KV_done1:
  s_nop 11
  v_mul_f32 v68, s68, v68
  v_mul_f32 v69, s68, v69
  v_mul_f32 v70, s68, v70
  v_mul_f32 v71, s68, v71
  v_mul_f32 v72, s68, v72
  v_mul_f32 v73, s68, v73
  v_mul_f32 v74, s68, v74
  v_mul_f32 v75, s68, v75
  v_cvt_pk_bf16_f32 v48, v68, v72
  v_cvt_pk_bf16_f32 v49, v69, v73
  v_cvt_pk_bf16_f32 v50, v70, v74
  v_cvt_pk_bf16_f32 v51, v71, v75
  buffer_store_dwordx4 v[48:51], v216, s[8:11], s72 offen offset:0 sc1
  v_mul_f32 v76, s68, v76
  v_mul_f32 v77, s68, v77
  v_mul_f32 v78, s68, v78
  v_mul_f32 v79, s68, v79
  v_mul_f32 v80, s68, v80
  v_mul_f32 v81, s68, v81
  v_mul_f32 v82, s68, v82
  v_mul_f32 v83, s68, v83
  v_cvt_pk_bf16_f32 v52, v76, v80
  v_cvt_pk_bf16_f32 v53, v77, v81
  v_cvt_pk_bf16_f32 v54, v78, v82
  v_cvt_pk_bf16_f32 v55, v79, v83
  buffer_store_dwordx4 v[52:55], v216, s[8:11], s72 offen offset:256 sc1
  v_cvt_pk_bf16_f32 v56, v84, v85
  v_cvt_pk_bf16_f32 v57, v88, v89
  v_cvt_pk_bf16_f32 v58, v92, v93
  v_cvt_pk_bf16_f32 v59, v96, v97
  buffer_store_dwordx4 v[56:59], v217, s[8:11], s64 offen offset:0 sc1
  v_cvt_pk_bf16_f32 v60, v86, v87
  v_cvt_pk_bf16_f32 v61, v90, v91
  v_cvt_pk_bf16_f32 v62, v94, v95
  v_cvt_pk_bf16_f32 v63, v98, v99
  buffer_store_dwordx4 v[60:63], v217, s[8:11], s64 offen offset:256 sc1
  buffer_store_dwordx4 v[64:67], v201, s[8:11], s73 offen sc1
  s_branch KV_fin
KV_done0:
  s_nop 11
  v_mul_f32 v0, s68, v0
  v_mul_f32 v1, s68, v1
  v_mul_f32 v2, s68, v2
  v_mul_f32 v3, s68, v3
  v_mul_f32 v4, s68, v4
  v_mul_f32 v5, s68, v5
  v_mul_f32 v6, s68, v6
  v_mul_f32 v7, s68, v7
  v_cvt_pk_bf16_f32 v48, v0, v4
  v_cvt_pk_bf16_f32 v49, v1, v5
  v_cvt_pk_bf16_f32 v50, v2, v6
  v_cvt_pk_bf16_f32 v51, v3, v7
  buffer_store_dwordx4 v[48:51], v216, s[8:11], s72 offen offset:0 sc1
  v_mul_f32 v8, s68, v8
  v_mul_f32 v9, s68, v9
  v_mul_f32 v10, s68, v10
  v_mul_f32 v11, s68, v11
  v_mul_f32 v12, s68, v12
  v_mul_f32 v13, s68, v13
  v_mul_f32 v14, s68, v14
  v_mul_f32 v15, s68, v15
  v_cvt_pk_bf16_f32 v52, v8, v12
  v_cvt_pk_bf16_f32 v53, v9, v13
  v_cvt_pk_bf16_f32 v54, v10, v14
  v_cvt_pk_bf16_f32 v55, v11, v15
  buffer_store_dwordx4 v[52:55], v216, s[8:11], s72 offen offset:256 sc1
  v_cvt_pk_bf16_f32 v56, v16, v17
  v_cvt_pk_bf16_f32 v57, v20, v21
  v_cvt_pk_bf16_f32 v58, v24, v25
  v_cvt_pk_bf16_f32 v59, v28, v29
  buffer_store_dwordx4 v[56:59], v217, s[8:11], s64 offen offset:0 sc1
  v_cvt_pk_bf16_f32 v60, v18, v19
  v_cvt_pk_bf16_f32 v61, v22, v23
  v_cvt_pk_bf16_f32 v62, v26, v27
  v_cvt_pk_bf16_f32 v63, v30, v31
  buffer_store_dwordx4 v[60:63], v217, s[8:11], s64 offen offset:256 sc1
  buffer_store_dwordx4 v[64:67], v201, s[8:11], s73 offen sc1
KV_fin:
  s_waitcnt vmcnt(0)
  s_barrier
  s_cmp_eq_u32 s52, 0
  s_cbranch_scc0 KV_sig
  v_mov_b32 v211, 256
  v_mov_b32 v212, 0
  s_mov_b64 exec, 1
  buffer_atomic_add v211, v212, s[12:15], s70 offen
  s_mov_b64 exec, -1
KV_sig:
  s_cmp_ge_u32 s53, 192
  s_cbranch_scc1 L_exit
  s_cmp_lt_u32 s53, 64
  s_cbranch_scc1 W_h
  s_sub_u32 s54, s53, 64
  s_lshr_b32 s68, s54, 4
  s_and_b32 s69, s54, 15
  s_lshl_b32 s60, s69, 2
  s_sub_u32 s60, s60, 1
  s_max_i32 s60, s60, 0
  s_mul_i32 s60, s60, 36864
  s_add_u32 m0, s67, 0
  s_nop 0
  buffer_load_dwordx4 v202, s[4:7], s60 offen offset:0 lds
  s_add_u32 m0, s67, 896
  s_nop 0
  buffer_load_dwordx4 v202, s[4:7], s60 offen offset:128 lds
  s_add_u32 m0, s67, 1792
  s_nop 0
  buffer_load_dwordx4 v202, s[4:7], s60 offen offset:256 lds
  s_add_u32 m0, s67, 2688
  s_nop 0
  buffer_load_dwordx4 v202, s[4:7], s60 offen offset:384 lds
  s_add_u32 m0, s67, 3584
  s_nop 0
  buffer_load_dwordx4 v202, s[4:7], s60 offen offset:512 lds
  s_add_u32 m0, s67, 4480
  s_nop 0
  buffer_load_dwordx4 v202, s[4:7], s60 offen offset:640 lds
  s_add_u32 m0, s67, 5376
  s_nop 0
  buffer_load_dwordx4 v202, s[4:7], s60 offen offset:768 lds
  s_add_u32 m0, s67, 6272
  s_nop 0
  buffer_load_dwordx4 v202, s[4:7], s60 offen offset:896 lds
  s_add_u32 m0, s67, 7168
  s_nop 0
  buffer_load_dwordx4 v202, s[4:7], s60 offen offset:1024 lds
  v_and_b32 v211, 15, v200
  v_mul_u32_u24 v211, 72, v211
  v_lshrrev_b32 v212, 4, v200
  v_mul_u32_u24 v213, 1152, v212
  v_add_u32 v213, v213, v211
  s_lshl_b32 s54, s54, 2
  s_add_u32 s70, s54, s52
  s_mul_i32 s55, s70, 4608
  buffer_load_dwordx4 v[48:51], v213, s[4:7], s55 offen offset:0
  buffer_load_dwordx4 v[52:55], v213, s[4:7], s55 offen offset:16
  buffer_load_dwordx4 v[56:59], v213, s[4:7], s55 offen offset:32
  buffer_load_dwordx4 v[60:63], v213, s[4:7], s55 offen offset:48
  buffer_load_dwordx2 v[64:65], v213, s[4:7], s55 offen offset:64
  buffer_load_dwordx4 v[68:71], v211, s[44:47], 0 offen offset:0
  buffer_load_dwordx4 v[72:75], v211, s[44:47], 0 offen offset:16
  buffer_load_dwordx4 v[76:79], v211, s[44:47], 0 offen offset:32
  buffer_load_dwordx4 v[80:83], v211, s[44:47], 0 offen offset:48
  buffer_load_dwordx2 v[84:85], v211, s[44:47], 0 offen offset:64
  v_mov_b32 v0, 0
  v_mov_b32 v1, 0x3f803f80
  s_waitcnt vmcnt(9)
  v_lshlrev_b32 v2, 16, v48
  s_waitcnt vmcnt(4)
  v_lshlrev_b32 v3, 16, v68
  v_and_b32 v4, 0xffff0000, v48
  v_and_b32 v5, 0xffff0000, v68
  v_mul_f32 v2, v2, v3
  v_mul_f32 v4, v4, v5
  v_cvt_pk_bf16_f32 v2, v2, v4
  v_lshlrev_b32 v3, 16, v2
  v_and_b32 v4, 0xffff0000, v2
  v_add_f32 v0, v0, v3
  v_add_f32 v0, v0, v4
  v_lshlrev_b32 v2, 16, v49
  v_lshlrev_b32 v3, 16, v69
  v_and_b32 v4, 0xffff0000, v49
  v_and_b32 v5, 0xffff0000, v69
  v_mul_f32 v2, v2, v3
  v_mul_f32 v4, v4, v5
  v_cvt_pk_bf16_f32 v2, v2, v4
  v_lshlrev_b32 v3, 16, v2
  v_and_b32 v4, 0xffff0000, v2
  v_add_f32 v0, v0, v3
  v_add_f32 v0, v0, v4
  v_lshlrev_b32 v2, 16, v50
  v_lshlrev_b32 v3, 16, v70
  v_and_b32 v4, 0xffff0000, v50
  v_and_b32 v5, 0xffff0000, v70
  v_mul_f32 v2, v2, v3
  v_mul_f32 v4, v4, v5
  v_cvt_pk_bf16_f32 v2, v2, v4
  v_lshlrev_b32 v3, 16, v2
  v_and_b32 v4, 0xffff0000, v2
  v_add_f32 v0, v0, v3
  v_add_f32 v0, v0, v4
  v_lshlrev_b32 v2, 16, v51
  v_lshlrev_b32 v3, 16, v71
  v_and_b32 v4, 0xffff0000, v51
  v_and_b32 v5, 0xffff0000, v71
  v_mul_f32 v2, v2, v3
  v_mul_f32 v4, v4, v5
  v_cvt_pk_bf16_f32 v2, v2, v4
  v_lshlrev_b32 v3, 16, v2
  v_and_b32 v4, 0xffff0000, v2
  v_add_f32 v0, v0, v3
  v_add_f32 v0, v0, v4
  v_lshlrev_b32 v2, 16, v52
  s_waitcnt vmcnt(3)
  v_lshlrev_b32 v3, 16, v72
  v_and_b32 v4, 0xffff0000, v52
  v_and_b32 v5, 0xffff0000, v72
  v_mul_f32 v2, v2, v3
  v_mul_f32 v4, v4, v5
  v_cvt_pk_bf16_f32 v2, v2, v4
  v_lshlrev_b32 v3, 16, v2
  v_and_b32 v4, 0xffff0000, v2
  v_add_f32 v0, v0, v3
  v_add_f32 v0, v0, v4
  v_lshlrev_b32 v2, 16, v53
  v_lshlrev_b32 v3, 16, v73
  v_and_b32 v4, 0xffff0000, v53
  v_and_b32 v5, 0xffff0000, v73
  v_mul_f32 v2, v2, v3
  v_mul_f32 v4, v4, v5
  v_cvt_pk_bf16_f32 v2, v2, v4
  v_lshlrev_b32 v3, 16, v2
  v_and_b32 v4, 0xffff0000, v2
  v_add_f32 v0, v0, v3
  v_add_f32 v0, v0, v4
  v_lshlrev_b32 v2, 16, v54
  v_lshlrev_b32 v3, 16, v74
  v_and_b32 v4, 0xffff0000, v54
  v_and_b32 v5, 0xffff0000, v74
  v_mul_f32 v2, v2, v3
  v_mul_f32 v4, v4, v5
  v_cvt_pk_bf16_f32 v2, v2, v4
  v_lshlrev_b32 v3, 16, v2
  v_and_b32 v4, 0xffff0000, v2
  v_add_f32 v0, v0, v3
  v_add_f32 v0, v0, v4
  v_lshlrev_b32 v2, 16, v55
  v_lshlrev_b32 v3, 16, v75
  v_and_b32 v4, 0xffff0000, v55
  v_and_b32 v5, 0xffff0000, v75
  v_mul_f32 v2, v2, v3
  v_mul_f32 v4, v4, v5
  v_cvt_pk_bf16_f32 v2, v2, v4
  v_lshlrev_b32 v3, 16, v2
  v_and_b32 v4, 0xffff0000, v2
  v_add_f32 v0, v0, v3
  v_add_f32 v0, v0, v4
  v_lshlrev_b32 v2, 16, v56
  s_waitcnt vmcnt(2)
  v_lshlrev_b32 v3, 16, v76
  v_and_b32 v4, 0xffff0000, v56
  v_and_b32 v5, 0xffff0000, v76
  v_mul_f32 v2, v2, v3
  v_mul_f32 v4, v4, v5
  v_cvt_pk_bf16_f32 v2, v2, v4
  v_lshlrev_b32 v3, 16, v2
  v_and_b32 v4, 0xffff0000, v2
  v_add_f32 v0, v0, v3
  v_add_f32 v0, v0, v4
  v_lshlrev_b32 v2, 16, v57
  v_lshlrev_b32 v3, 16, v77
  v_and_b32 v4, 0xffff0000, v57
  v_and_b32 v5, 0xffff0000, v77
  v_mul_f32 v2, v2, v3
  v_mul_f32 v4, v4, v5
  v_cvt_pk_bf16_f32 v2, v2, v4
  v_lshlrev_b32 v3, 16, v2
  v_and_b32 v4, 0xffff0000, v2
  v_add_f32 v0, v0, v3
  v_add_f32 v0, v0, v4
  v_lshlrev_b32 v2, 16, v58
  v_lshlrev_b32 v3, 16, v78
  v_and_b32 v4, 0xffff0000, v58
  v_and_b32 v5, 0xffff0000, v78
  v_mul_f32 v2, v2, v3
  v_mul_f32 v4, v4, v5
  v_cvt_pk_bf16_f32 v2, v2, v4
  v_lshlrev_b32 v3, 16, v2
  v_and_b32 v4, 0xffff0000, v2
  v_add_f32 v0, v0, v3
  v_add_f32 v0, v0, v4
  v_lshlrev_b32 v2, 16, v59
  v_lshlrev_b32 v3, 16, v79
  v_and_b32 v4, 0xffff0000, v59
  v_and_b32 v5, 0xffff0000, v79
  v_mul_f32 v2, v2, v3
  v_mul_f32 v4, v4, v5
  v_cvt_pk_bf16_f32 v2, v2, v4
  v_lshlrev_b32 v3, 16, v2
  v_and_b32 v4, 0xffff0000, v2
  v_add_f32 v0, v0, v3
  v_add_f32 v0, v0, v4
  v_lshlrev_b32 v2, 16, v60
  s_waitcnt vmcnt(1)
  v_lshlrev_b32 v3, 16, v80
  v_and_b32 v4, 0xffff0000, v60
  v_and_b32 v5, 0xffff0000, v80
  v_mul_f32 v2, v2, v3
  v_mul_f32 v4, v4, v5
  v_cvt_pk_bf16_f32 v2, v2, v4
  v_lshlrev_b32 v3, 16, v2
  v_and_b32 v4, 0xffff0000, v2
  v_add_f32 v0, v0, v3
  v_add_f32 v0, v0, v4
  v_lshlrev_b32 v2, 16, v61
  v_lshlrev_b32 v3, 16, v81
  v_and_b32 v4, 0xffff0000, v61
  v_and_b32 v5, 0xffff0000, v81
  v_mul_f32 v2, v2, v3
  v_mul_f32 v4, v4, v5
  v_cvt_pk_bf16_f32 v2, v2, v4
  v_lshlrev_b32 v3, 16, v2
  v_and_b32 v4, 0xffff0000, v2
  v_add_f32 v0, v0, v3
  v_add_f32 v0, v0, v4
  v_lshlrev_b32 v2, 16, v62
  v_lshlrev_b32 v3, 16, v82
  v_and_b32 v4, 0xffff0000, v62
  v_and_b32 v5, 0xffff0000, v82
  v_mul_f32 v2, v2, v3
  v_mul_f32 v4, v4, v5
  v_cvt_pk_bf16_f32 v2, v2, v4
  v_lshlrev_b32 v3, 16, v2
  v_and_b32 v4, 0xffff0000, v2
  v_add_f32 v0, v0, v3
  v_add_f32 v0, v0, v4
  v_lshlrev_b32 v2, 16, v63
  v_lshlrev_b32 v3, 16, v83
  v_and_b32 v4, 0xffff0000, v63
  v_and_b32 v5, 0xffff0000, v83
  v_mul_f32 v2, v2, v3
  v_mul_f32 v4, v4, v5
  v_cvt_pk_bf16_f32 v2, v2, v4
  v_lshlrev_b32 v3, 16, v2
  v_and_b32 v4, 0xffff0000, v2
  v_add_f32 v0, v0, v3
  v_add_f32 v0, v0, v4
  v_lshlrev_b32 v2, 16, v64
  s_waitcnt vmcnt(0)
  v_lshlrev_b32 v3, 16, v84
  v_and_b32 v4, 0xffff0000, v64
  v_and_b32 v5, 0xffff0000, v84
  v_mul_f32 v2, v2, v3
  v_mul_f32 v4, v4, v5
  v_cvt_pk_bf16_f32 v2, v2, v4
  v_lshlrev_b32 v3, 16, v2
  v_and_b32 v4, 0xffff0000, v2
  v_add_f32 v0, v0, v3
  v_add_f32 v0, v0, v4
  v_lshlrev_b32 v2, 16, v65
  v_lshlrev_b32 v3, 16, v85
  v_and_b32 v4, 0xffff0000, v65
  v_and_b32 v5, 0xffff0000, v85
  v_mul_f32 v2, v2, v3
  v_mul_f32 v4, v4, v5
  v_cvt_pk_bf16_f32 v2, v2, v4
  v_lshlrev_b32 v3, 16, v2
  v_and_b32 v4, 0xffff0000, v2
  v_add_f32 v0, v0, v3
  v_add_f32 v0, v0, v4
  s_nop 1
  v_add_f32_dpp v0, v0, v0 row_ror:1 row_mask:0xf bank_mask:0xf
  s_nop 1
  v_add_f32_dpp v0, v0, v0 row_ror:2 row_mask:0xf bank_mask:0xf
  s_nop 1
  v_add_f32_dpp v0, v0, v0 row_ror:4 row_mask:0xf bank_mask:0xf
  s_nop 1
  v_add_f32_dpp v0, v0, v0 row_ror:8 row_mask:0xf bank_mask:0xf
  v_cvt_pk_bf16_f32 v0, v0, v0
  v_lshlrev_b32 v0, 16, v0
  v_mul_f32 v0, 3216550459, v0
  v_exp_f32 v0, v0
  s_nop 0
  v_add_f32 v0, 1.0, v0
  v_rcp_f32 v0, v0
  s_nop 0
  v_cvt_pk_bf16_f32 v0, v0, v0
  v_lshlrev_b32 v0, 16, v0
  v_lshlrev_b32 v212, 2, v212
  s_lshl_b32 s55, s70, 4
  s_add_u32 s55, s55, 66060288
  s_mov_b32 exec_lo, 0x00010001
  s_mov_b32 exec_hi, 0x00010001
  buffer_store_dword v0, v212, s[8:11], s55 offen sc1
  s_mov_b64 exec, -1
  v_lshrrev_b32 v211, 4, v200
  v_lshlrev_b32 v212, 2, v211
  v_and_b32 v213, 15, v200
  v_xor_b32 v212, v212, v213
  v_mul_u32_u24 v211, 3456, v211
  v_mov_b32 v2, 0x40000000
  v_add_u32 v213, 0, v212
  v_mul_u32_u24 v214, 57, v213
  v_lshrrev_b32 v214, 9, v214
  v_mul_u32_u24 v214, 1008, v214
  v_lshl_add_u32 v214, v213, 4, v214
  v_add_u32 v214, v214, v211
  v_cmp_lt_u32 vcc, 26, v213
  s_nop 1
  v_cndmask_b32 v207, v214, v2, vcc
  v_add_u32 v213, 16, v212
  v_mul_u32_u24 v214, 57, v213
  v_lshrrev_b32 v214, 9, v214
  v_mul_u32_u24 v214, 1008, v214
  v_lshl_add_u32 v214, v213, 4, v214
  v_add_u32 v214, v214, v211
  v_cmp_lt_u32 vcc, 26, v213
  s_nop 1
  v_cndmask_b32 v208, v214, v2, vcc
  s_mul_i32 s62, s68, 144
  s_mul_i32 s54, s52, 13824
  s_add_u32 s62, s62, s54
  s_waitcnt vmcnt(0)
  s_lshl_b32 s61, s52, 10
  s_add_u32 s61, s61, 36864
  s_add_u32 m0, s61, 0
  s_add_u32 s54, s62, 0
  buffer_load_dwordx4 v207, s[36:39], s54 offen lds
  s_add_u32 m0, s61, 4096
  s_add_u32 s54, s62, 55296
  buffer_load_dwordx4 v207, s[36:39], s54 offen lds
  s_add_u32 m0, s61, 8192
  s_add_u32 s54, s62, 110592
  buffer_load_dwordx4 v207, s[36:39], s54 offen lds
  s_add_u32 m0, s61, 12288
  s_add_u32 s54, s62, 165888
  buffer_load_dwordx4 v207, s[36:39], s54 offen lds
  s_add_u32 m0, s61, 16384
  s_add_u32 s54, s62, 0
  buffer_load_dwordx4 v208, s[36:39], s54 offen lds
  s_add_u32 m0, s61, 20480
  s_add_u32 s54, s62, 55296
  buffer_load_dwordx4 v208, s[36:39], s54 offen lds
  s_add_u32 m0, s61, 24576
  s_add_u32 s54, s62, 110592
  buffer_load_dwordx4 v208, s[36:39], s54 offen lds
  s_add_u32 m0, s61, 28672
  s_add_u32 s54, s62, 165888
  buffer_load_dwordx4 v208, s[36:39], s54 offen lds
  s_add_u32 m0, s61, 32768
  s_add_u32 s54, s62, 221184
  buffer_load_dwordx4 v207, s[36:39], s54 offen lds
  s_add_u32 m0, s61, 36864
  s_add_u32 s54, s62, 276480
  buffer_load_dwordx4 v207, s[36:39], s54 offen lds
  s_add_u32 m0, s61, 40960
  s_add_u32 s54, s62, 331776
  buffer_load_dwordx4 v207, s[36:39], s54 offen lds
  s_add_u32 m0, s61, 45056
  s_add_u32 s54, s62, 387072
  buffer_load_dwordx4 v207, s[36:39], s54 offen lds
  s_add_u32 m0, s61, 49152
  s_add_u32 s54, s62, 221184
  buffer_load_dwordx4 v208, s[36:39], s54 offen lds
  s_add_u32 m0, s61, 53248
  s_add_u32 s54, s62, 276480
  buffer_load_dwordx4 v208, s[36:39], s54 offen lds
  s_add_u32 m0, s61, 57344
  s_add_u32 s54, s62, 331776
  buffer_load_dwordx4 v208, s[36:39], s54 offen lds
  s_add_u32 m0, s61, 61440
  s_add_u32 s54, s62, 387072
  buffer_load_dwordx4 v208, s[36:39], s54 offen lds
  s_add_u32 m0, s61, 65536
  s_add_u32 s54, s62, 442368
  buffer_load_dwordx4 v207, s[36:39], s54 offen lds
  s_add_u32 m0, s61, 69632
  s_add_u32 s54, s62, 497664
  buffer_load_dwordx4 v207, s[36:39], s54 offen lds
  s_add_u32 m0, s61, 73728
  s_add_u32 s54, s62, 552960
  buffer_load_dwordx4 v207, s[36:39], s54 offen lds
  s_add_u32 m0, s61, 77824
  s_add_u32 s54, s62, 608256
  buffer_load_dwordx4 v207, s[36:39], s54 offen lds
  s_add_u32 m0, s61, 81920
  s_add_u32 s54, s62, 442368
  buffer_load_dwordx4 v208, s[36:39], s54 offen lds
  s_add_u32 m0, s61, 86016
  s_add_u32 s54, s62, 497664
  buffer_load_dwordx4 v208, s[36:39], s54 offen lds
  s_add_u32 m0, s61, 90112
  s_add_u32 s54, s62, 552960
  buffer_load_dwordx4 v208, s[36:39], s54 offen lds
  s_add_u32 m0, s61, 94208
  s_add_u32 s54, s62, 608256
  buffer_load_dwordx4 v208, s[36:39], s54 offen lds
  s_waitcnt vmcnt(20) lgkmcnt(0)
  s_barrier
  s_add_u32 m0, s61, 98304
  s_add_u32 s54, s62, 663552
  buffer_load_dwordx4 v207, s[36:39], s54 offen lds
  s_add_u32 m0, s61, 102400
  s_add_u32 s54, s62, 718848
  buffer_load_dwordx4 v207, s[36:39], s54 offen lds
  s_add_u32 m0, s61, 106496
  s_add_u32 s54, s62, 774144
  buffer_load_dwordx4 v207, s[36:39], s54 offen lds
  s_add_u32 m0, s61, 110592
  s_add_u32 s54, s62, 829440
  buffer_load_dwordx4 v207, s[36:39], s54 offen lds
  v_add_u32 v215, 36864, v210
  ds_read_b64_tr_b16 a[0:1], v215 offset:0
  ds_read_b64_tr_b16 a[2:3], v215 offset:1024
  ds_read_b64_tr_b16 a[4:5], v215 offset:4096
  ds_read_b64_tr_b16 a[6:7], v215 offset:5120
  ds_read_b64_tr_b16 a[8:9], v215 offset:8192
  ds_read_b64_tr_b16 a[10:11], v215 offset:9216
  ds_read_b64_tr_b16 a[12:13], v215 offset:12288
  ds_read_b64_tr_b16 a[14:15], v215 offset:13312
  s_waitcnt vmcnt(20) lgkmcnt(0)
  s_barrier
  s_add_u32 m0, s61, 0
  s_add_u32 s54, s62, 663552
  buffer_load_dwordx4 v208, s[36:39], s54 offen lds
  s_add_u32 m0, s61, 4096
  s_add_u32 s54, s62, 718848
  buffer_load_dwordx4 v208, s[36:39], s54 offen lds
  s_add_u32 m0, s61, 8192
  s_add_u32 s54, s62, 774144
  buffer_load_dwordx4 v208, s[36:39], s54 offen lds
  s_add_u32 m0, s61, 12288
  s_add_u32 s54, s62, 829440
  buffer_load_dwordx4 v208, s[36:39], s54 offen lds
  v_add_u32 v215, 53248, v210
  ds_read_b64_tr_b16 a[144:145], v215 offset:0
  ds_read_b64_tr_b16 a[146:147], v215 offset:1024
  ds_read_b64_tr_b16 a[148:149], v215 offset:4096
  ds_read_b64_tr_b16 a[150:151], v215 offset:5120
  ds_read_b64_tr_b16 a[152:153], v215 offset:8192
  ds_read_b64_tr_b16 a[154:155], v215 offset:9216
  ds_read_b64_tr_b16 a[156:157], v215 offset:12288
  ds_read_b64_tr_b16 a[158:159], v215 offset:13312
  s_waitcnt vmcnt(20) lgkmcnt(0)
  s_barrier
  s_add_u32 m0, s61, 16384
  s_add_u32 s54, s62, 884736
  buffer_load_dwordx4 v207, s[36:39], s54 offen lds
  s_add_u32 m0, s61, 20480
  s_add_u32 s54, s62, 940032
  buffer_load_dwordx4 v207, s[36:39], s54 offen lds
  s_add_u32 m0, s61, 24576
  s_add_u32 s54, s62, 995328
  buffer_load_dwordx4 v207, s[36:39], s54 offen lds
  s_add_u32 m0, s61, 28672
  s_add_u32 s54, s62, 1050624
  buffer_load_dwordx4 v207, s[36:39], s54 offen lds
  v_add_u32 v215, 69632, v210
  ds_read_b64_tr_b16 a[16:17], v215 offset:0
  ds_read_b64_tr_b16 a[18:19], v215 offset:1024
  ds_read_b64_tr_b16 a[20:21], v215 offset:4096
  ds_read_b64_tr_b16 a[22:23], v215 offset:5120
  ds_read_b64_tr_b16 a[24:25], v215 offset:8192
  ds_read_b64_tr_b16 a[26:27], v215 offset:9216
  ds_read_b64_tr_b16 a[28:29], v215 offset:12288
  ds_read_b64_tr_b16 a[30:31], v215 offset:13312
  s_waitcnt vmcnt(20) lgkmcnt(0)
  s_barrier
  s_add_u32 m0, s61, 32768
  s_add_u32 s54, s62, 884736
  buffer_load_dwordx4 v208, s[36:39], s54 offen lds
  s_add_u32 m0, s61, 36864
  s_add_u32 s54, s62, 940032
  buffer_load_dwordx4 v208, s[36:39], s54 offen lds
  s_add_u32 m0, s61, 40960
  s_add_u32 s54, s62, 995328
  buffer_load_dwordx4 v208, s[36:39], s54 offen lds
  s_add_u32 m0, s61, 45056
  s_add_u32 s54, s62, 1050624
  buffer_load_dwordx4 v208, s[36:39], s54 offen lds
  v_add_u32 v215, 86016, v210
  ds_read_b64_tr_b16 a[160:161], v215 offset:0
  ds_read_b64_tr_b16 a[162:163], v215 offset:1024
  ds_read_b64_tr_b16 a[164:165], v215 offset:4096
  ds_read_b64_tr_b16 a[166:167], v215 offset:5120
  ds_read_b64_tr_b16 a[168:169], v215 offset:8192
  ds_read_b64_tr_b16 a[170:171], v215 offset:9216
  ds_read_b64_tr_b16 a[172:173], v215 offset:12288
  ds_read_b64_tr_b16 a[174:175], v215 offset:13312
  s_waitcnt vmcnt(20) lgkmcnt(0)
  s_barrier
  s_add_u32 m0, s61, 49152
  s_add_u32 s54, s62, 1105920
  buffer_load_dwordx4 v207, s[36:39], s54 offen lds
  s_add_u32 m0, s61, 53248
  s_add_u32 s54, s62, 1161216
  buffer_load_dwordx4 v207, s[36:39], s54 offen lds
  s_add_u32 m0, s61, 57344
  s_add_u32 s54, s62, 1216512
  buffer_load_dwordx4 v207, s[36:39], s54 offen lds
  s_add_u32 m0, s61, 61440
  s_add_u32 s54, s62, 1271808
  buffer_load_dwordx4 v207, s[36:39], s54 offen lds
  v_add_u32 v215, 102400, v210
  ds_read_b64_tr_b16 a[32:33], v215 offset:0
  ds_read_b64_tr_b16 a[34:35], v215 offset:1024
  ds_read_b64_tr_b16 a[36:37], v215 offset:4096
  ds_read_b64_tr_b16 a[38:39], v215 offset:5120
  ds_read_b64_tr_b16 a[40:41], v215 offset:8192
  ds_read_b64_tr_b16 a[42:43], v215 offset:9216
  ds_read_b64_tr_b16 a[44:45], v215 offset:12288
  ds_read_b64_tr_b16 a[46:47], v215 offset:13312
  s_waitcnt vmcnt(20) lgkmcnt(0)
  s_barrier
  s_add_u32 m0, s61, 65536
  s_add_u32 s54, s62, 1105920
  buffer_load_dwordx4 v208, s[36:39], s54 offen lds
  s_add_u32 m0, s61, 69632
  s_add_u32 s54, s62, 1161216
  buffer_load_dwordx4 v208, s[36:39], s54 offen lds
  s_add_u32 m0, s61, 73728
  s_add_u32 s54, s62, 1216512
  buffer_load_dwordx4 v208, s[36:39], s54 offen lds
  s_add_u32 m0, s61, 77824
  s_add_u32 s54, s62, 1271808
  buffer_load_dwordx4 v208, s[36:39], s54 offen lds
  v_add_u32 v215, 118784, v210
  ds_read_b64_tr_b16 a[176:177], v215 offset:0
  ds_read_b64_tr_b16 a[178:179], v215 offset:1024
  ds_read_b64_tr_b16 a[180:181], v215 offset:4096
  ds_read_b64_tr_b16 a[182:183], v215 offset:5120
  ds_read_b64_tr_b16 a[184:185], v215 offset:8192
  ds_read_b64_tr_b16 a[186:187], v215 offset:9216
  ds_read_b64_tr_b16 a[188:189], v215 offset:12288
  ds_read_b64_tr_b16 a[190:191], v215 offset:13312
  s_waitcnt vmcnt(20) lgkmcnt(0)
  s_barrier
  s_add_u32 m0, s61, 81920
  s_add_u32 s54, s62, 1327104
  buffer_load_dwordx4 v207, s[36:39], s54 offen lds
  s_add_u32 m0, s61, 86016
  s_add_u32 s54, s62, 1382400
  buffer_load_dwordx4 v207, s[36:39], s54 offen lds
  s_add_u32 m0, s61, 90112
  s_add_u32 s54, s62, 1437696
  buffer_load_dwordx4 v207, s[36:39], s54 offen lds
  s_add_u32 m0, s61, 94208
  s_add_u32 s54, s62, 1492992
  buffer_load_dwordx4 v207, s[36:39], s54 offen lds
  v_add_u32 v215, 135168, v210
  ds_read_b64_tr_b16 a[48:49], v215 offset:0
  ds_read_b64_tr_b16 a[50:51], v215 offset:1024
  ds_read_b64_tr_b16 a[52:53], v215 offset:4096
  ds_read_b64_tr_b16 a[54:55], v215 offset:5120
  ds_read_b64_tr_b16 a[56:57], v215 offset:8192
  ds_read_b64_tr_b16 a[58:59], v215 offset:9216
  ds_read_b64_tr_b16 a[60:61], v215 offset:12288
  ds_read_b64_tr_b16 a[62:63], v215 offset:13312
  s_waitcnt vmcnt(20) lgkmcnt(0)
  s_barrier
  s_add_u32 m0, s61, 98304
  s_add_u32 s54, s62, 1327104
  buffer_load_dwordx4 v208, s[36:39], s54 offen lds
  s_add_u32 m0, s61, 102400
  s_add_u32 s54, s62, 1382400
  buffer_load_dwordx4 v208, s[36:39], s54 offen lds
  s_add_u32 m0, s61, 106496
  s_add_u32 s54, s62, 1437696
  buffer_load_dwordx4 v208, s[36:39], s54 offen lds
  s_add_u32 m0, s61, 110592
  s_add_u32 s54, s62, 1492992
  buffer_load_dwordx4 v208, s[36:39], s54 offen lds
  v_add_u32 v215, 36864, v210
  ds_read_b64_tr_b16 a[192:193], v215 offset:0
  ds_read_b64_tr_b16 a[194:195], v215 offset:1024
  ds_read_b64_tr_b16 a[196:197], v215 offset:4096
  ds_read_b64_tr_b16 a[198:199], v215 offset:5120
  ds_read_b64_tr_b16 a[200:201], v215 offset:8192
  ds_read_b64_tr_b16 a[202:203], v215 offset:9216
  ds_read_b64_tr_b16 a[204:205], v215 offset:12288
  ds_read_b64_tr_b16 a[206:207], v215 offset:13312
  s_waitcnt vmcnt(20) lgkmcnt(0)
  s_barrier
  s_add_u32 m0, s61, 0
  s_add_u32 s54, s62, 1548288
  buffer_load_dwordx4 v207, s[36:39], s54 offen lds
  s_add_u32 m0, s61, 4096
  s_add_u32 s54, s62, 1603584
  buffer_load_dwordx4 v207, s[36:39], s54 offen lds
  s_add_u32 m0, s61, 8192
  s_add_u32 s54, s62, 1658880
  buffer_load_dwordx4 v207, s[36:39], s54 offen lds
  s_add_u32 m0, s61, 12288
  s_add_u32 s54, s62, 1714176
  buffer_load_dwordx4 v207, s[36:39], s54 offen lds
  v_add_u32 v215, 53248, v210
  ds_read_b64_tr_b16 a[64:65], v215 offset:0
  ds_read_b64_tr_b16 a[66:67], v215 offset:1024
  ds_read_b64_tr_b16 a[68:69], v215 offset:4096
  ds_read_b64_tr_b16 a[70:71], v215 offset:5120
  ds_read_b64_tr_b16 a[72:73], v215 offset:8192
  ds_read_b64_tr_b16 a[74:75], v215 offset:9216
  ds_read_b64_tr_b16 a[76:77], v215 offset:12288
  ds_read_b64_tr_b16 a[78:79], v215 offset:13312
  s_waitcnt vmcnt(20) lgkmcnt(0)
  s_barrier
  s_add_u32 m0, s61, 16384
  s_add_u32 s54, s62, 1548288
  buffer_load_dwordx4 v208, s[36:39], s54 offen lds
  s_add_u32 m0, s61, 20480
  s_add_u32 s54, s62, 1603584
  buffer_load_dwordx4 v208, s[36:39], s54 offen lds
  s_add_u32 m0, s61, 24576
  s_add_u32 s54, s62, 1658880
  buffer_load_dwordx4 v208, s[36:39], s54 offen lds
  s_add_u32 m0, s61, 28672
  s_add_u32 s54, s62, 1714176
  buffer_load_dwordx4 v208, s[36:39], s54 offen lds
  v_add_u32 v215, 69632, v210
  ds_read_b64_tr_b16 a[208:209], v215 offset:0
  ds_read_b64_tr_b16 a[210:211], v215 offset:1024
  ds_read_b64_tr_b16 a[212:213], v215 offset:4096
  ds_read_b64_tr_b16 a[214:215], v215 offset:5120
  ds_read_b64_tr_b16 a[216:217], v215 offset:8192
  ds_read_b64_tr_b16 a[218:219], v215 offset:9216
  ds_read_b64_tr_b16 a[220:221], v215 offset:12288
  ds_read_b64_tr_b16 a[222:223], v215 offset:13312
  s_waitcnt vmcnt(20) lgkmcnt(0)
  s_barrier
  s_add_u32 m0, s61, 32768
  s_add_u32 s54, s62, 1769472
  buffer_load_dwordx4 v207, s[36:39], s54 offen lds
  s_add_u32 m0, s61, 36864
  s_add_u32 s54, s62, 1824768
  buffer_load_dwordx4 v207, s[36:39], s54 offen lds
  s_add_u32 m0, s61, 40960
  s_add_u32 s54, s62, 1880064
  buffer_load_dwordx4 v207, s[36:39], s54 offen lds
  s_add_u32 m0, s61, 45056
  s_add_u32 s54, s62, 1935360
  buffer_load_dwordx4 v207, s[36:39], s54 offen lds
  v_add_u32 v215, 86016, v210
  ds_read_b64_tr_b16 a[80:81], v215 offset:0
  ds_read_b64_tr_b16 a[82:83], v215 offset:1024
  ds_read_b64_tr_b16 a[84:85], v215 offset:4096
  ds_read_b64_tr_b16 a[86:87], v215 offset:5120
  ds_read_b64_tr_b16 a[88:89], v215 offset:8192
  ds_read_b64_tr_b16 a[90:91], v215 offset:9216
  ds_read_b64_tr_b16 a[92:93], v215 offset:12288
  ds_read_b64_tr_b16 a[94:95], v215 offset:13312
  s_waitcnt vmcnt(20) lgkmcnt(0)
  s_barrier
  s_add_u32 m0, s61, 49152
  s_add_u32 s54, s62, 1769472
  buffer_load_dwordx4 v208, s[36:39], s54 offen lds
  s_add_u32 m0, s61, 53248
  s_add_u32 s54, s62, 1824768
  buffer_load_dwordx4 v208, s[36:39], s54 offen lds
  s_add_u32 m0, s61, 57344
  s_add_u32 s54, s62, 1880064
  buffer_load_dwordx4 v208, s[36:39], s54 offen lds
  s_add_u32 m0, s61, 61440
  s_add_u32 s54, s62, 1935360
  buffer_load_dwordx4 v208, s[36:39], s54 offen lds
  v_add_u32 v215, 102400, v210
  ds_read_b64_tr_b16 a[224:225], v215 offset:0
  ds_read_b64_tr_b16 a[226:227], v215 offset:1024
  ds_read_b64_tr_b16 a[228:229], v215 offset:4096
  ds_read_b64_tr_b16 a[230:231], v215 offset:5120
  ds_read_b64_tr_b16 a[232:233], v215 offset:8192
  ds_read_b64_tr_b16 a[234:235], v215 offset:9216
  ds_read_b64_tr_b16 a[236:237], v215 offset:12288
  ds_read_b64_tr_b16 a[238:239], v215 offset:13312
  s_waitcnt vmcnt(20) lgkmcnt(0)
  s_barrier
  v_add_u32 v215, 118784, v210
  ds_read_b64_tr_b16 a[96:97], v215 offset:0
  ds_read_b64_tr_b16 a[98:99], v215 offset:1024
  ds_read_b64_tr_b16 a[100:101], v215 offset:4096
  ds_read_b64_tr_b16 a[102:103], v215 offset:5120
  ds_read_b64_tr_b16 a[104:105], v215 offset:8192
  ds_read_b64_tr_b16 a[106:107], v215 offset:9216
  ds_read_b64_tr_b16 a[108:109], v215 offset:12288
  ds_read_b64_tr_b16 a[110:111], v215 offset:13312
  s_waitcnt vmcnt(16) lgkmcnt(0)
  s_barrier
  v_add_u32 v215, 135168, v210
  ds_read_b64_tr_b16 a[240:241], v215 offset:0
  ds_read_b64_tr_b16 a[242:243], v215 offset:1024
  ds_read_b64_tr_b16 a[244:245], v215 offset:4096
  ds_read_b64_tr_b16 a[246:247], v215 offset:5120
  ds_read_b64_tr_b16 a[248:249], v215 offset:8192
  ds_read_b64_tr_b16 a[250:251], v215 offset:9216
  ds_read_b64_tr_b16 a[252:253], v215 offset:12288
  ds_read_b64_tr_b16 a[254:255], v215 offset:13312
  s_waitcnt vmcnt(12) lgkmcnt(0)
  s_barrier
  v_add_u32 v215, 36864, v210
  ds_read_b64_tr_b16 a[112:113], v215 offset:0
  ds_read_b64_tr_b16 a[114:115], v215 offset:1024
  ds_read_b64_tr_b16 a[116:117], v215 offset:4096
  ds_read_b64_tr_b16 a[118:119], v215 offset:5120
  ds_read_b64_tr_b16 a[120:121], v215 offset:8192
  ds_read_b64_tr_b16 a[122:123], v215 offset:9216
  ds_read_b64_tr_b16 a[124:125], v215 offset:12288
  ds_read_b64_tr_b16 a[126:127], v215 offset:13312
  s_waitcnt vmcnt(8) lgkmcnt(0)
  s_barrier
  v_add_u32 v215, 53248, v210
  ds_read_b64_tr_b16 v[224:225], v215 offset:0
  ds_read_b64_tr_b16 v[226:227], v215 offset:1024
  ds_read_b64_tr_b16 v[228:229], v215 offset:4096
  ds_read_b64_tr_b16 v[230:231], v215 offset:5120
  ds_read_b64_tr_b16 v[232:233], v215 offset:8192
  ds_read_b64_tr_b16 v[234:235], v215 offset:9216
  ds_read_b64_tr_b16 v[236:237], v215 offset:12288
  ds_read_b64_tr_b16 v[238:239], v215 offset:13312
  s_waitcnt vmcnt(4) lgkmcnt(0)
  s_barrier
  v_add_u32 v215, 69632, v210
  ds_read_b64_tr_b16 a[128:129], v215 offset:0
  ds_read_b64_tr_b16 a[130:131], v215 offset:1024
  ds_read_b64_tr_b16 a[132:133], v215 offset:4096
  ds_read_b64_tr_b16 a[134:135], v215 offset:5120
  ds_read_b64_tr_b16 a[136:137], v215 offset:8192
  ds_read_b64_tr_b16 a[138:139], v215 offset:9216
  ds_read_b64_tr_b16 a[140:141], v215 offset:12288
  ds_read_b64_tr_b16 a[142:143], v215 offset:13312
  s_waitcnt vmcnt(0) lgkmcnt(0)
  s_barrier
  v_add_u32 v215, 86016, v210
  ds_read_b64_tr_b16 v[240:241], v215 offset:0
  ds_read_b64_tr_b16 v[242:243], v215 offset:1024
  ds_read_b64_tr_b16 v[244:245], v215 offset:4096
  ds_read_b64_tr_b16 v[246:247], v215 offset:5120
  ds_read_b64_tr_b16 v[248:249], v215 offset:8192
  ds_read_b64_tr_b16 v[250:251], v215 offset:9216
  ds_read_b64_tr_b16 v[252:253], v215 offset:12288
  ds_read_b64_tr_b16 v[254:255], v215 offset:13312
  s_waitcnt lgkmcnt(0)
  s_barrier
  v_and_b32 v211, 31, v200
  v_mul_u32_u24 v218, 516, v211
  v_lshrrev_b32 v212, 5, v200
  v_lshl_add_u32 v218, v212, 3, v218
  s_lshl_b32 s54, s52, 6
  s_add_u32 s54, s54, 73728
  v_add_u32 v218, s54, v218
  s_lshl_b32 s60, s69, 2
  s_mul_i32 s60, s60, 36864
  ds_read_b128 v[32:35], v203 offset:0
  ds_read_b128 v[36:39], v204 offset:0
  ds_read_b128 v[40:43], v205 offset:0
  s_waitcnt lgkmcnt(2)
  v_mfma_f32_32x32x16_bf16 v[0:15], a[0:3], v[32:35], 0
  ds_read_b128 v[44:47], v206 offset:0
  s_add_u32 m0, s67, 36864
  s_nop 0
  buffer_load_dwordx4 v202, s[4:7], s60 offen offset:0 lds
  v_mfma_f32_32x32x16_bf16 v[16:31], a[144:147], v[32:35], 0
  s_waitcnt lgkmcnt(2)
  v_mfma_f32_32x32x16_bf16 v[0:15], a[4:7], v[36:39], v[0:15]
  ds_read_b128 v[32:35], v203 offset:1024
  s_add_u32 m0, s67, 37760
  s_nop 0
  buffer_load_dwordx4 v202, s[4:7], s60 offen offset:128 lds
  v_mfma_f32_32x32x16_bf16 v[16:31], a[148:151], v[36:39], v[16:31]
  s_waitcnt lgkmcnt(2)
  v_mfma_f32_32x32x16_bf16 v[0:15], a[8:11], v[40:43], v[0:15]
  ds_read_b128 v[36:39], v204 offset:1024
  s_add_u32 m0, s67, 38656
  s_nop 0
  buffer_load_dwordx4 v202, s[4:7], s60 offen offset:256 lds
  v_mfma_f32_32x32x16_bf16 v[16:31], a[152:155], v[40:43], v[16:31]
  s_waitcnt lgkmcnt(2)
  v_mfma_f32_32x32x16_bf16 v[0:15], a[12:15], v[44:47], v[0:15]
  ds_read_b128 v[40:43], v205 offset:1024
  s_add_u32 m0, s67, 39552
  s_nop 0
  buffer_load_dwordx4 v202, s[4:7], s60 offen offset:384 lds
  v_mfma_f32_32x32x16_bf16 v[16:31], a[156:159], v[44:47], v[16:31]
  s_waitcnt lgkmcnt(2)
  v_mfma_f32_32x32x16_bf16 v[0:15], a[16:19], v[32:35], v[0:15]
  ds_read_b128 v[44:47], v206 offset:1024
  s_add_u32 m0, s67, 40448
  s_nop 0
  buffer_load_dwordx4 v202, s[4:7], s60 offen offset:512 lds
  v_mfma_f32_32x32x16_bf16 v[16:31], a[160:163], v[32:35], v[16:31]
  s_waitcnt lgkmcnt(2)
  v_mfma_f32_32x32x16_bf16 v[0:15], a[20:23], v[36:39], v[0:15]
  ds_read_b128 v[32:35], v203 offset:2048
  s_add_u32 m0, s67, 41344
  s_nop 0
  buffer_load_dwordx4 v202, s[4:7], s60 offen offset:640 lds
  v_mfma_f32_32x32x16_bf16 v[16:31], a[164:167], v[36:39], v[16:31]
  s_waitcnt lgkmcnt(2)
  v_mfma_f32_32x32x16_bf16 v[0:15], a[24:27], v[40:43], v[0:15]
  ds_read_b128 v[36:39], v204 offset:2048
  s_add_u32 m0, s67, 42240
  s_nop 0
  buffer_load_dwordx4 v202, s[4:7], s60 offen offset:768 lds
  v_mfma_f32_32x32x16_bf16 v[16:31], a[168:171], v[40:43], v[16:31]
  s_waitcnt lgkmcnt(2)
  v_mfma_f32_32x32x16_bf16 v[0:15], a[28:31], v[44:47], v[0:15]
  ds_read_b128 v[40:43], v205 offset:2048
  s_add_u32 m0, s67, 43136
  s_nop 0
  buffer_load_dwordx4 v202, s[4:7], s60 offen offset:896 lds
  v_mfma_f32_32x32x16_bf16 v[16:31], a[172:175], v[44:47], v[16:31]
  s_waitcnt lgkmcnt(2)
  v_mfma_f32_32x32x16_bf16 v[0:15], a[32:35], v[32:35], v[0:15]
  ds_read_b128 v[44:47], v206 offset:2048
  s_add_u32 m0, s67, 44032
  s_nop 0
  buffer_load_dwordx4 v202, s[4:7], s60 offen offset:1024 lds
  v_mfma_f32_32x32x16_bf16 v[16:31], a[176:179], v[32:35], v[16:31]
  s_waitcnt lgkmcnt(2)
  v_mfma_f32_32x32x16_bf16 v[0:15], a[36:39], v[36:39], v[0:15]
  ds_read_b128 v[32:35], v203 offset:3072
  v_mfma_f32_32x32x16_bf16 v[16:31], a[180:183], v[36:39], v[16:31]
  s_waitcnt lgkmcnt(2)
  v_mfma_f32_32x32x16_bf16 v[0:15], a[40:43], v[40:43], v[0:15]
  ds_read_b128 v[36:39], v204 offset:3072
  v_mfma_f32_32x32x16_bf16 v[16:31], a[184:187], v[40:43], v[16:31]
  s_waitcnt lgkmcnt(2)
  v_mfma_f32_32x32x16_bf16 v[0:15], a[44:47], v[44:47], v[0:15]
  ds_read_b128 v[40:43], v205 offset:3072
  v_mfma_f32_32x32x16_bf16 v[16:31], a[188:191], v[44:47], v[16:31]
  s_waitcnt lgkmcnt(2)
  v_mfma_f32_32x32x16_bf16 v[0:15], a[48:51], v[32:35], v[0:15]
  ds_read_b128 v[44:47], v206 offset:3072
  v_mfma_f32_32x32x16_bf16 v[16:31], a[192:195], v[32:35], v[16:31]
  s_waitcnt lgkmcnt(2)
  v_mfma_f32_32x32x16_bf16 v[0:15], a[52:55], v[36:39], v[0:15]
  ds_read_b128 v[32:35], v203 offset:4096
  v_mfma_f32_32x32x16_bf16 v[16:31], a[196:199], v[36:39], v[16:31]
  s_waitcnt lgkmcnt(2)
  v_mfma_f32_32x32x16_bf16 v[0:15], a[56:59], v[40:43], v[0:15]
  ds_read_b128 v[36:39], v204 offset:4096
  v_mfma_f32_32x32x16_bf16 v[16:31], a[200:203], v[40:43], v[16:31]
  s_waitcnt lgkmcnt(2)
  v_mfma_f32_32x32x16_bf16 v[0:15], a[60:63], v[44:47], v[0:15]
  ds_read_b128 v[40:43], v205 offset:4096
  v_mfma_f32_32x32x16_bf16 v[16:31], a[204:207], v[44:47], v[16:31]
  s_waitcnt lgkmcnt(2)
  v_mfma_f32_32x32x16_bf16 v[0:15], a[64:67], v[32:35], v[0:15]
  ds_read_b128 v[44:47], v206 offset:4096
  v_mfma_f32_32x32x16_bf16 v[16:31], a[208:211], v[32:35], v[16:31]
  s_waitcnt lgkmcnt(2)
  v_mfma_f32_32x32x16_bf16 v[0:15], a[68:71], v[36:39], v[0:15]
  ds_read_b128 v[32:35], v203 offset:5120
  v_mfma_f32_32x32x16_bf16 v[16:31], a[212:215], v[36:39], v[16:31]
  s_waitcnt lgkmcnt(2)
  v_mfma_f32_32x32x16_bf16 v[0:15], a[72:75], v[40:43], v[0:15]
  ds_read_b128 v[36:39], v204 offset:5120
  v_mfma_f32_32x32x16_bf16 v[16:31], a[216:219], v[40:43], v[16:31]
  s_waitcnt lgkmcnt(2)
  v_mfma_f32_32x32x16_bf16 v[0:15], a[76:79], v[44:47], v[0:15]
  ds_read_b128 v[40:43], v205 offset:5120
  v_mfma_f32_32x32x16_bf16 v[16:31], a[220:223], v[44:47], v[16:31]
  s_waitcnt lgkmcnt(2)
  v_mfma_f32_32x32x16_bf16 v[0:15], a[80:83], v[32:35], v[0:15]
  ds_read_b128 v[44:47], v206 offset:5120
  v_mfma_f32_32x32x16_bf16 v[16:31], a[224:227], v[32:35], v[16:31]
  s_waitcnt lgkmcnt(2)
  v_mfma_f32_32x32x16_bf16 v[0:15], a[84:87], v[36:39], v[0:15]
  ds_read_b128 v[32:35], v203 offset:6144
  v_mfma_f32_32x32x16_bf16 v[16:31], a[228:231], v[36:39], v[16:31]
  s_waitcnt lgkmcnt(2)
  v_mfma_f32_32x32x16_bf16 v[0:15], a[88:91], v[40:43], v[0:15]
  ds_read_b128 v[36:39], v204 offset:6144
  v_mfma_f32_32x32x16_bf16 v[16:31], a[232:235], v[40:43], v[16:31]
  s_waitcnt lgkmcnt(2)
  v_mfma_f32_32x32x16_bf16 v[0:15], a[92:95], v[44:47], v[0:15]
  ds_read_b128 v[40:43], v205 offset:6144
  v_mfma_f32_32x32x16_bf16 v[16:31], a[236:239], v[44:47], v[16:31]
  s_waitcnt lgkmcnt(2)
  v_mfma_f32_32x32x16_bf16 v[0:15], a[96:99], v[32:35], v[0:15]
  ds_read_b128 v[44:47], v206 offset:6144
  v_mfma_f32_32x32x16_bf16 v[16:31], a[240:243], v[32:35], v[16:31]
  s_waitcnt lgkmcnt(2)
  v_mfma_f32_32x32x16_bf16 v[0:15], a[100:103], v[36:39], v[0:15]
  ds_read_b128 v[32:35], v203 offset:7168
  v_mfma_f32_32x32x16_bf16 v[16:31], a[244:247], v[36:39], v[16:31]
  s_waitcnt lgkmcnt(2)
  v_mfma_f32_32x32x16_bf16 v[0:15], a[104:107], v[40:43], v[0:15]
  ds_read_b128 v[36:39], v204 offset:7168
  v_mfma_f32_32x32x16_bf16 v[16:31], a[248:251], v[40:43], v[16:31]
  s_waitcnt lgkmcnt(2)
  v_mfma_f32_32x32x16_bf16 v[0:15], a[108:111], v[44:47], v[0:15]
  ds_read_b128 v[40:43], v205 offset:7168
  v_mfma_f32_32x32x16_bf16 v[16:31], a[252:255], v[44:47], v[16:31]
  s_waitcnt lgkmcnt(2)
  v_mfma_f32_32x32x16_bf16 v[0:15], a[112:115], v[32:35], v[0:15]
  ds_read_b128 v[44:47], v206 offset:7168
  v_mfma_f32_32x32x16_bf16 v[16:31], v[224:227], v[32:35], v[16:31]
  s_waitcnt lgkmcnt(2)
  v_mfma_f32_32x32x16_bf16 v[0:15], a[116:119], v[36:39], v[0:15]
  ds_read_b128 v[32:35], v203 offset:8192
  v_mfma_f32_32x32x16_bf16 v[16:31], v[228:231], v[36:39], v[16:31]
  s_waitcnt lgkmcnt(2)
  v_mfma_f32_32x32x16_bf16 v[0:15], a[120:123], v[40:43], v[0:15]
  ds_read_b128 v[36:39], v204 offset:8192
  v_mfma_f32_32x32x16_bf16 v[16:31], v[232:235], v[40:43], v[16:31]
  s_waitcnt lgkmcnt(2)
  v_mfma_f32_32x32x16_bf16 v[0:15], a[124:127], v[44:47], v[0:15]
  ds_read_b128 v[40:43], v205 offset:8192
  v_mfma_f32_32x32x16_bf16 v[16:31], v[236:239], v[44:47], v[16:31]
  s_waitcnt lgkmcnt(2)
  v_mfma_f32_32x32x16_bf16 v[0:15], a[128:131], v[32:35], v[0:15]
  ds_read_b128 v[44:47], v206 offset:8192
  v_mfma_f32_32x32x16_bf16 v[16:31], v[240:243], v[32:35], v[16:31]
  s_waitcnt lgkmcnt(2)
  v_mfma_f32_32x32x16_bf16 v[0:15], a[132:135], v[36:39], v[0:15]
  v_mfma_f32_32x32x16_bf16 v[16:31], v[244:247], v[36:39], v[16:31]
  s_waitcnt lgkmcnt(1)
  v_mfma_f32_32x32x16_bf16 v[0:15], a[136:139], v[40:43], v[0:15]
  v_mfma_f32_32x32x16_bf16 v[16:31], v[248:251], v[40:43], v[16:31]
  s_waitcnt lgkmcnt(0)
  v_mfma_f32_32x32x16_bf16 v[0:15], a[140:143], v[44:47], v[0:15]
  v_mfma_f32_32x32x16_bf16 v[16:31], v[252:255], v[44:47], v[16:31]
  s_add_u32 s60, s60, 36864
  s_nop 2
  v_cvt_pk_bf16_f32 v48, v0, v1
  v_cvt_pk_bf16_f32 v49, v2, v3
  ds_write2_b32 v218, v48, v49 offset0:0 offset1:1
  v_cvt_pk_bf16_f32 v48, v4, v5
  v_cvt_pk_bf16_f32 v49, v6, v7
  ds_write2_b32 v218, v48, v49 offset0:4 offset1:5
  v_cvt_pk_bf16_f32 v48, v8, v9
  v_cvt_pk_bf16_f32 v49, v10, v11
  ds_write2_b32 v218, v48, v49 offset0:8 offset1:9
  v_cvt_pk_bf16_f32 v48, v12, v13
  v_cvt_pk_bf16_f32 v49, v14, v15
  ds_write2_b32 v218, v48, v49 offset0:12 offset1:13
  v_cvt_pk_bf16_f32 v48, v16, v17
  v_cvt_pk_bf16_f32 v49, v18, v19
  ds_write2_b32 v218, v48, v49 offset0:64 offset1:65
  v_cvt_pk_bf16_f32 v48, v20, v21
  v_cvt_pk_bf16_f32 v49, v22, v23
  ds_write2_b32 v218, v48, v49 offset0:68 offset1:69
  v_cvt_pk_bf16_f32 v48, v24, v25
  v_cvt_pk_bf16_f32 v49, v26, v27
  ds_write2_b32 v218, v48, v49 offset0:72 offset1:73
  v_cvt_pk_bf16_f32 v48, v28, v29
  v_cvt_pk_bf16_f32 v49, v30, v31
  ds_write2_b32 v218, v48, v49 offset0:76 offset1:77
  v_add_u32 v218, 16512, v218
  s_waitcnt vmcnt(0) lgkmcnt(0)
  s_barrier
  ds_read_b128 v[32:35], v203 offset:36864
  ds_read_b128 v[36:39], v204 offset:36864
  ds_read_b128 v[40:43], v205 offset:36864
  s_waitcnt lgkmcnt(2)
  v_mfma_f32_32x32x16_bf16 v[0:15], a[0:3], v[32:35], 0
  ds_read_b128 v[44:47], v206 offset:36864
  s_add_u32 m0, s67, 0
  s_nop 0
  buffer_load_dwordx4 v202, s[4:7], s60 offen offset:0 lds
  v_mfma_f32_32x32x16_bf16 v[16:31], a[144:147], v[32:35], 0
  s_waitcnt lgkmcnt(2)
  v_mfma_f32_32x32x16_bf16 v[0:15], a[4:7], v[36:39], v[0:15]
  ds_read_b128 v[32:35], v203 offset:37888
  s_add_u32 m0, s67, 896
  s_nop 0
  buffer_load_dwordx4 v202, s[4:7], s60 offen offset:128 lds
  v_mfma_f32_32x32x16_bf16 v[16:31], a[148:151], v[36:39], v[16:31]
  s_waitcnt lgkmcnt(2)
  v_mfma_f32_32x32x16_bf16 v[0:15], a[8:11], v[40:43], v[0:15]
  ds_read_b128 v[36:39], v204 offset:37888
  s_add_u32 m0, s67, 1792
  s_nop 0
  buffer_load_dwordx4 v202, s[4:7], s60 offen offset:256 lds
  v_mfma_f32_32x32x16_bf16 v[16:31], a[152:155], v[40:43], v[16:31]
  s_waitcnt lgkmcnt(2)
  v_mfma_f32_32x32x16_bf16 v[0:15], a[12:15], v[44:47], v[0:15]
  ds_read_b128 v[40:43], v205 offset:37888
  s_add_u32 m0, s67, 2688
  s_nop 0
  buffer_load_dwordx4 v202, s[4:7], s60 offen offset:384 lds
  v_mfma_f32_32x32x16_bf16 v[16:31], a[156:159], v[44:47], v[16:31]
  s_waitcnt lgkmcnt(2)
  v_mfma_f32_32x32x16_bf16 v[0:15], a[16:19], v[32:35], v[0:15]
  ds_read_b128 v[44:47], v206 offset:37888
  s_add_u32 m0, s67, 3584
  s_nop 0
  buffer_load_dwordx4 v202, s[4:7], s60 offen offset:512 lds
  v_mfma_f32_32x32x16_bf16 v[16:31], a[160:163], v[32:35], v[16:31]
  s_waitcnt lgkmcnt(2)
  v_mfma_f32_32x32x16_bf16 v[0:15], a[20:23], v[36:39], v[0:15]
  ds_read_b128 v[32:35], v203 offset:38912
  s_add_u32 m0, s67, 4480
  s_nop 0
  buffer_load_dwordx4 v202, s[4:7], s60 offen offset:640 lds
  v_mfma_f32_32x32x16_bf16 v[16:31], a[164:167], v[36:39], v[16:31]
  s_waitcnt lgkmcnt(2)
  v_mfma_f32_32x32x16_bf16 v[0:15], a[24:27], v[40:43], v[0:15]
  ds_read_b128 v[36:39], v204 offset:38912
  s_add_u32 m0, s67, 5376
  s_nop 0
  buffer_load_dwordx4 v202, s[4:7], s60 offen offset:768 lds
  v_mfma_f32_32x32x16_bf16 v[16:31], a[168:171], v[40:43], v[16:31]
  s_waitcnt lgkmcnt(2)
  v_mfma_f32_32x32x16_bf16 v[0:15], a[28:31], v[44:47], v[0:15]
  ds_read_b128 v[40:43], v205 offset:38912
  s_add_u32 m0, s67, 6272
  s_nop 0
  buffer_load_dwordx4 v202, s[4:7], s60 offen offset:896 lds
  v_mfma_f32_32x32x16_bf16 v[16:31], a[172:175], v[44:47], v[16:31]
  s_waitcnt lgkmcnt(2)
  v_mfma_f32_32x32x16_bf16 v[0:15], a[32:35], v[32:35], v[0:15]
  ds_read_b128 v[44:47], v206 offset:38912
  s_add_u32 m0, s67, 7168
  s_nop 0
  buffer_load_dwordx4 v202, s[4:7], s60 offen offset:1024 lds
  v_mfma_f32_32x32x16_bf16 v[16:31], a[176:179], v[32:35], v[16:31]
  s_waitcnt lgkmcnt(2)
  v_mfma_f32_32x32x16_bf16 v[0:15], a[36:39], v[36:39], v[0:15]
  ds_read_b128 v[32:35], v203 offset:39936
  v_mfma_f32_32x32x16_bf16 v[16:31], a[180:183], v[36:39], v[16:31]
  s_waitcnt lgkmcnt(2)
  v_mfma_f32_32x32x16_bf16 v[0:15], a[40:43], v[40:43], v[0:15]
  ds_read_b128 v[36:39], v204 offset:39936
  v_mfma_f32_32x32x16_bf16 v[16:31], a[184:187], v[40:43], v[16:31]
  s_waitcnt lgkmcnt(2)
  v_mfma_f32_32x32x16_bf16 v[0:15], a[44:47], v[44:47], v[0:15]
  ds_read_b128 v[40:43], v205 offset:39936
  v_mfma_f32_32x32x16_bf16 v[16:31], a[188:191], v[44:47], v[16:31]
  s_waitcnt lgkmcnt(2)
  v_mfma_f32_32x32x16_bf16 v[0:15], a[48:51], v[32:35], v[0:15]
  ds_read_b128 v[44:47], v206 offset:39936
  v_mfma_f32_32x32x16_bf16 v[16:31], a[192:195], v[32:35], v[16:31]
  s_waitcnt lgkmcnt(2)
  v_mfma_f32_32x32x16_bf16 v[0:15], a[52:55], v[36:39], v[0:15]
  ds_read_b128 v[32:35], v203 offset:40960
  v_mfma_f32_32x32x16_bf16 v[16:31], a[196:199], v[36:39], v[16:31]
  s_waitcnt lgkmcnt(2)
  v_mfma_f32_32x32x16_bf16 v[0:15], a[56:59], v[40:43], v[0:15]
  ds_read_b128 v[36:39], v204 offset:40960
  v_mfma_f32_32x32x16_bf16 v[16:31], a[200:203], v[40:43], v[16:31]
  s_waitcnt lgkmcnt(2)
  v_mfma_f32_32x32x16_bf16 v[0:15], a[60:63], v[44:47], v[0:15]
  ds_read_b128 v[40:43], v205 offset:40960
  v_mfma_f32_32x32x16_bf16 v[16:31], a[204:207], v[44:47], v[16:31]
  s_waitcnt lgkmcnt(2)
  v_mfma_f32_32x32x16_bf16 v[0:15], a[64:67], v[32:35], v[0:15]
  ds_read_b128 v[44:47], v206 offset:40960
  v_mfma_f32_32x32x16_bf16 v[16:31], a[208:211], v[32:35], v[16:31]
  s_waitcnt lgkmcnt(2)
  v_mfma_f32_32x32x16_bf16 v[0:15], a[68:71], v[36:39], v[0:15]
  ds_read_b128 v[32:35], v203 offset:41984
  v_mfma_f32_32x32x16_bf16 v[16:31], a[212:215], v[36:39], v[16:31]
  s_waitcnt lgkmcnt(2)
  v_mfma_f32_32x32x16_bf16 v[0:15], a[72:75], v[40:43], v[0:15]
  ds_read_b128 v[36:39], v204 offset:41984
  v_mfma_f32_32x32x16_bf16 v[16:31], a[216:219], v[40:43], v[16:31]
  s_waitcnt lgkmcnt(2)
  v_mfma_f32_32x32x16_bf16 v[0:15], a[76:79], v[44:47], v[0:15]
  ds_read_b128 v[40:43], v205 offset:41984
  v_mfma_f32_32x32x16_bf16 v[16:31], a[220:223], v[44:47], v[16:31]
  s_waitcnt lgkmcnt(2)
  v_mfma_f32_32x32x16_bf16 v[0:15], a[80:83], v[32:35], v[0:15]
  ds_read_b128 v[44:47], v206 offset:41984
  v_mfma_f32_32x32x16_bf16 v[16:31], a[224:227], v[32:35], v[16:31]
  s_waitcnt lgkmcnt(2)
  v_mfma_f32_32x32x16_bf16 v[0:15], a[84:87], v[36:39], v[0:15]
  ds_read_b128 v[32:35], v203 offset:43008
  v_mfma_f32_32x32x16_bf16 v[16:31], a[228:231], v[36:39], v[16:31]
  s_waitcnt lgkmcnt(2)
  v_mfma_f32_32x32x16_bf16 v[0:15], a[88:91], v[40:43], v[0:15]
  ds_read_b128 v[36:39], v204 offset:43008
  v_mfma_f32_32x32x16_bf16 v[16:31], a[232:235], v[40:43], v[16:31]
  s_waitcnt lgkmcnt(2)
  v_mfma_f32_32x32x16_bf16 v[0:15], a[92:95], v[44:47], v[0:15]
  ds_read_b128 v[40:43], v205 offset:43008
  v_mfma_f32_32x32x16_bf16 v[16:31], a[236:239], v[44:47], v[16:31]
  s_waitcnt lgkmcnt(2)
  v_mfma_f32_32x32x16_bf16 v[0:15], a[96:99], v[32:35], v[0:15]
  ds_read_b128 v[44:47], v206 offset:43008
  v_mfma_f32_32x32x16_bf16 v[16:31], a[240:243], v[32:35], v[16:31]
  s_waitcnt lgkmcnt(2)
  v_mfma_f32_32x32x16_bf16 v[0:15], a[100:103], v[36:39], v[0:15]
  ds_read_b128 v[32:35], v203 offset:44032
  v_mfma_f32_32x32x16_bf16 v[16:31], a[244:247], v[36:39], v[16:31]
  s_waitcnt lgkmcnt(2)
  v_mfma_f32_32x32x16_bf16 v[0:15], a[104:107], v[40:43], v[0:15]
  ds_read_b128 v[36:39], v204 offset:44032
  v_mfma_f32_32x32x16_bf16 v[16:31], a[248:251], v[40:43], v[16:31]
  s_waitcnt lgkmcnt(2)
  v_mfma_f32_32x32x16_bf16 v[0:15], a[108:111], v[44:47], v[0:15]
  ds_read_b128 v[40:43], v205 offset:44032
  v_mfma_f32_32x32x16_bf16 v[16:31], a[252:255], v[44:47], v[16:31]
  s_waitcnt lgkmcnt(2)
  v_mfma_f32_32x32x16_bf16 v[0:15], a[112:115], v[32:35], v[0:15]
  ds_read_b128 v[44:47], v206 offset:44032
  v_mfma_f32_32x32x16_bf16 v[16:31], v[224:227], v[32:35], v[16:31]
  s_waitcnt lgkmcnt(2)
  v_mfma_f32_32x32x16_bf16 v[0:15], a[116:119], v[36:39], v[0:15]
  ds_read_b128 v[32:35], v203 offset:45056
  v_mfma_f32_32x32x16_bf16 v[16:31], v[228:231], v[36:39], v[16:31]
  s_waitcnt lgkmcnt(2)
  v_mfma_f32_32x32x16_bf16 v[0:15], a[120:123], v[40:43], v[0:15]
  ds_read_b128 v[36:39], v204 offset:45056
  v_mfma_f32_32x32x16_bf16 v[16:31], v[232:235], v[40:43], v[16:31]
  s_waitcnt lgkmcnt(2)
  v_mfma_f32_32x32x16_bf16 v[0:15], a[124:127], v[44:47], v[0:15]
  ds_read_b128 v[40:43], v205 offset:45056
  v_mfma_f32_32x32x16_bf16 v[16:31], v[236:239], v[44:47], v[16:31]
  s_waitcnt lgkmcnt(2)
  v_mfma_f32_32x32x16_bf16 v[0:15], a[128:131], v[32:35], v[0:15]
  ds_read_b128 v[44:47], v206 offset:45056
  v_mfma_f32_32x32x16_bf16 v[16:31], v[240:243], v[32:35], v[16:31]
  s_waitcnt lgkmcnt(2)
  v_mfma_f32_32x32x16_bf16 v[0:15], a[132:135], v[36:39], v[0:15]
  v_mfma_f32_32x32x16_bf16 v[16:31], v[244:247], v[36:39], v[16:31]
  s_waitcnt lgkmcnt(1)
  v_mfma_f32_32x32x16_bf16 v[0:15], a[136:139], v[40:43], v[0:15]
  v_mfma_f32_32x32x16_bf16 v[16:31], v[248:251], v[40:43], v[16:31]
  s_waitcnt lgkmcnt(0)
  v_mfma_f32_32x32x16_bf16 v[0:15], a[140:143], v[44:47], v[0:15]
  v_mfma_f32_32x32x16_bf16 v[16:31], v[252:255], v[44:47], v[16:31]
  s_add_u32 s60, s60, 36864
  s_nop 2
  v_cvt_pk_bf16_f32 v48, v0, v1
  v_cvt_pk_bf16_f32 v49, v2, v3
  ds_write2_b32 v218, v48, v49 offset0:0 offset1:1
  v_cvt_pk_bf16_f32 v48, v4, v5
  v_cvt_pk_bf16_f32 v49, v6, v7
  ds_write2_b32 v218, v48, v49 offset0:4 offset1:5
  v_cvt_pk_bf16_f32 v48, v8, v9
  v_cvt_pk_bf16_f32 v49, v10, v11
  ds_write2_b32 v218, v48, v49 offset0:8 offset1:9
  v_cvt_pk_bf16_f32 v48, v12, v13
  v_cvt_pk_bf16_f32 v49, v14, v15
  ds_write2_b32 v218, v48, v49 offset0:12 offset1:13
  v_cvt_pk_bf16_f32 v48, v16, v17
  v_cvt_pk_bf16_f32 v49, v18, v19
  ds_write2_b32 v218, v48, v49 offset0:64 offset1:65
  v_cvt_pk_bf16_f32 v48, v20, v21
  v_cvt_pk_bf16_f32 v49, v22, v23
  ds_write2_b32 v218, v48, v49 offset0:68 offset1:69
  v_cvt_pk_bf16_f32 v48, v24, v25
  v_cvt_pk_bf16_f32 v49, v26, v27
  ds_write2_b32 v218, v48, v49 offset0:72 offset1:73
  v_cvt_pk_bf16_f32 v48, v28, v29
  v_cvt_pk_bf16_f32 v49, v30, v31
  ds_write2_b32 v218, v48, v49 offset0:76 offset1:77
  v_add_u32 v218, 16512, v218
  s_waitcnt vmcnt(0) lgkmcnt(0)
  s_barrier
  ds_read_b128 v[32:35], v203 offset:0
  ds_read_b128 v[36:39], v204 offset:0
  ds_read_b128 v[40:43], v205 offset:0
  s_waitcnt lgkmcnt(2)
  v_mfma_f32_32x32x16_bf16 v[0:15], a[0:3], v[32:35], 0
  ds_read_b128 v[44:47], v206 offset:0
  s_add_u32 m0, s67, 36864
  s_nop 0
  buffer_load_dwordx4 v202, s[4:7], s60 offen offset:0 lds
  v_mfma_f32_32x32x16_bf16 v[16:31], a[144:147], v[32:35], 0
  s_waitcnt lgkmcnt(2)
  v_mfma_f32_32x32x16_bf16 v[0:15], a[4:7], v[36:39], v[0:15]
  ds_read_b128 v[32:35], v203 offset:1024
  s_add_u32 m0, s67, 37760
  s_nop 0
  buffer_load_dwordx4 v202, s[4:7], s60 offen offset:128 lds
  v_mfma_f32_32x32x16_bf16 v[16:31], a[148:151], v[36:39], v[16:31]
  s_waitcnt lgkmcnt(2)
  v_mfma_f32_32x32x16_bf16 v[0:15], a[8:11], v[40:43], v[0:15]
  ds_read_b128 v[36:39], v204 offset:1024
  s_add_u32 m0, s67, 38656
  s_nop 0
  buffer_load_dwordx4 v202, s[4:7], s60 offen offset:256 lds
  v_mfma_f32_32x32x16_bf16 v[16:31], a[152:155], v[40:43], v[16:31]
  s_waitcnt lgkmcnt(2)
  v_mfma_f32_32x32x16_bf16 v[0:15], a[12:15], v[44:47], v[0:15]
  ds_read_b128 v[40:43], v205 offset:1024
  s_add_u32 m0, s67, 39552
  s_nop 0
  buffer_load_dwordx4 v202, s[4:7], s60 offen offset:384 lds
  v_mfma_f32_32x32x16_bf16 v[16:31], a[156:159], v[44:47], v[16:31]
  s_waitcnt lgkmcnt(2)
  v_mfma_f32_32x32x16_bf16 v[0:15], a[16:19], v[32:35], v[0:15]
  ds_read_b128 v[44:47], v206 offset:1024
  s_add_u32 m0, s67, 40448
  s_nop 0
  buffer_load_dwordx4 v202, s[4:7], s60 offen offset:512 lds
  v_mfma_f32_32x32x16_bf16 v[16:31], a[160:163], v[32:35], v[16:31]
  s_waitcnt lgkmcnt(2)
  v_mfma_f32_32x32x16_bf16 v[0:15], a[20:23], v[36:39], v[0:15]
  ds_read_b128 v[32:35], v203 offset:2048
  s_add_u32 m0, s67, 41344
  s_nop 0
  buffer_load_dwordx4 v202, s[4:7], s60 offen offset:640 lds
  v_mfma_f32_32x32x16_bf16 v[16:31], a[164:167], v[36:39], v[16:31]
  s_waitcnt lgkmcnt(2)
  v_mfma_f32_32x32x16_bf16 v[0:15], a[24:27], v[40:43], v[0:15]
  ds_read_b128 v[36:39], v204 offset:2048
  s_add_u32 m0, s67, 42240
  s_nop 0
  buffer_load_dwordx4 v202, s[4:7], s60 offen offset:768 lds
  v_mfma_f32_32x32x16_bf16 v[16:31], a[168:171], v[40:43], v[16:31]
  s_waitcnt lgkmcnt(2)
  v_mfma_f32_32x32x16_bf16 v[0:15], a[28:31], v[44:47], v[0:15]
  ds_read_b128 v[40:43], v205 offset:2048
  s_add_u32 m0, s67, 43136
  s_nop 0
  buffer_load_dwordx4 v202, s[4:7], s60 offen offset:896 lds
  v_mfma_f32_32x32x16_bf16 v[16:31], a[172:175], v[44:47], v[16:31]
  s_waitcnt lgkmcnt(2)
  v_mfma_f32_32x32x16_bf16 v[0:15], a[32:35], v[32:35], v[0:15]
  ds_read_b128 v[44:47], v206 offset:2048
  s_add_u32 m0, s67, 44032
  s_nop 0
  buffer_load_dwordx4 v202, s[4:7], s60 offen offset:1024 lds
  v_mfma_f32_32x32x16_bf16 v[16:31], a[176:179], v[32:35], v[16:31]
  s_waitcnt lgkmcnt(2)
  v_mfma_f32_32x32x16_bf16 v[0:15], a[36:39], v[36:39], v[0:15]
  ds_read_b128 v[32:35], v203 offset:3072
  v_mfma_f32_32x32x16_bf16 v[16:31], a[180:183], v[36:39], v[16:31]
  s_waitcnt lgkmcnt(2)
  v_mfma_f32_32x32x16_bf16 v[0:15], a[40:43], v[40:43], v[0:15]
  ds_read_b128 v[36:39], v204 offset:3072
  v_mfma_f32_32x32x16_bf16 v[16:31], a[184:187], v[40:43], v[16:31]
  s_waitcnt lgkmcnt(2)
  v_mfma_f32_32x32x16_bf16 v[0:15], a[44:47], v[44:47], v[0:15]
  ds_read_b128 v[40:43], v205 offset:3072
  v_mfma_f32_32x32x16_bf16 v[16:31], a[188:191], v[44:47], v[16:31]
  s_waitcnt lgkmcnt(2)
  v_mfma_f32_32x32x16_bf16 v[0:15], a[48:51], v[32:35], v[0:15]
  ds_read_b128 v[44:47], v206 offset:3072
  v_mfma_f32_32x32x16_bf16 v[16:31], a[192:195], v[32:35], v[16:31]
  s_waitcnt lgkmcnt(2)
  v_mfma_f32_32x32x16_bf16 v[0:15], a[52:55], v[36:39], v[0:15]
  ds_read_b128 v[32:35], v203 offset:4096
  v_mfma_f32_32x32x16_bf16 v[16:31], a[196:199], v[36:39], v[16:31]
  s_waitcnt lgkmcnt(2)
  v_mfma_f32_32x32x16_bf16 v[0:15], a[56:59], v[40:43], v[0:15]
  ds_read_b128 v[36:39], v204 offset:4096
  v_mfma_f32_32x32x16_bf16 v[16:31], a[200:203], v[40:43], v[16:31]
  s_waitcnt lgkmcnt(2)
  v_mfma_f32_32x32x16_bf16 v[0:15], a[60:63], v[44:47], v[0:15]
  ds_read_b128 v[40:43], v205 offset:4096
  v_mfma_f32_32x32x16_bf16 v[16:31], a[204:207], v[44:47], v[16:31]
  s_waitcnt lgkmcnt(2)
  v_mfma_f32_32x32x16_bf16 v[0:15], a[64:67], v[32:35], v[0:15]
  ds_read_b128 v[44:47], v206 offset:4096
  v_mfma_f32_32x32x16_bf16 v[16:31], a[208:211], v[32:35], v[16:31]
  s_waitcnt lgkmcnt(2)
  v_mfma_f32_32x32x16_bf16 v[0:15], a[68:71], v[36:39], v[0:15]
  ds_read_b128 v[32:35], v203 offset:5120
  v_mfma_f32_32x32x16_bf16 v[16:31], a[212:215], v[36:39], v[16:31]
  s_waitcnt lgkmcnt(2)
  v_mfma_f32_32x32x16_bf16 v[0:15], a[72:75], v[40:43], v[0:15]
  ds_read_b128 v[36:39], v204 offset:5120
  v_mfma_f32_32x32x16_bf16 v[16:31], a[216:219], v[40:43], v[16:31]
  s_waitcnt lgkmcnt(2)
  v_mfma_f32_32x32x16_bf16 v[0:15], a[76:79], v[44:47], v[0:15]
  ds_read_b128 v[40:43], v205 offset:5120
  v_mfma_f32_32x32x16_bf16 v[16:31], a[220:223], v[44:47], v[16:31]
  s_waitcnt lgkmcnt(2)
  v_mfma_f32_32x32x16_bf16 v[0:15], a[80:83], v[32:35], v[0:15]
  ds_read_b128 v[44:47], v206 offset:5120
  v_mfma_f32_32x32x16_bf16 v[16:31], a[224:227], v[32:35], v[16:31]
  s_waitcnt lgkmcnt(2)
  v_mfma_f32_32x32x16_bf16 v[0:15], a[84:87], v[36:39], v[0:15]
  ds_read_b128 v[32:35], v203 offset:6144
  v_mfma_f32_32x32x16_bf16 v[16:31], a[228:231], v[36:39], v[16:31]
  s_waitcnt lgkmcnt(2)
  v_mfma_f32_32x32x16_bf16 v[0:15], a[88:91], v[40:43], v[0:15]
  ds_read_b128 v[36:39], v204 offset:6144
  v_mfma_f32_32x32x16_bf16 v[16:31], a[232:235], v[40:43], v[16:31]
  s_waitcnt lgkmcnt(2)
  v_mfma_f32_32x32x16_bf16 v[0:15], a[92:95], v[44:47], v[0:15]
  ds_read_b128 v[40:43], v205 offset:6144
  v_mfma_f32_32x32x16_bf16 v[16:31], a[236:239], v[44:47], v[16:31]
  s_waitcnt lgkmcnt(2)
  v_mfma_f32_32x32x16_bf16 v[0:15], a[96:99], v[32:35], v[0:15]
  ds_read_b128 v[44:47], v206 offset:6144
  v_mfma_f32_32x32x16_bf16 v[16:31], a[240:243], v[32:35], v[16:31]
  s_waitcnt lgkmcnt(2)
  v_mfma_f32_32x32x16_bf16 v[0:15], a[100:103], v[36:39], v[0:15]
  ds_read_b128 v[32:35], v203 offset:7168
  v_mfma_f32_32x32x16_bf16 v[16:31], a[244:247], v[36:39], v[16:31]
  s_waitcnt lgkmcnt(2)
  v_mfma_f32_32x32x16_bf16 v[0:15], a[104:107], v[40:43], v[0:15]
  ds_read_b128 v[36:39], v204 offset:7168
  v_mfma_f32_32x32x16_bf16 v[16:31], a[248:251], v[40:43], v[16:31]
  s_waitcnt lgkmcnt(2)
  v_mfma_f32_32x32x16_bf16 v[0:15], a[108:111], v[44:47], v[0:15]
  ds_read_b128 v[40:43], v205 offset:7168
  v_mfma_f32_32x32x16_bf16 v[16:31], a[252:255], v[44:47], v[16:31]
  s_waitcnt lgkmcnt(2)
  v_mfma_f32_32x32x16_bf16 v[0:15], a[112:115], v[32:35], v[0:15]
  ds_read_b128 v[44:47], v206 offset:7168
  v_mfma_f32_32x32x16_bf16 v[16:31], v[224:227], v[32:35], v[16:31]
  s_waitcnt lgkmcnt(2)
  v_mfma_f32_32x32x16_bf16 v[0:15], a[116:119], v[36:39], v[0:15]
  ds_read_b128 v[32:35], v203 offset:8192
  v_mfma_f32_32x32x16_bf16 v[16:31], v[228:231], v[36:39], v[16:31]
  s_waitcnt lgkmcnt(2)
  v_mfma_f32_32x32x16_bf16 v[0:15], a[120:123], v[40:43], v[0:15]
  ds_read_b128 v[36:39], v204 offset:8192
  v_mfma_f32_32x32x16_bf16 v[16:31], v[232:235], v[40:43], v[16:31]
  s_waitcnt lgkmcnt(2)
  v_mfma_f32_32x32x16_bf16 v[0:15], a[124:127], v[44:47], v[0:15]
  ds_read_b128 v[40:43], v205 offset:8192
  v_mfma_f32_32x32x16_bf16 v[16:31], v[236:239], v[44:47], v[16:31]
  s_waitcnt lgkmcnt(2)
  v_mfma_f32_32x32x16_bf16 v[0:15], a[128:131], v[32:35], v[0:15]
  ds_read_b128 v[44:47], v206 offset:8192
  v_mfma_f32_32x32x16_bf16 v[16:31], v[240:243], v[32:35], v[16:31]
  s_waitcnt lgkmcnt(2)
  v_mfma_f32_32x32x16_bf16 v[0:15], a[132:135], v[36:39], v[0:15]
  v_mfma_f32_32x32x16_bf16 v[16:31], v[244:247], v[36:39], v[16:31]
  s_waitcnt lgkmcnt(1)
  v_mfma_f32_32x32x16_bf16 v[0:15], a[136:139], v[40:43], v[0:15]
  v_mfma_f32_32x32x16_bf16 v[16:31], v[248:251], v[40:43], v[16:31]
  s_waitcnt lgkmcnt(0)
  v_mfma_f32_32x32x16_bf16 v[0:15], a[140:143], v[44:47], v[0:15]
  v_mfma_f32_32x32x16_bf16 v[16:31], v[252:255], v[44:47], v[16:31]
  s_add_u32 s60, s60, 36864
  s_nop 2
  v_cvt_pk_bf16_f32 v48, v0, v1
  v_cvt_pk_bf16_f32 v49, v2, v3
  ds_write2_b32 v218, v48, v49 offset0:0 offset1:1
  v_cvt_pk_bf16_f32 v48, v4, v5
  v_cvt_pk_bf16_f32 v49, v6, v7
  ds_write2_b32 v218, v48, v49 offset0:4 offset1:5
  v_cvt_pk_bf16_f32 v48, v8, v9
  v_cvt_pk_bf16_f32 v49, v10, v11
  ds_write2_b32 v218, v48, v49 offset0:8 offset1:9
  v_cvt_pk_bf16_f32 v48, v12, v13
  v_cvt_pk_bf16_f32 v49, v14, v15
  ds_write2_b32 v218, v48, v49 offset0:12 offset1:13
  v_cvt_pk_bf16_f32 v48, v16, v17
  v_cvt_pk_bf16_f32 v49, v18, v19
  ds_write2_b32 v218, v48, v49 offset0:64 offset1:65
  v_cvt_pk_bf16_f32 v48, v20, v21
  v_cvt_pk_bf16_f32 v49, v22, v23
  ds_write2_b32 v218, v48, v49 offset0:68 offset1:69
  v_cvt_pk_bf16_f32 v48, v24, v25
  v_cvt_pk_bf16_f32 v49, v26, v27
  ds_write2_b32 v218, v48, v49 offset0:72 offset1:73
  v_cvt_pk_bf16_f32 v48, v28, v29
  v_cvt_pk_bf16_f32 v49, v30, v31
  ds_write2_b32 v218, v48, v49 offset0:76 offset1:77
  v_add_u32 v218, 16512, v218
  s_waitcnt vmcnt(0) lgkmcnt(0)
  s_barrier
  ds_read_b128 v[32:35], v203 offset:36864
  ds_read_b128 v[36:39], v204 offset:36864
  ds_read_b128 v[40:43], v205 offset:36864
  s_waitcnt lgkmcnt(2)
  v_mfma_f32_32x32x16_bf16 v[0:15], a[0:3], v[32:35], 0
  ds_read_b128 v[44:47], v206 offset:36864
  s_add_u32 m0, s67, 0
  s_nop 0
  buffer_load_dwordx4 v202, s[4:7], s60 offen offset:0 lds
  v_mfma_f32_32x32x16_bf16 v[16:31], a[144:147], v[32:35], 0
  s_waitcnt lgkmcnt(2)
  v_mfma_f32_32x32x16_bf16 v[0:15], a[4:7], v[36:39], v[0:15]
  ds_read_b128 v[32:35], v203 offset:37888
  s_add_u32 m0, s67, 896
  s_nop 0
  buffer_load_dwordx4 v202, s[4:7], s60 offen offset:128 lds
  v_mfma_f32_32x32x16_bf16 v[16:31], a[148:151], v[36:39], v[16:31]
  s_waitcnt lgkmcnt(2)
  v_mfma_f32_32x32x16_bf16 v[0:15], a[8:11], v[40:43], v[0:15]
  ds_read_b128 v[36:39], v204 offset:37888
  s_add_u32 m0, s67, 1792
  s_nop 0
  buffer_load_dwordx4 v202, s[4:7], s60 offen offset:256 lds
  v_mfma_f32_32x32x16_bf16 v[16:31], a[152:155], v[40:43], v[16:31]
  s_waitcnt lgkmcnt(2)
  v_mfma_f32_32x32x16_bf16 v[0:15], a[12:15], v[44:47], v[0:15]
  ds_read_b128 v[40:43], v205 offset:37888
  s_add_u32 m0, s67, 2688
  s_nop 0
  buffer_load_dwordx4 v202, s[4:7], s60 offen offset:384 lds
  v_mfma_f32_32x32x16_bf16 v[16:31], a[156:159], v[44:47], v[16:31]
  s_waitcnt lgkmcnt(2)
  v_mfma_f32_32x32x16_bf16 v[0:15], a[16:19], v[32:35], v[0:15]
  ds_read_b128 v[44:47], v206 offset:37888
  s_add_u32 m0, s67, 3584
  s_nop 0
  buffer_load_dwordx4 v202, s[4:7], s60 offen offset:512 lds
  v_mfma_f32_32x32x16_bf16 v[16:31], a[160:163], v[32:35], v[16:31]
  s_waitcnt lgkmcnt(2)
  v_mfma_f32_32x32x16_bf16 v[0:15], a[20:23], v[36:39], v[0:15]
  ds_read_b128 v[32:35], v203 offset:38912
  s_add_u32 m0, s67, 4480
  s_nop 0
  buffer_load_dwordx4 v202, s[4:7], s60 offen offset:640 lds
  v_mfma_f32_32x32x16_bf16 v[16:31], a[164:167], v[36:39], v[16:31]
  s_waitcnt lgkmcnt(2)
  v_mfma_f32_32x32x16_bf16 v[0:15], a[24:27], v[40:43], v[0:15]
  ds_read_b128 v[36:39], v204 offset:38912
  s_add_u32 m0, s67, 5376
  s_nop 0
  buffer_load_dwordx4 v202, s[4:7], s60 offen offset:768 lds
  v_mfma_f32_32x32x16_bf16 v[16:31], a[168:171], v[40:43], v[16:31]
  s_waitcnt lgkmcnt(2)
  v_mfma_f32_32x32x16_bf16 v[0:15], a[28:31], v[44:47], v[0:15]
  ds_read_b128 v[40:43], v205 offset:38912
  s_add_u32 m0, s67, 6272
  s_nop 0
  buffer_load_dwordx4 v202, s[4:7], s60 offen offset:896 lds
  v_mfma_f32_32x32x16_bf16 v[16:31], a[172:175], v[44:47], v[16:31]
  s_waitcnt lgkmcnt(2)
  v_mfma_f32_32x32x16_bf16 v[0:15], a[32:35], v[32:35], v[0:15]
  ds_read_b128 v[44:47], v206 offset:38912
  s_add_u32 m0, s67, 7168
  s_nop 0
  buffer_load_dwordx4 v202, s[4:7], s60 offen offset:1024 lds
  v_mfma_f32_32x32x16_bf16 v[16:31], a[176:179], v[32:35], v[16:31]
  s_waitcnt lgkmcnt(2)
  v_mfma_f32_32x32x16_bf16 v[0:15], a[36:39], v[36:39], v[0:15]
  ds_read_b128 v[32:35], v203 offset:39936
  v_mfma_f32_32x32x16_bf16 v[16:31], a[180:183], v[36:39], v[16:31]
  s_waitcnt lgkmcnt(2)
  v_mfma_f32_32x32x16_bf16 v[0:15], a[40:43], v[40:43], v[0:15]
  ds_read_b128 v[36:39], v204 offset:39936
  v_mfma_f32_32x32x16_bf16 v[16:31], a[184:187], v[40:43], v[16:31]
  s_waitcnt lgkmcnt(2)
  v_mfma_f32_32x32x16_bf16 v[0:15], a[44:47], v[44:47], v[0:15]
  ds_read_b128 v[40:43], v205 offset:39936
  v_mfma_f32_32x32x16_bf16 v[16:31], a[188:191], v[44:47], v[16:31]
  s_waitcnt lgkmcnt(2)
  v_mfma_f32_32x32x16_bf16 v[0:15], a[48:51], v[32:35], v[0:15]
  ds_read_b128 v[44:47], v206 offset:39936
  v_mfma_f32_32x32x16_bf16 v[16:31], a[192:195], v[32:35], v[16:31]
  s_waitcnt lgkmcnt(2)
  v_mfma_f32_32x32x16_bf16 v[0:15], a[52:55], v[36:39], v[0:15]
  ds_read_b128 v[32:35], v203 offset:40960
  v_mfma_f32_32x32x16_bf16 v[16:31], a[196:199], v[36:39], v[16:31]
  s_waitcnt lgkmcnt(2)
  v_mfma_f32_32x32x16_bf16 v[0:15], a[56:59], v[40:43], v[0:15]
  ds_read_b128 v[36:39], v204 offset:40960
  v_mfma_f32_32x32x16_bf16 v[16:31], a[200:203], v[40:43], v[16:31]
  s_waitcnt lgkmcnt(2)
  v_mfma_f32_32x32x16_bf16 v[0:15], a[60:63], v[44:47], v[0:15]
  ds_read_b128 v[40:43], v205 offset:40960
  v_mfma_f32_32x32x16_bf16 v[16:31], a[204:207], v[44:47], v[16:31]
  s_waitcnt lgkmcnt(2)
  v_mfma_f32_32x32x16_bf16 v[0:15], a[64:67], v[32:35], v[0:15]
  ds_read_b128 v[44:47], v206 offset:40960
  v_mfma_f32_32x32x16_bf16 v[16:31], a[208:211], v[32:35], v[16:31]
  s_waitcnt lgkmcnt(2)
  v_mfma_f32_32x32x16_bf16 v[0:15], a[68:71], v[36:39], v[0:15]
  ds_read_b128 v[32:35], v203 offset:41984
  v_mfma_f32_32x32x16_bf16 v[16:31], a[212:215], v[36:39], v[16:31]
  s_waitcnt lgkmcnt(2)
  v_mfma_f32_32x32x16_bf16 v[0:15], a[72:75], v[40:43], v[0:15]
  ds_read_b128 v[36:39], v204 offset:41984
  v_mfma_f32_32x32x16_bf16 v[16:31], a[216:219], v[40:43], v[16:31]
  s_waitcnt lgkmcnt(2)
  v_mfma_f32_32x32x16_bf16 v[0:15], a[76:79], v[44:47], v[0:15]
  ds_read_b128 v[40:43], v205 offset:41984
  v_mfma_f32_32x32x16_bf16 v[16:31], a[220:223], v[44:47], v[16:31]
  s_waitcnt lgkmcnt(2)
  v_mfma_f32_32x32x16_bf16 v[0:15], a[80:83], v[32:35], v[0:15]
  ds_read_b128 v[44:47], v206 offset:41984
  v_mfma_f32_32x32x16_bf16 v[16:31], a[224:227], v[32:35], v[16:31]
  s_waitcnt lgkmcnt(2)
  v_mfma_f32_32x32x16_bf16 v[0:15], a[84:87], v[36:39], v[0:15]
  ds_read_b128 v[32:35], v203 offset:43008
  v_mfma_f32_32x32x16_bf16 v[16:31], a[228:231], v[36:39], v[16:31]
  s_waitcnt lgkmcnt(2)
  v_mfma_f32_32x32x16_bf16 v[0:15], a[88:91], v[40:43], v[0:15]
  ds_read_b128 v[36:39], v204 offset:43008
  v_mfma_f32_32x32x16_bf16 v[16:31], a[232:235], v[40:43], v[16:31]
  s_waitcnt lgkmcnt(2)
  v_mfma_f32_32x32x16_bf16 v[0:15], a[92:95], v[44:47], v[0:15]
  ds_read_b128 v[40:43], v205 offset:43008
  v_mfma_f32_32x32x16_bf16 v[16:31], a[236:239], v[44:47], v[16:31]
  s_waitcnt lgkmcnt(2)
  v_mfma_f32_32x32x16_bf16 v[0:15], a[96:99], v[32:35], v[0:15]
  ds_read_b128 v[44:47], v206 offset:43008
  v_mfma_f32_32x32x16_bf16 v[16:31], a[240:243], v[32:35], v[16:31]
  s_waitcnt lgkmcnt(2)
  v_mfma_f32_32x32x16_bf16 v[0:15], a[100:103], v[36:39], v[0:15]
  ds_read_b128 v[32:35], v203 offset:44032
  v_mfma_f32_32x32x16_bf16 v[16:31], a[244:247], v[36:39], v[16:31]
  s_waitcnt lgkmcnt(2)
  v_mfma_f32_32x32x16_bf16 v[0:15], a[104:107], v[40:43], v[0:15]
  ds_read_b128 v[36:39], v204 offset:44032
  v_mfma_f32_32x32x16_bf16 v[16:31], a[248:251], v[40:43], v[16:31]
  s_waitcnt lgkmcnt(2)
  v_mfma_f32_32x32x16_bf16 v[0:15], a[108:111], v[44:47], v[0:15]
  ds_read_b128 v[40:43], v205 offset:44032
  v_mfma_f32_32x32x16_bf16 v[16:31], a[252:255], v[44:47], v[16:31]
  s_waitcnt lgkmcnt(2)
  v_mfma_f32_32x32x16_bf16 v[0:15], a[112:115], v[32:35], v[0:15]
  ds_read_b128 v[44:47], v206 offset:44032
  v_mfma_f32_32x32x16_bf16 v[16:31], v[224:227], v[32:35], v[16:31]
  s_waitcnt lgkmcnt(2)
  v_mfma_f32_32x32x16_bf16 v[0:15], a[116:119], v[36:39], v[0:15]
  ds_read_b128 v[32:35], v203 offset:45056
  v_mfma_f32_32x32x16_bf16 v[16:31], v[228:231], v[36:39], v[16:31]
  s_waitcnt lgkmcnt(2)
  v_mfma_f32_32x32x16_bf16 v[0:15], a[120:123], v[40:43], v[0:15]
  ds_read_b128 v[36:39], v204 offset:45056
  v_mfma_f32_32x32x16_bf16 v[16:31], v[232:235], v[40:43], v[16:31]
  s_waitcnt lgkmcnt(2)
  v_mfma_f32_32x32x16_bf16 v[0:15], a[124:127], v[44:47], v[0:15]
  ds_read_b128 v[40:43], v205 offset:45056
  v_mfma_f32_32x32x16_bf16 v[16:31], v[236:239], v[44:47], v[16:31]
  s_waitcnt lgkmcnt(2)
  v_mfma_f32_32x32x16_bf16 v[0:15], a[128:131], v[32:35], v[0:15]
  ds_read_b128 v[44:47], v206 offset:45056
  v_mfma_f32_32x32x16_bf16 v[16:31], v[240:243], v[32:35], v[16:31]
  s_waitcnt lgkmcnt(2)
  v_mfma_f32_32x32x16_bf16 v[0:15], a[132:135], v[36:39], v[0:15]
  v_mfma_f32_32x32x16_bf16 v[16:31], v[244:247], v[36:39], v[16:31]
  s_waitcnt lgkmcnt(1)
  v_mfma_f32_32x32x16_bf16 v[0:15], a[136:139], v[40:43], v[0:15]
  v_mfma_f32_32x32x16_bf16 v[16:31], v[248:251], v[40:43], v[16:31]
  s_waitcnt lgkmcnt(0)
  v_mfma_f32_32x32x16_bf16 v[0:15], a[140:143], v[44:47], v[0:15]
  v_mfma_f32_32x32x16_bf16 v[16:31], v[252:255], v[44:47], v[16:31]
  s_add_u32 s60, s60, 36864
  s_nop 2
  v_cvt_pk_bf16_f32 v48, v0, v1
  v_cvt_pk_bf16_f32 v49, v2, v3
  ds_write2_b32 v218, v48, v49 offset0:0 offset1:1
  v_cvt_pk_bf16_f32 v48, v4, v5
  v_cvt_pk_bf16_f32 v49, v6, v7
  ds_write2_b32 v218, v48, v49 offset0:4 offset1:5
  v_cvt_pk_bf16_f32 v48, v8, v9
  v_cvt_pk_bf16_f32 v49, v10, v11
  ds_write2_b32 v218, v48, v49 offset0:8 offset1:9
  v_cvt_pk_bf16_f32 v48, v12, v13
  v_cvt_pk_bf16_f32 v49, v14, v15
  ds_write2_b32 v218, v48, v49 offset0:12 offset1:13
  v_cvt_pk_bf16_f32 v48, v16, v17
  v_cvt_pk_bf16_f32 v49, v18, v19
  ds_write2_b32 v218, v48, v49 offset0:64 offset1:65
  v_cvt_pk_bf16_f32 v48, v20, v21
  v_cvt_pk_bf16_f32 v49, v22, v23
  ds_write2_b32 v218, v48, v49 offset0:68 offset1:69
  v_cvt_pk_bf16_f32 v48, v24, v25
  v_cvt_pk_bf16_f32 v49, v26, v27
  ds_write2_b32 v218, v48, v49 offset0:72 offset1:73
  v_cvt_pk_bf16_f32 v48, v28, v29
  v_cvt_pk_bf16_f32 v49, v30, v31
  ds_write2_b32 v218, v48, v49 offset0:76 offset1:77
  v_add_u32 v218, 16512, v218
  s_waitcnt vmcnt(0) lgkmcnt(0)
  s_barrier
  ds_read_b128 v[32:35], v203 offset:0
  ds_read_b128 v[36:39], v204 offset:0
  ds_read_b128 v[40:43], v205 offset:0
  s_waitcnt lgkmcnt(2)
  v_mfma_f32_32x32x16_bf16 v[0:15], a[0:3], v[32:35], 0
  ds_read_b128 v[44:47], v206 offset:0
  v_mfma_f32_32x32x16_bf16 v[16:31], a[144:147], v[32:35], 0
  s_waitcnt lgkmcnt(2)
  v_mfma_f32_32x32x16_bf16 v[0:15], a[4:7], v[36:39], v[0:15]
  ds_read_b128 v[32:35], v203 offset:1024
  v_mfma_f32_32x32x16_bf16 v[16:31], a[148:151], v[36:39], v[16:31]
  s_waitcnt lgkmcnt(2)
  v_mfma_f32_32x32x16_bf16 v[0:15], a[8:11], v[40:43], v[0:15]
  ds_read_b128 v[36:39], v204 offset:1024
  v_mfma_f32_32x32x16_bf16 v[16:31], a[152:155], v[40:43], v[16:31]
  s_waitcnt lgkmcnt(2)
  v_mfma_f32_32x32x16_bf16 v[0:15], a[12:15], v[44:47], v[0:15]
  ds_read_b128 v[40:43], v205 offset:1024
  v_mfma_f32_32x32x16_bf16 v[16:31], a[156:159], v[44:47], v[16:31]
  s_waitcnt lgkmcnt(2)
  v_mfma_f32_32x32x16_bf16 v[0:15], a[16:19], v[32:35], v[0:15]
  ds_read_b128 v[44:47], v206 offset:1024
  v_mfma_f32_32x32x16_bf16 v[16:31], a[160:163], v[32:35], v[16:31]
  s_waitcnt lgkmcnt(2)
  v_mfma_f32_32x32x16_bf16 v[0:15], a[20:23], v[36:39], v[0:15]
  ds_read_b128 v[32:35], v203 offset:2048
  v_mfma_f32_32x32x16_bf16 v[16:31], a[164:167], v[36:39], v[16:31]
  s_waitcnt lgkmcnt(2)
  v_mfma_f32_32x32x16_bf16 v[0:15], a[24:27], v[40:43], v[0:15]
  ds_read_b128 v[36:39], v204 offset:2048
  v_mfma_f32_32x32x16_bf16 v[16:31], a[168:171], v[40:43], v[16:31]
  s_waitcnt lgkmcnt(2)
  v_mfma_f32_32x32x16_bf16 v[0:15], a[28:31], v[44:47], v[0:15]
  ds_read_b128 v[40:43], v205 offset:2048
  v_mfma_f32_32x32x16_bf16 v[16:31], a[172:175], v[44:47], v[16:31]
  s_waitcnt lgkmcnt(2)
  v_mfma_f32_32x32x16_bf16 v[0:15], a[32:35], v[32:35], v[0:15]
  ds_read_b128 v[44:47], v206 offset:2048
  v_mfma_f32_32x32x16_bf16 v[16:31], a[176:179], v[32:35], v[16:31]
  s_waitcnt lgkmcnt(2)
  v_mfma_f32_32x32x16_bf16 v[0:15], a[36:39], v[36:39], v[0:15]
  ds_read_b128 v[32:35], v203 offset:3072
  v_mfma_f32_32x32x16_bf16 v[16:31], a[180:183], v[36:39], v[16:31]
  s_waitcnt lgkmcnt(2)
  v_mfma_f32_32x32x16_bf16 v[0:15], a[40:43], v[40:43], v[0:15]
  ds_read_b128 v[36:39], v204 offset:3072
  v_mfma_f32_32x32x16_bf16 v[16:31], a[184:187], v[40:43], v[16:31]
  s_waitcnt lgkmcnt(2)
  v_mfma_f32_32x32x16_bf16 v[0:15], a[44:47], v[44:47], v[0:15]
  ds_read_b128 v[40:43], v205 offset:3072
  v_mfma_f32_32x32x16_bf16 v[16:31], a[188:191], v[44:47], v[16:31]
  s_waitcnt lgkmcnt(2)
  v_mfma_f32_32x32x16_bf16 v[0:15], a[48:51], v[32:35], v[0:15]
  ds_read_b128 v[44:47], v206 offset:3072
  v_mfma_f32_32x32x16_bf16 v[16:31], a[192:195], v[32:35], v[16:31]
  s_waitcnt lgkmcnt(2)
  v_mfma_f32_32x32x16_bf16 v[0:15], a[52:55], v[36:39], v[0:15]
  ds_read_b128 v[32:35], v203 offset:4096
  v_mfma_f32_32x32x16_bf16 v[16:31], a[196:199], v[36:39], v[16:31]
  s_waitcnt lgkmcnt(2)
  v_mfma_f32_32x32x16_bf16 v[0:15], a[56:59], v[40:43], v[0:15]
  ds_read_b128 v[36:39], v204 offset:4096
  v_mfma_f32_32x32x16_bf16 v[16:31], a[200:203], v[40:43], v[16:31]
  s_waitcnt lgkmcnt(2)
  v_mfma_f32_32x32x16_bf16 v[0:15], a[60:63], v[44:47], v[0:15]
  ds_read_b128 v[40:43], v205 offset:4096
  v_mfma_f32_32x32x16_bf16 v[16:31], a[204:207], v[44:47], v[16:31]
  s_waitcnt lgkmcnt(2)
  v_mfma_f32_32x32x16_bf16 v[0:15], a[64:67], v[32:35], v[0:15]
  ds_read_b128 v[44:47], v206 offset:4096
  v_mfma_f32_32x32x16_bf16 v[16:31], a[208:211], v[32:35], v[16:31]
  s_waitcnt lgkmcnt(2)
  v_mfma_f32_32x32x16_bf16 v[0:15], a[68:71], v[36:39], v[0:15]
  ds_read_b128 v[32:35], v203 offset:5120
  v_mfma_f32_32x32x16_bf16 v[16:31], a[212:215], v[36:39], v[16:31]
  s_waitcnt lgkmcnt(2)
  v_mfma_f32_32x32x16_bf16 v[0:15], a[72:75], v[40:43], v[0:15]
  ds_read_b128 v[36:39], v204 offset:5120
  v_mfma_f32_32x32x16_bf16 v[16:31], a[216:219], v[40:43], v[16:31]
  s_waitcnt lgkmcnt(2)
  v_mfma_f32_32x32x16_bf16 v[0:15], a[76:79], v[44:47], v[0:15]
  ds_read_b128 v[40:43], v205 offset:5120
  v_mfma_f32_32x32x16_bf16 v[16:31], a[220:223], v[44:47], v[16:31]
  s_waitcnt lgkmcnt(2)
  v_mfma_f32_32x32x16_bf16 v[0:15], a[80:83], v[32:35], v[0:15]
  ds_read_b128 v[44:47], v206 offset:5120
  v_mfma_f32_32x32x16_bf16 v[16:31], a[224:227], v[32:35], v[16:31]
  s_waitcnt lgkmcnt(2)
  v_mfma_f32_32x32x16_bf16 v[0:15], a[84:87], v[36:39], v[0:15]
  ds_read_b128 v[32:35], v203 offset:6144
  v_mfma_f32_32x32x16_bf16 v[16:31], a[228:231], v[36:39], v[16:31]
  s_waitcnt lgkmcnt(2)
  v_mfma_f32_32x32x16_bf16 v[0:15], a[88:91], v[40:43], v[0:15]
  ds_read_b128 v[36:39], v204 offset:6144
  v_mfma_f32_32x32x16_bf16 v[16:31], a[232:235], v[40:43], v[16:31]
  s_waitcnt lgkmcnt(2)
  v_mfma_f32_32x32x16_bf16 v[0:15], a[92:95], v[44:47], v[0:15]
  ds_read_b128 v[40:43], v205 offset:6144
  v_mfma_f32_32x32x16_bf16 v[16:31], a[236:239], v[44:47], v[16:31]
  s_waitcnt lgkmcnt(2)
  v_mfma_f32_32x32x16_bf16 v[0:15], a[96:99], v[32:35], v[0:15]
  ds_read_b128 v[44:47], v206 offset:6144
  v_mfma_f32_32x32x16_bf16 v[16:31], a[240:243], v[32:35], v[16:31]
  s_waitcnt lgkmcnt(2)
  v_mfma_f32_32x32x16_bf16 v[0:15], a[100:103], v[36:39], v[0:15]
  ds_read_b128 v[32:35], v203 offset:7168
  v_mfma_f32_32x32x16_bf16 v[16:31], a[244:247], v[36:39], v[16:31]
  s_waitcnt lgkmcnt(2)
  v_mfma_f32_32x32x16_bf16 v[0:15], a[104:107], v[40:43], v[0:15]
  ds_read_b128 v[36:39], v204 offset:7168
  v_mfma_f32_32x32x16_bf16 v[16:31], a[248:251], v[40:43], v[16:31]
  s_waitcnt lgkmcnt(2)
  v_mfma_f32_32x32x16_bf16 v[0:15], a[108:111], v[44:47], v[0:15]
  ds_read_b128 v[40:43], v205 offset:7168
  v_mfma_f32_32x32x16_bf16 v[16:31], a[252:255], v[44:47], v[16:31]
  s_waitcnt lgkmcnt(2)
  v_mfma_f32_32x32x16_bf16 v[0:15], a[112:115], v[32:35], v[0:15]
  ds_read_b128 v[44:47], v206 offset:7168
  v_mfma_f32_32x32x16_bf16 v[16:31], v[224:227], v[32:35], v[16:31]
  s_waitcnt lgkmcnt(2)
  v_mfma_f32_32x32x16_bf16 v[0:15], a[116:119], v[36:39], v[0:15]
  ds_read_b128 v[32:35], v203 offset:8192
  v_mfma_f32_32x32x16_bf16 v[16:31], v[228:231], v[36:39], v[16:31]
  s_waitcnt lgkmcnt(2)
  v_mfma_f32_32x32x16_bf16 v[0:15], a[120:123], v[40:43], v[0:15]
  ds_read_b128 v[36:39], v204 offset:8192
  v_mfma_f32_32x32x16_bf16 v[16:31], v[232:235], v[40:43], v[16:31]
  s_waitcnt lgkmcnt(2)
  v_mfma_f32_32x32x16_bf16 v[0:15], a[124:127], v[44:47], v[0:15]
  ds_read_b128 v[40:43], v205 offset:8192
  v_mfma_f32_32x32x16_bf16 v[16:31], v[236:239], v[44:47], v[16:31]
  s_waitcnt lgkmcnt(2)
  v_mfma_f32_32x32x16_bf16 v[0:15], a[128:131], v[32:35], v[0:15]
  ds_read_b128 v[44:47], v206 offset:8192
  v_mfma_f32_32x32x16_bf16 v[16:31], v[240:243], v[32:35], v[16:31]
  s_waitcnt lgkmcnt(2)
  v_mfma_f32_32x32x16_bf16 v[0:15], a[132:135], v[36:39], v[0:15]
  v_mfma_f32_32x32x16_bf16 v[16:31], v[244:247], v[36:39], v[16:31]
  s_waitcnt lgkmcnt(1)
  v_mfma_f32_32x32x16_bf16 v[0:15], a[136:139], v[40:43], v[0:15]
  v_mfma_f32_32x32x16_bf16 v[16:31], v[248:251], v[40:43], v[16:31]
  s_waitcnt lgkmcnt(0)
  v_mfma_f32_32x32x16_bf16 v[0:15], a[140:143], v[44:47], v[0:15]
  v_mfma_f32_32x32x16_bf16 v[16:31], v[252:255], v[44:47], v[16:31]
  s_add_u32 s60, s60, 36864
  s_nop 2
  v_cvt_pk_bf16_f32 v48, v0, v1
  v_cvt_pk_bf16_f32 v49, v2, v3
  ds_write2_b32 v218, v48, v49 offset0:0 offset1:1
  v_cvt_pk_bf16_f32 v48, v4, v5
  v_cvt_pk_bf16_f32 v49, v6, v7
  ds_write2_b32 v218, v48, v49 offset0:4 offset1:5
  v_cvt_pk_bf16_f32 v48, v8, v9
  v_cvt_pk_bf16_f32 v49, v10, v11
  ds_write2_b32 v218, v48, v49 offset0:8 offset1:9
  v_cvt_pk_bf16_f32 v48, v12, v13
  v_cvt_pk_bf16_f32 v49, v14, v15
  ds_write2_b32 v218, v48, v49 offset0:12 offset1:13
  v_cvt_pk_bf16_f32 v48, v16, v17
  v_cvt_pk_bf16_f32 v49, v18, v19
  ds_write2_b32 v218, v48, v49 offset0:64 offset1:65
  v_cvt_pk_bf16_f32 v48, v20, v21
  v_cvt_pk_bf16_f32 v49, v22, v23
  ds_write2_b32 v218, v48, v49 offset0:68 offset1:69
  v_cvt_pk_bf16_f32 v48, v24, v25
  v_cvt_pk_bf16_f32 v49, v26, v27
  ds_write2_b32 v218, v48, v49 offset0:72 offset1:73
  v_cvt_pk_bf16_f32 v48, v28, v29
  v_cvt_pk_bf16_f32 v49, v30, v31
  ds_write2_b32 v218, v48, v49 offset0:76 offset1:77
  v_add_u32 v218, 16512, v218
  s_waitcnt vmcnt(0) lgkmcnt(0)
  s_barrier
  v_mul_u32_u24 v219, 516, v200
  s_mul_i32 s54, s52, 36
  s_add_u32 s55, s54, 83016
  v_add_u32 v219, s55, v219
  v_mul_u32_u24 v220, 144, v200
  v_add_u32 v220, s54, v220
  s_mul_i32 s54, s52, 3072
  v_add_u32 v218, s54, v201
  s_lshl_b32 s55, s68, 4
  s_add_u32 s55, s55, s69
  s_mul_i32 s64, s55, 18432
  s_add_u32 s64, s64, 62914560
  s_cmp_eq_u32 s52, 3
  s_cselect_b32 s64, 268435456, s64
  s_lshl_b32 s66, s69, 7
  s_mov_b32 s57, 1051597459
  ds_read_b32 v0, v219 offset:7224
  ds_read_b32 v1, v219 offset:7228
  ds_read_b32 v2, v219 offset:7232
  ds_read_b32 v3, v219 offset:7236
  ds_read_b32 v4, v219 offset:7240
  ds_read_b32 v5, v219 offset:7244
  ds_read_b32 v6, v219 offset:7248
  ds_read_b32 v7, v219 offset:7252
  ds_read_b32 v8, v219 offset:7256
  ds_read_b32 v16, v219 offset:7368
  ds_read_b32 v17, v219 offset:7372
  ds_read_b32 v18, v219 offset:7376
  ds_read_b32 v19, v219 offset:7380
  ds_read_b32 v20, v219 offset:7384
  ds_read_b32 v21, v219 offset:7388
  ds_read_b32 v22, v219 offset:7392
  ds_read_b32 v23, v219 offset:7396
  ds_read_b32 v24, v219 offset:7400
  ds_read_b32 v25, v219 offset:6336
  ds_read_b32 v26, v219 offset:6340
  ds_read_b32 v27, v219 offset:6344
  ds_read_b32 v28, v219 offset:6348
  ds_read_b32 v29, v219 offset:6352
  ds_read_b32 v30, v219 offset:6356
  ds_read_b32 v31, v219 offset:6360
  ds_read_b32 v32, v219 offset:6364
  ds_read_b32 v33, v219 offset:6368
  ds_read_b32 v34, v219 offset:5304
  ds_read_b32 v35, v219 offset:5308
  ds_read_b32 v36, v219 offset:5312
  ds_read_b32 v37, v219 offset:5316
  ds_read_b32 v38, v219 offset:5320
  ds_read_b32 v39, v219 offset:5324
  ds_read_b32 v40, v219 offset:5328
  ds_read_b32 v41, v219 offset:5332
  ds_read_b32 v42, v219 offset:5336
  ds_read_b32 v43, v219 offset:4272
  ds_read_b32 v44, v219 offset:4276
  ds_read_b32 v45, v219 offset:4280
  ds_read_b32 v46, v219 offset:4284
  ds_read_b32 v47, v219 offset:4288
  ds_read_b32 v48, v219 offset:4292
  ds_read_b32 v49, v219 offset:4296
  ds_read_b32 v50, v219 offset:4300
  ds_read_b32 v51, v219 offset:4304
  ds_read_b32 v52, v219 offset:3240
  ds_read_b32 v53, v219 offset:3244
  ds_read_b32 v54, v219 offset:3248
  ds_read_b32 v55, v219 offset:3252
  ds_read_b32 v56, v219 offset:3256
  ds_read_b32 v57, v219 offset:3260
  ds_read_b32 v58, v219 offset:3264
  ds_read_b32 v59, v219 offset:3268
  ds_read_b32 v60, v219 offset:3272
  ds_read_b32 v61, v219 offset:2208
  ds_read_b32 v62, v219 offset:2212
  ds_read_b32 v63, v219 offset:2216
  ds_read_b32 v64, v219 offset:2220
  ds_read_b32 v65, v219 offset:2224
  ds_read_b32 v66, v219 offset:2228
  ds_read_b32 v67, v219 offset:2232
  ds_read_b32 v68, v219 offset:2236
  ds_read_b32 v69, v219 offset:2240
  ds_read_b32 v70, v219 offset:1176
  ds_read_b32 v71, v219 offset:1180
  ds_read_b32 v72, v219 offset:1184
  ds_read_b32 v73, v219 offset:1188
  ds_read_b32 v74, v219 offset:1192
  ds_read_b32 v75, v219 offset:1196
  ds_read_b32 v76, v219 offset:1200
  ds_read_b32 v77, v219 offset:1204
  ds_read_b32 v78, v219 offset:1208
  ds_read_b32 v79, v219 offset:144
  ds_read_b32 v80, v219 offset:148
  ds_read_b32 v81, v219 offset:152
  ds_read_b32 v82, v219 offset:156
  ds_read_b32 v83, v219 offset:160
  ds_read_b32 v84, v219 offset:164
  ds_read_b32 v85, v219 offset:168
  ds_read_b32 v86, v219 offset:172
  ds_read_b32 v87, v219 offset:176
  v_mov_b32 v100, 0
  v_mov_b32 v101, 0
  v_mov_b32 v102, 0
  v_mov_b32 v103, 0
  v_mov_b32 v104, 0
  v_mov_b32 v105, 0
  v_mov_b32 v106, 0
  v_mov_b32 v107, 0
  s_waitcnt lgkmcnt(15)
  v_dot2c_f32_bf16 v100, v0, v16
  v_dot2c_f32_bf16 v101, v0, v25
  v_dot2c_f32_bf16 v102, v0, v34
  v_dot2c_f32_bf16 v103, v0, v43
  v_dot2c_f32_bf16 v104, v0, v52
  v_dot2c_f32_bf16 v105, v0, v61
  v_dot2c_f32_bf16 v106, v0, v70
  s_waitcnt lgkmcnt(8)
  v_dot2c_f32_bf16 v107, v0, v79
  v_dot2c_f32_bf16 v100, v1, v17
  v_dot2c_f32_bf16 v101, v1, v26
  v_dot2c_f32_bf16 v102, v1, v35
  v_dot2c_f32_bf16 v103, v1, v44
  v_dot2c_f32_bf16 v104, v1, v53
  v_dot2c_f32_bf16 v105, v1, v62
  v_dot2c_f32_bf16 v106, v1, v71
  s_waitcnt lgkmcnt(7)
  v_dot2c_f32_bf16 v107, v1, v80
  v_dot2c_f32_bf16 v100, v2, v18
  v_dot2c_f32_bf16 v101, v2, v27
  v_dot2c_f32_bf16 v102, v2, v36
  v_dot2c_f32_bf16 v103, v2, v45
  v_dot2c_f32_bf16 v104, v2, v54
  v_dot2c_f32_bf16 v105, v2, v63
  v_dot2c_f32_bf16 v106, v2, v72
  s_waitcnt lgkmcnt(6)
  v_dot2c_f32_bf16 v107, v2, v81
  v_dot2c_f32_bf16 v100, v3, v19
  v_dot2c_f32_bf16 v101, v3, v28
  v_dot2c_f32_bf16 v102, v3, v37
  v_dot2c_f32_bf16 v103, v3, v46
  v_dot2c_f32_bf16 v104, v3, v55
  v_dot2c_f32_bf16 v105, v3, v64
  v_dot2c_f32_bf16 v106, v3, v73
  s_waitcnt lgkmcnt(5)
  v_dot2c_f32_bf16 v107, v3, v82
  v_dot2c_f32_bf16 v100, v4, v20
  v_dot2c_f32_bf16 v101, v4, v29
  v_dot2c_f32_bf16 v102, v4, v38
  v_dot2c_f32_bf16 v103, v4, v47
  v_dot2c_f32_bf16 v104, v4, v56
  v_dot2c_f32_bf16 v105, v4, v65
  v_dot2c_f32_bf16 v106, v4, v74
  s_waitcnt lgkmcnt(4)
  v_dot2c_f32_bf16 v107, v4, v83
  v_dot2c_f32_bf16 v100, v5, v21
  v_dot2c_f32_bf16 v101, v5, v30
  v_dot2c_f32_bf16 v102, v5, v39
  v_dot2c_f32_bf16 v103, v5, v48
  v_dot2c_f32_bf16 v104, v5, v57
  v_dot2c_f32_bf16 v105, v5, v66
  v_dot2c_f32_bf16 v106, v5, v75
  s_waitcnt lgkmcnt(3)
  v_dot2c_f32_bf16 v107, v5, v84
  v_dot2c_f32_bf16 v100, v6, v22
  v_dot2c_f32_bf16 v101, v6, v31
  v_dot2c_f32_bf16 v102, v6, v40
  v_dot2c_f32_bf16 v103, v6, v49
  v_dot2c_f32_bf16 v104, v6, v58
  v_dot2c_f32_bf16 v105, v6, v67
  v_dot2c_f32_bf16 v106, v6, v76
  s_waitcnt lgkmcnt(2)
  v_dot2c_f32_bf16 v107, v6, v85
  v_dot2c_f32_bf16 v100, v7, v23
  v_dot2c_f32_bf16 v101, v7, v32
  v_dot2c_f32_bf16 v102, v7, v41
  v_dot2c_f32_bf16 v103, v7, v50
  v_dot2c_f32_bf16 v104, v7, v59
  v_dot2c_f32_bf16 v105, v7, v68
  v_dot2c_f32_bf16 v106, v7, v77
  s_waitcnt lgkmcnt(1)
  v_dot2c_f32_bf16 v107, v7, v86
  v_dot2c_f32_bf16 v100, v8, v24
  v_dot2c_f32_bf16 v101, v8, v33
  v_dot2c_f32_bf16 v102, v8, v42
  v_dot2c_f32_bf16 v103, v8, v51
  v_dot2c_f32_bf16 v104, v8, v60
  v_dot2c_f32_bf16 v105, v8, v69
  v_dot2c_f32_bf16 v106, v8, v78
  s_waitcnt lgkmcnt(0)
  v_dot2c_f32_bf16 v107, v8, v87
  ds_read_b32 v16, v219 offset:7512
  ds_read_b32 v17, v219 offset:7516
  ds_read_b32 v18, v219 offset:7520
  ds_read_b32 v19, v219 offset:7524
  ds_read_b32 v20, v219 offset:7528
  ds_read_b32 v21, v219 offset:7532
  ds_read_b32 v22, v219 offset:7536
  ds_read_b32 v23, v219 offset:7540
  ds_read_b32 v24, v219 offset:7544
  ds_read_b32 v25, v219 offset:6480
  ds_read_b32 v26, v219 offset:6484
  ds_read_b32 v27, v219 offset:6488
  ds_read_b32 v28, v219 offset:6492
  ds_read_b32 v29, v219 offset:6496
  ds_read_b32 v30, v219 offset:6500
  ds_read_b32 v31, v219 offset:6504
  ds_read_b32 v32, v219 offset:6508
  ds_read_b32 v33, v219 offset:6512
  ds_read_b32 v34, v219 offset:5448
  ds_read_b32 v35, v219 offset:5452
  ds_read_b32 v36, v219 offset:5456
  ds_read_b32 v37, v219 offset:5460
  ds_read_b32 v38, v219 offset:5464
  ds_read_b32 v39, v219 offset:5468
  ds_read_b32 v40, v219 offset:5472
  ds_read_b32 v41, v219 offset:5476
  ds_read_b32 v42, v219 offset:5480
  ds_read_b32 v43, v219 offset:4416
  ds_read_b32 v44, v219 offset:4420
  ds_read_b32 v45, v219 offset:4424
  ds_read_b32 v46, v219 offset:4428
  ds_read_b32 v47, v219 offset:4432
  ds_read_b32 v48, v219 offset:4436
  ds_read_b32 v49, v219 offset:4440
  ds_read_b32 v50, v219 offset:4444
  ds_read_b32 v51, v219 offset:4448
  ds_read_b32 v52, v219 offset:3384
  ds_read_b32 v53, v219 offset:3388
  ds_read_b32 v54, v219 offset:3392
  ds_read_b32 v55, v219 offset:3396
  ds_read_b32 v56, v219 offset:3400
  ds_read_b32 v57, v219 offset:3404
  ds_read_b32 v58, v219 offset:3408
  ds_read_b32 v59, v219 offset:3412
  ds_read_b32 v60, v219 offset:3416
  ds_read_b32 v61, v219 offset:2352
  ds_read_b32 v62, v219 offset:2356
  ds_read_b32 v63, v219 offset:2360
  ds_read_b32 v64, v219 offset:2364
  ds_read_b32 v65, v219 offset:2368
  ds_read_b32 v66, v219 offset:2372
  ds_read_b32 v67, v219 offset:2376
  ds_read_b32 v68, v219 offset:2380
  ds_read_b32 v69, v219 offset:2384
  ds_read_b32 v70, v219 offset:1320
  ds_read_b32 v71, v219 offset:1324
  ds_read_b32 v72, v219 offset:1328
  ds_read_b32 v73, v219 offset:1332
  ds_read_b32 v74, v219 offset:1336
  ds_read_b32 v75, v219 offset:1340
  ds_read_b32 v76, v219 offset:1344
  ds_read_b32 v77, v219 offset:1348
  ds_read_b32 v78, v219 offset:1352
  ds_read_b32 v79, v219 offset:288
  ds_read_b32 v80, v219 offset:292
  ds_read_b32 v81, v219 offset:296
  ds_read_b32 v82, v219 offset:300
  ds_read_b32 v83, v219 offset:304
  ds_read_b32 v84, v219 offset:308
  ds_read_b32 v85, v219 offset:312
  ds_read_b32 v86, v219 offset:316
  ds_read_b32 v87, v219 offset:320
  v_add_u32 v211, s66, v200
  v_mov_b32 v212, 0xf149f2ca
  v_mul_f32 v100, s57, v100
  v_mul_f32 v101, s57, v101
  v_mul_f32 v102, s57, v102
  v_mul_f32 v103, s57, v103
  v_mul_f32 v104, s57, v104
  v_mul_f32 v105, s57, v105
  v_mul_f32 v106, s57, v106
  v_mul_f32 v107, s57, v107
  v_cmp_gt_u32 vcc, 2, v211
  s_nop 1
  v_cndmask_b32 v101, v101, v212, vcc
  v_cmp_gt_u32 vcc, 4, v211
  s_nop 1
  v_cndmask_b32 v102, v102, v212, vcc
  v_cmp_gt_u32 vcc, 6, v211
  s_nop 1
  v_cndmask_b32 v103, v103, v212, vcc
  v_cmp_gt_u32 vcc, 8, v211
  s_nop 1
  v_cndmask_b32 v104, v104, v212, vcc
  v_cmp_gt_u32 vcc, 10, v211
  s_nop 1
  v_cndmask_b32 v105, v105, v212, vcc
  v_cmp_gt_u32 vcc, 12, v211
  s_nop 1
  v_cndmask_b32 v106, v106, v212, vcc
  v_cmp_gt_u32 vcc, 14, v211
  s_nop 1
  v_cndmask_b32 v107, v107, v212, vcc
  v_max3_f32 v213, v100, v101, v102
  v_max3_f32 v213, v213, v103, v104
  v_max3_f32 v213, v213, v105, v106
  v_max_f32 v213, v213, v107
  v_sub_f32 v100, v100, v213
  v_sub_f32 v101, v101, v213
  v_sub_f32 v102, v102, v213
  v_sub_f32 v103, v103, v213
  v_sub_f32 v104, v104, v213
  v_sub_f32 v105, v105, v213
  v_sub_f32 v106, v106, v213
  v_sub_f32 v107, v107, v213
  v_exp_f32 v100, v100
  v_exp_f32 v101, v101
  v_exp_f32 v102, v102
  v_exp_f32 v103, v103
  v_exp_f32 v104, v104
  v_exp_f32 v105, v105
  v_exp_f32 v106, v106
  v_exp_f32 v107, v107
  v_add_f32 v213, v100, v101
  v_add_f32 v213, v213, v102
  v_add_f32 v213, v213, v103
  v_add_f32 v213, v213, v104
  v_add_f32 v213, v213, v105
  v_add_f32 v213, v213, v106
  v_add_f32 v213, v213, v107
  v_rcp_f32 v213, v213
  v_mov_b32 v214, 0
  v_mul_f32 v100, v213, v100
  v_mul_f32 v101, v213, v101
  v_mul_f32 v102, v213, v102
  v_mul_f32 v103, v213, v103
  v_mul_f32 v104, v213, v104
  v_mul_f32 v105, v213, v105
  v_mul_f32 v106, v213, v106
  v_mul_f32 v107, v213, v107
  v_mov_b32 v112, 0
  v_mov_b32 v113, 0
  v_mov_b32 v114, 0
  v_mov_b32 v115, 0
  v_mov_b32 v116, 0
  v_mov_b32 v117, 0
  v_mov_b32 v118, 0
  v_mov_b32 v119, 0
  v_mov_b32 v120, 0
  v_mov_b32 v121, 0
  v_mov_b32 v122, 0
  v_mov_b32 v123, 0
  v_mov_b32 v124, 0
  v_mov_b32 v125, 0
  v_mov_b32 v126, 0
  v_mov_b32 v127, 0
  v_mov_b32 v128, 0
  v_mov_b32 v129, 0
  v_cvt_pk_bf16_f32 v0, v100, v214
  v_cvt_pk_bf16_f32 v1, v214, v100
  s_waitcnt lgkmcnt(15)
  v_dot2c_f32_bf16 v112, v16, v0
  v_dot2c_f32_bf16 v113, v16, v1
  v_dot2c_f32_bf16 v114, v17, v0
  v_dot2c_f32_bf16 v115, v17, v1
  v_dot2c_f32_bf16 v116, v18, v0
  v_dot2c_f32_bf16 v117, v18, v1
  v_dot2c_f32_bf16 v118, v19, v0
  v_dot2c_f32_bf16 v119, v19, v1
  v_dot2c_f32_bf16 v120, v20, v0
  v_dot2c_f32_bf16 v121, v20, v1
  v_dot2c_f32_bf16 v122, v21, v0
  v_dot2c_f32_bf16 v123, v21, v1
  v_dot2c_f32_bf16 v124, v22, v0
  v_dot2c_f32_bf16 v125, v22, v1
  v_dot2c_f32_bf16 v126, v23, v0
  v_dot2c_f32_bf16 v127, v23, v1
  v_dot2c_f32_bf16 v128, v24, v0
  v_dot2c_f32_bf16 v129, v24, v1
  v_cvt_pk_bf16_f32 v2, v101, v214
  v_cvt_pk_bf16_f32 v3, v214, v101
  v_dot2c_f32_bf16 v112, v25, v2
  v_dot2c_f32_bf16 v113, v25, v3
  v_dot2c_f32_bf16 v114, v26, v2
  v_dot2c_f32_bf16 v115, v26, v3
  v_dot2c_f32_bf16 v116, v27, v2
  v_dot2c_f32_bf16 v117, v27, v3
  v_dot2c_f32_bf16 v118, v28, v2
  v_dot2c_f32_bf16 v119, v28, v3
  v_dot2c_f32_bf16 v120, v29, v2
  v_dot2c_f32_bf16 v121, v29, v3
  v_dot2c_f32_bf16 v122, v30, v2
  v_dot2c_f32_bf16 v123, v30, v3
  v_dot2c_f32_bf16 v124, v31, v2
  v_dot2c_f32_bf16 v125, v31, v3
  v_dot2c_f32_bf16 v126, v32, v2
  v_dot2c_f32_bf16 v127, v32, v3
  v_dot2c_f32_bf16 v128, v33, v2
  v_dot2c_f32_bf16 v129, v33, v3
  v_cvt_pk_bf16_f32 v0, v102, v214
  v_cvt_pk_bf16_f32 v1, v214, v102
  v_dot2c_f32_bf16 v112, v34, v0
  v_dot2c_f32_bf16 v113, v34, v1
  v_dot2c_f32_bf16 v114, v35, v0
  v_dot2c_f32_bf16 v115, v35, v1
  v_dot2c_f32_bf16 v116, v36, v0
  v_dot2c_f32_bf16 v117, v36, v1
  v_dot2c_f32_bf16 v118, v37, v0
  v_dot2c_f32_bf16 v119, v37, v1
  v_dot2c_f32_bf16 v120, v38, v0
  v_dot2c_f32_bf16 v121, v38, v1
  v_dot2c_f32_bf16 v122, v39, v0
  v_dot2c_f32_bf16 v123, v39, v1
  v_dot2c_f32_bf16 v124, v40, v0
  v_dot2c_f32_bf16 v125, v40, v1
  v_dot2c_f32_bf16 v126, v41, v0
  v_dot2c_f32_bf16 v127, v41, v1
  v_dot2c_f32_bf16 v128, v42, v0
  v_dot2c_f32_bf16 v129, v42, v1
  v_cvt_pk_bf16_f32 v2, v103, v214
  v_cvt_pk_bf16_f32 v3, v214, v103
  v_dot2c_f32_bf16 v112, v43, v2
  v_dot2c_f32_bf16 v113, v43, v3
  v_dot2c_f32_bf16 v114, v44, v2
  v_dot2c_f32_bf16 v115, v44, v3
  v_dot2c_f32_bf16 v116, v45, v2
  v_dot2c_f32_bf16 v117, v45, v3
  v_dot2c_f32_bf16 v118, v46, v2
  v_dot2c_f32_bf16 v119, v46, v3
  v_dot2c_f32_bf16 v120, v47, v2
  v_dot2c_f32_bf16 v121, v47, v3
  v_dot2c_f32_bf16 v122, v48, v2
  v_dot2c_f32_bf16 v123, v48, v3
  v_dot2c_f32_bf16 v124, v49, v2
  v_dot2c_f32_bf16 v125, v49, v3
  v_dot2c_f32_bf16 v126, v50, v2
  v_dot2c_f32_bf16 v127, v50, v3
  v_dot2c_f32_bf16 v128, v51, v2
  v_dot2c_f32_bf16 v129, v51, v3
  v_cvt_pk_bf16_f32 v0, v104, v214
  v_cvt_pk_bf16_f32 v1, v214, v104
  v_dot2c_f32_bf16 v112, v52, v0
  v_dot2c_f32_bf16 v113, v52, v1
  v_dot2c_f32_bf16 v114, v53, v0
  v_dot2c_f32_bf16 v115, v53, v1
  v_dot2c_f32_bf16 v116, v54, v0
  v_dot2c_f32_bf16 v117, v54, v1
  v_dot2c_f32_bf16 v118, v55, v0
  v_dot2c_f32_bf16 v119, v55, v1
  v_dot2c_f32_bf16 v120, v56, v0
  v_dot2c_f32_bf16 v121, v56, v1
  v_dot2c_f32_bf16 v122, v57, v0
  v_dot2c_f32_bf16 v123, v57, v1
  v_dot2c_f32_bf16 v124, v58, v0
  v_dot2c_f32_bf16 v125, v58, v1
  v_dot2c_f32_bf16 v126, v59, v0
  v_dot2c_f32_bf16 v127, v59, v1
  v_dot2c_f32_bf16 v128, v60, v0
  v_dot2c_f32_bf16 v129, v60, v1
  v_cvt_pk_bf16_f32 v2, v105, v214
  v_cvt_pk_bf16_f32 v3, v214, v105
  v_dot2c_f32_bf16 v112, v61, v2
  v_dot2c_f32_bf16 v113, v61, v3
  v_dot2c_f32_bf16 v114, v62, v2
  v_dot2c_f32_bf16 v115, v62, v3
  v_dot2c_f32_bf16 v116, v63, v2
  v_dot2c_f32_bf16 v117, v63, v3
  v_dot2c_f32_bf16 v118, v64, v2
  v_dot2c_f32_bf16 v119, v64, v3
  v_dot2c_f32_bf16 v120, v65, v2
  v_dot2c_f32_bf16 v121, v65, v3
  v_dot2c_f32_bf16 v122, v66, v2
  v_dot2c_f32_bf16 v123, v66, v3
  v_dot2c_f32_bf16 v124, v67, v2
  v_dot2c_f32_bf16 v125, v67, v3
  v_dot2c_f32_bf16 v126, v68, v2
  v_dot2c_f32_bf16 v127, v68, v3
  v_dot2c_f32_bf16 v128, v69, v2
  v_dot2c_f32_bf16 v129, v69, v3
  v_cvt_pk_bf16_f32 v0, v106, v214
  v_cvt_pk_bf16_f32 v1, v214, v106
  v_dot2c_f32_bf16 v112, v70, v0
  v_dot2c_f32_bf16 v113, v70, v1
  v_dot2c_f32_bf16 v114, v71, v0
  v_dot2c_f32_bf16 v115, v71, v1
  v_dot2c_f32_bf16 v116, v72, v0
  v_dot2c_f32_bf16 v117, v72, v1
  s_waitcnt lgkmcnt(14)
  v_dot2c_f32_bf16 v118, v73, v0
  v_dot2c_f32_bf16 v119, v73, v1
  s_waitcnt lgkmcnt(13)
  v_dot2c_f32_bf16 v120, v74, v0
  v_dot2c_f32_bf16 v121, v74, v1
  s_waitcnt lgkmcnt(12)
  v_dot2c_f32_bf16 v122, v75, v0
  v_dot2c_f32_bf16 v123, v75, v1
  s_waitcnt lgkmcnt(11)
  v_dot2c_f32_bf16 v124, v76, v0
  v_dot2c_f32_bf16 v125, v76, v1
  s_waitcnt lgkmcnt(10)
  v_dot2c_f32_bf16 v126, v77, v0
  v_dot2c_f32_bf16 v127, v77, v1
  s_waitcnt lgkmcnt(9)
  v_dot2c_f32_bf16 v128, v78, v0
  v_dot2c_f32_bf16 v129, v78, v1
  v_cvt_pk_bf16_f32 v2, v107, v214
  v_cvt_pk_bf16_f32 v3, v214, v107
  s_waitcnt lgkmcnt(8)
  v_dot2c_f32_bf16 v112, v79, v2
  v_dot2c_f32_bf16 v113, v79, v3
  s_waitcnt lgkmcnt(7)
  v_dot2c_f32_bf16 v114, v80, v2
  v_dot2c_f32_bf16 v115, v80, v3
  s_waitcnt lgkmcnt(6)
  v_dot2c_f32_bf16 v116, v81, v2
  v_dot2c_f32_bf16 v117, v81, v3
  s_waitcnt lgkmcnt(5)
  v_dot2c_f32_bf16 v118, v82, v2
  v_dot2c_f32_bf16 v119, v82, v3
  s_waitcnt lgkmcnt(4)
  v_dot2c_f32_bf16 v120, v83, v2
  v_dot2c_f32_bf16 v121, v83, v3
  s_waitcnt lgkmcnt(3)
  v_dot2c_f32_bf16 v122, v84, v2
  v_dot2c_f32_bf16 v123, v84, v3
  s_waitcnt lgkmcnt(2)
  v_dot2c_f32_bf16 v124, v85, v2
  v_dot2c_f32_bf16 v125, v85, v3
  s_waitcnt lgkmcnt(1)
  v_dot2c_f32_bf16 v126, v86, v2
  v_dot2c_f32_bf16 v127, v86, v3
  s_waitcnt lgkmcnt(0)
  v_dot2c_f32_bf16 v128, v87, v2
  v_dot2c_f32_bf16 v129, v87, v3
  v_cvt_pk_bf16_f32 v132, v112, v113
  v_cvt_pk_bf16_f32 v133, v114, v115
  v_cvt_pk_bf16_f32 v134, v116, v117
  v_cvt_pk_bf16_f32 v135, v118, v119
  v_cvt_pk_bf16_f32 v136, v120, v121
  v_cvt_pk_bf16_f32 v137, v122, v123
  v_cvt_pk_bf16_f32 v138, v124, v125
  v_cvt_pk_bf16_f32 v139, v126, v127
  v_cvt_pk_bf16_f32 v140, v128, v129
  ds_write_b32 v220, v132 offset:0
  ds_write_b32 v220, v133 offset:4
  ds_write_b32 v220, v134 offset:8
  ds_write_b32 v220, v135 offset:12
  ds_write_b32 v220, v136 offset:16
  ds_write_b32 v220, v137 offset:20
  ds_write_b32 v220, v138 offset:24
  ds_write_b32 v220, v139 offset:28
  ds_write_b32 v220, v140 offset:32
  s_waitcnt lgkmcnt(0)
  s_barrier
  ds_read_b128 v[144:147], v218 offset:0
  ds_read_b128 v[148:151], v218 offset:1024
  ds_read_b128 v[152:155], v218 offset:2048
  s_waitcnt lgkmcnt(2)
  buffer_store_dwordx4 v[144:147], v218, s[8:11], s64 offen offset:0 sc1
  s_waitcnt lgkmcnt(1)
  buffer_store_dwordx4 v[148:151], v218, s[8:11], s64 offen offset:1024 sc1
  s_waitcnt lgkmcnt(0)
  buffer_store_dwordx4 v[152:155], v218, s[8:11], s64 offen offset:2048 sc1
  v_add_u32 v219, 33024, v219
  s_add_u32 s66, s66, 64
  s_add_u32 s64, s64, 9216
  ds_read_b32 v0, v219 offset:7224
  ds_read_b32 v1, v219 offset:7228
  ds_read_b32 v2, v219 offset:7232
  ds_read_b32 v3, v219 offset:7236
  ds_read_b32 v4, v219 offset:7240
  ds_read_b32 v5, v219 offset:7244
  ds_read_b32 v6, v219 offset:7248
  ds_read_b32 v7, v219 offset:7252
  ds_read_b32 v8, v219 offset:7256
  ds_read_b32 v16, v219 offset:7368
  ds_read_b32 v17, v219 offset:7372
  ds_read_b32 v18, v219 offset:7376
  ds_read_b32 v19, v219 offset:7380
  ds_read_b32 v20, v219 offset:7384
  ds_read_b32 v21, v219 offset:7388
  ds_read_b32 v22, v219 offset:7392
  ds_read_b32 v23, v219 offset:7396
  ds_read_b32 v24, v219 offset:7400
  ds_read_b32 v25, v219 offset:6336
  ds_read_b32 v26, v219 offset:6340
  ds_read_b32 v27, v219 offset:6344
  ds_read_b32 v28, v219 offset:6348
  ds_read_b32 v29, v219 offset:6352
  ds_read_b32 v30, v219 offset:6356
  ds_read_b32 v31, v219 offset:6360
  ds_read_b32 v32, v219 offset:6364
  ds_read_b32 v33, v219 offset:6368
  ds_read_b32 v34, v219 offset:5304
  ds_read_b32 v35, v219 offset:5308
  ds_read_b32 v36, v219 offset:5312
  ds_read_b32 v37, v219 offset:5316
  ds_read_b32 v38, v219 offset:5320
  ds_read_b32 v39, v219 offset:5324
  ds_read_b32 v40, v219 offset:5328
  ds_read_b32 v41, v219 offset:5332
  ds_read_b32 v42, v219 offset:5336
  ds_read_b32 v43, v219 offset:4272
  ds_read_b32 v44, v219 offset:4276
  ds_read_b32 v45, v219 offset:4280
  ds_read_b32 v46, v219 offset:4284
  ds_read_b32 v47, v219 offset:4288
  ds_read_b32 v48, v219 offset:4292
  ds_read_b32 v49, v219 offset:4296
  ds_read_b32 v50, v219 offset:4300
  ds_read_b32 v51, v219 offset:4304
  ds_read_b32 v52, v219 offset:3240
  ds_read_b32 v53, v219 offset:3244
  ds_read_b32 v54, v219 offset:3248
  ds_read_b32 v55, v219 offset:3252
  ds_read_b32 v56, v219 offset:3256
  ds_read_b32 v57, v219 offset:3260
  ds_read_b32 v58, v219 offset:3264
  ds_read_b32 v59, v219 offset:3268
  ds_read_b32 v60, v219 offset:3272
  ds_read_b32 v61, v219 offset:2208
  ds_read_b32 v62, v219 offset:2212
  ds_read_b32 v63, v219 offset:2216
  ds_read_b32 v64, v219 offset:2220
  ds_read_b32 v65, v219 offset:2224
  ds_read_b32 v66, v219 offset:2228
  ds_read_b32 v67, v219 offset:2232
  ds_read_b32 v68, v219 offset:2236
  ds_read_b32 v69, v219 offset:2240
  ds_read_b32 v70, v219 offset:1176
  ds_read_b32 v71, v219 offset:1180
  ds_read_b32 v72, v219 offset:1184
  ds_read_b32 v73, v219 offset:1188
  ds_read_b32 v74, v219 offset:1192
  ds_read_b32 v75, v219 offset:1196
  ds_read_b32 v76, v219 offset:1200
  ds_read_b32 v77, v219 offset:1204
  ds_read_b32 v78, v219 offset:1208
  ds_read_b32 v79, v219 offset:144
  ds_read_b32 v80, v219 offset:148
  ds_read_b32 v81, v219 offset:152
  ds_read_b32 v82, v219 offset:156
  ds_read_b32 v83, v219 offset:160
  ds_read_b32 v84, v219 offset:164
  ds_read_b32 v85, v219 offset:168
  ds_read_b32 v86, v219 offset:172
  ds_read_b32 v87, v219 offset:176
  v_mov_b32 v100, 0
  v_mov_b32 v101, 0
  v_mov_b32 v102, 0
  v_mov_b32 v103, 0
  v_mov_b32 v104, 0
  v_mov_b32 v105, 0
  v_mov_b32 v106, 0
  v_mov_b32 v107, 0
  s_waitcnt lgkmcnt(15)
  v_dot2c_f32_bf16 v100, v0, v16
  v_dot2c_f32_bf16 v101, v0, v25
  v_dot2c_f32_bf16 v102, v0, v34
  v_dot2c_f32_bf16 v103, v0, v43
  v_dot2c_f32_bf16 v104, v0, v52
  v_dot2c_f32_bf16 v105, v0, v61
  v_dot2c_f32_bf16 v106, v0, v70
  s_waitcnt lgkmcnt(8)
  v_dot2c_f32_bf16 v107, v0, v79
  v_dot2c_f32_bf16 v100, v1, v17
  v_dot2c_f32_bf16 v101, v1, v26
  v_dot2c_f32_bf16 v102, v1, v35
  v_dot2c_f32_bf16 v103, v1, v44
  v_dot2c_f32_bf16 v104, v1, v53
  v_dot2c_f32_bf16 v105, v1, v62
  v_dot2c_f32_bf16 v106, v1, v71
  s_waitcnt lgkmcnt(7)
  v_dot2c_f32_bf16 v107, v1, v80
  v_dot2c_f32_bf16 v100, v2, v18
  v_dot2c_f32_bf16 v101, v2, v27
  v_dot2c_f32_bf16 v102, v2, v36
  v_dot2c_f32_bf16 v103, v2, v45
  v_dot2c_f32_bf16 v104, v2, v54
  v_dot2c_f32_bf16 v105, v2, v63
  v_dot2c_f32_bf16 v106, v2, v72
  s_waitcnt lgkmcnt(6)
  v_dot2c_f32_bf16 v107, v2, v81
  v_dot2c_f32_bf16 v100, v3, v19
  v_dot2c_f32_bf16 v101, v3, v28
  v_dot2c_f32_bf16 v102, v3, v37
  v_dot2c_f32_bf16 v103, v3, v46
  v_dot2c_f32_bf16 v104, v3, v55
  v_dot2c_f32_bf16 v105, v3, v64
  v_dot2c_f32_bf16 v106, v3, v73
  s_waitcnt lgkmcnt(5)
  v_dot2c_f32_bf16 v107, v3, v82
  v_dot2c_f32_bf16 v100, v4, v20
  v_dot2c_f32_bf16 v101, v4, v29
  v_dot2c_f32_bf16 v102, v4, v38
  v_dot2c_f32_bf16 v103, v4, v47
  v_dot2c_f32_bf16 v104, v4, v56
  v_dot2c_f32_bf16 v105, v4, v65
  v_dot2c_f32_bf16 v106, v4, v74
  s_waitcnt lgkmcnt(4)
  v_dot2c_f32_bf16 v107, v4, v83
  v_dot2c_f32_bf16 v100, v5, v21
  v_dot2c_f32_bf16 v101, v5, v30
  v_dot2c_f32_bf16 v102, v5, v39
  v_dot2c_f32_bf16 v103, v5, v48
  v_dot2c_f32_bf16 v104, v5, v57
  v_dot2c_f32_bf16 v105, v5, v66
  v_dot2c_f32_bf16 v106, v5, v75
  s_waitcnt lgkmcnt(3)
  v_dot2c_f32_bf16 v107, v5, v84
  v_dot2c_f32_bf16 v100, v6, v22
  v_dot2c_f32_bf16 v101, v6, v31
  v_dot2c_f32_bf16 v102, v6, v40
  v_dot2c_f32_bf16 v103, v6, v49
  v_dot2c_f32_bf16 v104, v6, v58
  v_dot2c_f32_bf16 v105, v6, v67
  v_dot2c_f32_bf16 v106, v6, v76
  s_waitcnt lgkmcnt(2)
  v_dot2c_f32_bf16 v107, v6, v85
  v_dot2c_f32_bf16 v100, v7, v23
  v_dot2c_f32_bf16 v101, v7, v32
  v_dot2c_f32_bf16 v102, v7, v41
  v_dot2c_f32_bf16 v103, v7, v50
  v_dot2c_f32_bf16 v104, v7, v59
  v_dot2c_f32_bf16 v105, v7, v68
  v_dot2c_f32_bf16 v106, v7, v77
  s_waitcnt lgkmcnt(1)
  v_dot2c_f32_bf16 v107, v7, v86
  v_dot2c_f32_bf16 v100, v8, v24
  v_dot2c_f32_bf16 v101, v8, v33
  v_dot2c_f32_bf16 v102, v8, v42
  v_dot2c_f32_bf16 v103, v8, v51
  v_dot2c_f32_bf16 v104, v8, v60
  v_dot2c_f32_bf16 v105, v8, v69
  v_dot2c_f32_bf16 v106, v8, v78
  s_waitcnt lgkmcnt(0)
  v_dot2c_f32_bf16 v107, v8, v87
  ds_read_b32 v16, v219 offset:7512
  ds_read_b32 v17, v219 offset:7516
  ds_read_b32 v18, v219 offset:7520
  ds_read_b32 v19, v219 offset:7524
  ds_read_b32 v20, v219 offset:7528
  ds_read_b32 v21, v219 offset:7532
  ds_read_b32 v22, v219 offset:7536
  ds_read_b32 v23, v219 offset:7540
  ds_read_b32 v24, v219 offset:7544
  ds_read_b32 v25, v219 offset:6480
  ds_read_b32 v26, v219 offset:6484
  ds_read_b32 v27, v219 offset:6488
  ds_read_b32 v28, v219 offset:6492
  ds_read_b32 v29, v219 offset:6496
  ds_read_b32 v30, v219 offset:6500
  ds_read_b32 v31, v219 offset:6504
  ds_read_b32 v32, v219 offset:6508
  ds_read_b32 v33, v219 offset:6512
  ds_read_b32 v34, v219 offset:5448
  ds_read_b32 v35, v219 offset:5452
  ds_read_b32 v36, v219 offset:5456
  ds_read_b32 v37, v219 offset:5460
  ds_read_b32 v38, v219 offset:5464
  ds_read_b32 v39, v219 offset:5468
  ds_read_b32 v40, v219 offset:5472
  ds_read_b32 v41, v219 offset:5476
  ds_read_b32 v42, v219 offset:5480
  ds_read_b32 v43, v219 offset:4416
  ds_read_b32 v44, v219 offset:4420
  ds_read_b32 v45, v219 offset:4424
  ds_read_b32 v46, v219 offset:4428
  ds_read_b32 v47, v219 offset:4432
  ds_read_b32 v48, v219 offset:4436
  ds_read_b32 v49, v219 offset:4440
  ds_read_b32 v50, v219 offset:4444
  ds_read_b32 v51, v219 offset:4448
  ds_read_b32 v52, v219 offset:3384
  ds_read_b32 v53, v219 offset:3388
  ds_read_b32 v54, v219 offset:3392
  ds_read_b32 v55, v219 offset:3396
  ds_read_b32 v56, v219 offset:3400
  ds_read_b32 v57, v219 offset:3404
  ds_read_b32 v58, v219 offset:3408
  ds_read_b32 v59, v219 offset:3412
  ds_read_b32 v60, v219 offset:3416
  ds_read_b32 v61, v219 offset:2352
  ds_read_b32 v62, v219 offset:2356
  ds_read_b32 v63, v219 offset:2360
  ds_read_b32 v64, v219 offset:2364
  ds_read_b32 v65, v219 offset:2368
  ds_read_b32 v66, v219 offset:2372
  ds_read_b32 v67, v219 offset:2376
  ds_read_b32 v68, v219 offset:2380
  ds_read_b32 v69, v219 offset:2384
  ds_read_b32 v70, v219 offset:1320
  ds_read_b32 v71, v219 offset:1324
  ds_read_b32 v72, v219 offset:1328
  ds_read_b32 v73, v219 offset:1332
  ds_read_b32 v74, v219 offset:1336
  ds_read_b32 v75, v219 offset:1340
  ds_read_b32 v76, v219 offset:1344
  ds_read_b32 v77, v219 offset:1348
  ds_read_b32 v78, v219 offset:1352
  ds_read_b32 v79, v219 offset:288
  ds_read_b32 v80, v219 offset:292
  ds_read_b32 v81, v219 offset:296
  ds_read_b32 v82, v219 offset:300
  ds_read_b32 v83, v219 offset:304
  ds_read_b32 v84, v219 offset:308
  ds_read_b32 v85, v219 offset:312
  ds_read_b32 v86, v219 offset:316
  ds_read_b32 v87, v219 offset:320
  v_add_u32 v211, s66, v200
  v_mov_b32 v212, 0xf149f2ca
  v_mul_f32 v100, s57, v100
  v_mul_f32 v101, s57, v101
  v_mul_f32 v102, s57, v102
  v_mul_f32 v103, s57, v103
  v_mul_f32 v104, s57, v104
  v_mul_f32 v105, s57, v105
  v_mul_f32 v106, s57, v106
  v_mul_f32 v107, s57, v107
  v_cmp_gt_u32 vcc, 2, v211
  s_nop 1
  v_cndmask_b32 v101, v101, v212, vcc
  v_cmp_gt_u32 vcc, 4, v211
  s_nop 1
  v_cndmask_b32 v102, v102, v212, vcc
  v_cmp_gt_u32 vcc, 6, v211
  s_nop 1
  v_cndmask_b32 v103, v103, v212, vcc
  v_cmp_gt_u32 vcc, 8, v211
  s_nop 1
  v_cndmask_b32 v104, v104, v212, vcc
  v_cmp_gt_u32 vcc, 10, v211
  s_nop 1
  v_cndmask_b32 v105, v105, v212, vcc
  v_cmp_gt_u32 vcc, 12, v211
  s_nop 1
  v_cndmask_b32 v106, v106, v212, vcc
  v_cmp_gt_u32 vcc, 14, v211
  s_nop 1
  v_cndmask_b32 v107, v107, v212, vcc
  v_max3_f32 v213, v100, v101, v102
  v_max3_f32 v213, v213, v103, v104
  v_max3_f32 v213, v213, v105, v106
  v_max_f32 v213, v213, v107
  v_sub_f32 v100, v100, v213
  v_sub_f32 v101, v101, v213
  v_sub_f32 v102, v102, v213
  v_sub_f32 v103, v103, v213
  v_sub_f32 v104, v104, v213
  v_sub_f32 v105, v105, v213
  v_sub_f32 v106, v106, v213
  v_sub_f32 v107, v107, v213
  v_exp_f32 v100, v100
  v_exp_f32 v101, v101
  v_exp_f32 v102, v102
  v_exp_f32 v103, v103
  v_exp_f32 v104, v104
  v_exp_f32 v105, v105
  v_exp_f32 v106, v106
  v_exp_f32 v107, v107
  v_add_f32 v213, v100, v101
  v_add_f32 v213, v213, v102
  v_add_f32 v213, v213, v103
  v_add_f32 v213, v213, v104
  v_add_f32 v213, v213, v105
  v_add_f32 v213, v213, v106
  v_add_f32 v213, v213, v107
  v_rcp_f32 v213, v213
  v_mov_b32 v214, 0
  v_mul_f32 v100, v213, v100
  v_mul_f32 v101, v213, v101
  v_mul_f32 v102, v213, v102
  v_mul_f32 v103, v213, v103
  v_mul_f32 v104, v213, v104
  v_mul_f32 v105, v213, v105
  v_mul_f32 v106, v213, v106
  v_mul_f32 v107, v213, v107
  v_mov_b32 v112, 0
  v_mov_b32 v113, 0
  v_mov_b32 v114, 0
  v_mov_b32 v115, 0
  v_mov_b32 v116, 0
  v_mov_b32 v117, 0
  v_mov_b32 v118, 0
  v_mov_b32 v119, 0
  v_mov_b32 v120, 0
  v_mov_b32 v121, 0
  v_mov_b32 v122, 0
  v_mov_b32 v123, 0
  v_mov_b32 v124, 0
  v_mov_b32 v125, 0
  v_mov_b32 v126, 0
  v_mov_b32 v127, 0
  v_mov_b32 v128, 0
  v_mov_b32 v129, 0
  v_cvt_pk_bf16_f32 v0, v100, v214
  v_cvt_pk_bf16_f32 v1, v214, v100
  s_waitcnt lgkmcnt(15)
  v_dot2c_f32_bf16 v112, v16, v0
  v_dot2c_f32_bf16 v113, v16, v1
  v_dot2c_f32_bf16 v114, v17, v0
  v_dot2c_f32_bf16 v115, v17, v1
  v_dot2c_f32_bf16 v116, v18, v0
  v_dot2c_f32_bf16 v117, v18, v1
  v_dot2c_f32_bf16 v118, v19, v0
  v_dot2c_f32_bf16 v119, v19, v1
  v_dot2c_f32_bf16 v120, v20, v0
  v_dot2c_f32_bf16 v121, v20, v1
  v_dot2c_f32_bf16 v122, v21, v0
  v_dot2c_f32_bf16 v123, v21, v1
  v_dot2c_f32_bf16 v124, v22, v0
  v_dot2c_f32_bf16 v125, v22, v1
  v_dot2c_f32_bf16 v126, v23, v0
  v_dot2c_f32_bf16 v127, v23, v1
  v_dot2c_f32_bf16 v128, v24, v0
  v_dot2c_f32_bf16 v129, v24, v1
  v_cvt_pk_bf16_f32 v2, v101, v214
  v_cvt_pk_bf16_f32 v3, v214, v101
  v_dot2c_f32_bf16 v112, v25, v2
  v_dot2c_f32_bf16 v113, v25, v3
  v_dot2c_f32_bf16 v114, v26, v2
  v_dot2c_f32_bf16 v115, v26, v3
  v_dot2c_f32_bf16 v116, v27, v2
  v_dot2c_f32_bf16 v117, v27, v3
  v_dot2c_f32_bf16 v118, v28, v2
  v_dot2c_f32_bf16 v119, v28, v3
  v_dot2c_f32_bf16 v120, v29, v2
  v_dot2c_f32_bf16 v121, v29, v3
  v_dot2c_f32_bf16 v122, v30, v2
  v_dot2c_f32_bf16 v123, v30, v3
  v_dot2c_f32_bf16 v124, v31, v2
  v_dot2c_f32_bf16 v125, v31, v3
  v_dot2c_f32_bf16 v126, v32, v2
  v_dot2c_f32_bf16 v127, v32, v3
  v_dot2c_f32_bf16 v128, v33, v2
  v_dot2c_f32_bf16 v129, v33, v3
  v_cvt_pk_bf16_f32 v0, v102, v214
  v_cvt_pk_bf16_f32 v1, v214, v102
  v_dot2c_f32_bf16 v112, v34, v0
  v_dot2c_f32_bf16 v113, v34, v1
  v_dot2c_f32_bf16 v114, v35, v0
  v_dot2c_f32_bf16 v115, v35, v1
  v_dot2c_f32_bf16 v116, v36, v0
  v_dot2c_f32_bf16 v117, v36, v1
  v_dot2c_f32_bf16 v118, v37, v0
  v_dot2c_f32_bf16 v119, v37, v1
  v_dot2c_f32_bf16 v120, v38, v0
  v_dot2c_f32_bf16 v121, v38, v1
  v_dot2c_f32_bf16 v122, v39, v0
  v_dot2c_f32_bf16 v123, v39, v1
  v_dot2c_f32_bf16 v124, v40, v0
  v_dot2c_f32_bf16 v125, v40, v1
  v_dot2c_f32_bf16 v126, v41, v0
  v_dot2c_f32_bf16 v127, v41, v1
  v_dot2c_f32_bf16 v128, v42, v0
  v_dot2c_f32_bf16 v129, v42, v1
  v_cvt_pk_bf16_f32 v2, v103, v214
  v_cvt_pk_bf16_f32 v3, v214, v103
  v_dot2c_f32_bf16 v112, v43, v2
  v_dot2c_f32_bf16 v113, v43, v3
  v_dot2c_f32_bf16 v114, v44, v2
  v_dot2c_f32_bf16 v115, v44, v3
  v_dot2c_f32_bf16 v116, v45, v2
  v_dot2c_f32_bf16 v117, v45, v3
  v_dot2c_f32_bf16 v118, v46, v2
  v_dot2c_f32_bf16 v119, v46, v3
  v_dot2c_f32_bf16 v120, v47, v2
  v_dot2c_f32_bf16 v121, v47, v3
  v_dot2c_f32_bf16 v122, v48, v2
  v_dot2c_f32_bf16 v123, v48, v3
  v_dot2c_f32_bf16 v124, v49, v2
  v_dot2c_f32_bf16 v125, v49, v3
  v_dot2c_f32_bf16 v126, v50, v2
  v_dot2c_f32_bf16 v127, v50, v3
  v_dot2c_f32_bf16 v128, v51, v2
  v_dot2c_f32_bf16 v129, v51, v3
  v_cvt_pk_bf16_f32 v0, v104, v214
  v_cvt_pk_bf16_f32 v1, v214, v104
  v_dot2c_f32_bf16 v112, v52, v0
  v_dot2c_f32_bf16 v113, v52, v1
  v_dot2c_f32_bf16 v114, v53, v0
  v_dot2c_f32_bf16 v115, v53, v1
  v_dot2c_f32_bf16 v116, v54, v0
  v_dot2c_f32_bf16 v117, v54, v1
  v_dot2c_f32_bf16 v118, v55, v0
  v_dot2c_f32_bf16 v119, v55, v1
  v_dot2c_f32_bf16 v120, v56, v0
  v_dot2c_f32_bf16 v121, v56, v1
  v_dot2c_f32_bf16 v122, v57, v0
  v_dot2c_f32_bf16 v123, v57, v1
  v_dot2c_f32_bf16 v124, v58, v0
  v_dot2c_f32_bf16 v125, v58, v1
  v_dot2c_f32_bf16 v126, v59, v0
  v_dot2c_f32_bf16 v127, v59, v1
  v_dot2c_f32_bf16 v128, v60, v0
  v_dot2c_f32_bf16 v129, v60, v1
  v_cvt_pk_bf16_f32 v2, v105, v214
  v_cvt_pk_bf16_f32 v3, v214, v105
  v_dot2c_f32_bf16 v112, v61, v2
  v_dot2c_f32_bf16 v113, v61, v3
  v_dot2c_f32_bf16 v114, v62, v2
  v_dot2c_f32_bf16 v115, v62, v3
  v_dot2c_f32_bf16 v116, v63, v2
  v_dot2c_f32_bf16 v117, v63, v3
  v_dot2c_f32_bf16 v118, v64, v2
  v_dot2c_f32_bf16 v119, v64, v3
  v_dot2c_f32_bf16 v120, v65, v2
  v_dot2c_f32_bf16 v121, v65, v3
  v_dot2c_f32_bf16 v122, v66, v2
  v_dot2c_f32_bf16 v123, v66, v3
  v_dot2c_f32_bf16 v124, v67, v2
  v_dot2c_f32_bf16 v125, v67, v3
  v_dot2c_f32_bf16 v126, v68, v2
  v_dot2c_f32_bf16 v127, v68, v3
  v_dot2c_f32_bf16 v128, v69, v2
  v_dot2c_f32_bf16 v129, v69, v3
  v_cvt_pk_bf16_f32 v0, v106, v214
  v_cvt_pk_bf16_f32 v1, v214, v106
  v_dot2c_f32_bf16 v112, v70, v0
  v_dot2c_f32_bf16 v113, v70, v1
  v_dot2c_f32_bf16 v114, v71, v0
  v_dot2c_f32_bf16 v115, v71, v1
  v_dot2c_f32_bf16 v116, v72, v0
  v_dot2c_f32_bf16 v117, v72, v1
  s_waitcnt lgkmcnt(14)
  v_dot2c_f32_bf16 v118, v73, v0
  v_dot2c_f32_bf16 v119, v73, v1
  s_waitcnt lgkmcnt(13)
  v_dot2c_f32_bf16 v120, v74, v0
  v_dot2c_f32_bf16 v121, v74, v1
  s_waitcnt lgkmcnt(12)
  v_dot2c_f32_bf16 v122, v75, v0
  v_dot2c_f32_bf16 v123, v75, v1
  s_waitcnt lgkmcnt(11)
  v_dot2c_f32_bf16 v124, v76, v0
  v_dot2c_f32_bf16 v125, v76, v1
  s_waitcnt lgkmcnt(10)
  v_dot2c_f32_bf16 v126, v77, v0
  v_dot2c_f32_bf16 v127, v77, v1
  s_waitcnt lgkmcnt(9)
  v_dot2c_f32_bf16 v128, v78, v0
  v_dot2c_f32_bf16 v129, v78, v1
  v_cvt_pk_bf16_f32 v2, v107, v214
  v_cvt_pk_bf16_f32 v3, v214, v107
  s_waitcnt lgkmcnt(8)
  v_dot2c_f32_bf16 v112, v79, v2
  v_dot2c_f32_bf16 v113, v79, v3
  s_waitcnt lgkmcnt(7)
  v_dot2c_f32_bf16 v114, v80, v2
  v_dot2c_f32_bf16 v115, v80, v3
  s_waitcnt lgkmcnt(6)
  v_dot2c_f32_bf16 v116, v81, v2
  v_dot2c_f32_bf16 v117, v81, v3
  s_waitcnt lgkmcnt(5)
  v_dot2c_f32_bf16 v118, v82, v2
  v_dot2c_f32_bf16 v119, v82, v3
  s_waitcnt lgkmcnt(4)
  v_dot2c_f32_bf16 v120, v83, v2
  v_dot2c_f32_bf16 v121, v83, v3
  s_waitcnt lgkmcnt(3)
  v_dot2c_f32_bf16 v122, v84, v2
  v_dot2c_f32_bf16 v123, v84, v3
  s_waitcnt lgkmcnt(2)
  v_dot2c_f32_bf16 v124, v85, v2
  v_dot2c_f32_bf16 v125, v85, v3
  s_waitcnt lgkmcnt(1)
  v_dot2c_f32_bf16 v126, v86, v2
  v_dot2c_f32_bf16 v127, v86, v3
  s_waitcnt lgkmcnt(0)
  v_dot2c_f32_bf16 v128, v87, v2
  v_dot2c_f32_bf16 v129, v87, v3
  v_cvt_pk_bf16_f32 v132, v112, v113
  v_cvt_pk_bf16_f32 v133, v114, v115
  v_cvt_pk_bf16_f32 v134, v116, v117
  v_cvt_pk_bf16_f32 v135, v118, v119
  v_cvt_pk_bf16_f32 v136, v120, v121
  v_cvt_pk_bf16_f32 v137, v122, v123
  v_cvt_pk_bf16_f32 v138, v124, v125
  v_cvt_pk_bf16_f32 v139, v126, v127
  v_cvt_pk_bf16_f32 v140, v128, v129
  ds_write_b32 v220, v132 offset:16384
  ds_write_b32 v220, v133 offset:16388
  ds_write_b32 v220, v134 offset:16392
  ds_write_b32 v220, v135 offset:16396
  ds_write_b32 v220, v136 offset:16400
  ds_write_b32 v220, v137 offset:16404
  ds_write_b32 v220, v138 offset:16408
  ds_write_b32 v220, v139 offset:16412
  ds_write_b32 v220, v140 offset:16416
  s_waitcnt lgkmcnt(0)
  s_barrier
  ds_read_b128 v[144:147], v218 offset:16384
  ds_read_b128 v[148:151], v218 offset:17408
  ds_read_b128 v[152:155], v218 offset:18432
  s_waitcnt lgkmcnt(2)
  buffer_store_dwordx4 v[144:147], v218, s[8:11], s64 offen offset:0 sc1
  s_waitcnt lgkmcnt(1)
  buffer_store_dwordx4 v[148:151], v218, s[8:11], s64 offen offset:1024 sc1
  s_waitcnt lgkmcnt(0)
  buffer_store_dwordx4 v[152:155], v218, s[8:11], s64 offen offset:2048 sc1
  s_mov_b32 s56, 36
  s_waitcnt vmcnt(0)
  s_barrier
  s_cmp_eq_u32 s52, 0
  s_cbranch_scc0 A_sig
  v_mov_b32 v211, 1
  v_mov_b32 v212, 0
  s_mov_b64 exec, 1
  buffer_atomic_add v211, v212, s[12:15], s56 offen
  s_mov_b64 exec, -1
A_sig:
  s_and_b32 s54, s53, 31
  s_cmp_lt_u32 s54, 27
  s_cbranch_scc0 L_exit
  s_and_b32 s54, s53, 31
  s_mul_i32 s68, s54, 57
  s_lshr_b32 s68, s68, 9
  s_mul_i32 s56, s68, 9
  s_sub_u32 s70, s54, s56
  s_bfe_u32 s55, s53, 0x10005
  s_mul_i32 s55, s55, 9
  s_add_u32 s70, s70, s55
  s_bfe_u32 s69, s53, 0x10006
  v_lshrrev_b32 v211, 2, v200
  v_mul_u32_u24 v211, 1152, v211
  v_and_b32 v212, 3, v200
  v_lshl_add_u32 v207, v212, 4, v211
  s_lshl_b32 s54, s70, 6
  s_mul_i32 s55, s52, 1179648
  s_add_u32 s62, s54, s55
  s_mul_i32 s55, s52, 184320
  s_add_u32 s63, s54, s55
  s_mul_i32 s61, s52, 40960
  v_bfe_u32 v211, v200, 2, 2
  v_lshlrev_b32 v212, 4, v212
  v_add_u32 v212, s61, v212
  v_lshl_add_u32 v212, v211, 6, v212
  v_lshrrev_b32 v213, 4, v200
  v_lshl_add_u32 v210, v213, 9, v212
  v_lshrrev_b32 v214, 5, v200
  v_lshl_add_u32 v209, v214, 10, v212
  v_and_b32 v214, 1, v213
  v_lshl_add_u32 v209, v214, 8, v209
  s_add_u32 m0, s61, 0
  s_add_u32 s54, s62, 0
  buffer_load_dwordx4 v207, s[28:31], s54 offen lds
  s_add_u32 m0, s61, 1024
  s_add_u32 s54, s62, 18432
  buffer_load_dwordx4 v207, s[28:31], s54 offen lds
  s_add_u32 m0, s61, 2048
  s_add_u32 s54, s62, 36864
  buffer_load_dwordx4 v207, s[28:31], s54 offen lds
  s_add_u32 m0, s61, 3072
  s_add_u32 s54, s62, 55296
  buffer_load_dwordx4 v207, s[28:31], s54 offen lds
  s_add_u32 m0, s61, 4096
  s_add_u32 s54, s62, 73728
  buffer_load_dwordx4 v207, s[28:31], s54 offen lds
  s_add_u32 m0, s61, 5120
  s_add_u32 s54, s62, 92160
  buffer_load_dwordx4 v207, s[28:31], s54 offen lds
  s_add_u32 m0, s61, 6144
  s_add_u32 s54, s62, 110592
  buffer_load_dwordx4 v207, s[28:31], s54 offen lds
  s_add_u32 m0, s61, 7168
  s_add_u32 s54, s62, 129024
  buffer_load_dwordx4 v207, s[28:31], s54 offen lds
  s_add_u32 m0, s61, 8192
  s_add_u32 s54, s62, 147456
  buffer_load_dwordx4 v207, s[28:31], s54 offen lds
  s_add_u32 m0, s61, 9216
  s_add_u32 s54, s62, 165888
  buffer_load_dwordx4 v207, s[28:31], s54 offen lds
  s_add_u32 m0, s61, 10240
  s_add_u32 s54, s62, 184320
  buffer_load_dwordx4 v207, s[28:31], s54 offen lds
  s_add_u32 m0, s61, 11264
  s_add_u32 s54, s62, 202752
  buffer_load_dwordx4 v207, s[28:31], s54 offen lds
  s_add_u32 m0, s61, 12288
  s_add_u32 s54, s62, 221184
  buffer_load_dwordx4 v207, s[28:31], s54 offen lds
  s_add_u32 m0, s61, 13312
  s_add_u32 s54, s62, 239616
  buffer_load_dwordx4 v207, s[28:31], s54 offen lds
  s_add_u32 m0, s61, 14336
  s_add_u32 s54, s62, 258048
  buffer_load_dwordx4 v207, s[28:31], s54 offen lds
  s_add_u32 m0, s61, 15360
  s_add_u32 s54, s62, 276480
  buffer_load_dwordx4 v207, s[28:31], s54 offen lds
  s_add_u32 m0, s61, 16384
  s_add_u32 s54, s62, 294912
  buffer_load_dwordx4 v207, s[28:31], s54 offen lds
  s_add_u32 m0, s61, 17408
  s_add_u32 s54, s62, 313344
  buffer_load_dwordx4 v207, s[28:31], s54 offen lds
  s_add_u32 m0, s61, 18432
  s_add_u32 s54, s62, 331776
  buffer_load_dwordx4 v207, s[28:31], s54 offen lds
  s_add_u32 m0, s61, 19456
  s_add_u32 s54, s62, 350208
  buffer_load_dwordx4 v207, s[28:31], s54 offen lds
  s_add_u32 m0, s61, 20480
  s_add_u32 s54, s62, 368640
  buffer_load_dwordx4 v207, s[28:31], s54 offen lds
  s_add_u32 m0, s61, 21504
  s_add_u32 s54, s62, 387072
  buffer_load_dwordx4 v207, s[28:31], s54 offen lds
  s_add_u32 m0, s61, 22528
  s_add_u32 s54, s62, 405504
  buffer_load_dwordx4 v207, s[28:31], s54 offen lds
  s_add_u32 m0, s61, 23552
  s_add_u32 s54, s62, 423936
  buffer_load_dwordx4 v207, s[28:31], s54 offen lds
  s_add_u32 m0, s61, 24576
  s_add_u32 s54, s62, 442368
  buffer_load_dwordx4 v207, s[28:31], s54 offen lds
  s_add_u32 m0, s61, 25600
  s_add_u32 s54, s62, 460800
  buffer_load_dwordx4 v207, s[28:31], s54 offen lds
  s_add_u32 m0, s61, 26624
  s_add_u32 s54, s62, 479232
  buffer_load_dwordx4 v207, s[28:31], s54 offen lds
  s_add_u32 m0, s61, 27648
  s_add_u32 s54, s62, 497664
  buffer_load_dwordx4 v207, s[28:31], s54 offen lds
  s_add_u32 m0, s61, 28672
  s_add_u32 s54, s62, 516096
  buffer_load_dwordx4 v207, s[28:31], s54 offen lds
  s_add_u32 m0, s61, 29696
  s_add_u32 s54, s62, 534528
  buffer_load_dwordx4 v207, s[28:31], s54 offen lds
  s_add_u32 m0, s61, 30720
  s_add_u32 s54, s62, 552960
  buffer_load_dwordx4 v207, s[28:31], s54 offen lds
  s_add_u32 m0, s61, 31744
  s_add_u32 s54, s62, 571392
  buffer_load_dwordx4 v207, s[28:31], s54 offen lds
  s_add_u32 m0, s61, 32768
  s_add_u32 s54, s62, 589824
  buffer_load_dwordx4 v207, s[28:31], s54 offen lds
  s_add_u32 m0, s61, 33792
  s_add_u32 s54, s62, 608256
  buffer_load_dwordx4 v207, s[28:31], s54 offen lds
  s_add_u32 m0, s61, 34816
  s_add_u32 s54, s62, 626688
  buffer_load_dwordx4 v207, s[28:31], s54 offen lds
  s_add_u32 m0, s61, 35840
  s_add_u32 s54, s62, 645120
  buffer_load_dwordx4 v207, s[28:31], s54 offen lds
  s_add_u32 m0, s61, 36864
  s_add_u32 s54, s62, 663552
  buffer_load_dwordx4 v207, s[28:31], s54 offen lds
  s_add_u32 m0, s61, 37888
  s_add_u32 s54, s62, 681984
  buffer_load_dwordx4 v207, s[28:31], s54 offen lds
  s_waitcnt vmcnt(36) lgkmcnt(0)
  s_add_u32 m0, s61, 38912
  s_add_u32 s54, s62, 700416
  buffer_load_dwordx4 v207, s[28:31], s54 offen lds
  s_add_u32 m0, s61, 39936
  s_add_u32 s54, s62, 718848
  buffer_load_dwordx4 v207, s[28:31], s54 offen lds
  ds_read_b64_tr_b16 a[0:1], v209 offset:0
  ds_read_b64_tr_b16 a[2:3], v209 offset:512
  ds_read_b64_tr_b16 a[4:5], v209 offset:8
  ds_read_b64_tr_b16 a[6:7], v209 offset:520
  s_waitcnt vmcnt(36) lgkmcnt(0)
  s_add_u32 m0, s61, 0
  s_add_u32 s54, s62, 737280
  buffer_load_dwordx4 v207, s[28:31], s54 offen lds
  s_add_u32 m0, s61, 1024
  s_add_u32 s54, s62, 755712
  buffer_load_dwordx4 v207, s[28:31], s54 offen lds
  ds_read_b64_tr_b16 a[8:9], v209 offset:2048
  ds_read_b64_tr_b16 a[10:11], v209 offset:2560
  ds_read_b64_tr_b16 a[12:13], v209 offset:2056
  ds_read_b64_tr_b16 a[14:15], v209 offset:2568
  s_waitcnt vmcnt(36) lgkmcnt(0)
  s_add_u32 m0, s61, 2048
  s_add_u32 s54, s62, 774144
  buffer_load_dwordx4 v207, s[28:31], s54 offen lds
  s_add_u32 m0, s61, 3072
  s_add_u32 s54, s62, 792576
  buffer_load_dwordx4 v207, s[28:31], s54 offen lds
  ds_read_b64_tr_b16 a[16:17], v209 offset:4096
  ds_read_b64_tr_b16 a[18:19], v209 offset:4608
  ds_read_b64_tr_b16 a[20:21], v209 offset:4104
  ds_read_b64_tr_b16 a[22:23], v209 offset:4616
  s_waitcnt vmcnt(36) lgkmcnt(0)
  s_add_u32 m0, s61, 4096
  s_add_u32 s54, s62, 811008
  buffer_load_dwordx4 v207, s[28:31], s54 offen lds
  s_add_u32 m0, s61, 5120
  s_add_u32 s54, s62, 829440
  buffer_load_dwordx4 v207, s[28:31], s54 offen lds
  ds_read_b64_tr_b16 a[24:25], v209 offset:6144
  ds_read_b64_tr_b16 a[26:27], v209 offset:6656
  ds_read_b64_tr_b16 a[28:29], v209 offset:6152
  ds_read_b64_tr_b16 a[30:31], v209 offset:6664
  s_waitcnt vmcnt(36) lgkmcnt(0)
  s_add_u32 m0, s61, 6144
  s_add_u32 s54, s62, 847872
  buffer_load_dwordx4 v207, s[28:31], s54 offen lds
  s_add_u32 m0, s61, 7168
  s_add_u32 s54, s62, 866304
  buffer_load_dwordx4 v207, s[28:31], s54 offen lds
  ds_read_b64_tr_b16 a[32:33], v209 offset:8192
  ds_read_b64_tr_b16 a[34:35], v209 offset:8704
  ds_read_b64_tr_b16 a[36:37], v209 offset:8200
  ds_read_b64_tr_b16 a[38:39], v209 offset:8712
  s_waitcnt vmcnt(36) lgkmcnt(0)
  s_add_u32 m0, s61, 8192
  s_add_u32 s54, s62, 884736
  buffer_load_dwordx4 v207, s[28:31], s54 offen lds
  s_add_u32 m0, s61, 9216
  s_add_u32 s54, s62, 903168
  buffer_load_dwordx4 v207, s[28:31], s54 offen lds
  ds_read_b64_tr_b16 a[40:41], v209 offset:10240
  ds_read_b64_tr_b16 a[42:43], v209 offset:10752
  ds_read_b64_tr_b16 a[44:45], v209 offset:10248
  ds_read_b64_tr_b16 a[46:47], v209 offset:10760
  s_waitcnt vmcnt(36) lgkmcnt(0)
  s_add_u32 m0, s61, 10240
  s_add_u32 s54, s62, 921600
  buffer_load_dwordx4 v207, s[28:31], s54 offen lds
  s_add_u32 m0, s61, 11264
  s_add_u32 s54, s62, 940032
  buffer_load_dwordx4 v207, s[28:31], s54 offen lds
  ds_read_b64_tr_b16 a[48:49], v209 offset:12288
  ds_read_b64_tr_b16 a[50:51], v209 offset:12800
  ds_read_b64_tr_b16 a[52:53], v209 offset:12296
  ds_read_b64_tr_b16 a[54:55], v209 offset:12808
  s_waitcnt vmcnt(36) lgkmcnt(0)
  s_add_u32 m0, s61, 12288
  s_add_u32 s54, s62, 958464
  buffer_load_dwordx4 v207, s[28:31], s54 offen lds
  s_add_u32 m0, s61, 13312
  s_add_u32 s54, s62, 976896
  buffer_load_dwordx4 v207, s[28:31], s54 offen lds
  ds_read_b64_tr_b16 a[56:57], v209 offset:14336
  ds_read_b64_tr_b16 a[58:59], v209 offset:14848
  ds_read_b64_tr_b16 a[60:61], v209 offset:14344
  ds_read_b64_tr_b16 a[62:63], v209 offset:14856
  s_waitcnt vmcnt(36) lgkmcnt(0)
  s_add_u32 m0, s61, 14336
  s_add_u32 s54, s62, 995328
  buffer_load_dwordx4 v207, s[28:31], s54 offen lds
  s_add_u32 m0, s61, 15360
  s_add_u32 s54, s62, 1013760
  buffer_load_dwordx4 v207, s[28:31], s54 offen lds
  ds_read_b64_tr_b16 a[64:65], v209 offset:16384
  ds_read_b64_tr_b16 a[66:67], v209 offset:16896
  ds_read_b64_tr_b16 a[68:69], v209 offset:16392
  ds_read_b64_tr_b16 a[70:71], v209 offset:16904
  s_waitcnt vmcnt(36) lgkmcnt(0)
  s_add_u32 m0, s61, 16384
  s_add_u32 s54, s62, 1032192
  buffer_load_dwordx4 v207, s[28:31], s54 offen lds
  s_add_u32 m0, s61, 17408
  s_add_u32 s54, s62, 1050624
  buffer_load_dwordx4 v207, s[28:31], s54 offen lds
  ds_read_b64_tr_b16 a[72:73], v209 offset:18432
  ds_read_b64_tr_b16 a[74:75], v209 offset:18944
  ds_read_b64_tr_b16 a[76:77], v209 offset:18440
  ds_read_b64_tr_b16 a[78:79], v209 offset:18952
  s_waitcnt vmcnt(36) lgkmcnt(0)
  s_add_u32 m0, s61, 18432
  s_add_u32 s54, s62, 1069056
  buffer_load_dwordx4 v207, s[28:31], s54 offen lds
  s_add_u32 m0, s61, 19456
  s_add_u32 s54, s62, 1087488
  buffer_load_dwordx4 v207, s[28:31], s54 offen lds
  ds_read_b64_tr_b16 a[80:81], v209 offset:20480
  ds_read_b64_tr_b16 a[82:83], v209 offset:20992
  ds_read_b64_tr_b16 a[84:85], v209 offset:20488
  ds_read_b64_tr_b16 a[86:87], v209 offset:21000
  s_waitcnt vmcnt(36) lgkmcnt(0)
  s_add_u32 m0, s61, 20480
  s_add_u32 s54, s62, 1105920
  buffer_load_dwordx4 v207, s[28:31], s54 offen lds
  s_add_u32 m0, s61, 21504
  s_add_u32 s54, s62, 1124352
  buffer_load_dwordx4 v207, s[28:31], s54 offen lds
  ds_read_b64_tr_b16 a[88:89], v209 offset:22528
  ds_read_b64_tr_b16 a[90:91], v209 offset:23040
  ds_read_b64_tr_b16 a[92:93], v209 offset:22536
  ds_read_b64_tr_b16 a[94:95], v209 offset:23048
  s_waitcnt vmcnt(36) lgkmcnt(0)
  s_add_u32 m0, s61, 22528
  s_add_u32 s54, s62, 1142784
  buffer_load_dwordx4 v207, s[28:31], s54 offen lds
  s_add_u32 m0, s61, 23552
  s_add_u32 s54, s62, 1161216
  buffer_load_dwordx4 v207, s[28:31], s54 offen lds
  ds_read_b64_tr_b16 a[96:97], v209 offset:24576
  ds_read_b64_tr_b16 a[98:99], v209 offset:25088
  ds_read_b64_tr_b16 a[100:101], v209 offset:24584
  ds_read_b64_tr_b16 a[102:103], v209 offset:25096
  s_waitcnt vmcnt(36) lgkmcnt(0)
  s_add_u32 m0, s61, 24576
  s_add_u32 s54, s63, 0
  buffer_load_dwordx4 v207, s[40:43], s54 offen lds
  s_add_u32 m0, s61, 25600
  s_add_u32 s54, s63, 18432
  buffer_load_dwordx4 v207, s[40:43], s54 offen lds
  ds_read_b64_tr_b16 a[104:105], v209 offset:26624
  ds_read_b64_tr_b16 a[106:107], v209 offset:27136
  ds_read_b64_tr_b16 a[108:109], v209 offset:26632
  ds_read_b64_tr_b16 a[110:111], v209 offset:27144
  s_waitcnt vmcnt(36) lgkmcnt(0)
  s_add_u32 m0, s61, 26624
  s_add_u32 s54, s63, 36864
  buffer_load_dwordx4 v207, s[40:43], s54 offen lds
  s_add_u32 m0, s61, 27648
  s_add_u32 s54, s63, 55296
  buffer_load_dwordx4 v207, s[40:43], s54 offen lds
  ds_read_b64_tr_b16 a[112:113], v209 offset:28672
  ds_read_b64_tr_b16 a[114:115], v209 offset:29184
  ds_read_b64_tr_b16 a[116:117], v209 offset:28680
  ds_read_b64_tr_b16 a[118:119], v209 offset:29192
  s_waitcnt vmcnt(36) lgkmcnt(0)
  s_add_u32 m0, s61, 28672
  s_add_u32 s54, s63, 73728
  buffer_load_dwordx4 v207, s[40:43], s54 offen lds
  s_add_u32 m0, s61, 29696
  s_add_u32 s54, s63, 92160
  buffer_load_dwordx4 v207, s[40:43], s54 offen lds
  ds_read_b64_tr_b16 a[120:121], v209 offset:30720
  ds_read_b64_tr_b16 a[122:123], v209 offset:31232
  ds_read_b64_tr_b16 a[124:125], v209 offset:30728
  ds_read_b64_tr_b16 a[126:127], v209 offset:31240
  s_waitcnt vmcnt(36) lgkmcnt(0)
  s_add_u32 m0, s61, 30720
  s_add_u32 s54, s63, 110592
  buffer_load_dwordx4 v207, s[40:43], s54 offen lds
  s_add_u32 m0, s61, 31744
  s_add_u32 s54, s63, 129024
  buffer_load_dwordx4 v207, s[40:43], s54 offen lds
  ds_read_b64_tr_b16 a[128:129], v209 offset:32768
  ds_read_b64_tr_b16 a[130:131], v209 offset:33280
  ds_read_b64_tr_b16 a[132:133], v209 offset:32776
  ds_read_b64_tr_b16 a[134:135], v209 offset:33288
  s_waitcnt vmcnt(36) lgkmcnt(0)
  s_add_u32 m0, s61, 32768
  s_add_u32 s54, s63, 147456
  buffer_load_dwordx4 v207, s[40:43], s54 offen lds
  s_add_u32 m0, s61, 33792
  s_add_u32 s54, s63, 165888
  buffer_load_dwordx4 v207, s[40:43], s54 offen lds
  ds_read_b64_tr_b16 a[136:137], v209 offset:34816
  ds_read_b64_tr_b16 a[138:139], v209 offset:35328
  ds_read_b64_tr_b16 a[140:141], v209 offset:34824
  ds_read_b64_tr_b16 a[142:143], v209 offset:35336
  s_waitcnt vmcnt(36) lgkmcnt(0)
  ds_read_b64_tr_b16 a[144:145], v209 offset:36864
  ds_read_b64_tr_b16 a[146:147], v209 offset:37376
  ds_read_b64_tr_b16 a[148:149], v209 offset:36872
  ds_read_b64_tr_b16 a[150:151], v209 offset:37384
  s_waitcnt vmcnt(34) lgkmcnt(0)
  ds_read_b64_tr_b16 a[152:153], v209 offset:38912
  ds_read_b64_tr_b16 a[154:155], v209 offset:39424
  ds_read_b64_tr_b16 a[156:157], v209 offset:38920
  ds_read_b64_tr_b16 a[158:159], v209 offset:39432
  s_waitcnt vmcnt(32) lgkmcnt(0)
  ds_read_b64_tr_b16 a[160:161], v209 offset:0
  ds_read_b64_tr_b16 a[162:163], v209 offset:512
  ds_read_b64_tr_b16 a[164:165], v209 offset:8
  ds_read_b64_tr_b16 a[166:167], v209 offset:520
  s_waitcnt vmcnt(30) lgkmcnt(0)
  ds_read_b64_tr_b16 a[168:169], v209 offset:2048
  ds_read_b64_tr_b16 a[170:171], v209 offset:2560
  ds_read_b64_tr_b16 a[172:173], v209 offset:2056
  ds_read_b64_tr_b16 a[174:175], v209 offset:2568
  s_waitcnt vmcnt(28) lgkmcnt(0)
  ds_read_b64_tr_b16 a[176:177], v209 offset:4096
  ds_read_b64_tr_b16 a[178:179], v209 offset:4608
  ds_read_b64_tr_b16 a[180:181], v209 offset:4104
  ds_read_b64_tr_b16 a[182:183], v209 offset:4616
  s_waitcnt vmcnt(26) lgkmcnt(0)
  ds_read_b64_tr_b16 a[184:185], v209 offset:6144
  ds_read_b64_tr_b16 a[186:187], v209 offset:6656
  ds_read_b64_tr_b16 a[188:189], v209 offset:6152
  ds_read_b64_tr_b16 a[190:191], v209 offset:6664
  s_waitcnt vmcnt(24) lgkmcnt(0)
  ds_read_b64_tr_b16 a[192:193], v209 offset:8192
  ds_read_b64_tr_b16 a[194:195], v209 offset:8704
  ds_read_b64_tr_b16 a[196:197], v209 offset:8200
  ds_read_b64_tr_b16 a[198:199], v209 offset:8712
  s_waitcnt vmcnt(22) lgkmcnt(0)
  ds_read_b64_tr_b16 a[200:201], v209 offset:10240
  ds_read_b64_tr_b16 a[202:203], v209 offset:10752
  ds_read_b64_tr_b16 a[204:205], v209 offset:10248
  ds_read_b64_tr_b16 a[206:207], v209 offset:10760
  s_waitcnt vmcnt(20) lgkmcnt(0)
  ds_read_b64_tr_b16 a[208:209], v209 offset:12288
  ds_read_b64_tr_b16 a[210:211], v209 offset:12800
  ds_read_b64_tr_b16 a[212:213], v209 offset:12296
  ds_read_b64_tr_b16 a[214:215], v209 offset:12808
  s_waitcnt vmcnt(18) lgkmcnt(0)
  ds_read_b64_tr_b16 a[216:217], v209 offset:14336
  ds_read_b64_tr_b16 a[218:219], v209 offset:14848
  ds_read_b64_tr_b16 a[220:221], v209 offset:14344
  ds_read_b64_tr_b16 a[222:223], v209 offset:14856
  s_waitcnt vmcnt(16) lgkmcnt(0)
  ds_read_b64_tr_b16 a[224:225], v209 offset:16384
  ds_read_b64_tr_b16 a[226:227], v209 offset:16896
  ds_read_b64_tr_b16 a[228:229], v209 offset:16392
  ds_read_b64_tr_b16 a[230:231], v209 offset:16904
  s_waitcnt vmcnt(14) lgkmcnt(0)
  ds_read_b64_tr_b16 a[232:233], v209 offset:18432
  ds_read_b64_tr_b16 a[234:235], v209 offset:18944
  ds_read_b64_tr_b16 a[236:237], v209 offset:18440
  ds_read_b64_tr_b16 a[238:239], v209 offset:18952
  s_waitcnt vmcnt(12) lgkmcnt(0)
  ds_read_b64_tr_b16 a[240:241], v209 offset:20480
  ds_read_b64_tr_b16 a[242:243], v209 offset:20992
  ds_read_b64_tr_b16 a[244:245], v209 offset:20488
  ds_read_b64_tr_b16 a[246:247], v209 offset:21000
  s_waitcnt vmcnt(10) lgkmcnt(0)
  ds_read_b64_tr_b16 a[248:249], v209 offset:22528
  ds_read_b64_tr_b16 a[250:251], v209 offset:23040
  ds_read_b64_tr_b16 a[252:253], v209 offset:22536
  ds_read_b64_tr_b16 a[254:255], v209 offset:23048
  s_waitcnt vmcnt(8) lgkmcnt(0)
  ds_read_b64_tr_b16 v[216:217], v210 offset:24576
  ds_read_b64_tr_b16 v[218:219], v210 offset:24832
  ds_read_b64_tr_b16 v[220:221], v210 offset:24584
  ds_read_b64_tr_b16 v[222:223], v210 offset:24840
  s_waitcnt vmcnt(6) lgkmcnt(0)
  ds_read_b64_tr_b16 v[224:225], v210 offset:26624
  ds_read_b64_tr_b16 v[226:227], v210 offset:26880
  ds_read_b64_tr_b16 v[228:229], v210 offset:26632
  ds_read_b64_tr_b16 v[230:231], v210 offset:26888
  s_waitcnt vmcnt(4) lgkmcnt(0)
  ds_read_b64_tr_b16 v[232:233], v210 offset:28672
  ds_read_b64_tr_b16 v[234:235], v210 offset:28928
  ds_read_b64_tr_b16 v[236:237], v210 offset:28680
  ds_read_b64_tr_b16 v[238:239], v210 offset:28936
  s_waitcnt vmcnt(2) lgkmcnt(0)
  ds_read_b64_tr_b16 v[240:241], v210 offset:30720
  ds_read_b64_tr_b16 v[242:243], v210 offset:30976
  ds_read_b64_tr_b16 v[244:245], v210 offset:30728
  ds_read_b64_tr_b16 v[246:247], v210 offset:30984
  s_waitcnt vmcnt(0) lgkmcnt(0)
  ds_read_b64_tr_b16 v[248:249], v210 offset:32768
  ds_read_b64_tr_b16 v[250:251], v210 offset:33024
  ds_read_b64_tr_b16 v[252:253], v210 offset:32776
  ds_read_b64_tr_b16 v[254:255], v210 offset:33032
  v_and_b32 v211, 15, v200
  s_lshl_b32 s54, s69, 4
  v_add_u32 v211, s54, v211
  v_lshl_add_u32 v212, v214, 5, v211
  v_lshlrev_b32 v164, 4, v212
  v_lshrrev_b32 v212, 5, v200
  v_lshl_add_u32 v164, v212, 10, v164
  v_mul_u32_u24 v167, 1152, v211
  v_lshl_add_u32 v167, v213, 4, v167
  v_lshlrev_b32 v166, 2, v211
  v_mul_u32_u24 v211, 144, v211
  s_mul_i32 s54, s52, 20
  s_mov_b32 s55, 294768
  v_mov_b32 v214, 0x40000000
  v_add_u32 v212, s54, v213
  v_add_u32 v212, 0, v212
  v_mul_u32_u24 v176, 57, v212
  v_lshrrev_b32 v176, 9, v176
  v_mul_lo_u32 v176, v176, s55
  v_lshl_add_u32 v176, v212, 4, v176
  v_add_u32 v176, v176, v211
  v_cmp_lt_u32 vcc, 71, v212
  s_nop 1
  v_cndmask_b32 v176, v176, v214, vcc
  v_add_u32 v212, s54, v213
  v_add_u32 v212, 4, v212
  v_mul_u32_u24 v177, 57, v212
  v_lshrrev_b32 v177, 9, v177
  v_mul_lo_u32 v177, v177, s55
  v_lshl_add_u32 v177, v212, 4, v177
  v_add_u32 v177, v177, v211
  v_cmp_lt_u32 vcc, 71, v212
  s_nop 1
  v_cndmask_b32 v177, v177, v214, vcc
  v_add_u32 v212, s54, v213
  v_add_u32 v212, 8, v212
  v_mul_u32_u24 v178, 57, v212
  v_lshrrev_b32 v178, 9, v178
  v_mul_lo_u32 v178, v178, s55
  v_lshl_add_u32 v178, v212, 4, v178
  v_add_u32 v178, v178, v211
  v_cmp_lt_u32 vcc, 71, v212
  s_nop 1
  v_cndmask_b32 v178, v178, v214, vcc
  v_add_u32 v212, s54, v213
  v_add_u32 v212, 12, v212
  v_mul_u32_u24 v179, 57, v212
  v_lshrrev_b32 v179, 9, v179
  v_mul_lo_u32 v179, v179, s55
  v_lshl_add_u32 v179, v212, 4, v179
  v_add_u32 v179, v179, v211
  v_cmp_lt_u32 vcc, 71, v212
  s_nop 1
  v_cndmask_b32 v179, v179, v214, vcc
  v_add_u32 v212, s54, v213
  v_add_u32 v212, 16, v212
  v_mul_u32_u24 v180, 57, v212
  v_lshrrev_b32 v180, 9, v180
  v_mul_lo_u32 v180, v180, s55
  v_lshl_add_u32 v180, v212, 4, v180
  v_add_u32 v180, v180, v211
  v_cmp_lt_u32 vcc, 71, v212
  s_nop 1
  v_cndmask_b32 v180, v180, v214, vcc
  v_lshlrev_b32 v208, 2, v200
  s_lshl_b32 s54, s52, 11
  v_add_u32 v168, s54, v201
  s_mov_b32 s59, s68
  s_mov_b32 s56, 128
  s_mov_b32 s57, 36
  s_waitcnt lgkmcnt(0)
  s_cmp_eq_u32 s52, 0
  s_cbranch_scc0 O_p1_d
  s_mov_b32 exec_hi, 0
  s_mov_b32 exec_lo, -1
O_p1:
  buffer_load_dword v211, v208, s[12:15], s56 offen sc1
  s_add_u32 s65, s65, 1
  s_waitcnt vmcnt(0)
  v_cmp_gt_u32 vcc, 0x700, v211
  s_cbranch_vccz O_p1_x
  s_sleep 16
  s_cmp_lt_u32 s65, 131072
  s_cbranch_scc1 O_p1
O_p1_x:
  s_mov_b64 exec, -1
O_p1_d:
  s_barrier
  s_cmp_eq_u32 s52, 0
  s_cbranch_scc0 O_a_d
  s_mov_b32 exec_hi, 0
  s_mov_b32 exec_lo, 1
O_a:
  buffer_load_dword v211, v208, s[12:15], s57 offen sc1
  s_add_u32 s65, s65, 1
  s_waitcnt vmcnt(0)
  v_cmp_gt_u32 vcc, 0x80, v211
  s_cbranch_vccz O_a_x
  s_sleep 16
  s_cmp_lt_u32 s65, 131072
  s_cbranch_scc1 O_a
O_a_x:
  s_mov_b64 exec, -1
O_a_d:
  s_barrier
  s_cmp_ge_u32 s70, 9
  s_cselect_b32 s54, 9, 0
  s_sub_u32 s54, s70, s54
  s_and_b32 s54, s54, 7
  s_lshl_b32 s54, s54, 13
  s_lshl_b32 s55, s69, 8
  s_add_u32 s54, s54, s55
  v_lshrrev_b32 v211, 2, v200
  v_lshl_add_u32 v172, v211, 9, s54
  v_and_b32 v211, 3, v200
  v_lshl_add_u32 v172, v211, 6, v172
  s_mul_i32 s55, s59, 4608
  s_add_u32 s55, s55, 62914560
  buffer_load_dwordx4 v[128:131], v176, s[8:11], s55 offen sc1
  buffer_load_dwordx4 v[132:135], v177, s[8:11], s55 offen sc1
  buffer_load_dwordx4 v[136:139], v178, s[8:11], s55 offen sc1
  buffer_load_dwordx4 v[140:143], v179, s[8:11], s55 offen sc1
  buffer_load_dwordx4 v[144:147], v180, s[8:11], s55 offen sc1
  s_lshl_b32 s55, s59, 7
  s_add_u32 s55, s55, 66060288
  buffer_load_dword v171, v166, s[8:11], s55 offen sc1
  v_mov_b32 v169, 0
  v_lshlrev_b32 v208, 8, v200
  s_mov_b32 s66, 393216
  s_waitcnt vmcnt(0)
O_loop:
  v_mfma_f32_16x16x32_bf16 v[156:159], v[216:219], v[128:131], 0
  v_mfma_f32_16x16x32_bf16 v[160:163], v[220:223], v[128:131], 0
  v_mfma_f32_16x16x32_bf16 v[156:159], v[224:227], v[132:135], v[156:159]
  v_mfma_f32_16x16x32_bf16 v[160:163], v[228:231], v[132:135], v[160:163]
  v_mfma_f32_16x16x32_bf16 v[156:159], v[232:235], v[136:139], v[156:159]
  v_mfma_f32_16x16x32_bf16 v[160:163], v[236:239], v[136:139], v[160:163]
  v_mfma_f32_16x16x32_bf16 v[156:159], v[240:243], v[140:143], v[156:159]
  v_mfma_f32_16x16x32_bf16 v[160:163], v[244:247], v[140:143], v[160:163]
  v_mfma_f32_16x16x32_bf16 v[156:159], v[248:251], v[144:147], v[156:159]
  v_mfma_f32_16x16x32_bf16 v[160:163], v[252:255], v[144:147], v[160:163]
  s_mul_i32 s64, s59, 36864
  s_lshl_b32 s54, s70, 6
  s_add_u32 s64, s64, s54
  s_add_u32 s71, s59, 2
  s_lshl_b32 s55, s59, 18
  s_lshl_b32 s54, s52, 16
  s_add_u32 s55, s55, s54
  s_add_u32 s63, s55, 46137344
  s_and_b32 s54, s59, 1
  s_lshl_b32 s54, s54, 2
  s_add_u32 s54, s54, s52
  s_lshl_b32 s54, s54, 3
  s_lshl_b64 s[72:73], 0xff, s54
  v_sub_f32 v165, 1.0, v171
  v_cvt_pk_bf16_f32 v165, v165, v165
  v_lshlrev_b32 v165, 16, v165
  v_mul_f32 v156, v171, v156
  v_mul_f32 v157, v171, v157
  v_mul_f32 v158, v171, v158
  v_mul_f32 v159, v171, v159
  v_mul_f32 v160, v171, v160
  v_mul_f32 v161, v171, v161
  v_mul_f32 v162, v171, v162
  v_mul_f32 v163, v171, v163
  s_branch O_pc
O_pl:
  s_sleep 1
  s_mov_b64 exec, s[72:73]
  buffer_load_dword v169, v208, s[8:11], s66 offen sc1
  s_mov_b64 exec, -1
  s_add_u32 s65, s65, 1
  s_cmp_ge_u32 s65, 131072
  s_cbranch_scc1 O_ld
  s_waitcnt vmcnt(0)
O_pc:
  v_cmp_gt_u32 vcc, s71, v169
  s_nop 0
  s_and_b64 vcc, vcc, s[72:73]
  s_cbranch_scc1 O_pl
O_ld:
  s_mov_b32 s62, s63
  buffer_load_dwordx4 v[0:3], v164, s[8:11], s62 offen offset:0 sc1
  buffer_load_dwordx4 v[4:7], v164, s[8:11], s62 offen offset:2048 sc1
  s_add_u32 s62, s62, 4096
  buffer_load_dwordx4 v[8:11], v164, s[8:11], s62 offen offset:0 sc1
  buffer_load_dwordx4 v[12:15], v164, s[8:11], s62 offen offset:2048 sc1
  s_add_u32 s62, s62, 4096
  buffer_load_dwordx4 v[16:19], v164, s[8:11], s62 offen offset:0 sc1
  buffer_load_dwordx4 v[20:23], v164, s[8:11], s62 offen offset:2048 sc1
  s_add_u32 s62, s62, 4096
  buffer_load_dwordx4 v[24:27], v164, s[8:11], s62 offen offset:0 sc1
  buffer_load_dwordx4 v[28:31], v164, s[8:11], s62 offen offset:2048 sc1
  s_add_u32 s62, s62, 4096
  buffer_load_dwordx4 v[32:35], v164, s[8:11], s62 offen offset:0 sc1
  buffer_load_dwordx4 v[36:39], v164, s[8:11], s62 offen offset:2048 sc1
  s_add_u32 s62, s62, 4096
  buffer_load_dwordx4 v[40:43], v164, s[8:11], s62 offen offset:0 sc1
  buffer_load_dwordx4 v[44:47], v164, s[8:11], s62 offen offset:2048 sc1
  s_add_u32 s62, s62, 4096
  buffer_load_dwordx4 v[48:51], v164, s[8:11], s62 offen offset:0 sc1
  buffer_load_dwordx4 v[52:55], v164, s[8:11], s62 offen offset:2048 sc1
  s_add_u32 s62, s62, 4096
  buffer_load_dwordx4 v[56:59], v164, s[8:11], s62 offen offset:0 sc1
  buffer_load_dwordx4 v[60:63], v164, s[8:11], s62 offen offset:2048 sc1
  s_add_u32 s62, s62, 4096
  buffer_load_dwordx4 v[64:67], v164, s[8:11], s62 offen offset:0 sc1
  buffer_load_dwordx4 v[68:71], v164, s[8:11], s62 offen offset:2048 sc1
  s_add_u32 s62, s62, 4096
  buffer_load_dwordx4 v[72:75], v164, s[8:11], s62 offen offset:0 sc1
  buffer_load_dwordx4 v[76:79], v164, s[8:11], s62 offen offset:2048 sc1
  s_add_u32 s62, s62, 4096
  buffer_load_dwordx4 v[80:83], v164, s[8:11], s62 offen offset:0 sc1
  buffer_load_dwordx4 v[84:87], v164, s[8:11], s62 offen offset:2048 sc1
  s_add_u32 s62, s62, 4096
  buffer_load_dwordx4 v[88:91], v164, s[8:11], s62 offen offset:0 sc1
  buffer_load_dwordx4 v[92:95], v164, s[8:11], s62 offen offset:2048 sc1
  s_add_u32 s62, s62, 4096
  buffer_load_dwordx4 v[96:99], v164, s[8:11], s62 offen offset:0 sc1
  buffer_load_dwordx4 v[100:103], v164, s[8:11], s62 offen offset:2048 sc1
  s_add_u32 s62, s62, 4096
  buffer_load_dwordx4 v[104:107], v164, s[8:11], s62 offen offset:0 sc1
  buffer_load_dwordx4 v[108:111], v164, s[8:11], s62 offen offset:2048 sc1
  s_add_u32 s62, s62, 4096
  buffer_load_dwordx4 v[112:115], v164, s[8:11], s62 offen offset:0 sc1
  buffer_load_dwordx4 v[116:119], v164, s[8:11], s62 offen offset:2048 sc1
  s_add_u32 s62, s62, 4096
  buffer_load_dwordx4 v[120:123], v164, s[8:11], s62 offen offset:0 sc1
  buffer_load_dwordx4 v[124:127], v164, s[8:11], s62 offen offset:2048 sc1
  s_add_u32 s62, s62, 4096
  s_add_u32 s57, s59, 3
  s_min_u32 s74, s57, 63
  s_mul_i32 s55, s74, 4608
  s_add_u32 s55, s55, 62914560
  buffer_load_dwordx4 v[128:131], v176, s[8:11], s55 offen sc1
  buffer_load_dwordx4 v[132:135], v177, s[8:11], s55 offen sc1
  buffer_load_dwordx4 v[136:139], v178, s[8:11], s55 offen sc1
  buffer_load_dwordx4 v[140:143], v179, s[8:11], s55 offen sc1
  buffer_load_dwordx4 v[144:147], v180, s[8:11], s55 offen sc1
  s_lshl_b32 s55, s74, 7
  s_add_u32 s55, s55, 66060288
  buffer_load_dword v171, v166, s[8:11], s55 offen sc1
  s_add_u32 s65, s65, 1
  s_cmp_lt_u32 s65, 131072
  s_cselect_b32 s54, -2, -1
  s_waitcnt vmcnt(37)
  v_mfma_f32_16x16x32_bf16 v[148:151], a[0:3], v[0:3], 0
  v_mfma_f32_16x16x32_bf16 v[152:155], a[4:7], v[0:3], 0
  v_max3_u32 v170, v0, v1, v0
  v_max3_u32 v170, v2, v3, v170
  s_waitcnt vmcnt(36)
  v_mfma_f32_16x16x32_bf16 v[148:151], a[8:11], v[4:7], v[148:151]
  v_mfma_f32_16x16x32_bf16 v[152:155], a[12:15], v[4:7], v[152:155]
  v_max3_u32 v170, v4, v5, v170
  v_max3_u32 v170, v6, v7, v170
  s_waitcnt vmcnt(35)
  v_mfma_f32_16x16x32_bf16 v[148:151], a[16:19], v[8:11], v[148:151]
  v_mfma_f32_16x16x32_bf16 v[152:155], a[20:23], v[8:11], v[152:155]
  v_max3_u32 v170, v8, v9, v170
  v_max3_u32 v170, v10, v11, v170
  s_waitcnt vmcnt(34)
  v_mfma_f32_16x16x32_bf16 v[148:151], a[24:27], v[12:15], v[148:151]
  v_mfma_f32_16x16x32_bf16 v[152:155], a[28:31], v[12:15], v[152:155]
  v_max3_u32 v170, v12, v13, v170
  v_max3_u32 v170, v14, v15, v170
  s_waitcnt vmcnt(33)
  v_mfma_f32_16x16x32_bf16 v[148:151], a[32:35], v[16:19], v[148:151]
  v_mfma_f32_16x16x32_bf16 v[152:155], a[36:39], v[16:19], v[152:155]
  v_max3_u32 v170, v16, v17, v170
  v_max3_u32 v170, v18, v19, v170
  s_waitcnt vmcnt(32)
  v_mfma_f32_16x16x32_bf16 v[148:151], a[40:43], v[20:23], v[148:151]
  v_mfma_f32_16x16x32_bf16 v[152:155], a[44:47], v[20:23], v[152:155]
  v_max3_u32 v170, v20, v21, v170
  v_max3_u32 v170, v22, v23, v170
  s_waitcnt vmcnt(31)
  v_mfma_f32_16x16x32_bf16 v[148:151], a[48:51], v[24:27], v[148:151]
  v_mfma_f32_16x16x32_bf16 v[152:155], a[52:55], v[24:27], v[152:155]
  v_max3_u32 v170, v24, v25, v170
  v_max3_u32 v170, v26, v27, v170
  s_waitcnt vmcnt(30)
  v_mfma_f32_16x16x32_bf16 v[148:151], a[56:59], v[28:31], v[148:151]
  v_mfma_f32_16x16x32_bf16 v[152:155], a[60:63], v[28:31], v[152:155]
  v_max3_u32 v170, v28, v29, v170
  v_max3_u32 v170, v30, v31, v170
  s_waitcnt vmcnt(29)
  v_mfma_f32_16x16x32_bf16 v[148:151], a[64:67], v[32:35], v[148:151]
  v_mfma_f32_16x16x32_bf16 v[152:155], a[68:71], v[32:35], v[152:155]
  v_max3_u32 v170, v32, v33, v170
  v_max3_u32 v170, v34, v35, v170
  s_waitcnt vmcnt(28)
  v_mfma_f32_16x16x32_bf16 v[148:151], a[72:75], v[36:39], v[148:151]
  v_mfma_f32_16x16x32_bf16 v[152:155], a[76:79], v[36:39], v[152:155]
  v_max3_u32 v170, v36, v37, v170
  v_max3_u32 v170, v38, v39, v170
  s_waitcnt vmcnt(27)
  v_mfma_f32_16x16x32_bf16 v[148:151], a[80:83], v[40:43], v[148:151]
  v_mfma_f32_16x16x32_bf16 v[152:155], a[84:87], v[40:43], v[152:155]
  v_max3_u32 v170, v40, v41, v170
  v_max3_u32 v170, v42, v43, v170
  s_waitcnt vmcnt(26)
  v_mfma_f32_16x16x32_bf16 v[148:151], a[88:91], v[44:47], v[148:151]
  v_mfma_f32_16x16x32_bf16 v[152:155], a[92:95], v[44:47], v[152:155]
  v_max3_u32 v170, v44, v45, v170
  v_max3_u32 v170, v46, v47, v170
  s_waitcnt vmcnt(25)
  v_mfma_f32_16x16x32_bf16 v[148:151], a[96:99], v[48:51], v[148:151]
  v_mfma_f32_16x16x32_bf16 v[152:155], a[100:103], v[48:51], v[152:155]
  v_max3_u32 v170, v48, v49, v170
  v_max3_u32 v170, v50, v51, v170
  s_waitcnt vmcnt(24)
  v_mfma_f32_16x16x32_bf16 v[148:151], a[104:107], v[52:55], v[148:151]
  v_mfma_f32_16x16x32_bf16 v[152:155], a[108:111], v[52:55], v[152:155]
  v_max3_u32 v170, v52, v53, v170
  v_max3_u32 v170, v54, v55, v170
  s_waitcnt vmcnt(23)
  v_mfma_f32_16x16x32_bf16 v[148:151], a[112:115], v[56:59], v[148:151]
  v_mfma_f32_16x16x32_bf16 v[152:155], a[116:119], v[56:59], v[152:155]
  v_max3_u32 v170, v56, v57, v170
  v_max3_u32 v170, v58, v59, v170
  s_waitcnt vmcnt(22)
  v_mfma_f32_16x16x32_bf16 v[148:151], a[120:123], v[60:63], v[148:151]
  v_mfma_f32_16x16x32_bf16 v[152:155], a[124:127], v[60:63], v[152:155]
  v_max3_u32 v170, v60, v61, v170
  v_max3_u32 v170, v62, v63, v170
  s_waitcnt vmcnt(21)
  v_mfma_f32_16x16x32_bf16 v[148:151], a[128:131], v[64:67], v[148:151]
  v_mfma_f32_16x16x32_bf16 v[152:155], a[132:135], v[64:67], v[152:155]
  v_max3_u32 v170, v64, v65, v170
  v_max3_u32 v170, v66, v67, v170
  s_waitcnt vmcnt(20)
  v_mfma_f32_16x16x32_bf16 v[148:151], a[136:139], v[68:71], v[148:151]
  v_mfma_f32_16x16x32_bf16 v[152:155], a[140:143], v[68:71], v[152:155]
  v_max3_u32 v170, v68, v69, v170
  v_max3_u32 v170, v70, v71, v170
  s_waitcnt vmcnt(19)
  v_mfma_f32_16x16x32_bf16 v[148:151], a[144:147], v[72:75], v[148:151]
  v_mfma_f32_16x16x32_bf16 v[152:155], a[148:151], v[72:75], v[152:155]
  v_max3_u32 v170, v72, v73, v170
  v_max3_u32 v170, v74, v75, v170
  s_waitcnt vmcnt(18)
  v_mfma_f32_16x16x32_bf16 v[148:151], a[152:155], v[76:79], v[148:151]
  v_mfma_f32_16x16x32_bf16 v[152:155], a[156:159], v[76:79], v[152:155]
  v_max3_u32 v170, v76, v77, v170
  v_max3_u32 v170, v78, v79, v170
  s_waitcnt vmcnt(17)
  v_mfma_f32_16x16x32_bf16 v[148:151], a[160:163], v[80:83], v[148:151]
  v_mfma_f32_16x16x32_bf16 v[152:155], a[164:167], v[80:83], v[152:155]
  v_max3_u32 v170, v80, v81, v170
  v_max3_u32 v170, v82, v83, v170
  s_waitcnt vmcnt(16)
  v_mfma_f32_16x16x32_bf16 v[148:151], a[168:171], v[84:87], v[148:151]
  v_mfma_f32_16x16x32_bf16 v[152:155], a[172:175], v[84:87], v[152:155]
  v_max3_u32 v170, v84, v85, v170
  v_max3_u32 v170, v86, v87, v170
  s_waitcnt vmcnt(15)
  v_mfma_f32_16x16x32_bf16 v[148:151], a[176:179], v[88:91], v[148:151]
  v_mfma_f32_16x16x32_bf16 v[152:155], a[180:183], v[88:91], v[152:155]
  v_max3_u32 v170, v88, v89, v170
  v_max3_u32 v170, v90, v91, v170
  s_waitcnt vmcnt(14)
  v_mfma_f32_16x16x32_bf16 v[148:151], a[184:187], v[92:95], v[148:151]
  v_mfma_f32_16x16x32_bf16 v[152:155], a[188:191], v[92:95], v[152:155]
  v_max3_u32 v170, v92, v93, v170
  v_max3_u32 v170, v94, v95, v170
  s_waitcnt vmcnt(13)
  v_mfma_f32_16x16x32_bf16 v[148:151], a[192:195], v[96:99], v[148:151]
  v_mfma_f32_16x16x32_bf16 v[152:155], a[196:199], v[96:99], v[152:155]
  v_max3_u32 v170, v96, v97, v170
  v_max3_u32 v170, v98, v99, v170
  s_waitcnt vmcnt(12)
  v_mfma_f32_16x16x32_bf16 v[148:151], a[200:203], v[100:103], v[148:151]
  v_mfma_f32_16x16x32_bf16 v[152:155], a[204:207], v[100:103], v[152:155]
  v_max3_u32 v170, v100, v101, v170
  v_max3_u32 v170, v102, v103, v170
  s_waitcnt vmcnt(11)
  v_mfma_f32_16x16x32_bf16 v[148:151], a[208:211], v[104:107], v[148:151]
  v_mfma_f32_16x16x32_bf16 v[152:155], a[212:215], v[104:107], v[152:155]
  v_max3_u32 v170, v104, v105, v170
  v_max3_u32 v170, v106, v107, v170
  s_waitcnt vmcnt(10)
  v_mfma_f32_16x16x32_bf16 v[148:151], a[216:219], v[108:111], v[148:151]
  v_mfma_f32_16x16x32_bf16 v[152:155], a[220:223], v[108:111], v[152:155]
  v_max3_u32 v170, v108, v109, v170
  v_max3_u32 v170, v110, v111, v170
  s_waitcnt vmcnt(9)
  v_mfma_f32_16x16x32_bf16 v[148:151], a[224:227], v[112:115], v[148:151]
  v_mfma_f32_16x16x32_bf16 v[152:155], a[228:231], v[112:115], v[152:155]
  v_max3_u32 v170, v112, v113, v170
  v_max3_u32 v170, v114, v115, v170
  s_waitcnt vmcnt(8)
  v_mfma_f32_16x16x32_bf16 v[148:151], a[232:235], v[116:119], v[148:151]
  v_mfma_f32_16x16x32_bf16 v[152:155], a[236:239], v[116:119], v[152:155]
  v_max3_u32 v170, v116, v117, v170
  v_max3_u32 v170, v118, v119, v170
  s_waitcnt vmcnt(7)
  v_mfma_f32_16x16x32_bf16 v[148:151], a[240:243], v[120:123], v[148:151]
  v_mfma_f32_16x16x32_bf16 v[152:155], a[244:247], v[120:123], v[152:155]
  v_max3_u32 v170, v120, v121, v170
  v_max3_u32 v170, v122, v123, v170
  s_waitcnt vmcnt(6)
  v_mfma_f32_16x16x32_bf16 v[148:151], a[248:251], v[124:127], v[148:151]
  v_mfma_f32_16x16x32_bf16 v[152:155], a[252:255], v[124:127], v[152:155]
  v_max3_u32 v170, v124, v125, v170
  v_max3_u32 v170, v126, v127, v170
  v_cmp_lt_u32 vcc, s54, v170
  s_cbranch_vccnz O_ld
  v_fmac_f32 v156, v165, v148
  v_fmac_f32 v157, v165, v149
  v_fmac_f32 v158, v165, v150
  v_fmac_f32 v159, v165, v151
  v_fmac_f32 v160, v165, v152
  v_fmac_f32 v161, v165, v153
  v_fmac_f32 v162, v165, v154
  v_fmac_f32 v163, v165, v155
  ds_write_b128 v168, v[156:159]
  ds_write_b128 v168, v[160:163] offset:1024
  v_xor_b32 v168, 0x2000, v168
  s_mov_b32 s59, s57
  s_waitcnt lgkmcnt(0)
  s_barrier
  s_cmp_eq_u32 s52, 0
  s_cbranch_scc0 O_next
  v_xor_b32 v211, 0x2000, v168
  ds_read_b128 v[0:3], v211 offset:2048
  ds_read_b128 v[4:7], v211 offset:3072
  ds_read_b128 v[8:11], v211 offset:4096
  ds_read_b128 v[12:15], v211 offset:5120
  ds_read_b128 v[16:19], v211 offset:6144
  ds_read_b128 v[20:23], v211 offset:7168
  s_waitcnt lgkmcnt(5)
  v_add_f32 v156, v156, v0
  v_add_f32 v157, v157, v1
  v_add_f32 v158, v158, v2
  v_add_f32 v159, v159, v3
  s_waitcnt lgkmcnt(4)
  v_add_f32 v160, v160, v4
  v_add_f32 v161, v161, v5
  v_add_f32 v162, v162, v6
  v_add_f32 v163, v163, v7
  s_waitcnt lgkmcnt(3)
  v_add_f32 v156, v156, v8
  v_add_f32 v157, v157, v9
  v_add_f32 v158, v158, v10
  v_add_f32 v159, v159, v11
  s_waitcnt lgkmcnt(2)
  v_add_f32 v160, v160, v12
  v_add_f32 v161, v161, v13
  v_add_f32 v162, v162, v14
  v_add_f32 v163, v163, v15
  s_waitcnt lgkmcnt(1)
  v_add_f32 v156, v156, v16
  v_add_f32 v157, v157, v17
  v_add_f32 v158, v158, v18
  v_add_f32 v159, v159, v19
  s_waitcnt lgkmcnt(0)
  v_add_f32 v160, v160, v20
  v_add_f32 v161, v161, v21
  v_add_f32 v162, v162, v22
  v_add_f32 v163, v163, v23
  v_cvt_pk_bf16_f32 v148, v156, v157
  v_cvt_pk_bf16_f32 v149, v158, v159
  v_cvt_pk_bf16_f32 v150, v160, v161
  v_cvt_pk_bf16_f32 v151, v162, v163
  buffer_store_dwordx4 v[148:151], v167, s[48:51], s64 offen sc1
  s_waitcnt vmcnt(1)
  s_branch O_nx2
O_next:
  s_waitcnt vmcnt(0)
O_nx2:
  s_cmp_lt_u32 s59, 64
  s_cbranch_scc1 O_loop
  s_branch L_exit
W_h:
  s_lshr_b32 s58, s53, 1
  s_and_b32 s59, s53, 1
  s_mul_i32 s60, s59, 36864
  s_add_u32 m0, s67, 0
  s_nop 0
  buffer_load_dwordx4 v202, s[4:7], s60 offen offset:0 lds
  s_add_u32 m0, s67, 896
  s_nop 0
  buffer_load_dwordx4 v202, s[4:7], s60 offen offset:128 lds
  s_add_u32 m0, s67, 1792
  s_nop 0
  buffer_load_dwordx4 v202, s[4:7], s60 offen offset:256 lds
  s_add_u32 m0, s67, 2688
  s_nop 0
  buffer_load_dwordx4 v202, s[4:7], s60 offen offset:384 lds
  s_add_u32 m0, s67, 3584
  s_nop 0
  buffer_load_dwordx4 v202, s[4:7], s60 offen offset:512 lds
  s_add_u32 m0, s67, 4480
  s_nop 0
  buffer_load_dwordx4 v202, s[4:7], s60 offen offset:640 lds
  s_add_u32 m0, s67, 5376
  s_nop 0
  buffer_load_dwordx4 v202, s[4:7], s60 offen offset:768 lds
  s_add_u32 m0, s67, 6272
  s_nop 0
  buffer_load_dwordx4 v202, s[4:7], s60 offen offset:896 lds
  s_add_u32 m0, s67, 7168
  s_nop 0
  buffer_load_dwordx4 v202, s[4:7], s60 offen offset:1024 lds
  v_lshrrev_b32 v211, 4, v200
  v_lshlrev_b32 v212, 2, v211
  v_and_b32 v213, 15, v200
  v_xor_b32 v212, v212, v213
  v_lshlrev_b32 v212, 4, v212
  v_lshl_add_u32 v207, v211, 13, v212
  s_lshl_b32 s62, s58, 8
  s_lshl_b32 s54, s52, 15
  s_add_u32 s62, s62, s54
  s_lshl_b32 s61, s52, 10
  s_add_u32 s61, s61, 36864
  s_add_u32 m0, s61, 0
  s_add_u32 s54, s62, 0
  buffer_load_dwordx4 v207, s[16:19], s54 offen lds
  s_add_u32 m0, s61, 4096
  s_add_u32 s54, s62, 131072
  buffer_load_dwordx4 v207, s[16:19], s54 offen lds
  s_add_u32 m0, s61, 8192
  s_add_u32 s54, s62, 262144
  buffer_load_dwordx4 v207, s[16:19], s54 offen lds
  s_add_u32 m0, s61, 12288
  s_add_u32 s54, s62, 393216
  buffer_load_dwordx4 v207, s[16:19], s54 offen lds
  s_add_u32 m0, s61, 16384
  s_add_u32 s54, s62, 524288
  buffer_load_dwordx4 v207, s[16:19], s54 offen lds
  s_add_u32 m0, s61, 20480
  s_add_u32 s54, s62, 655360
  buffer_load_dwordx4 v207, s[16:19], s54 offen lds
  s_add_u32 m0, s61, 24576
  s_add_u32 s54, s62, 786432
  buffer_load_dwordx4 v207, s[16:19], s54 offen lds
  s_add_u32 m0, s61, 28672
  s_add_u32 s54, s62, 917504
  buffer_load_dwordx4 v207, s[16:19], s54 offen lds
  s_add_u32 m0, s61, 32768
  s_add_u32 s54, s62, 1048576
  buffer_load_dwordx4 v207, s[16:19], s54 offen lds
  s_add_u32 m0, s61, 36864
  s_add_u32 s54, s62, 1179648
  buffer_load_dwordx4 v207, s[16:19], s54 offen lds
  s_add_u32 m0, s61, 40960
  s_add_u32 s54, s62, 1310720
  buffer_load_dwordx4 v207, s[16:19], s54 offen lds
  s_add_u32 m0, s61, 45056
  s_add_u32 s54, s62, 1441792
  buffer_load_dwordx4 v207, s[16:19], s54 offen lds
  s_add_u32 m0, s61, 49152
  s_add_u32 s54, s62, 1572864
  buffer_load_dwordx4 v207, s[16:19], s54 offen lds
  s_add_u32 m0, s61, 53248
  s_add_u32 s54, s62, 1703936
  buffer_load_dwordx4 v207, s[16:19], s54 offen lds
  s_add_u32 m0, s61, 57344
  s_add_u32 s54, s62, 1835008
  buffer_load_dwordx4 v207, s[16:19], s54 offen lds
  s_add_u32 m0, s61, 61440
  s_add_u32 s54, s62, 1966080
  buffer_load_dwordx4 v207, s[16:19], s54 offen lds
  s_add_u32 m0, s61, 65536
  s_add_u32 s54, s62, 2097152
  buffer_load_dwordx4 v207, s[16:19], s54 offen lds
  s_add_u32 m0, s61, 69632
  s_add_u32 s54, s62, 2228224
  buffer_load_dwordx4 v207, s[16:19], s54 offen lds
  s_add_u32 m0, s61, 73728
  s_add_u32 s54, s62, 2359296
  buffer_load_dwordx4 v207, s[16:19], s54 offen lds
  s_add_u32 m0, s61, 77824
  s_add_u32 s54, s62, 2490368
  buffer_load_dwordx4 v207, s[16:19], s54 offen lds
  s_add_u32 m0, s61, 81920
  s_add_u32 s54, s62, 2621440
  buffer_load_dwordx4 v207, s[16:19], s54 offen lds
  s_add_u32 m0, s61, 86016
  s_add_u32 s54, s62, 2752512
  buffer_load_dwordx4 v207, s[16:19], s54 offen lds
  s_add_u32 m0, s61, 90112
  s_add_u32 s54, s62, 2883584
  buffer_load_dwordx4 v207, s[16:19], s54 offen lds
  s_add_u32 m0, s61, 94208
  s_add_u32 s54, s62, 3014656
  buffer_load_dwordx4 v207, s[16:19], s54 offen lds
  s_waitcnt vmcnt(20) lgkmcnt(0)
  s_barrier
  s_add_u32 m0, s61, 98304
  s_add_u32 s54, s62, 3145728
  buffer_load_dwordx4 v207, s[16:19], s54 offen lds
  s_add_u32 m0, s61, 102400
  s_add_u32 s54, s62, 3276800
  buffer_load_dwordx4 v207, s[16:19], s54 offen lds
  s_add_u32 m0, s61, 106496
  s_add_u32 s54, s62, 3407872
  buffer_load_dwordx4 v207, s[16:19], s54 offen lds
  s_add_u32 m0, s61, 110592
  s_add_u32 s54, s62, 3538944
  buffer_load_dwordx4 v207, s[16:19], s54 offen lds
  v_add_u32 v215, 36864, v209
  ds_read_b64_tr_b16 a[0:1], v215 offset:0
  ds_read_b64_tr_b16 a[2:3], v215 offset:1024
  ds_read_b64_tr_b16 a[4:5], v215 offset:4096
  ds_read_b64_tr_b16 a[6:7], v215 offset:5120
  ds_read_b64_tr_b16 a[8:9], v215 offset:8192
  ds_read_b64_tr_b16 a[10:11], v215 offset:9216
  ds_read_b64_tr_b16 a[12:13], v215 offset:12288
  ds_read_b64_tr_b16 a[14:15], v215 offset:13312
  s_waitcnt vmcnt(20) lgkmcnt(0)
  s_barrier
  s_add_u32 m0, s61, 0
  s_add_u32 s54, s62, 3670016
  buffer_load_dwordx4 v207, s[16:19], s54 offen lds
  s_add_u32 m0, s61, 4096
  s_add_u32 s54, s62, 3801088
  buffer_load_dwordx4 v207, s[16:19], s54 offen lds
  s_add_u32 m0, s61, 8192
  s_add_u32 s54, s62, 3932160
  buffer_load_dwordx4 v207, s[16:19], s54 offen lds
  s_add_u32 m0, s61, 12288
  s_add_u32 s54, s62, 4063232
  buffer_load_dwordx4 v207, s[16:19], s54 offen lds
  v_add_u32 v215, 53248, v209
  ds_read_b64_tr_b16 a[16:17], v215 offset:0
  ds_read_b64_tr_b16 a[18:19], v215 offset:1024
  ds_read_b64_tr_b16 a[20:21], v215 offset:4096
  ds_read_b64_tr_b16 a[22:23], v215 offset:5120
  ds_read_b64_tr_b16 a[24:25], v215 offset:8192
  ds_read_b64_tr_b16 a[26:27], v215 offset:9216
  ds_read_b64_tr_b16 a[28:29], v215 offset:12288
  ds_read_b64_tr_b16 a[30:31], v215 offset:13312
  s_waitcnt vmcnt(20) lgkmcnt(0)
  s_barrier
  s_add_u32 m0, s61, 16384
  s_add_u32 s54, s62, 4194304
  buffer_load_dwordx4 v207, s[16:19], s54 offen lds
  s_add_u32 m0, s61, 20480
  s_add_u32 s54, s62, 4325376
  buffer_load_dwordx4 v207, s[16:19], s54 offen lds
  s_add_u32 m0, s61, 24576
  s_add_u32 s54, s62, 4456448
  buffer_load_dwordx4 v207, s[16:19], s54 offen lds
  s_add_u32 m0, s61, 28672
  s_add_u32 s54, s62, 4587520
  buffer_load_dwordx4 v207, s[16:19], s54 offen lds
  v_add_u32 v215, 69632, v209
  ds_read_b64_tr_b16 a[32:33], v215 offset:0
  ds_read_b64_tr_b16 a[34:35], v215 offset:1024
  ds_read_b64_tr_b16 a[36:37], v215 offset:4096
  ds_read_b64_tr_b16 a[38:39], v215 offset:5120
  ds_read_b64_tr_b16 a[40:41], v215 offset:8192
  ds_read_b64_tr_b16 a[42:43], v215 offset:9216
  ds_read_b64_tr_b16 a[44:45], v215 offset:12288
  ds_read_b64_tr_b16 a[46:47], v215 offset:13312
  s_waitcnt vmcnt(20) lgkmcnt(0)
  s_barrier
  v_add_u32 v215, 86016, v209
  ds_read_b64_tr_b16 a[48:49], v215 offset:0
  ds_read_b64_tr_b16 a[50:51], v215 offset:1024
  ds_read_b64_tr_b16 a[52:53], v215 offset:4096
  ds_read_b64_tr_b16 a[54:55], v215 offset:5120
  ds_read_b64_tr_b16 a[56:57], v215 offset:8192
  ds_read_b64_tr_b16 a[58:59], v215 offset:9216
  ds_read_b64_tr_b16 a[60:61], v215 offset:12288
  ds_read_b64_tr_b16 a[62:63], v215 offset:13312
  s_waitcnt vmcnt(16) lgkmcnt(0)
  s_barrier
  v_add_u32 v215, 102400, v209
  ds_read_b64_tr_b16 a[64:65], v215 offset:0
  ds_read_b64_tr_b16 a[66:67], v215 offset:1024
  ds_read_b64_tr_b16 a[68:69], v215 offset:4096
  ds_read_b64_tr_b16 a[70:71], v215 offset:5120
  ds_read_b64_tr_b16 a[72:73], v215 offset:8192
  ds_read_b64_tr_b16 a[74:75], v215 offset:9216
  ds_read_b64_tr_b16 a[76:77], v215 offset:12288
  ds_read_b64_tr_b16 a[78:79], v215 offset:13312
  s_waitcnt vmcnt(12) lgkmcnt(0)
  s_barrier
  v_add_u32 v215, 118784, v209
  ds_read_b64_tr_b16 a[80:81], v215 offset:0
  ds_read_b64_tr_b16 a[82:83], v215 offset:1024
  ds_read_b64_tr_b16 a[84:85], v215 offset:4096
  ds_read_b64_tr_b16 a[86:87], v215 offset:5120
  ds_read_b64_tr_b16 a[88:89], v215 offset:8192
  ds_read_b64_tr_b16 a[90:91], v215 offset:9216
  ds_read_b64_tr_b16 a[92:93], v215 offset:12288
  ds_read_b64_tr_b16 a[94:95], v215 offset:13312
  s_waitcnt vmcnt(8) lgkmcnt(0)
  s_barrier
  v_add_u32 v215, 135168, v209
  ds_read_b64_tr_b16 a[96:97], v215 offset:0
  ds_read_b64_tr_b16 a[98:99], v215 offset:1024
  ds_read_b64_tr_b16 a[100:101], v215 offset:4096
  ds_read_b64_tr_b16 a[102:103], v215 offset:5120
  ds_read_b64_tr_b16 a[104:105], v215 offset:8192
  ds_read_b64_tr_b16 a[106:107], v215 offset:9216
  ds_read_b64_tr_b16 a[108:109], v215 offset:12288
  ds_read_b64_tr_b16 a[110:111], v215 offset:13312
  s_waitcnt vmcnt(4) lgkmcnt(0)
  s_barrier
  v_add_u32 v215, 36864, v209
  ds_read_b64_tr_b16 a[112:113], v215 offset:0
  ds_read_b64_tr_b16 a[114:115], v215 offset:1024
  ds_read_b64_tr_b16 a[116:117], v215 offset:4096
  ds_read_b64_tr_b16 a[118:119], v215 offset:5120
  ds_read_b64_tr_b16 a[120:121], v215 offset:8192
  ds_read_b64_tr_b16 a[122:123], v215 offset:9216
  ds_read_b64_tr_b16 a[124:125], v215 offset:12288
  ds_read_b64_tr_b16 a[126:127], v215 offset:13312
  s_waitcnt vmcnt(0) lgkmcnt(0)
  s_barrier
  v_add_u32 v215, 53248, v209
  ds_read_b64_tr_b16 a[128:129], v215 offset:0
  ds_read_b64_tr_b16 a[130:131], v215 offset:1024
  ds_read_b64_tr_b16 a[132:133], v215 offset:4096
  ds_read_b64_tr_b16 a[134:135], v215 offset:5120
  ds_read_b64_tr_b16 a[136:137], v215 offset:8192
  ds_read_b64_tr_b16 a[138:139], v215 offset:9216
  ds_read_b64_tr_b16 a[140:141], v215 offset:12288
  ds_read_b64_tr_b16 a[142:143], v215 offset:13312
  s_waitcnt lgkmcnt(0)
  s_barrier
  v_and_b32 v211, 31, v200
  v_lshrrev_b32 v212, 5, v200
  v_lshlrev_b32 v213, 2, v212
  v_sub_u32 v211, v211, v213
  v_mov_b32 v214, 0xf149f2ca
  v_cmp_gt_i32 vcc, 0, v211
  s_nop 1
  v_cndmask_b32 v48, 0, v214, vcc
  v_cmp_gt_i32 vcc, 1, v211
  s_nop 1
  v_cndmask_b32 v49, 0, v214, vcc
  v_cmp_gt_i32 vcc, 2, v211
  s_nop 1
  v_cndmask_b32 v50, 0, v214, vcc
  v_cmp_gt_i32 vcc, 3, v211
  s_nop 1
  v_cndmask_b32 v51, 0, v214, vcc
  v_cmp_gt_i32 vcc, 8, v211
  s_nop 1
  v_cndmask_b32 v52, 0, v214, vcc
  v_cmp_gt_i32 vcc, 9, v211
  s_nop 1
  v_cndmask_b32 v53, 0, v214, vcc
  v_cmp_gt_i32 vcc, 10, v211
  s_nop 1
  v_cndmask_b32 v54, 0, v214, vcc
  v_cmp_gt_i32 vcc, 11, v211
  s_nop 1
  v_cndmask_b32 v55, 0, v214, vcc
  v_cmp_gt_i32 vcc, 16, v211
  s_nop 1
  v_cndmask_b32 v56, 0, v214, vcc
  v_cmp_gt_i32 vcc, 17, v211
  s_nop 1
  v_cndmask_b32 v57, 0, v214, vcc
  v_cmp_gt_i32 vcc, 18, v211
  s_nop 1
  v_cndmask_b32 v58, 0, v214, vcc
  v_cmp_gt_i32 vcc, 19, v211
  s_nop 1
  v_cndmask_b32 v59, 0, v214, vcc
  v_cmp_gt_i32 vcc, 24, v211
  s_nop 1
  v_cndmask_b32 v60, 0, v214, vcc
  v_cmp_gt_i32 vcc, 25, v211
  s_nop 1
  v_cndmask_b32 v61, 0, v214, vcc
  v_cmp_gt_i32 vcc, 26, v211
  s_nop 1
  v_cndmask_b32 v62, 0, v214, vcc
  v_cmp_gt_i32 vcc, 27, v211
  s_nop 1
  v_cndmask_b32 v63, 0, v214, vcc
  v_and_b32 v218, 0xff, v216
  v_add_u32 v218, 81920, v218
  v_and_b32 v211, 15, v200
  v_lshl_add_u32 v211, v212, 5, v211
  v_lshlrev_b32 v219, 3, v211
  v_bfe_u32 v211, v200, 4, 1
  v_lshl_add_u32 v219, v211, 2, v219
  s_lshl_b32 s54, s52, 9
  s_add_u32 s54, s54, 83968
  v_add_u32 v219, s54, v219
  v_lshl_add_u32 v221, v200, 3, s54
  s_lshr_b32 s54, s52, 1
  s_lshl_b32 s54, s54, 10
  s_and_b32 s55, s52, 1
  s_lshl_b32 s55, s55, 3
  s_add_u32 s54, s54, s55
  s_add_u32 s54, s54, 81920
  v_add_u32 v220, s54, v201
  s_lshl_b32 s54, s52, 11
  s_add_u32 s54, s54, 73728
  v_add_u32 v215, s54, v201
  v_add_u32 v208, 73728, v201
  s_mov_b32 s68, 1040356334
  s_cmp_eq_u32 s52, 0
  s_cselect_b32 s71, s71, 268435456
  s_lshl_b32 s56, s58, 2
  s_add_u32 s56, s56, 128
  v_mov_b32 v176, -1
  v_mov_b32 v177, -1
  v_mov_b32 v178, -1
  v_mov_b32 v179, -1
  s_cmp_eq_u32 s52, 0
  s_cbranch_scc0 AT_p1_d
  s_mov_b32 exec_hi, 0
  s_mov_b32 exec_lo, 1
AT_p1:
  buffer_load_dword v211, v201, s[12:15], s56 offen sc1
  s_add_u32 s65, s65, 1
  s_waitcnt vmcnt(0)
  v_cmp_gt_u32 vcc, 0x700, v211
  s_cbranch_vccz AT_p1_x
  s_sleep 8
  s_cmp_lt_u32 s65, 131072
  s_cbranch_scc1 AT_p1
AT_p1_x:
  s_mov_b64 exec, -1
AT_p1_d:
  s_barrier
  s_mov_b32 s74, s59
  s_mul_i32 s66, s59, 655360
  s_lshl_b32 s55, s58, 14
  s_add_u32 s55, s55, s66
  s_add_u32 s55, s55, 1048576
  s_lshl_b32 s73, s58, 2
  s_add_u32 s73, s73, s52
  s_lshl_b32 s72, s59, 7
  s_add_u32 s72, s72, s73
  s_lshl_b32 s72, s72, 11
  s_add_u32 s72, s72, 46137344
  s_lshl_b32 s73, s73, 10
  s_add_u32 s73, s73, s66
  s_add_u32 s73, s73, 1572864
  s_add_u32 s59, s59, 2
  buffer_load_dwordx4 v[128:131], v216, s[8:11], s55 offen offset:0 sc1
  buffer_load_dwordx4 v[132:135], v216, s[8:11], s55 offen offset:256 sc1
  buffer_load_dwordx4 v[136:139], v216, s[8:11], s55 offen offset:512 sc1
  buffer_load_dwordx4 v[140:143], v216, s[8:11], s55 offen offset:768 sc1
  buffer_load_dwordx4 v[144:147], v216, s[8:11], s55 offen offset:1024 sc1
  buffer_load_dwordx4 v[148:151], v216, s[8:11], s55 offen offset:1280 sc1
  buffer_load_dwordx4 v[152:155], v216, s[8:11], s55 offen offset:1536 sc1
  buffer_load_dwordx4 v[156:159], v216, s[8:11], s55 offen offset:1792 sc1
  buffer_load_dwordx4 v[160:163], v217, s[8:11], s55 offen offset:0 sc1
  buffer_load_dwordx4 v[164:167], v217, s[8:11], s55 offen offset:256 sc1
  s_add_u32 s60, s60, 73728
  ds_read_b128 v[32:35], v203 offset:0
  ds_read_b128 v[36:39], v204 offset:0
  ds_read_b128 v[40:43], v205 offset:0
  s_waitcnt lgkmcnt(2)
  v_mfma_f32_32x32x16_bf16 v[240:255], a[0:3], v[32:35], 0
  ds_read_b128 v[44:47], v206 offset:0
  s_add_u32 m0, s67, 36864
  s_nop 0
  buffer_load_dwordx4 v202, s[4:7], s60 offen offset:0 lds
  s_waitcnt lgkmcnt(2)
  v_mfma_f32_32x32x16_bf16 v[240:255], a[4:7], v[36:39], v[240:255]
  ds_read_b128 v[32:35], v203 offset:1024
  s_waitcnt lgkmcnt(2)
  v_mfma_f32_32x32x16_bf16 v[240:255], a[8:11], v[40:43], v[240:255]
  ds_read_b128 v[36:39], v204 offset:1024
  s_add_u32 m0, s67, 37760
  s_nop 0
  buffer_load_dwordx4 v202, s[4:7], s60 offen offset:128 lds
  s_waitcnt lgkmcnt(2)
  v_mfma_f32_32x32x16_bf16 v[240:255], a[12:15], v[44:47], v[240:255]
  ds_read_b128 v[40:43], v205 offset:1024
  s_waitcnt lgkmcnt(2)
  v_mfma_f32_32x32x16_bf16 v[240:255], a[16:19], v[32:35], v[240:255]
  ds_read_b128 v[44:47], v206 offset:1024
  s_add_u32 m0, s67, 38656
  s_nop 0
  buffer_load_dwordx4 v202, s[4:7], s60 offen offset:256 lds
  s_waitcnt lgkmcnt(2)
  v_mfma_f32_32x32x16_bf16 v[240:255], a[20:23], v[36:39], v[240:255]
  ds_read_b128 v[32:35], v203 offset:2048
  s_waitcnt lgkmcnt(2)
  v_mfma_f32_32x32x16_bf16 v[240:255], a[24:27], v[40:43], v[240:255]
  ds_read_b128 v[36:39], v204 offset:2048
  s_add_u32 m0, s67, 39552
  s_nop 0
  buffer_load_dwordx4 v202, s[4:7], s60 offen offset:384 lds
  s_waitcnt lgkmcnt(2)
  v_mfma_f32_32x32x16_bf16 v[240:255], a[28:31], v[44:47], v[240:255]
  ds_read_b128 v[40:43], v205 offset:2048
  s_waitcnt lgkmcnt(2)
  v_mfma_f32_32x32x16_bf16 v[240:255], a[32:35], v[32:35], v[240:255]
  ds_read_b128 v[44:47], v206 offset:2048
  s_add_u32 m0, s67, 40448
  s_nop 0
  buffer_load_dwordx4 v202, s[4:7], s60 offen offset:512 lds
  s_waitcnt lgkmcnt(2)
  v_mfma_f32_32x32x16_bf16 v[240:255], a[36:39], v[36:39], v[240:255]
  ds_read_b128 v[32:35], v203 offset:3072
  s_waitcnt lgkmcnt(2)
  v_mfma_f32_32x32x16_bf16 v[240:255], a[40:43], v[40:43], v[240:255]
  ds_read_b128 v[36:39], v204 offset:3072
  s_add_u32 m0, s67, 41344
  s_nop 0
  buffer_load_dwordx4 v202, s[4:7], s60 offen offset:640 lds
  s_waitcnt lgkmcnt(2)
  v_mfma_f32_32x32x16_bf16 v[240:255], a[44:47], v[44:47], v[240:255]
  ds_read_b128 v[40:43], v205 offset:3072
  s_waitcnt lgkmcnt(2)
  v_mfma_f32_32x32x16_bf16 v[240:255], a[48:51], v[32:35], v[240:255]
  ds_read_b128 v[44:47], v206 offset:3072
  s_add_u32 m0, s67, 42240
  s_nop 0
  buffer_load_dwordx4 v202, s[4:7], s60 offen offset:768 lds
  s_waitcnt lgkmcnt(2)
  v_mfma_f32_32x32x16_bf16 v[240:255], a[52:55], v[36:39], v[240:255]
  ds_read_b128 v[32:35], v203 offset:4096
  s_waitcnt lgkmcnt(2)
  v_mfma_f32_32x32x16_bf16 v[240:255], a[56:59], v[40:43], v[240:255]
  ds_read_b128 v[36:39], v204 offset:4096
  s_add_u32 m0, s67, 43136
  s_nop 0
  buffer_load_dwordx4 v202, s[4:7], s60 offen offset:896 lds
  s_waitcnt lgkmcnt(2)
  v_mfma_f32_32x32x16_bf16 v[240:255], a[60:63], v[44:47], v[240:255]
  ds_read_b128 v[40:43], v205 offset:4096
  s_waitcnt lgkmcnt(2)
  v_mfma_f32_32x32x16_bf16 v[240:255], a[64:67], v[32:35], v[240:255]
  ds_read_b128 v[44:47], v206 offset:4096
  s_add_u32 m0, s67, 44032
  s_nop 0
  buffer_load_dwordx4 v202, s[4:7], s60 offen offset:1024 lds
  s_waitcnt lgkmcnt(2)
  v_mfma_f32_32x32x16_bf16 v[240:255], a[68:71], v[36:39], v[240:255]
  ds_read_b128 v[32:35], v203 offset:5120
  s_waitcnt lgkmcnt(2)
  v_mfma_f32_32x32x16_bf16 v[240:255], a[72:75], v[40:43], v[240:255]
  ds_read_b128 v[36:39], v204 offset:5120
  buffer_store_dwordx4 v[176:179], v201, s[8:11], s72 offen offset:0 sc1
  s_waitcnt lgkmcnt(2)
  v_mfma_f32_32x32x16_bf16 v[240:255], a[76:79], v[44:47], v[240:255]
  ds_read_b128 v[40:43], v205 offset:5120
  s_waitcnt lgkmcnt(2)
  v_mfma_f32_32x32x16_bf16 v[240:255], a[80:83], v[32:35], v[240:255]
  ds_read_b128 v[44:47], v206 offset:5120
  buffer_store_dwordx4 v[176:179], v201, s[8:11], s72 offen offset:1024 sc1
  s_waitcnt lgkmcnt(2)
  v_mfma_f32_32x32x16_bf16 v[240:255], a[84:87], v[36:39], v[240:255]
  ds_read_b128 v[32:35], v203 offset:6144
  s_waitcnt lgkmcnt(2)
  v_mfma_f32_32x32x16_bf16 v[240:255], a[88:91], v[40:43], v[240:255]
  ds_read_b128 v[36:39], v204 offset:6144
  s_waitcnt lgkmcnt(2)
  v_mfma_f32_32x32x16_bf16 v[240:255], a[92:95], v[44:47], v[240:255]
  ds_read_b128 v[40:43], v205 offset:6144
  s_waitcnt lgkmcnt(2)
  v_mfma_f32_32x32x16_bf16 v[240:255], a[96:99], v[32:35], v[240:255]
  ds_read_b128 v[44:47], v206 offset:6144
  s_waitcnt lgkmcnt(2)
  v_mfma_f32_32x32x16_bf16 v[240:255], a[100:103], v[36:39], v[240:255]
  ds_read_b128 v[32:35], v203 offset:7168
  s_waitcnt lgkmcnt(2)
  v_mfma_f32_32x32x16_bf16 v[240:255], a[104:107], v[40:43], v[240:255]
  ds_read_b128 v[36:39], v204 offset:7168
  s_waitcnt lgkmcnt(2)
  v_mfma_f32_32x32x16_bf16 v[240:255], a[108:111], v[44:47], v[240:255]
  ds_read_b128 v[40:43], v205 offset:7168
  s_waitcnt lgkmcnt(2)
  v_mfma_f32_32x32x16_bf16 v[240:255], a[112:115], v[32:35], v[240:255]
  ds_read_b128 v[44:47], v206 offset:7168
  s_waitcnt lgkmcnt(2)
  v_mfma_f32_32x32x16_bf16 v[240:255], a[116:119], v[36:39], v[240:255]
  ds_read_b128 v[32:35], v203 offset:8192
  s_waitcnt lgkmcnt(2)
  v_mfma_f32_32x32x16_bf16 v[240:255], a[120:123], v[40:43], v[240:255]
  ds_read_b128 v[36:39], v204 offset:8192
  s_waitcnt lgkmcnt(2)
  v_mfma_f32_32x32x16_bf16 v[240:255], a[124:127], v[44:47], v[240:255]
  ds_read_b128 v[40:43], v205 offset:8192
  s_waitcnt lgkmcnt(2)
  v_mfma_f32_32x32x16_bf16 v[240:255], a[128:131], v[32:35], v[240:255]
  ds_read_b128 v[44:47], v206 offset:8192
  s_waitcnt lgkmcnt(2)
  v_mfma_f32_32x32x16_bf16 v[240:255], a[132:135], v[36:39], v[240:255]
  s_waitcnt lgkmcnt(1)
  v_mfma_f32_32x32x16_bf16 v[240:255], a[136:139], v[40:43], v[240:255]
  s_waitcnt lgkmcnt(0)
  v_mfma_f32_32x32x16_bf16 v[240:255], a[140:143], v[44:47], v[240:255]
  s_nop 11
  v_cvt_pk_bf16_f32 v16, v240, v244
  v_cvt_pk_bf16_f32 v17, v241, v245
  v_cvt_pk_bf16_f32 v18, v242, v246
  v_cvt_pk_bf16_f32 v19, v243, v247
  ds_write_b128 v215, v[16:19] offset:0
  v_cvt_pk_bf16_f32 v20, v248, v252
  v_cvt_pk_bf16_f32 v21, v249, v253
  v_cvt_pk_bf16_f32 v22, v250, v254
  v_cvt_pk_bf16_f32 v23, v251, v255
  ds_write_b128 v215, v[20:23] offset:1024
  s_waitcnt lgkmcnt(0)
  s_barrier
  ds_read_b128 v[96:99], v208 offset:0
  ds_read_b128 v[100:103], v208 offset:1024
  ds_read_b128 v[104:107], v208 offset:2048
  ds_read_b128 v[108:111], v208 offset:3072
  ds_read_b128 v[112:115], v208 offset:4096
  ds_read_b128 v[116:119], v208 offset:5120
  ds_read_b128 v[120:123], v208 offset:6144
  ds_read_b128 v[124:127], v208 offset:7168
  s_waitcnt vmcnt(20) lgkmcnt(7)
  v_mfma_f32_32x32x16_bf16 v[64:79], v[128:131], v[96:99], v[48:63]
  s_waitcnt vmcnt(19) lgkmcnt(6)
  v_mfma_f32_32x32x16_bf16 v[64:79], v[132:135], v[100:103], v[64:79]
  s_waitcnt vmcnt(18) lgkmcnt(5)
  v_mfma_f32_32x32x16_bf16 v[64:79], v[136:139], v[104:107], v[64:79]
  s_waitcnt vmcnt(17) lgkmcnt(4)
  v_mfma_f32_32x32x16_bf16 v[64:79], v[140:143], v[108:111], v[64:79]
  s_waitcnt vmcnt(16) lgkmcnt(3)
  v_mfma_f32_32x32x16_bf16 v[64:79], v[144:147], v[112:115], v[64:79]
  s_waitcnt vmcnt(15) lgkmcnt(2)
  v_mfma_f32_32x32x16_bf16 v[64:79], v[148:151], v[116:119], v[64:79]
  s_waitcnt vmcnt(14) lgkmcnt(1)
  v_mfma_f32_32x32x16_bf16 v[64:79], v[152:155], v[120:123], v[64:79]
  s_waitcnt vmcnt(13) lgkmcnt(0)
  v_mfma_f32_32x32x16_bf16 v[64:79], v[156:159], v[124:127], v[64:79]
  s_nop 11
  v_max3_f32 v180, v64, v65, v66
  v_max3_f32 v180, v180, v67, v68
  v_max3_f32 v180, v180, v69, v70
  v_max3_f32 v180, v180, v71, v72
  v_max3_f32 v180, v180, v73, v74
  v_max3_f32 v180, v180, v75, v76
  v_max3_f32 v180, v180, v77, v78
  v_max_f32 v180, v180, v79
  v_mov_b32 v181, v180
  s_nop 1
  v_permlane32_swap_b32 v180, v181
  v_max_f32 v180, v180, v181
  v_sub_f32 v64, v64, v180
  v_sub_f32 v65, v65, v180
  v_sub_f32 v66, v66, v180
  v_sub_f32 v67, v67, v180
  v_sub_f32 v68, v68, v180
  v_sub_f32 v69, v69, v180
  v_sub_f32 v70, v70, v180
  v_sub_f32 v71, v71, v180
  v_sub_f32 v72, v72, v180
  v_sub_f32 v73, v73, v180
  v_sub_f32 v74, v74, v180
  v_sub_f32 v75, v75, v180
  v_sub_f32 v76, v76, v180
  v_sub_f32 v77, v77, v180
  v_sub_f32 v78, v78, v180
  v_sub_f32 v79, v79, v180
  v_exp_f32 v64, v64
  v_exp_f32 v65, v65
  v_exp_f32 v66, v66
  v_exp_f32 v67, v67
  v_exp_f32 v68, v68
  v_exp_f32 v69, v69
  v_exp_f32 v70, v70
  v_exp_f32 v71, v71
  v_exp_f32 v72, v72
  v_exp_f32 v73, v73
  v_exp_f32 v74, v74
  v_exp_f32 v75, v75
  v_exp_f32 v76, v76
  v_exp_f32 v77, v77
  v_exp_f32 v78, v78
  v_exp_f32 v79, v79
  v_cvt_pk_bf16_f32 v20, v64, v65
  v_cvt_pk_bf16_f32 v21, v68, v69
  v_cvt_pk_bf16_f32 v22, v72, v73
  v_cvt_pk_bf16_f32 v23, v76, v77
  v_cvt_pk_bf16_f32 v24, v66, v67
  v_cvt_pk_bf16_f32 v25, v70, v71
  v_cvt_pk_bf16_f32 v26, v74, v75
  v_cvt_pk_bf16_f32 v27, v78, v79
  s_waitcnt vmcnt(12)
  v_mfma_f32_32x32x16_bf16 v[0:15], v[160:163], v[20:23], 0
  v_add_f32 v182, v64, v65
  v_add_f32 v182, v182, v66
  v_add_f32 v182, v182, v67
  v_add_f32 v182, v182, v68
  v_add_f32 v182, v182, v69
  v_add_f32 v182, v182, v70
  v_add_f32 v182, v182, v71
  s_waitcnt vmcnt(11)
  v_mfma_f32_32x32x16_bf16 v[0:15], v[164:167], v[24:27], v[0:15]
  v_add_f32 v182, v182, v72
  v_add_f32 v182, v182, v73
  v_add_f32 v182, v182, v74
  v_add_f32 v182, v182, v75
  v_add_f32 v182, v182, v76
  v_add_f32 v182, v182, v77
  v_add_f32 v182, v182, v78
  v_add_f32 v182, v182, v79
  s_waitcnt vmcnt(0)
  s_barrier
AT_loop:
  s_cmp_ge_u32 s59, 64
  s_cbranch_scc1 AT_l0
  s_mov_b32 s77, s59
  s_mul_i32 s66, s59, 655360
  s_lshl_b32 s55, s58, 14
  s_add_u32 s55, s55, s66
  s_add_u32 s55, s55, 1048576
  s_lshl_b32 s76, s58, 2
  s_add_u32 s76, s76, s52
  s_lshl_b32 s75, s59, 7
  s_add_u32 s75, s75, s76
  s_lshl_b32 s75, s75, 11
  s_add_u32 s75, s75, 46137344
  s_lshl_b32 s76, s76, 10
  s_add_u32 s76, s76, s66
  s_add_u32 s76, s76, 1572864
  s_add_u32 s59, s59, 2
  buffer_load_dwordx4 v[128:131], v216, s[8:11], s55 offen offset:0 sc1
  buffer_load_dwordx4 v[132:135], v216, s[8:11], s55 offen offset:256 sc1
  buffer_load_dwordx4 v[136:139], v216, s[8:11], s55 offen offset:512 sc1
  buffer_load_dwordx4 v[140:143], v216, s[8:11], s55 offen offset:768 sc1
  buffer_load_dwordx4 v[144:147], v216, s[8:11], s55 offen offset:1024 sc1
  buffer_load_dwordx4 v[148:151], v216, s[8:11], s55 offen offset:1280 sc1
  buffer_load_dwordx4 v[152:155], v216, s[8:11], s55 offen offset:1536 sc1
  buffer_load_dwordx4 v[156:159], v216, s[8:11], s55 offen offset:1792 sc1
  buffer_load_dwordx4 v[160:163], v217, s[8:11], s55 offen offset:0 sc1
  buffer_load_dwordx4 v[164:167], v217, s[8:11], s55 offen offset:256 sc1
  s_or_b32 s70, s73, 0xc00
  buffer_load_dword v172, off, s[8:11], s70 sc1
  s_add_u32 s60, s60, 73728
  ds_read_b128 v[32:35], v203 offset:36864
  ds_read_b128 v[36:39], v204 offset:36864
  ds_read_b128 v[40:43], v205 offset:36864
  s_waitcnt lgkmcnt(2)
  v_mfma_f32_32x32x16_bf16 v[240:255], a[0:3], v[32:35], 0
  ds_read_b128 v[44:47], v206 offset:36864
  s_add_u32 m0, s67, 0
  s_nop 0
  buffer_load_dwordx4 v202, s[4:7], s60 offen offset:0 lds
  s_waitcnt lgkmcnt(2)
  v_mfma_f32_32x32x16_bf16 v[240:255], a[4:7], v[36:39], v[240:255]
  ds_read_b128 v[32:35], v203 offset:37888
  s_waitcnt lgkmcnt(2)
  v_mfma_f32_32x32x16_bf16 v[240:255], a[8:11], v[40:43], v[240:255]
  ds_read_b128 v[36:39], v204 offset:37888
  s_add_u32 m0, s67, 896
  s_nop 0
  buffer_load_dwordx4 v202, s[4:7], s60 offen offset:128 lds
  s_waitcnt lgkmcnt(2)
  v_mfma_f32_32x32x16_bf16 v[240:255], a[12:15], v[44:47], v[240:255]
  ds_read_b128 v[40:43], v205 offset:37888
  s_waitcnt lgkmcnt(2)
  v_mfma_f32_32x32x16_bf16 v[240:255], a[16:19], v[32:35], v[240:255]
  ds_read_b128 v[44:47], v206 offset:37888
  s_add_u32 m0, s67, 1792
  s_nop 0
  buffer_load_dwordx4 v202, s[4:7], s60 offen offset:256 lds
  s_waitcnt lgkmcnt(2)
  v_mfma_f32_32x32x16_bf16 v[240:255], a[20:23], v[36:39], v[240:255]
  ds_read_b128 v[32:35], v203 offset:38912
  s_waitcnt lgkmcnt(2)
  v_mfma_f32_32x32x16_bf16 v[240:255], a[24:27], v[40:43], v[240:255]
  ds_read_b128 v[36:39], v204 offset:38912
  s_add_u32 m0, s67, 2688
  s_nop 0
  buffer_load_dwordx4 v202, s[4:7], s60 offen offset:384 lds
  s_waitcnt lgkmcnt(2)
  v_mfma_f32_32x32x16_bf16 v[240:255], a[28:31], v[44:47], v[240:255]
  ds_read_b128 v[40:43], v205 offset:38912
  s_waitcnt lgkmcnt(2)
  v_mfma_f32_32x32x16_bf16 v[240:255], a[32:35], v[32:35], v[240:255]
  ds_read_b128 v[44:47], v206 offset:38912
  s_add_u32 m0, s67, 3584
  s_nop 0
  buffer_load_dwordx4 v202, s[4:7], s60 offen offset:512 lds
  s_waitcnt lgkmcnt(2)
  v_mfma_f32_32x32x16_bf16 v[240:255], a[36:39], v[36:39], v[240:255]
  ds_read_b128 v[32:35], v203 offset:39936
  s_waitcnt lgkmcnt(2)
  v_mfma_f32_32x32x16_bf16 v[240:255], a[40:43], v[40:43], v[240:255]
  ds_read_b128 v[36:39], v204 offset:39936
  s_add_u32 m0, s67, 4480
  s_nop 0
  buffer_load_dwordx4 v202, s[4:7], s60 offen offset:640 lds
  s_waitcnt lgkmcnt(2)
  v_mfma_f32_32x32x16_bf16 v[240:255], a[44:47], v[44:47], v[240:255]
  ds_read_b128 v[40:43], v205 offset:39936
  s_waitcnt lgkmcnt(2)
  v_mfma_f32_32x32x16_bf16 v[240:255], a[48:51], v[32:35], v[240:255]
  ds_read_b128 v[44:47], v206 offset:39936
  s_add_u32 m0, s67, 5376
  s_nop 0
  buffer_load_dwordx4 v202, s[4:7], s60 offen offset:768 lds
  s_waitcnt lgkmcnt(2)
  v_mfma_f32_32x32x16_bf16 v[240:255], a[52:55], v[36:39], v[240:255]
  ds_read_b128 v[32:35], v203 offset:40960
  s_waitcnt lgkmcnt(2)
  v_mfma_f32_32x32x16_bf16 v[240:255], a[56:59], v[40:43], v[240:255]
  ds_read_b128 v[36:39], v204 offset:40960
  s_add_u32 m0, s67, 6272
  s_nop 0
  buffer_load_dwordx4 v202, s[4:7], s60 offen offset:896 lds
  s_waitcnt lgkmcnt(2)
  v_mfma_f32_32x32x16_bf16 v[240:255], a[60:63], v[44:47], v[240:255]
  ds_read_b128 v[40:43], v205 offset:40960
  s_waitcnt lgkmcnt(2)
  v_mfma_f32_32x32x16_bf16 v[240:255], a[64:67], v[32:35], v[240:255]
  ds_read_b128 v[44:47], v206 offset:40960
  s_add_u32 m0, s67, 7168
  s_nop 0
  buffer_load_dwordx4 v202, s[4:7], s60 offen offset:1024 lds
  s_waitcnt lgkmcnt(2)
  v_mfma_f32_32x32x16_bf16 v[240:255], a[68:71], v[36:39], v[240:255]
  ds_read_b128 v[32:35], v203 offset:41984
  s_waitcnt lgkmcnt(2)
  v_mfma_f32_32x32x16_bf16 v[240:255], a[72:75], v[40:43], v[240:255]
  ds_read_b128 v[36:39], v204 offset:41984
  buffer_store_dwordx4 v[176:179], v201, s[8:11], s75 offen offset:0 sc1
  s_waitcnt lgkmcnt(2)
  v_mfma_f32_32x32x16_bf16 v[240:255], a[76:79], v[44:47], v[240:255]
  ds_read_b128 v[40:43], v205 offset:41984
  s_waitcnt lgkmcnt(2)
  v_mfma_f32_32x32x16_bf16 v[240:255], a[80:83], v[32:35], v[240:255]
  ds_read_b128 v[44:47], v206 offset:41984
  buffer_store_dwordx4 v[176:179], v201, s[8:11], s75 offen offset:1024 sc1
  s_waitcnt lgkmcnt(2)
  v_mfma_f32_32x32x16_bf16 v[240:255], a[84:87], v[36:39], v[240:255]
  ds_read_b128 v[32:35], v203 offset:43008
  s_waitcnt lgkmcnt(2)
  v_mfma_f32_32x32x16_bf16 v[240:255], a[88:91], v[40:43], v[240:255]
  ds_read_b128 v[36:39], v204 offset:43008
  s_waitcnt lgkmcnt(2)
  v_mfma_f32_32x32x16_bf16 v[240:255], a[92:95], v[44:47], v[240:255]
  ds_read_b128 v[40:43], v205 offset:43008
  s_waitcnt lgkmcnt(2)
  v_mfma_f32_32x32x16_bf16 v[240:255], a[96:99], v[32:35], v[240:255]
  ds_read_b128 v[44:47], v206 offset:43008
  s_waitcnt lgkmcnt(2)
  v_mfma_f32_32x32x16_bf16 v[240:255], a[100:103], v[36:39], v[240:255]
  ds_read_b128 v[32:35], v203 offset:44032
  s_waitcnt lgkmcnt(2)
  v_mfma_f32_32x32x16_bf16 v[240:255], a[104:107], v[40:43], v[240:255]
  ds_read_b128 v[36:39], v204 offset:44032
  s_waitcnt lgkmcnt(2)
  v_mfma_f32_32x32x16_bf16 v[240:255], a[108:111], v[44:47], v[240:255]
  ds_read_b128 v[40:43], v205 offset:44032
  s_waitcnt lgkmcnt(2)
  v_mfma_f32_32x32x16_bf16 v[240:255], a[112:115], v[32:35], v[240:255]
  ds_read_b128 v[44:47], v206 offset:44032
  s_waitcnt lgkmcnt(2)
  v_mfma_f32_32x32x16_bf16 v[240:255], a[116:119], v[36:39], v[240:255]
  ds_read_b128 v[32:35], v203 offset:45056
  s_waitcnt lgkmcnt(2)
  v_mfma_f32_32x32x16_bf16 v[240:255], a[120:123], v[40:43], v[240:255]
  ds_read_b128 v[36:39], v204 offset:45056
  s_waitcnt lgkmcnt(2)
  v_mfma_f32_32x32x16_bf16 v[240:255], a[124:127], v[44:47], v[240:255]
  ds_read_b128 v[40:43], v205 offset:45056
  s_waitcnt lgkmcnt(2)
  v_mfma_f32_32x32x16_bf16 v[240:255], a[128:131], v[32:35], v[240:255]
  ds_read_b128 v[44:47], v206 offset:45056
  s_waitcnt lgkmcnt(2)
  v_mfma_f32_32x32x16_bf16 v[240:255], a[132:135], v[36:39], v[240:255]
  s_waitcnt lgkmcnt(1)
  v_mfma_f32_32x32x16_bf16 v[240:255], a[136:139], v[40:43], v[240:255]
  s_waitcnt lgkmcnt(0)
  v_mfma_f32_32x32x16_bf16 v[240:255], a[140:143], v[44:47], v[240:255]
  s_nop 11
  v_cvt_pk_bf16_f32 v16, v240, v244
  v_cvt_pk_bf16_f32 v17, v241, v245
  v_cvt_pk_bf16_f32 v18, v242, v246
  v_cvt_pk_bf16_f32 v19, v243, v247
  ds_write_b128 v215, v[16:19] offset:0
  v_cvt_pk_bf16_f32 v20, v248, v252
  v_cvt_pk_bf16_f32 v21, v249, v253
  v_cvt_pk_bf16_f32 v22, v250, v254
  v_cvt_pk_bf16_f32 v23, v251, v255
  ds_write_b128 v215, v[20:23] offset:1024
  s_waitcnt lgkmcnt(0)
  s_barrier
  ds_read_b128 a[144:147], v208 offset:0
  ds_read_b128 a[148:151], v208 offset:1024
  ds_read_b128 a[152:155], v208 offset:2048
  ds_read_b128 a[156:159], v208 offset:3072
  ds_read_b128 a[160:163], v208 offset:4096
  ds_read_b128 a[164:167], v208 offset:5120
  ds_read_b128 a[168:171], v208 offset:6144
  ds_read_b128 a[172:175], v208 offset:7168
  s_waitcnt vmcnt(11)
  v_cmp_eq_u32 vcc, -1, v172
  s_mov_b32 s69, 0
  s_cbranch_vccnz AT_e1
  s_mov_b32 s69, 1
  buffer_load_dwordx4 v[172:175], v201, s[8:11], s73 offen sc1
AT_e1:
  s_waitcnt lgkmcnt(7)
  v_mfma_f32_32x32x16_bf16 v[64:79], v[128:131], a[144:147], v[48:63]
  s_waitcnt lgkmcnt(6)
  v_mfma_f32_32x32x16_bf16 v[64:79], v[132:135], a[148:151], v[64:79]
  s_waitcnt lgkmcnt(5)
  v_mfma_f32_32x32x16_bf16 v[64:79], v[136:139], a[152:155], v[64:79]
  s_waitcnt lgkmcnt(4)
  v_mfma_f32_32x32x16_bf16 v[64:79], v[140:143], a[156:159], v[64:79]
  s_waitcnt lgkmcnt(3)
  v_mfma_f32_32x32x16_bf16 v[64:79], v[144:147], a[160:163], v[64:79]
  s_waitcnt lgkmcnt(2)
  v_mfma_f32_32x32x16_bf16 v[64:79], v[148:151], a[164:167], v[64:79]
  s_waitcnt lgkmcnt(1)
  v_mfma_f32_32x32x16_bf16 v[64:79], v[152:155], a[168:171], v[64:79]
  s_waitcnt lgkmcnt(0)
  v_mfma_f32_32x32x16_bf16 v[64:79], v[156:159], a[172:175], v[64:79]
  s_nop 11
  v_max3_f32 v184, v64, v65, v66
  v_max3_f32 v184, v184, v67, v68
  v_max3_f32 v184, v184, v69, v70
  v_max3_f32 v184, v184, v71, v72
  v_max3_f32 v184, v184, v73, v74
  v_max3_f32 v184, v184, v75, v76
  v_max3_f32 v184, v184, v77, v78
  v_max_f32 v184, v184, v79
  v_mov_b32 v185, v184
  s_nop 1
  v_permlane32_swap_b32 v184, v185
  v_max_f32 v184, v184, v185
  v_sub_f32 v64, v64, v184
  v_sub_f32 v65, v65, v184
  v_sub_f32 v66, v66, v184
  v_sub_f32 v67, v67, v184
  v_sub_f32 v68, v68, v184
  v_sub_f32 v69, v69, v184
  v_sub_f32 v70, v70, v184
  v_sub_f32 v71, v71, v184
  v_sub_f32 v72, v72, v184
  v_sub_f32 v73, v73, v184
  v_sub_f32 v74, v74, v184
  v_sub_f32 v75, v75, v184
  v_sub_f32 v76, v76, v184
  v_sub_f32 v77, v77, v184
  v_sub_f32 v78, v78, v184
  v_sub_f32 v79, v79, v184
  v_exp_f32 v64, v64
  v_exp_f32 v65, v65
  v_exp_f32 v66, v66
  v_exp_f32 v67, v67
  v_exp_f32 v68, v68
  v_exp_f32 v69, v69
  v_exp_f32 v70, v70
  v_exp_f32 v71, v71
  v_exp_f32 v72, v72
  v_exp_f32 v73, v73
  v_exp_f32 v74, v74
  v_exp_f32 v75, v75
  v_exp_f32 v76, v76
  v_exp_f32 v77, v77
  v_exp_f32 v78, v78
  v_exp_f32 v79, v79
  v_cvt_pk_bf16_f32 v20, v64, v65
  v_cvt_pk_bf16_f32 v21, v68, v69
  v_cvt_pk_bf16_f32 v22, v72, v73
  v_cvt_pk_bf16_f32 v23, v76, v77
  v_cvt_pk_bf16_f32 v24, v66, v67
  v_cvt_pk_bf16_f32 v25, v70, v71
  v_cvt_pk_bf16_f32 v26, v74, v75
  v_cvt_pk_bf16_f32 v27, v78, v79
  v_mfma_f32_32x32x16_bf16 v[224:239], v[160:163], v[20:23], 0
  v_add_f32 v186, v64, v65
  v_add_f32 v186, v186, v66
  v_add_f32 v186, v186, v67
  v_add_f32 v186, v186, v68
  v_add_f32 v186, v186, v69
  v_add_f32 v186, v186, v70
  v_add_f32 v186, v186, v71
  v_mfma_f32_32x32x16_bf16 v[224:239], v[164:167], v[24:27], v[224:239]
  v_add_f32 v186, v186, v72
  v_add_f32 v186, v186, v73
  v_add_f32 v186, v186, v74
  v_add_f32 v186, v186, v75
  v_add_f32 v186, v186, v76
  v_add_f32 v186, v186, v77
  v_add_f32 v186, v186, v78
  v_add_f32 v186, v186, v79
AT_l0:
  s_cmp_eq_u32 s69, 1
  s_cbranch_scc1 AT_v0
  s_cmp_ge_u32 s74, 62
  s_cbranch_scc1 AT_k0
  s_branch AT_c0
AT_h0:
  s_sleep 2
AT_c0:
  buffer_load_dword v172, off, s[8:11], s70 sc1
  s_add_u32 s65, s65, 1
  s_cmp_lt_u32 s65, 131072
  s_cselect_b32 s54, -2, -1
  s_waitcnt vmcnt(0)
  v_cmp_lt_u32 vcc, s54, v172
  s_cbranch_vccnz AT_h0
AT_k0:
  buffer_load_dwordx4 v[172:175], v201, s[8:11], s73 offen sc1
AT_v0:
  s_mov_b32 s69, 0
  s_add_u32 s65, s65, 1
  s_cmp_lt_u32 s65, 131072
  s_cselect_b32 s54, -2, -1
  s_waitcnt vmcnt(0)
  ds_write_b64 v220, v[172:173] offset:0
  ds_write_b64 v221, v[174:175] offset:0
  v_max3_u32 v213, v172, v173, v174
  v_max_u32 v213, v213, v175
  v_cmp_lt_u32 vcc, s54, v213
  s_cbranch_vccnz AT_k0
  s_waitcnt lgkmcnt(0)
  s_barrier
  ds_read_b128 v[128:131], v218 offset:0
  ds_read_b128 v[132:135], v218 offset:256
  ds_read_b128 v[136:139], v218 offset:512
  ds_read_b128 v[140:143], v218 offset:768
  ds_read_b128 v[144:147], v218 offset:1024
  ds_read_b128 v[148:151], v218 offset:1280
  ds_read_b128 v[152:155], v218 offset:1536
  ds_read_b128 v[156:159], v218 offset:1792
  ds_read_b32 v168, v219 offset:0
  ds_read_b32 v169, v219 offset:128
  s_waitcnt lgkmcnt(9)
  v_mfma_f32_32x32x16_bf16 v[80:95], v[128:131], v[96:99], 0
  s_waitcnt lgkmcnt(8)
  v_mfma_f32_32x32x16_bf16 v[80:95], v[132:135], v[100:103], v[80:95]
  s_waitcnt lgkmcnt(7)
  v_mfma_f32_32x32x16_bf16 v[80:95], v[136:139], v[104:107], v[80:95]
  s_waitcnt lgkmcnt(6)
  v_mfma_f32_32x32x16_bf16 v[80:95], v[140:143], v[108:111], v[80:95]
  s_waitcnt lgkmcnt(5)
  v_mfma_f32_32x32x16_bf16 v[80:95], v[144:147], v[112:115], v[80:95]
  s_waitcnt lgkmcnt(4)
  v_mfma_f32_32x32x16_bf16 v[80:95], v[148:151], v[116:119], v[80:95]
  s_waitcnt lgkmcnt(3)
  v_mfma_f32_32x32x16_bf16 v[80:95], v[152:155], v[120:123], v[80:95]
  s_waitcnt lgkmcnt(2)
  v_mfma_f32_32x32x16_bf16 v[80:95], v[156:159], v[124:127], v[80:95]
  s_add_u32 s74, s74, 2
  v_mov_b32 v212, s74
  s_nop 9
  v_mul_f32 v80, s68, v80
  v_mul_f32 v81, s68, v81
  v_mul_f32 v82, s68, v82
  v_mul_f32 v83, s68, v83
  v_max3_f32 v84, v180, v80, v81
  v_max3_f32 v84, v84, v82, v83
  v_mov_b32 v85, v84
  s_nop 1
  v_permlane32_swap_b32 v84, v85
  v_max_f32 v84, v84, v85
  v_sub_f32 v86, v180, v84
  v_sub_f32 v80, v80, v84
  v_sub_f32 v81, v81, v84
  v_sub_f32 v82, v82, v84
  v_sub_f32 v83, v83, v84
  v_exp_f32 v86, v86
  v_exp_f32 v80, v80
  v_exp_f32 v81, v81
  v_exp_f32 v82, v82
  v_exp_f32 v83, v83
  v_fma_f32 v182, v182, v86, v80
  v_add_f32 v84, v81, v82
  v_add_f32 v182, v182, v83
  v_add_f32 v182, v182, v84
  v_mov_b32 v183, v182
  s_nop 1
  v_permlane32_swap_b32 v182, v183
  v_add_f32 v182, v182, v183
  v_rcp_f32 v182, v182
  s_nop 0
  v_mul_f32 v86, v86, v182
  v_mul_f32 v80, v182, v80
  v_mul_f32 v81, v182, v81
  v_mul_f32 v82, v182, v82
  v_mul_f32 v83, v182, v83
  v_cvt_pk_bf16_f32 v28, v80, v81
  v_cvt_pk_bf16_f32 v29, v82, v83
  v_mul_f32 v0, v86, v0
  v_mul_f32 v1, v86, v1
  v_mul_f32 v2, v86, v2
  v_mul_f32 v3, v86, v3
  v_mul_f32 v4, v86, v4
  v_mul_f32 v5, v86, v5
  v_mul_f32 v6, v86, v6
  v_mul_f32 v7, v86, v7
  v_mul_f32 v8, v86, v8
  v_mul_f32 v9, v86, v9
  v_mul_f32 v10, v86, v10
  v_mul_f32 v11, v86, v11
  v_mul_f32 v12, v86, v12
  v_mul_f32 v13, v86, v13
  v_mul_f32 v14, v86, v14
  v_mul_f32 v15, v86, v15
  s_waitcnt lgkmcnt(0)
  s_nop 0
  v_mfma_f32_32x32x8_bf16 v[0:15], v[168:169], v[28:29], v[0:15]
  s_nop 11
  v_cvt_pk_bf16_f32 v20, v0, v1
  v_cvt_pk_bf16_f32 v21, v2, v3
  v_cvt_pk_bf16_f32 v22, v4, v5
  v_cvt_pk_bf16_f32 v23, v6, v7
  buffer_store_dwordx4 v[20:23], v201, s[8:11], s72 offen offset:0 sc1
  v_cvt_pk_bf16_f32 v24, v8, v9
  v_cvt_pk_bf16_f32 v25, v10, v11
  v_cvt_pk_bf16_f32 v26, v12, v13
  v_cvt_pk_bf16_f32 v27, v14, v15
  buffer_store_dwordx4 v[24:27], v201, s[8:11], s72 offen offset:1024 sc1
  s_mov_b64 exec, 1
  buffer_store_dword v212, v201, s[8:11], s71 offen sc1
  s_mov_b64 exec, -1
  s_cmp_ge_u32 s74, 64
  s_cbranch_scc1 L_exit
  s_cmp_ge_u32 s59, 64
  s_cbranch_scc1 AT_l1
  s_mov_b32 s74, s59
  s_mul_i32 s66, s59, 655360
  s_lshl_b32 s55, s58, 14
  s_add_u32 s55, s55, s66
  s_add_u32 s55, s55, 1048576
  s_lshl_b32 s73, s58, 2
  s_add_u32 s73, s73, s52
  s_lshl_b32 s72, s59, 7
  s_add_u32 s72, s72, s73
  s_lshl_b32 s72, s72, 11
  s_add_u32 s72, s72, 46137344
  s_lshl_b32 s73, s73, 10
  s_add_u32 s73, s73, s66
  s_add_u32 s73, s73, 1572864
  s_add_u32 s59, s59, 2
  buffer_load_dwordx4 v[128:131], v216, s[8:11], s55 offen offset:0 sc1
  buffer_load_dwordx4 v[132:135], v216, s[8:11], s55 offen offset:256 sc1
  buffer_load_dwordx4 v[136:139], v216, s[8:11], s55 offen offset:512 sc1
  buffer_load_dwordx4 v[140:143], v216, s[8:11], s55 offen offset:768 sc1
  buffer_load_dwordx4 v[144:147], v216, s[8:11], s55 offen offset:1024 sc1
  buffer_load_dwordx4 v[148:151], v216, s[8:11], s55 offen offset:1280 sc1
  buffer_load_dwordx4 v[152:155], v216, s[8:11], s55 offen offset:1536 sc1
  buffer_load_dwordx4 v[156:159], v216, s[8:11], s55 offen offset:1792 sc1
  buffer_load_dwordx4 v[160:163], v217, s[8:11], s55 offen offset:0 sc1
  buffer_load_dwordx4 v[164:167], v217, s[8:11], s55 offen offset:256 sc1
  s_or_b32 s70, s76, 0xc00
  buffer_load_dword v172, off, s[8:11], s70 sc1
  s_add_u32 s60, s60, 73728
  ds_read_b128 v[32:35], v203 offset:0
  ds_read_b128 v[36:39], v204 offset:0
  ds_read_b128 v[40:43], v205 offset:0
  s_waitcnt lgkmcnt(2)
  v_mfma_f32_32x32x16_bf16 v[240:255], a[0:3], v[32:35], 0
  ds_read_b128 v[44:47], v206 offset:0
  s_add_u32 m0, s67, 36864
  s_nop 0
  buffer_load_dwordx4 v202, s[4:7], s60 offen offset:0 lds
  s_waitcnt lgkmcnt(2)
  v_mfma_f32_32x32x16_bf16 v[240:255], a[4:7], v[36:39], v[240:255]
  ds_read_b128 v[32:35], v203 offset:1024
  s_waitcnt lgkmcnt(2)
  v_mfma_f32_32x32x16_bf16 v[240:255], a[8:11], v[40:43], v[240:255]
  ds_read_b128 v[36:39], v204 offset:1024
  s_add_u32 m0, s67, 37760
  s_nop 0
  buffer_load_dwordx4 v202, s[4:7], s60 offen offset:128 lds
  s_waitcnt lgkmcnt(2)
  v_mfma_f32_32x32x16_bf16 v[240:255], a[12:15], v[44:47], v[240:255]
  ds_read_b128 v[40:43], v205 offset:1024
  s_waitcnt lgkmcnt(2)
  v_mfma_f32_32x32x16_bf16 v[240:255], a[16:19], v[32:35], v[240:255]
  ds_read_b128 v[44:47], v206 offset:1024
  s_add_u32 m0, s67, 38656
  s_nop 0
  buffer_load_dwordx4 v202, s[4:7], s60 offen offset:256 lds
  s_waitcnt lgkmcnt(2)
  v_mfma_f32_32x32x16_bf16 v[240:255], a[20:23], v[36:39], v[240:255]
  ds_read_b128 v[32:35], v203 offset:2048
  s_waitcnt lgkmcnt(2)
  v_mfma_f32_32x32x16_bf16 v[240:255], a[24:27], v[40:43], v[240:255]
  ds_read_b128 v[36:39], v204 offset:2048
  s_add_u32 m0, s67, 39552
  s_nop 0
  buffer_load_dwordx4 v202, s[4:7], s60 offen offset:384 lds
  s_waitcnt lgkmcnt(2)
  v_mfma_f32_32x32x16_bf16 v[240:255], a[28:31], v[44:47], v[240:255]
  ds_read_b128 v[40:43], v205 offset:2048
  s_waitcnt lgkmcnt(2)
  v_mfma_f32_32x32x16_bf16 v[240:255], a[32:35], v[32:35], v[240:255]
  ds_read_b128 v[44:47], v206 offset:2048
  s_add_u32 m0, s67, 40448
  s_nop 0
  buffer_load_dwordx4 v202, s[4:7], s60 offen offset:512 lds
  s_waitcnt lgkmcnt(2)
  v_mfma_f32_32x32x16_bf16 v[240:255], a[36:39], v[36:39], v[240:255]
  ds_read_b128 v[32:35], v203 offset:3072
  s_waitcnt lgkmcnt(2)
  v_mfma_f32_32x32x16_bf16 v[240:255], a[40:43], v[40:43], v[240:255]
  ds_read_b128 v[36:39], v204 offset:3072
  s_add_u32 m0, s67, 41344
  s_nop 0
  buffer_load_dwordx4 v202, s[4:7], s60 offen offset:640 lds
  s_waitcnt lgkmcnt(2)
  v_mfma_f32_32x32x16_bf16 v[240:255], a[44:47], v[44:47], v[240:255]
  ds_read_b128 v[40:43], v205 offset:3072
  s_waitcnt lgkmcnt(2)
  v_mfma_f32_32x32x16_bf16 v[240:255], a[48:51], v[32:35], v[240:255]
  ds_read_b128 v[44:47], v206 offset:3072
  s_add_u32 m0, s67, 42240
  s_nop 0
  buffer_load_dwordx4 v202, s[4:7], s60 offen offset:768 lds
  s_waitcnt lgkmcnt(2)
  v_mfma_f32_32x32x16_bf16 v[240:255], a[52:55], v[36:39], v[240:255]
  ds_read_b128 v[32:35], v203 offset:4096
  s_waitcnt lgkmcnt(2)
  v_mfma_f32_32x32x16_bf16 v[240:255], a[56:59], v[40:43], v[240:255]
  ds_read_b128 v[36:39], v204 offset:4096
  s_add_u32 m0, s67, 43136
  s_nop 0
  buffer_load_dwordx4 v202, s[4:7], s60 offen offset:896 lds
  s_waitcnt lgkmcnt(2)
  v_mfma_f32_32x32x16_bf16 v[240:255], a[60:63], v[44:47], v[240:255]
  ds_read_b128 v[40:43], v205 offset:4096
  s_waitcnt lgkmcnt(2)
  v_mfma_f32_32x32x16_bf16 v[240:255], a[64:67], v[32:35], v[240:255]
  ds_read_b128 v[44:47], v206 offset:4096
  s_add_u32 m0, s67, 44032
  s_nop 0
  buffer_load_dwordx4 v202, s[4:7], s60 offen offset:1024 lds
  s_waitcnt lgkmcnt(2)
  v_mfma_f32_32x32x16_bf16 v[240:255], a[68:71], v[36:39], v[240:255]
  ds_read_b128 v[32:35], v203 offset:5120
  s_waitcnt lgkmcnt(2)
  v_mfma_f32_32x32x16_bf16 v[240:255], a[72:75], v[40:43], v[240:255]
  ds_read_b128 v[36:39], v204 offset:5120
  buffer_store_dwordx4 v[176:179], v201, s[8:11], s72 offen offset:0 sc1
  s_waitcnt lgkmcnt(2)
  v_mfma_f32_32x32x16_bf16 v[240:255], a[76:79], v[44:47], v[240:255]
  ds_read_b128 v[40:43], v205 offset:5120
  s_waitcnt lgkmcnt(2)
  v_mfma_f32_32x32x16_bf16 v[240:255], a[80:83], v[32:35], v[240:255]
  ds_read_b128 v[44:47], v206 offset:5120
  buffer_store_dwordx4 v[176:179], v201, s[8:11], s72 offen offset:1024 sc1
  s_waitcnt lgkmcnt(2)
  v_mfma_f32_32x32x16_bf16 v[240:255], a[84:87], v[36:39], v[240:255]
  ds_read_b128 v[32:35], v203 offset:6144
  s_waitcnt lgkmcnt(2)
  v_mfma_f32_32x32x16_bf16 v[240:255], a[88:91], v[40:43], v[240:255]
  ds_read_b128 v[36:39], v204 offset:6144
  s_waitcnt lgkmcnt(2)
  v_mfma_f32_32x32x16_bf16 v[240:255], a[92:95], v[44:47], v[240:255]
  ds_read_b128 v[40:43], v205 offset:6144
  s_waitcnt lgkmcnt(2)
  v_mfma_f32_32x32x16_bf16 v[240:255], a[96:99], v[32:35], v[240:255]
  ds_read_b128 v[44:47], v206 offset:6144
  s_waitcnt lgkmcnt(2)
  v_mfma_f32_32x32x16_bf16 v[240:255], a[100:103], v[36:39], v[240:255]
  ds_read_b128 v[32:35], v203 offset:7168
  s_waitcnt lgkmcnt(2)
  v_mfma_f32_32x32x16_bf16 v[240:255], a[104:107], v[40:43], v[240:255]
  ds_read_b128 v[36:39], v204 offset:7168
  s_waitcnt lgkmcnt(2)
  v_mfma_f32_32x32x16_bf16 v[240:255], a[108:111], v[44:47], v[240:255]
  ds_read_b128 v[40:43], v205 offset:7168
  s_waitcnt lgkmcnt(2)
  v_mfma_f32_32x32x16_bf16 v[240:255], a[112:115], v[32:35], v[240:255]
  ds_read_b128 v[44:47], v206 offset:7168
  s_waitcnt lgkmcnt(2)
  v_mfma_f32_32x32x16_bf16 v[240:255], a[116:119], v[36:39], v[240:255]
  ds_read_b128 v[32:35], v203 offset:8192
  s_waitcnt lgkmcnt(2)
  v_mfma_f32_32x32x16_bf16 v[240:255], a[120:123], v[40:43], v[240:255]
  ds_read_b128 v[36:39], v204 offset:8192
  s_waitcnt lgkmcnt(2)
  v_mfma_f32_32x32x16_bf16 v[240:255], a[124:127], v[44:47], v[240:255]
  ds_read_b128 v[40:43], v205 offset:8192
  s_waitcnt lgkmcnt(2)
  v_mfma_f32_32x32x16_bf16 v[240:255], a[128:131], v[32:35], v[240:255]
  ds_read_b128 v[44:47], v206 offset:8192
  s_waitcnt lgkmcnt(2)
  v_mfma_f32_32x32x16_bf16 v[240:255], a[132:135], v[36:39], v[240:255]
  s_waitcnt lgkmcnt(1)
  v_mfma_f32_32x32x16_bf16 v[240:255], a[136:139], v[40:43], v[240:255]
  s_waitcnt lgkmcnt(0)
  v_mfma_f32_32x32x16_bf16 v[240:255], a[140:143], v[44:47], v[240:255]
  s_nop 11
  v_cvt_pk_bf16_f32 v16, v240, v244
  v_cvt_pk_bf16_f32 v17, v241, v245
  v_cvt_pk_bf16_f32 v18, v242, v246
  v_cvt_pk_bf16_f32 v19, v243, v247
  ds_write_b128 v215, v[16:19] offset:0
  v_cvt_pk_bf16_f32 v20, v248, v252
  v_cvt_pk_bf16_f32 v21, v249, v253
  v_cvt_pk_bf16_f32 v22, v250, v254
  v_cvt_pk_bf16_f32 v23, v251, v255
  ds_write_b128 v215, v[20:23] offset:1024
  s_waitcnt lgkmcnt(0)
  s_barrier
  ds_read_b128 v[96:99], v208 offset:0
  ds_read_b128 v[100:103], v208 offset:1024
  ds_read_b128 v[104:107], v208 offset:2048
  ds_read_b128 v[108:111], v208 offset:3072
  ds_read_b128 v[112:115], v208 offset:4096
  ds_read_b128 v[116:119], v208 offset:5120
  ds_read_b128 v[120:123], v208 offset:6144
  ds_read_b128 v[124:127], v208 offset:7168
  s_waitcnt vmcnt(11)
  v_cmp_eq_u32 vcc, -1, v172
  s_mov_b32 s69, 0
  s_cbranch_vccnz AT_e0
  s_mov_b32 s69, 1
  buffer_load_dwordx4 v[172:175], v201, s[8:11], s76 offen sc1
AT_e0:
  s_waitcnt lgkmcnt(7)
  v_mfma_f32_32x32x16_bf16 v[64:79], v[128:131], v[96:99], v[48:63]
  s_waitcnt lgkmcnt(6)
  v_mfma_f32_32x32x16_bf16 v[64:79], v[132:135], v[100:103], v[64:79]
  s_waitcnt lgkmcnt(5)
  v_mfma_f32_32x32x16_bf16 v[64:79], v[136:139], v[104:107], v[64:79]
  s_waitcnt lgkmcnt(4)
  v_mfma_f32_32x32x16_bf16 v[64:79], v[140:143], v[108:111], v[64:79]
  s_waitcnt lgkmcnt(3)
  v_mfma_f32_32x32x16_bf16 v[64:79], v[144:147], v[112:115], v[64:79]
  s_waitcnt lgkmcnt(2)
  v_mfma_f32_32x32x16_bf16 v[64:79], v[148:151], v[116:119], v[64:79]
  s_waitcnt lgkmcnt(1)
  v_mfma_f32_32x32x16_bf16 v[64:79], v[152:155], v[120:123], v[64:79]
  s_waitcnt lgkmcnt(0)
  v_mfma_f32_32x32x16_bf16 v[64:79], v[156:159], v[124:127], v[64:79]
  s_nop 11
  v_max3_f32 v180, v64, v65, v66
  v_max3_f32 v180, v180, v67, v68
  v_max3_f32 v180, v180, v69, v70
  v_max3_f32 v180, v180, v71, v72
  v_max3_f32 v180, v180, v73, v74
  v_max3_f32 v180, v180, v75, v76
  v_max3_f32 v180, v180, v77, v78
  v_max_f32 v180, v180, v79
  v_mov_b32 v181, v180
  s_nop 1
  v_permlane32_swap_b32 v180, v181
  v_max_f32 v180, v180, v181
  v_sub_f32 v64, v64, v180
  v_sub_f32 v65, v65, v180
  v_sub_f32 v66, v66, v180
  v_sub_f32 v67, v67, v180
  v_sub_f32 v68, v68, v180
  v_sub_f32 v69, v69, v180
  v_sub_f32 v70, v70, v180
  v_sub_f32 v71, v71, v180
  v_sub_f32 v72, v72, v180
  v_sub_f32 v73, v73, v180
  v_sub_f32 v74, v74, v180
  v_sub_f32 v75, v75, v180
  v_sub_f32 v76, v76, v180
  v_sub_f32 v77, v77, v180
  v_sub_f32 v78, v78, v180
  v_sub_f32 v79, v79, v180
  v_exp_f32 v64, v64
  v_exp_f32 v65, v65
  v_exp_f32 v66, v66
  v_exp_f32 v67, v67
  v_exp_f32 v68, v68
  v_exp_f32 v69, v69
  v_exp_f32 v70, v70
  v_exp_f32 v71, v71
  v_exp_f32 v72, v72
  v_exp_f32 v73, v73
  v_exp_f32 v74, v74
  v_exp_f32 v75, v75
  v_exp_f32 v76, v76
  v_exp_f32 v77, v77
  v_exp_f32 v78, v78
  v_exp_f32 v79, v79
  v_cvt_pk_bf16_f32 v20, v64, v65
  v_cvt_pk_bf16_f32 v21, v68, v69
  v_cvt_pk_bf16_f32 v22, v72, v73
  v_cvt_pk_bf16_f32 v23, v76, v77
  v_cvt_pk_bf16_f32 v24, v66, v67
  v_cvt_pk_bf16_f32 v25, v70, v71
  v_cvt_pk_bf16_f32 v26, v74, v75
  v_cvt_pk_bf16_f32 v27, v78, v79
  v_mfma_f32_32x32x16_bf16 v[0:15], v[160:163], v[20:23], 0
  v_add_f32 v182, v64, v65
  v_add_f32 v182, v182, v66
  v_add_f32 v182, v182, v67
  v_add_f32 v182, v182, v68
  v_add_f32 v182, v182, v69
  v_add_f32 v182, v182, v70
  v_add_f32 v182, v182, v71
  v_mfma_f32_32x32x16_bf16 v[0:15], v[164:167], v[24:27], v[0:15]
  v_add_f32 v182, v182, v72
  v_add_f32 v182, v182, v73
  v_add_f32 v182, v182, v74
  v_add_f32 v182, v182, v75
  v_add_f32 v182, v182, v76
  v_add_f32 v182, v182, v77
  v_add_f32 v182, v182, v78
  v_add_f32 v182, v182, v79
AT_l1:
  s_cmp_eq_u32 s69, 1
  s_cbranch_scc1 AT_v1
  s_cmp_ge_u32 s77, 62
  s_cbranch_scc1 AT_k1
  s_branch AT_c1
AT_h1:
  s_sleep 2
AT_c1:
  buffer_load_dword v172, off, s[8:11], s70 sc1
  s_add_u32 s65, s65, 1
  s_cmp_lt_u32 s65, 131072
  s_cselect_b32 s54, -2, -1
  s_waitcnt vmcnt(0)
  v_cmp_lt_u32 vcc, s54, v172
  s_cbranch_vccnz AT_h1
AT_k1:
  buffer_load_dwordx4 v[172:175], v201, s[8:11], s76 offen sc1
AT_v1:
  s_mov_b32 s69, 0
  s_add_u32 s65, s65, 1
  s_cmp_lt_u32 s65, 131072
  s_cselect_b32 s54, -2, -1
  s_waitcnt vmcnt(0)
  ds_write_b64 v220, v[172:173] offset:4096
  ds_write_b64 v221, v[174:175] offset:4096
  v_max3_u32 v213, v172, v173, v174
  v_max_u32 v213, v213, v175
  v_cmp_lt_u32 vcc, s54, v213
  s_cbranch_vccnz AT_k1
  s_waitcnt lgkmcnt(0)
  s_barrier
  ds_read_b128 v[128:131], v218 offset:4096
  ds_read_b128 v[132:135], v218 offset:4352
  ds_read_b128 v[136:139], v218 offset:4608
  ds_read_b128 v[140:143], v218 offset:4864
  ds_read_b128 v[144:147], v218 offset:5120
  ds_read_b128 v[148:151], v218 offset:5376
  ds_read_b128 v[152:155], v218 offset:5632
  ds_read_b128 v[156:159], v218 offset:5888
  ds_read_b32 v168, v219 offset:4096
  ds_read_b32 v169, v219 offset:4224
  s_waitcnt lgkmcnt(9)
  v_mfma_f32_32x32x16_bf16 v[80:95], v[128:131], a[144:147], 0
  s_waitcnt lgkmcnt(8)
  v_mfma_f32_32x32x16_bf16 v[80:95], v[132:135], a[148:151], v[80:95]
  s_waitcnt lgkmcnt(7)
  v_mfma_f32_32x32x16_bf16 v[80:95], v[136:139], a[152:155], v[80:95]
  s_waitcnt lgkmcnt(6)
  v_mfma_f32_32x32x16_bf16 v[80:95], v[140:143], a[156:159], v[80:95]
  s_waitcnt lgkmcnt(5)
  v_mfma_f32_32x32x16_bf16 v[80:95], v[144:147], a[160:163], v[80:95]
  s_waitcnt lgkmcnt(4)
  v_mfma_f32_32x32x16_bf16 v[80:95], v[148:151], a[164:167], v[80:95]
  s_waitcnt lgkmcnt(3)
  v_mfma_f32_32x32x16_bf16 v[80:95], v[152:155], a[168:171], v[80:95]
  s_waitcnt lgkmcnt(2)
  v_mfma_f32_32x32x16_bf16 v[80:95], v[156:159], a[172:175], v[80:95]
  s_add_u32 s77, s77, 2
  v_mov_b32 v212, s77
  s_nop 9
  v_mul_f32 v80, s68, v80
  v_mul_f32 v81, s68, v81
  v_mul_f32 v82, s68, v82
  v_mul_f32 v83, s68, v83
  v_max3_f32 v84, v184, v80, v81
  v_max3_f32 v84, v84, v82, v83
  v_mov_b32 v85, v84
  s_nop 1
  v_permlane32_swap_b32 v84, v85
  v_max_f32 v84, v84, v85
  v_sub_f32 v86, v184, v84
  v_sub_f32 v80, v80, v84
  v_sub_f32 v81, v81, v84
  v_sub_f32 v82, v82, v84
  v_sub_f32 v83, v83, v84
  v_exp_f32 v86, v86
  v_exp_f32 v80, v80
  v_exp_f32 v81, v81
  v_exp_f32 v82, v82
  v_exp_f32 v83, v83
  v_fma_f32 v186, v186, v86, v80
  v_add_f32 v84, v81, v82
  v_add_f32 v186, v186, v83
  v_add_f32 v186, v186, v84
  v_mov_b32 v187, v186
  s_nop 1
  v_permlane32_swap_b32 v186, v187
  v_add_f32 v186, v186, v187
  v_rcp_f32 v186, v186
  s_nop 0
  v_mul_f32 v86, v86, v186
  v_mul_f32 v80, v186, v80
  v_mul_f32 v81, v186, v81
  v_mul_f32 v82, v186, v82
  v_mul_f32 v83, v186, v83
  v_cvt_pk_bf16_f32 v28, v80, v81
  v_cvt_pk_bf16_f32 v29, v82, v83
  v_mul_f32 v224, v86, v224
  v_mul_f32 v225, v86, v225
  v_mul_f32 v226, v86, v226
  v_mul_f32 v227, v86, v227
  v_mul_f32 v228, v86, v228
  v_mul_f32 v229, v86, v229
  v_mul_f32 v230, v86, v230
  v_mul_f32 v231, v86, v231
  v_mul_f32 v232, v86, v232
  v_mul_f32 v233, v86, v233
  v_mul_f32 v234, v86, v234
  v_mul_f32 v235, v86, v235
  v_mul_f32 v236, v86, v236
  v_mul_f32 v237, v86, v237
  v_mul_f32 v238, v86, v238
  v_mul_f32 v239, v86, v239
  s_waitcnt lgkmcnt(0)
  s_nop 0
  v_mfma_f32_32x32x8_bf16 v[224:239], v[168:169], v[28:29], v[224:239]
  s_nop 11
  v_cvt_pk_bf16_f32 v20, v224, v225
  v_cvt_pk_bf16_f32 v21, v226, v227
  v_cvt_pk_bf16_f32 v22, v228, v229
  v_cvt_pk_bf16_f32 v23, v230, v231
  buffer_store_dwordx4 v[20:23], v201, s[8:11], s75 offen offset:0 sc1
  v_cvt_pk_bf16_f32 v24, v232, v233
  v_cvt_pk_bf16_f32 v25, v234, v235
  v_cvt_pk_bf16_f32 v26, v236, v237
  v_cvt_pk_bf16_f32 v27, v238, v239
  buffer_store_dwordx4 v[24:27], v201, s[8:11], s75 offen offset:1024 sc1
  s_mov_b64 exec, 1
  buffer_store_dword v212, v201, s[8:11], s71 offen sc1
  s_mov_b64 exec, -1
  s_cmp_ge_u32 s77, 64
  s_cbranch_scc1 L_exit
  s_branch AT_loop
L_cexit:
L_exit:
L_end:
s_endpgm
.section .rodata,"a"
.p2align 6
.amdhsa_kernel gated_mix__sliding_local_dilated__memory_aug_recurrent_mem_tr__prompt_kernel
  .amdhsa_next_free_vgpr 512
  .amdhsa_next_free_sgpr 102
  .amdhsa_accum_offset 256
  .amdhsa_group_segment_fixed_size 0
  .amdhsa_kernarg_size 112
  .amdhsa_user_sgpr_count 2
  .amdhsa_user_sgpr_kernarg_segment_ptr 1
  .amdhsa_system_sgpr_workgroup_id_x 1
.end_amdhsa_kernel
```

```asm
; @launch grid=(256,1,1) block=(256,1,1) lds=163840
.amdgcn_target "amdgcn-amd-amdhsa--gfx950"
.text
.globl gated_mix__sliding_local_dilated__memory_aug_recurrent_mem_tr__prompt_kernel
.p2align 8
.type gated_mix__sliding_local_dilated__memory_aug_recurrent_mem_tr__prompt_kernel,@function
gated_mix__sliding_local_dilated__memory_aug_recurrent_mem_tr__prompt_kernel:
  s_cmp_ge_u32 s2, 256
  s_cbranch_scc1 L_end
  s_load_dwordx2 s[4:5], s[0:1], 0
  s_load_dwordx2 s[8:9], s[0:1], 104
  s_load_dwordx2 s[12:13], s[0:1], 96
  s_load_dwordx2 s[16:17], s[0:1], 40
  s_load_dwordx2 s[20:21], s[0:1], 48
  s_load_dwordx2 s[24:25], s[0:1], 56
  s_load_dwordx2 s[28:29], s[0:1], 64
  s_load_dwordx2 s[32:33], s[0:1], 32
  s_load_dwordx2 s[36:37], s[0:1], 8
  s_load_dwordx2 s[40:41], s[0:1], 16
  s_load_dwordx2 s[44:45], s[0:1], 80
  s_load_dwordx2 s[48:49], s[0:1], 88
  s_getreg_b32 s54, hwreg(HW_REG_XCC_ID, 0, 3)
  v_lshrrev_b32 v1, 6, v0
  s_nop 0
  v_readfirstlane_b32 s52, v1
  s_mov_b32 s6, 2359296
  s_mov_b32 s7, 0x20000
  s_mov_b32 s10, 268435456
  s_mov_b32 s11, 0x20000
  s_mov_b32 s14, 256
  s_mov_b32 s15, 0x20000
  s_mov_b32 s18, 4718592
  s_mov_b32 s19, 0x20000
  s_mov_b32 s22, 4718592
  s_mov_b32 s23, 0x20000
  s_mov_b32 s26, 4718592
  s_mov_b32 s27, 0x20000
  s_mov_b32 s30, 4718592
  s_mov_b32 s31, 0x20000
  s_mov_b32 s34, 9216
  s_mov_b32 s35, 0x20000
  s_mov_b32 s38, 1990656
  s_mov_b32 s39, 0x20000
  s_mov_b32 s42, 663552
  s_mov_b32 s43, 0x20000
  s_mov_b32 s46, 1152
  s_mov_b32 s47, 0x20000
  s_mov_b32 s50, 2359296
  s_mov_b32 s51, 0x20000
  s_waitcnt lgkmcnt(0)
  s_lshr_b32 s0, s2, 3
  s_mov_b32 s2, s54
  s_mov_b32 s1, 0
L_role:
  s_mov_b32 s53, s0
  s_cmp_eq_u32 s2, 0
  s_cbranch_scc0 L_worker
  v_and_b32 v0, 63, v0
  v_and_b32 v1, 15, v0
  v_lshrrev_b32 v2, 4, v0
  v_and_b32 v3, 1, v2
  s_lshl_b32 s54, s52, 1
  v_add_u32 v3, s54, v3
  v_lshlrev_b32 v3, 1, v3
  v_xor_b32 v3, v3, v1
  v_lshlrev_b32 v3, 4, v3
  v_lshl_add_u32 v8, v2, 13, v3
  s_lshl_b32 s78, s53, 8
  s_lshl_b32 s54, s52, 15
  s_add_u32 s78, s78, s54
  s_mul_i32 s79, s53, 147456
  s_lshl_b32 s57, s52, 10
  s_add_u32 s57, s57, 16384
  s_getpc_b64 s[80:81]
L_pc_1:
  s_and_b32 s55, s0, 1
  s_lshl_b32 s55, s55, 2
  s_add_u32 s55, s55, s52
  s_lshl_b32 s55, s55, 10
  v_and_b32 v199, 63, v0
  v_lshl_add_u32 v199, v199, 4, s55
  v_min_u32 v199, (L_w0 - L_pc_1), v199
  global_load_dword v196, v199, s[80:81]
  s_add_u32 m0, s57, 0
  s_add_u32 s54, s78, 0
  buffer_load_dwordx4 v8, s[16:19], s54 offen  lds
  s_add_u32 m0, s57, 4096
  s_add_u32 s54, s78, 131072
  buffer_load_dwordx4 v8, s[16:19], s54 offen  lds
  s_add_u32 m0, s57, 8192
  s_add_u32 s54, s78, 262144
  buffer_load_dwordx4 v8, s[16:19], s54 offen  lds
  s_add_u32 m0, s57, 12288
  s_add_u32 s54, s78, 393216
  buffer_load_dwordx4 v8, s[16:19], s54 offen  lds
  s_add_u32 m0, s57, 16384
  s_add_u32 s54, s78, 524288
  buffer_load_dwordx4 v8, s[16:19], s54 offen  lds
  s_add_u32 m0, s57, 20480
  s_add_u32 s54, s78, 655360
  buffer_load_dwordx4 v8, s[16:19], s54 offen  lds
  s_add_u32 m0, s57, 24576
  s_add_u32 s54, s78, 786432
  buffer_load_dwordx4 v8, s[16:19], s54 offen  lds
  s_add_u32 m0, s57, 28672
  s_add_u32 s54, s78, 917504
  buffer_load_dwordx4 v8, s[16:19], s54 offen  lds
  s_add_u32 m0, s57, 32768
  s_add_u32 s54, s78, 1048576
  buffer_load_dwordx4 v8, s[16:19], s54 offen  lds
  s_add_u32 m0, s57, 36864
  s_add_u32 s54, s78, 1179648
  buffer_load_dwordx4 v8, s[16:19], s54 offen  lds
  s_add_u32 m0, s57, 40960
  s_add_u32 s54, s78, 1310720
  buffer_load_dwordx4 v8, s[16:19], s54 offen  lds
  s_add_u32 m0, s57, 45056
  s_add_u32 s54, s78, 1441792
  buffer_load_dwordx4 v8, s[16:19], s54 offen  lds
  s_add_u32 m0, s57, 49152
  s_add_u32 s54, s78, 1572864
  buffer_load_dwordx4 v8, s[16:19], s54 offen  lds
  s_add_u32 m0, s57, 53248
  s_add_u32 s54, s78, 1703936
  buffer_load_dwordx4 v8, s[16:19], s54 offen  lds
  s_add_u32 m0, s57, 57344
  s_add_u32 s54, s78, 1835008
  buffer_load_dwordx4 v8, s[16:19], s54 offen  lds
  s_add_u32 m0, s57, 61440
  s_add_u32 s54, s78, 1966080
  buffer_load_dwordx4 v8, s[16:19], s54 offen  lds
  v_lshlrev_b32 v76, 4, v0
  v_add_u32 v75, 0x10000, v76
  v_lshrrev_b32 v3, 2, v1
  v_and_b32 v4, 1, v1
  v_lshl_add_u32 v3, v3, 1, v4
  v_bfe_u32 v4, v1, 1, 1
  v_mul_u32_u24 v74, 0xaaaa, v4
  v_add_u32 v74, 0x4444, v74
  v_mul_u32_u24 v5, 576, v3
  v_add_u32 v5, 0, v5
  v_lshl_add_u32 v78, v2, 4, v5
  v_lshl_add_u32 v77, v2, 5, v5
  v_lshl_add_u32 v77, v4, 4, v77
  v_mul_u32_u24 v15, 1152, v3
  v_lshl_add_u32 v15, v2, 5, v15
  v_lshl_add_u32 v15, v4, 4, v15
  s_lshl_b32 s54, s52, 8
  buffer_load_dwordx4 v[20:23], v15, s[32:35], s54 offen
  buffer_load_dwordx4 v[24:27], v15, s[32:35], s54 offen offset:128
  buffer_load_dwordx4 v[28:31], v15, s[32:35], 0 offen offset:1024
  v_mul_u32_u24 v79, 1152, v2
  v_lshl_add_u32 v79, v1, 2, v79
  s_lshl_b32 s54, s52, 6
  s_add_u32 s54, s54, 0
  v_add_u32 v79, s54, v79
  v_lshrrev_b32 v5, 3, v0
  v_mul_u32_u24 v68, 2176, v5
  v_and_b32 v5, 7, v0
  v_lshl_add_u32 v68, v5, 3, v68
  v_lshrrev_b32 v6, 3, v0
  s_lshr_b32 s54, s53, 2
  v_add_u32 v68, s54, v6
  v_and_b32 v68, 7, v68
  v_xor_b32 v68, v68, v6
  v_lshlrev_b32 v68, 8, v68
  v_lshl_add_u32 v68, v6, 12, v68
  v_lshl_add_u32 v68, v5, 3, v68
  s_and_b32 s54, s53, 3
  s_lshl_b32 s54, s54, 6
  v_add_u32 v68, s54, v68
  v_and_b32 v5, 1, v2
  v_lshlrev_b32 v5, 4, v5
  v_lshl_add_u32 v5, v1, 2, v5
  v_mov_b32 v6, 0x40000000
  v_cmp_lt_u32 vcc, 3, v1
  s_nop 1
  v_cndmask_b32 v5, v5, v6, vcc
  v_lshrrev_b32 v6, 1, v2
  v_lshl_add_u32 v69, v6, 10, v5
  v_lshl_add_u32 v70, v6, 8, v5
  v_mov_b32 v71, -1
  ds_write_b128 v76, v[68:71] offset:13824
  v_and_b32 v5, 3, v1
  v_lshrrev_b32 v6, 2, v1
  v_lshl_add_u32 v5, v5, 2, v6
  v_and_b32 v6, 1, v5
  v_lshlrev_b32 v6, 4, v6
  v_mov_b32 v7, 0x3f80
  v_lshlrev_b32 v6, v6, v7
  v_lshrrev_b32 v5, 1, v5
  v_cmp_eq_u32 vcc, 0, v5
  s_nop 1
  v_cndmask_b32 v40, 0, v6, vcc
  v_cmp_eq_u32 vcc, 1, v5
  s_nop 1
  v_cndmask_b32 v41, 0, v6, vcc
  v_cmp_eq_u32 vcc, 2, v5
  s_nop 1
  v_cndmask_b32 v42, 0, v6, vcc
  v_cmp_eq_u32 vcc, 3, v5
  s_nop 1
  v_cndmask_b32 v43, 0, v6, vcc
  ds_write_b128 v76, v[40:43] offset:14848
  s_and_b32 s54, s52, 1
  s_lshr_b32 s55, s52, 1
  v_lshrrev_b32 v3, 3, v0
  v_and_b32 v4, 1, v3
  v_lshlrev_b32 v4, 4, v4
  v_and_b32 v5, 6, v3
  v_add_u32 v4, v4, v5
  s_lshl_b32 s56, s55, 3
  s_add_u32 s56, s56, s54
  v_add_u32 v4, s56, v4
  v_mul_u32_u24 v4, 1152, v4
  v_and_b32 v5, 2, v3
  v_lshlrev_b32 v5, 1, v5
  v_and_b32 v6, 7, v0
  v_xor_b32 v6, v6, v5
  v_lshl_add_u32 v9, v6, 4, v4
  v_and_b32 v4, 1, v2
  v_lshlrev_b32 v4, 4, v4
  v_and_b32 v5, 2, v2
  v_add_u32 v4, v4, v5
  s_lshl_b32 s56, s55, 2
  s_add_u32 s56, s56, s54
  v_add_u32 v4, s56, v4
  v_mul_u32_u24 v4, 1152, v4
  v_lshlrev_b32 v6, 1, v2
  v_xor_b32 v6, v6, v1
  v_lshl_add_u32 v10, v6, 4, v4
  v_bfe_u32 v17, v1, 2, 1
  v_bfe_u32 v18, v1, 3, 1
  v_and_b32 v19, 1, v2
  v_lshrrev_b32 v72, 1, v2
  v_and_b32 v73, 3, v1
  v_lshl_add_u32 v3, v19, 1, v17
  v_lshl_add_u32 v6, v18, 2, v3
  v_lshl_add_u32 v4, v72, 4, v17
  v_lshl_add_u32 v4, v19, 2, v4
  v_lshl_add_u32 v4, v18, 3, v4
  v_lshlrev_b32 v4, 8, v4
  s_lshl_b32 s54, s52, 6
  v_lshl_add_u32 v5, v73, 3, s54
  v_lshlrev_b32 v7, 5, v6
  v_xor_b32 v5, v5, v7
  v_add_u32 v11, v4, v5
  v_xor_b32 v12, 32, v11
  v_lshl_add_u32 v4, v72, 2, v3
  v_lshlrev_b32 v4, 7, v4
  v_lshl_add_u32 v4, v73, 3, v4
  s_and_b32 s54, s52, 1
  v_xor_b32 v7, s54, v19
  v_lshl_add_u32 v7, v7, 1, v18
  v_lshl_add_u32 v13, v7, 5, v4
  v_lshlrev_b32 v4, 11, v72
  v_lshl_add_u32 v4, v73, 3, v4
  v_lshl_add_u32 v5, v3, 8, v4
  v_lshl_add_u32 v7, v18, 2, s52
  v_xor_b32 v7, v7, v3
  v_lshl_add_u32 v14, v7, 5, v5
  s_lshl_b32 s54, s53, 14
  s_lshl_b32 s55, s52, 11
  s_add_u32 s54, s54, 1048576
  s_add_u32 s58, s54, s55
  s_add_u32 s59, s58, 8192
  s_lshl_b32 s55, s52, 12
  s_add_u32 s70, s54, s55
  s_add_u32 s70, s70, 655360
  s_lshl_b32 s54, s53, 12
  s_lshl_b32 s55, s52, 10
  s_add_u32 s54, s54, s55
  s_add_u32 s68, s54, 917504
  s_lshl_b32 s54, s53, 6
  s_mul_i32 s55, s52, 17408
  s_add_u32 s55, s54, s55
  s_add_u32 s73, s55, 0
  s_add_u32 s74, s55, 69632
  s_add_u32 s75, s55, 139264
  s_add_u32 s76, s55, 208896
  s_and_b32 s56, s52, 1
  s_mul_i32 s55, s56, 17408
  s_add_u32 s55, s54, s55
  s_add_u32 s77, s55, 278528
  s_mul_i32 s54, s52, 69632
  s_mul_i32 s55, s53, 2176
  s_add_u32 s54, s54, s55
  s_add_u32 s60, s54, 0
  s_and_b32 s56, s53, 15
  s_mul_i32 s55, s56, 2176
  s_add_u32 s61, s55, 278528
  s_lshr_b32 s54, s52, 1
  s_lshl_b32 s54, s54, 15
  s_and_b32 s55, s52, 1
  s_lshl_b32 s55, s55, 11
  s_add_u32 s54, s54, s55
  s_add_u32 s73, s54, 0
  s_add_u32 s74, s54, 65536
  s_add_u32 s75, s54, 131072
  s_add_u32 s76, s54, 196608
  s_add_u32 s77, s55, 262144
  s_and_b32 s54, s53, 7
  s_lshl_b32 s54, s54, 12
  s_bfe_u32 s55, s53, 0x10003
  s_lshl_b32 s55, s55, 11
  s_add_u32 s54, s54, s55
  s_add_u32 s61, s54, 262144
  s_lshr_b32 s55, s53, 4
  s_lshl_b32 s55, s55, 15
  s_add_u32 s54, s54, s55
  s_lshl_b32 s55, s52, 16
  s_add_u32 s54, s54, s55
  s_add_u32 s60, s54, 0
  s_lshl_b32 s54, s52, 11
  s_add_u32 s64, s54, 360448
  s_mov_b32 s65, 368640
  s_lshl_b32 s55, s53, 5
  s_add_u32 s54, s54, s55
  s_add_u32 s62, s54, 376832
  s_lshr_b32 s54, s56, 3
  s_lshl_b32 s54, s54, 9
  s_and_b32 s55, s56, 7
  s_lshl_b32 s55, s55, 5
  s_add_u32 s54, s54, s55
  s_add_u32 s63, s54, 385024
  s_mov_b32 s66, 0
  s_mov_b32 s67, 0
  s_mov_b32 s72, 0
  s_mov_b32 s69, 1040356334
  s_waitcnt vmcnt(15) lgkmcnt(0)
  s_barrier
  s_add_u32 m0, s57, 65536
  s_add_u32 s54, s78, 2097152
  buffer_load_dwordx4 v8, s[16:19], s54 offen  lds
  s_add_u32 m0, s57, 69632
  s_add_u32 s54, s78, 2228224
  buffer_load_dwordx4 v8, s[16:19], s54 offen  lds
  s_add_u32 m0, s57, 73728
  s_add_u32 s54, s78, 2359296
  buffer_load_dwordx4 v8, s[16:19], s54 offen  lds
  s_add_u32 m0, s57, 77824
  s_add_u32 s54, s78, 2490368
  buffer_load_dwordx4 v8, s[16:19], s54 offen  lds
  s_lshl_b32 s55, s2, 2
  s_or_b32 s56, s52, s1
  s_cmp_eq_u32 s56, 0
  s_cselect_b32 s55, s55, 0x1000
  s_lshl_b32 s56, 1, s0
  v_mov_b32 v35, s56
  s_mov_b64 exec, 1
  buffer_atomic_or v35, off, s[12:15], s55 sc0
  s_mov_b64 exec, -1
  v_add_u32 v15, 16384, v11
  v_add_u32 v16, 16384, v12
  ds_read_b64_tr_b16 v[80:81], v15 offset:0
  ds_read_b64_tr_b16 v[82:83], v15 offset:512
  ds_read_b64_tr_b16 v[84:85], v15 offset:8192
  ds_read_b64_tr_b16 v[86:87], v15 offset:8704
  ds_read_b64_tr_b16 v[88:89], v16 offset:0
  ds_read_b64_tr_b16 v[90:91], v16 offset:512
  ds_read_b64_tr_b16 v[92:93], v16 offset:8192
  ds_read_b64_tr_b16 v[94:95], v16 offset:8704
  s_waitcnt vmcnt(16) lgkmcnt(0)
  s_barrier
  s_add_u32 m0, s57, 81920
  s_add_u32 s54, s78, 2621440
  buffer_load_dwordx4 v8, s[16:19], s54 offen  lds
  s_add_u32 m0, s57, 86016
  s_add_u32 s54, s78, 2752512
  buffer_load_dwordx4 v8, s[16:19], s54 offen  lds
  s_add_u32 m0, s57, 90112
  s_add_u32 s54, s78, 2883584
  buffer_load_dwordx4 v8, s[16:19], s54 offen  lds
  s_add_u32 m0, s57, 94208
  s_add_u32 s54, s78, 3014656
  buffer_load_dwordx4 v8, s[16:19], s54 offen  lds
  v_add_u32 v15, 32768, v11
  v_add_u32 v16, 32768, v12
  ds_read_b64_tr_b16 v[96:97], v15 offset:0
  ds_read_b64_tr_b16 v[98:99], v15 offset:512
  ds_read_b64_tr_b16 v[100:101], v15 offset:8192
  ds_read_b64_tr_b16 v[102:103], v15 offset:8704
  ds_read_b64_tr_b16 v[104:105], v16 offset:0
  ds_read_b64_tr_b16 v[106:107], v16 offset:512
  ds_read_b64_tr_b16 v[108:109], v16 offset:8192
  ds_read_b64_tr_b16 v[110:111], v16 offset:8704
  s_waitcnt vmcnt(16) lgkmcnt(0)
  s_barrier
  s_add_u32 m0, s57, 98304
  s_add_u32 s54, s78, 3670016
  buffer_load_dwordx4 v8, s[16:19], s54 offen  lds
  s_add_u32 m0, s57, 102400
  s_add_u32 s54, s78, 3801088
  buffer_load_dwordx4 v8, s[16:19], s54 offen  lds
  s_add_u32 m0, s57, 106496
  s_add_u32 s54, s78, 3932160
  buffer_load_dwordx4 v8, s[16:19], s54 offen  lds
  s_add_u32 m0, s57, 110592
  s_add_u32 s54, s78, 4063232
  buffer_load_dwordx4 v8, s[16:19], s54 offen  lds
  v_add_u32 v15, 49152, v11
  v_add_u32 v16, 49152, v12
  ds_read_b64_tr_b16 v[112:113], v15 offset:0
  ds_read_b64_tr_b16 v[114:115], v15 offset:512
  ds_read_b64_tr_b16 v[116:117], v15 offset:8192
  ds_read_b64_tr_b16 v[118:119], v15 offset:8704
  ds_read_b64_tr_b16 v[120:121], v16 offset:0
  ds_read_b64_tr_b16 v[122:123], v16 offset:512
  ds_read_b64_tr_b16 v[124:125], v16 offset:8192
  ds_read_b64_tr_b16 v[126:127], v16 offset:8704
  s_waitcnt vmcnt(16) lgkmcnt(0)
  s_barrier
  s_add_u32 m0, s57, 114688
  s_add_u32 s54, s78, 4194304
  buffer_load_dwordx4 v8, s[16:19], s54 offen  lds
  s_add_u32 m0, s57, 118784
  s_add_u32 s54, s78, 4325376
  buffer_load_dwordx4 v8, s[16:19], s54 offen  lds
  s_add_u32 m0, s57, 122880
  s_add_u32 s54, s78, 4456448
  buffer_load_dwordx4 v8, s[16:19], s54 offen  lds
  s_add_u32 m0, s57, 126976
  s_add_u32 s54, s78, 4587520
  buffer_load_dwordx4 v8, s[16:19], s54 offen  lds
  v_add_u32 v15, 65536, v11
  v_add_u32 v16, 65536, v12
  ds_read_b64_tr_b16 v[128:129], v15 offset:0
  ds_read_b64_tr_b16 v[130:131], v15 offset:512
  ds_read_b64_tr_b16 v[132:133], v15 offset:8192
  ds_read_b64_tr_b16 v[134:135], v15 offset:8704
  ds_read_b64_tr_b16 v[136:137], v16 offset:0
  ds_read_b64_tr_b16 v[138:139], v16 offset:512
  ds_read_b64_tr_b16 v[140:141], v16 offset:8192
  ds_read_b64_tr_b16 v[142:143], v16 offset:8704
  s_waitcnt vmcnt(13) lgkmcnt(0)
  s_barrier
  s_add_u32 m0, s57, 131072
  s_add_u32 s54, s78, 1048576
  buffer_load_dwordx4 v8, s[20:23], s54 offen  lds
  s_add_u32 m0, s57, 135168
  s_add_u32 s54, s78, 1179648
  buffer_load_dwordx4 v8, s[20:23], s54 offen  lds
  s_add_u32 m0, s57, 139264
  s_add_u32 s54, s78, 1310720
  buffer_load_dwordx4 v8, s[20:23], s54 offen  lds
  s_add_u32 m0, s57, 143360
  s_add_u32 s54, s78, 1441792
  buffer_load_dwordx4 v8, s[20:23], s54 offen  lds
  v_add_u32 v15, 81920, v11
  v_add_u32 v16, 81920, v12
  ds_read_b64_tr_b16 v[144:145], v15 offset:0
  ds_read_b64_tr_b16 v[146:147], v15 offset:512
  ds_read_b64_tr_b16 v[148:149], v15 offset:8192
  ds_read_b64_tr_b16 v[150:151], v15 offset:8704
  ds_read_b64_tr_b16 v[152:153], v16 offset:0
  ds_read_b64_tr_b16 v[154:155], v16 offset:512
  ds_read_b64_tr_b16 v[156:157], v16 offset:8192
  ds_read_b64_tr_b16 v[158:159], v16 offset:8704
  s_waitcnt vmcnt(12) lgkmcnt(0)
  s_barrier
  s_add_u32 m0, s57, 0
  s_add_u32 s54, s78, 1572864
  buffer_load_dwordx4 v8, s[20:23], s54 offen  lds
  s_add_u32 m0, s57, 4096
  s_add_u32 s54, s78, 1703936
  buffer_load_dwordx4 v8, s[20:23], s54 offen  lds
  s_add_u32 m0, s57, 8192
  s_add_u32 s54, s78, 1835008
  buffer_load_dwordx4 v8, s[20:23], s54 offen  lds
  s_add_u32 m0, s57, 12288
  s_add_u32 s54, s78, 1966080
  buffer_load_dwordx4 v8, s[20:23], s54 offen  lds
  v_add_u32 v15, 98304, v11
  v_add_u32 v16, 98304, v12
  ds_read_b64_tr_b16 v[160:161], v15 offset:0
  ds_read_b64_tr_b16 v[162:163], v15 offset:512
  ds_read_b64_tr_b16 v[164:165], v15 offset:8192
  ds_read_b64_tr_b16 v[166:167], v15 offset:8704
  ds_read_b64_tr_b16 v[168:169], v16 offset:0
  ds_read_b64_tr_b16 v[170:171], v16 offset:512
  ds_read_b64_tr_b16 v[172:173], v16 offset:8192
  ds_read_b64_tr_b16 v[174:175], v16 offset:8704
  s_waitcnt vmcnt(12) lgkmcnt(0)
  s_barrier
  s_add_u32 m0, s57, 16384
  s_add_u32 s54, s78, 3145728
  buffer_load_dwordx4 v8, s[20:23], s54 offen  lds
  s_add_u32 m0, s57, 20480
  s_add_u32 s54, s78, 3276800
  buffer_load_dwordx4 v8, s[20:23], s54 offen  lds
  s_add_u32 m0, s57, 24576
  s_add_u32 s54, s78, 3407872
  buffer_load_dwordx4 v8, s[20:23], s54 offen  lds
  s_add_u32 m0, s57, 28672
  s_add_u32 s54, s78, 3538944
  buffer_load_dwordx4 v8, s[20:23], s54 offen  lds
  v_add_u32 v15, 114688, v11
  v_add_u32 v16, 114688, v12
  ds_read_b64_tr_b16 v[176:177], v15 offset:0
  ds_read_b64_tr_b16 v[178:179], v15 offset:512
  ds_read_b64_tr_b16 v[180:181], v15 offset:8192
  ds_read_b64_tr_b16 v[182:183], v15 offset:8704
  ds_read_b64_tr_b16 v[184:185], v16 offset:0
  ds_read_b64_tr_b16 v[186:187], v16 offset:512
  ds_read_b64_tr_b16 v[188:189], v16 offset:8192
  ds_read_b64_tr_b16 v[190:191], v16 offset:8704
  s_waitcnt vmcnt(12) lgkmcnt(0)
  s_barrier
  s_add_u32 m0, s57, 32768
  s_add_u32 s54, s78, 3670016
  buffer_load_dwordx4 v8, s[20:23], s54 offen  lds
  s_add_u32 m0, s57, 36864
  s_add_u32 s54, s78, 3801088
  buffer_load_dwordx4 v8, s[20:23], s54 offen  lds
  s_add_u32 m0, s57, 40960
  s_add_u32 s54, s78, 3932160
  buffer_load_dwordx4 v8, s[20:23], s54 offen  lds
  s_add_u32 m0, s57, 45056
  s_add_u32 s54, s78, 4063232
  buffer_load_dwordx4 v8, s[20:23], s54 offen  lds
  v_add_u32 v15, 131072, v11
  v_add_u32 v16, 131072, v12
  ds_read_b64_tr_b16 v[192:193], v15 offset:0
  ds_read_b64_tr_b16 v[194:195], v15 offset:512
  ds_read_b64_tr_b16 v[196:197], v15 offset:8192
  ds_read_b64_tr_b16 v[198:199], v15 offset:8704
  ds_read_b64_tr_b16 v[200:201], v16 offset:0
  ds_read_b64_tr_b16 v[202:203], v16 offset:512
  ds_read_b64_tr_b16 v[204:205], v16 offset:8192
  ds_read_b64_tr_b16 v[206:207], v16 offset:8704
  s_waitcnt vmcnt(12) lgkmcnt(0)
  s_barrier
  s_add_u32 m0, s57, 49152
  s_add_u32 s54, s78, 4194304
  buffer_load_dwordx4 v8, s[20:23], s54 offen  lds
  s_add_u32 m0, s57, 53248
  s_add_u32 s54, s78, 4325376
  buffer_load_dwordx4 v8, s[20:23], s54 offen  lds
  s_add_u32 m0, s57, 57344
  s_add_u32 s54, s78, 4456448
  buffer_load_dwordx4 v8, s[20:23], s54 offen  lds
  s_add_u32 m0, s57, 61440
  s_add_u32 s54, s78, 4587520
  buffer_load_dwordx4 v8, s[20:23], s54 offen  lds
  s_getpc_b64 s[80:81]
  v_lshlrev_b32 v7, 2, v76
  global_load_dword v19, v7, s[80:81] offset:1024
  s_cmp_eq_u32 s1, 1
  s_cbranch_scc1 C_ver_ok
  v_mov_b32 v33, 16320
  s_cmp_eq_u32 s52, 0
  s_cbranch_scc0 C_ver_b
  s_waitcnt vmcnt(33)
  s_mov_b64 exec, 1
  ds_write_b32 v33, v35
  s_mov_b64 exec, -1
  s_waitcnt lgkmcnt(0)
C_ver_b:
  s_barrier
  ds_read_b32 v32, v33
  s_waitcnt lgkmcnt(0)
  v_readfirstlane_b32 s54, v32
  s_nop 0
  s_bitcmp1_b32 s54, s0
  s_cbranch_scc1 L_conf
C_ver_ok:
  v_min_u32 v20, -2, v20
  v_min_u32 v21, -2, v21
  v_min_u32 v22, -2, v22
  v_min_u32 v23, -2, v23
  v_min_u32 v24, -2, v24
  v_min_u32 v25, -2, v25
  v_min_u32 v26, -2, v26
  v_min_u32 v27, -2, v27
  v_min_u32 v28, -2, v28
  v_min_u32 v29, -2, v29
  v_min_u32 v30, -2, v30
  v_min_u32 v31, -2, v31
  s_lshl_b32 s54, s52, 11
  v_add_u32 v3, s54, v76
  ds_write_b128 v3, v[20:23] offset:4608
  ds_write_b128 v3, v[24:27] offset:5632
  ds_write_b128 v76, v[28:31] offset:12800
  v_add_u32 v15, 147456, v11
  v_add_u32 v16, 147456, v12
  ds_read_b64_tr_b16 v[208:209], v15 offset:0
  ds_read_b64_tr_b16 v[210:211], v15 offset:512
  ds_read_b64_tr_b16 v[212:213], v15 offset:8192
  ds_read_b64_tr_b16 v[214:215], v15 offset:8704
  ds_read_b64_tr_b16 v[216:217], v16 offset:0
  ds_read_b64_tr_b16 v[218:219], v16 offset:512
  ds_read_b64_tr_b16 v[220:221], v16 offset:8192
  ds_read_b64_tr_b16 v[222:223], v16 offset:8704
  s_waitcnt vmcnt(13) lgkmcnt(0)
  s_barrier
  s_add_u32 m0, s57, 65536
  s_add_u32 s54, s78, 0
  buffer_load_dwordx4 v8, s[24:27], s54 offen  lds
  s_add_u32 m0, s57, 69632
  s_add_u32 s54, s78, 131072
  buffer_load_dwordx4 v8, s[24:27], s54 offen  lds
  s_add_u32 m0, s57, 73728
  s_add_u32 s54, s78, 262144
  buffer_load_dwordx4 v8, s[24:27], s54 offen  lds
  s_add_u32 m0, s57, 77824
  s_add_u32 s54, s78, 393216
  buffer_load_dwordx4 v8, s[24:27], s54 offen  lds
  v_add_u32 v15, 16384, v11
  v_add_u32 v16, 16384, v12
  ds_read_b64_tr_b16 v[224:225], v15 offset:0
  ds_read_b64_tr_b16 v[226:227], v15 offset:512
  ds_read_b64_tr_b16 v[228:229], v15 offset:8192
  ds_read_b64_tr_b16 v[230:231], v15 offset:8704
  ds_read_b64_tr_b16 v[232:233], v16 offset:0
  ds_read_b64_tr_b16 v[234:235], v16 offset:512
  ds_read_b64_tr_b16 v[236:237], v16 offset:8192
  ds_read_b64_tr_b16 v[238:239], v16 offset:8704
  s_waitcnt vmcnt(13) lgkmcnt(0)
  s_barrier
  s_add_u32 m0, s57, 81920
  s_add_u32 s54, s78, 524288
  buffer_load_dwordx4 v8, s[24:27], s54 offen  lds
  s_add_u32 m0, s57, 86016
  s_add_u32 s54, s78, 655360
  buffer_load_dwordx4 v8, s[24:27], s54 offen  lds
  s_add_u32 m0, s57, 90112
  s_add_u32 s54, s78, 786432
  buffer_load_dwordx4 v8, s[24:27], s54 offen  lds
  s_add_u32 m0, s57, 94208
  s_add_u32 s54, s78, 917504
  buffer_load_dwordx4 v8, s[24:27], s54 offen  lds
  v_add_u32 v15, 32768, v11
  v_add_u32 v16, 32768, v12
  ds_read_b64_tr_b16 v[240:241], v15 offset:0
  ds_read_b64_tr_b16 v[242:243], v15 offset:512
  ds_read_b64_tr_b16 v[244:245], v15 offset:8192
  ds_read_b64_tr_b16 v[246:247], v15 offset:8704
  ds_read_b64_tr_b16 v[248:249], v16 offset:0
  ds_read_b64_tr_b16 v[250:251], v16 offset:512
  ds_read_b64_tr_b16 v[252:253], v16 offset:8192
  ds_read_b64_tr_b16 v[254:255], v16 offset:8704
  s_waitcnt vmcnt(13) lgkmcnt(0)
  s_barrier
  s_add_u32 m0, s57, 98304
  s_add_u32 s54, s78, 1048576
  buffer_load_dwordx4 v8, s[24:27], s54 offen  lds
  s_add_u32 m0, s57, 102400
  s_add_u32 s54, s78, 1179648
  buffer_load_dwordx4 v8, s[24:27], s54 offen  lds
  s_add_u32 m0, s57, 106496
  s_add_u32 s54, s78, 1310720
  buffer_load_dwordx4 v8, s[24:27], s54 offen  lds
  s_add_u32 m0, s57, 110592
  s_add_u32 s54, s78, 1441792
  buffer_load_dwordx4 v8, s[24:27], s54 offen  lds
  v_add_u32 v15, 49152, v11
  v_add_u32 v16, 49152, v12
  ds_read_b64_tr_b16 a[0:1], v15 offset:0
  ds_read_b64_tr_b16 a[2:3], v15 offset:512
  ds_read_b64_tr_b16 a[4:5], v15 offset:8192
  ds_read_b64_tr_b16 a[6:7], v15 offset:8704
  ds_read_b64_tr_b16 a[8:9], v16 offset:0
  ds_read_b64_tr_b16 a[10:11], v16 offset:512
  ds_read_b64_tr_b16 a[12:13], v16 offset:8192
  ds_read_b64_tr_b16 a[14:15], v16 offset:8704
  s_waitcnt vmcnt(13) lgkmcnt(0)
  s_barrier
  s_add_u32 m0, s57, 114688
  s_add_u32 s54, s78, 1572864
  buffer_load_dwordx4 v8, s[24:27], s54 offen  lds
  s_add_u32 m0, s57, 118784
  s_add_u32 s54, s78, 1703936
  buffer_load_dwordx4 v8, s[24:27], s54 offen  lds
  s_add_u32 m0, s57, 122880
  s_add_u32 s54, s78, 1835008
  buffer_load_dwordx4 v8, s[24:27], s54 offen  lds
  s_add_u32 m0, s57, 126976
  s_add_u32 s54, s78, 1966080
  buffer_load_dwordx4 v8, s[24:27], s54 offen  lds
  v_add_u32 v15, 65536, v11
  v_add_u32 v16, 65536, v12
  ds_read_b64_tr_b16 a[16:17], v15 offset:0
  ds_read_b64_tr_b16 a[18:19], v15 offset:512
  ds_read_b64_tr_b16 a[20:21], v15 offset:8192
  ds_read_b64_tr_b16 a[22:23], v15 offset:8704
  ds_read_b64_tr_b16 a[24:25], v16 offset:0
  ds_read_b64_tr_b16 a[26:27], v16 offset:512
  ds_read_b64_tr_b16 a[28:29], v16 offset:8192
  ds_read_b64_tr_b16 a[30:31], v16 offset:8704
  s_waitcnt vmcnt(12) lgkmcnt(0)
  s_barrier
  s_add_u32 m0, s57, 131072
  s_add_u32 s54, s78, 2097152
  buffer_load_dwordx4 v8, s[24:27], s54 offen  lds
  s_add_u32 m0, s57, 135168
  s_add_u32 s54, s78, 2228224
  buffer_load_dwordx4 v8, s[24:27], s54 offen  lds
  s_add_u32 m0, s57, 139264
  s_add_u32 s54, s78, 2359296
  buffer_load_dwordx4 v8, s[24:27], s54 offen  lds
  s_add_u32 m0, s57, 143360
  s_add_u32 s54, s78, 2490368
  buffer_load_dwordx4 v8, s[24:27], s54 offen  lds
  v_add_u32 v15, 81920, v11
  v_add_u32 v16, 81920, v12
  ds_read_b64_tr_b16 a[32:33], v15 offset:0
  ds_read_b64_tr_b16 a[34:35], v15 offset:512
  ds_read_b64_tr_b16 a[36:37], v15 offset:8192
  ds_read_b64_tr_b16 a[38:39], v15 offset:8704
  ds_read_b64_tr_b16 a[40:41], v16 offset:0
  ds_read_b64_tr_b16 a[42:43], v16 offset:512
  ds_read_b64_tr_b16 a[44:45], v16 offset:8192
  ds_read_b64_tr_b16 a[46:47], v16 offset:8704
  s_waitcnt vmcnt(12) lgkmcnt(0)
  s_barrier
  s_add_u32 m0, s57, 0
  s_add_u32 s54, s78, 2621440
  buffer_load_dwordx4 v8, s[24:27], s54 offen  lds
  s_add_u32 m0, s57, 4096
  s_add_u32 s54, s78, 2752512
  buffer_load_dwordx4 v8, s[24:27], s54 offen  lds
  s_add_u32 m0, s57, 8192
  s_add_u32 s54, s78, 2883584
  buffer_load_dwordx4 v8, s[24:27], s54 offen  lds
  s_add_u32 m0, s57, 12288
  s_add_u32 s54, s78, 3014656
  buffer_load_dwordx4 v8, s[24:27], s54 offen  lds
  s_getpc_b64 s[80:81]
  v_lshlrev_b32 v7, 2, v76
  global_load_dword v19, v7, s[80:81] offset:1024
  v_add_u32 v15, 98304, v11
  v_add_u32 v16, 98304, v12
  ds_read_b64_tr_b16 a[48:49], v15 offset:0
  ds_read_b64_tr_b16 a[50:51], v15 offset:512
  ds_read_b64_tr_b16 a[52:53], v15 offset:8192
  ds_read_b64_tr_b16 a[54:55], v15 offset:8704
  ds_read_b64_tr_b16 a[56:57], v16 offset:0
  ds_read_b64_tr_b16 a[58:59], v16 offset:512
  ds_read_b64_tr_b16 a[60:61], v16 offset:8192
  ds_read_b64_tr_b16 a[62:63], v16 offset:8704
  s_waitcnt vmcnt(13) lgkmcnt(0)
  s_barrier
  s_add_u32 m0, s57, 16384
  s_add_u32 s54, s78, 3145728
  buffer_load_dwordx4 v8, s[24:27], s54 offen  lds
  s_add_u32 m0, s57, 20480
  s_add_u32 s54, s78, 3276800
  buffer_load_dwordx4 v8, s[24:27], s54 offen  lds
  s_add_u32 m0, s57, 24576
  s_add_u32 s54, s78, 3407872
  buffer_load_dwordx4 v8, s[24:27], s54 offen  lds
  s_add_u32 m0, s57, 28672
  s_add_u32 s54, s78, 3538944
  buffer_load_dwordx4 v8, s[24:27], s54 offen  lds
  v_add_u32 v15, 114688, v11
  v_add_u32 v16, 114688, v12
  ds_read_b64_tr_b16 a[64:65], v15 offset:0
  ds_read_b64_tr_b16 a[66:67], v15 offset:512
  ds_read_b64_tr_b16 a[68:69], v15 offset:8192
  ds_read_b64_tr_b16 a[70:71], v15 offset:8704
  ds_read_b64_tr_b16 a[72:73], v16 offset:0
  ds_read_b64_tr_b16 a[74:75], v16 offset:512
  ds_read_b64_tr_b16 a[76:77], v16 offset:8192
  ds_read_b64_tr_b16 a[78:79], v16 offset:8704
  s_waitcnt vmcnt(13) lgkmcnt(0)
  s_barrier
  s_add_u32 m0, s57, 32768
  s_add_u32 s54, s78, 3670016
  buffer_load_dwordx4 v8, s[24:27], s54 offen  lds
  s_add_u32 m0, s57, 36864
  s_add_u32 s54, s78, 3801088
  buffer_load_dwordx4 v8, s[24:27], s54 offen  lds
  s_add_u32 m0, s57, 40960
  s_add_u32 s54, s78, 3932160
  buffer_load_dwordx4 v8, s[24:27], s54 offen  lds
  s_add_u32 m0, s57, 45056
  s_add_u32 s54, s78, 4063232
  buffer_load_dwordx4 v8, s[24:27], s54 offen  lds
  v_add_u32 v15, 131072, v11
  v_add_u32 v16, 131072, v12
  ds_read_b64_tr_b16 a[80:81], v15 offset:0
  ds_read_b64_tr_b16 a[82:83], v15 offset:512
  ds_read_b64_tr_b16 a[84:85], v15 offset:8192
  ds_read_b64_tr_b16 a[86:87], v15 offset:8704
  ds_read_b64_tr_b16 a[88:89], v16 offset:0
  ds_read_b64_tr_b16 a[90:91], v16 offset:512
  ds_read_b64_tr_b16 a[92:93], v16 offset:8192
  ds_read_b64_tr_b16 a[94:95], v16 offset:8704
  s_waitcnt vmcnt(13) lgkmcnt(0)
  s_barrier
  s_add_u32 m0, s57, 49152
  s_add_u32 s54, s78, 4194304
  buffer_load_dwordx4 v8, s[24:27], s54 offen  lds
  s_add_u32 m0, s57, 53248
  s_add_u32 s54, s78, 4325376
  buffer_load_dwordx4 v8, s[24:27], s54 offen  lds
  s_add_u32 m0, s57, 57344
  s_add_u32 s54, s78, 4456448
  buffer_load_dwordx4 v8, s[24:27], s54 offen  lds
  s_add_u32 m0, s57, 61440
  s_add_u32 s54, s78, 4587520
  buffer_load_dwordx4 v8, s[24:27], s54 offen  lds
  v_add_u32 v15, 147456, v11
  v_add_u32 v16, 147456, v12
  ds_read_b64_tr_b16 a[96:97], v15 offset:0
  ds_read_b64_tr_b16 a[98:99], v15 offset:512
  ds_read_b64_tr_b16 a[100:101], v15 offset:8192
  ds_read_b64_tr_b16 a[102:103], v15 offset:8704
  ds_read_b64_tr_b16 a[104:105], v16 offset:0
  ds_read_b64_tr_b16 a[106:107], v16 offset:512
  ds_read_b64_tr_b16 a[108:109], v16 offset:8192
  ds_read_b64_tr_b16 a[110:111], v16 offset:8704
  s_waitcnt vmcnt(13) lgkmcnt(0)
  s_barrier
  s_add_u32 m0, s57, 65536
  s_add_u32 s54, s79, 73728
  buffer_load_dwordx4 v10, s[28:31], s54 offen  lds
  s_add_u32 m0, s57, 69632
  s_add_u32 s54, s79, 82944
  buffer_load_dwordx4 v10, s[28:31], s54 offen  lds
  s_add_u32 m0, s57, 73728
  s_add_u32 s54, s79, 110592
  buffer_load_dwordx4 v10, s[28:31], s54 offen  lds
  s_add_u32 m0, s57, 77824
  s_add_u32 s54, s79, 119808
  buffer_load_dwordx4 v10, s[28:31], s54 offen  lds
  v_add_u32 v15, 16384, v11
  v_add_u32 v16, 16384, v12
  ds_read_b64_tr_b16 a[112:113], v15 offset:0
  ds_read_b64_tr_b16 a[114:115], v15 offset:512
  ds_read_b64_tr_b16 a[116:117], v15 offset:8192
  ds_read_b64_tr_b16 a[118:119], v15 offset:8704
  ds_read_b64_tr_b16 a[120:121], v16 offset:0
  ds_read_b64_tr_b16 a[122:123], v16 offset:512
  ds_read_b64_tr_b16 a[124:125], v16 offset:8192
  ds_read_b64_tr_b16 a[126:127], v16 offset:8704
  s_waitcnt vmcnt(12) lgkmcnt(0)
  s_barrier
  s_add_u32 m0, s57, 81920
  s_add_u32 s54, s79, 256
  buffer_load_dwordx4 v10, s[28:31], s54 offen  lds
  s_add_u32 m0, s57, 86016
  s_add_u32 s54, s79, 9472
  buffer_load_dwordx4 v10, s[28:31], s54 offen  lds
  s_add_u32 m0, s57, 90112
  s_add_u32 s54, s79, 37120
  buffer_load_dwordx4 v10, s[28:31], s54 offen  lds
  s_add_u32 m0, s57, 94208
  s_add_u32 s54, s79, 46336
  buffer_load_dwordx4 v10, s[28:31], s54 offen  lds
  v_add_u32 v15, 32768, v11
  v_add_u32 v16, 32768, v12
  ds_read_b64_tr_b16 a[128:129], v15 offset:0
  ds_read_b64_tr_b16 a[130:131], v15 offset:512
  ds_read_b64_tr_b16 a[132:133], v15 offset:8192
  ds_read_b64_tr_b16 a[134:135], v15 offset:8704
  ds_read_b64_tr_b16 a[136:137], v16 offset:0
  ds_read_b64_tr_b16 a[138:139], v16 offset:512
  ds_read_b64_tr_b16 a[140:141], v16 offset:8192
  ds_read_b64_tr_b16 a[142:143], v16 offset:8704
  s_waitcnt vmcnt(12) lgkmcnt(0)
  s_barrier
  s_add_u32 m0, s57, 98304
  s_add_u32 s54, s79, 512
  buffer_load_dwordx4 v10, s[28:31], s54 offen  lds
  s_add_u32 m0, s57, 102400
  s_add_u32 s54, s79, 9728
  buffer_load_dwordx4 v10, s[28:31], s54 offen  lds
  s_add_u32 m0, s57, 106496
  s_add_u32 s54, s79, 37376
  buffer_load_dwordx4 v10, s[28:31], s54 offen  lds
  s_add_u32 m0, s57, 110592
  s_add_u32 s54, s79, 46592
  buffer_load_dwordx4 v10, s[28:31], s54 offen  lds
  s_getpc_b64 s[80:81]
  v_lshlrev_b32 v7, 2, v76
  global_load_dword v19, v7, s[80:81] offset:1024
  v_add_u32 v15, 49152, v11
  v_add_u32 v16, 49152, v12
  ds_read_b64_tr_b16 a[144:145], v15 offset:0
  ds_read_b64_tr_b16 a[146:147], v15 offset:512
  ds_read_b64_tr_b16 a[148:149], v15 offset:8192
  ds_read_b64_tr_b16 a[150:151], v15 offset:8704
  ds_read_b64_tr_b16 a[152:153], v16 offset:0
  ds_read_b64_tr_b16 a[154:155], v16 offset:512
  ds_read_b64_tr_b16 a[156:157], v16 offset:8192
  ds_read_b64_tr_b16 a[158:159], v16 offset:8704
  s_waitcnt vmcnt(13) lgkmcnt(0)
  s_barrier
  s_add_u32 m0, s57, 114688
  s_add_u32 s54, s79, 74240
  buffer_load_dwordx4 v10, s[28:31], s54 offen  lds
  s_add_u32 m0, s57, 118784
  s_add_u32 s54, s79, 83456
  buffer_load_dwordx4 v10, s[28:31], s54 offen  lds
  s_add_u32 m0, s57, 122880
  s_add_u32 s54, s79, 111104
  buffer_load_dwordx4 v10, s[28:31], s54 offen  lds
  s_add_u32 m0, s57, 126976
  s_add_u32 s54, s79, 120320
  buffer_load_dwordx4 v10, s[28:31], s54 offen  lds
  v_add_u32 v15, 65536, v11
  v_add_u32 v16, 65536, v12
  ds_read_b64_tr_b16 a[160:161], v15 offset:0
  ds_read_b64_tr_b16 a[162:163], v15 offset:512
  ds_read_b64_tr_b16 a[164:165], v15 offset:8192
  ds_read_b64_tr_b16 a[166:167], v15 offset:8704
  ds_read_b64_tr_b16 a[168:169], v16 offset:0
  ds_read_b64_tr_b16 a[170:171], v16 offset:512
  ds_read_b64_tr_b16 a[172:173], v16 offset:8192
  ds_read_b64_tr_b16 a[174:175], v16 offset:8704
  s_waitcnt vmcnt(13) lgkmcnt(0)
  s_barrier
  s_add_u32 m0, s57, 131072
  s_add_u32 s54, s79, 74496
  buffer_load_dwordx4 v10, s[28:31], s54 offen  lds
  s_add_u32 m0, s57, 135168
  s_add_u32 s54, s79, 83712
  buffer_load_dwordx4 v10, s[28:31], s54 offen  lds
  s_add_u32 m0, s57, 139264
  s_add_u32 s54, s79, 111360
  buffer_load_dwordx4 v10, s[28:31], s54 offen  lds
  s_add_u32 m0, s57, 143360
  s_add_u32 s54, s79, 120576
  buffer_load_dwordx4 v10, s[28:31], s54 offen  lds
  v_add_u32 v15, 81920, v14
  ds_read_b64_tr_b16 a[176:177], v15 offset:0
  ds_read_b64_tr_b16 a[178:179], v15 offset:1024
  ds_read_b64_tr_b16 a[180:181], v15 offset:4096
  ds_read_b64_tr_b16 a[182:183], v15 offset:5120
  ds_read_b64_tr_b16 a[184:185], v15 offset:8192
  ds_read_b64_tr_b16 a[186:187], v15 offset:9216
  ds_read_b64_tr_b16 a[188:189], v15 offset:12288
  ds_read_b64_tr_b16 a[190:191], v15 offset:13312
  s_waitcnt vmcnt(13) lgkmcnt(0)
  s_barrier
  s_add_u32 m0, s57, 0
  s_add_u32 s54, s78, 0
  buffer_load_dwordx4 v8, s[20:23], s54 offen  lds
  s_add_u32 m0, s57, 4096
  s_add_u32 s54, s78, 131072
  buffer_load_dwordx4 v8, s[20:23], s54 offen  lds
  s_add_u32 m0, s57, 8192
  s_add_u32 s54, s78, 262144
  buffer_load_dwordx4 v8, s[20:23], s54 offen  lds
  s_add_u32 m0, s57, 12288
  s_add_u32 s54, s78, 393216
  buffer_load_dwordx4 v8, s[20:23], s54 offen  lds
  v_add_u32 v15, 98304, v14
  ds_read_b64_tr_b16 a[192:193], v15 offset:0
  ds_read_b64_tr_b16 a[194:195], v15 offset:1024
  ds_read_b64_tr_b16 a[196:197], v15 offset:4096
  ds_read_b64_tr_b16 a[198:199], v15 offset:5120
  ds_read_b64_tr_b16 a[200:201], v15 offset:8192
  ds_read_b64_tr_b16 a[202:203], v15 offset:9216
  ds_read_b64_tr_b16 a[204:205], v15 offset:12288
  ds_read_b64_tr_b16 a[206:207], v15 offset:13312
  s_waitcnt vmcnt(13) lgkmcnt(0)
  s_barrier
  s_add_u32 m0, s57, 16384
  s_add_u32 s54, s78, 524288
  buffer_load_dwordx4 v8, s[20:23], s54 offen  lds
  s_add_u32 m0, s57, 20480
  s_add_u32 s54, s78, 655360
  buffer_load_dwordx4 v8, s[20:23], s54 offen  lds
  s_add_u32 m0, s57, 24576
  s_add_u32 s54, s78, 786432
  buffer_load_dwordx4 v8, s[20:23], s54 offen  lds
  s_add_u32 m0, s57, 28672
  s_add_u32 s54, s78, 917504
  buffer_load_dwordx4 v8, s[20:23], s54 offen  lds
  v_add_u32 v15, 114688, v14
  ds_read_b64_tr_b16 a[208:209], v15 offset:0
  ds_read_b64_tr_b16 a[210:211], v15 offset:1024
  ds_read_b64_tr_b16 a[212:213], v15 offset:4096
  ds_read_b64_tr_b16 a[214:215], v15 offset:5120
  ds_read_b64_tr_b16 a[216:217], v15 offset:8192
  ds_read_b64_tr_b16 a[218:219], v15 offset:9216
  ds_read_b64_tr_b16 a[220:221], v15 offset:12288
  ds_read_b64_tr_b16 a[222:223], v15 offset:13312
  s_waitcnt vmcnt(12) lgkmcnt(0)
  s_barrier
  s_add_u32 m0, s57, 32768
  s_add_u32 s54, s78, 2097152
  buffer_load_dwordx4 v8, s[20:23], s54 offen  lds
  s_add_u32 m0, s57, 36864
  s_add_u32 s54, s78, 2228224
  buffer_load_dwordx4 v8, s[20:23], s54 offen  lds
  s_add_u32 m0, s57, 40960
  s_add_u32 s54, s78, 2359296
  buffer_load_dwordx4 v8, s[20:23], s54 offen  lds
  s_add_u32 m0, s57, 45056
  s_add_u32 s54, s78, 2490368
  buffer_load_dwordx4 v8, s[20:23], s54 offen  lds
  v_add_u32 v15, 131072, v14
  ds_read_b64_tr_b16 a[224:225], v15 offset:0
  ds_read_b64_tr_b16 a[226:227], v15 offset:1024
  ds_read_b64_tr_b16 a[228:229], v15 offset:4096
  ds_read_b64_tr_b16 a[230:231], v15 offset:5120
  ds_read_b64_tr_b16 a[232:233], v15 offset:8192
  ds_read_b64_tr_b16 a[234:235], v15 offset:9216
  ds_read_b64_tr_b16 a[236:237], v15 offset:12288
  ds_read_b64_tr_b16 a[238:239], v15 offset:13312
  s_waitcnt vmcnt(12) lgkmcnt(0)
  s_barrier
  s_add_u32 m0, s57, 49152
  s_add_u32 s54, s78, 3145728
  buffer_load_dwordx4 v8, s[16:19], s54 offen  lds
  s_add_u32 m0, s57, 53248
  s_add_u32 s54, s78, 3276800
  buffer_load_dwordx4 v8, s[16:19], s54 offen  lds
  s_add_u32 m0, s57, 57344
  s_add_u32 s54, s78, 3407872
  buffer_load_dwordx4 v8, s[16:19], s54 offen  lds
  s_add_u32 m0, s57, 61440
  s_add_u32 s54, s78, 3538944
  buffer_load_dwordx4 v8, s[16:19], s54 offen  lds
  v_add_u32 v15, 147456, v14
  ds_read_b64_tr_b16 a[240:241], v15 offset:0
  ds_read_b64_tr_b16 a[242:243], v15 offset:1024
  ds_read_b64_tr_b16 a[244:245], v15 offset:4096
  ds_read_b64_tr_b16 a[246:247], v15 offset:5120
  ds_read_b64_tr_b16 a[248:249], v15 offset:8192
  ds_read_b64_tr_b16 a[250:251], v15 offset:9216
  ds_read_b64_tr_b16 a[252:253], v15 offset:12288
  ds_read_b64_tr_b16 a[254:255], v15 offset:13312
  s_waitcnt vmcnt(12) lgkmcnt(0)
  s_barrier
  s_add_u32 m0, s57, 65536
  s_add_u32 s54, s78, 2621440
  buffer_load_dwordx4 v8, s[20:23], s54 offen  lds
  s_add_u32 m0, s57, 69632
  s_add_u32 s54, s78, 2752512
  buffer_load_dwordx4 v8, s[20:23], s54 offen  lds
  s_add_u32 m0, s57, 73728
  s_add_u32 s54, s78, 2883584
  buffer_load_dwordx4 v8, s[20:23], s54 offen  lds
  s_add_u32 m0, s57, 77824
  s_add_u32 s54, s78, 3014656
  buffer_load_dwordx4 v8, s[20:23], s54 offen  lds
  v_add_u32 v15, 16384, v11
  v_add_u32 v16, 16384, v12
  ds_read_b64_tr_b16 v[52:53], v15 offset:0
  ds_read_b64_tr_b16 v[54:55], v15 offset:512
  ds_read_b64_tr_b16 v[56:57], v15 offset:8192
  ds_read_b64_tr_b16 v[58:59], v15 offset:8704
  ds_read_b64_tr_b16 v[60:61], v16 offset:0
  ds_read_b64_tr_b16 v[62:63], v16 offset:512
  ds_read_b64_tr_b16 v[64:65], v16 offset:8192
  ds_read_b64_tr_b16 v[66:67], v16 offset:8704
  s_waitcnt vmcnt(12) lgkmcnt(0)
  s_barrier
  s_lshl_b32 s54, s52, 12
  s_add_u32 s54, s54, 16384
  v_add_u32 v7, s54, v76
  ds_write_b128 v7, v[52:55] offset:0
  ds_write_b128 v7, v[56:59] offset:1024
  ds_write_b128 v7, v[60:63] offset:2048
  ds_write_b128 v7, v[64:67] offset:3072
  s_add_u32 m0, s57, 81920
  s_add_u32 s54, s79, 1024
  buffer_load_dwordx4 v9, s[28:31], s54 offen  lds
  s_add_u32 m0, s57, 86016
  s_add_u32 s54, s79, 37888
  buffer_load_dwordx4 v9, s[28:31], s54 offen  lds
  s_add_u32 m0, s57, 90112
  s_add_u32 s54, s79, 74752
  buffer_load_dwordx4 v9, s[28:31], s54 offen  lds
  s_add_u32 m0, s57, 94208
  s_add_u32 s54, s79, 111616
  buffer_load_dwordx4 v9, s[28:31], s54 offen  lds
  v_add_u32 v15, 32768, v11
  v_add_u32 v16, 32768, v12
  ds_read_b64_tr_b16 v[36:37], v15 offset:0
  ds_read_b64_tr_b16 v[38:39], v15 offset:512
  ds_read_b64_tr_b16 v[40:41], v15 offset:8192
  ds_read_b64_tr_b16 v[42:43], v15 offset:8704
  ds_read_b64_tr_b16 v[44:45], v16 offset:0
  ds_read_b64_tr_b16 v[46:47], v16 offset:512
  ds_read_b64_tr_b16 v[48:49], v16 offset:8192
  ds_read_b64_tr_b16 v[50:51], v16 offset:8704
  s_waitcnt vmcnt(12) lgkmcnt(0)
  s_barrier
  s_lshl_b32 s54, s52, 12
  s_add_u32 s54, s54, 32768
  v_add_u32 v7, s54, v76
  ds_write_b128 v7, v[36:39] offset:0
  ds_write_b128 v7, v[40:43] offset:1024
  ds_write_b128 v7, v[44:47] offset:2048
  ds_write_b128 v7, v[48:51] offset:3072
  s_add_u32 m0, s57, 98304
  s_add_u32 s54, s79, 0
  buffer_load_dwordx4 v10, s[28:31], s54 offen  lds
  s_add_u32 m0, s57, 102400
  s_add_u32 s54, s79, 9216
  buffer_load_dwordx4 v10, s[28:31], s54 offen  lds
  s_add_u32 m0, s57, 106496
  s_add_u32 s54, s79, 36864
  buffer_load_dwordx4 v10, s[28:31], s54 offen  lds
  s_add_u32 m0, s57, 110592
  s_add_u32 s54, s79, 46080
  buffer_load_dwordx4 v10, s[28:31], s54 offen  lds
  v_add_u32 v15, 49152, v11
  v_add_u32 v16, 49152, v12
  ds_read_b64_tr_b16 v[52:53], v15 offset:0
  ds_read_b64_tr_b16 v[54:55], v15 offset:512
  ds_read_b64_tr_b16 v[56:57], v15 offset:8192
  ds_read_b64_tr_b16 v[58:59], v15 offset:8704
  ds_read_b64_tr_b16 v[60:61], v16 offset:0
  ds_read_b64_tr_b16 v[62:63], v16 offset:512
  ds_read_b64_tr_b16 v[64:65], v16 offset:8192
  ds_read_b64_tr_b16 v[66:67], v16 offset:8704
  s_waitcnt vmcnt(12) lgkmcnt(0)
  s_barrier
  s_lshl_b32 s54, s52, 12
  s_add_u32 s54, s54, 49152
  v_add_u32 v7, s54, v76
  ds_write_b128 v7, v[52:55] offset:0
  ds_write_b128 v7, v[56:59] offset:1024
  ds_write_b128 v7, v[60:63] offset:2048
  ds_write_b128 v7, v[64:67] offset:3072
  s_add_u32 m0, s57, 114688
  s_add_u32 s54, s79, 73984
  buffer_load_dwordx4 v10, s[28:31], s54 offen  lds
  s_add_u32 m0, s57, 118784
  s_add_u32 s54, s79, 83200
  buffer_load_dwordx4 v10, s[28:31], s54 offen  lds
  s_add_u32 m0, s57, 122880
  s_add_u32 s54, s79, 110848
  buffer_load_dwordx4 v10, s[28:31], s54 offen  lds
  s_add_u32 m0, s57, 126976
  s_add_u32 s54, s79, 120064
  buffer_load_dwordx4 v10, s[28:31], s54 offen  lds
  v_add_u32 v15, 65536, v11
  v_add_u32 v16, 65536, v12
  ds_read_b64_tr_b16 v[36:37], v15 offset:0
  ds_read_b64_tr_b16 v[38:39], v15 offset:512
  ds_read_b64_tr_b16 v[40:41], v15 offset:8192
  ds_read_b64_tr_b16 v[42:43], v15 offset:8704
  ds_read_b64_tr_b16 v[44:45], v16 offset:0
  ds_read_b64_tr_b16 v[46:47], v16 offset:512
  ds_read_b64_tr_b16 v[48:49], v16 offset:8192
  ds_read_b64_tr_b16 v[50:51], v16 offset:8704
  s_waitcnt vmcnt(12) lgkmcnt(0)
  s_barrier
  s_lshl_b32 s54, s52, 12
  s_add_u32 s54, s54, 65536
  v_add_u32 v7, s54, v76
  ds_write_b128 v7, v[36:39] offset:0
  ds_write_b128 v7, v[40:43] offset:1024
  ds_write_b128 v7, v[44:47] offset:2048
  ds_write_b128 v7, v[48:51] offset:3072
  s_add_u32 m0, s57, 131072
  s_add_u32 s54, s79, 768
  buffer_load_dwordx4 v10, s[28:31], s54 offen  lds
  s_add_u32 m0, s57, 135168
  s_add_u32 s54, s79, 9984
  buffer_load_dwordx4 v10, s[28:31], s54 offen  lds
  s_add_u32 m0, s57, 139264
  s_add_u32 s54, s79, 37632
  buffer_load_dwordx4 v10, s[28:31], s54 offen  lds
  s_add_u32 m0, s57, 143360
  s_add_u32 s54, s79, 46848
  buffer_load_dwordx4 v10, s[28:31], s54 offen  lds
  v_lshlrev_b32 v7, 3, v76
  s_lshl_b32 s54, s52, 13
  s_add_u32 s54, s54, 360448
  s_bitcmp1_b32 s52, 0
  s_cselect_b64 exec, 0xff, -1
  buffer_load_dword v35, v7, s[8:11], s54 offen sc1
  s_mov_b64 exec, -1
  s_getpc_b64 s[80:81]
C_pc:
  s_mov_b32 s55, (L_w0 - C_pc)
  s_cmp_eq_u32 s52, 1
  s_cselect_b32 s55, (L_w1 - C_pc), s55
  s_cmp_eq_u32 s52, 2
  s_cselect_b32 s55, (L_w2 - C_pc), s55
  s_cmp_eq_u32 s52, 3
  s_cselect_b32 s55, (L_w3 - C_pc), s55
  v_lshl_add_u32 v7, v76, 3, s55
  global_load_dword v35, v7, s[80:81]
  v_add_u32 v15, 81920, v11
  v_add_u32 v16, 81920, v12
  ds_read_b64_tr_b16 v[52:53], v15 offset:0
  ds_read_b64_tr_b16 v[54:55], v15 offset:512
  ds_read_b64_tr_b16 v[56:57], v15 offset:8192
  ds_read_b64_tr_b16 v[58:59], v15 offset:8704
  ds_read_b64_tr_b16 v[60:61], v16 offset:0
  ds_read_b64_tr_b16 v[62:63], v16 offset:512
  ds_read_b64_tr_b16 v[64:65], v16 offset:8192
  ds_read_b64_tr_b16 v[66:67], v16 offset:8704
  s_waitcnt vmcnt(14) lgkmcnt(0)
  s_barrier
  s_lshl_b32 s54, s52, 12
  s_add_u32 s54, s54, 81920
  v_add_u32 v7, s54, v76
  ds_write_b128 v7, v[52:55] offset:0
  ds_write_b128 v7, v[56:59] offset:1024
  ds_write_b128 v7, v[60:63] offset:2048
  ds_write_b128 v7, v[64:67] offset:3072
  v_lshrrev_b32 v20, 2, v76
  buffer_load_dword v21, v20, s[12:15], 0 offen sc1
  v_add_u32 v15, 98304, v13
  s_waitcnt lgkmcnt(0)
  ds_read_b64_tr_b16 v[36:37], v15 offset:0
  ds_read_b64_tr_b16 v[38:39], v15 offset:1024
  ds_read_b64_tr_b16 v[40:41], v15 offset:2048
  ds_read_b64_tr_b16 v[42:43], v15 offset:3072
  ds_read_b64_tr_b16 v[44:45], v15 offset:4096
  ds_read_b64_tr_b16 v[46:47], v15 offset:5120
  ds_read_b64_tr_b16 v[48:49], v15 offset:6144
  ds_read_b64_tr_b16 v[50:51], v15 offset:7168
  ds_read_b64_tr_b16 v[52:53], v15 offset:8192
  ds_read_b64_tr_b16 v[54:55], v15 offset:9216
  ds_read_b64_tr_b16 v[56:57], v15 offset:10240
  ds_read_b64_tr_b16 v[58:59], v15 offset:11264
  ds_read_b64_tr_b16 v[60:61], v15 offset:12288
  ds_read_b64_tr_b16 v[62:63], v15 offset:13312
  ds_read_b64_tr_b16 v[64:65], v15 offset:14336
  ds_read_b64_tr_b16 v[66:67], v15 offset:15360
  s_waitcnt vmcnt(11) lgkmcnt(0)
  s_barrier
  s_and_b32 s54, s52, 1
  s_lshl_b32 s54, s54, 13
  s_add_u32 s54, s54, 98304
  v_add_u32 v7, s54, v76
  ds_write_b128 v7, v[36:39] offset:0
  ds_write_b128 v7, v[40:43] offset:1024
  ds_write_b128 v7, v[44:47] offset:2048
  ds_write_b128 v7, v[48:51] offset:3072
  ds_write_b128 v7, v[52:55] offset:4096
  ds_write_b128 v7, v[56:59] offset:5120
  ds_write_b128 v7, v[60:63] offset:6144
  ds_write_b128 v7, v[64:67] offset:7168
  v_add_u32 v15, 114688, v14
  ds_read_b64_tr_b16 v[52:53], v15 offset:0
  ds_read_b64_tr_b16 v[54:55], v15 offset:1024
  ds_read_b64_tr_b16 v[56:57], v15 offset:4096
  ds_read_b64_tr_b16 v[58:59], v15 offset:5120
  ds_read_b64_tr_b16 v[60:61], v15 offset:8192
  ds_read_b64_tr_b16 v[62:63], v15 offset:9216
  ds_read_b64_tr_b16 v[64:65], v15 offset:12288
  ds_read_b64_tr_b16 v[66:67], v15 offset:13312
  s_waitcnt vmcnt(7) lgkmcnt(0)
  s_barrier
  s_lshl_b32 s54, s52, 12
  s_add_u32 s54, s54, 114688
  v_add_u32 v7, s54, v76
  ds_write_b128 v7, v[52:55] offset:0
  ds_write_b128 v7, v[56:59] offset:1024
  ds_write_b128 v7, v[60:63] offset:2048
  ds_write_b128 v7, v[64:67] offset:3072
  v_add_u32 v15, 131072, v14
  ds_read_b64_tr_b16 v[36:37], v15 offset:0
  ds_read_b64_tr_b16 v[38:39], v15 offset:1024
  ds_read_b64_tr_b16 v[40:41], v15 offset:4096
  ds_read_b64_tr_b16 v[42:43], v15 offset:5120
  ds_read_b64_tr_b16 v[44:45], v15 offset:8192
  ds_read_b64_tr_b16 v[46:47], v15 offset:9216
  ds_read_b64_tr_b16 v[48:49], v15 offset:12288
  ds_read_b64_tr_b16 v[50:51], v15 offset:13312
  s_waitcnt vmcnt(3) lgkmcnt(0)
  s_barrier
  s_lshl_b32 s54, s52, 12
  s_add_u32 s54, s54, 131072
  v_add_u32 v7, s54, v76
  ds_write_b128 v7, v[36:39] offset:0
  ds_write_b128 v7, v[40:43] offset:1024
  ds_write_b128 v7, v[44:47] offset:2048
  ds_write_b128 v7, v[48:51] offset:3072
  v_add_u32 v15, 147456, v14
  ds_read_b64_tr_b16 v[52:53], v15 offset:0
  ds_read_b64_tr_b16 v[54:55], v15 offset:1024
  ds_read_b64_tr_b16 v[56:57], v15 offset:4096
  ds_read_b64_tr_b16 v[58:59], v15 offset:5120
  ds_read_b64_tr_b16 v[60:61], v15 offset:8192
  ds_read_b64_tr_b16 v[62:63], v15 offset:9216
  ds_read_b64_tr_b16 v[64:65], v15 offset:12288
  ds_read_b64_tr_b16 v[66:67], v15 offset:13312
  s_waitcnt vmcnt(0) lgkmcnt(0)
  s_barrier
  s_lshl_b32 s54, s52, 12
  s_add_u32 s54, s54, 147456
  v_add_u32 v7, s54, v76
  ds_write_b128 v7, v[52:55] offset:0
  ds_write_b128 v7, v[56:59] offset:1024
  ds_write_b128 v7, v[60:63] offset:2048
  ds_write_b128 v7, v[64:67] offset:3072
  s_waitcnt lgkmcnt(0)
  s_branch C_rd1
C_rd0:
  s_sleep 2
  buffer_load_dword v21, v20, s[12:15], 0 offen sc1
  s_waitcnt vmcnt(0)
C_rd1:
  v_and_b32 v22, 0xff, v21
  v_cmp_gt_u32 vcc, 7, v22
  v_readlane_b32 s56, v21, 0
  s_mov_b32 s3, 1
  s_add_u32 s67, s67, 1
  s_cmp_ge_u32 s67, 131072
  s_cbranch_scc1 C_rd2
  s_cmp_lg_u32 vcc_hi, 0
  s_cbranch_scc1 C_rd0
  s_mov_b32 s3, 0
  s_cmp_eq_u32 s56, -1
  s_cbranch_scc1 C_rd2
  s_mov_b32 s3, 1
  v_readlane_b32 s54, v21, 10
  v_readlane_b32 s55, v21, 0
  s_nop 0
  s_bcnt1_i32_b32 s55, s55
  s_add_u32 s54, s54, s55
  v_readlane_b32 s55, v21, 1
  s_nop 0
  s_bcnt1_i32_b32 s55, s55
  s_add_u32 s54, s54, s55
  v_readlane_b32 s55, v21, 2
  s_nop 0
  s_bcnt1_i32_b32 s55, s55
  s_add_u32 s54, s54, s55
  v_readlane_b32 s55, v21, 3
  s_nop 0
  s_bcnt1_i32_b32 s55, s55
  s_add_u32 s54, s54, s55
  v_readlane_b32 s55, v21, 4
  s_nop 0
  s_bcnt1_i32_b32 s55, s55
  s_add_u32 s54, s54, s55
  v_readlane_b32 s55, v21, 5
  s_nop 0
  s_bcnt1_i32_b32 s55, s55
  s_add_u32 s54, s54, s55
  v_readlane_b32 s55, v21, 6
  s_nop 0
  s_bcnt1_i32_b32 s55, s55
  s_add_u32 s54, s54, s55
  v_readlane_b32 s55, v21, 7
  s_nop 0
  s_bcnt1_i32_b32 s55, s55
  s_add_u32 s54, s54, s55
  s_cmp_lt_u32 s54, 256
  s_cbranch_scc1 C_rd0
C_rd2:
  s_lshl_b32 s54, s3, 2
  s_add_u32 s54, s54, s52
  s_cmp_eq_u32 s54, 1
  s_cbranch_scc1 L_w1
  s_cmp_eq_u32 s54, 2
  s_cbranch_scc1 L_w2
  s_cmp_eq_u32 s54, 3
  s_cbranch_scc1 L_w3
  s_cmp_eq_u32 s54, 4
  s_cbranch_scc1 L_w4
  s_cmp_eq_u32 s54, 5
  s_cbranch_scc1 L_w5
  s_cmp_eq_u32 s54, 6
  s_cbranch_scc1 L_w6
  s_cmp_eq_u32 s54, 7
  s_cbranch_scc1 L_w7
L_w0:
  v_mov_b64 v[20:21], 0
  v_mov_b64 v[22:23], 0
  v_mov_b64 v[24:25], 0
  v_mov_b64 v[26:27], 0
  v_mov_b64 v[28:29], 0
  v_mov_b64 v[30:31], 0
  v_mov_b64 v[32:33], 0
  v_mov_b64 v[34:35], 0
  s_mov_b32 s78, 0x3f803f80
  s_mov_b32 s79, s78
  s_mov_b32 s65, 360448
  s_mov_b32 m0, 16128
  s_lshl_b32 s71, s53, 2
  s_add_u32 s71, s71, 128
  s_movk_i32 s56, 0x1000
  v_lshlrev_b32 v73, 2, v76
  v_mov_b32 v72, 0
  s_mov_b64 s[16:17], s[8:9]
  s_mov_b32 s18, 268435456
  s_mov_b32 s19, 0x20000
  s_getpc_b64 s[20:21]
Cf0_pc:
  s_add_u32 s20, s20, (Cf0_last - Cf0_pc)
  s_addc_u32 s21, s21, 0
  v_mov_b32 v68, 14880
  buffer_load_dwordx4 v[52:55], v76, s[8:11], s59 offen offset:0 sc1
  buffer_load_dwordx4 v[56:59], v76, s[8:11], s59 offen offset:1024 sc1
  ds_read_b128 v[36:39], v76 offset:16384
  ds_read_b128 v[40:43], v76 offset:17408
  ds_read_b128 v[60:63], v76 offset:18432
  ds_read_b128 v[64:67], v76 offset:19456
  ds_read_b128 v[0:3], v76 offset:4608
  ds_read_b128 v[4:7], v76 offset:5632
  ds_read_b128 v[8:11], v76 offset:6656
  ds_read_b128 v[12:15], v76 offset:7680
  s_waitcnt lgkmcnt(0)
  s_cmp_eq_u32 s66, 1
  s_branch Cf0_top2
.p2align 6
Cf0_h2:
  s_cmp_eq_u32 s66, 12
  s_cselect_b32 s56, s71, 0x1000
  ds_read_b32 v72, v76 offset:16128
  s_cmp_eq_u32 s66, 13
  s_cselect_b32 s54, 0x700, 0
  s_waitcnt lgkmcnt(0)
  v_readfirstlane_b32 s57, v72
  s_nop 0
  s_cmp_lt_u32 s57, s54
  s_cbranch_scc1 Cf0_kv3
Cf0_kvb:
  buffer_load_dwordx4 v[0:3], v76, s[8:11], s65 offen offset:0 sc1
  ds_read_b128 v[36:39], v76 offset:16384
  s_waitcnt lgkmcnt(0)
  v_mov_b64 v[20:21], 0
  v_mov_b64 v[22:23], 0
  v_mov_b64 v[24:25], 0
  v_mov_b64 v[26:27], 0
  v_mov_b32 v68, 14880
  buffer_load_dwordx4 v[0:3], v76, s[8:11], s65 offen offset:0 sc1
  ds_read_b128 v[40:43], v76 offset:17408
  s_waitcnt lgkmcnt(0)
  s_cmp_eq_u32 s66, 62
  s_cselect_b64 s[16:17], s[20:21], s[16:17]
  s_cselect_b32 s18, (Cf0_done - Cf0_last), s18
  s_cselect_b32 s70, 0, s70
  s_cmp_eq_u32 s66, 63
  s_cselect_b32 s59, 268435456, s59
  s_cselect_b32 s58, 268435456, s58
  buffer_load_dwordx4 v[0:3], v76, s[8:11], s65 offen offset:0 sc1
  ds_read_b128 v[60:63], v76 offset:18432
  s_waitcnt lgkmcnt(0)
  v_lshlrev_b32 v73, 2, v76
  buffer_load_dwordx4 v[52:55], v76, s[8:11], s59 offen offset:0 sc1
  buffer_load_dwordx4 v[56:59], v76, s[8:11], s59 offen offset:1024 sc1
  s_waitcnt vmcnt(4)
  v_max3_u32 v72, v0, v1, v2
  v_max_u32 v72, v72, v3
  ds_write_b128 v76, v[0:3] offset:4608
  v_cmp_eq_u32 vcc, -1, v72
  s_cbranch_vccnz Cf0_h2r
Cf0_h2w:
  s_cmp_eq_u32 s66, 63
  s_waitcnt lgkmcnt(0)
  s_barrier
  ds_read_b128 v[8:11], v76 offset:6656
  buffer_load_dwordx4 v76, s[8:11], s85 offen offset:0 sc1 lds
Cf0_top2:
  v_smfmac_f32_16x16x64_bf16 v[20:23], v[0:3], v[80:87], v74
  s_cbranch_scc1 Cf0_last
  v_smfmac_f32_16x16x64_bf16 v[28:31], v[0:3], v[36:43], v74
  buffer_load_dwordx4 v[44:47], v76, s[8:11], s58 offen offset:0 sc1
  s_mov_b32 m0, 16128
  v_smfmac_f32_16x16x64_bf16 v[24:27], v[0:3], v[88:95], v74
  buffer_load_dwordx4 v[48:51], v76, s[8:11], s58 offen offset:1024 sc1
  v_smfmac_f32_16x16x64_bf16 v[32:35], v[0:3], v[60:67], v74
  ds_read_b128 v[4:7], v76 offset:5632
  s_waitcnt lgkmcnt(1)
  v_smfmac_f32_16x16x64_bf16 v[20:23], v[8:11], v[112:119], v74
  ds_read_b128 v[12:15], v76 offset:7680
  v_smfmac_f32_16x16x64_bf16 v[24:27], v[8:11], v[120:127], v74
  ds_read_b128 v[36:39], v76 offset:32768
  v_smfmac_f32_16x16x64_bf16 v[28:31], v[8:11], v[208:215], v74
  buffer_store_dwordx4 v[16:19], v76, s[8:11], s68 offen sc1
  ds_read_b128 v[40:43], v76 offset:33792
  v_smfmac_f32_16x16x64_bf16 v[32:35], v[8:11], v[216:223], v74
  buffer_load_dword v73, s[16:19], s70 offen lds
  ds_read_b128 v[60:63], v76 offset:34816
  s_waitcnt lgkmcnt(4)
  v_smfmac_f32_16x16x64_bf16 v[20:23], v[4:7], v[96:103], v74
  ds_read_b128 v[64:67], v76 offset:35840
  v_smfmac_f32_16x16x64_bf16 v[24:27], v[4:7], v[104:111], v74
  s_waitcnt vmcnt(5)
  s_waitcnt lgkmcnt(4)
  v_smfmac_f32_16x16x64_bf16 v[20:23], v[12:15], v[128:135], v74
  s_barrier
  ds_read_b128 v[0:3], v76 offset:8704
  s_waitcnt lgkmcnt(3)
  v_smfmac_f32_16x16x64_bf16 v[28:31], v[4:7], v[36:43], v74
  ds_read_b128 v[36:39], v76 offset:49152
  v_smfmac_f32_16x16x64_bf16 v[24:27], v[12:15], v[136:143], v74
  ds_read_b128 v[40:43], v76 offset:50176
  s_waitcnt lgkmcnt(3)
  v_smfmac_f32_16x16x64_bf16 v[32:35], v[4:7], v[60:67], v74
  ds_read_b128 v[8:11], v76 offset:9728
  v_smfmac_f32_16x16x64_bf16 v[28:31], v[12:15], v[224:231], v74
  ds_read_b128 v[60:63], v76 offset:51200
  v_smfmac_f32_16x16x64_bf16 v[32:35], v[12:15], v[232:239], v74
  s_waitcnt vmcnt(4)
  ds_read_b128 v[64:67], v76 offset:52224
  s_waitcnt lgkmcnt(5)
  v_smfmac_f32_16x16x64_bf16 v[20:23], v[0:3], v[144:151], v74
  s_barrier
  ds_read_b128 v[4:7], v76 offset:11776
  s_waitcnt lgkmcnt(4)
  v_smfmac_f32_16x16x64_bf16 v[28:31], v[0:3], v[36:43], v74
  ds_read_b128 v[12:15], v76 offset:12800
  ds_read_b128 v[36:39], v75 offset:0
  v_smfmac_f32_16x16x64_bf16 v[24:27], v[0:3], v[152:159], v74
  ds_read_b128 v[16:19], v76 offset:10752
  s_waitcnt lgkmcnt(6)
  v_smfmac_f32_16x16x64_bf16 v[20:23], v[8:11], v[160:167], v74
  ds_read_b128 v[40:43], v75 offset:1024
  s_waitcnt lgkmcnt(5)
  v_smfmac_f32_16x16x64_bf16 v[32:35], v[0:3], v[60:67], v74
  ds_read_b128 v[60:63], v75 offset:2048
  v_smfmac_f32_16x16x64_bf16 v[24:27], v[8:11], v[168:175], v74
  ds_read_b128 v[64:67], v75 offset:3072
  s_waitcnt lgkmcnt(6)
  v_smfmac_f32_16x16x64_bf16 v[20:23], v[4:7], v[176:183], v74
  buffer_load_dword off, s[12:15], s56 sc1 lds
  s_waitcnt lgkmcnt(5)
  v_smfmac_f32_16x16x64_bf16 v[20:23], v[12:15], v[192:199], v74
  s_waitcnt lgkmcnt(2)
  v_smfmac_f32_16x16x64_bf16 v[20:23], v[16:19], v[36:43], v74
  ds_read_b128 v[36:39], v75 offset:16384
  v_smfmac_f32_16x16x64_bf16 v[24:27], v[4:7], v[184:191], v74
  ds_read_b128 v[40:43], v75 offset:17408
  s_waitcnt lgkmcnt(2)
  v_smfmac_f32_16x16x64_bf16 v[24:27], v[16:19], v[60:67], v74
  ds_read_b128 v[60:63], v75 offset:18432
  v_add_f32 v20, v20, v22
  v_smfmac_f32_16x16x64_bf16 v[24:27], v[12:15], v[200:207], v74
  ds_read_b128 v[64:67], v75 offset:19456
  v_add_f32 v21, v21, v23
  v_smfmac_f32_16x16x64_bf16 v[28:31], v[16:19], v[240:247], v74
  v_mov_b64 v[70:71], s[78:79]
  v_smfmac_f32_16x16x64_bf16 v[28:31], v[4:7], a[0:7], v74
  s_waitcnt lgkmcnt(2)
  v_add_f32 v24, v24, v26
  v_smfmac_f32_16x16x64_bf16 v[28:31], v[8:11], v[36:43], v74
  ds_read_b128 v[36:39], v68
  v_cvt_pk_bf16_f32 v22, v20, v24
  v_smfmac_f32_16x16x64_bf16 v[28:31], v[12:15], a[16:23], v74
  ds_read_b128 v[40:43], v68
  ds_write_b32 v79, v22 offset:0
  s_waitcnt lgkmcnt(3)
  v_add_f32 v25, v25, v27
  v_cvt_pk_bf16_f32 v23, v21, v25
  v_smfmac_f32_16x16x64_bf16 v[32:35], v[8:11], v[60:67], v74
  ds_write_b32 v79, v23 offset:576
  v_cmp_u_f32 vcc, v20, v21
  v_smfmac_f32_16x16x64_bf16 v[32:35], v[16:19], v[248:255], v74
  v_add_f32 v28, v28, v30
  v_smfmac_f32_16x16x64_bf16 v[32:35], v[4:7], a[8:15], v74
  v_add_f32 v29, v29, v31
  v_smfmac_f32_16x16x64_bf16 v[32:35], v[12:15], a[24:31], v74
  s_cbranch_vccnz Cf0_rec
Cf0_recok:
  s_waitcnt lgkmcnt(3)
  v_smfmac_f32_16x16x64_bf16 v[36:39], v[16:19], a[128:135], v74
  s_waitcnt lgkmcnt(0)
  s_barrier
  ds_read_b128 v[60:63], v77
  v_smfmac_f32_16x16x64_bf16 v[40:43], v[16:19], a[136:143], v74
  ds_read_b128 v[64:67], v77 offset:128
  v_add_f32 v32, v32, v34
  v_cvt_pk_bf16_f32 v30, v28, v32
  v_smfmac_f32_16x16x64_bf16 v[36:39], v[0:3], a[96:103], v74
  ds_write_b32 v79, v30 offset:256
  v_add_f32 v33, v33, v35
  v_cvt_pk_bf16_f32 v31, v29, v33
  v_smfmac_f32_16x16x64_bf16 v[40:43], v[0:3], a[104:111], v74
  ds_write_b32 v79, v31 offset:832
  v_xor_b32 v75, 0x8000, v75
  v_smfmac_f32_16x16x64_bf16 v[36:39], v[4:7], a[144:151], v74
  ds_read_b128 v[0:3], v76 offset:4608
  v_mov_b32 v29, 0
  v_smfmac_f32_16x16x64_bf16 v[40:43], v[4:7], a[152:159], v74
  s_waitcnt vmcnt(3) lgkmcnt(3)
  v_mov_b32 v30, 0
  v_mfma_f32_16x16x32_bf16 v[44:47], v[44:47], v[60:63], 0
  ds_read_b128 v[4:7], v76 offset:5632
  s_waitcnt lgkmcnt(2)
  v_mfma_f32_16x16x32_bf16 v[44:47], v[48:51], v[64:67], v[44:47]
  s_barrier
  v_smfmac_f32_16x16x64_bf16 v[36:39], v[8:11], a[112:119], v74
  ds_read_b128 v[20:23], v77 offset:256
  ds_read_b128 v[24:27], v77 offset:384
  v_smfmac_f32_16x16x64_bf16 v[40:43], v[8:11], a[120:127], v74
  ds_read_b128 v[8:11], v76 offset:6656
  v_add_f32_dpp v72, v46, v44 quad_perm:[2,3,0,1] row_mask:0xf bank_mask:0xf
  v_add_f32_dpp v73, v47, v45 quad_perm:[2,3,0,1] row_mask:0xf bank_mask:0xf
  v_smfmac_f32_16x16x64_bf16 v[36:39], v[12:15], a[160:167], v74
  s_waitcnt lgkmcnt(4)
  v_exp_f32_dpp v72, v72 quad_perm:[0,1,0,1] row_mask:0xf bank_mask:0xf
  v_smfmac_f32_16x16x64_bf16 v[40:43], v[12:15], a[168:175], v74
  ds_read_b128 v[12:15], v76 offset:7680
  v_exp_f32_dpp v73, v73 quad_perm:[0,1,0,1] row_mask:0xf bank_mask:0xf
  v_smfmac_f32_16x16x64_bf16 v[36:39], v[0:3], a[32:39], v74
  s_waitcnt lgkmcnt(2)
  v_cvt_pk_bf16_f32 v72, v72, v73
  v_mfma_f32_16x16x32_bf16 v[20:23], v[20:23], v[60:63], 0
  ds_write_b32 v78, v72 offset:512
  v_mov_b64 v[16:17], 0
  v_mfma_f32_16x16x32_bf16 v[20:23], v[24:27], v[64:67], v[20:23]
  ds_read_b128 v[44:47], v75 offset:16384
  v_mov_b64 v[18:19], 0
  v_smfmac_f32_16x16x64_bf16 v[40:43], v[0:3], a[40:47], v74
  ds_read_b128 v[48:51], v75 offset:17408
  v_mov_b64 v[68:69], s[78:79]
  v_smfmac_f32_16x16x64_bf16 v[36:39], v[4:7], a[48:55], v74
  s_waitcnt lgkmcnt(4)
  v_add_f32_dpp v24, v22, v20 quad_perm:[2,3,0,1] row_mask:0xf bank_mask:0xf
  v_add_f32_dpp v25, v23, v21 quad_perm:[2,3,0,1] row_mask:0xf bank_mask:0xf
  v_smfmac_f32_16x16x64_bf16 v[36:39], v[8:11], a[64:71], v74
  s_waitcnt lgkmcnt(2)
  s_barrier
  ds_read_b128 v[32:35], v78 offset:512
  v_smfmac_f32_16x16x64_bf16 v[36:39], v[12:15], a[80:87], v74
  ds_read_b128 v[60:63], v75 offset:18432
  v_mul_f32 v24, s69, v24
  v_smfmac_f32_16x16x64_bf16 v[40:43], v[4:7], a[56:63], v74
  ds_read_b128 v[64:67], v75 offset:19456
  v_mul_f32 v25, s69, v25
  v_smfmac_f32_16x16x64_bf16 v[40:43], v[8:11], a[72:79], v74
  v_exp_f32_dpp v24, v24 quad_perm:[0,1,0,1] row_mask:0xf bank_mask:0xf
  v_smfmac_f32_16x16x64_bf16 v[40:43], v[12:15], a[88:95], v74
  s_waitcnt lgkmcnt(2)
  v_exp_f32_dpp v25, v25 quad_perm:[0,1,0,1] row_mask:0xf bank_mask:0xf
  v_mfma_f32_16x16x32_bf16 v[8:11], v[32:35], v[68:71], 0
  v_add_f32 v36, v36, v38
  v_add_f32 v37, v37, v39
  v_mfma_f32_16x16x32_bf16 v[0:3], v[32:35], v[52:55], 0
  v_add_f32 v40, v40, v42
  v_add_f32 v41, v41, v43
  v_mfma_f32_16x16x32_bf16 v[4:7], v[32:35], v[56:59], 0
  v_cvt_pk_bf16_f32 v28, v24, v25
  v_cvt_pk_bf16_f32 v72, v36, v37
  v_cvt_pk_bf16_f32 v73, v40, v41
  v_mfma_f32_16x16x16_bf16 v[8:11], v[28:29], v[68:69], v[8:11]
  v_cvt_pk_bf16_f32 v31, v24, v25
  v_mov_b64 v[20:21], 0
  v_mfma_f32_16x16x16_bf16 v[0:3], v[28:29], v[72:73], v[0:3]
  ds_read_b128 v[52:55], v75 offset:32768
  v_mov_b64 v[22:23], 0
  v_mfma_f32_16x16x16_bf16 v[4:7], v[30:31], v[72:73], v[4:7]
  v_rcp_f32 v10, v8
  v_rcp_f32 v11, v9
  v_mul_f32 v0, v10, v0
  v_mul_f32 v1, v11, v1
  v_max3_f32 v8, v8, v9, v10
  v_mul_f32 v4, v10, v4
  v_mul_f32 v5, v11, v5
  v_cvt_pk_bf16_f32 v2, v0, v4
  ds_write_b32 v79, v2 offset:8704
  v_cvt_pk_bf16_f32 v3, v1, v5
  ds_write_b32 v79, v3 offset:9280
  ds_read_b128 v[12:15], v78 offset:8704
  v_max_f32 v8, v8, v11
  v_cmp_le_f32 vcc, 1317011456, v8
  v_mov_b64 v[24:25], 0
  v_mov_b64 v[26:27], 0
  ds_read_b128 v[56:59], v75 offset:33792
  s_cbranch_vccnz Cf0_mx
Cf0_mxok:
  s_waitcnt lgkmcnt(2)
  s_barrier
  ds_read_b128 v[0:3], v78 offset:8768
  s_waitcnt lgkmcnt(2)
  v_smfmac_f32_16x16x64_bf16 v[16:19], v[12:15], v[44:51], v74
  ds_read_b128 v[4:7], v78 offset:8832
  v_smfmac_f32_16x16x64_bf16 v[20:23], v[12:15], a[192:199], v74
  ds_read_b128 v[8:11], v78 offset:8896
  v_smfmac_f32_16x16x64_bf16 v[24:27], v[12:15], a[208:215], v74
  ds_read_b128 v[36:39], v75 offset:34816
  s_waitcnt lgkmcnt(3)
  v_smfmac_f32_16x16x64_bf16 v[16:19], v[0:3], v[60:67], v74
  ds_read_b128 v[40:43], v75 offset:35840
  s_waitcnt lgkmcnt(3)
  v_smfmac_f32_16x16x64_bf16 v[16:19], v[4:7], a[176:183], v74
  ds_read_b128 v[68:71], v76 offset:13824
  s_waitcnt lgkmcnt(3)
  v_smfmac_f32_16x16x64_bf16 v[16:19], v[8:11], a[184:191], v74
  ds_read_b128 v[44:47], v75 offset:49152
  v_smfmac_f32_16x16x64_bf16 v[20:23], v[0:3], a[200:207], v74
  ds_read_b128 v[48:51], v75 offset:50176
  v_smfmac_f32_16x16x64_bf16 v[20:23], v[4:7], v[52:59], v74
  ds_read_b128 v[60:63], v75 offset:51200
  s_waitcnt lgkmcnt(4)
  v_cvt_pk_bf16_f32 v16, v16, v17
  v_cvt_pk_bf16_f32 v17, v18, v19
  v_bfi_b32 v16, 1, s72, v16
  v_smfmac_f32_16x16x64_bf16 v[20:23], v[8:11], v[36:43], v74
  s_waitcnt lgkmcnt(3)
  buffer_store_dwordx2 v[16:17], v68, s[8:11], s73 offen
  v_mov_b64 v[32:33], 0
  v_smfmac_f32_16x16x64_bf16 v[24:27], v[0:3], a[216:223], v74
  ds_read_b128 v[64:67], v75 offset:52224
  v_mov_b64 v[34:35], 0
  v_smfmac_f32_16x16x64_bf16 v[24:27], v[4:7], a[224:231], v74
  v_cvt_pk_bf16_f32 v20, v20, v21
  v_cvt_pk_bf16_f32 v21, v22, v23
  v_bfi_b32 v20, 1, s72, v20
  v_smfmac_f32_16x16x64_bf16 v[24:27], v[8:11], a[232:239], v74
  buffer_store_dwordx2 v[20:21], v68, s[8:11], s74 offen
  s_waitcnt lgkmcnt(2)
  v_smfmac_f32_16x16x64_bf16 v[32:35], v[12:15], v[44:51], v74
  s_waitcnt lgkmcnt(0)
  v_smfmac_f32_16x16x64_bf16 v[32:35], v[0:3], v[60:67], v74
  v_cvt_pk_bf16_f32 v24, v24, v25
  v_cvt_pk_bf16_f32 v25, v26, v27
  v_bfi_b32 v24, 1, s72, v24
  v_smfmac_f32_16x16x64_bf16 v[32:35], v[4:7], a[240:247], v74
  buffer_store_dwordx2 v[24:25], v68, s[8:11], s75 offen
  v_smfmac_f32_16x16x64_bf16 v[32:35], v[8:11], a[248:255], v74
  v_mov_b64 v[18:19], v[72:73]
  s_nop 4
  v_cvt_pk_bf16_f32 v32, v32, v33
  v_cvt_pk_bf16_f32 v33, v34, v35
  v_bfi_b32 v32, 1, s72, v32
  buffer_store_dwordx2 v[32:33], v68, s[8:11], s76 offen
  ds_read_b128 v[0:3], v76 offset:14848
  s_waitcnt lgkmcnt(0)
  ds_read_b64 v[16:17], v77 offset:256
  s_waitcnt lgkmcnt(0)
  ds_read_b128 v[64:67], v76 offset:19456
  s_waitcnt lgkmcnt(0)
  v_xor_b32 v75, 0x8000, v75
  v_mov_b64 v[28:29], 0
  v_mov_b64 v[30:31], 0
  v_mov_b64 v[32:33], 0
  v_mov_b64 v[34:35], 0
  buffer_load_dwordx4 v[52:55], v76, s[8:11], s60 offen offset:0 sc1
  buffer_load_dwordx4 v[56:59], v76, s[8:11], s60 offen offset:1024 sc1
  s_add_u32 s66, s66, 1
  s_xor_b32 s64, s64, 16384
  s_xor_b32 s65, s65, 16384
  s_add_u32 s58, s58, 655360
  s_add_u32 s59, s59, 655360
  s_add_u32 s70, s70, 655360
  s_add_u32 s68, s68, 655360
  s_mov_b32 m0, 10752
  s_add_u32 s85, s65, 6144
  s_waitcnt lgkmcnt(0)
  s_waitcnt vmcnt(1)
  v_mfma_f32_16x16x32_bf16 v[4:7], v[0:3], v[52:55], 0
  v_bitop3_b32 v72, v52, v54, s72 bitop3:0x7e
  s_waitcnt vmcnt(0)
  v_mfma_f32_16x16x32_bf16 v[4:7], v[0:3], v[56:59], v[4:7]
  v_bitop3_b32 v73, v56, v58, s72 bitop3:0x7e
  v_bitop3_b32 v72, v72, v73, 1 bitop3:0xa8
  v_cmp_ne_u32 vcc, 0, v72
  s_nop 3
  v_add_f32_dpp v4, v4, v4 row_ror:4 row_mask:0xf bank_mask:0xf
  v_add_f32_dpp v5, v5, v5 row_ror:4 row_mask:0xf bank_mask:0xf
  s_cmp_eq_u64 vcc, 0
  v_add_f32_dpp v4, v4, v4 row_ror:8 row_mask:0xf bank_mask:0xf
  v_add_f32_dpp v5, v5, v5 row_ror:8 row_mask:0xf bank_mask:0xf
  s_cselect_b32 s54, s62, 268435456
  v_cvt_pk_bf16_f32 v4, v4, v5
  buffer_store_dword v4, v69, s[8:11], s54 offen
  s_cbranch_vccnz Cf0_h1r
  s_xor_b32 s62, s62, 16384
  buffer_store_dword v71, v69, s[8:11], s62 offen
  s_xor_b32 s72, s72, 1
  s_branch Cf0_h2
Cf0_h1r:
  s_mov_b64 exec, vcc
  buffer_load_dwordx4 v[52:55], v76, s[8:11], s60 offen offset:0 sc1
  buffer_load_dwordx4 v[56:59], v76, s[8:11], s60 offen offset:1024 sc1
  s_mov_b64 exec, -1
  s_add_u32 s67, s67, 1
  s_waitcnt vmcnt(1)
  v_mfma_f32_16x16x32_bf16 v[4:7], v[0:3], v[52:55], 0
  v_bitop3_b32 v72, v52, v54, s72 bitop3:0x7e
  s_waitcnt vmcnt(0)
  v_mfma_f32_16x16x32_bf16 v[4:7], v[0:3], v[56:59], v[4:7]
  v_bitop3_b32 v73, v56, v58, s72 bitop3:0x7e
  v_bitop3_b32 v72, v72, v73, 1 bitop3:0xa8
  v_cmp_ne_u32 vcc, 0, v72
  s_cbranch_vccz Cf0_h1p
Cf0_h1s:
  s_mov_b64 exec, vcc
  buffer_load_dwordx4 v[52:55], v76, s[8:11], s60 offen offset:0 sc1
  buffer_load_dwordx4 v[56:59], v76, s[8:11], s60 offen offset:1024 sc1
  s_mov_b64 exec, -1
  s_add_u32 s67, s67, 1
  s_waitcnt vmcnt(1)
  v_mfma_f32_16x16x32_bf16 v[4:7], v[0:3], v[52:55], 0
  v_bitop3_b32 v72, v52, v54, s72 bitop3:0x7e
  s_waitcnt vmcnt(0)
  v_mfma_f32_16x16x32_bf16 v[4:7], v[0:3], v[56:59], v[4:7]
  v_bitop3_b32 v73, v56, v58, s72 bitop3:0x7e
  v_bitop3_b32 v72, v72, v73, 1 bitop3:0xa8
  v_cmp_ne_u32 vcc, 0, v72
  s_cbranch_vccz Cf0_h1p
  s_cmp_lt_u32 s67, 131072
  s_cbranch_scc1 Cf0_h1s
Cf0_h1p:
  s_nop 2
  v_add_f32_dpp v4, v4, v4 row_ror:4 row_mask:0xf bank_mask:0xf
  v_add_f32_dpp v5, v5, v5 row_ror:4 row_mask:0xf bank_mask:0xf
  s_nop 0
  v_add_f32_dpp v4, v4, v4 row_ror:8 row_mask:0xf bank_mask:0xf
  v_add_f32_dpp v5, v5, v5 row_ror:8 row_mask:0xf bank_mask:0xf
  v_cvt_pk_bf16_f32 v4, v4, v5
  buffer_store_dword v4, v69, s[8:11], s62 offen
  s_xor_b32 s62, s62, 16384
  buffer_store_dword v71, v69, s[8:11], s62 offen
  s_xor_b32 s72, s72, 1
  s_branch Cf0_h2
Cf0_h2r:
  s_mov_b64 exec, vcc
  buffer_load_dwordx4 v[0:3], v76, s[8:11], s65 offen offset:0 sc1
  s_mov_b64 exec, -1
  s_add_u32 s67, s67, 1
  s_waitcnt vmcnt(4)
  v_max3_u32 v72, v0, v1, v2
  v_max_u32 v72, v72, v3
  ds_write_b128 v76, v[0:3] offset:4608
  v_cmp_eq_u32 vcc, -1, v72
  s_cbranch_vccz Cf0_h2w
  s_mov_b64 exec, vcc
  buffer_load_dwordx4 v[0:3], v76, s[8:11], s65 offen offset:0 sc1
  s_mov_b64 exec, -1
  s_add_u32 s67, s67, 1
  s_waitcnt vmcnt(4)
  v_max3_u32 v72, v0, v1, v2
  v_max_u32 v72, v72, v3
  ds_write_b128 v76, v[0:3] offset:4608
  v_cmp_eq_u32 vcc, -1, v72
  s_cbranch_vccz Cf0_h2w
Cf0_h2s:
  s_mov_b64 exec, vcc
  buffer_load_dwordx4 v[0:3], v76, s[8:11], s65 offen offset:0 sc1
  s_mov_b64 exec, -1
  s_add_u32 s67, s67, 1
  s_waitcnt vmcnt(2)
  v_max3_u32 v72, v0, v1, v2
  v_max_u32 v72, v72, v3
  ds_write_b128 v76, v[0:3] offset:4608
  v_cmp_eq_u32 vcc, -1, v72
  s_cbranch_vccz Cf0_h2w
  s_mov_b64 exec, vcc
  buffer_load_dwordx4 v[0:3], v76, s[8:11], s65 offen offset:0 sc1
  s_mov_b64 exec, -1
  s_add_u32 s67, s67, 1
  s_waitcnt vmcnt(2)
  v_max3_u32 v72, v0, v1, v2
  v_max_u32 v72, v72, v3
  ds_write_b128 v76, v[0:3] offset:4608
  v_cmp_eq_u32 vcc, -1, v72
  s_cbranch_vccz Cf0_h2w
  s_mov_b64 exec, vcc
  buffer_load_dwordx4 v[0:3], v76, s[8:11], s65 offen offset:0 sc1
  s_mov_b64 exec, -1
  s_add_u32 s67, s67, 1
  s_waitcnt vmcnt(2)
  v_max3_u32 v72, v0, v1, v2
  v_max_u32 v72, v72, v3
  ds_write_b128 v76, v[0:3] offset:4608
  v_cmp_eq_u32 vcc, -1, v72
  s_cbranch_vccz Cf0_h2w
  s_cmp_lt_u32 s67, 131072
  s_cbranch_scc1 Cf0_h2s
  s_branch Cf0_h2w
Cf0_rec:
  s_nop 7
  s_waitcnt vmcnt(0) lgkmcnt(0)
  v_max3_u32 v72, v0, v1, v2
  v_max3_u32 v72, v72, v3, v4
  v_max3_u32 v72, v72, v5, v6
  v_max3_u32 v72, v72, v7, v8
  v_max3_u32 v72, v72, v9, v10
  v_max3_u32 v72, v72, v11, v12
  v_max3_u32 v72, v72, v13, v14
  v_max3_u32 v72, v72, v15, v16
  v_max3_u32 v72, v72, v17, v18
  v_max_u32 v72, v72, v19
  v_cmp_eq_u32 vcc, -1, v72
  s_cbranch_vccz Cf0_recok
  s_barrier
  v_mov_b64 v[20:21], 0
  v_mov_b64 v[22:23], 0
  v_mov_b64 v[24:25], 0
  v_mov_b64 v[26:27], 0
  v_mov_b64 v[28:29], 0
  v_mov_b64 v[30:31], 0
  v_mov_b64 v[32:33], 0
  v_mov_b64 v[34:35], 0
  s_waitcnt lgkmcnt(0)
  s_barrier
  ds_read_b128 v[0:3], v76 offset:4608
  s_waitcnt lgkmcnt(0)
  v_smfmac_f32_16x16x64_bf16 v[20:23], v[0:3], v[80:87], v74
  v_smfmac_f32_16x16x64_bf16 v[24:27], v[0:3], v[88:95], v74
  ds_read_b128 v[60:63], v76 offset:16384
  ds_read_b128 v[64:67], v76 offset:17408
  s_waitcnt lgkmcnt(0)
  v_smfmac_f32_16x16x64_bf16 v[28:31], v[0:3], v[60:67], v74
  ds_read_b128 v[60:63], v76 offset:18432
  ds_read_b128 v[64:67], v76 offset:19456
  s_waitcnt lgkmcnt(0)
  v_smfmac_f32_16x16x64_bf16 v[32:35], v[0:3], v[60:67], v74
  ds_read_b128 v[4:7], v76 offset:5632
  s_waitcnt lgkmcnt(0)
  v_smfmac_f32_16x16x64_bf16 v[20:23], v[4:7], v[96:103], v74
  v_smfmac_f32_16x16x64_bf16 v[24:27], v[4:7], v[104:111], v74
  ds_read_b128 v[60:63], v76 offset:32768
  ds_read_b128 v[64:67], v76 offset:33792
  s_waitcnt lgkmcnt(0)
  v_smfmac_f32_16x16x64_bf16 v[28:31], v[4:7], v[60:67], v74
  ds_read_b128 v[60:63], v76 offset:34816
  ds_read_b128 v[64:67], v76 offset:35840
  s_waitcnt lgkmcnt(0)
  v_smfmac_f32_16x16x64_bf16 v[32:35], v[4:7], v[60:67], v74
  ds_read_b128 v[8:11], v76 offset:6656
  s_waitcnt lgkmcnt(0)
  v_smfmac_f32_16x16x64_bf16 v[20:23], v[8:11], v[112:119], v74
  v_smfmac_f32_16x16x64_bf16 v[24:27], v[8:11], v[120:127], v74
  v_smfmac_f32_16x16x64_bf16 v[28:31], v[8:11], v[208:215], v74
  v_smfmac_f32_16x16x64_bf16 v[32:35], v[8:11], v[216:223], v74
  ds_read_b128 v[12:15], v76 offset:7680
  s_waitcnt lgkmcnt(0)
  v_smfmac_f32_16x16x64_bf16 v[20:23], v[12:15], v[128:135], v74
  v_smfmac_f32_16x16x64_bf16 v[24:27], v[12:15], v[136:143], v74
  v_smfmac_f32_16x16x64_bf16 v[28:31], v[12:15], v[224:231], v74
  v_smfmac_f32_16x16x64_bf16 v[32:35], v[12:15], v[232:239], v74
  ds_read_b128 v[0:3], v76 offset:8704
  s_waitcnt lgkmcnt(0)
  v_smfmac_f32_16x16x64_bf16 v[20:23], v[0:3], v[144:151], v74
  v_smfmac_f32_16x16x64_bf16 v[24:27], v[0:3], v[152:159], v74
  ds_read_b128 v[60:63], v76 offset:49152
  ds_read_b128 v[64:67], v76 offset:50176
  s_waitcnt lgkmcnt(0)
  v_smfmac_f32_16x16x64_bf16 v[28:31], v[0:3], v[60:67], v74
  ds_read_b128 v[60:63], v76 offset:51200
  ds_read_b128 v[64:67], v76 offset:52224
  s_waitcnt lgkmcnt(0)
  v_smfmac_f32_16x16x64_bf16 v[32:35], v[0:3], v[60:67], v74
  ds_read_b128 v[8:11], v76 offset:9728
  s_waitcnt lgkmcnt(0)
  v_smfmac_f32_16x16x64_bf16 v[20:23], v[8:11], v[160:167], v74
  v_smfmac_f32_16x16x64_bf16 v[24:27], v[8:11], v[168:175], v74
  ds_read_b128 v[60:63], v75 offset:16384
  ds_read_b128 v[64:67], v75 offset:17408
  s_waitcnt lgkmcnt(0)
  v_smfmac_f32_16x16x64_bf16 v[28:31], v[8:11], v[60:67], v74
  ds_read_b128 v[60:63], v75 offset:18432
  ds_read_b128 v[64:67], v75 offset:19456
  s_waitcnt lgkmcnt(0)
  v_smfmac_f32_16x16x64_bf16 v[32:35], v[8:11], v[60:67], v74
  ds_read_b128 v[16:19], v76 offset:10752
  ds_read_b128 v[60:63], v75 offset:0
  ds_read_b128 v[64:67], v75 offset:1024
  s_waitcnt lgkmcnt(0)
  v_smfmac_f32_16x16x64_bf16 v[20:23], v[16:19], v[60:67], v74
  ds_read_b128 v[60:63], v75 offset:2048
  ds_read_b128 v[64:67], v75 offset:3072
  s_waitcnt lgkmcnt(0)
  v_smfmac_f32_16x16x64_bf16 v[24:27], v[16:19], v[60:67], v74
  v_smfmac_f32_16x16x64_bf16 v[28:31], v[16:19], v[240:247], v74
  v_smfmac_f32_16x16x64_bf16 v[32:35], v[16:19], v[248:255], v74
  ds_read_b128 v[4:7], v76 offset:11776
  s_waitcnt lgkmcnt(0)
  v_smfmac_f32_16x16x64_bf16 v[20:23], v[4:7], v[176:183], v74
  v_smfmac_f32_16x16x64_bf16 v[24:27], v[4:7], v[184:191], v74
  v_smfmac_f32_16x16x64_bf16 v[28:31], v[4:7], a[0:7], v74
  v_smfmac_f32_16x16x64_bf16 v[32:35], v[4:7], a[8:15], v74
  ds_read_b128 v[12:15], v76 offset:12800
  s_waitcnt lgkmcnt(0)
  v_smfmac_f32_16x16x64_bf16 v[20:23], v[12:15], v[192:199], v74
  v_smfmac_f32_16x16x64_bf16 v[24:27], v[12:15], v[200:207], v74
  v_smfmac_f32_16x16x64_bf16 v[28:31], v[12:15], a[16:23], v74
  v_smfmac_f32_16x16x64_bf16 v[32:35], v[12:15], a[24:31], v74
  v_add_f32 v20, v20, v22
  v_add_f32 v21, v21, v23
  v_add_f32 v24, v24, v26
  v_cvt_pk_bf16_f32 v22, v20, v24
  ds_write_b32 v79, v22 offset:0
  v_add_f32 v25, v25, v27
  v_cvt_pk_bf16_f32 v23, v21, v25
  ds_write_b32 v79, v23 offset:576
  v_add_f32 v28, v28, v30
  v_add_f32 v29, v29, v31
  s_waitcnt lgkmcnt(0)
  s_nop 1
  s_branch Cf0_recok
Cf0_mx:
  s_waitcnt lgkmcnt(0)
  s_barrier
  buffer_load_dwordx4 v[52:55], v76, s[8:11], s59 offen offset:0 sc1
  buffer_load_dwordx4 v[0:3], v76, s[8:11], s58 offen offset:0 sc1
  ds_read_b128 v[20:23], v77 offset:0
  ds_read_b128 v[28:31], v77 offset:256
  buffer_load_dwordx4 v[56:59], v76, s[8:11], s59 offen offset:1024 sc1
  buffer_load_dwordx4 v[4:7], v76, s[8:11], s58 offen offset:1024 sc1
  ds_read_b128 v[24:27], v77 offset:128
  ds_read_b128 v[32:35], v77 offset:384
  s_waitcnt vmcnt(2) lgkmcnt(3)
  v_mfma_f32_16x16x32_bf16 v[8:11], v[0:3], v[20:23], 0
  s_waitcnt vmcnt(0) lgkmcnt(1)
  v_mfma_f32_16x16x32_bf16 v[8:11], v[4:7], v[24:27], v[8:11]
  v_mfma_f32_16x16x32_bf16 v[12:15], v[28:31], v[20:23], 0
  s_waitcnt lgkmcnt(0)
  v_mfma_f32_16x16x32_bf16 v[12:15], v[32:35], v[24:27], v[12:15]
  v_add_f32_dpp v8, v10, v8 quad_perm:[2,3,0,1] row_mask:0xf bank_mask:0xf
  v_add_f32_dpp v9, v11, v9 quad_perm:[2,3,0,1] row_mask:0xf bank_mask:0xf
  s_nop 0
  v_mov_b32_dpp v8, v8 quad_perm:[0,1,0,1] row_mask:0xf bank_mask:0xf
  v_mov_b32_dpp v9, v9 quad_perm:[0,1,0,1] row_mask:0xf bank_mask:0xf
  s_nop 1
  v_add_f32_dpp v12, v14, v12 quad_perm:[2,3,0,1] row_mask:0xf bank_mask:0xf
  v_add_f32_dpp v13, v15, v13 quad_perm:[2,3,0,1] row_mask:0xf bank_mask:0xf
  s_nop 0
  v_mov_b32_dpp v12, v12 quad_perm:[0,1,0,1] row_mask:0xf bank_mask:0xf
  v_mov_b32_dpp v13, v13 quad_perm:[0,1,0,1] row_mask:0xf bank_mask:0xf
  v_mul_f32 v12, s69, v12
  ds_write_b32 v78, v8 offset:8704
  v_mul_f32 v13, s69, v13
  ds_write_b32 v78, v9 offset:8768
  s_waitcnt lgkmcnt(0)
  s_barrier
  ds_read_b128 v[36:39], v78 offset:8704
  ds_read_b128 v[40:43], v78 offset:8768
  s_waitcnt lgkmcnt(0)
  s_barrier
  v_max_f32 v16, v36, v37
  v_max3_f32 v16, v16, v38, v39
  v_max3_f32 v16, v16, v40, v41
  v_max3_f32 v16, v16, v42, v43
  v_max3_f32 v16, v16, v12, v13
  v_mov_b32 v17, v16
  s_nop 1
  v_permlane16_swap_b32 v16, v17
  v_max_f32 v16, v16, v17
  v_mov_b32 v17, v16
  s_nop 1
  v_permlane32_swap_b32 v16, v17
  v_max_f32 v16, v16, v17
  v_sub_f32 v36, v36, v16
  v_sub_f32 v37, v37, v16
  v_sub_f32 v38, v38, v16
  v_sub_f32 v39, v39, v16
  v_sub_f32 v40, v40, v16
  v_sub_f32 v41, v41, v16
  v_sub_f32 v42, v42, v16
  v_sub_f32 v43, v43, v16
  v_sub_f32 v12, v12, v16
  v_sub_f32 v13, v13, v16
  v_exp_f32 v36, v36
  v_exp_f32 v37, v37
  v_exp_f32 v38, v38
  v_exp_f32 v39, v39
  v_exp_f32 v40, v40
  v_exp_f32 v41, v41
  v_exp_f32 v42, v42
  v_exp_f32 v43, v43
  v_exp_f32 v12, v12
  v_exp_f32 v13, v13
  v_cvt_pk_bf16_f32 v32, v36, v40
  v_cvt_pk_bf16_f32 v33, v37, v41
  v_cvt_pk_bf16_f32 v34, v38, v42
  v_cvt_pk_bf16_f32 v35, v39, v43
  v_cvt_pk_bf16_f32 v28, v12, v13
  v_cvt_pk_bf16_f32 v31, v12, v13
  v_mov_b32 v29, 0
  v_mov_b32 v30, 0
  v_mfma_f32_16x16x32_bf16 v[8:11], v[32:35], v[68:71], 0
  v_mfma_f32_16x16x32_bf16 v[0:3], v[32:35], v[52:55], 0
  v_mfma_f32_16x16x32_bf16 v[4:7], v[32:35], v[56:59], 0
  v_mfma_f32_16x16x16_bf16 v[8:11], v[28:29], v[68:69], v[8:11]
  v_mfma_f32_16x16x16_bf16 v[0:3], v[28:29], v[72:73], v[0:3]
  v_mfma_f32_16x16x16_bf16 v[4:7], v[30:31], v[72:73], v[4:7]
  ds_read_b128 v[52:55], v75 offset:32768
  v_rcp_f32 v10, v8
  v_rcp_f32 v11, v9
  v_mul_f32 v0, v10, v0
  v_mul_f32 v1, v11, v1
  v_max3_f32 v8, v8, v9, v10
  v_mul_f32 v4, v10, v4
  v_mul_f32 v5, v11, v5
  v_cvt_pk_bf16_f32 v2, v0, v4
  ds_write_b32 v79, v2 offset:8704
  v_cvt_pk_bf16_f32 v3, v1, v5
  ds_write_b32 v79, v3 offset:9280
  ds_read_b128 v[12:15], v78 offset:8704
  ds_read_b128 v[56:59], v75 offset:33792
  v_mov_b64 v[16:17], 0
  v_mov_b64 v[18:19], 0
  v_mov_b64 v[20:21], 0
  v_mov_b64 v[22:23], 0
  v_mov_b64 v[24:25], 0
  v_mov_b64 v[26:27], 0
  s_branch Cf0_mxok
Cf0_kv3:
  s_waitcnt lgkmcnt(0)
  s_cmp_ge_u32 s57, 0x700
  s_cbranch_scc1 Cf0_kvb
  s_load_dword s57, s[12:13], s71 glc
  s_add_u32 s67, s67, 1
  s_cmp_lt_u32 s67, 131072
  s_cbranch_scc1 Cf0_kv3
  s_waitcnt lgkmcnt(0)
  s_branch Cf0_kvb
Cf0_last:
  ds_read_b128 v[4:7], v76 offset:5632
  ds_read_b128 v[12:15], v76 offset:7680
  ds_read_b128 v[44:47], v76 offset:32768
  ds_read_b128 v[48:51], v76 offset:33792
  s_nop 5
  v_mov_b64 v[20:21], 0
  v_mov_b64 v[22:23], 0
  v_mov_b64 v[24:25], 0
  v_mov_b64 v[26:27], 0
  v_smfmac_f32_16x16x64_bf16 v[28:31], v[0:3], v[36:43], v74
  ds_read_b128 v[36:39], v76 offset:34816
  ds_read_b128 v[40:43], v76 offset:35840
  v_smfmac_f32_16x16x64_bf16 v[32:35], v[0:3], v[60:67], v74
  s_waitcnt lgkmcnt(5)
  v_smfmac_f32_16x16x64_bf16 v[20:23], v[0:3], a[32:39], v74
  ds_read_b128 v[60:63], v76 offset:49152
  ds_read_b128 v[64:67], v76 offset:50176
  v_smfmac_f32_16x16x64_bf16 v[24:27], v[0:3], a[40:47], v74
  s_waitcnt lgkmcnt(4)
  v_smfmac_f32_16x16x64_bf16 v[20:23], v[4:7], a[48:55], v74
  buffer_store_dwordx4 v[16:19], v76, s[8:11], s68 offen sc1
  v_smfmac_f32_16x16x64_bf16 v[24:27], v[4:7], a[56:63], v74
  v_smfmac_f32_16x16x64_bf16 v[28:31], v[4:7], v[44:51], v74
  s_waitcnt lgkmcnt(2)
  v_smfmac_f32_16x16x64_bf16 v[20:23], v[8:11], a[64:71], v74
  ds_read_b128 v[44:47], v76 offset:51200
  ds_read_b128 v[48:51], v76 offset:52224
  v_smfmac_f32_16x16x64_bf16 v[24:27], v[8:11], a[72:79], v74
  v_smfmac_f32_16x16x64_bf16 v[32:35], v[4:7], v[36:43], v74
  v_smfmac_f32_16x16x64_bf16 v[28:31], v[8:11], v[208:215], v74
  ds_read_b128 v[36:39], v75 offset:16384
  ds_read_b128 v[40:43], v75 offset:17408
  v_smfmac_f32_16x16x64_bf16 v[32:35], v[8:11], v[216:223], v74
  v_smfmac_f32_16x16x64_bf16 v[20:23], v[12:15], a[80:87], v74
  v_smfmac_f32_16x16x64_bf16 v[24:27], v[12:15], a[88:95], v74
  v_smfmac_f32_16x16x64_bf16 v[28:31], v[12:15], v[224:231], v74
  v_smfmac_f32_16x16x64_bf16 v[32:35], v[12:15], v[232:239], v74
  s_waitcnt vmcnt(2)
  s_waitcnt vmcnt(1)
  s_barrier
Cf0_lastr:
  ds_read_b128 v[0:3], v76 offset:8704
  ds_read_b128 v[8:11], v76 offset:9728
  ds_read_b128 v[16:19], v76 offset:10752
  ds_read_b128 v[4:7], v76 offset:11776
  ds_read_b128 v[12:15], v76 offset:12800
  s_waitcnt lgkmcnt(4)
  v_max3_u32 v72, v0, v1, v2
  s_waitcnt lgkmcnt(1)
  v_max3_u32 v72, v72, v3, v4
  v_max3_u32 v72, v72, v5, v6
  v_max3_u32 v72, v72, v7, v8
  v_max3_u32 v72, v72, v9, v10
  s_waitcnt lgkmcnt(0)
  v_max3_u32 v72, v72, v11, v12
  v_max3_u32 v72, v72, v13, v14
  v_max3_u32 v72, v72, v15, v16
  v_max3_u32 v72, v72, v17, v18
  v_max_u32 v72, v72, v19
  v_cmp_eq_u32 vcc, -1, v72
  s_cbranch_vccnz Cf0_lastp
Cf0_lastg:
  v_smfmac_f32_16x16x64_bf16 v[28:31], v[0:3], v[60:67], v74
  ds_read_b128 v[60:63], v75 offset:18432
  ds_read_b128 v[64:67], v75 offset:19456
  v_smfmac_f32_16x16x64_bf16 v[32:35], v[0:3], v[44:51], v74
  v_smfmac_f32_16x16x64_bf16 v[28:31], v[8:11], v[36:43], v74
  v_smfmac_f32_16x16x64_bf16 v[28:31], v[16:19], v[240:247], v74
  v_smfmac_f32_16x16x64_bf16 v[28:31], v[4:7], a[0:7], v74
  v_smfmac_f32_16x16x64_bf16 v[28:31], v[12:15], a[16:23], v74
  v_smfmac_f32_16x16x64_bf16 v[32:35], v[16:19], v[248:255], v74
  v_smfmac_f32_16x16x64_bf16 v[32:35], v[4:7], a[8:15], v74
  s_waitcnt lgkmcnt(0)
  v_smfmac_f32_16x16x64_bf16 v[32:35], v[12:15], a[24:31], v74
  v_smfmac_f32_16x16x64_bf16 v[32:35], v[8:11], v[60:67], v74
  v_smfmac_f32_16x16x64_bf16 v[20:23], v[0:3], a[96:103], v74
  v_smfmac_f32_16x16x64_bf16 v[20:23], v[8:11], a[112:119], v74
  v_add_f32 v28, v28, v30
  v_add_f32 v32, v32, v34
  v_cvt_pk_bf16_f32 v30, v28, v32
  v_smfmac_f32_16x16x64_bf16 v[20:23], v[16:19], a[128:135], v74
  ds_write_b32 v79, v30 offset:256
  v_add_f32 v29, v29, v31
  v_add_f32 v33, v33, v35
  v_cvt_pk_bf16_f32 v31, v29, v33
  v_smfmac_f32_16x16x64_bf16 v[20:23], v[4:7], a[144:151], v74
  ds_write_b32 v79, v31 offset:832
  v_smfmac_f32_16x16x64_bf16 v[20:23], v[12:15], a[160:167], v74
  v_smfmac_f32_16x16x64_bf16 v[24:27], v[0:3], a[104:111], v74
  v_smfmac_f32_16x16x64_bf16 v[24:27], v[8:11], a[120:127], v74
  v_smfmac_f32_16x16x64_bf16 v[24:27], v[16:19], a[136:143], v74
  s_waitcnt lgkmcnt(0)
  s_barrier
  ds_read_b64 v[52:53], v77 offset:256
  v_add_f32 v20, v20, v22
  v_smfmac_f32_16x16x64_bf16 v[24:27], v[4:7], a[152:159], v74
  v_add_f32 v21, v21, v23
  v_smfmac_f32_16x16x64_bf16 v[24:27], v[12:15], a[168:175], v74
  v_cvt_pk_bf16_f32 v54, v20, v21
  s_add_u32 s68, s68, 655360
  s_nop 3
  v_add_f32 v24, v24, v26
  v_add_f32 v25, v25, v27
  v_cvt_pk_bf16_f32 v55, v24, v25
  s_waitcnt lgkmcnt(0)
  buffer_store_dwordx4 v[52:55], v76, s[8:11], s68 offen sc1
  s_branch Cf0_done
Cf0_lastp:
  s_add_u32 s72, s72, 2
  s_cmp_ge_u32 s72, 131072
  s_cbranch_scc1 Cf0_lastg
  s_barrier
  buffer_load_dwordx4 v76, s[8:11], s85 offen offset:0 sc1 lds
  s_waitcnt vmcnt(0)
  s_barrier
  s_branch Cf0_lastr
Cf0_done:
  s_branch L_cexit
L_w1:
  v_mov_b64 v[20:21], 0
  v_mov_b64 v[22:23], 0
  v_mov_b64 v[24:25], 0
  v_mov_b64 v[26:27], 0
  v_mov_b64 v[28:29], 0
  v_mov_b64 v[30:31], 0
  v_mov_b64 v[32:33], 0
  v_mov_b64 v[34:35], 0
  s_mov_b32 s78, 0x3f803f80
  s_mov_b32 s79, s78
  s_mov_b32 s65, 360448
  s_mov_b32 m0, 15872
  s_lshl_b32 s71, s53, 2
  s_add_u32 s71, s71, 128
  s_movk_i32 s56, 0x1000
  v_lshlrev_b32 v73, 2, v76
  v_mov_b32 v72, 0
  s_mov_b64 s[16:17], s[8:9]
  s_mov_b32 s18, 268435456
  s_mov_b32 s19, 0x20000
  s_getpc_b64 s[20:21]
Cf1_pc:
  s_add_u32 s20, s20, (Cf1_last - Cf1_pc)
  s_addc_u32 s21, s21, 0
  v_mov_b32 v68, 14880
  buffer_load_dwordx4 v[52:55], v76, s[8:11], s59 offen offset:0 sc1
  buffer_load_dwordx4 v[56:59], v76, s[8:11], s59 offen offset:1024 sc1
  ds_read_b128 v[36:39], v76 offset:20480
  ds_read_b128 v[40:43], v76 offset:21504
  ds_read_b128 v[60:63], v76 offset:22528
  ds_read_b128 v[64:67], v76 offset:23552
  ds_read_b128 v[0:3], v76 offset:4608
  ds_read_b128 v[4:7], v76 offset:5632
  ds_read_b128 v[8:11], v76 offset:6656
  ds_read_b128 v[12:15], v76 offset:7680
  s_waitcnt lgkmcnt(0)
  s_cmp_eq_u32 s66, 1
  s_branch Cf1_top2
.p2align 6
Cf1_h2:
  ds_read_b128 v[36:39], v76 offset:20480
  s_waitcnt lgkmcnt(0)
  v_lshlrev_b32 v73, 2, v76
  buffer_load_dwordx4 v[8:11], v76, s[8:11], s65 offen offset:2048 sc1
  ds_read_b128 v[40:43], v76 offset:21504
  s_waitcnt lgkmcnt(0)
  v_mov_b64 v[20:21], 0
  v_mov_b64 v[22:23], 0
  v_mov_b64 v[24:25], 0
  v_mov_b64 v[26:27], 0
  v_mov_b32 v68, 14880
  buffer_load_dwordx4 v[8:11], v76, s[8:11], s65 offen offset:2048 sc1
  ds_read_b128 v[60:63], v76 offset:22528
  s_waitcnt lgkmcnt(0)
  s_cmp_eq_u32 s66, 62
  s_cselect_b64 s[16:17], s[20:21], s[16:17]
  s_cselect_b32 s18, (Cf1_done - Cf1_last), s18
  s_cselect_b32 s70, 0, s70
  s_cmp_eq_u32 s66, 63
  s_cselect_b32 s59, 268435456, s59
  s_cselect_b32 s58, 268435456, s58
  buffer_load_dwordx4 v[8:11], v76, s[8:11], s65 offen offset:2048 sc1
  buffer_load_dwordx4 v[52:55], v76, s[8:11], s59 offen offset:0 sc1
  buffer_load_dwordx4 v[56:59], v76, s[8:11], s59 offen offset:1024 sc1
  s_waitcnt vmcnt(4)
  v_max3_u32 v72, v8, v9, v10
  v_max_u32 v72, v72, v11
  ds_write_b128 v76, v[8:11] offset:6656
  v_cmp_eq_u32 vcc, -1, v72
  s_cbranch_vccnz Cf1_h2r
Cf1_h2w:
  s_cmp_eq_u32 s66, 63
  s_waitcnt lgkmcnt(0)
  s_barrier
  ds_read_b128 v[0:3], v76 offset:4608
  buffer_load_dwordx4 v76, s[8:11], s85 offen offset:0 sc1 lds
Cf1_top2:
  v_smfmac_f32_16x16x64_bf16 v[20:23], v[8:11], v[112:119], v74
  s_cbranch_scc1 Cf1_last
  v_smfmac_f32_16x16x64_bf16 v[24:27], v[8:11], v[120:127], v74
  buffer_load_dwordx4 v[44:47], v76, s[8:11], s58 offen offset:0 sc1
  s_mov_b32 m0, 15872
  v_smfmac_f32_16x16x64_bf16 v[28:31], v[8:11], v[208:215], v74
  buffer_load_dwordx4 v[48:51], v76, s[8:11], s58 offen offset:1024 sc1
  v_smfmac_f32_16x16x64_bf16 v[32:35], v[8:11], v[216:223], v74
  ds_read_b128 v[4:7], v76 offset:5632
  s_waitcnt lgkmcnt(1)
  v_smfmac_f32_16x16x64_bf16 v[20:23], v[0:3], v[80:87], v74
  ds_read_b128 v[12:15], v76 offset:7680
  v_smfmac_f32_16x16x64_bf16 v[28:31], v[0:3], v[36:43], v74
  ds_read_b128 v[36:39], v76 offset:36864
  v_smfmac_f32_16x16x64_bf16 v[24:27], v[0:3], v[88:95], v74
  buffer_store_dwordx4 v[16:19], v76, s[8:11], s68 offen sc1
  ds_read_b128 v[40:43], v76 offset:37888
  v_smfmac_f32_16x16x64_bf16 v[32:35], v[0:3], v[60:67], v74
  buffer_load_dword v73, s[16:19], s70 offen lds
  ds_read_b128 v[60:63], v76 offset:38912
  s_waitcnt lgkmcnt(4)
  v_smfmac_f32_16x16x64_bf16 v[20:23], v[4:7], v[96:103], v74
  ds_read_b128 v[64:67], v76 offset:39936
  v_smfmac_f32_16x16x64_bf16 v[24:27], v[4:7], v[104:111], v74
  s_waitcnt vmcnt(5)
  s_waitcnt lgkmcnt(4)
  v_smfmac_f32_16x16x64_bf16 v[20:23], v[12:15], v[128:135], v74
  s_barrier
  ds_read_b128 v[8:11], v76 offset:8704
  s_waitcnt lgkmcnt(3)
  v_smfmac_f32_16x16x64_bf16 v[28:31], v[4:7], v[36:43], v74
  ds_read_b128 v[36:39], v76 offset:53248
  v_smfmac_f32_16x16x64_bf16 v[24:27], v[12:15], v[136:143], v74
  ds_read_b128 v[40:43], v76 offset:54272
  s_waitcnt lgkmcnt(3)
  v_smfmac_f32_16x16x64_bf16 v[32:35], v[4:7], v[60:67], v74
  ds_read_b128 v[0:3], v76 offset:9728
  v_smfmac_f32_16x16x64_bf16 v[28:31], v[12:15], v[224:231], v74
  ds_read_b128 v[60:63], v76 offset:55296
  v_smfmac_f32_16x16x64_bf16 v[32:35], v[12:15], v[232:239], v74
  s_waitcnt vmcnt(4)
  ds_read_b128 v[64:67], v76 offset:56320
  s_waitcnt lgkmcnt(5)
  v_smfmac_f32_16x16x64_bf16 v[20:23], v[8:11], v[144:151], v74
  s_barrier
  ds_read_b128 v[4:7], v76 offset:11776
  s_waitcnt lgkmcnt(4)
  v_smfmac_f32_16x16x64_bf16 v[28:31], v[8:11], v[36:43], v74
  ds_read_b128 v[12:15], v76 offset:12800
  ds_read_b128 v[36:39], v75 offset:4096
  v_smfmac_f32_16x16x64_bf16 v[24:27], v[8:11], v[152:159], v74
  ds_read_b128 v[16:19], v76 offset:10752
  s_waitcnt lgkmcnt(6)
  v_smfmac_f32_16x16x64_bf16 v[20:23], v[0:3], v[160:167], v74
  ds_read_b128 v[40:43], v75 offset:5120
  s_waitcnt lgkmcnt(5)
  v_smfmac_f32_16x16x64_bf16 v[32:35], v[8:11], v[60:67], v74
  ds_read_b128 v[60:63], v75 offset:6144
  v_smfmac_f32_16x16x64_bf16 v[24:27], v[0:3], v[168:175], v74
  ds_read_b128 v[64:67], v75 offset:7168
  s_waitcnt lgkmcnt(6)
  v_smfmac_f32_16x16x64_bf16 v[20:23], v[4:7], v[176:183], v74
  s_waitcnt lgkmcnt(5)
  v_smfmac_f32_16x16x64_bf16 v[20:23], v[12:15], v[192:199], v74
  s_waitcnt lgkmcnt(2)
  v_smfmac_f32_16x16x64_bf16 v[20:23], v[16:19], v[36:43], v74
  ds_read_b128 v[36:39], v75 offset:20480
  v_smfmac_f32_16x16x64_bf16 v[24:27], v[4:7], v[184:191], v74
  ds_read_b128 v[40:43], v75 offset:21504
  s_waitcnt lgkmcnt(2)
  v_smfmac_f32_16x16x64_bf16 v[24:27], v[16:19], v[60:67], v74
  ds_read_b128 v[60:63], v75 offset:22528
  v_add_f32 v20, v20, v22
  v_smfmac_f32_16x16x64_bf16 v[24:27], v[12:15], v[200:207], v74
  ds_read_b128 v[64:67], v75 offset:23552
  v_add_f32 v21, v21, v23
  v_smfmac_f32_16x16x64_bf16 v[28:31], v[16:19], v[240:247], v74
  v_mov_b64 v[70:71], s[78:79]
  v_smfmac_f32_16x16x64_bf16 v[28:31], v[4:7], a[0:7], v74
  s_waitcnt lgkmcnt(2)
  v_add_f32 v24, v24, v26
  v_smfmac_f32_16x16x64_bf16 v[28:31], v[0:3], v[36:43], v74
  ds_read_b128 v[36:39], v68
  v_cvt_pk_bf16_f32 v22, v20, v24
  v_smfmac_f32_16x16x64_bf16 v[28:31], v[12:15], a[16:23], v74
  ds_read_b128 v[40:43], v68
  ds_write_b32 v79, v22 offset:0
  s_waitcnt lgkmcnt(3)
  v_add_f32 v25, v25, v27
  v_cvt_pk_bf16_f32 v23, v21, v25
  v_smfmac_f32_16x16x64_bf16 v[32:35], v[0:3], v[60:67], v74
  ds_write_b32 v79, v23 offset:576
  v_cmp_u_f32 vcc, v20, v21
  v_smfmac_f32_16x16x64_bf16 v[32:35], v[16:19], v[248:255], v74
  v_add_f32 v28, v28, v30
  v_smfmac_f32_16x16x64_bf16 v[32:35], v[4:7], a[8:15], v74
  v_add_f32 v29, v29, v31
  v_smfmac_f32_16x16x64_bf16 v[32:35], v[12:15], a[24:31], v74
  s_cbranch_vccnz Cf1_rec
Cf1_recok:
  s_waitcnt lgkmcnt(3)
  v_smfmac_f32_16x16x64_bf16 v[36:39], v[16:19], a[128:135], v74
  s_waitcnt lgkmcnt(0)
  s_barrier
  ds_read_b128 v[60:63], v77
  v_smfmac_f32_16x16x64_bf16 v[40:43], v[16:19], a[136:143], v74
  ds_read_b128 v[64:67], v77 offset:128
  v_add_f32 v32, v32, v34
  v_cvt_pk_bf16_f32 v30, v28, v32
  v_smfmac_f32_16x16x64_bf16 v[36:39], v[0:3], a[112:119], v74
  ds_write_b32 v79, v30 offset:256
  v_add_f32 v33, v33, v35
  v_cvt_pk_bf16_f32 v31, v29, v33
  v_smfmac_f32_16x16x64_bf16 v[40:43], v[0:3], a[120:127], v74
  ds_write_b32 v79, v31 offset:832
  v_xor_b32 v75, 0x8000, v75
  v_smfmac_f32_16x16x64_bf16 v[36:39], v[4:7], a[144:151], v74
  ds_read_b128 v[0:3], v76 offset:4608
  v_mov_b32 v29, 0
  v_smfmac_f32_16x16x64_bf16 v[40:43], v[4:7], a[152:159], v74
  s_waitcnt vmcnt(2) lgkmcnt(3)
  v_mov_b32 v30, 0
  v_mfma_f32_16x16x32_bf16 v[44:47], v[44:47], v[60:63], 0
  ds_read_b128 v[4:7], v76 offset:5632
  s_waitcnt lgkmcnt(2)
  v_mfma_f32_16x16x32_bf16 v[44:47], v[48:51], v[64:67], v[44:47]
  s_barrier
  v_smfmac_f32_16x16x64_bf16 v[36:39], v[8:11], a[96:103], v74
  ds_read_b128 v[20:23], v77 offset:256
  ds_read_b128 v[24:27], v77 offset:384
  v_smfmac_f32_16x16x64_bf16 v[40:43], v[8:11], a[104:111], v74
  ds_read_b128 v[8:11], v76 offset:6656
  v_add_f32_dpp v72, v46, v44 quad_perm:[2,3,0,1] row_mask:0xf bank_mask:0xf
  v_add_f32_dpp v73, v47, v45 quad_perm:[2,3,0,1] row_mask:0xf bank_mask:0xf
  v_smfmac_f32_16x16x64_bf16 v[36:39], v[12:15], a[160:167], v74
  s_waitcnt lgkmcnt(4)
  v_exp_f32_dpp v72, v72 quad_perm:[0,1,0,1] row_mask:0xf bank_mask:0xf
  v_smfmac_f32_16x16x64_bf16 v[40:43], v[12:15], a[168:175], v74
  ds_read_b128 v[12:15], v76 offset:7680
  v_exp_f32_dpp v73, v73 quad_perm:[0,1,0,1] row_mask:0xf bank_mask:0xf
  v_smfmac_f32_16x16x64_bf16 v[36:39], v[0:3], a[32:39], v74
  s_waitcnt lgkmcnt(2)
  v_cvt_pk_bf16_f32 v72, v72, v73
  v_mfma_f32_16x16x32_bf16 v[20:23], v[20:23], v[60:63], 0
  ds_write_b32 v78, v72 offset:516
  v_mov_b64 v[16:17], 0
  v_mfma_f32_16x16x32_bf16 v[20:23], v[24:27], v[64:67], v[20:23]
  ds_read_b128 v[44:47], v75 offset:22528
  v_mov_b64 v[18:19], 0
  v_smfmac_f32_16x16x64_bf16 v[40:43], v[0:3], a[40:47], v74
  ds_read_b128 v[48:51], v75 offset:23552
  v_mov_b64 v[68:69], s[78:79]
  v_smfmac_f32_16x16x64_bf16 v[36:39], v[4:7], a[48:55], v74
  s_waitcnt lgkmcnt(4)
  v_add_f32_dpp v24, v22, v20 quad_perm:[2,3,0,1] row_mask:0xf bank_mask:0xf
  v_add_f32_dpp v25, v23, v21 quad_perm:[2,3,0,1] row_mask:0xf bank_mask:0xf
  v_smfmac_f32_16x16x64_bf16 v[36:39], v[8:11], a[64:71], v74
  s_waitcnt lgkmcnt(2)
  s_barrier
  ds_read_b128 v[32:35], v78 offset:512
  v_smfmac_f32_16x16x64_bf16 v[36:39], v[12:15], a[80:87], v74
  ds_read_b128 v[60:63], v75 offset:20480
  v_mul_f32 v24, s69, v24
  v_smfmac_f32_16x16x64_bf16 v[40:43], v[4:7], a[56:63], v74
  ds_read_b128 v[64:67], v75 offset:21504
  v_mul_f32 v25, s69, v25
  v_smfmac_f32_16x16x64_bf16 v[40:43], v[8:11], a[72:79], v74
  v_exp_f32_dpp v24, v24 quad_perm:[0,1,0,1] row_mask:0xf bank_mask:0xf
  v_smfmac_f32_16x16x64_bf16 v[40:43], v[12:15], a[88:95], v74
  s_waitcnt lgkmcnt(2)
  v_exp_f32_dpp v25, v25 quad_perm:[0,1,0,1] row_mask:0xf bank_mask:0xf
  v_mfma_f32_16x16x32_bf16 v[8:11], v[32:35], v[68:71], 0
  v_add_f32 v36, v36, v38
  v_add_f32 v37, v37, v39
  v_mfma_f32_16x16x32_bf16 v[0:3], v[32:35], v[52:55], 0
  v_add_f32 v40, v40, v42
  v_add_f32 v41, v41, v43
  v_mfma_f32_16x16x32_bf16 v[4:7], v[32:35], v[56:59], 0
  v_cvt_pk_bf16_f32 v28, v24, v25
  v_cvt_pk_bf16_f32 v72, v36, v37
  v_cvt_pk_bf16_f32 v73, v40, v41
  v_mfma_f32_16x16x16_bf16 v[8:11], v[28:29], v[68:69], v[8:11]
  v_cvt_pk_bf16_f32 v31, v24, v25
  v_mov_b64 v[20:21], 0
  v_mfma_f32_16x16x16_bf16 v[0:3], v[28:29], v[72:73], v[0:3]
  ds_read_b128 v[52:55], v75 offset:36864
  v_mov_b64 v[22:23], 0
  v_mfma_f32_16x16x16_bf16 v[4:7], v[30:31], v[72:73], v[4:7]
  v_rcp_f32 v10, v8
  v_rcp_f32 v11, v9
  v_mul_f32 v0, v10, v0
  v_mul_f32 v1, v11, v1
  v_max3_f32 v8, v8, v9, v10
  v_mul_f32 v4, v10, v4
  v_mul_f32 v5, v11, v5
  v_cvt_pk_bf16_f32 v2, v0, v4
  ds_write_b32 v79, v2 offset:8704
  v_cvt_pk_bf16_f32 v3, v1, v5
  ds_write_b32 v79, v3 offset:9280
  ds_read_b128 v[12:15], v78 offset:8768
  v_max_f32 v8, v8, v11
  v_cmp_le_f32 vcc, 1317011456, v8
  v_mov_b64 v[24:25], 0
  v_mov_b64 v[26:27], 0
  ds_read_b128 v[56:59], v75 offset:37888
  s_cbranch_vccnz Cf1_mx
Cf1_mxok:
  s_waitcnt lgkmcnt(2)
  s_barrier
  ds_read_b128 v[0:3], v78 offset:8704
  s_waitcnt lgkmcnt(2)
  v_smfmac_f32_16x16x64_bf16 v[16:19], v[12:15], v[44:51], v74
  ds_read_b128 v[4:7], v78 offset:8832
  v_smfmac_f32_16x16x64_bf16 v[20:23], v[12:15], a[200:207], v74
  ds_read_b128 v[8:11], v78 offset:8896
  v_smfmac_f32_16x16x64_bf16 v[24:27], v[12:15], a[216:223], v74
  ds_read_b128 v[36:39], v75 offset:38912
  s_waitcnt lgkmcnt(3)
  v_smfmac_f32_16x16x64_bf16 v[16:19], v[0:3], v[60:67], v74
  ds_read_b128 v[40:43], v75 offset:39936
  s_waitcnt lgkmcnt(3)
  v_smfmac_f32_16x16x64_bf16 v[16:19], v[4:7], a[176:183], v74
  ds_read_b128 v[68:71], v76 offset:13824
  s_waitcnt lgkmcnt(3)
  v_smfmac_f32_16x16x64_bf16 v[16:19], v[8:11], a[184:191], v74
  ds_read_b128 v[44:47], v75 offset:53248
  v_smfmac_f32_16x16x64_bf16 v[20:23], v[0:3], a[192:199], v74
  ds_read_b128 v[48:51], v75 offset:54272
  v_smfmac_f32_16x16x64_bf16 v[20:23], v[4:7], v[52:59], v74
  ds_read_b128 v[60:63], v75 offset:55296
  s_waitcnt lgkmcnt(4)
  v_cvt_pk_bf16_f32 v16, v16, v17
  v_cvt_pk_bf16_f32 v17, v18, v19
  v_bfi_b32 v16, 1, s72, v16
  v_smfmac_f32_16x16x64_bf16 v[20:23], v[8:11], v[36:43], v74
  s_waitcnt lgkmcnt(3)
  buffer_store_dwordx2 v[16:17], v68, s[8:11], s73 offen
  v_mov_b64 v[32:33], 0
  v_smfmac_f32_16x16x64_bf16 v[24:27], v[0:3], a[208:215], v74
  ds_read_b128 v[64:67], v75 offset:56320
  v_mov_b64 v[34:35], 0
  v_smfmac_f32_16x16x64_bf16 v[24:27], v[4:7], a[224:231], v74
  v_cvt_pk_bf16_f32 v20, v20, v21
  v_cvt_pk_bf16_f32 v21, v22, v23
  v_bfi_b32 v20, 1, s72, v20
  v_smfmac_f32_16x16x64_bf16 v[24:27], v[8:11], a[232:239], v74
  buffer_store_dwordx2 v[20:21], v68, s[8:11], s74 offen
  s_waitcnt lgkmcnt(2)
  v_smfmac_f32_16x16x64_bf16 v[32:35], v[0:3], v[44:51], v74
  s_waitcnt lgkmcnt(0)
  v_smfmac_f32_16x16x64_bf16 v[32:35], v[12:15], v[60:67], v74
  v_cvt_pk_bf16_f32 v24, v24, v25
  v_cvt_pk_bf16_f32 v25, v26, v27
  v_bfi_b32 v24, 1, s72, v24
  v_smfmac_f32_16x16x64_bf16 v[32:35], v[4:7], a[240:247], v74
  buffer_store_dwordx2 v[24:25], v68, s[8:11], s75 offen
  v_smfmac_f32_16x16x64_bf16 v[32:35], v[8:11], a[248:255], v74
  v_mov_b64 v[18:19], v[72:73]
  s_nop 4
  v_cvt_pk_bf16_f32 v32, v32, v33
  v_cvt_pk_bf16_f32 v33, v34, v35
  v_bfi_b32 v32, 1, s72, v32
  buffer_store_dwordx2 v[32:33], v68, s[8:11], s76 offen
  ds_read_b128 v[0:3], v76 offset:14848
  s_waitcnt lgkmcnt(0)
  ds_read_b64 v[16:17], v77 offset:264
  s_waitcnt lgkmcnt(0)
  ds_read_b128 v[64:67], v76 offset:23552
  s_waitcnt lgkmcnt(0)
  s_add_u32 s66, s66, 1
  s_xor_b32 s64, s64, 16384
  s_xor_b32 s65, s65, 16384
  s_add_u32 s58, s58, 655360
  s_add_u32 s59, s59, 655360
  s_add_u32 s70, s70, 655360
  s_add_u32 s68, s68, 655360
  s_mov_b32 m0, 11776
  s_add_u32 s85, s65, 7168
  v_xor_b32 v75, 0x8000, v75
  v_mov_b64 v[28:29], 0
  v_mov_b64 v[30:31], 0
  v_mov_b64 v[32:33], 0
  v_mov_b64 v[34:35], 0
  buffer_load_dwordx4 v[52:55], v76, s[8:11], s60 offen offset:0 sc1
  buffer_load_dwordx4 v[56:59], v76, s[8:11], s60 offen offset:1024 sc1
  s_waitcnt lgkmcnt(0)
  s_waitcnt vmcnt(1)
  v_mfma_f32_16x16x32_bf16 v[4:7], v[0:3], v[52:55], 0
  v_bitop3_b32 v72, v52, v54, s72 bitop3:0x7e
  s_waitcnt vmcnt(0)
  v_mfma_f32_16x16x32_bf16 v[4:7], v[0:3], v[56:59], v[4:7]
  v_bitop3_b32 v73, v56, v58, s72 bitop3:0x7e
  v_bitop3_b32 v72, v72, v73, 1 bitop3:0xa8
  v_cmp_ne_u32 vcc, 0, v72
  s_nop 3
  v_add_f32_dpp v4, v4, v4 row_ror:4 row_mask:0xf bank_mask:0xf
  v_add_f32_dpp v5, v5, v5 row_ror:4 row_mask:0xf bank_mask:0xf
  s_cmp_eq_u64 vcc, 0
  v_add_f32_dpp v4, v4, v4 row_ror:8 row_mask:0xf bank_mask:0xf
  v_add_f32_dpp v5, v5, v5 row_ror:8 row_mask:0xf bank_mask:0xf
  s_cselect_b32 s54, s62, 268435456
  v_cvt_pk_bf16_f32 v4, v4, v5
  buffer_store_dword v4, v69, s[8:11], s54 offen
  s_cbranch_vccnz Cf1_h1r
  s_xor_b32 s62, s62, 16384
  buffer_store_dword v71, v69, s[8:11], s62 offen
  s_xor_b32 s72, s72, 1
  s_branch Cf1_h2
Cf1_h1r:
  s_mov_b64 exec, vcc
  buffer_load_dwordx4 v[52:55], v76, s[8:11], s60 offen offset:0 sc1
  buffer_load_dwordx4 v[56:59], v76, s[8:11], s60 offen offset:1024 sc1
  s_mov_b64 exec, -1
  s_add_u32 s67, s67, 1
  s_waitcnt vmcnt(1)
  v_mfma_f32_16x16x32_bf16 v[4:7], v[0:3], v[52:55], 0
  v_bitop3_b32 v72, v52, v54, s72 bitop3:0x7e
  s_waitcnt vmcnt(0)
  v_mfma_f32_16x16x32_bf16 v[4:7], v[0:3], v[56:59], v[4:7]
  v_bitop3_b32 v73, v56, v58, s72 bitop3:0x7e
  v_bitop3_b32 v72, v72, v73, 1 bitop3:0xa8
  v_cmp_ne_u32 vcc, 0, v72
  s_cbranch_vccz Cf1_h1p
Cf1_h1s:
  s_mov_b64 exec, vcc
  buffer_load_dwordx4 v[52:55], v76, s[8:11], s60 offen offset:0 sc1
  buffer_load_dwordx4 v[56:59], v76, s[8:11], s60 offen offset:1024 sc1
  s_mov_b64 exec, -1
  s_add_u32 s67, s67, 1
  s_waitcnt vmcnt(1)
  v_mfma_f32_16x16x32_bf16 v[4:7], v[0:3], v[52:55], 0
  v_bitop3_b32 v72, v52, v54, s72 bitop3:0x7e
  s_waitcnt vmcnt(0)
  v_mfma_f32_16x16x32_bf16 v[4:7], v[0:3], v[56:59], v[4:7]
  v_bitop3_b32 v73, v56, v58, s72 bitop3:0x7e
  v_bitop3_b32 v72, v72, v73, 1 bitop3:0xa8
  v_cmp_ne_u32 vcc, 0, v72
  s_cbranch_vccz Cf1_h1p
  s_cmp_lt_u32 s67, 131072
  s_cbranch_scc1 Cf1_h1s
Cf1_h1p:
  s_nop 2
  v_add_f32_dpp v4, v4, v4 row_ror:4 row_mask:0xf bank_mask:0xf
  v_add_f32_dpp v5, v5, v5 row_ror:4 row_mask:0xf bank_mask:0xf
  s_nop 0
  v_add_f32_dpp v4, v4, v4 row_ror:8 row_mask:0xf bank_mask:0xf
  v_add_f32_dpp v5, v5, v5 row_ror:8 row_mask:0xf bank_mask:0xf
  v_cvt_pk_bf16_f32 v4, v4, v5
  buffer_store_dword v4, v69, s[8:11], s62 offen
  s_xor_b32 s62, s62, 16384
  buffer_store_dword v71, v69, s[8:11], s62 offen
  s_xor_b32 s72, s72, 1
  s_branch Cf1_h2
Cf1_h2r:
  s_mov_b64 exec, vcc
  buffer_load_dwordx4 v[8:11], v76, s[8:11], s65 offen offset:2048 sc1
  s_mov_b64 exec, -1
  s_add_u32 s67, s67, 1
  s_waitcnt vmcnt(4)
  v_max3_u32 v72, v8, v9, v10
  v_max_u32 v72, v72, v11
  ds_write_b128 v76, v[8:11] offset:6656
  v_cmp_eq_u32 vcc, -1, v72
  s_cbranch_vccz Cf1_h2w
  s_mov_b64 exec, vcc
  buffer_load_dwordx4 v[8:11], v76, s[8:11], s65 offen offset:2048 sc1
  s_mov_b64 exec, -1
  s_add_u32 s67, s67, 1
  s_waitcnt vmcnt(4)
  v_max3_u32 v72, v8, v9, v10
  v_max_u32 v72, v72, v11
  ds_write_b128 v76, v[8:11] offset:6656
  v_cmp_eq_u32 vcc, -1, v72
  s_cbranch_vccz Cf1_h2w
Cf1_h2s:
  s_mov_b64 exec, vcc
  buffer_load_dwordx4 v[8:11], v76, s[8:11], s65 offen offset:2048 sc1
  s_mov_b64 exec, -1
  s_add_u32 s67, s67, 1
  s_waitcnt vmcnt(2)
  v_max3_u32 v72, v8, v9, v10
  v_max_u32 v72, v72, v11
  ds_write_b128 v76, v[8:11] offset:6656
  v_cmp_eq_u32 vcc, -1, v72
  s_cbranch_vccz Cf1_h2w
  s_mov_b64 exec, vcc
  buffer_load_dwordx4 v[8:11], v76, s[8:11], s65 offen offset:2048 sc1
  s_mov_b64 exec, -1
  s_add_u32 s67, s67, 1
  s_waitcnt vmcnt(2)
  v_max3_u32 v72, v8, v9, v10
  v_max_u32 v72, v72, v11
  ds_write_b128 v76, v[8:11] offset:6656
  v_cmp_eq_u32 vcc, -1, v72
  s_cbranch_vccz Cf1_h2w
  s_mov_b64 exec, vcc
  buffer_load_dwordx4 v[8:11], v76, s[8:11], s65 offen offset:2048 sc1
  s_mov_b64 exec, -1
  s_add_u32 s67, s67, 1
  s_waitcnt vmcnt(2)
  v_max3_u32 v72, v8, v9, v10
  v_max_u32 v72, v72, v11
  ds_write_b128 v76, v[8:11] offset:6656
  v_cmp_eq_u32 vcc, -1, v72
  s_cbranch_vccz Cf1_h2w
  s_cmp_lt_u32 s67, 131072
  s_cbranch_scc1 Cf1_h2s
  s_branch Cf1_h2w
Cf1_rec:
  s_nop 7
  s_waitcnt vmcnt(0) lgkmcnt(0)
  v_max3_u32 v72, v0, v1, v2
  v_max3_u32 v72, v72, v3, v4
  v_max3_u32 v72, v72, v5, v6
  v_max3_u32 v72, v72, v7, v8
  v_max3_u32 v72, v72, v9, v10
  v_max3_u32 v72, v72, v11, v12
  v_max3_u32 v72, v72, v13, v14
  v_max3_u32 v72, v72, v15, v16
  v_max3_u32 v72, v72, v17, v18
  v_max_u32 v72, v72, v19
  v_cmp_eq_u32 vcc, -1, v72
  s_cbranch_vccz Cf1_recok
  s_barrier
  v_mov_b64 v[20:21], 0
  v_mov_b64 v[22:23], 0
  v_mov_b64 v[24:25], 0
  v_mov_b64 v[26:27], 0
  v_mov_b64 v[28:29], 0
  v_mov_b64 v[30:31], 0
  v_mov_b64 v[32:33], 0
  v_mov_b64 v[34:35], 0
  s_waitcnt lgkmcnt(0)
  s_barrier
  ds_read_b128 v[0:3], v76 offset:4608
  s_waitcnt lgkmcnt(0)
  v_smfmac_f32_16x16x64_bf16 v[20:23], v[0:3], v[80:87], v74
  v_smfmac_f32_16x16x64_bf16 v[24:27], v[0:3], v[88:95], v74
  ds_read_b128 v[60:63], v76 offset:20480
  ds_read_b128 v[64:67], v76 offset:21504
  s_waitcnt lgkmcnt(0)
  v_smfmac_f32_16x16x64_bf16 v[28:31], v[0:3], v[60:67], v74
  ds_read_b128 v[60:63], v76 offset:22528
  ds_read_b128 v[64:67], v76 offset:23552
  s_waitcnt lgkmcnt(0)
  v_smfmac_f32_16x16x64_bf16 v[32:35], v[0:3], v[60:67], v74
  ds_read_b128 v[4:7], v76 offset:5632
  s_waitcnt lgkmcnt(0)
  v_smfmac_f32_16x16x64_bf16 v[20:23], v[4:7], v[96:103], v74
  v_smfmac_f32_16x16x64_bf16 v[24:27], v[4:7], v[104:111], v74
  ds_read_b128 v[60:63], v76 offset:36864
  ds_read_b128 v[64:67], v76 offset:37888
  s_waitcnt lgkmcnt(0)
  v_smfmac_f32_16x16x64_bf16 v[28:31], v[4:7], v[60:67], v74
  ds_read_b128 v[60:63], v76 offset:38912
  ds_read_b128 v[64:67], v76 offset:39936
  s_waitcnt lgkmcnt(0)
  v_smfmac_f32_16x16x64_bf16 v[32:35], v[4:7], v[60:67], v74
  ds_read_b128 v[8:11], v76 offset:6656
  s_waitcnt lgkmcnt(0)
  v_smfmac_f32_16x16x64_bf16 v[20:23], v[8:11], v[112:119], v74
  v_smfmac_f32_16x16x64_bf16 v[24:27], v[8:11], v[120:127], v74
  v_smfmac_f32_16x16x64_bf16 v[28:31], v[8:11], v[208:215], v74
  v_smfmac_f32_16x16x64_bf16 v[32:35], v[8:11], v[216:223], v74
  ds_read_b128 v[12:15], v76 offset:7680
  s_waitcnt lgkmcnt(0)
  v_smfmac_f32_16x16x64_bf16 v[20:23], v[12:15], v[128:135], v74
  v_smfmac_f32_16x16x64_bf16 v[24:27], v[12:15], v[136:143], v74
  v_smfmac_f32_16x16x64_bf16 v[28:31], v[12:15], v[224:231], v74
  v_smfmac_f32_16x16x64_bf16 v[32:35], v[12:15], v[232:239], v74
  ds_read_b128 v[8:11], v76 offset:8704
  s_waitcnt lgkmcnt(0)
  v_smfmac_f32_16x16x64_bf16 v[20:23], v[8:11], v[144:151], v74
  v_smfmac_f32_16x16x64_bf16 v[24:27], v[8:11], v[152:159], v74
  ds_read_b128 v[60:63], v76 offset:53248
  ds_read_b128 v[64:67], v76 offset:54272
  s_waitcnt lgkmcnt(0)
  v_smfmac_f32_16x16x64_bf16 v[28:31], v[8:11], v[60:67], v74
  ds_read_b128 v[60:63], v76 offset:55296
  ds_read_b128 v[64:67], v76 offset:56320
  s_waitcnt lgkmcnt(0)
  v_smfmac_f32_16x16x64_bf16 v[32:35], v[8:11], v[60:67], v74
  ds_read_b128 v[0:3], v76 offset:9728
  s_waitcnt lgkmcnt(0)
  v_smfmac_f32_16x16x64_bf16 v[20:23], v[0:3], v[160:167], v74
  v_smfmac_f32_16x16x64_bf16 v[24:27], v[0:3], v[168:175], v74
  ds_read_b128 v[60:63], v75 offset:20480
  ds_read_b128 v[64:67], v75 offset:21504
  s_waitcnt lgkmcnt(0)
  v_smfmac_f32_16x16x64_bf16 v[28:31], v[0:3], v[60:67], v74
  ds_read_b128 v[60:63], v75 offset:22528
  ds_read_b128 v[64:67], v75 offset:23552
  s_waitcnt lgkmcnt(0)
  v_smfmac_f32_16x16x64_bf16 v[32:35], v[0:3], v[60:67], v74
  ds_read_b128 v[16:19], v76 offset:10752
  ds_read_b128 v[60:63], v75 offset:4096
  ds_read_b128 v[64:67], v75 offset:5120
  s_waitcnt lgkmcnt(0)
  v_smfmac_f32_16x16x64_bf16 v[20:23], v[16:19], v[60:67], v74
  ds_read_b128 v[60:63], v75 offset:6144
  ds_read_b128 v[64:67], v75 offset:7168
  s_waitcnt lgkmcnt(0)
  v_smfmac_f32_16x16x64_bf16 v[24:27], v[16:19], v[60:67], v74
  v_smfmac_f32_16x16x64_bf16 v[28:31], v[16:19], v[240:247], v74
  v_smfmac_f32_16x16x64_bf16 v[32:35], v[16:19], v[248:255], v74
  ds_read_b128 v[4:7], v76 offset:11776
  s_waitcnt lgkmcnt(0)
  v_smfmac_f32_16x16x64_bf16 v[20:23], v[4:7], v[176:183], v74
  v_smfmac_f32_16x16x64_bf16 v[24:27], v[4:7], v[184:191], v74
  v_smfmac_f32_16x16x64_bf16 v[28:31], v[4:7], a[0:7], v74
  v_smfmac_f32_16x16x64_bf16 v[32:35], v[4:7], a[8:15], v74
  ds_read_b128 v[12:15], v76 offset:12800
  s_waitcnt lgkmcnt(0)
  v_smfmac_f32_16x16x64_bf16 v[20:23], v[12:15], v[192:199], v74
  v_smfmac_f32_16x16x64_bf16 v[24:27], v[12:15], v[200:207], v74
  v_smfmac_f32_16x16x64_bf16 v[28:31], v[12:15], a[16:23], v74
  v_smfmac_f32_16x16x64_bf16 v[32:35], v[12:15], a[24:31], v74
  v_add_f32 v20, v20, v22
  v_add_f32 v21, v21, v23
  v_add_f32 v24, v24, v26
  v_cvt_pk_bf16_f32 v22, v20, v24
  ds_write_b32 v79, v22 offset:0
  v_add_f32 v25, v25, v27
  v_cvt_pk_bf16_f32 v23, v21, v25
  ds_write_b32 v79, v23 offset:576
  v_add_f32 v28, v28, v30
  v_add_f32 v29, v29, v31
  s_waitcnt lgkmcnt(0)
  s_nop 1
  s_branch Cf1_recok
Cf1_mx:
  s_waitcnt lgkmcnt(0)
  s_barrier
  buffer_load_dwordx4 v[52:55], v76, s[8:11], s59 offen offset:0 sc1
  buffer_load_dwordx4 v[0:3], v76, s[8:11], s58 offen offset:0 sc1
  ds_read_b128 v[20:23], v77 offset:0
  ds_read_b128 v[28:31], v77 offset:256
  buffer_load_dwordx4 v[56:59], v76, s[8:11], s59 offen offset:1024 sc1
  buffer_load_dwordx4 v[4:7], v76, s[8:11], s58 offen offset:1024 sc1
  ds_read_b128 v[24:27], v77 offset:128
  ds_read_b128 v[32:35], v77 offset:384
  s_waitcnt vmcnt(2) lgkmcnt(3)
  v_mfma_f32_16x16x32_bf16 v[8:11], v[0:3], v[20:23], 0
  s_waitcnt vmcnt(0) lgkmcnt(1)
  v_mfma_f32_16x16x32_bf16 v[8:11], v[4:7], v[24:27], v[8:11]
  v_mfma_f32_16x16x32_bf16 v[12:15], v[28:31], v[20:23], 0
  s_waitcnt lgkmcnt(0)
  v_mfma_f32_16x16x32_bf16 v[12:15], v[32:35], v[24:27], v[12:15]
  v_add_f32_dpp v8, v10, v8 quad_perm:[2,3,0,1] row_mask:0xf bank_mask:0xf
  v_add_f32_dpp v9, v11, v9 quad_perm:[2,3,0,1] row_mask:0xf bank_mask:0xf
  s_nop 0
  v_mov_b32_dpp v8, v8 quad_perm:[0,1,0,1] row_mask:0xf bank_mask:0xf
  v_mov_b32_dpp v9, v9 quad_perm:[0,1,0,1] row_mask:0xf bank_mask:0xf
  s_nop 1
  v_add_f32_dpp v12, v14, v12 quad_perm:[2,3,0,1] row_mask:0xf bank_mask:0xf
  v_add_f32_dpp v13, v15, v13 quad_perm:[2,3,0,1] row_mask:0xf bank_mask:0xf
  s_nop 0
  v_mov_b32_dpp v12, v12 quad_perm:[0,1,0,1] row_mask:0xf bank_mask:0xf
  v_mov_b32_dpp v13, v13 quad_perm:[0,1,0,1] row_mask:0xf bank_mask:0xf
  v_mul_f32 v12, s69, v12
  ds_write_b32 v78, v8 offset:8708
  v_mul_f32 v13, s69, v13
  ds_write_b32 v78, v9 offset:8772
  s_waitcnt lgkmcnt(0)
  s_barrier
  ds_read_b128 v[36:39], v78 offset:8704
  ds_read_b128 v[40:43], v78 offset:8768
  s_waitcnt lgkmcnt(0)
  s_barrier
  v_max_f32 v16, v36, v37
  v_max3_f32 v16, v16, v38, v39
  v_max3_f32 v16, v16, v40, v41
  v_max3_f32 v16, v16, v42, v43
  v_max3_f32 v16, v16, v12, v13
  v_mov_b32 v17, v16
  s_nop 1
  v_permlane16_swap_b32 v16, v17
  v_max_f32 v16, v16, v17
  v_mov_b32 v17, v16
  s_nop 1
  v_permlane32_swap_b32 v16, v17
  v_max_f32 v16, v16, v17
  v_sub_f32 v36, v36, v16
  v_sub_f32 v37, v37, v16
  v_sub_f32 v38, v38, v16
  v_sub_f32 v39, v39, v16
  v_sub_f32 v40, v40, v16
  v_sub_f32 v41, v41, v16
  v_sub_f32 v42, v42, v16
  v_sub_f32 v43, v43, v16
  v_sub_f32 v12, v12, v16
  v_sub_f32 v13, v13, v16
  v_exp_f32 v36, v36
  v_exp_f32 v37, v37
  v_exp_f32 v38, v38
  v_exp_f32 v39, v39
  v_exp_f32 v40, v40
  v_exp_f32 v41, v41
  v_exp_f32 v42, v42
  v_exp_f32 v43, v43
  v_exp_f32 v12, v12
  v_exp_f32 v13, v13
  v_cvt_pk_bf16_f32 v32, v36, v40
  v_cvt_pk_bf16_f32 v33, v37, v41
  v_cvt_pk_bf16_f32 v34, v38, v42
  v_cvt_pk_bf16_f32 v35, v39, v43
  v_cvt_pk_bf16_f32 v28, v12, v13
  v_cvt_pk_bf16_f32 v31, v12, v13
  v_mov_b32 v29, 0
  v_mov_b32 v30, 0
  v_mfma_f32_16x16x32_bf16 v[8:11], v[32:35], v[68:71], 0
  v_mfma_f32_16x16x32_bf16 v[0:3], v[32:35], v[52:55], 0
  v_mfma_f32_16x16x32_bf16 v[4:7], v[32:35], v[56:59], 0
  v_mfma_f32_16x16x16_bf16 v[8:11], v[28:29], v[68:69], v[8:11]
  v_mfma_f32_16x16x16_bf16 v[0:3], v[28:29], v[72:73], v[0:3]
  v_mfma_f32_16x16x16_bf16 v[4:7], v[30:31], v[72:73], v[4:7]
  ds_read_b128 v[52:55], v75 offset:36864
  v_rcp_f32 v10, v8
  v_rcp_f32 v11, v9
  v_mul_f32 v0, v10, v0
  v_mul_f32 v1, v11, v1
  v_max3_f32 v8, v8, v9, v10
  v_mul_f32 v4, v10, v4
  v_mul_f32 v5, v11, v5
  v_cvt_pk_bf16_f32 v2, v0, v4
  ds_write_b32 v79, v2 offset:8704
  v_cvt_pk_bf16_f32 v3, v1, v5
  ds_write_b32 v79, v3 offset:9280
  ds_read_b128 v[12:15], v78 offset:8768
  ds_read_b128 v[56:59], v75 offset:37888
  v_mov_b64 v[16:17], 0
  v_mov_b64 v[18:19], 0
  v_mov_b64 v[20:21], 0
  v_mov_b64 v[22:23], 0
  v_mov_b64 v[24:25], 0
  v_mov_b64 v[26:27], 0
  s_branch Cf1_mxok
Cf1_last:
  ds_read_b128 v[4:7], v76 offset:5632
  ds_read_b128 v[12:15], v76 offset:7680
  ds_read_b128 v[44:47], v76 offset:36864
  ds_read_b128 v[48:51], v76 offset:37888
  s_nop 5
  v_mov_b64 v[20:21], 0
  v_mov_b64 v[22:23], 0
  v_mov_b64 v[24:25], 0
  v_mov_b64 v[26:27], 0
  s_waitcnt lgkmcnt(4)
  v_smfmac_f32_16x16x64_bf16 v[28:31], v[0:3], v[36:43], v74
  ds_read_b128 v[36:39], v76 offset:38912
  ds_read_b128 v[40:43], v76 offset:39936
  v_smfmac_f32_16x16x64_bf16 v[32:35], v[0:3], v[60:67], v74
  s_waitcnt lgkmcnt(5)
  v_smfmac_f32_16x16x64_bf16 v[20:23], v[0:3], a[32:39], v74
  ds_read_b128 v[60:63], v76 offset:53248
  ds_read_b128 v[64:67], v76 offset:54272
  v_smfmac_f32_16x16x64_bf16 v[24:27], v[0:3], a[40:47], v74
  s_waitcnt lgkmcnt(4)
  v_smfmac_f32_16x16x64_bf16 v[20:23], v[4:7], a[48:55], v74
  buffer_store_dwordx4 v[16:19], v76, s[8:11], s68 offen sc1
  v_smfmac_f32_16x16x64_bf16 v[24:27], v[4:7], a[56:63], v74
  v_smfmac_f32_16x16x64_bf16 v[28:31], v[4:7], v[44:51], v74
  s_waitcnt lgkmcnt(2)
  v_smfmac_f32_16x16x64_bf16 v[20:23], v[8:11], a[64:71], v74
  ds_read_b128 v[44:47], v76 offset:55296
  ds_read_b128 v[48:51], v76 offset:56320
  v_smfmac_f32_16x16x64_bf16 v[24:27], v[8:11], a[72:79], v74
  v_smfmac_f32_16x16x64_bf16 v[32:35], v[4:7], v[36:43], v74
  v_smfmac_f32_16x16x64_bf16 v[28:31], v[8:11], v[208:215], v74
  ds_read_b128 v[36:39], v75 offset:20480
  ds_read_b128 v[40:43], v75 offset:21504
  v_smfmac_f32_16x16x64_bf16 v[32:35], v[8:11], v[216:223], v74
  v_smfmac_f32_16x16x64_bf16 v[20:23], v[12:15], a[80:87], v74
  v_smfmac_f32_16x16x64_bf16 v[24:27], v[12:15], a[88:95], v74
  v_smfmac_f32_16x16x64_bf16 v[28:31], v[12:15], v[224:231], v74
  v_smfmac_f32_16x16x64_bf16 v[32:35], v[12:15], v[232:239], v74
  s_waitcnt vmcnt(2)
  s_waitcnt vmcnt(1)
  s_barrier
Cf1_lastr:
  ds_read_b128 v[8:11], v76 offset:8704
  ds_read_b128 v[0:3], v76 offset:9728
  ds_read_b128 v[16:19], v76 offset:10752
  ds_read_b128 v[4:7], v76 offset:11776
  ds_read_b128 v[12:15], v76 offset:12800
  s_waitcnt lgkmcnt(3)
  v_max3_u32 v72, v0, v1, v2
  s_waitcnt lgkmcnt(1)
  v_max3_u32 v72, v72, v3, v4
  v_max3_u32 v72, v72, v5, v6
  v_max3_u32 v72, v72, v7, v8
  v_max3_u32 v72, v72, v9, v10
  s_waitcnt lgkmcnt(0)
  v_max3_u32 v72, v72, v11, v12
  v_max3_u32 v72, v72, v13, v14
  v_max3_u32 v72, v72, v15, v16
  v_max3_u32 v72, v72, v17, v18
  v_max_u32 v72, v72, v19
  v_cmp_eq_u32 vcc, -1, v72
  s_cbranch_vccnz Cf1_lastp
Cf1_lastg:
  v_smfmac_f32_16x16x64_bf16 v[28:31], v[8:11], v[60:67], v74
  ds_read_b128 v[60:63], v75 offset:22528
  ds_read_b128 v[64:67], v75 offset:23552
  v_smfmac_f32_16x16x64_bf16 v[32:35], v[8:11], v[44:51], v74
  v_smfmac_f32_16x16x64_bf16 v[28:31], v[0:3], v[36:43], v74
  v_smfmac_f32_16x16x64_bf16 v[28:31], v[16:19], v[240:247], v74
  v_smfmac_f32_16x16x64_bf16 v[28:31], v[4:7], a[0:7], v74
  v_smfmac_f32_16x16x64_bf16 v[28:31], v[12:15], a[16:23], v74
  v_smfmac_f32_16x16x64_bf16 v[32:35], v[16:19], v[248:255], v74
  v_smfmac_f32_16x16x64_bf16 v[32:35], v[4:7], a[8:15], v74
  s_waitcnt lgkmcnt(0)
  v_smfmac_f32_16x16x64_bf16 v[32:35], v[12:15], a[24:31], v74
  v_smfmac_f32_16x16x64_bf16 v[32:35], v[0:3], v[60:67], v74
  v_smfmac_f32_16x16x64_bf16 v[20:23], v[8:11], a[96:103], v74
  v_smfmac_f32_16x16x64_bf16 v[20:23], v[0:3], a[112:119], v74
  v_add_f32 v28, v28, v30
  v_add_f32 v32, v32, v34
  v_cvt_pk_bf16_f32 v30, v28, v32
  v_smfmac_f32_16x16x64_bf16 v[20:23], v[16:19], a[128:135], v74
  ds_write_b32 v79, v30 offset:256
  v_add_f32 v29, v29, v31
  v_add_f32 v33, v33, v35
  v_cvt_pk_bf16_f32 v31, v29, v33
  v_smfmac_f32_16x16x64_bf16 v[20:23], v[4:7], a[144:151], v74
  ds_write_b32 v79, v31 offset:832
  v_smfmac_f32_16x16x64_bf16 v[20:23], v[12:15], a[160:167], v74
  v_smfmac_f32_16x16x64_bf16 v[24:27], v[8:11], a[104:111], v74
  v_smfmac_f32_16x16x64_bf16 v[24:27], v[0:3], a[120:127], v74
  v_smfmac_f32_16x16x64_bf16 v[24:27], v[16:19], a[136:143], v74
  s_waitcnt lgkmcnt(0)
  s_barrier
  ds_read_b64 v[52:53], v77 offset:264
  v_add_f32 v20, v20, v22
  v_smfmac_f32_16x16x64_bf16 v[24:27], v[4:7], a[152:159], v74
  v_add_f32 v21, v21, v23
  v_smfmac_f32_16x16x64_bf16 v[24:27], v[12:15], a[168:175], v74
  v_cvt_pk_bf16_f32 v54, v20, v21
  s_add_u32 s68, s68, 655360
  s_nop 3
  v_add_f32 v24, v24, v26
  v_add_f32 v25, v25, v27
  v_cvt_pk_bf16_f32 v55, v24, v25
  s_waitcnt lgkmcnt(0)
  buffer_store_dwordx4 v[52:55], v76, s[8:11], s68 offen sc1
  s_branch Cf1_done
Cf1_lastp:
  s_add_u32 s72, s72, 2
  s_cmp_ge_u32 s72, 131072
  s_cbranch_scc1 Cf1_lastg
  s_barrier
  buffer_load_dwordx4 v76, s[8:11], s85 offen offset:0 sc1 lds
  s_waitcnt vmcnt(0)
  s_barrier
  s_branch Cf1_lastr
Cf1_done:
  s_branch L_cexit
L_w2:
  v_mov_b64 v[20:21], 0
  v_mov_b64 v[22:23], 0
  v_mov_b64 v[24:25], 0
  v_mov_b64 v[26:27], 0
  v_mov_b64 v[28:29], 0
  v_mov_b64 v[30:31], 0
  v_mov_b64 v[32:33], 0
  v_mov_b64 v[34:35], 0
  s_mov_b32 s78, 0x3f803f80
  s_mov_b32 s79, s78
  s_mov_b32 s65, 360448
  s_mov_b32 m0, 15872
  s_lshl_b32 s71, s53, 2
  s_add_u32 s71, s71, 128
  s_movk_i32 s56, 0x1000
  v_lshlrev_b32 v73, 2, v76
  v_mov_b32 v72, 0
  s_mov_b64 s[16:17], s[8:9]
  s_mov_b32 s18, 268435456
  s_mov_b32 s19, 0x20000
  s_getpc_b64 s[20:21]
Cf2_pc:
  s_add_u32 s20, s20, (Cf2_last - Cf2_pc)
  s_addc_u32 s21, s21, 0
  v_mov_b32 v68, 14880
  buffer_load_dwordx4 v[52:55], v76, s[8:11], s59 offen offset:0 sc1
  buffer_load_dwordx4 v[56:59], v76, s[8:11], s59 offen offset:1024 sc1
  ds_read_b128 v[36:39], v76 offset:24576
  ds_read_b128 v[40:43], v76 offset:25600
  ds_read_b128 v[60:63], v76 offset:26624
  ds_read_b128 v[64:67], v76 offset:27648
  ds_read_b128 v[0:3], v76 offset:4608
  ds_read_b128 v[4:7], v76 offset:5632
  ds_read_b128 v[8:11], v76 offset:6656
  ds_read_b128 v[12:15], v76 offset:7680
  s_waitcnt lgkmcnt(0)
  s_cmp_eq_u32 s66, 1
  s_branch Cf2_top2
.p2align 6
Cf2_h2:
  buffer_load_dwordx4 v[12:15], v76, s[8:11], s65 offen offset:3072 sc1
  ds_read_b128 v[36:39], v76 offset:24576
  s_waitcnt lgkmcnt(0)
  s_cmp_eq_u32 s66, 62
  s_cselect_b64 s[16:17], s[20:21], s[16:17]
  s_cselect_b32 s18, (Cf2_done - Cf2_last), s18
  s_cselect_b32 s70, 0, s70
  s_cmp_eq_u32 s66, 63
  s_cselect_b32 s59, 268435456, s59
  s_cselect_b32 s58, 268435456, s58
  buffer_load_dwordx4 v[12:15], v76, s[8:11], s65 offen offset:3072 sc1
  ds_read_b128 v[40:43], v76 offset:25600
  s_waitcnt lgkmcnt(0)
  v_mov_b64 v[20:21], 0
  v_mov_b64 v[22:23], 0
  v_mov_b64 v[24:25], 0
  v_mov_b64 v[26:27], 0
  v_mov_b32 v68, 14880
  v_lshlrev_b32 v73, 2, v76
  buffer_load_dwordx4 v[12:15], v76, s[8:11], s65 offen offset:3072 sc1
  buffer_load_dwordx4 v[52:55], v76, s[8:11], s59 offen offset:0 sc1
  buffer_load_dwordx4 v[56:59], v76, s[8:11], s59 offen offset:1024 sc1
  s_waitcnt vmcnt(4)
  v_max3_u32 v72, v12, v13, v14
  v_max_u32 v72, v72, v15
  ds_write_b128 v76, v[12:15] offset:7680
  v_cmp_eq_u32 vcc, -1, v72
  s_cbranch_vccnz Cf2_h2r
Cf2_h2w:
  s_cmp_eq_u32 s66, 63
  s_waitcnt lgkmcnt(0)
  s_barrier
  ds_read_b128 v[0:3], v76 offset:4608
  buffer_load_dwordx4 v76, s[8:11], s85 offen offset:0 sc1 lds
Cf2_top2:
  v_smfmac_f32_16x16x64_bf16 v[20:23], v[12:15], v[128:135], v74
  s_cbranch_scc1 Cf2_last
  v_smfmac_f32_16x16x64_bf16 v[24:27], v[12:15], v[136:143], v74
  buffer_load_dwordx4 v[44:47], v76, s[8:11], s58 offen offset:0 sc1
  s_mov_b32 m0, 15872
  v_smfmac_f32_16x16x64_bf16 v[28:31], v[12:15], v[224:231], v74
  buffer_load_dwordx4 v[48:51], v76, s[8:11], s58 offen offset:1024 sc1
  v_smfmac_f32_16x16x64_bf16 v[32:35], v[12:15], v[232:239], v74
  ds_read_b128 v[4:7], v76 offset:5632
  s_waitcnt lgkmcnt(1)
  v_smfmac_f32_16x16x64_bf16 v[20:23], v[0:3], v[80:87], v74
  ds_read_b128 v[8:11], v76 offset:6656
  v_smfmac_f32_16x16x64_bf16 v[28:31], v[0:3], v[36:43], v74
  ds_read_b128 v[36:39], v76 offset:40960
  v_smfmac_f32_16x16x64_bf16 v[24:27], v[0:3], v[88:95], v74
  buffer_store_dwordx4 v[16:19], v76, s[8:11], s68 offen sc1
  ds_read_b128 v[40:43], v76 offset:41984
  v_smfmac_f32_16x16x64_bf16 v[32:35], v[0:3], v[60:67], v74
  buffer_load_dword v73, s[16:19], s70 offen lds
  ds_read_b128 v[60:63], v76 offset:43008
  s_waitcnt lgkmcnt(4)
  v_smfmac_f32_16x16x64_bf16 v[20:23], v[4:7], v[96:103], v74
  ds_read_b128 v[64:67], v76 offset:44032
  v_smfmac_f32_16x16x64_bf16 v[24:27], v[4:7], v[104:111], v74
  s_waitcnt vmcnt(5)
  s_waitcnt lgkmcnt(4)
  v_smfmac_f32_16x16x64_bf16 v[20:23], v[8:11], v[112:119], v74
  s_barrier
  ds_read_b128 v[12:15], v76 offset:8704
  s_waitcnt lgkmcnt(3)
  v_smfmac_f32_16x16x64_bf16 v[28:31], v[4:7], v[36:43], v74
  ds_read_b128 v[36:39], v76 offset:57344
  v_smfmac_f32_16x16x64_bf16 v[24:27], v[8:11], v[120:127], v74
  ds_read_b128 v[40:43], v76 offset:58368
  s_waitcnt lgkmcnt(3)
  v_smfmac_f32_16x16x64_bf16 v[32:35], v[4:7], v[60:67], v74
  ds_read_b128 v[0:3], v76 offset:9728
  v_smfmac_f32_16x16x64_bf16 v[28:31], v[8:11], v[208:215], v74
  ds_read_b128 v[60:63], v76 offset:59392
  v_smfmac_f32_16x16x64_bf16 v[32:35], v[8:11], v[216:223], v74
  s_waitcnt vmcnt(4)
  ds_read_b128 v[64:67], v76 offset:60416
  s_waitcnt lgkmcnt(5)
  v_smfmac_f32_16x16x64_bf16 v[20:23], v[12:15], v[144:151], v74
  s_barrier
  ds_read_b128 v[4:7], v76 offset:11776
  s_waitcnt lgkmcnt(4)
  v_smfmac_f32_16x16x64_bf16 v[28:31], v[12:15], v[36:43], v74
  ds_read_b128 v[8:11], v76 offset:12800
  ds_read_b128 v[36:39], v75 offset:8192
  v_smfmac_f32_16x16x64_bf16 v[24:27], v[12:15], v[152:159], v74
  ds_read_b128 v[16:19], v76 offset:10752
  s_waitcnt lgkmcnt(6)
  v_smfmac_f32_16x16x64_bf16 v[20:23], v[0:3], v[160:167], v74
  ds_read_b128 v[40:43], v75 offset:9216
  s_waitcnt lgkmcnt(5)
  v_smfmac_f32_16x16x64_bf16 v[32:35], v[12:15], v[60:67], v74
  ds_read_b128 v[60:63], v75 offset:10240
  v_smfmac_f32_16x16x64_bf16 v[24:27], v[0:3], v[168:175], v74
  ds_read_b128 v[64:67], v75 offset:11264
  s_waitcnt lgkmcnt(6)
  v_smfmac_f32_16x16x64_bf16 v[20:23], v[4:7], v[176:183], v74
  s_waitcnt lgkmcnt(5)
  v_smfmac_f32_16x16x64_bf16 v[20:23], v[8:11], v[192:199], v74
  s_waitcnt lgkmcnt(2)
  v_smfmac_f32_16x16x64_bf16 v[20:23], v[16:19], v[36:43], v74
  ds_read_b128 v[36:39], v75 offset:24576
  v_smfmac_f32_16x16x64_bf16 v[24:27], v[4:7], v[184:191], v74
  ds_read_b128 v[40:43], v75 offset:25600
  s_waitcnt lgkmcnt(2)
  v_smfmac_f32_16x16x64_bf16 v[24:27], v[16:19], v[60:67], v74
  ds_read_b128 v[60:63], v75 offset:26624
  v_add_f32 v20, v20, v22
  v_smfmac_f32_16x16x64_bf16 v[24:27], v[8:11], v[200:207], v74
  ds_read_b128 v[64:67], v75 offset:27648
  v_add_f32 v21, v21, v23
  v_smfmac_f32_16x16x64_bf16 v[28:31], v[16:19], v[240:247], v74
  v_mov_b64 v[70:71], s[78:79]
  v_smfmac_f32_16x16x64_bf16 v[28:31], v[4:7], a[0:7], v74
  s_waitcnt lgkmcnt(2)
  v_add_f32 v24, v24, v26
  v_smfmac_f32_16x16x64_bf16 v[28:31], v[0:3], v[36:43], v74
  ds_read_b128 v[36:39], v68
  v_cvt_pk_bf16_f32 v22, v20, v24
  v_smfmac_f32_16x16x64_bf16 v[28:31], v[8:11], a[16:23], v74
  ds_read_b128 v[40:43], v68
  ds_write_b32 v79, v22 offset:0
  s_waitcnt lgkmcnt(3)
  v_add_f32 v25, v25, v27
  v_cvt_pk_bf16_f32 v23, v21, v25
  v_smfmac_f32_16x16x64_bf16 v[32:35], v[0:3], v[60:67], v74
  ds_write_b32 v79, v23 offset:576
  v_cmp_u_f32 vcc, v20, v21
  v_smfmac_f32_16x16x64_bf16 v[32:35], v[16:19], v[248:255], v74
  v_add_f32 v28, v28, v30
  v_smfmac_f32_16x16x64_bf16 v[32:35], v[4:7], a[8:15], v74
  v_add_f32 v29, v29, v31
  v_smfmac_f32_16x16x64_bf16 v[32:35], v[8:11], a[24:31], v74
  s_cbranch_vccnz Cf2_rec
Cf2_recok:
  s_waitcnt lgkmcnt(3)
  v_smfmac_f32_16x16x64_bf16 v[36:39], v[16:19], a[128:135], v74
  s_waitcnt lgkmcnt(0)
  s_barrier
  ds_read_b128 v[60:63], v77
  v_smfmac_f32_16x16x64_bf16 v[40:43], v[16:19], a[136:143], v74
  ds_read_b128 v[64:67], v77 offset:128
  v_add_f32 v32, v32, v34
  v_cvt_pk_bf16_f32 v30, v28, v32
  v_smfmac_f32_16x16x64_bf16 v[36:39], v[0:3], a[112:119], v74
  ds_write_b32 v79, v30 offset:256
  v_add_f32 v33, v33, v35
  v_cvt_pk_bf16_f32 v31, v29, v33
  v_smfmac_f32_16x16x64_bf16 v[40:43], v[0:3], a[120:127], v74
  ds_write_b32 v79, v31 offset:832
  v_xor_b32 v75, 0x8000, v75
  v_smfmac_f32_16x16x64_bf16 v[36:39], v[4:7], a[144:151], v74
  ds_read_b128 v[0:3], v76 offset:4608
  v_mov_b32 v29, 0
  v_smfmac_f32_16x16x64_bf16 v[40:43], v[4:7], a[152:159], v74
  s_waitcnt vmcnt(2) lgkmcnt(3)
  v_mov_b32 v30, 0
  v_mfma_f32_16x16x32_bf16 v[44:47], v[44:47], v[60:63], 0
  ds_read_b128 v[4:7], v76 offset:5632
  s_waitcnt lgkmcnt(2)
  v_mfma_f32_16x16x32_bf16 v[44:47], v[48:51], v[64:67], v[44:47]
  s_barrier
  v_smfmac_f32_16x16x64_bf16 v[36:39], v[8:11], a[160:167], v74
  ds_read_b128 v[20:23], v77 offset:256
  ds_read_b128 v[24:27], v77 offset:384
  v_smfmac_f32_16x16x64_bf16 v[40:43], v[8:11], a[168:175], v74
  ds_read_b128 v[8:11], v76 offset:6656
  v_add_f32_dpp v72, v46, v44 quad_perm:[2,3,0,1] row_mask:0xf bank_mask:0xf
  v_add_f32_dpp v73, v47, v45 quad_perm:[2,3,0,1] row_mask:0xf bank_mask:0xf
  v_smfmac_f32_16x16x64_bf16 v[36:39], v[12:15], a[96:103], v74
  s_waitcnt lgkmcnt(4)
  v_exp_f32_dpp v72, v72 quad_perm:[0,1,0,1] row_mask:0xf bank_mask:0xf
  v_smfmac_f32_16x16x64_bf16 v[40:43], v[12:15], a[104:111], v74
  ds_read_b128 v[12:15], v76 offset:7680
  v_exp_f32_dpp v73, v73 quad_perm:[0,1,0,1] row_mask:0xf bank_mask:0xf
  v_smfmac_f32_16x16x64_bf16 v[36:39], v[0:3], a[32:39], v74
  s_waitcnt lgkmcnt(2)
  v_cvt_pk_bf16_f32 v72, v72, v73
  v_mfma_f32_16x16x32_bf16 v[20:23], v[20:23], v[60:63], 0
  ds_write_b32 v78, v72 offset:520
  v_mov_b64 v[16:17], 0
  v_mfma_f32_16x16x32_bf16 v[20:23], v[24:27], v[64:67], v[20:23]
  ds_read_b128 v[44:47], v75 offset:40960
  v_mov_b64 v[18:19], 0
  v_smfmac_f32_16x16x64_bf16 v[40:43], v[0:3], a[40:47], v74
  ds_read_b128 v[48:51], v75 offset:41984
  v_mov_b64 v[68:69], s[78:79]
  v_smfmac_f32_16x16x64_bf16 v[36:39], v[4:7], a[48:55], v74
  s_waitcnt lgkmcnt(4)
  v_add_f32_dpp v24, v22, v20 quad_perm:[2,3,0,1] row_mask:0xf bank_mask:0xf
  v_add_f32_dpp v25, v23, v21 quad_perm:[2,3,0,1] row_mask:0xf bank_mask:0xf
  v_smfmac_f32_16x16x64_bf16 v[36:39], v[8:11], a[64:71], v74
  s_waitcnt lgkmcnt(2)
  s_barrier
  ds_read_b128 v[32:35], v78 offset:512
  v_smfmac_f32_16x16x64_bf16 v[36:39], v[12:15], a[80:87], v74
  ds_read_b128 v[60:63], v75 offset:24576
  v_mul_f32 v24, s69, v24
  v_smfmac_f32_16x16x64_bf16 v[40:43], v[4:7], a[56:63], v74
  ds_read_b128 v[64:67], v75 offset:25600
  v_mul_f32 v25, s69, v25
  v_smfmac_f32_16x16x64_bf16 v[40:43], v[8:11], a[72:79], v74
  v_exp_f32_dpp v24, v24 quad_perm:[0,1,0,1] row_mask:0xf bank_mask:0xf
  v_smfmac_f32_16x16x64_bf16 v[40:43], v[12:15], a[88:95], v74
  s_waitcnt lgkmcnt(2)
  v_exp_f32_dpp v25, v25 quad_perm:[0,1,0,1] row_mask:0xf bank_mask:0xf
  v_mfma_f32_16x16x32_bf16 v[8:11], v[32:35], v[68:71], 0
  v_add_f32 v36, v36, v38
  v_add_f32 v37, v37, v39
  v_mfma_f32_16x16x32_bf16 v[0:3], v[32:35], v[52:55], 0
  v_add_f32 v40, v40, v42
  v_add_f32 v41, v41, v43
  v_mfma_f32_16x16x32_bf16 v[4:7], v[32:35], v[56:59], 0
  v_cvt_pk_bf16_f32 v28, v24, v25
  v_cvt_pk_bf16_f32 v72, v36, v37
  v_cvt_pk_bf16_f32 v73, v40, v41
  v_mfma_f32_16x16x16_bf16 v[8:11], v[28:29], v[68:69], v[8:11]
  v_cvt_pk_bf16_f32 v31, v24, v25
  v_mov_b64 v[20:21], 0
  v_mfma_f32_16x16x16_bf16 v[0:3], v[28:29], v[72:73], v[0:3]
  ds_read_b128 v[52:55], v75 offset:26624
  v_mov_b64 v[22:23], 0
  v_mfma_f32_16x16x16_bf16 v[4:7], v[30:31], v[72:73], v[4:7]
  v_rcp_f32 v10, v8
  v_rcp_f32 v11, v9
  v_mul_f32 v0, v10, v0
  v_mul_f32 v1, v11, v1
  v_max3_f32 v8, v8, v9, v10
  v_mul_f32 v4, v10, v4
  v_mul_f32 v5, v11, v5
  v_cvt_pk_bf16_f32 v2, v0, v4
  ds_write_b32 v79, v2 offset:8704
  v_cvt_pk_bf16_f32 v3, v1, v5
  ds_write_b32 v79, v3 offset:9280
  ds_read_b128 v[12:15], v78 offset:8832
  v_max_f32 v8, v8, v11
  v_cmp_le_f32 vcc, 1317011456, v8
  v_mov_b64 v[24:25], 0
  v_mov_b64 v[26:27], 0
  ds_read_b128 v[56:59], v75 offset:27648
  s_cbranch_vccnz Cf2_mx
Cf2_mxok:
  s_waitcnt lgkmcnt(2)
  s_barrier
  ds_read_b128 v[0:3], v78 offset:8896
  s_waitcnt lgkmcnt(2)
  v_smfmac_f32_16x16x64_bf16 v[16:19], v[12:15], a[176:183], v74
  ds_read_b128 v[4:7], v78 offset:8704
  v_smfmac_f32_16x16x64_bf16 v[20:23], v[12:15], v[44:51], v74
  ds_read_b128 v[8:11], v78 offset:8768
  v_smfmac_f32_16x16x64_bf16 v[24:27], v[12:15], a[224:231], v74
  ds_read_b128 v[36:39], v75 offset:43008
  s_waitcnt lgkmcnt(3)
  v_smfmac_f32_16x16x64_bf16 v[16:19], v[0:3], a[184:191], v74
  ds_read_b128 v[40:43], v75 offset:44032
  s_waitcnt lgkmcnt(3)
  v_smfmac_f32_16x16x64_bf16 v[16:19], v[4:7], v[60:67], v74
  ds_read_b128 v[68:71], v76 offset:13824
  s_waitcnt lgkmcnt(3)
  v_smfmac_f32_16x16x64_bf16 v[16:19], v[8:11], v[52:59], v74
  ds_read_b128 v[44:47], v75 offset:57344
  v_smfmac_f32_16x16x64_bf16 v[20:23], v[4:7], a[192:199], v74
  ds_read_b128 v[48:51], v75 offset:58368
  v_smfmac_f32_16x16x64_bf16 v[20:23], v[8:11], a[200:207], v74
  ds_read_b128 v[60:63], v75 offset:59392
  s_waitcnt lgkmcnt(4)
  v_cvt_pk_bf16_f32 v16, v16, v17
  v_cvt_pk_bf16_f32 v17, v18, v19
  v_bfi_b32 v16, 1, s72, v16
  v_smfmac_f32_16x16x64_bf16 v[20:23], v[0:3], v[36:43], v74
  s_waitcnt lgkmcnt(3)
  buffer_store_dwordx2 v[16:17], v68, s[8:11], s73 offen
  v_mov_b64 v[32:33], 0
  v_smfmac_f32_16x16x64_bf16 v[24:27], v[4:7], a[208:215], v74
  ds_read_b128 v[64:67], v75 offset:60416
  v_mov_b64 v[34:35], 0
  v_smfmac_f32_16x16x64_bf16 v[24:27], v[8:11], a[216:223], v74
  ds_read_b128 v[52:55], v75 offset:0
  v_cvt_pk_bf16_f32 v20, v20, v21
  v_cvt_pk_bf16_f32 v21, v22, v23
  v_bfi_b32 v20, 1, s72, v20
  v_smfmac_f32_16x16x64_bf16 v[24:27], v[0:3], a[232:239], v74
  ds_read_b128 v[56:59], v75 offset:1024
  buffer_store_dwordx2 v[20:21], v68, s[8:11], s74 offen
  s_waitcnt lgkmcnt(4)
  v_mov_b64 v[28:29], 0
  v_smfmac_f32_16x16x64_bf16 v[32:35], v[4:7], v[44:51], v74
  ds_read_b128 v[36:39], v75 offset:2048
  ds_read_b128 v[40:43], v75 offset:3072
  s_waitcnt lgkmcnt(4)
  v_smfmac_f32_16x16x64_bf16 v[32:35], v[8:11], v[60:67], v74
  ds_read_b128 v[44:47], v75 offset:4096
  v_cvt_pk_bf16_f32 v24, v24, v25
  v_cvt_pk_bf16_f32 v25, v26, v27
  v_bfi_b32 v24, 1, s72, v24
  v_smfmac_f32_16x16x64_bf16 v[32:35], v[12:15], a[240:247], v74
  ds_read_b128 v[48:51], v75 offset:5120
  buffer_store_dwordx2 v[24:25], v68, s[8:11], s75 offen
  v_mov_b64 v[30:31], 0
  v_smfmac_f32_16x16x64_bf16 v[32:35], v[0:3], a[248:255], v74
  ds_read_b128 v[60:63], v75 offset:6144
  ds_read_b128 v[64:67], v75 offset:7168
  s_waitcnt lgkmcnt(6)
  v_smfmac_f32_16x16x64_bf16 v[28:31], v[4:7], v[52:59], v74
  s_waitcnt lgkmcnt(4)
  v_smfmac_f32_16x16x64_bf16 v[28:31], v[8:11], v[36:43], v74
  s_waitcnt lgkmcnt(2)
  v_cvt_pk_bf16_f32 v32, v32, v33
  v_cvt_pk_bf16_f32 v33, v34, v35
  v_bfi_b32 v32, 1, s72, v32
  v_smfmac_f32_16x16x64_bf16 v[28:31], v[12:15], v[44:51], v74
  buffer_store_dwordx2 v[32:33], v68, s[8:11], s76 offen
  s_waitcnt lgkmcnt(0)
  v_smfmac_f32_16x16x64_bf16 v[28:31], v[0:3], v[60:67], v74
  v_mov_b64 v[18:19], v[72:73]
  s_nop 4
  v_cvt_pk_bf16_f32 v28, v28, v29
  v_cvt_pk_bf16_f32 v29, v30, v31
  v_bfi_b32 v28, 1, s72, v28
  buffer_store_dwordx2 v[28:29], v68, s[8:11], s77 offen
  ds_read_b128 v[0:3], v76 offset:14848
  s_waitcnt lgkmcnt(0)
  ds_read_b64 v[16:17], v77 offset:384
  s_waitcnt lgkmcnt(0)
  ds_read_b128 v[64:67], v76 offset:27648
  s_waitcnt lgkmcnt(0)
  ds_read_b128 v[60:63], v76 offset:26624
  s_waitcnt lgkmcnt(0)
  v_xor_b32 v75, 0x8000, v75
  v_mov_b64 v[28:29], 0
  v_mov_b64 v[30:31], 0
  v_mov_b64 v[32:33], 0
  v_mov_b64 v[34:35], 0
  buffer_load_dwordx4 v[52:55], v76, s[8:11], s60 offen offset:0 sc1
  buffer_load_dwordx4 v[56:59], v76, s[8:11], s60 offen offset:1024 sc1
  s_add_u32 s66, s66, 1
  s_xor_b32 s64, s64, 16384
  s_xor_b32 s65, s65, 16384
  s_add_u32 s58, s58, 655360
  s_add_u32 s59, s59, 655360
  s_add_u32 s70, s70, 655360
  s_add_u32 s68, s68, 655360
  s_mov_b32 m0, 12800
  s_add_u32 s85, s65, 8192
  s_waitcnt lgkmcnt(0)
  s_waitcnt vmcnt(1)
  v_mfma_f32_16x16x32_bf16 v[4:7], v[0:3], v[52:55], 0
  v_bitop3_b32 v72, v52, v54, s72 bitop3:0x7e
  s_waitcnt vmcnt(0)
  v_mfma_f32_16x16x32_bf16 v[4:7], v[0:3], v[56:59], v[4:7]
  v_bitop3_b32 v73, v56, v58, s72 bitop3:0x7e
  v_bitop3_b32 v72, v72, v73, 1 bitop3:0xa8
  v_cmp_ne_u32 vcc, 0, v72
  s_nop 3
  v_add_f32_dpp v4, v4, v4 row_ror:4 row_mask:0xf bank_mask:0xf
  v_add_f32_dpp v5, v5, v5 row_ror:4 row_mask:0xf bank_mask:0xf
  s_cmp_eq_u64 vcc, 0
  v_add_f32_dpp v4, v4, v4 row_ror:8 row_mask:0xf bank_mask:0xf
  v_add_f32_dpp v5, v5, v5 row_ror:8 row_mask:0xf bank_mask:0xf
  s_cselect_b32 s54, s62, 268435456
  v_cvt_pk_bf16_f32 v4, v4, v5
  buffer_store_dword v4, v69, s[8:11], s54 offen
  s_cbranch_vccnz Cf2_h1r
  s_xor_b32 s62, s62, 16384
  buffer_store_dword v71, v69, s[8:11], s62 offen
  s_xor_b32 s72, s72, 1
  s_branch Cf2_h2
Cf2_h1r:
  s_mov_b64 exec, vcc
  buffer_load_dwordx4 v[52:55], v76, s[8:11], s60 offen offset:0 sc1
  buffer_load_dwordx4 v[56:59], v76, s[8:11], s60 offen offset:1024 sc1
  s_mov_b64 exec, -1
  s_add_u32 s67, s67, 1
  s_waitcnt vmcnt(1)
  v_mfma_f32_16x16x32_bf16 v[4:7], v[0:3], v[52:55], 0
  v_bitop3_b32 v72, v52, v54, s72 bitop3:0x7e
  s_waitcnt vmcnt(0)
  v_mfma_f32_16x16x32_bf16 v[4:7], v[0:3], v[56:59], v[4:7]
  v_bitop3_b32 v73, v56, v58, s72 bitop3:0x7e
  v_bitop3_b32 v72, v72, v73, 1 bitop3:0xa8
  v_cmp_ne_u32 vcc, 0, v72
  s_cbranch_vccz Cf2_h1p
Cf2_h1s:
  s_mov_b64 exec, vcc
  buffer_load_dwordx4 v[52:55], v76, s[8:11], s60 offen offset:0 sc1
  buffer_load_dwordx4 v[56:59], v76, s[8:11], s60 offen offset:1024 sc1
  s_mov_b64 exec, -1
  s_add_u32 s67, s67, 1
  s_waitcnt vmcnt(1)
  v_mfma_f32_16x16x32_bf16 v[4:7], v[0:3], v[52:55], 0
  v_bitop3_b32 v72, v52, v54, s72 bitop3:0x7e
  s_waitcnt vmcnt(0)
  v_mfma_f32_16x16x32_bf16 v[4:7], v[0:3], v[56:59], v[4:7]
  v_bitop3_b32 v73, v56, v58, s72 bitop3:0x7e
  v_bitop3_b32 v72, v72, v73, 1 bitop3:0xa8
  v_cmp_ne_u32 vcc, 0, v72
  s_cbranch_vccz Cf2_h1p
  s_cmp_lt_u32 s67, 131072
  s_cbranch_scc1 Cf2_h1s
Cf2_h1p:
  s_nop 2
  v_add_f32_dpp v4, v4, v4 row_ror:4 row_mask:0xf bank_mask:0xf
  v_add_f32_dpp v5, v5, v5 row_ror:4 row_mask:0xf bank_mask:0xf
  s_nop 0
  v_add_f32_dpp v4, v4, v4 row_ror:8 row_mask:0xf bank_mask:0xf
  v_add_f32_dpp v5, v5, v5 row_ror:8 row_mask:0xf bank_mask:0xf
  v_cvt_pk_bf16_f32 v4, v4, v5
  buffer_store_dword v4, v69, s[8:11], s62 offen
  s_xor_b32 s62, s62, 16384
  buffer_store_dword v71, v69, s[8:11], s62 offen
  s_xor_b32 s72, s72, 1
  s_branch Cf2_h2
Cf2_h2r:
  s_mov_b64 exec, vcc
  buffer_load_dwordx4 v[12:15], v76, s[8:11], s65 offen offset:3072 sc1
  s_mov_b64 exec, -1
  s_add_u32 s67, s67, 1
  s_waitcnt vmcnt(4)
  v_max3_u32 v72, v12, v13, v14
  v_max_u32 v72, v72, v15
  ds_write_b128 v76, v[12:15] offset:7680
  v_cmp_eq_u32 vcc, -1, v72
  s_cbranch_vccz Cf2_h2w
  s_mov_b64 exec, vcc
  buffer_load_dwordx4 v[12:15], v76, s[8:11], s65 offen offset:3072 sc1
  s_mov_b64 exec, -1
  s_add_u32 s67, s67, 1
  s_waitcnt vmcnt(4)
  v_max3_u32 v72, v12, v13, v14
  v_max_u32 v72, v72, v15
  ds_write_b128 v76, v[12:15] offset:7680
  v_cmp_eq_u32 vcc, -1, v72
  s_cbranch_vccz Cf2_h2w
Cf2_h2s:
  s_mov_b64 exec, vcc
  buffer_load_dwordx4 v[12:15], v76, s[8:11], s65 offen offset:3072 sc1
  s_mov_b64 exec, -1
  s_add_u32 s67, s67, 1
  s_waitcnt vmcnt(2)
  v_max3_u32 v72, v12, v13, v14
  v_max_u32 v72, v72, v15
  ds_write_b128 v76, v[12:15] offset:7680
  v_cmp_eq_u32 vcc, -1, v72
  s_cbranch_vccz Cf2_h2w
  s_mov_b64 exec, vcc
  buffer_load_dwordx4 v[12:15], v76, s[8:11], s65 offen offset:3072 sc1
  s_mov_b64 exec, -1
  s_add_u32 s67, s67, 1
  s_waitcnt vmcnt(2)
  v_max3_u32 v72, v12, v13, v14
  v_max_u32 v72, v72, v15
  ds_write_b128 v76, v[12:15] offset:7680
  v_cmp_eq_u32 vcc, -1, v72
  s_cbranch_vccz Cf2_h2w
  s_mov_b64 exec, vcc
  buffer_load_dwordx4 v[12:15], v76, s[8:11], s65 offen offset:3072 sc1
  s_mov_b64 exec, -1
  s_add_u32 s67, s67, 1
  s_waitcnt vmcnt(2)
  v_max3_u32 v72, v12, v13, v14
  v_max_u32 v72, v72, v15
  ds_write_b128 v76, v[12:15] offset:7680
  v_cmp_eq_u32 vcc, -1, v72
  s_cbranch_vccz Cf2_h2w
  s_cmp_lt_u32 s67, 131072
  s_cbranch_scc1 Cf2_h2s
  s_branch Cf2_h2w
Cf2_rec:
  s_nop 7
  s_waitcnt vmcnt(0) lgkmcnt(0)
  v_max3_u32 v72, v0, v1, v2
  v_max3_u32 v72, v72, v3, v4
  v_max3_u32 v72, v72, v5, v6
  v_max3_u32 v72, v72, v7, v8
  v_max3_u32 v72, v72, v9, v10
  v_max3_u32 v72, v72, v11, v12
  v_max3_u32 v72, v72, v13, v14
  v_max3_u32 v72, v72, v15, v16
  v_max3_u32 v72, v72, v17, v18
  v_max_u32 v72, v72, v19
  v_cmp_eq_u32 vcc, -1, v72
  s_cbranch_vccz Cf2_recok
  s_barrier
Cf2_recp:
  buffer_load_dwordx4 v[0:3], v76, s[8:11], s64 offen offset:0 sc1
  buffer_load_dwordx4 v[4:7], v76, s[8:11], s64 offen offset:1024 sc1
  s_add_u32 s67, s67, 1
  s_cmp_lt_u32 s67, 131072
  s_cselect_b32 s54, -2, -1
  s_waitcnt vmcnt(1)
  v_max3_u32 v72, v0, v1, v2
  s_waitcnt vmcnt(0)
  v_max3_u32 v72, v72, v3, v4
  v_max3_u32 v72, v72, v5, v6
  v_max_u32 v72, v72, v7
  v_cmp_lt_u32 vcc, s54, v72
  s_cbranch_vccnz Cf2_recp
  ds_write_b128 v76, v[0:3] offset:8704
  ds_write_b128 v76, v[4:7] offset:9728
  v_mov_b64 v[20:21], 0
  v_mov_b64 v[22:23], 0
  v_mov_b64 v[24:25], 0
  v_mov_b64 v[26:27], 0
  v_mov_b64 v[28:29], 0
  v_mov_b64 v[30:31], 0
  v_mov_b64 v[32:33], 0
  v_mov_b64 v[34:35], 0
  s_waitcnt lgkmcnt(0)
  s_barrier
  ds_read_b128 v[0:3], v76 offset:4608
  s_waitcnt lgkmcnt(0)
  v_smfmac_f32_16x16x64_bf16 v[20:23], v[0:3], v[80:87], v74
  v_smfmac_f32_16x16x64_bf16 v[24:27], v[0:3], v[88:95], v74
  ds_read_b128 v[60:63], v76 offset:24576
  ds_read_b128 v[64:67], v76 offset:25600
  s_waitcnt lgkmcnt(0)
  v_smfmac_f32_16x16x64_bf16 v[28:31], v[0:3], v[60:67], v74
  ds_read_b128 v[60:63], v76 offset:26624
  ds_read_b128 v[64:67], v76 offset:27648
  s_waitcnt lgkmcnt(0)
  v_smfmac_f32_16x16x64_bf16 v[32:35], v[0:3], v[60:67], v74
  ds_read_b128 v[4:7], v76 offset:5632
  s_waitcnt lgkmcnt(0)
  v_smfmac_f32_16x16x64_bf16 v[20:23], v[4:7], v[96:103], v74
  v_smfmac_f32_16x16x64_bf16 v[24:27], v[4:7], v[104:111], v74
  ds_read_b128 v[60:63], v76 offset:40960
  ds_read_b128 v[64:67], v76 offset:41984
  s_waitcnt lgkmcnt(0)
  v_smfmac_f32_16x16x64_bf16 v[28:31], v[4:7], v[60:67], v74
  ds_read_b128 v[60:63], v76 offset:43008
  ds_read_b128 v[64:67], v76 offset:44032
  s_waitcnt lgkmcnt(0)
  v_smfmac_f32_16x16x64_bf16 v[32:35], v[4:7], v[60:67], v74
  ds_read_b128 v[8:11], v76 offset:6656
  s_waitcnt lgkmcnt(0)
  v_smfmac_f32_16x16x64_bf16 v[20:23], v[8:11], v[112:119], v74
  v_smfmac_f32_16x16x64_bf16 v[24:27], v[8:11], v[120:127], v74
  v_smfmac_f32_16x16x64_bf16 v[28:31], v[8:11], v[208:215], v74
  v_smfmac_f32_16x16x64_bf16 v[32:35], v[8:11], v[216:223], v74
  ds_read_b128 v[12:15], v76 offset:7680
  s_waitcnt lgkmcnt(0)
  v_smfmac_f32_16x16x64_bf16 v[20:23], v[12:15], v[128:135], v74
  v_smfmac_f32_16x16x64_bf16 v[24:27], v[12:15], v[136:143], v74
  v_smfmac_f32_16x16x64_bf16 v[28:31], v[12:15], v[224:231], v74
  v_smfmac_f32_16x16x64_bf16 v[32:35], v[12:15], v[232:239], v74
  ds_read_b128 v[12:15], v76 offset:8704
  s_waitcnt lgkmcnt(0)
  v_smfmac_f32_16x16x64_bf16 v[20:23], v[12:15], v[144:151], v74
  v_smfmac_f32_16x16x64_bf16 v[24:27], v[12:15], v[152:159], v74
  ds_read_b128 v[60:63], v76 offset:57344
  ds_read_b128 v[64:67], v76 offset:58368
  s_waitcnt lgkmcnt(0)
  v_smfmac_f32_16x16x64_bf16 v[28:31], v[12:15], v[60:67], v74
  ds_read_b128 v[60:63], v76 offset:59392
  ds_read_b128 v[64:67], v76 offset:60416
  s_waitcnt lgkmcnt(0)
  v_smfmac_f32_16x16x64_bf16 v[32:35], v[12:15], v[60:67], v74
  ds_read_b128 v[0:3], v76 offset:9728
  s_waitcnt lgkmcnt(0)
  v_smfmac_f32_16x16x64_bf16 v[20:23], v[0:3], v[160:167], v74
  v_smfmac_f32_16x16x64_bf16 v[24:27], v[0:3], v[168:175], v74
  ds_read_b128 v[60:63], v75 offset:24576
  ds_read_b128 v[64:67], v75 offset:25600
  s_waitcnt lgkmcnt(0)
  v_smfmac_f32_16x16x64_bf16 v[28:31], v[0:3], v[60:67], v74
  ds_read_b128 v[60:63], v75 offset:26624
  ds_read_b128 v[64:67], v75 offset:27648
  s_waitcnt lgkmcnt(0)
  v_smfmac_f32_16x16x64_bf16 v[32:35], v[0:3], v[60:67], v74
  ds_read_b128 v[16:19], v76 offset:10752
  ds_read_b128 v[60:63], v75 offset:8192
  ds_read_b128 v[64:67], v75 offset:9216
  s_waitcnt lgkmcnt(0)
  v_smfmac_f32_16x16x64_bf16 v[20:23], v[16:19], v[60:67], v74
  ds_read_b128 v[60:63], v75 offset:10240
  ds_read_b128 v[64:67], v75 offset:11264
  s_waitcnt lgkmcnt(0)
  v_smfmac_f32_16x16x64_bf16 v[24:27], v[16:19], v[60:67], v74
  v_smfmac_f32_16x16x64_bf16 v[28:31], v[16:19], v[240:247], v74
  v_smfmac_f32_16x16x64_bf16 v[32:35], v[16:19], v[248:255], v74
  ds_read_b128 v[4:7], v76 offset:11776
  s_waitcnt lgkmcnt(0)
  v_smfmac_f32_16x16x64_bf16 v[20:23], v[4:7], v[176:183], v74
  v_smfmac_f32_16x16x64_bf16 v[24:27], v[4:7], v[184:191], v74
  v_smfmac_f32_16x16x64_bf16 v[28:31], v[4:7], a[0:7], v74
  v_smfmac_f32_16x16x64_bf16 v[32:35], v[4:7], a[8:15], v74
  ds_read_b128 v[8:11], v76 offset:12800
  s_waitcnt lgkmcnt(0)
  v_smfmac_f32_16x16x64_bf16 v[20:23], v[8:11], v[192:199], v74
  v_smfmac_f32_16x16x64_bf16 v[24:27], v[8:11], v[200:207], v74
  v_smfmac_f32_16x16x64_bf16 v[28:31], v[8:11], a[16:23], v74
  v_smfmac_f32_16x16x64_bf16 v[32:35], v[8:11], a[24:31], v74
  v_add_f32 v20, v20, v22
  v_add_f32 v21, v21, v23
  v_add_f32 v24, v24, v26
  v_cvt_pk_bf16_f32 v22, v20, v24
  ds_write_b32 v79, v22 offset:0
  v_add_f32 v25, v25, v27
  v_cvt_pk_bf16_f32 v23, v21, v25
  ds_write_b32 v79, v23 offset:576
  v_add_f32 v28, v28, v30
  v_add_f32 v29, v29, v31
  s_waitcnt lgkmcnt(0)
  s_nop 1
  s_branch Cf2_recok
Cf2_mx:
  s_waitcnt lgkmcnt(0)
  s_barrier
  buffer_load_dwordx4 v[52:55], v76, s[8:11], s59 offen offset:0 sc1
  buffer_load_dwordx4 v[0:3], v76, s[8:11], s58 offen offset:0 sc1
  ds_read_b128 v[20:23], v77 offset:0
  ds_read_b128 v[28:31], v77 offset:256
  buffer_load_dwordx4 v[56:59], v76, s[8:11], s59 offen offset:1024 sc1
  buffer_load_dwordx4 v[4:7], v76, s[8:11], s58 offen offset:1024 sc1
  ds_read_b128 v[24:27], v77 offset:128
  ds_read_b128 v[32:35], v77 offset:384
  s_waitcnt vmcnt(2) lgkmcnt(3)
  v_mfma_f32_16x16x32_bf16 v[8:11], v[0:3], v[20:23], 0
  s_waitcnt vmcnt(0) lgkmcnt(1)
  v_mfma_f32_16x16x32_bf16 v[8:11], v[4:7], v[24:27], v[8:11]
  v_mfma_f32_16x16x32_bf16 v[12:15], v[28:31], v[20:23], 0
  s_waitcnt lgkmcnt(0)
  v_mfma_f32_16x16x32_bf16 v[12:15], v[32:35], v[24:27], v[12:15]
  v_add_f32_dpp v8, v10, v8 quad_perm:[2,3,0,1] row_mask:0xf bank_mask:0xf
  v_add_f32_dpp v9, v11, v9 quad_perm:[2,3,0,1] row_mask:0xf bank_mask:0xf
  s_nop 0
  v_mov_b32_dpp v8, v8 quad_perm:[0,1,0,1] row_mask:0xf bank_mask:0xf
  v_mov_b32_dpp v9, v9 quad_perm:[0,1,0,1] row_mask:0xf bank_mask:0xf
  s_nop 1
  v_add_f32_dpp v12, v14, v12 quad_perm:[2,3,0,1] row_mask:0xf bank_mask:0xf
  v_add_f32_dpp v13, v15, v13 quad_perm:[2,3,0,1] row_mask:0xf bank_mask:0xf
  s_nop 0
  v_mov_b32_dpp v12, v12 quad_perm:[0,1,0,1] row_mask:0xf bank_mask:0xf
  v_mov_b32_dpp v13, v13 quad_perm:[0,1,0,1] row_mask:0xf bank_mask:0xf
  v_mul_f32 v12, s69, v12
  ds_write_b32 v78, v8 offset:8712
  v_mul_f32 v13, s69, v13
  ds_write_b32 v78, v9 offset:8776
  s_waitcnt lgkmcnt(0)
  s_barrier
  ds_read_b128 v[36:39], v78 offset:8704
  ds_read_b128 v[40:43], v78 offset:8768
  s_waitcnt lgkmcnt(0)
  s_barrier
  v_max_f32 v16, v36, v37
  v_max3_f32 v16, v16, v38, v39
  v_max3_f32 v16, v16, v40, v41
  v_max3_f32 v16, v16, v42, v43
  v_max3_f32 v16, v16, v12, v13
  v_mov_b32 v17, v16
  s_nop 1
  v_permlane16_swap_b32 v16, v17
  v_max_f32 v16, v16, v17
  v_mov_b32 v17, v16
  s_nop 1
  v_permlane32_swap_b32 v16, v17
  v_max_f32 v16, v16, v17
  v_sub_f32 v36, v36, v16
  v_sub_f32 v37, v37, v16
  v_sub_f32 v38, v38, v16
  v_sub_f32 v39, v39, v16
  v_sub_f32 v40, v40, v16
  v_sub_f32 v41, v41, v16
  v_sub_f32 v42, v42, v16
  v_sub_f32 v43, v43, v16
  v_sub_f32 v12, v12, v16
  v_sub_f32 v13, v13, v16
  v_exp_f32 v36, v36
  v_exp_f32 v37, v37
  v_exp_f32 v38, v38
  v_exp_f32 v39, v39
  v_exp_f32 v40, v40
  v_exp_f32 v41, v41
  v_exp_f32 v42, v42
  v_exp_f32 v43, v43
  v_exp_f32 v12, v12
  v_exp_f32 v13, v13
  v_cvt_pk_bf16_f32 v32, v36, v40
  v_cvt_pk_bf16_f32 v33, v37, v41
  v_cvt_pk_bf16_f32 v34, v38, v42
  v_cvt_pk_bf16_f32 v35, v39, v43
  v_cvt_pk_bf16_f32 v28, v12, v13
  v_cvt_pk_bf16_f32 v31, v12, v13
  v_mov_b32 v29, 0
  v_mov_b32 v30, 0
  v_mfma_f32_16x16x32_bf16 v[8:11], v[32:35], v[68:71], 0
  v_mfma_f32_16x16x32_bf16 v[0:3], v[32:35], v[52:55], 0
  v_mfma_f32_16x16x32_bf16 v[4:7], v[32:35], v[56:59], 0
  v_mfma_f32_16x16x16_bf16 v[8:11], v[28:29], v[68:69], v[8:11]
  v_mfma_f32_16x16x16_bf16 v[0:3], v[28:29], v[72:73], v[0:3]
  v_mfma_f32_16x16x16_bf16 v[4:7], v[30:31], v[72:73], v[4:7]
  ds_read_b128 v[52:55], v75 offset:26624
  v_rcp_f32 v10, v8
  v_rcp_f32 v11, v9
  v_mul_f32 v0, v10, v0
  v_mul_f32 v1, v11, v1
  v_max3_f32 v8, v8, v9, v10
  v_mul_f32 v4, v10, v4
  v_mul_f32 v5, v11, v5
  v_cvt_pk_bf16_f32 v2, v0, v4
  ds_write_b32 v79, v2 offset:8704
  v_cvt_pk_bf16_f32 v3, v1, v5
  ds_write_b32 v79, v3 offset:9280
  ds_read_b128 v[12:15], v78 offset:8832
  ds_read_b128 v[56:59], v75 offset:27648
  v_mov_b64 v[16:17], 0
  v_mov_b64 v[18:19], 0
  v_mov_b64 v[20:21], 0
  v_mov_b64 v[22:23], 0
  v_mov_b64 v[24:25], 0
  v_mov_b64 v[26:27], 0
  s_branch Cf2_mxok
Cf2_last:
  ds_read_b128 v[4:7], v76 offset:5632
  ds_read_b128 v[8:11], v76 offset:6656
  ds_read_b128 v[44:47], v76 offset:40960
  ds_read_b128 v[48:51], v76 offset:41984
  s_nop 5
  v_mov_b64 v[20:21], 0
  v_mov_b64 v[22:23], 0
  v_mov_b64 v[24:25], 0
  v_mov_b64 v[26:27], 0
  s_waitcnt lgkmcnt(4)
  v_smfmac_f32_16x16x64_bf16 v[28:31], v[0:3], v[36:43], v74
  ds_read_b128 v[36:39], v76 offset:43008
  ds_read_b128 v[40:43], v76 offset:44032
  v_smfmac_f32_16x16x64_bf16 v[32:35], v[0:3], v[60:67], v74
  s_waitcnt lgkmcnt(5)
  v_smfmac_f32_16x16x64_bf16 v[20:23], v[0:3], a[32:39], v74
  ds_read_b128 v[60:63], v76 offset:57344
  ds_read_b128 v[64:67], v76 offset:58368
  v_smfmac_f32_16x16x64_bf16 v[24:27], v[0:3], a[40:47], v74
  s_waitcnt lgkmcnt(4)
  v_smfmac_f32_16x16x64_bf16 v[20:23], v[4:7], a[48:55], v74
  buffer_store_dwordx4 v[16:19], v76, s[8:11], s68 offen sc1
  v_smfmac_f32_16x16x64_bf16 v[24:27], v[4:7], a[56:63], v74
  v_smfmac_f32_16x16x64_bf16 v[28:31], v[4:7], v[44:51], v74
  s_waitcnt lgkmcnt(2)
  v_smfmac_f32_16x16x64_bf16 v[20:23], v[8:11], a[64:71], v74
  ds_read_b128 v[44:47], v76 offset:59392
  ds_read_b128 v[48:51], v76 offset:60416
  v_smfmac_f32_16x16x64_bf16 v[24:27], v[8:11], a[72:79], v74
  v_smfmac_f32_16x16x64_bf16 v[32:35], v[4:7], v[36:43], v74
  v_smfmac_f32_16x16x64_bf16 v[28:31], v[8:11], v[208:215], v74
  ds_read_b128 v[36:39], v75 offset:24576
  ds_read_b128 v[40:43], v75 offset:25600
  v_smfmac_f32_16x16x64_bf16 v[32:35], v[8:11], v[216:223], v74
  v_smfmac_f32_16x16x64_bf16 v[20:23], v[12:15], a[80:87], v74
  v_smfmac_f32_16x16x64_bf16 v[24:27], v[12:15], a[88:95], v74
  v_smfmac_f32_16x16x64_bf16 v[28:31], v[12:15], v[224:231], v74
  v_smfmac_f32_16x16x64_bf16 v[32:35], v[12:15], v[232:239], v74
  s_waitcnt vmcnt(2)
  s_waitcnt vmcnt(1)
  s_barrier
Cf2_lastr:
  ds_read_b128 v[12:15], v76 offset:8704
  ds_read_b128 v[0:3], v76 offset:9728
  ds_read_b128 v[16:19], v76 offset:10752
  ds_read_b128 v[4:7], v76 offset:11776
  ds_read_b128 v[8:11], v76 offset:12800
  s_waitcnt lgkmcnt(3)
  v_max3_u32 v72, v0, v1, v2
  s_waitcnt lgkmcnt(1)
  v_max3_u32 v72, v72, v3, v4
  v_max3_u32 v72, v72, v5, v6
  s_waitcnt lgkmcnt(0)
  v_max3_u32 v72, v72, v7, v8
  v_max3_u32 v72, v72, v9, v10
  v_max3_u32 v72, v72, v11, v12
  v_max3_u32 v72, v72, v13, v14
  v_max3_u32 v72, v72, v15, v16
  v_max3_u32 v72, v72, v17, v18
  v_max_u32 v72, v72, v19
  v_cmp_eq_u32 vcc, -1, v72
  s_cbranch_vccnz Cf2_lastp
Cf2_lastg:
  v_smfmac_f32_16x16x64_bf16 v[28:31], v[12:15], v[60:67], v74
  ds_read_b128 v[60:63], v75 offset:26624
  ds_read_b128 v[64:67], v75 offset:27648
  v_smfmac_f32_16x16x64_bf16 v[32:35], v[12:15], v[44:51], v74
  v_smfmac_f32_16x16x64_bf16 v[28:31], v[0:3], v[36:43], v74
  v_smfmac_f32_16x16x64_bf16 v[28:31], v[16:19], v[240:247], v74
  v_smfmac_f32_16x16x64_bf16 v[28:31], v[4:7], a[0:7], v74
  v_smfmac_f32_16x16x64_bf16 v[28:31], v[8:11], a[16:23], v74
  v_smfmac_f32_16x16x64_bf16 v[32:35], v[16:19], v[248:255], v74
  v_smfmac_f32_16x16x64_bf16 v[32:35], v[4:7], a[8:15], v74
  s_waitcnt lgkmcnt(0)
  v_smfmac_f32_16x16x64_bf16 v[32:35], v[8:11], a[24:31], v74
  v_smfmac_f32_16x16x64_bf16 v[32:35], v[0:3], v[60:67], v74
  v_smfmac_f32_16x16x64_bf16 v[20:23], v[12:15], a[96:103], v74
  v_smfmac_f32_16x16x64_bf16 v[20:23], v[0:3], a[112:119], v74
  v_add_f32 v28, v28, v30
  v_add_f32 v32, v32, v34
  v_cvt_pk_bf16_f32 v30, v28, v32
  v_smfmac_f32_16x16x64_bf16 v[20:23], v[16:19], a[128:135], v74
  ds_write_b32 v79, v30 offset:256
  v_add_f32 v29, v29, v31
  v_add_f32 v33, v33, v35
  v_cvt_pk_bf16_f32 v31, v29, v33
  v_smfmac_f32_16x16x64_bf16 v[20:23], v[4:7], a[144:151], v74
  ds_write_b32 v79, v31 offset:832
  v_smfmac_f32_16x16x64_bf16 v[20:23], v[8:11], a[160:167], v74
  v_smfmac_f32_16x16x64_bf16 v[24:27], v[12:15], a[104:111], v74
  v_smfmac_f32_16x16x64_bf16 v[24:27], v[0:3], a[120:127], v74
  v_smfmac_f32_16x16x64_bf16 v[24:27], v[16:19], a[136:143], v74
  s_waitcnt lgkmcnt(0)
  s_barrier
  ds_read_b64 v[52:53], v77 offset:384
  v_add_f32 v20, v20, v22
  v_smfmac_f32_16x16x64_bf16 v[24:27], v[4:7], a[152:159], v74
  v_add_f32 v21, v21, v23
  v_smfmac_f32_16x16x64_bf16 v[24:27], v[8:11], a[168:175], v74
  v_cvt_pk_bf16_f32 v54, v20, v21
  s_add_u32 s68, s68, 655360
  s_nop 3
  v_add_f32 v24, v24, v26
  v_add_f32 v25, v25, v27
  v_cvt_pk_bf16_f32 v55, v24, v25
  s_waitcnt lgkmcnt(0)
  buffer_store_dwordx4 v[52:55], v76, s[8:11], s68 offen sc1
  s_branch Cf2_done
Cf2_lastp:
  s_add_u32 s72, s72, 2
  s_cmp_ge_u32 s72, 131072
  s_cbranch_scc1 Cf2_lastg
  s_barrier
  buffer_load_dwordx4 v76, s[8:11], s85 offen offset:0 sc1 lds
  s_waitcnt vmcnt(0)
  s_barrier
  s_branch Cf2_lastr
Cf2_done:
  s_branch L_cexit
L_w3:
  v_mov_b64 v[20:21], 0
  v_mov_b64 v[22:23], 0
  v_mov_b64 v[24:25], 0
  v_mov_b64 v[26:27], 0
  v_mov_b64 v[28:29], 0
  v_mov_b64 v[30:31], 0
  v_mov_b64 v[32:33], 0
  v_mov_b64 v[34:35], 0
  s_mov_b32 s78, 0x3f803f80
  s_mov_b32 s79, s78
  s_mov_b32 s65, 360448
  s_mov_b32 m0, 15872
  s_lshl_b32 s71, s53, 2
  s_add_u32 s71, s71, 128
  s_movk_i32 s56, 0x1000
  v_lshlrev_b32 v73, 2, v76
  v_mov_b32 v72, 0
  s_mov_b64 s[16:17], s[8:9]
  s_mov_b32 s18, 268435456
  s_mov_b32 s19, 0x20000
  s_getpc_b64 s[20:21]
Cf3_pc:
  s_add_u32 s20, s20, (Cf3_last - Cf3_pc)
  s_addc_u32 s21, s21, 0
  v_mov_b32 v68, 14880
  buffer_load_dwordx4 v[52:55], v76, s[8:11], s59 offen offset:0 sc1
  buffer_load_dwordx4 v[56:59], v76, s[8:11], s59 offen offset:1024 sc1
  ds_read_b128 v[36:39], v76 offset:45056
  ds_read_b128 v[40:43], v76 offset:46080
  ds_read_b128 v[60:63], v76 offset:47104
  ds_read_b128 v[64:67], v76 offset:48128
  ds_read_b128 v[0:3], v76 offset:4608
  ds_read_b128 v[4:7], v76 offset:5632
  ds_read_b128 v[8:11], v76 offset:6656
  ds_read_b128 v[12:15], v76 offset:7680
  s_waitcnt lgkmcnt(0)
  s_cmp_eq_u32 s66, 1
  s_branch Cf3_top2
.p2align 6
Cf3_h2:
  v_lshlrev_b32 v73, 2, v76
  buffer_load_dwordx4 v[4:7], v76, s[8:11], s65 offen offset:1024 sc1
  ds_read_b128 v[36:39], v76 offset:45056
  ds_read_b128 v[40:43], v76 offset:46080
  buffer_load_dwordx4 v[52:55], v76, s[8:11], s59 offen offset:0 sc1
  buffer_load_dwordx4 v[56:59], v76, s[8:11], s59 offen offset:1024 sc1
  s_waitcnt vmcnt(7)
  v_max3_u32 v72, v4, v5, v6
  v_max_u32 v72, v72, v7
  ds_write_b128 v76, v[4:7] offset:5632
  v_cmp_eq_u32 vcc, -1, v72
  s_cbranch_vccnz Cf3_h2r
Cf3_h2w:
  buffer_load_dwordx4 v76, s[8:11], s85 offen offset:0 sc1 lds
  buffer_load_dwordx4 v76, s[8:11], s85 offen offset:1024 sc1 lds
  s_cmp_eq_u32 s66, 63
  s_waitcnt lgkmcnt(0)
  s_barrier
  ds_read_b128 v[8:11], v76 offset:6656
Cf3_top2:
  v_smfmac_f32_16x16x64_bf16 v[20:23], v[4:7], v[96:103], v74
  s_cbranch_scc1 Cf3_last
  v_smfmac_f32_16x16x64_bf16 v[28:31], v[4:7], v[36:43], v74
  buffer_load_dwordx4 v[44:47], v76, s[8:11], s58 offen offset:0 sc1
  s_mov_b32 m0, 15872
  v_smfmac_f32_16x16x64_bf16 v[24:27], v[4:7], v[104:111], v74
  buffer_load_dwordx4 v[48:51], v76, s[8:11], s58 offen offset:1024 sc1
  v_smfmac_f32_16x16x64_bf16 v[32:35], v[4:7], v[60:67], v74
  ds_read_b128 v[0:3], v76 offset:4608
  s_waitcnt lgkmcnt(1)
  v_smfmac_f32_16x16x64_bf16 v[20:23], v[8:11], v[112:119], v74
  ds_read_b128 v[12:15], v76 offset:7680
  v_smfmac_f32_16x16x64_bf16 v[24:27], v[8:11], v[120:127], v74
  ds_read_b128 v[36:39], v76 offset:28672
  v_smfmac_f32_16x16x64_bf16 v[28:31], v[8:11], v[208:215], v74
  buffer_store_dwordx4 v[16:19], v76, s[8:11], s68 offen sc1
  ds_read_b128 v[40:43], v76 offset:29696
  v_smfmac_f32_16x16x64_bf16 v[32:35], v[8:11], v[216:223], v74
  buffer_load_dword v73, s[16:19], s70 offen lds
  ds_read_b128 v[60:63], v76 offset:30720
  s_waitcnt lgkmcnt(4)
  v_smfmac_f32_16x16x64_bf16 v[20:23], v[0:3], v[80:87], v74
  ds_read_b128 v[64:67], v76 offset:31744
  v_smfmac_f32_16x16x64_bf16 v[24:27], v[0:3], v[88:95], v74
  s_waitcnt vmcnt(4)
  s_waitcnt lgkmcnt(4)
  v_smfmac_f32_16x16x64_bf16 v[20:23], v[12:15], v[128:135], v74
  s_barrier
  ds_read_b128 v[4:7], v76 offset:8704
  s_waitcnt lgkmcnt(3)
  v_smfmac_f32_16x16x64_bf16 v[28:31], v[0:3], v[36:43], v74
  ds_read_b128 v[36:39], v76 offset:61440
  v_smfmac_f32_16x16x64_bf16 v[24:27], v[12:15], v[136:143], v74
  ds_read_b128 v[40:43], v76 offset:62464
  s_waitcnt lgkmcnt(3)
  v_smfmac_f32_16x16x64_bf16 v[32:35], v[0:3], v[60:67], v74
  ds_read_b128 v[8:11], v76 offset:9728
  v_smfmac_f32_16x16x64_bf16 v[28:31], v[12:15], v[224:231], v74
  ds_read_b128 v[60:63], v76 offset:63488
  v_smfmac_f32_16x16x64_bf16 v[32:35], v[12:15], v[232:239], v74
  ds_read_b128 v[64:67], v76 offset:64512
  s_waitcnt lgkmcnt(5)
  v_smfmac_f32_16x16x64_bf16 v[20:23], v[4:7], v[144:151], v74
  s_barrier
  ds_read_b128 v[0:3], v76 offset:11776
  s_waitcnt lgkmcnt(4)
  v_smfmac_f32_16x16x64_bf16 v[28:31], v[4:7], v[36:43], v74
  ds_read_b128 v[12:15], v76 offset:12800
  ds_read_b128 v[36:39], v75 offset:12288
  v_smfmac_f32_16x16x64_bf16 v[24:27], v[4:7], v[152:159], v74
  ds_read_b128 v[16:19], v76 offset:10752
  s_waitcnt lgkmcnt(6)
  v_smfmac_f32_16x16x64_bf16 v[20:23], v[8:11], v[160:167], v74
  ds_read_b128 v[40:43], v75 offset:13312
  s_waitcnt lgkmcnt(5)
  v_smfmac_f32_16x16x64_bf16 v[32:35], v[4:7], v[60:67], v74
  ds_read_b128 v[60:63], v75 offset:14336
  v_smfmac_f32_16x16x64_bf16 v[24:27], v[8:11], v[168:175], v74
  ds_read_b128 v[64:67], v75 offset:15360
  s_waitcnt lgkmcnt(6)
  v_smfmac_f32_16x16x64_bf16 v[20:23], v[0:3], v[176:183], v74
  s_waitcnt lgkmcnt(5)
  v_smfmac_f32_16x16x64_bf16 v[20:23], v[12:15], v[192:199], v74
  s_waitcnt lgkmcnt(2)
  v_smfmac_f32_16x16x64_bf16 v[20:23], v[16:19], v[36:43], v74
  ds_read_b128 v[36:39], v75 offset:28672
  v_smfmac_f32_16x16x64_bf16 v[24:27], v[0:3], v[184:191], v74
  ds_read_b128 v[40:43], v75 offset:29696
  s_waitcnt lgkmcnt(2)
  v_smfmac_f32_16x16x64_bf16 v[24:27], v[16:19], v[60:67], v74
  ds_read_b128 v[60:63], v75 offset:30720
  v_add_f32 v20, v20, v22
  v_smfmac_f32_16x16x64_bf16 v[24:27], v[12:15], v[200:207], v74
  ds_read_b128 v[64:67], v75 offset:31744
  v_add_f32 v21, v21, v23
  v_smfmac_f32_16x16x64_bf16 v[28:31], v[16:19], v[240:247], v74
  v_mov_b64 v[70:71], s[78:79]
  v_smfmac_f32_16x16x64_bf16 v[28:31], v[0:3], a[0:7], v74
  s_waitcnt lgkmcnt(2)
  v_add_f32 v24, v24, v26
  v_smfmac_f32_16x16x64_bf16 v[28:31], v[8:11], v[36:43], v74
  ds_read_b128 v[36:39], v68
  v_cvt_pk_bf16_f32 v22, v20, v24
  v_smfmac_f32_16x16x64_bf16 v[28:31], v[12:15], a[16:23], v74
  ds_read_b128 v[40:43], v68
  ds_write_b32 v79, v22 offset:0
  s_waitcnt lgkmcnt(3)
  v_add_f32 v25, v25, v27
  v_cvt_pk_bf16_f32 v23, v21, v25
  v_smfmac_f32_16x16x64_bf16 v[32:35], v[8:11], v[60:67], v74
  ds_write_b32 v79, v23 offset:576
  v_cmp_u_f32 vcc, v20, v21
  v_smfmac_f32_16x16x64_bf16 v[32:35], v[16:19], v[248:255], v74
  v_add_f32 v28, v28, v30
  v_smfmac_f32_16x16x64_bf16 v[32:35], v[0:3], a[8:15], v74
  v_add_f32 v29, v29, v31
  v_smfmac_f32_16x16x64_bf16 v[32:35], v[12:15], a[24:31], v74
  s_cbranch_vccnz Cf3_rec
Cf3_recok:
  s_waitcnt lgkmcnt(3)
  v_smfmac_f32_16x16x64_bf16 v[36:39], v[16:19], a[128:135], v74
  s_waitcnt lgkmcnt(0)
  s_barrier
  ds_read_b128 v[60:63], v77
  v_smfmac_f32_16x16x64_bf16 v[40:43], v[16:19], a[136:143], v74
  ds_read_b128 v[64:67], v77 offset:128
  v_add_f32 v32, v32, v34
  v_cvt_pk_bf16_f32 v30, v28, v32
  v_smfmac_f32_16x16x64_bf16 v[36:39], v[0:3], a[144:151], v74
  ds_write_b32 v79, v30 offset:256
  v_add_f32 v33, v33, v35
  v_cvt_pk_bf16_f32 v31, v29, v33
  v_smfmac_f32_16x16x64_bf16 v[40:43], v[0:3], a[152:159], v74
  ds_write_b32 v79, v31 offset:832
  v_xor_b32 v75, 0x8000, v75
  v_smfmac_f32_16x16x64_bf16 v[36:39], v[4:7], a[96:103], v74
  ds_read_b128 v[0:3], v76 offset:4608
  v_mov_b32 v29, 0
  v_smfmac_f32_16x16x64_bf16 v[40:43], v[4:7], a[104:111], v74
  s_waitcnt vmcnt(2) lgkmcnt(3)
  v_mov_b32 v30, 0
  v_mfma_f32_16x16x32_bf16 v[44:47], v[44:47], v[60:63], 0
  ds_read_b128 v[4:7], v76 offset:5632
  s_waitcnt lgkmcnt(2)
  v_mfma_f32_16x16x32_bf16 v[44:47], v[48:51], v[64:67], v[44:47]
  s_barrier
  v_smfmac_f32_16x16x64_bf16 v[36:39], v[8:11], a[112:119], v74
  ds_read_b128 v[20:23], v77 offset:256
  ds_read_b128 v[24:27], v77 offset:384
  v_smfmac_f32_16x16x64_bf16 v[40:43], v[8:11], a[120:127], v74
  ds_read_b128 v[8:11], v76 offset:6656
  v_add_f32_dpp v72, v46, v44 quad_perm:[2,3,0,1] row_mask:0xf bank_mask:0xf
  v_add_f32_dpp v73, v47, v45 quad_perm:[2,3,0,1] row_mask:0xf bank_mask:0xf
  v_smfmac_f32_16x16x64_bf16 v[36:39], v[12:15], a[160:167], v74
  s_waitcnt lgkmcnt(4)
  v_exp_f32_dpp v72, v72 quad_perm:[0,1,0,1] row_mask:0xf bank_mask:0xf
  v_smfmac_f32_16x16x64_bf16 v[40:43], v[12:15], a[168:175], v74
  ds_read_b128 v[12:15], v76 offset:7680
  v_exp_f32_dpp v73, v73 quad_perm:[0,1,0,1] row_mask:0xf bank_mask:0xf
  v_smfmac_f32_16x16x64_bf16 v[36:39], v[0:3], a[32:39], v74
  s_waitcnt lgkmcnt(2)
  v_cvt_pk_bf16_f32 v72, v72, v73
  v_mfma_f32_16x16x32_bf16 v[20:23], v[20:23], v[60:63], 0
  ds_write_b32 v78, v72 offset:524
  v_mov_b64 v[16:17], 0
  v_mfma_f32_16x16x32_bf16 v[20:23], v[24:27], v[64:67], v[20:23]
  ds_read_b128 v[44:47], v75 offset:47104
  v_mov_b64 v[18:19], 0
  v_smfmac_f32_16x16x64_bf16 v[40:43], v[0:3], a[40:47], v74
  ds_read_b128 v[48:51], v75 offset:48128
  v_mov_b64 v[68:69], s[78:79]
  v_smfmac_f32_16x16x64_bf16 v[36:39], v[4:7], a[48:55], v74
  s_waitcnt lgkmcnt(4)
  v_add_f32_dpp v24, v22, v20 quad_perm:[2,3,0,1] row_mask:0xf bank_mask:0xf
  v_add_f32_dpp v25, v23, v21 quad_perm:[2,3,0,1] row_mask:0xf bank_mask:0xf
  v_smfmac_f32_16x16x64_bf16 v[36:39], v[8:11], a[64:71], v74
  s_waitcnt lgkmcnt(2)
  s_barrier
  ds_read_b128 v[32:35], v78 offset:512
  v_smfmac_f32_16x16x64_bf16 v[36:39], v[12:15], a[80:87], v74
  ds_read_b128 v[60:63], v75 offset:28672
  v_mul_f32 v24, s69, v24
  v_smfmac_f32_16x16x64_bf16 v[40:43], v[4:7], a[56:63], v74
  ds_read_b128 v[64:67], v75 offset:29696
  v_mul_f32 v25, s69, v25
  v_smfmac_f32_16x16x64_bf16 v[40:43], v[8:11], a[72:79], v74
  v_exp_f32_dpp v24, v24 quad_perm:[0,1,0,1] row_mask:0xf bank_mask:0xf
  v_smfmac_f32_16x16x64_bf16 v[40:43], v[12:15], a[88:95], v74
  s_waitcnt lgkmcnt(2)
  v_exp_f32_dpp v25, v25 quad_perm:[0,1,0,1] row_mask:0xf bank_mask:0xf
  v_mfma_f32_16x16x32_bf16 v[8:11], v[32:35], v[68:71], 0
  v_add_f32 v36, v36, v38
  v_add_f32 v37, v37, v39
  v_mfma_f32_16x16x32_bf16 v[0:3], v[32:35], v[52:55], 0
  v_add_f32 v40, v40, v42
  v_add_f32 v41, v41, v43
  v_mfma_f32_16x16x32_bf16 v[4:7], v[32:35], v[56:59], 0
  v_cvt_pk_bf16_f32 v28, v24, v25
  v_cvt_pk_bf16_f32 v72, v36, v37
  v_cvt_pk_bf16_f32 v73, v40, v41
  v_mfma_f32_16x16x16_bf16 v[8:11], v[28:29], v[68:69], v[8:11]
  v_cvt_pk_bf16_f32 v31, v24, v25
  v_mov_b64 v[20:21], 0
  v_mfma_f32_16x16x16_bf16 v[0:3], v[28:29], v[72:73], v[0:3]
  ds_read_b128 v[52:55], v75 offset:30720
  v_mov_b64 v[22:23], 0
  v_mfma_f32_16x16x16_bf16 v[4:7], v[30:31], v[72:73], v[4:7]
  v_rcp_f32 v10, v8
  v_rcp_f32 v11, v9
  v_mul_f32 v0, v10, v0
  v_mul_f32 v1, v11, v1
  v_max3_f32 v8, v8, v9, v10
  v_mul_f32 v4, v10, v4
  v_mul_f32 v5, v11, v5
  v_cvt_pk_bf16_f32 v2, v0, v4
  ds_write_b32 v79, v2 offset:8704
  v_cvt_pk_bf16_f32 v3, v1, v5
  ds_write_b32 v79, v3 offset:9280
  ds_read_b128 v[12:15], v78 offset:8896
  v_max_f32 v8, v8, v11
  v_cmp_le_f32 vcc, 1317011456, v8
  v_mov_b64 v[24:25], 0
  v_mov_b64 v[26:27], 0
  ds_read_b128 v[56:59], v75 offset:31744
  s_cbranch_vccnz Cf3_mx
Cf3_mxok:
  s_waitcnt lgkmcnt(2)
  s_barrier
  ds_read_b128 v[0:3], v78 offset:8832
  s_waitcnt lgkmcnt(2)
  v_smfmac_f32_16x16x64_bf16 v[16:19], v[12:15], a[184:191], v74
  ds_read_b128 v[4:7], v78 offset:8704
  v_smfmac_f32_16x16x64_bf16 v[20:23], v[12:15], v[44:51], v74
  ds_read_b128 v[8:11], v78 offset:8768
  v_smfmac_f32_16x16x64_bf16 v[24:27], v[12:15], a[232:239], v74
  ds_read_b128 v[36:39], v75 offset:45056
  s_waitcnt lgkmcnt(3)
  v_smfmac_f32_16x16x64_bf16 v[16:19], v[0:3], a[176:183], v74
  ds_read_b128 v[40:43], v75 offset:46080
  s_waitcnt lgkmcnt(3)
  v_smfmac_f32_16x16x64_bf16 v[16:19], v[4:7], v[60:67], v74
  ds_read_b128 v[68:71], v76 offset:13824
  s_waitcnt lgkmcnt(3)
  v_smfmac_f32_16x16x64_bf16 v[16:19], v[8:11], v[52:59], v74
  ds_read_b128 v[44:47], v75 offset:61440
  v_smfmac_f32_16x16x64_bf16 v[20:23], v[4:7], a[192:199], v74
  ds_read_b128 v[48:51], v75 offset:62464
  v_smfmac_f32_16x16x64_bf16 v[20:23], v[8:11], a[200:207], v74
  ds_read_b128 v[60:63], v75 offset:63488
  s_waitcnt lgkmcnt(4)
  v_cvt_pk_bf16_f32 v16, v16, v17
  v_cvt_pk_bf16_f32 v17, v18, v19
  v_bfi_b32 v16, 1, s72, v16
  v_smfmac_f32_16x16x64_bf16 v[20:23], v[0:3], v[36:43], v74
  s_waitcnt lgkmcnt(3)
  buffer_store_dwordx2 v[16:17], v68, s[8:11], s73 offen
  v_mov_b64 v[32:33], 0
  v_smfmac_f32_16x16x64_bf16 v[24:27], v[4:7], a[208:215], v74
  ds_read_b128 v[64:67], v75 offset:64512
  v_mov_b64 v[34:35], 0
  v_smfmac_f32_16x16x64_bf16 v[24:27], v[8:11], a[216:223], v74
  ds_read_b128 v[52:55], v75 offset:8192
  v_cvt_pk_bf16_f32 v20, v20, v21
  v_cvt_pk_bf16_f32 v21, v22, v23
  v_bfi_b32 v20, 1, s72, v20
  v_smfmac_f32_16x16x64_bf16 v[24:27], v[0:3], a[224:231], v74
  ds_read_b128 v[56:59], v75 offset:9216
  buffer_store_dwordx2 v[20:21], v68, s[8:11], s74 offen
  s_waitcnt lgkmcnt(4)
  v_mov_b64 v[28:29], 0
  v_smfmac_f32_16x16x64_bf16 v[32:35], v[4:7], v[44:51], v74
  ds_read_b128 v[36:39], v75 offset:10240
  ds_read_b128 v[40:43], v75 offset:11264
  s_waitcnt lgkmcnt(4)
  v_smfmac_f32_16x16x64_bf16 v[32:35], v[8:11], v[60:67], v74
  ds_read_b128 v[44:47], v75 offset:12288
  v_cvt_pk_bf16_f32 v24, v24, v25
  v_cvt_pk_bf16_f32 v25, v26, v27
  v_bfi_b32 v24, 1, s72, v24
  v_smfmac_f32_16x16x64_bf16 v[32:35], v[0:3], a[240:247], v74
  ds_read_b128 v[48:51], v75 offset:13312
  buffer_store_dwordx2 v[24:25], v68, s[8:11], s75 offen
  v_mov_b64 v[30:31], 0
  v_smfmac_f32_16x16x64_bf16 v[32:35], v[12:15], a[248:255], v74
  ds_read_b128 v[60:63], v75 offset:14336
  ds_read_b128 v[64:67], v75 offset:15360
  s_waitcnt lgkmcnt(6)
  v_smfmac_f32_16x16x64_bf16 v[28:31], v[4:7], v[52:59], v74
  s_waitcnt lgkmcnt(4)
  v_smfmac_f32_16x16x64_bf16 v[28:31], v[8:11], v[36:43], v74
  s_waitcnt lgkmcnt(2)
  v_cvt_pk_bf16_f32 v32, v32, v33
  v_cvt_pk_bf16_f32 v33, v34, v35
  v_bfi_b32 v32, 1, s72, v32
  v_smfmac_f32_16x16x64_bf16 v[28:31], v[0:3], v[44:51], v74
  buffer_store_dwordx2 v[32:33], v68, s[8:11], s76 offen
  s_waitcnt lgkmcnt(0)
  v_smfmac_f32_16x16x64_bf16 v[28:31], v[12:15], v[60:67], v74
  v_mov_b64 v[18:19], v[72:73]
  s_nop 4
  v_cvt_pk_bf16_f32 v28, v28, v29
  v_cvt_pk_bf16_f32 v29, v30, v31
  v_bfi_b32 v28, 1, s72, v28
  buffer_store_dwordx2 v[28:29], v68, s[8:11], s77 offen
  ds_read_b128 v[52:55], v76 offset:14848
  s_waitcnt lgkmcnt(0)
  ds_read_b64 v[16:17], v77 offset:392
  s_waitcnt lgkmcnt(0)
  ds_read_b128 v[60:63], v76 offset:47104
  s_waitcnt lgkmcnt(0)
  ds_read_b128 v[64:67], v76 offset:48128
  s_waitcnt lgkmcnt(0)
  s_add_u32 s66, s66, 1
  s_xor_b32 s64, s64, 16384
  s_xor_b32 s65, s65, 16384
  s_add_u32 s58, s58, 655360
  s_add_u32 s59, s59, 655360
  s_add_u32 s70, s70, 655360
  s_add_u32 s68, s68, 655360
  s_mov_b32 m0, 8704
  s_add_u32 s85, s65, 4096
  v_xor_b32 v75, 0x8000, v75
  v_mov_b64 v[28:29], 0
  v_mov_b64 v[30:31], 0
  v_mov_b64 v[32:33], 0
  v_mov_b64 v[34:35], 0
  buffer_load_dwordx4 v[0:3], v76, s[8:11], s60 offen offset:0 sc1
  buffer_load_dwordx4 v[4:7], v76, s[8:11], s60 offen offset:1024 sc1
  buffer_load_dwordx4 v[8:11], v76, s[8:11], s61 offen offset:0 sc1
  buffer_load_dwordx4 v[12:15], v76, s[8:11], s61 offen offset:1024 sc1
  v_mov_b64 v[20:21], 0
  v_mov_b64 v[22:23], 0
  v_mov_b64 v[24:25], 0
  v_mov_b64 v[26:27], 0
  v_mov_b32 v68, 14880
  s_cmp_eq_u32 s66, 62
  s_cselect_b64 s[16:17], s[20:21], s[16:17]
  s_cselect_b32 s18, (Cf3_done - Cf3_last), s18
  s_cselect_b32 s70, 0, s70
  s_cmp_eq_u32 s66, 63
  s_cselect_b32 s59, 268435456, s59
  s_cselect_b32 s58, 268435456, s58
  s_waitcnt lgkmcnt(0)
  s_waitcnt vmcnt(3)
  v_mfma_f32_16x16x32_bf16 v[56:59], v[52:55], v[0:3], 0
  v_bitop3_b32 v72, v0, v2, s72 bitop3:0x7e
  s_waitcnt vmcnt(2)
  v_mfma_f32_16x16x32_bf16 v[56:59], v[52:55], v[4:7], v[56:59]
  v_bitop3_b32 v73, v4, v6, s72 bitop3:0x7e
  v_or_b32 v72, v72, v73
  s_waitcnt vmcnt(1)
  v_mfma_f32_16x16x32_bf16 v[36:39], v[52:55], v[8:11], 0
  v_bitop3_b32 v73, v8, v10, s72 bitop3:0x7e
  v_or_b32 v72, v72, v73
  s_waitcnt vmcnt(0)
  v_mfma_f32_16x16x32_bf16 v[36:39], v[52:55], v[12:15], v[36:39]
  v_bitop3_b32 v73, v12, v14, s72 bitop3:0x7e
  v_bitop3_b32 v72, v72, v73, 1 bitop3:0xa8
  v_cmp_ne_u32 vcc, 0, v72
  s_cbranch_vccnz Cf3_h1r
  buffer_load_dwordx4 v[4:7], v76, s[8:11], s65 offen offset:1024 sc1
  v_add_f32_dpp v56, v56, v56 row_ror:4 row_mask:0xf bank_mask:0xf
  v_add_f32_dpp v57, v57, v57 row_ror:4 row_mask:0xf bank_mask:0xf
  v_add_f32_dpp v36, v36, v36 row_ror:4 row_mask:0xf bank_mask:0xf
  v_add_f32_dpp v37, v37, v37 row_ror:4 row_mask:0xf bank_mask:0xf
  v_add_f32_dpp v56, v56, v56 row_ror:8 row_mask:0xf bank_mask:0xf
  v_add_f32_dpp v57, v57, v57 row_ror:8 row_mask:0xf bank_mask:0xf
  v_add_f32_dpp v36, v36, v36 row_ror:8 row_mask:0xf bank_mask:0xf
  v_add_f32_dpp v37, v37, v37 row_ror:8 row_mask:0xf bank_mask:0xf
  v_cvt_pk_bf16_f32 v56, v56, v57
  buffer_store_dword v56, v69, s[8:11], s62 offen
  v_cvt_pk_bf16_f32 v36, v36, v37
  buffer_store_dword v36, v70, s[8:11], s63 offen
  s_xor_b32 s62, s62, 16384
  buffer_store_dword v71, v69, s[8:11], s62 offen
  s_xor_b32 s63, s63, 16384
  buffer_store_dword v71, v70, s[8:11], s63 offen
  s_xor_b32 s72, s72, 1
  s_branch Cf3_h2
Cf3_h1r:
  s_mov_b64 exec, vcc
  buffer_load_dwordx4 v[0:3], v76, s[8:11], s60 offen offset:0 sc1
  buffer_load_dwordx4 v[4:7], v76, s[8:11], s60 offen offset:1024 sc1
  buffer_load_dwordx4 v[8:11], v76, s[8:11], s61 offen offset:0 sc1
  buffer_load_dwordx4 v[12:15], v76, s[8:11], s61 offen offset:1024 sc1
  s_mov_b64 exec, -1
  s_add_u32 s67, s67, 1
  s_waitcnt vmcnt(3)
  v_mfma_f32_16x16x32_bf16 v[56:59], v[52:55], v[0:3], 0
  v_bitop3_b32 v72, v0, v2, s72 bitop3:0x7e
  s_waitcnt vmcnt(2)
  v_mfma_f32_16x16x32_bf16 v[56:59], v[52:55], v[4:7], v[56:59]
  v_bitop3_b32 v73, v4, v6, s72 bitop3:0x7e
  v_or_b32 v72, v72, v73
  s_waitcnt vmcnt(1)
  v_mfma_f32_16x16x32_bf16 v[36:39], v[52:55], v[8:11], 0
  v_bitop3_b32 v73, v8, v10, s72 bitop3:0x7e
  v_or_b32 v72, v72, v73
  s_waitcnt vmcnt(0)
  v_mfma_f32_16x16x32_bf16 v[36:39], v[52:55], v[12:15], v[36:39]
  v_bitop3_b32 v73, v12, v14, s72 bitop3:0x7e
  v_bitop3_b32 v72, v72, v73, 1 bitop3:0xa8
  v_cmp_ne_u32 vcc, 0, v72
  s_cbranch_vccz Cf3_h1p
Cf3_h1s:
  s_mov_b64 exec, vcc
  buffer_load_dwordx4 v[0:3], v76, s[8:11], s60 offen offset:0 sc1
  buffer_load_dwordx4 v[4:7], v76, s[8:11], s60 offen offset:1024 sc1
  buffer_load_dwordx4 v[8:11], v76, s[8:11], s61 offen offset:0 sc1
  buffer_load_dwordx4 v[12:15], v76, s[8:11], s61 offen offset:1024 sc1
  s_mov_b64 exec, -1
  s_add_u32 s67, s67, 1
  s_waitcnt vmcnt(3)
  v_mfma_f32_16x16x32_bf16 v[56:59], v[52:55], v[0:3], 0
  v_bitop3_b32 v72, v0, v2, s72 bitop3:0x7e
  s_waitcnt vmcnt(2)
  v_mfma_f32_16x16x32_bf16 v[56:59], v[52:55], v[4:7], v[56:59]
  v_bitop3_b32 v73, v4, v6, s72 bitop3:0x7e
  v_or_b32 v72, v72, v73
  s_waitcnt vmcnt(1)
  v_mfma_f32_16x16x32_bf16 v[36:39], v[52:55], v[8:11], 0
  v_bitop3_b32 v73, v8, v10, s72 bitop3:0x7e
  v_or_b32 v72, v72, v73
  s_waitcnt vmcnt(0)
  v_mfma_f32_16x16x32_bf16 v[36:39], v[52:55], v[12:15], v[36:39]
  v_bitop3_b32 v73, v12, v14, s72 bitop3:0x7e
  v_bitop3_b32 v72, v72, v73, 1 bitop3:0xa8
  v_cmp_ne_u32 vcc, 0, v72
  s_cbranch_vccz Cf3_h1p
  s_cmp_lt_u32 s67, 131072
  s_cbranch_scc1 Cf3_h1s
Cf3_h1p:
  s_nop 2
  buffer_load_dwordx4 v[4:7], v76, s[8:11], s65 offen offset:1024 sc1
  v_add_f32_dpp v56, v56, v56 row_ror:4 row_mask:0xf bank_mask:0xf
  v_add_f32_dpp v57, v57, v57 row_ror:4 row_mask:0xf bank_mask:0xf
  v_add_f32_dpp v36, v36, v36 row_ror:4 row_mask:0xf bank_mask:0xf
  v_add_f32_dpp v37, v37, v37 row_ror:4 row_mask:0xf bank_mask:0xf
  v_add_f32_dpp v56, v56, v56 row_ror:8 row_mask:0xf bank_mask:0xf
  v_add_f32_dpp v57, v57, v57 row_ror:8 row_mask:0xf bank_mask:0xf
  v_add_f32_dpp v36, v36, v36 row_ror:8 row_mask:0xf bank_mask:0xf
  v_add_f32_dpp v37, v37, v37 row_ror:8 row_mask:0xf bank_mask:0xf
  v_cvt_pk_bf16_f32 v56, v56, v57
  buffer_store_dword v56, v69, s[8:11], s62 offen
  v_cvt_pk_bf16_f32 v36, v36, v37
  buffer_store_dword v36, v70, s[8:11], s63 offen
  s_xor_b32 s62, s62, 16384
  buffer_store_dword v71, v69, s[8:11], s62 offen
  s_xor_b32 s63, s63, 16384
  buffer_store_dword v71, v70, s[8:11], s63 offen
  s_xor_b32 s72, s72, 1
  s_branch Cf3_h2
Cf3_h2r:
  s_mov_b64 exec, vcc
  buffer_load_dwordx4 v[4:7], v76, s[8:11], s65 offen offset:1024 sc1
  s_mov_b64 exec, -1
  s_add_u32 s67, s67, 1
  s_waitcnt vmcnt(3)
  v_max3_u32 v72, v4, v5, v6
  v_max_u32 v72, v72, v7
  ds_write_b128 v76, v[4:7] offset:5632
  v_cmp_eq_u32 vcc, -1, v72
  s_cbranch_vccz Cf3_h2w
Cf3_h2s:
  s_mov_b64 exec, vcc
  buffer_load_dwordx4 v[4:7], v76, s[8:11], s65 offen offset:1024 sc1
  s_mov_b64 exec, -1
  s_add_u32 s67, s67, 1
  s_waitcnt vmcnt(1)
  v_max3_u32 v72, v4, v5, v6
  v_max_u32 v72, v72, v7
  ds_write_b128 v76, v[4:7] offset:5632
  v_cmp_eq_u32 vcc, -1, v72
  s_cbranch_vccz Cf3_h2w
  s_mov_b64 exec, vcc
  buffer_load_dwordx4 v[4:7], v76, s[8:11], s65 offen offset:1024 sc1
  s_mov_b64 exec, -1
  s_add_u32 s67, s67, 1
  s_waitcnt vmcnt(1)
  v_max3_u32 v72, v4, v5, v6
  v_max_u32 v72, v72, v7
  ds_write_b128 v76, v[4:7] offset:5632
  v_cmp_eq_u32 vcc, -1, v72
  s_cbranch_vccz Cf3_h2w
  s_mov_b64 exec, vcc
  buffer_load_dwordx4 v[4:7], v76, s[8:11], s65 offen offset:1024 sc1
  s_mov_b64 exec, -1
  s_add_u32 s67, s67, 1
  s_waitcnt vmcnt(1)
  v_max3_u32 v72, v4, v5, v6
  v_max_u32 v72, v72, v7
  ds_write_b128 v76, v[4:7] offset:5632
  v_cmp_eq_u32 vcc, -1, v72
  s_cbranch_vccz Cf3_h2w
  s_cmp_lt_u32 s67, 131072
  s_cbranch_scc1 Cf3_h2s
  s_branch Cf3_h2w
Cf3_rec:
  s_nop 7
  s_waitcnt vmcnt(0) lgkmcnt(0)
  v_max3_u32 v72, v0, v1, v2
  v_max3_u32 v72, v72, v3, v4
  v_max3_u32 v72, v72, v5, v6
  v_max3_u32 v72, v72, v7, v8
  v_max3_u32 v72, v72, v9, v10
  v_max3_u32 v72, v72, v11, v12
  v_max3_u32 v72, v72, v13, v14
  v_max3_u32 v72, v72, v15, v16
  v_max3_u32 v72, v72, v17, v18
  v_max_u32 v72, v72, v19
  v_cmp_eq_u32 vcc, -1, v72
  s_cbranch_vccz Cf3_recok
  s_barrier
Cf3_recp:
  buffer_load_dwordx4 v[0:3], v76, s[8:11], s64 offen offset:0 sc1
  buffer_load_dwordx4 v[4:7], v76, s[8:11], s64 offen offset:1024 sc1
  buffer_load_dwordx4 v[8:11], v76, s[8:11], s64 offen offset:2048 sc1
  s_add_u32 s67, s67, 1
  s_cmp_lt_u32 s67, 131072
  s_cselect_b32 s54, -2, -1
  s_waitcnt vmcnt(2)
  v_max3_u32 v72, v0, v1, v2
  s_waitcnt vmcnt(1)
  v_max3_u32 v72, v72, v3, v4
  v_max3_u32 v72, v72, v5, v6
  s_waitcnt vmcnt(0)
  v_max3_u32 v72, v72, v7, v8
  v_max3_u32 v72, v72, v9, v10
  v_max_u32 v72, v72, v11
  v_cmp_lt_u32 vcc, s54, v72
  s_cbranch_vccnz Cf3_recp
  ds_write_b128 v76, v[0:3] offset:10752
  ds_write_b128 v76, v[4:7] offset:11776
  ds_write_b128 v76, v[8:11] offset:12800
  v_mov_b64 v[20:21], 0
  v_mov_b64 v[22:23], 0
  v_mov_b64 v[24:25], 0
  v_mov_b64 v[26:27], 0
  v_mov_b64 v[28:29], 0
  v_mov_b64 v[30:31], 0
  v_mov_b64 v[32:33], 0
  v_mov_b64 v[34:35], 0
  s_waitcnt lgkmcnt(0)
  s_barrier
  ds_read_b128 v[0:3], v76 offset:4608
  s_waitcnt lgkmcnt(0)
  v_smfmac_f32_16x16x64_bf16 v[20:23], v[0:3], v[80:87], v74
  v_smfmac_f32_16x16x64_bf16 v[24:27], v[0:3], v[88:95], v74
  ds_read_b128 v[60:63], v76 offset:28672
  ds_read_b128 v[64:67], v76 offset:29696
  s_waitcnt lgkmcnt(0)
  v_smfmac_f32_16x16x64_bf16 v[28:31], v[0:3], v[60:67], v74
  ds_read_b128 v[60:63], v76 offset:30720
  ds_read_b128 v[64:67], v76 offset:31744
  s_waitcnt lgkmcnt(0)
  v_smfmac_f32_16x16x64_bf16 v[32:35], v[0:3], v[60:67], v74
  ds_read_b128 v[4:7], v76 offset:5632
  s_waitcnt lgkmcnt(0)
  v_smfmac_f32_16x16x64_bf16 v[20:23], v[4:7], v[96:103], v74
  v_smfmac_f32_16x16x64_bf16 v[24:27], v[4:7], v[104:111], v74
  ds_read_b128 v[60:63], v76 offset:45056
  ds_read_b128 v[64:67], v76 offset:46080
  s_waitcnt lgkmcnt(0)
  v_smfmac_f32_16x16x64_bf16 v[28:31], v[4:7], v[60:67], v74
  ds_read_b128 v[60:63], v76 offset:47104
  ds_read_b128 v[64:67], v76 offset:48128
  s_waitcnt lgkmcnt(0)
  v_smfmac_f32_16x16x64_bf16 v[32:35], v[4:7], v[60:67], v74
  ds_read_b128 v[8:11], v76 offset:6656
  s_waitcnt lgkmcnt(0)
  v_smfmac_f32_16x16x64_bf16 v[20:23], v[8:11], v[112:119], v74
  v_smfmac_f32_16x16x64_bf16 v[24:27], v[8:11], v[120:127], v74
  v_smfmac_f32_16x16x64_bf16 v[28:31], v[8:11], v[208:215], v74
  v_smfmac_f32_16x16x64_bf16 v[32:35], v[8:11], v[216:223], v74
  ds_read_b128 v[12:15], v76 offset:7680
  s_waitcnt lgkmcnt(0)
  v_smfmac_f32_16x16x64_bf16 v[20:23], v[12:15], v[128:135], v74
  v_smfmac_f32_16x16x64_bf16 v[24:27], v[12:15], v[136:143], v74
  v_smfmac_f32_16x16x64_bf16 v[28:31], v[12:15], v[224:231], v74
  v_smfmac_f32_16x16x64_bf16 v[32:35], v[12:15], v[232:239], v74
  ds_read_b128 v[4:7], v76 offset:8704
  s_waitcnt lgkmcnt(0)
  v_smfmac_f32_16x16x64_bf16 v[20:23], v[4:7], v[144:151], v74
  v_smfmac_f32_16x16x64_bf16 v[24:27], v[4:7], v[152:159], v74
  ds_read_b128 v[60:63], v76 offset:61440
  ds_read_b128 v[64:67], v76 offset:62464
  s_waitcnt lgkmcnt(0)
  v_smfmac_f32_16x16x64_bf16 v[28:31], v[4:7], v[60:67], v74
  ds_read_b128 v[60:63], v76 offset:63488
  ds_read_b128 v[64:67], v76 offset:64512
  s_waitcnt lgkmcnt(0)
  v_smfmac_f32_16x16x64_bf16 v[32:35], v[4:7], v[60:67], v74
  ds_read_b128 v[8:11], v76 offset:9728
  s_waitcnt lgkmcnt(0)
  v_smfmac_f32_16x16x64_bf16 v[20:23], v[8:11], v[160:167], v74
  v_smfmac_f32_16x16x64_bf16 v[24:27], v[8:11], v[168:175], v74
  ds_read_b128 v[60:63], v75 offset:28672
  ds_read_b128 v[64:67], v75 offset:29696
  s_waitcnt lgkmcnt(0)
  v_smfmac_f32_16x16x64_bf16 v[28:31], v[8:11], v[60:67], v74
  ds_read_b128 v[60:63], v75 offset:30720
  ds_read_b128 v[64:67], v75 offset:31744
  s_waitcnt lgkmcnt(0)
  v_smfmac_f32_16x16x64_bf16 v[32:35], v[8:11], v[60:67], v74
  ds_read_b128 v[16:19], v76 offset:10752
  ds_read_b128 v[60:63], v75 offset:12288
  ds_read_b128 v[64:67], v75 offset:13312
  s_waitcnt lgkmcnt(0)
  v_smfmac_f32_16x16x64_bf16 v[20:23], v[16:19], v[60:67], v74
  ds_read_b128 v[60:63], v75 offset:14336
  ds_read_b128 v[64:67], v75 offset:15360
  s_waitcnt lgkmcnt(0)
  v_smfmac_f32_16x16x64_bf16 v[24:27], v[16:19], v[60:67], v74
  v_smfmac_f32_16x16x64_bf16 v[28:31], v[16:19], v[240:247], v74
  v_smfmac_f32_16x16x64_bf16 v[32:35], v[16:19], v[248:255], v74
  ds_read_b128 v[0:3], v76 offset:11776
  s_waitcnt lgkmcnt(0)
  v_smfmac_f32_16x16x64_bf16 v[20:23], v[0:3], v[176:183], v74
  v_smfmac_f32_16x16x64_bf16 v[24:27], v[0:3], v[184:191], v74
  v_smfmac_f32_16x16x64_bf16 v[28:31], v[0:3], a[0:7], v74
  v_smfmac_f32_16x16x64_bf16 v[32:35], v[0:3], a[8:15], v74
  ds_read_b128 v[12:15], v76 offset:12800
  s_waitcnt lgkmcnt(0)
  v_smfmac_f32_16x16x64_bf16 v[20:23], v[12:15], v[192:199], v74
  v_smfmac_f32_16x16x64_bf16 v[24:27], v[12:15], v[200:207], v74
  v_smfmac_f32_16x16x64_bf16 v[28:31], v[12:15], a[16:23], v74
  v_smfmac_f32_16x16x64_bf16 v[32:35], v[12:15], a[24:31], v74
  v_add_f32 v20, v20, v22
  v_add_f32 v21, v21, v23
  v_add_f32 v24, v24, v26
  v_cvt_pk_bf16_f32 v22, v20, v24
  ds_write_b32 v79, v22 offset:0
  v_add_f32 v25, v25, v27
  v_cvt_pk_bf16_f32 v23, v21, v25
  ds_write_b32 v79, v23 offset:576
  v_add_f32 v28, v28, v30
  v_add_f32 v29, v29, v31
  s_waitcnt lgkmcnt(0)
  s_nop 1
  s_branch Cf3_recok
Cf3_mx:
  s_waitcnt lgkmcnt(0)
  s_barrier
  buffer_load_dwordx4 v[52:55], v76, s[8:11], s59 offen offset:0 sc1
  buffer_load_dwordx4 v[0:3], v76, s[8:11], s58 offen offset:0 sc1
  ds_read_b128 v[20:23], v77 offset:0
  ds_read_b128 v[28:31], v77 offset:256
  buffer_load_dwordx4 v[56:59], v76, s[8:11], s59 offen offset:1024 sc1
  buffer_load_dwordx4 v[4:7], v76, s[8:11], s58 offen offset:1024 sc1
  ds_read_b128 v[24:27], v77 offset:128
  ds_read_b128 v[32:35], v77 offset:384
  s_waitcnt vmcnt(2) lgkmcnt(3)
  v_mfma_f32_16x16x32_bf16 v[8:11], v[0:3], v[20:23], 0
  s_waitcnt vmcnt(0) lgkmcnt(1)
  v_mfma_f32_16x16x32_bf16 v[8:11], v[4:7], v[24:27], v[8:11]
  v_mfma_f32_16x16x32_bf16 v[12:15], v[28:31], v[20:23], 0
  s_waitcnt lgkmcnt(0)
  v_mfma_f32_16x16x32_bf16 v[12:15], v[32:35], v[24:27], v[12:15]
  v_add_f32_dpp v8, v10, v8 quad_perm:[2,3,0,1] row_mask:0xf bank_mask:0xf
  v_add_f32_dpp v9, v11, v9 quad_perm:[2,3,0,1] row_mask:0xf bank_mask:0xf
  s_nop 0
  v_mov_b32_dpp v8, v8 quad_perm:[0,1,0,1] row_mask:0xf bank_mask:0xf
  v_mov_b32_dpp v9, v9 quad_perm:[0,1,0,1] row_mask:0xf bank_mask:0xf
  s_nop 1
  v_add_f32_dpp v12, v14, v12 quad_perm:[2,3,0,1] row_mask:0xf bank_mask:0xf
  v_add_f32_dpp v13, v15, v13 quad_perm:[2,3,0,1] row_mask:0xf bank_mask:0xf
  s_nop 0
  v_mov_b32_dpp v12, v12 quad_perm:[0,1,0,1] row_mask:0xf bank_mask:0xf
  v_mov_b32_dpp v13, v13 quad_perm:[0,1,0,1] row_mask:0xf bank_mask:0xf
  v_mul_f32 v12, s69, v12
  ds_write_b32 v78, v8 offset:8716
  v_mul_f32 v13, s69, v13
  ds_write_b32 v78, v9 offset:8780
  s_waitcnt lgkmcnt(0)
  s_barrier
  ds_read_b128 v[36:39], v78 offset:8704
  ds_read_b128 v[40:43], v78 offset:8768
  s_waitcnt lgkmcnt(0)
  s_barrier
  v_max_f32 v16, v36, v37
  v_max3_f32 v16, v16, v38, v39
  v_max3_f32 v16, v16, v40, v41
  v_max3_f32 v16, v16, v42, v43
  v_max3_f32 v16, v16, v12, v13
  v_mov_b32 v17, v16
  s_nop 1
  v_permlane16_swap_b32 v16, v17
  v_max_f32 v16, v16, v17
  v_mov_b32 v17, v16
  s_nop 1
  v_permlane32_swap_b32 v16, v17
  v_max_f32 v16, v16, v17
  v_sub_f32 v36, v36, v16
  v_sub_f32 v37, v37, v16
  v_sub_f32 v38, v38, v16
  v_sub_f32 v39, v39, v16
  v_sub_f32 v40, v40, v16
  v_sub_f32 v41, v41, v16
  v_sub_f32 v42, v42, v16
  v_sub_f32 v43, v43, v16
  v_sub_f32 v12, v12, v16
  v_sub_f32 v13, v13, v16
  v_exp_f32 v36, v36
  v_exp_f32 v37, v37
  v_exp_f32 v38, v38
  v_exp_f32 v39, v39
  v_exp_f32 v40, v40
  v_exp_f32 v41, v41
  v_exp_f32 v42, v42
  v_exp_f32 v43, v43
  v_exp_f32 v12, v12
  v_exp_f32 v13, v13
  v_cvt_pk_bf16_f32 v32, v36, v40
  v_cvt_pk_bf16_f32 v33, v37, v41
  v_cvt_pk_bf16_f32 v34, v38, v42
  v_cvt_pk_bf16_f32 v35, v39, v43
  v_cvt_pk_bf16_f32 v28, v12, v13
  v_cvt_pk_bf16_f32 v31, v12, v13
  v_mov_b32 v29, 0
  v_mov_b32 v30, 0
  v_mfma_f32_16x16x32_bf16 v[8:11], v[32:35], v[68:71], 0
  v_mfma_f32_16x16x32_bf16 v[0:3], v[32:35], v[52:55], 0
  v_mfma_f32_16x16x32_bf16 v[4:7], v[32:35], v[56:59], 0
  v_mfma_f32_16x16x16_bf16 v[8:11], v[28:29], v[68:69], v[8:11]
  v_mfma_f32_16x16x16_bf16 v[0:3], v[28:29], v[72:73], v[0:3]
  v_mfma_f32_16x16x16_bf16 v[4:7], v[30:31], v[72:73], v[4:7]
  ds_read_b128 v[52:55], v75 offset:30720
  v_rcp_f32 v10, v8
  v_rcp_f32 v11, v9
  v_mul_f32 v0, v10, v0
  v_mul_f32 v1, v11, v1
  v_max3_f32 v8, v8, v9, v10
  v_mul_f32 v4, v10, v4
  v_mul_f32 v5, v11, v5
  v_cvt_pk_bf16_f32 v2, v0, v4
  ds_write_b32 v79, v2 offset:8704
  v_cvt_pk_bf16_f32 v3, v1, v5
  ds_write_b32 v79, v3 offset:9280
  ds_read_b128 v[12:15], v78 offset:8896
  ds_read_b128 v[56:59], v75 offset:31744
  v_mov_b64 v[16:17], 0
  v_mov_b64 v[18:19], 0
  v_mov_b64 v[20:21], 0
  v_mov_b64 v[22:23], 0
  v_mov_b64 v[24:25], 0
  v_mov_b64 v[26:27], 0
  s_branch Cf3_mxok
Cf3_last:
  ds_read_b128 v[0:3], v76 offset:4608
  ds_read_b128 v[12:15], v76 offset:7680
  ds_read_b128 v[44:47], v76 offset:28672
  ds_read_b128 v[48:51], v76 offset:29696
  s_nop 5
  v_mov_b64 v[20:21], 0
  v_mov_b64 v[22:23], 0
  v_mov_b64 v[24:25], 0
  v_mov_b64 v[26:27], 0
  v_smfmac_f32_16x16x64_bf16 v[28:31], v[4:7], v[36:43], v74
  ds_read_b128 v[36:39], v76 offset:30720
  ds_read_b128 v[40:43], v76 offset:31744
  v_smfmac_f32_16x16x64_bf16 v[32:35], v[4:7], v[60:67], v74
  s_waitcnt lgkmcnt(5)
  v_smfmac_f32_16x16x64_bf16 v[20:23], v[0:3], a[32:39], v74
  ds_read_b128 v[60:63], v76 offset:61440
  ds_read_b128 v[64:67], v76 offset:62464
  v_smfmac_f32_16x16x64_bf16 v[24:27], v[0:3], a[40:47], v74
  s_waitcnt lgkmcnt(4)
  v_smfmac_f32_16x16x64_bf16 v[20:23], v[4:7], a[48:55], v74
  buffer_store_dwordx4 v[16:19], v76, s[8:11], s68 offen sc1
  v_smfmac_f32_16x16x64_bf16 v[24:27], v[4:7], a[56:63], v74
  v_smfmac_f32_16x16x64_bf16 v[28:31], v[0:3], v[44:51], v74
  s_waitcnt lgkmcnt(2)
  v_smfmac_f32_16x16x64_bf16 v[20:23], v[8:11], a[64:71], v74
  ds_read_b128 v[44:47], v76 offset:63488
  ds_read_b128 v[48:51], v76 offset:64512
  v_smfmac_f32_16x16x64_bf16 v[24:27], v[8:11], a[72:79], v74
  v_smfmac_f32_16x16x64_bf16 v[32:35], v[0:3], v[36:43], v74
  v_smfmac_f32_16x16x64_bf16 v[28:31], v[8:11], v[208:215], v74
  ds_read_b128 v[36:39], v75 offset:28672
  ds_read_b128 v[40:43], v75 offset:29696
  v_smfmac_f32_16x16x64_bf16 v[32:35], v[8:11], v[216:223], v74
  v_smfmac_f32_16x16x64_bf16 v[20:23], v[12:15], a[80:87], v74
  v_smfmac_f32_16x16x64_bf16 v[24:27], v[12:15], a[88:95], v74
  v_smfmac_f32_16x16x64_bf16 v[28:31], v[12:15], v[224:231], v74
  v_smfmac_f32_16x16x64_bf16 v[32:35], v[12:15], v[232:239], v74
  s_waitcnt vmcnt(1)
  s_barrier
Cf3_lastr:
  ds_read_b128 v[4:7], v76 offset:8704
  ds_read_b128 v[8:11], v76 offset:9728
  ds_read_b128 v[16:19], v76 offset:10752
  ds_read_b128 v[0:3], v76 offset:11776
  ds_read_b128 v[12:15], v76 offset:12800
  s_waitcnt lgkmcnt(1)
  v_max3_u32 v72, v0, v1, v2
  v_max3_u32 v72, v72, v3, v4
  v_max3_u32 v72, v72, v5, v6
  v_max3_u32 v72, v72, v7, v8
  v_max3_u32 v72, v72, v9, v10
  s_waitcnt lgkmcnt(0)
  v_max3_u32 v72, v72, v11, v12
  v_max3_u32 v72, v72, v13, v14
  v_max3_u32 v72, v72, v15, v16
  v_max3_u32 v72, v72, v17, v18
  v_max_u32 v72, v72, v19
  v_cmp_eq_u32 vcc, -1, v72
  s_cbranch_vccnz Cf3_lastp
Cf3_lastg:
  v_smfmac_f32_16x16x64_bf16 v[28:31], v[4:7], v[60:67], v74
  ds_read_b128 v[60:63], v75 offset:30720
  ds_read_b128 v[64:67], v75 offset:31744
  v_smfmac_f32_16x16x64_bf16 v[32:35], v[4:7], v[44:51], v74
  v_smfmac_f32_16x16x64_bf16 v[28:31], v[8:11], v[36:43], v74
  v_smfmac_f32_16x16x64_bf16 v[28:31], v[16:19], v[240:247], v74
  v_smfmac_f32_16x16x64_bf16 v[28:31], v[0:3], a[0:7], v74
  v_smfmac_f32_16x16x64_bf16 v[28:31], v[12:15], a[16:23], v74
  v_smfmac_f32_16x16x64_bf16 v[32:35], v[16:19], v[248:255], v74
  v_smfmac_f32_16x16x64_bf16 v[32:35], v[0:3], a[8:15], v74
  s_waitcnt lgkmcnt(0)
  v_smfmac_f32_16x16x64_bf16 v[32:35], v[12:15], a[24:31], v74
  v_smfmac_f32_16x16x64_bf16 v[32:35], v[8:11], v[60:67], v74
  v_smfmac_f32_16x16x64_bf16 v[20:23], v[4:7], a[96:103], v74
  v_smfmac_f32_16x16x64_bf16 v[20:23], v[8:11], a[112:119], v74
  v_add_f32 v28, v28, v30
  v_add_f32 v32, v32, v34
  v_cvt_pk_bf16_f32 v30, v28, v32
  v_smfmac_f32_16x16x64_bf16 v[20:23], v[16:19], a[128:135], v74
  ds_write_b32 v79, v30 offset:256
  v_add_f32 v29, v29, v31
  v_add_f32 v33, v33, v35
  v_cvt_pk_bf16_f32 v31, v29, v33
  v_smfmac_f32_16x16x64_bf16 v[20:23], v[0:3], a[144:151], v74
  ds_write_b32 v79, v31 offset:832
  v_smfmac_f32_16x16x64_bf16 v[20:23], v[12:15], a[160:167], v74
  v_smfmac_f32_16x16x64_bf16 v[24:27], v[4:7], a[104:111], v74
  v_smfmac_f32_16x16x64_bf16 v[24:27], v[8:11], a[120:127], v74
  v_smfmac_f32_16x16x64_bf16 v[24:27], v[16:19], a[136:143], v74
  s_waitcnt lgkmcnt(0)
  s_barrier
  ds_read_b64 v[52:53], v77 offset:392
  v_add_f32 v20, v20, v22
  v_smfmac_f32_16x16x64_bf16 v[24:27], v[0:3], a[152:159], v74
  v_add_f32 v21, v21, v23
  v_smfmac_f32_16x16x64_bf16 v[24:27], v[12:15], a[168:175], v74
  v_cvt_pk_bf16_f32 v54, v20, v21
  s_add_u32 s68, s68, 655360
  s_nop 3
  v_add_f32 v24, v24, v26
  v_add_f32 v25, v25, v27
  v_cvt_pk_bf16_f32 v55, v24, v25
  s_waitcnt lgkmcnt(0)
  buffer_store_dwordx4 v[52:55], v76, s[8:11], s68 offen sc1
  s_branch Cf3_done
Cf3_lastp:
  s_add_u32 s72, s72, 2
  s_cmp_ge_u32 s72, 131072
  s_cbranch_scc1 Cf3_lastg
  s_barrier
  buffer_load_dwordx4 v76, s[8:11], s85 offen offset:0 sc1 lds
  buffer_load_dwordx4 v76, s[8:11], s85 offen offset:1024 sc1 lds
  s_waitcnt vmcnt(0)
  s_barrier
  s_branch Cf3_lastr
Cf3_done:
  s_branch L_cexit
L_w4:
  v_mov_b64 v[20:21], 0
  v_mov_b64 v[22:23], 0
  v_mov_b64 v[24:25], 0
  v_mov_b64 v[26:27], 0
  v_mov_b64 v[28:29], 0
  v_mov_b64 v[30:31], 0
  v_mov_b64 v[32:33], 0
  v_mov_b64 v[34:35], 0
  s_mov_b32 s78, 0x3f803f80
  s_mov_b32 s79, s78
  s_mov_b32 s65, 360448
  s_mov_b32 m0, 16128
  s_lshl_b32 s71, s53, 2
  s_add_u32 s71, s71, 128
  s_movk_i32 s56, 0x1000
  v_lshlrev_b32 v73, 2, v76
  v_mov_b32 v72, 0
  s_mov_b64 s[16:17], s[8:9]
  s_mov_b32 s18, 268435456
  s_mov_b32 s19, 0x20000
  s_getpc_b64 s[20:21]
Cs0_pc:
  s_add_u32 s20, s20, (Cs0_last - Cs0_pc)
  s_addc_u32 s21, s21, 0
  v_mov_b32 v68, 14880
  buffer_load_dwordx4 v[52:55], v76, s[8:11], s59 offen offset:0 sc1
  buffer_load_dwordx4 v[56:59], v76, s[8:11], s59 offen offset:1024 sc1
  ds_read_b128 v[36:39], v76 offset:16384
  ds_read_b128 v[40:43], v76 offset:17408
  ds_read_b128 v[60:63], v76 offset:18432
  ds_read_b128 v[64:67], v76 offset:19456
  ds_read_b128 v[0:3], v76 offset:4608
  ds_read_b128 v[4:7], v76 offset:5632
  ds_read_b128 v[8:11], v76 offset:6656
  ds_read_b128 v[12:15], v76 offset:7680
  s_waitcnt lgkmcnt(0)
  s_cmp_eq_u32 s66, 1
  s_branch Cs0_top2
.p2align 6
Cs0_h2:
  ds_read_b128 v[36:39], v76 offset:16384
  v_mov_b64 v[20:21], 0
  v_mov_b64 v[22:23], 0
  v_mov_b64 v[24:25], 0
  v_mov_b64 v[26:27], 0
  v_mov_b32 v68, 14880
  ds_read_b128 v[40:43], v76 offset:17408
  s_cmp_eq_u32 s66, 62
  s_cselect_b64 s[16:17], s[20:21], s[16:17]
  s_cselect_b32 s18, (Cs0_done - Cs0_last), s18
  s_cselect_b32 s70, 0, s70
  s_cmp_eq_u32 s66, 63
  s_cselect_b32 s59, 268435456, s59
  s_cselect_b32 s58, 268435456, s58
  ds_read_b128 v[60:63], v76 offset:18432
  v_lshlrev_b32 v73, 2, v76
  s_cmp_eq_u32 s66, 12
  s_cselect_b32 s56, s71, 0x1000
  ds_read_b32 v72, v76 offset:16128
  s_cmp_eq_u32 s66, 13
  s_cselect_b32 s54, 0x700, 0
  s_waitcnt lgkmcnt(0)
  v_readfirstlane_b32 s57, v72
  s_nop 0
  s_cmp_lt_u32 s57, s54
  s_cbranch_scc1 Cs0_kv3
Cs0_kvb:
  buffer_load_dwordx4 v[52:55], v76, s[8:11], s59 offen offset:0 sc1
  buffer_load_dwordx4 v[56:59], v76, s[8:11], s59 offen offset:1024 sc1
  s_waitcnt vmcnt(0)
  s_mov_b64 vcc, -1
Cs0_h2r:
  s_mov_b64 exec, vcc
  buffer_load_dwordx4 v[0:3], v76, s[8:11], s65 offen offset:0 sc1
  buffer_load_dwordx4 v[4:7], v76, s[8:11], s85 offen offset:0 sc1
  s_mov_b64 exec, -1
  s_add_u32 s67, s67, 1
  s_cmp_lt_u32 s67, 131072
  s_cselect_b32 s54, -2, -1
  s_waitcnt vmcnt(1)
  v_max3_u32 v72, v0, v1, v2
  s_waitcnt vmcnt(0)
  v_max3_u32 v72, v72, v3, v4
  v_max3_u32 v72, v72, v5, v6
  v_max_u32 v72, v72, v7
  v_cmp_lt_u32 vcc, s54, v72
  s_cbranch_vccnz Cs0_h2r
  ds_write_b128 v76, v[0:3] offset:4608
  ds_write_b128 v76, v[4:7] offset:10752
Cs0_h2w:
  s_cmp_eq_u32 s66, 63
  s_waitcnt lgkmcnt(0)
  s_barrier
  ds_read_b128 v[8:11], v76 offset:6656
Cs0_top2:
  v_smfmac_f32_16x16x64_bf16 v[20:23], v[0:3], v[80:87], v74
  s_cbranch_scc1 Cs0_last
  v_smfmac_f32_16x16x64_bf16 v[28:31], v[0:3], v[36:43], v74
  buffer_load_dwordx4 v[44:47], v76, s[8:11], s58 offen offset:0 sc1
  s_mov_b32 m0, 16128
  v_smfmac_f32_16x16x64_bf16 v[24:27], v[0:3], v[88:95], v74
  buffer_load_dwordx4 v[48:51], v76, s[8:11], s58 offen offset:1024 sc1
  v_smfmac_f32_16x16x64_bf16 v[32:35], v[0:3], v[60:67], v74
  ds_read_b128 v[4:7], v76 offset:5632
  s_waitcnt lgkmcnt(1)
  v_smfmac_f32_16x16x64_bf16 v[20:23], v[8:11], v[112:119], v74
  ds_read_b128 v[12:15], v76 offset:7680
  v_smfmac_f32_16x16x64_bf16 v[24:27], v[8:11], v[120:127], v74
  ds_read_b128 v[36:39], v76 offset:32768
  v_smfmac_f32_16x16x64_bf16 v[28:31], v[8:11], v[208:215], v74
  buffer_store_dwordx4 v[16:19], v76, s[8:11], s68 offen sc1
  ds_read_b128 v[40:43], v76 offset:33792
  v_smfmac_f32_16x16x64_bf16 v[32:35], v[8:11], v[216:223], v74
  buffer_load_dword v73, s[16:19], s70 offen lds
  ds_read_b128 v[60:63], v76 offset:34816
  s_waitcnt lgkmcnt(4)
  v_smfmac_f32_16x16x64_bf16 v[20:23], v[4:7], v[96:103], v74
  ds_read_b128 v[64:67], v76 offset:35840
  v_smfmac_f32_16x16x64_bf16 v[24:27], v[4:7], v[104:111], v74
  s_waitcnt vmcnt(4)
  s_waitcnt lgkmcnt(4)
  v_smfmac_f32_16x16x64_bf16 v[20:23], v[12:15], v[128:135], v74
  s_barrier
  ds_read_b128 v[0:3], v76 offset:8704
  s_waitcnt lgkmcnt(3)
  v_smfmac_f32_16x16x64_bf16 v[28:31], v[4:7], v[36:43], v74
  ds_read_b128 v[36:39], v76 offset:49152
  v_smfmac_f32_16x16x64_bf16 v[24:27], v[12:15], v[136:143], v74
  ds_read_b128 v[40:43], v76 offset:50176
  s_waitcnt lgkmcnt(3)
  v_smfmac_f32_16x16x64_bf16 v[32:35], v[4:7], v[60:67], v74
  ds_read_b128 v[8:11], v76 offset:9728
  v_smfmac_f32_16x16x64_bf16 v[28:31], v[12:15], v[224:231], v74
  ds_read_b128 v[60:63], v76 offset:51200
  v_smfmac_f32_16x16x64_bf16 v[32:35], v[12:15], v[232:239], v74
  ds_read_b128 v[64:67], v76 offset:52224
  s_waitcnt lgkmcnt(5)
  v_smfmac_f32_16x16x64_bf16 v[20:23], v[0:3], v[144:151], v74
  s_barrier
  ds_read_b128 v[4:7], v76 offset:11776
  s_waitcnt lgkmcnt(4)
  v_smfmac_f32_16x16x64_bf16 v[28:31], v[0:3], v[36:43], v74
  ds_read_b128 v[12:15], v76 offset:12800
  ds_read_b128 v[36:39], v75 offset:0
  v_smfmac_f32_16x16x64_bf16 v[24:27], v[0:3], v[152:159], v74
  ds_read_b128 v[16:19], v76 offset:10752
  s_waitcnt lgkmcnt(6)
  v_smfmac_f32_16x16x64_bf16 v[20:23], v[8:11], v[160:167], v74
  ds_read_b128 v[40:43], v75 offset:1024
  s_waitcnt lgkmcnt(5)
  v_smfmac_f32_16x16x64_bf16 v[32:35], v[0:3], v[60:67], v74
  ds_read_b128 v[60:63], v75 offset:2048
  v_smfmac_f32_16x16x64_bf16 v[24:27], v[8:11], v[168:175], v74
  ds_read_b128 v[64:67], v75 offset:3072
  s_waitcnt lgkmcnt(6)
  v_smfmac_f32_16x16x64_bf16 v[20:23], v[4:7], v[176:183], v74
  buffer_load_dword off, s[12:15], s56 sc1 lds
  s_waitcnt lgkmcnt(5)
  v_smfmac_f32_16x16x64_bf16 v[20:23], v[12:15], v[192:199], v74
  s_waitcnt lgkmcnt(2)
  v_smfmac_f32_16x16x64_bf16 v[20:23], v[16:19], v[36:43], v74
  ds_read_b128 v[36:39], v75 offset:16384
  v_smfmac_f32_16x16x64_bf16 v[24:27], v[4:7], v[184:191], v74
  ds_read_b128 v[40:43], v75 offset:17408
  s_waitcnt lgkmcnt(2)
  v_smfmac_f32_16x16x64_bf16 v[24:27], v[16:19], v[60:67], v74
  ds_read_b128 v[60:63], v75 offset:18432
  v_add_f32 v20, v20, v22
  v_smfmac_f32_16x16x64_bf16 v[24:27], v[12:15], v[200:207], v74
  ds_read_b128 v[64:67], v75 offset:19456
  v_add_f32 v21, v21, v23
  v_smfmac_f32_16x16x64_bf16 v[28:31], v[16:19], v[240:247], v74
  v_mov_b64 v[70:71], s[78:79]
  v_smfmac_f32_16x16x64_bf16 v[28:31], v[4:7], a[0:7], v74
  s_waitcnt lgkmcnt(2)
  v_add_f32 v24, v24, v26
  v_smfmac_f32_16x16x64_bf16 v[28:31], v[8:11], v[36:43], v74
  ds_read_b128 v[36:39], v68
  v_cvt_pk_bf16_f32 v22, v20, v24
  v_smfmac_f32_16x16x64_bf16 v[28:31], v[12:15], a[16:23], v74
  ds_read_b128 v[40:43], v68
  ds_write_b32 v79, v22 offset:0
  s_waitcnt lgkmcnt(3)
  v_add_f32 v25, v25, v27
  v_cvt_pk_bf16_f32 v23, v21, v25
  v_smfmac_f32_16x16x64_bf16 v[32:35], v[8:11], v[60:67], v74
  ds_write_b32 v79, v23 offset:576
  v_cmp_u_f32 vcc, v20, v21
  v_smfmac_f32_16x16x64_bf16 v[32:35], v[16:19], v[248:255], v74
  v_add_f32 v28, v28, v30
  v_smfmac_f32_16x16x64_bf16 v[32:35], v[4:7], a[8:15], v74
  v_add_f32 v29, v29, v31
  v_smfmac_f32_16x16x64_bf16 v[32:35], v[12:15], a[24:31], v74
  s_cbranch_vccnz Cs0_rec
Cs0_recok:
  s_waitcnt lgkmcnt(3)
  v_smfmac_f32_16x16x64_bf16 v[36:39], v[16:19], a[128:135], v74
  s_waitcnt lgkmcnt(0)
  s_barrier
  ds_read_b128 v[60:63], v77
  v_smfmac_f32_16x16x64_bf16 v[40:43], v[16:19], a[136:143], v74
  ds_read_b128 v[64:67], v77 offset:128
  v_add_f32 v32, v32, v34
  v_cvt_pk_bf16_f32 v30, v28, v32
  v_smfmac_f32_16x16x64_bf16 v[36:39], v[0:3], a[96:103], v74
  ds_write_b32 v79, v30 offset:256
  v_add_f32 v33, v33, v35
  v_cvt_pk_bf16_f32 v31, v29, v33
  v_smfmac_f32_16x16x64_bf16 v[40:43], v[0:3], a[104:111], v74
  ds_write_b32 v79, v31 offset:832
  v_xor_b32 v75, 0x8000, v75
  v_smfmac_f32_16x16x64_bf16 v[36:39], v[4:7], a[144:151], v74
  ds_read_b128 v[0:3], v76 offset:4608
  v_mov_b32 v29, 0
  v_smfmac_f32_16x16x64_bf16 v[40:43], v[4:7], a[152:159], v74
  s_waitcnt vmcnt(3) lgkmcnt(3)
  v_mov_b32 v30, 0
  v_mfma_f32_16x16x32_bf16 v[44:47], v[44:47], v[60:63], 0
  ds_read_b128 v[4:7], v76 offset:5632
  s_waitcnt lgkmcnt(2)
  v_mfma_f32_16x16x32_bf16 v[44:47], v[48:51], v[64:67], v[44:47]
  s_barrier
  v_smfmac_f32_16x16x64_bf16 v[36:39], v[8:11], a[112:119], v74
  ds_read_b128 v[20:23], v77 offset:256
  ds_read_b128 v[24:27], v77 offset:384
  v_smfmac_f32_16x16x64_bf16 v[40:43], v[8:11], a[120:127], v74
  ds_read_b128 v[8:11], v76 offset:6656
  v_add_f32_dpp v72, v46, v44 quad_perm:[2,3,0,1] row_mask:0xf bank_mask:0xf
  v_add_f32_dpp v73, v47, v45 quad_perm:[2,3,0,1] row_mask:0xf bank_mask:0xf
  v_smfmac_f32_16x16x64_bf16 v[36:39], v[12:15], a[160:167], v74
  s_waitcnt lgkmcnt(4)
  v_exp_f32_dpp v72, v72 quad_perm:[0,1,0,1] row_mask:0xf bank_mask:0xf
  v_smfmac_f32_16x16x64_bf16 v[40:43], v[12:15], a[168:175], v74
  ds_read_b128 v[12:15], v76 offset:7680
  v_exp_f32_dpp v73, v73 quad_perm:[0,1,0,1] row_mask:0xf bank_mask:0xf
  v_smfmac_f32_16x16x64_bf16 v[36:39], v[0:3], a[32:39], v74
  s_waitcnt lgkmcnt(2)
  v_cvt_pk_bf16_f32 v72, v72, v73
  v_mfma_f32_16x16x32_bf16 v[20:23], v[20:23], v[60:63], 0
  ds_write_b32 v78, v72 offset:512
  v_mov_b64 v[16:17], 0
  v_mfma_f32_16x16x32_bf16 v[20:23], v[24:27], v[64:67], v[20:23]
  ds_read_b128 v[44:47], v75 offset:16384
  v_mov_b64 v[18:19], 0
  v_smfmac_f32_16x16x64_bf16 v[40:43], v[0:3], a[40:47], v74
  ds_read_b128 v[48:51], v75 offset:17408
  v_mov_b64 v[68:69], s[78:79]
  v_smfmac_f32_16x16x64_bf16 v[36:39], v[4:7], a[48:55], v74
  s_waitcnt lgkmcnt(4)
  v_add_f32_dpp v24, v22, v20 quad_perm:[2,3,0,1] row_mask:0xf bank_mask:0xf
  v_add_f32_dpp v25, v23, v21 quad_perm:[2,3,0,1] row_mask:0xf bank_mask:0xf
  v_smfmac_f32_16x16x64_bf16 v[36:39], v[8:11], a[64:71], v74
  s_waitcnt lgkmcnt(2)
  s_barrier
  ds_read_b128 v[32:35], v78 offset:512
  v_smfmac_f32_16x16x64_bf16 v[36:39], v[12:15], a[80:87], v74
  ds_read_b128 v[60:63], v75 offset:18432
  v_mul_f32 v24, s69, v24
  v_smfmac_f32_16x16x64_bf16 v[40:43], v[4:7], a[56:63], v74
  ds_read_b128 v[64:67], v75 offset:19456
  v_mul_f32 v25, s69, v25
  v_smfmac_f32_16x16x64_bf16 v[40:43], v[8:11], a[72:79], v74
  v_exp_f32_dpp v24, v24 quad_perm:[0,1,0,1] row_mask:0xf bank_mask:0xf
  v_smfmac_f32_16x16x64_bf16 v[40:43], v[12:15], a[88:95], v74
  s_waitcnt lgkmcnt(2)
  v_exp_f32_dpp v25, v25 quad_perm:[0,1,0,1] row_mask:0xf bank_mask:0xf
  v_mfma_f32_16x16x32_bf16 v[8:11], v[32:35], v[68:71], 0
  v_add_f32 v36, v36, v38
  v_add_f32 v37, v37, v39
  v_mfma_f32_16x16x32_bf16 v[0:3], v[32:35], v[52:55], 0
  v_add_f32 v40, v40, v42
  v_add_f32 v41, v41, v43
  v_mfma_f32_16x16x32_bf16 v[4:7], v[32:35], v[56:59], 0
  v_cvt_pk_bf16_f32 v28, v24, v25
  v_cvt_pk_bf16_f32 v72, v36, v37
  v_cvt_pk_bf16_f32 v73, v40, v41
  v_mfma_f32_16x16x16_bf16 v[8:11], v[28:29], v[68:69], v[8:11]
  v_cvt_pk_bf16_f32 v31, v24, v25
  v_mov_b64 v[20:21], 0
  v_mfma_f32_16x16x16_bf16 v[0:3], v[28:29], v[72:73], v[0:3]
  ds_read_b128 v[52:55], v75 offset:32768
  v_mov_b64 v[22:23], 0
  v_mfma_f32_16x16x16_bf16 v[4:7], v[30:31], v[72:73], v[4:7]
  v_rcp_f32 v10, v8
  v_rcp_f32 v11, v9
  v_mul_f32 v0, v10, v0
  v_mul_f32 v1, v11, v1
  v_max3_f32 v8, v8, v9, v10
  v_mul_f32 v4, v10, v4
  v_mul_f32 v5, v11, v5
  v_cvt_pk_bf16_f32 v2, v0, v4
  ds_write_b32 v79, v2 offset:8704
  v_cvt_pk_bf16_f32 v3, v1, v5
  ds_write_b32 v79, v3 offset:9280
  ds_read_b128 v[12:15], v78 offset:8704
  v_max_f32 v8, v8, v11
  v_cmp_le_f32 vcc, 1317011456, v8
  v_mov_b64 v[24:25], 0
  v_mov_b64 v[26:27], 0
  ds_read_b128 v[56:59], v75 offset:33792
  s_cbranch_vccnz Cs0_mx
Cs0_mxok:
  s_waitcnt lgkmcnt(2)
  s_barrier
  ds_read_b128 v[0:3], v78 offset:8768
  s_waitcnt lgkmcnt(2)
  v_smfmac_f32_16x16x64_bf16 v[16:19], v[12:15], v[44:51], v74
  ds_read_b128 v[4:7], v78 offset:8832
  v_smfmac_f32_16x16x64_bf16 v[20:23], v[12:15], a[192:199], v74
  ds_read_b128 v[8:11], v78 offset:8896
  v_smfmac_f32_16x16x64_bf16 v[24:27], v[12:15], a[208:215], v74
  ds_read_b128 v[36:39], v75 offset:34816
  s_waitcnt lgkmcnt(3)
  v_smfmac_f32_16x16x64_bf16 v[16:19], v[0:3], v[60:67], v74
  ds_read_b128 v[40:43], v75 offset:35840
  s_waitcnt lgkmcnt(3)
  v_smfmac_f32_16x16x64_bf16 v[16:19], v[4:7], a[176:183], v74
  ds_read_b128 v[68:71], v76 offset:13824
  s_waitcnt lgkmcnt(3)
  v_smfmac_f32_16x16x64_bf16 v[16:19], v[8:11], a[184:191], v74
  ds_read_b128 v[44:47], v75 offset:49152
  v_smfmac_f32_16x16x64_bf16 v[20:23], v[0:3], a[200:207], v74
  ds_read_b128 v[48:51], v75 offset:50176
  v_smfmac_f32_16x16x64_bf16 v[20:23], v[4:7], v[52:59], v74
  ds_read_b128 v[60:63], v75 offset:51200
  s_waitcnt lgkmcnt(4)
  v_cvt_pk_bf16_f32 v16, v16, v17
  v_cvt_pk_bf16_f32 v17, v18, v19
  v_bfi_b32 v16, 1, s72, v16
  v_smfmac_f32_16x16x64_bf16 v[20:23], v[8:11], v[36:43], v74
  s_waitcnt lgkmcnt(3)
  buffer_store_dwordx2 v[16:17], v68, s[8:11], s73 offen sc1
  v_mov_b64 v[32:33], 0
  v_smfmac_f32_16x16x64_bf16 v[24:27], v[0:3], a[216:223], v74
  ds_read_b128 v[64:67], v75 offset:52224
  v_mov_b64 v[34:35], 0
  v_smfmac_f32_16x16x64_bf16 v[24:27], v[4:7], a[224:231], v74
  v_cvt_pk_bf16_f32 v20, v20, v21
  v_cvt_pk_bf16_f32 v21, v22, v23
  v_bfi_b32 v20, 1, s72, v20
  v_smfmac_f32_16x16x64_bf16 v[24:27], v[8:11], a[232:239], v74
  buffer_store_dwordx2 v[20:21], v68, s[8:11], s74 offen sc1
  s_waitcnt lgkmcnt(2)
  v_smfmac_f32_16x16x64_bf16 v[32:35], v[12:15], v[44:51], v74
  s_waitcnt lgkmcnt(0)
  v_smfmac_f32_16x16x64_bf16 v[32:35], v[0:3], v[60:67], v74
  v_cvt_pk_bf16_f32 v24, v24, v25
  v_cvt_pk_bf16_f32 v25, v26, v27
  v_bfi_b32 v24, 1, s72, v24
  v_smfmac_f32_16x16x64_bf16 v[32:35], v[4:7], a[240:247], v74
  buffer_store_dwordx2 v[24:25], v68, s[8:11], s75 offen sc1
  v_smfmac_f32_16x16x64_bf16 v[32:35], v[8:11], a[248:255], v74
  v_mov_b64 v[18:19], v[72:73]
  s_nop 4
  v_cvt_pk_bf16_f32 v32, v32, v33
  v_cvt_pk_bf16_f32 v33, v34, v35
  v_bfi_b32 v32, 1, s72, v32
  buffer_store_dwordx2 v[32:33], v68, s[8:11], s76 offen sc1
  ds_read_b128 v[0:3], v76 offset:14848
  s_waitcnt lgkmcnt(0)
  ds_read_b64 v[16:17], v77 offset:256
  s_waitcnt lgkmcnt(0)
  ds_read_b128 v[64:67], v76 offset:19456
  s_waitcnt lgkmcnt(0)
  v_xor_b32 v75, 0x8000, v75
  v_mov_b64 v[28:29], 0
  v_mov_b64 v[30:31], 0
  v_mov_b64 v[32:33], 0
  v_mov_b64 v[34:35], 0
  s_waitcnt vmcnt(0)
  buffer_load_dwordx4 v[52:55], v76, s[8:11], s60 offen offset:0 sc1
  buffer_load_dwordx4 v[56:59], v76, s[8:11], s60 offen offset:1024 sc1
  s_add_u32 s66, s66, 1
  s_xor_b32 s64, s64, 16384
  s_xor_b32 s65, s65, 16384
  s_add_u32 s58, s58, 655360
  s_add_u32 s59, s59, 655360
  s_add_u32 s70, s70, 655360
  s_add_u32 s68, s68, 655360
  s_mov_b32 m0, 10752
  s_add_u32 s85, s65, 6144
  s_waitcnt lgkmcnt(0)
  s_waitcnt vmcnt(1)
  v_mfma_f32_16x16x32_bf16 v[4:7], v[0:3], v[52:55], 0
  v_bitop3_b32 v72, v52, v54, s72 bitop3:0x7e
  s_waitcnt vmcnt(0)
  v_mfma_f32_16x16x32_bf16 v[4:7], v[0:3], v[56:59], v[4:7]
  v_bitop3_b32 v73, v56, v58, s72 bitop3:0x7e
  v_bitop3_b32 v72, v72, v73, 1 bitop3:0xa8
  v_cmp_ne_u32 vcc, 0, v72
  s_cbranch_vccnz Cs0_h1r
  s_nop 2
  v_add_f32_dpp v4, v4, v4 row_ror:4 row_mask:0xf bank_mask:0xf
  v_add_f32_dpp v5, v5, v5 row_ror:4 row_mask:0xf bank_mask:0xf
  s_nop 0
  v_add_f32_dpp v4, v4, v4 row_ror:8 row_mask:0xf bank_mask:0xf
  v_add_f32_dpp v5, v5, v5 row_ror:8 row_mask:0xf bank_mask:0xf
  v_cvt_pk_bf16_f32 v4, v4, v5
  buffer_store_dword v4, v69, s[8:11], s62 offen sc1
  s_xor_b32 s62, s62, 16384
  buffer_store_dword v71, v69, s[8:11], s62 offen sc1
  s_xor_b32 s72, s72, 1
  s_branch Cs0_h2
Cs0_h1r:
  s_mov_b64 exec, vcc
  buffer_load_dwordx4 v[52:55], v76, s[8:11], s60 offen offset:0 sc1
  buffer_load_dwordx4 v[56:59], v76, s[8:11], s60 offen offset:1024 sc1
  s_mov_b64 exec, -1
  s_add_u32 s67, s67, 1
  s_waitcnt vmcnt(1)
  v_mfma_f32_16x16x32_bf16 v[4:7], v[0:3], v[52:55], 0
  v_bitop3_b32 v72, v52, v54, s72 bitop3:0x7e
  s_waitcnt vmcnt(0)
  v_mfma_f32_16x16x32_bf16 v[4:7], v[0:3], v[56:59], v[4:7]
  v_bitop3_b32 v73, v56, v58, s72 bitop3:0x7e
  v_bitop3_b32 v72, v72, v73, 1 bitop3:0xa8
  v_cmp_ne_u32 vcc, 0, v72
  s_cbranch_vccz Cs0_h1p
Cs0_h1s:
  s_mov_b64 exec, vcc
  buffer_load_dwordx4 v[52:55], v76, s[8:11], s60 offen offset:0 sc1
  buffer_load_dwordx4 v[56:59], v76, s[8:11], s60 offen offset:1024 sc1
  s_mov_b64 exec, -1
  s_add_u32 s67, s67, 1
  s_waitcnt vmcnt(1)
  v_mfma_f32_16x16x32_bf16 v[4:7], v[0:3], v[52:55], 0
  v_bitop3_b32 v72, v52, v54, s72 bitop3:0x7e
  s_waitcnt vmcnt(0)
  v_mfma_f32_16x16x32_bf16 v[4:7], v[0:3], v[56:59], v[4:7]
  v_bitop3_b32 v73, v56, v58, s72 bitop3:0x7e
  v_bitop3_b32 v72, v72, v73, 1 bitop3:0xa8
  v_cmp_ne_u32 vcc, 0, v72
  s_cbranch_vccz Cs0_h1p
  s_cmp_lt_u32 s67, 131072
  s_cbranch_scc1 Cs0_h1s
Cs0_h1p:
  s_nop 2
  v_add_f32_dpp v4, v4, v4 row_ror:4 row_mask:0xf bank_mask:0xf
  v_add_f32_dpp v5, v5, v5 row_ror:4 row_mask:0xf bank_mask:0xf
  s_nop 0
  v_add_f32_dpp v4, v4, v4 row_ror:8 row_mask:0xf bank_mask:0xf
  v_add_f32_dpp v5, v5, v5 row_ror:8 row_mask:0xf bank_mask:0xf
  v_cvt_pk_bf16_f32 v4, v4, v5
  buffer_store_dword v4, v69, s[8:11], s62 offen sc1
  s_xor_b32 s62, s62, 16384
  buffer_store_dword v71, v69, s[8:11], s62 offen sc1
  s_xor_b32 s72, s72, 1
  s_branch Cs0_h2
Cs0_rec:
  s_nop 7
  s_waitcnt vmcnt(0) lgkmcnt(0)
  v_max3_u32 v72, v0, v1, v2
  v_max3_u32 v72, v72, v3, v4
  v_max3_u32 v72, v72, v5, v6
  v_max3_u32 v72, v72, v7, v8
  v_max3_u32 v72, v72, v9, v10
  v_max3_u32 v72, v72, v11, v12
  v_max3_u32 v72, v72, v13, v14
  v_max3_u32 v72, v72, v15, v16
  v_max3_u32 v72, v72, v17, v18
  v_max_u32 v72, v72, v19
  v_cmp_eq_u32 vcc, -1, v72
  s_cbranch_vccz Cs0_recok
  s_barrier
  v_mov_b64 v[20:21], 0
  v_mov_b64 v[22:23], 0
  v_mov_b64 v[24:25], 0
  v_mov_b64 v[26:27], 0
  v_mov_b64 v[28:29], 0
  v_mov_b64 v[30:31], 0
  v_mov_b64 v[32:33], 0
  v_mov_b64 v[34:35], 0
  s_waitcnt lgkmcnt(0)
  s_barrier
  ds_read_b128 v[0:3], v76 offset:4608
  s_waitcnt lgkmcnt(0)
  v_smfmac_f32_16x16x64_bf16 v[20:23], v[0:3], v[80:87], v74
  v_smfmac_f32_16x16x64_bf16 v[24:27], v[0:3], v[88:95], v74
  ds_read_b128 v[60:63], v76 offset:16384
  ds_read_b128 v[64:67], v76 offset:17408
  s_waitcnt lgkmcnt(0)
  v_smfmac_f32_16x16x64_bf16 v[28:31], v[0:3], v[60:67], v74
  ds_read_b128 v[60:63], v76 offset:18432
  ds_read_b128 v[64:67], v76 offset:19456
  s_waitcnt lgkmcnt(0)
  v_smfmac_f32_16x16x64_bf16 v[32:35], v[0:3], v[60:67], v74
  ds_read_b128 v[4:7], v76 offset:5632
  s_waitcnt lgkmcnt(0)
  v_smfmac_f32_16x16x64_bf16 v[20:23], v[4:7], v[96:103], v74
  v_smfmac_f32_16x16x64_bf16 v[24:27], v[4:7], v[104:111], v74
  ds_read_b128 v[60:63], v76 offset:32768
  ds_read_b128 v[64:67], v76 offset:33792
  s_waitcnt lgkmcnt(0)
  v_smfmac_f32_16x16x64_bf16 v[28:31], v[4:7], v[60:67], v74
  ds_read_b128 v[60:63], v76 offset:34816
  ds_read_b128 v[64:67], v76 offset:35840
  s_waitcnt lgkmcnt(0)
  v_smfmac_f32_16x16x64_bf16 v[32:35], v[4:7], v[60:67], v74
  ds_read_b128 v[8:11], v76 offset:6656
  s_waitcnt lgkmcnt(0)
  v_smfmac_f32_16x16x64_bf16 v[20:23], v[8:11], v[112:119], v74
  v_smfmac_f32_16x16x64_bf16 v[24:27], v[8:11], v[120:127], v74
  v_smfmac_f32_16x16x64_bf16 v[28:31], v[8:11], v[208:215], v74
  v_smfmac_f32_16x16x64_bf16 v[32:35], v[8:11], v[216:223], v74
  ds_read_b128 v[12:15], v76 offset:7680
  s_waitcnt lgkmcnt(0)
  v_smfmac_f32_16x16x64_bf16 v[20:23], v[12:15], v[128:135], v74
  v_smfmac_f32_16x16x64_bf16 v[24:27], v[12:15], v[136:143], v74
  v_smfmac_f32_16x16x64_bf16 v[28:31], v[12:15], v[224:231], v74
  v_smfmac_f32_16x16x64_bf16 v[32:35], v[12:15], v[232:239], v74
  ds_read_b128 v[0:3], v76 offset:8704
  s_waitcnt lgkmcnt(0)
  v_smfmac_f32_16x16x64_bf16 v[20:23], v[0:3], v[144:151], v74
  v_smfmac_f32_16x16x64_bf16 v[24:27], v[0:3], v[152:159], v74
  ds_read_b128 v[60:63], v76 offset:49152
  ds_read_b128 v[64:67], v76 offset:50176
  s_waitcnt lgkmcnt(0)
  v_smfmac_f32_16x16x64_bf16 v[28:31], v[0:3], v[60:67], v74
  ds_read_b128 v[60:63], v76 offset:51200
  ds_read_b128 v[64:67], v76 offset:52224
  s_waitcnt lgkmcnt(0)
  v_smfmac_f32_16x16x64_bf16 v[32:35], v[0:3], v[60:67], v74
  ds_read_b128 v[8:11], v76 offset:9728
  s_waitcnt lgkmcnt(0)
  v_smfmac_f32_16x16x64_bf16 v[20:23], v[8:11], v[160:167], v74
  v_smfmac_f32_16x16x64_bf16 v[24:27], v[8:11], v[168:175], v74
  ds_read_b128 v[60:63], v75 offset:16384
  ds_read_b128 v[64:67], v75 offset:17408
  s_waitcnt lgkmcnt(0)
  v_smfmac_f32_16x16x64_bf16 v[28:31], v[8:11], v[60:67], v74
  ds_read_b128 v[60:63], v75 offset:18432
  ds_read_b128 v[64:67], v75 offset:19456
  s_waitcnt lgkmcnt(0)
  v_smfmac_f32_16x16x64_bf16 v[32:35], v[8:11], v[60:67], v74
  ds_read_b128 v[16:19], v76 offset:10752
  ds_read_b128 v[60:63], v75 offset:0
  ds_read_b128 v[64:67], v75 offset:1024
  s_waitcnt lgkmcnt(0)
  v_smfmac_f32_16x16x64_bf16 v[20:23], v[16:19], v[60:67], v74
  ds_read_b128 v[60:63], v75 offset:2048
  ds_read_b128 v[64:67], v75 offset:3072
  s_waitcnt lgkmcnt(0)
  v_smfmac_f32_16x16x64_bf16 v[24:27], v[16:19], v[60:67], v74
  v_smfmac_f32_16x16x64_bf16 v[28:31], v[16:19], v[240:247], v74
  v_smfmac_f32_16x16x64_bf16 v[32:35], v[16:19], v[248:255], v74
  ds_read_b128 v[4:7], v76 offset:11776
  s_waitcnt lgkmcnt(0)
  v_smfmac_f32_16x16x64_bf16 v[20:23], v[4:7], v[176:183], v74
  v_smfmac_f32_16x16x64_bf16 v[24:27], v[4:7], v[184:191], v74
  v_smfmac_f32_16x16x64_bf16 v[28:31], v[4:7], a[0:7], v74
  v_smfmac_f32_16x16x64_bf16 v[32:35], v[4:7], a[8:15], v74
  ds_read_b128 v[12:15], v76 offset:12800
  s_waitcnt lgkmcnt(0)
  v_smfmac_f32_16x16x64_bf16 v[20:23], v[12:15], v[192:199], v74
  v_smfmac_f32_16x16x64_bf16 v[24:27], v[12:15], v[200:207], v74
  v_smfmac_f32_16x16x64_bf16 v[28:31], v[12:15], a[16:23], v74
  v_smfmac_f32_16x16x64_bf16 v[32:35], v[12:15], a[24:31], v74
  v_add_f32 v20, v20, v22
  v_add_f32 v21, v21, v23
  v_add_f32 v24, v24, v26
  v_cvt_pk_bf16_f32 v22, v20, v24
  ds_write_b32 v79, v22 offset:0
  v_add_f32 v25, v25, v27
  v_cvt_pk_bf16_f32 v23, v21, v25
  ds_write_b32 v79, v23 offset:576
  v_add_f32 v28, v28, v30
  v_add_f32 v29, v29, v31
  s_waitcnt lgkmcnt(0)
  s_nop 1
  s_branch Cs0_recok
Cs0_mx:
  s_waitcnt lgkmcnt(0)
  s_barrier
  buffer_load_dwordx4 v[52:55], v76, s[8:11], s59 offen offset:0 sc1
  buffer_load_dwordx4 v[0:3], v76, s[8:11], s58 offen offset:0 sc1
  ds_read_b128 v[20:23], v77 offset:0
  ds_read_b128 v[28:31], v77 offset:256
  buffer_load_dwordx4 v[56:59], v76, s[8:11], s59 offen offset:1024 sc1
  buffer_load_dwordx4 v[4:7], v76, s[8:11], s58 offen offset:1024 sc1
  ds_read_b128 v[24:27], v77 offset:128
  ds_read_b128 v[32:35], v77 offset:384
  s_waitcnt vmcnt(2) lgkmcnt(3)
  v_mfma_f32_16x16x32_bf16 v[8:11], v[0:3], v[20:23], 0
  s_waitcnt vmcnt(0) lgkmcnt(1)
  v_mfma_f32_16x16x32_bf16 v[8:11], v[4:7], v[24:27], v[8:11]
  v_mfma_f32_16x16x32_bf16 v[12:15], v[28:31], v[20:23], 0
  s_waitcnt lgkmcnt(0)
  v_mfma_f32_16x16x32_bf16 v[12:15], v[32:35], v[24:27], v[12:15]
  v_add_f32_dpp v8, v10, v8 quad_perm:[2,3,0,1] row_mask:0xf bank_mask:0xf
  v_add_f32_dpp v9, v11, v9 quad_perm:[2,3,0,1] row_mask:0xf bank_mask:0xf
  s_nop 0
  v_mov_b32_dpp v8, v8 quad_perm:[0,1,0,1] row_mask:0xf bank_mask:0xf
  v_mov_b32_dpp v9, v9 quad_perm:[0,1,0,1] row_mask:0xf bank_mask:0xf
  s_nop 1
  v_add_f32_dpp v12, v14, v12 quad_perm:[2,3,0,1] row_mask:0xf bank_mask:0xf
  v_add_f32_dpp v13, v15, v13 quad_perm:[2,3,0,1] row_mask:0xf bank_mask:0xf
  s_nop 0
  v_mov_b32_dpp v12, v12 quad_perm:[0,1,0,1] row_mask:0xf bank_mask:0xf
  v_mov_b32_dpp v13, v13 quad_perm:[0,1,0,1] row_mask:0xf bank_mask:0xf
  v_mul_f32 v12, s69, v12
  ds_write_b32 v78, v8 offset:8704
  v_mul_f32 v13, s69, v13
  ds_write_b32 v78, v9 offset:8768
  s_waitcnt lgkmcnt(0)
  s_barrier
  ds_read_b128 v[36:39], v78 offset:8704
  ds_read_b128 v[40:43], v78 offset:8768
  s_waitcnt lgkmcnt(0)
  s_barrier
  v_max_f32 v16, v36, v37
  v_max3_f32 v16, v16, v38, v39
  v_max3_f32 v16, v16, v40, v41
  v_max3_f32 v16, v16, v42, v43
  v_max3_f32 v16, v16, v12, v13
  v_mov_b32 v17, v16
  s_nop 1
  v_permlane16_swap_b32 v16, v17
  v_max_f32 v16, v16, v17
  v_mov_b32 v17, v16
  s_nop 1
  v_permlane32_swap_b32 v16, v17
  v_max_f32 v16, v16, v17
  v_sub_f32 v36, v36, v16
  v_sub_f32 v37, v37, v16
  v_sub_f32 v38, v38, v16
  v_sub_f32 v39, v39, v16
  v_sub_f32 v40, v40, v16
  v_sub_f32 v41, v41, v16
  v_sub_f32 v42, v42, v16
  v_sub_f32 v43, v43, v16
  v_sub_f32 v12, v12, v16
  v_sub_f32 v13, v13, v16
  v_exp_f32 v36, v36
  v_exp_f32 v37, v37
  v_exp_f32 v38, v38
  v_exp_f32 v39, v39
  v_exp_f32 v40, v40
  v_exp_f32 v41, v41
  v_exp_f32 v42, v42
  v_exp_f32 v43, v43
  v_exp_f32 v12, v12
  v_exp_f32 v13, v13
  v_cvt_pk_bf16_f32 v32, v36, v40
  v_cvt_pk_bf16_f32 v33, v37, v41
  v_cvt_pk_bf16_f32 v34, v38, v42
  v_cvt_pk_bf16_f32 v35, v39, v43
  v_cvt_pk_bf16_f32 v28, v12, v13
  v_cvt_pk_bf16_f32 v31, v12, v13
  v_mov_b32 v29, 0
  v_mov_b32 v30, 0
  v_mfma_f32_16x16x32_bf16 v[8:11], v[32:35], v[68:71], 0
  v_mfma_f32_16x16x32_bf16 v[0:3], v[32:35], v[52:55], 0
  v_mfma_f32_16x16x32_bf16 v[4:7], v[32:35], v[56:59], 0
  v_mfma_f32_16x16x16_bf16 v[8:11], v[28:29], v[68:69], v[8:11]
  v_mfma_f32_16x16x16_bf16 v[0:3], v[28:29], v[72:73], v[0:3]
  v_mfma_f32_16x16x16_bf16 v[4:7], v[30:31], v[72:73], v[4:7]
  ds_read_b128 v[52:55], v75 offset:32768
  v_rcp_f32 v10, v8
  v_rcp_f32 v11, v9
  v_mul_f32 v0, v10, v0
  v_mul_f32 v1, v11, v1
  v_max3_f32 v8, v8, v9, v10
  v_mul_f32 v4, v10, v4
  v_mul_f32 v5, v11, v5
  v_cvt_pk_bf16_f32 v2, v0, v4
  ds_write_b32 v79, v2 offset:8704
  v_cvt_pk_bf16_f32 v3, v1, v5
  ds_write_b32 v79, v3 offset:9280
  ds_read_b128 v[12:15], v78 offset:8704
  ds_read_b128 v[56:59], v75 offset:33792
  v_mov_b64 v[16:17], 0
  v_mov_b64 v[18:19], 0
  v_mov_b64 v[20:21], 0
  v_mov_b64 v[22:23], 0
  v_mov_b64 v[24:25], 0
  v_mov_b64 v[26:27], 0
  s_branch Cs0_mxok
Cs0_kv3:
  s_waitcnt lgkmcnt(0)
  s_cmp_ge_u32 s57, 0x700
  s_cbranch_scc1 Cs0_kvb
  s_load_dword s57, s[12:13], s71 glc
  s_add_u32 s67, s67, 1
  s_cmp_lt_u32 s67, 131072
  s_cbranch_scc1 Cs0_kv3
  s_waitcnt lgkmcnt(0)
  s_branch Cs0_kvb
Cs0_last:
  ds_read_b128 v[4:7], v76 offset:5632
  ds_read_b128 v[12:15], v76 offset:7680
  ds_read_b128 v[44:47], v76 offset:32768
  ds_read_b128 v[48:51], v76 offset:33792
  s_nop 5
  v_mov_b64 v[20:21], 0
  v_mov_b64 v[22:23], 0
  v_mov_b64 v[24:25], 0
  v_mov_b64 v[26:27], 0
  v_smfmac_f32_16x16x64_bf16 v[28:31], v[0:3], v[36:43], v74
  ds_read_b128 v[36:39], v76 offset:34816
  ds_read_b128 v[40:43], v76 offset:35840
  v_smfmac_f32_16x16x64_bf16 v[32:35], v[0:3], v[60:67], v74
  s_waitcnt lgkmcnt(5)
  v_smfmac_f32_16x16x64_bf16 v[20:23], v[0:3], a[32:39], v74
  ds_read_b128 v[60:63], v76 offset:49152
  ds_read_b128 v[64:67], v76 offset:50176
  v_smfmac_f32_16x16x64_bf16 v[24:27], v[0:3], a[40:47], v74
  s_waitcnt lgkmcnt(4)
  v_smfmac_f32_16x16x64_bf16 v[20:23], v[4:7], a[48:55], v74
  buffer_store_dwordx4 v[16:19], v76, s[8:11], s68 offen sc1
  v_smfmac_f32_16x16x64_bf16 v[24:27], v[4:7], a[56:63], v74
  v_smfmac_f32_16x16x64_bf16 v[28:31], v[4:7], v[44:51], v74
  s_waitcnt lgkmcnt(2)
  v_smfmac_f32_16x16x64_bf16 v[20:23], v[8:11], a[64:71], v74
  ds_read_b128 v[44:47], v76 offset:51200
  ds_read_b128 v[48:51], v76 offset:52224
  v_smfmac_f32_16x16x64_bf16 v[24:27], v[8:11], a[72:79], v74
  v_smfmac_f32_16x16x64_bf16 v[32:35], v[4:7], v[36:43], v74
  v_smfmac_f32_16x16x64_bf16 v[28:31], v[8:11], v[208:215], v74
  ds_read_b128 v[36:39], v75 offset:16384
  ds_read_b128 v[40:43], v75 offset:17408
  v_smfmac_f32_16x16x64_bf16 v[32:35], v[8:11], v[216:223], v74
  v_smfmac_f32_16x16x64_bf16 v[20:23], v[12:15], a[80:87], v74
  v_smfmac_f32_16x16x64_bf16 v[24:27], v[12:15], a[88:95], v74
  v_smfmac_f32_16x16x64_bf16 v[28:31], v[12:15], v[224:231], v74
  v_smfmac_f32_16x16x64_bf16 v[32:35], v[12:15], v[232:239], v74
  s_waitcnt vmcnt(1)
  s_barrier
Cs0_lastr:
  ds_read_b128 v[0:3], v76 offset:8704
  ds_read_b128 v[8:11], v76 offset:9728
  ds_read_b128 v[16:19], v76 offset:10752
  ds_read_b128 v[4:7], v76 offset:11776
  ds_read_b128 v[12:15], v76 offset:12800
  s_waitcnt lgkmcnt(4)
  v_max3_u32 v72, v0, v1, v2
  s_waitcnt lgkmcnt(1)
  v_max3_u32 v72, v72, v3, v4
  v_max3_u32 v72, v72, v5, v6
  v_max3_u32 v72, v72, v7, v8
  v_max3_u32 v72, v72, v9, v10
  s_waitcnt lgkmcnt(0)
  v_max3_u32 v72, v72, v11, v12
  v_max3_u32 v72, v72, v13, v14
  v_max3_u32 v72, v72, v15, v16
  v_max3_u32 v72, v72, v17, v18
  v_max_u32 v72, v72, v19
  v_cmp_eq_u32 vcc, -1, v72
  s_cbranch_vccnz Cs0_lastp
Cs0_lastg:
  v_smfmac_f32_16x16x64_bf16 v[28:31], v[0:3], v[60:67], v74
  ds_read_b128 v[60:63], v75 offset:18432
  ds_read_b128 v[64:67], v75 offset:19456
  v_smfmac_f32_16x16x64_bf16 v[32:35], v[0:3], v[44:51], v74
  v_smfmac_f32_16x16x64_bf16 v[28:31], v[8:11], v[36:43], v74
  v_smfmac_f32_16x16x64_bf16 v[28:31], v[16:19], v[240:247], v74
  v_smfmac_f32_16x16x64_bf16 v[28:31], v[4:7], a[0:7], v74
  v_smfmac_f32_16x16x64_bf16 v[28:31], v[12:15], a[16:23], v74
  v_smfmac_f32_16x16x64_bf16 v[32:35], v[16:19], v[248:255], v74
  v_smfmac_f32_16x16x64_bf16 v[32:35], v[4:7], a[8:15], v74
  s_waitcnt lgkmcnt(0)
  v_smfmac_f32_16x16x64_bf16 v[32:35], v[12:15], a[24:31], v74
  v_smfmac_f32_16x16x64_bf16 v[32:35], v[8:11], v[60:67], v74
  v_smfmac_f32_16x16x64_bf16 v[20:23], v[0:3], a[96:103], v74
  v_smfmac_f32_16x16x64_bf16 v[20:23], v[8:11], a[112:119], v74
  v_add_f32 v28, v28, v30
  v_add_f32 v32, v32, v34
  v_cvt_pk_bf16_f32 v30, v28, v32
  v_smfmac_f32_16x16x64_bf16 v[20:23], v[16:19], a[128:135], v74
  ds_write_b32 v79, v30 offset:256
  v_add_f32 v29, v29, v31
  v_add_f32 v33, v33, v35
  v_cvt_pk_bf16_f32 v31, v29, v33
  v_smfmac_f32_16x16x64_bf16 v[20:23], v[4:7], a[144:151], v74
  ds_write_b32 v79, v31 offset:832
  v_smfmac_f32_16x16x64_bf16 v[20:23], v[12:15], a[160:167], v74
  v_smfmac_f32_16x16x64_bf16 v[24:27], v[0:3], a[104:111], v74
  v_smfmac_f32_16x16x64_bf16 v[24:27], v[8:11], a[120:127], v74
  v_smfmac_f32_16x16x64_bf16 v[24:27], v[16:19], a[136:143], v74
  s_waitcnt lgkmcnt(0)
  s_barrier
  ds_read_b64 v[52:53], v77 offset:256
  v_add_f32 v20, v20, v22
  v_smfmac_f32_16x16x64_bf16 v[24:27], v[4:7], a[152:159], v74
  v_add_f32 v21, v21, v23
  v_smfmac_f32_16x16x64_bf16 v[24:27], v[12:15], a[168:175], v74
  v_cvt_pk_bf16_f32 v54, v20, v21
  s_add_u32 s68, s68, 655360
  s_nop 3
  v_add_f32 v24, v24, v26
  v_add_f32 v25, v25, v27
  v_cvt_pk_bf16_f32 v55, v24, v25
  s_waitcnt lgkmcnt(0)
  buffer_store_dwordx4 v[52:55], v76, s[8:11], s68 offen sc1
  s_branch Cs0_done
Cs0_lastp:
  s_add_u32 s72, s72, 2
  s_cmp_ge_u32 s72, 131072
  s_cbranch_scc1 Cs0_lastg
  s_barrier
  buffer_load_dwordx4 v76, s[8:11], s85 offen offset:0 sc1 lds
  s_waitcnt vmcnt(0)
  s_barrier
  s_branch Cs0_lastr
Cs0_done:
  s_branch L_cexit
L_w5:
  v_mov_b64 v[20:21], 0
  v_mov_b64 v[22:23], 0
  v_mov_b64 v[24:25], 0
  v_mov_b64 v[26:27], 0
  v_mov_b64 v[28:29], 0
  v_mov_b64 v[30:31], 0
  v_mov_b64 v[32:33], 0
  v_mov_b64 v[34:35], 0
  s_mov_b32 s78, 0x3f803f80
  s_mov_b32 s79, s78
  s_mov_b32 s65, 360448
  s_mov_b32 m0, 15872
  s_lshl_b32 s71, s53, 2
  s_add_u32 s71, s71, 128
  s_movk_i32 s56, 0x1000
  v_lshlrev_b32 v73, 2, v76
  v_mov_b32 v72, 0
  s_mov_b64 s[16:17], s[8:9]
  s_mov_b32 s18, 268435456
  s_mov_b32 s19, 0x20000
  s_getpc_b64 s[20:21]
Cs1_pc:
  s_add_u32 s20, s20, (Cs1_last - Cs1_pc)
  s_addc_u32 s21, s21, 0
  v_mov_b32 v68, 14880
  buffer_load_dwordx4 v[52:55], v76, s[8:11], s59 offen offset:0 sc1
  buffer_load_dwordx4 v[56:59], v76, s[8:11], s59 offen offset:1024 sc1
  ds_read_b128 v[36:39], v76 offset:20480
  ds_read_b128 v[40:43], v76 offset:21504
  ds_read_b128 v[60:63], v76 offset:22528
  ds_read_b128 v[64:67], v76 offset:23552
  ds_read_b128 v[0:3], v76 offset:4608
  ds_read_b128 v[4:7], v76 offset:5632
  ds_read_b128 v[8:11], v76 offset:6656
  ds_read_b128 v[12:15], v76 offset:7680
  s_waitcnt lgkmcnt(0)
  s_cmp_eq_u32 s66, 1
  s_branch Cs1_top2
.p2align 6
Cs1_h2:
  ds_read_b128 v[36:39], v76 offset:20480
  v_lshlrev_b32 v73, 2, v76
  ds_read_b128 v[40:43], v76 offset:21504
  v_mov_b64 v[20:21], 0
  v_mov_b64 v[22:23], 0
  v_mov_b64 v[24:25], 0
  v_mov_b64 v[26:27], 0
  v_mov_b32 v68, 14880
  ds_read_b128 v[60:63], v76 offset:22528
  s_cmp_eq_u32 s66, 62
  s_cselect_b64 s[16:17], s[20:21], s[16:17]
  s_cselect_b32 s18, (Cs1_done - Cs1_last), s18
  s_cselect_b32 s70, 0, s70
  s_cmp_eq_u32 s66, 63
  s_cselect_b32 s59, 268435456, s59
  s_cselect_b32 s58, 268435456, s58
  buffer_load_dwordx4 v[52:55], v76, s[8:11], s59 offen offset:0 sc1
  buffer_load_dwordx4 v[56:59], v76, s[8:11], s59 offen offset:1024 sc1
  s_waitcnt vmcnt(0)
  s_mov_b64 vcc, -1
Cs1_h2r:
  s_mov_b64 exec, vcc
  buffer_load_dwordx4 v[8:11], v76, s[8:11], s65 offen offset:2048 sc1
  buffer_load_dwordx4 v[0:3], v76, s[8:11], s85 offen offset:0 sc1
  s_mov_b64 exec, -1
  s_add_u32 s67, s67, 1
  s_cmp_lt_u32 s67, 131072
  s_cselect_b32 s54, -2, -1
  s_waitcnt vmcnt(1)
  v_max3_u32 v72, v8, v9, v10
  s_waitcnt vmcnt(0)
  v_max3_u32 v72, v72, v11, v0
  v_max3_u32 v72, v72, v1, v2
  v_max_u32 v72, v72, v3
  v_cmp_lt_u32 vcc, s54, v72
  s_cbranch_vccnz Cs1_h2r
  ds_write_b128 v76, v[8:11] offset:6656
  ds_write_b128 v76, v[0:3] offset:11776
Cs1_h2w:
  s_cmp_eq_u32 s66, 63
  s_waitcnt lgkmcnt(0)
  s_barrier
  ds_read_b128 v[0:3], v76 offset:4608
Cs1_top2:
  v_smfmac_f32_16x16x64_bf16 v[20:23], v[8:11], v[112:119], v74
  s_cbranch_scc1 Cs1_last
  v_smfmac_f32_16x16x64_bf16 v[24:27], v[8:11], v[120:127], v74
  buffer_load_dwordx4 v[44:47], v76, s[8:11], s58 offen offset:0 sc1
  s_mov_b32 m0, 15872
  v_smfmac_f32_16x16x64_bf16 v[28:31], v[8:11], v[208:215], v74
  buffer_load_dwordx4 v[48:51], v76, s[8:11], s58 offen offset:1024 sc1
  v_smfmac_f32_16x16x64_bf16 v[32:35], v[8:11], v[216:223], v74
  ds_read_b128 v[4:7], v76 offset:5632
  s_waitcnt lgkmcnt(1)
  v_smfmac_f32_16x16x64_bf16 v[20:23], v[0:3], v[80:87], v74
  ds_read_b128 v[12:15], v76 offset:7680
  v_smfmac_f32_16x16x64_bf16 v[28:31], v[0:3], v[36:43], v74
  ds_read_b128 v[36:39], v76 offset:36864
  v_smfmac_f32_16x16x64_bf16 v[24:27], v[0:3], v[88:95], v74
  buffer_store_dwordx4 v[16:19], v76, s[8:11], s68 offen sc1
  ds_read_b128 v[40:43], v76 offset:37888
  v_smfmac_f32_16x16x64_bf16 v[32:35], v[0:3], v[60:67], v74
  buffer_load_dword v73, s[16:19], s70 offen lds
  ds_read_b128 v[60:63], v76 offset:38912
  s_waitcnt lgkmcnt(4)
  v_smfmac_f32_16x16x64_bf16 v[20:23], v[4:7], v[96:103], v74
  ds_read_b128 v[64:67], v76 offset:39936
  v_smfmac_f32_16x16x64_bf16 v[24:27], v[4:7], v[104:111], v74
  s_waitcnt vmcnt(4)
  s_waitcnt lgkmcnt(4)
  v_smfmac_f32_16x16x64_bf16 v[20:23], v[12:15], v[128:135], v74
  s_barrier
  ds_read_b128 v[8:11], v76 offset:8704
  s_waitcnt lgkmcnt(3)
  v_smfmac_f32_16x16x64_bf16 v[28:31], v[4:7], v[36:43], v74
  ds_read_b128 v[36:39], v76 offset:53248
  v_smfmac_f32_16x16x64_bf16 v[24:27], v[12:15], v[136:143], v74
  ds_read_b128 v[40:43], v76 offset:54272
  s_waitcnt lgkmcnt(3)
  v_smfmac_f32_16x16x64_bf16 v[32:35], v[4:7], v[60:67], v74
  ds_read_b128 v[0:3], v76 offset:9728
  v_smfmac_f32_16x16x64_bf16 v[28:31], v[12:15], v[224:231], v74
  ds_read_b128 v[60:63], v76 offset:55296
  v_smfmac_f32_16x16x64_bf16 v[32:35], v[12:15], v[232:239], v74
  ds_read_b128 v[64:67], v76 offset:56320
  s_waitcnt lgkmcnt(5)
  v_smfmac_f32_16x16x64_bf16 v[20:23], v[8:11], v[144:151], v74
  s_barrier
  ds_read_b128 v[4:7], v76 offset:11776
  s_waitcnt lgkmcnt(4)
  v_smfmac_f32_16x16x64_bf16 v[28:31], v[8:11], v[36:43], v74
  ds_read_b128 v[12:15], v76 offset:12800
  ds_read_b128 v[36:39], v75 offset:4096
  v_smfmac_f32_16x16x64_bf16 v[24:27], v[8:11], v[152:159], v74
  ds_read_b128 v[16:19], v76 offset:10752
  s_waitcnt lgkmcnt(6)
  v_smfmac_f32_16x16x64_bf16 v[20:23], v[0:3], v[160:167], v74
  ds_read_b128 v[40:43], v75 offset:5120
  s_waitcnt lgkmcnt(5)
  v_smfmac_f32_16x16x64_bf16 v[32:35], v[8:11], v[60:67], v74
  ds_read_b128 v[60:63], v75 offset:6144
  v_smfmac_f32_16x16x64_bf16 v[24:27], v[0:3], v[168:175], v74
  ds_read_b128 v[64:67], v75 offset:7168
  s_waitcnt lgkmcnt(6)
  v_smfmac_f32_16x16x64_bf16 v[20:23], v[4:7], v[176:183], v74
  s_waitcnt lgkmcnt(5)
  v_smfmac_f32_16x16x64_bf16 v[20:23], v[12:15], v[192:199], v74
  s_waitcnt lgkmcnt(2)
  v_smfmac_f32_16x16x64_bf16 v[20:23], v[16:19], v[36:43], v74
  ds_read_b128 v[36:39], v75 offset:20480
  v_smfmac_f32_16x16x64_bf16 v[24:27], v[4:7], v[184:191], v74
  ds_read_b128 v[40:43], v75 offset:21504
  s_waitcnt lgkmcnt(2)
  v_smfmac_f32_16x16x64_bf16 v[24:27], v[16:19], v[60:67], v74
  ds_read_b128 v[60:63], v75 offset:22528
  v_add_f32 v20, v20, v22
  v_smfmac_f32_16x16x64_bf16 v[24:27], v[12:15], v[200:207], v74
  ds_read_b128 v[64:67], v75 offset:23552
  v_add_f32 v21, v21, v23
  v_smfmac_f32_16x16x64_bf16 v[28:31], v[16:19], v[240:247], v74
  v_mov_b64 v[70:71], s[78:79]
  v_smfmac_f32_16x16x64_bf16 v[28:31], v[4:7], a[0:7], v74
  s_waitcnt lgkmcnt(2)
  v_add_f32 v24, v24, v26
  v_smfmac_f32_16x16x64_bf16 v[28:31], v[0:3], v[36:43], v74
  ds_read_b128 v[36:39], v68
  v_cvt_pk_bf16_f32 v22, v20, v24
  v_smfmac_f32_16x16x64_bf16 v[28:31], v[12:15], a[16:23], v74
  ds_read_b128 v[40:43], v68
  ds_write_b32 v79, v22 offset:0
  s_waitcnt lgkmcnt(3)
  v_add_f32 v25, v25, v27
  v_cvt_pk_bf16_f32 v23, v21, v25
  v_smfmac_f32_16x16x64_bf16 v[32:35], v[0:3], v[60:67], v74
  ds_write_b32 v79, v23 offset:576
  v_cmp_u_f32 vcc, v20, v21
  v_smfmac_f32_16x16x64_bf16 v[32:35], v[16:19], v[248:255], v74
  v_add_f32 v28, v28, v30
  v_smfmac_f32_16x16x64_bf16 v[32:35], v[4:7], a[8:15], v74
  v_add_f32 v29, v29, v31
  v_smfmac_f32_16x16x64_bf16 v[32:35], v[12:15], a[24:31], v74
  s_cbranch_vccnz Cs1_rec
Cs1_recok:
  s_waitcnt lgkmcnt(3)
  v_smfmac_f32_16x16x64_bf16 v[36:39], v[16:19], a[128:135], v74
  s_waitcnt lgkmcnt(0)
  s_barrier
  ds_read_b128 v[60:63], v77
  v_smfmac_f32_16x16x64_bf16 v[40:43], v[16:19], a[136:143], v74
  ds_read_b128 v[64:67], v77 offset:128
  v_add_f32 v32, v32, v34
  v_cvt_pk_bf16_f32 v30, v28, v32
  v_smfmac_f32_16x16x64_bf16 v[36:39], v[0:3], a[112:119], v74
  ds_write_b32 v79, v30 offset:256
  v_add_f32 v33, v33, v35
  v_cvt_pk_bf16_f32 v31, v29, v33
  v_smfmac_f32_16x16x64_bf16 v[40:43], v[0:3], a[120:127], v74
  ds_write_b32 v79, v31 offset:832
  v_xor_b32 v75, 0x8000, v75
  v_smfmac_f32_16x16x64_bf16 v[36:39], v[4:7], a[144:151], v74
  ds_read_b128 v[0:3], v76 offset:4608
  v_mov_b32 v29, 0
  v_smfmac_f32_16x16x64_bf16 v[40:43], v[4:7], a[152:159], v74
  s_waitcnt vmcnt(2) lgkmcnt(3)
  v_mov_b32 v30, 0
  v_mfma_f32_16x16x32_bf16 v[44:47], v[44:47], v[60:63], 0
  ds_read_b128 v[4:7], v76 offset:5632
  s_waitcnt lgkmcnt(2)
  v_mfma_f32_16x16x32_bf16 v[44:47], v[48:51], v[64:67], v[44:47]
  s_barrier
  v_smfmac_f32_16x16x64_bf16 v[36:39], v[8:11], a[96:103], v74
  ds_read_b128 v[20:23], v77 offset:256
  ds_read_b128 v[24:27], v77 offset:384
  v_smfmac_f32_16x16x64_bf16 v[40:43], v[8:11], a[104:111], v74
  ds_read_b128 v[8:11], v76 offset:6656
  v_add_f32_dpp v72, v46, v44 quad_perm:[2,3,0,1] row_mask:0xf bank_mask:0xf
  v_add_f32_dpp v73, v47, v45 quad_perm:[2,3,0,1] row_mask:0xf bank_mask:0xf
  v_smfmac_f32_16x16x64_bf16 v[36:39], v[12:15], a[160:167], v74
  s_waitcnt lgkmcnt(4)
  v_exp_f32_dpp v72, v72 quad_perm:[0,1,0,1] row_mask:0xf bank_mask:0xf
  v_smfmac_f32_16x16x64_bf16 v[40:43], v[12:15], a[168:175], v74
  ds_read_b128 v[12:15], v76 offset:7680
  v_exp_f32_dpp v73, v73 quad_perm:[0,1,0,1] row_mask:0xf bank_mask:0xf
  v_smfmac_f32_16x16x64_bf16 v[36:39], v[0:3], a[32:39], v74
  s_waitcnt lgkmcnt(2)
  v_cvt_pk_bf16_f32 v72, v72, v73
  v_mfma_f32_16x16x32_bf16 v[20:23], v[20:23], v[60:63], 0
  ds_write_b32 v78, v72 offset:516
  v_mov_b64 v[16:17], 0
  v_mfma_f32_16x16x32_bf16 v[20:23], v[24:27], v[64:67], v[20:23]
  ds_read_b128 v[44:47], v75 offset:22528
  v_mov_b64 v[18:19], 0
  v_smfmac_f32_16x16x64_bf16 v[40:43], v[0:3], a[40:47], v74
  ds_read_b128 v[48:51], v75 offset:23552
  v_mov_b64 v[68:69], s[78:79]
  v_smfmac_f32_16x16x64_bf16 v[36:39], v[4:7], a[48:55], v74
  s_waitcnt lgkmcnt(4)
  v_add_f32_dpp v24, v22, v20 quad_perm:[2,3,0,1] row_mask:0xf bank_mask:0xf
  v_add_f32_dpp v25, v23, v21 quad_perm:[2,3,0,1] row_mask:0xf bank_mask:0xf
  v_smfmac_f32_16x16x64_bf16 v[36:39], v[8:11], a[64:71], v74
  s_waitcnt lgkmcnt(2)
  s_barrier
  ds_read_b128 v[32:35], v78 offset:512
  v_smfmac_f32_16x16x64_bf16 v[36:39], v[12:15], a[80:87], v74
  ds_read_b128 v[60:63], v75 offset:20480
  v_mul_f32 v24, s69, v24
  v_smfmac_f32_16x16x64_bf16 v[40:43], v[4:7], a[56:63], v74
  ds_read_b128 v[64:67], v75 offset:21504
  v_mul_f32 v25, s69, v25
  v_smfmac_f32_16x16x64_bf16 v[40:43], v[8:11], a[72:79], v74
  v_exp_f32_dpp v24, v24 quad_perm:[0,1,0,1] row_mask:0xf bank_mask:0xf
  v_smfmac_f32_16x16x64_bf16 v[40:43], v[12:15], a[88:95], v74
  s_waitcnt lgkmcnt(2)
  v_exp_f32_dpp v25, v25 quad_perm:[0,1,0,1] row_mask:0xf bank_mask:0xf
  v_mfma_f32_16x16x32_bf16 v[8:11], v[32:35], v[68:71], 0
  v_add_f32 v36, v36, v38
  v_add_f32 v37, v37, v39
  v_mfma_f32_16x16x32_bf16 v[0:3], v[32:35], v[52:55], 0
  v_add_f32 v40, v40, v42
  v_add_f32 v41, v41, v43
  v_mfma_f32_16x16x32_bf16 v[4:7], v[32:35], v[56:59], 0
  v_cvt_pk_bf16_f32 v28, v24, v25
  v_cvt_pk_bf16_f32 v72, v36, v37
  v_cvt_pk_bf16_f32 v73, v40, v41
  v_mfma_f32_16x16x16_bf16 v[8:11], v[28:29], v[68:69], v[8:11]
  v_cvt_pk_bf16_f32 v31, v24, v25
  v_mov_b64 v[20:21], 0
  v_mfma_f32_16x16x16_bf16 v[0:3], v[28:29], v[72:73], v[0:3]
  ds_read_b128 v[52:55], v75 offset:36864
  v_mov_b64 v[22:23], 0
  v_mfma_f32_16x16x16_bf16 v[4:7], v[30:31], v[72:73], v[4:7]
  v_rcp_f32 v10, v8
  v_rcp_f32 v11, v9
  v_mul_f32 v0, v10, v0
  v_mul_f32 v1, v11, v1
  v_max3_f32 v8, v8, v9, v10
  v_mul_f32 v4, v10, v4
  v_mul_f32 v5, v11, v5
  v_cvt_pk_bf16_f32 v2, v0, v4
  ds_write_b32 v79, v2 offset:8704
  v_cvt_pk_bf16_f32 v3, v1, v5
  ds_write_b32 v79, v3 offset:9280
  ds_read_b128 v[12:15], v78 offset:8768
  v_max_f32 v8, v8, v11
  v_cmp_le_f32 vcc, 1317011456, v8
  v_mov_b64 v[24:25], 0
  v_mov_b64 v[26:27], 0
  ds_read_b128 v[56:59], v75 offset:37888
  s_cbranch_vccnz Cs1_mx
Cs1_mxok:
  s_waitcnt lgkmcnt(2)
  s_barrier
  ds_read_b128 v[0:3], v78 offset:8704
  s_waitcnt lgkmcnt(2)
  v_smfmac_f32_16x16x64_bf16 v[16:19], v[12:15], v[44:51], v74
  ds_read_b128 v[4:7], v78 offset:8832
  v_smfmac_f32_16x16x64_bf16 v[20:23], v[12:15], a[200:207], v74
  ds_read_b128 v[8:11], v78 offset:8896
  v_smfmac_f32_16x16x64_bf16 v[24:27], v[12:15], a[216:223], v74
  ds_read_b128 v[36:39], v75 offset:38912
  s_waitcnt lgkmcnt(3)
  v_smfmac_f32_16x16x64_bf16 v[16:19], v[0:3], v[60:67], v74
  ds_read_b128 v[40:43], v75 offset:39936
  s_waitcnt lgkmcnt(3)
  v_smfmac_f32_16x16x64_bf16 v[16:19], v[4:7], a[176:183], v74
  ds_read_b128 v[68:71], v76 offset:13824
  s_waitcnt lgkmcnt(3)
  v_smfmac_f32_16x16x64_bf16 v[16:19], v[8:11], a[184:191], v74
  ds_read_b128 v[44:47], v75 offset:53248
  v_smfmac_f32_16x16x64_bf16 v[20:23], v[0:3], a[192:199], v74
  ds_read_b128 v[48:51], v75 offset:54272
  v_smfmac_f32_16x16x64_bf16 v[20:23], v[4:7], v[52:59], v74
  ds_read_b128 v[60:63], v75 offset:55296
  s_waitcnt lgkmcnt(4)
  v_cvt_pk_bf16_f32 v16, v16, v17
  v_cvt_pk_bf16_f32 v17, v18, v19
  v_bfi_b32 v16, 1, s72, v16
  v_smfmac_f32_16x16x64_bf16 v[20:23], v[8:11], v[36:43], v74
  s_waitcnt lgkmcnt(3)
  buffer_store_dwordx2 v[16:17], v68, s[8:11], s73 offen sc1
  v_mov_b64 v[32:33], 0
  v_smfmac_f32_16x16x64_bf16 v[24:27], v[0:3], a[208:215], v74
  ds_read_b128 v[64:67], v75 offset:56320
  v_mov_b64 v[34:35], 0
  v_smfmac_f32_16x16x64_bf16 v[24:27], v[4:7], a[224:231], v74
  v_cvt_pk_bf16_f32 v20, v20, v21
  v_cvt_pk_bf16_f32 v21, v22, v23
  v_bfi_b32 v20, 1, s72, v20
  v_smfmac_f32_16x16x64_bf16 v[24:27], v[8:11], a[232:239], v74
  buffer_store_dwordx2 v[20:21], v68, s[8:11], s74 offen sc1
  s_waitcnt lgkmcnt(2)
  v_smfmac_f32_16x16x64_bf16 v[32:35], v[0:3], v[44:51], v74
  s_waitcnt lgkmcnt(0)
  v_smfmac_f32_16x16x64_bf16 v[32:35], v[12:15], v[60:67], v74
  v_cvt_pk_bf16_f32 v24, v24, v25
  v_cvt_pk_bf16_f32 v25, v26, v27
  v_bfi_b32 v24, 1, s72, v24
  v_smfmac_f32_16x16x64_bf16 v[32:35], v[4:7], a[240:247], v74
  buffer_store_dwordx2 v[24:25], v68, s[8:11], s75 offen sc1
  v_smfmac_f32_16x16x64_bf16 v[32:35], v[8:11], a[248:255], v74
  v_mov_b64 v[18:19], v[72:73]
  s_nop 4
  v_cvt_pk_bf16_f32 v32, v32, v33
  v_cvt_pk_bf16_f32 v33, v34, v35
  v_bfi_b32 v32, 1, s72, v32
  buffer_store_dwordx2 v[32:33], v68, s[8:11], s76 offen sc1
  ds_read_b128 v[0:3], v76 offset:14848
  s_waitcnt lgkmcnt(0)
  ds_read_b64 v[16:17], v77 offset:264
  s_waitcnt lgkmcnt(0)
  ds_read_b128 v[64:67], v76 offset:23552
  s_waitcnt lgkmcnt(0)
  s_add_u32 s66, s66, 1
  s_xor_b32 s64, s64, 16384
  s_xor_b32 s65, s65, 16384
  s_add_u32 s58, s58, 655360
  s_add_u32 s59, s59, 655360
  s_add_u32 s70, s70, 655360
  s_add_u32 s68, s68, 655360
  s_mov_b32 m0, 11776
  s_add_u32 s85, s65, 7168
  v_xor_b32 v75, 0x8000, v75
  v_mov_b64 v[28:29], 0
  v_mov_b64 v[30:31], 0
  v_mov_b64 v[32:33], 0
  v_mov_b64 v[34:35], 0
  s_waitcnt vmcnt(0)
  buffer_load_dwordx4 v[52:55], v76, s[8:11], s60 offen offset:0 sc1
  buffer_load_dwordx4 v[56:59], v76, s[8:11], s60 offen offset:1024 sc1
  s_waitcnt lgkmcnt(0)
  s_waitcnt vmcnt(1)
  v_mfma_f32_16x16x32_bf16 v[4:7], v[0:3], v[52:55], 0
  v_bitop3_b32 v72, v52, v54, s72 bitop3:0x7e
  s_waitcnt vmcnt(0)
  v_mfma_f32_16x16x32_bf16 v[4:7], v[0:3], v[56:59], v[4:7]
  v_bitop3_b32 v73, v56, v58, s72 bitop3:0x7e
  v_bitop3_b32 v72, v72, v73, 1 bitop3:0xa8
  v_cmp_ne_u32 vcc, 0, v72
  s_cbranch_vccnz Cs1_h1r
  s_nop 2
  v_add_f32_dpp v4, v4, v4 row_ror:4 row_mask:0xf bank_mask:0xf
  v_add_f32_dpp v5, v5, v5 row_ror:4 row_mask:0xf bank_mask:0xf
  s_nop 0
  v_add_f32_dpp v4, v4, v4 row_ror:8 row_mask:0xf bank_mask:0xf
  v_add_f32_dpp v5, v5, v5 row_ror:8 row_mask:0xf bank_mask:0xf
  v_cvt_pk_bf16_f32 v4, v4, v5
  buffer_store_dword v4, v69, s[8:11], s62 offen sc1
  s_xor_b32 s62, s62, 16384
  buffer_store_dword v71, v69, s[8:11], s62 offen sc1
  s_xor_b32 s72, s72, 1
  s_branch Cs1_h2
Cs1_h1r:
  s_mov_b64 exec, vcc
  buffer_load_dwordx4 v[52:55], v76, s[8:11], s60 offen offset:0 sc1
  buffer_load_dwordx4 v[56:59], v76, s[8:11], s60 offen offset:1024 sc1
  s_mov_b64 exec, -1
  s_add_u32 s67, s67, 1
  s_waitcnt vmcnt(1)
  v_mfma_f32_16x16x32_bf16 v[4:7], v[0:3], v[52:55], 0
  v_bitop3_b32 v72, v52, v54, s72 bitop3:0x7e
  s_waitcnt vmcnt(0)
  v_mfma_f32_16x16x32_bf16 v[4:7], v[0:3], v[56:59], v[4:7]
  v_bitop3_b32 v73, v56, v58, s72 bitop3:0x7e
  v_bitop3_b32 v72, v72, v73, 1 bitop3:0xa8
  v_cmp_ne_u32 vcc, 0, v72
  s_cbranch_vccz Cs1_h1p
Cs1_h1s:
  s_mov_b64 exec, vcc
  buffer_load_dwordx4 v[52:55], v76, s[8:11], s60 offen offset:0 sc1
  buffer_load_dwordx4 v[56:59], v76, s[8:11], s60 offen offset:1024 sc1
  s_mov_b64 exec, -1
  s_add_u32 s67, s67, 1
  s_waitcnt vmcnt(1)
  v_mfma_f32_16x16x32_bf16 v[4:7], v[0:3], v[52:55], 0
  v_bitop3_b32 v72, v52, v54, s72 bitop3:0x7e
  s_waitcnt vmcnt(0)
  v_mfma_f32_16x16x32_bf16 v[4:7], v[0:3], v[56:59], v[4:7]
  v_bitop3_b32 v73, v56, v58, s72 bitop3:0x7e
  v_bitop3_b32 v72, v72, v73, 1 bitop3:0xa8
  v_cmp_ne_u32 vcc, 0, v72
  s_cbranch_vccz Cs1_h1p
  s_cmp_lt_u32 s67, 131072
  s_cbranch_scc1 Cs1_h1s
Cs1_h1p:
  s_nop 2
  v_add_f32_dpp v4, v4, v4 row_ror:4 row_mask:0xf bank_mask:0xf
  v_add_f32_dpp v5, v5, v5 row_ror:4 row_mask:0xf bank_mask:0xf
  s_nop 0
  v_add_f32_dpp v4, v4, v4 row_ror:8 row_mask:0xf bank_mask:0xf
  v_add_f32_dpp v5, v5, v5 row_ror:8 row_mask:0xf bank_mask:0xf
  v_cvt_pk_bf16_f32 v4, v4, v5
  buffer_store_dword v4, v69, s[8:11], s62 offen sc1
  s_xor_b32 s62, s62, 16384
  buffer_store_dword v71, v69, s[8:11], s62 offen sc1
  s_xor_b32 s72, s72, 1
  s_branch Cs1_h2
Cs1_rec:
  s_nop 7
  s_waitcnt vmcnt(0) lgkmcnt(0)
  v_max3_u32 v72, v0, v1, v2
  v_max3_u32 v72, v72, v3, v4
  v_max3_u32 v72, v72, v5, v6
  v_max3_u32 v72, v72, v7, v8
  v_max3_u32 v72, v72, v9, v10
  v_max3_u32 v72, v72, v11, v12
  v_max3_u32 v72, v72, v13, v14
  v_max3_u32 v72, v72, v15, v16
  v_max3_u32 v72, v72, v17, v18
  v_max_u32 v72, v72, v19
  v_cmp_eq_u32 vcc, -1, v72
  s_cbranch_vccz Cs1_recok
  s_barrier
  v_mov_b64 v[20:21], 0
  v_mov_b64 v[22:23], 0
  v_mov_b64 v[24:25], 0
  v_mov_b64 v[26:27], 0
  v_mov_b64 v[28:29], 0
  v_mov_b64 v[30:31], 0
  v_mov_b64 v[32:33], 0
  v_mov_b64 v[34:35], 0
  s_waitcnt lgkmcnt(0)
  s_barrier
  ds_read_b128 v[0:3], v76 offset:4608
  s_waitcnt lgkmcnt(0)
  v_smfmac_f32_16x16x64_bf16 v[20:23], v[0:3], v[80:87], v74
  v_smfmac_f32_16x16x64_bf16 v[24:27], v[0:3], v[88:95], v74
  ds_read_b128 v[60:63], v76 offset:20480
  ds_read_b128 v[64:67], v76 offset:21504
  s_waitcnt lgkmcnt(0)
  v_smfmac_f32_16x16x64_bf16 v[28:31], v[0:3], v[60:67], v74
  ds_read_b128 v[60:63], v76 offset:22528
  ds_read_b128 v[64:67], v76 offset:23552
  s_waitcnt lgkmcnt(0)
  v_smfmac_f32_16x16x64_bf16 v[32:35], v[0:3], v[60:67], v74
  ds_read_b128 v[4:7], v76 offset:5632
  s_waitcnt lgkmcnt(0)
  v_smfmac_f32_16x16x64_bf16 v[20:23], v[4:7], v[96:103], v74
  v_smfmac_f32_16x16x64_bf16 v[24:27], v[4:7], v[104:111], v74
  ds_read_b128 v[60:63], v76 offset:36864
  ds_read_b128 v[64:67], v76 offset:37888
  s_waitcnt lgkmcnt(0)
  v_smfmac_f32_16x16x64_bf16 v[28:31], v[4:7], v[60:67], v74
  ds_read_b128 v[60:63], v76 offset:38912
  ds_read_b128 v[64:67], v76 offset:39936
  s_waitcnt lgkmcnt(0)
  v_smfmac_f32_16x16x64_bf16 v[32:35], v[4:7], v[60:67], v74
  ds_read_b128 v[8:11], v76 offset:6656
  s_waitcnt lgkmcnt(0)
  v_smfmac_f32_16x16x64_bf16 v[20:23], v[8:11], v[112:119], v74
  v_smfmac_f32_16x16x64_bf16 v[24:27], v[8:11], v[120:127], v74
  v_smfmac_f32_16x16x64_bf16 v[28:31], v[8:11], v[208:215], v74
  v_smfmac_f32_16x16x64_bf16 v[32:35], v[8:11], v[216:223], v74
  ds_read_b128 v[12:15], v76 offset:7680
  s_waitcnt lgkmcnt(0)
  v_smfmac_f32_16x16x64_bf16 v[20:23], v[12:15], v[128:135], v74
  v_smfmac_f32_16x16x64_bf16 v[24:27], v[12:15], v[136:143], v74
  v_smfmac_f32_16x16x64_bf16 v[28:31], v[12:15], v[224:231], v74
  v_smfmac_f32_16x16x64_bf16 v[32:35], v[12:15], v[232:239], v74
  ds_read_b128 v[8:11], v76 offset:8704
  s_waitcnt lgkmcnt(0)
  v_smfmac_f32_16x16x64_bf16 v[20:23], v[8:11], v[144:151], v74
  v_smfmac_f32_16x16x64_bf16 v[24:27], v[8:11], v[152:159], v74
  ds_read_b128 v[60:63], v76 offset:53248
  ds_read_b128 v[64:67], v76 offset:54272
  s_waitcnt lgkmcnt(0)
  v_smfmac_f32_16x16x64_bf16 v[28:31], v[8:11], v[60:67], v74
  ds_read_b128 v[60:63], v76 offset:55296
  ds_read_b128 v[64:67], v76 offset:56320
  s_waitcnt lgkmcnt(0)
  v_smfmac_f32_16x16x64_bf16 v[32:35], v[8:11], v[60:67], v74
  ds_read_b128 v[0:3], v76 offset:9728
  s_waitcnt lgkmcnt(0)
  v_smfmac_f32_16x16x64_bf16 v[20:23], v[0:3], v[160:167], v74
  v_smfmac_f32_16x16x64_bf16 v[24:27], v[0:3], v[168:175], v74
  ds_read_b128 v[60:63], v75 offset:20480
  ds_read_b128 v[64:67], v75 offset:21504
  s_waitcnt lgkmcnt(0)
  v_smfmac_f32_16x16x64_bf16 v[28:31], v[0:3], v[60:67], v74
  ds_read_b128 v[60:63], v75 offset:22528
  ds_read_b128 v[64:67], v75 offset:23552
  s_waitcnt lgkmcnt(0)
  v_smfmac_f32_16x16x64_bf16 v[32:35], v[0:3], v[60:67], v74
  ds_read_b128 v[16:19], v76 offset:10752
  ds_read_b128 v[60:63], v75 offset:4096
  ds_read_b128 v[64:67], v75 offset:5120
  s_waitcnt lgkmcnt(0)
  v_smfmac_f32_16x16x64_bf16 v[20:23], v[16:19], v[60:67], v74
  ds_read_b128 v[60:63], v75 offset:6144
  ds_read_b128 v[64:67], v75 offset:7168
  s_waitcnt lgkmcnt(0)
  v_smfmac_f32_16x16x64_bf16 v[24:27], v[16:19], v[60:67], v74
  v_smfmac_f32_16x16x64_bf16 v[28:31], v[16:19], v[240:247], v74
  v_smfmac_f32_16x16x64_bf16 v[32:35], v[16:19], v[248:255], v74
  ds_read_b128 v[4:7], v76 offset:11776
  s_waitcnt lgkmcnt(0)
  v_smfmac_f32_16x16x64_bf16 v[20:23], v[4:7], v[176:183], v74
  v_smfmac_f32_16x16x64_bf16 v[24:27], v[4:7], v[184:191], v74
  v_smfmac_f32_16x16x64_bf16 v[28:31], v[4:7], a[0:7], v74
  v_smfmac_f32_16x16x64_bf16 v[32:35], v[4:7], a[8:15], v74
  ds_read_b128 v[12:15], v76 offset:12800
  s_waitcnt lgkmcnt(0)
  v_smfmac_f32_16x16x64_bf16 v[20:23], v[12:15], v[192:199], v74
  v_smfmac_f32_16x16x64_bf16 v[24:27], v[12:15], v[200:207], v74
  v_smfmac_f32_16x16x64_bf16 v[28:31], v[12:15], a[16:23], v74
  v_smfmac_f32_16x16x64_bf16 v[32:35], v[12:15], a[24:31], v74
  v_add_f32 v20, v20, v22
  v_add_f32 v21, v21, v23
  v_add_f32 v24, v24, v26
  v_cvt_pk_bf16_f32 v22, v20, v24
  ds_write_b32 v79, v22 offset:0
  v_add_f32 v25, v25, v27
  v_cvt_pk_bf16_f32 v23, v21, v25
  ds_write_b32 v79, v23 offset:576
  v_add_f32 v28, v28, v30
  v_add_f32 v29, v29, v31
  s_waitcnt lgkmcnt(0)
  s_nop 1
  s_branch Cs1_recok
Cs1_mx:
  s_waitcnt lgkmcnt(0)
  s_barrier
  buffer_load_dwordx4 v[52:55], v76, s[8:11], s59 offen offset:0 sc1
  buffer_load_dwordx4 v[0:3], v76, s[8:11], s58 offen offset:0 sc1
  ds_read_b128 v[20:23], v77 offset:0
  ds_read_b128 v[28:31], v77 offset:256
  buffer_load_dwordx4 v[56:59], v76, s[8:11], s59 offen offset:1024 sc1
  buffer_load_dwordx4 v[4:7], v76, s[8:11], s58 offen offset:1024 sc1
  ds_read_b128 v[24:27], v77 offset:128
  ds_read_b128 v[32:35], v77 offset:384
  s_waitcnt vmcnt(2) lgkmcnt(3)
  v_mfma_f32_16x16x32_bf16 v[8:11], v[0:3], v[20:23], 0
  s_waitcnt vmcnt(0) lgkmcnt(1)
  v_mfma_f32_16x16x32_bf16 v[8:11], v[4:7], v[24:27], v[8:11]
  v_mfma_f32_16x16x32_bf16 v[12:15], v[28:31], v[20:23], 0
  s_waitcnt lgkmcnt(0)
  v_mfma_f32_16x16x32_bf16 v[12:15], v[32:35], v[24:27], v[12:15]
  v_add_f32_dpp v8, v10, v8 quad_perm:[2,3,0,1] row_mask:0xf bank_mask:0xf
  v_add_f32_dpp v9, v11, v9 quad_perm:[2,3,0,1] row_mask:0xf bank_mask:0xf
  s_nop 0
  v_mov_b32_dpp v8, v8 quad_perm:[0,1,0,1] row_mask:0xf bank_mask:0xf
  v_mov_b32_dpp v9, v9 quad_perm:[0,1,0,1] row_mask:0xf bank_mask:0xf
  s_nop 1
  v_add_f32_dpp v12, v14, v12 quad_perm:[2,3,0,1] row_mask:0xf bank_mask:0xf
  v_add_f32_dpp v13, v15, v13 quad_perm:[2,3,0,1] row_mask:0xf bank_mask:0xf
  s_nop 0
  v_mov_b32_dpp v12, v12 quad_perm:[0,1,0,1] row_mask:0xf bank_mask:0xf
  v_mov_b32_dpp v13, v13 quad_perm:[0,1,0,1] row_mask:0xf bank_mask:0xf
  v_mul_f32 v12, s69, v12
  ds_write_b32 v78, v8 offset:8708
  v_mul_f32 v13, s69, v13
  ds_write_b32 v78, v9 offset:8772
  s_waitcnt lgkmcnt(0)
  s_barrier
  ds_read_b128 v[36:39], v78 offset:8704
  ds_read_b128 v[40:43], v78 offset:8768
  s_waitcnt lgkmcnt(0)
  s_barrier
  v_max_f32 v16, v36, v37
  v_max3_f32 v16, v16, v38, v39
  v_max3_f32 v16, v16, v40, v41
  v_max3_f32 v16, v16, v42, v43
  v_max3_f32 v16, v16, v12, v13
  v_mov_b32 v17, v16
  s_nop 1
  v_permlane16_swap_b32 v16, v17
  v_max_f32 v16, v16, v17
  v_mov_b32 v17, v16
  s_nop 1
  v_permlane32_swap_b32 v16, v17
  v_max_f32 v16, v16, v17
  v_sub_f32 v36, v36, v16
  v_sub_f32 v37, v37, v16
  v_sub_f32 v38, v38, v16
  v_sub_f32 v39, v39, v16
  v_sub_f32 v40, v40, v16
  v_sub_f32 v41, v41, v16
  v_sub_f32 v42, v42, v16
  v_sub_f32 v43, v43, v16
  v_sub_f32 v12, v12, v16
  v_sub_f32 v13, v13, v16
  v_exp_f32 v36, v36
  v_exp_f32 v37, v37
  v_exp_f32 v38, v38
  v_exp_f32 v39, v39
  v_exp_f32 v40, v40
  v_exp_f32 v41, v41
  v_exp_f32 v42, v42
  v_exp_f32 v43, v43
  v_exp_f32 v12, v12
  v_exp_f32 v13, v13
  v_cvt_pk_bf16_f32 v32, v36, v40
  v_cvt_pk_bf16_f32 v33, v37, v41
  v_cvt_pk_bf16_f32 v34, v38, v42
  v_cvt_pk_bf16_f32 v35, v39, v43
  v_cvt_pk_bf16_f32 v28, v12, v13
  v_cvt_pk_bf16_f32 v31, v12, v13
  v_mov_b32 v29, 0
  v_mov_b32 v30, 0
  v_mfma_f32_16x16x32_bf16 v[8:11], v[32:35], v[68:71], 0
  v_mfma_f32_16x16x32_bf16 v[0:3], v[32:35], v[52:55], 0
  v_mfma_f32_16x16x32_bf16 v[4:7], v[32:35], v[56:59], 0
  v_mfma_f32_16x16x16_bf16 v[8:11], v[28:29], v[68:69], v[8:11]
  v_mfma_f32_16x16x16_bf16 v[0:3], v[28:29], v[72:73], v[0:3]
  v_mfma_f32_16x16x16_bf16 v[4:7], v[30:31], v[72:73], v[4:7]
  ds_read_b128 v[52:55], v75 offset:36864
  v_rcp_f32 v10, v8
  v_rcp_f32 v11, v9
  v_mul_f32 v0, v10, v0
  v_mul_f32 v1, v11, v1
  v_max3_f32 v8, v8, v9, v10
  v_mul_f32 v4, v10, v4
  v_mul_f32 v5, v11, v5
  v_cvt_pk_bf16_f32 v2, v0, v4
  ds_write_b32 v79, v2 offset:8704
  v_cvt_pk_bf16_f32 v3, v1, v5
  ds_write_b32 v79, v3 offset:9280
  ds_read_b128 v[12:15], v78 offset:8768
  ds_read_b128 v[56:59], v75 offset:37888
  v_mov_b64 v[16:17], 0
  v_mov_b64 v[18:19], 0
  v_mov_b64 v[20:21], 0
  v_mov_b64 v[22:23], 0
  v_mov_b64 v[24:25], 0
  v_mov_b64 v[26:27], 0
  s_branch Cs1_mxok
Cs1_last:
  ds_read_b128 v[4:7], v76 offset:5632
  ds_read_b128 v[12:15], v76 offset:7680
  ds_read_b128 v[44:47], v76 offset:36864
  ds_read_b128 v[48:51], v76 offset:37888
  s_nop 5
  v_mov_b64 v[20:21], 0
  v_mov_b64 v[22:23], 0
  v_mov_b64 v[24:25], 0
  v_mov_b64 v[26:27], 0
  s_waitcnt lgkmcnt(4)
  v_smfmac_f32_16x16x64_bf16 v[28:31], v[0:3], v[36:43], v74
  ds_read_b128 v[36:39], v76 offset:38912
  ds_read_b128 v[40:43], v76 offset:39936
  v_smfmac_f32_16x16x64_bf16 v[32:35], v[0:3], v[60:67], v74
  s_waitcnt lgkmcnt(5)
  v_smfmac_f32_16x16x64_bf16 v[20:23], v[0:3], a[32:39], v74
  ds_read_b128 v[60:63], v76 offset:53248
  ds_read_b128 v[64:67], v76 offset:54272
  v_smfmac_f32_16x16x64_bf16 v[24:27], v[0:3], a[40:47], v74
  s_waitcnt lgkmcnt(4)
  v_smfmac_f32_16x16x64_bf16 v[20:23], v[4:7], a[48:55], v74
  buffer_store_dwordx4 v[16:19], v76, s[8:11], s68 offen sc1
  v_smfmac_f32_16x16x64_bf16 v[24:27], v[4:7], a[56:63], v74
  v_smfmac_f32_16x16x64_bf16 v[28:31], v[4:7], v[44:51], v74
  s_waitcnt lgkmcnt(2)
  v_smfmac_f32_16x16x64_bf16 v[20:23], v[8:11], a[64:71], v74
  ds_read_b128 v[44:47], v76 offset:55296
  ds_read_b128 v[48:51], v76 offset:56320
  v_smfmac_f32_16x16x64_bf16 v[24:27], v[8:11], a[72:79], v74
  v_smfmac_f32_16x16x64_bf16 v[32:35], v[4:7], v[36:43], v74
  v_smfmac_f32_16x16x64_bf16 v[28:31], v[8:11], v[208:215], v74
  ds_read_b128 v[36:39], v75 offset:20480
  ds_read_b128 v[40:43], v75 offset:21504
  v_smfmac_f32_16x16x64_bf16 v[32:35], v[8:11], v[216:223], v74
  v_smfmac_f32_16x16x64_bf16 v[20:23], v[12:15], a[80:87], v74
  v_smfmac_f32_16x16x64_bf16 v[24:27], v[12:15], a[88:95], v74
  v_smfmac_f32_16x16x64_bf16 v[28:31], v[12:15], v[224:231], v74
  v_smfmac_f32_16x16x64_bf16 v[32:35], v[12:15], v[232:239], v74
  s_waitcnt vmcnt(1)
  s_barrier
Cs1_lastr:
  ds_read_b128 v[8:11], v76 offset:8704
  ds_read_b128 v[0:3], v76 offset:9728
  ds_read_b128 v[16:19], v76 offset:10752
  ds_read_b128 v[4:7], v76 offset:11776
  ds_read_b128 v[12:15], v76 offset:12800
  s_waitcnt lgkmcnt(3)
  v_max3_u32 v72, v0, v1, v2
  s_waitcnt lgkmcnt(1)
  v_max3_u32 v72, v72, v3, v4
  v_max3_u32 v72, v72, v5, v6
  v_max3_u32 v72, v72, v7, v8
  v_max3_u32 v72, v72, v9, v10
  s_waitcnt lgkmcnt(0)
  v_max3_u32 v72, v72, v11, v12
  v_max3_u32 v72, v72, v13, v14
  v_max3_u32 v72, v72, v15, v16
  v_max3_u32 v72, v72, v17, v18
  v_max_u32 v72, v72, v19
  v_cmp_eq_u32 vcc, -1, v72
  s_cbranch_vccnz Cs1_lastp
Cs1_lastg:
  v_smfmac_f32_16x16x64_bf16 v[28:31], v[8:11], v[60:67], v74
  ds_read_b128 v[60:63], v75 offset:22528
  ds_read_b128 v[64:67], v75 offset:23552
  v_smfmac_f32_16x16x64_bf16 v[32:35], v[8:11], v[44:51], v74
  v_smfmac_f32_16x16x64_bf16 v[28:31], v[0:3], v[36:43], v74
  v_smfmac_f32_16x16x64_bf16 v[28:31], v[16:19], v[240:247], v74
  v_smfmac_f32_16x16x64_bf16 v[28:31], v[4:7], a[0:7], v74
  v_smfmac_f32_16x16x64_bf16 v[28:31], v[12:15], a[16:23], v74
  v_smfmac_f32_16x16x64_bf16 v[32:35], v[16:19], v[248:255], v74
  v_smfmac_f32_16x16x64_bf16 v[32:35], v[4:7], a[8:15], v74
  s_waitcnt lgkmcnt(0)
  v_smfmac_f32_16x16x64_bf16 v[32:35], v[12:15], a[24:31], v74
  v_smfmac_f32_16x16x64_bf16 v[32:35], v[0:3], v[60:67], v74
  v_smfmac_f32_16x16x64_bf16 v[20:23], v[8:11], a[96:103], v74
  v_smfmac_f32_16x16x64_bf16 v[20:23], v[0:3], a[112:119], v74
  v_add_f32 v28, v28, v30
  v_add_f32 v32, v32, v34
  v_cvt_pk_bf16_f32 v30, v28, v32
  v_smfmac_f32_16x16x64_bf16 v[20:23], v[16:19], a[128:135], v74
  ds_write_b32 v79, v30 offset:256
  v_add_f32 v29, v29, v31
  v_add_f32 v33, v33, v35
  v_cvt_pk_bf16_f32 v31, v29, v33
  v_smfmac_f32_16x16x64_bf16 v[20:23], v[4:7], a[144:151], v74
  ds_write_b32 v79, v31 offset:832
  v_smfmac_f32_16x16x64_bf16 v[20:23], v[12:15], a[160:167], v74
  v_smfmac_f32_16x16x64_bf16 v[24:27], v[8:11], a[104:111], v74
  v_smfmac_f32_16x16x64_bf16 v[24:27], v[0:3], a[120:127], v74
  v_smfmac_f32_16x16x64_bf16 v[24:27], v[16:19], a[136:143], v74
  s_waitcnt lgkmcnt(0)
  s_barrier
  ds_read_b64 v[52:53], v77 offset:264
  v_add_f32 v20, v20, v22
  v_smfmac_f32_16x16x64_bf16 v[24:27], v[4:7], a[152:159], v74
  v_add_f32 v21, v21, v23
  v_smfmac_f32_16x16x64_bf16 v[24:27], v[12:15], a[168:175], v74
  v_cvt_pk_bf16_f32 v54, v20, v21
  s_add_u32 s68, s68, 655360
  s_nop 3
  v_add_f32 v24, v24, v26
  v_add_f32 v25, v25, v27
  v_cvt_pk_bf16_f32 v55, v24, v25
  s_waitcnt lgkmcnt(0)
  buffer_store_dwordx4 v[52:55], v76, s[8:11], s68 offen sc1
  s_branch Cs1_done
Cs1_lastp:
  s_add_u32 s72, s72, 2
  s_cmp_ge_u32 s72, 131072
  s_cbranch_scc1 Cs1_lastg
  s_barrier
  buffer_load_dwordx4 v76, s[8:11], s85 offen offset:0 sc1 lds
  s_waitcnt vmcnt(0)
  s_barrier
  s_branch Cs1_lastr
Cs1_done:
  s_branch L_cexit
L_w6:
  v_mov_b64 v[20:21], 0
  v_mov_b64 v[22:23], 0
  v_mov_b64 v[24:25], 0
  v_mov_b64 v[26:27], 0
  v_mov_b64 v[28:29], 0
  v_mov_b64 v[30:31], 0
  v_mov_b64 v[32:33], 0
  v_mov_b64 v[34:35], 0
  s_mov_b32 s78, 0x3f803f80
  s_mov_b32 s79, s78
  s_mov_b32 s65, 360448
  s_mov_b32 m0, 15872
  s_lshl_b32 s71, s53, 2
  s_add_u32 s71, s71, 128
  s_movk_i32 s56, 0x1000
  v_lshlrev_b32 v73, 2, v76
  v_mov_b32 v72, 0
  s_mov_b64 s[16:17], s[8:9]
  s_mov_b32 s18, 268435456
  s_mov_b32 s19, 0x20000
  s_getpc_b64 s[20:21]
Cs2_pc:
  s_add_u32 s20, s20, (Cs2_last - Cs2_pc)
  s_addc_u32 s21, s21, 0
  v_mov_b32 v68, 14880
  buffer_load_dwordx4 v[52:55], v76, s[8:11], s59 offen offset:0 sc1
  buffer_load_dwordx4 v[56:59], v76, s[8:11], s59 offen offset:1024 sc1
  ds_read_b128 v[36:39], v76 offset:24576
  ds_read_b128 v[40:43], v76 offset:25600
  ds_read_b128 v[60:63], v76 offset:26624
  ds_read_b128 v[64:67], v76 offset:27648
  ds_read_b128 v[0:3], v76 offset:4608
  ds_read_b128 v[4:7], v76 offset:5632
  ds_read_b128 v[8:11], v76 offset:6656
  ds_read_b128 v[12:15], v76 offset:7680
  s_waitcnt lgkmcnt(0)
  s_cmp_eq_u32 s66, 1
  s_branch Cs2_top2
.p2align 6
Cs2_h2:
  ds_read_b128 v[36:39], v76 offset:24576
  s_cmp_eq_u32 s66, 62
  s_cselect_b64 s[16:17], s[20:21], s[16:17]
  s_cselect_b32 s18, (Cs2_done - Cs2_last), s18
  s_cselect_b32 s70, 0, s70
  s_cmp_eq_u32 s66, 63
  s_cselect_b32 s59, 268435456, s59
  s_cselect_b32 s58, 268435456, s58
  ds_read_b128 v[40:43], v76 offset:25600
  v_mov_b64 v[20:21], 0
  v_mov_b64 v[22:23], 0
  v_mov_b64 v[24:25], 0
  v_mov_b64 v[26:27], 0
  v_mov_b32 v68, 14880
  v_lshlrev_b32 v73, 2, v76
  buffer_load_dwordx4 v[52:55], v76, s[8:11], s59 offen offset:0 sc1
  buffer_load_dwordx4 v[56:59], v76, s[8:11], s59 offen offset:1024 sc1
  s_waitcnt vmcnt(0)
  s_mov_b64 vcc, -1
Cs2_h2r:
  s_mov_b64 exec, vcc
  buffer_load_dwordx4 v[12:15], v76, s[8:11], s65 offen offset:3072 sc1
  buffer_load_dwordx4 v[0:3], v76, s[8:11], s85 offen offset:0 sc1
  s_mov_b64 exec, -1
  s_add_u32 s67, s67, 1
  s_cmp_lt_u32 s67, 131072
  s_cselect_b32 s54, -2, -1
  s_waitcnt vmcnt(1)
  v_max3_u32 v72, v12, v13, v14
  s_waitcnt vmcnt(0)
  v_max3_u32 v72, v72, v15, v0
  v_max3_u32 v72, v72, v1, v2
  v_max_u32 v72, v72, v3
  v_cmp_lt_u32 vcc, s54, v72
  s_cbranch_vccnz Cs2_h2r
  ds_write_b128 v76, v[12:15] offset:7680
  ds_write_b128 v76, v[0:3] offset:12800
Cs2_h2w:
  s_cmp_eq_u32 s66, 63
  s_waitcnt lgkmcnt(0)
  s_barrier
  ds_read_b128 v[0:3], v76 offset:4608
Cs2_top2:
  v_smfmac_f32_16x16x64_bf16 v[20:23], v[12:15], v[128:135], v74
  s_cbranch_scc1 Cs2_last
  v_smfmac_f32_16x16x64_bf16 v[24:27], v[12:15], v[136:143], v74
  buffer_load_dwordx4 v[44:47], v76, s[8:11], s58 offen offset:0 sc1
  s_mov_b32 m0, 15872
  v_smfmac_f32_16x16x64_bf16 v[28:31], v[12:15], v[224:231], v74
  buffer_load_dwordx4 v[48:51], v76, s[8:11], s58 offen offset:1024 sc1
  v_smfmac_f32_16x16x64_bf16 v[32:35], v[12:15], v[232:239], v74
  ds_read_b128 v[4:7], v76 offset:5632
  s_waitcnt lgkmcnt(1)
  v_smfmac_f32_16x16x64_bf16 v[20:23], v[0:3], v[80:87], v74
  ds_read_b128 v[8:11], v76 offset:6656
  v_smfmac_f32_16x16x64_bf16 v[28:31], v[0:3], v[36:43], v74
  ds_read_b128 v[36:39], v76 offset:40960
  v_smfmac_f32_16x16x64_bf16 v[24:27], v[0:3], v[88:95], v74
  buffer_store_dwordx4 v[16:19], v76, s[8:11], s68 offen sc1
  ds_read_b128 v[40:43], v76 offset:41984
  v_smfmac_f32_16x16x64_bf16 v[32:35], v[0:3], v[60:67], v74
  buffer_load_dword v73, s[16:19], s70 offen lds
  ds_read_b128 v[60:63], v76 offset:43008
  s_waitcnt lgkmcnt(4)
  v_smfmac_f32_16x16x64_bf16 v[20:23], v[4:7], v[96:103], v74
  ds_read_b128 v[64:67], v76 offset:44032
  v_smfmac_f32_16x16x64_bf16 v[24:27], v[4:7], v[104:111], v74
  s_waitcnt vmcnt(4)
  s_waitcnt lgkmcnt(4)
  v_smfmac_f32_16x16x64_bf16 v[20:23], v[8:11], v[112:119], v74
  s_barrier
  ds_read_b128 v[12:15], v76 offset:8704
  s_waitcnt lgkmcnt(3)
  v_smfmac_f32_16x16x64_bf16 v[28:31], v[4:7], v[36:43], v74
  ds_read_b128 v[36:39], v76 offset:57344
  v_smfmac_f32_16x16x64_bf16 v[24:27], v[8:11], v[120:127], v74
  ds_read_b128 v[40:43], v76 offset:58368
  s_waitcnt lgkmcnt(3)
  v_smfmac_f32_16x16x64_bf16 v[32:35], v[4:7], v[60:67], v74
  ds_read_b128 v[0:3], v76 offset:9728
  v_smfmac_f32_16x16x64_bf16 v[28:31], v[8:11], v[208:215], v74
  ds_read_b128 v[60:63], v76 offset:59392
  v_smfmac_f32_16x16x64_bf16 v[32:35], v[8:11], v[216:223], v74
  ds_read_b128 v[64:67], v76 offset:60416
  s_waitcnt lgkmcnt(5)
  v_smfmac_f32_16x16x64_bf16 v[20:23], v[12:15], v[144:151], v74
  s_barrier
  ds_read_b128 v[4:7], v76 offset:11776
  s_waitcnt lgkmcnt(4)
  v_smfmac_f32_16x16x64_bf16 v[28:31], v[12:15], v[36:43], v74
  ds_read_b128 v[8:11], v76 offset:12800
  ds_read_b128 v[36:39], v75 offset:8192
  v_smfmac_f32_16x16x64_bf16 v[24:27], v[12:15], v[152:159], v74
  ds_read_b128 v[16:19], v76 offset:10752
  s_waitcnt lgkmcnt(6)
  v_smfmac_f32_16x16x64_bf16 v[20:23], v[0:3], v[160:167], v74
  ds_read_b128 v[40:43], v75 offset:9216
  s_waitcnt lgkmcnt(5)
  v_smfmac_f32_16x16x64_bf16 v[32:35], v[12:15], v[60:67], v74
  ds_read_b128 v[60:63], v75 offset:10240
  v_smfmac_f32_16x16x64_bf16 v[24:27], v[0:3], v[168:175], v74
  ds_read_b128 v[64:67], v75 offset:11264
  s_waitcnt lgkmcnt(6)
  v_smfmac_f32_16x16x64_bf16 v[20:23], v[4:7], v[176:183], v74
  s_waitcnt lgkmcnt(5)
  v_smfmac_f32_16x16x64_bf16 v[20:23], v[8:11], v[192:199], v74
  s_waitcnt lgkmcnt(2)
  v_smfmac_f32_16x16x64_bf16 v[20:23], v[16:19], v[36:43], v74
  ds_read_b128 v[36:39], v75 offset:24576
  v_smfmac_f32_16x16x64_bf16 v[24:27], v[4:7], v[184:191], v74
  ds_read_b128 v[40:43], v75 offset:25600
  s_waitcnt lgkmcnt(2)
  v_smfmac_f32_16x16x64_bf16 v[24:27], v[16:19], v[60:67], v74
  ds_read_b128 v[60:63], v75 offset:26624
  v_add_f32 v20, v20, v22
  v_smfmac_f32_16x16x64_bf16 v[24:27], v[8:11], v[200:207], v74
  ds_read_b128 v[64:67], v75 offset:27648
  v_add_f32 v21, v21, v23
  v_smfmac_f32_16x16x64_bf16 v[28:31], v[16:19], v[240:247], v74
  v_mov_b64 v[70:71], s[78:79]
  v_smfmac_f32_16x16x64_bf16 v[28:31], v[4:7], a[0:7], v74
  s_waitcnt lgkmcnt(2)
  v_add_f32 v24, v24, v26
  v_smfmac_f32_16x16x64_bf16 v[28:31], v[0:3], v[36:43], v74
  ds_read_b128 v[36:39], v68
  v_cvt_pk_bf16_f32 v22, v20, v24
  v_smfmac_f32_16x16x64_bf16 v[28:31], v[8:11], a[16:23], v74
  ds_read_b128 v[40:43], v68
  ds_write_b32 v79, v22 offset:0
  s_waitcnt lgkmcnt(3)
  v_add_f32 v25, v25, v27
  v_cvt_pk_bf16_f32 v23, v21, v25
  v_smfmac_f32_16x16x64_bf16 v[32:35], v[0:3], v[60:67], v74
  ds_write_b32 v79, v23 offset:576
  v_cmp_u_f32 vcc, v20, v21
  v_smfmac_f32_16x16x64_bf16 v[32:35], v[16:19], v[248:255], v74
  v_add_f32 v28, v28, v30
  v_smfmac_f32_16x16x64_bf16 v[32:35], v[4:7], a[8:15], v74
  v_add_f32 v29, v29, v31
  v_smfmac_f32_16x16x64_bf16 v[32:35], v[8:11], a[24:31], v74
  s_cbranch_vccnz Cs2_rec
Cs2_recok:
  s_waitcnt lgkmcnt(3)
  v_smfmac_f32_16x16x64_bf16 v[36:39], v[16:19], a[128:135], v74
  s_waitcnt lgkmcnt(0)
  s_barrier
  ds_read_b128 v[60:63], v77
  v_smfmac_f32_16x16x64_bf16 v[40:43], v[16:19], a[136:143], v74
  ds_read_b128 v[64:67], v77 offset:128
  v_add_f32 v32, v32, v34
  v_cvt_pk_bf16_f32 v30, v28, v32
  v_smfmac_f32_16x16x64_bf16 v[36:39], v[0:3], a[112:119], v74
  ds_write_b32 v79, v30 offset:256
  v_add_f32 v33, v33, v35
  v_cvt_pk_bf16_f32 v31, v29, v33
  v_smfmac_f32_16x16x64_bf16 v[40:43], v[0:3], a[120:127], v74
  ds_write_b32 v79, v31 offset:832
  v_xor_b32 v75, 0x8000, v75
  v_smfmac_f32_16x16x64_bf16 v[36:39], v[4:7], a[144:151], v74
  ds_read_b128 v[0:3], v76 offset:4608
  v_mov_b32 v29, 0
  v_smfmac_f32_16x16x64_bf16 v[40:43], v[4:7], a[152:159], v74
  s_waitcnt vmcnt(2) lgkmcnt(3)
  v_mov_b32 v30, 0
  v_mfma_f32_16x16x32_bf16 v[44:47], v[44:47], v[60:63], 0
  ds_read_b128 v[4:7], v76 offset:5632
  s_waitcnt lgkmcnt(2)
  v_mfma_f32_16x16x32_bf16 v[44:47], v[48:51], v[64:67], v[44:47]
  s_barrier
  v_smfmac_f32_16x16x64_bf16 v[36:39], v[8:11], a[160:167], v74
  ds_read_b128 v[20:23], v77 offset:256
  ds_read_b128 v[24:27], v77 offset:384
  v_smfmac_f32_16x16x64_bf16 v[40:43], v[8:11], a[168:175], v74
  ds_read_b128 v[8:11], v76 offset:6656
  v_add_f32_dpp v72, v46, v44 quad_perm:[2,3,0,1] row_mask:0xf bank_mask:0xf
  v_add_f32_dpp v73, v47, v45 quad_perm:[2,3,0,1] row_mask:0xf bank_mask:0xf
  v_smfmac_f32_16x16x64_bf16 v[36:39], v[12:15], a[96:103], v74
  s_waitcnt lgkmcnt(4)
  v_exp_f32_dpp v72, v72 quad_perm:[0,1,0,1] row_mask:0xf bank_mask:0xf
  v_smfmac_f32_16x16x64_bf16 v[40:43], v[12:15], a[104:111], v74
  ds_read_b128 v[12:15], v76 offset:7680
  v_exp_f32_dpp v73, v73 quad_perm:[0,1,0,1] row_mask:0xf bank_mask:0xf
  v_smfmac_f32_16x16x64_bf16 v[36:39], v[0:3], a[32:39], v74
  s_waitcnt lgkmcnt(2)
  v_cvt_pk_bf16_f32 v72, v72, v73
  v_mfma_f32_16x16x32_bf16 v[20:23], v[20:23], v[60:63], 0
  ds_write_b32 v78, v72 offset:520
  v_mov_b64 v[16:17], 0
  v_mfma_f32_16x16x32_bf16 v[20:23], v[24:27], v[64:67], v[20:23]
  ds_read_b128 v[44:47], v75 offset:40960
  v_mov_b64 v[18:19], 0
  v_smfmac_f32_16x16x64_bf16 v[40:43], v[0:3], a[40:47], v74
  ds_read_b128 v[48:51], v75 offset:41984
  v_mov_b64 v[68:69], s[78:79]
  v_smfmac_f32_16x16x64_bf16 v[36:39], v[4:7], a[48:55], v74
  s_waitcnt lgkmcnt(4)
  v_add_f32_dpp v24, v22, v20 quad_perm:[2,3,0,1] row_mask:0xf bank_mask:0xf
  v_add_f32_dpp v25, v23, v21 quad_perm:[2,3,0,1] row_mask:0xf bank_mask:0xf
  v_smfmac_f32_16x16x64_bf16 v[36:39], v[8:11], a[64:71], v74
  s_waitcnt lgkmcnt(2)
  s_barrier
  ds_read_b128 v[32:35], v78 offset:512
  v_smfmac_f32_16x16x64_bf16 v[36:39], v[12:15], a[80:87], v74
  ds_read_b128 v[60:63], v75 offset:24576
  v_mul_f32 v24, s69, v24
  v_smfmac_f32_16x16x64_bf16 v[40:43], v[4:7], a[56:63], v74
  ds_read_b128 v[64:67], v75 offset:25600
  v_mul_f32 v25, s69, v25
  v_smfmac_f32_16x16x64_bf16 v[40:43], v[8:11], a[72:79], v74
  v_exp_f32_dpp v24, v24 quad_perm:[0,1,0,1] row_mask:0xf bank_mask:0xf
  v_smfmac_f32_16x16x64_bf16 v[40:43], v[12:15], a[88:95], v74
  s_waitcnt lgkmcnt(2)
  v_exp_f32_dpp v25, v25 quad_perm:[0,1,0,1] row_mask:0xf bank_mask:0xf
  v_mfma_f32_16x16x32_bf16 v[8:11], v[32:35], v[68:71], 0
  v_add_f32 v36, v36, v38
  v_add_f32 v37, v37, v39
  v_mfma_f32_16x16x32_bf16 v[0:3], v[32:35], v[52:55], 0
  v_add_f32 v40, v40, v42
  v_add_f32 v41, v41, v43
  v_mfma_f32_16x16x32_bf16 v[4:7], v[32:35], v[56:59], 0
  v_cvt_pk_bf16_f32 v28, v24, v25
  v_cvt_pk_bf16_f32 v72, v36, v37
  v_cvt_pk_bf16_f32 v73, v40, v41
  v_mfma_f32_16x16x16_bf16 v[8:11], v[28:29], v[68:69], v[8:11]
  v_cvt_pk_bf16_f32 v31, v24, v25
  v_mov_b64 v[20:21], 0
  v_mfma_f32_16x16x16_bf16 v[0:3], v[28:29], v[72:73], v[0:3]
  ds_read_b128 v[52:55], v75 offset:26624
  v_mov_b64 v[22:23], 0
  v_mfma_f32_16x16x16_bf16 v[4:7], v[30:31], v[72:73], v[4:7]
  v_rcp_f32 v10, v8
  v_rcp_f32 v11, v9
  v_mul_f32 v0, v10, v0
  v_mul_f32 v1, v11, v1
  v_max3_f32 v8, v8, v9, v10
  v_mul_f32 v4, v10, v4
  v_mul_f32 v5, v11, v5
  v_cvt_pk_bf16_f32 v2, v0, v4
  ds_write_b32 v79, v2 offset:8704
  v_cvt_pk_bf16_f32 v3, v1, v5
  ds_write_b32 v79, v3 offset:9280
  ds_read_b128 v[12:15], v78 offset:8832
  v_max_f32 v8, v8, v11
  v_cmp_le_f32 vcc, 1317011456, v8
  v_mov_b64 v[24:25], 0
  v_mov_b64 v[26:27], 0
  ds_read_b128 v[56:59], v75 offset:27648
  s_cbranch_vccnz Cs2_mx
Cs2_mxok:
  s_waitcnt lgkmcnt(2)
  s_barrier
  ds_read_b128 v[0:3], v78 offset:8896
  s_waitcnt lgkmcnt(2)
  v_smfmac_f32_16x16x64_bf16 v[16:19], v[12:15], a[176:183], v74
  ds_read_b128 v[4:7], v78 offset:8704
  v_smfmac_f32_16x16x64_bf16 v[20:23], v[12:15], v[44:51], v74
  ds_read_b128 v[8:11], v78 offset:8768
  v_smfmac_f32_16x16x64_bf16 v[24:27], v[12:15], a[224:231], v74
  ds_read_b128 v[36:39], v75 offset:43008
  s_waitcnt lgkmcnt(3)
  v_smfmac_f32_16x16x64_bf16 v[16:19], v[0:3], a[184:191], v74
  ds_read_b128 v[40:43], v75 offset:44032
  s_waitcnt lgkmcnt(3)
  v_smfmac_f32_16x16x64_bf16 v[16:19], v[4:7], v[60:67], v74
  ds_read_b128 v[68:71], v76 offset:13824
  s_waitcnt lgkmcnt(3)
  v_smfmac_f32_16x16x64_bf16 v[16:19], v[8:11], v[52:59], v74
  ds_read_b128 v[44:47], v75 offset:57344
  v_smfmac_f32_16x16x64_bf16 v[20:23], v[4:7], a[192:199], v74
  ds_read_b128 v[48:51], v75 offset:58368
  v_smfmac_f32_16x16x64_bf16 v[20:23], v[8:11], a[200:207], v74
  ds_read_b128 v[60:63], v75 offset:59392
  s_waitcnt lgkmcnt(4)
  v_cvt_pk_bf16_f32 v16, v16, v17
  v_cvt_pk_bf16_f32 v17, v18, v19
  v_bfi_b32 v16, 1, s72, v16
  v_smfmac_f32_16x16x64_bf16 v[20:23], v[0:3], v[36:43], v74
  s_waitcnt lgkmcnt(3)
  buffer_store_dwordx2 v[16:17], v68, s[8:11], s73 offen sc1
  v_mov_b64 v[32:33], 0
  v_smfmac_f32_16x16x64_bf16 v[24:27], v[4:7], a[208:215], v74
  ds_read_b128 v[64:67], v75 offset:60416
  v_mov_b64 v[34:35], 0
  v_smfmac_f32_16x16x64_bf16 v[24:27], v[8:11], a[216:223], v74
  ds_read_b128 v[52:55], v75 offset:0
  v_cvt_pk_bf16_f32 v20, v20, v21
  v_cvt_pk_bf16_f32 v21, v22, v23
  v_bfi_b32 v20, 1, s72, v20
  v_smfmac_f32_16x16x64_bf16 v[24:27], v[0:3], a[232:239], v74
  ds_read_b128 v[56:59], v75 offset:1024
  buffer_store_dwordx2 v[20:21], v68, s[8:11], s74 offen sc1
  s_waitcnt lgkmcnt(4)
  v_mov_b64 v[28:29], 0
  v_smfmac_f32_16x16x64_bf16 v[32:35], v[4:7], v[44:51], v74
  ds_read_b128 v[36:39], v75 offset:2048
  ds_read_b128 v[40:43], v75 offset:3072
  s_waitcnt lgkmcnt(4)
  v_smfmac_f32_16x16x64_bf16 v[32:35], v[8:11], v[60:67], v74
  ds_read_b128 v[44:47], v75 offset:4096
  v_cvt_pk_bf16_f32 v24, v24, v25
  v_cvt_pk_bf16_f32 v25, v26, v27
  v_bfi_b32 v24, 1, s72, v24
  v_smfmac_f32_16x16x64_bf16 v[32:35], v[12:15], a[240:247], v74
  ds_read_b128 v[48:51], v75 offset:5120
  buffer_store_dwordx2 v[24:25], v68, s[8:11], s75 offen sc1
  v_mov_b64 v[30:31], 0
  v_smfmac_f32_16x16x64_bf16 v[32:35], v[0:3], a[248:255], v74
  ds_read_b128 v[60:63], v75 offset:6144
  ds_read_b128 v[64:67], v75 offset:7168
  s_waitcnt lgkmcnt(6)
  v_smfmac_f32_16x16x64_bf16 v[28:31], v[4:7], v[52:59], v74
  s_waitcnt lgkmcnt(4)
  v_smfmac_f32_16x16x64_bf16 v[28:31], v[8:11], v[36:43], v74
  s_waitcnt lgkmcnt(2)
  v_cvt_pk_bf16_f32 v32, v32, v33
  v_cvt_pk_bf16_f32 v33, v34, v35
  v_bfi_b32 v32, 1, s72, v32
  v_smfmac_f32_16x16x64_bf16 v[28:31], v[12:15], v[44:51], v74
  buffer_store_dwordx2 v[32:33], v68, s[8:11], s76 offen sc1
  s_waitcnt lgkmcnt(0)
  v_smfmac_f32_16x16x64_bf16 v[28:31], v[0:3], v[60:67], v74
  v_mov_b64 v[18:19], v[72:73]
  s_nop 4
  v_cvt_pk_bf16_f32 v28, v28, v29
  v_cvt_pk_bf16_f32 v29, v30, v31
  v_bfi_b32 v28, 1, s72, v28
  buffer_store_dwordx2 v[28:29], v68, s[8:11], s77 offen sc1
  ds_read_b128 v[0:3], v76 offset:14848
  s_waitcnt lgkmcnt(0)
  ds_read_b64 v[16:17], v77 offset:384
  s_waitcnt lgkmcnt(0)
  ds_read_b128 v[64:67], v76 offset:27648
  s_waitcnt lgkmcnt(0)
  ds_read_b128 v[60:63], v76 offset:26624
  s_waitcnt lgkmcnt(0)
  v_xor_b32 v75, 0x8000, v75
  v_mov_b64 v[28:29], 0
  v_mov_b64 v[30:31], 0
  v_mov_b64 v[32:33], 0
  v_mov_b64 v[34:35], 0
  s_waitcnt vmcnt(0)
  buffer_load_dwordx4 v[52:55], v76, s[8:11], s60 offen offset:0 sc1
  buffer_load_dwordx4 v[56:59], v76, s[8:11], s60 offen offset:1024 sc1
  s_add_u32 s66, s66, 1
  s_xor_b32 s64, s64, 16384
  s_xor_b32 s65, s65, 16384
  s_add_u32 s58, s58, 655360
  s_add_u32 s59, s59, 655360
  s_add_u32 s70, s70, 655360
  s_add_u32 s68, s68, 655360
  s_mov_b32 m0, 12800
  s_add_u32 s85, s65, 8192
  s_waitcnt lgkmcnt(0)
  s_waitcnt vmcnt(1)
  v_mfma_f32_16x16x32_bf16 v[4:7], v[0:3], v[52:55], 0
  v_bitop3_b32 v72, v52, v54, s72 bitop3:0x7e
  s_waitcnt vmcnt(0)
  v_mfma_f32_16x16x32_bf16 v[4:7], v[0:3], v[56:59], v[4:7]
  v_bitop3_b32 v73, v56, v58, s72 bitop3:0x7e
  v_bitop3_b32 v72, v72, v73, 1 bitop3:0xa8
  v_cmp_ne_u32 vcc, 0, v72
  s_cbranch_vccnz Cs2_h1r
  s_nop 2
  v_add_f32_dpp v4, v4, v4 row_ror:4 row_mask:0xf bank_mask:0xf
  v_add_f32_dpp v5, v5, v5 row_ror:4 row_mask:0xf bank_mask:0xf
  s_nop 0
  v_add_f32_dpp v4, v4, v4 row_ror:8 row_mask:0xf bank_mask:0xf
  v_add_f32_dpp v5, v5, v5 row_ror:8 row_mask:0xf bank_mask:0xf
  v_cvt_pk_bf16_f32 v4, v4, v5
  buffer_store_dword v4, v69, s[8:11], s62 offen sc1
  s_xor_b32 s62, s62, 16384
  buffer_store_dword v71, v69, s[8:11], s62 offen sc1
  s_xor_b32 s72, s72, 1
  s_branch Cs2_h2
Cs2_h1r:
  s_mov_b64 exec, vcc
  buffer_load_dwordx4 v[52:55], v76, s[8:11], s60 offen offset:0 sc1
  buffer_load_dwordx4 v[56:59], v76, s[8:11], s60 offen offset:1024 sc1
  s_mov_b64 exec, -1
  s_add_u32 s67, s67, 1
  s_waitcnt vmcnt(1)
  v_mfma_f32_16x16x32_bf16 v[4:7], v[0:3], v[52:55], 0
  v_bitop3_b32 v72, v52, v54, s72 bitop3:0x7e
  s_waitcnt vmcnt(0)
  v_mfma_f32_16x16x32_bf16 v[4:7], v[0:3], v[56:59], v[4:7]
  v_bitop3_b32 v73, v56, v58, s72 bitop3:0x7e
  v_bitop3_b32 v72, v72, v73, 1 bitop3:0xa8
  v_cmp_ne_u32 vcc, 0, v72
  s_cbranch_vccz Cs2_h1p
Cs2_h1s:
  s_mov_b64 exec, vcc
  buffer_load_dwordx4 v[52:55], v76, s[8:11], s60 offen offset:0 sc1
  buffer_load_dwordx4 v[56:59], v76, s[8:11], s60 offen offset:1024 sc1
  s_mov_b64 exec, -1
  s_add_u32 s67, s67, 1
  s_waitcnt vmcnt(1)
  v_mfma_f32_16x16x32_bf16 v[4:7], v[0:3], v[52:55], 0
  v_bitop3_b32 v72, v52, v54, s72 bitop3:0x7e
  s_waitcnt vmcnt(0)
  v_mfma_f32_16x16x32_bf16 v[4:7], v[0:3], v[56:59], v[4:7]
  v_bitop3_b32 v73, v56, v58, s72 bitop3:0x7e
  v_bitop3_b32 v72, v72, v73, 1 bitop3:0xa8
  v_cmp_ne_u32 vcc, 0, v72
  s_cbranch_vccz Cs2_h1p
  s_cmp_lt_u32 s67, 131072
  s_cbranch_scc1 Cs2_h1s
Cs2_h1p:
  s_nop 2
  v_add_f32_dpp v4, v4, v4 row_ror:4 row_mask:0xf bank_mask:0xf
  v_add_f32_dpp v5, v5, v5 row_ror:4 row_mask:0xf bank_mask:0xf
  s_nop 0
  v_add_f32_dpp v4, v4, v4 row_ror:8 row_mask:0xf bank_mask:0xf
  v_add_f32_dpp v5, v5, v5 row_ror:8 row_mask:0xf bank_mask:0xf
  v_cvt_pk_bf16_f32 v4, v4, v5
  buffer_store_dword v4, v69, s[8:11], s62 offen sc1
  s_xor_b32 s62, s62, 16384
  buffer_store_dword v71, v69, s[8:11], s62 offen sc1
  s_xor_b32 s72, s72, 1
  s_branch Cs2_h2
Cs2_rec:
  s_nop 7
  s_waitcnt vmcnt(0) lgkmcnt(0)
  v_max3_u32 v72, v0, v1, v2
  v_max3_u32 v72, v72, v3, v4
  v_max3_u32 v72, v72, v5, v6
  v_max3_u32 v72, v72, v7, v8
  v_max3_u32 v72, v72, v9, v10
  v_max3_u32 v72, v72, v11, v12
  v_max3_u32 v72, v72, v13, v14
  v_max3_u32 v72, v72, v15, v16
  v_max3_u32 v72, v72, v17, v18
  v_max_u32 v72, v72, v19
  v_cmp_eq_u32 vcc, -1, v72
  s_cbranch_vccz Cs2_recok
  s_barrier
Cs2_recp:
  buffer_load_dwordx4 v[0:3], v76, s[8:11], s64 offen offset:0 sc1
  buffer_load_dwordx4 v[4:7], v76, s[8:11], s64 offen offset:1024 sc1
  s_add_u32 s67, s67, 1
  s_cmp_lt_u32 s67, 131072
  s_cselect_b32 s54, -2, -1
  s_waitcnt vmcnt(1)
  v_max3_u32 v72, v0, v1, v2
  s_waitcnt vmcnt(0)
  v_max3_u32 v72, v72, v3, v4
  v_max3_u32 v72, v72, v5, v6
  v_max_u32 v72, v72, v7
  v_cmp_lt_u32 vcc, s54, v72
  s_cbranch_vccnz Cs2_recp
  ds_write_b128 v76, v[0:3] offset:8704
  ds_write_b128 v76, v[4:7] offset:9728
  v_mov_b64 v[20:21], 0
  v_mov_b64 v[22:23], 0
  v_mov_b64 v[24:25], 0
  v_mov_b64 v[26:27], 0
  v_mov_b64 v[28:29], 0
  v_mov_b64 v[30:31], 0
  v_mov_b64 v[32:33], 0
  v_mov_b64 v[34:35], 0
  s_waitcnt lgkmcnt(0)
  s_barrier
  ds_read_b128 v[0:3], v76 offset:4608
  s_waitcnt lgkmcnt(0)
  v_smfmac_f32_16x16x64_bf16 v[20:23], v[0:3], v[80:87], v74
  v_smfmac_f32_16x16x64_bf16 v[24:27], v[0:3], v[88:95], v74
  ds_read_b128 v[60:63], v76 offset:24576
  ds_read_b128 v[64:67], v76 offset:25600
  s_waitcnt lgkmcnt(0)
  v_smfmac_f32_16x16x64_bf16 v[28:31], v[0:3], v[60:67], v74
  ds_read_b128 v[60:63], v76 offset:26624
  ds_read_b128 v[64:67], v76 offset:27648
  s_waitcnt lgkmcnt(0)
  v_smfmac_f32_16x16x64_bf16 v[32:35], v[0:3], v[60:67], v74
  ds_read_b128 v[4:7], v76 offset:5632
  s_waitcnt lgkmcnt(0)
  v_smfmac_f32_16x16x64_bf16 v[20:23], v[4:7], v[96:103], v74
  v_smfmac_f32_16x16x64_bf16 v[24:27], v[4:7], v[104:111], v74
  ds_read_b128 v[60:63], v76 offset:40960
  ds_read_b128 v[64:67], v76 offset:41984
  s_waitcnt lgkmcnt(0)
  v_smfmac_f32_16x16x64_bf16 v[28:31], v[4:7], v[60:67], v74
  ds_read_b128 v[60:63], v76 offset:43008
  ds_read_b128 v[64:67], v76 offset:44032
  s_waitcnt lgkmcnt(0)
  v_smfmac_f32_16x16x64_bf16 v[32:35], v[4:7], v[60:67], v74
  ds_read_b128 v[8:11], v76 offset:6656
  s_waitcnt lgkmcnt(0)
  v_smfmac_f32_16x16x64_bf16 v[20:23], v[8:11], v[112:119], v74
  v_smfmac_f32_16x16x64_bf16 v[24:27], v[8:11], v[120:127], v74
  v_smfmac_f32_16x16x64_bf16 v[28:31], v[8:11], v[208:215], v74
  v_smfmac_f32_16x16x64_bf16 v[32:35], v[8:11], v[216:223], v74
  ds_read_b128 v[12:15], v76 offset:7680
  s_waitcnt lgkmcnt(0)
  v_smfmac_f32_16x16x64_bf16 v[20:23], v[12:15], v[128:135], v74
  v_smfmac_f32_16x16x64_bf16 v[24:27], v[12:15], v[136:143], v74
  v_smfmac_f32_16x16x64_bf16 v[28:31], v[12:15], v[224:231], v74
  v_smfmac_f32_16x16x64_bf16 v[32:35], v[12:15], v[232:239], v74
  ds_read_b128 v[12:15], v76 offset:8704
  s_waitcnt lgkmcnt(0)
  v_smfmac_f32_16x16x64_bf16 v[20:23], v[12:15], v[144:151], v74
  v_smfmac_f32_16x16x64_bf16 v[24:27], v[12:15], v[152:159], v74
  ds_read_b128 v[60:63], v76 offset:57344
  ds_read_b128 v[64:67], v76 offset:58368
  s_waitcnt lgkmcnt(0)
  v_smfmac_f32_16x16x64_bf16 v[28:31], v[12:15], v[60:67], v74
  ds_read_b128 v[60:63], v76 offset:59392
  ds_read_b128 v[64:67], v76 offset:60416
  s_waitcnt lgkmcnt(0)
  v_smfmac_f32_16x16x64_bf16 v[32:35], v[12:15], v[60:67], v74
  ds_read_b128 v[0:3], v76 offset:9728
  s_waitcnt lgkmcnt(0)
  v_smfmac_f32_16x16x64_bf16 v[20:23], v[0:3], v[160:167], v74
  v_smfmac_f32_16x16x64_bf16 v[24:27], v[0:3], v[168:175], v74
  ds_read_b128 v[60:63], v75 offset:24576
  ds_read_b128 v[64:67], v75 offset:25600
  s_waitcnt lgkmcnt(0)
  v_smfmac_f32_16x16x64_bf16 v[28:31], v[0:3], v[60:67], v74
  ds_read_b128 v[60:63], v75 offset:26624
  ds_read_b128 v[64:67], v75 offset:27648
  s_waitcnt lgkmcnt(0)
  v_smfmac_f32_16x16x64_bf16 v[32:35], v[0:3], v[60:67], v74
  ds_read_b128 v[16:19], v76 offset:10752
  ds_read_b128 v[60:63], v75 offset:8192
  ds_read_b128 v[64:67], v75 offset:9216
  s_waitcnt lgkmcnt(0)
  v_smfmac_f32_16x16x64_bf16 v[20:23], v[16:19], v[60:67], v74
  ds_read_b128 v[60:63], v75 offset:10240
  ds_read_b128 v[64:67], v75 offset:11264
  s_waitcnt lgkmcnt(0)
  v_smfmac_f32_16x16x64_bf16 v[24:27], v[16:19], v[60:67], v74
  v_smfmac_f32_16x16x64_bf16 v[28:31], v[16:19], v[240:247], v74
  v_smfmac_f32_16x16x64_bf16 v[32:35], v[16:19], v[248:255], v74
  ds_read_b128 v[4:7], v76 offset:11776
  s_waitcnt lgkmcnt(0)
  v_smfmac_f32_16x16x64_bf16 v[20:23], v[4:7], v[176:183], v74
  v_smfmac_f32_16x16x64_bf16 v[24:27], v[4:7], v[184:191], v74
  v_smfmac_f32_16x16x64_bf16 v[28:31], v[4:7], a[0:7], v74
  v_smfmac_f32_16x16x64_bf16 v[32:35], v[4:7], a[8:15], v74
  ds_read_b128 v[8:11], v76 offset:12800
  s_waitcnt lgkmcnt(0)
  v_smfmac_f32_16x16x64_bf16 v[20:23], v[8:11], v[192:199], v74
  v_smfmac_f32_16x16x64_bf16 v[24:27], v[8:11], v[200:207], v74
  v_smfmac_f32_16x16x64_bf16 v[28:31], v[8:11], a[16:23], v74
  v_smfmac_f32_16x16x64_bf16 v[32:35], v[8:11], a[24:31], v74
  v_add_f32 v20, v20, v22
  v_add_f32 v21, v21, v23
  v_add_f32 v24, v24, v26
  v_cvt_pk_bf16_f32 v22, v20, v24
  ds_write_b32 v79, v22 offset:0
  v_add_f32 v25, v25, v27
  v_cvt_pk_bf16_f32 v23, v21, v25
  ds_write_b32 v79, v23 offset:576
  v_add_f32 v28, v28, v30
  v_add_f32 v29, v29, v31
  s_waitcnt lgkmcnt(0)
  s_nop 1
  s_branch Cs2_recok
Cs2_mx:
  s_waitcnt lgkmcnt(0)
  s_barrier
  buffer_load_dwordx4 v[52:55], v76, s[8:11], s59 offen offset:0 sc1
  buffer_load_dwordx4 v[0:3], v76, s[8:11], s58 offen offset:0 sc1
  ds_read_b128 v[20:23], v77 offset:0
  ds_read_b128 v[28:31], v77 offset:256
  buffer_load_dwordx4 v[56:59], v76, s[8:11], s59 offen offset:1024 sc1
  buffer_load_dwordx4 v[4:7], v76, s[8:11], s58 offen offset:1024 sc1
  ds_read_b128 v[24:27], v77 offset:128
  ds_read_b128 v[32:35], v77 offset:384
  s_waitcnt vmcnt(2) lgkmcnt(3)
  v_mfma_f32_16x16x32_bf16 v[8:11], v[0:3], v[20:23], 0
  s_waitcnt vmcnt(0) lgkmcnt(1)
  v_mfma_f32_16x16x32_bf16 v[8:11], v[4:7], v[24:27], v[8:11]
  v_mfma_f32_16x16x32_bf16 v[12:15], v[28:31], v[20:23], 0
  s_waitcnt lgkmcnt(0)
  v_mfma_f32_16x16x32_bf16 v[12:15], v[32:35], v[24:27], v[12:15]
  v_add_f32_dpp v8, v10, v8 quad_perm:[2,3,0,1] row_mask:0xf bank_mask:0xf
  v_add_f32_dpp v9, v11, v9 quad_perm:[2,3,0,1] row_mask:0xf bank_mask:0xf
  s_nop 0
  v_mov_b32_dpp v8, v8 quad_perm:[0,1,0,1] row_mask:0xf bank_mask:0xf
  v_mov_b32_dpp v9, v9 quad_perm:[0,1,0,1] row_mask:0xf bank_mask:0xf
  s_nop 1
  v_add_f32_dpp v12, v14, v12 quad_perm:[2,3,0,1] row_mask:0xf bank_mask:0xf
  v_add_f32_dpp v13, v15, v13 quad_perm:[2,3,0,1] row_mask:0xf bank_mask:0xf
  s_nop 0
  v_mov_b32_dpp v12, v12 quad_perm:[0,1,0,1] row_mask:0xf bank_mask:0xf
  v_mov_b32_dpp v13, v13 quad_perm:[0,1,0,1] row_mask:0xf bank_mask:0xf
  v_mul_f32 v12, s69, v12
  ds_write_b32 v78, v8 offset:8712
  v_mul_f32 v13, s69, v13
  ds_write_b32 v78, v9 offset:8776
  s_waitcnt lgkmcnt(0)
  s_barrier
  ds_read_b128 v[36:39], v78 offset:8704
  ds_read_b128 v[40:43], v78 offset:8768
  s_waitcnt lgkmcnt(0)
  s_barrier
  v_max_f32 v16, v36, v37
  v_max3_f32 v16, v16, v38, v39
  v_max3_f32 v16, v16, v40, v41
  v_max3_f32 v16, v16, v42, v43
  v_max3_f32 v16, v16, v12, v13
  v_mov_b32 v17, v16
  s_nop 1
  v_permlane16_swap_b32 v16, v17
  v_max_f32 v16, v16, v17
  v_mov_b32 v17, v16
  s_nop 1
  v_permlane32_swap_b32 v16, v17
  v_max_f32 v16, v16, v17
  v_sub_f32 v36, v36, v16
  v_sub_f32 v37, v37, v16
  v_sub_f32 v38, v38, v16
  v_sub_f32 v39, v39, v16
  v_sub_f32 v40, v40, v16
  v_sub_f32 v41, v41, v16
  v_sub_f32 v42, v42, v16
  v_sub_f32 v43, v43, v16
  v_sub_f32 v12, v12, v16
  v_sub_f32 v13, v13, v16
  v_exp_f32 v36, v36
  v_exp_f32 v37, v37
  v_exp_f32 v38, v38
  v_exp_f32 v39, v39
  v_exp_f32 v40, v40
  v_exp_f32 v41, v41
  v_exp_f32 v42, v42
  v_exp_f32 v43, v43
  v_exp_f32 v12, v12
  v_exp_f32 v13, v13
  v_cvt_pk_bf16_f32 v32, v36, v40
  v_cvt_pk_bf16_f32 v33, v37, v41
  v_cvt_pk_bf16_f32 v34, v38, v42
  v_cvt_pk_bf16_f32 v35, v39, v43
  v_cvt_pk_bf16_f32 v28, v12, v13
  v_cvt_pk_bf16_f32 v31, v12, v13
  v_mov_b32 v29, 0
  v_mov_b32 v30, 0
  v_mfma_f32_16x16x32_bf16 v[8:11], v[32:35], v[68:71], 0
  v_mfma_f32_16x16x32_bf16 v[0:3], v[32:35], v[52:55], 0
  v_mfma_f32_16x16x32_bf16 v[4:7], v[32:35], v[56:59], 0
  v_mfma_f32_16x16x16_bf16 v[8:11], v[28:29], v[68:69], v[8:11]
  v_mfma_f32_16x16x16_bf16 v[0:3], v[28:29], v[72:73], v[0:3]
  v_mfma_f32_16x16x16_bf16 v[4:7], v[30:31], v[72:73], v[4:7]
  ds_read_b128 v[52:55], v75 offset:26624
  v_rcp_f32 v10, v8
  v_rcp_f32 v11, v9
  v_mul_f32 v0, v10, v0
  v_mul_f32 v1, v11, v1
  v_max3_f32 v8, v8, v9, v10
  v_mul_f32 v4, v10, v4
  v_mul_f32 v5, v11, v5
  v_cvt_pk_bf16_f32 v2, v0, v4
  ds_write_b32 v79, v2 offset:8704
  v_cvt_pk_bf16_f32 v3, v1, v5
  ds_write_b32 v79, v3 offset:9280
  ds_read_b128 v[12:15], v78 offset:8832
  ds_read_b128 v[56:59], v75 offset:27648
  v_mov_b64 v[16:17], 0
  v_mov_b64 v[18:19], 0
  v_mov_b64 v[20:21], 0
  v_mov_b64 v[22:23], 0
  v_mov_b64 v[24:25], 0
  v_mov_b64 v[26:27], 0
  s_branch Cs2_mxok
Cs2_last:
  ds_read_b128 v[4:7], v76 offset:5632
  ds_read_b128 v[8:11], v76 offset:6656
  ds_read_b128 v[44:47], v76 offset:40960
  ds_read_b128 v[48:51], v76 offset:41984
  s_nop 5
  v_mov_b64 v[20:21], 0
  v_mov_b64 v[22:23], 0
  v_mov_b64 v[24:25], 0
  v_mov_b64 v[26:27], 0
  s_waitcnt lgkmcnt(4)
  v_smfmac_f32_16x16x64_bf16 v[28:31], v[0:3], v[36:43], v74
  ds_read_b128 v[36:39], v76 offset:43008
  ds_read_b128 v[40:43], v76 offset:44032
  v_smfmac_f32_16x16x64_bf16 v[32:35], v[0:3], v[60:67], v74
  s_waitcnt lgkmcnt(5)
  v_smfmac_f32_16x16x64_bf16 v[20:23], v[0:3], a[32:39], v74
  ds_read_b128 v[60:63], v76 offset:57344
  ds_read_b128 v[64:67], v76 offset:58368
  v_smfmac_f32_16x16x64_bf16 v[24:27], v[0:3], a[40:47], v74
  s_waitcnt lgkmcnt(4)
  v_smfmac_f32_16x16x64_bf16 v[20:23], v[4:7], a[48:55], v74
  buffer_store_dwordx4 v[16:19], v76, s[8:11], s68 offen sc1
  v_smfmac_f32_16x16x64_bf16 v[24:27], v[4:7], a[56:63], v74
  v_smfmac_f32_16x16x64_bf16 v[28:31], v[4:7], v[44:51], v74
  s_waitcnt lgkmcnt(2)
  v_smfmac_f32_16x16x64_bf16 v[20:23], v[8:11], a[64:71], v74
  ds_read_b128 v[44:47], v76 offset:59392
  ds_read_b128 v[48:51], v76 offset:60416
  v_smfmac_f32_16x16x64_bf16 v[24:27], v[8:11], a[72:79], v74
  v_smfmac_f32_16x16x64_bf16 v[32:35], v[4:7], v[36:43], v74
  v_smfmac_f32_16x16x64_bf16 v[28:31], v[8:11], v[208:215], v74
  ds_read_b128 v[36:39], v75 offset:24576
  ds_read_b128 v[40:43], v75 offset:25600
  v_smfmac_f32_16x16x64_bf16 v[32:35], v[8:11], v[216:223], v74
  v_smfmac_f32_16x16x64_bf16 v[20:23], v[12:15], a[80:87], v74
  v_smfmac_f32_16x16x64_bf16 v[24:27], v[12:15], a[88:95], v74
  v_smfmac_f32_16x16x64_bf16 v[28:31], v[12:15], v[224:231], v74
  v_smfmac_f32_16x16x64_bf16 v[32:35], v[12:15], v[232:239], v74
  s_waitcnt vmcnt(1)
  s_barrier
Cs2_lastr:
  ds_read_b128 v[12:15], v76 offset:8704
  ds_read_b128 v[0:3], v76 offset:9728
  ds_read_b128 v[16:19], v76 offset:10752
  ds_read_b128 v[4:7], v76 offset:11776
  ds_read_b128 v[8:11], v76 offset:12800
  s_waitcnt lgkmcnt(3)
  v_max3_u32 v72, v0, v1, v2
  s_waitcnt lgkmcnt(1)
  v_max3_u32 v72, v72, v3, v4
  v_max3_u32 v72, v72, v5, v6
  s_waitcnt lgkmcnt(0)
  v_max3_u32 v72, v72, v7, v8
  v_max3_u32 v72, v72, v9, v10
  v_max3_u32 v72, v72, v11, v12
  v_max3_u32 v72, v72, v13, v14
  v_max3_u32 v72, v72, v15, v16
  v_max3_u32 v72, v72, v17, v18
  v_max_u32 v72, v72, v19
  v_cmp_eq_u32 vcc, -1, v72
  s_cbranch_vccnz Cs2_lastp
Cs2_lastg:
  v_smfmac_f32_16x16x64_bf16 v[28:31], v[12:15], v[60:67], v74
  ds_read_b128 v[60:63], v75 offset:26624
  ds_read_b128 v[64:67], v75 offset:27648
  v_smfmac_f32_16x16x64_bf16 v[32:35], v[12:15], v[44:51], v74
  v_smfmac_f32_16x16x64_bf16 v[28:31], v[0:3], v[36:43], v74
  v_smfmac_f32_16x16x64_bf16 v[28:31], v[16:19], v[240:247], v74
  v_smfmac_f32_16x16x64_bf16 v[28:31], v[4:7], a[0:7], v74
  v_smfmac_f32_16x16x64_bf16 v[28:31], v[8:11], a[16:23], v74
  v_smfmac_f32_16x16x64_bf16 v[32:35], v[16:19], v[248:255], v74
  v_smfmac_f32_16x16x64_bf16 v[32:35], v[4:7], a[8:15], v74
  s_waitcnt lgkmcnt(0)
  v_smfmac_f32_16x16x64_bf16 v[32:35], v[8:11], a[24:31], v74
  v_smfmac_f32_16x16x64_bf16 v[32:35], v[0:3], v[60:67], v74
  v_smfmac_f32_16x16x64_bf16 v[20:23], v[12:15], a[96:103], v74
  v_smfmac_f32_16x16x64_bf16 v[20:23], v[0:3], a[112:119], v74
  v_add_f32 v28, v28, v30
  v_add_f32 v32, v32, v34
  v_cvt_pk_bf16_f32 v30, v28, v32
  v_smfmac_f32_16x16x64_bf16 v[20:23], v[16:19], a[128:135], v74
  ds_write_b32 v79, v30 offset:256
  v_add_f32 v29, v29, v31
  v_add_f32 v33, v33, v35
  v_cvt_pk_bf16_f32 v31, v29, v33
  v_smfmac_f32_16x16x64_bf16 v[20:23], v[4:7], a[144:151], v74
  ds_write_b32 v79, v31 offset:832
  v_smfmac_f32_16x16x64_bf16 v[20:23], v[8:11], a[160:167], v74
  v_smfmac_f32_16x16x64_bf16 v[24:27], v[12:15], a[104:111], v74
  v_smfmac_f32_16x16x64_bf16 v[24:27], v[0:3], a[120:127], v74
  v_smfmac_f32_16x16x64_bf16 v[24:27], v[16:19], a[136:143], v74
  s_waitcnt lgkmcnt(0)
  s_barrier
  ds_read_b64 v[52:53], v77 offset:384
  v_add_f32 v20, v20, v22
  v_smfmac_f32_16x16x64_bf16 v[24:27], v[4:7], a[152:159], v74
  v_add_f32 v21, v21, v23
  v_smfmac_f32_16x16x64_bf16 v[24:27], v[8:11], a[168:175], v74
  v_cvt_pk_bf16_f32 v54, v20, v21
  s_add_u32 s68, s68, 655360
  s_nop 3
  v_add_f32 v24, v24, v26
  v_add_f32 v25, v25, v27
  v_cvt_pk_bf16_f32 v55, v24, v25
  s_waitcnt lgkmcnt(0)
  buffer_store_dwordx4 v[52:55], v76, s[8:11], s68 offen sc1
  s_branch Cs2_done
Cs2_lastp:
  s_add_u32 s72, s72, 2
  s_cmp_ge_u32 s72, 131072
  s_cbranch_scc1 Cs2_lastg
  s_barrier
  buffer_load_dwordx4 v76, s[8:11], s85 offen offset:0 sc1 lds
  s_waitcnt vmcnt(0)
  s_barrier
  s_branch Cs2_lastr
Cs2_done:
  s_branch L_cexit
L_w7:
  v_mov_b64 v[20:21], 0
  v_mov_b64 v[22:23], 0
  v_mov_b64 v[24:25], 0
  v_mov_b64 v[26:27], 0
  v_mov_b64 v[28:29], 0
  v_mov_b64 v[30:31], 0
  v_mov_b64 v[32:33], 0
  v_mov_b64 v[34:35], 0
  s_mov_b32 s78, 0x3f803f80
  s_mov_b32 s79, s78
  s_mov_b32 s65, 360448
  s_mov_b32 m0, 15872
  s_lshl_b32 s71, s53, 2
  s_add_u32 s71, s71, 128
  s_movk_i32 s56, 0x1000
  v_lshlrev_b32 v73, 2, v76
  v_mov_b32 v72, 0
  s_mov_b64 s[16:17], s[8:9]
  s_mov_b32 s18, 268435456
  s_mov_b32 s19, 0x20000
  s_getpc_b64 s[20:21]
Cs3_pc:
  s_add_u32 s20, s20, (Cs3_last - Cs3_pc)
  s_addc_u32 s21, s21, 0
  v_mov_b32 v68, 14880
  buffer_load_dwordx4 v[52:55], v76, s[8:11], s59 offen offset:0 sc1
  buffer_load_dwordx4 v[56:59], v76, s[8:11], s59 offen offset:1024 sc1
  ds_read_b128 v[36:39], v76 offset:45056
  ds_read_b128 v[40:43], v76 offset:46080
  ds_read_b128 v[60:63], v76 offset:47104
  ds_read_b128 v[64:67], v76 offset:48128
  ds_read_b128 v[0:3], v76 offset:4608
  ds_read_b128 v[4:7], v76 offset:5632
  ds_read_b128 v[8:11], v76 offset:6656
  ds_read_b128 v[12:15], v76 offset:7680
  s_waitcnt lgkmcnt(0)
  s_cmp_eq_u32 s66, 1
  s_branch Cs3_top2
.p2align 6
Cs3_h2:
  v_lshlrev_b32 v73, 2, v76
  ds_read_b128 v[36:39], v76 offset:45056
  ds_read_b128 v[40:43], v76 offset:46080
  buffer_load_dwordx4 v[52:55], v76, s[8:11], s59 offen offset:0 sc1
  buffer_load_dwordx4 v[56:59], v76, s[8:11], s59 offen offset:1024 sc1
  s_waitcnt vmcnt(0)
  s_mov_b64 vcc, -1
Cs3_h2r:
  s_mov_b64 exec, vcc
  buffer_load_dwordx4 v[4:7], v76, s[8:11], s65 offen offset:1024 sc1
  buffer_load_dwordx4 v[0:3], v76, s[8:11], s85 offen offset:0 sc1
  buffer_load_dwordx4 v[8:11], v76, s[8:11], s85 offen offset:1024 sc1
  s_mov_b64 exec, -1
  s_add_u32 s67, s67, 1
  s_cmp_lt_u32 s67, 131072
  s_cselect_b32 s54, -2, -1
  s_waitcnt vmcnt(2)
  v_max3_u32 v72, v4, v5, v6
  s_waitcnt vmcnt(1)
  v_max3_u32 v72, v72, v7, v0
  v_max3_u32 v72, v72, v1, v2
  s_waitcnt vmcnt(0)
  v_max3_u32 v72, v72, v3, v8
  v_max3_u32 v72, v72, v9, v10
  v_max_u32 v72, v72, v11
  v_cmp_lt_u32 vcc, s54, v72
  s_cbranch_vccnz Cs3_h2r
  ds_write_b128 v76, v[4:7] offset:5632
  ds_write_b128 v76, v[0:3] offset:8704
  ds_write_b128 v76, v[8:11] offset:9728
Cs3_h2w:
  s_cmp_eq_u32 s66, 63
  s_waitcnt lgkmcnt(0)
  s_barrier
  ds_read_b128 v[8:11], v76 offset:6656
Cs3_top2:
  v_smfmac_f32_16x16x64_bf16 v[20:23], v[4:7], v[96:103], v74
  s_cbranch_scc1 Cs3_last
  v_smfmac_f32_16x16x64_bf16 v[28:31], v[4:7], v[36:43], v74
  buffer_load_dwordx4 v[44:47], v76, s[8:11], s58 offen offset:0 sc1
  s_mov_b32 m0, 15872
  v_smfmac_f32_16x16x64_bf16 v[24:27], v[4:7], v[104:111], v74
  buffer_load_dwordx4 v[48:51], v76, s[8:11], s58 offen offset:1024 sc1
  v_smfmac_f32_16x16x64_bf16 v[32:35], v[4:7], v[60:67], v74
  ds_read_b128 v[0:3], v76 offset:4608
  s_waitcnt lgkmcnt(1)
  v_smfmac_f32_16x16x64_bf16 v[20:23], v[8:11], v[112:119], v74
  ds_read_b128 v[12:15], v76 offset:7680
  v_smfmac_f32_16x16x64_bf16 v[24:27], v[8:11], v[120:127], v74
  ds_read_b128 v[36:39], v76 offset:28672
  v_smfmac_f32_16x16x64_bf16 v[28:31], v[8:11], v[208:215], v74
  buffer_store_dwordx4 v[16:19], v76, s[8:11], s68 offen sc1
  ds_read_b128 v[40:43], v76 offset:29696
  v_smfmac_f32_16x16x64_bf16 v[32:35], v[8:11], v[216:223], v74
  buffer_load_dword v73, s[16:19], s70 offen lds
  ds_read_b128 v[60:63], v76 offset:30720
  s_waitcnt lgkmcnt(4)
  v_smfmac_f32_16x16x64_bf16 v[20:23], v[0:3], v[80:87], v74
  ds_read_b128 v[64:67], v76 offset:31744
  v_smfmac_f32_16x16x64_bf16 v[24:27], v[0:3], v[88:95], v74
  s_waitcnt vmcnt(4)
  s_waitcnt lgkmcnt(4)
  v_smfmac_f32_16x16x64_bf16 v[20:23], v[12:15], v[128:135], v74
  s_barrier
  ds_read_b128 v[4:7], v76 offset:8704
  s_waitcnt lgkmcnt(3)
  v_smfmac_f32_16x16x64_bf16 v[28:31], v[0:3], v[36:43], v74
  ds_read_b128 v[36:39], v76 offset:61440
  v_smfmac_f32_16x16x64_bf16 v[24:27], v[12:15], v[136:143], v74
  ds_read_b128 v[40:43], v76 offset:62464
  s_waitcnt lgkmcnt(3)
  v_smfmac_f32_16x16x64_bf16 v[32:35], v[0:3], v[60:67], v74
  ds_read_b128 v[8:11], v76 offset:9728
  v_smfmac_f32_16x16x64_bf16 v[28:31], v[12:15], v[224:231], v74
  ds_read_b128 v[60:63], v76 offset:63488
  v_smfmac_f32_16x16x64_bf16 v[32:35], v[12:15], v[232:239], v74
  ds_read_b128 v[64:67], v76 offset:64512
  s_waitcnt lgkmcnt(5)
  v_smfmac_f32_16x16x64_bf16 v[20:23], v[4:7], v[144:151], v74
  s_barrier
  ds_read_b128 v[0:3], v76 offset:11776
  s_waitcnt lgkmcnt(4)
  v_smfmac_f32_16x16x64_bf16 v[28:31], v[4:7], v[36:43], v74
  ds_read_b128 v[12:15], v76 offset:12800
  ds_read_b128 v[36:39], v75 offset:12288
  v_smfmac_f32_16x16x64_bf16 v[24:27], v[4:7], v[152:159], v74
  ds_read_b128 v[16:19], v76 offset:10752
  s_waitcnt lgkmcnt(6)
  v_smfmac_f32_16x16x64_bf16 v[20:23], v[8:11], v[160:167], v74
  ds_read_b128 v[40:43], v75 offset:13312
  s_waitcnt lgkmcnt(5)
  v_smfmac_f32_16x16x64_bf16 v[32:35], v[4:7], v[60:67], v74
  ds_read_b128 v[60:63], v75 offset:14336
  v_smfmac_f32_16x16x64_bf16 v[24:27], v[8:11], v[168:175], v74
  ds_read_b128 v[64:67], v75 offset:15360
  s_waitcnt lgkmcnt(6)
  v_smfmac_f32_16x16x64_bf16 v[20:23], v[0:3], v[176:183], v74
  s_waitcnt lgkmcnt(5)
  v_smfmac_f32_16x16x64_bf16 v[20:23], v[12:15], v[192:199], v74
  s_waitcnt lgkmcnt(2)
  v_smfmac_f32_16x16x64_bf16 v[20:23], v[16:19], v[36:43], v74
  ds_read_b128 v[36:39], v75 offset:28672
  v_smfmac_f32_16x16x64_bf16 v[24:27], v[0:3], v[184:191], v74
  ds_read_b128 v[40:43], v75 offset:29696
  s_waitcnt lgkmcnt(2)
  v_smfmac_f32_16x16x64_bf16 v[24:27], v[16:19], v[60:67], v74
  ds_read_b128 v[60:63], v75 offset:30720
  v_add_f32 v20, v20, v22
  v_smfmac_f32_16x16x64_bf16 v[24:27], v[12:15], v[200:207], v74
  ds_read_b128 v[64:67], v75 offset:31744
  v_add_f32 v21, v21, v23
  v_smfmac_f32_16x16x64_bf16 v[28:31], v[16:19], v[240:247], v74
  v_mov_b64 v[70:71], s[78:79]
  v_smfmac_f32_16x16x64_bf16 v[28:31], v[0:3], a[0:7], v74
  s_waitcnt lgkmcnt(2)
  v_add_f32 v24, v24, v26
  v_smfmac_f32_16x16x64_bf16 v[28:31], v[8:11], v[36:43], v74
  ds_read_b128 v[36:39], v68
  v_cvt_pk_bf16_f32 v22, v20, v24
  v_smfmac_f32_16x16x64_bf16 v[28:31], v[12:15], a[16:23], v74
  ds_read_b128 v[40:43], v68
  ds_write_b32 v79, v22 offset:0
  s_waitcnt lgkmcnt(3)
  v_add_f32 v25, v25, v27
  v_cvt_pk_bf16_f32 v23, v21, v25
  v_smfmac_f32_16x16x64_bf16 v[32:35], v[8:11], v[60:67], v74
  ds_write_b32 v79, v23 offset:576
  v_cmp_u_f32 vcc, v20, v21
  v_smfmac_f32_16x16x64_bf16 v[32:35], v[16:19], v[248:255], v74
  v_add_f32 v28, v28, v30
  v_smfmac_f32_16x16x64_bf16 v[32:35], v[0:3], a[8:15], v74
  v_add_f32 v29, v29, v31
  v_smfmac_f32_16x16x64_bf16 v[32:35], v[12:15], a[24:31], v74
  s_cbranch_vccnz Cs3_rec
Cs3_recok:
  s_waitcnt lgkmcnt(3)
  v_smfmac_f32_16x16x64_bf16 v[36:39], v[16:19], a[128:135], v74
  s_waitcnt lgkmcnt(0)
  s_barrier
  ds_read_b128 v[60:63], v77
  v_smfmac_f32_16x16x64_bf16 v[40:43], v[16:19], a[136:143], v74
  ds_read_b128 v[64:67], v77 offset:128
  v_add_f32 v32, v32, v34
  v_cvt_pk_bf16_f32 v30, v28, v32
  v_smfmac_f32_16x16x64_bf16 v[36:39], v[0:3], a[144:151], v74
  ds_write_b32 v79, v30 offset:256
  v_add_f32 v33, v33, v35
  v_cvt_pk_bf16_f32 v31, v29, v33
  v_smfmac_f32_16x16x64_bf16 v[40:43], v[0:3], a[152:159], v74
  ds_write_b32 v79, v31 offset:832
  v_xor_b32 v75, 0x8000, v75
  v_smfmac_f32_16x16x64_bf16 v[36:39], v[4:7], a[96:103], v74
  ds_read_b128 v[0:3], v76 offset:4608
  v_mov_b32 v29, 0
  v_smfmac_f32_16x16x64_bf16 v[40:43], v[4:7], a[104:111], v74
  s_waitcnt vmcnt(2) lgkmcnt(3)
  v_mov_b32 v30, 0
  v_mfma_f32_16x16x32_bf16 v[44:47], v[44:47], v[60:63], 0
  ds_read_b128 v[4:7], v76 offset:5632
  s_waitcnt lgkmcnt(2)
  v_mfma_f32_16x16x32_bf16 v[44:47], v[48:51], v[64:67], v[44:47]
  s_barrier
  v_smfmac_f32_16x16x64_bf16 v[36:39], v[8:11], a[112:119], v74
  ds_read_b128 v[20:23], v77 offset:256
  ds_read_b128 v[24:27], v77 offset:384
  v_smfmac_f32_16x16x64_bf16 v[40:43], v[8:11], a[120:127], v74
  ds_read_b128 v[8:11], v76 offset:6656
  v_add_f32_dpp v72, v46, v44 quad_perm:[2,3,0,1] row_mask:0xf bank_mask:0xf
  v_add_f32_dpp v73, v47, v45 quad_perm:[2,3,0,1] row_mask:0xf bank_mask:0xf
  v_smfmac_f32_16x16x64_bf16 v[36:39], v[12:15], a[160:167], v74
  s_waitcnt lgkmcnt(4)
  v_exp_f32_dpp v72, v72 quad_perm:[0,1,0,1] row_mask:0xf bank_mask:0xf
  v_smfmac_f32_16x16x64_bf16 v[40:43], v[12:15], a[168:175], v74
  ds_read_b128 v[12:15], v76 offset:7680
  v_exp_f32_dpp v73, v73 quad_perm:[0,1,0,1] row_mask:0xf bank_mask:0xf
  v_smfmac_f32_16x16x64_bf16 v[36:39], v[0:3], a[32:39], v74
  s_waitcnt lgkmcnt(2)
  v_cvt_pk_bf16_f32 v72, v72, v73
  v_mfma_f32_16x16x32_bf16 v[20:23], v[20:23], v[60:63], 0
  ds_write_b32 v78, v72 offset:524
  v_mov_b64 v[16:17], 0
  v_mfma_f32_16x16x32_bf16 v[20:23], v[24:27], v[64:67], v[20:23]
  ds_read_b128 v[44:47], v75 offset:47104
  v_mov_b64 v[18:19], 0
  v_smfmac_f32_16x16x64_bf16 v[40:43], v[0:3], a[40:47], v74
  ds_read_b128 v[48:51], v75 offset:48128
  v_mov_b64 v[68:69], s[78:79]
  v_smfmac_f32_16x16x64_bf16 v[36:39], v[4:7], a[48:55], v74
  s_waitcnt lgkmcnt(4)
  v_add_f32_dpp v24, v22, v20 quad_perm:[2,3,0,1] row_mask:0xf bank_mask:0xf
  v_add_f32_dpp v25, v23, v21 quad_perm:[2,3,0,1] row_mask:0xf bank_mask:0xf
  v_smfmac_f32_16x16x64_bf16 v[36:39], v[8:11], a[64:71], v74
  s_waitcnt lgkmcnt(2)
  s_barrier
  ds_read_b128 v[32:35], v78 offset:512
  v_smfmac_f32_16x16x64_bf16 v[36:39], v[12:15], a[80:87], v74
  ds_read_b128 v[60:63], v75 offset:28672
  v_mul_f32 v24, s69, v24
  v_smfmac_f32_16x16x64_bf16 v[40:43], v[4:7], a[56:63], v74
  ds_read_b128 v[64:67], v75 offset:29696
  v_mul_f32 v25, s69, v25
  v_smfmac_f32_16x16x64_bf16 v[40:43], v[8:11], a[72:79], v74
  v_exp_f32_dpp v24, v24 quad_perm:[0,1,0,1] row_mask:0xf bank_mask:0xf
  v_smfmac_f32_16x16x64_bf16 v[40:43], v[12:15], a[88:95], v74
  s_waitcnt lgkmcnt(2)
  v_exp_f32_dpp v25, v25 quad_perm:[0,1,0,1] row_mask:0xf bank_mask:0xf
  v_mfma_f32_16x16x32_bf16 v[8:11], v[32:35], v[68:71], 0
  v_add_f32 v36, v36, v38
  v_add_f32 v37, v37, v39
  v_mfma_f32_16x16x32_bf16 v[0:3], v[32:35], v[52:55], 0
  v_add_f32 v40, v40, v42
  v_add_f32 v41, v41, v43
  v_mfma_f32_16x16x32_bf16 v[4:7], v[32:35], v[56:59], 0
  v_cvt_pk_bf16_f32 v28, v24, v25
  v_cvt_pk_bf16_f32 v72, v36, v37
  v_cvt_pk_bf16_f32 v73, v40, v41
  v_mfma_f32_16x16x16_bf16 v[8:11], v[28:29], v[68:69], v[8:11]
  v_cvt_pk_bf16_f32 v31, v24, v25
  v_mov_b64 v[20:21], 0
  v_mfma_f32_16x16x16_bf16 v[0:3], v[28:29], v[72:73], v[0:3]
  ds_read_b128 v[52:55], v75 offset:30720
  v_mov_b64 v[22:23], 0
  v_mfma_f32_16x16x16_bf16 v[4:7], v[30:31], v[72:73], v[4:7]
  v_rcp_f32 v10, v8
  v_rcp_f32 v11, v9
  v_mul_f32 v0, v10, v0
  v_mul_f32 v1, v11, v1
  v_max3_f32 v8, v8, v9, v10
  v_mul_f32 v4, v10, v4
  v_mul_f32 v5, v11, v5
  v_cvt_pk_bf16_f32 v2, v0, v4
  ds_write_b32 v79, v2 offset:8704
  v_cvt_pk_bf16_f32 v3, v1, v5
  ds_write_b32 v79, v3 offset:9280
  ds_read_b128 v[12:15], v78 offset:8896
  v_max_f32 v8, v8, v11
  v_cmp_le_f32 vcc, 1317011456, v8
  v_mov_b64 v[24:25], 0
  v_mov_b64 v[26:27], 0
  ds_read_b128 v[56:59], v75 offset:31744
  s_cbranch_vccnz Cs3_mx
Cs3_mxok:
  s_waitcnt lgkmcnt(2)
  s_barrier
  ds_read_b128 v[0:3], v78 offset:8832
  s_waitcnt lgkmcnt(2)
  v_smfmac_f32_16x16x64_bf16 v[16:19], v[12:15], a[184:191], v74
  ds_read_b128 v[4:7], v78 offset:8704
  v_smfmac_f32_16x16x64_bf16 v[20:23], v[12:15], v[44:51], v74
  ds_read_b128 v[8:11], v78 offset:8768
  v_smfmac_f32_16x16x64_bf16 v[24:27], v[12:15], a[232:239], v74
  ds_read_b128 v[36:39], v75 offset:45056
  s_waitcnt lgkmcnt(3)
  v_smfmac_f32_16x16x64_bf16 v[16:19], v[0:3], a[176:183], v74
  ds_read_b128 v[40:43], v75 offset:46080
  s_waitcnt lgkmcnt(3)
  v_smfmac_f32_16x16x64_bf16 v[16:19], v[4:7], v[60:67], v74
  ds_read_b128 v[68:71], v76 offset:13824
  s_waitcnt lgkmcnt(3)
  v_smfmac_f32_16x16x64_bf16 v[16:19], v[8:11], v[52:59], v74
  ds_read_b128 v[44:47], v75 offset:61440
  v_smfmac_f32_16x16x64_bf16 v[20:23], v[4:7], a[192:199], v74
  ds_read_b128 v[48:51], v75 offset:62464
  v_smfmac_f32_16x16x64_bf16 v[20:23], v[8:11], a[200:207], v74
  ds_read_b128 v[60:63], v75 offset:63488
  s_waitcnt lgkmcnt(4)
  v_cvt_pk_bf16_f32 v16, v16, v17
  v_cvt_pk_bf16_f32 v17, v18, v19
  v_bfi_b32 v16, 1, s72, v16
  v_smfmac_f32_16x16x64_bf16 v[20:23], v[0:3], v[36:43], v74
  s_waitcnt lgkmcnt(3)
  buffer_store_dwordx2 v[16:17], v68, s[8:11], s73 offen sc1
  v_mov_b64 v[32:33], 0
  v_smfmac_f32_16x16x64_bf16 v[24:27], v[4:7], a[208:215], v74
  ds_read_b128 v[64:67], v75 offset:64512
  v_mov_b64 v[34:35], 0
  v_smfmac_f32_16x16x64_bf16 v[24:27], v[8:11], a[216:223], v74
  ds_read_b128 v[52:55], v75 offset:8192
  v_cvt_pk_bf16_f32 v20, v20, v21
  v_cvt_pk_bf16_f32 v21, v22, v23
  v_bfi_b32 v20, 1, s72, v20
  v_smfmac_f32_16x16x64_bf16 v[24:27], v[0:3], a[224:231], v74
  ds_read_b128 v[56:59], v75 offset:9216
  buffer_store_dwordx2 v[20:21], v68, s[8:11], s74 offen sc1
  s_waitcnt lgkmcnt(4)
  v_mov_b64 v[28:29], 0
  v_smfmac_f32_16x16x64_bf16 v[32:35], v[4:7], v[44:51], v74
  ds_read_b128 v[36:39], v75 offset:10240
  ds_read_b128 v[40:43], v75 offset:11264
  s_waitcnt lgkmcnt(4)
  v_smfmac_f32_16x16x64_bf16 v[32:35], v[8:11], v[60:67], v74
  ds_read_b128 v[44:47], v75 offset:12288
  v_cvt_pk_bf16_f32 v24, v24, v25
  v_cvt_pk_bf16_f32 v25, v26, v27
  v_bfi_b32 v24, 1, s72, v24
  v_smfmac_f32_16x16x64_bf16 v[32:35], v[0:3], a[240:247], v74
  ds_read_b128 v[48:51], v75 offset:13312
  buffer_store_dwordx2 v[24:25], v68, s[8:11], s75 offen sc1
  v_mov_b64 v[30:31], 0
  v_smfmac_f32_16x16x64_bf16 v[32:35], v[12:15], a[248:255], v74
  ds_read_b128 v[60:63], v75 offset:14336
  ds_read_b128 v[64:67], v75 offset:15360
  s_waitcnt lgkmcnt(6)
  v_smfmac_f32_16x16x64_bf16 v[28:31], v[4:7], v[52:59], v74
  s_waitcnt lgkmcnt(4)
  v_smfmac_f32_16x16x64_bf16 v[28:31], v[8:11], v[36:43], v74
  s_waitcnt lgkmcnt(2)
  v_cvt_pk_bf16_f32 v32, v32, v33
  v_cvt_pk_bf16_f32 v33, v34, v35
  v_bfi_b32 v32, 1, s72, v32
  v_smfmac_f32_16x16x64_bf16 v[28:31], v[0:3], v[44:51], v74
  buffer_store_dwordx2 v[32:33], v68, s[8:11], s76 offen sc1
  s_waitcnt lgkmcnt(0)
  v_smfmac_f32_16x16x64_bf16 v[28:31], v[12:15], v[60:67], v74
  v_mov_b64 v[18:19], v[72:73]
  s_nop 4
  v_cvt_pk_bf16_f32 v28, v28, v29
  v_cvt_pk_bf16_f32 v29, v30, v31
  v_bfi_b32 v28, 1, s72, v28
  buffer_store_dwordx2 v[28:29], v68, s[8:11], s77 offen sc1
  ds_read_b128 v[52:55], v76 offset:14848
  s_waitcnt lgkmcnt(0)
  ds_read_b64 v[16:17], v77 offset:392
  s_waitcnt lgkmcnt(0)
  ds_read_b128 v[60:63], v76 offset:47104
  s_waitcnt lgkmcnt(0)
  ds_read_b128 v[64:67], v76 offset:48128
  s_waitcnt lgkmcnt(0)
  s_add_u32 s66, s66, 1
  s_xor_b32 s64, s64, 16384
  s_xor_b32 s65, s65, 16384
  s_add_u32 s58, s58, 655360
  s_add_u32 s59, s59, 655360
  s_add_u32 s70, s70, 655360
  s_add_u32 s68, s68, 655360
  s_mov_b32 m0, 8704
  s_add_u32 s85, s65, 4096
  v_xor_b32 v75, 0x8000, v75
  v_mov_b64 v[28:29], 0
  v_mov_b64 v[30:31], 0
  v_mov_b64 v[32:33], 0
  v_mov_b64 v[34:35], 0
  s_waitcnt vmcnt(0)
  buffer_load_dwordx4 v[0:3], v76, s[8:11], s60 offen offset:0 sc1
  buffer_load_dwordx4 v[4:7], v76, s[8:11], s60 offen offset:1024 sc1
  buffer_load_dwordx4 v[8:11], v76, s[8:11], s61 offen offset:0 sc1
  buffer_load_dwordx4 v[12:15], v76, s[8:11], s61 offen offset:1024 sc1
  v_mov_b64 v[20:21], 0
  v_mov_b64 v[22:23], 0
  v_mov_b64 v[24:25], 0
  v_mov_b64 v[26:27], 0
  v_mov_b32 v68, 14880
  s_cmp_eq_u32 s66, 62
  s_cselect_b64 s[16:17], s[20:21], s[16:17]
  s_cselect_b32 s18, (Cs3_done - Cs3_last), s18
  s_cselect_b32 s70, 0, s70
  s_cmp_eq_u32 s66, 63
  s_cselect_b32 s59, 268435456, s59
  s_cselect_b32 s58, 268435456, s58
  s_waitcnt lgkmcnt(0)
  s_waitcnt vmcnt(3)
  v_mfma_f32_16x16x32_bf16 v[56:59], v[52:55], v[0:3], 0
  v_bitop3_b32 v72, v0, v2, s72 bitop3:0x7e
  s_waitcnt vmcnt(2)
  v_mfma_f32_16x16x32_bf16 v[56:59], v[52:55], v[4:7], v[56:59]
  v_bitop3_b32 v73, v4, v6, s72 bitop3:0x7e
  v_or_b32 v72, v72, v73
  s_waitcnt vmcnt(1)
  v_mfma_f32_16x16x32_bf16 v[36:39], v[52:55], v[8:11], 0
  v_bitop3_b32 v73, v8, v10, s72 bitop3:0x7e
  v_or_b32 v72, v72, v73
  s_waitcnt vmcnt(0)
  v_mfma_f32_16x16x32_bf16 v[36:39], v[52:55], v[12:15], v[36:39]
  v_bitop3_b32 v73, v12, v14, s72 bitop3:0x7e
  v_bitop3_b32 v72, v72, v73, 1 bitop3:0xa8
  v_cmp_ne_u32 vcc, 0, v72
  s_cbranch_vccnz Cs3_h1r
  v_add_f32_dpp v56, v56, v56 row_ror:4 row_mask:0xf bank_mask:0xf
  v_add_f32_dpp v57, v57, v57 row_ror:4 row_mask:0xf bank_mask:0xf
  s_nop 0
  v_add_f32_dpp v36, v36, v36 row_ror:4 row_mask:0xf bank_mask:0xf
  v_add_f32_dpp v37, v37, v37 row_ror:4 row_mask:0xf bank_mask:0xf
  v_add_f32_dpp v56, v56, v56 row_ror:8 row_mask:0xf bank_mask:0xf
  v_add_f32_dpp v57, v57, v57 row_ror:8 row_mask:0xf bank_mask:0xf
  v_add_f32_dpp v36, v36, v36 row_ror:8 row_mask:0xf bank_mask:0xf
  v_add_f32_dpp v37, v37, v37 row_ror:8 row_mask:0xf bank_mask:0xf
  v_cvt_pk_bf16_f32 v56, v56, v57
  buffer_store_dword v56, v69, s[8:11], s62 offen sc1
  v_cvt_pk_bf16_f32 v36, v36, v37
  buffer_store_dword v36, v70, s[8:11], s63 offen sc1
  s_xor_b32 s62, s62, 16384
  buffer_store_dword v71, v69, s[8:11], s62 offen sc1
  s_xor_b32 s63, s63, 16384
  buffer_store_dword v71, v70, s[8:11], s63 offen sc1
  s_xor_b32 s72, s72, 1
  s_branch Cs3_h2
Cs3_h1r:
  s_mov_b64 exec, vcc
  buffer_load_dwordx4 v[0:3], v76, s[8:11], s60 offen offset:0 sc1
  buffer_load_dwordx4 v[4:7], v76, s[8:11], s60 offen offset:1024 sc1
  buffer_load_dwordx4 v[8:11], v76, s[8:11], s61 offen offset:0 sc1
  buffer_load_dwordx4 v[12:15], v76, s[8:11], s61 offen offset:1024 sc1
  s_mov_b64 exec, -1
  s_add_u32 s67, s67, 1
  s_waitcnt vmcnt(3)
  v_mfma_f32_16x16x32_bf16 v[56:59], v[52:55], v[0:3], 0
  v_bitop3_b32 v72, v0, v2, s72 bitop3:0x7e
  s_waitcnt vmcnt(2)
  v_mfma_f32_16x16x32_bf16 v[56:59], v[52:55], v[4:7], v[56:59]
  v_bitop3_b32 v73, v4, v6, s72 bitop3:0x7e
  v_or_b32 v72, v72, v73
  s_waitcnt vmcnt(1)
  v_mfma_f32_16x16x32_bf16 v[36:39], v[52:55], v[8:11], 0
  v_bitop3_b32 v73, v8, v10, s72 bitop3:0x7e
  v_or_b32 v72, v72, v73
  s_waitcnt vmcnt(0)
  v_mfma_f32_16x16x32_bf16 v[36:39], v[52:55], v[12:15], v[36:39]
  v_bitop3_b32 v73, v12, v14, s72 bitop3:0x7e
  v_bitop3_b32 v72, v72, v73, 1 bitop3:0xa8
  v_cmp_ne_u32 vcc, 0, v72
  s_cbranch_vccz Cs3_h1p
Cs3_h1s:
  s_mov_b64 exec, vcc
  buffer_load_dwordx4 v[0:3], v76, s[8:11], s60 offen offset:0 sc1
  buffer_load_dwordx4 v[4:7], v76, s[8:11], s60 offen offset:1024 sc1
  buffer_load_dwordx4 v[8:11], v76, s[8:11], s61 offen offset:0 sc1
  buffer_load_dwordx4 v[12:15], v76, s[8:11], s61 offen offset:1024 sc1
  s_mov_b64 exec, -1
  s_add_u32 s67, s67, 1
  s_waitcnt vmcnt(3)
  v_mfma_f32_16x16x32_bf16 v[56:59], v[52:55], v[0:3], 0
  v_bitop3_b32 v72, v0, v2, s72 bitop3:0x7e
  s_waitcnt vmcnt(2)
  v_mfma_f32_16x16x32_bf16 v[56:59], v[52:55], v[4:7], v[56:59]
  v_bitop3_b32 v73, v4, v6, s72 bitop3:0x7e
  v_or_b32 v72, v72, v73
  s_waitcnt vmcnt(1)
  v_mfma_f32_16x16x32_bf16 v[36:39], v[52:55], v[8:11], 0
  v_bitop3_b32 v73, v8, v10, s72 bitop3:0x7e
  v_or_b32 v72, v72, v73
  s_waitcnt vmcnt(0)
  v_mfma_f32_16x16x32_bf16 v[36:39], v[52:55], v[12:15], v[36:39]
  v_bitop3_b32 v73, v12, v14, s72 bitop3:0x7e
  v_bitop3_b32 v72, v72, v73, 1 bitop3:0xa8
  v_cmp_ne_u32 vcc, 0, v72
  s_cbranch_vccz Cs3_h1p
  s_cmp_lt_u32 s67, 131072
  s_cbranch_scc1 Cs3_h1s
Cs3_h1p:
  s_nop 2
  v_add_f32_dpp v56, v56, v56 row_ror:4 row_mask:0xf bank_mask:0xf
  v_add_f32_dpp v57, v57, v57 row_ror:4 row_mask:0xf bank_mask:0xf
  v_add_f32_dpp v36, v36, v36 row_ror:4 row_mask:0xf bank_mask:0xf
  v_add_f32_dpp v37, v37, v37 row_ror:4 row_mask:0xf bank_mask:0xf
  v_add_f32_dpp v56, v56, v56 row_ror:8 row_mask:0xf bank_mask:0xf
  v_add_f32_dpp v57, v57, v57 row_ror:8 row_mask:0xf bank_mask:0xf
  v_add_f32_dpp v36, v36, v36 row_ror:8 row_mask:0xf bank_mask:0xf
  v_add_f32_dpp v37, v37, v37 row_ror:8 row_mask:0xf bank_mask:0xf
  v_cvt_pk_bf16_f32 v56, v56, v57
  buffer_store_dword v56, v69, s[8:11], s62 offen sc1
  v_cvt_pk_bf16_f32 v36, v36, v37
  buffer_store_dword v36, v70, s[8:11], s63 offen sc1
  s_xor_b32 s62, s62, 16384
  buffer_store_dword v71, v69, s[8:11], s62 offen sc1
  s_xor_b32 s63, s63, 16384
  buffer_store_dword v71, v70, s[8:11], s63 offen sc1
  s_xor_b32 s72, s72, 1
  s_branch Cs3_h2
Cs3_rec:
  s_nop 7
  s_waitcnt vmcnt(0) lgkmcnt(0)
  v_max3_u32 v72, v0, v1, v2
  v_max3_u32 v72, v72, v3, v4
  v_max3_u32 v72, v72, v5, v6
  v_max3_u32 v72, v72, v7, v8
  v_max3_u32 v72, v72, v9, v10
  v_max3_u32 v72, v72, v11, v12
  v_max3_u32 v72, v72, v13, v14
  v_max3_u32 v72, v72, v15, v16
  v_max3_u32 v72, v72, v17, v18
  v_max_u32 v72, v72, v19
  v_cmp_eq_u32 vcc, -1, v72
  s_cbranch_vccz Cs3_recok
  s_barrier
Cs3_recp:
  buffer_load_dwordx4 v[0:3], v76, s[8:11], s64 offen offset:0 sc1
  buffer_load_dwordx4 v[4:7], v76, s[8:11], s64 offen offset:1024 sc1
  buffer_load_dwordx4 v[8:11], v76, s[8:11], s64 offen offset:2048 sc1
  s_add_u32 s67, s67, 1
  s_cmp_lt_u32 s67, 131072
  s_cselect_b32 s54, -2, -1
  s_waitcnt vmcnt(2)
  v_max3_u32 v72, v0, v1, v2
  s_waitcnt vmcnt(1)
  v_max3_u32 v72, v72, v3, v4
  v_max3_u32 v72, v72, v5, v6
  s_waitcnt vmcnt(0)
  v_max3_u32 v72, v72, v7, v8
  v_max3_u32 v72, v72, v9, v10
  v_max_u32 v72, v72, v11
  v_cmp_lt_u32 vcc, s54, v72
  s_cbranch_vccnz Cs3_recp
  ds_write_b128 v76, v[0:3] offset:10752
  ds_write_b128 v76, v[4:7] offset:11776
  ds_write_b128 v76, v[8:11] offset:12800
  v_mov_b64 v[20:21], 0
  v_mov_b64 v[22:23], 0
  v_mov_b64 v[24:25], 0
  v_mov_b64 v[26:27], 0
  v_mov_b64 v[28:29], 0
  v_mov_b64 v[30:31], 0
  v_mov_b64 v[32:33], 0
  v_mov_b64 v[34:35], 0
  s_waitcnt lgkmcnt(0)
  s_barrier
  ds_read_b128 v[0:3], v76 offset:4608
  s_waitcnt lgkmcnt(0)
  v_smfmac_f32_16x16x64_bf16 v[20:23], v[0:3], v[80:87], v74
  v_smfmac_f32_16x16x64_bf16 v[24:27], v[0:3], v[88:95], v74
  ds_read_b128 v[60:63], v76 offset:28672
  ds_read_b128 v[64:67], v76 offset:29696
  s_waitcnt lgkmcnt(0)
  v_smfmac_f32_16x16x64_bf16 v[28:31], v[0:3], v[60:67], v74
  ds_read_b128 v[60:63], v76 offset:30720
  ds_read_b128 v[64:67], v76 offset:31744
  s_waitcnt lgkmcnt(0)
  v_smfmac_f32_16x16x64_bf16 v[32:35], v[0:3], v[60:67], v74
  ds_read_b128 v[4:7], v76 offset:5632
  s_waitcnt lgkmcnt(0)
  v_smfmac_f32_16x16x64_bf16 v[20:23], v[4:7], v[96:103], v74
  v_smfmac_f32_16x16x64_bf16 v[24:27], v[4:7], v[104:111], v74
  ds_read_b128 v[60:63], v76 offset:45056
  ds_read_b128 v[64:67], v76 offset:46080
  s_waitcnt lgkmcnt(0)
  v_smfmac_f32_16x16x64_bf16 v[28:31], v[4:7], v[60:67], v74
  ds_read_b128 v[60:63], v76 offset:47104
  ds_read_b128 v[64:67], v76 offset:48128
  s_waitcnt lgkmcnt(0)
  v_smfmac_f32_16x16x64_bf16 v[32:35], v[4:7], v[60:67], v74
  ds_read_b128 v[8:11], v76 offset:6656
  s_waitcnt lgkmcnt(0)
  v_smfmac_f32_16x16x64_bf16 v[20:23], v[8:11], v[112:119], v74
  v_smfmac_f32_16x16x64_bf16 v[24:27], v[8:11], v[120:127], v74
  v_smfmac_f32_16x16x64_bf16 v[28:31], v[8:11], v[208:215], v74
  v_smfmac_f32_16x16x64_bf16 v[32:35], v[8:11], v[216:223], v74
  ds_read_b128 v[12:15], v76 offset:7680
  s_waitcnt lgkmcnt(0)
  v_smfmac_f32_16x16x64_bf16 v[20:23], v[12:15], v[128:135], v74
  v_smfmac_f32_16x16x64_bf16 v[24:27], v[12:15], v[136:143], v74
  v_smfmac_f32_16x16x64_bf16 v[28:31], v[12:15], v[224:231], v74
  v_smfmac_f32_16x16x64_bf16 v[32:35], v[12:15], v[232:239], v74
  ds_read_b128 v[4:7], v76 offset:8704
  s_waitcnt lgkmcnt(0)
  v_smfmac_f32_16x16x64_bf16 v[20:23], v[4:7], v[144:151], v74
  v_smfmac_f32_16x16x64_bf16 v[24:27], v[4:7], v[152:159], v74
  ds_read_b128 v[60:63], v76 offset:61440
  ds_read_b128 v[64:67], v76 offset:62464
  s_waitcnt lgkmcnt(0)
  v_smfmac_f32_16x16x64_bf16 v[28:31], v[4:7], v[60:67], v74
  ds_read_b128 v[60:63], v76 offset:63488
  ds_read_b128 v[64:67], v76 offset:64512
  s_waitcnt lgkmcnt(0)
  v_smfmac_f32_16x16x64_bf16 v[32:35], v[4:7], v[60:67], v74
  ds_read_b128 v[8:11], v76 offset:9728
  s_waitcnt lgkmcnt(0)
  v_smfmac_f32_16x16x64_bf16 v[20:23], v[8:11], v[160:167], v74
  v_smfmac_f32_16x16x64_bf16 v[24:27], v[8:11], v[168:175], v74
  ds_read_b128 v[60:63], v75 offset:28672
  ds_read_b128 v[64:67], v75 offset:29696
  s_waitcnt lgkmcnt(0)
  v_smfmac_f32_16x16x64_bf16 v[28:31], v[8:11], v[60:67], v74
  ds_read_b128 v[60:63], v75 offset:30720
  ds_read_b128 v[64:67], v75 offset:31744
  s_waitcnt lgkmcnt(0)
  v_smfmac_f32_16x16x64_bf16 v[32:35], v[8:11], v[60:67], v74
  ds_read_b128 v[16:19], v76 offset:10752
  ds_read_b128 v[60:63], v75 offset:12288
  ds_read_b128 v[64:67], v75 offset:13312
  s_waitcnt lgkmcnt(0)
  v_smfmac_f32_16x16x64_bf16 v[20:23], v[16:19], v[60:67], v74
  ds_read_b128 v[60:63], v75 offset:14336
  ds_read_b128 v[64:67], v75 offset:15360
  s_waitcnt lgkmcnt(0)
  v_smfmac_f32_16x16x64_bf16 v[24:27], v[16:19], v[60:67], v74
  v_smfmac_f32_16x16x64_bf16 v[28:31], v[16:19], v[240:247], v74
  v_smfmac_f32_16x16x64_bf16 v[32:35], v[16:19], v[248:255], v74
  ds_read_b128 v[0:3], v76 offset:11776
  s_waitcnt lgkmcnt(0)
  v_smfmac_f32_16x16x64_bf16 v[20:23], v[0:3], v[176:183], v74
  v_smfmac_f32_16x16x64_bf16 v[24:27], v[0:3], v[184:191], v74
  v_smfmac_f32_16x16x64_bf16 v[28:31], v[0:3], a[0:7], v74
  v_smfmac_f32_16x16x64_bf16 v[32:35], v[0:3], a[8:15], v74
  ds_read_b128 v[12:15], v76 offset:12800
  s_waitcnt lgkmcnt(0)
  v_smfmac_f32_16x16x64_bf16 v[20:23], v[12:15], v[192:199], v74
  v_smfmac_f32_16x16x64_bf16 v[24:27], v[12:15], v[200:207], v74
  v_smfmac_f32_16x16x64_bf16 v[28:31], v[12:15], a[16:23], v74
  v_smfmac_f32_16x16x64_bf16 v[32:35], v[12:15], a[24:31], v74
  v_add_f32 v20, v20, v22
  v_add_f32 v21, v21, v23
  v_add_f32 v24, v24, v26
  v_cvt_pk_bf16_f32 v22, v20, v24
  ds_write_b32 v79, v22 offset:0
  v_add_f32 v25, v25, v27
  v_cvt_pk_bf16_f32 v23, v21, v25
  ds_write_b32 v79, v23 offset:576
  v_add_f32 v28, v28, v30
  v_add_f32 v29, v29, v31
  s_waitcnt lgkmcnt(0)
  s_nop 1
  s_branch Cs3_recok
Cs3_mx:
  s_waitcnt lgkmcnt(0)
  s_barrier
  buffer_load_dwordx4 v[52:55], v76, s[8:11], s59 offen offset:0 sc1
  buffer_load_dwordx4 v[0:3], v76, s[8:11], s58 offen offset:0 sc1
  ds_read_b128 v[20:23], v77 offset:0
  ds_read_b128 v[28:31], v77 offset:256
  buffer_load_dwordx4 v[56:59], v76, s[8:11], s59 offen offset:1024 sc1
  buffer_load_dwordx4 v[4:7], v76, s[8:11], s58 offen offset:1024 sc1
  ds_read_b128 v[24:27], v77 offset:128
  ds_read_b128 v[32:35], v77 offset:384
  s_waitcnt vmcnt(2) lgkmcnt(3)
  v_mfma_f32_16x16x32_bf16 v[8:11], v[0:3], v[20:23], 0
  s_waitcnt vmcnt(0) lgkmcnt(1)
  v_mfma_f32_16x16x32_bf16 v[8:11], v[4:7], v[24:27], v[8:11]
  v_mfma_f32_16x16x32_bf16 v[12:15], v[28:31], v[20:23], 0
  s_waitcnt lgkmcnt(0)
  v_mfma_f32_16x16x32_bf16 v[12:15], v[32:35], v[24:27], v[12:15]
  v_add_f32_dpp v8, v10, v8 quad_perm:[2,3,0,1] row_mask:0xf bank_mask:0xf
  v_add_f32_dpp v9, v11, v9 quad_perm:[2,3,0,1] row_mask:0xf bank_mask:0xf
  s_nop 0
  v_mov_b32_dpp v8, v8 quad_perm:[0,1,0,1] row_mask:0xf bank_mask:0xf
  v_mov_b32_dpp v9, v9 quad_perm:[0,1,0,1] row_mask:0xf bank_mask:0xf
  s_nop 1
  v_add_f32_dpp v12, v14, v12 quad_perm:[2,3,0,1] row_mask:0xf bank_mask:0xf
  v_add_f32_dpp v13, v15, v13 quad_perm:[2,3,0,1] row_mask:0xf bank_mask:0xf
  s_nop 0
  v_mov_b32_dpp v12, v12 quad_perm:[0,1,0,1] row_mask:0xf bank_mask:0xf
  v_mov_b32_dpp v13, v13 quad_perm:[0,1,0,1] row_mask:0xf bank_mask:0xf
  v_mul_f32 v12, s69, v12
  ds_write_b32 v78, v8 offset:8716
  v_mul_f32 v13, s69, v13
  ds_write_b32 v78, v9 offset:8780
  s_waitcnt lgkmcnt(0)
  s_barrier
  ds_read_b128 v[36:39], v78 offset:8704
  ds_read_b128 v[40:43], v78 offset:8768
  s_waitcnt lgkmcnt(0)
  s_barrier
  v_max_f32 v16, v36, v37
  v_max3_f32 v16, v16, v38, v39
  v_max3_f32 v16, v16, v40, v41
  v_max3_f32 v16, v16, v42, v43
  v_max3_f32 v16, v16, v12, v13
  v_mov_b32 v17, v16
  s_nop 1
  v_permlane16_swap_b32 v16, v17
  v_max_f32 v16, v16, v17
  v_mov_b32 v17, v16
  s_nop 1
  v_permlane32_swap_b32 v16, v17
  v_max_f32 v16, v16, v17
  v_sub_f32 v36, v36, v16
  v_sub_f32 v37, v37, v16
  v_sub_f32 v38, v38, v16
  v_sub_f32 v39, v39, v16
  v_sub_f32 v40, v40, v16
  v_sub_f32 v41, v41, v16
  v_sub_f32 v42, v42, v16
  v_sub_f32 v43, v43, v16
  v_sub_f32 v12, v12, v16
  v_sub_f32 v13, v13, v16
  v_exp_f32 v36, v36
  v_exp_f32 v37, v37
  v_exp_f32 v38, v38
  v_exp_f32 v39, v39
  v_exp_f32 v40, v40
  v_exp_f32 v41, v41
  v_exp_f32 v42, v42
  v_exp_f32 v43, v43
  v_exp_f32 v12, v12
  v_exp_f32 v13, v13
  v_cvt_pk_bf16_f32 v32, v36, v40
  v_cvt_pk_bf16_f32 v33, v37, v41
  v_cvt_pk_bf16_f32 v34, v38, v42
  v_cvt_pk_bf16_f32 v35, v39, v43
  v_cvt_pk_bf16_f32 v28, v12, v13
  v_cvt_pk_bf16_f32 v31, v12, v13
  v_mov_b32 v29, 0
  v_mov_b32 v30, 0
  v_mfma_f32_16x16x32_bf16 v[8:11], v[32:35], v[68:71], 0
  v_mfma_f32_16x16x32_bf16 v[0:3], v[32:35], v[52:55], 0
  v_mfma_f32_16x16x32_bf16 v[4:7], v[32:35], v[56:59], 0
  v_mfma_f32_16x16x16_bf16 v[8:11], v[28:29], v[68:69], v[8:11]
  v_mfma_f32_16x16x16_bf16 v[0:3], v[28:29], v[72:73], v[0:3]
  v_mfma_f32_16x16x16_bf16 v[4:7], v[30:31], v[72:73], v[4:7]
  ds_read_b128 v[52:55], v75 offset:30720
  v_rcp_f32 v10, v8
  v_rcp_f32 v11, v9
  v_mul_f32 v0, v10, v0
  v_mul_f32 v1, v11, v1
  v_max3_f32 v8, v8, v9, v10
  v_mul_f32 v4, v10, v4
  v_mul_f32 v5, v11, v5
  v_cvt_pk_bf16_f32 v2, v0, v4
  ds_write_b32 v79, v2 offset:8704
  v_cvt_pk_bf16_f32 v3, v1, v5
  ds_write_b32 v79, v3 offset:9280
  ds_read_b128 v[12:15], v78 offset:8896
  ds_read_b128 v[56:59], v75 offset:31744
  v_mov_b64 v[16:17], 0
  v_mov_b64 v[18:19], 0
  v_mov_b64 v[20:21], 0
  v_mov_b64 v[22:23], 0
  v_mov_b64 v[24:25], 0
  v_mov_b64 v[26:27], 0
  s_branch Cs3_mxok
Cs3_last:
  ds_read_b128 v[0:3], v76 offset:4608
  ds_read_b128 v[12:15], v76 offset:7680
  ds_read_b128 v[44:47], v76 offset:28672
  ds_read_b128 v[48:51], v76 offset:29696
  s_nop 5
  v_mov_b64 v[20:21], 0
  v_mov_b64 v[22:23], 0
  v_mov_b64 v[24:25], 0
  v_mov_b64 v[26:27], 0
  v_smfmac_f32_16x16x64_bf16 v[28:31], v[4:7], v[36:43], v74
  ds_read_b128 v[36:39], v76 offset:30720
  ds_read_b128 v[40:43], v76 offset:31744
  v_smfmac_f32_16x16x64_bf16 v[32:35], v[4:7], v[60:67], v74
  s_waitcnt lgkmcnt(5)
  v_smfmac_f32_16x16x64_bf16 v[20:23], v[0:3], a[32:39], v74
  ds_read_b128 v[60:63], v76 offset:61440
  ds_read_b128 v[64:67], v76 offset:62464
  v_smfmac_f32_16x16x64_bf16 v[24:27], v[0:3], a[40:47], v74
  s_waitcnt lgkmcnt(4)
  v_smfmac_f32_16x16x64_bf16 v[20:23], v[4:7], a[48:55], v74
  buffer_store_dwordx4 v[16:19], v76, s[8:11], s68 offen sc1
  v_smfmac_f32_16x16x64_bf16 v[24:27], v[4:7], a[56:63], v74
  v_smfmac_f32_16x16x64_bf16 v[28:31], v[0:3], v[44:51], v74
  s_waitcnt lgkmcnt(2)
  v_smfmac_f32_16x16x64_bf16 v[20:23], v[8:11], a[64:71], v74
  ds_read_b128 v[44:47], v76 offset:63488
  ds_read_b128 v[48:51], v76 offset:64512
  v_smfmac_f32_16x16x64_bf16 v[24:27], v[8:11], a[72:79], v74
  v_smfmac_f32_16x16x64_bf16 v[32:35], v[0:3], v[36:43], v74
  v_smfmac_f32_16x16x64_bf16 v[28:31], v[8:11], v[208:215], v74
  ds_read_b128 v[36:39], v75 offset:28672
  ds_read_b128 v[40:43], v75 offset:29696
  v_smfmac_f32_16x16x64_bf16 v[32:35], v[8:11], v[216:223], v74
  v_smfmac_f32_16x16x64_bf16 v[20:23], v[12:15], a[80:87], v74
  v_smfmac_f32_16x16x64_bf16 v[24:27], v[12:15], a[88:95], v74
  v_smfmac_f32_16x16x64_bf16 v[28:31], v[12:15], v[224:231], v74
  v_smfmac_f32_16x16x64_bf16 v[32:35], v[12:15], v[232:239], v74
  s_waitcnt vmcnt(1)
  s_barrier
Cs3_lastr:
  ds_read_b128 v[4:7], v76 offset:8704
  ds_read_b128 v[8:11], v76 offset:9728
  ds_read_b128 v[16:19], v76 offset:10752
  ds_read_b128 v[0:3], v76 offset:11776
  ds_read_b128 v[12:15], v76 offset:12800
  s_waitcnt lgkmcnt(1)
  v_max3_u32 v72, v0, v1, v2
  v_max3_u32 v72, v72, v3, v4
  v_max3_u32 v72, v72, v5, v6
  v_max3_u32 v72, v72, v7, v8
  v_max3_u32 v72, v72, v9, v10
  s_waitcnt lgkmcnt(0)
  v_max3_u32 v72, v72, v11, v12
  v_max3_u32 v72, v72, v13, v14
  v_max3_u32 v72, v72, v15, v16
  v_max3_u32 v72, v72, v17, v18
  v_max_u32 v72, v72, v19
  v_cmp_eq_u32 vcc, -1, v72
  s_cbranch_vccnz Cs3_lastp
Cs3_lastg:
  v_smfmac_f32_16x16x64_bf16 v[28:31], v[4:7], v[60:67], v74
  ds_read_b128 v[60:63], v75 offset:30720
  ds_read_b128 v[64:67], v75 offset:31744
  v_smfmac_f32_16x16x64_bf16 v[32:35], v[4:7], v[44:51], v74
  v_smfmac_f32_16x16x64_bf16 v[28:31], v[8:11], v[36:43], v74
  v_smfmac_f32_16x16x64_bf16 v[28:31], v[16:19], v[240:247], v74
  v_smfmac_f32_16x16x64_bf16 v[28:31], v[0:3], a[0:7], v74
  v_smfmac_f32_16x16x64_bf16 v[28:31], v[12:15], a[16:23], v74
  v_smfmac_f32_16x16x64_bf16 v[32:35], v[16:19], v[248:255], v74
  v_smfmac_f32_16x16x64_bf16 v[32:35], v[0:3], a[8:15], v74
  s_waitcnt lgkmcnt(0)
  v_smfmac_f32_16x16x64_bf16 v[32:35], v[12:15], a[24:31], v74
  v_smfmac_f32_16x16x64_bf16 v[32:35], v[8:11], v[60:67], v74
  v_smfmac_f32_16x16x64_bf16 v[20:23], v[4:7], a[96:103], v74
  v_smfmac_f32_16x16x64_bf16 v[20:23], v[8:11], a[112:119], v74
  v_add_f32 v28, v28, v30
  v_add_f32 v32, v32, v34
  v_cvt_pk_bf16_f32 v30, v28, v32
  v_smfmac_f32_16x16x64_bf16 v[20:23], v[16:19], a[128:135], v74
  ds_write_b32 v79, v30 offset:256
  v_add_f32 v29, v29, v31
  v_add_f32 v33, v33, v35
  v_cvt_pk_bf16_f32 v31, v29, v33
  v_smfmac_f32_16x16x64_bf16 v[20:23], v[0:3], a[144:151], v74
  ds_write_b32 v79, v31 offset:832
  v_smfmac_f32_16x16x64_bf16 v[20:23], v[12:15], a[160:167], v74
  v_smfmac_f32_16x16x64_bf16 v[24:27], v[4:7], a[104:111], v74
  v_smfmac_f32_16x16x64_bf16 v[24:27], v[8:11], a[120:127], v74
  v_smfmac_f32_16x16x64_bf16 v[24:27], v[16:19], a[136:143], v74
  s_waitcnt lgkmcnt(0)
  s_barrier
  ds_read_b64 v[52:53], v77 offset:392
  v_add_f32 v20, v20, v22
  v_smfmac_f32_16x16x64_bf16 v[24:27], v[0:3], a[152:159], v74
  v_add_f32 v21, v21, v23
  v_smfmac_f32_16x16x64_bf16 v[24:27], v[12:15], a[168:175], v74
  v_cvt_pk_bf16_f32 v54, v20, v21
  s_add_u32 s68, s68, 655360
  s_nop 3
  v_add_f32 v24, v24, v26
  v_add_f32 v25, v25, v27
  v_cvt_pk_bf16_f32 v55, v24, v25
  s_waitcnt lgkmcnt(0)
  buffer_store_dwordx4 v[52:55], v76, s[8:11], s68 offen sc1
  s_branch Cs3_done
Cs3_lastp:
  s_add_u32 s72, s72, 2
  s_cmp_ge_u32 s72, 131072
  s_cbranch_scc1 Cs3_lastg
  s_barrier
  buffer_load_dwordx4 v76, s[8:11], s85 offen offset:0 sc1 lds
  buffer_load_dwordx4 v76, s[8:11], s85 offen offset:1024 sc1 lds
  s_waitcnt vmcnt(0)
  s_barrier
  s_branch Cs3_lastr
Cs3_done:
  s_branch L_cexit
L_conf:
  s_nop 11
  s_waitcnt vmcnt(0) lgkmcnt(0)
  s_barrier
  s_cmp_eq_u32 s52, 0
  s_cbranch_scc0 L_cf2
  s_mov_b64 exec, 1
  s_lshl_b32 s57, s2, 2
  v_mov_b32 v1, 0
L_cf0:
  s_cmp_eq_u32 s54, -1
  s_cbranch_scc1 L_cf1
  s_mov_b32 s55, s54
  s_lshr_b64 s[54:55], s[54:55], s0
  s_ff0_i32_b32 s56, s54
  s_add_u32 s0, s0, s56
  s_and_b32 s0, s0, 31
  s_lshl_b32 s56, 1, s0
  v_mov_b32 v35, s56
  buffer_atomic_or v35, v1, s[12:15], s57 offen sc0
  s_waitcnt vmcnt(0)
  v_readfirstlane_b32 s54, v35
  s_nop 0
  s_bitcmp1_b32 s54, s0
  s_cbranch_scc1 L_cf0
  v_mov_b32 v35, s0
  s_branch L_cf3
L_cf1:
  v_mov_b32 v35, 1
  buffer_atomic_add v35, v1, s[12:15], 0 offen offset:40 sc0
  s_waitcnt vmcnt(0)
  v_add_u32 v35, 32, v35
L_cf3:
  ds_write_b32 v33, v35
  s_mov_b64 exec, -1
  s_waitcnt lgkmcnt(0)
L_cf2:
  s_barrier
  ds_read_b32 v32, v33
  s_waitcnt lgkmcnt(0)
  v_readfirstlane_b32 s0, v32
  v_mbcnt_lo_u32_b32 v0, -1, 0
  v_mbcnt_hi_u32_b32 v0, -1, v0
  s_mov_b32 s1, 1
  s_cmp_lt_u32 s0, 32
  s_cbranch_scc1 L_role
  s_sub_u32 s53, s0, 32
  s_mov_b32 s57, 0
L_sur:
  s_load_dwordx16 s[60:75], s[12:13], 0 glc
  s_add_u32 s57, s57, 1
  s_waitcnt lgkmcnt(0)
  s_mov_b32 s55, s70
  s_bcnt1_i32_b32 s56, s60
  s_add_u32 s55, s55, s56
  s_bcnt1_i32_b32 s56, s61
  s_add_u32 s55, s55, s56
  s_bcnt1_i32_b32 s56, s62
  s_add_u32 s55, s55, s56
  s_bcnt1_i32_b32 s56, s63
  s_add_u32 s55, s55, s56
  s_bcnt1_i32_b32 s56, s64
  s_add_u32 s55, s55, s56
  s_bcnt1_i32_b32 s56, s65
  s_add_u32 s55, s55, s56
  s_bcnt1_i32_b32 s56, s66
  s_add_u32 s55, s55, s56
  s_bcnt1_i32_b32 s56, s67
  s_add_u32 s55, s55, s56
  s_cmp_ge_u32 s57, 131072
  s_cbranch_scc1 L_end
  s_cmp_lt_u32 s55, 256
  s_cbranch_scc1 L_sur
  s_mov_b32 s2, 0
  s_mov_b32 s54, s60
  s_bcnt0_i32_b32 s56, s54
  s_cmp_lt_u32 s53, s56
  s_cbranch_scc1 L_sur2
  s_sub_u32 s53, s53, s56
  s_mov_b32 s2, 1
  s_mov_b32 s54, s61
  s_bcnt0_i32_b32 s56, s54
  s_cmp_lt_u32 s53, s56
  s_cbranch_scc1 L_sur2
  s_sub_u32 s53, s53, s56
  s_mov_b32 s2, 2
  s_mov_b32 s54, s62
  s_bcnt0_i32_b32 s56, s54
  s_cmp_lt_u32 s53, s56
  s_cbranch_scc1 L_sur2
  s_sub_u32 s53, s53, s56
  s_mov_b32 s2, 3
  s_mov_b32 s54, s63
  s_bcnt0_i32_b32 s56, s54
  s_cmp_lt_u32 s53, s56
  s_cbranch_scc1 L_sur2
  s_sub_u32 s53, s53, s56
  s_mov_b32 s2, 4
  s_mov_b32 s54, s64
  s_bcnt0_i32_b32 s56, s54
  s_cmp_lt_u32 s53, s56
  s_cbranch_scc1 L_sur2
  s_sub_u32 s53, s53, s56
  s_mov_b32 s2, 5
  s_mov_b32 s54, s65
  s_bcnt0_i32_b32 s56, s54
  s_cmp_lt_u32 s53, s56
  s_cbranch_scc1 L_sur2
  s_sub_u32 s53, s53, s56
  s_mov_b32 s2, 6
  s_mov_b32 s54, s66
  s_bcnt0_i32_b32 s56, s54
  s_cmp_lt_u32 s53, s56
  s_cbranch_scc1 L_sur2
  s_sub_u32 s53, s53, s56
  s_mov_b32 s2, 7
  s_mov_b32 s54, s67
  s_bcnt0_i32_b32 s56, s54
  s_cmp_lt_u32 s53, s56
  s_cbranch_scc1 L_sur2
  s_sub_u32 s53, s53, s56
  s_branch L_end
L_sur2:
  s_ff0_i32_b32 s0, s54
  s_bitset1_b32 s54, s0
  s_sub_u32 s53, s53, 1
  s_cbranch_scc0 L_sur2
  s_branch L_role
L_worker:
  s_lshl_b32 s54, s2, 2
  s_lshr_b32 s54, 1412567136, s54
  s_and_b32 s54, s54, 7
  s_lshl_b32 s54, s54, 5
  s_add_u32 s53, s53, s54
  s_getpc_b64 s[80:81]
L_pc_2:
  s_and_b32 s55, s0, 1
  s_lshl_b32 s55, s55, 2
  s_add_u32 s55, s55, s52
  s_lshl_b32 s55, s55, 13
  v_and_b32 v199, 63, v0
  v_lshl_add_u32 v199, v199, 7, s55
  s_sub_u32 s82, s80, (L_pc_2 - L_w0)
  s_subb_u32 s83, s81, 0
  v_min_u32 v198, (L_w4 - L_w0), v199
  global_load_dword v196, v198, s[82:83]
  v_min_u32 v199, (L_end - L_pc_2), v199
  global_load_dword v196, v199, s[80:81]
  v_and_b32 v200, 63, v0
  v_lshlrev_b32 v201, 4, v200
  v_lshrrev_b32 v211, 3, v200
  s_lshl_b32 s54, s52, 3
  v_add_u32 v211, s54, v211
  v_bfe_u32 v212, v211, 1, 3
  v_and_b32 v213, 7, v200
  v_xor_b32 v212, v212, v213
  v_mul_u32_u24 v211, 1152, v211
  v_lshl_add_u32 v202, v212, 4, v211
  s_mul_i32 s67, s52, 9216
  v_and_b32 v211, 31, v200
  v_lshrrev_b32 v212, 3, v211
  v_mul_u32_u24 v212, 9216, v212
  v_and_b32 v213, 7, v211
  v_lshl_add_u32 v212, v213, 7, v212
  v_bfe_u32 v213, v211, 1, 3
  v_lshrrev_b32 v214, 5, v200
  v_xor_b32 v213, v213, v214
  v_lshl_add_u32 v203, v213, 4, v212
  v_xor_b32 v204, 32, v203
  v_xor_b32 v205, 64, v203
  v_xor_b32 v206, 0x60, v203
  v_bfe_u32 v211, v200, 2, 2
  v_lshl_add_u32 v212, v214, 3, v211
  v_lshlrev_b32 v212, 8, v212
  v_xor_b32 v211, s52, v211
  v_lshl_add_u32 v212, v211, 6, v212
  v_bfe_u32 v213, v200, 4, 1
  v_and_b32 v211, 3, v200
  v_lshl_add_u32 v210, v213, 5, v212
  v_lshl_add_u32 v210, v211, 3, v210
  v_lshl_add_u32 v209, v213, 4, v212
  v_and_b32 v213, 1, v211
  v_lshl_add_u32 v209, v213, 3, v209
  v_lshrrev_b32 v213, 1, v211
  v_lshl_add_u32 v209, v213, 5, v209
  s_mov_b32 s65, 0
  s_mul_i32 s58, s53, 9363
  s_lshr_b32 s58, s58, 16
  s_mul_i32 s54, s58, 7
  s_sub_u32 s59, s53, s54
  s_mul_i32 s60, s59, 36864
  s_add_u32 m0, s67, 0
  s_nop 0
  buffer_load_dwordx4 v202, s[4:7], s60 offen offset:0 lds
  s_add_u32 m0, s67, 896
  s_nop 0
  buffer_load_dwordx4 v202, s[4:7], s60 offen offset:128 lds
  s_add_u32 m0, s67, 1792
  s_nop 0
  buffer_load_dwordx4 v202, s[4:7], s60 offen offset:256 lds
  s_add_u32 m0, s67, 2688
  s_nop 0
  buffer_load_dwordx4 v202, s[4:7], s60 offen offset:384 lds
  s_add_u32 m0, s67, 3584
  s_nop 0
  buffer_load_dwordx4 v202, s[4:7], s60 offen offset:512 lds
  s_add_u32 m0, s67, 4480
  s_nop 0
  buffer_load_dwordx4 v202, s[4:7], s60 offen offset:640 lds
  s_add_u32 m0, s67, 5376
  s_nop 0
  buffer_load_dwordx4 v202, s[4:7], s60 offen offset:768 lds
  s_add_u32 m0, s67, 6272
  s_nop 0
  buffer_load_dwordx4 v202, s[4:7], s60 offen offset:896 lds
  s_add_u32 m0, s67, 7168
  s_nop 0
  buffer_load_dwordx4 v202, s[4:7], s60 offen offset:1024 lds
  v_lshrrev_b32 v211, 4, v200
  v_lshlrev_b32 v212, 2, v211
  v_and_b32 v213, 15, v200
  v_xor_b32 v212, v212, v213
  v_lshlrev_b32 v212, 4, v212
  v_lshl_add_u32 v207, v211, 13, v212
  s_lshl_b32 s62, s58, 8
  s_lshl_b32 s54, s52, 15
  s_add_u32 s62, s62, s54
  s_lshl_b32 s61, s52, 10
  s_add_u32 s61, s61, 36864
  s_add_u32 m0, s61, 0
  s_add_u32 s54, s62, 0
  buffer_load_dwordx4 v207, s[20:23], s54 offen lds
  s_add_u32 m0, s61, 4096
  s_add_u32 s54, s62, 131072
  buffer_load_dwordx4 v207, s[20:23], s54 offen lds
  s_add_u32 m0, s61, 8192
  s_add_u32 s54, s62, 262144
  buffer_load_dwordx4 v207, s[20:23], s54 offen lds
  s_add_u32 m0, s61, 12288
  s_add_u32 s54, s62, 393216
  buffer_load_dwordx4 v207, s[20:23], s54 offen lds
  s_add_u32 m0, s61, 16384
  s_add_u32 s54, s62, 0
  buffer_load_dwordx4 v207, s[24:27], s54 offen lds
  s_add_u32 m0, s61, 20480
  s_add_u32 s54, s62, 131072
  buffer_load_dwordx4 v207, s[24:27], s54 offen lds
  s_add_u32 m0, s61, 24576
  s_add_u32 s54, s62, 262144
  buffer_load_dwordx4 v207, s[24:27], s54 offen lds
  s_add_u32 m0, s61, 28672
  s_add_u32 s54, s62, 393216
  buffer_load_dwordx4 v207, s[24:27], s54 offen lds
  s_add_u32 m0, s61, 32768
  s_add_u32 s54, s62, 524288
  buffer_load_dwordx4 v207, s[20:23], s54 offen lds
  s_add_u32 m0, s61, 36864
  s_add_u32 s54, s62, 655360
  buffer_load_dwordx4 v207, s[20:23], s54 offen lds
  s_add_u32 m0, s61, 40960
  s_add_u32 s54, s62, 786432
  buffer_load_dwordx4 v207, s[20:23], s54 offen lds
  s_add_u32 m0, s61, 45056
  s_add_u32 s54, s62, 917504
  buffer_load_dwordx4 v207, s[20:23], s54 offen lds
  s_add_u32 m0, s61, 49152
  s_add_u32 s54, s62, 524288
  buffer_load_dwordx4 v207, s[24:27], s54 offen lds
  s_add_u32 m0, s61, 53248
  s_add_u32 s54, s62, 655360
  buffer_load_dwordx4 v207, s[24:27], s54 offen lds
  s_add_u32 m0, s61, 57344
  s_add_u32 s54, s62, 786432
  buffer_load_dwordx4 v207, s[24:27], s54 offen lds
  s_add_u32 m0, s61, 61440
  s_add_u32 s54, s62, 917504
  buffer_load_dwordx4 v207, s[24:27], s54 offen lds
  s_add_u32 m0, s61, 65536
  s_add_u32 s54, s62, 1048576
  buffer_load_dwordx4 v207, s[20:23], s54 offen lds
  s_add_u32 m0, s61, 69632
  s_add_u32 s54, s62, 1179648
  buffer_load_dwordx4 v207, s[20:23], s54 offen lds
  s_add_u32 m0, s61, 73728
  s_add_u32 s54, s62, 1310720
  buffer_load_dwordx4 v207, s[20:23], s54 offen lds
  s_add_u32 m0, s61, 77824
  s_add_u32 s54, s62, 1441792
  buffer_load_dwordx4 v207, s[20:23], s54 offen lds
  s_add_u32 m0, s61, 81920
  s_add_u32 s54, s62, 1048576
  buffer_load_dwordx4 v207, s[24:27], s54 offen lds
  s_add_u32 m0, s61, 86016
  s_add_u32 s54, s62, 1179648
  buffer_load_dwordx4 v207, s[24:27], s54 offen lds
  s_add_u32 m0, s61, 90112
  s_add_u32 s54, s62, 1310720
  buffer_load_dwordx4 v207, s[24:27], s54 offen lds
  s_add_u32 m0, s61, 94208
  s_add_u32 s54, s62, 1441792
  buffer_load_dwordx4 v207, s[24:27], s54 offen lds
  v_bfe_u32 v211, v200, 3, 2
  v_lshlrev_b32 v216, 11, v211
  v_bfe_u32 v211, v200, 1, 2
  v_lshl_add_u32 v216, v211, 6, v216
  v_lshrrev_b32 v212, 5, v200
  v_lshl_add_u32 v216, v212, 5, v216
  v_and_b32 v211, 1, v200
  v_lshl_add_u32 v216, v211, 4, v216
  v_bfe_u32 v211, v200, 4, 1
  v_lshlrev_b32 v217, 10, v211
  v_lshl_add_u32 v217, v212, 9, v217
  v_and_b32 v211, 15, v200
  v_lshl_add_u32 v217, v211, 4, v217
  s_lshl_b32 s54, s52, 11
  s_add_u32 s54, s54, 8192
  v_add_u32 v217, s54, v217
  s_waitcnt vmcnt(20) lgkmcnt(0)
  s_barrier
  s_add_u32 m0, s61, 98304
  s_add_u32 s54, s62, 1572864
  buffer_load_dwordx4 v207, s[20:23], s54 offen lds
  s_add_u32 m0, s61, 102400
  s_add_u32 s54, s62, 1703936
  buffer_load_dwordx4 v207, s[20:23], s54 offen lds
  s_add_u32 m0, s61, 106496
  s_add_u32 s54, s62, 1835008
  buffer_load_dwordx4 v207, s[20:23], s54 offen lds
  s_add_u32 m0, s61, 110592
  s_add_u32 s54, s62, 1966080
  buffer_load_dwordx4 v207, s[20:23], s54 offen lds
  v_add_u32 v215, 36864, v209
  ds_read_b64_tr_b16 a[0:1], v215 offset:0
  ds_read_b64_tr_b16 a[2:3], v215 offset:1024
  ds_read_b64_tr_b16 a[4:5], v215 offset:4096
  ds_read_b64_tr_b16 a[6:7], v215 offset:5120
  ds_read_b64_tr_b16 a[8:9], v215 offset:8192
  ds_read_b64_tr_b16 a[10:11], v215 offset:9216
  ds_read_b64_tr_b16 a[12:13], v215 offset:12288
  ds_read_b64_tr_b16 a[14:15], v215 offset:13312
  s_waitcnt vmcnt(20) lgkmcnt(0)
  s_barrier
  s_add_u32 m0, s61, 0
  s_add_u32 s54, s62, 1572864
  buffer_load_dwordx4 v207, s[24:27], s54 offen lds
  s_add_u32 m0, s61, 4096
  s_add_u32 s54, s62, 1703936
  buffer_load_dwordx4 v207, s[24:27], s54 offen lds
  s_add_u32 m0, s61, 8192
  s_add_u32 s54, s62, 1835008
  buffer_load_dwordx4 v207, s[24:27], s54 offen lds
  s_add_u32 m0, s61, 12288
  s_add_u32 s54, s62, 1966080
  buffer_load_dwordx4 v207, s[24:27], s54 offen lds
  v_add_u32 v215, 53248, v210
  ds_read_b64_tr_b16 a[144:145], v215 offset:0
  ds_read_b64_tr_b16 a[146:147], v215 offset:1024
  ds_read_b64_tr_b16 a[148:149], v215 offset:4096
  ds_read_b64_tr_b16 a[150:151], v215 offset:5120
  ds_read_b64_tr_b16 a[152:153], v215 offset:8192
  ds_read_b64_tr_b16 a[154:155], v215 offset:9216
  ds_read_b64_tr_b16 a[156:157], v215 offset:12288
  ds_read_b64_tr_b16 a[158:159], v215 offset:13312
  s_waitcnt vmcnt(20) lgkmcnt(0)
  s_barrier
  s_add_u32 m0, s61, 16384
  s_add_u32 s54, s62, 2097152
  buffer_load_dwordx4 v207, s[20:23], s54 offen lds
  s_add_u32 m0, s61, 20480
  s_add_u32 s54, s62, 2228224
  buffer_load_dwordx4 v207, s[20:23], s54 offen lds
  s_add_u32 m0, s61, 24576
  s_add_u32 s54, s62, 2359296
  buffer_load_dwordx4 v207, s[20:23], s54 offen lds
  s_add_u32 m0, s61, 28672
  s_add_u32 s54, s62, 2490368
  buffer_load_dwordx4 v207, s[20:23], s54 offen lds
  v_add_u32 v215, 69632, v209
  ds_read_b64_tr_b16 a[16:17], v215 offset:0
  ds_read_b64_tr_b16 a[18:19], v215 offset:1024
  ds_read_b64_tr_b16 a[20:21], v215 offset:4096
  ds_read_b64_tr_b16 a[22:23], v215 offset:5120
  ds_read_b64_tr_b16 a[24:25], v215 offset:8192
  ds_read_b64_tr_b16 a[26:27], v215 offset:9216
  ds_read_b64_tr_b16 a[28:29], v215 offset:12288
  ds_read_b64_tr_b16 a[30:31], v215 offset:13312
  s_waitcnt vmcnt(20) lgkmcnt(0)
  s_barrier
  s_add_u32 m0, s61, 32768
  s_add_u32 s54, s62, 2097152
  buffer_load_dwordx4 v207, s[24:27], s54 offen lds
  s_add_u32 m0, s61, 36864
  s_add_u32 s54, s62, 2228224
  buffer_load_dwordx4 v207, s[24:27], s54 offen lds
  s_add_u32 m0, s61, 40960
  s_add_u32 s54, s62, 2359296
  buffer_load_dwordx4 v207, s[24:27], s54 offen lds
  s_add_u32 m0, s61, 45056
  s_add_u32 s54, s62, 2490368
  buffer_load_dwordx4 v207, s[24:27], s54 offen lds
  v_add_u32 v215, 86016, v210
  ds_read_b64_tr_b16 a[160:161], v215 offset:0
  ds_read_b64_tr_b16 a[162:163], v215 offset:1024
  ds_read_b64_tr_b16 a[164:165], v215 offset:4096
  ds_read_b64_tr_b16 a[166:167], v215 offset:5120
  ds_read_b64_tr_b16 a[168:169], v215 offset:8192
  ds_read_b64_tr_b16 a[170:171], v215 offset:9216
  ds_read_b64_tr_b16 a[172:173], v215 offset:12288
  ds_read_b64_tr_b16 a[174:175], v215 offset:13312
  s_waitcnt vmcnt(20) lgkmcnt(0)
  s_barrier
  s_add_u32 m0, s61, 49152
  s_add_u32 s54, s62, 2621440
  buffer_load_dwordx4 v207, s[20:23], s54 offen lds
  s_add_u32 m0, s61, 53248
  s_add_u32 s54, s62, 2752512
  buffer_load_dwordx4 v207, s[20:23], s54 offen lds
  s_add_u32 m0, s61, 57344
  s_add_u32 s54, s62, 2883584
  buffer_load_dwordx4 v207, s[20:23], s54 offen lds
  s_add_u32 m0, s61, 61440
  s_add_u32 s54, s62, 3014656
  buffer_load_dwordx4 v207, s[20:23], s54 offen lds
  v_add_u32 v215, 102400, v209
  ds_read_b64_tr_b16 a[32:33], v215 offset:0
  ds_read_b64_tr_b16 a[34:35], v215 offset:1024
  ds_read_b64_tr_b16 a[36:37], v215 offset:4096
  ds_read_b64_tr_b16 a[38:39], v215 offset:5120
  ds_read_b64_tr_b16 a[40:41], v215 offset:8192
  ds_read_b64_tr_b16 a[42:43], v215 offset:9216
  ds_read_b64_tr_b16 a[44:45], v215 offset:12288
  ds_read_b64_tr_b16 a[46:47], v215 offset:13312
  s_waitcnt vmcnt(20) lgkmcnt(0)
  s_barrier
  s_add_u32 m0, s61, 65536
  s_add_u32 s54, s62, 2621440
  buffer_load_dwordx4 v207, s[24:27], s54 offen lds
  s_add_u32 m0, s61, 69632
  s_add_u32 s54, s62, 2752512
  buffer_load_dwordx4 v207, s[24:27], s54 offen lds
  s_add_u32 m0, s61, 73728
  s_add_u32 s54, s62, 2883584
  buffer_load_dwordx4 v207, s[24:27], s54 offen lds
  s_add_u32 m0, s61, 77824
  s_add_u32 s54, s62, 3014656
  buffer_load_dwordx4 v207, s[24:27], s54 offen lds
  v_add_u32 v215, 118784, v210
  ds_read_b64_tr_b16 a[176:177], v215 offset:0
  ds_read_b64_tr_b16 a[178:179], v215 offset:1024
  ds_read_b64_tr_b16 a[180:181], v215 offset:4096
  ds_read_b64_tr_b16 a[182:183], v215 offset:5120
  ds_read_b64_tr_b16 a[184:185], v215 offset:8192
  ds_read_b64_tr_b16 a[186:187], v215 offset:9216
  ds_read_b64_tr_b16 a[188:189], v215 offset:12288
  ds_read_b64_tr_b16 a[190:191], v215 offset:13312
  s_waitcnt vmcnt(20) lgkmcnt(0)
  s_barrier
  s_add_u32 m0, s61, 81920
  s_add_u32 s54, s62, 3145728
  buffer_load_dwordx4 v207, s[20:23], s54 offen lds
  s_add_u32 m0, s61, 86016
  s_add_u32 s54, s62, 3276800
  buffer_load_dwordx4 v207, s[20:23], s54 offen lds
  s_add_u32 m0, s61, 90112
  s_add_u32 s54, s62, 3407872
  buffer_load_dwordx4 v207, s[20:23], s54 offen lds
  s_add_u32 m0, s61, 94208
  s_add_u32 s54, s62, 3538944
  buffer_load_dwordx4 v207, s[20:23], s54 offen lds
  v_add_u32 v215, 135168, v209
  ds_read_b64_tr_b16 a[48:49], v215 offset:0
  ds_read_b64_tr_b16 a[50:51], v215 offset:1024
  ds_read_b64_tr_b16 a[52:53], v215 offset:4096
  ds_read_b64_tr_b16 a[54:55], v215 offset:5120
  ds_read_b64_tr_b16 a[56:57], v215 offset:8192
  ds_read_b64_tr_b16 a[58:59], v215 offset:9216
  ds_read_b64_tr_b16 a[60:61], v215 offset:12288
  ds_read_b64_tr_b16 a[62:63], v215 offset:13312
  s_waitcnt vmcnt(20) lgkmcnt(0)
  s_barrier
  s_add_u32 m0, s61, 98304
  s_add_u32 s54, s62, 3145728
  buffer_load_dwordx4 v207, s[24:27], s54 offen lds
  s_add_u32 m0, s61, 102400
  s_add_u32 s54, s62, 3276800
  buffer_load_dwordx4 v207, s[24:27], s54 offen lds
  s_add_u32 m0, s61, 106496
  s_add_u32 s54, s62, 3407872
  buffer_load_dwordx4 v207, s[24:27], s54 offen lds
  s_add_u32 m0, s61, 110592
  s_add_u32 s54, s62, 3538944
  buffer_load_dwordx4 v207, s[24:27], s54 offen lds
  v_add_u32 v215, 36864, v210
  ds_read_b64_tr_b16 a[192:193], v215 offset:0
  ds_read_b64_tr_b16 a[194:195], v215 offset:1024
  ds_read_b64_tr_b16 a[196:197], v215 offset:4096
  ds_read_b64_tr_b16 a[198:199], v215 offset:5120
  ds_read_b64_tr_b16 a[200:201], v215 offset:8192
  ds_read_b64_tr_b16 a[202:203], v215 offset:9216
  ds_read_b64_tr_b16 a[204:205], v215 offset:12288
  ds_read_b64_tr_b16 a[206:207], v215 offset:13312
  s_waitcnt vmcnt(20) lgkmcnt(0)
  s_barrier
  s_add_u32 m0, s61, 0
  s_add_u32 s54, s62, 3670016
  buffer_load_dwordx4 v207, s[20:23], s54 offen lds
  s_add_u32 m0, s61, 4096
  s_add_u32 s54, s62, 3801088
  buffer_load_dwordx4 v207, s[20:23], s54 offen lds
  s_add_u32 m0, s61, 8192
  s_add_u32 s54, s62, 3932160
  buffer_load_dwordx4 v207, s[20:23], s54 offen lds
  s_add_u32 m0, s61, 12288
  s_add_u32 s54, s62, 4063232
  buffer_load_dwordx4 v207, s[20:23], s54 offen lds
  v_add_u32 v215, 53248, v209
  ds_read_b64_tr_b16 a[64:65], v215 offset:0
  ds_read_b64_tr_b16 a[66:67], v215 offset:1024
  ds_read_b64_tr_b16 a[68:69], v215 offset:4096
  ds_read_b64_tr_b16 a[70:71], v215 offset:5120
  ds_read_b64_tr_b16 a[72:73], v215 offset:8192
  ds_read_b64_tr_b16 a[74:75], v215 offset:9216
  ds_read_b64_tr_b16 a[76:77], v215 offset:12288
  ds_read_b64_tr_b16 a[78:79], v215 offset:13312
  s_waitcnt vmcnt(20) lgkmcnt(0)
  s_barrier
  s_add_u32 m0, s61, 16384
  s_add_u32 s54, s62, 3670016
  buffer_load_dwordx4 v207, s[24:27], s54 offen lds
  s_add_u32 m0, s61, 20480
  s_add_u32 s54, s62, 3801088
  buffer_load_dwordx4 v207, s[24:27], s54 offen lds
  s_add_u32 m0, s61, 24576
  s_add_u32 s54, s62, 3932160
  buffer_load_dwordx4 v207, s[24:27], s54 offen lds
  s_add_u32 m0, s61, 28672
  s_add_u32 s54, s62, 4063232
  buffer_load_dwordx4 v207, s[24:27], s54 offen lds
  v_add_u32 v215, 69632, v210
  ds_read_b64_tr_b16 a[208:209], v215 offset:0
  ds_read_b64_tr_b16 a[210:211], v215 offset:1024
  ds_read_b64_tr_b16 a[212:213], v215 offset:4096
  ds_read_b64_tr_b16 a[214:215], v215 offset:5120
  ds_read_b64_tr_b16 a[216:217], v215 offset:8192
  ds_read_b64_tr_b16 a[218:219], v215 offset:9216
  ds_read_b64_tr_b16 a[220:221], v215 offset:12288
  ds_read_b64_tr_b16 a[222:223], v215 offset:13312
  s_waitcnt vmcnt(20) lgkmcnt(0)
  s_barrier
  s_add_u32 m0, s61, 32768
  s_add_u32 s54, s62, 4194304
  buffer_load_dwordx4 v207, s[20:23], s54 offen lds
  s_add_u32 m0, s61, 36864
  s_add_u32 s54, s62, 4325376
  buffer_load_dwordx4 v207, s[20:23], s54 offen lds
  s_add_u32 m0, s61, 40960
  s_add_u32 s54, s62, 4456448
  buffer_load_dwordx4 v207, s[20:23], s54 offen lds
  s_add_u32 m0, s61, 45056
  s_add_u32 s54, s62, 4587520
  buffer_load_dwordx4 v207, s[20:23], s54 offen lds
  v_add_u32 v215, 86016, v209
  ds_read_b64_tr_b16 a[80:81], v215 offset:0
  ds_read_b64_tr_b16 a[82:83], v215 offset:1024
  ds_read_b64_tr_b16 a[84:85], v215 offset:4096
  ds_read_b64_tr_b16 a[86:87], v215 offset:5120
  ds_read_b64_tr_b16 a[88:89], v215 offset:8192
  ds_read_b64_tr_b16 a[90:91], v215 offset:9216
  ds_read_b64_tr_b16 a[92:93], v215 offset:12288
  ds_read_b64_tr_b16 a[94:95], v215 offset:13312
  s_waitcnt vmcnt(20) lgkmcnt(0)
  s_barrier
  s_add_u32 m0, s61, 49152
  s_add_u32 s54, s62, 4194304
  buffer_load_dwordx4 v207, s[24:27], s54 offen lds
  s_add_u32 m0, s61, 53248
  s_add_u32 s54, s62, 4325376
  buffer_load_dwordx4 v207, s[24:27], s54 offen lds
  s_add_u32 m0, s61, 57344
  s_add_u32 s54, s62, 4456448
  buffer_load_dwordx4 v207, s[24:27], s54 offen lds
  s_add_u32 m0, s61, 61440
  s_add_u32 s54, s62, 4587520
  buffer_load_dwordx4 v207, s[24:27], s54 offen lds
  s_mul_i32 s54, s53, 21120
  s_lshl_b32 s55, s52, 13
  s_add_u32 s54, s54, s55
  s_cmp_eq_u32 s52, 3
  s_cselect_b32 s54, 0x10000000, s54
  v_lshlrev_b32 v211, 3, v201
  buffer_load_dword v196, v211, s[28:31], s54 offen
  v_add_u32 v215, 102400, v210
  ds_read_b64_tr_b16 a[224:225], v215 offset:0
  ds_read_b64_tr_b16 a[226:227], v215 offset:1024
  ds_read_b64_tr_b16 a[228:229], v215 offset:4096
  ds_read_b64_tr_b16 a[230:231], v215 offset:5120
  ds_read_b64_tr_b16 a[232:233], v215 offset:8192
  ds_read_b64_tr_b16 a[234:235], v215 offset:9216
  ds_read_b64_tr_b16 a[236:237], v215 offset:12288
  ds_read_b64_tr_b16 a[238:239], v215 offset:13312
  s_waitcnt vmcnt(21) lgkmcnt(0)
  s_barrier
  s_lshl_b32 s54, s53, 13
  s_lshr_b32 s55, s53, 6
  s_or_b32 s55, s55, s52
  s_cmp_eq_u32 s55, 0
  s_cselect_b32 s54, s54, 0x10000000
  v_lshlrev_b32 v211, 3, v201
  s_add_u32 s54, s54, 3145728
  buffer_load_dword v196, v211, s[16:19], s54 offen
  v_add_u32 v215, 118784, v209
  ds_read_b64_tr_b16 a[96:97], v215 offset:0
  ds_read_b64_tr_b16 a[98:99], v215 offset:1024
  ds_read_b64_tr_b16 a[100:101], v215 offset:4096
  ds_read_b64_tr_b16 a[102:103], v215 offset:5120
  ds_read_b64_tr_b16 a[104:105], v215 offset:8192
  ds_read_b64_tr_b16 a[106:107], v215 offset:9216
  ds_read_b64_tr_b16 a[108:109], v215 offset:12288
  ds_read_b64_tr_b16 a[110:111], v215 offset:13312
  s_waitcnt vmcnt(18) lgkmcnt(0)
  s_barrier
  s_lshl_b32 s55, s2, 2
  s_or_b32 s56, s52, s1
  s_cmp_eq_u32 s56, 0
  s_cselect_b32 s55, s55, 0x1000
  s_lshl_b32 s56, 1, s0
  v_mov_b32 v197, s56
  s_mov_b64 exec, 1
  buffer_atomic_or v197, off, s[12:15], s55 sc0
  s_mov_b64 exec, -1
  v_add_u32 v215, 135168, v210
  ds_read_b64_tr_b16 a[240:241], v215 offset:0
  ds_read_b64_tr_b16 a[242:243], v215 offset:1024
  ds_read_b64_tr_b16 a[244:245], v215 offset:4096
  ds_read_b64_tr_b16 a[246:247], v215 offset:5120
  ds_read_b64_tr_b16 a[248:249], v215 offset:8192
  ds_read_b64_tr_b16 a[250:251], v215 offset:9216
  ds_read_b64_tr_b16 a[252:253], v215 offset:12288
  ds_read_b64_tr_b16 a[254:255], v215 offset:13312
  s_waitcnt vmcnt(15) lgkmcnt(0)
  s_barrier
  v_add_u32 v215, 36864, v209
  ds_read_b64_tr_b16 a[112:113], v215 offset:0
  ds_read_b64_tr_b16 a[114:115], v215 offset:1024
  ds_read_b64_tr_b16 a[116:117], v215 offset:4096
  ds_read_b64_tr_b16 a[118:119], v215 offset:5120
  ds_read_b64_tr_b16 a[120:121], v215 offset:8192
  ds_read_b64_tr_b16 a[122:123], v215 offset:9216
  ds_read_b64_tr_b16 a[124:125], v215 offset:12288
  ds_read_b64_tr_b16 a[126:127], v215 offset:13312
  s_waitcnt vmcnt(11) lgkmcnt(0)
  s_barrier
  v_add_u32 v215, 53248, v210
  ds_read_b64_tr_b16 v[224:225], v215 offset:0
  ds_read_b64_tr_b16 v[226:227], v215 offset:1024
  ds_read_b64_tr_b16 v[228:229], v215 offset:4096
  ds_read_b64_tr_b16 v[230:231], v215 offset:5120
  ds_read_b64_tr_b16 v[232:233], v215 offset:8192
  ds_read_b64_tr_b16 v[234:235], v215 offset:9216
  ds_read_b64_tr_b16 v[236:237], v215 offset:12288
  ds_read_b64_tr_b16 v[238:239], v215 offset:13312
  s_waitcnt vmcnt(7) lgkmcnt(0)
  s_barrier
  v_add_u32 v215, 69632, v209
  ds_read_b64_tr_b16 a[128:129], v215 offset:0
  ds_read_b64_tr_b16 a[130:131], v215 offset:1024
  ds_read_b64_tr_b16 a[132:133], v215 offset:4096
  ds_read_b64_tr_b16 a[134:135], v215 offset:5120
  ds_read_b64_tr_b16 a[136:137], v215 offset:8192
  ds_read_b64_tr_b16 a[138:139], v215 offset:9216
  ds_read_b64_tr_b16 a[140:141], v215 offset:12288
  ds_read_b64_tr_b16 a[142:143], v215 offset:13312
  s_waitcnt vmcnt(3) lgkmcnt(0)
  s_barrier
  v_add_u32 v215, 86016, v210
  ds_read_b64_tr_b16 v[240:241], v215 offset:0
  ds_read_b64_tr_b16 v[242:243], v215 offset:1024
  ds_read_b64_tr_b16 v[244:245], v215 offset:4096
  ds_read_b64_tr_b16 v[246:247], v215 offset:5120
  ds_read_b64_tr_b16 v[248:249], v215 offset:8192
  ds_read_b64_tr_b16 v[250:251], v215 offset:9216
  ds_read_b64_tr_b16 v[252:253], v215 offset:12288
  ds_read_b64_tr_b16 v[254:255], v215 offset:13312
  s_waitcnt lgkmcnt(0)
  s_barrier
  s_mov_b32 s68, 1040356334
  s_lshl_b32 s69, s52, 9
  s_lshl_b32 s70, s58, 2
  s_add_u32 s70, s70, 128
  s_mul_i32 s66, s58, -12288
  s_lshl_b32 s54, s52, 10
  s_add_u32 s66, s66, s54
  s_add_u32 s66, s66, 524288
  v_mov_b32 v64, -1
  v_mov_b32 v65, -1
  v_mov_b32 v66, -1
  v_mov_b32 v67, -1
  s_add_u32 s60, s60, 258048
  ds_read_b128 v[32:35], v203 offset:0
  ds_read_b128 v[36:39], v204 offset:0
  ds_read_b128 v[40:43], v205 offset:0
  s_waitcnt lgkmcnt(2)
  v_mfma_f32_32x32x16_bf16 v[0:15], a[0:3], v[32:35], 0
  ds_read_b128 v[44:47], v206 offset:0
  s_add_u32 m0, s67, 36864
  s_nop 0
  buffer_load_dwordx4 v202, s[4:7], s60 offen offset:0 lds
  v_mfma_f32_32x32x16_bf16 v[16:31], v[32:35], a[144:147], 0
  s_waitcnt lgkmcnt(2)
  v_mfma_f32_32x32x16_bf16 v[0:15], a[4:7], v[36:39], v[0:15]
  ds_read_b128 v[32:35], v203 offset:1024
  s_add_u32 m0, s67, 37760
  s_nop 0
  buffer_load_dwordx4 v202, s[4:7], s60 offen offset:128 lds
  v_mfma_f32_32x32x16_bf16 v[16:31], v[36:39], a[148:151], v[16:31]
  s_waitcnt lgkmcnt(2)
  v_mfma_f32_32x32x16_bf16 v[0:15], a[8:11], v[40:43], v[0:15]
  ds_read_b128 v[36:39], v204 offset:1024
  s_add_u32 m0, s67, 38656
  s_nop 0
  buffer_load_dwordx4 v202, s[4:7], s60 offen offset:256 lds
  v_mfma_f32_32x32x16_bf16 v[16:31], v[40:43], a[152:155], v[16:31]
  s_waitcnt lgkmcnt(2)
  v_mfma_f32_32x32x16_bf16 v[0:15], a[12:15], v[44:47], v[0:15]
  ds_read_b128 v[40:43], v205 offset:1024
  s_add_u32 m0, s67, 39552
  s_nop 0
  buffer_load_dwordx4 v202, s[4:7], s60 offen offset:384 lds
  v_mfma_f32_32x32x16_bf16 v[16:31], v[44:47], a[156:159], v[16:31]
  s_waitcnt lgkmcnt(2)
  v_mfma_f32_32x32x16_bf16 v[0:15], a[16:19], v[32:35], v[0:15]
  ds_read_b128 v[44:47], v206 offset:1024
  s_add_u32 m0, s67, 40448
  s_nop 0
  buffer_load_dwordx4 v202, s[4:7], s60 offen offset:512 lds
  v_mfma_f32_32x32x16_bf16 v[16:31], v[32:35], a[160:163], v[16:31]
  s_waitcnt lgkmcnt(2)
  v_mfma_f32_32x32x16_bf16 v[0:15], a[20:23], v[36:39], v[0:15]
  ds_read_b128 v[32:35], v203 offset:2048
  s_add_u32 m0, s67, 41344
  s_nop 0
  buffer_load_dwordx4 v202, s[4:7], s60 offen offset:640 lds
  v_mfma_f32_32x32x16_bf16 v[16:31], v[36:39], a[164:167], v[16:31]
  s_waitcnt lgkmcnt(2)
  v_mfma_f32_32x32x16_bf16 v[0:15], a[24:27], v[40:43], v[0:15]
  ds_read_b128 v[36:39], v204 offset:2048
  s_add_u32 m0, s67, 42240
  s_nop 0
  buffer_load_dwordx4 v202, s[4:7], s60 offen offset:768 lds
  v_mfma_f32_32x32x16_bf16 v[16:31], v[40:43], a[168:171], v[16:31]
  s_waitcnt lgkmcnt(2)
  v_mfma_f32_32x32x16_bf16 v[0:15], a[28:31], v[44:47], v[0:15]
  ds_read_b128 v[40:43], v205 offset:2048
  s_add_u32 m0, s67, 43136
  s_nop 0
  buffer_load_dwordx4 v202, s[4:7], s60 offen offset:896 lds
  v_mfma_f32_32x32x16_bf16 v[16:31], v[44:47], a[172:175], v[16:31]
  s_waitcnt lgkmcnt(2)
  v_mfma_f32_32x32x16_bf16 v[0:15], a[32:35], v[32:35], v[0:15]
  ds_read_b128 v[44:47], v206 offset:2048
  s_add_u32 m0, s67, 44032
  s_nop 0
  buffer_load_dwordx4 v202, s[4:7], s60 offen offset:1024 lds
  v_mfma_f32_32x32x16_bf16 v[16:31], v[32:35], a[176:179], v[16:31]
  s_waitcnt lgkmcnt(2)
  v_mfma_f32_32x32x16_bf16 v[0:15], a[36:39], v[36:39], v[0:15]
  ds_read_b128 v[32:35], v203 offset:3072
  v_mfma_f32_32x32x16_bf16 v[16:31], v[36:39], a[180:183], v[16:31]
  s_waitcnt lgkmcnt(2)
  v_mfma_f32_32x32x16_bf16 v[0:15], a[40:43], v[40:43], v[0:15]
  ds_read_b128 v[36:39], v204 offset:3072
  v_mfma_f32_32x32x16_bf16 v[16:31], v[40:43], a[184:187], v[16:31]
  s_waitcnt lgkmcnt(2)
  v_mfma_f32_32x32x16_bf16 v[0:15], a[44:47], v[44:47], v[0:15]
  ds_read_b128 v[40:43], v205 offset:3072
  v_mfma_f32_32x32x16_bf16 v[16:31], v[44:47], a[188:191], v[16:31]
  s_waitcnt lgkmcnt(2)
  v_mfma_f32_32x32x16_bf16 v[0:15], a[48:51], v[32:35], v[0:15]
  ds_read_b128 v[44:47], v206 offset:3072
  v_mfma_f32_32x32x16_bf16 v[16:31], v[32:35], a[192:195], v[16:31]
  s_waitcnt lgkmcnt(2)
  v_mfma_f32_32x32x16_bf16 v[0:15], a[52:55], v[36:39], v[0:15]
  ds_read_b128 v[32:35], v203 offset:4096
  v_mfma_f32_32x32x16_bf16 v[16:31], v[36:39], a[196:199], v[16:31]
  s_waitcnt lgkmcnt(2)
  v_mfma_f32_32x32x16_bf16 v[0:15], a[56:59], v[40:43], v[0:15]
  ds_read_b128 v[36:39], v204 offset:4096
  v_mfma_f32_32x32x16_bf16 v[16:31], v[40:43], a[200:203], v[16:31]
  s_waitcnt lgkmcnt(2)
  v_mfma_f32_32x32x16_bf16 v[0:15], a[60:63], v[44:47], v[0:15]
  ds_read_b128 v[40:43], v205 offset:4096
  v_mfma_f32_32x32x16_bf16 v[16:31], v[44:47], a[204:207], v[16:31]
  s_waitcnt lgkmcnt(2)
  v_mfma_f32_32x32x16_bf16 v[0:15], a[64:67], v[32:35], v[0:15]
  ds_read_b128 v[44:47], v206 offset:4096
  v_mfma_f32_32x32x16_bf16 v[16:31], v[32:35], a[208:211], v[16:31]
  s_waitcnt lgkmcnt(2)
  v_mfma_f32_32x32x16_bf16 v[0:15], a[68:71], v[36:39], v[0:15]
  ds_read_b128 v[32:35], v203 offset:5120
  v_mfma_f32_32x32x16_bf16 v[16:31], v[36:39], a[212:215], v[16:31]
  s_waitcnt lgkmcnt(2)
  v_mfma_f32_32x32x16_bf16 v[0:15], a[72:75], v[40:43], v[0:15]
  ds_read_b128 v[36:39], v204 offset:5120
  v_mfma_f32_32x32x16_bf16 v[16:31], v[40:43], a[216:219], v[16:31]
  s_waitcnt lgkmcnt(2)
  v_mfma_f32_32x32x16_bf16 v[0:15], a[76:79], v[44:47], v[0:15]
  ds_read_b128 v[40:43], v205 offset:5120
  v_mfma_f32_32x32x16_bf16 v[16:31], v[44:47], a[220:223], v[16:31]
  s_waitcnt lgkmcnt(2)
  v_mfma_f32_32x32x16_bf16 v[0:15], a[80:83], v[32:35], v[0:15]
  ds_read_b128 v[44:47], v206 offset:5120
  v_mfma_f32_32x32x16_bf16 v[16:31], v[32:35], a[224:227], v[16:31]
  s_waitcnt lgkmcnt(2)
  v_mfma_f32_32x32x16_bf16 v[0:15], a[84:87], v[36:39], v[0:15]
  ds_read_b128 v[32:35], v203 offset:6144
  v_mfma_f32_32x32x16_bf16 v[16:31], v[36:39], a[228:231], v[16:31]
  s_waitcnt lgkmcnt(2)
  v_mfma_f32_32x32x16_bf16 v[0:15], a[88:91], v[40:43], v[0:15]
  ds_read_b128 v[36:39], v204 offset:6144
  v_mfma_f32_32x32x16_bf16 v[16:31], v[40:43], a[232:235], v[16:31]
  s_waitcnt lgkmcnt(2)
  v_mfma_f32_32x32x16_bf16 v[0:15], a[92:95], v[44:47], v[0:15]
  ds_read_b128 v[40:43], v205 offset:6144
  v_mfma_f32_32x32x16_bf16 v[16:31], v[44:47], a[236:239], v[16:31]
  s_waitcnt lgkmcnt(2)
  v_mfma_f32_32x32x16_bf16 v[0:15], a[96:99], v[32:35], v[0:15]
  ds_read_b128 v[44:47], v206 offset:6144
  v_mfma_f32_32x32x16_bf16 v[16:31], v[32:35], a[240:243], v[16:31]
  s_waitcnt lgkmcnt(2)
  v_mfma_f32_32x32x16_bf16 v[0:15], a[100:103], v[36:39], v[0:15]
  ds_read_b128 v[32:35], v203 offset:7168
  v_mfma_f32_32x32x16_bf16 v[16:31], v[36:39], a[244:247], v[16:31]
  s_waitcnt lgkmcnt(2)
  v_mfma_f32_32x32x16_bf16 v[0:15], a[104:107], v[40:43], v[0:15]
  ds_read_b128 v[36:39], v204 offset:7168
  v_mfma_f32_32x32x16_bf16 v[16:31], v[40:43], a[248:251], v[16:31]
  s_waitcnt lgkmcnt(2)
  v_mfma_f32_32x32x16_bf16 v[0:15], a[108:111], v[44:47], v[0:15]
  ds_read_b128 v[40:43], v205 offset:7168
  v_mfma_f32_32x32x16_bf16 v[16:31], v[44:47], a[252:255], v[16:31]
  s_waitcnt lgkmcnt(2)
  v_mfma_f32_32x32x16_bf16 v[0:15], a[112:115], v[32:35], v[0:15]
  ds_read_b128 v[44:47], v206 offset:7168
  v_mfma_f32_32x32x16_bf16 v[16:31], v[32:35], v[224:227], v[16:31]
  s_waitcnt lgkmcnt(2)
  v_mfma_f32_32x32x16_bf16 v[0:15], a[116:119], v[36:39], v[0:15]
  ds_read_b128 v[32:35], v203 offset:8192
  v_mfma_f32_32x32x16_bf16 v[16:31], v[36:39], v[228:231], v[16:31]
  s_waitcnt lgkmcnt(2)
  v_mfma_f32_32x32x16_bf16 v[0:15], a[120:123], v[40:43], v[0:15]
  ds_read_b128 v[36:39], v204 offset:8192
  v_mfma_f32_32x32x16_bf16 v[16:31], v[40:43], v[232:235], v[16:31]
  s_waitcnt lgkmcnt(2)
  v_mfma_f32_32x32x16_bf16 v[0:15], a[124:127], v[44:47], v[0:15]
  ds_read_b128 v[40:43], v205 offset:8192
  v_mfma_f32_32x32x16_bf16 v[16:31], v[44:47], v[236:239], v[16:31]
  s_waitcnt lgkmcnt(2)
  v_mfma_f32_32x32x16_bf16 v[0:15], a[128:131], v[32:35], v[0:15]
  ds_read_b128 v[44:47], v206 offset:8192
  v_mfma_f32_32x32x16_bf16 v[16:31], v[32:35], v[240:243], v[16:31]
  s_waitcnt lgkmcnt(2)
  v_mfma_f32_32x32x16_bf16 v[0:15], a[132:135], v[36:39], v[0:15]
  v_mfma_f32_32x32x16_bf16 v[16:31], v[36:39], v[244:247], v[16:31]
  s_waitcnt lgkmcnt(1)
  v_mfma_f32_32x32x16_bf16 v[0:15], a[136:139], v[40:43], v[0:15]
  v_mfma_f32_32x32x16_bf16 v[16:31], v[40:43], v[248:251], v[16:31]
  s_waitcnt lgkmcnt(0)
  v_mfma_f32_32x32x16_bf16 v[0:15], a[140:143], v[44:47], v[0:15]
  v_mfma_f32_32x32x16_bf16 v[16:31], v[44:47], v[252:255], v[16:31]
  s_mul_i32 s64, s59, 655360
  s_lshl_b32 s55, s58, 14
  s_add_u32 s64, s64, s55
  s_add_u32 s64, s64, 1048576
  s_add_u32 s72, s64, s69
  s_add_u32 s73, s64, s66
  s_add_u32 s59, s59, 7
  s_waitcnt vmcnt(0)
  s_barrier
  s_cmp_eq_u32 s1, 1
  s_cbranch_scc1 W_ver_ok
  v_mov_b32 v33, 163832
  s_cmp_eq_u32 s52, 0
  s_cbranch_scc0 W_ver_b
  s_waitcnt vmcnt(0)
  s_mov_b64 exec, 1
  ds_write_b32 v33, v197
  s_mov_b64 exec, -1
  s_waitcnt lgkmcnt(0)
W_ver_b:
  s_barrier
  ds_read_b32 v32, v33
  s_waitcnt lgkmcnt(0)
  v_readfirstlane_b32 s54, v32
  s_nop 0
  s_bitcmp1_b32 s54, s0
  s_cbranch_scc1 L_conf
W_ver_ok:
  s_lshr_b32 s55, s53, 1
  s_and_b32 s56, s53, 1
  s_lshl_b32 s56, s56, 13
  s_lshl_b32 s55, s55, 8
  s_add_u32 s55, s55, s56
  s_add_u32 s55, s55, 393216
  s_cmp_lt_u32 s53, 64
  s_cselect_b32 s71, s55, 268435456
  v_mov_b32 v211, 0
  s_mov_b64 exec, 1
  buffer_store_dword v211, v211, s[8:11], s71 offen sc1
  s_mov_b64 exec, -1
  s_cmp_eq_u32 s59, 7
  s_cbranch_scc0 KV_na
  s_mul_i32 s54, s58, 2176
  s_mul_i32 s55, s52, 69632
  s_add_u32 s55, s55, s54
  s_add_u32 s55, s55, 0
  s_add_u32 s54, s54, 278528
  s_and_b32 s56, s58, 7
  s_lshl_b32 s56, s56, 12
  s_bfe_u32 s57, s58, 0x10003
  s_lshl_b32 s57, s57, 11
  s_add_u32 s56, s56, s57
  s_add_u32 s54, s56, 262144
  s_lshr_b32 s57, s58, 4
  s_lshl_b32 s57, s57, 15
  s_add_u32 s56, s56, s57
  s_lshl_b32 s57, s52, 16
  s_add_u32 s56, s56, s57
  s_add_u32 s55, s56, 0
  s_lshl_b32 s56, s58, 14
  s_mul_i32 s57, s52, 3072
  s_add_u32 s56, s56, s57
  s_add_u32 s56, s56, 360448
  s_cmp_lt_u32 s58, 2
  s_cselect_b32 s56, s56, 268435456
  s_cmp_eq_u32 s52, 0
  s_cselect_b32 s54, s54, 268435456
  buffer_store_dwordx4 v[64:67], v201, s[8:11], s55 offen offset:0 sc1
  buffer_store_dwordx4 v[64:67], v201, s[8:11], s55 offen offset:1024 sc1
  buffer_store_dwordx4 v[64:67], v201, s[8:11], s54 offen offset:0 sc1
  buffer_store_dwordx4 v[64:67], v201, s[8:11], s54 offen offset:1024 sc1
  buffer_store_dwordx4 v[64:67], v201, s[8:11], s56 offen offset:0 sc1
  buffer_store_dwordx4 v[64:67], v201, s[8:11], s56 offen offset:1024 sc1
  buffer_store_dwordx4 v[64:67], v201, s[8:11], s56 offen offset:2048 sc1
KV_na:
KV_loop:
  s_add_u32 s60, s60, 258048
  ds_read_b128 v[32:35], v203 offset:36864
  ds_read_b128 v[36:39], v204 offset:36864
  ds_read_b128 v[40:43], v205 offset:36864
  s_waitcnt lgkmcnt(2)
  v_mfma_f32_32x32x16_bf16 v[68:83], a[0:3], v[32:35], 0
  ds_read_b128 v[44:47], v206 offset:36864
  s_add_u32 m0, s67, 0
  s_nop 0
  buffer_load_dwordx4 v202, s[4:7], s60 offen offset:0 lds
  v_mfma_f32_32x32x16_bf16 v[84:99], v[32:35], a[144:147], 0
  s_waitcnt lgkmcnt(2)
  v_mfma_f32_32x32x16_bf16 v[68:83], a[4:7], v[36:39], v[68:83]
  ds_read_b128 v[32:35], v203 offset:37888
  s_add_u32 m0, s67, 896
  s_nop 0
  buffer_load_dwordx4 v202, s[4:7], s60 offen offset:128 lds
  v_mfma_f32_32x32x16_bf16 v[84:99], v[36:39], a[148:151], v[84:99]
  s_waitcnt lgkmcnt(2)
  v_mfma_f32_32x32x16_bf16 v[68:83], a[8:11], v[40:43], v[68:83]
  ds_read_b128 v[36:39], v204 offset:37888
  s_add_u32 m0, s67, 1792
  s_nop 0
  buffer_load_dwordx4 v202, s[4:7], s60 offen offset:256 lds
  v_mfma_f32_32x32x16_bf16 v[84:99], v[40:43], a[152:155], v[84:99]
  s_waitcnt lgkmcnt(2)
  v_mfma_f32_32x32x16_bf16 v[68:83], a[12:15], v[44:47], v[68:83]
  ds_read_b128 v[40:43], v205 offset:37888
  s_add_u32 m0, s67, 2688
  s_nop 0
  buffer_load_dwordx4 v202, s[4:7], s60 offen offset:384 lds
  v_mfma_f32_32x32x16_bf16 v[84:99], v[44:47], a[156:159], v[84:99]
  s_waitcnt lgkmcnt(2)
  v_mfma_f32_32x32x16_bf16 v[68:83], a[16:19], v[32:35], v[68:83]
  ds_read_b128 v[44:47], v206 offset:37888
  s_add_u32 m0, s67, 3584
  s_nop 0
  buffer_load_dwordx4 v202, s[4:7], s60 offen offset:512 lds
  v_mfma_f32_32x32x16_bf16 v[84:99], v[32:35], a[160:163], v[84:99]
  s_waitcnt lgkmcnt(2)
  v_mfma_f32_32x32x16_bf16 v[68:83], a[20:23], v[36:39], v[68:83]
  ds_read_b128 v[32:35], v203 offset:38912
  s_add_u32 m0, s67, 4480
  s_nop 0
  buffer_load_dwordx4 v202, s[4:7], s60 offen offset:640 lds
  v_mfma_f32_32x32x16_bf16 v[84:99], v[36:39], a[164:167], v[84:99]
  s_waitcnt lgkmcnt(2)
  v_mfma_f32_32x32x16_bf16 v[68:83], a[24:27], v[40:43], v[68:83]
  ds_read_b128 v[36:39], v204 offset:38912
  s_add_u32 m0, s67, 5376
  s_nop 0
  buffer_load_dwordx4 v202, s[4:7], s60 offen offset:768 lds
  v_mfma_f32_32x32x16_bf16 v[84:99], v[40:43], a[168:171], v[84:99]
  s_waitcnt lgkmcnt(2)
  v_mfma_f32_32x32x16_bf16 v[68:83], a[28:31], v[44:47], v[68:83]
  ds_read_b128 v[40:43], v205 offset:38912
  s_add_u32 m0, s67, 6272
  s_nop 0
  buffer_load_dwordx4 v202, s[4:7], s60 offen offset:896 lds
  v_mfma_f32_32x32x16_bf16 v[84:99], v[44:47], a[172:175], v[84:99]
  s_waitcnt lgkmcnt(2)
  v_mfma_f32_32x32x16_bf16 v[68:83], a[32:35], v[32:35], v[68:83]
  ds_read_b128 v[44:47], v206 offset:38912
  s_add_u32 m0, s67, 7168
  s_nop 0
  buffer_load_dwordx4 v202, s[4:7], s60 offen offset:1024 lds
  v_mfma_f32_32x32x16_bf16 v[84:99], v[32:35], a[176:179], v[84:99]
  s_waitcnt lgkmcnt(2)
  v_mfma_f32_32x32x16_bf16 v[68:83], a[36:39], v[36:39], v[68:83]
  ds_read_b128 v[32:35], v203 offset:39936
  v_mul_f32 v0, s68, v0
  v_mul_f32 v1, s68, v1
  v_mul_f32 v2, s68, v2
  v_mul_f32 v3, s68, v3
  v_mfma_f32_32x32x16_bf16 v[84:99], v[36:39], a[180:183], v[84:99]
  v_mul_f32 v4, s68, v4
  v_mul_f32 v5, s68, v5
  v_mul_f32 v6, s68, v6
  v_mul_f32 v7, s68, v7
  s_waitcnt lgkmcnt(2)
  v_mfma_f32_32x32x16_bf16 v[68:83], a[40:43], v[40:43], v[68:83]
  ds_read_b128 v[36:39], v204 offset:39936
  v_cvt_pk_bf16_f32 v48, v0, v4
  v_cvt_pk_bf16_f32 v49, v1, v5
  v_cvt_pk_bf16_f32 v50, v2, v6
  v_cvt_pk_bf16_f32 v51, v3, v7
  v_mfma_f32_32x32x16_bf16 v[84:99], v[40:43], a[184:187], v[84:99]
  buffer_store_dwordx4 v[48:51], v216, s[8:11], s72 offen offset:0 sc1
  s_waitcnt lgkmcnt(2)
  v_mfma_f32_32x32x16_bf16 v[68:83], a[44:47], v[44:47], v[68:83]
  ds_read_b128 v[40:43], v205 offset:39936
  v_mfma_f32_32x32x16_bf16 v[84:99], v[44:47], a[188:191], v[84:99]
  s_waitcnt lgkmcnt(2)
  v_mfma_f32_32x32x16_bf16 v[68:83], a[48:51], v[32:35], v[68:83]
  ds_read_b128 v[44:47], v206 offset:39936
  v_mul_f32 v8, s68, v8
  v_mul_f32 v9, s68, v9
  v_mul_f32 v10, s68, v10
  v_mul_f32 v11, s68, v11
  v_mfma_f32_32x32x16_bf16 v[84:99], v[32:35], a[192:195], v[84:99]
  v_mul_f32 v12, s68, v12
  v_mul_f32 v13, s68, v13
  v_mul_f32 v14, s68, v14
  v_mul_f32 v15, s68, v15
  s_waitcnt lgkmcnt(2)
  v_mfma_f32_32x32x16_bf16 v[68:83], a[52:55], v[36:39], v[68:83]
  ds_read_b128 v[32:35], v203 offset:40960
  v_cvt_pk_bf16_f32 v52, v8, v12
  v_cvt_pk_bf16_f32 v53, v9, v13
  v_cvt_pk_bf16_f32 v54, v10, v14
  v_cvt_pk_bf16_f32 v55, v11, v15
  v_mfma_f32_32x32x16_bf16 v[84:99], v[36:39], a[196:199], v[84:99]
  buffer_store_dwordx4 v[52:55], v216, s[8:11], s72 offen offset:256 sc1
  s_waitcnt lgkmcnt(2)
  v_mfma_f32_32x32x16_bf16 v[68:83], a[56:59], v[40:43], v[68:83]
  ds_read_b128 v[36:39], v204 offset:40960
  v_mfma_f32_32x32x16_bf16 v[84:99], v[40:43], a[200:203], v[84:99]
  s_waitcnt lgkmcnt(2)
  v_mfma_f32_32x32x16_bf16 v[68:83], a[60:63], v[44:47], v[68:83]
  ds_read_b128 v[40:43], v205 offset:40960
  v_cvt_pk_bf16_f32 v56, v16, v17
  v_cvt_pk_bf16_f32 v57, v20, v21
  v_cvt_pk_bf16_f32 v58, v24, v25
  v_cvt_pk_bf16_f32 v59, v28, v29
  v_mfma_f32_32x32x16_bf16 v[84:99], v[44:47], a[204:207], v[84:99]
  buffer_store_dwordx4 v[56:59], v217, s[8:11], s64 offen offset:0 sc1
  s_waitcnt lgkmcnt(2)
  v_mfma_f32_32x32x16_bf16 v[68:83], a[64:67], v[32:35], v[68:83]
  ds_read_b128 v[44:47], v206 offset:40960
  v_mfma_f32_32x32x16_bf16 v[84:99], v[32:35], a[208:211], v[84:99]
  s_waitcnt lgkmcnt(2)
  v_mfma_f32_32x32x16_bf16 v[68:83], a[68:71], v[36:39], v[68:83]
  ds_read_b128 v[32:35], v203 offset:41984
  v_cvt_pk_bf16_f32 v60, v18, v19
  v_cvt_pk_bf16_f32 v61, v22, v23
  v_cvt_pk_bf16_f32 v62, v26, v27
  v_cvt_pk_bf16_f32 v63, v30, v31
  v_mfma_f32_32x32x16_bf16 v[84:99], v[36:39], a[212:215], v[84:99]
  buffer_store_dwordx4 v[60:63], v217, s[8:11], s64 offen offset:256 sc1
  s_waitcnt lgkmcnt(2)
  v_mfma_f32_32x32x16_bf16 v[68:83], a[72:75], v[40:43], v[68:83]
  ds_read_b128 v[36:39], v204 offset:41984
  v_mfma_f32_32x32x16_bf16 v[84:99], v[40:43], a[216:219], v[84:99]
  s_waitcnt lgkmcnt(2)
  v_mfma_f32_32x32x16_bf16 v[68:83], a[76:79], v[44:47], v[68:83]
  ds_read_b128 v[40:43], v205 offset:41984
  buffer_store_dwordx4 v[64:67], v201, s[8:11], s73 offen sc1
  v_mfma_f32_32x32x16_bf16 v[84:99], v[44:47], a[220:223], v[84:99]
  s_waitcnt lgkmcnt(2)
  v_mfma_f32_32x32x16_bf16 v[68:83], a[80:83], v[32:35], v[68:83]
  ds_read_b128 v[44:47], v206 offset:41984
  v_mfma_f32_32x32x16_bf16 v[84:99], v[32:35], a[224:227], v[84:99]
  s_waitcnt lgkmcnt(2)
  v_mfma_f32_32x32x16_bf16 v[68:83], a[84:87], v[36:39], v[68:83]
  ds_read_b128 v[32:35], v203 offset:43008
  v_mfma_f32_32x32x16_bf16 v[84:99], v[36:39], a[228:231], v[84:99]
  s_waitcnt lgkmcnt(2)
  v_mfma_f32_32x32x16_bf16 v[68:83], a[88:91], v[40:43], v[68:83]
  ds_read_b128 v[36:39], v204 offset:43008
  v_mfma_f32_32x32x16_bf16 v[84:99], v[40:43], a[232:235], v[84:99]
  s_waitcnt lgkmcnt(2)
  v_mfma_f32_32x32x16_bf16 v[68:83], a[92:95], v[44:47], v[68:83]
  ds_read_b128 v[40:43], v205 offset:43008
  v_mfma_f32_32x32x16_bf16 v[84:99], v[44:47], a[236:239], v[84:99]
  s_waitcnt lgkmcnt(2)
  v_mfma_f32_32x32x16_bf16 v[68:83], a[96:99], v[32:35], v[68:83]
  ds_read_b128 v[44:47], v206 offset:43008
  v_mfma_f32_32x32x16_bf16 v[84:99], v[32:35], a[240:243], v[84:99]
  s_waitcnt lgkmcnt(2)
  v_mfma_f32_32x32x16_bf16 v[68:83], a[100:103], v[36:39], v[68:83]
  ds_read_b128 v[32:35], v203 offset:44032
  v_mfma_f32_32x32x16_bf16 v[84:99], v[36:39], a[244:247], v[84:99]
  s_waitcnt lgkmcnt(2)
  v_mfma_f32_32x32x16_bf16 v[68:83], a[104:107], v[40:43], v[68:83]
  ds_read_b128 v[36:39], v204 offset:44032
  v_mfma_f32_32x32x16_bf16 v[84:99], v[40:43], a[248:251], v[84:99]
  s_waitcnt lgkmcnt(2)
  v_mfma_f32_32x32x16_bf16 v[68:83], a[108:111], v[44:47], v[68:83]
  ds_read_b128 v[40:43], v205 offset:44032
  v_mfma_f32_32x32x16_bf16 v[84:99], v[44:47], a[252:255], v[84:99]
  s_waitcnt lgkmcnt(2)
  v_mfma_f32_32x32x16_bf16 v[68:83], a[112:115], v[32:35], v[68:83]
  ds_read_b128 v[44:47], v206 offset:44032
  v_mfma_f32_32x32x16_bf16 v[84:99], v[32:35], v[224:227], v[84:99]
  s_waitcnt lgkmcnt(2)
  v_mfma_f32_32x32x16_bf16 v[68:83], a[116:119], v[36:39], v[68:83]
  ds_read_b128 v[32:35], v203 offset:45056
  v_mfma_f32_32x32x16_bf16 v[84:99], v[36:39], v[228:231], v[84:99]
  s_waitcnt lgkmcnt(2)
  v_mfma_f32_32x32x16_bf16 v[68:83], a[120:123], v[40:43], v[68:83]
  ds_read_b128 v[36:39], v204 offset:45056
  v_mfma_f32_32x32x16_bf16 v[84:99], v[40:43], v[232:235], v[84:99]
  s_waitcnt lgkmcnt(2)
  v_mfma_f32_32x32x16_bf16 v[68:83], a[124:127], v[44:47], v[68:83]
  ds_read_b128 v[40:43], v205 offset:45056
  v_mfma_f32_32x32x16_bf16 v[84:99], v[44:47], v[236:239], v[84:99]
  s_waitcnt lgkmcnt(2)
  v_mfma_f32_32x32x16_bf16 v[68:83], a[128:131], v[32:35], v[68:83]
  ds_read_b128 v[44:47], v206 offset:45056
  v_mfma_f32_32x32x16_bf16 v[84:99], v[32:35], v[240:243], v[84:99]
  s_waitcnt lgkmcnt(2)
  v_mfma_f32_32x32x16_bf16 v[68:83], a[132:135], v[36:39], v[68:83]
  v_mfma_f32_32x32x16_bf16 v[84:99], v[36:39], v[244:247], v[84:99]
  s_waitcnt lgkmcnt(1)
  v_mfma_f32_32x32x16_bf16 v[68:83], a[136:139], v[40:43], v[68:83]
  v_mfma_f32_32x32x16_bf16 v[84:99], v[40:43], v[248:251], v[84:99]
  s_waitcnt lgkmcnt(0)
  v_mfma_f32_32x32x16_bf16 v[68:83], a[140:143], v[44:47], v[68:83]
  v_mfma_f32_32x32x16_bf16 v[84:99], v[44:47], v[252:255], v[84:99]
  s_mul_i32 s64, s59, 655360
  s_lshl_b32 s55, s58, 14
  s_add_u32 s64, s64, s55
  s_add_u32 s64, s64, 1048576
  s_add_u32 s72, s64, s69
  s_add_u32 s73, s64, s66
  s_add_u32 s59, s59, 7
  s_cmp_ge_u32 s59, 64
  s_cbranch_scc1 KV_done1
  s_waitcnt vmcnt(5)
  s_barrier
  s_add_u32 s60, s60, 258048
  ds_read_b128 v[32:35], v203 offset:0
  ds_read_b128 v[36:39], v204 offset:0
  ds_read_b128 v[40:43], v205 offset:0
  s_waitcnt lgkmcnt(2)
  v_mfma_f32_32x32x16_bf16 v[0:15], a[0:3], v[32:35], 0
  ds_read_b128 v[44:47], v206 offset:0
  s_add_u32 m0, s67, 36864
  s_nop 0
  buffer_load_dwordx4 v202, s[4:7], s60 offen offset:0 lds
  v_mfma_f32_32x32x16_bf16 v[16:31], v[32:35], a[144:147], 0
  s_waitcnt lgkmcnt(2)
  v_mfma_f32_32x32x16_bf16 v[0:15], a[4:7], v[36:39], v[0:15]
  ds_read_b128 v[32:35], v203 offset:1024
  s_add_u32 m0, s67, 37760
  s_nop 0
  buffer_load_dwordx4 v202, s[4:7], s60 offen offset:128 lds
  v_mfma_f32_32x32x16_bf16 v[16:31], v[36:39], a[148:151], v[16:31]
  s_waitcnt lgkmcnt(2)
  v_mfma_f32_32x32x16_bf16 v[0:15], a[8:11], v[40:43], v[0:15]
  ds_read_b128 v[36:39], v204 offset:1024
  s_add_u32 m0, s67, 38656
  s_nop 0
  buffer_load_dwordx4 v202, s[4:7], s60 offen offset:256 lds
  v_mfma_f32_32x32x16_bf16 v[16:31], v[40:43], a[152:155], v[16:31]
  s_waitcnt lgkmcnt(2)
  v_mfma_f32_32x32x16_bf16 v[0:15], a[12:15], v[44:47], v[0:15]
  ds_read_b128 v[40:43], v205 offset:1024
  s_add_u32 m0, s67, 39552
  s_nop 0
  buffer_load_dwordx4 v202, s[4:7], s60 offen offset:384 lds
  v_mfma_f32_32x32x16_bf16 v[16:31], v[44:47], a[156:159], v[16:31]
  s_waitcnt lgkmcnt(2)
  v_mfma_f32_32x32x16_bf16 v[0:15], a[16:19], v[32:35], v[0:15]
  ds_read_b128 v[44:47], v206 offset:1024
  s_add_u32 m0, s67, 40448
  s_nop 0
  buffer_load_dwordx4 v202, s[4:7], s60 offen offset:512 lds
  v_mfma_f32_32x32x16_bf16 v[16:31], v[32:35], a[160:163], v[16:31]
  s_waitcnt lgkmcnt(2)
  v_mfma_f32_32x32x16_bf16 v[0:15], a[20:23], v[36:39], v[0:15]
  ds_read_b128 v[32:35], v203 offset:2048
  s_add_u32 m0, s67, 41344
  s_nop 0
  buffer_load_dwordx4 v202, s[4:7], s60 offen offset:640 lds
  v_mfma_f32_32x32x16_bf16 v[16:31], v[36:39], a[164:167], v[16:31]
  s_waitcnt lgkmcnt(2)
  v_mfma_f32_32x32x16_bf16 v[0:15], a[24:27], v[40:43], v[0:15]
  ds_read_b128 v[36:39], v204 offset:2048
  s_add_u32 m0, s67, 42240
  s_nop 0
  buffer_load_dwordx4 v202, s[4:7], s60 offen offset:768 lds
  v_mfma_f32_32x32x16_bf16 v[16:31], v[40:43], a[168:171], v[16:31]
  s_waitcnt lgkmcnt(2)
  v_mfma_f32_32x32x16_bf16 v[0:15], a[28:31], v[44:47], v[0:15]
  ds_read_b128 v[40:43], v205 offset:2048
  s_add_u32 m0, s67, 43136
  s_nop 0
  buffer_load_dwordx4 v202, s[4:7], s60 offen offset:896 lds
  v_mfma_f32_32x32x16_bf16 v[16:31], v[44:47], a[172:175], v[16:31]
  s_waitcnt lgkmcnt(2)
  v_mfma_f32_32x32x16_bf16 v[0:15], a[32:35], v[32:35], v[0:15]
  ds_read_b128 v[44:47], v206 offset:2048
  s_add_u32 m0, s67, 44032
  s_nop 0
  buffer_load_dwordx4 v202, s[4:7], s60 offen offset:1024 lds
  v_mfma_f32_32x32x16_bf16 v[16:31], v[32:35], a[176:179], v[16:31]
  s_waitcnt lgkmcnt(2)
  v_mfma_f32_32x32x16_bf16 v[0:15], a[36:39], v[36:39], v[0:15]
  ds_read_b128 v[32:35], v203 offset:3072
  v_mul_f32 v68, s68, v68
  v_mul_f32 v69, s68, v69
  v_mul_f32 v70, s68, v70
  v_mul_f32 v71, s68, v71
  v_mfma_f32_32x32x16_bf16 v[16:31], v[36:39], a[180:183], v[16:31]
  v_mul_f32 v72, s68, v72
  v_mul_f32 v73, s68, v73
  v_mul_f32 v74, s68, v74
  v_mul_f32 v75, s68, v75
  s_waitcnt lgkmcnt(2)
  v_mfma_f32_32x32x16_bf16 v[0:15], a[40:43], v[40:43], v[0:15]
  ds_read_b128 v[36:39], v204 offset:3072
  v_cvt_pk_bf16_f32 v48, v68, v72
  v_cvt_pk_bf16_f32 v49, v69, v73
  v_cvt_pk_bf16_f32 v50, v70, v74
  v_cvt_pk_bf16_f32 v51, v71, v75
  v_mfma_f32_32x32x16_bf16 v[16:31], v[40:43], a[184:187], v[16:31]
  buffer_store_dwordx4 v[48:51], v216, s[8:11], s72 offen offset:0 sc1
  s_waitcnt lgkmcnt(2)
  v_mfma_f32_32x32x16_bf16 v[0:15], a[44:47], v[44:47], v[0:15]
  ds_read_b128 v[40:43], v205 offset:3072
  v_mfma_f32_32x32x16_bf16 v[16:31], v[44:47], a[188:191], v[16:31]
  s_waitcnt lgkmcnt(2)
  v_mfma_f32_32x32x16_bf16 v[0:15], a[48:51], v[32:35], v[0:15]
  ds_read_b128 v[44:47], v206 offset:3072
  v_mul_f32 v76, s68, v76
  v_mul_f32 v77, s68, v77
  v_mul_f32 v78, s68, v78
  v_mul_f32 v79, s68, v79
  v_mfma_f32_32x32x16_bf16 v[16:31], v[32:35], a[192:195], v[16:31]
  v_mul_f32 v80, s68, v80
  v_mul_f32 v81, s68, v81
  v_mul_f32 v82, s68, v82
  v_mul_f32 v83, s68, v83
  s_waitcnt lgkmcnt(2)
  v_mfma_f32_32x32x16_bf16 v[0:15], a[52:55], v[36:39], v[0:15]
  ds_read_b128 v[32:35], v203 offset:4096
  v_cvt_pk_bf16_f32 v52, v76, v80
  v_cvt_pk_bf16_f32 v53, v77, v81
  v_cvt_pk_bf16_f32 v54, v78, v82
  v_cvt_pk_bf16_f32 v55, v79, v83
  v_mfma_f32_32x32x16_bf16 v[16:31], v[36:39], a[196:199], v[16:31]
  buffer_store_dwordx4 v[52:55], v216, s[8:11], s72 offen offset:256 sc1
  s_waitcnt lgkmcnt(2)
  v_mfma_f32_32x32x16_bf16 v[0:15], a[56:59], v[40:43], v[0:15]
  ds_read_b128 v[36:39], v204 offset:4096
  v_mfma_f32_32x32x16_bf16 v[16:31], v[40:43], a[200:203], v[16:31]
  s_waitcnt lgkmcnt(2)
  v_mfma_f32_32x32x16_bf16 v[0:15], a[60:63], v[44:47], v[0:15]
  ds_read_b128 v[40:43], v205 offset:4096
  v_cvt_pk_bf16_f32 v56, v84, v85
  v_cvt_pk_bf16_f32 v57, v88, v89
  v_cvt_pk_bf16_f32 v58, v92, v93
  v_cvt_pk_bf16_f32 v59, v96, v97
  v_mfma_f32_32x32x16_bf16 v[16:31], v[44:47], a[204:207], v[16:31]
  buffer_store_dwordx4 v[56:59], v217, s[8:11], s64 offen offset:0 sc1
  s_waitcnt lgkmcnt(2)
  v_mfma_f32_32x32x16_bf16 v[0:15], a[64:67], v[32:35], v[0:15]
  ds_read_b128 v[44:47], v206 offset:4096
  v_mfma_f32_32x32x16_bf16 v[16:31], v[32:35], a[208:211], v[16:31]
  s_waitcnt lgkmcnt(2)
  v_mfma_f32_32x32x16_bf16 v[0:15], a[68:71], v[36:39], v[0:15]
  ds_read_b128 v[32:35], v203 offset:5120
  v_cvt_pk_bf16_f32 v60, v86, v87
  v_cvt_pk_bf16_f32 v61, v90, v91
  v_cvt_pk_bf16_f32 v62, v94, v95
  v_cvt_pk_bf16_f32 v63, v98, v99
  v_mfma_f32_32x32x16_bf16 v[16:31], v[36:39], a[212:215], v[16:31]
  buffer_store_dwordx4 v[60:63], v217, s[8:11], s64 offen offset:256 sc1
  s_waitcnt lgkmcnt(2)
  v_mfma_f32_32x32x16_bf16 v[0:15], a[72:75], v[40:43], v[0:15]
  ds_read_b128 v[36:39], v204 offset:5120
  v_mfma_f32_32x32x16_bf16 v[16:31], v[40:43], a[216:219], v[16:31]
  s_waitcnt lgkmcnt(2)
  v_mfma_f32_32x32x16_bf16 v[0:15], a[76:79], v[44:47], v[0:15]
  ds_read_b128 v[40:43], v205 offset:5120
  buffer_store_dwordx4 v[64:67], v201, s[8:11], s73 offen sc1
  v_mfma_f32_32x32x16_bf16 v[16:31], v[44:47], a[220:223], v[16:31]
  s_waitcnt lgkmcnt(2)
  v_mfma_f32_32x32x16_bf16 v[0:15], a[80:83], v[32:35], v[0:15]
  ds_read_b128 v[44:47], v206 offset:5120
  v_mfma_f32_32x32x16_bf16 v[16:31], v[32:35], a[224:227], v[16:31]
  s_waitcnt lgkmcnt(2)
  v_mfma_f32_32x32x16_bf16 v[0:15], a[84:87], v[36:39], v[0:15]
  ds_read_b128 v[32:35], v203 offset:6144
  v_mfma_f32_32x32x16_bf16 v[16:31], v[36:39], a[228:231], v[16:31]
  s_waitcnt lgkmcnt(2)
  v_mfma_f32_32x32x16_bf16 v[0:15], a[88:91], v[40:43], v[0:15]
  ds_read_b128 v[36:39], v204 offset:6144
  v_mfma_f32_32x32x16_bf16 v[16:31], v[40:43], a[232:235], v[16:31]
  s_waitcnt lgkmcnt(2)
  v_mfma_f32_32x32x16_bf16 v[0:15], a[92:95], v[44:47], v[0:15]
  ds_read_b128 v[40:43], v205 offset:6144
  v_mfma_f32_32x32x16_bf16 v[16:31], v[44:47], a[236:239], v[16:31]
  s_waitcnt lgkmcnt(2)
  v_mfma_f32_32x32x16_bf16 v[0:15], a[96:99], v[32:35], v[0:15]
  ds_read_b128 v[44:47], v206 offset:6144
  v_mfma_f32_32x32x16_bf16 v[16:31], v[32:35], a[240:243], v[16:31]
  s_waitcnt lgkmcnt(2)
  v_mfma_f32_32x32x16_bf16 v[0:15], a[100:103], v[36:39], v[0:15]
  ds_read_b128 v[32:35], v203 offset:7168
  v_mfma_f32_32x32x16_bf16 v[16:31], v[36:39], a[244:247], v[16:31]
  s_waitcnt lgkmcnt(2)
  v_mfma_f32_32x32x16_bf16 v[0:15], a[104:107], v[40:43], v[0:15]
  ds_read_b128 v[36:39], v204 offset:7168
  v_mfma_f32_32x32x16_bf16 v[16:31], v[40:43], a[248:251], v[16:31]
  s_waitcnt lgkmcnt(2)
  v_mfma_f32_32x32x16_bf16 v[0:15], a[108:111], v[44:47], v[0:15]
  ds_read_b128 v[40:43], v205 offset:7168
  v_mfma_f32_32x32x16_bf16 v[16:31], v[44:47], a[252:255], v[16:31]
  s_waitcnt lgkmcnt(2)
  v_mfma_f32_32x32x16_bf16 v[0:15], a[112:115], v[32:35], v[0:15]
  ds_read_b128 v[44:47], v206 offset:7168
  v_mfma_f32_32x32x16_bf16 v[16:31], v[32:35], v[224:227], v[16:31]
  s_waitcnt lgkmcnt(2)
  v_mfma_f32_32x32x16_bf16 v[0:15], a[116:119], v[36:39], v[0:15]
  ds_read_b128 v[32:35], v203 offset:8192
  v_mfma_f32_32x32x16_bf16 v[16:31], v[36:39], v[228:231], v[16:31]
  s_waitcnt lgkmcnt(2)
  v_mfma_f32_32x32x16_bf16 v[0:15], a[120:123], v[40:43], v[0:15]
  ds_read_b128 v[36:39], v204 offset:8192
  v_mfma_f32_32x32x16_bf16 v[16:31], v[40:43], v[232:235], v[16:31]
  s_waitcnt lgkmcnt(2)
  v_mfma_f32_32x32x16_bf16 v[0:15], a[124:127], v[44:47], v[0:15]
  ds_read_b128 v[40:43], v205 offset:8192
  v_mfma_f32_32x32x16_bf16 v[16:31], v[44:47], v[236:239], v[16:31]
  s_waitcnt lgkmcnt(2)
  v_mfma_f32_32x32x16_bf16 v[0:15], a[128:131], v[32:35], v[0:15]
  ds_read_b128 v[44:47], v206 offset:8192
  v_mfma_f32_32x32x16_bf16 v[16:31], v[32:35], v[240:243], v[16:31]
  s_waitcnt lgkmcnt(2)
  v_mfma_f32_32x32x16_bf16 v[0:15], a[132:135], v[36:39], v[0:15]
  v_mfma_f32_32x32x16_bf16 v[16:31], v[36:39], v[244:247], v[16:31]
  s_waitcnt lgkmcnt(1)
  v_mfma_f32_32x32x16_bf16 v[0:15], a[136:139], v[40:43], v[0:15]
  v_mfma_f32_32x32x16_bf16 v[16:31], v[40:43], v[248:251], v[16:31]
  s_waitcnt lgkmcnt(0)
  v_mfma_f32_32x32x16_bf16 v[0:15], a[140:143], v[44:47], v[0:15]
  v_mfma_f32_32x32x16_bf16 v[16:31], v[44:47], v[252:255], v[16:31]
  s_mul_i32 s64, s59, 655360
  s_lshl_b32 s55, s58, 14
  s_add_u32 s64, s64, s55
  s_add_u32 s64, s64, 1048576
  s_add_u32 s72, s64, s69
  s_add_u32 s73, s64, s66
  s_add_u32 s59, s59, 7
  s_cmp_ge_u32 s59, 64
  s_cbranch_scc1 KV_done0
  s_sub_u32 s54, s59, 21
  s_cmp_lt_u32 s54, 7
  s_cbranch_scc1 KV_early
  s_waitcnt vmcnt(5)
  s_barrier
KV_cont:
  s_branch KV_loop
KV_early:
  s_waitcnt vmcnt(0)
  s_barrier
  s_cmp_eq_u32 s52, 0
  s_cbranch_scc0 KV_sig0
  v_mov_b32 v211, 1
  v_mov_b32 v212, 0
  s_mov_b64 exec, 1
  buffer_atomic_add v211, v212, s[12:15], s70 offen
  s_mov_b64 exec, -1
KV_sig0:
  s_branch KV_cont
KV_done1:
  s_nop 11
  v_mul_f32 v68, s68, v68
  v_mul_f32 v69, s68, v69
  v_mul_f32 v70, s68, v70
  v_mul_f32 v71, s68, v71
  v_mul_f32 v72, s68, v72
  v_mul_f32 v73, s68, v73
  v_mul_f32 v74, s68, v74
  v_mul_f32 v75, s68, v75
  v_cvt_pk_bf16_f32 v48, v68, v72
  v_cvt_pk_bf16_f32 v49, v69, v73
  v_cvt_pk_bf16_f32 v50, v70, v74
  v_cvt_pk_bf16_f32 v51, v71, v75
  buffer_store_dwordx4 v[48:51], v216, s[8:11], s72 offen offset:0 sc1
  v_mul_f32 v76, s68, v76
  v_mul_f32 v77, s68, v77
  v_mul_f32 v78, s68, v78
  v_mul_f32 v79, s68, v79
  v_mul_f32 v80, s68, v80
  v_mul_f32 v81, s68, v81
  v_mul_f32 v82, s68, v82
  v_mul_f32 v83, s68, v83
  v_cvt_pk_bf16_f32 v52, v76, v80
  v_cvt_pk_bf16_f32 v53, v77, v81
  v_cvt_pk_bf16_f32 v54, v78, v82
  v_cvt_pk_bf16_f32 v55, v79, v83
  buffer_store_dwordx4 v[52:55], v216, s[8:11], s72 offen offset:256 sc1
  v_cvt_pk_bf16_f32 v56, v84, v85
  v_cvt_pk_bf16_f32 v57, v88, v89
  v_cvt_pk_bf16_f32 v58, v92, v93
  v_cvt_pk_bf16_f32 v59, v96, v97
  buffer_store_dwordx4 v[56:59], v217, s[8:11], s64 offen offset:0 sc1
  v_cvt_pk_bf16_f32 v60, v86, v87
  v_cvt_pk_bf16_f32 v61, v90, v91
  v_cvt_pk_bf16_f32 v62, v94, v95
  v_cvt_pk_bf16_f32 v63, v98, v99
  buffer_store_dwordx4 v[60:63], v217, s[8:11], s64 offen offset:256 sc1
  buffer_store_dwordx4 v[64:67], v201, s[8:11], s73 offen sc1
  s_branch KV_fin
KV_done0:
  s_nop 11
  v_mul_f32 v0, s68, v0
  v_mul_f32 v1, s68, v1
  v_mul_f32 v2, s68, v2
  v_mul_f32 v3, s68, v3
  v_mul_f32 v4, s68, v4
  v_mul_f32 v5, s68, v5
  v_mul_f32 v6, s68, v6
  v_mul_f32 v7, s68, v7
  v_cvt_pk_bf16_f32 v48, v0, v4
  v_cvt_pk_bf16_f32 v49, v1, v5
  v_cvt_pk_bf16_f32 v50, v2, v6
  v_cvt_pk_bf16_f32 v51, v3, v7
  buffer_store_dwordx4 v[48:51], v216, s[8:11], s72 offen offset:0 sc1
  v_mul_f32 v8, s68, v8
  v_mul_f32 v9, s68, v9
  v_mul_f32 v10, s68, v10
  v_mul_f32 v11, s68, v11
  v_mul_f32 v12, s68, v12
  v_mul_f32 v13, s68, v13
  v_mul_f32 v14, s68, v14
  v_mul_f32 v15, s68, v15
  v_cvt_pk_bf16_f32 v52, v8, v12
  v_cvt_pk_bf16_f32 v53, v9, v13
  v_cvt_pk_bf16_f32 v54, v10, v14
  v_cvt_pk_bf16_f32 v55, v11, v15
  buffer_store_dwordx4 v[52:55], v216, s[8:11], s72 offen offset:256 sc1
  v_cvt_pk_bf16_f32 v56, v16, v17
  v_cvt_pk_bf16_f32 v57, v20, v21
  v_cvt_pk_bf16_f32 v58, v24, v25
  v_cvt_pk_bf16_f32 v59, v28, v29
  buffer_store_dwordx4 v[56:59], v217, s[8:11], s64 offen offset:0 sc1
  v_cvt_pk_bf16_f32 v60, v18, v19
  v_cvt_pk_bf16_f32 v61, v22, v23
  v_cvt_pk_bf16_f32 v62, v26, v27
  v_cvt_pk_bf16_f32 v63, v30, v31
  buffer_store_dwordx4 v[60:63], v217, s[8:11], s64 offen offset:256 sc1
  buffer_store_dwordx4 v[64:67], v201, s[8:11], s73 offen sc1
KV_fin:
  s_waitcnt vmcnt(0)
  s_barrier
  s_cmp_eq_u32 s52, 0
  s_cbranch_scc0 KV_sig
  v_mov_b32 v211, 256
  v_mov_b32 v212, 0
  s_mov_b64 exec, 1
  buffer_atomic_add v211, v212, s[12:15], s70 offen
  s_mov_b64 exec, -1
KV_sig:
  s_cmp_ge_u32 s53, 192
  s_cbranch_scc1 L_exit
  s_cmp_lt_u32 s53, 64
  s_cbranch_scc1 W_h
  s_sub_u32 s54, s53, 64
  s_lshr_b32 s68, s54, 4
  s_and_b32 s69, s54, 15
  s_lshl_b32 s60, s69, 2
  s_sub_u32 s60, s60, 1
  s_max_i32 s60, s60, 0
  s_mul_i32 s60, s60, 36864
  s_add_u32 m0, s67, 0
  s_nop 0
  buffer_load_dwordx4 v202, s[4:7], s60 offen offset:0 lds
  s_add_u32 m0, s67, 896
  s_nop 0
  buffer_load_dwordx4 v202, s[4:7], s60 offen offset:128 lds
  s_add_u32 m0, s67, 1792
  s_nop 0
  buffer_load_dwordx4 v202, s[4:7], s60 offen offset:256 lds
  s_add_u32 m0, s67, 2688
  s_nop 0
  buffer_load_dwordx4 v202, s[4:7], s60 offen offset:384 lds
  s_add_u32 m0, s67, 3584
  s_nop 0
  buffer_load_dwordx4 v202, s[4:7], s60 offen offset:512 lds
  s_add_u32 m0, s67, 4480
  s_nop 0
  buffer_load_dwordx4 v202, s[4:7], s60 offen offset:640 lds
  s_add_u32 m0, s67, 5376
  s_nop 0
  buffer_load_dwordx4 v202, s[4:7], s60 offen offset:768 lds
  s_add_u32 m0, s67, 6272
  s_nop 0
  buffer_load_dwordx4 v202, s[4:7], s60 offen offset:896 lds
  s_add_u32 m0, s67, 7168
  s_nop 0
  buffer_load_dwordx4 v202, s[4:7], s60 offen offset:1024 lds
  v_and_b32 v211, 15, v200
  v_mul_u32_u24 v211, 72, v211
  v_lshrrev_b32 v212, 4, v200
  v_mul_u32_u24 v213, 1152, v212
  v_add_u32 v213, v213, v211
  s_lshl_b32 s54, s54, 2
  s_add_u32 s70, s54, s52
  s_mul_i32 s55, s70, 4608
  buffer_load_dwordx4 v[48:51], v213, s[4:7], s55 offen offset:0
  buffer_load_dwordx4 v[52:55], v213, s[4:7], s55 offen offset:16
  buffer_load_dwordx4 v[56:59], v213, s[4:7], s55 offen offset:32
  buffer_load_dwordx4 v[60:63], v213, s[4:7], s55 offen offset:48
  buffer_load_dwordx2 v[64:65], v213, s[4:7], s55 offen offset:64
  buffer_load_dwordx4 v[68:71], v211, s[44:47], 0 offen offset:0
  buffer_load_dwordx4 v[72:75], v211, s[44:47], 0 offen offset:16
  buffer_load_dwordx4 v[76:79], v211, s[44:47], 0 offen offset:32
  buffer_load_dwordx4 v[80:83], v211, s[44:47], 0 offen offset:48
  buffer_load_dwordx2 v[84:85], v211, s[44:47], 0 offen offset:64
  v_mov_b32 v0, 0
  v_mov_b32 v1, 0x3f803f80
  s_waitcnt vmcnt(9)
  v_lshlrev_b32 v2, 16, v48
  s_waitcnt vmcnt(4)
  v_lshlrev_b32 v3, 16, v68
  v_and_b32 v4, 0xffff0000, v48
  v_and_b32 v5, 0xffff0000, v68
  v_mul_f32 v2, v2, v3
  v_mul_f32 v4, v4, v5
  v_cvt_pk_bf16_f32 v2, v2, v4
  v_lshlrev_b32 v3, 16, v2
  v_and_b32 v4, 0xffff0000, v2
  v_add_f32 v0, v0, v3
  v_add_f32 v0, v0, v4
  v_lshlrev_b32 v2, 16, v49
  v_lshlrev_b32 v3, 16, v69
  v_and_b32 v4, 0xffff0000, v49
  v_and_b32 v5, 0xffff0000, v69
  v_mul_f32 v2, v2, v3
  v_mul_f32 v4, v4, v5
  v_cvt_pk_bf16_f32 v2, v2, v4
  v_lshlrev_b32 v3, 16, v2
  v_and_b32 v4, 0xffff0000, v2
  v_add_f32 v0, v0, v3
  v_add_f32 v0, v0, v4
  v_lshlrev_b32 v2, 16, v50
  v_lshlrev_b32 v3, 16, v70
  v_and_b32 v4, 0xffff0000, v50
  v_and_b32 v5, 0xffff0000, v70
  v_mul_f32 v2, v2, v3
  v_mul_f32 v4, v4, v5
  v_cvt_pk_bf16_f32 v2, v2, v4
  v_lshlrev_b32 v3, 16, v2
  v_and_b32 v4, 0xffff0000, v2
  v_add_f32 v0, v0, v3
  v_add_f32 v0, v0, v4
  v_lshlrev_b32 v2, 16, v51
  v_lshlrev_b32 v3, 16, v71
  v_and_b32 v4, 0xffff0000, v51
  v_and_b32 v5, 0xffff0000, v71
  v_mul_f32 v2, v2, v3
  v_mul_f32 v4, v4, v5
  v_cvt_pk_bf16_f32 v2, v2, v4
  v_lshlrev_b32 v3, 16, v2
  v_and_b32 v4, 0xffff0000, v2
  v_add_f32 v0, v0, v3
  v_add_f32 v0, v0, v4
  v_lshlrev_b32 v2, 16, v52
  s_waitcnt vmcnt(3)
  v_lshlrev_b32 v3, 16, v72
  v_and_b32 v4, 0xffff0000, v52
  v_and_b32 v5, 0xffff0000, v72
  v_mul_f32 v2, v2, v3
  v_mul_f32 v4, v4, v5
  v_cvt_pk_bf16_f32 v2, v2, v4
  v_lshlrev_b32 v3, 16, v2
  v_and_b32 v4, 0xffff0000, v2
  v_add_f32 v0, v0, v3
  v_add_f32 v0, v0, v4
  v_lshlrev_b32 v2, 16, v53
  v_lshlrev_b32 v3, 16, v73
  v_and_b32 v4, 0xffff0000, v53
  v_and_b32 v5, 0xffff0000, v73
  v_mul_f32 v2, v2, v3
  v_mul_f32 v4, v4, v5
  v_cvt_pk_bf16_f32 v2, v2, v4
  v_lshlrev_b32 v3, 16, v2
  v_and_b32 v4, 0xffff0000, v2
  v_add_f32 v0, v0, v3
  v_add_f32 v0, v0, v4
  v_lshlrev_b32 v2, 16, v54
  v_lshlrev_b32 v3, 16, v74
  v_and_b32 v4, 0xffff0000, v54
  v_and_b32 v5, 0xffff0000, v74
  v_mul_f32 v2, v2, v3
  v_mul_f32 v4, v4, v5
  v_cvt_pk_bf16_f32 v2, v2, v4
  v_lshlrev_b32 v3, 16, v2
  v_and_b32 v4, 0xffff0000, v2
  v_add_f32 v0, v0, v3
  v_add_f32 v0, v0, v4
  v_lshlrev_b32 v2, 16, v55
  v_lshlrev_b32 v3, 16, v75
  v_and_b32 v4, 0xffff0000, v55
  v_and_b32 v5, 0xffff0000, v75
  v_mul_f32 v2, v2, v3
  v_mul_f32 v4, v4, v5
  v_cvt_pk_bf16_f32 v2, v2, v4
  v_lshlrev_b32 v3, 16, v2
  v_and_b32 v4, 0xffff0000, v2
  v_add_f32 v0, v0, v3
  v_add_f32 v0, v0, v4
  v_lshlrev_b32 v2, 16, v56
  s_waitcnt vmcnt(2)
  v_lshlrev_b32 v3, 16, v76
  v_and_b32 v4, 0xffff0000, v56
  v_and_b32 v5, 0xffff0000, v76
  v_mul_f32 v2, v2, v3
  v_mul_f32 v4, v4, v5
  v_cvt_pk_bf16_f32 v2, v2, v4
  v_lshlrev_b32 v3, 16, v2
  v_and_b32 v4, 0xffff0000, v2
  v_add_f32 v0, v0, v3
  v_add_f32 v0, v0, v4
  v_lshlrev_b32 v2, 16, v57
  v_lshlrev_b32 v3, 16, v77
  v_and_b32 v4, 0xffff0000, v57
  v_and_b32 v5, 0xffff0000, v77
  v_mul_f32 v2, v2, v3
  v_mul_f32 v4, v4, v5
  v_cvt_pk_bf16_f32 v2, v2, v4
  v_lshlrev_b32 v3, 16, v2
  v_and_b32 v4, 0xffff0000, v2
  v_add_f32 v0, v0, v3
  v_add_f32 v0, v0, v4
  v_lshlrev_b32 v2, 16, v58
  v_lshlrev_b32 v3, 16, v78
  v_and_b32 v4, 0xffff0000, v58
  v_and_b32 v5, 0xffff0000, v78
  v_mul_f32 v2, v2, v3
  v_mul_f32 v4, v4, v5
  v_cvt_pk_bf16_f32 v2, v2, v4
  v_lshlrev_b32 v3, 16, v2
  v_and_b32 v4, 0xffff0000, v2
  v_add_f32 v0, v0, v3
  v_add_f32 v0, v0, v4
  v_lshlrev_b32 v2, 16, v59
  v_lshlrev_b32 v3, 16, v79
  v_and_b32 v4, 0xffff0000, v59
  v_and_b32 v5, 0xffff0000, v79
  v_mul_f32 v2, v2, v3
  v_mul_f32 v4, v4, v5
  v_cvt_pk_bf16_f32 v2, v2, v4
  v_lshlrev_b32 v3, 16, v2
  v_and_b32 v4, 0xffff0000, v2
  v_add_f32 v0, v0, v3
  v_add_f32 v0, v0, v4
  v_lshlrev_b32 v2, 16, v60
  s_waitcnt vmcnt(1)
  v_lshlrev_b32 v3, 16, v80
  v_and_b32 v4, 0xffff0000, v60
  v_and_b32 v5, 0xffff0000, v80
  v_mul_f32 v2, v2, v3
  v_mul_f32 v4, v4, v5
  v_cvt_pk_bf16_f32 v2, v2, v4
  v_lshlrev_b32 v3, 16, v2
  v_and_b32 v4, 0xffff0000, v2
  v_add_f32 v0, v0, v3
  v_add_f32 v0, v0, v4
  v_lshlrev_b32 v2, 16, v61
  v_lshlrev_b32 v3, 16, v81
  v_and_b32 v4, 0xffff0000, v61
  v_and_b32 v5, 0xffff0000, v81
  v_mul_f32 v2, v2, v3
  v_mul_f32 v4, v4, v5
  v_cvt_pk_bf16_f32 v2, v2, v4
  v_lshlrev_b32 v3, 16, v2
  v_and_b32 v4, 0xffff0000, v2
  v_add_f32 v0, v0, v3
  v_add_f32 v0, v0, v4
  v_lshlrev_b32 v2, 16, v62
  v_lshlrev_b32 v3, 16, v82
  v_and_b32 v4, 0xffff0000, v62
  v_and_b32 v5, 0xffff0000, v82
  v_mul_f32 v2, v2, v3
  v_mul_f32 v4, v4, v5
  v_cvt_pk_bf16_f32 v2, v2, v4
  v_lshlrev_b32 v3, 16, v2
  v_and_b32 v4, 0xffff0000, v2
  v_add_f32 v0, v0, v3
  v_add_f32 v0, v0, v4
  v_lshlrev_b32 v2, 16, v63
  v_lshlrev_b32 v3, 16, v83
  v_and_b32 v4, 0xffff0000, v63
  v_and_b32 v5, 0xffff0000, v83
  v_mul_f32 v2, v2, v3
  v_mul_f32 v4, v4, v5
  v_cvt_pk_bf16_f32 v2, v2, v4
  v_lshlrev_b32 v3, 16, v2
  v_and_b32 v4, 0xffff0000, v2
  v_add_f32 v0, v0, v3
  v_add_f32 v0, v0, v4
  v_lshlrev_b32 v2, 16, v64
  s_waitcnt vmcnt(0)
  v_lshlrev_b32 v3, 16, v84
  v_and_b32 v4, 0xffff0000, v64
  v_and_b32 v5, 0xffff0000, v84
  v_mul_f32 v2, v2, v3
  v_mul_f32 v4, v4, v5
  v_cvt_pk_bf16_f32 v2, v2, v4
  v_lshlrev_b32 v3, 16, v2
  v_and_b32 v4, 0xffff0000, v2
  v_add_f32 v0, v0, v3
  v_add_f32 v0, v0, v4
  v_lshlrev_b32 v2, 16, v65
  v_lshlrev_b32 v3, 16, v85
  v_and_b32 v4, 0xffff0000, v65
  v_and_b32 v5, 0xffff0000, v85
  v_mul_f32 v2, v2, v3
  v_mul_f32 v4, v4, v5
  v_cvt_pk_bf16_f32 v2, v2, v4
  v_lshlrev_b32 v3, 16, v2
  v_and_b32 v4, 0xffff0000, v2
  v_add_f32 v0, v0, v3
  v_add_f32 v0, v0, v4
  s_nop 1
  v_add_f32_dpp v0, v0, v0 row_ror:1 row_mask:0xf bank_mask:0xf
  s_nop 1
  v_add_f32_dpp v0, v0, v0 row_ror:2 row_mask:0xf bank_mask:0xf
  s_nop 1
  v_add_f32_dpp v0, v0, v0 row_ror:4 row_mask:0xf bank_mask:0xf
  s_nop 1
  v_add_f32_dpp v0, v0, v0 row_ror:8 row_mask:0xf bank_mask:0xf
  v_cvt_pk_bf16_f32 v0, v0, v0
  v_lshlrev_b32 v0, 16, v0
  v_mul_f32 v0, 3216550459, v0
  v_exp_f32 v0, v0
  s_nop 0
  v_add_f32 v0, 1.0, v0
  v_rcp_f32 v0, v0
  s_nop 0
  v_cvt_pk_bf16_f32 v0, v0, v0
  v_lshlrev_b32 v0, 16, v0
  v_lshlrev_b32 v212, 2, v212
  s_lshl_b32 s55, s70, 4
  s_add_u32 s55, s55, 66060288
  s_mov_b32 exec_lo, 0x00010001
  s_mov_b32 exec_hi, 0x00010001
  buffer_store_dword v0, v212, s[8:11], s55 offen sc1
  s_mov_b64 exec, -1
  v_lshrrev_b32 v211, 4, v200
  v_lshlrev_b32 v212, 2, v211
  v_and_b32 v213, 15, v200
  v_xor_b32 v212, v212, v213
  v_mul_u32_u24 v211, 3456, v211
  v_mov_b32 v2, 0x40000000
  v_add_u32 v213, 0, v212
  v_mul_u32_u24 v214, 57, v213
  v_lshrrev_b32 v214, 9, v214
  v_mul_u32_u24 v214, 1008, v214
  v_lshl_add_u32 v214, v213, 4, v214
  v_add_u32 v214, v214, v211
  v_cmp_lt_u32 vcc, 26, v213
  s_nop 1
  v_cndmask_b32 v207, v214, v2, vcc
  v_add_u32 v213, 16, v212
  v_mul_u32_u24 v214, 57, v213
  v_lshrrev_b32 v214, 9, v214
  v_mul_u32_u24 v214, 1008, v214
  v_lshl_add_u32 v214, v213, 4, v214
  v_add_u32 v214, v214, v211
  v_cmp_lt_u32 vcc, 26, v213
  s_nop 1
  v_cndmask_b32 v208, v214, v2, vcc
  s_mul_i32 s62, s68, 144
  s_mul_i32 s54, s52, 13824
  s_add_u32 s62, s62, s54
  s_waitcnt vmcnt(0)
  s_lshl_b32 s61, s52, 10
  s_add_u32 s61, s61, 36864
  s_add_u32 m0, s61, 0
  s_add_u32 s54, s62, 0
  buffer_load_dwordx4 v207, s[36:39], s54 offen lds
  s_add_u32 m0, s61, 4096
  s_add_u32 s54, s62, 55296
  buffer_load_dwordx4 v207, s[36:39], s54 offen lds
  s_add_u32 m0, s61, 8192
  s_add_u32 s54, s62, 110592
  buffer_load_dwordx4 v207, s[36:39], s54 offen lds
  s_add_u32 m0, s61, 12288
  s_add_u32 s54, s62, 165888
  buffer_load_dwordx4 v207, s[36:39], s54 offen lds
  s_add_u32 m0, s61, 16384
  s_add_u32 s54, s62, 0
  buffer_load_dwordx4 v208, s[36:39], s54 offen lds
  s_add_u32 m0, s61, 20480
  s_add_u32 s54, s62, 55296
  buffer_load_dwordx4 v208, s[36:39], s54 offen lds
  s_add_u32 m0, s61, 24576
  s_add_u32 s54, s62, 110592
  buffer_load_dwordx4 v208, s[36:39], s54 offen lds
  s_add_u32 m0, s61, 28672
  s_add_u32 s54, s62, 165888
  buffer_load_dwordx4 v208, s[36:39], s54 offen lds
  s_add_u32 m0, s61, 32768
  s_add_u32 s54, s62, 221184
  buffer_load_dwordx4 v207, s[36:39], s54 offen lds
  s_add_u32 m0, s61, 36864
  s_add_u32 s54, s62, 276480
  buffer_load_dwordx4 v207, s[36:39], s54 offen lds
  s_add_u32 m0, s61, 40960
  s_add_u32 s54, s62, 331776
  buffer_load_dwordx4 v207, s[36:39], s54 offen lds
  s_add_u32 m0, s61, 45056
  s_add_u32 s54, s62, 387072
  buffer_load_dwordx4 v207, s[36:39], s54 offen lds
  s_add_u32 m0, s61, 49152
  s_add_u32 s54, s62, 221184
  buffer_load_dwordx4 v208, s[36:39], s54 offen lds
  s_add_u32 m0, s61, 53248
  s_add_u32 s54, s62, 276480
  buffer_load_dwordx4 v208, s[36:39], s54 offen lds
  s_add_u32 m0, s61, 57344
  s_add_u32 s54, s62, 331776
  buffer_load_dwordx4 v208, s[36:39], s54 offen lds
  s_add_u32 m0, s61, 61440
  s_add_u32 s54, s62, 387072
  buffer_load_dwordx4 v208, s[36:39], s54 offen lds
  s_add_u32 m0, s61, 65536
  s_add_u32 s54, s62, 442368
  buffer_load_dwordx4 v207, s[36:39], s54 offen lds
  s_add_u32 m0, s61, 69632
  s_add_u32 s54, s62, 497664
  buffer_load_dwordx4 v207, s[36:39], s54 offen lds
  s_add_u32 m0, s61, 73728
  s_add_u32 s54, s62, 552960
  buffer_load_dwordx4 v207, s[36:39], s54 offen lds
  s_add_u32 m0, s61, 77824
  s_add_u32 s54, s62, 608256
  buffer_load_dwordx4 v207, s[36:39], s54 offen lds
  s_add_u32 m0, s61, 81920
  s_add_u32 s54, s62, 442368
  buffer_load_dwordx4 v208, s[36:39], s54 offen lds
  s_add_u32 m0, s61, 86016
  s_add_u32 s54, s62, 497664
  buffer_load_dwordx4 v208, s[36:39], s54 offen lds
  s_add_u32 m0, s61, 90112
  s_add_u32 s54, s62, 552960
  buffer_load_dwordx4 v208, s[36:39], s54 offen lds
  s_add_u32 m0, s61, 94208
  s_add_u32 s54, s62, 608256
  buffer_load_dwordx4 v208, s[36:39], s54 offen lds
  s_waitcnt vmcnt(20) lgkmcnt(0)
  s_barrier
  s_add_u32 m0, s61, 98304
  s_add_u32 s54, s62, 663552
  buffer_load_dwordx4 v207, s[36:39], s54 offen lds
  s_add_u32 m0, s61, 102400
  s_add_u32 s54, s62, 718848
  buffer_load_dwordx4 v207, s[36:39], s54 offen lds
  s_add_u32 m0, s61, 106496
  s_add_u32 s54, s62, 774144
  buffer_load_dwordx4 v207, s[36:39], s54 offen lds
  s_add_u32 m0, s61, 110592
  s_add_u32 s54, s62, 829440
  buffer_load_dwordx4 v207, s[36:39], s54 offen lds
  v_add_u32 v215, 36864, v210
  ds_read_b64_tr_b16 a[0:1], v215 offset:0
  ds_read_b64_tr_b16 a[2:3], v215 offset:1024
  ds_read_b64_tr_b16 a[4:5], v215 offset:4096
  ds_read_b64_tr_b16 a[6:7], v215 offset:5120
  ds_read_b64_tr_b16 a[8:9], v215 offset:8192
  ds_read_b64_tr_b16 a[10:11], v215 offset:9216
  ds_read_b64_tr_b16 a[12:13], v215 offset:12288
  ds_read_b64_tr_b16 a[14:15], v215 offset:13312
  s_waitcnt vmcnt(20) lgkmcnt(0)
  s_barrier
  s_add_u32 m0, s61, 0
  s_add_u32 s54, s62, 663552
  buffer_load_dwordx4 v208, s[36:39], s54 offen lds
  s_add_u32 m0, s61, 4096
  s_add_u32 s54, s62, 718848
  buffer_load_dwordx4 v208, s[36:39], s54 offen lds
  s_add_u32 m0, s61, 8192
  s_add_u32 s54, s62, 774144
  buffer_load_dwordx4 v208, s[36:39], s54 offen lds
  s_add_u32 m0, s61, 12288
  s_add_u32 s54, s62, 829440
  buffer_load_dwordx4 v208, s[36:39], s54 offen lds
  v_add_u32 v215, 53248, v210
  ds_read_b64_tr_b16 a[144:145], v215 offset:0
  ds_read_b64_tr_b16 a[146:147], v215 offset:1024
  ds_read_b64_tr_b16 a[148:149], v215 offset:4096
  ds_read_b64_tr_b16 a[150:151], v215 offset:5120
  ds_read_b64_tr_b16 a[152:153], v215 offset:8192
  ds_read_b64_tr_b16 a[154:155], v215 offset:9216
  ds_read_b64_tr_b16 a[156:157], v215 offset:12288
  ds_read_b64_tr_b16 a[158:159], v215 offset:13312
  s_waitcnt vmcnt(20) lgkmcnt(0)
  s_barrier
  s_add_u32 m0, s61, 16384
  s_add_u32 s54, s62, 884736
  buffer_load_dwordx4 v207, s[36:39], s54 offen lds
  s_add_u32 m0, s61, 20480
  s_add_u32 s54, s62, 940032
  buffer_load_dwordx4 v207, s[36:39], s54 offen lds
  s_add_u32 m0, s61, 24576
  s_add_u32 s54, s62, 995328
  buffer_load_dwordx4 v207, s[36:39], s54 offen lds
  s_add_u32 m0, s61, 28672
  s_add_u32 s54, s62, 1050624
  buffer_load_dwordx4 v207, s[36:39], s54 offen lds
  v_add_u32 v215, 69632, v210
  ds_read_b64_tr_b16 a[16:17], v215 offset:0
  ds_read_b64_tr_b16 a[18:19], v215 offset:1024
  ds_read_b64_tr_b16 a[20:21], v215 offset:4096
  ds_read_b64_tr_b16 a[22:23], v215 offset:5120
  ds_read_b64_tr_b16 a[24:25], v215 offset:8192
  ds_read_b64_tr_b16 a[26:27], v215 offset:9216
  ds_read_b64_tr_b16 a[28:29], v215 offset:12288
  ds_read_b64_tr_b16 a[30:31], v215 offset:13312
  s_waitcnt vmcnt(20) lgkmcnt(0)
  s_barrier
  s_add_u32 m0, s61, 32768
  s_add_u32 s54, s62, 884736
  buffer_load_dwordx4 v208, s[36:39], s54 offen lds
  s_add_u32 m0, s61, 36864
  s_add_u32 s54, s62, 940032
  buffer_load_dwordx4 v208, s[36:39], s54 offen lds
  s_add_u32 m0, s61, 40960
  s_add_u32 s54, s62, 995328
  buffer_load_dwordx4 v208, s[36:39], s54 offen lds
  s_add_u32 m0, s61, 45056
  s_add_u32 s54, s62, 1050624
  buffer_load_dwordx4 v208, s[36:39], s54 offen lds
  v_add_u32 v215, 86016, v210
  ds_read_b64_tr_b16 a[160:161], v215 offset:0
  ds_read_b64_tr_b16 a[162:163], v215 offset:1024
  ds_read_b64_tr_b16 a[164:165], v215 offset:4096
  ds_read_b64_tr_b16 a[166:167], v215 offset:5120
  ds_read_b64_tr_b16 a[168:169], v215 offset:8192
  ds_read_b64_tr_b16 a[170:171], v215 offset:9216
  ds_read_b64_tr_b16 a[172:173], v215 offset:12288
  ds_read_b64_tr_b16 a[174:175], v215 offset:13312
  s_waitcnt vmcnt(20) lgkmcnt(0)
  s_barrier
  s_add_u32 m0, s61, 49152
  s_add_u32 s54, s62, 1105920
  buffer_load_dwordx4 v207, s[36:39], s54 offen lds
  s_add_u32 m0, s61, 53248
  s_add_u32 s54, s62, 1161216
  buffer_load_dwordx4 v207, s[36:39], s54 offen lds
  s_add_u32 m0, s61, 57344
  s_add_u32 s54, s62, 1216512
  buffer_load_dwordx4 v207, s[36:39], s54 offen lds
  s_add_u32 m0, s61, 61440
  s_add_u32 s54, s62, 1271808
  buffer_load_dwordx4 v207, s[36:39], s54 offen lds
  v_add_u32 v215, 102400, v210
  ds_read_b64_tr_b16 a[32:33], v215 offset:0
  ds_read_b64_tr_b16 a[34:35], v215 offset:1024
  ds_read_b64_tr_b16 a[36:37], v215 offset:4096
  ds_read_b64_tr_b16 a[38:39], v215 offset:5120
  ds_read_b64_tr_b16 a[40:41], v215 offset:8192
  ds_read_b64_tr_b16 a[42:43], v215 offset:9216
  ds_read_b64_tr_b16 a[44:45], v215 offset:12288
  ds_read_b64_tr_b16 a[46:47], v215 offset:13312
  s_waitcnt vmcnt(20) lgkmcnt(0)
  s_barrier
  s_add_u32 m0, s61, 65536
  s_add_u32 s54, s62, 1105920
  buffer_load_dwordx4 v208, s[36:39], s54 offen lds
  s_add_u32 m0, s61, 69632
  s_add_u32 s54, s62, 1161216
  buffer_load_dwordx4 v208, s[36:39], s54 offen lds
  s_add_u32 m0, s61, 73728
  s_add_u32 s54, s62, 1216512
  buffer_load_dwordx4 v208, s[36:39], s54 offen lds
  s_add_u32 m0, s61, 77824
  s_add_u32 s54, s62, 1271808
  buffer_load_dwordx4 v208, s[36:39], s54 offen lds
  v_add_u32 v215, 118784, v210
  ds_read_b64_tr_b16 a[176:177], v215 offset:0
  ds_read_b64_tr_b16 a[178:179], v215 offset:1024
  ds_read_b64_tr_b16 a[180:181], v215 offset:4096
  ds_read_b64_tr_b16 a[182:183], v215 offset:5120
  ds_read_b64_tr_b16 a[184:185], v215 offset:8192
  ds_read_b64_tr_b16 a[186:187], v215 offset:9216
  ds_read_b64_tr_b16 a[188:189], v215 offset:12288
  ds_read_b64_tr_b16 a[190:191], v215 offset:13312
  s_waitcnt vmcnt(20) lgkmcnt(0)
  s_barrier
  s_add_u32 m0, s61, 81920
  s_add_u32 s54, s62, 1327104
  buffer_load_dwordx4 v207, s[36:39], s54 offen lds
  s_add_u32 m0, s61, 86016
  s_add_u32 s54, s62, 1382400
  buffer_load_dwordx4 v207, s[36:39], s54 offen lds
  s_add_u32 m0, s61, 90112
  s_add_u32 s54, s62, 1437696
  buffer_load_dwordx4 v207, s[36:39], s54 offen lds
  s_add_u32 m0, s61, 94208
  s_add_u32 s54, s62, 1492992
  buffer_load_dwordx4 v207, s[36:39], s54 offen lds
  v_add_u32 v215, 135168, v210
  ds_read_b64_tr_b16 a[48:49], v215 offset:0
  ds_read_b64_tr_b16 a[50:51], v215 offset:1024
  ds_read_b64_tr_b16 a[52:53], v215 offset:4096
  ds_read_b64_tr_b16 a[54:55], v215 offset:5120
  ds_read_b64_tr_b16 a[56:57], v215 offset:8192
  ds_read_b64_tr_b16 a[58:59], v215 offset:9216
  ds_read_b64_tr_b16 a[60:61], v215 offset:12288
  ds_read_b64_tr_b16 a[62:63], v215 offset:13312
  s_waitcnt vmcnt(20) lgkmcnt(0)
  s_barrier
  s_add_u32 m0, s61, 98304
  s_add_u32 s54, s62, 1327104
  buffer_load_dwordx4 v208, s[36:39], s54 offen lds
  s_add_u32 m0, s61, 102400
  s_add_u32 s54, s62, 1382400
  buffer_load_dwordx4 v208, s[36:39], s54 offen lds
  s_add_u32 m0, s61, 106496
  s_add_u32 s54, s62, 1437696
  buffer_load_dwordx4 v208, s[36:39], s54 offen lds
  s_add_u32 m0, s61, 110592
  s_add_u32 s54, s62, 1492992
  buffer_load_dwordx4 v208, s[36:39], s54 offen lds
  v_add_u32 v215, 36864, v210
  ds_read_b64_tr_b16 a[192:193], v215 offset:0
  ds_read_b64_tr_b16 a[194:195], v215 offset:1024
  ds_read_b64_tr_b16 a[196:197], v215 offset:4096
  ds_read_b64_tr_b16 a[198:199], v215 offset:5120
  ds_read_b64_tr_b16 a[200:201], v215 offset:8192
  ds_read_b64_tr_b16 a[202:203], v215 offset:9216
  ds_read_b64_tr_b16 a[204:205], v215 offset:12288
  ds_read_b64_tr_b16 a[206:207], v215 offset:13312
  s_waitcnt vmcnt(20) lgkmcnt(0)
  s_barrier
  s_add_u32 m0, s61, 0
  s_add_u32 s54, s62, 1548288
  buffer_load_dwordx4 v207, s[36:39], s54 offen lds
  s_add_u32 m0, s61, 4096
  s_add_u32 s54, s62, 1603584
  buffer_load_dwordx4 v207, s[36:39], s54 offen lds
  s_add_u32 m0, s61, 8192
  s_add_u32 s54, s62, 1658880
  buffer_load_dwordx4 v207, s[36:39], s54 offen lds
  s_add_u32 m0, s61, 12288
  s_add_u32 s54, s62, 1714176
  buffer_load_dwordx4 v207, s[36:39], s54 offen lds
  v_add_u32 v215, 53248, v210
  ds_read_b64_tr_b16 a[64:65], v215 offset:0
  ds_read_b64_tr_b16 a[66:67], v215 offset:1024
  ds_read_b64_tr_b16 a[68:69], v215 offset:4096
  ds_read_b64_tr_b16 a[70:71], v215 offset:5120
  ds_read_b64_tr_b16 a[72:73], v215 offset:8192
  ds_read_b64_tr_b16 a[74:75], v215 offset:9216
  ds_read_b64_tr_b16 a[76:77], v215 offset:12288
  ds_read_b64_tr_b16 a[78:79], v215 offset:13312
  s_waitcnt vmcnt(20) lgkmcnt(0)
  s_barrier
  s_add_u32 m0, s61, 16384
  s_add_u32 s54, s62, 1548288
  buffer_load_dwordx4 v208, s[36:39], s54 offen lds
  s_add_u32 m0, s61, 20480
  s_add_u32 s54, s62, 1603584
  buffer_load_dwordx4 v208, s[36:39], s54 offen lds
  s_add_u32 m0, s61, 24576
  s_add_u32 s54, s62, 1658880
  buffer_load_dwordx4 v208, s[36:39], s54 offen lds
  s_add_u32 m0, s61, 28672
  s_add_u32 s54, s62, 1714176
  buffer_load_dwordx4 v208, s[36:39], s54 offen lds
  v_add_u32 v215, 69632, v210
  ds_read_b64_tr_b16 a[208:209], v215 offset:0
  ds_read_b64_tr_b16 a[210:211], v215 offset:1024
  ds_read_b64_tr_b16 a[212:213], v215 offset:4096
  ds_read_b64_tr_b16 a[214:215], v215 offset:5120
  ds_read_b64_tr_b16 a[216:217], v215 offset:8192
  ds_read_b64_tr_b16 a[218:219], v215 offset:9216
  ds_read_b64_tr_b16 a[220:221], v215 offset:12288
  ds_read_b64_tr_b16 a[222:223], v215 offset:13312
  s_waitcnt vmcnt(20) lgkmcnt(0)
  s_barrier
  s_add_u32 m0, s61, 32768
  s_add_u32 s54, s62, 1769472
  buffer_load_dwordx4 v207, s[36:39], s54 offen lds
  s_add_u32 m0, s61, 36864
  s_add_u32 s54, s62, 1824768
  buffer_load_dwordx4 v207, s[36:39], s54 offen lds
  s_add_u32 m0, s61, 40960
  s_add_u32 s54, s62, 1880064
  buffer_load_dwordx4 v207, s[36:39], s54 offen lds
  s_add_u32 m0, s61, 45056
  s_add_u32 s54, s62, 1935360
  buffer_load_dwordx4 v207, s[36:39], s54 offen lds
  v_add_u32 v215, 86016, v210
  ds_read_b64_tr_b16 a[80:81], v215 offset:0
  ds_read_b64_tr_b16 a[82:83], v215 offset:1024
  ds_read_b64_tr_b16 a[84:85], v215 offset:4096
  ds_read_b64_tr_b16 a[86:87], v215 offset:5120
  ds_read_b64_tr_b16 a[88:89], v215 offset:8192
  ds_read_b64_tr_b16 a[90:91], v215 offset:9216
  ds_read_b64_tr_b16 a[92:93], v215 offset:12288
  ds_read_b64_tr_b16 a[94:95], v215 offset:13312
  s_waitcnt vmcnt(20) lgkmcnt(0)
  s_barrier
  s_add_u32 m0, s61, 49152
  s_add_u32 s54, s62, 1769472
  buffer_load_dwordx4 v208, s[36:39], s54 offen lds
  s_add_u32 m0, s61, 53248
  s_add_u32 s54, s62, 1824768
  buffer_load_dwordx4 v208, s[36:39], s54 offen lds
  s_add_u32 m0, s61, 57344
  s_add_u32 s54, s62, 1880064
  buffer_load_dwordx4 v208, s[36:39], s54 offen lds
  s_add_u32 m0, s61, 61440
  s_add_u32 s54, s62, 1935360
  buffer_load_dwordx4 v208, s[36:39], s54 offen lds
  v_add_u32 v215, 102400, v210
  ds_read_b64_tr_b16 a[224:225], v215 offset:0
  ds_read_b64_tr_b16 a[226:227], v215 offset:1024
  ds_read_b64_tr_b16 a[228:229], v215 offset:4096
  ds_read_b64_tr_b16 a[230:231], v215 offset:5120
  ds_read_b64_tr_b16 a[232:233], v215 offset:8192
  ds_read_b64_tr_b16 a[234:235], v215 offset:9216
  ds_read_b64_tr_b16 a[236:237], v215 offset:12288
  ds_read_b64_tr_b16 a[238:239], v215 offset:13312
  s_waitcnt vmcnt(20) lgkmcnt(0)
  s_barrier
  v_add_u32 v215, 118784, v210
  ds_read_b64_tr_b16 a[96:97], v215 offset:0
  ds_read_b64_tr_b16 a[98:99], v215 offset:1024
  ds_read_b64_tr_b16 a[100:101], v215 offset:4096
  ds_read_b64_tr_b16 a[102:103], v215 offset:5120
  ds_read_b64_tr_b16 a[104:105], v215 offset:8192
  ds_read_b64_tr_b16 a[106:107], v215 offset:9216
  ds_read_b64_tr_b16 a[108:109], v215 offset:12288
  ds_read_b64_tr_b16 a[110:111], v215 offset:13312
  s_waitcnt vmcnt(16) lgkmcnt(0)
  s_barrier
  v_add_u32 v215, 135168, v210
  ds_read_b64_tr_b16 a[240:241], v215 offset:0
  ds_read_b64_tr_b16 a[242:243], v215 offset:1024
  ds_read_b64_tr_b16 a[244:245], v215 offset:4096
  ds_read_b64_tr_b16 a[246:247], v215 offset:5120
  ds_read_b64_tr_b16 a[248:249], v215 offset:8192
  ds_read_b64_tr_b16 a[250:251], v215 offset:9216
  ds_read_b64_tr_b16 a[252:253], v215 offset:12288
  ds_read_b64_tr_b16 a[254:255], v215 offset:13312
  s_waitcnt vmcnt(12) lgkmcnt(0)
  s_barrier
  v_add_u32 v215, 36864, v210
  ds_read_b64_tr_b16 a[112:113], v215 offset:0
  ds_read_b64_tr_b16 a[114:115], v215 offset:1024
  ds_read_b64_tr_b16 a[116:117], v215 offset:4096
  ds_read_b64_tr_b16 a[118:119], v215 offset:5120
  ds_read_b64_tr_b16 a[120:121], v215 offset:8192
  ds_read_b64_tr_b16 a[122:123], v215 offset:9216
  ds_read_b64_tr_b16 a[124:125], v215 offset:12288
  ds_read_b64_tr_b16 a[126:127], v215 offset:13312
  s_waitcnt vmcnt(8) lgkmcnt(0)
  s_barrier
  v_add_u32 v215, 53248, v210
  ds_read_b64_tr_b16 v[224:225], v215 offset:0
  ds_read_b64_tr_b16 v[226:227], v215 offset:1024
  ds_read_b64_tr_b16 v[228:229], v215 offset:4096
  ds_read_b64_tr_b16 v[230:231], v215 offset:5120
  ds_read_b64_tr_b16 v[232:233], v215 offset:8192
  ds_read_b64_tr_b16 v[234:235], v215 offset:9216
  ds_read_b64_tr_b16 v[236:237], v215 offset:12288
  ds_read_b64_tr_b16 v[238:239], v215 offset:13312
  s_waitcnt vmcnt(4) lgkmcnt(0)
  s_barrier
  v_add_u32 v215, 69632, v210
  ds_read_b64_tr_b16 a[128:129], v215 offset:0
  ds_read_b64_tr_b16 a[130:131], v215 offset:1024
  ds_read_b64_tr_b16 a[132:133], v215 offset:4096
  ds_read_b64_tr_b16 a[134:135], v215 offset:5120
  ds_read_b64_tr_b16 a[136:137], v215 offset:8192
  ds_read_b64_tr_b16 a[138:139], v215 offset:9216
  ds_read_b64_tr_b16 a[140:141], v215 offset:12288
  ds_read_b64_tr_b16 a[142:143], v215 offset:13312
  s_waitcnt vmcnt(0) lgkmcnt(0)
  s_barrier
  v_add_u32 v215, 86016, v210
  ds_read_b64_tr_b16 v[240:241], v215 offset:0
  ds_read_b64_tr_b16 v[242:243], v215 offset:1024
  ds_read_b64_tr_b16 v[244:245], v215 offset:4096
  ds_read_b64_tr_b16 v[246:247], v215 offset:5120
  ds_read_b64_tr_b16 v[248:249], v215 offset:8192
  ds_read_b64_tr_b16 v[250:251], v215 offset:9216
  ds_read_b64_tr_b16 v[252:253], v215 offset:12288
  ds_read_b64_tr_b16 v[254:255], v215 offset:13312
  s_waitcnt lgkmcnt(0)
  s_barrier
  v_and_b32 v211, 31, v200
  v_mul_u32_u24 v218, 516, v211
  v_lshrrev_b32 v212, 5, v200
  v_lshl_add_u32 v218, v212, 3, v218
  s_lshl_b32 s54, s52, 6
  s_add_u32 s54, s54, 73728
  v_add_u32 v218, s54, v218
  s_lshl_b32 s60, s69, 2
  s_mul_i32 s60, s60, 36864
  ds_read_b128 v[32:35], v203 offset:0
  ds_read_b128 v[36:39], v204 offset:0
  ds_read_b128 v[40:43], v205 offset:0
  s_waitcnt lgkmcnt(2)
  v_mfma_f32_32x32x16_bf16 v[0:15], a[0:3], v[32:35], 0
  ds_read_b128 v[44:47], v206 offset:0
  s_add_u32 m0, s67, 36864
  s_nop 0
  buffer_load_dwordx4 v202, s[4:7], s60 offen offset:0 lds
  v_mfma_f32_32x32x16_bf16 v[16:31], a[144:147], v[32:35], 0
  s_waitcnt lgkmcnt(2)
  v_mfma_f32_32x32x16_bf16 v[0:15], a[4:7], v[36:39], v[0:15]
  ds_read_b128 v[32:35], v203 offset:1024
  s_add_u32 m0, s67, 37760
  s_nop 0
  buffer_load_dwordx4 v202, s[4:7], s60 offen offset:128 lds
  v_mfma_f32_32x32x16_bf16 v[16:31], a[148:151], v[36:39], v[16:31]
  s_waitcnt lgkmcnt(2)
  v_mfma_f32_32x32x16_bf16 v[0:15], a[8:11], v[40:43], v[0:15]
  ds_read_b128 v[36:39], v204 offset:1024
  s_add_u32 m0, s67, 38656
  s_nop 0
  buffer_load_dwordx4 v202, s[4:7], s60 offen offset:256 lds
  v_mfma_f32_32x32x16_bf16 v[16:31], a[152:155], v[40:43], v[16:31]
  s_waitcnt lgkmcnt(2)
  v_mfma_f32_32x32x16_bf16 v[0:15], a[12:15], v[44:47], v[0:15]
  ds_read_b128 v[40:43], v205 offset:1024
  s_add_u32 m0, s67, 39552
  s_nop 0
  buffer_load_dwordx4 v202, s[4:7], s60 offen offset:384 lds
  v_mfma_f32_32x32x16_bf16 v[16:31], a[156:159], v[44:47], v[16:31]
  s_waitcnt lgkmcnt(2)
  v_mfma_f32_32x32x16_bf16 v[0:15], a[16:19], v[32:35], v[0:15]
  ds_read_b128 v[44:47], v206 offset:1024
  s_add_u32 m0, s67, 40448
  s_nop 0
  buffer_load_dwordx4 v202, s[4:7], s60 offen offset:512 lds
  v_mfma_f32_32x32x16_bf16 v[16:31], a[160:163], v[32:35], v[16:31]
  s_waitcnt lgkmcnt(2)
  v_mfma_f32_32x32x16_bf16 v[0:15], a[20:23], v[36:39], v[0:15]
  ds_read_b128 v[32:35], v203 offset:2048
  s_add_u32 m0, s67, 41344
  s_nop 0
  buffer_load_dwordx4 v202, s[4:7], s60 offen offset:640 lds
  v_mfma_f32_32x32x16_bf16 v[16:31], a[164:167], v[36:39], v[16:31]
  s_waitcnt lgkmcnt(2)
  v_mfma_f32_32x32x16_bf16 v[0:15], a[24:27], v[40:43], v[0:15]
  ds_read_b128 v[36:39], v204 offset:2048
  s_add_u32 m0, s67, 42240
  s_nop 0
  buffer_load_dwordx4 v202, s[4:7], s60 offen offset:768 lds
  v_mfma_f32_32x32x16_bf16 v[16:31], a[168:171], v[40:43], v[16:31]
  s_waitcnt lgkmcnt(2)
  v_mfma_f32_32x32x16_bf16 v[0:15], a[28:31], v[44:47], v[0:15]
  ds_read_b128 v[40:43], v205 offset:2048
  s_add_u32 m0, s67, 43136
  s_nop 0
  buffer_load_dwordx4 v202, s[4:7], s60 offen offset:896 lds
  v_mfma_f32_32x32x16_bf16 v[16:31], a[172:175], v[44:47], v[16:31]
  s_waitcnt lgkmcnt(2)
  v_mfma_f32_32x32x16_bf16 v[0:15], a[32:35], v[32:35], v[0:15]
  ds_read_b128 v[44:47], v206 offset:2048
  s_add_u32 m0, s67, 44032
  s_nop 0
  buffer_load_dwordx4 v202, s[4:7], s60 offen offset:1024 lds
  v_mfma_f32_32x32x16_bf16 v[16:31], a[176:179], v[32:35], v[16:31]
  s_waitcnt lgkmcnt(2)
  v_mfma_f32_32x32x16_bf16 v[0:15], a[36:39], v[36:39], v[0:15]
  ds_read_b128 v[32:35], v203 offset:3072
  v_mfma_f32_32x32x16_bf16 v[16:31], a[180:183], v[36:39], v[16:31]
  s_waitcnt lgkmcnt(2)
  v_mfma_f32_32x32x16_bf16 v[0:15], a[40:43], v[40:43], v[0:15]
  ds_read_b128 v[36:39], v204 offset:3072
  v_mfma_f32_32x32x16_bf16 v[16:31], a[184:187], v[40:43], v[16:31]
  s_waitcnt lgkmcnt(2)
  v_mfma_f32_32x32x16_bf16 v[0:15], a[44:47], v[44:47], v[0:15]
  ds_read_b128 v[40:43], v205 offset:3072
  v_mfma_f32_32x32x16_bf16 v[16:31], a[188:191], v[44:47], v[16:31]
  s_waitcnt lgkmcnt(2)
  v_mfma_f32_32x32x16_bf16 v[0:15], a[48:51], v[32:35], v[0:15]
  ds_read_b128 v[44:47], v206 offset:3072
  v_mfma_f32_32x32x16_bf16 v[16:31], a[192:195], v[32:35], v[16:31]
  s_waitcnt lgkmcnt(2)
  v_mfma_f32_32x32x16_bf16 v[0:15], a[52:55], v[36:39], v[0:15]
  ds_read_b128 v[32:35], v203 offset:4096
  v_mfma_f32_32x32x16_bf16 v[16:31], a[196:199], v[36:39], v[16:31]
  s_waitcnt lgkmcnt(2)
  v_mfma_f32_32x32x16_bf16 v[0:15], a[56:59], v[40:43], v[0:15]
  ds_read_b128 v[36:39], v204 offset:4096
  v_mfma_f32_32x32x16_bf16 v[16:31], a[200:203], v[40:43], v[16:31]
  s_waitcnt lgkmcnt(2)
  v_mfma_f32_32x32x16_bf16 v[0:15], a[60:63], v[44:47], v[0:15]
  ds_read_b128 v[40:43], v205 offset:4096
  v_mfma_f32_32x32x16_bf16 v[16:31], a[204:207], v[44:47], v[16:31]
  s_waitcnt lgkmcnt(2)
  v_mfma_f32_32x32x16_bf16 v[0:15], a[64:67], v[32:35], v[0:15]
  ds_read_b128 v[44:47], v206 offset:4096
  v_mfma_f32_32x32x16_bf16 v[16:31], a[208:211], v[32:35], v[16:31]
  s_waitcnt lgkmcnt(2)
  v_mfma_f32_32x32x16_bf16 v[0:15], a[68:71], v[36:39], v[0:15]
  ds_read_b128 v[32:35], v203 offset:5120
  v_mfma_f32_32x32x16_bf16 v[16:31], a[212:215], v[36:39], v[16:31]
  s_waitcnt lgkmcnt(2)
  v_mfma_f32_32x32x16_bf16 v[0:15], a[72:75], v[40:43], v[0:15]
  ds_read_b128 v[36:39], v204 offset:5120
  v_mfma_f32_32x32x16_bf16 v[16:31], a[216:219], v[40:43], v[16:31]
  s_waitcnt lgkmcnt(2)
  v_mfma_f32_32x32x16_bf16 v[0:15], a[76:79], v[44:47], v[0:15]
  ds_read_b128 v[40:43], v205 offset:5120
  v_mfma_f32_32x32x16_bf16 v[16:31], a[220:223], v[44:47], v[16:31]
  s_waitcnt lgkmcnt(2)
  v_mfma_f32_32x32x16_bf16 v[0:15], a[80:83], v[32:35], v[0:15]
  ds_read_b128 v[44:47], v206 offset:5120
  v_mfma_f32_32x32x16_bf16 v[16:31], a[224:227], v[32:35], v[16:31]
  s_waitcnt lgkmcnt(2)
  v_mfma_f32_32x32x16_bf16 v[0:15], a[84:87], v[36:39], v[0:15]
  ds_read_b128 v[32:35], v203 offset:6144
  v_mfma_f32_32x32x16_bf16 v[16:31], a[228:231], v[36:39], v[16:31]
  s_waitcnt lgkmcnt(2)
  v_mfma_f32_32x32x16_bf16 v[0:15], a[88:91], v[40:43], v[0:15]
  ds_read_b128 v[36:39], v204 offset:6144
  v_mfma_f32_32x32x16_bf16 v[16:31], a[232:235], v[40:43], v[16:31]
  s_waitcnt lgkmcnt(2)
  v_mfma_f32_32x32x16_bf16 v[0:15], a[92:95], v[44:47], v[0:15]
  ds_read_b128 v[40:43], v205 offset:6144
  v_mfma_f32_32x32x16_bf16 v[16:31], a[236:239], v[44:47], v[16:31]
  s_waitcnt lgkmcnt(2)
  v_mfma_f32_32x32x16_bf16 v[0:15], a[96:99], v[32:35], v[0:15]
  ds_read_b128 v[44:47], v206 offset:6144
  v_mfma_f32_32x32x16_bf16 v[16:31], a[240:243], v[32:35], v[16:31]
  s_waitcnt lgkmcnt(2)
  v_mfma_f32_32x32x16_bf16 v[0:15], a[100:103], v[36:39], v[0:15]
  ds_read_b128 v[32:35], v203 offset:7168
  v_mfma_f32_32x32x16_bf16 v[16:31], a[244:247], v[36:39], v[16:31]
  s_waitcnt lgkmcnt(2)
  v_mfma_f32_32x32x16_bf16 v[0:15], a[104:107], v[40:43], v[0:15]
  ds_read_b128 v[36:39], v204 offset:7168
  v_mfma_f32_32x32x16_bf16 v[16:31], a[248:251], v[40:43], v[16:31]
  s_waitcnt lgkmcnt(2)
  v_mfma_f32_32x32x16_bf16 v[0:15], a[108:111], v[44:47], v[0:15]
  ds_read_b128 v[40:43], v205 offset:7168
  v_mfma_f32_32x32x16_bf16 v[16:31], a[252:255], v[44:47], v[16:31]
  s_waitcnt lgkmcnt(2)
  v_mfma_f32_32x32x16_bf16 v[0:15], a[112:115], v[32:35], v[0:15]
  ds_read_b128 v[44:47], v206 offset:7168
  v_mfma_f32_32x32x16_bf16 v[16:31], v[224:227], v[32:35], v[16:31]
  s_waitcnt lgkmcnt(2)
  v_mfma_f32_32x32x16_bf16 v[0:15], a[116:119], v[36:39], v[0:15]
  ds_read_b128 v[32:35], v203 offset:8192
  v_mfma_f32_32x32x16_bf16 v[16:31], v[228:231], v[36:39], v[16:31]
  s_waitcnt lgkmcnt(2)
  v_mfma_f32_32x32x16_bf16 v[0:15], a[120:123], v[40:43], v[0:15]
  ds_read_b128 v[36:39], v204 offset:8192
  v_mfma_f32_32x32x16_bf16 v[16:31], v[232:235], v[40:43], v[16:31]
  s_waitcnt lgkmcnt(2)
  v_mfma_f32_32x32x16_bf16 v[0:15], a[124:127], v[44:47], v[0:15]
  ds_read_b128 v[40:43], v205 offset:8192
  v_mfma_f32_32x32x16_bf16 v[16:31], v[236:239], v[44:47], v[16:31]
  s_waitcnt lgkmcnt(2)
  v_mfma_f32_32x32x16_bf16 v[0:15], a[128:131], v[32:35], v[0:15]
  ds_read_b128 v[44:47], v206 offset:8192
  v_mfma_f32_32x32x16_bf16 v[16:31], v[240:243], v[32:35], v[16:31]
  s_waitcnt lgkmcnt(2)
  v_mfma_f32_32x32x16_bf16 v[0:15], a[132:135], v[36:39], v[0:15]
  v_mfma_f32_32x32x16_bf16 v[16:31], v[244:247], v[36:39], v[16:31]
  s_waitcnt lgkmcnt(1)
  v_mfma_f32_32x32x16_bf16 v[0:15], a[136:139], v[40:43], v[0:15]
  v_mfma_f32_32x32x16_bf16 v[16:31], v[248:251], v[40:43], v[16:31]
  s_waitcnt lgkmcnt(0)
  v_mfma_f32_32x32x16_bf16 v[0:15], a[140:143], v[44:47], v[0:15]
  v_mfma_f32_32x32x16_bf16 v[16:31], v[252:255], v[44:47], v[16:31]
  s_add_u32 s60, s60, 36864
  s_nop 2
  v_cvt_pk_bf16_f32 v48, v0, v1
  v_cvt_pk_bf16_f32 v49, v2, v3
  ds_write2_b32 v218, v48, v49 offset0:0 offset1:1
  v_cvt_pk_bf16_f32 v48, v4, v5
  v_cvt_pk_bf16_f32 v49, v6, v7
  ds_write2_b32 v218, v48, v49 offset0:4 offset1:5
  v_cvt_pk_bf16_f32 v48, v8, v9
  v_cvt_pk_bf16_f32 v49, v10, v11
  ds_write2_b32 v218, v48, v49 offset0:8 offset1:9
  v_cvt_pk_bf16_f32 v48, v12, v13
  v_cvt_pk_bf16_f32 v49, v14, v15
  ds_write2_b32 v218, v48, v49 offset0:12 offset1:13
  v_cvt_pk_bf16_f32 v48, v16, v17
  v_cvt_pk_bf16_f32 v49, v18, v19
  ds_write2_b32 v218, v48, v49 offset0:64 offset1:65
  v_cvt_pk_bf16_f32 v48, v20, v21
  v_cvt_pk_bf16_f32 v49, v22, v23
  ds_write2_b32 v218, v48, v49 offset0:68 offset1:69
  v_cvt_pk_bf16_f32 v48, v24, v25
  v_cvt_pk_bf16_f32 v49, v26, v27
  ds_write2_b32 v218, v48, v49 offset0:72 offset1:73
  v_cvt_pk_bf16_f32 v48, v28, v29
  v_cvt_pk_bf16_f32 v49, v30, v31
  ds_write2_b32 v218, v48, v49 offset0:76 offset1:77
  v_add_u32 v218, 16512, v218
  s_waitcnt vmcnt(0) lgkmcnt(0)
  s_barrier
  ds_read_b128 v[32:35], v203 offset:36864
  ds_read_b128 v[36:39], v204 offset:36864
  ds_read_b128 v[40:43], v205 offset:36864
  s_waitcnt lgkmcnt(2)
  v_mfma_f32_32x32x16_bf16 v[0:15], a[0:3], v[32:35], 0
  ds_read_b128 v[44:47], v206 offset:36864
  s_add_u32 m0, s67, 0
  s_nop 0
  buffer_load_dwordx4 v202, s[4:7], s60 offen offset:0 lds
  v_mfma_f32_32x32x16_bf16 v[16:31], a[144:147], v[32:35], 0
  s_waitcnt lgkmcnt(2)
  v_mfma_f32_32x32x16_bf16 v[0:15], a[4:7], v[36:39], v[0:15]
  ds_read_b128 v[32:35], v203 offset:37888
  s_add_u32 m0, s67, 896
  s_nop 0
  buffer_load_dwordx4 v202, s[4:7], s60 offen offset:128 lds
  v_mfma_f32_32x32x16_bf16 v[16:31], a[148:151], v[36:39], v[16:31]
  s_waitcnt lgkmcnt(2)
  v_mfma_f32_32x32x16_bf16 v[0:15], a[8:11], v[40:43], v[0:15]
  ds_read_b128 v[36:39], v204 offset:37888
  s_add_u32 m0, s67, 1792
  s_nop 0
  buffer_load_dwordx4 v202, s[4:7], s60 offen offset:256 lds
  v_mfma_f32_32x32x16_bf16 v[16:31], a[152:155], v[40:43], v[16:31]
  s_waitcnt lgkmcnt(2)
  v_mfma_f32_32x32x16_bf16 v[0:15], a[12:15], v[44:47], v[0:15]
  ds_read_b128 v[40:43], v205 offset:37888
  s_add_u32 m0, s67, 2688
  s_nop 0
  buffer_load_dwordx4 v202, s[4:7], s60 offen offset:384 lds
  v_mfma_f32_32x32x16_bf16 v[16:31], a[156:159], v[44:47], v[16:31]
  s_waitcnt lgkmcnt(2)
  v_mfma_f32_32x32x16_bf16 v[0:15], a[16:19], v[32:35], v[0:15]
  ds_read_b128 v[44:47], v206 offset:37888
  s_add_u32 m0, s67, 3584
  s_nop 0
  buffer_load_dwordx4 v202, s[4:7], s60 offen offset:512 lds
  v_mfma_f32_32x32x16_bf16 v[16:31], a[160:163], v[32:35], v[16:31]
  s_waitcnt lgkmcnt(2)
  v_mfma_f32_32x32x16_bf16 v[0:15], a[20:23], v[36:39], v[0:15]
  ds_read_b128 v[32:35], v203 offset:38912
  s_add_u32 m0, s67, 4480
  s_nop 0
  buffer_load_dwordx4 v202, s[4:7], s60 offen offset:640 lds
  v_mfma_f32_32x32x16_bf16 v[16:31], a[164:167], v[36:39], v[16:31]
  s_waitcnt lgkmcnt(2)
  v_mfma_f32_32x32x16_bf16 v[0:15], a[24:27], v[40:43], v[0:15]
  ds_read_b128 v[36:39], v204 offset:38912
  s_add_u32 m0, s67, 5376
  s_nop 0
  buffer_load_dwordx4 v202, s[4:7], s60 offen offset:768 lds
  v_mfma_f32_32x32x16_bf16 v[16:31], a[168:171], v[40:43], v[16:31]
  s_waitcnt lgkmcnt(2)
  v_mfma_f32_32x32x16_bf16 v[0:15], a[28:31], v[44:47], v[0:15]
  ds_read_b128 v[40:43], v205 offset:38912
  s_add_u32 m0, s67, 6272
  s_nop 0
  buffer_load_dwordx4 v202, s[4:7], s60 offen offset:896 lds
  v_mfma_f32_32x32x16_bf16 v[16:31], a[172:175], v[44:47], v[16:31]
  s_waitcnt lgkmcnt(2)
  v_mfma_f32_32x32x16_bf16 v[0:15], a[32:35], v[32:35], v[0:15]
  ds_read_b128 v[44:47], v206 offset:38912
  s_add_u32 m0, s67, 7168
  s_nop 0
  buffer_load_dwordx4 v202, s[4:7], s60 offen offset:1024 lds
  v_mfma_f32_32x32x16_bf16 v[16:31], a[176:179], v[32:35], v[16:31]
  s_waitcnt lgkmcnt(2)
  v_mfma_f32_32x32x16_bf16 v[0:15], a[36:39], v[36:39], v[0:15]
  ds_read_b128 v[32:35], v203 offset:39936
  v_mfma_f32_32x32x16_bf16 v[16:31], a[180:183], v[36:39], v[16:31]
  s_waitcnt lgkmcnt(2)
  v_mfma_f32_32x32x16_bf16 v[0:15], a[40:43], v[40:43], v[0:15]
  ds_read_b128 v[36:39], v204 offset:39936
  v_mfma_f32_32x32x16_bf16 v[16:31], a[184:187], v[40:43], v[16:31]
  s_waitcnt lgkmcnt(2)
  v_mfma_f32_32x32x16_bf16 v[0:15], a[44:47], v[44:47], v[0:15]
  ds_read_b128 v[40:43], v205 offset:39936
  v_mfma_f32_32x32x16_bf16 v[16:31], a[188:191], v[44:47], v[16:31]
  s_waitcnt lgkmcnt(2)
  v_mfma_f32_32x32x16_bf16 v[0:15], a[48:51], v[32:35], v[0:15]
  ds_read_b128 v[44:47], v206 offset:39936
  v_mfma_f32_32x32x16_bf16 v[16:31], a[192:195], v[32:35], v[16:31]
  s_waitcnt lgkmcnt(2)
  v_mfma_f32_32x32x16_bf16 v[0:15], a[52:55], v[36:39], v[0:15]
  ds_read_b128 v[32:35], v203 offset:40960
  v_mfma_f32_32x32x16_bf16 v[16:31], a[196:199], v[36:39], v[16:31]
  s_waitcnt lgkmcnt(2)
  v_mfma_f32_32x32x16_bf16 v[0:15], a[56:59], v[40:43], v[0:15]
  ds_read_b128 v[36:39], v204 offset:40960
  v_mfma_f32_32x32x16_bf16 v[16:31], a[200:203], v[40:43], v[16:31]
  s_waitcnt lgkmcnt(2)
  v_mfma_f32_32x32x16_bf16 v[0:15], a[60:63], v[44:47], v[0:15]
  ds_read_b128 v[40:43], v205 offset:40960
  v_mfma_f32_32x32x16_bf16 v[16:31], a[204:207], v[44:47], v[16:31]
  s_waitcnt lgkmcnt(2)
  v_mfma_f32_32x32x16_bf16 v[0:15], a[64:67], v[32:35], v[0:15]
  ds_read_b128 v[44:47], v206 offset:40960
  v_mfma_f32_32x32x16_bf16 v[16:31], a[208:211], v[32:35], v[16:31]
  s_waitcnt lgkmcnt(2)
  v_mfma_f32_32x32x16_bf16 v[0:15], a[68:71], v[36:39], v[0:15]
  ds_read_b128 v[32:35], v203 offset:41984
  v_mfma_f32_32x32x16_bf16 v[16:31], a[212:215], v[36:39], v[16:31]
  s_waitcnt lgkmcnt(2)
  v_mfma_f32_32x32x16_bf16 v[0:15], a[72:75], v[40:43], v[0:15]
  ds_read_b128 v[36:39], v204 offset:41984
  v_mfma_f32_32x32x16_bf16 v[16:31], a[216:219], v[40:43], v[16:31]
  s_waitcnt lgkmcnt(2)
  v_mfma_f32_32x32x16_bf16 v[0:15], a[76:79], v[44:47], v[0:15]
  ds_read_b128 v[40:43], v205 offset:41984
  v_mfma_f32_32x32x16_bf16 v[16:31], a[220:223], v[44:47], v[16:31]
  s_waitcnt lgkmcnt(2)
  v_mfma_f32_32x32x16_bf16 v[0:15], a[80:83], v[32:35], v[0:15]
  ds_read_b128 v[44:47], v206 offset:41984
  v_mfma_f32_32x32x16_bf16 v[16:31], a[224:227], v[32:35], v[16:31]
  s_waitcnt lgkmcnt(2)
  v_mfma_f32_32x32x16_bf16 v[0:15], a[84:87], v[36:39], v[0:15]
  ds_read_b128 v[32:35], v203 offset:43008
  v_mfma_f32_32x32x16_bf16 v[16:31], a[228:231], v[36:39], v[16:31]
  s_waitcnt lgkmcnt(2)
  v_mfma_f32_32x32x16_bf16 v[0:15], a[88:91], v[40:43], v[0:15]
  ds_read_b128 v[36:39], v204 offset:43008
  v_mfma_f32_32x32x16_bf16 v[16:31], a[232:235], v[40:43], v[16:31]
  s_waitcnt lgkmcnt(2)
  v_mfma_f32_32x32x16_bf16 v[0:15], a[92:95], v[44:47], v[0:15]
  ds_read_b128 v[40:43], v205 offset:43008
  v_mfma_f32_32x32x16_bf16 v[16:31], a[236:239], v[44:47], v[16:31]
  s_waitcnt lgkmcnt(2)
  v_mfma_f32_32x32x16_bf16 v[0:15], a[96:99], v[32:35], v[0:15]
  ds_read_b128 v[44:47], v206 offset:43008
  v_mfma_f32_32x32x16_bf16 v[16:31], a[240:243], v[32:35], v[16:31]
  s_waitcnt lgkmcnt(2)
  v_mfma_f32_32x32x16_bf16 v[0:15], a[100:103], v[36:39], v[0:15]
  ds_read_b128 v[32:35], v203 offset:44032
  v_mfma_f32_32x32x16_bf16 v[16:31], a[244:247], v[36:39], v[16:31]
  s_waitcnt lgkmcnt(2)
  v_mfma_f32_32x32x16_bf16 v[0:15], a[104:107], v[40:43], v[0:15]
  ds_read_b128 v[36:39], v204 offset:44032
  v_mfma_f32_32x32x16_bf16 v[16:31], a[248:251], v[40:43], v[16:31]
  s_waitcnt lgkmcnt(2)
  v_mfma_f32_32x32x16_bf16 v[0:15], a[108:111], v[44:47], v[0:15]
  ds_read_b128 v[40:43], v205 offset:44032
  v_mfma_f32_32x32x16_bf16 v[16:31], a[252:255], v[44:47], v[16:31]
  s_waitcnt lgkmcnt(2)
  v_mfma_f32_32x32x16_bf16 v[0:15], a[112:115], v[32:35], v[0:15]
  ds_read_b128 v[44:47], v206 offset:44032
  v_mfma_f32_32x32x16_bf16 v[16:31], v[224:227], v[32:35], v[16:31]
  s_waitcnt lgkmcnt(2)
  v_mfma_f32_32x32x16_bf16 v[0:15], a[116:119], v[36:39], v[0:15]
  ds_read_b128 v[32:35], v203 offset:45056
  v_mfma_f32_32x32x16_bf16 v[16:31], v[228:231], v[36:39], v[16:31]
  s_waitcnt lgkmcnt(2)
  v_mfma_f32_32x32x16_bf16 v[0:15], a[120:123], v[40:43], v[0:15]
  ds_read_b128 v[36:39], v204 offset:45056
  v_mfma_f32_32x32x16_bf16 v[16:31], v[232:235], v[40:43], v[16:31]
  s_waitcnt lgkmcnt(2)
  v_mfma_f32_32x32x16_bf16 v[0:15], a[124:127], v[44:47], v[0:15]
  ds_read_b128 v[40:43], v205 offset:45056
  v_mfma_f32_32x32x16_bf16 v[16:31], v[236:239], v[44:47], v[16:31]
  s_waitcnt lgkmcnt(2)
  v_mfma_f32_32x32x16_bf16 v[0:15], a[128:131], v[32:35], v[0:15]
  ds_read_b128 v[44:47], v206 offset:45056
  v_mfma_f32_32x32x16_bf16 v[16:31], v[240:243], v[32:35], v[16:31]
  s_waitcnt lgkmcnt(2)
  v_mfma_f32_32x32x16_bf16 v[0:15], a[132:135], v[36:39], v[0:15]
  v_mfma_f32_32x32x16_bf16 v[16:31], v[244:247], v[36:39], v[16:31]
  s_waitcnt lgkmcnt(1)
  v_mfma_f32_32x32x16_bf16 v[0:15], a[136:139], v[40:43], v[0:15]
  v_mfma_f32_32x32x16_bf16 v[16:31], v[248:251], v[40:43], v[16:31]
  s_waitcnt lgkmcnt(0)
  v_mfma_f32_32x32x16_bf16 v[0:15], a[140:143], v[44:47], v[0:15]
  v_mfma_f32_32x32x16_bf16 v[16:31], v[252:255], v[44:47], v[16:31]
  s_add_u32 s60, s60, 36864
  s_nop 2
  v_cvt_pk_bf16_f32 v48, v0, v1
  v_cvt_pk_bf16_f32 v49, v2, v3
  ds_write2_b32 v218, v48, v49 offset0:0 offset1:1
  v_cvt_pk_bf16_f32 v48, v4, v5
  v_cvt_pk_bf16_f32 v49, v6, v7
  ds_write2_b32 v218, v48, v49 offset0:4 offset1:5
  v_cvt_pk_bf16_f32 v48, v8, v9
  v_cvt_pk_bf16_f32 v49, v10, v11
  ds_write2_b32 v218, v48, v49 offset0:8 offset1:9
  v_cvt_pk_bf16_f32 v48, v12, v13
  v_cvt_pk_bf16_f32 v49, v14, v15
  ds_write2_b32 v218, v48, v49 offset0:12 offset1:13
  v_cvt_pk_bf16_f32 v48, v16, v17
  v_cvt_pk_bf16_f32 v49, v18, v19
  ds_write2_b32 v218, v48, v49 offset0:64 offset1:65
  v_cvt_pk_bf16_f32 v48, v20, v21
  v_cvt_pk_bf16_f32 v49, v22, v23
  ds_write2_b32 v218, v48, v49 offset0:68 offset1:69
  v_cvt_pk_bf16_f32 v48, v24, v25
  v_cvt_pk_bf16_f32 v49, v26, v27
  ds_write2_b32 v218, v48, v49 offset0:72 offset1:73
  v_cvt_pk_bf16_f32 v48, v28, v29
  v_cvt_pk_bf16_f32 v49, v30, v31
  ds_write2_b32 v218, v48, v49 offset0:76 offset1:77
  v_add_u32 v218, 16512, v218
  s_waitcnt vmcnt(0) lgkmcnt(0)
  s_barrier
  ds_read_b128 v[32:35], v203 offset:0
  ds_read_b128 v[36:39], v204 offset:0
  ds_read_b128 v[40:43], v205 offset:0
  s_waitcnt lgkmcnt(2)
  v_mfma_f32_32x32x16_bf16 v[0:15], a[0:3], v[32:35], 0
  ds_read_b128 v[44:47], v206 offset:0
  s_add_u32 m0, s67, 36864
  s_nop 0
  buffer_load_dwordx4 v202, s[4:7], s60 offen offset:0 lds
  v_mfma_f32_32x32x16_bf16 v[16:31], a[144:147], v[32:35], 0
  s_waitcnt lgkmcnt(2)
  v_mfma_f32_32x32x16_bf16 v[0:15], a[4:7], v[36:39], v[0:15]
  ds_read_b128 v[32:35], v203 offset:1024
  s_add_u32 m0, s67, 37760
  s_nop 0
  buffer_load_dwordx4 v202, s[4:7], s60 offen offset:128 lds
  v_mfma_f32_32x32x16_bf16 v[16:31], a[148:151], v[36:39], v[16:31]
  s_waitcnt lgkmcnt(2)
  v_mfma_f32_32x32x16_bf16 v[0:15], a[8:11], v[40:43], v[0:15]
  ds_read_b128 v[36:39], v204 offset:1024
  s_add_u32 m0, s67, 38656
  s_nop 0
  buffer_load_dwordx4 v202, s[4:7], s60 offen offset:256 lds
  v_mfma_f32_32x32x16_bf16 v[16:31], a[152:155], v[40:43], v[16:31]
  s_waitcnt lgkmcnt(2)
  v_mfma_f32_32x32x16_bf16 v[0:15], a[12:15], v[44:47], v[0:15]
  ds_read_b128 v[40:43], v205 offset:1024
  s_add_u32 m0, s67, 39552
  s_nop 0
  buffer_load_dwordx4 v202, s[4:7], s60 offen offset:384 lds
  v_mfma_f32_32x32x16_bf16 v[16:31], a[156:159], v[44:47], v[16:31]
  s_waitcnt lgkmcnt(2)
  v_mfma_f32_32x32x16_bf16 v[0:15], a[16:19], v[32:35], v[0:15]
  ds_read_b128 v[44:47], v206 offset:1024
  s_add_u32 m0, s67, 40448
  s_nop 0
  buffer_load_dwordx4 v202, s[4:7], s60 offen offset:512 lds
  v_mfma_f32_32x32x16_bf16 v[16:31], a[160:163], v[32:35], v[16:31]
  s_waitcnt lgkmcnt(2)
  v_mfma_f32_32x32x16_bf16 v[0:15], a[20:23], v[36:39], v[0:15]
  ds_read_b128 v[32:35], v203 offset:2048
  s_add_u32 m0, s67, 41344
  s_nop 0
  buffer_load_dwordx4 v202, s[4:7], s60 offen offset:640 lds
  v_mfma_f32_32x32x16_bf16 v[16:31], a[164:167], v[36:39], v[16:31]
  s_waitcnt lgkmcnt(2)
  v_mfma_f32_32x32x16_bf16 v[0:15], a[24:27], v[40:43], v[0:15]
  ds_read_b128 v[36:39], v204 offset:2048
  s_add_u32 m0, s67, 42240
  s_nop 0
  buffer_load_dwordx4 v202, s[4:7], s60 offen offset:768 lds
  v_mfma_f32_32x32x16_bf16 v[16:31], a[168:171], v[40:43], v[16:31]
  s_waitcnt lgkmcnt(2)
  v_mfma_f32_32x32x16_bf16 v[0:15], a[28:31], v[44:47], v[0:15]
  ds_read_b128 v[40:43], v205 offset:2048
  s_add_u32 m0, s67, 43136
  s_nop 0
  buffer_load_dwordx4 v202, s[4:7], s60 offen offset:896 lds
  v_mfma_f32_32x32x16_bf16 v[16:31], a[172:175], v[44:47], v[16:31]
  s_waitcnt lgkmcnt(2)
  v_mfma_f32_32x32x16_bf16 v[0:15], a[32:35], v[32:35], v[0:15]
  ds_read_b128 v[44:47], v206 offset:2048
  s_add_u32 m0, s67, 44032
  s_nop 0
  buffer_load_dwordx4 v202, s[4:7], s60 offen offset:1024 lds
  v_mfma_f32_32x32x16_bf16 v[16:31], a[176:179], v[32:35], v[16:31]
  s_waitcnt lgkmcnt(2)
  v_mfma_f32_32x32x16_bf16 v[0:15], a[36:39], v[36:39], v[0:15]
  ds_read_b128 v[32:35], v203 offset:3072
  v_mfma_f32_32x32x16_bf16 v[16:31], a[180:183], v[36:39], v[16:31]
  s_waitcnt lgkmcnt(2)
  v_mfma_f32_32x32x16_bf16 v[0:15], a[40:43], v[40:43], v[0:15]
  ds_read_b128 v[36:39], v204 offset:3072
  v_mfma_f32_32x32x16_bf16 v[16:31], a[184:187], v[40:43], v[16:31]
  s_waitcnt lgkmcnt(2)
  v_mfma_f32_32x32x16_bf16 v[0:15], a[44:47], v[44:47], v[0:15]
  ds_read_b128 v[40:43], v205 offset:3072
  v_mfma_f32_32x32x16_bf16 v[16:31], a[188:191], v[44:47], v[16:31]
  s_waitcnt lgkmcnt(2)
  v_mfma_f32_32x32x16_bf16 v[0:15], a[48:51], v[32:35], v[0:15]
  ds_read_b128 v[44:47], v206 offset:3072
  v_mfma_f32_32x32x16_bf16 v[16:31], a[192:195], v[32:35], v[16:31]
  s_waitcnt lgkmcnt(2)
  v_mfma_f32_32x32x16_bf16 v[0:15], a[52:55], v[36:39], v[0:15]
  ds_read_b128 v[32:35], v203 offset:4096
  v_mfma_f32_32x32x16_bf16 v[16:31], a[196:199], v[36:39], v[16:31]
  s_waitcnt lgkmcnt(2)
  v_mfma_f32_32x32x16_bf16 v[0:15], a[56:59], v[40:43], v[0:15]
  ds_read_b128 v[36:39], v204 offset:4096
  v_mfma_f32_32x32x16_bf16 v[16:31], a[200:203], v[40:43], v[16:31]
  s_waitcnt lgkmcnt(2)
  v_mfma_f32_32x32x16_bf16 v[0:15], a[60:63], v[44:47], v[0:15]
  ds_read_b128 v[40:43], v205 offset:4096
  v_mfma_f32_32x32x16_bf16 v[16:31], a[204:207], v[44:47], v[16:31]
  s_waitcnt lgkmcnt(2)
  v_mfma_f32_32x32x16_bf16 v[0:15], a[64:67], v[32:35], v[0:15]
  ds_read_b128 v[44:47], v206 offset:4096
  v_mfma_f32_32x32x16_bf16 v[16:31], a[208:211], v[32:35], v[16:31]
  s_waitcnt lgkmcnt(2)
  v_mfma_f32_32x32x16_bf16 v[0:15], a[68:71], v[36:39], v[0:15]
  ds_read_b128 v[32:35], v203 offset:5120
  v_mfma_f32_32x32x16_bf16 v[16:31], a[212:215], v[36:39], v[16:31]
  s_waitcnt lgkmcnt(2)
  v_mfma_f32_32x32x16_bf16 v[0:15], a[72:75], v[40:43], v[0:15]
  ds_read_b128 v[36:39], v204 offset:5120
  v_mfma_f32_32x32x16_bf16 v[16:31], a[216:219], v[40:43], v[16:31]
  s_waitcnt lgkmcnt(2)
  v_mfma_f32_32x32x16_bf16 v[0:15], a[76:79], v[44:47], v[0:15]
  ds_read_b128 v[40:43], v205 offset:5120
  v_mfma_f32_32x32x16_bf16 v[16:31], a[220:223], v[44:47], v[16:31]
  s_waitcnt lgkmcnt(2)
  v_mfma_f32_32x32x16_bf16 v[0:15], a[80:83], v[32:35], v[0:15]
  ds_read_b128 v[44:47], v206 offset:5120
  v_mfma_f32_32x32x16_bf16 v[16:31], a[224:227], v[32:35], v[16:31]
  s_waitcnt lgkmcnt(2)
  v_mfma_f32_32x32x16_bf16 v[0:15], a[84:87], v[36:39], v[0:15]
  ds_read_b128 v[32:35], v203 offset:6144
  v_mfma_f32_32x32x16_bf16 v[16:31], a[228:231], v[36:39], v[16:31]
  s_waitcnt lgkmcnt(2)
  v_mfma_f32_32x32x16_bf16 v[0:15], a[88:91], v[40:43], v[0:15]
  ds_read_b128 v[36:39], v204 offset:6144
  v_mfma_f32_32x32x16_bf16 v[16:31], a[232:235], v[40:43], v[16:31]
  s_waitcnt lgkmcnt(2)
  v_mfma_f32_32x32x16_bf16 v[0:15], a[92:95], v[44:47], v[0:15]
  ds_read_b128 v[40:43], v205 offset:6144
  v_mfma_f32_32x32x16_bf16 v[16:31], a[236:239], v[44:47], v[16:31]
  s_waitcnt lgkmcnt(2)
  v_mfma_f32_32x32x16_bf16 v[0:15], a[96:99], v[32:35], v[0:15]
  ds_read_b128 v[44:47], v206 offset:6144
  v_mfma_f32_32x32x16_bf16 v[16:31], a[240:243], v[32:35], v[16:31]
  s_waitcnt lgkmcnt(2)
  v_mfma_f32_32x32x16_bf16 v[0:15], a[100:103], v[36:39], v[0:15]
  ds_read_b128 v[32:35], v203 offset:7168
  v_mfma_f32_32x32x16_bf16 v[16:31], a[244:247], v[36:39], v[16:31]
  s_waitcnt lgkmcnt(2)
  v_mfma_f32_32x32x16_bf16 v[0:15], a[104:107], v[40:43], v[0:15]
  ds_read_b128 v[36:39], v204 offset:7168
  v_mfma_f32_32x32x16_bf16 v[16:31], a[248:251], v[40:43], v[16:31]
  s_waitcnt lgkmcnt(2)
  v_mfma_f32_32x32x16_bf16 v[0:15], a[108:111], v[44:47], v[0:15]
  ds_read_b128 v[40:43], v205 offset:7168
  v_mfma_f32_32x32x16_bf16 v[16:31], a[252:255], v[44:47], v[16:31]
  s_waitcnt lgkmcnt(2)
  v_mfma_f32_32x32x16_bf16 v[0:15], a[112:115], v[32:35], v[0:15]
  ds_read_b128 v[44:47], v206 offset:7168
  v_mfma_f32_32x32x16_bf16 v[16:31], v[224:227], v[32:35], v[16:31]
  s_waitcnt lgkmcnt(2)
  v_mfma_f32_32x32x16_bf16 v[0:15], a[116:119], v[36:39], v[0:15]
  ds_read_b128 v[32:35], v203 offset:8192
  v_mfma_f32_32x32x16_bf16 v[16:31], v[228:231], v[36:39], v[16:31]
  s_waitcnt lgkmcnt(2)
  v_mfma_f32_32x32x16_bf16 v[0:15], a[120:123], v[40:43], v[0:15]
  ds_read_b128 v[36:39], v204 offset:8192
  v_mfma_f32_32x32x16_bf16 v[16:31], v[232:235], v[40:43], v[16:31]
  s_waitcnt lgkmcnt(2)
  v_mfma_f32_32x32x16_bf16 v[0:15], a[124:127], v[44:47], v[0:15]
  ds_read_b128 v[40:43], v205 offset:8192
  v_mfma_f32_32x32x16_bf16 v[16:31], v[236:239], v[44:47], v[16:31]
  s_waitcnt lgkmcnt(2)
  v_mfma_f32_32x32x16_bf16 v[0:15], a[128:131], v[32:35], v[0:15]
  ds_read_b128 v[44:47], v206 offset:8192
  v_mfma_f32_32x32x16_bf16 v[16:31], v[240:243], v[32:35], v[16:31]
  s_waitcnt lgkmcnt(2)
  v_mfma_f32_32x32x16_bf16 v[0:15], a[132:135], v[36:39], v[0:15]
  v_mfma_f32_32x32x16_bf16 v[16:31], v[244:247], v[36:39], v[16:31]
  s_waitcnt lgkmcnt(1)
  v_mfma_f32_32x32x16_bf16 v[0:15], a[136:139], v[40:43], v[0:15]
  v_mfma_f32_32x32x16_bf16 v[16:31], v[248:251], v[40:43], v[16:31]
  s_waitcnt lgkmcnt(0)
  v_mfma_f32_32x32x16_bf16 v[0:15], a[140:143], v[44:47], v[0:15]
  v_mfma_f32_32x32x16_bf16 v[16:31], v[252:255], v[44:47], v[16:31]
  s_add_u32 s60, s60, 36864
  s_nop 2
  v_cvt_pk_bf16_f32 v48, v0, v1
  v_cvt_pk_bf16_f32 v49, v2, v3
  ds_write2_b32 v218, v48, v49 offset0:0 offset1:1
  v_cvt_pk_bf16_f32 v48, v4, v5
  v_cvt_pk_bf16_f32 v49, v6, v7
  ds_write2_b32 v218, v48, v49 offset0:4 offset1:5
  v_cvt_pk_bf16_f32 v48, v8, v9
  v_cvt_pk_bf16_f32 v49, v10, v11
  ds_write2_b32 v218, v48, v49 offset0:8 offset1:9
  v_cvt_pk_bf16_f32 v48, v12, v13
  v_cvt_pk_bf16_f32 v49, v14, v15
  ds_write2_b32 v218, v48, v49 offset0:12 offset1:13
  v_cvt_pk_bf16_f32 v48, v16, v17
  v_cvt_pk_bf16_f32 v49, v18, v19
  ds_write2_b32 v218, v48, v49 offset0:64 offset1:65
  v_cvt_pk_bf16_f32 v48, v20, v21
  v_cvt_pk_bf16_f32 v49, v22, v23
  ds_write2_b32 v218, v48, v49 offset0:68 offset1:69
  v_cvt_pk_bf16_f32 v48, v24, v25
  v_cvt_pk_bf16_f32 v49, v26, v27
  ds_write2_b32 v218, v48, v49 offset0:72 offset1:73
  v_cvt_pk_bf16_f32 v48, v28, v29
  v_cvt_pk_bf16_f32 v49, v30, v31
  ds_write2_b32 v218, v48, v49 offset0:76 offset1:77
  v_add_u32 v218, 16512, v218
  s_waitcnt vmcnt(0) lgkmcnt(0)
  s_barrier
  ds_read_b128 v[32:35], v203 offset:36864
  ds_read_b128 v[36:39], v204 offset:36864
  ds_read_b128 v[40:43], v205 offset:36864
  s_waitcnt lgkmcnt(2)
  v_mfma_f32_32x32x16_bf16 v[0:15], a[0:3], v[32:35], 0
  ds_read_b128 v[44:47], v206 offset:36864
  s_add_u32 m0, s67, 0
  s_nop 0
  buffer_load_dwordx4 v202, s[4:7], s60 offen offset:0 lds
  v_mfma_f32_32x32x16_bf16 v[16:31], a[144:147], v[32:35], 0
  s_waitcnt lgkmcnt(2)
  v_mfma_f32_32x32x16_bf16 v[0:15], a[4:7], v[36:39], v[0:15]
  ds_read_b128 v[32:35], v203 offset:37888
  s_add_u32 m0, s67, 896
  s_nop 0
  buffer_load_dwordx4 v202, s[4:7], s60 offen offset:128 lds
  v_mfma_f32_32x32x16_bf16 v[16:31], a[148:151], v[36:39], v[16:31]
  s_waitcnt lgkmcnt(2)
  v_mfma_f32_32x32x16_bf16 v[0:15], a[8:11], v[40:43], v[0:15]
  ds_read_b128 v[36:39], v204 offset:37888
  s_add_u32 m0, s67, 1792
  s_nop 0
  buffer_load_dwordx4 v202, s[4:7], s60 offen offset:256 lds
  v_mfma_f32_32x32x16_bf16 v[16:31], a[152:155], v[40:43], v[16:31]
  s_waitcnt lgkmcnt(2)
  v_mfma_f32_32x32x16_bf16 v[0:15], a[12:15], v[44:47], v[0:15]
  ds_read_b128 v[40:43], v205 offset:37888
  s_add_u32 m0, s67, 2688
  s_nop 0
  buffer_load_dwordx4 v202, s[4:7], s60 offen offset:384 lds
  v_mfma_f32_32x32x16_bf16 v[16:31], a[156:159], v[44:47], v[16:31]
  s_waitcnt lgkmcnt(2)
  v_mfma_f32_32x32x16_bf16 v[0:15], a[16:19], v[32:35], v[0:15]
  ds_read_b128 v[44:47], v206 offset:37888
  s_add_u32 m0, s67, 3584
  s_nop 0
  buffer_load_dwordx4 v202, s[4:7], s60 offen offset:512 lds
  v_mfma_f32_32x32x16_bf16 v[16:31], a[160:163], v[32:35], v[16:31]
  s_waitcnt lgkmcnt(2)
  v_mfma_f32_32x32x16_bf16 v[0:15], a[20:23], v[36:39], v[0:15]
  ds_read_b128 v[32:35], v203 offset:38912
  s_add_u32 m0, s67, 4480
  s_nop 0
  buffer_load_dwordx4 v202, s[4:7], s60 offen offset:640 lds
  v_mfma_f32_32x32x16_bf16 v[16:31], a[164:167], v[36:39], v[16:31]
  s_waitcnt lgkmcnt(2)
  v_mfma_f32_32x32x16_bf16 v[0:15], a[24:27], v[40:43], v[0:15]
  ds_read_b128 v[36:39], v204 offset:38912
  s_add_u32 m0, s67, 5376
  s_nop 0
  buffer_load_dwordx4 v202, s[4:7], s60 offen offset:768 lds
  v_mfma_f32_32x32x16_bf16 v[16:31], a[168:171], v[40:43], v[16:31]
  s_waitcnt lgkmcnt(2)
  v_mfma_f32_32x32x16_bf16 v[0:15], a[28:31], v[44:47], v[0:15]
  ds_read_b128 v[40:43], v205 offset:38912
  s_add_u32 m0, s67, 6272
  s_nop 0
  buffer_load_dwordx4 v202, s[4:7], s60 offen offset:896 lds
  v_mfma_f32_32x32x16_bf16 v[16:31], a[172:175], v[44:47], v[16:31]
  s_waitcnt lgkmcnt(2)
  v_mfma_f32_32x32x16_bf16 v[0:15], a[32:35], v[32:35], v[0:15]
  ds_read_b128 v[44:47], v206 offset:38912
  s_add_u32 m0, s67, 7168
  s_nop 0
  buffer_load_dwordx4 v202, s[4:7], s60 offen offset:1024 lds
  v_mfma_f32_32x32x16_bf16 v[16:31], a[176:179], v[32:35], v[16:31]
  s_waitcnt lgkmcnt(2)
  v_mfma_f32_32x32x16_bf16 v[0:15], a[36:39], v[36:39], v[0:15]
  ds_read_b128 v[32:35], v203 offset:39936
  v_mfma_f32_32x32x16_bf16 v[16:31], a[180:183], v[36:39], v[16:31]
  s_waitcnt lgkmcnt(2)
  v_mfma_f32_32x32x16_bf16 v[0:15], a[40:43], v[40:43], v[0:15]
  ds_read_b128 v[36:39], v204 offset:39936
  v_mfma_f32_32x32x16_bf16 v[16:31], a[184:187], v[40:43], v[16:31]
  s_waitcnt lgkmcnt(2)
  v_mfma_f32_32x32x16_bf16 v[0:15], a[44:47], v[44:47], v[0:15]
  ds_read_b128 v[40:43], v205 offset:39936
  v_mfma_f32_32x32x16_bf16 v[16:31], a[188:191], v[44:47], v[16:31]
  s_waitcnt lgkmcnt(2)
  v_mfma_f32_32x32x16_bf16 v[0:15], a[48:51], v[32:35], v[0:15]
  ds_read_b128 v[44:47], v206 offset:39936
  v_mfma_f32_32x32x16_bf16 v[16:31], a[192:195], v[32:35], v[16:31]
  s_waitcnt lgkmcnt(2)
  v_mfma_f32_32x32x16_bf16 v[0:15], a[52:55], v[36:39], v[0:15]
  ds_read_b128 v[32:35], v203 offset:40960
  v_mfma_f32_32x32x16_bf16 v[16:31], a[196:199], v[36:39], v[16:31]
  s_waitcnt lgkmcnt(2)
  v_mfma_f32_32x32x16_bf16 v[0:15], a[56:59], v[40:43], v[0:15]
  ds_read_b128 v[36:39], v204 offset:40960
  v_mfma_f32_32x32x16_bf16 v[16:31], a[200:203], v[40:43], v[16:31]
  s_waitcnt lgkmcnt(2)
  v_mfma_f32_32x32x16_bf16 v[0:15], a[60:63], v[44:47], v[0:15]
  ds_read_b128 v[40:43], v205 offset:40960
  v_mfma_f32_32x32x16_bf16 v[16:31], a[204:207], v[44:47], v[16:31]
  s_waitcnt lgkmcnt(2)
  v_mfma_f32_32x32x16_bf16 v[0:15], a[64:67], v[32:35], v[0:15]
  ds_read_b128 v[44:47], v206 offset:40960
  v_mfma_f32_32x32x16_bf16 v[16:31], a[208:211], v[32:35], v[16:31]
  s_waitcnt lgkmcnt(2)
  v_mfma_f32_32x32x16_bf16 v[0:15], a[68:71], v[36:39], v[0:15]
  ds_read_b128 v[32:35], v203 offset:41984
  v_mfma_f32_32x32x16_bf16 v[16:31], a[212:215], v[36:39], v[16:31]
  s_waitcnt lgkmcnt(2)
  v_mfma_f32_32x32x16_bf16 v[0:15], a[72:75], v[40:43], v[0:15]
  ds_read_b128 v[36:39], v204 offset:41984
  v_mfma_f32_32x32x16_bf16 v[16:31], a[216:219], v[40:43], v[16:31]
  s_waitcnt lgkmcnt(2)
  v_mfma_f32_32x32x16_bf16 v[0:15], a[76:79], v[44:47], v[0:15]
  ds_read_b128 v[40:43], v205 offset:41984
  v_mfma_f32_32x32x16_bf16 v[16:31], a[220:223], v[44:47], v[16:31]
  s_waitcnt lgkmcnt(2)
  v_mfma_f32_32x32x16_bf16 v[0:15], a[80:83], v[32:35], v[0:15]
  ds_read_b128 v[44:47], v206 offset:41984
  v_mfma_f32_32x32x16_bf16 v[16:31], a[224:227], v[32:35], v[16:31]
  s_waitcnt lgkmcnt(2)
  v_mfma_f32_32x32x16_bf16 v[0:15], a[84:87], v[36:39], v[0:15]
  ds_read_b128 v[32:35], v203 offset:43008
  v_mfma_f32_32x32x16_bf16 v[16:31], a[228:231], v[36:39], v[16:31]
  s_waitcnt lgkmcnt(2)
  v_mfma_f32_32x32x16_bf16 v[0:15], a[88:91], v[40:43], v[0:15]
  ds_read_b128 v[36:39], v204 offset:43008
  v_mfma_f32_32x32x16_bf16 v[16:31], a[232:235], v[40:43], v[16:31]
  s_waitcnt lgkmcnt(2)
  v_mfma_f32_32x32x16_bf16 v[0:15], a[92:95], v[44:47], v[0:15]
  ds_read_b128 v[40:43], v205 offset:43008
  v_mfma_f32_32x32x16_bf16 v[16:31], a[236:239], v[44:47], v[16:31]
  s_waitcnt lgkmcnt(2)
  v_mfma_f32_32x32x16_bf16 v[0:15], a[96:99], v[32:35], v[0:15]
  ds_read_b128 v[44:47], v206 offset:43008
  v_mfma_f32_32x32x16_bf16 v[16:31], a[240:243], v[32:35], v[16:31]
  s_waitcnt lgkmcnt(2)
  v_mfma_f32_32x32x16_bf16 v[0:15], a[100:103], v[36:39], v[0:15]
  ds_read_b128 v[32:35], v203 offset:44032
  v_mfma_f32_32x32x16_bf16 v[16:31], a[244:247], v[36:39], v[16:31]
  s_waitcnt lgkmcnt(2)
  v_mfma_f32_32x32x16_bf16 v[0:15], a[104:107], v[40:43], v[0:15]
  ds_read_b128 v[36:39], v204 offset:44032
  v_mfma_f32_32x32x16_bf16 v[16:31], a[248:251], v[40:43], v[16:31]
  s_waitcnt lgkmcnt(2)
  v_mfma_f32_32x32x16_bf16 v[0:15], a[108:111], v[44:47], v[0:15]
  ds_read_b128 v[40:43], v205 offset:44032
  v_mfma_f32_32x32x16_bf16 v[16:31], a[252:255], v[44:47], v[16:31]
  s_waitcnt lgkmcnt(2)
  v_mfma_f32_32x32x16_bf16 v[0:15], a[112:115], v[32:35], v[0:15]
  ds_read_b128 v[44:47], v206 offset:44032
  v_mfma_f32_32x32x16_bf16 v[16:31], v[224:227], v[32:35], v[16:31]
  s_waitcnt lgkmcnt(2)
  v_mfma_f32_32x32x16_bf16 v[0:15], a[116:119], v[36:39], v[0:15]
  ds_read_b128 v[32:35], v203 offset:45056
  v_mfma_f32_32x32x16_bf16 v[16:31], v[228:231], v[36:39], v[16:31]
  s_waitcnt lgkmcnt(2)
  v_mfma_f32_32x32x16_bf16 v[0:15], a[120:123], v[40:43], v[0:15]
  ds_read_b128 v[36:39], v204 offset:45056
  v_mfma_f32_32x32x16_bf16 v[16:31], v[232:235], v[40:43], v[16:31]
  s_waitcnt lgkmcnt(2)
  v_mfma_f32_32x32x16_bf16 v[0:15], a[124:127], v[44:47], v[0:15]
  ds_read_b128 v[40:43], v205 offset:45056
  v_mfma_f32_32x32x16_bf16 v[16:31], v[236:239], v[44:47], v[16:31]
  s_waitcnt lgkmcnt(2)
  v_mfma_f32_32x32x16_bf16 v[0:15], a[128:131], v[32:35], v[0:15]
  ds_read_b128 v[44:47], v206 offset:45056
  v_mfma_f32_32x32x16_bf16 v[16:31], v[240:243], v[32:35], v[16:31]
  s_waitcnt lgkmcnt(2)
  v_mfma_f32_32x32x16_bf16 v[0:15], a[132:135], v[36:39], v[0:15]
  v_mfma_f32_32x32x16_bf16 v[16:31], v[244:247], v[36:39], v[16:31]
  s_waitcnt lgkmcnt(1)
  v_mfma_f32_32x32x16_bf16 v[0:15], a[136:139], v[40:43], v[0:15]
  v_mfma_f32_32x32x16_bf16 v[16:31], v[248:251], v[40:43], v[16:31]
  s_waitcnt lgkmcnt(0)
  v_mfma_f32_32x32x16_bf16 v[0:15], a[140:143], v[44:47], v[0:15]
  v_mfma_f32_32x32x16_bf16 v[16:31], v[252:255], v[44:47], v[16:31]
  s_add_u32 s60, s60, 36864
  s_nop 2
  v_cvt_pk_bf16_f32 v48, v0, v1
  v_cvt_pk_bf16_f32 v49, v2, v3
  ds_write2_b32 v218, v48, v49 offset0:0 offset1:1
  v_cvt_pk_bf16_f32 v48, v4, v5
  v_cvt_pk_bf16_f32 v49, v6, v7
  ds_write2_b32 v218, v48, v49 offset0:4 offset1:5
  v_cvt_pk_bf16_f32 v48, v8, v9
  v_cvt_pk_bf16_f32 v49, v10, v11
  ds_write2_b32 v218, v48, v49 offset0:8 offset1:9
  v_cvt_pk_bf16_f32 v48, v12, v13
  v_cvt_pk_bf16_f32 v49, v14, v15
  ds_write2_b32 v218, v48, v49 offset0:12 offset1:13
  v_cvt_pk_bf16_f32 v48, v16, v17
  v_cvt_pk_bf16_f32 v49, v18, v19
  ds_write2_b32 v218, v48, v49 offset0:64 offset1:65
  v_cvt_pk_bf16_f32 v48, v20, v21
  v_cvt_pk_bf16_f32 v49, v22, v23
  ds_write2_b32 v218, v48, v49 offset0:68 offset1:69
  v_cvt_pk_bf16_f32 v48, v24, v25
  v_cvt_pk_bf16_f32 v49, v26, v27
  ds_write2_b32 v218, v48, v49 offset0:72 offset1:73
  v_cvt_pk_bf16_f32 v48, v28, v29
  v_cvt_pk_bf16_f32 v49, v30, v31
  ds_write2_b32 v218, v48, v49 offset0:76 offset1:77
  v_add_u32 v218, 16512, v218
  s_waitcnt vmcnt(0) lgkmcnt(0)
  s_barrier
  ds_read_b128 v[32:35], v203 offset:0
  ds_read_b128 v[36:39], v204 offset:0
  ds_read_b128 v[40:43], v205 offset:0
  s_waitcnt lgkmcnt(2)
  v_mfma_f32_32x32x16_bf16 v[0:15], a[0:3], v[32:35], 0
  ds_read_b128 v[44:47], v206 offset:0
  v_mfma_f32_32x32x16_bf16 v[16:31], a[144:147], v[32:35], 0
  s_waitcnt lgkmcnt(2)
  v_mfma_f32_32x32x16_bf16 v[0:15], a[4:7], v[36:39], v[0:15]
  ds_read_b128 v[32:35], v203 offset:1024
  v_mfma_f32_32x32x16_bf16 v[16:31], a[148:151], v[36:39], v[16:31]
  s_waitcnt lgkmcnt(2)
  v_mfma_f32_32x32x16_bf16 v[0:15], a[8:11], v[40:43], v[0:15]
  ds_read_b128 v[36:39], v204 offset:1024
  v_mfma_f32_32x32x16_bf16 v[16:31], a[152:155], v[40:43], v[16:31]
  s_waitcnt lgkmcnt(2)
  v_mfma_f32_32x32x16_bf16 v[0:15], a[12:15], v[44:47], v[0:15]
  ds_read_b128 v[40:43], v205 offset:1024
  v_mfma_f32_32x32x16_bf16 v[16:31], a[156:159], v[44:47], v[16:31]
  s_waitcnt lgkmcnt(2)
  v_mfma_f32_32x32x16_bf16 v[0:15], a[16:19], v[32:35], v[0:15]
  ds_read_b128 v[44:47], v206 offset:1024
  v_mfma_f32_32x32x16_bf16 v[16:31], a[160:163], v[32:35], v[16:31]
  s_waitcnt lgkmcnt(2)
  v_mfma_f32_32x32x16_bf16 v[0:15], a[20:23], v[36:39], v[0:15]
  ds_read_b128 v[32:35], v203 offset:2048
  v_mfma_f32_32x32x16_bf16 v[16:31], a[164:167], v[36:39], v[16:31]
  s_waitcnt lgkmcnt(2)
  v_mfma_f32_32x32x16_bf16 v[0:15], a[24:27], v[40:43], v[0:15]
  ds_read_b128 v[36:39], v204 offset:2048
  v_mfma_f32_32x32x16_bf16 v[16:31], a[168:171], v[40:43], v[16:31]
  s_waitcnt lgkmcnt(2)
  v_mfma_f32_32x32x16_bf16 v[0:15], a[28:31], v[44:47], v[0:15]
  ds_read_b128 v[40:43], v205 offset:2048
  v_mfma_f32_32x32x16_bf16 v[16:31], a[172:175], v[44:47], v[16:31]
  s_waitcnt lgkmcnt(2)
  v_mfma_f32_32x32x16_bf16 v[0:15], a[32:35], v[32:35], v[0:15]
  ds_read_b128 v[44:47], v206 offset:2048
  v_mfma_f32_32x32x16_bf16 v[16:31], a[176:179], v[32:35], v[16:31]
  s_waitcnt lgkmcnt(2)
  v_mfma_f32_32x32x16_bf16 v[0:15], a[36:39], v[36:39], v[0:15]
  ds_read_b128 v[32:35], v203 offset:3072
  v_mfma_f32_32x32x16_bf16 v[16:31], a[180:183], v[36:39], v[16:31]
  s_waitcnt lgkmcnt(2)
  v_mfma_f32_32x32x16_bf16 v[0:15], a[40:43], v[40:43], v[0:15]
  ds_read_b128 v[36:39], v204 offset:3072
  v_mfma_f32_32x32x16_bf16 v[16:31], a[184:187], v[40:43], v[16:31]
  s_waitcnt lgkmcnt(2)
  v_mfma_f32_32x32x16_bf16 v[0:15], a[44:47], v[44:47], v[0:15]
  ds_read_b128 v[40:43], v205 offset:3072
  v_mfma_f32_32x32x16_bf16 v[16:31], a[188:191], v[44:47], v[16:31]
  s_waitcnt lgkmcnt(2)
  v_mfma_f32_32x32x16_bf16 v[0:15], a[48:51], v[32:35], v[0:15]
  ds_read_b128 v[44:47], v206 offset:3072
  v_mfma_f32_32x32x16_bf16 v[16:31], a[192:195], v[32:35], v[16:31]
  s_waitcnt lgkmcnt(2)
  v_mfma_f32_32x32x16_bf16 v[0:15], a[52:55], v[36:39], v[0:15]
  ds_read_b128 v[32:35], v203 offset:4096
  v_mfma_f32_32x32x16_bf16 v[16:31], a[196:199], v[36:39], v[16:31]
  s_waitcnt lgkmcnt(2)
  v_mfma_f32_32x32x16_bf16 v[0:15], a[56:59], v[40:43], v[0:15]
  ds_read_b128 v[36:39], v204 offset:4096
  v_mfma_f32_32x32x16_bf16 v[16:31], a[200:203], v[40:43], v[16:31]
  s_waitcnt lgkmcnt(2)
  v_mfma_f32_32x32x16_bf16 v[0:15], a[60:63], v[44:47], v[0:15]
  ds_read_b128 v[40:43], v205 offset:4096
  v_mfma_f32_32x32x16_bf16 v[16:31], a[204:207], v[44:47], v[16:31]
  s_waitcnt lgkmcnt(2)
  v_mfma_f32_32x32x16_bf16 v[0:15], a[64:67], v[32:35], v[0:15]
  ds_read_b128 v[44:47], v206 offset:4096
  v_mfma_f32_32x32x16_bf16 v[16:31], a[208:211], v[32:35], v[16:31]
  s_waitcnt lgkmcnt(2)
  v_mfma_f32_32x32x16_bf16 v[0:15], a[68:71], v[36:39], v[0:15]
  ds_read_b128 v[32:35], v203 offset:5120
  v_mfma_f32_32x32x16_bf16 v[16:31], a[212:215], v[36:39], v[16:31]
  s_waitcnt lgkmcnt(2)
  v_mfma_f32_32x32x16_bf16 v[0:15], a[72:75], v[40:43], v[0:15]
  ds_read_b128 v[36:39], v204 offset:5120
  v_mfma_f32_32x32x16_bf16 v[16:31], a[216:219], v[40:43], v[16:31]
  s_waitcnt lgkmcnt(2)
  v_mfma_f32_32x32x16_bf16 v[0:15], a[76:79], v[44:47], v[0:15]
  ds_read_b128 v[40:43], v205 offset:5120
  v_mfma_f32_32x32x16_bf16 v[16:31], a[220:223], v[44:47], v[16:31]
  s_waitcnt lgkmcnt(2)
  v_mfma_f32_32x32x16_bf16 v[0:15], a[80:83], v[32:35], v[0:15]
  ds_read_b128 v[44:47], v206 offset:5120
  v_mfma_f32_32x32x16_bf16 v[16:31], a[224:227], v[32:35], v[16:31]
  s_waitcnt lgkmcnt(2)
  v_mfma_f32_32x32x16_bf16 v[0:15], a[84:87], v[36:39], v[0:15]
  ds_read_b128 v[32:35], v203 offset:6144
  v_mfma_f32_32x32x16_bf16 v[16:31], a[228:231], v[36:39], v[16:31]
  s_waitcnt lgkmcnt(2)
  v_mfma_f32_32x32x16_bf16 v[0:15], a[88:91], v[40:43], v[0:15]
  ds_read_b128 v[36:39], v204 offset:6144
  v_mfma_f32_32x32x16_bf16 v[16:31], a[232:235], v[40:43], v[16:31]
  s_waitcnt lgkmcnt(2)
  v_mfma_f32_32x32x16_bf16 v[0:15], a[92:95], v[44:47], v[0:15]
  ds_read_b128 v[40:43], v205 offset:6144
  v_mfma_f32_32x32x16_bf16 v[16:31], a[236:239], v[44:47], v[16:31]
  s_waitcnt lgkmcnt(2)
  v_mfma_f32_32x32x16_bf16 v[0:15], a[96:99], v[32:35], v[0:15]
  ds_read_b128 v[44:47], v206 offset:6144
  v_mfma_f32_32x32x16_bf16 v[16:31], a[240:243], v[32:35], v[16:31]
  s_waitcnt lgkmcnt(2)
  v_mfma_f32_32x32x16_bf16 v[0:15], a[100:103], v[36:39], v[0:15]
  ds_read_b128 v[32:35], v203 offset:7168
  v_mfma_f32_32x32x16_bf16 v[16:31], a[244:247], v[36:39], v[16:31]
  s_waitcnt lgkmcnt(2)
  v_mfma_f32_32x32x16_bf16 v[0:15], a[104:107], v[40:43], v[0:15]
  ds_read_b128 v[36:39], v204 offset:7168
  v_mfma_f32_32x32x16_bf16 v[16:31], a[248:251], v[40:43], v[16:31]
  s_waitcnt lgkmcnt(2)
  v_mfma_f32_32x32x16_bf16 v[0:15], a[108:111], v[44:47], v[0:15]
  ds_read_b128 v[40:43], v205 offset:7168
  v_mfma_f32_32x32x16_bf16 v[16:31], a[252:255], v[44:47], v[16:31]
  s_waitcnt lgkmcnt(2)
  v_mfma_f32_32x32x16_bf16 v[0:15], a[112:115], v[32:35], v[0:15]
  ds_read_b128 v[44:47], v206 offset:7168
  v_mfma_f32_32x32x16_bf16 v[16:31], v[224:227], v[32:35], v[16:31]
  s_waitcnt lgkmcnt(2)
  v_mfma_f32_32x32x16_bf16 v[0:15], a[116:119], v[36:39], v[0:15]
  ds_read_b128 v[32:35], v203 offset:8192
  v_mfma_f32_32x32x16_bf16 v[16:31], v[228:231], v[36:39], v[16:31]
  s_waitcnt lgkmcnt(2)
  v_mfma_f32_32x32x16_bf16 v[0:15], a[120:123], v[40:43], v[0:15]
  ds_read_b128 v[36:39], v204 offset:8192
  v_mfma_f32_32x32x16_bf16 v[16:31], v[232:235], v[40:43], v[16:31]
  s_waitcnt lgkmcnt(2)
  v_mfma_f32_32x32x16_bf16 v[0:15], a[124:127], v[44:47], v[0:15]
  ds_read_b128 v[40:43], v205 offset:8192
  v_mfma_f32_32x32x16_bf16 v[16:31], v[236:239], v[44:47], v[16:31]
  s_waitcnt lgkmcnt(2)
  v_mfma_f32_32x32x16_bf16 v[0:15], a[128:131], v[32:35], v[0:15]
  ds_read_b128 v[44:47], v206 offset:8192
  v_mfma_f32_32x32x16_bf16 v[16:31], v[240:243], v[32:35], v[16:31]
  s_waitcnt lgkmcnt(2)
  v_mfma_f32_32x32x16_bf16 v[0:15], a[132:135], v[36:39], v[0:15]
  v_mfma_f32_32x32x16_bf16 v[16:31], v[244:247], v[36:39], v[16:31]
  s_waitcnt lgkmcnt(1)
  v_mfma_f32_32x32x16_bf16 v[0:15], a[136:139], v[40:43], v[0:15]
  v_mfma_f32_32x32x16_bf16 v[16:31], v[248:251], v[40:43], v[16:31]
  s_waitcnt lgkmcnt(0)
  v_mfma_f32_32x32x16_bf16 v[0:15], a[140:143], v[44:47], v[0:15]
  v_mfma_f32_32x32x16_bf16 v[16:31], v[252:255], v[44:47], v[16:31]
  s_add_u32 s60, s60, 36864
  s_nop 2
  v_cvt_pk_bf16_f32 v48, v0, v1
  v_cvt_pk_bf16_f32 v49, v2, v3
  ds_write2_b32 v218, v48, v49 offset0:0 offset1:1
  v_cvt_pk_bf16_f32 v48, v4, v5
  v_cvt_pk_bf16_f32 v49, v6, v7
  ds_write2_b32 v218, v48, v49 offset0:4 offset1:5
  v_cvt_pk_bf16_f32 v48, v8, v9
  v_cvt_pk_bf16_f32 v49, v10, v11
  ds_write2_b32 v218, v48, v49 offset0:8 offset1:9
  v_cvt_pk_bf16_f32 v48, v12, v13
  v_cvt_pk_bf16_f32 v49, v14, v15
  ds_write2_b32 v218, v48, v49 offset0:12 offset1:13
  v_cvt_pk_bf16_f32 v48, v16, v17
  v_cvt_pk_bf16_f32 v49, v18, v19
  ds_write2_b32 v218, v48, v49 offset0:64 offset1:65
  v_cvt_pk_bf16_f32 v48, v20, v21
  v_cvt_pk_bf16_f32 v49, v22, v23
  ds_write2_b32 v218, v48, v49 offset0:68 offset1:69
  v_cvt_pk_bf16_f32 v48, v24, v25
  v_cvt_pk_bf16_f32 v49, v26, v27
  ds_write2_b32 v218, v48, v49 offset0:72 offset1:73
  v_cvt_pk_bf16_f32 v48, v28, v29
  v_cvt_pk_bf16_f32 v49, v30, v31
  ds_write2_b32 v218, v48, v49 offset0:76 offset1:77
  v_add_u32 v218, 16512, v218
  s_waitcnt vmcnt(0) lgkmcnt(0)
  s_barrier
  v_mul_u32_u24 v219, 516, v200
  s_mul_i32 s54, s52, 36
  s_add_u32 s55, s54, 83016
  v_add_u32 v219, s55, v219
  v_mul_u32_u24 v220, 144, v200
  v_add_u32 v220, s54, v220
  s_mul_i32 s54, s52, 3072
  v_add_u32 v218, s54, v201
  s_lshl_b32 s55, s68, 4
  s_add_u32 s55, s55, s69
  s_mul_i32 s64, s55, 18432
  s_add_u32 s64, s64, 62914560
  s_cmp_eq_u32 s52, 3
  s_cselect_b32 s64, 268435456, s64
  s_lshl_b32 s66, s69, 7
  s_mov_b32 s57, 1051597459
  ds_read_b32 v0, v219 offset:7224
  ds_read_b32 v1, v219 offset:7228
  ds_read_b32 v2, v219 offset:7232
  ds_read_b32 v3, v219 offset:7236
  ds_read_b32 v4, v219 offset:7240
  ds_read_b32 v5, v219 offset:7244
  ds_read_b32 v6, v219 offset:7248
  ds_read_b32 v7, v219 offset:7252
  ds_read_b32 v8, v219 offset:7256
  ds_read_b32 v16, v219 offset:7368
  ds_read_b32 v17, v219 offset:7372
  ds_read_b32 v18, v219 offset:7376
  ds_read_b32 v19, v219 offset:7380
  ds_read_b32 v20, v219 offset:7384
  ds_read_b32 v21, v219 offset:7388
  ds_read_b32 v22, v219 offset:7392
  ds_read_b32 v23, v219 offset:7396
  ds_read_b32 v24, v219 offset:7400
  ds_read_b32 v25, v219 offset:6336
  ds_read_b32 v26, v219 offset:6340
  ds_read_b32 v27, v219 offset:6344
  ds_read_b32 v28, v219 offset:6348
  ds_read_b32 v29, v219 offset:6352
  ds_read_b32 v30, v219 offset:6356
  ds_read_b32 v31, v219 offset:6360
  ds_read_b32 v32, v219 offset:6364
  ds_read_b32 v33, v219 offset:6368
  ds_read_b32 v34, v219 offset:5304
  ds_read_b32 v35, v219 offset:5308
  ds_read_b32 v36, v219 offset:5312
  ds_read_b32 v37, v219 offset:5316
  ds_read_b32 v38, v219 offset:5320
  ds_read_b32 v39, v219 offset:5324
  ds_read_b32 v40, v219 offset:5328
  ds_read_b32 v41, v219 offset:5332
  ds_read_b32 v42, v219 offset:5336
  ds_read_b32 v43, v219 offset:4272
  ds_read_b32 v44, v219 offset:4276
  ds_read_b32 v45, v219 offset:4280
  ds_read_b32 v46, v219 offset:4284
  ds_read_b32 v47, v219 offset:4288
  ds_read_b32 v48, v219 offset:4292
  ds_read_b32 v49, v219 offset:4296
  ds_read_b32 v50, v219 offset:4300
  ds_read_b32 v51, v219 offset:4304
  ds_read_b32 v52, v219 offset:3240
  ds_read_b32 v53, v219 offset:3244
  ds_read_b32 v54, v219 offset:3248
  ds_read_b32 v55, v219 offset:3252
  ds_read_b32 v56, v219 offset:3256
  ds_read_b32 v57, v219 offset:3260
  ds_read_b32 v58, v219 offset:3264
  ds_read_b32 v59, v219 offset:3268
  ds_read_b32 v60, v219 offset:3272
  ds_read_b32 v61, v219 offset:2208
  ds_read_b32 v62, v219 offset:2212
  ds_read_b32 v63, v219 offset:2216
  ds_read_b32 v64, v219 offset:2220
  ds_read_b32 v65, v219 offset:2224
  ds_read_b32 v66, v219 offset:2228
  ds_read_b32 v67, v219 offset:2232
  ds_read_b32 v68, v219 offset:2236
  ds_read_b32 v69, v219 offset:2240
  ds_read_b32 v70, v219 offset:1176
  ds_read_b32 v71, v219 offset:1180
  ds_read_b32 v72, v219 offset:1184
  ds_read_b32 v73, v219 offset:1188
  ds_read_b32 v74, v219 offset:1192
  ds_read_b32 v75, v219 offset:1196
  ds_read_b32 v76, v219 offset:1200
  ds_read_b32 v77, v219 offset:1204
  ds_read_b32 v78, v219 offset:1208
  ds_read_b32 v79, v219 offset:144
  ds_read_b32 v80, v219 offset:148
  ds_read_b32 v81, v219 offset:152
  ds_read_b32 v82, v219 offset:156
  ds_read_b32 v83, v219 offset:160
  ds_read_b32 v84, v219 offset:164
  ds_read_b32 v85, v219 offset:168
  ds_read_b32 v86, v219 offset:172
  ds_read_b32 v87, v219 offset:176
  v_mov_b32 v100, 0
  v_mov_b32 v101, 0
  v_mov_b32 v102, 0
  v_mov_b32 v103, 0
  v_mov_b32 v104, 0
  v_mov_b32 v105, 0
  v_mov_b32 v106, 0
  v_mov_b32 v107, 0
  s_waitcnt lgkmcnt(15)
  v_dot2c_f32_bf16 v100, v0, v16
  v_dot2c_f32_bf16 v101, v0, v25
  v_dot2c_f32_bf16 v102, v0, v34
  v_dot2c_f32_bf16 v103, v0, v43
  v_dot2c_f32_bf16 v104, v0, v52
  v_dot2c_f32_bf16 v105, v0, v61
  v_dot2c_f32_bf16 v106, v0, v70
  s_waitcnt lgkmcnt(8)
  v_dot2c_f32_bf16 v107, v0, v79
  v_dot2c_f32_bf16 v100, v1, v17
  v_dot2c_f32_bf16 v101, v1, v26
  v_dot2c_f32_bf16 v102, v1, v35
  v_dot2c_f32_bf16 v103, v1, v44
  v_dot2c_f32_bf16 v104, v1, v53
  v_dot2c_f32_bf16 v105, v1, v62
  v_dot2c_f32_bf16 v106, v1, v71
  s_waitcnt lgkmcnt(7)
  v_dot2c_f32_bf16 v107, v1, v80
  v_dot2c_f32_bf16 v100, v2, v18
  v_dot2c_f32_bf16 v101, v2, v27
  v_dot2c_f32_bf16 v102, v2, v36
  v_dot2c_f32_bf16 v103, v2, v45
  v_dot2c_f32_bf16 v104, v2, v54
  v_dot2c_f32_bf16 v105, v2, v63
  v_dot2c_f32_bf16 v106, v2, v72
  s_waitcnt lgkmcnt(6)
  v_dot2c_f32_bf16 v107, v2, v81
  v_dot2c_f32_bf16 v100, v3, v19
  v_dot2c_f32_bf16 v101, v3, v28
  v_dot2c_f32_bf16 v102, v3, v37
  v_dot2c_f32_bf16 v103, v3, v46
  v_dot2c_f32_bf16 v104, v3, v55
  v_dot2c_f32_bf16 v105, v3, v64
  v_dot2c_f32_bf16 v106, v3, v73
  s_waitcnt lgkmcnt(5)
  v_dot2c_f32_bf16 v107, v3, v82
  v_dot2c_f32_bf16 v100, v4, v20
  v_dot2c_f32_bf16 v101, v4, v29
  v_dot2c_f32_bf16 v102, v4, v38
  v_dot2c_f32_bf16 v103, v4, v47
  v_dot2c_f32_bf16 v104, v4, v56
  v_dot2c_f32_bf16 v105, v4, v65
  v_dot2c_f32_bf16 v106, v4, v74
  s_waitcnt lgkmcnt(4)
  v_dot2c_f32_bf16 v107, v4, v83
  v_dot2c_f32_bf16 v100, v5, v21
  v_dot2c_f32_bf16 v101, v5, v30
  v_dot2c_f32_bf16 v102, v5, v39
  v_dot2c_f32_bf16 v103, v5, v48
  v_dot2c_f32_bf16 v104, v5, v57
  v_dot2c_f32_bf16 v105, v5, v66
  v_dot2c_f32_bf16 v106, v5, v75
  s_waitcnt lgkmcnt(3)
  v_dot2c_f32_bf16 v107, v5, v84
  v_dot2c_f32_bf16 v100, v6, v22
  v_dot2c_f32_bf16 v101, v6, v31
  v_dot2c_f32_bf16 v102, v6, v40
  v_dot2c_f32_bf16 v103, v6, v49
  v_dot2c_f32_bf16 v104, v6, v58
  v_dot2c_f32_bf16 v105, v6, v67
  v_dot2c_f32_bf16 v106, v6, v76
  s_waitcnt lgkmcnt(2)
  v_dot2c_f32_bf16 v107, v6, v85
  v_dot2c_f32_bf16 v100, v7, v23
  v_dot2c_f32_bf16 v101, v7, v32
  v_dot2c_f32_bf16 v102, v7, v41
  v_dot2c_f32_bf16 v103, v7, v50
  v_dot2c_f32_bf16 v104, v7, v59
  v_dot2c_f32_bf16 v105, v7, v68
  v_dot2c_f32_bf16 v106, v7, v77
  s_waitcnt lgkmcnt(1)
  v_dot2c_f32_bf16 v107, v7, v86
  v_dot2c_f32_bf16 v100, v8, v24
  v_dot2c_f32_bf16 v101, v8, v33
  v_dot2c_f32_bf16 v102, v8, v42
  v_dot2c_f32_bf16 v103, v8, v51
  v_dot2c_f32_bf16 v104, v8, v60
  v_dot2c_f32_bf16 v105, v8, v69
  v_dot2c_f32_bf16 v106, v8, v78
  s_waitcnt lgkmcnt(0)
  v_dot2c_f32_bf16 v107, v8, v87
  ds_read_b32 v16, v219 offset:7512
  ds_read_b32 v17, v219 offset:7516
  ds_read_b32 v18, v219 offset:7520
  ds_read_b32 v19, v219 offset:7524
  ds_read_b32 v20, v219 offset:7528
  ds_read_b32 v21, v219 offset:7532
  ds_read_b32 v22, v219 offset:7536
  ds_read_b32 v23, v219 offset:7540
  ds_read_b32 v24, v219 offset:7544
  ds_read_b32 v25, v219 offset:6480
  ds_read_b32 v26, v219 offset:6484
  ds_read_b32 v27, v219 offset:6488
  ds_read_b32 v28, v219 offset:6492
  ds_read_b32 v29, v219 offset:6496
  ds_read_b32 v30, v219 offset:6500
  ds_read_b32 v31, v219 offset:6504
  ds_read_b32 v32, v219 offset:6508
  ds_read_b32 v33, v219 offset:6512
  ds_read_b32 v34, v219 offset:5448
  ds_read_b32 v35, v219 offset:5452
  ds_read_b32 v36, v219 offset:5456
  ds_read_b32 v37, v219 offset:5460
  ds_read_b32 v38, v219 offset:5464
  ds_read_b32 v39, v219 offset:5468
  ds_read_b32 v40, v219 offset:5472
  ds_read_b32 v41, v219 offset:5476
  ds_read_b32 v42, v219 offset:5480
  ds_read_b32 v43, v219 offset:4416
  ds_read_b32 v44, v219 offset:4420
  ds_read_b32 v45, v219 offset:4424
  ds_read_b32 v46, v219 offset:4428
  ds_read_b32 v47, v219 offset:4432
  ds_read_b32 v48, v219 offset:4436
  ds_read_b32 v49, v219 offset:4440
  ds_read_b32 v50, v219 offset:4444
  ds_read_b32 v51, v219 offset:4448
  ds_read_b32 v52, v219 offset:3384
  ds_read_b32 v53, v219 offset:3388
  ds_read_b32 v54, v219 offset:3392
  ds_read_b32 v55, v219 offset:3396
  ds_read_b32 v56, v219 offset:3400
  ds_read_b32 v57, v219 offset:3404
  ds_read_b32 v58, v219 offset:3408
  ds_read_b32 v59, v219 offset:3412
  ds_read_b32 v60, v219 offset:3416
  ds_read_b32 v61, v219 offset:2352
  ds_read_b32 v62, v219 offset:2356
  ds_read_b32 v63, v219 offset:2360
  ds_read_b32 v64, v219 offset:2364
  ds_read_b32 v65, v219 offset:2368
  ds_read_b32 v66, v219 offset:2372
  ds_read_b32 v67, v219 offset:2376
  ds_read_b32 v68, v219 offset:2380
  ds_read_b32 v69, v219 offset:2384
  ds_read_b32 v70, v219 offset:1320
  ds_read_b32 v71, v219 offset:1324
  ds_read_b32 v72, v219 offset:1328
  ds_read_b32 v73, v219 offset:1332
  ds_read_b32 v74, v219 offset:1336
  ds_read_b32 v75, v219 offset:1340
  ds_read_b32 v76, v219 offset:1344
  ds_read_b32 v77, v219 offset:1348
  ds_read_b32 v78, v219 offset:1352
  ds_read_b32 v79, v219 offset:288
  ds_read_b32 v80, v219 offset:292
  ds_read_b32 v81, v219 offset:296
  ds_read_b32 v82, v219 offset:300
  ds_read_b32 v83, v219 offset:304
  ds_read_b32 v84, v219 offset:308
  ds_read_b32 v85, v219 offset:312
  ds_read_b32 v86, v219 offset:316
  ds_read_b32 v87, v219 offset:320
  v_add_u32 v211, s66, v200
  v_mov_b32 v212, 0xf149f2ca
  v_mul_f32 v100, s57, v100
  v_mul_f32 v101, s57, v101
  v_mul_f32 v102, s57, v102
  v_mul_f32 v103, s57, v103
  v_mul_f32 v104, s57, v104
  v_mul_f32 v105, s57, v105
  v_mul_f32 v106, s57, v106
  v_mul_f32 v107, s57, v107
  v_cmp_gt_u32 vcc, 2, v211
  s_nop 1
  v_cndmask_b32 v101, v101, v212, vcc
  v_cmp_gt_u32 vcc, 4, v211
  s_nop 1
  v_cndmask_b32 v102, v102, v212, vcc
  v_cmp_gt_u32 vcc, 6, v211
  s_nop 1
  v_cndmask_b32 v103, v103, v212, vcc
  v_cmp_gt_u32 vcc, 8, v211
  s_nop 1
  v_cndmask_b32 v104, v104, v212, vcc
  v_cmp_gt_u32 vcc, 10, v211
  s_nop 1
  v_cndmask_b32 v105, v105, v212, vcc
  v_cmp_gt_u32 vcc, 12, v211
  s_nop 1
  v_cndmask_b32 v106, v106, v212, vcc
  v_cmp_gt_u32 vcc, 14, v211
  s_nop 1
  v_cndmask_b32 v107, v107, v212, vcc
  v_max3_f32 v213, v100, v101, v102
  v_max3_f32 v213, v213, v103, v104
  v_max3_f32 v213, v213, v105, v106
  v_max_f32 v213, v213, v107
  v_sub_f32 v100, v100, v213
  v_sub_f32 v101, v101, v213
  v_sub_f32 v102, v102, v213
  v_sub_f32 v103, v103, v213
  v_sub_f32 v104, v104, v213
  v_sub_f32 v105, v105, v213
  v_sub_f32 v106, v106, v213
  v_sub_f32 v107, v107, v213
  v_exp_f32 v100, v100
  v_exp_f32 v101, v101
  v_exp_f32 v102, v102
  v_exp_f32 v103, v103
  v_exp_f32 v104, v104
  v_exp_f32 v105, v105
  v_exp_f32 v106, v106
  v_exp_f32 v107, v107
  v_add_f32 v213, v100, v101
  v_add_f32 v213, v213, v102
  v_add_f32 v213, v213, v103
  v_add_f32 v213, v213, v104
  v_add_f32 v213, v213, v105
  v_add_f32 v213, v213, v106
  v_add_f32 v213, v213, v107
  v_rcp_f32 v213, v213
  v_mov_b32 v214, 0
  v_mul_f32 v100, v213, v100
  v_mul_f32 v101, v213, v101
  v_mul_f32 v102, v213, v102
  v_mul_f32 v103, v213, v103
  v_mul_f32 v104, v213, v104
  v_mul_f32 v105, v213, v105
  v_mul_f32 v106, v213, v106
  v_mul_f32 v107, v213, v107
  v_mov_b32 v112, 0
  v_mov_b32 v113, 0
  v_mov_b32 v114, 0
  v_mov_b32 v115, 0
  v_mov_b32 v116, 0
  v_mov_b32 v117, 0
  v_mov_b32 v118, 0
  v_mov_b32 v119, 0
  v_mov_b32 v120, 0
  v_mov_b32 v121, 0
  v_mov_b32 v122, 0
  v_mov_b32 v123, 0
  v_mov_b32 v124, 0
  v_mov_b32 v125, 0
  v_mov_b32 v126, 0
  v_mov_b32 v127, 0
  v_mov_b32 v128, 0
  v_mov_b32 v129, 0
  v_cvt_pk_bf16_f32 v0, v100, v214
  v_cvt_pk_bf16_f32 v1, v214, v100
  s_waitcnt lgkmcnt(15)
  v_dot2c_f32_bf16 v112, v16, v0
  v_dot2c_f32_bf16 v113, v16, v1
  v_dot2c_f32_bf16 v114, v17, v0
  v_dot2c_f32_bf16 v115, v17, v1
  v_dot2c_f32_bf16 v116, v18, v0
  v_dot2c_f32_bf16 v117, v18, v1
  v_dot2c_f32_bf16 v118, v19, v0
  v_dot2c_f32_bf16 v119, v19, v1
  v_dot2c_f32_bf16 v120, v20, v0
  v_dot2c_f32_bf16 v121, v20, v1
  v_dot2c_f32_bf16 v122, v21, v0
  v_dot2c_f32_bf16 v123, v21, v1
  v_dot2c_f32_bf16 v124, v22, v0
  v_dot2c_f32_bf16 v125, v22, v1
  v_dot2c_f32_bf16 v126, v23, v0
  v_dot2c_f32_bf16 v127, v23, v1
  v_dot2c_f32_bf16 v128, v24, v0
  v_dot2c_f32_bf16 v129, v24, v1
  v_cvt_pk_bf16_f32 v2, v101, v214
  v_cvt_pk_bf16_f32 v3, v214, v101
  v_dot2c_f32_bf16 v112, v25, v2
  v_dot2c_f32_bf16 v113, v25, v3
  v_dot2c_f32_bf16 v114, v26, v2
  v_dot2c_f32_bf16 v115, v26, v3
  v_dot2c_f32_bf16 v116, v27, v2
  v_dot2c_f32_bf16 v117, v27, v3
  v_dot2c_f32_bf16 v118, v28, v2
  v_dot2c_f32_bf16 v119, v28, v3
  v_dot2c_f32_bf16 v120, v29, v2
  v_dot2c_f32_bf16 v121, v29, v3
  v_dot2c_f32_bf16 v122, v30, v2
  v_dot2c_f32_bf16 v123, v30, v3
  v_dot2c_f32_bf16 v124, v31, v2
  v_dot2c_f32_bf16 v125, v31, v3
  v_dot2c_f32_bf16 v126, v32, v2
  v_dot2c_f32_bf16 v127, v32, v3
  v_dot2c_f32_bf16 v128, v33, v2
  v_dot2c_f32_bf16 v129, v33, v3
  v_cvt_pk_bf16_f32 v0, v102, v214
  v_cvt_pk_bf16_f32 v1, v214, v102
  v_dot2c_f32_bf16 v112, v34, v0
  v_dot2c_f32_bf16 v113, v34, v1
  v_dot2c_f32_bf16 v114, v35, v0
  v_dot2c_f32_bf16 v115, v35, v1
  v_dot2c_f32_bf16 v116, v36, v0
  v_dot2c_f32_bf16 v117, v36, v1
  v_dot2c_f32_bf16 v118, v37, v0
  v_dot2c_f32_bf16 v119, v37, v1
  v_dot2c_f32_bf16 v120, v38, v0
  v_dot2c_f32_bf16 v121, v38, v1
  v_dot2c_f32_bf16 v122, v39, v0
  v_dot2c_f32_bf16 v123, v39, v1
  v_dot2c_f32_bf16 v124, v40, v0
  v_dot2c_f32_bf16 v125, v40, v1
  v_dot2c_f32_bf16 v126, v41, v0
  v_dot2c_f32_bf16 v127, v41, v1
  v_dot2c_f32_bf16 v128, v42, v0
  v_dot2c_f32_bf16 v129, v42, v1
  v_cvt_pk_bf16_f32 v2, v103, v214
  v_cvt_pk_bf16_f32 v3, v214, v103
  v_dot2c_f32_bf16 v112, v43, v2
  v_dot2c_f32_bf16 v113, v43, v3
  v_dot2c_f32_bf16 v114, v44, v2
  v_dot2c_f32_bf16 v115, v44, v3
  v_dot2c_f32_bf16 v116, v45, v2
  v_dot2c_f32_bf16 v117, v45, v3
  v_dot2c_f32_bf16 v118, v46, v2
  v_dot2c_f32_bf16 v119, v46, v3
  v_dot2c_f32_bf16 v120, v47, v2
  v_dot2c_f32_bf16 v121, v47, v3
  v_dot2c_f32_bf16 v122, v48, v2
  v_dot2c_f32_bf16 v123, v48, v3
  v_dot2c_f32_bf16 v124, v49, v2
  v_dot2c_f32_bf16 v125, v49, v3
  v_dot2c_f32_bf16 v126, v50, v2
  v_dot2c_f32_bf16 v127, v50, v3
  v_dot2c_f32_bf16 v128, v51, v2
  v_dot2c_f32_bf16 v129, v51, v3
  v_cvt_pk_bf16_f32 v0, v104, v214
  v_cvt_pk_bf16_f32 v1, v214, v104
  v_dot2c_f32_bf16 v112, v52, v0
  v_dot2c_f32_bf16 v113, v52, v1
  v_dot2c_f32_bf16 v114, v53, v0
  v_dot2c_f32_bf16 v115, v53, v1
  v_dot2c_f32_bf16 v116, v54, v0
  v_dot2c_f32_bf16 v117, v54, v1
  v_dot2c_f32_bf16 v118, v55, v0
  v_dot2c_f32_bf16 v119, v55, v1
  v_dot2c_f32_bf16 v120, v56, v0
  v_dot2c_f32_bf16 v121, v56, v1
  v_dot2c_f32_bf16 v122, v57, v0
  v_dot2c_f32_bf16 v123, v57, v1
  v_dot2c_f32_bf16 v124, v58, v0
  v_dot2c_f32_bf16 v125, v58, v1
  v_dot2c_f32_bf16 v126, v59, v0
  v_dot2c_f32_bf16 v127, v59, v1
  v_dot2c_f32_bf16 v128, v60, v0
  v_dot2c_f32_bf16 v129, v60, v1
  v_cvt_pk_bf16_f32 v2, v105, v214
  v_cvt_pk_bf16_f32 v3, v214, v105
  v_dot2c_f32_bf16 v112, v61, v2
  v_dot2c_f32_bf16 v113, v61, v3
  v_dot2c_f32_bf16 v114, v62, v2
  v_dot2c_f32_bf16 v115, v62, v3
  v_dot2c_f32_bf16 v116, v63, v2
  v_dot2c_f32_bf16 v117, v63, v3
  v_dot2c_f32_bf16 v118, v64, v2
  v_dot2c_f32_bf16 v119, v64, v3
  v_dot2c_f32_bf16 v120, v65, v2
  v_dot2c_f32_bf16 v121, v65, v3
  v_dot2c_f32_bf16 v122, v66, v2
  v_dot2c_f32_bf16 v123, v66, v3
  v_dot2c_f32_bf16 v124, v67, v2
  v_dot2c_f32_bf16 v125, v67, v3
  v_dot2c_f32_bf16 v126, v68, v2
  v_dot2c_f32_bf16 v127, v68, v3
  v_dot2c_f32_bf16 v128, v69, v2
  v_dot2c_f32_bf16 v129, v69, v3
  v_cvt_pk_bf16_f32 v0, v106, v214
  v_cvt_pk_bf16_f32 v1, v214, v106
  v_dot2c_f32_bf16 v112, v70, v0
  v_dot2c_f32_bf16 v113, v70, v1
  v_dot2c_f32_bf16 v114, v71, v0
  v_dot2c_f32_bf16 v115, v71, v1
  v_dot2c_f32_bf16 v116, v72, v0
  v_dot2c_f32_bf16 v117, v72, v1
  s_waitcnt lgkmcnt(14)
  v_dot2c_f32_bf16 v118, v73, v0
  v_dot2c_f32_bf16 v119, v73, v1
  s_waitcnt lgkmcnt(13)
  v_dot2c_f32_bf16 v120, v74, v0
  v_dot2c_f32_bf16 v121, v74, v1
  s_waitcnt lgkmcnt(12)
  v_dot2c_f32_bf16 v122, v75, v0
  v_dot2c_f32_bf16 v123, v75, v1
  s_waitcnt lgkmcnt(11)
  v_dot2c_f32_bf16 v124, v76, v0
  v_dot2c_f32_bf16 v125, v76, v1
  s_waitcnt lgkmcnt(10)
  v_dot2c_f32_bf16 v126, v77, v0
  v_dot2c_f32_bf16 v127, v77, v1
  s_waitcnt lgkmcnt(9)
  v_dot2c_f32_bf16 v128, v78, v0
  v_dot2c_f32_bf16 v129, v78, v1
  v_cvt_pk_bf16_f32 v2, v107, v214
  v_cvt_pk_bf16_f32 v3, v214, v107
  s_waitcnt lgkmcnt(8)
  v_dot2c_f32_bf16 v112, v79, v2
  v_dot2c_f32_bf16 v113, v79, v3
  s_waitcnt lgkmcnt(7)
  v_dot2c_f32_bf16 v114, v80, v2
  v_dot2c_f32_bf16 v115, v80, v3
  s_waitcnt lgkmcnt(6)
  v_dot2c_f32_bf16 v116, v81, v2
  v_dot2c_f32_bf16 v117, v81, v3
  s_waitcnt lgkmcnt(5)
  v_dot2c_f32_bf16 v118, v82, v2
  v_dot2c_f32_bf16 v119, v82, v3
  s_waitcnt lgkmcnt(4)
  v_dot2c_f32_bf16 v120, v83, v2
  v_dot2c_f32_bf16 v121, v83, v3
  s_waitcnt lgkmcnt(3)
  v_dot2c_f32_bf16 v122, v84, v2
  v_dot2c_f32_bf16 v123, v84, v3
  s_waitcnt lgkmcnt(2)
  v_dot2c_f32_bf16 v124, v85, v2
  v_dot2c_f32_bf16 v125, v85, v3
  s_waitcnt lgkmcnt(1)
  v_dot2c_f32_bf16 v126, v86, v2
  v_dot2c_f32_bf16 v127, v86, v3
  s_waitcnt lgkmcnt(0)
  v_dot2c_f32_bf16 v128, v87, v2
  v_dot2c_f32_bf16 v129, v87, v3
  v_cvt_pk_bf16_f32 v132, v112, v113
  v_cvt_pk_bf16_f32 v133, v114, v115
  v_cvt_pk_bf16_f32 v134, v116, v117
  v_cvt_pk_bf16_f32 v135, v118, v119
  v_cvt_pk_bf16_f32 v136, v120, v121
  v_cvt_pk_bf16_f32 v137, v122, v123
  v_cvt_pk_bf16_f32 v138, v124, v125
  v_cvt_pk_bf16_f32 v139, v126, v127
  v_cvt_pk_bf16_f32 v140, v128, v129
  ds_write_b32 v220, v132 offset:0
  ds_write_b32 v220, v133 offset:4
  ds_write_b32 v220, v134 offset:8
  ds_write_b32 v220, v135 offset:12
  ds_write_b32 v220, v136 offset:16
  ds_write_b32 v220, v137 offset:20
  ds_write_b32 v220, v138 offset:24
  ds_write_b32 v220, v139 offset:28
  ds_write_b32 v220, v140 offset:32
  s_waitcnt lgkmcnt(0)
  s_barrier
  ds_read_b128 v[144:147], v218 offset:0
  ds_read_b128 v[148:151], v218 offset:1024
  ds_read_b128 v[152:155], v218 offset:2048
  s_waitcnt lgkmcnt(2)
  buffer_store_dwordx4 v[144:147], v218, s[8:11], s64 offen offset:0 sc1
  s_waitcnt lgkmcnt(1)
  buffer_store_dwordx4 v[148:151], v218, s[8:11], s64 offen offset:1024 sc1
  s_waitcnt lgkmcnt(0)
  buffer_store_dwordx4 v[152:155], v218, s[8:11], s64 offen offset:2048 sc1
  v_add_u32 v219, 33024, v219
  s_add_u32 s66, s66, 64
  s_add_u32 s64, s64, 9216
  ds_read_b32 v0, v219 offset:7224
  ds_read_b32 v1, v219 offset:7228
  ds_read_b32 v2, v219 offset:7232
  ds_read_b32 v3, v219 offset:7236
  ds_read_b32 v4, v219 offset:7240
  ds_read_b32 v5, v219 offset:7244
  ds_read_b32 v6, v219 offset:7248
  ds_read_b32 v7, v219 offset:7252
  ds_read_b32 v8, v219 offset:7256
  ds_read_b32 v16, v219 offset:7368
  ds_read_b32 v17, v219 offset:7372
  ds_read_b32 v18, v219 offset:7376
  ds_read_b32 v19, v219 offset:7380
  ds_read_b32 v20, v219 offset:7384
  ds_read_b32 v21, v219 offset:7388
  ds_read_b32 v22, v219 offset:7392
  ds_read_b32 v23, v219 offset:7396
  ds_read_b32 v24, v219 offset:7400
  ds_read_b32 v25, v219 offset:6336
  ds_read_b32 v26, v219 offset:6340
  ds_read_b32 v27, v219 offset:6344
  ds_read_b32 v28, v219 offset:6348
  ds_read_b32 v29, v219 offset:6352
  ds_read_b32 v30, v219 offset:6356
  ds_read_b32 v31, v219 offset:6360
  ds_read_b32 v32, v219 offset:6364
  ds_read_b32 v33, v219 offset:6368
  ds_read_b32 v34, v219 offset:5304
  ds_read_b32 v35, v219 offset:5308
  ds_read_b32 v36, v219 offset:5312
  ds_read_b32 v37, v219 offset:5316
  ds_read_b32 v38, v219 offset:5320
  ds_read_b32 v39, v219 offset:5324
  ds_read_b32 v40, v219 offset:5328
  ds_read_b32 v41, v219 offset:5332
  ds_read_b32 v42, v219 offset:5336
  ds_read_b32 v43, v219 offset:4272
  ds_read_b32 v44, v219 offset:4276
  ds_read_b32 v45, v219 offset:4280
  ds_read_b32 v46, v219 offset:4284
  ds_read_b32 v47, v219 offset:4288
  ds_read_b32 v48, v219 offset:4292
  ds_read_b32 v49, v219 offset:4296
  ds_read_b32 v50, v219 offset:4300
  ds_read_b32 v51, v219 offset:4304
  ds_read_b32 v52, v219 offset:3240
  ds_read_b32 v53, v219 offset:3244
  ds_read_b32 v54, v219 offset:3248
  ds_read_b32 v55, v219 offset:3252
  ds_read_b32 v56, v219 offset:3256
  ds_read_b32 v57, v219 offset:3260
  ds_read_b32 v58, v219 offset:3264
  ds_read_b32 v59, v219 offset:3268
  ds_read_b32 v60, v219 offset:3272
  ds_read_b32 v61, v219 offset:2208
  ds_read_b32 v62, v219 offset:2212
  ds_read_b32 v63, v219 offset:2216
  ds_read_b32 v64, v219 offset:2220
  ds_read_b32 v65, v219 offset:2224
  ds_read_b32 v66, v219 offset:2228
  ds_read_b32 v67, v219 offset:2232
  ds_read_b32 v68, v219 offset:2236
  ds_read_b32 v69, v219 offset:2240
  ds_read_b32 v70, v219 offset:1176
  ds_read_b32 v71, v219 offset:1180
  ds_read_b32 v72, v219 offset:1184
  ds_read_b32 v73, v219 offset:1188
  ds_read_b32 v74, v219 offset:1192
  ds_read_b32 v75, v219 offset:1196
  ds_read_b32 v76, v219 offset:1200
  ds_read_b32 v77, v219 offset:1204
  ds_read_b32 v78, v219 offset:1208
  ds_read_b32 v79, v219 offset:144
  ds_read_b32 v80, v219 offset:148
  ds_read_b32 v81, v219 offset:152
  ds_read_b32 v82, v219 offset:156
  ds_read_b32 v83, v219 offset:160
  ds_read_b32 v84, v219 offset:164
  ds_read_b32 v85, v219 offset:168
  ds_read_b32 v86, v219 offset:172
  ds_read_b32 v87, v219 offset:176
  v_mov_b32 v100, 0
  v_mov_b32 v101, 0
  v_mov_b32 v102, 0
  v_mov_b32 v103, 0
  v_mov_b32 v104, 0
  v_mov_b32 v105, 0
  v_mov_b32 v106, 0
  v_mov_b32 v107, 0
  s_waitcnt lgkmcnt(15)
  v_dot2c_f32_bf16 v100, v0, v16
  v_dot2c_f32_bf16 v101, v0, v25
  v_dot2c_f32_bf16 v102, v0, v34
  v_dot2c_f32_bf16 v103, v0, v43
  v_dot2c_f32_bf16 v104, v0, v52
  v_dot2c_f32_bf16 v105, v0, v61
  v_dot2c_f32_bf16 v106, v0, v70
  s_waitcnt lgkmcnt(8)
  v_dot2c_f32_bf16 v107, v0, v79
  v_dot2c_f32_bf16 v100, v1, v17
  v_dot2c_f32_bf16 v101, v1, v26
  v_dot2c_f32_bf16 v102, v1, v35
  v_dot2c_f32_bf16 v103, v1, v44
  v_dot2c_f32_bf16 v104, v1, v53
  v_dot2c_f32_bf16 v105, v1, v62
  v_dot2c_f32_bf16 v106, v1, v71
  s_waitcnt lgkmcnt(7)
  v_dot2c_f32_bf16 v107, v1, v80
  v_dot2c_f32_bf16 v100, v2, v18
  v_dot2c_f32_bf16 v101, v2, v27
  v_dot2c_f32_bf16 v102, v2, v36
  v_dot2c_f32_bf16 v103, v2, v45
  v_dot2c_f32_bf16 v104, v2, v54
  v_dot2c_f32_bf16 v105, v2, v63
  v_dot2c_f32_bf16 v106, v2, v72
  s_waitcnt lgkmcnt(6)
  v_dot2c_f32_bf16 v107, v2, v81
  v_dot2c_f32_bf16 v100, v3, v19
  v_dot2c_f32_bf16 v101, v3, v28
  v_dot2c_f32_bf16 v102, v3, v37
  v_dot2c_f32_bf16 v103, v3, v46
  v_dot2c_f32_bf16 v104, v3, v55
  v_dot2c_f32_bf16 v105, v3, v64
  v_dot2c_f32_bf16 v106, v3, v73
  s_waitcnt lgkmcnt(5)
  v_dot2c_f32_bf16 v107, v3, v82
  v_dot2c_f32_bf16 v100, v4, v20
  v_dot2c_f32_bf16 v101, v4, v29
  v_dot2c_f32_bf16 v102, v4, v38
  v_dot2c_f32_bf16 v103, v4, v47
  v_dot2c_f32_bf16 v104, v4, v56
  v_dot2c_f32_bf16 v105, v4, v65
  v_dot2c_f32_bf16 v106, v4, v74
  s_waitcnt lgkmcnt(4)
  v_dot2c_f32_bf16 v107, v4, v83
  v_dot2c_f32_bf16 v100, v5, v21
  v_dot2c_f32_bf16 v101, v5, v30
  v_dot2c_f32_bf16 v102, v5, v39
  v_dot2c_f32_bf16 v103, v5, v48
  v_dot2c_f32_bf16 v104, v5, v57
  v_dot2c_f32_bf16 v105, v5, v66
  v_dot2c_f32_bf16 v106, v5, v75
  s_waitcnt lgkmcnt(3)
  v_dot2c_f32_bf16 v107, v5, v84
  v_dot2c_f32_bf16 v100, v6, v22
  v_dot2c_f32_bf16 v101, v6, v31
  v_dot2c_f32_bf16 v102, v6, v40
  v_dot2c_f32_bf16 v103, v6, v49
  v_dot2c_f32_bf16 v104, v6, v58
  v_dot2c_f32_bf16 v105, v6, v67
  v_dot2c_f32_bf16 v106, v6, v76
  s_waitcnt lgkmcnt(2)
  v_dot2c_f32_bf16 v107, v6, v85
  v_dot2c_f32_bf16 v100, v7, v23
  v_dot2c_f32_bf16 v101, v7, v32
  v_dot2c_f32_bf16 v102, v7, v41
  v_dot2c_f32_bf16 v103, v7, v50
  v_dot2c_f32_bf16 v104, v7, v59
  v_dot2c_f32_bf16 v105, v7, v68
  v_dot2c_f32_bf16 v106, v7, v77
  s_waitcnt lgkmcnt(1)
  v_dot2c_f32_bf16 v107, v7, v86
  v_dot2c_f32_bf16 v100, v8, v24
  v_dot2c_f32_bf16 v101, v8, v33
  v_dot2c_f32_bf16 v102, v8, v42
  v_dot2c_f32_bf16 v103, v8, v51
  v_dot2c_f32_bf16 v104, v8, v60
  v_dot2c_f32_bf16 v105, v8, v69
  v_dot2c_f32_bf16 v106, v8, v78
  s_waitcnt lgkmcnt(0)
  v_dot2c_f32_bf16 v107, v8, v87
  ds_read_b32 v16, v219 offset:7512
  ds_read_b32 v17, v219 offset:7516
  ds_read_b32 v18, v219 offset:7520
  ds_read_b32 v19, v219 offset:7524
  ds_read_b32 v20, v219 offset:7528
  ds_read_b32 v21, v219 offset:7532
  ds_read_b32 v22, v219 offset:7536
  ds_read_b32 v23, v219 offset:7540
  ds_read_b32 v24, v219 offset:7544
  ds_read_b32 v25, v219 offset:6480
  ds_read_b32 v26, v219 offset:6484
  ds_read_b32 v27, v219 offset:6488
  ds_read_b32 v28, v219 offset:6492
  ds_read_b32 v29, v219 offset:6496
  ds_read_b32 v30, v219 offset:6500
  ds_read_b32 v31, v219 offset:6504
  ds_read_b32 v32, v219 offset:6508
  ds_read_b32 v33, v219 offset:6512
  ds_read_b32 v34, v219 offset:5448
  ds_read_b32 v35, v219 offset:5452
  ds_read_b32 v36, v219 offset:5456
  ds_read_b32 v37, v219 offset:5460
  ds_read_b32 v38, v219 offset:5464
  ds_read_b32 v39, v219 offset:5468
  ds_read_b32 v40, v219 offset:5472
  ds_read_b32 v41, v219 offset:5476
  ds_read_b32 v42, v219 offset:5480
  ds_read_b32 v43, v219 offset:4416
  ds_read_b32 v44, v219 offset:4420
  ds_read_b32 v45, v219 offset:4424
  ds_read_b32 v46, v219 offset:4428
  ds_read_b32 v47, v219 offset:4432
  ds_read_b32 v48, v219 offset:4436
  ds_read_b32 v49, v219 offset:4440
  ds_read_b32 v50, v219 offset:4444
  ds_read_b32 v51, v219 offset:4448
  ds_read_b32 v52, v219 offset:3384
  ds_read_b32 v53, v219 offset:3388
  ds_read_b32 v54, v219 offset:3392
  ds_read_b32 v55, v219 offset:3396
  ds_read_b32 v56, v219 offset:3400
  ds_read_b32 v57, v219 offset:3404
  ds_read_b32 v58, v219 offset:3408
  ds_read_b32 v59, v219 offset:3412
  ds_read_b32 v60, v219 offset:3416
  ds_read_b32 v61, v219 offset:2352
  ds_read_b32 v62, v219 offset:2356
  ds_read_b32 v63, v219 offset:2360
  ds_read_b32 v64, v219 offset:2364
  ds_read_b32 v65, v219 offset:2368
  ds_read_b32 v66, v219 offset:2372
  ds_read_b32 v67, v219 offset:2376
  ds_read_b32 v68, v219 offset:2380
  ds_read_b32 v69, v219 offset:2384
  ds_read_b32 v70, v219 offset:1320
  ds_read_b32 v71, v219 offset:1324
  ds_read_b32 v72, v219 offset:1328
  ds_read_b32 v73, v219 offset:1332
  ds_read_b32 v74, v219 offset:1336
  ds_read_b32 v75, v219 offset:1340
  ds_read_b32 v76, v219 offset:1344
  ds_read_b32 v77, v219 offset:1348
  ds_read_b32 v78, v219 offset:1352
  ds_read_b32 v79, v219 offset:288
  ds_read_b32 v80, v219 offset:292
  ds_read_b32 v81, v219 offset:296
  ds_read_b32 v82, v219 offset:300
  ds_read_b32 v83, v219 offset:304
  ds_read_b32 v84, v219 offset:308
  ds_read_b32 v85, v219 offset:312
  ds_read_b32 v86, v219 offset:316
  ds_read_b32 v87, v219 offset:320
  v_add_u32 v211, s66, v200
  v_mov_b32 v212, 0xf149f2ca
  v_mul_f32 v100, s57, v100
  v_mul_f32 v101, s57, v101
  v_mul_f32 v102, s57, v102
  v_mul_f32 v103, s57, v103
  v_mul_f32 v104, s57, v104
  v_mul_f32 v105, s57, v105
  v_mul_f32 v106, s57, v106
  v_mul_f32 v107, s57, v107
  v_cmp_gt_u32 vcc, 2, v211
  s_nop 1
  v_cndmask_b32 v101, v101, v212, vcc
  v_cmp_gt_u32 vcc, 4, v211
  s_nop 1
  v_cndmask_b32 v102, v102, v212, vcc
  v_cmp_gt_u32 vcc, 6, v211
  s_nop 1
  v_cndmask_b32 v103, v103, v212, vcc
  v_cmp_gt_u32 vcc, 8, v211
  s_nop 1
  v_cndmask_b32 v104, v104, v212, vcc
  v_cmp_gt_u32 vcc, 10, v211
  s_nop 1
  v_cndmask_b32 v105, v105, v212, vcc
  v_cmp_gt_u32 vcc, 12, v211
  s_nop 1
  v_cndmask_b32 v106, v106, v212, vcc
  v_cmp_gt_u32 vcc, 14, v211
  s_nop 1
  v_cndmask_b32 v107, v107, v212, vcc
  v_max3_f32 v213, v100, v101, v102
  v_max3_f32 v213, v213, v103, v104
  v_max3_f32 v213, v213, v105, v106
  v_max_f32 v213, v213, v107
  v_sub_f32 v100, v100, v213
  v_sub_f32 v101, v101, v213
  v_sub_f32 v102, v102, v213
  v_sub_f32 v103, v103, v213
  v_sub_f32 v104, v104, v213
  v_sub_f32 v105, v105, v213
  v_sub_f32 v106, v106, v213
  v_sub_f32 v107, v107, v213
  v_exp_f32 v100, v100
  v_exp_f32 v101, v101
  v_exp_f32 v102, v102
  v_exp_f32 v103, v103
  v_exp_f32 v104, v104
  v_exp_f32 v105, v105
  v_exp_f32 v106, v106
  v_exp_f32 v107, v107
  v_add_f32 v213, v100, v101
  v_add_f32 v213, v213, v102
  v_add_f32 v213, v213, v103
  v_add_f32 v213, v213, v104
  v_add_f32 v213, v213, v105
  v_add_f32 v213, v213, v106
  v_add_f32 v213, v213, v107
  v_rcp_f32 v213, v213
  v_mov_b32 v214, 0
  v_mul_f32 v100, v213, v100
  v_mul_f32 v101, v213, v101
  v_mul_f32 v102, v213, v102
  v_mul_f32 v103, v213, v103
  v_mul_f32 v104, v213, v104
  v_mul_f32 v105, v213, v105
  v_mul_f32 v106, v213, v106
  v_mul_f32 v107, v213, v107
  v_mov_b32 v112, 0
  v_mov_b32 v113, 0
  v_mov_b32 v114, 0
  v_mov_b32 v115, 0
  v_mov_b32 v116, 0
  v_mov_b32 v117, 0
  v_mov_b32 v118, 0
  v_mov_b32 v119, 0
  v_mov_b32 v120, 0
  v_mov_b32 v121, 0
  v_mov_b32 v122, 0
  v_mov_b32 v123, 0
  v_mov_b32 v124, 0
  v_mov_b32 v125, 0
  v_mov_b32 v126, 0
  v_mov_b32 v127, 0
  v_mov_b32 v128, 0
  v_mov_b32 v129, 0
  v_cvt_pk_bf16_f32 v0, v100, v214
  v_cvt_pk_bf16_f32 v1, v214, v100
  s_waitcnt lgkmcnt(15)
  v_dot2c_f32_bf16 v112, v16, v0
  v_dot2c_f32_bf16 v113, v16, v1
  v_dot2c_f32_bf16 v114, v17, v0
  v_dot2c_f32_bf16 v115, v17, v1
  v_dot2c_f32_bf16 v116, v18, v0
  v_dot2c_f32_bf16 v117, v18, v1
  v_dot2c_f32_bf16 v118, v19, v0
  v_dot2c_f32_bf16 v119, v19, v1
  v_dot2c_f32_bf16 v120, v20, v0
  v_dot2c_f32_bf16 v121, v20, v1
  v_dot2c_f32_bf16 v122, v21, v0
  v_dot2c_f32_bf16 v123, v21, v1
  v_dot2c_f32_bf16 v124, v22, v0
  v_dot2c_f32_bf16 v125, v22, v1
  v_dot2c_f32_bf16 v126, v23, v0
  v_dot2c_f32_bf16 v127, v23, v1
  v_dot2c_f32_bf16 v128, v24, v0
  v_dot2c_f32_bf16 v129, v24, v1
  v_cvt_pk_bf16_f32 v2, v101, v214
  v_cvt_pk_bf16_f32 v3, v214, v101
  v_dot2c_f32_bf16 v112, v25, v2
  v_dot2c_f32_bf16 v113, v25, v3
  v_dot2c_f32_bf16 v114, v26, v2
  v_dot2c_f32_bf16 v115, v26, v3
  v_dot2c_f32_bf16 v116, v27, v2
  v_dot2c_f32_bf16 v117, v27, v3
  v_dot2c_f32_bf16 v118, v28, v2
  v_dot2c_f32_bf16 v119, v28, v3
  v_dot2c_f32_bf16 v120, v29, v2
  v_dot2c_f32_bf16 v121, v29, v3
  v_dot2c_f32_bf16 v122, v30, v2
  v_dot2c_f32_bf16 v123, v30, v3
  v_dot2c_f32_bf16 v124, v31, v2
  v_dot2c_f32_bf16 v125, v31, v3
  v_dot2c_f32_bf16 v126, v32, v2
  v_dot2c_f32_bf16 v127, v32, v3
  v_dot2c_f32_bf16 v128, v33, v2
  v_dot2c_f32_bf16 v129, v33, v3
  v_cvt_pk_bf16_f32 v0, v102, v214
  v_cvt_pk_bf16_f32 v1, v214, v102
  v_dot2c_f32_bf16 v112, v34, v0
  v_dot2c_f32_bf16 v113, v34, v1
  v_dot2c_f32_bf16 v114, v35, v0
  v_dot2c_f32_bf16 v115, v35, v1
  v_dot2c_f32_bf16 v116, v36, v0
  v_dot2c_f32_bf16 v117, v36, v1
  v_dot2c_f32_bf16 v118, v37, v0
  v_dot2c_f32_bf16 v119, v37, v1
  v_dot2c_f32_bf16 v120, v38, v0
  v_dot2c_f32_bf16 v121, v38, v1
  v_dot2c_f32_bf16 v122, v39, v0
  v_dot2c_f32_bf16 v123, v39, v1
  v_dot2c_f32_bf16 v124, v40, v0
  v_dot2c_f32_bf16 v125, v40, v1
  v_dot2c_f32_bf16 v126, v41, v0
  v_dot2c_f32_bf16 v127, v41, v1
  v_dot2c_f32_bf16 v128, v42, v0
  v_dot2c_f32_bf16 v129, v42, v1
  v_cvt_pk_bf16_f32 v2, v103, v214
  v_cvt_pk_bf16_f32 v3, v214, v103
  v_dot2c_f32_bf16 v112, v43, v2
  v_dot2c_f32_bf16 v113, v43, v3
  v_dot2c_f32_bf16 v114, v44, v2
  v_dot2c_f32_bf16 v115, v44, v3
  v_dot2c_f32_bf16 v116, v45, v2
  v_dot2c_f32_bf16 v117, v45, v3
  v_dot2c_f32_bf16 v118, v46, v2
  v_dot2c_f32_bf16 v119, v46, v3
  v_dot2c_f32_bf16 v120, v47, v2
  v_dot2c_f32_bf16 v121, v47, v3
  v_dot2c_f32_bf16 v122, v48, v2
  v_dot2c_f32_bf16 v123, v48, v3
  v_dot2c_f32_bf16 v124, v49, v2
  v_dot2c_f32_bf16 v125, v49, v3
  v_dot2c_f32_bf16 v126, v50, v2
  v_dot2c_f32_bf16 v127, v50, v3
  v_dot2c_f32_bf16 v128, v51, v2
  v_dot2c_f32_bf16 v129, v51, v3
  v_cvt_pk_bf16_f32 v0, v104, v214
  v_cvt_pk_bf16_f32 v1, v214, v104
  v_dot2c_f32_bf16 v112, v52, v0
  v_dot2c_f32_bf16 v113, v52, v1
  v_dot2c_f32_bf16 v114, v53, v0
  v_dot2c_f32_bf16 v115, v53, v1
  v_dot2c_f32_bf16 v116, v54, v0
  v_dot2c_f32_bf16 v117, v54, v1
  v_dot2c_f32_bf16 v118, v55, v0
  v_dot2c_f32_bf16 v119, v55, v1
  v_dot2c_f32_bf16 v120, v56, v0
  v_dot2c_f32_bf16 v121, v56, v1
  v_dot2c_f32_bf16 v122, v57, v0
  v_dot2c_f32_bf16 v123, v57, v1
  v_dot2c_f32_bf16 v124, v58, v0
  v_dot2c_f32_bf16 v125, v58, v1
  v_dot2c_f32_bf16 v126, v59, v0
  v_dot2c_f32_bf16 v127, v59, v1
  v_dot2c_f32_bf16 v128, v60, v0
  v_dot2c_f32_bf16 v129, v60, v1
  v_cvt_pk_bf16_f32 v2, v105, v214
  v_cvt_pk_bf16_f32 v3, v214, v105
  v_dot2c_f32_bf16 v112, v61, v2
  v_dot2c_f32_bf16 v113, v61, v3
  v_dot2c_f32_bf16 v114, v62, v2
  v_dot2c_f32_bf16 v115, v62, v3
  v_dot2c_f32_bf16 v116, v63, v2
  v_dot2c_f32_bf16 v117, v63, v3
  v_dot2c_f32_bf16 v118, v64, v2
  v_dot2c_f32_bf16 v119, v64, v3
  v_dot2c_f32_bf16 v120, v65, v2
  v_dot2c_f32_bf16 v121, v65, v3
  v_dot2c_f32_bf16 v122, v66, v2
  v_dot2c_f32_bf16 v123, v66, v3
  v_dot2c_f32_bf16 v124, v67, v2
  v_dot2c_f32_bf16 v125, v67, v3
  v_dot2c_f32_bf16 v126, v68, v2
  v_dot2c_f32_bf16 v127, v68, v3
  v_dot2c_f32_bf16 v128, v69, v2
  v_dot2c_f32_bf16 v129, v69, v3
  v_cvt_pk_bf16_f32 v0, v106, v214
  v_cvt_pk_bf16_f32 v1, v214, v106
  v_dot2c_f32_bf16 v112, v70, v0
  v_dot2c_f32_bf16 v113, v70, v1
  v_dot2c_f32_bf16 v114, v71, v0
  v_dot2c_f32_bf16 v115, v71, v1
  v_dot2c_f32_bf16 v116, v72, v0
  v_dot2c_f32_bf16 v117, v72, v1
  s_waitcnt lgkmcnt(14)
  v_dot2c_f32_bf16 v118, v73, v0
  v_dot2c_f32_bf16 v119, v73, v1
  s_waitcnt lgkmcnt(13)
  v_dot2c_f32_bf16 v120, v74, v0
  v_dot2c_f32_bf16 v121, v74, v1
  s_waitcnt lgkmcnt(12)
  v_dot2c_f32_bf16 v122, v75, v0
  v_dot2c_f32_bf16 v123, v75, v1
  s_waitcnt lgkmcnt(11)
  v_dot2c_f32_bf16 v124, v76, v0
  v_dot2c_f32_bf16 v125, v76, v1
  s_waitcnt lgkmcnt(10)
  v_dot2c_f32_bf16 v126, v77, v0
  v_dot2c_f32_bf16 v127, v77, v1
  s_waitcnt lgkmcnt(9)
  v_dot2c_f32_bf16 v128, v78, v0
  v_dot2c_f32_bf16 v129, v78, v1
  v_cvt_pk_bf16_f32 v2, v107, v214
  v_cvt_pk_bf16_f32 v3, v214, v107
  s_waitcnt lgkmcnt(8)
  v_dot2c_f32_bf16 v112, v79, v2
  v_dot2c_f32_bf16 v113, v79, v3
  s_waitcnt lgkmcnt(7)
  v_dot2c_f32_bf16 v114, v80, v2
  v_dot2c_f32_bf16 v115, v80, v3
  s_waitcnt lgkmcnt(6)
  v_dot2c_f32_bf16 v116, v81, v2
  v_dot2c_f32_bf16 v117, v81, v3
  s_waitcnt lgkmcnt(5)
  v_dot2c_f32_bf16 v118, v82, v2
  v_dot2c_f32_bf16 v119, v82, v3
  s_waitcnt lgkmcnt(4)
  v_dot2c_f32_bf16 v120, v83, v2
  v_dot2c_f32_bf16 v121, v83, v3
  s_waitcnt lgkmcnt(3)
  v_dot2c_f32_bf16 v122, v84, v2
  v_dot2c_f32_bf16 v123, v84, v3
  s_waitcnt lgkmcnt(2)
  v_dot2c_f32_bf16 v124, v85, v2
  v_dot2c_f32_bf16 v125, v85, v3
  s_waitcnt lgkmcnt(1)
  v_dot2c_f32_bf16 v126, v86, v2
  v_dot2c_f32_bf16 v127, v86, v3
  s_waitcnt lgkmcnt(0)
  v_dot2c_f32_bf16 v128, v87, v2
  v_dot2c_f32_bf16 v129, v87, v3
  v_cvt_pk_bf16_f32 v132, v112, v113
  v_cvt_pk_bf16_f32 v133, v114, v115
  v_cvt_pk_bf16_f32 v134, v116, v117
  v_cvt_pk_bf16_f32 v135, v118, v119
  v_cvt_pk_bf16_f32 v136, v120, v121
  v_cvt_pk_bf16_f32 v137, v122, v123
  v_cvt_pk_bf16_f32 v138, v124, v125
  v_cvt_pk_bf16_f32 v139, v126, v127
  v_cvt_pk_bf16_f32 v140, v128, v129
  ds_write_b32 v220, v132 offset:16384
  ds_write_b32 v220, v133 offset:16388
  ds_write_b32 v220, v134 offset:16392
  ds_write_b32 v220, v135 offset:16396
  ds_write_b32 v220, v136 offset:16400
  ds_write_b32 v220, v137 offset:16404
  ds_write_b32 v220, v138 offset:16408
  ds_write_b32 v220, v139 offset:16412
  ds_write_b32 v220, v140 offset:16416
  s_waitcnt lgkmcnt(0)
  s_barrier
  ds_read_b128 v[144:147], v218 offset:16384
  ds_read_b128 v[148:151], v218 offset:17408
  ds_read_b128 v[152:155], v218 offset:18432
  s_waitcnt lgkmcnt(2)
  buffer_store_dwordx4 v[144:147], v218, s[8:11], s64 offen offset:0 sc1
  s_waitcnt lgkmcnt(1)
  buffer_store_dwordx4 v[148:151], v218, s[8:11], s64 offen offset:1024 sc1
  s_waitcnt lgkmcnt(0)
  buffer_store_dwordx4 v[152:155], v218, s[8:11], s64 offen offset:2048 sc1
  s_mov_b32 s56, 36
  s_waitcnt vmcnt(0)
  s_barrier
  s_cmp_eq_u32 s52, 0
  s_cbranch_scc0 A_sig
  v_mov_b32 v211, 1
  v_mov_b32 v212, 0
  s_mov_b64 exec, 1
  buffer_atomic_add v211, v212, s[12:15], s56 offen
  s_mov_b64 exec, -1
A_sig:
  s_and_b32 s54, s53, 31
  s_cmp_lt_u32 s54, 27
  s_cbranch_scc0 L_exit
  s_and_b32 s54, s53, 31
  s_mul_i32 s68, s54, 57
  s_lshr_b32 s68, s68, 9
  s_mul_i32 s56, s68, 9
  s_sub_u32 s70, s54, s56
  s_bfe_u32 s55, s53, 0x10005
  s_mul_i32 s55, s55, 9
  s_add_u32 s70, s70, s55
  s_bfe_u32 s69, s53, 0x10006
  v_lshrrev_b32 v211, 2, v200
  v_mul_u32_u24 v211, 1152, v211
  v_and_b32 v212, 3, v200
  v_lshl_add_u32 v207, v212, 4, v211
  s_lshl_b32 s54, s70, 6
  s_mul_i32 s55, s52, 1179648
  s_add_u32 s62, s54, s55
  s_mul_i32 s55, s52, 184320
  s_add_u32 s63, s54, s55
  s_mul_i32 s61, s52, 40960
  v_bfe_u32 v211, v200, 2, 2
  v_lshlrev_b32 v212, 4, v212
  v_add_u32 v212, s61, v212
  v_lshl_add_u32 v212, v211, 6, v212
  v_lshrrev_b32 v213, 4, v200
  v_lshl_add_u32 v210, v213, 9, v212
  v_lshrrev_b32 v214, 5, v200
  v_lshl_add_u32 v209, v214, 10, v212
  v_and_b32 v214, 1, v213
  v_lshl_add_u32 v209, v214, 8, v209
  s_add_u32 m0, s61, 0
  s_add_u32 s54, s62, 0
  buffer_load_dwordx4 v207, s[28:31], s54 offen lds
  s_add_u32 m0, s61, 1024
  s_add_u32 s54, s62, 18432
  buffer_load_dwordx4 v207, s[28:31], s54 offen lds
  s_add_u32 m0, s61, 2048
  s_add_u32 s54, s62, 36864
  buffer_load_dwordx4 v207, s[28:31], s54 offen lds
  s_add_u32 m0, s61, 3072
  s_add_u32 s54, s62, 55296
  buffer_load_dwordx4 v207, s[28:31], s54 offen lds
  s_add_u32 m0, s61, 4096
  s_add_u32 s54, s62, 73728
  buffer_load_dwordx4 v207, s[28:31], s54 offen lds
  s_add_u32 m0, s61, 5120
  s_add_u32 s54, s62, 92160
  buffer_load_dwordx4 v207, s[28:31], s54 offen lds
  s_add_u32 m0, s61, 6144
  s_add_u32 s54, s62, 110592
  buffer_load_dwordx4 v207, s[28:31], s54 offen lds
  s_add_u32 m0, s61, 7168
  s_add_u32 s54, s62, 129024
  buffer_load_dwordx4 v207, s[28:31], s54 offen lds
  s_add_u32 m0, s61, 8192
  s_add_u32 s54, s62, 147456
  buffer_load_dwordx4 v207, s[28:31], s54 offen lds
  s_add_u32 m0, s61, 9216
  s_add_u32 s54, s62, 165888
  buffer_load_dwordx4 v207, s[28:31], s54 offen lds
  s_add_u32 m0, s61, 10240
  s_add_u32 s54, s62, 184320
  buffer_load_dwordx4 v207, s[28:31], s54 offen lds
  s_add_u32 m0, s61, 11264
  s_add_u32 s54, s62, 202752
  buffer_load_dwordx4 v207, s[28:31], s54 offen lds
  s_add_u32 m0, s61, 12288
  s_add_u32 s54, s62, 221184
  buffer_load_dwordx4 v207, s[28:31], s54 offen lds
  s_add_u32 m0, s61, 13312
  s_add_u32 s54, s62, 239616
  buffer_load_dwordx4 v207, s[28:31], s54 offen lds
  s_add_u32 m0, s61, 14336
  s_add_u32 s54, s62, 258048
  buffer_load_dwordx4 v207, s[28:31], s54 offen lds
  s_add_u32 m0, s61, 15360
  s_add_u32 s54, s62, 276480
  buffer_load_dwordx4 v207, s[28:31], s54 offen lds
  s_add_u32 m0, s61, 16384
  s_add_u32 s54, s62, 294912
  buffer_load_dwordx4 v207, s[28:31], s54 offen lds
  s_add_u32 m0, s61, 17408
  s_add_u32 s54, s62, 313344
  buffer_load_dwordx4 v207, s[28:31], s54 offen lds
  s_add_u32 m0, s61, 18432
  s_add_u32 s54, s62, 331776
  buffer_load_dwordx4 v207, s[28:31], s54 offen lds
  s_add_u32 m0, s61, 19456
  s_add_u32 s54, s62, 350208
  buffer_load_dwordx4 v207, s[28:31], s54 offen lds
  s_add_u32 m0, s61, 20480
  s_add_u32 s54, s62, 368640
  buffer_load_dwordx4 v207, s[28:31], s54 offen lds
  s_add_u32 m0, s61, 21504
  s_add_u32 s54, s62, 387072
  buffer_load_dwordx4 v207, s[28:31], s54 offen lds
  s_add_u32 m0, s61, 22528
  s_add_u32 s54, s62, 405504
  buffer_load_dwordx4 v207, s[28:31], s54 offen lds
  s_add_u32 m0, s61, 23552
  s_add_u32 s54, s62, 423936
  buffer_load_dwordx4 v207, s[28:31], s54 offen lds
  s_add_u32 m0, s61, 24576
  s_add_u32 s54, s62, 442368
  buffer_load_dwordx4 v207, s[28:31], s54 offen lds
  s_add_u32 m0, s61, 25600
  s_add_u32 s54, s62, 460800
  buffer_load_dwordx4 v207, s[28:31], s54 offen lds
  s_add_u32 m0, s61, 26624
  s_add_u32 s54, s62, 479232
  buffer_load_dwordx4 v207, s[28:31], s54 offen lds
  s_add_u32 m0, s61, 27648
  s_add_u32 s54, s62, 497664
  buffer_load_dwordx4 v207, s[28:31], s54 offen lds
  s_add_u32 m0, s61, 28672
  s_add_u32 s54, s62, 516096
  buffer_load_dwordx4 v207, s[28:31], s54 offen lds
  s_add_u32 m0, s61, 29696
  s_add_u32 s54, s62, 534528
  buffer_load_dwordx4 v207, s[28:31], s54 offen lds
  s_add_u32 m0, s61, 30720
  s_add_u32 s54, s62, 552960
  buffer_load_dwordx4 v207, s[28:31], s54 offen lds
  s_add_u32 m0, s61, 31744
  s_add_u32 s54, s62, 571392
  buffer_load_dwordx4 v207, s[28:31], s54 offen lds
  s_add_u32 m0, s61, 32768
  s_add_u32 s54, s62, 589824
  buffer_load_dwordx4 v207, s[28:31], s54 offen lds
  s_add_u32 m0, s61, 33792
  s_add_u32 s54, s62, 608256
  buffer_load_dwordx4 v207, s[28:31], s54 offen lds
  s_add_u32 m0, s61, 34816
  s_add_u32 s54, s62, 626688
  buffer_load_dwordx4 v207, s[28:31], s54 offen lds
  s_add_u32 m0, s61, 35840
  s_add_u32 s54, s62, 645120
  buffer_load_dwordx4 v207, s[28:31], s54 offen lds
  s_add_u32 m0, s61, 36864
  s_add_u32 s54, s62, 663552
  buffer_load_dwordx4 v207, s[28:31], s54 offen lds
  s_add_u32 m0, s61, 37888
  s_add_u32 s54, s62, 681984
  buffer_load_dwordx4 v207, s[28:31], s54 offen lds
  s_waitcnt vmcnt(36) lgkmcnt(0)
  s_add_u32 m0, s61, 38912
  s_add_u32 s54, s62, 700416
  buffer_load_dwordx4 v207, s[28:31], s54 offen lds
  s_add_u32 m0, s61, 39936
  s_add_u32 s54, s62, 718848
  buffer_load_dwordx4 v207, s[28:31], s54 offen lds
  ds_read_b64_tr_b16 a[0:1], v209 offset:0
  ds_read_b64_tr_b16 a[2:3], v209 offset:512
  ds_read_b64_tr_b16 a[4:5], v209 offset:8
  ds_read_b64_tr_b16 a[6:7], v209 offset:520
  s_waitcnt vmcnt(36) lgkmcnt(0)
  s_add_u32 m0, s61, 0
  s_add_u32 s54, s62, 737280
  buffer_load_dwordx4 v207, s[28:31], s54 offen lds
  s_add_u32 m0, s61, 1024
  s_add_u32 s54, s62, 755712
  buffer_load_dwordx4 v207, s[28:31], s54 offen lds
  ds_read_b64_tr_b16 a[8:9], v209 offset:2048
  ds_read_b64_tr_b16 a[10:11], v209 offset:2560
  ds_read_b64_tr_b16 a[12:13], v209 offset:2056
  ds_read_b64_tr_b16 a[14:15], v209 offset:2568
  s_waitcnt vmcnt(36) lgkmcnt(0)
  s_add_u32 m0, s61, 2048
  s_add_u32 s54, s62, 774144
  buffer_load_dwordx4 v207, s[28:31], s54 offen lds
  s_add_u32 m0, s61, 3072
  s_add_u32 s54, s62, 792576
  buffer_load_dwordx4 v207, s[28:31], s54 offen lds
  ds_read_b64_tr_b16 a[16:17], v209 offset:4096
  ds_read_b64_tr_b16 a[18:19], v209 offset:4608
  ds_read_b64_tr_b16 a[20:21], v209 offset:4104
  ds_read_b64_tr_b16 a[22:23], v209 offset:4616
  s_waitcnt vmcnt(36) lgkmcnt(0)
  s_add_u32 m0, s61, 4096
  s_add_u32 s54, s62, 811008
  buffer_load_dwordx4 v207, s[28:31], s54 offen lds
  s_add_u32 m0, s61, 5120
  s_add_u32 s54, s62, 829440
  buffer_load_dwordx4 v207, s[28:31], s54 offen lds
  ds_read_b64_tr_b16 a[24:25], v209 offset:6144
  ds_read_b64_tr_b16 a[26:27], v209 offset:6656
  ds_read_b64_tr_b16 a[28:29], v209 offset:6152
  ds_read_b64_tr_b16 a[30:31], v209 offset:6664
  s_waitcnt vmcnt(36) lgkmcnt(0)
  s_add_u32 m0, s61, 6144
  s_add_u32 s54, s62, 847872
  buffer_load_dwordx4 v207, s[28:31], s54 offen lds
  s_add_u32 m0, s61, 7168
  s_add_u32 s54, s62, 866304
  buffer_load_dwordx4 v207, s[28:31], s54 offen lds
  ds_read_b64_tr_b16 a[32:33], v209 offset:8192
  ds_read_b64_tr_b16 a[34:35], v209 offset:8704
  ds_read_b64_tr_b16 a[36:37], v209 offset:8200
  ds_read_b64_tr_b16 a[38:39], v209 offset:8712
  s_waitcnt vmcnt(36) lgkmcnt(0)
  s_add_u32 m0, s61, 8192
  s_add_u32 s54, s62, 884736
  buffer_load_dwordx4 v207, s[28:31], s54 offen lds
  s_add_u32 m0, s61, 9216
  s_add_u32 s54, s62, 903168
  buffer_load_dwordx4 v207, s[28:31], s54 offen lds
  ds_read_b64_tr_b16 a[40:41], v209 offset:10240
  ds_read_b64_tr_b16 a[42:43], v209 offset:10752
  ds_read_b64_tr_b16 a[44:45], v209 offset:10248
  ds_read_b64_tr_b16 a[46:47], v209 offset:10760
  s_waitcnt vmcnt(36) lgkmcnt(0)
  s_add_u32 m0, s61, 10240
  s_add_u32 s54, s62, 921600
  buffer_load_dwordx4 v207, s[28:31], s54 offen lds
  s_add_u32 m0, s61, 11264
  s_add_u32 s54, s62, 940032
  buffer_load_dwordx4 v207, s[28:31], s54 offen lds
  ds_read_b64_tr_b16 a[48:49], v209 offset:12288
  ds_read_b64_tr_b16 a[50:51], v209 offset:12800
  ds_read_b64_tr_b16 a[52:53], v209 offset:12296
  ds_read_b64_tr_b16 a[54:55], v209 offset:12808
  s_waitcnt vmcnt(36) lgkmcnt(0)
  s_add_u32 m0, s61, 12288
  s_add_u32 s54, s62, 958464
  buffer_load_dwordx4 v207, s[28:31], s54 offen lds
  s_add_u32 m0, s61, 13312
  s_add_u32 s54, s62, 976896
  buffer_load_dwordx4 v207, s[28:31], s54 offen lds
  ds_read_b64_tr_b16 a[56:57], v209 offset:14336
  ds_read_b64_tr_b16 a[58:59], v209 offset:14848
  ds_read_b64_tr_b16 a[60:61], v209 offset:14344
  ds_read_b64_tr_b16 a[62:63], v209 offset:14856
  s_waitcnt vmcnt(36) lgkmcnt(0)
  s_add_u32 m0, s61, 14336
  s_add_u32 s54, s62, 995328
  buffer_load_dwordx4 v207, s[28:31], s54 offen lds
  s_add_u32 m0, s61, 15360
  s_add_u32 s54, s62, 1013760
  buffer_load_dwordx4 v207, s[28:31], s54 offen lds
  ds_read_b64_tr_b16 a[64:65], v209 offset:16384
  ds_read_b64_tr_b16 a[66:67], v209 offset:16896
  ds_read_b64_tr_b16 a[68:69], v209 offset:16392
  ds_read_b64_tr_b16 a[70:71], v209 offset:16904
  s_waitcnt vmcnt(36) lgkmcnt(0)
  s_add_u32 m0, s61, 16384
  s_add_u32 s54, s62, 1032192
  buffer_load_dwordx4 v207, s[28:31], s54 offen lds
  s_add_u32 m0, s61, 17408
  s_add_u32 s54, s62, 1050624
  buffer_load_dwordx4 v207, s[28:31], s54 offen lds
  ds_read_b64_tr_b16 a[72:73], v209 offset:18432
  ds_read_b64_tr_b16 a[74:75], v209 offset:18944
  ds_read_b64_tr_b16 a[76:77], v209 offset:18440
  ds_read_b64_tr_b16 a[78:79], v209 offset:18952
  s_waitcnt vmcnt(36) lgkmcnt(0)
  s_add_u32 m0, s61, 18432
  s_add_u32 s54, s62, 1069056
  buffer_load_dwordx4 v207, s[28:31], s54 offen lds
  s_add_u32 m0, s61, 19456
  s_add_u32 s54, s62, 1087488
  buffer_load_dwordx4 v207, s[28:31], s54 offen lds
  ds_read_b64_tr_b16 a[80:81], v209 offset:20480
  ds_read_b64_tr_b16 a[82:83], v209 offset:20992
  ds_read_b64_tr_b16 a[84:85], v209 offset:20488
  ds_read_b64_tr_b16 a[86:87], v209 offset:21000
  s_waitcnt vmcnt(36) lgkmcnt(0)
  s_add_u32 m0, s61, 20480
  s_add_u32 s54, s62, 1105920
  buffer_load_dwordx4 v207, s[28:31], s54 offen lds
  s_add_u32 m0, s61, 21504
  s_add_u32 s54, s62, 1124352
  buffer_load_dwordx4 v207, s[28:31], s54 offen lds
  ds_read_b64_tr_b16 a[88:89], v209 offset:22528
  ds_read_b64_tr_b16 a[90:91], v209 offset:23040
  ds_read_b64_tr_b16 a[92:93], v209 offset:22536
  ds_read_b64_tr_b16 a[94:95], v209 offset:23048
  s_waitcnt vmcnt(36) lgkmcnt(0)
  s_add_u32 m0, s61, 22528
  s_add_u32 s54, s62, 1142784
  buffer_load_dwordx4 v207, s[28:31], s54 offen lds
  s_add_u32 m0, s61, 23552
  s_add_u32 s54, s62, 1161216
  buffer_load_dwordx4 v207, s[28:31], s54 offen lds
  ds_read_b64_tr_b16 a[96:97], v209 offset:24576
  ds_read_b64_tr_b16 a[98:99], v209 offset:25088
  ds_read_b64_tr_b16 a[100:101], v209 offset:24584
  ds_read_b64_tr_b16 a[102:103], v209 offset:25096
  s_waitcnt vmcnt(36) lgkmcnt(0)
  s_add_u32 m0, s61, 24576
  s_add_u32 s54, s63, 0
  buffer_load_dwordx4 v207, s[40:43], s54 offen lds
  s_add_u32 m0, s61, 25600
  s_add_u32 s54, s63, 18432
  buffer_load_dwordx4 v207, s[40:43], s54 offen lds
  ds_read_b64_tr_b16 a[104:105], v209 offset:26624
  ds_read_b64_tr_b16 a[106:107], v209 offset:27136
  ds_read_b64_tr_b16 a[108:109], v209 offset:26632
  ds_read_b64_tr_b16 a[110:111], v209 offset:27144
  s_waitcnt vmcnt(36) lgkmcnt(0)
  s_add_u32 m0, s61, 26624
  s_add_u32 s54, s63, 36864
  buffer_load_dwordx4 v207, s[40:43], s54 offen lds
  s_add_u32 m0, s61, 27648
  s_add_u32 s54, s63, 55296
  buffer_load_dwordx4 v207, s[40:43], s54 offen lds
  ds_read_b64_tr_b16 a[112:113], v209 offset:28672
  ds_read_b64_tr_b16 a[114:115], v209 offset:29184
  ds_read_b64_tr_b16 a[116:117], v209 offset:28680
  ds_read_b64_tr_b16 a[118:119], v209 offset:29192
  s_waitcnt vmcnt(36) lgkmcnt(0)
  s_add_u32 m0, s61, 28672
  s_add_u32 s54, s63, 73728
  buffer_load_dwordx4 v207, s[40:43], s54 offen lds
  s_add_u32 m0, s61, 29696
  s_add_u32 s54, s63, 92160
  buffer_load_dwordx4 v207, s[40:43], s54 offen lds
  ds_read_b64_tr_b16 a[120:121], v209 offset:30720
  ds_read_b64_tr_b16 a[122:123], v209 offset:31232
  ds_read_b64_tr_b16 a[124:125], v209 offset:30728
  ds_read_b64_tr_b16 a[126:127], v209 offset:31240
  s_waitcnt vmcnt(36) lgkmcnt(0)
  s_add_u32 m0, s61, 30720
  s_add_u32 s54, s63, 110592
  buffer_load_dwordx4 v207, s[40:43], s54 offen lds
  s_add_u32 m0, s61, 31744
  s_add_u32 s54, s63, 129024
  buffer_load_dwordx4 v207, s[40:43], s54 offen lds
  ds_read_b64_tr_b16 a[128:129], v209 offset:32768
  ds_read_b64_tr_b16 a[130:131], v209 offset:33280
  ds_read_b64_tr_b16 a[132:133], v209 offset:32776
  ds_read_b64_tr_b16 a[134:135], v209 offset:33288
  s_waitcnt vmcnt(36) lgkmcnt(0)
  s_add_u32 m0, s61, 32768
  s_add_u32 s54, s63, 147456
  buffer_load_dwordx4 v207, s[40:43], s54 offen lds
  s_add_u32 m0, s61, 33792
  s_add_u32 s54, s63, 165888
  buffer_load_dwordx4 v207, s[40:43], s54 offen lds
  ds_read_b64_tr_b16 a[136:137], v209 offset:34816
  ds_read_b64_tr_b16 a[138:139], v209 offset:35328
  ds_read_b64_tr_b16 a[140:141], v209 offset:34824
  ds_read_b64_tr_b16 a[142:143], v209 offset:35336
  s_waitcnt vmcnt(36) lgkmcnt(0)
  ds_read_b64_tr_b16 a[144:145], v209 offset:36864
  ds_read_b64_tr_b16 a[146:147], v209 offset:37376
  ds_read_b64_tr_b16 a[148:149], v209 offset:36872
  ds_read_b64_tr_b16 a[150:151], v209 offset:37384
  s_waitcnt vmcnt(34) lgkmcnt(0)
  ds_read_b64_tr_b16 a[152:153], v209 offset:38912
  ds_read_b64_tr_b16 a[154:155], v209 offset:39424
  ds_read_b64_tr_b16 a[156:157], v209 offset:38920
  ds_read_b64_tr_b16 a[158:159], v209 offset:39432
  s_waitcnt vmcnt(32) lgkmcnt(0)
  ds_read_b64_tr_b16 a[160:161], v209 offset:0
  ds_read_b64_tr_b16 a[162:163], v209 offset:512
  ds_read_b64_tr_b16 a[164:165], v209 offset:8
  ds_read_b64_tr_b16 a[166:167], v209 offset:520
  s_waitcnt vmcnt(30) lgkmcnt(0)
  ds_read_b64_tr_b16 a[168:169], v209 offset:2048
  ds_read_b64_tr_b16 a[170:171], v209 offset:2560
  ds_read_b64_tr_b16 a[172:173], v209 offset:2056
  ds_read_b64_tr_b16 a[174:175], v209 offset:2568
  s_waitcnt vmcnt(28) lgkmcnt(0)
  ds_read_b64_tr_b16 a[176:177], v209 offset:4096
  ds_read_b64_tr_b16 a[178:179], v209 offset:4608
  ds_read_b64_tr_b16 a[180:181], v209 offset:4104
  ds_read_b64_tr_b16 a[182:183], v209 offset:4616
  s_waitcnt vmcnt(26) lgkmcnt(0)
  ds_read_b64_tr_b16 a[184:185], v209 offset:6144
  ds_read_b64_tr_b16 a[186:187], v209 offset:6656
  ds_read_b64_tr_b16 a[188:189], v209 offset:6152
  ds_read_b64_tr_b16 a[190:191], v209 offset:6664
  s_waitcnt vmcnt(24) lgkmcnt(0)
  ds_read_b64_tr_b16 a[192:193], v209 offset:8192
  ds_read_b64_tr_b16 a[194:195], v209 offset:8704
  ds_read_b64_tr_b16 a[196:197], v209 offset:8200
  ds_read_b64_tr_b16 a[198:199], v209 offset:8712
  s_waitcnt vmcnt(22) lgkmcnt(0)
  ds_read_b64_tr_b16 a[200:201], v209 offset:10240
  ds_read_b64_tr_b16 a[202:203], v209 offset:10752
  ds_read_b64_tr_b16 a[204:205], v209 offset:10248
  ds_read_b64_tr_b16 a[206:207], v209 offset:10760
  s_waitcnt vmcnt(20) lgkmcnt(0)
  ds_read_b64_tr_b16 a[208:209], v209 offset:12288
  ds_read_b64_tr_b16 a[210:211], v209 offset:12800
  ds_read_b64_tr_b16 a[212:213], v209 offset:12296
  ds_read_b64_tr_b16 a[214:215], v209 offset:12808
  s_waitcnt vmcnt(18) lgkmcnt(0)
  ds_read_b64_tr_b16 a[216:217], v209 offset:14336
  ds_read_b64_tr_b16 a[218:219], v209 offset:14848
  ds_read_b64_tr_b16 a[220:221], v209 offset:14344
  ds_read_b64_tr_b16 a[222:223], v209 offset:14856
  s_waitcnt vmcnt(16) lgkmcnt(0)
  ds_read_b64_tr_b16 a[224:225], v209 offset:16384
  ds_read_b64_tr_b16 a[226:227], v209 offset:16896
  ds_read_b64_tr_b16 a[228:229], v209 offset:16392
  ds_read_b64_tr_b16 a[230:231], v209 offset:16904
  s_waitcnt vmcnt(14) lgkmcnt(0)
  ds_read_b64_tr_b16 a[232:233], v209 offset:18432
  ds_read_b64_tr_b16 a[234:235], v209 offset:18944
  ds_read_b64_tr_b16 a[236:237], v209 offset:18440
  ds_read_b64_tr_b16 a[238:239], v209 offset:18952
  s_waitcnt vmcnt(12) lgkmcnt(0)
  ds_read_b64_tr_b16 a[240:241], v209 offset:20480
  ds_read_b64_tr_b16 a[242:243], v209 offset:20992
  ds_read_b64_tr_b16 a[244:245], v209 offset:20488
  ds_read_b64_tr_b16 a[246:247], v209 offset:21000
  s_waitcnt vmcnt(10) lgkmcnt(0)
  ds_read_b64_tr_b16 a[248:249], v209 offset:22528
  ds_read_b64_tr_b16 a[250:251], v209 offset:23040
  ds_read_b64_tr_b16 a[252:253], v209 offset:22536
  ds_read_b64_tr_b16 a[254:255], v209 offset:23048
  s_waitcnt vmcnt(8) lgkmcnt(0)
  ds_read_b64_tr_b16 v[216:217], v210 offset:24576
  ds_read_b64_tr_b16 v[218:219], v210 offset:24832
  ds_read_b64_tr_b16 v[220:221], v210 offset:24584
  ds_read_b64_tr_b16 v[222:223], v210 offset:24840
  s_waitcnt vmcnt(6) lgkmcnt(0)
  ds_read_b64_tr_b16 v[224:225], v210 offset:26624
  ds_read_b64_tr_b16 v[226:227], v210 offset:26880
  ds_read_b64_tr_b16 v[228:229], v210 offset:26632
  ds_read_b64_tr_b16 v[230:231], v210 offset:26888
  s_waitcnt vmcnt(4) lgkmcnt(0)
  ds_read_b64_tr_b16 v[232:233], v210 offset:28672
  ds_read_b64_tr_b16 v[234:235], v210 offset:28928
  ds_read_b64_tr_b16 v[236:237], v210 offset:28680
  ds_read_b64_tr_b16 v[238:239], v210 offset:28936
  s_waitcnt vmcnt(2) lgkmcnt(0)
  ds_read_b64_tr_b16 v[240:241], v210 offset:30720
  ds_read_b64_tr_b16 v[242:243], v210 offset:30976
  ds_read_b64_tr_b16 v[244:245], v210 offset:30728
  ds_read_b64_tr_b16 v[246:247], v210 offset:30984
  s_waitcnt vmcnt(0) lgkmcnt(0)
  ds_read_b64_tr_b16 v[248:249], v210 offset:32768
  ds_read_b64_tr_b16 v[250:251], v210 offset:33024
  ds_read_b64_tr_b16 v[252:253], v210 offset:32776
  ds_read_b64_tr_b16 v[254:255], v210 offset:33032
  v_and_b32 v211, 15, v200
  s_lshl_b32 s54, s69, 4
  v_add_u32 v211, s54, v211
  v_lshl_add_u32 v212, v214, 5, v211
  v_lshlrev_b32 v164, 4, v212
  v_lshrrev_b32 v212, 5, v200
  v_lshl_add_u32 v164, v212, 10, v164
  v_mul_u32_u24 v167, 1152, v211
  v_lshl_add_u32 v167, v213, 4, v167
  v_lshlrev_b32 v166, 2, v211
  v_mul_u32_u24 v211, 144, v211
  s_mul_i32 s54, s52, 20
  s_mov_b32 s55, 294768
  v_mov_b32 v214, 0x40000000
  v_add_u32 v212, s54, v213
  v_add_u32 v212, 0, v212
  v_mul_u32_u24 v176, 57, v212
  v_lshrrev_b32 v176, 9, v176
  v_mul_lo_u32 v176, v176, s55
  v_lshl_add_u32 v176, v212, 4, v176
  v_add_u32 v176, v176, v211
  v_cmp_lt_u32 vcc, 71, v212
  s_nop 1
  v_cndmask_b32 v176, v176, v214, vcc
  v_add_u32 v212, s54, v213
  v_add_u32 v212, 4, v212
  v_mul_u32_u24 v177, 57, v212
  v_lshrrev_b32 v177, 9, v177
  v_mul_lo_u32 v177, v177, s55
  v_lshl_add_u32 v177, v212, 4, v177
  v_add_u32 v177, v177, v211
  v_cmp_lt_u32 vcc, 71, v212
  s_nop 1
  v_cndmask_b32 v177, v177, v214, vcc
  v_add_u32 v212, s54, v213
  v_add_u32 v212, 8, v212
  v_mul_u32_u24 v178, 57, v212
  v_lshrrev_b32 v178, 9, v178
  v_mul_lo_u32 v178, v178, s55
  v_lshl_add_u32 v178, v212, 4, v178
  v_add_u32 v178, v178, v211
  v_cmp_lt_u32 vcc, 71, v212
  s_nop 1
  v_cndmask_b32 v178, v178, v214, vcc
  v_add_u32 v212, s54, v213
  v_add_u32 v212, 12, v212
  v_mul_u32_u24 v179, 57, v212
  v_lshrrev_b32 v179, 9, v179
  v_mul_lo_u32 v179, v179, s55
  v_lshl_add_u32 v179, v212, 4, v179
  v_add_u32 v179, v179, v211
  v_cmp_lt_u32 vcc, 71, v212
  s_nop 1
  v_cndmask_b32 v179, v179, v214, vcc
  v_add_u32 v212, s54, v213
  v_add_u32 v212, 16, v212
  v_mul_u32_u24 v180, 57, v212
  v_lshrrev_b32 v180, 9, v180
  v_mul_lo_u32 v180, v180, s55
  v_lshl_add_u32 v180, v212, 4, v180
  v_add_u32 v180, v180, v211
  v_cmp_lt_u32 vcc, 71, v212
  s_nop 1
  v_cndmask_b32 v180, v180, v214, vcc
  v_lshlrev_b32 v208, 2, v200
  s_lshl_b32 s54, s52, 11
  v_add_u32 v168, s54, v201
  s_mov_b32 s59, s68
  s_mov_b32 s56, 128
  s_mov_b32 s57, 36
  s_waitcnt lgkmcnt(0)
  s_cmp_eq_u32 s52, 0
  s_cbranch_scc0 O_p1_d
  s_mov_b32 exec_hi, 0
  s_mov_b32 exec_lo, -1
O_p1:
  buffer_load_dword v211, v208, s[12:15], s56 offen sc1
  s_add_u32 s65, s65, 1
  s_waitcnt vmcnt(0)
  v_cmp_gt_u32 vcc, 0x700, v211
  s_cbranch_vccz O_p1_x
  s_sleep 16
  s_cmp_lt_u32 s65, 131072
  s_cbranch_scc1 O_p1
O_p1_x:
  s_mov_b64 exec, -1
O_p1_d:
  s_barrier
  s_cmp_eq_u32 s52, 0
  s_cbranch_scc0 O_a_d
  s_mov_b32 exec_hi, 0
  s_mov_b32 exec_lo, 1
O_a:
  buffer_load_dword v211, v208, s[12:15], s57 offen sc1
  s_add_u32 s65, s65, 1
  s_waitcnt vmcnt(0)
  v_cmp_gt_u32 vcc, 0x80, v211
  s_cbranch_vccz O_a_x
  s_sleep 16
  s_cmp_lt_u32 s65, 131072
  s_cbranch_scc1 O_a
O_a_x:
  s_mov_b64 exec, -1
O_a_d:
  s_barrier
  s_cmp_ge_u32 s70, 9
  s_cselect_b32 s54, 9, 0
  s_sub_u32 s54, s70, s54
  s_and_b32 s54, s54, 7
  s_lshl_b32 s54, s54, 13
  s_lshl_b32 s55, s69, 8
  s_add_u32 s54, s54, s55
  v_lshrrev_b32 v211, 2, v200
  v_lshl_add_u32 v172, v211, 9, s54
  v_and_b32 v211, 3, v200
  v_lshl_add_u32 v172, v211, 6, v172
  s_mul_i32 s55, s59, 4608
  s_add_u32 s55, s55, 62914560
  buffer_load_dwordx4 v[128:131], v176, s[8:11], s55 offen sc1
  buffer_load_dwordx4 v[132:135], v177, s[8:11], s55 offen sc1
  buffer_load_dwordx4 v[136:139], v178, s[8:11], s55 offen sc1
  buffer_load_dwordx4 v[140:143], v179, s[8:11], s55 offen sc1
  buffer_load_dwordx4 v[144:147], v180, s[8:11], s55 offen sc1
  s_lshl_b32 s55, s59, 7
  s_add_u32 s55, s55, 66060288
  buffer_load_dword v171, v166, s[8:11], s55 offen sc1
  v_mov_b32 v169, 0
  v_lshlrev_b32 v208, 8, v200
  s_mov_b32 s66, 393216
  s_waitcnt vmcnt(0)
O_loop:
  v_mfma_f32_16x16x32_bf16 v[156:159], v[216:219], v[128:131], 0
  v_mfma_f32_16x16x32_bf16 v[160:163], v[220:223], v[128:131], 0
  v_mfma_f32_16x16x32_bf16 v[156:159], v[224:227], v[132:135], v[156:159]
  v_mfma_f32_16x16x32_bf16 v[160:163], v[228:231], v[132:135], v[160:163]
  v_mfma_f32_16x16x32_bf16 v[156:159], v[232:235], v[136:139], v[156:159]
  v_mfma_f32_16x16x32_bf16 v[160:163], v[236:239], v[136:139], v[160:163]
  v_mfma_f32_16x16x32_bf16 v[156:159], v[240:243], v[140:143], v[156:159]
  v_mfma_f32_16x16x32_bf16 v[160:163], v[244:247], v[140:143], v[160:163]
  v_mfma_f32_16x16x32_bf16 v[156:159], v[248:251], v[144:147], v[156:159]
  v_mfma_f32_16x16x32_bf16 v[160:163], v[252:255], v[144:147], v[160:163]
  s_mul_i32 s64, s59, 36864
  s_lshl_b32 s54, s70, 6
  s_add_u32 s64, s64, s54
  s_add_u32 s71, s59, 2
  s_lshl_b32 s55, s59, 18
  s_lshl_b32 s54, s52, 16
  s_add_u32 s55, s55, s54
  s_add_u32 s63, s55, 46137344
  s_and_b32 s54, s59, 1
  s_lshl_b32 s54, s54, 2
  s_add_u32 s54, s54, s52
  s_lshl_b32 s54, s54, 3
  s_lshl_b64 s[72:73], 0xff, s54
  v_sub_f32 v165, 1.0, v171
  v_cvt_pk_bf16_f32 v165, v165, v165
  v_lshlrev_b32 v165, 16, v165
  v_mul_f32 v156, v171, v156
  v_mul_f32 v157, v171, v157
  v_mul_f32 v158, v171, v158
  v_mul_f32 v159, v171, v159
  v_mul_f32 v160, v171, v160
  v_mul_f32 v161, v171, v161
  v_mul_f32 v162, v171, v162
  v_mul_f32 v163, v171, v163
  s_branch O_pc
O_pl:
  s_sleep 1
  s_mov_b64 exec, s[72:73]
  buffer_load_dword v169, v208, s[8:11], s66 offen sc1
  s_mov_b64 exec, -1
  s_add_u32 s65, s65, 1
  s_cmp_ge_u32 s65, 131072
  s_cbranch_scc1 O_ld
  s_waitcnt vmcnt(0)
O_pc:
  v_cmp_gt_u32 vcc, s71, v169
  s_nop 0
  s_and_b64 vcc, vcc, s[72:73]
  s_cbranch_scc1 O_pl
O_ld:
  s_mov_b32 s62, s63
  buffer_load_dwordx4 v[0:3], v164, s[8:11], s62 offen offset:0 sc1
  buffer_load_dwordx4 v[4:7], v164, s[8:11], s62 offen offset:2048 sc1
  s_add_u32 s62, s62, 4096
  buffer_load_dwordx4 v[8:11], v164, s[8:11], s62 offen offset:0 sc1
  buffer_load_dwordx4 v[12:15], v164, s[8:11], s62 offen offset:2048 sc1
  s_add_u32 s62, s62, 4096
  buffer_load_dwordx4 v[16:19], v164, s[8:11], s62 offen offset:0 sc1
  buffer_load_dwordx4 v[20:23], v164, s[8:11], s62 offen offset:2048 sc1
  s_add_u32 s62, s62, 4096
  buffer_load_dwordx4 v[24:27], v164, s[8:11], s62 offen offset:0 sc1
  buffer_load_dwordx4 v[28:31], v164, s[8:11], s62 offen offset:2048 sc1
  s_add_u32 s62, s62, 4096
  buffer_load_dwordx4 v[32:35], v164, s[8:11], s62 offen offset:0 sc1
  buffer_load_dwordx4 v[36:39], v164, s[8:11], s62 offen offset:2048 sc1
  s_add_u32 s62, s62, 4096
  buffer_load_dwordx4 v[40:43], v164, s[8:11], s62 offen offset:0 sc1
  buffer_load_dwordx4 v[44:47], v164, s[8:11], s62 offen offset:2048 sc1
  s_add_u32 s62, s62, 4096
  buffer_load_dwordx4 v[48:51], v164, s[8:11], s62 offen offset:0 sc1
  buffer_load_dwordx4 v[52:55], v164, s[8:11], s62 offen offset:2048 sc1
  s_add_u32 s62, s62, 4096
  buffer_load_dwordx4 v[56:59], v164, s[8:11], s62 offen offset:0 sc1
  buffer_load_dwordx4 v[60:63], v164, s[8:11], s62 offen offset:2048 sc1
  s_add_u32 s62, s62, 4096
  buffer_load_dwordx4 v[64:67], v164, s[8:11], s62 offen offset:0 sc1
  buffer_load_dwordx4 v[68:71], v164, s[8:11], s62 offen offset:2048 sc1
  s_add_u32 s62, s62, 4096
  buffer_load_dwordx4 v[72:75], v164, s[8:11], s62 offen offset:0 sc1
  buffer_load_dwordx4 v[76:79], v164, s[8:11], s62 offen offset:2048 sc1
  s_add_u32 s62, s62, 4096
  buffer_load_dwordx4 v[80:83], v164, s[8:11], s62 offen offset:0 sc1
  buffer_load_dwordx4 v[84:87], v164, s[8:11], s62 offen offset:2048 sc1
  s_add_u32 s62, s62, 4096
  buffer_load_dwordx4 v[88:91], v164, s[8:11], s62 offen offset:0 sc1
  buffer_load_dwordx4 v[92:95], v164, s[8:11], s62 offen offset:2048 sc1
  s_add_u32 s62, s62, 4096
  buffer_load_dwordx4 v[96:99], v164, s[8:11], s62 offen offset:0 sc1
  buffer_load_dwordx4 v[100:103], v164, s[8:11], s62 offen offset:2048 sc1
  s_add_u32 s62, s62, 4096
  buffer_load_dwordx4 v[104:107], v164, s[8:11], s62 offen offset:0 sc1
  buffer_load_dwordx4 v[108:111], v164, s[8:11], s62 offen offset:2048 sc1
  s_add_u32 s62, s62, 4096
  buffer_load_dwordx4 v[112:115], v164, s[8:11], s62 offen offset:0 sc1
  buffer_load_dwordx4 v[116:119], v164, s[8:11], s62 offen offset:2048 sc1
  s_add_u32 s62, s62, 4096
  buffer_load_dwordx4 v[120:123], v164, s[8:11], s62 offen offset:0 sc1
  buffer_load_dwordx4 v[124:127], v164, s[8:11], s62 offen offset:2048 sc1
  s_add_u32 s62, s62, 4096
  s_add_u32 s57, s59, 3
  s_min_u32 s74, s57, 63
  s_mul_i32 s55, s74, 4608
  s_add_u32 s55, s55, 62914560
  buffer_load_dwordx4 v[128:131], v176, s[8:11], s55 offen sc1
  buffer_load_dwordx4 v[132:135], v177, s[8:11], s55 offen sc1
  buffer_load_dwordx4 v[136:139], v178, s[8:11], s55 offen sc1
  buffer_load_dwordx4 v[140:143], v179, s[8:11], s55 offen sc1
  buffer_load_dwordx4 v[144:147], v180, s[8:11], s55 offen sc1
  s_lshl_b32 s55, s74, 7
  s_add_u32 s55, s55, 66060288
  buffer_load_dword v171, v166, s[8:11], s55 offen sc1
  s_add_u32 s65, s65, 1
  s_cmp_lt_u32 s65, 131072
  s_cselect_b32 s54, -2, -1
  s_waitcnt vmcnt(37)
  v_mfma_f32_16x16x32_bf16 v[148:151], a[0:3], v[0:3], 0
  v_mfma_f32_16x16x32_bf16 v[152:155], a[4:7], v[0:3], 0
  v_max3_u32 v170, v0, v1, v0
  v_max3_u32 v170, v2, v3, v170
  s_waitcnt vmcnt(36)
  v_mfma_f32_16x16x32_bf16 v[148:151], a[8:11], v[4:7], v[148:151]
  v_mfma_f32_16x16x32_bf16 v[152:155], a[12:15], v[4:7], v[152:155]
  v_max3_u32 v170, v4, v5, v170
  v_max3_u32 v170, v6, v7, v170
  s_waitcnt vmcnt(35)
  v_mfma_f32_16x16x32_bf16 v[148:151], a[16:19], v[8:11], v[148:151]
  v_mfma_f32_16x16x32_bf16 v[152:155], a[20:23], v[8:11], v[152:155]
  v_max3_u32 v170, v8, v9, v170
  v_max3_u32 v170, v10, v11, v170
  s_waitcnt vmcnt(34)
  v_mfma_f32_16x16x32_bf16 v[148:151], a[24:27], v[12:15], v[148:151]
  v_mfma_f32_16x16x32_bf16 v[152:155], a[28:31], v[12:15], v[152:155]
  v_max3_u32 v170, v12, v13, v170
  v_max3_u32 v170, v14, v15, v170
  s_waitcnt vmcnt(33)
  v_mfma_f32_16x16x32_bf16 v[148:151], a[32:35], v[16:19], v[148:151]
  v_mfma_f32_16x16x32_bf16 v[152:155], a[36:39], v[16:19], v[152:155]
  v_max3_u32 v170, v16, v17, v170
  v_max3_u32 v170, v18, v19, v170
  s_waitcnt vmcnt(32)
  v_mfma_f32_16x16x32_bf16 v[148:151], a[40:43], v[20:23], v[148:151]
  v_mfma_f32_16x16x32_bf16 v[152:155], a[44:47], v[20:23], v[152:155]
  v_max3_u32 v170, v20, v21, v170
  v_max3_u32 v170, v22, v23, v170
  s_waitcnt vmcnt(31)
  v_mfma_f32_16x16x32_bf16 v[148:151], a[48:51], v[24:27], v[148:151]
  v_mfma_f32_16x16x32_bf16 v[152:155], a[52:55], v[24:27], v[152:155]
  v_max3_u32 v170, v24, v25, v170
  v_max3_u32 v170, v26, v27, v170
  s_waitcnt vmcnt(30)
  v_mfma_f32_16x16x32_bf16 v[148:151], a[56:59], v[28:31], v[148:151]
  v_mfma_f32_16x16x32_bf16 v[152:155], a[60:63], v[28:31], v[152:155]
  v_max3_u32 v170, v28, v29, v170
  v_max3_u32 v170, v30, v31, v170
  s_waitcnt vmcnt(29)
  v_mfma_f32_16x16x32_bf16 v[148:151], a[64:67], v[32:35], v[148:151]
  v_mfma_f32_16x16x32_bf16 v[152:155], a[68:71], v[32:35], v[152:155]
  v_max3_u32 v170, v32, v33, v170
  v_max3_u32 v170, v34, v35, v170
  s_waitcnt vmcnt(28)
  v_mfma_f32_16x16x32_bf16 v[148:151], a[72:75], v[36:39], v[148:151]
  v_mfma_f32_16x16x32_bf16 v[152:155], a[76:79], v[36:39], v[152:155]
  v_max3_u32 v170, v36, v37, v170
  v_max3_u32 v170, v38, v39, v170
  s_waitcnt vmcnt(27)
  v_mfma_f32_16x16x32_bf16 v[148:151], a[80:83], v[40:43], v[148:151]
  v_mfma_f32_16x16x32_bf16 v[152:155], a[84:87], v[40:43], v[152:155]
  v_max3_u32 v170, v40, v41, v170
  v_max3_u32 v170, v42, v43, v170
  s_waitcnt vmcnt(26)
  v_mfma_f32_16x16x32_bf16 v[148:151], a[88:91], v[44:47], v[148:151]
  v_mfma_f32_16x16x32_bf16 v[152:155], a[92:95], v[44:47], v[152:155]
  v_max3_u32 v170, v44, v45, v170
  v_max3_u32 v170, v46, v47, v170
  s_waitcnt vmcnt(25)
  v_mfma_f32_16x16x32_bf16 v[148:151], a[96:99], v[48:51], v[148:151]
  v_mfma_f32_16x16x32_bf16 v[152:155], a[100:103], v[48:51], v[152:155]
  v_max3_u32 v170, v48, v49, v170
  v_max3_u32 v170, v50, v51, v170
  s_waitcnt vmcnt(24)
  v_mfma_f32_16x16x32_bf16 v[148:151], a[104:107], v[52:55], v[148:151]
  v_mfma_f32_16x16x32_bf16 v[152:155], a[108:111], v[52:55], v[152:155]
  v_max3_u32 v170, v52, v53, v170
  v_max3_u32 v170, v54, v55, v170
  s_waitcnt vmcnt(23)
  v_mfma_f32_16x16x32_bf16 v[148:151], a[112:115], v[56:59], v[148:151]
  v_mfma_f32_16x16x32_bf16 v[152:155], a[116:119], v[56:59], v[152:155]
  v_max3_u32 v170, v56, v57, v170
  v_max3_u32 v170, v58, v59, v170
  s_waitcnt vmcnt(22)
  v_mfma_f32_16x16x32_bf16 v[148:151], a[120:123], v[60:63], v[148:151]
  v_mfma_f32_16x16x32_bf16 v[152:155], a[124:127], v[60:63], v[152:155]
  v_max3_u32 v170, v60, v61, v170
  v_max3_u32 v170, v62, v63, v170
  s_waitcnt vmcnt(21)
  v_mfma_f32_16x16x32_bf16 v[148:151], a[128:131], v[64:67], v[148:151]
  v_mfma_f32_16x16x32_bf16 v[152:155], a[132:135], v[64:67], v[152:155]
  v_max3_u32 v170, v64, v65, v170
  v_max3_u32 v170, v66, v67, v170
  s_waitcnt vmcnt(20)
  v_mfma_f32_16x16x32_bf16 v[148:151], a[136:139], v[68:71], v[148:151]
  v_mfma_f32_16x16x32_bf16 v[152:155], a[140:143], v[68:71], v[152:155]
  v_max3_u32 v170, v68, v69, v170
  v_max3_u32 v170, v70, v71, v170
  s_waitcnt vmcnt(19)
  v_mfma_f32_16x16x32_bf16 v[148:151], a[144:147], v[72:75], v[148:151]
  v_mfma_f32_16x16x32_bf16 v[152:155], a[148:151], v[72:75], v[152:155]
  v_max3_u32 v170, v72, v73, v170
  v_max3_u32 v170, v74, v75, v170
  s_waitcnt vmcnt(18)
  v_mfma_f32_16x16x32_bf16 v[148:151], a[152:155], v[76:79], v[148:151]
  v_mfma_f32_16x16x32_bf16 v[152:155], a[156:159], v[76:79], v[152:155]
  v_max3_u32 v170, v76, v77, v170
  v_max3_u32 v170, v78, v79, v170
  s_waitcnt vmcnt(17)
  v_mfma_f32_16x16x32_bf16 v[148:151], a[160:163], v[80:83], v[148:151]
  v_mfma_f32_16x16x32_bf16 v[152:155], a[164:167], v[80:83], v[152:155]
  v_max3_u32 v170, v80, v81, v170
  v_max3_u32 v170, v82, v83, v170
  s_waitcnt vmcnt(16)
  v_mfma_f32_16x16x32_bf16 v[148:151], a[168:171], v[84:87], v[148:151]
  v_mfma_f32_16x16x32_bf16 v[152:155], a[172:175], v[84:87], v[152:155]
  v_max3_u32 v170, v84, v85, v170
  v_max3_u32 v170, v86, v87, v170
  s_waitcnt vmcnt(15)
  v_mfma_f32_16x16x32_bf16 v[148:151], a[176:179], v[88:91], v[148:151]
  v_mfma_f32_16x16x32_bf16 v[152:155], a[180:183], v[88:91], v[152:155]
  v_max3_u32 v170, v88, v89, v170
  v_max3_u32 v170, v90, v91, v170
  s_waitcnt vmcnt(14)
  v_mfma_f32_16x16x32_bf16 v[148:151], a[184:187], v[92:95], v[148:151]
  v_mfma_f32_16x16x32_bf16 v[152:155], a[188:191], v[92:95], v[152:155]
  v_max3_u32 v170, v92, v93, v170
  v_max3_u32 v170, v94, v95, v170
  s_waitcnt vmcnt(13)
  v_mfma_f32_16x16x32_bf16 v[148:151], a[192:195], v[96:99], v[148:151]
  v_mfma_f32_16x16x32_bf16 v[152:155], a[196:199], v[96:99], v[152:155]
  v_max3_u32 v170, v96, v97, v170
  v_max3_u32 v170, v98, v99, v170
  s_waitcnt vmcnt(12)
  v_mfma_f32_16x16x32_bf16 v[148:151], a[200:203], v[100:103], v[148:151]
  v_mfma_f32_16x16x32_bf16 v[152:155], a[204:207], v[100:103], v[152:155]
  v_max3_u32 v170, v100, v101, v170
  v_max3_u32 v170, v102, v103, v170
  s_waitcnt vmcnt(11)
  v_mfma_f32_16x16x32_bf16 v[148:151], a[208:211], v[104:107], v[148:151]
  v_mfma_f32_16x16x32_bf16 v[152:155], a[212:215], v[104:107], v[152:155]
  v_max3_u32 v170, v104, v105, v170
  v_max3_u32 v170, v106, v107, v170
  s_waitcnt vmcnt(10)
  v_mfma_f32_16x16x32_bf16 v[148:151], a[216:219], v[108:111], v[148:151]
  v_mfma_f32_16x16x32_bf16 v[152:155], a[220:223], v[108:111], v[152:155]
  v_max3_u32 v170, v108, v109, v170
  v_max3_u32 v170, v110, v111, v170
  s_waitcnt vmcnt(9)
  v_mfma_f32_16x16x32_bf16 v[148:151], a[224:227], v[112:115], v[148:151]
  v_mfma_f32_16x16x32_bf16 v[152:155], a[228:231], v[112:115], v[152:155]
  v_max3_u32 v170, v112, v113, v170
  v_max3_u32 v170, v114, v115, v170
  s_waitcnt vmcnt(8)
  v_mfma_f32_16x16x32_bf16 v[148:151], a[232:235], v[116:119], v[148:151]
  v_mfma_f32_16x16x32_bf16 v[152:155], a[236:239], v[116:119], v[152:155]
  v_max3_u32 v170, v116, v117, v170
  v_max3_u32 v170, v118, v119, v170
  s_waitcnt vmcnt(7)
  v_mfma_f32_16x16x32_bf16 v[148:151], a[240:243], v[120:123], v[148:151]
  v_mfma_f32_16x16x32_bf16 v[152:155], a[244:247], v[120:123], v[152:155]
  v_max3_u32 v170, v120, v121, v170
  v_max3_u32 v170, v122, v123, v170
  s_waitcnt vmcnt(6)
  v_mfma_f32_16x16x32_bf16 v[148:151], a[248:251], v[124:127], v[148:151]
  v_mfma_f32_16x16x32_bf16 v[152:155], a[252:255], v[124:127], v[152:155]
  v_max3_u32 v170, v124, v125, v170
  v_max3_u32 v170, v126, v127, v170
  v_cmp_lt_u32 vcc, s54, v170
  s_cbranch_vccnz O_ld
  v_fmac_f32 v156, v165, v148
  v_fmac_f32 v157, v165, v149
  v_fmac_f32 v158, v165, v150
  v_fmac_f32 v159, v165, v151
  v_fmac_f32 v160, v165, v152
  v_fmac_f32 v161, v165, v153
  v_fmac_f32 v162, v165, v154
  v_fmac_f32 v163, v165, v155
  ds_write_b128 v168, v[156:159]
  ds_write_b128 v168, v[160:163] offset:1024
  v_xor_b32 v168, 0x2000, v168
  s_mov_b32 s59, s57
  s_waitcnt lgkmcnt(0)
  s_barrier
  s_cmp_eq_u32 s52, 0
  s_cbranch_scc0 O_next
  v_xor_b32 v211, 0x2000, v168
  ds_read_b128 v[0:3], v211 offset:2048
  ds_read_b128 v[4:7], v211 offset:3072
  ds_read_b128 v[8:11], v211 offset:4096
  ds_read_b128 v[12:15], v211 offset:5120
  ds_read_b128 v[16:19], v211 offset:6144
  ds_read_b128 v[20:23], v211 offset:7168
  s_waitcnt lgkmcnt(5)
  v_add_f32 v156, v156, v0
  v_add_f32 v157, v157, v1
  v_add_f32 v158, v158, v2
  v_add_f32 v159, v159, v3
  s_waitcnt lgkmcnt(4)
  v_add_f32 v160, v160, v4
  v_add_f32 v161, v161, v5
  v_add_f32 v162, v162, v6
  v_add_f32 v163, v163, v7
  s_waitcnt lgkmcnt(3)
  v_add_f32 v156, v156, v8
  v_add_f32 v157, v157, v9
  v_add_f32 v158, v158, v10
  v_add_f32 v159, v159, v11
  s_waitcnt lgkmcnt(2)
  v_add_f32 v160, v160, v12
  v_add_f32 v161, v161, v13
  v_add_f32 v162, v162, v14
  v_add_f32 v163, v163, v15
  s_waitcnt lgkmcnt(1)
  v_add_f32 v156, v156, v16
  v_add_f32 v157, v157, v17
  v_add_f32 v158, v158, v18
  v_add_f32 v159, v159, v19
  s_waitcnt lgkmcnt(0)
  v_add_f32 v160, v160, v20
  v_add_f32 v161, v161, v21
  v_add_f32 v162, v162, v22
  v_add_f32 v163, v163, v23
  v_cvt_pk_bf16_f32 v148, v156, v157
  v_cvt_pk_bf16_f32 v149, v158, v159
  v_cvt_pk_bf16_f32 v150, v160, v161
  v_cvt_pk_bf16_f32 v151, v162, v163
  buffer_store_dwordx4 v[148:151], v167, s[48:51], s64 offen sc1
  s_waitcnt vmcnt(1)
  s_branch O_nx2
O_next:
  s_waitcnt vmcnt(0)
O_nx2:
  s_cmp_lt_u32 s59, 64
  s_cbranch_scc1 O_loop
  s_branch L_exit
W_h:
  s_lshr_b32 s58, s53, 1
  s_and_b32 s59, s53, 1
  s_mul_i32 s60, s59, 36864
  s_add_u32 m0, s67, 0
  s_nop 0
  buffer_load_dwordx4 v202, s[4:7], s60 offen offset:0 lds
  s_add_u32 m0, s67, 896
  s_nop 0
  buffer_load_dwordx4 v202, s[4:7], s60 offen offset:128 lds
  s_add_u32 m0, s67, 1792
  s_nop 0
  buffer_load_dwordx4 v202, s[4:7], s60 offen offset:256 lds
  s_add_u32 m0, s67, 2688
  s_nop 0
  buffer_load_dwordx4 v202, s[4:7], s60 offen offset:384 lds
  s_add_u32 m0, s67, 3584
  s_nop 0
  buffer_load_dwordx4 v202, s[4:7], s60 offen offset:512 lds
  s_add_u32 m0, s67, 4480
  s_nop 0
  buffer_load_dwordx4 v202, s[4:7], s60 offen offset:640 lds
  s_add_u32 m0, s67, 5376
  s_nop 0
  buffer_load_dwordx4 v202, s[4:7], s60 offen offset:768 lds
  s_add_u32 m0, s67, 6272
  s_nop 0
  buffer_load_dwordx4 v202, s[4:7], s60 offen offset:896 lds
  s_add_u32 m0, s67, 7168
  s_nop 0
  buffer_load_dwordx4 v202, s[4:7], s60 offen offset:1024 lds
  v_lshrrev_b32 v211, 4, v200
  v_lshlrev_b32 v212, 2, v211
  v_and_b32 v213, 15, v200
  v_xor_b32 v212, v212, v213
  v_lshlrev_b32 v212, 4, v212
  v_lshl_add_u32 v207, v211, 13, v212
  s_lshl_b32 s62, s58, 8
  s_lshl_b32 s54, s52, 15
  s_add_u32 s62, s62, s54
  s_lshl_b32 s61, s52, 10
  s_add_u32 s61, s61, 36864
  s_add_u32 m0, s61, 0
  s_add_u32 s54, s62, 0
  buffer_load_dwordx4 v207, s[16:19], s54 offen lds
  s_add_u32 m0, s61, 4096
  s_add_u32 s54, s62, 131072
  buffer_load_dwordx4 v207, s[16:19], s54 offen lds
  s_add_u32 m0, s61, 8192
  s_add_u32 s54, s62, 262144
  buffer_load_dwordx4 v207, s[16:19], s54 offen lds
  s_add_u32 m0, s61, 12288
  s_add_u32 s54, s62, 393216
  buffer_load_dwordx4 v207, s[16:19], s54 offen lds
  s_add_u32 m0, s61, 16384
  s_add_u32 s54, s62, 524288
  buffer_load_dwordx4 v207, s[16:19], s54 offen lds
  s_add_u32 m0, s61, 20480
  s_add_u32 s54, s62, 655360
  buffer_load_dwordx4 v207, s[16:19], s54 offen lds
  s_add_u32 m0, s61, 24576
  s_add_u32 s54, s62, 786432
  buffer_load_dwordx4 v207, s[16:19], s54 offen lds
  s_add_u32 m0, s61, 28672
  s_add_u32 s54, s62, 917504
  buffer_load_dwordx4 v207, s[16:19], s54 offen lds
  s_add_u32 m0, s61, 32768
  s_add_u32 s54, s62, 1048576
  buffer_load_dwordx4 v207, s[16:19], s54 offen lds
  s_add_u32 m0, s61, 36864
  s_add_u32 s54, s62, 1179648
  buffer_load_dwordx4 v207, s[16:19], s54 offen lds
  s_add_u32 m0, s61, 40960
  s_add_u32 s54, s62, 1310720
  buffer_load_dwordx4 v207, s[16:19], s54 offen lds
  s_add_u32 m0, s61, 45056
  s_add_u32 s54, s62, 1441792
  buffer_load_dwordx4 v207, s[16:19], s54 offen lds
  s_add_u32 m0, s61, 49152
  s_add_u32 s54, s62, 1572864
  buffer_load_dwordx4 v207, s[16:19], s54 offen lds
  s_add_u32 m0, s61, 53248
  s_add_u32 s54, s62, 1703936
  buffer_load_dwordx4 v207, s[16:19], s54 offen lds
  s_add_u32 m0, s61, 57344
  s_add_u32 s54, s62, 1835008
  buffer_load_dwordx4 v207, s[16:19], s54 offen lds
  s_add_u32 m0, s61, 61440
  s_add_u32 s54, s62, 1966080
  buffer_load_dwordx4 v207, s[16:19], s54 offen lds
  s_add_u32 m0, s61, 65536
  s_add_u32 s54, s62, 2097152
  buffer_load_dwordx4 v207, s[16:19], s54 offen lds
  s_add_u32 m0, s61, 69632
  s_add_u32 s54, s62, 2228224
  buffer_load_dwordx4 v207, s[16:19], s54 offen lds
  s_add_u32 m0, s61, 73728
  s_add_u32 s54, s62, 2359296
  buffer_load_dwordx4 v207, s[16:19], s54 offen lds
  s_add_u32 m0, s61, 77824
  s_add_u32 s54, s62, 2490368
  buffer_load_dwordx4 v207, s[16:19], s54 offen lds
  s_add_u32 m0, s61, 81920
  s_add_u32 s54, s62, 2621440
  buffer_load_dwordx4 v207, s[16:19], s54 offen lds
  s_add_u32 m0, s61, 86016
  s_add_u32 s54, s62, 2752512
  buffer_load_dwordx4 v207, s[16:19], s54 offen lds
  s_add_u32 m0, s61, 90112
  s_add_u32 s54, s62, 2883584
  buffer_load_dwordx4 v207, s[16:19], s54 offen lds
  s_add_u32 m0, s61, 94208
  s_add_u32 s54, s62, 3014656
  buffer_load_dwordx4 v207, s[16:19], s54 offen lds
  s_waitcnt vmcnt(20) lgkmcnt(0)
  s_barrier
  s_add_u32 m0, s61, 98304
  s_add_u32 s54, s62, 3145728
  buffer_load_dwordx4 v207, s[16:19], s54 offen lds
  s_add_u32 m0, s61, 102400
  s_add_u32 s54, s62, 3276800
  buffer_load_dwordx4 v207, s[16:19], s54 offen lds
  s_add_u32 m0, s61, 106496
  s_add_u32 s54, s62, 3407872
  buffer_load_dwordx4 v207, s[16:19], s54 offen lds
  s_add_u32 m0, s61, 110592
  s_add_u32 s54, s62, 3538944
  buffer_load_dwordx4 v207, s[16:19], s54 offen lds
  v_add_u32 v215, 36864, v209
  ds_read_b64_tr_b16 a[0:1], v215 offset:0
  ds_read_b64_tr_b16 a[2:3], v215 offset:1024
  ds_read_b64_tr_b16 a[4:5], v215 offset:4096
  ds_read_b64_tr_b16 a[6:7], v215 offset:5120
  ds_read_b64_tr_b16 a[8:9], v215 offset:8192
  ds_read_b64_tr_b16 a[10:11], v215 offset:9216
  ds_read_b64_tr_b16 a[12:13], v215 offset:12288
  ds_read_b64_tr_b16 a[14:15], v215 offset:13312
  s_waitcnt vmcnt(20) lgkmcnt(0)
  s_barrier
  s_add_u32 m0, s61, 0
  s_add_u32 s54, s62, 3670016
  buffer_load_dwordx4 v207, s[16:19], s54 offen lds
  s_add_u32 m0, s61, 4096
  s_add_u32 s54, s62, 3801088
  buffer_load_dwordx4 v207, s[16:19], s54 offen lds
  s_add_u32 m0, s61, 8192
  s_add_u32 s54, s62, 3932160
  buffer_load_dwordx4 v207, s[16:19], s54 offen lds
  s_add_u32 m0, s61, 12288
  s_add_u32 s54, s62, 4063232
  buffer_load_dwordx4 v207, s[16:19], s54 offen lds
  v_add_u32 v215, 53248, v209
  ds_read_b64_tr_b16 a[16:17], v215 offset:0
  ds_read_b64_tr_b16 a[18:19], v215 offset:1024
  ds_read_b64_tr_b16 a[20:21], v215 offset:4096
  ds_read_b64_tr_b16 a[22:23], v215 offset:5120
  ds_read_b64_tr_b16 a[24:25], v215 offset:8192
  ds_read_b64_tr_b16 a[26:27], v215 offset:9216
  ds_read_b64_tr_b16 a[28:29], v215 offset:12288
  ds_read_b64_tr_b16 a[30:31], v215 offset:13312
  s_waitcnt vmcnt(20) lgkmcnt(0)
  s_barrier
  s_add_u32 m0, s61, 16384
  s_add_u32 s54, s62, 4194304
  buffer_load_dwordx4 v207, s[16:19], s54 offen lds
  s_add_u32 m0, s61, 20480
  s_add_u32 s54, s62, 4325376
  buffer_load_dwordx4 v207, s[16:19], s54 offen lds
  s_add_u32 m0, s61, 24576
  s_add_u32 s54, s62, 4456448
  buffer_load_dwordx4 v207, s[16:19], s54 offen lds
  s_add_u32 m0, s61, 28672
  s_add_u32 s54, s62, 4587520
  buffer_load_dwordx4 v207, s[16:19], s54 offen lds
  v_add_u32 v215, 69632, v209
  ds_read_b64_tr_b16 a[32:33], v215 offset:0
  ds_read_b64_tr_b16 a[34:35], v215 offset:1024
  ds_read_b64_tr_b16 a[36:37], v215 offset:4096
  ds_read_b64_tr_b16 a[38:39], v215 offset:5120
  ds_read_b64_tr_b16 a[40:41], v215 offset:8192
  ds_read_b64_tr_b16 a[42:43], v215 offset:9216
  ds_read_b64_tr_b16 a[44:45], v215 offset:12288
  ds_read_b64_tr_b16 a[46:47], v215 offset:13312
  s_waitcnt vmcnt(20) lgkmcnt(0)
  s_barrier
  v_add_u32 v215, 86016, v209
  ds_read_b64_tr_b16 a[48:49], v215 offset:0
  ds_read_b64_tr_b16 a[50:51], v215 offset:1024
  ds_read_b64_tr_b16 a[52:53], v215 offset:4096
  ds_read_b64_tr_b16 a[54:55], v215 offset:5120
  ds_read_b64_tr_b16 a[56:57], v215 offset:8192
  ds_read_b64_tr_b16 a[58:59], v215 offset:9216
  ds_read_b64_tr_b16 a[60:61], v215 offset:12288
  ds_read_b64_tr_b16 a[62:63], v215 offset:13312
  s_waitcnt vmcnt(16) lgkmcnt(0)
  s_barrier
  v_add_u32 v215, 102400, v209
  ds_read_b64_tr_b16 a[64:65], v215 offset:0
  ds_read_b64_tr_b16 a[66:67], v215 offset:1024
  ds_read_b64_tr_b16 a[68:69], v215 offset:4096
  ds_read_b64_tr_b16 a[70:71], v215 offset:5120
  ds_read_b64_tr_b16 a[72:73], v215 offset:8192
  ds_read_b64_tr_b16 a[74:75], v215 offset:9216
  ds_read_b64_tr_b16 a[76:77], v215 offset:12288
  ds_read_b64_tr_b16 a[78:79], v215 offset:13312
  s_waitcnt vmcnt(12) lgkmcnt(0)
  s_barrier
  v_add_u32 v215, 118784, v209
  ds_read_b64_tr_b16 a[80:81], v215 offset:0
  ds_read_b64_tr_b16 a[82:83], v215 offset:1024
  ds_read_b64_tr_b16 a[84:85], v215 offset:4096
  ds_read_b64_tr_b16 a[86:87], v215 offset:5120
  ds_read_b64_tr_b16 a[88:89], v215 offset:8192
  ds_read_b64_tr_b16 a[90:91], v215 offset:9216
  ds_read_b64_tr_b16 a[92:93], v215 offset:12288
  ds_read_b64_tr_b16 a[94:95], v215 offset:13312
  s_waitcnt vmcnt(8) lgkmcnt(0)
  s_barrier
  v_add_u32 v215, 135168, v209
  ds_read_b64_tr_b16 a[96:97], v215 offset:0
  ds_read_b64_tr_b16 a[98:99], v215 offset:1024
  ds_read_b64_tr_b16 a[100:101], v215 offset:4096
  ds_read_b64_tr_b16 a[102:103], v215 offset:5120
  ds_read_b64_tr_b16 a[104:105], v215 offset:8192
  ds_read_b64_tr_b16 a[106:107], v215 offset:9216
  ds_read_b64_tr_b16 a[108:109], v215 offset:12288
  ds_read_b64_tr_b16 a[110:111], v215 offset:13312
  s_waitcnt vmcnt(4) lgkmcnt(0)
  s_barrier
  v_add_u32 v215, 36864, v209
  ds_read_b64_tr_b16 a[112:113], v215 offset:0
  ds_read_b64_tr_b16 a[114:115], v215 offset:1024
  ds_read_b64_tr_b16 a[116:117], v215 offset:4096
  ds_read_b64_tr_b16 a[118:119], v215 offset:5120
  ds_read_b64_tr_b16 a[120:121], v215 offset:8192
  ds_read_b64_tr_b16 a[122:123], v215 offset:9216
  ds_read_b64_tr_b16 a[124:125], v215 offset:12288
  ds_read_b64_tr_b16 a[126:127], v215 offset:13312
  s_waitcnt vmcnt(0) lgkmcnt(0)
  s_barrier
  v_add_u32 v215, 53248, v209
  ds_read_b64_tr_b16 a[128:129], v215 offset:0
  ds_read_b64_tr_b16 a[130:131], v215 offset:1024
  ds_read_b64_tr_b16 a[132:133], v215 offset:4096
  ds_read_b64_tr_b16 a[134:135], v215 offset:5120
  ds_read_b64_tr_b16 a[136:137], v215 offset:8192
  ds_read_b64_tr_b16 a[138:139], v215 offset:9216
  ds_read_b64_tr_b16 a[140:141], v215 offset:12288
  ds_read_b64_tr_b16 a[142:143], v215 offset:13312
  s_waitcnt lgkmcnt(0)
  s_barrier
  v_and_b32 v211, 31, v200
  v_lshrrev_b32 v212, 5, v200
  v_lshlrev_b32 v213, 2, v212
  v_sub_u32 v211, v211, v213
  v_mov_b32 v214, 0xf149f2ca
  v_cmp_gt_i32 vcc, 0, v211
  s_nop 1
  v_cndmask_b32 v48, 0, v214, vcc
  v_cmp_gt_i32 vcc, 1, v211
  s_nop 1
  v_cndmask_b32 v49, 0, v214, vcc
  v_cmp_gt_i32 vcc, 2, v211
  s_nop 1
  v_cndmask_b32 v50, 0, v214, vcc
  v_cmp_gt_i32 vcc, 3, v211
  s_nop 1
  v_cndmask_b32 v51, 0, v214, vcc
  v_cmp_gt_i32 vcc, 8, v211
  s_nop 1
  v_cndmask_b32 v52, 0, v214, vcc
  v_cmp_gt_i32 vcc, 9, v211
  s_nop 1
  v_cndmask_b32 v53, 0, v214, vcc
  v_cmp_gt_i32 vcc, 10, v211
  s_nop 1
  v_cndmask_b32 v54, 0, v214, vcc
  v_cmp_gt_i32 vcc, 11, v211
  s_nop 1
  v_cndmask_b32 v55, 0, v214, vcc
  v_cmp_gt_i32 vcc, 16, v211
  s_nop 1
  v_cndmask_b32 v56, 0, v214, vcc
  v_cmp_gt_i32 vcc, 17, v211
  s_nop 1
  v_cndmask_b32 v57, 0, v214, vcc
  v_cmp_gt_i32 vcc, 18, v211
  s_nop 1
  v_cndmask_b32 v58, 0, v214, vcc
  v_cmp_gt_i32 vcc, 19, v211
  s_nop 1
  v_cndmask_b32 v59, 0, v214, vcc
  v_cmp_gt_i32 vcc, 24, v211
  s_nop 1
  v_cndmask_b32 v60, 0, v214, vcc
  v_cmp_gt_i32 vcc, 25, v211
  s_nop 1
  v_cndmask_b32 v61, 0, v214, vcc
  v_cmp_gt_i32 vcc, 26, v211
  s_nop 1
  v_cndmask_b32 v62, 0, v214, vcc
  v_cmp_gt_i32 vcc, 27, v211
  s_nop 1
  v_cndmask_b32 v63, 0, v214, vcc
  v_and_b32 v218, 0xff, v216
  v_add_u32 v218, 81920, v218
  v_and_b32 v211, 15, v200
  v_lshl_add_u32 v211, v212, 5, v211
  v_lshlrev_b32 v219, 3, v211
  v_bfe_u32 v211, v200, 4, 1
  v_lshl_add_u32 v219, v211, 2, v219
  s_lshl_b32 s54, s52, 9
  s_add_u32 s54, s54, 83968
  v_add_u32 v219, s54, v219
  v_lshl_add_u32 v221, v200, 3, s54
  s_lshr_b32 s54, s52, 1
  s_lshl_b32 s54, s54, 10
  s_and_b32 s55, s52, 1
  s_lshl_b32 s55, s55, 3
  s_add_u32 s54, s54, s55
  s_add_u32 s54, s54, 81920
  v_add_u32 v220, s54, v201
  s_lshl_b32 s54, s52, 11
  s_add_u32 s54, s54, 73728
  v_add_u32 v215, s54, v201
  v_add_u32 v208, 73728, v201
  s_mov_b32 s68, 1040356334
  s_cmp_eq_u32 s52, 0
  s_cselect_b32 s71, s71, 268435456
  s_lshl_b32 s56, s58, 2
  s_add_u32 s56, s56, 128
  v_mov_b32 v176, -1
  v_mov_b32 v177, -1
  v_mov_b32 v178, -1
  v_mov_b32 v179, -1
  s_cmp_eq_u32 s52, 0
  s_cbranch_scc0 AT_p1_d
  s_mov_b32 exec_hi, 0
  s_mov_b32 exec_lo, 1
AT_p1:
  buffer_load_dword v211, v201, s[12:15], s56 offen sc1
  s_add_u32 s65, s65, 1
  s_waitcnt vmcnt(0)
  v_cmp_gt_u32 vcc, 0x700, v211
  s_cbranch_vccz AT_p1_x
  s_sleep 8
  s_cmp_lt_u32 s65, 131072
  s_cbranch_scc1 AT_p1
AT_p1_x:
  s_mov_b64 exec, -1
AT_p1_d:
  s_barrier
  s_mov_b32 s74, s59
  s_mul_i32 s66, s59, 655360
  s_lshl_b32 s55, s58, 14
  s_add_u32 s55, s55, s66
  s_add_u32 s55, s55, 1048576
  s_lshl_b32 s73, s58, 2
  s_add_u32 s73, s73, s52
  s_lshl_b32 s72, s59, 7
  s_add_u32 s72, s72, s73
  s_lshl_b32 s72, s72, 11
  s_add_u32 s72, s72, 46137344
  s_lshl_b32 s73, s73, 10
  s_add_u32 s73, s73, s66
  s_add_u32 s73, s73, 1572864
  s_add_u32 s59, s59, 2
  buffer_load_dwordx4 v[128:131], v216, s[8:11], s55 offen offset:0 sc1
  buffer_load_dwordx4 v[132:135], v216, s[8:11], s55 offen offset:256 sc1
  buffer_load_dwordx4 v[136:139], v216, s[8:11], s55 offen offset:512 sc1
  buffer_load_dwordx4 v[140:143], v216, s[8:11], s55 offen offset:768 sc1
  buffer_load_dwordx4 v[144:147], v216, s[8:11], s55 offen offset:1024 sc1
  buffer_load_dwordx4 v[148:151], v216, s[8:11], s55 offen offset:1280 sc1
  buffer_load_dwordx4 v[152:155], v216, s[8:11], s55 offen offset:1536 sc1
  buffer_load_dwordx4 v[156:159], v216, s[8:11], s55 offen offset:1792 sc1
  buffer_load_dwordx4 v[160:163], v217, s[8:11], s55 offen offset:0 sc1
  buffer_load_dwordx4 v[164:167], v217, s[8:11], s55 offen offset:256 sc1
  s_add_u32 s60, s60, 73728
  ds_read_b128 v[32:35], v203 offset:0
  ds_read_b128 v[36:39], v204 offset:0
  ds_read_b128 v[40:43], v205 offset:0
  s_waitcnt lgkmcnt(2)
  v_mfma_f32_32x32x16_bf16 v[240:255], a[0:3], v[32:35], 0
  ds_read_b128 v[44:47], v206 offset:0
  s_add_u32 m0, s67, 36864
  s_nop 0
  buffer_load_dwordx4 v202, s[4:7], s60 offen offset:0 lds
  s_waitcnt lgkmcnt(2)
  v_mfma_f32_32x32x16_bf16 v[240:255], a[4:7], v[36:39], v[240:255]
  ds_read_b128 v[32:35], v203 offset:1024
  s_waitcnt lgkmcnt(2)
  v_mfma_f32_32x32x16_bf16 v[240:255], a[8:11], v[40:43], v[240:255]
  ds_read_b128 v[36:39], v204 offset:1024
  s_add_u32 m0, s67, 37760
  s_nop 0
  buffer_load_dwordx4 v202, s[4:7], s60 offen offset:128 lds
  s_waitcnt lgkmcnt(2)
  v_mfma_f32_32x32x16_bf16 v[240:255], a[12:15], v[44:47], v[240:255]
  ds_read_b128 v[40:43], v205 offset:1024
  s_waitcnt lgkmcnt(2)
  v_mfma_f32_32x32x16_bf16 v[240:255], a[16:19], v[32:35], v[240:255]
  ds_read_b128 v[44:47], v206 offset:1024
  s_add_u32 m0, s67, 38656
  s_nop 0
  buffer_load_dwordx4 v202, s[4:7], s60 offen offset:256 lds
  s_waitcnt lgkmcnt(2)
  v_mfma_f32_32x32x16_bf16 v[240:255], a[20:23], v[36:39], v[240:255]
  ds_read_b128 v[32:35], v203 offset:2048
  s_waitcnt lgkmcnt(2)
  v_mfma_f32_32x32x16_bf16 v[240:255], a[24:27], v[40:43], v[240:255]
  ds_read_b128 v[36:39], v204 offset:2048
  s_add_u32 m0, s67, 39552
  s_nop 0
  buffer_load_dwordx4 v202, s[4:7], s60 offen offset:384 lds
  s_waitcnt lgkmcnt(2)
  v_mfma_f32_32x32x16_bf16 v[240:255], a[28:31], v[44:47], v[240:255]
  ds_read_b128 v[40:43], v205 offset:2048
  s_waitcnt lgkmcnt(2)
  v_mfma_f32_32x32x16_bf16 v[240:255], a[32:35], v[32:35], v[240:255]
  ds_read_b128 v[44:47], v206 offset:2048
  s_add_u32 m0, s67, 40448
  s_nop 0
  buffer_load_dwordx4 v202, s[4:7], s60 offen offset:512 lds
  s_waitcnt lgkmcnt(2)
  v_mfma_f32_32x32x16_bf16 v[240:255], a[36:39], v[36:39], v[240:255]
  ds_read_b128 v[32:35], v203 offset:3072
  s_waitcnt lgkmcnt(2)
  v_mfma_f32_32x32x16_bf16 v[240:255], a[40:43], v[40:43], v[240:255]
  ds_read_b128 v[36:39], v204 offset:3072
  s_add_u32 m0, s67, 41344
  s_nop 0
  buffer_load_dwordx4 v202, s[4:7], s60 offen offset:640 lds
  s_waitcnt lgkmcnt(2)
  v_mfma_f32_32x32x16_bf16 v[240:255], a[44:47], v[44:47], v[240:255]
  ds_read_b128 v[40:43], v205 offset:3072
  s_waitcnt lgkmcnt(2)
  v_mfma_f32_32x32x16_bf16 v[240:255], a[48:51], v[32:35], v[240:255]
  ds_read_b128 v[44:47], v206 offset:3072
  s_add_u32 m0, s67, 42240
  s_nop 0
  buffer_load_dwordx4 v202, s[4:7], s60 offen offset:768 lds
  s_waitcnt lgkmcnt(2)
  v_mfma_f32_32x32x16_bf16 v[240:255], a[52:55], v[36:39], v[240:255]
  ds_read_b128 v[32:35], v203 offset:4096
  s_waitcnt lgkmcnt(2)
  v_mfma_f32_32x32x16_bf16 v[240:255], a[56:59], v[40:43], v[240:255]
  ds_read_b128 v[36:39], v204 offset:4096
  s_add_u32 m0, s67, 43136
  s_nop 0
  buffer_load_dwordx4 v202, s[4:7], s60 offen offset:896 lds
  s_waitcnt lgkmcnt(2)
  v_mfma_f32_32x32x16_bf16 v[240:255], a[60:63], v[44:47], v[240:255]
  ds_read_b128 v[40:43], v205 offset:4096
  s_waitcnt lgkmcnt(2)
  v_mfma_f32_32x32x16_bf16 v[240:255], a[64:67], v[32:35], v[240:255]
  ds_read_b128 v[44:47], v206 offset:4096
  s_add_u32 m0, s67, 44032
  s_nop 0
  buffer_load_dwordx4 v202, s[4:7], s60 offen offset:1024 lds
  s_waitcnt lgkmcnt(2)
  v_mfma_f32_32x32x16_bf16 v[240:255], a[68:71], v[36:39], v[240:255]
  ds_read_b128 v[32:35], v203 offset:5120
  s_waitcnt lgkmcnt(2)
  v_mfma_f32_32x32x16_bf16 v[240:255], a[72:75], v[40:43], v[240:255]
  ds_read_b128 v[36:39], v204 offset:5120
  buffer_store_dwordx4 v[176:179], v201, s[8:11], s72 offen offset:0 sc1
  s_waitcnt lgkmcnt(2)
  v_mfma_f32_32x32x16_bf16 v[240:255], a[76:79], v[44:47], v[240:255]
  ds_read_b128 v[40:43], v205 offset:5120
  s_waitcnt lgkmcnt(2)
  v_mfma_f32_32x32x16_bf16 v[240:255], a[80:83], v[32:35], v[240:255]
  ds_read_b128 v[44:47], v206 offset:5120
  buffer_store_dwordx4 v[176:179], v201, s[8:11], s72 offen offset:1024 sc1
  s_waitcnt lgkmcnt(2)
  v_mfma_f32_32x32x16_bf16 v[240:255], a[84:87], v[36:39], v[240:255]
  ds_read_b128 v[32:35], v203 offset:6144
  s_waitcnt lgkmcnt(2)
  v_mfma_f32_32x32x16_bf16 v[240:255], a[88:91], v[40:43], v[240:255]
  ds_read_b128 v[36:39], v204 offset:6144
  s_waitcnt lgkmcnt(2)
  v_mfma_f32_32x32x16_bf16 v[240:255], a[92:95], v[44:47], v[240:255]
  ds_read_b128 v[40:43], v205 offset:6144
  s_waitcnt lgkmcnt(2)
  v_mfma_f32_32x32x16_bf16 v[240:255], a[96:99], v[32:35], v[240:255]
  ds_read_b128 v[44:47], v206 offset:6144
  s_waitcnt lgkmcnt(2)
  v_mfma_f32_32x32x16_bf16 v[240:255], a[100:103], v[36:39], v[240:255]
  ds_read_b128 v[32:35], v203 offset:7168
  s_waitcnt lgkmcnt(2)
  v_mfma_f32_32x32x16_bf16 v[240:255], a[104:107], v[40:43], v[240:255]
  ds_read_b128 v[36:39], v204 offset:7168
  s_waitcnt lgkmcnt(2)
  v_mfma_f32_32x32x16_bf16 v[240:255], a[108:111], v[44:47], v[240:255]
  ds_read_b128 v[40:43], v205 offset:7168
  s_waitcnt lgkmcnt(2)
  v_mfma_f32_32x32x16_bf16 v[240:255], a[112:115], v[32:35], v[240:255]
  ds_read_b128 v[44:47], v206 offset:7168
  s_waitcnt lgkmcnt(2)
  v_mfma_f32_32x32x16_bf16 v[240:255], a[116:119], v[36:39], v[240:255]
  ds_read_b128 v[32:35], v203 offset:8192
  s_waitcnt lgkmcnt(2)
  v_mfma_f32_32x32x16_bf16 v[240:255], a[120:123], v[40:43], v[240:255]
  ds_read_b128 v[36:39], v204 offset:8192
  s_waitcnt lgkmcnt(2)
  v_mfma_f32_32x32x16_bf16 v[240:255], a[124:127], v[44:47], v[240:255]
  ds_read_b128 v[40:43], v205 offset:8192
  s_waitcnt lgkmcnt(2)
  v_mfma_f32_32x32x16_bf16 v[240:255], a[128:131], v[32:35], v[240:255]
  ds_read_b128 v[44:47], v206 offset:8192
  s_waitcnt lgkmcnt(2)
  v_mfma_f32_32x32x16_bf16 v[240:255], a[132:135], v[36:39], v[240:255]
  s_waitcnt lgkmcnt(1)
  v_mfma_f32_32x32x16_bf16 v[240:255], a[136:139], v[40:43], v[240:255]
  s_waitcnt lgkmcnt(0)
  v_mfma_f32_32x32x16_bf16 v[240:255], a[140:143], v[44:47], v[240:255]
  s_nop 11
  v_cvt_pk_bf16_f32 v16, v240, v244
  v_cvt_pk_bf16_f32 v17, v241, v245
  v_cvt_pk_bf16_f32 v18, v242, v246
  v_cvt_pk_bf16_f32 v19, v243, v247
  ds_write_b128 v215, v[16:19] offset:0
  v_cvt_pk_bf16_f32 v20, v248, v252
  v_cvt_pk_bf16_f32 v21, v249, v253
  v_cvt_pk_bf16_f32 v22, v250, v254
  v_cvt_pk_bf16_f32 v23, v251, v255
  ds_write_b128 v215, v[20:23] offset:1024
  s_waitcnt lgkmcnt(0)
  s_barrier
  ds_read_b128 v[96:99], v208 offset:0
  ds_read_b128 v[100:103], v208 offset:1024
  ds_read_b128 v[104:107], v208 offset:2048
  ds_read_b128 v[108:111], v208 offset:3072
  ds_read_b128 v[112:115], v208 offset:4096
  ds_read_b128 v[116:119], v208 offset:5120
  ds_read_b128 v[120:123], v208 offset:6144
  ds_read_b128 v[124:127], v208 offset:7168
  s_waitcnt vmcnt(20) lgkmcnt(7)
  v_mfma_f32_32x32x16_bf16 v[64:79], v[128:131], v[96:99], v[48:63]
  s_waitcnt vmcnt(19) lgkmcnt(6)
  v_mfma_f32_32x32x16_bf16 v[64:79], v[132:135], v[100:103], v[64:79]
  s_waitcnt vmcnt(18) lgkmcnt(5)
  v_mfma_f32_32x32x16_bf16 v[64:79], v[136:139], v[104:107], v[64:79]
  s_waitcnt vmcnt(17) lgkmcnt(4)
  v_mfma_f32_32x32x16_bf16 v[64:79], v[140:143], v[108:111], v[64:79]
  s_waitcnt vmcnt(16) lgkmcnt(3)
  v_mfma_f32_32x32x16_bf16 v[64:79], v[144:147], v[112:115], v[64:79]
  s_waitcnt vmcnt(15) lgkmcnt(2)
  v_mfma_f32_32x32x16_bf16 v[64:79], v[148:151], v[116:119], v[64:79]
  s_waitcnt vmcnt(14) lgkmcnt(1)
  v_mfma_f32_32x32x16_bf16 v[64:79], v[152:155], v[120:123], v[64:79]
  s_waitcnt vmcnt(13) lgkmcnt(0)
  v_mfma_f32_32x32x16_bf16 v[64:79], v[156:159], v[124:127], v[64:79]
  s_nop 11
  v_max3_f32 v180, v64, v65, v66
  v_max3_f32 v180, v180, v67, v68
  v_max3_f32 v180, v180, v69, v70
  v_max3_f32 v180, v180, v71, v72
  v_max3_f32 v180, v180, v73, v74
  v_max3_f32 v180, v180, v75, v76
  v_max3_f32 v180, v180, v77, v78
  v_max_f32 v180, v180, v79
  v_mov_b32 v181, v180
  s_nop 1
  v_permlane32_swap_b32 v180, v181
  v_max_f32 v180, v180, v181
  v_sub_f32 v64, v64, v180
  v_sub_f32 v65, v65, v180
  v_sub_f32 v66, v66, v180
  v_sub_f32 v67, v67, v180
  v_sub_f32 v68, v68, v180
  v_sub_f32 v69, v69, v180
  v_sub_f32 v70, v70, v180
  v_sub_f32 v71, v71, v180
  v_sub_f32 v72, v72, v180
  v_sub_f32 v73, v73, v180
  v_sub_f32 v74, v74, v180
  v_sub_f32 v75, v75, v180
  v_sub_f32 v76, v76, v180
  v_sub_f32 v77, v77, v180
  v_sub_f32 v78, v78, v180
  v_sub_f32 v79, v79, v180
  v_exp_f32 v64, v64
  v_exp_f32 v65, v65
  v_exp_f32 v66, v66
  v_exp_f32 v67, v67
  v_exp_f32 v68, v68
  v_exp_f32 v69, v69
  v_exp_f32 v70, v70
  v_exp_f32 v71, v71
  v_exp_f32 v72, v72
  v_exp_f32 v73, v73
  v_exp_f32 v74, v74
  v_exp_f32 v75, v75
  v_exp_f32 v76, v76
  v_exp_f32 v77, v77
  v_exp_f32 v78, v78
  v_exp_f32 v79, v79
  v_cvt_pk_bf16_f32 v20, v64, v65
  v_cvt_pk_bf16_f32 v21, v68, v69
  v_cvt_pk_bf16_f32 v22, v72, v73
  v_cvt_pk_bf16_f32 v23, v76, v77
  v_cvt_pk_bf16_f32 v24, v66, v67
  v_cvt_pk_bf16_f32 v25, v70, v71
  v_cvt_pk_bf16_f32 v26, v74, v75
  v_cvt_pk_bf16_f32 v27, v78, v79
  s_waitcnt vmcnt(12)
  v_mfma_f32_32x32x16_bf16 v[0:15], v[160:163], v[20:23], 0
  v_add_f32 v182, v64, v65
  v_add_f32 v182, v182, v66
  v_add_f32 v182, v182, v67
  v_add_f32 v182, v182, v68
  v_add_f32 v182, v182, v69
  v_add_f32 v182, v182, v70
  v_add_f32 v182, v182, v71
  s_waitcnt vmcnt(11)
  v_mfma_f32_32x32x16_bf16 v[0:15], v[164:167], v[24:27], v[0:15]
  v_add_f32 v182, v182, v72
  v_add_f32 v182, v182, v73
  v_add_f32 v182, v182, v74
  v_add_f32 v182, v182, v75
  v_add_f32 v182, v182, v76
  v_add_f32 v182, v182, v77
  v_add_f32 v182, v182, v78
  v_add_f32 v182, v182, v79
  s_waitcnt vmcnt(0)
  s_barrier
AT_loop:
  s_cmp_ge_u32 s59, 64
  s_cbranch_scc1 AT_l0
  s_mov_b32 s77, s59
  s_mul_i32 s66, s59, 655360
  s_lshl_b32 s55, s58, 14
  s_add_u32 s55, s55, s66
  s_add_u32 s55, s55, 1048576
  s_lshl_b32 s76, s58, 2
  s_add_u32 s76, s76, s52
  s_lshl_b32 s75, s59, 7
  s_add_u32 s75, s75, s76
  s_lshl_b32 s75, s75, 11
  s_add_u32 s75, s75, 46137344
  s_lshl_b32 s76, s76, 10
  s_add_u32 s76, s76, s66
  s_add_u32 s76, s76, 1572864
  s_add_u32 s59, s59, 2
  buffer_load_dwordx4 v[128:131], v216, s[8:11], s55 offen offset:0 sc1
  buffer_load_dwordx4 v[132:135], v216, s[8:11], s55 offen offset:256 sc1
  buffer_load_dwordx4 v[136:139], v216, s[8:11], s55 offen offset:512 sc1
  buffer_load_dwordx4 v[140:143], v216, s[8:11], s55 offen offset:768 sc1
  buffer_load_dwordx4 v[144:147], v216, s[8:11], s55 offen offset:1024 sc1
  buffer_load_dwordx4 v[148:151], v216, s[8:11], s55 offen offset:1280 sc1
  buffer_load_dwordx4 v[152:155], v216, s[8:11], s55 offen offset:1536 sc1
  buffer_load_dwordx4 v[156:159], v216, s[8:11], s55 offen offset:1792 sc1
  buffer_load_dwordx4 v[160:163], v217, s[8:11], s55 offen offset:0 sc1
  buffer_load_dwordx4 v[164:167], v217, s[8:11], s55 offen offset:256 sc1
  s_or_b32 s70, s73, 0xc00
  buffer_load_dword v172, off, s[8:11], s70 sc1
  s_add_u32 s60, s60, 73728
  ds_read_b128 v[32:35], v203 offset:36864
  ds_read_b128 v[36:39], v204 offset:36864
  ds_read_b128 v[40:43], v205 offset:36864
  s_waitcnt lgkmcnt(2)
  v_mfma_f32_32x32x16_bf16 v[240:255], a[0:3], v[32:35], 0
  ds_read_b128 v[44:47], v206 offset:36864
  s_add_u32 m0, s67, 0
  s_nop 0
  buffer_load_dwordx4 v202, s[4:7], s60 offen offset:0 lds
  s_waitcnt lgkmcnt(2)
  v_mfma_f32_32x32x16_bf16 v[240:255], a[4:7], v[36:39], v[240:255]
  ds_read_b128 v[32:35], v203 offset:37888
  s_waitcnt lgkmcnt(2)
  v_mfma_f32_32x32x16_bf16 v[240:255], a[8:11], v[40:43], v[240:255]
  ds_read_b128 v[36:39], v204 offset:37888
  s_add_u32 m0, s67, 896
  s_nop 0
  buffer_load_dwordx4 v202, s[4:7], s60 offen offset:128 lds
  s_waitcnt lgkmcnt(2)
  v_mfma_f32_32x32x16_bf16 v[240:255], a[12:15], v[44:47], v[240:255]
  ds_read_b128 v[40:43], v205 offset:37888
  s_waitcnt lgkmcnt(2)
  v_mfma_f32_32x32x16_bf16 v[240:255], a[16:19], v[32:35], v[240:255]
  ds_read_b128 v[44:47], v206 offset:37888
  s_add_u32 m0, s67, 1792
  s_nop 0
  buffer_load_dwordx4 v202, s[4:7], s60 offen offset:256 lds
  s_waitcnt lgkmcnt(2)
  v_mfma_f32_32x32x16_bf16 v[240:255], a[20:23], v[36:39], v[240:255]
  ds_read_b128 v[32:35], v203 offset:38912
  s_waitcnt lgkmcnt(2)
  v_mfma_f32_32x32x16_bf16 v[240:255], a[24:27], v[40:43], v[240:255]
  ds_read_b128 v[36:39], v204 offset:38912
  s_add_u32 m0, s67, 2688
  s_nop 0
  buffer_load_dwordx4 v202, s[4:7], s60 offen offset:384 lds
  s_waitcnt lgkmcnt(2)
  v_mfma_f32_32x32x16_bf16 v[240:255], a[28:31], v[44:47], v[240:255]
  ds_read_b128 v[40:43], v205 offset:38912
  s_waitcnt lgkmcnt(2)
  v_mfma_f32_32x32x16_bf16 v[240:255], a[32:35], v[32:35], v[240:255]
  ds_read_b128 v[44:47], v206 offset:38912
  s_add_u32 m0, s67, 3584
  s_nop 0
  buffer_load_dwordx4 v202, s[4:7], s60 offen offset:512 lds
  s_waitcnt lgkmcnt(2)
  v_mfma_f32_32x32x16_bf16 v[240:255], a[36:39], v[36:39], v[240:255]
  ds_read_b128 v[32:35], v203 offset:39936
  s_waitcnt lgkmcnt(2)
  v_mfma_f32_32x32x16_bf16 v[240:255], a[40:43], v[40:43], v[240:255]
  ds_read_b128 v[36:39], v204 offset:39936
  s_add_u32 m0, s67, 4480
  s_nop 0
  buffer_load_dwordx4 v202, s[4:7], s60 offen offset:640 lds
  s_waitcnt lgkmcnt(2)
  v_mfma_f32_32x32x16_bf16 v[240:255], a[44:47], v[44:47], v[240:255]
  ds_read_b128 v[40:43], v205 offset:39936
  s_waitcnt lgkmcnt(2)
  v_mfma_f32_32x32x16_bf16 v[240:255], a[48:51], v[32:35], v[240:255]
  ds_read_b128 v[44:47], v206 offset:39936
  s_add_u32 m0, s67, 5376
  s_nop 0
  buffer_load_dwordx4 v202, s[4:7], s60 offen offset:768 lds
  s_waitcnt lgkmcnt(2)
  v_mfma_f32_32x32x16_bf16 v[240:255], a[52:55], v[36:39], v[240:255]
  ds_read_b128 v[32:35], v203 offset:40960
  s_waitcnt lgkmcnt(2)
  v_mfma_f32_32x32x16_bf16 v[240:255], a[56:59], v[40:43], v[240:255]
  ds_read_b128 v[36:39], v204 offset:40960
  s_add_u32 m0, s67, 6272
  s_nop 0
  buffer_load_dwordx4 v202, s[4:7], s60 offen offset:896 lds
  s_waitcnt lgkmcnt(2)
  v_mfma_f32_32x32x16_bf16 v[240:255], a[60:63], v[44:47], v[240:255]
  ds_read_b128 v[40:43], v205 offset:40960
  s_waitcnt lgkmcnt(2)
  v_mfma_f32_32x32x16_bf16 v[240:255], a[64:67], v[32:35], v[240:255]
  ds_read_b128 v[44:47], v206 offset:40960
  s_add_u32 m0, s67, 7168
  s_nop 0
  buffer_load_dwordx4 v202, s[4:7], s60 offen offset:1024 lds
  s_waitcnt lgkmcnt(2)
  v_mfma_f32_32x32x16_bf16 v[240:255], a[68:71], v[36:39], v[240:255]
  ds_read_b128 v[32:35], v203 offset:41984
  s_waitcnt lgkmcnt(2)
  v_mfma_f32_32x32x16_bf16 v[240:255], a[72:75], v[40:43], v[240:255]
  ds_read_b128 v[36:39], v204 offset:41984
  buffer_store_dwordx4 v[176:179], v201, s[8:11], s75 offen offset:0 sc1
  s_waitcnt lgkmcnt(2)
  v_mfma_f32_32x32x16_bf16 v[240:255], a[76:79], v[44:47], v[240:255]
  ds_read_b128 v[40:43], v205 offset:41984
  s_waitcnt lgkmcnt(2)
  v_mfma_f32_32x32x16_bf16 v[240:255], a[80:83], v[32:35], v[240:255]
  ds_read_b128 v[44:47], v206 offset:41984
  buffer_store_dwordx4 v[176:179], v201, s[8:11], s75 offen offset:1024 sc1
  s_waitcnt lgkmcnt(2)
  v_mfma_f32_32x32x16_bf16 v[240:255], a[84:87], v[36:39], v[240:255]
  ds_read_b128 v[32:35], v203 offset:43008
  s_waitcnt lgkmcnt(2)
  v_mfma_f32_32x32x16_bf16 v[240:255], a[88:91], v[40:43], v[240:255]
  ds_read_b128 v[36:39], v204 offset:43008
  s_waitcnt lgkmcnt(2)
  v_mfma_f32_32x32x16_bf16 v[240:255], a[92:95], v[44:47], v[240:255]
  ds_read_b128 v[40:43], v205 offset:43008
  s_waitcnt lgkmcnt(2)
  v_mfma_f32_32x32x16_bf16 v[240:255], a[96:99], v[32:35], v[240:255]
  ds_read_b128 v[44:47], v206 offset:43008
  s_waitcnt lgkmcnt(2)
  v_mfma_f32_32x32x16_bf16 v[240:255], a[100:103], v[36:39], v[240:255]
  ds_read_b128 v[32:35], v203 offset:44032
  s_waitcnt lgkmcnt(2)
  v_mfma_f32_32x32x16_bf16 v[240:255], a[104:107], v[40:43], v[240:255]
  ds_read_b128 v[36:39], v204 offset:44032
  s_waitcnt lgkmcnt(2)
  v_mfma_f32_32x32x16_bf16 v[240:255], a[108:111], v[44:47], v[240:255]
  ds_read_b128 v[40:43], v205 offset:44032
  s_waitcnt lgkmcnt(2)
  v_mfma_f32_32x32x16_bf16 v[240:255], a[112:115], v[32:35], v[240:255]
  ds_read_b128 v[44:47], v206 offset:44032
  s_waitcnt lgkmcnt(2)
  v_mfma_f32_32x32x16_bf16 v[240:255], a[116:119], v[36:39], v[240:255]
  ds_read_b128 v[32:35], v203 offset:45056
  s_waitcnt lgkmcnt(2)
  v_mfma_f32_32x32x16_bf16 v[240:255], a[120:123], v[40:43], v[240:255]
  ds_read_b128 v[36:39], v204 offset:45056
  s_waitcnt lgkmcnt(2)
  v_mfma_f32_32x32x16_bf16 v[240:255], a[124:127], v[44:47], v[240:255]
  ds_read_b128 v[40:43], v205 offset:45056
  s_waitcnt lgkmcnt(2)
  v_mfma_f32_32x32x16_bf16 v[240:255], a[128:131], v[32:35], v[240:255]
  ds_read_b128 v[44:47], v206 offset:45056
  s_waitcnt lgkmcnt(2)
  v_mfma_f32_32x32x16_bf16 v[240:255], a[132:135], v[36:39], v[240:255]
  s_waitcnt lgkmcnt(1)
  v_mfma_f32_32x32x16_bf16 v[240:255], a[136:139], v[40:43], v[240:255]
  s_waitcnt lgkmcnt(0)
  v_mfma_f32_32x32x16_bf16 v[240:255], a[140:143], v[44:47], v[240:255]
  s_nop 11
  v_cvt_pk_bf16_f32 v16, v240, v244
  v_cvt_pk_bf16_f32 v17, v241, v245
  v_cvt_pk_bf16_f32 v18, v242, v246
  v_cvt_pk_bf16_f32 v19, v243, v247
  ds_write_b128 v215, v[16:19] offset:0
  v_cvt_pk_bf16_f32 v20, v248, v252
  v_cvt_pk_bf16_f32 v21, v249, v253
  v_cvt_pk_bf16_f32 v22, v250, v254
  v_cvt_pk_bf16_f32 v23, v251, v255
  ds_write_b128 v215, v[20:23] offset:1024
  s_waitcnt lgkmcnt(0)
  s_barrier
  ds_read_b128 a[144:147], v208 offset:0
  ds_read_b128 a[148:151], v208 offset:1024
  ds_read_b128 a[152:155], v208 offset:2048
  ds_read_b128 a[156:159], v208 offset:3072
  ds_read_b128 a[160:163], v208 offset:4096
  ds_read_b128 a[164:167], v208 offset:5120
  ds_read_b128 a[168:171], v208 offset:6144
  ds_read_b128 a[172:175], v208 offset:7168
  s_waitcnt vmcnt(11)
  v_cmp_eq_u32 vcc, -1, v172
  s_mov_b32 s69, 0
  s_cbranch_vccnz AT_e1
  s_mov_b32 s69, 1
  buffer_load_dwordx4 v[172:175], v201, s[8:11], s73 offen sc1
AT_e1:
  s_waitcnt lgkmcnt(7)
  v_mfma_f32_32x32x16_bf16 v[64:79], v[128:131], a[144:147], v[48:63]
  s_waitcnt lgkmcnt(6)
  v_mfma_f32_32x32x16_bf16 v[64:79], v[132:135], a[148:151], v[64:79]
  s_waitcnt lgkmcnt(5)
  v_mfma_f32_32x32x16_bf16 v[64:79], v[136:139], a[152:155], v[64:79]
  s_waitcnt lgkmcnt(4)
  v_mfma_f32_32x32x16_bf16 v[64:79], v[140:143], a[156:159], v[64:79]
  s_waitcnt lgkmcnt(3)
  v_mfma_f32_32x32x16_bf16 v[64:79], v[144:147], a[160:163], v[64:79]
  s_waitcnt lgkmcnt(2)
  v_mfma_f32_32x32x16_bf16 v[64:79], v[148:151], a[164:167], v[64:79]
  s_waitcnt lgkmcnt(1)
  v_mfma_f32_32x32x16_bf16 v[64:79], v[152:155], a[168:171], v[64:79]
  s_waitcnt lgkmcnt(0)
  v_mfma_f32_32x32x16_bf16 v[64:79], v[156:159], a[172:175], v[64:79]
  s_nop 11
  v_max3_f32 v184, v64, v65, v66
  v_max3_f32 v184, v184, v67, v68
  v_max3_f32 v184, v184, v69, v70
  v_max3_f32 v184, v184, v71, v72
  v_max3_f32 v184, v184, v73, v74
  v_max3_f32 v184, v184, v75, v76
  v_max3_f32 v184, v184, v77, v78
  v_max_f32 v184, v184, v79
  v_mov_b32 v185, v184
  s_nop 1
  v_permlane32_swap_b32 v184, v185
  v_max_f32 v184, v184, v185
  v_sub_f32 v64, v64, v184
  v_sub_f32 v65, v65, v184
  v_sub_f32 v66, v66, v184
  v_sub_f32 v67, v67, v184
  v_sub_f32 v68, v68, v184
  v_sub_f32 v69, v69, v184
  v_sub_f32 v70, v70, v184
  v_sub_f32 v71, v71, v184
  v_sub_f32 v72, v72, v184
  v_sub_f32 v73, v73, v184
  v_sub_f32 v74, v74, v184
  v_sub_f32 v75, v75, v184
  v_sub_f32 v76, v76, v184
  v_sub_f32 v77, v77, v184
  v_sub_f32 v78, v78, v184
  v_sub_f32 v79, v79, v184
  v_exp_f32 v64, v64
  v_exp_f32 v65, v65
  v_exp_f32 v66, v66
  v_exp_f32 v67, v67
  v_exp_f32 v68, v68
  v_exp_f32 v69, v69
  v_exp_f32 v70, v70
  v_exp_f32 v71, v71
  v_exp_f32 v72, v72
  v_exp_f32 v73, v73
  v_exp_f32 v74, v74
  v_exp_f32 v75, v75
  v_exp_f32 v76, v76
  v_exp_f32 v77, v77
  v_exp_f32 v78, v78
  v_exp_f32 v79, v79
  v_cvt_pk_bf16_f32 v20, v64, v65
  v_cvt_pk_bf16_f32 v21, v68, v69
  v_cvt_pk_bf16_f32 v22, v72, v73
  v_cvt_pk_bf16_f32 v23, v76, v77
  v_cvt_pk_bf16_f32 v24, v66, v67
  v_cvt_pk_bf16_f32 v25, v70, v71
  v_cvt_pk_bf16_f32 v26, v74, v75
  v_cvt_pk_bf16_f32 v27, v78, v79
  v_mfma_f32_32x32x16_bf16 v[224:239], v[160:163], v[20:23], 0
  v_add_f32 v186, v64, v65
  v_add_f32 v186, v186, v66
  v_add_f32 v186, v186, v67
  v_add_f32 v186, v186, v68
  v_add_f32 v186, v186, v69
  v_add_f32 v186, v186, v70
  v_add_f32 v186, v186, v71
  v_mfma_f32_32x32x16_bf16 v[224:239], v[164:167], v[24:27], v[224:239]
  v_add_f32 v186, v186, v72
  v_add_f32 v186, v186, v73
  v_add_f32 v186, v186, v74
  v_add_f32 v186, v186, v75
  v_add_f32 v186, v186, v76
  v_add_f32 v186, v186, v77
  v_add_f32 v186, v186, v78
  v_add_f32 v186, v186, v79
AT_l0:
  s_cmp_eq_u32 s69, 1
  s_cbranch_scc1 AT_v0
  s_or_b32 s70, s73, 0xc00
  s_cmp_eq_u32 s74, 63
  s_cselect_b32 s54, 655360, 0
  s_sub_u32 s70, s70, s54
  s_branch AT_c0
AT_h0:
  s_sleep 1
AT_c0:
  buffer_load_dword v172, off, s[8:11], s70 sc1
  s_add_u32 s65, s65, 1
  s_cmp_lt_u32 s65, 131072
  s_cselect_b32 s54, -2, -1
  s_waitcnt vmcnt(0)
  v_cmp_lt_u32 vcc, s54, v172
  s_cbranch_vccnz AT_h0
AT_k0:
  buffer_load_dwordx4 v[172:175], v201, s[8:11], s73 offen sc1
AT_v0:
  s_mov_b32 s69, 0
  s_add_u32 s65, s65, 1
  s_cmp_lt_u32 s65, 131072
  s_cselect_b32 s54, -2, -1
  s_waitcnt vmcnt(0)
  ds_write_b64 v220, v[172:173] offset:0
  ds_write_b64 v221, v[174:175] offset:0
  v_max3_u32 v213, v172, v173, v174
  v_max_u32 v213, v213, v175
  v_cmp_lt_u32 vcc, s54, v213
  s_cbranch_vccnz AT_k0
  s_waitcnt lgkmcnt(0)
  s_barrier
  ds_read_b128 v[128:131], v218 offset:0
  ds_read_b128 v[132:135], v218 offset:256
  ds_read_b128 v[136:139], v218 offset:512
  ds_read_b128 v[140:143], v218 offset:768
  ds_read_b128 v[144:147], v218 offset:1024
  ds_read_b128 v[148:151], v218 offset:1280
  ds_read_b128 v[152:155], v218 offset:1536
  ds_read_b128 v[156:159], v218 offset:1792
  ds_read_b32 v168, v219 offset:0
  ds_read_b32 v169, v219 offset:128
  s_add_u32 s74, s74, 2
  v_mov_b32 v212, s74
  s_waitcnt lgkmcnt(9)
  v_mfma_f32_32x32x16_bf16 v[80:95], v[128:131], v[96:99], 0
  s_waitcnt lgkmcnt(8)
  v_mfma_f32_32x32x16_bf16 v[80:95], v[132:135], v[100:103], v[80:95]
  s_waitcnt lgkmcnt(7)
  v_mfma_f32_32x32x16_bf16 v[80:95], v[136:139], v[104:107], v[80:95]
  s_waitcnt lgkmcnt(6)
  v_mfma_f32_32x32x16_bf16 v[80:95], v[140:143], v[108:111], v[80:95]
  s_mov_b64 exec, 1
  buffer_store_dword v212, v201, s[8:11], s71 offen sc1
  s_mov_b64 exec, -1
  s_waitcnt lgkmcnt(5)
  v_mfma_f32_32x32x16_bf16 v[80:95], v[144:147], v[112:115], v[80:95]
  s_waitcnt lgkmcnt(4)
  v_mfma_f32_32x32x16_bf16 v[80:95], v[148:151], v[116:119], v[80:95]
  s_waitcnt lgkmcnt(3)
  v_mfma_f32_32x32x16_bf16 v[80:95], v[152:155], v[120:123], v[80:95]
  s_waitcnt lgkmcnt(2)
  v_mfma_f32_32x32x16_bf16 v[80:95], v[156:159], v[124:127], v[80:95]
  s_nop 11
  v_mul_f32 v80, s68, v80
  v_mul_f32 v81, s68, v81
  v_mul_f32 v82, s68, v82
  v_mul_f32 v83, s68, v83
  v_max3_f32 v84, v180, v80, v81
  v_max3_f32 v84, v84, v82, v83
  v_mov_b32 v85, v84
  s_nop 1
  v_permlane32_swap_b32 v84, v85
  v_max_f32 v84, v84, v85
  v_sub_f32 v86, v180, v84
  v_sub_f32 v80, v80, v84
  v_sub_f32 v81, v81, v84
  v_sub_f32 v82, v82, v84
  v_sub_f32 v83, v83, v84
  v_exp_f32 v86, v86
  v_exp_f32 v80, v80
  v_exp_f32 v81, v81
  v_exp_f32 v82, v82
  v_exp_f32 v83, v83
  v_fma_f32 v182, v182, v86, v80
  v_add_f32 v84, v81, v82
  v_add_f32 v182, v182, v83
  v_add_f32 v182, v182, v84
  v_mov_b32 v183, v182
  s_nop 1
  v_permlane32_swap_b32 v182, v183
  v_add_f32 v182, v182, v183
  v_rcp_f32 v182, v182
  s_nop 0
  v_mul_f32 v86, v86, v182
  v_mul_f32 v80, v182, v80
  v_mul_f32 v81, v182, v81
  v_mul_f32 v82, v182, v82
  v_mul_f32 v83, v182, v83
  v_cvt_pk_bf16_f32 v28, v80, v81
  v_cvt_pk_bf16_f32 v29, v82, v83
  v_mul_f32 v0, v86, v0
  v_mul_f32 v1, v86, v1
  v_mul_f32 v2, v86, v2
  v_mul_f32 v3, v86, v3
  v_mul_f32 v4, v86, v4
  v_mul_f32 v5, v86, v5
  v_mul_f32 v6, v86, v6
  v_mul_f32 v7, v86, v7
  v_mul_f32 v8, v86, v8
  v_mul_f32 v9, v86, v9
  v_mul_f32 v10, v86, v10
  v_mul_f32 v11, v86, v11
  v_mul_f32 v12, v86, v12
  v_mul_f32 v13, v86, v13
  v_mul_f32 v14, v86, v14
  v_mul_f32 v15, v86, v15
  s_waitcnt lgkmcnt(0)
  s_nop 0
  v_mfma_f32_32x32x8_bf16 v[0:15], v[168:169], v[28:29], v[0:15]
  s_nop 11
  v_cvt_pk_bf16_f32 v20, v0, v1
  v_cvt_pk_bf16_f32 v21, v2, v3
  v_cvt_pk_bf16_f32 v22, v4, v5
  v_cvt_pk_bf16_f32 v23, v6, v7
  buffer_store_dwordx4 v[20:23], v201, s[8:11], s72 offen offset:0 sc1
  v_cvt_pk_bf16_f32 v24, v8, v9
  v_cvt_pk_bf16_f32 v25, v10, v11
  v_cvt_pk_bf16_f32 v26, v12, v13
  v_cvt_pk_bf16_f32 v27, v14, v15
  buffer_store_dwordx4 v[24:27], v201, s[8:11], s72 offen offset:1024 sc1
  s_cmp_ge_u32 s74, 64
  s_cbranch_scc1 L_exit
  s_cmp_ge_u32 s59, 64
  s_cbranch_scc1 AT_l1
  s_mov_b32 s74, s59
  s_mul_i32 s66, s59, 655360
  s_lshl_b32 s55, s58, 14
  s_add_u32 s55, s55, s66
  s_add_u32 s55, s55, 1048576
  s_lshl_b32 s73, s58, 2
  s_add_u32 s73, s73, s52
  s_lshl_b32 s72, s59, 7
  s_add_u32 s72, s72, s73
  s_lshl_b32 s72, s72, 11
  s_add_u32 s72, s72, 46137344
  s_lshl_b32 s73, s73, 10
  s_add_u32 s73, s73, s66
  s_add_u32 s73, s73, 1572864
  s_add_u32 s59, s59, 2
  buffer_load_dwordx4 v[128:131], v216, s[8:11], s55 offen offset:0 sc1
  buffer_load_dwordx4 v[132:135], v216, s[8:11], s55 offen offset:256 sc1
  buffer_load_dwordx4 v[136:139], v216, s[8:11], s55 offen offset:512 sc1
  buffer_load_dwordx4 v[140:143], v216, s[8:11], s55 offen offset:768 sc1
  buffer_load_dwordx4 v[144:147], v216, s[8:11], s55 offen offset:1024 sc1
  buffer_load_dwordx4 v[148:151], v216, s[8:11], s55 offen offset:1280 sc1
  buffer_load_dwordx4 v[152:155], v216, s[8:11], s55 offen offset:1536 sc1
  buffer_load_dwordx4 v[156:159], v216, s[8:11], s55 offen offset:1792 sc1
  buffer_load_dwordx4 v[160:163], v217, s[8:11], s55 offen offset:0 sc1
  buffer_load_dwordx4 v[164:167], v217, s[8:11], s55 offen offset:256 sc1
  s_or_b32 s70, s76, 0xc00
  buffer_load_dword v172, off, s[8:11], s70 sc1
  s_add_u32 s60, s60, 73728
  ds_read_b128 v[32:35], v203 offset:0
  ds_read_b128 v[36:39], v204 offset:0
  ds_read_b128 v[40:43], v205 offset:0
  s_waitcnt lgkmcnt(2)
  v_mfma_f32_32x32x16_bf16 v[240:255], a[0:3], v[32:35], 0
  ds_read_b128 v[44:47], v206 offset:0
  s_add_u32 m0, s67, 36864
  s_nop 0
  buffer_load_dwordx4 v202, s[4:7], s60 offen offset:0 lds
  s_waitcnt lgkmcnt(2)
  v_mfma_f32_32x32x16_bf16 v[240:255], a[4:7], v[36:39], v[240:255]
  ds_read_b128 v[32:35], v203 offset:1024
  s_waitcnt lgkmcnt(2)
  v_mfma_f32_32x32x16_bf16 v[240:255], a[8:11], v[40:43], v[240:255]
  ds_read_b128 v[36:39], v204 offset:1024
  s_add_u32 m0, s67, 37760
  s_nop 0
  buffer_load_dwordx4 v202, s[4:7], s60 offen offset:128 lds
  s_waitcnt lgkmcnt(2)
  v_mfma_f32_32x32x16_bf16 v[240:255], a[12:15], v[44:47], v[240:255]
  ds_read_b128 v[40:43], v205 offset:1024
  s_waitcnt lgkmcnt(2)
  v_mfma_f32_32x32x16_bf16 v[240:255], a[16:19], v[32:35], v[240:255]
  ds_read_b128 v[44:47], v206 offset:1024
  s_add_u32 m0, s67, 38656
  s_nop 0
  buffer_load_dwordx4 v202, s[4:7], s60 offen offset:256 lds
  s_waitcnt lgkmcnt(2)
  v_mfma_f32_32x32x16_bf16 v[240:255], a[20:23], v[36:39], v[240:255]
  ds_read_b128 v[32:35], v203 offset:2048
  s_waitcnt lgkmcnt(2)
  v_mfma_f32_32x32x16_bf16 v[240:255], a[24:27], v[40:43], v[240:255]
  ds_read_b128 v[36:39], v204 offset:2048
  s_add_u32 m0, s67, 39552
  s_nop 0
  buffer_load_dwordx4 v202, s[4:7], s60 offen offset:384 lds
  s_waitcnt lgkmcnt(2)
  v_mfma_f32_32x32x16_bf16 v[240:255], a[28:31], v[44:47], v[240:255]
  ds_read_b128 v[40:43], v205 offset:2048
  s_waitcnt lgkmcnt(2)
  v_mfma_f32_32x32x16_bf16 v[240:255], a[32:35], v[32:35], v[240:255]
  ds_read_b128 v[44:47], v206 offset:2048
  s_add_u32 m0, s67, 40448
  s_nop 0
  buffer_load_dwordx4 v202, s[4:7], s60 offen offset:512 lds
  s_waitcnt lgkmcnt(2)
  v_mfma_f32_32x32x16_bf16 v[240:255], a[36:39], v[36:39], v[240:255]
  ds_read_b128 v[32:35], v203 offset:3072
  s_waitcnt lgkmcnt(2)
  v_mfma_f32_32x32x16_bf16 v[240:255], a[40:43], v[40:43], v[240:255]
  ds_read_b128 v[36:39], v204 offset:3072
  s_add_u32 m0, s67, 41344
  s_nop 0
  buffer_load_dwordx4 v202, s[4:7], s60 offen offset:640 lds
  s_waitcnt lgkmcnt(2)
  v_mfma_f32_32x32x16_bf16 v[240:255], a[44:47], v[44:47], v[240:255]
  ds_read_b128 v[40:43], v205 offset:3072
  s_waitcnt lgkmcnt(2)
  v_mfma_f32_32x32x16_bf16 v[240:255], a[48:51], v[32:35], v[240:255]
  ds_read_b128 v[44:47], v206 offset:3072
  s_add_u32 m0, s67, 42240
  s_nop 0
  buffer_load_dwordx4 v202, s[4:7], s60 offen offset:768 lds
  s_waitcnt lgkmcnt(2)
  v_mfma_f32_32x32x16_bf16 v[240:255], a[52:55], v[36:39], v[240:255]
  ds_read_b128 v[32:35], v203 offset:4096
  s_waitcnt lgkmcnt(2)
  v_mfma_f32_32x32x16_bf16 v[240:255], a[56:59], v[40:43], v[240:255]
  ds_read_b128 v[36:39], v204 offset:4096
  s_add_u32 m0, s67, 43136
  s_nop 0
  buffer_load_dwordx4 v202, s[4:7], s60 offen offset:896 lds
  s_waitcnt lgkmcnt(2)
  v_mfma_f32_32x32x16_bf16 v[240:255], a[60:63], v[44:47], v[240:255]
  ds_read_b128 v[40:43], v205 offset:4096
  s_waitcnt lgkmcnt(2)
  v_mfma_f32_32x32x16_bf16 v[240:255], a[64:67], v[32:35], v[240:255]
  ds_read_b128 v[44:47], v206 offset:4096
  s_add_u32 m0, s67, 44032
  s_nop 0
  buffer_load_dwordx4 v202, s[4:7], s60 offen offset:1024 lds
  s_waitcnt lgkmcnt(2)
  v_mfma_f32_32x32x16_bf16 v[240:255], a[68:71], v[36:39], v[240:255]
  ds_read_b128 v[32:35], v203 offset:5120
  s_waitcnt lgkmcnt(2)
  v_mfma_f32_32x32x16_bf16 v[240:255], a[72:75], v[40:43], v[240:255]
  ds_read_b128 v[36:39], v204 offset:5120
  buffer_store_dwordx4 v[176:179], v201, s[8:11], s72 offen offset:0 sc1
  s_waitcnt lgkmcnt(2)
  v_mfma_f32_32x32x16_bf16 v[240:255], a[76:79], v[44:47], v[240:255]
  ds_read_b128 v[40:43], v205 offset:5120
  s_waitcnt lgkmcnt(2)
  v_mfma_f32_32x32x16_bf16 v[240:255], a[80:83], v[32:35], v[240:255]
  ds_read_b128 v[44:47], v206 offset:5120
  buffer_store_dwordx4 v[176:179], v201, s[8:11], s72 offen offset:1024 sc1
  s_waitcnt lgkmcnt(2)
  v_mfma_f32_32x32x16_bf16 v[240:255], a[84:87], v[36:39], v[240:255]
  ds_read_b128 v[32:35], v203 offset:6144
  s_waitcnt lgkmcnt(2)
  v_mfma_f32_32x32x16_bf16 v[240:255], a[88:91], v[40:43], v[240:255]
  ds_read_b128 v[36:39], v204 offset:6144
  s_waitcnt lgkmcnt(2)
  v_mfma_f32_32x32x16_bf16 v[240:255], a[92:95], v[44:47], v[240:255]
  ds_read_b128 v[40:43], v205 offset:6144
  s_waitcnt lgkmcnt(2)
  v_mfma_f32_32x32x16_bf16 v[240:255], a[96:99], v[32:35], v[240:255]
  ds_read_b128 v[44:47], v206 offset:6144
  s_waitcnt lgkmcnt(2)
  v_mfma_f32_32x32x16_bf16 v[240:255], a[100:103], v[36:39], v[240:255]
  ds_read_b128 v[32:35], v203 offset:7168
  s_waitcnt lgkmcnt(2)
  v_mfma_f32_32x32x16_bf16 v[240:255], a[104:107], v[40:43], v[240:255]
  ds_read_b128 v[36:39], v204 offset:7168
  s_waitcnt lgkmcnt(2)
  v_mfma_f32_32x32x16_bf16 v[240:255], a[108:111], v[44:47], v[240:255]
  ds_read_b128 v[40:43], v205 offset:7168
  s_waitcnt lgkmcnt(2)
  v_mfma_f32_32x32x16_bf16 v[240:255], a[112:115], v[32:35], v[240:255]
  ds_read_b128 v[44:47], v206 offset:7168
  s_waitcnt lgkmcnt(2)
  v_mfma_f32_32x32x16_bf16 v[240:255], a[116:119], v[36:39], v[240:255]
  ds_read_b128 v[32:35], v203 offset:8192
  s_waitcnt lgkmcnt(2)
  v_mfma_f32_32x32x16_bf16 v[240:255], a[120:123], v[40:43], v[240:255]
  ds_read_b128 v[36:39], v204 offset:8192
  s_waitcnt lgkmcnt(2)
  v_mfma_f32_32x32x16_bf16 v[240:255], a[124:127], v[44:47], v[240:255]
  ds_read_b128 v[40:43], v205 offset:8192
  s_waitcnt lgkmcnt(2)
  v_mfma_f32_32x32x16_bf16 v[240:255], a[128:131], v[32:35], v[240:255]
  ds_read_b128 v[44:47], v206 offset:8192
  s_waitcnt lgkmcnt(2)
  v_mfma_f32_32x32x16_bf16 v[240:255], a[132:135], v[36:39], v[240:255]
  s_waitcnt lgkmcnt(1)
  v_mfma_f32_32x32x16_bf16 v[240:255], a[136:139], v[40:43], v[240:255]
  s_waitcnt lgkmcnt(0)
  v_mfma_f32_32x32x16_bf16 v[240:255], a[140:143], v[44:47], v[240:255]
  s_nop 11
  v_cvt_pk_bf16_f32 v16, v240, v244
  v_cvt_pk_bf16_f32 v17, v241, v245
  v_cvt_pk_bf16_f32 v18, v242, v246
  v_cvt_pk_bf16_f32 v19, v243, v247
  ds_write_b128 v215, v[16:19] offset:0
  v_cvt_pk_bf16_f32 v20, v248, v252
  v_cvt_pk_bf16_f32 v21, v249, v253
  v_cvt_pk_bf16_f32 v22, v250, v254
  v_cvt_pk_bf16_f32 v23, v251, v255
  ds_write_b128 v215, v[20:23] offset:1024
  s_waitcnt lgkmcnt(0)
  s_barrier
  ds_read_b128 v[96:99], v208 offset:0
  ds_read_b128 v[100:103], v208 offset:1024
  ds_read_b128 v[104:107], v208 offset:2048
  ds_read_b128 v[108:111], v208 offset:3072
  ds_read_b128 v[112:115], v208 offset:4096
  ds_read_b128 v[116:119], v208 offset:5120
  ds_read_b128 v[120:123], v208 offset:6144
  ds_read_b128 v[124:127], v208 offset:7168
  s_waitcnt vmcnt(11)
  v_cmp_eq_u32 vcc, -1, v172
  s_mov_b32 s69, 0
  s_cbranch_vccnz AT_e0
  s_mov_b32 s69, 1
  buffer_load_dwordx4 v[172:175], v201, s[8:11], s76 offen sc1
AT_e0:
  s_waitcnt lgkmcnt(7)
  v_mfma_f32_32x32x16_bf16 v[64:79], v[128:131], v[96:99], v[48:63]
  s_waitcnt lgkmcnt(6)
  v_mfma_f32_32x32x16_bf16 v[64:79], v[132:135], v[100:103], v[64:79]
  s_waitcnt lgkmcnt(5)
  v_mfma_f32_32x32x16_bf16 v[64:79], v[136:139], v[104:107], v[64:79]
  s_waitcnt lgkmcnt(4)
  v_mfma_f32_32x32x16_bf16 v[64:79], v[140:143], v[108:111], v[64:79]
  s_waitcnt lgkmcnt(3)
  v_mfma_f32_32x32x16_bf16 v[64:79], v[144:147], v[112:115], v[64:79]
  s_waitcnt lgkmcnt(2)
  v_mfma_f32_32x32x16_bf16 v[64:79], v[148:151], v[116:119], v[64:79]
  s_waitcnt lgkmcnt(1)
  v_mfma_f32_32x32x16_bf16 v[64:79], v[152:155], v[120:123], v[64:79]
  s_waitcnt lgkmcnt(0)
  v_mfma_f32_32x32x16_bf16 v[64:79], v[156:159], v[124:127], v[64:79]
  s_nop 11
  v_max3_f32 v180, v64, v65, v66
  v_max3_f32 v180, v180, v67, v68
  v_max3_f32 v180, v180, v69, v70
  v_max3_f32 v180, v180, v71, v72
  v_max3_f32 v180, v180, v73, v74
  v_max3_f32 v180, v180, v75, v76
  v_max3_f32 v180, v180, v77, v78
  v_max_f32 v180, v180, v79
  v_mov_b32 v181, v180
  s_nop 1
  v_permlane32_swap_b32 v180, v181
  v_max_f32 v180, v180, v181
  v_sub_f32 v64, v64, v180
  v_sub_f32 v65, v65, v180
  v_sub_f32 v66, v66, v180
  v_sub_f32 v67, v67, v180
  v_sub_f32 v68, v68, v180
  v_sub_f32 v69, v69, v180
  v_sub_f32 v70, v70, v180
  v_sub_f32 v71, v71, v180
  v_sub_f32 v72, v72, v180
  v_sub_f32 v73, v73, v180
  v_sub_f32 v74, v74, v180
  v_sub_f32 v75, v75, v180
  v_sub_f32 v76, v76, v180
  v_sub_f32 v77, v77, v180
  v_sub_f32 v78, v78, v180
  v_sub_f32 v79, v79, v180
  v_exp_f32 v64, v64
  v_exp_f32 v65, v65
  v_exp_f32 v66, v66
  v_exp_f32 v67, v67
  v_exp_f32 v68, v68
  v_exp_f32 v69, v69
  v_exp_f32 v70, v70
  v_exp_f32 v71, v71
  v_exp_f32 v72, v72
  v_exp_f32 v73, v73
  v_exp_f32 v74, v74
  v_exp_f32 v75, v75
  v_exp_f32 v76, v76
  v_exp_f32 v77, v77
  v_exp_f32 v78, v78
  v_exp_f32 v79, v79
  v_cvt_pk_bf16_f32 v20, v64, v65
  v_cvt_pk_bf16_f32 v21, v68, v69
  v_cvt_pk_bf16_f32 v22, v72, v73
  v_cvt_pk_bf16_f32 v23, v76, v77
  v_cvt_pk_bf16_f32 v24, v66, v67
  v_cvt_pk_bf16_f32 v25, v70, v71
  v_cvt_pk_bf16_f32 v26, v74, v75
  v_cvt_pk_bf16_f32 v27, v78, v79
  v_mfma_f32_32x32x16_bf16 v[0:15], v[160:163], v[20:23], 0
  v_add_f32 v182, v64, v65
  v_add_f32 v182, v182, v66
  v_add_f32 v182, v182, v67
  v_add_f32 v182, v182, v68
  v_add_f32 v182, v182, v69
  v_add_f32 v182, v182, v70
  v_add_f32 v182, v182, v71
  v_mfma_f32_32x32x16_bf16 v[0:15], v[164:167], v[24:27], v[0:15]
  v_add_f32 v182, v182, v72
  v_add_f32 v182, v182, v73
  v_add_f32 v182, v182, v74
  v_add_f32 v182, v182, v75
  v_add_f32 v182, v182, v76
  v_add_f32 v182, v182, v77
  v_add_f32 v182, v182, v78
  v_add_f32 v182, v182, v79
AT_l1:
  s_cmp_eq_u32 s69, 1
  s_cbranch_scc1 AT_v1
  s_or_b32 s70, s76, 0xc00
  s_cmp_eq_u32 s77, 63
  s_cselect_b32 s54, 655360, 0
  s_sub_u32 s70, s70, s54
  s_branch AT_c1
AT_h1:
  s_sleep 1
AT_c1:
  buffer_load_dword v172, off, s[8:11], s70 sc1
  s_add_u32 s65, s65, 1
  s_cmp_lt_u32 s65, 131072
  s_cselect_b32 s54, -2, -1
  s_waitcnt vmcnt(0)
  v_cmp_lt_u32 vcc, s54, v172
  s_cbranch_vccnz AT_h1
AT_k1:
  buffer_load_dwordx4 v[172:175], v201, s[8:11], s76 offen sc1
AT_v1:
  s_mov_b32 s69, 0
  s_add_u32 s65, s65, 1
  s_cmp_lt_u32 s65, 131072
  s_cselect_b32 s54, -2, -1
  s_waitcnt vmcnt(0)
  ds_write_b64 v220, v[172:173] offset:4096
  ds_write_b64 v221, v[174:175] offset:4096
  v_max3_u32 v213, v172, v173, v174
  v_max_u32 v213, v213, v175
  v_cmp_lt_u32 vcc, s54, v213
  s_cbranch_vccnz AT_k1
  s_waitcnt lgkmcnt(0)
  s_barrier
  ds_read_b128 v[128:131], v218 offset:4096
  ds_read_b128 v[132:135], v218 offset:4352
  ds_read_b128 v[136:139], v218 offset:4608
  ds_read_b128 v[140:143], v218 offset:4864
  ds_read_b128 v[144:147], v218 offset:5120
  ds_read_b128 v[148:151], v218 offset:5376
  ds_read_b128 v[152:155], v218 offset:5632
  ds_read_b128 v[156:159], v218 offset:5888
  ds_read_b32 v168, v219 offset:4096
  ds_read_b32 v169, v219 offset:4224
  s_add_u32 s77, s77, 2
  v_mov_b32 v212, s77
  s_waitcnt lgkmcnt(9)
  v_mfma_f32_32x32x16_bf16 v[80:95], v[128:131], a[144:147], 0
  s_waitcnt lgkmcnt(8)
  v_mfma_f32_32x32x16_bf16 v[80:95], v[132:135], a[148:151], v[80:95]
  s_waitcnt lgkmcnt(7)
  v_mfma_f32_32x32x16_bf16 v[80:95], v[136:139], a[152:155], v[80:95]
  s_waitcnt lgkmcnt(6)
  v_mfma_f32_32x32x16_bf16 v[80:95], v[140:143], a[156:159], v[80:95]
  s_mov_b64 exec, 1
  buffer_store_dword v212, v201, s[8:11], s71 offen sc1
  s_mov_b64 exec, -1
  s_waitcnt lgkmcnt(5)
  v_mfma_f32_32x32x16_bf16 v[80:95], v[144:147], a[160:163], v[80:95]
  s_waitcnt lgkmcnt(4)
  v_mfma_f32_32x32x16_bf16 v[80:95], v[148:151], a[164:167], v[80:95]
  s_waitcnt lgkmcnt(3)
  v_mfma_f32_32x32x16_bf16 v[80:95], v[152:155], a[168:171], v[80:95]
  s_waitcnt lgkmcnt(2)
  v_mfma_f32_32x32x16_bf16 v[80:95], v[156:159], a[172:175], v[80:95]
  s_nop 11
  v_mul_f32 v80, s68, v80
  v_mul_f32 v81, s68, v81
  v_mul_f32 v82, s68, v82
  v_mul_f32 v83, s68, v83
  v_max3_f32 v84, v184, v80, v81
  v_max3_f32 v84, v84, v82, v83
  v_mov_b32 v85, v84
  s_nop 1
  v_permlane32_swap_b32 v84, v85
  v_max_f32 v84, v84, v85
  v_sub_f32 v86, v184, v84
  v_sub_f32 v80, v80, v84
  v_sub_f32 v81, v81, v84
  v_sub_f32 v82, v82, v84
  v_sub_f32 v83, v83, v84
  v_exp_f32 v86, v86
  v_exp_f32 v80, v80
  v_exp_f32 v81, v81
  v_exp_f32 v82, v82
  v_exp_f32 v83, v83
  v_fma_f32 v186, v186, v86, v80
  v_add_f32 v84, v81, v82
  v_add_f32 v186, v186, v83
  v_add_f32 v186, v186, v84
  v_mov_b32 v187, v186
  s_nop 1
  v_permlane32_swap_b32 v186, v187
  v_add_f32 v186, v186, v187
  v_rcp_f32 v186, v186
  s_nop 0
  v_mul_f32 v86, v86, v186
  v_mul_f32 v80, v186, v80
  v_mul_f32 v81, v186, v81
  v_mul_f32 v82, v186, v82
  v_mul_f32 v83, v186, v83
  v_cvt_pk_bf16_f32 v28, v80, v81
  v_cvt_pk_bf16_f32 v29, v82, v83
  v_mul_f32 v224, v86, v224
  v_mul_f32 v225, v86, v225
  v_mul_f32 v226, v86, v226
  v_mul_f32 v227, v86, v227
  v_mul_f32 v228, v86, v228
  v_mul_f32 v229, v86, v229
  v_mul_f32 v230, v86, v230
  v_mul_f32 v231, v86, v231
  v_mul_f32 v232, v86, v232
  v_mul_f32 v233, v86, v233
  v_mul_f32 v234, v86, v234
  v_mul_f32 v235, v86, v235
  v_mul_f32 v236, v86, v236
  v_mul_f32 v237, v86, v237
  v_mul_f32 v238, v86, v238
  v_mul_f32 v239, v86, v239
  s_waitcnt lgkmcnt(0)
  s_nop 0
  v_mfma_f32_32x32x8_bf16 v[224:239], v[168:169], v[28:29], v[224:239]
  s_nop 11
  v_cvt_pk_bf16_f32 v20, v224, v225
  v_cvt_pk_bf16_f32 v21, v226, v227
  v_cvt_pk_bf16_f32 v22, v228, v229
  v_cvt_pk_bf16_f32 v23, v230, v231
  buffer_store_dwordx4 v[20:23], v201, s[8:11], s75 offen offset:0 sc1
  v_cvt_pk_bf16_f32 v24, v232, v233
  v_cvt_pk_bf16_f32 v25, v234, v235
  v_cvt_pk_bf16_f32 v26, v236, v237
  v_cvt_pk_bf16_f32 v27, v238, v239
  buffer_store_dwordx4 v[24:27], v201, s[8:11], s75 offen offset:1024 sc1
  s_cmp_ge_u32 s77, 64
  s_cbranch_scc1 L_exit
  s_branch AT_loop
L_cexit:
L_exit:
L_end:
s_endpgm
.section .rodata,"a"
.p2align 6
.amdhsa_kernel gated_mix__sliding_local_dilated__memory_aug_recurrent_mem_tr__prompt_kernel
  .amdhsa_next_free_vgpr 512
  .amdhsa_next_free_sgpr 102
  .amdhsa_accum_offset 256
  .amdhsa_group_segment_fixed_size 0
  .amdhsa_kernarg_size 112
  .amdhsa_user_sgpr_count 2
  .amdhsa_user_sgpr_kernarg_segment_ptr 1
  .amdhsa_system_sgpr_workgroup_id_x 1
.end_amdhsa_kernel
```

```asm
; @launch grid=(256,1,1) block=(256,1,1) lds=163840
.amdgcn_target "amdgcn-amd-amdhsa--gfx950"
.text
.globl gated_mix__sliding_local_dilated__memory_aug_recurrent_mem_tr__prompt_kernel
.p2align 8
.type gated_mix__sliding_local_dilated__memory_aug_recurrent_mem_tr__prompt_kernel,@function
gated_mix__sliding_local_dilated__memory_aug_recurrent_mem_tr__prompt_kernel:
  s_cmp_ge_u32 s2, 256
  s_cbranch_scc1 L_end
  s_load_dwordx2 s[4:5], s[0:1], 0
  s_load_dwordx2 s[8:9], s[0:1], 104
  s_load_dwordx2 s[12:13], s[0:1], 96
  s_load_dwordx2 s[16:17], s[0:1], 40
  s_load_dwordx2 s[20:21], s[0:1], 48
  s_load_dwordx2 s[24:25], s[0:1], 56
  s_load_dwordx2 s[28:29], s[0:1], 64
  s_load_dwordx2 s[32:33], s[0:1], 32
  s_load_dwordx2 s[36:37], s[0:1], 8
  s_load_dwordx2 s[40:41], s[0:1], 16
  s_load_dwordx2 s[44:45], s[0:1], 80
  s_load_dwordx2 s[48:49], s[0:1], 88
  s_getreg_b32 s54, hwreg(HW_REG_XCC_ID, 0, 3)
  v_lshrrev_b32 v1, 6, v0
  s_nop 0
  v_readfirstlane_b32 s52, v1
  s_mov_b32 s6, 2359296
  s_mov_b32 s7, 0x20000
  s_mov_b32 s10, 268435456
  s_mov_b32 s11, 0x20000
  s_mov_b32 s14, 256
  s_mov_b32 s15, 0x20000
  s_mov_b32 s18, 4718592
  s_mov_b32 s19, 0x20000
  s_mov_b32 s22, 4718592
  s_mov_b32 s23, 0x20000
  s_mov_b32 s26, 4718592
  s_mov_b32 s27, 0x20000
  s_mov_b32 s30, 4718592
  s_mov_b32 s31, 0x20000
  s_mov_b32 s34, 9216
  s_mov_b32 s35, 0x20000
  s_mov_b32 s38, 1990656
  s_mov_b32 s39, 0x20000
  s_mov_b32 s42, 663552
  s_mov_b32 s43, 0x20000
  s_mov_b32 s46, 1152
  s_mov_b32 s47, 0x20000
  s_mov_b32 s50, 2359296
  s_mov_b32 s51, 0x20000
  s_waitcnt lgkmcnt(0)
  s_lshr_b32 s0, s2, 3
  s_mov_b32 s2, s54
  s_mov_b32 s1, 0
L_role:
  s_mov_b32 s53, s0
  s_cmp_eq_u32 s2, 0
  s_cbranch_scc0 L_worker
  v_and_b32 v0, 63, v0
  v_and_b32 v1, 15, v0
  v_lshrrev_b32 v2, 4, v0
  v_and_b32 v3, 1, v2
  s_lshl_b32 s54, s52, 1
  v_add_u32 v3, s54, v3
  v_lshlrev_b32 v3, 1, v3
  v_xor_b32 v3, v3, v1
  v_lshlrev_b32 v3, 4, v3
  v_lshl_add_u32 v8, v2, 13, v3
  s_lshl_b32 s78, s53, 8
  s_lshl_b32 s54, s52, 15
  s_add_u32 s78, s78, s54
  s_mul_i32 s79, s53, 147456
  s_lshl_b32 s57, s52, 10
  s_add_u32 s57, s57, 16384
  s_getpc_b64 s[80:81]
L_pc_1:
  s_and_b32 s55, s0, 1
  s_lshl_b32 s55, s55, 2
  s_add_u32 s55, s55, s52
  s_lshl_b32 s55, s55, 10
  v_and_b32 v199, 63, v0
  v_lshl_add_u32 v199, v199, 4, s55
  v_min_u32 v199, (L_w0 - L_pc_1), v199
  global_load_dword v196, v199, s[80:81]
  s_add_u32 m0, s57, 0
  s_add_u32 s54, s78, 0
  buffer_load_dwordx4 v8, s[16:19], s54 offen  lds
  s_add_u32 m0, s57, 4096
  s_add_u32 s54, s78, 131072
  buffer_load_dwordx4 v8, s[16:19], s54 offen  lds
  s_add_u32 m0, s57, 8192
  s_add_u32 s54, s78, 262144
  buffer_load_dwordx4 v8, s[16:19], s54 offen  lds
  s_add_u32 m0, s57, 12288
  s_add_u32 s54, s78, 393216
  buffer_load_dwordx4 v8, s[16:19], s54 offen  lds
  s_add_u32 m0, s57, 16384
  s_add_u32 s54, s78, 524288
  buffer_load_dwordx4 v8, s[16:19], s54 offen  lds
  s_add_u32 m0, s57, 20480
  s_add_u32 s54, s78, 655360
  buffer_load_dwordx4 v8, s[16:19], s54 offen  lds
  s_add_u32 m0, s57, 24576
  s_add_u32 s54, s78, 786432
  buffer_load_dwordx4 v8, s[16:19], s54 offen  lds
  s_add_u32 m0, s57, 28672
  s_add_u32 s54, s78, 917504
  buffer_load_dwordx4 v8, s[16:19], s54 offen  lds
  s_add_u32 m0, s57, 32768
  s_add_u32 s54, s78, 1048576
  buffer_load_dwordx4 v8, s[16:19], s54 offen  lds
  s_add_u32 m0, s57, 36864
  s_add_u32 s54, s78, 1179648
  buffer_load_dwordx4 v8, s[16:19], s54 offen  lds
  s_add_u32 m0, s57, 40960
  s_add_u32 s54, s78, 1310720
  buffer_load_dwordx4 v8, s[16:19], s54 offen  lds
  s_add_u32 m0, s57, 45056
  s_add_u32 s54, s78, 1441792
  buffer_load_dwordx4 v8, s[16:19], s54 offen  lds
  s_add_u32 m0, s57, 49152
  s_add_u32 s54, s78, 1572864
  buffer_load_dwordx4 v8, s[16:19], s54 offen  lds
  s_add_u32 m0, s57, 53248
  s_add_u32 s54, s78, 1703936
  buffer_load_dwordx4 v8, s[16:19], s54 offen  lds
  s_add_u32 m0, s57, 57344
  s_add_u32 s54, s78, 1835008
  buffer_load_dwordx4 v8, s[16:19], s54 offen  lds
  s_add_u32 m0, s57, 61440
  s_add_u32 s54, s78, 1966080
  buffer_load_dwordx4 v8, s[16:19], s54 offen  lds
  v_lshlrev_b32 v76, 4, v0
  v_add_u32 v75, 0x10000, v76
  v_lshrrev_b32 v3, 2, v1
  v_and_b32 v4, 1, v1
  v_lshl_add_u32 v3, v3, 1, v4
  v_bfe_u32 v4, v1, 1, 1
  v_mul_u32_u24 v74, 0xaaaa, v4
  v_add_u32 v74, 0x4444, v74
  v_mul_u32_u24 v5, 576, v3
  v_add_u32 v5, 0, v5
  v_lshl_add_u32 v78, v2, 4, v5
  v_lshl_add_u32 v77, v2, 5, v5
  v_lshl_add_u32 v77, v4, 4, v77
  v_mul_u32_u24 v15, 1152, v3
  v_lshl_add_u32 v15, v2, 5, v15
  v_lshl_add_u32 v15, v4, 4, v15
  s_lshl_b32 s54, s52, 8
  buffer_load_dwordx4 v[20:23], v15, s[32:35], s54 offen
  buffer_load_dwordx4 v[24:27], v15, s[32:35], s54 offen offset:128
  buffer_load_dwordx4 v[28:31], v15, s[32:35], 0 offen offset:1024
  v_mul_u32_u24 v79, 1152, v2
  v_lshl_add_u32 v79, v1, 2, v79
  s_lshl_b32 s54, s52, 6
  s_add_u32 s54, s54, 0
  v_add_u32 v79, s54, v79
  v_lshrrev_b32 v5, 3, v0
  v_mul_u32_u24 v68, 2176, v5
  v_and_b32 v5, 7, v0
  v_lshl_add_u32 v68, v5, 3, v68
  v_lshrrev_b32 v6, 3, v0
  s_lshr_b32 s54, s53, 2
  v_add_u32 v68, s54, v6
  v_and_b32 v68, 7, v68
  v_xor_b32 v68, v68, v6
  v_lshlrev_b32 v68, 8, v68
  v_lshl_add_u32 v68, v6, 12, v68
  v_lshl_add_u32 v68, v5, 3, v68
  s_and_b32 s54, s53, 3
  s_lshl_b32 s54, s54, 6
  v_add_u32 v68, s54, v68
  v_and_b32 v5, 1, v2
  v_lshlrev_b32 v5, 4, v5
  v_lshl_add_u32 v5, v1, 2, v5
  v_mov_b32 v6, 0x40000000
  v_cmp_lt_u32 vcc, 3, v1
  s_nop 1
  v_cndmask_b32 v5, v5, v6, vcc
  v_lshrrev_b32 v6, 1, v2
  v_lshl_add_u32 v69, v6, 10, v5
  v_lshl_add_u32 v70, v6, 8, v5
  v_mov_b32 v71, -1
  ds_write_b128 v76, v[68:71] offset:13824
  v_and_b32 v5, 3, v1
  v_lshrrev_b32 v6, 2, v1
  v_lshl_add_u32 v5, v5, 2, v6
  v_and_b32 v6, 1, v5
  v_lshlrev_b32 v6, 4, v6
  v_mov_b32 v7, 0x3f80
  v_lshlrev_b32 v6, v6, v7
  v_lshrrev_b32 v5, 1, v5
  v_cmp_eq_u32 vcc, 0, v5
  s_nop 1
  v_cndmask_b32 v40, 0, v6, vcc
  v_cmp_eq_u32 vcc, 1, v5
  s_nop 1
  v_cndmask_b32 v41, 0, v6, vcc
  v_cmp_eq_u32 vcc, 2, v5
  s_nop 1
  v_cndmask_b32 v42, 0, v6, vcc
  v_cmp_eq_u32 vcc, 3, v5
  s_nop 1
  v_cndmask_b32 v43, 0, v6, vcc
  ds_write_b128 v76, v[40:43] offset:14848
  s_and_b32 s54, s52, 1
  s_lshr_b32 s55, s52, 1
  v_lshrrev_b32 v3, 3, v0
  v_and_b32 v4, 1, v3
  v_lshlrev_b32 v4, 4, v4
  v_and_b32 v5, 6, v3
  v_add_u32 v4, v4, v5
  s_lshl_b32 s56, s55, 3
  s_add_u32 s56, s56, s54
  v_add_u32 v4, s56, v4
  v_mul_u32_u24 v4, 1152, v4
  v_and_b32 v5, 2, v3
  v_lshlrev_b32 v5, 1, v5
  v_and_b32 v6, 7, v0
  v_xor_b32 v6, v6, v5
  v_lshl_add_u32 v9, v6, 4, v4
  v_and_b32 v4, 1, v2
  v_lshlrev_b32 v4, 4, v4
  v_and_b32 v5, 2, v2
  v_add_u32 v4, v4, v5
  s_lshl_b32 s56, s55, 2
  s_add_u32 s56, s56, s54
  v_add_u32 v4, s56, v4
  v_mul_u32_u24 v4, 1152, v4
  v_lshlrev_b32 v6, 1, v2
  v_xor_b32 v6, v6, v1
  v_lshl_add_u32 v10, v6, 4, v4
  v_bfe_u32 v17, v1, 2, 1
  v_bfe_u32 v18, v1, 3, 1
  v_and_b32 v19, 1, v2
  v_lshrrev_b32 v72, 1, v2
  v_and_b32 v73, 3, v1
  v_lshl_add_u32 v3, v19, 1, v17
  v_lshl_add_u32 v6, v18, 2, v3
  v_lshl_add_u32 v4, v72, 4, v17
  v_lshl_add_u32 v4, v19, 2, v4
  v_lshl_add_u32 v4, v18, 3, v4
  v_lshlrev_b32 v4, 8, v4
  s_lshl_b32 s54, s52, 6
  v_lshl_add_u32 v5, v73, 3, s54
  v_lshlrev_b32 v7, 5, v6
  v_xor_b32 v5, v5, v7
  v_add_u32 v11, v4, v5
  v_xor_b32 v12, 32, v11
  v_lshl_add_u32 v4, v72, 2, v3
  v_lshlrev_b32 v4, 7, v4
  v_lshl_add_u32 v4, v73, 3, v4
  s_and_b32 s54, s52, 1
  v_xor_b32 v7, s54, v19
  v_lshl_add_u32 v7, v7, 1, v18
  v_lshl_add_u32 v13, v7, 5, v4
  v_lshlrev_b32 v4, 11, v72
  v_lshl_add_u32 v4, v73, 3, v4
  v_lshl_add_u32 v5, v3, 8, v4
  v_lshl_add_u32 v7, v18, 2, s52
  v_xor_b32 v7, v7, v3
  v_lshl_add_u32 v14, v7, 5, v5
  s_lshl_b32 s54, s53, 14
  s_lshl_b32 s55, s52, 11
  s_add_u32 s54, s54, 1048576
  s_add_u32 s58, s54, s55
  s_add_u32 s59, s58, 8192
  s_lshl_b32 s55, s52, 12
  s_add_u32 s70, s54, s55
  s_add_u32 s70, s70, 655360
  s_lshl_b32 s54, s53, 12
  s_lshl_b32 s55, s52, 10
  s_add_u32 s54, s54, s55
  s_add_u32 s68, s54, 917504
  s_lshl_b32 s54, s53, 6
  s_mul_i32 s55, s52, 17408
  s_add_u32 s55, s54, s55
  s_add_u32 s73, s55, 0
  s_add_u32 s74, s55, 69632
  s_add_u32 s75, s55, 139264
  s_add_u32 s76, s55, 208896
  s_and_b32 s56, s52, 1
  s_mul_i32 s55, s56, 17408
  s_add_u32 s55, s54, s55
  s_add_u32 s77, s55, 278528
  s_mul_i32 s54, s52, 69632
  s_mul_i32 s55, s53, 2176
  s_add_u32 s54, s54, s55
  s_add_u32 s60, s54, 0
  s_and_b32 s56, s53, 15
  s_mul_i32 s55, s56, 2176
  s_add_u32 s61, s55, 278528
  s_lshr_b32 s54, s52, 1
  s_lshl_b32 s54, s54, 15
  s_and_b32 s55, s52, 1
  s_lshl_b32 s55, s55, 11
  s_add_u32 s54, s54, s55
  s_add_u32 s73, s54, 0
  s_add_u32 s74, s54, 65536
  s_add_u32 s75, s54, 131072
  s_add_u32 s76, s54, 196608
  s_add_u32 s77, s55, 262144
  s_and_b32 s54, s53, 7
  s_lshl_b32 s54, s54, 12
  s_bfe_u32 s55, s53, 0x10003
  s_lshl_b32 s55, s55, 11
  s_add_u32 s54, s54, s55
  s_add_u32 s61, s54, 262144
  s_lshr_b32 s55, s53, 4
  s_lshl_b32 s55, s55, 15
  s_add_u32 s54, s54, s55
  s_lshl_b32 s55, s52, 16
  s_add_u32 s54, s54, s55
  s_add_u32 s60, s54, 0
  s_lshl_b32 s54, s52, 11
  s_add_u32 s64, s54, 360448
  s_mov_b32 s65, 368640
  s_lshl_b32 s55, s53, 5
  s_add_u32 s54, s54, s55
  s_add_u32 s62, s54, 376832
  s_lshr_b32 s54, s56, 3
  s_lshl_b32 s54, s54, 9
  s_and_b32 s55, s56, 7
  s_lshl_b32 s55, s55, 5
  s_add_u32 s54, s54, s55
  s_add_u32 s63, s54, 385024
  s_mov_b32 s66, 0
  s_mov_b32 s67, 0
  s_mov_b32 s72, 0
  s_mov_b32 s69, 1040356334
  s_waitcnt vmcnt(15) lgkmcnt(0)
  s_barrier
  s_add_u32 m0, s57, 65536
  s_add_u32 s54, s78, 2097152
  buffer_load_dwordx4 v8, s[16:19], s54 offen  lds
  s_add_u32 m0, s57, 69632
  s_add_u32 s54, s78, 2228224
  buffer_load_dwordx4 v8, s[16:19], s54 offen  lds
  s_add_u32 m0, s57, 73728
  s_add_u32 s54, s78, 2359296
  buffer_load_dwordx4 v8, s[16:19], s54 offen  lds
  s_add_u32 m0, s57, 77824
  s_add_u32 s54, s78, 2490368
  buffer_load_dwordx4 v8, s[16:19], s54 offen  lds
  s_lshl_b32 s55, s2, 2
  s_or_b32 s56, s52, s1
  s_cmp_eq_u32 s56, 0
  s_cselect_b32 s55, s55, 0x1000
  s_lshl_b32 s56, 1, s0
  v_mov_b32 v35, s56
  s_mov_b64 exec, 1
  buffer_atomic_or v35, off, s[12:15], s55 sc0
  s_mov_b64 exec, -1
  v_add_u32 v15, 16384, v11
  v_add_u32 v16, 16384, v12
  ds_read_b64_tr_b16 v[80:81], v15 offset:0
  ds_read_b64_tr_b16 v[82:83], v15 offset:512
  ds_read_b64_tr_b16 v[84:85], v15 offset:8192
  ds_read_b64_tr_b16 v[86:87], v15 offset:8704
  ds_read_b64_tr_b16 v[88:89], v16 offset:0
  ds_read_b64_tr_b16 v[90:91], v16 offset:512
  ds_read_b64_tr_b16 v[92:93], v16 offset:8192
  ds_read_b64_tr_b16 v[94:95], v16 offset:8704
  s_waitcnt vmcnt(16) lgkmcnt(0)
  s_barrier
  s_add_u32 m0, s57, 81920
  s_add_u32 s54, s78, 2621440
  buffer_load_dwordx4 v8, s[16:19], s54 offen  lds
  s_add_u32 m0, s57, 86016
  s_add_u32 s54, s78, 2752512
  buffer_load_dwordx4 v8, s[16:19], s54 offen  lds
  s_add_u32 m0, s57, 90112
  s_add_u32 s54, s78, 2883584
  buffer_load_dwordx4 v8, s[16:19], s54 offen  lds
  s_add_u32 m0, s57, 94208
  s_add_u32 s54, s78, 3014656
  buffer_load_dwordx4 v8, s[16:19], s54 offen  lds
  v_add_u32 v15, 32768, v11
  v_add_u32 v16, 32768, v12
  ds_read_b64_tr_b16 v[96:97], v15 offset:0
  ds_read_b64_tr_b16 v[98:99], v15 offset:512
  ds_read_b64_tr_b16 v[100:101], v15 offset:8192
  ds_read_b64_tr_b16 v[102:103], v15 offset:8704
  ds_read_b64_tr_b16 v[104:105], v16 offset:0
  ds_read_b64_tr_b16 v[106:107], v16 offset:512
  ds_read_b64_tr_b16 v[108:109], v16 offset:8192
  ds_read_b64_tr_b16 v[110:111], v16 offset:8704
  s_waitcnt vmcnt(16) lgkmcnt(0)
  s_barrier
  s_add_u32 m0, s57, 98304
  s_add_u32 s54, s78, 3670016
  buffer_load_dwordx4 v8, s[16:19], s54 offen  lds
  s_add_u32 m0, s57, 102400
  s_add_u32 s54, s78, 3801088
  buffer_load_dwordx4 v8, s[16:19], s54 offen  lds
  s_add_u32 m0, s57, 106496
  s_add_u32 s54, s78, 3932160
  buffer_load_dwordx4 v8, s[16:19], s54 offen  lds
  s_add_u32 m0, s57, 110592
  s_add_u32 s54, s78, 4063232
  buffer_load_dwordx4 v8, s[16:19], s54 offen  lds
  v_add_u32 v15, 49152, v11
  v_add_u32 v16, 49152, v12
  ds_read_b64_tr_b16 v[112:113], v15 offset:0
  ds_read_b64_tr_b16 v[114:115], v15 offset:512
  ds_read_b64_tr_b16 v[116:117], v15 offset:8192
  ds_read_b64_tr_b16 v[118:119], v15 offset:8704
  ds_read_b64_tr_b16 v[120:121], v16 offset:0
  ds_read_b64_tr_b16 v[122:123], v16 offset:512
  ds_read_b64_tr_b16 v[124:125], v16 offset:8192
  ds_read_b64_tr_b16 v[126:127], v16 offset:8704
  s_waitcnt vmcnt(16) lgkmcnt(0)
  s_barrier
  s_add_u32 m0, s57, 114688
  s_add_u32 s54, s78, 4194304
  buffer_load_dwordx4 v8, s[16:19], s54 offen  lds
  s_add_u32 m0, s57, 118784
  s_add_u32 s54, s78, 4325376
  buffer_load_dwordx4 v8, s[16:19], s54 offen  lds
  s_add_u32 m0, s57, 122880
  s_add_u32 s54, s78, 4456448
  buffer_load_dwordx4 v8, s[16:19], s54 offen  lds
  s_add_u32 m0, s57, 126976
  s_add_u32 s54, s78, 4587520
  buffer_load_dwordx4 v8, s[16:19], s54 offen  lds
  v_add_u32 v15, 65536, v11
  v_add_u32 v16, 65536, v12
  ds_read_b64_tr_b16 v[128:129], v15 offset:0
  ds_read_b64_tr_b16 v[130:131], v15 offset:512
  ds_read_b64_tr_b16 v[132:133], v15 offset:8192
  ds_read_b64_tr_b16 v[134:135], v15 offset:8704
  ds_read_b64_tr_b16 v[136:137], v16 offset:0
  ds_read_b64_tr_b16 v[138:139], v16 offset:512
  ds_read_b64_tr_b16 v[140:141], v16 offset:8192
  ds_read_b64_tr_b16 v[142:143], v16 offset:8704
  s_waitcnt vmcnt(13) lgkmcnt(0)
  s_barrier
  s_add_u32 m0, s57, 131072
  s_add_u32 s54, s78, 1048576
  buffer_load_dwordx4 v8, s[20:23], s54 offen  lds
  s_add_u32 m0, s57, 135168
  s_add_u32 s54, s78, 1179648
  buffer_load_dwordx4 v8, s[20:23], s54 offen  lds
  s_add_u32 m0, s57, 139264
  s_add_u32 s54, s78, 1310720
  buffer_load_dwordx4 v8, s[20:23], s54 offen  lds
  s_add_u32 m0, s57, 143360
  s_add_u32 s54, s78, 1441792
  buffer_load_dwordx4 v8, s[20:23], s54 offen  lds
  v_add_u32 v15, 81920, v11
  v_add_u32 v16, 81920, v12
  ds_read_b64_tr_b16 v[144:145], v15 offset:0
  ds_read_b64_tr_b16 v[146:147], v15 offset:512
  ds_read_b64_tr_b16 v[148:149], v15 offset:8192
  ds_read_b64_tr_b16 v[150:151], v15 offset:8704
  ds_read_b64_tr_b16 v[152:153], v16 offset:0
  ds_read_b64_tr_b16 v[154:155], v16 offset:512
  ds_read_b64_tr_b16 v[156:157], v16 offset:8192
  ds_read_b64_tr_b16 v[158:159], v16 offset:8704
  s_waitcnt vmcnt(12) lgkmcnt(0)
  s_barrier
  s_add_u32 m0, s57, 0
  s_add_u32 s54, s78, 1572864
  buffer_load_dwordx4 v8, s[20:23], s54 offen  lds
  s_add_u32 m0, s57, 4096
  s_add_u32 s54, s78, 1703936
  buffer_load_dwordx4 v8, s[20:23], s54 offen  lds
  s_add_u32 m0, s57, 8192
  s_add_u32 s54, s78, 1835008
  buffer_load_dwordx4 v8, s[20:23], s54 offen  lds
  s_add_u32 m0, s57, 12288
  s_add_u32 s54, s78, 1966080
  buffer_load_dwordx4 v8, s[20:23], s54 offen  lds
  v_add_u32 v15, 98304, v11
  v_add_u32 v16, 98304, v12
  ds_read_b64_tr_b16 v[160:161], v15 offset:0
  ds_read_b64_tr_b16 v[162:163], v15 offset:512
  ds_read_b64_tr_b16 v[164:165], v15 offset:8192
  ds_read_b64_tr_b16 v[166:167], v15 offset:8704
  ds_read_b64_tr_b16 v[168:169], v16 offset:0
  ds_read_b64_tr_b16 v[170:171], v16 offset:512
  ds_read_b64_tr_b16 v[172:173], v16 offset:8192
  ds_read_b64_tr_b16 v[174:175], v16 offset:8704
  s_waitcnt vmcnt(12) lgkmcnt(0)
  s_barrier
  s_add_u32 m0, s57, 16384
  s_add_u32 s54, s78, 3145728
  buffer_load_dwordx4 v8, s[20:23], s54 offen  lds
  s_add_u32 m0, s57, 20480
  s_add_u32 s54, s78, 3276800
  buffer_load_dwordx4 v8, s[20:23], s54 offen  lds
  s_add_u32 m0, s57, 24576
  s_add_u32 s54, s78, 3407872
  buffer_load_dwordx4 v8, s[20:23], s54 offen  lds
  s_add_u32 m0, s57, 28672
  s_add_u32 s54, s78, 3538944
  buffer_load_dwordx4 v8, s[20:23], s54 offen  lds
  v_add_u32 v15, 114688, v11
  v_add_u32 v16, 114688, v12
  ds_read_b64_tr_b16 v[176:177], v15 offset:0
  ds_read_b64_tr_b16 v[178:179], v15 offset:512
  ds_read_b64_tr_b16 v[180:181], v15 offset:8192
  ds_read_b64_tr_b16 v[182:183], v15 offset:8704
  ds_read_b64_tr_b16 v[184:185], v16 offset:0
  ds_read_b64_tr_b16 v[186:187], v16 offset:512
  ds_read_b64_tr_b16 v[188:189], v16 offset:8192
  ds_read_b64_tr_b16 v[190:191], v16 offset:8704
  s_waitcnt vmcnt(12) lgkmcnt(0)
  s_barrier
  s_add_u32 m0, s57, 32768
  s_add_u32 s54, s78, 3670016
  buffer_load_dwordx4 v8, s[20:23], s54 offen  lds
  s_add_u32 m0, s57, 36864
  s_add_u32 s54, s78, 3801088
  buffer_load_dwordx4 v8, s[20:23], s54 offen  lds
  s_add_u32 m0, s57, 40960
  s_add_u32 s54, s78, 3932160
  buffer_load_dwordx4 v8, s[20:23], s54 offen  lds
  s_add_u32 m0, s57, 45056
  s_add_u32 s54, s78, 4063232
  buffer_load_dwordx4 v8, s[20:23], s54 offen  lds
  v_add_u32 v15, 131072, v11
  v_add_u32 v16, 131072, v12
  ds_read_b64_tr_b16 v[192:193], v15 offset:0
  ds_read_b64_tr_b16 v[194:195], v15 offset:512
  ds_read_b64_tr_b16 v[196:197], v15 offset:8192
  ds_read_b64_tr_b16 v[198:199], v15 offset:8704
  ds_read_b64_tr_b16 v[200:201], v16 offset:0
  ds_read_b64_tr_b16 v[202:203], v16 offset:512
  ds_read_b64_tr_b16 v[204:205], v16 offset:8192
  ds_read_b64_tr_b16 v[206:207], v16 offset:8704
  s_waitcnt vmcnt(12) lgkmcnt(0)
  s_barrier
  s_add_u32 m0, s57, 49152
  s_add_u32 s54, s78, 4194304
  buffer_load_dwordx4 v8, s[20:23], s54 offen  lds
  s_add_u32 m0, s57, 53248
  s_add_u32 s54, s78, 4325376
  buffer_load_dwordx4 v8, s[20:23], s54 offen  lds
  s_add_u32 m0, s57, 57344
  s_add_u32 s54, s78, 4456448
  buffer_load_dwordx4 v8, s[20:23], s54 offen  lds
  s_add_u32 m0, s57, 61440
  s_add_u32 s54, s78, 4587520
  buffer_load_dwordx4 v8, s[20:23], s54 offen  lds
  s_getpc_b64 s[80:81]
  v_lshlrev_b32 v7, 2, v76
  global_load_dword v19, v7, s[80:81] offset:1024
  s_cmp_eq_u32 s1, 1
  s_cbranch_scc1 C_ver_ok
  v_mov_b32 v33, 16320
  s_cmp_eq_u32 s52, 0
  s_cbranch_scc0 C_ver_b
  s_waitcnt vmcnt(33)
  s_mov_b64 exec, 1
  ds_write_b32 v33, v35
  s_mov_b64 exec, -1
  s_waitcnt lgkmcnt(0)
C_ver_b:
  s_barrier
  ds_read_b32 v32, v33
  s_waitcnt lgkmcnt(0)
  v_readfirstlane_b32 s54, v32
  s_nop 0
  s_bitcmp1_b32 s54, s0
  s_cbranch_scc1 L_conf
C_ver_ok:
  v_min_u32 v20, -2, v20
  v_min_u32 v21, -2, v21
  v_min_u32 v22, -2, v22
  v_min_u32 v23, -2, v23
  v_min_u32 v24, -2, v24
  v_min_u32 v25, -2, v25
  v_min_u32 v26, -2, v26
  v_min_u32 v27, -2, v27
  v_min_u32 v28, -2, v28
  v_min_u32 v29, -2, v29
  v_min_u32 v30, -2, v30
  v_min_u32 v31, -2, v31
  s_lshl_b32 s54, s52, 11
  v_add_u32 v3, s54, v76
  ds_write_b128 v3, v[20:23] offset:4608
  ds_write_b128 v3, v[24:27] offset:5632
  ds_write_b128 v76, v[28:31] offset:12800
  v_add_u32 v15, 147456, v11
  v_add_u32 v16, 147456, v12
  ds_read_b64_tr_b16 v[208:209], v15 offset:0
  ds_read_b64_tr_b16 v[210:211], v15 offset:512
  ds_read_b64_tr_b16 v[212:213], v15 offset:8192
  ds_read_b64_tr_b16 v[214:215], v15 offset:8704
  ds_read_b64_tr_b16 v[216:217], v16 offset:0
  ds_read_b64_tr_b16 v[218:219], v16 offset:512
  ds_read_b64_tr_b16 v[220:221], v16 offset:8192
  ds_read_b64_tr_b16 v[222:223], v16 offset:8704
  s_waitcnt vmcnt(13) lgkmcnt(0)
  s_barrier
  s_add_u32 m0, s57, 65536
  s_add_u32 s54, s78, 0
  buffer_load_dwordx4 v8, s[24:27], s54 offen  lds
  s_add_u32 m0, s57, 69632
  s_add_u32 s54, s78, 131072
  buffer_load_dwordx4 v8, s[24:27], s54 offen  lds
  s_add_u32 m0, s57, 73728
  s_add_u32 s54, s78, 262144
  buffer_load_dwordx4 v8, s[24:27], s54 offen  lds
  s_add_u32 m0, s57, 77824
  s_add_u32 s54, s78, 393216
  buffer_load_dwordx4 v8, s[24:27], s54 offen  lds
  v_add_u32 v15, 16384, v11
  v_add_u32 v16, 16384, v12
  ds_read_b64_tr_b16 v[224:225], v15 offset:0
  ds_read_b64_tr_b16 v[226:227], v15 offset:512
  ds_read_b64_tr_b16 v[228:229], v15 offset:8192
  ds_read_b64_tr_b16 v[230:231], v15 offset:8704
  ds_read_b64_tr_b16 v[232:233], v16 offset:0
  ds_read_b64_tr_b16 v[234:235], v16 offset:512
  ds_read_b64_tr_b16 v[236:237], v16 offset:8192
  ds_read_b64_tr_b16 v[238:239], v16 offset:8704
  s_waitcnt vmcnt(13) lgkmcnt(0)
  s_barrier
  s_add_u32 m0, s57, 81920
  s_add_u32 s54, s78, 524288
  buffer_load_dwordx4 v8, s[24:27], s54 offen  lds
  s_add_u32 m0, s57, 86016
  s_add_u32 s54, s78, 655360
  buffer_load_dwordx4 v8, s[24:27], s54 offen  lds
  s_add_u32 m0, s57, 90112
  s_add_u32 s54, s78, 786432
  buffer_load_dwordx4 v8, s[24:27], s54 offen  lds
  s_add_u32 m0, s57, 94208
  s_add_u32 s54, s78, 917504
  buffer_load_dwordx4 v8, s[24:27], s54 offen  lds
  v_add_u32 v15, 32768, v11
  v_add_u32 v16, 32768, v12
  ds_read_b64_tr_b16 v[240:241], v15 offset:0
  ds_read_b64_tr_b16 v[242:243], v15 offset:512
  ds_read_b64_tr_b16 v[244:245], v15 offset:8192
  ds_read_b64_tr_b16 v[246:247], v15 offset:8704
  ds_read_b64_tr_b16 v[248:249], v16 offset:0
  ds_read_b64_tr_b16 v[250:251], v16 offset:512
  ds_read_b64_tr_b16 v[252:253], v16 offset:8192
  ds_read_b64_tr_b16 v[254:255], v16 offset:8704
  s_waitcnt vmcnt(13) lgkmcnt(0)
  s_barrier
  s_add_u32 m0, s57, 98304
  s_add_u32 s54, s78, 1048576
  buffer_load_dwordx4 v8, s[24:27], s54 offen  lds
  s_add_u32 m0, s57, 102400
  s_add_u32 s54, s78, 1179648
  buffer_load_dwordx4 v8, s[24:27], s54 offen  lds
  s_add_u32 m0, s57, 106496
  s_add_u32 s54, s78, 1310720
  buffer_load_dwordx4 v8, s[24:27], s54 offen  lds
  s_add_u32 m0, s57, 110592
  s_add_u32 s54, s78, 1441792
  buffer_load_dwordx4 v8, s[24:27], s54 offen  lds
  v_add_u32 v15, 49152, v11
  v_add_u32 v16, 49152, v12
  ds_read_b64_tr_b16 a[0:1], v15 offset:0
  ds_read_b64_tr_b16 a[2:3], v15 offset:512
  ds_read_b64_tr_b16 a[4:5], v15 offset:8192
  ds_read_b64_tr_b16 a[6:7], v15 offset:8704
  ds_read_b64_tr_b16 a[8:9], v16 offset:0
  ds_read_b64_tr_b16 a[10:11], v16 offset:512
  ds_read_b64_tr_b16 a[12:13], v16 offset:8192
  ds_read_b64_tr_b16 a[14:15], v16 offset:8704
  s_waitcnt vmcnt(13) lgkmcnt(0)
  s_barrier
  s_add_u32 m0, s57, 114688
  s_add_u32 s54, s78, 1572864
  buffer_load_dwordx4 v8, s[24:27], s54 offen  lds
  s_add_u32 m0, s57, 118784
  s_add_u32 s54, s78, 1703936
  buffer_load_dwordx4 v8, s[24:27], s54 offen  lds
  s_add_u32 m0, s57, 122880
  s_add_u32 s54, s78, 1835008
  buffer_load_dwordx4 v8, s[24:27], s54 offen  lds
  s_add_u32 m0, s57, 126976
  s_add_u32 s54, s78, 1966080
  buffer_load_dwordx4 v8, s[24:27], s54 offen  lds
  v_add_u32 v15, 65536, v11
  v_add_u32 v16, 65536, v12
  ds_read_b64_tr_b16 a[16:17], v15 offset:0
  ds_read_b64_tr_b16 a[18:19], v15 offset:512
  ds_read_b64_tr_b16 a[20:21], v15 offset:8192
  ds_read_b64_tr_b16 a[22:23], v15 offset:8704
  ds_read_b64_tr_b16 a[24:25], v16 offset:0
  ds_read_b64_tr_b16 a[26:27], v16 offset:512
  ds_read_b64_tr_b16 a[28:29], v16 offset:8192
  ds_read_b64_tr_b16 a[30:31], v16 offset:8704
  s_waitcnt vmcnt(12) lgkmcnt(0)
  s_barrier
  s_add_u32 m0, s57, 131072
  s_add_u32 s54, s78, 2097152
  buffer_load_dwordx4 v8, s[24:27], s54 offen  lds
  s_add_u32 m0, s57, 135168
  s_add_u32 s54, s78, 2228224
  buffer_load_dwordx4 v8, s[24:27], s54 offen  lds
  s_add_u32 m0, s57, 139264
  s_add_u32 s54, s78, 2359296
  buffer_load_dwordx4 v8, s[24:27], s54 offen  lds
  s_add_u32 m0, s57, 143360
  s_add_u32 s54, s78, 2490368
  buffer_load_dwordx4 v8, s[24:27], s54 offen  lds
  v_add_u32 v15, 81920, v11
  v_add_u32 v16, 81920, v12
  ds_read_b64_tr_b16 a[32:33], v15 offset:0
  ds_read_b64_tr_b16 a[34:35], v15 offset:512
  ds_read_b64_tr_b16 a[36:37], v15 offset:8192
  ds_read_b64_tr_b16 a[38:39], v15 offset:8704
  ds_read_b64_tr_b16 a[40:41], v16 offset:0
  ds_read_b64_tr_b16 a[42:43], v16 offset:512
  ds_read_b64_tr_b16 a[44:45], v16 offset:8192
  ds_read_b64_tr_b16 a[46:47], v16 offset:8704
  s_waitcnt vmcnt(12) lgkmcnt(0)
  s_barrier
  s_add_u32 m0, s57, 0
  s_add_u32 s54, s78, 2621440
  buffer_load_dwordx4 v8, s[24:27], s54 offen  lds
  s_add_u32 m0, s57, 4096
  s_add_u32 s54, s78, 2752512
  buffer_load_dwordx4 v8, s[24:27], s54 offen  lds
  s_add_u32 m0, s57, 8192
  s_add_u32 s54, s78, 2883584
  buffer_load_dwordx4 v8, s[24:27], s54 offen  lds
  s_add_u32 m0, s57, 12288
  s_add_u32 s54, s78, 3014656
  buffer_load_dwordx4 v8, s[24:27], s54 offen  lds
  s_getpc_b64 s[80:81]
  v_lshlrev_b32 v7, 2, v76
  global_load_dword v19, v7, s[80:81] offset:1024
  v_add_u32 v15, 98304, v11
  v_add_u32 v16, 98304, v12
  ds_read_b64_tr_b16 a[48:49], v15 offset:0
  ds_read_b64_tr_b16 a[50:51], v15 offset:512
  ds_read_b64_tr_b16 a[52:53], v15 offset:8192
  ds_read_b64_tr_b16 a[54:55], v15 offset:8704
  ds_read_b64_tr_b16 a[56:57], v16 offset:0
  ds_read_b64_tr_b16 a[58:59], v16 offset:512
  ds_read_b64_tr_b16 a[60:61], v16 offset:8192
  ds_read_b64_tr_b16 a[62:63], v16 offset:8704
  s_waitcnt vmcnt(13) lgkmcnt(0)
  s_barrier
  s_add_u32 m0, s57, 16384
  s_add_u32 s54, s78, 3145728
  buffer_load_dwordx4 v8, s[24:27], s54 offen  lds
  s_add_u32 m0, s57, 20480
  s_add_u32 s54, s78, 3276800
  buffer_load_dwordx4 v8, s[24:27], s54 offen  lds
  s_add_u32 m0, s57, 24576
  s_add_u32 s54, s78, 3407872
  buffer_load_dwordx4 v8, s[24:27], s54 offen  lds
  s_add_u32 m0, s57, 28672
  s_add_u32 s54, s78, 3538944
  buffer_load_dwordx4 v8, s[24:27], s54 offen  lds
  v_add_u32 v15, 114688, v11
  v_add_u32 v16, 114688, v12
  ds_read_b64_tr_b16 a[64:65], v15 offset:0
  ds_read_b64_tr_b16 a[66:67], v15 offset:512
  ds_read_b64_tr_b16 a[68:69], v15 offset:8192
  ds_read_b64_tr_b16 a[70:71], v15 offset:8704
  ds_read_b64_tr_b16 a[72:73], v16 offset:0
  ds_read_b64_tr_b16 a[74:75], v16 offset:512
  ds_read_b64_tr_b16 a[76:77], v16 offset:8192
  ds_read_b64_tr_b16 a[78:79], v16 offset:8704
  s_waitcnt vmcnt(13) lgkmcnt(0)
  s_barrier
  s_add_u32 m0, s57, 32768
  s_add_u32 s54, s78, 3670016
  buffer_load_dwordx4 v8, s[24:27], s54 offen  lds
  s_add_u32 m0, s57, 36864
  s_add_u32 s54, s78, 3801088
  buffer_load_dwordx4 v8, s[24:27], s54 offen  lds
  s_add_u32 m0, s57, 40960
  s_add_u32 s54, s78, 3932160
  buffer_load_dwordx4 v8, s[24:27], s54 offen  lds
  s_add_u32 m0, s57, 45056
  s_add_u32 s54, s78, 4063232
  buffer_load_dwordx4 v8, s[24:27], s54 offen  lds
  v_add_u32 v15, 131072, v11
  v_add_u32 v16, 131072, v12
  ds_read_b64_tr_b16 a[80:81], v15 offset:0
  ds_read_b64_tr_b16 a[82:83], v15 offset:512
  ds_read_b64_tr_b16 a[84:85], v15 offset:8192
  ds_read_b64_tr_b16 a[86:87], v15 offset:8704
  ds_read_b64_tr_b16 a[88:89], v16 offset:0
  ds_read_b64_tr_b16 a[90:91], v16 offset:512
  ds_read_b64_tr_b16 a[92:93], v16 offset:8192
  ds_read_b64_tr_b16 a[94:95], v16 offset:8704
  s_waitcnt vmcnt(13) lgkmcnt(0)
  s_barrier
  s_add_u32 m0, s57, 49152
  s_add_u32 s54, s78, 4194304
  buffer_load_dwordx4 v8, s[24:27], s54 offen  lds
  s_add_u32 m0, s57, 53248
  s_add_u32 s54, s78, 4325376
  buffer_load_dwordx4 v8, s[24:27], s54 offen  lds
  s_add_u32 m0, s57, 57344
  s_add_u32 s54, s78, 4456448
  buffer_load_dwordx4 v8, s[24:27], s54 offen  lds
  s_add_u32 m0, s57, 61440
  s_add_u32 s54, s78, 4587520
  buffer_load_dwordx4 v8, s[24:27], s54 offen  lds
  v_add_u32 v15, 147456, v11
  v_add_u32 v16, 147456, v12
  ds_read_b64_tr_b16 a[96:97], v15 offset:0
  ds_read_b64_tr_b16 a[98:99], v15 offset:512
  ds_read_b64_tr_b16 a[100:101], v15 offset:8192
  ds_read_b64_tr_b16 a[102:103], v15 offset:8704
  ds_read_b64_tr_b16 a[104:105], v16 offset:0
  ds_read_b64_tr_b16 a[106:107], v16 offset:512
  ds_read_b64_tr_b16 a[108:109], v16 offset:8192
  ds_read_b64_tr_b16 a[110:111], v16 offset:8704
  s_waitcnt vmcnt(13) lgkmcnt(0)
  s_barrier
  s_add_u32 m0, s57, 65536
  s_add_u32 s54, s79, 73728
  buffer_load_dwordx4 v10, s[28:31], s54 offen  lds
  s_add_u32 m0, s57, 69632
  s_add_u32 s54, s79, 82944
  buffer_load_dwordx4 v10, s[28:31], s54 offen  lds
  s_add_u32 m0, s57, 73728
  s_add_u32 s54, s79, 110592
  buffer_load_dwordx4 v10, s[28:31], s54 offen  lds
  s_add_u32 m0, s57, 77824
  s_add_u32 s54, s79, 119808
  buffer_load_dwordx4 v10, s[28:31], s54 offen  lds
  v_add_u32 v15, 16384, v11
  v_add_u32 v16, 16384, v12
  ds_read_b64_tr_b16 a[112:113], v15 offset:0
  ds_read_b64_tr_b16 a[114:115], v15 offset:512
  ds_read_b64_tr_b16 a[116:117], v15 offset:8192
  ds_read_b64_tr_b16 a[118:119], v15 offset:8704
  ds_read_b64_tr_b16 a[120:121], v16 offset:0
  ds_read_b64_tr_b16 a[122:123], v16 offset:512
  ds_read_b64_tr_b16 a[124:125], v16 offset:8192
  ds_read_b64_tr_b16 a[126:127], v16 offset:8704
  s_waitcnt vmcnt(12) lgkmcnt(0)
  s_barrier
  s_add_u32 m0, s57, 81920
  s_add_u32 s54, s79, 256
  buffer_load_dwordx4 v10, s[28:31], s54 offen  lds
  s_add_u32 m0, s57, 86016
  s_add_u32 s54, s79, 9472
  buffer_load_dwordx4 v10, s[28:31], s54 offen  lds
  s_add_u32 m0, s57, 90112
  s_add_u32 s54, s79, 37120
  buffer_load_dwordx4 v10, s[28:31], s54 offen  lds
  s_add_u32 m0, s57, 94208
  s_add_u32 s54, s79, 46336
  buffer_load_dwordx4 v10, s[28:31], s54 offen  lds
  v_add_u32 v15, 32768, v11
  v_add_u32 v16, 32768, v12
  ds_read_b64_tr_b16 a[128:129], v15 offset:0
  ds_read_b64_tr_b16 a[130:131], v15 offset:512
  ds_read_b64_tr_b16 a[132:133], v15 offset:8192
  ds_read_b64_tr_b16 a[134:135], v15 offset:8704
  ds_read_b64_tr_b16 a[136:137], v16 offset:0
  ds_read_b64_tr_b16 a[138:139], v16 offset:512
  ds_read_b64_tr_b16 a[140:141], v16 offset:8192
  ds_read_b64_tr_b16 a[142:143], v16 offset:8704
  s_waitcnt vmcnt(12) lgkmcnt(0)
  s_barrier
  s_add_u32 m0, s57, 98304
  s_add_u32 s54, s79, 512
  buffer_load_dwordx4 v10, s[28:31], s54 offen  lds
  s_add_u32 m0, s57, 102400
  s_add_u32 s54, s79, 9728
  buffer_load_dwordx4 v10, s[28:31], s54 offen  lds
  s_add_u32 m0, s57, 106496
  s_add_u32 s54, s79, 37376
  buffer_load_dwordx4 v10, s[28:31], s54 offen  lds
  s_add_u32 m0, s57, 110592
  s_add_u32 s54, s79, 46592
  buffer_load_dwordx4 v10, s[28:31], s54 offen  lds
  s_getpc_b64 s[80:81]
  v_lshlrev_b32 v7, 2, v76
  global_load_dword v19, v7, s[80:81] offset:1024
  v_add_u32 v15, 49152, v11
  v_add_u32 v16, 49152, v12
  ds_read_b64_tr_b16 a[144:145], v15 offset:0
  ds_read_b64_tr_b16 a[146:147], v15 offset:512
  ds_read_b64_tr_b16 a[148:149], v15 offset:8192
  ds_read_b64_tr_b16 a[150:151], v15 offset:8704
  ds_read_b64_tr_b16 a[152:153], v16 offset:0
  ds_read_b64_tr_b16 a[154:155], v16 offset:512
  ds_read_b64_tr_b16 a[156:157], v16 offset:8192
  ds_read_b64_tr_b16 a[158:159], v16 offset:8704
  s_waitcnt vmcnt(13) lgkmcnt(0)
  s_barrier
  s_add_u32 m0, s57, 114688
  s_add_u32 s54, s79, 74240
  buffer_load_dwordx4 v10, s[28:31], s54 offen  lds
  s_add_u32 m0, s57, 118784
  s_add_u32 s54, s79, 83456
  buffer_load_dwordx4 v10, s[28:31], s54 offen  lds
  s_add_u32 m0, s57, 122880
  s_add_u32 s54, s79, 111104
  buffer_load_dwordx4 v10, s[28:31], s54 offen  lds
  s_add_u32 m0, s57, 126976
  s_add_u32 s54, s79, 120320
  buffer_load_dwordx4 v10, s[28:31], s54 offen  lds
  v_add_u32 v15, 65536, v11
  v_add_u32 v16, 65536, v12
  ds_read_b64_tr_b16 a[160:161], v15 offset:0
  ds_read_b64_tr_b16 a[162:163], v15 offset:512
  ds_read_b64_tr_b16 a[164:165], v15 offset:8192
  ds_read_b64_tr_b16 a[166:167], v15 offset:8704
  ds_read_b64_tr_b16 a[168:169], v16 offset:0
  ds_read_b64_tr_b16 a[170:171], v16 offset:512
  ds_read_b64_tr_b16 a[172:173], v16 offset:8192
  ds_read_b64_tr_b16 a[174:175], v16 offset:8704
  s_waitcnt vmcnt(13) lgkmcnt(0)
  s_barrier
  s_add_u32 m0, s57, 131072
  s_add_u32 s54, s79, 74496
  buffer_load_dwordx4 v10, s[28:31], s54 offen  lds
  s_add_u32 m0, s57, 135168
  s_add_u32 s54, s79, 83712
  buffer_load_dwordx4 v10, s[28:31], s54 offen  lds
  s_add_u32 m0, s57, 139264
  s_add_u32 s54, s79, 111360
  buffer_load_dwordx4 v10, s[28:31], s54 offen  lds
  s_add_u32 m0, s57, 143360
  s_add_u32 s54, s79, 120576
  buffer_load_dwordx4 v10, s[28:31], s54 offen  lds
  v_add_u32 v15, 81920, v14
  ds_read_b64_tr_b16 a[176:177], v15 offset:0
  ds_read_b64_tr_b16 a[178:179], v15 offset:1024
  ds_read_b64_tr_b16 a[180:181], v15 offset:4096
  ds_read_b64_tr_b16 a[182:183], v15 offset:5120
  ds_read_b64_tr_b16 a[184:185], v15 offset:8192
  ds_read_b64_tr_b16 a[186:187], v15 offset:9216
  ds_read_b64_tr_b16 a[188:189], v15 offset:12288
  ds_read_b64_tr_b16 a[190:191], v15 offset:13312
  s_waitcnt vmcnt(13) lgkmcnt(0)
  s_barrier
  s_add_u32 m0, s57, 0
  s_add_u32 s54, s78, 0
  buffer_load_dwordx4 v8, s[20:23], s54 offen  lds
  s_add_u32 m0, s57, 4096
  s_add_u32 s54, s78, 131072
  buffer_load_dwordx4 v8, s[20:23], s54 offen  lds
  s_add_u32 m0, s57, 8192
  s_add_u32 s54, s78, 262144
  buffer_load_dwordx4 v8, s[20:23], s54 offen  lds
  s_add_u32 m0, s57, 12288
  s_add_u32 s54, s78, 393216
  buffer_load_dwordx4 v8, s[20:23], s54 offen  lds
  v_add_u32 v15, 98304, v14
  ds_read_b64_tr_b16 a[192:193], v15 offset:0
  ds_read_b64_tr_b16 a[194:195], v15 offset:1024
  ds_read_b64_tr_b16 a[196:197], v15 offset:4096
  ds_read_b64_tr_b16 a[198:199], v15 offset:5120
  ds_read_b64_tr_b16 a[200:201], v15 offset:8192
  ds_read_b64_tr_b16 a[202:203], v15 offset:9216
  ds_read_b64_tr_b16 a[204:205], v15 offset:12288
  ds_read_b64_tr_b16 a[206:207], v15 offset:13312
  s_waitcnt vmcnt(13) lgkmcnt(0)
  s_barrier
  s_add_u32 m0, s57, 16384
  s_add_u32 s54, s78, 524288
  buffer_load_dwordx4 v8, s[20:23], s54 offen  lds
  s_add_u32 m0, s57, 20480
  s_add_u32 s54, s78, 655360
  buffer_load_dwordx4 v8, s[20:23], s54 offen  lds
  s_add_u32 m0, s57, 24576
  s_add_u32 s54, s78, 786432
  buffer_load_dwordx4 v8, s[20:23], s54 offen  lds
  s_add_u32 m0, s57, 28672
  s_add_u32 s54, s78, 917504
  buffer_load_dwordx4 v8, s[20:23], s54 offen  lds
  v_add_u32 v15, 114688, v14
  ds_read_b64_tr_b16 a[208:209], v15 offset:0
  ds_read_b64_tr_b16 a[210:211], v15 offset:1024
  ds_read_b64_tr_b16 a[212:213], v15 offset:4096
  ds_read_b64_tr_b16 a[214:215], v15 offset:5120
  ds_read_b64_tr_b16 a[216:217], v15 offset:8192
  ds_read_b64_tr_b16 a[218:219], v15 offset:9216
  ds_read_b64_tr_b16 a[220:221], v15 offset:12288
  ds_read_b64_tr_b16 a[222:223], v15 offset:13312
  s_waitcnt vmcnt(12) lgkmcnt(0)
  s_barrier
  s_add_u32 m0, s57, 32768
  s_add_u32 s54, s78, 2097152
  buffer_load_dwordx4 v8, s[20:23], s54 offen  lds
  s_add_u32 m0, s57, 36864
  s_add_u32 s54, s78, 2228224
  buffer_load_dwordx4 v8, s[20:23], s54 offen  lds
  s_add_u32 m0, s57, 40960
  s_add_u32 s54, s78, 2359296
  buffer_load_dwordx4 v8, s[20:23], s54 offen  lds
  s_add_u32 m0, s57, 45056
  s_add_u32 s54, s78, 2490368
  buffer_load_dwordx4 v8, s[20:23], s54 offen  lds
  v_add_u32 v15, 131072, v14
  ds_read_b64_tr_b16 a[224:225], v15 offset:0
  ds_read_b64_tr_b16 a[226:227], v15 offset:1024
  ds_read_b64_tr_b16 a[228:229], v15 offset:4096
  ds_read_b64_tr_b16 a[230:231], v15 offset:5120
  ds_read_b64_tr_b16 a[232:233], v15 offset:8192
  ds_read_b64_tr_b16 a[234:235], v15 offset:9216
  ds_read_b64_tr_b16 a[236:237], v15 offset:12288
  ds_read_b64_tr_b16 a[238:239], v15 offset:13312
  s_waitcnt vmcnt(12) lgkmcnt(0)
  s_barrier
  s_add_u32 m0, s57, 49152
  s_add_u32 s54, s78, 3145728
  buffer_load_dwordx4 v8, s[16:19], s54 offen  lds
  s_add_u32 m0, s57, 53248
  s_add_u32 s54, s78, 3276800
  buffer_load_dwordx4 v8, s[16:19], s54 offen  lds
  s_add_u32 m0, s57, 57344
  s_add_u32 s54, s78, 3407872
  buffer_load_dwordx4 v8, s[16:19], s54 offen  lds
  s_add_u32 m0, s57, 61440
  s_add_u32 s54, s78, 3538944
  buffer_load_dwordx4 v8, s[16:19], s54 offen  lds
  v_add_u32 v15, 147456, v14
  ds_read_b64_tr_b16 a[240:241], v15 offset:0
  ds_read_b64_tr_b16 a[242:243], v15 offset:1024
  ds_read_b64_tr_b16 a[244:245], v15 offset:4096
  ds_read_b64_tr_b16 a[246:247], v15 offset:5120
  ds_read_b64_tr_b16 a[248:249], v15 offset:8192
  ds_read_b64_tr_b16 a[250:251], v15 offset:9216
  ds_read_b64_tr_b16 a[252:253], v15 offset:12288
  ds_read_b64_tr_b16 a[254:255], v15 offset:13312
  s_waitcnt vmcnt(12) lgkmcnt(0)
  s_barrier
  s_add_u32 m0, s57, 65536
  s_add_u32 s54, s78, 2621440
  buffer_load_dwordx4 v8, s[20:23], s54 offen  lds
  s_add_u32 m0, s57, 69632
  s_add_u32 s54, s78, 2752512
  buffer_load_dwordx4 v8, s[20:23], s54 offen  lds
  s_add_u32 m0, s57, 73728
  s_add_u32 s54, s78, 2883584
  buffer_load_dwordx4 v8, s[20:23], s54 offen  lds
  s_add_u32 m0, s57, 77824
  s_add_u32 s54, s78, 3014656
  buffer_load_dwordx4 v8, s[20:23], s54 offen  lds
  v_add_u32 v15, 16384, v11
  v_add_u32 v16, 16384, v12
  ds_read_b64_tr_b16 v[52:53], v15 offset:0
  ds_read_b64_tr_b16 v[54:55], v15 offset:512
  ds_read_b64_tr_b16 v[56:57], v15 offset:8192
  ds_read_b64_tr_b16 v[58:59], v15 offset:8704
  ds_read_b64_tr_b16 v[60:61], v16 offset:0
  ds_read_b64_tr_b16 v[62:63], v16 offset:512
  ds_read_b64_tr_b16 v[64:65], v16 offset:8192
  ds_read_b64_tr_b16 v[66:67], v16 offset:8704
  s_waitcnt vmcnt(12) lgkmcnt(0)
  s_barrier
  s_lshl_b32 s54, s52, 12
  s_add_u32 s54, s54, 16384
  v_add_u32 v7, s54, v76
  ds_write_b128 v7, v[52:55] offset:0
  ds_write_b128 v7, v[56:59] offset:1024
  ds_write_b128 v7, v[60:63] offset:2048
  ds_write_b128 v7, v[64:67] offset:3072
  s_add_u32 m0, s57, 81920
  s_add_u32 s54, s79, 1024
  buffer_load_dwordx4 v9, s[28:31], s54 offen  lds
  s_add_u32 m0, s57, 86016
  s_add_u32 s54, s79, 37888
  buffer_load_dwordx4 v9, s[28:31], s54 offen  lds
  s_add_u32 m0, s57, 90112
  s_add_u32 s54, s79, 74752
  buffer_load_dwordx4 v9, s[28:31], s54 offen  lds
  s_add_u32 m0, s57, 94208
  s_add_u32 s54, s79, 111616
  buffer_load_dwordx4 v9, s[28:31], s54 offen  lds
  v_add_u32 v15, 32768, v11
  v_add_u32 v16, 32768, v12
  ds_read_b64_tr_b16 v[36:37], v15 offset:0
  ds_read_b64_tr_b16 v[38:39], v15 offset:512
  ds_read_b64_tr_b16 v[40:41], v15 offset:8192
  ds_read_b64_tr_b16 v[42:43], v15 offset:8704
  ds_read_b64_tr_b16 v[44:45], v16 offset:0
  ds_read_b64_tr_b16 v[46:47], v16 offset:512
  ds_read_b64_tr_b16 v[48:49], v16 offset:8192
  ds_read_b64_tr_b16 v[50:51], v16 offset:8704
  s_waitcnt vmcnt(12) lgkmcnt(0)
  s_barrier
  s_lshl_b32 s54, s52, 12
  s_add_u32 s54, s54, 32768
  v_add_u32 v7, s54, v76
  ds_write_b128 v7, v[36:39] offset:0
  ds_write_b128 v7, v[40:43] offset:1024
  ds_write_b128 v7, v[44:47] offset:2048
  ds_write_b128 v7, v[48:51] offset:3072
  s_add_u32 m0, s57, 98304
  s_add_u32 s54, s79, 0
  buffer_load_dwordx4 v10, s[28:31], s54 offen  lds
  s_add_u32 m0, s57, 102400
  s_add_u32 s54, s79, 9216
  buffer_load_dwordx4 v10, s[28:31], s54 offen  lds
  s_add_u32 m0, s57, 106496
  s_add_u32 s54, s79, 36864
  buffer_load_dwordx4 v10, s[28:31], s54 offen  lds
  s_add_u32 m0, s57, 110592
  s_add_u32 s54, s79, 46080
  buffer_load_dwordx4 v10, s[28:31], s54 offen  lds
  v_add_u32 v15, 49152, v11
  v_add_u32 v16, 49152, v12
  ds_read_b64_tr_b16 v[52:53], v15 offset:0
  ds_read_b64_tr_b16 v[54:55], v15 offset:512
  ds_read_b64_tr_b16 v[56:57], v15 offset:8192
  ds_read_b64_tr_b16 v[58:59], v15 offset:8704
  ds_read_b64_tr_b16 v[60:61], v16 offset:0
  ds_read_b64_tr_b16 v[62:63], v16 offset:512
  ds_read_b64_tr_b16 v[64:65], v16 offset:8192
  ds_read_b64_tr_b16 v[66:67], v16 offset:8704
  s_waitcnt vmcnt(12) lgkmcnt(0)
  s_barrier
  s_lshl_b32 s54, s52, 12
  s_add_u32 s54, s54, 49152
  v_add_u32 v7, s54, v76
  ds_write_b128 v7, v[52:55] offset:0
  ds_write_b128 v7, v[56:59] offset:1024
  ds_write_b128 v7, v[60:63] offset:2048
  ds_write_b128 v7, v[64:67] offset:3072
  s_add_u32 m0, s57, 114688
  s_add_u32 s54, s79, 73984
  buffer_load_dwordx4 v10, s[28:31], s54 offen  lds
  s_add_u32 m0, s57, 118784
  s_add_u32 s54, s79, 83200
  buffer_load_dwordx4 v10, s[28:31], s54 offen  lds
  s_add_u32 m0, s57, 122880
  s_add_u32 s54, s79, 110848
  buffer_load_dwordx4 v10, s[28:31], s54 offen  lds
  s_add_u32 m0, s57, 126976
  s_add_u32 s54, s79, 120064
  buffer_load_dwordx4 v10, s[28:31], s54 offen  lds
  v_add_u32 v15, 65536, v11
  v_add_u32 v16, 65536, v12
  ds_read_b64_tr_b16 v[36:37], v15 offset:0
  ds_read_b64_tr_b16 v[38:39], v15 offset:512
  ds_read_b64_tr_b16 v[40:41], v15 offset:8192
  ds_read_b64_tr_b16 v[42:43], v15 offset:8704
  ds_read_b64_tr_b16 v[44:45], v16 offset:0
  ds_read_b64_tr_b16 v[46:47], v16 offset:512
  ds_read_b64_tr_b16 v[48:49], v16 offset:8192
  ds_read_b64_tr_b16 v[50:51], v16 offset:8704
  s_waitcnt vmcnt(12) lgkmcnt(0)
  s_barrier
  s_lshl_b32 s54, s52, 12
  s_add_u32 s54, s54, 65536
  v_add_u32 v7, s54, v76
  ds_write_b128 v7, v[36:39] offset:0
  ds_write_b128 v7, v[40:43] offset:1024
  ds_write_b128 v7, v[44:47] offset:2048
  ds_write_b128 v7, v[48:51] offset:3072
  s_add_u32 m0, s57, 131072
  s_add_u32 s54, s79, 768
  buffer_load_dwordx4 v10, s[28:31], s54 offen  lds
  s_add_u32 m0, s57, 135168
  s_add_u32 s54, s79, 9984
  buffer_load_dwordx4 v10, s[28:31], s54 offen  lds
  s_add_u32 m0, s57, 139264
  s_add_u32 s54, s79, 37632
  buffer_load_dwordx4 v10, s[28:31], s54 offen  lds
  s_add_u32 m0, s57, 143360
  s_add_u32 s54, s79, 46848
  buffer_load_dwordx4 v10, s[28:31], s54 offen  lds
  v_lshlrev_b32 v7, 3, v76
  s_lshl_b32 s54, s52, 13
  s_add_u32 s54, s54, 360448
  s_bitcmp1_b32 s52, 0
  s_cselect_b64 exec, 0xff, -1
  buffer_load_dword v35, v7, s[8:11], s54 offen sc1
  s_mov_b64 exec, -1
  s_getpc_b64 s[80:81]
C_pc:
  s_mov_b32 s55, (L_w0 - C_pc)
  s_cmp_eq_u32 s52, 1
  s_cselect_b32 s55, (L_w1 - C_pc), s55
  s_cmp_eq_u32 s52, 2
  s_cselect_b32 s55, (L_w2 - C_pc), s55
  s_cmp_eq_u32 s52, 3
  s_cselect_b32 s55, (L_w3 - C_pc), s55
  v_lshl_add_u32 v7, v76, 3, s55
  global_load_dword v35, v7, s[80:81]
  v_add_u32 v15, 81920, v11
  v_add_u32 v16, 81920, v12
  ds_read_b64_tr_b16 v[52:53], v15 offset:0
  ds_read_b64_tr_b16 v[54:55], v15 offset:512
  ds_read_b64_tr_b16 v[56:57], v15 offset:8192
  ds_read_b64_tr_b16 v[58:59], v15 offset:8704
  ds_read_b64_tr_b16 v[60:61], v16 offset:0
  ds_read_b64_tr_b16 v[62:63], v16 offset:512
  ds_read_b64_tr_b16 v[64:65], v16 offset:8192
  ds_read_b64_tr_b16 v[66:67], v16 offset:8704
  s_waitcnt vmcnt(14) lgkmcnt(0)
  s_barrier
  s_lshl_b32 s54, s52, 12
  s_add_u32 s54, s54, 81920
  v_add_u32 v7, s54, v76
  ds_write_b128 v7, v[52:55] offset:0
  ds_write_b128 v7, v[56:59] offset:1024
  ds_write_b128 v7, v[60:63] offset:2048
  ds_write_b128 v7, v[64:67] offset:3072
  v_lshrrev_b32 v20, 2, v76
  buffer_load_dword v21, v20, s[12:15], 0 offen sc1
  v_add_u32 v15, 98304, v13
  s_waitcnt lgkmcnt(0)
  ds_read_b64_tr_b16 v[36:37], v15 offset:0
  ds_read_b64_tr_b16 v[38:39], v15 offset:1024
  ds_read_b64_tr_b16 v[40:41], v15 offset:2048
  ds_read_b64_tr_b16 v[42:43], v15 offset:3072
  ds_read_b64_tr_b16 v[44:45], v15 offset:4096
  ds_read_b64_tr_b16 v[46:47], v15 offset:5120
  ds_read_b64_tr_b16 v[48:49], v15 offset:6144
  ds_read_b64_tr_b16 v[50:51], v15 offset:7168
  ds_read_b64_tr_b16 v[52:53], v15 offset:8192
  ds_read_b64_tr_b16 v[54:55], v15 offset:9216
  ds_read_b64_tr_b16 v[56:57], v15 offset:10240
  ds_read_b64_tr_b16 v[58:59], v15 offset:11264
  ds_read_b64_tr_b16 v[60:61], v15 offset:12288
  ds_read_b64_tr_b16 v[62:63], v15 offset:13312
  ds_read_b64_tr_b16 v[64:65], v15 offset:14336
  ds_read_b64_tr_b16 v[66:67], v15 offset:15360
  s_waitcnt vmcnt(11) lgkmcnt(0)
  s_barrier
  s_and_b32 s54, s52, 1
  s_lshl_b32 s54, s54, 13
  s_add_u32 s54, s54, 98304
  v_add_u32 v7, s54, v76
  ds_write_b128 v7, v[36:39] offset:0
  ds_write_b128 v7, v[40:43] offset:1024
  ds_write_b128 v7, v[44:47] offset:2048
  ds_write_b128 v7, v[48:51] offset:3072
  ds_write_b128 v7, v[52:55] offset:4096
  ds_write_b128 v7, v[56:59] offset:5120
  ds_write_b128 v7, v[60:63] offset:6144
  ds_write_b128 v7, v[64:67] offset:7168
  v_add_u32 v15, 114688, v14
  ds_read_b64_tr_b16 v[52:53], v15 offset:0
  ds_read_b64_tr_b16 v[54:55], v15 offset:1024
  ds_read_b64_tr_b16 v[56:57], v15 offset:4096
  ds_read_b64_tr_b16 v[58:59], v15 offset:5120
  ds_read_b64_tr_b16 v[60:61], v15 offset:8192
  ds_read_b64_tr_b16 v[62:63], v15 offset:9216
  ds_read_b64_tr_b16 v[64:65], v15 offset:12288
  ds_read_b64_tr_b16 v[66:67], v15 offset:13312
  s_waitcnt vmcnt(7) lgkmcnt(0)
  s_barrier
  s_lshl_b32 s54, s52, 12
  s_add_u32 s54, s54, 114688
  v_add_u32 v7, s54, v76
  ds_write_b128 v7, v[52:55] offset:0
  ds_write_b128 v7, v[56:59] offset:1024
  ds_write_b128 v7, v[60:63] offset:2048
  ds_write_b128 v7, v[64:67] offset:3072
  v_add_u32 v15, 131072, v14
  ds_read_b64_tr_b16 v[36:37], v15 offset:0
  ds_read_b64_tr_b16 v[38:39], v15 offset:1024
  ds_read_b64_tr_b16 v[40:41], v15 offset:4096
  ds_read_b64_tr_b16 v[42:43], v15 offset:5120
  ds_read_b64_tr_b16 v[44:45], v15 offset:8192
  ds_read_b64_tr_b16 v[46:47], v15 offset:9216
  ds_read_b64_tr_b16 v[48:49], v15 offset:12288
  ds_read_b64_tr_b16 v[50:51], v15 offset:13312
  s_waitcnt vmcnt(3) lgkmcnt(0)
  s_barrier
  s_lshl_b32 s54, s52, 12
  s_add_u32 s54, s54, 131072
  v_add_u32 v7, s54, v76
  ds_write_b128 v7, v[36:39] offset:0
  ds_write_b128 v7, v[40:43] offset:1024
  ds_write_b128 v7, v[44:47] offset:2048
  ds_write_b128 v7, v[48:51] offset:3072
  v_add_u32 v15, 147456, v14
  ds_read_b64_tr_b16 v[52:53], v15 offset:0
  ds_read_b64_tr_b16 v[54:55], v15 offset:1024
  ds_read_b64_tr_b16 v[56:57], v15 offset:4096
  ds_read_b64_tr_b16 v[58:59], v15 offset:5120
  ds_read_b64_tr_b16 v[60:61], v15 offset:8192
  ds_read_b64_tr_b16 v[62:63], v15 offset:9216
  ds_read_b64_tr_b16 v[64:65], v15 offset:12288
  ds_read_b64_tr_b16 v[66:67], v15 offset:13312
  s_waitcnt vmcnt(0) lgkmcnt(0)
  s_barrier
  s_lshl_b32 s54, s52, 12
  s_add_u32 s54, s54, 147456
  v_add_u32 v7, s54, v76
  ds_write_b128 v7, v[52:55] offset:0
  ds_write_b128 v7, v[56:59] offset:1024
  ds_write_b128 v7, v[60:63] offset:2048
  ds_write_b128 v7, v[64:67] offset:3072
  s_waitcnt lgkmcnt(0)
  s_branch C_rd1
C_rd0:
  s_sleep 2
  buffer_load_dword v21, v20, s[12:15], 0 offen sc1
  s_waitcnt vmcnt(0)
C_rd1:
  v_and_b32 v22, 0xff, v21
  v_cmp_gt_u32 vcc, 7, v22
  v_readlane_b32 s56, v21, 0
  s_mov_b32 s3, 1
  s_add_u32 s67, s67, 1
  s_cmp_ge_u32 s67, 131072
  s_cbranch_scc1 C_rd2
  s_cmp_lg_u32 vcc_hi, 0
  s_cbranch_scc1 C_rd0
  s_mov_b32 s3, 0
  s_cmp_eq_u32 s56, -1
  s_cbranch_scc1 C_rd2
  s_mov_b32 s3, 1
  v_readlane_b32 s54, v21, 10
  v_readlane_b32 s55, v21, 0
  s_nop 0
  s_bcnt1_i32_b32 s55, s55
  s_add_u32 s54, s54, s55
  v_readlane_b32 s55, v21, 1
  s_nop 0
  s_bcnt1_i32_b32 s55, s55
  s_add_u32 s54, s54, s55
  v_readlane_b32 s55, v21, 2
  s_nop 0
  s_bcnt1_i32_b32 s55, s55
  s_add_u32 s54, s54, s55
  v_readlane_b32 s55, v21, 3
  s_nop 0
  s_bcnt1_i32_b32 s55, s55
  s_add_u32 s54, s54, s55
  v_readlane_b32 s55, v21, 4
  s_nop 0
  s_bcnt1_i32_b32 s55, s55
  s_add_u32 s54, s54, s55
  v_readlane_b32 s55, v21, 5
  s_nop 0
  s_bcnt1_i32_b32 s55, s55
  s_add_u32 s54, s54, s55
  v_readlane_b32 s55, v21, 6
  s_nop 0
  s_bcnt1_i32_b32 s55, s55
  s_add_u32 s54, s54, s55
  v_readlane_b32 s55, v21, 7
  s_nop 0
  s_bcnt1_i32_b32 s55, s55
  s_add_u32 s54, s54, s55
  s_cmp_lt_u32 s54, 256
  s_cbranch_scc1 C_rd0
C_rd2:
  s_lshl_b32 s54, s3, 2
  s_add_u32 s54, s54, s52
  s_cmp_eq_u32 s54, 1
  s_cbranch_scc1 L_w1
  s_cmp_eq_u32 s54, 2
  s_cbranch_scc1 L_w2
  s_cmp_eq_u32 s54, 3
  s_cbranch_scc1 L_w3
  s_cmp_eq_u32 s54, 4
  s_cbranch_scc1 L_w4
  s_cmp_eq_u32 s54, 5
  s_cbranch_scc1 L_w5
  s_cmp_eq_u32 s54, 6
  s_cbranch_scc1 L_w6
  s_cmp_eq_u32 s54, 7
  s_cbranch_scc1 L_w7
L_w0:
  v_mov_b64 v[20:21], 0
  v_mov_b64 v[22:23], 0
  v_mov_b64 v[24:25], 0
  v_mov_b64 v[26:27], 0
  v_mov_b64 v[28:29], 0
  v_mov_b64 v[30:31], 0
  v_mov_b64 v[32:33], 0
  v_mov_b64 v[34:35], 0
  s_mov_b32 s78, 0x3f803f80
  s_mov_b32 s79, s78
  s_mov_b32 s65, 360448
  s_mov_b32 m0, 16128
  s_lshl_b32 s71, s53, 2
  s_add_u32 s71, s71, 128
  s_movk_i32 s56, 0x1000
  v_lshlrev_b32 v73, 2, v76
  v_mov_b32 v72, 0
  s_mov_b64 s[16:17], s[8:9]
  s_mov_b32 s18, 268435456
  s_mov_b32 s19, 0x20000
  s_getpc_b64 s[20:21]
Cf0_pc:
  s_add_u32 s20, s20, (Cf0_last - Cf0_pc)
  s_addc_u32 s21, s21, 0
  v_mov_b32 v68, 14880
  buffer_load_dwordx4 v[52:55], v76, s[8:11], s59 offen offset:0 sc1
  buffer_load_dwordx4 v[56:59], v76, s[8:11], s59 offen offset:1024 sc1
  ds_read_b128 v[36:39], v76 offset:16384
  ds_read_b128 v[40:43], v76 offset:17408
  ds_read_b128 v[60:63], v76 offset:18432
  ds_read_b128 v[64:67], v76 offset:19456
  ds_read_b128 v[0:3], v76 offset:4608
  ds_read_b128 v[4:7], v76 offset:5632
  ds_read_b128 v[8:11], v76 offset:6656
  ds_read_b128 v[12:15], v76 offset:7680
  s_waitcnt lgkmcnt(0)
  s_cmp_eq_u32 s66, 1
  s_branch Cf0_top2
.p2align 6
Cf0_h2:
  s_cmp_eq_u32 s66, 12
  s_cselect_b32 s56, s71, 0x1000
  ds_read_b32 v72, v76 offset:16128
  s_cmp_eq_u32 s66, 13
  s_cselect_b32 s54, 0x700, 0
  s_waitcnt lgkmcnt(0)
  v_readfirstlane_b32 s57, v72
  s_nop 0
  s_cmp_lt_u32 s57, s54
  s_cbranch_scc1 Cf0_kv3
Cf0_kvb:
  buffer_load_dwordx4 v[0:3], v76, s[8:11], s65 offen offset:0 sc1
  ds_read_b128 v[36:39], v76 offset:16384
  s_waitcnt lgkmcnt(0)
  v_mov_b64 v[20:21], 0
  v_mov_b64 v[22:23], 0
  v_mov_b64 v[24:25], 0
  v_mov_b64 v[26:27], 0
  v_mov_b32 v68, 14880
  buffer_load_dwordx4 v[0:3], v76, s[8:11], s65 offen offset:0 sc1
  ds_read_b128 v[40:43], v76 offset:17408
  s_waitcnt lgkmcnt(0)
  s_cmp_eq_u32 s66, 62
  s_cselect_b64 s[16:17], s[20:21], s[16:17]
  s_cselect_b32 s18, (Cf0_done - Cf0_last), s18
  s_cselect_b32 s70, 0, s70
  s_cmp_eq_u32 s66, 63
  s_cselect_b32 s59, 268435456, s59
  s_cselect_b32 s58, 268435456, s58
  buffer_load_dwordx4 v[0:3], v76, s[8:11], s65 offen offset:0 sc1
  ds_read_b128 v[60:63], v76 offset:18432
  s_waitcnt lgkmcnt(0)
  v_lshlrev_b32 v73, 2, v76
  buffer_load_dwordx4 v[52:55], v76, s[8:11], s59 offen offset:0 sc1
  buffer_load_dwordx4 v[56:59], v76, s[8:11], s59 offen offset:1024 sc1
  s_waitcnt vmcnt(4)
  v_max3_u32 v72, v0, v1, v2
  v_max_u32 v72, v72, v3
  ds_write_b128 v76, v[0:3] offset:4608
  v_cmp_eq_u32 vcc, -1, v72
  s_cbranch_vccnz Cf0_h2r
Cf0_h2w:
  s_cmp_eq_u32 s66, 63
  s_waitcnt lgkmcnt(0)
  s_barrier
  ds_read_b128 v[8:11], v76 offset:6656
  buffer_load_dwordx4 v76, s[8:11], s85 offen offset:0 sc1 lds
Cf0_top2:
  v_smfmac_f32_16x16x64_bf16 v[20:23], v[0:3], v[80:87], v74
  s_cbranch_scc1 Cf0_last
  v_smfmac_f32_16x16x64_bf16 v[28:31], v[0:3], v[36:43], v74
  buffer_load_dwordx4 v[44:47], v76, s[8:11], s58 offen offset:0 sc1
  s_mov_b32 m0, 16128
  v_smfmac_f32_16x16x64_bf16 v[24:27], v[0:3], v[88:95], v74
  buffer_load_dwordx4 v[48:51], v76, s[8:11], s58 offen offset:1024 sc1
  v_smfmac_f32_16x16x64_bf16 v[32:35], v[0:3], v[60:67], v74
  ds_read_b128 v[4:7], v76 offset:5632
  s_waitcnt lgkmcnt(1)
  v_smfmac_f32_16x16x64_bf16 v[20:23], v[8:11], v[112:119], v74
  ds_read_b128 v[12:15], v76 offset:7680
  v_smfmac_f32_16x16x64_bf16 v[24:27], v[8:11], v[120:127], v74
  ds_read_b128 v[36:39], v76 offset:32768
  v_smfmac_f32_16x16x64_bf16 v[28:31], v[8:11], v[208:215], v74
  buffer_store_dwordx4 v[16:19], v76, s[8:11], s68 offen sc1
  ds_read_b128 v[40:43], v76 offset:33792
  v_smfmac_f32_16x16x64_bf16 v[32:35], v[8:11], v[216:223], v74
  buffer_load_dword v73, s[16:19], s70 offen lds
  ds_read_b128 v[60:63], v76 offset:34816
  s_waitcnt lgkmcnt(4)
  v_smfmac_f32_16x16x64_bf16 v[20:23], v[4:7], v[96:103], v74
  ds_read_b128 v[64:67], v76 offset:35840
  v_smfmac_f32_16x16x64_bf16 v[24:27], v[4:7], v[104:111], v74
  s_waitcnt vmcnt(5)
  s_waitcnt lgkmcnt(4)
  v_smfmac_f32_16x16x64_bf16 v[20:23], v[12:15], v[128:135], v74
  s_barrier
  ds_read_b128 v[0:3], v76 offset:8704
  s_waitcnt lgkmcnt(3)
  v_smfmac_f32_16x16x64_bf16 v[28:31], v[4:7], v[36:43], v74
  ds_read_b128 v[36:39], v76 offset:49152
  v_smfmac_f32_16x16x64_bf16 v[24:27], v[12:15], v[136:143], v74
  ds_read_b128 v[40:43], v76 offset:50176
  s_waitcnt lgkmcnt(3)
  v_smfmac_f32_16x16x64_bf16 v[32:35], v[4:7], v[60:67], v74
  ds_read_b128 v[8:11], v76 offset:9728
  v_smfmac_f32_16x16x64_bf16 v[28:31], v[12:15], v[224:231], v74
  ds_read_b128 v[60:63], v76 offset:51200
  v_smfmac_f32_16x16x64_bf16 v[32:35], v[12:15], v[232:239], v74
  s_waitcnt vmcnt(4)
  ds_read_b128 v[64:67], v76 offset:52224
  s_waitcnt lgkmcnt(5)
  v_smfmac_f32_16x16x64_bf16 v[20:23], v[0:3], v[144:151], v74
  s_barrier
  ds_read_b128 v[4:7], v76 offset:11776
  s_waitcnt lgkmcnt(4)
  v_smfmac_f32_16x16x64_bf16 v[28:31], v[0:3], v[36:43], v74
  ds_read_b128 v[12:15], v76 offset:12800
  ds_read_b128 v[36:39], v75 offset:0
  v_smfmac_f32_16x16x64_bf16 v[24:27], v[0:3], v[152:159], v74
  ds_read_b128 v[16:19], v76 offset:10752
  s_waitcnt lgkmcnt(6)
  v_smfmac_f32_16x16x64_bf16 v[20:23], v[8:11], v[160:167], v74
  ds_read_b128 v[40:43], v75 offset:1024
  s_waitcnt lgkmcnt(5)
  v_smfmac_f32_16x16x64_bf16 v[32:35], v[0:3], v[60:67], v74
  ds_read_b128 v[60:63], v75 offset:2048
  v_smfmac_f32_16x16x64_bf16 v[24:27], v[8:11], v[168:175], v74
  ds_read_b128 v[64:67], v75 offset:3072
  s_waitcnt lgkmcnt(6)
  v_smfmac_f32_16x16x64_bf16 v[20:23], v[4:7], v[176:183], v74
  buffer_load_dword off, s[12:15], s56 sc1 lds
  s_waitcnt lgkmcnt(5)
  v_smfmac_f32_16x16x64_bf16 v[20:23], v[12:15], v[192:199], v74
  s_waitcnt lgkmcnt(2)
  v_smfmac_f32_16x16x64_bf16 v[20:23], v[16:19], v[36:43], v74
  ds_read_b128 v[36:39], v75 offset:16384
  v_smfmac_f32_16x16x64_bf16 v[24:27], v[4:7], v[184:191], v74
  ds_read_b128 v[40:43], v75 offset:17408
  s_waitcnt lgkmcnt(2)
  v_smfmac_f32_16x16x64_bf16 v[24:27], v[16:19], v[60:67], v74
  ds_read_b128 v[60:63], v75 offset:18432
  v_add_f32 v20, v20, v22
  v_smfmac_f32_16x16x64_bf16 v[24:27], v[12:15], v[200:207], v74
  ds_read_b128 v[64:67], v75 offset:19456
  v_add_f32 v21, v21, v23
  v_smfmac_f32_16x16x64_bf16 v[28:31], v[16:19], v[240:247], v74
  v_mov_b64 v[70:71], s[78:79]
  v_smfmac_f32_16x16x64_bf16 v[28:31], v[4:7], a[0:7], v74
  s_waitcnt lgkmcnt(2)
  v_add_f32 v24, v24, v26
  v_smfmac_f32_16x16x64_bf16 v[28:31], v[8:11], v[36:43], v74
  ds_read_b128 v[36:39], v68
  v_cvt_pk_bf16_f32 v22, v20, v24
  v_smfmac_f32_16x16x64_bf16 v[28:31], v[12:15], a[16:23], v74
  ds_read_b128 v[40:43], v68
  ds_write_b32 v79, v22 offset:0
  s_waitcnt lgkmcnt(3)
  v_add_f32 v25, v25, v27
  v_cvt_pk_bf16_f32 v23, v21, v25
  v_smfmac_f32_16x16x64_bf16 v[32:35], v[8:11], v[60:67], v74
  ds_write_b32 v79, v23 offset:576
  v_cmp_u_f32 vcc, v20, v21
  v_smfmac_f32_16x16x64_bf16 v[32:35], v[16:19], v[248:255], v74
  v_add_f32 v28, v28, v30
  v_smfmac_f32_16x16x64_bf16 v[32:35], v[4:7], a[8:15], v74
  v_add_f32 v29, v29, v31
  v_smfmac_f32_16x16x64_bf16 v[32:35], v[12:15], a[24:31], v74
  s_cbranch_vccnz Cf0_rec
Cf0_recok:
  s_waitcnt lgkmcnt(3)
  v_smfmac_f32_16x16x64_bf16 v[36:39], v[16:19], a[128:135], v74
  s_waitcnt lgkmcnt(0)
  s_barrier
  ds_read_b128 v[60:63], v77
  v_smfmac_f32_16x16x64_bf16 v[40:43], v[16:19], a[136:143], v74
  ds_read_b128 v[64:67], v77 offset:128
  v_add_f32 v32, v32, v34
  v_cvt_pk_bf16_f32 v30, v28, v32
  v_smfmac_f32_16x16x64_bf16 v[36:39], v[0:3], a[96:103], v74
  ds_write_b32 v79, v30 offset:256
  v_add_f32 v33, v33, v35
  v_cvt_pk_bf16_f32 v31, v29, v33
  v_smfmac_f32_16x16x64_bf16 v[40:43], v[0:3], a[104:111], v74
  ds_write_b32 v79, v31 offset:832
  v_xor_b32 v75, 0x8000, v75
  v_smfmac_f32_16x16x64_bf16 v[36:39], v[4:7], a[144:151], v74
  ds_read_b128 v[0:3], v76 offset:4608
  v_mov_b32 v29, 0
  v_smfmac_f32_16x16x64_bf16 v[40:43], v[4:7], a[152:159], v74
  s_waitcnt vmcnt(3) lgkmcnt(3)
  v_mov_b32 v30, 0
  v_mfma_f32_16x16x32_bf16 v[44:47], v[44:47], v[60:63], 0
  ds_read_b128 v[4:7], v76 offset:5632
  s_waitcnt lgkmcnt(2)
  v_mfma_f32_16x16x32_bf16 v[44:47], v[48:51], v[64:67], v[44:47]
  s_barrier
  v_smfmac_f32_16x16x64_bf16 v[36:39], v[8:11], a[112:119], v74
  ds_read_b128 v[20:23], v77 offset:256
  ds_read_b128 v[24:27], v77 offset:384
  v_smfmac_f32_16x16x64_bf16 v[40:43], v[8:11], a[120:127], v74
  ds_read_b128 v[8:11], v76 offset:6656
  v_add_f32_dpp v72, v46, v44 quad_perm:[2,3,0,1] row_mask:0xf bank_mask:0xf
  v_add_f32_dpp v73, v47, v45 quad_perm:[2,3,0,1] row_mask:0xf bank_mask:0xf
  v_smfmac_f32_16x16x64_bf16 v[36:39], v[12:15], a[160:167], v74
  s_waitcnt lgkmcnt(4)
  v_exp_f32_dpp v72, v72 quad_perm:[0,1,0,1] row_mask:0xf bank_mask:0xf
  v_smfmac_f32_16x16x64_bf16 v[40:43], v[12:15], a[168:175], v74
  ds_read_b128 v[12:15], v76 offset:7680
  v_exp_f32_dpp v73, v73 quad_perm:[0,1,0,1] row_mask:0xf bank_mask:0xf
  v_smfmac_f32_16x16x64_bf16 v[36:39], v[0:3], a[32:39], v74
  s_waitcnt lgkmcnt(2)
  v_cvt_pk_bf16_f32 v72, v72, v73
  v_mfma_f32_16x16x32_bf16 v[20:23], v[20:23], v[60:63], 0
  ds_write_b32 v78, v72 offset:512
  v_mov_b64 v[16:17], 0
  v_mfma_f32_16x16x32_bf16 v[20:23], v[24:27], v[64:67], v[20:23]
  ds_read_b128 v[44:47], v75 offset:16384
  v_mov_b64 v[18:19], 0
  v_smfmac_f32_16x16x64_bf16 v[40:43], v[0:3], a[40:47], v74
  ds_read_b128 v[48:51], v75 offset:17408
  v_mov_b64 v[68:69], s[78:79]
  v_smfmac_f32_16x16x64_bf16 v[36:39], v[4:7], a[48:55], v74
  s_waitcnt lgkmcnt(4)
  v_add_f32_dpp v24, v22, v20 quad_perm:[2,3,0,1] row_mask:0xf bank_mask:0xf
  v_add_f32_dpp v25, v23, v21 quad_perm:[2,3,0,1] row_mask:0xf bank_mask:0xf
  v_smfmac_f32_16x16x64_bf16 v[36:39], v[8:11], a[64:71], v74
  s_waitcnt lgkmcnt(2)
  s_barrier
  ds_read_b128 v[32:35], v78 offset:512
  v_smfmac_f32_16x16x64_bf16 v[36:39], v[12:15], a[80:87], v74
  ds_read_b128 v[60:63], v75 offset:18432
  v_mul_f32 v24, s69, v24
  v_smfmac_f32_16x16x64_bf16 v[40:43], v[4:7], a[56:63], v74
  ds_read_b128 v[64:67], v75 offset:19456
  v_mul_f32 v25, s69, v25
  v_smfmac_f32_16x16x64_bf16 v[40:43], v[8:11], a[72:79], v74
  v_exp_f32_dpp v24, v24 quad_perm:[0,1,0,1] row_mask:0xf bank_mask:0xf
  v_smfmac_f32_16x16x64_bf16 v[40:43], v[12:15], a[88:95], v74
  s_waitcnt lgkmcnt(2)
  v_exp_f32_dpp v25, v25 quad_perm:[0,1,0,1] row_mask:0xf bank_mask:0xf
  v_mfma_f32_16x16x32_bf16 v[8:11], v[32:35], v[68:71], 0
  v_add_f32 v36, v36, v38
  v_add_f32 v37, v37, v39
  v_mfma_f32_16x16x32_bf16 v[0:3], v[32:35], v[52:55], 0
  v_add_f32 v40, v40, v42
  v_add_f32 v41, v41, v43
  v_mfma_f32_16x16x32_bf16 v[4:7], v[32:35], v[56:59], 0
  v_cvt_pk_bf16_f32 v28, v24, v25
  v_cvt_pk_bf16_f32 v72, v36, v37
  v_cvt_pk_bf16_f32 v73, v40, v41
  v_mfma_f32_16x16x16_bf16 v[8:11], v[28:29], v[68:69], v[8:11]
  v_cvt_pk_bf16_f32 v31, v24, v25
  v_mov_b64 v[20:21], 0
  v_mfma_f32_16x16x16_bf16 v[0:3], v[28:29], v[72:73], v[0:3]
  ds_read_b128 v[52:55], v75 offset:32768
  v_mov_b64 v[22:23], 0
  v_mfma_f32_16x16x16_bf16 v[4:7], v[30:31], v[72:73], v[4:7]
  v_rcp_f32 v10, v8
  v_rcp_f32 v11, v9
  v_mul_f32 v0, v10, v0
  v_mul_f32 v1, v11, v1
  v_max3_f32 v8, v8, v9, v10
  v_mul_f32 v4, v10, v4
  v_mul_f32 v5, v11, v5
  v_cvt_pk_bf16_f32 v2, v0, v4
  ds_write_b32 v79, v2 offset:8704
  v_cvt_pk_bf16_f32 v3, v1, v5
  ds_write_b32 v79, v3 offset:9280
  ds_read_b128 v[12:15], v78 offset:8704
  v_max_f32 v8, v8, v11
  v_cmp_le_f32 vcc, 1317011456, v8
  v_mov_b64 v[24:25], 0
  v_mov_b64 v[26:27], 0
  ds_read_b128 v[56:59], v75 offset:33792
  s_cbranch_vccnz Cf0_mx
Cf0_mxok:
  s_waitcnt lgkmcnt(2)
  s_barrier
  ds_read_b128 v[0:3], v78 offset:8768
  s_waitcnt lgkmcnt(2)
  v_smfmac_f32_16x16x64_bf16 v[16:19], v[12:15], v[44:51], v74
  ds_read_b128 v[4:7], v78 offset:8832
  v_smfmac_f32_16x16x64_bf16 v[20:23], v[12:15], a[192:199], v74
  ds_read_b128 v[8:11], v78 offset:8896
  v_smfmac_f32_16x16x64_bf16 v[24:27], v[12:15], a[208:215], v74
  ds_read_b128 v[36:39], v75 offset:34816
  s_waitcnt lgkmcnt(3)
  v_smfmac_f32_16x16x64_bf16 v[16:19], v[0:3], v[60:67], v74
  ds_read_b128 v[40:43], v75 offset:35840
  s_waitcnt lgkmcnt(3)
  v_smfmac_f32_16x16x64_bf16 v[16:19], v[4:7], a[176:183], v74
  ds_read_b128 v[68:71], v76 offset:13824
  s_waitcnt lgkmcnt(3)
  v_smfmac_f32_16x16x64_bf16 v[16:19], v[8:11], a[184:191], v74
  ds_read_b128 v[44:47], v75 offset:49152
  v_smfmac_f32_16x16x64_bf16 v[20:23], v[0:3], a[200:207], v74
  ds_read_b128 v[48:51], v75 offset:50176
  v_smfmac_f32_16x16x64_bf16 v[20:23], v[4:7], v[52:59], v74
  ds_read_b128 v[60:63], v75 offset:51200
  s_waitcnt lgkmcnt(4)
  v_cvt_pk_bf16_f32 v16, v16, v17
  v_cvt_pk_bf16_f32 v17, v18, v19
  v_bfi_b32 v16, 1, s72, v16
  v_smfmac_f32_16x16x64_bf16 v[20:23], v[8:11], v[36:43], v74
  s_waitcnt lgkmcnt(3)
  buffer_store_dwordx2 v[16:17], v68, s[8:11], s73 offen
  v_mov_b64 v[32:33], 0
  v_smfmac_f32_16x16x64_bf16 v[24:27], v[0:3], a[216:223], v74
  ds_read_b128 v[64:67], v75 offset:52224
  v_mov_b64 v[34:35], 0
  v_smfmac_f32_16x16x64_bf16 v[24:27], v[4:7], a[224:231], v74
  v_cvt_pk_bf16_f32 v20, v20, v21
  v_cvt_pk_bf16_f32 v21, v22, v23
  v_bfi_b32 v20, 1, s72, v20
  v_smfmac_f32_16x16x64_bf16 v[24:27], v[8:11], a[232:239], v74
  buffer_store_dwordx2 v[20:21], v68, s[8:11], s74 offen
  s_waitcnt lgkmcnt(2)
  v_smfmac_f32_16x16x64_bf16 v[32:35], v[12:15], v[44:51], v74
  s_waitcnt lgkmcnt(0)
  v_smfmac_f32_16x16x64_bf16 v[32:35], v[0:3], v[60:67], v74
  v_cvt_pk_bf16_f32 v24, v24, v25
  v_cvt_pk_bf16_f32 v25, v26, v27
  v_bfi_b32 v24, 1, s72, v24
  v_smfmac_f32_16x16x64_bf16 v[32:35], v[4:7], a[240:247], v74
  buffer_store_dwordx2 v[24:25], v68, s[8:11], s75 offen
  v_smfmac_f32_16x16x64_bf16 v[32:35], v[8:11], a[248:255], v74
  v_mov_b64 v[18:19], v[72:73]
  s_nop 4
  v_cvt_pk_bf16_f32 v32, v32, v33
  v_cvt_pk_bf16_f32 v33, v34, v35
  v_bfi_b32 v32, 1, s72, v32
  buffer_store_dwordx2 v[32:33], v68, s[8:11], s76 offen
  ds_read_b128 v[0:3], v76 offset:14848
  s_waitcnt lgkmcnt(0)
  ds_read_b64 v[16:17], v77 offset:256
  s_waitcnt lgkmcnt(0)
  ds_read_b128 v[64:67], v76 offset:19456
  s_waitcnt lgkmcnt(0)
  v_xor_b32 v75, 0x8000, v75
  v_mov_b64 v[28:29], 0
  v_mov_b64 v[30:31], 0
  v_mov_b64 v[32:33], 0
  v_mov_b64 v[34:35], 0
  buffer_load_dwordx4 v[52:55], v76, s[8:11], s60 offen offset:0 sc1
  buffer_load_dwordx4 v[56:59], v76, s[8:11], s60 offen offset:1024 sc1
  s_add_u32 s66, s66, 1
  s_xor_b32 s64, s64, 16384
  s_xor_b32 s65, s65, 16384
  s_add_u32 s58, s58, 655360
  s_add_u32 s59, s59, 655360
  s_add_u32 s70, s70, 655360
  s_add_u32 s68, s68, 655360
  s_mov_b32 m0, 10752
  s_add_u32 s85, s65, 6144
  s_waitcnt lgkmcnt(0)
  s_waitcnt vmcnt(1)
  v_mfma_f32_16x16x32_bf16 v[4:7], v[0:3], v[52:55], 0
  v_bitop3_b32 v72, v52, v54, s72 bitop3:0x7e
  s_waitcnt vmcnt(0)
  v_mfma_f32_16x16x32_bf16 v[4:7], v[0:3], v[56:59], v[4:7]
  v_bitop3_b32 v73, v56, v58, s72 bitop3:0x7e
  v_bitop3_b32 v72, v72, v73, 1 bitop3:0xa8
  v_cmp_ne_u32 vcc, 0, v72
  s_nop 3
  v_add_f32_dpp v4, v4, v4 row_ror:4 row_mask:0xf bank_mask:0xf
  v_add_f32_dpp v5, v5, v5 row_ror:4 row_mask:0xf bank_mask:0xf
  s_cmp_eq_u64 vcc, 0
  v_add_f32_dpp v4, v4, v4 row_ror:8 row_mask:0xf bank_mask:0xf
  v_add_f32_dpp v5, v5, v5 row_ror:8 row_mask:0xf bank_mask:0xf
  s_cselect_b32 s54, s62, 268435456
  v_cvt_pk_bf16_f32 v4, v4, v5
  buffer_store_dword v4, v69, s[8:11], s54 offen
  s_cbranch_vccnz Cf0_h1r
  s_xor_b32 s62, s62, 16384
  buffer_store_dword v71, v69, s[8:11], s62 offen
  s_xor_b32 s72, s72, 1
  s_branch Cf0_h2
Cf0_h1r:
  s_mov_b64 exec, vcc
  buffer_load_dwordx4 v[52:55], v76, s[8:11], s60 offen offset:0 sc1
  buffer_load_dwordx4 v[56:59], v76, s[8:11], s60 offen offset:1024 sc1
  s_mov_b64 exec, -1
  s_add_u32 s67, s67, 1
  s_waitcnt vmcnt(1)
  v_mfma_f32_16x16x32_bf16 v[4:7], v[0:3], v[52:55], 0
  v_bitop3_b32 v72, v52, v54, s72 bitop3:0x7e
  s_waitcnt vmcnt(0)
  v_mfma_f32_16x16x32_bf16 v[4:7], v[0:3], v[56:59], v[4:7]
  v_bitop3_b32 v73, v56, v58, s72 bitop3:0x7e
  v_bitop3_b32 v72, v72, v73, 1 bitop3:0xa8
  v_cmp_ne_u32 vcc, 0, v72
  s_cbranch_vccz Cf0_h1p
Cf0_h1s:
  s_mov_b64 exec, vcc
  buffer_load_dwordx4 v[52:55], v76, s[8:11], s60 offen offset:0 sc1
  buffer_load_dwordx4 v[56:59], v76, s[8:11], s60 offen offset:1024 sc1
  s_mov_b64 exec, -1
  s_add_u32 s67, s67, 1
  s_waitcnt vmcnt(1)
  v_mfma_f32_16x16x32_bf16 v[4:7], v[0:3], v[52:55], 0
  v_bitop3_b32 v72, v52, v54, s72 bitop3:0x7e
  s_waitcnt vmcnt(0)
  v_mfma_f32_16x16x32_bf16 v[4:7], v[0:3], v[56:59], v[4:7]
  v_bitop3_b32 v73, v56, v58, s72 bitop3:0x7e
  v_bitop3_b32 v72, v72, v73, 1 bitop3:0xa8
  v_cmp_ne_u32 vcc, 0, v72
  s_cbranch_vccz Cf0_h1p
  s_cmp_lt_u32 s67, 131072
  s_cbranch_scc1 Cf0_h1s
Cf0_h1p:
  s_nop 2
  v_add_f32_dpp v4, v4, v4 row_ror:4 row_mask:0xf bank_mask:0xf
  v_add_f32_dpp v5, v5, v5 row_ror:4 row_mask:0xf bank_mask:0xf
  s_nop 0
  v_add_f32_dpp v4, v4, v4 row_ror:8 row_mask:0xf bank_mask:0xf
  v_add_f32_dpp v5, v5, v5 row_ror:8 row_mask:0xf bank_mask:0xf
  v_cvt_pk_bf16_f32 v4, v4, v5
  buffer_store_dword v4, v69, s[8:11], s62 offen
  s_xor_b32 s62, s62, 16384
  buffer_store_dword v71, v69, s[8:11], s62 offen
  s_xor_b32 s72, s72, 1
  s_branch Cf0_h2
Cf0_h2r:
  s_mov_b64 exec, vcc
  buffer_load_dwordx4 v[0:3], v76, s[8:11], s65 offen offset:0 sc1
  s_mov_b64 exec, -1
  s_add_u32 s67, s67, 1
  s_waitcnt vmcnt(4)
  v_max3_u32 v72, v0, v1, v2
  v_max_u32 v72, v72, v3
  ds_write_b128 v76, v[0:3] offset:4608
  v_cmp_eq_u32 vcc, -1, v72
  s_cbranch_vccz Cf0_h2w
  s_mov_b64 exec, vcc
  buffer_load_dwordx4 v[0:3], v76, s[8:11], s65 offen offset:0 sc1
  s_mov_b64 exec, -1
  s_add_u32 s67, s67, 1
  s_waitcnt vmcnt(4)
  v_max3_u32 v72, v0, v1, v2
  v_max_u32 v72, v72, v3
  ds_write_b128 v76, v[0:3] offset:4608
  v_cmp_eq_u32 vcc, -1, v72
  s_cbranch_vccz Cf0_h2w
Cf0_h2s:
  s_mov_b64 exec, vcc
  buffer_load_dwordx4 v[0:3], v76, s[8:11], s65 offen offset:0 sc1
  s_mov_b64 exec, -1
  s_add_u32 s67, s67, 1
  s_waitcnt vmcnt(2)
  v_max3_u32 v72, v0, v1, v2
  v_max_u32 v72, v72, v3
  ds_write_b128 v76, v[0:3] offset:4608
  v_cmp_eq_u32 vcc, -1, v72
  s_cbranch_vccz Cf0_h2w
  s_mov_b64 exec, vcc
  buffer_load_dwordx4 v[0:3], v76, s[8:11], s65 offen offset:0 sc1
  s_mov_b64 exec, -1
  s_add_u32 s67, s67, 1
  s_waitcnt vmcnt(2)
  v_max3_u32 v72, v0, v1, v2
  v_max_u32 v72, v72, v3
  ds_write_b128 v76, v[0:3] offset:4608
  v_cmp_eq_u32 vcc, -1, v72
  s_cbranch_vccz Cf0_h2w
  s_mov_b64 exec, vcc
  buffer_load_dwordx4 v[0:3], v76, s[8:11], s65 offen offset:0 sc1
  s_mov_b64 exec, -1
  s_add_u32 s67, s67, 1
  s_waitcnt vmcnt(2)
  v_max3_u32 v72, v0, v1, v2
  v_max_u32 v72, v72, v3
  ds_write_b128 v76, v[0:3] offset:4608
  v_cmp_eq_u32 vcc, -1, v72
  s_cbranch_vccz Cf0_h2w
  s_cmp_lt_u32 s67, 131072
  s_cbranch_scc1 Cf0_h2s
  s_branch Cf0_h2w
Cf0_rec:
  s_nop 7
  s_waitcnt vmcnt(0) lgkmcnt(0)
  v_max3_u32 v72, v0, v1, v2
  v_max3_u32 v72, v72, v3, v4
  v_max3_u32 v72, v72, v5, v6
  v_max3_u32 v72, v72, v7, v8
  v_max3_u32 v72, v72, v9, v10
  v_max3_u32 v72, v72, v11, v12
  v_max3_u32 v72, v72, v13, v14
  v_max3_u32 v72, v72, v15, v16
  v_max3_u32 v72, v72, v17, v18
  v_max_u32 v72, v72, v19
  v_cmp_eq_u32 vcc, -1, v72
  s_cbranch_vccz Cf0_recok
  s_barrier
  v_mov_b64 v[20:21], 0
  v_mov_b64 v[22:23], 0
  v_mov_b64 v[24:25], 0
  v_mov_b64 v[26:27], 0
  v_mov_b64 v[28:29], 0
  v_mov_b64 v[30:31], 0
  v_mov_b64 v[32:33], 0
  v_mov_b64 v[34:35], 0
  s_waitcnt lgkmcnt(0)
  s_barrier
  ds_read_b128 v[0:3], v76 offset:4608
  s_waitcnt lgkmcnt(0)
  v_smfmac_f32_16x16x64_bf16 v[20:23], v[0:3], v[80:87], v74
  v_smfmac_f32_16x16x64_bf16 v[24:27], v[0:3], v[88:95], v74
  ds_read_b128 v[60:63], v76 offset:16384
  ds_read_b128 v[64:67], v76 offset:17408
  s_waitcnt lgkmcnt(0)
  v_smfmac_f32_16x16x64_bf16 v[28:31], v[0:3], v[60:67], v74
  ds_read_b128 v[60:63], v76 offset:18432
  ds_read_b128 v[64:67], v76 offset:19456
  s_waitcnt lgkmcnt(0)
  v_smfmac_f32_16x16x64_bf16 v[32:35], v[0:3], v[60:67], v74
  ds_read_b128 v[4:7], v76 offset:5632
  s_waitcnt lgkmcnt(0)
  v_smfmac_f32_16x16x64_bf16 v[20:23], v[4:7], v[96:103], v74
  v_smfmac_f32_16x16x64_bf16 v[24:27], v[4:7], v[104:111], v74
  ds_read_b128 v[60:63], v76 offset:32768
  ds_read_b128 v[64:67], v76 offset:33792
  s_waitcnt lgkmcnt(0)
  v_smfmac_f32_16x16x64_bf16 v[28:31], v[4:7], v[60:67], v74
  ds_read_b128 v[60:63], v76 offset:34816
  ds_read_b128 v[64:67], v76 offset:35840
  s_waitcnt lgkmcnt(0)
  v_smfmac_f32_16x16x64_bf16 v[32:35], v[4:7], v[60:67], v74
  ds_read_b128 v[8:11], v76 offset:6656
  s_waitcnt lgkmcnt(0)
  v_smfmac_f32_16x16x64_bf16 v[20:23], v[8:11], v[112:119], v74
  v_smfmac_f32_16x16x64_bf16 v[24:27], v[8:11], v[120:127], v74
  v_smfmac_f32_16x16x64_bf16 v[28:31], v[8:11], v[208:215], v74
  v_smfmac_f32_16x16x64_bf16 v[32:35], v[8:11], v[216:223], v74
  ds_read_b128 v[12:15], v76 offset:7680
  s_waitcnt lgkmcnt(0)
  v_smfmac_f32_16x16x64_bf16 v[20:23], v[12:15], v[128:135], v74
  v_smfmac_f32_16x16x64_bf16 v[24:27], v[12:15], v[136:143], v74
  v_smfmac_f32_16x16x64_bf16 v[28:31], v[12:15], v[224:231], v74
  v_smfmac_f32_16x16x64_bf16 v[32:35], v[12:15], v[232:239], v74
  ds_read_b128 v[0:3], v76 offset:8704
  s_waitcnt lgkmcnt(0)
  v_smfmac_f32_16x16x64_bf16 v[20:23], v[0:3], v[144:151], v74
  v_smfmac_f32_16x16x64_bf16 v[24:27], v[0:3], v[152:159], v74
  ds_read_b128 v[60:63], v76 offset:49152
  ds_read_b128 v[64:67], v76 offset:50176
  s_waitcnt lgkmcnt(0)
  v_smfmac_f32_16x16x64_bf16 v[28:31], v[0:3], v[60:67], v74
  ds_read_b128 v[60:63], v76 offset:51200
  ds_read_b128 v[64:67], v76 offset:52224
  s_waitcnt lgkmcnt(0)
  v_smfmac_f32_16x16x64_bf16 v[32:35], v[0:3], v[60:67], v74
  ds_read_b128 v[8:11], v76 offset:9728
  s_waitcnt lgkmcnt(0)
  v_smfmac_f32_16x16x64_bf16 v[20:23], v[8:11], v[160:167], v74
  v_smfmac_f32_16x16x64_bf16 v[24:27], v[8:11], v[168:175], v74
  ds_read_b128 v[60:63], v75 offset:16384
  ds_read_b128 v[64:67], v75 offset:17408
  s_waitcnt lgkmcnt(0)
  v_smfmac_f32_16x16x64_bf16 v[28:31], v[8:11], v[60:67], v74
  ds_read_b128 v[60:63], v75 offset:18432
  ds_read_b128 v[64:67], v75 offset:19456
  s_waitcnt lgkmcnt(0)
  v_smfmac_f32_16x16x64_bf16 v[32:35], v[8:11], v[60:67], v74
  ds_read_b128 v[16:19], v76 offset:10752
  ds_read_b128 v[60:63], v75 offset:0
  ds_read_b128 v[64:67], v75 offset:1024
  s_waitcnt lgkmcnt(0)
  v_smfmac_f32_16x16x64_bf16 v[20:23], v[16:19], v[60:67], v74
  ds_read_b128 v[60:63], v75 offset:2048
  ds_read_b128 v[64:67], v75 offset:3072
  s_waitcnt lgkmcnt(0)
  v_smfmac_f32_16x16x64_bf16 v[24:27], v[16:19], v[60:67], v74
  v_smfmac_f32_16x16x64_bf16 v[28:31], v[16:19], v[240:247], v74
  v_smfmac_f32_16x16x64_bf16 v[32:35], v[16:19], v[248:255], v74
  ds_read_b128 v[4:7], v76 offset:11776
  s_waitcnt lgkmcnt(0)
  v_smfmac_f32_16x16x64_bf16 v[20:23], v[4:7], v[176:183], v74
  v_smfmac_f32_16x16x64_bf16 v[24:27], v[4:7], v[184:191], v74
  v_smfmac_f32_16x16x64_bf16 v[28:31], v[4:7], a[0:7], v74
  v_smfmac_f32_16x16x64_bf16 v[32:35], v[4:7], a[8:15], v74
  ds_read_b128 v[12:15], v76 offset:12800
  s_waitcnt lgkmcnt(0)
  v_smfmac_f32_16x16x64_bf16 v[20:23], v[12:15], v[192:199], v74
  v_smfmac_f32_16x16x64_bf16 v[24:27], v[12:15], v[200:207], v74
  v_smfmac_f32_16x16x64_bf16 v[28:31], v[12:15], a[16:23], v74
  v_smfmac_f32_16x16x64_bf16 v[32:35], v[12:15], a[24:31], v74
  v_add_f32 v20, v20, v22
  v_add_f32 v21, v21, v23
  v_add_f32 v24, v24, v26
  v_cvt_pk_bf16_f32 v22, v20, v24
  ds_write_b32 v79, v22 offset:0
  v_add_f32 v25, v25, v27
  v_cvt_pk_bf16_f32 v23, v21, v25
  ds_write_b32 v79, v23 offset:576
  v_add_f32 v28, v28, v30
  v_add_f32 v29, v29, v31
  s_waitcnt lgkmcnt(0)
  s_nop 1
  s_branch Cf0_recok
Cf0_mx:
  s_waitcnt lgkmcnt(0)
  s_barrier
  buffer_load_dwordx4 v[52:55], v76, s[8:11], s59 offen offset:0 sc1
  buffer_load_dwordx4 v[0:3], v76, s[8:11], s58 offen offset:0 sc1
  ds_read_b128 v[20:23], v77 offset:0
  ds_read_b128 v[28:31], v77 offset:256
  buffer_load_dwordx4 v[56:59], v76, s[8:11], s59 offen offset:1024 sc1
  buffer_load_dwordx4 v[4:7], v76, s[8:11], s58 offen offset:1024 sc1
  ds_read_b128 v[24:27], v77 offset:128
  ds_read_b128 v[32:35], v77 offset:384
  s_waitcnt vmcnt(2) lgkmcnt(3)
  v_mfma_f32_16x16x32_bf16 v[8:11], v[0:3], v[20:23], 0
  s_waitcnt vmcnt(0) lgkmcnt(1)
  v_mfma_f32_16x16x32_bf16 v[8:11], v[4:7], v[24:27], v[8:11]
  v_mfma_f32_16x16x32_bf16 v[12:15], v[28:31], v[20:23], 0
  s_waitcnt lgkmcnt(0)
  v_mfma_f32_16x16x32_bf16 v[12:15], v[32:35], v[24:27], v[12:15]
  v_add_f32_dpp v8, v10, v8 quad_perm:[2,3,0,1] row_mask:0xf bank_mask:0xf
  v_add_f32_dpp v9, v11, v9 quad_perm:[2,3,0,1] row_mask:0xf bank_mask:0xf
  s_nop 0
  v_mov_b32_dpp v8, v8 quad_perm:[0,1,0,1] row_mask:0xf bank_mask:0xf
  v_mov_b32_dpp v9, v9 quad_perm:[0,1,0,1] row_mask:0xf bank_mask:0xf
  s_nop 1
  v_add_f32_dpp v12, v14, v12 quad_perm:[2,3,0,1] row_mask:0xf bank_mask:0xf
  v_add_f32_dpp v13, v15, v13 quad_perm:[2,3,0,1] row_mask:0xf bank_mask:0xf
  s_nop 0
  v_mov_b32_dpp v12, v12 quad_perm:[0,1,0,1] row_mask:0xf bank_mask:0xf
  v_mov_b32_dpp v13, v13 quad_perm:[0,1,0,1] row_mask:0xf bank_mask:0xf
  v_mul_f32 v12, s69, v12
  ds_write_b32 v78, v8 offset:8704
  v_mul_f32 v13, s69, v13
  ds_write_b32 v78, v9 offset:8768
  s_waitcnt lgkmcnt(0)
  s_barrier
  ds_read_b128 v[36:39], v78 offset:8704
  ds_read_b128 v[40:43], v78 offset:8768
  s_waitcnt lgkmcnt(0)
  s_barrier
  v_max_f32 v16, v36, v37
  v_max3_f32 v16, v16, v38, v39
  v_max3_f32 v16, v16, v40, v41
  v_max3_f32 v16, v16, v42, v43
  v_max3_f32 v16, v16, v12, v13
  v_mov_b32 v17, v16
  s_nop 1
  v_permlane16_swap_b32 v16, v17
  v_max_f32 v16, v16, v17
  v_mov_b32 v17, v16
  s_nop 1
  v_permlane32_swap_b32 v16, v17
  v_max_f32 v16, v16, v17
  v_sub_f32 v36, v36, v16
  v_sub_f32 v37, v37, v16
  v_sub_f32 v38, v38, v16
  v_sub_f32 v39, v39, v16
  v_sub_f32 v40, v40, v16
  v_sub_f32 v41, v41, v16
  v_sub_f32 v42, v42, v16
  v_sub_f32 v43, v43, v16
  v_sub_f32 v12, v12, v16
  v_sub_f32 v13, v13, v16
  v_exp_f32 v36, v36
  v_exp_f32 v37, v37
  v_exp_f32 v38, v38
  v_exp_f32 v39, v39
  v_exp_f32 v40, v40
  v_exp_f32 v41, v41
  v_exp_f32 v42, v42
  v_exp_f32 v43, v43
  v_exp_f32 v12, v12
  v_exp_f32 v13, v13
  v_cvt_pk_bf16_f32 v32, v36, v40
  v_cvt_pk_bf16_f32 v33, v37, v41
  v_cvt_pk_bf16_f32 v34, v38, v42
  v_cvt_pk_bf16_f32 v35, v39, v43
  v_cvt_pk_bf16_f32 v28, v12, v13
  v_cvt_pk_bf16_f32 v31, v12, v13
  v_mov_b32 v29, 0
  v_mov_b32 v30, 0
  v_mfma_f32_16x16x32_bf16 v[8:11], v[32:35], v[68:71], 0
  v_mfma_f32_16x16x32_bf16 v[0:3], v[32:35], v[52:55], 0
  v_mfma_f32_16x16x32_bf16 v[4:7], v[32:35], v[56:59], 0
  v_mfma_f32_16x16x16_bf16 v[8:11], v[28:29], v[68:69], v[8:11]
  v_mfma_f32_16x16x16_bf16 v[0:3], v[28:29], v[72:73], v[0:3]
  v_mfma_f32_16x16x16_bf16 v[4:7], v[30:31], v[72:73], v[4:7]
  ds_read_b128 v[52:55], v75 offset:32768
  v_rcp_f32 v10, v8
  v_rcp_f32 v11, v9
  v_mul_f32 v0, v10, v0
  v_mul_f32 v1, v11, v1
  v_max3_f32 v8, v8, v9, v10
  v_mul_f32 v4, v10, v4
  v_mul_f32 v5, v11, v5
  v_cvt_pk_bf16_f32 v2, v0, v4
  ds_write_b32 v79, v2 offset:8704
  v_cvt_pk_bf16_f32 v3, v1, v5
  ds_write_b32 v79, v3 offset:9280
  ds_read_b128 v[12:15], v78 offset:8704
  ds_read_b128 v[56:59], v75 offset:33792
  v_mov_b64 v[16:17], 0
  v_mov_b64 v[18:19], 0
  v_mov_b64 v[20:21], 0
  v_mov_b64 v[22:23], 0
  v_mov_b64 v[24:25], 0
  v_mov_b64 v[26:27], 0
  s_branch Cf0_mxok
Cf0_kv3:
  s_waitcnt lgkmcnt(0)
  s_cmp_ge_u32 s57, 0x700
  s_cbranch_scc1 Cf0_kvb
  s_load_dword s57, s[12:13], s71 glc
  s_add_u32 s67, s67, 1
  s_cmp_lt_u32 s67, 131072
  s_cbranch_scc1 Cf0_kv3
  s_waitcnt lgkmcnt(0)
  s_branch Cf0_kvb
Cf0_last:
  ds_read_b128 v[4:7], v76 offset:5632
  ds_read_b128 v[12:15], v76 offset:7680
  ds_read_b128 v[44:47], v76 offset:32768
  ds_read_b128 v[48:51], v76 offset:33792
  s_nop 5
  v_mov_b64 v[20:21], 0
  v_mov_b64 v[22:23], 0
  v_mov_b64 v[24:25], 0
  v_mov_b64 v[26:27], 0
  v_smfmac_f32_16x16x64_bf16 v[28:31], v[0:3], v[36:43], v74
  ds_read_b128 v[36:39], v76 offset:34816
  ds_read_b128 v[40:43], v76 offset:35840
  v_smfmac_f32_16x16x64_bf16 v[32:35], v[0:3], v[60:67], v74
  s_waitcnt lgkmcnt(5)
  v_smfmac_f32_16x16x64_bf16 v[20:23], v[0:3], a[32:39], v74
  ds_read_b128 v[60:63], v76 offset:49152
  ds_read_b128 v[64:67], v76 offset:50176
  v_smfmac_f32_16x16x64_bf16 v[24:27], v[0:3], a[40:47], v74
  s_waitcnt lgkmcnt(4)
  v_smfmac_f32_16x16x64_bf16 v[20:23], v[4:7], a[48:55], v74
  buffer_store_dwordx4 v[16:19], v76, s[8:11], s68 offen sc1
  v_smfmac_f32_16x16x64_bf16 v[24:27], v[4:7], a[56:63], v74
  v_smfmac_f32_16x16x64_bf16 v[28:31], v[4:7], v[44:51], v74
  s_waitcnt lgkmcnt(2)
  v_smfmac_f32_16x16x64_bf16 v[20:23], v[8:11], a[64:71], v74
  ds_read_b128 v[44:47], v76 offset:51200
  ds_read_b128 v[48:51], v76 offset:52224
  v_smfmac_f32_16x16x64_bf16 v[24:27], v[8:11], a[72:79], v74
  v_smfmac_f32_16x16x64_bf16 v[32:35], v[4:7], v[36:43], v74
  v_smfmac_f32_16x16x64_bf16 v[28:31], v[8:11], v[208:215], v74
  ds_read_b128 v[36:39], v75 offset:16384
  ds_read_b128 v[40:43], v75 offset:17408
  v_smfmac_f32_16x16x64_bf16 v[32:35], v[8:11], v[216:223], v74
  v_smfmac_f32_16x16x64_bf16 v[20:23], v[12:15], a[80:87], v74
  v_smfmac_f32_16x16x64_bf16 v[24:27], v[12:15], a[88:95], v74
  v_smfmac_f32_16x16x64_bf16 v[28:31], v[12:15], v[224:231], v74
  v_smfmac_f32_16x16x64_bf16 v[32:35], v[12:15], v[232:239], v74
  s_waitcnt vmcnt(2)
  s_waitcnt vmcnt(1)
  s_barrier
Cf0_lastr:
  ds_read_b128 v[0:3], v76 offset:8704
  ds_read_b128 v[8:11], v76 offset:9728
  ds_read_b128 v[16:19], v76 offset:10752
  ds_read_b128 v[4:7], v76 offset:11776
  ds_read_b128 v[12:15], v76 offset:12800
  s_waitcnt lgkmcnt(4)
  v_max3_u32 v72, v0, v1, v2
  s_waitcnt lgkmcnt(1)
  v_max3_u32 v72, v72, v3, v4
  v_max3_u32 v72, v72, v5, v6
  v_max3_u32 v72, v72, v7, v8
  v_max3_u32 v72, v72, v9, v10
  s_waitcnt lgkmcnt(0)
  v_max3_u32 v72, v72, v11, v12
  v_max3_u32 v72, v72, v13, v14
  v_max3_u32 v72, v72, v15, v16
  v_max3_u32 v72, v72, v17, v18
  v_max_u32 v72, v72, v19
  v_cmp_eq_u32 vcc, -1, v72
  s_cbranch_vccnz Cf0_lastp
Cf0_lastg:
  v_smfmac_f32_16x16x64_bf16 v[28:31], v[0:3], v[60:67], v74
  ds_read_b128 v[60:63], v75 offset:18432
  ds_read_b128 v[64:67], v75 offset:19456
  v_smfmac_f32_16x16x64_bf16 v[32:35], v[0:3], v[44:51], v74
  v_smfmac_f32_16x16x64_bf16 v[28:31], v[8:11], v[36:43], v74
  v_smfmac_f32_16x16x64_bf16 v[28:31], v[16:19], v[240:247], v74
  v_smfmac_f32_16x16x64_bf16 v[28:31], v[4:7], a[0:7], v74
  v_smfmac_f32_16x16x64_bf16 v[28:31], v[12:15], a[16:23], v74
  v_smfmac_f32_16x16x64_bf16 v[32:35], v[16:19], v[248:255], v74
  v_smfmac_f32_16x16x64_bf16 v[32:35], v[4:7], a[8:15], v74
  s_waitcnt lgkmcnt(0)
  v_smfmac_f32_16x16x64_bf16 v[32:35], v[12:15], a[24:31], v74
  v_smfmac_f32_16x16x64_bf16 v[32:35], v[8:11], v[60:67], v74
  v_smfmac_f32_16x16x64_bf16 v[20:23], v[0:3], a[96:103], v74
  v_smfmac_f32_16x16x64_bf16 v[20:23], v[8:11], a[112:119], v74
  v_add_f32 v28, v28, v30
  v_add_f32 v32, v32, v34
  v_cvt_pk_bf16_f32 v30, v28, v32
  v_smfmac_f32_16x16x64_bf16 v[20:23], v[16:19], a[128:135], v74
  ds_write_b32 v79, v30 offset:256
  v_add_f32 v29, v29, v31
  v_add_f32 v33, v33, v35
  v_cvt_pk_bf16_f32 v31, v29, v33
  v_smfmac_f32_16x16x64_bf16 v[20:23], v[4:7], a[144:151], v74
  ds_write_b32 v79, v31 offset:832
  v_smfmac_f32_16x16x64_bf16 v[20:23], v[12:15], a[160:167], v74
  v_smfmac_f32_16x16x64_bf16 v[24:27], v[0:3], a[104:111], v74
  v_smfmac_f32_16x16x64_bf16 v[24:27], v[8:11], a[120:127], v74
  v_smfmac_f32_16x16x64_bf16 v[24:27], v[16:19], a[136:143], v74
  s_waitcnt lgkmcnt(0)
  s_barrier
  ds_read_b64 v[52:53], v77 offset:256
  v_add_f32 v20, v20, v22
  v_smfmac_f32_16x16x64_bf16 v[24:27], v[4:7], a[152:159], v74
  v_add_f32 v21, v21, v23
  v_smfmac_f32_16x16x64_bf16 v[24:27], v[12:15], a[168:175], v74
  v_cvt_pk_bf16_f32 v54, v20, v21
  s_add_u32 s68, s68, 655360
  s_nop 3
  v_add_f32 v24, v24, v26
  v_add_f32 v25, v25, v27
  v_cvt_pk_bf16_f32 v55, v24, v25
  s_waitcnt lgkmcnt(0)
  buffer_store_dwordx4 v[52:55], v76, s[8:11], s68 offen sc1
  s_branch Cf0_done
Cf0_lastp:
  s_add_u32 s72, s72, 2
  s_cmp_ge_u32 s72, 131072
  s_cbranch_scc1 Cf0_lastg
  s_barrier
  buffer_load_dwordx4 v76, s[8:11], s85 offen offset:0 sc1 lds
  s_waitcnt vmcnt(0)
  s_barrier
  s_branch Cf0_lastr
Cf0_done:
  s_branch L_cexit
L_w1:
  v_mov_b64 v[20:21], 0
  v_mov_b64 v[22:23], 0
  v_mov_b64 v[24:25], 0
  v_mov_b64 v[26:27], 0
  v_mov_b64 v[28:29], 0
  v_mov_b64 v[30:31], 0
  v_mov_b64 v[32:33], 0
  v_mov_b64 v[34:35], 0
  s_mov_b32 s78, 0x3f803f80
  s_mov_b32 s79, s78
  s_mov_b32 s65, 360448
  s_mov_b32 m0, 15872
  s_lshl_b32 s71, s53, 2
  s_add_u32 s71, s71, 128
  s_movk_i32 s56, 0x1000
  v_lshlrev_b32 v73, 2, v76
  v_mov_b32 v72, 0
  s_mov_b64 s[16:17], s[8:9]
  s_mov_b32 s18, 268435456
  s_mov_b32 s19, 0x20000
  s_getpc_b64 s[20:21]
Cf1_pc:
  s_add_u32 s20, s20, (Cf1_last - Cf1_pc)
  s_addc_u32 s21, s21, 0
  v_mov_b32 v68, 14880
  buffer_load_dwordx4 v[52:55], v76, s[8:11], s59 offen offset:0 sc1
  buffer_load_dwordx4 v[56:59], v76, s[8:11], s59 offen offset:1024 sc1
  ds_read_b128 v[36:39], v76 offset:20480
  ds_read_b128 v[40:43], v76 offset:21504
  ds_read_b128 v[60:63], v76 offset:22528
  ds_read_b128 v[64:67], v76 offset:23552
  ds_read_b128 v[0:3], v76 offset:4608
  ds_read_b128 v[4:7], v76 offset:5632
  ds_read_b128 v[8:11], v76 offset:6656
  ds_read_b128 v[12:15], v76 offset:7680
  s_waitcnt lgkmcnt(0)
  s_cmp_eq_u32 s66, 1
  s_branch Cf1_top2
.p2align 6
Cf1_h2:
  ds_read_b128 v[36:39], v76 offset:20480
  s_waitcnt lgkmcnt(0)
  buffer_load_dwordx4 v[8:11], v76, s[8:11], s65 offen offset:2048 sc1
  ds_read_b128 v[40:43], v76 offset:21504
  s_waitcnt lgkmcnt(0)
  v_lshlrev_b32 v73, 2, v76
  buffer_load_dwordx4 v[8:11], v76, s[8:11], s65 offen offset:2048 sc1
  ds_read_b128 v[60:63], v76 offset:22528
  s_waitcnt lgkmcnt(0)
  s_cmp_eq_u32 s66, 62
  s_cselect_b64 s[16:17], s[20:21], s[16:17]
  s_cselect_b32 s18, (Cf1_done - Cf1_last), s18
  s_cselect_b32 s70, 0, s70
  s_cmp_eq_u32 s66, 63
  s_cselect_b32 s59, 268435456, s59
  s_cselect_b32 s58, 268435456, s58
  buffer_load_dwordx4 v[8:11], v76, s[8:11], s65 offen offset:2048 sc1
  buffer_load_dwordx4 v[52:55], v76, s[8:11], s59 offen offset:0 sc1
  buffer_load_dwordx4 v[56:59], v76, s[8:11], s59 offen offset:1024 sc1
  s_waitcnt vmcnt(4)
  v_max3_u32 v72, v8, v9, v10
  v_max_u32 v72, v72, v11
  ds_write_b128 v76, v[8:11] offset:6656
  v_cmp_eq_u32 vcc, -1, v72
  s_cbranch_vccnz Cf1_h2r
Cf1_h2w:
  s_cmp_eq_u32 s66, 63
  s_waitcnt lgkmcnt(0)
  s_barrier
  ds_read_b128 v[0:3], v76 offset:4608
  buffer_load_dwordx4 v76, s[8:11], s85 offen offset:0 sc1 lds
Cf1_top2:
  v_smfmac_f32_16x16x64_bf16 v[20:23], v[8:11], v[112:119], v74
  s_cbranch_scc1 Cf1_last
  v_smfmac_f32_16x16x64_bf16 v[24:27], v[8:11], v[120:127], v74
  buffer_load_dwordx4 v[44:47], v76, s[8:11], s58 offen offset:0 sc1
  s_mov_b32 m0, 15872
  v_smfmac_f32_16x16x64_bf16 v[28:31], v[8:11], v[208:215], v74
  buffer_load_dwordx4 v[48:51], v76, s[8:11], s58 offen offset:1024 sc1
  v_smfmac_f32_16x16x64_bf16 v[32:35], v[8:11], v[216:223], v74
  ds_read_b128 v[4:7], v76 offset:5632
  s_waitcnt lgkmcnt(1)
  v_smfmac_f32_16x16x64_bf16 v[20:23], v[0:3], v[80:87], v74
  ds_read_b128 v[12:15], v76 offset:7680
  v_smfmac_f32_16x16x64_bf16 v[28:31], v[0:3], v[36:43], v74
  ds_read_b128 v[36:39], v76 offset:36864
  v_smfmac_f32_16x16x64_bf16 v[24:27], v[0:3], v[88:95], v74
  buffer_store_dwordx4 v[16:19], v76, s[8:11], s68 offen sc1
  ds_read_b128 v[40:43], v76 offset:37888
  v_smfmac_f32_16x16x64_bf16 v[32:35], v[0:3], v[60:67], v74
  buffer_load_dword v73, s[16:19], s70 offen lds
  ds_read_b128 v[60:63], v76 offset:38912
  s_waitcnt lgkmcnt(4)
  v_smfmac_f32_16x16x64_bf16 v[20:23], v[4:7], v[96:103], v74
  ds_read_b128 v[64:67], v76 offset:39936
  v_smfmac_f32_16x16x64_bf16 v[24:27], v[4:7], v[104:111], v74
  s_waitcnt vmcnt(5)
  s_waitcnt lgkmcnt(4)
  v_smfmac_f32_16x16x64_bf16 v[20:23], v[12:15], v[128:135], v74
  s_barrier
  ds_read_b128 v[8:11], v76 offset:8704
  s_waitcnt lgkmcnt(3)
  v_smfmac_f32_16x16x64_bf16 v[28:31], v[4:7], v[36:43], v74
  ds_read_b128 v[36:39], v76 offset:53248
  v_smfmac_f32_16x16x64_bf16 v[24:27], v[12:15], v[136:143], v74
  ds_read_b128 v[40:43], v76 offset:54272
  s_waitcnt lgkmcnt(3)
  v_smfmac_f32_16x16x64_bf16 v[32:35], v[4:7], v[60:67], v74
  ds_read_b128 v[0:3], v76 offset:9728
  v_smfmac_f32_16x16x64_bf16 v[28:31], v[12:15], v[224:231], v74
  ds_read_b128 v[60:63], v76 offset:55296
  v_smfmac_f32_16x16x64_bf16 v[32:35], v[12:15], v[232:239], v74
  s_waitcnt vmcnt(4)
  ds_read_b128 v[64:67], v76 offset:56320
  s_waitcnt lgkmcnt(5)
  v_smfmac_f32_16x16x64_bf16 v[20:23], v[8:11], v[144:151], v74
  s_barrier
  ds_read_b128 v[4:7], v76 offset:11776
  s_waitcnt lgkmcnt(4)
  v_smfmac_f32_16x16x64_bf16 v[28:31], v[8:11], v[36:43], v74
  ds_read_b128 v[12:15], v76 offset:12800
  ds_read_b128 v[36:39], v75 offset:4096
  v_smfmac_f32_16x16x64_bf16 v[24:27], v[8:11], v[152:159], v74
  ds_read_b128 v[16:19], v76 offset:10752
  s_waitcnt lgkmcnt(6)
  v_smfmac_f32_16x16x64_bf16 v[20:23], v[0:3], v[160:167], v74
  ds_read_b128 v[40:43], v75 offset:5120
  s_waitcnt lgkmcnt(5)
  v_smfmac_f32_16x16x64_bf16 v[32:35], v[8:11], v[60:67], v74
  ds_read_b128 v[60:63], v75 offset:6144
  v_smfmac_f32_16x16x64_bf16 v[24:27], v[0:3], v[168:175], v74
  ds_read_b128 v[64:67], v75 offset:7168
  s_waitcnt lgkmcnt(6)
  v_smfmac_f32_16x16x64_bf16 v[20:23], v[4:7], v[176:183], v74
  s_waitcnt lgkmcnt(5)
  v_smfmac_f32_16x16x64_bf16 v[20:23], v[12:15], v[192:199], v74
  s_waitcnt lgkmcnt(2)
  v_smfmac_f32_16x16x64_bf16 v[20:23], v[16:19], v[36:43], v74
  ds_read_b128 v[36:39], v75 offset:20480
  v_smfmac_f32_16x16x64_bf16 v[24:27], v[4:7], v[184:191], v74
  ds_read_b128 v[40:43], v75 offset:21504
  s_waitcnt lgkmcnt(2)
  v_smfmac_f32_16x16x64_bf16 v[24:27], v[16:19], v[60:67], v74
  ds_read_b128 v[60:63], v75 offset:22528
  v_add_f32 v20, v20, v22
  v_smfmac_f32_16x16x64_bf16 v[24:27], v[12:15], v[200:207], v74
  ds_read_b128 v[64:67], v75 offset:23552
  v_add_f32 v21, v21, v23
  v_smfmac_f32_16x16x64_bf16 v[28:31], v[16:19], v[240:247], v74
  v_mov_b64 v[70:71], s[78:79]
  v_smfmac_f32_16x16x64_bf16 v[28:31], v[4:7], a[0:7], v74
  s_waitcnt lgkmcnt(2)
  v_add_f32 v24, v24, v26
  v_smfmac_f32_16x16x64_bf16 v[28:31], v[0:3], v[36:43], v74
  ds_read_b128 v[36:39], v68
  v_cvt_pk_bf16_f32 v22, v20, v24
  v_smfmac_f32_16x16x64_bf16 v[28:31], v[12:15], a[16:23], v74
  ds_read_b128 v[40:43], v68
  ds_write_b32 v79, v22 offset:0
  s_waitcnt lgkmcnt(3)
  v_add_f32 v25, v25, v27
  v_cvt_pk_bf16_f32 v23, v21, v25
  v_smfmac_f32_16x16x64_bf16 v[32:35], v[0:3], v[60:67], v74
  ds_write_b32 v79, v23 offset:576
  v_cmp_u_f32 vcc, v20, v21
  v_smfmac_f32_16x16x64_bf16 v[32:35], v[16:19], v[248:255], v74
  v_add_f32 v28, v28, v30
  v_smfmac_f32_16x16x64_bf16 v[32:35], v[4:7], a[8:15], v74
  v_add_f32 v29, v29, v31
  v_smfmac_f32_16x16x64_bf16 v[32:35], v[12:15], a[24:31], v74
  s_cbranch_vccnz Cf1_rec
Cf1_recok:
  s_waitcnt lgkmcnt(3)
  v_smfmac_f32_16x16x64_bf16 v[36:39], v[16:19], a[128:135], v74
  s_waitcnt lgkmcnt(0)
  s_barrier
  ds_read_b128 v[60:63], v77
  v_smfmac_f32_16x16x64_bf16 v[40:43], v[16:19], a[136:143], v74
  ds_read_b128 v[64:67], v77 offset:128
  v_add_f32 v32, v32, v34
  v_cvt_pk_bf16_f32 v30, v28, v32
  v_smfmac_f32_16x16x64_bf16 v[36:39], v[0:3], a[112:119], v74
  ds_write_b32 v79, v30 offset:256
  v_add_f32 v33, v33, v35
  v_cvt_pk_bf16_f32 v31, v29, v33
  v_smfmac_f32_16x16x64_bf16 v[40:43], v[0:3], a[120:127], v74
  ds_write_b32 v79, v31 offset:832
  v_xor_b32 v75, 0x8000, v75
  v_smfmac_f32_16x16x64_bf16 v[36:39], v[4:7], a[144:151], v74
  ds_read_b128 v[0:3], v76 offset:4608
  v_mov_b32 v29, 0
  v_smfmac_f32_16x16x64_bf16 v[40:43], v[4:7], a[152:159], v74
  s_waitcnt vmcnt(2) lgkmcnt(3)
  v_mov_b32 v30, 0
  v_mfma_f32_16x16x32_bf16 v[44:47], v[44:47], v[60:63], 0
  ds_read_b128 v[4:7], v76 offset:5632
  s_waitcnt lgkmcnt(2)
  v_mfma_f32_16x16x32_bf16 v[44:47], v[48:51], v[64:67], v[44:47]
  s_barrier
  v_smfmac_f32_16x16x64_bf16 v[36:39], v[8:11], a[96:103], v74
  ds_read_b128 v[20:23], v77 offset:256
  ds_read_b128 v[24:27], v77 offset:384
  v_smfmac_f32_16x16x64_bf16 v[40:43], v[8:11], a[104:111], v74
  ds_read_b128 v[8:11], v76 offset:6656
  v_add_f32_dpp v72, v46, v44 quad_perm:[2,3,0,1] row_mask:0xf bank_mask:0xf
  v_add_f32_dpp v73, v47, v45 quad_perm:[2,3,0,1] row_mask:0xf bank_mask:0xf
  v_smfmac_f32_16x16x64_bf16 v[36:39], v[12:15], a[160:167], v74
  s_waitcnt lgkmcnt(4)
  v_exp_f32_dpp v72, v72 quad_perm:[0,1,0,1] row_mask:0xf bank_mask:0xf
  v_smfmac_f32_16x16x64_bf16 v[40:43], v[12:15], a[168:175], v74
  ds_read_b128 v[12:15], v76 offset:7680
  v_exp_f32_dpp v73, v73 quad_perm:[0,1,0,1] row_mask:0xf bank_mask:0xf
  v_smfmac_f32_16x16x64_bf16 v[36:39], v[0:3], a[32:39], v74
  s_waitcnt lgkmcnt(2)
  v_cvt_pk_bf16_f32 v72, v72, v73
  v_mfma_f32_16x16x32_bf16 v[20:23], v[20:23], v[60:63], 0
  ds_write_b32 v78, v72 offset:516
  v_mov_b64 v[16:17], 0
  v_mfma_f32_16x16x32_bf16 v[20:23], v[24:27], v[64:67], v[20:23]
  ds_read_b128 v[44:47], v75 offset:22528
  v_mov_b64 v[18:19], 0
  v_smfmac_f32_16x16x64_bf16 v[40:43], v[0:3], a[40:47], v74
  ds_read_b128 v[48:51], v75 offset:23552
  v_mov_b64 v[68:69], s[78:79]
  v_smfmac_f32_16x16x64_bf16 v[36:39], v[4:7], a[48:55], v74
  s_waitcnt lgkmcnt(4)
  v_add_f32_dpp v24, v22, v20 quad_perm:[2,3,0,1] row_mask:0xf bank_mask:0xf
  v_add_f32_dpp v25, v23, v21 quad_perm:[2,3,0,1] row_mask:0xf bank_mask:0xf
  v_smfmac_f32_16x16x64_bf16 v[36:39], v[8:11], a[64:71], v74
  s_waitcnt lgkmcnt(2)
  s_barrier
  ds_read_b128 v[32:35], v78 offset:512
  v_smfmac_f32_16x16x64_bf16 v[36:39], v[12:15], a[80:87], v74
  ds_read_b128 v[60:63], v75 offset:20480
  v_mul_f32 v24, s69, v24
  v_smfmac_f32_16x16x64_bf16 v[40:43], v[4:7], a[56:63], v74
  ds_read_b128 v[64:67], v75 offset:21504
  v_mul_f32 v25, s69, v25
  v_smfmac_f32_16x16x64_bf16 v[40:43], v[8:11], a[72:79], v74
  v_exp_f32_dpp v24, v24 quad_perm:[0,1,0,1] row_mask:0xf bank_mask:0xf
  v_smfmac_f32_16x16x64_bf16 v[40:43], v[12:15], a[88:95], v74
  s_waitcnt lgkmcnt(2)
  v_exp_f32_dpp v25, v25 quad_perm:[0,1,0,1] row_mask:0xf bank_mask:0xf
  v_mfma_f32_16x16x32_bf16 v[8:11], v[32:35], v[68:71], 0
  v_add_f32 v36, v36, v38
  v_add_f32 v37, v37, v39
  v_mfma_f32_16x16x32_bf16 v[0:3], v[32:35], v[52:55], 0
  v_add_f32 v40, v40, v42
  v_add_f32 v41, v41, v43
  v_mfma_f32_16x16x32_bf16 v[4:7], v[32:35], v[56:59], 0
  v_cvt_pk_bf16_f32 v28, v24, v25
  v_cvt_pk_bf16_f32 v72, v36, v37
  v_cvt_pk_bf16_f32 v73, v40, v41
  v_mfma_f32_16x16x16_bf16 v[8:11], v[28:29], v[68:69], v[8:11]
  v_cvt_pk_bf16_f32 v31, v24, v25
  v_mov_b64 v[20:21], 0
  v_mfma_f32_16x16x16_bf16 v[0:3], v[28:29], v[72:73], v[0:3]
  ds_read_b128 v[52:55], v75 offset:36864
  v_mov_b64 v[22:23], 0
  v_mfma_f32_16x16x16_bf16 v[4:7], v[30:31], v[72:73], v[4:7]
  v_rcp_f32 v10, v8
  v_rcp_f32 v11, v9
  v_mul_f32 v0, v10, v0
  v_mul_f32 v1, v11, v1
  v_max3_f32 v8, v8, v9, v10
  v_mul_f32 v4, v10, v4
  v_mul_f32 v5, v11, v5
  v_cvt_pk_bf16_f32 v2, v0, v4
  ds_write_b32 v79, v2 offset:8704
  v_cvt_pk_bf16_f32 v3, v1, v5
  ds_write_b32 v79, v3 offset:9280
  ds_read_b128 v[12:15], v78 offset:8768
  v_max_f32 v8, v8, v11
  v_cmp_le_f32 vcc, 1317011456, v8
  v_mov_b64 v[24:25], 0
  v_mov_b64 v[26:27], 0
  ds_read_b128 v[56:59], v75 offset:37888
  s_cbranch_vccnz Cf1_mx
Cf1_mxok:
  s_waitcnt lgkmcnt(2)
  s_barrier
  ds_read_b128 v[0:3], v78 offset:8704
  s_waitcnt lgkmcnt(2)
  v_smfmac_f32_16x16x64_bf16 v[16:19], v[12:15], v[44:51], v74
  ds_read_b128 v[4:7], v78 offset:8832
  v_smfmac_f32_16x16x64_bf16 v[20:23], v[12:15], a[200:207], v74
  ds_read_b128 v[8:11], v78 offset:8896
  v_smfmac_f32_16x16x64_bf16 v[24:27], v[12:15], a[216:223], v74
  ds_read_b128 v[36:39], v75 offset:38912
  s_waitcnt lgkmcnt(3)
  v_smfmac_f32_16x16x64_bf16 v[16:19], v[0:3], v[60:67], v74
  ds_read_b128 v[40:43], v75 offset:39936
  s_waitcnt lgkmcnt(3)
  v_smfmac_f32_16x16x64_bf16 v[16:19], v[4:7], a[176:183], v74
  ds_read_b128 v[68:71], v76 offset:13824
  s_waitcnt lgkmcnt(3)
  v_smfmac_f32_16x16x64_bf16 v[16:19], v[8:11], a[184:191], v74
  ds_read_b128 v[44:47], v75 offset:53248
  v_smfmac_f32_16x16x64_bf16 v[20:23], v[0:3], a[192:199], v74
  ds_read_b128 v[48:51], v75 offset:54272
  v_smfmac_f32_16x16x64_bf16 v[20:23], v[4:7], v[52:59], v74
  ds_read_b128 v[60:63], v75 offset:55296
  s_waitcnt lgkmcnt(4)
  v_cvt_pk_bf16_f32 v16, v16, v17
  v_cvt_pk_bf16_f32 v17, v18, v19
  v_bfi_b32 v16, 1, s72, v16
  v_smfmac_f32_16x16x64_bf16 v[20:23], v[8:11], v[36:43], v74
  s_waitcnt lgkmcnt(3)
  buffer_store_dwordx2 v[16:17], v68, s[8:11], s73 offen
  v_mov_b64 v[32:33], 0
  v_smfmac_f32_16x16x64_bf16 v[24:27], v[0:3], a[208:215], v74
  ds_read_b128 v[64:67], v75 offset:56320
  v_mov_b64 v[34:35], 0
  v_smfmac_f32_16x16x64_bf16 v[24:27], v[4:7], a[224:231], v74
  v_cvt_pk_bf16_f32 v20, v20, v21
  v_cvt_pk_bf16_f32 v21, v22, v23
  v_bfi_b32 v20, 1, s72, v20
  v_smfmac_f32_16x16x64_bf16 v[24:27], v[8:11], a[232:239], v74
  buffer_store_dwordx2 v[20:21], v68, s[8:11], s74 offen
  s_waitcnt lgkmcnt(2)
  v_smfmac_f32_16x16x64_bf16 v[32:35], v[0:3], v[44:51], v74
  s_waitcnt lgkmcnt(0)
  v_smfmac_f32_16x16x64_bf16 v[32:35], v[12:15], v[60:67], v74
  v_cvt_pk_bf16_f32 v24, v24, v25
  v_cvt_pk_bf16_f32 v25, v26, v27
  v_bfi_b32 v24, 1, s72, v24
  v_smfmac_f32_16x16x64_bf16 v[32:35], v[4:7], a[240:247], v74
  buffer_store_dwordx2 v[24:25], v68, s[8:11], s75 offen
  v_smfmac_f32_16x16x64_bf16 v[32:35], v[8:11], a[248:255], v74
  v_mov_b64 v[18:19], v[72:73]
  s_nop 4
  v_cvt_pk_bf16_f32 v32, v32, v33
  v_cvt_pk_bf16_f32 v33, v34, v35
  v_bfi_b32 v32, 1, s72, v32
  buffer_store_dwordx2 v[32:33], v68, s[8:11], s76 offen
  ds_read_b128 v[0:3], v76 offset:14848
  s_waitcnt lgkmcnt(0)
  ds_read_b64 v[16:17], v77 offset:264
  s_waitcnt lgkmcnt(0)
  ds_read_b128 v[64:67], v76 offset:23552
  s_waitcnt lgkmcnt(0)
  s_add_u32 s66, s66, 1
  s_xor_b32 s64, s64, 16384
  s_xor_b32 s65, s65, 16384
  s_add_u32 s58, s58, 655360
  s_add_u32 s59, s59, 655360
  s_add_u32 s70, s70, 655360
  s_add_u32 s68, s68, 655360
  s_mov_b32 m0, 11776
  s_add_u32 s85, s65, 7168
  v_xor_b32 v75, 0x8000, v75
  v_mov_b64 v[28:29], 0
  v_mov_b64 v[30:31], 0
  v_mov_b64 v[32:33], 0
  v_mov_b64 v[34:35], 0
  v_mov_b64 v[20:21], 0
  v_mov_b64 v[22:23], 0
  v_mov_b64 v[24:25], 0
  v_mov_b64 v[26:27], 0
  v_mov_b32 v68, 14880
  buffer_load_dwordx4 v[52:55], v76, s[8:11], s60 offen offset:0 sc1
  buffer_load_dwordx4 v[56:59], v76, s[8:11], s60 offen offset:1024 sc1
  s_waitcnt lgkmcnt(0)
  s_waitcnt vmcnt(1)
  v_mfma_f32_16x16x32_bf16 v[4:7], v[0:3], v[52:55], 0
  v_bitop3_b32 v72, v52, v54, s72 bitop3:0x7e
  s_waitcnt vmcnt(0)
  v_mfma_f32_16x16x32_bf16 v[4:7], v[0:3], v[56:59], v[4:7]
  v_bitop3_b32 v73, v56, v58, s72 bitop3:0x7e
  v_bitop3_b32 v72, v72, v73, 1 bitop3:0xa8
  v_cmp_ne_u32 vcc, 0, v72
  s_nop 3
  v_add_f32_dpp v4, v4, v4 row_ror:4 row_mask:0xf bank_mask:0xf
  v_add_f32_dpp v5, v5, v5 row_ror:4 row_mask:0xf bank_mask:0xf
  s_cmp_eq_u64 vcc, 0
  v_add_f32_dpp v4, v4, v4 row_ror:8 row_mask:0xf bank_mask:0xf
  v_add_f32_dpp v5, v5, v5 row_ror:8 row_mask:0xf bank_mask:0xf
  s_cselect_b32 s54, s62, 268435456
  v_cvt_pk_bf16_f32 v4, v4, v5
  buffer_store_dword v4, v69, s[8:11], s54 offen
  s_cbranch_vccnz Cf1_h1r
  s_xor_b32 s62, s62, 16384
  buffer_store_dword v71, v69, s[8:11], s62 offen
  s_xor_b32 s72, s72, 1
  s_branch Cf1_h2
Cf1_h1r:
  s_mov_b64 exec, vcc
  buffer_load_dwordx4 v[52:55], v76, s[8:11], s60 offen offset:0 sc1
  buffer_load_dwordx4 v[56:59], v76, s[8:11], s60 offen offset:1024 sc1
  s_mov_b64 exec, -1
  s_add_u32 s67, s67, 1
  s_waitcnt vmcnt(1)
  v_mfma_f32_16x16x32_bf16 v[4:7], v[0:3], v[52:55], 0
  v_bitop3_b32 v72, v52, v54, s72 bitop3:0x7e
  s_waitcnt vmcnt(0)
  v_mfma_f32_16x16x32_bf16 v[4:7], v[0:3], v[56:59], v[4:7]
  v_bitop3_b32 v73, v56, v58, s72 bitop3:0x7e
  v_bitop3_b32 v72, v72, v73, 1 bitop3:0xa8
  v_cmp_ne_u32 vcc, 0, v72
  s_cbranch_vccz Cf1_h1p
Cf1_h1s:
  s_mov_b64 exec, vcc
  buffer_load_dwordx4 v[52:55], v76, s[8:11], s60 offen offset:0 sc1
  buffer_load_dwordx4 v[56:59], v76, s[8:11], s60 offen offset:1024 sc1
  s_mov_b64 exec, -1
  s_add_u32 s67, s67, 1
  s_waitcnt vmcnt(1)
  v_mfma_f32_16x16x32_bf16 v[4:7], v[0:3], v[52:55], 0
  v_bitop3_b32 v72, v52, v54, s72 bitop3:0x7e
  s_waitcnt vmcnt(0)
  v_mfma_f32_16x16x32_bf16 v[4:7], v[0:3], v[56:59], v[4:7]
  v_bitop3_b32 v73, v56, v58, s72 bitop3:0x7e
  v_bitop3_b32 v72, v72, v73, 1 bitop3:0xa8
  v_cmp_ne_u32 vcc, 0, v72
  s_cbranch_vccz Cf1_h1p
  s_cmp_lt_u32 s67, 131072
  s_cbranch_scc1 Cf1_h1s
Cf1_h1p:
  s_nop 2
  v_add_f32_dpp v4, v4, v4 row_ror:4 row_mask:0xf bank_mask:0xf
  v_add_f32_dpp v5, v5, v5 row_ror:4 row_mask:0xf bank_mask:0xf
  s_nop 0
  v_add_f32_dpp v4, v4, v4 row_ror:8 row_mask:0xf bank_mask:0xf
  v_add_f32_dpp v5, v5, v5 row_ror:8 row_mask:0xf bank_mask:0xf
  v_cvt_pk_bf16_f32 v4, v4, v5
  buffer_store_dword v4, v69, s[8:11], s62 offen
  s_xor_b32 s62, s62, 16384
  buffer_store_dword v71, v69, s[8:11], s62 offen
  s_xor_b32 s72, s72, 1
  s_branch Cf1_h2
Cf1_h2r:
  s_mov_b64 exec, vcc
  buffer_load_dwordx4 v[8:11], v76, s[8:11], s65 offen offset:2048 sc1
  s_mov_b64 exec, -1
  s_add_u32 s67, s67, 1
  s_waitcnt vmcnt(4)
  v_max3_u32 v72, v8, v9, v10
  v_max_u32 v72, v72, v11
  ds_write_b128 v76, v[8:11] offset:6656
  v_cmp_eq_u32 vcc, -1, v72
  s_cbranch_vccz Cf1_h2w
  s_mov_b64 exec, vcc
  buffer_load_dwordx4 v[8:11], v76, s[8:11], s65 offen offset:2048 sc1
  s_mov_b64 exec, -1
  s_add_u32 s67, s67, 1
  s_waitcnt vmcnt(4)
  v_max3_u32 v72, v8, v9, v10
  v_max_u32 v72, v72, v11
  ds_write_b128 v76, v[8:11] offset:6656
  v_cmp_eq_u32 vcc, -1, v72
  s_cbranch_vccz Cf1_h2w
Cf1_h2s:
  s_mov_b64 exec, vcc
  buffer_load_dwordx4 v[8:11], v76, s[8:11], s65 offen offset:2048 sc1
  s_mov_b64 exec, -1
  s_add_u32 s67, s67, 1
  s_waitcnt vmcnt(2)
  v_max3_u32 v72, v8, v9, v10
  v_max_u32 v72, v72, v11
  ds_write_b128 v76, v[8:11] offset:6656
  v_cmp_eq_u32 vcc, -1, v72
  s_cbranch_vccz Cf1_h2w
  s_mov_b64 exec, vcc
  buffer_load_dwordx4 v[8:11], v76, s[8:11], s65 offen offset:2048 sc1
  s_mov_b64 exec, -1
  s_add_u32 s67, s67, 1
  s_waitcnt vmcnt(2)
  v_max3_u32 v72, v8, v9, v10
  v_max_u32 v72, v72, v11
  ds_write_b128 v76, v[8:11] offset:6656
  v_cmp_eq_u32 vcc, -1, v72
  s_cbranch_vccz Cf1_h2w
  s_mov_b64 exec, vcc
  buffer_load_dwordx4 v[8:11], v76, s[8:11], s65 offen offset:2048 sc1
  s_mov_b64 exec, -1
  s_add_u32 s67, s67, 1
  s_waitcnt vmcnt(2)
  v_max3_u32 v72, v8, v9, v10
  v_max_u32 v72, v72, v11
  ds_write_b128 v76, v[8:11] offset:6656
  v_cmp_eq_u32 vcc, -1, v72
  s_cbranch_vccz Cf1_h2w
  s_cmp_lt_u32 s67, 131072
  s_cbranch_scc1 Cf1_h2s
  s_branch Cf1_h2w
Cf1_rec:
  s_nop 7
  s_waitcnt vmcnt(0) lgkmcnt(0)
  v_max3_u32 v72, v0, v1, v2
  v_max3_u32 v72, v72, v3, v4
  v_max3_u32 v72, v72, v5, v6
  v_max3_u32 v72, v72, v7, v8
  v_max3_u32 v72, v72, v9, v10
  v_max3_u32 v72, v72, v11, v12
  v_max3_u32 v72, v72, v13, v14
  v_max3_u32 v72, v72, v15, v16
  v_max3_u32 v72, v72, v17, v18
  v_max_u32 v72, v72, v19
  v_cmp_eq_u32 vcc, -1, v72
  s_cbranch_vccz Cf1_recok
  s_barrier
  v_mov_b64 v[20:21], 0
  v_mov_b64 v[22:23], 0
  v_mov_b64 v[24:25], 0
  v_mov_b64 v[26:27], 0
  v_mov_b64 v[28:29], 0
  v_mov_b64 v[30:31], 0
  v_mov_b64 v[32:33], 0
  v_mov_b64 v[34:35], 0
  s_waitcnt lgkmcnt(0)
  s_barrier
  ds_read_b128 v[0:3], v76 offset:4608
  s_waitcnt lgkmcnt(0)
  v_smfmac_f32_16x16x64_bf16 v[20:23], v[0:3], v[80:87], v74
  v_smfmac_f32_16x16x64_bf16 v[24:27], v[0:3], v[88:95], v74
  ds_read_b128 v[60:63], v76 offset:20480
  ds_read_b128 v[64:67], v76 offset:21504
  s_waitcnt lgkmcnt(0)
  v_smfmac_f32_16x16x64_bf16 v[28:31], v[0:3], v[60:67], v74
  ds_read_b128 v[60:63], v76 offset:22528
  ds_read_b128 v[64:67], v76 offset:23552
  s_waitcnt lgkmcnt(0)
  v_smfmac_f32_16x16x64_bf16 v[32:35], v[0:3], v[60:67], v74
  ds_read_b128 v[4:7], v76 offset:5632
  s_waitcnt lgkmcnt(0)
  v_smfmac_f32_16x16x64_bf16 v[20:23], v[4:7], v[96:103], v74
  v_smfmac_f32_16x16x64_bf16 v[24:27], v[4:7], v[104:111], v74
  ds_read_b128 v[60:63], v76 offset:36864
  ds_read_b128 v[64:67], v76 offset:37888
  s_waitcnt lgkmcnt(0)
  v_smfmac_f32_16x16x64_bf16 v[28:31], v[4:7], v[60:67], v74
  ds_read_b128 v[60:63], v76 offset:38912
  ds_read_b128 v[64:67], v76 offset:39936
  s_waitcnt lgkmcnt(0)
  v_smfmac_f32_16x16x64_bf16 v[32:35], v[4:7], v[60:67], v74
  ds_read_b128 v[8:11], v76 offset:6656
  s_waitcnt lgkmcnt(0)
  v_smfmac_f32_16x16x64_bf16 v[20:23], v[8:11], v[112:119], v74
  v_smfmac_f32_16x16x64_bf16 v[24:27], v[8:11], v[120:127], v74
  v_smfmac_f32_16x16x64_bf16 v[28:31], v[8:11], v[208:215], v74
  v_smfmac_f32_16x16x64_bf16 v[32:35], v[8:11], v[216:223], v74
  ds_read_b128 v[12:15], v76 offset:7680
  s_waitcnt lgkmcnt(0)
  v_smfmac_f32_16x16x64_bf16 v[20:23], v[12:15], v[128:135], v74
  v_smfmac_f32_16x16x64_bf16 v[24:27], v[12:15], v[136:143], v74
  v_smfmac_f32_16x16x64_bf16 v[28:31], v[12:15], v[224:231], v74
  v_smfmac_f32_16x16x64_bf16 v[32:35], v[12:15], v[232:239], v74
  ds_read_b128 v[8:11], v76 offset:8704
  s_waitcnt lgkmcnt(0)
  v_smfmac_f32_16x16x64_bf16 v[20:23], v[8:11], v[144:151], v74
  v_smfmac_f32_16x16x64_bf16 v[24:27], v[8:11], v[152:159], v74
  ds_read_b128 v[60:63], v76 offset:53248
  ds_read_b128 v[64:67], v76 offset:54272
  s_waitcnt lgkmcnt(0)
  v_smfmac_f32_16x16x64_bf16 v[28:31], v[8:11], v[60:67], v74
  ds_read_b128 v[60:63], v76 offset:55296
  ds_read_b128 v[64:67], v76 offset:56320
  s_waitcnt lgkmcnt(0)
  v_smfmac_f32_16x16x64_bf16 v[32:35], v[8:11], v[60:67], v74
  ds_read_b128 v[0:3], v76 offset:9728
  s_waitcnt lgkmcnt(0)
  v_smfmac_f32_16x16x64_bf16 v[20:23], v[0:3], v[160:167], v74
  v_smfmac_f32_16x16x64_bf16 v[24:27], v[0:3], v[168:175], v74
  ds_read_b128 v[60:63], v75 offset:20480
  ds_read_b128 v[64:67], v75 offset:21504
  s_waitcnt lgkmcnt(0)
  v_smfmac_f32_16x16x64_bf16 v[28:31], v[0:3], v[60:67], v74
  ds_read_b128 v[60:63], v75 offset:22528
  ds_read_b128 v[64:67], v75 offset:23552
  s_waitcnt lgkmcnt(0)
  v_smfmac_f32_16x16x64_bf16 v[32:35], v[0:3], v[60:67], v74
  ds_read_b128 v[16:19], v76 offset:10752
  ds_read_b128 v[60:63], v75 offset:4096
  ds_read_b128 v[64:67], v75 offset:5120
  s_waitcnt lgkmcnt(0)
  v_smfmac_f32_16x16x64_bf16 v[20:23], v[16:19], v[60:67], v74
  ds_read_b128 v[60:63], v75 offset:6144
  ds_read_b128 v[64:67], v75 offset:7168
  s_waitcnt lgkmcnt(0)
  v_smfmac_f32_16x16x64_bf16 v[24:27], v[16:19], v[60:67], v74
  v_smfmac_f32_16x16x64_bf16 v[28:31], v[16:19], v[240:247], v74
  v_smfmac_f32_16x16x64_bf16 v[32:35], v[16:19], v[248:255], v74
  ds_read_b128 v[4:7], v76 offset:11776
  s_waitcnt lgkmcnt(0)
  v_smfmac_f32_16x16x64_bf16 v[20:23], v[4:7], v[176:183], v74
  v_smfmac_f32_16x16x64_bf16 v[24:27], v[4:7], v[184:191], v74
  v_smfmac_f32_16x16x64_bf16 v[28:31], v[4:7], a[0:7], v74
  v_smfmac_f32_16x16x64_bf16 v[32:35], v[4:7], a[8:15], v74
  ds_read_b128 v[12:15], v76 offset:12800
  s_waitcnt lgkmcnt(0)
  v_smfmac_f32_16x16x64_bf16 v[20:23], v[12:15], v[192:199], v74
  v_smfmac_f32_16x16x64_bf16 v[24:27], v[12:15], v[200:207], v74
  v_smfmac_f32_16x16x64_bf16 v[28:31], v[12:15], a[16:23], v74
  v_smfmac_f32_16x16x64_bf16 v[32:35], v[12:15], a[24:31], v74
  v_add_f32 v20, v20, v22
  v_add_f32 v21, v21, v23
  v_add_f32 v24, v24, v26
  v_cvt_pk_bf16_f32 v22, v20, v24
  ds_write_b32 v79, v22 offset:0
  v_add_f32 v25, v25, v27
  v_cvt_pk_bf16_f32 v23, v21, v25
  ds_write_b32 v79, v23 offset:576
  v_add_f32 v28, v28, v30
  v_add_f32 v29, v29, v31
  s_waitcnt lgkmcnt(0)
  s_nop 1
  s_branch Cf1_recok
Cf1_mx:
  s_waitcnt lgkmcnt(0)
  s_barrier
  buffer_load_dwordx4 v[52:55], v76, s[8:11], s59 offen offset:0 sc1
  buffer_load_dwordx4 v[0:3], v76, s[8:11], s58 offen offset:0 sc1
  ds_read_b128 v[20:23], v77 offset:0
  ds_read_b128 v[28:31], v77 offset:256
  buffer_load_dwordx4 v[56:59], v76, s[8:11], s59 offen offset:1024 sc1
  buffer_load_dwordx4 v[4:7], v76, s[8:11], s58 offen offset:1024 sc1
  ds_read_b128 v[24:27], v77 offset:128
  ds_read_b128 v[32:35], v77 offset:384
  s_waitcnt vmcnt(2) lgkmcnt(3)
  v_mfma_f32_16x16x32_bf16 v[8:11], v[0:3], v[20:23], 0
  s_waitcnt vmcnt(0) lgkmcnt(1)
  v_mfma_f32_16x16x32_bf16 v[8:11], v[4:7], v[24:27], v[8:11]
  v_mfma_f32_16x16x32_bf16 v[12:15], v[28:31], v[20:23], 0
  s_waitcnt lgkmcnt(0)
  v_mfma_f32_16x16x32_bf16 v[12:15], v[32:35], v[24:27], v[12:15]
  v_add_f32_dpp v8, v10, v8 quad_perm:[2,3,0,1] row_mask:0xf bank_mask:0xf
  v_add_f32_dpp v9, v11, v9 quad_perm:[2,3,0,1] row_mask:0xf bank_mask:0xf
  s_nop 0
  v_mov_b32_dpp v8, v8 quad_perm:[0,1,0,1] row_mask:0xf bank_mask:0xf
  v_mov_b32_dpp v9, v9 quad_perm:[0,1,0,1] row_mask:0xf bank_mask:0xf
  s_nop 1
  v_add_f32_dpp v12, v14, v12 quad_perm:[2,3,0,1] row_mask:0xf bank_mask:0xf
  v_add_f32_dpp v13, v15, v13 quad_perm:[2,3,0,1] row_mask:0xf bank_mask:0xf
  s_nop 0
  v_mov_b32_dpp v12, v12 quad_perm:[0,1,0,1] row_mask:0xf bank_mask:0xf
  v_mov_b32_dpp v13, v13 quad_perm:[0,1,0,1] row_mask:0xf bank_mask:0xf
  v_mul_f32 v12, s69, v12
  ds_write_b32 v78, v8 offset:8708
  v_mul_f32 v13, s69, v13
  ds_write_b32 v78, v9 offset:8772
  s_waitcnt lgkmcnt(0)
  s_barrier
  ds_read_b128 v[36:39], v78 offset:8704
  ds_read_b128 v[40:43], v78 offset:8768
  s_waitcnt lgkmcnt(0)
  s_barrier
  v_max_f32 v16, v36, v37
  v_max3_f32 v16, v16, v38, v39
  v_max3_f32 v16, v16, v40, v41
  v_max3_f32 v16, v16, v42, v43
  v_max3_f32 v16, v16, v12, v13
  v_mov_b32 v17, v16
  s_nop 1
  v_permlane16_swap_b32 v16, v17
  v_max_f32 v16, v16, v17
  v_mov_b32 v17, v16
  s_nop 1
  v_permlane32_swap_b32 v16, v17
  v_max_f32 v16, v16, v17
  v_sub_f32 v36, v36, v16
  v_sub_f32 v37, v37, v16
  v_sub_f32 v38, v38, v16
  v_sub_f32 v39, v39, v16
  v_sub_f32 v40, v40, v16
  v_sub_f32 v41, v41, v16
  v_sub_f32 v42, v42, v16
  v_sub_f32 v43, v43, v16
  v_sub_f32 v12, v12, v16
  v_sub_f32 v13, v13, v16
  v_exp_f32 v36, v36
  v_exp_f32 v37, v37
  v_exp_f32 v38, v38
  v_exp_f32 v39, v39
  v_exp_f32 v40, v40
  v_exp_f32 v41, v41
  v_exp_f32 v42, v42
  v_exp_f32 v43, v43
  v_exp_f32 v12, v12
  v_exp_f32 v13, v13
  v_cvt_pk_bf16_f32 v32, v36, v40
  v_cvt_pk_bf16_f32 v33, v37, v41
  v_cvt_pk_bf16_f32 v34, v38, v42
  v_cvt_pk_bf16_f32 v35, v39, v43
  v_cvt_pk_bf16_f32 v28, v12, v13
  v_cvt_pk_bf16_f32 v31, v12, v13
  v_mov_b32 v29, 0
  v_mov_b32 v30, 0
  v_mfma_f32_16x16x32_bf16 v[8:11], v[32:35], v[68:71], 0
  v_mfma_f32_16x16x32_bf16 v[0:3], v[32:35], v[52:55], 0
  v_mfma_f32_16x16x32_bf16 v[4:7], v[32:35], v[56:59], 0
  v_mfma_f32_16x16x16_bf16 v[8:11], v[28:29], v[68:69], v[8:11]
  v_mfma_f32_16x16x16_bf16 v[0:3], v[28:29], v[72:73], v[0:3]
  v_mfma_f32_16x16x16_bf16 v[4:7], v[30:31], v[72:73], v[4:7]
  ds_read_b128 v[52:55], v75 offset:36864
  v_rcp_f32 v10, v8
  v_rcp_f32 v11, v9
  v_mul_f32 v0, v10, v0
  v_mul_f32 v1, v11, v1
  v_max3_f32 v8, v8, v9, v10
  v_mul_f32 v4, v10, v4
  v_mul_f32 v5, v11, v5
  v_cvt_pk_bf16_f32 v2, v0, v4
  ds_write_b32 v79, v2 offset:8704
  v_cvt_pk_bf16_f32 v3, v1, v5
  ds_write_b32 v79, v3 offset:9280
  ds_read_b128 v[12:15], v78 offset:8768
  ds_read_b128 v[56:59], v75 offset:37888
  v_mov_b64 v[16:17], 0
  v_mov_b64 v[18:19], 0
  v_mov_b64 v[20:21], 0
  v_mov_b64 v[22:23], 0
  v_mov_b64 v[24:25], 0
  v_mov_b64 v[26:27], 0
  s_branch Cf1_mxok
Cf1_last:
  ds_read_b128 v[4:7], v76 offset:5632
  ds_read_b128 v[12:15], v76 offset:7680
  ds_read_b128 v[44:47], v76 offset:36864
  ds_read_b128 v[48:51], v76 offset:37888
  s_nop 5
  v_mov_b64 v[20:21], 0
  v_mov_b64 v[22:23], 0
  v_mov_b64 v[24:25], 0
  v_mov_b64 v[26:27], 0
  s_waitcnt lgkmcnt(4)
  v_smfmac_f32_16x16x64_bf16 v[28:31], v[0:3], v[36:43], v74
  ds_read_b128 v[36:39], v76 offset:38912
  ds_read_b128 v[40:43], v76 offset:39936
  v_smfmac_f32_16x16x64_bf16 v[32:35], v[0:3], v[60:67], v74
  s_waitcnt lgkmcnt(5)
  v_smfmac_f32_16x16x64_bf16 v[20:23], v[0:3], a[32:39], v74
  ds_read_b128 v[60:63], v76 offset:53248
  ds_read_b128 v[64:67], v76 offset:54272
  v_smfmac_f32_16x16x64_bf16 v[24:27], v[0:3], a[40:47], v74
  s_waitcnt lgkmcnt(4)
  v_smfmac_f32_16x16x64_bf16 v[20:23], v[4:7], a[48:55], v74
  buffer_store_dwordx4 v[16:19], v76, s[8:11], s68 offen sc1
  v_smfmac_f32_16x16x64_bf16 v[24:27], v[4:7], a[56:63], v74
  v_smfmac_f32_16x16x64_bf16 v[28:31], v[4:7], v[44:51], v74
  s_waitcnt lgkmcnt(2)
  v_smfmac_f32_16x16x64_bf16 v[20:23], v[8:11], a[64:71], v74
  ds_read_b128 v[44:47], v76 offset:55296
  ds_read_b128 v[48:51], v76 offset:56320
  v_smfmac_f32_16x16x64_bf16 v[24:27], v[8:11], a[72:79], v74
  v_smfmac_f32_16x16x64_bf16 v[32:35], v[4:7], v[36:43], v74
  v_smfmac_f32_16x16x64_bf16 v[28:31], v[8:11], v[208:215], v74
  ds_read_b128 v[36:39], v75 offset:20480
  ds_read_b128 v[40:43], v75 offset:21504
  v_smfmac_f32_16x16x64_bf16 v[32:35], v[8:11], v[216:223], v74
  v_smfmac_f32_16x16x64_bf16 v[20:23], v[12:15], a[80:87], v74
  v_smfmac_f32_16x16x64_bf16 v[24:27], v[12:15], a[88:95], v74
  v_smfmac_f32_16x16x64_bf16 v[28:31], v[12:15], v[224:231], v74
  v_smfmac_f32_16x16x64_bf16 v[32:35], v[12:15], v[232:239], v74
  s_waitcnt vmcnt(2)
  s_waitcnt vmcnt(1)
  s_barrier
Cf1_lastr:
  ds_read_b128 v[8:11], v76 offset:8704
  ds_read_b128 v[0:3], v76 offset:9728
  ds_read_b128 v[16:19], v76 offset:10752
  ds_read_b128 v[4:7], v76 offset:11776
  ds_read_b128 v[12:15], v76 offset:12800
  s_waitcnt lgkmcnt(3)
  v_max3_u32 v72, v0, v1, v2
  s_waitcnt lgkmcnt(1)
  v_max3_u32 v72, v72, v3, v4
  v_max3_u32 v72, v72, v5, v6
  v_max3_u32 v72, v72, v7, v8
  v_max3_u32 v72, v72, v9, v10
  s_waitcnt lgkmcnt(0)
  v_max3_u32 v72, v72, v11, v12
  v_max3_u32 v72, v72, v13, v14
  v_max3_u32 v72, v72, v15, v16
  v_max3_u32 v72, v72, v17, v18
  v_max_u32 v72, v72, v19
  v_cmp_eq_u32 vcc, -1, v72
  s_cbranch_vccnz Cf1_lastp
Cf1_lastg:
  v_smfmac_f32_16x16x64_bf16 v[28:31], v[8:11], v[60:67], v74
  ds_read_b128 v[60:63], v75 offset:22528
  ds_read_b128 v[64:67], v75 offset:23552
  v_smfmac_f32_16x16x64_bf16 v[32:35], v[8:11], v[44:51], v74
  v_smfmac_f32_16x16x64_bf16 v[28:31], v[0:3], v[36:43], v74
  v_smfmac_f32_16x16x64_bf16 v[28:31], v[16:19], v[240:247], v74
  v_smfmac_f32_16x16x64_bf16 v[28:31], v[4:7], a[0:7], v74
  v_smfmac_f32_16x16x64_bf16 v[28:31], v[12:15], a[16:23], v74
  v_smfmac_f32_16x16x64_bf16 v[32:35], v[16:19], v[248:255], v74
  v_smfmac_f32_16x16x64_bf16 v[32:35], v[4:7], a[8:15], v74
  s_waitcnt lgkmcnt(0)
  v_smfmac_f32_16x16x64_bf16 v[32:35], v[12:15], a[24:31], v74
  v_smfmac_f32_16x16x64_bf16 v[32:35], v[0:3], v[60:67], v74
  v_smfmac_f32_16x16x64_bf16 v[20:23], v[8:11], a[96:103], v74
  v_smfmac_f32_16x16x64_bf16 v[20:23], v[0:3], a[112:119], v74
  v_add_f32 v28, v28, v30
  v_add_f32 v32, v32, v34
  v_cvt_pk_bf16_f32 v30, v28, v32
  v_smfmac_f32_16x16x64_bf16 v[20:23], v[16:19], a[128:135], v74
  ds_write_b32 v79, v30 offset:256
  v_add_f32 v29, v29, v31
  v_add_f32 v33, v33, v35
  v_cvt_pk_bf16_f32 v31, v29, v33
  v_smfmac_f32_16x16x64_bf16 v[20:23], v[4:7], a[144:151], v74
  ds_write_b32 v79, v31 offset:832
  v_smfmac_f32_16x16x64_bf16 v[20:23], v[12:15], a[160:167], v74
  v_smfmac_f32_16x16x64_bf16 v[24:27], v[8:11], a[104:111], v74
  v_smfmac_f32_16x16x64_bf16 v[24:27], v[0:3], a[120:127], v74
  v_smfmac_f32_16x16x64_bf16 v[24:27], v[16:19], a[136:143], v74
  s_waitcnt lgkmcnt(0)
  s_barrier
  ds_read_b64 v[52:53], v77 offset:264
  v_add_f32 v20, v20, v22
  v_smfmac_f32_16x16x64_bf16 v[24:27], v[4:7], a[152:159], v74
  v_add_f32 v21, v21, v23
  v_smfmac_f32_16x16x64_bf16 v[24:27], v[12:15], a[168:175], v74
  v_cvt_pk_bf16_f32 v54, v20, v21
  s_add_u32 s68, s68, 655360
  s_nop 3
  v_add_f32 v24, v24, v26
  v_add_f32 v25, v25, v27
  v_cvt_pk_bf16_f32 v55, v24, v25
  s_waitcnt lgkmcnt(0)
  buffer_store_dwordx4 v[52:55], v76, s[8:11], s68 offen sc1
  s_branch Cf1_done
Cf1_lastp:
  s_add_u32 s72, s72, 2
  s_cmp_ge_u32 s72, 131072
  s_cbranch_scc1 Cf1_lastg
  s_barrier
  buffer_load_dwordx4 v76, s[8:11], s85 offen offset:0 sc1 lds
  s_waitcnt vmcnt(0)
  s_barrier
  s_branch Cf1_lastr
Cf1_done:
  s_branch L_cexit
L_w2:
  v_mov_b64 v[20:21], 0
  v_mov_b64 v[22:23], 0
  v_mov_b64 v[24:25], 0
  v_mov_b64 v[26:27], 0
  v_mov_b64 v[28:29], 0
  v_mov_b64 v[30:31], 0
  v_mov_b64 v[32:33], 0
  v_mov_b64 v[34:35], 0
  s_mov_b32 s78, 0x3f803f80
  s_mov_b32 s79, s78
  s_mov_b32 s65, 360448
  s_mov_b32 m0, 15872
  s_lshl_b32 s71, s53, 2
  s_add_u32 s71, s71, 128
  s_movk_i32 s56, 0x1000
  v_lshlrev_b32 v73, 2, v76
  v_mov_b32 v72, 0
  s_mov_b64 s[16:17], s[8:9]
  s_mov_b32 s18, 268435456
  s_mov_b32 s19, 0x20000
  s_getpc_b64 s[20:21]
Cf2_pc:
  s_add_u32 s20, s20, (Cf2_last - Cf2_pc)
  s_addc_u32 s21, s21, 0
  v_mov_b32 v68, 14880
  buffer_load_dwordx4 v[52:55], v76, s[8:11], s59 offen offset:0 sc1
  buffer_load_dwordx4 v[56:59], v76, s[8:11], s59 offen offset:1024 sc1
  ds_read_b128 v[36:39], v76 offset:24576
  ds_read_b128 v[40:43], v76 offset:25600
  ds_read_b128 v[60:63], v76 offset:26624
  ds_read_b128 v[64:67], v76 offset:27648
  ds_read_b128 v[0:3], v76 offset:4608
  ds_read_b128 v[4:7], v76 offset:5632
  ds_read_b128 v[8:11], v76 offset:6656
  ds_read_b128 v[12:15], v76 offset:7680
  s_waitcnt lgkmcnt(0)
  s_cmp_eq_u32 s66, 1
  s_branch Cf2_top2
.p2align 6
Cf2_h2:
  buffer_load_dwordx4 v[12:15], v76, s[8:11], s65 offen offset:3072 sc1
  ds_read_b128 v[36:39], v76 offset:24576
  s_waitcnt lgkmcnt(0)
  s_cmp_eq_u32 s66, 62
  s_cselect_b64 s[16:17], s[20:21], s[16:17]
  s_cselect_b32 s18, (Cf2_done - Cf2_last), s18
  s_cselect_b32 s70, 0, s70
  s_cmp_eq_u32 s66, 63
  s_cselect_b32 s59, 268435456, s59
  s_cselect_b32 s58, 268435456, s58
  buffer_load_dwordx4 v[12:15], v76, s[8:11], s65 offen offset:3072 sc1
  ds_read_b128 v[40:43], v76 offset:25600
  s_waitcnt lgkmcnt(0)
  v_mov_b64 v[20:21], 0
  v_mov_b64 v[22:23], 0
  v_mov_b64 v[24:25], 0
  v_mov_b64 v[26:27], 0
  v_mov_b32 v68, 14880
  v_lshlrev_b32 v73, 2, v76
  buffer_load_dwordx4 v[12:15], v76, s[8:11], s65 offen offset:3072 sc1
  buffer_load_dwordx4 v[52:55], v76, s[8:11], s59 offen offset:0 sc1
  buffer_load_dwordx4 v[56:59], v76, s[8:11], s59 offen offset:1024 sc1
  s_waitcnt vmcnt(4)
  v_max3_u32 v72, v12, v13, v14
  v_max_u32 v72, v72, v15
  ds_write_b128 v76, v[12:15] offset:7680
  v_cmp_eq_u32 vcc, -1, v72
  s_cbranch_vccnz Cf2_h2r
Cf2_h2w:
  s_cmp_eq_u32 s66, 63
  s_waitcnt lgkmcnt(0)
  s_barrier
  ds_read_b128 v[0:3], v76 offset:4608
  buffer_load_dwordx4 v76, s[8:11], s85 offen offset:0 sc1 lds
Cf2_top2:
  v_smfmac_f32_16x16x64_bf16 v[20:23], v[12:15], v[128:135], v74
  s_cbranch_scc1 Cf2_last
  v_smfmac_f32_16x16x64_bf16 v[24:27], v[12:15], v[136:143], v74
  buffer_load_dwordx4 v[44:47], v76, s[8:11], s58 offen offset:0 sc1
  s_mov_b32 m0, 15872
  v_smfmac_f32_16x16x64_bf16 v[28:31], v[12:15], v[224:231], v74
  buffer_load_dwordx4 v[48:51], v76, s[8:11], s58 offen offset:1024 sc1
  v_smfmac_f32_16x16x64_bf16 v[32:35], v[12:15], v[232:239], v74
  ds_read_b128 v[4:7], v76 offset:5632
  s_waitcnt lgkmcnt(1)
  v_smfmac_f32_16x16x64_bf16 v[20:23], v[0:3], v[80:87], v74
  ds_read_b128 v[8:11], v76 offset:6656
  v_smfmac_f32_16x16x64_bf16 v[28:31], v[0:3], v[36:43], v74
  ds_read_b128 v[36:39], v76 offset:40960
  v_smfmac_f32_16x16x64_bf16 v[24:27], v[0:3], v[88:95], v74
  buffer_store_dwordx4 v[16:19], v76, s[8:11], s68 offen sc1
  ds_read_b128 v[40:43], v76 offset:41984
  v_smfmac_f32_16x16x64_bf16 v[32:35], v[0:3], v[60:67], v74
  buffer_load_dword v73, s[16:19], s70 offen lds
  ds_read_b128 v[60:63], v76 offset:43008
  s_waitcnt lgkmcnt(4)
  v_smfmac_f32_16x16x64_bf16 v[20:23], v[4:7], v[96:103], v74
  ds_read_b128 v[64:67], v76 offset:44032
  v_smfmac_f32_16x16x64_bf16 v[24:27], v[4:7], v[104:111], v74
  s_waitcnt vmcnt(5)
  s_waitcnt lgkmcnt(4)
  v_smfmac_f32_16x16x64_bf16 v[20:23], v[8:11], v[112:119], v74
  s_barrier
  ds_read_b128 v[12:15], v76 offset:8704
  s_waitcnt lgkmcnt(3)
  v_smfmac_f32_16x16x64_bf16 v[28:31], v[4:7], v[36:43], v74
  ds_read_b128 v[36:39], v76 offset:57344
  v_smfmac_f32_16x16x64_bf16 v[24:27], v[8:11], v[120:127], v74
  ds_read_b128 v[40:43], v76 offset:58368
  s_waitcnt lgkmcnt(3)
  v_smfmac_f32_16x16x64_bf16 v[32:35], v[4:7], v[60:67], v74
  ds_read_b128 v[0:3], v76 offset:9728
  v_smfmac_f32_16x16x64_bf16 v[28:31], v[8:11], v[208:215], v74
  ds_read_b128 v[60:63], v76 offset:59392
  v_smfmac_f32_16x16x64_bf16 v[32:35], v[8:11], v[216:223], v74
  s_waitcnt vmcnt(4)
  ds_read_b128 v[64:67], v76 offset:60416
  s_waitcnt lgkmcnt(5)
  v_smfmac_f32_16x16x64_bf16 v[20:23], v[12:15], v[144:151], v74
  s_barrier
  ds_read_b128 v[4:7], v76 offset:11776
  s_waitcnt lgkmcnt(4)
  v_smfmac_f32_16x16x64_bf16 v[28:31], v[12:15], v[36:43], v74
  ds_read_b128 v[8:11], v76 offset:12800
  ds_read_b128 v[36:39], v75 offset:8192
  v_smfmac_f32_16x16x64_bf16 v[24:27], v[12:15], v[152:159], v74
  ds_read_b128 v[16:19], v76 offset:10752
  s_waitcnt lgkmcnt(6)
  v_smfmac_f32_16x16x64_bf16 v[20:23], v[0:3], v[160:167], v74
  ds_read_b128 v[40:43], v75 offset:9216
  s_waitcnt lgkmcnt(5)
  v_smfmac_f32_16x16x64_bf16 v[32:35], v[12:15], v[60:67], v74
  ds_read_b128 v[60:63], v75 offset:10240
  v_smfmac_f32_16x16x64_bf16 v[24:27], v[0:3], v[168:175], v74
  ds_read_b128 v[64:67], v75 offset:11264
  s_waitcnt lgkmcnt(6)
  v_smfmac_f32_16x16x64_bf16 v[20:23], v[4:7], v[176:183], v74
  s_waitcnt lgkmcnt(5)
  v_smfmac_f32_16x16x64_bf16 v[20:23], v[8:11], v[192:199], v74
  s_waitcnt lgkmcnt(2)
  v_smfmac_f32_16x16x64_bf16 v[20:23], v[16:19], v[36:43], v74
  ds_read_b128 v[36:39], v75 offset:24576
  v_smfmac_f32_16x16x64_bf16 v[24:27], v[4:7], v[184:191], v74
  ds_read_b128 v[40:43], v75 offset:25600
  s_waitcnt lgkmcnt(2)
  v_smfmac_f32_16x16x64_bf16 v[24:27], v[16:19], v[60:67], v74
  ds_read_b128 v[60:63], v75 offset:26624
  v_add_f32 v20, v20, v22
  v_smfmac_f32_16x16x64_bf16 v[24:27], v[8:11], v[200:207], v74
  ds_read_b128 v[64:67], v75 offset:27648
  v_add_f32 v21, v21, v23
  v_smfmac_f32_16x16x64_bf16 v[28:31], v[16:19], v[240:247], v74
  v_mov_b64 v[70:71], s[78:79]
  v_smfmac_f32_16x16x64_bf16 v[28:31], v[4:7], a[0:7], v74
  s_waitcnt lgkmcnt(2)
  v_add_f32 v24, v24, v26
  v_smfmac_f32_16x16x64_bf16 v[28:31], v[0:3], v[36:43], v74
  ds_read_b128 v[36:39], v68
  v_cvt_pk_bf16_f32 v22, v20, v24
  v_smfmac_f32_16x16x64_bf16 v[28:31], v[8:11], a[16:23], v74
  ds_read_b128 v[40:43], v68
  ds_write_b32 v79, v22 offset:0
  s_waitcnt lgkmcnt(3)
  v_add_f32 v25, v25, v27
  v_cvt_pk_bf16_f32 v23, v21, v25
  v_smfmac_f32_16x16x64_bf16 v[32:35], v[0:3], v[60:67], v74
  ds_write_b32 v79, v23 offset:576
  v_cmp_u_f32 vcc, v20, v21
  v_smfmac_f32_16x16x64_bf16 v[32:35], v[16:19], v[248:255], v74
  v_add_f32 v28, v28, v30
  v_smfmac_f32_16x16x64_bf16 v[32:35], v[4:7], a[8:15], v74
  v_add_f32 v29, v29, v31
  v_smfmac_f32_16x16x64_bf16 v[32:35], v[8:11], a[24:31], v74
  s_cbranch_vccnz Cf2_rec
Cf2_recok:
  s_waitcnt lgkmcnt(3)
  v_smfmac_f32_16x16x64_bf16 v[36:39], v[16:19], a[128:135], v74
  s_waitcnt lgkmcnt(0)
  s_barrier
  ds_read_b128 v[60:63], v77
  v_smfmac_f32_16x16x64_bf16 v[40:43], v[16:19], a[136:143], v74
  ds_read_b128 v[64:67], v77 offset:128
  v_add_f32 v32, v32, v34
  v_cvt_pk_bf16_f32 v30, v28, v32
  v_smfmac_f32_16x16x64_bf16 v[36:39], v[0:3], a[112:119], v74
  ds_write_b32 v79, v30 offset:256
  v_add_f32 v33, v33, v35
  v_cvt_pk_bf16_f32 v31, v29, v33
  v_smfmac_f32_16x16x64_bf16 v[40:43], v[0:3], a[120:127], v74
  ds_write_b32 v79, v31 offset:832
  v_xor_b32 v75, 0x8000, v75
  v_smfmac_f32_16x16x64_bf16 v[36:39], v[4:7], a[144:151], v74
  ds_read_b128 v[0:3], v76 offset:4608
  v_mov_b32 v29, 0
  v_smfmac_f32_16x16x64_bf16 v[40:43], v[4:7], a[152:159], v74
  s_waitcnt vmcnt(2) lgkmcnt(3)
  v_mov_b32 v30, 0
  v_mfma_f32_16x16x32_bf16 v[44:47], v[44:47], v[60:63], 0
  ds_read_b128 v[4:7], v76 offset:5632
  s_waitcnt lgkmcnt(2)
  v_mfma_f32_16x16x32_bf16 v[44:47], v[48:51], v[64:67], v[44:47]
  s_barrier
  v_smfmac_f32_16x16x64_bf16 v[36:39], v[8:11], a[160:167], v74
  ds_read_b128 v[20:23], v77 offset:256
  ds_read_b128 v[24:27], v77 offset:384
  v_smfmac_f32_16x16x64_bf16 v[40:43], v[8:11], a[168:175], v74
  ds_read_b128 v[8:11], v76 offset:6656
  v_add_f32_dpp v72, v46, v44 quad_perm:[2,3,0,1] row_mask:0xf bank_mask:0xf
  v_add_f32_dpp v73, v47, v45 quad_perm:[2,3,0,1] row_mask:0xf bank_mask:0xf
  v_smfmac_f32_16x16x64_bf16 v[36:39], v[12:15], a[96:103], v74
  s_waitcnt lgkmcnt(4)
  v_exp_f32_dpp v72, v72 quad_perm:[0,1,0,1] row_mask:0xf bank_mask:0xf
  v_smfmac_f32_16x16x64_bf16 v[40:43], v[12:15], a[104:111], v74
  ds_read_b128 v[12:15], v76 offset:7680
  v_exp_f32_dpp v73, v73 quad_perm:[0,1,0,1] row_mask:0xf bank_mask:0xf
  v_smfmac_f32_16x16x64_bf16 v[36:39], v[0:3], a[32:39], v74
  s_waitcnt lgkmcnt(2)
  v_cvt_pk_bf16_f32 v72, v72, v73
  v_mfma_f32_16x16x32_bf16 v[20:23], v[20:23], v[60:63], 0
  ds_write_b32 v78, v72 offset:520
  v_mov_b64 v[16:17], 0
  v_mfma_f32_16x16x32_bf16 v[20:23], v[24:27], v[64:67], v[20:23]
  ds_read_b128 v[44:47], v75 offset:40960
  v_mov_b64 v[18:19], 0
  v_smfmac_f32_16x16x64_bf16 v[40:43], v[0:3], a[40:47], v74
  ds_read_b128 v[48:51], v75 offset:41984
  v_mov_b64 v[68:69], s[78:79]
  v_smfmac_f32_16x16x64_bf16 v[36:39], v[4:7], a[48:55], v74
  s_waitcnt lgkmcnt(4)
  v_add_f32_dpp v24, v22, v20 quad_perm:[2,3,0,1] row_mask:0xf bank_mask:0xf
  v_add_f32_dpp v25, v23, v21 quad_perm:[2,3,0,1] row_mask:0xf bank_mask:0xf
  v_smfmac_f32_16x16x64_bf16 v[36:39], v[8:11], a[64:71], v74
  s_waitcnt lgkmcnt(2)
  s_barrier
  ds_read_b128 v[32:35], v78 offset:512
  v_smfmac_f32_16x16x64_bf16 v[36:39], v[12:15], a[80:87], v74
  ds_read_b128 v[60:63], v75 offset:24576
  v_mul_f32 v24, s69, v24
  v_smfmac_f32_16x16x64_bf16 v[40:43], v[4:7], a[56:63], v74
  ds_read_b128 v[64:67], v75 offset:25600
  v_mul_f32 v25, s69, v25
  v_smfmac_f32_16x16x64_bf16 v[40:43], v[8:11], a[72:79], v74
  v_exp_f32_dpp v24, v24 quad_perm:[0,1,0,1] row_mask:0xf bank_mask:0xf
  v_smfmac_f32_16x16x64_bf16 v[40:43], v[12:15], a[88:95], v74
  s_waitcnt lgkmcnt(2)
  v_exp_f32_dpp v25, v25 quad_perm:[0,1,0,1] row_mask:0xf bank_mask:0xf
  v_mfma_f32_16x16x32_bf16 v[8:11], v[32:35], v[68:71], 0
  v_add_f32 v36, v36, v38
  v_add_f32 v37, v37, v39
  v_mfma_f32_16x16x32_bf16 v[0:3], v[32:35], v[52:55], 0
  v_add_f32 v40, v40, v42
  v_add_f32 v41, v41, v43
  v_mfma_f32_16x16x32_bf16 v[4:7], v[32:35], v[56:59], 0
  v_cvt_pk_bf16_f32 v28, v24, v25
  v_cvt_pk_bf16_f32 v72, v36, v37
  v_cvt_pk_bf16_f32 v73, v40, v41
  v_mfma_f32_16x16x16_bf16 v[8:11], v[28:29], v[68:69], v[8:11]
  v_cvt_pk_bf16_f32 v31, v24, v25
  v_mov_b64 v[20:21], 0
  v_mfma_f32_16x16x16_bf16 v[0:3], v[28:29], v[72:73], v[0:3]
  ds_read_b128 v[52:55], v75 offset:26624
  v_mov_b64 v[22:23], 0
  v_mfma_f32_16x16x16_bf16 v[4:7], v[30:31], v[72:73], v[4:7]
  v_rcp_f32 v10, v8
  v_rcp_f32 v11, v9
  v_mul_f32 v0, v10, v0
  v_mul_f32 v1, v11, v1
  v_max3_f32 v8, v8, v9, v10
  v_mul_f32 v4, v10, v4
  v_mul_f32 v5, v11, v5
  v_cvt_pk_bf16_f32 v2, v0, v4
  ds_write_b32 v79, v2 offset:8704
  v_cvt_pk_bf16_f32 v3, v1, v5
  ds_write_b32 v79, v3 offset:9280
  ds_read_b128 v[12:15], v78 offset:8832
  v_max_f32 v8, v8, v11
  v_cmp_le_f32 vcc, 1317011456, v8
  v_mov_b64 v[24:25], 0
  v_mov_b64 v[26:27], 0
  ds_read_b128 v[56:59], v75 offset:27648
  s_cbranch_vccnz Cf2_mx
Cf2_mxok:
  s_waitcnt lgkmcnt(2)
  s_barrier
  ds_read_b128 v[0:3], v78 offset:8896
  s_waitcnt lgkmcnt(2)
  v_smfmac_f32_16x16x64_bf16 v[16:19], v[12:15], a[176:183], v74
  ds_read_b128 v[4:7], v78 offset:8704
  v_smfmac_f32_16x16x64_bf16 v[20:23], v[12:15], v[44:51], v74
  ds_read_b128 v[8:11], v78 offset:8768
  v_smfmac_f32_16x16x64_bf16 v[24:27], v[12:15], a[224:231], v74
  ds_read_b128 v[36:39], v75 offset:43008
  s_waitcnt lgkmcnt(3)
  v_smfmac_f32_16x16x64_bf16 v[16:19], v[0:3], a[184:191], v74
  ds_read_b128 v[40:43], v75 offset:44032
  s_waitcnt lgkmcnt(3)
  v_smfmac_f32_16x16x64_bf16 v[16:19], v[4:7], v[60:67], v74
  ds_read_b128 v[68:71], v76 offset:13824
  s_waitcnt lgkmcnt(3)
  v_smfmac_f32_16x16x64_bf16 v[16:19], v[8:11], v[52:59], v74
  ds_read_b128 v[44:47], v75 offset:57344
  v_smfmac_f32_16x16x64_bf16 v[20:23], v[4:7], a[192:199], v74
  ds_read_b128 v[48:51], v75 offset:58368
  v_smfmac_f32_16x16x64_bf16 v[20:23], v[8:11], a[200:207], v74
  ds_read_b128 v[60:63], v75 offset:59392
  s_waitcnt lgkmcnt(4)
  v_cvt_pk_bf16_f32 v16, v16, v17
  v_cvt_pk_bf16_f32 v17, v18, v19
  v_bfi_b32 v16, 1, s72, v16
  v_smfmac_f32_16x16x64_bf16 v[20:23], v[0:3], v[36:43], v74
  s_waitcnt lgkmcnt(3)
  buffer_store_dwordx2 v[16:17], v68, s[8:11], s73 offen
  v_mov_b64 v[32:33], 0
  v_smfmac_f32_16x16x64_bf16 v[24:27], v[4:7], a[208:215], v74
  ds_read_b128 v[64:67], v75 offset:60416
  v_mov_b64 v[34:35], 0
  v_smfmac_f32_16x16x64_bf16 v[24:27], v[8:11], a[216:223], v74
  ds_read_b128 v[52:55], v75 offset:0
  v_cvt_pk_bf16_f32 v20, v20, v21
  v_cvt_pk_bf16_f32 v21, v22, v23
  v_bfi_b32 v20, 1, s72, v20
  v_smfmac_f32_16x16x64_bf16 v[24:27], v[0:3], a[232:239], v74
  ds_read_b128 v[56:59], v75 offset:1024
  buffer_store_dwordx2 v[20:21], v68, s[8:11], s74 offen
  s_waitcnt lgkmcnt(4)
  v_mov_b64 v[28:29], 0
  v_smfmac_f32_16x16x64_bf16 v[32:35], v[4:7], v[44:51], v74
  ds_read_b128 v[36:39], v75 offset:2048
  ds_read_b128 v[40:43], v75 offset:3072
  s_waitcnt lgkmcnt(4)
  v_smfmac_f32_16x16x64_bf16 v[32:35], v[8:11], v[60:67], v74
  ds_read_b128 v[44:47], v75 offset:4096
  v_cvt_pk_bf16_f32 v24, v24, v25
  v_cvt_pk_bf16_f32 v25, v26, v27
  v_bfi_b32 v24, 1, s72, v24
  v_smfmac_f32_16x16x64_bf16 v[32:35], v[12:15], a[240:247], v74
  ds_read_b128 v[48:51], v75 offset:5120
  buffer_store_dwordx2 v[24:25], v68, s[8:11], s75 offen
  v_mov_b64 v[30:31], 0
  v_smfmac_f32_16x16x64_bf16 v[32:35], v[0:3], a[248:255], v74
  ds_read_b128 v[60:63], v75 offset:6144
  ds_read_b128 v[64:67], v75 offset:7168
  s_waitcnt lgkmcnt(6)
  v_smfmac_f32_16x16x64_bf16 v[28:31], v[4:7], v[52:59], v74
  s_waitcnt lgkmcnt(4)
  v_smfmac_f32_16x16x64_bf16 v[28:31], v[8:11], v[36:43], v74
  s_waitcnt lgkmcnt(2)
  v_cvt_pk_bf16_f32 v32, v32, v33
  v_cvt_pk_bf16_f32 v33, v34, v35
  v_bfi_b32 v32, 1, s72, v32
  v_smfmac_f32_16x16x64_bf16 v[28:31], v[12:15], v[44:51], v74
  buffer_store_dwordx2 v[32:33], v68, s[8:11], s76 offen
  s_waitcnt lgkmcnt(0)
  v_smfmac_f32_16x16x64_bf16 v[28:31], v[0:3], v[60:67], v74
  v_mov_b64 v[18:19], v[72:73]
  s_nop 4
  v_cvt_pk_bf16_f32 v28, v28, v29
  v_cvt_pk_bf16_f32 v29, v30, v31
  v_bfi_b32 v28, 1, s72, v28
  buffer_store_dwordx2 v[28:29], v68, s[8:11], s77 offen
  ds_read_b128 v[0:3], v76 offset:14848
  s_waitcnt lgkmcnt(0)
  ds_read_b64 v[16:17], v77 offset:384
  s_waitcnt lgkmcnt(0)
  ds_read_b128 v[64:67], v76 offset:27648
  s_waitcnt lgkmcnt(0)
  ds_read_b128 v[60:63], v76 offset:26624
  s_waitcnt lgkmcnt(0)
  v_xor_b32 v75, 0x8000, v75
  v_mov_b64 v[28:29], 0
  v_mov_b64 v[30:31], 0
  v_mov_b64 v[32:33], 0
  v_mov_b64 v[34:35], 0
  buffer_load_dwordx4 v[52:55], v76, s[8:11], s60 offen offset:0 sc1
  buffer_load_dwordx4 v[56:59], v76, s[8:11], s60 offen offset:1024 sc1
  s_add_u32 s66, s66, 1
  s_xor_b32 s64, s64, 16384
  s_xor_b32 s65, s65, 16384
  s_add_u32 s58, s58, 655360
  s_add_u32 s59, s59, 655360
  s_add_u32 s70, s70, 655360
  s_add_u32 s68, s68, 655360
  s_mov_b32 m0, 12800
  s_add_u32 s85, s65, 8192
  s_waitcnt lgkmcnt(0)
  s_waitcnt vmcnt(1)
  v_mfma_f32_16x16x32_bf16 v[4:7], v[0:3], v[52:55], 0
  v_bitop3_b32 v72, v52, v54, s72 bitop3:0x7e
  s_waitcnt vmcnt(0)
  v_mfma_f32_16x16x32_bf16 v[4:7], v[0:3], v[56:59], v[4:7]
  v_bitop3_b32 v73, v56, v58, s72 bitop3:0x7e
  v_bitop3_b32 v72, v72, v73, 1 bitop3:0xa8
  v_cmp_ne_u32 vcc, 0, v72
  s_nop 3
  v_add_f32_dpp v4, v4, v4 row_ror:4 row_mask:0xf bank_mask:0xf
  v_add_f32_dpp v5, v5, v5 row_ror:4 row_mask:0xf bank_mask:0xf
  s_cmp_eq_u64 vcc, 0
  v_add_f32_dpp v4, v4, v4 row_ror:8 row_mask:0xf bank_mask:0xf
  v_add_f32_dpp v5, v5, v5 row_ror:8 row_mask:0xf bank_mask:0xf
  s_cselect_b32 s54, s62, 268435456
  v_cvt_pk_bf16_f32 v4, v4, v5
  buffer_store_dword v4, v69, s[8:11], s54 offen
  s_cbranch_vccnz Cf2_h1r
  s_xor_b32 s62, s62, 16384
  buffer_store_dword v71, v69, s[8:11], s62 offen
  s_xor_b32 s72, s72, 1
  s_branch Cf2_h2
Cf2_h1r:
  s_mov_b64 exec, vcc
  buffer_load_dwordx4 v[52:55], v76, s[8:11], s60 offen offset:0 sc1
  buffer_load_dwordx4 v[56:59], v76, s[8:11], s60 offen offset:1024 sc1
  s_mov_b64 exec, -1
  s_add_u32 s67, s67, 1
  s_waitcnt vmcnt(1)
  v_mfma_f32_16x16x32_bf16 v[4:7], v[0:3], v[52:55], 0
  v_bitop3_b32 v72, v52, v54, s72 bitop3:0x7e
  s_waitcnt vmcnt(0)
  v_mfma_f32_16x16x32_bf16 v[4:7], v[0:3], v[56:59], v[4:7]
  v_bitop3_b32 v73, v56, v58, s72 bitop3:0x7e
  v_bitop3_b32 v72, v72, v73, 1 bitop3:0xa8
  v_cmp_ne_u32 vcc, 0, v72
  s_cbranch_vccz Cf2_h1p
Cf2_h1s:
  s_mov_b64 exec, vcc
  buffer_load_dwordx4 v[52:55], v76, s[8:11], s60 offen offset:0 sc1
  buffer_load_dwordx4 v[56:59], v76, s[8:11], s60 offen offset:1024 sc1
  s_mov_b64 exec, -1
  s_add_u32 s67, s67, 1
  s_waitcnt vmcnt(1)
  v_mfma_f32_16x16x32_bf16 v[4:7], v[0:3], v[52:55], 0
  v_bitop3_b32 v72, v52, v54, s72 bitop3:0x7e
  s_waitcnt vmcnt(0)
  v_mfma_f32_16x16x32_bf16 v[4:7], v[0:3], v[56:59], v[4:7]
  v_bitop3_b32 v73, v56, v58, s72 bitop3:0x7e
  v_bitop3_b32 v72, v72, v73, 1 bitop3:0xa8
  v_cmp_ne_u32 vcc, 0, v72
  s_cbranch_vccz Cf2_h1p
  s_cmp_lt_u32 s67, 131072
  s_cbranch_scc1 Cf2_h1s
Cf2_h1p:
  s_nop 2
  v_add_f32_dpp v4, v4, v4 row_ror:4 row_mask:0xf bank_mask:0xf
  v_add_f32_dpp v5, v5, v5 row_ror:4 row_mask:0xf bank_mask:0xf
  s_nop 0
  v_add_f32_dpp v4, v4, v4 row_ror:8 row_mask:0xf bank_mask:0xf
  v_add_f32_dpp v5, v5, v5 row_ror:8 row_mask:0xf bank_mask:0xf
  v_cvt_pk_bf16_f32 v4, v4, v5
  buffer_store_dword v4, v69, s[8:11], s62 offen
  s_xor_b32 s62, s62, 16384
  buffer_store_dword v71, v69, s[8:11], s62 offen
  s_xor_b32 s72, s72, 1
  s_branch Cf2_h2
Cf2_h2r:
  s_mov_b64 exec, vcc
  buffer_load_dwordx4 v[12:15], v76, s[8:11], s65 offen offset:3072 sc1
  s_mov_b64 exec, -1
  s_add_u32 s67, s67, 1
  s_waitcnt vmcnt(4)
  v_max3_u32 v72, v12, v13, v14
  v_max_u32 v72, v72, v15
  ds_write_b128 v76, v[12:15] offset:7680
  v_cmp_eq_u32 vcc, -1, v72
  s_cbranch_vccz Cf2_h2w
  s_mov_b64 exec, vcc
  buffer_load_dwordx4 v[12:15], v76, s[8:11], s65 offen offset:3072 sc1
  s_mov_b64 exec, -1
  s_add_u32 s67, s67, 1
  s_waitcnt vmcnt(4)
  v_max3_u32 v72, v12, v13, v14
  v_max_u32 v72, v72, v15
  ds_write_b128 v76, v[12:15] offset:7680
  v_cmp_eq_u32 vcc, -1, v72
  s_cbranch_vccz Cf2_h2w
Cf2_h2s:
  s_mov_b64 exec, vcc
  buffer_load_dwordx4 v[12:15], v76, s[8:11], s65 offen offset:3072 sc1
  s_mov_b64 exec, -1
  s_add_u32 s67, s67, 1
  s_waitcnt vmcnt(2)
  v_max3_u32 v72, v12, v13, v14
  v_max_u32 v72, v72, v15
  ds_write_b128 v76, v[12:15] offset:7680
  v_cmp_eq_u32 vcc, -1, v72
  s_cbranch_vccz Cf2_h2w
  s_mov_b64 exec, vcc
  buffer_load_dwordx4 v[12:15], v76, s[8:11], s65 offen offset:3072 sc1
  s_mov_b64 exec, -1
  s_add_u32 s67, s67, 1
  s_waitcnt vmcnt(2)
  v_max3_u32 v72, v12, v13, v14
  v_max_u32 v72, v72, v15
  ds_write_b128 v76, v[12:15] offset:7680
  v_cmp_eq_u32 vcc, -1, v72
  s_cbranch_vccz Cf2_h2w
  s_mov_b64 exec, vcc
  buffer_load_dwordx4 v[12:15], v76, s[8:11], s65 offen offset:3072 sc1
  s_mov_b64 exec, -1
  s_add_u32 s67, s67, 1
  s_waitcnt vmcnt(2)
  v_max3_u32 v72, v12, v13, v14
  v_max_u32 v72, v72, v15
  ds_write_b128 v76, v[12:15] offset:7680
  v_cmp_eq_u32 vcc, -1, v72
  s_cbranch_vccz Cf2_h2w
  s_cmp_lt_u32 s67, 131072
  s_cbranch_scc1 Cf2_h2s
  s_branch Cf2_h2w
Cf2_rec:
  s_nop 7
  s_waitcnt vmcnt(0) lgkmcnt(0)
  v_max3_u32 v72, v0, v1, v2
  v_max3_u32 v72, v72, v3, v4
  v_max3_u32 v72, v72, v5, v6
  v_max3_u32 v72, v72, v7, v8
  v_max3_u32 v72, v72, v9, v10
  v_max3_u32 v72, v72, v11, v12
  v_max3_u32 v72, v72, v13, v14
  v_max3_u32 v72, v72, v15, v16
  v_max3_u32 v72, v72, v17, v18
  v_max_u32 v72, v72, v19
  v_cmp_eq_u32 vcc, -1, v72
  s_cbranch_vccz Cf2_recok
  s_barrier
Cf2_recp:
  buffer_load_dwordx4 v[0:3], v76, s[8:11], s64 offen offset:0 sc1
  buffer_load_dwordx4 v[4:7], v76, s[8:11], s64 offen offset:1024 sc1
  s_add_u32 s67, s67, 1
  s_cmp_lt_u32 s67, 131072
  s_cselect_b32 s54, -2, -1
  s_waitcnt vmcnt(1)
  v_max3_u32 v72, v0, v1, v2
  s_waitcnt vmcnt(0)
  v_max3_u32 v72, v72, v3, v4
  v_max3_u32 v72, v72, v5, v6
  v_max_u32 v72, v72, v7
  v_cmp_lt_u32 vcc, s54, v72
  s_cbranch_vccnz Cf2_recp
  ds_write_b128 v76, v[0:3] offset:8704
  ds_write_b128 v76, v[4:7] offset:9728
  v_mov_b64 v[20:21], 0
  v_mov_b64 v[22:23], 0
  v_mov_b64 v[24:25], 0
  v_mov_b64 v[26:27], 0
  v_mov_b64 v[28:29], 0
  v_mov_b64 v[30:31], 0
  v_mov_b64 v[32:33], 0
  v_mov_b64 v[34:35], 0
  s_waitcnt lgkmcnt(0)
  s_barrier
  ds_read_b128 v[0:3], v76 offset:4608
  s_waitcnt lgkmcnt(0)
  v_smfmac_f32_16x16x64_bf16 v[20:23], v[0:3], v[80:87], v74
  v_smfmac_f32_16x16x64_bf16 v[24:27], v[0:3], v[88:95], v74
  ds_read_b128 v[60:63], v76 offset:24576
  ds_read_b128 v[64:67], v76 offset:25600
  s_waitcnt lgkmcnt(0)
  v_smfmac_f32_16x16x64_bf16 v[28:31], v[0:3], v[60:67], v74
  ds_read_b128 v[60:63], v76 offset:26624
  ds_read_b128 v[64:67], v76 offset:27648
  s_waitcnt lgkmcnt(0)
  v_smfmac_f32_16x16x64_bf16 v[32:35], v[0:3], v[60:67], v74
  ds_read_b128 v[4:7], v76 offset:5632
  s_waitcnt lgkmcnt(0)
  v_smfmac_f32_16x16x64_bf16 v[20:23], v[4:7], v[96:103], v74
  v_smfmac_f32_16x16x64_bf16 v[24:27], v[4:7], v[104:111], v74
  ds_read_b128 v[60:63], v76 offset:40960
  ds_read_b128 v[64:67], v76 offset:41984
  s_waitcnt lgkmcnt(0)
  v_smfmac_f32_16x16x64_bf16 v[28:31], v[4:7], v[60:67], v74
  ds_read_b128 v[60:63], v76 offset:43008
  ds_read_b128 v[64:67], v76 offset:44032
  s_waitcnt lgkmcnt(0)
  v_smfmac_f32_16x16x64_bf16 v[32:35], v[4:7], v[60:67], v74
  ds_read_b128 v[8:11], v76 offset:6656
  s_waitcnt lgkmcnt(0)
  v_smfmac_f32_16x16x64_bf16 v[20:23], v[8:11], v[112:119], v74
  v_smfmac_f32_16x16x64_bf16 v[24:27], v[8:11], v[120:127], v74
  v_smfmac_f32_16x16x64_bf16 v[28:31], v[8:11], v[208:215], v74
  v_smfmac_f32_16x16x64_bf16 v[32:35], v[8:11], v[216:223], v74
  ds_read_b128 v[12:15], v76 offset:7680
  s_waitcnt lgkmcnt(0)
  v_smfmac_f32_16x16x64_bf16 v[20:23], v[12:15], v[128:135], v74
  v_smfmac_f32_16x16x64_bf16 v[24:27], v[12:15], v[136:143], v74
  v_smfmac_f32_16x16x64_bf16 v[28:31], v[12:15], v[224:231], v74
  v_smfmac_f32_16x16x64_bf16 v[32:35], v[12:15], v[232:239], v74
  ds_read_b128 v[12:15], v76 offset:8704
  s_waitcnt lgkmcnt(0)
  v_smfmac_f32_16x16x64_bf16 v[20:23], v[12:15], v[144:151], v74
  v_smfmac_f32_16x16x64_bf16 v[24:27], v[12:15], v[152:159], v74
  ds_read_b128 v[60:63], v76 offset:57344
  ds_read_b128 v[64:67], v76 offset:58368
  s_waitcnt lgkmcnt(0)
  v_smfmac_f32_16x16x64_bf16 v[28:31], v[12:15], v[60:67], v74
  ds_read_b128 v[60:63], v76 offset:59392
  ds_read_b128 v[64:67], v76 offset:60416
  s_waitcnt lgkmcnt(0)
  v_smfmac_f32_16x16x64_bf16 v[32:35], v[12:15], v[60:67], v74
  ds_read_b128 v[0:3], v76 offset:9728
  s_waitcnt lgkmcnt(0)
  v_smfmac_f32_16x16x64_bf16 v[20:23], v[0:3], v[160:167], v74
  v_smfmac_f32_16x16x64_bf16 v[24:27], v[0:3], v[168:175], v74
  ds_read_b128 v[60:63], v75 offset:24576
  ds_read_b128 v[64:67], v75 offset:25600
  s_waitcnt lgkmcnt(0)
  v_smfmac_f32_16x16x64_bf16 v[28:31], v[0:3], v[60:67], v74
  ds_read_b128 v[60:63], v75 offset:26624
  ds_read_b128 v[64:67], v75 offset:27648
  s_waitcnt lgkmcnt(0)
  v_smfmac_f32_16x16x64_bf16 v[32:35], v[0:3], v[60:67], v74
  ds_read_b128 v[16:19], v76 offset:10752
  ds_read_b128 v[60:63], v75 offset:8192
  ds_read_b128 v[64:67], v75 offset:9216
  s_waitcnt lgkmcnt(0)
  v_smfmac_f32_16x16x64_bf16 v[20:23], v[16:19], v[60:67], v74
  ds_read_b128 v[60:63], v75 offset:10240
  ds_read_b128 v[64:67], v75 offset:11264
  s_waitcnt lgkmcnt(0)
  v_smfmac_f32_16x16x64_bf16 v[24:27], v[16:19], v[60:67], v74
  v_smfmac_f32_16x16x64_bf16 v[28:31], v[16:19], v[240:247], v74
  v_smfmac_f32_16x16x64_bf16 v[32:35], v[16:19], v[248:255], v74
  ds_read_b128 v[4:7], v76 offset:11776
  s_waitcnt lgkmcnt(0)
  v_smfmac_f32_16x16x64_bf16 v[20:23], v[4:7], v[176:183], v74
  v_smfmac_f32_16x16x64_bf16 v[24:27], v[4:7], v[184:191], v74
  v_smfmac_f32_16x16x64_bf16 v[28:31], v[4:7], a[0:7], v74
  v_smfmac_f32_16x16x64_bf16 v[32:35], v[4:7], a[8:15], v74
  ds_read_b128 v[8:11], v76 offset:12800
  s_waitcnt lgkmcnt(0)
  v_smfmac_f32_16x16x64_bf16 v[20:23], v[8:11], v[192:199], v74
  v_smfmac_f32_16x16x64_bf16 v[24:27], v[8:11], v[200:207], v74
  v_smfmac_f32_16x16x64_bf16 v[28:31], v[8:11], a[16:23], v74
  v_smfmac_f32_16x16x64_bf16 v[32:35], v[8:11], a[24:31], v74
  v_add_f32 v20, v20, v22
  v_add_f32 v21, v21, v23
  v_add_f32 v24, v24, v26
  v_cvt_pk_bf16_f32 v22, v20, v24
  ds_write_b32 v79, v22 offset:0
  v_add_f32 v25, v25, v27
  v_cvt_pk_bf16_f32 v23, v21, v25
  ds_write_b32 v79, v23 offset:576
  v_add_f32 v28, v28, v30
  v_add_f32 v29, v29, v31
  s_waitcnt lgkmcnt(0)
  s_nop 1
  s_branch Cf2_recok
Cf2_mx:
  s_waitcnt lgkmcnt(0)
  s_barrier
  buffer_load_dwordx4 v[52:55], v76, s[8:11], s59 offen offset:0 sc1
  buffer_load_dwordx4 v[0:3], v76, s[8:11], s58 offen offset:0 sc1
  ds_read_b128 v[20:23], v77 offset:0
  ds_read_b128 v[28:31], v77 offset:256
  buffer_load_dwordx4 v[56:59], v76, s[8:11], s59 offen offset:1024 sc1
  buffer_load_dwordx4 v[4:7], v76, s[8:11], s58 offen offset:1024 sc1
  ds_read_b128 v[24:27], v77 offset:128
  ds_read_b128 v[32:35], v77 offset:384
  s_waitcnt vmcnt(2) lgkmcnt(3)
  v_mfma_f32_16x16x32_bf16 v[8:11], v[0:3], v[20:23], 0
  s_waitcnt vmcnt(0) lgkmcnt(1)
  v_mfma_f32_16x16x32_bf16 v[8:11], v[4:7], v[24:27], v[8:11]
  v_mfma_f32_16x16x32_bf16 v[12:15], v[28:31], v[20:23], 0
  s_waitcnt lgkmcnt(0)
  v_mfma_f32_16x16x32_bf16 v[12:15], v[32:35], v[24:27], v[12:15]
  v_add_f32_dpp v8, v10, v8 quad_perm:[2,3,0,1] row_mask:0xf bank_mask:0xf
  v_add_f32_dpp v9, v11, v9 quad_perm:[2,3,0,1] row_mask:0xf bank_mask:0xf
  s_nop 0
  v_mov_b32_dpp v8, v8 quad_perm:[0,1,0,1] row_mask:0xf bank_mask:0xf
  v_mov_b32_dpp v9, v9 quad_perm:[0,1,0,1] row_mask:0xf bank_mask:0xf
  s_nop 1
  v_add_f32_dpp v12, v14, v12 quad_perm:[2,3,0,1] row_mask:0xf bank_mask:0xf
  v_add_f32_dpp v13, v15, v13 quad_perm:[2,3,0,1] row_mask:0xf bank_mask:0xf
  s_nop 0
  v_mov_b32_dpp v12, v12 quad_perm:[0,1,0,1] row_mask:0xf bank_mask:0xf
  v_mov_b32_dpp v13, v13 quad_perm:[0,1,0,1] row_mask:0xf bank_mask:0xf
  v_mul_f32 v12, s69, v12
  ds_write_b32 v78, v8 offset:8712
  v_mul_f32 v13, s69, v13
  ds_write_b32 v78, v9 offset:8776
  s_waitcnt lgkmcnt(0)
  s_barrier
  ds_read_b128 v[36:39], v78 offset:8704
  ds_read_b128 v[40:43], v78 offset:8768
  s_waitcnt lgkmcnt(0)
  s_barrier
  v_max_f32 v16, v36, v37
  v_max3_f32 v16, v16, v38, v39
  v_max3_f32 v16, v16, v40, v41
  v_max3_f32 v16, v16, v42, v43
  v_max3_f32 v16, v16, v12, v13
  v_mov_b32 v17, v16
  s_nop 1
  v_permlane16_swap_b32 v16, v17
  v_max_f32 v16, v16, v17
  v_mov_b32 v17, v16
  s_nop 1
  v_permlane32_swap_b32 v16, v17
  v_max_f32 v16, v16, v17
  v_sub_f32 v36, v36, v16
  v_sub_f32 v37, v37, v16
  v_sub_f32 v38, v38, v16
  v_sub_f32 v39, v39, v16
  v_sub_f32 v40, v40, v16
  v_sub_f32 v41, v41, v16
  v_sub_f32 v42, v42, v16
  v_sub_f32 v43, v43, v16
  v_sub_f32 v12, v12, v16
  v_sub_f32 v13, v13, v16
  v_exp_f32 v36, v36
  v_exp_f32 v37, v37
  v_exp_f32 v38, v38
  v_exp_f32 v39, v39
  v_exp_f32 v40, v40
  v_exp_f32 v41, v41
  v_exp_f32 v42, v42
  v_exp_f32 v43, v43
  v_exp_f32 v12, v12
  v_exp_f32 v13, v13
  v_cvt_pk_bf16_f32 v32, v36, v40
  v_cvt_pk_bf16_f32 v33, v37, v41
  v_cvt_pk_bf16_f32 v34, v38, v42
  v_cvt_pk_bf16_f32 v35, v39, v43
  v_cvt_pk_bf16_f32 v28, v12, v13
  v_cvt_pk_bf16_f32 v31, v12, v13
  v_mov_b32 v29, 0
  v_mov_b32 v30, 0
  v_mfma_f32_16x16x32_bf16 v[8:11], v[32:35], v[68:71], 0
  v_mfma_f32_16x16x32_bf16 v[0:3], v[32:35], v[52:55], 0
  v_mfma_f32_16x16x32_bf16 v[4:7], v[32:35], v[56:59], 0
  v_mfma_f32_16x16x16_bf16 v[8:11], v[28:29], v[68:69], v[8:11]
  v_mfma_f32_16x16x16_bf16 v[0:3], v[28:29], v[72:73], v[0:3]
  v_mfma_f32_16x16x16_bf16 v[4:7], v[30:31], v[72:73], v[4:7]
  ds_read_b128 v[52:55], v75 offset:26624
  v_rcp_f32 v10, v8
  v_rcp_f32 v11, v9
  v_mul_f32 v0, v10, v0
  v_mul_f32 v1, v11, v1
  v_max3_f32 v8, v8, v9, v10
  v_mul_f32 v4, v10, v4
  v_mul_f32 v5, v11, v5
  v_cvt_pk_bf16_f32 v2, v0, v4
  ds_write_b32 v79, v2 offset:8704
  v_cvt_pk_bf16_f32 v3, v1, v5
  ds_write_b32 v79, v3 offset:9280
  ds_read_b128 v[12:15], v78 offset:8832
  ds_read_b128 v[56:59], v75 offset:27648
  v_mov_b64 v[16:17], 0
  v_mov_b64 v[18:19], 0
  v_mov_b64 v[20:21], 0
  v_mov_b64 v[22:23], 0
  v_mov_b64 v[24:25], 0
  v_mov_b64 v[26:27], 0
  s_branch Cf2_mxok
Cf2_last:
  ds_read_b128 v[4:7], v76 offset:5632
  ds_read_b128 v[8:11], v76 offset:6656
  ds_read_b128 v[44:47], v76 offset:40960
  ds_read_b128 v[48:51], v76 offset:41984
  s_nop 5
  v_mov_b64 v[20:21], 0
  v_mov_b64 v[22:23], 0
  v_mov_b64 v[24:25], 0
  v_mov_b64 v[26:27], 0
  s_waitcnt lgkmcnt(4)
  v_smfmac_f32_16x16x64_bf16 v[28:31], v[0:3], v[36:43], v74
  ds_read_b128 v[36:39], v76 offset:43008
  ds_read_b128 v[40:43], v76 offset:44032
  v_smfmac_f32_16x16x64_bf16 v[32:35], v[0:3], v[60:67], v74
  s_waitcnt lgkmcnt(5)
  v_smfmac_f32_16x16x64_bf16 v[20:23], v[0:3], a[32:39], v74
  ds_read_b128 v[60:63], v76 offset:57344
  ds_read_b128 v[64:67], v76 offset:58368
  v_smfmac_f32_16x16x64_bf16 v[24:27], v[0:3], a[40:47], v74
  s_waitcnt lgkmcnt(4)
  v_smfmac_f32_16x16x64_bf16 v[20:23], v[4:7], a[48:55], v74
  buffer_store_dwordx4 v[16:19], v76, s[8:11], s68 offen sc1
  v_smfmac_f32_16x16x64_bf16 v[24:27], v[4:7], a[56:63], v74
  v_smfmac_f32_16x16x64_bf16 v[28:31], v[4:7], v[44:51], v74
  s_waitcnt lgkmcnt(2)
  v_smfmac_f32_16x16x64_bf16 v[20:23], v[8:11], a[64:71], v74
  ds_read_b128 v[44:47], v76 offset:59392
  ds_read_b128 v[48:51], v76 offset:60416
  v_smfmac_f32_16x16x64_bf16 v[24:27], v[8:11], a[72:79], v74
  v_smfmac_f32_16x16x64_bf16 v[32:35], v[4:7], v[36:43], v74
  v_smfmac_f32_16x16x64_bf16 v[28:31], v[8:11], v[208:215], v74
  ds_read_b128 v[36:39], v75 offset:24576
  ds_read_b128 v[40:43], v75 offset:25600
  v_smfmac_f32_16x16x64_bf16 v[32:35], v[8:11], v[216:223], v74
  v_smfmac_f32_16x16x64_bf16 v[20:23], v[12:15], a[80:87], v74
  v_smfmac_f32_16x16x64_bf16 v[24:27], v[12:15], a[88:95], v74
  v_smfmac_f32_16x16x64_bf16 v[28:31], v[12:15], v[224:231], v74
  v_smfmac_f32_16x16x64_bf16 v[32:35], v[12:15], v[232:239], v74
  s_waitcnt vmcnt(2)
  s_waitcnt vmcnt(1)
  s_barrier
Cf2_lastr:
  ds_read_b128 v[12:15], v76 offset:8704
  ds_read_b128 v[0:3], v76 offset:9728
  ds_read_b128 v[16:19], v76 offset:10752
  ds_read_b128 v[4:7], v76 offset:11776
  ds_read_b128 v[8:11], v76 offset:12800
  s_waitcnt lgkmcnt(3)
  v_max3_u32 v72, v0, v1, v2
  s_waitcnt lgkmcnt(1)
  v_max3_u32 v72, v72, v3, v4
  v_max3_u32 v72, v72, v5, v6
  s_waitcnt lgkmcnt(0)
  v_max3_u32 v72, v72, v7, v8
  v_max3_u32 v72, v72, v9, v10
  v_max3_u32 v72, v72, v11, v12
  v_max3_u32 v72, v72, v13, v14
  v_max3_u32 v72, v72, v15, v16
  v_max3_u32 v72, v72, v17, v18
  v_max_u32 v72, v72, v19
  v_cmp_eq_u32 vcc, -1, v72
  s_cbranch_vccnz Cf2_lastp
Cf2_lastg:
  v_smfmac_f32_16x16x64_bf16 v[28:31], v[12:15], v[60:67], v74
  ds_read_b128 v[60:63], v75 offset:26624
  ds_read_b128 v[64:67], v75 offset:27648
  v_smfmac_f32_16x16x64_bf16 v[32:35], v[12:15], v[44:51], v74
  v_smfmac_f32_16x16x64_bf16 v[28:31], v[0:3], v[36:43], v74
  v_smfmac_f32_16x16x64_bf16 v[28:31], v[16:19], v[240:247], v74
  v_smfmac_f32_16x16x64_bf16 v[28:31], v[4:7], a[0:7], v74
  v_smfmac_f32_16x16x64_bf16 v[28:31], v[8:11], a[16:23], v74
  v_smfmac_f32_16x16x64_bf16 v[32:35], v[16:19], v[248:255], v74
  v_smfmac_f32_16x16x64_bf16 v[32:35], v[4:7], a[8:15], v74
  s_waitcnt lgkmcnt(0)
  v_smfmac_f32_16x16x64_bf16 v[32:35], v[8:11], a[24:31], v74
  v_smfmac_f32_16x16x64_bf16 v[32:35], v[0:3], v[60:67], v74
  v_smfmac_f32_16x16x64_bf16 v[20:23], v[12:15], a[96:103], v74
  v_smfmac_f32_16x16x64_bf16 v[20:23], v[0:3], a[112:119], v74
  v_add_f32 v28, v28, v30
  v_add_f32 v32, v32, v34
  v_cvt_pk_bf16_f32 v30, v28, v32
  v_smfmac_f32_16x16x64_bf16 v[20:23], v[16:19], a[128:135], v74
  ds_write_b32 v79, v30 offset:256
  v_add_f32 v29, v29, v31
  v_add_f32 v33, v33, v35
  v_cvt_pk_bf16_f32 v31, v29, v33
  v_smfmac_f32_16x16x64_bf16 v[20:23], v[4:7], a[144:151], v74
  ds_write_b32 v79, v31 offset:832
  v_smfmac_f32_16x16x64_bf16 v[20:23], v[8:11], a[160:167], v74
  v_smfmac_f32_16x16x64_bf16 v[24:27], v[12:15], a[104:111], v74
  v_smfmac_f32_16x16x64_bf16 v[24:27], v[0:3], a[120:127], v74
  v_smfmac_f32_16x16x64_bf16 v[24:27], v[16:19], a[136:143], v74
  s_waitcnt lgkmcnt(0)
  s_barrier
  ds_read_b64 v[52:53], v77 offset:384
  v_add_f32 v20, v20, v22
  v_smfmac_f32_16x16x64_bf16 v[24:27], v[4:7], a[152:159], v74
  v_add_f32 v21, v21, v23
  v_smfmac_f32_16x16x64_bf16 v[24:27], v[8:11], a[168:175], v74
  v_cvt_pk_bf16_f32 v54, v20, v21
  s_add_u32 s68, s68, 655360
  s_nop 3
  v_add_f32 v24, v24, v26
  v_add_f32 v25, v25, v27
  v_cvt_pk_bf16_f32 v55, v24, v25
  s_waitcnt lgkmcnt(0)
  buffer_store_dwordx4 v[52:55], v76, s[8:11], s68 offen sc1
  s_branch Cf2_done
Cf2_lastp:
  s_add_u32 s72, s72, 2
  s_cmp_ge_u32 s72, 131072
  s_cbranch_scc1 Cf2_lastg
  s_barrier
  buffer_load_dwordx4 v76, s[8:11], s85 offen offset:0 sc1 lds
  s_waitcnt vmcnt(0)
  s_barrier
  s_branch Cf2_lastr
Cf2_done:
  s_branch L_cexit
L_w3:
  v_mov_b64 v[20:21], 0
  v_mov_b64 v[22:23], 0
  v_mov_b64 v[24:25], 0
  v_mov_b64 v[26:27], 0
  v_mov_b64 v[28:29], 0
  v_mov_b64 v[30:31], 0
  v_mov_b64 v[32:33], 0
  v_mov_b64 v[34:35], 0
  s_mov_b32 s78, 0x3f803f80
  s_mov_b32 s79, s78
  s_mov_b32 s65, 360448
  s_mov_b32 m0, 15872
  s_lshl_b32 s71, s53, 2
  s_add_u32 s71, s71, 128
  s_movk_i32 s56, 0x1000
  v_lshlrev_b32 v73, 2, v76
  v_mov_b32 v72, 0
  s_mov_b64 s[16:17], s[8:9]
  s_mov_b32 s18, 268435456
  s_mov_b32 s19, 0x20000
  s_getpc_b64 s[20:21]
Cf3_pc:
  s_add_u32 s20, s20, (Cf3_last - Cf3_pc)
  s_addc_u32 s21, s21, 0
  v_mov_b32 v68, 14880
  buffer_load_dwordx4 v[52:55], v76, s[8:11], s59 offen offset:0 sc1
  buffer_load_dwordx4 v[56:59], v76, s[8:11], s59 offen offset:1024 sc1
  ds_read_b128 v[36:39], v76 offset:45056
  ds_read_b128 v[40:43], v76 offset:46080
  ds_read_b128 v[60:63], v76 offset:47104
  ds_read_b128 v[64:67], v76 offset:48128
  ds_read_b128 v[0:3], v76 offset:4608
  ds_read_b128 v[4:7], v76 offset:5632
  ds_read_b128 v[8:11], v76 offset:6656
  ds_read_b128 v[12:15], v76 offset:7680
  s_waitcnt lgkmcnt(0)
  s_cmp_eq_u32 s66, 1
  s_branch Cf3_top2
.p2align 6
Cf3_h2:
  v_lshlrev_b32 v73, 2, v76
  buffer_load_dwordx4 v[4:7], v76, s[8:11], s65 offen offset:1024 sc1
  ds_read_b128 v[36:39], v76 offset:45056
  ds_read_b128 v[40:43], v76 offset:46080
  buffer_load_dwordx4 v[52:55], v76, s[8:11], s59 offen offset:0 sc1
  buffer_load_dwordx4 v[56:59], v76, s[8:11], s59 offen offset:1024 sc1
  s_waitcnt vmcnt(7)
  v_max3_u32 v72, v4, v5, v6
  v_max_u32 v72, v72, v7
  ds_write_b128 v76, v[4:7] offset:5632
  v_cmp_eq_u32 vcc, -1, v72
  s_cbranch_vccnz Cf3_h2r
Cf3_h2w:
  buffer_load_dwordx4 v76, s[8:11], s85 offen offset:0 sc1 lds
  buffer_load_dwordx4 v76, s[8:11], s85 offen offset:1024 sc1 lds
  s_cmp_eq_u32 s66, 63
  s_waitcnt lgkmcnt(0)
  s_barrier
  ds_read_b128 v[8:11], v76 offset:6656
Cf3_top2:
  v_smfmac_f32_16x16x64_bf16 v[20:23], v[4:7], v[96:103], v74
  s_cbranch_scc1 Cf3_last
  v_smfmac_f32_16x16x64_bf16 v[28:31], v[4:7], v[36:43], v74
  buffer_load_dwordx4 v[44:47], v76, s[8:11], s58 offen offset:0 sc1
  s_mov_b32 m0, 15872
  v_smfmac_f32_16x16x64_bf16 v[24:27], v[4:7], v[104:111], v74
  buffer_load_dwordx4 v[48:51], v76, s[8:11], s58 offen offset:1024 sc1
  v_smfmac_f32_16x16x64_bf16 v[32:35], v[4:7], v[60:67], v74
  ds_read_b128 v[0:3], v76 offset:4608
  s_waitcnt lgkmcnt(1)
  v_smfmac_f32_16x16x64_bf16 v[20:23], v[8:11], v[112:119], v74
  ds_read_b128 v[12:15], v76 offset:7680
  v_smfmac_f32_16x16x64_bf16 v[24:27], v[8:11], v[120:127], v74
  ds_read_b128 v[36:39], v76 offset:28672
  v_smfmac_f32_16x16x64_bf16 v[28:31], v[8:11], v[208:215], v74
  buffer_store_dwordx4 v[16:19], v76, s[8:11], s68 offen sc1
  ds_read_b128 v[40:43], v76 offset:29696
  v_smfmac_f32_16x16x64_bf16 v[32:35], v[8:11], v[216:223], v74
  buffer_load_dword v73, s[16:19], s70 offen lds
  ds_read_b128 v[60:63], v76 offset:30720
  s_waitcnt lgkmcnt(4)
  v_smfmac_f32_16x16x64_bf16 v[20:23], v[0:3], v[80:87], v74
  ds_read_b128 v[64:67], v76 offset:31744
  v_smfmac_f32_16x16x64_bf16 v[24:27], v[0:3], v[88:95], v74
  s_waitcnt vmcnt(4)
  s_waitcnt lgkmcnt(4)
  v_smfmac_f32_16x16x64_bf16 v[20:23], v[12:15], v[128:135], v74
  s_barrier
  ds_read_b128 v[4:7], v76 offset:8704
  s_waitcnt lgkmcnt(3)
  v_smfmac_f32_16x16x64_bf16 v[28:31], v[0:3], v[36:43], v74
  ds_read_b128 v[36:39], v76 offset:61440
  v_smfmac_f32_16x16x64_bf16 v[24:27], v[12:15], v[136:143], v74
  ds_read_b128 v[40:43], v76 offset:62464
  s_waitcnt lgkmcnt(3)
  v_smfmac_f32_16x16x64_bf16 v[32:35], v[0:3], v[60:67], v74
  ds_read_b128 v[8:11], v76 offset:9728
  v_smfmac_f32_16x16x64_bf16 v[28:31], v[12:15], v[224:231], v74
  ds_read_b128 v[60:63], v76 offset:63488
  v_smfmac_f32_16x16x64_bf16 v[32:35], v[12:15], v[232:239], v74
  ds_read_b128 v[64:67], v76 offset:64512
  s_waitcnt lgkmcnt(5)
  v_smfmac_f32_16x16x64_bf16 v[20:23], v[4:7], v[144:151], v74
  s_barrier
  ds_read_b128 v[0:3], v76 offset:11776
  s_waitcnt lgkmcnt(4)
  v_smfmac_f32_16x16x64_bf16 v[28:31], v[4:7], v[36:43], v74
  ds_read_b128 v[12:15], v76 offset:12800
  ds_read_b128 v[36:39], v75 offset:12288
  v_smfmac_f32_16x16x64_bf16 v[24:27], v[4:7], v[152:159], v74
  ds_read_b128 v[16:19], v76 offset:10752
  s_waitcnt lgkmcnt(6)
  v_smfmac_f32_16x16x64_bf16 v[20:23], v[8:11], v[160:167], v74
  ds_read_b128 v[40:43], v75 offset:13312
  s_waitcnt lgkmcnt(5)
  v_smfmac_f32_16x16x64_bf16 v[32:35], v[4:7], v[60:67], v74
  ds_read_b128 v[60:63], v75 offset:14336
  v_smfmac_f32_16x16x64_bf16 v[24:27], v[8:11], v[168:175], v74
  ds_read_b128 v[64:67], v75 offset:15360
  s_waitcnt lgkmcnt(6)
  v_smfmac_f32_16x16x64_bf16 v[20:23], v[0:3], v[176:183], v74
  s_waitcnt lgkmcnt(5)
  v_smfmac_f32_16x16x64_bf16 v[20:23], v[12:15], v[192:199], v74
  s_waitcnt lgkmcnt(2)
  v_smfmac_f32_16x16x64_bf16 v[20:23], v[16:19], v[36:43], v74
  ds_read_b128 v[36:39], v75 offset:28672
  v_smfmac_f32_16x16x64_bf16 v[24:27], v[0:3], v[184:191], v74
  ds_read_b128 v[40:43], v75 offset:29696
  s_waitcnt lgkmcnt(2)
  v_smfmac_f32_16x16x64_bf16 v[24:27], v[16:19], v[60:67], v74
  ds_read_b128 v[60:63], v75 offset:30720
  v_add_f32 v20, v20, v22
  v_smfmac_f32_16x16x64_bf16 v[24:27], v[12:15], v[200:207], v74
  ds_read_b128 v[64:67], v75 offset:31744
  v_add_f32 v21, v21, v23
  v_smfmac_f32_16x16x64_bf16 v[28:31], v[16:19], v[240:247], v74
  v_mov_b64 v[70:71], s[78:79]
  v_smfmac_f32_16x16x64_bf16 v[28:31], v[0:3], a[0:7], v74
  s_waitcnt lgkmcnt(2)
  v_add_f32 v24, v24, v26
  v_smfmac_f32_16x16x64_bf16 v[28:31], v[8:11], v[36:43], v74
  ds_read_b128 v[36:39], v68
  v_cvt_pk_bf16_f32 v22, v20, v24
  v_smfmac_f32_16x16x64_bf16 v[28:31], v[12:15], a[16:23], v74
  ds_read_b128 v[40:43], v68
  ds_write_b32 v79, v22 offset:0
  s_waitcnt lgkmcnt(3)
  v_add_f32 v25, v25, v27
  v_cvt_pk_bf16_f32 v23, v21, v25
  v_smfmac_f32_16x16x64_bf16 v[32:35], v[8:11], v[60:67], v74
  ds_write_b32 v79, v23 offset:576
  v_cmp_u_f32 vcc, v20, v21
  v_smfmac_f32_16x16x64_bf16 v[32:35], v[16:19], v[248:255], v74
  v_add_f32 v28, v28, v30
  v_smfmac_f32_16x16x64_bf16 v[32:35], v[0:3], a[8:15], v74
  v_add_f32 v29, v29, v31
  v_smfmac_f32_16x16x64_bf16 v[32:35], v[12:15], a[24:31], v74
  s_cbranch_vccnz Cf3_rec
Cf3_recok:
  s_waitcnt lgkmcnt(3)
  v_smfmac_f32_16x16x64_bf16 v[36:39], v[16:19], a[128:135], v74
  s_waitcnt lgkmcnt(0)
  s_barrier
  ds_read_b128 v[60:63], v77
  v_smfmac_f32_16x16x64_bf16 v[40:43], v[16:19], a[136:143], v74
  ds_read_b128 v[64:67], v77 offset:128
  v_add_f32 v32, v32, v34
  v_cvt_pk_bf16_f32 v30, v28, v32
  v_smfmac_f32_16x16x64_bf16 v[36:39], v[0:3], a[144:151], v74
  ds_write_b32 v79, v30 offset:256
  v_add_f32 v33, v33, v35
  v_cvt_pk_bf16_f32 v31, v29, v33
  v_smfmac_f32_16x16x64_bf16 v[40:43], v[0:3], a[152:159], v74
  ds_write_b32 v79, v31 offset:832
  v_xor_b32 v75, 0x8000, v75
  v_smfmac_f32_16x16x64_bf16 v[36:39], v[4:7], a[96:103], v74
  ds_read_b128 v[0:3], v76 offset:4608
  v_mov_b32 v29, 0
  v_smfmac_f32_16x16x64_bf16 v[40:43], v[4:7], a[104:111], v74
  s_waitcnt vmcnt(2) lgkmcnt(3)
  v_mov_b32 v30, 0
  v_mfma_f32_16x16x32_bf16 v[44:47], v[44:47], v[60:63], 0
  ds_read_b128 v[4:7], v76 offset:5632
  s_waitcnt lgkmcnt(2)
  v_mfma_f32_16x16x32_bf16 v[44:47], v[48:51], v[64:67], v[44:47]
  s_barrier
  v_smfmac_f32_16x16x64_bf16 v[36:39], v[8:11], a[112:119], v74
  ds_read_b128 v[20:23], v77 offset:256
  ds_read_b128 v[24:27], v77 offset:384
  v_smfmac_f32_16x16x64_bf16 v[40:43], v[8:11], a[120:127], v74
  ds_read_b128 v[8:11], v76 offset:6656
  v_add_f32_dpp v72, v46, v44 quad_perm:[2,3,0,1] row_mask:0xf bank_mask:0xf
  v_add_f32_dpp v73, v47, v45 quad_perm:[2,3,0,1] row_mask:0xf bank_mask:0xf
  v_smfmac_f32_16x16x64_bf16 v[36:39], v[12:15], a[160:167], v74
  s_waitcnt lgkmcnt(4)
  v_exp_f32_dpp v72, v72 quad_perm:[0,1,0,1] row_mask:0xf bank_mask:0xf
  v_smfmac_f32_16x16x64_bf16 v[40:43], v[12:15], a[168:175], v74
  ds_read_b128 v[12:15], v76 offset:7680
  v_exp_f32_dpp v73, v73 quad_perm:[0,1,0,1] row_mask:0xf bank_mask:0xf
  v_smfmac_f32_16x16x64_bf16 v[36:39], v[0:3], a[32:39], v74
  s_waitcnt lgkmcnt(2)
  v_cvt_pk_bf16_f32 v72, v72, v73
  v_mfma_f32_16x16x32_bf16 v[20:23], v[20:23], v[60:63], 0
  ds_write_b32 v78, v72 offset:524
  v_mov_b64 v[16:17], 0
  v_mfma_f32_16x16x32_bf16 v[20:23], v[24:27], v[64:67], v[20:23]
  ds_read_b128 v[44:47], v75 offset:47104
  v_mov_b64 v[18:19], 0
  v_smfmac_f32_16x16x64_bf16 v[40:43], v[0:3], a[40:47], v74
  ds_read_b128 v[48:51], v75 offset:48128
  v_mov_b64 v[68:69], s[78:79]
  v_smfmac_f32_16x16x64_bf16 v[36:39], v[4:7], a[48:55], v74
  s_waitcnt lgkmcnt(4)
  v_add_f32_dpp v24, v22, v20 quad_perm:[2,3,0,1] row_mask:0xf bank_mask:0xf
  v_add_f32_dpp v25, v23, v21 quad_perm:[2,3,0,1] row_mask:0xf bank_mask:0xf
  v_smfmac_f32_16x16x64_bf16 v[36:39], v[8:11], a[64:71], v74
  s_waitcnt lgkmcnt(2)
  s_barrier
  ds_read_b128 v[32:35], v78 offset:512
  v_smfmac_f32_16x16x64_bf16 v[36:39], v[12:15], a[80:87], v74
  ds_read_b128 v[60:63], v75 offset:28672
  v_mul_f32 v24, s69, v24
  v_smfmac_f32_16x16x64_bf16 v[40:43], v[4:7], a[56:63], v74
  ds_read_b128 v[64:67], v75 offset:29696
  v_mul_f32 v25, s69, v25
  v_smfmac_f32_16x16x64_bf16 v[40:43], v[8:11], a[72:79], v74
  v_exp_f32_dpp v24, v24 quad_perm:[0,1,0,1] row_mask:0xf bank_mask:0xf
  v_smfmac_f32_16x16x64_bf16 v[40:43], v[12:15], a[88:95], v74
  s_waitcnt lgkmcnt(2)
  v_exp_f32_dpp v25, v25 quad_perm:[0,1,0,1] row_mask:0xf bank_mask:0xf
  v_mfma_f32_16x16x32_bf16 v[8:11], v[32:35], v[68:71], 0
  v_add_f32 v36, v36, v38
  v_add_f32 v37, v37, v39
  v_mfma_f32_16x16x32_bf16 v[0:3], v[32:35], v[52:55], 0
  v_add_f32 v40, v40, v42
  v_add_f32 v41, v41, v43
  v_mfma_f32_16x16x32_bf16 v[4:7], v[32:35], v[56:59], 0
  v_cvt_pk_bf16_f32 v28, v24, v25
  v_cvt_pk_bf16_f32 v72, v36, v37
  v_cvt_pk_bf16_f32 v73, v40, v41
  v_mfma_f32_16x16x16_bf16 v[8:11], v[28:29], v[68:69], v[8:11]
  v_cvt_pk_bf16_f32 v31, v24, v25
  v_mov_b64 v[20:21], 0
  v_mfma_f32_16x16x16_bf16 v[0:3], v[28:29], v[72:73], v[0:3]
  ds_read_b128 v[52:55], v75 offset:30720
  v_mov_b64 v[22:23], 0
  v_mfma_f32_16x16x16_bf16 v[4:7], v[30:31], v[72:73], v[4:7]
  v_rcp_f32 v10, v8
  v_rcp_f32 v11, v9
  v_mul_f32 v0, v10, v0
  v_mul_f32 v1, v11, v1
  v_max3_f32 v8, v8, v9, v10
  v_mul_f32 v4, v10, v4
  v_mul_f32 v5, v11, v5
  v_cvt_pk_bf16_f32 v2, v0, v4
  ds_write_b32 v79, v2 offset:8704
  v_cvt_pk_bf16_f32 v3, v1, v5
  ds_write_b32 v79, v3 offset:9280
  ds_read_b128 v[12:15], v78 offset:8896
  v_max_f32 v8, v8, v11
  v_cmp_le_f32 vcc, 1317011456, v8
  v_mov_b64 v[24:25], 0
  v_mov_b64 v[26:27], 0
  ds_read_b128 v[56:59], v75 offset:31744
  s_cbranch_vccnz Cf3_mx
Cf3_mxok:
  s_waitcnt lgkmcnt(2)
  s_barrier
  ds_read_b128 v[0:3], v78 offset:8832
  s_waitcnt lgkmcnt(2)
  v_smfmac_f32_16x16x64_bf16 v[16:19], v[12:15], a[184:191], v74
  ds_read_b128 v[4:7], v78 offset:8704
  v_smfmac_f32_16x16x64_bf16 v[20:23], v[12:15], v[44:51], v74
  ds_read_b128 v[8:11], v78 offset:8768
  v_smfmac_f32_16x16x64_bf16 v[24:27], v[12:15], a[232:239], v74
  ds_read_b128 v[36:39], v75 offset:45056
  s_waitcnt lgkmcnt(3)
  v_smfmac_f32_16x16x64_bf16 v[16:19], v[0:3], a[176:183], v74
  ds_read_b128 v[40:43], v75 offset:46080
  s_waitcnt lgkmcnt(3)
  v_smfmac_f32_16x16x64_bf16 v[16:19], v[4:7], v[60:67], v74
  ds_read_b128 v[68:71], v76 offset:13824
  s_waitcnt lgkmcnt(3)
  v_smfmac_f32_16x16x64_bf16 v[16:19], v[8:11], v[52:59], v74
  ds_read_b128 v[44:47], v75 offset:61440
  v_smfmac_f32_16x16x64_bf16 v[20:23], v[4:7], a[192:199], v74
  ds_read_b128 v[48:51], v75 offset:62464
  v_smfmac_f32_16x16x64_bf16 v[20:23], v[8:11], a[200:207], v74
  ds_read_b128 v[60:63], v75 offset:63488
  s_waitcnt lgkmcnt(4)
  v_cvt_pk_bf16_f32 v16, v16, v17
  v_cvt_pk_bf16_f32 v17, v18, v19
  v_bfi_b32 v16, 1, s72, v16
  v_smfmac_f32_16x16x64_bf16 v[20:23], v[0:3], v[36:43], v74
  s_waitcnt lgkmcnt(3)
  buffer_store_dwordx2 v[16:17], v68, s[8:11], s73 offen
  v_mov_b64 v[32:33], 0
  v_smfmac_f32_16x16x64_bf16 v[24:27], v[4:7], a[208:215], v74
  ds_read_b128 v[64:67], v75 offset:64512
  v_mov_b64 v[34:35], 0
  v_smfmac_f32_16x16x64_bf16 v[24:27], v[8:11], a[216:223], v74
  ds_read_b128 v[52:55], v75 offset:8192
  v_cvt_pk_bf16_f32 v20, v20, v21
  v_cvt_pk_bf16_f32 v21, v22, v23
  v_bfi_b32 v20, 1, s72, v20
  v_smfmac_f32_16x16x64_bf16 v[24:27], v[0:3], a[224:231], v74
  ds_read_b128 v[56:59], v75 offset:9216
  buffer_store_dwordx2 v[20:21], v68, s[8:11], s74 offen
  s_waitcnt lgkmcnt(4)
  v_mov_b64 v[28:29], 0
  v_smfmac_f32_16x16x64_bf16 v[32:35], v[4:7], v[44:51], v74
  ds_read_b128 v[36:39], v75 offset:10240
  ds_read_b128 v[40:43], v75 offset:11264
  s_waitcnt lgkmcnt(4)
  v_smfmac_f32_16x16x64_bf16 v[32:35], v[8:11], v[60:67], v74
  ds_read_b128 v[44:47], v75 offset:12288
  v_cvt_pk_bf16_f32 v24, v24, v25
  v_cvt_pk_bf16_f32 v25, v26, v27
  v_bfi_b32 v24, 1, s72, v24
  v_smfmac_f32_16x16x64_bf16 v[32:35], v[0:3], a[240:247], v74
  ds_read_b128 v[48:51], v75 offset:13312
  buffer_store_dwordx2 v[24:25], v68, s[8:11], s75 offen
  v_mov_b64 v[30:31], 0
  v_smfmac_f32_16x16x64_bf16 v[32:35], v[12:15], a[248:255], v74
  ds_read_b128 v[60:63], v75 offset:14336
  ds_read_b128 v[64:67], v75 offset:15360
  s_waitcnt lgkmcnt(6)
  v_smfmac_f32_16x16x64_bf16 v[28:31], v[4:7], v[52:59], v74
  s_waitcnt lgkmcnt(4)
  v_smfmac_f32_16x16x64_bf16 v[28:31], v[8:11], v[36:43], v74
  s_waitcnt lgkmcnt(2)
  v_cvt_pk_bf16_f32 v32, v32, v33
  v_cvt_pk_bf16_f32 v33, v34, v35
  v_bfi_b32 v32, 1, s72, v32
  v_smfmac_f32_16x16x64_bf16 v[28:31], v[0:3], v[44:51], v74
  buffer_store_dwordx2 v[32:33], v68, s[8:11], s76 offen
  s_waitcnt lgkmcnt(0)
  v_smfmac_f32_16x16x64_bf16 v[28:31], v[12:15], v[60:67], v74
  v_mov_b64 v[18:19], v[72:73]
  s_nop 4
  v_cvt_pk_bf16_f32 v28, v28, v29
  v_cvt_pk_bf16_f32 v29, v30, v31
  v_bfi_b32 v28, 1, s72, v28
  buffer_store_dwordx2 v[28:29], v68, s[8:11], s77 offen
  ds_read_b128 v[52:55], v76 offset:14848
  s_waitcnt lgkmcnt(0)
  ds_read_b64 v[16:17], v77 offset:392
  s_waitcnt lgkmcnt(0)
  ds_read_b128 v[60:63], v76 offset:47104
  s_waitcnt lgkmcnt(0)
  ds_read_b128 v[64:67], v76 offset:48128
  s_waitcnt lgkmcnt(0)
  s_add_u32 s66, s66, 1
  s_xor_b32 s64, s64, 16384
  s_xor_b32 s65, s65, 16384
  s_add_u32 s58, s58, 655360
  s_add_u32 s59, s59, 655360
  s_add_u32 s70, s70, 655360
  s_add_u32 s68, s68, 655360
  s_mov_b32 m0, 8704
  s_add_u32 s85, s65, 4096
  v_xor_b32 v75, 0x8000, v75
  v_mov_b64 v[28:29], 0
  v_mov_b64 v[30:31], 0
  v_mov_b64 v[32:33], 0
  v_mov_b64 v[34:35], 0
  buffer_load_dwordx4 v[0:3], v76, s[8:11], s60 offen offset:0 sc1
  buffer_load_dwordx4 v[4:7], v76, s[8:11], s60 offen offset:1024 sc1
  buffer_load_dwordx4 v[8:11], v76, s[8:11], s61 offen offset:0 sc1
  buffer_load_dwordx4 v[12:15], v76, s[8:11], s61 offen offset:1024 sc1
  v_mov_b64 v[20:21], 0
  v_mov_b64 v[22:23], 0
  v_mov_b64 v[24:25], 0
  v_mov_b64 v[26:27], 0
  v_mov_b32 v68, 14880
  s_cmp_eq_u32 s66, 62
  s_cselect_b64 s[16:17], s[20:21], s[16:17]
  s_cselect_b32 s18, (Cf3_done - Cf3_last), s18
  s_cselect_b32 s70, 0, s70
  s_cmp_eq_u32 s66, 63
  s_cselect_b32 s59, 268435456, s59
  s_cselect_b32 s58, 268435456, s58
  s_waitcnt lgkmcnt(0)
  s_waitcnt vmcnt(3)
  v_mfma_f32_16x16x32_bf16 v[56:59], v[52:55], v[0:3], 0
  v_bitop3_b32 v72, v0, v2, s72 bitop3:0x7e
  s_waitcnt vmcnt(2)
  v_mfma_f32_16x16x32_bf16 v[56:59], v[52:55], v[4:7], v[56:59]
  v_bitop3_b32 v73, v4, v6, s72 bitop3:0x7e
  v_or_b32 v72, v72, v73
  s_waitcnt vmcnt(1)
  v_mfma_f32_16x16x32_bf16 v[36:39], v[52:55], v[8:11], 0
  v_bitop3_b32 v73, v8, v10, s72 bitop3:0x7e
  v_or_b32 v72, v72, v73
  s_waitcnt vmcnt(0)
  v_mfma_f32_16x16x32_bf16 v[36:39], v[52:55], v[12:15], v[36:39]
  v_bitop3_b32 v73, v12, v14, s72 bitop3:0x7e
  v_bitop3_b32 v72, v72, v73, 1 bitop3:0xa8
  v_cmp_ne_u32 vcc, 0, v72
  s_cbranch_vccnz Cf3_h1r
  buffer_load_dwordx4 v[4:7], v76, s[8:11], s65 offen offset:1024 sc1
  v_add_f32_dpp v56, v56, v56 row_ror:4 row_mask:0xf bank_mask:0xf
  v_add_f32_dpp v57, v57, v57 row_ror:4 row_mask:0xf bank_mask:0xf
  v_add_f32_dpp v36, v36, v36 row_ror:4 row_mask:0xf bank_mask:0xf
  v_add_f32_dpp v37, v37, v37 row_ror:4 row_mask:0xf bank_mask:0xf
  v_add_f32_dpp v56, v56, v56 row_ror:8 row_mask:0xf bank_mask:0xf
  v_add_f32_dpp v57, v57, v57 row_ror:8 row_mask:0xf bank_mask:0xf
  v_add_f32_dpp v36, v36, v36 row_ror:8 row_mask:0xf bank_mask:0xf
  v_add_f32_dpp v37, v37, v37 row_ror:8 row_mask:0xf bank_mask:0xf
  v_cvt_pk_bf16_f32 v56, v56, v57
  buffer_store_dword v56, v69, s[8:11], s62 offen
  v_cvt_pk_bf16_f32 v36, v36, v37
  buffer_store_dword v36, v70, s[8:11], s63 offen
  s_xor_b32 s62, s62, 16384
  buffer_store_dword v71, v69, s[8:11], s62 offen
  s_xor_b32 s63, s63, 16384
  buffer_store_dword v71, v70, s[8:11], s63 offen
  s_xor_b32 s72, s72, 1
  s_branch Cf3_h2
Cf3_h1r:
  s_mov_b64 exec, vcc
  buffer_load_dwordx4 v[0:3], v76, s[8:11], s60 offen offset:0 sc1
  buffer_load_dwordx4 v[4:7], v76, s[8:11], s60 offen offset:1024 sc1
  buffer_load_dwordx4 v[8:11], v76, s[8:11], s61 offen offset:0 sc1
  buffer_load_dwordx4 v[12:15], v76, s[8:11], s61 offen offset:1024 sc1
  s_mov_b64 exec, -1
  s_add_u32 s67, s67, 1
  s_waitcnt vmcnt(3)
  v_mfma_f32_16x16x32_bf16 v[56:59], v[52:55], v[0:3], 0
  v_bitop3_b32 v72, v0, v2, s72 bitop3:0x7e
  s_waitcnt vmcnt(2)
  v_mfma_f32_16x16x32_bf16 v[56:59], v[52:55], v[4:7], v[56:59]
  v_bitop3_b32 v73, v4, v6, s72 bitop3:0x7e
  v_or_b32 v72, v72, v73
  s_waitcnt vmcnt(1)
  v_mfma_f32_16x16x32_bf16 v[36:39], v[52:55], v[8:11], 0
  v_bitop3_b32 v73, v8, v10, s72 bitop3:0x7e
  v_or_b32 v72, v72, v73
  s_waitcnt vmcnt(0)
  v_mfma_f32_16x16x32_bf16 v[36:39], v[52:55], v[12:15], v[36:39]
  v_bitop3_b32 v73, v12, v14, s72 bitop3:0x7e
  v_bitop3_b32 v72, v72, v73, 1 bitop3:0xa8
  v_cmp_ne_u32 vcc, 0, v72
  s_cbranch_vccz Cf3_h1p
Cf3_h1s:
  s_mov_b64 exec, vcc
  buffer_load_dwordx4 v[0:3], v76, s[8:11], s60 offen offset:0 sc1
  buffer_load_dwordx4 v[4:7], v76, s[8:11], s60 offen offset:1024 sc1
  buffer_load_dwordx4 v[8:11], v76, s[8:11], s61 offen offset:0 sc1
  buffer_load_dwordx4 v[12:15], v76, s[8:11], s61 offen offset:1024 sc1
  s_mov_b64 exec, -1
  s_add_u32 s67, s67, 1
  s_waitcnt vmcnt(3)
  v_mfma_f32_16x16x32_bf16 v[56:59], v[52:55], v[0:3], 0
  v_bitop3_b32 v72, v0, v2, s72 bitop3:0x7e
  s_waitcnt vmcnt(2)
  v_mfma_f32_16x16x32_bf16 v[56:59], v[52:55], v[4:7], v[56:59]
  v_bitop3_b32 v73, v4, v6, s72 bitop3:0x7e
  v_or_b32 v72, v72, v73
  s_waitcnt vmcnt(1)
  v_mfma_f32_16x16x32_bf16 v[36:39], v[52:55], v[8:11], 0
  v_bitop3_b32 v73, v8, v10, s72 bitop3:0x7e
  v_or_b32 v72, v72, v73
  s_waitcnt vmcnt(0)
  v_mfma_f32_16x16x32_bf16 v[36:39], v[52:55], v[12:15], v[36:39]
  v_bitop3_b32 v73, v12, v14, s72 bitop3:0x7e
  v_bitop3_b32 v72, v72, v73, 1 bitop3:0xa8
  v_cmp_ne_u32 vcc, 0, v72
  s_cbranch_vccz Cf3_h1p
  s_cmp_lt_u32 s67, 131072
  s_cbranch_scc1 Cf3_h1s
Cf3_h1p:
  s_nop 2
  buffer_load_dwordx4 v[4:7], v76, s[8:11], s65 offen offset:1024 sc1
  v_add_f32_dpp v56, v56, v56 row_ror:4 row_mask:0xf bank_mask:0xf
  v_add_f32_dpp v57, v57, v57 row_ror:4 row_mask:0xf bank_mask:0xf
  v_add_f32_dpp v36, v36, v36 row_ror:4 row_mask:0xf bank_mask:0xf
  v_add_f32_dpp v37, v37, v37 row_ror:4 row_mask:0xf bank_mask:0xf
  v_add_f32_dpp v56, v56, v56 row_ror:8 row_mask:0xf bank_mask:0xf
  v_add_f32_dpp v57, v57, v57 row_ror:8 row_mask:0xf bank_mask:0xf
  v_add_f32_dpp v36, v36, v36 row_ror:8 row_mask:0xf bank_mask:0xf
  v_add_f32_dpp v37, v37, v37 row_ror:8 row_mask:0xf bank_mask:0xf
  v_cvt_pk_bf16_f32 v56, v56, v57
  buffer_store_dword v56, v69, s[8:11], s62 offen
  v_cvt_pk_bf16_f32 v36, v36, v37
  buffer_store_dword v36, v70, s[8:11], s63 offen
  s_xor_b32 s62, s62, 16384
  buffer_store_dword v71, v69, s[8:11], s62 offen
  s_xor_b32 s63, s63, 16384
  buffer_store_dword v71, v70, s[8:11], s63 offen
  s_xor_b32 s72, s72, 1
  s_branch Cf3_h2
Cf3_h2r:
  s_mov_b64 exec, vcc
  buffer_load_dwordx4 v[4:7], v76, s[8:11], s65 offen offset:1024 sc1
  s_mov_b64 exec, -1
  s_add_u32 s67, s67, 1
  s_waitcnt vmcnt(3)
  v_max3_u32 v72, v4, v5, v6
  v_max_u32 v72, v72, v7
  ds_write_b128 v76, v[4:7] offset:5632
  v_cmp_eq_u32 vcc, -1, v72
  s_cbranch_vccz Cf3_h2w
Cf3_h2s:
  s_mov_b64 exec, vcc
  buffer_load_dwordx4 v[4:7], v76, s[8:11], s65 offen offset:1024 sc1
  s_mov_b64 exec, -1
  s_add_u32 s67, s67, 1
  s_waitcnt vmcnt(1)
  v_max3_u32 v72, v4, v5, v6
  v_max_u32 v72, v72, v7
  ds_write_b128 v76, v[4:7] offset:5632
  v_cmp_eq_u32 vcc, -1, v72
  s_cbranch_vccz Cf3_h2w
  s_mov_b64 exec, vcc
  buffer_load_dwordx4 v[4:7], v76, s[8:11], s65 offen offset:1024 sc1
  s_mov_b64 exec, -1
  s_add_u32 s67, s67, 1
  s_waitcnt vmcnt(1)
  v_max3_u32 v72, v4, v5, v6
  v_max_u32 v72, v72, v7
  ds_write_b128 v76, v[4:7] offset:5632
  v_cmp_eq_u32 vcc, -1, v72
  s_cbranch_vccz Cf3_h2w
  s_mov_b64 exec, vcc
  buffer_load_dwordx4 v[4:7], v76, s[8:11], s65 offen offset:1024 sc1
  s_mov_b64 exec, -1
  s_add_u32 s67, s67, 1
  s_waitcnt vmcnt(1)
  v_max3_u32 v72, v4, v5, v6
  v_max_u32 v72, v72, v7
  ds_write_b128 v76, v[4:7] offset:5632
  v_cmp_eq_u32 vcc, -1, v72
  s_cbranch_vccz Cf3_h2w
  s_cmp_lt_u32 s67, 131072
  s_cbranch_scc1 Cf3_h2s
  s_branch Cf3_h2w
Cf3_rec:
  s_nop 7
  s_waitcnt vmcnt(0) lgkmcnt(0)
  v_max3_u32 v72, v0, v1, v2
  v_max3_u32 v72, v72, v3, v4
  v_max3_u32 v72, v72, v5, v6
  v_max3_u32 v72, v72, v7, v8
  v_max3_u32 v72, v72, v9, v10
  v_max3_u32 v72, v72, v11, v12
  v_max3_u32 v72, v72, v13, v14
  v_max3_u32 v72, v72, v15, v16
  v_max3_u32 v72, v72, v17, v18
  v_max_u32 v72, v72, v19
  v_cmp_eq_u32 vcc, -1, v72
  s_cbranch_vccz Cf3_recok
  s_barrier
Cf3_recp:
  buffer_load_dwordx4 v[0:3], v76, s[8:11], s64 offen offset:0 sc1
  buffer_load_dwordx4 v[4:7], v76, s[8:11], s64 offen offset:1024 sc1
  buffer_load_dwordx4 v[8:11], v76, s[8:11], s64 offen offset:2048 sc1
  s_add_u32 s67, s67, 1
  s_cmp_lt_u32 s67, 131072
  s_cselect_b32 s54, -2, -1
  s_waitcnt vmcnt(2)
  v_max3_u32 v72, v0, v1, v2
  s_waitcnt vmcnt(1)
  v_max3_u32 v72, v72, v3, v4
  v_max3_u32 v72, v72, v5, v6
  s_waitcnt vmcnt(0)
  v_max3_u32 v72, v72, v7, v8
  v_max3_u32 v72, v72, v9, v10
  v_max_u32 v72, v72, v11
  v_cmp_lt_u32 vcc, s54, v72
  s_cbranch_vccnz Cf3_recp
  ds_write_b128 v76, v[0:3] offset:10752
  ds_write_b128 v76, v[4:7] offset:11776
  ds_write_b128 v76, v[8:11] offset:12800
  v_mov_b64 v[20:21], 0
  v_mov_b64 v[22:23], 0
  v_mov_b64 v[24:25], 0
  v_mov_b64 v[26:27], 0
  v_mov_b64 v[28:29], 0
  v_mov_b64 v[30:31], 0
  v_mov_b64 v[32:33], 0
  v_mov_b64 v[34:35], 0
  s_waitcnt lgkmcnt(0)
  s_barrier
  ds_read_b128 v[0:3], v76 offset:4608
  s_waitcnt lgkmcnt(0)
  v_smfmac_f32_16x16x64_bf16 v[20:23], v[0:3], v[80:87], v74
  v_smfmac_f32_16x16x64_bf16 v[24:27], v[0:3], v[88:95], v74
  ds_read_b128 v[60:63], v76 offset:28672
  ds_read_b128 v[64:67], v76 offset:29696
  s_waitcnt lgkmcnt(0)
  v_smfmac_f32_16x16x64_bf16 v[28:31], v[0:3], v[60:67], v74
  ds_read_b128 v[60:63], v76 offset:30720
  ds_read_b128 v[64:67], v76 offset:31744
  s_waitcnt lgkmcnt(0)
  v_smfmac_f32_16x16x64_bf16 v[32:35], v[0:3], v[60:67], v74
  ds_read_b128 v[4:7], v76 offset:5632
  s_waitcnt lgkmcnt(0)
  v_smfmac_f32_16x16x64_bf16 v[20:23], v[4:7], v[96:103], v74
  v_smfmac_f32_16x16x64_bf16 v[24:27], v[4:7], v[104:111], v74
  ds_read_b128 v[60:63], v76 offset:45056
  ds_read_b128 v[64:67], v76 offset:46080
  s_waitcnt lgkmcnt(0)
  v_smfmac_f32_16x16x64_bf16 v[28:31], v[4:7], v[60:67], v74
  ds_read_b128 v[60:63], v76 offset:47104
  ds_read_b128 v[64:67], v76 offset:48128
  s_waitcnt lgkmcnt(0)
  v_smfmac_f32_16x16x64_bf16 v[32:35], v[4:7], v[60:67], v74
  ds_read_b128 v[8:11], v76 offset:6656
  s_waitcnt lgkmcnt(0)
  v_smfmac_f32_16x16x64_bf16 v[20:23], v[8:11], v[112:119], v74
  v_smfmac_f32_16x16x64_bf16 v[24:27], v[8:11], v[120:127], v74
  v_smfmac_f32_16x16x64_bf16 v[28:31], v[8:11], v[208:215], v74
  v_smfmac_f32_16x16x64_bf16 v[32:35], v[8:11], v[216:223], v74
  ds_read_b128 v[12:15], v76 offset:7680
  s_waitcnt lgkmcnt(0)
  v_smfmac_f32_16x16x64_bf16 v[20:23], v[12:15], v[128:135], v74
  v_smfmac_f32_16x16x64_bf16 v[24:27], v[12:15], v[136:143], v74
  v_smfmac_f32_16x16x64_bf16 v[28:31], v[12:15], v[224:231], v74
  v_smfmac_f32_16x16x64_bf16 v[32:35], v[12:15], v[232:239], v74
  ds_read_b128 v[4:7], v76 offset:8704
  s_waitcnt lgkmcnt(0)
  v_smfmac_f32_16x16x64_bf16 v[20:23], v[4:7], v[144:151], v74
  v_smfmac_f32_16x16x64_bf16 v[24:27], v[4:7], v[152:159], v74
  ds_read_b128 v[60:63], v76 offset:61440
  ds_read_b128 v[64:67], v76 offset:62464
  s_waitcnt lgkmcnt(0)
  v_smfmac_f32_16x16x64_bf16 v[28:31], v[4:7], v[60:67], v74
  ds_read_b128 v[60:63], v76 offset:63488
  ds_read_b128 v[64:67], v76 offset:64512
  s_waitcnt lgkmcnt(0)
  v_smfmac_f32_16x16x64_bf16 v[32:35], v[4:7], v[60:67], v74
  ds_read_b128 v[8:11], v76 offset:9728
  s_waitcnt lgkmcnt(0)
  v_smfmac_f32_16x16x64_bf16 v[20:23], v[8:11], v[160:167], v74
  v_smfmac_f32_16x16x64_bf16 v[24:27], v[8:11], v[168:175], v74
  ds_read_b128 v[60:63], v75 offset:28672
  ds_read_b128 v[64:67], v75 offset:29696
  s_waitcnt lgkmcnt(0)
  v_smfmac_f32_16x16x64_bf16 v[28:31], v[8:11], v[60:67], v74
  ds_read_b128 v[60:63], v75 offset:30720
  ds_read_b128 v[64:67], v75 offset:31744
  s_waitcnt lgkmcnt(0)
  v_smfmac_f32_16x16x64_bf16 v[32:35], v[8:11], v[60:67], v74
  ds_read_b128 v[16:19], v76 offset:10752
  ds_read_b128 v[60:63], v75 offset:12288
  ds_read_b128 v[64:67], v75 offset:13312
  s_waitcnt lgkmcnt(0)
  v_smfmac_f32_16x16x64_bf16 v[20:23], v[16:19], v[60:67], v74
  ds_read_b128 v[60:63], v75 offset:14336
  ds_read_b128 v[64:67], v75 offset:15360
  s_waitcnt lgkmcnt(0)
  v_smfmac_f32_16x16x64_bf16 v[24:27], v[16:19], v[60:67], v74
  v_smfmac_f32_16x16x64_bf16 v[28:31], v[16:19], v[240:247], v74
  v_smfmac_f32_16x16x64_bf16 v[32:35], v[16:19], v[248:255], v74
  ds_read_b128 v[0:3], v76 offset:11776
  s_waitcnt lgkmcnt(0)
  v_smfmac_f32_16x16x64_bf16 v[20:23], v[0:3], v[176:183], v74
  v_smfmac_f32_16x16x64_bf16 v[24:27], v[0:3], v[184:191], v74
  v_smfmac_f32_16x16x64_bf16 v[28:31], v[0:3], a[0:7], v74
  v_smfmac_f32_16x16x64_bf16 v[32:35], v[0:3], a[8:15], v74
  ds_read_b128 v[12:15], v76 offset:12800
  s_waitcnt lgkmcnt(0)
  v_smfmac_f32_16x16x64_bf16 v[20:23], v[12:15], v[192:199], v74
  v_smfmac_f32_16x16x64_bf16 v[24:27], v[12:15], v[200:207], v74
  v_smfmac_f32_16x16x64_bf16 v[28:31], v[12:15], a[16:23], v74
  v_smfmac_f32_16x16x64_bf16 v[32:35], v[12:15], a[24:31], v74
  v_add_f32 v20, v20, v22
  v_add_f32 v21, v21, v23
  v_add_f32 v24, v24, v26
  v_cvt_pk_bf16_f32 v22, v20, v24
  ds_write_b32 v79, v22 offset:0
  v_add_f32 v25, v25, v27
  v_cvt_pk_bf16_f32 v23, v21, v25
  ds_write_b32 v79, v23 offset:576
  v_add_f32 v28, v28, v30
  v_add_f32 v29, v29, v31
  s_waitcnt lgkmcnt(0)
  s_nop 1
  s_branch Cf3_recok
Cf3_mx:
  s_waitcnt lgkmcnt(0)
  s_barrier
  buffer_load_dwordx4 v[52:55], v76, s[8:11], s59 offen offset:0 sc1
  buffer_load_dwordx4 v[0:3], v76, s[8:11], s58 offen offset:0 sc1
  ds_read_b128 v[20:23], v77 offset:0
  ds_read_b128 v[28:31], v77 offset:256
  buffer_load_dwordx4 v[56:59], v76, s[8:11], s59 offen offset:1024 sc1
  buffer_load_dwordx4 v[4:7], v76, s[8:11], s58 offen offset:1024 sc1
  ds_read_b128 v[24:27], v77 offset:128
  ds_read_b128 v[32:35], v77 offset:384
  s_waitcnt vmcnt(2) lgkmcnt(3)
  v_mfma_f32_16x16x32_bf16 v[8:11], v[0:3], v[20:23], 0
  s_waitcnt vmcnt(0) lgkmcnt(1)
  v_mfma_f32_16x16x32_bf16 v[8:11], v[4:7], v[24:27], v[8:11]
  v_mfma_f32_16x16x32_bf16 v[12:15], v[28:31], v[20:23], 0
  s_waitcnt lgkmcnt(0)
  v_mfma_f32_16x16x32_bf16 v[12:15], v[32:35], v[24:27], v[12:15]
  v_add_f32_dpp v8, v10, v8 quad_perm:[2,3,0,1] row_mask:0xf bank_mask:0xf
  v_add_f32_dpp v9, v11, v9 quad_perm:[2,3,0,1] row_mask:0xf bank_mask:0xf
  s_nop 0
  v_mov_b32_dpp v8, v8 quad_perm:[0,1,0,1] row_mask:0xf bank_mask:0xf
  v_mov_b32_dpp v9, v9 quad_perm:[0,1,0,1] row_mask:0xf bank_mask:0xf
  s_nop 1
  v_add_f32_dpp v12, v14, v12 quad_perm:[2,3,0,1] row_mask:0xf bank_mask:0xf
  v_add_f32_dpp v13, v15, v13 quad_perm:[2,3,0,1] row_mask:0xf bank_mask:0xf
  s_nop 0
  v_mov_b32_dpp v12, v12 quad_perm:[0,1,0,1] row_mask:0xf bank_mask:0xf
  v_mov_b32_dpp v13, v13 quad_perm:[0,1,0,1] row_mask:0xf bank_mask:0xf
  v_mul_f32 v12, s69, v12
  ds_write_b32 v78, v8 offset:8716
  v_mul_f32 v13, s69, v13
  ds_write_b32 v78, v9 offset:8780
  s_waitcnt lgkmcnt(0)
  s_barrier
  ds_read_b128 v[36:39], v78 offset:8704
  ds_read_b128 v[40:43], v78 offset:8768
  s_waitcnt lgkmcnt(0)
  s_barrier
  v_max_f32 v16, v36, v37
  v_max3_f32 v16, v16, v38, v39
  v_max3_f32 v16, v16, v40, v41
  v_max3_f32 v16, v16, v42, v43
  v_max3_f32 v16, v16, v12, v13
  v_mov_b32 v17, v16
  s_nop 1
  v_permlane16_swap_b32 v16, v17
  v_max_f32 v16, v16, v17
  v_mov_b32 v17, v16
  s_nop 1
  v_permlane32_swap_b32 v16, v17
  v_max_f32 v16, v16, v17
  v_sub_f32 v36, v36, v16
  v_sub_f32 v37, v37, v16
  v_sub_f32 v38, v38, v16
  v_sub_f32 v39, v39, v16
  v_sub_f32 v40, v40, v16
  v_sub_f32 v41, v41, v16
  v_sub_f32 v42, v42, v16
  v_sub_f32 v43, v43, v16
  v_sub_f32 v12, v12, v16
  v_sub_f32 v13, v13, v16
  v_exp_f32 v36, v36
  v_exp_f32 v37, v37
  v_exp_f32 v38, v38
  v_exp_f32 v39, v39
  v_exp_f32 v40, v40
  v_exp_f32 v41, v41
  v_exp_f32 v42, v42
  v_exp_f32 v43, v43
  v_exp_f32 v12, v12
  v_exp_f32 v13, v13
  v_cvt_pk_bf16_f32 v32, v36, v40
  v_cvt_pk_bf16_f32 v33, v37, v41
  v_cvt_pk_bf16_f32 v34, v38, v42
  v_cvt_pk_bf16_f32 v35, v39, v43
  v_cvt_pk_bf16_f32 v28, v12, v13
  v_cvt_pk_bf16_f32 v31, v12, v13
  v_mov_b32 v29, 0
  v_mov_b32 v30, 0
  v_mfma_f32_16x16x32_bf16 v[8:11], v[32:35], v[68:71], 0
  v_mfma_f32_16x16x32_bf16 v[0:3], v[32:35], v[52:55], 0
  v_mfma_f32_16x16x32_bf16 v[4:7], v[32:35], v[56:59], 0
  v_mfma_f32_16x16x16_bf16 v[8:11], v[28:29], v[68:69], v[8:11]
  v_mfma_f32_16x16x16_bf16 v[0:3], v[28:29], v[72:73], v[0:3]
  v_mfma_f32_16x16x16_bf16 v[4:7], v[30:31], v[72:73], v[4:7]
  ds_read_b128 v[52:55], v75 offset:30720
  v_rcp_f32 v10, v8
  v_rcp_f32 v11, v9
  v_mul_f32 v0, v10, v0
  v_mul_f32 v1, v11, v1
  v_max3_f32 v8, v8, v9, v10
  v_mul_f32 v4, v10, v4
  v_mul_f32 v5, v11, v5
  v_cvt_pk_bf16_f32 v2, v0, v4
  ds_write_b32 v79, v2 offset:8704
  v_cvt_pk_bf16_f32 v3, v1, v5
  ds_write_b32 v79, v3 offset:9280
  ds_read_b128 v[12:15], v78 offset:8896
  ds_read_b128 v[56:59], v75 offset:31744
  v_mov_b64 v[16:17], 0
  v_mov_b64 v[18:19], 0
  v_mov_b64 v[20:21], 0
  v_mov_b64 v[22:23], 0
  v_mov_b64 v[24:25], 0
  v_mov_b64 v[26:27], 0
  s_branch Cf3_mxok
Cf3_last:
  ds_read_b128 v[0:3], v76 offset:4608
  ds_read_b128 v[12:15], v76 offset:7680
  ds_read_b128 v[44:47], v76 offset:28672
  ds_read_b128 v[48:51], v76 offset:29696
  s_nop 5
  v_mov_b64 v[20:21], 0
  v_mov_b64 v[22:23], 0
  v_mov_b64 v[24:25], 0
  v_mov_b64 v[26:27], 0
  v_smfmac_f32_16x16x64_bf16 v[28:31], v[4:7], v[36:43], v74
  ds_read_b128 v[36:39], v76 offset:30720
  ds_read_b128 v[40:43], v76 offset:31744
  v_smfmac_f32_16x16x64_bf16 v[32:35], v[4:7], v[60:67], v74
  s_waitcnt lgkmcnt(5)
  v_smfmac_f32_16x16x64_bf16 v[20:23], v[0:3], a[32:39], v74
  ds_read_b128 v[60:63], v76 offset:61440
  ds_read_b128 v[64:67], v76 offset:62464
  v_smfmac_f32_16x16x64_bf16 v[24:27], v[0:3], a[40:47], v74
  s_waitcnt lgkmcnt(4)
  v_smfmac_f32_16x16x64_bf16 v[20:23], v[4:7], a[48:55], v74
  buffer_store_dwordx4 v[16:19], v76, s[8:11], s68 offen sc1
  v_smfmac_f32_16x16x64_bf16 v[24:27], v[4:7], a[56:63], v74
  v_smfmac_f32_16x16x64_bf16 v[28:31], v[0:3], v[44:51], v74
  s_waitcnt lgkmcnt(2)
  v_smfmac_f32_16x16x64_bf16 v[20:23], v[8:11], a[64:71], v74
  ds_read_b128 v[44:47], v76 offset:63488
  ds_read_b128 v[48:51], v76 offset:64512
  v_smfmac_f32_16x16x64_bf16 v[24:27], v[8:11], a[72:79], v74
  v_smfmac_f32_16x16x64_bf16 v[32:35], v[0:3], v[36:43], v74
  v_smfmac_f32_16x16x64_bf16 v[28:31], v[8:11], v[208:215], v74
  ds_read_b128 v[36:39], v75 offset:28672
  ds_read_b128 v[40:43], v75 offset:29696
  v_smfmac_f32_16x16x64_bf16 v[32:35], v[8:11], v[216:223], v74
  v_smfmac_f32_16x16x64_bf16 v[20:23], v[12:15], a[80:87], v74
  v_smfmac_f32_16x16x64_bf16 v[24:27], v[12:15], a[88:95], v74
  v_smfmac_f32_16x16x64_bf16 v[28:31], v[12:15], v[224:231], v74
  v_smfmac_f32_16x16x64_bf16 v[32:35], v[12:15], v[232:239], v74
  s_waitcnt vmcnt(1)
  s_barrier
Cf3_lastr:
  ds_read_b128 v[4:7], v76 offset:8704
  ds_read_b128 v[8:11], v76 offset:9728
  ds_read_b128 v[16:19], v76 offset:10752
  ds_read_b128 v[0:3], v76 offset:11776
  ds_read_b128 v[12:15], v76 offset:12800
  s_waitcnt lgkmcnt(1)
  v_max3_u32 v72, v0, v1, v2
  v_max3_u32 v72, v72, v3, v4
  v_max3_u32 v72, v72, v5, v6
  v_max3_u32 v72, v72, v7, v8
  v_max3_u32 v72, v72, v9, v10
  s_waitcnt lgkmcnt(0)
  v_max3_u32 v72, v72, v11, v12
  v_max3_u32 v72, v72, v13, v14
  v_max3_u32 v72, v72, v15, v16
  v_max3_u32 v72, v72, v17, v18
  v_max_u32 v72, v72, v19
  v_cmp_eq_u32 vcc, -1, v72
  s_cbranch_vccnz Cf3_lastp
Cf3_lastg:
  v_smfmac_f32_16x16x64_bf16 v[28:31], v[4:7], v[60:67], v74
  ds_read_b128 v[60:63], v75 offset:30720
  ds_read_b128 v[64:67], v75 offset:31744
  v_smfmac_f32_16x16x64_bf16 v[32:35], v[4:7], v[44:51], v74
  v_smfmac_f32_16x16x64_bf16 v[28:31], v[8:11], v[36:43], v74
  v_smfmac_f32_16x16x64_bf16 v[28:31], v[16:19], v[240:247], v74
  v_smfmac_f32_16x16x64_bf16 v[28:31], v[0:3], a[0:7], v74
  v_smfmac_f32_16x16x64_bf16 v[28:31], v[12:15], a[16:23], v74
  v_smfmac_f32_16x16x64_bf16 v[32:35], v[16:19], v[248:255], v74
  v_smfmac_f32_16x16x64_bf16 v[32:35], v[0:3], a[8:15], v74
  s_waitcnt lgkmcnt(0)
  v_smfmac_f32_16x16x64_bf16 v[32:35], v[12:15], a[24:31], v74
  v_smfmac_f32_16x16x64_bf16 v[32:35], v[8:11], v[60:67], v74
  v_smfmac_f32_16x16x64_bf16 v[20:23], v[4:7], a[96:103], v74
  v_smfmac_f32_16x16x64_bf16 v[20:23], v[8:11], a[112:119], v74
  v_add_f32 v28, v28, v30
  v_add_f32 v32, v32, v34
  v_cvt_pk_bf16_f32 v30, v28, v32
  v_smfmac_f32_16x16x64_bf16 v[20:23], v[16:19], a[128:135], v74
  ds_write_b32 v79, v30 offset:256
  v_add_f32 v29, v29, v31
  v_add_f32 v33, v33, v35
  v_cvt_pk_bf16_f32 v31, v29, v33
  v_smfmac_f32_16x16x64_bf16 v[20:23], v[0:3], a[144:151], v74
  ds_write_b32 v79, v31 offset:832
  v_smfmac_f32_16x16x64_bf16 v[20:23], v[12:15], a[160:167], v74
  v_smfmac_f32_16x16x64_bf16 v[24:27], v[4:7], a[104:111], v74
  v_smfmac_f32_16x16x64_bf16 v[24:27], v[8:11], a[120:127], v74
  v_smfmac_f32_16x16x64_bf16 v[24:27], v[16:19], a[136:143], v74
  s_waitcnt lgkmcnt(0)
  s_barrier
  ds_read_b64 v[52:53], v77 offset:392
  v_add_f32 v20, v20, v22
  v_smfmac_f32_16x16x64_bf16 v[24:27], v[0:3], a[152:159], v74
  v_add_f32 v21, v21, v23
  v_smfmac_f32_16x16x64_bf16 v[24:27], v[12:15], a[168:175], v74
  v_cvt_pk_bf16_f32 v54, v20, v21
  s_add_u32 s68, s68, 655360
  s_nop 3
  v_add_f32 v24, v24, v26
  v_add_f32 v25, v25, v27
  v_cvt_pk_bf16_f32 v55, v24, v25
  s_waitcnt lgkmcnt(0)
  buffer_store_dwordx4 v[52:55], v76, s[8:11], s68 offen sc1
  s_branch Cf3_done
Cf3_lastp:
  s_add_u32 s72, s72, 2
  s_cmp_ge_u32 s72, 131072
  s_cbranch_scc1 Cf3_lastg
  s_barrier
  buffer_load_dwordx4 v76, s[8:11], s85 offen offset:0 sc1 lds
  buffer_load_dwordx4 v76, s[8:11], s85 offen offset:1024 sc1 lds
  s_waitcnt vmcnt(0)
  s_barrier
  s_branch Cf3_lastr
Cf3_done:
  s_branch L_cexit
L_w4:
  v_mov_b64 v[20:21], 0
  v_mov_b64 v[22:23], 0
  v_mov_b64 v[24:25], 0
  v_mov_b64 v[26:27], 0
  v_mov_b64 v[28:29], 0
  v_mov_b64 v[30:31], 0
  v_mov_b64 v[32:33], 0
  v_mov_b64 v[34:35], 0
  s_mov_b32 s78, 0x3f803f80
  s_mov_b32 s79, s78
  s_mov_b32 s65, 360448
  s_mov_b32 m0, 16128
  s_lshl_b32 s71, s53, 2
  s_add_u32 s71, s71, 128
  s_movk_i32 s56, 0x1000
  v_lshlrev_b32 v73, 2, v76
  v_mov_b32 v72, 0
  s_mov_b64 s[16:17], s[8:9]
  s_mov_b32 s18, 268435456
  s_mov_b32 s19, 0x20000
  s_getpc_b64 s[20:21]
Cs0_pc:
  s_add_u32 s20, s20, (Cs0_last - Cs0_pc)
  s_addc_u32 s21, s21, 0
  v_mov_b32 v68, 14880
  buffer_load_dwordx4 v[52:55], v76, s[8:11], s59 offen offset:0 sc1
  buffer_load_dwordx4 v[56:59], v76, s[8:11], s59 offen offset:1024 sc1
  ds_read_b128 v[36:39], v76 offset:16384
  ds_read_b128 v[40:43], v76 offset:17408
  ds_read_b128 v[60:63], v76 offset:18432
  ds_read_b128 v[64:67], v76 offset:19456
  ds_read_b128 v[0:3], v76 offset:4608
  ds_read_b128 v[4:7], v76 offset:5632
  ds_read_b128 v[8:11], v76 offset:6656
  ds_read_b128 v[12:15], v76 offset:7680
  s_waitcnt lgkmcnt(0)
  s_cmp_eq_u32 s66, 1
  s_branch Cs0_top2
.p2align 6
Cs0_h2:
  ds_read_b128 v[36:39], v76 offset:16384
  v_mov_b64 v[20:21], 0
  v_mov_b64 v[22:23], 0
  v_mov_b64 v[24:25], 0
  v_mov_b64 v[26:27], 0
  v_mov_b32 v68, 14880
  ds_read_b128 v[40:43], v76 offset:17408
  s_cmp_eq_u32 s66, 62
  s_cselect_b64 s[16:17], s[20:21], s[16:17]
  s_cselect_b32 s18, (Cs0_done - Cs0_last), s18
  s_cselect_b32 s70, 0, s70
  s_cmp_eq_u32 s66, 63
  s_cselect_b32 s59, 268435456, s59
  s_cselect_b32 s58, 268435456, s58
  ds_read_b128 v[60:63], v76 offset:18432
  v_lshlrev_b32 v73, 2, v76
  s_cmp_eq_u32 s66, 12
  s_cselect_b32 s56, s71, 0x1000
  ds_read_b32 v72, v76 offset:16128
  s_cmp_eq_u32 s66, 13
  s_cselect_b32 s54, 0x700, 0
  s_waitcnt lgkmcnt(0)
  v_readfirstlane_b32 s57, v72
  s_nop 0
  s_cmp_lt_u32 s57, s54
  s_cbranch_scc1 Cs0_kv3
Cs0_kvb:
  buffer_load_dwordx4 v[52:55], v76, s[8:11], s59 offen offset:0 sc1
  buffer_load_dwordx4 v[56:59], v76, s[8:11], s59 offen offset:1024 sc1
  s_waitcnt vmcnt(0)
  s_mov_b64 vcc, -1
Cs0_h2r:
  s_mov_b64 exec, vcc
  buffer_load_dwordx4 v[0:3], v76, s[8:11], s65 offen offset:0 sc1
  buffer_load_dwordx4 v[4:7], v76, s[8:11], s85 offen offset:0 sc1
  s_mov_b64 exec, -1
  s_add_u32 s67, s67, 1
  s_cmp_lt_u32 s67, 131072
  s_cselect_b32 s54, -2, -1
  s_waitcnt vmcnt(1)
  v_max3_u32 v72, v0, v1, v2
  s_waitcnt vmcnt(0)
  v_max3_u32 v72, v72, v3, v4
  v_max3_u32 v72, v72, v5, v6
  v_max_u32 v72, v72, v7
  v_cmp_lt_u32 vcc, s54, v72
  s_cbranch_vccnz Cs0_h2r
  ds_write_b128 v76, v[0:3] offset:4608
  ds_write_b128 v76, v[4:7] offset:10752
Cs0_h2w:
  s_cmp_eq_u32 s66, 63
  s_waitcnt lgkmcnt(0)
  s_barrier
  ds_read_b128 v[8:11], v76 offset:6656
Cs0_top2:
  v_smfmac_f32_16x16x64_bf16 v[20:23], v[0:3], v[80:87], v74
  s_cbranch_scc1 Cs0_last
  v_smfmac_f32_16x16x64_bf16 v[28:31], v[0:3], v[36:43], v74
  buffer_load_dwordx4 v[44:47], v76, s[8:11], s58 offen offset:0 sc1
  s_mov_b32 m0, 16128
  v_smfmac_f32_16x16x64_bf16 v[24:27], v[0:3], v[88:95], v74
  buffer_load_dwordx4 v[48:51], v76, s[8:11], s58 offen offset:1024 sc1
  v_smfmac_f32_16x16x64_bf16 v[32:35], v[0:3], v[60:67], v74
  ds_read_b128 v[4:7], v76 offset:5632
  s_waitcnt lgkmcnt(1)
  v_smfmac_f32_16x16x64_bf16 v[20:23], v[8:11], v[112:119], v74
  ds_read_b128 v[12:15], v76 offset:7680
  v_smfmac_f32_16x16x64_bf16 v[24:27], v[8:11], v[120:127], v74
  ds_read_b128 v[36:39], v76 offset:32768
  v_smfmac_f32_16x16x64_bf16 v[28:31], v[8:11], v[208:215], v74
  buffer_store_dwordx4 v[16:19], v76, s[8:11], s68 offen sc1
  ds_read_b128 v[40:43], v76 offset:33792
  v_smfmac_f32_16x16x64_bf16 v[32:35], v[8:11], v[216:223], v74
  buffer_load_dword v73, s[16:19], s70 offen lds
  ds_read_b128 v[60:63], v76 offset:34816
  s_waitcnt lgkmcnt(4)
  v_smfmac_f32_16x16x64_bf16 v[20:23], v[4:7], v[96:103], v74
  ds_read_b128 v[64:67], v76 offset:35840
  v_smfmac_f32_16x16x64_bf16 v[24:27], v[4:7], v[104:111], v74
  s_waitcnt vmcnt(4)
  s_waitcnt lgkmcnt(4)
  v_smfmac_f32_16x16x64_bf16 v[20:23], v[12:15], v[128:135], v74
  s_barrier
  ds_read_b128 v[0:3], v76 offset:8704
  s_waitcnt lgkmcnt(3)
  v_smfmac_f32_16x16x64_bf16 v[28:31], v[4:7], v[36:43], v74
  ds_read_b128 v[36:39], v76 offset:49152
  v_smfmac_f32_16x16x64_bf16 v[24:27], v[12:15], v[136:143], v74
  ds_read_b128 v[40:43], v76 offset:50176
  s_waitcnt lgkmcnt(3)
  v_smfmac_f32_16x16x64_bf16 v[32:35], v[4:7], v[60:67], v74
  ds_read_b128 v[8:11], v76 offset:9728
  v_smfmac_f32_16x16x64_bf16 v[28:31], v[12:15], v[224:231], v74
  ds_read_b128 v[60:63], v76 offset:51200
  v_smfmac_f32_16x16x64_bf16 v[32:35], v[12:15], v[232:239], v74
  ds_read_b128 v[64:67], v76 offset:52224
  s_waitcnt lgkmcnt(5)
  v_smfmac_f32_16x16x64_bf16 v[20:23], v[0:3], v[144:151], v74
  s_barrier
  ds_read_b128 v[4:7], v76 offset:11776
  s_waitcnt lgkmcnt(4)
  v_smfmac_f32_16x16x64_bf16 v[28:31], v[0:3], v[36:43], v74
  ds_read_b128 v[12:15], v76 offset:12800
  ds_read_b128 v[36:39], v75 offset:0
  v_smfmac_f32_16x16x64_bf16 v[24:27], v[0:3], v[152:159], v74
  ds_read_b128 v[16:19], v76 offset:10752
  s_waitcnt lgkmcnt(6)
  v_smfmac_f32_16x16x64_bf16 v[20:23], v[8:11], v[160:167], v74
  ds_read_b128 v[40:43], v75 offset:1024
  s_waitcnt lgkmcnt(5)
  v_smfmac_f32_16x16x64_bf16 v[32:35], v[0:3], v[60:67], v74
  ds_read_b128 v[60:63], v75 offset:2048
  v_smfmac_f32_16x16x64_bf16 v[24:27], v[8:11], v[168:175], v74
  ds_read_b128 v[64:67], v75 offset:3072
  s_waitcnt lgkmcnt(6)
  v_smfmac_f32_16x16x64_bf16 v[20:23], v[4:7], v[176:183], v74
  buffer_load_dword off, s[12:15], s56 sc1 lds
  s_waitcnt lgkmcnt(5)
  v_smfmac_f32_16x16x64_bf16 v[20:23], v[12:15], v[192:199], v74
  s_waitcnt lgkmcnt(2)
  v_smfmac_f32_16x16x64_bf16 v[20:23], v[16:19], v[36:43], v74
  ds_read_b128 v[36:39], v75 offset:16384
  v_smfmac_f32_16x16x64_bf16 v[24:27], v[4:7], v[184:191], v74
  ds_read_b128 v[40:43], v75 offset:17408
  s_waitcnt lgkmcnt(2)
  v_smfmac_f32_16x16x64_bf16 v[24:27], v[16:19], v[60:67], v74
  ds_read_b128 v[60:63], v75 offset:18432
  v_add_f32 v20, v20, v22
  v_smfmac_f32_16x16x64_bf16 v[24:27], v[12:15], v[200:207], v74
  ds_read_b128 v[64:67], v75 offset:19456
  v_add_f32 v21, v21, v23
  v_smfmac_f32_16x16x64_bf16 v[28:31], v[16:19], v[240:247], v74
  v_mov_b64 v[70:71], s[78:79]
  v_smfmac_f32_16x16x64_bf16 v[28:31], v[4:7], a[0:7], v74
  s_waitcnt lgkmcnt(2)
  v_add_f32 v24, v24, v26
  v_smfmac_f32_16x16x64_bf16 v[28:31], v[8:11], v[36:43], v74
  ds_read_b128 v[36:39], v68
  v_cvt_pk_bf16_f32 v22, v20, v24
  v_smfmac_f32_16x16x64_bf16 v[28:31], v[12:15], a[16:23], v74
  ds_read_b128 v[40:43], v68
  ds_write_b32 v79, v22 offset:0
  s_waitcnt lgkmcnt(3)
  v_add_f32 v25, v25, v27
  v_cvt_pk_bf16_f32 v23, v21, v25
  v_smfmac_f32_16x16x64_bf16 v[32:35], v[8:11], v[60:67], v74
  ds_write_b32 v79, v23 offset:576
  v_cmp_u_f32 vcc, v20, v21
  v_smfmac_f32_16x16x64_bf16 v[32:35], v[16:19], v[248:255], v74
  v_add_f32 v28, v28, v30
  v_smfmac_f32_16x16x64_bf16 v[32:35], v[4:7], a[8:15], v74
  v_add_f32 v29, v29, v31
  v_smfmac_f32_16x16x64_bf16 v[32:35], v[12:15], a[24:31], v74
  s_cbranch_vccnz Cs0_rec
Cs0_recok:
  s_waitcnt lgkmcnt(3)
  v_smfmac_f32_16x16x64_bf16 v[36:39], v[16:19], a[128:135], v74
  s_waitcnt lgkmcnt(0)
  s_barrier
  ds_read_b128 v[60:63], v77
  v_smfmac_f32_16x16x64_bf16 v[40:43], v[16:19], a[136:143], v74
  ds_read_b128 v[64:67], v77 offset:128
  v_add_f32 v32, v32, v34
  v_cvt_pk_bf16_f32 v30, v28, v32
  v_smfmac_f32_16x16x64_bf16 v[36:39], v[0:3], a[96:103], v74
  ds_write_b32 v79, v30 offset:256
  v_add_f32 v33, v33, v35
  v_cvt_pk_bf16_f32 v31, v29, v33
  v_smfmac_f32_16x16x64_bf16 v[40:43], v[0:3], a[104:111], v74
  ds_write_b32 v79, v31 offset:832
  v_xor_b32 v75, 0x8000, v75
  v_smfmac_f32_16x16x64_bf16 v[36:39], v[4:7], a[144:151], v74
  ds_read_b128 v[0:3], v76 offset:4608
  v_mov_b32 v29, 0
  v_smfmac_f32_16x16x64_bf16 v[40:43], v[4:7], a[152:159], v74
  s_waitcnt vmcnt(3) lgkmcnt(3)
  v_mov_b32 v30, 0
  v_mfma_f32_16x16x32_bf16 v[44:47], v[44:47], v[60:63], 0
  ds_read_b128 v[4:7], v76 offset:5632
  s_waitcnt lgkmcnt(2)
  v_mfma_f32_16x16x32_bf16 v[44:47], v[48:51], v[64:67], v[44:47]
  s_barrier
  v_smfmac_f32_16x16x64_bf16 v[36:39], v[8:11], a[112:119], v74
  ds_read_b128 v[20:23], v77 offset:256
  ds_read_b128 v[24:27], v77 offset:384
  v_smfmac_f32_16x16x64_bf16 v[40:43], v[8:11], a[120:127], v74
  ds_read_b128 v[8:11], v76 offset:6656
  v_add_f32_dpp v72, v46, v44 quad_perm:[2,3,0,1] row_mask:0xf bank_mask:0xf
  v_add_f32_dpp v73, v47, v45 quad_perm:[2,3,0,1] row_mask:0xf bank_mask:0xf
  v_smfmac_f32_16x16x64_bf16 v[36:39], v[12:15], a[160:167], v74
  s_waitcnt lgkmcnt(4)
  v_exp_f32_dpp v72, v72 quad_perm:[0,1,0,1] row_mask:0xf bank_mask:0xf
  v_smfmac_f32_16x16x64_bf16 v[40:43], v[12:15], a[168:175], v74
  ds_read_b128 v[12:15], v76 offset:7680
  v_exp_f32_dpp v73, v73 quad_perm:[0,1,0,1] row_mask:0xf bank_mask:0xf
  v_smfmac_f32_16x16x64_bf16 v[36:39], v[0:3], a[32:39], v74
  s_waitcnt lgkmcnt(2)
  v_cvt_pk_bf16_f32 v72, v72, v73
  v_mfma_f32_16x16x32_bf16 v[20:23], v[20:23], v[60:63], 0
  ds_write_b32 v78, v72 offset:512
  v_mov_b64 v[16:17], 0
  v_mfma_f32_16x16x32_bf16 v[20:23], v[24:27], v[64:67], v[20:23]
  ds_read_b128 v[44:47], v75 offset:16384
  v_mov_b64 v[18:19], 0
  v_smfmac_f32_16x16x64_bf16 v[40:43], v[0:3], a[40:47], v74
  ds_read_b128 v[48:51], v75 offset:17408
  v_mov_b64 v[68:69], s[78:79]
  v_smfmac_f32_16x16x64_bf16 v[36:39], v[4:7], a[48:55], v74
  s_waitcnt lgkmcnt(4)
  v_add_f32_dpp v24, v22, v20 quad_perm:[2,3,0,1] row_mask:0xf bank_mask:0xf
  v_add_f32_dpp v25, v23, v21 quad_perm:[2,3,0,1] row_mask:0xf bank_mask:0xf
  v_smfmac_f32_16x16x64_bf16 v[36:39], v[8:11], a[64:71], v74
  s_waitcnt lgkmcnt(2)
  s_barrier
  ds_read_b128 v[32:35], v78 offset:512
  v_smfmac_f32_16x16x64_bf16 v[36:39], v[12:15], a[80:87], v74
  ds_read_b128 v[60:63], v75 offset:18432
  v_mul_f32 v24, s69, v24
  v_smfmac_f32_16x16x64_bf16 v[40:43], v[4:7], a[56:63], v74
  ds_read_b128 v[64:67], v75 offset:19456
  v_mul_f32 v25, s69, v25
  v_smfmac_f32_16x16x64_bf16 v[40:43], v[8:11], a[72:79], v74
  v_exp_f32_dpp v24, v24 quad_perm:[0,1,0,1] row_mask:0xf bank_mask:0xf
  v_smfmac_f32_16x16x64_bf16 v[40:43], v[12:15], a[88:95], v74
  s_waitcnt lgkmcnt(2)
  v_exp_f32_dpp v25, v25 quad_perm:[0,1,0,1] row_mask:0xf bank_mask:0xf
  v_mfma_f32_16x16x32_bf16 v[8:11], v[32:35], v[68:71], 0
  v_add_f32 v36, v36, v38
  v_add_f32 v37, v37, v39
  v_mfma_f32_16x16x32_bf16 v[0:3], v[32:35], v[52:55], 0
  v_add_f32 v40, v40, v42
  v_add_f32 v41, v41, v43
  v_mfma_f32_16x16x32_bf16 v[4:7], v[32:35], v[56:59], 0
  v_cvt_pk_bf16_f32 v28, v24, v25
  v_cvt_pk_bf16_f32 v72, v36, v37
  v_cvt_pk_bf16_f32 v73, v40, v41
  v_mfma_f32_16x16x16_bf16 v[8:11], v[28:29], v[68:69], v[8:11]
  v_cvt_pk_bf16_f32 v31, v24, v25
  v_mov_b64 v[20:21], 0
  v_mfma_f32_16x16x16_bf16 v[0:3], v[28:29], v[72:73], v[0:3]
  ds_read_b128 v[52:55], v75 offset:32768
  v_mov_b64 v[22:23], 0
  v_mfma_f32_16x16x16_bf16 v[4:7], v[30:31], v[72:73], v[4:7]
  v_rcp_f32 v10, v8
  v_rcp_f32 v11, v9
  v_mul_f32 v0, v10, v0
  v_mul_f32 v1, v11, v1
  v_max3_f32 v8, v8, v9, v10
  v_mul_f32 v4, v10, v4
  v_mul_f32 v5, v11, v5
  v_cvt_pk_bf16_f32 v2, v0, v4
  ds_write_b32 v79, v2 offset:8704
  v_cvt_pk_bf16_f32 v3, v1, v5
  ds_write_b32 v79, v3 offset:9280
  ds_read_b128 v[12:15], v78 offset:8704
  v_max_f32 v8, v8, v11
  v_cmp_le_f32 vcc, 1317011456, v8
  v_mov_b64 v[24:25], 0
  v_mov_b64 v[26:27], 0
  ds_read_b128 v[56:59], v75 offset:33792
  s_cbranch_vccnz Cs0_mx
Cs0_mxok:
  s_waitcnt lgkmcnt(2)
  s_barrier
  ds_read_b128 v[0:3], v78 offset:8768
  s_waitcnt lgkmcnt(2)
  v_smfmac_f32_16x16x64_bf16 v[16:19], v[12:15], v[44:51], v74
  ds_read_b128 v[4:7], v78 offset:8832
  v_smfmac_f32_16x16x64_bf16 v[20:23], v[12:15], a[192:199], v74
  ds_read_b128 v[8:11], v78 offset:8896
  v_smfmac_f32_16x16x64_bf16 v[24:27], v[12:15], a[208:215], v74
  ds_read_b128 v[36:39], v75 offset:34816
  s_waitcnt lgkmcnt(3)
  v_smfmac_f32_16x16x64_bf16 v[16:19], v[0:3], v[60:67], v74
  ds_read_b128 v[40:43], v75 offset:35840
  s_waitcnt lgkmcnt(3)
  v_smfmac_f32_16x16x64_bf16 v[16:19], v[4:7], a[176:183], v74
  ds_read_b128 v[68:71], v76 offset:13824
  s_waitcnt lgkmcnt(3)
  v_smfmac_f32_16x16x64_bf16 v[16:19], v[8:11], a[184:191], v74
  ds_read_b128 v[44:47], v75 offset:49152
  v_smfmac_f32_16x16x64_bf16 v[20:23], v[0:3], a[200:207], v74
  ds_read_b128 v[48:51], v75 offset:50176
  v_smfmac_f32_16x16x64_bf16 v[20:23], v[4:7], v[52:59], v74
  ds_read_b128 v[60:63], v75 offset:51200
  s_waitcnt lgkmcnt(4)
  v_cvt_pk_bf16_f32 v16, v16, v17
  v_cvt_pk_bf16_f32 v17, v18, v19
  v_bfi_b32 v16, 1, s72, v16
  v_smfmac_f32_16x16x64_bf16 v[20:23], v[8:11], v[36:43], v74
  s_waitcnt lgkmcnt(3)
  buffer_store_dwordx2 v[16:17], v68, s[8:11], s73 offen sc1
  v_mov_b64 v[32:33], 0
  v_smfmac_f32_16x16x64_bf16 v[24:27], v[0:3], a[216:223], v74
  ds_read_b128 v[64:67], v75 offset:52224
  v_mov_b64 v[34:35], 0
  v_smfmac_f32_16x16x64_bf16 v[24:27], v[4:7], a[224:231], v74
  v_cvt_pk_bf16_f32 v20, v20, v21
  v_cvt_pk_bf16_f32 v21, v22, v23
  v_bfi_b32 v20, 1, s72, v20
  v_smfmac_f32_16x16x64_bf16 v[24:27], v[8:11], a[232:239], v74
  buffer_store_dwordx2 v[20:21], v68, s[8:11], s74 offen sc1
  s_waitcnt lgkmcnt(2)
  v_smfmac_f32_16x16x64_bf16 v[32:35], v[12:15], v[44:51], v74
  s_waitcnt lgkmcnt(0)
  v_smfmac_f32_16x16x64_bf16 v[32:35], v[0:3], v[60:67], v74
  v_cvt_pk_bf16_f32 v24, v24, v25
  v_cvt_pk_bf16_f32 v25, v26, v27
  v_bfi_b32 v24, 1, s72, v24
  v_smfmac_f32_16x16x64_bf16 v[32:35], v[4:7], a[240:247], v74
  buffer_store_dwordx2 v[24:25], v68, s[8:11], s75 offen sc1
  v_smfmac_f32_16x16x64_bf16 v[32:35], v[8:11], a[248:255], v74
  v_mov_b64 v[18:19], v[72:73]
  s_nop 4
  v_cvt_pk_bf16_f32 v32, v32, v33
  v_cvt_pk_bf16_f32 v33, v34, v35
  v_bfi_b32 v32, 1, s72, v32
  buffer_store_dwordx2 v[32:33], v68, s[8:11], s76 offen sc1
  ds_read_b128 v[0:3], v76 offset:14848
  s_waitcnt lgkmcnt(0)
  ds_read_b64 v[16:17], v77 offset:256
  s_waitcnt lgkmcnt(0)
  ds_read_b128 v[64:67], v76 offset:19456
  s_waitcnt lgkmcnt(0)
  v_xor_b32 v75, 0x8000, v75
  v_mov_b64 v[28:29], 0
  v_mov_b64 v[30:31], 0
  v_mov_b64 v[32:33], 0
  v_mov_b64 v[34:35], 0
  s_waitcnt vmcnt(0)
  buffer_load_dwordx4 v[52:55], v76, s[8:11], s60 offen offset:0 sc1
  buffer_load_dwordx4 v[56:59], v76, s[8:11], s60 offen offset:1024 sc1
  s_add_u32 s66, s66, 1
  s_xor_b32 s64, s64, 16384
  s_xor_b32 s65, s65, 16384
  s_add_u32 s58, s58, 655360
  s_add_u32 s59, s59, 655360
  s_add_u32 s70, s70, 655360
  s_add_u32 s68, s68, 655360
  s_mov_b32 m0, 10752
  s_add_u32 s85, s65, 6144
  s_waitcnt lgkmcnt(0)
  s_waitcnt vmcnt(1)
  v_mfma_f32_16x16x32_bf16 v[4:7], v[0:3], v[52:55], 0
  v_bitop3_b32 v72, v52, v54, s72 bitop3:0x7e
  s_waitcnt vmcnt(0)
  v_mfma_f32_16x16x32_bf16 v[4:7], v[0:3], v[56:59], v[4:7]
  v_bitop3_b32 v73, v56, v58, s72 bitop3:0x7e
  v_bitop3_b32 v72, v72, v73, 1 bitop3:0xa8
  v_cmp_ne_u32 vcc, 0, v72
  s_cbranch_vccnz Cs0_h1r
  s_nop 2
  v_add_f32_dpp v4, v4, v4 row_ror:4 row_mask:0xf bank_mask:0xf
  v_add_f32_dpp v5, v5, v5 row_ror:4 row_mask:0xf bank_mask:0xf
  s_nop 0
  v_add_f32_dpp v4, v4, v4 row_ror:8 row_mask:0xf bank_mask:0xf
  v_add_f32_dpp v5, v5, v5 row_ror:8 row_mask:0xf bank_mask:0xf
  v_cvt_pk_bf16_f32 v4, v4, v5
  buffer_store_dword v4, v69, s[8:11], s62 offen sc1
  s_xor_b32 s62, s62, 16384
  buffer_store_dword v71, v69, s[8:11], s62 offen sc1
  s_xor_b32 s72, s72, 1
  s_branch Cs0_h2
Cs0_h1r:
  s_mov_b64 exec, vcc
  buffer_load_dwordx4 v[52:55], v76, s[8:11], s60 offen offset:0 sc1
  buffer_load_dwordx4 v[56:59], v76, s[8:11], s60 offen offset:1024 sc1
  s_mov_b64 exec, -1
  s_add_u32 s67, s67, 1
  s_waitcnt vmcnt(1)
  v_mfma_f32_16x16x32_bf16 v[4:7], v[0:3], v[52:55], 0
  v_bitop3_b32 v72, v52, v54, s72 bitop3:0x7e
  s_waitcnt vmcnt(0)
  v_mfma_f32_16x16x32_bf16 v[4:7], v[0:3], v[56:59], v[4:7]
  v_bitop3_b32 v73, v56, v58, s72 bitop3:0x7e
  v_bitop3_b32 v72, v72, v73, 1 bitop3:0xa8
  v_cmp_ne_u32 vcc, 0, v72
  s_cbranch_vccz Cs0_h1p
Cs0_h1s:
  s_mov_b64 exec, vcc
  buffer_load_dwordx4 v[52:55], v76, s[8:11], s60 offen offset:0 sc1
  buffer_load_dwordx4 v[56:59], v76, s[8:11], s60 offen offset:1024 sc1
  s_mov_b64 exec, -1
  s_add_u32 s67, s67, 1
  s_waitcnt vmcnt(1)
  v_mfma_f32_16x16x32_bf16 v[4:7], v[0:3], v[52:55], 0
  v_bitop3_b32 v72, v52, v54, s72 bitop3:0x7e
  s_waitcnt vmcnt(0)
  v_mfma_f32_16x16x32_bf16 v[4:7], v[0:3], v[56:59], v[4:7]
  v_bitop3_b32 v73, v56, v58, s72 bitop3:0x7e
  v_bitop3_b32 v72, v72, v73, 1 bitop3:0xa8
  v_cmp_ne_u32 vcc, 0, v72
  s_cbranch_vccz Cs0_h1p
  s_cmp_lt_u32 s67, 131072
  s_cbranch_scc1 Cs0_h1s
Cs0_h1p:
  s_nop 2
  v_add_f32_dpp v4, v4, v4 row_ror:4 row_mask:0xf bank_mask:0xf
  v_add_f32_dpp v5, v5, v5 row_ror:4 row_mask:0xf bank_mask:0xf
  s_nop 0
  v_add_f32_dpp v4, v4, v4 row_ror:8 row_mask:0xf bank_mask:0xf
  v_add_f32_dpp v5, v5, v5 row_ror:8 row_mask:0xf bank_mask:0xf
  v_cvt_pk_bf16_f32 v4, v4, v5
  buffer_store_dword v4, v69, s[8:11], s62 offen sc1
  s_xor_b32 s62, s62, 16384
  buffer_store_dword v71, v69, s[8:11], s62 offen sc1
  s_xor_b32 s72, s72, 1
  s_branch Cs0_h2
Cs0_rec:
  s_nop 7
  s_waitcnt vmcnt(0) lgkmcnt(0)
  v_max3_u32 v72, v0, v1, v2
  v_max3_u32 v72, v72, v3, v4
  v_max3_u32 v72, v72, v5, v6
  v_max3_u32 v72, v72, v7, v8
  v_max3_u32 v72, v72, v9, v10
  v_max3_u32 v72, v72, v11, v12
  v_max3_u32 v72, v72, v13, v14
  v_max3_u32 v72, v72, v15, v16
  v_max3_u32 v72, v72, v17, v18
  v_max_u32 v72, v72, v19
  v_cmp_eq_u32 vcc, -1, v72
  s_cbranch_vccz Cs0_recok
  s_barrier
  v_mov_b64 v[20:21], 0
  v_mov_b64 v[22:23], 0
  v_mov_b64 v[24:25], 0
  v_mov_b64 v[26:27], 0
  v_mov_b64 v[28:29], 0
  v_mov_b64 v[30:31], 0
  v_mov_b64 v[32:33], 0
  v_mov_b64 v[34:35], 0
  s_waitcnt lgkmcnt(0)
  s_barrier
  ds_read_b128 v[0:3], v76 offset:4608
  s_waitcnt lgkmcnt(0)
  v_smfmac_f32_16x16x64_bf16 v[20:23], v[0:3], v[80:87], v74
  v_smfmac_f32_16x16x64_bf16 v[24:27], v[0:3], v[88:95], v74
  ds_read_b128 v[60:63], v76 offset:16384
  ds_read_b128 v[64:67], v76 offset:17408
  s_waitcnt lgkmcnt(0)
  v_smfmac_f32_16x16x64_bf16 v[28:31], v[0:3], v[60:67], v74
  ds_read_b128 v[60:63], v76 offset:18432
  ds_read_b128 v[64:67], v76 offset:19456
  s_waitcnt lgkmcnt(0)
  v_smfmac_f32_16x16x64_bf16 v[32:35], v[0:3], v[60:67], v74
  ds_read_b128 v[4:7], v76 offset:5632
  s_waitcnt lgkmcnt(0)
  v_smfmac_f32_16x16x64_bf16 v[20:23], v[4:7], v[96:103], v74
  v_smfmac_f32_16x16x64_bf16 v[24:27], v[4:7], v[104:111], v74
  ds_read_b128 v[60:63], v76 offset:32768
  ds_read_b128 v[64:67], v76 offset:33792
  s_waitcnt lgkmcnt(0)
  v_smfmac_f32_16x16x64_bf16 v[28:31], v[4:7], v[60:67], v74
  ds_read_b128 v[60:63], v76 offset:34816
  ds_read_b128 v[64:67], v76 offset:35840
  s_waitcnt lgkmcnt(0)
  v_smfmac_f32_16x16x64_bf16 v[32:35], v[4:7], v[60:67], v74
  ds_read_b128 v[8:11], v76 offset:6656
  s_waitcnt lgkmcnt(0)
  v_smfmac_f32_16x16x64_bf16 v[20:23], v[8:11], v[112:119], v74
  v_smfmac_f32_16x16x64_bf16 v[24:27], v[8:11], v[120:127], v74
  v_smfmac_f32_16x16x64_bf16 v[28:31], v[8:11], v[208:215], v74
  v_smfmac_f32_16x16x64_bf16 v[32:35], v[8:11], v[216:223], v74
  ds_read_b128 v[12:15], v76 offset:7680
  s_waitcnt lgkmcnt(0)
  v_smfmac_f32_16x16x64_bf16 v[20:23], v[12:15], v[128:135], v74
  v_smfmac_f32_16x16x64_bf16 v[24:27], v[12:15], v[136:143], v74
  v_smfmac_f32_16x16x64_bf16 v[28:31], v[12:15], v[224:231], v74
  v_smfmac_f32_16x16x64_bf16 v[32:35], v[12:15], v[232:239], v74
  ds_read_b128 v[0:3], v76 offset:8704
  s_waitcnt lgkmcnt(0)
  v_smfmac_f32_16x16x64_bf16 v[20:23], v[0:3], v[144:151], v74
  v_smfmac_f32_16x16x64_bf16 v[24:27], v[0:3], v[152:159], v74
  ds_read_b128 v[60:63], v76 offset:49152
  ds_read_b128 v[64:67], v76 offset:50176
  s_waitcnt lgkmcnt(0)
  v_smfmac_f32_16x16x64_bf16 v[28:31], v[0:3], v[60:67], v74
  ds_read_b128 v[60:63], v76 offset:51200
  ds_read_b128 v[64:67], v76 offset:52224
  s_waitcnt lgkmcnt(0)
  v_smfmac_f32_16x16x64_bf16 v[32:35], v[0:3], v[60:67], v74
  ds_read_b128 v[8:11], v76 offset:9728
  s_waitcnt lgkmcnt(0)
  v_smfmac_f32_16x16x64_bf16 v[20:23], v[8:11], v[160:167], v74
  v_smfmac_f32_16x16x64_bf16 v[24:27], v[8:11], v[168:175], v74
  ds_read_b128 v[60:63], v75 offset:16384
  ds_read_b128 v[64:67], v75 offset:17408
  s_waitcnt lgkmcnt(0)
  v_smfmac_f32_16x16x64_bf16 v[28:31], v[8:11], v[60:67], v74
  ds_read_b128 v[60:63], v75 offset:18432
  ds_read_b128 v[64:67], v75 offset:19456
  s_waitcnt lgkmcnt(0)
  v_smfmac_f32_16x16x64_bf16 v[32:35], v[8:11], v[60:67], v74
  ds_read_b128 v[16:19], v76 offset:10752
  ds_read_b128 v[60:63], v75 offset:0
  ds_read_b128 v[64:67], v75 offset:1024
  s_waitcnt lgkmcnt(0)
  v_smfmac_f32_16x16x64_bf16 v[20:23], v[16:19], v[60:67], v74
  ds_read_b128 v[60:63], v75 offset:2048
  ds_read_b128 v[64:67], v75 offset:3072
  s_waitcnt lgkmcnt(0)
  v_smfmac_f32_16x16x64_bf16 v[24:27], v[16:19], v[60:67], v74
  v_smfmac_f32_16x16x64_bf16 v[28:31], v[16:19], v[240:247], v74
  v_smfmac_f32_16x16x64_bf16 v[32:35], v[16:19], v[248:255], v74
  ds_read_b128 v[4:7], v76 offset:11776
  s_waitcnt lgkmcnt(0)
  v_smfmac_f32_16x16x64_bf16 v[20:23], v[4:7], v[176:183], v74
  v_smfmac_f32_16x16x64_bf16 v[24:27], v[4:7], v[184:191], v74
  v_smfmac_f32_16x16x64_bf16 v[28:31], v[4:7], a[0:7], v74
  v_smfmac_f32_16x16x64_bf16 v[32:35], v[4:7], a[8:15], v74
  ds_read_b128 v[12:15], v76 offset:12800
  s_waitcnt lgkmcnt(0)
  v_smfmac_f32_16x16x64_bf16 v[20:23], v[12:15], v[192:199], v74
  v_smfmac_f32_16x16x64_bf16 v[24:27], v[12:15], v[200:207], v74
  v_smfmac_f32_16x16x64_bf16 v[28:31], v[12:15], a[16:23], v74
  v_smfmac_f32_16x16x64_bf16 v[32:35], v[12:15], a[24:31], v74
  v_add_f32 v20, v20, v22
  v_add_f32 v21, v21, v23
  v_add_f32 v24, v24, v26
  v_cvt_pk_bf16_f32 v22, v20, v24
  ds_write_b32 v79, v22 offset:0
  v_add_f32 v25, v25, v27
  v_cvt_pk_bf16_f32 v23, v21, v25
  ds_write_b32 v79, v23 offset:576
  v_add_f32 v28, v28, v30
  v_add_f32 v29, v29, v31
  s_waitcnt lgkmcnt(0)
  s_nop 1
  s_branch Cs0_recok
Cs0_mx:
  s_waitcnt lgkmcnt(0)
  s_barrier
  buffer_load_dwordx4 v[52:55], v76, s[8:11], s59 offen offset:0 sc1
  buffer_load_dwordx4 v[0:3], v76, s[8:11], s58 offen offset:0 sc1
  ds_read_b128 v[20:23], v77 offset:0
  ds_read_b128 v[28:31], v77 offset:256
  buffer_load_dwordx4 v[56:59], v76, s[8:11], s59 offen offset:1024 sc1
  buffer_load_dwordx4 v[4:7], v76, s[8:11], s58 offen offset:1024 sc1
  ds_read_b128 v[24:27], v77 offset:128
  ds_read_b128 v[32:35], v77 offset:384
  s_waitcnt vmcnt(2) lgkmcnt(3)
  v_mfma_f32_16x16x32_bf16 v[8:11], v[0:3], v[20:23], 0
  s_waitcnt vmcnt(0) lgkmcnt(1)
  v_mfma_f32_16x16x32_bf16 v[8:11], v[4:7], v[24:27], v[8:11]
  v_mfma_f32_16x16x32_bf16 v[12:15], v[28:31], v[20:23], 0
  s_waitcnt lgkmcnt(0)
  v_mfma_f32_16x16x32_bf16 v[12:15], v[32:35], v[24:27], v[12:15]
  v_add_f32_dpp v8, v10, v8 quad_perm:[2,3,0,1] row_mask:0xf bank_mask:0xf
  v_add_f32_dpp v9, v11, v9 quad_perm:[2,3,0,1] row_mask:0xf bank_mask:0xf
  s_nop 0
  v_mov_b32_dpp v8, v8 quad_perm:[0,1,0,1] row_mask:0xf bank_mask:0xf
  v_mov_b32_dpp v9, v9 quad_perm:[0,1,0,1] row_mask:0xf bank_mask:0xf
  s_nop 1
  v_add_f32_dpp v12, v14, v12 quad_perm:[2,3,0,1] row_mask:0xf bank_mask:0xf
  v_add_f32_dpp v13, v15, v13 quad_perm:[2,3,0,1] row_mask:0xf bank_mask:0xf
  s_nop 0
  v_mov_b32_dpp v12, v12 quad_perm:[0,1,0,1] row_mask:0xf bank_mask:0xf
  v_mov_b32_dpp v13, v13 quad_perm:[0,1,0,1] row_mask:0xf bank_mask:0xf
  v_mul_f32 v12, s69, v12
  ds_write_b32 v78, v8 offset:8704
  v_mul_f32 v13, s69, v13
  ds_write_b32 v78, v9 offset:8768
  s_waitcnt lgkmcnt(0)
  s_barrier
  ds_read_b128 v[36:39], v78 offset:8704
  ds_read_b128 v[40:43], v78 offset:8768
  s_waitcnt lgkmcnt(0)
  s_barrier
  v_max_f32 v16, v36, v37
  v_max3_f32 v16, v16, v38, v39
  v_max3_f32 v16, v16, v40, v41
  v_max3_f32 v16, v16, v42, v43
  v_max3_f32 v16, v16, v12, v13
  v_mov_b32 v17, v16
  s_nop 1
  v_permlane16_swap_b32 v16, v17
  v_max_f32 v16, v16, v17
  v_mov_b32 v17, v16
  s_nop 1
  v_permlane32_swap_b32 v16, v17
  v_max_f32 v16, v16, v17
  v_sub_f32 v36, v36, v16
  v_sub_f32 v37, v37, v16
  v_sub_f32 v38, v38, v16
  v_sub_f32 v39, v39, v16
  v_sub_f32 v40, v40, v16
  v_sub_f32 v41, v41, v16
  v_sub_f32 v42, v42, v16
  v_sub_f32 v43, v43, v16
  v_sub_f32 v12, v12, v16
  v_sub_f32 v13, v13, v16
  v_exp_f32 v36, v36
  v_exp_f32 v37, v37
  v_exp_f32 v38, v38
  v_exp_f32 v39, v39
  v_exp_f32 v40, v40
  v_exp_f32 v41, v41
  v_exp_f32 v42, v42
  v_exp_f32 v43, v43
  v_exp_f32 v12, v12
  v_exp_f32 v13, v13
  v_cvt_pk_bf16_f32 v32, v36, v40
  v_cvt_pk_bf16_f32 v33, v37, v41
  v_cvt_pk_bf16_f32 v34, v38, v42
  v_cvt_pk_bf16_f32 v35, v39, v43
  v_cvt_pk_bf16_f32 v28, v12, v13
  v_cvt_pk_bf16_f32 v31, v12, v13
  v_mov_b32 v29, 0
  v_mov_b32 v30, 0
  v_mfma_f32_16x16x32_bf16 v[8:11], v[32:35], v[68:71], 0
  v_mfma_f32_16x16x32_bf16 v[0:3], v[32:35], v[52:55], 0
  v_mfma_f32_16x16x32_bf16 v[4:7], v[32:35], v[56:59], 0
  v_mfma_f32_16x16x16_bf16 v[8:11], v[28:29], v[68:69], v[8:11]
  v_mfma_f32_16x16x16_bf16 v[0:3], v[28:29], v[72:73], v[0:3]
  v_mfma_f32_16x16x16_bf16 v[4:7], v[30:31], v[72:73], v[4:7]
  ds_read_b128 v[52:55], v75 offset:32768
  v_rcp_f32 v10, v8
  v_rcp_f32 v11, v9
  v_mul_f32 v0, v10, v0
  v_mul_f32 v1, v11, v1
  v_max3_f32 v8, v8, v9, v10
  v_mul_f32 v4, v10, v4
  v_mul_f32 v5, v11, v5
  v_cvt_pk_bf16_f32 v2, v0, v4
  ds_write_b32 v79, v2 offset:8704
  v_cvt_pk_bf16_f32 v3, v1, v5
  ds_write_b32 v79, v3 offset:9280
  ds_read_b128 v[12:15], v78 offset:8704
  ds_read_b128 v[56:59], v75 offset:33792
  v_mov_b64 v[16:17], 0
  v_mov_b64 v[18:19], 0
  v_mov_b64 v[20:21], 0
  v_mov_b64 v[22:23], 0
  v_mov_b64 v[24:25], 0
  v_mov_b64 v[26:27], 0
  s_branch Cs0_mxok
Cs0_kv3:
  s_waitcnt lgkmcnt(0)
  s_cmp_ge_u32 s57, 0x700
  s_cbranch_scc1 Cs0_kvb
  s_load_dword s57, s[12:13], s71 glc
  s_add_u32 s67, s67, 1
  s_cmp_lt_u32 s67, 131072
  s_cbranch_scc1 Cs0_kv3
  s_waitcnt lgkmcnt(0)
  s_branch Cs0_kvb
Cs0_last:
  ds_read_b128 v[4:7], v76 offset:5632
  ds_read_b128 v[12:15], v76 offset:7680
  ds_read_b128 v[44:47], v76 offset:32768
  ds_read_b128 v[48:51], v76 offset:33792
  s_nop 5
  v_mov_b64 v[20:21], 0
  v_mov_b64 v[22:23], 0
  v_mov_b64 v[24:25], 0
  v_mov_b64 v[26:27], 0
  v_smfmac_f32_16x16x64_bf16 v[28:31], v[0:3], v[36:43], v74
  ds_read_b128 v[36:39], v76 offset:34816
  ds_read_b128 v[40:43], v76 offset:35840
  v_smfmac_f32_16x16x64_bf16 v[32:35], v[0:3], v[60:67], v74
  s_waitcnt lgkmcnt(5)
  v_smfmac_f32_16x16x64_bf16 v[20:23], v[0:3], a[32:39], v74
  ds_read_b128 v[60:63], v76 offset:49152
  ds_read_b128 v[64:67], v76 offset:50176
  v_smfmac_f32_16x16x64_bf16 v[24:27], v[0:3], a[40:47], v74
  s_waitcnt lgkmcnt(4)
  v_smfmac_f32_16x16x64_bf16 v[20:23], v[4:7], a[48:55], v74
  buffer_store_dwordx4 v[16:19], v76, s[8:11], s68 offen sc1
  v_smfmac_f32_16x16x64_bf16 v[24:27], v[4:7], a[56:63], v74
  v_smfmac_f32_16x16x64_bf16 v[28:31], v[4:7], v[44:51], v74
  s_waitcnt lgkmcnt(2)
  v_smfmac_f32_16x16x64_bf16 v[20:23], v[8:11], a[64:71], v74
  ds_read_b128 v[44:47], v76 offset:51200
  ds_read_b128 v[48:51], v76 offset:52224
  v_smfmac_f32_16x16x64_bf16 v[24:27], v[8:11], a[72:79], v74
  v_smfmac_f32_16x16x64_bf16 v[32:35], v[4:7], v[36:43], v74
  v_smfmac_f32_16x16x64_bf16 v[28:31], v[8:11], v[208:215], v74
  ds_read_b128 v[36:39], v75 offset:16384
  ds_read_b128 v[40:43], v75 offset:17408
  v_smfmac_f32_16x16x64_bf16 v[32:35], v[8:11], v[216:223], v74
  v_smfmac_f32_16x16x64_bf16 v[20:23], v[12:15], a[80:87], v74
  v_smfmac_f32_16x16x64_bf16 v[24:27], v[12:15], a[88:95], v74
  v_smfmac_f32_16x16x64_bf16 v[28:31], v[12:15], v[224:231], v74
  v_smfmac_f32_16x16x64_bf16 v[32:35], v[12:15], v[232:239], v74
  s_waitcnt vmcnt(1)
  s_barrier
Cs0_lastr:
  ds_read_b128 v[0:3], v76 offset:8704
  ds_read_b128 v[8:11], v76 offset:9728
  ds_read_b128 v[16:19], v76 offset:10752
  ds_read_b128 v[4:7], v76 offset:11776
  ds_read_b128 v[12:15], v76 offset:12800
  s_waitcnt lgkmcnt(4)
  v_max3_u32 v72, v0, v1, v2
  s_waitcnt lgkmcnt(1)
  v_max3_u32 v72, v72, v3, v4
  v_max3_u32 v72, v72, v5, v6
  v_max3_u32 v72, v72, v7, v8
  v_max3_u32 v72, v72, v9, v10
  s_waitcnt lgkmcnt(0)
  v_max3_u32 v72, v72, v11, v12
  v_max3_u32 v72, v72, v13, v14
  v_max3_u32 v72, v72, v15, v16
  v_max3_u32 v72, v72, v17, v18
  v_max_u32 v72, v72, v19
  v_cmp_eq_u32 vcc, -1, v72
  s_cbranch_vccnz Cs0_lastp
Cs0_lastg:
  v_smfmac_f32_16x16x64_bf16 v[28:31], v[0:3], v[60:67], v74
  ds_read_b128 v[60:63], v75 offset:18432
  ds_read_b128 v[64:67], v75 offset:19456
  v_smfmac_f32_16x16x64_bf16 v[32:35], v[0:3], v[44:51], v74
  v_smfmac_f32_16x16x64_bf16 v[28:31], v[8:11], v[36:43], v74
  v_smfmac_f32_16x16x64_bf16 v[28:31], v[16:19], v[240:247], v74
  v_smfmac_f32_16x16x64_bf16 v[28:31], v[4:7], a[0:7], v74
  v_smfmac_f32_16x16x64_bf16 v[28:31], v[12:15], a[16:23], v74
  v_smfmac_f32_16x16x64_bf16 v[32:35], v[16:19], v[248:255], v74
  v_smfmac_f32_16x16x64_bf16 v[32:35], v[4:7], a[8:15], v74
  s_waitcnt lgkmcnt(0)
  v_smfmac_f32_16x16x64_bf16 v[32:35], v[12:15], a[24:31], v74
  v_smfmac_f32_16x16x64_bf16 v[32:35], v[8:11], v[60:67], v74
  v_smfmac_f32_16x16x64_bf16 v[20:23], v[0:3], a[96:103], v74
  v_smfmac_f32_16x16x64_bf16 v[20:23], v[8:11], a[112:119], v74
  v_add_f32 v28, v28, v30
  v_add_f32 v32, v32, v34
  v_cvt_pk_bf16_f32 v30, v28, v32
  v_smfmac_f32_16x16x64_bf16 v[20:23], v[16:19], a[128:135], v74
  ds_write_b32 v79, v30 offset:256
  v_add_f32 v29, v29, v31
  v_add_f32 v33, v33, v35
  v_cvt_pk_bf16_f32 v31, v29, v33
  v_smfmac_f32_16x16x64_bf16 v[20:23], v[4:7], a[144:151], v74
  ds_write_b32 v79, v31 offset:832
  v_smfmac_f32_16x16x64_bf16 v[20:23], v[12:15], a[160:167], v74
  v_smfmac_f32_16x16x64_bf16 v[24:27], v[0:3], a[104:111], v74
  v_smfmac_f32_16x16x64_bf16 v[24:27], v[8:11], a[120:127], v74
  v_smfmac_f32_16x16x64_bf16 v[24:27], v[16:19], a[136:143], v74
  s_waitcnt lgkmcnt(0)
  s_barrier
  ds_read_b64 v[52:53], v77 offset:256
  v_add_f32 v20, v20, v22
  v_smfmac_f32_16x16x64_bf16 v[24:27], v[4:7], a[152:159], v74
  v_add_f32 v21, v21, v23
  v_smfmac_f32_16x16x64_bf16 v[24:27], v[12:15], a[168:175], v74
  v_cvt_pk_bf16_f32 v54, v20, v21
  s_add_u32 s68, s68, 655360
  s_nop 3
  v_add_f32 v24, v24, v26
  v_add_f32 v25, v25, v27
  v_cvt_pk_bf16_f32 v55, v24, v25
  s_waitcnt lgkmcnt(0)
  buffer_store_dwordx4 v[52:55], v76, s[8:11], s68 offen sc1
  s_branch Cs0_done
Cs0_lastp:
  s_add_u32 s72, s72, 2
  s_cmp_ge_u32 s72, 131072
  s_cbranch_scc1 Cs0_lastg
  s_barrier
  buffer_load_dwordx4 v76, s[8:11], s85 offen offset:0 sc1 lds
  s_waitcnt vmcnt(0)
  s_barrier
  s_branch Cs0_lastr
Cs0_done:
  s_branch L_cexit
L_w5:
  v_mov_b64 v[20:21], 0
  v_mov_b64 v[22:23], 0
  v_mov_b64 v[24:25], 0
  v_mov_b64 v[26:27], 0
  v_mov_b64 v[28:29], 0
  v_mov_b64 v[30:31], 0
  v_mov_b64 v[32:33], 0
  v_mov_b64 v[34:35], 0
  s_mov_b32 s78, 0x3f803f80
  s_mov_b32 s79, s78
  s_mov_b32 s65, 360448
  s_mov_b32 m0, 15872
  s_lshl_b32 s71, s53, 2
  s_add_u32 s71, s71, 128
  s_movk_i32 s56, 0x1000
  v_lshlrev_b32 v73, 2, v76
  v_mov_b32 v72, 0
  s_mov_b64 s[16:17], s[8:9]
  s_mov_b32 s18, 268435456
  s_mov_b32 s19, 0x20000
  s_getpc_b64 s[20:21]
Cs1_pc:
  s_add_u32 s20, s20, (Cs1_last - Cs1_pc)
  s_addc_u32 s21, s21, 0
  v_mov_b32 v68, 14880
  buffer_load_dwordx4 v[52:55], v76, s[8:11], s59 offen offset:0 sc1
  buffer_load_dwordx4 v[56:59], v76, s[8:11], s59 offen offset:1024 sc1
  ds_read_b128 v[36:39], v76 offset:20480
  ds_read_b128 v[40:43], v76 offset:21504
  ds_read_b128 v[60:63], v76 offset:22528
  ds_read_b128 v[64:67], v76 offset:23552
  ds_read_b128 v[0:3], v76 offset:4608
  ds_read_b128 v[4:7], v76 offset:5632
  ds_read_b128 v[8:11], v76 offset:6656
  ds_read_b128 v[12:15], v76 offset:7680
  s_waitcnt lgkmcnt(0)
  s_cmp_eq_u32 s66, 1
  s_branch Cs1_top2
.p2align 6
Cs1_h2:
  ds_read_b128 v[36:39], v76 offset:20480
  ds_read_b128 v[40:43], v76 offset:21504
  v_lshlrev_b32 v73, 2, v76
  ds_read_b128 v[60:63], v76 offset:22528
  s_cmp_eq_u32 s66, 62
  s_cselect_b64 s[16:17], s[20:21], s[16:17]
  s_cselect_b32 s18, (Cs1_done - Cs1_last), s18
  s_cselect_b32 s70, 0, s70
  s_cmp_eq_u32 s66, 63
  s_cselect_b32 s59, 268435456, s59
  s_cselect_b32 s58, 268435456, s58
  buffer_load_dwordx4 v[52:55], v76, s[8:11], s59 offen offset:0 sc1
  buffer_load_dwordx4 v[56:59], v76, s[8:11], s59 offen offset:1024 sc1
  s_waitcnt vmcnt(0)
  s_mov_b64 vcc, -1
Cs1_h2r:
  s_mov_b64 exec, vcc
  buffer_load_dwordx4 v[8:11], v76, s[8:11], s65 offen offset:2048 sc1
  buffer_load_dwordx4 v[0:3], v76, s[8:11], s85 offen offset:0 sc1
  s_mov_b64 exec, -1
  s_add_u32 s67, s67, 1
  s_cmp_lt_u32 s67, 131072
  s_cselect_b32 s54, -2, -1
  s_waitcnt vmcnt(1)
  v_max3_u32 v72, v8, v9, v10
  s_waitcnt vmcnt(0)
  v_max3_u32 v72, v72, v11, v0
  v_max3_u32 v72, v72, v1, v2
  v_max_u32 v72, v72, v3
  v_cmp_lt_u32 vcc, s54, v72
  s_cbranch_vccnz Cs1_h2r
  ds_write_b128 v76, v[8:11] offset:6656
  ds_write_b128 v76, v[0:3] offset:11776
Cs1_h2w:
  s_cmp_eq_u32 s66, 63
  s_waitcnt lgkmcnt(0)
  s_barrier
  ds_read_b128 v[0:3], v76 offset:4608
Cs1_top2:
  v_smfmac_f32_16x16x64_bf16 v[20:23], v[8:11], v[112:119], v74
  s_cbranch_scc1 Cs1_last
  v_smfmac_f32_16x16x64_bf16 v[24:27], v[8:11], v[120:127], v74
  buffer_load_dwordx4 v[44:47], v76, s[8:11], s58 offen offset:0 sc1
  s_mov_b32 m0, 15872
  v_smfmac_f32_16x16x64_bf16 v[28:31], v[8:11], v[208:215], v74
  buffer_load_dwordx4 v[48:51], v76, s[8:11], s58 offen offset:1024 sc1
  v_smfmac_f32_16x16x64_bf16 v[32:35], v[8:11], v[216:223], v74
  ds_read_b128 v[4:7], v76 offset:5632
  s_waitcnt lgkmcnt(1)
  v_smfmac_f32_16x16x64_bf16 v[20:23], v[0:3], v[80:87], v74
  ds_read_b128 v[12:15], v76 offset:7680
  v_smfmac_f32_16x16x64_bf16 v[28:31], v[0:3], v[36:43], v74
  ds_read_b128 v[36:39], v76 offset:36864
  v_smfmac_f32_16x16x64_bf16 v[24:27], v[0:3], v[88:95], v74
  buffer_store_dwordx4 v[16:19], v76, s[8:11], s68 offen sc1
  ds_read_b128 v[40:43], v76 offset:37888
  v_smfmac_f32_16x16x64_bf16 v[32:35], v[0:3], v[60:67], v74
  buffer_load_dword v73, s[16:19], s70 offen lds
  ds_read_b128 v[60:63], v76 offset:38912
  s_waitcnt lgkmcnt(4)
  v_smfmac_f32_16x16x64_bf16 v[20:23], v[4:7], v[96:103], v74
  ds_read_b128 v[64:67], v76 offset:39936
  v_smfmac_f32_16x16x64_bf16 v[24:27], v[4:7], v[104:111], v74
  s_waitcnt vmcnt(4)
  s_waitcnt lgkmcnt(4)
  v_smfmac_f32_16x16x64_bf16 v[20:23], v[12:15], v[128:135], v74
  s_barrier
  ds_read_b128 v[8:11], v76 offset:8704
  s_waitcnt lgkmcnt(3)
  v_smfmac_f32_16x16x64_bf16 v[28:31], v[4:7], v[36:43], v74
  ds_read_b128 v[36:39], v76 offset:53248
  v_smfmac_f32_16x16x64_bf16 v[24:27], v[12:15], v[136:143], v74
  ds_read_b128 v[40:43], v76 offset:54272
  s_waitcnt lgkmcnt(3)
  v_smfmac_f32_16x16x64_bf16 v[32:35], v[4:7], v[60:67], v74
  ds_read_b128 v[0:3], v76 offset:9728
  v_smfmac_f32_16x16x64_bf16 v[28:31], v[12:15], v[224:231], v74
  ds_read_b128 v[60:63], v76 offset:55296
  v_smfmac_f32_16x16x64_bf16 v[32:35], v[12:15], v[232:239], v74
  ds_read_b128 v[64:67], v76 offset:56320
  s_waitcnt lgkmcnt(5)
  v_smfmac_f32_16x16x64_bf16 v[20:23], v[8:11], v[144:151], v74
  s_barrier
  ds_read_b128 v[4:7], v76 offset:11776
  s_waitcnt lgkmcnt(4)
  v_smfmac_f32_16x16x64_bf16 v[28:31], v[8:11], v[36:43], v74
  ds_read_b128 v[12:15], v76 offset:12800
  ds_read_b128 v[36:39], v75 offset:4096
  v_smfmac_f32_16x16x64_bf16 v[24:27], v[8:11], v[152:159], v74
  ds_read_b128 v[16:19], v76 offset:10752
  s_waitcnt lgkmcnt(6)
  v_smfmac_f32_16x16x64_bf16 v[20:23], v[0:3], v[160:167], v74
  ds_read_b128 v[40:43], v75 offset:5120
  s_waitcnt lgkmcnt(5)
  v_smfmac_f32_16x16x64_bf16 v[32:35], v[8:11], v[60:67], v74
  ds_read_b128 v[60:63], v75 offset:6144
  v_smfmac_f32_16x16x64_bf16 v[24:27], v[0:3], v[168:175], v74
  ds_read_b128 v[64:67], v75 offset:7168
  s_waitcnt lgkmcnt(6)
  v_smfmac_f32_16x16x64_bf16 v[20:23], v[4:7], v[176:183], v74
  s_waitcnt lgkmcnt(5)
  v_smfmac_f32_16x16x64_bf16 v[20:23], v[12:15], v[192:199], v74
  s_waitcnt lgkmcnt(2)
  v_smfmac_f32_16x16x64_bf16 v[20:23], v[16:19], v[36:43], v74
  ds_read_b128 v[36:39], v75 offset:20480
  v_smfmac_f32_16x16x64_bf16 v[24:27], v[4:7], v[184:191], v74
  ds_read_b128 v[40:43], v75 offset:21504
  s_waitcnt lgkmcnt(2)
  v_smfmac_f32_16x16x64_bf16 v[24:27], v[16:19], v[60:67], v74
  ds_read_b128 v[60:63], v75 offset:22528
  v_add_f32 v20, v20, v22
  v_smfmac_f32_16x16x64_bf16 v[24:27], v[12:15], v[200:207], v74
  ds_read_b128 v[64:67], v75 offset:23552
  v_add_f32 v21, v21, v23
  v_smfmac_f32_16x16x64_bf16 v[28:31], v[16:19], v[240:247], v74
  v_mov_b64 v[70:71], s[78:79]
  v_smfmac_f32_16x16x64_bf16 v[28:31], v[4:7], a[0:7], v74
  s_waitcnt lgkmcnt(2)
  v_add_f32 v24, v24, v26
  v_smfmac_f32_16x16x64_bf16 v[28:31], v[0:3], v[36:43], v74
  ds_read_b128 v[36:39], v68
  v_cvt_pk_bf16_f32 v22, v20, v24
  v_smfmac_f32_16x16x64_bf16 v[28:31], v[12:15], a[16:23], v74
  ds_read_b128 v[40:43], v68
  ds_write_b32 v79, v22 offset:0
  s_waitcnt lgkmcnt(3)
  v_add_f32 v25, v25, v27
  v_cvt_pk_bf16_f32 v23, v21, v25
  v_smfmac_f32_16x16x64_bf16 v[32:35], v[0:3], v[60:67], v74
  ds_write_b32 v79, v23 offset:576
  v_cmp_u_f32 vcc, v20, v21
  v_smfmac_f32_16x16x64_bf16 v[32:35], v[16:19], v[248:255], v74
  v_add_f32 v28, v28, v30
  v_smfmac_f32_16x16x64_bf16 v[32:35], v[4:7], a[8:15], v74
  v_add_f32 v29, v29, v31
  v_smfmac_f32_16x16x64_bf16 v[32:35], v[12:15], a[24:31], v74
  s_cbranch_vccnz Cs1_rec
Cs1_recok:
  s_waitcnt lgkmcnt(3)
  v_smfmac_f32_16x16x64_bf16 v[36:39], v[16:19], a[128:135], v74
  s_waitcnt lgkmcnt(0)
  s_barrier
  ds_read_b128 v[60:63], v77
  v_smfmac_f32_16x16x64_bf16 v[40:43], v[16:19], a[136:143], v74
  ds_read_b128 v[64:67], v77 offset:128
  v_add_f32 v32, v32, v34
  v_cvt_pk_bf16_f32 v30, v28, v32
  v_smfmac_f32_16x16x64_bf16 v[36:39], v[0:3], a[112:119], v74
  ds_write_b32 v79, v30 offset:256
  v_add_f32 v33, v33, v35
  v_cvt_pk_bf16_f32 v31, v29, v33
  v_smfmac_f32_16x16x64_bf16 v[40:43], v[0:3], a[120:127], v74
  ds_write_b32 v79, v31 offset:832
  v_xor_b32 v75, 0x8000, v75
  v_smfmac_f32_16x16x64_bf16 v[36:39], v[4:7], a[144:151], v74
  ds_read_b128 v[0:3], v76 offset:4608
  v_mov_b32 v29, 0
  v_smfmac_f32_16x16x64_bf16 v[40:43], v[4:7], a[152:159], v74
  s_waitcnt vmcnt(2) lgkmcnt(3)
  v_mov_b32 v30, 0
  v_mfma_f32_16x16x32_bf16 v[44:47], v[44:47], v[60:63], 0
  ds_read_b128 v[4:7], v76 offset:5632
  s_waitcnt lgkmcnt(2)
  v_mfma_f32_16x16x32_bf16 v[44:47], v[48:51], v[64:67], v[44:47]
  s_barrier
  v_smfmac_f32_16x16x64_bf16 v[36:39], v[8:11], a[96:103], v74
  ds_read_b128 v[20:23], v77 offset:256
  ds_read_b128 v[24:27], v77 offset:384
  v_smfmac_f32_16x16x64_bf16 v[40:43], v[8:11], a[104:111], v74
  ds_read_b128 v[8:11], v76 offset:6656
  v_add_f32_dpp v72, v46, v44 quad_perm:[2,3,0,1] row_mask:0xf bank_mask:0xf
  v_add_f32_dpp v73, v47, v45 quad_perm:[2,3,0,1] row_mask:0xf bank_mask:0xf
  v_smfmac_f32_16x16x64_bf16 v[36:39], v[12:15], a[160:167], v74
  s_waitcnt lgkmcnt(4)
  v_exp_f32_dpp v72, v72 quad_perm:[0,1,0,1] row_mask:0xf bank_mask:0xf
  v_smfmac_f32_16x16x64_bf16 v[40:43], v[12:15], a[168:175], v74
  ds_read_b128 v[12:15], v76 offset:7680
  v_exp_f32_dpp v73, v73 quad_perm:[0,1,0,1] row_mask:0xf bank_mask:0xf
  v_smfmac_f32_16x16x64_bf16 v[36:39], v[0:3], a[32:39], v74
  s_waitcnt lgkmcnt(2)
  v_cvt_pk_bf16_f32 v72, v72, v73
  v_mfma_f32_16x16x32_bf16 v[20:23], v[20:23], v[60:63], 0
  ds_write_b32 v78, v72 offset:516
  v_mov_b64 v[16:17], 0
  v_mfma_f32_16x16x32_bf16 v[20:23], v[24:27], v[64:67], v[20:23]
  ds_read_b128 v[44:47], v75 offset:22528
  v_mov_b64 v[18:19], 0
  v_smfmac_f32_16x16x64_bf16 v[40:43], v[0:3], a[40:47], v74
  ds_read_b128 v[48:51], v75 offset:23552
  v_mov_b64 v[68:69], s[78:79]
  v_smfmac_f32_16x16x64_bf16 v[36:39], v[4:7], a[48:55], v74
  s_waitcnt lgkmcnt(4)
  v_add_f32_dpp v24, v22, v20 quad_perm:[2,3,0,1] row_mask:0xf bank_mask:0xf
  v_add_f32_dpp v25, v23, v21 quad_perm:[2,3,0,1] row_mask:0xf bank_mask:0xf
  v_smfmac_f32_16x16x64_bf16 v[36:39], v[8:11], a[64:71], v74
  s_waitcnt lgkmcnt(2)
  s_barrier
  ds_read_b128 v[32:35], v78 offset:512
  v_smfmac_f32_16x16x64_bf16 v[36:39], v[12:15], a[80:87], v74
  ds_read_b128 v[60:63], v75 offset:20480
  v_mul_f32 v24, s69, v24
  v_smfmac_f32_16x16x64_bf16 v[40:43], v[4:7], a[56:63], v74
  ds_read_b128 v[64:67], v75 offset:21504
  v_mul_f32 v25, s69, v25
  v_smfmac_f32_16x16x64_bf16 v[40:43], v[8:11], a[72:79], v74
  v_exp_f32_dpp v24, v24 quad_perm:[0,1,0,1] row_mask:0xf bank_mask:0xf
  v_smfmac_f32_16x16x64_bf16 v[40:43], v[12:15], a[88:95], v74
  s_waitcnt lgkmcnt(2)
  v_exp_f32_dpp v25, v25 quad_perm:[0,1,0,1] row_mask:0xf bank_mask:0xf
  v_mfma_f32_16x16x32_bf16 v[8:11], v[32:35], v[68:71], 0
  v_add_f32 v36, v36, v38
  v_add_f32 v37, v37, v39
  v_mfma_f32_16x16x32_bf16 v[0:3], v[32:35], v[52:55], 0
  v_add_f32 v40, v40, v42
  v_add_f32 v41, v41, v43
  v_mfma_f32_16x16x32_bf16 v[4:7], v[32:35], v[56:59], 0
  v_cvt_pk_bf16_f32 v28, v24, v25
  v_cvt_pk_bf16_f32 v72, v36, v37
  v_cvt_pk_bf16_f32 v73, v40, v41
  v_mfma_f32_16x16x16_bf16 v[8:11], v[28:29], v[68:69], v[8:11]
  v_cvt_pk_bf16_f32 v31, v24, v25
  v_mov_b64 v[20:21], 0
  v_mfma_f32_16x16x16_bf16 v[0:3], v[28:29], v[72:73], v[0:3]
  ds_read_b128 v[52:55], v75 offset:36864
  v_mov_b64 v[22:23], 0
  v_mfma_f32_16x16x16_bf16 v[4:7], v[30:31], v[72:73], v[4:7]
  v_rcp_f32 v10, v8
  v_rcp_f32 v11, v9
  v_mul_f32 v0, v10, v0
  v_mul_f32 v1, v11, v1
  v_max3_f32 v8, v8, v9, v10
  v_mul_f32 v4, v10, v4
  v_mul_f32 v5, v11, v5
  v_cvt_pk_bf16_f32 v2, v0, v4
  ds_write_b32 v79, v2 offset:8704
  v_cvt_pk_bf16_f32 v3, v1, v5
  ds_write_b32 v79, v3 offset:9280
  ds_read_b128 v[12:15], v78 offset:8768
  v_max_f32 v8, v8, v11
  v_cmp_le_f32 vcc, 1317011456, v8
  v_mov_b64 v[24:25], 0
  v_mov_b64 v[26:27], 0
  ds_read_b128 v[56:59], v75 offset:37888
  s_cbranch_vccnz Cs1_mx
Cs1_mxok:
  s_waitcnt lgkmcnt(2)
  s_barrier
  ds_read_b128 v[0:3], v78 offset:8704
  s_waitcnt lgkmcnt(2)
  v_smfmac_f32_16x16x64_bf16 v[16:19], v[12:15], v[44:51], v74
  ds_read_b128 v[4:7], v78 offset:8832
  v_smfmac_f32_16x16x64_bf16 v[20:23], v[12:15], a[200:207], v74
  ds_read_b128 v[8:11], v78 offset:8896
  v_smfmac_f32_16x16x64_bf16 v[24:27], v[12:15], a[216:223], v74
  ds_read_b128 v[36:39], v75 offset:38912
  s_waitcnt lgkmcnt(3)
  v_smfmac_f32_16x16x64_bf16 v[16:19], v[0:3], v[60:67], v74
  ds_read_b128 v[40:43], v75 offset:39936
  s_waitcnt lgkmcnt(3)
  v_smfmac_f32_16x16x64_bf16 v[16:19], v[4:7], a[176:183], v74
  ds_read_b128 v[68:71], v76 offset:13824
  s_waitcnt lgkmcnt(3)
  v_smfmac_f32_16x16x64_bf16 v[16:19], v[8:11], a[184:191], v74
  ds_read_b128 v[44:47], v75 offset:53248
  v_smfmac_f32_16x16x64_bf16 v[20:23], v[0:3], a[192:199], v74
  ds_read_b128 v[48:51], v75 offset:54272
  v_smfmac_f32_16x16x64_bf16 v[20:23], v[4:7], v[52:59], v74
  ds_read_b128 v[60:63], v75 offset:55296
  s_waitcnt lgkmcnt(4)
  v_cvt_pk_bf16_f32 v16, v16, v17
  v_cvt_pk_bf16_f32 v17, v18, v19
  v_bfi_b32 v16, 1, s72, v16
  v_smfmac_f32_16x16x64_bf16 v[20:23], v[8:11], v[36:43], v74
  s_waitcnt lgkmcnt(3)
  buffer_store_dwordx2 v[16:17], v68, s[8:11], s73 offen sc1
  v_mov_b64 v[32:33], 0
  v_smfmac_f32_16x16x64_bf16 v[24:27], v[0:3], a[208:215], v74
  ds_read_b128 v[64:67], v75 offset:56320
  v_mov_b64 v[34:35], 0
  v_smfmac_f32_16x16x64_bf16 v[24:27], v[4:7], a[224:231], v74
  v_cvt_pk_bf16_f32 v20, v20, v21
  v_cvt_pk_bf16_f32 v21, v22, v23
  v_bfi_b32 v20, 1, s72, v20
  v_smfmac_f32_16x16x64_bf16 v[24:27], v[8:11], a[232:239], v74
  buffer_store_dwordx2 v[20:21], v68, s[8:11], s74 offen sc1
  s_waitcnt lgkmcnt(2)
  v_smfmac_f32_16x16x64_bf16 v[32:35], v[0:3], v[44:51], v74
  s_waitcnt lgkmcnt(0)
  v_smfmac_f32_16x16x64_bf16 v[32:35], v[12:15], v[60:67], v74
  v_cvt_pk_bf16_f32 v24, v24, v25
  v_cvt_pk_bf16_f32 v25, v26, v27
  v_bfi_b32 v24, 1, s72, v24
  v_smfmac_f32_16x16x64_bf16 v[32:35], v[4:7], a[240:247], v74
  buffer_store_dwordx2 v[24:25], v68, s[8:11], s75 offen sc1
  v_smfmac_f32_16x16x64_bf16 v[32:35], v[8:11], a[248:255], v74
  v_mov_b64 v[18:19], v[72:73]
  s_nop 4
  v_cvt_pk_bf16_f32 v32, v32, v33
  v_cvt_pk_bf16_f32 v33, v34, v35
  v_bfi_b32 v32, 1, s72, v32
  buffer_store_dwordx2 v[32:33], v68, s[8:11], s76 offen sc1
  ds_read_b128 v[0:3], v76 offset:14848
  s_waitcnt lgkmcnt(0)
  ds_read_b64 v[16:17], v77 offset:264
  s_waitcnt lgkmcnt(0)
  ds_read_b128 v[64:67], v76 offset:23552
  s_waitcnt lgkmcnt(0)
  s_add_u32 s66, s66, 1
  s_xor_b32 s64, s64, 16384
  s_xor_b32 s65, s65, 16384
  s_add_u32 s58, s58, 655360
  s_add_u32 s59, s59, 655360
  s_add_u32 s70, s70, 655360
  s_add_u32 s68, s68, 655360
  s_mov_b32 m0, 11776
  s_add_u32 s85, s65, 7168
  v_xor_b32 v75, 0x8000, v75
  v_mov_b64 v[28:29], 0
  v_mov_b64 v[30:31], 0
  v_mov_b64 v[32:33], 0
  v_mov_b64 v[34:35], 0
  v_mov_b64 v[20:21], 0
  v_mov_b64 v[22:23], 0
  v_mov_b64 v[24:25], 0
  v_mov_b64 v[26:27], 0
  v_mov_b32 v68, 14880
  s_waitcnt vmcnt(0)
  buffer_load_dwordx4 v[52:55], v76, s[8:11], s60 offen offset:0 sc1
  buffer_load_dwordx4 v[56:59], v76, s[8:11], s60 offen offset:1024 sc1
  s_waitcnt lgkmcnt(0)
  s_waitcnt vmcnt(1)
  v_mfma_f32_16x16x32_bf16 v[4:7], v[0:3], v[52:55], 0
  v_bitop3_b32 v72, v52, v54, s72 bitop3:0x7e
  s_waitcnt vmcnt(0)
  v_mfma_f32_16x16x32_bf16 v[4:7], v[0:3], v[56:59], v[4:7]
  v_bitop3_b32 v73, v56, v58, s72 bitop3:0x7e
  v_bitop3_b32 v72, v72, v73, 1 bitop3:0xa8
  v_cmp_ne_u32 vcc, 0, v72
  s_cbranch_vccnz Cs1_h1r
  s_nop 2
  v_add_f32_dpp v4, v4, v4 row_ror:4 row_mask:0xf bank_mask:0xf
  v_add_f32_dpp v5, v5, v5 row_ror:4 row_mask:0xf bank_mask:0xf
  s_nop 0
  v_add_f32_dpp v4, v4, v4 row_ror:8 row_mask:0xf bank_mask:0xf
  v_add_f32_dpp v5, v5, v5 row_ror:8 row_mask:0xf bank_mask:0xf
  v_cvt_pk_bf16_f32 v4, v4, v5
  buffer_store_dword v4, v69, s[8:11], s62 offen sc1
  s_xor_b32 s62, s62, 16384
  buffer_store_dword v71, v69, s[8:11], s62 offen sc1
  s_xor_b32 s72, s72, 1
  s_branch Cs1_h2
Cs1_h1r:
  s_mov_b64 exec, vcc
  buffer_load_dwordx4 v[52:55], v76, s[8:11], s60 offen offset:0 sc1
  buffer_load_dwordx4 v[56:59], v76, s[8:11], s60 offen offset:1024 sc1
  s_mov_b64 exec, -1
  s_add_u32 s67, s67, 1
  s_waitcnt vmcnt(1)
  v_mfma_f32_16x16x32_bf16 v[4:7], v[0:3], v[52:55], 0
  v_bitop3_b32 v72, v52, v54, s72 bitop3:0x7e
  s_waitcnt vmcnt(0)
  v_mfma_f32_16x16x32_bf16 v[4:7], v[0:3], v[56:59], v[4:7]
  v_bitop3_b32 v73, v56, v58, s72 bitop3:0x7e
  v_bitop3_b32 v72, v72, v73, 1 bitop3:0xa8
  v_cmp_ne_u32 vcc, 0, v72
  s_cbranch_vccz Cs1_h1p
Cs1_h1s:
  s_mov_b64 exec, vcc
  buffer_load_dwordx4 v[52:55], v76, s[8:11], s60 offen offset:0 sc1
  buffer_load_dwordx4 v[56:59], v76, s[8:11], s60 offen offset:1024 sc1
  s_mov_b64 exec, -1
  s_add_u32 s67, s67, 1
  s_waitcnt vmcnt(1)
  v_mfma_f32_16x16x32_bf16 v[4:7], v[0:3], v[52:55], 0
  v_bitop3_b32 v72, v52, v54, s72 bitop3:0x7e
  s_waitcnt vmcnt(0)
  v_mfma_f32_16x16x32_bf16 v[4:7], v[0:3], v[56:59], v[4:7]
  v_bitop3_b32 v73, v56, v58, s72 bitop3:0x7e
  v_bitop3_b32 v72, v72, v73, 1 bitop3:0xa8
  v_cmp_ne_u32 vcc, 0, v72
  s_cbranch_vccz Cs1_h1p
  s_cmp_lt_u32 s67, 131072
  s_cbranch_scc1 Cs1_h1s
Cs1_h1p:
  s_nop 2
  v_add_f32_dpp v4, v4, v4 row_ror:4 row_mask:0xf bank_mask:0xf
  v_add_f32_dpp v5, v5, v5 row_ror:4 row_mask:0xf bank_mask:0xf
  s_nop 0
  v_add_f32_dpp v4, v4, v4 row_ror:8 row_mask:0xf bank_mask:0xf
  v_add_f32_dpp v5, v5, v5 row_ror:8 row_mask:0xf bank_mask:0xf
  v_cvt_pk_bf16_f32 v4, v4, v5
  buffer_store_dword v4, v69, s[8:11], s62 offen sc1
  s_xor_b32 s62, s62, 16384
  buffer_store_dword v71, v69, s[8:11], s62 offen sc1
  s_xor_b32 s72, s72, 1
  s_branch Cs1_h2
Cs1_rec:
  s_nop 7
  s_waitcnt vmcnt(0) lgkmcnt(0)
  v_max3_u32 v72, v0, v1, v2
  v_max3_u32 v72, v72, v3, v4
  v_max3_u32 v72, v72, v5, v6
  v_max3_u32 v72, v72, v7, v8
  v_max3_u32 v72, v72, v9, v10
  v_max3_u32 v72, v72, v11, v12
  v_max3_u32 v72, v72, v13, v14
  v_max3_u32 v72, v72, v15, v16
  v_max3_u32 v72, v72, v17, v18
  v_max_u32 v72, v72, v19
  v_cmp_eq_u32 vcc, -1, v72
  s_cbranch_vccz Cs1_recok
  s_barrier
  v_mov_b64 v[20:21], 0
  v_mov_b64 v[22:23], 0
  v_mov_b64 v[24:25], 0
  v_mov_b64 v[26:27], 0
  v_mov_b64 v[28:29], 0
  v_mov_b64 v[30:31], 0
  v_mov_b64 v[32:33], 0
  v_mov_b64 v[34:35], 0
  s_waitcnt lgkmcnt(0)
  s_barrier
  ds_read_b128 v[0:3], v76 offset:4608
  s_waitcnt lgkmcnt(0)
  v_smfmac_f32_16x16x64_bf16 v[20:23], v[0:3], v[80:87], v74
  v_smfmac_f32_16x16x64_bf16 v[24:27], v[0:3], v[88:95], v74
  ds_read_b128 v[60:63], v76 offset:20480
  ds_read_b128 v[64:67], v76 offset:21504
  s_waitcnt lgkmcnt(0)
  v_smfmac_f32_16x16x64_bf16 v[28:31], v[0:3], v[60:67], v74
  ds_read_b128 v[60:63], v76 offset:22528
  ds_read_b128 v[64:67], v76 offset:23552
  s_waitcnt lgkmcnt(0)
  v_smfmac_f32_16x16x64_bf16 v[32:35], v[0:3], v[60:67], v74
  ds_read_b128 v[4:7], v76 offset:5632
  s_waitcnt lgkmcnt(0)
  v_smfmac_f32_16x16x64_bf16 v[20:23], v[4:7], v[96:103], v74
  v_smfmac_f32_16x16x64_bf16 v[24:27], v[4:7], v[104:111], v74
  ds_read_b128 v[60:63], v76 offset:36864
  ds_read_b128 v[64:67], v76 offset:37888
  s_waitcnt lgkmcnt(0)
  v_smfmac_f32_16x16x64_bf16 v[28:31], v[4:7], v[60:67], v74
  ds_read_b128 v[60:63], v76 offset:38912
  ds_read_b128 v[64:67], v76 offset:39936
  s_waitcnt lgkmcnt(0)
  v_smfmac_f32_16x16x64_bf16 v[32:35], v[4:7], v[60:67], v74
  ds_read_b128 v[8:11], v76 offset:6656
  s_waitcnt lgkmcnt(0)
  v_smfmac_f32_16x16x64_bf16 v[20:23], v[8:11], v[112:119], v74
  v_smfmac_f32_16x16x64_bf16 v[24:27], v[8:11], v[120:127], v74
  v_smfmac_f32_16x16x64_bf16 v[28:31], v[8:11], v[208:215], v74
  v_smfmac_f32_16x16x64_bf16 v[32:35], v[8:11], v[216:223], v74
  ds_read_b128 v[12:15], v76 offset:7680
  s_waitcnt lgkmcnt(0)
  v_smfmac_f32_16x16x64_bf16 v[20:23], v[12:15], v[128:135], v74
  v_smfmac_f32_16x16x64_bf16 v[24:27], v[12:15], v[136:143], v74
  v_smfmac_f32_16x16x64_bf16 v[28:31], v[12:15], v[224:231], v74
  v_smfmac_f32_16x16x64_bf16 v[32:35], v[12:15], v[232:239], v74
  ds_read_b128 v[8:11], v76 offset:8704
  s_waitcnt lgkmcnt(0)
  v_smfmac_f32_16x16x64_bf16 v[20:23], v[8:11], v[144:151], v74
  v_smfmac_f32_16x16x64_bf16 v[24:27], v[8:11], v[152:159], v74
  ds_read_b128 v[60:63], v76 offset:53248
  ds_read_b128 v[64:67], v76 offset:54272
  s_waitcnt lgkmcnt(0)
  v_smfmac_f32_16x16x64_bf16 v[28:31], v[8:11], v[60:67], v74
  ds_read_b128 v[60:63], v76 offset:55296
  ds_read_b128 v[64:67], v76 offset:56320
  s_waitcnt lgkmcnt(0)
  v_smfmac_f32_16x16x64_bf16 v[32:35], v[8:11], v[60:67], v74
  ds_read_b128 v[0:3], v76 offset:9728
  s_waitcnt lgkmcnt(0)
  v_smfmac_f32_16x16x64_bf16 v[20:23], v[0:3], v[160:167], v74
  v_smfmac_f32_16x16x64_bf16 v[24:27], v[0:3], v[168:175], v74
  ds_read_b128 v[60:63], v75 offset:20480
  ds_read_b128 v[64:67], v75 offset:21504
  s_waitcnt lgkmcnt(0)
  v_smfmac_f32_16x16x64_bf16 v[28:31], v[0:3], v[60:67], v74
  ds_read_b128 v[60:63], v75 offset:22528
  ds_read_b128 v[64:67], v75 offset:23552
  s_waitcnt lgkmcnt(0)
  v_smfmac_f32_16x16x64_bf16 v[32:35], v[0:3], v[60:67], v74
  ds_read_b128 v[16:19], v76 offset:10752
  ds_read_b128 v[60:63], v75 offset:4096
  ds_read_b128 v[64:67], v75 offset:5120
  s_waitcnt lgkmcnt(0)
  v_smfmac_f32_16x16x64_bf16 v[20:23], v[16:19], v[60:67], v74
  ds_read_b128 v[60:63], v75 offset:6144
  ds_read_b128 v[64:67], v75 offset:7168
  s_waitcnt lgkmcnt(0)
  v_smfmac_f32_16x16x64_bf16 v[24:27], v[16:19], v[60:67], v74
  v_smfmac_f32_16x16x64_bf16 v[28:31], v[16:19], v[240:247], v74
  v_smfmac_f32_16x16x64_bf16 v[32:35], v[16:19], v[248:255], v74
  ds_read_b128 v[4:7], v76 offset:11776
  s_waitcnt lgkmcnt(0)
  v_smfmac_f32_16x16x64_bf16 v[20:23], v[4:7], v[176:183], v74
  v_smfmac_f32_16x16x64_bf16 v[24:27], v[4:7], v[184:191], v74
  v_smfmac_f32_16x16x64_bf16 v[28:31], v[4:7], a[0:7], v74
  v_smfmac_f32_16x16x64_bf16 v[32:35], v[4:7], a[8:15], v74
  ds_read_b128 v[12:15], v76 offset:12800
  s_waitcnt lgkmcnt(0)
  v_smfmac_f32_16x16x64_bf16 v[20:23], v[12:15], v[192:199], v74
  v_smfmac_f32_16x16x64_bf16 v[24:27], v[12:15], v[200:207], v74
  v_smfmac_f32_16x16x64_bf16 v[28:31], v[12:15], a[16:23], v74
  v_smfmac_f32_16x16x64_bf16 v[32:35], v[12:15], a[24:31], v74
  v_add_f32 v20, v20, v22
  v_add_f32 v21, v21, v23
  v_add_f32 v24, v24, v26
  v_cvt_pk_bf16_f32 v22, v20, v24
  ds_write_b32 v79, v22 offset:0
  v_add_f32 v25, v25, v27
  v_cvt_pk_bf16_f32 v23, v21, v25
  ds_write_b32 v79, v23 offset:576
  v_add_f32 v28, v28, v30
  v_add_f32 v29, v29, v31
  s_waitcnt lgkmcnt(0)
  s_nop 1
  s_branch Cs1_recok
Cs1_mx:
  s_waitcnt lgkmcnt(0)
  s_barrier
  buffer_load_dwordx4 v[52:55], v76, s[8:11], s59 offen offset:0 sc1
  buffer_load_dwordx4 v[0:3], v76, s[8:11], s58 offen offset:0 sc1
  ds_read_b128 v[20:23], v77 offset:0
  ds_read_b128 v[28:31], v77 offset:256
  buffer_load_dwordx4 v[56:59], v76, s[8:11], s59 offen offset:1024 sc1
  buffer_load_dwordx4 v[4:7], v76, s[8:11], s58 offen offset:1024 sc1
  ds_read_b128 v[24:27], v77 offset:128
  ds_read_b128 v[32:35], v77 offset:384
  s_waitcnt vmcnt(2) lgkmcnt(3)
  v_mfma_f32_16x16x32_bf16 v[8:11], v[0:3], v[20:23], 0
  s_waitcnt vmcnt(0) lgkmcnt(1)
  v_mfma_f32_16x16x32_bf16 v[8:11], v[4:7], v[24:27], v[8:11]
  v_mfma_f32_16x16x32_bf16 v[12:15], v[28:31], v[20:23], 0
  s_waitcnt lgkmcnt(0)
  v_mfma_f32_16x16x32_bf16 v[12:15], v[32:35], v[24:27], v[12:15]
  v_add_f32_dpp v8, v10, v8 quad_perm:[2,3,0,1] row_mask:0xf bank_mask:0xf
  v_add_f32_dpp v9, v11, v9 quad_perm:[2,3,0,1] row_mask:0xf bank_mask:0xf
  s_nop 0
  v_mov_b32_dpp v8, v8 quad_perm:[0,1,0,1] row_mask:0xf bank_mask:0xf
  v_mov_b32_dpp v9, v9 quad_perm:[0,1,0,1] row_mask:0xf bank_mask:0xf
  s_nop 1
  v_add_f32_dpp v12, v14, v12 quad_perm:[2,3,0,1] row_mask:0xf bank_mask:0xf
  v_add_f32_dpp v13, v15, v13 quad_perm:[2,3,0,1] row_mask:0xf bank_mask:0xf
  s_nop 0
  v_mov_b32_dpp v12, v12 quad_perm:[0,1,0,1] row_mask:0xf bank_mask:0xf
  v_mov_b32_dpp v13, v13 quad_perm:[0,1,0,1] row_mask:0xf bank_mask:0xf
  v_mul_f32 v12, s69, v12
  ds_write_b32 v78, v8 offset:8708
  v_mul_f32 v13, s69, v13
  ds_write_b32 v78, v9 offset:8772
  s_waitcnt lgkmcnt(0)
  s_barrier
  ds_read_b128 v[36:39], v78 offset:8704
  ds_read_b128 v[40:43], v78 offset:8768
  s_waitcnt lgkmcnt(0)
  s_barrier
  v_max_f32 v16, v36, v37
  v_max3_f32 v16, v16, v38, v39
  v_max3_f32 v16, v16, v40, v41
  v_max3_f32 v16, v16, v42, v43
  v_max3_f32 v16, v16, v12, v13
  v_mov_b32 v17, v16
  s_nop 1
  v_permlane16_swap_b32 v16, v17
  v_max_f32 v16, v16, v17
  v_mov_b32 v17, v16
  s_nop 1
  v_permlane32_swap_b32 v16, v17
  v_max_f32 v16, v16, v17
  v_sub_f32 v36, v36, v16
  v_sub_f32 v37, v37, v16
  v_sub_f32 v38, v38, v16
  v_sub_f32 v39, v39, v16
  v_sub_f32 v40, v40, v16
  v_sub_f32 v41, v41, v16
  v_sub_f32 v42, v42, v16
  v_sub_f32 v43, v43, v16
  v_sub_f32 v12, v12, v16
  v_sub_f32 v13, v13, v16
  v_exp_f32 v36, v36
  v_exp_f32 v37, v37
  v_exp_f32 v38, v38
  v_exp_f32 v39, v39
  v_exp_f32 v40, v40
  v_exp_f32 v41, v41
  v_exp_f32 v42, v42
  v_exp_f32 v43, v43
  v_exp_f32 v12, v12
  v_exp_f32 v13, v13
  v_cvt_pk_bf16_f32 v32, v36, v40
  v_cvt_pk_bf16_f32 v33, v37, v41
  v_cvt_pk_bf16_f32 v34, v38, v42
  v_cvt_pk_bf16_f32 v35, v39, v43
  v_cvt_pk_bf16_f32 v28, v12, v13
  v_cvt_pk_bf16_f32 v31, v12, v13
  v_mov_b32 v29, 0
  v_mov_b32 v30, 0
  v_mfma_f32_16x16x32_bf16 v[8:11], v[32:35], v[68:71], 0
  v_mfma_f32_16x16x32_bf16 v[0:3], v[32:35], v[52:55], 0
  v_mfma_f32_16x16x32_bf16 v[4:7], v[32:35], v[56:59], 0
  v_mfma_f32_16x16x16_bf16 v[8:11], v[28:29], v[68:69], v[8:11]
  v_mfma_f32_16x16x16_bf16 v[0:3], v[28:29], v[72:73], v[0:3]
  v_mfma_f32_16x16x16_bf16 v[4:7], v[30:31], v[72:73], v[4:7]
  ds_read_b128 v[52:55], v75 offset:36864
  v_rcp_f32 v10, v8
  v_rcp_f32 v11, v9
  v_mul_f32 v0, v10, v0
  v_mul_f32 v1, v11, v1
  v_max3_f32 v8, v8, v9, v10
  v_mul_f32 v4, v10, v4
  v_mul_f32 v5, v11, v5
  v_cvt_pk_bf16_f32 v2, v0, v4
  ds_write_b32 v79, v2 offset:8704
  v_cvt_pk_bf16_f32 v3, v1, v5
  ds_write_b32 v79, v3 offset:9280
  ds_read_b128 v[12:15], v78 offset:8768
  ds_read_b128 v[56:59], v75 offset:37888
  v_mov_b64 v[16:17], 0
  v_mov_b64 v[18:19], 0
  v_mov_b64 v[20:21], 0
  v_mov_b64 v[22:23], 0
  v_mov_b64 v[24:25], 0
  v_mov_b64 v[26:27], 0
  s_branch Cs1_mxok
Cs1_last:
  ds_read_b128 v[4:7], v76 offset:5632
  ds_read_b128 v[12:15], v76 offset:7680
  ds_read_b128 v[44:47], v76 offset:36864
  ds_read_b128 v[48:51], v76 offset:37888
  s_nop 5
  v_mov_b64 v[20:21], 0
  v_mov_b64 v[22:23], 0
  v_mov_b64 v[24:25], 0
  v_mov_b64 v[26:27], 0
  s_waitcnt lgkmcnt(4)
  v_smfmac_f32_16x16x64_bf16 v[28:31], v[0:3], v[36:43], v74
  ds_read_b128 v[36:39], v76 offset:38912
  ds_read_b128 v[40:43], v76 offset:39936
  v_smfmac_f32_16x16x64_bf16 v[32:35], v[0:3], v[60:67], v74
  s_waitcnt lgkmcnt(5)
  v_smfmac_f32_16x16x64_bf16 v[20:23], v[0:3], a[32:39], v74
  ds_read_b128 v[60:63], v76 offset:53248
  ds_read_b128 v[64:67], v76 offset:54272
  v_smfmac_f32_16x16x64_bf16 v[24:27], v[0:3], a[40:47], v74
  s_waitcnt lgkmcnt(4)
  v_smfmac_f32_16x16x64_bf16 v[20:23], v[4:7], a[48:55], v74
  buffer_store_dwordx4 v[16:19], v76, s[8:11], s68 offen sc1
  v_smfmac_f32_16x16x64_bf16 v[24:27], v[4:7], a[56:63], v74
  v_smfmac_f32_16x16x64_bf16 v[28:31], v[4:7], v[44:51], v74
  s_waitcnt lgkmcnt(2)
  v_smfmac_f32_16x16x64_bf16 v[20:23], v[8:11], a[64:71], v74
  ds_read_b128 v[44:47], v76 offset:55296
  ds_read_b128 v[48:51], v76 offset:56320
  v_smfmac_f32_16x16x64_bf16 v[24:27], v[8:11], a[72:79], v74
  v_smfmac_f32_16x16x64_bf16 v[32:35], v[4:7], v[36:43], v74
  v_smfmac_f32_16x16x64_bf16 v[28:31], v[8:11], v[208:215], v74
  ds_read_b128 v[36:39], v75 offset:20480
  ds_read_b128 v[40:43], v75 offset:21504
  v_smfmac_f32_16x16x64_bf16 v[32:35], v[8:11], v[216:223], v74
  v_smfmac_f32_16x16x64_bf16 v[20:23], v[12:15], a[80:87], v74
  v_smfmac_f32_16x16x64_bf16 v[24:27], v[12:15], a[88:95], v74
  v_smfmac_f32_16x16x64_bf16 v[28:31], v[12:15], v[224:231], v74
  v_smfmac_f32_16x16x64_bf16 v[32:35], v[12:15], v[232:239], v74
  s_waitcnt vmcnt(1)
  s_barrier
Cs1_lastr:
  ds_read_b128 v[8:11], v76 offset:8704
  ds_read_b128 v[0:3], v76 offset:9728
  ds_read_b128 v[16:19], v76 offset:10752
  ds_read_b128 v[4:7], v76 offset:11776
  ds_read_b128 v[12:15], v76 offset:12800
  s_waitcnt lgkmcnt(3)
  v_max3_u32 v72, v0, v1, v2
  s_waitcnt lgkmcnt(1)
  v_max3_u32 v72, v72, v3, v4
  v_max3_u32 v72, v72, v5, v6
  v_max3_u32 v72, v72, v7, v8
  v_max3_u32 v72, v72, v9, v10
  s_waitcnt lgkmcnt(0)
  v_max3_u32 v72, v72, v11, v12
  v_max3_u32 v72, v72, v13, v14
  v_max3_u32 v72, v72, v15, v16
  v_max3_u32 v72, v72, v17, v18
  v_max_u32 v72, v72, v19
  v_cmp_eq_u32 vcc, -1, v72
  s_cbranch_vccnz Cs1_lastp
Cs1_lastg:
  v_smfmac_f32_16x16x64_bf16 v[28:31], v[8:11], v[60:67], v74
  ds_read_b128 v[60:63], v75 offset:22528
  ds_read_b128 v[64:67], v75 offset:23552
  v_smfmac_f32_16x16x64_bf16 v[32:35], v[8:11], v[44:51], v74
  v_smfmac_f32_16x16x64_bf16 v[28:31], v[0:3], v[36:43], v74
  v_smfmac_f32_16x16x64_bf16 v[28:31], v[16:19], v[240:247], v74
  v_smfmac_f32_16x16x64_bf16 v[28:31], v[4:7], a[0:7], v74
  v_smfmac_f32_16x16x64_bf16 v[28:31], v[12:15], a[16:23], v74
  v_smfmac_f32_16x16x64_bf16 v[32:35], v[16:19], v[248:255], v74
  v_smfmac_f32_16x16x64_bf16 v[32:35], v[4:7], a[8:15], v74
  s_waitcnt lgkmcnt(0)
  v_smfmac_f32_16x16x64_bf16 v[32:35], v[12:15], a[24:31], v74
  v_smfmac_f32_16x16x64_bf16 v[32:35], v[0:3], v[60:67], v74
  v_smfmac_f32_16x16x64_bf16 v[20:23], v[8:11], a[96:103], v74
  v_smfmac_f32_16x16x64_bf16 v[20:23], v[0:3], a[112:119], v74
  v_add_f32 v28, v28, v30
  v_add_f32 v32, v32, v34
  v_cvt_pk_bf16_f32 v30, v28, v32
  v_smfmac_f32_16x16x64_bf16 v[20:23], v[16:19], a[128:135], v74
  ds_write_b32 v79, v30 offset:256
  v_add_f32 v29, v29, v31
  v_add_f32 v33, v33, v35
  v_cvt_pk_bf16_f32 v31, v29, v33
  v_smfmac_f32_16x16x64_bf16 v[20:23], v[4:7], a[144:151], v74
  ds_write_b32 v79, v31 offset:832
  v_smfmac_f32_16x16x64_bf16 v[20:23], v[12:15], a[160:167], v74
  v_smfmac_f32_16x16x64_bf16 v[24:27], v[8:11], a[104:111], v74
  v_smfmac_f32_16x16x64_bf16 v[24:27], v[0:3], a[120:127], v74
  v_smfmac_f32_16x16x64_bf16 v[24:27], v[16:19], a[136:143], v74
  s_waitcnt lgkmcnt(0)
  s_barrier
  ds_read_b64 v[52:53], v77 offset:264
  v_add_f32 v20, v20, v22
  v_smfmac_f32_16x16x64_bf16 v[24:27], v[4:7], a[152:159], v74
  v_add_f32 v21, v21, v23
  v_smfmac_f32_16x16x64_bf16 v[24:27], v[12:15], a[168:175], v74
  v_cvt_pk_bf16_f32 v54, v20, v21
  s_add_u32 s68, s68, 655360
  s_nop 3
  v_add_f32 v24, v24, v26
  v_add_f32 v25, v25, v27
  v_cvt_pk_bf16_f32 v55, v24, v25
  s_waitcnt lgkmcnt(0)
  buffer_store_dwordx4 v[52:55], v76, s[8:11], s68 offen sc1
  s_branch Cs1_done
Cs1_lastp:
  s_add_u32 s72, s72, 2
  s_cmp_ge_u32 s72, 131072
  s_cbranch_scc1 Cs1_lastg
  s_barrier
  buffer_load_dwordx4 v76, s[8:11], s85 offen offset:0 sc1 lds
  s_waitcnt vmcnt(0)
  s_barrier
  s_branch Cs1_lastr
Cs1_done:
  s_branch L_cexit
L_w6:
  v_mov_b64 v[20:21], 0
  v_mov_b64 v[22:23], 0
  v_mov_b64 v[24:25], 0
  v_mov_b64 v[26:27], 0
  v_mov_b64 v[28:29], 0
  v_mov_b64 v[30:31], 0
  v_mov_b64 v[32:33], 0
  v_mov_b64 v[34:35], 0
  s_mov_b32 s78, 0x3f803f80
  s_mov_b32 s79, s78
  s_mov_b32 s65, 360448
  s_mov_b32 m0, 15872
  s_lshl_b32 s71, s53, 2
  s_add_u32 s71, s71, 128
  s_movk_i32 s56, 0x1000
  v_lshlrev_b32 v73, 2, v76
  v_mov_b32 v72, 0
  s_mov_b64 s[16:17], s[8:9]
  s_mov_b32 s18, 268435456
  s_mov_b32 s19, 0x20000
  s_getpc_b64 s[20:21]
Cs2_pc:
  s_add_u32 s20, s20, (Cs2_last - Cs2_pc)
  s_addc_u32 s21, s21, 0
  v_mov_b32 v68, 14880
  buffer_load_dwordx4 v[52:55], v76, s[8:11], s59 offen offset:0 sc1
  buffer_load_dwordx4 v[56:59], v76, s[8:11], s59 offen offset:1024 sc1
  ds_read_b128 v[36:39], v76 offset:24576
  ds_read_b128 v[40:43], v76 offset:25600
  ds_read_b128 v[60:63], v76 offset:26624
  ds_read_b128 v[64:67], v76 offset:27648
  ds_read_b128 v[0:3], v76 offset:4608
  ds_read_b128 v[4:7], v76 offset:5632
  ds_read_b128 v[8:11], v76 offset:6656
  ds_read_b128 v[12:15], v76 offset:7680
  s_waitcnt lgkmcnt(0)
  s_cmp_eq_u32 s66, 1
  s_branch Cs2_top2
.p2align 6
Cs2_h2:
  ds_read_b128 v[36:39], v76 offset:24576
  s_cmp_eq_u32 s66, 62
  s_cselect_b64 s[16:17], s[20:21], s[16:17]
  s_cselect_b32 s18, (Cs2_done - Cs2_last), s18
  s_cselect_b32 s70, 0, s70
  s_cmp_eq_u32 s66, 63
  s_cselect_b32 s59, 268435456, s59
  s_cselect_b32 s58, 268435456, s58
  ds_read_b128 v[40:43], v76 offset:25600
  v_mov_b64 v[20:21], 0
  v_mov_b64 v[22:23], 0
  v_mov_b64 v[24:25], 0
  v_mov_b64 v[26:27], 0
  v_mov_b32 v68, 14880
  v_lshlrev_b32 v73, 2, v76
  buffer_load_dwordx4 v[52:55], v76, s[8:11], s59 offen offset:0 sc1
  buffer_load_dwordx4 v[56:59], v76, s[8:11], s59 offen offset:1024 sc1
  s_waitcnt vmcnt(0)
  s_mov_b64 vcc, -1
Cs2_h2r:
  s_mov_b64 exec, vcc
  buffer_load_dwordx4 v[12:15], v76, s[8:11], s65 offen offset:3072 sc1
  buffer_load_dwordx4 v[0:3], v76, s[8:11], s85 offen offset:0 sc1
  s_mov_b64 exec, -1
  s_add_u32 s67, s67, 1
  s_cmp_lt_u32 s67, 131072
  s_cselect_b32 s54, -2, -1
  s_waitcnt vmcnt(1)
  v_max3_u32 v72, v12, v13, v14
  s_waitcnt vmcnt(0)
  v_max3_u32 v72, v72, v15, v0
  v_max3_u32 v72, v72, v1, v2
  v_max_u32 v72, v72, v3
  v_cmp_lt_u32 vcc, s54, v72
  s_cbranch_vccnz Cs2_h2r
  ds_write_b128 v76, v[12:15] offset:7680
  ds_write_b128 v76, v[0:3] offset:12800
Cs2_h2w:
  s_cmp_eq_u32 s66, 63
  s_waitcnt lgkmcnt(0)
  s_barrier
  ds_read_b128 v[0:3], v76 offset:4608
Cs2_top2:
  v_smfmac_f32_16x16x64_bf16 v[20:23], v[12:15], v[128:135], v74
  s_cbranch_scc1 Cs2_last
  v_smfmac_f32_16x16x64_bf16 v[24:27], v[12:15], v[136:143], v74
  buffer_load_dwordx4 v[44:47], v76, s[8:11], s58 offen offset:0 sc1
  s_mov_b32 m0, 15872
  v_smfmac_f32_16x16x64_bf16 v[28:31], v[12:15], v[224:231], v74
  buffer_load_dwordx4 v[48:51], v76, s[8:11], s58 offen offset:1024 sc1
  v_smfmac_f32_16x16x64_bf16 v[32:35], v[12:15], v[232:239], v74
  ds_read_b128 v[4:7], v76 offset:5632
  s_waitcnt lgkmcnt(1)
  v_smfmac_f32_16x16x64_bf16 v[20:23], v[0:3], v[80:87], v74
  ds_read_b128 v[8:11], v76 offset:6656
  v_smfmac_f32_16x16x64_bf16 v[28:31], v[0:3], v[36:43], v74
  ds_read_b128 v[36:39], v76 offset:40960
  v_smfmac_f32_16x16x64_bf16 v[24:27], v[0:3], v[88:95], v74
  buffer_store_dwordx4 v[16:19], v76, s[8:11], s68 offen sc1
  ds_read_b128 v[40:43], v76 offset:41984
  v_smfmac_f32_16x16x64_bf16 v[32:35], v[0:3], v[60:67], v74
  buffer_load_dword v73, s[16:19], s70 offen lds
  ds_read_b128 v[60:63], v76 offset:43008
  s_waitcnt lgkmcnt(4)
  v_smfmac_f32_16x16x64_bf16 v[20:23], v[4:7], v[96:103], v74
  ds_read_b128 v[64:67], v76 offset:44032
  v_smfmac_f32_16x16x64_bf16 v[24:27], v[4:7], v[104:111], v74
  s_waitcnt vmcnt(4)
  s_waitcnt lgkmcnt(4)
  v_smfmac_f32_16x16x64_bf16 v[20:23], v[8:11], v[112:119], v74
  s_barrier
  ds_read_b128 v[12:15], v76 offset:8704
  s_waitcnt lgkmcnt(3)
  v_smfmac_f32_16x16x64_bf16 v[28:31], v[4:7], v[36:43], v74
  ds_read_b128 v[36:39], v76 offset:57344
  v_smfmac_f32_16x16x64_bf16 v[24:27], v[8:11], v[120:127], v74
  ds_read_b128 v[40:43], v76 offset:58368
  s_waitcnt lgkmcnt(3)
  v_smfmac_f32_16x16x64_bf16 v[32:35], v[4:7], v[60:67], v74
  ds_read_b128 v[0:3], v76 offset:9728
  v_smfmac_f32_16x16x64_bf16 v[28:31], v[8:11], v[208:215], v74
  ds_read_b128 v[60:63], v76 offset:59392
  v_smfmac_f32_16x16x64_bf16 v[32:35], v[8:11], v[216:223], v74
  ds_read_b128 v[64:67], v76 offset:60416
  s_waitcnt lgkmcnt(5)
  v_smfmac_f32_16x16x64_bf16 v[20:23], v[12:15], v[144:151], v74
  s_barrier
  ds_read_b128 v[4:7], v76 offset:11776
  s_waitcnt lgkmcnt(4)
  v_smfmac_f32_16x16x64_bf16 v[28:31], v[12:15], v[36:43], v74
  ds_read_b128 v[8:11], v76 offset:12800
  ds_read_b128 v[36:39], v75 offset:8192
  v_smfmac_f32_16x16x64_bf16 v[24:27], v[12:15], v[152:159], v74
  ds_read_b128 v[16:19], v76 offset:10752
  s_waitcnt lgkmcnt(6)
  v_smfmac_f32_16x16x64_bf16 v[20:23], v[0:3], v[160:167], v74
  ds_read_b128 v[40:43], v75 offset:9216
  s_waitcnt lgkmcnt(5)
  v_smfmac_f32_16x16x64_bf16 v[32:35], v[12:15], v[60:67], v74
  ds_read_b128 v[60:63], v75 offset:10240
  v_smfmac_f32_16x16x64_bf16 v[24:27], v[0:3], v[168:175], v74
  ds_read_b128 v[64:67], v75 offset:11264
  s_waitcnt lgkmcnt(6)
  v_smfmac_f32_16x16x64_bf16 v[20:23], v[4:7], v[176:183], v74
  s_waitcnt lgkmcnt(5)
  v_smfmac_f32_16x16x64_bf16 v[20:23], v[8:11], v[192:199], v74
  s_waitcnt lgkmcnt(2)
  v_smfmac_f32_16x16x64_bf16 v[20:23], v[16:19], v[36:43], v74
  ds_read_b128 v[36:39], v75 offset:24576
  v_smfmac_f32_16x16x64_bf16 v[24:27], v[4:7], v[184:191], v74
  ds_read_b128 v[40:43], v75 offset:25600
  s_waitcnt lgkmcnt(2)
  v_smfmac_f32_16x16x64_bf16 v[24:27], v[16:19], v[60:67], v74
  ds_read_b128 v[60:63], v75 offset:26624
  v_add_f32 v20, v20, v22
  v_smfmac_f32_16x16x64_bf16 v[24:27], v[8:11], v[200:207], v74
  ds_read_b128 v[64:67], v75 offset:27648
  v_add_f32 v21, v21, v23
  v_smfmac_f32_16x16x64_bf16 v[28:31], v[16:19], v[240:247], v74
  v_mov_b64 v[70:71], s[78:79]
  v_smfmac_f32_16x16x64_bf16 v[28:31], v[4:7], a[0:7], v74
  s_waitcnt lgkmcnt(2)
  v_add_f32 v24, v24, v26
  v_smfmac_f32_16x16x64_bf16 v[28:31], v[0:3], v[36:43], v74
  ds_read_b128 v[36:39], v68
  v_cvt_pk_bf16_f32 v22, v20, v24
  v_smfmac_f32_16x16x64_bf16 v[28:31], v[8:11], a[16:23], v74
  ds_read_b128 v[40:43], v68
  ds_write_b32 v79, v22 offset:0
  s_waitcnt lgkmcnt(3)
  v_add_f32 v25, v25, v27
  v_cvt_pk_bf16_f32 v23, v21, v25
  v_smfmac_f32_16x16x64_bf16 v[32:35], v[0:3], v[60:67], v74
  ds_write_b32 v79, v23 offset:576
  v_cmp_u_f32 vcc, v20, v21
  v_smfmac_f32_16x16x64_bf16 v[32:35], v[16:19], v[248:255], v74
  v_add_f32 v28, v28, v30
  v_smfmac_f32_16x16x64_bf16 v[32:35], v[4:7], a[8:15], v74
  v_add_f32 v29, v29, v31
  v_smfmac_f32_16x16x64_bf16 v[32:35], v[8:11], a[24:31], v74
  s_cbranch_vccnz Cs2_rec
Cs2_recok:
  s_waitcnt lgkmcnt(3)
  v_smfmac_f32_16x16x64_bf16 v[36:39], v[16:19], a[128:135], v74
  s_waitcnt lgkmcnt(0)
  s_barrier
  ds_read_b128 v[60:63], v77
  v_smfmac_f32_16x16x64_bf16 v[40:43], v[16:19], a[136:143], v74
  ds_read_b128 v[64:67], v77 offset:128
  v_add_f32 v32, v32, v34
  v_cvt_pk_bf16_f32 v30, v28, v32
  v_smfmac_f32_16x16x64_bf16 v[36:39], v[0:3], a[112:119], v74
  ds_write_b32 v79, v30 offset:256
  v_add_f32 v33, v33, v35
  v_cvt_pk_bf16_f32 v31, v29, v33
  v_smfmac_f32_16x16x64_bf16 v[40:43], v[0:3], a[120:127], v74
  ds_write_b32 v79, v31 offset:832
  v_xor_b32 v75, 0x8000, v75
  v_smfmac_f32_16x16x64_bf16 v[36:39], v[4:7], a[144:151], v74
  ds_read_b128 v[0:3], v76 offset:4608
  v_mov_b32 v29, 0
  v_smfmac_f32_16x16x64_bf16 v[40:43], v[4:7], a[152:159], v74
  s_waitcnt vmcnt(2) lgkmcnt(3)
  v_mov_b32 v30, 0
  v_mfma_f32_16x16x32_bf16 v[44:47], v[44:47], v[60:63], 0
  ds_read_b128 v[4:7], v76 offset:5632
  s_waitcnt lgkmcnt(2)
  v_mfma_f32_16x16x32_bf16 v[44:47], v[48:51], v[64:67], v[44:47]
  s_barrier
  v_smfmac_f32_16x16x64_bf16 v[36:39], v[8:11], a[160:167], v74
  ds_read_b128 v[20:23], v77 offset:256
  ds_read_b128 v[24:27], v77 offset:384
  v_smfmac_f32_16x16x64_bf16 v[40:43], v[8:11], a[168:175], v74
  ds_read_b128 v[8:11], v76 offset:6656
  v_add_f32_dpp v72, v46, v44 quad_perm:[2,3,0,1] row_mask:0xf bank_mask:0xf
  v_add_f32_dpp v73, v47, v45 quad_perm:[2,3,0,1] row_mask:0xf bank_mask:0xf
  v_smfmac_f32_16x16x64_bf16 v[36:39], v[12:15], a[96:103], v74
  s_waitcnt lgkmcnt(4)
  v_exp_f32_dpp v72, v72 quad_perm:[0,1,0,1] row_mask:0xf bank_mask:0xf
  v_smfmac_f32_16x16x64_bf16 v[40:43], v[12:15], a[104:111], v74
  ds_read_b128 v[12:15], v76 offset:7680
  v_exp_f32_dpp v73, v73 quad_perm:[0,1,0,1] row_mask:0xf bank_mask:0xf
  v_smfmac_f32_16x16x64_bf16 v[36:39], v[0:3], a[32:39], v74
  s_waitcnt lgkmcnt(2)
  v_cvt_pk_bf16_f32 v72, v72, v73
  v_mfma_f32_16x16x32_bf16 v[20:23], v[20:23], v[60:63], 0
  ds_write_b32 v78, v72 offset:520
  v_mov_b64 v[16:17], 0
  v_mfma_f32_16x16x32_bf16 v[20:23], v[24:27], v[64:67], v[20:23]
  ds_read_b128 v[44:47], v75 offset:40960
  v_mov_b64 v[18:19], 0
  v_smfmac_f32_16x16x64_bf16 v[40:43], v[0:3], a[40:47], v74
  ds_read_b128 v[48:51], v75 offset:41984
  v_mov_b64 v[68:69], s[78:79]
  v_smfmac_f32_16x16x64_bf16 v[36:39], v[4:7], a[48:55], v74
  s_waitcnt lgkmcnt(4)
  v_add_f32_dpp v24, v22, v20 quad_perm:[2,3,0,1] row_mask:0xf bank_mask:0xf
  v_add_f32_dpp v25, v23, v21 quad_perm:[2,3,0,1] row_mask:0xf bank_mask:0xf
  v_smfmac_f32_16x16x64_bf16 v[36:39], v[8:11], a[64:71], v74
  s_waitcnt lgkmcnt(2)
  s_barrier
  ds_read_b128 v[32:35], v78 offset:512
  v_smfmac_f32_16x16x64_bf16 v[36:39], v[12:15], a[80:87], v74
  ds_read_b128 v[60:63], v75 offset:24576
  v_mul_f32 v24, s69, v24
  v_smfmac_f32_16x16x64_bf16 v[40:43], v[4:7], a[56:63], v74
  ds_read_b128 v[64:67], v75 offset:25600
  v_mul_f32 v25, s69, v25
  v_smfmac_f32_16x16x64_bf16 v[40:43], v[8:11], a[72:79], v74
  v_exp_f32_dpp v24, v24 quad_perm:[0,1,0,1] row_mask:0xf bank_mask:0xf
  v_smfmac_f32_16x16x64_bf16 v[40:43], v[12:15], a[88:95], v74
  s_waitcnt lgkmcnt(2)
  v_exp_f32_dpp v25, v25 quad_perm:[0,1,0,1] row_mask:0xf bank_mask:0xf
  v_mfma_f32_16x16x32_bf16 v[8:11], v[32:35], v[68:71], 0
  v_add_f32 v36, v36, v38
  v_add_f32 v37, v37, v39
  v_mfma_f32_16x16x32_bf16 v[0:3], v[32:35], v[52:55], 0
  v_add_f32 v40, v40, v42
  v_add_f32 v41, v41, v43
  v_mfma_f32_16x16x32_bf16 v[4:7], v[32:35], v[56:59], 0
  v_cvt_pk_bf16_f32 v28, v24, v25
  v_cvt_pk_bf16_f32 v72, v36, v37
  v_cvt_pk_bf16_f32 v73, v40, v41
  v_mfma_f32_16x16x16_bf16 v[8:11], v[28:29], v[68:69], v[8:11]
  v_cvt_pk_bf16_f32 v31, v24, v25
  v_mov_b64 v[20:21], 0
  v_mfma_f32_16x16x16_bf16 v[0:3], v[28:29], v[72:73], v[0:3]
  ds_read_b128 v[52:55], v75 offset:26624
  v_mov_b64 v[22:23], 0
  v_mfma_f32_16x16x16_bf16 v[4:7], v[30:31], v[72:73], v[4:7]
  v_rcp_f32 v10, v8
  v_rcp_f32 v11, v9
  v_mul_f32 v0, v10, v0
  v_mul_f32 v1, v11, v1
  v_max3_f32 v8, v8, v9, v10
  v_mul_f32 v4, v10, v4
  v_mul_f32 v5, v11, v5
  v_cvt_pk_bf16_f32 v2, v0, v4
  ds_write_b32 v79, v2 offset:8704
  v_cvt_pk_bf16_f32 v3, v1, v5
  ds_write_b32 v79, v3 offset:9280
  ds_read_b128 v[12:15], v78 offset:8832
  v_max_f32 v8, v8, v11
  v_cmp_le_f32 vcc, 1317011456, v8
  v_mov_b64 v[24:25], 0
  v_mov_b64 v[26:27], 0
  ds_read_b128 v[56:59], v75 offset:27648
  s_cbranch_vccnz Cs2_mx
Cs2_mxok:
  s_waitcnt lgkmcnt(2)
  s_barrier
  ds_read_b128 v[0:3], v78 offset:8896
  s_waitcnt lgkmcnt(2)
  v_smfmac_f32_16x16x64_bf16 v[16:19], v[12:15], a[176:183], v74
  ds_read_b128 v[4:7], v78 offset:8704
  v_smfmac_f32_16x16x64_bf16 v[20:23], v[12:15], v[44:51], v74
  ds_read_b128 v[8:11], v78 offset:8768
  v_smfmac_f32_16x16x64_bf16 v[24:27], v[12:15], a[224:231], v74
  ds_read_b128 v[36:39], v75 offset:43008
  s_waitcnt lgkmcnt(3)
  v_smfmac_f32_16x16x64_bf16 v[16:19], v[0:3], a[184:191], v74
  ds_read_b128 v[40:43], v75 offset:44032
  s_waitcnt lgkmcnt(3)
  v_smfmac_f32_16x16x64_bf16 v[16:19], v[4:7], v[60:67], v74
  ds_read_b128 v[68:71], v76 offset:13824
  s_waitcnt lgkmcnt(3)
  v_smfmac_f32_16x16x64_bf16 v[16:19], v[8:11], v[52:59], v74
  ds_read_b128 v[44:47], v75 offset:57344
  v_smfmac_f32_16x16x64_bf16 v[20:23], v[4:7], a[192:199], v74
  ds_read_b128 v[48:51], v75 offset:58368
  v_smfmac_f32_16x16x64_bf16 v[20:23], v[8:11], a[200:207], v74
  ds_read_b128 v[60:63], v75 offset:59392
  s_waitcnt lgkmcnt(4)
  v_cvt_pk_bf16_f32 v16, v16, v17
  v_cvt_pk_bf16_f32 v17, v18, v19
  v_bfi_b32 v16, 1, s72, v16
  v_smfmac_f32_16x16x64_bf16 v[20:23], v[0:3], v[36:43], v74
  s_waitcnt lgkmcnt(3)
  buffer_store_dwordx2 v[16:17], v68, s[8:11], s73 offen sc1
  v_mov_b64 v[32:33], 0
  v_smfmac_f32_16x16x64_bf16 v[24:27], v[4:7], a[208:215], v74
  ds_read_b128 v[64:67], v75 offset:60416
  v_mov_b64 v[34:35], 0
  v_smfmac_f32_16x16x64_bf16 v[24:27], v[8:11], a[216:223], v74
  ds_read_b128 v[52:55], v75 offset:0
  v_cvt_pk_bf16_f32 v20, v20, v21
  v_cvt_pk_bf16_f32 v21, v22, v23
  v_bfi_b32 v20, 1, s72, v20
  v_smfmac_f32_16x16x64_bf16 v[24:27], v[0:3], a[232:239], v74
  ds_read_b128 v[56:59], v75 offset:1024
  buffer_store_dwordx2 v[20:21], v68, s[8:11], s74 offen sc1
  s_waitcnt lgkmcnt(4)
  v_mov_b64 v[28:29], 0
  v_smfmac_f32_16x16x64_bf16 v[32:35], v[4:7], v[44:51], v74
  ds_read_b128 v[36:39], v75 offset:2048
  ds_read_b128 v[40:43], v75 offset:3072
  s_waitcnt lgkmcnt(4)
  v_smfmac_f32_16x16x64_bf16 v[32:35], v[8:11], v[60:67], v74
  ds_read_b128 v[44:47], v75 offset:4096
  v_cvt_pk_bf16_f32 v24, v24, v25
  v_cvt_pk_bf16_f32 v25, v26, v27
  v_bfi_b32 v24, 1, s72, v24
  v_smfmac_f32_16x16x64_bf16 v[32:35], v[12:15], a[240:247], v74
  ds_read_b128 v[48:51], v75 offset:5120
  buffer_store_dwordx2 v[24:25], v68, s[8:11], s75 offen sc1
  v_mov_b64 v[30:31], 0
  v_smfmac_f32_16x16x64_bf16 v[32:35], v[0:3], a[248:255], v74
  ds_read_b128 v[60:63], v75 offset:6144
  ds_read_b128 v[64:67], v75 offset:7168
  s_waitcnt lgkmcnt(6)
  v_smfmac_f32_16x16x64_bf16 v[28:31], v[4:7], v[52:59], v74
  s_waitcnt lgkmcnt(4)
  v_smfmac_f32_16x16x64_bf16 v[28:31], v[8:11], v[36:43], v74
  s_waitcnt lgkmcnt(2)
  v_cvt_pk_bf16_f32 v32, v32, v33
  v_cvt_pk_bf16_f32 v33, v34, v35
  v_bfi_b32 v32, 1, s72, v32
  v_smfmac_f32_16x16x64_bf16 v[28:31], v[12:15], v[44:51], v74
  buffer_store_dwordx2 v[32:33], v68, s[8:11], s76 offen sc1
  s_waitcnt lgkmcnt(0)
  v_smfmac_f32_16x16x64_bf16 v[28:31], v[0:3], v[60:67], v74
  v_mov_b64 v[18:19], v[72:73]
  s_nop 4
  v_cvt_pk_bf16_f32 v28, v28, v29
  v_cvt_pk_bf16_f32 v29, v30, v31
  v_bfi_b32 v28, 1, s72, v28
  buffer_store_dwordx2 v[28:29], v68, s[8:11], s77 offen sc1
  ds_read_b128 v[0:3], v76 offset:14848
  s_waitcnt lgkmcnt(0)
  ds_read_b64 v[16:17], v77 offset:384
  s_waitcnt lgkmcnt(0)
  ds_read_b128 v[64:67], v76 offset:27648
  s_waitcnt lgkmcnt(0)
  ds_read_b128 v[60:63], v76 offset:26624
  s_waitcnt lgkmcnt(0)
  v_xor_b32 v75, 0x8000, v75
  v_mov_b64 v[28:29], 0
  v_mov_b64 v[30:31], 0
  v_mov_b64 v[32:33], 0
  v_mov_b64 v[34:35], 0
  s_waitcnt vmcnt(0)
  buffer_load_dwordx4 v[52:55], v76, s[8:11], s60 offen offset:0 sc1
  buffer_load_dwordx4 v[56:59], v76, s[8:11], s60 offen offset:1024 sc1
  s_add_u32 s66, s66, 1
  s_xor_b32 s64, s64, 16384
  s_xor_b32 s65, s65, 16384
  s_add_u32 s58, s58, 655360
  s_add_u32 s59, s59, 655360
  s_add_u32 s70, s70, 655360
  s_add_u32 s68, s68, 655360
  s_mov_b32 m0, 12800
  s_add_u32 s85, s65, 8192
  s_waitcnt lgkmcnt(0)
  s_waitcnt vmcnt(1)
  v_mfma_f32_16x16x32_bf16 v[4:7], v[0:3], v[52:55], 0
  v_bitop3_b32 v72, v52, v54, s72 bitop3:0x7e
  s_waitcnt vmcnt(0)
  v_mfma_f32_16x16x32_bf16 v[4:7], v[0:3], v[56:59], v[4:7]
  v_bitop3_b32 v73, v56, v58, s72 bitop3:0x7e
  v_bitop3_b32 v72, v72, v73, 1 bitop3:0xa8
  v_cmp_ne_u32 vcc, 0, v72
  s_cbranch_vccnz Cs2_h1r
  s_nop 2
  v_add_f32_dpp v4, v4, v4 row_ror:4 row_mask:0xf bank_mask:0xf
  v_add_f32_dpp v5, v5, v5 row_ror:4 row_mask:0xf bank_mask:0xf
  s_nop 0
  v_add_f32_dpp v4, v4, v4 row_ror:8 row_mask:0xf bank_mask:0xf
  v_add_f32_dpp v5, v5, v5 row_ror:8 row_mask:0xf bank_mask:0xf
  v_cvt_pk_bf16_f32 v4, v4, v5
  buffer_store_dword v4, v69, s[8:11], s62 offen sc1
  s_xor_b32 s62, s62, 16384
  buffer_store_dword v71, v69, s[8:11], s62 offen sc1
  s_xor_b32 s72, s72, 1
  s_branch Cs2_h2
Cs2_h1r:
  s_mov_b64 exec, vcc
  buffer_load_dwordx4 v[52:55], v76, s[8:11], s60 offen offset:0 sc1
  buffer_load_dwordx4 v[56:59], v76, s[8:11], s60 offen offset:1024 sc1
  s_mov_b64 exec, -1
  s_add_u32 s67, s67, 1
  s_waitcnt vmcnt(1)
  v_mfma_f32_16x16x32_bf16 v[4:7], v[0:3], v[52:55], 0
  v_bitop3_b32 v72, v52, v54, s72 bitop3:0x7e
  s_waitcnt vmcnt(0)
  v_mfma_f32_16x16x32_bf16 v[4:7], v[0:3], v[56:59], v[4:7]
  v_bitop3_b32 v73, v56, v58, s72 bitop3:0x7e
  v_bitop3_b32 v72, v72, v73, 1 bitop3:0xa8
  v_cmp_ne_u32 vcc, 0, v72
  s_cbranch_vccz Cs2_h1p
Cs2_h1s:
  s_mov_b64 exec, vcc
  buffer_load_dwordx4 v[52:55], v76, s[8:11], s60 offen offset:0 sc1
  buffer_load_dwordx4 v[56:59], v76, s[8:11], s60 offen offset:1024 sc1
  s_mov_b64 exec, -1
  s_add_u32 s67, s67, 1
  s_waitcnt vmcnt(1)
  v_mfma_f32_16x16x32_bf16 v[4:7], v[0:3], v[52:55], 0
  v_bitop3_b32 v72, v52, v54, s72 bitop3:0x7e
  s_waitcnt vmcnt(0)
  v_mfma_f32_16x16x32_bf16 v[4:7], v[0:3], v[56:59], v[4:7]
  v_bitop3_b32 v73, v56, v58, s72 bitop3:0x7e
  v_bitop3_b32 v72, v72, v73, 1 bitop3:0xa8
  v_cmp_ne_u32 vcc, 0, v72
  s_cbranch_vccz Cs2_h1p
  s_cmp_lt_u32 s67, 131072
  s_cbranch_scc1 Cs2_h1s
Cs2_h1p:
  s_nop 2
  v_add_f32_dpp v4, v4, v4 row_ror:4 row_mask:0xf bank_mask:0xf
  v_add_f32_dpp v5, v5, v5 row_ror:4 row_mask:0xf bank_mask:0xf
  s_nop 0
  v_add_f32_dpp v4, v4, v4 row_ror:8 row_mask:0xf bank_mask:0xf
  v_add_f32_dpp v5, v5, v5 row_ror:8 row_mask:0xf bank_mask:0xf
  v_cvt_pk_bf16_f32 v4, v4, v5
  buffer_store_dword v4, v69, s[8:11], s62 offen sc1
  s_xor_b32 s62, s62, 16384
  buffer_store_dword v71, v69, s[8:11], s62 offen sc1
  s_xor_b32 s72, s72, 1
  s_branch Cs2_h2
Cs2_rec:
  s_nop 7
  s_waitcnt vmcnt(0) lgkmcnt(0)
  v_max3_u32 v72, v0, v1, v2
  v_max3_u32 v72, v72, v3, v4
  v_max3_u32 v72, v72, v5, v6
  v_max3_u32 v72, v72, v7, v8
  v_max3_u32 v72, v72, v9, v10
  v_max3_u32 v72, v72, v11, v12
  v_max3_u32 v72, v72, v13, v14
  v_max3_u32 v72, v72, v15, v16
  v_max3_u32 v72, v72, v17, v18
  v_max_u32 v72, v72, v19
  v_cmp_eq_u32 vcc, -1, v72
  s_cbranch_vccz Cs2_recok
  s_barrier
Cs2_recp:
  buffer_load_dwordx4 v[0:3], v76, s[8:11], s64 offen offset:0 sc1
  buffer_load_dwordx4 v[4:7], v76, s[8:11], s64 offen offset:1024 sc1
  s_add_u32 s67, s67, 1
  s_cmp_lt_u32 s67, 131072
  s_cselect_b32 s54, -2, -1
  s_waitcnt vmcnt(1)
  v_max3_u32 v72, v0, v1, v2
  s_waitcnt vmcnt(0)
  v_max3_u32 v72, v72, v3, v4
  v_max3_u32 v72, v72, v5, v6
  v_max_u32 v72, v72, v7
  v_cmp_lt_u32 vcc, s54, v72
  s_cbranch_vccnz Cs2_recp
  ds_write_b128 v76, v[0:3] offset:8704
  ds_write_b128 v76, v[4:7] offset:9728
  v_mov_b64 v[20:21], 0
  v_mov_b64 v[22:23], 0
  v_mov_b64 v[24:25], 0
  v_mov_b64 v[26:27], 0
  v_mov_b64 v[28:29], 0
  v_mov_b64 v[30:31], 0
  v_mov_b64 v[32:33], 0
  v_mov_b64 v[34:35], 0
  s_waitcnt lgkmcnt(0)
  s_barrier
  ds_read_b128 v[0:3], v76 offset:4608
  s_waitcnt lgkmcnt(0)
  v_smfmac_f32_16x16x64_bf16 v[20:23], v[0:3], v[80:87], v74
  v_smfmac_f32_16x16x64_bf16 v[24:27], v[0:3], v[88:95], v74
  ds_read_b128 v[60:63], v76 offset:24576
  ds_read_b128 v[64:67], v76 offset:25600
  s_waitcnt lgkmcnt(0)
  v_smfmac_f32_16x16x64_bf16 v[28:31], v[0:3], v[60:67], v74
  ds_read_b128 v[60:63], v76 offset:26624
  ds_read_b128 v[64:67], v76 offset:27648
  s_waitcnt lgkmcnt(0)
  v_smfmac_f32_16x16x64_bf16 v[32:35], v[0:3], v[60:67], v74
  ds_read_b128 v[4:7], v76 offset:5632
  s_waitcnt lgkmcnt(0)
  v_smfmac_f32_16x16x64_bf16 v[20:23], v[4:7], v[96:103], v74
  v_smfmac_f32_16x16x64_bf16 v[24:27], v[4:7], v[104:111], v74
  ds_read_b128 v[60:63], v76 offset:40960
  ds_read_b128 v[64:67], v76 offset:41984
  s_waitcnt lgkmcnt(0)
  v_smfmac_f32_16x16x64_bf16 v[28:31], v[4:7], v[60:67], v74
  ds_read_b128 v[60:63], v76 offset:43008
  ds_read_b128 v[64:67], v76 offset:44032
  s_waitcnt lgkmcnt(0)
  v_smfmac_f32_16x16x64_bf16 v[32:35], v[4:7], v[60:67], v74
  ds_read_b128 v[8:11], v76 offset:6656
  s_waitcnt lgkmcnt(0)
  v_smfmac_f32_16x16x64_bf16 v[20:23], v[8:11], v[112:119], v74
  v_smfmac_f32_16x16x64_bf16 v[24:27], v[8:11], v[120:127], v74
  v_smfmac_f32_16x16x64_bf16 v[28:31], v[8:11], v[208:215], v74
  v_smfmac_f32_16x16x64_bf16 v[32:35], v[8:11], v[216:223], v74
  ds_read_b128 v[12:15], v76 offset:7680
  s_waitcnt lgkmcnt(0)
  v_smfmac_f32_16x16x64_bf16 v[20:23], v[12:15], v[128:135], v74
  v_smfmac_f32_16x16x64_bf16 v[24:27], v[12:15], v[136:143], v74
  v_smfmac_f32_16x16x64_bf16 v[28:31], v[12:15], v[224:231], v74
  v_smfmac_f32_16x16x64_bf16 v[32:35], v[12:15], v[232:239], v74
  ds_read_b128 v[12:15], v76 offset:8704
  s_waitcnt lgkmcnt(0)
  v_smfmac_f32_16x16x64_bf16 v[20:23], v[12:15], v[144:151], v74
  v_smfmac_f32_16x16x64_bf16 v[24:27], v[12:15], v[152:159], v74
  ds_read_b128 v[60:63], v76 offset:57344
  ds_read_b128 v[64:67], v76 offset:58368
  s_waitcnt lgkmcnt(0)
  v_smfmac_f32_16x16x64_bf16 v[28:31], v[12:15], v[60:67], v74
  ds_read_b128 v[60:63], v76 offset:59392
  ds_read_b128 v[64:67], v76 offset:60416
  s_waitcnt lgkmcnt(0)
  v_smfmac_f32_16x16x64_bf16 v[32:35], v[12:15], v[60:67], v74
  ds_read_b128 v[0:3], v76 offset:9728
  s_waitcnt lgkmcnt(0)
  v_smfmac_f32_16x16x64_bf16 v[20:23], v[0:3], v[160:167], v74
  v_smfmac_f32_16x16x64_bf16 v[24:27], v[0:3], v[168:175], v74
  ds_read_b128 v[60:63], v75 offset:24576
  ds_read_b128 v[64:67], v75 offset:25600
  s_waitcnt lgkmcnt(0)
  v_smfmac_f32_16x16x64_bf16 v[28:31], v[0:3], v[60:67], v74
  ds_read_b128 v[60:63], v75 offset:26624
  ds_read_b128 v[64:67], v75 offset:27648
  s_waitcnt lgkmcnt(0)
  v_smfmac_f32_16x16x64_bf16 v[32:35], v[0:3], v[60:67], v74
  ds_read_b128 v[16:19], v76 offset:10752
  ds_read_b128 v[60:63], v75 offset:8192
  ds_read_b128 v[64:67], v75 offset:9216
  s_waitcnt lgkmcnt(0)
  v_smfmac_f32_16x16x64_bf16 v[20:23], v[16:19], v[60:67], v74
  ds_read_b128 v[60:63], v75 offset:10240
  ds_read_b128 v[64:67], v75 offset:11264
  s_waitcnt lgkmcnt(0)
  v_smfmac_f32_16x16x64_bf16 v[24:27], v[16:19], v[60:67], v74
  v_smfmac_f32_16x16x64_bf16 v[28:31], v[16:19], v[240:247], v74
  v_smfmac_f32_16x16x64_bf16 v[32:35], v[16:19], v[248:255], v74
  ds_read_b128 v[4:7], v76 offset:11776
  s_waitcnt lgkmcnt(0)
  v_smfmac_f32_16x16x64_bf16 v[20:23], v[4:7], v[176:183], v74
  v_smfmac_f32_16x16x64_bf16 v[24:27], v[4:7], v[184:191], v74
  v_smfmac_f32_16x16x64_bf16 v[28:31], v[4:7], a[0:7], v74
  v_smfmac_f32_16x16x64_bf16 v[32:35], v[4:7], a[8:15], v74
  ds_read_b128 v[8:11], v76 offset:12800
  s_waitcnt lgkmcnt(0)
  v_smfmac_f32_16x16x64_bf16 v[20:23], v[8:11], v[192:199], v74
  v_smfmac_f32_16x16x64_bf16 v[24:27], v[8:11], v[200:207], v74
  v_smfmac_f32_16x16x64_bf16 v[28:31], v[8:11], a[16:23], v74
  v_smfmac_f32_16x16x64_bf16 v[32:35], v[8:11], a[24:31], v74
  v_add_f32 v20, v20, v22
  v_add_f32 v21, v21, v23
  v_add_f32 v24, v24, v26
  v_cvt_pk_bf16_f32 v22, v20, v24
  ds_write_b32 v79, v22 offset:0
  v_add_f32 v25, v25, v27
  v_cvt_pk_bf16_f32 v23, v21, v25
  ds_write_b32 v79, v23 offset:576
  v_add_f32 v28, v28, v30
  v_add_f32 v29, v29, v31
  s_waitcnt lgkmcnt(0)
  s_nop 1
  s_branch Cs2_recok
Cs2_mx:
  s_waitcnt lgkmcnt(0)
  s_barrier
  buffer_load_dwordx4 v[52:55], v76, s[8:11], s59 offen offset:0 sc1
  buffer_load_dwordx4 v[0:3], v76, s[8:11], s58 offen offset:0 sc1
  ds_read_b128 v[20:23], v77 offset:0
  ds_read_b128 v[28:31], v77 offset:256
  buffer_load_dwordx4 v[56:59], v76, s[8:11], s59 offen offset:1024 sc1
  buffer_load_dwordx4 v[4:7], v76, s[8:11], s58 offen offset:1024 sc1
  ds_read_b128 v[24:27], v77 offset:128
  ds_read_b128 v[32:35], v77 offset:384
  s_waitcnt vmcnt(2) lgkmcnt(3)
  v_mfma_f32_16x16x32_bf16 v[8:11], v[0:3], v[20:23], 0
  s_waitcnt vmcnt(0) lgkmcnt(1)
  v_mfma_f32_16x16x32_bf16 v[8:11], v[4:7], v[24:27], v[8:11]
  v_mfma_f32_16x16x32_bf16 v[12:15], v[28:31], v[20:23], 0
  s_waitcnt lgkmcnt(0)
  v_mfma_f32_16x16x32_bf16 v[12:15], v[32:35], v[24:27], v[12:15]
  v_add_f32_dpp v8, v10, v8 quad_perm:[2,3,0,1] row_mask:0xf bank_mask:0xf
  v_add_f32_dpp v9, v11, v9 quad_perm:[2,3,0,1] row_mask:0xf bank_mask:0xf
  s_nop 0
  v_mov_b32_dpp v8, v8 quad_perm:[0,1,0,1] row_mask:0xf bank_mask:0xf
  v_mov_b32_dpp v9, v9 quad_perm:[0,1,0,1] row_mask:0xf bank_mask:0xf
  s_nop 1
  v_add_f32_dpp v12, v14, v12 quad_perm:[2,3,0,1] row_mask:0xf bank_mask:0xf
  v_add_f32_dpp v13, v15, v13 quad_perm:[2,3,0,1] row_mask:0xf bank_mask:0xf
  s_nop 0
  v_mov_b32_dpp v12, v12 quad_perm:[0,1,0,1] row_mask:0xf bank_mask:0xf
  v_mov_b32_dpp v13, v13 quad_perm:[0,1,0,1] row_mask:0xf bank_mask:0xf
  v_mul_f32 v12, s69, v12
  ds_write_b32 v78, v8 offset:8712
  v_mul_f32 v13, s69, v13
  ds_write_b32 v78, v9 offset:8776
  s_waitcnt lgkmcnt(0)
  s_barrier
  ds_read_b128 v[36:39], v78 offset:8704
  ds_read_b128 v[40:43], v78 offset:8768
  s_waitcnt lgkmcnt(0)
  s_barrier
  v_max_f32 v16, v36, v37
  v_max3_f32 v16, v16, v38, v39
  v_max3_f32 v16, v16, v40, v41
  v_max3_f32 v16, v16, v42, v43
  v_max3_f32 v16, v16, v12, v13
  v_mov_b32 v17, v16
  s_nop 1
  v_permlane16_swap_b32 v16, v17
  v_max_f32 v16, v16, v17
  v_mov_b32 v17, v16
  s_nop 1
  v_permlane32_swap_b32 v16, v17
  v_max_f32 v16, v16, v17
  v_sub_f32 v36, v36, v16
  v_sub_f32 v37, v37, v16
  v_sub_f32 v38, v38, v16
  v_sub_f32 v39, v39, v16
  v_sub_f32 v40, v40, v16
  v_sub_f32 v41, v41, v16
  v_sub_f32 v42, v42, v16
  v_sub_f32 v43, v43, v16
  v_sub_f32 v12, v12, v16
  v_sub_f32 v13, v13, v16
  v_exp_f32 v36, v36
  v_exp_f32 v37, v37
  v_exp_f32 v38, v38
  v_exp_f32 v39, v39
  v_exp_f32 v40, v40
  v_exp_f32 v41, v41
  v_exp_f32 v42, v42
  v_exp_f32 v43, v43
  v_exp_f32 v12, v12
  v_exp_f32 v13, v13
  v_cvt_pk_bf16_f32 v32, v36, v40
  v_cvt_pk_bf16_f32 v33, v37, v41
  v_cvt_pk_bf16_f32 v34, v38, v42
  v_cvt_pk_bf16_f32 v35, v39, v43
  v_cvt_pk_bf16_f32 v28, v12, v13
  v_cvt_pk_bf16_f32 v31, v12, v13
  v_mov_b32 v29, 0
  v_mov_b32 v30, 0
  v_mfma_f32_16x16x32_bf16 v[8:11], v[32:35], v[68:71], 0
  v_mfma_f32_16x16x32_bf16 v[0:3], v[32:35], v[52:55], 0
  v_mfma_f32_16x16x32_bf16 v[4:7], v[32:35], v[56:59], 0
  v_mfma_f32_16x16x16_bf16 v[8:11], v[28:29], v[68:69], v[8:11]
  v_mfma_f32_16x16x16_bf16 v[0:3], v[28:29], v[72:73], v[0:3]
  v_mfma_f32_16x16x16_bf16 v[4:7], v[30:31], v[72:73], v[4:7]
  ds_read_b128 v[52:55], v75 offset:26624
  v_rcp_f32 v10, v8
  v_rcp_f32 v11, v9
  v_mul_f32 v0, v10, v0
  v_mul_f32 v1, v11, v1
  v_max3_f32 v8, v8, v9, v10
  v_mul_f32 v4, v10, v4
  v_mul_f32 v5, v11, v5
  v_cvt_pk_bf16_f32 v2, v0, v4
  ds_write_b32 v79, v2 offset:8704
  v_cvt_pk_bf16_f32 v3, v1, v5
  ds_write_b32 v79, v3 offset:9280
  ds_read_b128 v[12:15], v78 offset:8832
  ds_read_b128 v[56:59], v75 offset:27648
  v_mov_b64 v[16:17], 0
  v_mov_b64 v[18:19], 0
  v_mov_b64 v[20:21], 0
  v_mov_b64 v[22:23], 0
  v_mov_b64 v[24:25], 0
  v_mov_b64 v[26:27], 0
  s_branch Cs2_mxok
Cs2_last:
  ds_read_b128 v[4:7], v76 offset:5632
  ds_read_b128 v[8:11], v76 offset:6656
  ds_read_b128 v[44:47], v76 offset:40960
  ds_read_b128 v[48:51], v76 offset:41984
  s_nop 5
  v_mov_b64 v[20:21], 0
  v_mov_b64 v[22:23], 0
  v_mov_b64 v[24:25], 0
  v_mov_b64 v[26:27], 0
  s_waitcnt lgkmcnt(4)
  v_smfmac_f32_16x16x64_bf16 v[28:31], v[0:3], v[36:43], v74
  ds_read_b128 v[36:39], v76 offset:43008
  ds_read_b128 v[40:43], v76 offset:44032
  v_smfmac_f32_16x16x64_bf16 v[32:35], v[0:3], v[60:67], v74
  s_waitcnt lgkmcnt(5)
  v_smfmac_f32_16x16x64_bf16 v[20:23], v[0:3], a[32:39], v74
  ds_read_b128 v[60:63], v76 offset:57344
  ds_read_b128 v[64:67], v76 offset:58368
  v_smfmac_f32_16x16x64_bf16 v[24:27], v[0:3], a[40:47], v74
  s_waitcnt lgkmcnt(4)
  v_smfmac_f32_16x16x64_bf16 v[20:23], v[4:7], a[48:55], v74
  buffer_store_dwordx4 v[16:19], v76, s[8:11], s68 offen sc1
  v_smfmac_f32_16x16x64_bf16 v[24:27], v[4:7], a[56:63], v74
  v_smfmac_f32_16x16x64_bf16 v[28:31], v[4:7], v[44:51], v74
  s_waitcnt lgkmcnt(2)
  v_smfmac_f32_16x16x64_bf16 v[20:23], v[8:11], a[64:71], v74
  ds_read_b128 v[44:47], v76 offset:59392
  ds_read_b128 v[48:51], v76 offset:60416
  v_smfmac_f32_16x16x64_bf16 v[24:27], v[8:11], a[72:79], v74
  v_smfmac_f32_16x16x64_bf16 v[32:35], v[4:7], v[36:43], v74
  v_smfmac_f32_16x16x64_bf16 v[28:31], v[8:11], v[208:215], v74
  ds_read_b128 v[36:39], v75 offset:24576
  ds_read_b128 v[40:43], v75 offset:25600
  v_smfmac_f32_16x16x64_bf16 v[32:35], v[8:11], v[216:223], v74
  v_smfmac_f32_16x16x64_bf16 v[20:23], v[12:15], a[80:87], v74
  v_smfmac_f32_16x16x64_bf16 v[24:27], v[12:15], a[88:95], v74
  v_smfmac_f32_16x16x64_bf16 v[28:31], v[12:15], v[224:231], v74
  v_smfmac_f32_16x16x64_bf16 v[32:35], v[12:15], v[232:239], v74
  s_waitcnt vmcnt(1)
  s_barrier
Cs2_lastr:
  ds_read_b128 v[12:15], v76 offset:8704
  ds_read_b128 v[0:3], v76 offset:9728
  ds_read_b128 v[16:19], v76 offset:10752
  ds_read_b128 v[4:7], v76 offset:11776
  ds_read_b128 v[8:11], v76 offset:12800
  s_waitcnt lgkmcnt(3)
  v_max3_u32 v72, v0, v1, v2
  s_waitcnt lgkmcnt(1)
  v_max3_u32 v72, v72, v3, v4
  v_max3_u32 v72, v72, v5, v6
  s_waitcnt lgkmcnt(0)
  v_max3_u32 v72, v72, v7, v8
  v_max3_u32 v72, v72, v9, v10
  v_max3_u32 v72, v72, v11, v12
  v_max3_u32 v72, v72, v13, v14
  v_max3_u32 v72, v72, v15, v16
  v_max3_u32 v72, v72, v17, v18
  v_max_u32 v72, v72, v19
  v_cmp_eq_u32 vcc, -1, v72
  s_cbranch_vccnz Cs2_lastp
Cs2_lastg:
  v_smfmac_f32_16x16x64_bf16 v[28:31], v[12:15], v[60:67], v74
  ds_read_b128 v[60:63], v75 offset:26624
  ds_read_b128 v[64:67], v75 offset:27648
  v_smfmac_f32_16x16x64_bf16 v[32:35], v[12:15], v[44:51], v74
  v_smfmac_f32_16x16x64_bf16 v[28:31], v[0:3], v[36:43], v74
  v_smfmac_f32_16x16x64_bf16 v[28:31], v[16:19], v[240:247], v74
  v_smfmac_f32_16x16x64_bf16 v[28:31], v[4:7], a[0:7], v74
  v_smfmac_f32_16x16x64_bf16 v[28:31], v[8:11], a[16:23], v74
  v_smfmac_f32_16x16x64_bf16 v[32:35], v[16:19], v[248:255], v74
  v_smfmac_f32_16x16x64_bf16 v[32:35], v[4:7], a[8:15], v74
  s_waitcnt lgkmcnt(0)
  v_smfmac_f32_16x16x64_bf16 v[32:35], v[8:11], a[24:31], v74
  v_smfmac_f32_16x16x64_bf16 v[32:35], v[0:3], v[60:67], v74
  v_smfmac_f32_16x16x64_bf16 v[20:23], v[12:15], a[96:103], v74
  v_smfmac_f32_16x16x64_bf16 v[20:23], v[0:3], a[112:119], v74
  v_add_f32 v28, v28, v30
  v_add_f32 v32, v32, v34
  v_cvt_pk_bf16_f32 v30, v28, v32
  v_smfmac_f32_16x16x64_bf16 v[20:23], v[16:19], a[128:135], v74
  ds_write_b32 v79, v30 offset:256
  v_add_f32 v29, v29, v31
  v_add_f32 v33, v33, v35
  v_cvt_pk_bf16_f32 v31, v29, v33
  v_smfmac_f32_16x16x64_bf16 v[20:23], v[4:7], a[144:151], v74
  ds_write_b32 v79, v31 offset:832
  v_smfmac_f32_16x16x64_bf16 v[20:23], v[8:11], a[160:167], v74
  v_smfmac_f32_16x16x64_bf16 v[24:27], v[12:15], a[104:111], v74
  v_smfmac_f32_16x16x64_bf16 v[24:27], v[0:3], a[120:127], v74
  v_smfmac_f32_16x16x64_bf16 v[24:27], v[16:19], a[136:143], v74
  s_waitcnt lgkmcnt(0)
  s_barrier
  ds_read_b64 v[52:53], v77 offset:384
  v_add_f32 v20, v20, v22
  v_smfmac_f32_16x16x64_bf16 v[24:27], v[4:7], a[152:159], v74
  v_add_f32 v21, v21, v23
  v_smfmac_f32_16x16x64_bf16 v[24:27], v[8:11], a[168:175], v74
  v_cvt_pk_bf16_f32 v54, v20, v21
  s_add_u32 s68, s68, 655360
  s_nop 3
  v_add_f32 v24, v24, v26
  v_add_f32 v25, v25, v27
  v_cvt_pk_bf16_f32 v55, v24, v25
  s_waitcnt lgkmcnt(0)
  buffer_store_dwordx4 v[52:55], v76, s[8:11], s68 offen sc1
  s_branch Cs2_done
Cs2_lastp:
  s_add_u32 s72, s72, 2
  s_cmp_ge_u32 s72, 131072
  s_cbranch_scc1 Cs2_lastg
  s_barrier
  buffer_load_dwordx4 v76, s[8:11], s85 offen offset:0 sc1 lds
  s_waitcnt vmcnt(0)
  s_barrier
  s_branch Cs2_lastr
Cs2_done:
  s_branch L_cexit
L_w7:
  v_mov_b64 v[20:21], 0
  v_mov_b64 v[22:23], 0
  v_mov_b64 v[24:25], 0
  v_mov_b64 v[26:27], 0
  v_mov_b64 v[28:29], 0
  v_mov_b64 v[30:31], 0
  v_mov_b64 v[32:33], 0
  v_mov_b64 v[34:35], 0
  s_mov_b32 s78, 0x3f803f80
  s_mov_b32 s79, s78
  s_mov_b32 s65, 360448
  s_mov_b32 m0, 15872
  s_lshl_b32 s71, s53, 2
  s_add_u32 s71, s71, 128
  s_movk_i32 s56, 0x1000
  v_lshlrev_b32 v73, 2, v76
  v_mov_b32 v72, 0
  s_mov_b64 s[16:17], s[8:9]
  s_mov_b32 s18, 268435456
  s_mov_b32 s19, 0x20000
  s_getpc_b64 s[20:21]
Cs3_pc:
  s_add_u32 s20, s20, (Cs3_last - Cs3_pc)
  s_addc_u32 s21, s21, 0
  v_mov_b32 v68, 14880
  buffer_load_dwordx4 v[52:55], v76, s[8:11], s59 offen offset:0 sc1
  buffer_load_dwordx4 v[56:59], v76, s[8:11], s59 offen offset:1024 sc1
  ds_read_b128 v[36:39], v76 offset:45056
  ds_read_b128 v[40:43], v76 offset:46080
  ds_read_b128 v[60:63], v76 offset:47104
  ds_read_b128 v[64:67], v76 offset:48128
  ds_read_b128 v[0:3], v76 offset:4608
  ds_read_b128 v[4:7], v76 offset:5632
  ds_read_b128 v[8:11], v76 offset:6656
  ds_read_b128 v[12:15], v76 offset:7680
  s_waitcnt lgkmcnt(0)
  s_cmp_eq_u32 s66, 1
  s_branch Cs3_top2
.p2align 6
Cs3_h2:
  v_lshlrev_b32 v73, 2, v76
  ds_read_b128 v[36:39], v76 offset:45056
  ds_read_b128 v[40:43], v76 offset:46080
  buffer_load_dwordx4 v[52:55], v76, s[8:11], s59 offen offset:0 sc1
  buffer_load_dwordx4 v[56:59], v76, s[8:11], s59 offen offset:1024 sc1
  s_waitcnt vmcnt(0)
  s_mov_b64 vcc, -1
Cs3_h2r:
  s_mov_b64 exec, vcc
  buffer_load_dwordx4 v[4:7], v76, s[8:11], s65 offen offset:1024 sc1
  buffer_load_dwordx4 v[0:3], v76, s[8:11], s85 offen offset:0 sc1
  buffer_load_dwordx4 v[8:11], v76, s[8:11], s85 offen offset:1024 sc1
  s_mov_b64 exec, -1
  s_add_u32 s67, s67, 1
  s_cmp_lt_u32 s67, 131072
  s_cselect_b32 s54, -2, -1
  s_waitcnt vmcnt(2)
  v_max3_u32 v72, v4, v5, v6
  s_waitcnt vmcnt(1)
  v_max3_u32 v72, v72, v7, v0
  v_max3_u32 v72, v72, v1, v2
  s_waitcnt vmcnt(0)
  v_max3_u32 v72, v72, v3, v8
  v_max3_u32 v72, v72, v9, v10
  v_max_u32 v72, v72, v11
  v_cmp_lt_u32 vcc, s54, v72
  s_cbranch_vccnz Cs3_h2r
  ds_write_b128 v76, v[4:7] offset:5632
  ds_write_b128 v76, v[0:3] offset:8704
  ds_write_b128 v76, v[8:11] offset:9728
Cs3_h2w:
  s_cmp_eq_u32 s66, 63
  s_waitcnt lgkmcnt(0)
  s_barrier
  ds_read_b128 v[8:11], v76 offset:6656
Cs3_top2:
  v_smfmac_f32_16x16x64_bf16 v[20:23], v[4:7], v[96:103], v74
  s_cbranch_scc1 Cs3_last
  v_smfmac_f32_16x16x64_bf16 v[28:31], v[4:7], v[36:43], v74
  buffer_load_dwordx4 v[44:47], v76, s[8:11], s58 offen offset:0 sc1
  s_mov_b32 m0, 15872
  v_smfmac_f32_16x16x64_bf16 v[24:27], v[4:7], v[104:111], v74
  buffer_load_dwordx4 v[48:51], v76, s[8:11], s58 offen offset:1024 sc1
  v_smfmac_f32_16x16x64_bf16 v[32:35], v[4:7], v[60:67], v74
  ds_read_b128 v[0:3], v76 offset:4608
  s_waitcnt lgkmcnt(1)
  v_smfmac_f32_16x16x64_bf16 v[20:23], v[8:11], v[112:119], v74
  ds_read_b128 v[12:15], v76 offset:7680
  v_smfmac_f32_16x16x64_bf16 v[24:27], v[8:11], v[120:127], v74
  ds_read_b128 v[36:39], v76 offset:28672
  v_smfmac_f32_16x16x64_bf16 v[28:31], v[8:11], v[208:215], v74
  buffer_store_dwordx4 v[16:19], v76, s[8:11], s68 offen sc1
  ds_read_b128 v[40:43], v76 offset:29696
  v_smfmac_f32_16x16x64_bf16 v[32:35], v[8:11], v[216:223], v74
  buffer_load_dword v73, s[16:19], s70 offen lds
  ds_read_b128 v[60:63], v76 offset:30720
  s_waitcnt lgkmcnt(4)
  v_smfmac_f32_16x16x64_bf16 v[20:23], v[0:3], v[80:87], v74
  ds_read_b128 v[64:67], v76 offset:31744
  v_smfmac_f32_16x16x64_bf16 v[24:27], v[0:3], v[88:95], v74
  s_waitcnt vmcnt(4)
  s_waitcnt lgkmcnt(4)
  v_smfmac_f32_16x16x64_bf16 v[20:23], v[12:15], v[128:135], v74
  s_barrier
  ds_read_b128 v[4:7], v76 offset:8704
  s_waitcnt lgkmcnt(3)
  v_smfmac_f32_16x16x64_bf16 v[28:31], v[0:3], v[36:43], v74
  ds_read_b128 v[36:39], v76 offset:61440
  v_smfmac_f32_16x16x64_bf16 v[24:27], v[12:15], v[136:143], v74
  ds_read_b128 v[40:43], v76 offset:62464
  s_waitcnt lgkmcnt(3)
  v_smfmac_f32_16x16x64_bf16 v[32:35], v[0:3], v[60:67], v74
  ds_read_b128 v[8:11], v76 offset:9728
  v_smfmac_f32_16x16x64_bf16 v[28:31], v[12:15], v[224:231], v74
  ds_read_b128 v[60:63], v76 offset:63488
  v_smfmac_f32_16x16x64_bf16 v[32:35], v[12:15], v[232:239], v74
  ds_read_b128 v[64:67], v76 offset:64512
  s_waitcnt lgkmcnt(5)
  v_smfmac_f32_16x16x64_bf16 v[20:23], v[4:7], v[144:151], v74
  s_barrier
  ds_read_b128 v[0:3], v76 offset:11776
  s_waitcnt lgkmcnt(4)
  v_smfmac_f32_16x16x64_bf16 v[28:31], v[4:7], v[36:43], v74
  ds_read_b128 v[12:15], v76 offset:12800
  ds_read_b128 v[36:39], v75 offset:12288
  v_smfmac_f32_16x16x64_bf16 v[24:27], v[4:7], v[152:159], v74
  ds_read_b128 v[16:19], v76 offset:10752
  s_waitcnt lgkmcnt(6)
  v_smfmac_f32_16x16x64_bf16 v[20:23], v[8:11], v[160:167], v74
  ds_read_b128 v[40:43], v75 offset:13312
  s_waitcnt lgkmcnt(5)
  v_smfmac_f32_16x16x64_bf16 v[32:35], v[4:7], v[60:67], v74
  ds_read_b128 v[60:63], v75 offset:14336
  v_smfmac_f32_16x16x64_bf16 v[24:27], v[8:11], v[168:175], v74
  ds_read_b128 v[64:67], v75 offset:15360
  s_waitcnt lgkmcnt(6)
  v_smfmac_f32_16x16x64_bf16 v[20:23], v[0:3], v[176:183], v74
  s_waitcnt lgkmcnt(5)
  v_smfmac_f32_16x16x64_bf16 v[20:23], v[12:15], v[192:199], v74
  s_waitcnt lgkmcnt(2)
  v_smfmac_f32_16x16x64_bf16 v[20:23], v[16:19], v[36:43], v74
  ds_read_b128 v[36:39], v75 offset:28672
  v_smfmac_f32_16x16x64_bf16 v[24:27], v[0:3], v[184:191], v74
  ds_read_b128 v[40:43], v75 offset:29696
  s_waitcnt lgkmcnt(2)
  v_smfmac_f32_16x16x64_bf16 v[24:27], v[16:19], v[60:67], v74
  ds_read_b128 v[60:63], v75 offset:30720
  v_add_f32 v20, v20, v22
  v_smfmac_f32_16x16x64_bf16 v[24:27], v[12:15], v[200:207], v74
  ds_read_b128 v[64:67], v75 offset:31744
  v_add_f32 v21, v21, v23
  v_smfmac_f32_16x16x64_bf16 v[28:31], v[16:19], v[240:247], v74
  v_mov_b64 v[70:71], s[78:79]
  v_smfmac_f32_16x16x64_bf16 v[28:31], v[0:3], a[0:7], v74
  s_waitcnt lgkmcnt(2)
  v_add_f32 v24, v24, v26
  v_smfmac_f32_16x16x64_bf16 v[28:31], v[8:11], v[36:43], v74
  ds_read_b128 v[36:39], v68
  v_cvt_pk_bf16_f32 v22, v20, v24
  v_smfmac_f32_16x16x64_bf16 v[28:31], v[12:15], a[16:23], v74
  ds_read_b128 v[40:43], v68
  ds_write_b32 v79, v22 offset:0
  s_waitcnt lgkmcnt(3)
  v_add_f32 v25, v25, v27
  v_cvt_pk_bf16_f32 v23, v21, v25
  v_smfmac_f32_16x16x64_bf16 v[32:35], v[8:11], v[60:67], v74
  ds_write_b32 v79, v23 offset:576
  v_cmp_u_f32 vcc, v20, v21
  v_smfmac_f32_16x16x64_bf16 v[32:35], v[16:19], v[248:255], v74
  v_add_f32 v28, v28, v30
  v_smfmac_f32_16x16x64_bf16 v[32:35], v[0:3], a[8:15], v74
  v_add_f32 v29, v29, v31
  v_smfmac_f32_16x16x64_bf16 v[32:35], v[12:15], a[24:31], v74
  s_cbranch_vccnz Cs3_rec
Cs3_recok:
  s_waitcnt lgkmcnt(3)
  v_smfmac_f32_16x16x64_bf16 v[36:39], v[16:19], a[128:135], v74
  s_waitcnt lgkmcnt(0)
  s_barrier
  ds_read_b128 v[60:63], v77
  v_smfmac_f32_16x16x64_bf16 v[40:43], v[16:19], a[136:143], v74
  ds_read_b128 v[64:67], v77 offset:128
  v_add_f32 v32, v32, v34
  v_cvt_pk_bf16_f32 v30, v28, v32
  v_smfmac_f32_16x16x64_bf16 v[36:39], v[0:3], a[144:151], v74
  ds_write_b32 v79, v30 offset:256
  v_add_f32 v33, v33, v35
  v_cvt_pk_bf16_f32 v31, v29, v33
  v_smfmac_f32_16x16x64_bf16 v[40:43], v[0:3], a[152:159], v74
  ds_write_b32 v79, v31 offset:832
  v_xor_b32 v75, 0x8000, v75
  v_smfmac_f32_16x16x64_bf16 v[36:39], v[4:7], a[96:103], v74
  ds_read_b128 v[0:3], v76 offset:4608
  v_mov_b32 v29, 0
  v_smfmac_f32_16x16x64_bf16 v[40:43], v[4:7], a[104:111], v74
  s_waitcnt vmcnt(2) lgkmcnt(3)
  v_mov_b32 v30, 0
  v_mfma_f32_16x16x32_bf16 v[44:47], v[44:47], v[60:63], 0
  ds_read_b128 v[4:7], v76 offset:5632
  s_waitcnt lgkmcnt(2)
  v_mfma_f32_16x16x32_bf16 v[44:47], v[48:51], v[64:67], v[44:47]
  s_barrier
  v_smfmac_f32_16x16x64_bf16 v[36:39], v[8:11], a[112:119], v74
  ds_read_b128 v[20:23], v77 offset:256
  ds_read_b128 v[24:27], v77 offset:384
  v_smfmac_f32_16x16x64_bf16 v[40:43], v[8:11], a[120:127], v74
  ds_read_b128 v[8:11], v76 offset:6656
  v_add_f32_dpp v72, v46, v44 quad_perm:[2,3,0,1] row_mask:0xf bank_mask:0xf
  v_add_f32_dpp v73, v47, v45 quad_perm:[2,3,0,1] row_mask:0xf bank_mask:0xf
  v_smfmac_f32_16x16x64_bf16 v[36:39], v[12:15], a[160:167], v74
  s_waitcnt lgkmcnt(4)
  v_exp_f32_dpp v72, v72 quad_perm:[0,1,0,1] row_mask:0xf bank_mask:0xf
  v_smfmac_f32_16x16x64_bf16 v[40:43], v[12:15], a[168:175], v74
  ds_read_b128 v[12:15], v76 offset:7680
  v_exp_f32_dpp v73, v73 quad_perm:[0,1,0,1] row_mask:0xf bank_mask:0xf
  v_smfmac_f32_16x16x64_bf16 v[36:39], v[0:3], a[32:39], v74
  s_waitcnt lgkmcnt(2)
  v_cvt_pk_bf16_f32 v72, v72, v73
  v_mfma_f32_16x16x32_bf16 v[20:23], v[20:23], v[60:63], 0
  ds_write_b32 v78, v72 offset:524
  v_mov_b64 v[16:17], 0
  v_mfma_f32_16x16x32_bf16 v[20:23], v[24:27], v[64:67], v[20:23]
  ds_read_b128 v[44:47], v75 offset:47104
  v_mov_b64 v[18:19], 0
  v_smfmac_f32_16x16x64_bf16 v[40:43], v[0:3], a[40:47], v74
  ds_read_b128 v[48:51], v75 offset:48128
  v_mov_b64 v[68:69], s[78:79]
  v_smfmac_f32_16x16x64_bf16 v[36:39], v[4:7], a[48:55], v74
  s_waitcnt lgkmcnt(4)
  v_add_f32_dpp v24, v22, v20 quad_perm:[2,3,0,1] row_mask:0xf bank_mask:0xf
  v_add_f32_dpp v25, v23, v21 quad_perm:[2,3,0,1] row_mask:0xf bank_mask:0xf
  v_smfmac_f32_16x16x64_bf16 v[36:39], v[8:11], a[64:71], v74
  s_waitcnt lgkmcnt(2)
  s_barrier
  ds_read_b128 v[32:35], v78 offset:512
  v_smfmac_f32_16x16x64_bf16 v[36:39], v[12:15], a[80:87], v74
  ds_read_b128 v[60:63], v75 offset:28672
  v_mul_f32 v24, s69, v24
  v_smfmac_f32_16x16x64_bf16 v[40:43], v[4:7], a[56:63], v74
  ds_read_b128 v[64:67], v75 offset:29696
  v_mul_f32 v25, s69, v25
  v_smfmac_f32_16x16x64_bf16 v[40:43], v[8:11], a[72:79], v74
  v_exp_f32_dpp v24, v24 quad_perm:[0,1,0,1] row_mask:0xf bank_mask:0xf
  v_smfmac_f32_16x16x64_bf16 v[40:43], v[12:15], a[88:95], v74
  s_waitcnt lgkmcnt(2)
  v_exp_f32_dpp v25, v25 quad_perm:[0,1,0,1] row_mask:0xf bank_mask:0xf
  v_mfma_f32_16x16x32_bf16 v[8:11], v[32:35], v[68:71], 0
  v_add_f32 v36, v36, v38
  v_add_f32 v37, v37, v39
  v_mfma_f32_16x16x32_bf16 v[0:3], v[32:35], v[52:55], 0
  v_add_f32 v40, v40, v42
  v_add_f32 v41, v41, v43
  v_mfma_f32_16x16x32_bf16 v[4:7], v[32:35], v[56:59], 0
  v_cvt_pk_bf16_f32 v28, v24, v25
  v_cvt_pk_bf16_f32 v72, v36, v37
  v_cvt_pk_bf16_f32 v73, v40, v41
  v_mfma_f32_16x16x16_bf16 v[8:11], v[28:29], v[68:69], v[8:11]
  v_cvt_pk_bf16_f32 v31, v24, v25
  v_mov_b64 v[20:21], 0
  v_mfma_f32_16x16x16_bf16 v[0:3], v[28:29], v[72:73], v[0:3]
  ds_read_b128 v[52:55], v75 offset:30720
  v_mov_b64 v[22:23], 0
  v_mfma_f32_16x16x16_bf16 v[4:7], v[30:31], v[72:73], v[4:7]
  v_rcp_f32 v10, v8
  v_rcp_f32 v11, v9
  v_mul_f32 v0, v10, v0
  v_mul_f32 v1, v11, v1
  v_max3_f32 v8, v8, v9, v10
  v_mul_f32 v4, v10, v4
  v_mul_f32 v5, v11, v5
  v_cvt_pk_bf16_f32 v2, v0, v4
  ds_write_b32 v79, v2 offset:8704
  v_cvt_pk_bf16_f32 v3, v1, v5
  ds_write_b32 v79, v3 offset:9280
  ds_read_b128 v[12:15], v78 offset:8896
  v_max_f32 v8, v8, v11
  v_cmp_le_f32 vcc, 1317011456, v8
  v_mov_b64 v[24:25], 0
  v_mov_b64 v[26:27], 0
  ds_read_b128 v[56:59], v75 offset:31744
  s_cbranch_vccnz Cs3_mx
Cs3_mxok:
  s_waitcnt lgkmcnt(2)
  s_barrier
  ds_read_b128 v[0:3], v78 offset:8832
  s_waitcnt lgkmcnt(2)
  v_smfmac_f32_16x16x64_bf16 v[16:19], v[12:15], a[184:191], v74
  ds_read_b128 v[4:7], v78 offset:8704
  v_smfmac_f32_16x16x64_bf16 v[20:23], v[12:15], v[44:51], v74
  ds_read_b128 v[8:11], v78 offset:8768
  v_smfmac_f32_16x16x64_bf16 v[24:27], v[12:15], a[232:239], v74
  ds_read_b128 v[36:39], v75 offset:45056
  s_waitcnt lgkmcnt(3)
  v_smfmac_f32_16x16x64_bf16 v[16:19], v[0:3], a[176:183], v74
  ds_read_b128 v[40:43], v75 offset:46080
  s_waitcnt lgkmcnt(3)
  v_smfmac_f32_16x16x64_bf16 v[16:19], v[4:7], v[60:67], v74
  ds_read_b128 v[68:71], v76 offset:13824
  s_waitcnt lgkmcnt(3)
  v_smfmac_f32_16x16x64_bf16 v[16:19], v[8:11], v[52:59], v74
  ds_read_b128 v[44:47], v75 offset:61440
  v_smfmac_f32_16x16x64_bf16 v[20:23], v[4:7], a[192:199], v74
  ds_read_b128 v[48:51], v75 offset:62464
  v_smfmac_f32_16x16x64_bf16 v[20:23], v[8:11], a[200:207], v74
  ds_read_b128 v[60:63], v75 offset:63488
  s_waitcnt lgkmcnt(4)
  v_cvt_pk_bf16_f32 v16, v16, v17
  v_cvt_pk_bf16_f32 v17, v18, v19
  v_bfi_b32 v16, 1, s72, v16
  v_smfmac_f32_16x16x64_bf16 v[20:23], v[0:3], v[36:43], v74
  s_waitcnt lgkmcnt(3)
  buffer_store_dwordx2 v[16:17], v68, s[8:11], s73 offen sc1
  v_mov_b64 v[32:33], 0
  v_smfmac_f32_16x16x64_bf16 v[24:27], v[4:7], a[208:215], v74
  ds_read_b128 v[64:67], v75 offset:64512
  v_mov_b64 v[34:35], 0
  v_smfmac_f32_16x16x64_bf16 v[24:27], v[8:11], a[216:223], v74
  ds_read_b128 v[52:55], v75 offset:8192
  v_cvt_pk_bf16_f32 v20, v20, v21
  v_cvt_pk_bf16_f32 v21, v22, v23
  v_bfi_b32 v20, 1, s72, v20
  v_smfmac_f32_16x16x64_bf16 v[24:27], v[0:3], a[224:231], v74
  ds_read_b128 v[56:59], v75 offset:9216
  buffer_store_dwordx2 v[20:21], v68, s[8:11], s74 offen sc1
  s_waitcnt lgkmcnt(4)
  v_mov_b64 v[28:29], 0
  v_smfmac_f32_16x16x64_bf16 v[32:35], v[4:7], v[44:51], v74
  ds_read_b128 v[36:39], v75 offset:10240
  ds_read_b128 v[40:43], v75 offset:11264
  s_waitcnt lgkmcnt(4)
  v_smfmac_f32_16x16x64_bf16 v[32:35], v[8:11], v[60:67], v74
  ds_read_b128 v[44:47], v75 offset:12288
  v_cvt_pk_bf16_f32 v24, v24, v25
  v_cvt_pk_bf16_f32 v25, v26, v27
  v_bfi_b32 v24, 1, s72, v24
  v_smfmac_f32_16x16x64_bf16 v[32:35], v[0:3], a[240:247], v74
  ds_read_b128 v[48:51], v75 offset:13312
  buffer_store_dwordx2 v[24:25], v68, s[8:11], s75 offen sc1
  v_mov_b64 v[30:31], 0
  v_smfmac_f32_16x16x64_bf16 v[32:35], v[12:15], a[248:255], v74
  ds_read_b128 v[60:63], v75 offset:14336
  ds_read_b128 v[64:67], v75 offset:15360
  s_waitcnt lgkmcnt(6)
  v_smfmac_f32_16x16x64_bf16 v[28:31], v[4:7], v[52:59], v74
  s_waitcnt lgkmcnt(4)
  v_smfmac_f32_16x16x64_bf16 v[28:31], v[8:11], v[36:43], v74
  s_waitcnt lgkmcnt(2)
  v_cvt_pk_bf16_f32 v32, v32, v33
  v_cvt_pk_bf16_f32 v33, v34, v35
  v_bfi_b32 v32, 1, s72, v32
  v_smfmac_f32_16x16x64_bf16 v[28:31], v[0:3], v[44:51], v74
  buffer_store_dwordx2 v[32:33], v68, s[8:11], s76 offen sc1
  s_waitcnt lgkmcnt(0)
  v_smfmac_f32_16x16x64_bf16 v[28:31], v[12:15], v[60:67], v74
  v_mov_b64 v[18:19], v[72:73]
  s_nop 4
  v_cvt_pk_bf16_f32 v28, v28, v29
  v_cvt_pk_bf16_f32 v29, v30, v31
  v_bfi_b32 v28, 1, s72, v28
  buffer_store_dwordx2 v[28:29], v68, s[8:11], s77 offen sc1
  ds_read_b128 v[52:55], v76 offset:14848
  s_waitcnt lgkmcnt(0)
  ds_read_b64 v[16:17], v77 offset:392
  s_waitcnt lgkmcnt(0)
  ds_read_b128 v[60:63], v76 offset:47104
  s_waitcnt lgkmcnt(0)
  ds_read_b128 v[64:67], v76 offset:48128
  s_waitcnt lgkmcnt(0)
  s_add_u32 s66, s66, 1
  s_xor_b32 s64, s64, 16384
  s_xor_b32 s65, s65, 16384
  s_add_u32 s58, s58, 655360
  s_add_u32 s59, s59, 655360
  s_add_u32 s70, s70, 655360
  s_add_u32 s68, s68, 655360
  s_mov_b32 m0, 8704
  s_add_u32 s85, s65, 4096
  v_xor_b32 v75, 0x8000, v75
  v_mov_b64 v[28:29], 0
  v_mov_b64 v[30:31], 0
  v_mov_b64 v[32:33], 0
  v_mov_b64 v[34:35], 0
  s_waitcnt vmcnt(0)
  buffer_load_dwordx4 v[0:3], v76, s[8:11], s60 offen offset:0 sc1
  buffer_load_dwordx4 v[4:7], v76, s[8:11], s60 offen offset:1024 sc1
  buffer_load_dwordx4 v[8:11], v76, s[8:11], s61 offen offset:0 sc1
  buffer_load_dwordx4 v[12:15], v76, s[8:11], s61 offen offset:1024 sc1
  v_mov_b64 v[20:21], 0
  v_mov_b64 v[22:23], 0
  v_mov_b64 v[24:25], 0
  v_mov_b64 v[26:27], 0
  v_mov_b32 v68, 14880
  s_cmp_eq_u32 s66, 62
  s_cselect_b64 s[16:17], s[20:21], s[16:17]
  s_cselect_b32 s18, (Cs3_done - Cs3_last), s18
  s_cselect_b32 s70, 0, s70
  s_cmp_eq_u32 s66, 63
  s_cselect_b32 s59, 268435456, s59
  s_cselect_b32 s58, 268435456, s58
  s_waitcnt lgkmcnt(0)
  s_waitcnt vmcnt(3)
  v_mfma_f32_16x16x32_bf16 v[56:59], v[52:55], v[0:3], 0
  v_bitop3_b32 v72, v0, v2, s72 bitop3:0x7e
  s_waitcnt vmcnt(2)
  v_mfma_f32_16x16x32_bf16 v[56:59], v[52:55], v[4:7], v[56:59]
  v_bitop3_b32 v73, v4, v6, s72 bitop3:0x7e
  v_or_b32 v72, v72, v73
  s_waitcnt vmcnt(1)
  v_mfma_f32_16x16x32_bf16 v[36:39], v[52:55], v[8:11], 0
  v_bitop3_b32 v73, v8, v10, s72 bitop3:0x7e
  v_or_b32 v72, v72, v73
  s_waitcnt vmcnt(0)
  v_mfma_f32_16x16x32_bf16 v[36:39], v[52:55], v[12:15], v[36:39]
  v_bitop3_b32 v73, v12, v14, s72 bitop3:0x7e
  v_bitop3_b32 v72, v72, v73, 1 bitop3:0xa8
  v_cmp_ne_u32 vcc, 0, v72
  s_cbranch_vccnz Cs3_h1r
  v_add_f32_dpp v56, v56, v56 row_ror:4 row_mask:0xf bank_mask:0xf
  v_add_f32_dpp v57, v57, v57 row_ror:4 row_mask:0xf bank_mask:0xf
  s_nop 0
  v_add_f32_dpp v36, v36, v36 row_ror:4 row_mask:0xf bank_mask:0xf
  v_add_f32_dpp v37, v37, v37 row_ror:4 row_mask:0xf bank_mask:0xf
  v_add_f32_dpp v56, v56, v56 row_ror:8 row_mask:0xf bank_mask:0xf
  v_add_f32_dpp v57, v57, v57 row_ror:8 row_mask:0xf bank_mask:0xf
  v_add_f32_dpp v36, v36, v36 row_ror:8 row_mask:0xf bank_mask:0xf
  v_add_f32_dpp v37, v37, v37 row_ror:8 row_mask:0xf bank_mask:0xf
  v_cvt_pk_bf16_f32 v56, v56, v57
  buffer_store_dword v56, v69, s[8:11], s62 offen sc1
  v_cvt_pk_bf16_f32 v36, v36, v37
  buffer_store_dword v36, v70, s[8:11], s63 offen sc1
  s_xor_b32 s62, s62, 16384
  buffer_store_dword v71, v69, s[8:11], s62 offen sc1
  s_xor_b32 s63, s63, 16384
  buffer_store_dword v71, v70, s[8:11], s63 offen sc1
  s_xor_b32 s72, s72, 1
  s_branch Cs3_h2
Cs3_h1r:
  s_mov_b64 exec, vcc
  buffer_load_dwordx4 v[0:3], v76, s[8:11], s60 offen offset:0 sc1
  buffer_load_dwordx4 v[4:7], v76, s[8:11], s60 offen offset:1024 sc1
  buffer_load_dwordx4 v[8:11], v76, s[8:11], s61 offen offset:0 sc1
  buffer_load_dwordx4 v[12:15], v76, s[8:11], s61 offen offset:1024 sc1
  s_mov_b64 exec, -1
  s_add_u32 s67, s67, 1
  s_waitcnt vmcnt(3)
  v_mfma_f32_16x16x32_bf16 v[56:59], v[52:55], v[0:3], 0
  v_bitop3_b32 v72, v0, v2, s72 bitop3:0x7e
  s_waitcnt vmcnt(2)
  v_mfma_f32_16x16x32_bf16 v[56:59], v[52:55], v[4:7], v[56:59]
  v_bitop3_b32 v73, v4, v6, s72 bitop3:0x7e
  v_or_b32 v72, v72, v73
  s_waitcnt vmcnt(1)
  v_mfma_f32_16x16x32_bf16 v[36:39], v[52:55], v[8:11], 0
  v_bitop3_b32 v73, v8, v10, s72 bitop3:0x7e
  v_or_b32 v72, v72, v73
  s_waitcnt vmcnt(0)
  v_mfma_f32_16x16x32_bf16 v[36:39], v[52:55], v[12:15], v[36:39]
  v_bitop3_b32 v73, v12, v14, s72 bitop3:0x7e
  v_bitop3_b32 v72, v72, v73, 1 bitop3:0xa8
  v_cmp_ne_u32 vcc, 0, v72
  s_cbranch_vccz Cs3_h1p
Cs3_h1s:
  s_mov_b64 exec, vcc
  buffer_load_dwordx4 v[0:3], v76, s[8:11], s60 offen offset:0 sc1
  buffer_load_dwordx4 v[4:7], v76, s[8:11], s60 offen offset:1024 sc1
  buffer_load_dwordx4 v[8:11], v76, s[8:11], s61 offen offset:0 sc1
  buffer_load_dwordx4 v[12:15], v76, s[8:11], s61 offen offset:1024 sc1
  s_mov_b64 exec, -1
  s_add_u32 s67, s67, 1
  s_waitcnt vmcnt(3)
  v_mfma_f32_16x16x32_bf16 v[56:59], v[52:55], v[0:3], 0
  v_bitop3_b32 v72, v0, v2, s72 bitop3:0x7e
  s_waitcnt vmcnt(2)
  v_mfma_f32_16x16x32_bf16 v[56:59], v[52:55], v[4:7], v[56:59]
  v_bitop3_b32 v73, v4, v6, s72 bitop3:0x7e
  v_or_b32 v72, v72, v73
  s_waitcnt vmcnt(1)
  v_mfma_f32_16x16x32_bf16 v[36:39], v[52:55], v[8:11], 0
  v_bitop3_b32 v73, v8, v10, s72 bitop3:0x7e
  v_or_b32 v72, v72, v73
  s_waitcnt vmcnt(0)
  v_mfma_f32_16x16x32_bf16 v[36:39], v[52:55], v[12:15], v[36:39]
  v_bitop3_b32 v73, v12, v14, s72 bitop3:0x7e
  v_bitop3_b32 v72, v72, v73, 1 bitop3:0xa8
  v_cmp_ne_u32 vcc, 0, v72
  s_cbranch_vccz Cs3_h1p
  s_cmp_lt_u32 s67, 131072
  s_cbranch_scc1 Cs3_h1s
Cs3_h1p:
  s_nop 2
  v_add_f32_dpp v56, v56, v56 row_ror:4 row_mask:0xf bank_mask:0xf
  v_add_f32_dpp v57, v57, v57 row_ror:4 row_mask:0xf bank_mask:0xf
  v_add_f32_dpp v36, v36, v36 row_ror:4 row_mask:0xf bank_mask:0xf
  v_add_f32_dpp v37, v37, v37 row_ror:4 row_mask:0xf bank_mask:0xf
  v_add_f32_dpp v56, v56, v56 row_ror:8 row_mask:0xf bank_mask:0xf
  v_add_f32_dpp v57, v57, v57 row_ror:8 row_mask:0xf bank_mask:0xf
  v_add_f32_dpp v36, v36, v36 row_ror:8 row_mask:0xf bank_mask:0xf
  v_add_f32_dpp v37, v37, v37 row_ror:8 row_mask:0xf bank_mask:0xf
  v_cvt_pk_bf16_f32 v56, v56, v57
  buffer_store_dword v56, v69, s[8:11], s62 offen sc1
  v_cvt_pk_bf16_f32 v36, v36, v37
  buffer_store_dword v36, v70, s[8:11], s63 offen sc1
  s_xor_b32 s62, s62, 16384
  buffer_store_dword v71, v69, s[8:11], s62 offen sc1
  s_xor_b32 s63, s63, 16384
  buffer_store_dword v71, v70, s[8:11], s63 offen sc1
  s_xor_b32 s72, s72, 1
  s_branch Cs3_h2
Cs3_rec:
  s_nop 7
  s_waitcnt vmcnt(0) lgkmcnt(0)
  v_max3_u32 v72, v0, v1, v2
  v_max3_u32 v72, v72, v3, v4
  v_max3_u32 v72, v72, v5, v6
  v_max3_u32 v72, v72, v7, v8
  v_max3_u32 v72, v72, v9, v10
  v_max3_u32 v72, v72, v11, v12
  v_max3_u32 v72, v72, v13, v14
  v_max3_u32 v72, v72, v15, v16
  v_max3_u32 v72, v72, v17, v18
  v_max_u32 v72, v72, v19
  v_cmp_eq_u32 vcc, -1, v72
  s_cbranch_vccz Cs3_recok
  s_barrier
Cs3_recp:
  buffer_load_dwordx4 v[0:3], v76, s[8:11], s64 offen offset:0 sc1
  buffer_load_dwordx4 v[4:7], v76, s[8:11], s64 offen offset:1024 sc1
  buffer_load_dwordx4 v[8:11], v76, s[8:11], s64 offen offset:2048 sc1
  s_add_u32 s67, s67, 1
  s_cmp_lt_u32 s67, 131072
  s_cselect_b32 s54, -2, -1
  s_waitcnt vmcnt(2)
  v_max3_u32 v72, v0, v1, v2
  s_waitcnt vmcnt(1)
  v_max3_u32 v72, v72, v3, v4
  v_max3_u32 v72, v72, v5, v6
  s_waitcnt vmcnt(0)
  v_max3_u32 v72, v72, v7, v8
  v_max3_u32 v72, v72, v9, v10
  v_max_u32 v72, v72, v11
  v_cmp_lt_u32 vcc, s54, v72
  s_cbranch_vccnz Cs3_recp
  ds_write_b128 v76, v[0:3] offset:10752
  ds_write_b128 v76, v[4:7] offset:11776
  ds_write_b128 v76, v[8:11] offset:12800
  v_mov_b64 v[20:21], 0
  v_mov_b64 v[22:23], 0
  v_mov_b64 v[24:25], 0
  v_mov_b64 v[26:27], 0
  v_mov_b64 v[28:29], 0
  v_mov_b64 v[30:31], 0
  v_mov_b64 v[32:33], 0
  v_mov_b64 v[34:35], 0
  s_waitcnt lgkmcnt(0)
  s_barrier
  ds_read_b128 v[0:3], v76 offset:4608
  s_waitcnt lgkmcnt(0)
  v_smfmac_f32_16x16x64_bf16 v[20:23], v[0:3], v[80:87], v74
  v_smfmac_f32_16x16x64_bf16 v[24:27], v[0:3], v[88:95], v74
  ds_read_b128 v[60:63], v76 offset:28672
  ds_read_b128 v[64:67], v76 offset:29696
  s_waitcnt lgkmcnt(0)
  v_smfmac_f32_16x16x64_bf16 v[28:31], v[0:3], v[60:67], v74
  ds_read_b128 v[60:63], v76 offset:30720
  ds_read_b128 v[64:67], v76 offset:31744
  s_waitcnt lgkmcnt(0)
  v_smfmac_f32_16x16x64_bf16 v[32:35], v[0:3], v[60:67], v74
  ds_read_b128 v[4:7], v76 offset:5632
  s_waitcnt lgkmcnt(0)
  v_smfmac_f32_16x16x64_bf16 v[20:23], v[4:7], v[96:103], v74
  v_smfmac_f32_16x16x64_bf16 v[24:27], v[4:7], v[104:111], v74
  ds_read_b128 v[60:63], v76 offset:45056
  ds_read_b128 v[64:67], v76 offset:46080
  s_waitcnt lgkmcnt(0)
  v_smfmac_f32_16x16x64_bf16 v[28:31], v[4:7], v[60:67], v74
  ds_read_b128 v[60:63], v76 offset:47104
  ds_read_b128 v[64:67], v76 offset:48128
  s_waitcnt lgkmcnt(0)
  v_smfmac_f32_16x16x64_bf16 v[32:35], v[4:7], v[60:67], v74
  ds_read_b128 v[8:11], v76 offset:6656
  s_waitcnt lgkmcnt(0)
  v_smfmac_f32_16x16x64_bf16 v[20:23], v[8:11], v[112:119], v74
  v_smfmac_f32_16x16x64_bf16 v[24:27], v[8:11], v[120:127], v74
  v_smfmac_f32_16x16x64_bf16 v[28:31], v[8:11], v[208:215], v74
  v_smfmac_f32_16x16x64_bf16 v[32:35], v[8:11], v[216:223], v74
  ds_read_b128 v[12:15], v76 offset:7680
  s_waitcnt lgkmcnt(0)
  v_smfmac_f32_16x16x64_bf16 v[20:23], v[12:15], v[128:135], v74
  v_smfmac_f32_16x16x64_bf16 v[24:27], v[12:15], v[136:143], v74
  v_smfmac_f32_16x16x64_bf16 v[28:31], v[12:15], v[224:231], v74
  v_smfmac_f32_16x16x64_bf16 v[32:35], v[12:15], v[232:239], v74
  ds_read_b128 v[4:7], v76 offset:8704
  s_waitcnt lgkmcnt(0)
  v_smfmac_f32_16x16x64_bf16 v[20:23], v[4:7], v[144:151], v74
  v_smfmac_f32_16x16x64_bf16 v[24:27], v[4:7], v[152:159], v74
  ds_read_b128 v[60:63], v76 offset:61440
  ds_read_b128 v[64:67], v76 offset:62464
  s_waitcnt lgkmcnt(0)
  v_smfmac_f32_16x16x64_bf16 v[28:31], v[4:7], v[60:67], v74
  ds_read_b128 v[60:63], v76 offset:63488
  ds_read_b128 v[64:67], v76 offset:64512
  s_waitcnt lgkmcnt(0)
  v_smfmac_f32_16x16x64_bf16 v[32:35], v[4:7], v[60:67], v74
  ds_read_b128 v[8:11], v76 offset:9728
  s_waitcnt lgkmcnt(0)
  v_smfmac_f32_16x16x64_bf16 v[20:23], v[8:11], v[160:167], v74
  v_smfmac_f32_16x16x64_bf16 v[24:27], v[8:11], v[168:175], v74
  ds_read_b128 v[60:63], v75 offset:28672
  ds_read_b128 v[64:67], v75 offset:29696
  s_waitcnt lgkmcnt(0)
  v_smfmac_f32_16x16x64_bf16 v[28:31], v[8:11], v[60:67], v74
  ds_read_b128 v[60:63], v75 offset:30720
  ds_read_b128 v[64:67], v75 offset:31744
  s_waitcnt lgkmcnt(0)
  v_smfmac_f32_16x16x64_bf16 v[32:35], v[8:11], v[60:67], v74
  ds_read_b128 v[16:19], v76 offset:10752
  ds_read_b128 v[60:63], v75 offset:12288
  ds_read_b128 v[64:67], v75 offset:13312
  s_waitcnt lgkmcnt(0)
  v_smfmac_f32_16x16x64_bf16 v[20:23], v[16:19], v[60:67], v74
  ds_read_b128 v[60:63], v75 offset:14336
  ds_read_b128 v[64:67], v75 offset:15360
  s_waitcnt lgkmcnt(0)
  v_smfmac_f32_16x16x64_bf16 v[24:27], v[16:19], v[60:67], v74
  v_smfmac_f32_16x16x64_bf16 v[28:31], v[16:19], v[240:247], v74
  v_smfmac_f32_16x16x64_bf16 v[32:35], v[16:19], v[248:255], v74
  ds_read_b128 v[0:3], v76 offset:11776
  s_waitcnt lgkmcnt(0)
  v_smfmac_f32_16x16x64_bf16 v[20:23], v[0:3], v[176:183], v74
  v_smfmac_f32_16x16x64_bf16 v[24:27], v[0:3], v[184:191], v74
  v_smfmac_f32_16x16x64_bf16 v[28:31], v[0:3], a[0:7], v74
  v_smfmac_f32_16x16x64_bf16 v[32:35], v[0:3], a[8:15], v74
  ds_read_b128 v[12:15], v76 offset:12800
  s_waitcnt lgkmcnt(0)
  v_smfmac_f32_16x16x64_bf16 v[20:23], v[12:15], v[192:199], v74
  v_smfmac_f32_16x16x64_bf16 v[24:27], v[12:15], v[200:207], v74
  v_smfmac_f32_16x16x64_bf16 v[28:31], v[12:15], a[16:23], v74
  v_smfmac_f32_16x16x64_bf16 v[32:35], v[12:15], a[24:31], v74
  v_add_f32 v20, v20, v22
  v_add_f32 v21, v21, v23
  v_add_f32 v24, v24, v26
  v_cvt_pk_bf16_f32 v22, v20, v24
  ds_write_b32 v79, v22 offset:0
  v_add_f32 v25, v25, v27
  v_cvt_pk_bf16_f32 v23, v21, v25
  ds_write_b32 v79, v23 offset:576
  v_add_f32 v28, v28, v30
  v_add_f32 v29, v29, v31
  s_waitcnt lgkmcnt(0)
  s_nop 1
  s_branch Cs3_recok
Cs3_mx:
  s_waitcnt lgkmcnt(0)
  s_barrier
  buffer_load_dwordx4 v[52:55], v76, s[8:11], s59 offen offset:0 sc1
  buffer_load_dwordx4 v[0:3], v76, s[8:11], s58 offen offset:0 sc1
  ds_read_b128 v[20:23], v77 offset:0
  ds_read_b128 v[28:31], v77 offset:256
  buffer_load_dwordx4 v[56:59], v76, s[8:11], s59 offen offset:1024 sc1
  buffer_load_dwordx4 v[4:7], v76, s[8:11], s58 offen offset:1024 sc1
  ds_read_b128 v[24:27], v77 offset:128
  ds_read_b128 v[32:35], v77 offset:384
  s_waitcnt vmcnt(2) lgkmcnt(3)
  v_mfma_f32_16x16x32_bf16 v[8:11], v[0:3], v[20:23], 0
  s_waitcnt vmcnt(0) lgkmcnt(1)
  v_mfma_f32_16x16x32_bf16 v[8:11], v[4:7], v[24:27], v[8:11]
  v_mfma_f32_16x16x32_bf16 v[12:15], v[28:31], v[20:23], 0
  s_waitcnt lgkmcnt(0)
  v_mfma_f32_16x16x32_bf16 v[12:15], v[32:35], v[24:27], v[12:15]
  v_add_f32_dpp v8, v10, v8 quad_perm:[2,3,0,1] row_mask:0xf bank_mask:0xf
  v_add_f32_dpp v9, v11, v9 quad_perm:[2,3,0,1] row_mask:0xf bank_mask:0xf
  s_nop 0
  v_mov_b32_dpp v8, v8 quad_perm:[0,1,0,1] row_mask:0xf bank_mask:0xf
  v_mov_b32_dpp v9, v9 quad_perm:[0,1,0,1] row_mask:0xf bank_mask:0xf
  s_nop 1
  v_add_f32_dpp v12, v14, v12 quad_perm:[2,3,0,1] row_mask:0xf bank_mask:0xf
  v_add_f32_dpp v13, v15, v13 quad_perm:[2,3,0,1] row_mask:0xf bank_mask:0xf
  s_nop 0
  v_mov_b32_dpp v12, v12 quad_perm:[0,1,0,1] row_mask:0xf bank_mask:0xf
  v_mov_b32_dpp v13, v13 quad_perm:[0,1,0,1] row_mask:0xf bank_mask:0xf
  v_mul_f32 v12, s69, v12
  ds_write_b32 v78, v8 offset:8716
  v_mul_f32 v13, s69, v13
  ds_write_b32 v78, v9 offset:8780
  s_waitcnt lgkmcnt(0)
  s_barrier
  ds_read_b128 v[36:39], v78 offset:8704
  ds_read_b128 v[40:43], v78 offset:8768
  s_waitcnt lgkmcnt(0)
  s_barrier
  v_max_f32 v16, v36, v37
  v_max3_f32 v16, v16, v38, v39
  v_max3_f32 v16, v16, v40, v41
  v_max3_f32 v16, v16, v42, v43
  v_max3_f32 v16, v16, v12, v13
  v_mov_b32 v17, v16
  s_nop 1
  v_permlane16_swap_b32 v16, v17
  v_max_f32 v16, v16, v17
  v_mov_b32 v17, v16
  s_nop 1
  v_permlane32_swap_b32 v16, v17
  v_max_f32 v16, v16, v17
  v_sub_f32 v36, v36, v16
  v_sub_f32 v37, v37, v16
  v_sub_f32 v38, v38, v16
  v_sub_f32 v39, v39, v16
  v_sub_f32 v40, v40, v16
  v_sub_f32 v41, v41, v16
  v_sub_f32 v42, v42, v16
  v_sub_f32 v43, v43, v16
  v_sub_f32 v12, v12, v16
  v_sub_f32 v13, v13, v16
  v_exp_f32 v36, v36
  v_exp_f32 v37, v37
  v_exp_f32 v38, v38
  v_exp_f32 v39, v39
  v_exp_f32 v40, v40
  v_exp_f32 v41, v41
  v_exp_f32 v42, v42
  v_exp_f32 v43, v43
  v_exp_f32 v12, v12
  v_exp_f32 v13, v13
  v_cvt_pk_bf16_f32 v32, v36, v40
  v_cvt_pk_bf16_f32 v33, v37, v41
  v_cvt_pk_bf16_f32 v34, v38, v42
  v_cvt_pk_bf16_f32 v35, v39, v43
  v_cvt_pk_bf16_f32 v28, v12, v13
  v_cvt_pk_bf16_f32 v31, v12, v13
  v_mov_b32 v29, 0
  v_mov_b32 v30, 0
  v_mfma_f32_16x16x32_bf16 v[8:11], v[32:35], v[68:71], 0
  v_mfma_f32_16x16x32_bf16 v[0:3], v[32:35], v[52:55], 0
  v_mfma_f32_16x16x32_bf16 v[4:7], v[32:35], v[56:59], 0
  v_mfma_f32_16x16x16_bf16 v[8:11], v[28:29], v[68:69], v[8:11]
  v_mfma_f32_16x16x16_bf16 v[0:3], v[28:29], v[72:73], v[0:3]
  v_mfma_f32_16x16x16_bf16 v[4:7], v[30:31], v[72:73], v[4:7]
  ds_read_b128 v[52:55], v75 offset:30720
  v_rcp_f32 v10, v8
  v_rcp_f32 v11, v9
  v_mul_f32 v0, v10, v0
  v_mul_f32 v1, v11, v1
  v_max3_f32 v8, v8, v9, v10
  v_mul_f32 v4, v10, v4
  v_mul_f32 v5, v11, v5
  v_cvt_pk_bf16_f32 v2, v0, v4
  ds_write_b32 v79, v2 offset:8704
  v_cvt_pk_bf16_f32 v3, v1, v5
  ds_write_b32 v79, v3 offset:9280
  ds_read_b128 v[12:15], v78 offset:8896
  ds_read_b128 v[56:59], v75 offset:31744
  v_mov_b64 v[16:17], 0
  v_mov_b64 v[18:19], 0
  v_mov_b64 v[20:21], 0
  v_mov_b64 v[22:23], 0
  v_mov_b64 v[24:25], 0
  v_mov_b64 v[26:27], 0
  s_branch Cs3_mxok
Cs3_last:
  ds_read_b128 v[0:3], v76 offset:4608
  ds_read_b128 v[12:15], v76 offset:7680
  ds_read_b128 v[44:47], v76 offset:28672
  ds_read_b128 v[48:51], v76 offset:29696
  s_nop 5
  v_mov_b64 v[20:21], 0
  v_mov_b64 v[22:23], 0
  v_mov_b64 v[24:25], 0
  v_mov_b64 v[26:27], 0
  v_smfmac_f32_16x16x64_bf16 v[28:31], v[4:7], v[36:43], v74
  ds_read_b128 v[36:39], v76 offset:30720
  ds_read_b128 v[40:43], v76 offset:31744
  v_smfmac_f32_16x16x64_bf16 v[32:35], v[4:7], v[60:67], v74
  s_waitcnt lgkmcnt(5)
  v_smfmac_f32_16x16x64_bf16 v[20:23], v[0:3], a[32:39], v74
  ds_read_b128 v[60:63], v76 offset:61440
  ds_read_b128 v[64:67], v76 offset:62464
  v_smfmac_f32_16x16x64_bf16 v[24:27], v[0:3], a[40:47], v74
  s_waitcnt lgkmcnt(4)
  v_smfmac_f32_16x16x64_bf16 v[20:23], v[4:7], a[48:55], v74
  buffer_store_dwordx4 v[16:19], v76, s[8:11], s68 offen sc1
  v_smfmac_f32_16x16x64_bf16 v[24:27], v[4:7], a[56:63], v74
  v_smfmac_f32_16x16x64_bf16 v[28:31], v[0:3], v[44:51], v74
  s_waitcnt lgkmcnt(2)
  v_smfmac_f32_16x16x64_bf16 v[20:23], v[8:11], a[64:71], v74
  ds_read_b128 v[44:47], v76 offset:63488
  ds_read_b128 v[48:51], v76 offset:64512
  v_smfmac_f32_16x16x64_bf16 v[24:27], v[8:11], a[72:79], v74
  v_smfmac_f32_16x16x64_bf16 v[32:35], v[0:3], v[36:43], v74
  v_smfmac_f32_16x16x64_bf16 v[28:31], v[8:11], v[208:215], v74
  ds_read_b128 v[36:39], v75 offset:28672
  ds_read_b128 v[40:43], v75 offset:29696
  v_smfmac_f32_16x16x64_bf16 v[32:35], v[8:11], v[216:223], v74
  v_smfmac_f32_16x16x64_bf16 v[20:23], v[12:15], a[80:87], v74
  v_smfmac_f32_16x16x64_bf16 v[24:27], v[12:15], a[88:95], v74
  v_smfmac_f32_16x16x64_bf16 v[28:31], v[12:15], v[224:231], v74
  v_smfmac_f32_16x16x64_bf16 v[32:35], v[12:15], v[232:239], v74
  s_waitcnt vmcnt(1)
  s_barrier
Cs3_lastr:
  ds_read_b128 v[4:7], v76 offset:8704
  ds_read_b128 v[8:11], v76 offset:9728
  ds_read_b128 v[16:19], v76 offset:10752
  ds_read_b128 v[0:3], v76 offset:11776
  ds_read_b128 v[12:15], v76 offset:12800
  s_waitcnt lgkmcnt(1)
  v_max3_u32 v72, v0, v1, v2
  v_max3_u32 v72, v72, v3, v4
  v_max3_u32 v72, v72, v5, v6
  v_max3_u32 v72, v72, v7, v8
  v_max3_u32 v72, v72, v9, v10
  s_waitcnt lgkmcnt(0)
  v_max3_u32 v72, v72, v11, v12
  v_max3_u32 v72, v72, v13, v14
  v_max3_u32 v72, v72, v15, v16
  v_max3_u32 v72, v72, v17, v18
  v_max_u32 v72, v72, v19
  v_cmp_eq_u32 vcc, -1, v72
  s_cbranch_vccnz Cs3_lastp
Cs3_lastg:
  v_smfmac_f32_16x16x64_bf16 v[28:31], v[4:7], v[60:67], v74
  ds_read_b128 v[60:63], v75 offset:30720
  ds_read_b128 v[64:67], v75 offset:31744
  v_smfmac_f32_16x16x64_bf16 v[32:35], v[4:7], v[44:51], v74
  v_smfmac_f32_16x16x64_bf16 v[28:31], v[8:11], v[36:43], v74
  v_smfmac_f32_16x16x64_bf16 v[28:31], v[16:19], v[240:247], v74
  v_smfmac_f32_16x16x64_bf16 v[28:31], v[0:3], a[0:7], v74
  v_smfmac_f32_16x16x64_bf16 v[28:31], v[12:15], a[16:23], v74
  v_smfmac_f32_16x16x64_bf16 v[32:35], v[16:19], v[248:255], v74
  v_smfmac_f32_16x16x64_bf16 v[32:35], v[0:3], a[8:15], v74
  s_waitcnt lgkmcnt(0)
  v_smfmac_f32_16x16x64_bf16 v[32:35], v[12:15], a[24:31], v74
  v_smfmac_f32_16x16x64_bf16 v[32:35], v[8:11], v[60:67], v74
  v_smfmac_f32_16x16x64_bf16 v[20:23], v[4:7], a[96:103], v74
  v_smfmac_f32_16x16x64_bf16 v[20:23], v[8:11], a[112:119], v74
  v_add_f32 v28, v28, v30
  v_add_f32 v32, v32, v34
  v_cvt_pk_bf16_f32 v30, v28, v32
  v_smfmac_f32_16x16x64_bf16 v[20:23], v[16:19], a[128:135], v74
  ds_write_b32 v79, v30 offset:256
  v_add_f32 v29, v29, v31
  v_add_f32 v33, v33, v35
  v_cvt_pk_bf16_f32 v31, v29, v33
  v_smfmac_f32_16x16x64_bf16 v[20:23], v[0:3], a[144:151], v74
  ds_write_b32 v79, v31 offset:832
  v_smfmac_f32_16x16x64_bf16 v[20:23], v[12:15], a[160:167], v74
  v_smfmac_f32_16x16x64_bf16 v[24:27], v[4:7], a[104:111], v74
  v_smfmac_f32_16x16x64_bf16 v[24:27], v[8:11], a[120:127], v74
  v_smfmac_f32_16x16x64_bf16 v[24:27], v[16:19], a[136:143], v74
  s_waitcnt lgkmcnt(0)
  s_barrier
  ds_read_b64 v[52:53], v77 offset:392
  v_add_f32 v20, v20, v22
  v_smfmac_f32_16x16x64_bf16 v[24:27], v[0:3], a[152:159], v74
  v_add_f32 v21, v21, v23
  v_smfmac_f32_16x16x64_bf16 v[24:27], v[12:15], a[168:175], v74
  v_cvt_pk_bf16_f32 v54, v20, v21
  s_add_u32 s68, s68, 655360
  s_nop 3
  v_add_f32 v24, v24, v26
  v_add_f32 v25, v25, v27
  v_cvt_pk_bf16_f32 v55, v24, v25
  s_waitcnt lgkmcnt(0)
  buffer_store_dwordx4 v[52:55], v76, s[8:11], s68 offen sc1
  s_branch Cs3_done
Cs3_lastp:
  s_add_u32 s72, s72, 2
  s_cmp_ge_u32 s72, 131072
  s_cbranch_scc1 Cs3_lastg
  s_barrier
  buffer_load_dwordx4 v76, s[8:11], s85 offen offset:0 sc1 lds
  buffer_load_dwordx4 v76, s[8:11], s85 offen offset:1024 sc1 lds
  s_waitcnt vmcnt(0)
  s_barrier
  s_branch Cs3_lastr
Cs3_done:
  s_branch L_cexit
L_conf:
  s_nop 11
  s_waitcnt vmcnt(0) lgkmcnt(0)
  s_barrier
  s_cmp_eq_u32 s52, 0
  s_cbranch_scc0 L_cf2
  s_mov_b64 exec, 1
  s_lshl_b32 s57, s2, 2
  v_mov_b32 v1, 0
L_cf0:
  s_cmp_eq_u32 s54, -1
  s_cbranch_scc1 L_cf1
  s_mov_b32 s55, s54
  s_lshr_b64 s[54:55], s[54:55], s0
  s_ff0_i32_b32 s56, s54
  s_add_u32 s0, s0, s56
  s_and_b32 s0, s0, 31
  s_lshl_b32 s56, 1, s0
  v_mov_b32 v35, s56
  buffer_atomic_or v35, v1, s[12:15], s57 offen sc0
  s_waitcnt vmcnt(0)
  v_readfirstlane_b32 s54, v35
  s_nop 0
  s_bitcmp1_b32 s54, s0
  s_cbranch_scc1 L_cf0
  v_mov_b32 v35, s0
  s_branch L_cf3
L_cf1:
  v_mov_b32 v35, 1
  buffer_atomic_add v35, v1, s[12:15], 0 offen offset:40 sc0
  s_waitcnt vmcnt(0)
  v_add_u32 v35, 32, v35
L_cf3:
  ds_write_b32 v33, v35
  s_mov_b64 exec, -1
  s_waitcnt lgkmcnt(0)
L_cf2:
  s_barrier
  ds_read_b32 v32, v33
  s_waitcnt lgkmcnt(0)
  v_readfirstlane_b32 s0, v32
  v_mbcnt_lo_u32_b32 v0, -1, 0
  v_mbcnt_hi_u32_b32 v0, -1, v0
  s_mov_b32 s1, 1
  s_cmp_lt_u32 s0, 32
  s_cbranch_scc1 L_role
  s_sub_u32 s53, s0, 32
  s_mov_b32 s57, 0
L_sur:
  s_load_dwordx16 s[60:75], s[12:13], 0 glc
  s_add_u32 s57, s57, 1
  s_waitcnt lgkmcnt(0)
  s_mov_b32 s55, s70
  s_bcnt1_i32_b32 s56, s60
  s_add_u32 s55, s55, s56
  s_bcnt1_i32_b32 s56, s61
  s_add_u32 s55, s55, s56
  s_bcnt1_i32_b32 s56, s62
  s_add_u32 s55, s55, s56
  s_bcnt1_i32_b32 s56, s63
  s_add_u32 s55, s55, s56
  s_bcnt1_i32_b32 s56, s64
  s_add_u32 s55, s55, s56
  s_bcnt1_i32_b32 s56, s65
  s_add_u32 s55, s55, s56
  s_bcnt1_i32_b32 s56, s66
  s_add_u32 s55, s55, s56
  s_bcnt1_i32_b32 s56, s67
  s_add_u32 s55, s55, s56
  s_cmp_ge_u32 s57, 131072
  s_cbranch_scc1 L_end
  s_cmp_lt_u32 s55, 256
  s_cbranch_scc1 L_sur
  s_mov_b32 s2, 0
  s_mov_b32 s54, s60
  s_bcnt0_i32_b32 s56, s54
  s_cmp_lt_u32 s53, s56
  s_cbranch_scc1 L_sur2
  s_sub_u32 s53, s53, s56
  s_mov_b32 s2, 1
  s_mov_b32 s54, s61
  s_bcnt0_i32_b32 s56, s54
  s_cmp_lt_u32 s53, s56
  s_cbranch_scc1 L_sur2
  s_sub_u32 s53, s53, s56
  s_mov_b32 s2, 2
  s_mov_b32 s54, s62
  s_bcnt0_i32_b32 s56, s54
  s_cmp_lt_u32 s53, s56
  s_cbranch_scc1 L_sur2
  s_sub_u32 s53, s53, s56
  s_mov_b32 s2, 3
  s_mov_b32 s54, s63
  s_bcnt0_i32_b32 s56, s54
  s_cmp_lt_u32 s53, s56
  s_cbranch_scc1 L_sur2
  s_sub_u32 s53, s53, s56
  s_mov_b32 s2, 4
  s_mov_b32 s54, s64
  s_bcnt0_i32_b32 s56, s54
  s_cmp_lt_u32 s53, s56
  s_cbranch_scc1 L_sur2
  s_sub_u32 s53, s53, s56
  s_mov_b32 s2, 5
  s_mov_b32 s54, s65
  s_bcnt0_i32_b32 s56, s54
  s_cmp_lt_u32 s53, s56
  s_cbranch_scc1 L_sur2
  s_sub_u32 s53, s53, s56
  s_mov_b32 s2, 6
  s_mov_b32 s54, s66
  s_bcnt0_i32_b32 s56, s54
  s_cmp_lt_u32 s53, s56
  s_cbranch_scc1 L_sur2
  s_sub_u32 s53, s53, s56
  s_mov_b32 s2, 7
  s_mov_b32 s54, s67
  s_bcnt0_i32_b32 s56, s54
  s_cmp_lt_u32 s53, s56
  s_cbranch_scc1 L_sur2
  s_sub_u32 s53, s53, s56
  s_branch L_end
L_sur2:
  s_ff0_i32_b32 s0, s54
  s_bitset1_b32 s54, s0
  s_sub_u32 s53, s53, 1
  s_cbranch_scc0 L_sur2
  s_branch L_role
L_worker:
  s_lshl_b32 s54, s2, 2
  s_lshr_b32 s54, 1412567136, s54
  s_and_b32 s54, s54, 7
  s_lshl_b32 s54, s54, 5
  s_add_u32 s53, s53, s54
  s_getpc_b64 s[80:81]
L_pc_2:
  s_and_b32 s55, s0, 1
  s_lshl_b32 s55, s55, 2
  s_add_u32 s55, s55, s52
  s_lshl_b32 s55, s55, 13
  v_and_b32 v199, 63, v0
  v_lshl_add_u32 v199, v199, 7, s55
  s_sub_u32 s82, s80, (L_pc_2 - L_w0)
  s_subb_u32 s83, s81, 0
  v_min_u32 v198, (L_w4 - L_w0), v199
  global_load_dword v196, v198, s[82:83]
  v_min_u32 v199, (L_end - L_pc_2), v199
  global_load_dword v196, v199, s[80:81]
  v_and_b32 v200, 63, v0
  v_lshlrev_b32 v201, 4, v200
  v_lshrrev_b32 v211, 3, v200
  s_lshl_b32 s54, s52, 3
  v_add_u32 v211, s54, v211
  v_bfe_u32 v212, v211, 1, 3
  v_and_b32 v213, 7, v200
  v_xor_b32 v212, v212, v213
  v_mul_u32_u24 v211, 1152, v211
  v_lshl_add_u32 v202, v212, 4, v211
  s_mul_i32 s67, s52, 9216
  v_and_b32 v211, 31, v200
  v_lshrrev_b32 v212, 3, v211
  v_mul_u32_u24 v212, 9216, v212
  v_and_b32 v213, 7, v211
  v_lshl_add_u32 v212, v213, 7, v212
  v_bfe_u32 v213, v211, 1, 3
  v_lshrrev_b32 v214, 5, v200
  v_xor_b32 v213, v213, v214
  v_lshl_add_u32 v203, v213, 4, v212
  v_xor_b32 v204, 32, v203
  v_xor_b32 v205, 64, v203
  v_xor_b32 v206, 0x60, v203
  v_bfe_u32 v211, v200, 2, 2
  v_lshl_add_u32 v212, v214, 3, v211
  v_lshlrev_b32 v212, 8, v212
  v_xor_b32 v211, s52, v211
  v_lshl_add_u32 v212, v211, 6, v212
  v_bfe_u32 v213, v200, 4, 1
  v_and_b32 v211, 3, v200
  v_lshl_add_u32 v210, v213, 5, v212
  v_lshl_add_u32 v210, v211, 3, v210
  v_lshl_add_u32 v209, v213, 4, v212
  v_and_b32 v213, 1, v211
  v_lshl_add_u32 v209, v213, 3, v209
  v_lshrrev_b32 v213, 1, v211
  v_lshl_add_u32 v209, v213, 5, v209
  s_mov_b32 s65, 0
  s_mul_i32 s58, s53, 9363
  s_lshr_b32 s58, s58, 16
  s_mul_i32 s54, s58, 7
  s_sub_u32 s59, s53, s54
  s_mul_i32 s60, s59, 36864
  s_add_u32 m0, s67, 0
  s_nop 0
  buffer_load_dwordx4 v202, s[4:7], s60 offen offset:0 lds
  s_add_u32 m0, s67, 896
  s_nop 0
  buffer_load_dwordx4 v202, s[4:7], s60 offen offset:128 lds
  s_add_u32 m0, s67, 1792
  s_nop 0
  buffer_load_dwordx4 v202, s[4:7], s60 offen offset:256 lds
  s_add_u32 m0, s67, 2688
  s_nop 0
  buffer_load_dwordx4 v202, s[4:7], s60 offen offset:384 lds
  s_add_u32 m0, s67, 3584
  s_nop 0
  buffer_load_dwordx4 v202, s[4:7], s60 offen offset:512 lds
  s_add_u32 m0, s67, 4480
  s_nop 0
  buffer_load_dwordx4 v202, s[4:7], s60 offen offset:640 lds
  s_add_u32 m0, s67, 5376
  s_nop 0
  buffer_load_dwordx4 v202, s[4:7], s60 offen offset:768 lds
  s_add_u32 m0, s67, 6272
  s_nop 0
  buffer_load_dwordx4 v202, s[4:7], s60 offen offset:896 lds
  s_add_u32 m0, s67, 7168
  s_nop 0
  buffer_load_dwordx4 v202, s[4:7], s60 offen offset:1024 lds
  v_lshrrev_b32 v211, 4, v200
  v_lshlrev_b32 v212, 2, v211
  v_and_b32 v213, 15, v200
  v_xor_b32 v212, v212, v213
  v_lshlrev_b32 v212, 4, v212
  v_lshl_add_u32 v207, v211, 13, v212
  s_lshl_b32 s62, s58, 8
  s_lshl_b32 s54, s52, 15
  s_add_u32 s62, s62, s54
  s_lshl_b32 s61, s52, 10
  s_add_u32 s61, s61, 36864
  s_add_u32 m0, s61, 0
  s_add_u32 s54, s62, 0
  buffer_load_dwordx4 v207, s[20:23], s54 offen lds
  s_add_u32 m0, s61, 4096
  s_add_u32 s54, s62, 131072
  buffer_load_dwordx4 v207, s[20:23], s54 offen lds
  s_add_u32 m0, s61, 8192
  s_add_u32 s54, s62, 262144
  buffer_load_dwordx4 v207, s[20:23], s54 offen lds
  s_add_u32 m0, s61, 12288
  s_add_u32 s54, s62, 393216
  buffer_load_dwordx4 v207, s[20:23], s54 offen lds
  s_add_u32 m0, s61, 16384
  s_add_u32 s54, s62, 0
  buffer_load_dwordx4 v207, s[24:27], s54 offen lds
  s_add_u32 m0, s61, 20480
  s_add_u32 s54, s62, 131072
  buffer_load_dwordx4 v207, s[24:27], s54 offen lds
  s_add_u32 m0, s61, 24576
  s_add_u32 s54, s62, 262144
  buffer_load_dwordx4 v207, s[24:27], s54 offen lds
  s_add_u32 m0, s61, 28672
  s_add_u32 s54, s62, 393216
  buffer_load_dwordx4 v207, s[24:27], s54 offen lds
  s_add_u32 m0, s61, 32768
  s_add_u32 s54, s62, 524288
  buffer_load_dwordx4 v207, s[20:23], s54 offen lds
  s_add_u32 m0, s61, 36864
  s_add_u32 s54, s62, 655360
  buffer_load_dwordx4 v207, s[20:23], s54 offen lds
  s_add_u32 m0, s61, 40960
  s_add_u32 s54, s62, 786432
  buffer_load_dwordx4 v207, s[20:23], s54 offen lds
  s_add_u32 m0, s61, 45056
  s_add_u32 s54, s62, 917504
  buffer_load_dwordx4 v207, s[20:23], s54 offen lds
  s_add_u32 m0, s61, 49152
  s_add_u32 s54, s62, 524288
  buffer_load_dwordx4 v207, s[24:27], s54 offen lds
  s_add_u32 m0, s61, 53248
  s_add_u32 s54, s62, 655360
  buffer_load_dwordx4 v207, s[24:27], s54 offen lds
  s_add_u32 m0, s61, 57344
  s_add_u32 s54, s62, 786432
  buffer_load_dwordx4 v207, s[24:27], s54 offen lds
  s_add_u32 m0, s61, 61440
  s_add_u32 s54, s62, 917504
  buffer_load_dwordx4 v207, s[24:27], s54 offen lds
  s_add_u32 m0, s61, 65536
  s_add_u32 s54, s62, 1048576
  buffer_load_dwordx4 v207, s[20:23], s54 offen lds
  s_add_u32 m0, s61, 69632
  s_add_u32 s54, s62, 1179648
  buffer_load_dwordx4 v207, s[20:23], s54 offen lds
  s_add_u32 m0, s61, 73728
  s_add_u32 s54, s62, 1310720
  buffer_load_dwordx4 v207, s[20:23], s54 offen lds
  s_add_u32 m0, s61, 77824
  s_add_u32 s54, s62, 1441792
  buffer_load_dwordx4 v207, s[20:23], s54 offen lds
  s_add_u32 m0, s61, 81920
  s_add_u32 s54, s62, 1048576
  buffer_load_dwordx4 v207, s[24:27], s54 offen lds
  s_add_u32 m0, s61, 86016
  s_add_u32 s54, s62, 1179648
  buffer_load_dwordx4 v207, s[24:27], s54 offen lds
  s_add_u32 m0, s61, 90112
  s_add_u32 s54, s62, 1310720
  buffer_load_dwordx4 v207, s[24:27], s54 offen lds
  s_add_u32 m0, s61, 94208
  s_add_u32 s54, s62, 1441792
  buffer_load_dwordx4 v207, s[24:27], s54 offen lds
  v_bfe_u32 v211, v200, 3, 2
  v_lshlrev_b32 v216, 11, v211
  v_bfe_u32 v211, v200, 1, 2
  v_lshl_add_u32 v216, v211, 6, v216
  v_lshrrev_b32 v212, 5, v200
  v_lshl_add_u32 v216, v212, 5, v216
  v_and_b32 v211, 1, v200
  v_lshl_add_u32 v216, v211, 4, v216
  v_bfe_u32 v211, v200, 4, 1
  v_lshlrev_b32 v217, 10, v211
  v_lshl_add_u32 v217, v212, 9, v217
  v_and_b32 v211, 15, v200
  v_lshl_add_u32 v217, v211, 4, v217
  s_lshl_b32 s54, s52, 11
  s_add_u32 s54, s54, 8192
  v_add_u32 v217, s54, v217
  s_waitcnt vmcnt(20) lgkmcnt(0)
  s_barrier
  s_add_u32 m0, s61, 98304
  s_add_u32 s54, s62, 1572864
  buffer_load_dwordx4 v207, s[20:23], s54 offen lds
  s_add_u32 m0, s61, 102400
  s_add_u32 s54, s62, 1703936
  buffer_load_dwordx4 v207, s[20:23], s54 offen lds
  s_add_u32 m0, s61, 106496
  s_add_u32 s54, s62, 1835008
  buffer_load_dwordx4 v207, s[20:23], s54 offen lds
  s_add_u32 m0, s61, 110592
  s_add_u32 s54, s62, 1966080
  buffer_load_dwordx4 v207, s[20:23], s54 offen lds
  v_add_u32 v215, 36864, v209
  ds_read_b64_tr_b16 a[0:1], v215 offset:0
  ds_read_b64_tr_b16 a[2:3], v215 offset:1024
  ds_read_b64_tr_b16 a[4:5], v215 offset:4096
  ds_read_b64_tr_b16 a[6:7], v215 offset:5120
  ds_read_b64_tr_b16 a[8:9], v215 offset:8192
  ds_read_b64_tr_b16 a[10:11], v215 offset:9216
  ds_read_b64_tr_b16 a[12:13], v215 offset:12288
  ds_read_b64_tr_b16 a[14:15], v215 offset:13312
  s_waitcnt vmcnt(20) lgkmcnt(0)
  s_barrier
  s_add_u32 m0, s61, 0
  s_add_u32 s54, s62, 1572864
  buffer_load_dwordx4 v207, s[24:27], s54 offen lds
  s_add_u32 m0, s61, 4096
  s_add_u32 s54, s62, 1703936
  buffer_load_dwordx4 v207, s[24:27], s54 offen lds
  s_add_u32 m0, s61, 8192
  s_add_u32 s54, s62, 1835008
  buffer_load_dwordx4 v207, s[24:27], s54 offen lds
  s_add_u32 m0, s61, 12288
  s_add_u32 s54, s62, 1966080
  buffer_load_dwordx4 v207, s[24:27], s54 offen lds
  v_add_u32 v215, 53248, v210
  ds_read_b64_tr_b16 a[144:145], v215 offset:0
  ds_read_b64_tr_b16 a[146:147], v215 offset:1024
  ds_read_b64_tr_b16 a[148:149], v215 offset:4096
  ds_read_b64_tr_b16 a[150:151], v215 offset:5120
  ds_read_b64_tr_b16 a[152:153], v215 offset:8192
  ds_read_b64_tr_b16 a[154:155], v215 offset:9216
  ds_read_b64_tr_b16 a[156:157], v215 offset:12288
  ds_read_b64_tr_b16 a[158:159], v215 offset:13312
  s_waitcnt vmcnt(20) lgkmcnt(0)
  s_barrier
  s_add_u32 m0, s61, 16384
  s_add_u32 s54, s62, 2097152
  buffer_load_dwordx4 v207, s[20:23], s54 offen lds
  s_add_u32 m0, s61, 20480
  s_add_u32 s54, s62, 2228224
  buffer_load_dwordx4 v207, s[20:23], s54 offen lds
  s_add_u32 m0, s61, 24576
  s_add_u32 s54, s62, 2359296
  buffer_load_dwordx4 v207, s[20:23], s54 offen lds
  s_add_u32 m0, s61, 28672
  s_add_u32 s54, s62, 2490368
  buffer_load_dwordx4 v207, s[20:23], s54 offen lds
  v_add_u32 v215, 69632, v209
  ds_read_b64_tr_b16 a[16:17], v215 offset:0
  ds_read_b64_tr_b16 a[18:19], v215 offset:1024
  ds_read_b64_tr_b16 a[20:21], v215 offset:4096
  ds_read_b64_tr_b16 a[22:23], v215 offset:5120
  ds_read_b64_tr_b16 a[24:25], v215 offset:8192
  ds_read_b64_tr_b16 a[26:27], v215 offset:9216
  ds_read_b64_tr_b16 a[28:29], v215 offset:12288
  ds_read_b64_tr_b16 a[30:31], v215 offset:13312
  s_waitcnt vmcnt(20) lgkmcnt(0)
  s_barrier
  s_add_u32 m0, s61, 32768
  s_add_u32 s54, s62, 2097152
  buffer_load_dwordx4 v207, s[24:27], s54 offen lds
  s_add_u32 m0, s61, 36864
  s_add_u32 s54, s62, 2228224
  buffer_load_dwordx4 v207, s[24:27], s54 offen lds
  s_add_u32 m0, s61, 40960
  s_add_u32 s54, s62, 2359296
  buffer_load_dwordx4 v207, s[24:27], s54 offen lds
  s_add_u32 m0, s61, 45056
  s_add_u32 s54, s62, 2490368
  buffer_load_dwordx4 v207, s[24:27], s54 offen lds
  v_add_u32 v215, 86016, v210
  ds_read_b64_tr_b16 a[160:161], v215 offset:0
  ds_read_b64_tr_b16 a[162:163], v215 offset:1024
  ds_read_b64_tr_b16 a[164:165], v215 offset:4096
  ds_read_b64_tr_b16 a[166:167], v215 offset:5120
  ds_read_b64_tr_b16 a[168:169], v215 offset:8192
  ds_read_b64_tr_b16 a[170:171], v215 offset:9216
  ds_read_b64_tr_b16 a[172:173], v215 offset:12288
  ds_read_b64_tr_b16 a[174:175], v215 offset:13312
  s_waitcnt vmcnt(20) lgkmcnt(0)
  s_barrier
  s_add_u32 m0, s61, 49152
  s_add_u32 s54, s62, 2621440
  buffer_load_dwordx4 v207, s[20:23], s54 offen lds
  s_add_u32 m0, s61, 53248
  s_add_u32 s54, s62, 2752512
  buffer_load_dwordx4 v207, s[20:23], s54 offen lds
  s_add_u32 m0, s61, 57344
  s_add_u32 s54, s62, 2883584
  buffer_load_dwordx4 v207, s[20:23], s54 offen lds
  s_add_u32 m0, s61, 61440
  s_add_u32 s54, s62, 3014656
  buffer_load_dwordx4 v207, s[20:23], s54 offen lds
  v_add_u32 v215, 102400, v209
  ds_read_b64_tr_b16 a[32:33], v215 offset:0
  ds_read_b64_tr_b16 a[34:35], v215 offset:1024
  ds_read_b64_tr_b16 a[36:37], v215 offset:4096
  ds_read_b64_tr_b16 a[38:39], v215 offset:5120
  ds_read_b64_tr_b16 a[40:41], v215 offset:8192
  ds_read_b64_tr_b16 a[42:43], v215 offset:9216
  ds_read_b64_tr_b16 a[44:45], v215 offset:12288
  ds_read_b64_tr_b16 a[46:47], v215 offset:13312
  s_waitcnt vmcnt(20) lgkmcnt(0)
  s_barrier
  s_add_u32 m0, s61, 65536
  s_add_u32 s54, s62, 2621440
  buffer_load_dwordx4 v207, s[24:27], s54 offen lds
  s_add_u32 m0, s61, 69632
  s_add_u32 s54, s62, 2752512
  buffer_load_dwordx4 v207, s[24:27], s54 offen lds
  s_add_u32 m0, s61, 73728
  s_add_u32 s54, s62, 2883584
  buffer_load_dwordx4 v207, s[24:27], s54 offen lds
  s_add_u32 m0, s61, 77824
  s_add_u32 s54, s62, 3014656
  buffer_load_dwordx4 v207, s[24:27], s54 offen lds
  v_add_u32 v215, 118784, v210
  ds_read_b64_tr_b16 a[176:177], v215 offset:0
  ds_read_b64_tr_b16 a[178:179], v215 offset:1024
  ds_read_b64_tr_b16 a[180:181], v215 offset:4096
  ds_read_b64_tr_b16 a[182:183], v215 offset:5120
  ds_read_b64_tr_b16 a[184:185], v215 offset:8192
  ds_read_b64_tr_b16 a[186:187], v215 offset:9216
  ds_read_b64_tr_b16 a[188:189], v215 offset:12288
  ds_read_b64_tr_b16 a[190:191], v215 offset:13312
  s_waitcnt vmcnt(20) lgkmcnt(0)
  s_barrier
  s_add_u32 m0, s61, 81920
  s_add_u32 s54, s62, 3145728
  buffer_load_dwordx4 v207, s[20:23], s54 offen lds
  s_add_u32 m0, s61, 86016
  s_add_u32 s54, s62, 3276800
  buffer_load_dwordx4 v207, s[20:23], s54 offen lds
  s_add_u32 m0, s61, 90112
  s_add_u32 s54, s62, 3407872
  buffer_load_dwordx4 v207, s[20:23], s54 offen lds
  s_add_u32 m0, s61, 94208
  s_add_u32 s54, s62, 3538944
  buffer_load_dwordx4 v207, s[20:23], s54 offen lds
  v_add_u32 v215, 135168, v209
  ds_read_b64_tr_b16 a[48:49], v215 offset:0
  ds_read_b64_tr_b16 a[50:51], v215 offset:1024
  ds_read_b64_tr_b16 a[52:53], v215 offset:4096
  ds_read_b64_tr_b16 a[54:55], v215 offset:5120
  ds_read_b64_tr_b16 a[56:57], v215 offset:8192
  ds_read_b64_tr_b16 a[58:59], v215 offset:9216
  ds_read_b64_tr_b16 a[60:61], v215 offset:12288
  ds_read_b64_tr_b16 a[62:63], v215 offset:13312
  s_waitcnt vmcnt(20) lgkmcnt(0)
  s_barrier
  s_add_u32 m0, s61, 98304
  s_add_u32 s54, s62, 3145728
  buffer_load_dwordx4 v207, s[24:27], s54 offen lds
  s_add_u32 m0, s61, 102400
  s_add_u32 s54, s62, 3276800
  buffer_load_dwordx4 v207, s[24:27], s54 offen lds
  s_add_u32 m0, s61, 106496
  s_add_u32 s54, s62, 3407872
  buffer_load_dwordx4 v207, s[24:27], s54 offen lds
  s_add_u32 m0, s61, 110592
  s_add_u32 s54, s62, 3538944
  buffer_load_dwordx4 v207, s[24:27], s54 offen lds
  v_add_u32 v215, 36864, v210
  ds_read_b64_tr_b16 a[192:193], v215 offset:0
  ds_read_b64_tr_b16 a[194:195], v215 offset:1024
  ds_read_b64_tr_b16 a[196:197], v215 offset:4096
  ds_read_b64_tr_b16 a[198:199], v215 offset:5120
  ds_read_b64_tr_b16 a[200:201], v215 offset:8192
  ds_read_b64_tr_b16 a[202:203], v215 offset:9216
  ds_read_b64_tr_b16 a[204:205], v215 offset:12288
  ds_read_b64_tr_b16 a[206:207], v215 offset:13312
  s_waitcnt vmcnt(20) lgkmcnt(0)
  s_barrier
  s_add_u32 m0, s61, 0
  s_add_u32 s54, s62, 3670016
  buffer_load_dwordx4 v207, s[20:23], s54 offen lds
  s_add_u32 m0, s61, 4096
  s_add_u32 s54, s62, 3801088
  buffer_load_dwordx4 v207, s[20:23], s54 offen lds
  s_add_u32 m0, s61, 8192
  s_add_u32 s54, s62, 3932160
  buffer_load_dwordx4 v207, s[20:23], s54 offen lds
  s_add_u32 m0, s61, 12288
  s_add_u32 s54, s62, 4063232
  buffer_load_dwordx4 v207, s[20:23], s54 offen lds
  v_add_u32 v215, 53248, v209
  ds_read_b64_tr_b16 a[64:65], v215 offset:0
  ds_read_b64_tr_b16 a[66:67], v215 offset:1024
  ds_read_b64_tr_b16 a[68:69], v215 offset:4096
  ds_read_b64_tr_b16 a[70:71], v215 offset:5120
  ds_read_b64_tr_b16 a[72:73], v215 offset:8192
  ds_read_b64_tr_b16 a[74:75], v215 offset:9216
  ds_read_b64_tr_b16 a[76:77], v215 offset:12288
  ds_read_b64_tr_b16 a[78:79], v215 offset:13312
  s_waitcnt vmcnt(20) lgkmcnt(0)
  s_barrier
  s_add_u32 m0, s61, 16384
  s_add_u32 s54, s62, 3670016
  buffer_load_dwordx4 v207, s[24:27], s54 offen lds
  s_add_u32 m0, s61, 20480
  s_add_u32 s54, s62, 3801088
  buffer_load_dwordx4 v207, s[24:27], s54 offen lds
  s_add_u32 m0, s61, 24576
  s_add_u32 s54, s62, 3932160
  buffer_load_dwordx4 v207, s[24:27], s54 offen lds
  s_add_u32 m0, s61, 28672
  s_add_u32 s54, s62, 4063232
  buffer_load_dwordx4 v207, s[24:27], s54 offen lds
  v_add_u32 v215, 69632, v210
  ds_read_b64_tr_b16 a[208:209], v215 offset:0
  ds_read_b64_tr_b16 a[210:211], v215 offset:1024
  ds_read_b64_tr_b16 a[212:213], v215 offset:4096
  ds_read_b64_tr_b16 a[214:215], v215 offset:5120
  ds_read_b64_tr_b16 a[216:217], v215 offset:8192
  ds_read_b64_tr_b16 a[218:219], v215 offset:9216
  ds_read_b64_tr_b16 a[220:221], v215 offset:12288
  ds_read_b64_tr_b16 a[222:223], v215 offset:13312
  s_waitcnt vmcnt(20) lgkmcnt(0)
  s_barrier
  s_add_u32 m0, s61, 32768
  s_add_u32 s54, s62, 4194304
  buffer_load_dwordx4 v207, s[20:23], s54 offen lds
  s_add_u32 m0, s61, 36864
  s_add_u32 s54, s62, 4325376
  buffer_load_dwordx4 v207, s[20:23], s54 offen lds
  s_add_u32 m0, s61, 40960
  s_add_u32 s54, s62, 4456448
  buffer_load_dwordx4 v207, s[20:23], s54 offen lds
  s_add_u32 m0, s61, 45056
  s_add_u32 s54, s62, 4587520
  buffer_load_dwordx4 v207, s[20:23], s54 offen lds
  v_add_u32 v215, 86016, v209
  ds_read_b64_tr_b16 a[80:81], v215 offset:0
  ds_read_b64_tr_b16 a[82:83], v215 offset:1024
  ds_read_b64_tr_b16 a[84:85], v215 offset:4096
  ds_read_b64_tr_b16 a[86:87], v215 offset:5120
  ds_read_b64_tr_b16 a[88:89], v215 offset:8192
  ds_read_b64_tr_b16 a[90:91], v215 offset:9216
  ds_read_b64_tr_b16 a[92:93], v215 offset:12288
  ds_read_b64_tr_b16 a[94:95], v215 offset:13312
  s_waitcnt vmcnt(20) lgkmcnt(0)
  s_barrier
  s_add_u32 m0, s61, 49152
  s_add_u32 s54, s62, 4194304
  buffer_load_dwordx4 v207, s[24:27], s54 offen lds
  s_add_u32 m0, s61, 53248
  s_add_u32 s54, s62, 4325376
  buffer_load_dwordx4 v207, s[24:27], s54 offen lds
  s_add_u32 m0, s61, 57344
  s_add_u32 s54, s62, 4456448
  buffer_load_dwordx4 v207, s[24:27], s54 offen lds
  s_add_u32 m0, s61, 61440
  s_add_u32 s54, s62, 4587520
  buffer_load_dwordx4 v207, s[24:27], s54 offen lds
  s_mul_i32 s54, s53, 21120
  s_lshl_b32 s55, s52, 13
  s_add_u32 s54, s54, s55
  s_cmp_eq_u32 s52, 3
  s_cselect_b32 s54, 0x10000000, s54
  v_lshlrev_b32 v211, 3, v201
  buffer_load_dword v196, v211, s[28:31], s54 offen
  v_add_u32 v215, 102400, v210
  ds_read_b64_tr_b16 a[224:225], v215 offset:0
  ds_read_b64_tr_b16 a[226:227], v215 offset:1024
  ds_read_b64_tr_b16 a[228:229], v215 offset:4096
  ds_read_b64_tr_b16 a[230:231], v215 offset:5120
  ds_read_b64_tr_b16 a[232:233], v215 offset:8192
  ds_read_b64_tr_b16 a[234:235], v215 offset:9216
  ds_read_b64_tr_b16 a[236:237], v215 offset:12288
  ds_read_b64_tr_b16 a[238:239], v215 offset:13312
  s_waitcnt vmcnt(21) lgkmcnt(0)
  s_barrier
  s_lshl_b32 s54, s53, 13
  s_lshr_b32 s55, s53, 6
  s_or_b32 s55, s55, s52
  s_cmp_eq_u32 s55, 0
  s_cselect_b32 s54, s54, 0x10000000
  v_lshlrev_b32 v211, 3, v201
  s_add_u32 s54, s54, 3145728
  buffer_load_dword v196, v211, s[16:19], s54 offen
  v_add_u32 v215, 118784, v209
  ds_read_b64_tr_b16 a[96:97], v215 offset:0
  ds_read_b64_tr_b16 a[98:99], v215 offset:1024
  ds_read_b64_tr_b16 a[100:101], v215 offset:4096
  ds_read_b64_tr_b16 a[102:103], v215 offset:5120
  ds_read_b64_tr_b16 a[104:105], v215 offset:8192
  ds_read_b64_tr_b16 a[106:107], v215 offset:9216
  ds_read_b64_tr_b16 a[108:109], v215 offset:12288
  ds_read_b64_tr_b16 a[110:111], v215 offset:13312
  s_waitcnt vmcnt(18) lgkmcnt(0)
  s_barrier
  s_lshl_b32 s55, s2, 2
  s_or_b32 s56, s52, s1
  s_cmp_eq_u32 s56, 0
  s_cselect_b32 s55, s55, 0x1000
  s_lshl_b32 s56, 1, s0
  v_mov_b32 v197, s56
  s_mov_b64 exec, 1
  buffer_atomic_or v197, off, s[12:15], s55 sc0
  s_mov_b64 exec, -1
  v_add_u32 v215, 135168, v210
  ds_read_b64_tr_b16 a[240:241], v215 offset:0
  ds_read_b64_tr_b16 a[242:243], v215 offset:1024
  ds_read_b64_tr_b16 a[244:245], v215 offset:4096
  ds_read_b64_tr_b16 a[246:247], v215 offset:5120
  ds_read_b64_tr_b16 a[248:249], v215 offset:8192
  ds_read_b64_tr_b16 a[250:251], v215 offset:9216
  ds_read_b64_tr_b16 a[252:253], v215 offset:12288
  ds_read_b64_tr_b16 a[254:255], v215 offset:13312
  s_waitcnt vmcnt(15) lgkmcnt(0)
  s_barrier
  v_add_u32 v215, 36864, v209
  ds_read_b64_tr_b16 a[112:113], v215 offset:0
  ds_read_b64_tr_b16 a[114:115], v215 offset:1024
  ds_read_b64_tr_b16 a[116:117], v215 offset:4096
  ds_read_b64_tr_b16 a[118:119], v215 offset:5120
  ds_read_b64_tr_b16 a[120:121], v215 offset:8192
  ds_read_b64_tr_b16 a[122:123], v215 offset:9216
  ds_read_b64_tr_b16 a[124:125], v215 offset:12288
  ds_read_b64_tr_b16 a[126:127], v215 offset:13312
  s_waitcnt vmcnt(11) lgkmcnt(0)
  s_barrier
  v_add_u32 v215, 53248, v210
  ds_read_b64_tr_b16 v[224:225], v215 offset:0
  ds_read_b64_tr_b16 v[226:227], v215 offset:1024
  ds_read_b64_tr_b16 v[228:229], v215 offset:4096
  ds_read_b64_tr_b16 v[230:231], v215 offset:5120
  ds_read_b64_tr_b16 v[232:233], v215 offset:8192
  ds_read_b64_tr_b16 v[234:235], v215 offset:9216
  ds_read_b64_tr_b16 v[236:237], v215 offset:12288
  ds_read_b64_tr_b16 v[238:239], v215 offset:13312
  s_waitcnt vmcnt(7) lgkmcnt(0)
  s_barrier
  v_add_u32 v215, 69632, v209
  ds_read_b64_tr_b16 a[128:129], v215 offset:0
  ds_read_b64_tr_b16 a[130:131], v215 offset:1024
  ds_read_b64_tr_b16 a[132:133], v215 offset:4096
  ds_read_b64_tr_b16 a[134:135], v215 offset:5120
  ds_read_b64_tr_b16 a[136:137], v215 offset:8192
  ds_read_b64_tr_b16 a[138:139], v215 offset:9216
  ds_read_b64_tr_b16 a[140:141], v215 offset:12288
  ds_read_b64_tr_b16 a[142:143], v215 offset:13312
  s_waitcnt vmcnt(3) lgkmcnt(0)
  s_barrier
  v_add_u32 v215, 86016, v210
  ds_read_b64_tr_b16 v[240:241], v215 offset:0
  ds_read_b64_tr_b16 v[242:243], v215 offset:1024
  ds_read_b64_tr_b16 v[244:245], v215 offset:4096
  ds_read_b64_tr_b16 v[246:247], v215 offset:5120
  ds_read_b64_tr_b16 v[248:249], v215 offset:8192
  ds_read_b64_tr_b16 v[250:251], v215 offset:9216
  ds_read_b64_tr_b16 v[252:253], v215 offset:12288
  ds_read_b64_tr_b16 v[254:255], v215 offset:13312
  s_waitcnt lgkmcnt(0)
  s_barrier
  s_mov_b32 s68, 1040356334
  s_lshl_b32 s69, s52, 9
  s_lshl_b32 s70, s58, 2
  s_add_u32 s70, s70, 128
  s_mul_i32 s66, s58, -12288
  s_lshl_b32 s54, s52, 10
  s_add_u32 s66, s66, s54
  s_add_u32 s66, s66, 524288
  v_mov_b32 v64, -1
  v_mov_b32 v65, -1
  v_mov_b32 v66, -1
  v_mov_b32 v67, -1
  s_add_u32 s60, s60, 258048
  ds_read_b128 v[32:35], v203 offset:0
  ds_read_b128 v[36:39], v204 offset:0
  ds_read_b128 v[40:43], v205 offset:0
  s_waitcnt lgkmcnt(2)
  v_mfma_f32_32x32x16_bf16 v[0:15], a[0:3], v[32:35], 0
  ds_read_b128 v[44:47], v206 offset:0
  s_add_u32 m0, s67, 36864
  s_nop 0
  buffer_load_dwordx4 v202, s[4:7], s60 offen offset:0 lds
  v_mfma_f32_32x32x16_bf16 v[16:31], v[32:35], a[144:147], 0
  s_waitcnt lgkmcnt(2)
  v_mfma_f32_32x32x16_bf16 v[0:15], a[4:7], v[36:39], v[0:15]
  ds_read_b128 v[32:35], v203 offset:1024
  s_add_u32 m0, s67, 37760
  s_nop 0
  buffer_load_dwordx4 v202, s[4:7], s60 offen offset:128 lds
  v_mfma_f32_32x32x16_bf16 v[16:31], v[36:39], a[148:151], v[16:31]
  s_waitcnt lgkmcnt(2)
  v_mfma_f32_32x32x16_bf16 v[0:15], a[8:11], v[40:43], v[0:15]
  ds_read_b128 v[36:39], v204 offset:1024
  s_add_u32 m0, s67, 38656
  s_nop 0
  buffer_load_dwordx4 v202, s[4:7], s60 offen offset:256 lds
  v_mfma_f32_32x32x16_bf16 v[16:31], v[40:43], a[152:155], v[16:31]
  s_waitcnt lgkmcnt(2)
  v_mfma_f32_32x32x16_bf16 v[0:15], a[12:15], v[44:47], v[0:15]
  ds_read_b128 v[40:43], v205 offset:1024
  s_add_u32 m0, s67, 39552
  s_nop 0
  buffer_load_dwordx4 v202, s[4:7], s60 offen offset:384 lds
  v_mfma_f32_32x32x16_bf16 v[16:31], v[44:47], a[156:159], v[16:31]
  s_waitcnt lgkmcnt(2)
  v_mfma_f32_32x32x16_bf16 v[0:15], a[16:19], v[32:35], v[0:15]
  ds_read_b128 v[44:47], v206 offset:1024
  s_add_u32 m0, s67, 40448
  s_nop 0
  buffer_load_dwordx4 v202, s[4:7], s60 offen offset:512 lds
  v_mfma_f32_32x32x16_bf16 v[16:31], v[32:35], a[160:163], v[16:31]
  s_waitcnt lgkmcnt(2)
  v_mfma_f32_32x32x16_bf16 v[0:15], a[20:23], v[36:39], v[0:15]
  ds_read_b128 v[32:35], v203 offset:2048
  s_add_u32 m0, s67, 41344
  s_nop 0
  buffer_load_dwordx4 v202, s[4:7], s60 offen offset:640 lds
  v_mfma_f32_32x32x16_bf16 v[16:31], v[36:39], a[164:167], v[16:31]
  s_waitcnt lgkmcnt(2)
  v_mfma_f32_32x32x16_bf16 v[0:15], a[24:27], v[40:43], v[0:15]
  ds_read_b128 v[36:39], v204 offset:2048
  s_add_u32 m0, s67, 42240
  s_nop 0
  buffer_load_dwordx4 v202, s[4:7], s60 offen offset:768 lds
  v_mfma_f32_32x32x16_bf16 v[16:31], v[40:43], a[168:171], v[16:31]
  s_waitcnt lgkmcnt(2)
  v_mfma_f32_32x32x16_bf16 v[0:15], a[28:31], v[44:47], v[0:15]
  ds_read_b128 v[40:43], v205 offset:2048
  s_add_u32 m0, s67, 43136
  s_nop 0
  buffer_load_dwordx4 v202, s[4:7], s60 offen offset:896 lds
  v_mfma_f32_32x32x16_bf16 v[16:31], v[44:47], a[172:175], v[16:31]
  s_waitcnt lgkmcnt(2)
  v_mfma_f32_32x32x16_bf16 v[0:15], a[32:35], v[32:35], v[0:15]
  ds_read_b128 v[44:47], v206 offset:2048
  s_add_u32 m0, s67, 44032
  s_nop 0
  buffer_load_dwordx4 v202, s[4:7], s60 offen offset:1024 lds
  v_mfma_f32_32x32x16_bf16 v[16:31], v[32:35], a[176:179], v[16:31]
  s_waitcnt lgkmcnt(2)
  v_mfma_f32_32x32x16_bf16 v[0:15], a[36:39], v[36:39], v[0:15]
  ds_read_b128 v[32:35], v203 offset:3072
  v_mfma_f32_32x32x16_bf16 v[16:31], v[36:39], a[180:183], v[16:31]
  s_waitcnt lgkmcnt(2)
  v_mfma_f32_32x32x16_bf16 v[0:15], a[40:43], v[40:43], v[0:15]
  ds_read_b128 v[36:39], v204 offset:3072
  v_mfma_f32_32x32x16_bf16 v[16:31], v[40:43], a[184:187], v[16:31]
  s_waitcnt lgkmcnt(2)
  v_mfma_f32_32x32x16_bf16 v[0:15], a[44:47], v[44:47], v[0:15]
  ds_read_b128 v[40:43], v205 offset:3072
  v_mfma_f32_32x32x16_bf16 v[16:31], v[44:47], a[188:191], v[16:31]
  s_waitcnt lgkmcnt(2)
  v_mfma_f32_32x32x16_bf16 v[0:15], a[48:51], v[32:35], v[0:15]
  ds_read_b128 v[44:47], v206 offset:3072
  v_mfma_f32_32x32x16_bf16 v[16:31], v[32:35], a[192:195], v[16:31]
  s_waitcnt lgkmcnt(2)
  v_mfma_f32_32x32x16_bf16 v[0:15], a[52:55], v[36:39], v[0:15]
  ds_read_b128 v[32:35], v203 offset:4096
  v_mfma_f32_32x32x16_bf16 v[16:31], v[36:39], a[196:199], v[16:31]
  s_waitcnt lgkmcnt(2)
  v_mfma_f32_32x32x16_bf16 v[0:15], a[56:59], v[40:43], v[0:15]
  ds_read_b128 v[36:39], v204 offset:4096
  v_mfma_f32_32x32x16_bf16 v[16:31], v[40:43], a[200:203], v[16:31]
  s_waitcnt lgkmcnt(2)
  v_mfma_f32_32x32x16_bf16 v[0:15], a[60:63], v[44:47], v[0:15]
  ds_read_b128 v[40:43], v205 offset:4096
  v_mfma_f32_32x32x16_bf16 v[16:31], v[44:47], a[204:207], v[16:31]
  s_waitcnt lgkmcnt(2)
  v_mfma_f32_32x32x16_bf16 v[0:15], a[64:67], v[32:35], v[0:15]
  ds_read_b128 v[44:47], v206 offset:4096
  v_mfma_f32_32x32x16_bf16 v[16:31], v[32:35], a[208:211], v[16:31]
  s_waitcnt lgkmcnt(2)
  v_mfma_f32_32x32x16_bf16 v[0:15], a[68:71], v[36:39], v[0:15]
  ds_read_b128 v[32:35], v203 offset:5120
  v_mfma_f32_32x32x16_bf16 v[16:31], v[36:39], a[212:215], v[16:31]
  s_waitcnt lgkmcnt(2)
  v_mfma_f32_32x32x16_bf16 v[0:15], a[72:75], v[40:43], v[0:15]
  ds_read_b128 v[36:39], v204 offset:5120
  v_mfma_f32_32x32x16_bf16 v[16:31], v[40:43], a[216:219], v[16:31]
  s_waitcnt lgkmcnt(2)
  v_mfma_f32_32x32x16_bf16 v[0:15], a[76:79], v[44:47], v[0:15]
  ds_read_b128 v[40:43], v205 offset:5120
  v_mfma_f32_32x32x16_bf16 v[16:31], v[44:47], a[220:223], v[16:31]
  s_waitcnt lgkmcnt(2)
  v_mfma_f32_32x32x16_bf16 v[0:15], a[80:83], v[32:35], v[0:15]
  ds_read_b128 v[44:47], v206 offset:5120
  v_mfma_f32_32x32x16_bf16 v[16:31], v[32:35], a[224:227], v[16:31]
  s_waitcnt lgkmcnt(2)
  v_mfma_f32_32x32x16_bf16 v[0:15], a[84:87], v[36:39], v[0:15]
  ds_read_b128 v[32:35], v203 offset:6144
  v_mfma_f32_32x32x16_bf16 v[16:31], v[36:39], a[228:231], v[16:31]
  s_waitcnt lgkmcnt(2)
  v_mfma_f32_32x32x16_bf16 v[0:15], a[88:91], v[40:43], v[0:15]
  ds_read_b128 v[36:39], v204 offset:6144
  v_mfma_f32_32x32x16_bf16 v[16:31], v[40:43], a[232:235], v[16:31]
  s_waitcnt lgkmcnt(2)
  v_mfma_f32_32x32x16_bf16 v[0:15], a[92:95], v[44:47], v[0:15]
  ds_read_b128 v[40:43], v205 offset:6144
  v_mfma_f32_32x32x16_bf16 v[16:31], v[44:47], a[236:239], v[16:31]
  s_waitcnt lgkmcnt(2)
  v_mfma_f32_32x32x16_bf16 v[0:15], a[96:99], v[32:35], v[0:15]
  ds_read_b128 v[44:47], v206 offset:6144
  v_mfma_f32_32x32x16_bf16 v[16:31], v[32:35], a[240:243], v[16:31]
  s_waitcnt lgkmcnt(2)
  v_mfma_f32_32x32x16_bf16 v[0:15], a[100:103], v[36:39], v[0:15]
  ds_read_b128 v[32:35], v203 offset:7168
  v_mfma_f32_32x32x16_bf16 v[16:31], v[36:39], a[244:247], v[16:31]
  s_waitcnt lgkmcnt(2)
  v_mfma_f32_32x32x16_bf16 v[0:15], a[104:107], v[40:43], v[0:15]
  ds_read_b128 v[36:39], v204 offset:7168
  v_mfma_f32_32x32x16_bf16 v[16:31], v[40:43], a[248:251], v[16:31]
  s_waitcnt lgkmcnt(2)
  v_mfma_f32_32x32x16_bf16 v[0:15], a[108:111], v[44:47], v[0:15]
  ds_read_b128 v[40:43], v205 offset:7168
  v_mfma_f32_32x32x16_bf16 v[16:31], v[44:47], a[252:255], v[16:31]
  s_waitcnt lgkmcnt(2)
  v_mfma_f32_32x32x16_bf16 v[0:15], a[112:115], v[32:35], v[0:15]
  ds_read_b128 v[44:47], v206 offset:7168
  v_mfma_f32_32x32x16_bf16 v[16:31], v[32:35], v[224:227], v[16:31]
  s_waitcnt lgkmcnt(2)
  v_mfma_f32_32x32x16_bf16 v[0:15], a[116:119], v[36:39], v[0:15]
  ds_read_b128 v[32:35], v203 offset:8192
  v_mfma_f32_32x32x16_bf16 v[16:31], v[36:39], v[228:231], v[16:31]
  s_waitcnt lgkmcnt(2)
  v_mfma_f32_32x32x16_bf16 v[0:15], a[120:123], v[40:43], v[0:15]
  ds_read_b128 v[36:39], v204 offset:8192
  v_mfma_f32_32x32x16_bf16 v[16:31], v[40:43], v[232:235], v[16:31]
  s_waitcnt lgkmcnt(2)
  v_mfma_f32_32x32x16_bf16 v[0:15], a[124:127], v[44:47], v[0:15]
  ds_read_b128 v[40:43], v205 offset:8192
  v_mfma_f32_32x32x16_bf16 v[16:31], v[44:47], v[236:239], v[16:31]
  s_waitcnt lgkmcnt(2)
  v_mfma_f32_32x32x16_bf16 v[0:15], a[128:131], v[32:35], v[0:15]
  ds_read_b128 v[44:47], v206 offset:8192
  v_mfma_f32_32x32x16_bf16 v[16:31], v[32:35], v[240:243], v[16:31]
  s_waitcnt lgkmcnt(2)
  v_mfma_f32_32x32x16_bf16 v[0:15], a[132:135], v[36:39], v[0:15]
  v_mfma_f32_32x32x16_bf16 v[16:31], v[36:39], v[244:247], v[16:31]
  s_waitcnt lgkmcnt(1)
  v_mfma_f32_32x32x16_bf16 v[0:15], a[136:139], v[40:43], v[0:15]
  v_mfma_f32_32x32x16_bf16 v[16:31], v[40:43], v[248:251], v[16:31]
  s_waitcnt lgkmcnt(0)
  v_mfma_f32_32x32x16_bf16 v[0:15], a[140:143], v[44:47], v[0:15]
  v_mfma_f32_32x32x16_bf16 v[16:31], v[44:47], v[252:255], v[16:31]
  s_mul_i32 s64, s59, 655360
  s_lshl_b32 s55, s58, 14
  s_add_u32 s64, s64, s55
  s_add_u32 s64, s64, 1048576
  s_add_u32 s72, s64, s69
  s_add_u32 s73, s64, s66
  s_add_u32 s59, s59, 7
  s_waitcnt vmcnt(0)
  s_barrier
  s_cmp_eq_u32 s1, 1
  s_cbranch_scc1 W_ver_ok
  v_mov_b32 v33, 163832
  s_cmp_eq_u32 s52, 0
  s_cbranch_scc0 W_ver_b
  s_waitcnt vmcnt(0)
  s_mov_b64 exec, 1
  ds_write_b32 v33, v197
  s_mov_b64 exec, -1
  s_waitcnt lgkmcnt(0)
W_ver_b:
  s_barrier
  ds_read_b32 v32, v33
  s_waitcnt lgkmcnt(0)
  v_readfirstlane_b32 s54, v32
  s_nop 0
  s_bitcmp1_b32 s54, s0
  s_cbranch_scc1 L_conf
W_ver_ok:
  s_lshr_b32 s55, s53, 1
  s_and_b32 s56, s53, 1
  s_lshl_b32 s56, s56, 13
  s_lshl_b32 s55, s55, 8
  s_add_u32 s55, s55, s56
  s_add_u32 s55, s55, 393216
  s_cmp_lt_u32 s53, 64
  s_cselect_b32 s71, s55, 268435456
  v_mov_b32 v211, 0
  s_mov_b64 exec, 1
  buffer_store_dword v211, v211, s[8:11], s71 offen sc1
  s_mov_b64 exec, -1
  s_cmp_eq_u32 s59, 7
  s_cbranch_scc0 KV_na
  s_mul_i32 s54, s58, 2176
  s_mul_i32 s55, s52, 69632
  s_add_u32 s55, s55, s54
  s_add_u32 s55, s55, 0
  s_add_u32 s54, s54, 278528
  s_and_b32 s56, s58, 7
  s_lshl_b32 s56, s56, 12
  s_bfe_u32 s57, s58, 0x10003
  s_lshl_b32 s57, s57, 11
  s_add_u32 s56, s56, s57
  s_add_u32 s54, s56, 262144
  s_lshr_b32 s57, s58, 4
  s_lshl_b32 s57, s57, 15
  s_add_u32 s56, s56, s57
  s_lshl_b32 s57, s52, 16
  s_add_u32 s56, s56, s57
  s_add_u32 s55, s56, 0
  s_lshl_b32 s56, s58, 14
  s_mul_i32 s57, s52, 3072
  s_add_u32 s56, s56, s57
  s_add_u32 s56, s56, 360448
  s_cmp_lt_u32 s58, 2
  s_cselect_b32 s56, s56, 268435456
  s_cmp_eq_u32 s52, 0
  s_cselect_b32 s54, s54, 268435456
  buffer_store_dwordx4 v[64:67], v201, s[8:11], s55 offen offset:0 sc1
  buffer_store_dwordx4 v[64:67], v201, s[8:11], s55 offen offset:1024 sc1
  buffer_store_dwordx4 v[64:67], v201, s[8:11], s54 offen offset:0 sc1
  buffer_store_dwordx4 v[64:67], v201, s[8:11], s54 offen offset:1024 sc1
  buffer_store_dwordx4 v[64:67], v201, s[8:11], s56 offen offset:0 sc1
  buffer_store_dwordx4 v[64:67], v201, s[8:11], s56 offen offset:1024 sc1
  buffer_store_dwordx4 v[64:67], v201, s[8:11], s56 offen offset:2048 sc1
KV_na:
KV_loop:
  s_add_u32 s60, s60, 258048
  ds_read_b128 v[32:35], v203 offset:36864
  ds_read_b128 v[36:39], v204 offset:36864
  ds_read_b128 v[40:43], v205 offset:36864
  s_waitcnt lgkmcnt(2)
  v_mfma_f32_32x32x16_bf16 v[68:83], a[0:3], v[32:35], 0
  ds_read_b128 v[44:47], v206 offset:36864
  s_add_u32 m0, s67, 0
  s_nop 0
  buffer_load_dwordx4 v202, s[4:7], s60 offen offset:0 lds
  v_mfma_f32_32x32x16_bf16 v[84:99], v[32:35], a[144:147], 0
  s_waitcnt lgkmcnt(2)
  v_mfma_f32_32x32x16_bf16 v[68:83], a[4:7], v[36:39], v[68:83]
  ds_read_b128 v[32:35], v203 offset:37888
  s_add_u32 m0, s67, 896
  s_nop 0
  buffer_load_dwordx4 v202, s[4:7], s60 offen offset:128 lds
  v_mfma_f32_32x32x16_bf16 v[84:99], v[36:39], a[148:151], v[84:99]
  s_waitcnt lgkmcnt(2)
  v_mfma_f32_32x32x16_bf16 v[68:83], a[8:11], v[40:43], v[68:83]
  ds_read_b128 v[36:39], v204 offset:37888
  s_add_u32 m0, s67, 1792
  s_nop 0
  buffer_load_dwordx4 v202, s[4:7], s60 offen offset:256 lds
  v_mfma_f32_32x32x16_bf16 v[84:99], v[40:43], a[152:155], v[84:99]
  s_waitcnt lgkmcnt(2)
  v_mfma_f32_32x32x16_bf16 v[68:83], a[12:15], v[44:47], v[68:83]
  ds_read_b128 v[40:43], v205 offset:37888
  s_add_u32 m0, s67, 2688
  s_nop 0
  buffer_load_dwordx4 v202, s[4:7], s60 offen offset:384 lds
  v_mfma_f32_32x32x16_bf16 v[84:99], v[44:47], a[156:159], v[84:99]
  s_waitcnt lgkmcnt(2)
  v_mfma_f32_32x32x16_bf16 v[68:83], a[16:19], v[32:35], v[68:83]
  ds_read_b128 v[44:47], v206 offset:37888
  s_add_u32 m0, s67, 3584
  s_nop 0
  buffer_load_dwordx4 v202, s[4:7], s60 offen offset:512 lds
  v_mfma_f32_32x32x16_bf16 v[84:99], v[32:35], a[160:163], v[84:99]
  s_waitcnt lgkmcnt(2)
  v_mfma_f32_32x32x16_bf16 v[68:83], a[20:23], v[36:39], v[68:83]
  ds_read_b128 v[32:35], v203 offset:38912
  s_add_u32 m0, s67, 4480
  s_nop 0
  buffer_load_dwordx4 v202, s[4:7], s60 offen offset:640 lds
  v_mfma_f32_32x32x16_bf16 v[84:99], v[36:39], a[164:167], v[84:99]
  s_waitcnt lgkmcnt(2)
  v_mfma_f32_32x32x16_bf16 v[68:83], a[24:27], v[40:43], v[68:83]
  ds_read_b128 v[36:39], v204 offset:38912
  s_add_u32 m0, s67, 5376
  s_nop 0
  buffer_load_dwordx4 v202, s[4:7], s60 offen offset:768 lds
  v_mfma_f32_32x32x16_bf16 v[84:99], v[40:43], a[168:171], v[84:99]
  s_waitcnt lgkmcnt(2)
  v_mfma_f32_32x32x16_bf16 v[68:83], a[28:31], v[44:47], v[68:83]
  ds_read_b128 v[40:43], v205 offset:38912
  s_add_u32 m0, s67, 6272
  s_nop 0
  buffer_load_dwordx4 v202, s[4:7], s60 offen offset:896 lds
  v_mfma_f32_32x32x16_bf16 v[84:99], v[44:47], a[172:175], v[84:99]
  s_waitcnt lgkmcnt(2)
  v_mfma_f32_32x32x16_bf16 v[68:83], a[32:35], v[32:35], v[68:83]
  ds_read_b128 v[44:47], v206 offset:38912
  s_add_u32 m0, s67, 7168
  s_nop 0
  buffer_load_dwordx4 v202, s[4:7], s60 offen offset:1024 lds
  v_mfma_f32_32x32x16_bf16 v[84:99], v[32:35], a[176:179], v[84:99]
  s_waitcnt lgkmcnt(2)
  v_mfma_f32_32x32x16_bf16 v[68:83], a[36:39], v[36:39], v[68:83]
  ds_read_b128 v[32:35], v203 offset:39936
  v_mul_f32 v0, s68, v0
  v_mul_f32 v1, s68, v1
  v_mul_f32 v2, s68, v2
  v_mul_f32 v3, s68, v3
  v_mfma_f32_32x32x16_bf16 v[84:99], v[36:39], a[180:183], v[84:99]
  v_mul_f32 v4, s68, v4
  v_mul_f32 v5, s68, v5
  v_mul_f32 v6, s68, v6
  v_mul_f32 v7, s68, v7
  s_waitcnt lgkmcnt(2)
  v_mfma_f32_32x32x16_bf16 v[68:83], a[40:43], v[40:43], v[68:83]
  ds_read_b128 v[36:39], v204 offset:39936
  v_cvt_pk_bf16_f32 v48, v0, v4
  v_cvt_pk_bf16_f32 v49, v1, v5
  v_cvt_pk_bf16_f32 v50, v2, v6
  v_cvt_pk_bf16_f32 v51, v3, v7
  v_mfma_f32_32x32x16_bf16 v[84:99], v[40:43], a[184:187], v[84:99]
  buffer_store_dwordx4 v[48:51], v216, s[8:11], s72 offen offset:0 sc1
  s_waitcnt lgkmcnt(2)
  v_mfma_f32_32x32x16_bf16 v[68:83], a[44:47], v[44:47], v[68:83]
  ds_read_b128 v[40:43], v205 offset:39936
  v_mfma_f32_32x32x16_bf16 v[84:99], v[44:47], a[188:191], v[84:99]
  s_waitcnt lgkmcnt(2)
  v_mfma_f32_32x32x16_bf16 v[68:83], a[48:51], v[32:35], v[68:83]
  ds_read_b128 v[44:47], v206 offset:39936
  v_mul_f32 v8, s68, v8
  v_mul_f32 v9, s68, v9
  v_mul_f32 v10, s68, v10
  v_mul_f32 v11, s68, v11
  v_mfma_f32_32x32x16_bf16 v[84:99], v[32:35], a[192:195], v[84:99]
  v_mul_f32 v12, s68, v12
  v_mul_f32 v13, s68, v13
  v_mul_f32 v14, s68, v14
  v_mul_f32 v15, s68, v15
  s_waitcnt lgkmcnt(2)
  v_mfma_f32_32x32x16_bf16 v[68:83], a[52:55], v[36:39], v[68:83]
  ds_read_b128 v[32:35], v203 offset:40960
  v_cvt_pk_bf16_f32 v52, v8, v12
  v_cvt_pk_bf16_f32 v53, v9, v13
  v_cvt_pk_bf16_f32 v54, v10, v14
  v_cvt_pk_bf16_f32 v55, v11, v15
  v_mfma_f32_32x32x16_bf16 v[84:99], v[36:39], a[196:199], v[84:99]
  buffer_store_dwordx4 v[52:55], v216, s[8:11], s72 offen offset:256 sc1
  s_waitcnt lgkmcnt(2)
  v_mfma_f32_32x32x16_bf16 v[68:83], a[56:59], v[40:43], v[68:83]
  ds_read_b128 v[36:39], v204 offset:40960
  v_mfma_f32_32x32x16_bf16 v[84:99], v[40:43], a[200:203], v[84:99]
  s_waitcnt lgkmcnt(2)
  v_mfma_f32_32x32x16_bf16 v[68:83], a[60:63], v[44:47], v[68:83]
  ds_read_b128 v[40:43], v205 offset:40960
  v_cvt_pk_bf16_f32 v56, v16, v17
  v_cvt_pk_bf16_f32 v57, v20, v21
  v_cvt_pk_bf16_f32 v58, v24, v25
  v_cvt_pk_bf16_f32 v59, v28, v29
  v_mfma_f32_32x32x16_bf16 v[84:99], v[44:47], a[204:207], v[84:99]
  buffer_store_dwordx4 v[56:59], v217, s[8:11], s64 offen offset:0 sc1
  s_waitcnt lgkmcnt(2)
  v_mfma_f32_32x32x16_bf16 v[68:83], a[64:67], v[32:35], v[68:83]
  ds_read_b128 v[44:47], v206 offset:40960
  v_mfma_f32_32x32x16_bf16 v[84:99], v[32:35], a[208:211], v[84:99]
  s_waitcnt lgkmcnt(2)
  v_mfma_f32_32x32x16_bf16 v[68:83], a[68:71], v[36:39], v[68:83]
  ds_read_b128 v[32:35], v203 offset:41984
  v_cvt_pk_bf16_f32 v60, v18, v19
  v_cvt_pk_bf16_f32 v61, v22, v23
  v_cvt_pk_bf16_f32 v62, v26, v27
  v_cvt_pk_bf16_f32 v63, v30, v31
  v_mfma_f32_32x32x16_bf16 v[84:99], v[36:39], a[212:215], v[84:99]
  buffer_store_dwordx4 v[60:63], v217, s[8:11], s64 offen offset:256 sc1
  s_waitcnt lgkmcnt(2)
  v_mfma_f32_32x32x16_bf16 v[68:83], a[72:75], v[40:43], v[68:83]
  ds_read_b128 v[36:39], v204 offset:41984
  v_mfma_f32_32x32x16_bf16 v[84:99], v[40:43], a[216:219], v[84:99]
  s_waitcnt lgkmcnt(2)
  v_mfma_f32_32x32x16_bf16 v[68:83], a[76:79], v[44:47], v[68:83]
  ds_read_b128 v[40:43], v205 offset:41984
  buffer_store_dwordx4 v[64:67], v201, s[8:11], s73 offen sc1
  v_mfma_f32_32x32x16_bf16 v[84:99], v[44:47], a[220:223], v[84:99]
  s_waitcnt lgkmcnt(2)
  v_mfma_f32_32x32x16_bf16 v[68:83], a[80:83], v[32:35], v[68:83]
  ds_read_b128 v[44:47], v206 offset:41984
  v_mfma_f32_32x32x16_bf16 v[84:99], v[32:35], a[224:227], v[84:99]
  s_waitcnt lgkmcnt(2)
  v_mfma_f32_32x32x16_bf16 v[68:83], a[84:87], v[36:39], v[68:83]
  ds_read_b128 v[32:35], v203 offset:43008
  v_mfma_f32_32x32x16_bf16 v[84:99], v[36:39], a[228:231], v[84:99]
  s_waitcnt lgkmcnt(2)
  v_mfma_f32_32x32x16_bf16 v[68:83], a[88:91], v[40:43], v[68:83]
  ds_read_b128 v[36:39], v204 offset:43008
  v_mfma_f32_32x32x16_bf16 v[84:99], v[40:43], a[232:235], v[84:99]
  s_waitcnt lgkmcnt(2)
  v_mfma_f32_32x32x16_bf16 v[68:83], a[92:95], v[44:47], v[68:83]
  ds_read_b128 v[40:43], v205 offset:43008
  v_mfma_f32_32x32x16_bf16 v[84:99], v[44:47], a[236:239], v[84:99]
  s_waitcnt lgkmcnt(2)
  v_mfma_f32_32x32x16_bf16 v[68:83], a[96:99], v[32:35], v[68:83]
  ds_read_b128 v[44:47], v206 offset:43008
  v_mfma_f32_32x32x16_bf16 v[84:99], v[32:35], a[240:243], v[84:99]
  s_waitcnt lgkmcnt(2)
  v_mfma_f32_32x32x16_bf16 v[68:83], a[100:103], v[36:39], v[68:83]
  ds_read_b128 v[32:35], v203 offset:44032
  v_mfma_f32_32x32x16_bf16 v[84:99], v[36:39], a[244:247], v[84:99]
  s_waitcnt lgkmcnt(2)
  v_mfma_f32_32x32x16_bf16 v[68:83], a[104:107], v[40:43], v[68:83]
  ds_read_b128 v[36:39], v204 offset:44032
  v_mfma_f32_32x32x16_bf16 v[84:99], v[40:43], a[248:251], v[84:99]
  s_waitcnt lgkmcnt(2)
  v_mfma_f32_32x32x16_bf16 v[68:83], a[108:111], v[44:47], v[68:83]
  ds_read_b128 v[40:43], v205 offset:44032
  v_mfma_f32_32x32x16_bf16 v[84:99], v[44:47], a[252:255], v[84:99]
  s_waitcnt lgkmcnt(2)
  v_mfma_f32_32x32x16_bf16 v[68:83], a[112:115], v[32:35], v[68:83]
  ds_read_b128 v[44:47], v206 offset:44032
  v_mfma_f32_32x32x16_bf16 v[84:99], v[32:35], v[224:227], v[84:99]
  s_waitcnt lgkmcnt(2)
  v_mfma_f32_32x32x16_bf16 v[68:83], a[116:119], v[36:39], v[68:83]
  ds_read_b128 v[32:35], v203 offset:45056
  v_mfma_f32_32x32x16_bf16 v[84:99], v[36:39], v[228:231], v[84:99]
  s_waitcnt lgkmcnt(2)
  v_mfma_f32_32x32x16_bf16 v[68:83], a[120:123], v[40:43], v[68:83]
  ds_read_b128 v[36:39], v204 offset:45056
  v_mfma_f32_32x32x16_bf16 v[84:99], v[40:43], v[232:235], v[84:99]
  s_waitcnt lgkmcnt(2)
  v_mfma_f32_32x32x16_bf16 v[68:83], a[124:127], v[44:47], v[68:83]
  ds_read_b128 v[40:43], v205 offset:45056
  v_mfma_f32_32x32x16_bf16 v[84:99], v[44:47], v[236:239], v[84:99]
  s_waitcnt lgkmcnt(2)
  v_mfma_f32_32x32x16_bf16 v[68:83], a[128:131], v[32:35], v[68:83]
  ds_read_b128 v[44:47], v206 offset:45056
  v_mfma_f32_32x32x16_bf16 v[84:99], v[32:35], v[240:243], v[84:99]
  s_waitcnt lgkmcnt(2)
  v_mfma_f32_32x32x16_bf16 v[68:83], a[132:135], v[36:39], v[68:83]
  v_mfma_f32_32x32x16_bf16 v[84:99], v[36:39], v[244:247], v[84:99]
  s_waitcnt lgkmcnt(1)
  v_mfma_f32_32x32x16_bf16 v[68:83], a[136:139], v[40:43], v[68:83]
  v_mfma_f32_32x32x16_bf16 v[84:99], v[40:43], v[248:251], v[84:99]
  s_waitcnt lgkmcnt(0)
  v_mfma_f32_32x32x16_bf16 v[68:83], a[140:143], v[44:47], v[68:83]
  v_mfma_f32_32x32x16_bf16 v[84:99], v[44:47], v[252:255], v[84:99]
  s_mul_i32 s64, s59, 655360
  s_lshl_b32 s55, s58, 14
  s_add_u32 s64, s64, s55
  s_add_u32 s64, s64, 1048576
  s_add_u32 s72, s64, s69
  s_add_u32 s73, s64, s66
  s_add_u32 s59, s59, 7
  s_cmp_ge_u32 s59, 64
  s_cbranch_scc1 KV_done1
  s_waitcnt vmcnt(5)
  s_barrier
  s_add_u32 s60, s60, 258048
  ds_read_b128 v[32:35], v203 offset:0
  ds_read_b128 v[36:39], v204 offset:0
  ds_read_b128 v[40:43], v205 offset:0
  s_waitcnt lgkmcnt(2)
  v_mfma_f32_32x32x16_bf16 v[0:15], a[0:3], v[32:35], 0
  ds_read_b128 v[44:47], v206 offset:0
  s_add_u32 m0, s67, 36864
  s_nop 0
  buffer_load_dwordx4 v202, s[4:7], s60 offen offset:0 lds
  v_mfma_f32_32x32x16_bf16 v[16:31], v[32:35], a[144:147], 0
  s_waitcnt lgkmcnt(2)
  v_mfma_f32_32x32x16_bf16 v[0:15], a[4:7], v[36:39], v[0:15]
  ds_read_b128 v[32:35], v203 offset:1024
  s_add_u32 m0, s67, 37760
  s_nop 0
  buffer_load_dwordx4 v202, s[4:7], s60 offen offset:128 lds
  v_mfma_f32_32x32x16_bf16 v[16:31], v[36:39], a[148:151], v[16:31]
  s_waitcnt lgkmcnt(2)
  v_mfma_f32_32x32x16_bf16 v[0:15], a[8:11], v[40:43], v[0:15]
  ds_read_b128 v[36:39], v204 offset:1024
  s_add_u32 m0, s67, 38656
  s_nop 0
  buffer_load_dwordx4 v202, s[4:7], s60 offen offset:256 lds
  v_mfma_f32_32x32x16_bf16 v[16:31], v[40:43], a[152:155], v[16:31]
  s_waitcnt lgkmcnt(2)
  v_mfma_f32_32x32x16_bf16 v[0:15], a[12:15], v[44:47], v[0:15]
  ds_read_b128 v[40:43], v205 offset:1024
  s_add_u32 m0, s67, 39552
  s_nop 0
  buffer_load_dwordx4 v202, s[4:7], s60 offen offset:384 lds
  v_mfma_f32_32x32x16_bf16 v[16:31], v[44:47], a[156:159], v[16:31]
  s_waitcnt lgkmcnt(2)
  v_mfma_f32_32x32x16_bf16 v[0:15], a[16:19], v[32:35], v[0:15]
  ds_read_b128 v[44:47], v206 offset:1024
  s_add_u32 m0, s67, 40448
  s_nop 0
  buffer_load_dwordx4 v202, s[4:7], s60 offen offset:512 lds
  v_mfma_f32_32x32x16_bf16 v[16:31], v[32:35], a[160:163], v[16:31]
  s_waitcnt lgkmcnt(2)
  v_mfma_f32_32x32x16_bf16 v[0:15], a[20:23], v[36:39], v[0:15]
  ds_read_b128 v[32:35], v203 offset:2048
  s_add_u32 m0, s67, 41344
  s_nop 0
  buffer_load_dwordx4 v202, s[4:7], s60 offen offset:640 lds
  v_mfma_f32_32x32x16_bf16 v[16:31], v[36:39], a[164:167], v[16:31]
  s_waitcnt lgkmcnt(2)
  v_mfma_f32_32x32x16_bf16 v[0:15], a[24:27], v[40:43], v[0:15]
  ds_read_b128 v[36:39], v204 offset:2048
  s_add_u32 m0, s67, 42240
  s_nop 0
  buffer_load_dwordx4 v202, s[4:7], s60 offen offset:768 lds
  v_mfma_f32_32x32x16_bf16 v[16:31], v[40:43], a[168:171], v[16:31]
  s_waitcnt lgkmcnt(2)
  v_mfma_f32_32x32x16_bf16 v[0:15], a[28:31], v[44:47], v[0:15]
  ds_read_b128 v[40:43], v205 offset:2048
  s_add_u32 m0, s67, 43136
  s_nop 0
  buffer_load_dwordx4 v202, s[4:7], s60 offen offset:896 lds
  v_mfma_f32_32x32x16_bf16 v[16:31], v[44:47], a[172:175], v[16:31]
  s_waitcnt lgkmcnt(2)
  v_mfma_f32_32x32x16_bf16 v[0:15], a[32:35], v[32:35], v[0:15]
  ds_read_b128 v[44:47], v206 offset:2048
  s_add_u32 m0, s67, 44032
  s_nop 0
  buffer_load_dwordx4 v202, s[4:7], s60 offen offset:1024 lds
  v_mfma_f32_32x32x16_bf16 v[16:31], v[32:35], a[176:179], v[16:31]
  s_waitcnt lgkmcnt(2)
  v_mfma_f32_32x32x16_bf16 v[0:15], a[36:39], v[36:39], v[0:15]
  ds_read_b128 v[32:35], v203 offset:3072
  v_mul_f32 v68, s68, v68
  v_mul_f32 v69, s68, v69
  v_mul_f32 v70, s68, v70
  v_mul_f32 v71, s68, v71
  v_mfma_f32_32x32x16_bf16 v[16:31], v[36:39], a[180:183], v[16:31]
  v_mul_f32 v72, s68, v72
  v_mul_f32 v73, s68, v73
  v_mul_f32 v74, s68, v74
  v_mul_f32 v75, s68, v75
  s_waitcnt lgkmcnt(2)
  v_mfma_f32_32x32x16_bf16 v[0:15], a[40:43], v[40:43], v[0:15]
  ds_read_b128 v[36:39], v204 offset:3072
  v_cvt_pk_bf16_f32 v48, v68, v72
  v_cvt_pk_bf16_f32 v49, v69, v73
  v_cvt_pk_bf16_f32 v50, v70, v74
  v_cvt_pk_bf16_f32 v51, v71, v75
  v_mfma_f32_32x32x16_bf16 v[16:31], v[40:43], a[184:187], v[16:31]
  buffer_store_dwordx4 v[48:51], v216, s[8:11], s72 offen offset:0 sc1
  s_waitcnt lgkmcnt(2)
  v_mfma_f32_32x32x16_bf16 v[0:15], a[44:47], v[44:47], v[0:15]
  ds_read_b128 v[40:43], v205 offset:3072
  v_mfma_f32_32x32x16_bf16 v[16:31], v[44:47], a[188:191], v[16:31]
  s_waitcnt lgkmcnt(2)
  v_mfma_f32_32x32x16_bf16 v[0:15], a[48:51], v[32:35], v[0:15]
  ds_read_b128 v[44:47], v206 offset:3072
  v_mul_f32 v76, s68, v76
  v_mul_f32 v77, s68, v77
  v_mul_f32 v78, s68, v78
  v_mul_f32 v79, s68, v79
  v_mfma_f32_32x32x16_bf16 v[16:31], v[32:35], a[192:195], v[16:31]
  v_mul_f32 v80, s68, v80
  v_mul_f32 v81, s68, v81
  v_mul_f32 v82, s68, v82
  v_mul_f32 v83, s68, v83
  s_waitcnt lgkmcnt(2)
  v_mfma_f32_32x32x16_bf16 v[0:15], a[52:55], v[36:39], v[0:15]
  ds_read_b128 v[32:35], v203 offset:4096
  v_cvt_pk_bf16_f32 v52, v76, v80
  v_cvt_pk_bf16_f32 v53, v77, v81
  v_cvt_pk_bf16_f32 v54, v78, v82
  v_cvt_pk_bf16_f32 v55, v79, v83
  v_mfma_f32_32x32x16_bf16 v[16:31], v[36:39], a[196:199], v[16:31]
  buffer_store_dwordx4 v[52:55], v216, s[8:11], s72 offen offset:256 sc1
  s_waitcnt lgkmcnt(2)
  v_mfma_f32_32x32x16_bf16 v[0:15], a[56:59], v[40:43], v[0:15]
  ds_read_b128 v[36:39], v204 offset:4096
  v_mfma_f32_32x32x16_bf16 v[16:31], v[40:43], a[200:203], v[16:31]
  s_waitcnt lgkmcnt(2)
  v_mfma_f32_32x32x16_bf16 v[0:15], a[60:63], v[44:47], v[0:15]
  ds_read_b128 v[40:43], v205 offset:4096
  v_cvt_pk_bf16_f32 v56, v84, v85
  v_cvt_pk_bf16_f32 v57, v88, v89
  v_cvt_pk_bf16_f32 v58, v92, v93
  v_cvt_pk_bf16_f32 v59, v96, v97
  v_mfma_f32_32x32x16_bf16 v[16:31], v[44:47], a[204:207], v[16:31]
  buffer_store_dwordx4 v[56:59], v217, s[8:11], s64 offen offset:0 sc1
  s_waitcnt lgkmcnt(2)
  v_mfma_f32_32x32x16_bf16 v[0:15], a[64:67], v[32:35], v[0:15]
  ds_read_b128 v[44:47], v206 offset:4096
  v_mfma_f32_32x32x16_bf16 v[16:31], v[32:35], a[208:211], v[16:31]
  s_waitcnt lgkmcnt(2)
  v_mfma_f32_32x32x16_bf16 v[0:15], a[68:71], v[36:39], v[0:15]
  ds_read_b128 v[32:35], v203 offset:5120
  v_cvt_pk_bf16_f32 v60, v86, v87
  v_cvt_pk_bf16_f32 v61, v90, v91
  v_cvt_pk_bf16_f32 v62, v94, v95
  v_cvt_pk_bf16_f32 v63, v98, v99
  v_mfma_f32_32x32x16_bf16 v[16:31], v[36:39], a[212:215], v[16:31]
  buffer_store_dwordx4 v[60:63], v217, s[8:11], s64 offen offset:256 sc1
  s_waitcnt lgkmcnt(2)
  v_mfma_f32_32x32x16_bf16 v[0:15], a[72:75], v[40:43], v[0:15]
  ds_read_b128 v[36:39], v204 offset:5120
  v_mfma_f32_32x32x16_bf16 v[16:31], v[40:43], a[216:219], v[16:31]
  s_waitcnt lgkmcnt(2)
  v_mfma_f32_32x32x16_bf16 v[0:15], a[76:79], v[44:47], v[0:15]
  ds_read_b128 v[40:43], v205 offset:5120
  buffer_store_dwordx4 v[64:67], v201, s[8:11], s73 offen sc1
  v_mfma_f32_32x32x16_bf16 v[16:31], v[44:47], a[220:223], v[16:31]
  s_waitcnt lgkmcnt(2)
  v_mfma_f32_32x32x16_bf16 v[0:15], a[80:83], v[32:35], v[0:15]
  ds_read_b128 v[44:47], v206 offset:5120
  v_mfma_f32_32x32x16_bf16 v[16:31], v[32:35], a[224:227], v[16:31]
  s_waitcnt lgkmcnt(2)
  v_mfma_f32_32x32x16_bf16 v[0:15], a[84:87], v[36:39], v[0:15]
  ds_read_b128 v[32:35], v203 offset:6144
  v_mfma_f32_32x32x16_bf16 v[16:31], v[36:39], a[228:231], v[16:31]
  s_waitcnt lgkmcnt(2)
  v_mfma_f32_32x32x16_bf16 v[0:15], a[88:91], v[40:43], v[0:15]
  ds_read_b128 v[36:39], v204 offset:6144
  v_mfma_f32_32x32x16_bf16 v[16:31], v[40:43], a[232:235], v[16:31]
  s_waitcnt lgkmcnt(2)
  v_mfma_f32_32x32x16_bf16 v[0:15], a[92:95], v[44:47], v[0:15]
  ds_read_b128 v[40:43], v205 offset:6144
  v_mfma_f32_32x32x16_bf16 v[16:31], v[44:47], a[236:239], v[16:31]
  s_waitcnt lgkmcnt(2)
  v_mfma_f32_32x32x16_bf16 v[0:15], a[96:99], v[32:35], v[0:15]
  ds_read_b128 v[44:47], v206 offset:6144
  v_mfma_f32_32x32x16_bf16 v[16:31], v[32:35], a[240:243], v[16:31]
  s_waitcnt lgkmcnt(2)
  v_mfma_f32_32x32x16_bf16 v[0:15], a[100:103], v[36:39], v[0:15]
  ds_read_b128 v[32:35], v203 offset:7168
  v_mfma_f32_32x32x16_bf16 v[16:31], v[36:39], a[244:247], v[16:31]
  s_waitcnt lgkmcnt(2)
  v_mfma_f32_32x32x16_bf16 v[0:15], a[104:107], v[40:43], v[0:15]
  ds_read_b128 v[36:39], v204 offset:7168
  v_mfma_f32_32x32x16_bf16 v[16:31], v[40:43], a[248:251], v[16:31]
  s_waitcnt lgkmcnt(2)
  v_mfma_f32_32x32x16_bf16 v[0:15], a[108:111], v[44:47], v[0:15]
  ds_read_b128 v[40:43], v205 offset:7168
  v_mfma_f32_32x32x16_bf16 v[16:31], v[44:47], a[252:255], v[16:31]
  s_waitcnt lgkmcnt(2)
  v_mfma_f32_32x32x16_bf16 v[0:15], a[112:115], v[32:35], v[0:15]
  ds_read_b128 v[44:47], v206 offset:7168
  v_mfma_f32_32x32x16_bf16 v[16:31], v[32:35], v[224:227], v[16:31]
  s_waitcnt lgkmcnt(2)
  v_mfma_f32_32x32x16_bf16 v[0:15], a[116:119], v[36:39], v[0:15]
  ds_read_b128 v[32:35], v203 offset:8192
  v_mfma_f32_32x32x16_bf16 v[16:31], v[36:39], v[228:231], v[16:31]
  s_waitcnt lgkmcnt(2)
  v_mfma_f32_32x32x16_bf16 v[0:15], a[120:123], v[40:43], v[0:15]
  ds_read_b128 v[36:39], v204 offset:8192
  v_mfma_f32_32x32x16_bf16 v[16:31], v[40:43], v[232:235], v[16:31]
  s_waitcnt lgkmcnt(2)
  v_mfma_f32_32x32x16_bf16 v[0:15], a[124:127], v[44:47], v[0:15]
  ds_read_b128 v[40:43], v205 offset:8192
  v_mfma_f32_32x32x16_bf16 v[16:31], v[44:47], v[236:239], v[16:31]
  s_waitcnt lgkmcnt(2)
  v_mfma_f32_32x32x16_bf16 v[0:15], a[128:131], v[32:35], v[0:15]
  ds_read_b128 v[44:47], v206 offset:8192
  v_mfma_f32_32x32x16_bf16 v[16:31], v[32:35], v[240:243], v[16:31]
  s_waitcnt lgkmcnt(2)
  v_mfma_f32_32x32x16_bf16 v[0:15], a[132:135], v[36:39], v[0:15]
  v_mfma_f32_32x32x16_bf16 v[16:31], v[36:39], v[244:247], v[16:31]
  s_waitcnt lgkmcnt(1)
  v_mfma_f32_32x32x16_bf16 v[0:15], a[136:139], v[40:43], v[0:15]
  v_mfma_f32_32x32x16_bf16 v[16:31], v[40:43], v[248:251], v[16:31]
  s_waitcnt lgkmcnt(0)
  v_mfma_f32_32x32x16_bf16 v[0:15], a[140:143], v[44:47], v[0:15]
  v_mfma_f32_32x32x16_bf16 v[16:31], v[44:47], v[252:255], v[16:31]
  s_mul_i32 s64, s59, 655360
  s_lshl_b32 s55, s58, 14
  s_add_u32 s64, s64, s55
  s_add_u32 s64, s64, 1048576
  s_add_u32 s72, s64, s69
  s_add_u32 s73, s64, s66
  s_add_u32 s59, s59, 7
  s_cmp_ge_u32 s59, 64
  s_cbranch_scc1 KV_done0
  s_sub_u32 s54, s59, 21
  s_cmp_lt_u32 s54, 7
  s_cbranch_scc1 KV_early
  s_waitcnt vmcnt(5)
  s_barrier
KV_cont:
  s_branch KV_loop
KV_early:
  s_waitcnt vmcnt(0)
  s_barrier
  s_cmp_eq_u32 s52, 0
  s_cbranch_scc0 KV_sig0
  v_mov_b32 v211, 1
  v_mov_b32 v212, 0
  s_mov_b64 exec, 1
  buffer_atomic_add v211, v212, s[12:15], s70 offen
  s_mov_b64 exec, -1
KV_sig0:
  s_branch KV_cont
KV_done1:
  s_nop 11
  v_mul_f32 v68, s68, v68
  v_mul_f32 v69, s68, v69
  v_mul_f32 v70, s68, v70
  v_mul_f32 v71, s68, v71
  v_mul_f32 v72, s68, v72
  v_mul_f32 v73, s68, v73
  v_mul_f32 v74, s68, v74
  v_mul_f32 v75, s68, v75
  v_cvt_pk_bf16_f32 v48, v68, v72
  v_cvt_pk_bf16_f32 v49, v69, v73
  v_cvt_pk_bf16_f32 v50, v70, v74
  v_cvt_pk_bf16_f32 v51, v71, v75
  buffer_store_dwordx4 v[48:51], v216, s[8:11], s72 offen offset:0 sc1
  v_mul_f32 v76, s68, v76
  v_mul_f32 v77, s68, v77
  v_mul_f32 v78, s68, v78
  v_mul_f32 v79, s68, v79
  v_mul_f32 v80, s68, v80
  v_mul_f32 v81, s68, v81
  v_mul_f32 v82, s68, v82
  v_mul_f32 v83, s68, v83
  v_cvt_pk_bf16_f32 v52, v76, v80
  v_cvt_pk_bf16_f32 v53, v77, v81
  v_cvt_pk_bf16_f32 v54, v78, v82
  v_cvt_pk_bf16_f32 v55, v79, v83
  buffer_store_dwordx4 v[52:55], v216, s[8:11], s72 offen offset:256 sc1
  v_cvt_pk_bf16_f32 v56, v84, v85
  v_cvt_pk_bf16_f32 v57, v88, v89
  v_cvt_pk_bf16_f32 v58, v92, v93
  v_cvt_pk_bf16_f32 v59, v96, v97
  buffer_store_dwordx4 v[56:59], v217, s[8:11], s64 offen offset:0 sc1
  v_cvt_pk_bf16_f32 v60, v86, v87
  v_cvt_pk_bf16_f32 v61, v90, v91
  v_cvt_pk_bf16_f32 v62, v94, v95
  v_cvt_pk_bf16_f32 v63, v98, v99
  buffer_store_dwordx4 v[60:63], v217, s[8:11], s64 offen offset:256 sc1
  buffer_store_dwordx4 v[64:67], v201, s[8:11], s73 offen sc1
  s_branch KV_fin
KV_done0:
  s_nop 11
  v_mul_f32 v0, s68, v0
  v_mul_f32 v1, s68, v1
  v_mul_f32 v2, s68, v2
  v_mul_f32 v3, s68, v3
  v_mul_f32 v4, s68, v4
  v_mul_f32 v5, s68, v5
  v_mul_f32 v6, s68, v6
  v_mul_f32 v7, s68, v7
  v_cvt_pk_bf16_f32 v48, v0, v4
  v_cvt_pk_bf16_f32 v49, v1, v5
  v_cvt_pk_bf16_f32 v50, v2, v6
  v_cvt_pk_bf16_f32 v51, v3, v7
  buffer_store_dwordx4 v[48:51], v216, s[8:11], s72 offen offset:0 sc1
  v_mul_f32 v8, s68, v8
  v_mul_f32 v9, s68, v9
  v_mul_f32 v10, s68, v10
  v_mul_f32 v11, s68, v11
  v_mul_f32 v12, s68, v12
  v_mul_f32 v13, s68, v13
  v_mul_f32 v14, s68, v14
  v_mul_f32 v15, s68, v15
  v_cvt_pk_bf16_f32 v52, v8, v12
  v_cvt_pk_bf16_f32 v53, v9, v13
  v_cvt_pk_bf16_f32 v54, v10, v14
  v_cvt_pk_bf16_f32 v55, v11, v15
  buffer_store_dwordx4 v[52:55], v216, s[8:11], s72 offen offset:256 sc1
  v_cvt_pk_bf16_f32 v56, v16, v17
  v_cvt_pk_bf16_f32 v57, v20, v21
  v_cvt_pk_bf16_f32 v58, v24, v25
  v_cvt_pk_bf16_f32 v59, v28, v29
  buffer_store_dwordx4 v[56:59], v217, s[8:11], s64 offen offset:0 sc1
  v_cvt_pk_bf16_f32 v60, v18, v19
  v_cvt_pk_bf16_f32 v61, v22, v23
  v_cvt_pk_bf16_f32 v62, v26, v27
  v_cvt_pk_bf16_f32 v63, v30, v31
  buffer_store_dwordx4 v[60:63], v217, s[8:11], s64 offen offset:256 sc1
  buffer_store_dwordx4 v[64:67], v201, s[8:11], s73 offen sc1
KV_fin:
  s_waitcnt vmcnt(0)
  s_barrier
  s_cmp_eq_u32 s52, 0
  s_cbranch_scc0 KV_sig
  v_mov_b32 v211, 256
  v_mov_b32 v212, 0
  s_mov_b64 exec, 1
  buffer_atomic_add v211, v212, s[12:15], s70 offen
  s_mov_b64 exec, -1
KV_sig:
  s_cmp_ge_u32 s53, 192
  s_cbranch_scc1 L_exit
  s_cmp_lt_u32 s53, 64
  s_cbranch_scc1 W_h
  s_sub_u32 s54, s53, 64
  s_lshr_b32 s68, s54, 4
  s_and_b32 s69, s54, 15
  s_lshl_b32 s60, s69, 2
  s_sub_u32 s60, s60, 1
  s_max_i32 s60, s60, 0
  s_mul_i32 s60, s60, 36864
  s_add_u32 m0, s67, 0
  s_nop 0
  buffer_load_dwordx4 v202, s[4:7], s60 offen offset:0 lds
  s_add_u32 m0, s67, 896
  s_nop 0
  buffer_load_dwordx4 v202, s[4:7], s60 offen offset:128 lds
  s_add_u32 m0, s67, 1792
  s_nop 0
  buffer_load_dwordx4 v202, s[4:7], s60 offen offset:256 lds
  s_add_u32 m0, s67, 2688
  s_nop 0
  buffer_load_dwordx4 v202, s[4:7], s60 offen offset:384 lds
  s_add_u32 m0, s67, 3584
  s_nop 0
  buffer_load_dwordx4 v202, s[4:7], s60 offen offset:512 lds
  s_add_u32 m0, s67, 4480
  s_nop 0
  buffer_load_dwordx4 v202, s[4:7], s60 offen offset:640 lds
  s_add_u32 m0, s67, 5376
  s_nop 0
  buffer_load_dwordx4 v202, s[4:7], s60 offen offset:768 lds
  s_add_u32 m0, s67, 6272
  s_nop 0
  buffer_load_dwordx4 v202, s[4:7], s60 offen offset:896 lds
  s_add_u32 m0, s67, 7168
  s_nop 0
  buffer_load_dwordx4 v202, s[4:7], s60 offen offset:1024 lds
  v_and_b32 v211, 15, v200
  v_mul_u32_u24 v211, 72, v211
  v_lshrrev_b32 v212, 4, v200
  v_mul_u32_u24 v213, 1152, v212
  v_add_u32 v213, v213, v211
  s_lshl_b32 s54, s54, 2
  s_add_u32 s70, s54, s52
  s_mul_i32 s55, s70, 4608
  buffer_load_dwordx4 v[48:51], v213, s[4:7], s55 offen offset:0
  buffer_load_dwordx4 v[52:55], v213, s[4:7], s55 offen offset:16
  buffer_load_dwordx4 v[56:59], v213, s[4:7], s55 offen offset:32
  buffer_load_dwordx4 v[60:63], v213, s[4:7], s55 offen offset:48
  buffer_load_dwordx2 v[64:65], v213, s[4:7], s55 offen offset:64
  buffer_load_dwordx4 v[68:71], v211, s[44:47], 0 offen offset:0
  buffer_load_dwordx4 v[72:75], v211, s[44:47], 0 offen offset:16
  buffer_load_dwordx4 v[76:79], v211, s[44:47], 0 offen offset:32
  buffer_load_dwordx4 v[80:83], v211, s[44:47], 0 offen offset:48
  buffer_load_dwordx2 v[84:85], v211, s[44:47], 0 offen offset:64
  v_mov_b32 v0, 0
  v_mov_b32 v1, 0x3f803f80
  s_waitcnt vmcnt(9)
  v_lshlrev_b32 v2, 16, v48
  s_waitcnt vmcnt(4)
  v_lshlrev_b32 v3, 16, v68
  v_and_b32 v4, 0xffff0000, v48
  v_and_b32 v5, 0xffff0000, v68
  v_mul_f32 v2, v2, v3
  v_mul_f32 v4, v4, v5
  v_cvt_pk_bf16_f32 v2, v2, v4
  v_lshlrev_b32 v3, 16, v2
  v_and_b32 v4, 0xffff0000, v2
  v_add_f32 v0, v0, v3
  v_add_f32 v0, v0, v4
  v_lshlrev_b32 v2, 16, v49
  v_lshlrev_b32 v3, 16, v69
  v_and_b32 v4, 0xffff0000, v49
  v_and_b32 v5, 0xffff0000, v69
  v_mul_f32 v2, v2, v3
  v_mul_f32 v4, v4, v5
  v_cvt_pk_bf16_f32 v2, v2, v4
  v_lshlrev_b32 v3, 16, v2
  v_and_b32 v4, 0xffff0000, v2
  v_add_f32 v0, v0, v3
  v_add_f32 v0, v0, v4
  v_lshlrev_b32 v2, 16, v50
  v_lshlrev_b32 v3, 16, v70
  v_and_b32 v4, 0xffff0000, v50
  v_and_b32 v5, 0xffff0000, v70
  v_mul_f32 v2, v2, v3
  v_mul_f32 v4, v4, v5
  v_cvt_pk_bf16_f32 v2, v2, v4
  v_lshlrev_b32 v3, 16, v2
  v_and_b32 v4, 0xffff0000, v2
  v_add_f32 v0, v0, v3
  v_add_f32 v0, v0, v4
  v_lshlrev_b32 v2, 16, v51
  v_lshlrev_b32 v3, 16, v71
  v_and_b32 v4, 0xffff0000, v51
  v_and_b32 v5, 0xffff0000, v71
  v_mul_f32 v2, v2, v3
  v_mul_f32 v4, v4, v5
  v_cvt_pk_bf16_f32 v2, v2, v4
  v_lshlrev_b32 v3, 16, v2
  v_and_b32 v4, 0xffff0000, v2
  v_add_f32 v0, v0, v3
  v_add_f32 v0, v0, v4
  v_lshlrev_b32 v2, 16, v52
  s_waitcnt vmcnt(3)
  v_lshlrev_b32 v3, 16, v72
  v_and_b32 v4, 0xffff0000, v52
  v_and_b32 v5, 0xffff0000, v72
  v_mul_f32 v2, v2, v3
  v_mul_f32 v4, v4, v5
  v_cvt_pk_bf16_f32 v2, v2, v4
  v_lshlrev_b32 v3, 16, v2
  v_and_b32 v4, 0xffff0000, v2
  v_add_f32 v0, v0, v3
  v_add_f32 v0, v0, v4
  v_lshlrev_b32 v2, 16, v53
  v_lshlrev_b32 v3, 16, v73
  v_and_b32 v4, 0xffff0000, v53
  v_and_b32 v5, 0xffff0000, v73
  v_mul_f32 v2, v2, v3
  v_mul_f32 v4, v4, v5
  v_cvt_pk_bf16_f32 v2, v2, v4
  v_lshlrev_b32 v3, 16, v2
  v_and_b32 v4, 0xffff0000, v2
  v_add_f32 v0, v0, v3
  v_add_f32 v0, v0, v4
  v_lshlrev_b32 v2, 16, v54
  v_lshlrev_b32 v3, 16, v74
  v_and_b32 v4, 0xffff0000, v54
  v_and_b32 v5, 0xffff0000, v74
  v_mul_f32 v2, v2, v3
  v_mul_f32 v4, v4, v5
  v_cvt_pk_bf16_f32 v2, v2, v4
  v_lshlrev_b32 v3, 16, v2
  v_and_b32 v4, 0xffff0000, v2
  v_add_f32 v0, v0, v3
  v_add_f32 v0, v0, v4
  v_lshlrev_b32 v2, 16, v55
  v_lshlrev_b32 v3, 16, v75
  v_and_b32 v4, 0xffff0000, v55
  v_and_b32 v5, 0xffff0000, v75
  v_mul_f32 v2, v2, v3
  v_mul_f32 v4, v4, v5
  v_cvt_pk_bf16_f32 v2, v2, v4
  v_lshlrev_b32 v3, 16, v2
  v_and_b32 v4, 0xffff0000, v2
  v_add_f32 v0, v0, v3
  v_add_f32 v0, v0, v4
  v_lshlrev_b32 v2, 16, v56
  s_waitcnt vmcnt(2)
  v_lshlrev_b32 v3, 16, v76
  v_and_b32 v4, 0xffff0000, v56
  v_and_b32 v5, 0xffff0000, v76
  v_mul_f32 v2, v2, v3
  v_mul_f32 v4, v4, v5
  v_cvt_pk_bf16_f32 v2, v2, v4
  v_lshlrev_b32 v3, 16, v2
  v_and_b32 v4, 0xffff0000, v2
  v_add_f32 v0, v0, v3
  v_add_f32 v0, v0, v4
  v_lshlrev_b32 v2, 16, v57
  v_lshlrev_b32 v3, 16, v77
  v_and_b32 v4, 0xffff0000, v57
  v_and_b32 v5, 0xffff0000, v77
  v_mul_f32 v2, v2, v3
  v_mul_f32 v4, v4, v5
  v_cvt_pk_bf16_f32 v2, v2, v4
  v_lshlrev_b32 v3, 16, v2
  v_and_b32 v4, 0xffff0000, v2
  v_add_f32 v0, v0, v3
  v_add_f32 v0, v0, v4
  v_lshlrev_b32 v2, 16, v58
  v_lshlrev_b32 v3, 16, v78
  v_and_b32 v4, 0xffff0000, v58
  v_and_b32 v5, 0xffff0000, v78
  v_mul_f32 v2, v2, v3
  v_mul_f32 v4, v4, v5
  v_cvt_pk_bf16_f32 v2, v2, v4
  v_lshlrev_b32 v3, 16, v2
  v_and_b32 v4, 0xffff0000, v2
  v_add_f32 v0, v0, v3
  v_add_f32 v0, v0, v4
  v_lshlrev_b32 v2, 16, v59
  v_lshlrev_b32 v3, 16, v79
  v_and_b32 v4, 0xffff0000, v59
  v_and_b32 v5, 0xffff0000, v79
  v_mul_f32 v2, v2, v3
  v_mul_f32 v4, v4, v5
  v_cvt_pk_bf16_f32 v2, v2, v4
  v_lshlrev_b32 v3, 16, v2
  v_and_b32 v4, 0xffff0000, v2
  v_add_f32 v0, v0, v3
  v_add_f32 v0, v0, v4
  v_lshlrev_b32 v2, 16, v60
  s_waitcnt vmcnt(1)
  v_lshlrev_b32 v3, 16, v80
  v_and_b32 v4, 0xffff0000, v60
  v_and_b32 v5, 0xffff0000, v80
  v_mul_f32 v2, v2, v3
  v_mul_f32 v4, v4, v5
  v_cvt_pk_bf16_f32 v2, v2, v4
  v_lshlrev_b32 v3, 16, v2
  v_and_b32 v4, 0xffff0000, v2
  v_add_f32 v0, v0, v3
  v_add_f32 v0, v0, v4
  v_lshlrev_b32 v2, 16, v61
  v_lshlrev_b32 v3, 16, v81
  v_and_b32 v4, 0xffff0000, v61
  v_and_b32 v5, 0xffff0000, v81
  v_mul_f32 v2, v2, v3
  v_mul_f32 v4, v4, v5
  v_cvt_pk_bf16_f32 v2, v2, v4
  v_lshlrev_b32 v3, 16, v2
  v_and_b32 v4, 0xffff0000, v2
  v_add_f32 v0, v0, v3
  v_add_f32 v0, v0, v4
  v_lshlrev_b32 v2, 16, v62
  v_lshlrev_b32 v3, 16, v82
  v_and_b32 v4, 0xffff0000, v62
  v_and_b32 v5, 0xffff0000, v82
  v_mul_f32 v2, v2, v3
  v_mul_f32 v4, v4, v5
  v_cvt_pk_bf16_f32 v2, v2, v4
  v_lshlrev_b32 v3, 16, v2
  v_and_b32 v4, 0xffff0000, v2
  v_add_f32 v0, v0, v3
  v_add_f32 v0, v0, v4
  v_lshlrev_b32 v2, 16, v63
  v_lshlrev_b32 v3, 16, v83
  v_and_b32 v4, 0xffff0000, v63
  v_and_b32 v5, 0xffff0000, v83
  v_mul_f32 v2, v2, v3
  v_mul_f32 v4, v4, v5
  v_cvt_pk_bf16_f32 v2, v2, v4
  v_lshlrev_b32 v3, 16, v2
  v_and_b32 v4, 0xffff0000, v2
  v_add_f32 v0, v0, v3
  v_add_f32 v0, v0, v4
  v_lshlrev_b32 v2, 16, v64
  s_waitcnt vmcnt(0)
  v_lshlrev_b32 v3, 16, v84
  v_and_b32 v4, 0xffff0000, v64
  v_and_b32 v5, 0xffff0000, v84
  v_mul_f32 v2, v2, v3
  v_mul_f32 v4, v4, v5
  v_cvt_pk_bf16_f32 v2, v2, v4
  v_lshlrev_b32 v3, 16, v2
  v_and_b32 v4, 0xffff0000, v2
  v_add_f32 v0, v0, v3
  v_add_f32 v0, v0, v4
  v_lshlrev_b32 v2, 16, v65
  v_lshlrev_b32 v3, 16, v85
  v_and_b32 v4, 0xffff0000, v65
  v_and_b32 v5, 0xffff0000, v85
  v_mul_f32 v2, v2, v3
  v_mul_f32 v4, v4, v5
  v_cvt_pk_bf16_f32 v2, v2, v4
  v_lshlrev_b32 v3, 16, v2
  v_and_b32 v4, 0xffff0000, v2
  v_add_f32 v0, v0, v3
  v_add_f32 v0, v0, v4
  s_nop 1
  v_add_f32_dpp v0, v0, v0 row_ror:1 row_mask:0xf bank_mask:0xf
  s_nop 1
  v_add_f32_dpp v0, v0, v0 row_ror:2 row_mask:0xf bank_mask:0xf
  s_nop 1
  v_add_f32_dpp v0, v0, v0 row_ror:4 row_mask:0xf bank_mask:0xf
  s_nop 1
  v_add_f32_dpp v0, v0, v0 row_ror:8 row_mask:0xf bank_mask:0xf
  v_cvt_pk_bf16_f32 v0, v0, v0
  v_lshlrev_b32 v0, 16, v0
  v_mul_f32 v0, 3216550459, v0
  v_exp_f32 v0, v0
  s_nop 0
  v_add_f32 v0, 1.0, v0
  v_rcp_f32 v0, v0
  s_nop 0
  v_cvt_pk_bf16_f32 v0, v0, v0
  v_lshlrev_b32 v0, 16, v0
  v_lshlrev_b32 v212, 2, v212
  s_lshl_b32 s55, s70, 4
  s_add_u32 s55, s55, 66060288
  s_mov_b32 exec_lo, 0x00010001
  s_mov_b32 exec_hi, 0x00010001
  buffer_store_dword v0, v212, s[8:11], s55 offen sc1
  s_mov_b64 exec, -1
  v_lshrrev_b32 v211, 4, v200
  v_lshlrev_b32 v212, 2, v211
  v_and_b32 v213, 15, v200
  v_xor_b32 v212, v212, v213
  v_mul_u32_u24 v211, 3456, v211
  v_mov_b32 v2, 0x40000000
  v_add_u32 v213, 0, v212
  v_mul_u32_u24 v214, 57, v213
  v_lshrrev_b32 v214, 9, v214
  v_mul_u32_u24 v214, 1008, v214
  v_lshl_add_u32 v214, v213, 4, v214
  v_add_u32 v214, v214, v211
  v_cmp_lt_u32 vcc, 26, v213
  s_nop 1
  v_cndmask_b32 v207, v214, v2, vcc
  v_add_u32 v213, 16, v212
  v_mul_u32_u24 v214, 57, v213
  v_lshrrev_b32 v214, 9, v214
  v_mul_u32_u24 v214, 1008, v214
  v_lshl_add_u32 v214, v213, 4, v214
  v_add_u32 v214, v214, v211
  v_cmp_lt_u32 vcc, 26, v213
  s_nop 1
  v_cndmask_b32 v208, v214, v2, vcc
  s_mul_i32 s62, s68, 144
  s_mul_i32 s54, s52, 13824
  s_add_u32 s62, s62, s54
  s_waitcnt vmcnt(0)
  s_lshl_b32 s61, s52, 10
  s_add_u32 s61, s61, 36864
  s_add_u32 m0, s61, 0
  s_add_u32 s54, s62, 0
  buffer_load_dwordx4 v207, s[36:39], s54 offen lds
  s_add_u32 m0, s61, 4096
  s_add_u32 s54, s62, 55296
  buffer_load_dwordx4 v207, s[36:39], s54 offen lds
  s_add_u32 m0, s61, 8192
  s_add_u32 s54, s62, 110592
  buffer_load_dwordx4 v207, s[36:39], s54 offen lds
  s_add_u32 m0, s61, 12288
  s_add_u32 s54, s62, 165888
  buffer_load_dwordx4 v207, s[36:39], s54 offen lds
  s_add_u32 m0, s61, 16384
  s_add_u32 s54, s62, 0
  buffer_load_dwordx4 v208, s[36:39], s54 offen lds
  s_add_u32 m0, s61, 20480
  s_add_u32 s54, s62, 55296
  buffer_load_dwordx4 v208, s[36:39], s54 offen lds
  s_add_u32 m0, s61, 24576
  s_add_u32 s54, s62, 110592
  buffer_load_dwordx4 v208, s[36:39], s54 offen lds
  s_add_u32 m0, s61, 28672
  s_add_u32 s54, s62, 165888
  buffer_load_dwordx4 v208, s[36:39], s54 offen lds
  s_add_u32 m0, s61, 32768
  s_add_u32 s54, s62, 221184
  buffer_load_dwordx4 v207, s[36:39], s54 offen lds
  s_add_u32 m0, s61, 36864
  s_add_u32 s54, s62, 276480
  buffer_load_dwordx4 v207, s[36:39], s54 offen lds
  s_add_u32 m0, s61, 40960
  s_add_u32 s54, s62, 331776
  buffer_load_dwordx4 v207, s[36:39], s54 offen lds
  s_add_u32 m0, s61, 45056
  s_add_u32 s54, s62, 387072
  buffer_load_dwordx4 v207, s[36:39], s54 offen lds
  s_add_u32 m0, s61, 49152
  s_add_u32 s54, s62, 221184
  buffer_load_dwordx4 v208, s[36:39], s54 offen lds
  s_add_u32 m0, s61, 53248
  s_add_u32 s54, s62, 276480
  buffer_load_dwordx4 v208, s[36:39], s54 offen lds
  s_add_u32 m0, s61, 57344
  s_add_u32 s54, s62, 331776
  buffer_load_dwordx4 v208, s[36:39], s54 offen lds
  s_add_u32 m0, s61, 61440
  s_add_u32 s54, s62, 387072
  buffer_load_dwordx4 v208, s[36:39], s54 offen lds
  s_add_u32 m0, s61, 65536
  s_add_u32 s54, s62, 442368
  buffer_load_dwordx4 v207, s[36:39], s54 offen lds
  s_add_u32 m0, s61, 69632
  s_add_u32 s54, s62, 497664
  buffer_load_dwordx4 v207, s[36:39], s54 offen lds
  s_add_u32 m0, s61, 73728
  s_add_u32 s54, s62, 552960
  buffer_load_dwordx4 v207, s[36:39], s54 offen lds
  s_add_u32 m0, s61, 77824
  s_add_u32 s54, s62, 608256
  buffer_load_dwordx4 v207, s[36:39], s54 offen lds
  s_add_u32 m0, s61, 81920
  s_add_u32 s54, s62, 442368
  buffer_load_dwordx4 v208, s[36:39], s54 offen lds
  s_add_u32 m0, s61, 86016
  s_add_u32 s54, s62, 497664
  buffer_load_dwordx4 v208, s[36:39], s54 offen lds
  s_add_u32 m0, s61, 90112
  s_add_u32 s54, s62, 552960
  buffer_load_dwordx4 v208, s[36:39], s54 offen lds
  s_add_u32 m0, s61, 94208
  s_add_u32 s54, s62, 608256
  buffer_load_dwordx4 v208, s[36:39], s54 offen lds
  s_waitcnt vmcnt(20) lgkmcnt(0)
  s_barrier
  s_add_u32 m0, s61, 98304
  s_add_u32 s54, s62, 663552
  buffer_load_dwordx4 v207, s[36:39], s54 offen lds
  s_add_u32 m0, s61, 102400
  s_add_u32 s54, s62, 718848
  buffer_load_dwordx4 v207, s[36:39], s54 offen lds
  s_add_u32 m0, s61, 106496
  s_add_u32 s54, s62, 774144
  buffer_load_dwordx4 v207, s[36:39], s54 offen lds
  s_add_u32 m0, s61, 110592
  s_add_u32 s54, s62, 829440
  buffer_load_dwordx4 v207, s[36:39], s54 offen lds
  v_add_u32 v215, 36864, v210
  ds_read_b64_tr_b16 a[0:1], v215 offset:0
  ds_read_b64_tr_b16 a[2:3], v215 offset:1024
  ds_read_b64_tr_b16 a[4:5], v215 offset:4096
  ds_read_b64_tr_b16 a[6:7], v215 offset:5120
  ds_read_b64_tr_b16 a[8:9], v215 offset:8192
  ds_read_b64_tr_b16 a[10:11], v215 offset:9216
  ds_read_b64_tr_b16 a[12:13], v215 offset:12288
  ds_read_b64_tr_b16 a[14:15], v215 offset:13312
  s_waitcnt vmcnt(20) lgkmcnt(0)
  s_barrier
  s_add_u32 m0, s61, 0
  s_add_u32 s54, s62, 663552
  buffer_load_dwordx4 v208, s[36:39], s54 offen lds
  s_add_u32 m0, s61, 4096
  s_add_u32 s54, s62, 718848
  buffer_load_dwordx4 v208, s[36:39], s54 offen lds
  s_add_u32 m0, s61, 8192
  s_add_u32 s54, s62, 774144
  buffer_load_dwordx4 v208, s[36:39], s54 offen lds
  s_add_u32 m0, s61, 12288
  s_add_u32 s54, s62, 829440
  buffer_load_dwordx4 v208, s[36:39], s54 offen lds
  v_add_u32 v215, 53248, v210
  ds_read_b64_tr_b16 a[144:145], v215 offset:0
  ds_read_b64_tr_b16 a[146:147], v215 offset:1024
  ds_read_b64_tr_b16 a[148:149], v215 offset:4096
  ds_read_b64_tr_b16 a[150:151], v215 offset:5120
  ds_read_b64_tr_b16 a[152:153], v215 offset:8192
  ds_read_b64_tr_b16 a[154:155], v215 offset:9216
  ds_read_b64_tr_b16 a[156:157], v215 offset:12288
  ds_read_b64_tr_b16 a[158:159], v215 offset:13312
  s_waitcnt vmcnt(20) lgkmcnt(0)
  s_barrier
  s_add_u32 m0, s61, 16384
  s_add_u32 s54, s62, 884736
  buffer_load_dwordx4 v207, s[36:39], s54 offen lds
  s_add_u32 m0, s61, 20480
  s_add_u32 s54, s62, 940032
  buffer_load_dwordx4 v207, s[36:39], s54 offen lds
  s_add_u32 m0, s61, 24576
  s_add_u32 s54, s62, 995328
  buffer_load_dwordx4 v207, s[36:39], s54 offen lds
  s_add_u32 m0, s61, 28672
  s_add_u32 s54, s62, 1050624
  buffer_load_dwordx4 v207, s[36:39], s54 offen lds
  v_add_u32 v215, 69632, v210
  ds_read_b64_tr_b16 a[16:17], v215 offset:0
  ds_read_b64_tr_b16 a[18:19], v215 offset:1024
  ds_read_b64_tr_b16 a[20:21], v215 offset:4096
  ds_read_b64_tr_b16 a[22:23], v215 offset:5120
  ds_read_b64_tr_b16 a[24:25], v215 offset:8192
  ds_read_b64_tr_b16 a[26:27], v215 offset:9216
  ds_read_b64_tr_b16 a[28:29], v215 offset:12288
  ds_read_b64_tr_b16 a[30:31], v215 offset:13312
  s_waitcnt vmcnt(20) lgkmcnt(0)
  s_barrier
  s_add_u32 m0, s61, 32768
  s_add_u32 s54, s62, 884736
  buffer_load_dwordx4 v208, s[36:39], s54 offen lds
  s_add_u32 m0, s61, 36864
  s_add_u32 s54, s62, 940032
  buffer_load_dwordx4 v208, s[36:39], s54 offen lds
  s_add_u32 m0, s61, 40960
  s_add_u32 s54, s62, 995328
  buffer_load_dwordx4 v208, s[36:39], s54 offen lds
  s_add_u32 m0, s61, 45056
  s_add_u32 s54, s62, 1050624
  buffer_load_dwordx4 v208, s[36:39], s54 offen lds
  v_add_u32 v215, 86016, v210
  ds_read_b64_tr_b16 a[160:161], v215 offset:0
  ds_read_b64_tr_b16 a[162:163], v215 offset:1024
  ds_read_b64_tr_b16 a[164:165], v215 offset:4096
  ds_read_b64_tr_b16 a[166:167], v215 offset:5120
  ds_read_b64_tr_b16 a[168:169], v215 offset:8192
  ds_read_b64_tr_b16 a[170:171], v215 offset:9216
  ds_read_b64_tr_b16 a[172:173], v215 offset:12288
  ds_read_b64_tr_b16 a[174:175], v215 offset:13312
  s_waitcnt vmcnt(20) lgkmcnt(0)
  s_barrier
  s_add_u32 m0, s61, 49152
  s_add_u32 s54, s62, 1105920
  buffer_load_dwordx4 v207, s[36:39], s54 offen lds
  s_add_u32 m0, s61, 53248
  s_add_u32 s54, s62, 1161216
  buffer_load_dwordx4 v207, s[36:39], s54 offen lds
  s_add_u32 m0, s61, 57344
  s_add_u32 s54, s62, 1216512
  buffer_load_dwordx4 v207, s[36:39], s54 offen lds
  s_add_u32 m0, s61, 61440
  s_add_u32 s54, s62, 1271808
  buffer_load_dwordx4 v207, s[36:39], s54 offen lds
  v_add_u32 v215, 102400, v210
  ds_read_b64_tr_b16 a[32:33], v215 offset:0
  ds_read_b64_tr_b16 a[34:35], v215 offset:1024
  ds_read_b64_tr_b16 a[36:37], v215 offset:4096
  ds_read_b64_tr_b16 a[38:39], v215 offset:5120
  ds_read_b64_tr_b16 a[40:41], v215 offset:8192
  ds_read_b64_tr_b16 a[42:43], v215 offset:9216
  ds_read_b64_tr_b16 a[44:45], v215 offset:12288
  ds_read_b64_tr_b16 a[46:47], v215 offset:13312
  s_waitcnt vmcnt(20) lgkmcnt(0)
  s_barrier
  s_add_u32 m0, s61, 65536
  s_add_u32 s54, s62, 1105920
  buffer_load_dwordx4 v208, s[36:39], s54 offen lds
  s_add_u32 m0, s61, 69632
  s_add_u32 s54, s62, 1161216
  buffer_load_dwordx4 v208, s[36:39], s54 offen lds
  s_add_u32 m0, s61, 73728
  s_add_u32 s54, s62, 1216512
  buffer_load_dwordx4 v208, s[36:39], s54 offen lds
  s_add_u32 m0, s61, 77824
  s_add_u32 s54, s62, 1271808
  buffer_load_dwordx4 v208, s[36:39], s54 offen lds
  v_add_u32 v215, 118784, v210
  ds_read_b64_tr_b16 a[176:177], v215 offset:0
  ds_read_b64_tr_b16 a[178:179], v215 offset:1024
  ds_read_b64_tr_b16 a[180:181], v215 offset:4096
  ds_read_b64_tr_b16 a[182:183], v215 offset:5120
  ds_read_b64_tr_b16 a[184:185], v215 offset:8192
  ds_read_b64_tr_b16 a[186:187], v215 offset:9216
  ds_read_b64_tr_b16 a[188:189], v215 offset:12288
  ds_read_b64_tr_b16 a[190:191], v215 offset:13312
  s_waitcnt vmcnt(20) lgkmcnt(0)
  s_barrier
  s_add_u32 m0, s61, 81920
  s_add_u32 s54, s62, 1327104
  buffer_load_dwordx4 v207, s[36:39], s54 offen lds
  s_add_u32 m0, s61, 86016
  s_add_u32 s54, s62, 1382400
  buffer_load_dwordx4 v207, s[36:39], s54 offen lds
  s_add_u32 m0, s61, 90112
  s_add_u32 s54, s62, 1437696
  buffer_load_dwordx4 v207, s[36:39], s54 offen lds
  s_add_u32 m0, s61, 94208
  s_add_u32 s54, s62, 1492992
  buffer_load_dwordx4 v207, s[36:39], s54 offen lds
  v_add_u32 v215, 135168, v210
  ds_read_b64_tr_b16 a[48:49], v215 offset:0
  ds_read_b64_tr_b16 a[50:51], v215 offset:1024
  ds_read_b64_tr_b16 a[52:53], v215 offset:4096
  ds_read_b64_tr_b16 a[54:55], v215 offset:5120
  ds_read_b64_tr_b16 a[56:57], v215 offset:8192
  ds_read_b64_tr_b16 a[58:59], v215 offset:9216
  ds_read_b64_tr_b16 a[60:61], v215 offset:12288
  ds_read_b64_tr_b16 a[62:63], v215 offset:13312
  s_waitcnt vmcnt(20) lgkmcnt(0)
  s_barrier
  s_add_u32 m0, s61, 98304
  s_add_u32 s54, s62, 1327104
  buffer_load_dwordx4 v208, s[36:39], s54 offen lds
  s_add_u32 m0, s61, 102400
  s_add_u32 s54, s62, 1382400
  buffer_load_dwordx4 v208, s[36:39], s54 offen lds
  s_add_u32 m0, s61, 106496
  s_add_u32 s54, s62, 1437696
  buffer_load_dwordx4 v208, s[36:39], s54 offen lds
  s_add_u32 m0, s61, 110592
  s_add_u32 s54, s62, 1492992
  buffer_load_dwordx4 v208, s[36:39], s54 offen lds
  v_add_u32 v215, 36864, v210
  ds_read_b64_tr_b16 a[192:193], v215 offset:0
  ds_read_b64_tr_b16 a[194:195], v215 offset:1024
  ds_read_b64_tr_b16 a[196:197], v215 offset:4096
  ds_read_b64_tr_b16 a[198:199], v215 offset:5120
  ds_read_b64_tr_b16 a[200:201], v215 offset:8192
  ds_read_b64_tr_b16 a[202:203], v215 offset:9216
  ds_read_b64_tr_b16 a[204:205], v215 offset:12288
  ds_read_b64_tr_b16 a[206:207], v215 offset:13312
  s_waitcnt vmcnt(20) lgkmcnt(0)
  s_barrier
  s_add_u32 m0, s61, 0
  s_add_u32 s54, s62, 1548288
  buffer_load_dwordx4 v207, s[36:39], s54 offen lds
  s_add_u32 m0, s61, 4096
  s_add_u32 s54, s62, 1603584
  buffer_load_dwordx4 v207, s[36:39], s54 offen lds
  s_add_u32 m0, s61, 8192
  s_add_u32 s54, s62, 1658880
  buffer_load_dwordx4 v207, s[36:39], s54 offen lds
  s_add_u32 m0, s61, 12288
  s_add_u32 s54, s62, 1714176
  buffer_load_dwordx4 v207, s[36:39], s54 offen lds
  v_add_u32 v215, 53248, v210
  ds_read_b64_tr_b16 a[64:65], v215 offset:0
  ds_read_b64_tr_b16 a[66:67], v215 offset:1024
  ds_read_b64_tr_b16 a[68:69], v215 offset:4096
  ds_read_b64_tr_b16 a[70:71], v215 offset:5120
  ds_read_b64_tr_b16 a[72:73], v215 offset:8192
  ds_read_b64_tr_b16 a[74:75], v215 offset:9216
  ds_read_b64_tr_b16 a[76:77], v215 offset:12288
  ds_read_b64_tr_b16 a[78:79], v215 offset:13312
  s_waitcnt vmcnt(20) lgkmcnt(0)
  s_barrier
  s_add_u32 m0, s61, 16384
  s_add_u32 s54, s62, 1548288
  buffer_load_dwordx4 v208, s[36:39], s54 offen lds
  s_add_u32 m0, s61, 20480
  s_add_u32 s54, s62, 1603584
  buffer_load_dwordx4 v208, s[36:39], s54 offen lds
  s_add_u32 m0, s61, 24576
  s_add_u32 s54, s62, 1658880
  buffer_load_dwordx4 v208, s[36:39], s54 offen lds
  s_add_u32 m0, s61, 28672
  s_add_u32 s54, s62, 1714176
  buffer_load_dwordx4 v208, s[36:39], s54 offen lds
  v_add_u32 v215, 69632, v210
  ds_read_b64_tr_b16 a[208:209], v215 offset:0
  ds_read_b64_tr_b16 a[210:211], v215 offset:1024
  ds_read_b64_tr_b16 a[212:213], v215 offset:4096
  ds_read_b64_tr_b16 a[214:215], v215 offset:5120
  ds_read_b64_tr_b16 a[216:217], v215 offset:8192
  ds_read_b64_tr_b16 a[218:219], v215 offset:9216
  ds_read_b64_tr_b16 a[220:221], v215 offset:12288
  ds_read_b64_tr_b16 a[222:223], v215 offset:13312
  s_waitcnt vmcnt(20) lgkmcnt(0)
  s_barrier
  s_add_u32 m0, s61, 32768
  s_add_u32 s54, s62, 1769472
  buffer_load_dwordx4 v207, s[36:39], s54 offen lds
  s_add_u32 m0, s61, 36864
  s_add_u32 s54, s62, 1824768
  buffer_load_dwordx4 v207, s[36:39], s54 offen lds
  s_add_u32 m0, s61, 40960
  s_add_u32 s54, s62, 1880064
  buffer_load_dwordx4 v207, s[36:39], s54 offen lds
  s_add_u32 m0, s61, 45056
  s_add_u32 s54, s62, 1935360
  buffer_load_dwordx4 v207, s[36:39], s54 offen lds
  v_add_u32 v215, 86016, v210
  ds_read_b64_tr_b16 a[80:81], v215 offset:0
  ds_read_b64_tr_b16 a[82:83], v215 offset:1024
  ds_read_b64_tr_b16 a[84:85], v215 offset:4096
  ds_read_b64_tr_b16 a[86:87], v215 offset:5120
  ds_read_b64_tr_b16 a[88:89], v215 offset:8192
  ds_read_b64_tr_b16 a[90:91], v215 offset:9216
  ds_read_b64_tr_b16 a[92:93], v215 offset:12288
  ds_read_b64_tr_b16 a[94:95], v215 offset:13312
  s_waitcnt vmcnt(20) lgkmcnt(0)
  s_barrier
  s_add_u32 m0, s61, 49152
  s_add_u32 s54, s62, 1769472
  buffer_load_dwordx4 v208, s[36:39], s54 offen lds
  s_add_u32 m0, s61, 53248
  s_add_u32 s54, s62, 1824768
  buffer_load_dwordx4 v208, s[36:39], s54 offen lds
  s_add_u32 m0, s61, 57344
  s_add_u32 s54, s62, 1880064
  buffer_load_dwordx4 v208, s[36:39], s54 offen lds
  s_add_u32 m0, s61, 61440
  s_add_u32 s54, s62, 1935360
  buffer_load_dwordx4 v208, s[36:39], s54 offen lds
  v_add_u32 v215, 102400, v210
  ds_read_b64_tr_b16 a[224:225], v215 offset:0
  ds_read_b64_tr_b16 a[226:227], v215 offset:1024
  ds_read_b64_tr_b16 a[228:229], v215 offset:4096
  ds_read_b64_tr_b16 a[230:231], v215 offset:5120
  ds_read_b64_tr_b16 a[232:233], v215 offset:8192
  ds_read_b64_tr_b16 a[234:235], v215 offset:9216
  ds_read_b64_tr_b16 a[236:237], v215 offset:12288
  ds_read_b64_tr_b16 a[238:239], v215 offset:13312
  s_waitcnt vmcnt(20) lgkmcnt(0)
  s_barrier
  v_add_u32 v215, 118784, v210
  ds_read_b64_tr_b16 a[96:97], v215 offset:0
  ds_read_b64_tr_b16 a[98:99], v215 offset:1024
  ds_read_b64_tr_b16 a[100:101], v215 offset:4096
  ds_read_b64_tr_b16 a[102:103], v215 offset:5120
  ds_read_b64_tr_b16 a[104:105], v215 offset:8192
  ds_read_b64_tr_b16 a[106:107], v215 offset:9216
  ds_read_b64_tr_b16 a[108:109], v215 offset:12288
  ds_read_b64_tr_b16 a[110:111], v215 offset:13312
  s_waitcnt vmcnt(16) lgkmcnt(0)
  s_barrier
  v_add_u32 v215, 135168, v210
  ds_read_b64_tr_b16 a[240:241], v215 offset:0
  ds_read_b64_tr_b16 a[242:243], v215 offset:1024
  ds_read_b64_tr_b16 a[244:245], v215 offset:4096
  ds_read_b64_tr_b16 a[246:247], v215 offset:5120
  ds_read_b64_tr_b16 a[248:249], v215 offset:8192
  ds_read_b64_tr_b16 a[250:251], v215 offset:9216
  ds_read_b64_tr_b16 a[252:253], v215 offset:12288
  ds_read_b64_tr_b16 a[254:255], v215 offset:13312
  s_waitcnt vmcnt(12) lgkmcnt(0)
  s_barrier
  v_add_u32 v215, 36864, v210
  ds_read_b64_tr_b16 a[112:113], v215 offset:0
  ds_read_b64_tr_b16 a[114:115], v215 offset:1024
  ds_read_b64_tr_b16 a[116:117], v215 offset:4096
  ds_read_b64_tr_b16 a[118:119], v215 offset:5120
  ds_read_b64_tr_b16 a[120:121], v215 offset:8192
  ds_read_b64_tr_b16 a[122:123], v215 offset:9216
  ds_read_b64_tr_b16 a[124:125], v215 offset:12288
  ds_read_b64_tr_b16 a[126:127], v215 offset:13312
  s_waitcnt vmcnt(8) lgkmcnt(0)
  s_barrier
  v_add_u32 v215, 53248, v210
  ds_read_b64_tr_b16 v[224:225], v215 offset:0
  ds_read_b64_tr_b16 v[226:227], v215 offset:1024
  ds_read_b64_tr_b16 v[228:229], v215 offset:4096
  ds_read_b64_tr_b16 v[230:231], v215 offset:5120
  ds_read_b64_tr_b16 v[232:233], v215 offset:8192
  ds_read_b64_tr_b16 v[234:235], v215 offset:9216
  ds_read_b64_tr_b16 v[236:237], v215 offset:12288
  ds_read_b64_tr_b16 v[238:239], v215 offset:13312
  s_waitcnt vmcnt(4) lgkmcnt(0)
  s_barrier
  v_add_u32 v215, 69632, v210
  ds_read_b64_tr_b16 a[128:129], v215 offset:0
  ds_read_b64_tr_b16 a[130:131], v215 offset:1024
  ds_read_b64_tr_b16 a[132:133], v215 offset:4096
  ds_read_b64_tr_b16 a[134:135], v215 offset:5120
  ds_read_b64_tr_b16 a[136:137], v215 offset:8192
  ds_read_b64_tr_b16 a[138:139], v215 offset:9216
  ds_read_b64_tr_b16 a[140:141], v215 offset:12288
  ds_read_b64_tr_b16 a[142:143], v215 offset:13312
  s_waitcnt vmcnt(0) lgkmcnt(0)
  s_barrier
  v_add_u32 v215, 86016, v210
  ds_read_b64_tr_b16 v[240:241], v215 offset:0
  ds_read_b64_tr_b16 v[242:243], v215 offset:1024
  ds_read_b64_tr_b16 v[244:245], v215 offset:4096
  ds_read_b64_tr_b16 v[246:247], v215 offset:5120
  ds_read_b64_tr_b16 v[248:249], v215 offset:8192
  ds_read_b64_tr_b16 v[250:251], v215 offset:9216
  ds_read_b64_tr_b16 v[252:253], v215 offset:12288
  ds_read_b64_tr_b16 v[254:255], v215 offset:13312
  s_waitcnt lgkmcnt(0)
  s_barrier
  v_and_b32 v211, 31, v200
  v_mul_u32_u24 v218, 516, v211
  v_lshrrev_b32 v212, 5, v200
  v_lshl_add_u32 v218, v212, 3, v218
  s_lshl_b32 s54, s52, 6
  s_add_u32 s54, s54, 73728
  v_add_u32 v218, s54, v218
  s_lshl_b32 s60, s69, 2
  s_mul_i32 s60, s60, 36864
  ds_read_b128 v[32:35], v203 offset:0
  ds_read_b128 v[36:39], v204 offset:0
  ds_read_b128 v[40:43], v205 offset:0
  s_waitcnt lgkmcnt(2)
  v_mfma_f32_32x32x16_bf16 v[0:15], a[0:3], v[32:35], 0
  ds_read_b128 v[44:47], v206 offset:0
  s_add_u32 m0, s67, 36864
  s_nop 0
  buffer_load_dwordx4 v202, s[4:7], s60 offen offset:0 lds
  v_mfma_f32_32x32x16_bf16 v[16:31], a[144:147], v[32:35], 0
  s_waitcnt lgkmcnt(2)
  v_mfma_f32_32x32x16_bf16 v[0:15], a[4:7], v[36:39], v[0:15]
  ds_read_b128 v[32:35], v203 offset:1024
  s_add_u32 m0, s67, 37760
  s_nop 0
  buffer_load_dwordx4 v202, s[4:7], s60 offen offset:128 lds
  v_mfma_f32_32x32x16_bf16 v[16:31], a[148:151], v[36:39], v[16:31]
  s_waitcnt lgkmcnt(2)
  v_mfma_f32_32x32x16_bf16 v[0:15], a[8:11], v[40:43], v[0:15]
  ds_read_b128 v[36:39], v204 offset:1024
  s_add_u32 m0, s67, 38656
  s_nop 0
  buffer_load_dwordx4 v202, s[4:7], s60 offen offset:256 lds
  v_mfma_f32_32x32x16_bf16 v[16:31], a[152:155], v[40:43], v[16:31]
  s_waitcnt lgkmcnt(2)
  v_mfma_f32_32x32x16_bf16 v[0:15], a[12:15], v[44:47], v[0:15]
  ds_read_b128 v[40:43], v205 offset:1024
  s_add_u32 m0, s67, 39552
  s_nop 0
  buffer_load_dwordx4 v202, s[4:7], s60 offen offset:384 lds
  v_mfma_f32_32x32x16_bf16 v[16:31], a[156:159], v[44:47], v[16:31]
  s_waitcnt lgkmcnt(2)
  v_mfma_f32_32x32x16_bf16 v[0:15], a[16:19], v[32:35], v[0:15]
  ds_read_b128 v[44:47], v206 offset:1024
  s_add_u32 m0, s67, 40448
  s_nop 0
  buffer_load_dwordx4 v202, s[4:7], s60 offen offset:512 lds
  v_mfma_f32_32x32x16_bf16 v[16:31], a[160:163], v[32:35], v[16:31]
  s_waitcnt lgkmcnt(2)
  v_mfma_f32_32x32x16_bf16 v[0:15], a[20:23], v[36:39], v[0:15]
  ds_read_b128 v[32:35], v203 offset:2048
  s_add_u32 m0, s67, 41344
  s_nop 0
  buffer_load_dwordx4 v202, s[4:7], s60 offen offset:640 lds
  v_mfma_f32_32x32x16_bf16 v[16:31], a[164:167], v[36:39], v[16:31]
  s_waitcnt lgkmcnt(2)
  v_mfma_f32_32x32x16_bf16 v[0:15], a[24:27], v[40:43], v[0:15]
  ds_read_b128 v[36:39], v204 offset:2048
  s_add_u32 m0, s67, 42240
  s_nop 0
  buffer_load_dwordx4 v202, s[4:7], s60 offen offset:768 lds
  v_mfma_f32_32x32x16_bf16 v[16:31], a[168:171], v[40:43], v[16:31]
  s_waitcnt lgkmcnt(2)
  v_mfma_f32_32x32x16_bf16 v[0:15], a[28:31], v[44:47], v[0:15]
  ds_read_b128 v[40:43], v205 offset:2048
  s_add_u32 m0, s67, 43136
  s_nop 0
  buffer_load_dwordx4 v202, s[4:7], s60 offen offset:896 lds
  v_mfma_f32_32x32x16_bf16 v[16:31], a[172:175], v[44:47], v[16:31]
  s_waitcnt lgkmcnt(2)
  v_mfma_f32_32x32x16_bf16 v[0:15], a[32:35], v[32:35], v[0:15]
  ds_read_b128 v[44:47], v206 offset:2048
  s_add_u32 m0, s67, 44032
  s_nop 0
  buffer_load_dwordx4 v202, s[4:7], s60 offen offset:1024 lds
  v_mfma_f32_32x32x16_bf16 v[16:31], a[176:179], v[32:35], v[16:31]
  s_waitcnt lgkmcnt(2)
  v_mfma_f32_32x32x16_bf16 v[0:15], a[36:39], v[36:39], v[0:15]
  ds_read_b128 v[32:35], v203 offset:3072
  v_mfma_f32_32x32x16_bf16 v[16:31], a[180:183], v[36:39], v[16:31]
  s_waitcnt lgkmcnt(2)
  v_mfma_f32_32x32x16_bf16 v[0:15], a[40:43], v[40:43], v[0:15]
  ds_read_b128 v[36:39], v204 offset:3072
  v_mfma_f32_32x32x16_bf16 v[16:31], a[184:187], v[40:43], v[16:31]
  s_waitcnt lgkmcnt(2)
  v_mfma_f32_32x32x16_bf16 v[0:15], a[44:47], v[44:47], v[0:15]
  ds_read_b128 v[40:43], v205 offset:3072
  v_mfma_f32_32x32x16_bf16 v[16:31], a[188:191], v[44:47], v[16:31]
  s_waitcnt lgkmcnt(2)
  v_mfma_f32_32x32x16_bf16 v[0:15], a[48:51], v[32:35], v[0:15]
  ds_read_b128 v[44:47], v206 offset:3072
  v_mfma_f32_32x32x16_bf16 v[16:31], a[192:195], v[32:35], v[16:31]
  s_waitcnt lgkmcnt(2)
  v_mfma_f32_32x32x16_bf16 v[0:15], a[52:55], v[36:39], v[0:15]
  ds_read_b128 v[32:35], v203 offset:4096
  v_mfma_f32_32x32x16_bf16 v[16:31], a[196:199], v[36:39], v[16:31]
  s_waitcnt lgkmcnt(2)
  v_mfma_f32_32x32x16_bf16 v[0:15], a[56:59], v[40:43], v[0:15]
  ds_read_b128 v[36:39], v204 offset:4096
  v_mfma_f32_32x32x16_bf16 v[16:31], a[200:203], v[40:43], v[16:31]
  s_waitcnt lgkmcnt(2)
  v_mfma_f32_32x32x16_bf16 v[0:15], a[60:63], v[44:47], v[0:15]
  ds_read_b128 v[40:43], v205 offset:4096
  v_mfma_f32_32x32x16_bf16 v[16:31], a[204:207], v[44:47], v[16:31]
  s_waitcnt lgkmcnt(2)
  v_mfma_f32_32x32x16_bf16 v[0:15], a[64:67], v[32:35], v[0:15]
  ds_read_b128 v[44:47], v206 offset:4096
  v_mfma_f32_32x32x16_bf16 v[16:31], a[208:211], v[32:35], v[16:31]
  s_waitcnt lgkmcnt(2)
  v_mfma_f32_32x32x16_bf16 v[0:15], a[68:71], v[36:39], v[0:15]
  ds_read_b128 v[32:35], v203 offset:5120
  v_mfma_f32_32x32x16_bf16 v[16:31], a[212:215], v[36:39], v[16:31]
  s_waitcnt lgkmcnt(2)
  v_mfma_f32_32x32x16_bf16 v[0:15], a[72:75], v[40:43], v[0:15]
  ds_read_b128 v[36:39], v204 offset:5120
  v_mfma_f32_32x32x16_bf16 v[16:31], a[216:219], v[40:43], v[16:31]
  s_waitcnt lgkmcnt(2)
  v_mfma_f32_32x32x16_bf16 v[0:15], a[76:79], v[44:47], v[0:15]
  ds_read_b128 v[40:43], v205 offset:5120
  v_mfma_f32_32x32x16_bf16 v[16:31], a[220:223], v[44:47], v[16:31]
  s_waitcnt lgkmcnt(2)
  v_mfma_f32_32x32x16_bf16 v[0:15], a[80:83], v[32:35], v[0:15]
  ds_read_b128 v[44:47], v206 offset:5120
  v_mfma_f32_32x32x16_bf16 v[16:31], a[224:227], v[32:35], v[16:31]
  s_waitcnt lgkmcnt(2)
  v_mfma_f32_32x32x16_bf16 v[0:15], a[84:87], v[36:39], v[0:15]
  ds_read_b128 v[32:35], v203 offset:6144
  v_mfma_f32_32x32x16_bf16 v[16:31], a[228:231], v[36:39], v[16:31]
  s_waitcnt lgkmcnt(2)
  v_mfma_f32_32x32x16_bf16 v[0:15], a[88:91], v[40:43], v[0:15]
  ds_read_b128 v[36:39], v204 offset:6144
  v_mfma_f32_32x32x16_bf16 v[16:31], a[232:235], v[40:43], v[16:31]
  s_waitcnt lgkmcnt(2)
  v_mfma_f32_32x32x16_bf16 v[0:15], a[92:95], v[44:47], v[0:15]
  ds_read_b128 v[40:43], v205 offset:6144
  v_mfma_f32_32x32x16_bf16 v[16:31], a[236:239], v[44:47], v[16:31]
  s_waitcnt lgkmcnt(2)
  v_mfma_f32_32x32x16_bf16 v[0:15], a[96:99], v[32:35], v[0:15]
  ds_read_b128 v[44:47], v206 offset:6144
  v_mfma_f32_32x32x16_bf16 v[16:31], a[240:243], v[32:35], v[16:31]
  s_waitcnt lgkmcnt(2)
  v_mfma_f32_32x32x16_bf16 v[0:15], a[100:103], v[36:39], v[0:15]
  ds_read_b128 v[32:35], v203 offset:7168
  v_mfma_f32_32x32x16_bf16 v[16:31], a[244:247], v[36:39], v[16:31]
  s_waitcnt lgkmcnt(2)
  v_mfma_f32_32x32x16_bf16 v[0:15], a[104:107], v[40:43], v[0:15]
  ds_read_b128 v[36:39], v204 offset:7168
  v_mfma_f32_32x32x16_bf16 v[16:31], a[248:251], v[40:43], v[16:31]
  s_waitcnt lgkmcnt(2)
  v_mfma_f32_32x32x16_bf16 v[0:15], a[108:111], v[44:47], v[0:15]
  ds_read_b128 v[40:43], v205 offset:7168
  v_mfma_f32_32x32x16_bf16 v[16:31], a[252:255], v[44:47], v[16:31]
  s_waitcnt lgkmcnt(2)
  v_mfma_f32_32x32x16_bf16 v[0:15], a[112:115], v[32:35], v[0:15]
  ds_read_b128 v[44:47], v206 offset:7168
  v_mfma_f32_32x32x16_bf16 v[16:31], v[224:227], v[32:35], v[16:31]
  s_waitcnt lgkmcnt(2)
  v_mfma_f32_32x32x16_bf16 v[0:15], a[116:119], v[36:39], v[0:15]
  ds_read_b128 v[32:35], v203 offset:8192
  v_mfma_f32_32x32x16_bf16 v[16:31], v[228:231], v[36:39], v[16:31]
  s_waitcnt lgkmcnt(2)
  v_mfma_f32_32x32x16_bf16 v[0:15], a[120:123], v[40:43], v[0:15]
  ds_read_b128 v[36:39], v204 offset:8192
  v_mfma_f32_32x32x16_bf16 v[16:31], v[232:235], v[40:43], v[16:31]
  s_waitcnt lgkmcnt(2)
  v_mfma_f32_32x32x16_bf16 v[0:15], a[124:127], v[44:47], v[0:15]
  ds_read_b128 v[40:43], v205 offset:8192
  v_mfma_f32_32x32x16_bf16 v[16:31], v[236:239], v[44:47], v[16:31]
  s_waitcnt lgkmcnt(2)
  v_mfma_f32_32x32x16_bf16 v[0:15], a[128:131], v[32:35], v[0:15]
  ds_read_b128 v[44:47], v206 offset:8192
  v_mfma_f32_32x32x16_bf16 v[16:31], v[240:243], v[32:35], v[16:31]
  s_waitcnt lgkmcnt(2)
  v_mfma_f32_32x32x16_bf16 v[0:15], a[132:135], v[36:39], v[0:15]
  v_mfma_f32_32x32x16_bf16 v[16:31], v[244:247], v[36:39], v[16:31]
  s_waitcnt lgkmcnt(1)
  v_mfma_f32_32x32x16_bf16 v[0:15], a[136:139], v[40:43], v[0:15]
  v_mfma_f32_32x32x16_bf16 v[16:31], v[248:251], v[40:43], v[16:31]
  s_waitcnt lgkmcnt(0)
  v_mfma_f32_32x32x16_bf16 v[0:15], a[140:143], v[44:47], v[0:15]
  v_mfma_f32_32x32x16_bf16 v[16:31], v[252:255], v[44:47], v[16:31]
  s_add_u32 s60, s60, 36864
  s_nop 2
  v_cvt_pk_bf16_f32 v48, v0, v1
  v_cvt_pk_bf16_f32 v49, v2, v3
  ds_write2_b32 v218, v48, v49 offset0:0 offset1:1
  v_cvt_pk_bf16_f32 v48, v4, v5
  v_cvt_pk_bf16_f32 v49, v6, v7
  ds_write2_b32 v218, v48, v49 offset0:4 offset1:5
  v_cvt_pk_bf16_f32 v48, v8, v9
  v_cvt_pk_bf16_f32 v49, v10, v11
  ds_write2_b32 v218, v48, v49 offset0:8 offset1:9
  v_cvt_pk_bf16_f32 v48, v12, v13
  v_cvt_pk_bf16_f32 v49, v14, v15
  ds_write2_b32 v218, v48, v49 offset0:12 offset1:13
  v_cvt_pk_bf16_f32 v48, v16, v17
  v_cvt_pk_bf16_f32 v49, v18, v19
  ds_write2_b32 v218, v48, v49 offset0:64 offset1:65
  v_cvt_pk_bf16_f32 v48, v20, v21
  v_cvt_pk_bf16_f32 v49, v22, v23
  ds_write2_b32 v218, v48, v49 offset0:68 offset1:69
  v_cvt_pk_bf16_f32 v48, v24, v25
  v_cvt_pk_bf16_f32 v49, v26, v27
  ds_write2_b32 v218, v48, v49 offset0:72 offset1:73
  v_cvt_pk_bf16_f32 v48, v28, v29
  v_cvt_pk_bf16_f32 v49, v30, v31
  ds_write2_b32 v218, v48, v49 offset0:76 offset1:77
  v_add_u32 v218, 16512, v218
  s_waitcnt vmcnt(0) lgkmcnt(0)
  s_barrier
  ds_read_b128 v[32:35], v203 offset:36864
  ds_read_b128 v[36:39], v204 offset:36864
  ds_read_b128 v[40:43], v205 offset:36864
  s_waitcnt lgkmcnt(2)
  v_mfma_f32_32x32x16_bf16 v[0:15], a[0:3], v[32:35], 0
  ds_read_b128 v[44:47], v206 offset:36864
  s_add_u32 m0, s67, 0
  s_nop 0
  buffer_load_dwordx4 v202, s[4:7], s60 offen offset:0 lds
  v_mfma_f32_32x32x16_bf16 v[16:31], a[144:147], v[32:35], 0
  s_waitcnt lgkmcnt(2)
  v_mfma_f32_32x32x16_bf16 v[0:15], a[4:7], v[36:39], v[0:15]
  ds_read_b128 v[32:35], v203 offset:37888
  s_add_u32 m0, s67, 896
  s_nop 0
  buffer_load_dwordx4 v202, s[4:7], s60 offen offset:128 lds
  v_mfma_f32_32x32x16_bf16 v[16:31], a[148:151], v[36:39], v[16:31]
  s_waitcnt lgkmcnt(2)
  v_mfma_f32_32x32x16_bf16 v[0:15], a[8:11], v[40:43], v[0:15]
  ds_read_b128 v[36:39], v204 offset:37888
  s_add_u32 m0, s67, 1792
  s_nop 0
  buffer_load_dwordx4 v202, s[4:7], s60 offen offset:256 lds
  v_mfma_f32_32x32x16_bf16 v[16:31], a[152:155], v[40:43], v[16:31]
  s_waitcnt lgkmcnt(2)
  v_mfma_f32_32x32x16_bf16 v[0:15], a[12:15], v[44:47], v[0:15]
  ds_read_b128 v[40:43], v205 offset:37888
  s_add_u32 m0, s67, 2688
  s_nop 0
  buffer_load_dwordx4 v202, s[4:7], s60 offen offset:384 lds
  v_mfma_f32_32x32x16_bf16 v[16:31], a[156:159], v[44:47], v[16:31]
  s_waitcnt lgkmcnt(2)
  v_mfma_f32_32x32x16_bf16 v[0:15], a[16:19], v[32:35], v[0:15]
  ds_read_b128 v[44:47], v206 offset:37888
  s_add_u32 m0, s67, 3584
  s_nop 0
  buffer_load_dwordx4 v202, s[4:7], s60 offen offset:512 lds
  v_mfma_f32_32x32x16_bf16 v[16:31], a[160:163], v[32:35], v[16:31]
  s_waitcnt lgkmcnt(2)
  v_mfma_f32_32x32x16_bf16 v[0:15], a[20:23], v[36:39], v[0:15]
  ds_read_b128 v[32:35], v203 offset:38912
  s_add_u32 m0, s67, 4480
  s_nop 0
  buffer_load_dwordx4 v202, s[4:7], s60 offen offset:640 lds
  v_mfma_f32_32x32x16_bf16 v[16:31], a[164:167], v[36:39], v[16:31]
  s_waitcnt lgkmcnt(2)
  v_mfma_f32_32x32x16_bf16 v[0:15], a[24:27], v[40:43], v[0:15]
  ds_read_b128 v[36:39], v204 offset:38912
  s_add_u32 m0, s67, 5376
  s_nop 0
  buffer_load_dwordx4 v202, s[4:7], s60 offen offset:768 lds
  v_mfma_f32_32x32x16_bf16 v[16:31], a[168:171], v[40:43], v[16:31]
  s_waitcnt lgkmcnt(2)
  v_mfma_f32_32x32x16_bf16 v[0:15], a[28:31], v[44:47], v[0:15]
  ds_read_b128 v[40:43], v205 offset:38912
  s_add_u32 m0, s67, 6272
  s_nop 0
  buffer_load_dwordx4 v202, s[4:7], s60 offen offset:896 lds
  v_mfma_f32_32x32x16_bf16 v[16:31], a[172:175], v[44:47], v[16:31]
  s_waitcnt lgkmcnt(2)
  v_mfma_f32_32x32x16_bf16 v[0:15], a[32:35], v[32:35], v[0:15]
  ds_read_b128 v[44:47], v206 offset:38912
  s_add_u32 m0, s67, 7168
  s_nop 0
  buffer_load_dwordx4 v202, s[4:7], s60 offen offset:1024 lds
  v_mfma_f32_32x32x16_bf16 v[16:31], a[176:179], v[32:35], v[16:31]
  s_waitcnt lgkmcnt(2)
  v_mfma_f32_32x32x16_bf16 v[0:15], a[36:39], v[36:39], v[0:15]
  ds_read_b128 v[32:35], v203 offset:39936
  v_mfma_f32_32x32x16_bf16 v[16:31], a[180:183], v[36:39], v[16:31]
  s_waitcnt lgkmcnt(2)
  v_mfma_f32_32x32x16_bf16 v[0:15], a[40:43], v[40:43], v[0:15]
  ds_read_b128 v[36:39], v204 offset:39936
  v_mfma_f32_32x32x16_bf16 v[16:31], a[184:187], v[40:43], v[16:31]
  s_waitcnt lgkmcnt(2)
  v_mfma_f32_32x32x16_bf16 v[0:15], a[44:47], v[44:47], v[0:15]
  ds_read_b128 v[40:43], v205 offset:39936
  v_mfma_f32_32x32x16_bf16 v[16:31], a[188:191], v[44:47], v[16:31]
  s_waitcnt lgkmcnt(2)
  v_mfma_f32_32x32x16_bf16 v[0:15], a[48:51], v[32:35], v[0:15]
  ds_read_b128 v[44:47], v206 offset:39936
  v_mfma_f32_32x32x16_bf16 v[16:31], a[192:195], v[32:35], v[16:31]
  s_waitcnt lgkmcnt(2)
  v_mfma_f32_32x32x16_bf16 v[0:15], a[52:55], v[36:39], v[0:15]
  ds_read_b128 v[32:35], v203 offset:40960
  v_mfma_f32_32x32x16_bf16 v[16:31], a[196:199], v[36:39], v[16:31]
  s_waitcnt lgkmcnt(2)
  v_mfma_f32_32x32x16_bf16 v[0:15], a[56:59], v[40:43], v[0:15]
  ds_read_b128 v[36:39], v204 offset:40960
  v_mfma_f32_32x32x16_bf16 v[16:31], a[200:203], v[40:43], v[16:31]
  s_waitcnt lgkmcnt(2)
  v_mfma_f32_32x32x16_bf16 v[0:15], a[60:63], v[44:47], v[0:15]
  ds_read_b128 v[40:43], v205 offset:40960
  v_mfma_f32_32x32x16_bf16 v[16:31], a[204:207], v[44:47], v[16:31]
  s_waitcnt lgkmcnt(2)
  v_mfma_f32_32x32x16_bf16 v[0:15], a[64:67], v[32:35], v[0:15]
  ds_read_b128 v[44:47], v206 offset:40960
  v_mfma_f32_32x32x16_bf16 v[16:31], a[208:211], v[32:35], v[16:31]
  s_waitcnt lgkmcnt(2)
  v_mfma_f32_32x32x16_bf16 v[0:15], a[68:71], v[36:39], v[0:15]
  ds_read_b128 v[32:35], v203 offset:41984
  v_mfma_f32_32x32x16_bf16 v[16:31], a[212:215], v[36:39], v[16:31]
  s_waitcnt lgkmcnt(2)
  v_mfma_f32_32x32x16_bf16 v[0:15], a[72:75], v[40:43], v[0:15]
  ds_read_b128 v[36:39], v204 offset:41984
  v_mfma_f32_32x32x16_bf16 v[16:31], a[216:219], v[40:43], v[16:31]
  s_waitcnt lgkmcnt(2)
  v_mfma_f32_32x32x16_bf16 v[0:15], a[76:79], v[44:47], v[0:15]
  ds_read_b128 v[40:43], v205 offset:41984
  v_mfma_f32_32x32x16_bf16 v[16:31], a[220:223], v[44:47], v[16:31]
  s_waitcnt lgkmcnt(2)
  v_mfma_f32_32x32x16_bf16 v[0:15], a[80:83], v[32:35], v[0:15]
  ds_read_b128 v[44:47], v206 offset:41984
  v_mfma_f32_32x32x16_bf16 v[16:31], a[224:227], v[32:35], v[16:31]
  s_waitcnt lgkmcnt(2)
  v_mfma_f32_32x32x16_bf16 v[0:15], a[84:87], v[36:39], v[0:15]
  ds_read_b128 v[32:35], v203 offset:43008
  v_mfma_f32_32x32x16_bf16 v[16:31], a[228:231], v[36:39], v[16:31]
  s_waitcnt lgkmcnt(2)
  v_mfma_f32_32x32x16_bf16 v[0:15], a[88:91], v[40:43], v[0:15]
  ds_read_b128 v[36:39], v204 offset:43008
  v_mfma_f32_32x32x16_bf16 v[16:31], a[232:235], v[40:43], v[16:31]
  s_waitcnt lgkmcnt(2)
  v_mfma_f32_32x32x16_bf16 v[0:15], a[92:95], v[44:47], v[0:15]
  ds_read_b128 v[40:43], v205 offset:43008
  v_mfma_f32_32x32x16_bf16 v[16:31], a[236:239], v[44:47], v[16:31]
  s_waitcnt lgkmcnt(2)
  v_mfma_f32_32x32x16_bf16 v[0:15], a[96:99], v[32:35], v[0:15]
  ds_read_b128 v[44:47], v206 offset:43008
  v_mfma_f32_32x32x16_bf16 v[16:31], a[240:243], v[32:35], v[16:31]
  s_waitcnt lgkmcnt(2)
  v_mfma_f32_32x32x16_bf16 v[0:15], a[100:103], v[36:39], v[0:15]
  ds_read_b128 v[32:35], v203 offset:44032
  v_mfma_f32_32x32x16_bf16 v[16:31], a[244:247], v[36:39], v[16:31]
  s_waitcnt lgkmcnt(2)
  v_mfma_f32_32x32x16_bf16 v[0:15], a[104:107], v[40:43], v[0:15]
  ds_read_b128 v[36:39], v204 offset:44032
  v_mfma_f32_32x32x16_bf16 v[16:31], a[248:251], v[40:43], v[16:31]
  s_waitcnt lgkmcnt(2)
  v_mfma_f32_32x32x16_bf16 v[0:15], a[108:111], v[44:47], v[0:15]
  ds_read_b128 v[40:43], v205 offset:44032
  v_mfma_f32_32x32x16_bf16 v[16:31], a[252:255], v[44:47], v[16:31]
  s_waitcnt lgkmcnt(2)
  v_mfma_f32_32x32x16_bf16 v[0:15], a[112:115], v[32:35], v[0:15]
  ds_read_b128 v[44:47], v206 offset:44032
  v_mfma_f32_32x32x16_bf16 v[16:31], v[224:227], v[32:35], v[16:31]
  s_waitcnt lgkmcnt(2)
  v_mfma_f32_32x32x16_bf16 v[0:15], a[116:119], v[36:39], v[0:15]
  ds_read_b128 v[32:35], v203 offset:45056
  v_mfma_f32_32x32x16_bf16 v[16:31], v[228:231], v[36:39], v[16:31]
  s_waitcnt lgkmcnt(2)
  v_mfma_f32_32x32x16_bf16 v[0:15], a[120:123], v[40:43], v[0:15]
  ds_read_b128 v[36:39], v204 offset:45056
  v_mfma_f32_32x32x16_bf16 v[16:31], v[232:235], v[40:43], v[16:31]
  s_waitcnt lgkmcnt(2)
  v_mfma_f32_32x32x16_bf16 v[0:15], a[124:127], v[44:47], v[0:15]
  ds_read_b128 v[40:43], v205 offset:45056
  v_mfma_f32_32x32x16_bf16 v[16:31], v[236:239], v[44:47], v[16:31]
  s_waitcnt lgkmcnt(2)
  v_mfma_f32_32x32x16_bf16 v[0:15], a[128:131], v[32:35], v[0:15]
  ds_read_b128 v[44:47], v206 offset:45056
  v_mfma_f32_32x32x16_bf16 v[16:31], v[240:243], v[32:35], v[16:31]
  s_waitcnt lgkmcnt(2)
  v_mfma_f32_32x32x16_bf16 v[0:15], a[132:135], v[36:39], v[0:15]
  v_mfma_f32_32x32x16_bf16 v[16:31], v[244:247], v[36:39], v[16:31]
  s_waitcnt lgkmcnt(1)
  v_mfma_f32_32x32x16_bf16 v[0:15], a[136:139], v[40:43], v[0:15]
  v_mfma_f32_32x32x16_bf16 v[16:31], v[248:251], v[40:43], v[16:31]
  s_waitcnt lgkmcnt(0)
  v_mfma_f32_32x32x16_bf16 v[0:15], a[140:143], v[44:47], v[0:15]
  v_mfma_f32_32x32x16_bf16 v[16:31], v[252:255], v[44:47], v[16:31]
  s_add_u32 s60, s60, 36864
  s_nop 2
  v_cvt_pk_bf16_f32 v48, v0, v1
  v_cvt_pk_bf16_f32 v49, v2, v3
  ds_write2_b32 v218, v48, v49 offset0:0 offset1:1
  v_cvt_pk_bf16_f32 v48, v4, v5
  v_cvt_pk_bf16_f32 v49, v6, v7
  ds_write2_b32 v218, v48, v49 offset0:4 offset1:5
  v_cvt_pk_bf16_f32 v48, v8, v9
  v_cvt_pk_bf16_f32 v49, v10, v11
  ds_write2_b32 v218, v48, v49 offset0:8 offset1:9
  v_cvt_pk_bf16_f32 v48, v12, v13
  v_cvt_pk_bf16_f32 v49, v14, v15
  ds_write2_b32 v218, v48, v49 offset0:12 offset1:13
  v_cvt_pk_bf16_f32 v48, v16, v17
  v_cvt_pk_bf16_f32 v49, v18, v19
  ds_write2_b32 v218, v48, v49 offset0:64 offset1:65
  v_cvt_pk_bf16_f32 v48, v20, v21
  v_cvt_pk_bf16_f32 v49, v22, v23
  ds_write2_b32 v218, v48, v49 offset0:68 offset1:69
  v_cvt_pk_bf16_f32 v48, v24, v25
  v_cvt_pk_bf16_f32 v49, v26, v27
  ds_write2_b32 v218, v48, v49 offset0:72 offset1:73
  v_cvt_pk_bf16_f32 v48, v28, v29
  v_cvt_pk_bf16_f32 v49, v30, v31
  ds_write2_b32 v218, v48, v49 offset0:76 offset1:77
  v_add_u32 v218, 16512, v218
  s_waitcnt vmcnt(0) lgkmcnt(0)
  s_barrier
  ds_read_b128 v[32:35], v203 offset:0
  ds_read_b128 v[36:39], v204 offset:0
  ds_read_b128 v[40:43], v205 offset:0
  s_waitcnt lgkmcnt(2)
  v_mfma_f32_32x32x16_bf16 v[0:15], a[0:3], v[32:35], 0
  ds_read_b128 v[44:47], v206 offset:0
  s_add_u32 m0, s67, 36864
  s_nop 0
  buffer_load_dwordx4 v202, s[4:7], s60 offen offset:0 lds
  v_mfma_f32_32x32x16_bf16 v[16:31], a[144:147], v[32:35], 0
  s_waitcnt lgkmcnt(2)
  v_mfma_f32_32x32x16_bf16 v[0:15], a[4:7], v[36:39], v[0:15]
  ds_read_b128 v[32:35], v203 offset:1024
  s_add_u32 m0, s67, 37760
  s_nop 0
  buffer_load_dwordx4 v202, s[4:7], s60 offen offset:128 lds
  v_mfma_f32_32x32x16_bf16 v[16:31], a[148:151], v[36:39], v[16:31]
  s_waitcnt lgkmcnt(2)
  v_mfma_f32_32x32x16_bf16 v[0:15], a[8:11], v[40:43], v[0:15]
  ds_read_b128 v[36:39], v204 offset:1024
  s_add_u32 m0, s67, 38656
  s_nop 0
  buffer_load_dwordx4 v202, s[4:7], s60 offen offset:256 lds
  v_mfma_f32_32x32x16_bf16 v[16:31], a[152:155], v[40:43], v[16:31]
  s_waitcnt lgkmcnt(2)
  v_mfma_f32_32x32x16_bf16 v[0:15], a[12:15], v[44:47], v[0:15]
  ds_read_b128 v[40:43], v205 offset:1024
  s_add_u32 m0, s67, 39552
  s_nop 0
  buffer_load_dwordx4 v202, s[4:7], s60 offen offset:384 lds
  v_mfma_f32_32x32x16_bf16 v[16:31], a[156:159], v[44:47], v[16:31]
  s_waitcnt lgkmcnt(2)
  v_mfma_f32_32x32x16_bf16 v[0:15], a[16:19], v[32:35], v[0:15]
  ds_read_b128 v[44:47], v206 offset:1024
  s_add_u32 m0, s67, 40448
  s_nop 0
  buffer_load_dwordx4 v202, s[4:7], s60 offen offset:512 lds
  v_mfma_f32_32x32x16_bf16 v[16:31], a[160:163], v[32:35], v[16:31]
  s_waitcnt lgkmcnt(2)
  v_mfma_f32_32x32x16_bf16 v[0:15], a[20:23], v[36:39], v[0:15]
  ds_read_b128 v[32:35], v203 offset:2048
  s_add_u32 m0, s67, 41344
  s_nop 0
  buffer_load_dwordx4 v202, s[4:7], s60 offen offset:640 lds
  v_mfma_f32_32x32x16_bf16 v[16:31], a[164:167], v[36:39], v[16:31]
  s_waitcnt lgkmcnt(2)
  v_mfma_f32_32x32x16_bf16 v[0:15], a[24:27], v[40:43], v[0:15]
  ds_read_b128 v[36:39], v204 offset:2048
  s_add_u32 m0, s67, 42240
  s_nop 0
  buffer_load_dwordx4 v202, s[4:7], s60 offen offset:768 lds
  v_mfma_f32_32x32x16_bf16 v[16:31], a[168:171], v[40:43], v[16:31]
  s_waitcnt lgkmcnt(2)
  v_mfma_f32_32x32x16_bf16 v[0:15], a[28:31], v[44:47], v[0:15]
  ds_read_b128 v[40:43], v205 offset:2048
  s_add_u32 m0, s67, 43136
  s_nop 0
  buffer_load_dwordx4 v202, s[4:7], s60 offen offset:896 lds
  v_mfma_f32_32x32x16_bf16 v[16:31], a[172:175], v[44:47], v[16:31]
  s_waitcnt lgkmcnt(2)
  v_mfma_f32_32x32x16_bf16 v[0:15], a[32:35], v[32:35], v[0:15]
  ds_read_b128 v[44:47], v206 offset:2048
  s_add_u32 m0, s67, 44032
  s_nop 0
  buffer_load_dwordx4 v202, s[4:7], s60 offen offset:1024 lds
  v_mfma_f32_32x32x16_bf16 v[16:31], a[176:179], v[32:35], v[16:31]
  s_waitcnt lgkmcnt(2)
  v_mfma_f32_32x32x16_bf16 v[0:15], a[36:39], v[36:39], v[0:15]
  ds_read_b128 v[32:35], v203 offset:3072
  v_mfma_f32_32x32x16_bf16 v[16:31], a[180:183], v[36:39], v[16:31]
  s_waitcnt lgkmcnt(2)
  v_mfma_f32_32x32x16_bf16 v[0:15], a[40:43], v[40:43], v[0:15]
  ds_read_b128 v[36:39], v204 offset:3072
  v_mfma_f32_32x32x16_bf16 v[16:31], a[184:187], v[40:43], v[16:31]
  s_waitcnt lgkmcnt(2)
  v_mfma_f32_32x32x16_bf16 v[0:15], a[44:47], v[44:47], v[0:15]
  ds_read_b128 v[40:43], v205 offset:3072
  v_mfma_f32_32x32x16_bf16 v[16:31], a[188:191], v[44:47], v[16:31]
  s_waitcnt lgkmcnt(2)
  v_mfma_f32_32x32x16_bf16 v[0:15], a[48:51], v[32:35], v[0:15]
  ds_read_b128 v[44:47], v206 offset:3072
  v_mfma_f32_32x32x16_bf16 v[16:31], a[192:195], v[32:35], v[16:31]
  s_waitcnt lgkmcnt(2)
  v_mfma_f32_32x32x16_bf16 v[0:15], a[52:55], v[36:39], v[0:15]
  ds_read_b128 v[32:35], v203 offset:4096
  v_mfma_f32_32x32x16_bf16 v[16:31], a[196:199], v[36:39], v[16:31]
  s_waitcnt lgkmcnt(2)
  v_mfma_f32_32x32x16_bf16 v[0:15], a[56:59], v[40:43], v[0:15]
  ds_read_b128 v[36:39], v204 offset:4096
  v_mfma_f32_32x32x16_bf16 v[16:31], a[200:203], v[40:43], v[16:31]
  s_waitcnt lgkmcnt(2)
  v_mfma_f32_32x32x16_bf16 v[0:15], a[60:63], v[44:47], v[0:15]
  ds_read_b128 v[40:43], v205 offset:4096
  v_mfma_f32_32x32x16_bf16 v[16:31], a[204:207], v[44:47], v[16:31]
  s_waitcnt lgkmcnt(2)
  v_mfma_f32_32x32x16_bf16 v[0:15], a[64:67], v[32:35], v[0:15]
  ds_read_b128 v[44:47], v206 offset:4096
  v_mfma_f32_32x32x16_bf16 v[16:31], a[208:211], v[32:35], v[16:31]
  s_waitcnt lgkmcnt(2)
  v_mfma_f32_32x32x16_bf16 v[0:15], a[68:71], v[36:39], v[0:15]
  ds_read_b128 v[32:35], v203 offset:5120
  v_mfma_f32_32x32x16_bf16 v[16:31], a[212:215], v[36:39], v[16:31]
  s_waitcnt lgkmcnt(2)
  v_mfma_f32_32x32x16_bf16 v[0:15], a[72:75], v[40:43], v[0:15]
  ds_read_b128 v[36:39], v204 offset:5120
  v_mfma_f32_32x32x16_bf16 v[16:31], a[216:219], v[40:43], v[16:31]
  s_waitcnt lgkmcnt(2)
  v_mfma_f32_32x32x16_bf16 v[0:15], a[76:79], v[44:47], v[0:15]
  ds_read_b128 v[40:43], v205 offset:5120
  v_mfma_f32_32x32x16_bf16 v[16:31], a[220:223], v[44:47], v[16:31]
  s_waitcnt lgkmcnt(2)
  v_mfma_f32_32x32x16_bf16 v[0:15], a[80:83], v[32:35], v[0:15]
  ds_read_b128 v[44:47], v206 offset:5120
  v_mfma_f32_32x32x16_bf16 v[16:31], a[224:227], v[32:35], v[16:31]
  s_waitcnt lgkmcnt(2)
  v_mfma_f32_32x32x16_bf16 v[0:15], a[84:87], v[36:39], v[0:15]
  ds_read_b128 v[32:35], v203 offset:6144
  v_mfma_f32_32x32x16_bf16 v[16:31], a[228:231], v[36:39], v[16:31]
  s_waitcnt lgkmcnt(2)
  v_mfma_f32_32x32x16_bf16 v[0:15], a[88:91], v[40:43], v[0:15]
  ds_read_b128 v[36:39], v204 offset:6144
  v_mfma_f32_32x32x16_bf16 v[16:31], a[232:235], v[40:43], v[16:31]
  s_waitcnt lgkmcnt(2)
  v_mfma_f32_32x32x16_bf16 v[0:15], a[92:95], v[44:47], v[0:15]
  ds_read_b128 v[40:43], v205 offset:6144
  v_mfma_f32_32x32x16_bf16 v[16:31], a[236:239], v[44:47], v[16:31]
  s_waitcnt lgkmcnt(2)
  v_mfma_f32_32x32x16_bf16 v[0:15], a[96:99], v[32:35], v[0:15]
  ds_read_b128 v[44:47], v206 offset:6144
  v_mfma_f32_32x32x16_bf16 v[16:31], a[240:243], v[32:35], v[16:31]
  s_waitcnt lgkmcnt(2)
  v_mfma_f32_32x32x16_bf16 v[0:15], a[100:103], v[36:39], v[0:15]
  ds_read_b128 v[32:35], v203 offset:7168
  v_mfma_f32_32x32x16_bf16 v[16:31], a[244:247], v[36:39], v[16:31]
  s_waitcnt lgkmcnt(2)
  v_mfma_f32_32x32x16_bf16 v[0:15], a[104:107], v[40:43], v[0:15]
  ds_read_b128 v[36:39], v204 offset:7168
  v_mfma_f32_32x32x16_bf16 v[16:31], a[248:251], v[40:43], v[16:31]
  s_waitcnt lgkmcnt(2)
  v_mfma_f32_32x32x16_bf16 v[0:15], a[108:111], v[44:47], v[0:15]
  ds_read_b128 v[40:43], v205 offset:7168
  v_mfma_f32_32x32x16_bf16 v[16:31], a[252:255], v[44:47], v[16:31]
  s_waitcnt lgkmcnt(2)
  v_mfma_f32_32x32x16_bf16 v[0:15], a[112:115], v[32:35], v[0:15]
  ds_read_b128 v[44:47], v206 offset:7168
  v_mfma_f32_32x32x16_bf16 v[16:31], v[224:227], v[32:35], v[16:31]
  s_waitcnt lgkmcnt(2)
  v_mfma_f32_32x32x16_bf16 v[0:15], a[116:119], v[36:39], v[0:15]
  ds_read_b128 v[32:35], v203 offset:8192
  v_mfma_f32_32x32x16_bf16 v[16:31], v[228:231], v[36:39], v[16:31]
  s_waitcnt lgkmcnt(2)
  v_mfma_f32_32x32x16_bf16 v[0:15], a[120:123], v[40:43], v[0:15]
  ds_read_b128 v[36:39], v204 offset:8192
  v_mfma_f32_32x32x16_bf16 v[16:31], v[232:235], v[40:43], v[16:31]
  s_waitcnt lgkmcnt(2)
  v_mfma_f32_32x32x16_bf16 v[0:15], a[124:127], v[44:47], v[0:15]
  ds_read_b128 v[40:43], v205 offset:8192
  v_mfma_f32_32x32x16_bf16 v[16:31], v[236:239], v[44:47], v[16:31]
  s_waitcnt lgkmcnt(2)
  v_mfma_f32_32x32x16_bf16 v[0:15], a[128:131], v[32:35], v[0:15]
  ds_read_b128 v[44:47], v206 offset:8192
  v_mfma_f32_32x32x16_bf16 v[16:31], v[240:243], v[32:35], v[16:31]
  s_waitcnt lgkmcnt(2)
  v_mfma_f32_32x32x16_bf16 v[0:15], a[132:135], v[36:39], v[0:15]
  v_mfma_f32_32x32x16_bf16 v[16:31], v[244:247], v[36:39], v[16:31]
  s_waitcnt lgkmcnt(1)
  v_mfma_f32_32x32x16_bf16 v[0:15], a[136:139], v[40:43], v[0:15]
  v_mfma_f32_32x32x16_bf16 v[16:31], v[248:251], v[40:43], v[16:31]
  s_waitcnt lgkmcnt(0)
  v_mfma_f32_32x32x16_bf16 v[0:15], a[140:143], v[44:47], v[0:15]
  v_mfma_f32_32x32x16_bf16 v[16:31], v[252:255], v[44:47], v[16:31]
  s_add_u32 s60, s60, 36864
  s_nop 2
  v_cvt_pk_bf16_f32 v48, v0, v1
  v_cvt_pk_bf16_f32 v49, v2, v3
  ds_write2_b32 v218, v48, v49 offset0:0 offset1:1
  v_cvt_pk_bf16_f32 v48, v4, v5
  v_cvt_pk_bf16_f32 v49, v6, v7
  ds_write2_b32 v218, v48, v49 offset0:4 offset1:5
  v_cvt_pk_bf16_f32 v48, v8, v9
  v_cvt_pk_bf16_f32 v49, v10, v11
  ds_write2_b32 v218, v48, v49 offset0:8 offset1:9
  v_cvt_pk_bf16_f32 v48, v12, v13
  v_cvt_pk_bf16_f32 v49, v14, v15
  ds_write2_b32 v218, v48, v49 offset0:12 offset1:13
  v_cvt_pk_bf16_f32 v48, v16, v17
  v_cvt_pk_bf16_f32 v49, v18, v19
  ds_write2_b32 v218, v48, v49 offset0:64 offset1:65
  v_cvt_pk_bf16_f32 v48, v20, v21
  v_cvt_pk_bf16_f32 v49, v22, v23
  ds_write2_b32 v218, v48, v49 offset0:68 offset1:69
  v_cvt_pk_bf16_f32 v48, v24, v25
  v_cvt_pk_bf16_f32 v49, v26, v27
  ds_write2_b32 v218, v48, v49 offset0:72 offset1:73
  v_cvt_pk_bf16_f32 v48, v28, v29
  v_cvt_pk_bf16_f32 v49, v30, v31
  ds_write2_b32 v218, v48, v49 offset0:76 offset1:77
  v_add_u32 v218, 16512, v218
  s_waitcnt vmcnt(0) lgkmcnt(0)
  s_barrier
  ds_read_b128 v[32:35], v203 offset:36864
  ds_read_b128 v[36:39], v204 offset:36864
  ds_read_b128 v[40:43], v205 offset:36864
  s_waitcnt lgkmcnt(2)
  v_mfma_f32_32x32x16_bf16 v[0:15], a[0:3], v[32:35], 0
  ds_read_b128 v[44:47], v206 offset:36864
  s_add_u32 m0, s67, 0
  s_nop 0
  buffer_load_dwordx4 v202, s[4:7], s60 offen offset:0 lds
  v_mfma_f32_32x32x16_bf16 v[16:31], a[144:147], v[32:35], 0
  s_waitcnt lgkmcnt(2)
  v_mfma_f32_32x32x16_bf16 v[0:15], a[4:7], v[36:39], v[0:15]
  ds_read_b128 v[32:35], v203 offset:37888
  s_add_u32 m0, s67, 896
  s_nop 0
  buffer_load_dwordx4 v202, s[4:7], s60 offen offset:128 lds
  v_mfma_f32_32x32x16_bf16 v[16:31], a[148:151], v[36:39], v[16:31]
  s_waitcnt lgkmcnt(2)
  v_mfma_f32_32x32x16_bf16 v[0:15], a[8:11], v[40:43], v[0:15]
  ds_read_b128 v[36:39], v204 offset:37888
  s_add_u32 m0, s67, 1792
  s_nop 0
  buffer_load_dwordx4 v202, s[4:7], s60 offen offset:256 lds
  v_mfma_f32_32x32x16_bf16 v[16:31], a[152:155], v[40:43], v[16:31]
  s_waitcnt lgkmcnt(2)
  v_mfma_f32_32x32x16_bf16 v[0:15], a[12:15], v[44:47], v[0:15]
  ds_read_b128 v[40:43], v205 offset:37888
  s_add_u32 m0, s67, 2688
  s_nop 0
  buffer_load_dwordx4 v202, s[4:7], s60 offen offset:384 lds
  v_mfma_f32_32x32x16_bf16 v[16:31], a[156:159], v[44:47], v[16:31]
  s_waitcnt lgkmcnt(2)
  v_mfma_f32_32x32x16_bf16 v[0:15], a[16:19], v[32:35], v[0:15]
  ds_read_b128 v[44:47], v206 offset:37888
  s_add_u32 m0, s67, 3584
  s_nop 0
  buffer_load_dwordx4 v202, s[4:7], s60 offen offset:512 lds
  v_mfma_f32_32x32x16_bf16 v[16:31], a[160:163], v[32:35], v[16:31]
  s_waitcnt lgkmcnt(2)
  v_mfma_f32_32x32x16_bf16 v[0:15], a[20:23], v[36:39], v[0:15]
  ds_read_b128 v[32:35], v203 offset:38912
  s_add_u32 m0, s67, 4480
  s_nop 0
  buffer_load_dwordx4 v202, s[4:7], s60 offen offset:640 lds
  v_mfma_f32_32x32x16_bf16 v[16:31], a[164:167], v[36:39], v[16:31]
  s_waitcnt lgkmcnt(2)
  v_mfma_f32_32x32x16_bf16 v[0:15], a[24:27], v[40:43], v[0:15]
  ds_read_b128 v[36:39], v204 offset:38912
  s_add_u32 m0, s67, 5376
  s_nop 0
  buffer_load_dwordx4 v202, s[4:7], s60 offen offset:768 lds
  v_mfma_f32_32x32x16_bf16 v[16:31], a[168:171], v[40:43], v[16:31]
  s_waitcnt lgkmcnt(2)
  v_mfma_f32_32x32x16_bf16 v[0:15], a[28:31], v[44:47], v[0:15]
  ds_read_b128 v[40:43], v205 offset:38912
  s_add_u32 m0, s67, 6272
  s_nop 0
  buffer_load_dwordx4 v202, s[4:7], s60 offen offset:896 lds
  v_mfma_f32_32x32x16_bf16 v[16:31], a[172:175], v[44:47], v[16:31]
  s_waitcnt lgkmcnt(2)
  v_mfma_f32_32x32x16_bf16 v[0:15], a[32:35], v[32:35], v[0:15]
  ds_read_b128 v[44:47], v206 offset:38912
  s_add_u32 m0, s67, 7168
  s_nop 0
  buffer_load_dwordx4 v202, s[4:7], s60 offen offset:1024 lds
  v_mfma_f32_32x32x16_bf16 v[16:31], a[176:179], v[32:35], v[16:31]
  s_waitcnt lgkmcnt(2)
  v_mfma_f32_32x32x16_bf16 v[0:15], a[36:39], v[36:39], v[0:15]
  ds_read_b128 v[32:35], v203 offset:39936
  v_mfma_f32_32x32x16_bf16 v[16:31], a[180:183], v[36:39], v[16:31]
  s_waitcnt lgkmcnt(2)
  v_mfma_f32_32x32x16_bf16 v[0:15], a[40:43], v[40:43], v[0:15]
  ds_read_b128 v[36:39], v204 offset:39936
  v_mfma_f32_32x32x16_bf16 v[16:31], a[184:187], v[40:43], v[16:31]
  s_waitcnt lgkmcnt(2)
  v_mfma_f32_32x32x16_bf16 v[0:15], a[44:47], v[44:47], v[0:15]
  ds_read_b128 v[40:43], v205 offset:39936
  v_mfma_f32_32x32x16_bf16 v[16:31], a[188:191], v[44:47], v[16:31]
  s_waitcnt lgkmcnt(2)
  v_mfma_f32_32x32x16_bf16 v[0:15], a[48:51], v[32:35], v[0:15]
  ds_read_b128 v[44:47], v206 offset:39936
  v_mfma_f32_32x32x16_bf16 v[16:31], a[192:195], v[32:35], v[16:31]
  s_waitcnt lgkmcnt(2)
  v_mfma_f32_32x32x16_bf16 v[0:15], a[52:55], v[36:39], v[0:15]
  ds_read_b128 v[32:35], v203 offset:40960
  v_mfma_f32_32x32x16_bf16 v[16:31], a[196:199], v[36:39], v[16:31]
  s_waitcnt lgkmcnt(2)
  v_mfma_f32_32x32x16_bf16 v[0:15], a[56:59], v[40:43], v[0:15]
  ds_read_b128 v[36:39], v204 offset:40960
  v_mfma_f32_32x32x16_bf16 v[16:31], a[200:203], v[40:43], v[16:31]
  s_waitcnt lgkmcnt(2)
  v_mfma_f32_32x32x16_bf16 v[0:15], a[60:63], v[44:47], v[0:15]
  ds_read_b128 v[40:43], v205 offset:40960
  v_mfma_f32_32x32x16_bf16 v[16:31], a[204:207], v[44:47], v[16:31]
  s_waitcnt lgkmcnt(2)
  v_mfma_f32_32x32x16_bf16 v[0:15], a[64:67], v[32:35], v[0:15]
  ds_read_b128 v[44:47], v206 offset:40960
  v_mfma_f32_32x32x16_bf16 v[16:31], a[208:211], v[32:35], v[16:31]
  s_waitcnt lgkmcnt(2)
  v_mfma_f32_32x32x16_bf16 v[0:15], a[68:71], v[36:39], v[0:15]
  ds_read_b128 v[32:35], v203 offset:41984
  v_mfma_f32_32x32x16_bf16 v[16:31], a[212:215], v[36:39], v[16:31]
  s_waitcnt lgkmcnt(2)
  v_mfma_f32_32x32x16_bf16 v[0:15], a[72:75], v[40:43], v[0:15]
  ds_read_b128 v[36:39], v204 offset:41984
  v_mfma_f32_32x32x16_bf16 v[16:31], a[216:219], v[40:43], v[16:31]
  s_waitcnt lgkmcnt(2)
  v_mfma_f32_32x32x16_bf16 v[0:15], a[76:79], v[44:47], v[0:15]
  ds_read_b128 v[40:43], v205 offset:41984
  v_mfma_f32_32x32x16_bf16 v[16:31], a[220:223], v[44:47], v[16:31]
  s_waitcnt lgkmcnt(2)
  v_mfma_f32_32x32x16_bf16 v[0:15], a[80:83], v[32:35], v[0:15]
  ds_read_b128 v[44:47], v206 offset:41984
  v_mfma_f32_32x32x16_bf16 v[16:31], a[224:227], v[32:35], v[16:31]
  s_waitcnt lgkmcnt(2)
  v_mfma_f32_32x32x16_bf16 v[0:15], a[84:87], v[36:39], v[0:15]
  ds_read_b128 v[32:35], v203 offset:43008
  v_mfma_f32_32x32x16_bf16 v[16:31], a[228:231], v[36:39], v[16:31]
  s_waitcnt lgkmcnt(2)
  v_mfma_f32_32x32x16_bf16 v[0:15], a[88:91], v[40:43], v[0:15]
  ds_read_b128 v[36:39], v204 offset:43008
  v_mfma_f32_32x32x16_bf16 v[16:31], a[232:235], v[40:43], v[16:31]
  s_waitcnt lgkmcnt(2)
  v_mfma_f32_32x32x16_bf16 v[0:15], a[92:95], v[44:47], v[0:15]
  ds_read_b128 v[40:43], v205 offset:43008
  v_mfma_f32_32x32x16_bf16 v[16:31], a[236:239], v[44:47], v[16:31]
  s_waitcnt lgkmcnt(2)
  v_mfma_f32_32x32x16_bf16 v[0:15], a[96:99], v[32:35], v[0:15]
  ds_read_b128 v[44:47], v206 offset:43008
  v_mfma_f32_32x32x16_bf16 v[16:31], a[240:243], v[32:35], v[16:31]
  s_waitcnt lgkmcnt(2)
  v_mfma_f32_32x32x16_bf16 v[0:15], a[100:103], v[36:39], v[0:15]
  ds_read_b128 v[32:35], v203 offset:44032
  v_mfma_f32_32x32x16_bf16 v[16:31], a[244:247], v[36:39], v[16:31]
  s_waitcnt lgkmcnt(2)
  v_mfma_f32_32x32x16_bf16 v[0:15], a[104:107], v[40:43], v[0:15]
  ds_read_b128 v[36:39], v204 offset:44032
  v_mfma_f32_32x32x16_bf16 v[16:31], a[248:251], v[40:43], v[16:31]
  s_waitcnt lgkmcnt(2)
  v_mfma_f32_32x32x16_bf16 v[0:15], a[108:111], v[44:47], v[0:15]
  ds_read_b128 v[40:43], v205 offset:44032
  v_mfma_f32_32x32x16_bf16 v[16:31], a[252:255], v[44:47], v[16:31]
  s_waitcnt lgkmcnt(2)
  v_mfma_f32_32x32x16_bf16 v[0:15], a[112:115], v[32:35], v[0:15]
  ds_read_b128 v[44:47], v206 offset:44032
  v_mfma_f32_32x32x16_bf16 v[16:31], v[224:227], v[32:35], v[16:31]
  s_waitcnt lgkmcnt(2)
  v_mfma_f32_32x32x16_bf16 v[0:15], a[116:119], v[36:39], v[0:15]
  ds_read_b128 v[32:35], v203 offset:45056
  v_mfma_f32_32x32x16_bf16 v[16:31], v[228:231], v[36:39], v[16:31]
  s_waitcnt lgkmcnt(2)
  v_mfma_f32_32x32x16_bf16 v[0:15], a[120:123], v[40:43], v[0:15]
  ds_read_b128 v[36:39], v204 offset:45056
  v_mfma_f32_32x32x16_bf16 v[16:31], v[232:235], v[40:43], v[16:31]
  s_waitcnt lgkmcnt(2)
  v_mfma_f32_32x32x16_bf16 v[0:15], a[124:127], v[44:47], v[0:15]
  ds_read_b128 v[40:43], v205 offset:45056
  v_mfma_f32_32x32x16_bf16 v[16:31], v[236:239], v[44:47], v[16:31]
  s_waitcnt lgkmcnt(2)
  v_mfma_f32_32x32x16_bf16 v[0:15], a[128:131], v[32:35], v[0:15]
  ds_read_b128 v[44:47], v206 offset:45056
  v_mfma_f32_32x32x16_bf16 v[16:31], v[240:243], v[32:35], v[16:31]
  s_waitcnt lgkmcnt(2)
  v_mfma_f32_32x32x16_bf16 v[0:15], a[132:135], v[36:39], v[0:15]
  v_mfma_f32_32x32x16_bf16 v[16:31], v[244:247], v[36:39], v[16:31]
  s_waitcnt lgkmcnt(1)
  v_mfma_f32_32x32x16_bf16 v[0:15], a[136:139], v[40:43], v[0:15]
  v_mfma_f32_32x32x16_bf16 v[16:31], v[248:251], v[40:43], v[16:31]
  s_waitcnt lgkmcnt(0)
  v_mfma_f32_32x32x16_bf16 v[0:15], a[140:143], v[44:47], v[0:15]
  v_mfma_f32_32x32x16_bf16 v[16:31], v[252:255], v[44:47], v[16:31]
  s_add_u32 s60, s60, 36864
  s_nop 2
  v_cvt_pk_bf16_f32 v48, v0, v1
  v_cvt_pk_bf16_f32 v49, v2, v3
  ds_write2_b32 v218, v48, v49 offset0:0 offset1:1
  v_cvt_pk_bf16_f32 v48, v4, v5
  v_cvt_pk_bf16_f32 v49, v6, v7
  ds_write2_b32 v218, v48, v49 offset0:4 offset1:5
  v_cvt_pk_bf16_f32 v48, v8, v9
  v_cvt_pk_bf16_f32 v49, v10, v11
  ds_write2_b32 v218, v48, v49 offset0:8 offset1:9
  v_cvt_pk_bf16_f32 v48, v12, v13
  v_cvt_pk_bf16_f32 v49, v14, v15
  ds_write2_b32 v218, v48, v49 offset0:12 offset1:13
  v_cvt_pk_bf16_f32 v48, v16, v17
  v_cvt_pk_bf16_f32 v49, v18, v19
  ds_write2_b32 v218, v48, v49 offset0:64 offset1:65
  v_cvt_pk_bf16_f32 v48, v20, v21
  v_cvt_pk_bf16_f32 v49, v22, v23
  ds_write2_b32 v218, v48, v49 offset0:68 offset1:69
  v_cvt_pk_bf16_f32 v48, v24, v25
  v_cvt_pk_bf16_f32 v49, v26, v27
  ds_write2_b32 v218, v48, v49 offset0:72 offset1:73
  v_cvt_pk_bf16_f32 v48, v28, v29
  v_cvt_pk_bf16_f32 v49, v30, v31
  ds_write2_b32 v218, v48, v49 offset0:76 offset1:77
  v_add_u32 v218, 16512, v218
  s_waitcnt vmcnt(0) lgkmcnt(0)
  s_barrier
  ds_read_b128 v[32:35], v203 offset:0
  ds_read_b128 v[36:39], v204 offset:0
  ds_read_b128 v[40:43], v205 offset:0
  s_waitcnt lgkmcnt(2)
  v_mfma_f32_32x32x16_bf16 v[0:15], a[0:3], v[32:35], 0
  ds_read_b128 v[44:47], v206 offset:0
  v_mfma_f32_32x32x16_bf16 v[16:31], a[144:147], v[32:35], 0
  s_waitcnt lgkmcnt(2)
  v_mfma_f32_32x32x16_bf16 v[0:15], a[4:7], v[36:39], v[0:15]
  ds_read_b128 v[32:35], v203 offset:1024
  v_mfma_f32_32x32x16_bf16 v[16:31], a[148:151], v[36:39], v[16:31]
  s_waitcnt lgkmcnt(2)
  v_mfma_f32_32x32x16_bf16 v[0:15], a[8:11], v[40:43], v[0:15]
  ds_read_b128 v[36:39], v204 offset:1024
  v_mfma_f32_32x32x16_bf16 v[16:31], a[152:155], v[40:43], v[16:31]
  s_waitcnt lgkmcnt(2)
  v_mfma_f32_32x32x16_bf16 v[0:15], a[12:15], v[44:47], v[0:15]
  ds_read_b128 v[40:43], v205 offset:1024
  v_mfma_f32_32x32x16_bf16 v[16:31], a[156:159], v[44:47], v[16:31]
  s_waitcnt lgkmcnt(2)
  v_mfma_f32_32x32x16_bf16 v[0:15], a[16:19], v[32:35], v[0:15]
  ds_read_b128 v[44:47], v206 offset:1024
  v_mfma_f32_32x32x16_bf16 v[16:31], a[160:163], v[32:35], v[16:31]
  s_waitcnt lgkmcnt(2)
  v_mfma_f32_32x32x16_bf16 v[0:15], a[20:23], v[36:39], v[0:15]
  ds_read_b128 v[32:35], v203 offset:2048
  v_mfma_f32_32x32x16_bf16 v[16:31], a[164:167], v[36:39], v[16:31]
  s_waitcnt lgkmcnt(2)
  v_mfma_f32_32x32x16_bf16 v[0:15], a[24:27], v[40:43], v[0:15]
  ds_read_b128 v[36:39], v204 offset:2048
  v_mfma_f32_32x32x16_bf16 v[16:31], a[168:171], v[40:43], v[16:31]
  s_waitcnt lgkmcnt(2)
  v_mfma_f32_32x32x16_bf16 v[0:15], a[28:31], v[44:47], v[0:15]
  ds_read_b128 v[40:43], v205 offset:2048
  v_mfma_f32_32x32x16_bf16 v[16:31], a[172:175], v[44:47], v[16:31]
  s_waitcnt lgkmcnt(2)
  v_mfma_f32_32x32x16_bf16 v[0:15], a[32:35], v[32:35], v[0:15]
  ds_read_b128 v[44:47], v206 offset:2048
  v_mfma_f32_32x32x16_bf16 v[16:31], a[176:179], v[32:35], v[16:31]
  s_waitcnt lgkmcnt(2)
  v_mfma_f32_32x32x16_bf16 v[0:15], a[36:39], v[36:39], v[0:15]
  ds_read_b128 v[32:35], v203 offset:3072
  v_mfma_f32_32x32x16_bf16 v[16:31], a[180:183], v[36:39], v[16:31]
  s_waitcnt lgkmcnt(2)
  v_mfma_f32_32x32x16_bf16 v[0:15], a[40:43], v[40:43], v[0:15]
  ds_read_b128 v[36:39], v204 offset:3072
  v_mfma_f32_32x32x16_bf16 v[16:31], a[184:187], v[40:43], v[16:31]
  s_waitcnt lgkmcnt(2)
  v_mfma_f32_32x32x16_bf16 v[0:15], a[44:47], v[44:47], v[0:15]
  ds_read_b128 v[40:43], v205 offset:3072
  v_mfma_f32_32x32x16_bf16 v[16:31], a[188:191], v[44:47], v[16:31]
  s_waitcnt lgkmcnt(2)
  v_mfma_f32_32x32x16_bf16 v[0:15], a[48:51], v[32:35], v[0:15]
  ds_read_b128 v[44:47], v206 offset:3072
  v_mfma_f32_32x32x16_bf16 v[16:31], a[192:195], v[32:35], v[16:31]
  s_waitcnt lgkmcnt(2)
  v_mfma_f32_32x32x16_bf16 v[0:15], a[52:55], v[36:39], v[0:15]
  ds_read_b128 v[32:35], v203 offset:4096
  v_mfma_f32_32x32x16_bf16 v[16:31], a[196:199], v[36:39], v[16:31]
  s_waitcnt lgkmcnt(2)
  v_mfma_f32_32x32x16_bf16 v[0:15], a[56:59], v[40:43], v[0:15]
  ds_read_b128 v[36:39], v204 offset:4096
  v_mfma_f32_32x32x16_bf16 v[16:31], a[200:203], v[40:43], v[16:31]
  s_waitcnt lgkmcnt(2)
  v_mfma_f32_32x32x16_bf16 v[0:15], a[60:63], v[44:47], v[0:15]
  ds_read_b128 v[40:43], v205 offset:4096
  v_mfma_f32_32x32x16_bf16 v[16:31], a[204:207], v[44:47], v[16:31]
  s_waitcnt lgkmcnt(2)
  v_mfma_f32_32x32x16_bf16 v[0:15], a[64:67], v[32:35], v[0:15]
  ds_read_b128 v[44:47], v206 offset:4096
  v_mfma_f32_32x32x16_bf16 v[16:31], a[208:211], v[32:35], v[16:31]
  s_waitcnt lgkmcnt(2)
  v_mfma_f32_32x32x16_bf16 v[0:15], a[68:71], v[36:39], v[0:15]
  ds_read_b128 v[32:35], v203 offset:5120
  v_mfma_f32_32x32x16_bf16 v[16:31], a[212:215], v[36:39], v[16:31]
  s_waitcnt lgkmcnt(2)
  v_mfma_f32_32x32x16_bf16 v[0:15], a[72:75], v[40:43], v[0:15]
  ds_read_b128 v[36:39], v204 offset:5120
  v_mfma_f32_32x32x16_bf16 v[16:31], a[216:219], v[40:43], v[16:31]
  s_waitcnt lgkmcnt(2)
  v_mfma_f32_32x32x16_bf16 v[0:15], a[76:79], v[44:47], v[0:15]
  ds_read_b128 v[40:43], v205 offset:5120
  v_mfma_f32_32x32x16_bf16 v[16:31], a[220:223], v[44:47], v[16:31]
  s_waitcnt lgkmcnt(2)
  v_mfma_f32_32x32x16_bf16 v[0:15], a[80:83], v[32:35], v[0:15]
  ds_read_b128 v[44:47], v206 offset:5120
  v_mfma_f32_32x32x16_bf16 v[16:31], a[224:227], v[32:35], v[16:31]
  s_waitcnt lgkmcnt(2)
  v_mfma_f32_32x32x16_bf16 v[0:15], a[84:87], v[36:39], v[0:15]
  ds_read_b128 v[32:35], v203 offset:6144
  v_mfma_f32_32x32x16_bf16 v[16:31], a[228:231], v[36:39], v[16:31]
  s_waitcnt lgkmcnt(2)
  v_mfma_f32_32x32x16_bf16 v[0:15], a[88:91], v[40:43], v[0:15]
  ds_read_b128 v[36:39], v204 offset:6144
  v_mfma_f32_32x32x16_bf16 v[16:31], a[232:235], v[40:43], v[16:31]
  s_waitcnt lgkmcnt(2)
  v_mfma_f32_32x32x16_bf16 v[0:15], a[92:95], v[44:47], v[0:15]
  ds_read_b128 v[40:43], v205 offset:6144
  v_mfma_f32_32x32x16_bf16 v[16:31], a[236:239], v[44:47], v[16:31]
  s_waitcnt lgkmcnt(2)
  v_mfma_f32_32x32x16_bf16 v[0:15], a[96:99], v[32:35], v[0:15]
  ds_read_b128 v[44:47], v206 offset:6144
  v_mfma_f32_32x32x16_bf16 v[16:31], a[240:243], v[32:35], v[16:31]
  s_waitcnt lgkmcnt(2)
  v_mfma_f32_32x32x16_bf16 v[0:15], a[100:103], v[36:39], v[0:15]
  ds_read_b128 v[32:35], v203 offset:7168
  v_mfma_f32_32x32x16_bf16 v[16:31], a[244:247], v[36:39], v[16:31]
  s_waitcnt lgkmcnt(2)
  v_mfma_f32_32x32x16_bf16 v[0:15], a[104:107], v[40:43], v[0:15]
  ds_read_b128 v[36:39], v204 offset:7168
  v_mfma_f32_32x32x16_bf16 v[16:31], a[248:251], v[40:43], v[16:31]
  s_waitcnt lgkmcnt(2)
  v_mfma_f32_32x32x16_bf16 v[0:15], a[108:111], v[44:47], v[0:15]
  ds_read_b128 v[40:43], v205 offset:7168
  v_mfma_f32_32x32x16_bf16 v[16:31], a[252:255], v[44:47], v[16:31]
  s_waitcnt lgkmcnt(2)
  v_mfma_f32_32x32x16_bf16 v[0:15], a[112:115], v[32:35], v[0:15]
  ds_read_b128 v[44:47], v206 offset:7168
  v_mfma_f32_32x32x16_bf16 v[16:31], v[224:227], v[32:35], v[16:31]
  s_waitcnt lgkmcnt(2)
  v_mfma_f32_32x32x16_bf16 v[0:15], a[116:119], v[36:39], v[0:15]
  ds_read_b128 v[32:35], v203 offset:8192
  v_mfma_f32_32x32x16_bf16 v[16:31], v[228:231], v[36:39], v[16:31]
  s_waitcnt lgkmcnt(2)
  v_mfma_f32_32x32x16_bf16 v[0:15], a[120:123], v[40:43], v[0:15]
  ds_read_b128 v[36:39], v204 offset:8192
  v_mfma_f32_32x32x16_bf16 v[16:31], v[232:235], v[40:43], v[16:31]
  s_waitcnt lgkmcnt(2)
  v_mfma_f32_32x32x16_bf16 v[0:15], a[124:127], v[44:47], v[0:15]
  ds_read_b128 v[40:43], v205 offset:8192
  v_mfma_f32_32x32x16_bf16 v[16:31], v[236:239], v[44:47], v[16:31]
  s_waitcnt lgkmcnt(2)
  v_mfma_f32_32x32x16_bf16 v[0:15], a[128:131], v[32:35], v[0:15]
  ds_read_b128 v[44:47], v206 offset:8192
  v_mfma_f32_32x32x16_bf16 v[16:31], v[240:243], v[32:35], v[16:31]
  s_waitcnt lgkmcnt(2)
  v_mfma_f32_32x32x16_bf16 v[0:15], a[132:135], v[36:39], v[0:15]
  v_mfma_f32_32x32x16_bf16 v[16:31], v[244:247], v[36:39], v[16:31]
  s_waitcnt lgkmcnt(1)
  v_mfma_f32_32x32x16_bf16 v[0:15], a[136:139], v[40:43], v[0:15]
  v_mfma_f32_32x32x16_bf16 v[16:31], v[248:251], v[40:43], v[16:31]
  s_waitcnt lgkmcnt(0)
  v_mfma_f32_32x32x16_bf16 v[0:15], a[140:143], v[44:47], v[0:15]
  v_mfma_f32_32x32x16_bf16 v[16:31], v[252:255], v[44:47], v[16:31]
  s_add_u32 s60, s60, 36864
  s_nop 2
  v_cvt_pk_bf16_f32 v48, v0, v1
  v_cvt_pk_bf16_f32 v49, v2, v3
  ds_write2_b32 v218, v48, v49 offset0:0 offset1:1
  v_cvt_pk_bf16_f32 v48, v4, v5
  v_cvt_pk_bf16_f32 v49, v6, v7
  ds_write2_b32 v218, v48, v49 offset0:4 offset1:5
  v_cvt_pk_bf16_f32 v48, v8, v9
  v_cvt_pk_bf16_f32 v49, v10, v11
  ds_write2_b32 v218, v48, v49 offset0:8 offset1:9
  v_cvt_pk_bf16_f32 v48, v12, v13
  v_cvt_pk_bf16_f32 v49, v14, v15
  ds_write2_b32 v218, v48, v49 offset0:12 offset1:13
  v_cvt_pk_bf16_f32 v48, v16, v17
  v_cvt_pk_bf16_f32 v49, v18, v19
  ds_write2_b32 v218, v48, v49 offset0:64 offset1:65
  v_cvt_pk_bf16_f32 v48, v20, v21
  v_cvt_pk_bf16_f32 v49, v22, v23
  ds_write2_b32 v218, v48, v49 offset0:68 offset1:69
  v_cvt_pk_bf16_f32 v48, v24, v25
  v_cvt_pk_bf16_f32 v49, v26, v27
  ds_write2_b32 v218, v48, v49 offset0:72 offset1:73
  v_cvt_pk_bf16_f32 v48, v28, v29
  v_cvt_pk_bf16_f32 v49, v30, v31
  ds_write2_b32 v218, v48, v49 offset0:76 offset1:77
  v_add_u32 v218, 16512, v218
  s_waitcnt vmcnt(0) lgkmcnt(0)
  s_barrier
  v_mul_u32_u24 v219, 516, v200
  s_mul_i32 s54, s52, 36
  s_add_u32 s55, s54, 83016
  v_add_u32 v219, s55, v219
  v_mul_u32_u24 v220, 144, v200
  v_add_u32 v220, s54, v220
  s_mul_i32 s54, s52, 3072
  v_add_u32 v218, s54, v201
  s_lshl_b32 s55, s68, 4
  s_add_u32 s55, s55, s69
  s_mul_i32 s64, s55, 18432
  s_add_u32 s64, s64, 62914560
  s_cmp_eq_u32 s52, 3
  s_cselect_b32 s64, 268435456, s64
  s_lshl_b32 s66, s69, 7
  s_mov_b32 s57, 1051597459
  ds_read_b32 v0, v219 offset:7224
  ds_read_b32 v1, v219 offset:7228
  ds_read_b32 v2, v219 offset:7232
  ds_read_b32 v3, v219 offset:7236
  ds_read_b32 v4, v219 offset:7240
  ds_read_b32 v5, v219 offset:7244
  ds_read_b32 v6, v219 offset:7248
  ds_read_b32 v7, v219 offset:7252
  ds_read_b32 v8, v219 offset:7256
  ds_read_b32 v16, v219 offset:7368
  ds_read_b32 v17, v219 offset:7372
  ds_read_b32 v18, v219 offset:7376
  ds_read_b32 v19, v219 offset:7380
  ds_read_b32 v20, v219 offset:7384
  ds_read_b32 v21, v219 offset:7388
  ds_read_b32 v22, v219 offset:7392
  ds_read_b32 v23, v219 offset:7396
  ds_read_b32 v24, v219 offset:7400
  ds_read_b32 v25, v219 offset:6336
  ds_read_b32 v26, v219 offset:6340
  ds_read_b32 v27, v219 offset:6344
  ds_read_b32 v28, v219 offset:6348
  ds_read_b32 v29, v219 offset:6352
  ds_read_b32 v30, v219 offset:6356
  ds_read_b32 v31, v219 offset:6360
  ds_read_b32 v32, v219 offset:6364
  ds_read_b32 v33, v219 offset:6368
  ds_read_b32 v34, v219 offset:5304
  ds_read_b32 v35, v219 offset:5308
  ds_read_b32 v36, v219 offset:5312
  ds_read_b32 v37, v219 offset:5316
  ds_read_b32 v38, v219 offset:5320
  ds_read_b32 v39, v219 offset:5324
  ds_read_b32 v40, v219 offset:5328
  ds_read_b32 v41, v219 offset:5332
  ds_read_b32 v42, v219 offset:5336
  ds_read_b32 v43, v219 offset:4272
  ds_read_b32 v44, v219 offset:4276
  ds_read_b32 v45, v219 offset:4280
  ds_read_b32 v46, v219 offset:4284
  ds_read_b32 v47, v219 offset:4288
  ds_read_b32 v48, v219 offset:4292
  ds_read_b32 v49, v219 offset:4296
  ds_read_b32 v50, v219 offset:4300
  ds_read_b32 v51, v219 offset:4304
  ds_read_b32 v52, v219 offset:3240
  ds_read_b32 v53, v219 offset:3244
  ds_read_b32 v54, v219 offset:3248
  ds_read_b32 v55, v219 offset:3252
  ds_read_b32 v56, v219 offset:3256
  ds_read_b32 v57, v219 offset:3260
  ds_read_b32 v58, v219 offset:3264
  ds_read_b32 v59, v219 offset:3268
  ds_read_b32 v60, v219 offset:3272
  ds_read_b32 v61, v219 offset:2208
  ds_read_b32 v62, v219 offset:2212
  ds_read_b32 v63, v219 offset:2216
  ds_read_b32 v64, v219 offset:2220
  ds_read_b32 v65, v219 offset:2224
  ds_read_b32 v66, v219 offset:2228
  ds_read_b32 v67, v219 offset:2232
  ds_read_b32 v68, v219 offset:2236
  ds_read_b32 v69, v219 offset:2240
  ds_read_b32 v70, v219 offset:1176
  ds_read_b32 v71, v219 offset:1180
  ds_read_b32 v72, v219 offset:1184
  ds_read_b32 v73, v219 offset:1188
  ds_read_b32 v74, v219 offset:1192
  ds_read_b32 v75, v219 offset:1196
  ds_read_b32 v76, v219 offset:1200
  ds_read_b32 v77, v219 offset:1204
  ds_read_b32 v78, v219 offset:1208
  ds_read_b32 v79, v219 offset:144
  ds_read_b32 v80, v219 offset:148
  ds_read_b32 v81, v219 offset:152
  ds_read_b32 v82, v219 offset:156
  ds_read_b32 v83, v219 offset:160
  ds_read_b32 v84, v219 offset:164
  ds_read_b32 v85, v219 offset:168
  ds_read_b32 v86, v219 offset:172
  ds_read_b32 v87, v219 offset:176
  v_mov_b32 v100, 0
  v_mov_b32 v101, 0
  v_mov_b32 v102, 0
  v_mov_b32 v103, 0
  v_mov_b32 v104, 0
  v_mov_b32 v105, 0
  v_mov_b32 v106, 0
  v_mov_b32 v107, 0
  s_waitcnt lgkmcnt(15)
  v_dot2c_f32_bf16 v100, v0, v16
  v_dot2c_f32_bf16 v101, v0, v25
  v_dot2c_f32_bf16 v102, v0, v34
  v_dot2c_f32_bf16 v103, v0, v43
  v_dot2c_f32_bf16 v104, v0, v52
  v_dot2c_f32_bf16 v105, v0, v61
  v_dot2c_f32_bf16 v106, v0, v70
  s_waitcnt lgkmcnt(8)
  v_dot2c_f32_bf16 v107, v0, v79
  v_dot2c_f32_bf16 v100, v1, v17
  v_dot2c_f32_bf16 v101, v1, v26
  v_dot2c_f32_bf16 v102, v1, v35
  v_dot2c_f32_bf16 v103, v1, v44
  v_dot2c_f32_bf16 v104, v1, v53
  v_dot2c_f32_bf16 v105, v1, v62
  v_dot2c_f32_bf16 v106, v1, v71
  s_waitcnt lgkmcnt(7)
  v_dot2c_f32_bf16 v107, v1, v80
  v_dot2c_f32_bf16 v100, v2, v18
  v_dot2c_f32_bf16 v101, v2, v27
  v_dot2c_f32_bf16 v102, v2, v36
  v_dot2c_f32_bf16 v103, v2, v45
  v_dot2c_f32_bf16 v104, v2, v54
  v_dot2c_f32_bf16 v105, v2, v63
  v_dot2c_f32_bf16 v106, v2, v72
  s_waitcnt lgkmcnt(6)
  v_dot2c_f32_bf16 v107, v2, v81
  v_dot2c_f32_bf16 v100, v3, v19
  v_dot2c_f32_bf16 v101, v3, v28
  v_dot2c_f32_bf16 v102, v3, v37
  v_dot2c_f32_bf16 v103, v3, v46
  v_dot2c_f32_bf16 v104, v3, v55
  v_dot2c_f32_bf16 v105, v3, v64
  v_dot2c_f32_bf16 v106, v3, v73
  s_waitcnt lgkmcnt(5)
  v_dot2c_f32_bf16 v107, v3, v82
  v_dot2c_f32_bf16 v100, v4, v20
  v_dot2c_f32_bf16 v101, v4, v29
  v_dot2c_f32_bf16 v102, v4, v38
  v_dot2c_f32_bf16 v103, v4, v47
  v_dot2c_f32_bf16 v104, v4, v56
  v_dot2c_f32_bf16 v105, v4, v65
  v_dot2c_f32_bf16 v106, v4, v74
  s_waitcnt lgkmcnt(4)
  v_dot2c_f32_bf16 v107, v4, v83
  v_dot2c_f32_bf16 v100, v5, v21
  v_dot2c_f32_bf16 v101, v5, v30
  v_dot2c_f32_bf16 v102, v5, v39
  v_dot2c_f32_bf16 v103, v5, v48
  v_dot2c_f32_bf16 v104, v5, v57
  v_dot2c_f32_bf16 v105, v5, v66
  v_dot2c_f32_bf16 v106, v5, v75
  s_waitcnt lgkmcnt(3)
  v_dot2c_f32_bf16 v107, v5, v84
  v_dot2c_f32_bf16 v100, v6, v22
  v_dot2c_f32_bf16 v101, v6, v31
  v_dot2c_f32_bf16 v102, v6, v40
  v_dot2c_f32_bf16 v103, v6, v49
  v_dot2c_f32_bf16 v104, v6, v58
  v_dot2c_f32_bf16 v105, v6, v67
  v_dot2c_f32_bf16 v106, v6, v76
  s_waitcnt lgkmcnt(2)
  v_dot2c_f32_bf16 v107, v6, v85
  v_dot2c_f32_bf16 v100, v7, v23
  v_dot2c_f32_bf16 v101, v7, v32
  v_dot2c_f32_bf16 v102, v7, v41
  v_dot2c_f32_bf16 v103, v7, v50
  v_dot2c_f32_bf16 v104, v7, v59
  v_dot2c_f32_bf16 v105, v7, v68
  v_dot2c_f32_bf16 v106, v7, v77
  s_waitcnt lgkmcnt(1)
  v_dot2c_f32_bf16 v107, v7, v86
  v_dot2c_f32_bf16 v100, v8, v24
  v_dot2c_f32_bf16 v101, v8, v33
  v_dot2c_f32_bf16 v102, v8, v42
  v_dot2c_f32_bf16 v103, v8, v51
  v_dot2c_f32_bf16 v104, v8, v60
  v_dot2c_f32_bf16 v105, v8, v69
  v_dot2c_f32_bf16 v106, v8, v78
  s_waitcnt lgkmcnt(0)
  v_dot2c_f32_bf16 v107, v8, v87
  ds_read_b32 v16, v219 offset:7512
  ds_read_b32 v17, v219 offset:7516
  ds_read_b32 v18, v219 offset:7520
  ds_read_b32 v19, v219 offset:7524
  ds_read_b32 v20, v219 offset:7528
  ds_read_b32 v21, v219 offset:7532
  ds_read_b32 v22, v219 offset:7536
  ds_read_b32 v23, v219 offset:7540
  ds_read_b32 v24, v219 offset:7544
  ds_read_b32 v25, v219 offset:6480
  ds_read_b32 v26, v219 offset:6484
  ds_read_b32 v27, v219 offset:6488
  ds_read_b32 v28, v219 offset:6492
  ds_read_b32 v29, v219 offset:6496
  ds_read_b32 v30, v219 offset:6500
  ds_read_b32 v31, v219 offset:6504
  ds_read_b32 v32, v219 offset:6508
  ds_read_b32 v33, v219 offset:6512
  ds_read_b32 v34, v219 offset:5448
  ds_read_b32 v35, v219 offset:5452
  ds_read_b32 v36, v219 offset:5456
  ds_read_b32 v37, v219 offset:5460
  ds_read_b32 v38, v219 offset:5464
  ds_read_b32 v39, v219 offset:5468
  ds_read_b32 v40, v219 offset:5472
  ds_read_b32 v41, v219 offset:5476
  ds_read_b32 v42, v219 offset:5480
  ds_read_b32 v43, v219 offset:4416
  ds_read_b32 v44, v219 offset:4420
  ds_read_b32 v45, v219 offset:4424
  ds_read_b32 v46, v219 offset:4428
  ds_read_b32 v47, v219 offset:4432
  ds_read_b32 v48, v219 offset:4436
  ds_read_b32 v49, v219 offset:4440
  ds_read_b32 v50, v219 offset:4444
  ds_read_b32 v51, v219 offset:4448
  ds_read_b32 v52, v219 offset:3384
  ds_read_b32 v53, v219 offset:3388
  ds_read_b32 v54, v219 offset:3392
  ds_read_b32 v55, v219 offset:3396
  ds_read_b32 v56, v219 offset:3400
  ds_read_b32 v57, v219 offset:3404
  ds_read_b32 v58, v219 offset:3408
  ds_read_b32 v59, v219 offset:3412
  ds_read_b32 v60, v219 offset:3416
  ds_read_b32 v61, v219 offset:2352
  ds_read_b32 v62, v219 offset:2356
  ds_read_b32 v63, v219 offset:2360
  ds_read_b32 v64, v219 offset:2364
  ds_read_b32 v65, v219 offset:2368
  ds_read_b32 v66, v219 offset:2372
  ds_read_b32 v67, v219 offset:2376
  ds_read_b32 v68, v219 offset:2380
  ds_read_b32 v69, v219 offset:2384
  ds_read_b32 v70, v219 offset:1320
  ds_read_b32 v71, v219 offset:1324
  ds_read_b32 v72, v219 offset:1328
  ds_read_b32 v73, v219 offset:1332
  ds_read_b32 v74, v219 offset:1336
  ds_read_b32 v75, v219 offset:1340
  ds_read_b32 v76, v219 offset:1344
  ds_read_b32 v77, v219 offset:1348
  ds_read_b32 v78, v219 offset:1352
  ds_read_b32 v79, v219 offset:288
  ds_read_b32 v80, v219 offset:292
  ds_read_b32 v81, v219 offset:296
  ds_read_b32 v82, v219 offset:300
  ds_read_b32 v83, v219 offset:304
  ds_read_b32 v84, v219 offset:308
  ds_read_b32 v85, v219 offset:312
  ds_read_b32 v86, v219 offset:316
  ds_read_b32 v87, v219 offset:320
  v_add_u32 v211, s66, v200
  v_mov_b32 v212, 0xf149f2ca
  v_mul_f32 v100, s57, v100
  v_mul_f32 v101, s57, v101
  v_mul_f32 v102, s57, v102
  v_mul_f32 v103, s57, v103
  v_mul_f32 v104, s57, v104
  v_mul_f32 v105, s57, v105
  v_mul_f32 v106, s57, v106
  v_mul_f32 v107, s57, v107
  v_cmp_gt_u32 vcc, 2, v211
  s_nop 1
  v_cndmask_b32 v101, v101, v212, vcc
  v_cmp_gt_u32 vcc, 4, v211
  s_nop 1
  v_cndmask_b32 v102, v102, v212, vcc
  v_cmp_gt_u32 vcc, 6, v211
  s_nop 1
  v_cndmask_b32 v103, v103, v212, vcc
  v_cmp_gt_u32 vcc, 8, v211
  s_nop 1
  v_cndmask_b32 v104, v104, v212, vcc
  v_cmp_gt_u32 vcc, 10, v211
  s_nop 1
  v_cndmask_b32 v105, v105, v212, vcc
  v_cmp_gt_u32 vcc, 12, v211
  s_nop 1
  v_cndmask_b32 v106, v106, v212, vcc
  v_cmp_gt_u32 vcc, 14, v211
  s_nop 1
  v_cndmask_b32 v107, v107, v212, vcc
  v_max3_f32 v213, v100, v101, v102
  v_max3_f32 v213, v213, v103, v104
  v_max3_f32 v213, v213, v105, v106
  v_max_f32 v213, v213, v107
  v_sub_f32 v100, v100, v213
  v_sub_f32 v101, v101, v213
  v_sub_f32 v102, v102, v213
  v_sub_f32 v103, v103, v213
  v_sub_f32 v104, v104, v213
  v_sub_f32 v105, v105, v213
  v_sub_f32 v106, v106, v213
  v_sub_f32 v107, v107, v213
  v_exp_f32 v100, v100
  v_exp_f32 v101, v101
  v_exp_f32 v102, v102
  v_exp_f32 v103, v103
  v_exp_f32 v104, v104
  v_exp_f32 v105, v105
  v_exp_f32 v106, v106
  v_exp_f32 v107, v107
  v_add_f32 v213, v100, v101
  v_add_f32 v213, v213, v102
  v_add_f32 v213, v213, v103
  v_add_f32 v213, v213, v104
  v_add_f32 v213, v213, v105
  v_add_f32 v213, v213, v106
  v_add_f32 v213, v213, v107
  v_rcp_f32 v213, v213
  v_mov_b32 v214, 0
  v_mul_f32 v100, v213, v100
  v_mul_f32 v101, v213, v101
  v_mul_f32 v102, v213, v102
  v_mul_f32 v103, v213, v103
  v_mul_f32 v104, v213, v104
  v_mul_f32 v105, v213, v105
  v_mul_f32 v106, v213, v106
  v_mul_f32 v107, v213, v107
  v_mov_b32 v112, 0
  v_mov_b32 v113, 0
  v_mov_b32 v114, 0
  v_mov_b32 v115, 0
  v_mov_b32 v116, 0
  v_mov_b32 v117, 0
  v_mov_b32 v118, 0
  v_mov_b32 v119, 0
  v_mov_b32 v120, 0
  v_mov_b32 v121, 0
  v_mov_b32 v122, 0
  v_mov_b32 v123, 0
  v_mov_b32 v124, 0
  v_mov_b32 v125, 0
  v_mov_b32 v126, 0
  v_mov_b32 v127, 0
  v_mov_b32 v128, 0
  v_mov_b32 v129, 0
  v_cvt_pk_bf16_f32 v0, v100, v214
  v_cvt_pk_bf16_f32 v1, v214, v100
  s_waitcnt lgkmcnt(15)
  v_dot2c_f32_bf16 v112, v16, v0
  v_dot2c_f32_bf16 v113, v16, v1
  v_dot2c_f32_bf16 v114, v17, v0
  v_dot2c_f32_bf16 v115, v17, v1
  v_dot2c_f32_bf16 v116, v18, v0
  v_dot2c_f32_bf16 v117, v18, v1
  v_dot2c_f32_bf16 v118, v19, v0
  v_dot2c_f32_bf16 v119, v19, v1
  v_dot2c_f32_bf16 v120, v20, v0
  v_dot2c_f32_bf16 v121, v20, v1
  v_dot2c_f32_bf16 v122, v21, v0
  v_dot2c_f32_bf16 v123, v21, v1
  v_dot2c_f32_bf16 v124, v22, v0
  v_dot2c_f32_bf16 v125, v22, v1
  v_dot2c_f32_bf16 v126, v23, v0
  v_dot2c_f32_bf16 v127, v23, v1
  v_dot2c_f32_bf16 v128, v24, v0
  v_dot2c_f32_bf16 v129, v24, v1
  v_cvt_pk_bf16_f32 v2, v101, v214
  v_cvt_pk_bf16_f32 v3, v214, v101
  v_dot2c_f32_bf16 v112, v25, v2
  v_dot2c_f32_bf16 v113, v25, v3
  v_dot2c_f32_bf16 v114, v26, v2
  v_dot2c_f32_bf16 v115, v26, v3
  v_dot2c_f32_bf16 v116, v27, v2
  v_dot2c_f32_bf16 v117, v27, v3
  v_dot2c_f32_bf16 v118, v28, v2
  v_dot2c_f32_bf16 v119, v28, v3
  v_dot2c_f32_bf16 v120, v29, v2
  v_dot2c_f32_bf16 v121, v29, v3
  v_dot2c_f32_bf16 v122, v30, v2
  v_dot2c_f32_bf16 v123, v30, v3
  v_dot2c_f32_bf16 v124, v31, v2
  v_dot2c_f32_bf16 v125, v31, v3
  v_dot2c_f32_bf16 v126, v32, v2
  v_dot2c_f32_bf16 v127, v32, v3
  v_dot2c_f32_bf16 v128, v33, v2
  v_dot2c_f32_bf16 v129, v33, v3
  v_cvt_pk_bf16_f32 v0, v102, v214
  v_cvt_pk_bf16_f32 v1, v214, v102
  v_dot2c_f32_bf16 v112, v34, v0
  v_dot2c_f32_bf16 v113, v34, v1
  v_dot2c_f32_bf16 v114, v35, v0
  v_dot2c_f32_bf16 v115, v35, v1
  v_dot2c_f32_bf16 v116, v36, v0
  v_dot2c_f32_bf16 v117, v36, v1
  v_dot2c_f32_bf16 v118, v37, v0
  v_dot2c_f32_bf16 v119, v37, v1
  v_dot2c_f32_bf16 v120, v38, v0
  v_dot2c_f32_bf16 v121, v38, v1
  v_dot2c_f32_bf16 v122, v39, v0
  v_dot2c_f32_bf16 v123, v39, v1
  v_dot2c_f32_bf16 v124, v40, v0
  v_dot2c_f32_bf16 v125, v40, v1
  v_dot2c_f32_bf16 v126, v41, v0
  v_dot2c_f32_bf16 v127, v41, v1
  v_dot2c_f32_bf16 v128, v42, v0
  v_dot2c_f32_bf16 v129, v42, v1
  v_cvt_pk_bf16_f32 v2, v103, v214
  v_cvt_pk_bf16_f32 v3, v214, v103
  v_dot2c_f32_bf16 v112, v43, v2
  v_dot2c_f32_bf16 v113, v43, v3
  v_dot2c_f32_bf16 v114, v44, v2
  v_dot2c_f32_bf16 v115, v44, v3
  v_dot2c_f32_bf16 v116, v45, v2
  v_dot2c_f32_bf16 v117, v45, v3
  v_dot2c_f32_bf16 v118, v46, v2
  v_dot2c_f32_bf16 v119, v46, v3
  v_dot2c_f32_bf16 v120, v47, v2
  v_dot2c_f32_bf16 v121, v47, v3
  v_dot2c_f32_bf16 v122, v48, v2
  v_dot2c_f32_bf16 v123, v48, v3
  v_dot2c_f32_bf16 v124, v49, v2
  v_dot2c_f32_bf16 v125, v49, v3
  v_dot2c_f32_bf16 v126, v50, v2
  v_dot2c_f32_bf16 v127, v50, v3
  v_dot2c_f32_bf16 v128, v51, v2
  v_dot2c_f32_bf16 v129, v51, v3
  v_cvt_pk_bf16_f32 v0, v104, v214
  v_cvt_pk_bf16_f32 v1, v214, v104
  v_dot2c_f32_bf16 v112, v52, v0
  v_dot2c_f32_bf16 v113, v52, v1
  v_dot2c_f32_bf16 v114, v53, v0
  v_dot2c_f32_bf16 v115, v53, v1
  v_dot2c_f32_bf16 v116, v54, v0
  v_dot2c_f32_bf16 v117, v54, v1
  v_dot2c_f32_bf16 v118, v55, v0
  v_dot2c_f32_bf16 v119, v55, v1
  v_dot2c_f32_bf16 v120, v56, v0
  v_dot2c_f32_bf16 v121, v56, v1
  v_dot2c_f32_bf16 v122, v57, v0
  v_dot2c_f32_bf16 v123, v57, v1
  v_dot2c_f32_bf16 v124, v58, v0
  v_dot2c_f32_bf16 v125, v58, v1
  v_dot2c_f32_bf16 v126, v59, v0
  v_dot2c_f32_bf16 v127, v59, v1
  v_dot2c_f32_bf16 v128, v60, v0
  v_dot2c_f32_bf16 v129, v60, v1
  v_cvt_pk_bf16_f32 v2, v105, v214
  v_cvt_pk_bf16_f32 v3, v214, v105
  v_dot2c_f32_bf16 v112, v61, v2
  v_dot2c_f32_bf16 v113, v61, v3
  v_dot2c_f32_bf16 v114, v62, v2
  v_dot2c_f32_bf16 v115, v62, v3
  v_dot2c_f32_bf16 v116, v63, v2
  v_dot2c_f32_bf16 v117, v63, v3
  v_dot2c_f32_bf16 v118, v64, v2
  v_dot2c_f32_bf16 v119, v64, v3
  v_dot2c_f32_bf16 v120, v65, v2
  v_dot2c_f32_bf16 v121, v65, v3
  v_dot2c_f32_bf16 v122, v66, v2
  v_dot2c_f32_bf16 v123, v66, v3
  v_dot2c_f32_bf16 v124, v67, v2
  v_dot2c_f32_bf16 v125, v67, v3
  v_dot2c_f32_bf16 v126, v68, v2
  v_dot2c_f32_bf16 v127, v68, v3
  v_dot2c_f32_bf16 v128, v69, v2
  v_dot2c_f32_bf16 v129, v69, v3
  v_cvt_pk_bf16_f32 v0, v106, v214
  v_cvt_pk_bf16_f32 v1, v214, v106
  v_dot2c_f32_bf16 v112, v70, v0
  v_dot2c_f32_bf16 v113, v70, v1
  v_dot2c_f32_bf16 v114, v71, v0
  v_dot2c_f32_bf16 v115, v71, v1
  v_dot2c_f32_bf16 v116, v72, v0
  v_dot2c_f32_bf16 v117, v72, v1
  s_waitcnt lgkmcnt(14)
  v_dot2c_f32_bf16 v118, v73, v0
  v_dot2c_f32_bf16 v119, v73, v1
  s_waitcnt lgkmcnt(13)
  v_dot2c_f32_bf16 v120, v74, v0
  v_dot2c_f32_bf16 v121, v74, v1
  s_waitcnt lgkmcnt(12)
  v_dot2c_f32_bf16 v122, v75, v0
  v_dot2c_f32_bf16 v123, v75, v1
  s_waitcnt lgkmcnt(11)
  v_dot2c_f32_bf16 v124, v76, v0
  v_dot2c_f32_bf16 v125, v76, v1
  s_waitcnt lgkmcnt(10)
  v_dot2c_f32_bf16 v126, v77, v0
  v_dot2c_f32_bf16 v127, v77, v1
  s_waitcnt lgkmcnt(9)
  v_dot2c_f32_bf16 v128, v78, v0
  v_dot2c_f32_bf16 v129, v78, v1
  v_cvt_pk_bf16_f32 v2, v107, v214
  v_cvt_pk_bf16_f32 v3, v214, v107
  s_waitcnt lgkmcnt(8)
  v_dot2c_f32_bf16 v112, v79, v2
  v_dot2c_f32_bf16 v113, v79, v3
  s_waitcnt lgkmcnt(7)
  v_dot2c_f32_bf16 v114, v80, v2
  v_dot2c_f32_bf16 v115, v80, v3
  s_waitcnt lgkmcnt(6)
  v_dot2c_f32_bf16 v116, v81, v2
  v_dot2c_f32_bf16 v117, v81, v3
  s_waitcnt lgkmcnt(5)
  v_dot2c_f32_bf16 v118, v82, v2
  v_dot2c_f32_bf16 v119, v82, v3
  s_waitcnt lgkmcnt(4)
  v_dot2c_f32_bf16 v120, v83, v2
  v_dot2c_f32_bf16 v121, v83, v3
  s_waitcnt lgkmcnt(3)
  v_dot2c_f32_bf16 v122, v84, v2
  v_dot2c_f32_bf16 v123, v84, v3
  s_waitcnt lgkmcnt(2)
  v_dot2c_f32_bf16 v124, v85, v2
  v_dot2c_f32_bf16 v125, v85, v3
  s_waitcnt lgkmcnt(1)
  v_dot2c_f32_bf16 v126, v86, v2
  v_dot2c_f32_bf16 v127, v86, v3
  s_waitcnt lgkmcnt(0)
  v_dot2c_f32_bf16 v128, v87, v2
  v_dot2c_f32_bf16 v129, v87, v3
  v_cvt_pk_bf16_f32 v132, v112, v113
  v_cvt_pk_bf16_f32 v133, v114, v115
  v_cvt_pk_bf16_f32 v134, v116, v117
  v_cvt_pk_bf16_f32 v135, v118, v119
  v_cvt_pk_bf16_f32 v136, v120, v121
  v_cvt_pk_bf16_f32 v137, v122, v123
  v_cvt_pk_bf16_f32 v138, v124, v125
  v_cvt_pk_bf16_f32 v139, v126, v127
  v_cvt_pk_bf16_f32 v140, v128, v129
  ds_write_b32 v220, v132 offset:0
  ds_write_b32 v220, v133 offset:4
  ds_write_b32 v220, v134 offset:8
  ds_write_b32 v220, v135 offset:12
  ds_write_b32 v220, v136 offset:16
  ds_write_b32 v220, v137 offset:20
  ds_write_b32 v220, v138 offset:24
  ds_write_b32 v220, v139 offset:28
  ds_write_b32 v220, v140 offset:32
  s_waitcnt lgkmcnt(0)
  s_barrier
  ds_read_b128 v[144:147], v218 offset:0
  ds_read_b128 v[148:151], v218 offset:1024
  ds_read_b128 v[152:155], v218 offset:2048
  s_waitcnt lgkmcnt(2)
  buffer_store_dwordx4 v[144:147], v218, s[8:11], s64 offen offset:0 sc1
  s_waitcnt lgkmcnt(1)
  buffer_store_dwordx4 v[148:151], v218, s[8:11], s64 offen offset:1024 sc1
  s_waitcnt lgkmcnt(0)
  buffer_store_dwordx4 v[152:155], v218, s[8:11], s64 offen offset:2048 sc1
  v_add_u32 v219, 33024, v219
  s_add_u32 s66, s66, 64
  s_add_u32 s64, s64, 9216
  ds_read_b32 v0, v219 offset:7224
  ds_read_b32 v1, v219 offset:7228
  ds_read_b32 v2, v219 offset:7232
  ds_read_b32 v3, v219 offset:7236
  ds_read_b32 v4, v219 offset:7240
  ds_read_b32 v5, v219 offset:7244
  ds_read_b32 v6, v219 offset:7248
  ds_read_b32 v7, v219 offset:7252
  ds_read_b32 v8, v219 offset:7256
  ds_read_b32 v16, v219 offset:7368
  ds_read_b32 v17, v219 offset:7372
  ds_read_b32 v18, v219 offset:7376
  ds_read_b32 v19, v219 offset:7380
  ds_read_b32 v20, v219 offset:7384
  ds_read_b32 v21, v219 offset:7388
  ds_read_b32 v22, v219 offset:7392
  ds_read_b32 v23, v219 offset:7396
  ds_read_b32 v24, v219 offset:7400
  ds_read_b32 v25, v219 offset:6336
  ds_read_b32 v26, v219 offset:6340
  ds_read_b32 v27, v219 offset:6344
  ds_read_b32 v28, v219 offset:6348
  ds_read_b32 v29, v219 offset:6352
  ds_read_b32 v30, v219 offset:6356
  ds_read_b32 v31, v219 offset:6360
  ds_read_b32 v32, v219 offset:6364
  ds_read_b32 v33, v219 offset:6368
  ds_read_b32 v34, v219 offset:5304
  ds_read_b32 v35, v219 offset:5308
  ds_read_b32 v36, v219 offset:5312
  ds_read_b32 v37, v219 offset:5316
  ds_read_b32 v38, v219 offset:5320
  ds_read_b32 v39, v219 offset:5324
  ds_read_b32 v40, v219 offset:5328
  ds_read_b32 v41, v219 offset:5332
  ds_read_b32 v42, v219 offset:5336
  ds_read_b32 v43, v219 offset:4272
  ds_read_b32 v44, v219 offset:4276
  ds_read_b32 v45, v219 offset:4280
  ds_read_b32 v46, v219 offset:4284
  ds_read_b32 v47, v219 offset:4288
  ds_read_b32 v48, v219 offset:4292
  ds_read_b32 v49, v219 offset:4296
  ds_read_b32 v50, v219 offset:4300
  ds_read_b32 v51, v219 offset:4304
  ds_read_b32 v52, v219 offset:3240
  ds_read_b32 v53, v219 offset:3244
  ds_read_b32 v54, v219 offset:3248
  ds_read_b32 v55, v219 offset:3252
  ds_read_b32 v56, v219 offset:3256
  ds_read_b32 v57, v219 offset:3260
  ds_read_b32 v58, v219 offset:3264
  ds_read_b32 v59, v219 offset:3268
  ds_read_b32 v60, v219 offset:3272
  ds_read_b32 v61, v219 offset:2208
  ds_read_b32 v62, v219 offset:2212
  ds_read_b32 v63, v219 offset:2216
  ds_read_b32 v64, v219 offset:2220
  ds_read_b32 v65, v219 offset:2224
  ds_read_b32 v66, v219 offset:2228
  ds_read_b32 v67, v219 offset:2232
  ds_read_b32 v68, v219 offset:2236
  ds_read_b32 v69, v219 offset:2240
  ds_read_b32 v70, v219 offset:1176
  ds_read_b32 v71, v219 offset:1180
  ds_read_b32 v72, v219 offset:1184
  ds_read_b32 v73, v219 offset:1188
  ds_read_b32 v74, v219 offset:1192
  ds_read_b32 v75, v219 offset:1196
  ds_read_b32 v76, v219 offset:1200
  ds_read_b32 v77, v219 offset:1204
  ds_read_b32 v78, v219 offset:1208
  ds_read_b32 v79, v219 offset:144
  ds_read_b32 v80, v219 offset:148
  ds_read_b32 v81, v219 offset:152
  ds_read_b32 v82, v219 offset:156
  ds_read_b32 v83, v219 offset:160
  ds_read_b32 v84, v219 offset:164
  ds_read_b32 v85, v219 offset:168
  ds_read_b32 v86, v219 offset:172
  ds_read_b32 v87, v219 offset:176
  v_mov_b32 v100, 0
  v_mov_b32 v101, 0
  v_mov_b32 v102, 0
  v_mov_b32 v103, 0
  v_mov_b32 v104, 0
  v_mov_b32 v105, 0
  v_mov_b32 v106, 0
  v_mov_b32 v107, 0
  s_waitcnt lgkmcnt(15)
  v_dot2c_f32_bf16 v100, v0, v16
  v_dot2c_f32_bf16 v101, v0, v25
  v_dot2c_f32_bf16 v102, v0, v34
  v_dot2c_f32_bf16 v103, v0, v43
  v_dot2c_f32_bf16 v104, v0, v52
  v_dot2c_f32_bf16 v105, v0, v61
  v_dot2c_f32_bf16 v106, v0, v70
  s_waitcnt lgkmcnt(8)
  v_dot2c_f32_bf16 v107, v0, v79
  v_dot2c_f32_bf16 v100, v1, v17
  v_dot2c_f32_bf16 v101, v1, v26
  v_dot2c_f32_bf16 v102, v1, v35
  v_dot2c_f32_bf16 v103, v1, v44
  v_dot2c_f32_bf16 v104, v1, v53
  v_dot2c_f32_bf16 v105, v1, v62
  v_dot2c_f32_bf16 v106, v1, v71
  s_waitcnt lgkmcnt(7)
  v_dot2c_f32_bf16 v107, v1, v80
  v_dot2c_f32_bf16 v100, v2, v18
  v_dot2c_f32_bf16 v101, v2, v27
  v_dot2c_f32_bf16 v102, v2, v36
  v_dot2c_f32_bf16 v103, v2, v45
  v_dot2c_f32_bf16 v104, v2, v54
  v_dot2c_f32_bf16 v105, v2, v63
  v_dot2c_f32_bf16 v106, v2, v72
  s_waitcnt lgkmcnt(6)
  v_dot2c_f32_bf16 v107, v2, v81
  v_dot2c_f32_bf16 v100, v3, v19
  v_dot2c_f32_bf16 v101, v3, v28
  v_dot2c_f32_bf16 v102, v3, v37
  v_dot2c_f32_bf16 v103, v3, v46
  v_dot2c_f32_bf16 v104, v3, v55
  v_dot2c_f32_bf16 v105, v3, v64
  v_dot2c_f32_bf16 v106, v3, v73
  s_waitcnt lgkmcnt(5)
  v_dot2c_f32_bf16 v107, v3, v82
  v_dot2c_f32_bf16 v100, v4, v20
  v_dot2c_f32_bf16 v101, v4, v29
  v_dot2c_f32_bf16 v102, v4, v38
  v_dot2c_f32_bf16 v103, v4, v47
  v_dot2c_f32_bf16 v104, v4, v56
  v_dot2c_f32_bf16 v105, v4, v65
  v_dot2c_f32_bf16 v106, v4, v74
  s_waitcnt lgkmcnt(4)
  v_dot2c_f32_bf16 v107, v4, v83
  v_dot2c_f32_bf16 v100, v5, v21
  v_dot2c_f32_bf16 v101, v5, v30
  v_dot2c_f32_bf16 v102, v5, v39
  v_dot2c_f32_bf16 v103, v5, v48
  v_dot2c_f32_bf16 v104, v5, v57
  v_dot2c_f32_bf16 v105, v5, v66
  v_dot2c_f32_bf16 v106, v5, v75
  s_waitcnt lgkmcnt(3)
  v_dot2c_f32_bf16 v107, v5, v84
  v_dot2c_f32_bf16 v100, v6, v22
  v_dot2c_f32_bf16 v101, v6, v31
  v_dot2c_f32_bf16 v102, v6, v40
  v_dot2c_f32_bf16 v103, v6, v49
  v_dot2c_f32_bf16 v104, v6, v58
  v_dot2c_f32_bf16 v105, v6, v67
  v_dot2c_f32_bf16 v106, v6, v76
  s_waitcnt lgkmcnt(2)
  v_dot2c_f32_bf16 v107, v6, v85
  v_dot2c_f32_bf16 v100, v7, v23
  v_dot2c_f32_bf16 v101, v7, v32
  v_dot2c_f32_bf16 v102, v7, v41
  v_dot2c_f32_bf16 v103, v7, v50
  v_dot2c_f32_bf16 v104, v7, v59
  v_dot2c_f32_bf16 v105, v7, v68
  v_dot2c_f32_bf16 v106, v7, v77
  s_waitcnt lgkmcnt(1)
  v_dot2c_f32_bf16 v107, v7, v86
  v_dot2c_f32_bf16 v100, v8, v24
  v_dot2c_f32_bf16 v101, v8, v33
  v_dot2c_f32_bf16 v102, v8, v42
  v_dot2c_f32_bf16 v103, v8, v51
  v_dot2c_f32_bf16 v104, v8, v60
  v_dot2c_f32_bf16 v105, v8, v69
  v_dot2c_f32_bf16 v106, v8, v78
  s_waitcnt lgkmcnt(0)
  v_dot2c_f32_bf16 v107, v8, v87
  ds_read_b32 v16, v219 offset:7512
  ds_read_b32 v17, v219 offset:7516
  ds_read_b32 v18, v219 offset:7520
  ds_read_b32 v19, v219 offset:7524
  ds_read_b32 v20, v219 offset:7528
  ds_read_b32 v21, v219 offset:7532
  ds_read_b32 v22, v219 offset:7536
  ds_read_b32 v23, v219 offset:7540
  ds_read_b32 v24, v219 offset:7544
  ds_read_b32 v25, v219 offset:6480
  ds_read_b32 v26, v219 offset:6484
  ds_read_b32 v27, v219 offset:6488
  ds_read_b32 v28, v219 offset:6492
  ds_read_b32 v29, v219 offset:6496
  ds_read_b32 v30, v219 offset:6500
  ds_read_b32 v31, v219 offset:6504
  ds_read_b32 v32, v219 offset:6508
  ds_read_b32 v33, v219 offset:6512
  ds_read_b32 v34, v219 offset:5448
  ds_read_b32 v35, v219 offset:5452
  ds_read_b32 v36, v219 offset:5456
  ds_read_b32 v37, v219 offset:5460
  ds_read_b32 v38, v219 offset:5464
  ds_read_b32 v39, v219 offset:5468
  ds_read_b32 v40, v219 offset:5472
  ds_read_b32 v41, v219 offset:5476
  ds_read_b32 v42, v219 offset:5480
  ds_read_b32 v43, v219 offset:4416
  ds_read_b32 v44, v219 offset:4420
  ds_read_b32 v45, v219 offset:4424
  ds_read_b32 v46, v219 offset:4428
  ds_read_b32 v47, v219 offset:4432
  ds_read_b32 v48, v219 offset:4436
  ds_read_b32 v49, v219 offset:4440
  ds_read_b32 v50, v219 offset:4444
  ds_read_b32 v51, v219 offset:4448
  ds_read_b32 v52, v219 offset:3384
  ds_read_b32 v53, v219 offset:3388
  ds_read_b32 v54, v219 offset:3392
  ds_read_b32 v55, v219 offset:3396
  ds_read_b32 v56, v219 offset:3400
  ds_read_b32 v57, v219 offset:3404
  ds_read_b32 v58, v219 offset:3408
  ds_read_b32 v59, v219 offset:3412
  ds_read_b32 v60, v219 offset:3416
  ds_read_b32 v61, v219 offset:2352
  ds_read_b32 v62, v219 offset:2356
  ds_read_b32 v63, v219 offset:2360
  ds_read_b32 v64, v219 offset:2364
  ds_read_b32 v65, v219 offset:2368
  ds_read_b32 v66, v219 offset:2372
  ds_read_b32 v67, v219 offset:2376
  ds_read_b32 v68, v219 offset:2380
  ds_read_b32 v69, v219 offset:2384
  ds_read_b32 v70, v219 offset:1320
  ds_read_b32 v71, v219 offset:1324
  ds_read_b32 v72, v219 offset:1328
  ds_read_b32 v73, v219 offset:1332
  ds_read_b32 v74, v219 offset:1336
  ds_read_b32 v75, v219 offset:1340
  ds_read_b32 v76, v219 offset:1344
  ds_read_b32 v77, v219 offset:1348
  ds_read_b32 v78, v219 offset:1352
  ds_read_b32 v79, v219 offset:288
  ds_read_b32 v80, v219 offset:292
  ds_read_b32 v81, v219 offset:296
  ds_read_b32 v82, v219 offset:300
  ds_read_b32 v83, v219 offset:304
  ds_read_b32 v84, v219 offset:308
  ds_read_b32 v85, v219 offset:312
  ds_read_b32 v86, v219 offset:316
  ds_read_b32 v87, v219 offset:320
  v_add_u32 v211, s66, v200
  v_mov_b32 v212, 0xf149f2ca
  v_mul_f32 v100, s57, v100
  v_mul_f32 v101, s57, v101
  v_mul_f32 v102, s57, v102
  v_mul_f32 v103, s57, v103
  v_mul_f32 v104, s57, v104
  v_mul_f32 v105, s57, v105
  v_mul_f32 v106, s57, v106
  v_mul_f32 v107, s57, v107
  v_cmp_gt_u32 vcc, 2, v211
  s_nop 1
  v_cndmask_b32 v101, v101, v212, vcc
  v_cmp_gt_u32 vcc, 4, v211
  s_nop 1
  v_cndmask_b32 v102, v102, v212, vcc
  v_cmp_gt_u32 vcc, 6, v211
  s_nop 1
  v_cndmask_b32 v103, v103, v212, vcc
  v_cmp_gt_u32 vcc, 8, v211
  s_nop 1
  v_cndmask_b32 v104, v104, v212, vcc
  v_cmp_gt_u32 vcc, 10, v211
  s_nop 1
  v_cndmask_b32 v105, v105, v212, vcc
  v_cmp_gt_u32 vcc, 12, v211
  s_nop 1
  v_cndmask_b32 v106, v106, v212, vcc
  v_cmp_gt_u32 vcc, 14, v211
  s_nop 1
  v_cndmask_b32 v107, v107, v212, vcc
  v_max3_f32 v213, v100, v101, v102
  v_max3_f32 v213, v213, v103, v104
  v_max3_f32 v213, v213, v105, v106
  v_max_f32 v213, v213, v107
  v_sub_f32 v100, v100, v213
  v_sub_f32 v101, v101, v213
  v_sub_f32 v102, v102, v213
  v_sub_f32 v103, v103, v213
  v_sub_f32 v104, v104, v213
  v_sub_f32 v105, v105, v213
  v_sub_f32 v106, v106, v213
  v_sub_f32 v107, v107, v213
  v_exp_f32 v100, v100
  v_exp_f32 v101, v101
  v_exp_f32 v102, v102
  v_exp_f32 v103, v103
  v_exp_f32 v104, v104
  v_exp_f32 v105, v105
  v_exp_f32 v106, v106
  v_exp_f32 v107, v107
  v_add_f32 v213, v100, v101
  v_add_f32 v213, v213, v102
  v_add_f32 v213, v213, v103
  v_add_f32 v213, v213, v104
  v_add_f32 v213, v213, v105
  v_add_f32 v213, v213, v106
  v_add_f32 v213, v213, v107
  v_rcp_f32 v213, v213
  v_mov_b32 v214, 0
  v_mul_f32 v100, v213, v100
  v_mul_f32 v101, v213, v101
  v_mul_f32 v102, v213, v102
  v_mul_f32 v103, v213, v103
  v_mul_f32 v104, v213, v104
  v_mul_f32 v105, v213, v105
  v_mul_f32 v106, v213, v106
  v_mul_f32 v107, v213, v107
  v_mov_b32 v112, 0
  v_mov_b32 v113, 0
  v_mov_b32 v114, 0
  v_mov_b32 v115, 0
  v_mov_b32 v116, 0
  v_mov_b32 v117, 0
  v_mov_b32 v118, 0
  v_mov_b32 v119, 0
  v_mov_b32 v120, 0
  v_mov_b32 v121, 0
  v_mov_b32 v122, 0
  v_mov_b32 v123, 0
  v_mov_b32 v124, 0
  v_mov_b32 v125, 0
  v_mov_b32 v126, 0
  v_mov_b32 v127, 0
  v_mov_b32 v128, 0
  v_mov_b32 v129, 0
  v_cvt_pk_bf16_f32 v0, v100, v214
  v_cvt_pk_bf16_f32 v1, v214, v100
  s_waitcnt lgkmcnt(15)
  v_dot2c_f32_bf16 v112, v16, v0
  v_dot2c_f32_bf16 v113, v16, v1
  v_dot2c_f32_bf16 v114, v17, v0
  v_dot2c_f32_bf16 v115, v17, v1
  v_dot2c_f32_bf16 v116, v18, v0
  v_dot2c_f32_bf16 v117, v18, v1
  v_dot2c_f32_bf16 v118, v19, v0
  v_dot2c_f32_bf16 v119, v19, v1
  v_dot2c_f32_bf16 v120, v20, v0
  v_dot2c_f32_bf16 v121, v20, v1
  v_dot2c_f32_bf16 v122, v21, v0
  v_dot2c_f32_bf16 v123, v21, v1
  v_dot2c_f32_bf16 v124, v22, v0
  v_dot2c_f32_bf16 v125, v22, v1
  v_dot2c_f32_bf16 v126, v23, v0
  v_dot2c_f32_bf16 v127, v23, v1
  v_dot2c_f32_bf16 v128, v24, v0
  v_dot2c_f32_bf16 v129, v24, v1
  v_cvt_pk_bf16_f32 v2, v101, v214
  v_cvt_pk_bf16_f32 v3, v214, v101
  v_dot2c_f32_bf16 v112, v25, v2
  v_dot2c_f32_bf16 v113, v25, v3
  v_dot2c_f32_bf16 v114, v26, v2
  v_dot2c_f32_bf16 v115, v26, v3
  v_dot2c_f32_bf16 v116, v27, v2
  v_dot2c_f32_bf16 v117, v27, v3
  v_dot2c_f32_bf16 v118, v28, v2
  v_dot2c_f32_bf16 v119, v28, v3
  v_dot2c_f32_bf16 v120, v29, v2
  v_dot2c_f32_bf16 v121, v29, v3
  v_dot2c_f32_bf16 v122, v30, v2
  v_dot2c_f32_bf16 v123, v30, v3
  v_dot2c_f32_bf16 v124, v31, v2
  v_dot2c_f32_bf16 v125, v31, v3
  v_dot2c_f32_bf16 v126, v32, v2
  v_dot2c_f32_bf16 v127, v32, v3
  v_dot2c_f32_bf16 v128, v33, v2
  v_dot2c_f32_bf16 v129, v33, v3
  v_cvt_pk_bf16_f32 v0, v102, v214
  v_cvt_pk_bf16_f32 v1, v214, v102
  v_dot2c_f32_bf16 v112, v34, v0
  v_dot2c_f32_bf16 v113, v34, v1
  v_dot2c_f32_bf16 v114, v35, v0
  v_dot2c_f32_bf16 v115, v35, v1
  v_dot2c_f32_bf16 v116, v36, v0
  v_dot2c_f32_bf16 v117, v36, v1
  v_dot2c_f32_bf16 v118, v37, v0
  v_dot2c_f32_bf16 v119, v37, v1
  v_dot2c_f32_bf16 v120, v38, v0
  v_dot2c_f32_bf16 v121, v38, v1
  v_dot2c_f32_bf16 v122, v39, v0
  v_dot2c_f32_bf16 v123, v39, v1
  v_dot2c_f32_bf16 v124, v40, v0
  v_dot2c_f32_bf16 v125, v40, v1
  v_dot2c_f32_bf16 v126, v41, v0
  v_dot2c_f32_bf16 v127, v41, v1
  v_dot2c_f32_bf16 v128, v42, v0
  v_dot2c_f32_bf16 v129, v42, v1
  v_cvt_pk_bf16_f32 v2, v103, v214
  v_cvt_pk_bf16_f32 v3, v214, v103
  v_dot2c_f32_bf16 v112, v43, v2
  v_dot2c_f32_bf16 v113, v43, v3
  v_dot2c_f32_bf16 v114, v44, v2
  v_dot2c_f32_bf16 v115, v44, v3
  v_dot2c_f32_bf16 v116, v45, v2
  v_dot2c_f32_bf16 v117, v45, v3
  v_dot2c_f32_bf16 v118, v46, v2
  v_dot2c_f32_bf16 v119, v46, v3
  v_dot2c_f32_bf16 v120, v47, v2
  v_dot2c_f32_bf16 v121, v47, v3
  v_dot2c_f32_bf16 v122, v48, v2
  v_dot2c_f32_bf16 v123, v48, v3
  v_dot2c_f32_bf16 v124, v49, v2
  v_dot2c_f32_bf16 v125, v49, v3
  v_dot2c_f32_bf16 v126, v50, v2
  v_dot2c_f32_bf16 v127, v50, v3
  v_dot2c_f32_bf16 v128, v51, v2
  v_dot2c_f32_bf16 v129, v51, v3
  v_cvt_pk_bf16_f32 v0, v104, v214
  v_cvt_pk_bf16_f32 v1, v214, v104
  v_dot2c_f32_bf16 v112, v52, v0
  v_dot2c_f32_bf16 v113, v52, v1
  v_dot2c_f32_bf16 v114, v53, v0
  v_dot2c_f32_bf16 v115, v53, v1
  v_dot2c_f32_bf16 v116, v54, v0
  v_dot2c_f32_bf16 v117, v54, v1
  v_dot2c_f32_bf16 v118, v55, v0
  v_dot2c_f32_bf16 v119, v55, v1
  v_dot2c_f32_bf16 v120, v56, v0
  v_dot2c_f32_bf16 v121, v56, v1
  v_dot2c_f32_bf16 v122, v57, v0
  v_dot2c_f32_bf16 v123, v57, v1
  v_dot2c_f32_bf16 v124, v58, v0
  v_dot2c_f32_bf16 v125, v58, v1
  v_dot2c_f32_bf16 v126, v59, v0
  v_dot2c_f32_bf16 v127, v59, v1
  v_dot2c_f32_bf16 v128, v60, v0
  v_dot2c_f32_bf16 v129, v60, v1
  v_cvt_pk_bf16_f32 v2, v105, v214
  v_cvt_pk_bf16_f32 v3, v214, v105
  v_dot2c_f32_bf16 v112, v61, v2
  v_dot2c_f32_bf16 v113, v61, v3
  v_dot2c_f32_bf16 v114, v62, v2
  v_dot2c_f32_bf16 v115, v62, v3
  v_dot2c_f32_bf16 v116, v63, v2
  v_dot2c_f32_bf16 v117, v63, v3
  v_dot2c_f32_bf16 v118, v64, v2
  v_dot2c_f32_bf16 v119, v64, v3
  v_dot2c_f32_bf16 v120, v65, v2
  v_dot2c_f32_bf16 v121, v65, v3
  v_dot2c_f32_bf16 v122, v66, v2
  v_dot2c_f32_bf16 v123, v66, v3
  v_dot2c_f32_bf16 v124, v67, v2
  v_dot2c_f32_bf16 v125, v67, v3
  v_dot2c_f32_bf16 v126, v68, v2
  v_dot2c_f32_bf16 v127, v68, v3
  v_dot2c_f32_bf16 v128, v69, v2
  v_dot2c_f32_bf16 v129, v69, v3
  v_cvt_pk_bf16_f32 v0, v106, v214
  v_cvt_pk_bf16_f32 v1, v214, v106
  v_dot2c_f32_bf16 v112, v70, v0
  v_dot2c_f32_bf16 v113, v70, v1
  v_dot2c_f32_bf16 v114, v71, v0
  v_dot2c_f32_bf16 v115, v71, v1
  v_dot2c_f32_bf16 v116, v72, v0
  v_dot2c_f32_bf16 v117, v72, v1
  s_waitcnt lgkmcnt(14)
  v_dot2c_f32_bf16 v118, v73, v0
  v_dot2c_f32_bf16 v119, v73, v1
  s_waitcnt lgkmcnt(13)
  v_dot2c_f32_bf16 v120, v74, v0
  v_dot2c_f32_bf16 v121, v74, v1
  s_waitcnt lgkmcnt(12)
  v_dot2c_f32_bf16 v122, v75, v0
  v_dot2c_f32_bf16 v123, v75, v1
  s_waitcnt lgkmcnt(11)
  v_dot2c_f32_bf16 v124, v76, v0
  v_dot2c_f32_bf16 v125, v76, v1
  s_waitcnt lgkmcnt(10)
  v_dot2c_f32_bf16 v126, v77, v0
  v_dot2c_f32_bf16 v127, v77, v1
  s_waitcnt lgkmcnt(9)
  v_dot2c_f32_bf16 v128, v78, v0
  v_dot2c_f32_bf16 v129, v78, v1
  v_cvt_pk_bf16_f32 v2, v107, v214
  v_cvt_pk_bf16_f32 v3, v214, v107
  s_waitcnt lgkmcnt(8)
  v_dot2c_f32_bf16 v112, v79, v2
  v_dot2c_f32_bf16 v113, v79, v3
  s_waitcnt lgkmcnt(7)
  v_dot2c_f32_bf16 v114, v80, v2
  v_dot2c_f32_bf16 v115, v80, v3
  s_waitcnt lgkmcnt(6)
  v_dot2c_f32_bf16 v116, v81, v2
  v_dot2c_f32_bf16 v117, v81, v3
  s_waitcnt lgkmcnt(5)
  v_dot2c_f32_bf16 v118, v82, v2
  v_dot2c_f32_bf16 v119, v82, v3
  s_waitcnt lgkmcnt(4)
  v_dot2c_f32_bf16 v120, v83, v2
  v_dot2c_f32_bf16 v121, v83, v3
  s_waitcnt lgkmcnt(3)
  v_dot2c_f32_bf16 v122, v84, v2
  v_dot2c_f32_bf16 v123, v84, v3
  s_waitcnt lgkmcnt(2)
  v_dot2c_f32_bf16 v124, v85, v2
  v_dot2c_f32_bf16 v125, v85, v3
  s_waitcnt lgkmcnt(1)
  v_dot2c_f32_bf16 v126, v86, v2
  v_dot2c_f32_bf16 v127, v86, v3
  s_waitcnt lgkmcnt(0)
  v_dot2c_f32_bf16 v128, v87, v2
  v_dot2c_f32_bf16 v129, v87, v3
  v_cvt_pk_bf16_f32 v132, v112, v113
  v_cvt_pk_bf16_f32 v133, v114, v115
  v_cvt_pk_bf16_f32 v134, v116, v117
  v_cvt_pk_bf16_f32 v135, v118, v119
  v_cvt_pk_bf16_f32 v136, v120, v121
  v_cvt_pk_bf16_f32 v137, v122, v123
  v_cvt_pk_bf16_f32 v138, v124, v125
  v_cvt_pk_bf16_f32 v139, v126, v127
  v_cvt_pk_bf16_f32 v140, v128, v129
  ds_write_b32 v220, v132 offset:16384
  ds_write_b32 v220, v133 offset:16388
  ds_write_b32 v220, v134 offset:16392
  ds_write_b32 v220, v135 offset:16396
  ds_write_b32 v220, v136 offset:16400
  ds_write_b32 v220, v137 offset:16404
  ds_write_b32 v220, v138 offset:16408
  ds_write_b32 v220, v139 offset:16412
  ds_write_b32 v220, v140 offset:16416
  s_waitcnt lgkmcnt(0)
  s_barrier
  ds_read_b128 v[144:147], v218 offset:16384
  ds_read_b128 v[148:151], v218 offset:17408
  ds_read_b128 v[152:155], v218 offset:18432
  s_waitcnt lgkmcnt(2)
  buffer_store_dwordx4 v[144:147], v218, s[8:11], s64 offen offset:0 sc1
  s_waitcnt lgkmcnt(1)
  buffer_store_dwordx4 v[148:151], v218, s[8:11], s64 offen offset:1024 sc1
  s_waitcnt lgkmcnt(0)
  buffer_store_dwordx4 v[152:155], v218, s[8:11], s64 offen offset:2048 sc1
  s_mov_b32 s56, 36
  s_waitcnt vmcnt(0)
  s_barrier
  s_cmp_eq_u32 s52, 0
  s_cbranch_scc0 A_sig
  v_mov_b32 v211, 1
  v_mov_b32 v212, 0
  s_mov_b64 exec, 1
  buffer_atomic_add v211, v212, s[12:15], s56 offen
  s_mov_b64 exec, -1
A_sig:
  s_and_b32 s54, s53, 31
  s_cmp_lt_u32 s54, 27
  s_cbranch_scc0 L_exit
  s_and_b32 s54, s53, 31
  s_mul_i32 s68, s54, 57
  s_lshr_b32 s68, s68, 9
  s_mul_i32 s56, s68, 9
  s_sub_u32 s70, s54, s56
  s_bfe_u32 s55, s53, 0x10005
  s_mul_i32 s55, s55, 9
  s_add_u32 s70, s70, s55
  s_bfe_u32 s69, s53, 0x10006
  v_lshrrev_b32 v211, 2, v200
  v_mul_u32_u24 v211, 1152, v211
  v_and_b32 v212, 3, v200
  v_lshl_add_u32 v207, v212, 4, v211
  s_lshl_b32 s54, s70, 6
  s_mul_i32 s55, s52, 1179648
  s_add_u32 s62, s54, s55
  s_mul_i32 s55, s52, 184320
  s_add_u32 s63, s54, s55
  s_mul_i32 s61, s52, 40960
  v_bfe_u32 v211, v200, 2, 2
  v_lshlrev_b32 v212, 4, v212
  v_add_u32 v212, s61, v212
  v_lshl_add_u32 v212, v211, 6, v212
  v_lshrrev_b32 v213, 4, v200
  v_lshl_add_u32 v210, v213, 9, v212
  v_lshrrev_b32 v214, 5, v200
  v_lshl_add_u32 v209, v214, 10, v212
  v_and_b32 v214, 1, v213
  v_lshl_add_u32 v209, v214, 8, v209
  s_add_u32 m0, s61, 0
  s_add_u32 s54, s62, 0
  buffer_load_dwordx4 v207, s[28:31], s54 offen lds
  s_add_u32 m0, s61, 1024
  s_add_u32 s54, s62, 18432
  buffer_load_dwordx4 v207, s[28:31], s54 offen lds
  s_add_u32 m0, s61, 2048
  s_add_u32 s54, s62, 36864
  buffer_load_dwordx4 v207, s[28:31], s54 offen lds
  s_add_u32 m0, s61, 3072
  s_add_u32 s54, s62, 55296
  buffer_load_dwordx4 v207, s[28:31], s54 offen lds
  s_add_u32 m0, s61, 4096
  s_add_u32 s54, s62, 73728
  buffer_load_dwordx4 v207, s[28:31], s54 offen lds
  s_add_u32 m0, s61, 5120
  s_add_u32 s54, s62, 92160
  buffer_load_dwordx4 v207, s[28:31], s54 offen lds
  s_add_u32 m0, s61, 6144
  s_add_u32 s54, s62, 110592
  buffer_load_dwordx4 v207, s[28:31], s54 offen lds
  s_add_u32 m0, s61, 7168
  s_add_u32 s54, s62, 129024
  buffer_load_dwordx4 v207, s[28:31], s54 offen lds
  s_add_u32 m0, s61, 8192
  s_add_u32 s54, s62, 147456
  buffer_load_dwordx4 v207, s[28:31], s54 offen lds
  s_add_u32 m0, s61, 9216
  s_add_u32 s54, s62, 165888
  buffer_load_dwordx4 v207, s[28:31], s54 offen lds
  s_add_u32 m0, s61, 10240
  s_add_u32 s54, s62, 184320
  buffer_load_dwordx4 v207, s[28:31], s54 offen lds
  s_add_u32 m0, s61, 11264
  s_add_u32 s54, s62, 202752
  buffer_load_dwordx4 v207, s[28:31], s54 offen lds
  s_add_u32 m0, s61, 12288
  s_add_u32 s54, s62, 221184
  buffer_load_dwordx4 v207, s[28:31], s54 offen lds
  s_add_u32 m0, s61, 13312
  s_add_u32 s54, s62, 239616
  buffer_load_dwordx4 v207, s[28:31], s54 offen lds
  s_add_u32 m0, s61, 14336
  s_add_u32 s54, s62, 258048
  buffer_load_dwordx4 v207, s[28:31], s54 offen lds
  s_add_u32 m0, s61, 15360
  s_add_u32 s54, s62, 276480
  buffer_load_dwordx4 v207, s[28:31], s54 offen lds
  s_add_u32 m0, s61, 16384
  s_add_u32 s54, s62, 294912
  buffer_load_dwordx4 v207, s[28:31], s54 offen lds
  s_add_u32 m0, s61, 17408
  s_add_u32 s54, s62, 313344
  buffer_load_dwordx4 v207, s[28:31], s54 offen lds
  s_add_u32 m0, s61, 18432
  s_add_u32 s54, s62, 331776
  buffer_load_dwordx4 v207, s[28:31], s54 offen lds
  s_add_u32 m0, s61, 19456
  s_add_u32 s54, s62, 350208
  buffer_load_dwordx4 v207, s[28:31], s54 offen lds
  s_add_u32 m0, s61, 20480
  s_add_u32 s54, s62, 368640
  buffer_load_dwordx4 v207, s[28:31], s54 offen lds
  s_add_u32 m0, s61, 21504
  s_add_u32 s54, s62, 387072
  buffer_load_dwordx4 v207, s[28:31], s54 offen lds
  s_add_u32 m0, s61, 22528
  s_add_u32 s54, s62, 405504
  buffer_load_dwordx4 v207, s[28:31], s54 offen lds
  s_add_u32 m0, s61, 23552
  s_add_u32 s54, s62, 423936
  buffer_load_dwordx4 v207, s[28:31], s54 offen lds
  s_add_u32 m0, s61, 24576
  s_add_u32 s54, s62, 442368
  buffer_load_dwordx4 v207, s[28:31], s54 offen lds
  s_add_u32 m0, s61, 25600
  s_add_u32 s54, s62, 460800
  buffer_load_dwordx4 v207, s[28:31], s54 offen lds
  s_add_u32 m0, s61, 26624
  s_add_u32 s54, s62, 479232
  buffer_load_dwordx4 v207, s[28:31], s54 offen lds
  s_add_u32 m0, s61, 27648
  s_add_u32 s54, s62, 497664
  buffer_load_dwordx4 v207, s[28:31], s54 offen lds
  s_add_u32 m0, s61, 28672
  s_add_u32 s54, s62, 516096
  buffer_load_dwordx4 v207, s[28:31], s54 offen lds
  s_add_u32 m0, s61, 29696
  s_add_u32 s54, s62, 534528
  buffer_load_dwordx4 v207, s[28:31], s54 offen lds
  s_add_u32 m0, s61, 30720
  s_add_u32 s54, s62, 552960
  buffer_load_dwordx4 v207, s[28:31], s54 offen lds
  s_add_u32 m0, s61, 31744
  s_add_u32 s54, s62, 571392
  buffer_load_dwordx4 v207, s[28:31], s54 offen lds
  s_add_u32 m0, s61, 32768
  s_add_u32 s54, s62, 589824
  buffer_load_dwordx4 v207, s[28:31], s54 offen lds
  s_add_u32 m0, s61, 33792
  s_add_u32 s54, s62, 608256
  buffer_load_dwordx4 v207, s[28:31], s54 offen lds
  s_add_u32 m0, s61, 34816
  s_add_u32 s54, s62, 626688
  buffer_load_dwordx4 v207, s[28:31], s54 offen lds
  s_add_u32 m0, s61, 35840
  s_add_u32 s54, s62, 645120
  buffer_load_dwordx4 v207, s[28:31], s54 offen lds
  s_add_u32 m0, s61, 36864
  s_add_u32 s54, s62, 663552
  buffer_load_dwordx4 v207, s[28:31], s54 offen lds
  s_add_u32 m0, s61, 37888
  s_add_u32 s54, s62, 681984
  buffer_load_dwordx4 v207, s[28:31], s54 offen lds
  s_waitcnt vmcnt(36) lgkmcnt(0)
  s_add_u32 m0, s61, 38912
  s_add_u32 s54, s62, 700416
  buffer_load_dwordx4 v207, s[28:31], s54 offen lds
  s_add_u32 m0, s61, 39936
  s_add_u32 s54, s62, 718848
  buffer_load_dwordx4 v207, s[28:31], s54 offen lds
  ds_read_b64_tr_b16 a[0:1], v209 offset:0
  ds_read_b64_tr_b16 a[2:3], v209 offset:512
  ds_read_b64_tr_b16 a[4:5], v209 offset:8
  ds_read_b64_tr_b16 a[6:7], v209 offset:520
  s_waitcnt vmcnt(36) lgkmcnt(0)
  s_add_u32 m0, s61, 0
  s_add_u32 s54, s62, 737280
  buffer_load_dwordx4 v207, s[28:31], s54 offen lds
  s_add_u32 m0, s61, 1024
  s_add_u32 s54, s62, 755712
  buffer_load_dwordx4 v207, s[28:31], s54 offen lds
  ds_read_b64_tr_b16 a[8:9], v209 offset:2048
  ds_read_b64_tr_b16 a[10:11], v209 offset:2560
  ds_read_b64_tr_b16 a[12:13], v209 offset:2056
  ds_read_b64_tr_b16 a[14:15], v209 offset:2568
  s_waitcnt vmcnt(36) lgkmcnt(0)
  s_add_u32 m0, s61, 2048
  s_add_u32 s54, s62, 774144
  buffer_load_dwordx4 v207, s[28:31], s54 offen lds
  s_add_u32 m0, s61, 3072
  s_add_u32 s54, s62, 792576
  buffer_load_dwordx4 v207, s[28:31], s54 offen lds
  ds_read_b64_tr_b16 a[16:17], v209 offset:4096
  ds_read_b64_tr_b16 a[18:19], v209 offset:4608
  ds_read_b64_tr_b16 a[20:21], v209 offset:4104
  ds_read_b64_tr_b16 a[22:23], v209 offset:4616
  s_waitcnt vmcnt(36) lgkmcnt(0)
  s_add_u32 m0, s61, 4096
  s_add_u32 s54, s62, 811008
  buffer_load_dwordx4 v207, s[28:31], s54 offen lds
  s_add_u32 m0, s61, 5120
  s_add_u32 s54, s62, 829440
  buffer_load_dwordx4 v207, s[28:31], s54 offen lds
  ds_read_b64_tr_b16 a[24:25], v209 offset:6144
  ds_read_b64_tr_b16 a[26:27], v209 offset:6656
  ds_read_b64_tr_b16 a[28:29], v209 offset:6152
  ds_read_b64_tr_b16 a[30:31], v209 offset:6664
  s_waitcnt vmcnt(36) lgkmcnt(0)
  s_add_u32 m0, s61, 6144
  s_add_u32 s54, s62, 847872
  buffer_load_dwordx4 v207, s[28:31], s54 offen lds
  s_add_u32 m0, s61, 7168
  s_add_u32 s54, s62, 866304
  buffer_load_dwordx4 v207, s[28:31], s54 offen lds
  ds_read_b64_tr_b16 a[32:33], v209 offset:8192
  ds_read_b64_tr_b16 a[34:35], v209 offset:8704
  ds_read_b64_tr_b16 a[36:37], v209 offset:8200
  ds_read_b64_tr_b16 a[38:39], v209 offset:8712
  s_waitcnt vmcnt(36) lgkmcnt(0)
  s_add_u32 m0, s61, 8192
  s_add_u32 s54, s62, 884736
  buffer_load_dwordx4 v207, s[28:31], s54 offen lds
  s_add_u32 m0, s61, 9216
  s_add_u32 s54, s62, 903168
  buffer_load_dwordx4 v207, s[28:31], s54 offen lds
  ds_read_b64_tr_b16 a[40:41], v209 offset:10240
  ds_read_b64_tr_b16 a[42:43], v209 offset:10752
  ds_read_b64_tr_b16 a[44:45], v209 offset:10248
  ds_read_b64_tr_b16 a[46:47], v209 offset:10760
  s_waitcnt vmcnt(36) lgkmcnt(0)
  s_add_u32 m0, s61, 10240
  s_add_u32 s54, s62, 921600
  buffer_load_dwordx4 v207, s[28:31], s54 offen lds
  s_add_u32 m0, s61, 11264
  s_add_u32 s54, s62, 940032
  buffer_load_dwordx4 v207, s[28:31], s54 offen lds
  ds_read_b64_tr_b16 a[48:49], v209 offset:12288
  ds_read_b64_tr_b16 a[50:51], v209 offset:12800
  ds_read_b64_tr_b16 a[52:53], v209 offset:12296
  ds_read_b64_tr_b16 a[54:55], v209 offset:12808
  s_waitcnt vmcnt(36) lgkmcnt(0)
  s_add_u32 m0, s61, 12288
  s_add_u32 s54, s62, 958464
  buffer_load_dwordx4 v207, s[28:31], s54 offen lds
  s_add_u32 m0, s61, 13312
  s_add_u32 s54, s62, 976896
  buffer_load_dwordx4 v207, s[28:31], s54 offen lds
  ds_read_b64_tr_b16 a[56:57], v209 offset:14336
  ds_read_b64_tr_b16 a[58:59], v209 offset:14848
  ds_read_b64_tr_b16 a[60:61], v209 offset:14344
  ds_read_b64_tr_b16 a[62:63], v209 offset:14856
  s_waitcnt vmcnt(36) lgkmcnt(0)
  s_add_u32 m0, s61, 14336
  s_add_u32 s54, s62, 995328
  buffer_load_dwordx4 v207, s[28:31], s54 offen lds
  s_add_u32 m0, s61, 15360
  s_add_u32 s54, s62, 1013760
  buffer_load_dwordx4 v207, s[28:31], s54 offen lds
  ds_read_b64_tr_b16 a[64:65], v209 offset:16384
  ds_read_b64_tr_b16 a[66:67], v209 offset:16896
  ds_read_b64_tr_b16 a[68:69], v209 offset:16392
  ds_read_b64_tr_b16 a[70:71], v209 offset:16904
  s_waitcnt vmcnt(36) lgkmcnt(0)
  s_add_u32 m0, s61, 16384
  s_add_u32 s54, s62, 1032192
  buffer_load_dwordx4 v207, s[28:31], s54 offen lds
  s_add_u32 m0, s61, 17408
  s_add_u32 s54, s62, 1050624
  buffer_load_dwordx4 v207, s[28:31], s54 offen lds
  ds_read_b64_tr_b16 a[72:73], v209 offset:18432
  ds_read_b64_tr_b16 a[74:75], v209 offset:18944
  ds_read_b64_tr_b16 a[76:77], v209 offset:18440
  ds_read_b64_tr_b16 a[78:79], v209 offset:18952
  s_waitcnt vmcnt(36) lgkmcnt(0)
  s_add_u32 m0, s61, 18432
  s_add_u32 s54, s62, 1069056
  buffer_load_dwordx4 v207, s[28:31], s54 offen lds
  s_add_u32 m0, s61, 19456
  s_add_u32 s54, s62, 1087488
  buffer_load_dwordx4 v207, s[28:31], s54 offen lds
  ds_read_b64_tr_b16 a[80:81], v209 offset:20480
  ds_read_b64_tr_b16 a[82:83], v209 offset:20992
  ds_read_b64_tr_b16 a[84:85], v209 offset:20488
  ds_read_b64_tr_b16 a[86:87], v209 offset:21000
  s_waitcnt vmcnt(36) lgkmcnt(0)
  s_add_u32 m0, s61, 20480
  s_add_u32 s54, s62, 1105920
  buffer_load_dwordx4 v207, s[28:31], s54 offen lds
  s_add_u32 m0, s61, 21504
  s_add_u32 s54, s62, 1124352
  buffer_load_dwordx4 v207, s[28:31], s54 offen lds
  ds_read_b64_tr_b16 a[88:89], v209 offset:22528
  ds_read_b64_tr_b16 a[90:91], v209 offset:23040
  ds_read_b64_tr_b16 a[92:93], v209 offset:22536
  ds_read_b64_tr_b16 a[94:95], v209 offset:23048
  s_waitcnt vmcnt(36) lgkmcnt(0)
  s_add_u32 m0, s61, 22528
  s_add_u32 s54, s62, 1142784
  buffer_load_dwordx4 v207, s[28:31], s54 offen lds
  s_add_u32 m0, s61, 23552
  s_add_u32 s54, s62, 1161216
  buffer_load_dwordx4 v207, s[28:31], s54 offen lds
  ds_read_b64_tr_b16 a[96:97], v209 offset:24576
  ds_read_b64_tr_b16 a[98:99], v209 offset:25088
  ds_read_b64_tr_b16 a[100:101], v209 offset:24584
  ds_read_b64_tr_b16 a[102:103], v209 offset:25096
  s_waitcnt vmcnt(36) lgkmcnt(0)
  s_add_u32 m0, s61, 24576
  s_add_u32 s54, s63, 0
  buffer_load_dwordx4 v207, s[40:43], s54 offen lds
  s_add_u32 m0, s61, 25600
  s_add_u32 s54, s63, 18432
  buffer_load_dwordx4 v207, s[40:43], s54 offen lds
  ds_read_b64_tr_b16 a[104:105], v209 offset:26624
  ds_read_b64_tr_b16 a[106:107], v209 offset:27136
  ds_read_b64_tr_b16 a[108:109], v209 offset:26632
  ds_read_b64_tr_b16 a[110:111], v209 offset:27144
  s_waitcnt vmcnt(36) lgkmcnt(0)
  s_add_u32 m0, s61, 26624
  s_add_u32 s54, s63, 36864
  buffer_load_dwordx4 v207, s[40:43], s54 offen lds
  s_add_u32 m0, s61, 27648
  s_add_u32 s54, s63, 55296
  buffer_load_dwordx4 v207, s[40:43], s54 offen lds
  ds_read_b64_tr_b16 a[112:113], v209 offset:28672
  ds_read_b64_tr_b16 a[114:115], v209 offset:29184
  ds_read_b64_tr_b16 a[116:117], v209 offset:28680
  ds_read_b64_tr_b16 a[118:119], v209 offset:29192
  s_waitcnt vmcnt(36) lgkmcnt(0)
  s_add_u32 m0, s61, 28672
  s_add_u32 s54, s63, 73728
  buffer_load_dwordx4 v207, s[40:43], s54 offen lds
  s_add_u32 m0, s61, 29696
  s_add_u32 s54, s63, 92160
  buffer_load_dwordx4 v207, s[40:43], s54 offen lds
  ds_read_b64_tr_b16 a[120:121], v209 offset:30720
  ds_read_b64_tr_b16 a[122:123], v209 offset:31232
  ds_read_b64_tr_b16 a[124:125], v209 offset:30728
  ds_read_b64_tr_b16 a[126:127], v209 offset:31240
  s_waitcnt vmcnt(36) lgkmcnt(0)
  s_add_u32 m0, s61, 30720
  s_add_u32 s54, s63, 110592
  buffer_load_dwordx4 v207, s[40:43], s54 offen lds
  s_add_u32 m0, s61, 31744
  s_add_u32 s54, s63, 129024
  buffer_load_dwordx4 v207, s[40:43], s54 offen lds
  ds_read_b64_tr_b16 a[128:129], v209 offset:32768
  ds_read_b64_tr_b16 a[130:131], v209 offset:33280
  ds_read_b64_tr_b16 a[132:133], v209 offset:32776
  ds_read_b64_tr_b16 a[134:135], v209 offset:33288
  s_waitcnt vmcnt(36) lgkmcnt(0)
  s_add_u32 m0, s61, 32768
  s_add_u32 s54, s63, 147456
  buffer_load_dwordx4 v207, s[40:43], s54 offen lds
  s_add_u32 m0, s61, 33792
  s_add_u32 s54, s63, 165888
  buffer_load_dwordx4 v207, s[40:43], s54 offen lds
  ds_read_b64_tr_b16 a[136:137], v209 offset:34816
  ds_read_b64_tr_b16 a[138:139], v209 offset:35328
  ds_read_b64_tr_b16 a[140:141], v209 offset:34824
  ds_read_b64_tr_b16 a[142:143], v209 offset:35336
  s_waitcnt vmcnt(36) lgkmcnt(0)
  ds_read_b64_tr_b16 a[144:145], v209 offset:36864
  ds_read_b64_tr_b16 a[146:147], v209 offset:37376
  ds_read_b64_tr_b16 a[148:149], v209 offset:36872
  ds_read_b64_tr_b16 a[150:151], v209 offset:37384
  s_waitcnt vmcnt(34) lgkmcnt(0)
  ds_read_b64_tr_b16 a[152:153], v209 offset:38912
  ds_read_b64_tr_b16 a[154:155], v209 offset:39424
  ds_read_b64_tr_b16 a[156:157], v209 offset:38920
  ds_read_b64_tr_b16 a[158:159], v209 offset:39432
  s_waitcnt vmcnt(32) lgkmcnt(0)
  ds_read_b64_tr_b16 a[160:161], v209 offset:0
  ds_read_b64_tr_b16 a[162:163], v209 offset:512
  ds_read_b64_tr_b16 a[164:165], v209 offset:8
  ds_read_b64_tr_b16 a[166:167], v209 offset:520
  s_waitcnt vmcnt(30) lgkmcnt(0)
  ds_read_b64_tr_b16 a[168:169], v209 offset:2048
  ds_read_b64_tr_b16 a[170:171], v209 offset:2560
  ds_read_b64_tr_b16 a[172:173], v209 offset:2056
  ds_read_b64_tr_b16 a[174:175], v209 offset:2568
  s_waitcnt vmcnt(28) lgkmcnt(0)
  ds_read_b64_tr_b16 a[176:177], v209 offset:4096
  ds_read_b64_tr_b16 a[178:179], v209 offset:4608
  ds_read_b64_tr_b16 a[180:181], v209 offset:4104
  ds_read_b64_tr_b16 a[182:183], v209 offset:4616
  s_waitcnt vmcnt(26) lgkmcnt(0)
  ds_read_b64_tr_b16 a[184:185], v209 offset:6144
  ds_read_b64_tr_b16 a[186:187], v209 offset:6656
  ds_read_b64_tr_b16 a[188:189], v209 offset:6152
  ds_read_b64_tr_b16 a[190:191], v209 offset:6664
  s_waitcnt vmcnt(24) lgkmcnt(0)
  ds_read_b64_tr_b16 a[192:193], v209 offset:8192
  ds_read_b64_tr_b16 a[194:195], v209 offset:8704
  ds_read_b64_tr_b16 a[196:197], v209 offset:8200
  ds_read_b64_tr_b16 a[198:199], v209 offset:8712
  s_waitcnt vmcnt(22) lgkmcnt(0)
  ds_read_b64_tr_b16 a[200:201], v209 offset:10240
  ds_read_b64_tr_b16 a[202:203], v209 offset:10752
  ds_read_b64_tr_b16 a[204:205], v209 offset:10248
  ds_read_b64_tr_b16 a[206:207], v209 offset:10760
  s_waitcnt vmcnt(20) lgkmcnt(0)
  ds_read_b64_tr_b16 a[208:209], v209 offset:12288
  ds_read_b64_tr_b16 a[210:211], v209 offset:12800
  ds_read_b64_tr_b16 a[212:213], v209 offset:12296
  ds_read_b64_tr_b16 a[214:215], v209 offset:12808
  s_waitcnt vmcnt(18) lgkmcnt(0)
  ds_read_b64_tr_b16 a[216:217], v209 offset:14336
  ds_read_b64_tr_b16 a[218:219], v209 offset:14848
  ds_read_b64_tr_b16 a[220:221], v209 offset:14344
  ds_read_b64_tr_b16 a[222:223], v209 offset:14856
  s_waitcnt vmcnt(16) lgkmcnt(0)
  ds_read_b64_tr_b16 a[224:225], v209 offset:16384
  ds_read_b64_tr_b16 a[226:227], v209 offset:16896
  ds_read_b64_tr_b16 a[228:229], v209 offset:16392
  ds_read_b64_tr_b16 a[230:231], v209 offset:16904
  s_waitcnt vmcnt(14) lgkmcnt(0)
  ds_read_b64_tr_b16 a[232:233], v209 offset:18432
  ds_read_b64_tr_b16 a[234:235], v209 offset:18944
  ds_read_b64_tr_b16 a[236:237], v209 offset:18440
  ds_read_b64_tr_b16 a[238:239], v209 offset:18952
  s_waitcnt vmcnt(12) lgkmcnt(0)
  ds_read_b64_tr_b16 a[240:241], v209 offset:20480
  ds_read_b64_tr_b16 a[242:243], v209 offset:20992
  ds_read_b64_tr_b16 a[244:245], v209 offset:20488
  ds_read_b64_tr_b16 a[246:247], v209 offset:21000
  s_waitcnt vmcnt(10) lgkmcnt(0)
  ds_read_b64_tr_b16 a[248:249], v209 offset:22528
  ds_read_b64_tr_b16 a[250:251], v209 offset:23040
  ds_read_b64_tr_b16 a[252:253], v209 offset:22536
  ds_read_b64_tr_b16 a[254:255], v209 offset:23048
  s_waitcnt vmcnt(8) lgkmcnt(0)
  ds_read_b64_tr_b16 v[216:217], v210 offset:24576
  ds_read_b64_tr_b16 v[218:219], v210 offset:24832
  ds_read_b64_tr_b16 v[220:221], v210 offset:24584
  ds_read_b64_tr_b16 v[222:223], v210 offset:24840
  s_waitcnt vmcnt(6) lgkmcnt(0)
  ds_read_b64_tr_b16 v[224:225], v210 offset:26624
  ds_read_b64_tr_b16 v[226:227], v210 offset:26880
  ds_read_b64_tr_b16 v[228:229], v210 offset:26632
  ds_read_b64_tr_b16 v[230:231], v210 offset:26888
  s_waitcnt vmcnt(4) lgkmcnt(0)
  ds_read_b64_tr_b16 v[232:233], v210 offset:28672
  ds_read_b64_tr_b16 v[234:235], v210 offset:28928
  ds_read_b64_tr_b16 v[236:237], v210 offset:28680
  ds_read_b64_tr_b16 v[238:239], v210 offset:28936
  s_waitcnt vmcnt(2) lgkmcnt(0)
  ds_read_b64_tr_b16 v[240:241], v210 offset:30720
  ds_read_b64_tr_b16 v[242:243], v210 offset:30976
  ds_read_b64_tr_b16 v[244:245], v210 offset:30728
  ds_read_b64_tr_b16 v[246:247], v210 offset:30984
  s_waitcnt vmcnt(0) lgkmcnt(0)
  ds_read_b64_tr_b16 v[248:249], v210 offset:32768
  ds_read_b64_tr_b16 v[250:251], v210 offset:33024
  ds_read_b64_tr_b16 v[252:253], v210 offset:32776
  ds_read_b64_tr_b16 v[254:255], v210 offset:33032
  v_and_b32 v211, 15, v200
  s_lshl_b32 s54, s69, 4
  v_add_u32 v211, s54, v211
  v_lshl_add_u32 v212, v214, 5, v211
  v_lshlrev_b32 v164, 4, v212
  v_lshrrev_b32 v212, 5, v200
  v_lshl_add_u32 v164, v212, 10, v164
  v_mul_u32_u24 v167, 1152, v211
  v_lshl_add_u32 v167, v213, 4, v167
  v_lshlrev_b32 v166, 2, v211
  v_mul_u32_u24 v211, 144, v211
  s_mul_i32 s54, s52, 20
  s_mov_b32 s55, 294768
  v_mov_b32 v214, 0x40000000
  v_add_u32 v212, s54, v213
  v_add_u32 v212, 0, v212
  v_mul_u32_u24 v176, 57, v212
  v_lshrrev_b32 v176, 9, v176
  v_mul_lo_u32 v176, v176, s55
  v_lshl_add_u32 v176, v212, 4, v176
  v_add_u32 v176, v176, v211
  v_cmp_lt_u32 vcc, 71, v212
  s_nop 1
  v_cndmask_b32 v176, v176, v214, vcc
  v_add_u32 v212, s54, v213
  v_add_u32 v212, 4, v212
  v_mul_u32_u24 v177, 57, v212
  v_lshrrev_b32 v177, 9, v177
  v_mul_lo_u32 v177, v177, s55
  v_lshl_add_u32 v177, v212, 4, v177
  v_add_u32 v177, v177, v211
  v_cmp_lt_u32 vcc, 71, v212
  s_nop 1
  v_cndmask_b32 v177, v177, v214, vcc
  v_add_u32 v212, s54, v213
  v_add_u32 v212, 8, v212
  v_mul_u32_u24 v178, 57, v212
  v_lshrrev_b32 v178, 9, v178
  v_mul_lo_u32 v178, v178, s55
  v_lshl_add_u32 v178, v212, 4, v178
  v_add_u32 v178, v178, v211
  v_cmp_lt_u32 vcc, 71, v212
  s_nop 1
  v_cndmask_b32 v178, v178, v214, vcc
  v_add_u32 v212, s54, v213
  v_add_u32 v212, 12, v212
  v_mul_u32_u24 v179, 57, v212
  v_lshrrev_b32 v179, 9, v179
  v_mul_lo_u32 v179, v179, s55
  v_lshl_add_u32 v179, v212, 4, v179
  v_add_u32 v179, v179, v211
  v_cmp_lt_u32 vcc, 71, v212
  s_nop 1
  v_cndmask_b32 v179, v179, v214, vcc
  v_add_u32 v212, s54, v213
  v_add_u32 v212, 16, v212
  v_mul_u32_u24 v180, 57, v212
  v_lshrrev_b32 v180, 9, v180
  v_mul_lo_u32 v180, v180, s55
  v_lshl_add_u32 v180, v212, 4, v180
  v_add_u32 v180, v180, v211
  v_cmp_lt_u32 vcc, 71, v212
  s_nop 1
  v_cndmask_b32 v180, v180, v214, vcc
  v_lshlrev_b32 v208, 2, v200
  s_lshl_b32 s54, s52, 11
  v_add_u32 v168, s54, v201
  s_mov_b32 s59, s68
  s_mov_b32 s56, 128
  s_mov_b32 s57, 36
  s_waitcnt lgkmcnt(0)
  s_cmp_eq_u32 s52, 0
  s_cbranch_scc0 O_p1_d
  s_mov_b32 exec_hi, 0
  s_mov_b32 exec_lo, -1
O_p1:
  buffer_load_dword v211, v208, s[12:15], s56 offen sc1
  s_add_u32 s65, s65, 1
  s_waitcnt vmcnt(0)
  v_cmp_gt_u32 vcc, 0x700, v211
  s_cbranch_vccz O_p1_x
  s_sleep 16
  s_cmp_lt_u32 s65, 131072
  s_cbranch_scc1 O_p1
O_p1_x:
  s_mov_b64 exec, -1
O_p1_d:
  s_barrier
  s_cmp_eq_u32 s52, 0
  s_cbranch_scc0 O_a_d
  s_mov_b32 exec_hi, 0
  s_mov_b32 exec_lo, 1
O_a:
  buffer_load_dword v211, v208, s[12:15], s57 offen sc1
  s_add_u32 s65, s65, 1
  s_waitcnt vmcnt(0)
  v_cmp_gt_u32 vcc, 0x80, v211
  s_cbranch_vccz O_a_x
  s_sleep 16
  s_cmp_lt_u32 s65, 131072
  s_cbranch_scc1 O_a
O_a_x:
  s_mov_b64 exec, -1
O_a_d:
  s_barrier
  s_cmp_ge_u32 s70, 9
  s_cselect_b32 s54, 9, 0
  s_sub_u32 s54, s70, s54
  s_and_b32 s54, s54, 7
  s_lshl_b32 s54, s54, 13
  s_lshl_b32 s55, s69, 8
  s_add_u32 s54, s54, s55
  v_lshrrev_b32 v211, 2, v200
  v_lshl_add_u32 v172, v211, 9, s54
  v_and_b32 v211, 3, v200
  v_lshl_add_u32 v172, v211, 6, v172
  s_mul_i32 s55, s59, 4608
  s_add_u32 s55, s55, 62914560
  buffer_load_dwordx4 v[128:131], v176, s[8:11], s55 offen sc1
  buffer_load_dwordx4 v[132:135], v177, s[8:11], s55 offen sc1
  buffer_load_dwordx4 v[136:139], v178, s[8:11], s55 offen sc1
  buffer_load_dwordx4 v[140:143], v179, s[8:11], s55 offen sc1
  buffer_load_dwordx4 v[144:147], v180, s[8:11], s55 offen sc1
  s_lshl_b32 s55, s59, 7
  s_add_u32 s55, s55, 66060288
  buffer_load_dword v171, v166, s[8:11], s55 offen sc1
  v_mov_b32 v169, 0
  v_lshlrev_b32 v208, 8, v200
  s_mov_b32 s66, 393216
  s_waitcnt vmcnt(0)
O_loop:
  v_mfma_f32_16x16x32_bf16 v[156:159], v[216:219], v[128:131], 0
  v_mfma_f32_16x16x32_bf16 v[160:163], v[220:223], v[128:131], 0
  v_mfma_f32_16x16x32_bf16 v[156:159], v[224:227], v[132:135], v[156:159]
  v_mfma_f32_16x16x32_bf16 v[160:163], v[228:231], v[132:135], v[160:163]
  v_mfma_f32_16x16x32_bf16 v[156:159], v[232:235], v[136:139], v[156:159]
  v_mfma_f32_16x16x32_bf16 v[160:163], v[236:239], v[136:139], v[160:163]
  v_mfma_f32_16x16x32_bf16 v[156:159], v[240:243], v[140:143], v[156:159]
  v_mfma_f32_16x16x32_bf16 v[160:163], v[244:247], v[140:143], v[160:163]
  v_mfma_f32_16x16x32_bf16 v[156:159], v[248:251], v[144:147], v[156:159]
  v_mfma_f32_16x16x32_bf16 v[160:163], v[252:255], v[144:147], v[160:163]
  s_mul_i32 s64, s59, 36864
  s_lshl_b32 s54, s70, 6
  s_add_u32 s64, s64, s54
  s_add_u32 s71, s59, 2
  s_lshl_b32 s55, s59, 18
  s_lshl_b32 s54, s52, 16
  s_add_u32 s55, s55, s54
  s_add_u32 s63, s55, 46137344
  s_and_b32 s54, s59, 1
  s_lshl_b32 s54, s54, 2
  s_add_u32 s54, s54, s52
  s_lshl_b32 s54, s54, 3
  s_lshl_b64 s[72:73], 0xff, s54
  v_sub_f32 v165, 1.0, v171
  v_cvt_pk_bf16_f32 v165, v165, v165
  v_lshlrev_b32 v165, 16, v165
  v_mul_f32 v156, v171, v156
  v_mul_f32 v157, v171, v157
  v_mul_f32 v158, v171, v158
  v_mul_f32 v159, v171, v159
  v_mul_f32 v160, v171, v160
  v_mul_f32 v161, v171, v161
  v_mul_f32 v162, v171, v162
  v_mul_f32 v163, v171, v163
  s_branch O_pc
O_pl:
  s_sleep 1
  s_mov_b64 exec, s[72:73]
  buffer_load_dword v169, v208, s[8:11], s66 offen sc1
  s_mov_b64 exec, -1
  s_add_u32 s65, s65, 1
  s_cmp_ge_u32 s65, 131072
  s_cbranch_scc1 O_ld
  s_waitcnt vmcnt(0)
O_pc:
  v_cmp_gt_u32 vcc, s71, v169
  s_nop 0
  s_and_b64 vcc, vcc, s[72:73]
  s_cbranch_scc1 O_pl
O_ld:
  s_mov_b32 s62, s63
  buffer_load_dwordx4 v[0:3], v164, s[8:11], s62 offen offset:0 sc1
  buffer_load_dwordx4 v[4:7], v164, s[8:11], s62 offen offset:2048 sc1
  s_add_u32 s62, s62, 4096
  buffer_load_dwordx4 v[8:11], v164, s[8:11], s62 offen offset:0 sc1
  buffer_load_dwordx4 v[12:15], v164, s[8:11], s62 offen offset:2048 sc1
  s_add_u32 s62, s62, 4096
  buffer_load_dwordx4 v[16:19], v164, s[8:11], s62 offen offset:0 sc1
  buffer_load_dwordx4 v[20:23], v164, s[8:11], s62 offen offset:2048 sc1
  s_add_u32 s62, s62, 4096
  buffer_load_dwordx4 v[24:27], v164, s[8:11], s62 offen offset:0 sc1
  buffer_load_dwordx4 v[28:31], v164, s[8:11], s62 offen offset:2048 sc1
  s_add_u32 s62, s62, 4096
  buffer_load_dwordx4 v[32:35], v164, s[8:11], s62 offen offset:0 sc1
  buffer_load_dwordx4 v[36:39], v164, s[8:11], s62 offen offset:2048 sc1
  s_add_u32 s62, s62, 4096
  buffer_load_dwordx4 v[40:43], v164, s[8:11], s62 offen offset:0 sc1
  buffer_load_dwordx4 v[44:47], v164, s[8:11], s62 offen offset:2048 sc1
  s_add_u32 s62, s62, 4096
  buffer_load_dwordx4 v[48:51], v164, s[8:11], s62 offen offset:0 sc1
  buffer_load_dwordx4 v[52:55], v164, s[8:11], s62 offen offset:2048 sc1
  s_add_u32 s62, s62, 4096
  buffer_load_dwordx4 v[56:59], v164, s[8:11], s62 offen offset:0 sc1
  buffer_load_dwordx4 v[60:63], v164, s[8:11], s62 offen offset:2048 sc1
  s_add_u32 s62, s62, 4096
  buffer_load_dwordx4 v[64:67], v164, s[8:11], s62 offen offset:0 sc1
  buffer_load_dwordx4 v[68:71], v164, s[8:11], s62 offen offset:2048 sc1
  s_add_u32 s62, s62, 4096
  buffer_load_dwordx4 v[72:75], v164, s[8:11], s62 offen offset:0 sc1
  buffer_load_dwordx4 v[76:79], v164, s[8:11], s62 offen offset:2048 sc1
  s_add_u32 s62, s62, 4096
  buffer_load_dwordx4 v[80:83], v164, s[8:11], s62 offen offset:0 sc1
  buffer_load_dwordx4 v[84:87], v164, s[8:11], s62 offen offset:2048 sc1
  s_add_u32 s62, s62, 4096
  buffer_load_dwordx4 v[88:91], v164, s[8:11], s62 offen offset:0 sc1
  buffer_load_dwordx4 v[92:95], v164, s[8:11], s62 offen offset:2048 sc1
  s_add_u32 s62, s62, 4096
  buffer_load_dwordx4 v[96:99], v164, s[8:11], s62 offen offset:0 sc1
  buffer_load_dwordx4 v[100:103], v164, s[8:11], s62 offen offset:2048 sc1
  s_add_u32 s62, s62, 4096
  buffer_load_dwordx4 v[104:107], v164, s[8:11], s62 offen offset:0 sc1
  buffer_load_dwordx4 v[108:111], v164, s[8:11], s62 offen offset:2048 sc1
  s_add_u32 s62, s62, 4096
  buffer_load_dwordx4 v[112:115], v164, s[8:11], s62 offen offset:0 sc1
  buffer_load_dwordx4 v[116:119], v164, s[8:11], s62 offen offset:2048 sc1
  s_add_u32 s62, s62, 4096
  buffer_load_dwordx4 v[120:123], v164, s[8:11], s62 offen offset:0 sc1
  buffer_load_dwordx4 v[124:127], v164, s[8:11], s62 offen offset:2048 sc1
  s_add_u32 s62, s62, 4096
  s_add_u32 s57, s59, 3
  s_min_u32 s74, s57, 63
  s_mul_i32 s55, s74, 4608
  s_add_u32 s55, s55, 62914560
  buffer_load_dwordx4 v[128:131], v176, s[8:11], s55 offen sc1
  buffer_load_dwordx4 v[132:135], v177, s[8:11], s55 offen sc1
  buffer_load_dwordx4 v[136:139], v178, s[8:11], s55 offen sc1
  buffer_load_dwordx4 v[140:143], v179, s[8:11], s55 offen sc1
  buffer_load_dwordx4 v[144:147], v180, s[8:11], s55 offen sc1
  s_lshl_b32 s55, s74, 7
  s_add_u32 s55, s55, 66060288
  buffer_load_dword v171, v166, s[8:11], s55 offen sc1
  s_add_u32 s65, s65, 1
  s_cmp_lt_u32 s65, 131072
  s_cselect_b32 s54, -2, -1
  s_waitcnt vmcnt(37)
  v_mfma_f32_16x16x32_bf16 v[148:151], a[0:3], v[0:3], 0
  v_mfma_f32_16x16x32_bf16 v[152:155], a[4:7], v[0:3], 0
  v_max3_u32 v170, v0, v1, v0
  v_max3_u32 v170, v2, v3, v170
  s_waitcnt vmcnt(36)
  v_mfma_f32_16x16x32_bf16 v[148:151], a[8:11], v[4:7], v[148:151]
  v_mfma_f32_16x16x32_bf16 v[152:155], a[12:15], v[4:7], v[152:155]
  v_max3_u32 v170, v4, v5, v170
  v_max3_u32 v170, v6, v7, v170
  s_waitcnt vmcnt(35)
  v_mfma_f32_16x16x32_bf16 v[148:151], a[16:19], v[8:11], v[148:151]
  v_mfma_f32_16x16x32_bf16 v[152:155], a[20:23], v[8:11], v[152:155]
  v_max3_u32 v170, v8, v9, v170
  v_max3_u32 v170, v10, v11, v170
  s_waitcnt vmcnt(34)
  v_mfma_f32_16x16x32_bf16 v[148:151], a[24:27], v[12:15], v[148:151]
  v_mfma_f32_16x16x32_bf16 v[152:155], a[28:31], v[12:15], v[152:155]
  v_max3_u32 v170, v12, v13, v170
  v_max3_u32 v170, v14, v15, v170
  s_waitcnt vmcnt(33)
  v_mfma_f32_16x16x32_bf16 v[148:151], a[32:35], v[16:19], v[148:151]
  v_mfma_f32_16x16x32_bf16 v[152:155], a[36:39], v[16:19], v[152:155]
  v_max3_u32 v170, v16, v17, v170
  v_max3_u32 v170, v18, v19, v170
  s_waitcnt vmcnt(32)
  v_mfma_f32_16x16x32_bf16 v[148:151], a[40:43], v[20:23], v[148:151]
  v_mfma_f32_16x16x32_bf16 v[152:155], a[44:47], v[20:23], v[152:155]
  v_max3_u32 v170, v20, v21, v170
  v_max3_u32 v170, v22, v23, v170
  s_waitcnt vmcnt(31)
  v_mfma_f32_16x16x32_bf16 v[148:151], a[48:51], v[24:27], v[148:151]
  v_mfma_f32_16x16x32_bf16 v[152:155], a[52:55], v[24:27], v[152:155]
  v_max3_u32 v170, v24, v25, v170
  v_max3_u32 v170, v26, v27, v170
  s_waitcnt vmcnt(30)
  v_mfma_f32_16x16x32_bf16 v[148:151], a[56:59], v[28:31], v[148:151]
  v_mfma_f32_16x16x32_bf16 v[152:155], a[60:63], v[28:31], v[152:155]
  v_max3_u32 v170, v28, v29, v170
  v_max3_u32 v170, v30, v31, v170
  s_waitcnt vmcnt(29)
  v_mfma_f32_16x16x32_bf16 v[148:151], a[64:67], v[32:35], v[148:151]
  v_mfma_f32_16x16x32_bf16 v[152:155], a[68:71], v[32:35], v[152:155]
  v_max3_u32 v170, v32, v33, v170
  v_max3_u32 v170, v34, v35, v170
  s_waitcnt vmcnt(28)
  v_mfma_f32_16x16x32_bf16 v[148:151], a[72:75], v[36:39], v[148:151]
  v_mfma_f32_16x16x32_bf16 v[152:155], a[76:79], v[36:39], v[152:155]
  v_max3_u32 v170, v36, v37, v170
  v_max3_u32 v170, v38, v39, v170
  s_waitcnt vmcnt(27)
  v_mfma_f32_16x16x32_bf16 v[148:151], a[80:83], v[40:43], v[148:151]
  v_mfma_f32_16x16x32_bf16 v[152:155], a[84:87], v[40:43], v[152:155]
  v_max3_u32 v170, v40, v41, v170
  v_max3_u32 v170, v42, v43, v170
  s_waitcnt vmcnt(26)
  v_mfma_f32_16x16x32_bf16 v[148:151], a[88:91], v[44:47], v[148:151]
  v_mfma_f32_16x16x32_bf16 v[152:155], a[92:95], v[44:47], v[152:155]
  v_max3_u32 v170, v44, v45, v170
  v_max3_u32 v170, v46, v47, v170
  s_waitcnt vmcnt(25)
  v_mfma_f32_16x16x32_bf16 v[148:151], a[96:99], v[48:51], v[148:151]
  v_mfma_f32_16x16x32_bf16 v[152:155], a[100:103], v[48:51], v[152:155]
  v_max3_u32 v170, v48, v49, v170
  v_max3_u32 v170, v50, v51, v170
  s_waitcnt vmcnt(24)
  v_mfma_f32_16x16x32_bf16 v[148:151], a[104:107], v[52:55], v[148:151]
  v_mfma_f32_16x16x32_bf16 v[152:155], a[108:111], v[52:55], v[152:155]
  v_max3_u32 v170, v52, v53, v170
  v_max3_u32 v170, v54, v55, v170
  s_waitcnt vmcnt(23)
  v_mfma_f32_16x16x32_bf16 v[148:151], a[112:115], v[56:59], v[148:151]
  v_mfma_f32_16x16x32_bf16 v[152:155], a[116:119], v[56:59], v[152:155]
  v_max3_u32 v170, v56, v57, v170
  v_max3_u32 v170, v58, v59, v170
  s_waitcnt vmcnt(22)
  v_mfma_f32_16x16x32_bf16 v[148:151], a[120:123], v[60:63], v[148:151]
  v_mfma_f32_16x16x32_bf16 v[152:155], a[124:127], v[60:63], v[152:155]
  v_max3_u32 v170, v60, v61, v170
  v_max3_u32 v170, v62, v63, v170
  s_waitcnt vmcnt(21)
  v_mfma_f32_16x16x32_bf16 v[148:151], a[128:131], v[64:67], v[148:151]
  v_mfma_f32_16x16x32_bf16 v[152:155], a[132:135], v[64:67], v[152:155]
  v_max3_u32 v170, v64, v65, v170
  v_max3_u32 v170, v66, v67, v170
  s_waitcnt vmcnt(20)
  v_mfma_f32_16x16x32_bf16 v[148:151], a[136:139], v[68:71], v[148:151]
  v_mfma_f32_16x16x32_bf16 v[152:155], a[140:143], v[68:71], v[152:155]
  v_max3_u32 v170, v68, v69, v170
  v_max3_u32 v170, v70, v71, v170
  s_waitcnt vmcnt(19)
  v_mfma_f32_16x16x32_bf16 v[148:151], a[144:147], v[72:75], v[148:151]
  v_mfma_f32_16x16x32_bf16 v[152:155], a[148:151], v[72:75], v[152:155]
  v_max3_u32 v170, v72, v73, v170
  v_max3_u32 v170, v74, v75, v170
  s_waitcnt vmcnt(18)
  v_mfma_f32_16x16x32_bf16 v[148:151], a[152:155], v[76:79], v[148:151]
  v_mfma_f32_16x16x32_bf16 v[152:155], a[156:159], v[76:79], v[152:155]
  v_max3_u32 v170, v76, v77, v170
  v_max3_u32 v170, v78, v79, v170
  s_waitcnt vmcnt(17)
  v_mfma_f32_16x16x32_bf16 v[148:151], a[160:163], v[80:83], v[148:151]
  v_mfma_f32_16x16x32_bf16 v[152:155], a[164:167], v[80:83], v[152:155]
  v_max3_u32 v170, v80, v81, v170
  v_max3_u32 v170, v82, v83, v170
  s_waitcnt vmcnt(16)
  v_mfma_f32_16x16x32_bf16 v[148:151], a[168:171], v[84:87], v[148:151]
  v_mfma_f32_16x16x32_bf16 v[152:155], a[172:175], v[84:87], v[152:155]
  v_max3_u32 v170, v84, v85, v170
  v_max3_u32 v170, v86, v87, v170
  s_waitcnt vmcnt(15)
  v_mfma_f32_16x16x32_bf16 v[148:151], a[176:179], v[88:91], v[148:151]
  v_mfma_f32_16x16x32_bf16 v[152:155], a[180:183], v[88:91], v[152:155]
  v_max3_u32 v170, v88, v89, v170
  v_max3_u32 v170, v90, v91, v170
  s_waitcnt vmcnt(14)
  v_mfma_f32_16x16x32_bf16 v[148:151], a[184:187], v[92:95], v[148:151]
  v_mfma_f32_16x16x32_bf16 v[152:155], a[188:191], v[92:95], v[152:155]
  v_max3_u32 v170, v92, v93, v170
  v_max3_u32 v170, v94, v95, v170
  s_waitcnt vmcnt(13)
  v_mfma_f32_16x16x32_bf16 v[148:151], a[192:195], v[96:99], v[148:151]
  v_mfma_f32_16x16x32_bf16 v[152:155], a[196:199], v[96:99], v[152:155]
  v_max3_u32 v170, v96, v97, v170
  v_max3_u32 v170, v98, v99, v170
  s_waitcnt vmcnt(12)
  v_mfma_f32_16x16x32_bf16 v[148:151], a[200:203], v[100:103], v[148:151]
  v_mfma_f32_16x16x32_bf16 v[152:155], a[204:207], v[100:103], v[152:155]
  v_max3_u32 v170, v100, v101, v170
  v_max3_u32 v170, v102, v103, v170
  s_waitcnt vmcnt(11)
  v_mfma_f32_16x16x32_bf16 v[148:151], a[208:211], v[104:107], v[148:151]
  v_mfma_f32_16x16x32_bf16 v[152:155], a[212:215], v[104:107], v[152:155]
  v_max3_u32 v170, v104, v105, v170
  v_max3_u32 v170, v106, v107, v170
  s_waitcnt vmcnt(10)
  v_mfma_f32_16x16x32_bf16 v[148:151], a[216:219], v[108:111], v[148:151]
  v_mfma_f32_16x16x32_bf16 v[152:155], a[220:223], v[108:111], v[152:155]
  v_max3_u32 v170, v108, v109, v170
  v_max3_u32 v170, v110, v111, v170
  s_waitcnt vmcnt(9)
  v_mfma_f32_16x16x32_bf16 v[148:151], a[224:227], v[112:115], v[148:151]
  v_mfma_f32_16x16x32_bf16 v[152:155], a[228:231], v[112:115], v[152:155]
  v_max3_u32 v170, v112, v113, v170
  v_max3_u32 v170, v114, v115, v170
  s_waitcnt vmcnt(8)
  v_mfma_f32_16x16x32_bf16 v[148:151], a[232:235], v[116:119], v[148:151]
  v_mfma_f32_16x16x32_bf16 v[152:155], a[236:239], v[116:119], v[152:155]
  v_max3_u32 v170, v116, v117, v170
  v_max3_u32 v170, v118, v119, v170
  s_waitcnt vmcnt(7)
  v_mfma_f32_16x16x32_bf16 v[148:151], a[240:243], v[120:123], v[148:151]
  v_mfma_f32_16x16x32_bf16 v[152:155], a[244:247], v[120:123], v[152:155]
  v_max3_u32 v170, v120, v121, v170
  v_max3_u32 v170, v122, v123, v170
  s_waitcnt vmcnt(6)
  v_mfma_f32_16x16x32_bf16 v[148:151], a[248:251], v[124:127], v[148:151]
  v_mfma_f32_16x16x32_bf16 v[152:155], a[252:255], v[124:127], v[152:155]
  v_max3_u32 v170, v124, v125, v170
  v_max3_u32 v170, v126, v127, v170
  v_cmp_lt_u32 vcc, s54, v170
  s_cbranch_vccnz O_ld
  v_fmac_f32 v156, v165, v148
  v_fmac_f32 v157, v165, v149
  v_fmac_f32 v158, v165, v150
  v_fmac_f32 v159, v165, v151
  v_fmac_f32 v160, v165, v152
  v_fmac_f32 v161, v165, v153
  v_fmac_f32 v162, v165, v154
  v_fmac_f32 v163, v165, v155
  ds_write_b128 v168, v[156:159]
  ds_write_b128 v168, v[160:163] offset:1024
  v_xor_b32 v168, 0x2000, v168
  s_mov_b32 s59, s57
  s_waitcnt lgkmcnt(0)
  s_barrier
  s_cmp_eq_u32 s52, 0
  s_cbranch_scc0 O_next
  v_xor_b32 v211, 0x2000, v168
  ds_read_b128 v[0:3], v211 offset:2048
  ds_read_b128 v[4:7], v211 offset:3072
  ds_read_b128 v[8:11], v211 offset:4096
  ds_read_b128 v[12:15], v211 offset:5120
  ds_read_b128 v[16:19], v211 offset:6144
  ds_read_b128 v[20:23], v211 offset:7168
  s_waitcnt lgkmcnt(5)
  v_add_f32 v156, v156, v0
  v_add_f32 v157, v157, v1
  v_add_f32 v158, v158, v2
  v_add_f32 v159, v159, v3
  s_waitcnt lgkmcnt(4)
  v_add_f32 v160, v160, v4
  v_add_f32 v161, v161, v5
  v_add_f32 v162, v162, v6
  v_add_f32 v163, v163, v7
  s_waitcnt lgkmcnt(3)
  v_add_f32 v156, v156, v8
  v_add_f32 v157, v157, v9
  v_add_f32 v158, v158, v10
  v_add_f32 v159, v159, v11
  s_waitcnt lgkmcnt(2)
  v_add_f32 v160, v160, v12
  v_add_f32 v161, v161, v13
  v_add_f32 v162, v162, v14
  v_add_f32 v163, v163, v15
  s_waitcnt lgkmcnt(1)
  v_add_f32 v156, v156, v16
  v_add_f32 v157, v157, v17
  v_add_f32 v158, v158, v18
  v_add_f32 v159, v159, v19
  s_waitcnt lgkmcnt(0)
  v_add_f32 v160, v160, v20
  v_add_f32 v161, v161, v21
  v_add_f32 v162, v162, v22
  v_add_f32 v163, v163, v23
  v_cvt_pk_bf16_f32 v148, v156, v157
  v_cvt_pk_bf16_f32 v149, v158, v159
  v_cvt_pk_bf16_f32 v150, v160, v161
  v_cvt_pk_bf16_f32 v151, v162, v163
  buffer_store_dwordx4 v[148:151], v167, s[48:51], s64 offen sc1
  s_waitcnt vmcnt(1)
  s_branch O_nx2
O_next:
  s_waitcnt vmcnt(0)
O_nx2:
  s_cmp_lt_u32 s59, 64
  s_cbranch_scc1 O_loop
  s_branch L_exit
W_h:
  s_lshr_b32 s58, s53, 1
  s_and_b32 s59, s53, 1
  s_mul_i32 s60, s59, 36864
  s_add_u32 m0, s67, 0
  s_nop 0
  buffer_load_dwordx4 v202, s[4:7], s60 offen offset:0 lds
  s_add_u32 m0, s67, 896
  s_nop 0
  buffer_load_dwordx4 v202, s[4:7], s60 offen offset:128 lds
  s_add_u32 m0, s67, 1792
  s_nop 0
  buffer_load_dwordx4 v202, s[4:7], s60 offen offset:256 lds
  s_add_u32 m0, s67, 2688
  s_nop 0
  buffer_load_dwordx4 v202, s[4:7], s60 offen offset:384 lds
  s_add_u32 m0, s67, 3584
  s_nop 0
  buffer_load_dwordx4 v202, s[4:7], s60 offen offset:512 lds
  s_add_u32 m0, s67, 4480
  s_nop 0
  buffer_load_dwordx4 v202, s[4:7], s60 offen offset:640 lds
  s_add_u32 m0, s67, 5376
  s_nop 0
  buffer_load_dwordx4 v202, s[4:7], s60 offen offset:768 lds
  s_add_u32 m0, s67, 6272
  s_nop 0
  buffer_load_dwordx4 v202, s[4:7], s60 offen offset:896 lds
  s_add_u32 m0, s67, 7168
  s_nop 0
  buffer_load_dwordx4 v202, s[4:7], s60 offen offset:1024 lds
  v_lshrrev_b32 v211, 4, v200
  v_lshlrev_b32 v212, 2, v211
  v_and_b32 v213, 15, v200
  v_xor_b32 v212, v212, v213
  v_lshlrev_b32 v212, 4, v212
  v_lshl_add_u32 v207, v211, 13, v212
  s_lshl_b32 s62, s58, 8
  s_lshl_b32 s54, s52, 15
  s_add_u32 s62, s62, s54
  s_lshl_b32 s61, s52, 10
  s_add_u32 s61, s61, 36864
  s_add_u32 m0, s61, 0
  s_add_u32 s54, s62, 0
  buffer_load_dwordx4 v207, s[16:19], s54 offen lds
  s_add_u32 m0, s61, 4096
  s_add_u32 s54, s62, 131072
  buffer_load_dwordx4 v207, s[16:19], s54 offen lds
  s_add_u32 m0, s61, 8192
  s_add_u32 s54, s62, 262144
  buffer_load_dwordx4 v207, s[16:19], s54 offen lds
  s_add_u32 m0, s61, 12288
  s_add_u32 s54, s62, 393216
  buffer_load_dwordx4 v207, s[16:19], s54 offen lds
  s_add_u32 m0, s61, 16384
  s_add_u32 s54, s62, 524288
  buffer_load_dwordx4 v207, s[16:19], s54 offen lds
  s_add_u32 m0, s61, 20480
  s_add_u32 s54, s62, 655360
  buffer_load_dwordx4 v207, s[16:19], s54 offen lds
  s_add_u32 m0, s61, 24576
  s_add_u32 s54, s62, 786432
  buffer_load_dwordx4 v207, s[16:19], s54 offen lds
  s_add_u32 m0, s61, 28672
  s_add_u32 s54, s62, 917504
  buffer_load_dwordx4 v207, s[16:19], s54 offen lds
  s_add_u32 m0, s61, 32768
  s_add_u32 s54, s62, 1048576
  buffer_load_dwordx4 v207, s[16:19], s54 offen lds
  s_add_u32 m0, s61, 36864
  s_add_u32 s54, s62, 1179648
  buffer_load_dwordx4 v207, s[16:19], s54 offen lds
  s_add_u32 m0, s61, 40960
  s_add_u32 s54, s62, 1310720
  buffer_load_dwordx4 v207, s[16:19], s54 offen lds
  s_add_u32 m0, s61, 45056
  s_add_u32 s54, s62, 1441792
  buffer_load_dwordx4 v207, s[16:19], s54 offen lds
  s_add_u32 m0, s61, 49152
  s_add_u32 s54, s62, 1572864
  buffer_load_dwordx4 v207, s[16:19], s54 offen lds
  s_add_u32 m0, s61, 53248
  s_add_u32 s54, s62, 1703936
  buffer_load_dwordx4 v207, s[16:19], s54 offen lds
  s_add_u32 m0, s61, 57344
  s_add_u32 s54, s62, 1835008
  buffer_load_dwordx4 v207, s[16:19], s54 offen lds
  s_add_u32 m0, s61, 61440
  s_add_u32 s54, s62, 1966080
  buffer_load_dwordx4 v207, s[16:19], s54 offen lds
  s_add_u32 m0, s61, 65536
  s_add_u32 s54, s62, 2097152
  buffer_load_dwordx4 v207, s[16:19], s54 offen lds
  s_add_u32 m0, s61, 69632
  s_add_u32 s54, s62, 2228224
  buffer_load_dwordx4 v207, s[16:19], s54 offen lds
  s_add_u32 m0, s61, 73728
  s_add_u32 s54, s62, 2359296
  buffer_load_dwordx4 v207, s[16:19], s54 offen lds
  s_add_u32 m0, s61, 77824
  s_add_u32 s54, s62, 2490368
  buffer_load_dwordx4 v207, s[16:19], s54 offen lds
  s_add_u32 m0, s61, 81920
  s_add_u32 s54, s62, 2621440
  buffer_load_dwordx4 v207, s[16:19], s54 offen lds
  s_add_u32 m0, s61, 86016
  s_add_u32 s54, s62, 2752512
  buffer_load_dwordx4 v207, s[16:19], s54 offen lds
  s_add_u32 m0, s61, 90112
  s_add_u32 s54, s62, 2883584
  buffer_load_dwordx4 v207, s[16:19], s54 offen lds
  s_add_u32 m0, s61, 94208
  s_add_u32 s54, s62, 3014656
  buffer_load_dwordx4 v207, s[16:19], s54 offen lds
  s_waitcnt vmcnt(20) lgkmcnt(0)
  s_barrier
  s_add_u32 m0, s61, 98304
  s_add_u32 s54, s62, 3145728
  buffer_load_dwordx4 v207, s[16:19], s54 offen lds
  s_add_u32 m0, s61, 102400
  s_add_u32 s54, s62, 3276800
  buffer_load_dwordx4 v207, s[16:19], s54 offen lds
  s_add_u32 m0, s61, 106496
  s_add_u32 s54, s62, 3407872
  buffer_load_dwordx4 v207, s[16:19], s54 offen lds
  s_add_u32 m0, s61, 110592
  s_add_u32 s54, s62, 3538944
  buffer_load_dwordx4 v207, s[16:19], s54 offen lds
  v_add_u32 v215, 36864, v209
  ds_read_b64_tr_b16 a[0:1], v215 offset:0
  ds_read_b64_tr_b16 a[2:3], v215 offset:1024
  ds_read_b64_tr_b16 a[4:5], v215 offset:4096
  ds_read_b64_tr_b16 a[6:7], v215 offset:5120
  ds_read_b64_tr_b16 a[8:9], v215 offset:8192
  ds_read_b64_tr_b16 a[10:11], v215 offset:9216
  ds_read_b64_tr_b16 a[12:13], v215 offset:12288
  ds_read_b64_tr_b16 a[14:15], v215 offset:13312
  s_waitcnt vmcnt(20) lgkmcnt(0)
  s_barrier
  s_add_u32 m0, s61, 0
  s_add_u32 s54, s62, 3670016
  buffer_load_dwordx4 v207, s[16:19], s54 offen lds
  s_add_u32 m0, s61, 4096
  s_add_u32 s54, s62, 3801088
  buffer_load_dwordx4 v207, s[16:19], s54 offen lds
  s_add_u32 m0, s61, 8192
  s_add_u32 s54, s62, 3932160
  buffer_load_dwordx4 v207, s[16:19], s54 offen lds
  s_add_u32 m0, s61, 12288
  s_add_u32 s54, s62, 4063232
  buffer_load_dwordx4 v207, s[16:19], s54 offen lds
  v_add_u32 v215, 53248, v209
  ds_read_b64_tr_b16 a[16:17], v215 offset:0
  ds_read_b64_tr_b16 a[18:19], v215 offset:1024
  ds_read_b64_tr_b16 a[20:21], v215 offset:4096
  ds_read_b64_tr_b16 a[22:23], v215 offset:5120
  ds_read_b64_tr_b16 a[24:25], v215 offset:8192
  ds_read_b64_tr_b16 a[26:27], v215 offset:9216
  ds_read_b64_tr_b16 a[28:29], v215 offset:12288
  ds_read_b64_tr_b16 a[30:31], v215 offset:13312
  s_waitcnt vmcnt(20) lgkmcnt(0)
  s_barrier
  s_add_u32 m0, s61, 16384
  s_add_u32 s54, s62, 4194304
  buffer_load_dwordx4 v207, s[16:19], s54 offen lds
  s_add_u32 m0, s61, 20480
  s_add_u32 s54, s62, 4325376
  buffer_load_dwordx4 v207, s[16:19], s54 offen lds
  s_add_u32 m0, s61, 24576
  s_add_u32 s54, s62, 4456448
  buffer_load_dwordx4 v207, s[16:19], s54 offen lds
  s_add_u32 m0, s61, 28672
  s_add_u32 s54, s62, 4587520
  buffer_load_dwordx4 v207, s[16:19], s54 offen lds
  v_add_u32 v215, 69632, v209
  ds_read_b64_tr_b16 a[32:33], v215 offset:0
  ds_read_b64_tr_b16 a[34:35], v215 offset:1024
  ds_read_b64_tr_b16 a[36:37], v215 offset:4096
  ds_read_b64_tr_b16 a[38:39], v215 offset:5120
  ds_read_b64_tr_b16 a[40:41], v215 offset:8192
  ds_read_b64_tr_b16 a[42:43], v215 offset:9216
  ds_read_b64_tr_b16 a[44:45], v215 offset:12288
  ds_read_b64_tr_b16 a[46:47], v215 offset:13312
  s_waitcnt vmcnt(20) lgkmcnt(0)
  s_barrier
  v_add_u32 v215, 86016, v209
  ds_read_b64_tr_b16 a[48:49], v215 offset:0
  ds_read_b64_tr_b16 a[50:51], v215 offset:1024
  ds_read_b64_tr_b16 a[52:53], v215 offset:4096
  ds_read_b64_tr_b16 a[54:55], v215 offset:5120
  ds_read_b64_tr_b16 a[56:57], v215 offset:8192
  ds_read_b64_tr_b16 a[58:59], v215 offset:9216
  ds_read_b64_tr_b16 a[60:61], v215 offset:12288
  ds_read_b64_tr_b16 a[62:63], v215 offset:13312
  s_waitcnt vmcnt(16) lgkmcnt(0)
  s_barrier
  v_add_u32 v215, 102400, v209
  ds_read_b64_tr_b16 a[64:65], v215 offset:0
  ds_read_b64_tr_b16 a[66:67], v215 offset:1024
  ds_read_b64_tr_b16 a[68:69], v215 offset:4096
  ds_read_b64_tr_b16 a[70:71], v215 offset:5120
  ds_read_b64_tr_b16 a[72:73], v215 offset:8192
  ds_read_b64_tr_b16 a[74:75], v215 offset:9216
  ds_read_b64_tr_b16 a[76:77], v215 offset:12288
  ds_read_b64_tr_b16 a[78:79], v215 offset:13312
  s_waitcnt vmcnt(12) lgkmcnt(0)
  s_barrier
  v_add_u32 v215, 118784, v209
  ds_read_b64_tr_b16 a[80:81], v215 offset:0
  ds_read_b64_tr_b16 a[82:83], v215 offset:1024
  ds_read_b64_tr_b16 a[84:85], v215 offset:4096
  ds_read_b64_tr_b16 a[86:87], v215 offset:5120
  ds_read_b64_tr_b16 a[88:89], v215 offset:8192
  ds_read_b64_tr_b16 a[90:91], v215 offset:9216
  ds_read_b64_tr_b16 a[92:93], v215 offset:12288
  ds_read_b64_tr_b16 a[94:95], v215 offset:13312
  s_waitcnt vmcnt(8) lgkmcnt(0)
  s_barrier
  v_add_u32 v215, 135168, v209
  ds_read_b64_tr_b16 a[96:97], v215 offset:0
  ds_read_b64_tr_b16 a[98:99], v215 offset:1024
  ds_read_b64_tr_b16 a[100:101], v215 offset:4096
  ds_read_b64_tr_b16 a[102:103], v215 offset:5120
  ds_read_b64_tr_b16 a[104:105], v215 offset:8192
  ds_read_b64_tr_b16 a[106:107], v215 offset:9216
  ds_read_b64_tr_b16 a[108:109], v215 offset:12288
  ds_read_b64_tr_b16 a[110:111], v215 offset:13312
  s_waitcnt vmcnt(4) lgkmcnt(0)
  s_barrier
  v_add_u32 v215, 36864, v209
  ds_read_b64_tr_b16 a[112:113], v215 offset:0
  ds_read_b64_tr_b16 a[114:115], v215 offset:1024
  ds_read_b64_tr_b16 a[116:117], v215 offset:4096
  ds_read_b64_tr_b16 a[118:119], v215 offset:5120
  ds_read_b64_tr_b16 a[120:121], v215 offset:8192
  ds_read_b64_tr_b16 a[122:123], v215 offset:9216
  ds_read_b64_tr_b16 a[124:125], v215 offset:12288
  ds_read_b64_tr_b16 a[126:127], v215 offset:13312
  s_waitcnt vmcnt(0) lgkmcnt(0)
  s_barrier
  v_add_u32 v215, 53248, v209
  ds_read_b64_tr_b16 a[128:129], v215 offset:0
  ds_read_b64_tr_b16 a[130:131], v215 offset:1024
  ds_read_b64_tr_b16 a[132:133], v215 offset:4096
  ds_read_b64_tr_b16 a[134:135], v215 offset:5120
  ds_read_b64_tr_b16 a[136:137], v215 offset:8192
  ds_read_b64_tr_b16 a[138:139], v215 offset:9216
  ds_read_b64_tr_b16 a[140:141], v215 offset:12288
  ds_read_b64_tr_b16 a[142:143], v215 offset:13312
  s_waitcnt lgkmcnt(0)
  s_barrier
  v_and_b32 v211, 31, v200
  v_lshrrev_b32 v212, 5, v200
  v_lshlrev_b32 v213, 2, v212
  v_sub_u32 v211, v211, v213
  v_mov_b32 v214, 0xf149f2ca
  v_cmp_gt_i32 vcc, 0, v211
  s_nop 1
  v_cndmask_b32 v48, 0, v214, vcc
  v_cmp_gt_i32 vcc, 1, v211
  s_nop 1
  v_cndmask_b32 v49, 0, v214, vcc
  v_cmp_gt_i32 vcc, 2, v211
  s_nop 1
  v_cndmask_b32 v50, 0, v214, vcc
  v_cmp_gt_i32 vcc, 3, v211
  s_nop 1
  v_cndmask_b32 v51, 0, v214, vcc
  v_cmp_gt_i32 vcc, 8, v211
  s_nop 1
  v_cndmask_b32 v52, 0, v214, vcc
  v_cmp_gt_i32 vcc, 9, v211
  s_nop 1
  v_cndmask_b32 v53, 0, v214, vcc
  v_cmp_gt_i32 vcc, 10, v211
  s_nop 1
  v_cndmask_b32 v54, 0, v214, vcc
  v_cmp_gt_i32 vcc, 11, v211
  s_nop 1
  v_cndmask_b32 v55, 0, v214, vcc
  v_cmp_gt_i32 vcc, 16, v211
  s_nop 1
  v_cndmask_b32 v56, 0, v214, vcc
  v_cmp_gt_i32 vcc, 17, v211
  s_nop 1
  v_cndmask_b32 v57, 0, v214, vcc
  v_cmp_gt_i32 vcc, 18, v211
  s_nop 1
  v_cndmask_b32 v58, 0, v214, vcc
  v_cmp_gt_i32 vcc, 19, v211
  s_nop 1
  v_cndmask_b32 v59, 0, v214, vcc
  v_cmp_gt_i32 vcc, 24, v211
  s_nop 1
  v_cndmask_b32 v60, 0, v214, vcc
  v_cmp_gt_i32 vcc, 25, v211
  s_nop 1
  v_cndmask_b32 v61, 0, v214, vcc
  v_cmp_gt_i32 vcc, 26, v211
  s_nop 1
  v_cndmask_b32 v62, 0, v214, vcc
  v_cmp_gt_i32 vcc, 27, v211
  s_nop 1
  v_cndmask_b32 v63, 0, v214, vcc
  v_and_b32 v218, 0xff, v216
  v_add_u32 v218, 81920, v218
  v_and_b32 v211, 15, v200
  v_lshl_add_u32 v211, v212, 5, v211
  v_lshlrev_b32 v219, 3, v211
  v_bfe_u32 v211, v200, 4, 1
  v_lshl_add_u32 v219, v211, 2, v219
  s_lshl_b32 s54, s52, 9
  s_add_u32 s54, s54, 83968
  v_add_u32 v219, s54, v219
  v_lshl_add_u32 v221, v200, 3, s54
  s_lshr_b32 s54, s52, 1
  s_lshl_b32 s54, s54, 10
  s_and_b32 s55, s52, 1
  s_lshl_b32 s55, s55, 3
  s_add_u32 s54, s54, s55
  s_add_u32 s54, s54, 81920
  v_add_u32 v220, s54, v201
  s_lshl_b32 s54, s52, 11
  s_add_u32 s54, s54, 73728
  v_add_u32 v215, s54, v201
  v_add_u32 v208, 73728, v201
  s_mov_b32 s68, 1040356334
  s_cmp_eq_u32 s52, 0
  s_cselect_b32 s71, s71, 268435456
  s_lshl_b32 s56, s58, 2
  s_add_u32 s56, s56, 128
  v_mov_b32 v176, -1
  v_mov_b32 v177, -1
  v_mov_b32 v178, -1
  v_mov_b32 v179, -1
  s_cmp_eq_u32 s52, 0
  s_cbranch_scc0 AT_p1_d
  s_mov_b32 exec_hi, 0
  s_mov_b32 exec_lo, 1
AT_p1:
  buffer_load_dword v211, v201, s[12:15], s56 offen sc1
  s_add_u32 s65, s65, 1
  s_waitcnt vmcnt(0)
  v_cmp_gt_u32 vcc, 0x700, v211
  s_cbranch_vccz AT_p1_x
  s_sleep 8
  s_cmp_lt_u32 s65, 131072
  s_cbranch_scc1 AT_p1
AT_p1_x:
  s_mov_b64 exec, -1
AT_p1_d:
  s_barrier
  s_mov_b32 s74, s59
  s_mul_i32 s66, s59, 655360
  s_lshl_b32 s55, s58, 14
  s_add_u32 s55, s55, s66
  s_add_u32 s55, s55, 1048576
  s_lshl_b32 s73, s58, 2
  s_add_u32 s73, s73, s52
  s_lshl_b32 s72, s59, 7
  s_add_u32 s72, s72, s73
  s_lshl_b32 s72, s72, 11
  s_add_u32 s72, s72, 46137344
  s_lshl_b32 s73, s73, 10
  s_add_u32 s73, s73, s66
  s_add_u32 s73, s73, 1572864
  s_add_u32 s59, s59, 2
  buffer_load_dwordx4 v[128:131], v216, s[8:11], s55 offen offset:0 sc1
  buffer_load_dwordx4 v[132:135], v216, s[8:11], s55 offen offset:256 sc1
  buffer_load_dwordx4 v[136:139], v216, s[8:11], s55 offen offset:512 sc1
  buffer_load_dwordx4 v[140:143], v216, s[8:11], s55 offen offset:768 sc1
  buffer_load_dwordx4 v[144:147], v216, s[8:11], s55 offen offset:1024 sc1
  buffer_load_dwordx4 v[148:151], v216, s[8:11], s55 offen offset:1280 sc1
  buffer_load_dwordx4 v[152:155], v216, s[8:11], s55 offen offset:1536 sc1
  buffer_load_dwordx4 v[156:159], v216, s[8:11], s55 offen offset:1792 sc1
  buffer_load_dwordx4 v[160:163], v217, s[8:11], s55 offen offset:0 sc1
  buffer_load_dwordx4 v[164:167], v217, s[8:11], s55 offen offset:256 sc1
  s_add_u32 s60, s60, 73728
  ds_read_b128 v[32:35], v203 offset:0
  ds_read_b128 v[36:39], v204 offset:0
  ds_read_b128 v[40:43], v205 offset:0
  s_waitcnt lgkmcnt(2)
  v_mfma_f32_32x32x16_bf16 v[240:255], a[0:3], v[32:35], 0
  ds_read_b128 v[44:47], v206 offset:0
  s_add_u32 m0, s67, 36864
  s_nop 0
  buffer_load_dwordx4 v202, s[4:7], s60 offen offset:0 lds
  s_waitcnt lgkmcnt(2)
  v_mfma_f32_32x32x16_bf16 v[240:255], a[4:7], v[36:39], v[240:255]
  ds_read_b128 v[32:35], v203 offset:1024
  s_waitcnt lgkmcnt(2)
  v_mfma_f32_32x32x16_bf16 v[240:255], a[8:11], v[40:43], v[240:255]
  ds_read_b128 v[36:39], v204 offset:1024
  s_add_u32 m0, s67, 37760
  s_nop 0
  buffer_load_dwordx4 v202, s[4:7], s60 offen offset:128 lds
  s_waitcnt lgkmcnt(2)
  v_mfma_f32_32x32x16_bf16 v[240:255], a[12:15], v[44:47], v[240:255]
  ds_read_b128 v[40:43], v205 offset:1024
  s_waitcnt lgkmcnt(2)
  v_mfma_f32_32x32x16_bf16 v[240:255], a[16:19], v[32:35], v[240:255]
  ds_read_b128 v[44:47], v206 offset:1024
  s_add_u32 m0, s67, 38656
  s_nop 0
  buffer_load_dwordx4 v202, s[4:7], s60 offen offset:256 lds
  s_waitcnt lgkmcnt(2)
  v_mfma_f32_32x32x16_bf16 v[240:255], a[20:23], v[36:39], v[240:255]
  ds_read_b128 v[32:35], v203 offset:2048
  s_waitcnt lgkmcnt(2)
  v_mfma_f32_32x32x16_bf16 v[240:255], a[24:27], v[40:43], v[240:255]
  ds_read_b128 v[36:39], v204 offset:2048
  s_add_u32 m0, s67, 39552
  s_nop 0
  buffer_load_dwordx4 v202, s[4:7], s60 offen offset:384 lds
  s_waitcnt lgkmcnt(2)
  v_mfma_f32_32x32x16_bf16 v[240:255], a[28:31], v[44:47], v[240:255]
  ds_read_b128 v[40:43], v205 offset:2048
  s_waitcnt lgkmcnt(2)
  v_mfma_f32_32x32x16_bf16 v[240:255], a[32:35], v[32:35], v[240:255]
  ds_read_b128 v[44:47], v206 offset:2048
  s_add_u32 m0, s67, 40448
  s_nop 0
  buffer_load_dwordx4 v202, s[4:7], s60 offen offset:512 lds
  s_waitcnt lgkmcnt(2)
  v_mfma_f32_32x32x16_bf16 v[240:255], a[36:39], v[36:39], v[240:255]
  ds_read_b128 v[32:35], v203 offset:3072
  s_waitcnt lgkmcnt(2)
  v_mfma_f32_32x32x16_bf16 v[240:255], a[40:43], v[40:43], v[240:255]
  ds_read_b128 v[36:39], v204 offset:3072
  s_add_u32 m0, s67, 41344
  s_nop 0
  buffer_load_dwordx4 v202, s[4:7], s60 offen offset:640 lds
  s_waitcnt lgkmcnt(2)
  v_mfma_f32_32x32x16_bf16 v[240:255], a[44:47], v[44:47], v[240:255]
  ds_read_b128 v[40:43], v205 offset:3072
  s_waitcnt lgkmcnt(2)
  v_mfma_f32_32x32x16_bf16 v[240:255], a[48:51], v[32:35], v[240:255]
  ds_read_b128 v[44:47], v206 offset:3072
  s_add_u32 m0, s67, 42240
  s_nop 0
  buffer_load_dwordx4 v202, s[4:7], s60 offen offset:768 lds
  s_waitcnt lgkmcnt(2)
  v_mfma_f32_32x32x16_bf16 v[240:255], a[52:55], v[36:39], v[240:255]
  ds_read_b128 v[32:35], v203 offset:4096
  s_waitcnt lgkmcnt(2)
  v_mfma_f32_32x32x16_bf16 v[240:255], a[56:59], v[40:43], v[240:255]
  ds_read_b128 v[36:39], v204 offset:4096
  s_add_u32 m0, s67, 43136
  s_nop 0
  buffer_load_dwordx4 v202, s[4:7], s60 offen offset:896 lds
  s_waitcnt lgkmcnt(2)
  v_mfma_f32_32x32x16_bf16 v[240:255], a[60:63], v[44:47], v[240:255]
  ds_read_b128 v[40:43], v205 offset:4096
  s_waitcnt lgkmcnt(2)
  v_mfma_f32_32x32x16_bf16 v[240:255], a[64:67], v[32:35], v[240:255]
  ds_read_b128 v[44:47], v206 offset:4096
  s_add_u32 m0, s67, 44032
  s_nop 0
  buffer_load_dwordx4 v202, s[4:7], s60 offen offset:1024 lds
  s_waitcnt lgkmcnt(2)
  v_mfma_f32_32x32x16_bf16 v[240:255], a[68:71], v[36:39], v[240:255]
  ds_read_b128 v[32:35], v203 offset:5120
  s_waitcnt lgkmcnt(2)
  v_mfma_f32_32x32x16_bf16 v[240:255], a[72:75], v[40:43], v[240:255]
  ds_read_b128 v[36:39], v204 offset:5120
  buffer_store_dwordx4 v[176:179], v201, s[8:11], s72 offen offset:0 sc1
  s_waitcnt lgkmcnt(2)
  v_mfma_f32_32x32x16_bf16 v[240:255], a[76:79], v[44:47], v[240:255]
  ds_read_b128 v[40:43], v205 offset:5120
  s_waitcnt lgkmcnt(2)
  v_mfma_f32_32x32x16_bf16 v[240:255], a[80:83], v[32:35], v[240:255]
  ds_read_b128 v[44:47], v206 offset:5120
  buffer_store_dwordx4 v[176:179], v201, s[8:11], s72 offen offset:1024 sc1
  s_waitcnt lgkmcnt(2)
  v_mfma_f32_32x32x16_bf16 v[240:255], a[84:87], v[36:39], v[240:255]
  ds_read_b128 v[32:35], v203 offset:6144
  s_waitcnt lgkmcnt(2)
  v_mfma_f32_32x32x16_bf16 v[240:255], a[88:91], v[40:43], v[240:255]
  ds_read_b128 v[36:39], v204 offset:6144
  s_waitcnt lgkmcnt(2)
  v_mfma_f32_32x32x16_bf16 v[240:255], a[92:95], v[44:47], v[240:255]
  ds_read_b128 v[40:43], v205 offset:6144
  s_waitcnt lgkmcnt(2)
  v_mfma_f32_32x32x16_bf16 v[240:255], a[96:99], v[32:35], v[240:255]
  ds_read_b128 v[44:47], v206 offset:6144
  s_waitcnt lgkmcnt(2)
  v_mfma_f32_32x32x16_bf16 v[240:255], a[100:103], v[36:39], v[240:255]
  ds_read_b128 v[32:35], v203 offset:7168
  s_waitcnt lgkmcnt(2)
  v_mfma_f32_32x32x16_bf16 v[240:255], a[104:107], v[40:43], v[240:255]
  ds_read_b128 v[36:39], v204 offset:7168
  s_waitcnt lgkmcnt(2)
  v_mfma_f32_32x32x16_bf16 v[240:255], a[108:111], v[44:47], v[240:255]
  ds_read_b128 v[40:43], v205 offset:7168
  s_waitcnt lgkmcnt(2)
  v_mfma_f32_32x32x16_bf16 v[240:255], a[112:115], v[32:35], v[240:255]
  ds_read_b128 v[44:47], v206 offset:7168
  s_waitcnt lgkmcnt(2)
  v_mfma_f32_32x32x16_bf16 v[240:255], a[116:119], v[36:39], v[240:255]
  ds_read_b128 v[32:35], v203 offset:8192
  s_waitcnt lgkmcnt(2)
  v_mfma_f32_32x32x16_bf16 v[240:255], a[120:123], v[40:43], v[240:255]
  ds_read_b128 v[36:39], v204 offset:8192
  s_waitcnt lgkmcnt(2)
  v_mfma_f32_32x32x16_bf16 v[240:255], a[124:127], v[44:47], v[240:255]
  ds_read_b128 v[40:43], v205 offset:8192
  s_waitcnt lgkmcnt(2)
  v_mfma_f32_32x32x16_bf16 v[240:255], a[128:131], v[32:35], v[240:255]
  ds_read_b128 v[44:47], v206 offset:8192
  s_waitcnt lgkmcnt(2)
  v_mfma_f32_32x32x16_bf16 v[240:255], a[132:135], v[36:39], v[240:255]
  s_waitcnt lgkmcnt(1)
  v_mfma_f32_32x32x16_bf16 v[240:255], a[136:139], v[40:43], v[240:255]
  s_waitcnt lgkmcnt(0)
  v_mfma_f32_32x32x16_bf16 v[240:255], a[140:143], v[44:47], v[240:255]
  s_nop 11
  v_cvt_pk_bf16_f32 v16, v240, v244
  v_cvt_pk_bf16_f32 v17, v241, v245
  v_cvt_pk_bf16_f32 v18, v242, v246
  v_cvt_pk_bf16_f32 v19, v243, v247
  ds_write_b128 v215, v[16:19] offset:0
  v_cvt_pk_bf16_f32 v20, v248, v252
  v_cvt_pk_bf16_f32 v21, v249, v253
  v_cvt_pk_bf16_f32 v22, v250, v254
  v_cvt_pk_bf16_f32 v23, v251, v255
  ds_write_b128 v215, v[20:23] offset:1024
  s_waitcnt lgkmcnt(0)
  s_barrier
  ds_read_b128 v[96:99], v208 offset:0
  ds_read_b128 v[100:103], v208 offset:1024
  ds_read_b128 v[104:107], v208 offset:2048
  ds_read_b128 v[108:111], v208 offset:3072
  ds_read_b128 v[112:115], v208 offset:4096
  ds_read_b128 v[116:119], v208 offset:5120
  ds_read_b128 v[120:123], v208 offset:6144
  ds_read_b128 v[124:127], v208 offset:7168
  s_waitcnt vmcnt(20) lgkmcnt(7)
  v_mfma_f32_32x32x16_bf16 v[64:79], v[128:131], v[96:99], v[48:63]
  s_waitcnt vmcnt(19) lgkmcnt(6)
  v_mfma_f32_32x32x16_bf16 v[64:79], v[132:135], v[100:103], v[64:79]
  s_waitcnt vmcnt(18) lgkmcnt(5)
  v_mfma_f32_32x32x16_bf16 v[64:79], v[136:139], v[104:107], v[64:79]
  s_waitcnt vmcnt(17) lgkmcnt(4)
  v_mfma_f32_32x32x16_bf16 v[64:79], v[140:143], v[108:111], v[64:79]
  s_waitcnt vmcnt(16) lgkmcnt(3)
  v_mfma_f32_32x32x16_bf16 v[64:79], v[144:147], v[112:115], v[64:79]
  s_waitcnt vmcnt(15) lgkmcnt(2)
  v_mfma_f32_32x32x16_bf16 v[64:79], v[148:151], v[116:119], v[64:79]
  s_waitcnt vmcnt(14) lgkmcnt(1)
  v_mfma_f32_32x32x16_bf16 v[64:79], v[152:155], v[120:123], v[64:79]
  s_waitcnt vmcnt(13) lgkmcnt(0)
  v_mfma_f32_32x32x16_bf16 v[64:79], v[156:159], v[124:127], v[64:79]
  s_nop 11
  v_max3_f32 v180, v64, v65, v66
  v_max3_f32 v180, v180, v67, v68
  v_max3_f32 v180, v180, v69, v70
  v_max3_f32 v180, v180, v71, v72
  v_max3_f32 v180, v180, v73, v74
  v_max3_f32 v180, v180, v75, v76
  v_max3_f32 v180, v180, v77, v78
  v_max_f32 v180, v180, v79
  v_mov_b32 v181, v180
  s_nop 1
  v_permlane32_swap_b32 v180, v181
  v_max_f32 v180, v180, v181
  v_sub_f32 v64, v64, v180
  v_sub_f32 v65, v65, v180
  v_sub_f32 v66, v66, v180
  v_sub_f32 v67, v67, v180
  v_sub_f32 v68, v68, v180
  v_sub_f32 v69, v69, v180
  v_sub_f32 v70, v70, v180
  v_sub_f32 v71, v71, v180
  v_sub_f32 v72, v72, v180
  v_sub_f32 v73, v73, v180
  v_sub_f32 v74, v74, v180
  v_sub_f32 v75, v75, v180
  v_sub_f32 v76, v76, v180
  v_sub_f32 v77, v77, v180
  v_sub_f32 v78, v78, v180
  v_sub_f32 v79, v79, v180
  v_exp_f32 v64, v64
  v_exp_f32 v65, v65
  v_exp_f32 v66, v66
  v_exp_f32 v67, v67
  v_exp_f32 v68, v68
  v_exp_f32 v69, v69
  v_exp_f32 v70, v70
  v_exp_f32 v71, v71
  v_exp_f32 v72, v72
  v_exp_f32 v73, v73
  v_exp_f32 v74, v74
  v_exp_f32 v75, v75
  v_exp_f32 v76, v76
  v_exp_f32 v77, v77
  v_exp_f32 v78, v78
  v_exp_f32 v79, v79
  v_cvt_pk_bf16_f32 v20, v64, v65
  v_cvt_pk_bf16_f32 v21, v68, v69
  v_cvt_pk_bf16_f32 v22, v72, v73
  v_cvt_pk_bf16_f32 v23, v76, v77
  v_cvt_pk_bf16_f32 v24, v66, v67
  v_cvt_pk_bf16_f32 v25, v70, v71
  v_cvt_pk_bf16_f32 v26, v74, v75
  v_cvt_pk_bf16_f32 v27, v78, v79
  s_waitcnt vmcnt(12)
  v_mfma_f32_32x32x16_bf16 v[0:15], v[160:163], v[20:23], 0
  v_add_f32 v182, v64, v65
  v_add_f32 v182, v182, v66
  v_add_f32 v182, v182, v67
  v_add_f32 v182, v182, v68
  v_add_f32 v182, v182, v69
  v_add_f32 v182, v182, v70
  v_add_f32 v182, v182, v71
  s_waitcnt vmcnt(11)
  v_mfma_f32_32x32x16_bf16 v[0:15], v[164:167], v[24:27], v[0:15]
  v_add_f32 v182, v182, v72
  v_add_f32 v182, v182, v73
  v_add_f32 v182, v182, v74
  v_add_f32 v182, v182, v75
  v_add_f32 v182, v182, v76
  v_add_f32 v182, v182, v77
  v_add_f32 v182, v182, v78
  v_add_f32 v182, v182, v79
  s_waitcnt vmcnt(0)
  s_barrier
AT_loop:
  s_cmp_ge_u32 s59, 64
  s_cbranch_scc1 AT_l0
  s_mov_b32 s77, s59
  s_mul_i32 s66, s59, 655360
  s_lshl_b32 s55, s58, 14
  s_add_u32 s55, s55, s66
  s_add_u32 s55, s55, 1048576
  s_lshl_b32 s76, s58, 2
  s_add_u32 s76, s76, s52
  s_lshl_b32 s75, s59, 7
  s_add_u32 s75, s75, s76
  s_lshl_b32 s75, s75, 11
  s_add_u32 s75, s75, 46137344
  s_lshl_b32 s76, s76, 10
  s_add_u32 s76, s76, s66
  s_add_u32 s76, s76, 1572864
  s_add_u32 s59, s59, 2
  buffer_load_dwordx4 v[128:131], v216, s[8:11], s55 offen offset:0 sc1
  buffer_load_dwordx4 v[132:135], v216, s[8:11], s55 offen offset:256 sc1
  buffer_load_dwordx4 v[136:139], v216, s[8:11], s55 offen offset:512 sc1
  buffer_load_dwordx4 v[140:143], v216, s[8:11], s55 offen offset:768 sc1
  buffer_load_dwordx4 v[144:147], v216, s[8:11], s55 offen offset:1024 sc1
  buffer_load_dwordx4 v[148:151], v216, s[8:11], s55 offen offset:1280 sc1
  buffer_load_dwordx4 v[152:155], v216, s[8:11], s55 offen offset:1536 sc1
  buffer_load_dwordx4 v[156:159], v216, s[8:11], s55 offen offset:1792 sc1
  buffer_load_dwordx4 v[160:163], v217, s[8:11], s55 offen offset:0 sc1
  buffer_load_dwordx4 v[164:167], v217, s[8:11], s55 offen offset:256 sc1
  s_or_b32 s70, s73, 0xc00
  buffer_load_dword v172, off, s[8:11], s70 sc1
  s_add_u32 s60, s60, 73728
  ds_read_b128 v[32:35], v203 offset:36864
  ds_read_b128 v[36:39], v204 offset:36864
  ds_read_b128 v[40:43], v205 offset:36864
  s_waitcnt lgkmcnt(2)
  v_mfma_f32_32x32x16_bf16 v[240:255], a[0:3], v[32:35], 0
  ds_read_b128 v[44:47], v206 offset:36864
  s_add_u32 m0, s67, 0
  s_nop 0
  buffer_load_dwordx4 v202, s[4:7], s60 offen offset:0 lds
  s_waitcnt lgkmcnt(2)
  v_mfma_f32_32x32x16_bf16 v[240:255], a[4:7], v[36:39], v[240:255]
  ds_read_b128 v[32:35], v203 offset:37888
  s_waitcnt lgkmcnt(2)
  v_mfma_f32_32x32x16_bf16 v[240:255], a[8:11], v[40:43], v[240:255]
  ds_read_b128 v[36:39], v204 offset:37888
  s_add_u32 m0, s67, 896
  s_nop 0
  buffer_load_dwordx4 v202, s[4:7], s60 offen offset:128 lds
  s_waitcnt lgkmcnt(2)
  v_mfma_f32_32x32x16_bf16 v[240:255], a[12:15], v[44:47], v[240:255]
  ds_read_b128 v[40:43], v205 offset:37888
  s_waitcnt lgkmcnt(2)
  v_mfma_f32_32x32x16_bf16 v[240:255], a[16:19], v[32:35], v[240:255]
  ds_read_b128 v[44:47], v206 offset:37888
  s_add_u32 m0, s67, 1792
  s_nop 0
  buffer_load_dwordx4 v202, s[4:7], s60 offen offset:256 lds
  s_waitcnt lgkmcnt(2)
  v_mfma_f32_32x32x16_bf16 v[240:255], a[20:23], v[36:39], v[240:255]
  ds_read_b128 v[32:35], v203 offset:38912
  s_waitcnt lgkmcnt(2)
  v_mfma_f32_32x32x16_bf16 v[240:255], a[24:27], v[40:43], v[240:255]
  ds_read_b128 v[36:39], v204 offset:38912
  s_add_u32 m0, s67, 2688
  s_nop 0
  buffer_load_dwordx4 v202, s[4:7], s60 offen offset:384 lds
  s_waitcnt lgkmcnt(2)
  v_mfma_f32_32x32x16_bf16 v[240:255], a[28:31], v[44:47], v[240:255]
  ds_read_b128 v[40:43], v205 offset:38912
  s_waitcnt lgkmcnt(2)
  v_mfma_f32_32x32x16_bf16 v[240:255], a[32:35], v[32:35], v[240:255]
  ds_read_b128 v[44:47], v206 offset:38912
  s_add_u32 m0, s67, 3584
  s_nop 0
  buffer_load_dwordx4 v202, s[4:7], s60 offen offset:512 lds
  s_waitcnt lgkmcnt(2)
  v_mfma_f32_32x32x16_bf16 v[240:255], a[36:39], v[36:39], v[240:255]
  ds_read_b128 v[32:35], v203 offset:39936
  s_waitcnt lgkmcnt(2)
  v_mfma_f32_32x32x16_bf16 v[240:255], a[40:43], v[40:43], v[240:255]
  ds_read_b128 v[36:39], v204 offset:39936
  s_add_u32 m0, s67, 4480
  s_nop 0
  buffer_load_dwordx4 v202, s[4:7], s60 offen offset:640 lds
  s_waitcnt lgkmcnt(2)
  v_mfma_f32_32x32x16_bf16 v[240:255], a[44:47], v[44:47], v[240:255]
  ds_read_b128 v[40:43], v205 offset:39936
  s_waitcnt lgkmcnt(2)
  v_mfma_f32_32x32x16_bf16 v[240:255], a[48:51], v[32:35], v[240:255]
  ds_read_b128 v[44:47], v206 offset:39936
  s_add_u32 m0, s67, 5376
  s_nop 0
  buffer_load_dwordx4 v202, s[4:7], s60 offen offset:768 lds
  s_waitcnt lgkmcnt(2)
  v_mfma_f32_32x32x16_bf16 v[240:255], a[52:55], v[36:39], v[240:255]
  ds_read_b128 v[32:35], v203 offset:40960
  s_waitcnt lgkmcnt(2)
  v_mfma_f32_32x32x16_bf16 v[240:255], a[56:59], v[40:43], v[240:255]
  ds_read_b128 v[36:39], v204 offset:40960
  s_add_u32 m0, s67, 6272
  s_nop 0
  buffer_load_dwordx4 v202, s[4:7], s60 offen offset:896 lds
  s_waitcnt lgkmcnt(2)
  v_mfma_f32_32x32x16_bf16 v[240:255], a[60:63], v[44:47], v[240:255]
  ds_read_b128 v[40:43], v205 offset:40960
  s_waitcnt lgkmcnt(2)
  v_mfma_f32_32x32x16_bf16 v[240:255], a[64:67], v[32:35], v[240:255]
  ds_read_b128 v[44:47], v206 offset:40960
  s_add_u32 m0, s67, 7168
  s_nop 0
  buffer_load_dwordx4 v202, s[4:7], s60 offen offset:1024 lds
  s_waitcnt lgkmcnt(2)
  v_mfma_f32_32x32x16_bf16 v[240:255], a[68:71], v[36:39], v[240:255]
  ds_read_b128 v[32:35], v203 offset:41984
  s_waitcnt lgkmcnt(2)
  v_mfma_f32_32x32x16_bf16 v[240:255], a[72:75], v[40:43], v[240:255]
  ds_read_b128 v[36:39], v204 offset:41984
  buffer_store_dwordx4 v[176:179], v201, s[8:11], s75 offen offset:0 sc1
  s_waitcnt lgkmcnt(2)
  v_mfma_f32_32x32x16_bf16 v[240:255], a[76:79], v[44:47], v[240:255]
  ds_read_b128 v[40:43], v205 offset:41984
  s_waitcnt lgkmcnt(2)
  v_mfma_f32_32x32x16_bf16 v[240:255], a[80:83], v[32:35], v[240:255]
  ds_read_b128 v[44:47], v206 offset:41984
  buffer_store_dwordx4 v[176:179], v201, s[8:11], s75 offen offset:1024 sc1
  s_waitcnt lgkmcnt(2)
  v_mfma_f32_32x32x16_bf16 v[240:255], a[84:87], v[36:39], v[240:255]
  ds_read_b128 v[32:35], v203 offset:43008
  s_waitcnt lgkmcnt(2)
  v_mfma_f32_32x32x16_bf16 v[240:255], a[88:91], v[40:43], v[240:255]
  ds_read_b128 v[36:39], v204 offset:43008
  s_waitcnt lgkmcnt(2)
  v_mfma_f32_32x32x16_bf16 v[240:255], a[92:95], v[44:47], v[240:255]
  ds_read_b128 v[40:43], v205 offset:43008
  s_waitcnt lgkmcnt(2)
  v_mfma_f32_32x32x16_bf16 v[240:255], a[96:99], v[32:35], v[240:255]
  ds_read_b128 v[44:47], v206 offset:43008
  s_waitcnt lgkmcnt(2)
  v_mfma_f32_32x32x16_bf16 v[240:255], a[100:103], v[36:39], v[240:255]
  ds_read_b128 v[32:35], v203 offset:44032
  s_waitcnt lgkmcnt(2)
  v_mfma_f32_32x32x16_bf16 v[240:255], a[104:107], v[40:43], v[240:255]
  ds_read_b128 v[36:39], v204 offset:44032
  s_waitcnt lgkmcnt(2)
  v_mfma_f32_32x32x16_bf16 v[240:255], a[108:111], v[44:47], v[240:255]
  ds_read_b128 v[40:43], v205 offset:44032
  s_waitcnt lgkmcnt(2)
  v_mfma_f32_32x32x16_bf16 v[240:255], a[112:115], v[32:35], v[240:255]
  ds_read_b128 v[44:47], v206 offset:44032
  s_waitcnt lgkmcnt(2)
  v_mfma_f32_32x32x16_bf16 v[240:255], a[116:119], v[36:39], v[240:255]
  ds_read_b128 v[32:35], v203 offset:45056
  s_waitcnt lgkmcnt(2)
  v_mfma_f32_32x32x16_bf16 v[240:255], a[120:123], v[40:43], v[240:255]
  ds_read_b128 v[36:39], v204 offset:45056
  s_waitcnt lgkmcnt(2)
  v_mfma_f32_32x32x16_bf16 v[240:255], a[124:127], v[44:47], v[240:255]
  ds_read_b128 v[40:43], v205 offset:45056
  s_waitcnt lgkmcnt(2)
  v_mfma_f32_32x32x16_bf16 v[240:255], a[128:131], v[32:35], v[240:255]
  ds_read_b128 v[44:47], v206 offset:45056
  s_waitcnt lgkmcnt(2)
  v_mfma_f32_32x32x16_bf16 v[240:255], a[132:135], v[36:39], v[240:255]
  s_waitcnt lgkmcnt(1)
  v_mfma_f32_32x32x16_bf16 v[240:255], a[136:139], v[40:43], v[240:255]
  s_waitcnt lgkmcnt(0)
  v_mfma_f32_32x32x16_bf16 v[240:255], a[140:143], v[44:47], v[240:255]
  s_nop 11
  v_cvt_pk_bf16_f32 v16, v240, v244
  v_cvt_pk_bf16_f32 v17, v241, v245
  v_cvt_pk_bf16_f32 v18, v242, v246
  v_cvt_pk_bf16_f32 v19, v243, v247
  ds_write_b128 v215, v[16:19] offset:0
  v_cvt_pk_bf16_f32 v20, v248, v252
  v_cvt_pk_bf16_f32 v21, v249, v253
  v_cvt_pk_bf16_f32 v22, v250, v254
  v_cvt_pk_bf16_f32 v23, v251, v255
  ds_write_b128 v215, v[20:23] offset:1024
  s_waitcnt lgkmcnt(0)
  s_barrier
  ds_read_b128 a[144:147], v208 offset:0
  ds_read_b128 a[148:151], v208 offset:1024
  ds_read_b128 a[152:155], v208 offset:2048
  ds_read_b128 a[156:159], v208 offset:3072
  ds_read_b128 a[160:163], v208 offset:4096
  ds_read_b128 a[164:167], v208 offset:5120
  ds_read_b128 a[168:171], v208 offset:6144
  ds_read_b128 a[172:175], v208 offset:7168
  s_waitcnt vmcnt(11)
  v_cmp_eq_u32 vcc, -1, v172
  s_mov_b32 s69, 0
  s_cbranch_vccnz AT_e1
  s_mov_b32 s69, 1
  buffer_load_dwordx4 v[172:175], v201, s[8:11], s73 offen sc1
AT_e1:
  s_waitcnt lgkmcnt(7)
  v_mfma_f32_32x32x16_bf16 v[64:79], v[128:131], a[144:147], v[48:63]
  s_waitcnt lgkmcnt(6)
  v_mfma_f32_32x32x16_bf16 v[64:79], v[132:135], a[148:151], v[64:79]
  s_waitcnt lgkmcnt(5)
  v_mfma_f32_32x32x16_bf16 v[64:79], v[136:139], a[152:155], v[64:79]
  s_waitcnt lgkmcnt(4)
  v_mfma_f32_32x32x16_bf16 v[64:79], v[140:143], a[156:159], v[64:79]
  s_waitcnt lgkmcnt(3)
  v_mfma_f32_32x32x16_bf16 v[64:79], v[144:147], a[160:163], v[64:79]
  s_waitcnt lgkmcnt(2)
  v_mfma_f32_32x32x16_bf16 v[64:79], v[148:151], a[164:167], v[64:79]
  s_waitcnt lgkmcnt(1)
  v_mfma_f32_32x32x16_bf16 v[64:79], v[152:155], a[168:171], v[64:79]
  s_waitcnt lgkmcnt(0)
  v_mfma_f32_32x32x16_bf16 v[64:79], v[156:159], a[172:175], v[64:79]
  s_nop 11
  v_max3_f32 v184, v64, v65, v66
  v_max3_f32 v184, v184, v67, v68
  v_max3_f32 v184, v184, v69, v70
  v_max3_f32 v184, v184, v71, v72
  v_max3_f32 v184, v184, v73, v74
  v_max3_f32 v184, v184, v75, v76
  v_max3_f32 v184, v184, v77, v78
  v_max_f32 v184, v184, v79
  v_mov_b32 v185, v184
  s_nop 1
  v_permlane32_swap_b32 v184, v185
  v_max_f32 v184, v184, v185
  v_sub_f32 v64, v64, v184
  v_sub_f32 v65, v65, v184
  v_sub_f32 v66, v66, v184
  v_sub_f32 v67, v67, v184
  v_sub_f32 v68, v68, v184
  v_sub_f32 v69, v69, v184
  v_sub_f32 v70, v70, v184
  v_sub_f32 v71, v71, v184
  v_sub_f32 v72, v72, v184
  v_sub_f32 v73, v73, v184
  v_sub_f32 v74, v74, v184
  v_sub_f32 v75, v75, v184
  v_sub_f32 v76, v76, v184
  v_sub_f32 v77, v77, v184
  v_sub_f32 v78, v78, v184
  v_sub_f32 v79, v79, v184
  v_exp_f32 v64, v64
  v_exp_f32 v65, v65
  v_exp_f32 v66, v66
  v_exp_f32 v67, v67
  v_exp_f32 v68, v68
  v_exp_f32 v69, v69
  v_exp_f32 v70, v70
  v_exp_f32 v71, v71
  v_exp_f32 v72, v72
  v_exp_f32 v73, v73
  v_exp_f32 v74, v74
  v_exp_f32 v75, v75
  v_exp_f32 v76, v76
  v_exp_f32 v77, v77
  v_exp_f32 v78, v78
  v_exp_f32 v79, v79
  v_cvt_pk_bf16_f32 v20, v64, v65
  v_cvt_pk_bf16_f32 v21, v68, v69
  v_cvt_pk_bf16_f32 v22, v72, v73
  v_cvt_pk_bf16_f32 v23, v76, v77
  v_cvt_pk_bf16_f32 v24, v66, v67
  v_cvt_pk_bf16_f32 v25, v70, v71
  v_cvt_pk_bf16_f32 v26, v74, v75
  v_cvt_pk_bf16_f32 v27, v78, v79
  v_mfma_f32_32x32x16_bf16 v[224:239], v[160:163], v[20:23], 0
  v_add_f32 v186, v64, v65
  v_add_f32 v186, v186, v66
  v_add_f32 v186, v186, v67
  v_add_f32 v186, v186, v68
  v_add_f32 v186, v186, v69
  v_add_f32 v186, v186, v70
  v_add_f32 v186, v186, v71
  v_mfma_f32_32x32x16_bf16 v[224:239], v[164:167], v[24:27], v[224:239]
  v_add_f32 v186, v186, v72
  v_add_f32 v186, v186, v73
  v_add_f32 v186, v186, v74
  v_add_f32 v186, v186, v75
  v_add_f32 v186, v186, v76
  v_add_f32 v186, v186, v77
  v_add_f32 v186, v186, v78
  v_add_f32 v186, v186, v79
AT_l0:
  s_cmp_eq_u32 s69, 1
  s_cbranch_scc1 AT_v0
  s_or_b32 s70, s73, 0xc00
  s_cmp_eq_u32 s74, 63
  s_cselect_b32 s54, 655360, 0
  s_sub_u32 s70, s70, s54
  s_branch AT_c0
AT_h0:
  s_sleep 1
AT_c0:
  buffer_load_dword v172, off, s[8:11], s70 sc1
  s_add_u32 s65, s65, 1
  s_cmp_lt_u32 s65, 131072
  s_cselect_b32 s54, -2, -1
  s_waitcnt vmcnt(0)
  v_cmp_lt_u32 vcc, s54, v172
  s_cbranch_vccnz AT_h0
AT_k0:
  buffer_load_dwordx4 v[172:175], v201, s[8:11], s73 offen sc1
AT_v0:
  s_mov_b32 s69, 0
  s_add_u32 s65, s65, 1
  s_cmp_lt_u32 s65, 131072
  s_cselect_b32 s54, -2, -1
  s_waitcnt vmcnt(0)
  ds_write_b64 v220, v[172:173] offset:0
  ds_write_b64 v221, v[174:175] offset:0
  v_max3_u32 v213, v172, v173, v174
  v_max_u32 v213, v213, v175
  v_cmp_lt_u32 vcc, s54, v213
  s_cbranch_vccnz AT_k0
  s_waitcnt lgkmcnt(0)
  s_barrier
  ds_read_b128 v[128:131], v218 offset:0
  ds_read_b128 v[132:135], v218 offset:256
  ds_read_b128 v[136:139], v218 offset:512
  ds_read_b128 v[140:143], v218 offset:768
  ds_read_b128 v[144:147], v218 offset:1024
  ds_read_b128 v[148:151], v218 offset:1280
  ds_read_b128 v[152:155], v218 offset:1536
  ds_read_b128 v[156:159], v218 offset:1792
  ds_read_b32 v168, v219 offset:0
  ds_read_b32 v169, v219 offset:128
  s_add_u32 s74, s74, 2
  v_mov_b32 v212, s74
  s_waitcnt lgkmcnt(9)
  v_mfma_f32_32x32x16_bf16 v[80:95], v[128:131], v[96:99], 0
  s_waitcnt lgkmcnt(8)
  v_mfma_f32_32x32x16_bf16 v[80:95], v[132:135], v[100:103], v[80:95]
  s_waitcnt lgkmcnt(7)
  v_mfma_f32_32x32x16_bf16 v[80:95], v[136:139], v[104:107], v[80:95]
  s_waitcnt lgkmcnt(6)
  v_mfma_f32_32x32x16_bf16 v[80:95], v[140:143], v[108:111], v[80:95]
  s_mov_b64 exec, 1
  buffer_store_dword v212, v201, s[8:11], s71 offen sc1
  s_mov_b64 exec, -1
  s_waitcnt lgkmcnt(5)
  v_mfma_f32_32x32x16_bf16 v[80:95], v[144:147], v[112:115], v[80:95]
  s_waitcnt lgkmcnt(4)
  v_mfma_f32_32x32x16_bf16 v[80:95], v[148:151], v[116:119], v[80:95]
  s_waitcnt lgkmcnt(3)
  v_mfma_f32_32x32x16_bf16 v[80:95], v[152:155], v[120:123], v[80:95]
  s_waitcnt lgkmcnt(2)
  v_mfma_f32_32x32x16_bf16 v[80:95], v[156:159], v[124:127], v[80:95]
  s_nop 11
  v_mul_f32 v80, s68, v80
  v_mul_f32 v81, s68, v81
  v_mul_f32 v82, s68, v82
  v_mul_f32 v83, s68, v83
  v_max3_f32 v84, v180, v80, v81
  v_max3_f32 v84, v84, v82, v83
  v_mov_b32 v85, v84
  s_nop 1
  v_permlane32_swap_b32 v84, v85
  v_max_f32 v84, v84, v85
  v_sub_f32 v86, v180, v84
  v_sub_f32 v80, v80, v84
  v_sub_f32 v81, v81, v84
  v_sub_f32 v82, v82, v84
  v_sub_f32 v83, v83, v84
  v_exp_f32 v86, v86
  v_exp_f32 v80, v80
  v_exp_f32 v81, v81
  v_exp_f32 v82, v82
  v_exp_f32 v83, v83
  v_fma_f32 v182, v182, v86, v80
  v_add_f32 v84, v81, v82
  v_add_f32 v182, v182, v83
  v_add_f32 v182, v182, v84
  v_mov_b32 v183, v182
  s_nop 1
  v_permlane32_swap_b32 v182, v183
  v_add_f32 v182, v182, v183
  v_rcp_f32 v182, v182
  s_nop 0
  v_mul_f32 v86, v86, v182
  v_mul_f32 v80, v182, v80
  v_mul_f32 v81, v182, v81
  v_mul_f32 v82, v182, v82
  v_mul_f32 v83, v182, v83
  v_cvt_pk_bf16_f32 v28, v80, v81
  v_cvt_pk_bf16_f32 v29, v82, v83
  v_mul_f32 v0, v86, v0
  v_mul_f32 v1, v86, v1
  v_mul_f32 v2, v86, v2
  v_mul_f32 v3, v86, v3
  v_mul_f32 v4, v86, v4
  v_mul_f32 v5, v86, v5
  v_mul_f32 v6, v86, v6
  v_mul_f32 v7, v86, v7
  v_mul_f32 v8, v86, v8
  v_mul_f32 v9, v86, v9
  v_mul_f32 v10, v86, v10
  v_mul_f32 v11, v86, v11
  v_mul_f32 v12, v86, v12
  v_mul_f32 v13, v86, v13
  v_mul_f32 v14, v86, v14
  v_mul_f32 v15, v86, v15
  s_waitcnt lgkmcnt(0)
  s_nop 0
  v_mfma_f32_32x32x8_bf16 v[0:15], v[168:169], v[28:29], v[0:15]
  s_nop 11
  v_cvt_pk_bf16_f32 v20, v0, v1
  v_cvt_pk_bf16_f32 v21, v2, v3
  v_cvt_pk_bf16_f32 v22, v4, v5
  v_cvt_pk_bf16_f32 v23, v6, v7
  buffer_store_dwordx4 v[20:23], v201, s[8:11], s72 offen offset:0 sc1
  v_cvt_pk_bf16_f32 v24, v8, v9
  v_cvt_pk_bf16_f32 v25, v10, v11
  v_cvt_pk_bf16_f32 v26, v12, v13
  v_cvt_pk_bf16_f32 v27, v14, v15
  buffer_store_dwordx4 v[24:27], v201, s[8:11], s72 offen offset:1024 sc1
  s_cmp_ge_u32 s74, 64
  s_cbranch_scc1 L_exit
  s_cmp_ge_u32 s59, 64
  s_cbranch_scc1 AT_l1
  s_mov_b32 s74, s59
  s_mul_i32 s66, s59, 655360
  s_lshl_b32 s55, s58, 14
  s_add_u32 s55, s55, s66
  s_add_u32 s55, s55, 1048576
  s_lshl_b32 s73, s58, 2
  s_add_u32 s73, s73, s52
  s_lshl_b32 s72, s59, 7
  s_add_u32 s72, s72, s73
  s_lshl_b32 s72, s72, 11
  s_add_u32 s72, s72, 46137344
  s_lshl_b32 s73, s73, 10
  s_add_u32 s73, s73, s66
  s_add_u32 s73, s73, 1572864
  s_add_u32 s59, s59, 2
  buffer_load_dwordx4 v[128:131], v216, s[8:11], s55 offen offset:0 sc1
  buffer_load_dwordx4 v[132:135], v216, s[8:11], s55 offen offset:256 sc1
  buffer_load_dwordx4 v[136:139], v216, s[8:11], s55 offen offset:512 sc1
  buffer_load_dwordx4 v[140:143], v216, s[8:11], s55 offen offset:768 sc1
  buffer_load_dwordx4 v[144:147], v216, s[8:11], s55 offen offset:1024 sc1
  buffer_load_dwordx4 v[148:151], v216, s[8:11], s55 offen offset:1280 sc1
  buffer_load_dwordx4 v[152:155], v216, s[8:11], s55 offen offset:1536 sc1
  buffer_load_dwordx4 v[156:159], v216, s[8:11], s55 offen offset:1792 sc1
  buffer_load_dwordx4 v[160:163], v217, s[8:11], s55 offen offset:0 sc1
  buffer_load_dwordx4 v[164:167], v217, s[8:11], s55 offen offset:256 sc1
  s_or_b32 s70, s76, 0xc00
  buffer_load_dword v172, off, s[8:11], s70 sc1
  s_add_u32 s60, s60, 73728
  ds_read_b128 v[32:35], v203 offset:0
  ds_read_b128 v[36:39], v204 offset:0
  ds_read_b128 v[40:43], v205 offset:0
  s_waitcnt lgkmcnt(2)
  v_mfma_f32_32x32x16_bf16 v[240:255], a[0:3], v[32:35], 0
  ds_read_b128 v[44:47], v206 offset:0
  s_add_u32 m0, s67, 36864
  s_nop 0
  buffer_load_dwordx4 v202, s[4:7], s60 offen offset:0 lds
  s_waitcnt lgkmcnt(2)
  v_mfma_f32_32x32x16_bf16 v[240:255], a[4:7], v[36:39], v[240:255]
  ds_read_b128 v[32:35], v203 offset:1024
  s_waitcnt lgkmcnt(2)
  v_mfma_f32_32x32x16_bf16 v[240:255], a[8:11], v[40:43], v[240:255]
  ds_read_b128 v[36:39], v204 offset:1024
  s_add_u32 m0, s67, 37760
  s_nop 0
  buffer_load_dwordx4 v202, s[4:7], s60 offen offset:128 lds
  s_waitcnt lgkmcnt(2)
  v_mfma_f32_32x32x16_bf16 v[240:255], a[12:15], v[44:47], v[240:255]
  ds_read_b128 v[40:43], v205 offset:1024
  s_waitcnt lgkmcnt(2)
  v_mfma_f32_32x32x16_bf16 v[240:255], a[16:19], v[32:35], v[240:255]
  ds_read_b128 v[44:47], v206 offset:1024
  s_add_u32 m0, s67, 38656
  s_nop 0
  buffer_load_dwordx4 v202, s[4:7], s60 offen offset:256 lds
  s_waitcnt lgkmcnt(2)
  v_mfma_f32_32x32x16_bf16 v[240:255], a[20:23], v[36:39], v[240:255]
  ds_read_b128 v[32:35], v203 offset:2048
  s_waitcnt lgkmcnt(2)
  v_mfma_f32_32x32x16_bf16 v[240:255], a[24:27], v[40:43], v[240:255]
  ds_read_b128 v[36:39], v204 offset:2048
  s_add_u32 m0, s67, 39552
  s_nop 0
  buffer_load_dwordx4 v202, s[4:7], s60 offen offset:384 lds
  s_waitcnt lgkmcnt(2)
  v_mfma_f32_32x32x16_bf16 v[240:255], a[28:31], v[44:47], v[240:255]
  ds_read_b128 v[40:43], v205 offset:2048
  s_waitcnt lgkmcnt(2)
  v_mfma_f32_32x32x16_bf16 v[240:255], a[32:35], v[32:35], v[240:255]
  ds_read_b128 v[44:47], v206 offset:2048
  s_add_u32 m0, s67, 40448
  s_nop 0
  buffer_load_dwordx4 v202, s[4:7], s60 offen offset:512 lds
  s_waitcnt lgkmcnt(2)
  v_mfma_f32_32x32x16_bf16 v[240:255], a[36:39], v[36:39], v[240:255]
  ds_read_b128 v[32:35], v203 offset:3072
  s_waitcnt lgkmcnt(2)
  v_mfma_f32_32x32x16_bf16 v[240:255], a[40:43], v[40:43], v[240:255]
  ds_read_b128 v[36:39], v204 offset:3072
  s_add_u32 m0, s67, 41344
  s_nop 0
  buffer_load_dwordx4 v202, s[4:7], s60 offen offset:640 lds
  s_waitcnt lgkmcnt(2)
  v_mfma_f32_32x32x16_bf16 v[240:255], a[44:47], v[44:47], v[240:255]
  ds_read_b128 v[40:43], v205 offset:3072
  s_waitcnt lgkmcnt(2)
  v_mfma_f32_32x32x16_bf16 v[240:255], a[48:51], v[32:35], v[240:255]
  ds_read_b128 v[44:47], v206 offset:3072
  s_add_u32 m0, s67, 42240
  s_nop 0
  buffer_load_dwordx4 v202, s[4:7], s60 offen offset:768 lds
  s_waitcnt lgkmcnt(2)
  v_mfma_f32_32x32x16_bf16 v[240:255], a[52:55], v[36:39], v[240:255]
  ds_read_b128 v[32:35], v203 offset:4096
  s_waitcnt lgkmcnt(2)
  v_mfma_f32_32x32x16_bf16 v[240:255], a[56:59], v[40:43], v[240:255]
  ds_read_b128 v[36:39], v204 offset:4096
  s_add_u32 m0, s67, 43136
  s_nop 0
  buffer_load_dwordx4 v202, s[4:7], s60 offen offset:896 lds
  s_waitcnt lgkmcnt(2)
  v_mfma_f32_32x32x16_bf16 v[240:255], a[60:63], v[44:47], v[240:255]
  ds_read_b128 v[40:43], v205 offset:4096
  s_waitcnt lgkmcnt(2)
  v_mfma_f32_32x32x16_bf16 v[240:255], a[64:67], v[32:35], v[240:255]
  ds_read_b128 v[44:47], v206 offset:4096
  s_add_u32 m0, s67, 44032
  s_nop 0
  buffer_load_dwordx4 v202, s[4:7], s60 offen offset:1024 lds
  s_waitcnt lgkmcnt(2)
  v_mfma_f32_32x32x16_bf16 v[240:255], a[68:71], v[36:39], v[240:255]
  ds_read_b128 v[32:35], v203 offset:5120
  s_waitcnt lgkmcnt(2)
  v_mfma_f32_32x32x16_bf16 v[240:255], a[72:75], v[40:43], v[240:255]
  ds_read_b128 v[36:39], v204 offset:5120
  buffer_store_dwordx4 v[176:179], v201, s[8:11], s72 offen offset:0 sc1
  s_waitcnt lgkmcnt(2)
  v_mfma_f32_32x32x16_bf16 v[240:255], a[76:79], v[44:47], v[240:255]
  ds_read_b128 v[40:43], v205 offset:5120
  s_waitcnt lgkmcnt(2)
  v_mfma_f32_32x32x16_bf16 v[240:255], a[80:83], v[32:35], v[240:255]
  ds_read_b128 v[44:47], v206 offset:5120
  buffer_store_dwordx4 v[176:179], v201, s[8:11], s72 offen offset:1024 sc1
  s_waitcnt lgkmcnt(2)
  v_mfma_f32_32x32x16_bf16 v[240:255], a[84:87], v[36:39], v[240:255]
  ds_read_b128 v[32:35], v203 offset:6144
  s_waitcnt lgkmcnt(2)
  v_mfma_f32_32x32x16_bf16 v[240:255], a[88:91], v[40:43], v[240:255]
  ds_read_b128 v[36:39], v204 offset:6144
  s_waitcnt lgkmcnt(2)
  v_mfma_f32_32x32x16_bf16 v[240:255], a[92:95], v[44:47], v[240:255]
  ds_read_b128 v[40:43], v205 offset:6144
  s_waitcnt lgkmcnt(2)
  v_mfma_f32_32x32x16_bf16 v[240:255], a[96:99], v[32:35], v[240:255]
  ds_read_b128 v[44:47], v206 offset:6144
  s_waitcnt lgkmcnt(2)
  v_mfma_f32_32x32x16_bf16 v[240:255], a[100:103], v[36:39], v[240:255]
  ds_read_b128 v[32:35], v203 offset:7168
  s_waitcnt lgkmcnt(2)
  v_mfma_f32_32x32x16_bf16 v[240:255], a[104:107], v[40:43], v[240:255]
  ds_read_b128 v[36:39], v204 offset:7168
  s_waitcnt lgkmcnt(2)
  v_mfma_f32_32x32x16_bf16 v[240:255], a[108:111], v[44:47], v[240:255]
  ds_read_b128 v[40:43], v205 offset:7168
  s_waitcnt lgkmcnt(2)
  v_mfma_f32_32x32x16_bf16 v[240:255], a[112:115], v[32:35], v[240:255]
  ds_read_b128 v[44:47], v206 offset:7168
  s_waitcnt lgkmcnt(2)
  v_mfma_f32_32x32x16_bf16 v[240:255], a[116:119], v[36:39], v[240:255]
  ds_read_b128 v[32:35], v203 offset:8192
  s_waitcnt lgkmcnt(2)
  v_mfma_f32_32x32x16_bf16 v[240:255], a[120:123], v[40:43], v[240:255]
  ds_read_b128 v[36:39], v204 offset:8192
  s_waitcnt lgkmcnt(2)
  v_mfma_f32_32x32x16_bf16 v[240:255], a[124:127], v[44:47], v[240:255]
  ds_read_b128 v[40:43], v205 offset:8192
  s_waitcnt lgkmcnt(2)
  v_mfma_f32_32x32x16_bf16 v[240:255], a[128:131], v[32:35], v[240:255]
  ds_read_b128 v[44:47], v206 offset:8192
  s_waitcnt lgkmcnt(2)
  v_mfma_f32_32x32x16_bf16 v[240:255], a[132:135], v[36:39], v[240:255]
  s_waitcnt lgkmcnt(1)
  v_mfma_f32_32x32x16_bf16 v[240:255], a[136:139], v[40:43], v[240:255]
  s_waitcnt lgkmcnt(0)
  v_mfma_f32_32x32x16_bf16 v[240:255], a[140:143], v[44:47], v[240:255]
  s_nop 11
  v_cvt_pk_bf16_f32 v16, v240, v244
  v_cvt_pk_bf16_f32 v17, v241, v245
  v_cvt_pk_bf16_f32 v18, v242, v246
  v_cvt_pk_bf16_f32 v19, v243, v247
  ds_write_b128 v215, v[16:19] offset:0
  v_cvt_pk_bf16_f32 v20, v248, v252
  v_cvt_pk_bf16_f32 v21, v249, v253
  v_cvt_pk_bf16_f32 v22, v250, v254
  v_cvt_pk_bf16_f32 v23, v251, v255
  ds_write_b128 v215, v[20:23] offset:1024
  s_waitcnt lgkmcnt(0)
  s_barrier
  ds_read_b128 v[96:99], v208 offset:0
  ds_read_b128 v[100:103], v208 offset:1024
  ds_read_b128 v[104:107], v208 offset:2048
  ds_read_b128 v[108:111], v208 offset:3072
  ds_read_b128 v[112:115], v208 offset:4096
  ds_read_b128 v[116:119], v208 offset:5120
  ds_read_b128 v[120:123], v208 offset:6144
  ds_read_b128 v[124:127], v208 offset:7168
  s_waitcnt vmcnt(11)
  v_cmp_eq_u32 vcc, -1, v172
  s_mov_b32 s69, 0
  s_cbranch_vccnz AT_e0
  s_mov_b32 s69, 1
  buffer_load_dwordx4 v[172:175], v201, s[8:11], s76 offen sc1
AT_e0:
  s_waitcnt lgkmcnt(7)
  v_mfma_f32_32x32x16_bf16 v[64:79], v[128:131], v[96:99], v[48:63]
  s_waitcnt lgkmcnt(6)
  v_mfma_f32_32x32x16_bf16 v[64:79], v[132:135], v[100:103], v[64:79]
  s_waitcnt lgkmcnt(5)
  v_mfma_f32_32x32x16_bf16 v[64:79], v[136:139], v[104:107], v[64:79]
  s_waitcnt lgkmcnt(4)
  v_mfma_f32_32x32x16_bf16 v[64:79], v[140:143], v[108:111], v[64:79]
  s_waitcnt lgkmcnt(3)
  v_mfma_f32_32x32x16_bf16 v[64:79], v[144:147], v[112:115], v[64:79]
  s_waitcnt lgkmcnt(2)
  v_mfma_f32_32x32x16_bf16 v[64:79], v[148:151], v[116:119], v[64:79]
  s_waitcnt lgkmcnt(1)
  v_mfma_f32_32x32x16_bf16 v[64:79], v[152:155], v[120:123], v[64:79]
  s_waitcnt lgkmcnt(0)
  v_mfma_f32_32x32x16_bf16 v[64:79], v[156:159], v[124:127], v[64:79]
  s_nop 11
  v_max3_f32 v180, v64, v65, v66
  v_max3_f32 v180, v180, v67, v68
  v_max3_f32 v180, v180, v69, v70
  v_max3_f32 v180, v180, v71, v72
  v_max3_f32 v180, v180, v73, v74
  v_max3_f32 v180, v180, v75, v76
  v_max3_f32 v180, v180, v77, v78
  v_max_f32 v180, v180, v79
  v_mov_b32 v181, v180
  s_nop 1
  v_permlane32_swap_b32 v180, v181
  v_max_f32 v180, v180, v181
  v_sub_f32 v64, v64, v180
  v_sub_f32 v65, v65, v180
  v_sub_f32 v66, v66, v180
  v_sub_f32 v67, v67, v180
  v_sub_f32 v68, v68, v180
  v_sub_f32 v69, v69, v180
  v_sub_f32 v70, v70, v180
  v_sub_f32 v71, v71, v180
  v_sub_f32 v72, v72, v180
  v_sub_f32 v73, v73, v180
  v_sub_f32 v74, v74, v180
  v_sub_f32 v75, v75, v180
  v_sub_f32 v76, v76, v180
  v_sub_f32 v77, v77, v180
  v_sub_f32 v78, v78, v180
  v_sub_f32 v79, v79, v180
  v_exp_f32 v64, v64
  v_exp_f32 v65, v65
  v_exp_f32 v66, v66
  v_exp_f32 v67, v67
  v_exp_f32 v68, v68
  v_exp_f32 v69, v69
  v_exp_f32 v70, v70
  v_exp_f32 v71, v71
  v_exp_f32 v72, v72
  v_exp_f32 v73, v73
  v_exp_f32 v74, v74
  v_exp_f32 v75, v75
  v_exp_f32 v76, v76
  v_exp_f32 v77, v77
  v_exp_f32 v78, v78
  v_exp_f32 v79, v79
  v_cvt_pk_bf16_f32 v20, v64, v65
  v_cvt_pk_bf16_f32 v21, v68, v69
  v_cvt_pk_bf16_f32 v22, v72, v73
  v_cvt_pk_bf16_f32 v23, v76, v77
  v_cvt_pk_bf16_f32 v24, v66, v67
  v_cvt_pk_bf16_f32 v25, v70, v71
  v_cvt_pk_bf16_f32 v26, v74, v75
  v_cvt_pk_bf16_f32 v27, v78, v79
  v_mfma_f32_32x32x16_bf16 v[0:15], v[160:163], v[20:23], 0
  v_add_f32 v182, v64, v65
  v_add_f32 v182, v182, v66
  v_add_f32 v182, v182, v67
  v_add_f32 v182, v182, v68
  v_add_f32 v182, v182, v69
  v_add_f32 v182, v182, v70
  v_add_f32 v182, v182, v71
  v_mfma_f32_32x32x16_bf16 v[0:15], v[164:167], v[24:27], v[0:15]
  v_add_f32 v182, v182, v72
  v_add_f32 v182, v182, v73
  v_add_f32 v182, v182, v74
  v_add_f32 v182, v182, v75
  v_add_f32 v182, v182, v76
  v_add_f32 v182, v182, v77
  v_add_f32 v182, v182, v78
  v_add_f32 v182, v182, v79
AT_l1:
  s_cmp_eq_u32 s69, 1
  s_cbranch_scc1 AT_v1
  s_or_b32 s70, s76, 0xc00
  s_cmp_eq_u32 s77, 63
  s_cselect_b32 s54, 655360, 0
  s_sub_u32 s70, s70, s54
  s_branch AT_c1
AT_h1:
  s_sleep 1
AT_c1:
  buffer_load_dword v172, off, s[8:11], s70 sc1
  s_add_u32 s65, s65, 1
  s_cmp_lt_u32 s65, 131072
  s_cselect_b32 s54, -2, -1
  s_waitcnt vmcnt(0)
  v_cmp_lt_u32 vcc, s54, v172
  s_cbranch_vccnz AT_h1
AT_k1:
  buffer_load_dwordx4 v[172:175], v201, s[8:11], s76 offen sc1
AT_v1:
  s_mov_b32 s69, 0
  s_add_u32 s65, s65, 1
  s_cmp_lt_u32 s65, 131072
  s_cselect_b32 s54, -2, -1
  s_waitcnt vmcnt(0)
  ds_write_b64 v220, v[172:173] offset:4096
  ds_write_b64 v221, v[174:175] offset:4096
  v_max3_u32 v213, v172, v173, v174
  v_max_u32 v213, v213, v175
  v_cmp_lt_u32 vcc, s54, v213
  s_cbranch_vccnz AT_k1
  s_waitcnt lgkmcnt(0)
  s_barrier
  ds_read_b128 v[128:131], v218 offset:4096
  ds_read_b128 v[132:135], v218 offset:4352
  ds_read_b128 v[136:139], v218 offset:4608
  ds_read_b128 v[140:143], v218 offset:4864
  ds_read_b128 v[144:147], v218 offset:5120
  ds_read_b128 v[148:151], v218 offset:5376
  ds_read_b128 v[152:155], v218 offset:5632
  ds_read_b128 v[156:159], v218 offset:5888
  ds_read_b32 v168, v219 offset:4096
  ds_read_b32 v169, v219 offset:4224
  s_add_u32 s77, s77, 2
  v_mov_b32 v212, s77
  s_waitcnt lgkmcnt(9)
  v_mfma_f32_32x32x16_bf16 v[80:95], v[128:131], a[144:147], 0
  s_waitcnt lgkmcnt(8)
  v_mfma_f32_32x32x16_bf16 v[80:95], v[132:135], a[148:151], v[80:95]
  s_waitcnt lgkmcnt(7)
  v_mfma_f32_32x32x16_bf16 v[80:95], v[136:139], a[152:155], v[80:95]
  s_waitcnt lgkmcnt(6)
  v_mfma_f32_32x32x16_bf16 v[80:95], v[140:143], a[156:159], v[80:95]
  s_mov_b64 exec, 1
  buffer_store_dword v212, v201, s[8:11], s71 offen sc1
  s_mov_b64 exec, -1
  s_waitcnt lgkmcnt(5)
  v_mfma_f32_32x32x16_bf16 v[80:95], v[144:147], a[160:163], v[80:95]
  s_waitcnt lgkmcnt(4)
  v_mfma_f32_32x32x16_bf16 v[80:95], v[148:151], a[164:167], v[80:95]
  s_waitcnt lgkmcnt(3)
  v_mfma_f32_32x32x16_bf16 v[80:95], v[152:155], a[168:171], v[80:95]
  s_waitcnt lgkmcnt(2)
  v_mfma_f32_32x32x16_bf16 v[80:95], v[156:159], a[172:175], v[80:95]
  s_nop 11
  v_mul_f32 v80, s68, v80
  v_mul_f32 v81, s68, v81
  v_mul_f32 v82, s68, v82
  v_mul_f32 v83, s68, v83
  v_max3_f32 v84, v184, v80, v81
  v_max3_f32 v84, v84, v82, v83
  v_mov_b32 v85, v84
  s_nop 1
  v_permlane32_swap_b32 v84, v85
  v_max_f32 v84, v84, v85
  v_sub_f32 v86, v184, v84
  v_sub_f32 v80, v80, v84
  v_sub_f32 v81, v81, v84
  v_sub_f32 v82, v82, v84
  v_sub_f32 v83, v83, v84
  v_exp_f32 v86, v86
  v_exp_f32 v80, v80
  v_exp_f32 v81, v81
  v_exp_f32 v82, v82
  v_exp_f32 v83, v83
  v_fma_f32 v186, v186, v86, v80
  v_add_f32 v84, v81, v82
  v_add_f32 v186, v186, v83
  v_add_f32 v186, v186, v84
  v_mov_b32 v187, v186
  s_nop 1
  v_permlane32_swap_b32 v186, v187
  v_add_f32 v186, v186, v187
  v_rcp_f32 v186, v186
  s_nop 0
  v_mul_f32 v86, v86, v186
  v_mul_f32 v80, v186, v80
  v_mul_f32 v81, v186, v81
  v_mul_f32 v82, v186, v82
  v_mul_f32 v83, v186, v83
  v_cvt_pk_bf16_f32 v28, v80, v81
  v_cvt_pk_bf16_f32 v29, v82, v83
  v_mul_f32 v224, v86, v224
  v_mul_f32 v225, v86, v225
  v_mul_f32 v226, v86, v226
  v_mul_f32 v227, v86, v227
  v_mul_f32 v228, v86, v228
  v_mul_f32 v229, v86, v229
  v_mul_f32 v230, v86, v230
  v_mul_f32 v231, v86, v231
  v_mul_f32 v232, v86, v232
  v_mul_f32 v233, v86, v233
  v_mul_f32 v234, v86, v234
  v_mul_f32 v235, v86, v235
  v_mul_f32 v236, v86, v236
  v_mul_f32 v237, v86, v237
  v_mul_f32 v238, v86, v238
  v_mul_f32 v239, v86, v239
  s_waitcnt lgkmcnt(0)
  s_nop 0
  v_mfma_f32_32x32x8_bf16 v[224:239], v[168:169], v[28:29], v[224:239]
  s_nop 11
  v_cvt_pk_bf16_f32 v20, v224, v225
  v_cvt_pk_bf16_f32 v21, v226, v227
  v_cvt_pk_bf16_f32 v22, v228, v229
  v_cvt_pk_bf16_f32 v23, v230, v231
  buffer_store_dwordx4 v[20:23], v201, s[8:11], s75 offen offset:0 sc1
  v_cvt_pk_bf16_f32 v24, v232, v233
  v_cvt_pk_bf16_f32 v25, v234, v235
  v_cvt_pk_bf16_f32 v26, v236, v237
  v_cvt_pk_bf16_f32 v27, v238, v239
  buffer_store_dwordx4 v[24:27], v201, s[8:11], s75 offen offset:1024 sc1
  s_cmp_ge_u32 s77, 64
  s_cbranch_scc1 L_exit
  s_branch AT_loop
L_cexit:
  s_or_b32 s54, s52, s53
  s_cmp_eq_u32 s54, 0
  s_cbranch_scc0 L_nwb
  s_waitcnt vmcnt(0)
  buffer_wbl2 sc1
L_nwb:
L_exit:
L_end:
s_endpgm
.section .rodata,"a"
.p2align 6
.amdhsa_kernel gated_mix__sliding_local_dilated__memory_aug_recurrent_mem_tr__prompt_kernel
  .amdhsa_next_free_vgpr 512
  .amdhsa_next_free_sgpr 102
  .amdhsa_accum_offset 256
  .amdhsa_group_segment_fixed_size 0
  .amdhsa_kernarg_size 112
  .amdhsa_user_sgpr_count 2
  .amdhsa_user_sgpr_kernarg_segment_ptr 1
  .amdhsa_system_sgpr_workgroup_id_x 1
.end_amdhsa_kernel
```

```asm
; @launch grid=(256,1,1) block=(256,1,1) lds=163840
.amdgcn_target "amdgcn-amd-amdhsa--gfx950"
.text
.globl gated_mix__sliding_local_dilated__memory_aug_recurrent_mem_tr__prompt_kernel
.p2align 8
.type gated_mix__sliding_local_dilated__memory_aug_recurrent_mem_tr__prompt_kernel,@function
gated_mix__sliding_local_dilated__memory_aug_recurrent_mem_tr__prompt_kernel:
  s_cmp_ge_u32 s2, 256
  s_cbranch_scc1 L_end
  s_load_dwordx2 s[4:5], s[0:1], 0
  s_load_dwordx2 s[8:9], s[0:1], 104
  s_load_dwordx2 s[12:13], s[0:1], 96
  s_load_dwordx2 s[16:17], s[0:1], 40
  s_load_dwordx2 s[20:21], s[0:1], 48
  s_load_dwordx2 s[24:25], s[0:1], 56
  s_load_dwordx2 s[28:29], s[0:1], 64
  s_load_dwordx2 s[32:33], s[0:1], 32
  s_load_dwordx2 s[36:37], s[0:1], 8
  s_load_dwordx2 s[40:41], s[0:1], 16
  s_load_dwordx2 s[44:45], s[0:1], 80
  s_load_dwordx2 s[48:49], s[0:1], 88
  s_getreg_b32 s54, hwreg(HW_REG_XCC_ID, 0, 3)
  v_lshrrev_b32 v1, 6, v0
  s_nop 0
  v_readfirstlane_b32 s52, v1
  s_mov_b32 s6, 2359296
  s_mov_b32 s7, 0x20000
  s_mov_b32 s10, 268435456
  s_mov_b32 s11, 0x20000
  s_mov_b32 s14, 256
  s_mov_b32 s15, 0x20000
  s_mov_b32 s18, 4718592
  s_mov_b32 s19, 0x20000
  s_mov_b32 s22, 4718592
  s_mov_b32 s23, 0x20000
  s_mov_b32 s26, 4718592
  s_mov_b32 s27, 0x20000
  s_mov_b32 s30, 4718592
  s_mov_b32 s31, 0x20000
  s_mov_b32 s34, 9216
  s_mov_b32 s35, 0x20000
  s_mov_b32 s38, 1990656
  s_mov_b32 s39, 0x20000
  s_mov_b32 s42, 663552
  s_mov_b32 s43, 0x20000
  s_mov_b32 s46, 1152
  s_mov_b32 s47, 0x20000
  s_mov_b32 s50, 2359296
  s_mov_b32 s51, 0x20000
  s_waitcnt lgkmcnt(0)
  s_lshr_b32 s0, s2, 3
  s_mov_b32 s2, s54
  s_mov_b32 s1, 0
L_role:
  s_mov_b32 s53, s0
  s_cmp_eq_u32 s2, 0
  s_cbranch_scc0 L_worker
  v_and_b32 v0, 63, v0
  v_and_b32 v1, 15, v0
  v_lshrrev_b32 v2, 4, v0
  v_and_b32 v3, 1, v2
  s_lshl_b32 s54, s52, 1
  v_add_u32 v3, s54, v3
  v_lshlrev_b32 v3, 1, v3
  v_xor_b32 v3, v3, v1
  v_lshlrev_b32 v3, 4, v3
  v_lshl_add_u32 v8, v2, 13, v3
  s_lshl_b32 s78, s53, 8
  s_lshl_b32 s54, s52, 15
  s_add_u32 s78, s78, s54
  s_mul_i32 s79, s53, 147456
  s_lshl_b32 s57, s52, 10
  s_add_u32 s57, s57, 16384
  s_getpc_b64 s[80:81]
L_pc_1:
  s_and_b32 s55, s0, 1
  s_lshl_b32 s55, s55, 2
  s_add_u32 s55, s55, s52
  s_lshl_b32 s55, s55, 10
  v_and_b32 v199, 63, v0
  v_lshl_add_u32 v199, v199, 4, s55
  v_min_u32 v199, (L_w0 - L_pc_1), v199
  global_load_dword v196, v199, s[80:81]
  s_add_u32 m0, s57, 0
  s_add_u32 s54, s78, 0
  buffer_load_dwordx4 v8, s[16:19], s54 offen  lds
  s_add_u32 m0, s57, 4096
  s_add_u32 s54, s78, 131072
  buffer_load_dwordx4 v8, s[16:19], s54 offen  lds
  s_add_u32 m0, s57, 8192
  s_add_u32 s54, s78, 262144
  buffer_load_dwordx4 v8, s[16:19], s54 offen  lds
  s_add_u32 m0, s57, 12288
  s_add_u32 s54, s78, 393216
  buffer_load_dwordx4 v8, s[16:19], s54 offen  lds
  s_add_u32 m0, s57, 16384
  s_add_u32 s54, s78, 524288
  buffer_load_dwordx4 v8, s[16:19], s54 offen  lds
  s_add_u32 m0, s57, 20480
  s_add_u32 s54, s78, 655360
  buffer_load_dwordx4 v8, s[16:19], s54 offen  lds
  s_add_u32 m0, s57, 24576
  s_add_u32 s54, s78, 786432
  buffer_load_dwordx4 v8, s[16:19], s54 offen  lds
  s_add_u32 m0, s57, 28672
  s_add_u32 s54, s78, 917504
  buffer_load_dwordx4 v8, s[16:19], s54 offen  lds
  s_add_u32 m0, s57, 32768
  s_add_u32 s54, s78, 1048576
  buffer_load_dwordx4 v8, s[16:19], s54 offen  lds
  s_add_u32 m0, s57, 36864
  s_add_u32 s54, s78, 1179648
  buffer_load_dwordx4 v8, s[16:19], s54 offen  lds
  s_add_u32 m0, s57, 40960
  s_add_u32 s54, s78, 1310720
  buffer_load_dwordx4 v8, s[16:19], s54 offen  lds
  s_add_u32 m0, s57, 45056
  s_add_u32 s54, s78, 1441792
  buffer_load_dwordx4 v8, s[16:19], s54 offen  lds
  s_add_u32 m0, s57, 49152
  s_add_u32 s54, s78, 1572864
  buffer_load_dwordx4 v8, s[16:19], s54 offen  lds
  s_add_u32 m0, s57, 53248
  s_add_u32 s54, s78, 1703936
  buffer_load_dwordx4 v8, s[16:19], s54 offen  lds
  s_add_u32 m0, s57, 57344
  s_add_u32 s54, s78, 1835008
  buffer_load_dwordx4 v8, s[16:19], s54 offen  lds
  s_add_u32 m0, s57, 61440
  s_add_u32 s54, s78, 1966080
  buffer_load_dwordx4 v8, s[16:19], s54 offen  lds
  v_lshlrev_b32 v76, 4, v0
  v_add_u32 v75, 0x10000, v76
  v_lshrrev_b32 v3, 2, v1
  v_and_b32 v4, 1, v1
  v_lshl_add_u32 v3, v3, 1, v4
  v_bfe_u32 v4, v1, 1, 1
  v_mul_u32_u24 v74, 0xaaaa, v4
  v_add_u32 v74, 0x4444, v74
  v_mul_u32_u24 v5, 576, v3
  v_add_u32 v5, 0, v5
  v_lshl_add_u32 v78, v2, 4, v5
  v_lshl_add_u32 v77, v2, 5, v5
  v_lshl_add_u32 v77, v4, 4, v77
  v_mul_u32_u24 v15, 1152, v3
  v_lshl_add_u32 v15, v2, 5, v15
  v_lshl_add_u32 v15, v4, 4, v15
  s_lshl_b32 s54, s52, 8
  buffer_load_dwordx4 v[20:23], v15, s[32:35], s54 offen
  buffer_load_dwordx4 v[24:27], v15, s[32:35], s54 offen offset:128
  buffer_load_dwordx4 v[28:31], v15, s[32:35], 0 offen offset:1024
  v_mul_u32_u24 v79, 1152, v2
  v_lshl_add_u32 v79, v1, 2, v79
  s_lshl_b32 s54, s52, 6
  s_add_u32 s54, s54, 0
  v_add_u32 v79, s54, v79
  v_lshrrev_b32 v5, 3, v0
  v_mul_u32_u24 v68, 2176, v5
  v_and_b32 v5, 7, v0
  v_lshl_add_u32 v68, v5, 3, v68
  v_lshrrev_b32 v6, 3, v0
  s_lshr_b32 s54, s53, 2
  v_add_u32 v68, s54, v6
  v_and_b32 v68, 7, v68
  v_xor_b32 v68, v68, v6
  v_lshlrev_b32 v68, 8, v68
  v_lshl_add_u32 v68, v6, 12, v68
  v_lshl_add_u32 v68, v5, 3, v68
  s_and_b32 s54, s53, 3
  s_lshl_b32 s54, s54, 6
  v_add_u32 v68, s54, v68
  v_and_b32 v5, 1, v2
  v_lshlrev_b32 v5, 4, v5
  v_lshl_add_u32 v5, v1, 2, v5
  v_mov_b32 v6, 0x40000000
  v_cmp_lt_u32 vcc, 3, v1
  s_nop 1
  v_cndmask_b32 v5, v5, v6, vcc
  v_lshrrev_b32 v6, 1, v2
  v_lshl_add_u32 v69, v6, 10, v5
  v_lshl_add_u32 v70, v6, 8, v5
  v_mov_b32 v71, -1
  ds_write_b128 v76, v[68:71] offset:13824
  v_and_b32 v5, 3, v1
  v_lshrrev_b32 v6, 2, v1
  v_lshl_add_u32 v5, v5, 2, v6
  v_and_b32 v6, 1, v5
  v_lshlrev_b32 v6, 4, v6
  v_mov_b32 v7, 0x3f80
  v_lshlrev_b32 v6, v6, v7
  v_lshrrev_b32 v5, 1, v5
  v_cmp_eq_u32 vcc, 0, v5
  s_nop 1
  v_cndmask_b32 v40, 0, v6, vcc
  v_cmp_eq_u32 vcc, 1, v5
  s_nop 1
  v_cndmask_b32 v41, 0, v6, vcc
  v_cmp_eq_u32 vcc, 2, v5
  s_nop 1
  v_cndmask_b32 v42, 0, v6, vcc
  v_cmp_eq_u32 vcc, 3, v5
  s_nop 1
  v_cndmask_b32 v43, 0, v6, vcc
  ds_write_b128 v76, v[40:43] offset:14848
  s_and_b32 s54, s52, 1
  s_lshr_b32 s55, s52, 1
  v_lshrrev_b32 v3, 3, v0
  v_and_b32 v4, 1, v3
  v_lshlrev_b32 v4, 4, v4
  v_and_b32 v5, 6, v3
  v_add_u32 v4, v4, v5
  s_lshl_b32 s56, s55, 3
  s_add_u32 s56, s56, s54
  v_add_u32 v4, s56, v4
  v_mul_u32_u24 v4, 1152, v4
  v_and_b32 v5, 2, v3
  v_lshlrev_b32 v5, 1, v5
  v_and_b32 v6, 7, v0
  v_xor_b32 v6, v6, v5
  v_lshl_add_u32 v9, v6, 4, v4
  v_and_b32 v4, 1, v2
  v_lshlrev_b32 v4, 4, v4
  v_and_b32 v5, 2, v2
  v_add_u32 v4, v4, v5
  s_lshl_b32 s56, s55, 2
  s_add_u32 s56, s56, s54
  v_add_u32 v4, s56, v4
  v_mul_u32_u24 v4, 1152, v4
  v_lshlrev_b32 v6, 1, v2
  v_xor_b32 v6, v6, v1
  v_lshl_add_u32 v10, v6, 4, v4
  v_bfe_u32 v17, v1, 2, 1
  v_bfe_u32 v18, v1, 3, 1
  v_and_b32 v19, 1, v2
  v_lshrrev_b32 v72, 1, v2
  v_and_b32 v73, 3, v1
  v_lshl_add_u32 v3, v19, 1, v17
  v_lshl_add_u32 v6, v18, 2, v3
  v_lshl_add_u32 v4, v72, 4, v17
  v_lshl_add_u32 v4, v19, 2, v4
  v_lshl_add_u32 v4, v18, 3, v4
  v_lshlrev_b32 v4, 8, v4
  s_lshl_b32 s54, s52, 6
  v_lshl_add_u32 v5, v73, 3, s54
  v_lshlrev_b32 v7, 5, v6
  v_xor_b32 v5, v5, v7
  v_add_u32 v11, v4, v5
  v_xor_b32 v12, 32, v11
  v_lshl_add_u32 v4, v72, 2, v3
  v_lshlrev_b32 v4, 7, v4
  v_lshl_add_u32 v4, v73, 3, v4
  s_and_b32 s54, s52, 1
  v_xor_b32 v7, s54, v19
  v_lshl_add_u32 v7, v7, 1, v18
  v_lshl_add_u32 v13, v7, 5, v4
  v_lshlrev_b32 v4, 11, v72
  v_lshl_add_u32 v4, v73, 3, v4
  v_lshl_add_u32 v5, v3, 8, v4
  v_lshl_add_u32 v7, v18, 2, s52
  v_xor_b32 v7, v7, v3
  v_lshl_add_u32 v14, v7, 5, v5
  s_lshl_b32 s54, s53, 14
  s_lshl_b32 s55, s52, 11
  s_add_u32 s54, s54, 1048576
  s_add_u32 s58, s54, s55
  s_add_u32 s59, s58, 8192
  s_lshl_b32 s55, s52, 12
  s_add_u32 s70, s54, s55
  s_add_u32 s70, s70, 655360
  s_lshl_b32 s54, s53, 12
  s_lshl_b32 s55, s52, 10
  s_add_u32 s54, s54, s55
  s_add_u32 s68, s54, 917504
  s_lshl_b32 s54, s53, 6
  s_mul_i32 s55, s52, 17408
  s_add_u32 s55, s54, s55
  s_add_u32 s73, s55, 0
  s_add_u32 s74, s55, 69632
  s_add_u32 s75, s55, 139264
  s_add_u32 s76, s55, 208896
  s_and_b32 s56, s52, 1
  s_mul_i32 s55, s56, 17408
  s_add_u32 s55, s54, s55
  s_add_u32 s77, s55, 278528
  s_mul_i32 s54, s52, 69632
  s_mul_i32 s55, s53, 2176
  s_add_u32 s54, s54, s55
  s_add_u32 s60, s54, 0
  s_and_b32 s56, s53, 15
  s_mul_i32 s55, s56, 2176
  s_add_u32 s61, s55, 278528
  s_lshr_b32 s54, s52, 1
  s_lshl_b32 s54, s54, 15
  s_and_b32 s55, s52, 1
  s_lshl_b32 s55, s55, 11
  s_add_u32 s54, s54, s55
  s_add_u32 s73, s54, 0
  s_add_u32 s74, s54, 65536
  s_add_u32 s75, s54, 131072
  s_add_u32 s76, s54, 196608
  s_add_u32 s77, s55, 262144
  s_and_b32 s54, s53, 7
  s_lshl_b32 s54, s54, 12
  s_bfe_u32 s55, s53, 0x10003
  s_lshl_b32 s55, s55, 11
  s_add_u32 s54, s54, s55
  s_add_u32 s61, s54, 262144
  s_lshr_b32 s55, s53, 4
  s_lshl_b32 s55, s55, 15
  s_add_u32 s54, s54, s55
  s_lshl_b32 s55, s52, 16
  s_add_u32 s54, s54, s55
  s_add_u32 s60, s54, 0
  s_lshl_b32 s54, s52, 11
  s_add_u32 s64, s54, 360448
  s_mov_b32 s65, 368640
  s_lshl_b32 s55, s53, 5
  s_add_u32 s54, s54, s55
  s_add_u32 s62, s54, 376832
  s_lshr_b32 s54, s56, 3
  s_lshl_b32 s54, s54, 9
  s_and_b32 s55, s56, 7
  s_lshl_b32 s55, s55, 5
  s_add_u32 s54, s54, s55
  s_add_u32 s63, s54, 385024
  s_mov_b32 s66, 0
  s_mov_b32 s67, 0
  s_mov_b32 s72, 0
  s_mov_b32 s69, 1040356334
  s_waitcnt vmcnt(15) lgkmcnt(0)
  s_barrier
  s_add_u32 m0, s57, 65536
  s_add_u32 s54, s78, 2097152
  buffer_load_dwordx4 v8, s[16:19], s54 offen  lds
  s_add_u32 m0, s57, 69632
  s_add_u32 s54, s78, 2228224
  buffer_load_dwordx4 v8, s[16:19], s54 offen  lds
  s_add_u32 m0, s57, 73728
  s_add_u32 s54, s78, 2359296
  buffer_load_dwordx4 v8, s[16:19], s54 offen  lds
  s_add_u32 m0, s57, 77824
  s_add_u32 s54, s78, 2490368
  buffer_load_dwordx4 v8, s[16:19], s54 offen  lds
  s_lshl_b32 s55, s2, 2
  s_or_b32 s56, s52, s1
  s_cmp_eq_u32 s56, 0
  s_cselect_b32 s55, s55, 0x1000
  s_lshl_b32 s56, 1, s0
  v_mov_b32 v35, s56
  s_mov_b64 exec, 1
  buffer_atomic_or v35, off, s[12:15], s55 sc0
  s_mov_b64 exec, -1
  v_add_u32 v15, 16384, v11
  v_add_u32 v16, 16384, v12
  ds_read_b64_tr_b16 v[80:81], v15 offset:0
  ds_read_b64_tr_b16 v[82:83], v15 offset:512
  ds_read_b64_tr_b16 v[84:85], v15 offset:8192
  ds_read_b64_tr_b16 v[86:87], v15 offset:8704
  ds_read_b64_tr_b16 v[88:89], v16 offset:0
  ds_read_b64_tr_b16 v[90:91], v16 offset:512
  ds_read_b64_tr_b16 v[92:93], v16 offset:8192
  ds_read_b64_tr_b16 v[94:95], v16 offset:8704
  s_waitcnt vmcnt(16) lgkmcnt(0)
  s_barrier
  s_add_u32 m0, s57, 81920
  s_add_u32 s54, s78, 2621440
  buffer_load_dwordx4 v8, s[16:19], s54 offen  lds
  s_add_u32 m0, s57, 86016
  s_add_u32 s54, s78, 2752512
  buffer_load_dwordx4 v8, s[16:19], s54 offen  lds
  s_add_u32 m0, s57, 90112
  s_add_u32 s54, s78, 2883584
  buffer_load_dwordx4 v8, s[16:19], s54 offen  lds
  s_add_u32 m0, s57, 94208
  s_add_u32 s54, s78, 3014656
  buffer_load_dwordx4 v8, s[16:19], s54 offen  lds
  v_add_u32 v15, 32768, v11
  v_add_u32 v16, 32768, v12
  ds_read_b64_tr_b16 v[96:97], v15 offset:0
  ds_read_b64_tr_b16 v[98:99], v15 offset:512
  ds_read_b64_tr_b16 v[100:101], v15 offset:8192
  ds_read_b64_tr_b16 v[102:103], v15 offset:8704
  ds_read_b64_tr_b16 v[104:105], v16 offset:0
  ds_read_b64_tr_b16 v[106:107], v16 offset:512
  ds_read_b64_tr_b16 v[108:109], v16 offset:8192
  ds_read_b64_tr_b16 v[110:111], v16 offset:8704
  s_waitcnt vmcnt(16) lgkmcnt(0)
  s_barrier
  s_add_u32 m0, s57, 98304
  s_add_u32 s54, s78, 3670016
  buffer_load_dwordx4 v8, s[16:19], s54 offen  lds
  s_add_u32 m0, s57, 102400
  s_add_u32 s54, s78, 3801088
  buffer_load_dwordx4 v8, s[16:19], s54 offen  lds
  s_add_u32 m0, s57, 106496
  s_add_u32 s54, s78, 3932160
  buffer_load_dwordx4 v8, s[16:19], s54 offen  lds
  s_add_u32 m0, s57, 110592
  s_add_u32 s54, s78, 4063232
  buffer_load_dwordx4 v8, s[16:19], s54 offen  lds
  v_add_u32 v15, 49152, v11
  v_add_u32 v16, 49152, v12
  ds_read_b64_tr_b16 v[112:113], v15 offset:0
  ds_read_b64_tr_b16 v[114:115], v15 offset:512
  ds_read_b64_tr_b16 v[116:117], v15 offset:8192
  ds_read_b64_tr_b16 v[118:119], v15 offset:8704
  ds_read_b64_tr_b16 v[120:121], v16 offset:0
  ds_read_b64_tr_b16 v[122:123], v16 offset:512
  ds_read_b64_tr_b16 v[124:125], v16 offset:8192
  ds_read_b64_tr_b16 v[126:127], v16 offset:8704
  s_waitcnt vmcnt(16) lgkmcnt(0)
  s_barrier
  s_add_u32 m0, s57, 114688
  s_add_u32 s54, s78, 4194304
  buffer_load_dwordx4 v8, s[16:19], s54 offen  lds
  s_add_u32 m0, s57, 118784
  s_add_u32 s54, s78, 4325376
  buffer_load_dwordx4 v8, s[16:19], s54 offen  lds
  s_add_u32 m0, s57, 122880
  s_add_u32 s54, s78, 4456448
  buffer_load_dwordx4 v8, s[16:19], s54 offen  lds
  s_add_u32 m0, s57, 126976
  s_add_u32 s54, s78, 4587520
  buffer_load_dwordx4 v8, s[16:19], s54 offen  lds
  v_add_u32 v15, 65536, v11
  v_add_u32 v16, 65536, v12
  ds_read_b64_tr_b16 v[128:129], v15 offset:0
  ds_read_b64_tr_b16 v[130:131], v15 offset:512
  ds_read_b64_tr_b16 v[132:133], v15 offset:8192
  ds_read_b64_tr_b16 v[134:135], v15 offset:8704
  ds_read_b64_tr_b16 v[136:137], v16 offset:0
  ds_read_b64_tr_b16 v[138:139], v16 offset:512
  ds_read_b64_tr_b16 v[140:141], v16 offset:8192
  ds_read_b64_tr_b16 v[142:143], v16 offset:8704
  s_waitcnt vmcnt(13) lgkmcnt(0)
  s_barrier
  s_add_u32 m0, s57, 131072
  s_add_u32 s54, s78, 1048576
  buffer_load_dwordx4 v8, s[20:23], s54 offen  lds
  s_add_u32 m0, s57, 135168
  s_add_u32 s54, s78, 1179648
  buffer_load_dwordx4 v8, s[20:23], s54 offen  lds
  s_add_u32 m0, s57, 139264
  s_add_u32 s54, s78, 1310720
  buffer_load_dwordx4 v8, s[20:23], s54 offen  lds
  s_add_u32 m0, s57, 143360
  s_add_u32 s54, s78, 1441792
  buffer_load_dwordx4 v8, s[20:23], s54 offen  lds
  v_add_u32 v15, 81920, v11
  v_add_u32 v16, 81920, v12
  ds_read_b64_tr_b16 v[144:145], v15 offset:0
  ds_read_b64_tr_b16 v[146:147], v15 offset:512
  ds_read_b64_tr_b16 v[148:149], v15 offset:8192
  ds_read_b64_tr_b16 v[150:151], v15 offset:8704
  ds_read_b64_tr_b16 v[152:153], v16 offset:0
  ds_read_b64_tr_b16 v[154:155], v16 offset:512
  ds_read_b64_tr_b16 v[156:157], v16 offset:8192
  ds_read_b64_tr_b16 v[158:159], v16 offset:8704
  s_waitcnt vmcnt(12) lgkmcnt(0)
  s_barrier
  s_add_u32 m0, s57, 0
  s_add_u32 s54, s78, 1572864
  buffer_load_dwordx4 v8, s[20:23], s54 offen  lds
  s_add_u32 m0, s57, 4096
  s_add_u32 s54, s78, 1703936
  buffer_load_dwordx4 v8, s[20:23], s54 offen  lds
  s_add_u32 m0, s57, 8192
  s_add_u32 s54, s78, 1835008
  buffer_load_dwordx4 v8, s[20:23], s54 offen  lds
  s_add_u32 m0, s57, 12288
  s_add_u32 s54, s78, 1966080
  buffer_load_dwordx4 v8, s[20:23], s54 offen  lds
  v_add_u32 v15, 98304, v11
  v_add_u32 v16, 98304, v12
  ds_read_b64_tr_b16 v[160:161], v15 offset:0
  ds_read_b64_tr_b16 v[162:163], v15 offset:512
  ds_read_b64_tr_b16 v[164:165], v15 offset:8192
  ds_read_b64_tr_b16 v[166:167], v15 offset:8704
  ds_read_b64_tr_b16 v[168:169], v16 offset:0
  ds_read_b64_tr_b16 v[170:171], v16 offset:512
  ds_read_b64_tr_b16 v[172:173], v16 offset:8192
  ds_read_b64_tr_b16 v[174:175], v16 offset:8704
  s_waitcnt vmcnt(12) lgkmcnt(0)
  s_barrier
  s_add_u32 m0, s57, 16384
  s_add_u32 s54, s78, 3145728
  buffer_load_dwordx4 v8, s[20:23], s54 offen  lds
  s_add_u32 m0, s57, 20480
  s_add_u32 s54, s78, 3276800
  buffer_load_dwordx4 v8, s[20:23], s54 offen  lds
  s_add_u32 m0, s57, 24576
  s_add_u32 s54, s78, 3407872
  buffer_load_dwordx4 v8, s[20:23], s54 offen  lds
  s_add_u32 m0, s57, 28672
  s_add_u32 s54, s78, 3538944
  buffer_load_dwordx4 v8, s[20:23], s54 offen  lds
  v_add_u32 v15, 114688, v11
  v_add_u32 v16, 114688, v12
  ds_read_b64_tr_b16 v[176:177], v15 offset:0
  ds_read_b64_tr_b16 v[178:179], v15 offset:512
  ds_read_b64_tr_b16 v[180:181], v15 offset:8192
  ds_read_b64_tr_b16 v[182:183], v15 offset:8704
  ds_read_b64_tr_b16 v[184:185], v16 offset:0
  ds_read_b64_tr_b16 v[186:187], v16 offset:512
  ds_read_b64_tr_b16 v[188:189], v16 offset:8192
  ds_read_b64_tr_b16 v[190:191], v16 offset:8704
  s_waitcnt vmcnt(12) lgkmcnt(0)
  s_barrier
  s_add_u32 m0, s57, 32768
  s_add_u32 s54, s78, 3670016
  buffer_load_dwordx4 v8, s[20:23], s54 offen  lds
  s_add_u32 m0, s57, 36864
  s_add_u32 s54, s78, 3801088
  buffer_load_dwordx4 v8, s[20:23], s54 offen  lds
  s_add_u32 m0, s57, 40960
  s_add_u32 s54, s78, 3932160
  buffer_load_dwordx4 v8, s[20:23], s54 offen  lds
  s_add_u32 m0, s57, 45056
  s_add_u32 s54, s78, 4063232
  buffer_load_dwordx4 v8, s[20:23], s54 offen  lds
  v_add_u32 v15, 131072, v11
  v_add_u32 v16, 131072, v12
  ds_read_b64_tr_b16 v[192:193], v15 offset:0
  ds_read_b64_tr_b16 v[194:195], v15 offset:512
  ds_read_b64_tr_b16 v[196:197], v15 offset:8192
  ds_read_b64_tr_b16 v[198:199], v15 offset:8704
  ds_read_b64_tr_b16 v[200:201], v16 offset:0
  ds_read_b64_tr_b16 v[202:203], v16 offset:512
  ds_read_b64_tr_b16 v[204:205], v16 offset:8192
  ds_read_b64_tr_b16 v[206:207], v16 offset:8704
  s_waitcnt vmcnt(12) lgkmcnt(0)
  s_barrier
  s_add_u32 m0, s57, 49152
  s_add_u32 s54, s78, 4194304
  buffer_load_dwordx4 v8, s[20:23], s54 offen  lds
  s_add_u32 m0, s57, 53248
  s_add_u32 s54, s78, 4325376
  buffer_load_dwordx4 v8, s[20:23], s54 offen  lds
  s_add_u32 m0, s57, 57344
  s_add_u32 s54, s78, 4456448
  buffer_load_dwordx4 v8, s[20:23], s54 offen  lds
  s_add_u32 m0, s57, 61440
  s_add_u32 s54, s78, 4587520
  buffer_load_dwordx4 v8, s[20:23], s54 offen  lds
  s_getpc_b64 s[80:81]
  v_lshlrev_b32 v7, 2, v76
  global_load_dword v19, v7, s[80:81] offset:1024
  s_cmp_eq_u32 s1, 1
  s_cbranch_scc1 C_ver_ok
  v_mov_b32 v33, 16320
  s_cmp_eq_u32 s52, 0
  s_cbranch_scc0 C_ver_b
  s_waitcnt vmcnt(33)
  s_mov_b64 exec, 1
  ds_write_b32 v33, v35
  s_mov_b64 exec, -1
  s_waitcnt lgkmcnt(0)
C_ver_b:
  s_barrier
  ds_read_b32 v32, v33
  s_waitcnt lgkmcnt(0)
  v_readfirstlane_b32 s54, v32
  s_nop 0
  s_bitcmp1_b32 s54, s0
  s_cbranch_scc1 L_conf
C_ver_ok:
  v_min_u32 v20, -2, v20
  v_min_u32 v21, -2, v21
  v_min_u32 v22, -2, v22
  v_min_u32 v23, -2, v23
  v_min_u32 v24, -2, v24
  v_min_u32 v25, -2, v25
  v_min_u32 v26, -2, v26
  v_min_u32 v27, -2, v27
  v_min_u32 v28, -2, v28
  v_min_u32 v29, -2, v29
  v_min_u32 v30, -2, v30
  v_min_u32 v31, -2, v31
  s_lshl_b32 s54, s52, 11
  v_add_u32 v3, s54, v76
  ds_write_b128 v3, v[20:23] offset:4608
  ds_write_b128 v3, v[24:27] offset:5632
  ds_write_b128 v76, v[28:31] offset:12800
  v_add_u32 v15, 147456, v11
  v_add_u32 v16, 147456, v12
  ds_read_b64_tr_b16 v[208:209], v15 offset:0
  ds_read_b64_tr_b16 v[210:211], v15 offset:512
  ds_read_b64_tr_b16 v[212:213], v15 offset:8192
  ds_read_b64_tr_b16 v[214:215], v15 offset:8704
  ds_read_b64_tr_b16 v[216:217], v16 offset:0
  ds_read_b64_tr_b16 v[218:219], v16 offset:512
  ds_read_b64_tr_b16 v[220:221], v16 offset:8192
  ds_read_b64_tr_b16 v[222:223], v16 offset:8704
  s_waitcnt vmcnt(13) lgkmcnt(0)
  s_barrier
  s_add_u32 m0, s57, 65536
  s_add_u32 s54, s78, 0
  buffer_load_dwordx4 v8, s[24:27], s54 offen  lds
  s_add_u32 m0, s57, 69632
  s_add_u32 s54, s78, 131072
  buffer_load_dwordx4 v8, s[24:27], s54 offen  lds
  s_add_u32 m0, s57, 73728
  s_add_u32 s54, s78, 262144
  buffer_load_dwordx4 v8, s[24:27], s54 offen  lds
  s_add_u32 m0, s57, 77824
  s_add_u32 s54, s78, 393216
  buffer_load_dwordx4 v8, s[24:27], s54 offen  lds
  v_add_u32 v15, 16384, v11
  v_add_u32 v16, 16384, v12
  ds_read_b64_tr_b16 v[224:225], v15 offset:0
  ds_read_b64_tr_b16 v[226:227], v15 offset:512
  ds_read_b64_tr_b16 v[228:229], v15 offset:8192
  ds_read_b64_tr_b16 v[230:231], v15 offset:8704
  ds_read_b64_tr_b16 v[232:233], v16 offset:0
  ds_read_b64_tr_b16 v[234:235], v16 offset:512
  ds_read_b64_tr_b16 v[236:237], v16 offset:8192
  ds_read_b64_tr_b16 v[238:239], v16 offset:8704
  s_waitcnt vmcnt(13) lgkmcnt(0)
  s_barrier
  s_add_u32 m0, s57, 81920
  s_add_u32 s54, s78, 524288
  buffer_load_dwordx4 v8, s[24:27], s54 offen  lds
  s_add_u32 m0, s57, 86016
  s_add_u32 s54, s78, 655360
  buffer_load_dwordx4 v8, s[24:27], s54 offen  lds
  s_add_u32 m0, s57, 90112
  s_add_u32 s54, s78, 786432
  buffer_load_dwordx4 v8, s[24:27], s54 offen  lds
  s_add_u32 m0, s57, 94208
  s_add_u32 s54, s78, 917504
  buffer_load_dwordx4 v8, s[24:27], s54 offen  lds
  v_add_u32 v15, 32768, v11
  v_add_u32 v16, 32768, v12
  ds_read_b64_tr_b16 v[240:241], v15 offset:0
  ds_read_b64_tr_b16 v[242:243], v15 offset:512
  ds_read_b64_tr_b16 v[244:245], v15 offset:8192
  ds_read_b64_tr_b16 v[246:247], v15 offset:8704
  ds_read_b64_tr_b16 v[248:249], v16 offset:0
  ds_read_b64_tr_b16 v[250:251], v16 offset:512
  ds_read_b64_tr_b16 v[252:253], v16 offset:8192
  ds_read_b64_tr_b16 v[254:255], v16 offset:8704
  s_waitcnt vmcnt(13) lgkmcnt(0)
  s_barrier
  s_add_u32 m0, s57, 98304
  s_add_u32 s54, s78, 1048576
  buffer_load_dwordx4 v8, s[24:27], s54 offen  lds
  s_add_u32 m0, s57, 102400
  s_add_u32 s54, s78, 1179648
  buffer_load_dwordx4 v8, s[24:27], s54 offen  lds
  s_add_u32 m0, s57, 106496
  s_add_u32 s54, s78, 1310720
  buffer_load_dwordx4 v8, s[24:27], s54 offen  lds
  s_add_u32 m0, s57, 110592
  s_add_u32 s54, s78, 1441792
  buffer_load_dwordx4 v8, s[24:27], s54 offen  lds
  v_add_u32 v15, 49152, v11
  v_add_u32 v16, 49152, v12
  ds_read_b64_tr_b16 a[0:1], v15 offset:0
  ds_read_b64_tr_b16 a[2:3], v15 offset:512
  ds_read_b64_tr_b16 a[4:5], v15 offset:8192
  ds_read_b64_tr_b16 a[6:7], v15 offset:8704
  ds_read_b64_tr_b16 a[8:9], v16 offset:0
  ds_read_b64_tr_b16 a[10:11], v16 offset:512
  ds_read_b64_tr_b16 a[12:13], v16 offset:8192
  ds_read_b64_tr_b16 a[14:15], v16 offset:8704
  s_waitcnt vmcnt(13) lgkmcnt(0)
  s_barrier
  s_add_u32 m0, s57, 114688
  s_add_u32 s54, s78, 1572864
  buffer_load_dwordx4 v8, s[24:27], s54 offen  lds
  s_add_u32 m0, s57, 118784
  s_add_u32 s54, s78, 1703936
  buffer_load_dwordx4 v8, s[24:27], s54 offen  lds
  s_add_u32 m0, s57, 122880
  s_add_u32 s54, s78, 1835008
  buffer_load_dwordx4 v8, s[24:27], s54 offen  lds
  s_add_u32 m0, s57, 126976
  s_add_u32 s54, s78, 1966080
  buffer_load_dwordx4 v8, s[24:27], s54 offen  lds
  v_add_u32 v15, 65536, v11
  v_add_u32 v16, 65536, v12
  ds_read_b64_tr_b16 a[16:17], v15 offset:0
  ds_read_b64_tr_b16 a[18:19], v15 offset:512
  ds_read_b64_tr_b16 a[20:21], v15 offset:8192
  ds_read_b64_tr_b16 a[22:23], v15 offset:8704
  ds_read_b64_tr_b16 a[24:25], v16 offset:0
  ds_read_b64_tr_b16 a[26:27], v16 offset:512
  ds_read_b64_tr_b16 a[28:29], v16 offset:8192
  ds_read_b64_tr_b16 a[30:31], v16 offset:8704
  s_waitcnt vmcnt(12) lgkmcnt(0)
  s_barrier
  s_add_u32 m0, s57, 131072
  s_add_u32 s54, s78, 2097152
  buffer_load_dwordx4 v8, s[24:27], s54 offen  lds
  s_add_u32 m0, s57, 135168
  s_add_u32 s54, s78, 2228224
  buffer_load_dwordx4 v8, s[24:27], s54 offen  lds
  s_add_u32 m0, s57, 139264
  s_add_u32 s54, s78, 2359296
  buffer_load_dwordx4 v8, s[24:27], s54 offen  lds
  s_add_u32 m0, s57, 143360
  s_add_u32 s54, s78, 2490368
  buffer_load_dwordx4 v8, s[24:27], s54 offen  lds
  v_add_u32 v15, 81920, v11
  v_add_u32 v16, 81920, v12
  ds_read_b64_tr_b16 a[32:33], v15 offset:0
  ds_read_b64_tr_b16 a[34:35], v15 offset:512
  ds_read_b64_tr_b16 a[36:37], v15 offset:8192
  ds_read_b64_tr_b16 a[38:39], v15 offset:8704
  ds_read_b64_tr_b16 a[40:41], v16 offset:0
  ds_read_b64_tr_b16 a[42:43], v16 offset:512
  ds_read_b64_tr_b16 a[44:45], v16 offset:8192
  ds_read_b64_tr_b16 a[46:47], v16 offset:8704
  s_waitcnt vmcnt(12) lgkmcnt(0)
  s_barrier
  s_add_u32 m0, s57, 0
  s_add_u32 s54, s78, 2621440
  buffer_load_dwordx4 v8, s[24:27], s54 offen  lds
  s_add_u32 m0, s57, 4096
  s_add_u32 s54, s78, 2752512
  buffer_load_dwordx4 v8, s[24:27], s54 offen  lds
  s_add_u32 m0, s57, 8192
  s_add_u32 s54, s78, 2883584
  buffer_load_dwordx4 v8, s[24:27], s54 offen  lds
  s_add_u32 m0, s57, 12288
  s_add_u32 s54, s78, 3014656
  buffer_load_dwordx4 v8, s[24:27], s54 offen  lds
  s_getpc_b64 s[80:81]
  v_lshlrev_b32 v7, 2, v76
  global_load_dword v19, v7, s[80:81] offset:1024
  v_add_u32 v15, 98304, v11
  v_add_u32 v16, 98304, v12
  ds_read_b64_tr_b16 a[48:49], v15 offset:0
  ds_read_b64_tr_b16 a[50:51], v15 offset:512
  ds_read_b64_tr_b16 a[52:53], v15 offset:8192
  ds_read_b64_tr_b16 a[54:55], v15 offset:8704
  ds_read_b64_tr_b16 a[56:57], v16 offset:0
  ds_read_b64_tr_b16 a[58:59], v16 offset:512
  ds_read_b64_tr_b16 a[60:61], v16 offset:8192
  ds_read_b64_tr_b16 a[62:63], v16 offset:8704
  s_waitcnt vmcnt(13) lgkmcnt(0)
  s_barrier
  s_add_u32 m0, s57, 16384
  s_add_u32 s54, s78, 3145728
  buffer_load_dwordx4 v8, s[24:27], s54 offen  lds
  s_add_u32 m0, s57, 20480
  s_add_u32 s54, s78, 3276800
  buffer_load_dwordx4 v8, s[24:27], s54 offen  lds
  s_add_u32 m0, s57, 24576
  s_add_u32 s54, s78, 3407872
  buffer_load_dwordx4 v8, s[24:27], s54 offen  lds
  s_add_u32 m0, s57, 28672
  s_add_u32 s54, s78, 3538944
  buffer_load_dwordx4 v8, s[24:27], s54 offen  lds
  v_add_u32 v15, 114688, v11
  v_add_u32 v16, 114688, v12
  ds_read_b64_tr_b16 a[64:65], v15 offset:0
  ds_read_b64_tr_b16 a[66:67], v15 offset:512
  ds_read_b64_tr_b16 a[68:69], v15 offset:8192
  ds_read_b64_tr_b16 a[70:71], v15 offset:8704
  ds_read_b64_tr_b16 a[72:73], v16 offset:0
  ds_read_b64_tr_b16 a[74:75], v16 offset:512
  ds_read_b64_tr_b16 a[76:77], v16 offset:8192
  ds_read_b64_tr_b16 a[78:79], v16 offset:8704
  s_waitcnt vmcnt(13) lgkmcnt(0)
  s_barrier
  s_add_u32 m0, s57, 32768
  s_add_u32 s54, s78, 3670016
  buffer_load_dwordx4 v8, s[24:27], s54 offen  lds
  s_add_u32 m0, s57, 36864
  s_add_u32 s54, s78, 3801088
  buffer_load_dwordx4 v8, s[24:27], s54 offen  lds
  s_add_u32 m0, s57, 40960
  s_add_u32 s54, s78, 3932160
  buffer_load_dwordx4 v8, s[24:27], s54 offen  lds
  s_add_u32 m0, s57, 45056
  s_add_u32 s54, s78, 4063232
  buffer_load_dwordx4 v8, s[24:27], s54 offen  lds
  v_add_u32 v15, 131072, v11
  v_add_u32 v16, 131072, v12
  ds_read_b64_tr_b16 a[80:81], v15 offset:0
  ds_read_b64_tr_b16 a[82:83], v15 offset:512
  ds_read_b64_tr_b16 a[84:85], v15 offset:8192
  ds_read_b64_tr_b16 a[86:87], v15 offset:8704
  ds_read_b64_tr_b16 a[88:89], v16 offset:0
  ds_read_b64_tr_b16 a[90:91], v16 offset:512
  ds_read_b64_tr_b16 a[92:93], v16 offset:8192
  ds_read_b64_tr_b16 a[94:95], v16 offset:8704
  s_waitcnt vmcnt(13) lgkmcnt(0)
  s_barrier
  s_add_u32 m0, s57, 49152
  s_add_u32 s54, s78, 4194304
  buffer_load_dwordx4 v8, s[24:27], s54 offen  lds
  s_add_u32 m0, s57, 53248
  s_add_u32 s54, s78, 4325376
  buffer_load_dwordx4 v8, s[24:27], s54 offen  lds
  s_add_u32 m0, s57, 57344
  s_add_u32 s54, s78, 4456448
  buffer_load_dwordx4 v8, s[24:27], s54 offen  lds
  s_add_u32 m0, s57, 61440
  s_add_u32 s54, s78, 4587520
  buffer_load_dwordx4 v8, s[24:27], s54 offen  lds
  v_add_u32 v15, 147456, v11
  v_add_u32 v16, 147456, v12
  ds_read_b64_tr_b16 a[96:97], v15 offset:0
  ds_read_b64_tr_b16 a[98:99], v15 offset:512
  ds_read_b64_tr_b16 a[100:101], v15 offset:8192
  ds_read_b64_tr_b16 a[102:103], v15 offset:8704
  ds_read_b64_tr_b16 a[104:105], v16 offset:0
  ds_read_b64_tr_b16 a[106:107], v16 offset:512
  ds_read_b64_tr_b16 a[108:109], v16 offset:8192
  ds_read_b64_tr_b16 a[110:111], v16 offset:8704
  s_waitcnt vmcnt(13) lgkmcnt(0)
  s_barrier
  s_add_u32 m0, s57, 65536
  s_add_u32 s54, s79, 73728
  buffer_load_dwordx4 v10, s[28:31], s54 offen  lds
  s_add_u32 m0, s57, 69632
  s_add_u32 s54, s79, 82944
  buffer_load_dwordx4 v10, s[28:31], s54 offen  lds
  s_add_u32 m0, s57, 73728
  s_add_u32 s54, s79, 110592
  buffer_load_dwordx4 v10, s[28:31], s54 offen  lds
  s_add_u32 m0, s57, 77824
  s_add_u32 s54, s79, 119808
  buffer_load_dwordx4 v10, s[28:31], s54 offen  lds
  v_add_u32 v15, 16384, v11
  v_add_u32 v16, 16384, v12
  ds_read_b64_tr_b16 a[112:113], v15 offset:0
  ds_read_b64_tr_b16 a[114:115], v15 offset:512
  ds_read_b64_tr_b16 a[116:117], v15 offset:8192
  ds_read_b64_tr_b16 a[118:119], v15 offset:8704
  ds_read_b64_tr_b16 a[120:121], v16 offset:0
  ds_read_b64_tr_b16 a[122:123], v16 offset:512
  ds_read_b64_tr_b16 a[124:125], v16 offset:8192
  ds_read_b64_tr_b16 a[126:127], v16 offset:8704
  s_waitcnt vmcnt(12) lgkmcnt(0)
  s_barrier
  s_add_u32 m0, s57, 81920
  s_add_u32 s54, s79, 256
  buffer_load_dwordx4 v10, s[28:31], s54 offen  lds
  s_add_u32 m0, s57, 86016
  s_add_u32 s54, s79, 9472
  buffer_load_dwordx4 v10, s[28:31], s54 offen  lds
  s_add_u32 m0, s57, 90112
  s_add_u32 s54, s79, 37120
  buffer_load_dwordx4 v10, s[28:31], s54 offen  lds
  s_add_u32 m0, s57, 94208
  s_add_u32 s54, s79, 46336
  buffer_load_dwordx4 v10, s[28:31], s54 offen  lds
  v_add_u32 v15, 32768, v11
  v_add_u32 v16, 32768, v12
  ds_read_b64_tr_b16 a[128:129], v15 offset:0
  ds_read_b64_tr_b16 a[130:131], v15 offset:512
  ds_read_b64_tr_b16 a[132:133], v15 offset:8192
  ds_read_b64_tr_b16 a[134:135], v15 offset:8704
  ds_read_b64_tr_b16 a[136:137], v16 offset:0
  ds_read_b64_tr_b16 a[138:139], v16 offset:512
  ds_read_b64_tr_b16 a[140:141], v16 offset:8192
  ds_read_b64_tr_b16 a[142:143], v16 offset:8704
  s_waitcnt vmcnt(12) lgkmcnt(0)
  s_barrier
  s_add_u32 m0, s57, 98304
  s_add_u32 s54, s79, 512
  buffer_load_dwordx4 v10, s[28:31], s54 offen  lds
  s_add_u32 m0, s57, 102400
  s_add_u32 s54, s79, 9728
  buffer_load_dwordx4 v10, s[28:31], s54 offen  lds
  s_add_u32 m0, s57, 106496
  s_add_u32 s54, s79, 37376
  buffer_load_dwordx4 v10, s[28:31], s54 offen  lds
  s_add_u32 m0, s57, 110592
  s_add_u32 s54, s79, 46592
  buffer_load_dwordx4 v10, s[28:31], s54 offen  lds
  s_getpc_b64 s[80:81]
  v_lshlrev_b32 v7, 2, v76
  global_load_dword v19, v7, s[80:81] offset:1024
  v_add_u32 v15, 49152, v11
  v_add_u32 v16, 49152, v12
  ds_read_b64_tr_b16 a[144:145], v15 offset:0
  ds_read_b64_tr_b16 a[146:147], v15 offset:512
  ds_read_b64_tr_b16 a[148:149], v15 offset:8192
  ds_read_b64_tr_b16 a[150:151], v15 offset:8704
  ds_read_b64_tr_b16 a[152:153], v16 offset:0
  ds_read_b64_tr_b16 a[154:155], v16 offset:512
  ds_read_b64_tr_b16 a[156:157], v16 offset:8192
  ds_read_b64_tr_b16 a[158:159], v16 offset:8704
  s_waitcnt vmcnt(13) lgkmcnt(0)
  s_barrier
  s_add_u32 m0, s57, 114688
  s_add_u32 s54, s79, 74240
  buffer_load_dwordx4 v10, s[28:31], s54 offen  lds
  s_add_u32 m0, s57, 118784
  s_add_u32 s54, s79, 83456
  buffer_load_dwordx4 v10, s[28:31], s54 offen  lds
  s_add_u32 m0, s57, 122880
  s_add_u32 s54, s79, 111104
  buffer_load_dwordx4 v10, s[28:31], s54 offen  lds
  s_add_u32 m0, s57, 126976
  s_add_u32 s54, s79, 120320
  buffer_load_dwordx4 v10, s[28:31], s54 offen  lds
  v_add_u32 v15, 65536, v11
  v_add_u32 v16, 65536, v12
  ds_read_b64_tr_b16 a[160:161], v15 offset:0
  ds_read_b64_tr_b16 a[162:163], v15 offset:512
  ds_read_b64_tr_b16 a[164:165], v15 offset:8192
  ds_read_b64_tr_b16 a[166:167], v15 offset:8704
  ds_read_b64_tr_b16 a[168:169], v16 offset:0
  ds_read_b64_tr_b16 a[170:171], v16 offset:512
  ds_read_b64_tr_b16 a[172:173], v16 offset:8192
  ds_read_b64_tr_b16 a[174:175], v16 offset:8704
  s_waitcnt vmcnt(13) lgkmcnt(0)
  s_barrier
  s_add_u32 m0, s57, 131072
  s_add_u32 s54, s79, 74496
  buffer_load_dwordx4 v10, s[28:31], s54 offen  lds
  s_add_u32 m0, s57, 135168
  s_add_u32 s54, s79, 83712
  buffer_load_dwordx4 v10, s[28:31], s54 offen  lds
  s_add_u32 m0, s57, 139264
  s_add_u32 s54, s79, 111360
  buffer_load_dwordx4 v10, s[28:31], s54 offen  lds
  s_add_u32 m0, s57, 143360
  s_add_u32 s54, s79, 120576
  buffer_load_dwordx4 v10, s[28:31], s54 offen  lds
  v_add_u32 v15, 81920, v14
  ds_read_b64_tr_b16 a[176:177], v15 offset:0
  ds_read_b64_tr_b16 a[178:179], v15 offset:1024
  ds_read_b64_tr_b16 a[180:181], v15 offset:4096
  ds_read_b64_tr_b16 a[182:183], v15 offset:5120
  ds_read_b64_tr_b16 a[184:185], v15 offset:8192
  ds_read_b64_tr_b16 a[186:187], v15 offset:9216
  ds_read_b64_tr_b16 a[188:189], v15 offset:12288
  ds_read_b64_tr_b16 a[190:191], v15 offset:13312
  s_waitcnt vmcnt(13) lgkmcnt(0)
  s_barrier
  s_add_u32 m0, s57, 0
  s_add_u32 s54, s78, 0
  buffer_load_dwordx4 v8, s[20:23], s54 offen  lds
  s_add_u32 m0, s57, 4096
  s_add_u32 s54, s78, 131072
  buffer_load_dwordx4 v8, s[20:23], s54 offen  lds
  s_add_u32 m0, s57, 8192
  s_add_u32 s54, s78, 262144
  buffer_load_dwordx4 v8, s[20:23], s54 offen  lds
  s_add_u32 m0, s57, 12288
  s_add_u32 s54, s78, 393216
  buffer_load_dwordx4 v8, s[20:23], s54 offen  lds
  v_add_u32 v15, 98304, v14
  ds_read_b64_tr_b16 a[192:193], v15 offset:0
  ds_read_b64_tr_b16 a[194:195], v15 offset:1024
  ds_read_b64_tr_b16 a[196:197], v15 offset:4096
  ds_read_b64_tr_b16 a[198:199], v15 offset:5120
  ds_read_b64_tr_b16 a[200:201], v15 offset:8192
  ds_read_b64_tr_b16 a[202:203], v15 offset:9216
  ds_read_b64_tr_b16 a[204:205], v15 offset:12288
  ds_read_b64_tr_b16 a[206:207], v15 offset:13312
  s_waitcnt vmcnt(13) lgkmcnt(0)
  s_barrier
  s_add_u32 m0, s57, 16384
  s_add_u32 s54, s78, 524288
  buffer_load_dwordx4 v8, s[20:23], s54 offen  lds
  s_add_u32 m0, s57, 20480
  s_add_u32 s54, s78, 655360
  buffer_load_dwordx4 v8, s[20:23], s54 offen  lds
  s_add_u32 m0, s57, 24576
  s_add_u32 s54, s78, 786432
  buffer_load_dwordx4 v8, s[20:23], s54 offen  lds
  s_add_u32 m0, s57, 28672
  s_add_u32 s54, s78, 917504
  buffer_load_dwordx4 v8, s[20:23], s54 offen  lds
  v_add_u32 v15, 114688, v14
  ds_read_b64_tr_b16 a[208:209], v15 offset:0
  ds_read_b64_tr_b16 a[210:211], v15 offset:1024
  ds_read_b64_tr_b16 a[212:213], v15 offset:4096
  ds_read_b64_tr_b16 a[214:215], v15 offset:5120
  ds_read_b64_tr_b16 a[216:217], v15 offset:8192
  ds_read_b64_tr_b16 a[218:219], v15 offset:9216
  ds_read_b64_tr_b16 a[220:221], v15 offset:12288
  ds_read_b64_tr_b16 a[222:223], v15 offset:13312
  s_waitcnt vmcnt(12) lgkmcnt(0)
  s_barrier
  s_add_u32 m0, s57, 32768
  s_add_u32 s54, s78, 2097152
  buffer_load_dwordx4 v8, s[20:23], s54 offen  lds
  s_add_u32 m0, s57, 36864
  s_add_u32 s54, s78, 2228224
  buffer_load_dwordx4 v8, s[20:23], s54 offen  lds
  s_add_u32 m0, s57, 40960
  s_add_u32 s54, s78, 2359296
  buffer_load_dwordx4 v8, s[20:23], s54 offen  lds
  s_add_u32 m0, s57, 45056
  s_add_u32 s54, s78, 2490368
  buffer_load_dwordx4 v8, s[20:23], s54 offen  lds
  v_add_u32 v15, 131072, v14
  ds_read_b64_tr_b16 a[224:225], v15 offset:0
  ds_read_b64_tr_b16 a[226:227], v15 offset:1024
  ds_read_b64_tr_b16 a[228:229], v15 offset:4096
  ds_read_b64_tr_b16 a[230:231], v15 offset:5120
  ds_read_b64_tr_b16 a[232:233], v15 offset:8192
  ds_read_b64_tr_b16 a[234:235], v15 offset:9216
  ds_read_b64_tr_b16 a[236:237], v15 offset:12288
  ds_read_b64_tr_b16 a[238:239], v15 offset:13312
  s_waitcnt vmcnt(12) lgkmcnt(0)
  s_barrier
  s_add_u32 m0, s57, 49152
  s_add_u32 s54, s78, 3145728
  buffer_load_dwordx4 v8, s[16:19], s54 offen  lds
  s_add_u32 m0, s57, 53248
  s_add_u32 s54, s78, 3276800
  buffer_load_dwordx4 v8, s[16:19], s54 offen  lds
  s_add_u32 m0, s57, 57344
  s_add_u32 s54, s78, 3407872
  buffer_load_dwordx4 v8, s[16:19], s54 offen  lds
  s_add_u32 m0, s57, 61440
  s_add_u32 s54, s78, 3538944
  buffer_load_dwordx4 v8, s[16:19], s54 offen  lds
  v_add_u32 v15, 147456, v14
  ds_read_b64_tr_b16 a[240:241], v15 offset:0
  ds_read_b64_tr_b16 a[242:243], v15 offset:1024
  ds_read_b64_tr_b16 a[244:245], v15 offset:4096
  ds_read_b64_tr_b16 a[246:247], v15 offset:5120
  ds_read_b64_tr_b16 a[248:249], v15 offset:8192
  ds_read_b64_tr_b16 a[250:251], v15 offset:9216
  ds_read_b64_tr_b16 a[252:253], v15 offset:12288
  ds_read_b64_tr_b16 a[254:255], v15 offset:13312
  s_waitcnt vmcnt(12) lgkmcnt(0)
  s_barrier
  s_add_u32 m0, s57, 65536
  s_add_u32 s54, s78, 2621440
  buffer_load_dwordx4 v8, s[20:23], s54 offen  lds
  s_add_u32 m0, s57, 69632
  s_add_u32 s54, s78, 2752512
  buffer_load_dwordx4 v8, s[20:23], s54 offen  lds
  s_add_u32 m0, s57, 73728
  s_add_u32 s54, s78, 2883584
  buffer_load_dwordx4 v8, s[20:23], s54 offen  lds
  s_add_u32 m0, s57, 77824
  s_add_u32 s54, s78, 3014656
  buffer_load_dwordx4 v8, s[20:23], s54 offen  lds
  v_add_u32 v15, 16384, v11
  v_add_u32 v16, 16384, v12
  ds_read_b64_tr_b16 v[52:53], v15 offset:0
  ds_read_b64_tr_b16 v[54:55], v15 offset:512
  ds_read_b64_tr_b16 v[56:57], v15 offset:8192
  ds_read_b64_tr_b16 v[58:59], v15 offset:8704
  ds_read_b64_tr_b16 v[60:61], v16 offset:0
  ds_read_b64_tr_b16 v[62:63], v16 offset:512
  ds_read_b64_tr_b16 v[64:65], v16 offset:8192
  ds_read_b64_tr_b16 v[66:67], v16 offset:8704
  s_waitcnt vmcnt(12) lgkmcnt(0)
  s_barrier
  s_lshl_b32 s54, s52, 12
  s_add_u32 s54, s54, 16384
  v_add_u32 v7, s54, v76
  ds_write_b128 v7, v[52:55] offset:0
  ds_write_b128 v7, v[56:59] offset:1024
  ds_write_b128 v7, v[60:63] offset:2048
  ds_write_b128 v7, v[64:67] offset:3072
  s_add_u32 m0, s57, 81920
  s_add_u32 s54, s79, 1024
  buffer_load_dwordx4 v9, s[28:31], s54 offen  lds
  s_add_u32 m0, s57, 86016
  s_add_u32 s54, s79, 37888
  buffer_load_dwordx4 v9, s[28:31], s54 offen  lds
  s_add_u32 m0, s57, 90112
  s_add_u32 s54, s79, 74752
  buffer_load_dwordx4 v9, s[28:31], s54 offen  lds
  s_add_u32 m0, s57, 94208
  s_add_u32 s54, s79, 111616
  buffer_load_dwordx4 v9, s[28:31], s54 offen  lds
  v_add_u32 v15, 32768, v11
  v_add_u32 v16, 32768, v12
  ds_read_b64_tr_b16 v[36:37], v15 offset:0
  ds_read_b64_tr_b16 v[38:39], v15 offset:512
  ds_read_b64_tr_b16 v[40:41], v15 offset:8192
  ds_read_b64_tr_b16 v[42:43], v15 offset:8704
  ds_read_b64_tr_b16 v[44:45], v16 offset:0
  ds_read_b64_tr_b16 v[46:47], v16 offset:512
  ds_read_b64_tr_b16 v[48:49], v16 offset:8192
  ds_read_b64_tr_b16 v[50:51], v16 offset:8704
  s_waitcnt vmcnt(12) lgkmcnt(0)
  s_barrier
  s_lshl_b32 s54, s52, 12
  s_add_u32 s54, s54, 32768
  v_add_u32 v7, s54, v76
  ds_write_b128 v7, v[36:39] offset:0
  ds_write_b128 v7, v[40:43] offset:1024
  ds_write_b128 v7, v[44:47] offset:2048
  ds_write_b128 v7, v[48:51] offset:3072
  s_add_u32 m0, s57, 98304
  s_add_u32 s54, s79, 0
  buffer_load_dwordx4 v10, s[28:31], s54 offen  lds
  s_add_u32 m0, s57, 102400
  s_add_u32 s54, s79, 9216
  buffer_load_dwordx4 v10, s[28:31], s54 offen  lds
  s_add_u32 m0, s57, 106496
  s_add_u32 s54, s79, 36864
  buffer_load_dwordx4 v10, s[28:31], s54 offen  lds
  s_add_u32 m0, s57, 110592
  s_add_u32 s54, s79, 46080
  buffer_load_dwordx4 v10, s[28:31], s54 offen  lds
  v_add_u32 v15, 49152, v11
  v_add_u32 v16, 49152, v12
  ds_read_b64_tr_b16 v[52:53], v15 offset:0
  ds_read_b64_tr_b16 v[54:55], v15 offset:512
  ds_read_b64_tr_b16 v[56:57], v15 offset:8192
  ds_read_b64_tr_b16 v[58:59], v15 offset:8704
  ds_read_b64_tr_b16 v[60:61], v16 offset:0
  ds_read_b64_tr_b16 v[62:63], v16 offset:512
  ds_read_b64_tr_b16 v[64:65], v16 offset:8192
  ds_read_b64_tr_b16 v[66:67], v16 offset:8704
  s_waitcnt vmcnt(12) lgkmcnt(0)
  s_barrier
  s_lshl_b32 s54, s52, 12
  s_add_u32 s54, s54, 49152
  v_add_u32 v7, s54, v76
  ds_write_b128 v7, v[52:55] offset:0
  ds_write_b128 v7, v[56:59] offset:1024
  ds_write_b128 v7, v[60:63] offset:2048
  ds_write_b128 v7, v[64:67] offset:3072
  s_add_u32 m0, s57, 114688
  s_add_u32 s54, s79, 73984
  buffer_load_dwordx4 v10, s[28:31], s54 offen  lds
  s_add_u32 m0, s57, 118784
  s_add_u32 s54, s79, 83200
  buffer_load_dwordx4 v10, s[28:31], s54 offen  lds
  s_add_u32 m0, s57, 122880
  s_add_u32 s54, s79, 110848
  buffer_load_dwordx4 v10, s[28:31], s54 offen  lds
  s_add_u32 m0, s57, 126976
  s_add_u32 s54, s79, 120064
  buffer_load_dwordx4 v10, s[28:31], s54 offen  lds
  v_add_u32 v15, 65536, v11
  v_add_u32 v16, 65536, v12
  ds_read_b64_tr_b16 v[36:37], v15 offset:0
  ds_read_b64_tr_b16 v[38:39], v15 offset:512
  ds_read_b64_tr_b16 v[40:41], v15 offset:8192
  ds_read_b64_tr_b16 v[42:43], v15 offset:8704
  ds_read_b64_tr_b16 v[44:45], v16 offset:0
  ds_read_b64_tr_b16 v[46:47], v16 offset:512
  ds_read_b64_tr_b16 v[48:49], v16 offset:8192
  ds_read_b64_tr_b16 v[50:51], v16 offset:8704
  s_waitcnt vmcnt(12) lgkmcnt(0)
  s_barrier
  s_lshl_b32 s54, s52, 12
  s_add_u32 s54, s54, 65536
  v_add_u32 v7, s54, v76
  ds_write_b128 v7, v[36:39] offset:0
  ds_write_b128 v7, v[40:43] offset:1024
  ds_write_b128 v7, v[44:47] offset:2048
  ds_write_b128 v7, v[48:51] offset:3072
  s_add_u32 m0, s57, 131072
  s_add_u32 s54, s79, 768
  buffer_load_dwordx4 v10, s[28:31], s54 offen  lds
  s_add_u32 m0, s57, 135168
  s_add_u32 s54, s79, 9984
  buffer_load_dwordx4 v10, s[28:31], s54 offen  lds
  s_add_u32 m0, s57, 139264
  s_add_u32 s54, s79, 37632
  buffer_load_dwordx4 v10, s[28:31], s54 offen  lds
  s_add_u32 m0, s57, 143360
  s_add_u32 s54, s79, 46848
  buffer_load_dwordx4 v10, s[28:31], s54 offen  lds
  v_lshlrev_b32 v7, 3, v76
  s_lshl_b32 s54, s52, 13
  s_add_u32 s54, s54, 360448
  s_bitcmp1_b32 s52, 0
  s_cselect_b64 exec, 0xff, -1
  buffer_load_dword v35, v7, s[8:11], s54 offen sc1
  s_mov_b64 exec, -1
  s_getpc_b64 s[80:81]
C_pc:
  s_mov_b32 s55, (L_w0 - C_pc)
  s_cmp_eq_u32 s52, 1
  s_cselect_b32 s55, (L_w1 - C_pc), s55
  s_cmp_eq_u32 s52, 2
  s_cselect_b32 s55, (L_w2 - C_pc), s55
  s_cmp_eq_u32 s52, 3
  s_cselect_b32 s55, (L_w3 - C_pc), s55
  v_lshl_add_u32 v7, v76, 3, s55
  global_load_dword v35, v7, s[80:81]
  v_add_u32 v15, 81920, v11
  v_add_u32 v16, 81920, v12
  ds_read_b64_tr_b16 v[52:53], v15 offset:0
  ds_read_b64_tr_b16 v[54:55], v15 offset:512
  ds_read_b64_tr_b16 v[56:57], v15 offset:8192
  ds_read_b64_tr_b16 v[58:59], v15 offset:8704
  ds_read_b64_tr_b16 v[60:61], v16 offset:0
  ds_read_b64_tr_b16 v[62:63], v16 offset:512
  ds_read_b64_tr_b16 v[64:65], v16 offset:8192
  ds_read_b64_tr_b16 v[66:67], v16 offset:8704
  s_waitcnt vmcnt(14) lgkmcnt(0)
  s_barrier
  s_lshl_b32 s54, s52, 12
  s_add_u32 s54, s54, 81920
  v_add_u32 v7, s54, v76
  ds_write_b128 v7, v[52:55] offset:0
  ds_write_b128 v7, v[56:59] offset:1024
  ds_write_b128 v7, v[60:63] offset:2048
  ds_write_b128 v7, v[64:67] offset:3072
  v_lshrrev_b32 v20, 2, v76
  buffer_load_dword v21, v20, s[12:15], 0 offen sc1
  v_add_u32 v15, 98304, v13
  s_waitcnt lgkmcnt(0)
  ds_read_b64_tr_b16 v[36:37], v15 offset:0
  ds_read_b64_tr_b16 v[38:39], v15 offset:1024
  ds_read_b64_tr_b16 v[40:41], v15 offset:2048
  ds_read_b64_tr_b16 v[42:43], v15 offset:3072
  ds_read_b64_tr_b16 v[44:45], v15 offset:4096
  ds_read_b64_tr_b16 v[46:47], v15 offset:5120
  ds_read_b64_tr_b16 v[48:49], v15 offset:6144
  ds_read_b64_tr_b16 v[50:51], v15 offset:7168
  ds_read_b64_tr_b16 v[52:53], v15 offset:8192
  ds_read_b64_tr_b16 v[54:55], v15 offset:9216
  ds_read_b64_tr_b16 v[56:57], v15 offset:10240
  ds_read_b64_tr_b16 v[58:59], v15 offset:11264
  ds_read_b64_tr_b16 v[60:61], v15 offset:12288
  ds_read_b64_tr_b16 v[62:63], v15 offset:13312
  ds_read_b64_tr_b16 v[64:65], v15 offset:14336
  ds_read_b64_tr_b16 v[66:67], v15 offset:15360
  s_waitcnt vmcnt(11) lgkmcnt(0)
  s_barrier
  s_and_b32 s54, s52, 1
  s_lshl_b32 s54, s54, 13
  s_add_u32 s54, s54, 98304
  v_add_u32 v7, s54, v76
  ds_write_b128 v7, v[36:39] offset:0
  ds_write_b128 v7, v[40:43] offset:1024
  ds_write_b128 v7, v[44:47] offset:2048
  ds_write_b128 v7, v[48:51] offset:3072
  ds_write_b128 v7, v[52:55] offset:4096
  ds_write_b128 v7, v[56:59] offset:5120
  ds_write_b128 v7, v[60:63] offset:6144
  ds_write_b128 v7, v[64:67] offset:7168
  v_add_u32 v15, 114688, v14
  ds_read_b64_tr_b16 v[52:53], v15 offset:0
  ds_read_b64_tr_b16 v[54:55], v15 offset:1024
  ds_read_b64_tr_b16 v[56:57], v15 offset:4096
  ds_read_b64_tr_b16 v[58:59], v15 offset:5120
  ds_read_b64_tr_b16 v[60:61], v15 offset:8192
  ds_read_b64_tr_b16 v[62:63], v15 offset:9216
  ds_read_b64_tr_b16 v[64:65], v15 offset:12288
  ds_read_b64_tr_b16 v[66:67], v15 offset:13312
  s_waitcnt vmcnt(7) lgkmcnt(0)
  s_barrier
  s_lshl_b32 s54, s52, 12
  s_add_u32 s54, s54, 114688
  v_add_u32 v7, s54, v76
  ds_write_b128 v7, v[52:55] offset:0
  ds_write_b128 v7, v[56:59] offset:1024
  ds_write_b128 v7, v[60:63] offset:2048
  ds_write_b128 v7, v[64:67] offset:3072
  v_add_u32 v15, 131072, v14
  ds_read_b64_tr_b16 v[36:37], v15 offset:0
  ds_read_b64_tr_b16 v[38:39], v15 offset:1024
  ds_read_b64_tr_b16 v[40:41], v15 offset:4096
  ds_read_b64_tr_b16 v[42:43], v15 offset:5120
  ds_read_b64_tr_b16 v[44:45], v15 offset:8192
  ds_read_b64_tr_b16 v[46:47], v15 offset:9216
  ds_read_b64_tr_b16 v[48:49], v15 offset:12288
  ds_read_b64_tr_b16 v[50:51], v15 offset:13312
  s_waitcnt vmcnt(3) lgkmcnt(0)
  s_barrier
  s_lshl_b32 s54, s52, 12
  s_add_u32 s54, s54, 131072
  v_add_u32 v7, s54, v76
  ds_write_b128 v7, v[36:39] offset:0
  ds_write_b128 v7, v[40:43] offset:1024
  ds_write_b128 v7, v[44:47] offset:2048
  ds_write_b128 v7, v[48:51] offset:3072
  v_add_u32 v15, 147456, v14
  ds_read_b64_tr_b16 v[52:53], v15 offset:0
  ds_read_b64_tr_b16 v[54:55], v15 offset:1024
  ds_read_b64_tr_b16 v[56:57], v15 offset:4096
  ds_read_b64_tr_b16 v[58:59], v15 offset:5120
  ds_read_b64_tr_b16 v[60:61], v15 offset:8192
  ds_read_b64_tr_b16 v[62:63], v15 offset:9216
  ds_read_b64_tr_b16 v[64:65], v15 offset:12288
  ds_read_b64_tr_b16 v[66:67], v15 offset:13312
  s_waitcnt vmcnt(0) lgkmcnt(0)
  s_barrier
  s_lshl_b32 s54, s52, 12
  s_add_u32 s54, s54, 147456
  v_add_u32 v7, s54, v76
  ds_write_b128 v7, v[52:55] offset:0
  ds_write_b128 v7, v[56:59] offset:1024
  ds_write_b128 v7, v[60:63] offset:2048
  ds_write_b128 v7, v[64:67] offset:3072
  s_waitcnt lgkmcnt(0)
  s_branch C_rd1
C_rd0:
  s_sleep 2
  buffer_load_dword v21, v20, s[12:15], 0 offen sc1
  s_waitcnt vmcnt(0)
C_rd1:
  v_and_b32 v22, 0xff, v21
  v_cmp_gt_u32 vcc, 7, v22
  v_readlane_b32 s56, v21, 0
  s_mov_b32 s3, 1
  s_add_u32 s67, s67, 1
  s_cmp_ge_u32 s67, 131072
  s_cbranch_scc1 C_rd2
  s_cmp_lg_u32 vcc_hi, 0
  s_cbranch_scc1 C_rd0
  s_mov_b32 s3, 0
  s_cmp_eq_u32 s56, -1
  s_cbranch_scc1 C_rd2
  s_mov_b32 s3, 1
  v_readlane_b32 s54, v21, 10
  v_readlane_b32 s55, v21, 0
  s_nop 0
  s_bcnt1_i32_b32 s55, s55
  s_add_u32 s54, s54, s55
  v_readlane_b32 s55, v21, 1
  s_nop 0
  s_bcnt1_i32_b32 s55, s55
  s_add_u32 s54, s54, s55
  v_readlane_b32 s55, v21, 2
  s_nop 0
  s_bcnt1_i32_b32 s55, s55
  s_add_u32 s54, s54, s55
  v_readlane_b32 s55, v21, 3
  s_nop 0
  s_bcnt1_i32_b32 s55, s55
  s_add_u32 s54, s54, s55
  v_readlane_b32 s55, v21, 4
  s_nop 0
  s_bcnt1_i32_b32 s55, s55
  s_add_u32 s54, s54, s55
  v_readlane_b32 s55, v21, 5
  s_nop 0
  s_bcnt1_i32_b32 s55, s55
  s_add_u32 s54, s54, s55
  v_readlane_b32 s55, v21, 6
  s_nop 0
  s_bcnt1_i32_b32 s55, s55
  s_add_u32 s54, s54, s55
  v_readlane_b32 s55, v21, 7
  s_nop 0
  s_bcnt1_i32_b32 s55, s55
  s_add_u32 s54, s54, s55
  s_cmp_lt_u32 s54, 256
  s_cbranch_scc1 C_rd0
C_rd2:
  s_lshl_b32 s54, s3, 2
  s_add_u32 s54, s54, s52
  s_cmp_eq_u32 s54, 1
  s_cbranch_scc1 L_w1
  s_cmp_eq_u32 s54, 2
  s_cbranch_scc1 L_w2
  s_cmp_eq_u32 s54, 3
  s_cbranch_scc1 L_w3
  s_cmp_eq_u32 s54, 4
  s_cbranch_scc1 L_w4
  s_cmp_eq_u32 s54, 5
  s_cbranch_scc1 L_w5
  s_cmp_eq_u32 s54, 6
  s_cbranch_scc1 L_w6
  s_cmp_eq_u32 s54, 7
  s_cbranch_scc1 L_w7
L_w0:
  v_mov_b64 v[20:21], 0
  v_mov_b64 v[22:23], 0
  v_mov_b64 v[24:25], 0
  v_mov_b64 v[26:27], 0
  v_mov_b64 v[28:29], 0
  v_mov_b64 v[30:31], 0
  v_mov_b64 v[32:33], 0
  v_mov_b64 v[34:35], 0
  s_mov_b32 s78, 0x3f803f80
  s_mov_b32 s79, s78
  s_mov_b32 s65, 360448
  s_mov_b32 m0, 16128
  s_lshl_b32 s71, s53, 2
  s_add_u32 s71, s71, 128
  s_movk_i32 s56, 0x1000
  v_lshlrev_b32 v73, 2, v76
  v_mov_b32 v72, 0
  s_mov_b64 s[16:17], s[8:9]
  s_mov_b32 s18, 268435456
  s_mov_b32 s19, 0x20000
  s_getpc_b64 s[20:21]
Cf0_pc:
  s_add_u32 s20, s20, (Cf0_last - Cf0_pc)
  s_addc_u32 s21, s21, 0
  v_mov_b32 v68, 14880
  buffer_load_dwordx4 v[52:55], v76, s[8:11], s59 offen offset:0 sc1
  buffer_load_dwordx4 v[56:59], v76, s[8:11], s59 offen offset:1024 sc1
  ds_read_b128 v[36:39], v76 offset:16384
  ds_read_b128 v[40:43], v76 offset:17408
  ds_read_b128 v[60:63], v76 offset:18432
  ds_read_b128 v[64:67], v76 offset:19456
  ds_read_b128 v[0:3], v76 offset:4608
  ds_read_b128 v[4:7], v76 offset:5632
  ds_read_b128 v[8:11], v76 offset:6656
  ds_read_b128 v[12:15], v76 offset:7680
  s_waitcnt lgkmcnt(0)
  s_cmp_eq_u32 s66, 1
  s_branch Cf0_top2
.p2align 6
Cf0_h2:
  s_cmp_eq_u32 s66, 12
  s_cselect_b32 s56, s71, 0x1000
  ds_read_b32 v72, v76 offset:16128
  s_cmp_eq_u32 s66, 13
  s_cselect_b32 s54, 0x700, 0
  s_waitcnt lgkmcnt(0)
  v_readfirstlane_b32 s57, v72
  s_nop 0
  s_cmp_lt_u32 s57, s54
  s_cbranch_scc1 Cf0_kv3
Cf0_kvb:
  buffer_load_dwordx4 v[0:3], v76, s[8:11], s65 offen offset:0 sc1
  ds_read_b128 v[36:39], v76 offset:16384
  s_waitcnt lgkmcnt(0)
  v_mov_b64 v[20:21], 0
  v_mov_b64 v[22:23], 0
  v_mov_b64 v[24:25], 0
  v_mov_b64 v[26:27], 0
  v_mov_b32 v68, 14880
  buffer_load_dwordx4 v[0:3], v76, s[8:11], s65 offen offset:0 sc1
  ds_read_b128 v[40:43], v76 offset:17408
  s_waitcnt lgkmcnt(0)
  s_cmp_eq_u32 s66, 62
  s_cselect_b64 s[16:17], s[20:21], s[16:17]
  s_cselect_b32 s18, (Cf0_done - Cf0_last), s18
  s_cselect_b32 s70, 0, s70
  s_cmp_eq_u32 s66, 63
  s_cselect_b32 s59, 268435456, s59
  s_cselect_b32 s58, 268435456, s58
  buffer_load_dwordx4 v[0:3], v76, s[8:11], s65 offen offset:0 sc1
  ds_read_b128 v[60:63], v76 offset:18432
  s_waitcnt lgkmcnt(0)
  v_lshlrev_b32 v73, 2, v76
  buffer_load_dwordx4 v[52:55], v76, s[8:11], s59 offen offset:0 sc1
  buffer_load_dwordx4 v[56:59], v76, s[8:11], s59 offen offset:1024 sc1
  s_waitcnt vmcnt(4)
  v_max3_u32 v72, v0, v1, v2
  v_max_u32 v72, v72, v3
  ds_write_b128 v76, v[0:3] offset:4608
  v_cmp_eq_u32 vcc, -1, v72
  s_cbranch_vccnz Cf0_h2r
Cf0_h2w:
  s_cmp_eq_u32 s66, 63
  s_waitcnt lgkmcnt(0)
  s_barrier
  ds_read_b128 v[8:11], v76 offset:6656
  buffer_load_dwordx4 v76, s[8:11], s85 offen offset:0 sc1 lds
Cf0_top2:
  v_smfmac_f32_16x16x64_bf16 v[20:23], v[0:3], v[80:87], v74
  s_cbranch_scc1 Cf0_last
  v_smfmac_f32_16x16x64_bf16 v[28:31], v[0:3], v[36:43], v74
  buffer_load_dwordx4 v[44:47], v76, s[8:11], s58 offen offset:0 sc1
  s_mov_b32 m0, 16128
  v_smfmac_f32_16x16x64_bf16 v[24:27], v[0:3], v[88:95], v74
  buffer_load_dwordx4 v[48:51], v76, s[8:11], s58 offen offset:1024 sc1
  v_smfmac_f32_16x16x64_bf16 v[32:35], v[0:3], v[60:67], v74
  ds_read_b128 v[4:7], v76 offset:5632
  s_waitcnt lgkmcnt(1)
  v_smfmac_f32_16x16x64_bf16 v[20:23], v[8:11], v[112:119], v74
  ds_read_b128 v[12:15], v76 offset:7680
  v_smfmac_f32_16x16x64_bf16 v[24:27], v[8:11], v[120:127], v74
  ds_read_b128 v[36:39], v76 offset:32768
  v_smfmac_f32_16x16x64_bf16 v[28:31], v[8:11], v[208:215], v74
  buffer_store_dwordx4 v[16:19], v76, s[8:11], s68 offen sc1
  ds_read_b128 v[40:43], v76 offset:33792
  v_smfmac_f32_16x16x64_bf16 v[32:35], v[8:11], v[216:223], v74
  buffer_load_dword v73, s[16:19], s70 offen lds
  ds_read_b128 v[60:63], v76 offset:34816
  s_waitcnt lgkmcnt(4)
  v_smfmac_f32_16x16x64_bf16 v[20:23], v[4:7], v[96:103], v74
  ds_read_b128 v[64:67], v76 offset:35840
  v_smfmac_f32_16x16x64_bf16 v[24:27], v[4:7], v[104:111], v74
  s_waitcnt vmcnt(5)
  s_waitcnt lgkmcnt(4)
  v_smfmac_f32_16x16x64_bf16 v[20:23], v[12:15], v[128:135], v74
  s_barrier
  ds_read_b128 v[0:3], v76 offset:8704
  s_waitcnt lgkmcnt(3)
  v_smfmac_f32_16x16x64_bf16 v[28:31], v[4:7], v[36:43], v74
  ds_read_b128 v[36:39], v76 offset:49152
  v_smfmac_f32_16x16x64_bf16 v[24:27], v[12:15], v[136:143], v74
  ds_read_b128 v[40:43], v76 offset:50176
  s_waitcnt lgkmcnt(3)
  v_smfmac_f32_16x16x64_bf16 v[32:35], v[4:7], v[60:67], v74
  ds_read_b128 v[8:11], v76 offset:9728
  v_smfmac_f32_16x16x64_bf16 v[28:31], v[12:15], v[224:231], v74
  ds_read_b128 v[60:63], v76 offset:51200
  v_smfmac_f32_16x16x64_bf16 v[32:35], v[12:15], v[232:239], v74
  s_waitcnt vmcnt(4)
  ds_read_b128 v[64:67], v76 offset:52224
  s_waitcnt lgkmcnt(5)
  v_smfmac_f32_16x16x64_bf16 v[20:23], v[0:3], v[144:151], v74
  s_barrier
  ds_read_b128 v[4:7], v76 offset:11776
  s_waitcnt lgkmcnt(4)
  v_smfmac_f32_16x16x64_bf16 v[28:31], v[0:3], v[36:43], v74
  ds_read_b128 v[12:15], v76 offset:12800
  ds_read_b128 v[36:39], v75 offset:0
  v_smfmac_f32_16x16x64_bf16 v[24:27], v[0:3], v[152:159], v74
  ds_read_b128 v[16:19], v76 offset:10752
  s_waitcnt lgkmcnt(6)
  v_smfmac_f32_16x16x64_bf16 v[20:23], v[8:11], v[160:167], v74
  ds_read_b128 v[40:43], v75 offset:1024
  s_waitcnt lgkmcnt(5)
  v_smfmac_f32_16x16x64_bf16 v[32:35], v[0:3], v[60:67], v74
  ds_read_b128 v[60:63], v75 offset:2048
  v_smfmac_f32_16x16x64_bf16 v[24:27], v[8:11], v[168:175], v74
  ds_read_b128 v[64:67], v75 offset:3072
  s_waitcnt lgkmcnt(6)
  v_smfmac_f32_16x16x64_bf16 v[20:23], v[4:7], v[176:183], v74
  buffer_load_dword off, s[12:15], s56 sc1 lds
  s_waitcnt lgkmcnt(5)
  v_smfmac_f32_16x16x64_bf16 v[20:23], v[12:15], v[192:199], v74
  s_waitcnt lgkmcnt(2)
  v_smfmac_f32_16x16x64_bf16 v[20:23], v[16:19], v[36:43], v74
  ds_read_b128 v[36:39], v75 offset:16384
  v_smfmac_f32_16x16x64_bf16 v[24:27], v[4:7], v[184:191], v74
  ds_read_b128 v[40:43], v75 offset:17408
  s_waitcnt lgkmcnt(2)
  v_smfmac_f32_16x16x64_bf16 v[24:27], v[16:19], v[60:67], v74
  ds_read_b128 v[60:63], v75 offset:18432
  v_add_f32 v20, v20, v22
  v_smfmac_f32_16x16x64_bf16 v[24:27], v[12:15], v[200:207], v74
  ds_read_b128 v[64:67], v75 offset:19456
  v_add_f32 v21, v21, v23
  v_smfmac_f32_16x16x64_bf16 v[28:31], v[16:19], v[240:247], v74
  v_mov_b64 v[70:71], s[78:79]
  v_smfmac_f32_16x16x64_bf16 v[28:31], v[4:7], a[0:7], v74
  s_waitcnt lgkmcnt(2)
  v_add_f32 v24, v24, v26
  v_smfmac_f32_16x16x64_bf16 v[28:31], v[8:11], v[36:43], v74
  ds_read_b128 v[36:39], v68
  v_cvt_pk_bf16_f32 v22, v20, v24
  v_smfmac_f32_16x16x64_bf16 v[28:31], v[12:15], a[16:23], v74
  ds_read_b128 v[40:43], v68
  ds_write_b32 v79, v22 offset:0
  s_waitcnt lgkmcnt(3)
  v_add_f32 v25, v25, v27
  v_cvt_pk_bf16_f32 v23, v21, v25
  v_smfmac_f32_16x16x64_bf16 v[32:35], v[8:11], v[60:67], v74
  ds_write_b32 v79, v23 offset:576
  v_cmp_u_f32 vcc, v20, v21
  v_smfmac_f32_16x16x64_bf16 v[32:35], v[16:19], v[248:255], v74
  v_add_f32 v28, v28, v30
  v_smfmac_f32_16x16x64_bf16 v[32:35], v[4:7], a[8:15], v74
  v_add_f32 v29, v29, v31
  v_smfmac_f32_16x16x64_bf16 v[32:35], v[12:15], a[24:31], v74
  s_cbranch_vccnz Cf0_rec
Cf0_recok:
  s_waitcnt lgkmcnt(3)
  v_smfmac_f32_16x16x64_bf16 v[36:39], v[16:19], a[128:135], v74
  s_waitcnt lgkmcnt(0)
  s_barrier
  ds_read_b128 v[60:63], v77
  v_smfmac_f32_16x16x64_bf16 v[40:43], v[16:19], a[136:143], v74
  ds_read_b128 v[64:67], v77 offset:128
  v_add_f32 v32, v32, v34
  v_cvt_pk_bf16_f32 v30, v28, v32
  v_smfmac_f32_16x16x64_bf16 v[36:39], v[0:3], a[96:103], v74
  ds_write_b32 v79, v30 offset:256
  v_add_f32 v33, v33, v35
  v_cvt_pk_bf16_f32 v31, v29, v33
  v_smfmac_f32_16x16x64_bf16 v[40:43], v[0:3], a[104:111], v74
  ds_write_b32 v79, v31 offset:832
  v_xor_b32 v75, 0x8000, v75
  v_smfmac_f32_16x16x64_bf16 v[36:39], v[4:7], a[144:151], v74
  ds_read_b128 v[0:3], v76 offset:4608
  v_mov_b32 v29, 0
  v_smfmac_f32_16x16x64_bf16 v[40:43], v[4:7], a[152:159], v74
  s_waitcnt vmcnt(3) lgkmcnt(3)
  v_mov_b32 v30, 0
  v_mfma_f32_16x16x32_bf16 v[44:47], v[44:47], v[60:63], 0
  ds_read_b128 v[4:7], v76 offset:5632
  s_waitcnt lgkmcnt(2)
  v_mfma_f32_16x16x32_bf16 v[44:47], v[48:51], v[64:67], v[44:47]
  s_barrier
  v_smfmac_f32_16x16x64_bf16 v[36:39], v[8:11], a[112:119], v74
  ds_read_b128 v[20:23], v77 offset:256
  ds_read_b128 v[24:27], v77 offset:384
  v_smfmac_f32_16x16x64_bf16 v[40:43], v[8:11], a[120:127], v74
  ds_read_b128 v[8:11], v76 offset:6656
  v_add_f32_dpp v72, v46, v44 quad_perm:[2,3,0,1] row_mask:0xf bank_mask:0xf
  v_add_f32_dpp v73, v47, v45 quad_perm:[2,3,0,1] row_mask:0xf bank_mask:0xf
  v_smfmac_f32_16x16x64_bf16 v[36:39], v[12:15], a[160:167], v74
  s_waitcnt lgkmcnt(4)
  v_exp_f32_dpp v72, v72 quad_perm:[0,1,0,1] row_mask:0xf bank_mask:0xf
  v_smfmac_f32_16x16x64_bf16 v[40:43], v[12:15], a[168:175], v74
  ds_read_b128 v[12:15], v76 offset:7680
  v_exp_f32_dpp v73, v73 quad_perm:[0,1,0,1] row_mask:0xf bank_mask:0xf
  v_smfmac_f32_16x16x64_bf16 v[36:39], v[0:3], a[32:39], v74
  s_waitcnt lgkmcnt(2)
  v_cvt_pk_bf16_f32 v72, v72, v73
  v_mfma_f32_16x16x32_bf16 v[20:23], v[20:23], v[60:63], 0
  ds_write_b32 v78, v72 offset:512
  v_mov_b64 v[16:17], 0
  v_mfma_f32_16x16x32_bf16 v[20:23], v[24:27], v[64:67], v[20:23]
  ds_read_b128 v[44:47], v75 offset:16384
  v_mov_b64 v[18:19], 0
  v_smfmac_f32_16x16x64_bf16 v[40:43], v[0:3], a[40:47], v74
  ds_read_b128 v[48:51], v75 offset:17408
  v_mov_b64 v[68:69], s[78:79]
  v_smfmac_f32_16x16x64_bf16 v[36:39], v[4:7], a[48:55], v74
  s_waitcnt lgkmcnt(4)
  v_add_f32_dpp v24, v22, v20 quad_perm:[2,3,0,1] row_mask:0xf bank_mask:0xf
  v_add_f32_dpp v25, v23, v21 quad_perm:[2,3,0,1] row_mask:0xf bank_mask:0xf
  v_smfmac_f32_16x16x64_bf16 v[36:39], v[8:11], a[64:71], v74
  s_waitcnt lgkmcnt(2)
  s_barrier
  ds_read_b128 v[32:35], v78 offset:512
  v_smfmac_f32_16x16x64_bf16 v[36:39], v[12:15], a[80:87], v74
  ds_read_b128 v[60:63], v75 offset:18432
  v_mul_f32 v24, s69, v24
  v_smfmac_f32_16x16x64_bf16 v[40:43], v[4:7], a[56:63], v74
  ds_read_b128 v[64:67], v75 offset:19456
  v_mul_f32 v25, s69, v25
  v_smfmac_f32_16x16x64_bf16 v[40:43], v[8:11], a[72:79], v74
  v_exp_f32_dpp v24, v24 quad_perm:[0,1,0,1] row_mask:0xf bank_mask:0xf
  v_smfmac_f32_16x16x64_bf16 v[40:43], v[12:15], a[88:95], v74
  s_waitcnt lgkmcnt(2)
  v_exp_f32_dpp v25, v25 quad_perm:[0,1,0,1] row_mask:0xf bank_mask:0xf
  v_mfma_f32_16x16x32_bf16 v[8:11], v[32:35], v[68:71], 0
  v_add_f32 v36, v36, v38
  v_add_f32 v37, v37, v39
  v_mfma_f32_16x16x32_bf16 v[0:3], v[32:35], v[52:55], 0
  v_add_f32 v40, v40, v42
  v_add_f32 v41, v41, v43
  v_mfma_f32_16x16x32_bf16 v[4:7], v[32:35], v[56:59], 0
  v_cvt_pk_bf16_f32 v28, v24, v25
  v_cvt_pk_bf16_f32 v72, v36, v37
  v_cvt_pk_bf16_f32 v73, v40, v41
  v_mfma_f32_16x16x16_bf16 v[8:11], v[28:29], v[68:69], v[8:11]
  v_cvt_pk_bf16_f32 v31, v24, v25
  v_mov_b64 v[20:21], 0
  v_mfma_f32_16x16x16_bf16 v[0:3], v[28:29], v[72:73], v[0:3]
  ds_read_b128 v[52:55], v75 offset:32768
  v_mov_b64 v[22:23], 0
  v_mfma_f32_16x16x16_bf16 v[4:7], v[30:31], v[72:73], v[4:7]
  v_rcp_f32 v10, v8
  v_rcp_f32 v11, v9
  v_mul_f32 v0, v10, v0
  v_mul_f32 v1, v11, v1
  v_max3_f32 v8, v8, v9, v10
  v_mul_f32 v4, v10, v4
  v_mul_f32 v5, v11, v5
  v_cvt_pk_bf16_f32 v2, v0, v4
  ds_write_b32 v79, v2 offset:8704
  v_cvt_pk_bf16_f32 v3, v1, v5
  ds_write_b32 v79, v3 offset:9280
  ds_read_b128 v[12:15], v78 offset:8704
  v_max_f32 v8, v8, v11
  v_cmp_le_f32 vcc, 1317011456, v8
  v_mov_b64 v[24:25], 0
  v_mov_b64 v[26:27], 0
  ds_read_b128 v[56:59], v75 offset:33792
  s_cbranch_vccnz Cf0_mx
Cf0_mxok:
  s_waitcnt lgkmcnt(2)
  s_barrier
  ds_read_b128 v[0:3], v78 offset:8768
  s_waitcnt lgkmcnt(2)
  v_smfmac_f32_16x16x64_bf16 v[16:19], v[12:15], v[44:51], v74
  ds_read_b128 v[4:7], v78 offset:8832
  v_smfmac_f32_16x16x64_bf16 v[20:23], v[12:15], a[192:199], v74
  ds_read_b128 v[8:11], v78 offset:8896
  v_smfmac_f32_16x16x64_bf16 v[24:27], v[12:15], a[208:215], v74
  ds_read_b128 v[36:39], v75 offset:34816
  s_waitcnt lgkmcnt(3)
  v_smfmac_f32_16x16x64_bf16 v[16:19], v[0:3], v[60:67], v74
  ds_read_b128 v[40:43], v75 offset:35840
  s_waitcnt lgkmcnt(3)
  v_smfmac_f32_16x16x64_bf16 v[16:19], v[4:7], a[176:183], v74
  ds_read_b128 v[68:71], v76 offset:13824
  s_waitcnt lgkmcnt(3)
  v_smfmac_f32_16x16x64_bf16 v[16:19], v[8:11], a[184:191], v74
  ds_read_b128 v[44:47], v75 offset:49152
  v_smfmac_f32_16x16x64_bf16 v[20:23], v[0:3], a[200:207], v74
  ds_read_b128 v[48:51], v75 offset:50176
  v_smfmac_f32_16x16x64_bf16 v[20:23], v[4:7], v[52:59], v74
  ds_read_b128 v[60:63], v75 offset:51200
  s_waitcnt lgkmcnt(4)
  v_cvt_pk_bf16_f32 v16, v16, v17
  v_cvt_pk_bf16_f32 v17, v18, v19
  v_bfi_b32 v16, 1, s72, v16
  v_smfmac_f32_16x16x64_bf16 v[20:23], v[8:11], v[36:43], v74
  s_waitcnt lgkmcnt(3)
  buffer_store_dwordx2 v[16:17], v68, s[8:11], s73 offen
  v_mov_b64 v[32:33], 0
  v_smfmac_f32_16x16x64_bf16 v[24:27], v[0:3], a[216:223], v74
  ds_read_b128 v[64:67], v75 offset:52224
  v_mov_b64 v[34:35], 0
  v_smfmac_f32_16x16x64_bf16 v[24:27], v[4:7], a[224:231], v74
  v_cvt_pk_bf16_f32 v20, v20, v21
  v_cvt_pk_bf16_f32 v21, v22, v23
  v_bfi_b32 v20, 1, s72, v20
  v_smfmac_f32_16x16x64_bf16 v[24:27], v[8:11], a[232:239], v74
  buffer_store_dwordx2 v[20:21], v68, s[8:11], s74 offen
  s_waitcnt lgkmcnt(2)
  v_smfmac_f32_16x16x64_bf16 v[32:35], v[12:15], v[44:51], v74
  s_waitcnt lgkmcnt(0)
  v_smfmac_f32_16x16x64_bf16 v[32:35], v[0:3], v[60:67], v74
  v_cvt_pk_bf16_f32 v24, v24, v25
  v_cvt_pk_bf16_f32 v25, v26, v27
  v_bfi_b32 v24, 1, s72, v24
  v_smfmac_f32_16x16x64_bf16 v[32:35], v[4:7], a[240:247], v74
  buffer_store_dwordx2 v[24:25], v68, s[8:11], s75 offen
  v_smfmac_f32_16x16x64_bf16 v[32:35], v[8:11], a[248:255], v74
  v_mov_b64 v[18:19], v[72:73]
  s_nop 4
  v_cvt_pk_bf16_f32 v32, v32, v33
  v_cvt_pk_bf16_f32 v33, v34, v35
  v_bfi_b32 v32, 1, s72, v32
  buffer_store_dwordx2 v[32:33], v68, s[8:11], s76 offen
  ds_read_b128 v[0:3], v76 offset:14848
  s_waitcnt lgkmcnt(0)
  ds_read_b64 v[16:17], v77 offset:256
  s_waitcnt lgkmcnt(0)
  ds_read_b128 v[64:67], v76 offset:19456
  s_waitcnt lgkmcnt(0)
  v_xor_b32 v75, 0x8000, v75
  v_mov_b64 v[28:29], 0
  v_mov_b64 v[30:31], 0
  v_mov_b64 v[32:33], 0
  v_mov_b64 v[34:35], 0
  buffer_load_dwordx4 v[52:55], v76, s[8:11], s60 offen offset:0 sc1
  buffer_load_dwordx4 v[56:59], v76, s[8:11], s60 offen offset:1024 sc1
  s_add_u32 s66, s66, 1
  s_xor_b32 s64, s64, 16384
  s_xor_b32 s65, s65, 16384
  s_add_u32 s58, s58, 655360
  s_add_u32 s59, s59, 655360
  s_add_u32 s70, s70, 655360
  s_add_u32 s68, s68, 655360
  s_mov_b32 m0, 10752
  s_add_u32 s85, s65, 6144
  s_waitcnt lgkmcnt(0)
  s_waitcnt vmcnt(1)
  v_mfma_f32_16x16x32_bf16 v[4:7], v[0:3], v[52:55], 0
  v_bitop3_b32 v72, v52, v54, s72 bitop3:0x7e
  s_waitcnt vmcnt(0)
  v_mfma_f32_16x16x32_bf16 v[4:7], v[0:3], v[56:59], v[4:7]
  v_bitop3_b32 v73, v56, v58, s72 bitop3:0x7e
  v_bitop3_b32 v72, v72, v73, 1 bitop3:0xa8
  v_cmp_ne_u32 vcc, 0, v72
  s_nop 3
  v_add_f32_dpp v4, v4, v4 row_ror:4 row_mask:0xf bank_mask:0xf
  v_add_f32_dpp v5, v5, v5 row_ror:4 row_mask:0xf bank_mask:0xf
  s_cmp_eq_u64 vcc, 0
  v_add_f32_dpp v4, v4, v4 row_ror:8 row_mask:0xf bank_mask:0xf
  v_add_f32_dpp v5, v5, v5 row_ror:8 row_mask:0xf bank_mask:0xf
  s_cselect_b32 s54, s62, 268435456
  v_cvt_pk_bf16_f32 v4, v4, v5
  buffer_store_dword v4, v69, s[8:11], s54 offen
  s_cbranch_vccnz Cf0_h1r
  s_xor_b32 s62, s62, 16384
  buffer_store_dword v71, v69, s[8:11], s62 offen
  s_xor_b32 s72, s72, 1
  s_branch Cf0_h2
Cf0_h1r:
  s_mov_b64 exec, vcc
  buffer_load_dwordx4 v[52:55], v76, s[8:11], s60 offen offset:0 sc1
  buffer_load_dwordx4 v[56:59], v76, s[8:11], s60 offen offset:1024 sc1
  s_mov_b64 exec, -1
  s_add_u32 s67, s67, 1
  s_waitcnt vmcnt(1)
  v_mfma_f32_16x16x32_bf16 v[4:7], v[0:3], v[52:55], 0
  v_bitop3_b32 v72, v52, v54, s72 bitop3:0x7e
  s_waitcnt vmcnt(0)
  v_mfma_f32_16x16x32_bf16 v[4:7], v[0:3], v[56:59], v[4:7]
  v_bitop3_b32 v73, v56, v58, s72 bitop3:0x7e
  v_bitop3_b32 v72, v72, v73, 1 bitop3:0xa8
  v_cmp_ne_u32 vcc, 0, v72
  s_cbranch_vccz Cf0_h1p
Cf0_h1s:
  s_mov_b64 exec, vcc
  buffer_load_dwordx4 v[52:55], v76, s[8:11], s60 offen offset:0 sc1
  buffer_load_dwordx4 v[56:59], v76, s[8:11], s60 offen offset:1024 sc1
  s_mov_b64 exec, -1
  s_add_u32 s67, s67, 1
  s_waitcnt vmcnt(1)
  v_mfma_f32_16x16x32_bf16 v[4:7], v[0:3], v[52:55], 0
  v_bitop3_b32 v72, v52, v54, s72 bitop3:0x7e
  s_waitcnt vmcnt(0)
  v_mfma_f32_16x16x32_bf16 v[4:7], v[0:3], v[56:59], v[4:7]
  v_bitop3_b32 v73, v56, v58, s72 bitop3:0x7e
  v_bitop3_b32 v72, v72, v73, 1 bitop3:0xa8
  v_cmp_ne_u32 vcc, 0, v72
  s_cbranch_vccz Cf0_h1p
  s_cmp_lt_u32 s67, 131072
  s_cbranch_scc1 Cf0_h1s
Cf0_h1p:
  s_nop 2
  v_add_f32_dpp v4, v4, v4 row_ror:4 row_mask:0xf bank_mask:0xf
  v_add_f32_dpp v5, v5, v5 row_ror:4 row_mask:0xf bank_mask:0xf
  s_nop 0
  v_add_f32_dpp v4, v4, v4 row_ror:8 row_mask:0xf bank_mask:0xf
  v_add_f32_dpp v5, v5, v5 row_ror:8 row_mask:0xf bank_mask:0xf
  v_cvt_pk_bf16_f32 v4, v4, v5
  buffer_store_dword v4, v69, s[8:11], s62 offen
  s_xor_b32 s62, s62, 16384
  buffer_store_dword v71, v69, s[8:11], s62 offen
  s_xor_b32 s72, s72, 1
  s_branch Cf0_h2
Cf0_h2r:
  s_mov_b64 exec, vcc
  buffer_load_dwordx4 v[0:3], v76, s[8:11], s65 offen offset:0 sc1
  s_mov_b64 exec, -1
  s_add_u32 s67, s67, 1
  s_waitcnt vmcnt(4)
  v_max3_u32 v72, v0, v1, v2
  v_max_u32 v72, v72, v3
  ds_write_b128 v76, v[0:3] offset:4608
  v_cmp_eq_u32 vcc, -1, v72
  s_cbranch_vccz Cf0_h2w
  s_mov_b64 exec, vcc
  buffer_load_dwordx4 v[0:3], v76, s[8:11], s65 offen offset:0 sc1
  s_mov_b64 exec, -1
  s_add_u32 s67, s67, 1
  s_waitcnt vmcnt(4)
  v_max3_u32 v72, v0, v1, v2
  v_max_u32 v72, v72, v3
  ds_write_b128 v76, v[0:3] offset:4608
  v_cmp_eq_u32 vcc, -1, v72
  s_cbranch_vccz Cf0_h2w
Cf0_h2s:
  s_mov_b64 exec, vcc
  buffer_load_dwordx4 v[0:3], v76, s[8:11], s65 offen offset:0 sc1
  s_mov_b64 exec, -1
  s_add_u32 s67, s67, 1
  s_waitcnt vmcnt(2)
  v_max3_u32 v72, v0, v1, v2
  v_max_u32 v72, v72, v3
  ds_write_b128 v76, v[0:3] offset:4608
  v_cmp_eq_u32 vcc, -1, v72
  s_cbranch_vccz Cf0_h2w
  s_mov_b64 exec, vcc
  buffer_load_dwordx4 v[0:3], v76, s[8:11], s65 offen offset:0 sc1
  s_mov_b64 exec, -1
  s_add_u32 s67, s67, 1
  s_waitcnt vmcnt(2)
  v_max3_u32 v72, v0, v1, v2
  v_max_u32 v72, v72, v3
  ds_write_b128 v76, v[0:3] offset:4608
  v_cmp_eq_u32 vcc, -1, v72
  s_cbranch_vccz Cf0_h2w
  s_mov_b64 exec, vcc
  buffer_load_dwordx4 v[0:3], v76, s[8:11], s65 offen offset:0 sc1
  s_mov_b64 exec, -1
  s_add_u32 s67, s67, 1
  s_waitcnt vmcnt(2)
  v_max3_u32 v72, v0, v1, v2
  v_max_u32 v72, v72, v3
  ds_write_b128 v76, v[0:3] offset:4608
  v_cmp_eq_u32 vcc, -1, v72
  s_cbranch_vccz Cf0_h2w
  s_cmp_lt_u32 s67, 131072
  s_cbranch_scc1 Cf0_h2s
  s_branch Cf0_h2w
Cf0_rec:
  s_nop 7
  s_waitcnt vmcnt(0) lgkmcnt(0)
  v_max3_u32 v72, v0, v1, v2
  v_max3_u32 v72, v72, v3, v4
  v_max3_u32 v72, v72, v5, v6
  v_max3_u32 v72, v72, v7, v8
  v_max3_u32 v72, v72, v9, v10
  v_max3_u32 v72, v72, v11, v12
  v_max3_u32 v72, v72, v13, v14
  v_max3_u32 v72, v72, v15, v16
  v_max3_u32 v72, v72, v17, v18
  v_max_u32 v72, v72, v19
  v_cmp_eq_u32 vcc, -1, v72
  s_cbranch_vccz Cf0_recok
  s_barrier
  v_mov_b64 v[20:21], 0
  v_mov_b64 v[22:23], 0
  v_mov_b64 v[24:25], 0
  v_mov_b64 v[26:27], 0
  v_mov_b64 v[28:29], 0
  v_mov_b64 v[30:31], 0
  v_mov_b64 v[32:33], 0
  v_mov_b64 v[34:35], 0
  s_waitcnt lgkmcnt(0)
  s_barrier
  ds_read_b128 v[0:3], v76 offset:4608
  s_waitcnt lgkmcnt(0)
  v_smfmac_f32_16x16x64_bf16 v[20:23], v[0:3], v[80:87], v74
  v_smfmac_f32_16x16x64_bf16 v[24:27], v[0:3], v[88:95], v74
  ds_read_b128 v[60:63], v76 offset:16384
  ds_read_b128 v[64:67], v76 offset:17408
  s_waitcnt lgkmcnt(0)
  v_smfmac_f32_16x16x64_bf16 v[28:31], v[0:3], v[60:67], v74
  ds_read_b128 v[60:63], v76 offset:18432
  ds_read_b128 v[64:67], v76 offset:19456
  s_waitcnt lgkmcnt(0)
  v_smfmac_f32_16x16x64_bf16 v[32:35], v[0:3], v[60:67], v74
  ds_read_b128 v[4:7], v76 offset:5632
  s_waitcnt lgkmcnt(0)
  v_smfmac_f32_16x16x64_bf16 v[20:23], v[4:7], v[96:103], v74
  v_smfmac_f32_16x16x64_bf16 v[24:27], v[4:7], v[104:111], v74
  ds_read_b128 v[60:63], v76 offset:32768
  ds_read_b128 v[64:67], v76 offset:33792
  s_waitcnt lgkmcnt(0)
  v_smfmac_f32_16x16x64_bf16 v[28:31], v[4:7], v[60:67], v74
  ds_read_b128 v[60:63], v76 offset:34816
  ds_read_b128 v[64:67], v76 offset:35840
  s_waitcnt lgkmcnt(0)
  v_smfmac_f32_16x16x64_bf16 v[32:35], v[4:7], v[60:67], v74
  ds_read_b128 v[8:11], v76 offset:6656
  s_waitcnt lgkmcnt(0)
  v_smfmac_f32_16x16x64_bf16 v[20:23], v[8:11], v[112:119], v74
  v_smfmac_f32_16x16x64_bf16 v[24:27], v[8:11], v[120:127], v74
  v_smfmac_f32_16x16x64_bf16 v[28:31], v[8:11], v[208:215], v74
  v_smfmac_f32_16x16x64_bf16 v[32:35], v[8:11], v[216:223], v74
  ds_read_b128 v[12:15], v76 offset:7680
  s_waitcnt lgkmcnt(0)
  v_smfmac_f32_16x16x64_bf16 v[20:23], v[12:15], v[128:135], v74
  v_smfmac_f32_16x16x64_bf16 v[24:27], v[12:15], v[136:143], v74
  v_smfmac_f32_16x16x64_bf16 v[28:31], v[12:15], v[224:231], v74
  v_smfmac_f32_16x16x64_bf16 v[32:35], v[12:15], v[232:239], v74
  ds_read_b128 v[0:3], v76 offset:8704
  s_waitcnt lgkmcnt(0)
  v_smfmac_f32_16x16x64_bf16 v[20:23], v[0:3], v[144:151], v74
  v_smfmac_f32_16x16x64_bf16 v[24:27], v[0:3], v[152:159], v74
  ds_read_b128 v[60:63], v76 offset:49152
  ds_read_b128 v[64:67], v76 offset:50176
  s_waitcnt lgkmcnt(0)
  v_smfmac_f32_16x16x64_bf16 v[28:31], v[0:3], v[60:67], v74
  ds_read_b128 v[60:63], v76 offset:51200
  ds_read_b128 v[64:67], v76 offset:52224
  s_waitcnt lgkmcnt(0)
  v_smfmac_f32_16x16x64_bf16 v[32:35], v[0:3], v[60:67], v74
  ds_read_b128 v[8:11], v76 offset:9728
  s_waitcnt lgkmcnt(0)
  v_smfmac_f32_16x16x64_bf16 v[20:23], v[8:11], v[160:167], v74
  v_smfmac_f32_16x16x64_bf16 v[24:27], v[8:11], v[168:175], v74
  ds_read_b128 v[60:63], v75 offset:16384
  ds_read_b128 v[64:67], v75 offset:17408
  s_waitcnt lgkmcnt(0)
  v_smfmac_f32_16x16x64_bf16 v[28:31], v[8:11], v[60:67], v74
  ds_read_b128 v[60:63], v75 offset:18432
  ds_read_b128 v[64:67], v75 offset:19456
  s_waitcnt lgkmcnt(0)
  v_smfmac_f32_16x16x64_bf16 v[32:35], v[8:11], v[60:67], v74
  ds_read_b128 v[16:19], v76 offset:10752
  ds_read_b128 v[60:63], v75 offset:0
  ds_read_b128 v[64:67], v75 offset:1024
  s_waitcnt lgkmcnt(0)
  v_smfmac_f32_16x16x64_bf16 v[20:23], v[16:19], v[60:67], v74
  ds_read_b128 v[60:63], v75 offset:2048
  ds_read_b128 v[64:67], v75 offset:3072
  s_waitcnt lgkmcnt(0)
  v_smfmac_f32_16x16x64_bf16 v[24:27], v[16:19], v[60:67], v74
  v_smfmac_f32_16x16x64_bf16 v[28:31], v[16:19], v[240:247], v74
  v_smfmac_f32_16x16x64_bf16 v[32:35], v[16:19], v[248:255], v74
  ds_read_b128 v[4:7], v76 offset:11776
  s_waitcnt lgkmcnt(0)
  v_smfmac_f32_16x16x64_bf16 v[20:23], v[4:7], v[176:183], v74
  v_smfmac_f32_16x16x64_bf16 v[24:27], v[4:7], v[184:191], v74
  v_smfmac_f32_16x16x64_bf16 v[28:31], v[4:7], a[0:7], v74
  v_smfmac_f32_16x16x64_bf16 v[32:35], v[4:7], a[8:15], v74
  ds_read_b128 v[12:15], v76 offset:12800
  s_waitcnt lgkmcnt(0)
  v_smfmac_f32_16x16x64_bf16 v[20:23], v[12:15], v[192:199], v74
  v_smfmac_f32_16x16x64_bf16 v[24:27], v[12:15], v[200:207], v74
  v_smfmac_f32_16x16x64_bf16 v[28:31], v[12:15], a[16:23], v74
  v_smfmac_f32_16x16x64_bf16 v[32:35], v[12:15], a[24:31], v74
  v_add_f32 v20, v20, v22
  v_add_f32 v21, v21, v23
  v_add_f32 v24, v24, v26
  v_cvt_pk_bf16_f32 v22, v20, v24
  ds_write_b32 v79, v22 offset:0
  v_add_f32 v25, v25, v27
  v_cvt_pk_bf16_f32 v23, v21, v25
  ds_write_b32 v79, v23 offset:576
  v_add_f32 v28, v28, v30
  v_add_f32 v29, v29, v31
  s_waitcnt lgkmcnt(0)
  s_nop 1
  s_branch Cf0_recok
Cf0_mx:
  s_waitcnt lgkmcnt(0)
  s_barrier
  buffer_load_dwordx4 v[52:55], v76, s[8:11], s59 offen offset:0 sc1
  buffer_load_dwordx4 v[0:3], v76, s[8:11], s58 offen offset:0 sc1
  ds_read_b128 v[20:23], v77 offset:0
  ds_read_b128 v[28:31], v77 offset:256
  buffer_load_dwordx4 v[56:59], v76, s[8:11], s59 offen offset:1024 sc1
  buffer_load_dwordx4 v[4:7], v76, s[8:11], s58 offen offset:1024 sc1
  ds_read_b128 v[24:27], v77 offset:128
  ds_read_b128 v[32:35], v77 offset:384
  s_waitcnt vmcnt(2) lgkmcnt(3)
  v_mfma_f32_16x16x32_bf16 v[8:11], v[0:3], v[20:23], 0
  s_waitcnt vmcnt(0) lgkmcnt(1)
  v_mfma_f32_16x16x32_bf16 v[8:11], v[4:7], v[24:27], v[8:11]
  v_mfma_f32_16x16x32_bf16 v[12:15], v[28:31], v[20:23], 0
  s_waitcnt lgkmcnt(0)
  v_mfma_f32_16x16x32_bf16 v[12:15], v[32:35], v[24:27], v[12:15]
  v_add_f32_dpp v8, v10, v8 quad_perm:[2,3,0,1] row_mask:0xf bank_mask:0xf
  v_add_f32_dpp v9, v11, v9 quad_perm:[2,3,0,1] row_mask:0xf bank_mask:0xf
  s_nop 0
  v_mov_b32_dpp v8, v8 quad_perm:[0,1,0,1] row_mask:0xf bank_mask:0xf
  v_mov_b32_dpp v9, v9 quad_perm:[0,1,0,1] row_mask:0xf bank_mask:0xf
  s_nop 1
  v_add_f32_dpp v12, v14, v12 quad_perm:[2,3,0,1] row_mask:0xf bank_mask:0xf
  v_add_f32_dpp v13, v15, v13 quad_perm:[2,3,0,1] row_mask:0xf bank_mask:0xf
  s_nop 0
  v_mov_b32_dpp v12, v12 quad_perm:[0,1,0,1] row_mask:0xf bank_mask:0xf
  v_mov_b32_dpp v13, v13 quad_perm:[0,1,0,1] row_mask:0xf bank_mask:0xf
  v_mul_f32 v12, s69, v12
  ds_write_b32 v78, v8 offset:8704
  v_mul_f32 v13, s69, v13
  ds_write_b32 v78, v9 offset:8768
  s_waitcnt lgkmcnt(0)
  s_barrier
  ds_read_b128 v[36:39], v78 offset:8704
  ds_read_b128 v[40:43], v78 offset:8768
  s_waitcnt lgkmcnt(0)
  s_barrier
  v_max_f32 v16, v36, v37
  v_max3_f32 v16, v16, v38, v39
  v_max3_f32 v16, v16, v40, v41
  v_max3_f32 v16, v16, v42, v43
  v_max3_f32 v16, v16, v12, v13
  v_mov_b32 v17, v16
  s_nop 1
  v_permlane16_swap_b32 v16, v17
  v_max_f32 v16, v16, v17
  v_mov_b32 v17, v16
  s_nop 1
  v_permlane32_swap_b32 v16, v17
  v_max_f32 v16, v16, v17
  v_sub_f32 v36, v36, v16
  v_sub_f32 v37, v37, v16
  v_sub_f32 v38, v38, v16
  v_sub_f32 v39, v39, v16
  v_sub_f32 v40, v40, v16
  v_sub_f32 v41, v41, v16
  v_sub_f32 v42, v42, v16
  v_sub_f32 v43, v43, v16
  v_sub_f32 v12, v12, v16
  v_sub_f32 v13, v13, v16
  v_exp_f32 v36, v36
  v_exp_f32 v37, v37
  v_exp_f32 v38, v38
  v_exp_f32 v39, v39
  v_exp_f32 v40, v40
  v_exp_f32 v41, v41
  v_exp_f32 v42, v42
  v_exp_f32 v43, v43
  v_exp_f32 v12, v12
  v_exp_f32 v13, v13
  v_cvt_pk_bf16_f32 v32, v36, v40
  v_cvt_pk_bf16_f32 v33, v37, v41
  v_cvt_pk_bf16_f32 v34, v38, v42
  v_cvt_pk_bf16_f32 v35, v39, v43
  v_cvt_pk_bf16_f32 v28, v12, v13
  v_cvt_pk_bf16_f32 v31, v12, v13
  v_mov_b32 v29, 0
  v_mov_b32 v30, 0
  v_mfma_f32_16x16x32_bf16 v[8:11], v[32:35], v[68:71], 0
  v_mfma_f32_16x16x32_bf16 v[0:3], v[32:35], v[52:55], 0
  v_mfma_f32_16x16x32_bf16 v[4:7], v[32:35], v[56:59], 0
  v_mfma_f32_16x16x16_bf16 v[8:11], v[28:29], v[68:69], v[8:11]
  v_mfma_f32_16x16x16_bf16 v[0:3], v[28:29], v[72:73], v[0:3]
  v_mfma_f32_16x16x16_bf16 v[4:7], v[30:31], v[72:73], v[4:7]
  ds_read_b128 v[52:55], v75 offset:32768
  v_rcp_f32 v10, v8
  v_rcp_f32 v11, v9
  v_mul_f32 v0, v10, v0
  v_mul_f32 v1, v11, v1
  v_max3_f32 v8, v8, v9, v10
  v_mul_f32 v4, v10, v4
  v_mul_f32 v5, v11, v5
  v_cvt_pk_bf16_f32 v2, v0, v4
  ds_write_b32 v79, v2 offset:8704
  v_cvt_pk_bf16_f32 v3, v1, v5
  ds_write_b32 v79, v3 offset:9280
  ds_read_b128 v[12:15], v78 offset:8704
  ds_read_b128 v[56:59], v75 offset:33792
  v_mov_b64 v[16:17], 0
  v_mov_b64 v[18:19], 0
  v_mov_b64 v[20:21], 0
  v_mov_b64 v[22:23], 0
  v_mov_b64 v[24:25], 0
  v_mov_b64 v[26:27], 0
  s_branch Cf0_mxok
Cf0_kv3:
  s_waitcnt lgkmcnt(0)
  s_cmp_ge_u32 s57, 0x700
  s_cbranch_scc1 Cf0_kvb
  s_load_dword s57, s[12:13], s71 glc
  s_add_u32 s67, s67, 1
  s_cmp_lt_u32 s67, 131072
  s_cbranch_scc1 Cf0_kv3
  s_waitcnt lgkmcnt(0)
  s_branch Cf0_kvb
Cf0_last:
  ds_read_b128 v[4:7], v76 offset:5632
  ds_read_b128 v[12:15], v76 offset:7680
  ds_read_b128 v[44:47], v76 offset:32768
  ds_read_b128 v[48:51], v76 offset:33792
  s_nop 5
  v_mov_b64 v[20:21], 0
  v_mov_b64 v[22:23], 0
  v_mov_b64 v[24:25], 0
  v_mov_b64 v[26:27], 0
  v_smfmac_f32_16x16x64_bf16 v[28:31], v[0:3], v[36:43], v74
  ds_read_b128 v[36:39], v76 offset:34816
  ds_read_b128 v[40:43], v76 offset:35840
  v_smfmac_f32_16x16x64_bf16 v[32:35], v[0:3], v[60:67], v74
  s_waitcnt lgkmcnt(5)
  v_smfmac_f32_16x16x64_bf16 v[20:23], v[0:3], a[32:39], v74
  ds_read_b128 v[60:63], v76 offset:49152
  ds_read_b128 v[64:67], v76 offset:50176
  v_smfmac_f32_16x16x64_bf16 v[24:27], v[0:3], a[40:47], v74
  s_waitcnt lgkmcnt(4)
  v_smfmac_f32_16x16x64_bf16 v[20:23], v[4:7], a[48:55], v74
  buffer_store_dwordx4 v[16:19], v76, s[8:11], s68 offen sc1
  v_smfmac_f32_16x16x64_bf16 v[24:27], v[4:7], a[56:63], v74
  v_smfmac_f32_16x16x64_bf16 v[28:31], v[4:7], v[44:51], v74
  s_waitcnt lgkmcnt(2)
  v_smfmac_f32_16x16x64_bf16 v[20:23], v[8:11], a[64:71], v74
  ds_read_b128 v[44:47], v76 offset:51200
  ds_read_b128 v[48:51], v76 offset:52224
  v_smfmac_f32_16x16x64_bf16 v[24:27], v[8:11], a[72:79], v74
  v_smfmac_f32_16x16x64_bf16 v[32:35], v[4:7], v[36:43], v74
  v_smfmac_f32_16x16x64_bf16 v[28:31], v[8:11], v[208:215], v74
  ds_read_b128 v[36:39], v75 offset:16384
  ds_read_b128 v[40:43], v75 offset:17408
  v_smfmac_f32_16x16x64_bf16 v[32:35], v[8:11], v[216:223], v74
  v_smfmac_f32_16x16x64_bf16 v[20:23], v[12:15], a[80:87], v74
  v_smfmac_f32_16x16x64_bf16 v[24:27], v[12:15], a[88:95], v74
  v_smfmac_f32_16x16x64_bf16 v[28:31], v[12:15], v[224:231], v74
  v_smfmac_f32_16x16x64_bf16 v[32:35], v[12:15], v[232:239], v74
  s_waitcnt vmcnt(2)
  s_waitcnt vmcnt(1)
  s_barrier
Cf0_lastr:
  ds_read_b128 v[0:3], v76 offset:8704
  ds_read_b128 v[8:11], v76 offset:9728
  ds_read_b128 v[16:19], v76 offset:10752
  ds_read_b128 v[4:7], v76 offset:11776
  ds_read_b128 v[12:15], v76 offset:12800
  s_waitcnt lgkmcnt(4)
  v_max3_u32 v72, v0, v1, v2
  s_waitcnt lgkmcnt(1)
  v_max3_u32 v72, v72, v3, v4
  v_max3_u32 v72, v72, v5, v6
  v_max3_u32 v72, v72, v7, v8
  v_max3_u32 v72, v72, v9, v10
  s_waitcnt lgkmcnt(0)
  v_max3_u32 v72, v72, v11, v12
  v_max3_u32 v72, v72, v13, v14
  v_max3_u32 v72, v72, v15, v16
  v_max3_u32 v72, v72, v17, v18
  v_max_u32 v72, v72, v19
  v_cmp_eq_u32 vcc, -1, v72
  s_cbranch_vccnz Cf0_lastp
Cf0_lastg:
  v_smfmac_f32_16x16x64_bf16 v[28:31], v[0:3], v[60:67], v74
  ds_read_b128 v[60:63], v75 offset:18432
  ds_read_b128 v[64:67], v75 offset:19456
  v_smfmac_f32_16x16x64_bf16 v[32:35], v[0:3], v[44:51], v74
  v_smfmac_f32_16x16x64_bf16 v[28:31], v[8:11], v[36:43], v74
  v_smfmac_f32_16x16x64_bf16 v[28:31], v[16:19], v[240:247], v74
  v_smfmac_f32_16x16x64_bf16 v[28:31], v[4:7], a[0:7], v74
  v_smfmac_f32_16x16x64_bf16 v[28:31], v[12:15], a[16:23], v74
  v_smfmac_f32_16x16x64_bf16 v[32:35], v[16:19], v[248:255], v74
  v_smfmac_f32_16x16x64_bf16 v[32:35], v[4:7], a[8:15], v74
  s_waitcnt lgkmcnt(0)
  v_smfmac_f32_16x16x64_bf16 v[32:35], v[12:15], a[24:31], v74
  v_smfmac_f32_16x16x64_bf16 v[32:35], v[8:11], v[60:67], v74
  v_smfmac_f32_16x16x64_bf16 v[20:23], v[0:3], a[96:103], v74
  v_smfmac_f32_16x16x64_bf16 v[20:23], v[8:11], a[112:119], v74
  v_add_f32 v28, v28, v30
  v_add_f32 v32, v32, v34
  v_cvt_pk_bf16_f32 v30, v28, v32
  v_smfmac_f32_16x16x64_bf16 v[20:23], v[16:19], a[128:135], v74
  ds_write_b32 v79, v30 offset:256
  v_add_f32 v29, v29, v31
  v_add_f32 v33, v33, v35
  v_cvt_pk_bf16_f32 v31, v29, v33
  v_smfmac_f32_16x16x64_bf16 v[20:23], v[4:7], a[144:151], v74
  ds_write_b32 v79, v31 offset:832
  v_smfmac_f32_16x16x64_bf16 v[20:23], v[12:15], a[160:167], v74
  v_smfmac_f32_16x16x64_bf16 v[24:27], v[0:3], a[104:111], v74
  v_smfmac_f32_16x16x64_bf16 v[24:27], v[8:11], a[120:127], v74
  v_smfmac_f32_16x16x64_bf16 v[24:27], v[16:19], a[136:143], v74
  s_waitcnt lgkmcnt(0)
  s_barrier
  ds_read_b64 v[52:53], v77 offset:256
  v_add_f32 v20, v20, v22
  v_smfmac_f32_16x16x64_bf16 v[24:27], v[4:7], a[152:159], v74
  v_add_f32 v21, v21, v23
  v_smfmac_f32_16x16x64_bf16 v[24:27], v[12:15], a[168:175], v74
  v_cvt_pk_bf16_f32 v54, v20, v21
  s_add_u32 s68, s68, 655360
  s_nop 3
  v_add_f32 v24, v24, v26
  v_add_f32 v25, v25, v27
  v_cvt_pk_bf16_f32 v55, v24, v25
  s_waitcnt lgkmcnt(0)
  buffer_store_dwordx4 v[52:55], v76, s[8:11], s68 offen sc1
  s_branch Cf0_done
Cf0_lastp:
  s_add_u32 s72, s72, 2
  s_cmp_ge_u32 s72, 131072
  s_cbranch_scc1 Cf0_lastg
  s_barrier
  buffer_load_dwordx4 v76, s[8:11], s85 offen offset:0 sc1 lds
  s_waitcnt vmcnt(0)
  s_barrier
  s_branch Cf0_lastr
Cf0_done:
  s_branch L_cexit
L_w1:
  v_mov_b64 v[20:21], 0
  v_mov_b64 v[22:23], 0
  v_mov_b64 v[24:25], 0
  v_mov_b64 v[26:27], 0
  v_mov_b64 v[28:29], 0
  v_mov_b64 v[30:31], 0
  v_mov_b64 v[32:33], 0
  v_mov_b64 v[34:35], 0
  s_mov_b32 s78, 0x3f803f80
  s_mov_b32 s79, s78
  s_mov_b32 s65, 360448
  s_mov_b32 m0, 15872
  s_lshl_b32 s71, s53, 2
  s_add_u32 s71, s71, 128
  s_movk_i32 s56, 0x1000
  v_lshlrev_b32 v73, 2, v76
  v_mov_b32 v72, 0
  s_mov_b64 s[16:17], s[8:9]
  s_mov_b32 s18, 268435456
  s_mov_b32 s19, 0x20000
  s_getpc_b64 s[20:21]
Cf1_pc:
  s_add_u32 s20, s20, (Cf1_last - Cf1_pc)
  s_addc_u32 s21, s21, 0
  v_mov_b32 v68, 14880
  buffer_load_dwordx4 v[52:55], v76, s[8:11], s59 offen offset:0 sc1
  buffer_load_dwordx4 v[56:59], v76, s[8:11], s59 offen offset:1024 sc1
  ds_read_b128 v[36:39], v76 offset:20480
  ds_read_b128 v[40:43], v76 offset:21504
  ds_read_b128 v[60:63], v76 offset:22528
  ds_read_b128 v[64:67], v76 offset:23552
  ds_read_b128 v[0:3], v76 offset:4608
  ds_read_b128 v[4:7], v76 offset:5632
  ds_read_b128 v[8:11], v76 offset:6656
  ds_read_b128 v[12:15], v76 offset:7680
  s_waitcnt lgkmcnt(0)
  s_cmp_eq_u32 s66, 1
  s_branch Cf1_top2
.p2align 6
Cf1_h2:
  ds_read_b128 v[36:39], v76 offset:20480
  s_waitcnt lgkmcnt(0)
  buffer_load_dwordx4 v[8:11], v76, s[8:11], s65 offen offset:2048 sc1
  ds_read_b128 v[40:43], v76 offset:21504
  s_waitcnt lgkmcnt(0)
  v_lshlrev_b32 v73, 2, v76
  buffer_load_dwordx4 v[8:11], v76, s[8:11], s65 offen offset:2048 sc1
  ds_read_b128 v[60:63], v76 offset:22528
  s_waitcnt lgkmcnt(0)
  s_cmp_eq_u32 s66, 62
  s_cselect_b64 s[16:17], s[20:21], s[16:17]
  s_cselect_b32 s18, (Cf1_done - Cf1_last), s18
  s_cselect_b32 s70, 0, s70
  s_cmp_eq_u32 s66, 63
  s_cselect_b32 s59, 268435456, s59
  s_cselect_b32 s58, 268435456, s58
  buffer_load_dwordx4 v[8:11], v76, s[8:11], s65 offen offset:2048 sc1
  buffer_load_dwordx4 v[52:55], v76, s[8:11], s59 offen offset:0 sc1
  buffer_load_dwordx4 v[56:59], v76, s[8:11], s59 offen offset:1024 sc1
  s_waitcnt vmcnt(4)
  v_max3_u32 v72, v8, v9, v10
  v_max_u32 v72, v72, v11
  ds_write_b128 v76, v[8:11] offset:6656
  v_cmp_eq_u32 vcc, -1, v72
  s_cbranch_vccnz Cf1_h2r
Cf1_h2w:
  s_cmp_eq_u32 s66, 63
  s_waitcnt lgkmcnt(0)
  s_barrier
  ds_read_b128 v[0:3], v76 offset:4608
  buffer_load_dwordx4 v76, s[8:11], s85 offen offset:0 sc1 lds
Cf1_top2:
  v_smfmac_f32_16x16x64_bf16 v[20:23], v[8:11], v[112:119], v74
  s_cbranch_scc1 Cf1_last
  v_smfmac_f32_16x16x64_bf16 v[24:27], v[8:11], v[120:127], v74
  buffer_load_dwordx4 v[44:47], v76, s[8:11], s58 offen offset:0 sc1
  s_mov_b32 m0, 15872
  v_smfmac_f32_16x16x64_bf16 v[28:31], v[8:11], v[208:215], v74
  buffer_load_dwordx4 v[48:51], v76, s[8:11], s58 offen offset:1024 sc1
  v_smfmac_f32_16x16x64_bf16 v[32:35], v[8:11], v[216:223], v74
  ds_read_b128 v[4:7], v76 offset:5632
  s_waitcnt lgkmcnt(1)
  v_smfmac_f32_16x16x64_bf16 v[20:23], v[0:3], v[80:87], v74
  ds_read_b128 v[12:15], v76 offset:7680
  v_smfmac_f32_16x16x64_bf16 v[28:31], v[0:3], v[36:43], v74
  ds_read_b128 v[36:39], v76 offset:36864
  v_smfmac_f32_16x16x64_bf16 v[24:27], v[0:3], v[88:95], v74
  buffer_store_dwordx4 v[16:19], v76, s[8:11], s68 offen sc1
  ds_read_b128 v[40:43], v76 offset:37888
  v_smfmac_f32_16x16x64_bf16 v[32:35], v[0:3], v[60:67], v74
  buffer_load_dword v73, s[16:19], s70 offen lds
  ds_read_b128 v[60:63], v76 offset:38912
  s_waitcnt lgkmcnt(4)
  v_smfmac_f32_16x16x64_bf16 v[20:23], v[4:7], v[96:103], v74
  ds_read_b128 v[64:67], v76 offset:39936
  v_smfmac_f32_16x16x64_bf16 v[24:27], v[4:7], v[104:111], v74
  s_waitcnt vmcnt(5)
  s_waitcnt lgkmcnt(4)
  v_smfmac_f32_16x16x64_bf16 v[20:23], v[12:15], v[128:135], v74
  s_barrier
  ds_read_b128 v[8:11], v76 offset:8704
  s_waitcnt lgkmcnt(3)
  v_smfmac_f32_16x16x64_bf16 v[28:31], v[4:7], v[36:43], v74
  ds_read_b128 v[36:39], v76 offset:53248
  v_smfmac_f32_16x16x64_bf16 v[24:27], v[12:15], v[136:143], v74
  ds_read_b128 v[40:43], v76 offset:54272
  s_waitcnt lgkmcnt(3)
  v_smfmac_f32_16x16x64_bf16 v[32:35], v[4:7], v[60:67], v74
  ds_read_b128 v[0:3], v76 offset:9728
  v_smfmac_f32_16x16x64_bf16 v[28:31], v[12:15], v[224:231], v74
  ds_read_b128 v[60:63], v76 offset:55296
  v_smfmac_f32_16x16x64_bf16 v[32:35], v[12:15], v[232:239], v74
  s_waitcnt vmcnt(4)
  ds_read_b128 v[64:67], v76 offset:56320
  s_waitcnt lgkmcnt(5)
  v_smfmac_f32_16x16x64_bf16 v[20:23], v[8:11], v[144:151], v74
  s_barrier
  ds_read_b128 v[4:7], v76 offset:11776
  s_waitcnt lgkmcnt(4)
  v_smfmac_f32_16x16x64_bf16 v[28:31], v[8:11], v[36:43], v74
  ds_read_b128 v[12:15], v76 offset:12800
  ds_read_b128 v[36:39], v75 offset:4096
  v_smfmac_f32_16x16x64_bf16 v[24:27], v[8:11], v[152:159], v74
  ds_read_b128 v[16:19], v76 offset:10752
  s_waitcnt lgkmcnt(6)
  v_smfmac_f32_16x16x64_bf16 v[20:23], v[0:3], v[160:167], v74
  ds_read_b128 v[40:43], v75 offset:5120
  s_waitcnt lgkmcnt(5)
  v_smfmac_f32_16x16x64_bf16 v[32:35], v[8:11], v[60:67], v74
  ds_read_b128 v[60:63], v75 offset:6144
  v_smfmac_f32_16x16x64_bf16 v[24:27], v[0:3], v[168:175], v74
  ds_read_b128 v[64:67], v75 offset:7168
  s_waitcnt lgkmcnt(6)
  v_smfmac_f32_16x16x64_bf16 v[20:23], v[4:7], v[176:183], v74
  s_waitcnt lgkmcnt(5)
  v_smfmac_f32_16x16x64_bf16 v[20:23], v[12:15], v[192:199], v74
  s_waitcnt lgkmcnt(2)
  v_smfmac_f32_16x16x64_bf16 v[20:23], v[16:19], v[36:43], v74
  ds_read_b128 v[36:39], v75 offset:20480
  v_smfmac_f32_16x16x64_bf16 v[24:27], v[4:7], v[184:191], v74
  ds_read_b128 v[40:43], v75 offset:21504
  s_waitcnt lgkmcnt(2)
  v_smfmac_f32_16x16x64_bf16 v[24:27], v[16:19], v[60:67], v74
  ds_read_b128 v[60:63], v75 offset:22528
  v_add_f32 v20, v20, v22
  v_smfmac_f32_16x16x64_bf16 v[24:27], v[12:15], v[200:207], v74
  ds_read_b128 v[64:67], v75 offset:23552
  v_add_f32 v21, v21, v23
  v_smfmac_f32_16x16x64_bf16 v[28:31], v[16:19], v[240:247], v74
  v_mov_b64 v[70:71], s[78:79]
  v_smfmac_f32_16x16x64_bf16 v[28:31], v[4:7], a[0:7], v74
  s_waitcnt lgkmcnt(2)
  v_add_f32 v24, v24, v26
  v_smfmac_f32_16x16x64_bf16 v[28:31], v[0:3], v[36:43], v74
  ds_read_b128 v[36:39], v68
  v_cvt_pk_bf16_f32 v22, v20, v24
  v_smfmac_f32_16x16x64_bf16 v[28:31], v[12:15], a[16:23], v74
  ds_read_b128 v[40:43], v68
  ds_write_b32 v79, v22 offset:0
  s_waitcnt lgkmcnt(3)
  v_add_f32 v25, v25, v27
  v_cvt_pk_bf16_f32 v23, v21, v25
  v_smfmac_f32_16x16x64_bf16 v[32:35], v[0:3], v[60:67], v74
  ds_write_b32 v79, v23 offset:576
  v_cmp_u_f32 vcc, v20, v21
  v_smfmac_f32_16x16x64_bf16 v[32:35], v[16:19], v[248:255], v74
  v_add_f32 v28, v28, v30
  v_smfmac_f32_16x16x64_bf16 v[32:35], v[4:7], a[8:15], v74
  v_add_f32 v29, v29, v31
  v_smfmac_f32_16x16x64_bf16 v[32:35], v[12:15], a[24:31], v74
  s_cbranch_vccnz Cf1_rec
Cf1_recok:
  s_waitcnt lgkmcnt(3)
  v_smfmac_f32_16x16x64_bf16 v[36:39], v[16:19], a[128:135], v74
  s_waitcnt lgkmcnt(0)
  s_barrier
  ds_read_b128 v[60:63], v77
  v_smfmac_f32_16x16x64_bf16 v[40:43], v[16:19], a[136:143], v74
  ds_read_b128 v[64:67], v77 offset:128
  v_add_f32 v32, v32, v34
  v_cvt_pk_bf16_f32 v30, v28, v32
  v_smfmac_f32_16x16x64_bf16 v[36:39], v[0:3], a[112:119], v74
  ds_write_b32 v79, v30 offset:256
  v_add_f32 v33, v33, v35
  v_cvt_pk_bf16_f32 v31, v29, v33
  v_smfmac_f32_16x16x64_bf16 v[40:43], v[0:3], a[120:127], v74
  ds_write_b32 v79, v31 offset:832
  v_xor_b32 v75, 0x8000, v75
  v_smfmac_f32_16x16x64_bf16 v[36:39], v[4:7], a[144:151], v74
  ds_read_b128 v[0:3], v76 offset:4608
  v_mov_b32 v29, 0
  v_smfmac_f32_16x16x64_bf16 v[40:43], v[4:7], a[152:159], v74
  s_waitcnt vmcnt(2) lgkmcnt(3)
  v_mov_b32 v30, 0
  v_mfma_f32_16x16x32_bf16 v[44:47], v[44:47], v[60:63], 0
  ds_read_b128 v[4:7], v76 offset:5632
  s_waitcnt lgkmcnt(2)
  v_mfma_f32_16x16x32_bf16 v[44:47], v[48:51], v[64:67], v[44:47]
  s_barrier
  v_smfmac_f32_16x16x64_bf16 v[36:39], v[8:11], a[96:103], v74
  ds_read_b128 v[20:23], v77 offset:256
  ds_read_b128 v[24:27], v77 offset:384
  v_smfmac_f32_16x16x64_bf16 v[40:43], v[8:11], a[104:111], v74
  ds_read_b128 v[8:11], v76 offset:6656
  v_add_f32_dpp v72, v46, v44 quad_perm:[2,3,0,1] row_mask:0xf bank_mask:0xf
  v_add_f32_dpp v73, v47, v45 quad_perm:[2,3,0,1] row_mask:0xf bank_mask:0xf
  v_smfmac_f32_16x16x64_bf16 v[36:39], v[12:15], a[160:167], v74
  s_waitcnt lgkmcnt(4)
  v_exp_f32_dpp v72, v72 quad_perm:[0,1,0,1] row_mask:0xf bank_mask:0xf
  v_smfmac_f32_16x16x64_bf16 v[40:43], v[12:15], a[168:175], v74
  ds_read_b128 v[12:15], v76 offset:7680
  v_exp_f32_dpp v73, v73 quad_perm:[0,1,0,1] row_mask:0xf bank_mask:0xf
  v_smfmac_f32_16x16x64_bf16 v[36:39], v[0:3], a[32:39], v74
  s_waitcnt lgkmcnt(2)
  v_cvt_pk_bf16_f32 v72, v72, v73
  v_mfma_f32_16x16x32_bf16 v[20:23], v[20:23], v[60:63], 0
  ds_write_b32 v78, v72 offset:516
  v_mov_b64 v[16:17], 0
  v_mfma_f32_16x16x32_bf16 v[20:23], v[24:27], v[64:67], v[20:23]
  ds_read_b128 v[44:47], v75 offset:22528
  v_mov_b64 v[18:19], 0
  v_smfmac_f32_16x16x64_bf16 v[40:43], v[0:3], a[40:47], v74
  ds_read_b128 v[48:51], v75 offset:23552
  v_mov_b64 v[68:69], s[78:79]
  v_smfmac_f32_16x16x64_bf16 v[36:39], v[4:7], a[48:55], v74
  s_waitcnt lgkmcnt(4)
  v_add_f32_dpp v24, v22, v20 quad_perm:[2,3,0,1] row_mask:0xf bank_mask:0xf
  v_add_f32_dpp v25, v23, v21 quad_perm:[2,3,0,1] row_mask:0xf bank_mask:0xf
  v_smfmac_f32_16x16x64_bf16 v[36:39], v[8:11], a[64:71], v74
  s_waitcnt lgkmcnt(2)
  s_barrier
  ds_read_b128 v[32:35], v78 offset:512
  v_smfmac_f32_16x16x64_bf16 v[36:39], v[12:15], a[80:87], v74
  ds_read_b128 v[60:63], v75 offset:20480
  v_mul_f32 v24, s69, v24
  v_smfmac_f32_16x16x64_bf16 v[40:43], v[4:7], a[56:63], v74
  ds_read_b128 v[64:67], v75 offset:21504
  v_mul_f32 v25, s69, v25
  v_smfmac_f32_16x16x64_bf16 v[40:43], v[8:11], a[72:79], v74
  v_exp_f32_dpp v24, v24 quad_perm:[0,1,0,1] row_mask:0xf bank_mask:0xf
  v_smfmac_f32_16x16x64_bf16 v[40:43], v[12:15], a[88:95], v74
  s_waitcnt lgkmcnt(2)
  v_exp_f32_dpp v25, v25 quad_perm:[0,1,0,1] row_mask:0xf bank_mask:0xf
  v_mfma_f32_16x16x32_bf16 v[8:11], v[32:35], v[68:71], 0
  v_add_f32 v36, v36, v38
  v_add_f32 v37, v37, v39
  v_mfma_f32_16x16x32_bf16 v[0:3], v[32:35], v[52:55], 0
  v_add_f32 v40, v40, v42
  v_add_f32 v41, v41, v43
  v_mfma_f32_16x16x32_bf16 v[4:7], v[32:35], v[56:59], 0
  v_cvt_pk_bf16_f32 v28, v24, v25
  v_cvt_pk_bf16_f32 v72, v36, v37
  v_cvt_pk_bf16_f32 v73, v40, v41
  v_mfma_f32_16x16x16_bf16 v[8:11], v[28:29], v[68:69], v[8:11]
  v_cvt_pk_bf16_f32 v31, v24, v25
  v_mov_b64 v[20:21], 0
  v_mfma_f32_16x16x16_bf16 v[0:3], v[28:29], v[72:73], v[0:3]
  ds_read_b128 v[52:55], v75 offset:36864
  v_mov_b64 v[22:23], 0
  v_mfma_f32_16x16x16_bf16 v[4:7], v[30:31], v[72:73], v[4:7]
  v_rcp_f32 v10, v8
  v_rcp_f32 v11, v9
  v_mul_f32 v0, v10, v0
  v_mul_f32 v1, v11, v1
  v_max3_f32 v8, v8, v9, v10
  v_mul_f32 v4, v10, v4
  v_mul_f32 v5, v11, v5
  v_cvt_pk_bf16_f32 v2, v0, v4
  ds_write_b32 v79, v2 offset:8704
  v_cvt_pk_bf16_f32 v3, v1, v5
  ds_write_b32 v79, v3 offset:9280
  ds_read_b128 v[12:15], v78 offset:8768
  v_max_f32 v8, v8, v11
  v_cmp_le_f32 vcc, 1317011456, v8
  v_mov_b64 v[24:25], 0
  v_mov_b64 v[26:27], 0
  ds_read_b128 v[56:59], v75 offset:37888
  s_cbranch_vccnz Cf1_mx
Cf1_mxok:
  s_waitcnt lgkmcnt(2)
  s_barrier
  ds_read_b128 v[0:3], v78 offset:8704
  s_waitcnt lgkmcnt(2)
  v_smfmac_f32_16x16x64_bf16 v[16:19], v[12:15], v[44:51], v74
  ds_read_b128 v[4:7], v78 offset:8832
  v_smfmac_f32_16x16x64_bf16 v[20:23], v[12:15], a[200:207], v74
  ds_read_b128 v[8:11], v78 offset:8896
  v_smfmac_f32_16x16x64_bf16 v[24:27], v[12:15], a[216:223], v74
  ds_read_b128 v[36:39], v75 offset:38912
  s_waitcnt lgkmcnt(3)
  v_smfmac_f32_16x16x64_bf16 v[16:19], v[0:3], v[60:67], v74
  ds_read_b128 v[40:43], v75 offset:39936
  s_waitcnt lgkmcnt(3)
  v_smfmac_f32_16x16x64_bf16 v[16:19], v[4:7], a[176:183], v74
  ds_read_b128 v[68:71], v76 offset:13824
  s_waitcnt lgkmcnt(3)
  v_smfmac_f32_16x16x64_bf16 v[16:19], v[8:11], a[184:191], v74
  ds_read_b128 v[44:47], v75 offset:53248
  v_smfmac_f32_16x16x64_bf16 v[20:23], v[0:3], a[192:199], v74
  ds_read_b128 v[48:51], v75 offset:54272
  v_smfmac_f32_16x16x64_bf16 v[20:23], v[4:7], v[52:59], v74
  ds_read_b128 v[60:63], v75 offset:55296
  s_waitcnt lgkmcnt(4)
  v_cvt_pk_bf16_f32 v16, v16, v17
  v_cvt_pk_bf16_f32 v17, v18, v19
  v_bfi_b32 v16, 1, s72, v16
  v_smfmac_f32_16x16x64_bf16 v[20:23], v[8:11], v[36:43], v74
  s_waitcnt lgkmcnt(3)
  buffer_store_dwordx2 v[16:17], v68, s[8:11], s73 offen
  v_mov_b64 v[32:33], 0
  v_smfmac_f32_16x16x64_bf16 v[24:27], v[0:3], a[208:215], v74
  ds_read_b128 v[64:67], v75 offset:56320
  v_mov_b64 v[34:35], 0
  v_smfmac_f32_16x16x64_bf16 v[24:27], v[4:7], a[224:231], v74
  v_cvt_pk_bf16_f32 v20, v20, v21
  v_cvt_pk_bf16_f32 v21, v22, v23
  v_bfi_b32 v20, 1, s72, v20
  v_smfmac_f32_16x16x64_bf16 v[24:27], v[8:11], a[232:239], v74
  buffer_store_dwordx2 v[20:21], v68, s[8:11], s74 offen
  s_waitcnt lgkmcnt(2)
  v_smfmac_f32_16x16x64_bf16 v[32:35], v[0:3], v[44:51], v74
  s_waitcnt lgkmcnt(0)
  v_smfmac_f32_16x16x64_bf16 v[32:35], v[12:15], v[60:67], v74
  v_cvt_pk_bf16_f32 v24, v24, v25
  v_cvt_pk_bf16_f32 v25, v26, v27
  v_bfi_b32 v24, 1, s72, v24
  v_smfmac_f32_16x16x64_bf16 v[32:35], v[4:7], a[240:247], v74
  buffer_store_dwordx2 v[24:25], v68, s[8:11], s75 offen
  v_smfmac_f32_16x16x64_bf16 v[32:35], v[8:11], a[248:255], v74
  v_mov_b64 v[18:19], v[72:73]
  s_nop 4
  v_cvt_pk_bf16_f32 v32, v32, v33
  v_cvt_pk_bf16_f32 v33, v34, v35
  v_bfi_b32 v32, 1, s72, v32
  buffer_store_dwordx2 v[32:33], v68, s[8:11], s76 offen
  ds_read_b128 v[0:3], v76 offset:14848
  s_waitcnt lgkmcnt(0)
  ds_read_b64 v[16:17], v77 offset:264
  s_waitcnt lgkmcnt(0)
  ds_read_b128 v[64:67], v76 offset:23552
  s_waitcnt lgkmcnt(0)
  s_add_u32 s66, s66, 1
  s_xor_b32 s64, s64, 16384
  s_xor_b32 s65, s65, 16384
  s_add_u32 s58, s58, 655360
  s_add_u32 s59, s59, 655360
  s_add_u32 s70, s70, 655360
  s_add_u32 s68, s68, 655360
  s_mov_b32 m0, 11776
  s_add_u32 s85, s65, 7168
  v_xor_b32 v75, 0x8000, v75
  v_mov_b64 v[28:29], 0
  v_mov_b64 v[30:31], 0
  v_mov_b64 v[32:33], 0
  v_mov_b64 v[34:35], 0
  v_mov_b64 v[20:21], 0
  v_mov_b64 v[22:23], 0
  v_mov_b64 v[24:25], 0
  v_mov_b64 v[26:27], 0
  v_mov_b32 v68, 14880
  buffer_load_dwordx4 v[52:55], v76, s[8:11], s60 offen offset:0 sc1
  buffer_load_dwordx4 v[56:59], v76, s[8:11], s60 offen offset:1024 sc1
  s_waitcnt lgkmcnt(0)
  s_waitcnt vmcnt(1)
  v_mfma_f32_16x16x32_bf16 v[4:7], v[0:3], v[52:55], 0
  v_bitop3_b32 v72, v52, v54, s72 bitop3:0x7e
  s_waitcnt vmcnt(0)
  v_mfma_f32_16x16x32_bf16 v[4:7], v[0:3], v[56:59], v[4:7]
  v_bitop3_b32 v73, v56, v58, s72 bitop3:0x7e
  v_bitop3_b32 v72, v72, v73, 1 bitop3:0xa8
  v_cmp_ne_u32 vcc, 0, v72
  s_nop 3
  v_add_f32_dpp v4, v4, v4 row_ror:4 row_mask:0xf bank_mask:0xf
  v_add_f32_dpp v5, v5, v5 row_ror:4 row_mask:0xf bank_mask:0xf
  s_cmp_eq_u64 vcc, 0
  v_add_f32_dpp v4, v4, v4 row_ror:8 row_mask:0xf bank_mask:0xf
  v_add_f32_dpp v5, v5, v5 row_ror:8 row_mask:0xf bank_mask:0xf
  s_cselect_b32 s54, s62, 268435456
  v_cvt_pk_bf16_f32 v4, v4, v5
  buffer_store_dword v4, v69, s[8:11], s54 offen
  s_cbranch_vccnz Cf1_h1r
  s_xor_b32 s62, s62, 16384
  buffer_store_dword v71, v69, s[8:11], s62 offen
  s_xor_b32 s72, s72, 1
  s_branch Cf1_h2
Cf1_h1r:
  s_mov_b64 exec, vcc
  buffer_load_dwordx4 v[52:55], v76, s[8:11], s60 offen offset:0 sc1
  buffer_load_dwordx4 v[56:59], v76, s[8:11], s60 offen offset:1024 sc1
  s_mov_b64 exec, -1
  s_add_u32 s67, s67, 1
  s_waitcnt vmcnt(1)
  v_mfma_f32_16x16x32_bf16 v[4:7], v[0:3], v[52:55], 0
  v_bitop3_b32 v72, v52, v54, s72 bitop3:0x7e
  s_waitcnt vmcnt(0)
  v_mfma_f32_16x16x32_bf16 v[4:7], v[0:3], v[56:59], v[4:7]
  v_bitop3_b32 v73, v56, v58, s72 bitop3:0x7e
  v_bitop3_b32 v72, v72, v73, 1 bitop3:0xa8
  v_cmp_ne_u32 vcc, 0, v72
  s_cbranch_vccz Cf1_h1p
Cf1_h1s:
  s_mov_b64 exec, vcc
  buffer_load_dwordx4 v[52:55], v76, s[8:11], s60 offen offset:0 sc1
  buffer_load_dwordx4 v[56:59], v76, s[8:11], s60 offen offset:1024 sc1
  s_mov_b64 exec, -1
  s_add_u32 s67, s67, 1
  s_waitcnt vmcnt(1)
  v_mfma_f32_16x16x32_bf16 v[4:7], v[0:3], v[52:55], 0
  v_bitop3_b32 v72, v52, v54, s72 bitop3:0x7e
  s_waitcnt vmcnt(0)
  v_mfma_f32_16x16x32_bf16 v[4:7], v[0:3], v[56:59], v[4:7]
  v_bitop3_b32 v73, v56, v58, s72 bitop3:0x7e
  v_bitop3_b32 v72, v72, v73, 1 bitop3:0xa8
  v_cmp_ne_u32 vcc, 0, v72
  s_cbranch_vccz Cf1_h1p
  s_cmp_lt_u32 s67, 131072
  s_cbranch_scc1 Cf1_h1s
Cf1_h1p:
  s_nop 2
  v_add_f32_dpp v4, v4, v4 row_ror:4 row_mask:0xf bank_mask:0xf
  v_add_f32_dpp v5, v5, v5 row_ror:4 row_mask:0xf bank_mask:0xf
  s_nop 0
  v_add_f32_dpp v4, v4, v4 row_ror:8 row_mask:0xf bank_mask:0xf
  v_add_f32_dpp v5, v5, v5 row_ror:8 row_mask:0xf bank_mask:0xf
  v_cvt_pk_bf16_f32 v4, v4, v5
  buffer_store_dword v4, v69, s[8:11], s62 offen
  s_xor_b32 s62, s62, 16384
  buffer_store_dword v71, v69, s[8:11], s62 offen
  s_xor_b32 s72, s72, 1
  s_branch Cf1_h2
Cf1_h2r:
  s_mov_b64 exec, vcc
  buffer_load_dwordx4 v[8:11], v76, s[8:11], s65 offen offset:2048 sc1
  s_mov_b64 exec, -1
  s_add_u32 s67, s67, 1
  s_waitcnt vmcnt(4)
  v_max3_u32 v72, v8, v9, v10
  v_max_u32 v72, v72, v11
  ds_write_b128 v76, v[8:11] offset:6656
  v_cmp_eq_u32 vcc, -1, v72
  s_cbranch_vccz Cf1_h2w
  s_mov_b64 exec, vcc
  buffer_load_dwordx4 v[8:11], v76, s[8:11], s65 offen offset:2048 sc1
  s_mov_b64 exec, -1
  s_add_u32 s67, s67, 1
  s_waitcnt vmcnt(4)
  v_max3_u32 v72, v8, v9, v10
  v_max_u32 v72, v72, v11
  ds_write_b128 v76, v[8:11] offset:6656
  v_cmp_eq_u32 vcc, -1, v72
  s_cbranch_vccz Cf1_h2w
Cf1_h2s:
  s_mov_b64 exec, vcc
  buffer_load_dwordx4 v[8:11], v76, s[8:11], s65 offen offset:2048 sc1
  s_mov_b64 exec, -1
  s_add_u32 s67, s67, 1
  s_waitcnt vmcnt(2)
  v_max3_u32 v72, v8, v9, v10
  v_max_u32 v72, v72, v11
  ds_write_b128 v76, v[8:11] offset:6656
  v_cmp_eq_u32 vcc, -1, v72
  s_cbranch_vccz Cf1_h2w
  s_mov_b64 exec, vcc
  buffer_load_dwordx4 v[8:11], v76, s[8:11], s65 offen offset:2048 sc1
  s_mov_b64 exec, -1
  s_add_u32 s67, s67, 1
  s_waitcnt vmcnt(2)
  v_max3_u32 v72, v8, v9, v10
  v_max_u32 v72, v72, v11
  ds_write_b128 v76, v[8:11] offset:6656
  v_cmp_eq_u32 vcc, -1, v72
  s_cbranch_vccz Cf1_h2w
  s_mov_b64 exec, vcc
  buffer_load_dwordx4 v[8:11], v76, s[8:11], s65 offen offset:2048 sc1
  s_mov_b64 exec, -1
  s_add_u32 s67, s67, 1
  s_waitcnt vmcnt(2)
  v_max3_u32 v72, v8, v9, v10
  v_max_u32 v72, v72, v11
  ds_write_b128 v76, v[8:11] offset:6656
  v_cmp_eq_u32 vcc, -1, v72
  s_cbranch_vccz Cf1_h2w
  s_cmp_lt_u32 s67, 131072
  s_cbranch_scc1 Cf1_h2s
  s_branch Cf1_h2w
Cf1_rec:
  s_nop 7
  s_waitcnt vmcnt(0) lgkmcnt(0)
  v_max3_u32 v72, v0, v1, v2
  v_max3_u32 v72, v72, v3, v4
  v_max3_u32 v72, v72, v5, v6
  v_max3_u32 v72, v72, v7, v8
  v_max3_u32 v72, v72, v9, v10
  v_max3_u32 v72, v72, v11, v12
  v_max3_u32 v72, v72, v13, v14
  v_max3_u32 v72, v72, v15, v16
  v_max3_u32 v72, v72, v17, v18
  v_max_u32 v72, v72, v19
  v_cmp_eq_u32 vcc, -1, v72
  s_cbranch_vccz Cf1_recok
  s_barrier
  v_mov_b64 v[20:21], 0
  v_mov_b64 v[22:23], 0
  v_mov_b64 v[24:25], 0
  v_mov_b64 v[26:27], 0
  v_mov_b64 v[28:29], 0
  v_mov_b64 v[30:31], 0
  v_mov_b64 v[32:33], 0
  v_mov_b64 v[34:35], 0
  s_waitcnt lgkmcnt(0)
  s_barrier
  ds_read_b128 v[0:3], v76 offset:4608
  s_waitcnt lgkmcnt(0)
  v_smfmac_f32_16x16x64_bf16 v[20:23], v[0:3], v[80:87], v74
  v_smfmac_f32_16x16x64_bf16 v[24:27], v[0:3], v[88:95], v74
  ds_read_b128 v[60:63], v76 offset:20480
  ds_read_b128 v[64:67], v76 offset:21504
  s_waitcnt lgkmcnt(0)
  v_smfmac_f32_16x16x64_bf16 v[28:31], v[0:3], v[60:67], v74
  ds_read_b128 v[60:63], v76 offset:22528
  ds_read_b128 v[64:67], v76 offset:23552
  s_waitcnt lgkmcnt(0)
  v_smfmac_f32_16x16x64_bf16 v[32:35], v[0:3], v[60:67], v74
  ds_read_b128 v[4:7], v76 offset:5632
  s_waitcnt lgkmcnt(0)
  v_smfmac_f32_16x16x64_bf16 v[20:23], v[4:7], v[96:103], v74
  v_smfmac_f32_16x16x64_bf16 v[24:27], v[4:7], v[104:111], v74
  ds_read_b128 v[60:63], v76 offset:36864
  ds_read_b128 v[64:67], v76 offset:37888
  s_waitcnt lgkmcnt(0)
  v_smfmac_f32_16x16x64_bf16 v[28:31], v[4:7], v[60:67], v74
  ds_read_b128 v[60:63], v76 offset:38912
  ds_read_b128 v[64:67], v76 offset:39936
  s_waitcnt lgkmcnt(0)
  v_smfmac_f32_16x16x64_bf16 v[32:35], v[4:7], v[60:67], v74
  ds_read_b128 v[8:11], v76 offset:6656
  s_waitcnt lgkmcnt(0)
  v_smfmac_f32_16x16x64_bf16 v[20:23], v[8:11], v[112:119], v74
  v_smfmac_f32_16x16x64_bf16 v[24:27], v[8:11], v[120:127], v74
  v_smfmac_f32_16x16x64_bf16 v[28:31], v[8:11], v[208:215], v74
  v_smfmac_f32_16x16x64_bf16 v[32:35], v[8:11], v[216:223], v74
  ds_read_b128 v[12:15], v76 offset:7680
  s_waitcnt lgkmcnt(0)
  v_smfmac_f32_16x16x64_bf16 v[20:23], v[12:15], v[128:135], v74
  v_smfmac_f32_16x16x64_bf16 v[24:27], v[12:15], v[136:143], v74
  v_smfmac_f32_16x16x64_bf16 v[28:31], v[12:15], v[224:231], v74
  v_smfmac_f32_16x16x64_bf16 v[32:35], v[12:15], v[232:239], v74
  ds_read_b128 v[8:11], v76 offset:8704
  s_waitcnt lgkmcnt(0)
  v_smfmac_f32_16x16x64_bf16 v[20:23], v[8:11], v[144:151], v74
  v_smfmac_f32_16x16x64_bf16 v[24:27], v[8:11], v[152:159], v74
  ds_read_b128 v[60:63], v76 offset:53248
  ds_read_b128 v[64:67], v76 offset:54272
  s_waitcnt lgkmcnt(0)
  v_smfmac_f32_16x16x64_bf16 v[28:31], v[8:11], v[60:67], v74
  ds_read_b128 v[60:63], v76 offset:55296
  ds_read_b128 v[64:67], v76 offset:56320
  s_waitcnt lgkmcnt(0)
  v_smfmac_f32_16x16x64_bf16 v[32:35], v[8:11], v[60:67], v74
  ds_read_b128 v[0:3], v76 offset:9728
  s_waitcnt lgkmcnt(0)
  v_smfmac_f32_16x16x64_bf16 v[20:23], v[0:3], v[160:167], v74
  v_smfmac_f32_16x16x64_bf16 v[24:27], v[0:3], v[168:175], v74
  ds_read_b128 v[60:63], v75 offset:20480
  ds_read_b128 v[64:67], v75 offset:21504
  s_waitcnt lgkmcnt(0)
  v_smfmac_f32_16x16x64_bf16 v[28:31], v[0:3], v[60:67], v74
  ds_read_b128 v[60:63], v75 offset:22528
  ds_read_b128 v[64:67], v75 offset:23552
  s_waitcnt lgkmcnt(0)
  v_smfmac_f32_16x16x64_bf16 v[32:35], v[0:3], v[60:67], v74
  ds_read_b128 v[16:19], v76 offset:10752
  ds_read_b128 v[60:63], v75 offset:4096
  ds_read_b128 v[64:67], v75 offset:5120
  s_waitcnt lgkmcnt(0)
  v_smfmac_f32_16x16x64_bf16 v[20:23], v[16:19], v[60:67], v74
  ds_read_b128 v[60:63], v75 offset:6144
  ds_read_b128 v[64:67], v75 offset:7168
  s_waitcnt lgkmcnt(0)
  v_smfmac_f32_16x16x64_bf16 v[24:27], v[16:19], v[60:67], v74
  v_smfmac_f32_16x16x64_bf16 v[28:31], v[16:19], v[240:247], v74
  v_smfmac_f32_16x16x64_bf16 v[32:35], v[16:19], v[248:255], v74
  ds_read_b128 v[4:7], v76 offset:11776
  s_waitcnt lgkmcnt(0)
  v_smfmac_f32_16x16x64_bf16 v[20:23], v[4:7], v[176:183], v74
  v_smfmac_f32_16x16x64_bf16 v[24:27], v[4:7], v[184:191], v74
  v_smfmac_f32_16x16x64_bf16 v[28:31], v[4:7], a[0:7], v74
  v_smfmac_f32_16x16x64_bf16 v[32:35], v[4:7], a[8:15], v74
  ds_read_b128 v[12:15], v76 offset:12800
  s_waitcnt lgkmcnt(0)
  v_smfmac_f32_16x16x64_bf16 v[20:23], v[12:15], v[192:199], v74
  v_smfmac_f32_16x16x64_bf16 v[24:27], v[12:15], v[200:207], v74
  v_smfmac_f32_16x16x64_bf16 v[28:31], v[12:15], a[16:23], v74
  v_smfmac_f32_16x16x64_bf16 v[32:35], v[12:15], a[24:31], v74
  v_add_f32 v20, v20, v22
  v_add_f32 v21, v21, v23
  v_add_f32 v24, v24, v26
  v_cvt_pk_bf16_f32 v22, v20, v24
  ds_write_b32 v79, v22 offset:0
  v_add_f32 v25, v25, v27
  v_cvt_pk_bf16_f32 v23, v21, v25
  ds_write_b32 v79, v23 offset:576
  v_add_f32 v28, v28, v30
  v_add_f32 v29, v29, v31
  s_waitcnt lgkmcnt(0)
  s_nop 1
  s_branch Cf1_recok
Cf1_mx:
  s_waitcnt lgkmcnt(0)
  s_barrier
  buffer_load_dwordx4 v[52:55], v76, s[8:11], s59 offen offset:0 sc1
  buffer_load_dwordx4 v[0:3], v76, s[8:11], s58 offen offset:0 sc1
  ds_read_b128 v[20:23], v77 offset:0
  ds_read_b128 v[28:31], v77 offset:256
  buffer_load_dwordx4 v[56:59], v76, s[8:11], s59 offen offset:1024 sc1
  buffer_load_dwordx4 v[4:7], v76, s[8:11], s58 offen offset:1024 sc1
  ds_read_b128 v[24:27], v77 offset:128
  ds_read_b128 v[32:35], v77 offset:384
  s_waitcnt vmcnt(2) lgkmcnt(3)
  v_mfma_f32_16x16x32_bf16 v[8:11], v[0:3], v[20:23], 0
  s_waitcnt vmcnt(0) lgkmcnt(1)
  v_mfma_f32_16x16x32_bf16 v[8:11], v[4:7], v[24:27], v[8:11]
  v_mfma_f32_16x16x32_bf16 v[12:15], v[28:31], v[20:23], 0
  s_waitcnt lgkmcnt(0)
  v_mfma_f32_16x16x32_bf16 v[12:15], v[32:35], v[24:27], v[12:15]
  v_add_f32_dpp v8, v10, v8 quad_perm:[2,3,0,1] row_mask:0xf bank_mask:0xf
  v_add_f32_dpp v9, v11, v9 quad_perm:[2,3,0,1] row_mask:0xf bank_mask:0xf
  s_nop 0
  v_mov_b32_dpp v8, v8 quad_perm:[0,1,0,1] row_mask:0xf bank_mask:0xf
  v_mov_b32_dpp v9, v9 quad_perm:[0,1,0,1] row_mask:0xf bank_mask:0xf
  s_nop 1
  v_add_f32_dpp v12, v14, v12 quad_perm:[2,3,0,1] row_mask:0xf bank_mask:0xf
  v_add_f32_dpp v13, v15, v13 quad_perm:[2,3,0,1] row_mask:0xf bank_mask:0xf
  s_nop 0
  v_mov_b32_dpp v12, v12 quad_perm:[0,1,0,1] row_mask:0xf bank_mask:0xf
  v_mov_b32_dpp v13, v13 quad_perm:[0,1,0,1] row_mask:0xf bank_mask:0xf
  v_mul_f32 v12, s69, v12
  ds_write_b32 v78, v8 offset:8708
  v_mul_f32 v13, s69, v13
  ds_write_b32 v78, v9 offset:8772
  s_waitcnt lgkmcnt(0)
  s_barrier
  ds_read_b128 v[36:39], v78 offset:8704
  ds_read_b128 v[40:43], v78 offset:8768
  s_waitcnt lgkmcnt(0)
  s_barrier
  v_max_f32 v16, v36, v37
  v_max3_f32 v16, v16, v38, v39
  v_max3_f32 v16, v16, v40, v41
  v_max3_f32 v16, v16, v42, v43
  v_max3_f32 v16, v16, v12, v13
  v_mov_b32 v17, v16
  s_nop 1
  v_permlane16_swap_b32 v16, v17
  v_max_f32 v16, v16, v17
  v_mov_b32 v17, v16
  s_nop 1
  v_permlane32_swap_b32 v16, v17
  v_max_f32 v16, v16, v17
  v_sub_f32 v36, v36, v16
  v_sub_f32 v37, v37, v16
  v_sub_f32 v38, v38, v16
  v_sub_f32 v39, v39, v16
  v_sub_f32 v40, v40, v16
  v_sub_f32 v41, v41, v16
  v_sub_f32 v42, v42, v16
  v_sub_f32 v43, v43, v16
  v_sub_f32 v12, v12, v16
  v_sub_f32 v13, v13, v16
  v_exp_f32 v36, v36
  v_exp_f32 v37, v37
  v_exp_f32 v38, v38
  v_exp_f32 v39, v39
  v_exp_f32 v40, v40
  v_exp_f32 v41, v41
  v_exp_f32 v42, v42
  v_exp_f32 v43, v43
  v_exp_f32 v12, v12
  v_exp_f32 v13, v13
  v_cvt_pk_bf16_f32 v32, v36, v40
  v_cvt_pk_bf16_f32 v33, v37, v41
  v_cvt_pk_bf16_f32 v34, v38, v42
  v_cvt_pk_bf16_f32 v35, v39, v43
  v_cvt_pk_bf16_f32 v28, v12, v13
  v_cvt_pk_bf16_f32 v31, v12, v13
  v_mov_b32 v29, 0
  v_mov_b32 v30, 0
  v_mfma_f32_16x16x32_bf16 v[8:11], v[32:35], v[68:71], 0
  v_mfma_f32_16x16x32_bf16 v[0:3], v[32:35], v[52:55], 0
  v_mfma_f32_16x16x32_bf16 v[4:7], v[32:35], v[56:59], 0
  v_mfma_f32_16x16x16_bf16 v[8:11], v[28:29], v[68:69], v[8:11]
  v_mfma_f32_16x16x16_bf16 v[0:3], v[28:29], v[72:73], v[0:3]
  v_mfma_f32_16x16x16_bf16 v[4:7], v[30:31], v[72:73], v[4:7]
  ds_read_b128 v[52:55], v75 offset:36864
  v_rcp_f32 v10, v8
  v_rcp_f32 v11, v9
  v_mul_f32 v0, v10, v0
  v_mul_f32 v1, v11, v1
  v_max3_f32 v8, v8, v9, v10
  v_mul_f32 v4, v10, v4
  v_mul_f32 v5, v11, v5
  v_cvt_pk_bf16_f32 v2, v0, v4
  ds_write_b32 v79, v2 offset:8704
  v_cvt_pk_bf16_f32 v3, v1, v5
  ds_write_b32 v79, v3 offset:9280
  ds_read_b128 v[12:15], v78 offset:8768
  ds_read_b128 v[56:59], v75 offset:37888
  v_mov_b64 v[16:17], 0
  v_mov_b64 v[18:19], 0
  v_mov_b64 v[20:21], 0
  v_mov_b64 v[22:23], 0
  v_mov_b64 v[24:25], 0
  v_mov_b64 v[26:27], 0
  s_branch Cf1_mxok
Cf1_last:
  ds_read_b128 v[4:7], v76 offset:5632
  ds_read_b128 v[12:15], v76 offset:7680
  ds_read_b128 v[44:47], v76 offset:36864
  ds_read_b128 v[48:51], v76 offset:37888
  s_nop 5
  v_mov_b64 v[20:21], 0
  v_mov_b64 v[22:23], 0
  v_mov_b64 v[24:25], 0
  v_mov_b64 v[26:27], 0
  s_waitcnt lgkmcnt(4)
  v_smfmac_f32_16x16x64_bf16 v[28:31], v[0:3], v[36:43], v74
  ds_read_b128 v[36:39], v76 offset:38912
  ds_read_b128 v[40:43], v76 offset:39936
  v_smfmac_f32_16x16x64_bf16 v[32:35], v[0:3], v[60:67], v74
  s_waitcnt lgkmcnt(5)
  v_smfmac_f32_16x16x64_bf16 v[20:23], v[0:3], a[32:39], v74
  ds_read_b128 v[60:63], v76 offset:53248
  ds_read_b128 v[64:67], v76 offset:54272
  v_smfmac_f32_16x16x64_bf16 v[24:27], v[0:3], a[40:47], v74
  s_waitcnt lgkmcnt(4)
  v_smfmac_f32_16x16x64_bf16 v[20:23], v[4:7], a[48:55], v74
  buffer_store_dwordx4 v[16:19], v76, s[8:11], s68 offen sc1
  v_smfmac_f32_16x16x64_bf16 v[24:27], v[4:7], a[56:63], v74
  v_smfmac_f32_16x16x64_bf16 v[28:31], v[4:7], v[44:51], v74
  s_waitcnt lgkmcnt(2)
  v_smfmac_f32_16x16x64_bf16 v[20:23], v[8:11], a[64:71], v74
  ds_read_b128 v[44:47], v76 offset:55296
  ds_read_b128 v[48:51], v76 offset:56320
  v_smfmac_f32_16x16x64_bf16 v[24:27], v[8:11], a[72:79], v74
  v_smfmac_f32_16x16x64_bf16 v[32:35], v[4:7], v[36:43], v74
  v_smfmac_f32_16x16x64_bf16 v[28:31], v[8:11], v[208:215], v74
  ds_read_b128 v[36:39], v75 offset:20480
  ds_read_b128 v[40:43], v75 offset:21504
  v_smfmac_f32_16x16x64_bf16 v[32:35], v[8:11], v[216:223], v74
  v_smfmac_f32_16x16x64_bf16 v[20:23], v[12:15], a[80:87], v74
  v_smfmac_f32_16x16x64_bf16 v[24:27], v[12:15], a[88:95], v74
  v_smfmac_f32_16x16x64_bf16 v[28:31], v[12:15], v[224:231], v74
  v_smfmac_f32_16x16x64_bf16 v[32:35], v[12:15], v[232:239], v74
  s_waitcnt vmcnt(2)
  s_waitcnt vmcnt(1)
  s_barrier
Cf1_lastr:
  ds_read_b128 v[8:11], v76 offset:8704
  ds_read_b128 v[0:3], v76 offset:9728
  ds_read_b128 v[16:19], v76 offset:10752
  ds_read_b128 v[4:7], v76 offset:11776
  ds_read_b128 v[12:15], v76 offset:12800
  s_waitcnt lgkmcnt(3)
  v_max3_u32 v72, v0, v1, v2
  s_waitcnt lgkmcnt(1)
  v_max3_u32 v72, v72, v3, v4
  v_max3_u32 v72, v72, v5, v6
  v_max3_u32 v72, v72, v7, v8
  v_max3_u32 v72, v72, v9, v10
  s_waitcnt lgkmcnt(0)
  v_max3_u32 v72, v72, v11, v12
  v_max3_u32 v72, v72, v13, v14
  v_max3_u32 v72, v72, v15, v16
  v_max3_u32 v72, v72, v17, v18
  v_max_u32 v72, v72, v19
  v_cmp_eq_u32 vcc, -1, v72
  s_cbranch_vccnz Cf1_lastp
Cf1_lastg:
  v_smfmac_f32_16x16x64_bf16 v[28:31], v[8:11], v[60:67], v74
  ds_read_b128 v[60:63], v75 offset:22528
  ds_read_b128 v[64:67], v75 offset:23552
  v_smfmac_f32_16x16x64_bf16 v[32:35], v[8:11], v[44:51], v74
  v_smfmac_f32_16x16x64_bf16 v[28:31], v[0:3], v[36:43], v74
  v_smfmac_f32_16x16x64_bf16 v[28:31], v[16:19], v[240:247], v74
  v_smfmac_f32_16x16x64_bf16 v[28:31], v[4:7], a[0:7], v74
  v_smfmac_f32_16x16x64_bf16 v[28:31], v[12:15], a[16:23], v74
  v_smfmac_f32_16x16x64_bf16 v[32:35], v[16:19], v[248:255], v74
  v_smfmac_f32_16x16x64_bf16 v[32:35], v[4:7], a[8:15], v74
  s_waitcnt lgkmcnt(0)
  v_smfmac_f32_16x16x64_bf16 v[32:35], v[12:15], a[24:31], v74
  v_smfmac_f32_16x16x64_bf16 v[32:35], v[0:3], v[60:67], v74
  v_smfmac_f32_16x16x64_bf16 v[20:23], v[8:11], a[96:103], v74
  v_smfmac_f32_16x16x64_bf16 v[20:23], v[0:3], a[112:119], v74
  v_add_f32 v28, v28, v30
  v_add_f32 v32, v32, v34
  v_cvt_pk_bf16_f32 v30, v28, v32
  v_smfmac_f32_16x16x64_bf16 v[20:23], v[16:19], a[128:135], v74
  ds_write_b32 v79, v30 offset:256
  v_add_f32 v29, v29, v31
  v_add_f32 v33, v33, v35
  v_cvt_pk_bf16_f32 v31, v29, v33
  v_smfmac_f32_16x16x64_bf16 v[20:23], v[4:7], a[144:151], v74
  ds_write_b32 v79, v31 offset:832
  v_smfmac_f32_16x16x64_bf16 v[20:23], v[12:15], a[160:167], v74
  v_smfmac_f32_16x16x64_bf16 v[24:27], v[8:11], a[104:111], v74
  v_smfmac_f32_16x16x64_bf16 v[24:27], v[0:3], a[120:127], v74
  v_smfmac_f32_16x16x64_bf16 v[24:27], v[16:19], a[136:143], v74
  s_waitcnt lgkmcnt(0)
  s_barrier
  ds_read_b64 v[52:53], v77 offset:264
  v_add_f32 v20, v20, v22
  v_smfmac_f32_16x16x64_bf16 v[24:27], v[4:7], a[152:159], v74
  v_add_f32 v21, v21, v23
  v_smfmac_f32_16x16x64_bf16 v[24:27], v[12:15], a[168:175], v74
  v_cvt_pk_bf16_f32 v54, v20, v21
  s_add_u32 s68, s68, 655360
  s_nop 3
  v_add_f32 v24, v24, v26
  v_add_f32 v25, v25, v27
  v_cvt_pk_bf16_f32 v55, v24, v25
  s_waitcnt lgkmcnt(0)
  buffer_store_dwordx4 v[52:55], v76, s[8:11], s68 offen sc1
  s_branch Cf1_done
Cf1_lastp:
  s_add_u32 s72, s72, 2
  s_cmp_ge_u32 s72, 131072
  s_cbranch_scc1 Cf1_lastg
  s_barrier
  buffer_load_dwordx4 v76, s[8:11], s85 offen offset:0 sc1 lds
  s_waitcnt vmcnt(0)
  s_barrier
  s_branch Cf1_lastr
Cf1_done:
  s_branch L_cexit
L_w2:
  v_mov_b64 v[20:21], 0
  v_mov_b64 v[22:23], 0
  v_mov_b64 v[24:25], 0
  v_mov_b64 v[26:27], 0
  v_mov_b64 v[28:29], 0
  v_mov_b64 v[30:31], 0
  v_mov_b64 v[32:33], 0
  v_mov_b64 v[34:35], 0
  s_mov_b32 s78, 0x3f803f80
  s_mov_b32 s79, s78
  s_mov_b32 s65, 360448
  s_mov_b32 m0, 15872
  s_lshl_b32 s71, s53, 2
  s_add_u32 s71, s71, 128
  s_movk_i32 s56, 0x1000
  v_lshlrev_b32 v73, 2, v76
  v_mov_b32 v72, 0
  s_mov_b64 s[16:17], s[8:9]
  s_mov_b32 s18, 268435456
  s_mov_b32 s19, 0x20000
  s_getpc_b64 s[20:21]
Cf2_pc:
  s_add_u32 s20, s20, (Cf2_last - Cf2_pc)
  s_addc_u32 s21, s21, 0
  v_mov_b32 v68, 14880
  buffer_load_dwordx4 v[52:55], v76, s[8:11], s59 offen offset:0 sc1
  buffer_load_dwordx4 v[56:59], v76, s[8:11], s59 offen offset:1024 sc1
  ds_read_b128 v[36:39], v76 offset:24576
  ds_read_b128 v[40:43], v76 offset:25600
  ds_read_b128 v[60:63], v76 offset:26624
  ds_read_b128 v[64:67], v76 offset:27648
  ds_read_b128 v[0:3], v76 offset:4608
  ds_read_b128 v[4:7], v76 offset:5632
  ds_read_b128 v[8:11], v76 offset:6656
  ds_read_b128 v[12:15], v76 offset:7680
  s_waitcnt lgkmcnt(0)
  s_cmp_eq_u32 s66, 1
  s_branch Cf2_top2
.p2align 6
Cf2_h2:
  buffer_load_dwordx4 v[12:15], v76, s[8:11], s65 offen offset:3072 sc1
  ds_read_b128 v[36:39], v76 offset:24576
  s_waitcnt lgkmcnt(0)
  s_cmp_eq_u32 s66, 62
  s_cselect_b64 s[16:17], s[20:21], s[16:17]
  s_cselect_b32 s18, (Cf2_done - Cf2_last), s18
  s_cselect_b32 s70, 0, s70
  s_cmp_eq_u32 s66, 63
  s_cselect_b32 s59, 268435456, s59
  s_cselect_b32 s58, 268435456, s58
  buffer_load_dwordx4 v[12:15], v76, s[8:11], s65 offen offset:3072 sc1
  ds_read_b128 v[40:43], v76 offset:25600
  s_waitcnt lgkmcnt(0)
  v_mov_b64 v[20:21], 0
  v_mov_b64 v[22:23], 0
  v_mov_b64 v[24:25], 0
  v_mov_b64 v[26:27], 0
  v_mov_b32 v68, 14880
  v_lshlrev_b32 v73, 2, v76
  buffer_load_dwordx4 v[12:15], v76, s[8:11], s65 offen offset:3072 sc1
  buffer_load_dwordx4 v[52:55], v76, s[8:11], s59 offen offset:0 sc1
  buffer_load_dwordx4 v[56:59], v76, s[8:11], s59 offen offset:1024 sc1
  s_waitcnt vmcnt(4)
  v_max3_u32 v72, v12, v13, v14
  v_max_u32 v72, v72, v15
  ds_write_b128 v76, v[12:15] offset:7680
  v_cmp_eq_u32 vcc, -1, v72
  s_cbranch_vccnz Cf2_h2r
Cf2_h2w:
  s_cmp_eq_u32 s66, 63
  s_waitcnt lgkmcnt(0)
  s_barrier
  ds_read_b128 v[0:3], v76 offset:4608
  buffer_load_dwordx4 v76, s[8:11], s85 offen offset:0 sc1 lds
Cf2_top2:
  v_smfmac_f32_16x16x64_bf16 v[20:23], v[12:15], v[128:135], v74
  s_cbranch_scc1 Cf2_last
  v_smfmac_f32_16x16x64_bf16 v[24:27], v[12:15], v[136:143], v74
  buffer_load_dwordx4 v[44:47], v76, s[8:11], s58 offen offset:0 sc1
  s_mov_b32 m0, 15872
  v_smfmac_f32_16x16x64_bf16 v[28:31], v[12:15], v[224:231], v74
  buffer_load_dwordx4 v[48:51], v76, s[8:11], s58 offen offset:1024 sc1
  v_smfmac_f32_16x16x64_bf16 v[32:35], v[12:15], v[232:239], v74
  ds_read_b128 v[4:7], v76 offset:5632
  s_waitcnt lgkmcnt(1)
  v_smfmac_f32_16x16x64_bf16 v[20:23], v[0:3], v[80:87], v74
  ds_read_b128 v[8:11], v76 offset:6656
  v_smfmac_f32_16x16x64_bf16 v[28:31], v[0:3], v[36:43], v74
  ds_read_b128 v[36:39], v76 offset:40960
  v_smfmac_f32_16x16x64_bf16 v[24:27], v[0:3], v[88:95], v74
  buffer_store_dwordx4 v[16:19], v76, s[8:11], s68 offen sc1
  ds_read_b128 v[40:43], v76 offset:41984
  v_smfmac_f32_16x16x64_bf16 v[32:35], v[0:3], v[60:67], v74
  buffer_load_dword v73, s[16:19], s70 offen lds
  ds_read_b128 v[60:63], v76 offset:43008
  s_waitcnt lgkmcnt(4)
  v_smfmac_f32_16x16x64_bf16 v[20:23], v[4:7], v[96:103], v74
  ds_read_b128 v[64:67], v76 offset:44032
  v_smfmac_f32_16x16x64_bf16 v[24:27], v[4:7], v[104:111], v74
  s_waitcnt vmcnt(5)
  s_waitcnt lgkmcnt(4)
  v_smfmac_f32_16x16x64_bf16 v[20:23], v[8:11], v[112:119], v74
  s_barrier
  ds_read_b128 v[12:15], v76 offset:8704
  s_waitcnt lgkmcnt(3)
  v_smfmac_f32_16x16x64_bf16 v[28:31], v[4:7], v[36:43], v74
  ds_read_b128 v[36:39], v76 offset:57344
  v_smfmac_f32_16x16x64_bf16 v[24:27], v[8:11], v[120:127], v74
  ds_read_b128 v[40:43], v76 offset:58368
  s_waitcnt lgkmcnt(3)
  v_smfmac_f32_16x16x64_bf16 v[32:35], v[4:7], v[60:67], v74
  ds_read_b128 v[0:3], v76 offset:9728
  v_smfmac_f32_16x16x64_bf16 v[28:31], v[8:11], v[208:215], v74
  ds_read_b128 v[60:63], v76 offset:59392
  v_smfmac_f32_16x16x64_bf16 v[32:35], v[8:11], v[216:223], v74
  s_waitcnt vmcnt(4)
  ds_read_b128 v[64:67], v76 offset:60416
  s_waitcnt lgkmcnt(5)
  v_smfmac_f32_16x16x64_bf16 v[20:23], v[12:15], v[144:151], v74
  s_barrier
  ds_read_b128 v[4:7], v76 offset:11776
  s_waitcnt lgkmcnt(4)
  v_smfmac_f32_16x16x64_bf16 v[28:31], v[12:15], v[36:43], v74
  ds_read_b128 v[8:11], v76 offset:12800
  ds_read_b128 v[36:39], v75 offset:8192
  v_smfmac_f32_16x16x64_bf16 v[24:27], v[12:15], v[152:159], v74
  ds_read_b128 v[16:19], v76 offset:10752
  s_waitcnt lgkmcnt(6)
  v_smfmac_f32_16x16x64_bf16 v[20:23], v[0:3], v[160:167], v74
  ds_read_b128 v[40:43], v75 offset:9216
  s_waitcnt lgkmcnt(5)
  v_smfmac_f32_16x16x64_bf16 v[32:35], v[12:15], v[60:67], v74
  ds_read_b128 v[60:63], v75 offset:10240
  v_smfmac_f32_16x16x64_bf16 v[24:27], v[0:3], v[168:175], v74
  ds_read_b128 v[64:67], v75 offset:11264
  s_waitcnt lgkmcnt(6)
  v_smfmac_f32_16x16x64_bf16 v[20:23], v[4:7], v[176:183], v74
  s_waitcnt lgkmcnt(5)
  v_smfmac_f32_16x16x64_bf16 v[20:23], v[8:11], v[192:199], v74
  s_waitcnt lgkmcnt(2)
  v_smfmac_f32_16x16x64_bf16 v[20:23], v[16:19], v[36:43], v74
  ds_read_b128 v[36:39], v75 offset:24576
  v_smfmac_f32_16x16x64_bf16 v[24:27], v[4:7], v[184:191], v74
  ds_read_b128 v[40:43], v75 offset:25600
  s_waitcnt lgkmcnt(2)
  v_smfmac_f32_16x16x64_bf16 v[24:27], v[16:19], v[60:67], v74
  ds_read_b128 v[60:63], v75 offset:26624
  v_add_f32 v20, v20, v22
  v_smfmac_f32_16x16x64_bf16 v[24:27], v[8:11], v[200:207], v74
  ds_read_b128 v[64:67], v75 offset:27648
  v_add_f32 v21, v21, v23
  v_smfmac_f32_16x16x64_bf16 v[28:31], v[16:19], v[240:247], v74
  v_mov_b64 v[70:71], s[78:79]
  v_smfmac_f32_16x16x64_bf16 v[28:31], v[4:7], a[0:7], v74
  s_waitcnt lgkmcnt(2)
  v_add_f32 v24, v24, v26
  v_smfmac_f32_16x16x64_bf16 v[28:31], v[0:3], v[36:43], v74
  ds_read_b128 v[36:39], v68
  v_cvt_pk_bf16_f32 v22, v20, v24
  v_smfmac_f32_16x16x64_bf16 v[28:31], v[8:11], a[16:23], v74
  ds_read_b128 v[40:43], v68
  ds_write_b32 v79, v22 offset:0
  s_waitcnt lgkmcnt(3)
  v_add_f32 v25, v25, v27
  v_cvt_pk_bf16_f32 v23, v21, v25
  v_smfmac_f32_16x16x64_bf16 v[32:35], v[0:3], v[60:67], v74
  ds_write_b32 v79, v23 offset:576
  v_cmp_u_f32 vcc, v20, v21
  v_smfmac_f32_16x16x64_bf16 v[32:35], v[16:19], v[248:255], v74
  v_add_f32 v28, v28, v30
  v_smfmac_f32_16x16x64_bf16 v[32:35], v[4:7], a[8:15], v74
  v_add_f32 v29, v29, v31
  v_smfmac_f32_16x16x64_bf16 v[32:35], v[8:11], a[24:31], v74
  s_cbranch_vccnz Cf2_rec
Cf2_recok:
  s_waitcnt lgkmcnt(3)
  v_smfmac_f32_16x16x64_bf16 v[36:39], v[16:19], a[128:135], v74
  s_waitcnt lgkmcnt(0)
  s_barrier
  ds_read_b128 v[60:63], v77
  v_smfmac_f32_16x16x64_bf16 v[40:43], v[16:19], a[136:143], v74
  ds_read_b128 v[64:67], v77 offset:128
  v_add_f32 v32, v32, v34
  v_cvt_pk_bf16_f32 v30, v28, v32
  v_smfmac_f32_16x16x64_bf16 v[36:39], v[0:3], a[112:119], v74
  ds_write_b32 v79, v30 offset:256
  v_add_f32 v33, v33, v35
  v_cvt_pk_bf16_f32 v31, v29, v33
  v_smfmac_f32_16x16x64_bf16 v[40:43], v[0:3], a[120:127], v74
  ds_write_b32 v79, v31 offset:832
  v_xor_b32 v75, 0x8000, v75
  v_smfmac_f32_16x16x64_bf16 v[36:39], v[4:7], a[144:151], v74
  ds_read_b128 v[0:3], v76 offset:4608
  v_mov_b32 v29, 0
  v_smfmac_f32_16x16x64_bf16 v[40:43], v[4:7], a[152:159], v74
  s_waitcnt vmcnt(2) lgkmcnt(3)
  v_mov_b32 v30, 0
  v_mfma_f32_16x16x32_bf16 v[44:47], v[44:47], v[60:63], 0
  ds_read_b128 v[4:7], v76 offset:5632
  s_waitcnt lgkmcnt(2)
  v_mfma_f32_16x16x32_bf16 v[44:47], v[48:51], v[64:67], v[44:47]
  s_barrier
  v_smfmac_f32_16x16x64_bf16 v[36:39], v[8:11], a[160:167], v74
  ds_read_b128 v[20:23], v77 offset:256
  ds_read_b128 v[24:27], v77 offset:384
  v_smfmac_f32_16x16x64_bf16 v[40:43], v[8:11], a[168:175], v74
  ds_read_b128 v[8:11], v76 offset:6656
  v_add_f32_dpp v72, v46, v44 quad_perm:[2,3,0,1] row_mask:0xf bank_mask:0xf
  v_add_f32_dpp v73, v47, v45 quad_perm:[2,3,0,1] row_mask:0xf bank_mask:0xf
  v_smfmac_f32_16x16x64_bf16 v[36:39], v[12:15], a[96:103], v74
  s_waitcnt lgkmcnt(4)
  v_exp_f32_dpp v72, v72 quad_perm:[0,1,0,1] row_mask:0xf bank_mask:0xf
  v_smfmac_f32_16x16x64_bf16 v[40:43], v[12:15], a[104:111], v74
  ds_read_b128 v[12:15], v76 offset:7680
  v_exp_f32_dpp v73, v73 quad_perm:[0,1,0,1] row_mask:0xf bank_mask:0xf
  v_smfmac_f32_16x16x64_bf16 v[36:39], v[0:3], a[32:39], v74
  s_waitcnt lgkmcnt(2)
  v_cvt_pk_bf16_f32 v72, v72, v73
  v_mfma_f32_16x16x32_bf16 v[20:23], v[20:23], v[60:63], 0
  ds_write_b32 v78, v72 offset:520
  v_mov_b64 v[16:17], 0
  v_mfma_f32_16x16x32_bf16 v[20:23], v[24:27], v[64:67], v[20:23]
  ds_read_b128 v[44:47], v75 offset:40960
  v_mov_b64 v[18:19], 0
  v_smfmac_f32_16x16x64_bf16 v[40:43], v[0:3], a[40:47], v74
  ds_read_b128 v[48:51], v75 offset:41984
  v_mov_b64 v[68:69], s[78:79]
  v_smfmac_f32_16x16x64_bf16 v[36:39], v[4:7], a[48:55], v74
  s_waitcnt lgkmcnt(4)
  v_add_f32_dpp v24, v22, v20 quad_perm:[2,3,0,1] row_mask:0xf bank_mask:0xf
  v_add_f32_dpp v25, v23, v21 quad_perm:[2,3,0,1] row_mask:0xf bank_mask:0xf
  v_smfmac_f32_16x16x64_bf16 v[36:39], v[8:11], a[64:71], v74
  s_waitcnt lgkmcnt(2)
  s_barrier
  ds_read_b128 v[32:35], v78 offset:512
  v_smfmac_f32_16x16x64_bf16 v[36:39], v[12:15], a[80:87], v74
  ds_read_b128 v[60:63], v75 offset:24576
  v_mul_f32 v24, s69, v24
  v_smfmac_f32_16x16x64_bf16 v[40:43], v[4:7], a[56:63], v74
  ds_read_b128 v[64:67], v75 offset:25600
  v_mul_f32 v25, s69, v25
  v_smfmac_f32_16x16x64_bf16 v[40:43], v[8:11], a[72:79], v74
  v_exp_f32_dpp v24, v24 quad_perm:[0,1,0,1] row_mask:0xf bank_mask:0xf
  v_smfmac_f32_16x16x64_bf16 v[40:43], v[12:15], a[88:95], v74
  s_waitcnt lgkmcnt(2)
  v_exp_f32_dpp v25, v25 quad_perm:[0,1,0,1] row_mask:0xf bank_mask:0xf
  v_mfma_f32_16x16x32_bf16 v[8:11], v[32:35], v[68:71], 0
  v_add_f32 v36, v36, v38
  v_add_f32 v37, v37, v39
  v_mfma_f32_16x16x32_bf16 v[0:3], v[32:35], v[52:55], 0
  v_add_f32 v40, v40, v42
  v_add_f32 v41, v41, v43
  v_mfma_f32_16x16x32_bf16 v[4:7], v[32:35], v[56:59], 0
  v_cvt_pk_bf16_f32 v28, v24, v25
  v_cvt_pk_bf16_f32 v72, v36, v37
  v_cvt_pk_bf16_f32 v73, v40, v41
  v_mfma_f32_16x16x16_bf16 v[8:11], v[28:29], v[68:69], v[8:11]
  v_cvt_pk_bf16_f32 v31, v24, v25
  v_mov_b64 v[20:21], 0
  v_mfma_f32_16x16x16_bf16 v[0:3], v[28:29], v[72:73], v[0:3]
  ds_read_b128 v[52:55], v75 offset:26624
  v_mov_b64 v[22:23], 0
  v_mfma_f32_16x16x16_bf16 v[4:7], v[30:31], v[72:73], v[4:7]
  v_rcp_f32 v10, v8
  v_rcp_f32 v11, v9
  v_mul_f32 v0, v10, v0
  v_mul_f32 v1, v11, v1
  v_max3_f32 v8, v8, v9, v10
  v_mul_f32 v4, v10, v4
  v_mul_f32 v5, v11, v5
  v_cvt_pk_bf16_f32 v2, v0, v4
  ds_write_b32 v79, v2 offset:8704
  v_cvt_pk_bf16_f32 v3, v1, v5
  ds_write_b32 v79, v3 offset:9280
  ds_read_b128 v[12:15], v78 offset:8832
  v_max_f32 v8, v8, v11
  v_cmp_le_f32 vcc, 1317011456, v8
  v_mov_b64 v[24:25], 0
  v_mov_b64 v[26:27], 0
  ds_read_b128 v[56:59], v75 offset:27648
  s_cbranch_vccnz Cf2_mx
Cf2_mxok:
  s_waitcnt lgkmcnt(2)
  s_barrier
  ds_read_b128 v[0:3], v78 offset:8896
  s_waitcnt lgkmcnt(2)
  v_smfmac_f32_16x16x64_bf16 v[16:19], v[12:15], a[176:183], v74
  ds_read_b128 v[4:7], v78 offset:8704
  v_smfmac_f32_16x16x64_bf16 v[20:23], v[12:15], v[44:51], v74
  ds_read_b128 v[8:11], v78 offset:8768
  v_smfmac_f32_16x16x64_bf16 v[24:27], v[12:15], a[224:231], v74
  ds_read_b128 v[36:39], v75 offset:43008
  s_waitcnt lgkmcnt(3)
  v_smfmac_f32_16x16x64_bf16 v[16:19], v[0:3], a[184:191], v74
  ds_read_b128 v[40:43], v75 offset:44032
  s_waitcnt lgkmcnt(3)
  v_smfmac_f32_16x16x64_bf16 v[16:19], v[4:7], v[60:67], v74
  ds_read_b128 v[68:71], v76 offset:13824
  s_waitcnt lgkmcnt(3)
  v_smfmac_f32_16x16x64_bf16 v[16:19], v[8:11], v[52:59], v74
  ds_read_b128 v[44:47], v75 offset:57344
  v_smfmac_f32_16x16x64_bf16 v[20:23], v[4:7], a[192:199], v74
  ds_read_b128 v[48:51], v75 offset:58368
  v_smfmac_f32_16x16x64_bf16 v[20:23], v[8:11], a[200:207], v74
  ds_read_b128 v[60:63], v75 offset:59392
  s_waitcnt lgkmcnt(4)
  v_cvt_pk_bf16_f32 v16, v16, v17
  v_cvt_pk_bf16_f32 v17, v18, v19
  v_bfi_b32 v16, 1, s72, v16
  v_smfmac_f32_16x16x64_bf16 v[20:23], v[0:3], v[36:43], v74
  s_waitcnt lgkmcnt(3)
  buffer_store_dwordx2 v[16:17], v68, s[8:11], s73 offen
  v_mov_b64 v[32:33], 0
  v_smfmac_f32_16x16x64_bf16 v[24:27], v[4:7], a[208:215], v74
  ds_read_b128 v[64:67], v75 offset:60416
  v_mov_b64 v[34:35], 0
  v_smfmac_f32_16x16x64_bf16 v[24:27], v[8:11], a[216:223], v74
  ds_read_b128 v[52:55], v75 offset:0
  v_cvt_pk_bf16_f32 v20, v20, v21
  v_cvt_pk_bf16_f32 v21, v22, v23
  v_bfi_b32 v20, 1, s72, v20
  v_smfmac_f32_16x16x64_bf16 v[24:27], v[0:3], a[232:239], v74
  ds_read_b128 v[56:59], v75 offset:1024
  buffer_store_dwordx2 v[20:21], v68, s[8:11], s74 offen
  s_waitcnt lgkmcnt(4)
  v_mov_b64 v[28:29], 0
  v_smfmac_f32_16x16x64_bf16 v[32:35], v[4:7], v[44:51], v74
  ds_read_b128 v[36:39], v75 offset:2048
  ds_read_b128 v[40:43], v75 offset:3072
  s_waitcnt lgkmcnt(4)
  v_smfmac_f32_16x16x64_bf16 v[32:35], v[8:11], v[60:67], v74
  ds_read_b128 v[44:47], v75 offset:4096
  v_cvt_pk_bf16_f32 v24, v24, v25
  v_cvt_pk_bf16_f32 v25, v26, v27
  v_bfi_b32 v24, 1, s72, v24
  v_smfmac_f32_16x16x64_bf16 v[32:35], v[12:15], a[240:247], v74
  ds_read_b128 v[48:51], v75 offset:5120
  buffer_store_dwordx2 v[24:25], v68, s[8:11], s75 offen
  v_mov_b64 v[30:31], 0
  v_smfmac_f32_16x16x64_bf16 v[32:35], v[0:3], a[248:255], v74
  ds_read_b128 v[60:63], v75 offset:6144
  ds_read_b128 v[64:67], v75 offset:7168
  s_waitcnt lgkmcnt(6)
  v_smfmac_f32_16x16x64_bf16 v[28:31], v[4:7], v[52:59], v74
  s_waitcnt lgkmcnt(4)
  v_smfmac_f32_16x16x64_bf16 v[28:31], v[8:11], v[36:43], v74
  s_waitcnt lgkmcnt(2)
  v_cvt_pk_bf16_f32 v32, v32, v33
  v_cvt_pk_bf16_f32 v33, v34, v35
  v_bfi_b32 v32, 1, s72, v32
  v_smfmac_f32_16x16x64_bf16 v[28:31], v[12:15], v[44:51], v74
  buffer_store_dwordx2 v[32:33], v68, s[8:11], s76 offen
  s_waitcnt lgkmcnt(0)
  v_smfmac_f32_16x16x64_bf16 v[28:31], v[0:3], v[60:67], v74
  v_mov_b64 v[18:19], v[72:73]
  s_nop 4
  v_cvt_pk_bf16_f32 v28, v28, v29
  v_cvt_pk_bf16_f32 v29, v30, v31
  v_bfi_b32 v28, 1, s72, v28
  buffer_store_dwordx2 v[28:29], v68, s[8:11], s77 offen
  ds_read_b128 v[0:3], v76 offset:14848
  s_waitcnt lgkmcnt(0)
  ds_read_b64 v[16:17], v77 offset:384
  s_waitcnt lgkmcnt(0)
  ds_read_b128 v[64:67], v76 offset:27648
  s_waitcnt lgkmcnt(0)
  ds_read_b128 v[60:63], v76 offset:26624
  s_waitcnt lgkmcnt(0)
  v_xor_b32 v75, 0x8000, v75
  v_mov_b64 v[28:29], 0
  v_mov_b64 v[30:31], 0
  v_mov_b64 v[32:33], 0
  v_mov_b64 v[34:35], 0
  buffer_load_dwordx4 v[52:55], v76, s[8:11], s60 offen offset:0 sc1
  buffer_load_dwordx4 v[56:59], v76, s[8:11], s60 offen offset:1024 sc1
  s_add_u32 s66, s66, 1
  s_xor_b32 s64, s64, 16384
  s_xor_b32 s65, s65, 16384
  s_add_u32 s58, s58, 655360
  s_add_u32 s59, s59, 655360
  s_add_u32 s70, s70, 655360
  s_add_u32 s68, s68, 655360
  s_mov_b32 m0, 12800
  s_add_u32 s85, s65, 8192
  s_waitcnt lgkmcnt(0)
  s_waitcnt vmcnt(1)
  v_mfma_f32_16x16x32_bf16 v[4:7], v[0:3], v[52:55], 0
  v_bitop3_b32 v72, v52, v54, s72 bitop3:0x7e
  s_waitcnt vmcnt(0)
  v_mfma_f32_16x16x32_bf16 v[4:7], v[0:3], v[56:59], v[4:7]
  v_bitop3_b32 v73, v56, v58, s72 bitop3:0x7e
  v_bitop3_b32 v72, v72, v73, 1 bitop3:0xa8
  v_cmp_ne_u32 vcc, 0, v72
  s_nop 3
  v_add_f32_dpp v4, v4, v4 row_ror:4 row_mask:0xf bank_mask:0xf
  v_add_f32_dpp v5, v5, v5 row_ror:4 row_mask:0xf bank_mask:0xf
  s_cmp_eq_u64 vcc, 0
  v_add_f32_dpp v4, v4, v4 row_ror:8 row_mask:0xf bank_mask:0xf
  v_add_f32_dpp v5, v5, v5 row_ror:8 row_mask:0xf bank_mask:0xf
  s_cselect_b32 s54, s62, 268435456
  v_cvt_pk_bf16_f32 v4, v4, v5
  buffer_store_dword v4, v69, s[8:11], s54 offen
  s_cbranch_vccnz Cf2_h1r
  s_xor_b32 s62, s62, 16384
  buffer_store_dword v71, v69, s[8:11], s62 offen
  s_xor_b32 s72, s72, 1
  s_branch Cf2_h2
Cf2_h1r:
  s_mov_b64 exec, vcc
  buffer_load_dwordx4 v[52:55], v76, s[8:11], s60 offen offset:0 sc1
  buffer_load_dwordx4 v[56:59], v76, s[8:11], s60 offen offset:1024 sc1
  s_mov_b64 exec, -1
  s_add_u32 s67, s67, 1
  s_waitcnt vmcnt(1)
  v_mfma_f32_16x16x32_bf16 v[4:7], v[0:3], v[52:55], 0
  v_bitop3_b32 v72, v52, v54, s72 bitop3:0x7e
  s_waitcnt vmcnt(0)
  v_mfma_f32_16x16x32_bf16 v[4:7], v[0:3], v[56:59], v[4:7]
  v_bitop3_b32 v73, v56, v58, s72 bitop3:0x7e
  v_bitop3_b32 v72, v72, v73, 1 bitop3:0xa8
  v_cmp_ne_u32 vcc, 0, v72
  s_cbranch_vccz Cf2_h1p
Cf2_h1s:
  s_mov_b64 exec, vcc
  buffer_load_dwordx4 v[52:55], v76, s[8:11], s60 offen offset:0 sc1
  buffer_load_dwordx4 v[56:59], v76, s[8:11], s60 offen offset:1024 sc1
  s_mov_b64 exec, -1
  s_add_u32 s67, s67, 1
  s_waitcnt vmcnt(1)
  v_mfma_f32_16x16x32_bf16 v[4:7], v[0:3], v[52:55], 0
  v_bitop3_b32 v72, v52, v54, s72 bitop3:0x7e
  s_waitcnt vmcnt(0)
  v_mfma_f32_16x16x32_bf16 v[4:7], v[0:3], v[56:59], v[4:7]
  v_bitop3_b32 v73, v56, v58, s72 bitop3:0x7e
  v_bitop3_b32 v72, v72, v73, 1 bitop3:0xa8
  v_cmp_ne_u32 vcc, 0, v72
  s_cbranch_vccz Cf2_h1p
  s_cmp_lt_u32 s67, 131072
  s_cbranch_scc1 Cf2_h1s
Cf2_h1p:
  s_nop 2
  v_add_f32_dpp v4, v4, v4 row_ror:4 row_mask:0xf bank_mask:0xf
  v_add_f32_dpp v5, v5, v5 row_ror:4 row_mask:0xf bank_mask:0xf
  s_nop 0
  v_add_f32_dpp v4, v4, v4 row_ror:8 row_mask:0xf bank_mask:0xf
  v_add_f32_dpp v5, v5, v5 row_ror:8 row_mask:0xf bank_mask:0xf
  v_cvt_pk_bf16_f32 v4, v4, v5
  buffer_store_dword v4, v69, s[8:11], s62 offen
  s_xor_b32 s62, s62, 16384
  buffer_store_dword v71, v69, s[8:11], s62 offen
  s_xor_b32 s72, s72, 1
  s_branch Cf2_h2
Cf2_h2r:
  s_mov_b64 exec, vcc
  buffer_load_dwordx4 v[12:15], v76, s[8:11], s65 offen offset:3072 sc1
  s_mov_b64 exec, -1
  s_add_u32 s67, s67, 1
  s_waitcnt vmcnt(4)
  v_max3_u32 v72, v12, v13, v14
  v_max_u32 v72, v72, v15
  ds_write_b128 v76, v[12:15] offset:7680
  v_cmp_eq_u32 vcc, -1, v72
  s_cbranch_vccz Cf2_h2w
  s_mov_b64 exec, vcc
  buffer_load_dwordx4 v[12:15], v76, s[8:11], s65 offen offset:3072 sc1
  s_mov_b64 exec, -1
  s_add_u32 s67, s67, 1
  s_waitcnt vmcnt(4)
  v_max3_u32 v72, v12, v13, v14
  v_max_u32 v72, v72, v15
  ds_write_b128 v76, v[12:15] offset:7680
  v_cmp_eq_u32 vcc, -1, v72
  s_cbranch_vccz Cf2_h2w
Cf2_h2s:
  s_mov_b64 exec, vcc
  buffer_load_dwordx4 v[12:15], v76, s[8:11], s65 offen offset:3072 sc1
  s_mov_b64 exec, -1
  s_add_u32 s67, s67, 1
  s_waitcnt vmcnt(2)
  v_max3_u32 v72, v12, v13, v14
  v_max_u32 v72, v72, v15
  ds_write_b128 v76, v[12:15] offset:7680
  v_cmp_eq_u32 vcc, -1, v72
  s_cbranch_vccz Cf2_h2w
  s_mov_b64 exec, vcc
  buffer_load_dwordx4 v[12:15], v76, s[8:11], s65 offen offset:3072 sc1
  s_mov_b64 exec, -1
  s_add_u32 s67, s67, 1
  s_waitcnt vmcnt(2)
  v_max3_u32 v72, v12, v13, v14
  v_max_u32 v72, v72, v15
  ds_write_b128 v76, v[12:15] offset:7680
  v_cmp_eq_u32 vcc, -1, v72
  s_cbranch_vccz Cf2_h2w
  s_mov_b64 exec, vcc
  buffer_load_dwordx4 v[12:15], v76, s[8:11], s65 offen offset:3072 sc1
  s_mov_b64 exec, -1
  s_add_u32 s67, s67, 1
  s_waitcnt vmcnt(2)
  v_max3_u32 v72, v12, v13, v14
  v_max_u32 v72, v72, v15
  ds_write_b128 v76, v[12:15] offset:7680
  v_cmp_eq_u32 vcc, -1, v72
  s_cbranch_vccz Cf2_h2w
  s_cmp_lt_u32 s67, 131072
  s_cbranch_scc1 Cf2_h2s
  s_branch Cf2_h2w
Cf2_rec:
  s_nop 7
  s_waitcnt vmcnt(0) lgkmcnt(0)
  v_max3_u32 v72, v0, v1, v2
  v_max3_u32 v72, v72, v3, v4
  v_max3_u32 v72, v72, v5, v6
  v_max3_u32 v72, v72, v7, v8
  v_max3_u32 v72, v72, v9, v10
  v_max3_u32 v72, v72, v11, v12
  v_max3_u32 v72, v72, v13, v14
  v_max3_u32 v72, v72, v15, v16
  v_max3_u32 v72, v72, v17, v18
  v_max_u32 v72, v72, v19
  v_cmp_eq_u32 vcc, -1, v72
  s_cbranch_vccz Cf2_recok
  s_barrier
Cf2_recp:
  buffer_load_dwordx4 v[0:3], v76, s[8:11], s64 offen offset:0 sc1
  buffer_load_dwordx4 v[4:7], v76, s[8:11], s64 offen offset:1024 sc1
  s_add_u32 s67, s67, 1
  s_cmp_lt_u32 s67, 131072
  s_cselect_b32 s54, -2, -1
  s_waitcnt vmcnt(1)
  v_max3_u32 v72, v0, v1, v2
  s_waitcnt vmcnt(0)
  v_max3_u32 v72, v72, v3, v4
  v_max3_u32 v72, v72, v5, v6
  v_max_u32 v72, v72, v7
  v_cmp_lt_u32 vcc, s54, v72
  s_cbranch_vccnz Cf2_recp
  ds_write_b128 v76, v[0:3] offset:8704
  ds_write_b128 v76, v[4:7] offset:9728
  v_mov_b64 v[20:21], 0
  v_mov_b64 v[22:23], 0
  v_mov_b64 v[24:25], 0
  v_mov_b64 v[26:27], 0
  v_mov_b64 v[28:29], 0
  v_mov_b64 v[30:31], 0
  v_mov_b64 v[32:33], 0
  v_mov_b64 v[34:35], 0
  s_waitcnt lgkmcnt(0)
  s_barrier
  ds_read_b128 v[0:3], v76 offset:4608
  s_waitcnt lgkmcnt(0)
  v_smfmac_f32_16x16x64_bf16 v[20:23], v[0:3], v[80:87], v74
  v_smfmac_f32_16x16x64_bf16 v[24:27], v[0:3], v[88:95], v74
  ds_read_b128 v[60:63], v76 offset:24576
  ds_read_b128 v[64:67], v76 offset:25600
  s_waitcnt lgkmcnt(0)
  v_smfmac_f32_16x16x64_bf16 v[28:31], v[0:3], v[60:67], v74
  ds_read_b128 v[60:63], v76 offset:26624
  ds_read_b128 v[64:67], v76 offset:27648
  s_waitcnt lgkmcnt(0)
  v_smfmac_f32_16x16x64_bf16 v[32:35], v[0:3], v[60:67], v74
  ds_read_b128 v[4:7], v76 offset:5632
  s_waitcnt lgkmcnt(0)
  v_smfmac_f32_16x16x64_bf16 v[20:23], v[4:7], v[96:103], v74
  v_smfmac_f32_16x16x64_bf16 v[24:27], v[4:7], v[104:111], v74
  ds_read_b128 v[60:63], v76 offset:40960
  ds_read_b128 v[64:67], v76 offset:41984
  s_waitcnt lgkmcnt(0)
  v_smfmac_f32_16x16x64_bf16 v[28:31], v[4:7], v[60:67], v74
  ds_read_b128 v[60:63], v76 offset:43008
  ds_read_b128 v[64:67], v76 offset:44032
  s_waitcnt lgkmcnt(0)
  v_smfmac_f32_16x16x64_bf16 v[32:35], v[4:7], v[60:67], v74
  ds_read_b128 v[8:11], v76 offset:6656
  s_waitcnt lgkmcnt(0)
  v_smfmac_f32_16x16x64_bf16 v[20:23], v[8:11], v[112:119], v74
  v_smfmac_f32_16x16x64_bf16 v[24:27], v[8:11], v[120:127], v74
  v_smfmac_f32_16x16x64_bf16 v[28:31], v[8:11], v[208:215], v74
  v_smfmac_f32_16x16x64_bf16 v[32:35], v[8:11], v[216:223], v74
  ds_read_b128 v[12:15], v76 offset:7680
  s_waitcnt lgkmcnt(0)
  v_smfmac_f32_16x16x64_bf16 v[20:23], v[12:15], v[128:135], v74
  v_smfmac_f32_16x16x64_bf16 v[24:27], v[12:15], v[136:143], v74
  v_smfmac_f32_16x16x64_bf16 v[28:31], v[12:15], v[224:231], v74
  v_smfmac_f32_16x16x64_bf16 v[32:35], v[12:15], v[232:239], v74
  ds_read_b128 v[12:15], v76 offset:8704
  s_waitcnt lgkmcnt(0)
  v_smfmac_f32_16x16x64_bf16 v[20:23], v[12:15], v[144:151], v74
  v_smfmac_f32_16x16x64_bf16 v[24:27], v[12:15], v[152:159], v74
  ds_read_b128 v[60:63], v76 offset:57344
  ds_read_b128 v[64:67], v76 offset:58368
  s_waitcnt lgkmcnt(0)
  v_smfmac_f32_16x16x64_bf16 v[28:31], v[12:15], v[60:67], v74
  ds_read_b128 v[60:63], v76 offset:59392
  ds_read_b128 v[64:67], v76 offset:60416
  s_waitcnt lgkmcnt(0)
  v_smfmac_f32_16x16x64_bf16 v[32:35], v[12:15], v[60:67], v74
  ds_read_b128 v[0:3], v76 offset:9728
  s_waitcnt lgkmcnt(0)
  v_smfmac_f32_16x16x64_bf16 v[20:23], v[0:3], v[160:167], v74
  v_smfmac_f32_16x16x64_bf16 v[24:27], v[0:3], v[168:175], v74
  ds_read_b128 v[60:63], v75 offset:24576
  ds_read_b128 v[64:67], v75 offset:25600
  s_waitcnt lgkmcnt(0)
  v_smfmac_f32_16x16x64_bf16 v[28:31], v[0:3], v[60:67], v74
  ds_read_b128 v[60:63], v75 offset:26624
  ds_read_b128 v[64:67], v75 offset:27648
  s_waitcnt lgkmcnt(0)
  v_smfmac_f32_16x16x64_bf16 v[32:35], v[0:3], v[60:67], v74
  ds_read_b128 v[16:19], v76 offset:10752
  ds_read_b128 v[60:63], v75 offset:8192
  ds_read_b128 v[64:67], v75 offset:9216
  s_waitcnt lgkmcnt(0)
  v_smfmac_f32_16x16x64_bf16 v[20:23], v[16:19], v[60:67], v74
  ds_read_b128 v[60:63], v75 offset:10240
  ds_read_b128 v[64:67], v75 offset:11264
  s_waitcnt lgkmcnt(0)
  v_smfmac_f32_16x16x64_bf16 v[24:27], v[16:19], v[60:67], v74
  v_smfmac_f32_16x16x64_bf16 v[28:31], v[16:19], v[240:247], v74
  v_smfmac_f32_16x16x64_bf16 v[32:35], v[16:19], v[248:255], v74
  ds_read_b128 v[4:7], v76 offset:11776
  s_waitcnt lgkmcnt(0)
  v_smfmac_f32_16x16x64_bf16 v[20:23], v[4:7], v[176:183], v74
  v_smfmac_f32_16x16x64_bf16 v[24:27], v[4:7], v[184:191], v74
  v_smfmac_f32_16x16x64_bf16 v[28:31], v[4:7], a[0:7], v74
  v_smfmac_f32_16x16x64_bf16 v[32:35], v[4:7], a[8:15], v74
  ds_read_b128 v[8:11], v76 offset:12800
  s_waitcnt lgkmcnt(0)
  v_smfmac_f32_16x16x64_bf16 v[20:23], v[8:11], v[192:199], v74
  v_smfmac_f32_16x16x64_bf16 v[24:27], v[8:11], v[200:207], v74
  v_smfmac_f32_16x16x64_bf16 v[28:31], v[8:11], a[16:23], v74
  v_smfmac_f32_16x16x64_bf16 v[32:35], v[8:11], a[24:31], v74
  v_add_f32 v20, v20, v22
  v_add_f32 v21, v21, v23
  v_add_f32 v24, v24, v26
  v_cvt_pk_bf16_f32 v22, v20, v24
  ds_write_b32 v79, v22 offset:0
  v_add_f32 v25, v25, v27
  v_cvt_pk_bf16_f32 v23, v21, v25
  ds_write_b32 v79, v23 offset:576
  v_add_f32 v28, v28, v30
  v_add_f32 v29, v29, v31
  s_waitcnt lgkmcnt(0)
  s_nop 1
  s_branch Cf2_recok
Cf2_mx:
  s_waitcnt lgkmcnt(0)
  s_barrier
  buffer_load_dwordx4 v[52:55], v76, s[8:11], s59 offen offset:0 sc1
  buffer_load_dwordx4 v[0:3], v76, s[8:11], s58 offen offset:0 sc1
  ds_read_b128 v[20:23], v77 offset:0
  ds_read_b128 v[28:31], v77 offset:256
  buffer_load_dwordx4 v[56:59], v76, s[8:11], s59 offen offset:1024 sc1
  buffer_load_dwordx4 v[4:7], v76, s[8:11], s58 offen offset:1024 sc1
  ds_read_b128 v[24:27], v77 offset:128
  ds_read_b128 v[32:35], v77 offset:384
  s_waitcnt vmcnt(2) lgkmcnt(3)
  v_mfma_f32_16x16x32_bf16 v[8:11], v[0:3], v[20:23], 0
  s_waitcnt vmcnt(0) lgkmcnt(1)
  v_mfma_f32_16x16x32_bf16 v[8:11], v[4:7], v[24:27], v[8:11]
  v_mfma_f32_16x16x32_bf16 v[12:15], v[28:31], v[20:23], 0
  s_waitcnt lgkmcnt(0)
  v_mfma_f32_16x16x32_bf16 v[12:15], v[32:35], v[24:27], v[12:15]
  v_add_f32_dpp v8, v10, v8 quad_perm:[2,3,0,1] row_mask:0xf bank_mask:0xf
  v_add_f32_dpp v9, v11, v9 quad_perm:[2,3,0,1] row_mask:0xf bank_mask:0xf
  s_nop 0
  v_mov_b32_dpp v8, v8 quad_perm:[0,1,0,1] row_mask:0xf bank_mask:0xf
  v_mov_b32_dpp v9, v9 quad_perm:[0,1,0,1] row_mask:0xf bank_mask:0xf
  s_nop 1
  v_add_f32_dpp v12, v14, v12 quad_perm:[2,3,0,1] row_mask:0xf bank_mask:0xf
  v_add_f32_dpp v13, v15, v13 quad_perm:[2,3,0,1] row_mask:0xf bank_mask:0xf
  s_nop 0
  v_mov_b32_dpp v12, v12 quad_perm:[0,1,0,1] row_mask:0xf bank_mask:0xf
  v_mov_b32_dpp v13, v13 quad_perm:[0,1,0,1] row_mask:0xf bank_mask:0xf
  v_mul_f32 v12, s69, v12
  ds_write_b32 v78, v8 offset:8712
  v_mul_f32 v13, s69, v13
  ds_write_b32 v78, v9 offset:8776
  s_waitcnt lgkmcnt(0)
  s_barrier
  ds_read_b128 v[36:39], v78 offset:8704
  ds_read_b128 v[40:43], v78 offset:8768
  s_waitcnt lgkmcnt(0)
  s_barrier
  v_max_f32 v16, v36, v37
  v_max3_f32 v16, v16, v38, v39
  v_max3_f32 v16, v16, v40, v41
  v_max3_f32 v16, v16, v42, v43
  v_max3_f32 v16, v16, v12, v13
  v_mov_b32 v17, v16
  s_nop 1
  v_permlane16_swap_b32 v16, v17
  v_max_f32 v16, v16, v17
  v_mov_b32 v17, v16
  s_nop 1
  v_permlane32_swap_b32 v16, v17
  v_max_f32 v16, v16, v17
  v_sub_f32 v36, v36, v16
  v_sub_f32 v37, v37, v16
  v_sub_f32 v38, v38, v16
  v_sub_f32 v39, v39, v16
  v_sub_f32 v40, v40, v16
  v_sub_f32 v41, v41, v16
  v_sub_f32 v42, v42, v16
  v_sub_f32 v43, v43, v16
  v_sub_f32 v12, v12, v16
  v_sub_f32 v13, v13, v16
  v_exp_f32 v36, v36
  v_exp_f32 v37, v37
  v_exp_f32 v38, v38
  v_exp_f32 v39, v39
  v_exp_f32 v40, v40
  v_exp_f32 v41, v41
  v_exp_f32 v42, v42
  v_exp_f32 v43, v43
  v_exp_f32 v12, v12
  v_exp_f32 v13, v13
  v_cvt_pk_bf16_f32 v32, v36, v40
  v_cvt_pk_bf16_f32 v33, v37, v41
  v_cvt_pk_bf16_f32 v34, v38, v42
  v_cvt_pk_bf16_f32 v35, v39, v43
  v_cvt_pk_bf16_f32 v28, v12, v13
  v_cvt_pk_bf16_f32 v31, v12, v13
  v_mov_b32 v29, 0
  v_mov_b32 v30, 0
  v_mfma_f32_16x16x32_bf16 v[8:11], v[32:35], v[68:71], 0
  v_mfma_f32_16x16x32_bf16 v[0:3], v[32:35], v[52:55], 0
  v_mfma_f32_16x16x32_bf16 v[4:7], v[32:35], v[56:59], 0
  v_mfma_f32_16x16x16_bf16 v[8:11], v[28:29], v[68:69], v[8:11]
  v_mfma_f32_16x16x16_bf16 v[0:3], v[28:29], v[72:73], v[0:3]
  v_mfma_f32_16x16x16_bf16 v[4:7], v[30:31], v[72:73], v[4:7]
  ds_read_b128 v[52:55], v75 offset:26624
  v_rcp_f32 v10, v8
  v_rcp_f32 v11, v9
  v_mul_f32 v0, v10, v0
  v_mul_f32 v1, v11, v1
  v_max3_f32 v8, v8, v9, v10
  v_mul_f32 v4, v10, v4
  v_mul_f32 v5, v11, v5
  v_cvt_pk_bf16_f32 v2, v0, v4
  ds_write_b32 v79, v2 offset:8704
  v_cvt_pk_bf16_f32 v3, v1, v5
  ds_write_b32 v79, v3 offset:9280
  ds_read_b128 v[12:15], v78 offset:8832
  ds_read_b128 v[56:59], v75 offset:27648
  v_mov_b64 v[16:17], 0
  v_mov_b64 v[18:19], 0
  v_mov_b64 v[20:21], 0
  v_mov_b64 v[22:23], 0
  v_mov_b64 v[24:25], 0
  v_mov_b64 v[26:27], 0
  s_branch Cf2_mxok
Cf2_last:
  ds_read_b128 v[4:7], v76 offset:5632
  ds_read_b128 v[8:11], v76 offset:6656
  ds_read_b128 v[44:47], v76 offset:40960
  ds_read_b128 v[48:51], v76 offset:41984
  s_nop 5
  v_mov_b64 v[20:21], 0
  v_mov_b64 v[22:23], 0
  v_mov_b64 v[24:25], 0
  v_mov_b64 v[26:27], 0
  s_waitcnt lgkmcnt(4)
  v_smfmac_f32_16x16x64_bf16 v[28:31], v[0:3], v[36:43], v74
  ds_read_b128 v[36:39], v76 offset:43008
  ds_read_b128 v[40:43], v76 offset:44032
  v_smfmac_f32_16x16x64_bf16 v[32:35], v[0:3], v[60:67], v74
  s_waitcnt lgkmcnt(5)
  v_smfmac_f32_16x16x64_bf16 v[20:23], v[0:3], a[32:39], v74
  ds_read_b128 v[60:63], v76 offset:57344
  ds_read_b128 v[64:67], v76 offset:58368
  v_smfmac_f32_16x16x64_bf16 v[24:27], v[0:3], a[40:47], v74
  s_waitcnt lgkmcnt(4)
  v_smfmac_f32_16x16x64_bf16 v[20:23], v[4:7], a[48:55], v74
  buffer_store_dwordx4 v[16:19], v76, s[8:11], s68 offen sc1
  v_smfmac_f32_16x16x64_bf16 v[24:27], v[4:7], a[56:63], v74
  v_smfmac_f32_16x16x64_bf16 v[28:31], v[4:7], v[44:51], v74
  s_waitcnt lgkmcnt(2)
  v_smfmac_f32_16x16x64_bf16 v[20:23], v[8:11], a[64:71], v74
  ds_read_b128 v[44:47], v76 offset:59392
  ds_read_b128 v[48:51], v76 offset:60416
  v_smfmac_f32_16x16x64_bf16 v[24:27], v[8:11], a[72:79], v74
  v_smfmac_f32_16x16x64_bf16 v[32:35], v[4:7], v[36:43], v74
  v_smfmac_f32_16x16x64_bf16 v[28:31], v[8:11], v[208:215], v74
  ds_read_b128 v[36:39], v75 offset:24576
  ds_read_b128 v[40:43], v75 offset:25600
  v_smfmac_f32_16x16x64_bf16 v[32:35], v[8:11], v[216:223], v74
  v_smfmac_f32_16x16x64_bf16 v[20:23], v[12:15], a[80:87], v74
  v_smfmac_f32_16x16x64_bf16 v[24:27], v[12:15], a[88:95], v74
  v_smfmac_f32_16x16x64_bf16 v[28:31], v[12:15], v[224:231], v74
  v_smfmac_f32_16x16x64_bf16 v[32:35], v[12:15], v[232:239], v74
  s_waitcnt vmcnt(2)
  s_waitcnt vmcnt(1)
  s_barrier
Cf2_lastr:
  ds_read_b128 v[12:15], v76 offset:8704
  ds_read_b128 v[0:3], v76 offset:9728
  ds_read_b128 v[16:19], v76 offset:10752
  ds_read_b128 v[4:7], v76 offset:11776
  ds_read_b128 v[8:11], v76 offset:12800
  s_waitcnt lgkmcnt(3)
  v_max3_u32 v72, v0, v1, v2
  s_waitcnt lgkmcnt(1)
  v_max3_u32 v72, v72, v3, v4
  v_max3_u32 v72, v72, v5, v6
  s_waitcnt lgkmcnt(0)
  v_max3_u32 v72, v72, v7, v8
  v_max3_u32 v72, v72, v9, v10
  v_max3_u32 v72, v72, v11, v12
  v_max3_u32 v72, v72, v13, v14
  v_max3_u32 v72, v72, v15, v16
  v_max3_u32 v72, v72, v17, v18
  v_max_u32 v72, v72, v19
  v_cmp_eq_u32 vcc, -1, v72
  s_cbranch_vccnz Cf2_lastp
Cf2_lastg:
  v_smfmac_f32_16x16x64_bf16 v[28:31], v[12:15], v[60:67], v74
  ds_read_b128 v[60:63], v75 offset:26624
  ds_read_b128 v[64:67], v75 offset:27648
  v_smfmac_f32_16x16x64_bf16 v[32:35], v[12:15], v[44:51], v74
  v_smfmac_f32_16x16x64_bf16 v[28:31], v[0:3], v[36:43], v74
  v_smfmac_f32_16x16x64_bf16 v[28:31], v[16:19], v[240:247], v74
  v_smfmac_f32_16x16x64_bf16 v[28:31], v[4:7], a[0:7], v74
  v_smfmac_f32_16x16x64_bf16 v[28:31], v[8:11], a[16:23], v74
  v_smfmac_f32_16x16x64_bf16 v[32:35], v[16:19], v[248:255], v74
  v_smfmac_f32_16x16x64_bf16 v[32:35], v[4:7], a[8:15], v74
  s_waitcnt lgkmcnt(0)
  v_smfmac_f32_16x16x64_bf16 v[32:35], v[8:11], a[24:31], v74
  v_smfmac_f32_16x16x64_bf16 v[32:35], v[0:3], v[60:67], v74
  v_smfmac_f32_16x16x64_bf16 v[20:23], v[12:15], a[96:103], v74
  v_smfmac_f32_16x16x64_bf16 v[20:23], v[0:3], a[112:119], v74
  v_add_f32 v28, v28, v30
  v_add_f32 v32, v32, v34
  v_cvt_pk_bf16_f32 v30, v28, v32
  v_smfmac_f32_16x16x64_bf16 v[20:23], v[16:19], a[128:135], v74
  ds_write_b32 v79, v30 offset:256
  v_add_f32 v29, v29, v31
  v_add_f32 v33, v33, v35
  v_cvt_pk_bf16_f32 v31, v29, v33
  v_smfmac_f32_16x16x64_bf16 v[20:23], v[4:7], a[144:151], v74
  ds_write_b32 v79, v31 offset:832
  v_smfmac_f32_16x16x64_bf16 v[20:23], v[8:11], a[160:167], v74
  v_smfmac_f32_16x16x64_bf16 v[24:27], v[12:15], a[104:111], v74
  v_smfmac_f32_16x16x64_bf16 v[24:27], v[0:3], a[120:127], v74
  v_smfmac_f32_16x16x64_bf16 v[24:27], v[16:19], a[136:143], v74
  s_waitcnt lgkmcnt(0)
  s_barrier
  ds_read_b64 v[52:53], v77 offset:384
  v_add_f32 v20, v20, v22
  v_smfmac_f32_16x16x64_bf16 v[24:27], v[4:7], a[152:159], v74
  v_add_f32 v21, v21, v23
  v_smfmac_f32_16x16x64_bf16 v[24:27], v[8:11], a[168:175], v74
  v_cvt_pk_bf16_f32 v54, v20, v21
  s_add_u32 s68, s68, 655360
  s_nop 3
  v_add_f32 v24, v24, v26
  v_add_f32 v25, v25, v27
  v_cvt_pk_bf16_f32 v55, v24, v25
  s_waitcnt lgkmcnt(0)
  buffer_store_dwordx4 v[52:55], v76, s[8:11], s68 offen sc1
  s_branch Cf2_done
Cf2_lastp:
  s_add_u32 s72, s72, 2
  s_cmp_ge_u32 s72, 131072
  s_cbranch_scc1 Cf2_lastg
  s_barrier
  buffer_load_dwordx4 v76, s[8:11], s85 offen offset:0 sc1 lds
  s_waitcnt vmcnt(0)
  s_barrier
  s_branch Cf2_lastr
Cf2_done:
  s_branch L_cexit
L_w3:
  v_mov_b64 v[20:21], 0
  v_mov_b64 v[22:23], 0
  v_mov_b64 v[24:25], 0
  v_mov_b64 v[26:27], 0
  v_mov_b64 v[28:29], 0
  v_mov_b64 v[30:31], 0
  v_mov_b64 v[32:33], 0
  v_mov_b64 v[34:35], 0
  s_mov_b32 s78, 0x3f803f80
  s_mov_b32 s79, s78
  s_mov_b32 s65, 360448
  s_mov_b32 m0, 15872
  s_lshl_b32 s71, s53, 2
  s_add_u32 s71, s71, 128
  s_movk_i32 s56, 0x1000
  v_lshlrev_b32 v73, 2, v76
  v_mov_b32 v72, 0
  s_mov_b64 s[16:17], s[8:9]
  s_mov_b32 s18, 268435456
  s_mov_b32 s19, 0x20000
  s_getpc_b64 s[20:21]
Cf3_pc:
  s_add_u32 s20, s20, (Cf3_last - Cf3_pc)
  s_addc_u32 s21, s21, 0
  v_mov_b32 v68, 14880
  buffer_load_dwordx4 v[52:55], v76, s[8:11], s59 offen offset:0 sc1
  buffer_load_dwordx4 v[56:59], v76, s[8:11], s59 offen offset:1024 sc1
  ds_read_b128 v[36:39], v76 offset:45056
  ds_read_b128 v[40:43], v76 offset:46080
  ds_read_b128 v[60:63], v76 offset:47104
  ds_read_b128 v[64:67], v76 offset:48128
  ds_read_b128 v[0:3], v76 offset:4608
  ds_read_b128 v[4:7], v76 offset:5632
  ds_read_b128 v[8:11], v76 offset:6656
  ds_read_b128 v[12:15], v76 offset:7680
  s_waitcnt lgkmcnt(0)
  s_cmp_eq_u32 s66, 1
  s_branch Cf3_top2
.p2align 6
Cf3_h2:
  v_lshlrev_b32 v73, 2, v76
  buffer_load_dwordx4 v[4:7], v76, s[8:11], s65 offen offset:1024 sc1
  ds_read_b128 v[36:39], v76 offset:45056
  ds_read_b128 v[40:43], v76 offset:46080
  buffer_load_dwordx4 v[52:55], v76, s[8:11], s59 offen offset:0 sc1
  buffer_load_dwordx4 v[56:59], v76, s[8:11], s59 offen offset:1024 sc1
  s_waitcnt vmcnt(7)
  v_max3_u32 v72, v4, v5, v6
  v_max_u32 v72, v72, v7
  ds_write_b128 v76, v[4:7] offset:5632
  v_cmp_eq_u32 vcc, -1, v72
  s_cbranch_vccnz Cf3_h2r
Cf3_h2w:
  buffer_load_dwordx4 v76, s[8:11], s85 offen offset:0 sc1 lds
  buffer_load_dwordx4 v76, s[8:11], s85 offen offset:1024 sc1 lds
  s_cmp_eq_u32 s66, 63
  s_waitcnt lgkmcnt(0)
  s_barrier
  ds_read_b128 v[8:11], v76 offset:6656
Cf3_top2:
  v_smfmac_f32_16x16x64_bf16 v[20:23], v[4:7], v[96:103], v74
  s_cbranch_scc1 Cf3_last
  v_smfmac_f32_16x16x64_bf16 v[28:31], v[4:7], v[36:43], v74
  buffer_load_dwordx4 v[44:47], v76, s[8:11], s58 offen offset:0 sc1
  s_mov_b32 m0, 15872
  v_smfmac_f32_16x16x64_bf16 v[24:27], v[4:7], v[104:111], v74
  buffer_load_dwordx4 v[48:51], v76, s[8:11], s58 offen offset:1024 sc1
  v_smfmac_f32_16x16x64_bf16 v[32:35], v[4:7], v[60:67], v74
  ds_read_b128 v[0:3], v76 offset:4608
  s_waitcnt lgkmcnt(1)
  v_smfmac_f32_16x16x64_bf16 v[20:23], v[8:11], v[112:119], v74
  ds_read_b128 v[12:15], v76 offset:7680
  v_smfmac_f32_16x16x64_bf16 v[24:27], v[8:11], v[120:127], v74
  ds_read_b128 v[36:39], v76 offset:28672
  v_smfmac_f32_16x16x64_bf16 v[28:31], v[8:11], v[208:215], v74
  buffer_store_dwordx4 v[16:19], v76, s[8:11], s68 offen sc1
  ds_read_b128 v[40:43], v76 offset:29696
  v_smfmac_f32_16x16x64_bf16 v[32:35], v[8:11], v[216:223], v74
  buffer_load_dword v73, s[16:19], s70 offen lds
  ds_read_b128 v[60:63], v76 offset:30720
  s_waitcnt lgkmcnt(4)
  v_smfmac_f32_16x16x64_bf16 v[20:23], v[0:3], v[80:87], v74
  ds_read_b128 v[64:67], v76 offset:31744
  v_smfmac_f32_16x16x64_bf16 v[24:27], v[0:3], v[88:95], v74
  s_waitcnt vmcnt(4)
  s_waitcnt lgkmcnt(4)
  v_smfmac_f32_16x16x64_bf16 v[20:23], v[12:15], v[128:135], v74
  s_barrier
  ds_read_b128 v[4:7], v76 offset:8704
  s_waitcnt lgkmcnt(3)
  v_smfmac_f32_16x16x64_bf16 v[28:31], v[0:3], v[36:43], v74
  ds_read_b128 v[36:39], v76 offset:61440
  v_smfmac_f32_16x16x64_bf16 v[24:27], v[12:15], v[136:143], v74
  ds_read_b128 v[40:43], v76 offset:62464
  s_waitcnt lgkmcnt(3)
  v_smfmac_f32_16x16x64_bf16 v[32:35], v[0:3], v[60:67], v74
  ds_read_b128 v[8:11], v76 offset:9728
  v_smfmac_f32_16x16x64_bf16 v[28:31], v[12:15], v[224:231], v74
  ds_read_b128 v[60:63], v76 offset:63488
  v_smfmac_f32_16x16x64_bf16 v[32:35], v[12:15], v[232:239], v74
  ds_read_b128 v[64:67], v76 offset:64512
  s_waitcnt lgkmcnt(5)
  v_smfmac_f32_16x16x64_bf16 v[20:23], v[4:7], v[144:151], v74
  s_barrier
  ds_read_b128 v[0:3], v76 offset:11776
  s_waitcnt lgkmcnt(4)
  v_smfmac_f32_16x16x64_bf16 v[28:31], v[4:7], v[36:43], v74
  ds_read_b128 v[12:15], v76 offset:12800
  ds_read_b128 v[36:39], v75 offset:12288
  v_smfmac_f32_16x16x64_bf16 v[24:27], v[4:7], v[152:159], v74
  ds_read_b128 v[16:19], v76 offset:10752
  s_waitcnt lgkmcnt(6)
  v_smfmac_f32_16x16x64_bf16 v[20:23], v[8:11], v[160:167], v74
  ds_read_b128 v[40:43], v75 offset:13312
  s_waitcnt lgkmcnt(5)
  v_smfmac_f32_16x16x64_bf16 v[32:35], v[4:7], v[60:67], v74
  ds_read_b128 v[60:63], v75 offset:14336
  v_smfmac_f32_16x16x64_bf16 v[24:27], v[8:11], v[168:175], v74
  ds_read_b128 v[64:67], v75 offset:15360
  s_waitcnt lgkmcnt(6)
  v_smfmac_f32_16x16x64_bf16 v[20:23], v[0:3], v[176:183], v74
  s_waitcnt lgkmcnt(5)
  v_smfmac_f32_16x16x64_bf16 v[20:23], v[12:15], v[192:199], v74
  s_waitcnt lgkmcnt(2)
  v_smfmac_f32_16x16x64_bf16 v[20:23], v[16:19], v[36:43], v74
  ds_read_b128 v[36:39], v75 offset:28672
  v_smfmac_f32_16x16x64_bf16 v[24:27], v[0:3], v[184:191], v74
  ds_read_b128 v[40:43], v75 offset:29696
  s_waitcnt lgkmcnt(2)
  v_smfmac_f32_16x16x64_bf16 v[24:27], v[16:19], v[60:67], v74
  ds_read_b128 v[60:63], v75 offset:30720
  v_add_f32 v20, v20, v22
  v_smfmac_f32_16x16x64_bf16 v[24:27], v[12:15], v[200:207], v74
  ds_read_b128 v[64:67], v75 offset:31744
  v_add_f32 v21, v21, v23
  v_smfmac_f32_16x16x64_bf16 v[28:31], v[16:19], v[240:247], v74
  v_mov_b64 v[70:71], s[78:79]
  v_smfmac_f32_16x16x64_bf16 v[28:31], v[0:3], a[0:7], v74
  s_waitcnt lgkmcnt(2)
  v_add_f32 v24, v24, v26
  v_smfmac_f32_16x16x64_bf16 v[28:31], v[8:11], v[36:43], v74
  ds_read_b128 v[36:39], v68
  v_cvt_pk_bf16_f32 v22, v20, v24
  v_smfmac_f32_16x16x64_bf16 v[28:31], v[12:15], a[16:23], v74
  ds_read_b128 v[40:43], v68
  ds_write_b32 v79, v22 offset:0
  s_waitcnt lgkmcnt(3)
  v_add_f32 v25, v25, v27
  v_cvt_pk_bf16_f32 v23, v21, v25
  v_smfmac_f32_16x16x64_bf16 v[32:35], v[8:11], v[60:67], v74
  ds_write_b32 v79, v23 offset:576
  v_cmp_u_f32 vcc, v20, v21
  v_smfmac_f32_16x16x64_bf16 v[32:35], v[16:19], v[248:255], v74
  v_add_f32 v28, v28, v30
  v_smfmac_f32_16x16x64_bf16 v[32:35], v[0:3], a[8:15], v74
  v_add_f32 v29, v29, v31
  v_smfmac_f32_16x16x64_bf16 v[32:35], v[12:15], a[24:31], v74
  s_cbranch_vccnz Cf3_rec
Cf3_recok:
  s_waitcnt lgkmcnt(3)
  v_smfmac_f32_16x16x64_bf16 v[36:39], v[16:19], a[128:135], v74
  s_waitcnt lgkmcnt(0)
  s_barrier
  ds_read_b128 v[60:63], v77
  v_smfmac_f32_16x16x64_bf16 v[40:43], v[16:19], a[136:143], v74
  ds_read_b128 v[64:67], v77 offset:128
  v_add_f32 v32, v32, v34
  v_cvt_pk_bf16_f32 v30, v28, v32
  v_smfmac_f32_16x16x64_bf16 v[36:39], v[0:3], a[144:151], v74
  ds_write_b32 v79, v30 offset:256
  v_add_f32 v33, v33, v35
  v_cvt_pk_bf16_f32 v31, v29, v33
  v_smfmac_f32_16x16x64_bf16 v[40:43], v[0:3], a[152:159], v74
  ds_write_b32 v79, v31 offset:832
  v_xor_b32 v75, 0x8000, v75
  v_smfmac_f32_16x16x64_bf16 v[36:39], v[4:7], a[96:103], v74
  ds_read_b128 v[0:3], v76 offset:4608
  v_mov_b32 v29, 0
  v_smfmac_f32_16x16x64_bf16 v[40:43], v[4:7], a[104:111], v74
  s_waitcnt vmcnt(2) lgkmcnt(3)
  v_mov_b32 v30, 0
  v_mfma_f32_16x16x32_bf16 v[44:47], v[44:47], v[60:63], 0
  ds_read_b128 v[4:7], v76 offset:5632
  s_waitcnt lgkmcnt(2)
  v_mfma_f32_16x16x32_bf16 v[44:47], v[48:51], v[64:67], v[44:47]
  s_barrier
  v_smfmac_f32_16x16x64_bf16 v[36:39], v[8:11], a[112:119], v74
  ds_read_b128 v[20:23], v77 offset:256
  ds_read_b128 v[24:27], v77 offset:384
  v_smfmac_f32_16x16x64_bf16 v[40:43], v[8:11], a[120:127], v74
  ds_read_b128 v[8:11], v76 offset:6656
  v_add_f32_dpp v72, v46, v44 quad_perm:[2,3,0,1] row_mask:0xf bank_mask:0xf
  v_add_f32_dpp v73, v47, v45 quad_perm:[2,3,0,1] row_mask:0xf bank_mask:0xf
  v_smfmac_f32_16x16x64_bf16 v[36:39], v[12:15], a[160:167], v74
  s_waitcnt lgkmcnt(4)
  v_exp_f32_dpp v72, v72 quad_perm:[0,1,0,1] row_mask:0xf bank_mask:0xf
  v_smfmac_f32_16x16x64_bf16 v[40:43], v[12:15], a[168:175], v74
  ds_read_b128 v[12:15], v76 offset:7680
  v_exp_f32_dpp v73, v73 quad_perm:[0,1,0,1] row_mask:0xf bank_mask:0xf
  v_smfmac_f32_16x16x64_bf16 v[36:39], v[0:3], a[32:39], v74
  s_waitcnt lgkmcnt(2)
  v_cvt_pk_bf16_f32 v72, v72, v73
  v_mfma_f32_16x16x32_bf16 v[20:23], v[20:23], v[60:63], 0
  ds_write_b32 v78, v72 offset:524
  v_mov_b64 v[16:17], 0
  v_mfma_f32_16x16x32_bf16 v[20:23], v[24:27], v[64:67], v[20:23]
  ds_read_b128 v[44:47], v75 offset:47104
  v_mov_b64 v[18:19], 0
  v_smfmac_f32_16x16x64_bf16 v[40:43], v[0:3], a[40:47], v74
  ds_read_b128 v[48:51], v75 offset:48128
  v_mov_b64 v[68:69], s[78:79]
  v_smfmac_f32_16x16x64_bf16 v[36:39], v[4:7], a[48:55], v74
  s_waitcnt lgkmcnt(4)
  v_add_f32_dpp v24, v22, v20 quad_perm:[2,3,0,1] row_mask:0xf bank_mask:0xf
  v_add_f32_dpp v25, v23, v21 quad_perm:[2,3,0,1] row_mask:0xf bank_mask:0xf
  v_smfmac_f32_16x16x64_bf16 v[36:39], v[8:11], a[64:71], v74
  s_waitcnt lgkmcnt(2)
  s_barrier
  ds_read_b128 v[32:35], v78 offset:512
  v_smfmac_f32_16x16x64_bf16 v[36:39], v[12:15], a[80:87], v74
  ds_read_b128 v[60:63], v75 offset:28672
  v_mul_f32 v24, s69, v24
  v_smfmac_f32_16x16x64_bf16 v[40:43], v[4:7], a[56:63], v74
  ds_read_b128 v[64:67], v75 offset:29696
  v_mul_f32 v25, s69, v25
  v_smfmac_f32_16x16x64_bf16 v[40:43], v[8:11], a[72:79], v74
  v_exp_f32_dpp v24, v24 quad_perm:[0,1,0,1] row_mask:0xf bank_mask:0xf
  v_smfmac_f32_16x16x64_bf16 v[40:43], v[12:15], a[88:95], v74
  s_waitcnt lgkmcnt(2)
  v_exp_f32_dpp v25, v25 quad_perm:[0,1,0,1] row_mask:0xf bank_mask:0xf
  v_mfma_f32_16x16x32_bf16 v[8:11], v[32:35], v[68:71], 0
  v_add_f32 v36, v36, v38
  v_add_f32 v37, v37, v39
  v_mfma_f32_16x16x32_bf16 v[0:3], v[32:35], v[52:55], 0
  v_add_f32 v40, v40, v42
  v_add_f32 v41, v41, v43
  v_mfma_f32_16x16x32_bf16 v[4:7], v[32:35], v[56:59], 0
  v_cvt_pk_bf16_f32 v28, v24, v25
  v_cvt_pk_bf16_f32 v72, v36, v37
  v_cvt_pk_bf16_f32 v73, v40, v41
  v_mfma_f32_16x16x16_bf16 v[8:11], v[28:29], v[68:69], v[8:11]
  v_cvt_pk_bf16_f32 v31, v24, v25
  v_mov_b64 v[20:21], 0
  v_mfma_f32_16x16x16_bf16 v[0:3], v[28:29], v[72:73], v[0:3]
  ds_read_b128 v[52:55], v75 offset:30720
  v_mov_b64 v[22:23], 0
  v_mfma_f32_16x16x16_bf16 v[4:7], v[30:31], v[72:73], v[4:7]
  v_rcp_f32 v10, v8
  v_rcp_f32 v11, v9
  v_mul_f32 v0, v10, v0
  v_mul_f32 v1, v11, v1
  v_max3_f32 v8, v8, v9, v10
  v_mul_f32 v4, v10, v4
  v_mul_f32 v5, v11, v5
  v_cvt_pk_bf16_f32 v2, v0, v4
  ds_write_b32 v79, v2 offset:8704
  v_cvt_pk_bf16_f32 v3, v1, v5
  ds_write_b32 v79, v3 offset:9280
  ds_read_b128 v[12:15], v78 offset:8896
  v_max_f32 v8, v8, v11
  v_cmp_le_f32 vcc, 1317011456, v8
  v_mov_b64 v[24:25], 0
  v_mov_b64 v[26:27], 0
  ds_read_b128 v[56:59], v75 offset:31744
  s_cbranch_vccnz Cf3_mx
Cf3_mxok:
  s_waitcnt lgkmcnt(2)
  s_barrier
  ds_read_b128 v[0:3], v78 offset:8832
  s_waitcnt lgkmcnt(2)
  v_smfmac_f32_16x16x64_bf16 v[16:19], v[12:15], a[184:191], v74
  ds_read_b128 v[4:7], v78 offset:8704
  v_smfmac_f32_16x16x64_bf16 v[20:23], v[12:15], v[44:51], v74
  ds_read_b128 v[8:11], v78 offset:8768
  v_smfmac_f32_16x16x64_bf16 v[24:27], v[12:15], a[232:239], v74
  ds_read_b128 v[36:39], v75 offset:45056
  s_waitcnt lgkmcnt(3)
  v_smfmac_f32_16x16x64_bf16 v[16:19], v[0:3], a[176:183], v74
  ds_read_b128 v[40:43], v75 offset:46080
  s_waitcnt lgkmcnt(3)
  v_smfmac_f32_16x16x64_bf16 v[16:19], v[4:7], v[60:67], v74
  ds_read_b128 v[68:71], v76 offset:13824
  s_waitcnt lgkmcnt(3)
  v_smfmac_f32_16x16x64_bf16 v[16:19], v[8:11], v[52:59], v74
  ds_read_b128 v[44:47], v75 offset:61440
  v_smfmac_f32_16x16x64_bf16 v[20:23], v[4:7], a[192:199], v74
  ds_read_b128 v[48:51], v75 offset:62464
  v_smfmac_f32_16x16x64_bf16 v[20:23], v[8:11], a[200:207], v74
  ds_read_b128 v[60:63], v75 offset:63488
  s_waitcnt lgkmcnt(4)
  v_cvt_pk_bf16_f32 v16, v16, v17
  v_cvt_pk_bf16_f32 v17, v18, v19
  v_bfi_b32 v16, 1, s72, v16
  v_smfmac_f32_16x16x64_bf16 v[20:23], v[0:3], v[36:43], v74
  s_waitcnt lgkmcnt(3)
  buffer_store_dwordx2 v[16:17], v68, s[8:11], s73 offen
  v_mov_b64 v[32:33], 0
  v_smfmac_f32_16x16x64_bf16 v[24:27], v[4:7], a[208:215], v74
  ds_read_b128 v[64:67], v75 offset:64512
  v_mov_b64 v[34:35], 0
  v_smfmac_f32_16x16x64_bf16 v[24:27], v[8:11], a[216:223], v74
  ds_read_b128 v[52:55], v75 offset:8192
  v_cvt_pk_bf16_f32 v20, v20, v21
  v_cvt_pk_bf16_f32 v21, v22, v23
  v_bfi_b32 v20, 1, s72, v20
  v_smfmac_f32_16x16x64_bf16 v[24:27], v[0:3], a[224:231], v74
  ds_read_b128 v[56:59], v75 offset:9216
  buffer_store_dwordx2 v[20:21], v68, s[8:11], s74 offen
  s_waitcnt lgkmcnt(4)
  v_mov_b64 v[28:29], 0
  v_smfmac_f32_16x16x64_bf16 v[32:35], v[4:7], v[44:51], v74
  ds_read_b128 v[36:39], v75 offset:10240
  ds_read_b128 v[40:43], v75 offset:11264
  s_waitcnt lgkmcnt(4)
  v_smfmac_f32_16x16x64_bf16 v[32:35], v[8:11], v[60:67], v74
  ds_read_b128 v[44:47], v75 offset:12288
  v_cvt_pk_bf16_f32 v24, v24, v25
  v_cvt_pk_bf16_f32 v25, v26, v27
  v_bfi_b32 v24, 1, s72, v24
  v_smfmac_f32_16x16x64_bf16 v[32:35], v[0:3], a[240:247], v74
  ds_read_b128 v[48:51], v75 offset:13312
  buffer_store_dwordx2 v[24:25], v68, s[8:11], s75 offen
  v_mov_b64 v[30:31], 0
  v_smfmac_f32_16x16x64_bf16 v[32:35], v[12:15], a[248:255], v74
  ds_read_b128 v[60:63], v75 offset:14336
  ds_read_b128 v[64:67], v75 offset:15360
  s_waitcnt lgkmcnt(6)
  v_smfmac_f32_16x16x64_bf16 v[28:31], v[4:7], v[52:59], v74
  s_waitcnt lgkmcnt(4)
  v_smfmac_f32_16x16x64_bf16 v[28:31], v[8:11], v[36:43], v74
  s_waitcnt lgkmcnt(2)
  v_cvt_pk_bf16_f32 v32, v32, v33
  v_cvt_pk_bf16_f32 v33, v34, v35
  v_bfi_b32 v32, 1, s72, v32
  v_smfmac_f32_16x16x64_bf16 v[28:31], v[0:3], v[44:51], v74
  buffer_store_dwordx2 v[32:33], v68, s[8:11], s76 offen
  s_waitcnt lgkmcnt(0)
  v_smfmac_f32_16x16x64_bf16 v[28:31], v[12:15], v[60:67], v74
  v_mov_b64 v[18:19], v[72:73]
  s_nop 4
  v_cvt_pk_bf16_f32 v28, v28, v29
  v_cvt_pk_bf16_f32 v29, v30, v31
  v_bfi_b32 v28, 1, s72, v28
  buffer_store_dwordx2 v[28:29], v68, s[8:11], s77 offen
  ds_read_b128 v[52:55], v76 offset:14848
  s_waitcnt lgkmcnt(0)
  ds_read_b64 v[16:17], v77 offset:392
  s_waitcnt lgkmcnt(0)
  ds_read_b128 v[60:63], v76 offset:47104
  s_waitcnt lgkmcnt(0)
  ds_read_b128 v[64:67], v76 offset:48128
  s_waitcnt lgkmcnt(0)
  s_add_u32 s66, s66, 1
  s_xor_b32 s64, s64, 16384
  s_xor_b32 s65, s65, 16384
  s_add_u32 s58, s58, 655360
  s_add_u32 s59, s59, 655360
  s_add_u32 s70, s70, 655360
  s_add_u32 s68, s68, 655360
  s_mov_b32 m0, 8704
  s_add_u32 s85, s65, 4096
  v_xor_b32 v75, 0x8000, v75
  v_mov_b64 v[28:29], 0
  v_mov_b64 v[30:31], 0
  v_mov_b64 v[32:33], 0
  v_mov_b64 v[34:35], 0
  buffer_load_dwordx4 v[0:3], v76, s[8:11], s60 offen offset:0 sc1
  buffer_load_dwordx4 v[4:7], v76, s[8:11], s60 offen offset:1024 sc1
  buffer_load_dwordx4 v[8:11], v76, s[8:11], s61 offen offset:0 sc1
  buffer_load_dwordx4 v[12:15], v76, s[8:11], s61 offen offset:1024 sc1
  v_mov_b64 v[20:21], 0
  v_mov_b64 v[22:23], 0
  v_mov_b64 v[24:25], 0
  v_mov_b64 v[26:27], 0
  v_mov_b32 v68, 14880
  s_cmp_eq_u32 s66, 62
  s_cselect_b64 s[16:17], s[20:21], s[16:17]
  s_cselect_b32 s18, (Cf3_done - Cf3_last), s18
  s_cselect_b32 s70, 0, s70
  s_cmp_eq_u32 s66, 63
  s_cselect_b32 s59, 268435456, s59
  s_cselect_b32 s58, 268435456, s58
  s_waitcnt lgkmcnt(0)
  s_waitcnt vmcnt(3)
  v_mfma_f32_16x16x32_bf16 v[56:59], v[52:55], v[0:3], 0
  v_bitop3_b32 v72, v0, v2, s72 bitop3:0x7e
  s_waitcnt vmcnt(2)
  v_mfma_f32_16x16x32_bf16 v[56:59], v[52:55], v[4:7], v[56:59]
  v_bitop3_b32 v73, v4, v6, s72 bitop3:0x7e
  v_or_b32 v72, v72, v73
  s_waitcnt vmcnt(1)
  v_mfma_f32_16x16x32_bf16 v[36:39], v[52:55], v[8:11], 0
  v_bitop3_b32 v73, v8, v10, s72 bitop3:0x7e
  v_or_b32 v72, v72, v73
  s_waitcnt vmcnt(0)
  v_mfma_f32_16x16x32_bf16 v[36:39], v[52:55], v[12:15], v[36:39]
  v_bitop3_b32 v73, v12, v14, s72 bitop3:0x7e
  v_bitop3_b32 v72, v72, v73, 1 bitop3:0xa8
  v_cmp_ne_u32 vcc, 0, v72
  s_cbranch_vccnz Cf3_h1r
  buffer_load_dwordx4 v[4:7], v76, s[8:11], s65 offen offset:1024 sc1
  v_add_f32_dpp v56, v56, v56 row_ror:4 row_mask:0xf bank_mask:0xf
  v_add_f32_dpp v57, v57, v57 row_ror:4 row_mask:0xf bank_mask:0xf
  v_add_f32_dpp v36, v36, v36 row_ror:4 row_mask:0xf bank_mask:0xf
  v_add_f32_dpp v37, v37, v37 row_ror:4 row_mask:0xf bank_mask:0xf
  v_add_f32_dpp v56, v56, v56 row_ror:8 row_mask:0xf bank_mask:0xf
  v_add_f32_dpp v57, v57, v57 row_ror:8 row_mask:0xf bank_mask:0xf
  v_add_f32_dpp v36, v36, v36 row_ror:8 row_mask:0xf bank_mask:0xf
  v_add_f32_dpp v37, v37, v37 row_ror:8 row_mask:0xf bank_mask:0xf
  v_cvt_pk_bf16_f32 v56, v56, v57
  buffer_store_dword v56, v69, s[8:11], s62 offen
  v_cvt_pk_bf16_f32 v36, v36, v37
  buffer_store_dword v36, v70, s[8:11], s63 offen
  s_xor_b32 s62, s62, 16384
  buffer_store_dword v71, v69, s[8:11], s62 offen
  s_xor_b32 s63, s63, 16384
  buffer_store_dword v71, v70, s[8:11], s63 offen
  s_xor_b32 s72, s72, 1
  s_branch Cf3_h2
Cf3_h1r:
  s_mov_b64 exec, vcc
  buffer_load_dwordx4 v[0:3], v76, s[8:11], s60 offen offset:0 sc1
  buffer_load_dwordx4 v[4:7], v76, s[8:11], s60 offen offset:1024 sc1
  buffer_load_dwordx4 v[8:11], v76, s[8:11], s61 offen offset:0 sc1
  buffer_load_dwordx4 v[12:15], v76, s[8:11], s61 offen offset:1024 sc1
  s_mov_b64 exec, -1
  s_add_u32 s67, s67, 1
  s_waitcnt vmcnt(3)
  v_mfma_f32_16x16x32_bf16 v[56:59], v[52:55], v[0:3], 0
  v_bitop3_b32 v72, v0, v2, s72 bitop3:0x7e
  s_waitcnt vmcnt(2)
  v_mfma_f32_16x16x32_bf16 v[56:59], v[52:55], v[4:7], v[56:59]
  v_bitop3_b32 v73, v4, v6, s72 bitop3:0x7e
  v_or_b32 v72, v72, v73
  s_waitcnt vmcnt(1)
  v_mfma_f32_16x16x32_bf16 v[36:39], v[52:55], v[8:11], 0
  v_bitop3_b32 v73, v8, v10, s72 bitop3:0x7e
  v_or_b32 v72, v72, v73
  s_waitcnt vmcnt(0)
  v_mfma_f32_16x16x32_bf16 v[36:39], v[52:55], v[12:15], v[36:39]
  v_bitop3_b32 v73, v12, v14, s72 bitop3:0x7e
  v_bitop3_b32 v72, v72, v73, 1 bitop3:0xa8
  v_cmp_ne_u32 vcc, 0, v72
  s_cbranch_vccz Cf3_h1p
Cf3_h1s:
  s_mov_b64 exec, vcc
  buffer_load_dwordx4 v[0:3], v76, s[8:11], s60 offen offset:0 sc1
  buffer_load_dwordx4 v[4:7], v76, s[8:11], s60 offen offset:1024 sc1
  buffer_load_dwordx4 v[8:11], v76, s[8:11], s61 offen offset:0 sc1
  buffer_load_dwordx4 v[12:15], v76, s[8:11], s61 offen offset:1024 sc1
  s_mov_b64 exec, -1
  s_add_u32 s67, s67, 1
  s_waitcnt vmcnt(3)
  v_mfma_f32_16x16x32_bf16 v[56:59], v[52:55], v[0:3], 0
  v_bitop3_b32 v72, v0, v2, s72 bitop3:0x7e
  s_waitcnt vmcnt(2)
  v_mfma_f32_16x16x32_bf16 v[56:59], v[52:55], v[4:7], v[56:59]
  v_bitop3_b32 v73, v4, v6, s72 bitop3:0x7e
  v_or_b32 v72, v72, v73
  s_waitcnt vmcnt(1)
  v_mfma_f32_16x16x32_bf16 v[36:39], v[52:55], v[8:11], 0
  v_bitop3_b32 v73, v8, v10, s72 bitop3:0x7e
  v_or_b32 v72, v72, v73
  s_waitcnt vmcnt(0)
  v_mfma_f32_16x16x32_bf16 v[36:39], v[52:55], v[12:15], v[36:39]
  v_bitop3_b32 v73, v12, v14, s72 bitop3:0x7e
  v_bitop3_b32 v72, v72, v73, 1 bitop3:0xa8
  v_cmp_ne_u32 vcc, 0, v72
  s_cbranch_vccz Cf3_h1p
  s_cmp_lt_u32 s67, 131072
  s_cbranch_scc1 Cf3_h1s
Cf3_h1p:
  s_nop 2
  buffer_load_dwordx4 v[4:7], v76, s[8:11], s65 offen offset:1024 sc1
  v_add_f32_dpp v56, v56, v56 row_ror:4 row_mask:0xf bank_mask:0xf
  v_add_f32_dpp v57, v57, v57 row_ror:4 row_mask:0xf bank_mask:0xf
  v_add_f32_dpp v36, v36, v36 row_ror:4 row_mask:0xf bank_mask:0xf
  v_add_f32_dpp v37, v37, v37 row_ror:4 row_mask:0xf bank_mask:0xf
  v_add_f32_dpp v56, v56, v56 row_ror:8 row_mask:0xf bank_mask:0xf
  v_add_f32_dpp v57, v57, v57 row_ror:8 row_mask:0xf bank_mask:0xf
  v_add_f32_dpp v36, v36, v36 row_ror:8 row_mask:0xf bank_mask:0xf
  v_add_f32_dpp v37, v37, v37 row_ror:8 row_mask:0xf bank_mask:0xf
  v_cvt_pk_bf16_f32 v56, v56, v57
  buffer_store_dword v56, v69, s[8:11], s62 offen
  v_cvt_pk_bf16_f32 v36, v36, v37
  buffer_store_dword v36, v70, s[8:11], s63 offen
  s_xor_b32 s62, s62, 16384
  buffer_store_dword v71, v69, s[8:11], s62 offen
  s_xor_b32 s63, s63, 16384
  buffer_store_dword v71, v70, s[8:11], s63 offen
  s_xor_b32 s72, s72, 1
  s_branch Cf3_h2
Cf3_h2r:
  s_mov_b64 exec, vcc
  buffer_load_dwordx4 v[4:7], v76, s[8:11], s65 offen offset:1024 sc1
  s_mov_b64 exec, -1
  s_add_u32 s67, s67, 1
  s_waitcnt vmcnt(3)
  v_max3_u32 v72, v4, v5, v6
  v_max_u32 v72, v72, v7
  ds_write_b128 v76, v[4:7] offset:5632
  v_cmp_eq_u32 vcc, -1, v72
  s_cbranch_vccz Cf3_h2w
Cf3_h2s:
  s_mov_b64 exec, vcc
  buffer_load_dwordx4 v[4:7], v76, s[8:11], s65 offen offset:1024 sc1
  s_mov_b64 exec, -1
  s_add_u32 s67, s67, 1
  s_waitcnt vmcnt(1)
  v_max3_u32 v72, v4, v5, v6
  v_max_u32 v72, v72, v7
  ds_write_b128 v76, v[4:7] offset:5632
  v_cmp_eq_u32 vcc, -1, v72
  s_cbranch_vccz Cf3_h2w
  s_mov_b64 exec, vcc
  buffer_load_dwordx4 v[4:7], v76, s[8:11], s65 offen offset:1024 sc1
  s_mov_b64 exec, -1
  s_add_u32 s67, s67, 1
  s_waitcnt vmcnt(1)
  v_max3_u32 v72, v4, v5, v6
  v_max_u32 v72, v72, v7
  ds_write_b128 v76, v[4:7] offset:5632
  v_cmp_eq_u32 vcc, -1, v72
  s_cbranch_vccz Cf3_h2w
  s_mov_b64 exec, vcc
  buffer_load_dwordx4 v[4:7], v76, s[8:11], s65 offen offset:1024 sc1
  s_mov_b64 exec, -1
  s_add_u32 s67, s67, 1
  s_waitcnt vmcnt(1)
  v_max3_u32 v72, v4, v5, v6
  v_max_u32 v72, v72, v7
  ds_write_b128 v76, v[4:7] offset:5632
  v_cmp_eq_u32 vcc, -1, v72
  s_cbranch_vccz Cf3_h2w
  s_cmp_lt_u32 s67, 131072
  s_cbranch_scc1 Cf3_h2s
  s_branch Cf3_h2w
Cf3_rec:
  s_nop 7
  s_waitcnt vmcnt(0) lgkmcnt(0)
  v_max3_u32 v72, v0, v1, v2
  v_max3_u32 v72, v72, v3, v4
  v_max3_u32 v72, v72, v5, v6
  v_max3_u32 v72, v72, v7, v8
  v_max3_u32 v72, v72, v9, v10
  v_max3_u32 v72, v72, v11, v12
  v_max3_u32 v72, v72, v13, v14
  v_max3_u32 v72, v72, v15, v16
  v_max3_u32 v72, v72, v17, v18
  v_max_u32 v72, v72, v19
  v_cmp_eq_u32 vcc, -1, v72
  s_cbranch_vccz Cf3_recok
  s_barrier
Cf3_recp:
  buffer_load_dwordx4 v[0:3], v76, s[8:11], s64 offen offset:0 sc1
  buffer_load_dwordx4 v[4:7], v76, s[8:11], s64 offen offset:1024 sc1
  buffer_load_dwordx4 v[8:11], v76, s[8:11], s64 offen offset:2048 sc1
  s_add_u32 s67, s67, 1
  s_cmp_lt_u32 s67, 131072
  s_cselect_b32 s54, -2, -1
  s_waitcnt vmcnt(2)
  v_max3_u32 v72, v0, v1, v2
  s_waitcnt vmcnt(1)
  v_max3_u32 v72, v72, v3, v4
  v_max3_u32 v72, v72, v5, v6
  s_waitcnt vmcnt(0)
  v_max3_u32 v72, v72, v7, v8
  v_max3_u32 v72, v72, v9, v10
  v_max_u32 v72, v72, v11
  v_cmp_lt_u32 vcc, s54, v72
  s_cbranch_vccnz Cf3_recp
  ds_write_b128 v76, v[0:3] offset:10752
  ds_write_b128 v76, v[4:7] offset:11776
  ds_write_b128 v76, v[8:11] offset:12800
  v_mov_b64 v[20:21], 0
  v_mov_b64 v[22:23], 0
  v_mov_b64 v[24:25], 0
  v_mov_b64 v[26:27], 0
  v_mov_b64 v[28:29], 0
  v_mov_b64 v[30:31], 0
  v_mov_b64 v[32:33], 0
  v_mov_b64 v[34:35], 0
  s_waitcnt lgkmcnt(0)
  s_barrier
  ds_read_b128 v[0:3], v76 offset:4608
  s_waitcnt lgkmcnt(0)
  v_smfmac_f32_16x16x64_bf16 v[20:23], v[0:3], v[80:87], v74
  v_smfmac_f32_16x16x64_bf16 v[24:27], v[0:3], v[88:95], v74
  ds_read_b128 v[60:63], v76 offset:28672
  ds_read_b128 v[64:67], v76 offset:29696
  s_waitcnt lgkmcnt(0)
  v_smfmac_f32_16x16x64_bf16 v[28:31], v[0:3], v[60:67], v74
  ds_read_b128 v[60:63], v76 offset:30720
  ds_read_b128 v[64:67], v76 offset:31744
  s_waitcnt lgkmcnt(0)
  v_smfmac_f32_16x16x64_bf16 v[32:35], v[0:3], v[60:67], v74
  ds_read_b128 v[4:7], v76 offset:5632
  s_waitcnt lgkmcnt(0)
  v_smfmac_f32_16x16x64_bf16 v[20:23], v[4:7], v[96:103], v74
  v_smfmac_f32_16x16x64_bf16 v[24:27], v[4:7], v[104:111], v74
  ds_read_b128 v[60:63], v76 offset:45056
  ds_read_b128 v[64:67], v76 offset:46080
  s_waitcnt lgkmcnt(0)
  v_smfmac_f32_16x16x64_bf16 v[28:31], v[4:7], v[60:67], v74
  ds_read_b128 v[60:63], v76 offset:47104
  ds_read_b128 v[64:67], v76 offset:48128
  s_waitcnt lgkmcnt(0)
  v_smfmac_f32_16x16x64_bf16 v[32:35], v[4:7], v[60:67], v74
  ds_read_b128 v[8:11], v76 offset:6656
  s_waitcnt lgkmcnt(0)
  v_smfmac_f32_16x16x64_bf16 v[20:23], v[8:11], v[112:119], v74
  v_smfmac_f32_16x16x64_bf16 v[24:27], v[8:11], v[120:127], v74
  v_smfmac_f32_16x16x64_bf16 v[28:31], v[8:11], v[208:215], v74
  v_smfmac_f32_16x16x64_bf16 v[32:35], v[8:11], v[216:223], v74
  ds_read_b128 v[12:15], v76 offset:7680
  s_waitcnt lgkmcnt(0)
  v_smfmac_f32_16x16x64_bf16 v[20:23], v[12:15], v[128:135], v74
  v_smfmac_f32_16x16x64_bf16 v[24:27], v[12:15], v[136:143], v74
  v_smfmac_f32_16x16x64_bf16 v[28:31], v[12:15], v[224:231], v74
  v_smfmac_f32_16x16x64_bf16 v[32:35], v[12:15], v[232:239], v74
  ds_read_b128 v[4:7], v76 offset:8704
  s_waitcnt lgkmcnt(0)
  v_smfmac_f32_16x16x64_bf16 v[20:23], v[4:7], v[144:151], v74
  v_smfmac_f32_16x16x64_bf16 v[24:27], v[4:7], v[152:159], v74
  ds_read_b128 v[60:63], v76 offset:61440
  ds_read_b128 v[64:67], v76 offset:62464
  s_waitcnt lgkmcnt(0)
  v_smfmac_f32_16x16x64_bf16 v[28:31], v[4:7], v[60:67], v74
  ds_read_b128 v[60:63], v76 offset:63488
  ds_read_b128 v[64:67], v76 offset:64512
  s_waitcnt lgkmcnt(0)
  v_smfmac_f32_16x16x64_bf16 v[32:35], v[4:7], v[60:67], v74
  ds_read_b128 v[8:11], v76 offset:9728
  s_waitcnt lgkmcnt(0)
  v_smfmac_f32_16x16x64_bf16 v[20:23], v[8:11], v[160:167], v74
  v_smfmac_f32_16x16x64_bf16 v[24:27], v[8:11], v[168:175], v74
  ds_read_b128 v[60:63], v75 offset:28672
  ds_read_b128 v[64:67], v75 offset:29696
  s_waitcnt lgkmcnt(0)
  v_smfmac_f32_16x16x64_bf16 v[28:31], v[8:11], v[60:67], v74
  ds_read_b128 v[60:63], v75 offset:30720
  ds_read_b128 v[64:67], v75 offset:31744
  s_waitcnt lgkmcnt(0)
  v_smfmac_f32_16x16x64_bf16 v[32:35], v[8:11], v[60:67], v74
  ds_read_b128 v[16:19], v76 offset:10752
  ds_read_b128 v[60:63], v75 offset:12288
  ds_read_b128 v[64:67], v75 offset:13312
  s_waitcnt lgkmcnt(0)
  v_smfmac_f32_16x16x64_bf16 v[20:23], v[16:19], v[60:67], v74
  ds_read_b128 v[60:63], v75 offset:14336
  ds_read_b128 v[64:67], v75 offset:15360
  s_waitcnt lgkmcnt(0)
  v_smfmac_f32_16x16x64_bf16 v[24:27], v[16:19], v[60:67], v74
  v_smfmac_f32_16x16x64_bf16 v[28:31], v[16:19], v[240:247], v74
  v_smfmac_f32_16x16x64_bf16 v[32:35], v[16:19], v[248:255], v74
  ds_read_b128 v[0:3], v76 offset:11776
  s_waitcnt lgkmcnt(0)
  v_smfmac_f32_16x16x64_bf16 v[20:23], v[0:3], v[176:183], v74
  v_smfmac_f32_16x16x64_bf16 v[24:27], v[0:3], v[184:191], v74
  v_smfmac_f32_16x16x64_bf16 v[28:31], v[0:3], a[0:7], v74
  v_smfmac_f32_16x16x64_bf16 v[32:35], v[0:3], a[8:15], v74
  ds_read_b128 v[12:15], v76 offset:12800
  s_waitcnt lgkmcnt(0)
  v_smfmac_f32_16x16x64_bf16 v[20:23], v[12:15], v[192:199], v74
  v_smfmac_f32_16x16x64_bf16 v[24:27], v[12:15], v[200:207], v74
  v_smfmac_f32_16x16x64_bf16 v[28:31], v[12:15], a[16:23], v74
  v_smfmac_f32_16x16x64_bf16 v[32:35], v[12:15], a[24:31], v74
  v_add_f32 v20, v20, v22
  v_add_f32 v21, v21, v23
  v_add_f32 v24, v24, v26
  v_cvt_pk_bf16_f32 v22, v20, v24
  ds_write_b32 v79, v22 offset:0
  v_add_f32 v25, v25, v27
  v_cvt_pk_bf16_f32 v23, v21, v25
  ds_write_b32 v79, v23 offset:576
  v_add_f32 v28, v28, v30
  v_add_f32 v29, v29, v31
  s_waitcnt lgkmcnt(0)
  s_nop 1
  s_branch Cf3_recok
Cf3_mx:
  s_waitcnt lgkmcnt(0)
  s_barrier
  buffer_load_dwordx4 v[52:55], v76, s[8:11], s59 offen offset:0 sc1
  buffer_load_dwordx4 v[0:3], v76, s[8:11], s58 offen offset:0 sc1
  ds_read_b128 v[20:23], v77 offset:0
  ds_read_b128 v[28:31], v77 offset:256
  buffer_load_dwordx4 v[56:59], v76, s[8:11], s59 offen offset:1024 sc1
  buffer_load_dwordx4 v[4:7], v76, s[8:11], s58 offen offset:1024 sc1
  ds_read_b128 v[24:27], v77 offset:128
  ds_read_b128 v[32:35], v77 offset:384
  s_waitcnt vmcnt(2) lgkmcnt(3)
  v_mfma_f32_16x16x32_bf16 v[8:11], v[0:3], v[20:23], 0
  s_waitcnt vmcnt(0) lgkmcnt(1)
  v_mfma_f32_16x16x32_bf16 v[8:11], v[4:7], v[24:27], v[8:11]
  v_mfma_f32_16x16x32_bf16 v[12:15], v[28:31], v[20:23], 0
  s_waitcnt lgkmcnt(0)
  v_mfma_f32_16x16x32_bf16 v[12:15], v[32:35], v[24:27], v[12:15]
  v_add_f32_dpp v8, v10, v8 quad_perm:[2,3,0,1] row_mask:0xf bank_mask:0xf
  v_add_f32_dpp v9, v11, v9 quad_perm:[2,3,0,1] row_mask:0xf bank_mask:0xf
  s_nop 0
  v_mov_b32_dpp v8, v8 quad_perm:[0,1,0,1] row_mask:0xf bank_mask:0xf
  v_mov_b32_dpp v9, v9 quad_perm:[0,1,0,1] row_mask:0xf bank_mask:0xf
  s_nop 1
  v_add_f32_dpp v12, v14, v12 quad_perm:[2,3,0,1] row_mask:0xf bank_mask:0xf
  v_add_f32_dpp v13, v15, v13 quad_perm:[2,3,0,1] row_mask:0xf bank_mask:0xf
  s_nop 0
  v_mov_b32_dpp v12, v12 quad_perm:[0,1,0,1] row_mask:0xf bank_mask:0xf
  v_mov_b32_dpp v13, v13 quad_perm:[0,1,0,1] row_mask:0xf bank_mask:0xf
  v_mul_f32 v12, s69, v12
  ds_write_b32 v78, v8 offset:8716
  v_mul_f32 v13, s69, v13
  ds_write_b32 v78, v9 offset:8780
  s_waitcnt lgkmcnt(0)
  s_barrier
  ds_read_b128 v[36:39], v78 offset:8704
  ds_read_b128 v[40:43], v78 offset:8768
  s_waitcnt lgkmcnt(0)
  s_barrier
  v_max_f32 v16, v36, v37
  v_max3_f32 v16, v16, v38, v39
  v_max3_f32 v16, v16, v40, v41
  v_max3_f32 v16, v16, v42, v43
  v_max3_f32 v16, v16, v12, v13
  v_mov_b32 v17, v16
  s_nop 1
  v_permlane16_swap_b32 v16, v17
  v_max_f32 v16, v16, v17
  v_mov_b32 v17, v16
  s_nop 1
  v_permlane32_swap_b32 v16, v17
  v_max_f32 v16, v16, v17
  v_sub_f32 v36, v36, v16
  v_sub_f32 v37, v37, v16
  v_sub_f32 v38, v38, v16
  v_sub_f32 v39, v39, v16
  v_sub_f32 v40, v40, v16
  v_sub_f32 v41, v41, v16
  v_sub_f32 v42, v42, v16
  v_sub_f32 v43, v43, v16
  v_sub_f32 v12, v12, v16
  v_sub_f32 v13, v13, v16
  v_exp_f32 v36, v36
  v_exp_f32 v37, v37
  v_exp_f32 v38, v38
  v_exp_f32 v39, v39
  v_exp_f32 v40, v40
  v_exp_f32 v41, v41
  v_exp_f32 v42, v42
  v_exp_f32 v43, v43
  v_exp_f32 v12, v12
  v_exp_f32 v13, v13
  v_cvt_pk_bf16_f32 v32, v36, v40
  v_cvt_pk_bf16_f32 v33, v37, v41
  v_cvt_pk_bf16_f32 v34, v38, v42
  v_cvt_pk_bf16_f32 v35, v39, v43
  v_cvt_pk_bf16_f32 v28, v12, v13
  v_cvt_pk_bf16_f32 v31, v12, v13
  v_mov_b32 v29, 0
  v_mov_b32 v30, 0
  v_mfma_f32_16x16x32_bf16 v[8:11], v[32:35], v[68:71], 0
  v_mfma_f32_16x16x32_bf16 v[0:3], v[32:35], v[52:55], 0
  v_mfma_f32_16x16x32_bf16 v[4:7], v[32:35], v[56:59], 0
  v_mfma_f32_16x16x16_bf16 v[8:11], v[28:29], v[68:69], v[8:11]
  v_mfma_f32_16x16x16_bf16 v[0:3], v[28:29], v[72:73], v[0:3]
  v_mfma_f32_16x16x16_bf16 v[4:7], v[30:31], v[72:73], v[4:7]
  ds_read_b128 v[52:55], v75 offset:30720
  v_rcp_f32 v10, v8
  v_rcp_f32 v11, v9
  v_mul_f32 v0, v10, v0
  v_mul_f32 v1, v11, v1
  v_max3_f32 v8, v8, v9, v10
  v_mul_f32 v4, v10, v4
  v_mul_f32 v5, v11, v5
  v_cvt_pk_bf16_f32 v2, v0, v4
  ds_write_b32 v79, v2 offset:8704
  v_cvt_pk_bf16_f32 v3, v1, v5
  ds_write_b32 v79, v3 offset:9280
  ds_read_b128 v[12:15], v78 offset:8896
  ds_read_b128 v[56:59], v75 offset:31744
  v_mov_b64 v[16:17], 0
  v_mov_b64 v[18:19], 0
  v_mov_b64 v[20:21], 0
  v_mov_b64 v[22:23], 0
  v_mov_b64 v[24:25], 0
  v_mov_b64 v[26:27], 0
  s_branch Cf3_mxok
Cf3_last:
  ds_read_b128 v[0:3], v76 offset:4608
  ds_read_b128 v[12:15], v76 offset:7680
  ds_read_b128 v[44:47], v76 offset:28672
  ds_read_b128 v[48:51], v76 offset:29696
  s_nop 5
  v_mov_b64 v[20:21], 0
  v_mov_b64 v[22:23], 0
  v_mov_b64 v[24:25], 0
  v_mov_b64 v[26:27], 0
  v_smfmac_f32_16x16x64_bf16 v[28:31], v[4:7], v[36:43], v74
  ds_read_b128 v[36:39], v76 offset:30720
  ds_read_b128 v[40:43], v76 offset:31744
  v_smfmac_f32_16x16x64_bf16 v[32:35], v[4:7], v[60:67], v74
  s_waitcnt lgkmcnt(5)
  v_smfmac_f32_16x16x64_bf16 v[20:23], v[0:3], a[32:39], v74
  ds_read_b128 v[60:63], v76 offset:61440
  ds_read_b128 v[64:67], v76 offset:62464
  v_smfmac_f32_16x16x64_bf16 v[24:27], v[0:3], a[40:47], v74
  s_waitcnt lgkmcnt(4)
  v_smfmac_f32_16x16x64_bf16 v[20:23], v[4:7], a[48:55], v74
  buffer_store_dwordx4 v[16:19], v76, s[8:11], s68 offen sc1
  v_smfmac_f32_16x16x64_bf16 v[24:27], v[4:7], a[56:63], v74
  v_smfmac_f32_16x16x64_bf16 v[28:31], v[0:3], v[44:51], v74
  s_waitcnt lgkmcnt(2)
  v_smfmac_f32_16x16x64_bf16 v[20:23], v[8:11], a[64:71], v74
  ds_read_b128 v[44:47], v76 offset:63488
  ds_read_b128 v[48:51], v76 offset:64512
  v_smfmac_f32_16x16x64_bf16 v[24:27], v[8:11], a[72:79], v74
  v_smfmac_f32_16x16x64_bf16 v[32:35], v[0:3], v[36:43], v74
  v_smfmac_f32_16x16x64_bf16 v[28:31], v[8:11], v[208:215], v74
  ds_read_b128 v[36:39], v75 offset:28672
  ds_read_b128 v[40:43], v75 offset:29696
  v_smfmac_f32_16x16x64_bf16 v[32:35], v[8:11], v[216:223], v74
  v_smfmac_f32_16x16x64_bf16 v[20:23], v[12:15], a[80:87], v74
  v_smfmac_f32_16x16x64_bf16 v[24:27], v[12:15], a[88:95], v74
  v_smfmac_f32_16x16x64_bf16 v[28:31], v[12:15], v[224:231], v74
  v_smfmac_f32_16x16x64_bf16 v[32:35], v[12:15], v[232:239], v74
  s_waitcnt vmcnt(1)
  s_barrier
Cf3_lastr:
  ds_read_b128 v[4:7], v76 offset:8704
  ds_read_b128 v[8:11], v76 offset:9728
  ds_read_b128 v[16:19], v76 offset:10752
  ds_read_b128 v[0:3], v76 offset:11776
  ds_read_b128 v[12:15], v76 offset:12800
  s_waitcnt lgkmcnt(1)
  v_max3_u32 v72, v0, v1, v2
  v_max3_u32 v72, v72, v3, v4
  v_max3_u32 v72, v72, v5, v6
  v_max3_u32 v72, v72, v7, v8
  v_max3_u32 v72, v72, v9, v10
  s_waitcnt lgkmcnt(0)
  v_max3_u32 v72, v72, v11, v12
  v_max3_u32 v72, v72, v13, v14
  v_max3_u32 v72, v72, v15, v16
  v_max3_u32 v72, v72, v17, v18
  v_max_u32 v72, v72, v19
  v_cmp_eq_u32 vcc, -1, v72
  s_cbranch_vccnz Cf3_lastp
Cf3_lastg:
  v_smfmac_f32_16x16x64_bf16 v[28:31], v[4:7], v[60:67], v74
  ds_read_b128 v[60:63], v75 offset:30720
  ds_read_b128 v[64:67], v75 offset:31744
  v_smfmac_f32_16x16x64_bf16 v[32:35], v[4:7], v[44:51], v74
  v_smfmac_f32_16x16x64_bf16 v[28:31], v[8:11], v[36:43], v74
  v_smfmac_f32_16x16x64_bf16 v[28:31], v[16:19], v[240:247], v74
  v_smfmac_f32_16x16x64_bf16 v[28:31], v[0:3], a[0:7], v74
  v_smfmac_f32_16x16x64_bf16 v[28:31], v[12:15], a[16:23], v74
  v_smfmac_f32_16x16x64_bf16 v[32:35], v[16:19], v[248:255], v74
  v_smfmac_f32_16x16x64_bf16 v[32:35], v[0:3], a[8:15], v74
  s_waitcnt lgkmcnt(0)
  v_smfmac_f32_16x16x64_bf16 v[32:35], v[12:15], a[24:31], v74
  v_smfmac_f32_16x16x64_bf16 v[32:35], v[8:11], v[60:67], v74
  v_smfmac_f32_16x16x64_bf16 v[20:23], v[4:7], a[96:103], v74
  v_smfmac_f32_16x16x64_bf16 v[20:23], v[8:11], a[112:119], v74
  v_add_f32 v28, v28, v30
  v_add_f32 v32, v32, v34
  v_cvt_pk_bf16_f32 v30, v28, v32
  v_smfmac_f32_16x16x64_bf16 v[20:23], v[16:19], a[128:135], v74
  ds_write_b32 v79, v30 offset:256
  v_add_f32 v29, v29, v31
  v_add_f32 v33, v33, v35
  v_cvt_pk_bf16_f32 v31, v29, v33
  v_smfmac_f32_16x16x64_bf16 v[20:23], v[0:3], a[144:151], v74
  ds_write_b32 v79, v31 offset:832
  v_smfmac_f32_16x16x64_bf16 v[20:23], v[12:15], a[160:167], v74
  v_smfmac_f32_16x16x64_bf16 v[24:27], v[4:7], a[104:111], v74
  v_smfmac_f32_16x16x64_bf16 v[24:27], v[8:11], a[120:127], v74
  v_smfmac_f32_16x16x64_bf16 v[24:27], v[16:19], a[136:143], v74
  s_waitcnt lgkmcnt(0)
  s_barrier
  ds_read_b64 v[52:53], v77 offset:392
  v_add_f32 v20, v20, v22
  v_smfmac_f32_16x16x64_bf16 v[24:27], v[0:3], a[152:159], v74
  v_add_f32 v21, v21, v23
  v_smfmac_f32_16x16x64_bf16 v[24:27], v[12:15], a[168:175], v74
  v_cvt_pk_bf16_f32 v54, v20, v21
  s_add_u32 s68, s68, 655360
  s_nop 3
  v_add_f32 v24, v24, v26
  v_add_f32 v25, v25, v27
  v_cvt_pk_bf16_f32 v55, v24, v25
  s_waitcnt lgkmcnt(0)
  buffer_store_dwordx4 v[52:55], v76, s[8:11], s68 offen sc1
  s_branch Cf3_done
Cf3_lastp:
  s_add_u32 s72, s72, 2
  s_cmp_ge_u32 s72, 131072
  s_cbranch_scc1 Cf3_lastg
  s_barrier
  buffer_load_dwordx4 v76, s[8:11], s85 offen offset:0 sc1 lds
  buffer_load_dwordx4 v76, s[8:11], s85 offen offset:1024 sc1 lds
  s_waitcnt vmcnt(0)
  s_barrier
  s_branch Cf3_lastr
Cf3_done:
  s_branch L_cexit
L_w4:
  v_mov_b64 v[20:21], 0
  v_mov_b64 v[22:23], 0
  v_mov_b64 v[24:25], 0
  v_mov_b64 v[26:27], 0
  v_mov_b64 v[28:29], 0
  v_mov_b64 v[30:31], 0
  v_mov_b64 v[32:33], 0
  v_mov_b64 v[34:35], 0
  s_mov_b32 s78, 0x3f803f80
  s_mov_b32 s79, s78
  s_mov_b32 s65, 360448
  s_mov_b32 m0, 16128
  s_lshl_b32 s71, s53, 2
  s_add_u32 s71, s71, 128
  s_movk_i32 s56, 0x1000
  v_lshlrev_b32 v73, 2, v76
  v_mov_b32 v72, 0
  s_mov_b64 s[16:17], s[8:9]
  s_mov_b32 s18, 268435456
  s_mov_b32 s19, 0x20000
  s_getpc_b64 s[20:21]
Cs0_pc:
  s_add_u32 s20, s20, (Cs0_last - Cs0_pc)
  s_addc_u32 s21, s21, 0
  v_mov_b32 v68, 14880
  buffer_load_dwordx4 v[52:55], v76, s[8:11], s59 offen offset:0 sc1
  buffer_load_dwordx4 v[56:59], v76, s[8:11], s59 offen offset:1024 sc1
  ds_read_b128 v[36:39], v76 offset:16384
  ds_read_b128 v[40:43], v76 offset:17408
  ds_read_b128 v[60:63], v76 offset:18432
  ds_read_b128 v[64:67], v76 offset:19456
  ds_read_b128 v[0:3], v76 offset:4608
  ds_read_b128 v[4:7], v76 offset:5632
  ds_read_b128 v[8:11], v76 offset:6656
  ds_read_b128 v[12:15], v76 offset:7680
  s_waitcnt lgkmcnt(0)
  s_cmp_eq_u32 s66, 1
  s_branch Cs0_top2
.p2align 6
Cs0_h2:
  ds_read_b128 v[36:39], v76 offset:16384
  v_mov_b64 v[20:21], 0
  v_mov_b64 v[22:23], 0
  v_mov_b64 v[24:25], 0
  v_mov_b64 v[26:27], 0
  v_mov_b32 v68, 14880
  ds_read_b128 v[40:43], v76 offset:17408
  s_cmp_eq_u32 s66, 62
  s_cselect_b64 s[16:17], s[20:21], s[16:17]
  s_cselect_b32 s18, (Cs0_done - Cs0_last), s18
  s_cselect_b32 s70, 0, s70
  s_cmp_eq_u32 s66, 63
  s_cselect_b32 s59, 268435456, s59
  s_cselect_b32 s58, 268435456, s58
  ds_read_b128 v[60:63], v76 offset:18432
  v_lshlrev_b32 v73, 2, v76
  s_cmp_eq_u32 s66, 12
  s_cselect_b32 s56, s71, 0x1000
  ds_read_b32 v72, v76 offset:16128
  s_cmp_eq_u32 s66, 13
  s_cselect_b32 s54, 0x700, 0
  s_waitcnt lgkmcnt(0)
  v_readfirstlane_b32 s57, v72
  s_nop 0
  s_cmp_lt_u32 s57, s54
  s_cbranch_scc1 Cs0_kv3
Cs0_kvb:
  buffer_load_dwordx4 v[52:55], v76, s[8:11], s59 offen offset:0 sc1
  buffer_load_dwordx4 v[56:59], v76, s[8:11], s59 offen offset:1024 sc1
  s_waitcnt vmcnt(0)
  s_mov_b64 vcc, -1
Cs0_h2r:
  s_mov_b64 exec, vcc
  buffer_load_dwordx4 v[0:3], v76, s[8:11], s65 offen offset:0 sc1
  buffer_load_dwordx4 v[4:7], v76, s[8:11], s85 offen offset:0 sc1
  s_mov_b64 exec, -1
  s_add_u32 s67, s67, 1
  s_cmp_lt_u32 s67, 131072
  s_cselect_b32 s54, -2, -1
  s_waitcnt vmcnt(1)
  v_max3_u32 v72, v0, v1, v2
  s_waitcnt vmcnt(0)
  v_max3_u32 v72, v72, v3, v4
  v_max3_u32 v72, v72, v5, v6
  v_max_u32 v72, v72, v7
  v_cmp_lt_u32 vcc, s54, v72
  s_cbranch_vccnz Cs0_h2r
  ds_write_b128 v76, v[0:3] offset:4608
  ds_write_b128 v76, v[4:7] offset:10752
Cs0_h2w:
  s_cmp_eq_u32 s66, 63
  s_waitcnt lgkmcnt(0)
  s_barrier
  ds_read_b128 v[8:11], v76 offset:6656
Cs0_top2:
  v_smfmac_f32_16x16x64_bf16 v[20:23], v[0:3], v[80:87], v74
  s_cbranch_scc1 Cs0_last
  v_smfmac_f32_16x16x64_bf16 v[28:31], v[0:3], v[36:43], v74
  buffer_load_dwordx4 v[44:47], v76, s[8:11], s58 offen offset:0 sc1
  s_mov_b32 m0, 16128
  v_smfmac_f32_16x16x64_bf16 v[24:27], v[0:3], v[88:95], v74
  buffer_load_dwordx4 v[48:51], v76, s[8:11], s58 offen offset:1024 sc1
  v_smfmac_f32_16x16x64_bf16 v[32:35], v[0:3], v[60:67], v74
  ds_read_b128 v[4:7], v76 offset:5632
  s_waitcnt lgkmcnt(1)
  v_smfmac_f32_16x16x64_bf16 v[20:23], v[8:11], v[112:119], v74
  ds_read_b128 v[12:15], v76 offset:7680
  v_smfmac_f32_16x16x64_bf16 v[24:27], v[8:11], v[120:127], v74
  ds_read_b128 v[36:39], v76 offset:32768
  v_smfmac_f32_16x16x64_bf16 v[28:31], v[8:11], v[208:215], v74
  buffer_store_dwordx4 v[16:19], v76, s[8:11], s68 offen sc1
  ds_read_b128 v[40:43], v76 offset:33792
  v_smfmac_f32_16x16x64_bf16 v[32:35], v[8:11], v[216:223], v74
  buffer_load_dword v73, s[16:19], s70 offen lds
  ds_read_b128 v[60:63], v76 offset:34816
  s_waitcnt lgkmcnt(4)
  v_smfmac_f32_16x16x64_bf16 v[20:23], v[4:7], v[96:103], v74
  ds_read_b128 v[64:67], v76 offset:35840
  v_smfmac_f32_16x16x64_bf16 v[24:27], v[4:7], v[104:111], v74
  s_waitcnt vmcnt(4)
  s_waitcnt lgkmcnt(4)
  v_smfmac_f32_16x16x64_bf16 v[20:23], v[12:15], v[128:135], v74
  s_barrier
  ds_read_b128 v[0:3], v76 offset:8704
  s_waitcnt lgkmcnt(3)
  v_smfmac_f32_16x16x64_bf16 v[28:31], v[4:7], v[36:43], v74
  ds_read_b128 v[36:39], v76 offset:49152
  v_smfmac_f32_16x16x64_bf16 v[24:27], v[12:15], v[136:143], v74
  ds_read_b128 v[40:43], v76 offset:50176
  s_waitcnt lgkmcnt(3)
  v_smfmac_f32_16x16x64_bf16 v[32:35], v[4:7], v[60:67], v74
  ds_read_b128 v[8:11], v76 offset:9728
  v_smfmac_f32_16x16x64_bf16 v[28:31], v[12:15], v[224:231], v74
  ds_read_b128 v[60:63], v76 offset:51200
  v_smfmac_f32_16x16x64_bf16 v[32:35], v[12:15], v[232:239], v74
  ds_read_b128 v[64:67], v76 offset:52224
  s_waitcnt lgkmcnt(5)
  v_smfmac_f32_16x16x64_bf16 v[20:23], v[0:3], v[144:151], v74
  s_barrier
  ds_read_b128 v[4:7], v76 offset:11776
  s_waitcnt lgkmcnt(4)
  v_smfmac_f32_16x16x64_bf16 v[28:31], v[0:3], v[36:43], v74
  ds_read_b128 v[12:15], v76 offset:12800
  ds_read_b128 v[36:39], v75 offset:0
  v_smfmac_f32_16x16x64_bf16 v[24:27], v[0:3], v[152:159], v74
  ds_read_b128 v[16:19], v76 offset:10752
  s_waitcnt lgkmcnt(6)
  v_smfmac_f32_16x16x64_bf16 v[20:23], v[8:11], v[160:167], v74
  ds_read_b128 v[40:43], v75 offset:1024
  s_waitcnt lgkmcnt(5)
  v_smfmac_f32_16x16x64_bf16 v[32:35], v[0:3], v[60:67], v74
  ds_read_b128 v[60:63], v75 offset:2048
  v_smfmac_f32_16x16x64_bf16 v[24:27], v[8:11], v[168:175], v74
  ds_read_b128 v[64:67], v75 offset:3072
  s_waitcnt lgkmcnt(6)
  v_smfmac_f32_16x16x64_bf16 v[20:23], v[4:7], v[176:183], v74
  buffer_load_dword off, s[12:15], s56 sc1 lds
  s_waitcnt lgkmcnt(5)
  v_smfmac_f32_16x16x64_bf16 v[20:23], v[12:15], v[192:199], v74
  s_waitcnt lgkmcnt(2)
  v_smfmac_f32_16x16x64_bf16 v[20:23], v[16:19], v[36:43], v74
  ds_read_b128 v[36:39], v75 offset:16384
  v_smfmac_f32_16x16x64_bf16 v[24:27], v[4:7], v[184:191], v74
  ds_read_b128 v[40:43], v75 offset:17408
  s_waitcnt lgkmcnt(2)
  v_smfmac_f32_16x16x64_bf16 v[24:27], v[16:19], v[60:67], v74
  ds_read_b128 v[60:63], v75 offset:18432
  v_add_f32 v20, v20, v22
  v_smfmac_f32_16x16x64_bf16 v[24:27], v[12:15], v[200:207], v74
  ds_read_b128 v[64:67], v75 offset:19456
  v_add_f32 v21, v21, v23
  v_smfmac_f32_16x16x64_bf16 v[28:31], v[16:19], v[240:247], v74
  v_mov_b64 v[70:71], s[78:79]
  v_smfmac_f32_16x16x64_bf16 v[28:31], v[4:7], a[0:7], v74
  s_waitcnt lgkmcnt(2)
  v_add_f32 v24, v24, v26
  v_smfmac_f32_16x16x64_bf16 v[28:31], v[8:11], v[36:43], v74
  ds_read_b128 v[36:39], v68
  v_cvt_pk_bf16_f32 v22, v20, v24
  v_smfmac_f32_16x16x64_bf16 v[28:31], v[12:15], a[16:23], v74
  ds_read_b128 v[40:43], v68
  ds_write_b32 v79, v22 offset:0
  s_waitcnt lgkmcnt(3)
  v_add_f32 v25, v25, v27
  v_cvt_pk_bf16_f32 v23, v21, v25
  v_smfmac_f32_16x16x64_bf16 v[32:35], v[8:11], v[60:67], v74
  ds_write_b32 v79, v23 offset:576
  v_cmp_u_f32 vcc, v20, v21
  v_smfmac_f32_16x16x64_bf16 v[32:35], v[16:19], v[248:255], v74
  v_add_f32 v28, v28, v30
  v_smfmac_f32_16x16x64_bf16 v[32:35], v[4:7], a[8:15], v74
  v_add_f32 v29, v29, v31
  v_smfmac_f32_16x16x64_bf16 v[32:35], v[12:15], a[24:31], v74
  s_cbranch_vccnz Cs0_rec
Cs0_recok:
  s_waitcnt lgkmcnt(3)
  v_smfmac_f32_16x16x64_bf16 v[36:39], v[16:19], a[128:135], v74
  s_waitcnt lgkmcnt(0)
  s_barrier
  ds_read_b128 v[60:63], v77
  v_smfmac_f32_16x16x64_bf16 v[40:43], v[16:19], a[136:143], v74
  ds_read_b128 v[64:67], v77 offset:128
  v_add_f32 v32, v32, v34
  v_cvt_pk_bf16_f32 v30, v28, v32
  v_smfmac_f32_16x16x64_bf16 v[36:39], v[0:3], a[96:103], v74
  ds_write_b32 v79, v30 offset:256
  v_add_f32 v33, v33, v35
  v_cvt_pk_bf16_f32 v31, v29, v33
  v_smfmac_f32_16x16x64_bf16 v[40:43], v[0:3], a[104:111], v74
  ds_write_b32 v79, v31 offset:832
  v_xor_b32 v75, 0x8000, v75
  v_smfmac_f32_16x16x64_bf16 v[36:39], v[4:7], a[144:151], v74
  ds_read_b128 v[0:3], v76 offset:4608
  v_mov_b32 v29, 0
  v_smfmac_f32_16x16x64_bf16 v[40:43], v[4:7], a[152:159], v74
  s_waitcnt vmcnt(3) lgkmcnt(3)
  v_mov_b32 v30, 0
  v_mfma_f32_16x16x32_bf16 v[44:47], v[44:47], v[60:63], 0
  ds_read_b128 v[4:7], v76 offset:5632
  s_waitcnt lgkmcnt(2)
  v_mfma_f32_16x16x32_bf16 v[44:47], v[48:51], v[64:67], v[44:47]
  s_barrier
  v_smfmac_f32_16x16x64_bf16 v[36:39], v[8:11], a[112:119], v74
  ds_read_b128 v[20:23], v77 offset:256
  ds_read_b128 v[24:27], v77 offset:384
  v_smfmac_f32_16x16x64_bf16 v[40:43], v[8:11], a[120:127], v74
  ds_read_b128 v[8:11], v76 offset:6656
  v_add_f32_dpp v72, v46, v44 quad_perm:[2,3,0,1] row_mask:0xf bank_mask:0xf
  v_add_f32_dpp v73, v47, v45 quad_perm:[2,3,0,1] row_mask:0xf bank_mask:0xf
  v_smfmac_f32_16x16x64_bf16 v[36:39], v[12:15], a[160:167], v74
  s_waitcnt lgkmcnt(4)
  v_exp_f32_dpp v72, v72 quad_perm:[0,1,0,1] row_mask:0xf bank_mask:0xf
  v_smfmac_f32_16x16x64_bf16 v[40:43], v[12:15], a[168:175], v74
  ds_read_b128 v[12:15], v76 offset:7680
  v_exp_f32_dpp v73, v73 quad_perm:[0,1,0,1] row_mask:0xf bank_mask:0xf
  v_smfmac_f32_16x16x64_bf16 v[36:39], v[0:3], a[32:39], v74
  s_waitcnt lgkmcnt(2)
  v_cvt_pk_bf16_f32 v72, v72, v73
  v_mfma_f32_16x16x32_bf16 v[20:23], v[20:23], v[60:63], 0
  ds_write_b32 v78, v72 offset:512
  v_mov_b64 v[16:17], 0
  v_mfma_f32_16x16x32_bf16 v[20:23], v[24:27], v[64:67], v[20:23]
  ds_read_b128 v[44:47], v75 offset:16384
  v_mov_b64 v[18:19], 0
  v_smfmac_f32_16x16x64_bf16 v[40:43], v[0:3], a[40:47], v74
  ds_read_b128 v[48:51], v75 offset:17408
  v_mov_b64 v[68:69], s[78:79]
  v_smfmac_f32_16x16x64_bf16 v[36:39], v[4:7], a[48:55], v74
  s_waitcnt lgkmcnt(4)
  v_add_f32_dpp v24, v22, v20 quad_perm:[2,3,0,1] row_mask:0xf bank_mask:0xf
  v_add_f32_dpp v25, v23, v21 quad_perm:[2,3,0,1] row_mask:0xf bank_mask:0xf
  v_smfmac_f32_16x16x64_bf16 v[36:39], v[8:11], a[64:71], v74
  s_waitcnt lgkmcnt(2)
  s_barrier
  ds_read_b128 v[32:35], v78 offset:512
  v_smfmac_f32_16x16x64_bf16 v[36:39], v[12:15], a[80:87], v74
  ds_read_b128 v[60:63], v75 offset:18432
  v_mul_f32 v24, s69, v24
  v_smfmac_f32_16x16x64_bf16 v[40:43], v[4:7], a[56:63], v74
  ds_read_b128 v[64:67], v75 offset:19456
  v_mul_f32 v25, s69, v25
  v_smfmac_f32_16x16x64_bf16 v[40:43], v[8:11], a[72:79], v74
  v_exp_f32_dpp v24, v24 quad_perm:[0,1,0,1] row_mask:0xf bank_mask:0xf
  v_smfmac_f32_16x16x64_bf16 v[40:43], v[12:15], a[88:95], v74
  s_waitcnt lgkmcnt(2)
  v_exp_f32_dpp v25, v25 quad_perm:[0,1,0,1] row_mask:0xf bank_mask:0xf
  v_mfma_f32_16x16x32_bf16 v[8:11], v[32:35], v[68:71], 0
  v_add_f32 v36, v36, v38
  v_add_f32 v37, v37, v39
  v_mfma_f32_16x16x32_bf16 v[0:3], v[32:35], v[52:55], 0
  v_add_f32 v40, v40, v42
  v_add_f32 v41, v41, v43
  v_mfma_f32_16x16x32_bf16 v[4:7], v[32:35], v[56:59], 0
  v_cvt_pk_bf16_f32 v28, v24, v25
  v_cvt_pk_bf16_f32 v72, v36, v37
  v_cvt_pk_bf16_f32 v73, v40, v41
  v_mfma_f32_16x16x16_bf16 v[8:11], v[28:29], v[68:69], v[8:11]
  v_cvt_pk_bf16_f32 v31, v24, v25
  v_mov_b64 v[20:21], 0
  v_mfma_f32_16x16x16_bf16 v[0:3], v[28:29], v[72:73], v[0:3]
  ds_read_b128 v[52:55], v75 offset:32768
  v_mov_b64 v[22:23], 0
  v_mfma_f32_16x16x16_bf16 v[4:7], v[30:31], v[72:73], v[4:7]
  v_rcp_f32 v10, v8
  v_rcp_f32 v11, v9
  v_mul_f32 v0, v10, v0
  v_mul_f32 v1, v11, v1
  v_max3_f32 v8, v8, v9, v10
  v_mul_f32 v4, v10, v4
  v_mul_f32 v5, v11, v5
  v_cvt_pk_bf16_f32 v2, v0, v4
  ds_write_b32 v79, v2 offset:8704
  v_cvt_pk_bf16_f32 v3, v1, v5
  ds_write_b32 v79, v3 offset:9280
  ds_read_b128 v[12:15], v78 offset:8704
  v_max_f32 v8, v8, v11
  v_cmp_le_f32 vcc, 1317011456, v8
  v_mov_b64 v[24:25], 0
  v_mov_b64 v[26:27], 0
  ds_read_b128 v[56:59], v75 offset:33792
  s_cbranch_vccnz Cs0_mx
Cs0_mxok:
  s_waitcnt lgkmcnt(2)
  s_barrier
  ds_read_b128 v[0:3], v78 offset:8768
  s_waitcnt lgkmcnt(2)
  v_smfmac_f32_16x16x64_bf16 v[16:19], v[12:15], v[44:51], v74
  ds_read_b128 v[4:7], v78 offset:8832
  v_smfmac_f32_16x16x64_bf16 v[20:23], v[12:15], a[192:199], v74
  ds_read_b128 v[8:11], v78 offset:8896
  v_smfmac_f32_16x16x64_bf16 v[24:27], v[12:15], a[208:215], v74
  ds_read_b128 v[36:39], v75 offset:34816
  s_waitcnt lgkmcnt(3)
  v_smfmac_f32_16x16x64_bf16 v[16:19], v[0:3], v[60:67], v74
  ds_read_b128 v[40:43], v75 offset:35840
  s_waitcnt lgkmcnt(3)
  v_smfmac_f32_16x16x64_bf16 v[16:19], v[4:7], a[176:183], v74
  ds_read_b128 v[68:71], v76 offset:13824
  s_waitcnt lgkmcnt(3)
  v_smfmac_f32_16x16x64_bf16 v[16:19], v[8:11], a[184:191], v74
  ds_read_b128 v[44:47], v75 offset:49152
  v_smfmac_f32_16x16x64_bf16 v[20:23], v[0:3], a[200:207], v74
  ds_read_b128 v[48:51], v75 offset:50176
  v_smfmac_f32_16x16x64_bf16 v[20:23], v[4:7], v[52:59], v74
  ds_read_b128 v[60:63], v75 offset:51200
  s_waitcnt lgkmcnt(4)
  v_cvt_pk_bf16_f32 v16, v16, v17
  v_cvt_pk_bf16_f32 v17, v18, v19
  v_bfi_b32 v16, 1, s72, v16
  v_smfmac_f32_16x16x64_bf16 v[20:23], v[8:11], v[36:43], v74
  s_waitcnt lgkmcnt(3)
  buffer_store_dwordx2 v[16:17], v68, s[8:11], s73 offen sc1
  v_mov_b64 v[32:33], 0
  v_smfmac_f32_16x16x64_bf16 v[24:27], v[0:3], a[216:223], v74
  ds_read_b128 v[64:67], v75 offset:52224
  v_mov_b64 v[34:35], 0
  v_smfmac_f32_16x16x64_bf16 v[24:27], v[4:7], a[224:231], v74
  v_cvt_pk_bf16_f32 v20, v20, v21
  v_cvt_pk_bf16_f32 v21, v22, v23
  v_bfi_b32 v20, 1, s72, v20
  v_smfmac_f32_16x16x64_bf16 v[24:27], v[8:11], a[232:239], v74
  buffer_store_dwordx2 v[20:21], v68, s[8:11], s74 offen sc1
  s_waitcnt lgkmcnt(2)
  v_smfmac_f32_16x16x64_bf16 v[32:35], v[12:15], v[44:51], v74
  s_waitcnt lgkmcnt(0)
  v_smfmac_f32_16x16x64_bf16 v[32:35], v[0:3], v[60:67], v74
  v_cvt_pk_bf16_f32 v24, v24, v25
  v_cvt_pk_bf16_f32 v25, v26, v27
  v_bfi_b32 v24, 1, s72, v24
  v_smfmac_f32_16x16x64_bf16 v[32:35], v[4:7], a[240:247], v74
  buffer_store_dwordx2 v[24:25], v68, s[8:11], s75 offen sc1
  v_smfmac_f32_16x16x64_bf16 v[32:35], v[8:11], a[248:255], v74
  v_mov_b64 v[18:19], v[72:73]
  s_nop 4
  v_cvt_pk_bf16_f32 v32, v32, v33
  v_cvt_pk_bf16_f32 v33, v34, v35
  v_bfi_b32 v32, 1, s72, v32
  buffer_store_dwordx2 v[32:33], v68, s[8:11], s76 offen sc1
  ds_read_b128 v[0:3], v76 offset:14848
  s_waitcnt lgkmcnt(0)
  ds_read_b64 v[16:17], v77 offset:256
  s_waitcnt lgkmcnt(0)
  ds_read_b128 v[64:67], v76 offset:19456
  s_waitcnt lgkmcnt(0)
  v_xor_b32 v75, 0x8000, v75
  v_mov_b64 v[28:29], 0
  v_mov_b64 v[30:31], 0
  v_mov_b64 v[32:33], 0
  v_mov_b64 v[34:35], 0
  s_waitcnt vmcnt(0)
  buffer_load_dwordx4 v[52:55], v76, s[8:11], s60 offen offset:0 sc1
  buffer_load_dwordx4 v[56:59], v76, s[8:11], s60 offen offset:1024 sc1
  s_add_u32 s66, s66, 1
  s_xor_b32 s64, s64, 16384
  s_xor_b32 s65, s65, 16384
  s_add_u32 s58, s58, 655360
  s_add_u32 s59, s59, 655360
  s_add_u32 s70, s70, 655360
  s_add_u32 s68, s68, 655360
  s_mov_b32 m0, 10752
  s_add_u32 s85, s65, 6144
  s_waitcnt lgkmcnt(0)
  s_waitcnt vmcnt(1)
  v_mfma_f32_16x16x32_bf16 v[4:7], v[0:3], v[52:55], 0
  v_bitop3_b32 v72, v52, v54, s72 bitop3:0x7e
  s_waitcnt vmcnt(0)
  v_mfma_f32_16x16x32_bf16 v[4:7], v[0:3], v[56:59], v[4:7]
  v_bitop3_b32 v73, v56, v58, s72 bitop3:0x7e
  v_bitop3_b32 v72, v72, v73, 1 bitop3:0xa8
  v_cmp_ne_u32 vcc, 0, v72
  s_cbranch_vccnz Cs0_h1r
  s_nop 2
  v_add_f32_dpp v4, v4, v4 row_ror:4 row_mask:0xf bank_mask:0xf
  v_add_f32_dpp v5, v5, v5 row_ror:4 row_mask:0xf bank_mask:0xf
  s_nop 0
  v_add_f32_dpp v4, v4, v4 row_ror:8 row_mask:0xf bank_mask:0xf
  v_add_f32_dpp v5, v5, v5 row_ror:8 row_mask:0xf bank_mask:0xf
  v_cvt_pk_bf16_f32 v4, v4, v5
  buffer_store_dword v4, v69, s[8:11], s62 offen sc1
  s_xor_b32 s62, s62, 16384
  buffer_store_dword v71, v69, s[8:11], s62 offen sc1
  s_xor_b32 s72, s72, 1
  s_branch Cs0_h2
Cs0_h1r:
  s_mov_b64 exec, vcc
  buffer_load_dwordx4 v[52:55], v76, s[8:11], s60 offen offset:0 sc1
  buffer_load_dwordx4 v[56:59], v76, s[8:11], s60 offen offset:1024 sc1
  s_mov_b64 exec, -1
  s_add_u32 s67, s67, 1
  s_waitcnt vmcnt(1)
  v_mfma_f32_16x16x32_bf16 v[4:7], v[0:3], v[52:55], 0
  v_bitop3_b32 v72, v52, v54, s72 bitop3:0x7e
  s_waitcnt vmcnt(0)
  v_mfma_f32_16x16x32_bf16 v[4:7], v[0:3], v[56:59], v[4:7]
  v_bitop3_b32 v73, v56, v58, s72 bitop3:0x7e
  v_bitop3_b32 v72, v72, v73, 1 bitop3:0xa8
  v_cmp_ne_u32 vcc, 0, v72
  s_cbranch_vccz Cs0_h1p
Cs0_h1s:
  s_mov_b64 exec, vcc
  buffer_load_dwordx4 v[52:55], v76, s[8:11], s60 offen offset:0 sc1
  buffer_load_dwordx4 v[56:59], v76, s[8:11], s60 offen offset:1024 sc1
  s_mov_b64 exec, -1
  s_add_u32 s67, s67, 1
  s_waitcnt vmcnt(1)
  v_mfma_f32_16x16x32_bf16 v[4:7], v[0:3], v[52:55], 0
  v_bitop3_b32 v72, v52, v54, s72 bitop3:0x7e
  s_waitcnt vmcnt(0)
  v_mfma_f32_16x16x32_bf16 v[4:7], v[0:3], v[56:59], v[4:7]
  v_bitop3_b32 v73, v56, v58, s72 bitop3:0x7e
  v_bitop3_b32 v72, v72, v73, 1 bitop3:0xa8
  v_cmp_ne_u32 vcc, 0, v72
  s_cbranch_vccz Cs0_h1p
  s_cmp_lt_u32 s67, 131072
  s_cbranch_scc1 Cs0_h1s
Cs0_h1p:
  s_nop 2
  v_add_f32_dpp v4, v4, v4 row_ror:4 row_mask:0xf bank_mask:0xf
  v_add_f32_dpp v5, v5, v5 row_ror:4 row_mask:0xf bank_mask:0xf
  s_nop 0
  v_add_f32_dpp v4, v4, v4 row_ror:8 row_mask:0xf bank_mask:0xf
  v_add_f32_dpp v5, v5, v5 row_ror:8 row_mask:0xf bank_mask:0xf
  v_cvt_pk_bf16_f32 v4, v4, v5
  buffer_store_dword v4, v69, s[8:11], s62 offen sc1
  s_xor_b32 s62, s62, 16384
  buffer_store_dword v71, v69, s[8:11], s62 offen sc1
  s_xor_b32 s72, s72, 1
  s_branch Cs0_h2
Cs0_rec:
  s_nop 7
  s_waitcnt vmcnt(0) lgkmcnt(0)
  v_max3_u32 v72, v0, v1, v2
  v_max3_u32 v72, v72, v3, v4
  v_max3_u32 v72, v72, v5, v6
  v_max3_u32 v72, v72, v7, v8
  v_max3_u32 v72, v72, v9, v10
  v_max3_u32 v72, v72, v11, v12
  v_max3_u32 v72, v72, v13, v14
  v_max3_u32 v72, v72, v15, v16
  v_max3_u32 v72, v72, v17, v18
  v_max_u32 v72, v72, v19
  v_cmp_eq_u32 vcc, -1, v72
  s_cbranch_vccz Cs0_recok
  s_barrier
  v_mov_b64 v[20:21], 0
  v_mov_b64 v[22:23], 0
  v_mov_b64 v[24:25], 0
  v_mov_b64 v[26:27], 0
  v_mov_b64 v[28:29], 0
  v_mov_b64 v[30:31], 0
  v_mov_b64 v[32:33], 0
  v_mov_b64 v[34:35], 0
  s_waitcnt lgkmcnt(0)
  s_barrier
  ds_read_b128 v[0:3], v76 offset:4608
  s_waitcnt lgkmcnt(0)
  v_smfmac_f32_16x16x64_bf16 v[20:23], v[0:3], v[80:87], v74
  v_smfmac_f32_16x16x64_bf16 v[24:27], v[0:3], v[88:95], v74
  ds_read_b128 v[60:63], v76 offset:16384
  ds_read_b128 v[64:67], v76 offset:17408
  s_waitcnt lgkmcnt(0)
  v_smfmac_f32_16x16x64_bf16 v[28:31], v[0:3], v[60:67], v74
  ds_read_b128 v[60:63], v76 offset:18432
  ds_read_b128 v[64:67], v76 offset:19456
  s_waitcnt lgkmcnt(0)
  v_smfmac_f32_16x16x64_bf16 v[32:35], v[0:3], v[60:67], v74
  ds_read_b128 v[4:7], v76 offset:5632
  s_waitcnt lgkmcnt(0)
  v_smfmac_f32_16x16x64_bf16 v[20:23], v[4:7], v[96:103], v74
  v_smfmac_f32_16x16x64_bf16 v[24:27], v[4:7], v[104:111], v74
  ds_read_b128 v[60:63], v76 offset:32768
  ds_read_b128 v[64:67], v76 offset:33792
  s_waitcnt lgkmcnt(0)
  v_smfmac_f32_16x16x64_bf16 v[28:31], v[4:7], v[60:67], v74
  ds_read_b128 v[60:63], v76 offset:34816
  ds_read_b128 v[64:67], v76 offset:35840
  s_waitcnt lgkmcnt(0)
  v_smfmac_f32_16x16x64_bf16 v[32:35], v[4:7], v[60:67], v74
  ds_read_b128 v[8:11], v76 offset:6656
  s_waitcnt lgkmcnt(0)
  v_smfmac_f32_16x16x64_bf16 v[20:23], v[8:11], v[112:119], v74
  v_smfmac_f32_16x16x64_bf16 v[24:27], v[8:11], v[120:127], v74
  v_smfmac_f32_16x16x64_bf16 v[28:31], v[8:11], v[208:215], v74
  v_smfmac_f32_16x16x64_bf16 v[32:35], v[8:11], v[216:223], v74
  ds_read_b128 v[12:15], v76 offset:7680
  s_waitcnt lgkmcnt(0)
  v_smfmac_f32_16x16x64_bf16 v[20:23], v[12:15], v[128:135], v74
  v_smfmac_f32_16x16x64_bf16 v[24:27], v[12:15], v[136:143], v74
  v_smfmac_f32_16x16x64_bf16 v[28:31], v[12:15], v[224:231], v74
  v_smfmac_f32_16x16x64_bf16 v[32:35], v[12:15], v[232:239], v74
  ds_read_b128 v[0:3], v76 offset:8704
  s_waitcnt lgkmcnt(0)
  v_smfmac_f32_16x16x64_bf16 v[20:23], v[0:3], v[144:151], v74
  v_smfmac_f32_16x16x64_bf16 v[24:27], v[0:3], v[152:159], v74
  ds_read_b128 v[60:63], v76 offset:49152
  ds_read_b128 v[64:67], v76 offset:50176
  s_waitcnt lgkmcnt(0)
  v_smfmac_f32_16x16x64_bf16 v[28:31], v[0:3], v[60:67], v74
  ds_read_b128 v[60:63], v76 offset:51200
  ds_read_b128 v[64:67], v76 offset:52224
  s_waitcnt lgkmcnt(0)
  v_smfmac_f32_16x16x64_bf16 v[32:35], v[0:3], v[60:67], v74
  ds_read_b128 v[8:11], v76 offset:9728
  s_waitcnt lgkmcnt(0)
  v_smfmac_f32_16x16x64_bf16 v[20:23], v[8:11], v[160:167], v74
  v_smfmac_f32_16x16x64_bf16 v[24:27], v[8:11], v[168:175], v74
  ds_read_b128 v[60:63], v75 offset:16384
  ds_read_b128 v[64:67], v75 offset:17408
  s_waitcnt lgkmcnt(0)
  v_smfmac_f32_16x16x64_bf16 v[28:31], v[8:11], v[60:67], v74
  ds_read_b128 v[60:63], v75 offset:18432
  ds_read_b128 v[64:67], v75 offset:19456
  s_waitcnt lgkmcnt(0)
  v_smfmac_f32_16x16x64_bf16 v[32:35], v[8:11], v[60:67], v74
  ds_read_b128 v[16:19], v76 offset:10752
  ds_read_b128 v[60:63], v75 offset:0
  ds_read_b128 v[64:67], v75 offset:1024
  s_waitcnt lgkmcnt(0)
  v_smfmac_f32_16x16x64_bf16 v[20:23], v[16:19], v[60:67], v74
  ds_read_b128 v[60:63], v75 offset:2048
  ds_read_b128 v[64:67], v75 offset:3072
  s_waitcnt lgkmcnt(0)
  v_smfmac_f32_16x16x64_bf16 v[24:27], v[16:19], v[60:67], v74
  v_smfmac_f32_16x16x64_bf16 v[28:31], v[16:19], v[240:247], v74
  v_smfmac_f32_16x16x64_bf16 v[32:35], v[16:19], v[248:255], v74
  ds_read_b128 v[4:7], v76 offset:11776
  s_waitcnt lgkmcnt(0)
  v_smfmac_f32_16x16x64_bf16 v[20:23], v[4:7], v[176:183], v74
  v_smfmac_f32_16x16x64_bf16 v[24:27], v[4:7], v[184:191], v74
  v_smfmac_f32_16x16x64_bf16 v[28:31], v[4:7], a[0:7], v74
  v_smfmac_f32_16x16x64_bf16 v[32:35], v[4:7], a[8:15], v74
  ds_read_b128 v[12:15], v76 offset:12800
  s_waitcnt lgkmcnt(0)
  v_smfmac_f32_16x16x64_bf16 v[20:23], v[12:15], v[192:199], v74
  v_smfmac_f32_16x16x64_bf16 v[24:27], v[12:15], v[200:207], v74
  v_smfmac_f32_16x16x64_bf16 v[28:31], v[12:15], a[16:23], v74
  v_smfmac_f32_16x16x64_bf16 v[32:35], v[12:15], a[24:31], v74
  v_add_f32 v20, v20, v22
  v_add_f32 v21, v21, v23
  v_add_f32 v24, v24, v26
  v_cvt_pk_bf16_f32 v22, v20, v24
  ds_write_b32 v79, v22 offset:0
  v_add_f32 v25, v25, v27
  v_cvt_pk_bf16_f32 v23, v21, v25
  ds_write_b32 v79, v23 offset:576
  v_add_f32 v28, v28, v30
  v_add_f32 v29, v29, v31
  s_waitcnt lgkmcnt(0)
  s_nop 1
  s_branch Cs0_recok
Cs0_mx:
  s_waitcnt lgkmcnt(0)
  s_barrier
  buffer_load_dwordx4 v[52:55], v76, s[8:11], s59 offen offset:0 sc1
  buffer_load_dwordx4 v[0:3], v76, s[8:11], s58 offen offset:0 sc1
  ds_read_b128 v[20:23], v77 offset:0
  ds_read_b128 v[28:31], v77 offset:256
  buffer_load_dwordx4 v[56:59], v76, s[8:11], s59 offen offset:1024 sc1
  buffer_load_dwordx4 v[4:7], v76, s[8:11], s58 offen offset:1024 sc1
  ds_read_b128 v[24:27], v77 offset:128
  ds_read_b128 v[32:35], v77 offset:384
  s_waitcnt vmcnt(2) lgkmcnt(3)
  v_mfma_f32_16x16x32_bf16 v[8:11], v[0:3], v[20:23], 0
  s_waitcnt vmcnt(0) lgkmcnt(1)
  v_mfma_f32_16x16x32_bf16 v[8:11], v[4:7], v[24:27], v[8:11]
  v_mfma_f32_16x16x32_bf16 v[12:15], v[28:31], v[20:23], 0
  s_waitcnt lgkmcnt(0)
  v_mfma_f32_16x16x32_bf16 v[12:15], v[32:35], v[24:27], v[12:15]
  v_add_f32_dpp v8, v10, v8 quad_perm:[2,3,0,1] row_mask:0xf bank_mask:0xf
  v_add_f32_dpp v9, v11, v9 quad_perm:[2,3,0,1] row_mask:0xf bank_mask:0xf
  s_nop 0
  v_mov_b32_dpp v8, v8 quad_perm:[0,1,0,1] row_mask:0xf bank_mask:0xf
  v_mov_b32_dpp v9, v9 quad_perm:[0,1,0,1] row_mask:0xf bank_mask:0xf
  s_nop 1
  v_add_f32_dpp v12, v14, v12 quad_perm:[2,3,0,1] row_mask:0xf bank_mask:0xf
  v_add_f32_dpp v13, v15, v13 quad_perm:[2,3,0,1] row_mask:0xf bank_mask:0xf
  s_nop 0
  v_mov_b32_dpp v12, v12 quad_perm:[0,1,0,1] row_mask:0xf bank_mask:0xf
  v_mov_b32_dpp v13, v13 quad_perm:[0,1,0,1] row_mask:0xf bank_mask:0xf
  v_mul_f32 v12, s69, v12
  ds_write_b32 v78, v8 offset:8704
  v_mul_f32 v13, s69, v13
  ds_write_b32 v78, v9 offset:8768
  s_waitcnt lgkmcnt(0)
  s_barrier
  ds_read_b128 v[36:39], v78 offset:8704
  ds_read_b128 v[40:43], v78 offset:8768
  s_waitcnt lgkmcnt(0)
  s_barrier
  v_max_f32 v16, v36, v37
  v_max3_f32 v16, v16, v38, v39
  v_max3_f32 v16, v16, v40, v41
  v_max3_f32 v16, v16, v42, v43
  v_max3_f32 v16, v16, v12, v13
  v_mov_b32 v17, v16
  s_nop 1
  v_permlane16_swap_b32 v16, v17
  v_max_f32 v16, v16, v17
  v_mov_b32 v17, v16
  s_nop 1
  v_permlane32_swap_b32 v16, v17
  v_max_f32 v16, v16, v17
  v_sub_f32 v36, v36, v16
  v_sub_f32 v37, v37, v16
  v_sub_f32 v38, v38, v16
  v_sub_f32 v39, v39, v16
  v_sub_f32 v40, v40, v16
  v_sub_f32 v41, v41, v16
  v_sub_f32 v42, v42, v16
  v_sub_f32 v43, v43, v16
  v_sub_f32 v12, v12, v16
  v_sub_f32 v13, v13, v16
  v_exp_f32 v36, v36
  v_exp_f32 v37, v37
  v_exp_f32 v38, v38
  v_exp_f32 v39, v39
  v_exp_f32 v40, v40
  v_exp_f32 v41, v41
  v_exp_f32 v42, v42
  v_exp_f32 v43, v43
  v_exp_f32 v12, v12
  v_exp_f32 v13, v13
  v_cvt_pk_bf16_f32 v32, v36, v40
  v_cvt_pk_bf16_f32 v33, v37, v41
  v_cvt_pk_bf16_f32 v34, v38, v42
  v_cvt_pk_bf16_f32 v35, v39, v43
  v_cvt_pk_bf16_f32 v28, v12, v13
  v_cvt_pk_bf16_f32 v31, v12, v13
  v_mov_b32 v29, 0
  v_mov_b32 v30, 0
  v_mfma_f32_16x16x32_bf16 v[8:11], v[32:35], v[68:71], 0
  v_mfma_f32_16x16x32_bf16 v[0:3], v[32:35], v[52:55], 0
  v_mfma_f32_16x16x32_bf16 v[4:7], v[32:35], v[56:59], 0
  v_mfma_f32_16x16x16_bf16 v[8:11], v[28:29], v[68:69], v[8:11]
  v_mfma_f32_16x16x16_bf16 v[0:3], v[28:29], v[72:73], v[0:3]
  v_mfma_f32_16x16x16_bf16 v[4:7], v[30:31], v[72:73], v[4:7]
  ds_read_b128 v[52:55], v75 offset:32768
  v_rcp_f32 v10, v8
  v_rcp_f32 v11, v9
  v_mul_f32 v0, v10, v0
  v_mul_f32 v1, v11, v1
  v_max3_f32 v8, v8, v9, v10
  v_mul_f32 v4, v10, v4
  v_mul_f32 v5, v11, v5
  v_cvt_pk_bf16_f32 v2, v0, v4
  ds_write_b32 v79, v2 offset:8704
  v_cvt_pk_bf16_f32 v3, v1, v5
  ds_write_b32 v79, v3 offset:9280
  ds_read_b128 v[12:15], v78 offset:8704
  ds_read_b128 v[56:59], v75 offset:33792
  v_mov_b64 v[16:17], 0
  v_mov_b64 v[18:19], 0
  v_mov_b64 v[20:21], 0
  v_mov_b64 v[22:23], 0
  v_mov_b64 v[24:25], 0
  v_mov_b64 v[26:27], 0
  s_branch Cs0_mxok
Cs0_kv3:
  s_waitcnt lgkmcnt(0)
  s_cmp_ge_u32 s57, 0x700
  s_cbranch_scc1 Cs0_kvb
  s_load_dword s57, s[12:13], s71 glc
  s_add_u32 s67, s67, 1
  s_cmp_lt_u32 s67, 131072
  s_cbranch_scc1 Cs0_kv3
  s_waitcnt lgkmcnt(0)
  s_branch Cs0_kvb
Cs0_last:
  ds_read_b128 v[4:7], v76 offset:5632
  ds_read_b128 v[12:15], v76 offset:7680
  ds_read_b128 v[44:47], v76 offset:32768
  ds_read_b128 v[48:51], v76 offset:33792
  s_nop 5
  v_mov_b64 v[20:21], 0
  v_mov_b64 v[22:23], 0
  v_mov_b64 v[24:25], 0
  v_mov_b64 v[26:27], 0
  v_smfmac_f32_16x16x64_bf16 v[28:31], v[0:3], v[36:43], v74
  ds_read_b128 v[36:39], v76 offset:34816
  ds_read_b128 v[40:43], v76 offset:35840
  v_smfmac_f32_16x16x64_bf16 v[32:35], v[0:3], v[60:67], v74
  s_waitcnt lgkmcnt(5)
  v_smfmac_f32_16x16x64_bf16 v[20:23], v[0:3], a[32:39], v74
  ds_read_b128 v[60:63], v76 offset:49152
  ds_read_b128 v[64:67], v76 offset:50176
  v_smfmac_f32_16x16x64_bf16 v[24:27], v[0:3], a[40:47], v74
  s_waitcnt lgkmcnt(4)
  v_smfmac_f32_16x16x64_bf16 v[20:23], v[4:7], a[48:55], v74
  buffer_store_dwordx4 v[16:19], v76, s[8:11], s68 offen sc1
  v_smfmac_f32_16x16x64_bf16 v[24:27], v[4:7], a[56:63], v74
  v_smfmac_f32_16x16x64_bf16 v[28:31], v[4:7], v[44:51], v74
  s_waitcnt lgkmcnt(2)
  v_smfmac_f32_16x16x64_bf16 v[20:23], v[8:11], a[64:71], v74
  ds_read_b128 v[44:47], v76 offset:51200
  ds_read_b128 v[48:51], v76 offset:52224
  v_smfmac_f32_16x16x64_bf16 v[24:27], v[8:11], a[72:79], v74
  v_smfmac_f32_16x16x64_bf16 v[32:35], v[4:7], v[36:43], v74
  v_smfmac_f32_16x16x64_bf16 v[28:31], v[8:11], v[208:215], v74
  ds_read_b128 v[36:39], v75 offset:16384
  ds_read_b128 v[40:43], v75 offset:17408
  v_smfmac_f32_16x16x64_bf16 v[32:35], v[8:11], v[216:223], v74
  v_smfmac_f32_16x16x64_bf16 v[20:23], v[12:15], a[80:87], v74
  v_smfmac_f32_16x16x64_bf16 v[24:27], v[12:15], a[88:95], v74
  v_smfmac_f32_16x16x64_bf16 v[28:31], v[12:15], v[224:231], v74
  v_smfmac_f32_16x16x64_bf16 v[32:35], v[12:15], v[232:239], v74
  s_waitcnt vmcnt(1)
  s_barrier
Cs0_lastr:
  ds_read_b128 v[0:3], v76 offset:8704
  ds_read_b128 v[8:11], v76 offset:9728
  ds_read_b128 v[16:19], v76 offset:10752
  ds_read_b128 v[4:7], v76 offset:11776
  ds_read_b128 v[12:15], v76 offset:12800
  s_waitcnt lgkmcnt(4)
  v_max3_u32 v72, v0, v1, v2
  s_waitcnt lgkmcnt(1)
  v_max3_u32 v72, v72, v3, v4
  v_max3_u32 v72, v72, v5, v6
  v_max3_u32 v72, v72, v7, v8
  v_max3_u32 v72, v72, v9, v10
  s_waitcnt lgkmcnt(0)
  v_max3_u32 v72, v72, v11, v12
  v_max3_u32 v72, v72, v13, v14
  v_max3_u32 v72, v72, v15, v16
  v_max3_u32 v72, v72, v17, v18
  v_max_u32 v72, v72, v19
  v_cmp_eq_u32 vcc, -1, v72
  s_cbranch_vccnz Cs0_lastp
Cs0_lastg:
  v_smfmac_f32_16x16x64_bf16 v[28:31], v[0:3], v[60:67], v74
  ds_read_b128 v[60:63], v75 offset:18432
  ds_read_b128 v[64:67], v75 offset:19456
  v_smfmac_f32_16x16x64_bf16 v[32:35], v[0:3], v[44:51], v74
  v_smfmac_f32_16x16x64_bf16 v[28:31], v[8:11], v[36:43], v74
  v_smfmac_f32_16x16x64_bf16 v[28:31], v[16:19], v[240:247], v74
  v_smfmac_f32_16x16x64_bf16 v[28:31], v[4:7], a[0:7], v74
  v_smfmac_f32_16x16x64_bf16 v[28:31], v[12:15], a[16:23], v74
  v_smfmac_f32_16x16x64_bf16 v[32:35], v[16:19], v[248:255], v74
  v_smfmac_f32_16x16x64_bf16 v[32:35], v[4:7], a[8:15], v74
  s_waitcnt lgkmcnt(0)
  v_smfmac_f32_16x16x64_bf16 v[32:35], v[12:15], a[24:31], v74
  v_smfmac_f32_16x16x64_bf16 v[32:35], v[8:11], v[60:67], v74
  v_smfmac_f32_16x16x64_bf16 v[20:23], v[0:3], a[96:103], v74
  v_smfmac_f32_16x16x64_bf16 v[20:23], v[8:11], a[112:119], v74
  v_add_f32 v28, v28, v30
  v_add_f32 v32, v32, v34
  v_cvt_pk_bf16_f32 v30, v28, v32
  v_smfmac_f32_16x16x64_bf16 v[20:23], v[16:19], a[128:135], v74
  ds_write_b32 v79, v30 offset:256
  v_add_f32 v29, v29, v31
  v_add_f32 v33, v33, v35
  v_cvt_pk_bf16_f32 v31, v29, v33
  v_smfmac_f32_16x16x64_bf16 v[20:23], v[4:7], a[144:151], v74
  ds_write_b32 v79, v31 offset:832
  v_smfmac_f32_16x16x64_bf16 v[20:23], v[12:15], a[160:167], v74
  v_smfmac_f32_16x16x64_bf16 v[24:27], v[0:3], a[104:111], v74
  v_smfmac_f32_16x16x64_bf16 v[24:27], v[8:11], a[120:127], v74
  v_smfmac_f32_16x16x64_bf16 v[24:27], v[16:19], a[136:143], v74
  s_waitcnt lgkmcnt(0)
  s_barrier
  ds_read_b64 v[52:53], v77 offset:256
  v_add_f32 v20, v20, v22
  v_smfmac_f32_16x16x64_bf16 v[24:27], v[4:7], a[152:159], v74
  v_add_f32 v21, v21, v23
  v_smfmac_f32_16x16x64_bf16 v[24:27], v[12:15], a[168:175], v74
  v_cvt_pk_bf16_f32 v54, v20, v21
  s_add_u32 s68, s68, 655360
  s_nop 3
  v_add_f32 v24, v24, v26
  v_add_f32 v25, v25, v27
  v_cvt_pk_bf16_f32 v55, v24, v25
  s_waitcnt lgkmcnt(0)
  buffer_store_dwordx4 v[52:55], v76, s[8:11], s68 offen sc1
  s_branch Cs0_done
Cs0_lastp:
  s_add_u32 s72, s72, 2
  s_cmp_ge_u32 s72, 131072
  s_cbranch_scc1 Cs0_lastg
  s_barrier
  buffer_load_dwordx4 v76, s[8:11], s85 offen offset:0 sc1 lds
  s_waitcnt vmcnt(0)
  s_barrier
  s_branch Cs0_lastr
Cs0_done:
  s_branch L_cexit
L_w5:
  v_mov_b64 v[20:21], 0
  v_mov_b64 v[22:23], 0
  v_mov_b64 v[24:25], 0
  v_mov_b64 v[26:27], 0
  v_mov_b64 v[28:29], 0
  v_mov_b64 v[30:31], 0
  v_mov_b64 v[32:33], 0
  v_mov_b64 v[34:35], 0
  s_mov_b32 s78, 0x3f803f80
  s_mov_b32 s79, s78
  s_mov_b32 s65, 360448
  s_mov_b32 m0, 15872
  s_lshl_b32 s71, s53, 2
  s_add_u32 s71, s71, 128
  s_movk_i32 s56, 0x1000
  v_lshlrev_b32 v73, 2, v76
  v_mov_b32 v72, 0
  s_mov_b64 s[16:17], s[8:9]
  s_mov_b32 s18, 268435456
  s_mov_b32 s19, 0x20000
  s_getpc_b64 s[20:21]
Cs1_pc:
  s_add_u32 s20, s20, (Cs1_last - Cs1_pc)
  s_addc_u32 s21, s21, 0
  v_mov_b32 v68, 14880
  buffer_load_dwordx4 v[52:55], v76, s[8:11], s59 offen offset:0 sc1
  buffer_load_dwordx4 v[56:59], v76, s[8:11], s59 offen offset:1024 sc1
  ds_read_b128 v[36:39], v76 offset:20480
  ds_read_b128 v[40:43], v76 offset:21504
  ds_read_b128 v[60:63], v76 offset:22528
  ds_read_b128 v[64:67], v76 offset:23552
  ds_read_b128 v[0:3], v76 offset:4608
  ds_read_b128 v[4:7], v76 offset:5632
  ds_read_b128 v[8:11], v76 offset:6656
  ds_read_b128 v[12:15], v76 offset:7680
  s_waitcnt lgkmcnt(0)
  s_cmp_eq_u32 s66, 1
  s_branch Cs1_top2
.p2align 6
Cs1_h2:
  ds_read_b128 v[36:39], v76 offset:20480
  ds_read_b128 v[40:43], v76 offset:21504
  v_lshlrev_b32 v73, 2, v76
  ds_read_b128 v[60:63], v76 offset:22528
  s_cmp_eq_u32 s66, 62
  s_cselect_b64 s[16:17], s[20:21], s[16:17]
  s_cselect_b32 s18, (Cs1_done - Cs1_last), s18
  s_cselect_b32 s70, 0, s70
  s_cmp_eq_u32 s66, 63
  s_cselect_b32 s59, 268435456, s59
  s_cselect_b32 s58, 268435456, s58
  buffer_load_dwordx4 v[52:55], v76, s[8:11], s59 offen offset:0 sc1
  buffer_load_dwordx4 v[56:59], v76, s[8:11], s59 offen offset:1024 sc1
  s_waitcnt vmcnt(0)
  s_mov_b64 vcc, -1
Cs1_h2r:
  s_mov_b64 exec, vcc
  buffer_load_dwordx4 v[8:11], v76, s[8:11], s65 offen offset:2048 sc1
  buffer_load_dwordx4 v[0:3], v76, s[8:11], s85 offen offset:0 sc1
  s_mov_b64 exec, -1
  s_add_u32 s67, s67, 1
  s_cmp_lt_u32 s67, 131072
  s_cselect_b32 s54, -2, -1
  s_waitcnt vmcnt(1)
  v_max3_u32 v72, v8, v9, v10
  s_waitcnt vmcnt(0)
  v_max3_u32 v72, v72, v11, v0
  v_max3_u32 v72, v72, v1, v2
  v_max_u32 v72, v72, v3
  v_cmp_lt_u32 vcc, s54, v72
  s_cbranch_vccnz Cs1_h2r
  ds_write_b128 v76, v[8:11] offset:6656
  ds_write_b128 v76, v[0:3] offset:11776
Cs1_h2w:
  s_cmp_eq_u32 s66, 63
  s_waitcnt lgkmcnt(0)
  s_barrier
  ds_read_b128 v[0:3], v76 offset:4608
Cs1_top2:
  v_smfmac_f32_16x16x64_bf16 v[20:23], v[8:11], v[112:119], v74
  s_cbranch_scc1 Cs1_last
  v_smfmac_f32_16x16x64_bf16 v[24:27], v[8:11], v[120:127], v74
  buffer_load_dwordx4 v[44:47], v76, s[8:11], s58 offen offset:0 sc1
  s_mov_b32 m0, 15872
  v_smfmac_f32_16x16x64_bf16 v[28:31], v[8:11], v[208:215], v74
  buffer_load_dwordx4 v[48:51], v76, s[8:11], s58 offen offset:1024 sc1
  v_smfmac_f32_16x16x64_bf16 v[32:35], v[8:11], v[216:223], v74
  ds_read_b128 v[4:7], v76 offset:5632
  s_waitcnt lgkmcnt(1)
  v_smfmac_f32_16x16x64_bf16 v[20:23], v[0:3], v[80:87], v74
  ds_read_b128 v[12:15], v76 offset:7680
  v_smfmac_f32_16x16x64_bf16 v[28:31], v[0:3], v[36:43], v74
  ds_read_b128 v[36:39], v76 offset:36864
  v_smfmac_f32_16x16x64_bf16 v[24:27], v[0:3], v[88:95], v74
  buffer_store_dwordx4 v[16:19], v76, s[8:11], s68 offen sc1
  ds_read_b128 v[40:43], v76 offset:37888
  v_smfmac_f32_16x16x64_bf16 v[32:35], v[0:3], v[60:67], v74
  buffer_load_dword v73, s[16:19], s70 offen lds
  ds_read_b128 v[60:63], v76 offset:38912
  s_waitcnt lgkmcnt(4)
  v_smfmac_f32_16x16x64_bf16 v[20:23], v[4:7], v[96:103], v74
  ds_read_b128 v[64:67], v76 offset:39936
  v_smfmac_f32_16x16x64_bf16 v[24:27], v[4:7], v[104:111], v74
  s_waitcnt vmcnt(4)
  s_waitcnt lgkmcnt(4)
  v_smfmac_f32_16x16x64_bf16 v[20:23], v[12:15], v[128:135], v74
  s_barrier
  ds_read_b128 v[8:11], v76 offset:8704
  s_waitcnt lgkmcnt(3)
  v_smfmac_f32_16x16x64_bf16 v[28:31], v[4:7], v[36:43], v74
  ds_read_b128 v[36:39], v76 offset:53248
  v_smfmac_f32_16x16x64_bf16 v[24:27], v[12:15], v[136:143], v74
  ds_read_b128 v[40:43], v76 offset:54272
  s_waitcnt lgkmcnt(3)
  v_smfmac_f32_16x16x64_bf16 v[32:35], v[4:7], v[60:67], v74
  ds_read_b128 v[0:3], v76 offset:9728
  v_smfmac_f32_16x16x64_bf16 v[28:31], v[12:15], v[224:231], v74
  ds_read_b128 v[60:63], v76 offset:55296
  v_smfmac_f32_16x16x64_bf16 v[32:35], v[12:15], v[232:239], v74
  ds_read_b128 v[64:67], v76 offset:56320
  s_waitcnt lgkmcnt(5)
  v_smfmac_f32_16x16x64_bf16 v[20:23], v[8:11], v[144:151], v74
  s_barrier
  ds_read_b128 v[4:7], v76 offset:11776
  s_waitcnt lgkmcnt(4)
  v_smfmac_f32_16x16x64_bf16 v[28:31], v[8:11], v[36:43], v74
  ds_read_b128 v[12:15], v76 offset:12800
  ds_read_b128 v[36:39], v75 offset:4096
  v_smfmac_f32_16x16x64_bf16 v[24:27], v[8:11], v[152:159], v74
  ds_read_b128 v[16:19], v76 offset:10752
  s_waitcnt lgkmcnt(6)
  v_smfmac_f32_16x16x64_bf16 v[20:23], v[0:3], v[160:167], v74
  ds_read_b128 v[40:43], v75 offset:5120
  s_waitcnt lgkmcnt(5)
  v_smfmac_f32_16x16x64_bf16 v[32:35], v[8:11], v[60:67], v74
  ds_read_b128 v[60:63], v75 offset:6144
  v_smfmac_f32_16x16x64_bf16 v[24:27], v[0:3], v[168:175], v74
  ds_read_b128 v[64:67], v75 offset:7168
  s_waitcnt lgkmcnt(6)
  v_smfmac_f32_16x16x64_bf16 v[20:23], v[4:7], v[176:183], v74
  s_waitcnt lgkmcnt(5)
  v_smfmac_f32_16x16x64_bf16 v[20:23], v[12:15], v[192:199], v74
  s_waitcnt lgkmcnt(2)
  v_smfmac_f32_16x16x64_bf16 v[20:23], v[16:19], v[36:43], v74
  ds_read_b128 v[36:39], v75 offset:20480
  v_smfmac_f32_16x16x64_bf16 v[24:27], v[4:7], v[184:191], v74
  ds_read_b128 v[40:43], v75 offset:21504
  s_waitcnt lgkmcnt(2)
  v_smfmac_f32_16x16x64_bf16 v[24:27], v[16:19], v[60:67], v74
  ds_read_b128 v[60:63], v75 offset:22528
  v_add_f32 v20, v20, v22
  v_smfmac_f32_16x16x64_bf16 v[24:27], v[12:15], v[200:207], v74
  ds_read_b128 v[64:67], v75 offset:23552
  v_add_f32 v21, v21, v23
  v_smfmac_f32_16x16x64_bf16 v[28:31], v[16:19], v[240:247], v74
  v_mov_b64 v[70:71], s[78:79]
  v_smfmac_f32_16x16x64_bf16 v[28:31], v[4:7], a[0:7], v74
  s_waitcnt lgkmcnt(2)
  v_add_f32 v24, v24, v26
  v_smfmac_f32_16x16x64_bf16 v[28:31], v[0:3], v[36:43], v74
  ds_read_b128 v[36:39], v68
  v_cvt_pk_bf16_f32 v22, v20, v24
  v_smfmac_f32_16x16x64_bf16 v[28:31], v[12:15], a[16:23], v74
  ds_read_b128 v[40:43], v68
  ds_write_b32 v79, v22 offset:0
  s_waitcnt lgkmcnt(3)
  v_add_f32 v25, v25, v27
  v_cvt_pk_bf16_f32 v23, v21, v25
  v_smfmac_f32_16x16x64_bf16 v[32:35], v[0:3], v[60:67], v74
  ds_write_b32 v79, v23 offset:576
  v_cmp_u_f32 vcc, v20, v21
  v_smfmac_f32_16x16x64_bf16 v[32:35], v[16:19], v[248:255], v74
  v_add_f32 v28, v28, v30
  v_smfmac_f32_16x16x64_bf16 v[32:35], v[4:7], a[8:15], v74
  v_add_f32 v29, v29, v31
  v_smfmac_f32_16x16x64_bf16 v[32:35], v[12:15], a[24:31], v74
  s_cbranch_vccnz Cs1_rec
Cs1_recok:
  s_waitcnt lgkmcnt(3)
  v_smfmac_f32_16x16x64_bf16 v[36:39], v[16:19], a[128:135], v74
  s_waitcnt lgkmcnt(0)
  s_barrier
  ds_read_b128 v[60:63], v77
  v_smfmac_f32_16x16x64_bf16 v[40:43], v[16:19], a[136:143], v74
  ds_read_b128 v[64:67], v77 offset:128
  v_add_f32 v32, v32, v34
  v_cvt_pk_bf16_f32 v30, v28, v32
  v_smfmac_f32_16x16x64_bf16 v[36:39], v[0:3], a[112:119], v74
  ds_write_b32 v79, v30 offset:256
  v_add_f32 v33, v33, v35
  v_cvt_pk_bf16_f32 v31, v29, v33
  v_smfmac_f32_16x16x64_bf16 v[40:43], v[0:3], a[120:127], v74
  ds_write_b32 v79, v31 offset:832
  v_xor_b32 v75, 0x8000, v75
  v_smfmac_f32_16x16x64_bf16 v[36:39], v[4:7], a[144:151], v74
  ds_read_b128 v[0:3], v76 offset:4608
  v_mov_b32 v29, 0
  v_smfmac_f32_16x16x64_bf16 v[40:43], v[4:7], a[152:159], v74
  s_waitcnt vmcnt(2) lgkmcnt(3)
  v_mov_b32 v30, 0
  v_mfma_f32_16x16x32_bf16 v[44:47], v[44:47], v[60:63], 0
  ds_read_b128 v[4:7], v76 offset:5632
  s_waitcnt lgkmcnt(2)
  v_mfma_f32_16x16x32_bf16 v[44:47], v[48:51], v[64:67], v[44:47]
  s_barrier
  v_smfmac_f32_16x16x64_bf16 v[36:39], v[8:11], a[96:103], v74
  ds_read_b128 v[20:23], v77 offset:256
  ds_read_b128 v[24:27], v77 offset:384
  v_smfmac_f32_16x16x64_bf16 v[40:43], v[8:11], a[104:111], v74
  ds_read_b128 v[8:11], v76 offset:6656
  v_add_f32_dpp v72, v46, v44 quad_perm:[2,3,0,1] row_mask:0xf bank_mask:0xf
  v_add_f32_dpp v73, v47, v45 quad_perm:[2,3,0,1] row_mask:0xf bank_mask:0xf
  v_smfmac_f32_16x16x64_bf16 v[36:39], v[12:15], a[160:167], v74
  s_waitcnt lgkmcnt(4)
  v_exp_f32_dpp v72, v72 quad_perm:[0,1,0,1] row_mask:0xf bank_mask:0xf
  v_smfmac_f32_16x16x64_bf16 v[40:43], v[12:15], a[168:175], v74
  ds_read_b128 v[12:15], v76 offset:7680
  v_exp_f32_dpp v73, v73 quad_perm:[0,1,0,1] row_mask:0xf bank_mask:0xf
  v_smfmac_f32_16x16x64_bf16 v[36:39], v[0:3], a[32:39], v74
  s_waitcnt lgkmcnt(2)
  v_cvt_pk_bf16_f32 v72, v72, v73
  v_mfma_f32_16x16x32_bf16 v[20:23], v[20:23], v[60:63], 0
  ds_write_b32 v78, v72 offset:516
  v_mov_b64 v[16:17], 0
  v_mfma_f32_16x16x32_bf16 v[20:23], v[24:27], v[64:67], v[20:23]
  ds_read_b128 v[44:47], v75 offset:22528
  v_mov_b64 v[18:19], 0
  v_smfmac_f32_16x16x64_bf16 v[40:43], v[0:3], a[40:47], v74
  ds_read_b128 v[48:51], v75 offset:23552
  v_mov_b64 v[68:69], s[78:79]
  v_smfmac_f32_16x16x64_bf16 v[36:39], v[4:7], a[48:55], v74
  s_waitcnt lgkmcnt(4)
  v_add_f32_dpp v24, v22, v20 quad_perm:[2,3,0,1] row_mask:0xf bank_mask:0xf
  v_add_f32_dpp v25, v23, v21 quad_perm:[2,3,0,1] row_mask:0xf bank_mask:0xf
  v_smfmac_f32_16x16x64_bf16 v[36:39], v[8:11], a[64:71], v74
  s_waitcnt lgkmcnt(2)
  s_barrier
  ds_read_b128 v[32:35], v78 offset:512
  v_smfmac_f32_16x16x64_bf16 v[36:39], v[12:15], a[80:87], v74
  ds_read_b128 v[60:63], v75 offset:20480
  v_mul_f32 v24, s69, v24
  v_smfmac_f32_16x16x64_bf16 v[40:43], v[4:7], a[56:63], v74
  ds_read_b128 v[64:67], v75 offset:21504
  v_mul_f32 v25, s69, v25
  v_smfmac_f32_16x16x64_bf16 v[40:43], v[8:11], a[72:79], v74
  v_exp_f32_dpp v24, v24 quad_perm:[0,1,0,1] row_mask:0xf bank_mask:0xf
  v_smfmac_f32_16x16x64_bf16 v[40:43], v[12:15], a[88:95], v74
  s_waitcnt lgkmcnt(2)
  v_exp_f32_dpp v25, v25 quad_perm:[0,1,0,1] row_mask:0xf bank_mask:0xf
  v_mfma_f32_16x16x32_bf16 v[8:11], v[32:35], v[68:71], 0
  v_add_f32 v36, v36, v38
  v_add_f32 v37, v37, v39
  v_mfma_f32_16x16x32_bf16 v[0:3], v[32:35], v[52:55], 0
  v_add_f32 v40, v40, v42
  v_add_f32 v41, v41, v43
  v_mfma_f32_16x16x32_bf16 v[4:7], v[32:35], v[56:59], 0
  v_cvt_pk_bf16_f32 v28, v24, v25
  v_cvt_pk_bf16_f32 v72, v36, v37
  v_cvt_pk_bf16_f32 v73, v40, v41
  v_mfma_f32_16x16x16_bf16 v[8:11], v[28:29], v[68:69], v[8:11]
  v_cvt_pk_bf16_f32 v31, v24, v25
  v_mov_b64 v[20:21], 0
  v_mfma_f32_16x16x16_bf16 v[0:3], v[28:29], v[72:73], v[0:3]
  ds_read_b128 v[52:55], v75 offset:36864
  v_mov_b64 v[22:23], 0
  v_mfma_f32_16x16x16_bf16 v[4:7], v[30:31], v[72:73], v[4:7]
  v_rcp_f32 v10, v8
  v_rcp_f32 v11, v9
  v_mul_f32 v0, v10, v0
  v_mul_f32 v1, v11, v1
  v_max3_f32 v8, v8, v9, v10
  v_mul_f32 v4, v10, v4
  v_mul_f32 v5, v11, v5
  v_cvt_pk_bf16_f32 v2, v0, v4
  ds_write_b32 v79, v2 offset:8704
  v_cvt_pk_bf16_f32 v3, v1, v5
  ds_write_b32 v79, v3 offset:9280
  ds_read_b128 v[12:15], v78 offset:8768
  v_max_f32 v8, v8, v11
  v_cmp_le_f32 vcc, 1317011456, v8
  v_mov_b64 v[24:25], 0
  v_mov_b64 v[26:27], 0
  ds_read_b128 v[56:59], v75 offset:37888
  s_cbranch_vccnz Cs1_mx
Cs1_mxok:
  s_waitcnt lgkmcnt(2)
  s_barrier
  ds_read_b128 v[0:3], v78 offset:8704
  s_waitcnt lgkmcnt(2)
  v_smfmac_f32_16x16x64_bf16 v[16:19], v[12:15], v[44:51], v74
  ds_read_b128 v[4:7], v78 offset:8832
  v_smfmac_f32_16x16x64_bf16 v[20:23], v[12:15], a[200:207], v74
  ds_read_b128 v[8:11], v78 offset:8896
  v_smfmac_f32_16x16x64_bf16 v[24:27], v[12:15], a[216:223], v74
  ds_read_b128 v[36:39], v75 offset:38912
  s_waitcnt lgkmcnt(3)
  v_smfmac_f32_16x16x64_bf16 v[16:19], v[0:3], v[60:67], v74
  ds_read_b128 v[40:43], v75 offset:39936
  s_waitcnt lgkmcnt(3)
  v_smfmac_f32_16x16x64_bf16 v[16:19], v[4:7], a[176:183], v74
  ds_read_b128 v[68:71], v76 offset:13824
  s_waitcnt lgkmcnt(3)
  v_smfmac_f32_16x16x64_bf16 v[16:19], v[8:11], a[184:191], v74
  ds_read_b128 v[44:47], v75 offset:53248
  v_smfmac_f32_16x16x64_bf16 v[20:23], v[0:3], a[192:199], v74
  ds_read_b128 v[48:51], v75 offset:54272
  v_smfmac_f32_16x16x64_bf16 v[20:23], v[4:7], v[52:59], v74
  ds_read_b128 v[60:63], v75 offset:55296
  s_waitcnt lgkmcnt(4)
  v_cvt_pk_bf16_f32 v16, v16, v17
  v_cvt_pk_bf16_f32 v17, v18, v19
  v_bfi_b32 v16, 1, s72, v16
  v_smfmac_f32_16x16x64_bf16 v[20:23], v[8:11], v[36:43], v74
  s_waitcnt lgkmcnt(3)
  buffer_store_dwordx2 v[16:17], v68, s[8:11], s73 offen sc1
  v_mov_b64 v[32:33], 0
  v_smfmac_f32_16x16x64_bf16 v[24:27], v[0:3], a[208:215], v74
  ds_read_b128 v[64:67], v75 offset:56320
  v_mov_b64 v[34:35], 0
  v_smfmac_f32_16x16x64_bf16 v[24:27], v[4:7], a[224:231], v74
  v_cvt_pk_bf16_f32 v20, v20, v21
  v_cvt_pk_bf16_f32 v21, v22, v23
  v_bfi_b32 v20, 1, s72, v20
  v_smfmac_f32_16x16x64_bf16 v[24:27], v[8:11], a[232:239], v74
  buffer_store_dwordx2 v[20:21], v68, s[8:11], s74 offen sc1
  s_waitcnt lgkmcnt(2)
  v_smfmac_f32_16x16x64_bf16 v[32:35], v[0:3], v[44:51], v74
  s_waitcnt lgkmcnt(0)
  v_smfmac_f32_16x16x64_bf16 v[32:35], v[12:15], v[60:67], v74
  v_cvt_pk_bf16_f32 v24, v24, v25
  v_cvt_pk_bf16_f32 v25, v26, v27
  v_bfi_b32 v24, 1, s72, v24
  v_smfmac_f32_16x16x64_bf16 v[32:35], v[4:7], a[240:247], v74
  buffer_store_dwordx2 v[24:25], v68, s[8:11], s75 offen sc1
  v_smfmac_f32_16x16x64_bf16 v[32:35], v[8:11], a[248:255], v74
  v_mov_b64 v[18:19], v[72:73]
  s_nop 4
  v_cvt_pk_bf16_f32 v32, v32, v33
  v_cvt_pk_bf16_f32 v33, v34, v35
  v_bfi_b32 v32, 1, s72, v32
  buffer_store_dwordx2 v[32:33], v68, s[8:11], s76 offen sc1
  ds_read_b128 v[0:3], v76 offset:14848
  s_waitcnt lgkmcnt(0)
  ds_read_b64 v[16:17], v77 offset:264
  s_waitcnt lgkmcnt(0)
  ds_read_b128 v[64:67], v76 offset:23552
  s_waitcnt lgkmcnt(0)
  s_add_u32 s66, s66, 1
  s_xor_b32 s64, s64, 16384
  s_xor_b32 s65, s65, 16384
  s_add_u32 s58, s58, 655360
  s_add_u32 s59, s59, 655360
  s_add_u32 s70, s70, 655360
  s_add_u32 s68, s68, 655360
  s_mov_b32 m0, 11776
  s_add_u32 s85, s65, 7168
  v_xor_b32 v75, 0x8000, v75
  v_mov_b64 v[28:29], 0
  v_mov_b64 v[30:31], 0
  v_mov_b64 v[32:33], 0
  v_mov_b64 v[34:35], 0
  v_mov_b64 v[20:21], 0
  v_mov_b64 v[22:23], 0
  v_mov_b64 v[24:25], 0
  v_mov_b64 v[26:27], 0
  v_mov_b32 v68, 14880
  s_waitcnt vmcnt(0)
  buffer_load_dwordx4 v[52:55], v76, s[8:11], s60 offen offset:0 sc1
  buffer_load_dwordx4 v[56:59], v76, s[8:11], s60 offen offset:1024 sc1
  s_waitcnt lgkmcnt(0)
  s_waitcnt vmcnt(1)
  v_mfma_f32_16x16x32_bf16 v[4:7], v[0:3], v[52:55], 0
  v_bitop3_b32 v72, v52, v54, s72 bitop3:0x7e
  s_waitcnt vmcnt(0)
  v_mfma_f32_16x16x32_bf16 v[4:7], v[0:3], v[56:59], v[4:7]
  v_bitop3_b32 v73, v56, v58, s72 bitop3:0x7e
  v_bitop3_b32 v72, v72, v73, 1 bitop3:0xa8
  v_cmp_ne_u32 vcc, 0, v72
  s_cbranch_vccnz Cs1_h1r
  s_nop 2
  v_add_f32_dpp v4, v4, v4 row_ror:4 row_mask:0xf bank_mask:0xf
  v_add_f32_dpp v5, v5, v5 row_ror:4 row_mask:0xf bank_mask:0xf
  s_nop 0
  v_add_f32_dpp v4, v4, v4 row_ror:8 row_mask:0xf bank_mask:0xf
  v_add_f32_dpp v5, v5, v5 row_ror:8 row_mask:0xf bank_mask:0xf
  v_cvt_pk_bf16_f32 v4, v4, v5
  buffer_store_dword v4, v69, s[8:11], s62 offen sc1
  s_xor_b32 s62, s62, 16384
  buffer_store_dword v71, v69, s[8:11], s62 offen sc1
  s_xor_b32 s72, s72, 1
  s_branch Cs1_h2
Cs1_h1r:
  s_mov_b64 exec, vcc
  buffer_load_dwordx4 v[52:55], v76, s[8:11], s60 offen offset:0 sc1
  buffer_load_dwordx4 v[56:59], v76, s[8:11], s60 offen offset:1024 sc1
  s_mov_b64 exec, -1
  s_add_u32 s67, s67, 1
  s_waitcnt vmcnt(1)
  v_mfma_f32_16x16x32_bf16 v[4:7], v[0:3], v[52:55], 0
  v_bitop3_b32 v72, v52, v54, s72 bitop3:0x7e
  s_waitcnt vmcnt(0)
  v_mfma_f32_16x16x32_bf16 v[4:7], v[0:3], v[56:59], v[4:7]
  v_bitop3_b32 v73, v56, v58, s72 bitop3:0x7e
  v_bitop3_b32 v72, v72, v73, 1 bitop3:0xa8
  v_cmp_ne_u32 vcc, 0, v72
  s_cbranch_vccz Cs1_h1p
Cs1_h1s:
  s_mov_b64 exec, vcc
  buffer_load_dwordx4 v[52:55], v76, s[8:11], s60 offen offset:0 sc1
  buffer_load_dwordx4 v[56:59], v76, s[8:11], s60 offen offset:1024 sc1
  s_mov_b64 exec, -1
  s_add_u32 s67, s67, 1
  s_waitcnt vmcnt(1)
  v_mfma_f32_16x16x32_bf16 v[4:7], v[0:3], v[52:55], 0
  v_bitop3_b32 v72, v52, v54, s72 bitop3:0x7e
  s_waitcnt vmcnt(0)
  v_mfma_f32_16x16x32_bf16 v[4:7], v[0:3], v[56:59], v[4:7]
  v_bitop3_b32 v73, v56, v58, s72 bitop3:0x7e
  v_bitop3_b32 v72, v72, v73, 1 bitop3:0xa8
  v_cmp_ne_u32 vcc, 0, v72
  s_cbranch_vccz Cs1_h1p
  s_cmp_lt_u32 s67, 131072
  s_cbranch_scc1 Cs1_h1s
Cs1_h1p:
  s_nop 2
  v_add_f32_dpp v4, v4, v4 row_ror:4 row_mask:0xf bank_mask:0xf
  v_add_f32_dpp v5, v5, v5 row_ror:4 row_mask:0xf bank_mask:0xf
  s_nop 0
  v_add_f32_dpp v4, v4, v4 row_ror:8 row_mask:0xf bank_mask:0xf
  v_add_f32_dpp v5, v5, v5 row_ror:8 row_mask:0xf bank_mask:0xf
  v_cvt_pk_bf16_f32 v4, v4, v5
  buffer_store_dword v4, v69, s[8:11], s62 offen sc1
  s_xor_b32 s62, s62, 16384
  buffer_store_dword v71, v69, s[8:11], s62 offen sc1
  s_xor_b32 s72, s72, 1
  s_branch Cs1_h2
Cs1_rec:
  s_nop 7
  s_waitcnt vmcnt(0) lgkmcnt(0)
  v_max3_u32 v72, v0, v1, v2
  v_max3_u32 v72, v72, v3, v4
  v_max3_u32 v72, v72, v5, v6
  v_max3_u32 v72, v72, v7, v8
  v_max3_u32 v72, v72, v9, v10
  v_max3_u32 v72, v72, v11, v12
  v_max3_u32 v72, v72, v13, v14
  v_max3_u32 v72, v72, v15, v16
  v_max3_u32 v72, v72, v17, v18
  v_max_u32 v72, v72, v19
  v_cmp_eq_u32 vcc, -1, v72
  s_cbranch_vccz Cs1_recok
  s_barrier
  v_mov_b64 v[20:21], 0
  v_mov_b64 v[22:23], 0
  v_mov_b64 v[24:25], 0
  v_mov_b64 v[26:27], 0
  v_mov_b64 v[28:29], 0
  v_mov_b64 v[30:31], 0
  v_mov_b64 v[32:33], 0
  v_mov_b64 v[34:35], 0
  s_waitcnt lgkmcnt(0)
  s_barrier
  ds_read_b128 v[0:3], v76 offset:4608
  s_waitcnt lgkmcnt(0)
  v_smfmac_f32_16x16x64_bf16 v[20:23], v[0:3], v[80:87], v74
  v_smfmac_f32_16x16x64_bf16 v[24:27], v[0:3], v[88:95], v74
  ds_read_b128 v[60:63], v76 offset:20480
  ds_read_b128 v[64:67], v76 offset:21504
  s_waitcnt lgkmcnt(0)
  v_smfmac_f32_16x16x64_bf16 v[28:31], v[0:3], v[60:67], v74
  ds_read_b128 v[60:63], v76 offset:22528
  ds_read_b128 v[64:67], v76 offset:23552
  s_waitcnt lgkmcnt(0)
  v_smfmac_f32_16x16x64_bf16 v[32:35], v[0:3], v[60:67], v74
  ds_read_b128 v[4:7], v76 offset:5632
  s_waitcnt lgkmcnt(0)
  v_smfmac_f32_16x16x64_bf16 v[20:23], v[4:7], v[96:103], v74
  v_smfmac_f32_16x16x64_bf16 v[24:27], v[4:7], v[104:111], v74
  ds_read_b128 v[60:63], v76 offset:36864
  ds_read_b128 v[64:67], v76 offset:37888
  s_waitcnt lgkmcnt(0)
  v_smfmac_f32_16x16x64_bf16 v[28:31], v[4:7], v[60:67], v74
  ds_read_b128 v[60:63], v76 offset:38912
  ds_read_b128 v[64:67], v76 offset:39936
  s_waitcnt lgkmcnt(0)
  v_smfmac_f32_16x16x64_bf16 v[32:35], v[4:7], v[60:67], v74
  ds_read_b128 v[8:11], v76 offset:6656
  s_waitcnt lgkmcnt(0)
  v_smfmac_f32_16x16x64_bf16 v[20:23], v[8:11], v[112:119], v74
  v_smfmac_f32_16x16x64_bf16 v[24:27], v[8:11], v[120:127], v74
  v_smfmac_f32_16x16x64_bf16 v[28:31], v[8:11], v[208:215], v74
  v_smfmac_f32_16x16x64_bf16 v[32:35], v[8:11], v[216:223], v74
  ds_read_b128 v[12:15], v76 offset:7680
  s_waitcnt lgkmcnt(0)
  v_smfmac_f32_16x16x64_bf16 v[20:23], v[12:15], v[128:135], v74
  v_smfmac_f32_16x16x64_bf16 v[24:27], v[12:15], v[136:143], v74
  v_smfmac_f32_16x16x64_bf16 v[28:31], v[12:15], v[224:231], v74
  v_smfmac_f32_16x16x64_bf16 v[32:35], v[12:15], v[232:239], v74
  ds_read_b128 v[8:11], v76 offset:8704
  s_waitcnt lgkmcnt(0)
  v_smfmac_f32_16x16x64_bf16 v[20:23], v[8:11], v[144:151], v74
  v_smfmac_f32_16x16x64_bf16 v[24:27], v[8:11], v[152:159], v74
  ds_read_b128 v[60:63], v76 offset:53248
  ds_read_b128 v[64:67], v76 offset:54272
  s_waitcnt lgkmcnt(0)
  v_smfmac_f32_16x16x64_bf16 v[28:31], v[8:11], v[60:67], v74
  ds_read_b128 v[60:63], v76 offset:55296
  ds_read_b128 v[64:67], v76 offset:56320
  s_waitcnt lgkmcnt(0)
  v_smfmac_f32_16x16x64_bf16 v[32:35], v[8:11], v[60:67], v74
  ds_read_b128 v[0:3], v76 offset:9728
  s_waitcnt lgkmcnt(0)
  v_smfmac_f32_16x16x64_bf16 v[20:23], v[0:3], v[160:167], v74
  v_smfmac_f32_16x16x64_bf16 v[24:27], v[0:3], v[168:175], v74
  ds_read_b128 v[60:63], v75 offset:20480
  ds_read_b128 v[64:67], v75 offset:21504
  s_waitcnt lgkmcnt(0)
  v_smfmac_f32_16x16x64_bf16 v[28:31], v[0:3], v[60:67], v74
  ds_read_b128 v[60:63], v75 offset:22528
  ds_read_b128 v[64:67], v75 offset:23552
  s_waitcnt lgkmcnt(0)
  v_smfmac_f32_16x16x64_bf16 v[32:35], v[0:3], v[60:67], v74
  ds_read_b128 v[16:19], v76 offset:10752
  ds_read_b128 v[60:63], v75 offset:4096
  ds_read_b128 v[64:67], v75 offset:5120
  s_waitcnt lgkmcnt(0)
  v_smfmac_f32_16x16x64_bf16 v[20:23], v[16:19], v[60:67], v74
  ds_read_b128 v[60:63], v75 offset:6144
  ds_read_b128 v[64:67], v75 offset:7168
  s_waitcnt lgkmcnt(0)
  v_smfmac_f32_16x16x64_bf16 v[24:27], v[16:19], v[60:67], v74
  v_smfmac_f32_16x16x64_bf16 v[28:31], v[16:19], v[240:247], v74
  v_smfmac_f32_16x16x64_bf16 v[32:35], v[16:19], v[248:255], v74
  ds_read_b128 v[4:7], v76 offset:11776
  s_waitcnt lgkmcnt(0)
  v_smfmac_f32_16x16x64_bf16 v[20:23], v[4:7], v[176:183], v74
  v_smfmac_f32_16x16x64_bf16 v[24:27], v[4:7], v[184:191], v74
  v_smfmac_f32_16x16x64_bf16 v[28:31], v[4:7], a[0:7], v74
  v_smfmac_f32_16x16x64_bf16 v[32:35], v[4:7], a[8:15], v74
  ds_read_b128 v[12:15], v76 offset:12800
  s_waitcnt lgkmcnt(0)
  v_smfmac_f32_16x16x64_bf16 v[20:23], v[12:15], v[192:199], v74
  v_smfmac_f32_16x16x64_bf16 v[24:27], v[12:15], v[200:207], v74
  v_smfmac_f32_16x16x64_bf16 v[28:31], v[12:15], a[16:23], v74
  v_smfmac_f32_16x16x64_bf16 v[32:35], v[12:15], a[24:31], v74
  v_add_f32 v20, v20, v22
  v_add_f32 v21, v21, v23
  v_add_f32 v24, v24, v26
  v_cvt_pk_bf16_f32 v22, v20, v24
  ds_write_b32 v79, v22 offset:0
  v_add_f32 v25, v25, v27
  v_cvt_pk_bf16_f32 v23, v21, v25
  ds_write_b32 v79, v23 offset:576
  v_add_f32 v28, v28, v30
  v_add_f32 v29, v29, v31
  s_waitcnt lgkmcnt(0)
  s_nop 1
  s_branch Cs1_recok
Cs1_mx:
  s_waitcnt lgkmcnt(0)
  s_barrier
  buffer_load_dwordx4 v[52:55], v76, s[8:11], s59 offen offset:0 sc1
  buffer_load_dwordx4 v[0:3], v76, s[8:11], s58 offen offset:0 sc1
  ds_read_b128 v[20:23], v77 offset:0
  ds_read_b128 v[28:31], v77 offset:256
  buffer_load_dwordx4 v[56:59], v76, s[8:11], s59 offen offset:1024 sc1
  buffer_load_dwordx4 v[4:7], v76, s[8:11], s58 offen offset:1024 sc1
  ds_read_b128 v[24:27], v77 offset:128
  ds_read_b128 v[32:35], v77 offset:384
  s_waitcnt vmcnt(2) lgkmcnt(3)
  v_mfma_f32_16x16x32_bf16 v[8:11], v[0:3], v[20:23], 0
  s_waitcnt vmcnt(0) lgkmcnt(1)
  v_mfma_f32_16x16x32_bf16 v[8:11], v[4:7], v[24:27], v[8:11]
  v_mfma_f32_16x16x32_bf16 v[12:15], v[28:31], v[20:23], 0
  s_waitcnt lgkmcnt(0)
  v_mfma_f32_16x16x32_bf16 v[12:15], v[32:35], v[24:27], v[12:15]
  v_add_f32_dpp v8, v10, v8 quad_perm:[2,3,0,1] row_mask:0xf bank_mask:0xf
  v_add_f32_dpp v9, v11, v9 quad_perm:[2,3,0,1] row_mask:0xf bank_mask:0xf
  s_nop 0
  v_mov_b32_dpp v8, v8 quad_perm:[0,1,0,1] row_mask:0xf bank_mask:0xf
  v_mov_b32_dpp v9, v9 quad_perm:[0,1,0,1] row_mask:0xf bank_mask:0xf
  s_nop 1
  v_add_f32_dpp v12, v14, v12 quad_perm:[2,3,0,1] row_mask:0xf bank_mask:0xf
  v_add_f32_dpp v13, v15, v13 quad_perm:[2,3,0,1] row_mask:0xf bank_mask:0xf
  s_nop 0
  v_mov_b32_dpp v12, v12 quad_perm:[0,1,0,1] row_mask:0xf bank_mask:0xf
  v_mov_b32_dpp v13, v13 quad_perm:[0,1,0,1] row_mask:0xf bank_mask:0xf
  v_mul_f32 v12, s69, v12
  ds_write_b32 v78, v8 offset:8708
  v_mul_f32 v13, s69, v13
  ds_write_b32 v78, v9 offset:8772
  s_waitcnt lgkmcnt(0)
  s_barrier
  ds_read_b128 v[36:39], v78 offset:8704
  ds_read_b128 v[40:43], v78 offset:8768
  s_waitcnt lgkmcnt(0)
  s_barrier
  v_max_f32 v16, v36, v37
  v_max3_f32 v16, v16, v38, v39
  v_max3_f32 v16, v16, v40, v41
  v_max3_f32 v16, v16, v42, v43
  v_max3_f32 v16, v16, v12, v13
  v_mov_b32 v17, v16
  s_nop 1
  v_permlane16_swap_b32 v16, v17
  v_max_f32 v16, v16, v17
  v_mov_b32 v17, v16
  s_nop 1
  v_permlane32_swap_b32 v16, v17
  v_max_f32 v16, v16, v17
  v_sub_f32 v36, v36, v16
  v_sub_f32 v37, v37, v16
  v_sub_f32 v38, v38, v16
  v_sub_f32 v39, v39, v16
  v_sub_f32 v40, v40, v16
  v_sub_f32 v41, v41, v16
  v_sub_f32 v42, v42, v16
  v_sub_f32 v43, v43, v16
  v_sub_f32 v12, v12, v16
  v_sub_f32 v13, v13, v16
  v_exp_f32 v36, v36
  v_exp_f32 v37, v37
  v_exp_f32 v38, v38
  v_exp_f32 v39, v39
  v_exp_f32 v40, v40
  v_exp_f32 v41, v41
  v_exp_f32 v42, v42
  v_exp_f32 v43, v43
  v_exp_f32 v12, v12
  v_exp_f32 v13, v13
  v_cvt_pk_bf16_f32 v32, v36, v40
  v_cvt_pk_bf16_f32 v33, v37, v41
  v_cvt_pk_bf16_f32 v34, v38, v42
  v_cvt_pk_bf16_f32 v35, v39, v43
  v_cvt_pk_bf16_f32 v28, v12, v13
  v_cvt_pk_bf16_f32 v31, v12, v13
  v_mov_b32 v29, 0
  v_mov_b32 v30, 0
  v_mfma_f32_16x16x32_bf16 v[8:11], v[32:35], v[68:71], 0
  v_mfma_f32_16x16x32_bf16 v[0:3], v[32:35], v[52:55], 0
  v_mfma_f32_16x16x32_bf16 v[4:7], v[32:35], v[56:59], 0
  v_mfma_f32_16x16x16_bf16 v[8:11], v[28:29], v[68:69], v[8:11]
  v_mfma_f32_16x16x16_bf16 v[0:3], v[28:29], v[72:73], v[0:3]
  v_mfma_f32_16x16x16_bf16 v[4:7], v[30:31], v[72:73], v[4:7]
  ds_read_b128 v[52:55], v75 offset:36864
  v_rcp_f32 v10, v8
  v_rcp_f32 v11, v9
  v_mul_f32 v0, v10, v0
  v_mul_f32 v1, v11, v1
  v_max3_f32 v8, v8, v9, v10
  v_mul_f32 v4, v10, v4
  v_mul_f32 v5, v11, v5
  v_cvt_pk_bf16_f32 v2, v0, v4
  ds_write_b32 v79, v2 offset:8704
  v_cvt_pk_bf16_f32 v3, v1, v5
  ds_write_b32 v79, v3 offset:9280
  ds_read_b128 v[12:15], v78 offset:8768
  ds_read_b128 v[56:59], v75 offset:37888
  v_mov_b64 v[16:17], 0
  v_mov_b64 v[18:19], 0
  v_mov_b64 v[20:21], 0
  v_mov_b64 v[22:23], 0
  v_mov_b64 v[24:25], 0
  v_mov_b64 v[26:27], 0
  s_branch Cs1_mxok
Cs1_last:
  ds_read_b128 v[4:7], v76 offset:5632
  ds_read_b128 v[12:15], v76 offset:7680
  ds_read_b128 v[44:47], v76 offset:36864
  ds_read_b128 v[48:51], v76 offset:37888
  s_nop 5
  v_mov_b64 v[20:21], 0
  v_mov_b64 v[22:23], 0
  v_mov_b64 v[24:25], 0
  v_mov_b64 v[26:27], 0
  s_waitcnt lgkmcnt(4)
  v_smfmac_f32_16x16x64_bf16 v[28:31], v[0:3], v[36:43], v74
  ds_read_b128 v[36:39], v76 offset:38912
  ds_read_b128 v[40:43], v76 offset:39936
  v_smfmac_f32_16x16x64_bf16 v[32:35], v[0:3], v[60:67], v74
  s_waitcnt lgkmcnt(5)
  v_smfmac_f32_16x16x64_bf16 v[20:23], v[0:3], a[32:39], v74
  ds_read_b128 v[60:63], v76 offset:53248
  ds_read_b128 v[64:67], v76 offset:54272
  v_smfmac_f32_16x16x64_bf16 v[24:27], v[0:3], a[40:47], v74
  s_waitcnt lgkmcnt(4)
  v_smfmac_f32_16x16x64_bf16 v[20:23], v[4:7], a[48:55], v74
  buffer_store_dwordx4 v[16:19], v76, s[8:11], s68 offen sc1
  v_smfmac_f32_16x16x64_bf16 v[24:27], v[4:7], a[56:63], v74
  v_smfmac_f32_16x16x64_bf16 v[28:31], v[4:7], v[44:51], v74
  s_waitcnt lgkmcnt(2)
  v_smfmac_f32_16x16x64_bf16 v[20:23], v[8:11], a[64:71], v74
  ds_read_b128 v[44:47], v76 offset:55296
  ds_read_b128 v[48:51], v76 offset:56320
  v_smfmac_f32_16x16x64_bf16 v[24:27], v[8:11], a[72:79], v74
  v_smfmac_f32_16x16x64_bf16 v[32:35], v[4:7], v[36:43], v74
  v_smfmac_f32_16x16x64_bf16 v[28:31], v[8:11], v[208:215], v74
  ds_read_b128 v[36:39], v75 offset:20480
  ds_read_b128 v[40:43], v75 offset:21504
  v_smfmac_f32_16x16x64_bf16 v[32:35], v[8:11], v[216:223], v74
  v_smfmac_f32_16x16x64_bf16 v[20:23], v[12:15], a[80:87], v74
  v_smfmac_f32_16x16x64_bf16 v[24:27], v[12:15], a[88:95], v74
  v_smfmac_f32_16x16x64_bf16 v[28:31], v[12:15], v[224:231], v74
  v_smfmac_f32_16x16x64_bf16 v[32:35], v[12:15], v[232:239], v74
  s_waitcnt vmcnt(1)
  s_barrier
Cs1_lastr:
  ds_read_b128 v[8:11], v76 offset:8704
  ds_read_b128 v[0:3], v76 offset:9728
  ds_read_b128 v[16:19], v76 offset:10752
  ds_read_b128 v[4:7], v76 offset:11776
  ds_read_b128 v[12:15], v76 offset:12800
  s_waitcnt lgkmcnt(3)
  v_max3_u32 v72, v0, v1, v2
  s_waitcnt lgkmcnt(1)
  v_max3_u32 v72, v72, v3, v4
  v_max3_u32 v72, v72, v5, v6
  v_max3_u32 v72, v72, v7, v8
  v_max3_u32 v72, v72, v9, v10
  s_waitcnt lgkmcnt(0)
  v_max3_u32 v72, v72, v11, v12
  v_max3_u32 v72, v72, v13, v14
  v_max3_u32 v72, v72, v15, v16
  v_max3_u32 v72, v72, v17, v18
  v_max_u32 v72, v72, v19
  v_cmp_eq_u32 vcc, -1, v72
  s_cbranch_vccnz Cs1_lastp
Cs1_lastg:
  v_smfmac_f32_16x16x64_bf16 v[28:31], v[8:11], v[60:67], v74
  ds_read_b128 v[60:63], v75 offset:22528
  ds_read_b128 v[64:67], v75 offset:23552
  v_smfmac_f32_16x16x64_bf16 v[32:35], v[8:11], v[44:51], v74
  v_smfmac_f32_16x16x64_bf16 v[28:31], v[0:3], v[36:43], v74
  v_smfmac_f32_16x16x64_bf16 v[28:31], v[16:19], v[240:247], v74
  v_smfmac_f32_16x16x64_bf16 v[28:31], v[4:7], a[0:7], v74
  v_smfmac_f32_16x16x64_bf16 v[28:31], v[12:15], a[16:23], v74
  v_smfmac_f32_16x16x64_bf16 v[32:35], v[16:19], v[248:255], v74
  v_smfmac_f32_16x16x64_bf16 v[32:35], v[4:7], a[8:15], v74
  s_waitcnt lgkmcnt(0)
  v_smfmac_f32_16x16x64_bf16 v[32:35], v[12:15], a[24:31], v74
  v_smfmac_f32_16x16x64_bf16 v[32:35], v[0:3], v[60:67], v74
  v_smfmac_f32_16x16x64_bf16 v[20:23], v[8:11], a[96:103], v74
  v_smfmac_f32_16x16x64_bf16 v[20:23], v[0:3], a[112:119], v74
  v_add_f32 v28, v28, v30
  v_add_f32 v32, v32, v34
  v_cvt_pk_bf16_f32 v30, v28, v32
  v_smfmac_f32_16x16x64_bf16 v[20:23], v[16:19], a[128:135], v74
  ds_write_b32 v79, v30 offset:256
  v_add_f32 v29, v29, v31
  v_add_f32 v33, v33, v35
  v_cvt_pk_bf16_f32 v31, v29, v33
  v_smfmac_f32_16x16x64_bf16 v[20:23], v[4:7], a[144:151], v74
  ds_write_b32 v79, v31 offset:832
  v_smfmac_f32_16x16x64_bf16 v[20:23], v[12:15], a[160:167], v74
  v_smfmac_f32_16x16x64_bf16 v[24:27], v[8:11], a[104:111], v74
  v_smfmac_f32_16x16x64_bf16 v[24:27], v[0:3], a[120:127], v74
  v_smfmac_f32_16x16x64_bf16 v[24:27], v[16:19], a[136:143], v74
  s_waitcnt lgkmcnt(0)
  s_barrier
  ds_read_b64 v[52:53], v77 offset:264
  v_add_f32 v20, v20, v22
  v_smfmac_f32_16x16x64_bf16 v[24:27], v[4:7], a[152:159], v74
  v_add_f32 v21, v21, v23
  v_smfmac_f32_16x16x64_bf16 v[24:27], v[12:15], a[168:175], v74
  v_cvt_pk_bf16_f32 v54, v20, v21
  s_add_u32 s68, s68, 655360
  s_nop 3
  v_add_f32 v24, v24, v26
  v_add_f32 v25, v25, v27
  v_cvt_pk_bf16_f32 v55, v24, v25
  s_waitcnt lgkmcnt(0)
  buffer_store_dwordx4 v[52:55], v76, s[8:11], s68 offen sc1
  s_branch Cs1_done
Cs1_lastp:
  s_add_u32 s72, s72, 2
  s_cmp_ge_u32 s72, 131072
  s_cbranch_scc1 Cs1_lastg
  s_barrier
  buffer_load_dwordx4 v76, s[8:11], s85 offen offset:0 sc1 lds
  s_waitcnt vmcnt(0)
  s_barrier
  s_branch Cs1_lastr
Cs1_done:
  s_branch L_cexit
L_w6:
  v_mov_b64 v[20:21], 0
  v_mov_b64 v[22:23], 0
  v_mov_b64 v[24:25], 0
  v_mov_b64 v[26:27], 0
  v_mov_b64 v[28:29], 0
  v_mov_b64 v[30:31], 0
  v_mov_b64 v[32:33], 0
  v_mov_b64 v[34:35], 0
  s_mov_b32 s78, 0x3f803f80
  s_mov_b32 s79, s78
  s_mov_b32 s65, 360448
  s_mov_b32 m0, 15872
  s_lshl_b32 s71, s53, 2
  s_add_u32 s71, s71, 128
  s_movk_i32 s56, 0x1000
  v_lshlrev_b32 v73, 2, v76
  v_mov_b32 v72, 0
  s_mov_b64 s[16:17], s[8:9]
  s_mov_b32 s18, 268435456
  s_mov_b32 s19, 0x20000
  s_getpc_b64 s[20:21]
Cs2_pc:
  s_add_u32 s20, s20, (Cs2_last - Cs2_pc)
  s_addc_u32 s21, s21, 0
  v_mov_b32 v68, 14880
  buffer_load_dwordx4 v[52:55], v76, s[8:11], s59 offen offset:0 sc1
  buffer_load_dwordx4 v[56:59], v76, s[8:11], s59 offen offset:1024 sc1
  ds_read_b128 v[36:39], v76 offset:24576
  ds_read_b128 v[40:43], v76 offset:25600
  ds_read_b128 v[60:63], v76 offset:26624
  ds_read_b128 v[64:67], v76 offset:27648
  ds_read_b128 v[0:3], v76 offset:4608
  ds_read_b128 v[4:7], v76 offset:5632
  ds_read_b128 v[8:11], v76 offset:6656
  ds_read_b128 v[12:15], v76 offset:7680
  s_waitcnt lgkmcnt(0)
  s_cmp_eq_u32 s66, 1
  s_branch Cs2_top2
.p2align 6
Cs2_h2:
  ds_read_b128 v[36:39], v76 offset:24576
  s_cmp_eq_u32 s66, 62
  s_cselect_b64 s[16:17], s[20:21], s[16:17]
  s_cselect_b32 s18, (Cs2_done - Cs2_last), s18
  s_cselect_b32 s70, 0, s70
  s_cmp_eq_u32 s66, 63
  s_cselect_b32 s59, 268435456, s59
  s_cselect_b32 s58, 268435456, s58
  ds_read_b128 v[40:43], v76 offset:25600
  v_mov_b64 v[20:21], 0
  v_mov_b64 v[22:23], 0
  v_mov_b64 v[24:25], 0
  v_mov_b64 v[26:27], 0
  v_mov_b32 v68, 14880
  v_lshlrev_b32 v73, 2, v76
  buffer_load_dwordx4 v[52:55], v76, s[8:11], s59 offen offset:0 sc1
  buffer_load_dwordx4 v[56:59], v76, s[8:11], s59 offen offset:1024 sc1
  s_waitcnt vmcnt(0)
  s_mov_b64 vcc, -1
Cs2_h2r:
  s_mov_b64 exec, vcc
  buffer_load_dwordx4 v[12:15], v76, s[8:11], s65 offen offset:3072 sc1
  buffer_load_dwordx4 v[0:3], v76, s[8:11], s85 offen offset:0 sc1
  s_mov_b64 exec, -1
  s_add_u32 s67, s67, 1
  s_cmp_lt_u32 s67, 131072
  s_cselect_b32 s54, -2, -1
  s_waitcnt vmcnt(1)
  v_max3_u32 v72, v12, v13, v14
  s_waitcnt vmcnt(0)
  v_max3_u32 v72, v72, v15, v0
  v_max3_u32 v72, v72, v1, v2
  v_max_u32 v72, v72, v3
  v_cmp_lt_u32 vcc, s54, v72
  s_cbranch_vccnz Cs2_h2r
  ds_write_b128 v76, v[12:15] offset:7680
  ds_write_b128 v76, v[0:3] offset:12800
Cs2_h2w:
  s_cmp_eq_u32 s66, 63
  s_waitcnt lgkmcnt(0)
  s_barrier
  ds_read_b128 v[0:3], v76 offset:4608
Cs2_top2:
  v_smfmac_f32_16x16x64_bf16 v[20:23], v[12:15], v[128:135], v74
  s_cbranch_scc1 Cs2_last
  v_smfmac_f32_16x16x64_bf16 v[24:27], v[12:15], v[136:143], v74
  buffer_load_dwordx4 v[44:47], v76, s[8:11], s58 offen offset:0 sc1
  s_mov_b32 m0, 15872
  v_smfmac_f32_16x16x64_bf16 v[28:31], v[12:15], v[224:231], v74
  buffer_load_dwordx4 v[48:51], v76, s[8:11], s58 offen offset:1024 sc1
  v_smfmac_f32_16x16x64_bf16 v[32:35], v[12:15], v[232:239], v74
  ds_read_b128 v[4:7], v76 offset:5632
  s_waitcnt lgkmcnt(1)
  v_smfmac_f32_16x16x64_bf16 v[20:23], v[0:3], v[80:87], v74
  ds_read_b128 v[8:11], v76 offset:6656
  v_smfmac_f32_16x16x64_bf16 v[28:31], v[0:3], v[36:43], v74
  ds_read_b128 v[36:39], v76 offset:40960
  v_smfmac_f32_16x16x64_bf16 v[24:27], v[0:3], v[88:95], v74
  buffer_store_dwordx4 v[16:19], v76, s[8:11], s68 offen sc1
  ds_read_b128 v[40:43], v76 offset:41984
  v_smfmac_f32_16x16x64_bf16 v[32:35], v[0:3], v[60:67], v74
  buffer_load_dword v73, s[16:19], s70 offen lds
  ds_read_b128 v[60:63], v76 offset:43008
  s_waitcnt lgkmcnt(4)
  v_smfmac_f32_16x16x64_bf16 v[20:23], v[4:7], v[96:103], v74
  ds_read_b128 v[64:67], v76 offset:44032
  v_smfmac_f32_16x16x64_bf16 v[24:27], v[4:7], v[104:111], v74
  s_waitcnt vmcnt(4)
  s_waitcnt lgkmcnt(4)
  v_smfmac_f32_16x16x64_bf16 v[20:23], v[8:11], v[112:119], v74
  s_barrier
  ds_read_b128 v[12:15], v76 offset:8704
  s_waitcnt lgkmcnt(3)
  v_smfmac_f32_16x16x64_bf16 v[28:31], v[4:7], v[36:43], v74
  ds_read_b128 v[36:39], v76 offset:57344
  v_smfmac_f32_16x16x64_bf16 v[24:27], v[8:11], v[120:127], v74
  ds_read_b128 v[40:43], v76 offset:58368
  s_waitcnt lgkmcnt(3)
  v_smfmac_f32_16x16x64_bf16 v[32:35], v[4:7], v[60:67], v74
  ds_read_b128 v[0:3], v76 offset:9728
  v_smfmac_f32_16x16x64_bf16 v[28:31], v[8:11], v[208:215], v74
  ds_read_b128 v[60:63], v76 offset:59392
  v_smfmac_f32_16x16x64_bf16 v[32:35], v[8:11], v[216:223], v74
  ds_read_b128 v[64:67], v76 offset:60416
  s_waitcnt lgkmcnt(5)
  v_smfmac_f32_16x16x64_bf16 v[20:23], v[12:15], v[144:151], v74
  s_barrier
  ds_read_b128 v[4:7], v76 offset:11776
  s_waitcnt lgkmcnt(4)
  v_smfmac_f32_16x16x64_bf16 v[28:31], v[12:15], v[36:43], v74
  ds_read_b128 v[8:11], v76 offset:12800
  ds_read_b128 v[36:39], v75 offset:8192
  v_smfmac_f32_16x16x64_bf16 v[24:27], v[12:15], v[152:159], v74
  ds_read_b128 v[16:19], v76 offset:10752
  s_waitcnt lgkmcnt(6)
  v_smfmac_f32_16x16x64_bf16 v[20:23], v[0:3], v[160:167], v74
  ds_read_b128 v[40:43], v75 offset:9216
  s_waitcnt lgkmcnt(5)
  v_smfmac_f32_16x16x64_bf16 v[32:35], v[12:15], v[60:67], v74
  ds_read_b128 v[60:63], v75 offset:10240
  v_smfmac_f32_16x16x64_bf16 v[24:27], v[0:3], v[168:175], v74
  ds_read_b128 v[64:67], v75 offset:11264
  s_waitcnt lgkmcnt(6)
  v_smfmac_f32_16x16x64_bf16 v[20:23], v[4:7], v[176:183], v74
  s_waitcnt lgkmcnt(5)
  v_smfmac_f32_16x16x64_bf16 v[20:23], v[8:11], v[192:199], v74
  s_waitcnt lgkmcnt(2)
  v_smfmac_f32_16x16x64_bf16 v[20:23], v[16:19], v[36:43], v74
  ds_read_b128 v[36:39], v75 offset:24576
  v_smfmac_f32_16x16x64_bf16 v[24:27], v[4:7], v[184:191], v74
  ds_read_b128 v[40:43], v75 offset:25600
  s_waitcnt lgkmcnt(2)
  v_smfmac_f32_16x16x64_bf16 v[24:27], v[16:19], v[60:67], v74
  ds_read_b128 v[60:63], v75 offset:26624
  v_add_f32 v20, v20, v22
  v_smfmac_f32_16x16x64_bf16 v[24:27], v[8:11], v[200:207], v74
  ds_read_b128 v[64:67], v75 offset:27648
  v_add_f32 v21, v21, v23
  v_smfmac_f32_16x16x64_bf16 v[28:31], v[16:19], v[240:247], v74
  v_mov_b64 v[70:71], s[78:79]
  v_smfmac_f32_16x16x64_bf16 v[28:31], v[4:7], a[0:7], v74
  s_waitcnt lgkmcnt(2)
  v_add_f32 v24, v24, v26
  v_smfmac_f32_16x16x64_bf16 v[28:31], v[0:3], v[36:43], v74
  ds_read_b128 v[36:39], v68
  v_cvt_pk_bf16_f32 v22, v20, v24
  v_smfmac_f32_16x16x64_bf16 v[28:31], v[8:11], a[16:23], v74
  ds_read_b128 v[40:43], v68
  ds_write_b32 v79, v22 offset:0
  s_waitcnt lgkmcnt(3)
  v_add_f32 v25, v25, v27
  v_cvt_pk_bf16_f32 v23, v21, v25
  v_smfmac_f32_16x16x64_bf16 v[32:35], v[0:3], v[60:67], v74
  ds_write_b32 v79, v23 offset:576
  v_cmp_u_f32 vcc, v20, v21
  v_smfmac_f32_16x16x64_bf16 v[32:35], v[16:19], v[248:255], v74
  v_add_f32 v28, v28, v30
  v_smfmac_f32_16x16x64_bf16 v[32:35], v[4:7], a[8:15], v74
  v_add_f32 v29, v29, v31
  v_smfmac_f32_16x16x64_bf16 v[32:35], v[8:11], a[24:31], v74
  s_cbranch_vccnz Cs2_rec
Cs2_recok:
  s_waitcnt lgkmcnt(3)
  v_smfmac_f32_16x16x64_bf16 v[36:39], v[16:19], a[128:135], v74
  s_waitcnt lgkmcnt(0)
  s_barrier
  ds_read_b128 v[60:63], v77
  v_smfmac_f32_16x16x64_bf16 v[40:43], v[16:19], a[136:143], v74
  ds_read_b128 v[64:67], v77 offset:128
  v_add_f32 v32, v32, v34
  v_cvt_pk_bf16_f32 v30, v28, v32
  v_smfmac_f32_16x16x64_bf16 v[36:39], v[0:3], a[112:119], v74
  ds_write_b32 v79, v30 offset:256
  v_add_f32 v33, v33, v35
  v_cvt_pk_bf16_f32 v31, v29, v33
  v_smfmac_f32_16x16x64_bf16 v[40:43], v[0:3], a[120:127], v74
  ds_write_b32 v79, v31 offset:832
  v_xor_b32 v75, 0x8000, v75
  v_smfmac_f32_16x16x64_bf16 v[36:39], v[4:7], a[144:151], v74
  ds_read_b128 v[0:3], v76 offset:4608
  v_mov_b32 v29, 0
  v_smfmac_f32_16x16x64_bf16 v[40:43], v[4:7], a[152:159], v74
  s_waitcnt vmcnt(2) lgkmcnt(3)
  v_mov_b32 v30, 0
  v_mfma_f32_16x16x32_bf16 v[44:47], v[44:47], v[60:63], 0
  ds_read_b128 v[4:7], v76 offset:5632
  s_waitcnt lgkmcnt(2)
  v_mfma_f32_16x16x32_bf16 v[44:47], v[48:51], v[64:67], v[44:47]
  s_barrier
  v_smfmac_f32_16x16x64_bf16 v[36:39], v[8:11], a[160:167], v74
  ds_read_b128 v[20:23], v77 offset:256
  ds_read_b128 v[24:27], v77 offset:384
  v_smfmac_f32_16x16x64_bf16 v[40:43], v[8:11], a[168:175], v74
  ds_read_b128 v[8:11], v76 offset:6656
  v_add_f32_dpp v72, v46, v44 quad_perm:[2,3,0,1] row_mask:0xf bank_mask:0xf
  v_add_f32_dpp v73, v47, v45 quad_perm:[2,3,0,1] row_mask:0xf bank_mask:0xf
  v_smfmac_f32_16x16x64_bf16 v[36:39], v[12:15], a[96:103], v74
  s_waitcnt lgkmcnt(4)
  v_exp_f32_dpp v72, v72 quad_perm:[0,1,0,1] row_mask:0xf bank_mask:0xf
  v_smfmac_f32_16x16x64_bf16 v[40:43], v[12:15], a[104:111], v74
  ds_read_b128 v[12:15], v76 offset:7680
  v_exp_f32_dpp v73, v73 quad_perm:[0,1,0,1] row_mask:0xf bank_mask:0xf
  v_smfmac_f32_16x16x64_bf16 v[36:39], v[0:3], a[32:39], v74
  s_waitcnt lgkmcnt(2)
  v_cvt_pk_bf16_f32 v72, v72, v73
  v_mfma_f32_16x16x32_bf16 v[20:23], v[20:23], v[60:63], 0
  ds_write_b32 v78, v72 offset:520
  v_mov_b64 v[16:17], 0
  v_mfma_f32_16x16x32_bf16 v[20:23], v[24:27], v[64:67], v[20:23]
  ds_read_b128 v[44:47], v75 offset:40960
  v_mov_b64 v[18:19], 0
  v_smfmac_f32_16x16x64_bf16 v[40:43], v[0:3], a[40:47], v74
  ds_read_b128 v[48:51], v75 offset:41984
  v_mov_b64 v[68:69], s[78:79]
  v_smfmac_f32_16x16x64_bf16 v[36:39], v[4:7], a[48:55], v74
  s_waitcnt lgkmcnt(4)
  v_add_f32_dpp v24, v22, v20 quad_perm:[2,3,0,1] row_mask:0xf bank_mask:0xf
  v_add_f32_dpp v25, v23, v21 quad_perm:[2,3,0,1] row_mask:0xf bank_mask:0xf
  v_smfmac_f32_16x16x64_bf16 v[36:39], v[8:11], a[64:71], v74
  s_waitcnt lgkmcnt(2)
  s_barrier
  ds_read_b128 v[32:35], v78 offset:512
  v_smfmac_f32_16x16x64_bf16 v[36:39], v[12:15], a[80:87], v74
  ds_read_b128 v[60:63], v75 offset:24576
  v_mul_f32 v24, s69, v24
  v_smfmac_f32_16x16x64_bf16 v[40:43], v[4:7], a[56:63], v74
  ds_read_b128 v[64:67], v75 offset:25600
  v_mul_f32 v25, s69, v25
  v_smfmac_f32_16x16x64_bf16 v[40:43], v[8:11], a[72:79], v74
  v_exp_f32_dpp v24, v24 quad_perm:[0,1,0,1] row_mask:0xf bank_mask:0xf
  v_smfmac_f32_16x16x64_bf16 v[40:43], v[12:15], a[88:95], v74
  s_waitcnt lgkmcnt(2)
  v_exp_f32_dpp v25, v25 quad_perm:[0,1,0,1] row_mask:0xf bank_mask:0xf
  v_mfma_f32_16x16x32_bf16 v[8:11], v[32:35], v[68:71], 0
  v_add_f32 v36, v36, v38
  v_add_f32 v37, v37, v39
  v_mfma_f32_16x16x32_bf16 v[0:3], v[32:35], v[52:55], 0
  v_add_f32 v40, v40, v42
  v_add_f32 v41, v41, v43
  v_mfma_f32_16x16x32_bf16 v[4:7], v[32:35], v[56:59], 0
  v_cvt_pk_bf16_f32 v28, v24, v25
  v_cvt_pk_bf16_f32 v72, v36, v37
  v_cvt_pk_bf16_f32 v73, v40, v41
  v_mfma_f32_16x16x16_bf16 v[8:11], v[28:29], v[68:69], v[8:11]
  v_cvt_pk_bf16_f32 v31, v24, v25
  v_mov_b64 v[20:21], 0
  v_mfma_f32_16x16x16_bf16 v[0:3], v[28:29], v[72:73], v[0:3]
  ds_read_b128 v[52:55], v75 offset:26624
  v_mov_b64 v[22:23], 0
  v_mfma_f32_16x16x16_bf16 v[4:7], v[30:31], v[72:73], v[4:7]
  v_rcp_f32 v10, v8
  v_rcp_f32 v11, v9
  v_mul_f32 v0, v10, v0
  v_mul_f32 v1, v11, v1
  v_max3_f32 v8, v8, v9, v10
  v_mul_f32 v4, v10, v4
  v_mul_f32 v5, v11, v5
  v_cvt_pk_bf16_f32 v2, v0, v4
  ds_write_b32 v79, v2 offset:8704
  v_cvt_pk_bf16_f32 v3, v1, v5
  ds_write_b32 v79, v3 offset:9280
  ds_read_b128 v[12:15], v78 offset:8832
  v_max_f32 v8, v8, v11
  v_cmp_le_f32 vcc, 1317011456, v8
  v_mov_b64 v[24:25], 0
  v_mov_b64 v[26:27], 0
  ds_read_b128 v[56:59], v75 offset:27648
  s_cbranch_vccnz Cs2_mx
Cs2_mxok:
  s_waitcnt lgkmcnt(2)
  s_barrier
  ds_read_b128 v[0:3], v78 offset:8896
  s_waitcnt lgkmcnt(2)
  v_smfmac_f32_16x16x64_bf16 v[16:19], v[12:15], a[176:183], v74
  ds_read_b128 v[4:7], v78 offset:8704
  v_smfmac_f32_16x16x64_bf16 v[20:23], v[12:15], v[44:51], v74
  ds_read_b128 v[8:11], v78 offset:8768
  v_smfmac_f32_16x16x64_bf16 v[24:27], v[12:15], a[224:231], v74
  ds_read_b128 v[36:39], v75 offset:43008
  s_waitcnt lgkmcnt(3)
  v_smfmac_f32_16x16x64_bf16 v[16:19], v[0:3], a[184:191], v74
  ds_read_b128 v[40:43], v75 offset:44032
  s_waitcnt lgkmcnt(3)
  v_smfmac_f32_16x16x64_bf16 v[16:19], v[4:7], v[60:67], v74
  ds_read_b128 v[68:71], v76 offset:13824
  s_waitcnt lgkmcnt(3)
  v_smfmac_f32_16x16x64_bf16 v[16:19], v[8:11], v[52:59], v74
  ds_read_b128 v[44:47], v75 offset:57344
  v_smfmac_f32_16x16x64_bf16 v[20:23], v[4:7], a[192:199], v74
  ds_read_b128 v[48:51], v75 offset:58368
  v_smfmac_f32_16x16x64_bf16 v[20:23], v[8:11], a[200:207], v74
  ds_read_b128 v[60:63], v75 offset:59392
  s_waitcnt lgkmcnt(4)
  v_cvt_pk_bf16_f32 v16, v16, v17
  v_cvt_pk_bf16_f32 v17, v18, v19
  v_bfi_b32 v16, 1, s72, v16
  v_smfmac_f32_16x16x64_bf16 v[20:23], v[0:3], v[36:43], v74
  s_waitcnt lgkmcnt(3)
  buffer_store_dwordx2 v[16:17], v68, s[8:11], s73 offen sc1
  v_mov_b64 v[32:33], 0
  v_smfmac_f32_16x16x64_bf16 v[24:27], v[4:7], a[208:215], v74
  ds_read_b128 v[64:67], v75 offset:60416
  v_mov_b64 v[34:35], 0
  v_smfmac_f32_16x16x64_bf16 v[24:27], v[8:11], a[216:223], v74
  ds_read_b128 v[52:55], v75 offset:0
  v_cvt_pk_bf16_f32 v20, v20, v21
  v_cvt_pk_bf16_f32 v21, v22, v23
  v_bfi_b32 v20, 1, s72, v20
  v_smfmac_f32_16x16x64_bf16 v[24:27], v[0:3], a[232:239], v74
  ds_read_b128 v[56:59], v75 offset:1024
  buffer_store_dwordx2 v[20:21], v68, s[8:11], s74 offen sc1
  s_waitcnt lgkmcnt(4)
  v_mov_b64 v[28:29], 0
  v_smfmac_f32_16x16x64_bf16 v[32:35], v[4:7], v[44:51], v74
  ds_read_b128 v[36:39], v75 offset:2048
  ds_read_b128 v[40:43], v75 offset:3072
  s_waitcnt lgkmcnt(4)
  v_smfmac_f32_16x16x64_bf16 v[32:35], v[8:11], v[60:67], v74
  ds_read_b128 v[44:47], v75 offset:4096
  v_cvt_pk_bf16_f32 v24, v24, v25
  v_cvt_pk_bf16_f32 v25, v26, v27
  v_bfi_b32 v24, 1, s72, v24
  v_smfmac_f32_16x16x64_bf16 v[32:35], v[12:15], a[240:247], v74
  ds_read_b128 v[48:51], v75 offset:5120
  buffer_store_dwordx2 v[24:25], v68, s[8:11], s75 offen sc1
  v_mov_b64 v[30:31], 0
  v_smfmac_f32_16x16x64_bf16 v[32:35], v[0:3], a[248:255], v74
  ds_read_b128 v[60:63], v75 offset:6144
  ds_read_b128 v[64:67], v75 offset:7168
  s_waitcnt lgkmcnt(6)
  v_smfmac_f32_16x16x64_bf16 v[28:31], v[4:7], v[52:59], v74
  s_waitcnt lgkmcnt(4)
  v_smfmac_f32_16x16x64_bf16 v[28:31], v[8:11], v[36:43], v74
  s_waitcnt lgkmcnt(2)
  v_cvt_pk_bf16_f32 v32, v32, v33
  v_cvt_pk_bf16_f32 v33, v34, v35
  v_bfi_b32 v32, 1, s72, v32
  v_smfmac_f32_16x16x64_bf16 v[28:31], v[12:15], v[44:51], v74
  buffer_store_dwordx2 v[32:33], v68, s[8:11], s76 offen sc1
  s_waitcnt lgkmcnt(0)
  v_smfmac_f32_16x16x64_bf16 v[28:31], v[0:3], v[60:67], v74
  v_mov_b64 v[18:19], v[72:73]
  s_nop 4
  v_cvt_pk_bf16_f32 v28, v28, v29
  v_cvt_pk_bf16_f32 v29, v30, v31
  v_bfi_b32 v28, 1, s72, v28
  buffer_store_dwordx2 v[28:29], v68, s[8:11], s77 offen sc1
  ds_read_b128 v[0:3], v76 offset:14848
  s_waitcnt lgkmcnt(0)
  ds_read_b64 v[16:17], v77 offset:384
  s_waitcnt lgkmcnt(0)
  ds_read_b128 v[64:67], v76 offset:27648
  s_waitcnt lgkmcnt(0)
  ds_read_b128 v[60:63], v76 offset:26624
  s_waitcnt lgkmcnt(0)
  v_xor_b32 v75, 0x8000, v75
  v_mov_b64 v[28:29], 0
  v_mov_b64 v[30:31], 0
  v_mov_b64 v[32:33], 0
  v_mov_b64 v[34:35], 0
  s_waitcnt vmcnt(0)
  buffer_load_dwordx4 v[52:55], v76, s[8:11], s60 offen offset:0 sc1
  buffer_load_dwordx4 v[56:59], v76, s[8:11], s60 offen offset:1024 sc1
  s_add_u32 s66, s66, 1
  s_xor_b32 s64, s64, 16384
  s_xor_b32 s65, s65, 16384
  s_add_u32 s58, s58, 655360
  s_add_u32 s59, s59, 655360
  s_add_u32 s70, s70, 655360
  s_add_u32 s68, s68, 655360
  s_mov_b32 m0, 12800
  s_add_u32 s85, s65, 8192
  s_waitcnt lgkmcnt(0)
  s_waitcnt vmcnt(1)
  v_mfma_f32_16x16x32_bf16 v[4:7], v[0:3], v[52:55], 0
  v_bitop3_b32 v72, v52, v54, s72 bitop3:0x7e
  s_waitcnt vmcnt(0)
  v_mfma_f32_16x16x32_bf16 v[4:7], v[0:3], v[56:59], v[4:7]
  v_bitop3_b32 v73, v56, v58, s72 bitop3:0x7e
  v_bitop3_b32 v72, v72, v73, 1 bitop3:0xa8
  v_cmp_ne_u32 vcc, 0, v72
  s_cbranch_vccnz Cs2_h1r
  s_nop 2
  v_add_f32_dpp v4, v4, v4 row_ror:4 row_mask:0xf bank_mask:0xf
  v_add_f32_dpp v5, v5, v5 row_ror:4 row_mask:0xf bank_mask:0xf
  s_nop 0
  v_add_f32_dpp v4, v4, v4 row_ror:8 row_mask:0xf bank_mask:0xf
  v_add_f32_dpp v5, v5, v5 row_ror:8 row_mask:0xf bank_mask:0xf
  v_cvt_pk_bf16_f32 v4, v4, v5
  buffer_store_dword v4, v69, s[8:11], s62 offen sc1
  s_xor_b32 s62, s62, 16384
  buffer_store_dword v71, v69, s[8:11], s62 offen sc1
  s_xor_b32 s72, s72, 1
  s_branch Cs2_h2
Cs2_h1r:
  s_mov_b64 exec, vcc
  buffer_load_dwordx4 v[52:55], v76, s[8:11], s60 offen offset:0 sc1
  buffer_load_dwordx4 v[56:59], v76, s[8:11], s60 offen offset:1024 sc1
  s_mov_b64 exec, -1
  s_add_u32 s67, s67, 1
  s_waitcnt vmcnt(1)
  v_mfma_f32_16x16x32_bf16 v[4:7], v[0:3], v[52:55], 0
  v_bitop3_b32 v72, v52, v54, s72 bitop3:0x7e
  s_waitcnt vmcnt(0)
  v_mfma_f32_16x16x32_bf16 v[4:7], v[0:3], v[56:59], v[4:7]
  v_bitop3_b32 v73, v56, v58, s72 bitop3:0x7e
  v_bitop3_b32 v72, v72, v73, 1 bitop3:0xa8
  v_cmp_ne_u32 vcc, 0, v72
  s_cbranch_vccz Cs2_h1p
Cs2_h1s:
  s_mov_b64 exec, vcc
  buffer_load_dwordx4 v[52:55], v76, s[8:11], s60 offen offset:0 sc1
  buffer_load_dwordx4 v[56:59], v76, s[8:11], s60 offen offset:1024 sc1
  s_mov_b64 exec, -1
  s_add_u32 s67, s67, 1
  s_waitcnt vmcnt(1)
  v_mfma_f32_16x16x32_bf16 v[4:7], v[0:3], v[52:55], 0
  v_bitop3_b32 v72, v52, v54, s72 bitop3:0x7e
  s_waitcnt vmcnt(0)
  v_mfma_f32_16x16x32_bf16 v[4:7], v[0:3], v[56:59], v[4:7]
  v_bitop3_b32 v73, v56, v58, s72 bitop3:0x7e
  v_bitop3_b32 v72, v72, v73, 1 bitop3:0xa8
  v_cmp_ne_u32 vcc, 0, v72
  s_cbranch_vccz Cs2_h1p
  s_cmp_lt_u32 s67, 131072
  s_cbranch_scc1 Cs2_h1s
Cs2_h1p:
  s_nop 2
  v_add_f32_dpp v4, v4, v4 row_ror:4 row_mask:0xf bank_mask:0xf
  v_add_f32_dpp v5, v5, v5 row_ror:4 row_mask:0xf bank_mask:0xf
  s_nop 0
  v_add_f32_dpp v4, v4, v4 row_ror:8 row_mask:0xf bank_mask:0xf
  v_add_f32_dpp v5, v5, v5 row_ror:8 row_mask:0xf bank_mask:0xf
  v_cvt_pk_bf16_f32 v4, v4, v5
  buffer_store_dword v4, v69, s[8:11], s62 offen sc1
  s_xor_b32 s62, s62, 16384
  buffer_store_dword v71, v69, s[8:11], s62 offen sc1
  s_xor_b32 s72, s72, 1
  s_branch Cs2_h2
Cs2_rec:
  s_nop 7
  s_waitcnt vmcnt(0) lgkmcnt(0)
  v_max3_u32 v72, v0, v1, v2
  v_max3_u32 v72, v72, v3, v4
  v_max3_u32 v72, v72, v5, v6
  v_max3_u32 v72, v72, v7, v8
  v_max3_u32 v72, v72, v9, v10
  v_max3_u32 v72, v72, v11, v12
  v_max3_u32 v72, v72, v13, v14
  v_max3_u32 v72, v72, v15, v16
  v_max3_u32 v72, v72, v17, v18
  v_max_u32 v72, v72, v19
  v_cmp_eq_u32 vcc, -1, v72
  s_cbranch_vccz Cs2_recok
  s_barrier
Cs2_recp:
  buffer_load_dwordx4 v[0:3], v76, s[8:11], s64 offen offset:0 sc1
  buffer_load_dwordx4 v[4:7], v76, s[8:11], s64 offen offset:1024 sc1
  s_add_u32 s67, s67, 1
  s_cmp_lt_u32 s67, 131072
  s_cselect_b32 s54, -2, -1
  s_waitcnt vmcnt(1)
  v_max3_u32 v72, v0, v1, v2
  s_waitcnt vmcnt(0)
  v_max3_u32 v72, v72, v3, v4
  v_max3_u32 v72, v72, v5, v6
  v_max_u32 v72, v72, v7
  v_cmp_lt_u32 vcc, s54, v72
  s_cbranch_vccnz Cs2_recp
  ds_write_b128 v76, v[0:3] offset:8704
  ds_write_b128 v76, v[4:7] offset:9728
  v_mov_b64 v[20:21], 0
  v_mov_b64 v[22:23], 0
  v_mov_b64 v[24:25], 0
  v_mov_b64 v[26:27], 0
  v_mov_b64 v[28:29], 0
  v_mov_b64 v[30:31], 0
  v_mov_b64 v[32:33], 0
  v_mov_b64 v[34:35], 0
  s_waitcnt lgkmcnt(0)
  s_barrier
  ds_read_b128 v[0:3], v76 offset:4608
  s_waitcnt lgkmcnt(0)
  v_smfmac_f32_16x16x64_bf16 v[20:23], v[0:3], v[80:87], v74
  v_smfmac_f32_16x16x64_bf16 v[24:27], v[0:3], v[88:95], v74
  ds_read_b128 v[60:63], v76 offset:24576
  ds_read_b128 v[64:67], v76 offset:25600
  s_waitcnt lgkmcnt(0)
  v_smfmac_f32_16x16x64_bf16 v[28:31], v[0:3], v[60:67], v74
  ds_read_b128 v[60:63], v76 offset:26624
  ds_read_b128 v[64:67], v76 offset:27648
  s_waitcnt lgkmcnt(0)
  v_smfmac_f32_16x16x64_bf16 v[32:35], v[0:3], v[60:67], v74
  ds_read_b128 v[4:7], v76 offset:5632
  s_waitcnt lgkmcnt(0)
  v_smfmac_f32_16x16x64_bf16 v[20:23], v[4:7], v[96:103], v74
  v_smfmac_f32_16x16x64_bf16 v[24:27], v[4:7], v[104:111], v74
  ds_read_b128 v[60:63], v76 offset:40960
  ds_read_b128 v[64:67], v76 offset:41984
  s_waitcnt lgkmcnt(0)
  v_smfmac_f32_16x16x64_bf16 v[28:31], v[4:7], v[60:67], v74
  ds_read_b128 v[60:63], v76 offset:43008
  ds_read_b128 v[64:67], v76 offset:44032
  s_waitcnt lgkmcnt(0)
  v_smfmac_f32_16x16x64_bf16 v[32:35], v[4:7], v[60:67], v74
  ds_read_b128 v[8:11], v76 offset:6656
  s_waitcnt lgkmcnt(0)
  v_smfmac_f32_16x16x64_bf16 v[20:23], v[8:11], v[112:119], v74
  v_smfmac_f32_16x16x64_bf16 v[24:27], v[8:11], v[120:127], v74
  v_smfmac_f32_16x16x64_bf16 v[28:31], v[8:11], v[208:215], v74
  v_smfmac_f32_16x16x64_bf16 v[32:35], v[8:11], v[216:223], v74
  ds_read_b128 v[12:15], v76 offset:7680
  s_waitcnt lgkmcnt(0)
  v_smfmac_f32_16x16x64_bf16 v[20:23], v[12:15], v[128:135], v74
  v_smfmac_f32_16x16x64_bf16 v[24:27], v[12:15], v[136:143], v74
  v_smfmac_f32_16x16x64_bf16 v[28:31], v[12:15], v[224:231], v74
  v_smfmac_f32_16x16x64_bf16 v[32:35], v[12:15], v[232:239], v74
  ds_read_b128 v[12:15], v76 offset:8704
  s_waitcnt lgkmcnt(0)
  v_smfmac_f32_16x16x64_bf16 v[20:23], v[12:15], v[144:151], v74
  v_smfmac_f32_16x16x64_bf16 v[24:27], v[12:15], v[152:159], v74
  ds_read_b128 v[60:63], v76 offset:57344
  ds_read_b128 v[64:67], v76 offset:58368
  s_waitcnt lgkmcnt(0)
  v_smfmac_f32_16x16x64_bf16 v[28:31], v[12:15], v[60:67], v74
  ds_read_b128 v[60:63], v76 offset:59392
  ds_read_b128 v[64:67], v76 offset:60416
  s_waitcnt lgkmcnt(0)
  v_smfmac_f32_16x16x64_bf16 v[32:35], v[12:15], v[60:67], v74
  ds_read_b128 v[0:3], v76 offset:9728
  s_waitcnt lgkmcnt(0)
  v_smfmac_f32_16x16x64_bf16 v[20:23], v[0:3], v[160:167], v74
  v_smfmac_f32_16x16x64_bf16 v[24:27], v[0:3], v[168:175], v74
  ds_read_b128 v[60:63], v75 offset:24576
  ds_read_b128 v[64:67], v75 offset:25600
  s_waitcnt lgkmcnt(0)
  v_smfmac_f32_16x16x64_bf16 v[28:31], v[0:3], v[60:67], v74
  ds_read_b128 v[60:63], v75 offset:26624
  ds_read_b128 v[64:67], v75 offset:27648
  s_waitcnt lgkmcnt(0)
  v_smfmac_f32_16x16x64_bf16 v[32:35], v[0:3], v[60:67], v74
  ds_read_b128 v[16:19], v76 offset:10752
  ds_read_b128 v[60:63], v75 offset:8192
  ds_read_b128 v[64:67], v75 offset:9216
  s_waitcnt lgkmcnt(0)
  v_smfmac_f32_16x16x64_bf16 v[20:23], v[16:19], v[60:67], v74
  ds_read_b128 v[60:63], v75 offset:10240
  ds_read_b128 v[64:67], v75 offset:11264
  s_waitcnt lgkmcnt(0)
  v_smfmac_f32_16x16x64_bf16 v[24:27], v[16:19], v[60:67], v74
  v_smfmac_f32_16x16x64_bf16 v[28:31], v[16:19], v[240:247], v74
  v_smfmac_f32_16x16x64_bf16 v[32:35], v[16:19], v[248:255], v74
  ds_read_b128 v[4:7], v76 offset:11776
  s_waitcnt lgkmcnt(0)
  v_smfmac_f32_16x16x64_bf16 v[20:23], v[4:7], v[176:183], v74
  v_smfmac_f32_16x16x64_bf16 v[24:27], v[4:7], v[184:191], v74
  v_smfmac_f32_16x16x64_bf16 v[28:31], v[4:7], a[0:7], v74
  v_smfmac_f32_16x16x64_bf16 v[32:35], v[4:7], a[8:15], v74
  ds_read_b128 v[8:11], v76 offset:12800
  s_waitcnt lgkmcnt(0)
  v_smfmac_f32_16x16x64_bf16 v[20:23], v[8:11], v[192:199], v74
  v_smfmac_f32_16x16x64_bf16 v[24:27], v[8:11], v[200:207], v74
  v_smfmac_f32_16x16x64_bf16 v[28:31], v[8:11], a[16:23], v74
  v_smfmac_f32_16x16x64_bf16 v[32:35], v[8:11], a[24:31], v74
  v_add_f32 v20, v20, v22
  v_add_f32 v21, v21, v23
  v_add_f32 v24, v24, v26
  v_cvt_pk_bf16_f32 v22, v20, v24
  ds_write_b32 v79, v22 offset:0
  v_add_f32 v25, v25, v27
  v_cvt_pk_bf16_f32 v23, v21, v25
  ds_write_b32 v79, v23 offset:576
  v_add_f32 v28, v28, v30
  v_add_f32 v29, v29, v31
  s_waitcnt lgkmcnt(0)
  s_nop 1
  s_branch Cs2_recok
Cs2_mx:
  s_waitcnt lgkmcnt(0)
  s_barrier
  buffer_load_dwordx4 v[52:55], v76, s[8:11], s59 offen offset:0 sc1
  buffer_load_dwordx4 v[0:3], v76, s[8:11], s58 offen offset:0 sc1
  ds_read_b128 v[20:23], v77 offset:0
  ds_read_b128 v[28:31], v77 offset:256
  buffer_load_dwordx4 v[56:59], v76, s[8:11], s59 offen offset:1024 sc1
  buffer_load_dwordx4 v[4:7], v76, s[8:11], s58 offen offset:1024 sc1
  ds_read_b128 v[24:27], v77 offset:128
  ds_read_b128 v[32:35], v77 offset:384
  s_waitcnt vmcnt(2) lgkmcnt(3)
  v_mfma_f32_16x16x32_bf16 v[8:11], v[0:3], v[20:23], 0
  s_waitcnt vmcnt(0) lgkmcnt(1)
  v_mfma_f32_16x16x32_bf16 v[8:11], v[4:7], v[24:27], v[8:11]
  v_mfma_f32_16x16x32_bf16 v[12:15], v[28:31], v[20:23], 0
  s_waitcnt lgkmcnt(0)
  v_mfma_f32_16x16x32_bf16 v[12:15], v[32:35], v[24:27], v[12:15]
  v_add_f32_dpp v8, v10, v8 quad_perm:[2,3,0,1] row_mask:0xf bank_mask:0xf
  v_add_f32_dpp v9, v11, v9 quad_perm:[2,3,0,1] row_mask:0xf bank_mask:0xf
  s_nop 0
  v_mov_b32_dpp v8, v8 quad_perm:[0,1,0,1] row_mask:0xf bank_mask:0xf
  v_mov_b32_dpp v9, v9 quad_perm:[0,1,0,1] row_mask:0xf bank_mask:0xf
  s_nop 1
  v_add_f32_dpp v12, v14, v12 quad_perm:[2,3,0,1] row_mask:0xf bank_mask:0xf
  v_add_f32_dpp v13, v15, v13 quad_perm:[2,3,0,1] row_mask:0xf bank_mask:0xf
  s_nop 0
  v_mov_b32_dpp v12, v12 quad_perm:[0,1,0,1] row_mask:0xf bank_mask:0xf
  v_mov_b32_dpp v13, v13 quad_perm:[0,1,0,1] row_mask:0xf bank_mask:0xf
  v_mul_f32 v12, s69, v12
  ds_write_b32 v78, v8 offset:8712
  v_mul_f32 v13, s69, v13
  ds_write_b32 v78, v9 offset:8776
  s_waitcnt lgkmcnt(0)
  s_barrier
  ds_read_b128 v[36:39], v78 offset:8704
  ds_read_b128 v[40:43], v78 offset:8768
  s_waitcnt lgkmcnt(0)
  s_barrier
  v_max_f32 v16, v36, v37
  v_max3_f32 v16, v16, v38, v39
  v_max3_f32 v16, v16, v40, v41
  v_max3_f32 v16, v16, v42, v43
  v_max3_f32 v16, v16, v12, v13
  v_mov_b32 v17, v16
  s_nop 1
  v_permlane16_swap_b32 v16, v17
  v_max_f32 v16, v16, v17
  v_mov_b32 v17, v16
  s_nop 1
  v_permlane32_swap_b32 v16, v17
  v_max_f32 v16, v16, v17
  v_sub_f32 v36, v36, v16
  v_sub_f32 v37, v37, v16
  v_sub_f32 v38, v38, v16
  v_sub_f32 v39, v39, v16
  v_sub_f32 v40, v40, v16
  v_sub_f32 v41, v41, v16
  v_sub_f32 v42, v42, v16
  v_sub_f32 v43, v43, v16
  v_sub_f32 v12, v12, v16
  v_sub_f32 v13, v13, v16
  v_exp_f32 v36, v36
  v_exp_f32 v37, v37
  v_exp_f32 v38, v38
  v_exp_f32 v39, v39
  v_exp_f32 v40, v40
  v_exp_f32 v41, v41
  v_exp_f32 v42, v42
  v_exp_f32 v43, v43
  v_exp_f32 v12, v12
  v_exp_f32 v13, v13
  v_cvt_pk_bf16_f32 v32, v36, v40
  v_cvt_pk_bf16_f32 v33, v37, v41
  v_cvt_pk_bf16_f32 v34, v38, v42
  v_cvt_pk_bf16_f32 v35, v39, v43
  v_cvt_pk_bf16_f32 v28, v12, v13
  v_cvt_pk_bf16_f32 v31, v12, v13
  v_mov_b32 v29, 0
  v_mov_b32 v30, 0
  v_mfma_f32_16x16x32_bf16 v[8:11], v[32:35], v[68:71], 0
  v_mfma_f32_16x16x32_bf16 v[0:3], v[32:35], v[52:55], 0
  v_mfma_f32_16x16x32_bf16 v[4:7], v[32:35], v[56:59], 0
  v_mfma_f32_16x16x16_bf16 v[8:11], v[28:29], v[68:69], v[8:11]
  v_mfma_f32_16x16x16_bf16 v[0:3], v[28:29], v[72:73], v[0:3]
  v_mfma_f32_16x16x16_bf16 v[4:7], v[30:31], v[72:73], v[4:7]
  ds_read_b128 v[52:55], v75 offset:26624
  v_rcp_f32 v10, v8
  v_rcp_f32 v11, v9
  v_mul_f32 v0, v10, v0
  v_mul_f32 v1, v11, v1
  v_max3_f32 v8, v8, v9, v10
  v_mul_f32 v4, v10, v4
  v_mul_f32 v5, v11, v5
  v_cvt_pk_bf16_f32 v2, v0, v4
  ds_write_b32 v79, v2 offset:8704
  v_cvt_pk_bf16_f32 v3, v1, v5
  ds_write_b32 v79, v3 offset:9280
  ds_read_b128 v[12:15], v78 offset:8832
  ds_read_b128 v[56:59], v75 offset:27648
  v_mov_b64 v[16:17], 0
  v_mov_b64 v[18:19], 0
  v_mov_b64 v[20:21], 0
  v_mov_b64 v[22:23], 0
  v_mov_b64 v[24:25], 0
  v_mov_b64 v[26:27], 0
  s_branch Cs2_mxok
Cs2_last:
  ds_read_b128 v[4:7], v76 offset:5632
  ds_read_b128 v[8:11], v76 offset:6656
  ds_read_b128 v[44:47], v76 offset:40960
  ds_read_b128 v[48:51], v76 offset:41984
  s_nop 5
  v_mov_b64 v[20:21], 0
  v_mov_b64 v[22:23], 0
  v_mov_b64 v[24:25], 0
  v_mov_b64 v[26:27], 0
  s_waitcnt lgkmcnt(4)
  v_smfmac_f32_16x16x64_bf16 v[28:31], v[0:3], v[36:43], v74
  ds_read_b128 v[36:39], v76 offset:43008
  ds_read_b128 v[40:43], v76 offset:44032
  v_smfmac_f32_16x16x64_bf16 v[32:35], v[0:3], v[60:67], v74
  s_waitcnt lgkmcnt(5)
  v_smfmac_f32_16x16x64_bf16 v[20:23], v[0:3], a[32:39], v74
  ds_read_b128 v[60:63], v76 offset:57344
  ds_read_b128 v[64:67], v76 offset:58368
  v_smfmac_f32_16x16x64_bf16 v[24:27], v[0:3], a[40:47], v74
  s_waitcnt lgkmcnt(4)
  v_smfmac_f32_16x16x64_bf16 v[20:23], v[4:7], a[48:55], v74
  buffer_store_dwordx4 v[16:19], v76, s[8:11], s68 offen sc1
  v_smfmac_f32_16x16x64_bf16 v[24:27], v[4:7], a[56:63], v74
  v_smfmac_f32_16x16x64_bf16 v[28:31], v[4:7], v[44:51], v74
  s_waitcnt lgkmcnt(2)
  v_smfmac_f32_16x16x64_bf16 v[20:23], v[8:11], a[64:71], v74
  ds_read_b128 v[44:47], v76 offset:59392
  ds_read_b128 v[48:51], v76 offset:60416
  v_smfmac_f32_16x16x64_bf16 v[24:27], v[8:11], a[72:79], v74
  v_smfmac_f32_16x16x64_bf16 v[32:35], v[4:7], v[36:43], v74
  v_smfmac_f32_16x16x64_bf16 v[28:31], v[8:11], v[208:215], v74
  ds_read_b128 v[36:39], v75 offset:24576
  ds_read_b128 v[40:43], v75 offset:25600
  v_smfmac_f32_16x16x64_bf16 v[32:35], v[8:11], v[216:223], v74
  v_smfmac_f32_16x16x64_bf16 v[20:23], v[12:15], a[80:87], v74
  v_smfmac_f32_16x16x64_bf16 v[24:27], v[12:15], a[88:95], v74
  v_smfmac_f32_16x16x64_bf16 v[28:31], v[12:15], v[224:231], v74
  v_smfmac_f32_16x16x64_bf16 v[32:35], v[12:15], v[232:239], v74
  s_waitcnt vmcnt(1)
  s_barrier
Cs2_lastr:
  ds_read_b128 v[12:15], v76 offset:8704
  ds_read_b128 v[0:3], v76 offset:9728
  ds_read_b128 v[16:19], v76 offset:10752
  ds_read_b128 v[4:7], v76 offset:11776
  ds_read_b128 v[8:11], v76 offset:12800
  s_waitcnt lgkmcnt(3)
  v_max3_u32 v72, v0, v1, v2
  s_waitcnt lgkmcnt(1)
  v_max3_u32 v72, v72, v3, v4
  v_max3_u32 v72, v72, v5, v6
  s_waitcnt lgkmcnt(0)
  v_max3_u32 v72, v72, v7, v8
  v_max3_u32 v72, v72, v9, v10
  v_max3_u32 v72, v72, v11, v12
  v_max3_u32 v72, v72, v13, v14
  v_max3_u32 v72, v72, v15, v16
  v_max3_u32 v72, v72, v17, v18
  v_max_u32 v72, v72, v19
  v_cmp_eq_u32 vcc, -1, v72
  s_cbranch_vccnz Cs2_lastp
Cs2_lastg:
  v_smfmac_f32_16x16x64_bf16 v[28:31], v[12:15], v[60:67], v74
  ds_read_b128 v[60:63], v75 offset:26624
  ds_read_b128 v[64:67], v75 offset:27648
  v_smfmac_f32_16x16x64_bf16 v[32:35], v[12:15], v[44:51], v74
  v_smfmac_f32_16x16x64_bf16 v[28:31], v[0:3], v[36:43], v74
  v_smfmac_f32_16x16x64_bf16 v[28:31], v[16:19], v[240:247], v74
  v_smfmac_f32_16x16x64_bf16 v[28:31], v[4:7], a[0:7], v74
  v_smfmac_f32_16x16x64_bf16 v[28:31], v[8:11], a[16:23], v74
  v_smfmac_f32_16x16x64_bf16 v[32:35], v[16:19], v[248:255], v74
  v_smfmac_f32_16x16x64_bf16 v[32:35], v[4:7], a[8:15], v74
  s_waitcnt lgkmcnt(0)
  v_smfmac_f32_16x16x64_bf16 v[32:35], v[8:11], a[24:31], v74
  v_smfmac_f32_16x16x64_bf16 v[32:35], v[0:3], v[60:67], v74
  v_smfmac_f32_16x16x64_bf16 v[20:23], v[12:15], a[96:103], v74
  v_smfmac_f32_16x16x64_bf16 v[20:23], v[0:3], a[112:119], v74
  v_add_f32 v28, v28, v30
  v_add_f32 v32, v32, v34
  v_cvt_pk_bf16_f32 v30, v28, v32
  v_smfmac_f32_16x16x64_bf16 v[20:23], v[16:19], a[128:135], v74
  ds_write_b32 v79, v30 offset:256
  v_add_f32 v29, v29, v31
  v_add_f32 v33, v33, v35
  v_cvt_pk_bf16_f32 v31, v29, v33
  v_smfmac_f32_16x16x64_bf16 v[20:23], v[4:7], a[144:151], v74
  ds_write_b32 v79, v31 offset:832
  v_smfmac_f32_16x16x64_bf16 v[20:23], v[8:11], a[160:167], v74
  v_smfmac_f32_16x16x64_bf16 v[24:27], v[12:15], a[104:111], v74
  v_smfmac_f32_16x16x64_bf16 v[24:27], v[0:3], a[120:127], v74
  v_smfmac_f32_16x16x64_bf16 v[24:27], v[16:19], a[136:143], v74
  s_waitcnt lgkmcnt(0)
  s_barrier
  ds_read_b64 v[52:53], v77 offset:384
  v_add_f32 v20, v20, v22
  v_smfmac_f32_16x16x64_bf16 v[24:27], v[4:7], a[152:159], v74
  v_add_f32 v21, v21, v23
  v_smfmac_f32_16x16x64_bf16 v[24:27], v[8:11], a[168:175], v74
  v_cvt_pk_bf16_f32 v54, v20, v21
  s_add_u32 s68, s68, 655360
  s_nop 3
  v_add_f32 v24, v24, v26
  v_add_f32 v25, v25, v27
  v_cvt_pk_bf16_f32 v55, v24, v25
  s_waitcnt lgkmcnt(0)
  buffer_store_dwordx4 v[52:55], v76, s[8:11], s68 offen sc1
  s_branch Cs2_done
Cs2_lastp:
  s_add_u32 s72, s72, 2
  s_cmp_ge_u32 s72, 131072
  s_cbranch_scc1 Cs2_lastg
  s_barrier
  buffer_load_dwordx4 v76, s[8:11], s85 offen offset:0 sc1 lds
  s_waitcnt vmcnt(0)
  s_barrier
  s_branch Cs2_lastr
Cs2_done:
  s_branch L_cexit
L_w7:
  v_mov_b64 v[20:21], 0
  v_mov_b64 v[22:23], 0
  v_mov_b64 v[24:25], 0
  v_mov_b64 v[26:27], 0
  v_mov_b64 v[28:29], 0
  v_mov_b64 v[30:31], 0
  v_mov_b64 v[32:33], 0
  v_mov_b64 v[34:35], 0
  s_mov_b32 s78, 0x3f803f80
  s_mov_b32 s79, s78
  s_mov_b32 s65, 360448
  s_mov_b32 m0, 15872
  s_lshl_b32 s71, s53, 2
  s_add_u32 s71, s71, 128
  s_movk_i32 s56, 0x1000
  v_lshlrev_b32 v73, 2, v76
  v_mov_b32 v72, 0
  s_mov_b64 s[16:17], s[8:9]
  s_mov_b32 s18, 268435456
  s_mov_b32 s19, 0x20000
  s_getpc_b64 s[20:21]
Cs3_pc:
  s_add_u32 s20, s20, (Cs3_last - Cs3_pc)
  s_addc_u32 s21, s21, 0
  v_mov_b32 v68, 14880
  buffer_load_dwordx4 v[52:55], v76, s[8:11], s59 offen offset:0 sc1
  buffer_load_dwordx4 v[56:59], v76, s[8:11], s59 offen offset:1024 sc1
  ds_read_b128 v[36:39], v76 offset:45056
  ds_read_b128 v[40:43], v76 offset:46080
  ds_read_b128 v[60:63], v76 offset:47104
  ds_read_b128 v[64:67], v76 offset:48128
  ds_read_b128 v[0:3], v76 offset:4608
  ds_read_b128 v[4:7], v76 offset:5632
  ds_read_b128 v[8:11], v76 offset:6656
  ds_read_b128 v[12:15], v76 offset:7680
  s_waitcnt lgkmcnt(0)
  s_cmp_eq_u32 s66, 1
  s_branch Cs3_top2
.p2align 6
Cs3_h2:
  v_lshlrev_b32 v73, 2, v76
  ds_read_b128 v[36:39], v76 offset:45056
  ds_read_b128 v[40:43], v76 offset:46080
  buffer_load_dwordx4 v[52:55], v76, s[8:11], s59 offen offset:0 sc1
  buffer_load_dwordx4 v[56:59], v76, s[8:11], s59 offen offset:1024 sc1
  s_waitcnt vmcnt(0)
  s_mov_b64 vcc, -1
Cs3_h2r:
  s_mov_b64 exec, vcc
  buffer_load_dwordx4 v[4:7], v76, s[8:11], s65 offen offset:1024 sc1
  buffer_load_dwordx4 v[0:3], v76, s[8:11], s85 offen offset:0 sc1
  buffer_load_dwordx4 v[8:11], v76, s[8:11], s85 offen offset:1024 sc1
  s_mov_b64 exec, -1
  s_add_u32 s67, s67, 1
  s_cmp_lt_u32 s67, 131072
  s_cselect_b32 s54, -2, -1
  s_waitcnt vmcnt(2)
  v_max3_u32 v72, v4, v5, v6
  s_waitcnt vmcnt(1)
  v_max3_u32 v72, v72, v7, v0
  v_max3_u32 v72, v72, v1, v2
  s_waitcnt vmcnt(0)
  v_max3_u32 v72, v72, v3, v8
  v_max3_u32 v72, v72, v9, v10
  v_max_u32 v72, v72, v11
  v_cmp_lt_u32 vcc, s54, v72
  s_cbranch_vccnz Cs3_h2r
  ds_write_b128 v76, v[4:7] offset:5632
  ds_write_b128 v76, v[0:3] offset:8704
  ds_write_b128 v76, v[8:11] offset:9728
Cs3_h2w:
  s_cmp_eq_u32 s66, 63
  s_waitcnt lgkmcnt(0)
  s_barrier
  ds_read_b128 v[8:11], v76 offset:6656
Cs3_top2:
  v_smfmac_f32_16x16x64_bf16 v[20:23], v[4:7], v[96:103], v74
  s_cbranch_scc1 Cs3_last
  v_smfmac_f32_16x16x64_bf16 v[28:31], v[4:7], v[36:43], v74
  buffer_load_dwordx4 v[44:47], v76, s[8:11], s58 offen offset:0 sc1
  s_mov_b32 m0, 15872
  v_smfmac_f32_16x16x64_bf16 v[24:27], v[4:7], v[104:111], v74
  buffer_load_dwordx4 v[48:51], v76, s[8:11], s58 offen offset:1024 sc1
  v_smfmac_f32_16x16x64_bf16 v[32:35], v[4:7], v[60:67], v74
  ds_read_b128 v[0:3], v76 offset:4608
  s_waitcnt lgkmcnt(1)
  v_smfmac_f32_16x16x64_bf16 v[20:23], v[8:11], v[112:119], v74
  ds_read_b128 v[12:15], v76 offset:7680
  v_smfmac_f32_16x16x64_bf16 v[24:27], v[8:11], v[120:127], v74
  ds_read_b128 v[36:39], v76 offset:28672
  v_smfmac_f32_16x16x64_bf16 v[28:31], v[8:11], v[208:215], v74
  buffer_store_dwordx4 v[16:19], v76, s[8:11], s68 offen sc1
  ds_read_b128 v[40:43], v76 offset:29696
  v_smfmac_f32_16x16x64_bf16 v[32:35], v[8:11], v[216:223], v74
  buffer_load_dword v73, s[16:19], s70 offen lds
  ds_read_b128 v[60:63], v76 offset:30720
  s_waitcnt lgkmcnt(4)
  v_smfmac_f32_16x16x64_bf16 v[20:23], v[0:3], v[80:87], v74
  ds_read_b128 v[64:67], v76 offset:31744
  v_smfmac_f32_16x16x64_bf16 v[24:27], v[0:3], v[88:95], v74
  s_waitcnt vmcnt(4)
  s_waitcnt lgkmcnt(4)
  v_smfmac_f32_16x16x64_bf16 v[20:23], v[12:15], v[128:135], v74
  s_barrier
  ds_read_b128 v[4:7], v76 offset:8704
  s_waitcnt lgkmcnt(3)
  v_smfmac_f32_16x16x64_bf16 v[28:31], v[0:3], v[36:43], v74
  ds_read_b128 v[36:39], v76 offset:61440
  v_smfmac_f32_16x16x64_bf16 v[24:27], v[12:15], v[136:143], v74
  ds_read_b128 v[40:43], v76 offset:62464
  s_waitcnt lgkmcnt(3)
  v_smfmac_f32_16x16x64_bf16 v[32:35], v[0:3], v[60:67], v74
  ds_read_b128 v[8:11], v76 offset:9728
  v_smfmac_f32_16x16x64_bf16 v[28:31], v[12:15], v[224:231], v74
  ds_read_b128 v[60:63], v76 offset:63488
  v_smfmac_f32_16x16x64_bf16 v[32:35], v[12:15], v[232:239], v74
  ds_read_b128 v[64:67], v76 offset:64512
  s_waitcnt lgkmcnt(5)
  v_smfmac_f32_16x16x64_bf16 v[20:23], v[4:7], v[144:151], v74
  s_barrier
  ds_read_b128 v[0:3], v76 offset:11776
  s_waitcnt lgkmcnt(4)
  v_smfmac_f32_16x16x64_bf16 v[28:31], v[4:7], v[36:43], v74
  ds_read_b128 v[12:15], v76 offset:12800
  ds_read_b128 v[36:39], v75 offset:12288
  v_smfmac_f32_16x16x64_bf16 v[24:27], v[4:7], v[152:159], v74
  ds_read_b128 v[16:19], v76 offset:10752
  s_waitcnt lgkmcnt(6)
  v_smfmac_f32_16x16x64_bf16 v[20:23], v[8:11], v[160:167], v74
  ds_read_b128 v[40:43], v75 offset:13312
  s_waitcnt lgkmcnt(5)
  v_smfmac_f32_16x16x64_bf16 v[32:35], v[4:7], v[60:67], v74
  ds_read_b128 v[60:63], v75 offset:14336
  v_smfmac_f32_16x16x64_bf16 v[24:27], v[8:11], v[168:175], v74
  ds_read_b128 v[64:67], v75 offset:15360
  s_waitcnt lgkmcnt(6)
  v_smfmac_f32_16x16x64_bf16 v[20:23], v[0:3], v[176:183], v74
  s_waitcnt lgkmcnt(5)
  v_smfmac_f32_16x16x64_bf16 v[20:23], v[12:15], v[192:199], v74
  s_waitcnt lgkmcnt(2)
  v_smfmac_f32_16x16x64_bf16 v[20:23], v[16:19], v[36:43], v74
  ds_read_b128 v[36:39], v75 offset:28672
  v_smfmac_f32_16x16x64_bf16 v[24:27], v[0:3], v[184:191], v74
  ds_read_b128 v[40:43], v75 offset:29696
  s_waitcnt lgkmcnt(2)
  v_smfmac_f32_16x16x64_bf16 v[24:27], v[16:19], v[60:67], v74
  ds_read_b128 v[60:63], v75 offset:30720
  v_add_f32 v20, v20, v22
  v_smfmac_f32_16x16x64_bf16 v[24:27], v[12:15], v[200:207], v74
  ds_read_b128 v[64:67], v75 offset:31744
  v_add_f32 v21, v21, v23
  v_smfmac_f32_16x16x64_bf16 v[28:31], v[16:19], v[240:247], v74
  v_mov_b64 v[70:71], s[78:79]
  v_smfmac_f32_16x16x64_bf16 v[28:31], v[0:3], a[0:7], v74
  s_waitcnt lgkmcnt(2)
  v_add_f32 v24, v24, v26
  v_smfmac_f32_16x16x64_bf16 v[28:31], v[8:11], v[36:43], v74
  ds_read_b128 v[36:39], v68
  v_cvt_pk_bf16_f32 v22, v20, v24
  v_smfmac_f32_16x16x64_bf16 v[28:31], v[12:15], a[16:23], v74
  ds_read_b128 v[40:43], v68
  ds_write_b32 v79, v22 offset:0
  s_waitcnt lgkmcnt(3)
  v_add_f32 v25, v25, v27
  v_cvt_pk_bf16_f32 v23, v21, v25
  v_smfmac_f32_16x16x64_bf16 v[32:35], v[8:11], v[60:67], v74
  ds_write_b32 v79, v23 offset:576
  v_cmp_u_f32 vcc, v20, v21
  v_smfmac_f32_16x16x64_bf16 v[32:35], v[16:19], v[248:255], v74
  v_add_f32 v28, v28, v30
  v_smfmac_f32_16x16x64_bf16 v[32:35], v[0:3], a[8:15], v74
  v_add_f32 v29, v29, v31
  v_smfmac_f32_16x16x64_bf16 v[32:35], v[12:15], a[24:31], v74
  s_cbranch_vccnz Cs3_rec
Cs3_recok:
  s_waitcnt lgkmcnt(3)
  v_smfmac_f32_16x16x64_bf16 v[36:39], v[16:19], a[128:135], v74
  s_waitcnt lgkmcnt(0)
  s_barrier
  ds_read_b128 v[60:63], v77
  v_smfmac_f32_16x16x64_bf16 v[40:43], v[16:19], a[136:143], v74
  ds_read_b128 v[64:67], v77 offset:128
  v_add_f32 v32, v32, v34
  v_cvt_pk_bf16_f32 v30, v28, v32
  v_smfmac_f32_16x16x64_bf16 v[36:39], v[0:3], a[144:151], v74
  ds_write_b32 v79, v30 offset:256
  v_add_f32 v33, v33, v35
  v_cvt_pk_bf16_f32 v31, v29, v33
  v_smfmac_f32_16x16x64_bf16 v[40:43], v[0:3], a[152:159], v74
  ds_write_b32 v79, v31 offset:832
  v_xor_b32 v75, 0x8000, v75
  v_smfmac_f32_16x16x64_bf16 v[36:39], v[4:7], a[96:103], v74
  ds_read_b128 v[0:3], v76 offset:4608
  v_mov_b32 v29, 0
  v_smfmac_f32_16x16x64_bf16 v[40:43], v[4:7], a[104:111], v74
  s_waitcnt vmcnt(2) lgkmcnt(3)
  v_mov_b32 v30, 0
  v_mfma_f32_16x16x32_bf16 v[44:47], v[44:47], v[60:63], 0
  ds_read_b128 v[4:7], v76 offset:5632
  s_waitcnt lgkmcnt(2)
  v_mfma_f32_16x16x32_bf16 v[44:47], v[48:51], v[64:67], v[44:47]
  s_barrier
  v_smfmac_f32_16x16x64_bf16 v[36:39], v[8:11], a[112:119], v74
  ds_read_b128 v[20:23], v77 offset:256
  ds_read_b128 v[24:27], v77 offset:384
  v_smfmac_f32_16x16x64_bf16 v[40:43], v[8:11], a[120:127], v74
  ds_read_b128 v[8:11], v76 offset:6656
  v_add_f32_dpp v72, v46, v44 quad_perm:[2,3,0,1] row_mask:0xf bank_mask:0xf
  v_add_f32_dpp v73, v47, v45 quad_perm:[2,3,0,1] row_mask:0xf bank_mask:0xf
  v_smfmac_f32_16x16x64_bf16 v[36:39], v[12:15], a[160:167], v74
  s_waitcnt lgkmcnt(4)
  v_exp_f32_dpp v72, v72 quad_perm:[0,1,0,1] row_mask:0xf bank_mask:0xf
  v_smfmac_f32_16x16x64_bf16 v[40:43], v[12:15], a[168:175], v74
  ds_read_b128 v[12:15], v76 offset:7680
  v_exp_f32_dpp v73, v73 quad_perm:[0,1,0,1] row_mask:0xf bank_mask:0xf
  v_smfmac_f32_16x16x64_bf16 v[36:39], v[0:3], a[32:39], v74
  s_waitcnt lgkmcnt(2)
  v_cvt_pk_bf16_f32 v72, v72, v73
  v_mfma_f32_16x16x32_bf16 v[20:23], v[20:23], v[60:63], 0
  ds_write_b32 v78, v72 offset:524
  v_mov_b64 v[16:17], 0
  v_mfma_f32_16x16x32_bf16 v[20:23], v[24:27], v[64:67], v[20:23]
  ds_read_b128 v[44:47], v75 offset:47104
  v_mov_b64 v[18:19], 0
  v_smfmac_f32_16x16x64_bf16 v[40:43], v[0:3], a[40:47], v74
  ds_read_b128 v[48:51], v75 offset:48128
  v_mov_b64 v[68:69], s[78:79]
  v_smfmac_f32_16x16x64_bf16 v[36:39], v[4:7], a[48:55], v74
  s_waitcnt lgkmcnt(4)
  v_add_f32_dpp v24, v22, v20 quad_perm:[2,3,0,1] row_mask:0xf bank_mask:0xf
  v_add_f32_dpp v25, v23, v21 quad_perm:[2,3,0,1] row_mask:0xf bank_mask:0xf
  v_smfmac_f32_16x16x64_bf16 v[36:39], v[8:11], a[64:71], v74
  s_waitcnt lgkmcnt(2)
  s_barrier
  ds_read_b128 v[32:35], v78 offset:512
  v_smfmac_f32_16x16x64_bf16 v[36:39], v[12:15], a[80:87], v74
  ds_read_b128 v[60:63], v75 offset:28672
  v_mul_f32 v24, s69, v24
  v_smfmac_f32_16x16x64_bf16 v[40:43], v[4:7], a[56:63], v74
  ds_read_b128 v[64:67], v75 offset:29696
  v_mul_f32 v25, s69, v25
  v_smfmac_f32_16x16x64_bf16 v[40:43], v[8:11], a[72:79], v74
  v_exp_f32_dpp v24, v24 quad_perm:[0,1,0,1] row_mask:0xf bank_mask:0xf
  v_smfmac_f32_16x16x64_bf16 v[40:43], v[12:15], a[88:95], v74
  s_waitcnt lgkmcnt(2)
  v_exp_f32_dpp v25, v25 quad_perm:[0,1,0,1] row_mask:0xf bank_mask:0xf
  v_mfma_f32_16x16x32_bf16 v[8:11], v[32:35], v[68:71], 0
  v_add_f32 v36, v36, v38
  v_add_f32 v37, v37, v39
  v_mfma_f32_16x16x32_bf16 v[0:3], v[32:35], v[52:55], 0
  v_add_f32 v40, v40, v42
  v_add_f32 v41, v41, v43
  v_mfma_f32_16x16x32_bf16 v[4:7], v[32:35], v[56:59], 0
  v_cvt_pk_bf16_f32 v28, v24, v25
  v_cvt_pk_bf16_f32 v72, v36, v37
  v_cvt_pk_bf16_f32 v73, v40, v41
  v_mfma_f32_16x16x16_bf16 v[8:11], v[28:29], v[68:69], v[8:11]
  v_cvt_pk_bf16_f32 v31, v24, v25
  v_mov_b64 v[20:21], 0
  v_mfma_f32_16x16x16_bf16 v[0:3], v[28:29], v[72:73], v[0:3]
  ds_read_b128 v[52:55], v75 offset:30720
  v_mov_b64 v[22:23], 0
  v_mfma_f32_16x16x16_bf16 v[4:7], v[30:31], v[72:73], v[4:7]
  v_rcp_f32 v10, v8
  v_rcp_f32 v11, v9
  v_mul_f32 v0, v10, v0
  v_mul_f32 v1, v11, v1
  v_max3_f32 v8, v8, v9, v10
  v_mul_f32 v4, v10, v4
  v_mul_f32 v5, v11, v5
  v_cvt_pk_bf16_f32 v2, v0, v4
  ds_write_b32 v79, v2 offset:8704
  v_cvt_pk_bf16_f32 v3, v1, v5
  ds_write_b32 v79, v3 offset:9280
  ds_read_b128 v[12:15], v78 offset:8896
  v_max_f32 v8, v8, v11
  v_cmp_le_f32 vcc, 1317011456, v8
  v_mov_b64 v[24:25], 0
  v_mov_b64 v[26:27], 0
  ds_read_b128 v[56:59], v75 offset:31744
  s_cbranch_vccnz Cs3_mx
Cs3_mxok:
  s_waitcnt lgkmcnt(2)
  s_barrier
  ds_read_b128 v[0:3], v78 offset:8832
  s_waitcnt lgkmcnt(2)
  v_smfmac_f32_16x16x64_bf16 v[16:19], v[12:15], a[184:191], v74
  ds_read_b128 v[4:7], v78 offset:8704
  v_smfmac_f32_16x16x64_bf16 v[20:23], v[12:15], v[44:51], v74
  ds_read_b128 v[8:11], v78 offset:8768
  v_smfmac_f32_16x16x64_bf16 v[24:27], v[12:15], a[232:239], v74
  ds_read_b128 v[36:39], v75 offset:45056
  s_waitcnt lgkmcnt(3)
  v_smfmac_f32_16x16x64_bf16 v[16:19], v[0:3], a[176:183], v74
  ds_read_b128 v[40:43], v75 offset:46080
  s_waitcnt lgkmcnt(3)
  v_smfmac_f32_16x16x64_bf16 v[16:19], v[4:7], v[60:67], v74
  ds_read_b128 v[68:71], v76 offset:13824
  s_waitcnt lgkmcnt(3)
  v_smfmac_f32_16x16x64_bf16 v[16:19], v[8:11], v[52:59], v74
  ds_read_b128 v[44:47], v75 offset:61440
  v_smfmac_f32_16x16x64_bf16 v[20:23], v[4:7], a[192:199], v74
  ds_read_b128 v[48:51], v75 offset:62464
  v_smfmac_f32_16x16x64_bf16 v[20:23], v[8:11], a[200:207], v74
  ds_read_b128 v[60:63], v75 offset:63488
  s_waitcnt lgkmcnt(4)
  v_cvt_pk_bf16_f32 v16, v16, v17
  v_cvt_pk_bf16_f32 v17, v18, v19
  v_bfi_b32 v16, 1, s72, v16
  v_smfmac_f32_16x16x64_bf16 v[20:23], v[0:3], v[36:43], v74
  s_waitcnt lgkmcnt(3)
  buffer_store_dwordx2 v[16:17], v68, s[8:11], s73 offen sc1
  v_mov_b64 v[32:33], 0
  v_smfmac_f32_16x16x64_bf16 v[24:27], v[4:7], a[208:215], v74
  ds_read_b128 v[64:67], v75 offset:64512
  v_mov_b64 v[34:35], 0
  v_smfmac_f32_16x16x64_bf16 v[24:27], v[8:11], a[216:223], v74
  ds_read_b128 v[52:55], v75 offset:8192
  v_cvt_pk_bf16_f32 v20, v20, v21
  v_cvt_pk_bf16_f32 v21, v22, v23
  v_bfi_b32 v20, 1, s72, v20
  v_smfmac_f32_16x16x64_bf16 v[24:27], v[0:3], a[224:231], v74
  ds_read_b128 v[56:59], v75 offset:9216
  buffer_store_dwordx2 v[20:21], v68, s[8:11], s74 offen sc1
  s_waitcnt lgkmcnt(4)
  v_mov_b64 v[28:29], 0
  v_smfmac_f32_16x16x64_bf16 v[32:35], v[4:7], v[44:51], v74
  ds_read_b128 v[36:39], v75 offset:10240
  ds_read_b128 v[40:43], v75 offset:11264
  s_waitcnt lgkmcnt(4)
  v_smfmac_f32_16x16x64_bf16 v[32:35], v[8:11], v[60:67], v74
  ds_read_b128 v[44:47], v75 offset:12288
  v_cvt_pk_bf16_f32 v24, v24, v25
  v_cvt_pk_bf16_f32 v25, v26, v27
  v_bfi_b32 v24, 1, s72, v24
  v_smfmac_f32_16x16x64_bf16 v[32:35], v[0:3], a[240:247], v74
  ds_read_b128 v[48:51], v75 offset:13312
  buffer_store_dwordx2 v[24:25], v68, s[8:11], s75 offen sc1
  v_mov_b64 v[30:31], 0
  v_smfmac_f32_16x16x64_bf16 v[32:35], v[12:15], a[248:255], v74
  ds_read_b128 v[60:63], v75 offset:14336
  ds_read_b128 v[64:67], v75 offset:15360
  s_waitcnt lgkmcnt(6)
  v_smfmac_f32_16x16x64_bf16 v[28:31], v[4:7], v[52:59], v74
  s_waitcnt lgkmcnt(4)
  v_smfmac_f32_16x16x64_bf16 v[28:31], v[8:11], v[36:43], v74
  s_waitcnt lgkmcnt(2)
  v_cvt_pk_bf16_f32 v32, v32, v33
  v_cvt_pk_bf16_f32 v33, v34, v35
  v_bfi_b32 v32, 1, s72, v32
  v_smfmac_f32_16x16x64_bf16 v[28:31], v[0:3], v[44:51], v74
  buffer_store_dwordx2 v[32:33], v68, s[8:11], s76 offen sc1
  s_waitcnt lgkmcnt(0)
  v_smfmac_f32_16x16x64_bf16 v[28:31], v[12:15], v[60:67], v74
  v_mov_b64 v[18:19], v[72:73]
  s_nop 4
  v_cvt_pk_bf16_f32 v28, v28, v29
  v_cvt_pk_bf16_f32 v29, v30, v31
  v_bfi_b32 v28, 1, s72, v28
  buffer_store_dwordx2 v[28:29], v68, s[8:11], s77 offen sc1
  ds_read_b128 v[52:55], v76 offset:14848
  s_waitcnt lgkmcnt(0)
  ds_read_b64 v[16:17], v77 offset:392
  s_waitcnt lgkmcnt(0)
  ds_read_b128 v[60:63], v76 offset:47104
  s_waitcnt lgkmcnt(0)
  ds_read_b128 v[64:67], v76 offset:48128
  s_waitcnt lgkmcnt(0)
  s_add_u32 s66, s66, 1
  s_xor_b32 s64, s64, 16384
  s_xor_b32 s65, s65, 16384
  s_add_u32 s58, s58, 655360
  s_add_u32 s59, s59, 655360
  s_add_u32 s70, s70, 655360
  s_add_u32 s68, s68, 655360
  s_mov_b32 m0, 8704
  s_add_u32 s85, s65, 4096
  v_xor_b32 v75, 0x8000, v75
  v_mov_b64 v[28:29], 0
  v_mov_b64 v[30:31], 0
  v_mov_b64 v[32:33], 0
  v_mov_b64 v[34:35], 0
  s_waitcnt vmcnt(0)
  buffer_load_dwordx4 v[0:3], v76, s[8:11], s60 offen offset:0 sc1
  buffer_load_dwordx4 v[4:7], v76, s[8:11], s60 offen offset:1024 sc1
  buffer_load_dwordx4 v[8:11], v76, s[8:11], s61 offen offset:0 sc1
  buffer_load_dwordx4 v[12:15], v76, s[8:11], s61 offen offset:1024 sc1
  v_mov_b64 v[20:21], 0
  v_mov_b64 v[22:23], 0
  v_mov_b64 v[24:25], 0
  v_mov_b64 v[26:27], 0
  v_mov_b32 v68, 14880
  s_cmp_eq_u32 s66, 62
  s_cselect_b64 s[16:17], s[20:21], s[16:17]
  s_cselect_b32 s18, (Cs3_done - Cs3_last), s18
  s_cselect_b32 s70, 0, s70
  s_cmp_eq_u32 s66, 63
  s_cselect_b32 s59, 268435456, s59
  s_cselect_b32 s58, 268435456, s58
  s_waitcnt lgkmcnt(0)
  s_waitcnt vmcnt(3)
  v_mfma_f32_16x16x32_bf16 v[56:59], v[52:55], v[0:3], 0
  v_bitop3_b32 v72, v0, v2, s72 bitop3:0x7e
  s_waitcnt vmcnt(2)
  v_mfma_f32_16x16x32_bf16 v[56:59], v[52:55], v[4:7], v[56:59]
  v_bitop3_b32 v73, v4, v6, s72 bitop3:0x7e
  v_or_b32 v72, v72, v73
  s_waitcnt vmcnt(1)
  v_mfma_f32_16x16x32_bf16 v[36:39], v[52:55], v[8:11], 0
  v_bitop3_b32 v73, v8, v10, s72 bitop3:0x7e
  v_or_b32 v72, v72, v73
  s_waitcnt vmcnt(0)
  v_mfma_f32_16x16x32_bf16 v[36:39], v[52:55], v[12:15], v[36:39]
  v_bitop3_b32 v73, v12, v14, s72 bitop3:0x7e
  v_bitop3_b32 v72, v72, v73, 1 bitop3:0xa8
  v_cmp_ne_u32 vcc, 0, v72
  s_cbranch_vccnz Cs3_h1r
  v_add_f32_dpp v56, v56, v56 row_ror:4 row_mask:0xf bank_mask:0xf
  v_add_f32_dpp v57, v57, v57 row_ror:4 row_mask:0xf bank_mask:0xf
  s_nop 0
  v_add_f32_dpp v36, v36, v36 row_ror:4 row_mask:0xf bank_mask:0xf
  v_add_f32_dpp v37, v37, v37 row_ror:4 row_mask:0xf bank_mask:0xf
  v_add_f32_dpp v56, v56, v56 row_ror:8 row_mask:0xf bank_mask:0xf
  v_add_f32_dpp v57, v57, v57 row_ror:8 row_mask:0xf bank_mask:0xf
  v_add_f32_dpp v36, v36, v36 row_ror:8 row_mask:0xf bank_mask:0xf
  v_add_f32_dpp v37, v37, v37 row_ror:8 row_mask:0xf bank_mask:0xf
  v_cvt_pk_bf16_f32 v56, v56, v57
  buffer_store_dword v56, v69, s[8:11], s62 offen sc1
  v_cvt_pk_bf16_f32 v36, v36, v37
  buffer_store_dword v36, v70, s[8:11], s63 offen sc1
  s_xor_b32 s62, s62, 16384
  buffer_store_dword v71, v69, s[8:11], s62 offen sc1
  s_xor_b32 s63, s63, 16384
  buffer_store_dword v71, v70, s[8:11], s63 offen sc1
  s_xor_b32 s72, s72, 1
  s_branch Cs3_h2
Cs3_h1r:
  s_mov_b64 exec, vcc
  buffer_load_dwordx4 v[0:3], v76, s[8:11], s60 offen offset:0 sc1
  buffer_load_dwordx4 v[4:7], v76, s[8:11], s60 offen offset:1024 sc1
  buffer_load_dwordx4 v[8:11], v76, s[8:11], s61 offen offset:0 sc1
  buffer_load_dwordx4 v[12:15], v76, s[8:11], s61 offen offset:1024 sc1
  s_mov_b64 exec, -1
  s_add_u32 s67, s67, 1
  s_waitcnt vmcnt(3)
  v_mfma_f32_16x16x32_bf16 v[56:59], v[52:55], v[0:3], 0
  v_bitop3_b32 v72, v0, v2, s72 bitop3:0x7e
  s_waitcnt vmcnt(2)
  v_mfma_f32_16x16x32_bf16 v[56:59], v[52:55], v[4:7], v[56:59]
  v_bitop3_b32 v73, v4, v6, s72 bitop3:0x7e
  v_or_b32 v72, v72, v73
  s_waitcnt vmcnt(1)
  v_mfma_f32_16x16x32_bf16 v[36:39], v[52:55], v[8:11], 0
  v_bitop3_b32 v73, v8, v10, s72 bitop3:0x7e
  v_or_b32 v72, v72, v73
  s_waitcnt vmcnt(0)
  v_mfma_f32_16x16x32_bf16 v[36:39], v[52:55], v[12:15], v[36:39]
  v_bitop3_b32 v73, v12, v14, s72 bitop3:0x7e
  v_bitop3_b32 v72, v72, v73, 1 bitop3:0xa8
  v_cmp_ne_u32 vcc, 0, v72
  s_cbranch_vccz Cs3_h1p
Cs3_h1s:
  s_mov_b64 exec, vcc
  buffer_load_dwordx4 v[0:3], v76, s[8:11], s60 offen offset:0 sc1
  buffer_load_dwordx4 v[4:7], v76, s[8:11], s60 offen offset:1024 sc1
  buffer_load_dwordx4 v[8:11], v76, s[8:11], s61 offen offset:0 sc1
  buffer_load_dwordx4 v[12:15], v76, s[8:11], s61 offen offset:1024 sc1
  s_mov_b64 exec, -1
  s_add_u32 s67, s67, 1
  s_waitcnt vmcnt(3)
  v_mfma_f32_16x16x32_bf16 v[56:59], v[52:55], v[0:3], 0
  v_bitop3_b32 v72, v0, v2, s72 bitop3:0x7e
  s_waitcnt vmcnt(2)
  v_mfma_f32_16x16x32_bf16 v[56:59], v[52:55], v[4:7], v[56:59]
  v_bitop3_b32 v73, v4, v6, s72 bitop3:0x7e
  v_or_b32 v72, v72, v73
  s_waitcnt vmcnt(1)
  v_mfma_f32_16x16x32_bf16 v[36:39], v[52:55], v[8:11], 0
  v_bitop3_b32 v73, v8, v10, s72 bitop3:0x7e
  v_or_b32 v72, v72, v73
  s_waitcnt vmcnt(0)
  v_mfma_f32_16x16x32_bf16 v[36:39], v[52:55], v[12:15], v[36:39]
  v_bitop3_b32 v73, v12, v14, s72 bitop3:0x7e
  v_bitop3_b32 v72, v72, v73, 1 bitop3:0xa8
  v_cmp_ne_u32 vcc, 0, v72
  s_cbranch_vccz Cs3_h1p
  s_cmp_lt_u32 s67, 131072
  s_cbranch_scc1 Cs3_h1s
Cs3_h1p:
  s_nop 2
  v_add_f32_dpp v56, v56, v56 row_ror:4 row_mask:0xf bank_mask:0xf
  v_add_f32_dpp v57, v57, v57 row_ror:4 row_mask:0xf bank_mask:0xf
  v_add_f32_dpp v36, v36, v36 row_ror:4 row_mask:0xf bank_mask:0xf
  v_add_f32_dpp v37, v37, v37 row_ror:4 row_mask:0xf bank_mask:0xf
  v_add_f32_dpp v56, v56, v56 row_ror:8 row_mask:0xf bank_mask:0xf
  v_add_f32_dpp v57, v57, v57 row_ror:8 row_mask:0xf bank_mask:0xf
  v_add_f32_dpp v36, v36, v36 row_ror:8 row_mask:0xf bank_mask:0xf
  v_add_f32_dpp v37, v37, v37 row_ror:8 row_mask:0xf bank_mask:0xf
  v_cvt_pk_bf16_f32 v56, v56, v57
  buffer_store_dword v56, v69, s[8:11], s62 offen sc1
  v_cvt_pk_bf16_f32 v36, v36, v37
  buffer_store_dword v36, v70, s[8:11], s63 offen sc1
  s_xor_b32 s62, s62, 16384
  buffer_store_dword v71, v69, s[8:11], s62 offen sc1
  s_xor_b32 s63, s63, 16384
  buffer_store_dword v71, v70, s[8:11], s63 offen sc1
  s_xor_b32 s72, s72, 1
  s_branch Cs3_h2
Cs3_rec:
  s_nop 7
  s_waitcnt vmcnt(0) lgkmcnt(0)
  v_max3_u32 v72, v0, v1, v2
  v_max3_u32 v72, v72, v3, v4
  v_max3_u32 v72, v72, v5, v6
  v_max3_u32 v72, v72, v7, v8
  v_max3_u32 v72, v72, v9, v10
  v_max3_u32 v72, v72, v11, v12
  v_max3_u32 v72, v72, v13, v14
  v_max3_u32 v72, v72, v15, v16
  v_max3_u32 v72, v72, v17, v18
  v_max_u32 v72, v72, v19
  v_cmp_eq_u32 vcc, -1, v72
  s_cbranch_vccz Cs3_recok
  s_barrier
Cs3_recp:
  buffer_load_dwordx4 v[0:3], v76, s[8:11], s64 offen offset:0 sc1
  buffer_load_dwordx4 v[4:7], v76, s[8:11], s64 offen offset:1024 sc1
  buffer_load_dwordx4 v[8:11], v76, s[8:11], s64 offen offset:2048 sc1
  s_add_u32 s67, s67, 1
  s_cmp_lt_u32 s67, 131072
  s_cselect_b32 s54, -2, -1
  s_waitcnt vmcnt(2)
  v_max3_u32 v72, v0, v1, v2
  s_waitcnt vmcnt(1)
  v_max3_u32 v72, v72, v3, v4
  v_max3_u32 v72, v72, v5, v6
  s_waitcnt vmcnt(0)
  v_max3_u32 v72, v72, v7, v8
  v_max3_u32 v72, v72, v9, v10
  v_max_u32 v72, v72, v11
  v_cmp_lt_u32 vcc, s54, v72
  s_cbranch_vccnz Cs3_recp
  ds_write_b128 v76, v[0:3] offset:10752
  ds_write_b128 v76, v[4:7] offset:11776
  ds_write_b128 v76, v[8:11] offset:12800
  v_mov_b64 v[20:21], 0
  v_mov_b64 v[22:23], 0
  v_mov_b64 v[24:25], 0
  v_mov_b64 v[26:27], 0
  v_mov_b64 v[28:29], 0
  v_mov_b64 v[30:31], 0
  v_mov_b64 v[32:33], 0
  v_mov_b64 v[34:35], 0
  s_waitcnt lgkmcnt(0)
  s_barrier
  ds_read_b128 v[0:3], v76 offset:4608
  s_waitcnt lgkmcnt(0)
  v_smfmac_f32_16x16x64_bf16 v[20:23], v[0:3], v[80:87], v74
  v_smfmac_f32_16x16x64_bf16 v[24:27], v[0:3], v[88:95], v74
  ds_read_b128 v[60:63], v76 offset:28672
  ds_read_b128 v[64:67], v76 offset:29696
  s_waitcnt lgkmcnt(0)
  v_smfmac_f32_16x16x64_bf16 v[28:31], v[0:3], v[60:67], v74
  ds_read_b128 v[60:63], v76 offset:30720
  ds_read_b128 v[64:67], v76 offset:31744
  s_waitcnt lgkmcnt(0)
  v_smfmac_f32_16x16x64_bf16 v[32:35], v[0:3], v[60:67], v74
  ds_read_b128 v[4:7], v76 offset:5632
  s_waitcnt lgkmcnt(0)
  v_smfmac_f32_16x16x64_bf16 v[20:23], v[4:7], v[96:103], v74
  v_smfmac_f32_16x16x64_bf16 v[24:27], v[4:7], v[104:111], v74
  ds_read_b128 v[60:63], v76 offset:45056
  ds_read_b128 v[64:67], v76 offset:46080
  s_waitcnt lgkmcnt(0)
  v_smfmac_f32_16x16x64_bf16 v[28:31], v[4:7], v[60:67], v74
  ds_read_b128 v[60:63], v76 offset:47104
  ds_read_b128 v[64:67], v76 offset:48128
  s_waitcnt lgkmcnt(0)
  v_smfmac_f32_16x16x64_bf16 v[32:35], v[4:7], v[60:67], v74
  ds_read_b128 v[8:11], v76 offset:6656
  s_waitcnt lgkmcnt(0)
  v_smfmac_f32_16x16x64_bf16 v[20:23], v[8:11], v[112:119], v74
  v_smfmac_f32_16x16x64_bf16 v[24:27], v[8:11], v[120:127], v74
  v_smfmac_f32_16x16x64_bf16 v[28:31], v[8:11], v[208:215], v74
  v_smfmac_f32_16x16x64_bf16 v[32:35], v[8:11], v[216:223], v74
  ds_read_b128 v[12:15], v76 offset:7680
  s_waitcnt lgkmcnt(0)
  v_smfmac_f32_16x16x64_bf16 v[20:23], v[12:15], v[128:135], v74
  v_smfmac_f32_16x16x64_bf16 v[24:27], v[12:15], v[136:143], v74
  v_smfmac_f32_16x16x64_bf16 v[28:31], v[12:15], v[224:231], v74
  v_smfmac_f32_16x16x64_bf16 v[32:35], v[12:15], v[232:239], v74
  ds_read_b128 v[4:7], v76 offset:8704
  s_waitcnt lgkmcnt(0)
  v_smfmac_f32_16x16x64_bf16 v[20:23], v[4:7], v[144:151], v74
  v_smfmac_f32_16x16x64_bf16 v[24:27], v[4:7], v[152:159], v74
  ds_read_b128 v[60:63], v76 offset:61440
  ds_read_b128 v[64:67], v76 offset:62464
  s_waitcnt lgkmcnt(0)
  v_smfmac_f32_16x16x64_bf16 v[28:31], v[4:7], v[60:67], v74
  ds_read_b128 v[60:63], v76 offset:63488
  ds_read_b128 v[64:67], v76 offset:64512
  s_waitcnt lgkmcnt(0)
  v_smfmac_f32_16x16x64_bf16 v[32:35], v[4:7], v[60:67], v74
  ds_read_b128 v[8:11], v76 offset:9728
  s_waitcnt lgkmcnt(0)
  v_smfmac_f32_16x16x64_bf16 v[20:23], v[8:11], v[160:167], v74
  v_smfmac_f32_16x16x64_bf16 v[24:27], v[8:11], v[168:175], v74
  ds_read_b128 v[60:63], v75 offset:28672
  ds_read_b128 v[64:67], v75 offset:29696
  s_waitcnt lgkmcnt(0)
  v_smfmac_f32_16x16x64_bf16 v[28:31], v[8:11], v[60:67], v74
  ds_read_b128 v[60:63], v75 offset:30720
  ds_read_b128 v[64:67], v75 offset:31744
  s_waitcnt lgkmcnt(0)
  v_smfmac_f32_16x16x64_bf16 v[32:35], v[8:11], v[60:67], v74
  ds_read_b128 v[16:19], v76 offset:10752
  ds_read_b128 v[60:63], v75 offset:12288
  ds_read_b128 v[64:67], v75 offset:13312
  s_waitcnt lgkmcnt(0)
  v_smfmac_f32_16x16x64_bf16 v[20:23], v[16:19], v[60:67], v74
  ds_read_b128 v[60:63], v75 offset:14336
  ds_read_b128 v[64:67], v75 offset:15360
  s_waitcnt lgkmcnt(0)
  v_smfmac_f32_16x16x64_bf16 v[24:27], v[16:19], v[60:67], v74
  v_smfmac_f32_16x16x64_bf16 v[28:31], v[16:19], v[240:247], v74
  v_smfmac_f32_16x16x64_bf16 v[32:35], v[16:19], v[248:255], v74
  ds_read_b128 v[0:3], v76 offset:11776
  s_waitcnt lgkmcnt(0)
  v_smfmac_f32_16x16x64_bf16 v[20:23], v[0:3], v[176:183], v74
  v_smfmac_f32_16x16x64_bf16 v[24:27], v[0:3], v[184:191], v74
  v_smfmac_f32_16x16x64_bf16 v[28:31], v[0:3], a[0:7], v74
  v_smfmac_f32_16x16x64_bf16 v[32:35], v[0:3], a[8:15], v74
  ds_read_b128 v[12:15], v76 offset:12800
  s_waitcnt lgkmcnt(0)
  v_smfmac_f32_16x16x64_bf16 v[20:23], v[12:15], v[192:199], v74
  v_smfmac_f32_16x16x64_bf16 v[24:27], v[12:15], v[200:207], v74
  v_smfmac_f32_16x16x64_bf16 v[28:31], v[12:15], a[16:23], v74
  v_smfmac_f32_16x16x64_bf16 v[32:35], v[12:15], a[24:31], v74
  v_add_f32 v20, v20, v22
  v_add_f32 v21, v21, v23
  v_add_f32 v24, v24, v26
  v_cvt_pk_bf16_f32 v22, v20, v24
  ds_write_b32 v79, v22 offset:0
  v_add_f32 v25, v25, v27
  v_cvt_pk_bf16_f32 v23, v21, v25
  ds_write_b32 v79, v23 offset:576
  v_add_f32 v28, v28, v30
  v_add_f32 v29, v29, v31
  s_waitcnt lgkmcnt(0)
  s_nop 1
  s_branch Cs3_recok
Cs3_mx:
  s_waitcnt lgkmcnt(0)
  s_barrier
  buffer_load_dwordx4 v[52:55], v76, s[8:11], s59 offen offset:0 sc1
  buffer_load_dwordx4 v[0:3], v76, s[8:11], s58 offen offset:0 sc1
  ds_read_b128 v[20:23], v77 offset:0
  ds_read_b128 v[28:31], v77 offset:256
  buffer_load_dwordx4 v[56:59], v76, s[8:11], s59 offen offset:1024 sc1
  buffer_load_dwordx4 v[4:7], v76, s[8:11], s58 offen offset:1024 sc1
  ds_read_b128 v[24:27], v77 offset:128
  ds_read_b128 v[32:35], v77 offset:384
  s_waitcnt vmcnt(2) lgkmcnt(3)
  v_mfma_f32_16x16x32_bf16 v[8:11], v[0:3], v[20:23], 0
  s_waitcnt vmcnt(0) lgkmcnt(1)
  v_mfma_f32_16x16x32_bf16 v[8:11], v[4:7], v[24:27], v[8:11]
  v_mfma_f32_16x16x32_bf16 v[12:15], v[28:31], v[20:23], 0
  s_waitcnt lgkmcnt(0)
  v_mfma_f32_16x16x32_bf16 v[12:15], v[32:35], v[24:27], v[12:15]
  v_add_f32_dpp v8, v10, v8 quad_perm:[2,3,0,1] row_mask:0xf bank_mask:0xf
  v_add_f32_dpp v9, v11, v9 quad_perm:[2,3,0,1] row_mask:0xf bank_mask:0xf
  s_nop 0
  v_mov_b32_dpp v8, v8 quad_perm:[0,1,0,1] row_mask:0xf bank_mask:0xf
  v_mov_b32_dpp v9, v9 quad_perm:[0,1,0,1] row_mask:0xf bank_mask:0xf
  s_nop 1
  v_add_f32_dpp v12, v14, v12 quad_perm:[2,3,0,1] row_mask:0xf bank_mask:0xf
  v_add_f32_dpp v13, v15, v13 quad_perm:[2,3,0,1] row_mask:0xf bank_mask:0xf
  s_nop 0
  v_mov_b32_dpp v12, v12 quad_perm:[0,1,0,1] row_mask:0xf bank_mask:0xf
  v_mov_b32_dpp v13, v13 quad_perm:[0,1,0,1] row_mask:0xf bank_mask:0xf
  v_mul_f32 v12, s69, v12
  ds_write_b32 v78, v8 offset:8716
  v_mul_f32 v13, s69, v13
  ds_write_b32 v78, v9 offset:8780
  s_waitcnt lgkmcnt(0)
  s_barrier
  ds_read_b128 v[36:39], v78 offset:8704
  ds_read_b128 v[40:43], v78 offset:8768
  s_waitcnt lgkmcnt(0)
  s_barrier
  v_max_f32 v16, v36, v37
  v_max3_f32 v16, v16, v38, v39
  v_max3_f32 v16, v16, v40, v41
  v_max3_f32 v16, v16, v42, v43
  v_max3_f32 v16, v16, v12, v13
  v_mov_b32 v17, v16
  s_nop 1
  v_permlane16_swap_b32 v16, v17
  v_max_f32 v16, v16, v17
  v_mov_b32 v17, v16
  s_nop 1
  v_permlane32_swap_b32 v16, v17
  v_max_f32 v16, v16, v17
  v_sub_f32 v36, v36, v16
  v_sub_f32 v37, v37, v16
  v_sub_f32 v38, v38, v16
  v_sub_f32 v39, v39, v16
  v_sub_f32 v40, v40, v16
  v_sub_f32 v41, v41, v16
  v_sub_f32 v42, v42, v16
  v_sub_f32 v43, v43, v16
  v_sub_f32 v12, v12, v16
  v_sub_f32 v13, v13, v16
  v_exp_f32 v36, v36
  v_exp_f32 v37, v37
  v_exp_f32 v38, v38
  v_exp_f32 v39, v39
  v_exp_f32 v40, v40
  v_exp_f32 v41, v41
  v_exp_f32 v42, v42
  v_exp_f32 v43, v43
  v_exp_f32 v12, v12
  v_exp_f32 v13, v13
  v_cvt_pk_bf16_f32 v32, v36, v40
  v_cvt_pk_bf16_f32 v33, v37, v41
  v_cvt_pk_bf16_f32 v34, v38, v42
  v_cvt_pk_bf16_f32 v35, v39, v43
  v_cvt_pk_bf16_f32 v28, v12, v13
  v_cvt_pk_bf16_f32 v31, v12, v13
  v_mov_b32 v29, 0
  v_mov_b32 v30, 0
  v_mfma_f32_16x16x32_bf16 v[8:11], v[32:35], v[68:71], 0
  v_mfma_f32_16x16x32_bf16 v[0:3], v[32:35], v[52:55], 0
  v_mfma_f32_16x16x32_bf16 v[4:7], v[32:35], v[56:59], 0
  v_mfma_f32_16x16x16_bf16 v[8:11], v[28:29], v[68:69], v[8:11]
  v_mfma_f32_16x16x16_bf16 v[0:3], v[28:29], v[72:73], v[0:3]
  v_mfma_f32_16x16x16_bf16 v[4:7], v[30:31], v[72:73], v[4:7]
  ds_read_b128 v[52:55], v75 offset:30720
  v_rcp_f32 v10, v8
  v_rcp_f32 v11, v9
  v_mul_f32 v0, v10, v0
  v_mul_f32 v1, v11, v1
  v_max3_f32 v8, v8, v9, v10
  v_mul_f32 v4, v10, v4
  v_mul_f32 v5, v11, v5
  v_cvt_pk_bf16_f32 v2, v0, v4
  ds_write_b32 v79, v2 offset:8704
  v_cvt_pk_bf16_f32 v3, v1, v5
  ds_write_b32 v79, v3 offset:9280
  ds_read_b128 v[12:15], v78 offset:8896
  ds_read_b128 v[56:59], v75 offset:31744
  v_mov_b64 v[16:17], 0
  v_mov_b64 v[18:19], 0
  v_mov_b64 v[20:21], 0
  v_mov_b64 v[22:23], 0
  v_mov_b64 v[24:25], 0
  v_mov_b64 v[26:27], 0
  s_branch Cs3_mxok
Cs3_last:
  ds_read_b128 v[0:3], v76 offset:4608
  ds_read_b128 v[12:15], v76 offset:7680
  ds_read_b128 v[44:47], v76 offset:28672
  ds_read_b128 v[48:51], v76 offset:29696
  s_nop 5
  v_mov_b64 v[20:21], 0
  v_mov_b64 v[22:23], 0
  v_mov_b64 v[24:25], 0
  v_mov_b64 v[26:27], 0
  v_smfmac_f32_16x16x64_bf16 v[28:31], v[4:7], v[36:43], v74
  ds_read_b128 v[36:39], v76 offset:30720
  ds_read_b128 v[40:43], v76 offset:31744
  v_smfmac_f32_16x16x64_bf16 v[32:35], v[4:7], v[60:67], v74
  s_waitcnt lgkmcnt(5)
  v_smfmac_f32_16x16x64_bf16 v[20:23], v[0:3], a[32:39], v74
  ds_read_b128 v[60:63], v76 offset:61440
  ds_read_b128 v[64:67], v76 offset:62464
  v_smfmac_f32_16x16x64_bf16 v[24:27], v[0:3], a[40:47], v74
  s_waitcnt lgkmcnt(4)
  v_smfmac_f32_16x16x64_bf16 v[20:23], v[4:7], a[48:55], v74
  buffer_store_dwordx4 v[16:19], v76, s[8:11], s68 offen sc1
  v_smfmac_f32_16x16x64_bf16 v[24:27], v[4:7], a[56:63], v74
  v_smfmac_f32_16x16x64_bf16 v[28:31], v[0:3], v[44:51], v74
  s_waitcnt lgkmcnt(2)
  v_smfmac_f32_16x16x64_bf16 v[20:23], v[8:11], a[64:71], v74
  ds_read_b128 v[44:47], v76 offset:63488
  ds_read_b128 v[48:51], v76 offset:64512
  v_smfmac_f32_16x16x64_bf16 v[24:27], v[8:11], a[72:79], v74
  v_smfmac_f32_16x16x64_bf16 v[32:35], v[0:3], v[36:43], v74
  v_smfmac_f32_16x16x64_bf16 v[28:31], v[8:11], v[208:215], v74
  ds_read_b128 v[36:39], v75 offset:28672
  ds_read_b128 v[40:43], v75 offset:29696
  v_smfmac_f32_16x16x64_bf16 v[32:35], v[8:11], v[216:223], v74
  v_smfmac_f32_16x16x64_bf16 v[20:23], v[12:15], a[80:87], v74
  v_smfmac_f32_16x16x64_bf16 v[24:27], v[12:15], a[88:95], v74
  v_smfmac_f32_16x16x64_bf16 v[28:31], v[12:15], v[224:231], v74
  v_smfmac_f32_16x16x64_bf16 v[32:35], v[12:15], v[232:239], v74
  s_waitcnt vmcnt(1)
  s_barrier
Cs3_lastr:
  ds_read_b128 v[4:7], v76 offset:8704
  ds_read_b128 v[8:11], v76 offset:9728
  ds_read_b128 v[16:19], v76 offset:10752
  ds_read_b128 v[0:3], v76 offset:11776
  ds_read_b128 v[12:15], v76 offset:12800
  s_waitcnt lgkmcnt(1)
  v_max3_u32 v72, v0, v1, v2
  v_max3_u32 v72, v72, v3, v4
  v_max3_u32 v72, v72, v5, v6
  v_max3_u32 v72, v72, v7, v8
  v_max3_u32 v72, v72, v9, v10
  s_waitcnt lgkmcnt(0)
  v_max3_u32 v72, v72, v11, v12
  v_max3_u32 v72, v72, v13, v14
  v_max3_u32 v72, v72, v15, v16
  v_max3_u32 v72, v72, v17, v18
  v_max_u32 v72, v72, v19
  v_cmp_eq_u32 vcc, -1, v72
  s_cbranch_vccnz Cs3_lastp
Cs3_lastg:
  v_smfmac_f32_16x16x64_bf16 v[28:31], v[4:7], v[60:67], v74
  ds_read_b128 v[60:63], v75 offset:30720
  ds_read_b128 v[64:67], v75 offset:31744
  v_smfmac_f32_16x16x64_bf16 v[32:35], v[4:7], v[44:51], v74
  v_smfmac_f32_16x16x64_bf16 v[28:31], v[8:11], v[36:43], v74
  v_smfmac_f32_16x16x64_bf16 v[28:31], v[16:19], v[240:247], v74
  v_smfmac_f32_16x16x64_bf16 v[28:31], v[0:3], a[0:7], v74
  v_smfmac_f32_16x16x64_bf16 v[28:31], v[12:15], a[16:23], v74
  v_smfmac_f32_16x16x64_bf16 v[32:35], v[16:19], v[248:255], v74
  v_smfmac_f32_16x16x64_bf16 v[32:35], v[0:3], a[8:15], v74
  s_waitcnt lgkmcnt(0)
  v_smfmac_f32_16x16x64_bf16 v[32:35], v[12:15], a[24:31], v74
  v_smfmac_f32_16x16x64_bf16 v[32:35], v[8:11], v[60:67], v74
  v_smfmac_f32_16x16x64_bf16 v[20:23], v[4:7], a[96:103], v74
  v_smfmac_f32_16x16x64_bf16 v[20:23], v[8:11], a[112:119], v74
  v_add_f32 v28, v28, v30
  v_add_f32 v32, v32, v34
  v_cvt_pk_bf16_f32 v30, v28, v32
  v_smfmac_f32_16x16x64_bf16 v[20:23], v[16:19], a[128:135], v74
  ds_write_b32 v79, v30 offset:256
  v_add_f32 v29, v29, v31
  v_add_f32 v33, v33, v35
  v_cvt_pk_bf16_f32 v31, v29, v33
  v_smfmac_f32_16x16x64_bf16 v[20:23], v[0:3], a[144:151], v74
  ds_write_b32 v79, v31 offset:832
  v_smfmac_f32_16x16x64_bf16 v[20:23], v[12:15], a[160:167], v74
  v_smfmac_f32_16x16x64_bf16 v[24:27], v[4:7], a[104:111], v74
  v_smfmac_f32_16x16x64_bf16 v[24:27], v[8:11], a[120:127], v74
  v_smfmac_f32_16x16x64_bf16 v[24:27], v[16:19], a[136:143], v74
  s_waitcnt lgkmcnt(0)
  s_barrier
  ds_read_b64 v[52:53], v77 offset:392
  v_add_f32 v20, v20, v22
  v_smfmac_f32_16x16x64_bf16 v[24:27], v[0:3], a[152:159], v74
  v_add_f32 v21, v21, v23
  v_smfmac_f32_16x16x64_bf16 v[24:27], v[12:15], a[168:175], v74
  v_cvt_pk_bf16_f32 v54, v20, v21
  s_add_u32 s68, s68, 655360
  s_nop 3
  v_add_f32 v24, v24, v26
  v_add_f32 v25, v25, v27
  v_cvt_pk_bf16_f32 v55, v24, v25
  s_waitcnt lgkmcnt(0)
  buffer_store_dwordx4 v[52:55], v76, s[8:11], s68 offen sc1
  s_branch Cs3_done
Cs3_lastp:
  s_add_u32 s72, s72, 2
  s_cmp_ge_u32 s72, 131072
  s_cbranch_scc1 Cs3_lastg
  s_barrier
  buffer_load_dwordx4 v76, s[8:11], s85 offen offset:0 sc1 lds
  buffer_load_dwordx4 v76, s[8:11], s85 offen offset:1024 sc1 lds
  s_waitcnt vmcnt(0)
  s_barrier
  s_branch Cs3_lastr
Cs3_done:
  s_branch L_cexit
L_conf:
  s_nop 11
  s_waitcnt vmcnt(0) lgkmcnt(0)
  s_barrier
  s_cmp_eq_u32 s52, 0
  s_cbranch_scc0 L_cf2
  s_mov_b64 exec, 1
  s_lshl_b32 s57, s2, 2
  v_mov_b32 v1, 0
L_cf0:
  s_cmp_eq_u32 s54, -1
  s_cbranch_scc1 L_cf1
  s_mov_b32 s55, s54
  s_lshr_b64 s[54:55], s[54:55], s0
  s_ff0_i32_b32 s56, s54
  s_add_u32 s0, s0, s56
  s_and_b32 s0, s0, 31
  s_lshl_b32 s56, 1, s0
  v_mov_b32 v35, s56
  buffer_atomic_or v35, v1, s[12:15], s57 offen sc0
  s_waitcnt vmcnt(0)
  v_readfirstlane_b32 s54, v35
  s_nop 0
  s_bitcmp1_b32 s54, s0
  s_cbranch_scc1 L_cf0
  v_mov_b32 v35, s0
  s_branch L_cf3
L_cf1:
  v_mov_b32 v35, 1
  buffer_atomic_add v35, v1, s[12:15], 0 offen offset:40 sc0
  s_waitcnt vmcnt(0)
  v_add_u32 v35, 32, v35
L_cf3:
  ds_write_b32 v33, v35
  s_mov_b64 exec, -1
  s_waitcnt lgkmcnt(0)
L_cf2:
  s_barrier
  ds_read_b32 v32, v33
  s_waitcnt lgkmcnt(0)
  v_readfirstlane_b32 s0, v32
  v_mbcnt_lo_u32_b32 v0, -1, 0
  v_mbcnt_hi_u32_b32 v0, -1, v0
  s_mov_b32 s1, 1
  s_cmp_lt_u32 s0, 32
  s_cbranch_scc1 L_role
  s_sub_u32 s53, s0, 32
  s_mov_b32 s57, 0
L_sur:
  s_load_dwordx16 s[60:75], s[12:13], 0 glc
  s_add_u32 s57, s57, 1
  s_waitcnt lgkmcnt(0)
  s_mov_b32 s55, s70
  s_bcnt1_i32_b32 s56, s60
  s_add_u32 s55, s55, s56
  s_bcnt1_i32_b32 s56, s61
  s_add_u32 s55, s55, s56
  s_bcnt1_i32_b32 s56, s62
  s_add_u32 s55, s55, s56
  s_bcnt1_i32_b32 s56, s63
  s_add_u32 s55, s55, s56
  s_bcnt1_i32_b32 s56, s64
  s_add_u32 s55, s55, s56
  s_bcnt1_i32_b32 s56, s65
  s_add_u32 s55, s55, s56
  s_bcnt1_i32_b32 s56, s66
  s_add_u32 s55, s55, s56
  s_bcnt1_i32_b32 s56, s67
  s_add_u32 s55, s55, s56
  s_cmp_ge_u32 s57, 131072
  s_cbranch_scc1 L_end
  s_cmp_lt_u32 s55, 256
  s_cbranch_scc1 L_sur
  s_mov_b32 s2, 0
  s_mov_b32 s54, s60
  s_bcnt0_i32_b32 s56, s54
  s_cmp_lt_u32 s53, s56
  s_cbranch_scc1 L_sur2
  s_sub_u32 s53, s53, s56
  s_mov_b32 s2, 1
  s_mov_b32 s54, s61
  s_bcnt0_i32_b32 s56, s54
  s_cmp_lt_u32 s53, s56
  s_cbranch_scc1 L_sur2
  s_sub_u32 s53, s53, s56
  s_mov_b32 s2, 2
  s_mov_b32 s54, s62
  s_bcnt0_i32_b32 s56, s54
  s_cmp_lt_u32 s53, s56
  s_cbranch_scc1 L_sur2
  s_sub_u32 s53, s53, s56
  s_mov_b32 s2, 3
  s_mov_b32 s54, s63
  s_bcnt0_i32_b32 s56, s54
  s_cmp_lt_u32 s53, s56
  s_cbranch_scc1 L_sur2
  s_sub_u32 s53, s53, s56
  s_mov_b32 s2, 4
  s_mov_b32 s54, s64
  s_bcnt0_i32_b32 s56, s54
  s_cmp_lt_u32 s53, s56
  s_cbranch_scc1 L_sur2
  s_sub_u32 s53, s53, s56
  s_mov_b32 s2, 5
  s_mov_b32 s54, s65
  s_bcnt0_i32_b32 s56, s54
  s_cmp_lt_u32 s53, s56
  s_cbranch_scc1 L_sur2
  s_sub_u32 s53, s53, s56
  s_mov_b32 s2, 6
  s_mov_b32 s54, s66
  s_bcnt0_i32_b32 s56, s54
  s_cmp_lt_u32 s53, s56
  s_cbranch_scc1 L_sur2
  s_sub_u32 s53, s53, s56
  s_mov_b32 s2, 7
  s_mov_b32 s54, s67
  s_bcnt0_i32_b32 s56, s54
  s_cmp_lt_u32 s53, s56
  s_cbranch_scc1 L_sur2
  s_sub_u32 s53, s53, s56
  s_branch L_end
L_sur2:
  s_ff0_i32_b32 s0, s54
  s_bitset1_b32 s54, s0
  s_sub_u32 s53, s53, 1
  s_cbranch_scc0 L_sur2
  s_branch L_role
L_worker:
  s_lshl_b32 s54, s2, 2
  s_lshr_b32 s54, 1412567136, s54
  s_and_b32 s54, s54, 7
  s_lshl_b32 s54, s54, 5
  s_add_u32 s53, s53, s54
  s_getpc_b64 s[80:81]
L_pc_2:
  s_and_b32 s55, s0, 1
  s_lshl_b32 s55, s55, 2
  s_add_u32 s55, s55, s52
  s_lshl_b32 s55, s55, 13
  v_and_b32 v199, 63, v0
  v_lshl_add_u32 v199, v199, 7, s55
  s_sub_u32 s82, s80, (L_pc_2 - L_w0)
  s_subb_u32 s83, s81, 0
  v_min_u32 v198, (L_w4 - L_w0), v199
  global_load_dword v196, v198, s[82:83]
  v_min_u32 v199, (L_end - L_pc_2), v199
  global_load_dword v196, v199, s[80:81]
  v_and_b32 v200, 63, v0
  v_lshlrev_b32 v201, 4, v200
  v_lshrrev_b32 v211, 3, v200
  s_lshl_b32 s54, s52, 3
  v_add_u32 v211, s54, v211
  v_bfe_u32 v212, v211, 1, 3
  v_and_b32 v213, 7, v200
  v_xor_b32 v212, v212, v213
  v_mul_u32_u24 v211, 1152, v211
  v_lshl_add_u32 v202, v212, 4, v211
  s_mul_i32 s67, s52, 9216
  v_and_b32 v211, 31, v200
  v_lshrrev_b32 v212, 3, v211
  v_mul_u32_u24 v212, 9216, v212
  v_and_b32 v213, 7, v211
  v_lshl_add_u32 v212, v213, 7, v212
  v_bfe_u32 v213, v211, 1, 3
  v_lshrrev_b32 v214, 5, v200
  v_xor_b32 v213, v213, v214
  v_lshl_add_u32 v203, v213, 4, v212
  v_xor_b32 v204, 32, v203
  v_xor_b32 v205, 64, v203
  v_xor_b32 v206, 0x60, v203
  v_bfe_u32 v211, v200, 2, 2
  v_lshl_add_u32 v212, v214, 3, v211
  v_lshlrev_b32 v212, 8, v212
  v_xor_b32 v211, s52, v211
  v_lshl_add_u32 v212, v211, 6, v212
  v_bfe_u32 v213, v200, 4, 1
  v_and_b32 v211, 3, v200
  v_lshl_add_u32 v210, v213, 5, v212
  v_lshl_add_u32 v210, v211, 3, v210
  v_lshl_add_u32 v209, v213, 4, v212
  v_and_b32 v213, 1, v211
  v_lshl_add_u32 v209, v213, 3, v209
  v_lshrrev_b32 v213, 1, v211
  v_lshl_add_u32 v209, v213, 5, v209
  s_mov_b32 s65, 0
  s_mul_i32 s58, s53, 9363
  s_lshr_b32 s58, s58, 16
  s_mul_i32 s54, s58, 7
  s_sub_u32 s59, s53, s54
  s_mul_i32 s60, s59, 36864
  s_add_u32 m0, s67, 0
  s_nop 0
  buffer_load_dwordx4 v202, s[4:7], s60 offen offset:0 lds
  s_add_u32 m0, s67, 896
  s_nop 0
  buffer_load_dwordx4 v202, s[4:7], s60 offen offset:128 lds
  s_add_u32 m0, s67, 1792
  s_nop 0
  buffer_load_dwordx4 v202, s[4:7], s60 offen offset:256 lds
  s_add_u32 m0, s67, 2688
  s_nop 0
  buffer_load_dwordx4 v202, s[4:7], s60 offen offset:384 lds
  s_add_u32 m0, s67, 3584
  s_nop 0
  buffer_load_dwordx4 v202, s[4:7], s60 offen offset:512 lds
  s_add_u32 m0, s67, 4480
  s_nop 0
  buffer_load_dwordx4 v202, s[4:7], s60 offen offset:640 lds
  s_add_u32 m0, s67, 5376
  s_nop 0
  buffer_load_dwordx4 v202, s[4:7], s60 offen offset:768 lds
  s_add_u32 m0, s67, 6272
  s_nop 0
  buffer_load_dwordx4 v202, s[4:7], s60 offen offset:896 lds
  s_add_u32 m0, s67, 7168
  s_nop 0
  buffer_load_dwordx4 v202, s[4:7], s60 offen offset:1024 lds
  v_lshrrev_b32 v211, 4, v200
  v_lshlrev_b32 v212, 2, v211
  v_and_b32 v213, 15, v200
  v_xor_b32 v212, v212, v213
  v_lshlrev_b32 v212, 4, v212
  v_lshl_add_u32 v207, v211, 13, v212
  s_lshl_b32 s62, s58, 8
  s_lshl_b32 s54, s52, 15
  s_add_u32 s62, s62, s54
  s_lshl_b32 s61, s52, 10
  s_add_u32 s61, s61, 36864
  s_add_u32 m0, s61, 0
  s_add_u32 s54, s62, 0
  buffer_load_dwordx4 v207, s[20:23], s54 offen lds
  s_add_u32 m0, s61, 4096
  s_add_u32 s54, s62, 131072
  buffer_load_dwordx4 v207, s[20:23], s54 offen lds
  s_add_u32 m0, s61, 8192
  s_add_u32 s54, s62, 262144
  buffer_load_dwordx4 v207, s[20:23], s54 offen lds
  s_add_u32 m0, s61, 12288
  s_add_u32 s54, s62, 393216
  buffer_load_dwordx4 v207, s[20:23], s54 offen lds
  s_add_u32 m0, s61, 16384
  s_add_u32 s54, s62, 0
  buffer_load_dwordx4 v207, s[24:27], s54 offen lds
  s_add_u32 m0, s61, 20480
  s_add_u32 s54, s62, 131072
  buffer_load_dwordx4 v207, s[24:27], s54 offen lds
  s_add_u32 m0, s61, 24576
  s_add_u32 s54, s62, 262144
  buffer_load_dwordx4 v207, s[24:27], s54 offen lds
  s_add_u32 m0, s61, 28672
  s_add_u32 s54, s62, 393216
  buffer_load_dwordx4 v207, s[24:27], s54 offen lds
  s_add_u32 m0, s61, 32768
  s_add_u32 s54, s62, 524288
  buffer_load_dwordx4 v207, s[20:23], s54 offen lds
  s_add_u32 m0, s61, 36864
  s_add_u32 s54, s62, 655360
  buffer_load_dwordx4 v207, s[20:23], s54 offen lds
  s_add_u32 m0, s61, 40960
  s_add_u32 s54, s62, 786432
  buffer_load_dwordx4 v207, s[20:23], s54 offen lds
  s_add_u32 m0, s61, 45056
  s_add_u32 s54, s62, 917504
  buffer_load_dwordx4 v207, s[20:23], s54 offen lds
  s_add_u32 m0, s61, 49152
  s_add_u32 s54, s62, 524288
  buffer_load_dwordx4 v207, s[24:27], s54 offen lds
  s_add_u32 m0, s61, 53248
  s_add_u32 s54, s62, 655360
  buffer_load_dwordx4 v207, s[24:27], s54 offen lds
  s_add_u32 m0, s61, 57344
  s_add_u32 s54, s62, 786432
  buffer_load_dwordx4 v207, s[24:27], s54 offen lds
  s_add_u32 m0, s61, 61440
  s_add_u32 s54, s62, 917504
  buffer_load_dwordx4 v207, s[24:27], s54 offen lds
  s_add_u32 m0, s61, 65536
  s_add_u32 s54, s62, 1048576
  buffer_load_dwordx4 v207, s[20:23], s54 offen lds
  s_add_u32 m0, s61, 69632
  s_add_u32 s54, s62, 1179648
  buffer_load_dwordx4 v207, s[20:23], s54 offen lds
  s_add_u32 m0, s61, 73728
  s_add_u32 s54, s62, 1310720
  buffer_load_dwordx4 v207, s[20:23], s54 offen lds
  s_add_u32 m0, s61, 77824
  s_add_u32 s54, s62, 1441792
  buffer_load_dwordx4 v207, s[20:23], s54 offen lds
  s_add_u32 m0, s61, 81920
  s_add_u32 s54, s62, 1048576
  buffer_load_dwordx4 v207, s[24:27], s54 offen lds
  s_add_u32 m0, s61, 86016
  s_add_u32 s54, s62, 1179648
  buffer_load_dwordx4 v207, s[24:27], s54 offen lds
  s_add_u32 m0, s61, 90112
  s_add_u32 s54, s62, 1310720
  buffer_load_dwordx4 v207, s[24:27], s54 offen lds
  s_add_u32 m0, s61, 94208
  s_add_u32 s54, s62, 1441792
  buffer_load_dwordx4 v207, s[24:27], s54 offen lds
  v_bfe_u32 v211, v200, 3, 2
  v_lshlrev_b32 v216, 11, v211
  v_bfe_u32 v211, v200, 1, 2
  v_lshl_add_u32 v216, v211, 6, v216
  v_lshrrev_b32 v212, 5, v200
  v_lshl_add_u32 v216, v212, 5, v216
  v_and_b32 v211, 1, v200
  v_lshl_add_u32 v216, v211, 4, v216
  v_bfe_u32 v211, v200, 4, 1
  v_lshlrev_b32 v217, 10, v211
  v_lshl_add_u32 v217, v212, 9, v217
  v_and_b32 v211, 15, v200
  v_lshl_add_u32 v217, v211, 4, v217
  s_lshl_b32 s54, s52, 11
  s_add_u32 s54, s54, 8192
  v_add_u32 v217, s54, v217
  s_waitcnt vmcnt(20) lgkmcnt(0)
  s_barrier
  s_add_u32 m0, s61, 98304
  s_add_u32 s54, s62, 1572864
  buffer_load_dwordx4 v207, s[20:23], s54 offen lds
  s_add_u32 m0, s61, 102400
  s_add_u32 s54, s62, 1703936
  buffer_load_dwordx4 v207, s[20:23], s54 offen lds
  s_add_u32 m0, s61, 106496
  s_add_u32 s54, s62, 1835008
  buffer_load_dwordx4 v207, s[20:23], s54 offen lds
  s_add_u32 m0, s61, 110592
  s_add_u32 s54, s62, 1966080
  buffer_load_dwordx4 v207, s[20:23], s54 offen lds
  v_add_u32 v215, 36864, v209
  ds_read_b64_tr_b16 a[0:1], v215 offset:0
  ds_read_b64_tr_b16 a[2:3], v215 offset:1024
  ds_read_b64_tr_b16 a[4:5], v215 offset:4096
  ds_read_b64_tr_b16 a[6:7], v215 offset:5120
  ds_read_b64_tr_b16 a[8:9], v215 offset:8192
  ds_read_b64_tr_b16 a[10:11], v215 offset:9216
  ds_read_b64_tr_b16 a[12:13], v215 offset:12288
  ds_read_b64_tr_b16 a[14:15], v215 offset:13312
  s_waitcnt vmcnt(20) lgkmcnt(0)
  s_barrier
  s_add_u32 m0, s61, 0
  s_add_u32 s54, s62, 1572864
  buffer_load_dwordx4 v207, s[24:27], s54 offen lds
  s_add_u32 m0, s61, 4096
  s_add_u32 s54, s62, 1703936
  buffer_load_dwordx4 v207, s[24:27], s54 offen lds
  s_add_u32 m0, s61, 8192
  s_add_u32 s54, s62, 1835008
  buffer_load_dwordx4 v207, s[24:27], s54 offen lds
  s_add_u32 m0, s61, 12288
  s_add_u32 s54, s62, 1966080
  buffer_load_dwordx4 v207, s[24:27], s54 offen lds
  v_add_u32 v215, 53248, v210
  ds_read_b64_tr_b16 a[144:145], v215 offset:0
  ds_read_b64_tr_b16 a[146:147], v215 offset:1024
  ds_read_b64_tr_b16 a[148:149], v215 offset:4096
  ds_read_b64_tr_b16 a[150:151], v215 offset:5120
  ds_read_b64_tr_b16 a[152:153], v215 offset:8192
  ds_read_b64_tr_b16 a[154:155], v215 offset:9216
  ds_read_b64_tr_b16 a[156:157], v215 offset:12288
  ds_read_b64_tr_b16 a[158:159], v215 offset:13312
  s_waitcnt vmcnt(20) lgkmcnt(0)
  s_barrier
  s_add_u32 m0, s61, 16384
  s_add_u32 s54, s62, 2097152
  buffer_load_dwordx4 v207, s[20:23], s54 offen lds
  s_add_u32 m0, s61, 20480
  s_add_u32 s54, s62, 2228224
  buffer_load_dwordx4 v207, s[20:23], s54 offen lds
  s_add_u32 m0, s61, 24576
  s_add_u32 s54, s62, 2359296
  buffer_load_dwordx4 v207, s[20:23], s54 offen lds
  s_add_u32 m0, s61, 28672
  s_add_u32 s54, s62, 2490368
  buffer_load_dwordx4 v207, s[20:23], s54 offen lds
  v_add_u32 v215, 69632, v209
  ds_read_b64_tr_b16 a[16:17], v215 offset:0
  ds_read_b64_tr_b16 a[18:19], v215 offset:1024
  ds_read_b64_tr_b16 a[20:21], v215 offset:4096
  ds_read_b64_tr_b16 a[22:23], v215 offset:5120
  ds_read_b64_tr_b16 a[24:25], v215 offset:8192
  ds_read_b64_tr_b16 a[26:27], v215 offset:9216
  ds_read_b64_tr_b16 a[28:29], v215 offset:12288
  ds_read_b64_tr_b16 a[30:31], v215 offset:13312
  s_waitcnt vmcnt(20) lgkmcnt(0)
  s_barrier
  s_add_u32 m0, s61, 32768
  s_add_u32 s54, s62, 2097152
  buffer_load_dwordx4 v207, s[24:27], s54 offen lds
  s_add_u32 m0, s61, 36864
  s_add_u32 s54, s62, 2228224
  buffer_load_dwordx4 v207, s[24:27], s54 offen lds
  s_add_u32 m0, s61, 40960
  s_add_u32 s54, s62, 2359296
  buffer_load_dwordx4 v207, s[24:27], s54 offen lds
  s_add_u32 m0, s61, 45056
  s_add_u32 s54, s62, 2490368
  buffer_load_dwordx4 v207, s[24:27], s54 offen lds
  v_add_u32 v215, 86016, v210
  ds_read_b64_tr_b16 a[160:161], v215 offset:0
  ds_read_b64_tr_b16 a[162:163], v215 offset:1024
  ds_read_b64_tr_b16 a[164:165], v215 offset:4096
  ds_read_b64_tr_b16 a[166:167], v215 offset:5120
  ds_read_b64_tr_b16 a[168:169], v215 offset:8192
  ds_read_b64_tr_b16 a[170:171], v215 offset:9216
  ds_read_b64_tr_b16 a[172:173], v215 offset:12288
  ds_read_b64_tr_b16 a[174:175], v215 offset:13312
  s_waitcnt vmcnt(20) lgkmcnt(0)
  s_barrier
  s_add_u32 m0, s61, 49152
  s_add_u32 s54, s62, 2621440
  buffer_load_dwordx4 v207, s[20:23], s54 offen lds
  s_add_u32 m0, s61, 53248
  s_add_u32 s54, s62, 2752512
  buffer_load_dwordx4 v207, s[20:23], s54 offen lds
  s_add_u32 m0, s61, 57344
  s_add_u32 s54, s62, 2883584
  buffer_load_dwordx4 v207, s[20:23], s54 offen lds
  s_add_u32 m0, s61, 61440
  s_add_u32 s54, s62, 3014656
  buffer_load_dwordx4 v207, s[20:23], s54 offen lds
  v_add_u32 v215, 102400, v209
  ds_read_b64_tr_b16 a[32:33], v215 offset:0
  ds_read_b64_tr_b16 a[34:35], v215 offset:1024
  ds_read_b64_tr_b16 a[36:37], v215 offset:4096
  ds_read_b64_tr_b16 a[38:39], v215 offset:5120
  ds_read_b64_tr_b16 a[40:41], v215 offset:8192
  ds_read_b64_tr_b16 a[42:43], v215 offset:9216
  ds_read_b64_tr_b16 a[44:45], v215 offset:12288
  ds_read_b64_tr_b16 a[46:47], v215 offset:13312
  s_waitcnt vmcnt(20) lgkmcnt(0)
  s_barrier
  s_add_u32 m0, s61, 65536
  s_add_u32 s54, s62, 2621440
  buffer_load_dwordx4 v207, s[24:27], s54 offen lds
  s_add_u32 m0, s61, 69632
  s_add_u32 s54, s62, 2752512
  buffer_load_dwordx4 v207, s[24:27], s54 offen lds
  s_add_u32 m0, s61, 73728
  s_add_u32 s54, s62, 2883584
  buffer_load_dwordx4 v207, s[24:27], s54 offen lds
  s_add_u32 m0, s61, 77824
  s_add_u32 s54, s62, 3014656
  buffer_load_dwordx4 v207, s[24:27], s54 offen lds
  v_add_u32 v215, 118784, v210
  ds_read_b64_tr_b16 a[176:177], v215 offset:0
  ds_read_b64_tr_b16 a[178:179], v215 offset:1024
  ds_read_b64_tr_b16 a[180:181], v215 offset:4096
  ds_read_b64_tr_b16 a[182:183], v215 offset:5120
  ds_read_b64_tr_b16 a[184:185], v215 offset:8192
  ds_read_b64_tr_b16 a[186:187], v215 offset:9216
  ds_read_b64_tr_b16 a[188:189], v215 offset:12288
  ds_read_b64_tr_b16 a[190:191], v215 offset:13312
  s_waitcnt vmcnt(20) lgkmcnt(0)
  s_barrier
  s_add_u32 m0, s61, 81920
  s_add_u32 s54, s62, 3145728
  buffer_load_dwordx4 v207, s[20:23], s54 offen lds
  s_add_u32 m0, s61, 86016
  s_add_u32 s54, s62, 3276800
  buffer_load_dwordx4 v207, s[20:23], s54 offen lds
  s_add_u32 m0, s61, 90112
  s_add_u32 s54, s62, 3407872
  buffer_load_dwordx4 v207, s[20:23], s54 offen lds
  s_add_u32 m0, s61, 94208
  s_add_u32 s54, s62, 3538944
  buffer_load_dwordx4 v207, s[20:23], s54 offen lds
  v_add_u32 v215, 135168, v209
  ds_read_b64_tr_b16 a[48:49], v215 offset:0
  ds_read_b64_tr_b16 a[50:51], v215 offset:1024
  ds_read_b64_tr_b16 a[52:53], v215 offset:4096
  ds_read_b64_tr_b16 a[54:55], v215 offset:5120
  ds_read_b64_tr_b16 a[56:57], v215 offset:8192
  ds_read_b64_tr_b16 a[58:59], v215 offset:9216
  ds_read_b64_tr_b16 a[60:61], v215 offset:12288
  ds_read_b64_tr_b16 a[62:63], v215 offset:13312
  s_waitcnt vmcnt(20) lgkmcnt(0)
  s_barrier
  s_add_u32 m0, s61, 98304
  s_add_u32 s54, s62, 3145728
  buffer_load_dwordx4 v207, s[24:27], s54 offen lds
  s_add_u32 m0, s61, 102400
  s_add_u32 s54, s62, 3276800
  buffer_load_dwordx4 v207, s[24:27], s54 offen lds
  s_add_u32 m0, s61, 106496
  s_add_u32 s54, s62, 3407872
  buffer_load_dwordx4 v207, s[24:27], s54 offen lds
  s_add_u32 m0, s61, 110592
  s_add_u32 s54, s62, 3538944
  buffer_load_dwordx4 v207, s[24:27], s54 offen lds
  v_add_u32 v215, 36864, v210
  ds_read_b64_tr_b16 a[192:193], v215 offset:0
  ds_read_b64_tr_b16 a[194:195], v215 offset:1024
  ds_read_b64_tr_b16 a[196:197], v215 offset:4096
  ds_read_b64_tr_b16 a[198:199], v215 offset:5120
  ds_read_b64_tr_b16 a[200:201], v215 offset:8192
  ds_read_b64_tr_b16 a[202:203], v215 offset:9216
  ds_read_b64_tr_b16 a[204:205], v215 offset:12288
  ds_read_b64_tr_b16 a[206:207], v215 offset:13312
  s_waitcnt vmcnt(20) lgkmcnt(0)
  s_barrier
  s_add_u32 m0, s61, 0
  s_add_u32 s54, s62, 3670016
  buffer_load_dwordx4 v207, s[20:23], s54 offen lds
  s_add_u32 m0, s61, 4096
  s_add_u32 s54, s62, 3801088
  buffer_load_dwordx4 v207, s[20:23], s54 offen lds
  s_add_u32 m0, s61, 8192
  s_add_u32 s54, s62, 3932160
  buffer_load_dwordx4 v207, s[20:23], s54 offen lds
  s_add_u32 m0, s61, 12288
  s_add_u32 s54, s62, 4063232
  buffer_load_dwordx4 v207, s[20:23], s54 offen lds
  v_add_u32 v215, 53248, v209
  ds_read_b64_tr_b16 a[64:65], v215 offset:0
  ds_read_b64_tr_b16 a[66:67], v215 offset:1024
  ds_read_b64_tr_b16 a[68:69], v215 offset:4096
  ds_read_b64_tr_b16 a[70:71], v215 offset:5120
  ds_read_b64_tr_b16 a[72:73], v215 offset:8192
  ds_read_b64_tr_b16 a[74:75], v215 offset:9216
  ds_read_b64_tr_b16 a[76:77], v215 offset:12288
  ds_read_b64_tr_b16 a[78:79], v215 offset:13312
  s_waitcnt vmcnt(20) lgkmcnt(0)
  s_barrier
  s_add_u32 m0, s61, 16384
  s_add_u32 s54, s62, 3670016
  buffer_load_dwordx4 v207, s[24:27], s54 offen lds
  s_add_u32 m0, s61, 20480
  s_add_u32 s54, s62, 3801088
  buffer_load_dwordx4 v207, s[24:27], s54 offen lds
  s_add_u32 m0, s61, 24576
  s_add_u32 s54, s62, 3932160
  buffer_load_dwordx4 v207, s[24:27], s54 offen lds
  s_add_u32 m0, s61, 28672
  s_add_u32 s54, s62, 4063232
  buffer_load_dwordx4 v207, s[24:27], s54 offen lds
  v_add_u32 v215, 69632, v210
  ds_read_b64_tr_b16 a[208:209], v215 offset:0
  ds_read_b64_tr_b16 a[210:211], v215 offset:1024
  ds_read_b64_tr_b16 a[212:213], v215 offset:4096
  ds_read_b64_tr_b16 a[214:215], v215 offset:5120
  ds_read_b64_tr_b16 a[216:217], v215 offset:8192
  ds_read_b64_tr_b16 a[218:219], v215 offset:9216
  ds_read_b64_tr_b16 a[220:221], v215 offset:12288
  ds_read_b64_tr_b16 a[222:223], v215 offset:13312
  s_waitcnt vmcnt(20) lgkmcnt(0)
  s_barrier
  s_add_u32 m0, s61, 32768
  s_add_u32 s54, s62, 4194304
  buffer_load_dwordx4 v207, s[20:23], s54 offen lds
  s_add_u32 m0, s61, 36864
  s_add_u32 s54, s62, 4325376
  buffer_load_dwordx4 v207, s[20:23], s54 offen lds
  s_add_u32 m0, s61, 40960
  s_add_u32 s54, s62, 4456448
  buffer_load_dwordx4 v207, s[20:23], s54 offen lds
  s_add_u32 m0, s61, 45056
  s_add_u32 s54, s62, 4587520
  buffer_load_dwordx4 v207, s[20:23], s54 offen lds
  v_add_u32 v215, 86016, v209
  ds_read_b64_tr_b16 a[80:81], v215 offset:0
  ds_read_b64_tr_b16 a[82:83], v215 offset:1024
  ds_read_b64_tr_b16 a[84:85], v215 offset:4096
  ds_read_b64_tr_b16 a[86:87], v215 offset:5120
  ds_read_b64_tr_b16 a[88:89], v215 offset:8192
  ds_read_b64_tr_b16 a[90:91], v215 offset:9216
  ds_read_b64_tr_b16 a[92:93], v215 offset:12288
  ds_read_b64_tr_b16 a[94:95], v215 offset:13312
  s_waitcnt vmcnt(20) lgkmcnt(0)
  s_barrier
  s_add_u32 m0, s61, 49152
  s_add_u32 s54, s62, 4194304
  buffer_load_dwordx4 v207, s[24:27], s54 offen lds
  s_add_u32 m0, s61, 53248
  s_add_u32 s54, s62, 4325376
  buffer_load_dwordx4 v207, s[24:27], s54 offen lds
  s_add_u32 m0, s61, 57344
  s_add_u32 s54, s62, 4456448
  buffer_load_dwordx4 v207, s[24:27], s54 offen lds
  s_add_u32 m0, s61, 61440
  s_add_u32 s54, s62, 4587520
  buffer_load_dwordx4 v207, s[24:27], s54 offen lds
  s_mul_i32 s54, s53, 21120
  s_lshl_b32 s55, s52, 13
  s_add_u32 s54, s54, s55
  s_cmp_eq_u32 s52, 3
  s_cselect_b32 s54, 0x10000000, s54
  v_lshlrev_b32 v211, 3, v201
  buffer_load_dword v196, v211, s[28:31], s54 offen
  v_add_u32 v215, 102400, v210
  ds_read_b64_tr_b16 a[224:225], v215 offset:0
  ds_read_b64_tr_b16 a[226:227], v215 offset:1024
  ds_read_b64_tr_b16 a[228:229], v215 offset:4096
  ds_read_b64_tr_b16 a[230:231], v215 offset:5120
  ds_read_b64_tr_b16 a[232:233], v215 offset:8192
  ds_read_b64_tr_b16 a[234:235], v215 offset:9216
  ds_read_b64_tr_b16 a[236:237], v215 offset:12288
  ds_read_b64_tr_b16 a[238:239], v215 offset:13312
  s_waitcnt vmcnt(21) lgkmcnt(0)
  s_barrier
  s_lshl_b32 s54, s53, 13
  s_lshr_b32 s55, s53, 6
  s_or_b32 s55, s55, s52
  s_cmp_eq_u32 s55, 0
  s_cselect_b32 s54, s54, 0x10000000
  v_lshlrev_b32 v211, 3, v201
  s_add_u32 s54, s54, 3145728
  buffer_load_dword v196, v211, s[16:19], s54 offen
  v_add_u32 v215, 118784, v209
  ds_read_b64_tr_b16 a[96:97], v215 offset:0
  ds_read_b64_tr_b16 a[98:99], v215 offset:1024
  ds_read_b64_tr_b16 a[100:101], v215 offset:4096
  ds_read_b64_tr_b16 a[102:103], v215 offset:5120
  ds_read_b64_tr_b16 a[104:105], v215 offset:8192
  ds_read_b64_tr_b16 a[106:107], v215 offset:9216
  ds_read_b64_tr_b16 a[108:109], v215 offset:12288
  ds_read_b64_tr_b16 a[110:111], v215 offset:13312
  s_waitcnt vmcnt(18) lgkmcnt(0)
  s_barrier
  s_lshl_b32 s55, s2, 2
  s_or_b32 s56, s52, s1
  s_cmp_eq_u32 s56, 0
  s_cselect_b32 s55, s55, 0x1000
  s_lshl_b32 s56, 1, s0
  v_mov_b32 v197, s56
  s_mov_b64 exec, 1
  buffer_atomic_or v197, off, s[12:15], s55 sc0
  s_mov_b64 exec, -1
  v_add_u32 v215, 135168, v210
  ds_read_b64_tr_b16 a[240:241], v215 offset:0
  ds_read_b64_tr_b16 a[242:243], v215 offset:1024
  ds_read_b64_tr_b16 a[244:245], v215 offset:4096
  ds_read_b64_tr_b16 a[246:247], v215 offset:5120
  ds_read_b64_tr_b16 a[248:249], v215 offset:8192
  ds_read_b64_tr_b16 a[250:251], v215 offset:9216
  ds_read_b64_tr_b16 a[252:253], v215 offset:12288
  ds_read_b64_tr_b16 a[254:255], v215 offset:13312
  s_waitcnt vmcnt(15) lgkmcnt(0)
  s_barrier
  v_add_u32 v215, 36864, v209
  ds_read_b64_tr_b16 a[112:113], v215 offset:0
  ds_read_b64_tr_b16 a[114:115], v215 offset:1024
  ds_read_b64_tr_b16 a[116:117], v215 offset:4096
  ds_read_b64_tr_b16 a[118:119], v215 offset:5120
  ds_read_b64_tr_b16 a[120:121], v215 offset:8192
  ds_read_b64_tr_b16 a[122:123], v215 offset:9216
  ds_read_b64_tr_b16 a[124:125], v215 offset:12288
  ds_read_b64_tr_b16 a[126:127], v215 offset:13312
  s_waitcnt vmcnt(11) lgkmcnt(0)
  s_barrier
  v_add_u32 v215, 53248, v210
  ds_read_b64_tr_b16 v[224:225], v215 offset:0
  ds_read_b64_tr_b16 v[226:227], v215 offset:1024
  ds_read_b64_tr_b16 v[228:229], v215 offset:4096
  ds_read_b64_tr_b16 v[230:231], v215 offset:5120
  ds_read_b64_tr_b16 v[232:233], v215 offset:8192
  ds_read_b64_tr_b16 v[234:235], v215 offset:9216
  ds_read_b64_tr_b16 v[236:237], v215 offset:12288
  ds_read_b64_tr_b16 v[238:239], v215 offset:13312
  s_waitcnt vmcnt(7) lgkmcnt(0)
  s_barrier
  v_add_u32 v215, 69632, v209
  ds_read_b64_tr_b16 a[128:129], v215 offset:0
  ds_read_b64_tr_b16 a[130:131], v215 offset:1024
  ds_read_b64_tr_b16 a[132:133], v215 offset:4096
  ds_read_b64_tr_b16 a[134:135], v215 offset:5120
  ds_read_b64_tr_b16 a[136:137], v215 offset:8192
  ds_read_b64_tr_b16 a[138:139], v215 offset:9216
  ds_read_b64_tr_b16 a[140:141], v215 offset:12288
  ds_read_b64_tr_b16 a[142:143], v215 offset:13312
  s_waitcnt vmcnt(3) lgkmcnt(0)
  s_barrier
  v_add_u32 v215, 86016, v210
  ds_read_b64_tr_b16 v[240:241], v215 offset:0
  ds_read_b64_tr_b16 v[242:243], v215 offset:1024
  ds_read_b64_tr_b16 v[244:245], v215 offset:4096
  ds_read_b64_tr_b16 v[246:247], v215 offset:5120
  ds_read_b64_tr_b16 v[248:249], v215 offset:8192
  ds_read_b64_tr_b16 v[250:251], v215 offset:9216
  ds_read_b64_tr_b16 v[252:253], v215 offset:12288
  ds_read_b64_tr_b16 v[254:255], v215 offset:13312
  s_waitcnt lgkmcnt(0)
  s_barrier
  s_mov_b32 s68, 1040356334
  s_lshl_b32 s69, s52, 9
  s_lshl_b32 s70, s58, 2
  s_add_u32 s70, s70, 128
  s_mul_i32 s66, s58, -12288
  s_lshl_b32 s54, s52, 10
  s_add_u32 s66, s66, s54
  s_add_u32 s66, s66, 524288
  v_mov_b32 v64, -1
  v_mov_b32 v65, -1
  v_mov_b32 v66, -1
  v_mov_b32 v67, -1
  s_add_u32 s60, s60, 258048
  ds_read_b128 v[32:35], v203 offset:0
  ds_read_b128 v[36:39], v204 offset:0
  ds_read_b128 v[40:43], v205 offset:0
  s_waitcnt lgkmcnt(2)
  v_mfma_f32_32x32x16_bf16 v[0:15], a[0:3], v[32:35], 0
  ds_read_b128 v[44:47], v206 offset:0
  s_add_u32 m0, s67, 36864
  s_nop 0
  buffer_load_dwordx4 v202, s[4:7], s60 offen offset:0 lds
  v_mfma_f32_32x32x16_bf16 v[16:31], v[32:35], a[144:147], 0
  s_waitcnt lgkmcnt(2)
  v_mfma_f32_32x32x16_bf16 v[0:15], a[4:7], v[36:39], v[0:15]
  ds_read_b128 v[32:35], v203 offset:1024
  s_add_u32 m0, s67, 37760
  s_nop 0
  buffer_load_dwordx4 v202, s[4:7], s60 offen offset:128 lds
  v_mfma_f32_32x32x16_bf16 v[16:31], v[36:39], a[148:151], v[16:31]
  s_waitcnt lgkmcnt(2)
  v_mfma_f32_32x32x16_bf16 v[0:15], a[8:11], v[40:43], v[0:15]
  ds_read_b128 v[36:39], v204 offset:1024
  s_add_u32 m0, s67, 38656
  s_nop 0
  buffer_load_dwordx4 v202, s[4:7], s60 offen offset:256 lds
  v_mfma_f32_32x32x16_bf16 v[16:31], v[40:43], a[152:155], v[16:31]
  s_waitcnt lgkmcnt(2)
  v_mfma_f32_32x32x16_bf16 v[0:15], a[12:15], v[44:47], v[0:15]
  ds_read_b128 v[40:43], v205 offset:1024
  s_add_u32 m0, s67, 39552
  s_nop 0
  buffer_load_dwordx4 v202, s[4:7], s60 offen offset:384 lds
  v_mfma_f32_32x32x16_bf16 v[16:31], v[44:47], a[156:159], v[16:31]
  s_waitcnt lgkmcnt(2)
  v_mfma_f32_32x32x16_bf16 v[0:15], a[16:19], v[32:35], v[0:15]
  ds_read_b128 v[44:47], v206 offset:1024
  s_add_u32 m0, s67, 40448
  s_nop 0
  buffer_load_dwordx4 v202, s[4:7], s60 offen offset:512 lds
  v_mfma_f32_32x32x16_bf16 v[16:31], v[32:35], a[160:163], v[16:31]
  s_waitcnt lgkmcnt(2)
  v_mfma_f32_32x32x16_bf16 v[0:15], a[20:23], v[36:39], v[0:15]
  ds_read_b128 v[32:35], v203 offset:2048
  s_add_u32 m0, s67, 41344
  s_nop 0
  buffer_load_dwordx4 v202, s[4:7], s60 offen offset:640 lds
  v_mfma_f32_32x32x16_bf16 v[16:31], v[36:39], a[164:167], v[16:31]
  s_waitcnt lgkmcnt(2)
  v_mfma_f32_32x32x16_bf16 v[0:15], a[24:27], v[40:43], v[0:15]
  ds_read_b128 v[36:39], v204 offset:2048
  s_add_u32 m0, s67, 42240
  s_nop 0
  buffer_load_dwordx4 v202, s[4:7], s60 offen offset:768 lds
  v_mfma_f32_32x32x16_bf16 v[16:31], v[40:43], a[168:171], v[16:31]
  s_waitcnt lgkmcnt(2)
  v_mfma_f32_32x32x16_bf16 v[0:15], a[28:31], v[44:47], v[0:15]
  ds_read_b128 v[40:43], v205 offset:2048
  s_add_u32 m0, s67, 43136
  s_nop 0
  buffer_load_dwordx4 v202, s[4:7], s60 offen offset:896 lds
  v_mfma_f32_32x32x16_bf16 v[16:31], v[44:47], a[172:175], v[16:31]
  s_waitcnt lgkmcnt(2)
  v_mfma_f32_32x32x16_bf16 v[0:15], a[32:35], v[32:35], v[0:15]
  ds_read_b128 v[44:47], v206 offset:2048
  s_add_u32 m0, s67, 44032
  s_nop 0
  buffer_load_dwordx4 v202, s[4:7], s60 offen offset:1024 lds
  v_mfma_f32_32x32x16_bf16 v[16:31], v[32:35], a[176:179], v[16:31]
  s_waitcnt lgkmcnt(2)
  v_mfma_f32_32x32x16_bf16 v[0:15], a[36:39], v[36:39], v[0:15]
  ds_read_b128 v[32:35], v203 offset:3072
  v_mfma_f32_32x32x16_bf16 v[16:31], v[36:39], a[180:183], v[16:31]
  s_waitcnt lgkmcnt(2)
  v_mfma_f32_32x32x16_bf16 v[0:15], a[40:43], v[40:43], v[0:15]
  ds_read_b128 v[36:39], v204 offset:3072
  v_mfma_f32_32x32x16_bf16 v[16:31], v[40:43], a[184:187], v[16:31]
  s_waitcnt lgkmcnt(2)
  v_mfma_f32_32x32x16_bf16 v[0:15], a[44:47], v[44:47], v[0:15]
  ds_read_b128 v[40:43], v205 offset:3072
  v_mfma_f32_32x32x16_bf16 v[16:31], v[44:47], a[188:191], v[16:31]
  s_waitcnt lgkmcnt(2)
  v_mfma_f32_32x32x16_bf16 v[0:15], a[48:51], v[32:35], v[0:15]
  ds_read_b128 v[44:47], v206 offset:3072
  v_mfma_f32_32x32x16_bf16 v[16:31], v[32:35], a[192:195], v[16:31]
  s_waitcnt lgkmcnt(2)
  v_mfma_f32_32x32x16_bf16 v[0:15], a[52:55], v[36:39], v[0:15]
  ds_read_b128 v[32:35], v203 offset:4096
  v_mfma_f32_32x32x16_bf16 v[16:31], v[36:39], a[196:199], v[16:31]
  s_waitcnt lgkmcnt(2)
  v_mfma_f32_32x32x16_bf16 v[0:15], a[56:59], v[40:43], v[0:15]
  ds_read_b128 v[36:39], v204 offset:4096
  v_mfma_f32_32x32x16_bf16 v[16:31], v[40:43], a[200:203], v[16:31]
  s_waitcnt lgkmcnt(2)
  v_mfma_f32_32x32x16_bf16 v[0:15], a[60:63], v[44:47], v[0:15]
  ds_read_b128 v[40:43], v205 offset:4096
  v_mfma_f32_32x32x16_bf16 v[16:31], v[44:47], a[204:207], v[16:31]
  s_waitcnt lgkmcnt(2)
  v_mfma_f32_32x32x16_bf16 v[0:15], a[64:67], v[32:35], v[0:15]
  ds_read_b128 v[44:47], v206 offset:4096
  v_mfma_f32_32x32x16_bf16 v[16:31], v[32:35], a[208:211], v[16:31]
  s_waitcnt lgkmcnt(2)
  v_mfma_f32_32x32x16_bf16 v[0:15], a[68:71], v[36:39], v[0:15]
  ds_read_b128 v[32:35], v203 offset:5120
  v_mfma_f32_32x32x16_bf16 v[16:31], v[36:39], a[212:215], v[16:31]
  s_waitcnt lgkmcnt(2)
  v_mfma_f32_32x32x16_bf16 v[0:15], a[72:75], v[40:43], v[0:15]
  ds_read_b128 v[36:39], v204 offset:5120
  v_mfma_f32_32x32x16_bf16 v[16:31], v[40:43], a[216:219], v[16:31]
  s_waitcnt lgkmcnt(2)
  v_mfma_f32_32x32x16_bf16 v[0:15], a[76:79], v[44:47], v[0:15]
  ds_read_b128 v[40:43], v205 offset:5120
  v_mfma_f32_32x32x16_bf16 v[16:31], v[44:47], a[220:223], v[16:31]
  s_waitcnt lgkmcnt(2)
  v_mfma_f32_32x32x16_bf16 v[0:15], a[80:83], v[32:35], v[0:15]
  ds_read_b128 v[44:47], v206 offset:5120
  v_mfma_f32_32x32x16_bf16 v[16:31], v[32:35], a[224:227], v[16:31]
  s_waitcnt lgkmcnt(2)
  v_mfma_f32_32x32x16_bf16 v[0:15], a[84:87], v[36:39], v[0:15]
  ds_read_b128 v[32:35], v203 offset:6144
  v_mfma_f32_32x32x16_bf16 v[16:31], v[36:39], a[228:231], v[16:31]
  s_waitcnt lgkmcnt(2)
  v_mfma_f32_32x32x16_bf16 v[0:15], a[88:91], v[40:43], v[0:15]
  ds_read_b128 v[36:39], v204 offset:6144
  v_mfma_f32_32x32x16_bf16 v[16:31], v[40:43], a[232:235], v[16:31]
  s_waitcnt lgkmcnt(2)
  v_mfma_f32_32x32x16_bf16 v[0:15], a[92:95], v[44:47], v[0:15]
  ds_read_b128 v[40:43], v205 offset:6144
  v_mfma_f32_32x32x16_bf16 v[16:31], v[44:47], a[236:239], v[16:31]
  s_waitcnt lgkmcnt(2)
  v_mfma_f32_32x32x16_bf16 v[0:15], a[96:99], v[32:35], v[0:15]
  ds_read_b128 v[44:47], v206 offset:6144
  v_mfma_f32_32x32x16_bf16 v[16:31], v[32:35], a[240:243], v[16:31]
  s_waitcnt lgkmcnt(2)
  v_mfma_f32_32x32x16_bf16 v[0:15], a[100:103], v[36:39], v[0:15]
  ds_read_b128 v[32:35], v203 offset:7168
  v_mfma_f32_32x32x16_bf16 v[16:31], v[36:39], a[244:247], v[16:31]
  s_waitcnt lgkmcnt(2)
  v_mfma_f32_32x32x16_bf16 v[0:15], a[104:107], v[40:43], v[0:15]
  ds_read_b128 v[36:39], v204 offset:7168
  v_mfma_f32_32x32x16_bf16 v[16:31], v[40:43], a[248:251], v[16:31]
  s_waitcnt lgkmcnt(2)
  v_mfma_f32_32x32x16_bf16 v[0:15], a[108:111], v[44:47], v[0:15]
  ds_read_b128 v[40:43], v205 offset:7168
  v_mfma_f32_32x32x16_bf16 v[16:31], v[44:47], a[252:255], v[16:31]
  s_waitcnt lgkmcnt(2)
  v_mfma_f32_32x32x16_bf16 v[0:15], a[112:115], v[32:35], v[0:15]
  ds_read_b128 v[44:47], v206 offset:7168
  v_mfma_f32_32x32x16_bf16 v[16:31], v[32:35], v[224:227], v[16:31]
  s_waitcnt lgkmcnt(2)
  v_mfma_f32_32x32x16_bf16 v[0:15], a[116:119], v[36:39], v[0:15]
  ds_read_b128 v[32:35], v203 offset:8192
  v_mfma_f32_32x32x16_bf16 v[16:31], v[36:39], v[228:231], v[16:31]
  s_waitcnt lgkmcnt(2)
  v_mfma_f32_32x32x16_bf16 v[0:15], a[120:123], v[40:43], v[0:15]
  ds_read_b128 v[36:39], v204 offset:8192
  v_mfma_f32_32x32x16_bf16 v[16:31], v[40:43], v[232:235], v[16:31]
  s_waitcnt lgkmcnt(2)
  v_mfma_f32_32x32x16_bf16 v[0:15], a[124:127], v[44:47], v[0:15]
  ds_read_b128 v[40:43], v205 offset:8192
  v_mfma_f32_32x32x16_bf16 v[16:31], v[44:47], v[236:239], v[16:31]
  s_waitcnt lgkmcnt(2)
  v_mfma_f32_32x32x16_bf16 v[0:15], a[128:131], v[32:35], v[0:15]
  ds_read_b128 v[44:47], v206 offset:8192
  v_mfma_f32_32x32x16_bf16 v[16:31], v[32:35], v[240:243], v[16:31]
  s_waitcnt lgkmcnt(2)
  v_mfma_f32_32x32x16_bf16 v[0:15], a[132:135], v[36:39], v[0:15]
  v_mfma_f32_32x32x16_bf16 v[16:31], v[36:39], v[244:247], v[16:31]
  s_waitcnt lgkmcnt(1)
  v_mfma_f32_32x32x16_bf16 v[0:15], a[136:139], v[40:43], v[0:15]
  v_mfma_f32_32x32x16_bf16 v[16:31], v[40:43], v[248:251], v[16:31]
  s_waitcnt lgkmcnt(0)
  v_mfma_f32_32x32x16_bf16 v[0:15], a[140:143], v[44:47], v[0:15]
  v_mfma_f32_32x32x16_bf16 v[16:31], v[44:47], v[252:255], v[16:31]
  s_mul_i32 s64, s59, 655360
  s_lshl_b32 s55, s58, 14
  s_add_u32 s64, s64, s55
  s_add_u32 s64, s64, 1048576
  s_add_u32 s72, s64, s69
  s_add_u32 s73, s64, s66
  s_add_u32 s59, s59, 7
  s_waitcnt vmcnt(0)
  s_barrier
  s_cmp_eq_u32 s1, 1
  s_cbranch_scc1 W_ver_ok
  v_mov_b32 v33, 163832
  s_cmp_eq_u32 s52, 0
  s_cbranch_scc0 W_ver_b
  s_waitcnt vmcnt(0)
  s_mov_b64 exec, 1
  ds_write_b32 v33, v197
  s_mov_b64 exec, -1
  s_waitcnt lgkmcnt(0)
W_ver_b:
  s_barrier
  ds_read_b32 v32, v33
  s_waitcnt lgkmcnt(0)
  v_readfirstlane_b32 s54, v32
  s_nop 0
  s_bitcmp1_b32 s54, s0
  s_cbranch_scc1 L_conf
W_ver_ok:
  s_lshr_b32 s55, s53, 1
  s_and_b32 s56, s53, 1
  s_lshl_b32 s56, s56, 13
  s_lshl_b32 s55, s55, 8
  s_add_u32 s55, s55, s56
  s_add_u32 s55, s55, 393216
  s_cmp_lt_u32 s53, 64
  s_cselect_b32 s71, s55, 268435456
  v_mov_b32 v211, 0
  s_mov_b64 exec, 1
  buffer_store_dword v211, v211, s[8:11], s71 offen sc1
  s_mov_b64 exec, -1
  s_cmp_eq_u32 s59, 7
  s_cbranch_scc0 KV_na
  s_mul_i32 s54, s58, 2176
  s_mul_i32 s55, s52, 69632
  s_add_u32 s55, s55, s54
  s_add_u32 s55, s55, 0
  s_add_u32 s54, s54, 278528
  s_and_b32 s56, s58, 7
  s_lshl_b32 s56, s56, 12
  s_bfe_u32 s57, s58, 0x10003
  s_lshl_b32 s57, s57, 11
  s_add_u32 s56, s56, s57
  s_add_u32 s54, s56, 262144
  s_lshr_b32 s57, s58, 4
  s_lshl_b32 s57, s57, 15
  s_add_u32 s56, s56, s57
  s_lshl_b32 s57, s52, 16
  s_add_u32 s56, s56, s57
  s_add_u32 s55, s56, 0
  s_lshl_b32 s56, s58, 14
  s_mul_i32 s57, s52, 3072
  s_add_u32 s56, s56, s57
  s_add_u32 s56, s56, 360448
  s_cmp_lt_u32 s58, 2
  s_cselect_b32 s56, s56, 268435456
  s_cmp_eq_u32 s52, 0
  s_cselect_b32 s54, s54, 268435456
  buffer_store_dwordx4 v[64:67], v201, s[8:11], s55 offen offset:0 sc1
  buffer_store_dwordx4 v[64:67], v201, s[8:11], s55 offen offset:1024 sc1
  buffer_store_dwordx4 v[64:67], v201, s[8:11], s54 offen offset:0 sc1
  buffer_store_dwordx4 v[64:67], v201, s[8:11], s54 offen offset:1024 sc1
  buffer_store_dwordx4 v[64:67], v201, s[8:11], s56 offen offset:0 sc1
  buffer_store_dwordx4 v[64:67], v201, s[8:11], s56 offen offset:1024 sc1
  buffer_store_dwordx4 v[64:67], v201, s[8:11], s56 offen offset:2048 sc1
KV_na:
KV_loop:
  s_add_u32 s60, s60, 258048
  ds_read_b128 v[32:35], v203 offset:36864
  ds_read_b128 v[36:39], v204 offset:36864
  ds_read_b128 v[40:43], v205 offset:36864
  s_waitcnt lgkmcnt(2)
  v_mfma_f32_32x32x16_bf16 v[68:83], a[0:3], v[32:35], 0
  ds_read_b128 v[44:47], v206 offset:36864
  s_add_u32 m0, s67, 0
  s_nop 0
  buffer_load_dwordx4 v202, s[4:7], s60 offen offset:0 lds
  v_mfma_f32_32x32x16_bf16 v[84:99], v[32:35], a[144:147], 0
  s_waitcnt lgkmcnt(2)
  v_mfma_f32_32x32x16_bf16 v[68:83], a[4:7], v[36:39], v[68:83]
  ds_read_b128 v[32:35], v203 offset:37888
  s_add_u32 m0, s67, 896
  s_nop 0
  buffer_load_dwordx4 v202, s[4:7], s60 offen offset:128 lds
  v_mfma_f32_32x32x16_bf16 v[84:99], v[36:39], a[148:151], v[84:99]
  s_waitcnt lgkmcnt(2)
  v_mfma_f32_32x32x16_bf16 v[68:83], a[8:11], v[40:43], v[68:83]
  ds_read_b128 v[36:39], v204 offset:37888
  s_add_u32 m0, s67, 1792
  s_nop 0
  buffer_load_dwordx4 v202, s[4:7], s60 offen offset:256 lds
  v_mfma_f32_32x32x16_bf16 v[84:99], v[40:43], a[152:155], v[84:99]
  s_waitcnt lgkmcnt(2)
  v_mfma_f32_32x32x16_bf16 v[68:83], a[12:15], v[44:47], v[68:83]
  ds_read_b128 v[40:43], v205 offset:37888
  s_add_u32 m0, s67, 2688
  s_nop 0
  buffer_load_dwordx4 v202, s[4:7], s60 offen offset:384 lds
  v_mfma_f32_32x32x16_bf16 v[84:99], v[44:47], a[156:159], v[84:99]
  s_waitcnt lgkmcnt(2)
  v_mfma_f32_32x32x16_bf16 v[68:83], a[16:19], v[32:35], v[68:83]
  ds_read_b128 v[44:47], v206 offset:37888
  s_add_u32 m0, s67, 3584
  s_nop 0
  buffer_load_dwordx4 v202, s[4:7], s60 offen offset:512 lds
  v_mfma_f32_32x32x16_bf16 v[84:99], v[32:35], a[160:163], v[84:99]
  s_waitcnt lgkmcnt(2)
  v_mfma_f32_32x32x16_bf16 v[68:83], a[20:23], v[36:39], v[68:83]
  ds_read_b128 v[32:35], v203 offset:38912
  s_add_u32 m0, s67, 4480
  s_nop 0
  buffer_load_dwordx4 v202, s[4:7], s60 offen offset:640 lds
  v_mfma_f32_32x32x16_bf16 v[84:99], v[36:39], a[164:167], v[84:99]
  s_waitcnt lgkmcnt(2)
  v_mfma_f32_32x32x16_bf16 v[68:83], a[24:27], v[40:43], v[68:83]
  ds_read_b128 v[36:39], v204 offset:38912
  s_add_u32 m0, s67, 5376
  s_nop 0
  buffer_load_dwordx4 v202, s[4:7], s60 offen offset:768 lds
  v_mfma_f32_32x32x16_bf16 v[84:99], v[40:43], a[168:171], v[84:99]
  s_waitcnt lgkmcnt(2)
  v_mfma_f32_32x32x16_bf16 v[68:83], a[28:31], v[44:47], v[68:83]
  ds_read_b128 v[40:43], v205 offset:38912
  s_add_u32 m0, s67, 6272
  s_nop 0
  buffer_load_dwordx4 v202, s[4:7], s60 offen offset:896 lds
  v_mfma_f32_32x32x16_bf16 v[84:99], v[44:47], a[172:175], v[84:99]
  s_waitcnt lgkmcnt(2)
  v_mfma_f32_32x32x16_bf16 v[68:83], a[32:35], v[32:35], v[68:83]
  ds_read_b128 v[44:47], v206 offset:38912
  s_add_u32 m0, s67, 7168
  s_nop 0
  buffer_load_dwordx4 v202, s[4:7], s60 offen offset:1024 lds
  v_mfma_f32_32x32x16_bf16 v[84:99], v[32:35], a[176:179], v[84:99]
  s_waitcnt lgkmcnt(2)
  v_mfma_f32_32x32x16_bf16 v[68:83], a[36:39], v[36:39], v[68:83]
  ds_read_b128 v[32:35], v203 offset:39936
  v_mul_f32 v0, s68, v0
  v_mul_f32 v1, s68, v1
  v_mul_f32 v2, s68, v2
  v_mul_f32 v3, s68, v3
  v_mfma_f32_32x32x16_bf16 v[84:99], v[36:39], a[180:183], v[84:99]
  v_mul_f32 v4, s68, v4
  v_mul_f32 v5, s68, v5
  v_mul_f32 v6, s68, v6
  v_mul_f32 v7, s68, v7
  s_waitcnt lgkmcnt(2)
  v_mfma_f32_32x32x16_bf16 v[68:83], a[40:43], v[40:43], v[68:83]
  ds_read_b128 v[36:39], v204 offset:39936
  v_cvt_pk_bf16_f32 v48, v0, v4
  v_cvt_pk_bf16_f32 v49, v1, v5
  v_cvt_pk_bf16_f32 v50, v2, v6
  v_cvt_pk_bf16_f32 v51, v3, v7
  v_mfma_f32_32x32x16_bf16 v[84:99], v[40:43], a[184:187], v[84:99]
  buffer_store_dwordx4 v[48:51], v216, s[8:11], s72 offen offset:0 sc1
  s_waitcnt lgkmcnt(2)
  v_mfma_f32_32x32x16_bf16 v[68:83], a[44:47], v[44:47], v[68:83]
  ds_read_b128 v[40:43], v205 offset:39936
  v_mfma_f32_32x32x16_bf16 v[84:99], v[44:47], a[188:191], v[84:99]
  s_waitcnt lgkmcnt(2)
  v_mfma_f32_32x32x16_bf16 v[68:83], a[48:51], v[32:35], v[68:83]
  ds_read_b128 v[44:47], v206 offset:39936
  v_mul_f32 v8, s68, v8
  v_mul_f32 v9, s68, v9
  v_mul_f32 v10, s68, v10
  v_mul_f32 v11, s68, v11
  v_mfma_f32_32x32x16_bf16 v[84:99], v[32:35], a[192:195], v[84:99]
  v_mul_f32 v12, s68, v12
  v_mul_f32 v13, s68, v13
  v_mul_f32 v14, s68, v14
  v_mul_f32 v15, s68, v15
  s_waitcnt lgkmcnt(2)
  v_mfma_f32_32x32x16_bf16 v[68:83], a[52:55], v[36:39], v[68:83]
  ds_read_b128 v[32:35], v203 offset:40960
  v_cvt_pk_bf16_f32 v52, v8, v12
  v_cvt_pk_bf16_f32 v53, v9, v13
  v_cvt_pk_bf16_f32 v54, v10, v14
  v_cvt_pk_bf16_f32 v55, v11, v15
  v_mfma_f32_32x32x16_bf16 v[84:99], v[36:39], a[196:199], v[84:99]
  buffer_store_dwordx4 v[52:55], v216, s[8:11], s72 offen offset:256 sc1
  s_waitcnt lgkmcnt(2)
  v_mfma_f32_32x32x16_bf16 v[68:83], a[56:59], v[40:43], v[68:83]
  ds_read_b128 v[36:39], v204 offset:40960
  v_mfma_f32_32x32x16_bf16 v[84:99], v[40:43], a[200:203], v[84:99]
  s_waitcnt lgkmcnt(2)
  v_mfma_f32_32x32x16_bf16 v[68:83], a[60:63], v[44:47], v[68:83]
  ds_read_b128 v[40:43], v205 offset:40960
  v_cvt_pk_bf16_f32 v56, v16, v17
  v_cvt_pk_bf16_f32 v57, v20, v21
  v_cvt_pk_bf16_f32 v58, v24, v25
  v_cvt_pk_bf16_f32 v59, v28, v29
  v_mfma_f32_32x32x16_bf16 v[84:99], v[44:47], a[204:207], v[84:99]
  buffer_store_dwordx4 v[56:59], v217, s[8:11], s64 offen offset:0 sc1
  s_waitcnt lgkmcnt(2)
  v_mfma_f32_32x32x16_bf16 v[68:83], a[64:67], v[32:35], v[68:83]
  ds_read_b128 v[44:47], v206 offset:40960
  v_mfma_f32_32x32x16_bf16 v[84:99], v[32:35], a[208:211], v[84:99]
  s_waitcnt lgkmcnt(2)
  v_mfma_f32_32x32x16_bf16 v[68:83], a[68:71], v[36:39], v[68:83]
  ds_read_b128 v[32:35], v203 offset:41984
  v_cvt_pk_bf16_f32 v60, v18, v19
  v_cvt_pk_bf16_f32 v61, v22, v23
  v_cvt_pk_bf16_f32 v62, v26, v27
  v_cvt_pk_bf16_f32 v63, v30, v31
  v_mfma_f32_32x32x16_bf16 v[84:99], v[36:39], a[212:215], v[84:99]
  buffer_store_dwordx4 v[60:63], v217, s[8:11], s64 offen offset:256 sc1
  s_waitcnt lgkmcnt(2)
  v_mfma_f32_32x32x16_bf16 v[68:83], a[72:75], v[40:43], v[68:83]
  ds_read_b128 v[36:39], v204 offset:41984
  v_mfma_f32_32x32x16_bf16 v[84:99], v[40:43], a[216:219], v[84:99]
  s_waitcnt lgkmcnt(2)
  v_mfma_f32_32x32x16_bf16 v[68:83], a[76:79], v[44:47], v[68:83]
  ds_read_b128 v[40:43], v205 offset:41984
  buffer_store_dwordx4 v[64:67], v201, s[8:11], s73 offen sc1
  v_mfma_f32_32x32x16_bf16 v[84:99], v[44:47], a[220:223], v[84:99]
  s_waitcnt lgkmcnt(2)
  v_mfma_f32_32x32x16_bf16 v[68:83], a[80:83], v[32:35], v[68:83]
  ds_read_b128 v[44:47], v206 offset:41984
  v_mfma_f32_32x32x16_bf16 v[84:99], v[32:35], a[224:227], v[84:99]
  s_waitcnt lgkmcnt(2)
  v_mfma_f32_32x32x16_bf16 v[68:83], a[84:87], v[36:39], v[68:83]
  ds_read_b128 v[32:35], v203 offset:43008
  v_mfma_f32_32x32x16_bf16 v[84:99], v[36:39], a[228:231], v[84:99]
  s_waitcnt lgkmcnt(2)
  v_mfma_f32_32x32x16_bf16 v[68:83], a[88:91], v[40:43], v[68:83]
  ds_read_b128 v[36:39], v204 offset:43008
  v_mfma_f32_32x32x16_bf16 v[84:99], v[40:43], a[232:235], v[84:99]
  s_waitcnt lgkmcnt(2)
  v_mfma_f32_32x32x16_bf16 v[68:83], a[92:95], v[44:47], v[68:83]
  ds_read_b128 v[40:43], v205 offset:43008
  v_mfma_f32_32x32x16_bf16 v[84:99], v[44:47], a[236:239], v[84:99]
  s_waitcnt lgkmcnt(2)
  v_mfma_f32_32x32x16_bf16 v[68:83], a[96:99], v[32:35], v[68:83]
  ds_read_b128 v[44:47], v206 offset:43008
  v_mfma_f32_32x32x16_bf16 v[84:99], v[32:35], a[240:243], v[84:99]
  s_waitcnt lgkmcnt(2)
  v_mfma_f32_32x32x16_bf16 v[68:83], a[100:103], v[36:39], v[68:83]
  ds_read_b128 v[32:35], v203 offset:44032
  v_mfma_f32_32x32x16_bf16 v[84:99], v[36:39], a[244:247], v[84:99]
  s_waitcnt lgkmcnt(2)
  v_mfma_f32_32x32x16_bf16 v[68:83], a[104:107], v[40:43], v[68:83]
  ds_read_b128 v[36:39], v204 offset:44032
  v_mfma_f32_32x32x16_bf16 v[84:99], v[40:43], a[248:251], v[84:99]
  s_waitcnt lgkmcnt(2)
  v_mfma_f32_32x32x16_bf16 v[68:83], a[108:111], v[44:47], v[68:83]
  ds_read_b128 v[40:43], v205 offset:44032
  v_mfma_f32_32x32x16_bf16 v[84:99], v[44:47], a[252:255], v[84:99]
  s_waitcnt lgkmcnt(2)
  v_mfma_f32_32x32x16_bf16 v[68:83], a[112:115], v[32:35], v[68:83]
  ds_read_b128 v[44:47], v206 offset:44032
  v_mfma_f32_32x32x16_bf16 v[84:99], v[32:35], v[224:227], v[84:99]
  s_waitcnt lgkmcnt(2)
  v_mfma_f32_32x32x16_bf16 v[68:83], a[116:119], v[36:39], v[68:83]
  ds_read_b128 v[32:35], v203 offset:45056
  v_mfma_f32_32x32x16_bf16 v[84:99], v[36:39], v[228:231], v[84:99]
  s_waitcnt lgkmcnt(2)
  v_mfma_f32_32x32x16_bf16 v[68:83], a[120:123], v[40:43], v[68:83]
  ds_read_b128 v[36:39], v204 offset:45056
  v_mfma_f32_32x32x16_bf16 v[84:99], v[40:43], v[232:235], v[84:99]
  s_waitcnt lgkmcnt(2)
  v_mfma_f32_32x32x16_bf16 v[68:83], a[124:127], v[44:47], v[68:83]
  ds_read_b128 v[40:43], v205 offset:45056
  v_mfma_f32_32x32x16_bf16 v[84:99], v[44:47], v[236:239], v[84:99]
  s_waitcnt lgkmcnt(2)
  v_mfma_f32_32x32x16_bf16 v[68:83], a[128:131], v[32:35], v[68:83]
  ds_read_b128 v[44:47], v206 offset:45056
  v_mfma_f32_32x32x16_bf16 v[84:99], v[32:35], v[240:243], v[84:99]
  s_waitcnt lgkmcnt(2)
  v_mfma_f32_32x32x16_bf16 v[68:83], a[132:135], v[36:39], v[68:83]
  v_mfma_f32_32x32x16_bf16 v[84:99], v[36:39], v[244:247], v[84:99]
  s_waitcnt lgkmcnt(1)
  v_mfma_f32_32x32x16_bf16 v[68:83], a[136:139], v[40:43], v[68:83]
  v_mfma_f32_32x32x16_bf16 v[84:99], v[40:43], v[248:251], v[84:99]
  s_waitcnt lgkmcnt(0)
  v_mfma_f32_32x32x16_bf16 v[68:83], a[140:143], v[44:47], v[68:83]
  v_mfma_f32_32x32x16_bf16 v[84:99], v[44:47], v[252:255], v[84:99]
  s_mul_i32 s64, s59, 655360
  s_lshl_b32 s55, s58, 14
  s_add_u32 s64, s64, s55
  s_add_u32 s64, s64, 1048576
  s_add_u32 s72, s64, s69
  s_add_u32 s73, s64, s66
  s_add_u32 s59, s59, 7
  s_cmp_ge_u32 s59, 64
  s_cbranch_scc1 KV_done1
  s_waitcnt vmcnt(5)
  s_barrier
  s_add_u32 s60, s60, 258048
  ds_read_b128 v[32:35], v203 offset:0
  ds_read_b128 v[36:39], v204 offset:0
  ds_read_b128 v[40:43], v205 offset:0
  s_waitcnt lgkmcnt(2)
  v_mfma_f32_32x32x16_bf16 v[0:15], a[0:3], v[32:35], 0
  ds_read_b128 v[44:47], v206 offset:0
  s_add_u32 m0, s67, 36864
  s_nop 0
  buffer_load_dwordx4 v202, s[4:7], s60 offen offset:0 lds
  v_mfma_f32_32x32x16_bf16 v[16:31], v[32:35], a[144:147], 0
  s_waitcnt lgkmcnt(2)
  v_mfma_f32_32x32x16_bf16 v[0:15], a[4:7], v[36:39], v[0:15]
  ds_read_b128 v[32:35], v203 offset:1024
  s_add_u32 m0, s67, 37760
  s_nop 0
  buffer_load_dwordx4 v202, s[4:7], s60 offen offset:128 lds
  v_mfma_f32_32x32x16_bf16 v[16:31], v[36:39], a[148:151], v[16:31]
  s_waitcnt lgkmcnt(2)
  v_mfma_f32_32x32x16_bf16 v[0:15], a[8:11], v[40:43], v[0:15]
  ds_read_b128 v[36:39], v204 offset:1024
  s_add_u32 m0, s67, 38656
  s_nop 0
  buffer_load_dwordx4 v202, s[4:7], s60 offen offset:256 lds
  v_mfma_f32_32x32x16_bf16 v[16:31], v[40:43], a[152:155], v[16:31]
  s_waitcnt lgkmcnt(2)
  v_mfma_f32_32x32x16_bf16 v[0:15], a[12:15], v[44:47], v[0:15]
  ds_read_b128 v[40:43], v205 offset:1024
  s_add_u32 m0, s67, 39552
  s_nop 0
  buffer_load_dwordx4 v202, s[4:7], s60 offen offset:384 lds
  v_mfma_f32_32x32x16_bf16 v[16:31], v[44:47], a[156:159], v[16:31]
  s_waitcnt lgkmcnt(2)
  v_mfma_f32_32x32x16_bf16 v[0:15], a[16:19], v[32:35], v[0:15]
  ds_read_b128 v[44:47], v206 offset:1024
  s_add_u32 m0, s67, 40448
  s_nop 0
  buffer_load_dwordx4 v202, s[4:7], s60 offen offset:512 lds
  v_mfma_f32_32x32x16_bf16 v[16:31], v[32:35], a[160:163], v[16:31]
  s_waitcnt lgkmcnt(2)
  v_mfma_f32_32x32x16_bf16 v[0:15], a[20:23], v[36:39], v[0:15]
  ds_read_b128 v[32:35], v203 offset:2048
  s_add_u32 m0, s67, 41344
  s_nop 0
  buffer_load_dwordx4 v202, s[4:7], s60 offen offset:640 lds
  v_mfma_f32_32x32x16_bf16 v[16:31], v[36:39], a[164:167], v[16:31]
  s_waitcnt lgkmcnt(2)
  v_mfma_f32_32x32x16_bf16 v[0:15], a[24:27], v[40:43], v[0:15]
  ds_read_b128 v[36:39], v204 offset:2048
  s_add_u32 m0, s67, 42240
  s_nop 0
  buffer_load_dwordx4 v202, s[4:7], s60 offen offset:768 lds
  v_mfma_f32_32x32x16_bf16 v[16:31], v[40:43], a[168:171], v[16:31]
  s_waitcnt lgkmcnt(2)
  v_mfma_f32_32x32x16_bf16 v[0:15], a[28:31], v[44:47], v[0:15]
  ds_read_b128 v[40:43], v205 offset:2048
  s_add_u32 m0, s67, 43136
  s_nop 0
  buffer_load_dwordx4 v202, s[4:7], s60 offen offset:896 lds
  v_mfma_f32_32x32x16_bf16 v[16:31], v[44:47], a[172:175], v[16:31]
  s_waitcnt lgkmcnt(2)
  v_mfma_f32_32x32x16_bf16 v[0:15], a[32:35], v[32:35], v[0:15]
  ds_read_b128 v[44:47], v206 offset:2048
  s_add_u32 m0, s67, 44032
  s_nop 0
  buffer_load_dwordx4 v202, s[4:7], s60 offen offset:1024 lds
  v_mfma_f32_32x32x16_bf16 v[16:31], v[32:35], a[176:179], v[16:31]
  s_waitcnt lgkmcnt(2)
  v_mfma_f32_32x32x16_bf16 v[0:15], a[36:39], v[36:39], v[0:15]
  ds_read_b128 v[32:35], v203 offset:3072
  v_mul_f32 v68, s68, v68
  v_mul_f32 v69, s68, v69
  v_mul_f32 v70, s68, v70
  v_mul_f32 v71, s68, v71
  v_mfma_f32_32x32x16_bf16 v[16:31], v[36:39], a[180:183], v[16:31]
  v_mul_f32 v72, s68, v72
  v_mul_f32 v73, s68, v73
  v_mul_f32 v74, s68, v74
  v_mul_f32 v75, s68, v75
  s_waitcnt lgkmcnt(2)
  v_mfma_f32_32x32x16_bf16 v[0:15], a[40:43], v[40:43], v[0:15]
  ds_read_b128 v[36:39], v204 offset:3072
  v_cvt_pk_bf16_f32 v48, v68, v72
  v_cvt_pk_bf16_f32 v49, v69, v73
  v_cvt_pk_bf16_f32 v50, v70, v74
  v_cvt_pk_bf16_f32 v51, v71, v75
  v_mfma_f32_32x32x16_bf16 v[16:31], v[40:43], a[184:187], v[16:31]
  buffer_store_dwordx4 v[48:51], v216, s[8:11], s72 offen offset:0 sc1
  s_waitcnt lgkmcnt(2)
  v_mfma_f32_32x32x16_bf16 v[0:15], a[44:47], v[44:47], v[0:15]
  ds_read_b128 v[40:43], v205 offset:3072
  v_mfma_f32_32x32x16_bf16 v[16:31], v[44:47], a[188:191], v[16:31]
  s_waitcnt lgkmcnt(2)
  v_mfma_f32_32x32x16_bf16 v[0:15], a[48:51], v[32:35], v[0:15]
  ds_read_b128 v[44:47], v206 offset:3072
  v_mul_f32 v76, s68, v76
  v_mul_f32 v77, s68, v77
  v_mul_f32 v78, s68, v78
  v_mul_f32 v79, s68, v79
  v_mfma_f32_32x32x16_bf16 v[16:31], v[32:35], a[192:195], v[16:31]
  v_mul_f32 v80, s68, v80
  v_mul_f32 v81, s68, v81
  v_mul_f32 v82, s68, v82
  v_mul_f32 v83, s68, v83
  s_waitcnt lgkmcnt(2)
  v_mfma_f32_32x32x16_bf16 v[0:15], a[52:55], v[36:39], v[0:15]
  ds_read_b128 v[32:35], v203 offset:4096
  v_cvt_pk_bf16_f32 v52, v76, v80
  v_cvt_pk_bf16_f32 v53, v77, v81
  v_cvt_pk_bf16_f32 v54, v78, v82
  v_cvt_pk_bf16_f32 v55, v79, v83
  v_mfma_f32_32x32x16_bf16 v[16:31], v[36:39], a[196:199], v[16:31]
  buffer_store_dwordx4 v[52:55], v216, s[8:11], s72 offen offset:256 sc1
  s_waitcnt lgkmcnt(2)
  v_mfma_f32_32x32x16_bf16 v[0:15], a[56:59], v[40:43], v[0:15]
  ds_read_b128 v[36:39], v204 offset:4096
  v_mfma_f32_32x32x16_bf16 v[16:31], v[40:43], a[200:203], v[16:31]
  s_waitcnt lgkmcnt(2)
  v_mfma_f32_32x32x16_bf16 v[0:15], a[60:63], v[44:47], v[0:15]
  ds_read_b128 v[40:43], v205 offset:4096
  v_cvt_pk_bf16_f32 v56, v84, v85
  v_cvt_pk_bf16_f32 v57, v88, v89
  v_cvt_pk_bf16_f32 v58, v92, v93
  v_cvt_pk_bf16_f32 v59, v96, v97
  v_mfma_f32_32x32x16_bf16 v[16:31], v[44:47], a[204:207], v[16:31]
  buffer_store_dwordx4 v[56:59], v217, s[8:11], s64 offen offset:0 sc1
  s_waitcnt lgkmcnt(2)
  v_mfma_f32_32x32x16_bf16 v[0:15], a[64:67], v[32:35], v[0:15]
  ds_read_b128 v[44:47], v206 offset:4096
  v_mfma_f32_32x32x16_bf16 v[16:31], v[32:35], a[208:211], v[16:31]
  s_waitcnt lgkmcnt(2)
  v_mfma_f32_32x32x16_bf16 v[0:15], a[68:71], v[36:39], v[0:15]
  ds_read_b128 v[32:35], v203 offset:5120
  v_cvt_pk_bf16_f32 v60, v86, v87
  v_cvt_pk_bf16_f32 v61, v90, v91
  v_cvt_pk_bf16_f32 v62, v94, v95
  v_cvt_pk_bf16_f32 v63, v98, v99
  v_mfma_f32_32x32x16_bf16 v[16:31], v[36:39], a[212:215], v[16:31]
  buffer_store_dwordx4 v[60:63], v217, s[8:11], s64 offen offset:256 sc1
  s_waitcnt lgkmcnt(2)
  v_mfma_f32_32x32x16_bf16 v[0:15], a[72:75], v[40:43], v[0:15]
  ds_read_b128 v[36:39], v204 offset:5120
  v_mfma_f32_32x32x16_bf16 v[16:31], v[40:43], a[216:219], v[16:31]
  s_waitcnt lgkmcnt(2)
  v_mfma_f32_32x32x16_bf16 v[0:15], a[76:79], v[44:47], v[0:15]
  ds_read_b128 v[40:43], v205 offset:5120
  buffer_store_dwordx4 v[64:67], v201, s[8:11], s73 offen sc1
  v_mfma_f32_32x32x16_bf16 v[16:31], v[44:47], a[220:223], v[16:31]
  s_waitcnt lgkmcnt(2)
  v_mfma_f32_32x32x16_bf16 v[0:15], a[80:83], v[32:35], v[0:15]
  ds_read_b128 v[44:47], v206 offset:5120
  v_mfma_f32_32x32x16_bf16 v[16:31], v[32:35], a[224:227], v[16:31]
  s_waitcnt lgkmcnt(2)
  v_mfma_f32_32x32x16_bf16 v[0:15], a[84:87], v[36:39], v[0:15]
  ds_read_b128 v[32:35], v203 offset:6144
  v_mfma_f32_32x32x16_bf16 v[16:31], v[36:39], a[228:231], v[16:31]
  s_waitcnt lgkmcnt(2)
  v_mfma_f32_32x32x16_bf16 v[0:15], a[88:91], v[40:43], v[0:15]
  ds_read_b128 v[36:39], v204 offset:6144
  v_mfma_f32_32x32x16_bf16 v[16:31], v[40:43], a[232:235], v[16:31]
  s_waitcnt lgkmcnt(2)
  v_mfma_f32_32x32x16_bf16 v[0:15], a[92:95], v[44:47], v[0:15]
  ds_read_b128 v[40:43], v205 offset:6144
  v_mfma_f32_32x32x16_bf16 v[16:31], v[44:47], a[236:239], v[16:31]
  s_waitcnt lgkmcnt(2)
  v_mfma_f32_32x32x16_bf16 v[0:15], a[96:99], v[32:35], v[0:15]
  ds_read_b128 v[44:47], v206 offset:6144
  v_mfma_f32_32x32x16_bf16 v[16:31], v[32:35], a[240:243], v[16:31]
  s_waitcnt lgkmcnt(2)
  v_mfma_f32_32x32x16_bf16 v[0:15], a[100:103], v[36:39], v[0:15]
  ds_read_b128 v[32:35], v203 offset:7168
  v_mfma_f32_32x32x16_bf16 v[16:31], v[36:39], a[244:247], v[16:31]
  s_waitcnt lgkmcnt(2)
  v_mfma_f32_32x32x16_bf16 v[0:15], a[104:107], v[40:43], v[0:15]
  ds_read_b128 v[36:39], v204 offset:7168
  v_mfma_f32_32x32x16_bf16 v[16:31], v[40:43], a[248:251], v[16:31]
  s_waitcnt lgkmcnt(2)
  v_mfma_f32_32x32x16_bf16 v[0:15], a[108:111], v[44:47], v[0:15]
  ds_read_b128 v[40:43], v205 offset:7168
  v_mfma_f32_32x32x16_bf16 v[16:31], v[44:47], a[252:255], v[16:31]
  s_waitcnt lgkmcnt(2)
  v_mfma_f32_32x32x16_bf16 v[0:15], a[112:115], v[32:35], v[0:15]
  ds_read_b128 v[44:47], v206 offset:7168
  v_mfma_f32_32x32x16_bf16 v[16:31], v[32:35], v[224:227], v[16:31]
  s_waitcnt lgkmcnt(2)
  v_mfma_f32_32x32x16_bf16 v[0:15], a[116:119], v[36:39], v[0:15]
  ds_read_b128 v[32:35], v203 offset:8192
  v_mfma_f32_32x32x16_bf16 v[16:31], v[36:39], v[228:231], v[16:31]
  s_waitcnt lgkmcnt(2)
  v_mfma_f32_32x32x16_bf16 v[0:15], a[120:123], v[40:43], v[0:15]
  ds_read_b128 v[36:39], v204 offset:8192
  v_mfma_f32_32x32x16_bf16 v[16:31], v[40:43], v[232:235], v[16:31]
  s_waitcnt lgkmcnt(2)
  v_mfma_f32_32x32x16_bf16 v[0:15], a[124:127], v[44:47], v[0:15]
  ds_read_b128 v[40:43], v205 offset:8192
  v_mfma_f32_32x32x16_bf16 v[16:31], v[44:47], v[236:239], v[16:31]
  s_waitcnt lgkmcnt(2)
  v_mfma_f32_32x32x16_bf16 v[0:15], a[128:131], v[32:35], v[0:15]
  ds_read_b128 v[44:47], v206 offset:8192
  v_mfma_f32_32x32x16_bf16 v[16:31], v[32:35], v[240:243], v[16:31]
  s_waitcnt lgkmcnt(2)
  v_mfma_f32_32x32x16_bf16 v[0:15], a[132:135], v[36:39], v[0:15]
  v_mfma_f32_32x32x16_bf16 v[16:31], v[36:39], v[244:247], v[16:31]
  s_waitcnt lgkmcnt(1)
  v_mfma_f32_32x32x16_bf16 v[0:15], a[136:139], v[40:43], v[0:15]
  v_mfma_f32_32x32x16_bf16 v[16:31], v[40:43], v[248:251], v[16:31]
  s_waitcnt lgkmcnt(0)
  v_mfma_f32_32x32x16_bf16 v[0:15], a[140:143], v[44:47], v[0:15]
  v_mfma_f32_32x32x16_bf16 v[16:31], v[44:47], v[252:255], v[16:31]
  s_mul_i32 s64, s59, 655360
  s_lshl_b32 s55, s58, 14
  s_add_u32 s64, s64, s55
  s_add_u32 s64, s64, 1048576
  s_add_u32 s72, s64, s69
  s_add_u32 s73, s64, s66
  s_add_u32 s59, s59, 7
  s_cmp_ge_u32 s59, 64
  s_cbranch_scc1 KV_done0
  s_sub_u32 s54, s59, 21
  s_cmp_lt_u32 s54, 7
  s_cbranch_scc1 KV_early
  s_waitcnt vmcnt(5)
  s_barrier
KV_cont:
  s_branch KV_loop
KV_early:
  s_waitcnt vmcnt(0)
  s_barrier
  s_cmp_eq_u32 s52, 0
  s_cbranch_scc0 KV_sig0
  v_mov_b32 v211, 1
  v_mov_b32 v212, 0
  s_mov_b64 exec, 1
  buffer_atomic_add v211, v212, s[12:15], s70 offen
  s_mov_b64 exec, -1
KV_sig0:
  s_branch KV_cont
KV_done1:
  s_nop 11
  v_mul_f32 v68, s68, v68
  v_mul_f32 v69, s68, v69
  v_mul_f32 v70, s68, v70
  v_mul_f32 v71, s68, v71
  v_mul_f32 v72, s68, v72
  v_mul_f32 v73, s68, v73
  v_mul_f32 v74, s68, v74
  v_mul_f32 v75, s68, v75
  v_cvt_pk_bf16_f32 v48, v68, v72
  v_cvt_pk_bf16_f32 v49, v69, v73
  v_cvt_pk_bf16_f32 v50, v70, v74
  v_cvt_pk_bf16_f32 v51, v71, v75
  buffer_store_dwordx4 v[48:51], v216, s[8:11], s72 offen offset:0 sc1
  v_mul_f32 v76, s68, v76
  v_mul_f32 v77, s68, v77
  v_mul_f32 v78, s68, v78
  v_mul_f32 v79, s68, v79
  v_mul_f32 v80, s68, v80
  v_mul_f32 v81, s68, v81
  v_mul_f32 v82, s68, v82
  v_mul_f32 v83, s68, v83
  v_cvt_pk_bf16_f32 v52, v76, v80
  v_cvt_pk_bf16_f32 v53, v77, v81
  v_cvt_pk_bf16_f32 v54, v78, v82
  v_cvt_pk_bf16_f32 v55, v79, v83
  buffer_store_dwordx4 v[52:55], v216, s[8:11], s72 offen offset:256 sc1
  v_cvt_pk_bf16_f32 v56, v84, v85
  v_cvt_pk_bf16_f32 v57, v88, v89
  v_cvt_pk_bf16_f32 v58, v92, v93
  v_cvt_pk_bf16_f32 v59, v96, v97
  buffer_store_dwordx4 v[56:59], v217, s[8:11], s64 offen offset:0 sc1
  v_cvt_pk_bf16_f32 v60, v86, v87
  v_cvt_pk_bf16_f32 v61, v90, v91
  v_cvt_pk_bf16_f32 v62, v94, v95
  v_cvt_pk_bf16_f32 v63, v98, v99
  buffer_store_dwordx4 v[60:63], v217, s[8:11], s64 offen offset:256 sc1
  buffer_store_dwordx4 v[64:67], v201, s[8:11], s73 offen sc1
  s_branch KV_fin
KV_done0:
  s_nop 11
  v_mul_f32 v0, s68, v0
  v_mul_f32 v1, s68, v1
  v_mul_f32 v2, s68, v2
  v_mul_f32 v3, s68, v3
  v_mul_f32 v4, s68, v4
  v_mul_f32 v5, s68, v5
  v_mul_f32 v6, s68, v6
  v_mul_f32 v7, s68, v7
  v_cvt_pk_bf16_f32 v48, v0, v4
  v_cvt_pk_bf16_f32 v49, v1, v5
  v_cvt_pk_bf16_f32 v50, v2, v6
  v_cvt_pk_bf16_f32 v51, v3, v7
  buffer_store_dwordx4 v[48:51], v216, s[8:11], s72 offen offset:0 sc1
  v_mul_f32 v8, s68, v8
  v_mul_f32 v9, s68, v9
  v_mul_f32 v10, s68, v10
  v_mul_f32 v11, s68, v11
  v_mul_f32 v12, s68, v12
  v_mul_f32 v13, s68, v13
  v_mul_f32 v14, s68, v14
  v_mul_f32 v15, s68, v15
  v_cvt_pk_bf16_f32 v52, v8, v12
  v_cvt_pk_bf16_f32 v53, v9, v13
  v_cvt_pk_bf16_f32 v54, v10, v14
  v_cvt_pk_bf16_f32 v55, v11, v15
  buffer_store_dwordx4 v[52:55], v216, s[8:11], s72 offen offset:256 sc1
  v_cvt_pk_bf16_f32 v56, v16, v17
  v_cvt_pk_bf16_f32 v57, v20, v21
  v_cvt_pk_bf16_f32 v58, v24, v25
  v_cvt_pk_bf16_f32 v59, v28, v29
  buffer_store_dwordx4 v[56:59], v217, s[8:11], s64 offen offset:0 sc1
  v_cvt_pk_bf16_f32 v60, v18, v19
  v_cvt_pk_bf16_f32 v61, v22, v23
  v_cvt_pk_bf16_f32 v62, v26, v27
  v_cvt_pk_bf16_f32 v63, v30, v31
  buffer_store_dwordx4 v[60:63], v217, s[8:11], s64 offen offset:256 sc1
  buffer_store_dwordx4 v[64:67], v201, s[8:11], s73 offen sc1
KV_fin:
  s_waitcnt vmcnt(0)
  s_barrier
  s_cmp_eq_u32 s52, 0
  s_cbranch_scc0 KV_sig
  v_mov_b32 v211, 256
  v_mov_b32 v212, 0
  s_mov_b64 exec, 1
  buffer_atomic_add v211, v212, s[12:15], s70 offen
  s_mov_b64 exec, -1
KV_sig:
  s_cmp_ge_u32 s53, 208
  s_cbranch_scc1 L_exit
  s_cmp_ge_u32 s53, 192
  s_cbranch_scc1 W_o
  s_cmp_lt_u32 s53, 64
  s_cbranch_scc1 W_h
  s_sub_u32 s54, s53, 64
  s_lshr_b32 s68, s54, 4
  s_and_b32 s69, s54, 15
  s_lshl_b32 s60, s69, 2
  s_sub_u32 s60, s60, 1
  s_max_i32 s60, s60, 0
  s_mul_i32 s60, s60, 36864
  s_add_u32 m0, s67, 0
  s_nop 0
  buffer_load_dwordx4 v202, s[4:7], s60 offen offset:0 lds
  s_add_u32 m0, s67, 896
  s_nop 0
  buffer_load_dwordx4 v202, s[4:7], s60 offen offset:128 lds
  s_add_u32 m0, s67, 1792
  s_nop 0
  buffer_load_dwordx4 v202, s[4:7], s60 offen offset:256 lds
  s_add_u32 m0, s67, 2688
  s_nop 0
  buffer_load_dwordx4 v202, s[4:7], s60 offen offset:384 lds
  s_add_u32 m0, s67, 3584
  s_nop 0
  buffer_load_dwordx4 v202, s[4:7], s60 offen offset:512 lds
  s_add_u32 m0, s67, 4480
  s_nop 0
  buffer_load_dwordx4 v202, s[4:7], s60 offen offset:640 lds
  s_add_u32 m0, s67, 5376
  s_nop 0
  buffer_load_dwordx4 v202, s[4:7], s60 offen offset:768 lds
  s_add_u32 m0, s67, 6272
  s_nop 0
  buffer_load_dwordx4 v202, s[4:7], s60 offen offset:896 lds
  s_add_u32 m0, s67, 7168
  s_nop 0
  buffer_load_dwordx4 v202, s[4:7], s60 offen offset:1024 lds
  v_and_b32 v211, 15, v200
  v_mul_u32_u24 v211, 72, v211
  v_lshrrev_b32 v212, 4, v200
  v_mul_u32_u24 v213, 1152, v212
  v_add_u32 v213, v213, v211
  s_lshl_b32 s54, s54, 2
  s_add_u32 s70, s54, s52
  s_mul_i32 s55, s70, 4608
  buffer_load_dwordx4 v[48:51], v213, s[4:7], s55 offen offset:0
  buffer_load_dwordx4 v[52:55], v213, s[4:7], s55 offen offset:16
  buffer_load_dwordx4 v[56:59], v213, s[4:7], s55 offen offset:32
  buffer_load_dwordx4 v[60:63], v213, s[4:7], s55 offen offset:48
  buffer_load_dwordx2 v[64:65], v213, s[4:7], s55 offen offset:64
  buffer_load_dwordx4 v[68:71], v211, s[44:47], 0 offen offset:0
  buffer_load_dwordx4 v[72:75], v211, s[44:47], 0 offen offset:16
  buffer_load_dwordx4 v[76:79], v211, s[44:47], 0 offen offset:32
  buffer_load_dwordx4 v[80:83], v211, s[44:47], 0 offen offset:48
  buffer_load_dwordx2 v[84:85], v211, s[44:47], 0 offen offset:64
  v_mov_b32 v0, 0
  v_mov_b32 v1, 0x3f803f80
  s_waitcnt vmcnt(9)
  v_lshlrev_b32 v2, 16, v48
  s_waitcnt vmcnt(4)
  v_lshlrev_b32 v3, 16, v68
  v_and_b32 v4, 0xffff0000, v48
  v_and_b32 v5, 0xffff0000, v68
  v_mul_f32 v2, v2, v3
  v_mul_f32 v4, v4, v5
  v_cvt_pk_bf16_f32 v2, v2, v4
  v_lshlrev_b32 v3, 16, v2
  v_and_b32 v4, 0xffff0000, v2
  v_add_f32 v0, v0, v3
  v_add_f32 v0, v0, v4
  v_lshlrev_b32 v2, 16, v49
  v_lshlrev_b32 v3, 16, v69
  v_and_b32 v4, 0xffff0000, v49
  v_and_b32 v5, 0xffff0000, v69
  v_mul_f32 v2, v2, v3
  v_mul_f32 v4, v4, v5
  v_cvt_pk_bf16_f32 v2, v2, v4
  v_lshlrev_b32 v3, 16, v2
  v_and_b32 v4, 0xffff0000, v2
  v_add_f32 v0, v0, v3
  v_add_f32 v0, v0, v4
  v_lshlrev_b32 v2, 16, v50
  v_lshlrev_b32 v3, 16, v70
  v_and_b32 v4, 0xffff0000, v50
  v_and_b32 v5, 0xffff0000, v70
  v_mul_f32 v2, v2, v3
  v_mul_f32 v4, v4, v5
  v_cvt_pk_bf16_f32 v2, v2, v4
  v_lshlrev_b32 v3, 16, v2
  v_and_b32 v4, 0xffff0000, v2
  v_add_f32 v0, v0, v3
  v_add_f32 v0, v0, v4
  v_lshlrev_b32 v2, 16, v51
  v_lshlrev_b32 v3, 16, v71
  v_and_b32 v4, 0xffff0000, v51
  v_and_b32 v5, 0xffff0000, v71
  v_mul_f32 v2, v2, v3
  v_mul_f32 v4, v4, v5
  v_cvt_pk_bf16_f32 v2, v2, v4
  v_lshlrev_b32 v3, 16, v2
  v_and_b32 v4, 0xffff0000, v2
  v_add_f32 v0, v0, v3
  v_add_f32 v0, v0, v4
  v_lshlrev_b32 v2, 16, v52
  s_waitcnt vmcnt(3)
  v_lshlrev_b32 v3, 16, v72
  v_and_b32 v4, 0xffff0000, v52
  v_and_b32 v5, 0xffff0000, v72
  v_mul_f32 v2, v2, v3
  v_mul_f32 v4, v4, v5
  v_cvt_pk_bf16_f32 v2, v2, v4
  v_lshlrev_b32 v3, 16, v2
  v_and_b32 v4, 0xffff0000, v2
  v_add_f32 v0, v0, v3
  v_add_f32 v0, v0, v4
  v_lshlrev_b32 v2, 16, v53
  v_lshlrev_b32 v3, 16, v73
  v_and_b32 v4, 0xffff0000, v53
  v_and_b32 v5, 0xffff0000, v73
  v_mul_f32 v2, v2, v3
  v_mul_f32 v4, v4, v5
  v_cvt_pk_bf16_f32 v2, v2, v4
  v_lshlrev_b32 v3, 16, v2
  v_and_b32 v4, 0xffff0000, v2
  v_add_f32 v0, v0, v3
  v_add_f32 v0, v0, v4
  v_lshlrev_b32 v2, 16, v54
  v_lshlrev_b32 v3, 16, v74
  v_and_b32 v4, 0xffff0000, v54
  v_and_b32 v5, 0xffff0000, v74
  v_mul_f32 v2, v2, v3
  v_mul_f32 v4, v4, v5
  v_cvt_pk_bf16_f32 v2, v2, v4
  v_lshlrev_b32 v3, 16, v2
  v_and_b32 v4, 0xffff0000, v2
  v_add_f32 v0, v0, v3
  v_add_f32 v0, v0, v4
  v_lshlrev_b32 v2, 16, v55
  v_lshlrev_b32 v3, 16, v75
  v_and_b32 v4, 0xffff0000, v55
  v_and_b32 v5, 0xffff0000, v75
  v_mul_f32 v2, v2, v3
  v_mul_f32 v4, v4, v5
  v_cvt_pk_bf16_f32 v2, v2, v4
  v_lshlrev_b32 v3, 16, v2
  v_and_b32 v4, 0xffff0000, v2
  v_add_f32 v0, v0, v3
  v_add_f32 v0, v0, v4
  v_lshlrev_b32 v2, 16, v56
  s_waitcnt vmcnt(2)
  v_lshlrev_b32 v3, 16, v76
  v_and_b32 v4, 0xffff0000, v56
  v_and_b32 v5, 0xffff0000, v76
  v_mul_f32 v2, v2, v3
  v_mul_f32 v4, v4, v5
  v_cvt_pk_bf16_f32 v2, v2, v4
  v_lshlrev_b32 v3, 16, v2
  v_and_b32 v4, 0xffff0000, v2
  v_add_f32 v0, v0, v3
  v_add_f32 v0, v0, v4
  v_lshlrev_b32 v2, 16, v57
  v_lshlrev_b32 v3, 16, v77
  v_and_b32 v4, 0xffff0000, v57
  v_and_b32 v5, 0xffff0000, v77
  v_mul_f32 v2, v2, v3
  v_mul_f32 v4, v4, v5
  v_cvt_pk_bf16_f32 v2, v2, v4
  v_lshlrev_b32 v3, 16, v2
  v_and_b32 v4, 0xffff0000, v2
  v_add_f32 v0, v0, v3
  v_add_f32 v0, v0, v4
  v_lshlrev_b32 v2, 16, v58
  v_lshlrev_b32 v3, 16, v78
  v_and_b32 v4, 0xffff0000, v58
  v_and_b32 v5, 0xffff0000, v78
  v_mul_f32 v2, v2, v3
  v_mul_f32 v4, v4, v5
  v_cvt_pk_bf16_f32 v2, v2, v4
  v_lshlrev_b32 v3, 16, v2
  v_and_b32 v4, 0xffff0000, v2
  v_add_f32 v0, v0, v3
  v_add_f32 v0, v0, v4
  v_lshlrev_b32 v2, 16, v59
  v_lshlrev_b32 v3, 16, v79
  v_and_b32 v4, 0xffff0000, v59
  v_and_b32 v5, 0xffff0000, v79
  v_mul_f32 v2, v2, v3
  v_mul_f32 v4, v4, v5
  v_cvt_pk_bf16_f32 v2, v2, v4
  v_lshlrev_b32 v3, 16, v2
  v_and_b32 v4, 0xffff0000, v2
  v_add_f32 v0, v0, v3
  v_add_f32 v0, v0, v4
  v_lshlrev_b32 v2, 16, v60
  s_waitcnt vmcnt(1)
  v_lshlrev_b32 v3, 16, v80
  v_and_b32 v4, 0xffff0000, v60
  v_and_b32 v5, 0xffff0000, v80
  v_mul_f32 v2, v2, v3
  v_mul_f32 v4, v4, v5
  v_cvt_pk_bf16_f32 v2, v2, v4
  v_lshlrev_b32 v3, 16, v2
  v_and_b32 v4, 0xffff0000, v2
  v_add_f32 v0, v0, v3
  v_add_f32 v0, v0, v4
  v_lshlrev_b32 v2, 16, v61
  v_lshlrev_b32 v3, 16, v81
  v_and_b32 v4, 0xffff0000, v61
  v_and_b32 v5, 0xffff0000, v81
  v_mul_f32 v2, v2, v3
  v_mul_f32 v4, v4, v5
  v_cvt_pk_bf16_f32 v2, v2, v4
  v_lshlrev_b32 v3, 16, v2
  v_and_b32 v4, 0xffff0000, v2
  v_add_f32 v0, v0, v3
  v_add_f32 v0, v0, v4
  v_lshlrev_b32 v2, 16, v62
  v_lshlrev_b32 v3, 16, v82
  v_and_b32 v4, 0xffff0000, v62
  v_and_b32 v5, 0xffff0000, v82
  v_mul_f32 v2, v2, v3
  v_mul_f32 v4, v4, v5
  v_cvt_pk_bf16_f32 v2, v2, v4
  v_lshlrev_b32 v3, 16, v2
  v_and_b32 v4, 0xffff0000, v2
  v_add_f32 v0, v0, v3
  v_add_f32 v0, v0, v4
  v_lshlrev_b32 v2, 16, v63
  v_lshlrev_b32 v3, 16, v83
  v_and_b32 v4, 0xffff0000, v63
  v_and_b32 v5, 0xffff0000, v83
  v_mul_f32 v2, v2, v3
  v_mul_f32 v4, v4, v5
  v_cvt_pk_bf16_f32 v2, v2, v4
  v_lshlrev_b32 v3, 16, v2
  v_and_b32 v4, 0xffff0000, v2
  v_add_f32 v0, v0, v3
  v_add_f32 v0, v0, v4
  v_lshlrev_b32 v2, 16, v64
  s_waitcnt vmcnt(0)
  v_lshlrev_b32 v3, 16, v84
  v_and_b32 v4, 0xffff0000, v64
  v_and_b32 v5, 0xffff0000, v84
  v_mul_f32 v2, v2, v3
  v_mul_f32 v4, v4, v5
  v_cvt_pk_bf16_f32 v2, v2, v4
  v_lshlrev_b32 v3, 16, v2
  v_and_b32 v4, 0xffff0000, v2
  v_add_f32 v0, v0, v3
  v_add_f32 v0, v0, v4
  v_lshlrev_b32 v2, 16, v65
  v_lshlrev_b32 v3, 16, v85
  v_and_b32 v4, 0xffff0000, v65
  v_and_b32 v5, 0xffff0000, v85
  v_mul_f32 v2, v2, v3
  v_mul_f32 v4, v4, v5
  v_cvt_pk_bf16_f32 v2, v2, v4
  v_lshlrev_b32 v3, 16, v2
  v_and_b32 v4, 0xffff0000, v2
  v_add_f32 v0, v0, v3
  v_add_f32 v0, v0, v4
  s_nop 1
  v_add_f32_dpp v0, v0, v0 row_ror:1 row_mask:0xf bank_mask:0xf
  s_nop 1
  v_add_f32_dpp v0, v0, v0 row_ror:2 row_mask:0xf bank_mask:0xf
  s_nop 1
  v_add_f32_dpp v0, v0, v0 row_ror:4 row_mask:0xf bank_mask:0xf
  s_nop 1
  v_add_f32_dpp v0, v0, v0 row_ror:8 row_mask:0xf bank_mask:0xf
  v_cvt_pk_bf16_f32 v0, v0, v0
  v_lshlrev_b32 v0, 16, v0
  v_mul_f32 v0, 3216550459, v0
  v_exp_f32 v0, v0
  s_nop 0
  v_add_f32 v0, 1.0, v0
  v_rcp_f32 v0, v0
  s_nop 0
  v_cvt_pk_bf16_f32 v0, v0, v0
  v_lshlrev_b32 v0, 16, v0
  v_lshlrev_b32 v212, 2, v212
  s_lshl_b32 s55, s70, 4
  s_add_u32 s55, s55, 66060288
  s_mov_b32 exec_lo, 0x00010001
  s_mov_b32 exec_hi, 0x00010001
  buffer_store_dword v0, v212, s[8:11], s55 offen sc1
  s_mov_b64 exec, -1
  v_lshrrev_b32 v211, 4, v200
  v_lshlrev_b32 v212, 2, v211
  v_and_b32 v213, 15, v200
  v_xor_b32 v212, v212, v213
  v_mul_u32_u24 v211, 3456, v211
  v_mov_b32 v2, 0x40000000
  v_add_u32 v213, 0, v212
  v_mul_u32_u24 v214, 57, v213
  v_lshrrev_b32 v214, 9, v214
  v_mul_u32_u24 v214, 1008, v214
  v_lshl_add_u32 v214, v213, 4, v214
  v_add_u32 v214, v214, v211
  v_cmp_lt_u32 vcc, 26, v213
  s_nop 1
  v_cndmask_b32 v207, v214, v2, vcc
  v_add_u32 v213, 16, v212
  v_mul_u32_u24 v214, 57, v213
  v_lshrrev_b32 v214, 9, v214
  v_mul_u32_u24 v214, 1008, v214
  v_lshl_add_u32 v214, v213, 4, v214
  v_add_u32 v214, v214, v211
  v_cmp_lt_u32 vcc, 26, v213
  s_nop 1
  v_cndmask_b32 v208, v214, v2, vcc
  s_mul_i32 s62, s68, 144
  s_mul_i32 s54, s52, 13824
  s_add_u32 s62, s62, s54
  s_waitcnt vmcnt(0)
  s_lshl_b32 s61, s52, 10
  s_add_u32 s61, s61, 36864
  s_add_u32 m0, s61, 0
  s_add_u32 s54, s62, 0
  buffer_load_dwordx4 v207, s[36:39], s54 offen lds
  s_add_u32 m0, s61, 4096
  s_add_u32 s54, s62, 55296
  buffer_load_dwordx4 v207, s[36:39], s54 offen lds
  s_add_u32 m0, s61, 8192
  s_add_u32 s54, s62, 110592
  buffer_load_dwordx4 v207, s[36:39], s54 offen lds
  s_add_u32 m0, s61, 12288
  s_add_u32 s54, s62, 165888
  buffer_load_dwordx4 v207, s[36:39], s54 offen lds
  s_add_u32 m0, s61, 16384
  s_add_u32 s54, s62, 0
  buffer_load_dwordx4 v208, s[36:39], s54 offen lds
  s_add_u32 m0, s61, 20480
  s_add_u32 s54, s62, 55296
  buffer_load_dwordx4 v208, s[36:39], s54 offen lds
  s_add_u32 m0, s61, 24576
  s_add_u32 s54, s62, 110592
  buffer_load_dwordx4 v208, s[36:39], s54 offen lds
  s_add_u32 m0, s61, 28672
  s_add_u32 s54, s62, 165888
  buffer_load_dwordx4 v208, s[36:39], s54 offen lds
  s_add_u32 m0, s61, 32768
  s_add_u32 s54, s62, 221184
  buffer_load_dwordx4 v207, s[36:39], s54 offen lds
  s_add_u32 m0, s61, 36864
  s_add_u32 s54, s62, 276480
  buffer_load_dwordx4 v207, s[36:39], s54 offen lds
  s_add_u32 m0, s61, 40960
  s_add_u32 s54, s62, 331776
  buffer_load_dwordx4 v207, s[36:39], s54 offen lds
  s_add_u32 m0, s61, 45056
  s_add_u32 s54, s62, 387072
  buffer_load_dwordx4 v207, s[36:39], s54 offen lds
  s_add_u32 m0, s61, 49152
  s_add_u32 s54, s62, 221184
  buffer_load_dwordx4 v208, s[36:39], s54 offen lds
  s_add_u32 m0, s61, 53248
  s_add_u32 s54, s62, 276480
  buffer_load_dwordx4 v208, s[36:39], s54 offen lds
  s_add_u32 m0, s61, 57344
  s_add_u32 s54, s62, 331776
  buffer_load_dwordx4 v208, s[36:39], s54 offen lds
  s_add_u32 m0, s61, 61440
  s_add_u32 s54, s62, 387072
  buffer_load_dwordx4 v208, s[36:39], s54 offen lds
  s_add_u32 m0, s61, 65536
  s_add_u32 s54, s62, 442368
  buffer_load_dwordx4 v207, s[36:39], s54 offen lds
  s_add_u32 m0, s61, 69632
  s_add_u32 s54, s62, 497664
  buffer_load_dwordx4 v207, s[36:39], s54 offen lds
  s_add_u32 m0, s61, 73728
  s_add_u32 s54, s62, 552960
  buffer_load_dwordx4 v207, s[36:39], s54 offen lds
  s_add_u32 m0, s61, 77824
  s_add_u32 s54, s62, 608256
  buffer_load_dwordx4 v207, s[36:39], s54 offen lds
  s_add_u32 m0, s61, 81920
  s_add_u32 s54, s62, 442368
  buffer_load_dwordx4 v208, s[36:39], s54 offen lds
  s_add_u32 m0, s61, 86016
  s_add_u32 s54, s62, 497664
  buffer_load_dwordx4 v208, s[36:39], s54 offen lds
  s_add_u32 m0, s61, 90112
  s_add_u32 s54, s62, 552960
  buffer_load_dwordx4 v208, s[36:39], s54 offen lds
  s_add_u32 m0, s61, 94208
  s_add_u32 s54, s62, 608256
  buffer_load_dwordx4 v208, s[36:39], s54 offen lds
  s_waitcnt vmcnt(20) lgkmcnt(0)
  s_barrier
  s_add_u32 m0, s61, 98304
  s_add_u32 s54, s62, 663552
  buffer_load_dwordx4 v207, s[36:39], s54 offen lds
  s_add_u32 m0, s61, 102400
  s_add_u32 s54, s62, 718848
  buffer_load_dwordx4 v207, s[36:39], s54 offen lds
  s_add_u32 m0, s61, 106496
  s_add_u32 s54, s62, 774144
  buffer_load_dwordx4 v207, s[36:39], s54 offen lds
  s_add_u32 m0, s61, 110592
  s_add_u32 s54, s62, 829440
  buffer_load_dwordx4 v207, s[36:39], s54 offen lds
  v_add_u32 v215, 36864, v210
  ds_read_b64_tr_b16 a[0:1], v215 offset:0
  ds_read_b64_tr_b16 a[2:3], v215 offset:1024
  ds_read_b64_tr_b16 a[4:5], v215 offset:4096
  ds_read_b64_tr_b16 a[6:7], v215 offset:5120
  ds_read_b64_tr_b16 a[8:9], v215 offset:8192
  ds_read_b64_tr_b16 a[10:11], v215 offset:9216
  ds_read_b64_tr_b16 a[12:13], v215 offset:12288
  ds_read_b64_tr_b16 a[14:15], v215 offset:13312
  s_waitcnt vmcnt(20) lgkmcnt(0)
  s_barrier
  s_add_u32 m0, s61, 0
  s_add_u32 s54, s62, 663552
  buffer_load_dwordx4 v208, s[36:39], s54 offen lds
  s_add_u32 m0, s61, 4096
  s_add_u32 s54, s62, 718848
  buffer_load_dwordx4 v208, s[36:39], s54 offen lds
  s_add_u32 m0, s61, 8192
  s_add_u32 s54, s62, 774144
  buffer_load_dwordx4 v208, s[36:39], s54 offen lds
  s_add_u32 m0, s61, 12288
  s_add_u32 s54, s62, 829440
  buffer_load_dwordx4 v208, s[36:39], s54 offen lds
  v_add_u32 v215, 53248, v210
  ds_read_b64_tr_b16 a[144:145], v215 offset:0
  ds_read_b64_tr_b16 a[146:147], v215 offset:1024
  ds_read_b64_tr_b16 a[148:149], v215 offset:4096
  ds_read_b64_tr_b16 a[150:151], v215 offset:5120
  ds_read_b64_tr_b16 a[152:153], v215 offset:8192
  ds_read_b64_tr_b16 a[154:155], v215 offset:9216
  ds_read_b64_tr_b16 a[156:157], v215 offset:12288
  ds_read_b64_tr_b16 a[158:159], v215 offset:13312
  s_waitcnt vmcnt(20) lgkmcnt(0)
  s_barrier
  s_add_u32 m0, s61, 16384
  s_add_u32 s54, s62, 884736
  buffer_load_dwordx4 v207, s[36:39], s54 offen lds
  s_add_u32 m0, s61, 20480
  s_add_u32 s54, s62, 940032
  buffer_load_dwordx4 v207, s[36:39], s54 offen lds
  s_add_u32 m0, s61, 24576
  s_add_u32 s54, s62, 995328
  buffer_load_dwordx4 v207, s[36:39], s54 offen lds
  s_add_u32 m0, s61, 28672
  s_add_u32 s54, s62, 1050624
  buffer_load_dwordx4 v207, s[36:39], s54 offen lds
  v_add_u32 v215, 69632, v210
  ds_read_b64_tr_b16 a[16:17], v215 offset:0
  ds_read_b64_tr_b16 a[18:19], v215 offset:1024
  ds_read_b64_tr_b16 a[20:21], v215 offset:4096
  ds_read_b64_tr_b16 a[22:23], v215 offset:5120
  ds_read_b64_tr_b16 a[24:25], v215 offset:8192
  ds_read_b64_tr_b16 a[26:27], v215 offset:9216
  ds_read_b64_tr_b16 a[28:29], v215 offset:12288
  ds_read_b64_tr_b16 a[30:31], v215 offset:13312
  s_waitcnt vmcnt(20) lgkmcnt(0)
  s_barrier
  s_add_u32 m0, s61, 32768
  s_add_u32 s54, s62, 884736
  buffer_load_dwordx4 v208, s[36:39], s54 offen lds
  s_add_u32 m0, s61, 36864
  s_add_u32 s54, s62, 940032
  buffer_load_dwordx4 v208, s[36:39], s54 offen lds
  s_add_u32 m0, s61, 40960
  s_add_u32 s54, s62, 995328
  buffer_load_dwordx4 v208, s[36:39], s54 offen lds
  s_add_u32 m0, s61, 45056
  s_add_u32 s54, s62, 1050624
  buffer_load_dwordx4 v208, s[36:39], s54 offen lds
  v_add_u32 v215, 86016, v210
  ds_read_b64_tr_b16 a[160:161], v215 offset:0
  ds_read_b64_tr_b16 a[162:163], v215 offset:1024
  ds_read_b64_tr_b16 a[164:165], v215 offset:4096
  ds_read_b64_tr_b16 a[166:167], v215 offset:5120
  ds_read_b64_tr_b16 a[168:169], v215 offset:8192
  ds_read_b64_tr_b16 a[170:171], v215 offset:9216
  ds_read_b64_tr_b16 a[172:173], v215 offset:12288
  ds_read_b64_tr_b16 a[174:175], v215 offset:13312
  s_waitcnt vmcnt(20) lgkmcnt(0)
  s_barrier
  s_add_u32 m0, s61, 49152
  s_add_u32 s54, s62, 1105920
  buffer_load_dwordx4 v207, s[36:39], s54 offen lds
  s_add_u32 m0, s61, 53248
  s_add_u32 s54, s62, 1161216
  buffer_load_dwordx4 v207, s[36:39], s54 offen lds
  s_add_u32 m0, s61, 57344
  s_add_u32 s54, s62, 1216512
  buffer_load_dwordx4 v207, s[36:39], s54 offen lds
  s_add_u32 m0, s61, 61440
  s_add_u32 s54, s62, 1271808
  buffer_load_dwordx4 v207, s[36:39], s54 offen lds
  v_add_u32 v215, 102400, v210
  ds_read_b64_tr_b16 a[32:33], v215 offset:0
  ds_read_b64_tr_b16 a[34:35], v215 offset:1024
  ds_read_b64_tr_b16 a[36:37], v215 offset:4096
  ds_read_b64_tr_b16 a[38:39], v215 offset:5120
  ds_read_b64_tr_b16 a[40:41], v215 offset:8192
  ds_read_b64_tr_b16 a[42:43], v215 offset:9216
  ds_read_b64_tr_b16 a[44:45], v215 offset:12288
  ds_read_b64_tr_b16 a[46:47], v215 offset:13312
  s_waitcnt vmcnt(20) lgkmcnt(0)
  s_barrier
  s_add_u32 m0, s61, 65536
  s_add_u32 s54, s62, 1105920
  buffer_load_dwordx4 v208, s[36:39], s54 offen lds
  s_add_u32 m0, s61, 69632
  s_add_u32 s54, s62, 1161216
  buffer_load_dwordx4 v208, s[36:39], s54 offen lds
  s_add_u32 m0, s61, 73728
  s_add_u32 s54, s62, 1216512
  buffer_load_dwordx4 v208, s[36:39], s54 offen lds
  s_add_u32 m0, s61, 77824
  s_add_u32 s54, s62, 1271808
  buffer_load_dwordx4 v208, s[36:39], s54 offen lds
  v_add_u32 v215, 118784, v210
  ds_read_b64_tr_b16 a[176:177], v215 offset:0
  ds_read_b64_tr_b16 a[178:179], v215 offset:1024
  ds_read_b64_tr_b16 a[180:181], v215 offset:4096
  ds_read_b64_tr_b16 a[182:183], v215 offset:5120
  ds_read_b64_tr_b16 a[184:185], v215 offset:8192
  ds_read_b64_tr_b16 a[186:187], v215 offset:9216
  ds_read_b64_tr_b16 a[188:189], v215 offset:12288
  ds_read_b64_tr_b16 a[190:191], v215 offset:13312
  s_waitcnt vmcnt(20) lgkmcnt(0)
  s_barrier
  s_add_u32 m0, s61, 81920
  s_add_u32 s54, s62, 1327104
  buffer_load_dwordx4 v207, s[36:39], s54 offen lds
  s_add_u32 m0, s61, 86016
  s_add_u32 s54, s62, 1382400
  buffer_load_dwordx4 v207, s[36:39], s54 offen lds
  s_add_u32 m0, s61, 90112
  s_add_u32 s54, s62, 1437696
  buffer_load_dwordx4 v207, s[36:39], s54 offen lds
  s_add_u32 m0, s61, 94208
  s_add_u32 s54, s62, 1492992
  buffer_load_dwordx4 v207, s[36:39], s54 offen lds
  v_add_u32 v215, 135168, v210
  ds_read_b64_tr_b16 a[48:49], v215 offset:0
  ds_read_b64_tr_b16 a[50:51], v215 offset:1024
  ds_read_b64_tr_b16 a[52:53], v215 offset:4096
  ds_read_b64_tr_b16 a[54:55], v215 offset:5120
  ds_read_b64_tr_b16 a[56:57], v215 offset:8192
  ds_read_b64_tr_b16 a[58:59], v215 offset:9216
  ds_read_b64_tr_b16 a[60:61], v215 offset:12288
  ds_read_b64_tr_b16 a[62:63], v215 offset:13312
  s_waitcnt vmcnt(20) lgkmcnt(0)
  s_barrier
  s_add_u32 m0, s61, 98304
  s_add_u32 s54, s62, 1327104
  buffer_load_dwordx4 v208, s[36:39], s54 offen lds
  s_add_u32 m0, s61, 102400
  s_add_u32 s54, s62, 1382400
  buffer_load_dwordx4 v208, s[36:39], s54 offen lds
  s_add_u32 m0, s61, 106496
  s_add_u32 s54, s62, 1437696
  buffer_load_dwordx4 v208, s[36:39], s54 offen lds
  s_add_u32 m0, s61, 110592
  s_add_u32 s54, s62, 1492992
  buffer_load_dwordx4 v208, s[36:39], s54 offen lds
  v_add_u32 v215, 36864, v210
  ds_read_b64_tr_b16 a[192:193], v215 offset:0
  ds_read_b64_tr_b16 a[194:195], v215 offset:1024
  ds_read_b64_tr_b16 a[196:197], v215 offset:4096
  ds_read_b64_tr_b16 a[198:199], v215 offset:5120
  ds_read_b64_tr_b16 a[200:201], v215 offset:8192
  ds_read_b64_tr_b16 a[202:203], v215 offset:9216
  ds_read_b64_tr_b16 a[204:205], v215 offset:12288
  ds_read_b64_tr_b16 a[206:207], v215 offset:13312
  s_waitcnt vmcnt(20) lgkmcnt(0)
  s_barrier
  s_add_u32 m0, s61, 0
  s_add_u32 s54, s62, 1548288
  buffer_load_dwordx4 v207, s[36:39], s54 offen lds
  s_add_u32 m0, s61, 4096
  s_add_u32 s54, s62, 1603584
  buffer_load_dwordx4 v207, s[36:39], s54 offen lds
  s_add_u32 m0, s61, 8192
  s_add_u32 s54, s62, 1658880
  buffer_load_dwordx4 v207, s[36:39], s54 offen lds
  s_add_u32 m0, s61, 12288
  s_add_u32 s54, s62, 1714176
  buffer_load_dwordx4 v207, s[36:39], s54 offen lds
  v_add_u32 v215, 53248, v210
  ds_read_b64_tr_b16 a[64:65], v215 offset:0
  ds_read_b64_tr_b16 a[66:67], v215 offset:1024
  ds_read_b64_tr_b16 a[68:69], v215 offset:4096
  ds_read_b64_tr_b16 a[70:71], v215 offset:5120
  ds_read_b64_tr_b16 a[72:73], v215 offset:8192
  ds_read_b64_tr_b16 a[74:75], v215 offset:9216
  ds_read_b64_tr_b16 a[76:77], v215 offset:12288
  ds_read_b64_tr_b16 a[78:79], v215 offset:13312
  s_waitcnt vmcnt(20) lgkmcnt(0)
  s_barrier
  s_add_u32 m0, s61, 16384
  s_add_u32 s54, s62, 1548288
  buffer_load_dwordx4 v208, s[36:39], s54 offen lds
  s_add_u32 m0, s61, 20480
  s_add_u32 s54, s62, 1603584
  buffer_load_dwordx4 v208, s[36:39], s54 offen lds
  s_add_u32 m0, s61, 24576
  s_add_u32 s54, s62, 1658880
  buffer_load_dwordx4 v208, s[36:39], s54 offen lds
  s_add_u32 m0, s61, 28672
  s_add_u32 s54, s62, 1714176
  buffer_load_dwordx4 v208, s[36:39], s54 offen lds
  v_add_u32 v215, 69632, v210
  ds_read_b64_tr_b16 a[208:209], v215 offset:0
  ds_read_b64_tr_b16 a[210:211], v215 offset:1024
  ds_read_b64_tr_b16 a[212:213], v215 offset:4096
  ds_read_b64_tr_b16 a[214:215], v215 offset:5120
  ds_read_b64_tr_b16 a[216:217], v215 offset:8192
  ds_read_b64_tr_b16 a[218:219], v215 offset:9216
  ds_read_b64_tr_b16 a[220:221], v215 offset:12288
  ds_read_b64_tr_b16 a[222:223], v215 offset:13312
  s_waitcnt vmcnt(20) lgkmcnt(0)
  s_barrier
  s_add_u32 m0, s61, 32768
  s_add_u32 s54, s62, 1769472
  buffer_load_dwordx4 v207, s[36:39], s54 offen lds
  s_add_u32 m0, s61, 36864
  s_add_u32 s54, s62, 1824768
  buffer_load_dwordx4 v207, s[36:39], s54 offen lds
  s_add_u32 m0, s61, 40960
  s_add_u32 s54, s62, 1880064
  buffer_load_dwordx4 v207, s[36:39], s54 offen lds
  s_add_u32 m0, s61, 45056
  s_add_u32 s54, s62, 1935360
  buffer_load_dwordx4 v207, s[36:39], s54 offen lds
  v_add_u32 v215, 86016, v210
  ds_read_b64_tr_b16 a[80:81], v215 offset:0
  ds_read_b64_tr_b16 a[82:83], v215 offset:1024
  ds_read_b64_tr_b16 a[84:85], v215 offset:4096
  ds_read_b64_tr_b16 a[86:87], v215 offset:5120
  ds_read_b64_tr_b16 a[88:89], v215 offset:8192
  ds_read_b64_tr_b16 a[90:91], v215 offset:9216
  ds_read_b64_tr_b16 a[92:93], v215 offset:12288
  ds_read_b64_tr_b16 a[94:95], v215 offset:13312
  s_waitcnt vmcnt(20) lgkmcnt(0)
  s_barrier
  s_add_u32 m0, s61, 49152
  s_add_u32 s54, s62, 1769472
  buffer_load_dwordx4 v208, s[36:39], s54 offen lds
  s_add_u32 m0, s61, 53248
  s_add_u32 s54, s62, 1824768
  buffer_load_dwordx4 v208, s[36:39], s54 offen lds
  s_add_u32 m0, s61, 57344
  s_add_u32 s54, s62, 1880064
  buffer_load_dwordx4 v208, s[36:39], s54 offen lds
  s_add_u32 m0, s61, 61440
  s_add_u32 s54, s62, 1935360
  buffer_load_dwordx4 v208, s[36:39], s54 offen lds
  v_add_u32 v215, 102400, v210
  ds_read_b64_tr_b16 a[224:225], v215 offset:0
  ds_read_b64_tr_b16 a[226:227], v215 offset:1024
  ds_read_b64_tr_b16 a[228:229], v215 offset:4096
  ds_read_b64_tr_b16 a[230:231], v215 offset:5120
  ds_read_b64_tr_b16 a[232:233], v215 offset:8192
  ds_read_b64_tr_b16 a[234:235], v215 offset:9216
  ds_read_b64_tr_b16 a[236:237], v215 offset:12288
  ds_read_b64_tr_b16 a[238:239], v215 offset:13312
  s_waitcnt vmcnt(20) lgkmcnt(0)
  s_barrier
  v_add_u32 v215, 118784, v210
  ds_read_b64_tr_b16 a[96:97], v215 offset:0
  ds_read_b64_tr_b16 a[98:99], v215 offset:1024
  ds_read_b64_tr_b16 a[100:101], v215 offset:4096
  ds_read_b64_tr_b16 a[102:103], v215 offset:5120
  ds_read_b64_tr_b16 a[104:105], v215 offset:8192
  ds_read_b64_tr_b16 a[106:107], v215 offset:9216
  ds_read_b64_tr_b16 a[108:109], v215 offset:12288
  ds_read_b64_tr_b16 a[110:111], v215 offset:13312
  s_waitcnt vmcnt(16) lgkmcnt(0)
  s_barrier
  v_add_u32 v215, 135168, v210
  ds_read_b64_tr_b16 a[240:241], v215 offset:0
  ds_read_b64_tr_b16 a[242:243], v215 offset:1024
  ds_read_b64_tr_b16 a[244:245], v215 offset:4096
  ds_read_b64_tr_b16 a[246:247], v215 offset:5120
  ds_read_b64_tr_b16 a[248:249], v215 offset:8192
  ds_read_b64_tr_b16 a[250:251], v215 offset:9216
  ds_read_b64_tr_b16 a[252:253], v215 offset:12288
  ds_read_b64_tr_b16 a[254:255], v215 offset:13312
  s_waitcnt vmcnt(12) lgkmcnt(0)
  s_barrier
  v_add_u32 v215, 36864, v210
  ds_read_b64_tr_b16 a[112:113], v215 offset:0
  ds_read_b64_tr_b16 a[114:115], v215 offset:1024
  ds_read_b64_tr_b16 a[116:117], v215 offset:4096
  ds_read_b64_tr_b16 a[118:119], v215 offset:5120
  ds_read_b64_tr_b16 a[120:121], v215 offset:8192
  ds_read_b64_tr_b16 a[122:123], v215 offset:9216
  ds_read_b64_tr_b16 a[124:125], v215 offset:12288
  ds_read_b64_tr_b16 a[126:127], v215 offset:13312
  s_waitcnt vmcnt(8) lgkmcnt(0)
  s_barrier
  v_add_u32 v215, 53248, v210
  ds_read_b64_tr_b16 v[224:225], v215 offset:0
  ds_read_b64_tr_b16 v[226:227], v215 offset:1024
  ds_read_b64_tr_b16 v[228:229], v215 offset:4096
  ds_read_b64_tr_b16 v[230:231], v215 offset:5120
  ds_read_b64_tr_b16 v[232:233], v215 offset:8192
  ds_read_b64_tr_b16 v[234:235], v215 offset:9216
  ds_read_b64_tr_b16 v[236:237], v215 offset:12288
  ds_read_b64_tr_b16 v[238:239], v215 offset:13312
  s_waitcnt vmcnt(4) lgkmcnt(0)
  s_barrier
  v_add_u32 v215, 69632, v210
  ds_read_b64_tr_b16 a[128:129], v215 offset:0
  ds_read_b64_tr_b16 a[130:131], v215 offset:1024
  ds_read_b64_tr_b16 a[132:133], v215 offset:4096
  ds_read_b64_tr_b16 a[134:135], v215 offset:5120
  ds_read_b64_tr_b16 a[136:137], v215 offset:8192
  ds_read_b64_tr_b16 a[138:139], v215 offset:9216
  ds_read_b64_tr_b16 a[140:141], v215 offset:12288
  ds_read_b64_tr_b16 a[142:143], v215 offset:13312
  s_waitcnt vmcnt(0) lgkmcnt(0)
  s_barrier
  v_add_u32 v215, 86016, v210
  ds_read_b64_tr_b16 v[240:241], v215 offset:0
  ds_read_b64_tr_b16 v[242:243], v215 offset:1024
  ds_read_b64_tr_b16 v[244:245], v215 offset:4096
  ds_read_b64_tr_b16 v[246:247], v215 offset:5120
  ds_read_b64_tr_b16 v[248:249], v215 offset:8192
  ds_read_b64_tr_b16 v[250:251], v215 offset:9216
  ds_read_b64_tr_b16 v[252:253], v215 offset:12288
  ds_read_b64_tr_b16 v[254:255], v215 offset:13312
  s_waitcnt lgkmcnt(0)
  s_barrier
  v_and_b32 v211, 31, v200
  v_mul_u32_u24 v218, 516, v211
  v_lshrrev_b32 v212, 5, v200
  v_lshl_add_u32 v218, v212, 3, v218
  s_lshl_b32 s54, s52, 6
  s_add_u32 s54, s54, 73728
  v_add_u32 v218, s54, v218
  s_lshl_b32 s60, s69, 2
  s_mul_i32 s60, s60, 36864
  ds_read_b128 v[32:35], v203 offset:0
  ds_read_b128 v[36:39], v204 offset:0
  ds_read_b128 v[40:43], v205 offset:0
  s_waitcnt lgkmcnt(2)
  v_mfma_f32_32x32x16_bf16 v[0:15], a[0:3], v[32:35], 0
  ds_read_b128 v[44:47], v206 offset:0
  s_add_u32 m0, s67, 36864
  s_nop 0
  buffer_load_dwordx4 v202, s[4:7], s60 offen offset:0 lds
  v_mfma_f32_32x32x16_bf16 v[16:31], a[144:147], v[32:35], 0
  s_waitcnt lgkmcnt(2)
  v_mfma_f32_32x32x16_bf16 v[0:15], a[4:7], v[36:39], v[0:15]
  ds_read_b128 v[32:35], v203 offset:1024
  s_add_u32 m0, s67, 37760
  s_nop 0
  buffer_load_dwordx4 v202, s[4:7], s60 offen offset:128 lds
  v_mfma_f32_32x32x16_bf16 v[16:31], a[148:151], v[36:39], v[16:31]
  s_waitcnt lgkmcnt(2)
  v_mfma_f32_32x32x16_bf16 v[0:15], a[8:11], v[40:43], v[0:15]
  ds_read_b128 v[36:39], v204 offset:1024
  s_add_u32 m0, s67, 38656
  s_nop 0
  buffer_load_dwordx4 v202, s[4:7], s60 offen offset:256 lds
  v_mfma_f32_32x32x16_bf16 v[16:31], a[152:155], v[40:43], v[16:31]
  s_waitcnt lgkmcnt(2)
  v_mfma_f32_32x32x16_bf16 v[0:15], a[12:15], v[44:47], v[0:15]
  ds_read_b128 v[40:43], v205 offset:1024
  s_add_u32 m0, s67, 39552
  s_nop 0
  buffer_load_dwordx4 v202, s[4:7], s60 offen offset:384 lds
  v_mfma_f32_32x32x16_bf16 v[16:31], a[156:159], v[44:47], v[16:31]
  s_waitcnt lgkmcnt(2)
  v_mfma_f32_32x32x16_bf16 v[0:15], a[16:19], v[32:35], v[0:15]
  ds_read_b128 v[44:47], v206 offset:1024
  s_add_u32 m0, s67, 40448
  s_nop 0
  buffer_load_dwordx4 v202, s[4:7], s60 offen offset:512 lds
  v_mfma_f32_32x32x16_bf16 v[16:31], a[160:163], v[32:35], v[16:31]
  s_waitcnt lgkmcnt(2)
  v_mfma_f32_32x32x16_bf16 v[0:15], a[20:23], v[36:39], v[0:15]
  ds_read_b128 v[32:35], v203 offset:2048
  s_add_u32 m0, s67, 41344
  s_nop 0
  buffer_load_dwordx4 v202, s[4:7], s60 offen offset:640 lds
  v_mfma_f32_32x32x16_bf16 v[16:31], a[164:167], v[36:39], v[16:31]
  s_waitcnt lgkmcnt(2)
  v_mfma_f32_32x32x16_bf16 v[0:15], a[24:27], v[40:43], v[0:15]
  ds_read_b128 v[36:39], v204 offset:2048
  s_add_u32 m0, s67, 42240
  s_nop 0
  buffer_load_dwordx4 v202, s[4:7], s60 offen offset:768 lds
  v_mfma_f32_32x32x16_bf16 v[16:31], a[168:171], v[40:43], v[16:31]
  s_waitcnt lgkmcnt(2)
  v_mfma_f32_32x32x16_bf16 v[0:15], a[28:31], v[44:47], v[0:15]
  ds_read_b128 v[40:43], v205 offset:2048
  s_add_u32 m0, s67, 43136
  s_nop 0
  buffer_load_dwordx4 v202, s[4:7], s60 offen offset:896 lds
  v_mfma_f32_32x32x16_bf16 v[16:31], a[172:175], v[44:47], v[16:31]
  s_waitcnt lgkmcnt(2)
  v_mfma_f32_32x32x16_bf16 v[0:15], a[32:35], v[32:35], v[0:15]
  ds_read_b128 v[44:47], v206 offset:2048
  s_add_u32 m0, s67, 44032
  s_nop 0
  buffer_load_dwordx4 v202, s[4:7], s60 offen offset:1024 lds
  v_mfma_f32_32x32x16_bf16 v[16:31], a[176:179], v[32:35], v[16:31]
  s_waitcnt lgkmcnt(2)
  v_mfma_f32_32x32x16_bf16 v[0:15], a[36:39], v[36:39], v[0:15]
  ds_read_b128 v[32:35], v203 offset:3072
  v_mfma_f32_32x32x16_bf16 v[16:31], a[180:183], v[36:39], v[16:31]
  s_waitcnt lgkmcnt(2)
  v_mfma_f32_32x32x16_bf16 v[0:15], a[40:43], v[40:43], v[0:15]
  ds_read_b128 v[36:39], v204 offset:3072
  v_mfma_f32_32x32x16_bf16 v[16:31], a[184:187], v[40:43], v[16:31]
  s_waitcnt lgkmcnt(2)
  v_mfma_f32_32x32x16_bf16 v[0:15], a[44:47], v[44:47], v[0:15]
  ds_read_b128 v[40:43], v205 offset:3072
  v_mfma_f32_32x32x16_bf16 v[16:31], a[188:191], v[44:47], v[16:31]
  s_waitcnt lgkmcnt(2)
  v_mfma_f32_32x32x16_bf16 v[0:15], a[48:51], v[32:35], v[0:15]
  ds_read_b128 v[44:47], v206 offset:3072
  v_mfma_f32_32x32x16_bf16 v[16:31], a[192:195], v[32:35], v[16:31]
  s_waitcnt lgkmcnt(2)
  v_mfma_f32_32x32x16_bf16 v[0:15], a[52:55], v[36:39], v[0:15]
  ds_read_b128 v[32:35], v203 offset:4096
  v_mfma_f32_32x32x16_bf16 v[16:31], a[196:199], v[36:39], v[16:31]
  s_waitcnt lgkmcnt(2)
  v_mfma_f32_32x32x16_bf16 v[0:15], a[56:59], v[40:43], v[0:15]
  ds_read_b128 v[36:39], v204 offset:4096
  v_mfma_f32_32x32x16_bf16 v[16:31], a[200:203], v[40:43], v[16:31]
  s_waitcnt lgkmcnt(2)
  v_mfma_f32_32x32x16_bf16 v[0:15], a[60:63], v[44:47], v[0:15]
  ds_read_b128 v[40:43], v205 offset:4096
  v_mfma_f32_32x32x16_bf16 v[16:31], a[204:207], v[44:47], v[16:31]
  s_waitcnt lgkmcnt(2)
  v_mfma_f32_32x32x16_bf16 v[0:15], a[64:67], v[32:35], v[0:15]
  ds_read_b128 v[44:47], v206 offset:4096
  v_mfma_f32_32x32x16_bf16 v[16:31], a[208:211], v[32:35], v[16:31]
  s_waitcnt lgkmcnt(2)
  v_mfma_f32_32x32x16_bf16 v[0:15], a[68:71], v[36:39], v[0:15]
  ds_read_b128 v[32:35], v203 offset:5120
  v_mfma_f32_32x32x16_bf16 v[16:31], a[212:215], v[36:39], v[16:31]
  s_waitcnt lgkmcnt(2)
  v_mfma_f32_32x32x16_bf16 v[0:15], a[72:75], v[40:43], v[0:15]
  ds_read_b128 v[36:39], v204 offset:5120
  v_mfma_f32_32x32x16_bf16 v[16:31], a[216:219], v[40:43], v[16:31]
  s_waitcnt lgkmcnt(2)
  v_mfma_f32_32x32x16_bf16 v[0:15], a[76:79], v[44:47], v[0:15]
  ds_read_b128 v[40:43], v205 offset:5120
  v_mfma_f32_32x32x16_bf16 v[16:31], a[220:223], v[44:47], v[16:31]
  s_waitcnt lgkmcnt(2)
  v_mfma_f32_32x32x16_bf16 v[0:15], a[80:83], v[32:35], v[0:15]
  ds_read_b128 v[44:47], v206 offset:5120
  v_mfma_f32_32x32x16_bf16 v[16:31], a[224:227], v[32:35], v[16:31]
  s_waitcnt lgkmcnt(2)
  v_mfma_f32_32x32x16_bf16 v[0:15], a[84:87], v[36:39], v[0:15]
  ds_read_b128 v[32:35], v203 offset:6144
  v_mfma_f32_32x32x16_bf16 v[16:31], a[228:231], v[36:39], v[16:31]
  s_waitcnt lgkmcnt(2)
  v_mfma_f32_32x32x16_bf16 v[0:15], a[88:91], v[40:43], v[0:15]
  ds_read_b128 v[36:39], v204 offset:6144
  v_mfma_f32_32x32x16_bf16 v[16:31], a[232:235], v[40:43], v[16:31]
  s_waitcnt lgkmcnt(2)
  v_mfma_f32_32x32x16_bf16 v[0:15], a[92:95], v[44:47], v[0:15]
  ds_read_b128 v[40:43], v205 offset:6144
  v_mfma_f32_32x32x16_bf16 v[16:31], a[236:239], v[44:47], v[16:31]
  s_waitcnt lgkmcnt(2)
  v_mfma_f32_32x32x16_bf16 v[0:15], a[96:99], v[32:35], v[0:15]
  ds_read_b128 v[44:47], v206 offset:6144
  v_mfma_f32_32x32x16_bf16 v[16:31], a[240:243], v[32:35], v[16:31]
  s_waitcnt lgkmcnt(2)
  v_mfma_f32_32x32x16_bf16 v[0:15], a[100:103], v[36:39], v[0:15]
  ds_read_b128 v[32:35], v203 offset:7168
  v_mfma_f32_32x32x16_bf16 v[16:31], a[244:247], v[36:39], v[16:31]
  s_waitcnt lgkmcnt(2)
  v_mfma_f32_32x32x16_bf16 v[0:15], a[104:107], v[40:43], v[0:15]
  ds_read_b128 v[36:39], v204 offset:7168
  v_mfma_f32_32x32x16_bf16 v[16:31], a[248:251], v[40:43], v[16:31]
  s_waitcnt lgkmcnt(2)
  v_mfma_f32_32x32x16_bf16 v[0:15], a[108:111], v[44:47], v[0:15]
  ds_read_b128 v[40:43], v205 offset:7168
  v_mfma_f32_32x32x16_bf16 v[16:31], a[252:255], v[44:47], v[16:31]
  s_waitcnt lgkmcnt(2)
  v_mfma_f32_32x32x16_bf16 v[0:15], a[112:115], v[32:35], v[0:15]
  ds_read_b128 v[44:47], v206 offset:7168
  v_mfma_f32_32x32x16_bf16 v[16:31], v[224:227], v[32:35], v[16:31]
  s_waitcnt lgkmcnt(2)
  v_mfma_f32_32x32x16_bf16 v[0:15], a[116:119], v[36:39], v[0:15]
  ds_read_b128 v[32:35], v203 offset:8192
  v_mfma_f32_32x32x16_bf16 v[16:31], v[228:231], v[36:39], v[16:31]
  s_waitcnt lgkmcnt(2)
  v_mfma_f32_32x32x16_bf16 v[0:15], a[120:123], v[40:43], v[0:15]
  ds_read_b128 v[36:39], v204 offset:8192
  v_mfma_f32_32x32x16_bf16 v[16:31], v[232:235], v[40:43], v[16:31]
  s_waitcnt lgkmcnt(2)
  v_mfma_f32_32x32x16_bf16 v[0:15], a[124:127], v[44:47], v[0:15]
  ds_read_b128 v[40:43], v205 offset:8192
  v_mfma_f32_32x32x16_bf16 v[16:31], v[236:239], v[44:47], v[16:31]
  s_waitcnt lgkmcnt(2)
  v_mfma_f32_32x32x16_bf16 v[0:15], a[128:131], v[32:35], v[0:15]
  ds_read_b128 v[44:47], v206 offset:8192
  v_mfma_f32_32x32x16_bf16 v[16:31], v[240:243], v[32:35], v[16:31]
  s_waitcnt lgkmcnt(2)
  v_mfma_f32_32x32x16_bf16 v[0:15], a[132:135], v[36:39], v[0:15]
  v_mfma_f32_32x32x16_bf16 v[16:31], v[244:247], v[36:39], v[16:31]
  s_waitcnt lgkmcnt(1)
  v_mfma_f32_32x32x16_bf16 v[0:15], a[136:139], v[40:43], v[0:15]
  v_mfma_f32_32x32x16_bf16 v[16:31], v[248:251], v[40:43], v[16:31]
  s_waitcnt lgkmcnt(0)
  v_mfma_f32_32x32x16_bf16 v[0:15], a[140:143], v[44:47], v[0:15]
  v_mfma_f32_32x32x16_bf16 v[16:31], v[252:255], v[44:47], v[16:31]
  s_add_u32 s60, s60, 36864
  s_nop 2
  v_cvt_pk_bf16_f32 v48, v0, v1
  v_cvt_pk_bf16_f32 v49, v2, v3
  ds_write2_b32 v218, v48, v49 offset0:0 offset1:1
  v_cvt_pk_bf16_f32 v48, v4, v5
  v_cvt_pk_bf16_f32 v49, v6, v7
  ds_write2_b32 v218, v48, v49 offset0:4 offset1:5
  v_cvt_pk_bf16_f32 v48, v8, v9
  v_cvt_pk_bf16_f32 v49, v10, v11
  ds_write2_b32 v218, v48, v49 offset0:8 offset1:9
  v_cvt_pk_bf16_f32 v48, v12, v13
  v_cvt_pk_bf16_f32 v49, v14, v15
  ds_write2_b32 v218, v48, v49 offset0:12 offset1:13
  v_cvt_pk_bf16_f32 v48, v16, v17
  v_cvt_pk_bf16_f32 v49, v18, v19
  ds_write2_b32 v218, v48, v49 offset0:64 offset1:65
  v_cvt_pk_bf16_f32 v48, v20, v21
  v_cvt_pk_bf16_f32 v49, v22, v23
  ds_write2_b32 v218, v48, v49 offset0:68 offset1:69
  v_cvt_pk_bf16_f32 v48, v24, v25
  v_cvt_pk_bf16_f32 v49, v26, v27
  ds_write2_b32 v218, v48, v49 offset0:72 offset1:73
  v_cvt_pk_bf16_f32 v48, v28, v29
  v_cvt_pk_bf16_f32 v49, v30, v31
  ds_write2_b32 v218, v48, v49 offset0:76 offset1:77
  v_add_u32 v218, 16512, v218
  s_waitcnt vmcnt(0) lgkmcnt(0)
  s_barrier
  ds_read_b128 v[32:35], v203 offset:36864
  ds_read_b128 v[36:39], v204 offset:36864
  ds_read_b128 v[40:43], v205 offset:36864
  s_waitcnt lgkmcnt(2)
  v_mfma_f32_32x32x16_bf16 v[0:15], a[0:3], v[32:35], 0
  ds_read_b128 v[44:47], v206 offset:36864
  s_add_u32 m0, s67, 0
  s_nop 0
  buffer_load_dwordx4 v202, s[4:7], s60 offen offset:0 lds
  v_mfma_f32_32x32x16_bf16 v[16:31], a[144:147], v[32:35], 0
  s_waitcnt lgkmcnt(2)
  v_mfma_f32_32x32x16_bf16 v[0:15], a[4:7], v[36:39], v[0:15]
  ds_read_b128 v[32:35], v203 offset:37888
  s_add_u32 m0, s67, 896
  s_nop 0
  buffer_load_dwordx4 v202, s[4:7], s60 offen offset:128 lds
  v_mfma_f32_32x32x16_bf16 v[16:31], a[148:151], v[36:39], v[16:31]
  s_waitcnt lgkmcnt(2)
  v_mfma_f32_32x32x16_bf16 v[0:15], a[8:11], v[40:43], v[0:15]
  ds_read_b128 v[36:39], v204 offset:37888
  s_add_u32 m0, s67, 1792
  s_nop 0
  buffer_load_dwordx4 v202, s[4:7], s60 offen offset:256 lds
  v_mfma_f32_32x32x16_bf16 v[16:31], a[152:155], v[40:43], v[16:31]
  s_waitcnt lgkmcnt(2)
  v_mfma_f32_32x32x16_bf16 v[0:15], a[12:15], v[44:47], v[0:15]
  ds_read_b128 v[40:43], v205 offset:37888
  s_add_u32 m0, s67, 2688
  s_nop 0
  buffer_load_dwordx4 v202, s[4:7], s60 offen offset:384 lds
  v_mfma_f32_32x32x16_bf16 v[16:31], a[156:159], v[44:47], v[16:31]
  s_waitcnt lgkmcnt(2)
  v_mfma_f32_32x32x16_bf16 v[0:15], a[16:19], v[32:35], v[0:15]
  ds_read_b128 v[44:47], v206 offset:37888
  s_add_u32 m0, s67, 3584
  s_nop 0
  buffer_load_dwordx4 v202, s[4:7], s60 offen offset:512 lds
  v_mfma_f32_32x32x16_bf16 v[16:31], a[160:163], v[32:35], v[16:31]
  s_waitcnt lgkmcnt(2)
  v_mfma_f32_32x32x16_bf16 v[0:15], a[20:23], v[36:39], v[0:15]
  ds_read_b128 v[32:35], v203 offset:38912
  s_add_u32 m0, s67, 4480
  s_nop 0
  buffer_load_dwordx4 v202, s[4:7], s60 offen offset:640 lds
  v_mfma_f32_32x32x16_bf16 v[16:31], a[164:167], v[36:39], v[16:31]
  s_waitcnt lgkmcnt(2)
  v_mfma_f32_32x32x16_bf16 v[0:15], a[24:27], v[40:43], v[0:15]
  ds_read_b128 v[36:39], v204 offset:38912
  s_add_u32 m0, s67, 5376
  s_nop 0
  buffer_load_dwordx4 v202, s[4:7], s60 offen offset:768 lds
  v_mfma_f32_32x32x16_bf16 v[16:31], a[168:171], v[40:43], v[16:31]
  s_waitcnt lgkmcnt(2)
  v_mfma_f32_32x32x16_bf16 v[0:15], a[28:31], v[44:47], v[0:15]
  ds_read_b128 v[40:43], v205 offset:38912
  s_add_u32 m0, s67, 6272
  s_nop 0
  buffer_load_dwordx4 v202, s[4:7], s60 offen offset:896 lds
  v_mfma_f32_32x32x16_bf16 v[16:31], a[172:175], v[44:47], v[16:31]
  s_waitcnt lgkmcnt(2)
  v_mfma_f32_32x32x16_bf16 v[0:15], a[32:35], v[32:35], v[0:15]
  ds_read_b128 v[44:47], v206 offset:38912
  s_add_u32 m0, s67, 7168
  s_nop 0
  buffer_load_dwordx4 v202, s[4:7], s60 offen offset:1024 lds
  v_mfma_f32_32x32x16_bf16 v[16:31], a[176:179], v[32:35], v[16:31]
  s_waitcnt lgkmcnt(2)
  v_mfma_f32_32x32x16_bf16 v[0:15], a[36:39], v[36:39], v[0:15]
  ds_read_b128 v[32:35], v203 offset:39936
  v_mfma_f32_32x32x16_bf16 v[16:31], a[180:183], v[36:39], v[16:31]
  s_waitcnt lgkmcnt(2)
  v_mfma_f32_32x32x16_bf16 v[0:15], a[40:43], v[40:43], v[0:15]
  ds_read_b128 v[36:39], v204 offset:39936
  v_mfma_f32_32x32x16_bf16 v[16:31], a[184:187], v[40:43], v[16:31]
  s_waitcnt lgkmcnt(2)
  v_mfma_f32_32x32x16_bf16 v[0:15], a[44:47], v[44:47], v[0:15]
  ds_read_b128 v[40:43], v205 offset:39936
  v_mfma_f32_32x32x16_bf16 v[16:31], a[188:191], v[44:47], v[16:31]
  s_waitcnt lgkmcnt(2)
  v_mfma_f32_32x32x16_bf16 v[0:15], a[48:51], v[32:35], v[0:15]
  ds_read_b128 v[44:47], v206 offset:39936
  v_mfma_f32_32x32x16_bf16 v[16:31], a[192:195], v[32:35], v[16:31]
  s_waitcnt lgkmcnt(2)
  v_mfma_f32_32x32x16_bf16 v[0:15], a[52:55], v[36:39], v[0:15]
  ds_read_b128 v[32:35], v203 offset:40960
  v_mfma_f32_32x32x16_bf16 v[16:31], a[196:199], v[36:39], v[16:31]
  s_waitcnt lgkmcnt(2)
  v_mfma_f32_32x32x16_bf16 v[0:15], a[56:59], v[40:43], v[0:15]
  ds_read_b128 v[36:39], v204 offset:40960
  v_mfma_f32_32x32x16_bf16 v[16:31], a[200:203], v[40:43], v[16:31]
  s_waitcnt lgkmcnt(2)
  v_mfma_f32_32x32x16_bf16 v[0:15], a[60:63], v[44:47], v[0:15]
  ds_read_b128 v[40:43], v205 offset:40960
  v_mfma_f32_32x32x16_bf16 v[16:31], a[204:207], v[44:47], v[16:31]
  s_waitcnt lgkmcnt(2)
  v_mfma_f32_32x32x16_bf16 v[0:15], a[64:67], v[32:35], v[0:15]
  ds_read_b128 v[44:47], v206 offset:40960
  v_mfma_f32_32x32x16_bf16 v[16:31], a[208:211], v[32:35], v[16:31]
  s_waitcnt lgkmcnt(2)
  v_mfma_f32_32x32x16_bf16 v[0:15], a[68:71], v[36:39], v[0:15]
  ds_read_b128 v[32:35], v203 offset:41984
  v_mfma_f32_32x32x16_bf16 v[16:31], a[212:215], v[36:39], v[16:31]
  s_waitcnt lgkmcnt(2)
  v_mfma_f32_32x32x16_bf16 v[0:15], a[72:75], v[40:43], v[0:15]
  ds_read_b128 v[36:39], v204 offset:41984
  v_mfma_f32_32x32x16_bf16 v[16:31], a[216:219], v[40:43], v[16:31]
  s_waitcnt lgkmcnt(2)
  v_mfma_f32_32x32x16_bf16 v[0:15], a[76:79], v[44:47], v[0:15]
  ds_read_b128 v[40:43], v205 offset:41984
  v_mfma_f32_32x32x16_bf16 v[16:31], a[220:223], v[44:47], v[16:31]
  s_waitcnt lgkmcnt(2)
  v_mfma_f32_32x32x16_bf16 v[0:15], a[80:83], v[32:35], v[0:15]
  ds_read_b128 v[44:47], v206 offset:41984
  v_mfma_f32_32x32x16_bf16 v[16:31], a[224:227], v[32:35], v[16:31]
  s_waitcnt lgkmcnt(2)
  v_mfma_f32_32x32x16_bf16 v[0:15], a[84:87], v[36:39], v[0:15]
  ds_read_b128 v[32:35], v203 offset:43008
  v_mfma_f32_32x32x16_bf16 v[16:31], a[228:231], v[36:39], v[16:31]
  s_waitcnt lgkmcnt(2)
  v_mfma_f32_32x32x16_bf16 v[0:15], a[88:91], v[40:43], v[0:15]
  ds_read_b128 v[36:39], v204 offset:43008
  v_mfma_f32_32x32x16_bf16 v[16:31], a[232:235], v[40:43], v[16:31]
  s_waitcnt lgkmcnt(2)
  v_mfma_f32_32x32x16_bf16 v[0:15], a[92:95], v[44:47], v[0:15]
  ds_read_b128 v[40:43], v205 offset:43008
  v_mfma_f32_32x32x16_bf16 v[16:31], a[236:239], v[44:47], v[16:31]
  s_waitcnt lgkmcnt(2)
  v_mfma_f32_32x32x16_bf16 v[0:15], a[96:99], v[32:35], v[0:15]
  ds_read_b128 v[44:47], v206 offset:43008
  v_mfma_f32_32x32x16_bf16 v[16:31], a[240:243], v[32:35], v[16:31]
  s_waitcnt lgkmcnt(2)
  v_mfma_f32_32x32x16_bf16 v[0:15], a[100:103], v[36:39], v[0:15]
  ds_read_b128 v[32:35], v203 offset:44032
  v_mfma_f32_32x32x16_bf16 v[16:31], a[244:247], v[36:39], v[16:31]
  s_waitcnt lgkmcnt(2)
  v_mfma_f32_32x32x16_bf16 v[0:15], a[104:107], v[40:43], v[0:15]
  ds_read_b128 v[36:39], v204 offset:44032
  v_mfma_f32_32x32x16_bf16 v[16:31], a[248:251], v[40:43], v[16:31]
  s_waitcnt lgkmcnt(2)
  v_mfma_f32_32x32x16_bf16 v[0:15], a[108:111], v[44:47], v[0:15]
  ds_read_b128 v[40:43], v205 offset:44032
  v_mfma_f32_32x32x16_bf16 v[16:31], a[252:255], v[44:47], v[16:31]
  s_waitcnt lgkmcnt(2)
  v_mfma_f32_32x32x16_bf16 v[0:15], a[112:115], v[32:35], v[0:15]
  ds_read_b128 v[44:47], v206 offset:44032
  v_mfma_f32_32x32x16_bf16 v[16:31], v[224:227], v[32:35], v[16:31]
  s_waitcnt lgkmcnt(2)
  v_mfma_f32_32x32x16_bf16 v[0:15], a[116:119], v[36:39], v[0:15]
  ds_read_b128 v[32:35], v203 offset:45056
  v_mfma_f32_32x32x16_bf16 v[16:31], v[228:231], v[36:39], v[16:31]
  s_waitcnt lgkmcnt(2)
  v_mfma_f32_32x32x16_bf16 v[0:15], a[120:123], v[40:43], v[0:15]
  ds_read_b128 v[36:39], v204 offset:45056
  v_mfma_f32_32x32x16_bf16 v[16:31], v[232:235], v[40:43], v[16:31]
  s_waitcnt lgkmcnt(2)
  v_mfma_f32_32x32x16_bf16 v[0:15], a[124:127], v[44:47], v[0:15]
  ds_read_b128 v[40:43], v205 offset:45056
  v_mfma_f32_32x32x16_bf16 v[16:31], v[236:239], v[44:47], v[16:31]
  s_waitcnt lgkmcnt(2)
  v_mfma_f32_32x32x16_bf16 v[0:15], a[128:131], v[32:35], v[0:15]
  ds_read_b128 v[44:47], v206 offset:45056
  v_mfma_f32_32x32x16_bf16 v[16:31], v[240:243], v[32:35], v[16:31]
  s_waitcnt lgkmcnt(2)
  v_mfma_f32_32x32x16_bf16 v[0:15], a[132:135], v[36:39], v[0:15]
  v_mfma_f32_32x32x16_bf16 v[16:31], v[244:247], v[36:39], v[16:31]
  s_waitcnt lgkmcnt(1)
  v_mfma_f32_32x32x16_bf16 v[0:15], a[136:139], v[40:43], v[0:15]
  v_mfma_f32_32x32x16_bf16 v[16:31], v[248:251], v[40:43], v[16:31]
  s_waitcnt lgkmcnt(0)
  v_mfma_f32_32x32x16_bf16 v[0:15], a[140:143], v[44:47], v[0:15]
  v_mfma_f32_32x32x16_bf16 v[16:31], v[252:255], v[44:47], v[16:31]
  s_add_u32 s60, s60, 36864
  s_nop 2
  v_cvt_pk_bf16_f32 v48, v0, v1
  v_cvt_pk_bf16_f32 v49, v2, v3
  ds_write2_b32 v218, v48, v49 offset0:0 offset1:1
  v_cvt_pk_bf16_f32 v48, v4, v5
  v_cvt_pk_bf16_f32 v49, v6, v7
  ds_write2_b32 v218, v48, v49 offset0:4 offset1:5
  v_cvt_pk_bf16_f32 v48, v8, v9
  v_cvt_pk_bf16_f32 v49, v10, v11
  ds_write2_b32 v218, v48, v49 offset0:8 offset1:9
  v_cvt_pk_bf16_f32 v48, v12, v13
  v_cvt_pk_bf16_f32 v49, v14, v15
  ds_write2_b32 v218, v48, v49 offset0:12 offset1:13
  v_cvt_pk_bf16_f32 v48, v16, v17
  v_cvt_pk_bf16_f32 v49, v18, v19
  ds_write2_b32 v218, v48, v49 offset0:64 offset1:65
  v_cvt_pk_bf16_f32 v48, v20, v21
  v_cvt_pk_bf16_f32 v49, v22, v23
  ds_write2_b32 v218, v48, v49 offset0:68 offset1:69
  v_cvt_pk_bf16_f32 v48, v24, v25
  v_cvt_pk_bf16_f32 v49, v26, v27
  ds_write2_b32 v218, v48, v49 offset0:72 offset1:73
  v_cvt_pk_bf16_f32 v48, v28, v29
  v_cvt_pk_bf16_f32 v49, v30, v31
  ds_write2_b32 v218, v48, v49 offset0:76 offset1:77
  v_add_u32 v218, 16512, v218
  s_waitcnt vmcnt(0) lgkmcnt(0)
  s_barrier
  ds_read_b128 v[32:35], v203 offset:0
  ds_read_b128 v[36:39], v204 offset:0
  ds_read_b128 v[40:43], v205 offset:0
  s_waitcnt lgkmcnt(2)
  v_mfma_f32_32x32x16_bf16 v[0:15], a[0:3], v[32:35], 0
  ds_read_b128 v[44:47], v206 offset:0
  s_add_u32 m0, s67, 36864
  s_nop 0
  buffer_load_dwordx4 v202, s[4:7], s60 offen offset:0 lds
  v_mfma_f32_32x32x16_bf16 v[16:31], a[144:147], v[32:35], 0
  s_waitcnt lgkmcnt(2)
  v_mfma_f32_32x32x16_bf16 v[0:15], a[4:7], v[36:39], v[0:15]
  ds_read_b128 v[32:35], v203 offset:1024
  s_add_u32 m0, s67, 37760
  s_nop 0
  buffer_load_dwordx4 v202, s[4:7], s60 offen offset:128 lds
  v_mfma_f32_32x32x16_bf16 v[16:31], a[148:151], v[36:39], v[16:31]
  s_waitcnt lgkmcnt(2)
  v_mfma_f32_32x32x16_bf16 v[0:15], a[8:11], v[40:43], v[0:15]
  ds_read_b128 v[36:39], v204 offset:1024
  s_add_u32 m0, s67, 38656
  s_nop 0
  buffer_load_dwordx4 v202, s[4:7], s60 offen offset:256 lds
  v_mfma_f32_32x32x16_bf16 v[16:31], a[152:155], v[40:43], v[16:31]
  s_waitcnt lgkmcnt(2)
  v_mfma_f32_32x32x16_bf16 v[0:15], a[12:15], v[44:47], v[0:15]
  ds_read_b128 v[40:43], v205 offset:1024
  s_add_u32 m0, s67, 39552
  s_nop 0
  buffer_load_dwordx4 v202, s[4:7], s60 offen offset:384 lds
  v_mfma_f32_32x32x16_bf16 v[16:31], a[156:159], v[44:47], v[16:31]
  s_waitcnt lgkmcnt(2)
  v_mfma_f32_32x32x16_bf16 v[0:15], a[16:19], v[32:35], v[0:15]
  ds_read_b128 v[44:47], v206 offset:1024
  s_add_u32 m0, s67, 40448
  s_nop 0
  buffer_load_dwordx4 v202, s[4:7], s60 offen offset:512 lds
  v_mfma_f32_32x32x16_bf16 v[16:31], a[160:163], v[32:35], v[16:31]
  s_waitcnt lgkmcnt(2)
  v_mfma_f32_32x32x16_bf16 v[0:15], a[20:23], v[36:39], v[0:15]
  ds_read_b128 v[32:35], v203 offset:2048
  s_add_u32 m0, s67, 41344
  s_nop 0
  buffer_load_dwordx4 v202, s[4:7], s60 offen offset:640 lds
  v_mfma_f32_32x32x16_bf16 v[16:31], a[164:167], v[36:39], v[16:31]
  s_waitcnt lgkmcnt(2)
  v_mfma_f32_32x32x16_bf16 v[0:15], a[24:27], v[40:43], v[0:15]
  ds_read_b128 v[36:39], v204 offset:2048
  s_add_u32 m0, s67, 42240
  s_nop 0
  buffer_load_dwordx4 v202, s[4:7], s60 offen offset:768 lds
  v_mfma_f32_32x32x16_bf16 v[16:31], a[168:171], v[40:43], v[16:31]
  s_waitcnt lgkmcnt(2)
  v_mfma_f32_32x32x16_bf16 v[0:15], a[28:31], v[44:47], v[0:15]
  ds_read_b128 v[40:43], v205 offset:2048
  s_add_u32 m0, s67, 43136
  s_nop 0
  buffer_load_dwordx4 v202, s[4:7], s60 offen offset:896 lds
  v_mfma_f32_32x32x16_bf16 v[16:31], a[172:175], v[44:47], v[16:31]
  s_waitcnt lgkmcnt(2)
  v_mfma_f32_32x32x16_bf16 v[0:15], a[32:35], v[32:35], v[0:15]
  ds_read_b128 v[44:47], v206 offset:2048
  s_add_u32 m0, s67, 44032
  s_nop 0
  buffer_load_dwordx4 v202, s[4:7], s60 offen offset:1024 lds
  v_mfma_f32_32x32x16_bf16 v[16:31], a[176:179], v[32:35], v[16:31]
  s_waitcnt lgkmcnt(2)
  v_mfma_f32_32x32x16_bf16 v[0:15], a[36:39], v[36:39], v[0:15]
  ds_read_b128 v[32:35], v203 offset:3072
  v_mfma_f32_32x32x16_bf16 v[16:31], a[180:183], v[36:39], v[16:31]
  s_waitcnt lgkmcnt(2)
  v_mfma_f32_32x32x16_bf16 v[0:15], a[40:43], v[40:43], v[0:15]
  ds_read_b128 v[36:39], v204 offset:3072
  v_mfma_f32_32x32x16_bf16 v[16:31], a[184:187], v[40:43], v[16:31]
  s_waitcnt lgkmcnt(2)
  v_mfma_f32_32x32x16_bf16 v[0:15], a[44:47], v[44:47], v[0:15]
  ds_read_b128 v[40:43], v205 offset:3072
  v_mfma_f32_32x32x16_bf16 v[16:31], a[188:191], v[44:47], v[16:31]
  s_waitcnt lgkmcnt(2)
  v_mfma_f32_32x32x16_bf16 v[0:15], a[48:51], v[32:35], v[0:15]
  ds_read_b128 v[44:47], v206 offset:3072
  v_mfma_f32_32x32x16_bf16 v[16:31], a[192:195], v[32:35], v[16:31]
  s_waitcnt lgkmcnt(2)
  v_mfma_f32_32x32x16_bf16 v[0:15], a[52:55], v[36:39], v[0:15]
  ds_read_b128 v[32:35], v203 offset:4096
  v_mfma_f32_32x32x16_bf16 v[16:31], a[196:199], v[36:39], v[16:31]
  s_waitcnt lgkmcnt(2)
  v_mfma_f32_32x32x16_bf16 v[0:15], a[56:59], v[40:43], v[0:15]
  ds_read_b128 v[36:39], v204 offset:4096
  v_mfma_f32_32x32x16_bf16 v[16:31], a[200:203], v[40:43], v[16:31]
  s_waitcnt lgkmcnt(2)
  v_mfma_f32_32x32x16_bf16 v[0:15], a[60:63], v[44:47], v[0:15]
  ds_read_b128 v[40:43], v205 offset:4096
  v_mfma_f32_32x32x16_bf16 v[16:31], a[204:207], v[44:47], v[16:31]
  s_waitcnt lgkmcnt(2)
  v_mfma_f32_32x32x16_bf16 v[0:15], a[64:67], v[32:35], v[0:15]
  ds_read_b128 v[44:47], v206 offset:4096
  v_mfma_f32_32x32x16_bf16 v[16:31], a[208:211], v[32:35], v[16:31]
  s_waitcnt lgkmcnt(2)
  v_mfma_f32_32x32x16_bf16 v[0:15], a[68:71], v[36:39], v[0:15]
  ds_read_b128 v[32:35], v203 offset:5120
  v_mfma_f32_32x32x16_bf16 v[16:31], a[212:215], v[36:39], v[16:31]
  s_waitcnt lgkmcnt(2)
  v_mfma_f32_32x32x16_bf16 v[0:15], a[72:75], v[40:43], v[0:15]
  ds_read_b128 v[36:39], v204 offset:5120
  v_mfma_f32_32x32x16_bf16 v[16:31], a[216:219], v[40:43], v[16:31]
  s_waitcnt lgkmcnt(2)
  v_mfma_f32_32x32x16_bf16 v[0:15], a[76:79], v[44:47], v[0:15]
  ds_read_b128 v[40:43], v205 offset:5120
  v_mfma_f32_32x32x16_bf16 v[16:31], a[220:223], v[44:47], v[16:31]
  s_waitcnt lgkmcnt(2)
  v_mfma_f32_32x32x16_bf16 v[0:15], a[80:83], v[32:35], v[0:15]
  ds_read_b128 v[44:47], v206 offset:5120
  v_mfma_f32_32x32x16_bf16 v[16:31], a[224:227], v[32:35], v[16:31]
  s_waitcnt lgkmcnt(2)
  v_mfma_f32_32x32x16_bf16 v[0:15], a[84:87], v[36:39], v[0:15]
  ds_read_b128 v[32:35], v203 offset:6144
  v_mfma_f32_32x32x16_bf16 v[16:31], a[228:231], v[36:39], v[16:31]
  s_waitcnt lgkmcnt(2)
  v_mfma_f32_32x32x16_bf16 v[0:15], a[88:91], v[40:43], v[0:15]
  ds_read_b128 v[36:39], v204 offset:6144
  v_mfma_f32_32x32x16_bf16 v[16:31], a[232:235], v[40:43], v[16:31]
  s_waitcnt lgkmcnt(2)
  v_mfma_f32_32x32x16_bf16 v[0:15], a[92:95], v[44:47], v[0:15]
  ds_read_b128 v[40:43], v205 offset:6144
  v_mfma_f32_32x32x16_bf16 v[16:31], a[236:239], v[44:47], v[16:31]
  s_waitcnt lgkmcnt(2)
  v_mfma_f32_32x32x16_bf16 v[0:15], a[96:99], v[32:35], v[0:15]
  ds_read_b128 v[44:47], v206 offset:6144
  v_mfma_f32_32x32x16_bf16 v[16:31], a[240:243], v[32:35], v[16:31]
  s_waitcnt lgkmcnt(2)
  v_mfma_f32_32x32x16_bf16 v[0:15], a[100:103], v[36:39], v[0:15]
  ds_read_b128 v[32:35], v203 offset:7168
  v_mfma_f32_32x32x16_bf16 v[16:31], a[244:247], v[36:39], v[16:31]
  s_waitcnt lgkmcnt(2)
  v_mfma_f32_32x32x16_bf16 v[0:15], a[104:107], v[40:43], v[0:15]
  ds_read_b128 v[36:39], v204 offset:7168
  v_mfma_f32_32x32x16_bf16 v[16:31], a[248:251], v[40:43], v[16:31]
  s_waitcnt lgkmcnt(2)
  v_mfma_f32_32x32x16_bf16 v[0:15], a[108:111], v[44:47], v[0:15]
  ds_read_b128 v[40:43], v205 offset:7168
  v_mfma_f32_32x32x16_bf16 v[16:31], a[252:255], v[44:47], v[16:31]
  s_waitcnt lgkmcnt(2)
  v_mfma_f32_32x32x16_bf16 v[0:15], a[112:115], v[32:35], v[0:15]
  ds_read_b128 v[44:47], v206 offset:7168
  v_mfma_f32_32x32x16_bf16 v[16:31], v[224:227], v[32:35], v[16:31]
  s_waitcnt lgkmcnt(2)
  v_mfma_f32_32x32x16_bf16 v[0:15], a[116:119], v[36:39], v[0:15]
  ds_read_b128 v[32:35], v203 offset:8192
  v_mfma_f32_32x32x16_bf16 v[16:31], v[228:231], v[36:39], v[16:31]
  s_waitcnt lgkmcnt(2)
  v_mfma_f32_32x32x16_bf16 v[0:15], a[120:123], v[40:43], v[0:15]
  ds_read_b128 v[36:39], v204 offset:8192
  v_mfma_f32_32x32x16_bf16 v[16:31], v[232:235], v[40:43], v[16:31]
  s_waitcnt lgkmcnt(2)
  v_mfma_f32_32x32x16_bf16 v[0:15], a[124:127], v[44:47], v[0:15]
  ds_read_b128 v[40:43], v205 offset:8192
  v_mfma_f32_32x32x16_bf16 v[16:31], v[236:239], v[44:47], v[16:31]
  s_waitcnt lgkmcnt(2)
  v_mfma_f32_32x32x16_bf16 v[0:15], a[128:131], v[32:35], v[0:15]
  ds_read_b128 v[44:47], v206 offset:8192
  v_mfma_f32_32x32x16_bf16 v[16:31], v[240:243], v[32:35], v[16:31]
  s_waitcnt lgkmcnt(2)
  v_mfma_f32_32x32x16_bf16 v[0:15], a[132:135], v[36:39], v[0:15]
  v_mfma_f32_32x32x16_bf16 v[16:31], v[244:247], v[36:39], v[16:31]
  s_waitcnt lgkmcnt(1)
  v_mfma_f32_32x32x16_bf16 v[0:15], a[136:139], v[40:43], v[0:15]
  v_mfma_f32_32x32x16_bf16 v[16:31], v[248:251], v[40:43], v[16:31]
  s_waitcnt lgkmcnt(0)
  v_mfma_f32_32x32x16_bf16 v[0:15], a[140:143], v[44:47], v[0:15]
  v_mfma_f32_32x32x16_bf16 v[16:31], v[252:255], v[44:47], v[16:31]
  s_add_u32 s60, s60, 36864
  s_nop 2
  v_cvt_pk_bf16_f32 v48, v0, v1
  v_cvt_pk_bf16_f32 v49, v2, v3
  ds_write2_b32 v218, v48, v49 offset0:0 offset1:1
  v_cvt_pk_bf16_f32 v48, v4, v5
  v_cvt_pk_bf16_f32 v49, v6, v7
  ds_write2_b32 v218, v48, v49 offset0:4 offset1:5
  v_cvt_pk_bf16_f32 v48, v8, v9
  v_cvt_pk_bf16_f32 v49, v10, v11
  ds_write2_b32 v218, v48, v49 offset0:8 offset1:9
  v_cvt_pk_bf16_f32 v48, v12, v13
  v_cvt_pk_bf16_f32 v49, v14, v15
  ds_write2_b32 v218, v48, v49 offset0:12 offset1:13
  v_cvt_pk_bf16_f32 v48, v16, v17
  v_cvt_pk_bf16_f32 v49, v18, v19
  ds_write2_b32 v218, v48, v49 offset0:64 offset1:65
  v_cvt_pk_bf16_f32 v48, v20, v21
  v_cvt_pk_bf16_f32 v49, v22, v23
  ds_write2_b32 v218, v48, v49 offset0:68 offset1:69
  v_cvt_pk_bf16_f32 v48, v24, v25
  v_cvt_pk_bf16_f32 v49, v26, v27
  ds_write2_b32 v218, v48, v49 offset0:72 offset1:73
  v_cvt_pk_bf16_f32 v48, v28, v29
  v_cvt_pk_bf16_f32 v49, v30, v31
  ds_write2_b32 v218, v48, v49 offset0:76 offset1:77
  v_add_u32 v218, 16512, v218
  s_waitcnt vmcnt(0) lgkmcnt(0)
  s_barrier
  ds_read_b128 v[32:35], v203 offset:36864
  ds_read_b128 v[36:39], v204 offset:36864
  ds_read_b128 v[40:43], v205 offset:36864
  s_waitcnt lgkmcnt(2)
  v_mfma_f32_32x32x16_bf16 v[0:15], a[0:3], v[32:35], 0
  ds_read_b128 v[44:47], v206 offset:36864
  s_add_u32 m0, s67, 0
  s_nop 0
  buffer_load_dwordx4 v202, s[4:7], s60 offen offset:0 lds
  v_mfma_f32_32x32x16_bf16 v[16:31], a[144:147], v[32:35], 0
  s_waitcnt lgkmcnt(2)
  v_mfma_f32_32x32x16_bf16 v[0:15], a[4:7], v[36:39], v[0:15]
  ds_read_b128 v[32:35], v203 offset:37888
  s_add_u32 m0, s67, 896
  s_nop 0
  buffer_load_dwordx4 v202, s[4:7], s60 offen offset:128 lds
  v_mfma_f32_32x32x16_bf16 v[16:31], a[148:151], v[36:39], v[16:31]
  s_waitcnt lgkmcnt(2)
  v_mfma_f32_32x32x16_bf16 v[0:15], a[8:11], v[40:43], v[0:15]
  ds_read_b128 v[36:39], v204 offset:37888
  s_add_u32 m0, s67, 1792
  s_nop 0
  buffer_load_dwordx4 v202, s[4:7], s60 offen offset:256 lds
  v_mfma_f32_32x32x16_bf16 v[16:31], a[152:155], v[40:43], v[16:31]
  s_waitcnt lgkmcnt(2)
  v_mfma_f32_32x32x16_bf16 v[0:15], a[12:15], v[44:47], v[0:15]
  ds_read_b128 v[40:43], v205 offset:37888
  s_add_u32 m0, s67, 2688
  s_nop 0
  buffer_load_dwordx4 v202, s[4:7], s60 offen offset:384 lds
  v_mfma_f32_32x32x16_bf16 v[16:31], a[156:159], v[44:47], v[16:31]
  s_waitcnt lgkmcnt(2)
  v_mfma_f32_32x32x16_bf16 v[0:15], a[16:19], v[32:35], v[0:15]
  ds_read_b128 v[44:47], v206 offset:37888
  s_add_u32 m0, s67, 3584
  s_nop 0
  buffer_load_dwordx4 v202, s[4:7], s60 offen offset:512 lds
  v_mfma_f32_32x32x16_bf16 v[16:31], a[160:163], v[32:35], v[16:31]
  s_waitcnt lgkmcnt(2)
  v_mfma_f32_32x32x16_bf16 v[0:15], a[20:23], v[36:39], v[0:15]
  ds_read_b128 v[32:35], v203 offset:38912
  s_add_u32 m0, s67, 4480
  s_nop 0
  buffer_load_dwordx4 v202, s[4:7], s60 offen offset:640 lds
  v_mfma_f32_32x32x16_bf16 v[16:31], a[164:167], v[36:39], v[16:31]
  s_waitcnt lgkmcnt(2)
  v_mfma_f32_32x32x16_bf16 v[0:15], a[24:27], v[40:43], v[0:15]
  ds_read_b128 v[36:39], v204 offset:38912
  s_add_u32 m0, s67, 5376
  s_nop 0
  buffer_load_dwordx4 v202, s[4:7], s60 offen offset:768 lds
  v_mfma_f32_32x32x16_bf16 v[16:31], a[168:171], v[40:43], v[16:31]
  s_waitcnt lgkmcnt(2)
  v_mfma_f32_32x32x16_bf16 v[0:15], a[28:31], v[44:47], v[0:15]
  ds_read_b128 v[40:43], v205 offset:38912
  s_add_u32 m0, s67, 6272
  s_nop 0
  buffer_load_dwordx4 v202, s[4:7], s60 offen offset:896 lds
  v_mfma_f32_32x32x16_bf16 v[16:31], a[172:175], v[44:47], v[16:31]
  s_waitcnt lgkmcnt(2)
  v_mfma_f32_32x32x16_bf16 v[0:15], a[32:35], v[32:35], v[0:15]
  ds_read_b128 v[44:47], v206 offset:38912
  s_add_u32 m0, s67, 7168
  s_nop 0
  buffer_load_dwordx4 v202, s[4:7], s60 offen offset:1024 lds
  v_mfma_f32_32x32x16_bf16 v[16:31], a[176:179], v[32:35], v[16:31]
  s_waitcnt lgkmcnt(2)
  v_mfma_f32_32x32x16_bf16 v[0:15], a[36:39], v[36:39], v[0:15]
  ds_read_b128 v[32:35], v203 offset:39936
  v_mfma_f32_32x32x16_bf16 v[16:31], a[180:183], v[36:39], v[16:31]
  s_waitcnt lgkmcnt(2)
  v_mfma_f32_32x32x16_bf16 v[0:15], a[40:43], v[40:43], v[0:15]
  ds_read_b128 v[36:39], v204 offset:39936
  v_mfma_f32_32x32x16_bf16 v[16:31], a[184:187], v[40:43], v[16:31]
  s_waitcnt lgkmcnt(2)
  v_mfma_f32_32x32x16_bf16 v[0:15], a[44:47], v[44:47], v[0:15]
  ds_read_b128 v[40:43], v205 offset:39936
  v_mfma_f32_32x32x16_bf16 v[16:31], a[188:191], v[44:47], v[16:31]
  s_waitcnt lgkmcnt(2)
  v_mfma_f32_32x32x16_bf16 v[0:15], a[48:51], v[32:35], v[0:15]
  ds_read_b128 v[44:47], v206 offset:39936
  v_mfma_f32_32x32x16_bf16 v[16:31], a[192:195], v[32:35], v[16:31]
  s_waitcnt lgkmcnt(2)
  v_mfma_f32_32x32x16_bf16 v[0:15], a[52:55], v[36:39], v[0:15]
  ds_read_b128 v[32:35], v203 offset:40960
  v_mfma_f32_32x32x16_bf16 v[16:31], a[196:199], v[36:39], v[16:31]
  s_waitcnt lgkmcnt(2)
  v_mfma_f32_32x32x16_bf16 v[0:15], a[56:59], v[40:43], v[0:15]
  ds_read_b128 v[36:39], v204 offset:40960
  v_mfma_f32_32x32x16_bf16 v[16:31], a[200:203], v[40:43], v[16:31]
  s_waitcnt lgkmcnt(2)
  v_mfma_f32_32x32x16_bf16 v[0:15], a[60:63], v[44:47], v[0:15]
  ds_read_b128 v[40:43], v205 offset:40960
  v_mfma_f32_32x32x16_bf16 v[16:31], a[204:207], v[44:47], v[16:31]
  s_waitcnt lgkmcnt(2)
  v_mfma_f32_32x32x16_bf16 v[0:15], a[64:67], v[32:35], v[0:15]
  ds_read_b128 v[44:47], v206 offset:40960
  v_mfma_f32_32x32x16_bf16 v[16:31], a[208:211], v[32:35], v[16:31]
  s_waitcnt lgkmcnt(2)
  v_mfma_f32_32x32x16_bf16 v[0:15], a[68:71], v[36:39], v[0:15]
  ds_read_b128 v[32:35], v203 offset:41984
  v_mfma_f32_32x32x16_bf16 v[16:31], a[212:215], v[36:39], v[16:31]
  s_waitcnt lgkmcnt(2)
  v_mfma_f32_32x32x16_bf16 v[0:15], a[72:75], v[40:43], v[0:15]
  ds_read_b128 v[36:39], v204 offset:41984
  v_mfma_f32_32x32x16_bf16 v[16:31], a[216:219], v[40:43], v[16:31]
  s_waitcnt lgkmcnt(2)
  v_mfma_f32_32x32x16_bf16 v[0:15], a[76:79], v[44:47], v[0:15]
  ds_read_b128 v[40:43], v205 offset:41984
  v_mfma_f32_32x32x16_bf16 v[16:31], a[220:223], v[44:47], v[16:31]
  s_waitcnt lgkmcnt(2)
  v_mfma_f32_32x32x16_bf16 v[0:15], a[80:83], v[32:35], v[0:15]
  ds_read_b128 v[44:47], v206 offset:41984
  v_mfma_f32_32x32x16_bf16 v[16:31], a[224:227], v[32:35], v[16:31]
  s_waitcnt lgkmcnt(2)
  v_mfma_f32_32x32x16_bf16 v[0:15], a[84:87], v[36:39], v[0:15]
  ds_read_b128 v[32:35], v203 offset:43008
  v_mfma_f32_32x32x16_bf16 v[16:31], a[228:231], v[36:39], v[16:31]
  s_waitcnt lgkmcnt(2)
  v_mfma_f32_32x32x16_bf16 v[0:15], a[88:91], v[40:43], v[0:15]
  ds_read_b128 v[36:39], v204 offset:43008
  v_mfma_f32_32x32x16_bf16 v[16:31], a[232:235], v[40:43], v[16:31]
  s_waitcnt lgkmcnt(2)
  v_mfma_f32_32x32x16_bf16 v[0:15], a[92:95], v[44:47], v[0:15]
  ds_read_b128 v[40:43], v205 offset:43008
  v_mfma_f32_32x32x16_bf16 v[16:31], a[236:239], v[44:47], v[16:31]
  s_waitcnt lgkmcnt(2)
  v_mfma_f32_32x32x16_bf16 v[0:15], a[96:99], v[32:35], v[0:15]
  ds_read_b128 v[44:47], v206 offset:43008
  v_mfma_f32_32x32x16_bf16 v[16:31], a[240:243], v[32:35], v[16:31]
  s_waitcnt lgkmcnt(2)
  v_mfma_f32_32x32x16_bf16 v[0:15], a[100:103], v[36:39], v[0:15]
  ds_read_b128 v[32:35], v203 offset:44032
  v_mfma_f32_32x32x16_bf16 v[16:31], a[244:247], v[36:39], v[16:31]
  s_waitcnt lgkmcnt(2)
  v_mfma_f32_32x32x16_bf16 v[0:15], a[104:107], v[40:43], v[0:15]
  ds_read_b128 v[36:39], v204 offset:44032
  v_mfma_f32_32x32x16_bf16 v[16:31], a[248:251], v[40:43], v[16:31]
  s_waitcnt lgkmcnt(2)
  v_mfma_f32_32x32x16_bf16 v[0:15], a[108:111], v[44:47], v[0:15]
  ds_read_b128 v[40:43], v205 offset:44032
  v_mfma_f32_32x32x16_bf16 v[16:31], a[252:255], v[44:47], v[16:31]
  s_waitcnt lgkmcnt(2)
  v_mfma_f32_32x32x16_bf16 v[0:15], a[112:115], v[32:35], v[0:15]
  ds_read_b128 v[44:47], v206 offset:44032
  v_mfma_f32_32x32x16_bf16 v[16:31], v[224:227], v[32:35], v[16:31]
  s_waitcnt lgkmcnt(2)
  v_mfma_f32_32x32x16_bf16 v[0:15], a[116:119], v[36:39], v[0:15]
  ds_read_b128 v[32:35], v203 offset:45056
  v_mfma_f32_32x32x16_bf16 v[16:31], v[228:231], v[36:39], v[16:31]
  s_waitcnt lgkmcnt(2)
  v_mfma_f32_32x32x16_bf16 v[0:15], a[120:123], v[40:43], v[0:15]
  ds_read_b128 v[36:39], v204 offset:45056
  v_mfma_f32_32x32x16_bf16 v[16:31], v[232:235], v[40:43], v[16:31]
  s_waitcnt lgkmcnt(2)
  v_mfma_f32_32x32x16_bf16 v[0:15], a[124:127], v[44:47], v[0:15]
  ds_read_b128 v[40:43], v205 offset:45056
  v_mfma_f32_32x32x16_bf16 v[16:31], v[236:239], v[44:47], v[16:31]
  s_waitcnt lgkmcnt(2)
  v_mfma_f32_32x32x16_bf16 v[0:15], a[128:131], v[32:35], v[0:15]
  ds_read_b128 v[44:47], v206 offset:45056
  v_mfma_f32_32x32x16_bf16 v[16:31], v[240:243], v[32:35], v[16:31]
  s_waitcnt lgkmcnt(2)
  v_mfma_f32_32x32x16_bf16 v[0:15], a[132:135], v[36:39], v[0:15]
  v_mfma_f32_32x32x16_bf16 v[16:31], v[244:247], v[36:39], v[16:31]
  s_waitcnt lgkmcnt(1)
  v_mfma_f32_32x32x16_bf16 v[0:15], a[136:139], v[40:43], v[0:15]
  v_mfma_f32_32x32x16_bf16 v[16:31], v[248:251], v[40:43], v[16:31]
  s_waitcnt lgkmcnt(0)
  v_mfma_f32_32x32x16_bf16 v[0:15], a[140:143], v[44:47], v[0:15]
  v_mfma_f32_32x32x16_bf16 v[16:31], v[252:255], v[44:47], v[16:31]
  s_add_u32 s60, s60, 36864
  s_nop 2
  v_cvt_pk_bf16_f32 v48, v0, v1
  v_cvt_pk_bf16_f32 v49, v2, v3
  ds_write2_b32 v218, v48, v49 offset0:0 offset1:1
  v_cvt_pk_bf16_f32 v48, v4, v5
  v_cvt_pk_bf16_f32 v49, v6, v7
  ds_write2_b32 v218, v48, v49 offset0:4 offset1:5
  v_cvt_pk_bf16_f32 v48, v8, v9
  v_cvt_pk_bf16_f32 v49, v10, v11
  ds_write2_b32 v218, v48, v49 offset0:8 offset1:9
  v_cvt_pk_bf16_f32 v48, v12, v13
  v_cvt_pk_bf16_f32 v49, v14, v15
  ds_write2_b32 v218, v48, v49 offset0:12 offset1:13
  v_cvt_pk_bf16_f32 v48, v16, v17
  v_cvt_pk_bf16_f32 v49, v18, v19
  ds_write2_b32 v218, v48, v49 offset0:64 offset1:65
  v_cvt_pk_bf16_f32 v48, v20, v21
  v_cvt_pk_bf16_f32 v49, v22, v23
  ds_write2_b32 v218, v48, v49 offset0:68 offset1:69
  v_cvt_pk_bf16_f32 v48, v24, v25
  v_cvt_pk_bf16_f32 v49, v26, v27
  ds_write2_b32 v218, v48, v49 offset0:72 offset1:73
  v_cvt_pk_bf16_f32 v48, v28, v29
  v_cvt_pk_bf16_f32 v49, v30, v31
  ds_write2_b32 v218, v48, v49 offset0:76 offset1:77
  v_add_u32 v218, 16512, v218
  s_waitcnt vmcnt(0) lgkmcnt(0)
  s_barrier
  ds_read_b128 v[32:35], v203 offset:0
  ds_read_b128 v[36:39], v204 offset:0
  ds_read_b128 v[40:43], v205 offset:0
  s_waitcnt lgkmcnt(2)
  v_mfma_f32_32x32x16_bf16 v[0:15], a[0:3], v[32:35], 0
  ds_read_b128 v[44:47], v206 offset:0
  v_mfma_f32_32x32x16_bf16 v[16:31], a[144:147], v[32:35], 0
  s_waitcnt lgkmcnt(2)
  v_mfma_f32_32x32x16_bf16 v[0:15], a[4:7], v[36:39], v[0:15]
  ds_read_b128 v[32:35], v203 offset:1024
  v_mfma_f32_32x32x16_bf16 v[16:31], a[148:151], v[36:39], v[16:31]
  s_waitcnt lgkmcnt(2)
  v_mfma_f32_32x32x16_bf16 v[0:15], a[8:11], v[40:43], v[0:15]
  ds_read_b128 v[36:39], v204 offset:1024
  v_mfma_f32_32x32x16_bf16 v[16:31], a[152:155], v[40:43], v[16:31]
  s_waitcnt lgkmcnt(2)
  v_mfma_f32_32x32x16_bf16 v[0:15], a[12:15], v[44:47], v[0:15]
  ds_read_b128 v[40:43], v205 offset:1024
  v_mfma_f32_32x32x16_bf16 v[16:31], a[156:159], v[44:47], v[16:31]
  s_waitcnt lgkmcnt(2)
  v_mfma_f32_32x32x16_bf16 v[0:15], a[16:19], v[32:35], v[0:15]
  ds_read_b128 v[44:47], v206 offset:1024
  v_mfma_f32_32x32x16_bf16 v[16:31], a[160:163], v[32:35], v[16:31]
  s_waitcnt lgkmcnt(2)
  v_mfma_f32_32x32x16_bf16 v[0:15], a[20:23], v[36:39], v[0:15]
  ds_read_b128 v[32:35], v203 offset:2048
  v_mfma_f32_32x32x16_bf16 v[16:31], a[164:167], v[36:39], v[16:31]
  s_waitcnt lgkmcnt(2)
  v_mfma_f32_32x32x16_bf16 v[0:15], a[24:27], v[40:43], v[0:15]
  ds_read_b128 v[36:39], v204 offset:2048
  v_mfma_f32_32x32x16_bf16 v[16:31], a[168:171], v[40:43], v[16:31]
  s_waitcnt lgkmcnt(2)
  v_mfma_f32_32x32x16_bf16 v[0:15], a[28:31], v[44:47], v[0:15]
  ds_read_b128 v[40:43], v205 offset:2048
  v_mfma_f32_32x32x16_bf16 v[16:31], a[172:175], v[44:47], v[16:31]
  s_waitcnt lgkmcnt(2)
  v_mfma_f32_32x32x16_bf16 v[0:15], a[32:35], v[32:35], v[0:15]
  ds_read_b128 v[44:47], v206 offset:2048
  v_mfma_f32_32x32x16_bf16 v[16:31], a[176:179], v[32:35], v[16:31]
  s_waitcnt lgkmcnt(2)
  v_mfma_f32_32x32x16_bf16 v[0:15], a[36:39], v[36:39], v[0:15]
  ds_read_b128 v[32:35], v203 offset:3072
  v_mfma_f32_32x32x16_bf16 v[16:31], a[180:183], v[36:39], v[16:31]
  s_waitcnt lgkmcnt(2)
  v_mfma_f32_32x32x16_bf16 v[0:15], a[40:43], v[40:43], v[0:15]
  ds_read_b128 v[36:39], v204 offset:3072
  v_mfma_f32_32x32x16_bf16 v[16:31], a[184:187], v[40:43], v[16:31]
  s_waitcnt lgkmcnt(2)
  v_mfma_f32_32x32x16_bf16 v[0:15], a[44:47], v[44:47], v[0:15]
  ds_read_b128 v[40:43], v205 offset:3072
  v_mfma_f32_32x32x16_bf16 v[16:31], a[188:191], v[44:47], v[16:31]
  s_waitcnt lgkmcnt(2)
  v_mfma_f32_32x32x16_bf16 v[0:15], a[48:51], v[32:35], v[0:15]
  ds_read_b128 v[44:47], v206 offset:3072
  v_mfma_f32_32x32x16_bf16 v[16:31], a[192:195], v[32:35], v[16:31]
  s_waitcnt lgkmcnt(2)
  v_mfma_f32_32x32x16_bf16 v[0:15], a[52:55], v[36:39], v[0:15]
  ds_read_b128 v[32:35], v203 offset:4096
  v_mfma_f32_32x32x16_bf16 v[16:31], a[196:199], v[36:39], v[16:31]
  s_waitcnt lgkmcnt(2)
  v_mfma_f32_32x32x16_bf16 v[0:15], a[56:59], v[40:43], v[0:15]
  ds_read_b128 v[36:39], v204 offset:4096
  v_mfma_f32_32x32x16_bf16 v[16:31], a[200:203], v[40:43], v[16:31]
  s_waitcnt lgkmcnt(2)
  v_mfma_f32_32x32x16_bf16 v[0:15], a[60:63], v[44:47], v[0:15]
  ds_read_b128 v[40:43], v205 offset:4096
  v_mfma_f32_32x32x16_bf16 v[16:31], a[204:207], v[44:47], v[16:31]
  s_waitcnt lgkmcnt(2)
  v_mfma_f32_32x32x16_bf16 v[0:15], a[64:67], v[32:35], v[0:15]
  ds_read_b128 v[44:47], v206 offset:4096
  v_mfma_f32_32x32x16_bf16 v[16:31], a[208:211], v[32:35], v[16:31]
  s_waitcnt lgkmcnt(2)
  v_mfma_f32_32x32x16_bf16 v[0:15], a[68:71], v[36:39], v[0:15]
  ds_read_b128 v[32:35], v203 offset:5120
  v_mfma_f32_32x32x16_bf16 v[16:31], a[212:215], v[36:39], v[16:31]
  s_waitcnt lgkmcnt(2)
  v_mfma_f32_32x32x16_bf16 v[0:15], a[72:75], v[40:43], v[0:15]
  ds_read_b128 v[36:39], v204 offset:5120
  v_mfma_f32_32x32x16_bf16 v[16:31], a[216:219], v[40:43], v[16:31]
  s_waitcnt lgkmcnt(2)
  v_mfma_f32_32x32x16_bf16 v[0:15], a[76:79], v[44:47], v[0:15]
  ds_read_b128 v[40:43], v205 offset:5120
  v_mfma_f32_32x32x16_bf16 v[16:31], a[220:223], v[44:47], v[16:31]
  s_waitcnt lgkmcnt(2)
  v_mfma_f32_32x32x16_bf16 v[0:15], a[80:83], v[32:35], v[0:15]
  ds_read_b128 v[44:47], v206 offset:5120
  v_mfma_f32_32x32x16_bf16 v[16:31], a[224:227], v[32:35], v[16:31]
  s_waitcnt lgkmcnt(2)
  v_mfma_f32_32x32x16_bf16 v[0:15], a[84:87], v[36:39], v[0:15]
  ds_read_b128 v[32:35], v203 offset:6144
  v_mfma_f32_32x32x16_bf16 v[16:31], a[228:231], v[36:39], v[16:31]
  s_waitcnt lgkmcnt(2)
  v_mfma_f32_32x32x16_bf16 v[0:15], a[88:91], v[40:43], v[0:15]
  ds_read_b128 v[36:39], v204 offset:6144
  v_mfma_f32_32x32x16_bf16 v[16:31], a[232:235], v[40:43], v[16:31]
  s_waitcnt lgkmcnt(2)
  v_mfma_f32_32x32x16_bf16 v[0:15], a[92:95], v[44:47], v[0:15]
  ds_read_b128 v[40:43], v205 offset:6144
  v_mfma_f32_32x32x16_bf16 v[16:31], a[236:239], v[44:47], v[16:31]
  s_waitcnt lgkmcnt(2)
  v_mfma_f32_32x32x16_bf16 v[0:15], a[96:99], v[32:35], v[0:15]
  ds_read_b128 v[44:47], v206 offset:6144
  v_mfma_f32_32x32x16_bf16 v[16:31], a[240:243], v[32:35], v[16:31]
  s_waitcnt lgkmcnt(2)
  v_mfma_f32_32x32x16_bf16 v[0:15], a[100:103], v[36:39], v[0:15]
  ds_read_b128 v[32:35], v203 offset:7168
  v_mfma_f32_32x32x16_bf16 v[16:31], a[244:247], v[36:39], v[16:31]
  s_waitcnt lgkmcnt(2)
  v_mfma_f32_32x32x16_bf16 v[0:15], a[104:107], v[40:43], v[0:15]
  ds_read_b128 v[36:39], v204 offset:7168
  v_mfma_f32_32x32x16_bf16 v[16:31], a[248:251], v[40:43], v[16:31]
  s_waitcnt lgkmcnt(2)
  v_mfma_f32_32x32x16_bf16 v[0:15], a[108:111], v[44:47], v[0:15]
  ds_read_b128 v[40:43], v205 offset:7168
  v_mfma_f32_32x32x16_bf16 v[16:31], a[252:255], v[44:47], v[16:31]
  s_waitcnt lgkmcnt(2)
  v_mfma_f32_32x32x16_bf16 v[0:15], a[112:115], v[32:35], v[0:15]
  ds_read_b128 v[44:47], v206 offset:7168
  v_mfma_f32_32x32x16_bf16 v[16:31], v[224:227], v[32:35], v[16:31]
  s_waitcnt lgkmcnt(2)
  v_mfma_f32_32x32x16_bf16 v[0:15], a[116:119], v[36:39], v[0:15]
  ds_read_b128 v[32:35], v203 offset:8192
  v_mfma_f32_32x32x16_bf16 v[16:31], v[228:231], v[36:39], v[16:31]
  s_waitcnt lgkmcnt(2)
  v_mfma_f32_32x32x16_bf16 v[0:15], a[120:123], v[40:43], v[0:15]
  ds_read_b128 v[36:39], v204 offset:8192
  v_mfma_f32_32x32x16_bf16 v[16:31], v[232:235], v[40:43], v[16:31]
  s_waitcnt lgkmcnt(2)
  v_mfma_f32_32x32x16_bf16 v[0:15], a[124:127], v[44:47], v[0:15]
  ds_read_b128 v[40:43], v205 offset:8192
  v_mfma_f32_32x32x16_bf16 v[16:31], v[236:239], v[44:47], v[16:31]
  s_waitcnt lgkmcnt(2)
  v_mfma_f32_32x32x16_bf16 v[0:15], a[128:131], v[32:35], v[0:15]
  ds_read_b128 v[44:47], v206 offset:8192
  v_mfma_f32_32x32x16_bf16 v[16:31], v[240:243], v[32:35], v[16:31]
  s_waitcnt lgkmcnt(2)
  v_mfma_f32_32x32x16_bf16 v[0:15], a[132:135], v[36:39], v[0:15]
  v_mfma_f32_32x32x16_bf16 v[16:31], v[244:247], v[36:39], v[16:31]
  s_waitcnt lgkmcnt(1)
  v_mfma_f32_32x32x16_bf16 v[0:15], a[136:139], v[40:43], v[0:15]
  v_mfma_f32_32x32x16_bf16 v[16:31], v[248:251], v[40:43], v[16:31]
  s_waitcnt lgkmcnt(0)
  v_mfma_f32_32x32x16_bf16 v[0:15], a[140:143], v[44:47], v[0:15]
  v_mfma_f32_32x32x16_bf16 v[16:31], v[252:255], v[44:47], v[16:31]
  s_add_u32 s60, s60, 36864
  s_nop 2
  v_cvt_pk_bf16_f32 v48, v0, v1
  v_cvt_pk_bf16_f32 v49, v2, v3
  ds_write2_b32 v218, v48, v49 offset0:0 offset1:1
  v_cvt_pk_bf16_f32 v48, v4, v5
  v_cvt_pk_bf16_f32 v49, v6, v7
  ds_write2_b32 v218, v48, v49 offset0:4 offset1:5
  v_cvt_pk_bf16_f32 v48, v8, v9
  v_cvt_pk_bf16_f32 v49, v10, v11
  ds_write2_b32 v218, v48, v49 offset0:8 offset1:9
  v_cvt_pk_bf16_f32 v48, v12, v13
  v_cvt_pk_bf16_f32 v49, v14, v15
  ds_write2_b32 v218, v48, v49 offset0:12 offset1:13
  v_cvt_pk_bf16_f32 v48, v16, v17
  v_cvt_pk_bf16_f32 v49, v18, v19
  ds_write2_b32 v218, v48, v49 offset0:64 offset1:65
  v_cvt_pk_bf16_f32 v48, v20, v21
  v_cvt_pk_bf16_f32 v49, v22, v23
  ds_write2_b32 v218, v48, v49 offset0:68 offset1:69
  v_cvt_pk_bf16_f32 v48, v24, v25
  v_cvt_pk_bf16_f32 v49, v26, v27
  ds_write2_b32 v218, v48, v49 offset0:72 offset1:73
  v_cvt_pk_bf16_f32 v48, v28, v29
  v_cvt_pk_bf16_f32 v49, v30, v31
  ds_write2_b32 v218, v48, v49 offset0:76 offset1:77
  v_add_u32 v218, 16512, v218
  s_waitcnt vmcnt(0) lgkmcnt(0)
  s_barrier
  v_mul_u32_u24 v219, 516, v200
  s_mul_i32 s54, s52, 36
  s_add_u32 s55, s54, 83016
  v_add_u32 v219, s55, v219
  v_mul_u32_u24 v220, 144, v200
  v_add_u32 v220, s54, v220
  s_mul_i32 s54, s52, 3072
  v_add_u32 v218, s54, v201
  s_lshl_b32 s55, s68, 4
  s_add_u32 s55, s55, s69
  s_mul_i32 s64, s55, 18432
  s_add_u32 s64, s64, 62914560
  s_cmp_eq_u32 s52, 3
  s_cselect_b32 s64, 268435456, s64
  s_lshl_b32 s66, s69, 7
  s_mov_b32 s57, 1051597459
  ds_read_b32 v0, v219 offset:7224
  ds_read_b32 v1, v219 offset:7228
  ds_read_b32 v2, v219 offset:7232
  ds_read_b32 v3, v219 offset:7236
  ds_read_b32 v4, v219 offset:7240
  ds_read_b32 v5, v219 offset:7244
  ds_read_b32 v6, v219 offset:7248
  ds_read_b32 v7, v219 offset:7252
  ds_read_b32 v8, v219 offset:7256
  ds_read_b32 v16, v219 offset:7368
  ds_read_b32 v17, v219 offset:7372
  ds_read_b32 v18, v219 offset:7376
  ds_read_b32 v19, v219 offset:7380
  ds_read_b32 v20, v219 offset:7384
  ds_read_b32 v21, v219 offset:7388
  ds_read_b32 v22, v219 offset:7392
  ds_read_b32 v23, v219 offset:7396
  ds_read_b32 v24, v219 offset:7400
  ds_read_b32 v25, v219 offset:6336
  ds_read_b32 v26, v219 offset:6340
  ds_read_b32 v27, v219 offset:6344
  ds_read_b32 v28, v219 offset:6348
  ds_read_b32 v29, v219 offset:6352
  ds_read_b32 v30, v219 offset:6356
  ds_read_b32 v31, v219 offset:6360
  ds_read_b32 v32, v219 offset:6364
  ds_read_b32 v33, v219 offset:6368
  ds_read_b32 v34, v219 offset:5304
  ds_read_b32 v35, v219 offset:5308
  ds_read_b32 v36, v219 offset:5312
  ds_read_b32 v37, v219 offset:5316
  ds_read_b32 v38, v219 offset:5320
  ds_read_b32 v39, v219 offset:5324
  ds_read_b32 v40, v219 offset:5328
  ds_read_b32 v41, v219 offset:5332
  ds_read_b32 v42, v219 offset:5336
  ds_read_b32 v43, v219 offset:4272
  ds_read_b32 v44, v219 offset:4276
  ds_read_b32 v45, v219 offset:4280
  ds_read_b32 v46, v219 offset:4284
  ds_read_b32 v47, v219 offset:4288
  ds_read_b32 v48, v219 offset:4292
  ds_read_b32 v49, v219 offset:4296
  ds_read_b32 v50, v219 offset:4300
  ds_read_b32 v51, v219 offset:4304
  ds_read_b32 v52, v219 offset:3240
  ds_read_b32 v53, v219 offset:3244
  ds_read_b32 v54, v219 offset:3248
  ds_read_b32 v55, v219 offset:3252
  ds_read_b32 v56, v219 offset:3256
  ds_read_b32 v57, v219 offset:3260
  ds_read_b32 v58, v219 offset:3264
  ds_read_b32 v59, v219 offset:3268
  ds_read_b32 v60, v219 offset:3272
  ds_read_b32 v61, v219 offset:2208
  ds_read_b32 v62, v219 offset:2212
  ds_read_b32 v63, v219 offset:2216
  ds_read_b32 v64, v219 offset:2220
  ds_read_b32 v65, v219 offset:2224
  ds_read_b32 v66, v219 offset:2228
  ds_read_b32 v67, v219 offset:2232
  ds_read_b32 v68, v219 offset:2236
  ds_read_b32 v69, v219 offset:2240
  ds_read_b32 v70, v219 offset:1176
  ds_read_b32 v71, v219 offset:1180
  ds_read_b32 v72, v219 offset:1184
  ds_read_b32 v73, v219 offset:1188
  ds_read_b32 v74, v219 offset:1192
  ds_read_b32 v75, v219 offset:1196
  ds_read_b32 v76, v219 offset:1200
  ds_read_b32 v77, v219 offset:1204
  ds_read_b32 v78, v219 offset:1208
  ds_read_b32 v79, v219 offset:144
  ds_read_b32 v80, v219 offset:148
  ds_read_b32 v81, v219 offset:152
  ds_read_b32 v82, v219 offset:156
  ds_read_b32 v83, v219 offset:160
  ds_read_b32 v84, v219 offset:164
  ds_read_b32 v85, v219 offset:168
  ds_read_b32 v86, v219 offset:172
  ds_read_b32 v87, v219 offset:176
  v_mov_b32 v100, 0
  v_mov_b32 v101, 0
  v_mov_b32 v102, 0
  v_mov_b32 v103, 0
  v_mov_b32 v104, 0
  v_mov_b32 v105, 0
  v_mov_b32 v106, 0
  v_mov_b32 v107, 0
  s_waitcnt lgkmcnt(15)
  v_dot2c_f32_bf16 v100, v0, v16
  v_dot2c_f32_bf16 v101, v0, v25
  v_dot2c_f32_bf16 v102, v0, v34
  v_dot2c_f32_bf16 v103, v0, v43
  v_dot2c_f32_bf16 v104, v0, v52
  v_dot2c_f32_bf16 v105, v0, v61
  v_dot2c_f32_bf16 v106, v0, v70
  s_waitcnt lgkmcnt(8)
  v_dot2c_f32_bf16 v107, v0, v79
  v_dot2c_f32_bf16 v100, v1, v17
  v_dot2c_f32_bf16 v101, v1, v26
  v_dot2c_f32_bf16 v102, v1, v35
  v_dot2c_f32_bf16 v103, v1, v44
  v_dot2c_f32_bf16 v104, v1, v53
  v_dot2c_f32_bf16 v105, v1, v62
  v_dot2c_f32_bf16 v106, v1, v71
  s_waitcnt lgkmcnt(7)
  v_dot2c_f32_bf16 v107, v1, v80
  v_dot2c_f32_bf16 v100, v2, v18
  v_dot2c_f32_bf16 v101, v2, v27
  v_dot2c_f32_bf16 v102, v2, v36
  v_dot2c_f32_bf16 v103, v2, v45
  v_dot2c_f32_bf16 v104, v2, v54
  v_dot2c_f32_bf16 v105, v2, v63
  v_dot2c_f32_bf16 v106, v2, v72
  s_waitcnt lgkmcnt(6)
  v_dot2c_f32_bf16 v107, v2, v81
  v_dot2c_f32_bf16 v100, v3, v19
  v_dot2c_f32_bf16 v101, v3, v28
  v_dot2c_f32_bf16 v102, v3, v37
  v_dot2c_f32_bf16 v103, v3, v46
  v_dot2c_f32_bf16 v104, v3, v55
  v_dot2c_f32_bf16 v105, v3, v64
  v_dot2c_f32_bf16 v106, v3, v73
  s_waitcnt lgkmcnt(5)
  v_dot2c_f32_bf16 v107, v3, v82
  v_dot2c_f32_bf16 v100, v4, v20
  v_dot2c_f32_bf16 v101, v4, v29
  v_dot2c_f32_bf16 v102, v4, v38
  v_dot2c_f32_bf16 v103, v4, v47
  v_dot2c_f32_bf16 v104, v4, v56
  v_dot2c_f32_bf16 v105, v4, v65
  v_dot2c_f32_bf16 v106, v4, v74
  s_waitcnt lgkmcnt(4)
  v_dot2c_f32_bf16 v107, v4, v83
  v_dot2c_f32_bf16 v100, v5, v21
  v_dot2c_f32_bf16 v101, v5, v30
  v_dot2c_f32_bf16 v102, v5, v39
  v_dot2c_f32_bf16 v103, v5, v48
  v_dot2c_f32_bf16 v104, v5, v57
  v_dot2c_f32_bf16 v105, v5, v66
  v_dot2c_f32_bf16 v106, v5, v75
  s_waitcnt lgkmcnt(3)
  v_dot2c_f32_bf16 v107, v5, v84
  v_dot2c_f32_bf16 v100, v6, v22
  v_dot2c_f32_bf16 v101, v6, v31
  v_dot2c_f32_bf16 v102, v6, v40
  v_dot2c_f32_bf16 v103, v6, v49
  v_dot2c_f32_bf16 v104, v6, v58
  v_dot2c_f32_bf16 v105, v6, v67
  v_dot2c_f32_bf16 v106, v6, v76
  s_waitcnt lgkmcnt(2)
  v_dot2c_f32_bf16 v107, v6, v85
  v_dot2c_f32_bf16 v100, v7, v23
  v_dot2c_f32_bf16 v101, v7, v32
  v_dot2c_f32_bf16 v102, v7, v41
  v_dot2c_f32_bf16 v103, v7, v50
  v_dot2c_f32_bf16 v104, v7, v59
  v_dot2c_f32_bf16 v105, v7, v68
  v_dot2c_f32_bf16 v106, v7, v77
  s_waitcnt lgkmcnt(1)
  v_dot2c_f32_bf16 v107, v7, v86
  v_dot2c_f32_bf16 v100, v8, v24
  v_dot2c_f32_bf16 v101, v8, v33
  v_dot2c_f32_bf16 v102, v8, v42
  v_dot2c_f32_bf16 v103, v8, v51
  v_dot2c_f32_bf16 v104, v8, v60
  v_dot2c_f32_bf16 v105, v8, v69
  v_dot2c_f32_bf16 v106, v8, v78
  s_waitcnt lgkmcnt(0)
  v_dot2c_f32_bf16 v107, v8, v87
  ds_read_b32 v16, v219 offset:7512
  ds_read_b32 v17, v219 offset:7516
  ds_read_b32 v18, v219 offset:7520
  ds_read_b32 v19, v219 offset:7524
  ds_read_b32 v20, v219 offset:7528
  ds_read_b32 v21, v219 offset:7532
  ds_read_b32 v22, v219 offset:7536
  ds_read_b32 v23, v219 offset:7540
  ds_read_b32 v24, v219 offset:7544
  ds_read_b32 v25, v219 offset:6480
  ds_read_b32 v26, v219 offset:6484
  ds_read_b32 v27, v219 offset:6488
  ds_read_b32 v28, v219 offset:6492
  ds_read_b32 v29, v219 offset:6496
  ds_read_b32 v30, v219 offset:6500
  ds_read_b32 v31, v219 offset:6504
  ds_read_b32 v32, v219 offset:6508
  ds_read_b32 v33, v219 offset:6512
  ds_read_b32 v34, v219 offset:5448
  ds_read_b32 v35, v219 offset:5452
  ds_read_b32 v36, v219 offset:5456
  ds_read_b32 v37, v219 offset:5460
  ds_read_b32 v38, v219 offset:5464
  ds_read_b32 v39, v219 offset:5468
  ds_read_b32 v40, v219 offset:5472
  ds_read_b32 v41, v219 offset:5476
  ds_read_b32 v42, v219 offset:5480
  ds_read_b32 v43, v219 offset:4416
  ds_read_b32 v44, v219 offset:4420
  ds_read_b32 v45, v219 offset:4424
  ds_read_b32 v46, v219 offset:4428
  ds_read_b32 v47, v219 offset:4432
  ds_read_b32 v48, v219 offset:4436
  ds_read_b32 v49, v219 offset:4440
  ds_read_b32 v50, v219 offset:4444
  ds_read_b32 v51, v219 offset:4448
  ds_read_b32 v52, v219 offset:3384
  ds_read_b32 v53, v219 offset:3388
  ds_read_b32 v54, v219 offset:3392
  ds_read_b32 v55, v219 offset:3396
  ds_read_b32 v56, v219 offset:3400
  ds_read_b32 v57, v219 offset:3404
  ds_read_b32 v58, v219 offset:3408
  ds_read_b32 v59, v219 offset:3412
  ds_read_b32 v60, v219 offset:3416
  ds_read_b32 v61, v219 offset:2352
  ds_read_b32 v62, v219 offset:2356
  ds_read_b32 v63, v219 offset:2360
  ds_read_b32 v64, v219 offset:2364
  ds_read_b32 v65, v219 offset:2368
  ds_read_b32 v66, v219 offset:2372
  ds_read_b32 v67, v219 offset:2376
  ds_read_b32 v68, v219 offset:2380
  ds_read_b32 v69, v219 offset:2384
  ds_read_b32 v70, v219 offset:1320
  ds_read_b32 v71, v219 offset:1324
  ds_read_b32 v72, v219 offset:1328
  ds_read_b32 v73, v219 offset:1332
  ds_read_b32 v74, v219 offset:1336
  ds_read_b32 v75, v219 offset:1340
  ds_read_b32 v76, v219 offset:1344
  ds_read_b32 v77, v219 offset:1348
  ds_read_b32 v78, v219 offset:1352
  ds_read_b32 v79, v219 offset:288
  ds_read_b32 v80, v219 offset:292
  ds_read_b32 v81, v219 offset:296
  ds_read_b32 v82, v219 offset:300
  ds_read_b32 v83, v219 offset:304
  ds_read_b32 v84, v219 offset:308
  ds_read_b32 v85, v219 offset:312
  ds_read_b32 v86, v219 offset:316
  ds_read_b32 v87, v219 offset:320
  v_add_u32 v211, s66, v200
  v_mov_b32 v212, 0xf149f2ca
  v_mul_f32 v100, s57, v100
  v_mul_f32 v101, s57, v101
  v_mul_f32 v102, s57, v102
  v_mul_f32 v103, s57, v103
  v_mul_f32 v104, s57, v104
  v_mul_f32 v105, s57, v105
  v_mul_f32 v106, s57, v106
  v_mul_f32 v107, s57, v107
  v_cmp_gt_u32 vcc, 2, v211
  s_nop 1
  v_cndmask_b32 v101, v101, v212, vcc
  v_cmp_gt_u32 vcc, 4, v211
  s_nop 1
  v_cndmask_b32 v102, v102, v212, vcc
  v_cmp_gt_u32 vcc, 6, v211
  s_nop 1
  v_cndmask_b32 v103, v103, v212, vcc
  v_cmp_gt_u32 vcc, 8, v211
  s_nop 1
  v_cndmask_b32 v104, v104, v212, vcc
  v_cmp_gt_u32 vcc, 10, v211
  s_nop 1
  v_cndmask_b32 v105, v105, v212, vcc
  v_cmp_gt_u32 vcc, 12, v211
  s_nop 1
  v_cndmask_b32 v106, v106, v212, vcc
  v_cmp_gt_u32 vcc, 14, v211
  s_nop 1
  v_cndmask_b32 v107, v107, v212, vcc
  v_max3_f32 v213, v100, v101, v102
  v_max3_f32 v213, v213, v103, v104
  v_max3_f32 v213, v213, v105, v106
  v_max_f32 v213, v213, v107
  v_sub_f32 v100, v100, v213
  v_sub_f32 v101, v101, v213
  v_sub_f32 v102, v102, v213
  v_sub_f32 v103, v103, v213
  v_sub_f32 v104, v104, v213
  v_sub_f32 v105, v105, v213
  v_sub_f32 v106, v106, v213
  v_sub_f32 v107, v107, v213
  v_exp_f32 v100, v100
  v_exp_f32 v101, v101
  v_exp_f32 v102, v102
  v_exp_f32 v103, v103
  v_exp_f32 v104, v104
  v_exp_f32 v105, v105
  v_exp_f32 v106, v106
  v_exp_f32 v107, v107
  v_add_f32 v213, v100, v101
  v_add_f32 v213, v213, v102
  v_add_f32 v213, v213, v103
  v_add_f32 v213, v213, v104
  v_add_f32 v213, v213, v105
  v_add_f32 v213, v213, v106
  v_add_f32 v213, v213, v107
  v_rcp_f32 v213, v213
  v_mov_b32 v214, 0
  v_mul_f32 v100, v213, v100
  v_mul_f32 v101, v213, v101
  v_mul_f32 v102, v213, v102
  v_mul_f32 v103, v213, v103
  v_mul_f32 v104, v213, v104
  v_mul_f32 v105, v213, v105
  v_mul_f32 v106, v213, v106
  v_mul_f32 v107, v213, v107
  v_mov_b32 v112, 0
  v_mov_b32 v113, 0
  v_mov_b32 v114, 0
  v_mov_b32 v115, 0
  v_mov_b32 v116, 0
  v_mov_b32 v117, 0
  v_mov_b32 v118, 0
  v_mov_b32 v119, 0
  v_mov_b32 v120, 0
  v_mov_b32 v121, 0
  v_mov_b32 v122, 0
  v_mov_b32 v123, 0
  v_mov_b32 v124, 0
  v_mov_b32 v125, 0
  v_mov_b32 v126, 0
  v_mov_b32 v127, 0
  v_mov_b32 v128, 0
  v_mov_b32 v129, 0
  v_cvt_pk_bf16_f32 v0, v100, v214
  v_cvt_pk_bf16_f32 v1, v214, v100
  s_waitcnt lgkmcnt(15)
  v_dot2c_f32_bf16 v112, v16, v0
  v_dot2c_f32_bf16 v113, v16, v1
  v_dot2c_f32_bf16 v114, v17, v0
  v_dot2c_f32_bf16 v115, v17, v1
  v_dot2c_f32_bf16 v116, v18, v0
  v_dot2c_f32_bf16 v117, v18, v1
  v_dot2c_f32_bf16 v118, v19, v0
  v_dot2c_f32_bf16 v119, v19, v1
  v_dot2c_f32_bf16 v120, v20, v0
  v_dot2c_f32_bf16 v121, v20, v1
  v_dot2c_f32_bf16 v122, v21, v0
  v_dot2c_f32_bf16 v123, v21, v1
  v_dot2c_f32_bf16 v124, v22, v0
  v_dot2c_f32_bf16 v125, v22, v1
  v_dot2c_f32_bf16 v126, v23, v0
  v_dot2c_f32_bf16 v127, v23, v1
  v_dot2c_f32_bf16 v128, v24, v0
  v_dot2c_f32_bf16 v129, v24, v1
  v_cvt_pk_bf16_f32 v2, v101, v214
  v_cvt_pk_bf16_f32 v3, v214, v101
  v_dot2c_f32_bf16 v112, v25, v2
  v_dot2c_f32_bf16 v113, v25, v3
  v_dot2c_f32_bf16 v114, v26, v2
  v_dot2c_f32_bf16 v115, v26, v3
  v_dot2c_f32_bf16 v116, v27, v2
  v_dot2c_f32_bf16 v117, v27, v3
  v_dot2c_f32_bf16 v118, v28, v2
  v_dot2c_f32_bf16 v119, v28, v3
  v_dot2c_f32_bf16 v120, v29, v2
  v_dot2c_f32_bf16 v121, v29, v3
  v_dot2c_f32_bf16 v122, v30, v2
  v_dot2c_f32_bf16 v123, v30, v3
  v_dot2c_f32_bf16 v124, v31, v2
  v_dot2c_f32_bf16 v125, v31, v3
  v_dot2c_f32_bf16 v126, v32, v2
  v_dot2c_f32_bf16 v127, v32, v3
  v_dot2c_f32_bf16 v128, v33, v2
  v_dot2c_f32_bf16 v129, v33, v3
  v_cvt_pk_bf16_f32 v0, v102, v214
  v_cvt_pk_bf16_f32 v1, v214, v102
  v_dot2c_f32_bf16 v112, v34, v0
  v_dot2c_f32_bf16 v113, v34, v1
  v_dot2c_f32_bf16 v114, v35, v0
  v_dot2c_f32_bf16 v115, v35, v1
  v_dot2c_f32_bf16 v116, v36, v0
  v_dot2c_f32_bf16 v117, v36, v1
  v_dot2c_f32_bf16 v118, v37, v0
  v_dot2c_f32_bf16 v119, v37, v1
  v_dot2c_f32_bf16 v120, v38, v0
  v_dot2c_f32_bf16 v121, v38, v1
  v_dot2c_f32_bf16 v122, v39, v0
  v_dot2c_f32_bf16 v123, v39, v1
  v_dot2c_f32_bf16 v124, v40, v0
  v_dot2c_f32_bf16 v125, v40, v1
  v_dot2c_f32_bf16 v126, v41, v0
  v_dot2c_f32_bf16 v127, v41, v1
  v_dot2c_f32_bf16 v128, v42, v0
  v_dot2c_f32_bf16 v129, v42, v1
  v_cvt_pk_bf16_f32 v2, v103, v214
  v_cvt_pk_bf16_f32 v3, v214, v103
  v_dot2c_f32_bf16 v112, v43, v2
  v_dot2c_f32_bf16 v113, v43, v3
  v_dot2c_f32_bf16 v114, v44, v2
  v_dot2c_f32_bf16 v115, v44, v3
  v_dot2c_f32_bf16 v116, v45, v2
  v_dot2c_f32_bf16 v117, v45, v3
  v_dot2c_f32_bf16 v118, v46, v2
  v_dot2c_f32_bf16 v119, v46, v3
  v_dot2c_f32_bf16 v120, v47, v2
  v_dot2c_f32_bf16 v121, v47, v3
  v_dot2c_f32_bf16 v122, v48, v2
  v_dot2c_f32_bf16 v123, v48, v3
  v_dot2c_f32_bf16 v124, v49, v2
  v_dot2c_f32_bf16 v125, v49, v3
  v_dot2c_f32_bf16 v126, v50, v2
  v_dot2c_f32_bf16 v127, v50, v3
  v_dot2c_f32_bf16 v128, v51, v2
  v_dot2c_f32_bf16 v129, v51, v3
  v_cvt_pk_bf16_f32 v0, v104, v214
  v_cvt_pk_bf16_f32 v1, v214, v104
  v_dot2c_f32_bf16 v112, v52, v0
  v_dot2c_f32_bf16 v113, v52, v1
  v_dot2c_f32_bf16 v114, v53, v0
  v_dot2c_f32_bf16 v115, v53, v1
  v_dot2c_f32_bf16 v116, v54, v0
  v_dot2c_f32_bf16 v117, v54, v1
  v_dot2c_f32_bf16 v118, v55, v0
  v_dot2c_f32_bf16 v119, v55, v1
  v_dot2c_f32_bf16 v120, v56, v0
  v_dot2c_f32_bf16 v121, v56, v1
  v_dot2c_f32_bf16 v122, v57, v0
  v_dot2c_f32_bf16 v123, v57, v1
  v_dot2c_f32_bf16 v124, v58, v0
  v_dot2c_f32_bf16 v125, v58, v1
  v_dot2c_f32_bf16 v126, v59, v0
  v_dot2c_f32_bf16 v127, v59, v1
  v_dot2c_f32_bf16 v128, v60, v0
  v_dot2c_f32_bf16 v129, v60, v1
  v_cvt_pk_bf16_f32 v2, v105, v214
  v_cvt_pk_bf16_f32 v3, v214, v105
  v_dot2c_f32_bf16 v112, v61, v2
  v_dot2c_f32_bf16 v113, v61, v3
  v_dot2c_f32_bf16 v114, v62, v2
  v_dot2c_f32_bf16 v115, v62, v3
  v_dot2c_f32_bf16 v116, v63, v2
  v_dot2c_f32_bf16 v117, v63, v3
  v_dot2c_f32_bf16 v118, v64, v2
  v_dot2c_f32_bf16 v119, v64, v3
  v_dot2c_f32_bf16 v120, v65, v2
  v_dot2c_f32_bf16 v121, v65, v3
  v_dot2c_f32_bf16 v122, v66, v2
  v_dot2c_f32_bf16 v123, v66, v3
  v_dot2c_f32_bf16 v124, v67, v2
  v_dot2c_f32_bf16 v125, v67, v3
  v_dot2c_f32_bf16 v126, v68, v2
  v_dot2c_f32_bf16 v127, v68, v3
  v_dot2c_f32_bf16 v128, v69, v2
  v_dot2c_f32_bf16 v129, v69, v3
  v_cvt_pk_bf16_f32 v0, v106, v214
  v_cvt_pk_bf16_f32 v1, v214, v106
  v_dot2c_f32_bf16 v112, v70, v0
  v_dot2c_f32_bf16 v113, v70, v1
  v_dot2c_f32_bf16 v114, v71, v0
  v_dot2c_f32_bf16 v115, v71, v1
  v_dot2c_f32_bf16 v116, v72, v0
  v_dot2c_f32_bf16 v117, v72, v1
  s_waitcnt lgkmcnt(14)
  v_dot2c_f32_bf16 v118, v73, v0
  v_dot2c_f32_bf16 v119, v73, v1
  s_waitcnt lgkmcnt(13)
  v_dot2c_f32_bf16 v120, v74, v0
  v_dot2c_f32_bf16 v121, v74, v1
  s_waitcnt lgkmcnt(12)
  v_dot2c_f32_bf16 v122, v75, v0
  v_dot2c_f32_bf16 v123, v75, v1
  s_waitcnt lgkmcnt(11)
  v_dot2c_f32_bf16 v124, v76, v0
  v_dot2c_f32_bf16 v125, v76, v1
  s_waitcnt lgkmcnt(10)
  v_dot2c_f32_bf16 v126, v77, v0
  v_dot2c_f32_bf16 v127, v77, v1
  s_waitcnt lgkmcnt(9)
  v_dot2c_f32_bf16 v128, v78, v0
  v_dot2c_f32_bf16 v129, v78, v1
  v_cvt_pk_bf16_f32 v2, v107, v214
  v_cvt_pk_bf16_f32 v3, v214, v107
  s_waitcnt lgkmcnt(8)
  v_dot2c_f32_bf16 v112, v79, v2
  v_dot2c_f32_bf16 v113, v79, v3
  s_waitcnt lgkmcnt(7)
  v_dot2c_f32_bf16 v114, v80, v2
  v_dot2c_f32_bf16 v115, v80, v3
  s_waitcnt lgkmcnt(6)
  v_dot2c_f32_bf16 v116, v81, v2
  v_dot2c_f32_bf16 v117, v81, v3
  s_waitcnt lgkmcnt(5)
  v_dot2c_f32_bf16 v118, v82, v2
  v_dot2c_f32_bf16 v119, v82, v3
  s_waitcnt lgkmcnt(4)
  v_dot2c_f32_bf16 v120, v83, v2
  v_dot2c_f32_bf16 v121, v83, v3
  s_waitcnt lgkmcnt(3)
  v_dot2c_f32_bf16 v122, v84, v2
  v_dot2c_f32_bf16 v123, v84, v3
  s_waitcnt lgkmcnt(2)
  v_dot2c_f32_bf16 v124, v85, v2
  v_dot2c_f32_bf16 v125, v85, v3
  s_waitcnt lgkmcnt(1)
  v_dot2c_f32_bf16 v126, v86, v2
  v_dot2c_f32_bf16 v127, v86, v3
  s_waitcnt lgkmcnt(0)
  v_dot2c_f32_bf16 v128, v87, v2
  v_dot2c_f32_bf16 v129, v87, v3
  v_cvt_pk_bf16_f32 v132, v112, v113
  v_cvt_pk_bf16_f32 v133, v114, v115
  v_cvt_pk_bf16_f32 v134, v116, v117
  v_cvt_pk_bf16_f32 v135, v118, v119
  v_cvt_pk_bf16_f32 v136, v120, v121
  v_cvt_pk_bf16_f32 v137, v122, v123
  v_cvt_pk_bf16_f32 v138, v124, v125
  v_cvt_pk_bf16_f32 v139, v126, v127
  v_cvt_pk_bf16_f32 v140, v128, v129
  ds_write_b32 v220, v132 offset:0
  ds_write_b32 v220, v133 offset:4
  ds_write_b32 v220, v134 offset:8
  ds_write_b32 v220, v135 offset:12
  ds_write_b32 v220, v136 offset:16
  ds_write_b32 v220, v137 offset:20
  ds_write_b32 v220, v138 offset:24
  ds_write_b32 v220, v139 offset:28
  ds_write_b32 v220, v140 offset:32
  s_waitcnt lgkmcnt(0)
  s_barrier
  ds_read_b128 v[144:147], v218 offset:0
  ds_read_b128 v[148:151], v218 offset:1024
  ds_read_b128 v[152:155], v218 offset:2048
  s_waitcnt lgkmcnt(2)
  buffer_store_dwordx4 v[144:147], v218, s[8:11], s64 offen offset:0 sc1
  s_waitcnt lgkmcnt(1)
  buffer_store_dwordx4 v[148:151], v218, s[8:11], s64 offen offset:1024 sc1
  s_waitcnt lgkmcnt(0)
  buffer_store_dwordx4 v[152:155], v218, s[8:11], s64 offen offset:2048 sc1
  v_add_u32 v219, 33024, v219
  s_add_u32 s66, s66, 64
  s_add_u32 s64, s64, 9216
  ds_read_b32 v0, v219 offset:7224
  ds_read_b32 v1, v219 offset:7228
  ds_read_b32 v2, v219 offset:7232
  ds_read_b32 v3, v219 offset:7236
  ds_read_b32 v4, v219 offset:7240
  ds_read_b32 v5, v219 offset:7244
  ds_read_b32 v6, v219 offset:7248
  ds_read_b32 v7, v219 offset:7252
  ds_read_b32 v8, v219 offset:7256
  ds_read_b32 v16, v219 offset:7368
  ds_read_b32 v17, v219 offset:7372
  ds_read_b32 v18, v219 offset:7376
  ds_read_b32 v19, v219 offset:7380
  ds_read_b32 v20, v219 offset:7384
  ds_read_b32 v21, v219 offset:7388
  ds_read_b32 v22, v219 offset:7392
  ds_read_b32 v23, v219 offset:7396
  ds_read_b32 v24, v219 offset:7400
  ds_read_b32 v25, v219 offset:6336
  ds_read_b32 v26, v219 offset:6340
  ds_read_b32 v27, v219 offset:6344
  ds_read_b32 v28, v219 offset:6348
  ds_read_b32 v29, v219 offset:6352
  ds_read_b32 v30, v219 offset:6356
  ds_read_b32 v31, v219 offset:6360
  ds_read_b32 v32, v219 offset:6364
  ds_read_b32 v33, v219 offset:6368
  ds_read_b32 v34, v219 offset:5304
  ds_read_b32 v35, v219 offset:5308
  ds_read_b32 v36, v219 offset:5312
  ds_read_b32 v37, v219 offset:5316
  ds_read_b32 v38, v219 offset:5320
  ds_read_b32 v39, v219 offset:5324
  ds_read_b32 v40, v219 offset:5328
  ds_read_b32 v41, v219 offset:5332
  ds_read_b32 v42, v219 offset:5336
  ds_read_b32 v43, v219 offset:4272
  ds_read_b32 v44, v219 offset:4276
  ds_read_b32 v45, v219 offset:4280
  ds_read_b32 v46, v219 offset:4284
  ds_read_b32 v47, v219 offset:4288
  ds_read_b32 v48, v219 offset:4292
  ds_read_b32 v49, v219 offset:4296
  ds_read_b32 v50, v219 offset:4300
  ds_read_b32 v51, v219 offset:4304
  ds_read_b32 v52, v219 offset:3240
  ds_read_b32 v53, v219 offset:3244
  ds_read_b32 v54, v219 offset:3248
  ds_read_b32 v55, v219 offset:3252
  ds_read_b32 v56, v219 offset:3256
  ds_read_b32 v57, v219 offset:3260
  ds_read_b32 v58, v219 offset:3264
  ds_read_b32 v59, v219 offset:3268
  ds_read_b32 v60, v219 offset:3272
  ds_read_b32 v61, v219 offset:2208
  ds_read_b32 v62, v219 offset:2212
  ds_read_b32 v63, v219 offset:2216
  ds_read_b32 v64, v219 offset:2220
  ds_read_b32 v65, v219 offset:2224
  ds_read_b32 v66, v219 offset:2228
  ds_read_b32 v67, v219 offset:2232
  ds_read_b32 v68, v219 offset:2236
  ds_read_b32 v69, v219 offset:2240
  ds_read_b32 v70, v219 offset:1176
  ds_read_b32 v71, v219 offset:1180
  ds_read_b32 v72, v219 offset:1184
  ds_read_b32 v73, v219 offset:1188
  ds_read_b32 v74, v219 offset:1192
  ds_read_b32 v75, v219 offset:1196
  ds_read_b32 v76, v219 offset:1200
  ds_read_b32 v77, v219 offset:1204
  ds_read_b32 v78, v219 offset:1208
  ds_read_b32 v79, v219 offset:144
  ds_read_b32 v80, v219 offset:148
  ds_read_b32 v81, v219 offset:152
  ds_read_b32 v82, v219 offset:156
  ds_read_b32 v83, v219 offset:160
  ds_read_b32 v84, v219 offset:164
  ds_read_b32 v85, v219 offset:168
  ds_read_b32 v86, v219 offset:172
  ds_read_b32 v87, v219 offset:176
  v_mov_b32 v100, 0
  v_mov_b32 v101, 0
  v_mov_b32 v102, 0
  v_mov_b32 v103, 0
  v_mov_b32 v104, 0
  v_mov_b32 v105, 0
  v_mov_b32 v106, 0
  v_mov_b32 v107, 0
  s_waitcnt lgkmcnt(15)
  v_dot2c_f32_bf16 v100, v0, v16
  v_dot2c_f32_bf16 v101, v0, v25
  v_dot2c_f32_bf16 v102, v0, v34
  v_dot2c_f32_bf16 v103, v0, v43
  v_dot2c_f32_bf16 v104, v0, v52
  v_dot2c_f32_bf16 v105, v0, v61
  v_dot2c_f32_bf16 v106, v0, v70
  s_waitcnt lgkmcnt(8)
  v_dot2c_f32_bf16 v107, v0, v79
  v_dot2c_f32_bf16 v100, v1, v17
  v_dot2c_f32_bf16 v101, v1, v26
  v_dot2c_f32_bf16 v102, v1, v35
  v_dot2c_f32_bf16 v103, v1, v44
  v_dot2c_f32_bf16 v104, v1, v53
  v_dot2c_f32_bf16 v105, v1, v62
  v_dot2c_f32_bf16 v106, v1, v71
  s_waitcnt lgkmcnt(7)
  v_dot2c_f32_bf16 v107, v1, v80
  v_dot2c_f32_bf16 v100, v2, v18
  v_dot2c_f32_bf16 v101, v2, v27
  v_dot2c_f32_bf16 v102, v2, v36
  v_dot2c_f32_bf16 v103, v2, v45
  v_dot2c_f32_bf16 v104, v2, v54
  v_dot2c_f32_bf16 v105, v2, v63
  v_dot2c_f32_bf16 v106, v2, v72
  s_waitcnt lgkmcnt(6)
  v_dot2c_f32_bf16 v107, v2, v81
  v_dot2c_f32_bf16 v100, v3, v19
  v_dot2c_f32_bf16 v101, v3, v28
  v_dot2c_f32_bf16 v102, v3, v37
  v_dot2c_f32_bf16 v103, v3, v46
  v_dot2c_f32_bf16 v104, v3, v55
  v_dot2c_f32_bf16 v105, v3, v64
  v_dot2c_f32_bf16 v106, v3, v73
  s_waitcnt lgkmcnt(5)
  v_dot2c_f32_bf16 v107, v3, v82
  v_dot2c_f32_bf16 v100, v4, v20
  v_dot2c_f32_bf16 v101, v4, v29
  v_dot2c_f32_bf16 v102, v4, v38
  v_dot2c_f32_bf16 v103, v4, v47
  v_dot2c_f32_bf16 v104, v4, v56
  v_dot2c_f32_bf16 v105, v4, v65
  v_dot2c_f32_bf16 v106, v4, v74
  s_waitcnt lgkmcnt(4)
  v_dot2c_f32_bf16 v107, v4, v83
  v_dot2c_f32_bf16 v100, v5, v21
  v_dot2c_f32_bf16 v101, v5, v30
  v_dot2c_f32_bf16 v102, v5, v39
  v_dot2c_f32_bf16 v103, v5, v48
  v_dot2c_f32_bf16 v104, v5, v57
  v_dot2c_f32_bf16 v105, v5, v66
  v_dot2c_f32_bf16 v106, v5, v75
  s_waitcnt lgkmcnt(3)
  v_dot2c_f32_bf16 v107, v5, v84
  v_dot2c_f32_bf16 v100, v6, v22
  v_dot2c_f32_bf16 v101, v6, v31
  v_dot2c_f32_bf16 v102, v6, v40
  v_dot2c_f32_bf16 v103, v6, v49
  v_dot2c_f32_bf16 v104, v6, v58
  v_dot2c_f32_bf16 v105, v6, v67
  v_dot2c_f32_bf16 v106, v6, v76
  s_waitcnt lgkmcnt(2)
  v_dot2c_f32_bf16 v107, v6, v85
  v_dot2c_f32_bf16 v100, v7, v23
  v_dot2c_f32_bf16 v101, v7, v32
  v_dot2c_f32_bf16 v102, v7, v41
  v_dot2c_f32_bf16 v103, v7, v50
  v_dot2c_f32_bf16 v104, v7, v59
  v_dot2c_f32_bf16 v105, v7, v68
  v_dot2c_f32_bf16 v106, v7, v77
  s_waitcnt lgkmcnt(1)
  v_dot2c_f32_bf16 v107, v7, v86
  v_dot2c_f32_bf16 v100, v8, v24
  v_dot2c_f32_bf16 v101, v8, v33
  v_dot2c_f32_bf16 v102, v8, v42
  v_dot2c_f32_bf16 v103, v8, v51
  v_dot2c_f32_bf16 v104, v8, v60
  v_dot2c_f32_bf16 v105, v8, v69
  v_dot2c_f32_bf16 v106, v8, v78
  s_waitcnt lgkmcnt(0)
  v_dot2c_f32_bf16 v107, v8, v87
  ds_read_b32 v16, v219 offset:7512
  ds_read_b32 v17, v219 offset:7516
  ds_read_b32 v18, v219 offset:7520
  ds_read_b32 v19, v219 offset:7524
  ds_read_b32 v20, v219 offset:7528
  ds_read_b32 v21, v219 offset:7532
  ds_read_b32 v22, v219 offset:7536
  ds_read_b32 v23, v219 offset:7540
  ds_read_b32 v24, v219 offset:7544
  ds_read_b32 v25, v219 offset:6480
  ds_read_b32 v26, v219 offset:6484
  ds_read_b32 v27, v219 offset:6488
  ds_read_b32 v28, v219 offset:6492
  ds_read_b32 v29, v219 offset:6496
  ds_read_b32 v30, v219 offset:6500
  ds_read_b32 v31, v219 offset:6504
  ds_read_b32 v32, v219 offset:6508
  ds_read_b32 v33, v219 offset:6512
  ds_read_b32 v34, v219 offset:5448
  ds_read_b32 v35, v219 offset:5452
  ds_read_b32 v36, v219 offset:5456
  ds_read_b32 v37, v219 offset:5460
  ds_read_b32 v38, v219 offset:5464
  ds_read_b32 v39, v219 offset:5468
  ds_read_b32 v40, v219 offset:5472
  ds_read_b32 v41, v219 offset:5476
  ds_read_b32 v42, v219 offset:5480
  ds_read_b32 v43, v219 offset:4416
  ds_read_b32 v44, v219 offset:4420
  ds_read_b32 v45, v219 offset:4424
  ds_read_b32 v46, v219 offset:4428
  ds_read_b32 v47, v219 offset:4432
  ds_read_b32 v48, v219 offset:4436
  ds_read_b32 v49, v219 offset:4440
  ds_read_b32 v50, v219 offset:4444
  ds_read_b32 v51, v219 offset:4448
  ds_read_b32 v52, v219 offset:3384
  ds_read_b32 v53, v219 offset:3388
  ds_read_b32 v54, v219 offset:3392
  ds_read_b32 v55, v219 offset:3396
  ds_read_b32 v56, v219 offset:3400
  ds_read_b32 v57, v219 offset:3404
  ds_read_b32 v58, v219 offset:3408
  ds_read_b32 v59, v219 offset:3412
  ds_read_b32 v60, v219 offset:3416
  ds_read_b32 v61, v219 offset:2352
  ds_read_b32 v62, v219 offset:2356
  ds_read_b32 v63, v219 offset:2360
  ds_read_b32 v64, v219 offset:2364
  ds_read_b32 v65, v219 offset:2368
  ds_read_b32 v66, v219 offset:2372
  ds_read_b32 v67, v219 offset:2376
  ds_read_b32 v68, v219 offset:2380
  ds_read_b32 v69, v219 offset:2384
  ds_read_b32 v70, v219 offset:1320
  ds_read_b32 v71, v219 offset:1324
  ds_read_b32 v72, v219 offset:1328
  ds_read_b32 v73, v219 offset:1332
  ds_read_b32 v74, v219 offset:1336
  ds_read_b32 v75, v219 offset:1340
  ds_read_b32 v76, v219 offset:1344
  ds_read_b32 v77, v219 offset:1348
  ds_read_b32 v78, v219 offset:1352
  ds_read_b32 v79, v219 offset:288
  ds_read_b32 v80, v219 offset:292
  ds_read_b32 v81, v219 offset:296
  ds_read_b32 v82, v219 offset:300
  ds_read_b32 v83, v219 offset:304
  ds_read_b32 v84, v219 offset:308
  ds_read_b32 v85, v219 offset:312
  ds_read_b32 v86, v219 offset:316
  ds_read_b32 v87, v219 offset:320
  v_add_u32 v211, s66, v200
  v_mov_b32 v212, 0xf149f2ca
  v_mul_f32 v100, s57, v100
  v_mul_f32 v101, s57, v101
  v_mul_f32 v102, s57, v102
  v_mul_f32 v103, s57, v103
  v_mul_f32 v104, s57, v104
  v_mul_f32 v105, s57, v105
  v_mul_f32 v106, s57, v106
  v_mul_f32 v107, s57, v107
  v_cmp_gt_u32 vcc, 2, v211
  s_nop 1
  v_cndmask_b32 v101, v101, v212, vcc
  v_cmp_gt_u32 vcc, 4, v211
  s_nop 1
  v_cndmask_b32 v102, v102, v212, vcc
  v_cmp_gt_u32 vcc, 6, v211
  s_nop 1
  v_cndmask_b32 v103, v103, v212, vcc
  v_cmp_gt_u32 vcc, 8, v211
  s_nop 1
  v_cndmask_b32 v104, v104, v212, vcc
  v_cmp_gt_u32 vcc, 10, v211
  s_nop 1
  v_cndmask_b32 v105, v105, v212, vcc
  v_cmp_gt_u32 vcc, 12, v211
  s_nop 1
  v_cndmask_b32 v106, v106, v212, vcc
  v_cmp_gt_u32 vcc, 14, v211
  s_nop 1
  v_cndmask_b32 v107, v107, v212, vcc
  v_max3_f32 v213, v100, v101, v102
  v_max3_f32 v213, v213, v103, v104
  v_max3_f32 v213, v213, v105, v106
  v_max_f32 v213, v213, v107
  v_sub_f32 v100, v100, v213
  v_sub_f32 v101, v101, v213
  v_sub_f32 v102, v102, v213
  v_sub_f32 v103, v103, v213
  v_sub_f32 v104, v104, v213
  v_sub_f32 v105, v105, v213
  v_sub_f32 v106, v106, v213
  v_sub_f32 v107, v107, v213
  v_exp_f32 v100, v100
  v_exp_f32 v101, v101
  v_exp_f32 v102, v102
  v_exp_f32 v103, v103
  v_exp_f32 v104, v104
  v_exp_f32 v105, v105
  v_exp_f32 v106, v106
  v_exp_f32 v107, v107
  v_add_f32 v213, v100, v101
  v_add_f32 v213, v213, v102
  v_add_f32 v213, v213, v103
  v_add_f32 v213, v213, v104
  v_add_f32 v213, v213, v105
  v_add_f32 v213, v213, v106
  v_add_f32 v213, v213, v107
  v_rcp_f32 v213, v213
  v_mov_b32 v214, 0
  v_mul_f32 v100, v213, v100
  v_mul_f32 v101, v213, v101
  v_mul_f32 v102, v213, v102
  v_mul_f32 v103, v213, v103
  v_mul_f32 v104, v213, v104
  v_mul_f32 v105, v213, v105
  v_mul_f32 v106, v213, v106
  v_mul_f32 v107, v213, v107
  v_mov_b32 v112, 0
  v_mov_b32 v113, 0
  v_mov_b32 v114, 0
  v_mov_b32 v115, 0
  v_mov_b32 v116, 0
  v_mov_b32 v117, 0
  v_mov_b32 v118, 0
  v_mov_b32 v119, 0
  v_mov_b32 v120, 0
  v_mov_b32 v121, 0
  v_mov_b32 v122, 0
  v_mov_b32 v123, 0
  v_mov_b32 v124, 0
  v_mov_b32 v125, 0
  v_mov_b32 v126, 0
  v_mov_b32 v127, 0
  v_mov_b32 v128, 0
  v_mov_b32 v129, 0
  v_cvt_pk_bf16_f32 v0, v100, v214
  v_cvt_pk_bf16_f32 v1, v214, v100
  s_waitcnt lgkmcnt(15)
  v_dot2c_f32_bf16 v112, v16, v0
  v_dot2c_f32_bf16 v113, v16, v1
  v_dot2c_f32_bf16 v114, v17, v0
  v_dot2c_f32_bf16 v115, v17, v1
  v_dot2c_f32_bf16 v116, v18, v0
  v_dot2c_f32_bf16 v117, v18, v1
  v_dot2c_f32_bf16 v118, v19, v0
  v_dot2c_f32_bf16 v119, v19, v1
  v_dot2c_f32_bf16 v120, v20, v0
  v_dot2c_f32_bf16 v121, v20, v1
  v_dot2c_f32_bf16 v122, v21, v0
  v_dot2c_f32_bf16 v123, v21, v1
  v_dot2c_f32_bf16 v124, v22, v0
  v_dot2c_f32_bf16 v125, v22, v1
  v_dot2c_f32_bf16 v126, v23, v0
  v_dot2c_f32_bf16 v127, v23, v1
  v_dot2c_f32_bf16 v128, v24, v0
  v_dot2c_f32_bf16 v129, v24, v1
  v_cvt_pk_bf16_f32 v2, v101, v214
  v_cvt_pk_bf16_f32 v3, v214, v101
  v_dot2c_f32_bf16 v112, v25, v2
  v_dot2c_f32_bf16 v113, v25, v3
  v_dot2c_f32_bf16 v114, v26, v2
  v_dot2c_f32_bf16 v115, v26, v3
  v_dot2c_f32_bf16 v116, v27, v2
  v_dot2c_f32_bf16 v117, v27, v3
  v_dot2c_f32_bf16 v118, v28, v2
  v_dot2c_f32_bf16 v119, v28, v3
  v_dot2c_f32_bf16 v120, v29, v2
  v_dot2c_f32_bf16 v121, v29, v3
  v_dot2c_f32_bf16 v122, v30, v2
  v_dot2c_f32_bf16 v123, v30, v3
  v_dot2c_f32_bf16 v124, v31, v2
  v_dot2c_f32_bf16 v125, v31, v3
  v_dot2c_f32_bf16 v126, v32, v2
  v_dot2c_f32_bf16 v127, v32, v3
  v_dot2c_f32_bf16 v128, v33, v2
  v_dot2c_f32_bf16 v129, v33, v3
  v_cvt_pk_bf16_f32 v0, v102, v214
  v_cvt_pk_bf16_f32 v1, v214, v102
  v_dot2c_f32_bf16 v112, v34, v0
  v_dot2c_f32_bf16 v113, v34, v1
  v_dot2c_f32_bf16 v114, v35, v0
  v_dot2c_f32_bf16 v115, v35, v1
  v_dot2c_f32_bf16 v116, v36, v0
  v_dot2c_f32_bf16 v117, v36, v1
  v_dot2c_f32_bf16 v118, v37, v0
  v_dot2c_f32_bf16 v119, v37, v1
  v_dot2c_f32_bf16 v120, v38, v0
  v_dot2c_f32_bf16 v121, v38, v1
  v_dot2c_f32_bf16 v122, v39, v0
  v_dot2c_f32_bf16 v123, v39, v1
  v_dot2c_f32_bf16 v124, v40, v0
  v_dot2c_f32_bf16 v125, v40, v1
  v_dot2c_f32_bf16 v126, v41, v0
  v_dot2c_f32_bf16 v127, v41, v1
  v_dot2c_f32_bf16 v128, v42, v0
  v_dot2c_f32_bf16 v129, v42, v1
  v_cvt_pk_bf16_f32 v2, v103, v214
  v_cvt_pk_bf16_f32 v3, v214, v103
  v_dot2c_f32_bf16 v112, v43, v2
  v_dot2c_f32_bf16 v113, v43, v3
  v_dot2c_f32_bf16 v114, v44, v2
  v_dot2c_f32_bf16 v115, v44, v3
  v_dot2c_f32_bf16 v116, v45, v2
  v_dot2c_f32_bf16 v117, v45, v3
  v_dot2c_f32_bf16 v118, v46, v2
  v_dot2c_f32_bf16 v119, v46, v3
  v_dot2c_f32_bf16 v120, v47, v2
  v_dot2c_f32_bf16 v121, v47, v3
  v_dot2c_f32_bf16 v122, v48, v2
  v_dot2c_f32_bf16 v123, v48, v3
  v_dot2c_f32_bf16 v124, v49, v2
  v_dot2c_f32_bf16 v125, v49, v3
  v_dot2c_f32_bf16 v126, v50, v2
  v_dot2c_f32_bf16 v127, v50, v3
  v_dot2c_f32_bf16 v128, v51, v2
  v_dot2c_f32_bf16 v129, v51, v3
  v_cvt_pk_bf16_f32 v0, v104, v214
  v_cvt_pk_bf16_f32 v1, v214, v104
  v_dot2c_f32_bf16 v112, v52, v0
  v_dot2c_f32_bf16 v113, v52, v1
  v_dot2c_f32_bf16 v114, v53, v0
  v_dot2c_f32_bf16 v115, v53, v1
  v_dot2c_f32_bf16 v116, v54, v0
  v_dot2c_f32_bf16 v117, v54, v1
  v_dot2c_f32_bf16 v118, v55, v0
  v_dot2c_f32_bf16 v119, v55, v1
  v_dot2c_f32_bf16 v120, v56, v0
  v_dot2c_f32_bf16 v121, v56, v1
  v_dot2c_f32_bf16 v122, v57, v0
  v_dot2c_f32_bf16 v123, v57, v1
  v_dot2c_f32_bf16 v124, v58, v0
  v_dot2c_f32_bf16 v125, v58, v1
  v_dot2c_f32_bf16 v126, v59, v0
  v_dot2c_f32_bf16 v127, v59, v1
  v_dot2c_f32_bf16 v128, v60, v0
  v_dot2c_f32_bf16 v129, v60, v1
  v_cvt_pk_bf16_f32 v2, v105, v214
  v_cvt_pk_bf16_f32 v3, v214, v105
  v_dot2c_f32_bf16 v112, v61, v2
  v_dot2c_f32_bf16 v113, v61, v3
  v_dot2c_f32_bf16 v114, v62, v2
  v_dot2c_f32_bf16 v115, v62, v3
  v_dot2c_f32_bf16 v116, v63, v2
  v_dot2c_f32_bf16 v117, v63, v3
  v_dot2c_f32_bf16 v118, v64, v2
  v_dot2c_f32_bf16 v119, v64, v3
  v_dot2c_f32_bf16 v120, v65, v2
  v_dot2c_f32_bf16 v121, v65, v3
  v_dot2c_f32_bf16 v122, v66, v2
  v_dot2c_f32_bf16 v123, v66, v3
  v_dot2c_f32_bf16 v124, v67, v2
  v_dot2c_f32_bf16 v125, v67, v3
  v_dot2c_f32_bf16 v126, v68, v2
  v_dot2c_f32_bf16 v127, v68, v3
  v_dot2c_f32_bf16 v128, v69, v2
  v_dot2c_f32_bf16 v129, v69, v3
  v_cvt_pk_bf16_f32 v0, v106, v214
  v_cvt_pk_bf16_f32 v1, v214, v106
  v_dot2c_f32_bf16 v112, v70, v0
  v_dot2c_f32_bf16 v113, v70, v1
  v_dot2c_f32_bf16 v114, v71, v0
  v_dot2c_f32_bf16 v115, v71, v1
  v_dot2c_f32_bf16 v116, v72, v0
  v_dot2c_f32_bf16 v117, v72, v1
  s_waitcnt lgkmcnt(14)
  v_dot2c_f32_bf16 v118, v73, v0
  v_dot2c_f32_bf16 v119, v73, v1
  s_waitcnt lgkmcnt(13)
  v_dot2c_f32_bf16 v120, v74, v0
  v_dot2c_f32_bf16 v121, v74, v1
  s_waitcnt lgkmcnt(12)
  v_dot2c_f32_bf16 v122, v75, v0
  v_dot2c_f32_bf16 v123, v75, v1
  s_waitcnt lgkmcnt(11)
  v_dot2c_f32_bf16 v124, v76, v0
  v_dot2c_f32_bf16 v125, v76, v1
  s_waitcnt lgkmcnt(10)
  v_dot2c_f32_bf16 v126, v77, v0
  v_dot2c_f32_bf16 v127, v77, v1
  s_waitcnt lgkmcnt(9)
  v_dot2c_f32_bf16 v128, v78, v0
  v_dot2c_f32_bf16 v129, v78, v1
  v_cvt_pk_bf16_f32 v2, v107, v214
  v_cvt_pk_bf16_f32 v3, v214, v107
  s_waitcnt lgkmcnt(8)
  v_dot2c_f32_bf16 v112, v79, v2
  v_dot2c_f32_bf16 v113, v79, v3
  s_waitcnt lgkmcnt(7)
  v_dot2c_f32_bf16 v114, v80, v2
  v_dot2c_f32_bf16 v115, v80, v3
  s_waitcnt lgkmcnt(6)
  v_dot2c_f32_bf16 v116, v81, v2
  v_dot2c_f32_bf16 v117, v81, v3
  s_waitcnt lgkmcnt(5)
  v_dot2c_f32_bf16 v118, v82, v2
  v_dot2c_f32_bf16 v119, v82, v3
  s_waitcnt lgkmcnt(4)
  v_dot2c_f32_bf16 v120, v83, v2
  v_dot2c_f32_bf16 v121, v83, v3
  s_waitcnt lgkmcnt(3)
  v_dot2c_f32_bf16 v122, v84, v2
  v_dot2c_f32_bf16 v123, v84, v3
  s_waitcnt lgkmcnt(2)
  v_dot2c_f32_bf16 v124, v85, v2
  v_dot2c_f32_bf16 v125, v85, v3
  s_waitcnt lgkmcnt(1)
  v_dot2c_f32_bf16 v126, v86, v2
  v_dot2c_f32_bf16 v127, v86, v3
  s_waitcnt lgkmcnt(0)
  v_dot2c_f32_bf16 v128, v87, v2
  v_dot2c_f32_bf16 v129, v87, v3
  v_cvt_pk_bf16_f32 v132, v112, v113
  v_cvt_pk_bf16_f32 v133, v114, v115
  v_cvt_pk_bf16_f32 v134, v116, v117
  v_cvt_pk_bf16_f32 v135, v118, v119
  v_cvt_pk_bf16_f32 v136, v120, v121
  v_cvt_pk_bf16_f32 v137, v122, v123
  v_cvt_pk_bf16_f32 v138, v124, v125
  v_cvt_pk_bf16_f32 v139, v126, v127
  v_cvt_pk_bf16_f32 v140, v128, v129
  ds_write_b32 v220, v132 offset:16384
  ds_write_b32 v220, v133 offset:16388
  ds_write_b32 v220, v134 offset:16392
  ds_write_b32 v220, v135 offset:16396
  ds_write_b32 v220, v136 offset:16400
  ds_write_b32 v220, v137 offset:16404
  ds_write_b32 v220, v138 offset:16408
  ds_write_b32 v220, v139 offset:16412
  ds_write_b32 v220, v140 offset:16416
  s_waitcnt lgkmcnt(0)
  s_barrier
  ds_read_b128 v[144:147], v218 offset:16384
  ds_read_b128 v[148:151], v218 offset:17408
  ds_read_b128 v[152:155], v218 offset:18432
  s_waitcnt lgkmcnt(2)
  buffer_store_dwordx4 v[144:147], v218, s[8:11], s64 offen offset:0 sc1
  s_waitcnt lgkmcnt(1)
  buffer_store_dwordx4 v[148:151], v218, s[8:11], s64 offen offset:1024 sc1
  s_waitcnt lgkmcnt(0)
  buffer_store_dwordx4 v[152:155], v218, s[8:11], s64 offen offset:2048 sc1
  s_mov_b32 s56, 36
  s_waitcnt vmcnt(0)
  s_barrier
  s_cmp_eq_u32 s52, 0
  s_cbranch_scc0 A_sig
  v_mov_b32 v211, 1
  v_mov_b32 v212, 0
  s_mov_b64 exec, 1
  buffer_atomic_add v211, v212, s[12:15], s56 offen
  s_mov_b64 exec, -1
A_sig:
W_o:
  s_and_b32 s54, s53, 31
  s_mul_i32 s68, s54, 57
  s_lshr_b32 s68, s68, 9
  s_mul_i32 s56, s68, 9
  s_sub_u32 s70, s54, s56
  s_bfe_u32 s55, s53, 0x10005
  s_mul_i32 s55, s55, 9
  s_add_u32 s70, s70, s55
  s_bfe_u32 s69, s53, 0x10006
  s_lshr_b32 s55, s53, 5
  s_mul_i32 s56, s55, 5
  s_add_u32 s56, s56, s54
  s_sub_u32 s56, s56, 37
  s_add_u32 s57, s54, 20
  s_cmp_eq_u32 s55, 6
  s_cselect_b32 s56, s57, s56
  s_cselect_b32 s68, 3, s68
  s_cmp_ge_u32 s56, 18
  s_cselect_b32 s55, 1, 0
  s_cselect_b32 s57, 18, 0
  s_sub_u32 s56, s56, s57
  s_cmp_eq_u32 s68, 3
  s_cselect_b32 s69, s55, s69
  s_cselect_b32 s70, s56, s70
  v_lshrrev_b32 v211, 2, v200
  v_mul_u32_u24 v211, 1152, v211
  v_and_b32 v212, 3, v200
  v_lshl_add_u32 v207, v212, 4, v211
  s_lshl_b32 s54, s70, 6
  s_mul_i32 s55, s52, 1179648
  s_add_u32 s62, s54, s55
  s_mul_i32 s55, s52, 184320
  s_add_u32 s63, s54, s55
  s_mul_i32 s61, s52, 40960
  v_bfe_u32 v211, v200, 2, 2
  v_lshlrev_b32 v212, 4, v212
  v_add_u32 v212, s61, v212
  v_lshl_add_u32 v212, v211, 6, v212
  v_lshrrev_b32 v213, 4, v200
  v_lshl_add_u32 v210, v213, 9, v212
  v_lshrrev_b32 v214, 5, v200
  v_lshl_add_u32 v209, v214, 10, v212
  v_and_b32 v214, 1, v213
  v_lshl_add_u32 v209, v214, 8, v209
  s_add_u32 m0, s61, 0
  s_add_u32 s54, s62, 0
  buffer_load_dwordx4 v207, s[28:31], s54 offen lds
  s_add_u32 m0, s61, 1024
  s_add_u32 s54, s62, 18432
  buffer_load_dwordx4 v207, s[28:31], s54 offen lds
  s_add_u32 m0, s61, 2048
  s_add_u32 s54, s62, 36864
  buffer_load_dwordx4 v207, s[28:31], s54 offen lds
  s_add_u32 m0, s61, 3072
  s_add_u32 s54, s62, 55296
  buffer_load_dwordx4 v207, s[28:31], s54 offen lds
  s_add_u32 m0, s61, 4096
  s_add_u32 s54, s62, 73728
  buffer_load_dwordx4 v207, s[28:31], s54 offen lds
  s_add_u32 m0, s61, 5120
  s_add_u32 s54, s62, 92160
  buffer_load_dwordx4 v207, s[28:31], s54 offen lds
  s_add_u32 m0, s61, 6144
  s_add_u32 s54, s62, 110592
  buffer_load_dwordx4 v207, s[28:31], s54 offen lds
  s_add_u32 m0, s61, 7168
  s_add_u32 s54, s62, 129024
  buffer_load_dwordx4 v207, s[28:31], s54 offen lds
  s_add_u32 m0, s61, 8192
  s_add_u32 s54, s62, 147456
  buffer_load_dwordx4 v207, s[28:31], s54 offen lds
  s_add_u32 m0, s61, 9216
  s_add_u32 s54, s62, 165888
  buffer_load_dwordx4 v207, s[28:31], s54 offen lds
  s_add_u32 m0, s61, 10240
  s_add_u32 s54, s62, 184320
  buffer_load_dwordx4 v207, s[28:31], s54 offen lds
  s_add_u32 m0, s61, 11264
  s_add_u32 s54, s62, 202752
  buffer_load_dwordx4 v207, s[28:31], s54 offen lds
  s_add_u32 m0, s61, 12288
  s_add_u32 s54, s62, 221184
  buffer_load_dwordx4 v207, s[28:31], s54 offen lds
  s_add_u32 m0, s61, 13312
  s_add_u32 s54, s62, 239616
  buffer_load_dwordx4 v207, s[28:31], s54 offen lds
  s_add_u32 m0, s61, 14336
  s_add_u32 s54, s62, 258048
  buffer_load_dwordx4 v207, s[28:31], s54 offen lds
  s_add_u32 m0, s61, 15360
  s_add_u32 s54, s62, 276480
  buffer_load_dwordx4 v207, s[28:31], s54 offen lds
  s_add_u32 m0, s61, 16384
  s_add_u32 s54, s62, 294912
  buffer_load_dwordx4 v207, s[28:31], s54 offen lds
  s_add_u32 m0, s61, 17408
  s_add_u32 s54, s62, 313344
  buffer_load_dwordx4 v207, s[28:31], s54 offen lds
  s_add_u32 m0, s61, 18432
  s_add_u32 s54, s62, 331776
  buffer_load_dwordx4 v207, s[28:31], s54 offen lds
  s_add_u32 m0, s61, 19456
  s_add_u32 s54, s62, 350208
  buffer_load_dwordx4 v207, s[28:31], s54 offen lds
  s_add_u32 m0, s61, 20480
  s_add_u32 s54, s62, 368640
  buffer_load_dwordx4 v207, s[28:31], s54 offen lds
  s_add_u32 m0, s61, 21504
  s_add_u32 s54, s62, 387072
  buffer_load_dwordx4 v207, s[28:31], s54 offen lds
  s_add_u32 m0, s61, 22528
  s_add_u32 s54, s62, 405504
  buffer_load_dwordx4 v207, s[28:31], s54 offen lds
  s_add_u32 m0, s61, 23552
  s_add_u32 s54, s62, 423936
  buffer_load_dwordx4 v207, s[28:31], s54 offen lds
  s_add_u32 m0, s61, 24576
  s_add_u32 s54, s62, 442368
  buffer_load_dwordx4 v207, s[28:31], s54 offen lds
  s_add_u32 m0, s61, 25600
  s_add_u32 s54, s62, 460800
  buffer_load_dwordx4 v207, s[28:31], s54 offen lds
  s_add_u32 m0, s61, 26624
  s_add_u32 s54, s62, 479232
  buffer_load_dwordx4 v207, s[28:31], s54 offen lds
  s_add_u32 m0, s61, 27648
  s_add_u32 s54, s62, 497664
  buffer_load_dwordx4 v207, s[28:31], s54 offen lds
  s_add_u32 m0, s61, 28672
  s_add_u32 s54, s62, 516096
  buffer_load_dwordx4 v207, s[28:31], s54 offen lds
  s_add_u32 m0, s61, 29696
  s_add_u32 s54, s62, 534528
  buffer_load_dwordx4 v207, s[28:31], s54 offen lds
  s_add_u32 m0, s61, 30720
  s_add_u32 s54, s62, 552960
  buffer_load_dwordx4 v207, s[28:31], s54 offen lds
  s_add_u32 m0, s61, 31744
  s_add_u32 s54, s62, 571392
  buffer_load_dwordx4 v207, s[28:31], s54 offen lds
  s_add_u32 m0, s61, 32768
  s_add_u32 s54, s62, 589824
  buffer_load_dwordx4 v207, s[28:31], s54 offen lds
  s_add_u32 m0, s61, 33792
  s_add_u32 s54, s62, 608256
  buffer_load_dwordx4 v207, s[28:31], s54 offen lds
  s_add_u32 m0, s61, 34816
  s_add_u32 s54, s62, 626688
  buffer_load_dwordx4 v207, s[28:31], s54 offen lds
  s_add_u32 m0, s61, 35840
  s_add_u32 s54, s62, 645120
  buffer_load_dwordx4 v207, s[28:31], s54 offen lds
  s_add_u32 m0, s61, 36864
  s_add_u32 s54, s62, 663552
  buffer_load_dwordx4 v207, s[28:31], s54 offen lds
  s_add_u32 m0, s61, 37888
  s_add_u32 s54, s62, 681984
  buffer_load_dwordx4 v207, s[28:31], s54 offen lds
  s_waitcnt vmcnt(36) lgkmcnt(0)
  s_add_u32 m0, s61, 38912
  s_add_u32 s54, s62, 700416
  buffer_load_dwordx4 v207, s[28:31], s54 offen lds
  s_add_u32 m0, s61, 39936
  s_add_u32 s54, s62, 718848
  buffer_load_dwordx4 v207, s[28:31], s54 offen lds
  ds_read_b64_tr_b16 a[0:1], v209 offset:0
  ds_read_b64_tr_b16 a[2:3], v209 offset:512
  ds_read_b64_tr_b16 a[4:5], v209 offset:8
  ds_read_b64_tr_b16 a[6:7], v209 offset:520
  s_waitcnt vmcnt(36) lgkmcnt(0)
  s_add_u32 m0, s61, 0
  s_add_u32 s54, s62, 737280
  buffer_load_dwordx4 v207, s[28:31], s54 offen lds
  s_add_u32 m0, s61, 1024
  s_add_u32 s54, s62, 755712
  buffer_load_dwordx4 v207, s[28:31], s54 offen lds
  ds_read_b64_tr_b16 a[8:9], v209 offset:2048
  ds_read_b64_tr_b16 a[10:11], v209 offset:2560
  ds_read_b64_tr_b16 a[12:13], v209 offset:2056
  ds_read_b64_tr_b16 a[14:15], v209 offset:2568
  s_waitcnt vmcnt(36) lgkmcnt(0)
  s_add_u32 m0, s61, 2048
  s_add_u32 s54, s62, 774144
  buffer_load_dwordx4 v207, s[28:31], s54 offen lds
  s_add_u32 m0, s61, 3072
  s_add_u32 s54, s62, 792576
  buffer_load_dwordx4 v207, s[28:31], s54 offen lds
  ds_read_b64_tr_b16 a[16:17], v209 offset:4096
  ds_read_b64_tr_b16 a[18:19], v209 offset:4608
  ds_read_b64_tr_b16 a[20:21], v209 offset:4104
  ds_read_b64_tr_b16 a[22:23], v209 offset:4616
  s_waitcnt vmcnt(36) lgkmcnt(0)
  s_add_u32 m0, s61, 4096
  s_add_u32 s54, s62, 811008
  buffer_load_dwordx4 v207, s[28:31], s54 offen lds
  s_add_u32 m0, s61, 5120
  s_add_u32 s54, s62, 829440
  buffer_load_dwordx4 v207, s[28:31], s54 offen lds
  ds_read_b64_tr_b16 a[24:25], v209 offset:6144
  ds_read_b64_tr_b16 a[26:27], v209 offset:6656
  ds_read_b64_tr_b16 a[28:29], v209 offset:6152
  ds_read_b64_tr_b16 a[30:31], v209 offset:6664
  s_waitcnt vmcnt(36) lgkmcnt(0)
  s_add_u32 m0, s61, 6144
  s_add_u32 s54, s62, 847872
  buffer_load_dwordx4 v207, s[28:31], s54 offen lds
  s_add_u32 m0, s61, 7168
  s_add_u32 s54, s62, 866304
  buffer_load_dwordx4 v207, s[28:31], s54 offen lds
  ds_read_b64_tr_b16 a[32:33], v209 offset:8192
  ds_read_b64_tr_b16 a[34:35], v209 offset:8704
  ds_read_b64_tr_b16 a[36:37], v209 offset:8200
  ds_read_b64_tr_b16 a[38:39], v209 offset:8712
  s_waitcnt vmcnt(36) lgkmcnt(0)
  s_add_u32 m0, s61, 8192
  s_add_u32 s54, s62, 884736
  buffer_load_dwordx4 v207, s[28:31], s54 offen lds
  s_add_u32 m0, s61, 9216
  s_add_u32 s54, s62, 903168
  buffer_load_dwordx4 v207, s[28:31], s54 offen lds
  ds_read_b64_tr_b16 a[40:41], v209 offset:10240
  ds_read_b64_tr_b16 a[42:43], v209 offset:10752
  ds_read_b64_tr_b16 a[44:45], v209 offset:10248
  ds_read_b64_tr_b16 a[46:47], v209 offset:10760
  s_waitcnt vmcnt(36) lgkmcnt(0)
  s_add_u32 m0, s61, 10240
  s_add_u32 s54, s62, 921600
  buffer_load_dwordx4 v207, s[28:31], s54 offen lds
  s_add_u32 m0, s61, 11264
  s_add_u32 s54, s62, 940032
  buffer_load_dwordx4 v207, s[28:31], s54 offen lds
  ds_read_b64_tr_b16 a[48:49], v209 offset:12288
  ds_read_b64_tr_b16 a[50:51], v209 offset:12800
  ds_read_b64_tr_b16 a[52:53], v209 offset:12296
  ds_read_b64_tr_b16 a[54:55], v209 offset:12808
  s_waitcnt vmcnt(36) lgkmcnt(0)
  s_add_u32 m0, s61, 12288
  s_add_u32 s54, s62, 958464
  buffer_load_dwordx4 v207, s[28:31], s54 offen lds
  s_add_u32 m0, s61, 13312
  s_add_u32 s54, s62, 976896
  buffer_load_dwordx4 v207, s[28:31], s54 offen lds
  ds_read_b64_tr_b16 a[56:57], v209 offset:14336
  ds_read_b64_tr_b16 a[58:59], v209 offset:14848
  ds_read_b64_tr_b16 a[60:61], v209 offset:14344
  ds_read_b64_tr_b16 a[62:63], v209 offset:14856
  s_waitcnt vmcnt(36) lgkmcnt(0)
  s_add_u32 m0, s61, 14336
  s_add_u32 s54, s62, 995328
  buffer_load_dwordx4 v207, s[28:31], s54 offen lds
  s_add_u32 m0, s61, 15360
  s_add_u32 s54, s62, 1013760
  buffer_load_dwordx4 v207, s[28:31], s54 offen lds
  ds_read_b64_tr_b16 a[64:65], v209 offset:16384
  ds_read_b64_tr_b16 a[66:67], v209 offset:16896
  ds_read_b64_tr_b16 a[68:69], v209 offset:16392
  ds_read_b64_tr_b16 a[70:71], v209 offset:16904
  s_waitcnt vmcnt(36) lgkmcnt(0)
  s_add_u32 m0, s61, 16384
  s_add_u32 s54, s62, 1032192
  buffer_load_dwordx4 v207, s[28:31], s54 offen lds
  s_add_u32 m0, s61, 17408
  s_add_u32 s54, s62, 1050624
  buffer_load_dwordx4 v207, s[28:31], s54 offen lds
  ds_read_b64_tr_b16 a[72:73], v209 offset:18432
  ds_read_b64_tr_b16 a[74:75], v209 offset:18944
  ds_read_b64_tr_b16 a[76:77], v209 offset:18440
  ds_read_b64_tr_b16 a[78:79], v209 offset:18952
  s_waitcnt vmcnt(36) lgkmcnt(0)
  s_add_u32 m0, s61, 18432
  s_add_u32 s54, s62, 1069056
  buffer_load_dwordx4 v207, s[28:31], s54 offen lds
  s_add_u32 m0, s61, 19456
  s_add_u32 s54, s62, 1087488
  buffer_load_dwordx4 v207, s[28:31], s54 offen lds
  ds_read_b64_tr_b16 a[80:81], v209 offset:20480
  ds_read_b64_tr_b16 a[82:83], v209 offset:20992
  ds_read_b64_tr_b16 a[84:85], v209 offset:20488
  ds_read_b64_tr_b16 a[86:87], v209 offset:21000
  s_waitcnt vmcnt(36) lgkmcnt(0)
  s_add_u32 m0, s61, 20480
  s_add_u32 s54, s62, 1105920
  buffer_load_dwordx4 v207, s[28:31], s54 offen lds
  s_add_u32 m0, s61, 21504
  s_add_u32 s54, s62, 1124352
  buffer_load_dwordx4 v207, s[28:31], s54 offen lds
  ds_read_b64_tr_b16 a[88:89], v209 offset:22528
  ds_read_b64_tr_b16 a[90:91], v209 offset:23040
  ds_read_b64_tr_b16 a[92:93], v209 offset:22536
  ds_read_b64_tr_b16 a[94:95], v209 offset:23048
  s_waitcnt vmcnt(36) lgkmcnt(0)
  s_add_u32 m0, s61, 22528
  s_add_u32 s54, s62, 1142784
  buffer_load_dwordx4 v207, s[28:31], s54 offen lds
  s_add_u32 m0, s61, 23552
  s_add_u32 s54, s62, 1161216
  buffer_load_dwordx4 v207, s[28:31], s54 offen lds
  ds_read_b64_tr_b16 a[96:97], v209 offset:24576
  ds_read_b64_tr_b16 a[98:99], v209 offset:25088
  ds_read_b64_tr_b16 a[100:101], v209 offset:24584
  ds_read_b64_tr_b16 a[102:103], v209 offset:25096
  s_waitcnt vmcnt(36) lgkmcnt(0)
  s_add_u32 m0, s61, 24576
  s_add_u32 s54, s63, 0
  buffer_load_dwordx4 v207, s[40:43], s54 offen lds
  s_add_u32 m0, s61, 25600
  s_add_u32 s54, s63, 18432
  buffer_load_dwordx4 v207, s[40:43], s54 offen lds
  ds_read_b64_tr_b16 a[104:105], v209 offset:26624
  ds_read_b64_tr_b16 a[106:107], v209 offset:27136
  ds_read_b64_tr_b16 a[108:109], v209 offset:26632
  ds_read_b64_tr_b16 a[110:111], v209 offset:27144
  s_waitcnt vmcnt(36) lgkmcnt(0)
  s_add_u32 m0, s61, 26624
  s_add_u32 s54, s63, 36864
  buffer_load_dwordx4 v207, s[40:43], s54 offen lds
  s_add_u32 m0, s61, 27648
  s_add_u32 s54, s63, 55296
  buffer_load_dwordx4 v207, s[40:43], s54 offen lds
  ds_read_b64_tr_b16 a[112:113], v209 offset:28672
  ds_read_b64_tr_b16 a[114:115], v209 offset:29184
  ds_read_b64_tr_b16 a[116:117], v209 offset:28680
  ds_read_b64_tr_b16 a[118:119], v209 offset:29192
  s_waitcnt vmcnt(36) lgkmcnt(0)
  s_add_u32 m0, s61, 28672
  s_add_u32 s54, s63, 73728
  buffer_load_dwordx4 v207, s[40:43], s54 offen lds
  s_add_u32 m0, s61, 29696
  s_add_u32 s54, s63, 92160
  buffer_load_dwordx4 v207, s[40:43], s54 offen lds
  ds_read_b64_tr_b16 a[120:121], v209 offset:30720
  ds_read_b64_tr_b16 a[122:123], v209 offset:31232
  ds_read_b64_tr_b16 a[124:125], v209 offset:30728
  ds_read_b64_tr_b16 a[126:127], v209 offset:31240
  s_waitcnt vmcnt(36) lgkmcnt(0)
  s_add_u32 m0, s61, 30720
  s_add_u32 s54, s63, 110592
  buffer_load_dwordx4 v207, s[40:43], s54 offen lds
  s_add_u32 m0, s61, 31744
  s_add_u32 s54, s63, 129024
  buffer_load_dwordx4 v207, s[40:43], s54 offen lds
  ds_read_b64_tr_b16 a[128:129], v209 offset:32768
  ds_read_b64_tr_b16 a[130:131], v209 offset:33280
  ds_read_b64_tr_b16 a[132:133], v209 offset:32776
  ds_read_b64_tr_b16 a[134:135], v209 offset:33288
  s_waitcnt vmcnt(36) lgkmcnt(0)
  s_add_u32 m0, s61, 32768
  s_add_u32 s54, s63, 147456
  buffer_load_dwordx4 v207, s[40:43], s54 offen lds
  s_add_u32 m0, s61, 33792
  s_add_u32 s54, s63, 165888
  buffer_load_dwordx4 v207, s[40:43], s54 offen lds
  ds_read_b64_tr_b16 a[136:137], v209 offset:34816
  ds_read_b64_tr_b16 a[138:139], v209 offset:35328
  ds_read_b64_tr_b16 a[140:141], v209 offset:34824
  ds_read_b64_tr_b16 a[142:143], v209 offset:35336
  s_waitcnt vmcnt(36) lgkmcnt(0)
  ds_read_b64_tr_b16 a[144:145], v209 offset:36864
  ds_read_b64_tr_b16 a[146:147], v209 offset:37376
  ds_read_b64_tr_b16 a[148:149], v209 offset:36872
  ds_read_b64_tr_b16 a[150:151], v209 offset:37384
  s_waitcnt vmcnt(34) lgkmcnt(0)
  ds_read_b64_tr_b16 a[152:153], v209 offset:38912
  ds_read_b64_tr_b16 a[154:155], v209 offset:39424
  ds_read_b64_tr_b16 a[156:157], v209 offset:38920
  ds_read_b64_tr_b16 a[158:159], v209 offset:39432
  s_waitcnt vmcnt(32) lgkmcnt(0)
  ds_read_b64_tr_b16 a[160:161], v209 offset:0
  ds_read_b64_tr_b16 a[162:163], v209 offset:512
  ds_read_b64_tr_b16 a[164:165], v209 offset:8
  ds_read_b64_tr_b16 a[166:167], v209 offset:520
  s_waitcnt vmcnt(30) lgkmcnt(0)
  ds_read_b64_tr_b16 a[168:169], v209 offset:2048
  ds_read_b64_tr_b16 a[170:171], v209 offset:2560
  ds_read_b64_tr_b16 a[172:173], v209 offset:2056
  ds_read_b64_tr_b16 a[174:175], v209 offset:2568
  s_waitcnt vmcnt(28) lgkmcnt(0)
  ds_read_b64_tr_b16 a[176:177], v209 offset:4096
  ds_read_b64_tr_b16 a[178:179], v209 offset:4608
  ds_read_b64_tr_b16 a[180:181], v209 offset:4104
  ds_read_b64_tr_b16 a[182:183], v209 offset:4616
  s_waitcnt vmcnt(26) lgkmcnt(0)
  ds_read_b64_tr_b16 a[184:185], v209 offset:6144
  ds_read_b64_tr_b16 a[186:187], v209 offset:6656
  ds_read_b64_tr_b16 a[188:189], v209 offset:6152
  ds_read_b64_tr_b16 a[190:191], v209 offset:6664
  s_waitcnt vmcnt(24) lgkmcnt(0)
  ds_read_b64_tr_b16 a[192:193], v209 offset:8192
  ds_read_b64_tr_b16 a[194:195], v209 offset:8704
  ds_read_b64_tr_b16 a[196:197], v209 offset:8200
  ds_read_b64_tr_b16 a[198:199], v209 offset:8712
  s_waitcnt vmcnt(22) lgkmcnt(0)
  ds_read_b64_tr_b16 a[200:201], v209 offset:10240
  ds_read_b64_tr_b16 a[202:203], v209 offset:10752
  ds_read_b64_tr_b16 a[204:205], v209 offset:10248
  ds_read_b64_tr_b16 a[206:207], v209 offset:10760
  s_waitcnt vmcnt(20) lgkmcnt(0)
  ds_read_b64_tr_b16 a[208:209], v209 offset:12288
  ds_read_b64_tr_b16 a[210:211], v209 offset:12800
  ds_read_b64_tr_b16 a[212:213], v209 offset:12296
  ds_read_b64_tr_b16 a[214:215], v209 offset:12808
  s_waitcnt vmcnt(18) lgkmcnt(0)
  ds_read_b64_tr_b16 a[216:217], v209 offset:14336
  ds_read_b64_tr_b16 a[218:219], v209 offset:14848
  ds_read_b64_tr_b16 a[220:221], v209 offset:14344
  ds_read_b64_tr_b16 a[222:223], v209 offset:14856
  s_waitcnt vmcnt(16) lgkmcnt(0)
  ds_read_b64_tr_b16 a[224:225], v209 offset:16384
  ds_read_b64_tr_b16 a[226:227], v209 offset:16896
  ds_read_b64_tr_b16 a[228:229], v209 offset:16392
  ds_read_b64_tr_b16 a[230:231], v209 offset:16904
  s_waitcnt vmcnt(14) lgkmcnt(0)
  ds_read_b64_tr_b16 a[232:233], v209 offset:18432
  ds_read_b64_tr_b16 a[234:235], v209 offset:18944
  ds_read_b64_tr_b16 a[236:237], v209 offset:18440
  ds_read_b64_tr_b16 a[238:239], v209 offset:18952
  s_waitcnt vmcnt(12) lgkmcnt(0)
  ds_read_b64_tr_b16 a[240:241], v209 offset:20480
  ds_read_b64_tr_b16 a[242:243], v209 offset:20992
  ds_read_b64_tr_b16 a[244:245], v209 offset:20488
  ds_read_b64_tr_b16 a[246:247], v209 offset:21000
  s_waitcnt vmcnt(10) lgkmcnt(0)
  ds_read_b64_tr_b16 a[248:249], v209 offset:22528
  ds_read_b64_tr_b16 a[250:251], v209 offset:23040
  ds_read_b64_tr_b16 a[252:253], v209 offset:22536
  ds_read_b64_tr_b16 a[254:255], v209 offset:23048
  s_waitcnt vmcnt(8) lgkmcnt(0)
  ds_read_b64_tr_b16 v[216:217], v210 offset:24576
  ds_read_b64_tr_b16 v[218:219], v210 offset:24832
  ds_read_b64_tr_b16 v[220:221], v210 offset:24584
  ds_read_b64_tr_b16 v[222:223], v210 offset:24840
  s_waitcnt vmcnt(6) lgkmcnt(0)
  ds_read_b64_tr_b16 v[224:225], v210 offset:26624
  ds_read_b64_tr_b16 v[226:227], v210 offset:26880
  ds_read_b64_tr_b16 v[228:229], v210 offset:26632
  ds_read_b64_tr_b16 v[230:231], v210 offset:26888
  s_waitcnt vmcnt(4) lgkmcnt(0)
  ds_read_b64_tr_b16 v[232:233], v210 offset:28672
  ds_read_b64_tr_b16 v[234:235], v210 offset:28928
  ds_read_b64_tr_b16 v[236:237], v210 offset:28680
  ds_read_b64_tr_b16 v[238:239], v210 offset:28936
  s_waitcnt vmcnt(2) lgkmcnt(0)
  ds_read_b64_tr_b16 v[240:241], v210 offset:30720
  ds_read_b64_tr_b16 v[242:243], v210 offset:30976
  ds_read_b64_tr_b16 v[244:245], v210 offset:30728
  ds_read_b64_tr_b16 v[246:247], v210 offset:30984
  s_waitcnt vmcnt(0) lgkmcnt(0)
  ds_read_b64_tr_b16 v[248:249], v210 offset:32768
  ds_read_b64_tr_b16 v[250:251], v210 offset:33024
  ds_read_b64_tr_b16 v[252:253], v210 offset:32776
  ds_read_b64_tr_b16 v[254:255], v210 offset:33032
  v_and_b32 v211, 15, v200
  s_lshl_b32 s54, s69, 4
  v_add_u32 v211, s54, v211
  v_lshl_add_u32 v212, v214, 5, v211
  v_lshlrev_b32 v164, 4, v212
  v_lshrrev_b32 v212, 5, v200
  v_lshl_add_u32 v164, v212, 10, v164
  v_mul_u32_u24 v167, 1152, v211
  v_lshl_add_u32 v167, v213, 4, v167
  v_lshlrev_b32 v166, 2, v211
  v_mul_u32_u24 v211, 144, v211
  s_mul_i32 s54, s52, 20
  s_mov_b32 s55, 294768
  v_mov_b32 v214, 0x40000000
  v_add_u32 v212, s54, v213
  v_add_u32 v212, 0, v212
  v_mul_u32_u24 v176, 57, v212
  v_lshrrev_b32 v176, 9, v176
  v_mul_lo_u32 v176, v176, s55
  v_lshl_add_u32 v176, v212, 4, v176
  v_add_u32 v176, v176, v211
  v_cmp_lt_u32 vcc, 71, v212
  s_nop 1
  v_cndmask_b32 v176, v176, v214, vcc
  v_add_u32 v212, s54, v213
  v_add_u32 v212, 4, v212
  v_mul_u32_u24 v177, 57, v212
  v_lshrrev_b32 v177, 9, v177
  v_mul_lo_u32 v177, v177, s55
  v_lshl_add_u32 v177, v212, 4, v177
  v_add_u32 v177, v177, v211
  v_cmp_lt_u32 vcc, 71, v212
  s_nop 1
  v_cndmask_b32 v177, v177, v214, vcc
  v_add_u32 v212, s54, v213
  v_add_u32 v212, 8, v212
  v_mul_u32_u24 v178, 57, v212
  v_lshrrev_b32 v178, 9, v178
  v_mul_lo_u32 v178, v178, s55
  v_lshl_add_u32 v178, v212, 4, v178
  v_add_u32 v178, v178, v211
  v_cmp_lt_u32 vcc, 71, v212
  s_nop 1
  v_cndmask_b32 v178, v178, v214, vcc
  v_add_u32 v212, s54, v213
  v_add_u32 v212, 12, v212
  v_mul_u32_u24 v179, 57, v212
  v_lshrrev_b32 v179, 9, v179
  v_mul_lo_u32 v179, v179, s55
  v_lshl_add_u32 v179, v212, 4, v179
  v_add_u32 v179, v179, v211
  v_cmp_lt_u32 vcc, 71, v212
  s_nop 1
  v_cndmask_b32 v179, v179, v214, vcc
  v_add_u32 v212, s54, v213
  v_add_u32 v212, 16, v212
  v_mul_u32_u24 v180, 57, v212
  v_lshrrev_b32 v180, 9, v180
  v_mul_lo_u32 v180, v180, s55
  v_lshl_add_u32 v180, v212, 4, v180
  v_add_u32 v180, v180, v211
  v_cmp_lt_u32 vcc, 71, v212
  s_nop 1
  v_cndmask_b32 v180, v180, v214, vcc
  v_lshlrev_b32 v208, 2, v200
  s_lshl_b32 s54, s52, 11
  v_add_u32 v168, s54, v201
  s_mov_b32 s56, 128
  s_mov_b32 s57, 36
  s_waitcnt lgkmcnt(0)
  s_cmp_eq_u32 s52, 0
  s_cbranch_scc0 O_p1_d
  s_mov_b32 exec_hi, 0
  s_mov_b32 exec_lo, -1
O_p1:
  buffer_load_dword v211, v208, s[12:15], s56 offen sc1
  s_add_u32 s65, s65, 1
  s_waitcnt vmcnt(0)
  v_cmp_gt_u32 vcc, 0x700, v211
  s_cbranch_vccz O_p1_x
  s_sleep 16
  s_cmp_lt_u32 s65, 131072
  s_cbranch_scc1 O_p1
O_p1_x:
  s_mov_b64 exec, -1
O_p1_d:
  s_barrier
  s_cmp_eq_u32 s52, 0
  s_cbranch_scc0 O_a_d
  s_mov_b32 exec_hi, 0
  s_mov_b32 exec_lo, 1
O_a:
  buffer_load_dword v211, v208, s[12:15], s57 offen sc1
  s_add_u32 s65, s65, 1
  s_waitcnt vmcnt(0)
  v_cmp_gt_u32 vcc, 0x80, v211
  s_cbranch_vccz O_a_x
  s_sleep 16
  s_cmp_lt_u32 s65, 131072
  s_cbranch_scc1 O_a
O_a_x:
  s_mov_b64 exec, -1
O_a_d:
  s_barrier
  s_and_b32 s54, s68, 1
  v_bfe_u32 v211, v200, 3, 1
  v_cmp_ne_u32 vcc, s54, v211
  v_xor_b32 v211, 0x880, v164
  v_mov_b32 v212, 0x40000000
  v_cndmask_b32 v172, v164, v211, vcc
  v_cndmask_b32 v173, v167, v212, vcc
  s_lshr_b32 s54, s68, 1
  s_sub_u32 s59, 1, s54
  s_sub_u32 s76, 61, s54
  s_lshl_b32 s54, s68, 3
  s_lshr_b32 s75, 0x3e020403, s54
  s_and_b32 s75, s75, 0xff
  s_mul_i32 s55, s59, 4608
  s_add_u32 s55, s55, 62914560
  buffer_load_dwordx4 v[128:131], v176, s[8:11], s55 offen sc1
  buffer_load_dwordx4 v[132:135], v177, s[8:11], s55 offen sc1
  buffer_load_dwordx4 v[136:139], v178, s[8:11], s55 offen sc1
  buffer_load_dwordx4 v[140:143], v179, s[8:11], s55 offen sc1
  buffer_load_dwordx4 v[144:147], v180, s[8:11], s55 offen sc1
  s_lshl_b32 s55, s59, 7
  s_add_u32 s55, s55, 66060288
  buffer_load_dword v171, v166, s[8:11], s55 offen sc1
  v_mov_b32 v169, 0
  v_lshlrev_b32 v208, 8, v200
  s_mov_b32 s66, 393216
  s_waitcnt vmcnt(0)
O_loop:
  v_mfma_f32_16x16x32_bf16 v[156:159], v[216:219], v[128:131], 0
  v_mfma_f32_16x16x32_bf16 v[160:163], v[220:223], v[128:131], 0
  v_mfma_f32_16x16x32_bf16 v[156:159], v[224:227], v[132:135], v[156:159]
  v_mfma_f32_16x16x32_bf16 v[160:163], v[228:231], v[132:135], v[160:163]
  v_mfma_f32_16x16x32_bf16 v[156:159], v[232:235], v[136:139], v[156:159]
  v_mfma_f32_16x16x32_bf16 v[160:163], v[236:239], v[136:139], v[160:163]
  v_mfma_f32_16x16x32_bf16 v[156:159], v[240:243], v[140:143], v[156:159]
  v_mfma_f32_16x16x32_bf16 v[160:163], v[244:247], v[140:143], v[160:163]
  v_mfma_f32_16x16x32_bf16 v[156:159], v[248:251], v[144:147], v[156:159]
  v_mfma_f32_16x16x32_bf16 v[160:163], v[252:255], v[144:147], v[160:163]
  s_mul_i32 s64, s59, 36864
  s_lshl_b32 s54, s70, 6
  s_add_u32 s64, s64, s54
  s_add_u32 s71, s59, 2
  s_lshl_b32 s55, s59, 18
  s_lshl_b32 s54, s52, 16
  s_add_u32 s55, s55, s54
  s_add_u32 s63, s55, 46137344
  s_and_b32 s54, s59, 1
  s_lshl_b32 s54, s54, 2
  s_add_u32 s54, s54, s52
  s_lshl_b32 s54, s54, 3
  s_lshl_b64 s[72:73], 0xff, s54
  v_sub_f32 v165, 1.0, v171
  v_cvt_pk_bf16_f32 v165, v165, v165
  v_lshlrev_b32 v165, 16, v165
  v_mul_f32 v156, v171, v156
  v_mul_f32 v157, v171, v157
  v_mul_f32 v158, v171, v158
  v_mul_f32 v159, v171, v159
  v_mul_f32 v160, v171, v160
  v_mul_f32 v161, v171, v161
  v_mul_f32 v162, v171, v162
  v_mul_f32 v163, v171, v163
  s_add_u32 s57, s59, 3
  s_cmp_lt_u32 s59, 2
  s_cselect_b32 s57, s75, s57
  s_cmp_gt_u32 s57, 59
  s_cselect_b32 s57, s76, s57
  s_add_u32 s74, s59, 2
  s_cmp_ge_u32 s59, 60
  s_cselect_b32 s57, s74, s57
  s_min_u32 s74, s57, 63
  s_sub_u32 s77, s71, 6
  s_branch O_pc
O_pl:
  v_cmp_gt_i32 vcc, s77, v169
  s_nop 0
  s_and_b64 vcc, vcc, s[72:73]
  s_cbranch_scc0 O_pn
  s_sleep 24
O_pn:
  s_sleep 1
  s_mov_b64 exec, s[72:73]
  buffer_load_dword v169, v208, s[8:11], s66 offen sc1
  s_mov_b64 exec, -1
  s_add_u32 s65, s65, 1
  s_cmp_ge_u32 s65, 131072
  s_cbranch_scc1 O_ld
  s_waitcnt vmcnt(0)
O_pc:
  v_cmp_gt_u32 vcc, s71, v169
  s_nop 0
  s_and_b64 vcc, vcc, s[72:73]
  s_cbranch_scc1 O_pl
O_ld:
  s_mov_b32 s62, s63
  s_add_u32 s65, s65, 1
  s_cmp_lt_u32 s65, 131072
  s_cselect_b32 s56, -2, -1
  s_sub_u32 s54, s59, 2
  s_cmp_lt_u32 s54, 58
  s_cbranch_scc1 O_full
  buffer_load_dwordx4 v[0:3], v172, s[8:11], s62 offen sc1
  s_add_u32 s62, s62, 4096
  buffer_load_dwordx4 v[4:7], v172, s[8:11], s62 offen sc1
  s_add_u32 s62, s62, 4096
  buffer_load_dwordx4 v[8:11], v172, s[8:11], s62 offen sc1
  s_add_u32 s62, s62, 4096
  buffer_load_dwordx4 v[12:15], v172, s[8:11], s62 offen sc1
  s_add_u32 s62, s62, 4096
  buffer_load_dwordx4 v[16:19], v172, s[8:11], s62 offen sc1
  s_add_u32 s62, s62, 4096
  buffer_load_dwordx4 v[20:23], v172, s[8:11], s62 offen sc1
  s_add_u32 s62, s62, 4096
  buffer_load_dwordx4 v[24:27], v172, s[8:11], s62 offen sc1
  s_add_u32 s62, s62, 4096
  buffer_load_dwordx4 v[28:31], v172, s[8:11], s62 offen sc1
  s_add_u32 s62, s62, 4096
  buffer_load_dwordx4 v[32:35], v172, s[8:11], s62 offen sc1
  s_add_u32 s62, s62, 4096
  buffer_load_dwordx4 v[36:39], v172, s[8:11], s62 offen sc1
  s_add_u32 s62, s62, 4096
  buffer_load_dwordx4 v[40:43], v172, s[8:11], s62 offen sc1
  s_add_u32 s62, s62, 4096
  buffer_load_dwordx4 v[44:47], v172, s[8:11], s62 offen sc1
  s_add_u32 s62, s62, 4096
  buffer_load_dwordx4 v[48:51], v172, s[8:11], s62 offen sc1
  s_add_u32 s62, s62, 4096
  buffer_load_dwordx4 v[52:55], v172, s[8:11], s62 offen sc1
  s_add_u32 s62, s62, 4096
  buffer_load_dwordx4 v[56:59], v172, s[8:11], s62 offen sc1
  s_add_u32 s62, s62, 4096
  buffer_load_dwordx4 v[60:63], v172, s[8:11], s62 offen sc1
  s_add_u32 s62, s62, 4096
  s_mul_i32 s55, s74, 4608
  s_add_u32 s55, s55, 62914560
  buffer_load_dwordx4 v[128:131], v176, s[8:11], s55 offen sc1
  buffer_load_dwordx4 v[132:135], v177, s[8:11], s55 offen sc1
  buffer_load_dwordx4 v[136:139], v178, s[8:11], s55 offen sc1
  buffer_load_dwordx4 v[140:143], v179, s[8:11], s55 offen sc1
  buffer_load_dwordx4 v[144:147], v180, s[8:11], s55 offen sc1
  s_lshl_b32 s55, s74, 7
  s_add_u32 s55, s55, 66060288
  buffer_load_dword v171, v166, s[8:11], s55 offen sc1
  v_mov_b32 v174, v173
  s_waitcnt vmcnt(21)
  v_mfma_f32_16x16x32_bf16 v[148:151], a[0:3], v[0:3], 0
  v_mfma_f32_16x16x32_bf16 v[152:155], a[4:7], v[0:3], 0
  v_mfma_f32_16x16x32_bf16 v[184:187], a[8:11], v[0:3], 0
  v_mfma_f32_16x16x32_bf16 v[188:191], a[12:15], v[0:3], 0
  v_max3_u32 v170, v0, v1, v0
  v_max3_u32 v170, v2, v3, v170
  s_waitcnt vmcnt(20)
  v_mfma_f32_16x16x32_bf16 v[148:151], a[16:19], v[4:7], v[148:151]
  v_mfma_f32_16x16x32_bf16 v[152:155], a[20:23], v[4:7], v[152:155]
  v_mfma_f32_16x16x32_bf16 v[184:187], a[24:27], v[4:7], v[184:187]
  v_mfma_f32_16x16x32_bf16 v[188:191], a[28:31], v[4:7], v[188:191]
  v_max3_u32 v170, v4, v5, v170
  v_max3_u32 v170, v6, v7, v170
  s_waitcnt vmcnt(19)
  v_mfma_f32_16x16x32_bf16 v[148:151], a[32:35], v[8:11], v[148:151]
  v_mfma_f32_16x16x32_bf16 v[152:155], a[36:39], v[8:11], v[152:155]
  v_mfma_f32_16x16x32_bf16 v[184:187], a[40:43], v[8:11], v[184:187]
  v_mfma_f32_16x16x32_bf16 v[188:191], a[44:47], v[8:11], v[188:191]
  v_max3_u32 v170, v8, v9, v170
  v_max3_u32 v170, v10, v11, v170
  s_waitcnt vmcnt(18)
  v_mfma_f32_16x16x32_bf16 v[148:151], a[48:51], v[12:15], v[148:151]
  v_mfma_f32_16x16x32_bf16 v[152:155], a[52:55], v[12:15], v[152:155]
  v_mfma_f32_16x16x32_bf16 v[184:187], a[56:59], v[12:15], v[184:187]
  v_mfma_f32_16x16x32_bf16 v[188:191], a[60:63], v[12:15], v[188:191]
  v_max3_u32 v170, v12, v13, v170
  v_max3_u32 v170, v14, v15, v170
  s_waitcnt vmcnt(17)
  v_mfma_f32_16x16x32_bf16 v[148:151], a[64:67], v[16:19], v[148:151]
  v_mfma_f32_16x16x32_bf16 v[152:155], a[68:71], v[16:19], v[152:155]
  v_mfma_f32_16x16x32_bf16 v[184:187], a[72:75], v[16:19], v[184:187]
  v_mfma_f32_16x16x32_bf16 v[188:191], a[76:79], v[16:19], v[188:191]
  v_max3_u32 v170, v16, v17, v170
  v_max3_u32 v170, v18, v19, v170
  s_waitcnt vmcnt(16)
  v_mfma_f32_16x16x32_bf16 v[148:151], a[80:83], v[20:23], v[148:151]
  v_mfma_f32_16x16x32_bf16 v[152:155], a[84:87], v[20:23], v[152:155]
  v_mfma_f32_16x16x32_bf16 v[184:187], a[88:91], v[20:23], v[184:187]
  v_mfma_f32_16x16x32_bf16 v[188:191], a[92:95], v[20:23], v[188:191]
  v_max3_u32 v170, v20, v21, v170
  v_max3_u32 v170, v22, v23, v170
  s_waitcnt vmcnt(15)
  v_mfma_f32_16x16x32_bf16 v[148:151], a[96:99], v[24:27], v[148:151]
  v_mfma_f32_16x16x32_bf16 v[152:155], a[100:103], v[24:27], v[152:155]
  v_mfma_f32_16x16x32_bf16 v[184:187], a[104:107], v[24:27], v[184:187]
  v_mfma_f32_16x16x32_bf16 v[188:191], a[108:111], v[24:27], v[188:191]
  v_max3_u32 v170, v24, v25, v170
  v_max3_u32 v170, v26, v27, v170
  s_waitcnt vmcnt(14)
  v_mfma_f32_16x16x32_bf16 v[148:151], a[112:115], v[28:31], v[148:151]
  v_mfma_f32_16x16x32_bf16 v[152:155], a[116:119], v[28:31], v[152:155]
  v_mfma_f32_16x16x32_bf16 v[184:187], a[120:123], v[28:31], v[184:187]
  v_mfma_f32_16x16x32_bf16 v[188:191], a[124:127], v[28:31], v[188:191]
  v_max3_u32 v170, v28, v29, v170
  v_max3_u32 v170, v30, v31, v170
  s_waitcnt vmcnt(13)
  v_mfma_f32_16x16x32_bf16 v[148:151], a[128:131], v[32:35], v[148:151]
  v_mfma_f32_16x16x32_bf16 v[152:155], a[132:135], v[32:35], v[152:155]
  v_mfma_f32_16x16x32_bf16 v[184:187], a[136:139], v[32:35], v[184:187]
  v_mfma_f32_16x16x32_bf16 v[188:191], a[140:143], v[32:35], v[188:191]
  v_max3_u32 v170, v32, v33, v170
  v_max3_u32 v170, v34, v35, v170
  s_waitcnt vmcnt(12)
  v_mfma_f32_16x16x32_bf16 v[148:151], a[144:147], v[36:39], v[148:151]
  v_mfma_f32_16x16x32_bf16 v[152:155], a[148:151], v[36:39], v[152:155]
  v_mfma_f32_16x16x32_bf16 v[184:187], a[152:155], v[36:39], v[184:187]
  v_mfma_f32_16x16x32_bf16 v[188:191], a[156:159], v[36:39], v[188:191]
  v_max3_u32 v170, v36, v37, v170
  v_max3_u32 v170, v38, v39, v170
  s_waitcnt vmcnt(11)
  v_mfma_f32_16x16x32_bf16 v[148:151], a[160:163], v[40:43], v[148:151]
  v_mfma_f32_16x16x32_bf16 v[152:155], a[164:167], v[40:43], v[152:155]
  v_mfma_f32_16x16x32_bf16 v[184:187], a[168:171], v[40:43], v[184:187]
  v_mfma_f32_16x16x32_bf16 v[188:191], a[172:175], v[40:43], v[188:191]
  v_max3_u32 v170, v40, v41, v170
  v_max3_u32 v170, v42, v43, v170
  s_waitcnt vmcnt(10)
  v_mfma_f32_16x16x32_bf16 v[148:151], a[176:179], v[44:47], v[148:151]
  v_mfma_f32_16x16x32_bf16 v[152:155], a[180:183], v[44:47], v[152:155]
  v_mfma_f32_16x16x32_bf16 v[184:187], a[184:187], v[44:47], v[184:187]
  v_mfma_f32_16x16x32_bf16 v[188:191], a[188:191], v[44:47], v[188:191]
  v_max3_u32 v170, v44, v45, v170
  v_max3_u32 v170, v46, v47, v170
  s_waitcnt vmcnt(9)
  v_mfma_f32_16x16x32_bf16 v[148:151], a[192:195], v[48:51], v[148:151]
  v_mfma_f32_16x16x32_bf16 v[152:155], a[196:199], v[48:51], v[152:155]
  v_mfma_f32_16x16x32_bf16 v[184:187], a[200:203], v[48:51], v[184:187]
  v_mfma_f32_16x16x32_bf16 v[188:191], a[204:207], v[48:51], v[188:191]
  v_max3_u32 v170, v48, v49, v170
  v_max3_u32 v170, v50, v51, v170
  s_waitcnt vmcnt(8)
  v_mfma_f32_16x16x32_bf16 v[148:151], a[208:211], v[52:55], v[148:151]
  v_mfma_f32_16x16x32_bf16 v[152:155], a[212:215], v[52:55], v[152:155]
  v_mfma_f32_16x16x32_bf16 v[184:187], a[216:219], v[52:55], v[184:187]
  v_mfma_f32_16x16x32_bf16 v[188:191], a[220:223], v[52:55], v[188:191]
  v_max3_u32 v170, v52, v53, v170
  v_max3_u32 v170, v54, v55, v170
  s_waitcnt vmcnt(7)
  v_mfma_f32_16x16x32_bf16 v[148:151], a[224:227], v[56:59], v[148:151]
  v_mfma_f32_16x16x32_bf16 v[152:155], a[228:231], v[56:59], v[152:155]
  v_mfma_f32_16x16x32_bf16 v[184:187], a[232:235], v[56:59], v[184:187]
  v_mfma_f32_16x16x32_bf16 v[188:191], a[236:239], v[56:59], v[188:191]
  v_max3_u32 v170, v56, v57, v170
  v_max3_u32 v170, v58, v59, v170
  s_waitcnt vmcnt(6)
  v_mfma_f32_16x16x32_bf16 v[148:151], a[240:243], v[60:63], v[148:151]
  v_mfma_f32_16x16x32_bf16 v[152:155], a[244:247], v[60:63], v[152:155]
  v_mfma_f32_16x16x32_bf16 v[184:187], a[248:251], v[60:63], v[184:187]
  v_mfma_f32_16x16x32_bf16 v[188:191], a[252:255], v[60:63], v[188:191]
  v_max3_u32 v170, v60, v61, v170
  v_max3_u32 v170, v62, v63, v170
  v_cmp_lt_u32 vcc, s56, v170
  s_cbranch_vccnz O_ld
  v_add_f32_dpp v148, v184, v148 row_ror:8 row_mask:0xf bank_mask:0xf
  v_add_f32_dpp v149, v185, v149 row_ror:8 row_mask:0xf bank_mask:0xf
  v_add_f32_dpp v150, v186, v150 row_ror:8 row_mask:0xf bank_mask:0xf
  v_add_f32_dpp v151, v187, v151 row_ror:8 row_mask:0xf bank_mask:0xf
  v_add_f32_dpp v152, v188, v152 row_ror:8 row_mask:0xf bank_mask:0xf
  v_add_f32_dpp v153, v189, v153 row_ror:8 row_mask:0xf bank_mask:0xf
  v_add_f32_dpp v154, v190, v154 row_ror:8 row_mask:0xf bank_mask:0xf
  v_add_f32_dpp v155, v191, v155 row_ror:8 row_mask:0xf bank_mask:0xf
  s_branch O_mix
O_full:
  buffer_load_dwordx4 v[0:3], v164, s[8:11], s62 offen offset:0 sc1
  buffer_load_dwordx4 v[4:7], v164, s[8:11], s62 offen offset:2048 sc1
  s_add_u32 s62, s62, 4096
  buffer_load_dwordx4 v[8:11], v164, s[8:11], s62 offen offset:0 sc1
  buffer_load_dwordx4 v[12:15], v164, s[8:11], s62 offen offset:2048 sc1
  s_add_u32 s62, s62, 4096
  buffer_load_dwordx4 v[16:19], v164, s[8:11], s62 offen offset:0 sc1
  buffer_load_dwordx4 v[20:23], v164, s[8:11], s62 offen offset:2048 sc1
  s_add_u32 s62, s62, 4096
  buffer_load_dwordx4 v[24:27], v164, s[8:11], s62 offen offset:0 sc1
  buffer_load_dwordx4 v[28:31], v164, s[8:11], s62 offen offset:2048 sc1
  s_add_u32 s62, s62, 4096
  buffer_load_dwordx4 v[32:35], v164, s[8:11], s62 offen offset:0 sc1
  buffer_load_dwordx4 v[36:39], v164, s[8:11], s62 offen offset:2048 sc1
  s_add_u32 s62, s62, 4096
  buffer_load_dwordx4 v[40:43], v164, s[8:11], s62 offen offset:0 sc1
  buffer_load_dwordx4 v[44:47], v164, s[8:11], s62 offen offset:2048 sc1
  s_add_u32 s62, s62, 4096
  buffer_load_dwordx4 v[48:51], v164, s[8:11], s62 offen offset:0 sc1
  buffer_load_dwordx4 v[52:55], v164, s[8:11], s62 offen offset:2048 sc1
  s_add_u32 s62, s62, 4096
  buffer_load_dwordx4 v[56:59], v164, s[8:11], s62 offen offset:0 sc1
  buffer_load_dwordx4 v[60:63], v164, s[8:11], s62 offen offset:2048 sc1
  s_add_u32 s62, s62, 4096
  buffer_load_dwordx4 v[64:67], v164, s[8:11], s62 offen offset:0 sc1
  buffer_load_dwordx4 v[68:71], v164, s[8:11], s62 offen offset:2048 sc1
  s_add_u32 s62, s62, 4096
  buffer_load_dwordx4 v[72:75], v164, s[8:11], s62 offen offset:0 sc1
  buffer_load_dwordx4 v[76:79], v164, s[8:11], s62 offen offset:2048 sc1
  s_add_u32 s62, s62, 4096
  buffer_load_dwordx4 v[80:83], v164, s[8:11], s62 offen offset:0 sc1
  buffer_load_dwordx4 v[84:87], v164, s[8:11], s62 offen offset:2048 sc1
  s_add_u32 s62, s62, 4096
  buffer_load_dwordx4 v[88:91], v164, s[8:11], s62 offen offset:0 sc1
  buffer_load_dwordx4 v[92:95], v164, s[8:11], s62 offen offset:2048 sc1
  s_add_u32 s62, s62, 4096
  buffer_load_dwordx4 v[96:99], v164, s[8:11], s62 offen offset:0 sc1
  buffer_load_dwordx4 v[100:103], v164, s[8:11], s62 offen offset:2048 sc1
  s_add_u32 s62, s62, 4096
  buffer_load_dwordx4 v[104:107], v164, s[8:11], s62 offen offset:0 sc1
  buffer_load_dwordx4 v[108:111], v164, s[8:11], s62 offen offset:2048 sc1
  s_add_u32 s62, s62, 4096
  buffer_load_dwordx4 v[112:115], v164, s[8:11], s62 offen offset:0 sc1
  buffer_load_dwordx4 v[116:119], v164, s[8:11], s62 offen offset:2048 sc1
  s_add_u32 s62, s62, 4096
  buffer_load_dwordx4 v[120:123], v164, s[8:11], s62 offen offset:0 sc1
  buffer_load_dwordx4 v[124:127], v164, s[8:11], s62 offen offset:2048 sc1
  s_add_u32 s62, s62, 4096
  s_mul_i32 s55, s74, 4608
  s_add_u32 s55, s55, 62914560
  buffer_load_dwordx4 v[128:131], v176, s[8:11], s55 offen sc1
  buffer_load_dwordx4 v[132:135], v177, s[8:11], s55 offen sc1
  buffer_load_dwordx4 v[136:139], v178, s[8:11], s55 offen sc1
  buffer_load_dwordx4 v[140:143], v179, s[8:11], s55 offen sc1
  buffer_load_dwordx4 v[144:147], v180, s[8:11], s55 offen sc1
  s_lshl_b32 s55, s74, 7
  s_add_u32 s55, s55, 66060288
  buffer_load_dword v171, v166, s[8:11], s55 offen sc1
  v_mov_b32 v174, v167
  s_waitcnt vmcnt(37)
  v_mfma_f32_16x16x32_bf16 v[148:151], a[0:3], v[0:3], 0
  v_mfma_f32_16x16x32_bf16 v[152:155], a[4:7], v[0:3], 0
  v_max3_u32 v170, v0, v1, v0
  v_max3_u32 v170, v2, v3, v170
  s_waitcnt vmcnt(36)
  v_mfma_f32_16x16x32_bf16 v[148:151], a[8:11], v[4:7], v[148:151]
  v_mfma_f32_16x16x32_bf16 v[152:155], a[12:15], v[4:7], v[152:155]
  v_max3_u32 v170, v4, v5, v170
  v_max3_u32 v170, v6, v7, v170
  s_waitcnt vmcnt(35)
  v_mfma_f32_16x16x32_bf16 v[148:151], a[16:19], v[8:11], v[148:151]
  v_mfma_f32_16x16x32_bf16 v[152:155], a[20:23], v[8:11], v[152:155]
  v_max3_u32 v170, v8, v9, v170
  v_max3_u32 v170, v10, v11, v170
  s_waitcnt vmcnt(34)
  v_mfma_f32_16x16x32_bf16 v[148:151], a[24:27], v[12:15], v[148:151]
  v_mfma_f32_16x16x32_bf16 v[152:155], a[28:31], v[12:15], v[152:155]
  v_max3_u32 v170, v12, v13, v170
  v_max3_u32 v170, v14, v15, v170
  s_waitcnt vmcnt(33)
  v_mfma_f32_16x16x32_bf16 v[148:151], a[32:35], v[16:19], v[148:151]
  v_mfma_f32_16x16x32_bf16 v[152:155], a[36:39], v[16:19], v[152:155]
  v_max3_u32 v170, v16, v17, v170
  v_max3_u32 v170, v18, v19, v170
  s_waitcnt vmcnt(32)
  v_mfma_f32_16x16x32_bf16 v[148:151], a[40:43], v[20:23], v[148:151]
  v_mfma_f32_16x16x32_bf16 v[152:155], a[44:47], v[20:23], v[152:155]
  v_max3_u32 v170, v20, v21, v170
  v_max3_u32 v170, v22, v23, v170
  s_waitcnt vmcnt(31)
  v_mfma_f32_16x16x32_bf16 v[148:151], a[48:51], v[24:27], v[148:151]
  v_mfma_f32_16x16x32_bf16 v[152:155], a[52:55], v[24:27], v[152:155]
  v_max3_u32 v170, v24, v25, v170
  v_max3_u32 v170, v26, v27, v170
  s_waitcnt vmcnt(30)
  v_mfma_f32_16x16x32_bf16 v[148:151], a[56:59], v[28:31], v[148:151]
  v_mfma_f32_16x16x32_bf16 v[152:155], a[60:63], v[28:31], v[152:155]
  v_max3_u32 v170, v28, v29, v170
  v_max3_u32 v170, v30, v31, v170
  s_waitcnt vmcnt(29)
  v_mfma_f32_16x16x32_bf16 v[148:151], a[64:67], v[32:35], v[148:151]
  v_mfma_f32_16x16x32_bf16 v[152:155], a[68:71], v[32:35], v[152:155]
  v_max3_u32 v170, v32, v33, v170
  v_max3_u32 v170, v34, v35, v170
  s_waitcnt vmcnt(28)
  v_mfma_f32_16x16x32_bf16 v[148:151], a[72:75], v[36:39], v[148:151]
  v_mfma_f32_16x16x32_bf16 v[152:155], a[76:79], v[36:39], v[152:155]
  v_max3_u32 v170, v36, v37, v170
  v_max3_u32 v170, v38, v39, v170
  s_waitcnt vmcnt(27)
  v_mfma_f32_16x16x32_bf16 v[148:151], a[80:83], v[40:43], v[148:151]
  v_mfma_f32_16x16x32_bf16 v[152:155], a[84:87], v[40:43], v[152:155]
  v_max3_u32 v170, v40, v41, v170
  v_max3_u32 v170, v42, v43, v170
  s_waitcnt vmcnt(26)
  v_mfma_f32_16x16x32_bf16 v[148:151], a[88:91], v[44:47], v[148:151]
  v_mfma_f32_16x16x32_bf16 v[152:155], a[92:95], v[44:47], v[152:155]
  v_max3_u32 v170, v44, v45, v170
  v_max3_u32 v170, v46, v47, v170
  s_waitcnt vmcnt(25)
  v_mfma_f32_16x16x32_bf16 v[148:151], a[96:99], v[48:51], v[148:151]
  v_mfma_f32_16x16x32_bf16 v[152:155], a[100:103], v[48:51], v[152:155]
  v_max3_u32 v170, v48, v49, v170
  v_max3_u32 v170, v50, v51, v170
  s_waitcnt vmcnt(24)
  v_mfma_f32_16x16x32_bf16 v[148:151], a[104:107], v[52:55], v[148:151]
  v_mfma_f32_16x16x32_bf16 v[152:155], a[108:111], v[52:55], v[152:155]
  v_max3_u32 v170, v52, v53, v170
  v_max3_u32 v170, v54, v55, v170
  s_waitcnt vmcnt(23)
  v_mfma_f32_16x16x32_bf16 v[148:151], a[112:115], v[56:59], v[148:151]
  v_mfma_f32_16x16x32_bf16 v[152:155], a[116:119], v[56:59], v[152:155]
  v_max3_u32 v170, v56, v57, v170
  v_max3_u32 v170, v58, v59, v170
  s_waitcnt vmcnt(22)
  v_mfma_f32_16x16x32_bf16 v[148:151], a[120:123], v[60:63], v[148:151]
  v_mfma_f32_16x16x32_bf16 v[152:155], a[124:127], v[60:63], v[152:155]
  v_max3_u32 v170, v60, v61, v170
  v_max3_u32 v170, v62, v63, v170
  s_waitcnt vmcnt(21)
  v_mfma_f32_16x16x32_bf16 v[148:151], a[128:131], v[64:67], v[148:151]
  v_mfma_f32_16x16x32_bf16 v[152:155], a[132:135], v[64:67], v[152:155]
  v_max3_u32 v170, v64, v65, v170
  v_max3_u32 v170, v66, v67, v170
  s_waitcnt vmcnt(20)
  v_mfma_f32_16x16x32_bf16 v[148:151], a[136:139], v[68:71], v[148:151]
  v_mfma_f32_16x16x32_bf16 v[152:155], a[140:143], v[68:71], v[152:155]
  v_max3_u32 v170, v68, v69, v170
  v_max3_u32 v170, v70, v71, v170
  s_waitcnt vmcnt(19)
  v_mfma_f32_16x16x32_bf16 v[148:151], a[144:147], v[72:75], v[148:151]
  v_mfma_f32_16x16x32_bf16 v[152:155], a[148:151], v[72:75], v[152:155]
  v_max3_u32 v170, v72, v73, v170
  v_max3_u32 v170, v74, v75, v170
  s_waitcnt vmcnt(18)
  v_mfma_f32_16x16x32_bf16 v[148:151], a[152:155], v[76:79], v[148:151]
  v_mfma_f32_16x16x32_bf16 v[152:155], a[156:159], v[76:79], v[152:155]
  v_max3_u32 v170, v76, v77, v170
  v_max3_u32 v170, v78, v79, v170
  s_waitcnt vmcnt(17)
  v_mfma_f32_16x16x32_bf16 v[148:151], a[160:163], v[80:83], v[148:151]
  v_mfma_f32_16x16x32_bf16 v[152:155], a[164:167], v[80:83], v[152:155]
  v_max3_u32 v170, v80, v81, v170
  v_max3_u32 v170, v82, v83, v170
  s_waitcnt vmcnt(16)
  v_mfma_f32_16x16x32_bf16 v[148:151], a[168:171], v[84:87], v[148:151]
  v_mfma_f32_16x16x32_bf16 v[152:155], a[172:175], v[84:87], v[152:155]
  v_max3_u32 v170, v84, v85, v170
  v_max3_u32 v170, v86, v87, v170
  s_waitcnt vmcnt(15)
  v_mfma_f32_16x16x32_bf16 v[148:151], a[176:179], v[88:91], v[148:151]
  v_mfma_f32_16x16x32_bf16 v[152:155], a[180:183], v[88:91], v[152:155]
  v_max3_u32 v170, v88, v89, v170
  v_max3_u32 v170, v90, v91, v170
  s_waitcnt vmcnt(14)
  v_mfma_f32_16x16x32_bf16 v[148:151], a[184:187], v[92:95], v[148:151]
  v_mfma_f32_16x16x32_bf16 v[152:155], a[188:191], v[92:95], v[152:155]
  v_max3_u32 v170, v92, v93, v170
  v_max3_u32 v170, v94, v95, v170
  s_waitcnt vmcnt(13)
  v_mfma_f32_16x16x32_bf16 v[148:151], a[192:195], v[96:99], v[148:151]
  v_mfma_f32_16x16x32_bf16 v[152:155], a[196:199], v[96:99], v[152:155]
  v_max3_u32 v170, v96, v97, v170
  v_max3_u32 v170, v98, v99, v170
  s_waitcnt vmcnt(12)
  v_mfma_f32_16x16x32_bf16 v[148:151], a[200:203], v[100:103], v[148:151]
  v_mfma_f32_16x16x32_bf16 v[152:155], a[204:207], v[100:103], v[152:155]
  v_max3_u32 v170, v100, v101, v170
  v_max3_u32 v170, v102, v103, v170
  s_waitcnt vmcnt(11)
  v_mfma_f32_16x16x32_bf16 v[148:151], a[208:211], v[104:107], v[148:151]
  v_mfma_f32_16x16x32_bf16 v[152:155], a[212:215], v[104:107], v[152:155]
  v_max3_u32 v170, v104, v105, v170
  v_max3_u32 v170, v106, v107, v170
  s_waitcnt vmcnt(10)
  v_mfma_f32_16x16x32_bf16 v[148:151], a[216:219], v[108:111], v[148:151]
  v_mfma_f32_16x16x32_bf16 v[152:155], a[220:223], v[108:111], v[152:155]
  v_max3_u32 v170, v108, v109, v170
  v_max3_u32 v170, v110, v111, v170
  s_waitcnt vmcnt(9)
  v_mfma_f32_16x16x32_bf16 v[148:151], a[224:227], v[112:115], v[148:151]
  v_mfma_f32_16x16x32_bf16 v[152:155], a[228:231], v[112:115], v[152:155]
  v_max3_u32 v170, v112, v113, v170
  v_max3_u32 v170, v114, v115, v170
  s_waitcnt vmcnt(8)
  v_mfma_f32_16x16x32_bf16 v[148:151], a[232:235], v[116:119], v[148:151]
  v_mfma_f32_16x16x32_bf16 v[152:155], a[236:239], v[116:119], v[152:155]
  v_max3_u32 v170, v116, v117, v170
  v_max3_u32 v170, v118, v119, v170
  s_waitcnt vmcnt(7)
  v_mfma_f32_16x16x32_bf16 v[148:151], a[240:243], v[120:123], v[148:151]
  v_mfma_f32_16x16x32_bf16 v[152:155], a[244:247], v[120:123], v[152:155]
  v_max3_u32 v170, v120, v121, v170
  v_max3_u32 v170, v122, v123, v170
  s_waitcnt vmcnt(6)
  v_mfma_f32_16x16x32_bf16 v[148:151], a[248:251], v[124:127], v[148:151]
  v_mfma_f32_16x16x32_bf16 v[152:155], a[252:255], v[124:127], v[152:155]
  v_max3_u32 v170, v124, v125, v170
  v_max3_u32 v170, v126, v127, v170
  v_cmp_lt_u32 vcc, s56, v170
  s_cbranch_vccnz O_ld
O_mix:
  v_fmac_f32 v156, v165, v148
  v_fmac_f32 v157, v165, v149
  v_fmac_f32 v158, v165, v150
  v_fmac_f32 v159, v165, v151
  v_fmac_f32 v160, v165, v152
  v_fmac_f32 v161, v165, v153
  v_fmac_f32 v162, v165, v154
  v_fmac_f32 v163, v165, v155
  ds_write_b128 v168, v[156:159]
  ds_write_b128 v168, v[160:163] offset:1024
  v_xor_b32 v168, 0x2000, v168
  s_mov_b32 s59, s57
  s_waitcnt lgkmcnt(0)
  s_barrier
  s_cmp_eq_u32 s52, 0
  s_cbranch_scc0 O_next
  v_xor_b32 v211, 0x2000, v168
  ds_read_b128 v[0:3], v211 offset:2048
  ds_read_b128 v[4:7], v211 offset:3072
  ds_read_b128 v[8:11], v211 offset:4096
  ds_read_b128 v[12:15], v211 offset:5120
  ds_read_b128 v[16:19], v211 offset:6144
  ds_read_b128 v[20:23], v211 offset:7168
  s_waitcnt lgkmcnt(5)
  v_add_f32 v156, v156, v0
  v_add_f32 v157, v157, v1
  v_add_f32 v158, v158, v2
  v_add_f32 v159, v159, v3
  s_waitcnt lgkmcnt(4)
  v_add_f32 v160, v160, v4
  v_add_f32 v161, v161, v5
  v_add_f32 v162, v162, v6
  v_add_f32 v163, v163, v7
  s_waitcnt lgkmcnt(3)
  v_add_f32 v156, v156, v8
  v_add_f32 v157, v157, v9
  v_add_f32 v158, v158, v10
  v_add_f32 v159, v159, v11
  s_waitcnt lgkmcnt(2)
  v_add_f32 v160, v160, v12
  v_add_f32 v161, v161, v13
  v_add_f32 v162, v162, v14
  v_add_f32 v163, v163, v15
  s_waitcnt lgkmcnt(1)
  v_add_f32 v156, v156, v16
  v_add_f32 v157, v157, v17
  v_add_f32 v158, v158, v18
  v_add_f32 v159, v159, v19
  s_waitcnt lgkmcnt(0)
  v_add_f32 v160, v160, v20
  v_add_f32 v161, v161, v21
  v_add_f32 v162, v162, v22
  v_add_f32 v163, v163, v23
  v_cvt_pk_bf16_f32 v148, v156, v157
  v_cvt_pk_bf16_f32 v149, v158, v159
  v_cvt_pk_bf16_f32 v150, v160, v161
  v_cvt_pk_bf16_f32 v151, v162, v163
  buffer_store_dwordx4 v[148:151], v174, s[48:51], s64 offen sc1
  s_waitcnt vmcnt(1)
  s_branch O_nx2
O_next:
  s_waitcnt vmcnt(0)
O_nx2:
  s_cmp_lt_u32 s59, 64
  s_cbranch_scc1 O_loop
  s_branch L_exit
W_h:
  s_lshr_b32 s58, s53, 1
  s_and_b32 s59, s53, 1
  s_mul_i32 s60, s59, 36864
  s_add_u32 m0, s67, 0
  s_nop 0
  buffer_load_dwordx4 v202, s[4:7], s60 offen offset:0 lds
  s_add_u32 m0, s67, 896
  s_nop 0
  buffer_load_dwordx4 v202, s[4:7], s60 offen offset:128 lds
  s_add_u32 m0, s67, 1792
  s_nop 0
  buffer_load_dwordx4 v202, s[4:7], s60 offen offset:256 lds
  s_add_u32 m0, s67, 2688
  s_nop 0
  buffer_load_dwordx4 v202, s[4:7], s60 offen offset:384 lds
  s_add_u32 m0, s67, 3584
  s_nop 0
  buffer_load_dwordx4 v202, s[4:7], s60 offen offset:512 lds
  s_add_u32 m0, s67, 4480
  s_nop 0
  buffer_load_dwordx4 v202, s[4:7], s60 offen offset:640 lds
  s_add_u32 m0, s67, 5376
  s_nop 0
  buffer_load_dwordx4 v202, s[4:7], s60 offen offset:768 lds
  s_add_u32 m0, s67, 6272
  s_nop 0
  buffer_load_dwordx4 v202, s[4:7], s60 offen offset:896 lds
  s_add_u32 m0, s67, 7168
  s_nop 0
  buffer_load_dwordx4 v202, s[4:7], s60 offen offset:1024 lds
  v_lshrrev_b32 v211, 4, v200
  v_lshlrev_b32 v212, 2, v211
  v_and_b32 v213, 15, v200
  v_xor_b32 v212, v212, v213
  v_lshlrev_b32 v212, 4, v212
  v_lshl_add_u32 v207, v211, 13, v212
  s_lshl_b32 s62, s58, 8
  s_lshl_b32 s54, s52, 15
  s_add_u32 s62, s62, s54
  s_lshl_b32 s61, s52, 10
  s_add_u32 s61, s61, 36864
  s_add_u32 m0, s61, 0
  s_add_u32 s54, s62, 0
  buffer_load_dwordx4 v207, s[16:19], s54 offen lds
  s_add_u32 m0, s61, 4096
  s_add_u32 s54, s62, 131072
  buffer_load_dwordx4 v207, s[16:19], s54 offen lds
  s_add_u32 m0, s61, 8192
  s_add_u32 s54, s62, 262144
  buffer_load_dwordx4 v207, s[16:19], s54 offen lds
  s_add_u32 m0, s61, 12288
  s_add_u32 s54, s62, 393216
  buffer_load_dwordx4 v207, s[16:19], s54 offen lds
  s_add_u32 m0, s61, 16384
  s_add_u32 s54, s62, 524288
  buffer_load_dwordx4 v207, s[16:19], s54 offen lds
  s_add_u32 m0, s61, 20480
  s_add_u32 s54, s62, 655360
  buffer_load_dwordx4 v207, s[16:19], s54 offen lds
  s_add_u32 m0, s61, 24576
  s_add_u32 s54, s62, 786432
  buffer_load_dwordx4 v207, s[16:19], s54 offen lds
  s_add_u32 m0, s61, 28672
  s_add_u32 s54, s62, 917504
  buffer_load_dwordx4 v207, s[16:19], s54 offen lds
  s_add_u32 m0, s61, 32768
  s_add_u32 s54, s62, 1048576
  buffer_load_dwordx4 v207, s[16:19], s54 offen lds
  s_add_u32 m0, s61, 36864
  s_add_u32 s54, s62, 1179648
  buffer_load_dwordx4 v207, s[16:19], s54 offen lds
  s_add_u32 m0, s61, 40960
  s_add_u32 s54, s62, 1310720
  buffer_load_dwordx4 v207, s[16:19], s54 offen lds
  s_add_u32 m0, s61, 45056
  s_add_u32 s54, s62, 1441792
  buffer_load_dwordx4 v207, s[16:19], s54 offen lds
  s_add_u32 m0, s61, 49152
  s_add_u32 s54, s62, 1572864
  buffer_load_dwordx4 v207, s[16:19], s54 offen lds
  s_add_u32 m0, s61, 53248
  s_add_u32 s54, s62, 1703936
  buffer_load_dwordx4 v207, s[16:19], s54 offen lds
  s_add_u32 m0, s61, 57344
  s_add_u32 s54, s62, 1835008
  buffer_load_dwordx4 v207, s[16:19], s54 offen lds
  s_add_u32 m0, s61, 61440
  s_add_u32 s54, s62, 1966080
  buffer_load_dwordx4 v207, s[16:19], s54 offen lds
  s_add_u32 m0, s61, 65536
  s_add_u32 s54, s62, 2097152
  buffer_load_dwordx4 v207, s[16:19], s54 offen lds
  s_add_u32 m0, s61, 69632
  s_add_u32 s54, s62, 2228224
  buffer_load_dwordx4 v207, s[16:19], s54 offen lds
  s_add_u32 m0, s61, 73728
  s_add_u32 s54, s62, 2359296
  buffer_load_dwordx4 v207, s[16:19], s54 offen lds
  s_add_u32 m0, s61, 77824
  s_add_u32 s54, s62, 2490368
  buffer_load_dwordx4 v207, s[16:19], s54 offen lds
  s_add_u32 m0, s61, 81920
  s_add_u32 s54, s62, 2621440
  buffer_load_dwordx4 v207, s[16:19], s54 offen lds
  s_add_u32 m0, s61, 86016
  s_add_u32 s54, s62, 2752512
  buffer_load_dwordx4 v207, s[16:19], s54 offen lds
  s_add_u32 m0, s61, 90112
  s_add_u32 s54, s62, 2883584
  buffer_load_dwordx4 v207, s[16:19], s54 offen lds
  s_add_u32 m0, s61, 94208
  s_add_u32 s54, s62, 3014656
  buffer_load_dwordx4 v207, s[16:19], s54 offen lds
  s_waitcnt vmcnt(20) lgkmcnt(0)
  s_barrier
  s_add_u32 m0, s61, 98304
  s_add_u32 s54, s62, 3145728
  buffer_load_dwordx4 v207, s[16:19], s54 offen lds
  s_add_u32 m0, s61, 102400
  s_add_u32 s54, s62, 3276800
  buffer_load_dwordx4 v207, s[16:19], s54 offen lds
  s_add_u32 m0, s61, 106496
  s_add_u32 s54, s62, 3407872
  buffer_load_dwordx4 v207, s[16:19], s54 offen lds
  s_add_u32 m0, s61, 110592
  s_add_u32 s54, s62, 3538944
  buffer_load_dwordx4 v207, s[16:19], s54 offen lds
  v_add_u32 v215, 36864, v209
  ds_read_b64_tr_b16 a[0:1], v215 offset:0
  ds_read_b64_tr_b16 a[2:3], v215 offset:1024
  ds_read_b64_tr_b16 a[4:5], v215 offset:4096
  ds_read_b64_tr_b16 a[6:7], v215 offset:5120
  ds_read_b64_tr_b16 a[8:9], v215 offset:8192
  ds_read_b64_tr_b16 a[10:11], v215 offset:9216
  ds_read_b64_tr_b16 a[12:13], v215 offset:12288
  ds_read_b64_tr_b16 a[14:15], v215 offset:13312
  s_waitcnt vmcnt(20) lgkmcnt(0)
  s_barrier
  s_add_u32 m0, s61, 0
  s_add_u32 s54, s62, 3670016
  buffer_load_dwordx4 v207, s[16:19], s54 offen lds
  s_add_u32 m0, s61, 4096
  s_add_u32 s54, s62, 3801088
  buffer_load_dwordx4 v207, s[16:19], s54 offen lds
  s_add_u32 m0, s61, 8192
  s_add_u32 s54, s62, 3932160
  buffer_load_dwordx4 v207, s[16:19], s54 offen lds
  s_add_u32 m0, s61, 12288
  s_add_u32 s54, s62, 4063232
  buffer_load_dwordx4 v207, s[16:19], s54 offen lds
  v_add_u32 v215, 53248, v209
  ds_read_b64_tr_b16 a[16:17], v215 offset:0
  ds_read_b64_tr_b16 a[18:19], v215 offset:1024
  ds_read_b64_tr_b16 a[20:21], v215 offset:4096
  ds_read_b64_tr_b16 a[22:23], v215 offset:5120
  ds_read_b64_tr_b16 a[24:25], v215 offset:8192
  ds_read_b64_tr_b16 a[26:27], v215 offset:9216
  ds_read_b64_tr_b16 a[28:29], v215 offset:12288
  ds_read_b64_tr_b16 a[30:31], v215 offset:13312
  s_waitcnt vmcnt(20) lgkmcnt(0)
  s_barrier
  s_add_u32 m0, s61, 16384
  s_add_u32 s54, s62, 4194304
  buffer_load_dwordx4 v207, s[16:19], s54 offen lds
  s_add_u32 m0, s61, 20480
  s_add_u32 s54, s62, 4325376
  buffer_load_dwordx4 v207, s[16:19], s54 offen lds
  s_add_u32 m0, s61, 24576
  s_add_u32 s54, s62, 4456448
  buffer_load_dwordx4 v207, s[16:19], s54 offen lds
  s_add_u32 m0, s61, 28672
  s_add_u32 s54, s62, 4587520
  buffer_load_dwordx4 v207, s[16:19], s54 offen lds
  v_add_u32 v215, 69632, v209
  ds_read_b64_tr_b16 a[32:33], v215 offset:0
  ds_read_b64_tr_b16 a[34:35], v215 offset:1024
  ds_read_b64_tr_b16 a[36:37], v215 offset:4096
  ds_read_b64_tr_b16 a[38:39], v215 offset:5120
  ds_read_b64_tr_b16 a[40:41], v215 offset:8192
  ds_read_b64_tr_b16 a[42:43], v215 offset:9216
  ds_read_b64_tr_b16 a[44:45], v215 offset:12288
  ds_read_b64_tr_b16 a[46:47], v215 offset:13312
  s_waitcnt vmcnt(20) lgkmcnt(0)
  s_barrier
  v_add_u32 v215, 86016, v209
  ds_read_b64_tr_b16 a[48:49], v215 offset:0
  ds_read_b64_tr_b16 a[50:51], v215 offset:1024
  ds_read_b64_tr_b16 a[52:53], v215 offset:4096
  ds_read_b64_tr_b16 a[54:55], v215 offset:5120
  ds_read_b64_tr_b16 a[56:57], v215 offset:8192
  ds_read_b64_tr_b16 a[58:59], v215 offset:9216
  ds_read_b64_tr_b16 a[60:61], v215 offset:12288
  ds_read_b64_tr_b16 a[62:63], v215 offset:13312
  s_waitcnt vmcnt(16) lgkmcnt(0)
  s_barrier
  v_add_u32 v215, 102400, v209
  ds_read_b64_tr_b16 a[64:65], v215 offset:0
  ds_read_b64_tr_b16 a[66:67], v215 offset:1024
  ds_read_b64_tr_b16 a[68:69], v215 offset:4096
  ds_read_b64_tr_b16 a[70:71], v215 offset:5120
  ds_read_b64_tr_b16 a[72:73], v215 offset:8192
  ds_read_b64_tr_b16 a[74:75], v215 offset:9216
  ds_read_b64_tr_b16 a[76:77], v215 offset:12288
  ds_read_b64_tr_b16 a[78:79], v215 offset:13312
  s_waitcnt vmcnt(12) lgkmcnt(0)
  s_barrier
  v_add_u32 v215, 118784, v209
  ds_read_b64_tr_b16 a[80:81], v215 offset:0
  ds_read_b64_tr_b16 a[82:83], v215 offset:1024
  ds_read_b64_tr_b16 a[84:85], v215 offset:4096
  ds_read_b64_tr_b16 a[86:87], v215 offset:5120
  ds_read_b64_tr_b16 a[88:89], v215 offset:8192
  ds_read_b64_tr_b16 a[90:91], v215 offset:9216
  ds_read_b64_tr_b16 a[92:93], v215 offset:12288
  ds_read_b64_tr_b16 a[94:95], v215 offset:13312
  s_waitcnt vmcnt(8) lgkmcnt(0)
  s_barrier
  v_add_u32 v215, 135168, v209
  ds_read_b64_tr_b16 a[96:97], v215 offset:0
  ds_read_b64_tr_b16 a[98:99], v215 offset:1024
  ds_read_b64_tr_b16 a[100:101], v215 offset:4096
  ds_read_b64_tr_b16 a[102:103], v215 offset:5120
  ds_read_b64_tr_b16 a[104:105], v215 offset:8192
  ds_read_b64_tr_b16 a[106:107], v215 offset:9216
  ds_read_b64_tr_b16 a[108:109], v215 offset:12288
  ds_read_b64_tr_b16 a[110:111], v215 offset:13312
  s_waitcnt vmcnt(4) lgkmcnt(0)
  s_barrier
  v_add_u32 v215, 36864, v209
  ds_read_b64_tr_b16 a[112:113], v215 offset:0
  ds_read_b64_tr_b16 a[114:115], v215 offset:1024
  ds_read_b64_tr_b16 a[116:117], v215 offset:4096
  ds_read_b64_tr_b16 a[118:119], v215 offset:5120
  ds_read_b64_tr_b16 a[120:121], v215 offset:8192
  ds_read_b64_tr_b16 a[122:123], v215 offset:9216
  ds_read_b64_tr_b16 a[124:125], v215 offset:12288
  ds_read_b64_tr_b16 a[126:127], v215 offset:13312
  s_waitcnt vmcnt(0) lgkmcnt(0)
  s_barrier
  v_add_u32 v215, 53248, v209
  ds_read_b64_tr_b16 a[128:129], v215 offset:0
  ds_read_b64_tr_b16 a[130:131], v215 offset:1024
  ds_read_b64_tr_b16 a[132:133], v215 offset:4096
  ds_read_b64_tr_b16 a[134:135], v215 offset:5120
  ds_read_b64_tr_b16 a[136:137], v215 offset:8192
  ds_read_b64_tr_b16 a[138:139], v215 offset:9216
  ds_read_b64_tr_b16 a[140:141], v215 offset:12288
  ds_read_b64_tr_b16 a[142:143], v215 offset:13312
  s_waitcnt lgkmcnt(0)
  s_barrier
  v_and_b32 v211, 31, v200
  v_lshrrev_b32 v212, 5, v200
  v_lshlrev_b32 v213, 2, v212
  v_sub_u32 v211, v211, v213
  v_mov_b32 v214, 0xf149f2ca
  v_cmp_gt_i32 vcc, 0, v211
  s_nop 1
  v_cndmask_b32 v48, 0, v214, vcc
  v_cmp_gt_i32 vcc, 1, v211
  s_nop 1
  v_cndmask_b32 v49, 0, v214, vcc
  v_cmp_gt_i32 vcc, 2, v211
  s_nop 1
  v_cndmask_b32 v50, 0, v214, vcc
  v_cmp_gt_i32 vcc, 3, v211
  s_nop 1
  v_cndmask_b32 v51, 0, v214, vcc
  v_cmp_gt_i32 vcc, 8, v211
  s_nop 1
  v_cndmask_b32 v52, 0, v214, vcc
  v_cmp_gt_i32 vcc, 9, v211
  s_nop 1
  v_cndmask_b32 v53, 0, v214, vcc
  v_cmp_gt_i32 vcc, 10, v211
  s_nop 1
  v_cndmask_b32 v54, 0, v214, vcc
  v_cmp_gt_i32 vcc, 11, v211
  s_nop 1
  v_cndmask_b32 v55, 0, v214, vcc
  v_cmp_gt_i32 vcc, 16, v211
  s_nop 1
  v_cndmask_b32 v56, 0, v214, vcc
  v_cmp_gt_i32 vcc, 17, v211
  s_nop 1
  v_cndmask_b32 v57, 0, v214, vcc
  v_cmp_gt_i32 vcc, 18, v211
  s_nop 1
  v_cndmask_b32 v58, 0, v214, vcc
  v_cmp_gt_i32 vcc, 19, v211
  s_nop 1
  v_cndmask_b32 v59, 0, v214, vcc
  v_cmp_gt_i32 vcc, 24, v211
  s_nop 1
  v_cndmask_b32 v60, 0, v214, vcc
  v_cmp_gt_i32 vcc, 25, v211
  s_nop 1
  v_cndmask_b32 v61, 0, v214, vcc
  v_cmp_gt_i32 vcc, 26, v211
  s_nop 1
  v_cndmask_b32 v62, 0, v214, vcc
  v_cmp_gt_i32 vcc, 27, v211
  s_nop 1
  v_cndmask_b32 v63, 0, v214, vcc
  v_and_b32 v218, 0xff, v216
  v_add_u32 v218, 81920, v218
  v_and_b32 v211, 15, v200
  v_lshl_add_u32 v211, v212, 5, v211
  v_lshlrev_b32 v219, 3, v211
  v_bfe_u32 v211, v200, 4, 1
  v_lshl_add_u32 v219, v211, 2, v219
  s_lshl_b32 s54, s52, 9
  s_add_u32 s54, s54, 83968
  v_add_u32 v219, s54, v219
  v_lshl_add_u32 v221, v200, 3, s54
  s_lshr_b32 s54, s52, 1
  s_lshl_b32 s54, s54, 10
  s_and_b32 s55, s52, 1
  s_lshl_b32 s55, s55, 3
  s_add_u32 s54, s54, s55
  s_add_u32 s54, s54, 81920
  v_add_u32 v220, s54, v201
  s_lshl_b32 s54, s52, 11
  s_add_u32 s54, s54, 73728
  v_add_u32 v215, s54, v201
  v_add_u32 v208, 73728, v201
  s_mov_b32 s68, 1040356334
  s_cmp_eq_u32 s52, 0
  s_cselect_b32 s71, s71, 268435456
  s_lshl_b32 s56, s58, 2
  s_add_u32 s56, s56, 128
  v_mov_b32 v176, -1
  v_mov_b32 v177, -1
  v_mov_b32 v178, -1
  v_mov_b32 v179, -1
  s_cmp_eq_u32 s52, 0
  s_cbranch_scc0 AT_p1_d
  s_mov_b32 exec_hi, 0
  s_mov_b32 exec_lo, 1
AT_p1:
  buffer_load_dword v211, v201, s[12:15], s56 offen sc1
  s_add_u32 s65, s65, 1
  s_waitcnt vmcnt(0)
  v_cmp_gt_u32 vcc, 0x700, v211
  s_cbranch_vccz AT_p1_x
  s_sleep 8
  s_cmp_lt_u32 s65, 131072
  s_cbranch_scc1 AT_p1
AT_p1_x:
  s_mov_b64 exec, -1
AT_p1_d:
  s_barrier
  s_mov_b32 s74, s59
  s_mul_i32 s66, s59, 655360
  s_lshl_b32 s55, s58, 14
  s_add_u32 s55, s55, s66
  s_add_u32 s55, s55, 1048576
  s_lshl_b32 s73, s58, 2
  s_add_u32 s73, s73, s52
  s_lshl_b32 s72, s59, 7
  s_add_u32 s72, s72, s73
  s_lshl_b32 s72, s72, 11
  s_add_u32 s72, s72, 46137344
  s_lshl_b32 s73, s73, 10
  s_add_u32 s73, s73, s66
  s_add_u32 s73, s73, 1572864
  s_add_u32 s59, s59, 2
  buffer_load_dwordx4 v[128:131], v216, s[8:11], s55 offen offset:0 sc1
  buffer_load_dwordx4 v[132:135], v216, s[8:11], s55 offen offset:256 sc1
  buffer_load_dwordx4 v[136:139], v216, s[8:11], s55 offen offset:512 sc1
  buffer_load_dwordx4 v[140:143], v216, s[8:11], s55 offen offset:768 sc1
  buffer_load_dwordx4 v[144:147], v216, s[8:11], s55 offen offset:1024 sc1
  buffer_load_dwordx4 v[148:151], v216, s[8:11], s55 offen offset:1280 sc1
  buffer_load_dwordx4 v[152:155], v216, s[8:11], s55 offen offset:1536 sc1
  buffer_load_dwordx4 v[156:159], v216, s[8:11], s55 offen offset:1792 sc1
  buffer_load_dwordx4 v[160:163], v217, s[8:11], s55 offen offset:0 sc1
  buffer_load_dwordx4 v[164:167], v217, s[8:11], s55 offen offset:256 sc1
  s_add_u32 s60, s60, 73728
  ds_read_b128 v[32:35], v203 offset:0
  ds_read_b128 v[36:39], v204 offset:0
  ds_read_b128 v[40:43], v205 offset:0
  s_waitcnt lgkmcnt(2)
  v_mfma_f32_32x32x16_bf16 v[240:255], a[0:3], v[32:35], 0
  ds_read_b128 v[44:47], v206 offset:0
  s_add_u32 m0, s67, 36864
  s_nop 0
  buffer_load_dwordx4 v202, s[4:7], s60 offen offset:0 lds
  s_waitcnt lgkmcnt(2)
  v_mfma_f32_32x32x16_bf16 v[240:255], a[4:7], v[36:39], v[240:255]
  ds_read_b128 v[32:35], v203 offset:1024
  s_waitcnt lgkmcnt(2)
  v_mfma_f32_32x32x16_bf16 v[240:255], a[8:11], v[40:43], v[240:255]
  ds_read_b128 v[36:39], v204 offset:1024
  s_add_u32 m0, s67, 37760
  s_nop 0
  buffer_load_dwordx4 v202, s[4:7], s60 offen offset:128 lds
  s_waitcnt lgkmcnt(2)
  v_mfma_f32_32x32x16_bf16 v[240:255], a[12:15], v[44:47], v[240:255]
  ds_read_b128 v[40:43], v205 offset:1024
  s_waitcnt lgkmcnt(2)
  v_mfma_f32_32x32x16_bf16 v[240:255], a[16:19], v[32:35], v[240:255]
  ds_read_b128 v[44:47], v206 offset:1024
  s_add_u32 m0, s67, 38656
  s_nop 0
  buffer_load_dwordx4 v202, s[4:7], s60 offen offset:256 lds
  s_waitcnt lgkmcnt(2)
  v_mfma_f32_32x32x16_bf16 v[240:255], a[20:23], v[36:39], v[240:255]
  ds_read_b128 v[32:35], v203 offset:2048
  s_waitcnt lgkmcnt(2)
  v_mfma_f32_32x32x16_bf16 v[240:255], a[24:27], v[40:43], v[240:255]
  ds_read_b128 v[36:39], v204 offset:2048
  s_add_u32 m0, s67, 39552
  s_nop 0
  buffer_load_dwordx4 v202, s[4:7], s60 offen offset:384 lds
  s_waitcnt lgkmcnt(2)
  v_mfma_f32_32x32x16_bf16 v[240:255], a[28:31], v[44:47], v[240:255]
  ds_read_b128 v[40:43], v205 offset:2048
  s_waitcnt lgkmcnt(2)
  v_mfma_f32_32x32x16_bf16 v[240:255], a[32:35], v[32:35], v[240:255]
  ds_read_b128 v[44:47], v206 offset:2048
  s_add_u32 m0, s67, 40448
  s_nop 0
  buffer_load_dwordx4 v202, s[4:7], s60 offen offset:512 lds
  s_waitcnt lgkmcnt(2)
  v_mfma_f32_32x32x16_bf16 v[240:255], a[36:39], v[36:39], v[240:255]
  ds_read_b128 v[32:35], v203 offset:3072
  s_waitcnt lgkmcnt(2)
  v_mfma_f32_32x32x16_bf16 v[240:255], a[40:43], v[40:43], v[240:255]
  ds_read_b128 v[36:39], v204 offset:3072
  s_add_u32 m0, s67, 41344
  s_nop 0
  buffer_load_dwordx4 v202, s[4:7], s60 offen offset:640 lds
  s_waitcnt lgkmcnt(2)
  v_mfma_f32_32x32x16_bf16 v[240:255], a[44:47], v[44:47], v[240:255]
  ds_read_b128 v[40:43], v205 offset:3072
  s_waitcnt lgkmcnt(2)
  v_mfma_f32_32x32x16_bf16 v[240:255], a[48:51], v[32:35], v[240:255]
  ds_read_b128 v[44:47], v206 offset:3072
  s_add_u32 m0, s67, 42240
  s_nop 0
  buffer_load_dwordx4 v202, s[4:7], s60 offen offset:768 lds
  s_waitcnt lgkmcnt(2)
  v_mfma_f32_32x32x16_bf16 v[240:255], a[52:55], v[36:39], v[240:255]
  ds_read_b128 v[32:35], v203 offset:4096
  s_waitcnt lgkmcnt(2)
  v_mfma_f32_32x32x16_bf16 v[240:255], a[56:59], v[40:43], v[240:255]
  ds_read_b128 v[36:39], v204 offset:4096
  s_add_u32 m0, s67, 43136
  s_nop 0
  buffer_load_dwordx4 v202, s[4:7], s60 offen offset:896 lds
  s_waitcnt lgkmcnt(2)
  v_mfma_f32_32x32x16_bf16 v[240:255], a[60:63], v[44:47], v[240:255]
  ds_read_b128 v[40:43], v205 offset:4096
  s_waitcnt lgkmcnt(2)
  v_mfma_f32_32x32x16_bf16 v[240:255], a[64:67], v[32:35], v[240:255]
  ds_read_b128 v[44:47], v206 offset:4096
  s_add_u32 m0, s67, 44032
  s_nop 0
  buffer_load_dwordx4 v202, s[4:7], s60 offen offset:1024 lds
  s_waitcnt lgkmcnt(2)
  v_mfma_f32_32x32x16_bf16 v[240:255], a[68:71], v[36:39], v[240:255]
  ds_read_b128 v[32:35], v203 offset:5120
  s_waitcnt lgkmcnt(2)
  v_mfma_f32_32x32x16_bf16 v[240:255], a[72:75], v[40:43], v[240:255]
  ds_read_b128 v[36:39], v204 offset:5120
  buffer_store_dwordx4 v[176:179], v201, s[8:11], s72 offen offset:0 sc1
  s_waitcnt lgkmcnt(2)
  v_mfma_f32_32x32x16_bf16 v[240:255], a[76:79], v[44:47], v[240:255]
  ds_read_b128 v[40:43], v205 offset:5120
  s_waitcnt lgkmcnt(2)
  v_mfma_f32_32x32x16_bf16 v[240:255], a[80:83], v[32:35], v[240:255]
  ds_read_b128 v[44:47], v206 offset:5120
  buffer_store_dwordx4 v[176:179], v201, s[8:11], s72 offen offset:1024 sc1
  s_waitcnt lgkmcnt(2)
  v_mfma_f32_32x32x16_bf16 v[240:255], a[84:87], v[36:39], v[240:255]
  ds_read_b128 v[32:35], v203 offset:6144
  s_waitcnt lgkmcnt(2)
  v_mfma_f32_32x32x16_bf16 v[240:255], a[88:91], v[40:43], v[240:255]
  ds_read_b128 v[36:39], v204 offset:6144
  s_waitcnt lgkmcnt(2)
  v_mfma_f32_32x32x16_bf16 v[240:255], a[92:95], v[44:47], v[240:255]
  ds_read_b128 v[40:43], v205 offset:6144
  s_waitcnt lgkmcnt(2)
  v_mfma_f32_32x32x16_bf16 v[240:255], a[96:99], v[32:35], v[240:255]
  ds_read_b128 v[44:47], v206 offset:6144
  s_waitcnt lgkmcnt(2)
  v_mfma_f32_32x32x16_bf16 v[240:255], a[100:103], v[36:39], v[240:255]
  ds_read_b128 v[32:35], v203 offset:7168
  s_waitcnt lgkmcnt(2)
  v_mfma_f32_32x32x16_bf16 v[240:255], a[104:107], v[40:43], v[240:255]
  ds_read_b128 v[36:39], v204 offset:7168
  s_waitcnt lgkmcnt(2)
  v_mfma_f32_32x32x16_bf16 v[240:255], a[108:111], v[44:47], v[240:255]
  ds_read_b128 v[40:43], v205 offset:7168
  s_waitcnt lgkmcnt(2)
  v_mfma_f32_32x32x16_bf16 v[240:255], a[112:115], v[32:35], v[240:255]
  ds_read_b128 v[44:47], v206 offset:7168
  s_waitcnt lgkmcnt(2)
  v_mfma_f32_32x32x16_bf16 v[240:255], a[116:119], v[36:39], v[240:255]
  ds_read_b128 v[32:35], v203 offset:8192
  s_waitcnt lgkmcnt(2)
  v_mfma_f32_32x32x16_bf16 v[240:255], a[120:123], v[40:43], v[240:255]
  ds_read_b128 v[36:39], v204 offset:8192
  s_waitcnt lgkmcnt(2)
  v_mfma_f32_32x32x16_bf16 v[240:255], a[124:127], v[44:47], v[240:255]
  ds_read_b128 v[40:43], v205 offset:8192
  s_waitcnt lgkmcnt(2)
  v_mfma_f32_32x32x16_bf16 v[240:255], a[128:131], v[32:35], v[240:255]
  ds_read_b128 v[44:47], v206 offset:8192
  s_waitcnt lgkmcnt(2)
  v_mfma_f32_32x32x16_bf16 v[240:255], a[132:135], v[36:39], v[240:255]
  s_waitcnt lgkmcnt(1)
  v_mfma_f32_32x32x16_bf16 v[240:255], a[136:139], v[40:43], v[240:255]
  s_waitcnt lgkmcnt(0)
  v_mfma_f32_32x32x16_bf16 v[240:255], a[140:143], v[44:47], v[240:255]
  s_nop 11
  v_cvt_pk_bf16_f32 v16, v240, v244
  v_cvt_pk_bf16_f32 v17, v241, v245
  v_cvt_pk_bf16_f32 v18, v242, v246
  v_cvt_pk_bf16_f32 v19, v243, v247
  ds_write_b128 v215, v[16:19] offset:0
  v_cvt_pk_bf16_f32 v20, v248, v252
  v_cvt_pk_bf16_f32 v21, v249, v253
  v_cvt_pk_bf16_f32 v22, v250, v254
  v_cvt_pk_bf16_f32 v23, v251, v255
  ds_write_b128 v215, v[20:23] offset:1024
  s_waitcnt lgkmcnt(0)
  s_barrier
  ds_read_b128 v[96:99], v208 offset:0
  ds_read_b128 v[100:103], v208 offset:1024
  ds_read_b128 v[104:107], v208 offset:2048
  ds_read_b128 v[108:111], v208 offset:3072
  ds_read_b128 v[112:115], v208 offset:4096
  ds_read_b128 v[116:119], v208 offset:5120
  ds_read_b128 v[120:123], v208 offset:6144
  ds_read_b128 v[124:127], v208 offset:7168
  s_waitcnt vmcnt(20) lgkmcnt(7)
  v_mfma_f32_32x32x16_bf16 v[64:79], v[128:131], v[96:99], v[48:63]
  s_waitcnt vmcnt(19) lgkmcnt(6)
  v_mfma_f32_32x32x16_bf16 v[64:79], v[132:135], v[100:103], v[64:79]
  s_waitcnt vmcnt(18) lgkmcnt(5)
  v_mfma_f32_32x32x16_bf16 v[64:79], v[136:139], v[104:107], v[64:79]
  s_waitcnt vmcnt(17) lgkmcnt(4)
  v_mfma_f32_32x32x16_bf16 v[64:79], v[140:143], v[108:111], v[64:79]
  s_waitcnt vmcnt(16) lgkmcnt(3)
  v_mfma_f32_32x32x16_bf16 v[64:79], v[144:147], v[112:115], v[64:79]
  s_waitcnt vmcnt(15) lgkmcnt(2)
  v_mfma_f32_32x32x16_bf16 v[64:79], v[148:151], v[116:119], v[64:79]
  s_waitcnt vmcnt(14) lgkmcnt(1)
  v_mfma_f32_32x32x16_bf16 v[64:79], v[152:155], v[120:123], v[64:79]
  s_waitcnt vmcnt(13) lgkmcnt(0)
  v_mfma_f32_32x32x16_bf16 v[64:79], v[156:159], v[124:127], v[64:79]
  s_nop 11
  v_max3_f32 v180, v64, v65, v66
  v_max3_f32 v180, v180, v67, v68
  v_max3_f32 v180, v180, v69, v70
  v_max3_f32 v180, v180, v71, v72
  v_max3_f32 v180, v180, v73, v74
  v_max3_f32 v180, v180, v75, v76
  v_max3_f32 v180, v180, v77, v78
  v_max_f32 v180, v180, v79
  v_mov_b32 v181, v180
  s_nop 1
  v_permlane32_swap_b32 v180, v181
  v_max_f32 v180, v180, v181
  v_sub_f32 v64, v64, v180
  v_sub_f32 v65, v65, v180
  v_sub_f32 v66, v66, v180
  v_sub_f32 v67, v67, v180
  v_sub_f32 v68, v68, v180
  v_sub_f32 v69, v69, v180
  v_sub_f32 v70, v70, v180
  v_sub_f32 v71, v71, v180
  v_sub_f32 v72, v72, v180
  v_sub_f32 v73, v73, v180
  v_sub_f32 v74, v74, v180
  v_sub_f32 v75, v75, v180
  v_sub_f32 v76, v76, v180
  v_sub_f32 v77, v77, v180
  v_sub_f32 v78, v78, v180
  v_sub_f32 v79, v79, v180
  v_exp_f32 v64, v64
  v_exp_f32 v65, v65
  v_exp_f32 v66, v66
  v_exp_f32 v67, v67
  v_exp_f32 v68, v68
  v_exp_f32 v69, v69
  v_exp_f32 v70, v70
  v_exp_f32 v71, v71
  v_exp_f32 v72, v72
  v_exp_f32 v73, v73
  v_exp_f32 v74, v74
  v_exp_f32 v75, v75
  v_exp_f32 v76, v76
  v_exp_f32 v77, v77
  v_exp_f32 v78, v78
  v_exp_f32 v79, v79
  v_cvt_pk_bf16_f32 v20, v64, v65
  v_cvt_pk_bf16_f32 v21, v68, v69
  v_cvt_pk_bf16_f32 v22, v72, v73
  v_cvt_pk_bf16_f32 v23, v76, v77
  v_cvt_pk_bf16_f32 v24, v66, v67
  v_cvt_pk_bf16_f32 v25, v70, v71
  v_cvt_pk_bf16_f32 v26, v74, v75
  v_cvt_pk_bf16_f32 v27, v78, v79
  s_waitcnt vmcnt(12)
  v_mfma_f32_32x32x16_bf16 v[0:15], v[160:163], v[20:23], 0
  v_add_f32 v182, v64, v65
  v_add_f32 v182, v182, v66
  v_add_f32 v182, v182, v67
  v_add_f32 v182, v182, v68
  v_add_f32 v182, v182, v69
  v_add_f32 v182, v182, v70
  v_add_f32 v182, v182, v71
  s_waitcnt vmcnt(11)
  v_mfma_f32_32x32x16_bf16 v[0:15], v[164:167], v[24:27], v[0:15]
  v_add_f32 v182, v182, v72
  v_add_f32 v182, v182, v73
  v_add_f32 v182, v182, v74
  v_add_f32 v182, v182, v75
  v_add_f32 v182, v182, v76
  v_add_f32 v182, v182, v77
  v_add_f32 v182, v182, v78
  v_add_f32 v182, v182, v79
  s_waitcnt vmcnt(0)
  s_barrier
AT_loop:
  s_cmp_ge_u32 s59, 64
  s_cbranch_scc1 AT_l0
  s_mov_b32 s77, s59
  s_mul_i32 s66, s59, 655360
  s_lshl_b32 s55, s58, 14
  s_add_u32 s55, s55, s66
  s_add_u32 s55, s55, 1048576
  s_lshl_b32 s76, s58, 2
  s_add_u32 s76, s76, s52
  s_lshl_b32 s75, s59, 7
  s_add_u32 s75, s75, s76
  s_lshl_b32 s75, s75, 11
  s_add_u32 s75, s75, 46137344
  s_lshl_b32 s76, s76, 10
  s_add_u32 s76, s76, s66
  s_add_u32 s76, s76, 1572864
  s_add_u32 s59, s59, 2
  buffer_load_dwordx4 v[128:131], v216, s[8:11], s55 offen offset:0 sc1
  buffer_load_dwordx4 v[132:135], v216, s[8:11], s55 offen offset:256 sc1
  buffer_load_dwordx4 v[136:139], v216, s[8:11], s55 offen offset:512 sc1
  buffer_load_dwordx4 v[140:143], v216, s[8:11], s55 offen offset:768 sc1
  buffer_load_dwordx4 v[144:147], v216, s[8:11], s55 offen offset:1024 sc1
  buffer_load_dwordx4 v[148:151], v216, s[8:11], s55 offen offset:1280 sc1
  buffer_load_dwordx4 v[152:155], v216, s[8:11], s55 offen offset:1536 sc1
  buffer_load_dwordx4 v[156:159], v216, s[8:11], s55 offen offset:1792 sc1
  buffer_load_dwordx4 v[160:163], v217, s[8:11], s55 offen offset:0 sc1
  buffer_load_dwordx4 v[164:167], v217, s[8:11], s55 offen offset:256 sc1
  s_or_b32 s70, s73, 0xc00
  buffer_load_dword v172, off, s[8:11], s70 sc1
  s_add_u32 s60, s60, 73728
  ds_read_b128 v[32:35], v203 offset:36864
  ds_read_b128 v[36:39], v204 offset:36864
  ds_read_b128 v[40:43], v205 offset:36864
  s_waitcnt lgkmcnt(2)
  v_mfma_f32_32x32x16_bf16 v[240:255], a[0:3], v[32:35], 0
  ds_read_b128 v[44:47], v206 offset:36864
  s_add_u32 m0, s67, 0
  s_nop 0
  buffer_load_dwordx4 v202, s[4:7], s60 offen offset:0 lds
  s_waitcnt lgkmcnt(2)
  v_mfma_f32_32x32x16_bf16 v[240:255], a[4:7], v[36:39], v[240:255]
  ds_read_b128 v[32:35], v203 offset:37888
  s_waitcnt lgkmcnt(2)
  v_mfma_f32_32x32x16_bf16 v[240:255], a[8:11], v[40:43], v[240:255]
  ds_read_b128 v[36:39], v204 offset:37888
  s_add_u32 m0, s67, 896
  s_nop 0
  buffer_load_dwordx4 v202, s[4:7], s60 offen offset:128 lds
  s_waitcnt lgkmcnt(2)
  v_mfma_f32_32x32x16_bf16 v[240:255], a[12:15], v[44:47], v[240:255]
  ds_read_b128 v[40:43], v205 offset:37888
  s_waitcnt lgkmcnt(2)
  v_mfma_f32_32x32x16_bf16 v[240:255], a[16:19], v[32:35], v[240:255]
  ds_read_b128 v[44:47], v206 offset:37888
  s_add_u32 m0, s67, 1792
  s_nop 0
  buffer_load_dwordx4 v202, s[4:7], s60 offen offset:256 lds
  s_waitcnt lgkmcnt(2)
  v_mfma_f32_32x32x16_bf16 v[240:255], a[20:23], v[36:39], v[240:255]
  ds_read_b128 v[32:35], v203 offset:38912
  s_waitcnt lgkmcnt(2)
  v_mfma_f32_32x32x16_bf16 v[240:255], a[24:27], v[40:43], v[240:255]
  ds_read_b128 v[36:39], v204 offset:38912
  s_add_u32 m0, s67, 2688
  s_nop 0
  buffer_load_dwordx4 v202, s[4:7], s60 offen offset:384 lds
  s_waitcnt lgkmcnt(2)
  v_mfma_f32_32x32x16_bf16 v[240:255], a[28:31], v[44:47], v[240:255]
  ds_read_b128 v[40:43], v205 offset:38912
  s_waitcnt lgkmcnt(2)
  v_mfma_f32_32x32x16_bf16 v[240:255], a[32:35], v[32:35], v[240:255]
  ds_read_b128 v[44:47], v206 offset:38912
  s_add_u32 m0, s67, 3584
  s_nop 0
  buffer_load_dwordx4 v202, s[4:7], s60 offen offset:512 lds
  s_waitcnt lgkmcnt(2)
  v_mfma_f32_32x32x16_bf16 v[240:255], a[36:39], v[36:39], v[240:255]
  ds_read_b128 v[32:35], v203 offset:39936
  s_waitcnt lgkmcnt(2)
  v_mfma_f32_32x32x16_bf16 v[240:255], a[40:43], v[40:43], v[240:255]
  ds_read_b128 v[36:39], v204 offset:39936
  s_add_u32 m0, s67, 4480
  s_nop 0
  buffer_load_dwordx4 v202, s[4:7], s60 offen offset:640 lds
  s_waitcnt lgkmcnt(2)
  v_mfma_f32_32x32x16_bf16 v[240:255], a[44:47], v[44:47], v[240:255]
  ds_read_b128 v[40:43], v205 offset:39936
  s_waitcnt lgkmcnt(2)
  v_mfma_f32_32x32x16_bf16 v[240:255], a[48:51], v[32:35], v[240:255]
  ds_read_b128 v[44:47], v206 offset:39936
  s_add_u32 m0, s67, 5376
  s_nop 0
  buffer_load_dwordx4 v202, s[4:7], s60 offen offset:768 lds
  s_waitcnt lgkmcnt(2)
  v_mfma_f32_32x32x16_bf16 v[240:255], a[52:55], v[36:39], v[240:255]
  ds_read_b128 v[32:35], v203 offset:40960
  s_waitcnt lgkmcnt(2)
  v_mfma_f32_32x32x16_bf16 v[240:255], a[56:59], v[40:43], v[240:255]
  ds_read_b128 v[36:39], v204 offset:40960
  s_add_u32 m0, s67, 6272
  s_nop 0
  buffer_load_dwordx4 v202, s[4:7], s60 offen offset:896 lds
  s_waitcnt lgkmcnt(2)
  v_mfma_f32_32x32x16_bf16 v[240:255], a[60:63], v[44:47], v[240:255]
  ds_read_b128 v[40:43], v205 offset:40960
  s_waitcnt lgkmcnt(2)
  v_mfma_f32_32x32x16_bf16 v[240:255], a[64:67], v[32:35], v[240:255]
  ds_read_b128 v[44:47], v206 offset:40960
  s_add_u32 m0, s67, 7168
  s_nop 0
  buffer_load_dwordx4 v202, s[4:7], s60 offen offset:1024 lds
  s_waitcnt lgkmcnt(2)
  v_mfma_f32_32x32x16_bf16 v[240:255], a[68:71], v[36:39], v[240:255]
  ds_read_b128 v[32:35], v203 offset:41984
  s_waitcnt lgkmcnt(2)
  v_mfma_f32_32x32x16_bf16 v[240:255], a[72:75], v[40:43], v[240:255]
  ds_read_b128 v[36:39], v204 offset:41984
  buffer_store_dwordx4 v[176:179], v201, s[8:11], s75 offen offset:0 sc1
  s_waitcnt lgkmcnt(2)
  v_mfma_f32_32x32x16_bf16 v[240:255], a[76:79], v[44:47], v[240:255]
  ds_read_b128 v[40:43], v205 offset:41984
  s_waitcnt lgkmcnt(2)
  v_mfma_f32_32x32x16_bf16 v[240:255], a[80:83], v[32:35], v[240:255]
  ds_read_b128 v[44:47], v206 offset:41984
  buffer_store_dwordx4 v[176:179], v201, s[8:11], s75 offen offset:1024 sc1
  s_waitcnt lgkmcnt(2)
  v_mfma_f32_32x32x16_bf16 v[240:255], a[84:87], v[36:39], v[240:255]
  ds_read_b128 v[32:35], v203 offset:43008
  s_waitcnt lgkmcnt(2)
  v_mfma_f32_32x32x16_bf16 v[240:255], a[88:91], v[40:43], v[240:255]
  ds_read_b128 v[36:39], v204 offset:43008
  s_waitcnt lgkmcnt(2)
  v_mfma_f32_32x32x16_bf16 v[240:255], a[92:95], v[44:47], v[240:255]
  ds_read_b128 v[40:43], v205 offset:43008
  s_waitcnt lgkmcnt(2)
  v_mfma_f32_32x32x16_bf16 v[240:255], a[96:99], v[32:35], v[240:255]
  ds_read_b128 v[44:47], v206 offset:43008
  s_waitcnt lgkmcnt(2)
  v_mfma_f32_32x32x16_bf16 v[240:255], a[100:103], v[36:39], v[240:255]
  ds_read_b128 v[32:35], v203 offset:44032
  s_waitcnt lgkmcnt(2)
  v_mfma_f32_32x32x16_bf16 v[240:255], a[104:107], v[40:43], v[240:255]
  ds_read_b128 v[36:39], v204 offset:44032
  s_waitcnt lgkmcnt(2)
  v_mfma_f32_32x32x16_bf16 v[240:255], a[108:111], v[44:47], v[240:255]
  ds_read_b128 v[40:43], v205 offset:44032
  s_waitcnt lgkmcnt(2)
  v_mfma_f32_32x32x16_bf16 v[240:255], a[112:115], v[32:35], v[240:255]
  ds_read_b128 v[44:47], v206 offset:44032
  s_waitcnt lgkmcnt(2)
  v_mfma_f32_32x32x16_bf16 v[240:255], a[116:119], v[36:39], v[240:255]
  ds_read_b128 v[32:35], v203 offset:45056
  s_waitcnt lgkmcnt(2)
  v_mfma_f32_32x32x16_bf16 v[240:255], a[120:123], v[40:43], v[240:255]
  ds_read_b128 v[36:39], v204 offset:45056
  s_waitcnt lgkmcnt(2)
  v_mfma_f32_32x32x16_bf16 v[240:255], a[124:127], v[44:47], v[240:255]
  ds_read_b128 v[40:43], v205 offset:45056
  s_waitcnt lgkmcnt(2)
  v_mfma_f32_32x32x16_bf16 v[240:255], a[128:131], v[32:35], v[240:255]
  ds_read_b128 v[44:47], v206 offset:45056
  s_waitcnt lgkmcnt(2)
  v_mfma_f32_32x32x16_bf16 v[240:255], a[132:135], v[36:39], v[240:255]
  s_waitcnt lgkmcnt(1)
  v_mfma_f32_32x32x16_bf16 v[240:255], a[136:139], v[40:43], v[240:255]
  s_waitcnt lgkmcnt(0)
  v_mfma_f32_32x32x16_bf16 v[240:255], a[140:143], v[44:47], v[240:255]
  s_nop 11
  v_cvt_pk_bf16_f32 v16, v240, v244
  v_cvt_pk_bf16_f32 v17, v241, v245
  v_cvt_pk_bf16_f32 v18, v242, v246
  v_cvt_pk_bf16_f32 v19, v243, v247
  ds_write_b128 v215, v[16:19] offset:0
  v_cvt_pk_bf16_f32 v20, v248, v252
  v_cvt_pk_bf16_f32 v21, v249, v253
  v_cvt_pk_bf16_f32 v22, v250, v254
  v_cvt_pk_bf16_f32 v23, v251, v255
  ds_write_b128 v215, v[20:23] offset:1024
  s_waitcnt lgkmcnt(0)
  s_barrier
  ds_read_b128 a[144:147], v208 offset:0
  ds_read_b128 a[148:151], v208 offset:1024
  ds_read_b128 a[152:155], v208 offset:2048
  ds_read_b128 a[156:159], v208 offset:3072
  ds_read_b128 a[160:163], v208 offset:4096
  ds_read_b128 a[164:167], v208 offset:5120
  ds_read_b128 a[168:171], v208 offset:6144
  ds_read_b128 a[172:175], v208 offset:7168
  s_waitcnt vmcnt(11)
  v_cmp_eq_u32 vcc, -1, v172
  s_mov_b32 s69, 0
  s_cbranch_vccnz AT_e1
  s_mov_b32 s69, 1
  buffer_load_dwordx4 v[172:175], v201, s[8:11], s73 offen sc1
AT_e1:
  s_waitcnt lgkmcnt(7)
  v_mfma_f32_32x32x16_bf16 v[64:79], v[128:131], a[144:147], v[48:63]
  s_waitcnt lgkmcnt(6)
  v_mfma_f32_32x32x16_bf16 v[64:79], v[132:135], a[148:151], v[64:79]
  s_waitcnt lgkmcnt(5)
  v_mfma_f32_32x32x16_bf16 v[64:79], v[136:139], a[152:155], v[64:79]
  s_waitcnt lgkmcnt(4)
  v_mfma_f32_32x32x16_bf16 v[64:79], v[140:143], a[156:159], v[64:79]
  s_waitcnt lgkmcnt(3)
  v_mfma_f32_32x32x16_bf16 v[64:79], v[144:147], a[160:163], v[64:79]
  s_waitcnt lgkmcnt(2)
  v_mfma_f32_32x32x16_bf16 v[64:79], v[148:151], a[164:167], v[64:79]
  s_waitcnt lgkmcnt(1)
  v_mfma_f32_32x32x16_bf16 v[64:79], v[152:155], a[168:171], v[64:79]
  s_waitcnt lgkmcnt(0)
  v_mfma_f32_32x32x16_bf16 v[64:79], v[156:159], a[172:175], v[64:79]
  s_nop 11
  v_max3_f32 v184, v64, v65, v66
  v_max3_f32 v184, v184, v67, v68
  v_max3_f32 v184, v184, v69, v70
  v_max3_f32 v184, v184, v71, v72
  v_max3_f32 v184, v184, v73, v74
  v_max3_f32 v184, v184, v75, v76
  v_max3_f32 v184, v184, v77, v78
  v_max_f32 v184, v184, v79
  v_mov_b32 v185, v184
  s_nop 1
  v_permlane32_swap_b32 v184, v185
  v_max_f32 v184, v184, v185
  v_sub_f32 v64, v64, v184
  v_sub_f32 v65, v65, v184
  v_sub_f32 v66, v66, v184
  v_sub_f32 v67, v67, v184
  v_sub_f32 v68, v68, v184
  v_sub_f32 v69, v69, v184
  v_sub_f32 v70, v70, v184
  v_sub_f32 v71, v71, v184
  v_sub_f32 v72, v72, v184
  v_sub_f32 v73, v73, v184
  v_sub_f32 v74, v74, v184
  v_sub_f32 v75, v75, v184
  v_sub_f32 v76, v76, v184
  v_sub_f32 v77, v77, v184
  v_sub_f32 v78, v78, v184
  v_sub_f32 v79, v79, v184
  v_exp_f32 v64, v64
  v_exp_f32 v65, v65
  v_exp_f32 v66, v66
  v_exp_f32 v67, v67
  v_exp_f32 v68, v68
  v_exp_f32 v69, v69
  v_exp_f32 v70, v70
  v_exp_f32 v71, v71
  v_exp_f32 v72, v72
  v_exp_f32 v73, v73
  v_exp_f32 v74, v74
  v_exp_f32 v75, v75
  v_exp_f32 v76, v76
  v_exp_f32 v77, v77
  v_exp_f32 v78, v78
  v_exp_f32 v79, v79
  v_cvt_pk_bf16_f32 v20, v64, v65
  v_cvt_pk_bf16_f32 v21, v68, v69
  v_cvt_pk_bf16_f32 v22, v72, v73
  v_cvt_pk_bf16_f32 v23, v76, v77
  v_cvt_pk_bf16_f32 v24, v66, v67
  v_cvt_pk_bf16_f32 v25, v70, v71
  v_cvt_pk_bf16_f32 v26, v74, v75
  v_cvt_pk_bf16_f32 v27, v78, v79
  v_mfma_f32_32x32x16_bf16 v[224:239], v[160:163], v[20:23], 0
  v_add_f32 v186, v64, v65
  v_add_f32 v186, v186, v66
  v_add_f32 v186, v186, v67
  v_add_f32 v186, v186, v68
  v_add_f32 v186, v186, v69
  v_add_f32 v186, v186, v70
  v_add_f32 v186, v186, v71
  v_mfma_f32_32x32x16_bf16 v[224:239], v[164:167], v[24:27], v[224:239]
  v_add_f32 v186, v186, v72
  v_add_f32 v186, v186, v73
  v_add_f32 v186, v186, v74
  v_add_f32 v186, v186, v75
  v_add_f32 v186, v186, v76
  v_add_f32 v186, v186, v77
  v_add_f32 v186, v186, v78
  v_add_f32 v186, v186, v79
AT_l0:
  s_cmp_eq_u32 s69, 1
  s_cbranch_scc1 AT_v0
  s_or_b32 s70, s73, 0xc00
  s_cmp_eq_u32 s74, 63
  s_cselect_b32 s54, 655360, 0
  s_sub_u32 s70, s70, s54
  s_branch AT_c0
AT_h0:
  s_sleep 1
AT_c0:
  buffer_load_dword v172, off, s[8:11], s70 sc1
  s_add_u32 s65, s65, 1
  s_cmp_lt_u32 s65, 131072
  s_cselect_b32 s54, -2, -1
  s_waitcnt vmcnt(0)
  v_cmp_lt_u32 vcc, s54, v172
  s_cbranch_vccnz AT_h0
AT_k0:
  buffer_load_dwordx4 v[172:175], v201, s[8:11], s73 offen sc1
AT_v0:
  s_mov_b32 s69, 0
  s_add_u32 s65, s65, 1
  s_cmp_lt_u32 s65, 131072
  s_cselect_b32 s54, -2, -1
  s_waitcnt vmcnt(0)
  ds_write_b64 v220, v[172:173] offset:0
  ds_write_b64 v221, v[174:175] offset:0
  v_max3_u32 v213, v172, v173, v174
  v_max_u32 v213, v213, v175
  v_cmp_lt_u32 vcc, s54, v213
  s_cbranch_vccnz AT_k0
  s_waitcnt lgkmcnt(0)
  s_barrier
  ds_read_b128 v[128:131], v218 offset:0
  ds_read_b128 v[132:135], v218 offset:256
  ds_read_b128 v[136:139], v218 offset:512
  ds_read_b128 v[140:143], v218 offset:768
  ds_read_b128 v[144:147], v218 offset:1024
  ds_read_b128 v[148:151], v218 offset:1280
  ds_read_b128 v[152:155], v218 offset:1536
  ds_read_b128 v[156:159], v218 offset:1792
  ds_read_b32 v168, v219 offset:0
  ds_read_b32 v169, v219 offset:128
  s_add_u32 s74, s74, 2
  v_mov_b32 v212, s74
  s_waitcnt lgkmcnt(9)
  v_mfma_f32_32x32x16_bf16 v[80:95], v[128:131], v[96:99], 0
  s_waitcnt lgkmcnt(8)
  v_mfma_f32_32x32x16_bf16 v[80:95], v[132:135], v[100:103], v[80:95]
  s_waitcnt lgkmcnt(7)
  v_mfma_f32_32x32x16_bf16 v[80:95], v[136:139], v[104:107], v[80:95]
  s_waitcnt lgkmcnt(6)
  v_mfma_f32_32x32x16_bf16 v[80:95], v[140:143], v[108:111], v[80:95]
  s_mov_b64 exec, 1
  buffer_store_dword v212, v201, s[8:11], s71 offen sc1
  s_mov_b64 exec, -1
  s_waitcnt lgkmcnt(5)
  v_mfma_f32_32x32x16_bf16 v[80:95], v[144:147], v[112:115], v[80:95]
  s_waitcnt lgkmcnt(4)
  v_mfma_f32_32x32x16_bf16 v[80:95], v[148:151], v[116:119], v[80:95]
  s_waitcnt lgkmcnt(3)
  v_mfma_f32_32x32x16_bf16 v[80:95], v[152:155], v[120:123], v[80:95]
  s_waitcnt lgkmcnt(2)
  v_mfma_f32_32x32x16_bf16 v[80:95], v[156:159], v[124:127], v[80:95]
  s_nop 11
  v_mul_f32 v80, s68, v80
  v_mul_f32 v81, s68, v81
  v_mul_f32 v82, s68, v82
  v_mul_f32 v83, s68, v83
  v_max3_f32 v84, v180, v80, v81
  v_max3_f32 v84, v84, v82, v83
  v_mov_b32 v85, v84
  s_nop 1
  v_permlane32_swap_b32 v84, v85
  v_max_f32 v84, v84, v85
  v_sub_f32 v86, v180, v84
  v_sub_f32 v80, v80, v84
  v_sub_f32 v81, v81, v84
  v_sub_f32 v82, v82, v84
  v_sub_f32 v83, v83, v84
  v_exp_f32 v86, v86
  v_exp_f32 v80, v80
  v_exp_f32 v81, v81
  v_exp_f32 v82, v82
  v_exp_f32 v83, v83
  v_fma_f32 v182, v182, v86, v80
  v_add_f32 v84, v81, v82
  v_add_f32 v182, v182, v83
  v_add_f32 v182, v182, v84
  v_mov_b32 v183, v182
  s_nop 1
  v_permlane32_swap_b32 v182, v183
  v_add_f32 v182, v182, v183
  v_rcp_f32 v182, v182
  s_nop 0
  v_mul_f32 v86, v86, v182
  v_mul_f32 v80, v182, v80
  v_mul_f32 v81, v182, v81
  v_mul_f32 v82, v182, v82
  v_mul_f32 v83, v182, v83
  v_cvt_pk_bf16_f32 v28, v80, v81
  v_cvt_pk_bf16_f32 v29, v82, v83
  v_mul_f32 v0, v86, v0
  v_mul_f32 v1, v86, v1
  v_mul_f32 v2, v86, v2
  v_mul_f32 v3, v86, v3
  v_mul_f32 v4, v86, v4
  v_mul_f32 v5, v86, v5
  v_mul_f32 v6, v86, v6
  v_mul_f32 v7, v86, v7
  v_mul_f32 v8, v86, v8
  v_mul_f32 v9, v86, v9
  v_mul_f32 v10, v86, v10
  v_mul_f32 v11, v86, v11
  v_mul_f32 v12, v86, v12
  v_mul_f32 v13, v86, v13
  v_mul_f32 v14, v86, v14
  v_mul_f32 v15, v86, v15
  s_waitcnt lgkmcnt(0)
  s_nop 0
  v_mfma_f32_32x32x8_bf16 v[0:15], v[168:169], v[28:29], v[0:15]
  s_nop 11
  v_cvt_pk_bf16_f32 v20, v0, v1
  v_cvt_pk_bf16_f32 v21, v2, v3
  v_cvt_pk_bf16_f32 v22, v4, v5
  v_cvt_pk_bf16_f32 v23, v6, v7
  buffer_store_dwordx4 v[20:23], v201, s[8:11], s72 offen offset:0 sc1
  v_cvt_pk_bf16_f32 v24, v8, v9
  v_cvt_pk_bf16_f32 v25, v10, v11
  v_cvt_pk_bf16_f32 v26, v12, v13
  v_cvt_pk_bf16_f32 v27, v14, v15
  buffer_store_dwordx4 v[24:27], v201, s[8:11], s72 offen offset:1024 sc1
  s_cmp_ge_u32 s74, 64
  s_cbranch_scc1 L_exit
  s_cmp_ge_u32 s59, 64
  s_cbranch_scc1 AT_l1
  s_mov_b32 s74, s59
  s_mul_i32 s66, s59, 655360
  s_lshl_b32 s55, s58, 14
  s_add_u32 s55, s55, s66
  s_add_u32 s55, s55, 1048576
  s_lshl_b32 s73, s58, 2
  s_add_u32 s73, s73, s52
  s_lshl_b32 s72, s59, 7
  s_add_u32 s72, s72, s73
  s_lshl_b32 s72, s72, 11
  s_add_u32 s72, s72, 46137344
  s_lshl_b32 s73, s73, 10
  s_add_u32 s73, s73, s66
  s_add_u32 s73, s73, 1572864
  s_add_u32 s59, s59, 2
  buffer_load_dwordx4 v[128:131], v216, s[8:11], s55 offen offset:0 sc1
  buffer_load_dwordx4 v[132:135], v216, s[8:11], s55 offen offset:256 sc1
  buffer_load_dwordx4 v[136:139], v216, s[8:11], s55 offen offset:512 sc1
  buffer_load_dwordx4 v[140:143], v216, s[8:11], s55 offen offset:768 sc1
  buffer_load_dwordx4 v[144:147], v216, s[8:11], s55 offen offset:1024 sc1
  buffer_load_dwordx4 v[148:151], v216, s[8:11], s55 offen offset:1280 sc1
  buffer_load_dwordx4 v[152:155], v216, s[8:11], s55 offen offset:1536 sc1
  buffer_load_dwordx4 v[156:159], v216, s[8:11], s55 offen offset:1792 sc1
  buffer_load_dwordx4 v[160:163], v217, s[8:11], s55 offen offset:0 sc1
  buffer_load_dwordx4 v[164:167], v217, s[8:11], s55 offen offset:256 sc1
  s_or_b32 s70, s76, 0xc00
  buffer_load_dword v172, off, s[8:11], s70 sc1
  s_add_u32 s60, s60, 73728
  ds_read_b128 v[32:35], v203 offset:0
  ds_read_b128 v[36:39], v204 offset:0
  ds_read_b128 v[40:43], v205 offset:0
  s_waitcnt lgkmcnt(2)
  v_mfma_f32_32x32x16_bf16 v[240:255], a[0:3], v[32:35], 0
  ds_read_b128 v[44:47], v206 offset:0
  s_add_u32 m0, s67, 36864
  s_nop 0
  buffer_load_dwordx4 v202, s[4:7], s60 offen offset:0 lds
  s_waitcnt lgkmcnt(2)
  v_mfma_f32_32x32x16_bf16 v[240:255], a[4:7], v[36:39], v[240:255]
  ds_read_b128 v[32:35], v203 offset:1024
  s_waitcnt lgkmcnt(2)
  v_mfma_f32_32x32x16_bf16 v[240:255], a[8:11], v[40:43], v[240:255]
  ds_read_b128 v[36:39], v204 offset:1024
  s_add_u32 m0, s67, 37760
  s_nop 0
  buffer_load_dwordx4 v202, s[4:7], s60 offen offset:128 lds
  s_waitcnt lgkmcnt(2)
  v_mfma_f32_32x32x16_bf16 v[240:255], a[12:15], v[44:47], v[240:255]
  ds_read_b128 v[40:43], v205 offset:1024
  s_waitcnt lgkmcnt(2)
  v_mfma_f32_32x32x16_bf16 v[240:255], a[16:19], v[32:35], v[240:255]
  ds_read_b128 v[44:47], v206 offset:1024
  s_add_u32 m0, s67, 38656
  s_nop 0
  buffer_load_dwordx4 v202, s[4:7], s60 offen offset:256 lds
  s_waitcnt lgkmcnt(2)
  v_mfma_f32_32x32x16_bf16 v[240:255], a[20:23], v[36:39], v[240:255]
  ds_read_b128 v[32:35], v203 offset:2048
  s_waitcnt lgkmcnt(2)
  v_mfma_f32_32x32x16_bf16 v[240:255], a[24:27], v[40:43], v[240:255]
  ds_read_b128 v[36:39], v204 offset:2048
  s_add_u32 m0, s67, 39552
  s_nop 0
  buffer_load_dwordx4 v202, s[4:7], s60 offen offset:384 lds
  s_waitcnt lgkmcnt(2)
  v_mfma_f32_32x32x16_bf16 v[240:255], a[28:31], v[44:47], v[240:255]
  ds_read_b128 v[40:43], v205 offset:2048
  s_waitcnt lgkmcnt(2)
  v_mfma_f32_32x32x16_bf16 v[240:255], a[32:35], v[32:35], v[240:255]
  ds_read_b128 v[44:47], v206 offset:2048
  s_add_u32 m0, s67, 40448
  s_nop 0
  buffer_load_dwordx4 v202, s[4:7], s60 offen offset:512 lds
  s_waitcnt lgkmcnt(2)
  v_mfma_f32_32x32x16_bf16 v[240:255], a[36:39], v[36:39], v[240:255]
  ds_read_b128 v[32:35], v203 offset:3072
  s_waitcnt lgkmcnt(2)
  v_mfma_f32_32x32x16_bf16 v[240:255], a[40:43], v[40:43], v[240:255]
  ds_read_b128 v[36:39], v204 offset:3072
  s_add_u32 m0, s67, 41344
  s_nop 0
  buffer_load_dwordx4 v202, s[4:7], s60 offen offset:640 lds
  s_waitcnt lgkmcnt(2)
  v_mfma_f32_32x32x16_bf16 v[240:255], a[44:47], v[44:47], v[240:255]
  ds_read_b128 v[40:43], v205 offset:3072
  s_waitcnt lgkmcnt(2)
  v_mfma_f32_32x32x16_bf16 v[240:255], a[48:51], v[32:35], v[240:255]
  ds_read_b128 v[44:47], v206 offset:3072
  s_add_u32 m0, s67, 42240
  s_nop 0
  buffer_load_dwordx4 v202, s[4:7], s60 offen offset:768 lds
  s_waitcnt lgkmcnt(2)
  v_mfma_f32_32x32x16_bf16 v[240:255], a[52:55], v[36:39], v[240:255]
  ds_read_b128 v[32:35], v203 offset:4096
  s_waitcnt lgkmcnt(2)
  v_mfma_f32_32x32x16_bf16 v[240:255], a[56:59], v[40:43], v[240:255]
  ds_read_b128 v[36:39], v204 offset:4096
  s_add_u32 m0, s67, 43136
  s_nop 0
  buffer_load_dwordx4 v202, s[4:7], s60 offen offset:896 lds
  s_waitcnt lgkmcnt(2)
  v_mfma_f32_32x32x16_bf16 v[240:255], a[60:63], v[44:47], v[240:255]
  ds_read_b128 v[40:43], v205 offset:4096
  s_waitcnt lgkmcnt(2)
  v_mfma_f32_32x32x16_bf16 v[240:255], a[64:67], v[32:35], v[240:255]
  ds_read_b128 v[44:47], v206 offset:4096
  s_add_u32 m0, s67, 44032
  s_nop 0
  buffer_load_dwordx4 v202, s[4:7], s60 offen offset:1024 lds
  s_waitcnt lgkmcnt(2)
  v_mfma_f32_32x32x16_bf16 v[240:255], a[68:71], v[36:39], v[240:255]
  ds_read_b128 v[32:35], v203 offset:5120
  s_waitcnt lgkmcnt(2)
  v_mfma_f32_32x32x16_bf16 v[240:255], a[72:75], v[40:43], v[240:255]
  ds_read_b128 v[36:39], v204 offset:5120
  buffer_store_dwordx4 v[176:179], v201, s[8:11], s72 offen offset:0 sc1
  s_waitcnt lgkmcnt(2)
  v_mfma_f32_32x32x16_bf16 v[240:255], a[76:79], v[44:47], v[240:255]
  ds_read_b128 v[40:43], v205 offset:5120
  s_waitcnt lgkmcnt(2)
  v_mfma_f32_32x32x16_bf16 v[240:255], a[80:83], v[32:35], v[240:255]
  ds_read_b128 v[44:47], v206 offset:5120
  buffer_store_dwordx4 v[176:179], v201, s[8:11], s72 offen offset:1024 sc1
  s_waitcnt lgkmcnt(2)
  v_mfma_f32_32x32x16_bf16 v[240:255], a[84:87], v[36:39], v[240:255]
  ds_read_b128 v[32:35], v203 offset:6144
  s_waitcnt lgkmcnt(2)
  v_mfma_f32_32x32x16_bf16 v[240:255], a[88:91], v[40:43], v[240:255]
  ds_read_b128 v[36:39], v204 offset:6144
  s_waitcnt lgkmcnt(2)
  v_mfma_f32_32x32x16_bf16 v[240:255], a[92:95], v[44:47], v[240:255]
  ds_read_b128 v[40:43], v205 offset:6144
  s_waitcnt lgkmcnt(2)
  v_mfma_f32_32x32x16_bf16 v[240:255], a[96:99], v[32:35], v[240:255]
  ds_read_b128 v[44:47], v206 offset:6144
  s_waitcnt lgkmcnt(2)
  v_mfma_f32_32x32x16_bf16 v[240:255], a[100:103], v[36:39], v[240:255]
  ds_read_b128 v[32:35], v203 offset:7168
  s_waitcnt lgkmcnt(2)
  v_mfma_f32_32x32x16_bf16 v[240:255], a[104:107], v[40:43], v[240:255]
  ds_read_b128 v[36:39], v204 offset:7168
  s_waitcnt lgkmcnt(2)
  v_mfma_f32_32x32x16_bf16 v[240:255], a[108:111], v[44:47], v[240:255]
  ds_read_b128 v[40:43], v205 offset:7168
  s_waitcnt lgkmcnt(2)
  v_mfma_f32_32x32x16_bf16 v[240:255], a[112:115], v[32:35], v[240:255]
  ds_read_b128 v[44:47], v206 offset:7168
  s_waitcnt lgkmcnt(2)
  v_mfma_f32_32x32x16_bf16 v[240:255], a[116:119], v[36:39], v[240:255]
  ds_read_b128 v[32:35], v203 offset:8192
  s_waitcnt lgkmcnt(2)
  v_mfma_f32_32x32x16_bf16 v[240:255], a[120:123], v[40:43], v[240:255]
  ds_read_b128 v[36:39], v204 offset:8192
  s_waitcnt lgkmcnt(2)
  v_mfma_f32_32x32x16_bf16 v[240:255], a[124:127], v[44:47], v[240:255]
  ds_read_b128 v[40:43], v205 offset:8192
  s_waitcnt lgkmcnt(2)
  v_mfma_f32_32x32x16_bf16 v[240:255], a[128:131], v[32:35], v[240:255]
  ds_read_b128 v[44:47], v206 offset:8192
  s_waitcnt lgkmcnt(2)
  v_mfma_f32_32x32x16_bf16 v[240:255], a[132:135], v[36:39], v[240:255]
  s_waitcnt lgkmcnt(1)
  v_mfma_f32_32x32x16_bf16 v[240:255], a[136:139], v[40:43], v[240:255]
  s_waitcnt lgkmcnt(0)
  v_mfma_f32_32x32x16_bf16 v[240:255], a[140:143], v[44:47], v[240:255]
  s_nop 11
  v_cvt_pk_bf16_f32 v16, v240, v244
  v_cvt_pk_bf16_f32 v17, v241, v245
  v_cvt_pk_bf16_f32 v18, v242, v246
  v_cvt_pk_bf16_f32 v19, v243, v247
  ds_write_b128 v215, v[16:19] offset:0
  v_cvt_pk_bf16_f32 v20, v248, v252
  v_cvt_pk_bf16_f32 v21, v249, v253
  v_cvt_pk_bf16_f32 v22, v250, v254
  v_cvt_pk_bf16_f32 v23, v251, v255
  ds_write_b128 v215, v[20:23] offset:1024
  s_waitcnt lgkmcnt(0)
  s_barrier
  ds_read_b128 v[96:99], v208 offset:0
  ds_read_b128 v[100:103], v208 offset:1024
  ds_read_b128 v[104:107], v208 offset:2048
  ds_read_b128 v[108:111], v208 offset:3072
  ds_read_b128 v[112:115], v208 offset:4096
  ds_read_b128 v[116:119], v208 offset:5120
  ds_read_b128 v[120:123], v208 offset:6144
  ds_read_b128 v[124:127], v208 offset:7168
  s_waitcnt vmcnt(11)
  v_cmp_eq_u32 vcc, -1, v172
  s_mov_b32 s69, 0
  s_cbranch_vccnz AT_e0
  s_mov_b32 s69, 1
  buffer_load_dwordx4 v[172:175], v201, s[8:11], s76 offen sc1
AT_e0:
  s_waitcnt lgkmcnt(7)
  v_mfma_f32_32x32x16_bf16 v[64:79], v[128:131], v[96:99], v[48:63]
  s_waitcnt lgkmcnt(6)
  v_mfma_f32_32x32x16_bf16 v[64:79], v[132:135], v[100:103], v[64:79]
  s_waitcnt lgkmcnt(5)
  v_mfma_f32_32x32x16_bf16 v[64:79], v[136:139], v[104:107], v[64:79]
  s_waitcnt lgkmcnt(4)
  v_mfma_f32_32x32x16_bf16 v[64:79], v[140:143], v[108:111], v[64:79]
  s_waitcnt lgkmcnt(3)
  v_mfma_f32_32x32x16_bf16 v[64:79], v[144:147], v[112:115], v[64:79]
  s_waitcnt lgkmcnt(2)
  v_mfma_f32_32x32x16_bf16 v[64:79], v[148:151], v[116:119], v[64:79]
  s_waitcnt lgkmcnt(1)
  v_mfma_f32_32x32x16_bf16 v[64:79], v[152:155], v[120:123], v[64:79]
  s_waitcnt lgkmcnt(0)
  v_mfma_f32_32x32x16_bf16 v[64:79], v[156:159], v[124:127], v[64:79]
  s_nop 11
  v_max3_f32 v180, v64, v65, v66
  v_max3_f32 v180, v180, v67, v68
  v_max3_f32 v180, v180, v69, v70
  v_max3_f32 v180, v180, v71, v72
  v_max3_f32 v180, v180, v73, v74
  v_max3_f32 v180, v180, v75, v76
  v_max3_f32 v180, v180, v77, v78
  v_max_f32 v180, v180, v79
  v_mov_b32 v181, v180
  s_nop 1
  v_permlane32_swap_b32 v180, v181
  v_max_f32 v180, v180, v181
  v_sub_f32 v64, v64, v180
  v_sub_f32 v65, v65, v180
  v_sub_f32 v66, v66, v180
  v_sub_f32 v67, v67, v180
  v_sub_f32 v68, v68, v180
  v_sub_f32 v69, v69, v180
  v_sub_f32 v70, v70, v180
  v_sub_f32 v71, v71, v180
  v_sub_f32 v72, v72, v180
  v_sub_f32 v73, v73, v180
  v_sub_f32 v74, v74, v180
  v_sub_f32 v75, v75, v180
  v_sub_f32 v76, v76, v180
  v_sub_f32 v77, v77, v180
  v_sub_f32 v78, v78, v180
  v_sub_f32 v79, v79, v180
  v_exp_f32 v64, v64
  v_exp_f32 v65, v65
  v_exp_f32 v66, v66
  v_exp_f32 v67, v67
  v_exp_f32 v68, v68
  v_exp_f32 v69, v69
  v_exp_f32 v70, v70
  v_exp_f32 v71, v71
  v_exp_f32 v72, v72
  v_exp_f32 v73, v73
  v_exp_f32 v74, v74
  v_exp_f32 v75, v75
  v_exp_f32 v76, v76
  v_exp_f32 v77, v77
  v_exp_f32 v78, v78
  v_exp_f32 v79, v79
  v_cvt_pk_bf16_f32 v20, v64, v65
  v_cvt_pk_bf16_f32 v21, v68, v69
  v_cvt_pk_bf16_f32 v22, v72, v73
  v_cvt_pk_bf16_f32 v23, v76, v77
  v_cvt_pk_bf16_f32 v24, v66, v67
  v_cvt_pk_bf16_f32 v25, v70, v71
  v_cvt_pk_bf16_f32 v26, v74, v75
  v_cvt_pk_bf16_f32 v27, v78, v79
  v_mfma_f32_32x32x16_bf16 v[0:15], v[160:163], v[20:23], 0
  v_add_f32 v182, v64, v65
  v_add_f32 v182, v182, v66
  v_add_f32 v182, v182, v67
  v_add_f32 v182, v182, v68
  v_add_f32 v182, v182, v69
  v_add_f32 v182, v182, v70
  v_add_f32 v182, v182, v71
  v_mfma_f32_32x32x16_bf16 v[0:15], v[164:167], v[24:27], v[0:15]
  v_add_f32 v182, v182, v72
  v_add_f32 v182, v182, v73
  v_add_f32 v182, v182, v74
  v_add_f32 v182, v182, v75
  v_add_f32 v182, v182, v76
  v_add_f32 v182, v182, v77
  v_add_f32 v182, v182, v78
  v_add_f32 v182, v182, v79
AT_l1:
  s_cmp_eq_u32 s69, 1
  s_cbranch_scc1 AT_v1
  s_or_b32 s70, s76, 0xc00
  s_cmp_eq_u32 s77, 63
  s_cselect_b32 s54, 655360, 0
  s_sub_u32 s70, s70, s54
  s_branch AT_c1
AT_h1:
  s_sleep 1
AT_c1:
  buffer_load_dword v172, off, s[8:11], s70 sc1
  s_add_u32 s65, s65, 1
  s_cmp_lt_u32 s65, 131072
  s_cselect_b32 s54, -2, -1
  s_waitcnt vmcnt(0)
  v_cmp_lt_u32 vcc, s54, v172
  s_cbranch_vccnz AT_h1
AT_k1:
  buffer_load_dwordx4 v[172:175], v201, s[8:11], s76 offen sc1
AT_v1:
  s_mov_b32 s69, 0
  s_add_u32 s65, s65, 1
  s_cmp_lt_u32 s65, 131072
  s_cselect_b32 s54, -2, -1
  s_waitcnt vmcnt(0)
  ds_write_b64 v220, v[172:173] offset:4096
  ds_write_b64 v221, v[174:175] offset:4096
  v_max3_u32 v213, v172, v173, v174
  v_max_u32 v213, v213, v175
  v_cmp_lt_u32 vcc, s54, v213
  s_cbranch_vccnz AT_k1
  s_waitcnt lgkmcnt(0)
  s_barrier
  ds_read_b128 v[128:131], v218 offset:4096
  ds_read_b128 v[132:135], v218 offset:4352
  ds_read_b128 v[136:139], v218 offset:4608
  ds_read_b128 v[140:143], v218 offset:4864
  ds_read_b128 v[144:147], v218 offset:5120
  ds_read_b128 v[148:151], v218 offset:5376
  ds_read_b128 v[152:155], v218 offset:5632
  ds_read_b128 v[156:159], v218 offset:5888
  ds_read_b32 v168, v219 offset:4096
  ds_read_b32 v169, v219 offset:4224
  s_add_u32 s77, s77, 2
  v_mov_b32 v212, s77
  s_waitcnt lgkmcnt(9)
  v_mfma_f32_32x32x16_bf16 v[80:95], v[128:131], a[144:147], 0
  s_waitcnt lgkmcnt(8)
  v_mfma_f32_32x32x16_bf16 v[80:95], v[132:135], a[148:151], v[80:95]
  s_waitcnt lgkmcnt(7)
  v_mfma_f32_32x32x16_bf16 v[80:95], v[136:139], a[152:155], v[80:95]
  s_waitcnt lgkmcnt(6)
  v_mfma_f32_32x32x16_bf16 v[80:95], v[140:143], a[156:159], v[80:95]
  s_mov_b64 exec, 1
  buffer_store_dword v212, v201, s[8:11], s71 offen sc1
  s_mov_b64 exec, -1
  s_waitcnt lgkmcnt(5)
  v_mfma_f32_32x32x16_bf16 v[80:95], v[144:147], a[160:163], v[80:95]
  s_waitcnt lgkmcnt(4)
  v_mfma_f32_32x32x16_bf16 v[80:95], v[148:151], a[164:167], v[80:95]
  s_waitcnt lgkmcnt(3)
  v_mfma_f32_32x32x16_bf16 v[80:95], v[152:155], a[168:171], v[80:95]
  s_waitcnt lgkmcnt(2)
  v_mfma_f32_32x32x16_bf16 v[80:95], v[156:159], a[172:175], v[80:95]
  s_nop 11
  v_mul_f32 v80, s68, v80
  v_mul_f32 v81, s68, v81
  v_mul_f32 v82, s68, v82
  v_mul_f32 v83, s68, v83
  v_max3_f32 v84, v184, v80, v81
  v_max3_f32 v84, v84, v82, v83
  v_mov_b32 v85, v84
  s_nop 1
  v_permlane32_swap_b32 v84, v85
  v_max_f32 v84, v84, v85
  v_sub_f32 v86, v184, v84
  v_sub_f32 v80, v80, v84
  v_sub_f32 v81, v81, v84
  v_sub_f32 v82, v82, v84
  v_sub_f32 v83, v83, v84
  v_exp_f32 v86, v86
  v_exp_f32 v80, v80
  v_exp_f32 v81, v81
  v_exp_f32 v82, v82
  v_exp_f32 v83, v83
  v_fma_f32 v186, v186, v86, v80
  v_add_f32 v84, v81, v82
  v_add_f32 v186, v186, v83
  v_add_f32 v186, v186, v84
  v_mov_b32 v187, v186
  s_nop 1
  v_permlane32_swap_b32 v186, v187
  v_add_f32 v186, v186, v187
  v_rcp_f32 v186, v186
  s_nop 0
  v_mul_f32 v86, v86, v186
  v_mul_f32 v80, v186, v80
  v_mul_f32 v81, v186, v81
  v_mul_f32 v82, v186, v82
  v_mul_f32 v83, v186, v83
  v_cvt_pk_bf16_f32 v28, v80, v81
  v_cvt_pk_bf16_f32 v29, v82, v83
  v_mul_f32 v224, v86, v224
  v_mul_f32 v225, v86, v225
  v_mul_f32 v226, v86, v226
  v_mul_f32 v227, v86, v227
  v_mul_f32 v228, v86, v228
  v_mul_f32 v229, v86, v229
  v_mul_f32 v230, v86, v230
  v_mul_f32 v231, v86, v231
  v_mul_f32 v232, v86, v232
  v_mul_f32 v233, v86, v233
  v_mul_f32 v234, v86, v234
  v_mul_f32 v235, v86, v235
  v_mul_f32 v236, v86, v236
  v_mul_f32 v237, v86, v237
  v_mul_f32 v238, v86, v238
  v_mul_f32 v239, v86, v239
  s_waitcnt lgkmcnt(0)
  s_nop 0
  v_mfma_f32_32x32x8_bf16 v[224:239], v[168:169], v[28:29], v[224:239]
  s_nop 11
  v_cvt_pk_bf16_f32 v20, v224, v225
  v_cvt_pk_bf16_f32 v21, v226, v227
  v_cvt_pk_bf16_f32 v22, v228, v229
  v_cvt_pk_bf16_f32 v23, v230, v231
  buffer_store_dwordx4 v[20:23], v201, s[8:11], s75 offen offset:0 sc1
  v_cvt_pk_bf16_f32 v24, v232, v233
  v_cvt_pk_bf16_f32 v25, v234, v235
  v_cvt_pk_bf16_f32 v26, v236, v237
  v_cvt_pk_bf16_f32 v27, v238, v239
  buffer_store_dwordx4 v[24:27], v201, s[8:11], s75 offen offset:1024 sc1
  s_cmp_ge_u32 s77, 64
  s_cbranch_scc1 L_exit
  s_branch AT_loop
L_cexit:
  s_or_b32 s54, s52, s53
  s_cmp_eq_u32 s54, 0
  s_cbranch_scc0 L_nwb
  s_waitcnt vmcnt(0)
  buffer_wbl2 sc1
L_nwb:
L_exit:
L_end:
s_endpgm
.section .rodata,"a"
.p2align 6
.amdhsa_kernel gated_mix__sliding_local_dilated__memory_aug_recurrent_mem_tr__prompt_kernel
  .amdhsa_next_free_vgpr 512
  .amdhsa_next_free_sgpr 102
  .amdhsa_accum_offset 256
  .amdhsa_group_segment_fixed_size 0
  .amdhsa_kernarg_size 112
  .amdhsa_user_sgpr_count 2
  .amdhsa_user_sgpr_kernarg_segment_ptr 1
  .amdhsa_system_sgpr_workgroup_id_x 1
.end_amdhsa_kernel
```

```asm
; @launch grid=(256,1,1) block=(256,1,1) lds=163840
.amdgcn_target "amdgcn-amd-amdhsa--gfx950"
.text
.globl gated_mix__sliding_local_dilated__memory_aug_recurrent_mem_tr__prompt_kernel
.p2align 8
.type gated_mix__sliding_local_dilated__memory_aug_recurrent_mem_tr__prompt_kernel,@function
gated_mix__sliding_local_dilated__memory_aug_recurrent_mem_tr__prompt_kernel:
  s_cmp_ge_u32 s2, 256
  s_cbranch_scc1 L_end
  s_load_dwordx2 s[4:5], s[0:1], 0
  s_load_dwordx2 s[8:9], s[0:1], 104
  s_load_dwordx2 s[12:13], s[0:1], 96
  s_load_dwordx2 s[16:17], s[0:1], 40
  s_load_dwordx2 s[20:21], s[0:1], 48
  s_load_dwordx2 s[24:25], s[0:1], 56
  s_load_dwordx2 s[28:29], s[0:1], 64
  s_load_dwordx2 s[32:33], s[0:1], 32
  s_load_dwordx2 s[36:37], s[0:1], 8
  s_load_dwordx2 s[40:41], s[0:1], 16
  s_load_dwordx2 s[44:45], s[0:1], 80
  s_load_dwordx2 s[48:49], s[0:1], 88
  s_getreg_b32 s54, hwreg(HW_REG_XCC_ID, 0, 3)
  v_lshrrev_b32 v1, 6, v0
  s_nop 0
  v_readfirstlane_b32 s52, v1
  s_mov_b32 s6, 2359296
  s_mov_b32 s7, 0x20000
  s_mov_b32 s10, 268435456
  s_mov_b32 s11, 0x20000
  s_mov_b32 s14, 256
  s_mov_b32 s15, 0x20000
  s_mov_b32 s18, 4718592
  s_mov_b32 s19, 0x20000
  s_mov_b32 s22, 4718592
  s_mov_b32 s23, 0x20000
  s_mov_b32 s26, 4718592
  s_mov_b32 s27, 0x20000
  s_mov_b32 s30, 4718592
  s_mov_b32 s31, 0x20000
  s_mov_b32 s34, 9216
  s_mov_b32 s35, 0x20000
  s_mov_b32 s38, 1990656
  s_mov_b32 s39, 0x20000
  s_mov_b32 s42, 663552
  s_mov_b32 s43, 0x20000
  s_mov_b32 s46, 1152
  s_mov_b32 s47, 0x20000
  s_mov_b32 s50, 2359296
  s_mov_b32 s51, 0x20000
  s_waitcnt lgkmcnt(0)
  s_lshr_b32 s0, s2, 3
  s_mov_b32 s2, s54
  s_mov_b32 s1, 0
L_role:
  s_mov_b32 s53, s0
  s_cmp_eq_u32 s2, 0
  s_cbranch_scc0 L_worker
  v_and_b32 v0, 63, v0
  v_and_b32 v1, 15, v0
  v_lshrrev_b32 v2, 4, v0
  v_and_b32 v3, 1, v2
  s_lshl_b32 s54, s52, 1
  v_add_u32 v3, s54, v3
  v_lshlrev_b32 v3, 1, v3
  v_xor_b32 v3, v3, v1
  v_lshlrev_b32 v3, 4, v3
  v_lshl_add_u32 v8, v2, 13, v3
  s_lshl_b32 s78, s53, 8
  s_lshl_b32 s54, s52, 15
  s_add_u32 s78, s78, s54
  s_mul_i32 s79, s53, 147456
  s_lshl_b32 s57, s52, 10
  s_add_u32 s57, s57, 16384
  s_getpc_b64 s[80:81]
L_pc_1:
  s_and_b32 s55, s0, 1
  s_lshl_b32 s55, s55, 2
  s_add_u32 s55, s55, s52
  s_lshl_b32 s55, s55, 10
  v_and_b32 v199, 63, v0
  v_lshl_add_u32 v199, v199, 4, s55
  v_min_u32 v199, (L_w0 - L_pc_1), v199
  global_load_dword v196, v199, s[80:81]
  s_add_u32 m0, s57, 0
  s_add_u32 s54, s78, 0
  buffer_load_dwordx4 v8, s[16:19], s54 offen  lds
  s_add_u32 m0, s57, 4096
  s_add_u32 s54, s78, 131072
  buffer_load_dwordx4 v8, s[16:19], s54 offen  lds
  s_add_u32 m0, s57, 8192
  s_add_u32 s54, s78, 262144
  buffer_load_dwordx4 v8, s[16:19], s54 offen  lds
  s_add_u32 m0, s57, 12288
  s_add_u32 s54, s78, 393216
  buffer_load_dwordx4 v8, s[16:19], s54 offen  lds
  s_add_u32 m0, s57, 16384
  s_add_u32 s54, s78, 524288
  buffer_load_dwordx4 v8, s[16:19], s54 offen  lds
  s_add_u32 m0, s57, 20480
  s_add_u32 s54, s78, 655360
  buffer_load_dwordx4 v8, s[16:19], s54 offen  lds
  s_add_u32 m0, s57, 24576
  s_add_u32 s54, s78, 786432
  buffer_load_dwordx4 v8, s[16:19], s54 offen  lds
  s_add_u32 m0, s57, 28672
  s_add_u32 s54, s78, 917504
  buffer_load_dwordx4 v8, s[16:19], s54 offen  lds
  s_add_u32 m0, s57, 32768
  s_add_u32 s54, s78, 1048576
  buffer_load_dwordx4 v8, s[16:19], s54 offen  lds
  s_add_u32 m0, s57, 36864
  s_add_u32 s54, s78, 1179648
  buffer_load_dwordx4 v8, s[16:19], s54 offen  lds
  s_add_u32 m0, s57, 40960
  s_add_u32 s54, s78, 1310720
  buffer_load_dwordx4 v8, s[16:19], s54 offen  lds
  s_add_u32 m0, s57, 45056
  s_add_u32 s54, s78, 1441792
  buffer_load_dwordx4 v8, s[16:19], s54 offen  lds
  s_add_u32 m0, s57, 49152
  s_add_u32 s54, s78, 1572864
  buffer_load_dwordx4 v8, s[16:19], s54 offen  lds
  s_add_u32 m0, s57, 53248
  s_add_u32 s54, s78, 1703936
  buffer_load_dwordx4 v8, s[16:19], s54 offen  lds
  s_add_u32 m0, s57, 57344
  s_add_u32 s54, s78, 1835008
  buffer_load_dwordx4 v8, s[16:19], s54 offen  lds
  s_add_u32 m0, s57, 61440
  s_add_u32 s54, s78, 1966080
  buffer_load_dwordx4 v8, s[16:19], s54 offen  lds
  v_lshlrev_b32 v76, 4, v0
  v_add_u32 v75, 0x10000, v76
  v_lshrrev_b32 v3, 2, v1
  v_and_b32 v4, 1, v1
  v_lshl_add_u32 v3, v3, 1, v4
  v_bfe_u32 v4, v1, 1, 1
  v_mul_u32_u24 v74, 0xaaaa, v4
  v_add_u32 v74, 0x4444, v74
  v_mul_u32_u24 v5, 576, v3
  v_add_u32 v5, 0, v5
  v_lshl_add_u32 v78, v2, 4, v5
  v_lshl_add_u32 v77, v2, 5, v5
  v_lshl_add_u32 v77, v4, 4, v77
  v_mul_u32_u24 v15, 1152, v3
  v_lshl_add_u32 v15, v2, 5, v15
  v_lshl_add_u32 v15, v4, 4, v15
  s_lshl_b32 s54, s52, 8
  buffer_load_dwordx4 v[20:23], v15, s[32:35], s54 offen
  buffer_load_dwordx4 v[24:27], v15, s[32:35], s54 offen offset:128
  buffer_load_dwordx4 v[28:31], v15, s[32:35], 0 offen offset:1024
  v_mul_u32_u24 v79, 1152, v2
  v_lshl_add_u32 v79, v1, 2, v79
  s_lshl_b32 s54, s52, 6
  s_add_u32 s54, s54, 0
  v_add_u32 v79, s54, v79
  v_lshrrev_b32 v5, 3, v0
  v_mul_u32_u24 v68, 2176, v5
  v_and_b32 v5, 7, v0
  v_lshl_add_u32 v68, v5, 3, v68
  v_lshrrev_b32 v6, 3, v0
  s_lshr_b32 s54, s53, 2
  v_add_u32 v68, s54, v6
  v_and_b32 v68, 7, v68
  v_xor_b32 v68, v68, v6
  v_lshlrev_b32 v68, 8, v68
  v_lshl_add_u32 v68, v6, 12, v68
  v_lshl_add_u32 v68, v5, 3, v68
  s_and_b32 s54, s53, 3
  s_lshl_b32 s54, s54, 6
  v_add_u32 v68, s54, v68
  v_and_b32 v5, 1, v2
  v_lshlrev_b32 v5, 4, v5
  v_lshl_add_u32 v5, v1, 2, v5
  v_mov_b32 v6, 0x40000000
  v_cmp_lt_u32 vcc, 3, v1
  s_nop 1
  v_cndmask_b32 v5, v5, v6, vcc
  v_lshrrev_b32 v6, 1, v2
  v_lshl_add_u32 v69, v6, 10, v5
  v_lshl_add_u32 v70, v6, 8, v5
  v_mov_b32 v71, -1
  ds_write_b128 v76, v[68:71] offset:13824
  v_and_b32 v5, 3, v1
  v_lshrrev_b32 v6, 2, v1
  v_lshl_add_u32 v5, v5, 2, v6
  v_and_b32 v6, 1, v5
  v_lshlrev_b32 v6, 4, v6
  v_mov_b32 v7, 0x3f80
  v_lshlrev_b32 v6, v6, v7
  v_lshrrev_b32 v5, 1, v5
  v_cmp_eq_u32 vcc, 0, v5
  s_nop 1
  v_cndmask_b32 v40, 0, v6, vcc
  v_cmp_eq_u32 vcc, 1, v5
  s_nop 1
  v_cndmask_b32 v41, 0, v6, vcc
  v_cmp_eq_u32 vcc, 2, v5
  s_nop 1
  v_cndmask_b32 v42, 0, v6, vcc
  v_cmp_eq_u32 vcc, 3, v5
  s_nop 1
  v_cndmask_b32 v43, 0, v6, vcc
  ds_write_b128 v76, v[40:43] offset:14848
  s_and_b32 s54, s52, 1
  s_lshr_b32 s55, s52, 1
  v_lshrrev_b32 v3, 3, v0
  v_and_b32 v4, 1, v3
  v_lshlrev_b32 v4, 4, v4
  v_and_b32 v5, 6, v3
  v_add_u32 v4, v4, v5
  s_lshl_b32 s56, s55, 3
  s_add_u32 s56, s56, s54
  v_add_u32 v4, s56, v4
  v_mul_u32_u24 v4, 1152, v4
  v_and_b32 v5, 2, v3
  v_lshlrev_b32 v5, 1, v5
  v_and_b32 v6, 7, v0
  v_xor_b32 v6, v6, v5
  v_lshl_add_u32 v9, v6, 4, v4
  v_and_b32 v4, 1, v2
  v_lshlrev_b32 v4, 4, v4
  v_and_b32 v5, 2, v2
  v_add_u32 v4, v4, v5
  s_lshl_b32 s56, s55, 2
  s_add_u32 s56, s56, s54
  v_add_u32 v4, s56, v4
  v_mul_u32_u24 v4, 1152, v4
  v_lshlrev_b32 v6, 1, v2
  v_xor_b32 v6, v6, v1
  v_lshl_add_u32 v10, v6, 4, v4
  v_bfe_u32 v17, v1, 2, 1
  v_bfe_u32 v18, v1, 3, 1
  v_and_b32 v19, 1, v2
  v_lshrrev_b32 v72, 1, v2
  v_and_b32 v73, 3, v1
  v_lshl_add_u32 v3, v19, 1, v17
  v_lshl_add_u32 v6, v18, 2, v3
  v_lshl_add_u32 v4, v72, 4, v17
  v_lshl_add_u32 v4, v19, 2, v4
  v_lshl_add_u32 v4, v18, 3, v4
  v_lshlrev_b32 v4, 8, v4
  s_lshl_b32 s54, s52, 6
  v_lshl_add_u32 v5, v73, 3, s54
  v_lshlrev_b32 v7, 5, v6
  v_xor_b32 v5, v5, v7
  v_add_u32 v11, v4, v5
  v_xor_b32 v12, 32, v11
  v_lshl_add_u32 v4, v72, 2, v3
  v_lshlrev_b32 v4, 7, v4
  v_lshl_add_u32 v4, v73, 3, v4
  s_and_b32 s54, s52, 1
  v_xor_b32 v7, s54, v19
  v_lshl_add_u32 v7, v7, 1, v18
  v_lshl_add_u32 v13, v7, 5, v4
  v_lshlrev_b32 v4, 11, v72
  v_lshl_add_u32 v4, v73, 3, v4
  v_lshl_add_u32 v5, v3, 8, v4
  v_lshl_add_u32 v7, v18, 2, s52
  v_xor_b32 v7, v7, v3
  v_lshl_add_u32 v14, v7, 5, v5
  s_lshl_b32 s54, s53, 14
  s_lshl_b32 s55, s52, 11
  s_add_u32 s54, s54, 1048576
  s_add_u32 s58, s54, s55
  s_add_u32 s59, s58, 8192
  s_lshl_b32 s55, s52, 12
  s_add_u32 s70, s54, s55
  s_add_u32 s70, s70, 655360
  s_lshl_b32 s54, s53, 12
  s_lshl_b32 s55, s52, 10
  s_add_u32 s54, s54, s55
  s_add_u32 s68, s54, 917504
  s_lshl_b32 s54, s53, 6
  s_mul_i32 s55, s52, 17408
  s_add_u32 s55, s54, s55
  s_add_u32 s73, s55, 0
  s_add_u32 s74, s55, 69632
  s_add_u32 s75, s55, 139264
  s_add_u32 s76, s55, 208896
  s_and_b32 s56, s52, 1
  s_mul_i32 s55, s56, 17408
  s_add_u32 s55, s54, s55
  s_add_u32 s77, s55, 278528
  s_mul_i32 s54, s52, 69632
  s_mul_i32 s55, s53, 2176
  s_add_u32 s54, s54, s55
  s_add_u32 s60, s54, 0
  s_and_b32 s56, s53, 15
  s_mul_i32 s55, s56, 2176
  s_add_u32 s61, s55, 278528
  s_lshr_b32 s54, s52, 1
  s_lshl_b32 s54, s54, 15
  s_and_b32 s55, s52, 1
  s_lshl_b32 s55, s55, 11
  s_add_u32 s54, s54, s55
  s_add_u32 s73, s54, 0
  s_add_u32 s74, s54, 65536
  s_add_u32 s75, s54, 131072
  s_add_u32 s76, s54, 196608
  s_add_u32 s77, s55, 262144
  s_and_b32 s54, s53, 7
  s_lshl_b32 s54, s54, 12
  s_bfe_u32 s55, s53, 0x10003
  s_lshl_b32 s55, s55, 11
  s_add_u32 s54, s54, s55
  s_add_u32 s61, s54, 262144
  s_lshr_b32 s55, s53, 4
  s_lshl_b32 s55, s55, 15
  s_add_u32 s54, s54, s55
  s_lshl_b32 s55, s52, 16
  s_add_u32 s54, s54, s55
  s_add_u32 s60, s54, 0
  s_lshl_b32 s54, s52, 11
  s_add_u32 s64, s54, 360448
  s_mov_b32 s65, 368640
  s_lshl_b32 s55, s53, 5
  s_add_u32 s54, s54, s55
  s_add_u32 s62, s54, 376832
  s_lshr_b32 s54, s56, 3
  s_lshl_b32 s54, s54, 9
  s_and_b32 s55, s56, 7
  s_lshl_b32 s55, s55, 5
  s_add_u32 s54, s54, s55
  s_add_u32 s63, s54, 385024
  s_mov_b32 s66, 0
  s_mov_b32 s67, 0
  s_mov_b32 s72, 0
  s_mov_b32 s69, 1040356334
  s_waitcnt vmcnt(15) lgkmcnt(0)
  s_barrier
  s_add_u32 m0, s57, 65536
  s_add_u32 s54, s78, 2097152
  buffer_load_dwordx4 v8, s[16:19], s54 offen  lds
  s_add_u32 m0, s57, 69632
  s_add_u32 s54, s78, 2228224
  buffer_load_dwordx4 v8, s[16:19], s54 offen  lds
  s_add_u32 m0, s57, 73728
  s_add_u32 s54, s78, 2359296
  buffer_load_dwordx4 v8, s[16:19], s54 offen  lds
  s_add_u32 m0, s57, 77824
  s_add_u32 s54, s78, 2490368
  buffer_load_dwordx4 v8, s[16:19], s54 offen  lds
  s_lshl_b32 s55, s2, 2
  s_or_b32 s56, s52, s1
  s_cmp_eq_u32 s56, 0
  s_cselect_b32 s55, s55, 0x1000
  s_lshl_b32 s56, 1, s0
  v_mov_b32 v35, s56
  s_mov_b64 exec, 1
  buffer_atomic_or v35, off, s[12:15], s55 sc0
  s_mov_b64 exec, -1
  v_add_u32 v15, 16384, v11
  v_add_u32 v16, 16384, v12
  ds_read_b64_tr_b16 v[80:81], v15 offset:0
  ds_read_b64_tr_b16 v[82:83], v15 offset:512
  ds_read_b64_tr_b16 v[84:85], v15 offset:8192
  ds_read_b64_tr_b16 v[86:87], v15 offset:8704
  ds_read_b64_tr_b16 v[88:89], v16 offset:0
  ds_read_b64_tr_b16 v[90:91], v16 offset:512
  ds_read_b64_tr_b16 v[92:93], v16 offset:8192
  ds_read_b64_tr_b16 v[94:95], v16 offset:8704
  s_waitcnt vmcnt(16) lgkmcnt(0)
  s_barrier
  s_add_u32 m0, s57, 81920
  s_add_u32 s54, s78, 2621440
  buffer_load_dwordx4 v8, s[16:19], s54 offen  lds
  s_add_u32 m0, s57, 86016
  s_add_u32 s54, s78, 2752512
  buffer_load_dwordx4 v8, s[16:19], s54 offen  lds
  s_add_u32 m0, s57, 90112
  s_add_u32 s54, s78, 2883584
  buffer_load_dwordx4 v8, s[16:19], s54 offen  lds
  s_add_u32 m0, s57, 94208
  s_add_u32 s54, s78, 3014656
  buffer_load_dwordx4 v8, s[16:19], s54 offen  lds
  v_add_u32 v15, 32768, v11
  v_add_u32 v16, 32768, v12
  ds_read_b64_tr_b16 v[96:97], v15 offset:0
  ds_read_b64_tr_b16 v[98:99], v15 offset:512
  ds_read_b64_tr_b16 v[100:101], v15 offset:8192
  ds_read_b64_tr_b16 v[102:103], v15 offset:8704
  ds_read_b64_tr_b16 v[104:105], v16 offset:0
  ds_read_b64_tr_b16 v[106:107], v16 offset:512
  ds_read_b64_tr_b16 v[108:109], v16 offset:8192
  ds_read_b64_tr_b16 v[110:111], v16 offset:8704
  s_waitcnt vmcnt(16) lgkmcnt(0)
  s_barrier
  s_add_u32 m0, s57, 98304
  s_add_u32 s54, s78, 3670016
  buffer_load_dwordx4 v8, s[16:19], s54 offen  lds
  s_add_u32 m0, s57, 102400
  s_add_u32 s54, s78, 3801088
  buffer_load_dwordx4 v8, s[16:19], s54 offen  lds
  s_add_u32 m0, s57, 106496
  s_add_u32 s54, s78, 3932160
  buffer_load_dwordx4 v8, s[16:19], s54 offen  lds
  s_add_u32 m0, s57, 110592
  s_add_u32 s54, s78, 4063232
  buffer_load_dwordx4 v8, s[16:19], s54 offen  lds
  v_add_u32 v15, 49152, v11
  v_add_u32 v16, 49152, v12
  ds_read_b64_tr_b16 v[112:113], v15 offset:0
  ds_read_b64_tr_b16 v[114:115], v15 offset:512
  ds_read_b64_tr_b16 v[116:117], v15 offset:8192
  ds_read_b64_tr_b16 v[118:119], v15 offset:8704
  ds_read_b64_tr_b16 v[120:121], v16 offset:0
  ds_read_b64_tr_b16 v[122:123], v16 offset:512
  ds_read_b64_tr_b16 v[124:125], v16 offset:8192
  ds_read_b64_tr_b16 v[126:127], v16 offset:8704
  s_waitcnt vmcnt(16) lgkmcnt(0)
  s_barrier
  s_add_u32 m0, s57, 114688
  s_add_u32 s54, s78, 4194304
  buffer_load_dwordx4 v8, s[16:19], s54 offen  lds
  s_add_u32 m0, s57, 118784
  s_add_u32 s54, s78, 4325376
  buffer_load_dwordx4 v8, s[16:19], s54 offen  lds
  s_add_u32 m0, s57, 122880
  s_add_u32 s54, s78, 4456448
  buffer_load_dwordx4 v8, s[16:19], s54 offen  lds
  s_add_u32 m0, s57, 126976
  s_add_u32 s54, s78, 4587520
  buffer_load_dwordx4 v8, s[16:19], s54 offen  lds
  v_add_u32 v15, 65536, v11
  v_add_u32 v16, 65536, v12
  ds_read_b64_tr_b16 v[128:129], v15 offset:0
  ds_read_b64_tr_b16 v[130:131], v15 offset:512
  ds_read_b64_tr_b16 v[132:133], v15 offset:8192
  ds_read_b64_tr_b16 v[134:135], v15 offset:8704
  ds_read_b64_tr_b16 v[136:137], v16 offset:0
  ds_read_b64_tr_b16 v[138:139], v16 offset:512
  ds_read_b64_tr_b16 v[140:141], v16 offset:8192
  ds_read_b64_tr_b16 v[142:143], v16 offset:8704
  s_waitcnt vmcnt(13) lgkmcnt(0)
  s_barrier
  s_add_u32 m0, s57, 131072
  s_add_u32 s54, s78, 1048576
  buffer_load_dwordx4 v8, s[20:23], s54 offen  lds
  s_add_u32 m0, s57, 135168
  s_add_u32 s54, s78, 1179648
  buffer_load_dwordx4 v8, s[20:23], s54 offen  lds
  s_add_u32 m0, s57, 139264
  s_add_u32 s54, s78, 1310720
  buffer_load_dwordx4 v8, s[20:23], s54 offen  lds
  s_add_u32 m0, s57, 143360
  s_add_u32 s54, s78, 1441792
  buffer_load_dwordx4 v8, s[20:23], s54 offen  lds
  v_add_u32 v15, 81920, v11
  v_add_u32 v16, 81920, v12
  ds_read_b64_tr_b16 v[144:145], v15 offset:0
  ds_read_b64_tr_b16 v[146:147], v15 offset:512
  ds_read_b64_tr_b16 v[148:149], v15 offset:8192
  ds_read_b64_tr_b16 v[150:151], v15 offset:8704
  ds_read_b64_tr_b16 v[152:153], v16 offset:0
  ds_read_b64_tr_b16 v[154:155], v16 offset:512
  ds_read_b64_tr_b16 v[156:157], v16 offset:8192
  ds_read_b64_tr_b16 v[158:159], v16 offset:8704
  s_waitcnt vmcnt(12) lgkmcnt(0)
  s_barrier
  s_add_u32 m0, s57, 0
  s_add_u32 s54, s78, 1572864
  buffer_load_dwordx4 v8, s[20:23], s54 offen  lds
  s_add_u32 m0, s57, 4096
  s_add_u32 s54, s78, 1703936
  buffer_load_dwordx4 v8, s[20:23], s54 offen  lds
  s_add_u32 m0, s57, 8192
  s_add_u32 s54, s78, 1835008
  buffer_load_dwordx4 v8, s[20:23], s54 offen  lds
  s_add_u32 m0, s57, 12288
  s_add_u32 s54, s78, 1966080
  buffer_load_dwordx4 v8, s[20:23], s54 offen  lds
  v_add_u32 v15, 98304, v11
  v_add_u32 v16, 98304, v12
  ds_read_b64_tr_b16 v[160:161], v15 offset:0
  ds_read_b64_tr_b16 v[162:163], v15 offset:512
  ds_read_b64_tr_b16 v[164:165], v15 offset:8192
  ds_read_b64_tr_b16 v[166:167], v15 offset:8704
  ds_read_b64_tr_b16 v[168:169], v16 offset:0
  ds_read_b64_tr_b16 v[170:171], v16 offset:512
  ds_read_b64_tr_b16 v[172:173], v16 offset:8192
  ds_read_b64_tr_b16 v[174:175], v16 offset:8704
  s_waitcnt vmcnt(12) lgkmcnt(0)
  s_barrier
  s_add_u32 m0, s57, 16384
  s_add_u32 s54, s78, 3145728
  buffer_load_dwordx4 v8, s[20:23], s54 offen  lds
  s_add_u32 m0, s57, 20480
  s_add_u32 s54, s78, 3276800
  buffer_load_dwordx4 v8, s[20:23], s54 offen  lds
  s_add_u32 m0, s57, 24576
  s_add_u32 s54, s78, 3407872
  buffer_load_dwordx4 v8, s[20:23], s54 offen  lds
  s_add_u32 m0, s57, 28672
  s_add_u32 s54, s78, 3538944
  buffer_load_dwordx4 v8, s[20:23], s54 offen  lds
  v_add_u32 v15, 114688, v11
  v_add_u32 v16, 114688, v12
  ds_read_b64_tr_b16 v[176:177], v15 offset:0
  ds_read_b64_tr_b16 v[178:179], v15 offset:512
  ds_read_b64_tr_b16 v[180:181], v15 offset:8192
  ds_read_b64_tr_b16 v[182:183], v15 offset:8704
  ds_read_b64_tr_b16 v[184:185], v16 offset:0
  ds_read_b64_tr_b16 v[186:187], v16 offset:512
  ds_read_b64_tr_b16 v[188:189], v16 offset:8192
  ds_read_b64_tr_b16 v[190:191], v16 offset:8704
  s_waitcnt vmcnt(12) lgkmcnt(0)
  s_barrier
  s_add_u32 m0, s57, 32768
  s_add_u32 s54, s78, 3670016
  buffer_load_dwordx4 v8, s[20:23], s54 offen  lds
  s_add_u32 m0, s57, 36864
  s_add_u32 s54, s78, 3801088
  buffer_load_dwordx4 v8, s[20:23], s54 offen  lds
  s_add_u32 m0, s57, 40960
  s_add_u32 s54, s78, 3932160
  buffer_load_dwordx4 v8, s[20:23], s54 offen  lds
  s_add_u32 m0, s57, 45056
  s_add_u32 s54, s78, 4063232
  buffer_load_dwordx4 v8, s[20:23], s54 offen  lds
  v_add_u32 v15, 131072, v11
  v_add_u32 v16, 131072, v12
  ds_read_b64_tr_b16 v[192:193], v15 offset:0
  ds_read_b64_tr_b16 v[194:195], v15 offset:512
  ds_read_b64_tr_b16 v[196:197], v15 offset:8192
  ds_read_b64_tr_b16 v[198:199], v15 offset:8704
  ds_read_b64_tr_b16 v[200:201], v16 offset:0
  ds_read_b64_tr_b16 v[202:203], v16 offset:512
  ds_read_b64_tr_b16 v[204:205], v16 offset:8192
  ds_read_b64_tr_b16 v[206:207], v16 offset:8704
  s_waitcnt vmcnt(12) lgkmcnt(0)
  s_barrier
  s_add_u32 m0, s57, 49152
  s_add_u32 s54, s78, 4194304
  buffer_load_dwordx4 v8, s[20:23], s54 offen  lds
  s_add_u32 m0, s57, 53248
  s_add_u32 s54, s78, 4325376
  buffer_load_dwordx4 v8, s[20:23], s54 offen  lds
  s_add_u32 m0, s57, 57344
  s_add_u32 s54, s78, 4456448
  buffer_load_dwordx4 v8, s[20:23], s54 offen  lds
  s_add_u32 m0, s57, 61440
  s_add_u32 s54, s78, 4587520
  buffer_load_dwordx4 v8, s[20:23], s54 offen  lds
  s_getpc_b64 s[80:81]
  s_lshl_b32 s54, s52, 10
  v_add_u32 v7, s54, v76
  global_load_dword v19, v7, s[80:81] offset:1024
  s_cmp_eq_u32 s1, 1
  s_cbranch_scc1 C_ver_ok
  v_mov_b32 v33, 16320
  s_cmp_eq_u32 s52, 0
  s_cbranch_scc0 C_ver_b
  s_waitcnt vmcnt(33)
  s_mov_b64 exec, 1
  ds_write_b32 v33, v35
  s_mov_b64 exec, -1
  s_waitcnt lgkmcnt(0)
C_ver_b:
  s_barrier
  ds_read_b32 v32, v33
  s_waitcnt lgkmcnt(0)
  v_readfirstlane_b32 s54, v32
  s_nop 0
  s_bitcmp1_b32 s54, s0
  s_cbranch_scc1 L_conf
C_ver_ok:
  v_min_u32 v20, -2, v20
  v_min_u32 v21, -2, v21
  v_min_u32 v22, -2, v22
  v_min_u32 v23, -2, v23
  v_min_u32 v24, -2, v24
  v_min_u32 v25, -2, v25
  v_min_u32 v26, -2, v26
  v_min_u32 v27, -2, v27
  v_min_u32 v28, -2, v28
  v_min_u32 v29, -2, v29
  v_min_u32 v30, -2, v30
  v_min_u32 v31, -2, v31
  s_lshl_b32 s54, s52, 11
  v_add_u32 v3, s54, v76
  ds_write_b128 v3, v[20:23] offset:4608
  ds_write_b128 v3, v[24:27] offset:5632
  ds_write_b128 v76, v[28:31] offset:12800
  v_add_u32 v15, 147456, v11
  v_add_u32 v16, 147456, v12
  ds_read_b64_tr_b16 v[208:209], v15 offset:0
  ds_read_b64_tr_b16 v[210:211], v15 offset:512
  ds_read_b64_tr_b16 v[212:213], v15 offset:8192
  ds_read_b64_tr_b16 v[214:215], v15 offset:8704
  ds_read_b64_tr_b16 v[216:217], v16 offset:0
  ds_read_b64_tr_b16 v[218:219], v16 offset:512
  ds_read_b64_tr_b16 v[220:221], v16 offset:8192
  ds_read_b64_tr_b16 v[222:223], v16 offset:8704
  s_waitcnt vmcnt(13) lgkmcnt(0)
  s_barrier
  s_add_u32 m0, s57, 65536
  s_add_u32 s54, s78, 0
  buffer_load_dwordx4 v8, s[24:27], s54 offen  lds
  s_add_u32 m0, s57, 69632
  s_add_u32 s54, s78, 131072
  buffer_load_dwordx4 v8, s[24:27], s54 offen  lds
  s_add_u32 m0, s57, 73728
  s_add_u32 s54, s78, 262144
  buffer_load_dwordx4 v8, s[24:27], s54 offen  lds
  s_add_u32 m0, s57, 77824
  s_add_u32 s54, s78, 393216
  buffer_load_dwordx4 v8, s[24:27], s54 offen  lds
  v_add_u32 v15, 16384, v11
  v_add_u32 v16, 16384, v12
  ds_read_b64_tr_b16 v[224:225], v15 offset:0
  ds_read_b64_tr_b16 v[226:227], v15 offset:512
  ds_read_b64_tr_b16 v[228:229], v15 offset:8192
  ds_read_b64_tr_b16 v[230:231], v15 offset:8704
  ds_read_b64_tr_b16 v[232:233], v16 offset:0
  ds_read_b64_tr_b16 v[234:235], v16 offset:512
  ds_read_b64_tr_b16 v[236:237], v16 offset:8192
  ds_read_b64_tr_b16 v[238:239], v16 offset:8704
  s_waitcnt vmcnt(13) lgkmcnt(0)
  s_barrier
  s_add_u32 m0, s57, 81920
  s_add_u32 s54, s78, 524288
  buffer_load_dwordx4 v8, s[24:27], s54 offen  lds
  s_add_u32 m0, s57, 86016
  s_add_u32 s54, s78, 655360
  buffer_load_dwordx4 v8, s[24:27], s54 offen  lds
  s_add_u32 m0, s57, 90112
  s_add_u32 s54, s78, 786432
  buffer_load_dwordx4 v8, s[24:27], s54 offen  lds
  s_add_u32 m0, s57, 94208
  s_add_u32 s54, s78, 917504
  buffer_load_dwordx4 v8, s[24:27], s54 offen  lds
  v_add_u32 v15, 32768, v11
  v_add_u32 v16, 32768, v12
  ds_read_b64_tr_b16 v[240:241], v15 offset:0
  ds_read_b64_tr_b16 v[242:243], v15 offset:512
  ds_read_b64_tr_b16 v[244:245], v15 offset:8192
  ds_read_b64_tr_b16 v[246:247], v15 offset:8704
  ds_read_b64_tr_b16 v[248:249], v16 offset:0
  ds_read_b64_tr_b16 v[250:251], v16 offset:512
  ds_read_b64_tr_b16 v[252:253], v16 offset:8192
  ds_read_b64_tr_b16 v[254:255], v16 offset:8704
  s_waitcnt vmcnt(13) lgkmcnt(0)
  s_barrier
  s_add_u32 m0, s57, 98304
  s_add_u32 s54, s78, 1048576
  buffer_load_dwordx4 v8, s[24:27], s54 offen  lds
  s_add_u32 m0, s57, 102400
  s_add_u32 s54, s78, 1179648
  buffer_load_dwordx4 v8, s[24:27], s54 offen  lds
  s_add_u32 m0, s57, 106496
  s_add_u32 s54, s78, 1310720
  buffer_load_dwordx4 v8, s[24:27], s54 offen  lds
  s_add_u32 m0, s57, 110592
  s_add_u32 s54, s78, 1441792
  buffer_load_dwordx4 v8, s[24:27], s54 offen  lds
  v_add_u32 v15, 49152, v11
  v_add_u32 v16, 49152, v12
  ds_read_b64_tr_b16 a[0:1], v15 offset:0
  ds_read_b64_tr_b16 a[2:3], v15 offset:512
  ds_read_b64_tr_b16 a[4:5], v15 offset:8192
  ds_read_b64_tr_b16 a[6:7], v15 offset:8704
  ds_read_b64_tr_b16 a[8:9], v16 offset:0
  ds_read_b64_tr_b16 a[10:11], v16 offset:512
  ds_read_b64_tr_b16 a[12:13], v16 offset:8192
  ds_read_b64_tr_b16 a[14:15], v16 offset:8704
  s_waitcnt vmcnt(13) lgkmcnt(0)
  s_barrier
  s_add_u32 m0, s57, 114688
  s_add_u32 s54, s78, 1572864
  buffer_load_dwordx4 v8, s[24:27], s54 offen  lds
  s_add_u32 m0, s57, 118784
  s_add_u32 s54, s78, 1703936
  buffer_load_dwordx4 v8, s[24:27], s54 offen  lds
  s_add_u32 m0, s57, 122880
  s_add_u32 s54, s78, 1835008
  buffer_load_dwordx4 v8, s[24:27], s54 offen  lds
  s_add_u32 m0, s57, 126976
  s_add_u32 s54, s78, 1966080
  buffer_load_dwordx4 v8, s[24:27], s54 offen  lds
  v_add_u32 v15, 65536, v11
  v_add_u32 v16, 65536, v12
  ds_read_b64_tr_b16 a[16:17], v15 offset:0
  ds_read_b64_tr_b16 a[18:19], v15 offset:512
  ds_read_b64_tr_b16 a[20:21], v15 offset:8192
  ds_read_b64_tr_b16 a[22:23], v15 offset:8704
  ds_read_b64_tr_b16 a[24:25], v16 offset:0
  ds_read_b64_tr_b16 a[26:27], v16 offset:512
  ds_read_b64_tr_b16 a[28:29], v16 offset:8192
  ds_read_b64_tr_b16 a[30:31], v16 offset:8704
  s_waitcnt vmcnt(12) lgkmcnt(0)
  s_barrier
  s_add_u32 m0, s57, 131072
  s_add_u32 s54, s78, 2097152
  buffer_load_dwordx4 v8, s[24:27], s54 offen  lds
  s_add_u32 m0, s57, 135168
  s_add_u32 s54, s78, 2228224
  buffer_load_dwordx4 v8, s[24:27], s54 offen  lds
  s_add_u32 m0, s57, 139264
  s_add_u32 s54, s78, 2359296
  buffer_load_dwordx4 v8, s[24:27], s54 offen  lds
  s_add_u32 m0, s57, 143360
  s_add_u32 s54, s78, 2490368
  buffer_load_dwordx4 v8, s[24:27], s54 offen  lds
  v_add_u32 v15, 81920, v11
  v_add_u32 v16, 81920, v12
  ds_read_b64_tr_b16 a[32:33], v15 offset:0
  ds_read_b64_tr_b16 a[34:35], v15 offset:512
  ds_read_b64_tr_b16 a[36:37], v15 offset:8192
  ds_read_b64_tr_b16 a[38:39], v15 offset:8704
  ds_read_b64_tr_b16 a[40:41], v16 offset:0
  ds_read_b64_tr_b16 a[42:43], v16 offset:512
  ds_read_b64_tr_b16 a[44:45], v16 offset:8192
  ds_read_b64_tr_b16 a[46:47], v16 offset:8704
  s_waitcnt vmcnt(12) lgkmcnt(0)
  s_barrier
  s_add_u32 m0, s57, 0
  s_add_u32 s54, s78, 2621440
  buffer_load_dwordx4 v8, s[24:27], s54 offen  lds
  s_add_u32 m0, s57, 4096
  s_add_u32 s54, s78, 2752512
  buffer_load_dwordx4 v8, s[24:27], s54 offen  lds
  s_add_u32 m0, s57, 8192
  s_add_u32 s54, s78, 2883584
  buffer_load_dwordx4 v8, s[24:27], s54 offen  lds
  s_add_u32 m0, s57, 12288
  s_add_u32 s54, s78, 3014656
  buffer_load_dwordx4 v8, s[24:27], s54 offen  lds
  s_getpc_b64 s[80:81]
  s_lshl_b32 s54, s52, 10
  v_add_u32 v7, s54, v76
  global_load_dword v19, v7, s[80:81] offset:1024
  v_add_u32 v15, 98304, v11
  v_add_u32 v16, 98304, v12
  ds_read_b64_tr_b16 a[48:49], v15 offset:0
  ds_read_b64_tr_b16 a[50:51], v15 offset:512
  ds_read_b64_tr_b16 a[52:53], v15 offset:8192
  ds_read_b64_tr_b16 a[54:55], v15 offset:8704
  ds_read_b64_tr_b16 a[56:57], v16 offset:0
  ds_read_b64_tr_b16 a[58:59], v16 offset:512
  ds_read_b64_tr_b16 a[60:61], v16 offset:8192
  ds_read_b64_tr_b16 a[62:63], v16 offset:8704
  s_waitcnt vmcnt(13) lgkmcnt(0)
  s_barrier
  s_add_u32 m0, s57, 16384
  s_add_u32 s54, s78, 3145728
  buffer_load_dwordx4 v8, s[24:27], s54 offen  lds
  s_add_u32 m0, s57, 20480
  s_add_u32 s54, s78, 3276800
  buffer_load_dwordx4 v8, s[24:27], s54 offen  lds
  s_add_u32 m0, s57, 24576
  s_add_u32 s54, s78, 3407872
  buffer_load_dwordx4 v8, s[24:27], s54 offen  lds
  s_add_u32 m0, s57, 28672
  s_add_u32 s54, s78, 3538944
  buffer_load_dwordx4 v8, s[24:27], s54 offen  lds
  v_add_u32 v15, 114688, v11
  v_add_u32 v16, 114688, v12
  ds_read_b64_tr_b16 a[64:65], v15 offset:0
  ds_read_b64_tr_b16 a[66:67], v15 offset:512
  ds_read_b64_tr_b16 a[68:69], v15 offset:8192
  ds_read_b64_tr_b16 a[70:71], v15 offset:8704
  ds_read_b64_tr_b16 a[72:73], v16 offset:0
  ds_read_b64_tr_b16 a[74:75], v16 offset:512
  ds_read_b64_tr_b16 a[76:77], v16 offset:8192
  ds_read_b64_tr_b16 a[78:79], v16 offset:8704
  s_waitcnt vmcnt(13) lgkmcnt(0)
  s_barrier
  s_add_u32 m0, s57, 32768
  s_add_u32 s54, s78, 3670016
  buffer_load_dwordx4 v8, s[24:27], s54 offen  lds
  s_add_u32 m0, s57, 36864
  s_add_u32 s54, s78, 3801088
  buffer_load_dwordx4 v8, s[24:27], s54 offen  lds
  s_add_u32 m0, s57, 40960
  s_add_u32 s54, s78, 3932160
  buffer_load_dwordx4 v8, s[24:27], s54 offen  lds
  s_add_u32 m0, s57, 45056
  s_add_u32 s54, s78, 4063232
  buffer_load_dwordx4 v8, s[24:27], s54 offen  lds
  v_add_u32 v15, 131072, v11
  v_add_u32 v16, 131072, v12
  ds_read_b64_tr_b16 a[80:81], v15 offset:0
  ds_read_b64_tr_b16 a[82:83], v15 offset:512
  ds_read_b64_tr_b16 a[84:85], v15 offset:8192
  ds_read_b64_tr_b16 a[86:87], v15 offset:8704
  ds_read_b64_tr_b16 a[88:89], v16 offset:0
  ds_read_b64_tr_b16 a[90:91], v16 offset:512
  ds_read_b64_tr_b16 a[92:93], v16 offset:8192
  ds_read_b64_tr_b16 a[94:95], v16 offset:8704
  s_waitcnt vmcnt(13) lgkmcnt(0)
  s_barrier
  s_add_u32 m0, s57, 49152
  s_add_u32 s54, s78, 4194304
  buffer_load_dwordx4 v8, s[24:27], s54 offen  lds
  s_add_u32 m0, s57, 53248
  s_add_u32 s54, s78, 4325376
  buffer_load_dwordx4 v8, s[24:27], s54 offen  lds
  s_add_u32 m0, s57, 57344
  s_add_u32 s54, s78, 4456448
  buffer_load_dwordx4 v8, s[24:27], s54 offen  lds
  s_add_u32 m0, s57, 61440
  s_add_u32 s54, s78, 4587520
  buffer_load_dwordx4 v8, s[24:27], s54 offen  lds
  v_add_u32 v15, 147456, v11
  v_add_u32 v16, 147456, v12
  ds_read_b64_tr_b16 a[96:97], v15 offset:0
  ds_read_b64_tr_b16 a[98:99], v15 offset:512
  ds_read_b64_tr_b16 a[100:101], v15 offset:8192
  ds_read_b64_tr_b16 a[102:103], v15 offset:8704
  ds_read_b64_tr_b16 a[104:105], v16 offset:0
  ds_read_b64_tr_b16 a[106:107], v16 offset:512
  ds_read_b64_tr_b16 a[108:109], v16 offset:8192
  ds_read_b64_tr_b16 a[110:111], v16 offset:8704
  s_waitcnt vmcnt(13) lgkmcnt(0)
  s_barrier
  s_add_u32 m0, s57, 65536
  s_add_u32 s54, s79, 73728
  buffer_load_dwordx4 v10, s[28:31], s54 offen  lds
  s_add_u32 m0, s57, 69632
  s_add_u32 s54, s79, 82944
  buffer_load_dwordx4 v10, s[28:31], s54 offen  lds
  s_add_u32 m0, s57, 73728
  s_add_u32 s54, s79, 110592
  buffer_load_dwordx4 v10, s[28:31], s54 offen  lds
  s_add_u32 m0, s57, 77824
  s_add_u32 s54, s79, 119808
  buffer_load_dwordx4 v10, s[28:31], s54 offen  lds
  v_add_u32 v15, 16384, v11
  v_add_u32 v16, 16384, v12
  ds_read_b64_tr_b16 a[112:113], v15 offset:0
  ds_read_b64_tr_b16 a[114:115], v15 offset:512
  ds_read_b64_tr_b16 a[116:117], v15 offset:8192
  ds_read_b64_tr_b16 a[118:119], v15 offset:8704
  ds_read_b64_tr_b16 a[120:121], v16 offset:0
  ds_read_b64_tr_b16 a[122:123], v16 offset:512
  ds_read_b64_tr_b16 a[124:125], v16 offset:8192
  ds_read_b64_tr_b16 a[126:127], v16 offset:8704
  s_waitcnt vmcnt(12) lgkmcnt(0)
  s_barrier
  s_add_u32 m0, s57, 81920
  s_add_u32 s54, s79, 256
  buffer_load_dwordx4 v10, s[28:31], s54 offen  lds
  s_add_u32 m0, s57, 86016
  s_add_u32 s54, s79, 9472
  buffer_load_dwordx4 v10, s[28:31], s54 offen  lds
  s_add_u32 m0, s57, 90112
  s_add_u32 s54, s79, 37120
  buffer_load_dwordx4 v10, s[28:31], s54 offen  lds
  s_add_u32 m0, s57, 94208
  s_add_u32 s54, s79, 46336
  buffer_load_dwordx4 v10, s[28:31], s54 offen  lds
  v_add_u32 v15, 32768, v11
  v_add_u32 v16, 32768, v12
  ds_read_b64_tr_b16 a[128:129], v15 offset:0
  ds_read_b64_tr_b16 a[130:131], v15 offset:512
  ds_read_b64_tr_b16 a[132:133], v15 offset:8192
  ds_read_b64_tr_b16 a[134:135], v15 offset:8704
  ds_read_b64_tr_b16 a[136:137], v16 offset:0
  ds_read_b64_tr_b16 a[138:139], v16 offset:512
  ds_read_b64_tr_b16 a[140:141], v16 offset:8192
  ds_read_b64_tr_b16 a[142:143], v16 offset:8704
  s_waitcnt vmcnt(12) lgkmcnt(0)
  s_barrier
  s_add_u32 m0, s57, 98304
  s_add_u32 s54, s79, 512
  buffer_load_dwordx4 v10, s[28:31], s54 offen  lds
  s_add_u32 m0, s57, 102400
  s_add_u32 s54, s79, 9728
  buffer_load_dwordx4 v10, s[28:31], s54 offen  lds
  s_add_u32 m0, s57, 106496
  s_add_u32 s54, s79, 37376
  buffer_load_dwordx4 v10, s[28:31], s54 offen  lds
  s_add_u32 m0, s57, 110592
  s_add_u32 s54, s79, 46592
  buffer_load_dwordx4 v10, s[28:31], s54 offen  lds
  s_getpc_b64 s[80:81]
  s_lshl_b32 s54, s52, 10
  v_add_u32 v7, s54, v76
  global_load_dword v19, v7, s[80:81] offset:1024
  v_add_u32 v15, 49152, v11
  v_add_u32 v16, 49152, v12
  ds_read_b64_tr_b16 a[144:145], v15 offset:0
  ds_read_b64_tr_b16 a[146:147], v15 offset:512
  ds_read_b64_tr_b16 a[148:149], v15 offset:8192
  ds_read_b64_tr_b16 a[150:151], v15 offset:8704
  ds_read_b64_tr_b16 a[152:153], v16 offset:0
  ds_read_b64_tr_b16 a[154:155], v16 offset:512
  ds_read_b64_tr_b16 a[156:157], v16 offset:8192
  ds_read_b64_tr_b16 a[158:159], v16 offset:8704
  s_waitcnt vmcnt(13) lgkmcnt(0)
  s_barrier
  s_add_u32 m0, s57, 114688
  s_add_u32 s54, s79, 74240
  buffer_load_dwordx4 v10, s[28:31], s54 offen  lds
  s_add_u32 m0, s57, 118784
  s_add_u32 s54, s79, 83456
  buffer_load_dwordx4 v10, s[28:31], s54 offen  lds
  s_add_u32 m0, s57, 122880
  s_add_u32 s54, s79, 111104
  buffer_load_dwordx4 v10, s[28:31], s54 offen  lds
  s_add_u32 m0, s57, 126976
  s_add_u32 s54, s79, 120320
  buffer_load_dwordx4 v10, s[28:31], s54 offen  lds
  v_add_u32 v15, 65536, v11
  v_add_u32 v16, 65536, v12
  ds_read_b64_tr_b16 a[160:161], v15 offset:0
  ds_read_b64_tr_b16 a[162:163], v15 offset:512
  ds_read_b64_tr_b16 a[164:165], v15 offset:8192
  ds_read_b64_tr_b16 a[166:167], v15 offset:8704
  ds_read_b64_tr_b16 a[168:169], v16 offset:0
  ds_read_b64_tr_b16 a[170:171], v16 offset:512
  ds_read_b64_tr_b16 a[172:173], v16 offset:8192
  ds_read_b64_tr_b16 a[174:175], v16 offset:8704
  s_waitcnt vmcnt(13) lgkmcnt(0)
  s_barrier
  s_add_u32 m0, s57, 131072
  s_add_u32 s54, s79, 74496
  buffer_load_dwordx4 v10, s[28:31], s54 offen  lds
  s_add_u32 m0, s57, 135168
  s_add_u32 s54, s79, 83712
  buffer_load_dwordx4 v10, s[28:31], s54 offen  lds
  s_add_u32 m0, s57, 139264
  s_add_u32 s54, s79, 111360
  buffer_load_dwordx4 v10, s[28:31], s54 offen  lds
  s_add_u32 m0, s57, 143360
  s_add_u32 s54, s79, 120576
  buffer_load_dwordx4 v10, s[28:31], s54 offen  lds
  v_add_u32 v15, 81920, v14
  ds_read_b64_tr_b16 a[176:177], v15 offset:0
  ds_read_b64_tr_b16 a[178:179], v15 offset:1024
  ds_read_b64_tr_b16 a[180:181], v15 offset:4096
  ds_read_b64_tr_b16 a[182:183], v15 offset:5120
  ds_read_b64_tr_b16 a[184:185], v15 offset:8192
  ds_read_b64_tr_b16 a[186:187], v15 offset:9216
  ds_read_b64_tr_b16 a[188:189], v15 offset:12288
  ds_read_b64_tr_b16 a[190:191], v15 offset:13312
  s_waitcnt vmcnt(13) lgkmcnt(0)
  s_barrier
  s_add_u32 m0, s57, 0
  s_add_u32 s54, s78, 0
  buffer_load_dwordx4 v8, s[20:23], s54 offen  lds
  s_add_u32 m0, s57, 4096
  s_add_u32 s54, s78, 131072
  buffer_load_dwordx4 v8, s[20:23], s54 offen  lds
  s_add_u32 m0, s57, 8192
  s_add_u32 s54, s78, 262144
  buffer_load_dwordx4 v8, s[20:23], s54 offen  lds
  s_add_u32 m0, s57, 12288
  s_add_u32 s54, s78, 393216
  buffer_load_dwordx4 v8, s[20:23], s54 offen  lds
  v_add_u32 v15, 98304, v14
  ds_read_b64_tr_b16 a[192:193], v15 offset:0
  ds_read_b64_tr_b16 a[194:195], v15 offset:1024
  ds_read_b64_tr_b16 a[196:197], v15 offset:4096
  ds_read_b64_tr_b16 a[198:199], v15 offset:5120
  ds_read_b64_tr_b16 a[200:201], v15 offset:8192
  ds_read_b64_tr_b16 a[202:203], v15 offset:9216
  ds_read_b64_tr_b16 a[204:205], v15 offset:12288
  ds_read_b64_tr_b16 a[206:207], v15 offset:13312
  s_waitcnt vmcnt(13) lgkmcnt(0)
  s_barrier
  s_add_u32 m0, s57, 16384
  s_add_u32 s54, s78, 524288
  buffer_load_dwordx4 v8, s[20:23], s54 offen  lds
  s_add_u32 m0, s57, 20480
  s_add_u32 s54, s78, 655360
  buffer_load_dwordx4 v8, s[20:23], s54 offen  lds
  s_add_u32 m0, s57, 24576
  s_add_u32 s54, s78, 786432
  buffer_load_dwordx4 v8, s[20:23], s54 offen  lds
  s_add_u32 m0, s57, 28672
  s_add_u32 s54, s78, 917504
  buffer_load_dwordx4 v8, s[20:23], s54 offen  lds
  v_add_u32 v15, 114688, v14
  ds_read_b64_tr_b16 a[208:209], v15 offset:0
  ds_read_b64_tr_b16 a[210:211], v15 offset:1024
  ds_read_b64_tr_b16 a[212:213], v15 offset:4096
  ds_read_b64_tr_b16 a[214:215], v15 offset:5120
  ds_read_b64_tr_b16 a[216:217], v15 offset:8192
  ds_read_b64_tr_b16 a[218:219], v15 offset:9216
  ds_read_b64_tr_b16 a[220:221], v15 offset:12288
  ds_read_b64_tr_b16 a[222:223], v15 offset:13312
  s_waitcnt vmcnt(12) lgkmcnt(0)
  s_barrier
  s_add_u32 m0, s57, 32768
  s_add_u32 s54, s78, 2097152
  buffer_load_dwordx4 v8, s[20:23], s54 offen  lds
  s_add_u32 m0, s57, 36864
  s_add_u32 s54, s78, 2228224
  buffer_load_dwordx4 v8, s[20:23], s54 offen  lds
  s_add_u32 m0, s57, 40960
  s_add_u32 s54, s78, 2359296
  buffer_load_dwordx4 v8, s[20:23], s54 offen  lds
  s_add_u32 m0, s57, 45056
  s_add_u32 s54, s78, 2490368
  buffer_load_dwordx4 v8, s[20:23], s54 offen  lds
  v_add_u32 v15, 131072, v14
  ds_read_b64_tr_b16 a[224:225], v15 offset:0
  ds_read_b64_tr_b16 a[226:227], v15 offset:1024
  ds_read_b64_tr_b16 a[228:229], v15 offset:4096
  ds_read_b64_tr_b16 a[230:231], v15 offset:5120
  ds_read_b64_tr_b16 a[232:233], v15 offset:8192
  ds_read_b64_tr_b16 a[234:235], v15 offset:9216
  ds_read_b64_tr_b16 a[236:237], v15 offset:12288
  ds_read_b64_tr_b16 a[238:239], v15 offset:13312
  s_waitcnt vmcnt(12) lgkmcnt(0)
  s_barrier
  s_add_u32 m0, s57, 49152
  s_add_u32 s54, s78, 3145728
  buffer_load_dwordx4 v8, s[16:19], s54 offen  lds
  s_add_u32 m0, s57, 53248
  s_add_u32 s54, s78, 3276800
  buffer_load_dwordx4 v8, s[16:19], s54 offen  lds
  s_add_u32 m0, s57, 57344
  s_add_u32 s54, s78, 3407872
  buffer_load_dwordx4 v8, s[16:19], s54 offen  lds
  s_add_u32 m0, s57, 61440
  s_add_u32 s54, s78, 3538944
  buffer_load_dwordx4 v8, s[16:19], s54 offen  lds
  v_add_u32 v15, 147456, v14
  ds_read_b64_tr_b16 a[240:241], v15 offset:0
  ds_read_b64_tr_b16 a[242:243], v15 offset:1024
  ds_read_b64_tr_b16 a[244:245], v15 offset:4096
  ds_read_b64_tr_b16 a[246:247], v15 offset:5120
  ds_read_b64_tr_b16 a[248:249], v15 offset:8192
  ds_read_b64_tr_b16 a[250:251], v15 offset:9216
  ds_read_b64_tr_b16 a[252:253], v15 offset:12288
  ds_read_b64_tr_b16 a[254:255], v15 offset:13312
  s_waitcnt vmcnt(12) lgkmcnt(0)
  s_barrier
  s_add_u32 m0, s57, 65536
  s_add_u32 s54, s78, 2621440
  buffer_load_dwordx4 v8, s[20:23], s54 offen  lds
  s_add_u32 m0, s57, 69632
  s_add_u32 s54, s78, 2752512
  buffer_load_dwordx4 v8, s[20:23], s54 offen  lds
  s_add_u32 m0, s57, 73728
  s_add_u32 s54, s78, 2883584
  buffer_load_dwordx4 v8, s[20:23], s54 offen  lds
  s_add_u32 m0, s57, 77824
  s_add_u32 s54, s78, 3014656
  buffer_load_dwordx4 v8, s[20:23], s54 offen  lds
  v_add_u32 v15, 16384, v11
  v_add_u32 v16, 16384, v12
  ds_read_b64_tr_b16 v[52:53], v15 offset:0
  ds_read_b64_tr_b16 v[54:55], v15 offset:512
  ds_read_b64_tr_b16 v[56:57], v15 offset:8192
  ds_read_b64_tr_b16 v[58:59], v15 offset:8704
  ds_read_b64_tr_b16 v[60:61], v16 offset:0
  ds_read_b64_tr_b16 v[62:63], v16 offset:512
  ds_read_b64_tr_b16 v[64:65], v16 offset:8192
  ds_read_b64_tr_b16 v[66:67], v16 offset:8704
  s_waitcnt vmcnt(12) lgkmcnt(0)
  s_barrier
  s_lshl_b32 s54, s52, 12
  s_add_u32 s54, s54, 16384
  v_add_u32 v7, s54, v76
  ds_write_b128 v7, v[52:55] offset:0
  ds_write_b128 v7, v[56:59] offset:1024
  ds_write_b128 v7, v[60:63] offset:2048
  ds_write_b128 v7, v[64:67] offset:3072
  s_add_u32 m0, s57, 81920
  s_add_u32 s54, s79, 1024
  buffer_load_dwordx4 v9, s[28:31], s54 offen  lds
  s_add_u32 m0, s57, 86016
  s_add_u32 s54, s79, 37888
  buffer_load_dwordx4 v9, s[28:31], s54 offen  lds
  s_add_u32 m0, s57, 90112
  s_add_u32 s54, s79, 74752
  buffer_load_dwordx4 v9, s[28:31], s54 offen  lds
  s_add_u32 m0, s57, 94208
  s_add_u32 s54, s79, 111616
  buffer_load_dwordx4 v9, s[28:31], s54 offen  lds
  v_add_u32 v15, 32768, v11
  v_add_u32 v16, 32768, v12
  ds_read_b64_tr_b16 v[36:37], v15 offset:0
  ds_read_b64_tr_b16 v[38:39], v15 offset:512
  ds_read_b64_tr_b16 v[40:41], v15 offset:8192
  ds_read_b64_tr_b16 v[42:43], v15 offset:8704
  ds_read_b64_tr_b16 v[44:45], v16 offset:0
  ds_read_b64_tr_b16 v[46:47], v16 offset:512
  ds_read_b64_tr_b16 v[48:49], v16 offset:8192
  ds_read_b64_tr_b16 v[50:51], v16 offset:8704
  s_waitcnt vmcnt(12) lgkmcnt(0)
  s_barrier
  s_lshl_b32 s54, s52, 12
  s_add_u32 s54, s54, 32768
  v_add_u32 v7, s54, v76
  ds_write_b128 v7, v[36:39] offset:0
  ds_write_b128 v7, v[40:43] offset:1024
  ds_write_b128 v7, v[44:47] offset:2048
  ds_write_b128 v7, v[48:51] offset:3072
  s_add_u32 m0, s57, 98304
  s_add_u32 s54, s79, 0
  buffer_load_dwordx4 v10, s[28:31], s54 offen  lds
  s_add_u32 m0, s57, 102400
  s_add_u32 s54, s79, 9216
  buffer_load_dwordx4 v10, s[28:31], s54 offen  lds
  s_add_u32 m0, s57, 106496
  s_add_u32 s54, s79, 36864
  buffer_load_dwordx4 v10, s[28:31], s54 offen  lds
  s_add_u32 m0, s57, 110592
  s_add_u32 s54, s79, 46080
  buffer_load_dwordx4 v10, s[28:31], s54 offen  lds
  v_add_u32 v15, 49152, v11
  v_add_u32 v16, 49152, v12
  ds_read_b64_tr_b16 v[52:53], v15 offset:0
  ds_read_b64_tr_b16 v[54:55], v15 offset:512
  ds_read_b64_tr_b16 v[56:57], v15 offset:8192
  ds_read_b64_tr_b16 v[58:59], v15 offset:8704
  ds_read_b64_tr_b16 v[60:61], v16 offset:0
  ds_read_b64_tr_b16 v[62:63], v16 offset:512
  ds_read_b64_tr_b16 v[64:65], v16 offset:8192
  ds_read_b64_tr_b16 v[66:67], v16 offset:8704
  s_waitcnt vmcnt(12) lgkmcnt(0)
  s_barrier
  s_lshl_b32 s54, s52, 12
  s_add_u32 s54, s54, 49152
  v_add_u32 v7, s54, v76
  ds_write_b128 v7, v[52:55] offset:0
  ds_write_b128 v7, v[56:59] offset:1024
  ds_write_b128 v7, v[60:63] offset:2048
  ds_write_b128 v7, v[64:67] offset:3072
  s_add_u32 m0, s57, 114688
  s_add_u32 s54, s79, 73984
  buffer_load_dwordx4 v10, s[28:31], s54 offen  lds
  s_add_u32 m0, s57, 118784
  s_add_u32 s54, s79, 83200
  buffer_load_dwordx4 v10, s[28:31], s54 offen  lds
  s_add_u32 m0, s57, 122880
  s_add_u32 s54, s79, 110848
  buffer_load_dwordx4 v10, s[28:31], s54 offen  lds
  s_add_u32 m0, s57, 126976
  s_add_u32 s54, s79, 120064
  buffer_load_dwordx4 v10, s[28:31], s54 offen  lds
  v_add_u32 v15, 65536, v11
  v_add_u32 v16, 65536, v12
  ds_read_b64_tr_b16 v[36:37], v15 offset:0
  ds_read_b64_tr_b16 v[38:39], v15 offset:512
  ds_read_b64_tr_b16 v[40:41], v15 offset:8192
  ds_read_b64_tr_b16 v[42:43], v15 offset:8704
  ds_read_b64_tr_b16 v[44:45], v16 offset:0
  ds_read_b64_tr_b16 v[46:47], v16 offset:512
  ds_read_b64_tr_b16 v[48:49], v16 offset:8192
  ds_read_b64_tr_b16 v[50:51], v16 offset:8704
  s_waitcnt vmcnt(12) lgkmcnt(0)
  s_barrier
  s_lshl_b32 s54, s52, 12
  s_add_u32 s54, s54, 65536
  v_add_u32 v7, s54, v76
  ds_write_b128 v7, v[36:39] offset:0
  ds_write_b128 v7, v[40:43] offset:1024
  ds_write_b128 v7, v[44:47] offset:2048
  ds_write_b128 v7, v[48:51] offset:3072
  s_add_u32 m0, s57, 131072
  s_add_u32 s54, s79, 768
  buffer_load_dwordx4 v10, s[28:31], s54 offen  lds
  s_add_u32 m0, s57, 135168
  s_add_u32 s54, s79, 9984
  buffer_load_dwordx4 v10, s[28:31], s54 offen  lds
  s_add_u32 m0, s57, 139264
  s_add_u32 s54, s79, 37632
  buffer_load_dwordx4 v10, s[28:31], s54 offen  lds
  s_add_u32 m0, s57, 143360
  s_add_u32 s54, s79, 46848
  buffer_load_dwordx4 v10, s[28:31], s54 offen  lds
  s_and_b32 s56, s53, 28
  s_add_u32 s56, s56, s52
  s_cmp_ge_u32 s56, 9
  s_cselect_b32 s54, 7, 0
  s_add_u32 s54, s54, s56
  s_lshl_b32 s54, s54, 10
  s_add_u32 s54, s54, 360448
  s_cmp_lt_u32 s56, 18
  s_cselect_b32 s54, s54, 268435456
  buffer_load_dword v35, v76, s[8:11], s54 offen sc1
  s_getpc_b64 s[80:81]
C_pc:
  s_lshl_b32 s55, s56, 10
  s_min_u32 s55, s55, (L_w4 - L_w0)
  s_add_u32 s55, s55, (L_w0 - C_pc)
  v_add_u32 v7, s55, v76
  global_load_dword v35, v7, s[80:81]
  v_add_u32 v15, 81920, v11
  v_add_u32 v16, 81920, v12
  ds_read_b64_tr_b16 v[52:53], v15 offset:0
  ds_read_b64_tr_b16 v[54:55], v15 offset:512
  ds_read_b64_tr_b16 v[56:57], v15 offset:8192
  ds_read_b64_tr_b16 v[58:59], v15 offset:8704
  ds_read_b64_tr_b16 v[60:61], v16 offset:0
  ds_read_b64_tr_b16 v[62:63], v16 offset:512
  ds_read_b64_tr_b16 v[64:65], v16 offset:8192
  ds_read_b64_tr_b16 v[66:67], v16 offset:8704
  s_waitcnt vmcnt(14) lgkmcnt(0)
  s_barrier
  s_lshl_b32 s54, s52, 12
  s_add_u32 s54, s54, 81920
  v_add_u32 v7, s54, v76
  ds_write_b128 v7, v[52:55] offset:0
  ds_write_b128 v7, v[56:59] offset:1024
  ds_write_b128 v7, v[60:63] offset:2048
  ds_write_b128 v7, v[64:67] offset:3072
  v_lshrrev_b32 v20, 2, v76
  buffer_load_dword v21, v20, s[12:15], 0 offen sc1
  v_add_u32 v15, 98304, v13
  s_waitcnt lgkmcnt(0)
  ds_read_b64_tr_b16 v[36:37], v15 offset:0
  ds_read_b64_tr_b16 v[38:39], v15 offset:1024
  ds_read_b64_tr_b16 v[40:41], v15 offset:2048
  ds_read_b64_tr_b16 v[42:43], v15 offset:3072
  ds_read_b64_tr_b16 v[44:45], v15 offset:4096
  ds_read_b64_tr_b16 v[46:47], v15 offset:5120
  ds_read_b64_tr_b16 v[48:49], v15 offset:6144
  ds_read_b64_tr_b16 v[50:51], v15 offset:7168
  ds_read_b64_tr_b16 v[52:53], v15 offset:8192
  ds_read_b64_tr_b16 v[54:55], v15 offset:9216
  ds_read_b64_tr_b16 v[56:57], v15 offset:10240
  ds_read_b64_tr_b16 v[58:59], v15 offset:11264
  ds_read_b64_tr_b16 v[60:61], v15 offset:12288
  ds_read_b64_tr_b16 v[62:63], v15 offset:13312
  ds_read_b64_tr_b16 v[64:65], v15 offset:14336
  ds_read_b64_tr_b16 v[66:67], v15 offset:15360
  s_waitcnt vmcnt(11) lgkmcnt(0)
  s_barrier
  s_and_b32 s54, s52, 1
  s_lshl_b32 s54, s54, 13
  s_add_u32 s54, s54, 98304
  v_add_u32 v7, s54, v76
  ds_write_b128 v7, v[36:39] offset:0
  ds_write_b128 v7, v[40:43] offset:1024
  ds_write_b128 v7, v[44:47] offset:2048
  ds_write_b128 v7, v[48:51] offset:3072
  ds_write_b128 v7, v[52:55] offset:4096
  ds_write_b128 v7, v[56:59] offset:5120
  ds_write_b128 v7, v[60:63] offset:6144
  ds_write_b128 v7, v[64:67] offset:7168
  v_add_u32 v15, 114688, v14
  ds_read_b64_tr_b16 v[52:53], v15 offset:0
  ds_read_b64_tr_b16 v[54:55], v15 offset:1024
  ds_read_b64_tr_b16 v[56:57], v15 offset:4096
  ds_read_b64_tr_b16 v[58:59], v15 offset:5120
  ds_read_b64_tr_b16 v[60:61], v15 offset:8192
  ds_read_b64_tr_b16 v[62:63], v15 offset:9216
  ds_read_b64_tr_b16 v[64:65], v15 offset:12288
  ds_read_b64_tr_b16 v[66:67], v15 offset:13312
  s_waitcnt vmcnt(7) lgkmcnt(0)
  s_barrier
  s_lshl_b32 s54, s52, 12
  s_add_u32 s54, s54, 114688
  v_add_u32 v7, s54, v76
  ds_write_b128 v7, v[52:55] offset:0
  ds_write_b128 v7, v[56:59] offset:1024
  ds_write_b128 v7, v[60:63] offset:2048
  ds_write_b128 v7, v[64:67] offset:3072
  v_add_u32 v15, 131072, v14
  ds_read_b64_tr_b16 v[36:37], v15 offset:0
  ds_read_b64_tr_b16 v[38:39], v15 offset:1024
  ds_read_b64_tr_b16 v[40:41], v15 offset:4096
  ds_read_b64_tr_b16 v[42:43], v15 offset:5120
  ds_read_b64_tr_b16 v[44:45], v15 offset:8192
  ds_read_b64_tr_b16 v[46:47], v15 offset:9216
  ds_read_b64_tr_b16 v[48:49], v15 offset:12288
  ds_read_b64_tr_b16 v[50:51], v15 offset:13312
  s_waitcnt vmcnt(3) lgkmcnt(0)
  s_barrier
  s_lshl_b32 s54, s52, 12
  s_add_u32 s54, s54, 131072
  v_add_u32 v7, s54, v76
  ds_write_b128 v7, v[36:39] offset:0
  ds_write_b128 v7, v[40:43] offset:1024
  ds_write_b128 v7, v[44:47] offset:2048
  ds_write_b128 v7, v[48:51] offset:3072
  v_add_u32 v15, 147456, v14
  ds_read_b64_tr_b16 v[52:53], v15 offset:0
  ds_read_b64_tr_b16 v[54:55], v15 offset:1024
  ds_read_b64_tr_b16 v[56:57], v15 offset:4096
  ds_read_b64_tr_b16 v[58:59], v15 offset:5120
  ds_read_b64_tr_b16 v[60:61], v15 offset:8192
  ds_read_b64_tr_b16 v[62:63], v15 offset:9216
  ds_read_b64_tr_b16 v[64:65], v15 offset:12288
  ds_read_b64_tr_b16 v[66:67], v15 offset:13312
  s_waitcnt vmcnt(0) lgkmcnt(0)
  s_barrier
  s_lshl_b32 s54, s52, 12
  s_add_u32 s54, s54, 147456
  v_add_u32 v7, s54, v76
  ds_write_b128 v7, v[52:55] offset:0
  ds_write_b128 v7, v[56:59] offset:1024
  ds_write_b128 v7, v[60:63] offset:2048
  ds_write_b128 v7, v[64:67] offset:3072
  s_waitcnt lgkmcnt(0)
  s_branch C_rd1
C_rd0:
  s_sleep 2
  buffer_load_dword v21, v20, s[12:15], 0 offen sc1
  s_waitcnt vmcnt(0)
C_rd1:
  v_and_b32 v22, 0xff, v21
  v_cmp_gt_u32 vcc, 7, v22
  v_readlane_b32 s56, v21, 0
  s_mov_b32 s3, 1
  s_add_u32 s67, s67, 1
  s_cmp_ge_u32 s67, 131072
  s_cbranch_scc1 C_rd2
  s_cmp_lg_u32 vcc_hi, 0
  s_cbranch_scc1 C_rd0
  s_mov_b32 s3, 0
  s_cmp_eq_u32 s56, -1
  s_cbranch_scc1 C_rd2
  s_mov_b32 s3, 1
  v_readlane_b32 s54, v21, 10
  v_readlane_b32 s55, v21, 0
  s_nop 0
  s_bcnt1_i32_b32 s55, s55
  s_add_u32 s54, s54, s55
  v_readlane_b32 s55, v21, 1
  s_nop 0
  s_bcnt1_i32_b32 s55, s55
  s_add_u32 s54, s54, s55
  v_readlane_b32 s55, v21, 2
  s_nop 0
  s_bcnt1_i32_b32 s55, s55
  s_add_u32 s54, s54, s55
  v_readlane_b32 s55, v21, 3
  s_nop 0
  s_bcnt1_i32_b32 s55, s55
  s_add_u32 s54, s54, s55
  v_readlane_b32 s55, v21, 4
  s_nop 0
  s_bcnt1_i32_b32 s55, s55
  s_add_u32 s54, s54, s55
  v_readlane_b32 s55, v21, 5
  s_nop 0
  s_bcnt1_i32_b32 s55, s55
  s_add_u32 s54, s54, s55
  v_readlane_b32 s55, v21, 6
  s_nop 0
  s_bcnt1_i32_b32 s55, s55
  s_add_u32 s54, s54, s55
  v_readlane_b32 s55, v21, 7
  s_nop 0
  s_bcnt1_i32_b32 s55, s55
  s_add_u32 s54, s54, s55
  s_cmp_lt_u32 s54, 256
  s_cbranch_scc1 C_rd0
C_rd2:
  s_lshl_b32 s54, s3, 2
  s_add_u32 s54, s54, s52
  s_cmp_eq_u32 s54, 1
  s_cbranch_scc1 L_w1
  s_cmp_eq_u32 s54, 2
  s_cbranch_scc1 L_w2
  s_cmp_eq_u32 s54, 3
  s_cbranch_scc1 L_w3
  s_cmp_eq_u32 s54, 4
  s_cbranch_scc1 L_w4
  s_cmp_eq_u32 s54, 5
  s_cbranch_scc1 L_w5
  s_cmp_eq_u32 s54, 6
  s_cbranch_scc1 L_w6
  s_cmp_eq_u32 s54, 7
  s_cbranch_scc1 L_w7
L_w0:
  v_mov_b64 v[20:21], 0
  v_mov_b64 v[22:23], 0
  v_mov_b64 v[24:25], 0
  v_mov_b64 v[26:27], 0
  v_mov_b64 v[28:29], 0
  v_mov_b64 v[30:31], 0
  v_mov_b64 v[32:33], 0
  v_mov_b64 v[34:35], 0
  s_mov_b32 s78, 0x3f803f80
  s_mov_b32 s79, s78
  s_mov_b32 s65, 360448
  s_mov_b32 m0, 16128
  s_lshl_b32 s71, s53, 2
  s_add_u32 s71, s71, 128
  s_movk_i32 s56, 0x1000
  v_lshlrev_b32 v73, 2, v76
  v_mov_b32 v72, 0
  s_mov_b64 s[16:17], s[8:9]
  s_mov_b32 s18, 268435456
  s_mov_b32 s19, 0x20000
  s_getpc_b64 s[20:21]
Cf0_pc:
  s_add_u32 s20, s20, (Cf0_last - Cf0_pc)
  s_addc_u32 s21, s21, 0
  v_mov_b32 v68, 14880
  buffer_load_dwordx4 v[52:55], v76, s[8:11], s59 offen offset:0 sc1
  buffer_load_dwordx4 v[56:59], v76, s[8:11], s59 offen offset:1024 sc1
  ds_read_b128 v[36:39], v76 offset:16384
  ds_read_b128 v[40:43], v76 offset:17408
  ds_read_b128 v[60:63], v76 offset:18432
  ds_read_b128 v[64:67], v76 offset:19456
  ds_read_b128 v[0:3], v76 offset:4608
  ds_read_b128 v[4:7], v76 offset:5632
  ds_read_b128 v[8:11], v76 offset:6656
  ds_read_b128 v[12:15], v76 offset:7680
  s_waitcnt lgkmcnt(0)
  s_cmp_eq_u32 s66, 1
  s_branch Cf0_top2
.p2align 6
Cf0_h2:
  s_cmp_eq_u32 s66, 12
  s_cselect_b32 s56, s71, 0x1000
  ds_read_b32 v72, v76 offset:16128
  s_cmp_eq_u32 s66, 13
  s_cselect_b32 s54, 0x700, 0
  s_waitcnt lgkmcnt(0)
  v_readfirstlane_b32 s57, v72
  s_nop 0
  s_cmp_lt_u32 s57, s54
  s_cbranch_scc1 Cf0_kv3
Cf0_kvb:
  buffer_load_dwordx4 v[0:3], v76, s[8:11], s65 offen offset:0 sc1
  ds_read_b128 v[36:39], v76 offset:16384
  s_waitcnt lgkmcnt(0)
  v_mov_b64 v[20:21], 0
  v_mov_b64 v[22:23], 0
  v_mov_b64 v[24:25], 0
  v_mov_b64 v[26:27], 0
  v_mov_b32 v68, 14880
  buffer_load_dwordx4 v[0:3], v76, s[8:11], s65 offen offset:0 sc1
  ds_read_b128 v[40:43], v76 offset:17408
  s_waitcnt lgkmcnt(0)
  s_cmp_eq_u32 s66, 62
  s_cselect_b64 s[16:17], s[20:21], s[16:17]
  s_cselect_b32 s18, (Cf0_done - Cf0_last), s18
  s_cselect_b32 s70, 0, s70
  s_cmp_eq_u32 s66, 63
  s_cselect_b32 s59, 268435456, s59
  s_cselect_b32 s58, 268435456, s58
  buffer_load_dwordx4 v[0:3], v76, s[8:11], s65 offen offset:0 sc1
  ds_read_b128 v[60:63], v76 offset:18432
  s_waitcnt lgkmcnt(0)
  v_lshlrev_b32 v73, 2, v76
  buffer_load_dwordx4 v[52:55], v76, s[8:11], s59 offen offset:0 sc1
  buffer_load_dwordx4 v[56:59], v76, s[8:11], s59 offen offset:1024 sc1
  s_waitcnt vmcnt(4)
  v_max3_u32 v72, v0, v1, v2
  v_max_u32 v72, v72, v3
  ds_write_b128 v76, v[0:3] offset:4608
  v_cmp_eq_u32 vcc, -1, v72
  s_cbranch_vccnz Cf0_h2r
Cf0_h2w:
  s_cmp_eq_u32 s66, 63
  s_waitcnt lgkmcnt(0)
  s_barrier
  ds_read_b128 v[8:11], v76 offset:6656
  buffer_load_dwordx4 v76, s[8:11], s85 offen offset:0 sc1 lds
Cf0_top2:
  v_smfmac_f32_16x16x64_bf16 v[20:23], v[0:3], v[80:87], v74
  s_cbranch_scc1 Cf0_last
  v_smfmac_f32_16x16x64_bf16 v[28:31], v[0:3], v[36:43], v74
  buffer_load_dwordx4 v[44:47], v76, s[8:11], s58 offen offset:0 sc1
  s_mov_b32 m0, 16128
  v_smfmac_f32_16x16x64_bf16 v[24:27], v[0:3], v[88:95], v74
  buffer_load_dwordx4 v[48:51], v76, s[8:11], s58 offen offset:1024 sc1
  v_smfmac_f32_16x16x64_bf16 v[32:35], v[0:3], v[60:67], v74
  ds_read_b128 v[4:7], v76 offset:5632
  s_waitcnt lgkmcnt(1)
  v_smfmac_f32_16x16x64_bf16 v[20:23], v[8:11], v[112:119], v74
  ds_read_b128 v[12:15], v76 offset:7680
  v_smfmac_f32_16x16x64_bf16 v[24:27], v[8:11], v[120:127], v74
  ds_read_b128 v[36:39], v76 offset:32768
  v_smfmac_f32_16x16x64_bf16 v[28:31], v[8:11], v[208:215], v74
  buffer_store_dwordx4 v[16:19], v76, s[8:11], s68 offen sc1
  ds_read_b128 v[40:43], v76 offset:33792
  v_smfmac_f32_16x16x64_bf16 v[32:35], v[8:11], v[216:223], v74
  buffer_load_dword v73, s[16:19], s70 offen lds
  ds_read_b128 v[60:63], v76 offset:34816
  s_waitcnt lgkmcnt(4)
  v_smfmac_f32_16x16x64_bf16 v[20:23], v[4:7], v[96:103], v74
  ds_read_b128 v[64:67], v76 offset:35840
  v_smfmac_f32_16x16x64_bf16 v[24:27], v[4:7], v[104:111], v74
  s_waitcnt vmcnt(5)
  s_waitcnt lgkmcnt(4)
  v_smfmac_f32_16x16x64_bf16 v[20:23], v[12:15], v[128:135], v74
  s_barrier
  ds_read_b128 v[0:3], v76 offset:8704
  s_waitcnt lgkmcnt(3)
  v_smfmac_f32_16x16x64_bf16 v[28:31], v[4:7], v[36:43], v74
  ds_read_b128 v[36:39], v76 offset:49152
  v_smfmac_f32_16x16x64_bf16 v[24:27], v[12:15], v[136:143], v74
  ds_read_b128 v[40:43], v76 offset:50176
  s_waitcnt lgkmcnt(3)
  v_smfmac_f32_16x16x64_bf16 v[32:35], v[4:7], v[60:67], v74
  ds_read_b128 v[8:11], v76 offset:9728
  v_smfmac_f32_16x16x64_bf16 v[28:31], v[12:15], v[224:231], v74
  ds_read_b128 v[60:63], v76 offset:51200
  v_smfmac_f32_16x16x64_bf16 v[32:35], v[12:15], v[232:239], v74
  s_waitcnt vmcnt(4)
  ds_read_b128 v[64:67], v76 offset:52224
  s_waitcnt lgkmcnt(5)
  v_smfmac_f32_16x16x64_bf16 v[20:23], v[0:3], v[144:151], v74
  s_barrier
  ds_read_b128 v[4:7], v76 offset:11776
  s_waitcnt lgkmcnt(4)
  v_smfmac_f32_16x16x64_bf16 v[28:31], v[0:3], v[36:43], v74
  ds_read_b128 v[12:15], v76 offset:12800
  ds_read_b128 v[36:39], v75 offset:0
  v_smfmac_f32_16x16x64_bf16 v[24:27], v[0:3], v[152:159], v74
  ds_read_b128 v[16:19], v76 offset:10752
  s_waitcnt lgkmcnt(6)
  v_smfmac_f32_16x16x64_bf16 v[20:23], v[8:11], v[160:167], v74
  ds_read_b128 v[40:43], v75 offset:1024
  s_waitcnt lgkmcnt(5)
  v_smfmac_f32_16x16x64_bf16 v[32:35], v[0:3], v[60:67], v74
  ds_read_b128 v[60:63], v75 offset:2048
  v_smfmac_f32_16x16x64_bf16 v[24:27], v[8:11], v[168:175], v74
  ds_read_b128 v[64:67], v75 offset:3072
  s_waitcnt lgkmcnt(6)
  v_smfmac_f32_16x16x64_bf16 v[20:23], v[4:7], v[176:183], v74
  buffer_load_dword off, s[12:15], s56 sc1 lds
  s_waitcnt lgkmcnt(5)
  v_smfmac_f32_16x16x64_bf16 v[20:23], v[12:15], v[192:199], v74
  s_waitcnt lgkmcnt(2)
  v_smfmac_f32_16x16x64_bf16 v[20:23], v[16:19], v[36:43], v74
  ds_read_b128 v[36:39], v75 offset:16384
  v_smfmac_f32_16x16x64_bf16 v[24:27], v[4:7], v[184:191], v74
  ds_read_b128 v[40:43], v75 offset:17408
  s_waitcnt lgkmcnt(2)
  v_smfmac_f32_16x16x64_bf16 v[24:27], v[16:19], v[60:67], v74
  ds_read_b128 v[60:63], v75 offset:18432
  v_add_f32 v20, v20, v22
  v_smfmac_f32_16x16x64_bf16 v[24:27], v[12:15], v[200:207], v74
  ds_read_b128 v[64:67], v75 offset:19456
  v_add_f32 v21, v21, v23
  v_smfmac_f32_16x16x64_bf16 v[28:31], v[16:19], v[240:247], v74
  v_mov_b64 v[70:71], s[78:79]
  v_smfmac_f32_16x16x64_bf16 v[28:31], v[4:7], a[0:7], v74
  s_waitcnt lgkmcnt(2)
  v_add_f32 v24, v24, v26
  v_smfmac_f32_16x16x64_bf16 v[28:31], v[8:11], v[36:43], v74
  ds_read_b128 v[36:39], v68
  v_cvt_pk_bf16_f32 v22, v20, v24
  v_smfmac_f32_16x16x64_bf16 v[28:31], v[12:15], a[16:23], v74
  ds_read_b128 v[40:43], v68
  ds_write_b32 v79, v22 offset:0
  s_waitcnt lgkmcnt(3)
  v_add_f32 v25, v25, v27
  v_cvt_pk_bf16_f32 v23, v21, v25
  v_smfmac_f32_16x16x64_bf16 v[32:35], v[8:11], v[60:67], v74
  ds_write_b32 v79, v23 offset:576
  v_cmp_u_f32 vcc, v20, v21
  v_smfmac_f32_16x16x64_bf16 v[32:35], v[16:19], v[248:255], v74
  v_add_f32 v28, v28, v30
  v_smfmac_f32_16x16x64_bf16 v[32:35], v[4:7], a[8:15], v74
  v_add_f32 v29, v29, v31
  v_smfmac_f32_16x16x64_bf16 v[32:35], v[12:15], a[24:31], v74
  s_cbranch_vccnz Cf0_rec
Cf0_recok:
  s_waitcnt lgkmcnt(3)
  v_smfmac_f32_16x16x64_bf16 v[36:39], v[16:19], a[128:135], v74
  s_waitcnt lgkmcnt(0)
  s_barrier
  ds_read_b128 v[60:63], v77
  v_smfmac_f32_16x16x64_bf16 v[40:43], v[16:19], a[136:143], v74
  ds_read_b128 v[64:67], v77 offset:128
  v_add_f32 v32, v32, v34
  v_cvt_pk_bf16_f32 v30, v28, v32
  v_smfmac_f32_16x16x64_bf16 v[36:39], v[0:3], a[96:103], v74
  ds_write_b32 v79, v30 offset:256
  v_add_f32 v33, v33, v35
  v_cvt_pk_bf16_f32 v31, v29, v33
  v_smfmac_f32_16x16x64_bf16 v[40:43], v[0:3], a[104:111], v74
  ds_write_b32 v79, v31 offset:832
  v_xor_b32 v75, 0x8000, v75
  v_smfmac_f32_16x16x64_bf16 v[36:39], v[4:7], a[144:151], v74
  ds_read_b128 v[0:3], v76 offset:4608
  v_mov_b32 v29, 0
  v_smfmac_f32_16x16x64_bf16 v[40:43], v[4:7], a[152:159], v74
  s_waitcnt vmcnt(3) lgkmcnt(3)
  v_mov_b32 v30, 0
  v_mfma_f32_16x16x32_bf16 v[44:47], v[44:47], v[60:63], 0
  ds_read_b128 v[4:7], v76 offset:5632
  s_waitcnt lgkmcnt(2)
  v_mfma_f32_16x16x32_bf16 v[44:47], v[48:51], v[64:67], v[44:47]
  s_barrier
  v_smfmac_f32_16x16x64_bf16 v[36:39], v[8:11], a[112:119], v74
  ds_read_b128 v[20:23], v77 offset:256
  ds_read_b128 v[24:27], v77 offset:384
  v_smfmac_f32_16x16x64_bf16 v[40:43], v[8:11], a[120:127], v74
  ds_read_b128 v[8:11], v76 offset:6656
  v_add_f32_dpp v72, v46, v44 quad_perm:[2,3,0,1] row_mask:0xf bank_mask:0xf
  v_add_f32_dpp v73, v47, v45 quad_perm:[2,3,0,1] row_mask:0xf bank_mask:0xf
  v_smfmac_f32_16x16x64_bf16 v[36:39], v[12:15], a[160:167], v74
  s_waitcnt lgkmcnt(4)
  v_exp_f32_dpp v72, v72 quad_perm:[0,1,0,1] row_mask:0xf bank_mask:0xf
  v_smfmac_f32_16x16x64_bf16 v[40:43], v[12:15], a[168:175], v74
  ds_read_b128 v[12:15], v76 offset:7680
  v_exp_f32_dpp v73, v73 quad_perm:[0,1,0,1] row_mask:0xf bank_mask:0xf
  v_smfmac_f32_16x16x64_bf16 v[36:39], v[0:3], a[32:39], v74
  s_waitcnt lgkmcnt(2)
  v_cvt_pk_bf16_f32 v72, v72, v73
  v_mfma_f32_16x16x32_bf16 v[20:23], v[20:23], v[60:63], 0
  ds_write_b32 v78, v72 offset:512
  v_mov_b64 v[16:17], 0
  v_mfma_f32_16x16x32_bf16 v[20:23], v[24:27], v[64:67], v[20:23]
  ds_read_b128 v[44:47], v75 offset:16384
  v_mov_b64 v[18:19], 0
  v_smfmac_f32_16x16x64_bf16 v[40:43], v[0:3], a[40:47], v74
  ds_read_b128 v[48:51], v75 offset:17408
  v_mov_b64 v[68:69], s[78:79]
  v_smfmac_f32_16x16x64_bf16 v[36:39], v[4:7], a[48:55], v74
  s_waitcnt lgkmcnt(4)
  v_add_f32_dpp v24, v22, v20 quad_perm:[2,3,0,1] row_mask:0xf bank_mask:0xf
  v_add_f32_dpp v25, v23, v21 quad_perm:[2,3,0,1] row_mask:0xf bank_mask:0xf
  v_smfmac_f32_16x16x64_bf16 v[36:39], v[8:11], a[64:71], v74
  s_waitcnt lgkmcnt(2)
  s_barrier
  ds_read_b128 v[32:35], v78 offset:512
  v_smfmac_f32_16x16x64_bf16 v[36:39], v[12:15], a[80:87], v74
  ds_read_b128 v[60:63], v75 offset:18432
  v_mul_f32 v24, s69, v24
  v_smfmac_f32_16x16x64_bf16 v[40:43], v[4:7], a[56:63], v74
  ds_read_b128 v[64:67], v75 offset:19456
  v_mul_f32 v25, s69, v25
  v_smfmac_f32_16x16x64_bf16 v[40:43], v[8:11], a[72:79], v74
  v_exp_f32_dpp v24, v24 quad_perm:[0,1,0,1] row_mask:0xf bank_mask:0xf
  v_smfmac_f32_16x16x64_bf16 v[40:43], v[12:15], a[88:95], v74
  s_waitcnt lgkmcnt(2)
  v_exp_f32_dpp v25, v25 quad_perm:[0,1,0,1] row_mask:0xf bank_mask:0xf
  v_mfma_f32_16x16x32_bf16 v[8:11], v[32:35], v[68:71], 0
  v_add_f32 v36, v36, v38
  v_add_f32 v37, v37, v39
  v_mfma_f32_16x16x32_bf16 v[0:3], v[32:35], v[52:55], 0
  v_add_f32 v40, v40, v42
  v_add_f32 v41, v41, v43
  v_mfma_f32_16x16x32_bf16 v[4:7], v[32:35], v[56:59], 0
  v_cvt_pk_bf16_f32 v28, v24, v25
  v_cvt_pk_bf16_f32 v72, v36, v37
  v_cvt_pk_bf16_f32 v73, v40, v41
  v_mfma_f32_16x16x16_bf16 v[8:11], v[28:29], v[68:69], v[8:11]
  v_cvt_pk_bf16_f32 v31, v24, v25
  v_mov_b64 v[20:21], 0
  v_mfma_f32_16x16x16_bf16 v[0:3], v[28:29], v[72:73], v[0:3]
  ds_read_b128 v[52:55], v75 offset:32768
  v_mov_b64 v[22:23], 0
  v_mfma_f32_16x16x16_bf16 v[4:7], v[30:31], v[72:73], v[4:7]
  v_rcp_f32 v10, v8
  v_rcp_f32 v11, v9
  v_mul_f32 v0, v10, v0
  v_mul_f32 v1, v11, v1
  v_max3_f32 v8, v8, v9, v10
  v_mul_f32 v4, v10, v4
  v_mul_f32 v5, v11, v5
  v_cvt_pk_bf16_f32 v2, v0, v4
  ds_write_b32 v79, v2 offset:8704
  v_cvt_pk_bf16_f32 v3, v1, v5
  ds_write_b32 v79, v3 offset:9280
  ds_read_b128 v[12:15], v78 offset:8704
  v_max_f32 v8, v8, v11
  v_cmp_le_f32 vcc, 1317011456, v8
  v_mov_b64 v[24:25], 0
  v_mov_b64 v[26:27], 0
  ds_read_b128 v[56:59], v75 offset:33792
  s_cbranch_vccnz Cf0_mx
Cf0_mxok:
  s_waitcnt lgkmcnt(2)
  s_barrier
  ds_read_b128 v[0:3], v78 offset:8768
  s_waitcnt lgkmcnt(2)
  v_smfmac_f32_16x16x64_bf16 v[16:19], v[12:15], v[44:51], v74
  ds_read_b128 v[4:7], v78 offset:8832
  v_smfmac_f32_16x16x64_bf16 v[20:23], v[12:15], a[192:199], v74
  ds_read_b128 v[8:11], v78 offset:8896
  v_smfmac_f32_16x16x64_bf16 v[24:27], v[12:15], a[208:215], v74
  ds_read_b128 v[36:39], v75 offset:34816
  s_waitcnt lgkmcnt(3)
  v_smfmac_f32_16x16x64_bf16 v[16:19], v[0:3], v[60:67], v74
  ds_read_b128 v[40:43], v75 offset:35840
  s_waitcnt lgkmcnt(3)
  v_smfmac_f32_16x16x64_bf16 v[16:19], v[4:7], a[176:183], v74
  ds_read_b128 v[68:71], v76 offset:13824
  s_waitcnt lgkmcnt(3)
  v_smfmac_f32_16x16x64_bf16 v[16:19], v[8:11], a[184:191], v74
  ds_read_b128 v[44:47], v75 offset:49152
  v_smfmac_f32_16x16x64_bf16 v[20:23], v[0:3], a[200:207], v74
  ds_read_b128 v[48:51], v75 offset:50176
  v_smfmac_f32_16x16x64_bf16 v[20:23], v[4:7], v[52:59], v74
  ds_read_b128 v[60:63], v75 offset:51200
  s_waitcnt lgkmcnt(4)
  v_cvt_pk_bf16_f32 v16, v16, v17
  v_cvt_pk_bf16_f32 v17, v18, v19
  v_bfi_b32 v16, 1, s72, v16
  v_smfmac_f32_16x16x64_bf16 v[20:23], v[8:11], v[36:43], v74
  s_waitcnt lgkmcnt(3)
  buffer_store_dwordx2 v[16:17], v68, s[8:11], s73 offen
  v_mov_b64 v[32:33], 0
  v_smfmac_f32_16x16x64_bf16 v[24:27], v[0:3], a[216:223], v74
  ds_read_b128 v[64:67], v75 offset:52224
  v_mov_b64 v[34:35], 0
  v_smfmac_f32_16x16x64_bf16 v[24:27], v[4:7], a[224:231], v74
  v_cvt_pk_bf16_f32 v20, v20, v21
  v_cvt_pk_bf16_f32 v21, v22, v23
  v_bfi_b32 v20, 1, s72, v20
  v_smfmac_f32_16x16x64_bf16 v[24:27], v[8:11], a[232:239], v74
  buffer_store_dwordx2 v[20:21], v68, s[8:11], s74 offen
  s_waitcnt lgkmcnt(2)
  v_smfmac_f32_16x16x64_bf16 v[32:35], v[12:15], v[44:51], v74
  s_waitcnt lgkmcnt(0)
  v_smfmac_f32_16x16x64_bf16 v[32:35], v[0:3], v[60:67], v74
  v_cvt_pk_bf16_f32 v24, v24, v25
  v_cvt_pk_bf16_f32 v25, v26, v27
  v_bfi_b32 v24, 1, s72, v24
  v_smfmac_f32_16x16x64_bf16 v[32:35], v[4:7], a[240:247], v74
  buffer_store_dwordx2 v[24:25], v68, s[8:11], s75 offen
  v_smfmac_f32_16x16x64_bf16 v[32:35], v[8:11], a[248:255], v74
  v_mov_b64 v[18:19], v[72:73]
  s_nop 4
  v_cvt_pk_bf16_f32 v32, v32, v33
  v_cvt_pk_bf16_f32 v33, v34, v35
  v_bfi_b32 v32, 1, s72, v32
  buffer_store_dwordx2 v[32:33], v68, s[8:11], s76 offen
  ds_read_b128 v[0:3], v76 offset:14848
  s_waitcnt lgkmcnt(0)
  ds_read_b64 v[16:17], v77 offset:256
  s_waitcnt lgkmcnt(0)
  ds_read_b128 v[64:67], v76 offset:19456
  s_waitcnt lgkmcnt(0)
  v_xor_b32 v75, 0x8000, v75
  v_mov_b64 v[28:29], 0
  v_mov_b64 v[30:31], 0
  v_mov_b64 v[32:33], 0
  v_mov_b64 v[34:35], 0
  buffer_load_dwordx4 v[52:55], v76, s[8:11], s60 offen offset:0 sc1
  buffer_load_dwordx4 v[56:59], v76, s[8:11], s60 offen offset:1024 sc1
  s_add_u32 s66, s66, 1
  s_xor_b32 s64, s64, 16384
  s_xor_b32 s65, s65, 16384
  s_add_u32 s58, s58, 655360
  s_add_u32 s59, s59, 655360
  s_add_u32 s70, s70, 655360
  s_add_u32 s68, s68, 655360
  s_mov_b32 m0, 10752
  s_add_u32 s85, s65, 6144
  s_waitcnt lgkmcnt(0)
  s_waitcnt vmcnt(1)
  v_mfma_f32_16x16x32_bf16 v[4:7], v[0:3], v[52:55], 0
  v_bitop3_b32 v72, v52, v54, s72 bitop3:0x7e
  s_waitcnt vmcnt(0)
  v_mfma_f32_16x16x32_bf16 v[4:7], v[0:3], v[56:59], v[4:7]
  v_bitop3_b32 v73, v56, v58, s72 bitop3:0x7e
  v_bitop3_b32 v72, v72, v73, 1 bitop3:0xa8
  v_cmp_ne_u32 vcc, 0, v72
  s_nop 3
  v_add_f32_dpp v4, v4, v4 row_ror:4 row_mask:0xf bank_mask:0xf
  v_add_f32_dpp v5, v5, v5 row_ror:4 row_mask:0xf bank_mask:0xf
  s_cmp_eq_u64 vcc, 0
  v_add_f32_dpp v4, v4, v4 row_ror:8 row_mask:0xf bank_mask:0xf
  v_add_f32_dpp v5, v5, v5 row_ror:8 row_mask:0xf bank_mask:0xf
  s_cselect_b32 s54, s62, 268435456
  v_cvt_pk_bf16_f32 v4, v4, v5
  buffer_store_dword v4, v69, s[8:11], s54 offen
  s_cbranch_vccnz Cf0_h1r
  s_xor_b32 s62, s62, 16384
  buffer_store_dword v71, v69, s[8:11], s62 offen
  s_xor_b32 s72, s72, 1
  s_branch Cf0_h2
Cf0_h1r:
  s_mov_b64 exec, vcc
  buffer_load_dwordx4 v[52:55], v76, s[8:11], s60 offen offset:0 sc1
  buffer_load_dwordx4 v[56:59], v76, s[8:11], s60 offen offset:1024 sc1
  s_mov_b64 exec, -1
  s_add_u32 s67, s67, 1
  s_waitcnt vmcnt(1)
  v_mfma_f32_16x16x32_bf16 v[4:7], v[0:3], v[52:55], 0
  v_bitop3_b32 v72, v52, v54, s72 bitop3:0x7e
  s_waitcnt vmcnt(0)
  v_mfma_f32_16x16x32_bf16 v[4:7], v[0:3], v[56:59], v[4:7]
  v_bitop3_b32 v73, v56, v58, s72 bitop3:0x7e
  v_bitop3_b32 v72, v72, v73, 1 bitop3:0xa8
  v_cmp_ne_u32 vcc, 0, v72
  s_cbranch_vccz Cf0_h1p
Cf0_h1s:
  s_mov_b64 exec, vcc
  buffer_load_dwordx4 v[52:55], v76, s[8:11], s60 offen offset:0 sc1
  buffer_load_dwordx4 v[56:59], v76, s[8:11], s60 offen offset:1024 sc1
  s_mov_b64 exec, -1
  s_add_u32 s67, s67, 1
  s_waitcnt vmcnt(1)
  v_mfma_f32_16x16x32_bf16 v[4:7], v[0:3], v[52:55], 0
  v_bitop3_b32 v72, v52, v54, s72 bitop3:0x7e
  s_waitcnt vmcnt(0)
  v_mfma_f32_16x16x32_bf16 v[4:7], v[0:3], v[56:59], v[4:7]
  v_bitop3_b32 v73, v56, v58, s72 bitop3:0x7e
  v_bitop3_b32 v72, v72, v73, 1 bitop3:0xa8
  v_cmp_ne_u32 vcc, 0, v72
  s_cbranch_vccz Cf0_h1p
  s_cmp_lt_u32 s67, 131072
  s_cbranch_scc1 Cf0_h1s
Cf0_h1p:
  s_nop 2
  v_add_f32_dpp v4, v4, v4 row_ror:4 row_mask:0xf bank_mask:0xf
  v_add_f32_dpp v5, v5, v5 row_ror:4 row_mask:0xf bank_mask:0xf
  s_nop 0
  v_add_f32_dpp v4, v4, v4 row_ror:8 row_mask:0xf bank_mask:0xf
  v_add_f32_dpp v5, v5, v5 row_ror:8 row_mask:0xf bank_mask:0xf
  v_cvt_pk_bf16_f32 v4, v4, v5
  buffer_store_dword v4, v69, s[8:11], s62 offen
  s_xor_b32 s62, s62, 16384
  buffer_store_dword v71, v69, s[8:11], s62 offen
  s_xor_b32 s72, s72, 1
  s_branch Cf0_h2
Cf0_h2r:
  s_mov_b64 exec, vcc
  buffer_load_dwordx4 v[0:3], v76, s[8:11], s65 offen offset:0 sc1
  s_mov_b64 exec, -1
  s_add_u32 s67, s67, 1
  s_waitcnt vmcnt(4)
  v_max3_u32 v72, v0, v1, v2
  v_max_u32 v72, v72, v3
  ds_write_b128 v76, v[0:3] offset:4608
  v_cmp_eq_u32 vcc, -1, v72
  s_cbranch_vccz Cf0_h2w
  s_mov_b64 exec, vcc
  buffer_load_dwordx4 v[0:3], v76, s[8:11], s65 offen offset:0 sc1
  s_mov_b64 exec, -1
  s_add_u32 s67, s67, 1
  s_waitcnt vmcnt(4)
  v_max3_u32 v72, v0, v1, v2
  v_max_u32 v72, v72, v3
  ds_write_b128 v76, v[0:3] offset:4608
  v_cmp_eq_u32 vcc, -1, v72
  s_cbranch_vccz Cf0_h2w
Cf0_h2s:
  s_mov_b64 exec, vcc
  buffer_load_dwordx4 v[0:3], v76, s[8:11], s65 offen offset:0 sc1
  s_mov_b64 exec, -1
  s_add_u32 s67, s67, 1
  s_waitcnt vmcnt(2)
  v_max3_u32 v72, v0, v1, v2
  v_max_u32 v72, v72, v3
  ds_write_b128 v76, v[0:3] offset:4608
  v_cmp_eq_u32 vcc, -1, v72
  s_cbranch_vccz Cf0_h2w
  s_mov_b64 exec, vcc
  buffer_load_dwordx4 v[0:3], v76, s[8:11], s65 offen offset:0 sc1
  s_mov_b64 exec, -1
  s_add_u32 s67, s67, 1
  s_waitcnt vmcnt(2)
  v_max3_u32 v72, v0, v1, v2
  v_max_u32 v72, v72, v3
  ds_write_b128 v76, v[0:3] offset:4608
  v_cmp_eq_u32 vcc, -1, v72
  s_cbranch_vccz Cf0_h2w
  s_mov_b64 exec, vcc
  buffer_load_dwordx4 v[0:3], v76, s[8:11], s65 offen offset:0 sc1
  s_mov_b64 exec, -1
  s_add_u32 s67, s67, 1
  s_waitcnt vmcnt(2)
  v_max3_u32 v72, v0, v1, v2
  v_max_u32 v72, v72, v3
  ds_write_b128 v76, v[0:3] offset:4608
  v_cmp_eq_u32 vcc, -1, v72
  s_cbranch_vccz Cf0_h2w
  s_cmp_lt_u32 s67, 131072
  s_cbranch_scc1 Cf0_h2s
  s_branch Cf0_h2w
Cf0_rec:
  s_nop 7
  s_waitcnt vmcnt(0) lgkmcnt(0)
  v_max3_u32 v72, v0, v1, v2
  v_max3_u32 v72, v72, v3, v4
  v_max3_u32 v72, v72, v5, v6
  v_max3_u32 v72, v72, v7, v8
  v_max3_u32 v72, v72, v9, v10
  v_max3_u32 v72, v72, v11, v12
  v_max3_u32 v72, v72, v13, v14
  v_max3_u32 v72, v72, v15, v16
  v_max3_u32 v72, v72, v17, v18
  v_max_u32 v72, v72, v19
  v_cmp_eq_u32 vcc, -1, v72
  s_cbranch_vccz Cf0_recok
  s_barrier
  v_mov_b64 v[20:21], 0
  v_mov_b64 v[22:23], 0
  v_mov_b64 v[24:25], 0
  v_mov_b64 v[26:27], 0
  v_mov_b64 v[28:29], 0
  v_mov_b64 v[30:31], 0
  v_mov_b64 v[32:33], 0
  v_mov_b64 v[34:35], 0
  s_waitcnt lgkmcnt(0)
  s_barrier
  ds_read_b128 v[0:3], v76 offset:4608
  s_waitcnt lgkmcnt(0)
  v_smfmac_f32_16x16x64_bf16 v[20:23], v[0:3], v[80:87], v74
  v_smfmac_f32_16x16x64_bf16 v[24:27], v[0:3], v[88:95], v74
  ds_read_b128 v[60:63], v76 offset:16384
  ds_read_b128 v[64:67], v76 offset:17408
  s_waitcnt lgkmcnt(0)
  v_smfmac_f32_16x16x64_bf16 v[28:31], v[0:3], v[60:67], v74
  ds_read_b128 v[60:63], v76 offset:18432
  ds_read_b128 v[64:67], v76 offset:19456
  s_waitcnt lgkmcnt(0)
  v_smfmac_f32_16x16x64_bf16 v[32:35], v[0:3], v[60:67], v74
  ds_read_b128 v[4:7], v76 offset:5632
  s_waitcnt lgkmcnt(0)
  v_smfmac_f32_16x16x64_bf16 v[20:23], v[4:7], v[96:103], v74
  v_smfmac_f32_16x16x64_bf16 v[24:27], v[4:7], v[104:111], v74
  ds_read_b128 v[60:63], v76 offset:32768
  ds_read_b128 v[64:67], v76 offset:33792
  s_waitcnt lgkmcnt(0)
  v_smfmac_f32_16x16x64_bf16 v[28:31], v[4:7], v[60:67], v74
  ds_read_b128 v[60:63], v76 offset:34816
  ds_read_b128 v[64:67], v76 offset:35840
  s_waitcnt lgkmcnt(0)
  v_smfmac_f32_16x16x64_bf16 v[32:35], v[4:7], v[60:67], v74
  ds_read_b128 v[8:11], v76 offset:6656
  s_waitcnt lgkmcnt(0)
  v_smfmac_f32_16x16x64_bf16 v[20:23], v[8:11], v[112:119], v74
  v_smfmac_f32_16x16x64_bf16 v[24:27], v[8:11], v[120:127], v74
  v_smfmac_f32_16x16x64_bf16 v[28:31], v[8:11], v[208:215], v74
  v_smfmac_f32_16x16x64_bf16 v[32:35], v[8:11], v[216:223], v74
  ds_read_b128 v[12:15], v76 offset:7680
  s_waitcnt lgkmcnt(0)
  v_smfmac_f32_16x16x64_bf16 v[20:23], v[12:15], v[128:135], v74
  v_smfmac_f32_16x16x64_bf16 v[24:27], v[12:15], v[136:143], v74
  v_smfmac_f32_16x16x64_bf16 v[28:31], v[12:15], v[224:231], v74
  v_smfmac_f32_16x16x64_bf16 v[32:35], v[12:15], v[232:239], v74
  ds_read_b128 v[0:3], v76 offset:8704
  s_waitcnt lgkmcnt(0)
  v_smfmac_f32_16x16x64_bf16 v[20:23], v[0:3], v[144:151], v74
  v_smfmac_f32_16x16x64_bf16 v[24:27], v[0:3], v[152:159], v74
  ds_read_b128 v[60:63], v76 offset:49152
  ds_read_b128 v[64:67], v76 offset:50176
  s_waitcnt lgkmcnt(0)
  v_smfmac_f32_16x16x64_bf16 v[28:31], v[0:3], v[60:67], v74
  ds_read_b128 v[60:63], v76 offset:51200
  ds_read_b128 v[64:67], v76 offset:52224
  s_waitcnt lgkmcnt(0)
  v_smfmac_f32_16x16x64_bf16 v[32:35], v[0:3], v[60:67], v74
  ds_read_b128 v[8:11], v76 offset:9728
  s_waitcnt lgkmcnt(0)
  v_smfmac_f32_16x16x64_bf16 v[20:23], v[8:11], v[160:167], v74
  v_smfmac_f32_16x16x64_bf16 v[24:27], v[8:11], v[168:175], v74
  ds_read_b128 v[60:63], v75 offset:16384
  ds_read_b128 v[64:67], v75 offset:17408
  s_waitcnt lgkmcnt(0)
  v_smfmac_f32_16x16x64_bf16 v[28:31], v[8:11], v[60:67], v74
  ds_read_b128 v[60:63], v75 offset:18432
  ds_read_b128 v[64:67], v75 offset:19456
  s_waitcnt lgkmcnt(0)
  v_smfmac_f32_16x16x64_bf16 v[32:35], v[8:11], v[60:67], v74
  ds_read_b128 v[16:19], v76 offset:10752
  ds_read_b128 v[60:63], v75 offset:0
  ds_read_b128 v[64:67], v75 offset:1024
  s_waitcnt lgkmcnt(0)
  v_smfmac_f32_16x16x64_bf16 v[20:23], v[16:19], v[60:67], v74
  ds_read_b128 v[60:63], v75 offset:2048
  ds_read_b128 v[64:67], v75 offset:3072
  s_waitcnt lgkmcnt(0)
  v_smfmac_f32_16x16x64_bf16 v[24:27], v[16:19], v[60:67], v74
  v_smfmac_f32_16x16x64_bf16 v[28:31], v[16:19], v[240:247], v74
  v_smfmac_f32_16x16x64_bf16 v[32:35], v[16:19], v[248:255], v74
  ds_read_b128 v[4:7], v76 offset:11776
  s_waitcnt lgkmcnt(0)
  v_smfmac_f32_16x16x64_bf16 v[20:23], v[4:7], v[176:183], v74
  v_smfmac_f32_16x16x64_bf16 v[24:27], v[4:7], v[184:191], v74
  v_smfmac_f32_16x16x64_bf16 v[28:31], v[4:7], a[0:7], v74
  v_smfmac_f32_16x16x64_bf16 v[32:35], v[4:7], a[8:15], v74
  ds_read_b128 v[12:15], v76 offset:12800
  s_waitcnt lgkmcnt(0)
  v_smfmac_f32_16x16x64_bf16 v[20:23], v[12:15], v[192:199], v74
  v_smfmac_f32_16x16x64_bf16 v[24:27], v[12:15], v[200:207], v74
  v_smfmac_f32_16x16x64_bf16 v[28:31], v[12:15], a[16:23], v74
  v_smfmac_f32_16x16x64_bf16 v[32:35], v[12:15], a[24:31], v74
  v_add_f32 v20, v20, v22
  v_add_f32 v21, v21, v23
  v_add_f32 v24, v24, v26
  v_cvt_pk_bf16_f32 v22, v20, v24
  ds_write_b32 v79, v22 offset:0
  v_add_f32 v25, v25, v27
  v_cvt_pk_bf16_f32 v23, v21, v25
  ds_write_b32 v79, v23 offset:576
  v_add_f32 v28, v28, v30
  v_add_f32 v29, v29, v31
  s_waitcnt lgkmcnt(0)
  s_nop 1
  s_branch Cf0_recok
Cf0_mx:
  s_waitcnt lgkmcnt(0)
  s_barrier
  buffer_load_dwordx4 v[52:55], v76, s[8:11], s59 offen offset:0 sc1
  buffer_load_dwordx4 v[0:3], v76, s[8:11], s58 offen offset:0 sc1
  ds_read_b128 v[20:23], v77 offset:0
  ds_read_b128 v[28:31], v77 offset:256
  buffer_load_dwordx4 v[56:59], v76, s[8:11], s59 offen offset:1024 sc1
  buffer_load_dwordx4 v[4:7], v76, s[8:11], s58 offen offset:1024 sc1
  ds_read_b128 v[24:27], v77 offset:128
  ds_read_b128 v[32:35], v77 offset:384
  s_waitcnt vmcnt(2) lgkmcnt(3)
  v_mfma_f32_16x16x32_bf16 v[8:11], v[0:3], v[20:23], 0
  s_waitcnt vmcnt(0) lgkmcnt(1)
  v_mfma_f32_16x16x32_bf16 v[8:11], v[4:7], v[24:27], v[8:11]
  v_mfma_f32_16x16x32_bf16 v[12:15], v[28:31], v[20:23], 0
  s_waitcnt lgkmcnt(0)
  v_mfma_f32_16x16x32_bf16 v[12:15], v[32:35], v[24:27], v[12:15]
  v_add_f32_dpp v8, v10, v8 quad_perm:[2,3,0,1] row_mask:0xf bank_mask:0xf
  v_add_f32_dpp v9, v11, v9 quad_perm:[2,3,0,1] row_mask:0xf bank_mask:0xf
  s_nop 0
  v_mov_b32_dpp v8, v8 quad_perm:[0,1,0,1] row_mask:0xf bank_mask:0xf
  v_mov_b32_dpp v9, v9 quad_perm:[0,1,0,1] row_mask:0xf bank_mask:0xf
  s_nop 1
  v_add_f32_dpp v12, v14, v12 quad_perm:[2,3,0,1] row_mask:0xf bank_mask:0xf
  v_add_f32_dpp v13, v15, v13 quad_perm:[2,3,0,1] row_mask:0xf bank_mask:0xf
  s_nop 0
  v_mov_b32_dpp v12, v12 quad_perm:[0,1,0,1] row_mask:0xf bank_mask:0xf
  v_mov_b32_dpp v13, v13 quad_perm:[0,1,0,1] row_mask:0xf bank_mask:0xf
  v_mul_f32 v12, s69, v12
  ds_write_b32 v78, v8 offset:8704
  v_mul_f32 v13, s69, v13
  ds_write_b32 v78, v9 offset:8768
  s_waitcnt lgkmcnt(0)
  s_barrier
  ds_read_b128 v[36:39], v78 offset:8704
  ds_read_b128 v[40:43], v78 offset:8768
  s_waitcnt lgkmcnt(0)
  s_barrier
  v_max_f32 v16, v36, v37
  v_max3_f32 v16, v16, v38, v39
  v_max3_f32 v16, v16, v40, v41
  v_max3_f32 v16, v16, v42, v43
  v_max3_f32 v16, v16, v12, v13
  v_mov_b32 v17, v16
  s_nop 1
  v_permlane16_swap_b32 v16, v17
  v_max_f32 v16, v16, v17
  v_mov_b32 v17, v16
  s_nop 1
  v_permlane32_swap_b32 v16, v17
  v_max_f32 v16, v16, v17
  v_sub_f32 v36, v36, v16
  v_sub_f32 v37, v37, v16
  v_sub_f32 v38, v38, v16
  v_sub_f32 v39, v39, v16
  v_sub_f32 v40, v40, v16
  v_sub_f32 v41, v41, v16
  v_sub_f32 v42, v42, v16
  v_sub_f32 v43, v43, v16
  v_sub_f32 v12, v12, v16
  v_sub_f32 v13, v13, v16
  v_exp_f32 v36, v36
  v_exp_f32 v37, v37
  v_exp_f32 v38, v38
  v_exp_f32 v39, v39
  v_exp_f32 v40, v40
  v_exp_f32 v41, v41
  v_exp_f32 v42, v42
  v_exp_f32 v43, v43
  v_exp_f32 v12, v12
  v_exp_f32 v13, v13
  v_cvt_pk_bf16_f32 v32, v36, v40
  v_cvt_pk_bf16_f32 v33, v37, v41
  v_cvt_pk_bf16_f32 v34, v38, v42
  v_cvt_pk_bf16_f32 v35, v39, v43
  v_cvt_pk_bf16_f32 v28, v12, v13
  v_cvt_pk_bf16_f32 v31, v12, v13
  v_mov_b32 v29, 0
  v_mov_b32 v30, 0
  v_mfma_f32_16x16x32_bf16 v[8:11], v[32:35], v[68:71], 0
  v_mfma_f32_16x16x32_bf16 v[0:3], v[32:35], v[52:55], 0
  v_mfma_f32_16x16x32_bf16 v[4:7], v[32:35], v[56:59], 0
  v_mfma_f32_16x16x16_bf16 v[8:11], v[28:29], v[68:69], v[8:11]
  v_mfma_f32_16x16x16_bf16 v[0:3], v[28:29], v[72:73], v[0:3]
  v_mfma_f32_16x16x16_bf16 v[4:7], v[30:31], v[72:73], v[4:7]
  ds_read_b128 v[52:55], v75 offset:32768
  v_rcp_f32 v10, v8
  v_rcp_f32 v11, v9
  v_mul_f32 v0, v10, v0
  v_mul_f32 v1, v11, v1
  v_max3_f32 v8, v8, v9, v10
  v_mul_f32 v4, v10, v4
  v_mul_f32 v5, v11, v5
  v_cvt_pk_bf16_f32 v2, v0, v4
  ds_write_b32 v79, v2 offset:8704
  v_cvt_pk_bf16_f32 v3, v1, v5
  ds_write_b32 v79, v3 offset:9280
  ds_read_b128 v[12:15], v78 offset:8704
  ds_read_b128 v[56:59], v75 offset:33792
  v_mov_b64 v[16:17], 0
  v_mov_b64 v[18:19], 0
  v_mov_b64 v[20:21], 0
  v_mov_b64 v[22:23], 0
  v_mov_b64 v[24:25], 0
  v_mov_b64 v[26:27], 0
  s_branch Cf0_mxok
Cf0_kv3:
  s_waitcnt lgkmcnt(0)
  s_cmp_ge_u32 s57, 0x700
  s_cbranch_scc1 Cf0_kvb
  s_load_dword s57, s[12:13], s71 glc
  s_add_u32 s67, s67, 1
  s_cmp_lt_u32 s67, 131072
  s_cbranch_scc1 Cf0_kv3
  s_waitcnt lgkmcnt(0)
  s_branch Cf0_kvb
Cf0_last:
  ds_read_b128 v[4:7], v76 offset:5632
  ds_read_b128 v[12:15], v76 offset:7680
  ds_read_b128 v[44:47], v76 offset:32768
  ds_read_b128 v[48:51], v76 offset:33792
  s_nop 5
  v_mov_b64 v[20:21], 0
  v_mov_b64 v[22:23], 0
  v_mov_b64 v[24:25], 0
  v_mov_b64 v[26:27], 0
  v_smfmac_f32_16x16x64_bf16 v[28:31], v[0:3], v[36:43], v74
  ds_read_b128 v[36:39], v76 offset:34816
  ds_read_b128 v[40:43], v76 offset:35840
  v_smfmac_f32_16x16x64_bf16 v[32:35], v[0:3], v[60:67], v74
  s_waitcnt lgkmcnt(5)
  v_smfmac_f32_16x16x64_bf16 v[20:23], v[0:3], a[32:39], v74
  ds_read_b128 v[60:63], v76 offset:49152
  ds_read_b128 v[64:67], v76 offset:50176
  v_smfmac_f32_16x16x64_bf16 v[24:27], v[0:3], a[40:47], v74
  s_waitcnt lgkmcnt(4)
  v_smfmac_f32_16x16x64_bf16 v[20:23], v[4:7], a[48:55], v74
  buffer_store_dwordx4 v[16:19], v76, s[8:11], s68 offen sc1
  v_smfmac_f32_16x16x64_bf16 v[24:27], v[4:7], a[56:63], v74
  v_smfmac_f32_16x16x64_bf16 v[28:31], v[4:7], v[44:51], v74
  s_waitcnt lgkmcnt(2)
  v_smfmac_f32_16x16x64_bf16 v[20:23], v[8:11], a[64:71], v74
  ds_read_b128 v[44:47], v76 offset:51200
  ds_read_b128 v[48:51], v76 offset:52224
  v_smfmac_f32_16x16x64_bf16 v[24:27], v[8:11], a[72:79], v74
  v_smfmac_f32_16x16x64_bf16 v[32:35], v[4:7], v[36:43], v74
  v_smfmac_f32_16x16x64_bf16 v[28:31], v[8:11], v[208:215], v74
  ds_read_b128 v[36:39], v75 offset:16384
  ds_read_b128 v[40:43], v75 offset:17408
  v_smfmac_f32_16x16x64_bf16 v[32:35], v[8:11], v[216:223], v74
  v_smfmac_f32_16x16x64_bf16 v[20:23], v[12:15], a[80:87], v74
  v_smfmac_f32_16x16x64_bf16 v[24:27], v[12:15], a[88:95], v74
  v_smfmac_f32_16x16x64_bf16 v[28:31], v[12:15], v[224:231], v74
  v_smfmac_f32_16x16x64_bf16 v[32:35], v[12:15], v[232:239], v74
  s_waitcnt vmcnt(2)
  s_waitcnt vmcnt(1)
  s_barrier
Cf0_lastr:
  ds_read_b128 v[0:3], v76 offset:8704
  ds_read_b128 v[8:11], v76 offset:9728
  ds_read_b128 v[16:19], v76 offset:10752
  ds_read_b128 v[4:7], v76 offset:11776
  ds_read_b128 v[12:15], v76 offset:12800
  s_waitcnt lgkmcnt(4)
  v_max3_u32 v72, v0, v1, v2
  s_waitcnt lgkmcnt(1)
  v_max3_u32 v72, v72, v3, v4
  v_max3_u32 v72, v72, v5, v6
  v_max3_u32 v72, v72, v7, v8
  v_max3_u32 v72, v72, v9, v10
  s_waitcnt lgkmcnt(0)
  v_max3_u32 v72, v72, v11, v12
  v_max3_u32 v72, v72, v13, v14
  v_max3_u32 v72, v72, v15, v16
  v_max3_u32 v72, v72, v17, v18
  v_max_u32 v72, v72, v19
  v_cmp_eq_u32 vcc, -1, v72
  s_cbranch_vccnz Cf0_lastp
Cf0_lastg:
  v_smfmac_f32_16x16x64_bf16 v[28:31], v[0:3], v[60:67], v74
  ds_read_b128 v[60:63], v75 offset:18432
  ds_read_b128 v[64:67], v75 offset:19456
  v_smfmac_f32_16x16x64_bf16 v[32:35], v[0:3], v[44:51], v74
  v_smfmac_f32_16x16x64_bf16 v[28:31], v[8:11], v[36:43], v74
  v_smfmac_f32_16x16x64_bf16 v[28:31], v[16:19], v[240:247], v74
  v_smfmac_f32_16x16x64_bf16 v[28:31], v[4:7], a[0:7], v74
  v_smfmac_f32_16x16x64_bf16 v[28:31], v[12:15], a[16:23], v74
  v_smfmac_f32_16x16x64_bf16 v[32:35], v[16:19], v[248:255], v74
  v_smfmac_f32_16x16x64_bf16 v[32:35], v[4:7], a[8:15], v74
  s_waitcnt lgkmcnt(0)
  v_smfmac_f32_16x16x64_bf16 v[32:35], v[12:15], a[24:31], v74
  v_smfmac_f32_16x16x64_bf16 v[32:35], v[8:11], v[60:67], v74
  v_smfmac_f32_16x16x64_bf16 v[20:23], v[0:3], a[96:103], v74
  v_smfmac_f32_16x16x64_bf16 v[20:23], v[8:11], a[112:119], v74
  v_add_f32 v28, v28, v30
  v_add_f32 v32, v32, v34
  v_cvt_pk_bf16_f32 v30, v28, v32
  v_smfmac_f32_16x16x64_bf16 v[20:23], v[16:19], a[128:135], v74
  ds_write_b32 v79, v30 offset:256
  v_add_f32 v29, v29, v31
  v_add_f32 v33, v33, v35
  v_cvt_pk_bf16_f32 v31, v29, v33
  v_smfmac_f32_16x16x64_bf16 v[20:23], v[4:7], a[144:151], v74
  ds_write_b32 v79, v31 offset:832
  v_smfmac_f32_16x16x64_bf16 v[20:23], v[12:15], a[160:167], v74
  v_smfmac_f32_16x16x64_bf16 v[24:27], v[0:3], a[104:111], v74
  v_smfmac_f32_16x16x64_bf16 v[24:27], v[8:11], a[120:127], v74
  v_smfmac_f32_16x16x64_bf16 v[24:27], v[16:19], a[136:143], v74
  s_waitcnt lgkmcnt(0)
  s_barrier
  ds_read_b64 v[52:53], v77 offset:256
  v_add_f32 v20, v20, v22
  v_smfmac_f32_16x16x64_bf16 v[24:27], v[4:7], a[152:159], v74
  v_add_f32 v21, v21, v23
  v_smfmac_f32_16x16x64_bf16 v[24:27], v[12:15], a[168:175], v74
  v_cvt_pk_bf16_f32 v54, v20, v21
  s_add_u32 s68, s68, 655360
  s_nop 3
  v_add_f32 v24, v24, v26
  v_add_f32 v25, v25, v27
  v_cvt_pk_bf16_f32 v55, v24, v25
  s_waitcnt lgkmcnt(0)
  buffer_store_dwordx4 v[52:55], v76, s[8:11], s68 offen sc1
  s_branch Cf0_done
Cf0_lastp:
  s_add_u32 s72, s72, 2
  s_cmp_ge_u32 s72, 131072
  s_cbranch_scc1 Cf0_lastg
  s_barrier
  buffer_load_dwordx4 v76, s[8:11], s85 offen offset:0 sc1 lds
  s_waitcnt vmcnt(0)
  s_barrier
  s_branch Cf0_lastr
Cf0_done:
  s_branch L_cexit
L_w1:
  v_mov_b64 v[20:21], 0
  v_mov_b64 v[22:23], 0
  v_mov_b64 v[24:25], 0
  v_mov_b64 v[26:27], 0
  v_mov_b64 v[28:29], 0
  v_mov_b64 v[30:31], 0
  v_mov_b64 v[32:33], 0
  v_mov_b64 v[34:35], 0
  s_mov_b32 s78, 0x3f803f80
  s_mov_b32 s79, s78
  s_mov_b32 s65, 360448
  s_mov_b32 m0, 15872
  s_lshl_b32 s71, s53, 2
  s_add_u32 s71, s71, 128
  s_movk_i32 s56, 0x1000
  v_lshlrev_b32 v73, 2, v76
  v_mov_b32 v72, 0
  s_mov_b64 s[16:17], s[8:9]
  s_mov_b32 s18, 268435456
  s_mov_b32 s19, 0x20000
  s_getpc_b64 s[20:21]
Cf1_pc:
  s_add_u32 s20, s20, (Cf1_last - Cf1_pc)
  s_addc_u32 s21, s21, 0
  v_mov_b32 v68, 14880
  buffer_load_dwordx4 v[52:55], v76, s[8:11], s59 offen offset:0 sc1
  buffer_load_dwordx4 v[56:59], v76, s[8:11], s59 offen offset:1024 sc1
  ds_read_b128 v[36:39], v76 offset:20480
  ds_read_b128 v[40:43], v76 offset:21504
  ds_read_b128 v[60:63], v76 offset:22528
  ds_read_b128 v[64:67], v76 offset:23552
  ds_read_b128 v[0:3], v76 offset:4608
  ds_read_b128 v[4:7], v76 offset:5632
  ds_read_b128 v[8:11], v76 offset:6656
  ds_read_b128 v[12:15], v76 offset:7680
  s_waitcnt lgkmcnt(0)
  s_cmp_eq_u32 s66, 1
  s_branch Cf1_top2
.p2align 6
Cf1_h2:
  ds_read_b128 v[36:39], v76 offset:20480
  s_waitcnt lgkmcnt(0)
  buffer_load_dwordx4 v[8:11], v76, s[8:11], s65 offen offset:2048 sc1
  ds_read_b128 v[40:43], v76 offset:21504
  s_waitcnt lgkmcnt(0)
  v_lshlrev_b32 v73, 2, v76
  buffer_load_dwordx4 v[8:11], v76, s[8:11], s65 offen offset:2048 sc1
  ds_read_b128 v[60:63], v76 offset:22528
  s_waitcnt lgkmcnt(0)
  s_cmp_eq_u32 s66, 62
  s_cselect_b64 s[16:17], s[20:21], s[16:17]
  s_cselect_b32 s18, (Cf1_done - Cf1_last), s18
  s_cselect_b32 s70, 0, s70
  s_cmp_eq_u32 s66, 63
  s_cselect_b32 s59, 268435456, s59
  s_cselect_b32 s58, 268435456, s58
  buffer_load_dwordx4 v[8:11], v76, s[8:11], s65 offen offset:2048 sc1
  buffer_load_dwordx4 v[52:55], v76, s[8:11], s59 offen offset:0 sc1
  buffer_load_dwordx4 v[56:59], v76, s[8:11], s59 offen offset:1024 sc1
  s_waitcnt vmcnt(4)
  v_max3_u32 v72, v8, v9, v10
  v_max_u32 v72, v72, v11
  ds_write_b128 v76, v[8:11] offset:6656
  v_cmp_eq_u32 vcc, -1, v72
  s_cbranch_vccnz Cf1_h2r
Cf1_h2w:
  s_cmp_eq_u32 s66, 63
  s_waitcnt lgkmcnt(0)
  s_barrier
  ds_read_b128 v[0:3], v76 offset:4608
  buffer_load_dwordx4 v76, s[8:11], s85 offen offset:0 sc1 lds
Cf1_top2:
  v_smfmac_f32_16x16x64_bf16 v[20:23], v[8:11], v[112:119], v74
  s_cbranch_scc1 Cf1_last
  v_smfmac_f32_16x16x64_bf16 v[24:27], v[8:11], v[120:127], v74
  buffer_load_dwordx4 v[44:47], v76, s[8:11], s58 offen offset:0 sc1
  s_mov_b32 m0, 15872
  v_smfmac_f32_16x16x64_bf16 v[28:31], v[8:11], v[208:215], v74
  buffer_load_dwordx4 v[48:51], v76, s[8:11], s58 offen offset:1024 sc1
  v_smfmac_f32_16x16x64_bf16 v[32:35], v[8:11], v[216:223], v74
  ds_read_b128 v[4:7], v76 offset:5632
  s_waitcnt lgkmcnt(1)
  v_smfmac_f32_16x16x64_bf16 v[20:23], v[0:3], v[80:87], v74
  ds_read_b128 v[12:15], v76 offset:7680
  v_smfmac_f32_16x16x64_bf16 v[28:31], v[0:3], v[36:43], v74
  ds_read_b128 v[36:39], v76 offset:36864
  v_smfmac_f32_16x16x64_bf16 v[24:27], v[0:3], v[88:95], v74
  buffer_store_dwordx4 v[16:19], v76, s[8:11], s68 offen sc1
  ds_read_b128 v[40:43], v76 offset:37888
  v_smfmac_f32_16x16x64_bf16 v[32:35], v[0:3], v[60:67], v74
  buffer_load_dword v73, s[16:19], s70 offen lds
  ds_read_b128 v[60:63], v76 offset:38912
  s_waitcnt lgkmcnt(4)
  v_smfmac_f32_16x16x64_bf16 v[20:23], v[4:7], v[96:103], v74
  ds_read_b128 v[64:67], v76 offset:39936
  v_smfmac_f32_16x16x64_bf16 v[24:27], v[4:7], v[104:111], v74
  s_waitcnt vmcnt(5)
  s_waitcnt lgkmcnt(4)
  v_smfmac_f32_16x16x64_bf16 v[20:23], v[12:15], v[128:135], v74
  s_barrier
  ds_read_b128 v[8:11], v76 offset:8704
  s_waitcnt lgkmcnt(3)
  v_smfmac_f32_16x16x64_bf16 v[28:31], v[4:7], v[36:43], v74
  ds_read_b128 v[36:39], v76 offset:53248
  v_smfmac_f32_16x16x64_bf16 v[24:27], v[12:15], v[136:143], v74
  ds_read_b128 v[40:43], v76 offset:54272
  s_waitcnt lgkmcnt(3)
  v_smfmac_f32_16x16x64_bf16 v[32:35], v[4:7], v[60:67], v74
  ds_read_b128 v[0:3], v76 offset:9728
  v_smfmac_f32_16x16x64_bf16 v[28:31], v[12:15], v[224:231], v74
  ds_read_b128 v[60:63], v76 offset:55296
  v_smfmac_f32_16x16x64_bf16 v[32:35], v[12:15], v[232:239], v74
  s_waitcnt vmcnt(4)
  ds_read_b128 v[64:67], v76 offset:56320
  s_waitcnt lgkmcnt(5)
  v_smfmac_f32_16x16x64_bf16 v[20:23], v[8:11], v[144:151], v74
  s_barrier
  ds_read_b128 v[4:7], v76 offset:11776
  s_waitcnt lgkmcnt(4)
  v_smfmac_f32_16x16x64_bf16 v[28:31], v[8:11], v[36:43], v74
  ds_read_b128 v[12:15], v76 offset:12800
  ds_read_b128 v[36:39], v75 offset:4096
  v_smfmac_f32_16x16x64_bf16 v[24:27], v[8:11], v[152:159], v74
  ds_read_b128 v[16:19], v76 offset:10752
  s_waitcnt lgkmcnt(6)
  v_smfmac_f32_16x16x64_bf16 v[20:23], v[0:3], v[160:167], v74
  ds_read_b128 v[40:43], v75 offset:5120
  s_waitcnt lgkmcnt(5)
  v_smfmac_f32_16x16x64_bf16 v[32:35], v[8:11], v[60:67], v74
  ds_read_b128 v[60:63], v75 offset:6144
  v_smfmac_f32_16x16x64_bf16 v[24:27], v[0:3], v[168:175], v74
  ds_read_b128 v[64:67], v75 offset:7168
  s_waitcnt lgkmcnt(6)
  v_smfmac_f32_16x16x64_bf16 v[20:23], v[4:7], v[176:183], v74
  s_waitcnt lgkmcnt(5)
  v_smfmac_f32_16x16x64_bf16 v[20:23], v[12:15], v[192:199], v74
  s_waitcnt lgkmcnt(2)
  v_smfmac_f32_16x16x64_bf16 v[20:23], v[16:19], v[36:43], v74
  ds_read_b128 v[36:39], v75 offset:20480
  v_smfmac_f32_16x16x64_bf16 v[24:27], v[4:7], v[184:191], v74
  ds_read_b128 v[40:43], v75 offset:21504
  s_waitcnt lgkmcnt(2)
  v_smfmac_f32_16x16x64_bf16 v[24:27], v[16:19], v[60:67], v74
  ds_read_b128 v[60:63], v75 offset:22528
  v_add_f32 v20, v20, v22
  v_smfmac_f32_16x16x64_bf16 v[24:27], v[12:15], v[200:207], v74
  ds_read_b128 v[64:67], v75 offset:23552
  v_add_f32 v21, v21, v23
  v_smfmac_f32_16x16x64_bf16 v[28:31], v[16:19], v[240:247], v74
  v_mov_b64 v[70:71], s[78:79]
  v_smfmac_f32_16x16x64_bf16 v[28:31], v[4:7], a[0:7], v74
  s_waitcnt lgkmcnt(2)
  v_add_f32 v24, v24, v26
  v_smfmac_f32_16x16x64_bf16 v[28:31], v[0:3], v[36:43], v74
  ds_read_b128 v[36:39], v68
  v_cvt_pk_bf16_f32 v22, v20, v24
  v_smfmac_f32_16x16x64_bf16 v[28:31], v[12:15], a[16:23], v74
  ds_read_b128 v[40:43], v68
  ds_write_b32 v79, v22 offset:0
  s_waitcnt lgkmcnt(3)
  v_add_f32 v25, v25, v27
  v_cvt_pk_bf16_f32 v23, v21, v25
  v_smfmac_f32_16x16x64_bf16 v[32:35], v[0:3], v[60:67], v74
  ds_write_b32 v79, v23 offset:576
  v_cmp_u_f32 vcc, v20, v21
  v_smfmac_f32_16x16x64_bf16 v[32:35], v[16:19], v[248:255], v74
  v_add_f32 v28, v28, v30
  v_smfmac_f32_16x16x64_bf16 v[32:35], v[4:7], a[8:15], v74
  v_add_f32 v29, v29, v31
  v_smfmac_f32_16x16x64_bf16 v[32:35], v[12:15], a[24:31], v74
  s_cbranch_vccnz Cf1_rec
Cf1_recok:
  s_waitcnt lgkmcnt(3)
  v_smfmac_f32_16x16x64_bf16 v[36:39], v[16:19], a[128:135], v74
  s_waitcnt lgkmcnt(0)
  s_barrier
  ds_read_b128 v[60:63], v77
  v_smfmac_f32_16x16x64_bf16 v[40:43], v[16:19], a[136:143], v74
  ds_read_b128 v[64:67], v77 offset:128
  v_add_f32 v32, v32, v34
  v_cvt_pk_bf16_f32 v30, v28, v32
  v_smfmac_f32_16x16x64_bf16 v[36:39], v[0:3], a[112:119], v74
  ds_write_b32 v79, v30 offset:256
  v_add_f32 v33, v33, v35
  v_cvt_pk_bf16_f32 v31, v29, v33
  v_smfmac_f32_16x16x64_bf16 v[40:43], v[0:3], a[120:127], v74
  ds_write_b32 v79, v31 offset:832
  v_xor_b32 v75, 0x8000, v75
  v_smfmac_f32_16x16x64_bf16 v[36:39], v[4:7], a[144:151], v74
  ds_read_b128 v[0:3], v76 offset:4608
  v_mov_b32 v29, 0
  v_smfmac_f32_16x16x64_bf16 v[40:43], v[4:7], a[152:159], v74
  s_waitcnt vmcnt(2) lgkmcnt(3)
  v_mov_b32 v30, 0
  v_mfma_f32_16x16x32_bf16 v[44:47], v[44:47], v[60:63], 0
  ds_read_b128 v[4:7], v76 offset:5632
  s_waitcnt lgkmcnt(2)
  v_mfma_f32_16x16x32_bf16 v[44:47], v[48:51], v[64:67], v[44:47]
  s_barrier
  v_smfmac_f32_16x16x64_bf16 v[36:39], v[8:11], a[96:103], v74
  ds_read_b128 v[20:23], v77 offset:256
  ds_read_b128 v[24:27], v77 offset:384
  v_smfmac_f32_16x16x64_bf16 v[40:43], v[8:11], a[104:111], v74
  ds_read_b128 v[8:11], v76 offset:6656
  v_add_f32_dpp v72, v46, v44 quad_perm:[2,3,0,1] row_mask:0xf bank_mask:0xf
  v_add_f32_dpp v73, v47, v45 quad_perm:[2,3,0,1] row_mask:0xf bank_mask:0xf
  v_smfmac_f32_16x16x64_bf16 v[36:39], v[12:15], a[160:167], v74
  s_waitcnt lgkmcnt(4)
  v_exp_f32_dpp v72, v72 quad_perm:[0,1,0,1] row_mask:0xf bank_mask:0xf
  v_smfmac_f32_16x16x64_bf16 v[40:43], v[12:15], a[168:175], v74
  ds_read_b128 v[12:15], v76 offset:7680
  v_exp_f32_dpp v73, v73 quad_perm:[0,1,0,1] row_mask:0xf bank_mask:0xf
  v_smfmac_f32_16x16x64_bf16 v[36:39], v[0:3], a[32:39], v74
  s_waitcnt lgkmcnt(2)
  v_cvt_pk_bf16_f32 v72, v72, v73
  v_mfma_f32_16x16x32_bf16 v[20:23], v[20:23], v[60:63], 0
  ds_write_b32 v78, v72 offset:516
  v_mov_b64 v[16:17], 0
  v_mfma_f32_16x16x32_bf16 v[20:23], v[24:27], v[64:67], v[20:23]
  ds_read_b128 v[44:47], v75 offset:22528
  v_mov_b64 v[18:19], 0
  v_smfmac_f32_16x16x64_bf16 v[40:43], v[0:3], a[40:47], v74
  ds_read_b128 v[48:51], v75 offset:23552
  v_mov_b64 v[68:69], s[78:79]
  v_smfmac_f32_16x16x64_bf16 v[36:39], v[4:7], a[48:55], v74
  s_waitcnt lgkmcnt(4)
  v_add_f32_dpp v24, v22, v20 quad_perm:[2,3,0,1] row_mask:0xf bank_mask:0xf
  v_add_f32_dpp v25, v23, v21 quad_perm:[2,3,0,1] row_mask:0xf bank_mask:0xf
  v_smfmac_f32_16x16x64_bf16 v[36:39], v[8:11], a[64:71], v74
  s_waitcnt lgkmcnt(2)
  s_barrier
  ds_read_b128 v[32:35], v78 offset:512
  v_smfmac_f32_16x16x64_bf16 v[36:39], v[12:15], a[80:87], v74
  ds_read_b128 v[60:63], v75 offset:20480
  v_mul_f32 v24, s69, v24
  v_smfmac_f32_16x16x64_bf16 v[40:43], v[4:7], a[56:63], v74
  ds_read_b128 v[64:67], v75 offset:21504
  v_mul_f32 v25, s69, v25
  v_smfmac_f32_16x16x64_bf16 v[40:43], v[8:11], a[72:79], v74
  v_exp_f32_dpp v24, v24 quad_perm:[0,1,0,1] row_mask:0xf bank_mask:0xf
  v_smfmac_f32_16x16x64_bf16 v[40:43], v[12:15], a[88:95], v74
  s_waitcnt lgkmcnt(2)
  v_exp_f32_dpp v25, v25 quad_perm:[0,1,0,1] row_mask:0xf bank_mask:0xf
  v_mfma_f32_16x16x32_bf16 v[8:11], v[32:35], v[68:71], 0
  v_add_f32 v36, v36, v38
  v_add_f32 v37, v37, v39
  v_mfma_f32_16x16x32_bf16 v[0:3], v[32:35], v[52:55], 0
  v_add_f32 v40, v40, v42
  v_add_f32 v41, v41, v43
  v_mfma_f32_16x16x32_bf16 v[4:7], v[32:35], v[56:59], 0
  v_cvt_pk_bf16_f32 v28, v24, v25
  v_cvt_pk_bf16_f32 v72, v36, v37
  v_cvt_pk_bf16_f32 v73, v40, v41
  v_mfma_f32_16x16x16_bf16 v[8:11], v[28:29], v[68:69], v[8:11]
  v_cvt_pk_bf16_f32 v31, v24, v25
  v_mov_b64 v[20:21], 0
  v_mfma_f32_16x16x16_bf16 v[0:3], v[28:29], v[72:73], v[0:3]
  ds_read_b128 v[52:55], v75 offset:36864
  v_mov_b64 v[22:23], 0
  v_mfma_f32_16x16x16_bf16 v[4:7], v[30:31], v[72:73], v[4:7]
  v_rcp_f32 v10, v8
  v_rcp_f32 v11, v9
  v_mul_f32 v0, v10, v0
  v_mul_f32 v1, v11, v1
  v_max3_f32 v8, v8, v9, v10
  v_mul_f32 v4, v10, v4
  v_mul_f32 v5, v11, v5
  v_cvt_pk_bf16_f32 v2, v0, v4
  ds_write_b32 v79, v2 offset:8704
  v_cvt_pk_bf16_f32 v3, v1, v5
  ds_write_b32 v79, v3 offset:9280
  ds_read_b128 v[12:15], v78 offset:8768
  v_max_f32 v8, v8, v11
  v_cmp_le_f32 vcc, 1317011456, v8
  v_mov_b64 v[24:25], 0
  v_mov_b64 v[26:27], 0
  ds_read_b128 v[56:59], v75 offset:37888
  s_cbranch_vccnz Cf1_mx
Cf1_mxok:
  s_waitcnt lgkmcnt(2)
  s_barrier
  ds_read_b128 v[0:3], v78 offset:8704
  s_waitcnt lgkmcnt(2)
  v_smfmac_f32_16x16x64_bf16 v[16:19], v[12:15], v[44:51], v74
  ds_read_b128 v[4:7], v78 offset:8832
  v_smfmac_f32_16x16x64_bf16 v[20:23], v[12:15], a[200:207], v74
  ds_read_b128 v[8:11], v78 offset:8896
  v_smfmac_f32_16x16x64_bf16 v[24:27], v[12:15], a[216:223], v74
  ds_read_b128 v[36:39], v75 offset:38912
  s_waitcnt lgkmcnt(3)
  v_smfmac_f32_16x16x64_bf16 v[16:19], v[0:3], v[60:67], v74
  ds_read_b128 v[40:43], v75 offset:39936
  s_waitcnt lgkmcnt(3)
  v_smfmac_f32_16x16x64_bf16 v[16:19], v[4:7], a[176:183], v74
  ds_read_b128 v[68:71], v76 offset:13824
  s_waitcnt lgkmcnt(3)
  v_smfmac_f32_16x16x64_bf16 v[16:19], v[8:11], a[184:191], v74
  ds_read_b128 v[44:47], v75 offset:53248
  v_smfmac_f32_16x16x64_bf16 v[20:23], v[0:3], a[192:199], v74
  ds_read_b128 v[48:51], v75 offset:54272
  v_smfmac_f32_16x16x64_bf16 v[20:23], v[4:7], v[52:59], v74
  ds_read_b128 v[60:63], v75 offset:55296
  s_waitcnt lgkmcnt(4)
  v_cvt_pk_bf16_f32 v16, v16, v17
  v_cvt_pk_bf16_f32 v17, v18, v19
  v_bfi_b32 v16, 1, s72, v16
  v_smfmac_f32_16x16x64_bf16 v[20:23], v[8:11], v[36:43], v74
  s_waitcnt lgkmcnt(3)
  buffer_store_dwordx2 v[16:17], v68, s[8:11], s73 offen
  v_mov_b64 v[32:33], 0
  v_smfmac_f32_16x16x64_bf16 v[24:27], v[0:3], a[208:215], v74
  ds_read_b128 v[64:67], v75 offset:56320
  v_mov_b64 v[34:35], 0
  v_smfmac_f32_16x16x64_bf16 v[24:27], v[4:7], a[224:231], v74
  v_cvt_pk_bf16_f32 v20, v20, v21
  v_cvt_pk_bf16_f32 v21, v22, v23
  v_bfi_b32 v20, 1, s72, v20
  v_smfmac_f32_16x16x64_bf16 v[24:27], v[8:11], a[232:239], v74
  buffer_store_dwordx2 v[20:21], v68, s[8:11], s74 offen
  s_waitcnt lgkmcnt(2)
  v_smfmac_f32_16x16x64_bf16 v[32:35], v[0:3], v[44:51], v74
  s_waitcnt lgkmcnt(0)
  v_smfmac_f32_16x16x64_bf16 v[32:35], v[12:15], v[60:67], v74
  v_cvt_pk_bf16_f32 v24, v24, v25
  v_cvt_pk_bf16_f32 v25, v26, v27
  v_bfi_b32 v24, 1, s72, v24
  v_smfmac_f32_16x16x64_bf16 v[32:35], v[4:7], a[240:247], v74
  buffer_store_dwordx2 v[24:25], v68, s[8:11], s75 offen
  v_smfmac_f32_16x16x64_bf16 v[32:35], v[8:11], a[248:255], v74
  v_mov_b64 v[18:19], v[72:73]
  s_nop 4
  v_cvt_pk_bf16_f32 v32, v32, v33
  v_cvt_pk_bf16_f32 v33, v34, v35
  v_bfi_b32 v32, 1, s72, v32
  buffer_store_dwordx2 v[32:33], v68, s[8:11], s76 offen
  ds_read_b128 v[0:3], v76 offset:14848
  s_waitcnt lgkmcnt(0)
  ds_read_b64 v[16:17], v77 offset:264
  s_waitcnt lgkmcnt(0)
  ds_read_b128 v[64:67], v76 offset:23552
  s_waitcnt lgkmcnt(0)
  s_add_u32 s66, s66, 1
  s_xor_b32 s64, s64, 16384
  s_xor_b32 s65, s65, 16384
  s_add_u32 s58, s58, 655360
  s_add_u32 s59, s59, 655360
  s_add_u32 s70, s70, 655360
  s_add_u32 s68, s68, 655360
  s_mov_b32 m0, 11776
  s_add_u32 s85, s65, 7168
  v_xor_b32 v75, 0x8000, v75
  v_mov_b64 v[28:29], 0
  v_mov_b64 v[30:31], 0
  v_mov_b64 v[32:33], 0
  v_mov_b64 v[34:35], 0
  v_mov_b64 v[20:21], 0
  v_mov_b64 v[22:23], 0
  v_mov_b64 v[24:25], 0
  v_mov_b64 v[26:27], 0
  v_mov_b32 v68, 14880
  buffer_load_dwordx4 v[52:55], v76, s[8:11], s60 offen offset:0 sc1
  buffer_load_dwordx4 v[56:59], v76, s[8:11], s60 offen offset:1024 sc1
  s_waitcnt lgkmcnt(0)
  s_waitcnt vmcnt(1)
  v_mfma_f32_16x16x32_bf16 v[4:7], v[0:3], v[52:55], 0
  v_bitop3_b32 v72, v52, v54, s72 bitop3:0x7e
  s_waitcnt vmcnt(0)
  v_mfma_f32_16x16x32_bf16 v[4:7], v[0:3], v[56:59], v[4:7]
  v_bitop3_b32 v73, v56, v58, s72 bitop3:0x7e
  v_bitop3_b32 v72, v72, v73, 1 bitop3:0xa8
  v_cmp_ne_u32 vcc, 0, v72
  s_nop 3
  v_add_f32_dpp v4, v4, v4 row_ror:4 row_mask:0xf bank_mask:0xf
  v_add_f32_dpp v5, v5, v5 row_ror:4 row_mask:0xf bank_mask:0xf
  s_cmp_eq_u64 vcc, 0
  v_add_f32_dpp v4, v4, v4 row_ror:8 row_mask:0xf bank_mask:0xf
  v_add_f32_dpp v5, v5, v5 row_ror:8 row_mask:0xf bank_mask:0xf
  s_cselect_b32 s54, s62, 268435456
  v_cvt_pk_bf16_f32 v4, v4, v5
  buffer_store_dword v4, v69, s[8:11], s54 offen
  s_cbranch_vccnz Cf1_h1r
  s_xor_b32 s62, s62, 16384
  buffer_store_dword v71, v69, s[8:11], s62 offen
  s_xor_b32 s72, s72, 1
  s_branch Cf1_h2
Cf1_h1r:
  s_mov_b64 exec, vcc
  buffer_load_dwordx4 v[52:55], v76, s[8:11], s60 offen offset:0 sc1
  buffer_load_dwordx4 v[56:59], v76, s[8:11], s60 offen offset:1024 sc1
  s_mov_b64 exec, -1
  s_add_u32 s67, s67, 1
  s_waitcnt vmcnt(1)
  v_mfma_f32_16x16x32_bf16 v[4:7], v[0:3], v[52:55], 0
  v_bitop3_b32 v72, v52, v54, s72 bitop3:0x7e
  s_waitcnt vmcnt(0)
  v_mfma_f32_16x16x32_bf16 v[4:7], v[0:3], v[56:59], v[4:7]
  v_bitop3_b32 v73, v56, v58, s72 bitop3:0x7e
  v_bitop3_b32 v72, v72, v73, 1 bitop3:0xa8
  v_cmp_ne_u32 vcc, 0, v72
  s_cbranch_vccz Cf1_h1p
Cf1_h1s:
  s_mov_b64 exec, vcc
  buffer_load_dwordx4 v[52:55], v76, s[8:11], s60 offen offset:0 sc1
  buffer_load_dwordx4 v[56:59], v76, s[8:11], s60 offen offset:1024 sc1
  s_mov_b64 exec, -1
  s_add_u32 s67, s67, 1
  s_waitcnt vmcnt(1)
  v_mfma_f32_16x16x32_bf16 v[4:7], v[0:3], v[52:55], 0
  v_bitop3_b32 v72, v52, v54, s72 bitop3:0x7e
  s_waitcnt vmcnt(0)
  v_mfma_f32_16x16x32_bf16 v[4:7], v[0:3], v[56:59], v[4:7]
  v_bitop3_b32 v73, v56, v58, s72 bitop3:0x7e
  v_bitop3_b32 v72, v72, v73, 1 bitop3:0xa8
  v_cmp_ne_u32 vcc, 0, v72
  s_cbranch_vccz Cf1_h1p
  s_cmp_lt_u32 s67, 131072
  s_cbranch_scc1 Cf1_h1s
Cf1_h1p:
  s_nop 2
  v_add_f32_dpp v4, v4, v4 row_ror:4 row_mask:0xf bank_mask:0xf
  v_add_f32_dpp v5, v5, v5 row_ror:4 row_mask:0xf bank_mask:0xf
  s_nop 0
  v_add_f32_dpp v4, v4, v4 row_ror:8 row_mask:0xf bank_mask:0xf
  v_add_f32_dpp v5, v5, v5 row_ror:8 row_mask:0xf bank_mask:0xf
  v_cvt_pk_bf16_f32 v4, v4, v5
  buffer_store_dword v4, v69, s[8:11], s62 offen
  s_xor_b32 s62, s62, 16384
  buffer_store_dword v71, v69, s[8:11], s62 offen
  s_xor_b32 s72, s72, 1
  s_branch Cf1_h2
Cf1_h2r:
  s_mov_b64 exec, vcc
  buffer_load_dwordx4 v[8:11], v76, s[8:11], s65 offen offset:2048 sc1
  s_mov_b64 exec, -1
  s_add_u32 s67, s67, 1
  s_waitcnt vmcnt(4)
  v_max3_u32 v72, v8, v9, v10
  v_max_u32 v72, v72, v11
  ds_write_b128 v76, v[8:11] offset:6656
  v_cmp_eq_u32 vcc, -1, v72
  s_cbranch_vccz Cf1_h2w
  s_mov_b64 exec, vcc
  buffer_load_dwordx4 v[8:11], v76, s[8:11], s65 offen offset:2048 sc1
  s_mov_b64 exec, -1
  s_add_u32 s67, s67, 1
  s_waitcnt vmcnt(4)
  v_max3_u32 v72, v8, v9, v10
  v_max_u32 v72, v72, v11
  ds_write_b128 v76, v[8:11] offset:6656
  v_cmp_eq_u32 vcc, -1, v72
  s_cbranch_vccz Cf1_h2w
Cf1_h2s:
  s_mov_b64 exec, vcc
  buffer_load_dwordx4 v[8:11], v76, s[8:11], s65 offen offset:2048 sc1
  s_mov_b64 exec, -1
  s_add_u32 s67, s67, 1
  s_waitcnt vmcnt(2)
  v_max3_u32 v72, v8, v9, v10
  v_max_u32 v72, v72, v11
  ds_write_b128 v76, v[8:11] offset:6656
  v_cmp_eq_u32 vcc, -1, v72
  s_cbranch_vccz Cf1_h2w
  s_mov_b64 exec, vcc
  buffer_load_dwordx4 v[8:11], v76, s[8:11], s65 offen offset:2048 sc1
  s_mov_b64 exec, -1
  s_add_u32 s67, s67, 1
  s_waitcnt vmcnt(2)
  v_max3_u32 v72, v8, v9, v10
  v_max_u32 v72, v72, v11
  ds_write_b128 v76, v[8:11] offset:6656
  v_cmp_eq_u32 vcc, -1, v72
  s_cbranch_vccz Cf1_h2w
  s_mov_b64 exec, vcc
  buffer_load_dwordx4 v[8:11], v76, s[8:11], s65 offen offset:2048 sc1
  s_mov_b64 exec, -1
  s_add_u32 s67, s67, 1
  s_waitcnt vmcnt(2)
  v_max3_u32 v72, v8, v9, v10
  v_max_u32 v72, v72, v11
  ds_write_b128 v76, v[8:11] offset:6656
  v_cmp_eq_u32 vcc, -1, v72
  s_cbranch_vccz Cf1_h2w
  s_cmp_lt_u32 s67, 131072
  s_cbranch_scc1 Cf1_h2s
  s_branch Cf1_h2w
Cf1_rec:
  s_nop 7
  s_waitcnt vmcnt(0) lgkmcnt(0)
  v_max3_u32 v72, v0, v1, v2
  v_max3_u32 v72, v72, v3, v4
  v_max3_u32 v72, v72, v5, v6
  v_max3_u32 v72, v72, v7, v8
  v_max3_u32 v72, v72, v9, v10
  v_max3_u32 v72, v72, v11, v12
  v_max3_u32 v72, v72, v13, v14
  v_max3_u32 v72, v72, v15, v16
  v_max3_u32 v72, v72, v17, v18
  v_max_u32 v72, v72, v19
  v_cmp_eq_u32 vcc, -1, v72
  s_cbranch_vccz Cf1_recok
  s_barrier
  v_mov_b64 v[20:21], 0
  v_mov_b64 v[22:23], 0
  v_mov_b64 v[24:25], 0
  v_mov_b64 v[26:27], 0
  v_mov_b64 v[28:29], 0
  v_mov_b64 v[30:31], 0
  v_mov_b64 v[32:33], 0
  v_mov_b64 v[34:35], 0
  s_waitcnt lgkmcnt(0)
  s_barrier
  ds_read_b128 v[0:3], v76 offset:4608
  s_waitcnt lgkmcnt(0)
  v_smfmac_f32_16x16x64_bf16 v[20:23], v[0:3], v[80:87], v74
  v_smfmac_f32_16x16x64_bf16 v[24:27], v[0:3], v[88:95], v74
  ds_read_b128 v[60:63], v76 offset:20480
  ds_read_b128 v[64:67], v76 offset:21504
  s_waitcnt lgkmcnt(0)
  v_smfmac_f32_16x16x64_bf16 v[28:31], v[0:3], v[60:67], v74
  ds_read_b128 v[60:63], v76 offset:22528
  ds_read_b128 v[64:67], v76 offset:23552
  s_waitcnt lgkmcnt(0)
  v_smfmac_f32_16x16x64_bf16 v[32:35], v[0:3], v[60:67], v74
  ds_read_b128 v[4:7], v76 offset:5632
  s_waitcnt lgkmcnt(0)
  v_smfmac_f32_16x16x64_bf16 v[20:23], v[4:7], v[96:103], v74
  v_smfmac_f32_16x16x64_bf16 v[24:27], v[4:7], v[104:111], v74
  ds_read_b128 v[60:63], v76 offset:36864
  ds_read_b128 v[64:67], v76 offset:37888
  s_waitcnt lgkmcnt(0)
  v_smfmac_f32_16x16x64_bf16 v[28:31], v[4:7], v[60:67], v74
  ds_read_b128 v[60:63], v76 offset:38912
  ds_read_b128 v[64:67], v76 offset:39936
  s_waitcnt lgkmcnt(0)
  v_smfmac_f32_16x16x64_bf16 v[32:35], v[4:7], v[60:67], v74
  ds_read_b128 v[8:11], v76 offset:6656
  s_waitcnt lgkmcnt(0)
  v_smfmac_f32_16x16x64_bf16 v[20:23], v[8:11], v[112:119], v74
  v_smfmac_f32_16x16x64_bf16 v[24:27], v[8:11], v[120:127], v74
  v_smfmac_f32_16x16x64_bf16 v[28:31], v[8:11], v[208:215], v74
  v_smfmac_f32_16x16x64_bf16 v[32:35], v[8:11], v[216:223], v74
  ds_read_b128 v[12:15], v76 offset:7680
  s_waitcnt lgkmcnt(0)
  v_smfmac_f32_16x16x64_bf16 v[20:23], v[12:15], v[128:135], v74
  v_smfmac_f32_16x16x64_bf16 v[24:27], v[12:15], v[136:143], v74
  v_smfmac_f32_16x16x64_bf16 v[28:31], v[12:15], v[224:231], v74
  v_smfmac_f32_16x16x64_bf16 v[32:35], v[12:15], v[232:239], v74
  ds_read_b128 v[8:11], v76 offset:8704
  s_waitcnt lgkmcnt(0)
  v_smfmac_f32_16x16x64_bf16 v[20:23], v[8:11], v[144:151], v74
  v_smfmac_f32_16x16x64_bf16 v[24:27], v[8:11], v[152:159], v74
  ds_read_b128 v[60:63], v76 offset:53248
  ds_read_b128 v[64:67], v76 offset:54272
  s_waitcnt lgkmcnt(0)
  v_smfmac_f32_16x16x64_bf16 v[28:31], v[8:11], v[60:67], v74
  ds_read_b128 v[60:63], v76 offset:55296
  ds_read_b128 v[64:67], v76 offset:56320
  s_waitcnt lgkmcnt(0)
  v_smfmac_f32_16x16x64_bf16 v[32:35], v[8:11], v[60:67], v74
  ds_read_b128 v[0:3], v76 offset:9728
  s_waitcnt lgkmcnt(0)
  v_smfmac_f32_16x16x64_bf16 v[20:23], v[0:3], v[160:167], v74
  v_smfmac_f32_16x16x64_bf16 v[24:27], v[0:3], v[168:175], v74
  ds_read_b128 v[60:63], v75 offset:20480
  ds_read_b128 v[64:67], v75 offset:21504
  s_waitcnt lgkmcnt(0)
  v_smfmac_f32_16x16x64_bf16 v[28:31], v[0:3], v[60:67], v74
  ds_read_b128 v[60:63], v75 offset:22528
  ds_read_b128 v[64:67], v75 offset:23552
  s_waitcnt lgkmcnt(0)
  v_smfmac_f32_16x16x64_bf16 v[32:35], v[0:3], v[60:67], v74
  ds_read_b128 v[16:19], v76 offset:10752
  ds_read_b128 v[60:63], v75 offset:4096
  ds_read_b128 v[64:67], v75 offset:5120
  s_waitcnt lgkmcnt(0)
  v_smfmac_f32_16x16x64_bf16 v[20:23], v[16:19], v[60:67], v74
  ds_read_b128 v[60:63], v75 offset:6144
  ds_read_b128 v[64:67], v75 offset:7168
  s_waitcnt lgkmcnt(0)
  v_smfmac_f32_16x16x64_bf16 v[24:27], v[16:19], v[60:67], v74
  v_smfmac_f32_16x16x64_bf16 v[28:31], v[16:19], v[240:247], v74
  v_smfmac_f32_16x16x64_bf16 v[32:35], v[16:19], v[248:255], v74
  ds_read_b128 v[4:7], v76 offset:11776
  s_waitcnt lgkmcnt(0)
  v_smfmac_f32_16x16x64_bf16 v[20:23], v[4:7], v[176:183], v74
  v_smfmac_f32_16x16x64_bf16 v[24:27], v[4:7], v[184:191], v74
  v_smfmac_f32_16x16x64_bf16 v[28:31], v[4:7], a[0:7], v74
  v_smfmac_f32_16x16x64_bf16 v[32:35], v[4:7], a[8:15], v74
  ds_read_b128 v[12:15], v76 offset:12800
  s_waitcnt lgkmcnt(0)
  v_smfmac_f32_16x16x64_bf16 v[20:23], v[12:15], v[192:199], v74
  v_smfmac_f32_16x16x64_bf16 v[24:27], v[12:15], v[200:207], v74
  v_smfmac_f32_16x16x64_bf16 v[28:31], v[12:15], a[16:23], v74
  v_smfmac_f32_16x16x64_bf16 v[32:35], v[12:15], a[24:31], v74
  v_add_f32 v20, v20, v22
  v_add_f32 v21, v21, v23
  v_add_f32 v24, v24, v26
  v_cvt_pk_bf16_f32 v22, v20, v24
  ds_write_b32 v79, v22 offset:0
  v_add_f32 v25, v25, v27
  v_cvt_pk_bf16_f32 v23, v21, v25
  ds_write_b32 v79, v23 offset:576
  v_add_f32 v28, v28, v30
  v_add_f32 v29, v29, v31
  s_waitcnt lgkmcnt(0)
  s_nop 1
  s_branch Cf1_recok
Cf1_mx:
  s_waitcnt lgkmcnt(0)
  s_barrier
  buffer_load_dwordx4 v[52:55], v76, s[8:11], s59 offen offset:0 sc1
  buffer_load_dwordx4 v[0:3], v76, s[8:11], s58 offen offset:0 sc1
  ds_read_b128 v[20:23], v77 offset:0
  ds_read_b128 v[28:31], v77 offset:256
  buffer_load_dwordx4 v[56:59], v76, s[8:11], s59 offen offset:1024 sc1
  buffer_load_dwordx4 v[4:7], v76, s[8:11], s58 offen offset:1024 sc1
  ds_read_b128 v[24:27], v77 offset:128
  ds_read_b128 v[32:35], v77 offset:384
  s_waitcnt vmcnt(2) lgkmcnt(3)
  v_mfma_f32_16x16x32_bf16 v[8:11], v[0:3], v[20:23], 0
  s_waitcnt vmcnt(0) lgkmcnt(1)
  v_mfma_f32_16x16x32_bf16 v[8:11], v[4:7], v[24:27], v[8:11]
  v_mfma_f32_16x16x32_bf16 v[12:15], v[28:31], v[20:23], 0
  s_waitcnt lgkmcnt(0)
  v_mfma_f32_16x16x32_bf16 v[12:15], v[32:35], v[24:27], v[12:15]
  v_add_f32_dpp v8, v10, v8 quad_perm:[2,3,0,1] row_mask:0xf bank_mask:0xf
  v_add_f32_dpp v9, v11, v9 quad_perm:[2,3,0,1] row_mask:0xf bank_mask:0xf
  s_nop 0
  v_mov_b32_dpp v8, v8 quad_perm:[0,1,0,1] row_mask:0xf bank_mask:0xf
  v_mov_b32_dpp v9, v9 quad_perm:[0,1,0,1] row_mask:0xf bank_mask:0xf
  s_nop 1
  v_add_f32_dpp v12, v14, v12 quad_perm:[2,3,0,1] row_mask:0xf bank_mask:0xf
  v_add_f32_dpp v13, v15, v13 quad_perm:[2,3,0,1] row_mask:0xf bank_mask:0xf
  s_nop 0
  v_mov_b32_dpp v12, v12 quad_perm:[0,1,0,1] row_mask:0xf bank_mask:0xf
  v_mov_b32_dpp v13, v13 quad_perm:[0,1,0,1] row_mask:0xf bank_mask:0xf
  v_mul_f32 v12, s69, v12
  ds_write_b32 v78, v8 offset:8708
  v_mul_f32 v13, s69, v13
  ds_write_b32 v78, v9 offset:8772
  s_waitcnt lgkmcnt(0)
  s_barrier
  ds_read_b128 v[36:39], v78 offset:8704
  ds_read_b128 v[40:43], v78 offset:8768
  s_waitcnt lgkmcnt(0)
  s_barrier
  v_max_f32 v16, v36, v37
  v_max3_f32 v16, v16, v38, v39
  v_max3_f32 v16, v16, v40, v41
  v_max3_f32 v16, v16, v42, v43
  v_max3_f32 v16, v16, v12, v13
  v_mov_b32 v17, v16
  s_nop 1
  v_permlane16_swap_b32 v16, v17
  v_max_f32 v16, v16, v17
  v_mov_b32 v17, v16
  s_nop 1
  v_permlane32_swap_b32 v16, v17
  v_max_f32 v16, v16, v17
  v_sub_f32 v36, v36, v16
  v_sub_f32 v37, v37, v16
  v_sub_f32 v38, v38, v16
  v_sub_f32 v39, v39, v16
  v_sub_f32 v40, v40, v16
  v_sub_f32 v41, v41, v16
  v_sub_f32 v42, v42, v16
  v_sub_f32 v43, v43, v16
  v_sub_f32 v12, v12, v16
  v_sub_f32 v13, v13, v16
  v_exp_f32 v36, v36
  v_exp_f32 v37, v37
  v_exp_f32 v38, v38
  v_exp_f32 v39, v39
  v_exp_f32 v40, v40
  v_exp_f32 v41, v41
  v_exp_f32 v42, v42
  v_exp_f32 v43, v43
  v_exp_f32 v12, v12
  v_exp_f32 v13, v13
  v_cvt_pk_bf16_f32 v32, v36, v40
  v_cvt_pk_bf16_f32 v33, v37, v41
  v_cvt_pk_bf16_f32 v34, v38, v42
  v_cvt_pk_bf16_f32 v35, v39, v43
  v_cvt_pk_bf16_f32 v28, v12, v13
  v_cvt_pk_bf16_f32 v31, v12, v13
  v_mov_b32 v29, 0
  v_mov_b32 v30, 0
  v_mfma_f32_16x16x32_bf16 v[8:11], v[32:35], v[68:71], 0
  v_mfma_f32_16x16x32_bf16 v[0:3], v[32:35], v[52:55], 0
  v_mfma_f32_16x16x32_bf16 v[4:7], v[32:35], v[56:59], 0
  v_mfma_f32_16x16x16_bf16 v[8:11], v[28:29], v[68:69], v[8:11]
  v_mfma_f32_16x16x16_bf16 v[0:3], v[28:29], v[72:73], v[0:3]
  v_mfma_f32_16x16x16_bf16 v[4:7], v[30:31], v[72:73], v[4:7]
  ds_read_b128 v[52:55], v75 offset:36864
  v_rcp_f32 v10, v8
  v_rcp_f32 v11, v9
  v_mul_f32 v0, v10, v0
  v_mul_f32 v1, v11, v1
  v_max3_f32 v8, v8, v9, v10
  v_mul_f32 v4, v10, v4
  v_mul_f32 v5, v11, v5
  v_cvt_pk_bf16_f32 v2, v0, v4
  ds_write_b32 v79, v2 offset:8704
  v_cvt_pk_bf16_f32 v3, v1, v5
  ds_write_b32 v79, v3 offset:9280
  ds_read_b128 v[12:15], v78 offset:8768
  ds_read_b128 v[56:59], v75 offset:37888
  v_mov_b64 v[16:17], 0
  v_mov_b64 v[18:19], 0
  v_mov_b64 v[20:21], 0
  v_mov_b64 v[22:23], 0
  v_mov_b64 v[24:25], 0
  v_mov_b64 v[26:27], 0
  s_branch Cf1_mxok
Cf1_last:
  ds_read_b128 v[4:7], v76 offset:5632
  ds_read_b128 v[12:15], v76 offset:7680
  ds_read_b128 v[44:47], v76 offset:36864
  ds_read_b128 v[48:51], v76 offset:37888
  s_nop 5
  v_mov_b64 v[20:21], 0
  v_mov_b64 v[22:23], 0
  v_mov_b64 v[24:25], 0
  v_mov_b64 v[26:27], 0
  s_waitcnt lgkmcnt(4)
  v_smfmac_f32_16x16x64_bf16 v[28:31], v[0:3], v[36:43], v74
  ds_read_b128 v[36:39], v76 offset:38912
  ds_read_b128 v[40:43], v76 offset:39936
  v_smfmac_f32_16x16x64_bf16 v[32:35], v[0:3], v[60:67], v74
  s_waitcnt lgkmcnt(5)
  v_smfmac_f32_16x16x64_bf16 v[20:23], v[0:3], a[32:39], v74
  ds_read_b128 v[60:63], v76 offset:53248
  ds_read_b128 v[64:67], v76 offset:54272
  v_smfmac_f32_16x16x64_bf16 v[24:27], v[0:3], a[40:47], v74
  s_waitcnt lgkmcnt(4)
  v_smfmac_f32_16x16x64_bf16 v[20:23], v[4:7], a[48:55], v74
  buffer_store_dwordx4 v[16:19], v76, s[8:11], s68 offen sc1
  v_smfmac_f32_16x16x64_bf16 v[24:27], v[4:7], a[56:63], v74
  v_smfmac_f32_16x16x64_bf16 v[28:31], v[4:7], v[44:51], v74
  s_waitcnt lgkmcnt(2)
  v_smfmac_f32_16x16x64_bf16 v[20:23], v[8:11], a[64:71], v74
  ds_read_b128 v[44:47], v76 offset:55296
  ds_read_b128 v[48:51], v76 offset:56320
  v_smfmac_f32_16x16x64_bf16 v[24:27], v[8:11], a[72:79], v74
  v_smfmac_f32_16x16x64_bf16 v[32:35], v[4:7], v[36:43], v74
  v_smfmac_f32_16x16x64_bf16 v[28:31], v[8:11], v[208:215], v74
  ds_read_b128 v[36:39], v75 offset:20480
  ds_read_b128 v[40:43], v75 offset:21504
  v_smfmac_f32_16x16x64_bf16 v[32:35], v[8:11], v[216:223], v74
  v_smfmac_f32_16x16x64_bf16 v[20:23], v[12:15], a[80:87], v74
  v_smfmac_f32_16x16x64_bf16 v[24:27], v[12:15], a[88:95], v74
  v_smfmac_f32_16x16x64_bf16 v[28:31], v[12:15], v[224:231], v74
  v_smfmac_f32_16x16x64_bf16 v[32:35], v[12:15], v[232:239], v74
  s_waitcnt vmcnt(2)
  s_waitcnt vmcnt(1)
  s_barrier
Cf1_lastr:
  ds_read_b128 v[8:11], v76 offset:8704
  ds_read_b128 v[0:3], v76 offset:9728
  ds_read_b128 v[16:19], v76 offset:10752
  ds_read_b128 v[4:7], v76 offset:11776
  ds_read_b128 v[12:15], v76 offset:12800
  s_waitcnt lgkmcnt(3)
  v_max3_u32 v72, v0, v1, v2
  s_waitcnt lgkmcnt(1)
  v_max3_u32 v72, v72, v3, v4
  v_max3_u32 v72, v72, v5, v6
  v_max3_u32 v72, v72, v7, v8
  v_max3_u32 v72, v72, v9, v10
  s_waitcnt lgkmcnt(0)
  v_max3_u32 v72, v72, v11, v12
  v_max3_u32 v72, v72, v13, v14
  v_max3_u32 v72, v72, v15, v16
  v_max3_u32 v72, v72, v17, v18
  v_max_u32 v72, v72, v19
  v_cmp_eq_u32 vcc, -1, v72
  s_cbranch_vccnz Cf1_lastp
Cf1_lastg:
  v_smfmac_f32_16x16x64_bf16 v[28:31], v[8:11], v[60:67], v74
  ds_read_b128 v[60:63], v75 offset:22528
  ds_read_b128 v[64:67], v75 offset:23552
  v_smfmac_f32_16x16x64_bf16 v[32:35], v[8:11], v[44:51], v74
  v_smfmac_f32_16x16x64_bf16 v[28:31], v[0:3], v[36:43], v74
  v_smfmac_f32_16x16x64_bf16 v[28:31], v[16:19], v[240:247], v74
  v_smfmac_f32_16x16x64_bf16 v[28:31], v[4:7], a[0:7], v74
  v_smfmac_f32_16x16x64_bf16 v[28:31], v[12:15], a[16:23], v74
  v_smfmac_f32_16x16x64_bf16 v[32:35], v[16:19], v[248:255], v74
  v_smfmac_f32_16x16x64_bf16 v[32:35], v[4:7], a[8:15], v74
  s_waitcnt lgkmcnt(0)
  v_smfmac_f32_16x16x64_bf16 v[32:35], v[12:15], a[24:31], v74
  v_smfmac_f32_16x16x64_bf16 v[32:35], v[0:3], v[60:67], v74
  v_smfmac_f32_16x16x64_bf16 v[20:23], v[8:11], a[96:103], v74
  v_smfmac_f32_16x16x64_bf16 v[20:23], v[0:3], a[112:119], v74
  v_add_f32 v28, v28, v30
  v_add_f32 v32, v32, v34
  v_cvt_pk_bf16_f32 v30, v28, v32
  v_smfmac_f32_16x16x64_bf16 v[20:23], v[16:19], a[128:135], v74
  ds_write_b32 v79, v30 offset:256
  v_add_f32 v29, v29, v31
  v_add_f32 v33, v33, v35
  v_cvt_pk_bf16_f32 v31, v29, v33
  v_smfmac_f32_16x16x64_bf16 v[20:23], v[4:7], a[144:151], v74
  ds_write_b32 v79, v31 offset:832
  v_smfmac_f32_16x16x64_bf16 v[20:23], v[12:15], a[160:167], v74
  v_smfmac_f32_16x16x64_bf16 v[24:27], v[8:11], a[104:111], v74
  v_smfmac_f32_16x16x64_bf16 v[24:27], v[0:3], a[120:127], v74
  v_smfmac_f32_16x16x64_bf16 v[24:27], v[16:19], a[136:143], v74
  s_waitcnt lgkmcnt(0)
  s_barrier
  ds_read_b64 v[52:53], v77 offset:264
  v_add_f32 v20, v20, v22
  v_smfmac_f32_16x16x64_bf16 v[24:27], v[4:7], a[152:159], v74
  v_add_f32 v21, v21, v23
  v_smfmac_f32_16x16x64_bf16 v[24:27], v[12:15], a[168:175], v74
  v_cvt_pk_bf16_f32 v54, v20, v21
  s_add_u32 s68, s68, 655360
  s_nop 3
  v_add_f32 v24, v24, v26
  v_add_f32 v25, v25, v27
  v_cvt_pk_bf16_f32 v55, v24, v25
  s_waitcnt lgkmcnt(0)
  buffer_store_dwordx4 v[52:55], v76, s[8:11], s68 offen sc1
  s_branch Cf1_done
Cf1_lastp:
  s_add_u32 s72, s72, 2
  s_cmp_ge_u32 s72, 131072
  s_cbranch_scc1 Cf1_lastg
  s_barrier
  buffer_load_dwordx4 v76, s[8:11], s85 offen offset:0 sc1 lds
  s_waitcnt vmcnt(0)
  s_barrier
  s_branch Cf1_lastr
Cf1_done:
  s_branch L_cexit
L_w2:
  v_mov_b64 v[20:21], 0
  v_mov_b64 v[22:23], 0
  v_mov_b64 v[24:25], 0
  v_mov_b64 v[26:27], 0
  v_mov_b64 v[28:29], 0
  v_mov_b64 v[30:31], 0
  v_mov_b64 v[32:33], 0
  v_mov_b64 v[34:35], 0
  s_mov_b32 s78, 0x3f803f80
  s_mov_b32 s79, s78
  s_mov_b32 s65, 360448
  s_mov_b32 m0, 15872
  s_lshl_b32 s71, s53, 2
  s_add_u32 s71, s71, 128
  s_movk_i32 s56, 0x1000
  v_lshlrev_b32 v73, 2, v76
  v_mov_b32 v72, 0
  s_mov_b64 s[16:17], s[8:9]
  s_mov_b32 s18, 268435456
  s_mov_b32 s19, 0x20000
  s_getpc_b64 s[20:21]
Cf2_pc:
  s_add_u32 s20, s20, (Cf2_last - Cf2_pc)
  s_addc_u32 s21, s21, 0
  v_mov_b32 v68, 14880
  buffer_load_dwordx4 v[52:55], v76, s[8:11], s59 offen offset:0 sc1
  buffer_load_dwordx4 v[56:59], v76, s[8:11], s59 offen offset:1024 sc1
  ds_read_b128 v[36:39], v76 offset:24576
  ds_read_b128 v[40:43], v76 offset:25600
  ds_read_b128 v[60:63], v76 offset:26624
  ds_read_b128 v[64:67], v76 offset:27648
  ds_read_b128 v[0:3], v76 offset:4608
  ds_read_b128 v[4:7], v76 offset:5632
  ds_read_b128 v[8:11], v76 offset:6656
  ds_read_b128 v[12:15], v76 offset:7680
  s_waitcnt lgkmcnt(0)
  s_cmp_eq_u32 s66, 1
  s_branch Cf2_top2
.p2align 6
Cf2_h2:
  buffer_load_dwordx4 v[12:15], v76, s[8:11], s65 offen offset:3072 sc1
  ds_read_b128 v[36:39], v76 offset:24576
  s_waitcnt lgkmcnt(0)
  s_cmp_eq_u32 s66, 62
  s_cselect_b64 s[16:17], s[20:21], s[16:17]
  s_cselect_b32 s18, (Cf2_done - Cf2_last), s18
  s_cselect_b32 s70, 0, s70
  s_cmp_eq_u32 s66, 63
  s_cselect_b32 s59, 268435456, s59
  s_cselect_b32 s58, 268435456, s58
  buffer_load_dwordx4 v[12:15], v76, s[8:11], s65 offen offset:3072 sc1
  ds_read_b128 v[40:43], v76 offset:25600
  s_waitcnt lgkmcnt(0)
  v_mov_b64 v[20:21], 0
  v_mov_b64 v[22:23], 0
  v_mov_b64 v[24:25], 0
  v_mov_b64 v[26:27], 0
  v_mov_b32 v68, 14880
  v_lshlrev_b32 v73, 2, v76
  buffer_load_dwordx4 v[12:15], v76, s[8:11], s65 offen offset:3072 sc1
  buffer_load_dwordx4 v[52:55], v76, s[8:11], s59 offen offset:0 sc1
  buffer_load_dwordx4 v[56:59], v76, s[8:11], s59 offen offset:1024 sc1
  s_waitcnt vmcnt(4)
  v_max3_u32 v72, v12, v13, v14
  v_max_u32 v72, v72, v15
  ds_write_b128 v76, v[12:15] offset:7680
  v_cmp_eq_u32 vcc, -1, v72
  s_cbranch_vccnz Cf2_h2r
Cf2_h2w:
  s_cmp_eq_u32 s66, 63
  s_waitcnt lgkmcnt(0)
  s_barrier
  ds_read_b128 v[0:3], v76 offset:4608
  buffer_load_dwordx4 v76, s[8:11], s85 offen offset:0 sc1 lds
Cf2_top2:
  v_smfmac_f32_16x16x64_bf16 v[20:23], v[12:15], v[128:135], v74
  s_cbranch_scc1 Cf2_last
  v_smfmac_f32_16x16x64_bf16 v[24:27], v[12:15], v[136:143], v74
  buffer_load_dwordx4 v[44:47], v76, s[8:11], s58 offen offset:0 sc1
  s_mov_b32 m0, 15872
  v_smfmac_f32_16x16x64_bf16 v[28:31], v[12:15], v[224:231], v74
  buffer_load_dwordx4 v[48:51], v76, s[8:11], s58 offen offset:1024 sc1
  v_smfmac_f32_16x16x64_bf16 v[32:35], v[12:15], v[232:239], v74
  ds_read_b128 v[4:7], v76 offset:5632
  s_waitcnt lgkmcnt(1)
  v_smfmac_f32_16x16x64_bf16 v[20:23], v[0:3], v[80:87], v74
  ds_read_b128 v[8:11], v76 offset:6656
  v_smfmac_f32_16x16x64_bf16 v[28:31], v[0:3], v[36:43], v74
  ds_read_b128 v[36:39], v76 offset:40960
  v_smfmac_f32_16x16x64_bf16 v[24:27], v[0:3], v[88:95], v74
  buffer_store_dwordx4 v[16:19], v76, s[8:11], s68 offen sc1
  ds_read_b128 v[40:43], v76 offset:41984
  v_smfmac_f32_16x16x64_bf16 v[32:35], v[0:3], v[60:67], v74
  buffer_load_dword v73, s[16:19], s70 offen lds
  ds_read_b128 v[60:63], v76 offset:43008
  s_waitcnt lgkmcnt(4)
  v_smfmac_f32_16x16x64_bf16 v[20:23], v[4:7], v[96:103], v74
  ds_read_b128 v[64:67], v76 offset:44032
  v_smfmac_f32_16x16x64_bf16 v[24:27], v[4:7], v[104:111], v74
  s_waitcnt vmcnt(5)
  s_waitcnt lgkmcnt(4)
  v_smfmac_f32_16x16x64_bf16 v[20:23], v[8:11], v[112:119], v74
  s_barrier
  ds_read_b128 v[12:15], v76 offset:8704
  s_waitcnt lgkmcnt(3)
  v_smfmac_f32_16x16x64_bf16 v[28:31], v[4:7], v[36:43], v74
  ds_read_b128 v[36:39], v76 offset:57344
  v_smfmac_f32_16x16x64_bf16 v[24:27], v[8:11], v[120:127], v74
  ds_read_b128 v[40:43], v76 offset:58368
  s_waitcnt lgkmcnt(3)
  v_smfmac_f32_16x16x64_bf16 v[32:35], v[4:7], v[60:67], v74
  ds_read_b128 v[0:3], v76 offset:9728
  v_smfmac_f32_16x16x64_bf16 v[28:31], v[8:11], v[208:215], v74
  ds_read_b128 v[60:63], v76 offset:59392
  v_smfmac_f32_16x16x64_bf16 v[32:35], v[8:11], v[216:223], v74
  s_waitcnt vmcnt(4)
  ds_read_b128 v[64:67], v76 offset:60416
  s_waitcnt lgkmcnt(5)
  v_smfmac_f32_16x16x64_bf16 v[20:23], v[12:15], v[144:151], v74
  s_barrier
  ds_read_b128 v[4:7], v76 offset:11776
  s_waitcnt lgkmcnt(4)
  v_smfmac_f32_16x16x64_bf16 v[28:31], v[12:15], v[36:43], v74
  ds_read_b128 v[8:11], v76 offset:12800
  ds_read_b128 v[36:39], v75 offset:8192
  v_smfmac_f32_16x16x64_bf16 v[24:27], v[12:15], v[152:159], v74
  ds_read_b128 v[16:19], v76 offset:10752
  s_waitcnt lgkmcnt(6)
  v_smfmac_f32_16x16x64_bf16 v[20:23], v[0:3], v[160:167], v74
  ds_read_b128 v[40:43], v75 offset:9216
  s_waitcnt lgkmcnt(5)
  v_smfmac_f32_16x16x64_bf16 v[32:35], v[12:15], v[60:67], v74
  ds_read_b128 v[60:63], v75 offset:10240
  v_smfmac_f32_16x16x64_bf16 v[24:27], v[0:3], v[168:175], v74
  ds_read_b128 v[64:67], v75 offset:11264
  s_waitcnt lgkmcnt(6)
  v_smfmac_f32_16x16x64_bf16 v[20:23], v[4:7], v[176:183], v74
  s_waitcnt lgkmcnt(5)
  v_smfmac_f32_16x16x64_bf16 v[20:23], v[8:11], v[192:199], v74
  s_waitcnt lgkmcnt(2)
  v_smfmac_f32_16x16x64_bf16 v[20:23], v[16:19], v[36:43], v74
  ds_read_b128 v[36:39], v75 offset:24576
  v_smfmac_f32_16x16x64_bf16 v[24:27], v[4:7], v[184:191], v74
  ds_read_b128 v[40:43], v75 offset:25600
  s_waitcnt lgkmcnt(2)
  v_smfmac_f32_16x16x64_bf16 v[24:27], v[16:19], v[60:67], v74
  ds_read_b128 v[60:63], v75 offset:26624
  v_add_f32 v20, v20, v22
  v_smfmac_f32_16x16x64_bf16 v[24:27], v[8:11], v[200:207], v74
  ds_read_b128 v[64:67], v75 offset:27648
  v_add_f32 v21, v21, v23
  v_smfmac_f32_16x16x64_bf16 v[28:31], v[16:19], v[240:247], v74
  v_mov_b64 v[70:71], s[78:79]
  v_smfmac_f32_16x16x64_bf16 v[28:31], v[4:7], a[0:7], v74
  s_waitcnt lgkmcnt(2)
  v_add_f32 v24, v24, v26
  v_smfmac_f32_16x16x64_bf16 v[28:31], v[0:3], v[36:43], v74
  ds_read_b128 v[36:39], v68
  v_cvt_pk_bf16_f32 v22, v20, v24
  v_smfmac_f32_16x16x64_bf16 v[28:31], v[8:11], a[16:23], v74
  ds_read_b128 v[40:43], v68
  ds_write_b32 v79, v22 offset:0
  s_waitcnt lgkmcnt(3)
  v_add_f32 v25, v25, v27
  v_cvt_pk_bf16_f32 v23, v21, v25
  v_smfmac_f32_16x16x64_bf16 v[32:35], v[0:3], v[60:67], v74
  ds_write_b32 v79, v23 offset:576
  v_cmp_u_f32 vcc, v20, v21
  v_smfmac_f32_16x16x64_bf16 v[32:35], v[16:19], v[248:255], v74
  v_add_f32 v28, v28, v30
  v_smfmac_f32_16x16x64_bf16 v[32:35], v[4:7], a[8:15], v74
  v_add_f32 v29, v29, v31
  v_smfmac_f32_16x16x64_bf16 v[32:35], v[8:11], a[24:31], v74
  s_cbranch_vccnz Cf2_rec
Cf2_recok:
  s_waitcnt lgkmcnt(3)
  v_smfmac_f32_16x16x64_bf16 v[36:39], v[16:19], a[128:135], v74
  s_waitcnt lgkmcnt(0)
  s_barrier
  ds_read_b128 v[60:63], v77
  v_smfmac_f32_16x16x64_bf16 v[40:43], v[16:19], a[136:143], v74
  ds_read_b128 v[64:67], v77 offset:128
  v_add_f32 v32, v32, v34
  v_cvt_pk_bf16_f32 v30, v28, v32
  v_smfmac_f32_16x16x64_bf16 v[36:39], v[0:3], a[112:119], v74
  ds_write_b32 v79, v30 offset:256
  v_add_f32 v33, v33, v35
  v_cvt_pk_bf16_f32 v31, v29, v33
  v_smfmac_f32_16x16x64_bf16 v[40:43], v[0:3], a[120:127], v74
  ds_write_b32 v79, v31 offset:832
  v_xor_b32 v75, 0x8000, v75
  v_smfmac_f32_16x16x64_bf16 v[36:39], v[4:7], a[144:151], v74
  ds_read_b128 v[0:3], v76 offset:4608
  v_mov_b32 v29, 0
  v_smfmac_f32_16x16x64_bf16 v[40:43], v[4:7], a[152:159], v74
  s_waitcnt vmcnt(2) lgkmcnt(3)
  v_mov_b32 v30, 0
  v_mfma_f32_16x16x32_bf16 v[44:47], v[44:47], v[60:63], 0
  ds_read_b128 v[4:7], v76 offset:5632
  s_waitcnt lgkmcnt(2)
  v_mfma_f32_16x16x32_bf16 v[44:47], v[48:51], v[64:67], v[44:47]
  s_barrier
  v_smfmac_f32_16x16x64_bf16 v[36:39], v[8:11], a[160:167], v74
  ds_read_b128 v[20:23], v77 offset:256
  ds_read_b128 v[24:27], v77 offset:384
  v_smfmac_f32_16x16x64_bf16 v[40:43], v[8:11], a[168:175], v74
  ds_read_b128 v[8:11], v76 offset:6656
  v_add_f32_dpp v72, v46, v44 quad_perm:[2,3,0,1] row_mask:0xf bank_mask:0xf
  v_add_f32_dpp v73, v47, v45 quad_perm:[2,3,0,1] row_mask:0xf bank_mask:0xf
  v_smfmac_f32_16x16x64_bf16 v[36:39], v[12:15], a[96:103], v74
  s_waitcnt lgkmcnt(4)
  v_exp_f32_dpp v72, v72 quad_perm:[0,1,0,1] row_mask:0xf bank_mask:0xf
  v_smfmac_f32_16x16x64_bf16 v[40:43], v[12:15], a[104:111], v74
  ds_read_b128 v[12:15], v76 offset:7680
  v_exp_f32_dpp v73, v73 quad_perm:[0,1,0,1] row_mask:0xf bank_mask:0xf
  v_smfmac_f32_16x16x64_bf16 v[36:39], v[0:3], a[32:39], v74
  s_waitcnt lgkmcnt(2)
  v_cvt_pk_bf16_f32 v72, v72, v73
  v_mfma_f32_16x16x32_bf16 v[20:23], v[20:23], v[60:63], 0
  ds_write_b32 v78, v72 offset:520
  v_mov_b64 v[16:17], 0
  v_mfma_f32_16x16x32_bf16 v[20:23], v[24:27], v[64:67], v[20:23]
  ds_read_b128 v[44:47], v75 offset:40960
  v_mov_b64 v[18:19], 0
  v_smfmac_f32_16x16x64_bf16 v[40:43], v[0:3], a[40:47], v74
  ds_read_b128 v[48:51], v75 offset:41984
  v_mov_b64 v[68:69], s[78:79]
  v_smfmac_f32_16x16x64_bf16 v[36:39], v[4:7], a[48:55], v74
  s_waitcnt lgkmcnt(4)
  v_add_f32_dpp v24, v22, v20 quad_perm:[2,3,0,1] row_mask:0xf bank_mask:0xf
  v_add_f32_dpp v25, v23, v21 quad_perm:[2,3,0,1] row_mask:0xf bank_mask:0xf
  v_smfmac_f32_16x16x64_bf16 v[36:39], v[8:11], a[64:71], v74
  s_waitcnt lgkmcnt(2)
  s_barrier
  ds_read_b128 v[32:35], v78 offset:512
  v_smfmac_f32_16x16x64_bf16 v[36:39], v[12:15], a[80:87], v74
  ds_read_b128 v[60:63], v75 offset:24576
  v_mul_f32 v24, s69, v24
  v_smfmac_f32_16x16x64_bf16 v[40:43], v[4:7], a[56:63], v74
  ds_read_b128 v[64:67], v75 offset:25600
  v_mul_f32 v25, s69, v25
  v_smfmac_f32_16x16x64_bf16 v[40:43], v[8:11], a[72:79], v74
  v_exp_f32_dpp v24, v24 quad_perm:[0,1,0,1] row_mask:0xf bank_mask:0xf
  v_smfmac_f32_16x16x64_bf16 v[40:43], v[12:15], a[88:95], v74
  s_waitcnt lgkmcnt(2)
  v_exp_f32_dpp v25, v25 quad_perm:[0,1,0,1] row_mask:0xf bank_mask:0xf
  v_mfma_f32_16x16x32_bf16 v[8:11], v[32:35], v[68:71], 0
  v_add_f32 v36, v36, v38
  v_add_f32 v37, v37, v39
  v_mfma_f32_16x16x32_bf16 v[0:3], v[32:35], v[52:55], 0
  v_add_f32 v40, v40, v42
  v_add_f32 v41, v41, v43
  v_mfma_f32_16x16x32_bf16 v[4:7], v[32:35], v[56:59], 0
  v_cvt_pk_bf16_f32 v28, v24, v25
  v_cvt_pk_bf16_f32 v72, v36, v37
  v_cvt_pk_bf16_f32 v73, v40, v41
  v_mfma_f32_16x16x16_bf16 v[8:11], v[28:29], v[68:69], v[8:11]
  v_cvt_pk_bf16_f32 v31, v24, v25
  v_mov_b64 v[20:21], 0
  v_mfma_f32_16x16x16_bf16 v[0:3], v[28:29], v[72:73], v[0:3]
  ds_read_b128 v[52:55], v75 offset:26624
  v_mov_b64 v[22:23], 0
  v_mfma_f32_16x16x16_bf16 v[4:7], v[30:31], v[72:73], v[4:7]
  v_rcp_f32 v10, v8
  v_rcp_f32 v11, v9
  v_mul_f32 v0, v10, v0
  v_mul_f32 v1, v11, v1
  v_max3_f32 v8, v8, v9, v10
  v_mul_f32 v4, v10, v4
  v_mul_f32 v5, v11, v5
  v_cvt_pk_bf16_f32 v2, v0, v4
  ds_write_b32 v79, v2 offset:8704
  v_cvt_pk_bf16_f32 v3, v1, v5
  ds_write_b32 v79, v3 offset:9280
  ds_read_b128 v[12:15], v78 offset:8832
  v_max_f32 v8, v8, v11
  v_cmp_le_f32 vcc, 1317011456, v8
  v_mov_b64 v[24:25], 0
  v_mov_b64 v[26:27], 0
  ds_read_b128 v[56:59], v75 offset:27648
  s_cbranch_vccnz Cf2_mx
Cf2_mxok:
  s_waitcnt lgkmcnt(2)
  s_barrier
  ds_read_b128 v[0:3], v78 offset:8896
  s_waitcnt lgkmcnt(2)
  v_smfmac_f32_16x16x64_bf16 v[16:19], v[12:15], a[176:183], v74
  ds_read_b128 v[4:7], v78 offset:8704
  v_smfmac_f32_16x16x64_bf16 v[20:23], v[12:15], v[44:51], v74
  ds_read_b128 v[8:11], v78 offset:8768
  v_smfmac_f32_16x16x64_bf16 v[24:27], v[12:15], a[224:231], v74
  ds_read_b128 v[36:39], v75 offset:43008
  s_waitcnt lgkmcnt(3)
  v_smfmac_f32_16x16x64_bf16 v[16:19], v[0:3], a[184:191], v74
  ds_read_b128 v[40:43], v75 offset:44032
  s_waitcnt lgkmcnt(3)
  v_smfmac_f32_16x16x64_bf16 v[16:19], v[4:7], v[60:67], v74
  ds_read_b128 v[68:71], v76 offset:13824
  s_waitcnt lgkmcnt(3)
  v_smfmac_f32_16x16x64_bf16 v[16:19], v[8:11], v[52:59], v74
  ds_read_b128 v[44:47], v75 offset:57344
  v_smfmac_f32_16x16x64_bf16 v[20:23], v[4:7], a[192:199], v74
  ds_read_b128 v[48:51], v75 offset:58368
  v_smfmac_f32_16x16x64_bf16 v[20:23], v[8:11], a[200:207], v74
  ds_read_b128 v[60:63], v75 offset:59392
  s_waitcnt lgkmcnt(4)
  v_cvt_pk_bf16_f32 v16, v16, v17
  v_cvt_pk_bf16_f32 v17, v18, v19
  v_bfi_b32 v16, 1, s72, v16
  v_smfmac_f32_16x16x64_bf16 v[20:23], v[0:3], v[36:43], v74
  s_waitcnt lgkmcnt(3)
  buffer_store_dwordx2 v[16:17], v68, s[8:11], s73 offen
  v_mov_b64 v[32:33], 0
  v_smfmac_f32_16x16x64_bf16 v[24:27], v[4:7], a[208:215], v74
  ds_read_b128 v[64:67], v75 offset:60416
  v_mov_b64 v[34:35], 0
  v_smfmac_f32_16x16x64_bf16 v[24:27], v[8:11], a[216:223], v74
  ds_read_b128 v[52:55], v75 offset:0
  v_cvt_pk_bf16_f32 v20, v20, v21
  v_cvt_pk_bf16_f32 v21, v22, v23
  v_bfi_b32 v20, 1, s72, v20
  v_smfmac_f32_16x16x64_bf16 v[24:27], v[0:3], a[232:239], v74
  ds_read_b128 v[56:59], v75 offset:1024
  buffer_store_dwordx2 v[20:21], v68, s[8:11], s74 offen
  s_waitcnt lgkmcnt(4)
  v_mov_b64 v[28:29], 0
  v_smfmac_f32_16x16x64_bf16 v[32:35], v[4:7], v[44:51], v74
  ds_read_b128 v[36:39], v75 offset:2048
  ds_read_b128 v[40:43], v75 offset:3072
  s_waitcnt lgkmcnt(4)
  v_smfmac_f32_16x16x64_bf16 v[32:35], v[8:11], v[60:67], v74
  ds_read_b128 v[44:47], v75 offset:4096
  v_cvt_pk_bf16_f32 v24, v24, v25
  v_cvt_pk_bf16_f32 v25, v26, v27
  v_bfi_b32 v24, 1, s72, v24
  v_smfmac_f32_16x16x64_bf16 v[32:35], v[12:15], a[240:247], v74
  ds_read_b128 v[48:51], v75 offset:5120
  buffer_store_dwordx2 v[24:25], v68, s[8:11], s75 offen
  v_mov_b64 v[30:31], 0
  v_smfmac_f32_16x16x64_bf16 v[32:35], v[0:3], a[248:255], v74
  ds_read_b128 v[60:63], v75 offset:6144
  ds_read_b128 v[64:67], v75 offset:7168
  s_waitcnt lgkmcnt(6)
  v_smfmac_f32_16x16x64_bf16 v[28:31], v[4:7], v[52:59], v74
  s_waitcnt lgkmcnt(4)
  v_smfmac_f32_16x16x64_bf16 v[28:31], v[8:11], v[36:43], v74
  s_waitcnt lgkmcnt(2)
  v_cvt_pk_bf16_f32 v32, v32, v33
  v_cvt_pk_bf16_f32 v33, v34, v35
  v_bfi_b32 v32, 1, s72, v32
  v_smfmac_f32_16x16x64_bf16 v[28:31], v[12:15], v[44:51], v74
  buffer_store_dwordx2 v[32:33], v68, s[8:11], s76 offen
  s_waitcnt lgkmcnt(0)
  v_smfmac_f32_16x16x64_bf16 v[28:31], v[0:3], v[60:67], v74
  v_mov_b64 v[18:19], v[72:73]
  s_nop 4
  v_cvt_pk_bf16_f32 v28, v28, v29
  v_cvt_pk_bf16_f32 v29, v30, v31
  v_bfi_b32 v28, 1, s72, v28
  buffer_store_dwordx2 v[28:29], v68, s[8:11], s77 offen
  ds_read_b128 v[0:3], v76 offset:14848
  s_waitcnt lgkmcnt(0)
  ds_read_b64 v[16:17], v77 offset:384
  s_waitcnt lgkmcnt(0)
  ds_read_b128 v[64:67], v76 offset:27648
  s_waitcnt lgkmcnt(0)
  ds_read_b128 v[60:63], v76 offset:26624
  s_waitcnt lgkmcnt(0)
  v_xor_b32 v75, 0x8000, v75
  v_mov_b64 v[28:29], 0
  v_mov_b64 v[30:31], 0
  v_mov_b64 v[32:33], 0
  v_mov_b64 v[34:35], 0
  buffer_load_dwordx4 v[52:55], v76, s[8:11], s60 offen offset:0 sc1
  buffer_load_dwordx4 v[56:59], v76, s[8:11], s60 offen offset:1024 sc1
  s_add_u32 s66, s66, 1
  s_xor_b32 s64, s64, 16384
  s_xor_b32 s65, s65, 16384
  s_add_u32 s58, s58, 655360
  s_add_u32 s59, s59, 655360
  s_add_u32 s70, s70, 655360
  s_add_u32 s68, s68, 655360
  s_mov_b32 m0, 12800
  s_add_u32 s85, s65, 8192
  s_waitcnt lgkmcnt(0)
  s_waitcnt vmcnt(1)
  v_mfma_f32_16x16x32_bf16 v[4:7], v[0:3], v[52:55], 0
  v_bitop3_b32 v72, v52, v54, s72 bitop3:0x7e
  s_waitcnt vmcnt(0)
  v_mfma_f32_16x16x32_bf16 v[4:7], v[0:3], v[56:59], v[4:7]
  v_bitop3_b32 v73, v56, v58, s72 bitop3:0x7e
  v_bitop3_b32 v72, v72, v73, 1 bitop3:0xa8
  v_cmp_ne_u32 vcc, 0, v72
  s_nop 3
  v_add_f32_dpp v4, v4, v4 row_ror:4 row_mask:0xf bank_mask:0xf
  v_add_f32_dpp v5, v5, v5 row_ror:4 row_mask:0xf bank_mask:0xf
  s_cmp_eq_u64 vcc, 0
  v_add_f32_dpp v4, v4, v4 row_ror:8 row_mask:0xf bank_mask:0xf
  v_add_f32_dpp v5, v5, v5 row_ror:8 row_mask:0xf bank_mask:0xf
  s_cselect_b32 s54, s62, 268435456
  v_cvt_pk_bf16_f32 v4, v4, v5
  buffer_store_dword v4, v69, s[8:11], s54 offen
  s_cbranch_vccnz Cf2_h1r
  s_xor_b32 s62, s62, 16384
  buffer_store_dword v71, v69, s[8:11], s62 offen
  s_xor_b32 s72, s72, 1
  s_branch Cf2_h2
Cf2_h1r:
  s_mov_b64 exec, vcc
  buffer_load_dwordx4 v[52:55], v76, s[8:11], s60 offen offset:0 sc1
  buffer_load_dwordx4 v[56:59], v76, s[8:11], s60 offen offset:1024 sc1
  s_mov_b64 exec, -1
  s_add_u32 s67, s67, 1
  s_waitcnt vmcnt(1)
  v_mfma_f32_16x16x32_bf16 v[4:7], v[0:3], v[52:55], 0
  v_bitop3_b32 v72, v52, v54, s72 bitop3:0x7e
  s_waitcnt vmcnt(0)
  v_mfma_f32_16x16x32_bf16 v[4:7], v[0:3], v[56:59], v[4:7]
  v_bitop3_b32 v73, v56, v58, s72 bitop3:0x7e
  v_bitop3_b32 v72, v72, v73, 1 bitop3:0xa8
  v_cmp_ne_u32 vcc, 0, v72
  s_cbranch_vccz Cf2_h1p
Cf2_h1s:
  s_mov_b64 exec, vcc
  buffer_load_dwordx4 v[52:55], v76, s[8:11], s60 offen offset:0 sc1
  buffer_load_dwordx4 v[56:59], v76, s[8:11], s60 offen offset:1024 sc1
  s_mov_b64 exec, -1
  s_add_u32 s67, s67, 1
  s_waitcnt vmcnt(1)
  v_mfma_f32_16x16x32_bf16 v[4:7], v[0:3], v[52:55], 0
  v_bitop3_b32 v72, v52, v54, s72 bitop3:0x7e
  s_waitcnt vmcnt(0)
  v_mfma_f32_16x16x32_bf16 v[4:7], v[0:3], v[56:59], v[4:7]
  v_bitop3_b32 v73, v56, v58, s72 bitop3:0x7e
  v_bitop3_b32 v72, v72, v73, 1 bitop3:0xa8
  v_cmp_ne_u32 vcc, 0, v72
  s_cbranch_vccz Cf2_h1p
  s_cmp_lt_u32 s67, 131072
  s_cbranch_scc1 Cf2_h1s
Cf2_h1p:
  s_nop 2
  v_add_f32_dpp v4, v4, v4 row_ror:4 row_mask:0xf bank_mask:0xf
  v_add_f32_dpp v5, v5, v5 row_ror:4 row_mask:0xf bank_mask:0xf
  s_nop 0
  v_add_f32_dpp v4, v4, v4 row_ror:8 row_mask:0xf bank_mask:0xf
  v_add_f32_dpp v5, v5, v5 row_ror:8 row_mask:0xf bank_mask:0xf
  v_cvt_pk_bf16_f32 v4, v4, v5
  buffer_store_dword v4, v69, s[8:11], s62 offen
  s_xor_b32 s62, s62, 16384
  buffer_store_dword v71, v69, s[8:11], s62 offen
  s_xor_b32 s72, s72, 1
  s_branch Cf2_h2
Cf2_h2r:
  s_mov_b64 exec, vcc
  buffer_load_dwordx4 v[12:15], v76, s[8:11], s65 offen offset:3072 sc1
  s_mov_b64 exec, -1
  s_add_u32 s67, s67, 1
  s_waitcnt vmcnt(4)
  v_max3_u32 v72, v12, v13, v14
  v_max_u32 v72, v72, v15
  ds_write_b128 v76, v[12:15] offset:7680
  v_cmp_eq_u32 vcc, -1, v72
  s_cbranch_vccz Cf2_h2w
  s_mov_b64 exec, vcc
  buffer_load_dwordx4 v[12:15], v76, s[8:11], s65 offen offset:3072 sc1
  s_mov_b64 exec, -1
  s_add_u32 s67, s67, 1
  s_waitcnt vmcnt(4)
  v_max3_u32 v72, v12, v13, v14
  v_max_u32 v72, v72, v15
  ds_write_b128 v76, v[12:15] offset:7680
  v_cmp_eq_u32 vcc, -1, v72
  s_cbranch_vccz Cf2_h2w
Cf2_h2s:
  s_mov_b64 exec, vcc
  buffer_load_dwordx4 v[12:15], v76, s[8:11], s65 offen offset:3072 sc1
  s_mov_b64 exec, -1
  s_add_u32 s67, s67, 1
  s_waitcnt vmcnt(2)
  v_max3_u32 v72, v12, v13, v14
  v_max_u32 v72, v72, v15
  ds_write_b128 v76, v[12:15] offset:7680
  v_cmp_eq_u32 vcc, -1, v72
  s_cbranch_vccz Cf2_h2w
  s_mov_b64 exec, vcc
  buffer_load_dwordx4 v[12:15], v76, s[8:11], s65 offen offset:3072 sc1
  s_mov_b64 exec, -1
  s_add_u32 s67, s67, 1
  s_waitcnt vmcnt(2)
  v_max3_u32 v72, v12, v13, v14
  v_max_u32 v72, v72, v15
  ds_write_b128 v76, v[12:15] offset:7680
  v_cmp_eq_u32 vcc, -1, v72
  s_cbranch_vccz Cf2_h2w
  s_mov_b64 exec, vcc
  buffer_load_dwordx4 v[12:15], v76, s[8:11], s65 offen offset:3072 sc1
  s_mov_b64 exec, -1
  s_add_u32 s67, s67, 1
  s_waitcnt vmcnt(2)
  v_max3_u32 v72, v12, v13, v14
  v_max_u32 v72, v72, v15
  ds_write_b128 v76, v[12:15] offset:7680
  v_cmp_eq_u32 vcc, -1, v72
  s_cbranch_vccz Cf2_h2w
  s_cmp_lt_u32 s67, 131072
  s_cbranch_scc1 Cf2_h2s
  s_branch Cf2_h2w
Cf2_rec:
  s_nop 7
  s_waitcnt vmcnt(0) lgkmcnt(0)
  v_max3_u32 v72, v0, v1, v2
  v_max3_u32 v72, v72, v3, v4
  v_max3_u32 v72, v72, v5, v6
  v_max3_u32 v72, v72, v7, v8
  v_max3_u32 v72, v72, v9, v10
  v_max3_u32 v72, v72, v11, v12
  v_max3_u32 v72, v72, v13, v14
  v_max3_u32 v72, v72, v15, v16
  v_max3_u32 v72, v72, v17, v18
  v_max_u32 v72, v72, v19
  v_cmp_eq_u32 vcc, -1, v72
  s_cbranch_vccz Cf2_recok
  s_barrier
Cf2_recp:
  buffer_load_dwordx4 v[0:3], v76, s[8:11], s64 offen offset:0 sc1
  buffer_load_dwordx4 v[4:7], v76, s[8:11], s64 offen offset:1024 sc1
  s_add_u32 s67, s67, 1
  s_cmp_lt_u32 s67, 131072
  s_cselect_b32 s54, -2, -1
  s_waitcnt vmcnt(1)
  v_max3_u32 v72, v0, v1, v2
  s_waitcnt vmcnt(0)
  v_max3_u32 v72, v72, v3, v4
  v_max3_u32 v72, v72, v5, v6
  v_max_u32 v72, v72, v7
  v_cmp_lt_u32 vcc, s54, v72
  s_cbranch_vccnz Cf2_recp
  ds_write_b128 v76, v[0:3] offset:8704
  ds_write_b128 v76, v[4:7] offset:9728
  v_mov_b64 v[20:21], 0
  v_mov_b64 v[22:23], 0
  v_mov_b64 v[24:25], 0
  v_mov_b64 v[26:27], 0
  v_mov_b64 v[28:29], 0
  v_mov_b64 v[30:31], 0
  v_mov_b64 v[32:33], 0
  v_mov_b64 v[34:35], 0
  s_waitcnt lgkmcnt(0)
  s_barrier
  ds_read_b128 v[0:3], v76 offset:4608
  s_waitcnt lgkmcnt(0)
  v_smfmac_f32_16x16x64_bf16 v[20:23], v[0:3], v[80:87], v74
  v_smfmac_f32_16x16x64_bf16 v[24:27], v[0:3], v[88:95], v74
  ds_read_b128 v[60:63], v76 offset:24576
  ds_read_b128 v[64:67], v76 offset:25600
  s_waitcnt lgkmcnt(0)
  v_smfmac_f32_16x16x64_bf16 v[28:31], v[0:3], v[60:67], v74
  ds_read_b128 v[60:63], v76 offset:26624
  ds_read_b128 v[64:67], v76 offset:27648
  s_waitcnt lgkmcnt(0)
  v_smfmac_f32_16x16x64_bf16 v[32:35], v[0:3], v[60:67], v74
  ds_read_b128 v[4:7], v76 offset:5632
  s_waitcnt lgkmcnt(0)
  v_smfmac_f32_16x16x64_bf16 v[20:23], v[4:7], v[96:103], v74
  v_smfmac_f32_16x16x64_bf16 v[24:27], v[4:7], v[104:111], v74
  ds_read_b128 v[60:63], v76 offset:40960
  ds_read_b128 v[64:67], v76 offset:41984
  s_waitcnt lgkmcnt(0)
  v_smfmac_f32_16x16x64_bf16 v[28:31], v[4:7], v[60:67], v74
  ds_read_b128 v[60:63], v76 offset:43008
  ds_read_b128 v[64:67], v76 offset:44032
  s_waitcnt lgkmcnt(0)
  v_smfmac_f32_16x16x64_bf16 v[32:35], v[4:7], v[60:67], v74
  ds_read_b128 v[8:11], v76 offset:6656
  s_waitcnt lgkmcnt(0)
  v_smfmac_f32_16x16x64_bf16 v[20:23], v[8:11], v[112:119], v74
  v_smfmac_f32_16x16x64_bf16 v[24:27], v[8:11], v[120:127], v74
  v_smfmac_f32_16x16x64_bf16 v[28:31], v[8:11], v[208:215], v74
  v_smfmac_f32_16x16x64_bf16 v[32:35], v[8:11], v[216:223], v74
  ds_read_b128 v[12:15], v76 offset:7680
  s_waitcnt lgkmcnt(0)
  v_smfmac_f32_16x16x64_bf16 v[20:23], v[12:15], v[128:135], v74
  v_smfmac_f32_16x16x64_bf16 v[24:27], v[12:15], v[136:143], v74
  v_smfmac_f32_16x16x64_bf16 v[28:31], v[12:15], v[224:231], v74
  v_smfmac_f32_16x16x64_bf16 v[32:35], v[12:15], v[232:239], v74
  ds_read_b128 v[12:15], v76 offset:8704
  s_waitcnt lgkmcnt(0)
  v_smfmac_f32_16x16x64_bf16 v[20:23], v[12:15], v[144:151], v74
  v_smfmac_f32_16x16x64_bf16 v[24:27], v[12:15], v[152:159], v74
  ds_read_b128 v[60:63], v76 offset:57344
  ds_read_b128 v[64:67], v76 offset:58368
  s_waitcnt lgkmcnt(0)
  v_smfmac_f32_16x16x64_bf16 v[28:31], v[12:15], v[60:67], v74
  ds_read_b128 v[60:63], v76 offset:59392
  ds_read_b128 v[64:67], v76 offset:60416
  s_waitcnt lgkmcnt(0)
  v_smfmac_f32_16x16x64_bf16 v[32:35], v[12:15], v[60:67], v74
  ds_read_b128 v[0:3], v76 offset:9728
  s_waitcnt lgkmcnt(0)
  v_smfmac_f32_16x16x64_bf16 v[20:23], v[0:3], v[160:167], v74
  v_smfmac_f32_16x16x64_bf16 v[24:27], v[0:3], v[168:175], v74
  ds_read_b128 v[60:63], v75 offset:24576
  ds_read_b128 v[64:67], v75 offset:25600
  s_waitcnt lgkmcnt(0)
  v_smfmac_f32_16x16x64_bf16 v[28:31], v[0:3], v[60:67], v74
  ds_read_b128 v[60:63], v75 offset:26624
  ds_read_b128 v[64:67], v75 offset:27648
  s_waitcnt lgkmcnt(0)
  v_smfmac_f32_16x16x64_bf16 v[32:35], v[0:3], v[60:67], v74
  ds_read_b128 v[16:19], v76 offset:10752
  ds_read_b128 v[60:63], v75 offset:8192
  ds_read_b128 v[64:67], v75 offset:9216
  s_waitcnt lgkmcnt(0)
  v_smfmac_f32_16x16x64_bf16 v[20:23], v[16:19], v[60:67], v74
  ds_read_b128 v[60:63], v75 offset:10240
  ds_read_b128 v[64:67], v75 offset:11264
  s_waitcnt lgkmcnt(0)
  v_smfmac_f32_16x16x64_bf16 v[24:27], v[16:19], v[60:67], v74
  v_smfmac_f32_16x16x64_bf16 v[28:31], v[16:19], v[240:247], v74
  v_smfmac_f32_16x16x64_bf16 v[32:35], v[16:19], v[248:255], v74
  ds_read_b128 v[4:7], v76 offset:11776
  s_waitcnt lgkmcnt(0)
  v_smfmac_f32_16x16x64_bf16 v[20:23], v[4:7], v[176:183], v74
  v_smfmac_f32_16x16x64_bf16 v[24:27], v[4:7], v[184:191], v74
  v_smfmac_f32_16x16x64_bf16 v[28:31], v[4:7], a[0:7], v74
  v_smfmac_f32_16x16x64_bf16 v[32:35], v[4:7], a[8:15], v74
  ds_read_b128 v[8:11], v76 offset:12800
  s_waitcnt lgkmcnt(0)
  v_smfmac_f32_16x16x64_bf16 v[20:23], v[8:11], v[192:199], v74
  v_smfmac_f32_16x16x64_bf16 v[24:27], v[8:11], v[200:207], v74
  v_smfmac_f32_16x16x64_bf16 v[28:31], v[8:11], a[16:23], v74
  v_smfmac_f32_16x16x64_bf16 v[32:35], v[8:11], a[24:31], v74
  v_add_f32 v20, v20, v22
  v_add_f32 v21, v21, v23
  v_add_f32 v24, v24, v26
  v_cvt_pk_bf16_f32 v22, v20, v24
  ds_write_b32 v79, v22 offset:0
  v_add_f32 v25, v25, v27
  v_cvt_pk_bf16_f32 v23, v21, v25
  ds_write_b32 v79, v23 offset:576
  v_add_f32 v28, v28, v30
  v_add_f32 v29, v29, v31
  s_waitcnt lgkmcnt(0)
  s_nop 1
  s_branch Cf2_recok
Cf2_mx:
  s_waitcnt lgkmcnt(0)
  s_barrier
  buffer_load_dwordx4 v[52:55], v76, s[8:11], s59 offen offset:0 sc1
  buffer_load_dwordx4 v[0:3], v76, s[8:11], s58 offen offset:0 sc1
  ds_read_b128 v[20:23], v77 offset:0
  ds_read_b128 v[28:31], v77 offset:256
  buffer_load_dwordx4 v[56:59], v76, s[8:11], s59 offen offset:1024 sc1
  buffer_load_dwordx4 v[4:7], v76, s[8:11], s58 offen offset:1024 sc1
  ds_read_b128 v[24:27], v77 offset:128
  ds_read_b128 v[32:35], v77 offset:384
  s_waitcnt vmcnt(2) lgkmcnt(3)
  v_mfma_f32_16x16x32_bf16 v[8:11], v[0:3], v[20:23], 0
  s_waitcnt vmcnt(0) lgkmcnt(1)
  v_mfma_f32_16x16x32_bf16 v[8:11], v[4:7], v[24:27], v[8:11]
  v_mfma_f32_16x16x32_bf16 v[12:15], v[28:31], v[20:23], 0
  s_waitcnt lgkmcnt(0)
  v_mfma_f32_16x16x32_bf16 v[12:15], v[32:35], v[24:27], v[12:15]
  v_add_f32_dpp v8, v10, v8 quad_perm:[2,3,0,1] row_mask:0xf bank_mask:0xf
  v_add_f32_dpp v9, v11, v9 quad_perm:[2,3,0,1] row_mask:0xf bank_mask:0xf
  s_nop 0
  v_mov_b32_dpp v8, v8 quad_perm:[0,1,0,1] row_mask:0xf bank_mask:0xf
  v_mov_b32_dpp v9, v9 quad_perm:[0,1,0,1] row_mask:0xf bank_mask:0xf
  s_nop 1
  v_add_f32_dpp v12, v14, v12 quad_perm:[2,3,0,1] row_mask:0xf bank_mask:0xf
  v_add_f32_dpp v13, v15, v13 quad_perm:[2,3,0,1] row_mask:0xf bank_mask:0xf
  s_nop 0
  v_mov_b32_dpp v12, v12 quad_perm:[0,1,0,1] row_mask:0xf bank_mask:0xf
  v_mov_b32_dpp v13, v13 quad_perm:[0,1,0,1] row_mask:0xf bank_mask:0xf
  v_mul_f32 v12, s69, v12
  ds_write_b32 v78, v8 offset:8712
  v_mul_f32 v13, s69, v13
  ds_write_b32 v78, v9 offset:8776
  s_waitcnt lgkmcnt(0)
  s_barrier
  ds_read_b128 v[36:39], v78 offset:8704
  ds_read_b128 v[40:43], v78 offset:8768
  s_waitcnt lgkmcnt(0)
  s_barrier
  v_max_f32 v16, v36, v37
  v_max3_f32 v16, v16, v38, v39
  v_max3_f32 v16, v16, v40, v41
  v_max3_f32 v16, v16, v42, v43
  v_max3_f32 v16, v16, v12, v13
  v_mov_b32 v17, v16
  s_nop 1
  v_permlane16_swap_b32 v16, v17
  v_max_f32 v16, v16, v17
  v_mov_b32 v17, v16
  s_nop 1
  v_permlane32_swap_b32 v16, v17
  v_max_f32 v16, v16, v17
  v_sub_f32 v36, v36, v16
  v_sub_f32 v37, v37, v16
  v_sub_f32 v38, v38, v16
  v_sub_f32 v39, v39, v16
  v_sub_f32 v40, v40, v16
  v_sub_f32 v41, v41, v16
  v_sub_f32 v42, v42, v16
  v_sub_f32 v43, v43, v16
  v_sub_f32 v12, v12, v16
  v_sub_f32 v13, v13, v16
  v_exp_f32 v36, v36
  v_exp_f32 v37, v37
  v_exp_f32 v38, v38
  v_exp_f32 v39, v39
  v_exp_f32 v40, v40
  v_exp_f32 v41, v41
  v_exp_f32 v42, v42
  v_exp_f32 v43, v43
  v_exp_f32 v12, v12
  v_exp_f32 v13, v13
  v_cvt_pk_bf16_f32 v32, v36, v40
  v_cvt_pk_bf16_f32 v33, v37, v41
  v_cvt_pk_bf16_f32 v34, v38, v42
  v_cvt_pk_bf16_f32 v35, v39, v43
  v_cvt_pk_bf16_f32 v28, v12, v13
  v_cvt_pk_bf16_f32 v31, v12, v13
  v_mov_b32 v29, 0
  v_mov_b32 v30, 0
  v_mfma_f32_16x16x32_bf16 v[8:11], v[32:35], v[68:71], 0
  v_mfma_f32_16x16x32_bf16 v[0:3], v[32:35], v[52:55], 0
  v_mfma_f32_16x16x32_bf16 v[4:7], v[32:35], v[56:59], 0
  v_mfma_f32_16x16x16_bf16 v[8:11], v[28:29], v[68:69], v[8:11]
  v_mfma_f32_16x16x16_bf16 v[0:3], v[28:29], v[72:73], v[0:3]
  v_mfma_f32_16x16x16_bf16 v[4:7], v[30:31], v[72:73], v[4:7]
  ds_read_b128 v[52:55], v75 offset:26624
  v_rcp_f32 v10, v8
  v_rcp_f32 v11, v9
  v_mul_f32 v0, v10, v0
  v_mul_f32 v1, v11, v1
  v_max3_f32 v8, v8, v9, v10
  v_mul_f32 v4, v10, v4
  v_mul_f32 v5, v11, v5
  v_cvt_pk_bf16_f32 v2, v0, v4
  ds_write_b32 v79, v2 offset:8704
  v_cvt_pk_bf16_f32 v3, v1, v5
  ds_write_b32 v79, v3 offset:9280
  ds_read_b128 v[12:15], v78 offset:8832
  ds_read_b128 v[56:59], v75 offset:27648
  v_mov_b64 v[16:17], 0
  v_mov_b64 v[18:19], 0
  v_mov_b64 v[20:21], 0
  v_mov_b64 v[22:23], 0
  v_mov_b64 v[24:25], 0
  v_mov_b64 v[26:27], 0
  s_branch Cf2_mxok
Cf2_last:
  ds_read_b128 v[4:7], v76 offset:5632
  ds_read_b128 v[8:11], v76 offset:6656
  ds_read_b128 v[44:47], v76 offset:40960
  ds_read_b128 v[48:51], v76 offset:41984
  s_nop 5
  v_mov_b64 v[20:21], 0
  v_mov_b64 v[22:23], 0
  v_mov_b64 v[24:25], 0
  v_mov_b64 v[26:27], 0
  s_waitcnt lgkmcnt(4)
  v_smfmac_f32_16x16x64_bf16 v[28:31], v[0:3], v[36:43], v74
  ds_read_b128 v[36:39], v76 offset:43008
  ds_read_b128 v[40:43], v76 offset:44032
  v_smfmac_f32_16x16x64_bf16 v[32:35], v[0:3], v[60:67], v74
  s_waitcnt lgkmcnt(5)
  v_smfmac_f32_16x16x64_bf16 v[20:23], v[0:3], a[32:39], v74
  ds_read_b128 v[60:63], v76 offset:57344
  ds_read_b128 v[64:67], v76 offset:58368
  v_smfmac_f32_16x16x64_bf16 v[24:27], v[0:3], a[40:47], v74
  s_waitcnt lgkmcnt(4)
  v_smfmac_f32_16x16x64_bf16 v[20:23], v[4:7], a[48:55], v74
  buffer_store_dwordx4 v[16:19], v76, s[8:11], s68 offen sc1
  v_smfmac_f32_16x16x64_bf16 v[24:27], v[4:7], a[56:63], v74
  v_smfmac_f32_16x16x64_bf16 v[28:31], v[4:7], v[44:51], v74
  s_waitcnt lgkmcnt(2)
  v_smfmac_f32_16x16x64_bf16 v[20:23], v[8:11], a[64:71], v74
  ds_read_b128 v[44:47], v76 offset:59392
  ds_read_b128 v[48:51], v76 offset:60416
  v_smfmac_f32_16x16x64_bf16 v[24:27], v[8:11], a[72:79], v74
  v_smfmac_f32_16x16x64_bf16 v[32:35], v[4:7], v[36:43], v74
  v_smfmac_f32_16x16x64_bf16 v[28:31], v[8:11], v[208:215], v74
  ds_read_b128 v[36:39], v75 offset:24576
  ds_read_b128 v[40:43], v75 offset:25600
  v_smfmac_f32_16x16x64_bf16 v[32:35], v[8:11], v[216:223], v74
  v_smfmac_f32_16x16x64_bf16 v[20:23], v[12:15], a[80:87], v74
  v_smfmac_f32_16x16x64_bf16 v[24:27], v[12:15], a[88:95], v74
  v_smfmac_f32_16x16x64_bf16 v[28:31], v[12:15], v[224:231], v74
  v_smfmac_f32_16x16x64_bf16 v[32:35], v[12:15], v[232:239], v74
  s_waitcnt vmcnt(2)
  s_waitcnt vmcnt(1)
  s_barrier
Cf2_lastr:
  ds_read_b128 v[12:15], v76 offset:8704
  ds_read_b128 v[0:3], v76 offset:9728
  ds_read_b128 v[16:19], v76 offset:10752
  ds_read_b128 v[4:7], v76 offset:11776
  ds_read_b128 v[8:11], v76 offset:12800
  s_waitcnt lgkmcnt(3)
  v_max3_u32 v72, v0, v1, v2
  s_waitcnt lgkmcnt(1)
  v_max3_u32 v72, v72, v3, v4
  v_max3_u32 v72, v72, v5, v6
  s_waitcnt lgkmcnt(0)
  v_max3_u32 v72, v72, v7, v8
  v_max3_u32 v72, v72, v9, v10
  v_max3_u32 v72, v72, v11, v12
  v_max3_u32 v72, v72, v13, v14
  v_max3_u32 v72, v72, v15, v16
  v_max3_u32 v72, v72, v17, v18
  v_max_u32 v72, v72, v19
  v_cmp_eq_u32 vcc, -1, v72
  s_cbranch_vccnz Cf2_lastp
Cf2_lastg:
  v_smfmac_f32_16x16x64_bf16 v[28:31], v[12:15], v[60:67], v74
  ds_read_b128 v[60:63], v75 offset:26624
  ds_read_b128 v[64:67], v75 offset:27648
  v_smfmac_f32_16x16x64_bf16 v[32:35], v[12:15], v[44:51], v74
  v_smfmac_f32_16x16x64_bf16 v[28:31], v[0:3], v[36:43], v74
  v_smfmac_f32_16x16x64_bf16 v[28:31], v[16:19], v[240:247], v74
  v_smfmac_f32_16x16x64_bf16 v[28:31], v[4:7], a[0:7], v74
  v_smfmac_f32_16x16x64_bf16 v[28:31], v[8:11], a[16:23], v74
  v_smfmac_f32_16x16x64_bf16 v[32:35], v[16:19], v[248:255], v74
  v_smfmac_f32_16x16x64_bf16 v[32:35], v[4:7], a[8:15], v74
  s_waitcnt lgkmcnt(0)
  v_smfmac_f32_16x16x64_bf16 v[32:35], v[8:11], a[24:31], v74
  v_smfmac_f32_16x16x64_bf16 v[32:35], v[0:3], v[60:67], v74
  v_smfmac_f32_16x16x64_bf16 v[20:23], v[12:15], a[96:103], v74
  v_smfmac_f32_16x16x64_bf16 v[20:23], v[0:3], a[112:119], v74
  v_add_f32 v28, v28, v30
  v_add_f32 v32, v32, v34
  v_cvt_pk_bf16_f32 v30, v28, v32
  v_smfmac_f32_16x16x64_bf16 v[20:23], v[16:19], a[128:135], v74
  ds_write_b32 v79, v30 offset:256
  v_add_f32 v29, v29, v31
  v_add_f32 v33, v33, v35
  v_cvt_pk_bf16_f32 v31, v29, v33
  v_smfmac_f32_16x16x64_bf16 v[20:23], v[4:7], a[144:151], v74
  ds_write_b32 v79, v31 offset:832
  v_smfmac_f32_16x16x64_bf16 v[20:23], v[8:11], a[160:167], v74
  v_smfmac_f32_16x16x64_bf16 v[24:27], v[12:15], a[104:111], v74
  v_smfmac_f32_16x16x64_bf16 v[24:27], v[0:3], a[120:127], v74
  v_smfmac_f32_16x16x64_bf16 v[24:27], v[16:19], a[136:143], v74
  s_waitcnt lgkmcnt(0)
  s_barrier
  ds_read_b64 v[52:53], v77 offset:384
  v_add_f32 v20, v20, v22
  v_smfmac_f32_16x16x64_bf16 v[24:27], v[4:7], a[152:159], v74
  v_add_f32 v21, v21, v23
  v_smfmac_f32_16x16x64_bf16 v[24:27], v[8:11], a[168:175], v74
  v_cvt_pk_bf16_f32 v54, v20, v21
  s_add_u32 s68, s68, 655360
  s_nop 3
  v_add_f32 v24, v24, v26
  v_add_f32 v25, v25, v27
  v_cvt_pk_bf16_f32 v55, v24, v25
  s_waitcnt lgkmcnt(0)
  buffer_store_dwordx4 v[52:55], v76, s[8:11], s68 offen sc1
  s_branch Cf2_done
Cf2_lastp:
  s_add_u32 s72, s72, 2
  s_cmp_ge_u32 s72, 131072
  s_cbranch_scc1 Cf2_lastg
  s_barrier
  buffer_load_dwordx4 v76, s[8:11], s85 offen offset:0 sc1 lds
  s_waitcnt vmcnt(0)
  s_barrier
  s_branch Cf2_lastr
Cf2_done:
  s_branch L_cexit
L_w3:
  v_mov_b64 v[20:21], 0
  v_mov_b64 v[22:23], 0
  v_mov_b64 v[24:25], 0
  v_mov_b64 v[26:27], 0
  v_mov_b64 v[28:29], 0
  v_mov_b64 v[30:31], 0
  v_mov_b64 v[32:33], 0
  v_mov_b64 v[34:35], 0
  s_mov_b32 s78, 0x3f803f80
  s_mov_b32 s79, s78
  s_mov_b32 s65, 360448
  s_mov_b32 m0, 15872
  s_lshl_b32 s71, s53, 2
  s_add_u32 s71, s71, 128
  s_movk_i32 s56, 0x1000
  v_lshlrev_b32 v73, 2, v76
  v_mov_b32 v72, 0
  s_mov_b64 s[16:17], s[8:9]
  s_mov_b32 s18, 268435456
  s_mov_b32 s19, 0x20000
  s_getpc_b64 s[20:21]
Cf3_pc:
  s_add_u32 s20, s20, (Cf3_last - Cf3_pc)
  s_addc_u32 s21, s21, 0
  v_mov_b32 v68, 14880
  buffer_load_dwordx4 v[52:55], v76, s[8:11], s59 offen offset:0 sc1
  buffer_load_dwordx4 v[56:59], v76, s[8:11], s59 offen offset:1024 sc1
  ds_read_b128 v[36:39], v76 offset:45056
  ds_read_b128 v[40:43], v76 offset:46080
  ds_read_b128 v[60:63], v76 offset:47104
  ds_read_b128 v[64:67], v76 offset:48128
  ds_read_b128 v[0:3], v76 offset:4608
  ds_read_b128 v[4:7], v76 offset:5632
  ds_read_b128 v[8:11], v76 offset:6656
  ds_read_b128 v[12:15], v76 offset:7680
  s_waitcnt lgkmcnt(0)
  s_cmp_eq_u32 s66, 1
  s_branch Cf3_top2
.p2align 6
Cf3_h2:
  v_lshlrev_b32 v73, 2, v76
  buffer_load_dwordx4 v[4:7], v76, s[8:11], s65 offen offset:1024 sc1
  ds_read_b128 v[36:39], v76 offset:45056
  ds_read_b128 v[40:43], v76 offset:46080
  buffer_load_dwordx4 v[52:55], v76, s[8:11], s59 offen offset:0 sc1
  buffer_load_dwordx4 v[56:59], v76, s[8:11], s59 offen offset:1024 sc1
  s_waitcnt vmcnt(7)
  v_max3_u32 v72, v4, v5, v6
  v_max_u32 v72, v72, v7
  ds_write_b128 v76, v[4:7] offset:5632
  v_cmp_eq_u32 vcc, -1, v72
  s_cbranch_vccnz Cf3_h2r
Cf3_h2w:
  buffer_load_dwordx4 v76, s[8:11], s85 offen offset:0 sc1 lds
  buffer_load_dwordx4 v76, s[8:11], s85 offen offset:1024 sc1 lds
  s_cmp_eq_u32 s66, 63
  s_waitcnt lgkmcnt(0)
  s_barrier
  ds_read_b128 v[8:11], v76 offset:6656
Cf3_top2:
  v_smfmac_f32_16x16x64_bf16 v[20:23], v[4:7], v[96:103], v74
  s_cbranch_scc1 Cf3_last
  v_smfmac_f32_16x16x64_bf16 v[28:31], v[4:7], v[36:43], v74
  buffer_load_dwordx4 v[44:47], v76, s[8:11], s58 offen offset:0 sc1
  s_mov_b32 m0, 15872
  v_smfmac_f32_16x16x64_bf16 v[24:27], v[4:7], v[104:111], v74
  buffer_load_dwordx4 v[48:51], v76, s[8:11], s58 offen offset:1024 sc1
  v_smfmac_f32_16x16x64_bf16 v[32:35], v[4:7], v[60:67], v74
  ds_read_b128 v[0:3], v76 offset:4608
  s_waitcnt lgkmcnt(1)
  v_smfmac_f32_16x16x64_bf16 v[20:23], v[8:11], v[112:119], v74
  ds_read_b128 v[12:15], v76 offset:7680
  v_smfmac_f32_16x16x64_bf16 v[24:27], v[8:11], v[120:127], v74
  ds_read_b128 v[36:39], v76 offset:28672
  v_smfmac_f32_16x16x64_bf16 v[28:31], v[8:11], v[208:215], v74
  buffer_store_dwordx4 v[16:19], v76, s[8:11], s68 offen sc1
  ds_read_b128 v[40:43], v76 offset:29696
  v_smfmac_f32_16x16x64_bf16 v[32:35], v[8:11], v[216:223], v74
  buffer_load_dword v73, s[16:19], s70 offen lds
  ds_read_b128 v[60:63], v76 offset:30720
  s_waitcnt lgkmcnt(4)
  v_smfmac_f32_16x16x64_bf16 v[20:23], v[0:3], v[80:87], v74
  ds_read_b128 v[64:67], v76 offset:31744
  v_smfmac_f32_16x16x64_bf16 v[24:27], v[0:3], v[88:95], v74
  s_waitcnt vmcnt(4)
  s_waitcnt lgkmcnt(4)
  v_smfmac_f32_16x16x64_bf16 v[20:23], v[12:15], v[128:135], v74
  s_barrier
  ds_read_b128 v[4:7], v76 offset:8704
  s_waitcnt lgkmcnt(3)
  v_smfmac_f32_16x16x64_bf16 v[28:31], v[0:3], v[36:43], v74
  ds_read_b128 v[36:39], v76 offset:61440
  v_smfmac_f32_16x16x64_bf16 v[24:27], v[12:15], v[136:143], v74
  ds_read_b128 v[40:43], v76 offset:62464
  s_waitcnt lgkmcnt(3)
  v_smfmac_f32_16x16x64_bf16 v[32:35], v[0:3], v[60:67], v74
  ds_read_b128 v[8:11], v76 offset:9728
  v_smfmac_f32_16x16x64_bf16 v[28:31], v[12:15], v[224:231], v74
  ds_read_b128 v[60:63], v76 offset:63488
  v_smfmac_f32_16x16x64_bf16 v[32:35], v[12:15], v[232:239], v74
  ds_read_b128 v[64:67], v76 offset:64512
  s_waitcnt lgkmcnt(5)
  v_smfmac_f32_16x16x64_bf16 v[20:23], v[4:7], v[144:151], v74
  s_barrier
  ds_read_b128 v[0:3], v76 offset:11776
  s_waitcnt lgkmcnt(4)
  v_smfmac_f32_16x16x64_bf16 v[28:31], v[4:7], v[36:43], v74
  ds_read_b128 v[12:15], v76 offset:12800
  ds_read_b128 v[36:39], v75 offset:12288
  v_smfmac_f32_16x16x64_bf16 v[24:27], v[4:7], v[152:159], v74
  ds_read_b128 v[16:19], v76 offset:10752
  s_waitcnt lgkmcnt(6)
  v_smfmac_f32_16x16x64_bf16 v[20:23], v[8:11], v[160:167], v74
  ds_read_b128 v[40:43], v75 offset:13312
  s_waitcnt lgkmcnt(5)
  v_smfmac_f32_16x16x64_bf16 v[32:35], v[4:7], v[60:67], v74
  ds_read_b128 v[60:63], v75 offset:14336
  v_smfmac_f32_16x16x64_bf16 v[24:27], v[8:11], v[168:175], v74
  ds_read_b128 v[64:67], v75 offset:15360
  s_waitcnt lgkmcnt(6)
  v_smfmac_f32_16x16x64_bf16 v[20:23], v[0:3], v[176:183], v74
  s_waitcnt lgkmcnt(5)
  v_smfmac_f32_16x16x64_bf16 v[20:23], v[12:15], v[192:199], v74
  s_waitcnt lgkmcnt(2)
  v_smfmac_f32_16x16x64_bf16 v[20:23], v[16:19], v[36:43], v74
  ds_read_b128 v[36:39], v75 offset:28672
  v_smfmac_f32_16x16x64_bf16 v[24:27], v[0:3], v[184:191], v74
  ds_read_b128 v[40:43], v75 offset:29696
  s_waitcnt lgkmcnt(2)
  v_smfmac_f32_16x16x64_bf16 v[24:27], v[16:19], v[60:67], v74
  ds_read_b128 v[60:63], v75 offset:30720
  v_add_f32 v20, v20, v22
  v_smfmac_f32_16x16x64_bf16 v[24:27], v[12:15], v[200:207], v74
  ds_read_b128 v[64:67], v75 offset:31744
  v_add_f32 v21, v21, v23
  v_smfmac_f32_16x16x64_bf16 v[28:31], v[16:19], v[240:247], v74
  v_mov_b64 v[70:71], s[78:79]
  v_smfmac_f32_16x16x64_bf16 v[28:31], v[0:3], a[0:7], v74
  s_waitcnt lgkmcnt(2)
  v_add_f32 v24, v24, v26
  v_smfmac_f32_16x16x64_bf16 v[28:31], v[8:11], v[36:43], v74
  ds_read_b128 v[36:39], v68
  v_cvt_pk_bf16_f32 v22, v20, v24
  v_smfmac_f32_16x16x64_bf16 v[28:31], v[12:15], a[16:23], v74
  ds_read_b128 v[40:43], v68
  ds_write_b32 v79, v22 offset:0
  s_waitcnt lgkmcnt(3)
  v_add_f32 v25, v25, v27
  v_cvt_pk_bf16_f32 v23, v21, v25
  v_smfmac_f32_16x16x64_bf16 v[32:35], v[8:11], v[60:67], v74
  ds_write_b32 v79, v23 offset:576
  v_cmp_u_f32 vcc, v20, v21
  v_smfmac_f32_16x16x64_bf16 v[32:35], v[16:19], v[248:255], v74
  v_add_f32 v28, v28, v30
  v_smfmac_f32_16x16x64_bf16 v[32:35], v[0:3], a[8:15], v74
  v_add_f32 v29, v29, v31
  v_smfmac_f32_16x16x64_bf16 v[32:35], v[12:15], a[24:31], v74
  s_cbranch_vccnz Cf3_rec
Cf3_recok:
  s_waitcnt lgkmcnt(3)
  v_smfmac_f32_16x16x64_bf16 v[36:39], v[16:19], a[128:135], v74
  s_waitcnt lgkmcnt(0)
  s_barrier
  ds_read_b128 v[60:63], v77
  v_smfmac_f32_16x16x64_bf16 v[40:43], v[16:19], a[136:143], v74
  ds_read_b128 v[64:67], v77 offset:128
  v_add_f32 v32, v32, v34
  v_cvt_pk_bf16_f32 v30, v28, v32
  v_smfmac_f32_16x16x64_bf16 v[36:39], v[0:3], a[144:151], v74
  ds_write_b32 v79, v30 offset:256
  v_add_f32 v33, v33, v35
  v_cvt_pk_bf16_f32 v31, v29, v33
  v_smfmac_f32_16x16x64_bf16 v[40:43], v[0:3], a[152:159], v74
  ds_write_b32 v79, v31 offset:832
  v_xor_b32 v75, 0x8000, v75
  v_smfmac_f32_16x16x64_bf16 v[36:39], v[4:7], a[96:103], v74
  ds_read_b128 v[0:3], v76 offset:4608
  v_mov_b32 v29, 0
  v_smfmac_f32_16x16x64_bf16 v[40:43], v[4:7], a[104:111], v74
  s_waitcnt vmcnt(2) lgkmcnt(3)
  v_mov_b32 v30, 0
  v_mfma_f32_16x16x32_bf16 v[44:47], v[44:47], v[60:63], 0
  ds_read_b128 v[4:7], v76 offset:5632
  s_waitcnt lgkmcnt(2)
  v_mfma_f32_16x16x32_bf16 v[44:47], v[48:51], v[64:67], v[44:47]
  s_barrier
  v_smfmac_f32_16x16x64_bf16 v[36:39], v[8:11], a[112:119], v74
  ds_read_b128 v[20:23], v77 offset:256
  ds_read_b128 v[24:27], v77 offset:384
  v_smfmac_f32_16x16x64_bf16 v[40:43], v[8:11], a[120:127], v74
  ds_read_b128 v[8:11], v76 offset:6656
  v_add_f32_dpp v72, v46, v44 quad_perm:[2,3,0,1] row_mask:0xf bank_mask:0xf
  v_add_f32_dpp v73, v47, v45 quad_perm:[2,3,0,1] row_mask:0xf bank_mask:0xf
  v_smfmac_f32_16x16x64_bf16 v[36:39], v[12:15], a[160:167], v74
  s_waitcnt lgkmcnt(4)
  v_exp_f32_dpp v72, v72 quad_perm:[0,1,0,1] row_mask:0xf bank_mask:0xf
  v_smfmac_f32_16x16x64_bf16 v[40:43], v[12:15], a[168:175], v74
  ds_read_b128 v[12:15], v76 offset:7680
  v_exp_f32_dpp v73, v73 quad_perm:[0,1,0,1] row_mask:0xf bank_mask:0xf
  v_smfmac_f32_16x16x64_bf16 v[36:39], v[0:3], a[32:39], v74
  s_waitcnt lgkmcnt(2)
  v_cvt_pk_bf16_f32 v72, v72, v73
  v_mfma_f32_16x16x32_bf16 v[20:23], v[20:23], v[60:63], 0
  ds_write_b32 v78, v72 offset:524
  v_mov_b64 v[16:17], 0
  v_mfma_f32_16x16x32_bf16 v[20:23], v[24:27], v[64:67], v[20:23]
  ds_read_b128 v[44:47], v75 offset:47104
  v_mov_b64 v[18:19], 0
  v_smfmac_f32_16x16x64_bf16 v[40:43], v[0:3], a[40:47], v74
  ds_read_b128 v[48:51], v75 offset:48128
  v_mov_b64 v[68:69], s[78:79]
  v_smfmac_f32_16x16x64_bf16 v[36:39], v[4:7], a[48:55], v74
  s_waitcnt lgkmcnt(4)
  v_add_f32_dpp v24, v22, v20 quad_perm:[2,3,0,1] row_mask:0xf bank_mask:0xf
  v_add_f32_dpp v25, v23, v21 quad_perm:[2,3,0,1] row_mask:0xf bank_mask:0xf
  v_smfmac_f32_16x16x64_bf16 v[36:39], v[8:11], a[64:71], v74
  s_waitcnt lgkmcnt(2)
  s_barrier
  ds_read_b128 v[32:35], v78 offset:512
  v_smfmac_f32_16x16x64_bf16 v[36:39], v[12:15], a[80:87], v74
  ds_read_b128 v[60:63], v75 offset:28672
  v_mul_f32 v24, s69, v24
  v_smfmac_f32_16x16x64_bf16 v[40:43], v[4:7], a[56:63], v74
  ds_read_b128 v[64:67], v75 offset:29696
  v_mul_f32 v25, s69, v25
  v_smfmac_f32_16x16x64_bf16 v[40:43], v[8:11], a[72:79], v74
  v_exp_f32_dpp v24, v24 quad_perm:[0,1,0,1] row_mask:0xf bank_mask:0xf
  v_smfmac_f32_16x16x64_bf16 v[40:43], v[12:15], a[88:95], v74
  s_waitcnt lgkmcnt(2)
  v_exp_f32_dpp v25, v25 quad_perm:[0,1,0,1] row_mask:0xf bank_mask:0xf
  v_mfma_f32_16x16x32_bf16 v[8:11], v[32:35], v[68:71], 0
  v_add_f32 v36, v36, v38
  v_add_f32 v37, v37, v39
  v_mfma_f32_16x16x32_bf16 v[0:3], v[32:35], v[52:55], 0
  v_add_f32 v40, v40, v42
  v_add_f32 v41, v41, v43
  v_mfma_f32_16x16x32_bf16 v[4:7], v[32:35], v[56:59], 0
  v_cvt_pk_bf16_f32 v28, v24, v25
  v_cvt_pk_bf16_f32 v72, v36, v37
  v_cvt_pk_bf16_f32 v73, v40, v41
  v_mfma_f32_16x16x16_bf16 v[8:11], v[28:29], v[68:69], v[8:11]
  v_cvt_pk_bf16_f32 v31, v24, v25
  v_mov_b64 v[20:21], 0
  v_mfma_f32_16x16x16_bf16 v[0:3], v[28:29], v[72:73], v[0:3]
  ds_read_b128 v[52:55], v75 offset:30720
  v_mov_b64 v[22:23], 0
  v_mfma_f32_16x16x16_bf16 v[4:7], v[30:31], v[72:73], v[4:7]
  v_rcp_f32 v10, v8
  v_rcp_f32 v11, v9
  v_mul_f32 v0, v10, v0
  v_mul_f32 v1, v11, v1
  v_max3_f32 v8, v8, v9, v10
  v_mul_f32 v4, v10, v4
  v_mul_f32 v5, v11, v5
  v_cvt_pk_bf16_f32 v2, v0, v4
  ds_write_b32 v79, v2 offset:8704
  v_cvt_pk_bf16_f32 v3, v1, v5
  ds_write_b32 v79, v3 offset:9280
  ds_read_b128 v[12:15], v78 offset:8896
  v_max_f32 v8, v8, v11
  v_cmp_le_f32 vcc, 1317011456, v8
  v_mov_b64 v[24:25], 0
  v_mov_b64 v[26:27], 0
  ds_read_b128 v[56:59], v75 offset:31744
  s_cbranch_vccnz Cf3_mx
Cf3_mxok:
  s_waitcnt lgkmcnt(2)
  s_barrier
  ds_read_b128 v[0:3], v78 offset:8832
  s_waitcnt lgkmcnt(2)
  v_smfmac_f32_16x16x64_bf16 v[16:19], v[12:15], a[184:191], v74
  ds_read_b128 v[4:7], v78 offset:8704
  v_smfmac_f32_16x16x64_bf16 v[20:23], v[12:15], v[44:51], v74
  ds_read_b128 v[8:11], v78 offset:8768
  v_smfmac_f32_16x16x64_bf16 v[24:27], v[12:15], a[232:239], v74
  ds_read_b128 v[36:39], v75 offset:45056
  s_waitcnt lgkmcnt(3)
  v_smfmac_f32_16x16x64_bf16 v[16:19], v[0:3], a[176:183], v74
  ds_read_b128 v[40:43], v75 offset:46080
  s_waitcnt lgkmcnt(3)
  v_smfmac_f32_16x16x64_bf16 v[16:19], v[4:7], v[60:67], v74
  ds_read_b128 v[68:71], v76 offset:13824
  s_waitcnt lgkmcnt(3)
  v_smfmac_f32_16x16x64_bf16 v[16:19], v[8:11], v[52:59], v74
  ds_read_b128 v[44:47], v75 offset:61440
  v_smfmac_f32_16x16x64_bf16 v[20:23], v[4:7], a[192:199], v74
  ds_read_b128 v[48:51], v75 offset:62464
  v_smfmac_f32_16x16x64_bf16 v[20:23], v[8:11], a[200:207], v74
  ds_read_b128 v[60:63], v75 offset:63488
  s_waitcnt lgkmcnt(4)
  v_cvt_pk_bf16_f32 v16, v16, v17
  v_cvt_pk_bf16_f32 v17, v18, v19
  v_bfi_b32 v16, 1, s72, v16
  v_smfmac_f32_16x16x64_bf16 v[20:23], v[0:3], v[36:43], v74
  s_waitcnt lgkmcnt(3)
  buffer_store_dwordx2 v[16:17], v68, s[8:11], s73 offen
  v_mov_b64 v[32:33], 0
  v_smfmac_f32_16x16x64_bf16 v[24:27], v[4:7], a[208:215], v74
  ds_read_b128 v[64:67], v75 offset:64512
  v_mov_b64 v[34:35], 0
  v_smfmac_f32_16x16x64_bf16 v[24:27], v[8:11], a[216:223], v74
  ds_read_b128 v[52:55], v75 offset:8192
  v_cvt_pk_bf16_f32 v20, v20, v21
  v_cvt_pk_bf16_f32 v21, v22, v23
  v_bfi_b32 v20, 1, s72, v20
  v_smfmac_f32_16x16x64_bf16 v[24:27], v[0:3], a[224:231], v74
  ds_read_b128 v[56:59], v75 offset:9216
  buffer_store_dwordx2 v[20:21], v68, s[8:11], s74 offen
  s_waitcnt lgkmcnt(4)
  v_mov_b64 v[28:29], 0
  v_smfmac_f32_16x16x64_bf16 v[32:35], v[4:7], v[44:51], v74
  ds_read_b128 v[36:39], v75 offset:10240
  ds_read_b128 v[40:43], v75 offset:11264
  s_waitcnt lgkmcnt(4)
  v_smfmac_f32_16x16x64_bf16 v[32:35], v[8:11], v[60:67], v74
  ds_read_b128 v[44:47], v75 offset:12288
  v_cvt_pk_bf16_f32 v24, v24, v25
  v_cvt_pk_bf16_f32 v25, v26, v27
  v_bfi_b32 v24, 1, s72, v24
  v_smfmac_f32_16x16x64_bf16 v[32:35], v[0:3], a[240:247], v74
  ds_read_b128 v[48:51], v75 offset:13312
  buffer_store_dwordx2 v[24:25], v68, s[8:11], s75 offen
  v_mov_b64 v[30:31], 0
  v_smfmac_f32_16x16x64_bf16 v[32:35], v[12:15], a[248:255], v74
  ds_read_b128 v[60:63], v75 offset:14336
  ds_read_b128 v[64:67], v75 offset:15360
  s_waitcnt lgkmcnt(6)
  v_smfmac_f32_16x16x64_bf16 v[28:31], v[4:7], v[52:59], v74
  s_waitcnt lgkmcnt(4)
  v_smfmac_f32_16x16x64_bf16 v[28:31], v[8:11], v[36:43], v74
  s_waitcnt lgkmcnt(2)
  v_cvt_pk_bf16_f32 v32, v32, v33
  v_cvt_pk_bf16_f32 v33, v34, v35
  v_bfi_b32 v32, 1, s72, v32
  v_smfmac_f32_16x16x64_bf16 v[28:31], v[0:3], v[44:51], v74
  buffer_store_dwordx2 v[32:33], v68, s[8:11], s76 offen
  s_waitcnt lgkmcnt(0)
  v_smfmac_f32_16x16x64_bf16 v[28:31], v[12:15], v[60:67], v74
  v_mov_b64 v[18:19], v[72:73]
  s_nop 4
  v_cvt_pk_bf16_f32 v28, v28, v29
  v_cvt_pk_bf16_f32 v29, v30, v31
  v_bfi_b32 v28, 1, s72, v28
  buffer_store_dwordx2 v[28:29], v68, s[8:11], s77 offen
  ds_read_b128 v[52:55], v76 offset:14848
  s_waitcnt lgkmcnt(0)
  ds_read_b64 v[16:17], v77 offset:392
  s_waitcnt lgkmcnt(0)
  ds_read_b128 v[60:63], v76 offset:47104
  s_waitcnt lgkmcnt(0)
  ds_read_b128 v[64:67], v76 offset:48128
  s_waitcnt lgkmcnt(0)
  s_add_u32 s66, s66, 1
  s_xor_b32 s64, s64, 16384
  s_xor_b32 s65, s65, 16384
  s_add_u32 s58, s58, 655360
  s_add_u32 s59, s59, 655360
  s_add_u32 s70, s70, 655360
  s_add_u32 s68, s68, 655360
  s_mov_b32 m0, 8704
  s_add_u32 s85, s65, 4096
  v_xor_b32 v75, 0x8000, v75
  v_mov_b64 v[28:29], 0
  v_mov_b64 v[30:31], 0
  v_mov_b64 v[32:33], 0
  v_mov_b64 v[34:35], 0
  buffer_load_dwordx4 v[0:3], v76, s[8:11], s60 offen offset:0 sc1
  buffer_load_dwordx4 v[4:7], v76, s[8:11], s60 offen offset:1024 sc1
  buffer_load_dwordx4 v[8:11], v76, s[8:11], s61 offen offset:0 sc1
  buffer_load_dwordx4 v[12:15], v76, s[8:11], s61 offen offset:1024 sc1
  v_mov_b64 v[20:21], 0
  v_mov_b64 v[22:23], 0
  v_mov_b64 v[24:25], 0
  v_mov_b64 v[26:27], 0
  v_mov_b32 v68, 14880
  s_cmp_eq_u32 s66, 62
  s_cselect_b64 s[16:17], s[20:21], s[16:17]
  s_cselect_b32 s18, (Cf3_done - Cf3_last), s18
  s_cselect_b32 s70, 0, s70
  s_cmp_eq_u32 s66, 63
  s_cselect_b32 s59, 268435456, s59
  s_cselect_b32 s58, 268435456, s58
  s_waitcnt lgkmcnt(0)
  s_waitcnt vmcnt(3)
  v_mfma_f32_16x16x32_bf16 v[56:59], v[52:55], v[0:3], 0
  v_bitop3_b32 v72, v0, v2, s72 bitop3:0x7e
  s_waitcnt vmcnt(2)
  v_mfma_f32_16x16x32_bf16 v[56:59], v[52:55], v[4:7], v[56:59]
  v_bitop3_b32 v73, v4, v6, s72 bitop3:0x7e
  v_or_b32 v72, v72, v73
  s_waitcnt vmcnt(1)
  v_mfma_f32_16x16x32_bf16 v[36:39], v[52:55], v[8:11], 0
  v_bitop3_b32 v73, v8, v10, s72 bitop3:0x7e
  v_or_b32 v72, v72, v73
  s_waitcnt vmcnt(0)
  v_mfma_f32_16x16x32_bf16 v[36:39], v[52:55], v[12:15], v[36:39]
  v_bitop3_b32 v73, v12, v14, s72 bitop3:0x7e
  v_bitop3_b32 v72, v72, v73, 1 bitop3:0xa8
  v_cmp_ne_u32 vcc, 0, v72
  s_cbranch_vccnz Cf3_h1r
  buffer_load_dwordx4 v[4:7], v76, s[8:11], s65 offen offset:1024 sc1
  v_add_f32_dpp v56, v56, v56 row_ror:4 row_mask:0xf bank_mask:0xf
  v_add_f32_dpp v57, v57, v57 row_ror:4 row_mask:0xf bank_mask:0xf
  v_add_f32_dpp v36, v36, v36 row_ror:4 row_mask:0xf bank_mask:0xf
  v_add_f32_dpp v37, v37, v37 row_ror:4 row_mask:0xf bank_mask:0xf
  v_add_f32_dpp v56, v56, v56 row_ror:8 row_mask:0xf bank_mask:0xf
  v_add_f32_dpp v57, v57, v57 row_ror:8 row_mask:0xf bank_mask:0xf
  v_add_f32_dpp v36, v36, v36 row_ror:8 row_mask:0xf bank_mask:0xf
  v_add_f32_dpp v37, v37, v37 row_ror:8 row_mask:0xf bank_mask:0xf
  v_cvt_pk_bf16_f32 v56, v56, v57
  buffer_store_dword v56, v69, s[8:11], s62 offen
  v_cvt_pk_bf16_f32 v36, v36, v37
  buffer_store_dword v36, v70, s[8:11], s63 offen
  s_xor_b32 s62, s62, 16384
  buffer_store_dword v71, v69, s[8:11], s62 offen
  s_xor_b32 s63, s63, 16384
  buffer_store_dword v71, v70, s[8:11], s63 offen
  s_xor_b32 s72, s72, 1
  s_branch Cf3_h2
Cf3_h1r:
  s_mov_b64 exec, vcc
  buffer_load_dwordx4 v[0:3], v76, s[8:11], s60 offen offset:0 sc1
  buffer_load_dwordx4 v[4:7], v76, s[8:11], s60 offen offset:1024 sc1
  buffer_load_dwordx4 v[8:11], v76, s[8:11], s61 offen offset:0 sc1
  buffer_load_dwordx4 v[12:15], v76, s[8:11], s61 offen offset:1024 sc1
  s_mov_b64 exec, -1
  s_add_u32 s67, s67, 1
  s_waitcnt vmcnt(3)
  v_mfma_f32_16x16x32_bf16 v[56:59], v[52:55], v[0:3], 0
  v_bitop3_b32 v72, v0, v2, s72 bitop3:0x7e
  s_waitcnt vmcnt(2)
  v_mfma_f32_16x16x32_bf16 v[56:59], v[52:55], v[4:7], v[56:59]
  v_bitop3_b32 v73, v4, v6, s72 bitop3:0x7e
  v_or_b32 v72, v72, v73
  s_waitcnt vmcnt(1)
  v_mfma_f32_16x16x32_bf16 v[36:39], v[52:55], v[8:11], 0
  v_bitop3_b32 v73, v8, v10, s72 bitop3:0x7e
  v_or_b32 v72, v72, v73
  s_waitcnt vmcnt(0)
  v_mfma_f32_16x16x32_bf16 v[36:39], v[52:55], v[12:15], v[36:39]
  v_bitop3_b32 v73, v12, v14, s72 bitop3:0x7e
  v_bitop3_b32 v72, v72, v73, 1 bitop3:0xa8
  v_cmp_ne_u32 vcc, 0, v72
  s_cbranch_vccz Cf3_h1p
Cf3_h1s:
  s_mov_b64 exec, vcc
  buffer_load_dwordx4 v[0:3], v76, s[8:11], s60 offen offset:0 sc1
  buffer_load_dwordx4 v[4:7], v76, s[8:11], s60 offen offset:1024 sc1
  buffer_load_dwordx4 v[8:11], v76, s[8:11], s61 offen offset:0 sc1
  buffer_load_dwordx4 v[12:15], v76, s[8:11], s61 offen offset:1024 sc1
  s_mov_b64 exec, -1
  s_add_u32 s67, s67, 1
  s_waitcnt vmcnt(3)
  v_mfma_f32_16x16x32_bf16 v[56:59], v[52:55], v[0:3], 0
  v_bitop3_b32 v72, v0, v2, s72 bitop3:0x7e
  s_waitcnt vmcnt(2)
  v_mfma_f32_16x16x32_bf16 v[56:59], v[52:55], v[4:7], v[56:59]
  v_bitop3_b32 v73, v4, v6, s72 bitop3:0x7e
  v_or_b32 v72, v72, v73
  s_waitcnt vmcnt(1)
  v_mfma_f32_16x16x32_bf16 v[36:39], v[52:55], v[8:11], 0
  v_bitop3_b32 v73, v8, v10, s72 bitop3:0x7e
  v_or_b32 v72, v72, v73
  s_waitcnt vmcnt(0)
  v_mfma_f32_16x16x32_bf16 v[36:39], v[52:55], v[12:15], v[36:39]
  v_bitop3_b32 v73, v12, v14, s72 bitop3:0x7e
  v_bitop3_b32 v72, v72, v73, 1 bitop3:0xa8
  v_cmp_ne_u32 vcc, 0, v72
  s_cbranch_vccz Cf3_h1p
  s_cmp_lt_u32 s67, 131072
  s_cbranch_scc1 Cf3_h1s
Cf3_h1p:
  s_nop 2
  buffer_load_dwordx4 v[4:7], v76, s[8:11], s65 offen offset:1024 sc1
  v_add_f32_dpp v56, v56, v56 row_ror:4 row_mask:0xf bank_mask:0xf
  v_add_f32_dpp v57, v57, v57 row_ror:4 row_mask:0xf bank_mask:0xf
  v_add_f32_dpp v36, v36, v36 row_ror:4 row_mask:0xf bank_mask:0xf
  v_add_f32_dpp v37, v37, v37 row_ror:4 row_mask:0xf bank_mask:0xf
  v_add_f32_dpp v56, v56, v56 row_ror:8 row_mask:0xf bank_mask:0xf
  v_add_f32_dpp v57, v57, v57 row_ror:8 row_mask:0xf bank_mask:0xf
  v_add_f32_dpp v36, v36, v36 row_ror:8 row_mask:0xf bank_mask:0xf
  v_add_f32_dpp v37, v37, v37 row_ror:8 row_mask:0xf bank_mask:0xf
  v_cvt_pk_bf16_f32 v56, v56, v57
  buffer_store_dword v56, v69, s[8:11], s62 offen
  v_cvt_pk_bf16_f32 v36, v36, v37
  buffer_store_dword v36, v70, s[8:11], s63 offen
  s_xor_b32 s62, s62, 16384
  buffer_store_dword v71, v69, s[8:11], s62 offen
  s_xor_b32 s63, s63, 16384
  buffer_store_dword v71, v70, s[8:11], s63 offen
  s_xor_b32 s72, s72, 1
  s_branch Cf3_h2
Cf3_h2r:
  s_mov_b64 exec, vcc
  buffer_load_dwordx4 v[4:7], v76, s[8:11], s65 offen offset:1024 sc1
  s_mov_b64 exec, -1
  s_add_u32 s67, s67, 1
  s_waitcnt vmcnt(3)
  v_max3_u32 v72, v4, v5, v6
  v_max_u32 v72, v72, v7
  ds_write_b128 v76, v[4:7] offset:5632
  v_cmp_eq_u32 vcc, -1, v72
  s_cbranch_vccz Cf3_h2w
Cf3_h2s:
  s_mov_b64 exec, vcc
  buffer_load_dwordx4 v[4:7], v76, s[8:11], s65 offen offset:1024 sc1
  s_mov_b64 exec, -1
  s_add_u32 s67, s67, 1
  s_waitcnt vmcnt(1)
  v_max3_u32 v72, v4, v5, v6
  v_max_u32 v72, v72, v7
  ds_write_b128 v76, v[4:7] offset:5632
  v_cmp_eq_u32 vcc, -1, v72
  s_cbranch_vccz Cf3_h2w
  s_mov_b64 exec, vcc
  buffer_load_dwordx4 v[4:7], v76, s[8:11], s65 offen offset:1024 sc1
  s_mov_b64 exec, -1
  s_add_u32 s67, s67, 1
  s_waitcnt vmcnt(1)
  v_max3_u32 v72, v4, v5, v6
  v_max_u32 v72, v72, v7
  ds_write_b128 v76, v[4:7] offset:5632
  v_cmp_eq_u32 vcc, -1, v72
  s_cbranch_vccz Cf3_h2w
  s_mov_b64 exec, vcc
  buffer_load_dwordx4 v[4:7], v76, s[8:11], s65 offen offset:1024 sc1
  s_mov_b64 exec, -1
  s_add_u32 s67, s67, 1
  s_waitcnt vmcnt(1)
  v_max3_u32 v72, v4, v5, v6
  v_max_u32 v72, v72, v7
  ds_write_b128 v76, v[4:7] offset:5632
  v_cmp_eq_u32 vcc, -1, v72
  s_cbranch_vccz Cf3_h2w
  s_cmp_lt_u32 s67, 131072
  s_cbranch_scc1 Cf3_h2s
  s_branch Cf3_h2w
Cf3_rec:
  s_nop 7
  s_waitcnt vmcnt(0) lgkmcnt(0)
  v_max3_u32 v72, v0, v1, v2
  v_max3_u32 v72, v72, v3, v4
  v_max3_u32 v72, v72, v5, v6
  v_max3_u32 v72, v72, v7, v8
  v_max3_u32 v72, v72, v9, v10
  v_max3_u32 v72, v72, v11, v12
  v_max3_u32 v72, v72, v13, v14
  v_max3_u32 v72, v72, v15, v16
  v_max3_u32 v72, v72, v17, v18
  v_max_u32 v72, v72, v19
  v_cmp_eq_u32 vcc, -1, v72
  s_cbranch_vccz Cf3_recok
  s_barrier
Cf3_recp:
  buffer_load_dwordx4 v[0:3], v76, s[8:11], s64 offen offset:0 sc1
  buffer_load_dwordx4 v[4:7], v76, s[8:11], s64 offen offset:1024 sc1
  buffer_load_dwordx4 v[8:11], v76, s[8:11], s64 offen offset:2048 sc1
  s_add_u32 s67, s67, 1
  s_cmp_lt_u32 s67, 131072
  s_cselect_b32 s54, -2, -1
  s_waitcnt vmcnt(2)
  v_max3_u32 v72, v0, v1, v2
  s_waitcnt vmcnt(1)
  v_max3_u32 v72, v72, v3, v4
  v_max3_u32 v72, v72, v5, v6
  s_waitcnt vmcnt(0)
  v_max3_u32 v72, v72, v7, v8
  v_max3_u32 v72, v72, v9, v10
  v_max_u32 v72, v72, v11
  v_cmp_lt_u32 vcc, s54, v72
  s_cbranch_vccnz Cf3_recp
  ds_write_b128 v76, v[0:3] offset:10752
  ds_write_b128 v76, v[4:7] offset:11776
  ds_write_b128 v76, v[8:11] offset:12800
  v_mov_b64 v[20:21], 0
  v_mov_b64 v[22:23], 0
  v_mov_b64 v[24:25], 0
  v_mov_b64 v[26:27], 0
  v_mov_b64 v[28:29], 0
  v_mov_b64 v[30:31], 0
  v_mov_b64 v[32:33], 0
  v_mov_b64 v[34:35], 0
  s_waitcnt lgkmcnt(0)
  s_barrier
  ds_read_b128 v[0:3], v76 offset:4608
  s_waitcnt lgkmcnt(0)
  v_smfmac_f32_16x16x64_bf16 v[20:23], v[0:3], v[80:87], v74
  v_smfmac_f32_16x16x64_bf16 v[24:27], v[0:3], v[88:95], v74
  ds_read_b128 v[60:63], v76 offset:28672
  ds_read_b128 v[64:67], v76 offset:29696
  s_waitcnt lgkmcnt(0)
  v_smfmac_f32_16x16x64_bf16 v[28:31], v[0:3], v[60:67], v74
  ds_read_b128 v[60:63], v76 offset:30720
  ds_read_b128 v[64:67], v76 offset:31744
  s_waitcnt lgkmcnt(0)
  v_smfmac_f32_16x16x64_bf16 v[32:35], v[0:3], v[60:67], v74
  ds_read_b128 v[4:7], v76 offset:5632
  s_waitcnt lgkmcnt(0)
  v_smfmac_f32_16x16x64_bf16 v[20:23], v[4:7], v[96:103], v74
  v_smfmac_f32_16x16x64_bf16 v[24:27], v[4:7], v[104:111], v74
  ds_read_b128 v[60:63], v76 offset:45056
  ds_read_b128 v[64:67], v76 offset:46080
  s_waitcnt lgkmcnt(0)
  v_smfmac_f32_16x16x64_bf16 v[28:31], v[4:7], v[60:67], v74
  ds_read_b128 v[60:63], v76 offset:47104
  ds_read_b128 v[64:67], v76 offset:48128
  s_waitcnt lgkmcnt(0)
  v_smfmac_f32_16x16x64_bf16 v[32:35], v[4:7], v[60:67], v74
  ds_read_b128 v[8:11], v76 offset:6656
  s_waitcnt lgkmcnt(0)
  v_smfmac_f32_16x16x64_bf16 v[20:23], v[8:11], v[112:119], v74
  v_smfmac_f32_16x16x64_bf16 v[24:27], v[8:11], v[120:127], v74
  v_smfmac_f32_16x16x64_bf16 v[28:31], v[8:11], v[208:215], v74
  v_smfmac_f32_16x16x64_bf16 v[32:35], v[8:11], v[216:223], v74
  ds_read_b128 v[12:15], v76 offset:7680
  s_waitcnt lgkmcnt(0)
  v_smfmac_f32_16x16x64_bf16 v[20:23], v[12:15], v[128:135], v74
  v_smfmac_f32_16x16x64_bf16 v[24:27], v[12:15], v[136:143], v74
  v_smfmac_f32_16x16x64_bf16 v[28:31], v[12:15], v[224:231], v74
  v_smfmac_f32_16x16x64_bf16 v[32:35], v[12:15], v[232:239], v74
  ds_read_b128 v[4:7], v76 offset:8704
  s_waitcnt lgkmcnt(0)
  v_smfmac_f32_16x16x64_bf16 v[20:23], v[4:7], v[144:151], v74
  v_smfmac_f32_16x16x64_bf16 v[24:27], v[4:7], v[152:159], v74
  ds_read_b128 v[60:63], v76 offset:61440
  ds_read_b128 v[64:67], v76 offset:62464
  s_waitcnt lgkmcnt(0)
  v_smfmac_f32_16x16x64_bf16 v[28:31], v[4:7], v[60:67], v74
  ds_read_b128 v[60:63], v76 offset:63488
  ds_read_b128 v[64:67], v76 offset:64512
  s_waitcnt lgkmcnt(0)
  v_smfmac_f32_16x16x64_bf16 v[32:35], v[4:7], v[60:67], v74
  ds_read_b128 v[8:11], v76 offset:9728
  s_waitcnt lgkmcnt(0)
  v_smfmac_f32_16x16x64_bf16 v[20:23], v[8:11], v[160:167], v74
  v_smfmac_f32_16x16x64_bf16 v[24:27], v[8:11], v[168:175], v74
  ds_read_b128 v[60:63], v75 offset:28672
  ds_read_b128 v[64:67], v75 offset:29696
  s_waitcnt lgkmcnt(0)
  v_smfmac_f32_16x16x64_bf16 v[28:31], v[8:11], v[60:67], v74
  ds_read_b128 v[60:63], v75 offset:30720
  ds_read_b128 v[64:67], v75 offset:31744
  s_waitcnt lgkmcnt(0)
  v_smfmac_f32_16x16x64_bf16 v[32:35], v[8:11], v[60:67], v74
  ds_read_b128 v[16:19], v76 offset:10752
  ds_read_b128 v[60:63], v75 offset:12288
  ds_read_b128 v[64:67], v75 offset:13312
  s_waitcnt lgkmcnt(0)
  v_smfmac_f32_16x16x64_bf16 v[20:23], v[16:19], v[60:67], v74
  ds_read_b128 v[60:63], v75 offset:14336
  ds_read_b128 v[64:67], v75 offset:15360
  s_waitcnt lgkmcnt(0)
  v_smfmac_f32_16x16x64_bf16 v[24:27], v[16:19], v[60:67], v74
  v_smfmac_f32_16x16x64_bf16 v[28:31], v[16:19], v[240:247], v74
  v_smfmac_f32_16x16x64_bf16 v[32:35], v[16:19], v[248:255], v74
  ds_read_b128 v[0:3], v76 offset:11776
  s_waitcnt lgkmcnt(0)
  v_smfmac_f32_16x16x64_bf16 v[20:23], v[0:3], v[176:183], v74
  v_smfmac_f32_16x16x64_bf16 v[24:27], v[0:3], v[184:191], v74
  v_smfmac_f32_16x16x64_bf16 v[28:31], v[0:3], a[0:7], v74
  v_smfmac_f32_16x16x64_bf16 v[32:35], v[0:3], a[8:15], v74
  ds_read_b128 v[12:15], v76 offset:12800
  s_waitcnt lgkmcnt(0)
  v_smfmac_f32_16x16x64_bf16 v[20:23], v[12:15], v[192:199], v74
  v_smfmac_f32_16x16x64_bf16 v[24:27], v[12:15], v[200:207], v74
  v_smfmac_f32_16x16x64_bf16 v[28:31], v[12:15], a[16:23], v74
  v_smfmac_f32_16x16x64_bf16 v[32:35], v[12:15], a[24:31], v74
  v_add_f32 v20, v20, v22
  v_add_f32 v21, v21, v23
  v_add_f32 v24, v24, v26
  v_cvt_pk_bf16_f32 v22, v20, v24
  ds_write_b32 v79, v22 offset:0
  v_add_f32 v25, v25, v27
  v_cvt_pk_bf16_f32 v23, v21, v25
  ds_write_b32 v79, v23 offset:576
  v_add_f32 v28, v28, v30
  v_add_f32 v29, v29, v31
  s_waitcnt lgkmcnt(0)
  s_nop 1
  s_branch Cf3_recok
Cf3_mx:
  s_waitcnt lgkmcnt(0)
  s_barrier
  buffer_load_dwordx4 v[52:55], v76, s[8:11], s59 offen offset:0 sc1
  buffer_load_dwordx4 v[0:3], v76, s[8:11], s58 offen offset:0 sc1
  ds_read_b128 v[20:23], v77 offset:0
  ds_read_b128 v[28:31], v77 offset:256
  buffer_load_dwordx4 v[56:59], v76, s[8:11], s59 offen offset:1024 sc1
  buffer_load_dwordx4 v[4:7], v76, s[8:11], s58 offen offset:1024 sc1
  ds_read_b128 v[24:27], v77 offset:128
  ds_read_b128 v[32:35], v77 offset:384
  s_waitcnt vmcnt(2) lgkmcnt(3)
  v_mfma_f32_16x16x32_bf16 v[8:11], v[0:3], v[20:23], 0
  s_waitcnt vmcnt(0) lgkmcnt(1)
  v_mfma_f32_16x16x32_bf16 v[8:11], v[4:7], v[24:27], v[8:11]
  v_mfma_f32_16x16x32_bf16 v[12:15], v[28:31], v[20:23], 0
  s_waitcnt lgkmcnt(0)
  v_mfma_f32_16x16x32_bf16 v[12:15], v[32:35], v[24:27], v[12:15]
  v_add_f32_dpp v8, v10, v8 quad_perm:[2,3,0,1] row_mask:0xf bank_mask:0xf
  v_add_f32_dpp v9, v11, v9 quad_perm:[2,3,0,1] row_mask:0xf bank_mask:0xf
  s_nop 0
  v_mov_b32_dpp v8, v8 quad_perm:[0,1,0,1] row_mask:0xf bank_mask:0xf
  v_mov_b32_dpp v9, v9 quad_perm:[0,1,0,1] row_mask:0xf bank_mask:0xf
  s_nop 1
  v_add_f32_dpp v12, v14, v12 quad_perm:[2,3,0,1] row_mask:0xf bank_mask:0xf
  v_add_f32_dpp v13, v15, v13 quad_perm:[2,3,0,1] row_mask:0xf bank_mask:0xf
  s_nop 0
  v_mov_b32_dpp v12, v12 quad_perm:[0,1,0,1] row_mask:0xf bank_mask:0xf
  v_mov_b32_dpp v13, v13 quad_perm:[0,1,0,1] row_mask:0xf bank_mask:0xf
  v_mul_f32 v12, s69, v12
  ds_write_b32 v78, v8 offset:8716
  v_mul_f32 v13, s69, v13
  ds_write_b32 v78, v9 offset:8780
  s_waitcnt lgkmcnt(0)
  s_barrier
  ds_read_b128 v[36:39], v78 offset:8704
  ds_read_b128 v[40:43], v78 offset:8768
  s_waitcnt lgkmcnt(0)
  s_barrier
  v_max_f32 v16, v36, v37
  v_max3_f32 v16, v16, v38, v39
  v_max3_f32 v16, v16, v40, v41
  v_max3_f32 v16, v16, v42, v43
  v_max3_f32 v16, v16, v12, v13
  v_mov_b32 v17, v16
  s_nop 1
  v_permlane16_swap_b32 v16, v17
  v_max_f32 v16, v16, v17
  v_mov_b32 v17, v16
  s_nop 1
  v_permlane32_swap_b32 v16, v17
  v_max_f32 v16, v16, v17
  v_sub_f32 v36, v36, v16
  v_sub_f32 v37, v37, v16
  v_sub_f32 v38, v38, v16
  v_sub_f32 v39, v39, v16
  v_sub_f32 v40, v40, v16
  v_sub_f32 v41, v41, v16
  v_sub_f32 v42, v42, v16
  v_sub_f32 v43, v43, v16
  v_sub_f32 v12, v12, v16
  v_sub_f32 v13, v13, v16
  v_exp_f32 v36, v36
  v_exp_f32 v37, v37
  v_exp_f32 v38, v38
  v_exp_f32 v39, v39
  v_exp_f32 v40, v40
  v_exp_f32 v41, v41
  v_exp_f32 v42, v42
  v_exp_f32 v43, v43
  v_exp_f32 v12, v12
  v_exp_f32 v13, v13
  v_cvt_pk_bf16_f32 v32, v36, v40
  v_cvt_pk_bf16_f32 v33, v37, v41
  v_cvt_pk_bf16_f32 v34, v38, v42
  v_cvt_pk_bf16_f32 v35, v39, v43
  v_cvt_pk_bf16_f32 v28, v12, v13
  v_cvt_pk_bf16_f32 v31, v12, v13
  v_mov_b32 v29, 0
  v_mov_b32 v30, 0
  v_mfma_f32_16x16x32_bf16 v[8:11], v[32:35], v[68:71], 0
  v_mfma_f32_16x16x32_bf16 v[0:3], v[32:35], v[52:55], 0
  v_mfma_f32_16x16x32_bf16 v[4:7], v[32:35], v[56:59], 0
  v_mfma_f32_16x16x16_bf16 v[8:11], v[28:29], v[68:69], v[8:11]
  v_mfma_f32_16x16x16_bf16 v[0:3], v[28:29], v[72:73], v[0:3]
  v_mfma_f32_16x16x16_bf16 v[4:7], v[30:31], v[72:73], v[4:7]
  ds_read_b128 v[52:55], v75 offset:30720
  v_rcp_f32 v10, v8
  v_rcp_f32 v11, v9
  v_mul_f32 v0, v10, v0
  v_mul_f32 v1, v11, v1
  v_max3_f32 v8, v8, v9, v10
  v_mul_f32 v4, v10, v4
  v_mul_f32 v5, v11, v5
  v_cvt_pk_bf16_f32 v2, v0, v4
  ds_write_b32 v79, v2 offset:8704
  v_cvt_pk_bf16_f32 v3, v1, v5
  ds_write_b32 v79, v3 offset:9280
  ds_read_b128 v[12:15], v78 offset:8896
  ds_read_b128 v[56:59], v75 offset:31744
  v_mov_b64 v[16:17], 0
  v_mov_b64 v[18:19], 0
  v_mov_b64 v[20:21], 0
  v_mov_b64 v[22:23], 0
  v_mov_b64 v[24:25], 0
  v_mov_b64 v[26:27], 0
  s_branch Cf3_mxok
Cf3_last:
  ds_read_b128 v[0:3], v76 offset:4608
  ds_read_b128 v[12:15], v76 offset:7680
  ds_read_b128 v[44:47], v76 offset:28672
  ds_read_b128 v[48:51], v76 offset:29696
  s_nop 5
  v_mov_b64 v[20:21], 0
  v_mov_b64 v[22:23], 0
  v_mov_b64 v[24:25], 0
  v_mov_b64 v[26:27], 0
  v_smfmac_f32_16x16x64_bf16 v[28:31], v[4:7], v[36:43], v74
  ds_read_b128 v[36:39], v76 offset:30720
  ds_read_b128 v[40:43], v76 offset:31744
  v_smfmac_f32_16x16x64_bf16 v[32:35], v[4:7], v[60:67], v74
  s_waitcnt lgkmcnt(5)
  v_smfmac_f32_16x16x64_bf16 v[20:23], v[0:3], a[32:39], v74
  ds_read_b128 v[60:63], v76 offset:61440
  ds_read_b128 v[64:67], v76 offset:62464
  v_smfmac_f32_16x16x64_bf16 v[24:27], v[0:3], a[40:47], v74
  s_waitcnt lgkmcnt(4)
  v_smfmac_f32_16x16x64_bf16 v[20:23], v[4:7], a[48:55], v74
  buffer_store_dwordx4 v[16:19], v76, s[8:11], s68 offen sc1
  v_smfmac_f32_16x16x64_bf16 v[24:27], v[4:7], a[56:63], v74
  v_smfmac_f32_16x16x64_bf16 v[28:31], v[0:3], v[44:51], v74
  s_waitcnt lgkmcnt(2)
  v_smfmac_f32_16x16x64_bf16 v[20:23], v[8:11], a[64:71], v74
  ds_read_b128 v[44:47], v76 offset:63488
  ds_read_b128 v[48:51], v76 offset:64512
  v_smfmac_f32_16x16x64_bf16 v[24:27], v[8:11], a[72:79], v74
  v_smfmac_f32_16x16x64_bf16 v[32:35], v[0:3], v[36:43], v74
  v_smfmac_f32_16x16x64_bf16 v[28:31], v[8:11], v[208:215], v74
  ds_read_b128 v[36:39], v75 offset:28672
  ds_read_b128 v[40:43], v75 offset:29696
  v_smfmac_f32_16x16x64_bf16 v[32:35], v[8:11], v[216:223], v74
  v_smfmac_f32_16x16x64_bf16 v[20:23], v[12:15], a[80:87], v74
  v_smfmac_f32_16x16x64_bf16 v[24:27], v[12:15], a[88:95], v74
  v_smfmac_f32_16x16x64_bf16 v[28:31], v[12:15], v[224:231], v74
  v_smfmac_f32_16x16x64_bf16 v[32:35], v[12:15], v[232:239], v74
  s_waitcnt vmcnt(1)
  s_barrier
Cf3_lastr:
  ds_read_b128 v[4:7], v76 offset:8704
  ds_read_b128 v[8:11], v76 offset:9728
  ds_read_b128 v[16:19], v76 offset:10752
  ds_read_b128 v[0:3], v76 offset:11776
  ds_read_b128 v[12:15], v76 offset:12800
  s_waitcnt lgkmcnt(1)
  v_max3_u32 v72, v0, v1, v2
  v_max3_u32 v72, v72, v3, v4
  v_max3_u32 v72, v72, v5, v6
  v_max3_u32 v72, v72, v7, v8
  v_max3_u32 v72, v72, v9, v10
  s_waitcnt lgkmcnt(0)
  v_max3_u32 v72, v72, v11, v12
  v_max3_u32 v72, v72, v13, v14
  v_max3_u32 v72, v72, v15, v16
  v_max3_u32 v72, v72, v17, v18
  v_max_u32 v72, v72, v19
  v_cmp_eq_u32 vcc, -1, v72
  s_cbranch_vccnz Cf3_lastp
Cf3_lastg:
  v_smfmac_f32_16x16x64_bf16 v[28:31], v[4:7], v[60:67], v74
  ds_read_b128 v[60:63], v75 offset:30720
  ds_read_b128 v[64:67], v75 offset:31744
  v_smfmac_f32_16x16x64_bf16 v[32:35], v[4:7], v[44:51], v74
  v_smfmac_f32_16x16x64_bf16 v[28:31], v[8:11], v[36:43], v74
  v_smfmac_f32_16x16x64_bf16 v[28:31], v[16:19], v[240:247], v74
  v_smfmac_f32_16x16x64_bf16 v[28:31], v[0:3], a[0:7], v74
  v_smfmac_f32_16x16x64_bf16 v[28:31], v[12:15], a[16:23], v74
  v_smfmac_f32_16x16x64_bf16 v[32:35], v[16:19], v[248:255], v74
  v_smfmac_f32_16x16x64_bf16 v[32:35], v[0:3], a[8:15], v74
  s_waitcnt lgkmcnt(0)
  v_smfmac_f32_16x16x64_bf16 v[32:35], v[12:15], a[24:31], v74
  v_smfmac_f32_16x16x64_bf16 v[32:35], v[8:11], v[60:67], v74
  v_smfmac_f32_16x16x64_bf16 v[20:23], v[4:7], a[96:103], v74
  v_smfmac_f32_16x16x64_bf16 v[20:23], v[8:11], a[112:119], v74
  v_add_f32 v28, v28, v30
  v_add_f32 v32, v32, v34
  v_cvt_pk_bf16_f32 v30, v28, v32
  v_smfmac_f32_16x16x64_bf16 v[20:23], v[16:19], a[128:135], v74
  ds_write_b32 v79, v30 offset:256
  v_add_f32 v29, v29, v31
  v_add_f32 v33, v33, v35
  v_cvt_pk_bf16_f32 v31, v29, v33
  v_smfmac_f32_16x16x64_bf16 v[20:23], v[0:3], a[144:151], v74
  ds_write_b32 v79, v31 offset:832
  v_smfmac_f32_16x16x64_bf16 v[20:23], v[12:15], a[160:167], v74
  v_smfmac_f32_16x16x64_bf16 v[24:27], v[4:7], a[104:111], v74
  v_smfmac_f32_16x16x64_bf16 v[24:27], v[8:11], a[120:127], v74
  v_smfmac_f32_16x16x64_bf16 v[24:27], v[16:19], a[136:143], v74
  s_waitcnt lgkmcnt(0)
  s_barrier
  ds_read_b64 v[52:53], v77 offset:392
  v_add_f32 v20, v20, v22
  v_smfmac_f32_16x16x64_bf16 v[24:27], v[0:3], a[152:159], v74
  v_add_f32 v21, v21, v23
  v_smfmac_f32_16x16x64_bf16 v[24:27], v[12:15], a[168:175], v74
  v_cvt_pk_bf16_f32 v54, v20, v21
  s_add_u32 s68, s68, 655360
  s_nop 3
  v_add_f32 v24, v24, v26
  v_add_f32 v25, v25, v27
  v_cvt_pk_bf16_f32 v55, v24, v25
  s_waitcnt lgkmcnt(0)
  buffer_store_dwordx4 v[52:55], v76, s[8:11], s68 offen sc1
  s_branch Cf3_done
Cf3_lastp:
  s_add_u32 s72, s72, 2
  s_cmp_ge_u32 s72, 131072
  s_cbranch_scc1 Cf3_lastg
  s_barrier
  buffer_load_dwordx4 v76, s[8:11], s85 offen offset:0 sc1 lds
  buffer_load_dwordx4 v76, s[8:11], s85 offen offset:1024 sc1 lds
  s_waitcnt vmcnt(0)
  s_barrier
  s_branch Cf3_lastr
Cf3_done:
  s_branch L_cexit
L_w4:
  v_mov_b64 v[20:21], 0
  v_mov_b64 v[22:23], 0
  v_mov_b64 v[24:25], 0
  v_mov_b64 v[26:27], 0
  v_mov_b64 v[28:29], 0
  v_mov_b64 v[30:31], 0
  v_mov_b64 v[32:33], 0
  v_mov_b64 v[34:35], 0
  s_mov_b32 s78, 0x3f803f80
  s_mov_b32 s79, s78
  s_mov_b32 s65, 360448
  s_mov_b32 m0, 16128
  s_lshl_b32 s71, s53, 2
  s_add_u32 s71, s71, 128
  s_movk_i32 s56, 0x1000
  v_lshlrev_b32 v73, 2, v76
  v_mov_b32 v72, 0
  s_mov_b64 s[16:17], s[8:9]
  s_mov_b32 s18, 268435456
  s_mov_b32 s19, 0x20000
  s_getpc_b64 s[20:21]
Cs0_pc:
  s_add_u32 s20, s20, (Cs0_last - Cs0_pc)
  s_addc_u32 s21, s21, 0
  v_mov_b32 v68, 14880
  buffer_load_dwordx4 v[52:55], v76, s[8:11], s59 offen offset:0 sc1
  buffer_load_dwordx4 v[56:59], v76, s[8:11], s59 offen offset:1024 sc1
  ds_read_b128 v[36:39], v76 offset:16384
  ds_read_b128 v[40:43], v76 offset:17408
  ds_read_b128 v[60:63], v76 offset:18432
  ds_read_b128 v[64:67], v76 offset:19456
  ds_read_b128 v[0:3], v76 offset:4608
  ds_read_b128 v[4:7], v76 offset:5632
  ds_read_b128 v[8:11], v76 offset:6656
  ds_read_b128 v[12:15], v76 offset:7680
  s_waitcnt lgkmcnt(0)
  s_cmp_eq_u32 s66, 1
  s_branch Cs0_top2
.p2align 6
Cs0_h2:
  ds_read_b128 v[36:39], v76 offset:16384
  v_mov_b64 v[20:21], 0
  v_mov_b64 v[22:23], 0
  v_mov_b64 v[24:25], 0
  v_mov_b64 v[26:27], 0
  v_mov_b32 v68, 14880
  ds_read_b128 v[40:43], v76 offset:17408
  s_cmp_eq_u32 s66, 62
  s_cselect_b64 s[16:17], s[20:21], s[16:17]
  s_cselect_b32 s18, (Cs0_done - Cs0_last), s18
  s_cselect_b32 s70, 0, s70
  s_cmp_eq_u32 s66, 63
  s_cselect_b32 s59, 268435456, s59
  s_cselect_b32 s58, 268435456, s58
  ds_read_b128 v[60:63], v76 offset:18432
  v_lshlrev_b32 v73, 2, v76
  s_cmp_eq_u32 s66, 12
  s_cselect_b32 s56, s71, 0x1000
  ds_read_b32 v72, v76 offset:16128
  s_cmp_eq_u32 s66, 13
  s_cselect_b32 s54, 0x700, 0
  s_waitcnt lgkmcnt(0)
  v_readfirstlane_b32 s57, v72
  s_nop 0
  s_cmp_lt_u32 s57, s54
  s_cbranch_scc1 Cs0_kv3
Cs0_kvb:
  buffer_load_dwordx4 v[52:55], v76, s[8:11], s59 offen offset:0 sc1
  buffer_load_dwordx4 v[56:59], v76, s[8:11], s59 offen offset:1024 sc1
  s_waitcnt vmcnt(0)
  s_mov_b64 vcc, -1
Cs0_h2r:
  s_mov_b64 exec, vcc
  buffer_load_dwordx4 v[0:3], v76, s[8:11], s65 offen offset:0 sc1
  buffer_load_dwordx4 v[4:7], v76, s[8:11], s85 offen offset:0 sc1
  s_mov_b64 exec, -1
  s_add_u32 s67, s67, 1
  s_cmp_lt_u32 s67, 131072
  s_cselect_b32 s54, -2, -1
  s_waitcnt vmcnt(1)
  v_max3_u32 v72, v0, v1, v2
  s_waitcnt vmcnt(0)
  v_max3_u32 v72, v72, v3, v4
  v_max3_u32 v72, v72, v5, v6
  v_max_u32 v72, v72, v7
  v_cmp_lt_u32 vcc, s54, v72
  s_cbranch_vccnz Cs0_h2r
  ds_write_b128 v76, v[0:3] offset:4608
  ds_write_b128 v76, v[4:7] offset:10752
Cs0_h2w:
  s_cmp_eq_u32 s66, 63
  s_waitcnt lgkmcnt(0)
  s_barrier
  ds_read_b128 v[8:11], v76 offset:6656
Cs0_top2:
  v_smfmac_f32_16x16x64_bf16 v[20:23], v[0:3], v[80:87], v74
  s_cbranch_scc1 Cs0_last
  v_smfmac_f32_16x16x64_bf16 v[28:31], v[0:3], v[36:43], v74
  buffer_load_dwordx4 v[44:47], v76, s[8:11], s58 offen offset:0 sc1
  s_mov_b32 m0, 16128
  v_smfmac_f32_16x16x64_bf16 v[24:27], v[0:3], v[88:95], v74
  buffer_load_dwordx4 v[48:51], v76, s[8:11], s58 offen offset:1024 sc1
  v_smfmac_f32_16x16x64_bf16 v[32:35], v[0:3], v[60:67], v74
  ds_read_b128 v[4:7], v76 offset:5632
  s_waitcnt lgkmcnt(1)
  v_smfmac_f32_16x16x64_bf16 v[20:23], v[8:11], v[112:119], v74
  ds_read_b128 v[12:15], v76 offset:7680
  v_smfmac_f32_16x16x64_bf16 v[24:27], v[8:11], v[120:127], v74
  ds_read_b128 v[36:39], v76 offset:32768
  v_smfmac_f32_16x16x64_bf16 v[28:31], v[8:11], v[208:215], v74
  buffer_store_dwordx4 v[16:19], v76, s[8:11], s68 offen sc1
  ds_read_b128 v[40:43], v76 offset:33792
  v_smfmac_f32_16x16x64_bf16 v[32:35], v[8:11], v[216:223], v74
  buffer_load_dword v73, s[16:19], s70 offen lds
  ds_read_b128 v[60:63], v76 offset:34816
  s_waitcnt lgkmcnt(4)
  v_smfmac_f32_16x16x64_bf16 v[20:23], v[4:7], v[96:103], v74
  ds_read_b128 v[64:67], v76 offset:35840
  v_smfmac_f32_16x16x64_bf16 v[24:27], v[4:7], v[104:111], v74
  s_waitcnt vmcnt(4)
  s_waitcnt lgkmcnt(4)
  v_smfmac_f32_16x16x64_bf16 v[20:23], v[12:15], v[128:135], v74
  s_barrier
  ds_read_b128 v[0:3], v76 offset:8704
  s_waitcnt lgkmcnt(3)
  v_smfmac_f32_16x16x64_bf16 v[28:31], v[4:7], v[36:43], v74
  ds_read_b128 v[36:39], v76 offset:49152
  v_smfmac_f32_16x16x64_bf16 v[24:27], v[12:15], v[136:143], v74
  ds_read_b128 v[40:43], v76 offset:50176
  s_waitcnt lgkmcnt(3)
  v_smfmac_f32_16x16x64_bf16 v[32:35], v[4:7], v[60:67], v74
  ds_read_b128 v[8:11], v76 offset:9728
  v_smfmac_f32_16x16x64_bf16 v[28:31], v[12:15], v[224:231], v74
  ds_read_b128 v[60:63], v76 offset:51200
  v_smfmac_f32_16x16x64_bf16 v[32:35], v[12:15], v[232:239], v74
  ds_read_b128 v[64:67], v76 offset:52224
  s_waitcnt lgkmcnt(5)
  v_smfmac_f32_16x16x64_bf16 v[20:23], v[0:3], v[144:151], v74
  s_barrier
  ds_read_b128 v[4:7], v76 offset:11776
  s_waitcnt lgkmcnt(4)
  v_smfmac_f32_16x16x64_bf16 v[28:31], v[0:3], v[36:43], v74
  ds_read_b128 v[12:15], v76 offset:12800
  ds_read_b128 v[36:39], v75 offset:0
  v_smfmac_f32_16x16x64_bf16 v[24:27], v[0:3], v[152:159], v74
  ds_read_b128 v[16:19], v76 offset:10752
  s_waitcnt lgkmcnt(6)
  v_smfmac_f32_16x16x64_bf16 v[20:23], v[8:11], v[160:167], v74
  ds_read_b128 v[40:43], v75 offset:1024
  s_waitcnt lgkmcnt(5)
  v_smfmac_f32_16x16x64_bf16 v[32:35], v[0:3], v[60:67], v74
  ds_read_b128 v[60:63], v75 offset:2048
  v_smfmac_f32_16x16x64_bf16 v[24:27], v[8:11], v[168:175], v74
  ds_read_b128 v[64:67], v75 offset:3072
  s_waitcnt lgkmcnt(6)
  v_smfmac_f32_16x16x64_bf16 v[20:23], v[4:7], v[176:183], v74
  buffer_load_dword off, s[12:15], s56 sc1 lds
  s_waitcnt lgkmcnt(5)
  v_smfmac_f32_16x16x64_bf16 v[20:23], v[12:15], v[192:199], v74
  s_waitcnt lgkmcnt(2)
  v_smfmac_f32_16x16x64_bf16 v[20:23], v[16:19], v[36:43], v74
  ds_read_b128 v[36:39], v75 offset:16384
  v_smfmac_f32_16x16x64_bf16 v[24:27], v[4:7], v[184:191], v74
  ds_read_b128 v[40:43], v75 offset:17408
  s_waitcnt lgkmcnt(2)
  v_smfmac_f32_16x16x64_bf16 v[24:27], v[16:19], v[60:67], v74
  ds_read_b128 v[60:63], v75 offset:18432
  v_add_f32 v20, v20, v22
  v_smfmac_f32_16x16x64_bf16 v[24:27], v[12:15], v[200:207], v74
  ds_read_b128 v[64:67], v75 offset:19456
  v_add_f32 v21, v21, v23
  v_smfmac_f32_16x16x64_bf16 v[28:31], v[16:19], v[240:247], v74
  v_mov_b64 v[70:71], s[78:79]
  v_smfmac_f32_16x16x64_bf16 v[28:31], v[4:7], a[0:7], v74
  s_waitcnt lgkmcnt(2)
  v_add_f32 v24, v24, v26
  v_smfmac_f32_16x16x64_bf16 v[28:31], v[8:11], v[36:43], v74
  ds_read_b128 v[36:39], v68
  v_cvt_pk_bf16_f32 v22, v20, v24
  v_smfmac_f32_16x16x64_bf16 v[28:31], v[12:15], a[16:23], v74
  ds_read_b128 v[40:43], v68
  ds_write_b32 v79, v22 offset:0
  s_waitcnt lgkmcnt(3)
  v_add_f32 v25, v25, v27
  v_cvt_pk_bf16_f32 v23, v21, v25
  v_smfmac_f32_16x16x64_bf16 v[32:35], v[8:11], v[60:67], v74
  ds_write_b32 v79, v23 offset:576
  v_cmp_u_f32 vcc, v20, v21
  v_smfmac_f32_16x16x64_bf16 v[32:35], v[16:19], v[248:255], v74
  v_add_f32 v28, v28, v30
  v_smfmac_f32_16x16x64_bf16 v[32:35], v[4:7], a[8:15], v74
  v_add_f32 v29, v29, v31
  v_smfmac_f32_16x16x64_bf16 v[32:35], v[12:15], a[24:31], v74
  s_cbranch_vccnz Cs0_rec
Cs0_recok:
  s_waitcnt lgkmcnt(3)
  v_smfmac_f32_16x16x64_bf16 v[36:39], v[16:19], a[128:135], v74
  s_waitcnt lgkmcnt(0)
  s_barrier
  ds_read_b128 v[60:63], v77
  v_smfmac_f32_16x16x64_bf16 v[40:43], v[16:19], a[136:143], v74
  ds_read_b128 v[64:67], v77 offset:128
  v_add_f32 v32, v32, v34
  v_cvt_pk_bf16_f32 v30, v28, v32
  v_smfmac_f32_16x16x64_bf16 v[36:39], v[0:3], a[96:103], v74
  ds_write_b32 v79, v30 offset:256
  v_add_f32 v33, v33, v35
  v_cvt_pk_bf16_f32 v31, v29, v33
  v_smfmac_f32_16x16x64_bf16 v[40:43], v[0:3], a[104:111], v74
  ds_write_b32 v79, v31 offset:832
  v_xor_b32 v75, 0x8000, v75
  v_smfmac_f32_16x16x64_bf16 v[36:39], v[4:7], a[144:151], v74
  ds_read_b128 v[0:3], v76 offset:4608
  v_mov_b32 v29, 0
  v_smfmac_f32_16x16x64_bf16 v[40:43], v[4:7], a[152:159], v74
  s_waitcnt vmcnt(3) lgkmcnt(3)
  v_mov_b32 v30, 0
  v_mfma_f32_16x16x32_bf16 v[44:47], v[44:47], v[60:63], 0
  ds_read_b128 v[4:7], v76 offset:5632
  s_waitcnt lgkmcnt(2)
  v_mfma_f32_16x16x32_bf16 v[44:47], v[48:51], v[64:67], v[44:47]
  s_barrier
  v_smfmac_f32_16x16x64_bf16 v[36:39], v[8:11], a[112:119], v74
  ds_read_b128 v[20:23], v77 offset:256
  ds_read_b128 v[24:27], v77 offset:384
  v_smfmac_f32_16x16x64_bf16 v[40:43], v[8:11], a[120:127], v74
  ds_read_b128 v[8:11], v76 offset:6656
  v_add_f32_dpp v72, v46, v44 quad_perm:[2,3,0,1] row_mask:0xf bank_mask:0xf
  v_add_f32_dpp v73, v47, v45 quad_perm:[2,3,0,1] row_mask:0xf bank_mask:0xf
  v_smfmac_f32_16x16x64_bf16 v[36:39], v[12:15], a[160:167], v74
  s_waitcnt lgkmcnt(4)
  v_exp_f32_dpp v72, v72 quad_perm:[0,1,0,1] row_mask:0xf bank_mask:0xf
  v_smfmac_f32_16x16x64_bf16 v[40:43], v[12:15], a[168:175], v74
  ds_read_b128 v[12:15], v76 offset:7680
  v_exp_f32_dpp v73, v73 quad_perm:[0,1,0,1] row_mask:0xf bank_mask:0xf
  v_smfmac_f32_16x16x64_bf16 v[36:39], v[0:3], a[32:39], v74
  s_waitcnt lgkmcnt(2)
  v_cvt_pk_bf16_f32 v72, v72, v73
  v_mfma_f32_16x16x32_bf16 v[20:23], v[20:23], v[60:63], 0
  ds_write_b32 v78, v72 offset:512
  v_mov_b64 v[16:17], 0
  v_mfma_f32_16x16x32_bf16 v[20:23], v[24:27], v[64:67], v[20:23]
  ds_read_b128 v[44:47], v75 offset:16384
  v_mov_b64 v[18:19], 0
  v_smfmac_f32_16x16x64_bf16 v[40:43], v[0:3], a[40:47], v74
  ds_read_b128 v[48:51], v75 offset:17408
  v_mov_b64 v[68:69], s[78:79]
  v_smfmac_f32_16x16x64_bf16 v[36:39], v[4:7], a[48:55], v74
  s_waitcnt lgkmcnt(4)
  v_add_f32_dpp v24, v22, v20 quad_perm:[2,3,0,1] row_mask:0xf bank_mask:0xf
  v_add_f32_dpp v25, v23, v21 quad_perm:[2,3,0,1] row_mask:0xf bank_mask:0xf
  v_smfmac_f32_16x16x64_bf16 v[36:39], v[8:11], a[64:71], v74
  s_waitcnt lgkmcnt(2)
  s_barrier
  ds_read_b128 v[32:35], v78 offset:512
  v_smfmac_f32_16x16x64_bf16 v[36:39], v[12:15], a[80:87], v74
  ds_read_b128 v[60:63], v75 offset:18432
  v_mul_f32 v24, s69, v24
  v_smfmac_f32_16x16x64_bf16 v[40:43], v[4:7], a[56:63], v74
  ds_read_b128 v[64:67], v75 offset:19456
  v_mul_f32 v25, s69, v25
  v_smfmac_f32_16x16x64_bf16 v[40:43], v[8:11], a[72:79], v74
  v_exp_f32_dpp v24, v24 quad_perm:[0,1,0,1] row_mask:0xf bank_mask:0xf
  v_smfmac_f32_16x16x64_bf16 v[40:43], v[12:15], a[88:95], v74
  s_waitcnt lgkmcnt(2)
  v_exp_f32_dpp v25, v25 quad_perm:[0,1,0,1] row_mask:0xf bank_mask:0xf
  v_mfma_f32_16x16x32_bf16 v[8:11], v[32:35], v[68:71], 0
  v_add_f32 v36, v36, v38
  v_add_f32 v37, v37, v39
  v_mfma_f32_16x16x32_bf16 v[0:3], v[32:35], v[52:55], 0
  v_add_f32 v40, v40, v42
  v_add_f32 v41, v41, v43
  v_mfma_f32_16x16x32_bf16 v[4:7], v[32:35], v[56:59], 0
  v_cvt_pk_bf16_f32 v28, v24, v25
  v_cvt_pk_bf16_f32 v72, v36, v37
  v_cvt_pk_bf16_f32 v73, v40, v41
  v_mfma_f32_16x16x16_bf16 v[8:11], v[28:29], v[68:69], v[8:11]
  v_cvt_pk_bf16_f32 v31, v24, v25
  v_mov_b64 v[20:21], 0
  v_mfma_f32_16x16x16_bf16 v[0:3], v[28:29], v[72:73], v[0:3]
  ds_read_b128 v[52:55], v75 offset:32768
  v_mov_b64 v[22:23], 0
  v_mfma_f32_16x16x16_bf16 v[4:7], v[30:31], v[72:73], v[4:7]
  v_rcp_f32 v10, v8
  v_rcp_f32 v11, v9
  v_mul_f32 v0, v10, v0
  v_mul_f32 v1, v11, v1
  v_max3_f32 v8, v8, v9, v10
  v_mul_f32 v4, v10, v4
  v_mul_f32 v5, v11, v5
  v_cvt_pk_bf16_f32 v2, v0, v4
  ds_write_b32 v79, v2 offset:8704
  v_cvt_pk_bf16_f32 v3, v1, v5
  ds_write_b32 v79, v3 offset:9280
  ds_read_b128 v[12:15], v78 offset:8704
  v_max_f32 v8, v8, v11
  v_cmp_le_f32 vcc, 1317011456, v8
  v_mov_b64 v[24:25], 0
  v_mov_b64 v[26:27], 0
  ds_read_b128 v[56:59], v75 offset:33792
  s_cbranch_vccnz Cs0_mx
Cs0_mxok:
  s_waitcnt lgkmcnt(2)
  s_barrier
  ds_read_b128 v[0:3], v78 offset:8768
  s_waitcnt lgkmcnt(2)
  v_smfmac_f32_16x16x64_bf16 v[16:19], v[12:15], v[44:51], v74
  ds_read_b128 v[4:7], v78 offset:8832
  v_smfmac_f32_16x16x64_bf16 v[20:23], v[12:15], a[192:199], v74
  ds_read_b128 v[8:11], v78 offset:8896
  v_smfmac_f32_16x16x64_bf16 v[24:27], v[12:15], a[208:215], v74
  ds_read_b128 v[36:39], v75 offset:34816
  s_waitcnt lgkmcnt(3)
  v_smfmac_f32_16x16x64_bf16 v[16:19], v[0:3], v[60:67], v74
  ds_read_b128 v[40:43], v75 offset:35840
  s_waitcnt lgkmcnt(3)
  v_smfmac_f32_16x16x64_bf16 v[16:19], v[4:7], a[176:183], v74
  ds_read_b128 v[68:71], v76 offset:13824
  s_waitcnt lgkmcnt(3)
  v_smfmac_f32_16x16x64_bf16 v[16:19], v[8:11], a[184:191], v74
  ds_read_b128 v[44:47], v75 offset:49152
  v_smfmac_f32_16x16x64_bf16 v[20:23], v[0:3], a[200:207], v74
  ds_read_b128 v[48:51], v75 offset:50176
  v_smfmac_f32_16x16x64_bf16 v[20:23], v[4:7], v[52:59], v74
  ds_read_b128 v[60:63], v75 offset:51200
  s_waitcnt lgkmcnt(4)
  v_cvt_pk_bf16_f32 v16, v16, v17
  v_cvt_pk_bf16_f32 v17, v18, v19
  v_bfi_b32 v16, 1, s72, v16
  v_smfmac_f32_16x16x64_bf16 v[20:23], v[8:11], v[36:43], v74
  s_waitcnt lgkmcnt(3)
  buffer_store_dwordx2 v[16:17], v68, s[8:11], s73 offen sc1
  v_mov_b64 v[32:33], 0
  v_smfmac_f32_16x16x64_bf16 v[24:27], v[0:3], a[216:223], v74
  ds_read_b128 v[64:67], v75 offset:52224
  v_mov_b64 v[34:35], 0
  v_smfmac_f32_16x16x64_bf16 v[24:27], v[4:7], a[224:231], v74
  v_cvt_pk_bf16_f32 v20, v20, v21
  v_cvt_pk_bf16_f32 v21, v22, v23
  v_bfi_b32 v20, 1, s72, v20
  v_smfmac_f32_16x16x64_bf16 v[24:27], v[8:11], a[232:239], v74
  buffer_store_dwordx2 v[20:21], v68, s[8:11], s74 offen sc1
  s_waitcnt lgkmcnt(2)
  v_smfmac_f32_16x16x64_bf16 v[32:35], v[12:15], v[44:51], v74
  s_waitcnt lgkmcnt(0)
  v_smfmac_f32_16x16x64_bf16 v[32:35], v[0:3], v[60:67], v74
  v_cvt_pk_bf16_f32 v24, v24, v25
  v_cvt_pk_bf16_f32 v25, v26, v27
  v_bfi_b32 v24, 1, s72, v24
  v_smfmac_f32_16x16x64_bf16 v[32:35], v[4:7], a[240:247], v74
  buffer_store_dwordx2 v[24:25], v68, s[8:11], s75 offen sc1
  v_smfmac_f32_16x16x64_bf16 v[32:35], v[8:11], a[248:255], v74
  v_mov_b64 v[18:19], v[72:73]
  s_nop 4
  v_cvt_pk_bf16_f32 v32, v32, v33
  v_cvt_pk_bf16_f32 v33, v34, v35
  v_bfi_b32 v32, 1, s72, v32
  buffer_store_dwordx2 v[32:33], v68, s[8:11], s76 offen sc1
  ds_read_b128 v[0:3], v76 offset:14848
  s_waitcnt lgkmcnt(0)
  ds_read_b64 v[16:17], v77 offset:256
  s_waitcnt lgkmcnt(0)
  ds_read_b128 v[64:67], v76 offset:19456
  s_waitcnt lgkmcnt(0)
  v_xor_b32 v75, 0x8000, v75
  v_mov_b64 v[28:29], 0
  v_mov_b64 v[30:31], 0
  v_mov_b64 v[32:33], 0
  v_mov_b64 v[34:35], 0
  s_waitcnt vmcnt(0)
  buffer_load_dwordx4 v[52:55], v76, s[8:11], s60 offen offset:0 sc1
  buffer_load_dwordx4 v[56:59], v76, s[8:11], s60 offen offset:1024 sc1
  s_add_u32 s66, s66, 1
  s_xor_b32 s64, s64, 16384
  s_xor_b32 s65, s65, 16384
  s_add_u32 s58, s58, 655360
  s_add_u32 s59, s59, 655360
  s_add_u32 s70, s70, 655360
  s_add_u32 s68, s68, 655360
  s_mov_b32 m0, 10752
  s_add_u32 s85, s65, 6144
  s_waitcnt lgkmcnt(0)
  s_waitcnt vmcnt(1)
  v_mfma_f32_16x16x32_bf16 v[4:7], v[0:3], v[52:55], 0
  v_bitop3_b32 v72, v52, v54, s72 bitop3:0x7e
  s_waitcnt vmcnt(0)
  v_mfma_f32_16x16x32_bf16 v[4:7], v[0:3], v[56:59], v[4:7]
  v_bitop3_b32 v73, v56, v58, s72 bitop3:0x7e
  v_bitop3_b32 v72, v72, v73, 1 bitop3:0xa8
  v_cmp_ne_u32 vcc, 0, v72
  s_cbranch_vccnz Cs0_h1r
  s_nop 2
  v_add_f32_dpp v4, v4, v4 row_ror:4 row_mask:0xf bank_mask:0xf
  v_add_f32_dpp v5, v5, v5 row_ror:4 row_mask:0xf bank_mask:0xf
  s_nop 0
  v_add_f32_dpp v4, v4, v4 row_ror:8 row_mask:0xf bank_mask:0xf
  v_add_f32_dpp v5, v5, v5 row_ror:8 row_mask:0xf bank_mask:0xf
  v_cvt_pk_bf16_f32 v4, v4, v5
  buffer_store_dword v4, v69, s[8:11], s62 offen sc1
  s_xor_b32 s62, s62, 16384
  buffer_store_dword v71, v69, s[8:11], s62 offen sc1
  s_xor_b32 s72, s72, 1
  s_branch Cs0_h2
Cs0_h1r:
  s_mov_b64 exec, vcc
  buffer_load_dwordx4 v[52:55], v76, s[8:11], s60 offen offset:0 sc1
  buffer_load_dwordx4 v[56:59], v76, s[8:11], s60 offen offset:1024 sc1
  s_mov_b64 exec, -1
  s_add_u32 s67, s67, 1
  s_waitcnt vmcnt(1)
  v_mfma_f32_16x16x32_bf16 v[4:7], v[0:3], v[52:55], 0
  v_bitop3_b32 v72, v52, v54, s72 bitop3:0x7e
  s_waitcnt vmcnt(0)
  v_mfma_f32_16x16x32_bf16 v[4:7], v[0:3], v[56:59], v[4:7]
  v_bitop3_b32 v73, v56, v58, s72 bitop3:0x7e
  v_bitop3_b32 v72, v72, v73, 1 bitop3:0xa8
  v_cmp_ne_u32 vcc, 0, v72
  s_cbranch_vccz Cs0_h1p
Cs0_h1s:
  s_mov_b64 exec, vcc
  buffer_load_dwordx4 v[52:55], v76, s[8:11], s60 offen offset:0 sc1
  buffer_load_dwordx4 v[56:59], v76, s[8:11], s60 offen offset:1024 sc1
  s_mov_b64 exec, -1
  s_add_u32 s67, s67, 1
  s_waitcnt vmcnt(1)
  v_mfma_f32_16x16x32_bf16 v[4:7], v[0:3], v[52:55], 0
  v_bitop3_b32 v72, v52, v54, s72 bitop3:0x7e
  s_waitcnt vmcnt(0)
  v_mfma_f32_16x16x32_bf16 v[4:7], v[0:3], v[56:59], v[4:7]
  v_bitop3_b32 v73, v56, v58, s72 bitop3:0x7e
  v_bitop3_b32 v72, v72, v73, 1 bitop3:0xa8
  v_cmp_ne_u32 vcc, 0, v72
  s_cbranch_vccz Cs0_h1p
  s_cmp_lt_u32 s67, 131072
  s_cbranch_scc1 Cs0_h1s
Cs0_h1p:
  s_nop 2
  v_add_f32_dpp v4, v4, v4 row_ror:4 row_mask:0xf bank_mask:0xf
  v_add_f32_dpp v5, v5, v5 row_ror:4 row_mask:0xf bank_mask:0xf
  s_nop 0
  v_add_f32_dpp v4, v4, v4 row_ror:8 row_mask:0xf bank_mask:0xf
  v_add_f32_dpp v5, v5, v5 row_ror:8 row_mask:0xf bank_mask:0xf
  v_cvt_pk_bf16_f32 v4, v4, v5
  buffer_store_dword v4, v69, s[8:11], s62 offen sc1
  s_xor_b32 s62, s62, 16384
  buffer_store_dword v71, v69, s[8:11], s62 offen sc1
  s_xor_b32 s72, s72, 1
  s_branch Cs0_h2
Cs0_rec:
  s_nop 7
  s_waitcnt vmcnt(0) lgkmcnt(0)
  v_max3_u32 v72, v0, v1, v2
  v_max3_u32 v72, v72, v3, v4
  v_max3_u32 v72, v72, v5, v6
  v_max3_u32 v72, v72, v7, v8
  v_max3_u32 v72, v72, v9, v10
  v_max3_u32 v72, v72, v11, v12
  v_max3_u32 v72, v72, v13, v14
  v_max3_u32 v72, v72, v15, v16
  v_max3_u32 v72, v72, v17, v18
  v_max_u32 v72, v72, v19
  v_cmp_eq_u32 vcc, -1, v72
  s_cbranch_vccz Cs0_recok
  s_barrier
  v_mov_b64 v[20:21], 0
  v_mov_b64 v[22:23], 0
  v_mov_b64 v[24:25], 0
  v_mov_b64 v[26:27], 0
  v_mov_b64 v[28:29], 0
  v_mov_b64 v[30:31], 0
  v_mov_b64 v[32:33], 0
  v_mov_b64 v[34:35], 0
  s_waitcnt lgkmcnt(0)
  s_barrier
  ds_read_b128 v[0:3], v76 offset:4608
  s_waitcnt lgkmcnt(0)
  v_smfmac_f32_16x16x64_bf16 v[20:23], v[0:3], v[80:87], v74
  v_smfmac_f32_16x16x64_bf16 v[24:27], v[0:3], v[88:95], v74
  ds_read_b128 v[60:63], v76 offset:16384
  ds_read_b128 v[64:67], v76 offset:17408
  s_waitcnt lgkmcnt(0)
  v_smfmac_f32_16x16x64_bf16 v[28:31], v[0:3], v[60:67], v74
  ds_read_b128 v[60:63], v76 offset:18432
  ds_read_b128 v[64:67], v76 offset:19456
  s_waitcnt lgkmcnt(0)
  v_smfmac_f32_16x16x64_bf16 v[32:35], v[0:3], v[60:67], v74
  ds_read_b128 v[4:7], v76 offset:5632
  s_waitcnt lgkmcnt(0)
  v_smfmac_f32_16x16x64_bf16 v[20:23], v[4:7], v[96:103], v74
  v_smfmac_f32_16x16x64_bf16 v[24:27], v[4:7], v[104:111], v74
  ds_read_b128 v[60:63], v76 offset:32768
  ds_read_b128 v[64:67], v76 offset:33792
  s_waitcnt lgkmcnt(0)
  v_smfmac_f32_16x16x64_bf16 v[28:31], v[4:7], v[60:67], v74
  ds_read_b128 v[60:63], v76 offset:34816
  ds_read_b128 v[64:67], v76 offset:35840
  s_waitcnt lgkmcnt(0)
  v_smfmac_f32_16x16x64_bf16 v[32:35], v[4:7], v[60:67], v74
  ds_read_b128 v[8:11], v76 offset:6656
  s_waitcnt lgkmcnt(0)
  v_smfmac_f32_16x16x64_bf16 v[20:23], v[8:11], v[112:119], v74
  v_smfmac_f32_16x16x64_bf16 v[24:27], v[8:11], v[120:127], v74
  v_smfmac_f32_16x16x64_bf16 v[28:31], v[8:11], v[208:215], v74
  v_smfmac_f32_16x16x64_bf16 v[32:35], v[8:11], v[216:223], v74
  ds_read_b128 v[12:15], v76 offset:7680
  s_waitcnt lgkmcnt(0)
  v_smfmac_f32_16x16x64_bf16 v[20:23], v[12:15], v[128:135], v74
  v_smfmac_f32_16x16x64_bf16 v[24:27], v[12:15], v[136:143], v74
  v_smfmac_f32_16x16x64_bf16 v[28:31], v[12:15], v[224:231], v74
  v_smfmac_f32_16x16x64_bf16 v[32:35], v[12:15], v[232:239], v74
  ds_read_b128 v[0:3], v76 offset:8704
  s_waitcnt lgkmcnt(0)
  v_smfmac_f32_16x16x64_bf16 v[20:23], v[0:3], v[144:151], v74
  v_smfmac_f32_16x16x64_bf16 v[24:27], v[0:3], v[152:159], v74
  ds_read_b128 v[60:63], v76 offset:49152
  ds_read_b128 v[64:67], v76 offset:50176
  s_waitcnt lgkmcnt(0)
  v_smfmac_f32_16x16x64_bf16 v[28:31], v[0:3], v[60:67], v74
  ds_read_b128 v[60:63], v76 offset:51200
  ds_read_b128 v[64:67], v76 offset:52224
  s_waitcnt lgkmcnt(0)
  v_smfmac_f32_16x16x64_bf16 v[32:35], v[0:3], v[60:67], v74
  ds_read_b128 v[8:11], v76 offset:9728
  s_waitcnt lgkmcnt(0)
  v_smfmac_f32_16x16x64_bf16 v[20:23], v[8:11], v[160:167], v74
  v_smfmac_f32_16x16x64_bf16 v[24:27], v[8:11], v[168:175], v74
  ds_read_b128 v[60:63], v75 offset:16384
  ds_read_b128 v[64:67], v75 offset:17408
  s_waitcnt lgkmcnt(0)
  v_smfmac_f32_16x16x64_bf16 v[28:31], v[8:11], v[60:67], v74
  ds_read_b128 v[60:63], v75 offset:18432
  ds_read_b128 v[64:67], v75 offset:19456
  s_waitcnt lgkmcnt(0)
  v_smfmac_f32_16x16x64_bf16 v[32:35], v[8:11], v[60:67], v74
  ds_read_b128 v[16:19], v76 offset:10752
  ds_read_b128 v[60:63], v75 offset:0
  ds_read_b128 v[64:67], v75 offset:1024
  s_waitcnt lgkmcnt(0)
  v_smfmac_f32_16x16x64_bf16 v[20:23], v[16:19], v[60:67], v74
  ds_read_b128 v[60:63], v75 offset:2048
  ds_read_b128 v[64:67], v75 offset:3072
  s_waitcnt lgkmcnt(0)
  v_smfmac_f32_16x16x64_bf16 v[24:27], v[16:19], v[60:67], v74
  v_smfmac_f32_16x16x64_bf16 v[28:31], v[16:19], v[240:247], v74
  v_smfmac_f32_16x16x64_bf16 v[32:35], v[16:19], v[248:255], v74
  ds_read_b128 v[4:7], v76 offset:11776
  s_waitcnt lgkmcnt(0)
  v_smfmac_f32_16x16x64_bf16 v[20:23], v[4:7], v[176:183], v74
  v_smfmac_f32_16x16x64_bf16 v[24:27], v[4:7], v[184:191], v74
  v_smfmac_f32_16x16x64_bf16 v[28:31], v[4:7], a[0:7], v74
  v_smfmac_f32_16x16x64_bf16 v[32:35], v[4:7], a[8:15], v74
  ds_read_b128 v[12:15], v76 offset:12800
  s_waitcnt lgkmcnt(0)
  v_smfmac_f32_16x16x64_bf16 v[20:23], v[12:15], v[192:199], v74
  v_smfmac_f32_16x16x64_bf16 v[24:27], v[12:15], v[200:207], v74
  v_smfmac_f32_16x16x64_bf16 v[28:31], v[12:15], a[16:23], v74
  v_smfmac_f32_16x16x64_bf16 v[32:35], v[12:15], a[24:31], v74
  v_add_f32 v20, v20, v22
  v_add_f32 v21, v21, v23
  v_add_f32 v24, v24, v26
  v_cvt_pk_bf16_f32 v22, v20, v24
  ds_write_b32 v79, v22 offset:0
  v_add_f32 v25, v25, v27
  v_cvt_pk_bf16_f32 v23, v21, v25
  ds_write_b32 v79, v23 offset:576
  v_add_f32 v28, v28, v30
  v_add_f32 v29, v29, v31
  s_waitcnt lgkmcnt(0)
  s_nop 1
  s_branch Cs0_recok
Cs0_mx:
  s_waitcnt lgkmcnt(0)
  s_barrier
  buffer_load_dwordx4 v[52:55], v76, s[8:11], s59 offen offset:0 sc1
  buffer_load_dwordx4 v[0:3], v76, s[8:11], s58 offen offset:0 sc1
  ds_read_b128 v[20:23], v77 offset:0
  ds_read_b128 v[28:31], v77 offset:256
  buffer_load_dwordx4 v[56:59], v76, s[8:11], s59 offen offset:1024 sc1
  buffer_load_dwordx4 v[4:7], v76, s[8:11], s58 offen offset:1024 sc1
  ds_read_b128 v[24:27], v77 offset:128
  ds_read_b128 v[32:35], v77 offset:384
  s_waitcnt vmcnt(2) lgkmcnt(3)
  v_mfma_f32_16x16x32_bf16 v[8:11], v[0:3], v[20:23], 0
  s_waitcnt vmcnt(0) lgkmcnt(1)
  v_mfma_f32_16x16x32_bf16 v[8:11], v[4:7], v[24:27], v[8:11]
  v_mfma_f32_16x16x32_bf16 v[12:15], v[28:31], v[20:23], 0
  s_waitcnt lgkmcnt(0)
  v_mfma_f32_16x16x32_bf16 v[12:15], v[32:35], v[24:27], v[12:15]
  v_add_f32_dpp v8, v10, v8 quad_perm:[2,3,0,1] row_mask:0xf bank_mask:0xf
  v_add_f32_dpp v9, v11, v9 quad_perm:[2,3,0,1] row_mask:0xf bank_mask:0xf
  s_nop 0
  v_mov_b32_dpp v8, v8 quad_perm:[0,1,0,1] row_mask:0xf bank_mask:0xf
  v_mov_b32_dpp v9, v9 quad_perm:[0,1,0,1] row_mask:0xf bank_mask:0xf
  s_nop 1
  v_add_f32_dpp v12, v14, v12 quad_perm:[2,3,0,1] row_mask:0xf bank_mask:0xf
  v_add_f32_dpp v13, v15, v13 quad_perm:[2,3,0,1] row_mask:0xf bank_mask:0xf
  s_nop 0
  v_mov_b32_dpp v12, v12 quad_perm:[0,1,0,1] row_mask:0xf bank_mask:0xf
  v_mov_b32_dpp v13, v13 quad_perm:[0,1,0,1] row_mask:0xf bank_mask:0xf
  v_mul_f32 v12, s69, v12
  ds_write_b32 v78, v8 offset:8704
  v_mul_f32 v13, s69, v13
  ds_write_b32 v78, v9 offset:8768
  s_waitcnt lgkmcnt(0)
  s_barrier
  ds_read_b128 v[36:39], v78 offset:8704
  ds_read_b128 v[40:43], v78 offset:8768
  s_waitcnt lgkmcnt(0)
  s_barrier
  v_max_f32 v16, v36, v37
  v_max3_f32 v16, v16, v38, v39
  v_max3_f32 v16, v16, v40, v41
  v_max3_f32 v16, v16, v42, v43
  v_max3_f32 v16, v16, v12, v13
  v_mov_b32 v17, v16
  s_nop 1
  v_permlane16_swap_b32 v16, v17
  v_max_f32 v16, v16, v17
  v_mov_b32 v17, v16
  s_nop 1
  v_permlane32_swap_b32 v16, v17
  v_max_f32 v16, v16, v17
  v_sub_f32 v36, v36, v16
  v_sub_f32 v37, v37, v16
  v_sub_f32 v38, v38, v16
  v_sub_f32 v39, v39, v16
  v_sub_f32 v40, v40, v16
  v_sub_f32 v41, v41, v16
  v_sub_f32 v42, v42, v16
  v_sub_f32 v43, v43, v16
  v_sub_f32 v12, v12, v16
  v_sub_f32 v13, v13, v16
  v_exp_f32 v36, v36
  v_exp_f32 v37, v37
  v_exp_f32 v38, v38
  v_exp_f32 v39, v39
  v_exp_f32 v40, v40
  v_exp_f32 v41, v41
  v_exp_f32 v42, v42
  v_exp_f32 v43, v43
  v_exp_f32 v12, v12
  v_exp_f32 v13, v13
  v_cvt_pk_bf16_f32 v32, v36, v40
  v_cvt_pk_bf16_f32 v33, v37, v41
  v_cvt_pk_bf16_f32 v34, v38, v42
  v_cvt_pk_bf16_f32 v35, v39, v43
  v_cvt_pk_bf16_f32 v28, v12, v13
  v_cvt_pk_bf16_f32 v31, v12, v13
  v_mov_b32 v29, 0
  v_mov_b32 v30, 0
  v_mfma_f32_16x16x32_bf16 v[8:11], v[32:35], v[68:71], 0
  v_mfma_f32_16x16x32_bf16 v[0:3], v[32:35], v[52:55], 0
  v_mfma_f32_16x16x32_bf16 v[4:7], v[32:35], v[56:59], 0
  v_mfma_f32_16x16x16_bf16 v[8:11], v[28:29], v[68:69], v[8:11]
  v_mfma_f32_16x16x16_bf16 v[0:3], v[28:29], v[72:73], v[0:3]
  v_mfma_f32_16x16x16_bf16 v[4:7], v[30:31], v[72:73], v[4:7]
  ds_read_b128 v[52:55], v75 offset:32768
  v_rcp_f32 v10, v8
  v_rcp_f32 v11, v9
  v_mul_f32 v0, v10, v0
  v_mul_f32 v1, v11, v1
  v_max3_f32 v8, v8, v9, v10
  v_mul_f32 v4, v10, v4
  v_mul_f32 v5, v11, v5
  v_cvt_pk_bf16_f32 v2, v0, v4
  ds_write_b32 v79, v2 offset:8704
  v_cvt_pk_bf16_f32 v3, v1, v5
  ds_write_b32 v79, v3 offset:9280
  ds_read_b128 v[12:15], v78 offset:8704
  ds_read_b128 v[56:59], v75 offset:33792
  v_mov_b64 v[16:17], 0
  v_mov_b64 v[18:19], 0
  v_mov_b64 v[20:21], 0
  v_mov_b64 v[22:23], 0
  v_mov_b64 v[24:25], 0
  v_mov_b64 v[26:27], 0
  s_branch Cs0_mxok
Cs0_kv3:
  s_waitcnt lgkmcnt(0)
  s_cmp_ge_u32 s57, 0x700
  s_cbranch_scc1 Cs0_kvb
  s_load_dword s57, s[12:13], s71 glc
  s_add_u32 s67, s67, 1
  s_cmp_lt_u32 s67, 131072
  s_cbranch_scc1 Cs0_kv3
  s_waitcnt lgkmcnt(0)
  s_branch Cs0_kvb
Cs0_last:
  ds_read_b128 v[4:7], v76 offset:5632
  ds_read_b128 v[12:15], v76 offset:7680
  ds_read_b128 v[44:47], v76 offset:32768
  ds_read_b128 v[48:51], v76 offset:33792
  s_nop 5
  v_mov_b64 v[20:21], 0
  v_mov_b64 v[22:23], 0
  v_mov_b64 v[24:25], 0
  v_mov_b64 v[26:27], 0
  v_smfmac_f32_16x16x64_bf16 v[28:31], v[0:3], v[36:43], v74
  ds_read_b128 v[36:39], v76 offset:34816
  ds_read_b128 v[40:43], v76 offset:35840
  v_smfmac_f32_16x16x64_bf16 v[32:35], v[0:3], v[60:67], v74
  s_waitcnt lgkmcnt(5)
  v_smfmac_f32_16x16x64_bf16 v[20:23], v[0:3], a[32:39], v74
  ds_read_b128 v[60:63], v76 offset:49152
  ds_read_b128 v[64:67], v76 offset:50176
  v_smfmac_f32_16x16x64_bf16 v[24:27], v[0:3], a[40:47], v74
  s_waitcnt lgkmcnt(4)
  v_smfmac_f32_16x16x64_bf16 v[20:23], v[4:7], a[48:55], v74
  buffer_store_dwordx4 v[16:19], v76, s[8:11], s68 offen sc1
  v_smfmac_f32_16x16x64_bf16 v[24:27], v[4:7], a[56:63], v74
  v_smfmac_f32_16x16x64_bf16 v[28:31], v[4:7], v[44:51], v74
  s_waitcnt lgkmcnt(2)
  v_smfmac_f32_16x16x64_bf16 v[20:23], v[8:11], a[64:71], v74
  ds_read_b128 v[44:47], v76 offset:51200
  ds_read_b128 v[48:51], v76 offset:52224
  v_smfmac_f32_16x16x64_bf16 v[24:27], v[8:11], a[72:79], v74
  v_smfmac_f32_16x16x64_bf16 v[32:35], v[4:7], v[36:43], v74
  v_smfmac_f32_16x16x64_bf16 v[28:31], v[8:11], v[208:215], v74
  ds_read_b128 v[36:39], v75 offset:16384
  ds_read_b128 v[40:43], v75 offset:17408
  v_smfmac_f32_16x16x64_bf16 v[32:35], v[8:11], v[216:223], v74
  v_smfmac_f32_16x16x64_bf16 v[20:23], v[12:15], a[80:87], v74
  v_smfmac_f32_16x16x64_bf16 v[24:27], v[12:15], a[88:95], v74
  v_smfmac_f32_16x16x64_bf16 v[28:31], v[12:15], v[224:231], v74
  v_smfmac_f32_16x16x64_bf16 v[32:35], v[12:15], v[232:239], v74
  s_waitcnt vmcnt(1)
  s_barrier
Cs0_lastr:
  ds_read_b128 v[0:3], v76 offset:8704
  ds_read_b128 v[8:11], v76 offset:9728
  ds_read_b128 v[16:19], v76 offset:10752
  ds_read_b128 v[4:7], v76 offset:11776
  ds_read_b128 v[12:15], v76 offset:12800
  s_waitcnt lgkmcnt(4)
  v_max3_u32 v72, v0, v1, v2
  s_waitcnt lgkmcnt(1)
  v_max3_u32 v72, v72, v3, v4
  v_max3_u32 v72, v72, v5, v6
  v_max3_u32 v72, v72, v7, v8
  v_max3_u32 v72, v72, v9, v10
  s_waitcnt lgkmcnt(0)
  v_max3_u32 v72, v72, v11, v12
  v_max3_u32 v72, v72, v13, v14
  v_max3_u32 v72, v72, v15, v16
  v_max3_u32 v72, v72, v17, v18
  v_max_u32 v72, v72, v19
  v_cmp_eq_u32 vcc, -1, v72
  s_cbranch_vccnz Cs0_lastp
Cs0_lastg:
  v_smfmac_f32_16x16x64_bf16 v[28:31], v[0:3], v[60:67], v74
  ds_read_b128 v[60:63], v75 offset:18432
  ds_read_b128 v[64:67], v75 offset:19456
  v_smfmac_f32_16x16x64_bf16 v[32:35], v[0:3], v[44:51], v74
  v_smfmac_f32_16x16x64_bf16 v[28:31], v[8:11], v[36:43], v74
  v_smfmac_f32_16x16x64_bf16 v[28:31], v[16:19], v[240:247], v74
  v_smfmac_f32_16x16x64_bf16 v[28:31], v[4:7], a[0:7], v74
  v_smfmac_f32_16x16x64_bf16 v[28:31], v[12:15], a[16:23], v74
  v_smfmac_f32_16x16x64_bf16 v[32:35], v[16:19], v[248:255], v74
  v_smfmac_f32_16x16x64_bf16 v[32:35], v[4:7], a[8:15], v74
  s_waitcnt lgkmcnt(0)
  v_smfmac_f32_16x16x64_bf16 v[32:35], v[12:15], a[24:31], v74
  v_smfmac_f32_16x16x64_bf16 v[32:35], v[8:11], v[60:67], v74
  v_smfmac_f32_16x16x64_bf16 v[20:23], v[0:3], a[96:103], v74
  v_smfmac_f32_16x16x64_bf16 v[20:23], v[8:11], a[112:119], v74
  v_add_f32 v28, v28, v30
  v_add_f32 v32, v32, v34
  v_cvt_pk_bf16_f32 v30, v28, v32
  v_smfmac_f32_16x16x64_bf16 v[20:23], v[16:19], a[128:135], v74
  ds_write_b32 v79, v30 offset:256
  v_add_f32 v29, v29, v31
  v_add_f32 v33, v33, v35
  v_cvt_pk_bf16_f32 v31, v29, v33
  v_smfmac_f32_16x16x64_bf16 v[20:23], v[4:7], a[144:151], v74
  ds_write_b32 v79, v31 offset:832
  v_smfmac_f32_16x16x64_bf16 v[20:23], v[12:15], a[160:167], v74
  v_smfmac_f32_16x16x64_bf16 v[24:27], v[0:3], a[104:111], v74
  v_smfmac_f32_16x16x64_bf16 v[24:27], v[8:11], a[120:127], v74
  v_smfmac_f32_16x16x64_bf16 v[24:27], v[16:19], a[136:143], v74
  s_waitcnt lgkmcnt(0)
  s_barrier
  ds_read_b64 v[52:53], v77 offset:256
  v_add_f32 v20, v20, v22
  v_smfmac_f32_16x16x64_bf16 v[24:27], v[4:7], a[152:159], v74
  v_add_f32 v21, v21, v23
  v_smfmac_f32_16x16x64_bf16 v[24:27], v[12:15], a[168:175], v74
  v_cvt_pk_bf16_f32 v54, v20, v21
  s_add_u32 s68, s68, 655360
  s_nop 3
  v_add_f32 v24, v24, v26
  v_add_f32 v25, v25, v27
  v_cvt_pk_bf16_f32 v55, v24, v25
  s_waitcnt lgkmcnt(0)
  buffer_store_dwordx4 v[52:55], v76, s[8:11], s68 offen sc1
  s_branch Cs0_done
Cs0_lastp:
  s_add_u32 s72, s72, 2
  s_cmp_ge_u32 s72, 131072
  s_cbranch_scc1 Cs0_lastg
  s_barrier
  buffer_load_dwordx4 v76, s[8:11], s85 offen offset:0 sc1 lds
  s_waitcnt vmcnt(0)
  s_barrier
  s_branch Cs0_lastr
Cs0_done:
  s_branch L_cexit
L_w5:
  v_mov_b64 v[20:21], 0
  v_mov_b64 v[22:23], 0
  v_mov_b64 v[24:25], 0
  v_mov_b64 v[26:27], 0
  v_mov_b64 v[28:29], 0
  v_mov_b64 v[30:31], 0
  v_mov_b64 v[32:33], 0
  v_mov_b64 v[34:35], 0
  s_mov_b32 s78, 0x3f803f80
  s_mov_b32 s79, s78
  s_mov_b32 s65, 360448
  s_mov_b32 m0, 15872
  s_lshl_b32 s71, s53, 2
  s_add_u32 s71, s71, 128
  s_movk_i32 s56, 0x1000
  v_lshlrev_b32 v73, 2, v76
  v_mov_b32 v72, 0
  s_mov_b64 s[16:17], s[8:9]
  s_mov_b32 s18, 268435456
  s_mov_b32 s19, 0x20000
  s_getpc_b64 s[20:21]
Cs1_pc:
  s_add_u32 s20, s20, (Cs1_last - Cs1_pc)
  s_addc_u32 s21, s21, 0
  v_mov_b32 v68, 14880
  buffer_load_dwordx4 v[52:55], v76, s[8:11], s59 offen offset:0 sc1
  buffer_load_dwordx4 v[56:59], v76, s[8:11], s59 offen offset:1024 sc1
  ds_read_b128 v[36:39], v76 offset:20480
  ds_read_b128 v[40:43], v76 offset:21504
  ds_read_b128 v[60:63], v76 offset:22528
  ds_read_b128 v[64:67], v76 offset:23552
  ds_read_b128 v[0:3], v76 offset:4608
  ds_read_b128 v[4:7], v76 offset:5632
  ds_read_b128 v[8:11], v76 offset:6656
  ds_read_b128 v[12:15], v76 offset:7680
  s_waitcnt lgkmcnt(0)
  s_cmp_eq_u32 s66, 1
  s_branch Cs1_top2
.p2align 6
Cs1_h2:
  ds_read_b128 v[36:39], v76 offset:20480
  ds_read_b128 v[40:43], v76 offset:21504
  v_lshlrev_b32 v73, 2, v76
  ds_read_b128 v[60:63], v76 offset:22528
  s_cmp_eq_u32 s66, 62
  s_cselect_b64 s[16:17], s[20:21], s[16:17]
  s_cselect_b32 s18, (Cs1_done - Cs1_last), s18
  s_cselect_b32 s70, 0, s70
  s_cmp_eq_u32 s66, 63
  s_cselect_b32 s59, 268435456, s59
  s_cselect_b32 s58, 268435456, s58
  buffer_load_dwordx4 v[52:55], v76, s[8:11], s59 offen offset:0 sc1
  buffer_load_dwordx4 v[56:59], v76, s[8:11], s59 offen offset:1024 sc1
  s_waitcnt vmcnt(0)
  s_mov_b64 vcc, -1
Cs1_h2r:
  s_mov_b64 exec, vcc
  buffer_load_dwordx4 v[8:11], v76, s[8:11], s65 offen offset:2048 sc1
  buffer_load_dwordx4 v[0:3], v76, s[8:11], s85 offen offset:0 sc1
  s_mov_b64 exec, -1
  s_add_u32 s67, s67, 1
  s_cmp_lt_u32 s67, 131072
  s_cselect_b32 s54, -2, -1
  s_waitcnt vmcnt(1)
  v_max3_u32 v72, v8, v9, v10
  s_waitcnt vmcnt(0)
  v_max3_u32 v72, v72, v11, v0
  v_max3_u32 v72, v72, v1, v2
  v_max_u32 v72, v72, v3
  v_cmp_lt_u32 vcc, s54, v72
  s_cbranch_vccnz Cs1_h2r
  ds_write_b128 v76, v[8:11] offset:6656
  ds_write_b128 v76, v[0:3] offset:11776
Cs1_h2w:
  s_cmp_eq_u32 s66, 63
  s_waitcnt lgkmcnt(0)
  s_barrier
  ds_read_b128 v[0:3], v76 offset:4608
Cs1_top2:
  v_smfmac_f32_16x16x64_bf16 v[20:23], v[8:11], v[112:119], v74
  s_cbranch_scc1 Cs1_last
  v_smfmac_f32_16x16x64_bf16 v[24:27], v[8:11], v[120:127], v74
  buffer_load_dwordx4 v[44:47], v76, s[8:11], s58 offen offset:0 sc1
  s_mov_b32 m0, 15872
  v_smfmac_f32_16x16x64_bf16 v[28:31], v[8:11], v[208:215], v74
  buffer_load_dwordx4 v[48:51], v76, s[8:11], s58 offen offset:1024 sc1
  v_smfmac_f32_16x16x64_bf16 v[32:35], v[8:11], v[216:223], v74
  ds_read_b128 v[4:7], v76 offset:5632
  s_waitcnt lgkmcnt(1)
  v_smfmac_f32_16x16x64_bf16 v[20:23], v[0:3], v[80:87], v74
  ds_read_b128 v[12:15], v76 offset:7680
  v_smfmac_f32_16x16x64_bf16 v[28:31], v[0:3], v[36:43], v74
  ds_read_b128 v[36:39], v76 offset:36864
  v_smfmac_f32_16x16x64_bf16 v[24:27], v[0:3], v[88:95], v74
  buffer_store_dwordx4 v[16:19], v76, s[8:11], s68 offen sc1
  ds_read_b128 v[40:43], v76 offset:37888
  v_smfmac_f32_16x16x64_bf16 v[32:35], v[0:3], v[60:67], v74
  buffer_load_dword v73, s[16:19], s70 offen lds
  ds_read_b128 v[60:63], v76 offset:38912
  s_waitcnt lgkmcnt(4)
  v_smfmac_f32_16x16x64_bf16 v[20:23], v[4:7], v[96:103], v74
  ds_read_b128 v[64:67], v76 offset:39936
  v_smfmac_f32_16x16x64_bf16 v[24:27], v[4:7], v[104:111], v74
  s_waitcnt vmcnt(4)
  s_waitcnt lgkmcnt(4)
  v_smfmac_f32_16x16x64_bf16 v[20:23], v[12:15], v[128:135], v74
  s_barrier
  ds_read_b128 v[8:11], v76 offset:8704
  s_waitcnt lgkmcnt(3)
  v_smfmac_f32_16x16x64_bf16 v[28:31], v[4:7], v[36:43], v74
  ds_read_b128 v[36:39], v76 offset:53248
  v_smfmac_f32_16x16x64_bf16 v[24:27], v[12:15], v[136:143], v74
  ds_read_b128 v[40:43], v76 offset:54272
  s_waitcnt lgkmcnt(3)
  v_smfmac_f32_16x16x64_bf16 v[32:35], v[4:7], v[60:67], v74
  ds_read_b128 v[0:3], v76 offset:9728
  v_smfmac_f32_16x16x64_bf16 v[28:31], v[12:15], v[224:231], v74
  ds_read_b128 v[60:63], v76 offset:55296
  v_smfmac_f32_16x16x64_bf16 v[32:35], v[12:15], v[232:239], v74
  ds_read_b128 v[64:67], v76 offset:56320
  s_waitcnt lgkmcnt(5)
  v_smfmac_f32_16x16x64_bf16 v[20:23], v[8:11], v[144:151], v74
  s_barrier
  ds_read_b128 v[4:7], v76 offset:11776
  s_waitcnt lgkmcnt(4)
  v_smfmac_f32_16x16x64_bf16 v[28:31], v[8:11], v[36:43], v74
  ds_read_b128 v[12:15], v76 offset:12800
  ds_read_b128 v[36:39], v75 offset:4096
  v_smfmac_f32_16x16x64_bf16 v[24:27], v[8:11], v[152:159], v74
  ds_read_b128 v[16:19], v76 offset:10752
  s_waitcnt lgkmcnt(6)
  v_smfmac_f32_16x16x64_bf16 v[20:23], v[0:3], v[160:167], v74
  ds_read_b128 v[40:43], v75 offset:5120
  s_waitcnt lgkmcnt(5)
  v_smfmac_f32_16x16x64_bf16 v[32:35], v[8:11], v[60:67], v74
  ds_read_b128 v[60:63], v75 offset:6144
  v_smfmac_f32_16x16x64_bf16 v[24:27], v[0:3], v[168:175], v74
  ds_read_b128 v[64:67], v75 offset:7168
  s_waitcnt lgkmcnt(6)
  v_smfmac_f32_16x16x64_bf16 v[20:23], v[4:7], v[176:183], v74
  s_waitcnt lgkmcnt(5)
  v_smfmac_f32_16x16x64_bf16 v[20:23], v[12:15], v[192:199], v74
  s_waitcnt lgkmcnt(2)
  v_smfmac_f32_16x16x64_bf16 v[20:23], v[16:19], v[36:43], v74
  ds_read_b128 v[36:39], v75 offset:20480
  v_smfmac_f32_16x16x64_bf16 v[24:27], v[4:7], v[184:191], v74
  ds_read_b128 v[40:43], v75 offset:21504
  s_waitcnt lgkmcnt(2)
  v_smfmac_f32_16x16x64_bf16 v[24:27], v[16:19], v[60:67], v74
  ds_read_b128 v[60:63], v75 offset:22528
  v_add_f32 v20, v20, v22
  v_smfmac_f32_16x16x64_bf16 v[24:27], v[12:15], v[200:207], v74
  ds_read_b128 v[64:67], v75 offset:23552
  v_add_f32 v21, v21, v23
  v_smfmac_f32_16x16x64_bf16 v[28:31], v[16:19], v[240:247], v74
  v_mov_b64 v[70:71], s[78:79]
  v_smfmac_f32_16x16x64_bf16 v[28:31], v[4:7], a[0:7], v74
  s_waitcnt lgkmcnt(2)
  v_add_f32 v24, v24, v26
  v_smfmac_f32_16x16x64_bf16 v[28:31], v[0:3], v[36:43], v74
  ds_read_b128 v[36:39], v68
  v_cvt_pk_bf16_f32 v22, v20, v24
  v_smfmac_f32_16x16x64_bf16 v[28:31], v[12:15], a[16:23], v74
  ds_read_b128 v[40:43], v68
  ds_write_b32 v79, v22 offset:0
  s_waitcnt lgkmcnt(3)
  v_add_f32 v25, v25, v27
  v_cvt_pk_bf16_f32 v23, v21, v25
  v_smfmac_f32_16x16x64_bf16 v[32:35], v[0:3], v[60:67], v74
  ds_write_b32 v79, v23 offset:576
  v_cmp_u_f32 vcc, v20, v21
  v_smfmac_f32_16x16x64_bf16 v[32:35], v[16:19], v[248:255], v74
  v_add_f32 v28, v28, v30
  v_smfmac_f32_16x16x64_bf16 v[32:35], v[4:7], a[8:15], v74
  v_add_f32 v29, v29, v31
  v_smfmac_f32_16x16x64_bf16 v[32:35], v[12:15], a[24:31], v74
  s_cbranch_vccnz Cs1_rec
Cs1_recok:
  s_waitcnt lgkmcnt(3)
  v_smfmac_f32_16x16x64_bf16 v[36:39], v[16:19], a[128:135], v74
  s_waitcnt lgkmcnt(0)
  s_barrier
  ds_read_b128 v[60:63], v77
  v_smfmac_f32_16x16x64_bf16 v[40:43], v[16:19], a[136:143], v74
  ds_read_b128 v[64:67], v77 offset:128
  v_add_f32 v32, v32, v34
  v_cvt_pk_bf16_f32 v30, v28, v32
  v_smfmac_f32_16x16x64_bf16 v[36:39], v[0:3], a[112:119], v74
  ds_write_b32 v79, v30 offset:256
  v_add_f32 v33, v33, v35
  v_cvt_pk_bf16_f32 v31, v29, v33
  v_smfmac_f32_16x16x64_bf16 v[40:43], v[0:3], a[120:127], v74
  ds_write_b32 v79, v31 offset:832
  v_xor_b32 v75, 0x8000, v75
  v_smfmac_f32_16x16x64_bf16 v[36:39], v[4:7], a[144:151], v74
  ds_read_b128 v[0:3], v76 offset:4608
  v_mov_b32 v29, 0
  v_smfmac_f32_16x16x64_bf16 v[40:43], v[4:7], a[152:159], v74
  s_waitcnt vmcnt(2) lgkmcnt(3)
  v_mov_b32 v30, 0
  v_mfma_f32_16x16x32_bf16 v[44:47], v[44:47], v[60:63], 0
  ds_read_b128 v[4:7], v76 offset:5632
  s_waitcnt lgkmcnt(2)
  v_mfma_f32_16x16x32_bf16 v[44:47], v[48:51], v[64:67], v[44:47]
  s_barrier
  v_smfmac_f32_16x16x64_bf16 v[36:39], v[8:11], a[96:103], v74
  ds_read_b128 v[20:23], v77 offset:256
  ds_read_b128 v[24:27], v77 offset:384
  v_smfmac_f32_16x16x64_bf16 v[40:43], v[8:11], a[104:111], v74
  ds_read_b128 v[8:11], v76 offset:6656
  v_add_f32_dpp v72, v46, v44 quad_perm:[2,3,0,1] row_mask:0xf bank_mask:0xf
  v_add_f32_dpp v73, v47, v45 quad_perm:[2,3,0,1] row_mask:0xf bank_mask:0xf
  v_smfmac_f32_16x16x64_bf16 v[36:39], v[12:15], a[160:167], v74
  s_waitcnt lgkmcnt(4)
  v_exp_f32_dpp v72, v72 quad_perm:[0,1,0,1] row_mask:0xf bank_mask:0xf
  v_smfmac_f32_16x16x64_bf16 v[40:43], v[12:15], a[168:175], v74
  ds_read_b128 v[12:15], v76 offset:7680
  v_exp_f32_dpp v73, v73 quad_perm:[0,1,0,1] row_mask:0xf bank_mask:0xf
  v_smfmac_f32_16x16x64_bf16 v[36:39], v[0:3], a[32:39], v74
  s_waitcnt lgkmcnt(2)
  v_cvt_pk_bf16_f32 v72, v72, v73
  v_mfma_f32_16x16x32_bf16 v[20:23], v[20:23], v[60:63], 0
  ds_write_b32 v78, v72 offset:516
  v_mov_b64 v[16:17], 0
  v_mfma_f32_16x16x32_bf16 v[20:23], v[24:27], v[64:67], v[20:23]
  ds_read_b128 v[44:47], v75 offset:22528
  v_mov_b64 v[18:19], 0
  v_smfmac_f32_16x16x64_bf16 v[40:43], v[0:3], a[40:47], v74
  ds_read_b128 v[48:51], v75 offset:23552
  v_mov_b64 v[68:69], s[78:79]
  v_smfmac_f32_16x16x64_bf16 v[36:39], v[4:7], a[48:55], v74
  s_waitcnt lgkmcnt(4)
  v_add_f32_dpp v24, v22, v20 quad_perm:[2,3,0,1] row_mask:0xf bank_mask:0xf
  v_add_f32_dpp v25, v23, v21 quad_perm:[2,3,0,1] row_mask:0xf bank_mask:0xf
  v_smfmac_f32_16x16x64_bf16 v[36:39], v[8:11], a[64:71], v74
  s_waitcnt lgkmcnt(2)
  s_barrier
  ds_read_b128 v[32:35], v78 offset:512
  v_smfmac_f32_16x16x64_bf16 v[36:39], v[12:15], a[80:87], v74
  ds_read_b128 v[60:63], v75 offset:20480
  v_mul_f32 v24, s69, v24
  v_smfmac_f32_16x16x64_bf16 v[40:43], v[4:7], a[56:63], v74
  ds_read_b128 v[64:67], v75 offset:21504
  v_mul_f32 v25, s69, v25
  v_smfmac_f32_16x16x64_bf16 v[40:43], v[8:11], a[72:79], v74
  v_exp_f32_dpp v24, v24 quad_perm:[0,1,0,1] row_mask:0xf bank_mask:0xf
  v_smfmac_f32_16x16x64_bf16 v[40:43], v[12:15], a[88:95], v74
  s_waitcnt lgkmcnt(2)
  v_exp_f32_dpp v25, v25 quad_perm:[0,1,0,1] row_mask:0xf bank_mask:0xf
  v_mfma_f32_16x16x32_bf16 v[8:11], v[32:35], v[68:71], 0
  v_add_f32 v36, v36, v38
  v_add_f32 v37, v37, v39
  v_mfma_f32_16x16x32_bf16 v[0:3], v[32:35], v[52:55], 0
  v_add_f32 v40, v40, v42
  v_add_f32 v41, v41, v43
  v_mfma_f32_16x16x32_bf16 v[4:7], v[32:35], v[56:59], 0
  v_cvt_pk_bf16_f32 v28, v24, v25
  v_cvt_pk_bf16_f32 v72, v36, v37
  v_cvt_pk_bf16_f32 v73, v40, v41
  v_mfma_f32_16x16x16_bf16 v[8:11], v[28:29], v[68:69], v[8:11]
  v_cvt_pk_bf16_f32 v31, v24, v25
  v_mov_b64 v[20:21], 0
  v_mfma_f32_16x16x16_bf16 v[0:3], v[28:29], v[72:73], v[0:3]
  ds_read_b128 v[52:55], v75 offset:36864
  v_mov_b64 v[22:23], 0
  v_mfma_f32_16x16x16_bf16 v[4:7], v[30:31], v[72:73], v[4:7]
  v_rcp_f32 v10, v8
  v_rcp_f32 v11, v9
  v_mul_f32 v0, v10, v0
  v_mul_f32 v1, v11, v1
  v_max3_f32 v8, v8, v9, v10
  v_mul_f32 v4, v10, v4
  v_mul_f32 v5, v11, v5
  v_cvt_pk_bf16_f32 v2, v0, v4
  ds_write_b32 v79, v2 offset:8704
  v_cvt_pk_bf16_f32 v3, v1, v5
  ds_write_b32 v79, v3 offset:9280
  ds_read_b128 v[12:15], v78 offset:8768
  v_max_f32 v8, v8, v11
  v_cmp_le_f32 vcc, 1317011456, v8
  v_mov_b64 v[24:25], 0
  v_mov_b64 v[26:27], 0
  ds_read_b128 v[56:59], v75 offset:37888
  s_cbranch_vccnz Cs1_mx
Cs1_mxok:
  s_waitcnt lgkmcnt(2)
  s_barrier
  ds_read_b128 v[0:3], v78 offset:8704
  s_waitcnt lgkmcnt(2)
  v_smfmac_f32_16x16x64_bf16 v[16:19], v[12:15], v[44:51], v74
  ds_read_b128 v[4:7], v78 offset:8832
  v_smfmac_f32_16x16x64_bf16 v[20:23], v[12:15], a[200:207], v74
  ds_read_b128 v[8:11], v78 offset:8896
  v_smfmac_f32_16x16x64_bf16 v[24:27], v[12:15], a[216:223], v74
  ds_read_b128 v[36:39], v75 offset:38912
  s_waitcnt lgkmcnt(3)
  v_smfmac_f32_16x16x64_bf16 v[16:19], v[0:3], v[60:67], v74
  ds_read_b128 v[40:43], v75 offset:39936
  s_waitcnt lgkmcnt(3)
  v_smfmac_f32_16x16x64_bf16 v[16:19], v[4:7], a[176:183], v74
  ds_read_b128 v[68:71], v76 offset:13824
  s_waitcnt lgkmcnt(3)
  v_smfmac_f32_16x16x64_bf16 v[16:19], v[8:11], a[184:191], v74
  ds_read_b128 v[44:47], v75 offset:53248
  v_smfmac_f32_16x16x64_bf16 v[20:23], v[0:3], a[192:199], v74
  ds_read_b128 v[48:51], v75 offset:54272
  v_smfmac_f32_16x16x64_bf16 v[20:23], v[4:7], v[52:59], v74
  ds_read_b128 v[60:63], v75 offset:55296
  s_waitcnt lgkmcnt(4)
  v_cvt_pk_bf16_f32 v16, v16, v17
  v_cvt_pk_bf16_f32 v17, v18, v19
  v_bfi_b32 v16, 1, s72, v16
  v_smfmac_f32_16x16x64_bf16 v[20:23], v[8:11], v[36:43], v74
  s_waitcnt lgkmcnt(3)
  buffer_store_dwordx2 v[16:17], v68, s[8:11], s73 offen sc1
  v_mov_b64 v[32:33], 0
  v_smfmac_f32_16x16x64_bf16 v[24:27], v[0:3], a[208:215], v74
  ds_read_b128 v[64:67], v75 offset:56320
  v_mov_b64 v[34:35], 0
  v_smfmac_f32_16x16x64_bf16 v[24:27], v[4:7], a[224:231], v74
  v_cvt_pk_bf16_f32 v20, v20, v21
  v_cvt_pk_bf16_f32 v21, v22, v23
  v_bfi_b32 v20, 1, s72, v20
  v_smfmac_f32_16x16x64_bf16 v[24:27], v[8:11], a[232:239], v74
  buffer_store_dwordx2 v[20:21], v68, s[8:11], s74 offen sc1
  s_waitcnt lgkmcnt(2)
  v_smfmac_f32_16x16x64_bf16 v[32:35], v[0:3], v[44:51], v74
  s_waitcnt lgkmcnt(0)
  v_smfmac_f32_16x16x64_bf16 v[32:35], v[12:15], v[60:67], v74
  v_cvt_pk_bf16_f32 v24, v24, v25
  v_cvt_pk_bf16_f32 v25, v26, v27
  v_bfi_b32 v24, 1, s72, v24
  v_smfmac_f32_16x16x64_bf16 v[32:35], v[4:7], a[240:247], v74
  buffer_store_dwordx2 v[24:25], v68, s[8:11], s75 offen sc1
  v_smfmac_f32_16x16x64_bf16 v[32:35], v[8:11], a[248:255], v74
  v_mov_b64 v[18:19], v[72:73]
  s_nop 4
  v_cvt_pk_bf16_f32 v32, v32, v33
  v_cvt_pk_bf16_f32 v33, v34, v35
  v_bfi_b32 v32, 1, s72, v32
  buffer_store_dwordx2 v[32:33], v68, s[8:11], s76 offen sc1
  ds_read_b128 v[0:3], v76 offset:14848
  s_waitcnt lgkmcnt(0)
  ds_read_b64 v[16:17], v77 offset:264
  s_waitcnt lgkmcnt(0)
  ds_read_b128 v[64:67], v76 offset:23552
  s_waitcnt lgkmcnt(0)
  s_add_u32 s66, s66, 1
  s_xor_b32 s64, s64, 16384
  s_xor_b32 s65, s65, 16384
  s_add_u32 s58, s58, 655360
  s_add_u32 s59, s59, 655360
  s_add_u32 s70, s70, 655360
  s_add_u32 s68, s68, 655360
  s_mov_b32 m0, 11776
  s_add_u32 s85, s65, 7168
  v_xor_b32 v75, 0x8000, v75
  v_mov_b64 v[28:29], 0
  v_mov_b64 v[30:31], 0
  v_mov_b64 v[32:33], 0
  v_mov_b64 v[34:35], 0
  v_mov_b64 v[20:21], 0
  v_mov_b64 v[22:23], 0
  v_mov_b64 v[24:25], 0
  v_mov_b64 v[26:27], 0
  v_mov_b32 v68, 14880
  s_waitcnt vmcnt(0)
  buffer_load_dwordx4 v[52:55], v76, s[8:11], s60 offen offset:0 sc1
  buffer_load_dwordx4 v[56:59], v76, s[8:11], s60 offen offset:1024 sc1
  s_waitcnt lgkmcnt(0)
  s_waitcnt vmcnt(1)
  v_mfma_f32_16x16x32_bf16 v[4:7], v[0:3], v[52:55], 0
  v_bitop3_b32 v72, v52, v54, s72 bitop3:0x7e
  s_waitcnt vmcnt(0)
  v_mfma_f32_16x16x32_bf16 v[4:7], v[0:3], v[56:59], v[4:7]
  v_bitop3_b32 v73, v56, v58, s72 bitop3:0x7e
  v_bitop3_b32 v72, v72, v73, 1 bitop3:0xa8
  v_cmp_ne_u32 vcc, 0, v72
  s_cbranch_vccnz Cs1_h1r
  s_nop 2
  v_add_f32_dpp v4, v4, v4 row_ror:4 row_mask:0xf bank_mask:0xf
  v_add_f32_dpp v5, v5, v5 row_ror:4 row_mask:0xf bank_mask:0xf
  s_nop 0
  v_add_f32_dpp v4, v4, v4 row_ror:8 row_mask:0xf bank_mask:0xf
  v_add_f32_dpp v5, v5, v5 row_ror:8 row_mask:0xf bank_mask:0xf
  v_cvt_pk_bf16_f32 v4, v4, v5
  buffer_store_dword v4, v69, s[8:11], s62 offen sc1
  s_xor_b32 s62, s62, 16384
  buffer_store_dword v71, v69, s[8:11], s62 offen sc1
  s_xor_b32 s72, s72, 1
  s_branch Cs1_h2
Cs1_h1r:
  s_mov_b64 exec, vcc
  buffer_load_dwordx4 v[52:55], v76, s[8:11], s60 offen offset:0 sc1
  buffer_load_dwordx4 v[56:59], v76, s[8:11], s60 offen offset:1024 sc1
  s_mov_b64 exec, -1
  s_add_u32 s67, s67, 1
  s_waitcnt vmcnt(1)
  v_mfma_f32_16x16x32_bf16 v[4:7], v[0:3], v[52:55], 0
  v_bitop3_b32 v72, v52, v54, s72 bitop3:0x7e
  s_waitcnt vmcnt(0)
  v_mfma_f32_16x16x32_bf16 v[4:7], v[0:3], v[56:59], v[4:7]
  v_bitop3_b32 v73, v56, v58, s72 bitop3:0x7e
  v_bitop3_b32 v72, v72, v73, 1 bitop3:0xa8
  v_cmp_ne_u32 vcc, 0, v72
  s_cbranch_vccz Cs1_h1p
Cs1_h1s:
  s_mov_b64 exec, vcc
  buffer_load_dwordx4 v[52:55], v76, s[8:11], s60 offen offset:0 sc1
  buffer_load_dwordx4 v[56:59], v76, s[8:11], s60 offen offset:1024 sc1
  s_mov_b64 exec, -1
  s_add_u32 s67, s67, 1
  s_waitcnt vmcnt(1)
  v_mfma_f32_16x16x32_bf16 v[4:7], v[0:3], v[52:55], 0
  v_bitop3_b32 v72, v52, v54, s72 bitop3:0x7e
  s_waitcnt vmcnt(0)
  v_mfma_f32_16x16x32_bf16 v[4:7], v[0:3], v[56:59], v[4:7]
  v_bitop3_b32 v73, v56, v58, s72 bitop3:0x7e
  v_bitop3_b32 v72, v72, v73, 1 bitop3:0xa8
  v_cmp_ne_u32 vcc, 0, v72
  s_cbranch_vccz Cs1_h1p
  s_cmp_lt_u32 s67, 131072
  s_cbranch_scc1 Cs1_h1s
Cs1_h1p:
  s_nop 2
  v_add_f32_dpp v4, v4, v4 row_ror:4 row_mask:0xf bank_mask:0xf
  v_add_f32_dpp v5, v5, v5 row_ror:4 row_mask:0xf bank_mask:0xf
  s_nop 0
  v_add_f32_dpp v4, v4, v4 row_ror:8 row_mask:0xf bank_mask:0xf
  v_add_f32_dpp v5, v5, v5 row_ror:8 row_mask:0xf bank_mask:0xf
  v_cvt_pk_bf16_f32 v4, v4, v5
  buffer_store_dword v4, v69, s[8:11], s62 offen sc1
  s_xor_b32 s62, s62, 16384
  buffer_store_dword v71, v69, s[8:11], s62 offen sc1
  s_xor_b32 s72, s72, 1
  s_branch Cs1_h2
Cs1_rec:
  s_nop 7
  s_waitcnt vmcnt(0) lgkmcnt(0)
  v_max3_u32 v72, v0, v1, v2
  v_max3_u32 v72, v72, v3, v4
  v_max3_u32 v72, v72, v5, v6
  v_max3_u32 v72, v72, v7, v8
  v_max3_u32 v72, v72, v9, v10
  v_max3_u32 v72, v72, v11, v12
  v_max3_u32 v72, v72, v13, v14
  v_max3_u32 v72, v72, v15, v16
  v_max3_u32 v72, v72, v17, v18
  v_max_u32 v72, v72, v19
  v_cmp_eq_u32 vcc, -1, v72
  s_cbranch_vccz Cs1_recok
  s_barrier
  v_mov_b64 v[20:21], 0
  v_mov_b64 v[22:23], 0
  v_mov_b64 v[24:25], 0
  v_mov_b64 v[26:27], 0
  v_mov_b64 v[28:29], 0
  v_mov_b64 v[30:31], 0
  v_mov_b64 v[32:33], 0
  v_mov_b64 v[34:35], 0
  s_waitcnt lgkmcnt(0)
  s_barrier
  ds_read_b128 v[0:3], v76 offset:4608
  s_waitcnt lgkmcnt(0)
  v_smfmac_f32_16x16x64_bf16 v[20:23], v[0:3], v[80:87], v74
  v_smfmac_f32_16x16x64_bf16 v[24:27], v[0:3], v[88:95], v74
  ds_read_b128 v[60:63], v76 offset:20480
  ds_read_b128 v[64:67], v76 offset:21504
  s_waitcnt lgkmcnt(0)
  v_smfmac_f32_16x16x64_bf16 v[28:31], v[0:3], v[60:67], v74
  ds_read_b128 v[60:63], v76 offset:22528
  ds_read_b128 v[64:67], v76 offset:23552
  s_waitcnt lgkmcnt(0)
  v_smfmac_f32_16x16x64_bf16 v[32:35], v[0:3], v[60:67], v74
  ds_read_b128 v[4:7], v76 offset:5632
  s_waitcnt lgkmcnt(0)
  v_smfmac_f32_16x16x64_bf16 v[20:23], v[4:7], v[96:103], v74
  v_smfmac_f32_16x16x64_bf16 v[24:27], v[4:7], v[104:111], v74
  ds_read_b128 v[60:63], v76 offset:36864
  ds_read_b128 v[64:67], v76 offset:37888
  s_waitcnt lgkmcnt(0)
  v_smfmac_f32_16x16x64_bf16 v[28:31], v[4:7], v[60:67], v74
  ds_read_b128 v[60:63], v76 offset:38912
  ds_read_b128 v[64:67], v76 offset:39936
  s_waitcnt lgkmcnt(0)
  v_smfmac_f32_16x16x64_bf16 v[32:35], v[4:7], v[60:67], v74
  ds_read_b128 v[8:11], v76 offset:6656
  s_waitcnt lgkmcnt(0)
  v_smfmac_f32_16x16x64_bf16 v[20:23], v[8:11], v[112:119], v74
  v_smfmac_f32_16x16x64_bf16 v[24:27], v[8:11], v[120:127], v74
  v_smfmac_f32_16x16x64_bf16 v[28:31], v[8:11], v[208:215], v74
  v_smfmac_f32_16x16x64_bf16 v[32:35], v[8:11], v[216:223], v74
  ds_read_b128 v[12:15], v76 offset:7680
  s_waitcnt lgkmcnt(0)
  v_smfmac_f32_16x16x64_bf16 v[20:23], v[12:15], v[128:135], v74
  v_smfmac_f32_16x16x64_bf16 v[24:27], v[12:15], v[136:143], v74
  v_smfmac_f32_16x16x64_bf16 v[28:31], v[12:15], v[224:231], v74
  v_smfmac_f32_16x16x64_bf16 v[32:35], v[12:15], v[232:239], v74
  ds_read_b128 v[8:11], v76 offset:8704
  s_waitcnt lgkmcnt(0)
  v_smfmac_f32_16x16x64_bf16 v[20:23], v[8:11], v[144:151], v74
  v_smfmac_f32_16x16x64_bf16 v[24:27], v[8:11], v[152:159], v74
  ds_read_b128 v[60:63], v76 offset:53248
  ds_read_b128 v[64:67], v76 offset:54272
  s_waitcnt lgkmcnt(0)
  v_smfmac_f32_16x16x64_bf16 v[28:31], v[8:11], v[60:67], v74
  ds_read_b128 v[60:63], v76 offset:55296
  ds_read_b128 v[64:67], v76 offset:56320
  s_waitcnt lgkmcnt(0)
  v_smfmac_f32_16x16x64_bf16 v[32:35], v[8:11], v[60:67], v74
  ds_read_b128 v[0:3], v76 offset:9728
  s_waitcnt lgkmcnt(0)
  v_smfmac_f32_16x16x64_bf16 v[20:23], v[0:3], v[160:167], v74
  v_smfmac_f32_16x16x64_bf16 v[24:27], v[0:3], v[168:175], v74
  ds_read_b128 v[60:63], v75 offset:20480
  ds_read_b128 v[64:67], v75 offset:21504
  s_waitcnt lgkmcnt(0)
  v_smfmac_f32_16x16x64_bf16 v[28:31], v[0:3], v[60:67], v74
  ds_read_b128 v[60:63], v75 offset:22528
  ds_read_b128 v[64:67], v75 offset:23552
  s_waitcnt lgkmcnt(0)
  v_smfmac_f32_16x16x64_bf16 v[32:35], v[0:3], v[60:67], v74
  ds_read_b128 v[16:19], v76 offset:10752
  ds_read_b128 v[60:63], v75 offset:4096
  ds_read_b128 v[64:67], v75 offset:5120
  s_waitcnt lgkmcnt(0)
  v_smfmac_f32_16x16x64_bf16 v[20:23], v[16:19], v[60:67], v74
  ds_read_b128 v[60:63], v75 offset:6144
  ds_read_b128 v[64:67], v75 offset:7168
  s_waitcnt lgkmcnt(0)
  v_smfmac_f32_16x16x64_bf16 v[24:27], v[16:19], v[60:67], v74
  v_smfmac_f32_16x16x64_bf16 v[28:31], v[16:19], v[240:247], v74
  v_smfmac_f32_16x16x64_bf16 v[32:35], v[16:19], v[248:255], v74
  ds_read_b128 v[4:7], v76 offset:11776
  s_waitcnt lgkmcnt(0)
  v_smfmac_f32_16x16x64_bf16 v[20:23], v[4:7], v[176:183], v74
  v_smfmac_f32_16x16x64_bf16 v[24:27], v[4:7], v[184:191], v74
  v_smfmac_f32_16x16x64_bf16 v[28:31], v[4:7], a[0:7], v74
  v_smfmac_f32_16x16x64_bf16 v[32:35], v[4:7], a[8:15], v74
  ds_read_b128 v[12:15], v76 offset:12800
  s_waitcnt lgkmcnt(0)
  v_smfmac_f32_16x16x64_bf16 v[20:23], v[12:15], v[192:199], v74
  v_smfmac_f32_16x16x64_bf16 v[24:27], v[12:15], v[200:207], v74
  v_smfmac_f32_16x16x64_bf16 v[28:31], v[12:15], a[16:23], v74
  v_smfmac_f32_16x16x64_bf16 v[32:35], v[12:15], a[24:31], v74
  v_add_f32 v20, v20, v22
  v_add_f32 v21, v21, v23
  v_add_f32 v24, v24, v26
  v_cvt_pk_bf16_f32 v22, v20, v24
  ds_write_b32 v79, v22 offset:0
  v_add_f32 v25, v25, v27
  v_cvt_pk_bf16_f32 v23, v21, v25
  ds_write_b32 v79, v23 offset:576
  v_add_f32 v28, v28, v30
  v_add_f32 v29, v29, v31
  s_waitcnt lgkmcnt(0)
  s_nop 1
  s_branch Cs1_recok
Cs1_mx:
  s_waitcnt lgkmcnt(0)
  s_barrier
  buffer_load_dwordx4 v[52:55], v76, s[8:11], s59 offen offset:0 sc1
  buffer_load_dwordx4 v[0:3], v76, s[8:11], s58 offen offset:0 sc1
  ds_read_b128 v[20:23], v77 offset:0
  ds_read_b128 v[28:31], v77 offset:256
  buffer_load_dwordx4 v[56:59], v76, s[8:11], s59 offen offset:1024 sc1
  buffer_load_dwordx4 v[4:7], v76, s[8:11], s58 offen offset:1024 sc1
  ds_read_b128 v[24:27], v77 offset:128
  ds_read_b128 v[32:35], v77 offset:384
  s_waitcnt vmcnt(2) lgkmcnt(3)
  v_mfma_f32_16x16x32_bf16 v[8:11], v[0:3], v[20:23], 0
  s_waitcnt vmcnt(0) lgkmcnt(1)
  v_mfma_f32_16x16x32_bf16 v[8:11], v[4:7], v[24:27], v[8:11]
  v_mfma_f32_16x16x32_bf16 v[12:15], v[28:31], v[20:23], 0
  s_waitcnt lgkmcnt(0)
  v_mfma_f32_16x16x32_bf16 v[12:15], v[32:35], v[24:27], v[12:15]
  v_add_f32_dpp v8, v10, v8 quad_perm:[2,3,0,1] row_mask:0xf bank_mask:0xf
  v_add_f32_dpp v9, v11, v9 quad_perm:[2,3,0,1] row_mask:0xf bank_mask:0xf
  s_nop 0
  v_mov_b32_dpp v8, v8 quad_perm:[0,1,0,1] row_mask:0xf bank_mask:0xf
  v_mov_b32_dpp v9, v9 quad_perm:[0,1,0,1] row_mask:0xf bank_mask:0xf
  s_nop 1
  v_add_f32_dpp v12, v14, v12 quad_perm:[2,3,0,1] row_mask:0xf bank_mask:0xf
  v_add_f32_dpp v13, v15, v13 quad_perm:[2,3,0,1] row_mask:0xf bank_mask:0xf
  s_nop 0
  v_mov_b32_dpp v12, v12 quad_perm:[0,1,0,1] row_mask:0xf bank_mask:0xf
  v_mov_b32_dpp v13, v13 quad_perm:[0,1,0,1] row_mask:0xf bank_mask:0xf
  v_mul_f32 v12, s69, v12
  ds_write_b32 v78, v8 offset:8708
  v_mul_f32 v13, s69, v13
  ds_write_b32 v78, v9 offset:8772
  s_waitcnt lgkmcnt(0)
  s_barrier
  ds_read_b128 v[36:39], v78 offset:8704
  ds_read_b128 v[40:43], v78 offset:8768
  s_waitcnt lgkmcnt(0)
  s_barrier
  v_max_f32 v16, v36, v37
  v_max3_f32 v16, v16, v38, v39
  v_max3_f32 v16, v16, v40, v41
  v_max3_f32 v16, v16, v42, v43
  v_max3_f32 v16, v16, v12, v13
  v_mov_b32 v17, v16
  s_nop 1
  v_permlane16_swap_b32 v16, v17
  v_max_f32 v16, v16, v17
  v_mov_b32 v17, v16
  s_nop 1
  v_permlane32_swap_b32 v16, v17
  v_max_f32 v16, v16, v17
  v_sub_f32 v36, v36, v16
  v_sub_f32 v37, v37, v16
  v_sub_f32 v38, v38, v16
  v_sub_f32 v39, v39, v16
  v_sub_f32 v40, v40, v16
  v_sub_f32 v41, v41, v16
  v_sub_f32 v42, v42, v16
  v_sub_f32 v43, v43, v16
  v_sub_f32 v12, v12, v16
  v_sub_f32 v13, v13, v16
  v_exp_f32 v36, v36
  v_exp_f32 v37, v37
  v_exp_f32 v38, v38
  v_exp_f32 v39, v39
  v_exp_f32 v40, v40
  v_exp_f32 v41, v41
  v_exp_f32 v42, v42
  v_exp_f32 v43, v43
  v_exp_f32 v12, v12
  v_exp_f32 v13, v13
  v_cvt_pk_bf16_f32 v32, v36, v40
  v_cvt_pk_bf16_f32 v33, v37, v41
  v_cvt_pk_bf16_f32 v34, v38, v42
  v_cvt_pk_bf16_f32 v35, v39, v43
  v_cvt_pk_bf16_f32 v28, v12, v13
  v_cvt_pk_bf16_f32 v31, v12, v13
  v_mov_b32 v29, 0
  v_mov_b32 v30, 0
  v_mfma_f32_16x16x32_bf16 v[8:11], v[32:35], v[68:71], 0
  v_mfma_f32_16x16x32_bf16 v[0:3], v[32:35], v[52:55], 0
  v_mfma_f32_16x16x32_bf16 v[4:7], v[32:35], v[56:59], 0
  v_mfma_f32_16x16x16_bf16 v[8:11], v[28:29], v[68:69], v[8:11]
  v_mfma_f32_16x16x16_bf16 v[0:3], v[28:29], v[72:73], v[0:3]
  v_mfma_f32_16x16x16_bf16 v[4:7], v[30:31], v[72:73], v[4:7]
  ds_read_b128 v[52:55], v75 offset:36864
  v_rcp_f32 v10, v8
  v_rcp_f32 v11, v9
  v_mul_f32 v0, v10, v0
  v_mul_f32 v1, v11, v1
  v_max3_f32 v8, v8, v9, v10
  v_mul_f32 v4, v10, v4
  v_mul_f32 v5, v11, v5
  v_cvt_pk_bf16_f32 v2, v0, v4
  ds_write_b32 v79, v2 offset:8704
  v_cvt_pk_bf16_f32 v3, v1, v5
  ds_write_b32 v79, v3 offset:9280
  ds_read_b128 v[12:15], v78 offset:8768
  ds_read_b128 v[56:59], v75 offset:37888
  v_mov_b64 v[16:17], 0
  v_mov_b64 v[18:19], 0
  v_mov_b64 v[20:21], 0
  v_mov_b64 v[22:23], 0
  v_mov_b64 v[24:25], 0
  v_mov_b64 v[26:27], 0
  s_branch Cs1_mxok
Cs1_last:
  ds_read_b128 v[4:7], v76 offset:5632
  ds_read_b128 v[12:15], v76 offset:7680
  ds_read_b128 v[44:47], v76 offset:36864
  ds_read_b128 v[48:51], v76 offset:37888
  s_nop 5
  v_mov_b64 v[20:21], 0
  v_mov_b64 v[22:23], 0
  v_mov_b64 v[24:25], 0
  v_mov_b64 v[26:27], 0
  s_waitcnt lgkmcnt(4)
  v_smfmac_f32_16x16x64_bf16 v[28:31], v[0:3], v[36:43], v74
  ds_read_b128 v[36:39], v76 offset:38912
  ds_read_b128 v[40:43], v76 offset:39936
  v_smfmac_f32_16x16x64_bf16 v[32:35], v[0:3], v[60:67], v74
  s_waitcnt lgkmcnt(5)
  v_smfmac_f32_16x16x64_bf16 v[20:23], v[0:3], a[32:39], v74
  ds_read_b128 v[60:63], v76 offset:53248
  ds_read_b128 v[64:67], v76 offset:54272
  v_smfmac_f32_16x16x64_bf16 v[24:27], v[0:3], a[40:47], v74
  s_waitcnt lgkmcnt(4)
  v_smfmac_f32_16x16x64_bf16 v[20:23], v[4:7], a[48:55], v74
  buffer_store_dwordx4 v[16:19], v76, s[8:11], s68 offen sc1
  v_smfmac_f32_16x16x64_bf16 v[24:27], v[4:7], a[56:63], v74
  v_smfmac_f32_16x16x64_bf16 v[28:31], v[4:7], v[44:51], v74
  s_waitcnt lgkmcnt(2)
  v_smfmac_f32_16x16x64_bf16 v[20:23], v[8:11], a[64:71], v74
  ds_read_b128 v[44:47], v76 offset:55296
  ds_read_b128 v[48:51], v76 offset:56320
  v_smfmac_f32_16x16x64_bf16 v[24:27], v[8:11], a[72:79], v74
  v_smfmac_f32_16x16x64_bf16 v[32:35], v[4:7], v[36:43], v74
  v_smfmac_f32_16x16x64_bf16 v[28:31], v[8:11], v[208:215], v74
  ds_read_b128 v[36:39], v75 offset:20480
  ds_read_b128 v[40:43], v75 offset:21504
  v_smfmac_f32_16x16x64_bf16 v[32:35], v[8:11], v[216:223], v74
  v_smfmac_f32_16x16x64_bf16 v[20:23], v[12:15], a[80:87], v74
  v_smfmac_f32_16x16x64_bf16 v[24:27], v[12:15], a[88:95], v74
  v_smfmac_f32_16x16x64_bf16 v[28:31], v[12:15], v[224:231], v74
  v_smfmac_f32_16x16x64_bf16 v[32:35], v[12:15], v[232:239], v74
  s_waitcnt vmcnt(1)
  s_barrier
Cs1_lastr:
  ds_read_b128 v[8:11], v76 offset:8704
  ds_read_b128 v[0:3], v76 offset:9728
  ds_read_b128 v[16:19], v76 offset:10752
  ds_read_b128 v[4:7], v76 offset:11776
  ds_read_b128 v[12:15], v76 offset:12800
  s_waitcnt lgkmcnt(3)
  v_max3_u32 v72, v0, v1, v2
  s_waitcnt lgkmcnt(1)
  v_max3_u32 v72, v72, v3, v4
  v_max3_u32 v72, v72, v5, v6
  v_max3_u32 v72, v72, v7, v8
  v_max3_u32 v72, v72, v9, v10
  s_waitcnt lgkmcnt(0)
  v_max3_u32 v72, v72, v11, v12
  v_max3_u32 v72, v72, v13, v14
  v_max3_u32 v72, v72, v15, v16
  v_max3_u32 v72, v72, v17, v18
  v_max_u32 v72, v72, v19
  v_cmp_eq_u32 vcc, -1, v72
  s_cbranch_vccnz Cs1_lastp
Cs1_lastg:
  v_smfmac_f32_16x16x64_bf16 v[28:31], v[8:11], v[60:67], v74
  ds_read_b128 v[60:63], v75 offset:22528
  ds_read_b128 v[64:67], v75 offset:23552
  v_smfmac_f32_16x16x64_bf16 v[32:35], v[8:11], v[44:51], v74
  v_smfmac_f32_16x16x64_bf16 v[28:31], v[0:3], v[36:43], v74
  v_smfmac_f32_16x16x64_bf16 v[28:31], v[16:19], v[240:247], v74
  v_smfmac_f32_16x16x64_bf16 v[28:31], v[4:7], a[0:7], v74
  v_smfmac_f32_16x16x64_bf16 v[28:31], v[12:15], a[16:23], v74
  v_smfmac_f32_16x16x64_bf16 v[32:35], v[16:19], v[248:255], v74
  v_smfmac_f32_16x16x64_bf16 v[32:35], v[4:7], a[8:15], v74
  s_waitcnt lgkmcnt(0)
  v_smfmac_f32_16x16x64_bf16 v[32:35], v[12:15], a[24:31], v74
  v_smfmac_f32_16x16x64_bf16 v[32:35], v[0:3], v[60:67], v74
  v_smfmac_f32_16x16x64_bf16 v[20:23], v[8:11], a[96:103], v74
  v_smfmac_f32_16x16x64_bf16 v[20:23], v[0:3], a[112:119], v74
  v_add_f32 v28, v28, v30
  v_add_f32 v32, v32, v34
  v_cvt_pk_bf16_f32 v30, v28, v32
  v_smfmac_f32_16x16x64_bf16 v[20:23], v[16:19], a[128:135], v74
  ds_write_b32 v79, v30 offset:256
  v_add_f32 v29, v29, v31
  v_add_f32 v33, v33, v35
  v_cvt_pk_bf16_f32 v31, v29, v33
  v_smfmac_f32_16x16x64_bf16 v[20:23], v[4:7], a[144:151], v74
  ds_write_b32 v79, v31 offset:832
  v_smfmac_f32_16x16x64_bf16 v[20:23], v[12:15], a[160:167], v74
  v_smfmac_f32_16x16x64_bf16 v[24:27], v[8:11], a[104:111], v74
  v_smfmac_f32_16x16x64_bf16 v[24:27], v[0:3], a[120:127], v74
  v_smfmac_f32_16x16x64_bf16 v[24:27], v[16:19], a[136:143], v74
  s_waitcnt lgkmcnt(0)
  s_barrier
  ds_read_b64 v[52:53], v77 offset:264
  v_add_f32 v20, v20, v22
  v_smfmac_f32_16x16x64_bf16 v[24:27], v[4:7], a[152:159], v74
  v_add_f32 v21, v21, v23
  v_smfmac_f32_16x16x64_bf16 v[24:27], v[12:15], a[168:175], v74
  v_cvt_pk_bf16_f32 v54, v20, v21
  s_add_u32 s68, s68, 655360
  s_nop 3
  v_add_f32 v24, v24, v26
  v_add_f32 v25, v25, v27
  v_cvt_pk_bf16_f32 v55, v24, v25
  s_waitcnt lgkmcnt(0)
  buffer_store_dwordx4 v[52:55], v76, s[8:11], s68 offen sc1
  s_branch Cs1_done
Cs1_lastp:
  s_add_u32 s72, s72, 2
  s_cmp_ge_u32 s72, 131072
  s_cbranch_scc1 Cs1_lastg
  s_barrier
  buffer_load_dwordx4 v76, s[8:11], s85 offen offset:0 sc1 lds
  s_waitcnt vmcnt(0)
  s_barrier
  s_branch Cs1_lastr
Cs1_done:
  s_branch L_cexit
L_w6:
  v_mov_b64 v[20:21], 0
  v_mov_b64 v[22:23], 0
  v_mov_b64 v[24:25], 0
  v_mov_b64 v[26:27], 0
  v_mov_b64 v[28:29], 0
  v_mov_b64 v[30:31], 0
  v_mov_b64 v[32:33], 0
  v_mov_b64 v[34:35], 0
  s_mov_b32 s78, 0x3f803f80
  s_mov_b32 s79, s78
  s_mov_b32 s65, 360448
  s_mov_b32 m0, 15872
  s_lshl_b32 s71, s53, 2
  s_add_u32 s71, s71, 128
  s_movk_i32 s56, 0x1000
  v_lshlrev_b32 v73, 2, v76
  v_mov_b32 v72, 0
  s_mov_b64 s[16:17], s[8:9]
  s_mov_b32 s18, 268435456
  s_mov_b32 s19, 0x20000
  s_getpc_b64 s[20:21]
Cs2_pc:
  s_add_u32 s20, s20, (Cs2_last - Cs2_pc)
  s_addc_u32 s21, s21, 0
  v_mov_b32 v68, 14880
  buffer_load_dwordx4 v[52:55], v76, s[8:11], s59 offen offset:0 sc1
  buffer_load_dwordx4 v[56:59], v76, s[8:11], s59 offen offset:1024 sc1
  ds_read_b128 v[36:39], v76 offset:24576
  ds_read_b128 v[40:43], v76 offset:25600
  ds_read_b128 v[60:63], v76 offset:26624
  ds_read_b128 v[64:67], v76 offset:27648
  ds_read_b128 v[0:3], v76 offset:4608
  ds_read_b128 v[4:7], v76 offset:5632
  ds_read_b128 v[8:11], v76 offset:6656
  ds_read_b128 v[12:15], v76 offset:7680
  s_waitcnt lgkmcnt(0)
  s_cmp_eq_u32 s66, 1
  s_branch Cs2_top2
.p2align 6
Cs2_h2:
  ds_read_b128 v[36:39], v76 offset:24576
  s_cmp_eq_u32 s66, 62
  s_cselect_b64 s[16:17], s[20:21], s[16:17]
  s_cselect_b32 s18, (Cs2_done - Cs2_last), s18
  s_cselect_b32 s70, 0, s70
  s_cmp_eq_u32 s66, 63
  s_cselect_b32 s59, 268435456, s59
  s_cselect_b32 s58, 268435456, s58
  ds_read_b128 v[40:43], v76 offset:25600
  v_mov_b64 v[20:21], 0
  v_mov_b64 v[22:23], 0
  v_mov_b64 v[24:25], 0
  v_mov_b64 v[26:27], 0
  v_mov_b32 v68, 14880
  v_lshlrev_b32 v73, 2, v76
  buffer_load_dwordx4 v[52:55], v76, s[8:11], s59 offen offset:0 sc1
  buffer_load_dwordx4 v[56:59], v76, s[8:11], s59 offen offset:1024 sc1
  s_waitcnt vmcnt(0)
  s_mov_b64 vcc, -1
Cs2_h2r:
  s_mov_b64 exec, vcc
  buffer_load_dwordx4 v[12:15], v76, s[8:11], s65 offen offset:3072 sc1
  buffer_load_dwordx4 v[0:3], v76, s[8:11], s85 offen offset:0 sc1
  s_mov_b64 exec, -1
  s_add_u32 s67, s67, 1
  s_cmp_lt_u32 s67, 131072
  s_cselect_b32 s54, -2, -1
  s_waitcnt vmcnt(1)
  v_max3_u32 v72, v12, v13, v14
  s_waitcnt vmcnt(0)
  v_max3_u32 v72, v72, v15, v0
  v_max3_u32 v72, v72, v1, v2
  v_max_u32 v72, v72, v3
  v_cmp_lt_u32 vcc, s54, v72
  s_cbranch_vccnz Cs2_h2r
  ds_write_b128 v76, v[12:15] offset:7680
  ds_write_b128 v76, v[0:3] offset:12800
Cs2_h2w:
  s_cmp_eq_u32 s66, 63
  s_waitcnt lgkmcnt(0)
  s_barrier
  ds_read_b128 v[0:3], v76 offset:4608
Cs2_top2:
  v_smfmac_f32_16x16x64_bf16 v[20:23], v[12:15], v[128:135], v74
  s_cbranch_scc1 Cs2_last
  v_smfmac_f32_16x16x64_bf16 v[24:27], v[12:15], v[136:143], v74
  buffer_load_dwordx4 v[44:47], v76, s[8:11], s58 offen offset:0 sc1
  s_mov_b32 m0, 15872
  v_smfmac_f32_16x16x64_bf16 v[28:31], v[12:15], v[224:231], v74
  buffer_load_dwordx4 v[48:51], v76, s[8:11], s58 offen offset:1024 sc1
  v_smfmac_f32_16x16x64_bf16 v[32:35], v[12:15], v[232:239], v74
  ds_read_b128 v[4:7], v76 offset:5632
  s_waitcnt lgkmcnt(1)
  v_smfmac_f32_16x16x64_bf16 v[20:23], v[0:3], v[80:87], v74
  ds_read_b128 v[8:11], v76 offset:6656
  v_smfmac_f32_16x16x64_bf16 v[28:31], v[0:3], v[36:43], v74
  ds_read_b128 v[36:39], v76 offset:40960
  v_smfmac_f32_16x16x64_bf16 v[24:27], v[0:3], v[88:95], v74
  buffer_store_dwordx4 v[16:19], v76, s[8:11], s68 offen sc1
  ds_read_b128 v[40:43], v76 offset:41984
  v_smfmac_f32_16x16x64_bf16 v[32:35], v[0:3], v[60:67], v74
  buffer_load_dword v73, s[16:19], s70 offen lds
  ds_read_b128 v[60:63], v76 offset:43008
  s_waitcnt lgkmcnt(4)
  v_smfmac_f32_16x16x64_bf16 v[20:23], v[4:7], v[96:103], v74
  ds_read_b128 v[64:67], v76 offset:44032
  v_smfmac_f32_16x16x64_bf16 v[24:27], v[4:7], v[104:111], v74
  s_waitcnt vmcnt(4)
  s_waitcnt lgkmcnt(4)
  v_smfmac_f32_16x16x64_bf16 v[20:23], v[8:11], v[112:119], v74
  s_barrier
  ds_read_b128 v[12:15], v76 offset:8704
  s_waitcnt lgkmcnt(3)
  v_smfmac_f32_16x16x64_bf16 v[28:31], v[4:7], v[36:43], v74
  ds_read_b128 v[36:39], v76 offset:57344
  v_smfmac_f32_16x16x64_bf16 v[24:27], v[8:11], v[120:127], v74
  ds_read_b128 v[40:43], v76 offset:58368
  s_waitcnt lgkmcnt(3)
  v_smfmac_f32_16x16x64_bf16 v[32:35], v[4:7], v[60:67], v74
  ds_read_b128 v[0:3], v76 offset:9728
  v_smfmac_f32_16x16x64_bf16 v[28:31], v[8:11], v[208:215], v74
  ds_read_b128 v[60:63], v76 offset:59392
  v_smfmac_f32_16x16x64_bf16 v[32:35], v[8:11], v[216:223], v74
  ds_read_b128 v[64:67], v76 offset:60416
  s_waitcnt lgkmcnt(5)
  v_smfmac_f32_16x16x64_bf16 v[20:23], v[12:15], v[144:151], v74
  s_barrier
  ds_read_b128 v[4:7], v76 offset:11776
  s_waitcnt lgkmcnt(4)
  v_smfmac_f32_16x16x64_bf16 v[28:31], v[12:15], v[36:43], v74
  ds_read_b128 v[8:11], v76 offset:12800
  ds_read_b128 v[36:39], v75 offset:8192
  v_smfmac_f32_16x16x64_bf16 v[24:27], v[12:15], v[152:159], v74
  ds_read_b128 v[16:19], v76 offset:10752
  s_waitcnt lgkmcnt(6)
  v_smfmac_f32_16x16x64_bf16 v[20:23], v[0:3], v[160:167], v74
  ds_read_b128 v[40:43], v75 offset:9216
  s_waitcnt lgkmcnt(5)
  v_smfmac_f32_16x16x64_bf16 v[32:35], v[12:15], v[60:67], v74
  ds_read_b128 v[60:63], v75 offset:10240
  v_smfmac_f32_16x16x64_bf16 v[24:27], v[0:3], v[168:175], v74
  ds_read_b128 v[64:67], v75 offset:11264
  s_waitcnt lgkmcnt(6)
  v_smfmac_f32_16x16x64_bf16 v[20:23], v[4:7], v[176:183], v74
  s_waitcnt lgkmcnt(5)
  v_smfmac_f32_16x16x64_bf16 v[20:23], v[8:11], v[192:199], v74
  s_waitcnt lgkmcnt(2)
  v_smfmac_f32_16x16x64_bf16 v[20:23], v[16:19], v[36:43], v74
  ds_read_b128 v[36:39], v75 offset:24576
  v_smfmac_f32_16x16x64_bf16 v[24:27], v[4:7], v[184:191], v74
  ds_read_b128 v[40:43], v75 offset:25600
  s_waitcnt lgkmcnt(2)
  v_smfmac_f32_16x16x64_bf16 v[24:27], v[16:19], v[60:67], v74
  ds_read_b128 v[60:63], v75 offset:26624
  v_add_f32 v20, v20, v22
  v_smfmac_f32_16x16x64_bf16 v[24:27], v[8:11], v[200:207], v74
  ds_read_b128 v[64:67], v75 offset:27648
  v_add_f32 v21, v21, v23
  v_smfmac_f32_16x16x64_bf16 v[28:31], v[16:19], v[240:247], v74
  v_mov_b64 v[70:71], s[78:79]
  v_smfmac_f32_16x16x64_bf16 v[28:31], v[4:7], a[0:7], v74
  s_waitcnt lgkmcnt(2)
  v_add_f32 v24, v24, v26
  v_smfmac_f32_16x16x64_bf16 v[28:31], v[0:3], v[36:43], v74
  ds_read_b128 v[36:39], v68
  v_cvt_pk_bf16_f32 v22, v20, v24
  v_smfmac_f32_16x16x64_bf16 v[28:31], v[8:11], a[16:23], v74
  ds_read_b128 v[40:43], v68
  ds_write_b32 v79, v22 offset:0
  s_waitcnt lgkmcnt(3)
  v_add_f32 v25, v25, v27
  v_cvt_pk_bf16_f32 v23, v21, v25
  v_smfmac_f32_16x16x64_bf16 v[32:35], v[0:3], v[60:67], v74
  ds_write_b32 v79, v23 offset:576
  v_cmp_u_f32 vcc, v20, v21
  v_smfmac_f32_16x16x64_bf16 v[32:35], v[16:19], v[248:255], v74
  v_add_f32 v28, v28, v30
  v_smfmac_f32_16x16x64_bf16 v[32:35], v[4:7], a[8:15], v74
  v_add_f32 v29, v29, v31
  v_smfmac_f32_16x16x64_bf16 v[32:35], v[8:11], a[24:31], v74
  s_cbranch_vccnz Cs2_rec
Cs2_recok:
  s_waitcnt lgkmcnt(3)
  v_smfmac_f32_16x16x64_bf16 v[36:39], v[16:19], a[128:135], v74
  s_waitcnt lgkmcnt(0)
  s_barrier
  ds_read_b128 v[60:63], v77
  v_smfmac_f32_16x16x64_bf16 v[40:43], v[16:19], a[136:143], v74
  ds_read_b128 v[64:67], v77 offset:128
  v_add_f32 v32, v32, v34
  v_cvt_pk_bf16_f32 v30, v28, v32
  v_smfmac_f32_16x16x64_bf16 v[36:39], v[0:3], a[112:119], v74
  ds_write_b32 v79, v30 offset:256
  v_add_f32 v33, v33, v35
  v_cvt_pk_bf16_f32 v31, v29, v33
  v_smfmac_f32_16x16x64_bf16 v[40:43], v[0:3], a[120:127], v74
  ds_write_b32 v79, v31 offset:832
  v_xor_b32 v75, 0x8000, v75
  v_smfmac_f32_16x16x64_bf16 v[36:39], v[4:7], a[144:151], v74
  ds_read_b128 v[0:3], v76 offset:4608
  v_mov_b32 v29, 0
  v_smfmac_f32_16x16x64_bf16 v[40:43], v[4:7], a[152:159], v74
  s_waitcnt vmcnt(2) lgkmcnt(3)
  v_mov_b32 v30, 0
  v_mfma_f32_16x16x32_bf16 v[44:47], v[44:47], v[60:63], 0
  ds_read_b128 v[4:7], v76 offset:5632
  s_waitcnt lgkmcnt(2)
  v_mfma_f32_16x16x32_bf16 v[44:47], v[48:51], v[64:67], v[44:47]
  s_barrier
  v_smfmac_f32_16x16x64_bf16 v[36:39], v[8:11], a[160:167], v74
  ds_read_b128 v[20:23], v77 offset:256
  ds_read_b128 v[24:27], v77 offset:384
  v_smfmac_f32_16x16x64_bf16 v[40:43], v[8:11], a[168:175], v74
  ds_read_b128 v[8:11], v76 offset:6656
  v_add_f32_dpp v72, v46, v44 quad_perm:[2,3,0,1] row_mask:0xf bank_mask:0xf
  v_add_f32_dpp v73, v47, v45 quad_perm:[2,3,0,1] row_mask:0xf bank_mask:0xf
  v_smfmac_f32_16x16x64_bf16 v[36:39], v[12:15], a[96:103], v74
  s_waitcnt lgkmcnt(4)
  v_exp_f32_dpp v72, v72 quad_perm:[0,1,0,1] row_mask:0xf bank_mask:0xf
  v_smfmac_f32_16x16x64_bf16 v[40:43], v[12:15], a[104:111], v74
  ds_read_b128 v[12:15], v76 offset:7680
  v_exp_f32_dpp v73, v73 quad_perm:[0,1,0,1] row_mask:0xf bank_mask:0xf
  v_smfmac_f32_16x16x64_bf16 v[36:39], v[0:3], a[32:39], v74
  s_waitcnt lgkmcnt(2)
  v_cvt_pk_bf16_f32 v72, v72, v73
  v_mfma_f32_16x16x32_bf16 v[20:23], v[20:23], v[60:63], 0
  ds_write_b32 v78, v72 offset:520
  v_mov_b64 v[16:17], 0
  v_mfma_f32_16x16x32_bf16 v[20:23], v[24:27], v[64:67], v[20:23]
  ds_read_b128 v[44:47], v75 offset:40960
  v_mov_b64 v[18:19], 0
  v_smfmac_f32_16x16x64_bf16 v[40:43], v[0:3], a[40:47], v74
  ds_read_b128 v[48:51], v75 offset:41984
  v_mov_b64 v[68:69], s[78:79]
  v_smfmac_f32_16x16x64_bf16 v[36:39], v[4:7], a[48:55], v74
  s_waitcnt lgkmcnt(4)
  v_add_f32_dpp v24, v22, v20 quad_perm:[2,3,0,1] row_mask:0xf bank_mask:0xf
  v_add_f32_dpp v25, v23, v21 quad_perm:[2,3,0,1] row_mask:0xf bank_mask:0xf
  v_smfmac_f32_16x16x64_bf16 v[36:39], v[8:11], a[64:71], v74
  s_waitcnt lgkmcnt(2)
  s_barrier
  ds_read_b128 v[32:35], v78 offset:512
  v_smfmac_f32_16x16x64_bf16 v[36:39], v[12:15], a[80:87], v74
  ds_read_b128 v[60:63], v75 offset:24576
  v_mul_f32 v24, s69, v24
  v_smfmac_f32_16x16x64_bf16 v[40:43], v[4:7], a[56:63], v74
  ds_read_b128 v[64:67], v75 offset:25600
  v_mul_f32 v25, s69, v25
  v_smfmac_f32_16x16x64_bf16 v[40:43], v[8:11], a[72:79], v74
  v_exp_f32_dpp v24, v24 quad_perm:[0,1,0,1] row_mask:0xf bank_mask:0xf
  v_smfmac_f32_16x16x64_bf16 v[40:43], v[12:15], a[88:95], v74
  s_waitcnt lgkmcnt(2)
  v_exp_f32_dpp v25, v25 quad_perm:[0,1,0,1] row_mask:0xf bank_mask:0xf
  v_mfma_f32_16x16x32_bf16 v[8:11], v[32:35], v[68:71], 0
  v_add_f32 v36, v36, v38
  v_add_f32 v37, v37, v39
  v_mfma_f32_16x16x32_bf16 v[0:3], v[32:35], v[52:55], 0
  v_add_f32 v40, v40, v42
  v_add_f32 v41, v41, v43
  v_mfma_f32_16x16x32_bf16 v[4:7], v[32:35], v[56:59], 0
  v_cvt_pk_bf16_f32 v28, v24, v25
  v_cvt_pk_bf16_f32 v72, v36, v37
  v_cvt_pk_bf16_f32 v73, v40, v41
  v_mfma_f32_16x16x16_bf16 v[8:11], v[28:29], v[68:69], v[8:11]
  v_cvt_pk_bf16_f32 v31, v24, v25
  v_mov_b64 v[20:21], 0
  v_mfma_f32_16x16x16_bf16 v[0:3], v[28:29], v[72:73], v[0:3]
  ds_read_b128 v[52:55], v75 offset:26624
  v_mov_b64 v[22:23], 0
  v_mfma_f32_16x16x16_bf16 v[4:7], v[30:31], v[72:73], v[4:7]
  v_rcp_f32 v10, v8
  v_rcp_f32 v11, v9
  v_mul_f32 v0, v10, v0
  v_mul_f32 v1, v11, v1
  v_max3_f32 v8, v8, v9, v10
  v_mul_f32 v4, v10, v4
  v_mul_f32 v5, v11, v5
  v_cvt_pk_bf16_f32 v2, v0, v4
  ds_write_b32 v79, v2 offset:8704
  v_cvt_pk_bf16_f32 v3, v1, v5
  ds_write_b32 v79, v3 offset:9280
  ds_read_b128 v[12:15], v78 offset:8832
  v_max_f32 v8, v8, v11
  v_cmp_le_f32 vcc, 1317011456, v8
  v_mov_b64 v[24:25], 0
  v_mov_b64 v[26:27], 0
  ds_read_b128 v[56:59], v75 offset:27648
  s_cbranch_vccnz Cs2_mx
Cs2_mxok:
  s_waitcnt lgkmcnt(2)
  s_barrier
  ds_read_b128 v[0:3], v78 offset:8896
  s_waitcnt lgkmcnt(2)
  v_smfmac_f32_16x16x64_bf16 v[16:19], v[12:15], a[176:183], v74
  ds_read_b128 v[4:7], v78 offset:8704
  v_smfmac_f32_16x16x64_bf16 v[20:23], v[12:15], v[44:51], v74
  ds_read_b128 v[8:11], v78 offset:8768
  v_smfmac_f32_16x16x64_bf16 v[24:27], v[12:15], a[224:231], v74
  ds_read_b128 v[36:39], v75 offset:43008
  s_waitcnt lgkmcnt(3)
  v_smfmac_f32_16x16x64_bf16 v[16:19], v[0:3], a[184:191], v74
  ds_read_b128 v[40:43], v75 offset:44032
  s_waitcnt lgkmcnt(3)
  v_smfmac_f32_16x16x64_bf16 v[16:19], v[4:7], v[60:67], v74
  ds_read_b128 v[68:71], v76 offset:13824
  s_waitcnt lgkmcnt(3)
  v_smfmac_f32_16x16x64_bf16 v[16:19], v[8:11], v[52:59], v74
  ds_read_b128 v[44:47], v75 offset:57344
  v_smfmac_f32_16x16x64_bf16 v[20:23], v[4:7], a[192:199], v74
  ds_read_b128 v[48:51], v75 offset:58368
  v_smfmac_f32_16x16x64_bf16 v[20:23], v[8:11], a[200:207], v74
  ds_read_b128 v[60:63], v75 offset:59392
  s_waitcnt lgkmcnt(4)
  v_cvt_pk_bf16_f32 v16, v16, v17
  v_cvt_pk_bf16_f32 v17, v18, v19
  v_bfi_b32 v16, 1, s72, v16
  v_smfmac_f32_16x16x64_bf16 v[20:23], v[0:3], v[36:43], v74
  s_waitcnt lgkmcnt(3)
  buffer_store_dwordx2 v[16:17], v68, s[8:11], s73 offen sc1
  v_mov_b64 v[32:33], 0
  v_smfmac_f32_16x16x64_bf16 v[24:27], v[4:7], a[208:215], v74
  ds_read_b128 v[64:67], v75 offset:60416
  v_mov_b64 v[34:35], 0
  v_smfmac_f32_16x16x64_bf16 v[24:27], v[8:11], a[216:223], v74
  ds_read_b128 v[52:55], v75 offset:0
  v_cvt_pk_bf16_f32 v20, v20, v21
  v_cvt_pk_bf16_f32 v21, v22, v23
  v_bfi_b32 v20, 1, s72, v20
  v_smfmac_f32_16x16x64_bf16 v[24:27], v[0:3], a[232:239], v74
  ds_read_b128 v[56:59], v75 offset:1024
  buffer_store_dwordx2 v[20:21], v68, s[8:11], s74 offen sc1
  s_waitcnt lgkmcnt(4)
  v_mov_b64 v[28:29], 0
  v_smfmac_f32_16x16x64_bf16 v[32:35], v[4:7], v[44:51], v74
  ds_read_b128 v[36:39], v75 offset:2048
  ds_read_b128 v[40:43], v75 offset:3072
  s_waitcnt lgkmcnt(4)
  v_smfmac_f32_16x16x64_bf16 v[32:35], v[8:11], v[60:67], v74
  ds_read_b128 v[44:47], v75 offset:4096
  v_cvt_pk_bf16_f32 v24, v24, v25
  v_cvt_pk_bf16_f32 v25, v26, v27
  v_bfi_b32 v24, 1, s72, v24
  v_smfmac_f32_16x16x64_bf16 v[32:35], v[12:15], a[240:247], v74
  ds_read_b128 v[48:51], v75 offset:5120
  buffer_store_dwordx2 v[24:25], v68, s[8:11], s75 offen sc1
  v_mov_b64 v[30:31], 0
  v_smfmac_f32_16x16x64_bf16 v[32:35], v[0:3], a[248:255], v74
  ds_read_b128 v[60:63], v75 offset:6144
  ds_read_b128 v[64:67], v75 offset:7168
  s_waitcnt lgkmcnt(6)
  v_smfmac_f32_16x16x64_bf16 v[28:31], v[4:7], v[52:59], v74
  s_waitcnt lgkmcnt(4)
  v_smfmac_f32_16x16x64_bf16 v[28:31], v[8:11], v[36:43], v74
  s_waitcnt lgkmcnt(2)
  v_cvt_pk_bf16_f32 v32, v32, v33
  v_cvt_pk_bf16_f32 v33, v34, v35
  v_bfi_b32 v32, 1, s72, v32
  v_smfmac_f32_16x16x64_bf16 v[28:31], v[12:15], v[44:51], v74
  buffer_store_dwordx2 v[32:33], v68, s[8:11], s76 offen sc1
  s_waitcnt lgkmcnt(0)
  v_smfmac_f32_16x16x64_bf16 v[28:31], v[0:3], v[60:67], v74
  v_mov_b64 v[18:19], v[72:73]
  s_nop 4
  v_cvt_pk_bf16_f32 v28, v28, v29
  v_cvt_pk_bf16_f32 v29, v30, v31
  v_bfi_b32 v28, 1, s72, v28
  buffer_store_dwordx2 v[28:29], v68, s[8:11], s77 offen sc1
  ds_read_b128 v[0:3], v76 offset:14848
  s_waitcnt lgkmcnt(0)
  ds_read_b64 v[16:17], v77 offset:384
  s_waitcnt lgkmcnt(0)
  ds_read_b128 v[64:67], v76 offset:27648
  s_waitcnt lgkmcnt(0)
  ds_read_b128 v[60:63], v76 offset:26624
  s_waitcnt lgkmcnt(0)
  v_xor_b32 v75, 0x8000, v75
  v_mov_b64 v[28:29], 0
  v_mov_b64 v[30:31], 0
  v_mov_b64 v[32:33], 0
  v_mov_b64 v[34:35], 0
  s_waitcnt vmcnt(0)
  buffer_load_dwordx4 v[52:55], v76, s[8:11], s60 offen offset:0 sc1
  buffer_load_dwordx4 v[56:59], v76, s[8:11], s60 offen offset:1024 sc1
  s_add_u32 s66, s66, 1
  s_xor_b32 s64, s64, 16384
  s_xor_b32 s65, s65, 16384
  s_add_u32 s58, s58, 655360
  s_add_u32 s59, s59, 655360
  s_add_u32 s70, s70, 655360
  s_add_u32 s68, s68, 655360
  s_mov_b32 m0, 12800
  s_add_u32 s85, s65, 8192
  s_waitcnt lgkmcnt(0)
  s_waitcnt vmcnt(1)
  v_mfma_f32_16x16x32_bf16 v[4:7], v[0:3], v[52:55], 0
  v_bitop3_b32 v72, v52, v54, s72 bitop3:0x7e
  s_waitcnt vmcnt(0)
  v_mfma_f32_16x16x32_bf16 v[4:7], v[0:3], v[56:59], v[4:7]
  v_bitop3_b32 v73, v56, v58, s72 bitop3:0x7e
  v_bitop3_b32 v72, v72, v73, 1 bitop3:0xa8
  v_cmp_ne_u32 vcc, 0, v72
  s_cbranch_vccnz Cs2_h1r
  s_nop 2
  v_add_f32_dpp v4, v4, v4 row_ror:4 row_mask:0xf bank_mask:0xf
  v_add_f32_dpp v5, v5, v5 row_ror:4 row_mask:0xf bank_mask:0xf
  s_nop 0
  v_add_f32_dpp v4, v4, v4 row_ror:8 row_mask:0xf bank_mask:0xf
  v_add_f32_dpp v5, v5, v5 row_ror:8 row_mask:0xf bank_mask:0xf
  v_cvt_pk_bf16_f32 v4, v4, v5
  buffer_store_dword v4, v69, s[8:11], s62 offen sc1
  s_xor_b32 s62, s62, 16384
  buffer_store_dword v71, v69, s[8:11], s62 offen sc1
  s_xor_b32 s72, s72, 1
  s_branch Cs2_h2
Cs2_h1r:
  s_mov_b64 exec, vcc
  buffer_load_dwordx4 v[52:55], v76, s[8:11], s60 offen offset:0 sc1
  buffer_load_dwordx4 v[56:59], v76, s[8:11], s60 offen offset:1024 sc1
  s_mov_b64 exec, -1
  s_add_u32 s67, s67, 1
  s_waitcnt vmcnt(1)
  v_mfma_f32_16x16x32_bf16 v[4:7], v[0:3], v[52:55], 0
  v_bitop3_b32 v72, v52, v54, s72 bitop3:0x7e
  s_waitcnt vmcnt(0)
  v_mfma_f32_16x16x32_bf16 v[4:7], v[0:3], v[56:59], v[4:7]
  v_bitop3_b32 v73, v56, v58, s72 bitop3:0x7e
  v_bitop3_b32 v72, v72, v73, 1 bitop3:0xa8
  v_cmp_ne_u32 vcc, 0, v72
  s_cbranch_vccz Cs2_h1p
Cs2_h1s:
  s_mov_b64 exec, vcc
  buffer_load_dwordx4 v[52:55], v76, s[8:11], s60 offen offset:0 sc1
  buffer_load_dwordx4 v[56:59], v76, s[8:11], s60 offen offset:1024 sc1
  s_mov_b64 exec, -1
  s_add_u32 s67, s67, 1
  s_waitcnt vmcnt(1)
  v_mfma_f32_16x16x32_bf16 v[4:7], v[0:3], v[52:55], 0
  v_bitop3_b32 v72, v52, v54, s72 bitop3:0x7e
  s_waitcnt vmcnt(0)
  v_mfma_f32_16x16x32_bf16 v[4:7], v[0:3], v[56:59], v[4:7]
  v_bitop3_b32 v73, v56, v58, s72 bitop3:0x7e
  v_bitop3_b32 v72, v72, v73, 1 bitop3:0xa8
  v_cmp_ne_u32 vcc, 0, v72
  s_cbranch_vccz Cs2_h1p
  s_cmp_lt_u32 s67, 131072
  s_cbranch_scc1 Cs2_h1s
Cs2_h1p:
  s_nop 2
  v_add_f32_dpp v4, v4, v4 row_ror:4 row_mask:0xf bank_mask:0xf
  v_add_f32_dpp v5, v5, v5 row_ror:4 row_mask:0xf bank_mask:0xf
  s_nop 0
  v_add_f32_dpp v4, v4, v4 row_ror:8 row_mask:0xf bank_mask:0xf
  v_add_f32_dpp v5, v5, v5 row_ror:8 row_mask:0xf bank_mask:0xf
  v_cvt_pk_bf16_f32 v4, v4, v5
  buffer_store_dword v4, v69, s[8:11], s62 offen sc1
  s_xor_b32 s62, s62, 16384
  buffer_store_dword v71, v69, s[8:11], s62 offen sc1
  s_xor_b32 s72, s72, 1
  s_branch Cs2_h2
Cs2_rec:
  s_nop 7
  s_waitcnt vmcnt(0) lgkmcnt(0)
  v_max3_u32 v72, v0, v1, v2
  v_max3_u32 v72, v72, v3, v4
  v_max3_u32 v72, v72, v5, v6
  v_max3_u32 v72, v72, v7, v8
  v_max3_u32 v72, v72, v9, v10
  v_max3_u32 v72, v72, v11, v12
  v_max3_u32 v72, v72, v13, v14
  v_max3_u32 v72, v72, v15, v16
  v_max3_u32 v72, v72, v17, v18
  v_max_u32 v72, v72, v19
  v_cmp_eq_u32 vcc, -1, v72
  s_cbranch_vccz Cs2_recok
  s_barrier
Cs2_recp:
  buffer_load_dwordx4 v[0:3], v76, s[8:11], s64 offen offset:0 sc1
  buffer_load_dwordx4 v[4:7], v76, s[8:11], s64 offen offset:1024 sc1
  s_add_u32 s67, s67, 1
  s_cmp_lt_u32 s67, 131072
  s_cselect_b32 s54, -2, -1
  s_waitcnt vmcnt(1)
  v_max3_u32 v72, v0, v1, v2
  s_waitcnt vmcnt(0)
  v_max3_u32 v72, v72, v3, v4
  v_max3_u32 v72, v72, v5, v6
  v_max_u32 v72, v72, v7
  v_cmp_lt_u32 vcc, s54, v72
  s_cbranch_vccnz Cs2_recp
  ds_write_b128 v76, v[0:3] offset:8704
  ds_write_b128 v76, v[4:7] offset:9728
  v_mov_b64 v[20:21], 0
  v_mov_b64 v[22:23], 0
  v_mov_b64 v[24:25], 0
  v_mov_b64 v[26:27], 0
  v_mov_b64 v[28:29], 0
  v_mov_b64 v[30:31], 0
  v_mov_b64 v[32:33], 0
  v_mov_b64 v[34:35], 0
  s_waitcnt lgkmcnt(0)
  s_barrier
  ds_read_b128 v[0:3], v76 offset:4608
  s_waitcnt lgkmcnt(0)
  v_smfmac_f32_16x16x64_bf16 v[20:23], v[0:3], v[80:87], v74
  v_smfmac_f32_16x16x64_bf16 v[24:27], v[0:3], v[88:95], v74
  ds_read_b128 v[60:63], v76 offset:24576
  ds_read_b128 v[64:67], v76 offset:25600
  s_waitcnt lgkmcnt(0)
  v_smfmac_f32_16x16x64_bf16 v[28:31], v[0:3], v[60:67], v74
  ds_read_b128 v[60:63], v76 offset:26624
  ds_read_b128 v[64:67], v76 offset:27648
  s_waitcnt lgkmcnt(0)
  v_smfmac_f32_16x16x64_bf16 v[32:35], v[0:3], v[60:67], v74
  ds_read_b128 v[4:7], v76 offset:5632
  s_waitcnt lgkmcnt(0)
  v_smfmac_f32_16x16x64_bf16 v[20:23], v[4:7], v[96:103], v74
  v_smfmac_f32_16x16x64_bf16 v[24:27], v[4:7], v[104:111], v74
  ds_read_b128 v[60:63], v76 offset:40960
  ds_read_b128 v[64:67], v76 offset:41984
  s_waitcnt lgkmcnt(0)
  v_smfmac_f32_16x16x64_bf16 v[28:31], v[4:7], v[60:67], v74
  ds_read_b128 v[60:63], v76 offset:43008
  ds_read_b128 v[64:67], v76 offset:44032
  s_waitcnt lgkmcnt(0)
  v_smfmac_f32_16x16x64_bf16 v[32:35], v[4:7], v[60:67], v74
  ds_read_b128 v[8:11], v76 offset:6656
  s_waitcnt lgkmcnt(0)
  v_smfmac_f32_16x16x64_bf16 v[20:23], v[8:11], v[112:119], v74
  v_smfmac_f32_16x16x64_bf16 v[24:27], v[8:11], v[120:127], v74
  v_smfmac_f32_16x16x64_bf16 v[28:31], v[8:11], v[208:215], v74
  v_smfmac_f32_16x16x64_bf16 v[32:35], v[8:11], v[216:223], v74
  ds_read_b128 v[12:15], v76 offset:7680
  s_waitcnt lgkmcnt(0)
  v_smfmac_f32_16x16x64_bf16 v[20:23], v[12:15], v[128:135], v74
  v_smfmac_f32_16x16x64_bf16 v[24:27], v[12:15], v[136:143], v74
  v_smfmac_f32_16x16x64_bf16 v[28:31], v[12:15], v[224:231], v74
  v_smfmac_f32_16x16x64_bf16 v[32:35], v[12:15], v[232:239], v74
  ds_read_b128 v[12:15], v76 offset:8704
  s_waitcnt lgkmcnt(0)
  v_smfmac_f32_16x16x64_bf16 v[20:23], v[12:15], v[144:151], v74
  v_smfmac_f32_16x16x64_bf16 v[24:27], v[12:15], v[152:159], v74
  ds_read_b128 v[60:63], v76 offset:57344
  ds_read_b128 v[64:67], v76 offset:58368
  s_waitcnt lgkmcnt(0)
  v_smfmac_f32_16x16x64_bf16 v[28:31], v[12:15], v[60:67], v74
  ds_read_b128 v[60:63], v76 offset:59392
  ds_read_b128 v[64:67], v76 offset:60416
  s_waitcnt lgkmcnt(0)
  v_smfmac_f32_16x16x64_bf16 v[32:35], v[12:15], v[60:67], v74
  ds_read_b128 v[0:3], v76 offset:9728
  s_waitcnt lgkmcnt(0)
  v_smfmac_f32_16x16x64_bf16 v[20:23], v[0:3], v[160:167], v74
  v_smfmac_f32_16x16x64_bf16 v[24:27], v[0:3], v[168:175], v74
  ds_read_b128 v[60:63], v75 offset:24576
  ds_read_b128 v[64:67], v75 offset:25600
  s_waitcnt lgkmcnt(0)
  v_smfmac_f32_16x16x64_bf16 v[28:31], v[0:3], v[60:67], v74
  ds_read_b128 v[60:63], v75 offset:26624
  ds_read_b128 v[64:67], v75 offset:27648
  s_waitcnt lgkmcnt(0)
  v_smfmac_f32_16x16x64_bf16 v[32:35], v[0:3], v[60:67], v74
  ds_read_b128 v[16:19], v76 offset:10752
  ds_read_b128 v[60:63], v75 offset:8192
  ds_read_b128 v[64:67], v75 offset:9216
  s_waitcnt lgkmcnt(0)
  v_smfmac_f32_16x16x64_bf16 v[20:23], v[16:19], v[60:67], v74
  ds_read_b128 v[60:63], v75 offset:10240
  ds_read_b128 v[64:67], v75 offset:11264
  s_waitcnt lgkmcnt(0)
  v_smfmac_f32_16x16x64_bf16 v[24:27], v[16:19], v[60:67], v74
  v_smfmac_f32_16x16x64_bf16 v[28:31], v[16:19], v[240:247], v74
  v_smfmac_f32_16x16x64_bf16 v[32:35], v[16:19], v[248:255], v74
  ds_read_b128 v[4:7], v76 offset:11776
  s_waitcnt lgkmcnt(0)
  v_smfmac_f32_16x16x64_bf16 v[20:23], v[4:7], v[176:183], v74
  v_smfmac_f32_16x16x64_bf16 v[24:27], v[4:7], v[184:191], v74
  v_smfmac_f32_16x16x64_bf16 v[28:31], v[4:7], a[0:7], v74
  v_smfmac_f32_16x16x64_bf16 v[32:35], v[4:7], a[8:15], v74
  ds_read_b128 v[8:11], v76 offset:12800
  s_waitcnt lgkmcnt(0)
  v_smfmac_f32_16x16x64_bf16 v[20:23], v[8:11], v[192:199], v74
  v_smfmac_f32_16x16x64_bf16 v[24:27], v[8:11], v[200:207], v74
  v_smfmac_f32_16x16x64_bf16 v[28:31], v[8:11], a[16:23], v74
  v_smfmac_f32_16x16x64_bf16 v[32:35], v[8:11], a[24:31], v74
  v_add_f32 v20, v20, v22
  v_add_f32 v21, v21, v23
  v_add_f32 v24, v24, v26
  v_cvt_pk_bf16_f32 v22, v20, v24
  ds_write_b32 v79, v22 offset:0
  v_add_f32 v25, v25, v27
  v_cvt_pk_bf16_f32 v23, v21, v25
  ds_write_b32 v79, v23 offset:576
  v_add_f32 v28, v28, v30
  v_add_f32 v29, v29, v31
  s_waitcnt lgkmcnt(0)
  s_nop 1
  s_branch Cs2_recok
Cs2_mx:
  s_waitcnt lgkmcnt(0)
  s_barrier
  buffer_load_dwordx4 v[52:55], v76, s[8:11], s59 offen offset:0 sc1
  buffer_load_dwordx4 v[0:3], v76, s[8:11], s58 offen offset:0 sc1
  ds_read_b128 v[20:23], v77 offset:0
  ds_read_b128 v[28:31], v77 offset:256
  buffer_load_dwordx4 v[56:59], v76, s[8:11], s59 offen offset:1024 sc1
  buffer_load_dwordx4 v[4:7], v76, s[8:11], s58 offen offset:1024 sc1
  ds_read_b128 v[24:27], v77 offset:128
  ds_read_b128 v[32:35], v77 offset:384
  s_waitcnt vmcnt(2) lgkmcnt(3)
  v_mfma_f32_16x16x32_bf16 v[8:11], v[0:3], v[20:23], 0
  s_waitcnt vmcnt(0) lgkmcnt(1)
  v_mfma_f32_16x16x32_bf16 v[8:11], v[4:7], v[24:27], v[8:11]
  v_mfma_f32_16x16x32_bf16 v[12:15], v[28:31], v[20:23], 0
  s_waitcnt lgkmcnt(0)
  v_mfma_f32_16x16x32_bf16 v[12:15], v[32:35], v[24:27], v[12:15]
  v_add_f32_dpp v8, v10, v8 quad_perm:[2,3,0,1] row_mask:0xf bank_mask:0xf
  v_add_f32_dpp v9, v11, v9 quad_perm:[2,3,0,1] row_mask:0xf bank_mask:0xf
  s_nop 0
  v_mov_b32_dpp v8, v8 quad_perm:[0,1,0,1] row_mask:0xf bank_mask:0xf
  v_mov_b32_dpp v9, v9 quad_perm:[0,1,0,1] row_mask:0xf bank_mask:0xf
  s_nop 1
  v_add_f32_dpp v12, v14, v12 quad_perm:[2,3,0,1] row_mask:0xf bank_mask:0xf
  v_add_f32_dpp v13, v15, v13 quad_perm:[2,3,0,1] row_mask:0xf bank_mask:0xf
  s_nop 0
  v_mov_b32_dpp v12, v12 quad_perm:[0,1,0,1] row_mask:0xf bank_mask:0xf
  v_mov_b32_dpp v13, v13 quad_perm:[0,1,0,1] row_mask:0xf bank_mask:0xf
  v_mul_f32 v12, s69, v12
  ds_write_b32 v78, v8 offset:8712
  v_mul_f32 v13, s69, v13
  ds_write_b32 v78, v9 offset:8776
  s_waitcnt lgkmcnt(0)
  s_barrier
  ds_read_b128 v[36:39], v78 offset:8704
  ds_read_b128 v[40:43], v78 offset:8768
  s_waitcnt lgkmcnt(0)
  s_barrier
  v_max_f32 v16, v36, v37
  v_max3_f32 v16, v16, v38, v39
  v_max3_f32 v16, v16, v40, v41
  v_max3_f32 v16, v16, v42, v43
  v_max3_f32 v16, v16, v12, v13
  v_mov_b32 v17, v16
  s_nop 1
  v_permlane16_swap_b32 v16, v17
  v_max_f32 v16, v16, v17
  v_mov_b32 v17, v16
  s_nop 1
  v_permlane32_swap_b32 v16, v17
  v_max_f32 v16, v16, v17
  v_sub_f32 v36, v36, v16
  v_sub_f32 v37, v37, v16
  v_sub_f32 v38, v38, v16
  v_sub_f32 v39, v39, v16
  v_sub_f32 v40, v40, v16
  v_sub_f32 v41, v41, v16
  v_sub_f32 v42, v42, v16
  v_sub_f32 v43, v43, v16
  v_sub_f32 v12, v12, v16
  v_sub_f32 v13, v13, v16
  v_exp_f32 v36, v36
  v_exp_f32 v37, v37
  v_exp_f32 v38, v38
  v_exp_f32 v39, v39
  v_exp_f32 v40, v40
  v_exp_f32 v41, v41
  v_exp_f32 v42, v42
  v_exp_f32 v43, v43
  v_exp_f32 v12, v12
  v_exp_f32 v13, v13
  v_cvt_pk_bf16_f32 v32, v36, v40
  v_cvt_pk_bf16_f32 v33, v37, v41
  v_cvt_pk_bf16_f32 v34, v38, v42
  v_cvt_pk_bf16_f32 v35, v39, v43
  v_cvt_pk_bf16_f32 v28, v12, v13
  v_cvt_pk_bf16_f32 v31, v12, v13
  v_mov_b32 v29, 0
  v_mov_b32 v30, 0
  v_mfma_f32_16x16x32_bf16 v[8:11], v[32:35], v[68:71], 0
  v_mfma_f32_16x16x32_bf16 v[0:3], v[32:35], v[52:55], 0
  v_mfma_f32_16x16x32_bf16 v[4:7], v[32:35], v[56:59], 0
  v_mfma_f32_16x16x16_bf16 v[8:11], v[28:29], v[68:69], v[8:11]
  v_mfma_f32_16x16x16_bf16 v[0:3], v[28:29], v[72:73], v[0:3]
  v_mfma_f32_16x16x16_bf16 v[4:7], v[30:31], v[72:73], v[4:7]
  ds_read_b128 v[52:55], v75 offset:26624
  v_rcp_f32 v10, v8
  v_rcp_f32 v11, v9
  v_mul_f32 v0, v10, v0
  v_mul_f32 v1, v11, v1
  v_max3_f32 v8, v8, v9, v10
  v_mul_f32 v4, v10, v4
  v_mul_f32 v5, v11, v5
  v_cvt_pk_bf16_f32 v2, v0, v4
  ds_write_b32 v79, v2 offset:8704
  v_cvt_pk_bf16_f32 v3, v1, v5
  ds_write_b32 v79, v3 offset:9280
  ds_read_b128 v[12:15], v78 offset:8832
  ds_read_b128 v[56:59], v75 offset:27648
  v_mov_b64 v[16:17], 0
  v_mov_b64 v[18:19], 0
  v_mov_b64 v[20:21], 0
  v_mov_b64 v[22:23], 0
  v_mov_b64 v[24:25], 0
  v_mov_b64 v[26:27], 0
  s_branch Cs2_mxok
Cs2_last:
  ds_read_b128 v[4:7], v76 offset:5632
  ds_read_b128 v[8:11], v76 offset:6656
  ds_read_b128 v[44:47], v76 offset:40960
  ds_read_b128 v[48:51], v76 offset:41984
  s_nop 5
  v_mov_b64 v[20:21], 0
  v_mov_b64 v[22:23], 0
  v_mov_b64 v[24:25], 0
  v_mov_b64 v[26:27], 0
  s_waitcnt lgkmcnt(4)
  v_smfmac_f32_16x16x64_bf16 v[28:31], v[0:3], v[36:43], v74
  ds_read_b128 v[36:39], v76 offset:43008
  ds_read_b128 v[40:43], v76 offset:44032
  v_smfmac_f32_16x16x64_bf16 v[32:35], v[0:3], v[60:67], v74
  s_waitcnt lgkmcnt(5)
  v_smfmac_f32_16x16x64_bf16 v[20:23], v[0:3], a[32:39], v74
  ds_read_b128 v[60:63], v76 offset:57344
  ds_read_b128 v[64:67], v76 offset:58368
  v_smfmac_f32_16x16x64_bf16 v[24:27], v[0:3], a[40:47], v74
  s_waitcnt lgkmcnt(4)
  v_smfmac_f32_16x16x64_bf16 v[20:23], v[4:7], a[48:55], v74
  buffer_store_dwordx4 v[16:19], v76, s[8:11], s68 offen sc1
  v_smfmac_f32_16x16x64_bf16 v[24:27], v[4:7], a[56:63], v74
  v_smfmac_f32_16x16x64_bf16 v[28:31], v[4:7], v[44:51], v74
  s_waitcnt lgkmcnt(2)
  v_smfmac_f32_16x16x64_bf16 v[20:23], v[8:11], a[64:71], v74
  ds_read_b128 v[44:47], v76 offset:59392
  ds_read_b128 v[48:51], v76 offset:60416
  v_smfmac_f32_16x16x64_bf16 v[24:27], v[8:11], a[72:79], v74
  v_smfmac_f32_16x16x64_bf16 v[32:35], v[4:7], v[36:43], v74
  v_smfmac_f32_16x16x64_bf16 v[28:31], v[8:11], v[208:215], v74
  ds_read_b128 v[36:39], v75 offset:24576
  ds_read_b128 v[40:43], v75 offset:25600
  v_smfmac_f32_16x16x64_bf16 v[32:35], v[8:11], v[216:223], v74
  v_smfmac_f32_16x16x64_bf16 v[20:23], v[12:15], a[80:87], v74
  v_smfmac_f32_16x16x64_bf16 v[24:27], v[12:15], a[88:95], v74
  v_smfmac_f32_16x16x64_bf16 v[28:31], v[12:15], v[224:231], v74
  v_smfmac_f32_16x16x64_bf16 v[32:35], v[12:15], v[232:239], v74
  s_waitcnt vmcnt(1)
  s_barrier
Cs2_lastr:
  ds_read_b128 v[12:15], v76 offset:8704
  ds_read_b128 v[0:3], v76 offset:9728
  ds_read_b128 v[16:19], v76 offset:10752
  ds_read_b128 v[4:7], v76 offset:11776
  ds_read_b128 v[8:11], v76 offset:12800
  s_waitcnt lgkmcnt(3)
  v_max3_u32 v72, v0, v1, v2
  s_waitcnt lgkmcnt(1)
  v_max3_u32 v72, v72, v3, v4
  v_max3_u32 v72, v72, v5, v6
  s_waitcnt lgkmcnt(0)
  v_max3_u32 v72, v72, v7, v8
  v_max3_u32 v72, v72, v9, v10
  v_max3_u32 v72, v72, v11, v12
  v_max3_u32 v72, v72, v13, v14
  v_max3_u32 v72, v72, v15, v16
  v_max3_u32 v72, v72, v17, v18
  v_max_u32 v72, v72, v19
  v_cmp_eq_u32 vcc, -1, v72
  s_cbranch_vccnz Cs2_lastp
Cs2_lastg:
  v_smfmac_f32_16x16x64_bf16 v[28:31], v[12:15], v[60:67], v74
  ds_read_b128 v[60:63], v75 offset:26624
  ds_read_b128 v[64:67], v75 offset:27648
  v_smfmac_f32_16x16x64_bf16 v[32:35], v[12:15], v[44:51], v74
  v_smfmac_f32_16x16x64_bf16 v[28:31], v[0:3], v[36:43], v74
  v_smfmac_f32_16x16x64_bf16 v[28:31], v[16:19], v[240:247], v74
  v_smfmac_f32_16x16x64_bf16 v[28:31], v[4:7], a[0:7], v74
  v_smfmac_f32_16x16x64_bf16 v[28:31], v[8:11], a[16:23], v74
  v_smfmac_f32_16x16x64_bf16 v[32:35], v[16:19], v[248:255], v74
  v_smfmac_f32_16x16x64_bf16 v[32:35], v[4:7], a[8:15], v74
  s_waitcnt lgkmcnt(0)
  v_smfmac_f32_16x16x64_bf16 v[32:35], v[8:11], a[24:31], v74
  v_smfmac_f32_16x16x64_bf16 v[32:35], v[0:3], v[60:67], v74
  v_smfmac_f32_16x16x64_bf16 v[20:23], v[12:15], a[96:103], v74
  v_smfmac_f32_16x16x64_bf16 v[20:23], v[0:3], a[112:119], v74
  v_add_f32 v28, v28, v30
  v_add_f32 v32, v32, v34
  v_cvt_pk_bf16_f32 v30, v28, v32
  v_smfmac_f32_16x16x64_bf16 v[20:23], v[16:19], a[128:135], v74
  ds_write_b32 v79, v30 offset:256
  v_add_f32 v29, v29, v31
  v_add_f32 v33, v33, v35
  v_cvt_pk_bf16_f32 v31, v29, v33
  v_smfmac_f32_16x16x64_bf16 v[20:23], v[4:7], a[144:151], v74
  ds_write_b32 v79, v31 offset:832
  v_smfmac_f32_16x16x64_bf16 v[20:23], v[8:11], a[160:167], v74
  v_smfmac_f32_16x16x64_bf16 v[24:27], v[12:15], a[104:111], v74
  v_smfmac_f32_16x16x64_bf16 v[24:27], v[0:3], a[120:127], v74
  v_smfmac_f32_16x16x64_bf16 v[24:27], v[16:19], a[136:143], v74
  s_waitcnt lgkmcnt(0)
  s_barrier
  ds_read_b64 v[52:53], v77 offset:384
  v_add_f32 v20, v20, v22
  v_smfmac_f32_16x16x64_bf16 v[24:27], v[4:7], a[152:159], v74
  v_add_f32 v21, v21, v23
  v_smfmac_f32_16x16x64_bf16 v[24:27], v[8:11], a[168:175], v74
  v_cvt_pk_bf16_f32 v54, v20, v21
  s_add_u32 s68, s68, 655360
  s_nop 3
  v_add_f32 v24, v24, v26
  v_add_f32 v25, v25, v27
  v_cvt_pk_bf16_f32 v55, v24, v25
  s_waitcnt lgkmcnt(0)
  buffer_store_dwordx4 v[52:55], v76, s[8:11], s68 offen sc1
  s_branch Cs2_done
Cs2_lastp:
  s_add_u32 s72, s72, 2
  s_cmp_ge_u32 s72, 131072
  s_cbranch_scc1 Cs2_lastg
  s_barrier
  buffer_load_dwordx4 v76, s[8:11], s85 offen offset:0 sc1 lds
  s_waitcnt vmcnt(0)
  s_barrier
  s_branch Cs2_lastr
Cs2_done:
  s_branch L_cexit
L_w7:
  v_mov_b64 v[20:21], 0
  v_mov_b64 v[22:23], 0
  v_mov_b64 v[24:25], 0
  v_mov_b64 v[26:27], 0
  v_mov_b64 v[28:29], 0
  v_mov_b64 v[30:31], 0
  v_mov_b64 v[32:33], 0
  v_mov_b64 v[34:35], 0
  s_mov_b32 s78, 0x3f803f80
  s_mov_b32 s79, s78
  s_mov_b32 s65, 360448
  s_mov_b32 m0, 15872
  s_lshl_b32 s71, s53, 2
  s_add_u32 s71, s71, 128
  s_movk_i32 s56, 0x1000
  v_lshlrev_b32 v73, 2, v76
  v_mov_b32 v72, 0
  s_mov_b64 s[16:17], s[8:9]
  s_mov_b32 s18, 268435456
  s_mov_b32 s19, 0x20000
  s_getpc_b64 s[20:21]
Cs3_pc:
  s_add_u32 s20, s20, (Cs3_last - Cs3_pc)
  s_addc_u32 s21, s21, 0
  v_mov_b32 v68, 14880
  buffer_load_dwordx4 v[52:55], v76, s[8:11], s59 offen offset:0 sc1
  buffer_load_dwordx4 v[56:59], v76, s[8:11], s59 offen offset:1024 sc1
  ds_read_b128 v[36:39], v76 offset:45056
  ds_read_b128 v[40:43], v76 offset:46080
  ds_read_b128 v[60:63], v76 offset:47104
  ds_read_b128 v[64:67], v76 offset:48128
  ds_read_b128 v[0:3], v76 offset:4608
  ds_read_b128 v[4:7], v76 offset:5632
  ds_read_b128 v[8:11], v76 offset:6656
  ds_read_b128 v[12:15], v76 offset:7680
  s_waitcnt lgkmcnt(0)
  s_cmp_eq_u32 s66, 1
  s_branch Cs3_top2
.p2align 6
Cs3_h2:
  v_lshlrev_b32 v73, 2, v76
  ds_read_b128 v[36:39], v76 offset:45056
  ds_read_b128 v[40:43], v76 offset:46080
  buffer_load_dwordx4 v[52:55], v76, s[8:11], s59 offen offset:0 sc1
  buffer_load_dwordx4 v[56:59], v76, s[8:11], s59 offen offset:1024 sc1
  s_waitcnt vmcnt(0)
  s_mov_b64 vcc, -1
Cs3_h2r:
  s_mov_b64 exec, vcc
  buffer_load_dwordx4 v[4:7], v76, s[8:11], s65 offen offset:1024 sc1
  buffer_load_dwordx4 v[0:3], v76, s[8:11], s85 offen offset:0 sc1
  buffer_load_dwordx4 v[8:11], v76, s[8:11], s85 offen offset:1024 sc1
  s_mov_b64 exec, -1
  s_add_u32 s67, s67, 1
  s_cmp_lt_u32 s67, 131072
  s_cselect_b32 s54, -2, -1
  s_waitcnt vmcnt(2)
  v_max3_u32 v72, v4, v5, v6
  s_waitcnt vmcnt(1)
  v_max3_u32 v72, v72, v7, v0
  v_max3_u32 v72, v72, v1, v2
  s_waitcnt vmcnt(0)
  v_max3_u32 v72, v72, v3, v8
  v_max3_u32 v72, v72, v9, v10
  v_max_u32 v72, v72, v11
  v_cmp_lt_u32 vcc, s54, v72
  s_cbranch_vccnz Cs3_h2r
  ds_write_b128 v76, v[4:7] offset:5632
  ds_write_b128 v76, v[0:3] offset:8704
  ds_write_b128 v76, v[8:11] offset:9728
Cs3_h2w:
  s_cmp_eq_u32 s66, 63
  s_waitcnt lgkmcnt(0)
  s_barrier
  ds_read_b128 v[8:11], v76 offset:6656
Cs3_top2:
  v_smfmac_f32_16x16x64_bf16 v[20:23], v[4:7], v[96:103], v74
  s_cbranch_scc1 Cs3_last
  v_smfmac_f32_16x16x64_bf16 v[28:31], v[4:7], v[36:43], v74
  buffer_load_dwordx4 v[44:47], v76, s[8:11], s58 offen offset:0 sc1
  s_mov_b32 m0, 15872
  v_smfmac_f32_16x16x64_bf16 v[24:27], v[4:7], v[104:111], v74
  buffer_load_dwordx4 v[48:51], v76, s[8:11], s58 offen offset:1024 sc1
  v_smfmac_f32_16x16x64_bf16 v[32:35], v[4:7], v[60:67], v74
  ds_read_b128 v[0:3], v76 offset:4608
  s_waitcnt lgkmcnt(1)
  v_smfmac_f32_16x16x64_bf16 v[20:23], v[8:11], v[112:119], v74
  ds_read_b128 v[12:15], v76 offset:7680
  v_smfmac_f32_16x16x64_bf16 v[24:27], v[8:11], v[120:127], v74
  ds_read_b128 v[36:39], v76 offset:28672
  v_smfmac_f32_16x16x64_bf16 v[28:31], v[8:11], v[208:215], v74
  buffer_store_dwordx4 v[16:19], v76, s[8:11], s68 offen sc1
  ds_read_b128 v[40:43], v76 offset:29696
  v_smfmac_f32_16x16x64_bf16 v[32:35], v[8:11], v[216:223], v74
  buffer_load_dword v73, s[16:19], s70 offen lds
  ds_read_b128 v[60:63], v76 offset:30720
  s_waitcnt lgkmcnt(4)
  v_smfmac_f32_16x16x64_bf16 v[20:23], v[0:3], v[80:87], v74
  ds_read_b128 v[64:67], v76 offset:31744
  v_smfmac_f32_16x16x64_bf16 v[24:27], v[0:3], v[88:95], v74
  s_waitcnt vmcnt(4)
  s_waitcnt lgkmcnt(4)
  v_smfmac_f32_16x16x64_bf16 v[20:23], v[12:15], v[128:135], v74
  s_barrier
  ds_read_b128 v[4:7], v76 offset:8704
  s_waitcnt lgkmcnt(3)
  v_smfmac_f32_16x16x64_bf16 v[28:31], v[0:3], v[36:43], v74
  ds_read_b128 v[36:39], v76 offset:61440
  v_smfmac_f32_16x16x64_bf16 v[24:27], v[12:15], v[136:143], v74
  ds_read_b128 v[40:43], v76 offset:62464
  s_waitcnt lgkmcnt(3)
  v_smfmac_f32_16x16x64_bf16 v[32:35], v[0:3], v[60:67], v74
  ds_read_b128 v[8:11], v76 offset:9728
  v_smfmac_f32_16x16x64_bf16 v[28:31], v[12:15], v[224:231], v74
  ds_read_b128 v[60:63], v76 offset:63488
  v_smfmac_f32_16x16x64_bf16 v[32:35], v[12:15], v[232:239], v74
  ds_read_b128 v[64:67], v76 offset:64512
  s_waitcnt lgkmcnt(5)
  v_smfmac_f32_16x16x64_bf16 v[20:23], v[4:7], v[144:151], v74
  s_barrier
  ds_read_b128 v[0:3], v76 offset:11776
  s_waitcnt lgkmcnt(4)
  v_smfmac_f32_16x16x64_bf16 v[28:31], v[4:7], v[36:43], v74
  ds_read_b128 v[12:15], v76 offset:12800
  ds_read_b128 v[36:39], v75 offset:12288
  v_smfmac_f32_16x16x64_bf16 v[24:27], v[4:7], v[152:159], v74
  ds_read_b128 v[16:19], v76 offset:10752
  s_waitcnt lgkmcnt(6)
  v_smfmac_f32_16x16x64_bf16 v[20:23], v[8:11], v[160:167], v74
  ds_read_b128 v[40:43], v75 offset:13312
  s_waitcnt lgkmcnt(5)
  v_smfmac_f32_16x16x64_bf16 v[32:35], v[4:7], v[60:67], v74
  ds_read_b128 v[60:63], v75 offset:14336
  v_smfmac_f32_16x16x64_bf16 v[24:27], v[8:11], v[168:175], v74
  ds_read_b128 v[64:67], v75 offset:15360
  s_waitcnt lgkmcnt(6)
  v_smfmac_f32_16x16x64_bf16 v[20:23], v[0:3], v[176:183], v74
  s_waitcnt lgkmcnt(5)
  v_smfmac_f32_16x16x64_bf16 v[20:23], v[12:15], v[192:199], v74
  s_waitcnt lgkmcnt(2)
  v_smfmac_f32_16x16x64_bf16 v[20:23], v[16:19], v[36:43], v74
  ds_read_b128 v[36:39], v75 offset:28672
  v_smfmac_f32_16x16x64_bf16 v[24:27], v[0:3], v[184:191], v74
  ds_read_b128 v[40:43], v75 offset:29696
  s_waitcnt lgkmcnt(2)
  v_smfmac_f32_16x16x64_bf16 v[24:27], v[16:19], v[60:67], v74
  ds_read_b128 v[60:63], v75 offset:30720
  v_add_f32 v20, v20, v22
  v_smfmac_f32_16x16x64_bf16 v[24:27], v[12:15], v[200:207], v74
  ds_read_b128 v[64:67], v75 offset:31744
  v_add_f32 v21, v21, v23
  v_smfmac_f32_16x16x64_bf16 v[28:31], v[16:19], v[240:247], v74
  v_mov_b64 v[70:71], s[78:79]
  v_smfmac_f32_16x16x64_bf16 v[28:31], v[0:3], a[0:7], v74
  s_waitcnt lgkmcnt(2)
  v_add_f32 v24, v24, v26
  v_smfmac_f32_16x16x64_bf16 v[28:31], v[8:11], v[36:43], v74
  ds_read_b128 v[36:39], v68
  v_cvt_pk_bf16_f32 v22, v20, v24
  v_smfmac_f32_16x16x64_bf16 v[28:31], v[12:15], a[16:23], v74
  ds_read_b128 v[40:43], v68
  ds_write_b32 v79, v22 offset:0
  s_waitcnt lgkmcnt(3)
  v_add_f32 v25, v25, v27
  v_cvt_pk_bf16_f32 v23, v21, v25
  v_smfmac_f32_16x16x64_bf16 v[32:35], v[8:11], v[60:67], v74
  ds_write_b32 v79, v23 offset:576
  v_cmp_u_f32 vcc, v20, v21
  v_smfmac_f32_16x16x64_bf16 v[32:35], v[16:19], v[248:255], v74
  v_add_f32 v28, v28, v30
  v_smfmac_f32_16x16x64_bf16 v[32:35], v[0:3], a[8:15], v74
  v_add_f32 v29, v29, v31
  v_smfmac_f32_16x16x64_bf16 v[32:35], v[12:15], a[24:31], v74
  s_cbranch_vccnz Cs3_rec
Cs3_recok:
  s_waitcnt lgkmcnt(3)
  v_smfmac_f32_16x16x64_bf16 v[36:39], v[16:19], a[128:135], v74
  s_waitcnt lgkmcnt(0)
  s_barrier
  ds_read_b128 v[60:63], v77
  v_smfmac_f32_16x16x64_bf16 v[40:43], v[16:19], a[136:143], v74
  ds_read_b128 v[64:67], v77 offset:128
  v_add_f32 v32, v32, v34
  v_cvt_pk_bf16_f32 v30, v28, v32
  v_smfmac_f32_16x16x64_bf16 v[36:39], v[0:3], a[144:151], v74
  ds_write_b32 v79, v30 offset:256
  v_add_f32 v33, v33, v35
  v_cvt_pk_bf16_f32 v31, v29, v33
  v_smfmac_f32_16x16x64_bf16 v[40:43], v[0:3], a[152:159], v74
  ds_write_b32 v79, v31 offset:832
  v_xor_b32 v75, 0x8000, v75
  v_smfmac_f32_16x16x64_bf16 v[36:39], v[4:7], a[96:103], v74
  ds_read_b128 v[0:3], v76 offset:4608
  v_mov_b32 v29, 0
  v_smfmac_f32_16x16x64_bf16 v[40:43], v[4:7], a[104:111], v74
  s_waitcnt vmcnt(2) lgkmcnt(3)
  v_mov_b32 v30, 0
  v_mfma_f32_16x16x32_bf16 v[44:47], v[44:47], v[60:63], 0
  ds_read_b128 v[4:7], v76 offset:5632
  s_waitcnt lgkmcnt(2)
  v_mfma_f32_16x16x32_bf16 v[44:47], v[48:51], v[64:67], v[44:47]
  s_barrier
  v_smfmac_f32_16x16x64_bf16 v[36:39], v[8:11], a[112:119], v74
  ds_read_b128 v[20:23], v77 offset:256
  ds_read_b128 v[24:27], v77 offset:384
  v_smfmac_f32_16x16x64_bf16 v[40:43], v[8:11], a[120:127], v74
  ds_read_b128 v[8:11], v76 offset:6656
  v_add_f32_dpp v72, v46, v44 quad_perm:[2,3,0,1] row_mask:0xf bank_mask:0xf
  v_add_f32_dpp v73, v47, v45 quad_perm:[2,3,0,1] row_mask:0xf bank_mask:0xf
  v_smfmac_f32_16x16x64_bf16 v[36:39], v[12:15], a[160:167], v74
  s_waitcnt lgkmcnt(4)
  v_exp_f32_dpp v72, v72 quad_perm:[0,1,0,1] row_mask:0xf bank_mask:0xf
  v_smfmac_f32_16x16x64_bf16 v[40:43], v[12:15], a[168:175], v74
  ds_read_b128 v[12:15], v76 offset:7680
  v_exp_f32_dpp v73, v73 quad_perm:[0,1,0,1] row_mask:0xf bank_mask:0xf
  v_smfmac_f32_16x16x64_bf16 v[36:39], v[0:3], a[32:39], v74
  s_waitcnt lgkmcnt(2)
  v_cvt_pk_bf16_f32 v72, v72, v73
  v_mfma_f32_16x16x32_bf16 v[20:23], v[20:23], v[60:63], 0
  ds_write_b32 v78, v72 offset:524
  v_mov_b64 v[16:17], 0
  v_mfma_f32_16x16x32_bf16 v[20:23], v[24:27], v[64:67], v[20:23]
  ds_read_b128 v[44:47], v75 offset:47104
  v_mov_b64 v[18:19], 0
  v_smfmac_f32_16x16x64_bf16 v[40:43], v[0:3], a[40:47], v74
  ds_read_b128 v[48:51], v75 offset:48128
  v_mov_b64 v[68:69], s[78:79]
  v_smfmac_f32_16x16x64_bf16 v[36:39], v[4:7], a[48:55], v74
  s_waitcnt lgkmcnt(4)
  v_add_f32_dpp v24, v22, v20 quad_perm:[2,3,0,1] row_mask:0xf bank_mask:0xf
  v_add_f32_dpp v25, v23, v21 quad_perm:[2,3,0,1] row_mask:0xf bank_mask:0xf
  v_smfmac_f32_16x16x64_bf16 v[36:39], v[8:11], a[64:71], v74
  s_waitcnt lgkmcnt(2)
  s_barrier
  ds_read_b128 v[32:35], v78 offset:512
  v_smfmac_f32_16x16x64_bf16 v[36:39], v[12:15], a[80:87], v74
  ds_read_b128 v[60:63], v75 offset:28672
  v_mul_f32 v24, s69, v24
  v_smfmac_f32_16x16x64_bf16 v[40:43], v[4:7], a[56:63], v74
  ds_read_b128 v[64:67], v75 offset:29696
  v_mul_f32 v25, s69, v25
  v_smfmac_f32_16x16x64_bf16 v[40:43], v[8:11], a[72:79], v74
  v_exp_f32_dpp v24, v24 quad_perm:[0,1,0,1] row_mask:0xf bank_mask:0xf
  v_smfmac_f32_16x16x64_bf16 v[40:43], v[12:15], a[88:95], v74
  s_waitcnt lgkmcnt(2)
  v_exp_f32_dpp v25, v25 quad_perm:[0,1,0,1] row_mask:0xf bank_mask:0xf
  v_mfma_f32_16x16x32_bf16 v[8:11], v[32:35], v[68:71], 0
  v_add_f32 v36, v36, v38
  v_add_f32 v37, v37, v39
  v_mfma_f32_16x16x32_bf16 v[0:3], v[32:35], v[52:55], 0
  v_add_f32 v40, v40, v42
  v_add_f32 v41, v41, v43
  v_mfma_f32_16x16x32_bf16 v[4:7], v[32:35], v[56:59], 0
  v_cvt_pk_bf16_f32 v28, v24, v25
  v_cvt_pk_bf16_f32 v72, v36, v37
  v_cvt_pk_bf16_f32 v73, v40, v41
  v_mfma_f32_16x16x16_bf16 v[8:11], v[28:29], v[68:69], v[8:11]
  v_cvt_pk_bf16_f32 v31, v24, v25
  v_mov_b64 v[20:21], 0
  v_mfma_f32_16x16x16_bf16 v[0:3], v[28:29], v[72:73], v[0:3]
  ds_read_b128 v[52:55], v75 offset:30720
  v_mov_b64 v[22:23], 0
  v_mfma_f32_16x16x16_bf16 v[4:7], v[30:31], v[72:73], v[4:7]
  v_rcp_f32 v10, v8
  v_rcp_f32 v11, v9
  v_mul_f32 v0, v10, v0
  v_mul_f32 v1, v11, v1
  v_max3_f32 v8, v8, v9, v10
  v_mul_f32 v4, v10, v4
  v_mul_f32 v5, v11, v5
  v_cvt_pk_bf16_f32 v2, v0, v4
  ds_write_b32 v79, v2 offset:8704
  v_cvt_pk_bf16_f32 v3, v1, v5
  ds_write_b32 v79, v3 offset:9280
  ds_read_b128 v[12:15], v78 offset:8896
  v_max_f32 v8, v8, v11
  v_cmp_le_f32 vcc, 1317011456, v8
  v_mov_b64 v[24:25], 0
  v_mov_b64 v[26:27], 0
  ds_read_b128 v[56:59], v75 offset:31744
  s_cbranch_vccnz Cs3_mx
Cs3_mxok:
  s_waitcnt lgkmcnt(2)
  s_barrier
  ds_read_b128 v[0:3], v78 offset:8832
  s_waitcnt lgkmcnt(2)
  v_smfmac_f32_16x16x64_bf16 v[16:19], v[12:15], a[184:191], v74
  ds_read_b128 v[4:7], v78 offset:8704
  v_smfmac_f32_16x16x64_bf16 v[20:23], v[12:15], v[44:51], v74
  ds_read_b128 v[8:11], v78 offset:8768
  v_smfmac_f32_16x16x64_bf16 v[24:27], v[12:15], a[232:239], v74
  ds_read_b128 v[36:39], v75 offset:45056
  s_waitcnt lgkmcnt(3)
  v_smfmac_f32_16x16x64_bf16 v[16:19], v[0:3], a[176:183], v74
  ds_read_b128 v[40:43], v75 offset:46080
  s_waitcnt lgkmcnt(3)
  v_smfmac_f32_16x16x64_bf16 v[16:19], v[4:7], v[60:67], v74
  ds_read_b128 v[68:71], v76 offset:13824
  s_waitcnt lgkmcnt(3)
  v_smfmac_f32_16x16x64_bf16 v[16:19], v[8:11], v[52:59], v74
  ds_read_b128 v[44:47], v75 offset:61440
  v_smfmac_f32_16x16x64_bf16 v[20:23], v[4:7], a[192:199], v74
  ds_read_b128 v[48:51], v75 offset:62464
  v_smfmac_f32_16x16x64_bf16 v[20:23], v[8:11], a[200:207], v74
  ds_read_b128 v[60:63], v75 offset:63488
  s_waitcnt lgkmcnt(4)
  v_cvt_pk_bf16_f32 v16, v16, v17
  v_cvt_pk_bf16_f32 v17, v18, v19
  v_bfi_b32 v16, 1, s72, v16
  v_smfmac_f32_16x16x64_bf16 v[20:23], v[0:3], v[36:43], v74
  s_waitcnt lgkmcnt(3)
  buffer_store_dwordx2 v[16:17], v68, s[8:11], s73 offen sc1
  v_mov_b64 v[32:33], 0
  v_smfmac_f32_16x16x64_bf16 v[24:27], v[4:7], a[208:215], v74
  ds_read_b128 v[64:67], v75 offset:64512
  v_mov_b64 v[34:35], 0
  v_smfmac_f32_16x16x64_bf16 v[24:27], v[8:11], a[216:223], v74
  ds_read_b128 v[52:55], v75 offset:8192
  v_cvt_pk_bf16_f32 v20, v20, v21
  v_cvt_pk_bf16_f32 v21, v22, v23
  v_bfi_b32 v20, 1, s72, v20
  v_smfmac_f32_16x16x64_bf16 v[24:27], v[0:3], a[224:231], v74
  ds_read_b128 v[56:59], v75 offset:9216
  buffer_store_dwordx2 v[20:21], v68, s[8:11], s74 offen sc1
  s_waitcnt lgkmcnt(4)
  v_mov_b64 v[28:29], 0
  v_smfmac_f32_16x16x64_bf16 v[32:35], v[4:7], v[44:51], v74
  ds_read_b128 v[36:39], v75 offset:10240
  ds_read_b128 v[40:43], v75 offset:11264
  s_waitcnt lgkmcnt(4)
  v_smfmac_f32_16x16x64_bf16 v[32:35], v[8:11], v[60:67], v74
  ds_read_b128 v[44:47], v75 offset:12288
  v_cvt_pk_bf16_f32 v24, v24, v25
  v_cvt_pk_bf16_f32 v25, v26, v27
  v_bfi_b32 v24, 1, s72, v24
  v_smfmac_f32_16x16x64_bf16 v[32:35], v[0:3], a[240:247], v74
  ds_read_b128 v[48:51], v75 offset:13312
  buffer_store_dwordx2 v[24:25], v68, s[8:11], s75 offen sc1
  v_mov_b64 v[30:31], 0
  v_smfmac_f32_16x16x64_bf16 v[32:35], v[12:15], a[248:255], v74
  ds_read_b128 v[60:63], v75 offset:14336
  ds_read_b128 v[64:67], v75 offset:15360
  s_waitcnt lgkmcnt(6)
  v_smfmac_f32_16x16x64_bf16 v[28:31], v[4:7], v[52:59], v74
  s_waitcnt lgkmcnt(4)
  v_smfmac_f32_16x16x64_bf16 v[28:31], v[8:11], v[36:43], v74
  s_waitcnt lgkmcnt(2)
  v_cvt_pk_bf16_f32 v32, v32, v33
  v_cvt_pk_bf16_f32 v33, v34, v35
  v_bfi_b32 v32, 1, s72, v32
  v_smfmac_f32_16x16x64_bf16 v[28:31], v[0:3], v[44:51], v74
  buffer_store_dwordx2 v[32:33], v68, s[8:11], s76 offen sc1
  s_waitcnt lgkmcnt(0)
  v_smfmac_f32_16x16x64_bf16 v[28:31], v[12:15], v[60:67], v74
  v_mov_b64 v[18:19], v[72:73]
  s_nop 4
  v_cvt_pk_bf16_f32 v28, v28, v29
  v_cvt_pk_bf16_f32 v29, v30, v31
  v_bfi_b32 v28, 1, s72, v28
  buffer_store_dwordx2 v[28:29], v68, s[8:11], s77 offen sc1
  ds_read_b128 v[52:55], v76 offset:14848
  s_waitcnt lgkmcnt(0)
  ds_read_b64 v[16:17], v77 offset:392
  s_waitcnt lgkmcnt(0)
  ds_read_b128 v[60:63], v76 offset:47104
  s_waitcnt lgkmcnt(0)
  ds_read_b128 v[64:67], v76 offset:48128
  s_waitcnt lgkmcnt(0)
  s_add_u32 s66, s66, 1
  s_xor_b32 s64, s64, 16384
  s_xor_b32 s65, s65, 16384
  s_add_u32 s58, s58, 655360
  s_add_u32 s59, s59, 655360
  s_add_u32 s70, s70, 655360
  s_add_u32 s68, s68, 655360
  s_mov_b32 m0, 8704
  s_add_u32 s85, s65, 4096
  v_xor_b32 v75, 0x8000, v75
  v_mov_b64 v[28:29], 0
  v_mov_b64 v[30:31], 0
  v_mov_b64 v[32:33], 0
  v_mov_b64 v[34:35], 0
  s_waitcnt vmcnt(0)
  buffer_load_dwordx4 v[0:3], v76, s[8:11], s60 offen offset:0 sc1
  buffer_load_dwordx4 v[4:7], v76, s[8:11], s60 offen offset:1024 sc1
  buffer_load_dwordx4 v[8:11], v76, s[8:11], s61 offen offset:0 sc1
  buffer_load_dwordx4 v[12:15], v76, s[8:11], s61 offen offset:1024 sc1
  v_mov_b64 v[20:21], 0
  v_mov_b64 v[22:23], 0
  v_mov_b64 v[24:25], 0
  v_mov_b64 v[26:27], 0
  v_mov_b32 v68, 14880
  s_cmp_eq_u32 s66, 62
  s_cselect_b64 s[16:17], s[20:21], s[16:17]
  s_cselect_b32 s18, (Cs3_done - Cs3_last), s18
  s_cselect_b32 s70, 0, s70
  s_cmp_eq_u32 s66, 63
  s_cselect_b32 s59, 268435456, s59
  s_cselect_b32 s58, 268435456, s58
  s_waitcnt lgkmcnt(0)
  s_waitcnt vmcnt(3)
  v_mfma_f32_16x16x32_bf16 v[56:59], v[52:55], v[0:3], 0
  v_bitop3_b32 v72, v0, v2, s72 bitop3:0x7e
  s_waitcnt vmcnt(2)
  v_mfma_f32_16x16x32_bf16 v[56:59], v[52:55], v[4:7], v[56:59]
  v_bitop3_b32 v73, v4, v6, s72 bitop3:0x7e
  v_or_b32 v72, v72, v73
  s_waitcnt vmcnt(1)
  v_mfma_f32_16x16x32_bf16 v[36:39], v[52:55], v[8:11], 0
  v_bitop3_b32 v73, v8, v10, s72 bitop3:0x7e
  v_or_b32 v72, v72, v73
  s_waitcnt vmcnt(0)
  v_mfma_f32_16x16x32_bf16 v[36:39], v[52:55], v[12:15], v[36:39]
  v_bitop3_b32 v73, v12, v14, s72 bitop3:0x7e
  v_bitop3_b32 v72, v72, v73, 1 bitop3:0xa8
  v_cmp_ne_u32 vcc, 0, v72
  s_cbranch_vccnz Cs3_h1r
  v_add_f32_dpp v56, v56, v56 row_ror:4 row_mask:0xf bank_mask:0xf
  v_add_f32_dpp v57, v57, v57 row_ror:4 row_mask:0xf bank_mask:0xf
  s_nop 0
  v_add_f32_dpp v36, v36, v36 row_ror:4 row_mask:0xf bank_mask:0xf
  v_add_f32_dpp v37, v37, v37 row_ror:4 row_mask:0xf bank_mask:0xf
  v_add_f32_dpp v56, v56, v56 row_ror:8 row_mask:0xf bank_mask:0xf
  v_add_f32_dpp v57, v57, v57 row_ror:8 row_mask:0xf bank_mask:0xf
  v_add_f32_dpp v36, v36, v36 row_ror:8 row_mask:0xf bank_mask:0xf
  v_add_f32_dpp v37, v37, v37 row_ror:8 row_mask:0xf bank_mask:0xf
  v_cvt_pk_bf16_f32 v56, v56, v57
  buffer_store_dword v56, v69, s[8:11], s62 offen sc1
  v_cvt_pk_bf16_f32 v36, v36, v37
  buffer_store_dword v36, v70, s[8:11], s63 offen sc1
  s_xor_b32 s62, s62, 16384
  buffer_store_dword v71, v69, s[8:11], s62 offen sc1
  s_xor_b32 s63, s63, 16384
  buffer_store_dword v71, v70, s[8:11], s63 offen sc1
  s_xor_b32 s72, s72, 1
  s_branch Cs3_h2
Cs3_h1r:
  s_mov_b64 exec, vcc
  buffer_load_dwordx4 v[0:3], v76, s[8:11], s60 offen offset:0 sc1
  buffer_load_dwordx4 v[4:7], v76, s[8:11], s60 offen offset:1024 sc1
  buffer_load_dwordx4 v[8:11], v76, s[8:11], s61 offen offset:0 sc1
  buffer_load_dwordx4 v[12:15], v76, s[8:11], s61 offen offset:1024 sc1
  s_mov_b64 exec, -1
  s_add_u32 s67, s67, 1
  s_waitcnt vmcnt(3)
  v_mfma_f32_16x16x32_bf16 v[56:59], v[52:55], v[0:3], 0
  v_bitop3_b32 v72, v0, v2, s72 bitop3:0x7e
  s_waitcnt vmcnt(2)
  v_mfma_f32_16x16x32_bf16 v[56:59], v[52:55], v[4:7], v[56:59]
  v_bitop3_b32 v73, v4, v6, s72 bitop3:0x7e
  v_or_b32 v72, v72, v73
  s_waitcnt vmcnt(1)
  v_mfma_f32_16x16x32_bf16 v[36:39], v[52:55], v[8:11], 0
  v_bitop3_b32 v73, v8, v10, s72 bitop3:0x7e
  v_or_b32 v72, v72, v73
  s_waitcnt vmcnt(0)
  v_mfma_f32_16x16x32_bf16 v[36:39], v[52:55], v[12:15], v[36:39]
  v_bitop3_b32 v73, v12, v14, s72 bitop3:0x7e
  v_bitop3_b32 v72, v72, v73, 1 bitop3:0xa8
  v_cmp_ne_u32 vcc, 0, v72
  s_cbranch_vccz Cs3_h1p
Cs3_h1s:
  s_mov_b64 exec, vcc
  buffer_load_dwordx4 v[0:3], v76, s[8:11], s60 offen offset:0 sc1
  buffer_load_dwordx4 v[4:7], v76, s[8:11], s60 offen offset:1024 sc1
  buffer_load_dwordx4 v[8:11], v76, s[8:11], s61 offen offset:0 sc1
  buffer_load_dwordx4 v[12:15], v76, s[8:11], s61 offen offset:1024 sc1
  s_mov_b64 exec, -1
  s_add_u32 s67, s67, 1
  s_waitcnt vmcnt(3)
  v_mfma_f32_16x16x32_bf16 v[56:59], v[52:55], v[0:3], 0
  v_bitop3_b32 v72, v0, v2, s72 bitop3:0x7e
  s_waitcnt vmcnt(2)
  v_mfma_f32_16x16x32_bf16 v[56:59], v[52:55], v[4:7], v[56:59]
  v_bitop3_b32 v73, v4, v6, s72 bitop3:0x7e
  v_or_b32 v72, v72, v73
  s_waitcnt vmcnt(1)
  v_mfma_f32_16x16x32_bf16 v[36:39], v[52:55], v[8:11], 0
  v_bitop3_b32 v73, v8, v10, s72 bitop3:0x7e
  v_or_b32 v72, v72, v73
  s_waitcnt vmcnt(0)
  v_mfma_f32_16x16x32_bf16 v[36:39], v[52:55], v[12:15], v[36:39]
  v_bitop3_b32 v73, v12, v14, s72 bitop3:0x7e
  v_bitop3_b32 v72, v72, v73, 1 bitop3:0xa8
  v_cmp_ne_u32 vcc, 0, v72
  s_cbranch_vccz Cs3_h1p
  s_cmp_lt_u32 s67, 131072
  s_cbranch_scc1 Cs3_h1s
Cs3_h1p:
  s_nop 2
  v_add_f32_dpp v56, v56, v56 row_ror:4 row_mask:0xf bank_mask:0xf
  v_add_f32_dpp v57, v57, v57 row_ror:4 row_mask:0xf bank_mask:0xf
  v_add_f32_dpp v36, v36, v36 row_ror:4 row_mask:0xf bank_mask:0xf
  v_add_f32_dpp v37, v37, v37 row_ror:4 row_mask:0xf bank_mask:0xf
  v_add_f32_dpp v56, v56, v56 row_ror:8 row_mask:0xf bank_mask:0xf
  v_add_f32_dpp v57, v57, v57 row_ror:8 row_mask:0xf bank_mask:0xf
  v_add_f32_dpp v36, v36, v36 row_ror:8 row_mask:0xf bank_mask:0xf
  v_add_f32_dpp v37, v37, v37 row_ror:8 row_mask:0xf bank_mask:0xf
  v_cvt_pk_bf16_f32 v56, v56, v57
  buffer_store_dword v56, v69, s[8:11], s62 offen sc1
  v_cvt_pk_bf16_f32 v36, v36, v37
  buffer_store_dword v36, v70, s[8:11], s63 offen sc1
  s_xor_b32 s62, s62, 16384
  buffer_store_dword v71, v69, s[8:11], s62 offen sc1
  s_xor_b32 s63, s63, 16384
  buffer_store_dword v71, v70, s[8:11], s63 offen sc1
  s_xor_b32 s72, s72, 1
  s_branch Cs3_h2
Cs3_rec:
  s_nop 7
  s_waitcnt vmcnt(0) lgkmcnt(0)
  v_max3_u32 v72, v0, v1, v2
  v_max3_u32 v72, v72, v3, v4
  v_max3_u32 v72, v72, v5, v6
  v_max3_u32 v72, v72, v7, v8
  v_max3_u32 v72, v72, v9, v10
  v_max3_u32 v72, v72, v11, v12
  v_max3_u32 v72, v72, v13, v14
  v_max3_u32 v72, v72, v15, v16
  v_max3_u32 v72, v72, v17, v18
  v_max_u32 v72, v72, v19
  v_cmp_eq_u32 vcc, -1, v72
  s_cbranch_vccz Cs3_recok
  s_barrier
Cs3_recp:
  buffer_load_dwordx4 v[0:3], v76, s[8:11], s64 offen offset:0 sc1
  buffer_load_dwordx4 v[4:7], v76, s[8:11], s64 offen offset:1024 sc1
  buffer_load_dwordx4 v[8:11], v76, s[8:11], s64 offen offset:2048 sc1
  s_add_u32 s67, s67, 1
  s_cmp_lt_u32 s67, 131072
  s_cselect_b32 s54, -2, -1
  s_waitcnt vmcnt(2)
  v_max3_u32 v72, v0, v1, v2
  s_waitcnt vmcnt(1)
  v_max3_u32 v72, v72, v3, v4
  v_max3_u32 v72, v72, v5, v6
  s_waitcnt vmcnt(0)
  v_max3_u32 v72, v72, v7, v8
  v_max3_u32 v72, v72, v9, v10
  v_max_u32 v72, v72, v11
  v_cmp_lt_u32 vcc, s54, v72
  s_cbranch_vccnz Cs3_recp
  ds_write_b128 v76, v[0:3] offset:10752
  ds_write_b128 v76, v[4:7] offset:11776
  ds_write_b128 v76, v[8:11] offset:12800
  v_mov_b64 v[20:21], 0
  v_mov_b64 v[22:23], 0
  v_mov_b64 v[24:25], 0
  v_mov_b64 v[26:27], 0
  v_mov_b64 v[28:29], 0
  v_mov_b64 v[30:31], 0
  v_mov_b64 v[32:33], 0
  v_mov_b64 v[34:35], 0
  s_waitcnt lgkmcnt(0)
  s_barrier
  ds_read_b128 v[0:3], v76 offset:4608
  s_waitcnt lgkmcnt(0)
  v_smfmac_f32_16x16x64_bf16 v[20:23], v[0:3], v[80:87], v74
  v_smfmac_f32_16x16x64_bf16 v[24:27], v[0:3], v[88:95], v74
  ds_read_b128 v[60:63], v76 offset:28672
  ds_read_b128 v[64:67], v76 offset:29696
  s_waitcnt lgkmcnt(0)
  v_smfmac_f32_16x16x64_bf16 v[28:31], v[0:3], v[60:67], v74
  ds_read_b128 v[60:63], v76 offset:30720
  ds_read_b128 v[64:67], v76 offset:31744
  s_waitcnt lgkmcnt(0)
  v_smfmac_f32_16x16x64_bf16 v[32:35], v[0:3], v[60:67], v74
  ds_read_b128 v[4:7], v76 offset:5632
  s_waitcnt lgkmcnt(0)
  v_smfmac_f32_16x16x64_bf16 v[20:23], v[4:7], v[96:103], v74
  v_smfmac_f32_16x16x64_bf16 v[24:27], v[4:7], v[104:111], v74
  ds_read_b128 v[60:63], v76 offset:45056
  ds_read_b128 v[64:67], v76 offset:46080
  s_waitcnt lgkmcnt(0)
  v_smfmac_f32_16x16x64_bf16 v[28:31], v[4:7], v[60:67], v74
  ds_read_b128 v[60:63], v76 offset:47104
  ds_read_b128 v[64:67], v76 offset:48128
  s_waitcnt lgkmcnt(0)
  v_smfmac_f32_16x16x64_bf16 v[32:35], v[4:7], v[60:67], v74
  ds_read_b128 v[8:11], v76 offset:6656
  s_waitcnt lgkmcnt(0)
  v_smfmac_f32_16x16x64_bf16 v[20:23], v[8:11], v[112:119], v74
  v_smfmac_f32_16x16x64_bf16 v[24:27], v[8:11], v[120:127], v74
  v_smfmac_f32_16x16x64_bf16 v[28:31], v[8:11], v[208:215], v74
  v_smfmac_f32_16x16x64_bf16 v[32:35], v[8:11], v[216:223], v74
  ds_read_b128 v[12:15], v76 offset:7680
  s_waitcnt lgkmcnt(0)
  v_smfmac_f32_16x16x64_bf16 v[20:23], v[12:15], v[128:135], v74
  v_smfmac_f32_16x16x64_bf16 v[24:27], v[12:15], v[136:143], v74
  v_smfmac_f32_16x16x64_bf16 v[28:31], v[12:15], v[224:231], v74
  v_smfmac_f32_16x16x64_bf16 v[32:35], v[12:15], v[232:239], v74
  ds_read_b128 v[4:7], v76 offset:8704
  s_waitcnt lgkmcnt(0)
  v_smfmac_f32_16x16x64_bf16 v[20:23], v[4:7], v[144:151], v74
  v_smfmac_f32_16x16x64_bf16 v[24:27], v[4:7], v[152:159], v74
  ds_read_b128 v[60:63], v76 offset:61440
  ds_read_b128 v[64:67], v76 offset:62464
  s_waitcnt lgkmcnt(0)
  v_smfmac_f32_16x16x64_bf16 v[28:31], v[4:7], v[60:67], v74
  ds_read_b128 v[60:63], v76 offset:63488
  ds_read_b128 v[64:67], v76 offset:64512
  s_waitcnt lgkmcnt(0)
  v_smfmac_f32_16x16x64_bf16 v[32:35], v[4:7], v[60:67], v74
  ds_read_b128 v[8:11], v76 offset:9728
  s_waitcnt lgkmcnt(0)
  v_smfmac_f32_16x16x64_bf16 v[20:23], v[8:11], v[160:167], v74
  v_smfmac_f32_16x16x64_bf16 v[24:27], v[8:11], v[168:175], v74
  ds_read_b128 v[60:63], v75 offset:28672
  ds_read_b128 v[64:67], v75 offset:29696
  s_waitcnt lgkmcnt(0)
  v_smfmac_f32_16x16x64_bf16 v[28:31], v[8:11], v[60:67], v74
  ds_read_b128 v[60:63], v75 offset:30720
  ds_read_b128 v[64:67], v75 offset:31744
  s_waitcnt lgkmcnt(0)
  v_smfmac_f32_16x16x64_bf16 v[32:35], v[8:11], v[60:67], v74
  ds_read_b128 v[16:19], v76 offset:10752
  ds_read_b128 v[60:63], v75 offset:12288
  ds_read_b128 v[64:67], v75 offset:13312
  s_waitcnt lgkmcnt(0)
  v_smfmac_f32_16x16x64_bf16 v[20:23], v[16:19], v[60:67], v74
  ds_read_b128 v[60:63], v75 offset:14336
  ds_read_b128 v[64:67], v75 offset:15360
  s_waitcnt lgkmcnt(0)
  v_smfmac_f32_16x16x64_bf16 v[24:27], v[16:19], v[60:67], v74
  v_smfmac_f32_16x16x64_bf16 v[28:31], v[16:19], v[240:247], v74
  v_smfmac_f32_16x16x64_bf16 v[32:35], v[16:19], v[248:255], v74
  ds_read_b128 v[0:3], v76 offset:11776
  s_waitcnt lgkmcnt(0)
  v_smfmac_f32_16x16x64_bf16 v[20:23], v[0:3], v[176:183], v74
  v_smfmac_f32_16x16x64_bf16 v[24:27], v[0:3], v[184:191], v74
  v_smfmac_f32_16x16x64_bf16 v[28:31], v[0:3], a[0:7], v74
  v_smfmac_f32_16x16x64_bf16 v[32:35], v[0:3], a[8:15], v74
  ds_read_b128 v[12:15], v76 offset:12800
  s_waitcnt lgkmcnt(0)
  v_smfmac_f32_16x16x64_bf16 v[20:23], v[12:15], v[192:199], v74
  v_smfmac_f32_16x16x64_bf16 v[24:27], v[12:15], v[200:207], v74
  v_smfmac_f32_16x16x64_bf16 v[28:31], v[12:15], a[16:23], v74
  v_smfmac_f32_16x16x64_bf16 v[32:35], v[12:15], a[24:31], v74
  v_add_f32 v20, v20, v22
  v_add_f32 v21, v21, v23
  v_add_f32 v24, v24, v26
  v_cvt_pk_bf16_f32 v22, v20, v24
  ds_write_b32 v79, v22 offset:0
  v_add_f32 v25, v25, v27
  v_cvt_pk_bf16_f32 v23, v21, v25
  ds_write_b32 v79, v23 offset:576
  v_add_f32 v28, v28, v30
  v_add_f32 v29, v29, v31
  s_waitcnt lgkmcnt(0)
  s_nop 1
  s_branch Cs3_recok
Cs3_mx:
  s_waitcnt lgkmcnt(0)
  s_barrier
  buffer_load_dwordx4 v[52:55], v76, s[8:11], s59 offen offset:0 sc1
  buffer_load_dwordx4 v[0:3], v76, s[8:11], s58 offen offset:0 sc1
  ds_read_b128 v[20:23], v77 offset:0
  ds_read_b128 v[28:31], v77 offset:256
  buffer_load_dwordx4 v[56:59], v76, s[8:11], s59 offen offset:1024 sc1
  buffer_load_dwordx4 v[4:7], v76, s[8:11], s58 offen offset:1024 sc1
  ds_read_b128 v[24:27], v77 offset:128
  ds_read_b128 v[32:35], v77 offset:384
  s_waitcnt vmcnt(2) lgkmcnt(3)
  v_mfma_f32_16x16x32_bf16 v[8:11], v[0:3], v[20:23], 0
  s_waitcnt vmcnt(0) lgkmcnt(1)
  v_mfma_f32_16x16x32_bf16 v[8:11], v[4:7], v[24:27], v[8:11]
  v_mfma_f32_16x16x32_bf16 v[12:15], v[28:31], v[20:23], 0
  s_waitcnt lgkmcnt(0)
  v_mfma_f32_16x16x32_bf16 v[12:15], v[32:35], v[24:27], v[12:15]
  v_add_f32_dpp v8, v10, v8 quad_perm:[2,3,0,1] row_mask:0xf bank_mask:0xf
  v_add_f32_dpp v9, v11, v9 quad_perm:[2,3,0,1] row_mask:0xf bank_mask:0xf
  s_nop 0
  v_mov_b32_dpp v8, v8 quad_perm:[0,1,0,1] row_mask:0xf bank_mask:0xf
  v_mov_b32_dpp v9, v9 quad_perm:[0,1,0,1] row_mask:0xf bank_mask:0xf
  s_nop 1
  v_add_f32_dpp v12, v14, v12 quad_perm:[2,3,0,1] row_mask:0xf bank_mask:0xf
  v_add_f32_dpp v13, v15, v13 quad_perm:[2,3,0,1] row_mask:0xf bank_mask:0xf
  s_nop 0
  v_mov_b32_dpp v12, v12 quad_perm:[0,1,0,1] row_mask:0xf bank_mask:0xf
  v_mov_b32_dpp v13, v13 quad_perm:[0,1,0,1] row_mask:0xf bank_mask:0xf
  v_mul_f32 v12, s69, v12
  ds_write_b32 v78, v8 offset:8716
  v_mul_f32 v13, s69, v13
  ds_write_b32 v78, v9 offset:8780
  s_waitcnt lgkmcnt(0)
  s_barrier
  ds_read_b128 v[36:39], v78 offset:8704
  ds_read_b128 v[40:43], v78 offset:8768
  s_waitcnt lgkmcnt(0)
  s_barrier
  v_max_f32 v16, v36, v37
  v_max3_f32 v16, v16, v38, v39
  v_max3_f32 v16, v16, v40, v41
  v_max3_f32 v16, v16, v42, v43
  v_max3_f32 v16, v16, v12, v13
  v_mov_b32 v17, v16
  s_nop 1
  v_permlane16_swap_b32 v16, v17
  v_max_f32 v16, v16, v17
  v_mov_b32 v17, v16
  s_nop 1
  v_permlane32_swap_b32 v16, v17
  v_max_f32 v16, v16, v17
  v_sub_f32 v36, v36, v16
  v_sub_f32 v37, v37, v16
  v_sub_f32 v38, v38, v16
  v_sub_f32 v39, v39, v16
  v_sub_f32 v40, v40, v16
  v_sub_f32 v41, v41, v16
  v_sub_f32 v42, v42, v16
  v_sub_f32 v43, v43, v16
  v_sub_f32 v12, v12, v16
  v_sub_f32 v13, v13, v16
  v_exp_f32 v36, v36
  v_exp_f32 v37, v37
  v_exp_f32 v38, v38
  v_exp_f32 v39, v39
  v_exp_f32 v40, v40
  v_exp_f32 v41, v41
  v_exp_f32 v42, v42
  v_exp_f32 v43, v43
  v_exp_f32 v12, v12
  v_exp_f32 v13, v13
  v_cvt_pk_bf16_f32 v32, v36, v40
  v_cvt_pk_bf16_f32 v33, v37, v41
  v_cvt_pk_bf16_f32 v34, v38, v42
  v_cvt_pk_bf16_f32 v35, v39, v43
  v_cvt_pk_bf16_f32 v28, v12, v13
  v_cvt_pk_bf16_f32 v31, v12, v13
  v_mov_b32 v29, 0
  v_mov_b32 v30, 0
  v_mfma_f32_16x16x32_bf16 v[8:11], v[32:35], v[68:71], 0
  v_mfma_f32_16x16x32_bf16 v[0:3], v[32:35], v[52:55], 0
  v_mfma_f32_16x16x32_bf16 v[4:7], v[32:35], v[56:59], 0
  v_mfma_f32_16x16x16_bf16 v[8:11], v[28:29], v[68:69], v[8:11]
  v_mfma_f32_16x16x16_bf16 v[0:3], v[28:29], v[72:73], v[0:3]
  v_mfma_f32_16x16x16_bf16 v[4:7], v[30:31], v[72:73], v[4:7]
  ds_read_b128 v[52:55], v75 offset:30720
  v_rcp_f32 v10, v8
  v_rcp_f32 v11, v9
  v_mul_f32 v0, v10, v0
  v_mul_f32 v1, v11, v1
  v_max3_f32 v8, v8, v9, v10
  v_mul_f32 v4, v10, v4
  v_mul_f32 v5, v11, v5
  v_cvt_pk_bf16_f32 v2, v0, v4
  ds_write_b32 v79, v2 offset:8704
  v_cvt_pk_bf16_f32 v3, v1, v5
  ds_write_b32 v79, v3 offset:9280
  ds_read_b128 v[12:15], v78 offset:8896
  ds_read_b128 v[56:59], v75 offset:31744
  v_mov_b64 v[16:17], 0
  v_mov_b64 v[18:19], 0
  v_mov_b64 v[20:21], 0
  v_mov_b64 v[22:23], 0
  v_mov_b64 v[24:25], 0
  v_mov_b64 v[26:27], 0
  s_branch Cs3_mxok
Cs3_last:
  ds_read_b128 v[0:3], v76 offset:4608
  ds_read_b128 v[12:15], v76 offset:7680
  ds_read_b128 v[44:47], v76 offset:28672
  ds_read_b128 v[48:51], v76 offset:29696
  s_nop 5
  v_mov_b64 v[20:21], 0
  v_mov_b64 v[22:23], 0
  v_mov_b64 v[24:25], 0
  v_mov_b64 v[26:27], 0
  v_smfmac_f32_16x16x64_bf16 v[28:31], v[4:7], v[36:43], v74
  ds_read_b128 v[36:39], v76 offset:30720
  ds_read_b128 v[40:43], v76 offset:31744
  v_smfmac_f32_16x16x64_bf16 v[32:35], v[4:7], v[60:67], v74
  s_waitcnt lgkmcnt(5)
  v_smfmac_f32_16x16x64_bf16 v[20:23], v[0:3], a[32:39], v74
  ds_read_b128 v[60:63], v76 offset:61440
  ds_read_b128 v[64:67], v76 offset:62464
  v_smfmac_f32_16x16x64_bf16 v[24:27], v[0:3], a[40:47], v74
  s_waitcnt lgkmcnt(4)
  v_smfmac_f32_16x16x64_bf16 v[20:23], v[4:7], a[48:55], v74
  buffer_store_dwordx4 v[16:19], v76, s[8:11], s68 offen sc1
  v_smfmac_f32_16x16x64_bf16 v[24:27], v[4:7], a[56:63], v74
  v_smfmac_f32_16x16x64_bf16 v[28:31], v[0:3], v[44:51], v74
  s_waitcnt lgkmcnt(2)
  v_smfmac_f32_16x16x64_bf16 v[20:23], v[8:11], a[64:71], v74
  ds_read_b128 v[44:47], v76 offset:63488
  ds_read_b128 v[48:51], v76 offset:64512
  v_smfmac_f32_16x16x64_bf16 v[24:27], v[8:11], a[72:79], v74
  v_smfmac_f32_16x16x64_bf16 v[32:35], v[0:3], v[36:43], v74
  v_smfmac_f32_16x16x64_bf16 v[28:31], v[8:11], v[208:215], v74
  ds_read_b128 v[36:39], v75 offset:28672
  ds_read_b128 v[40:43], v75 offset:29696
  v_smfmac_f32_16x16x64_bf16 v[32:35], v[8:11], v[216:223], v74
  v_smfmac_f32_16x16x64_bf16 v[20:23], v[12:15], a[80:87], v74
  v_smfmac_f32_16x16x64_bf16 v[24:27], v[12:15], a[88:95], v74
  v_smfmac_f32_16x16x64_bf16 v[28:31], v[12:15], v[224:231], v74
  v_smfmac_f32_16x16x64_bf16 v[32:35], v[12:15], v[232:239], v74
  s_waitcnt vmcnt(1)
  s_barrier
Cs3_lastr:
  ds_read_b128 v[4:7], v76 offset:8704
  ds_read_b128 v[8:11], v76 offset:9728
  ds_read_b128 v[16:19], v76 offset:10752
  ds_read_b128 v[0:3], v76 offset:11776
  ds_read_b128 v[12:15], v76 offset:12800
  s_waitcnt lgkmcnt(1)
  v_max3_u32 v72, v0, v1, v2
  v_max3_u32 v72, v72, v3, v4
  v_max3_u32 v72, v72, v5, v6
  v_max3_u32 v72, v72, v7, v8
  v_max3_u32 v72, v72, v9, v10
  s_waitcnt lgkmcnt(0)
  v_max3_u32 v72, v72, v11, v12
  v_max3_u32 v72, v72, v13, v14
  v_max3_u32 v72, v72, v15, v16
  v_max3_u32 v72, v72, v17, v18
  v_max_u32 v72, v72, v19
  v_cmp_eq_u32 vcc, -1, v72
  s_cbranch_vccnz Cs3_lastp
Cs3_lastg:
  v_smfmac_f32_16x16x64_bf16 v[28:31], v[4:7], v[60:67], v74
  ds_read_b128 v[60:63], v75 offset:30720
  ds_read_b128 v[64:67], v75 offset:31744
  v_smfmac_f32_16x16x64_bf16 v[32:35], v[4:7], v[44:51], v74
  v_smfmac_f32_16x16x64_bf16 v[28:31], v[8:11], v[36:43], v74
  v_smfmac_f32_16x16x64_bf16 v[28:31], v[16:19], v[240:247], v74
  v_smfmac_f32_16x16x64_bf16 v[28:31], v[0:3], a[0:7], v74
  v_smfmac_f32_16x16x64_bf16 v[28:31], v[12:15], a[16:23], v74
  v_smfmac_f32_16x16x64_bf16 v[32:35], v[16:19], v[248:255], v74
  v_smfmac_f32_16x16x64_bf16 v[32:35], v[0:3], a[8:15], v74
  s_waitcnt lgkmcnt(0)
  v_smfmac_f32_16x16x64_bf16 v[32:35], v[12:15], a[24:31], v74
  v_smfmac_f32_16x16x64_bf16 v[32:35], v[8:11], v[60:67], v74
  v_smfmac_f32_16x16x64_bf16 v[20:23], v[4:7], a[96:103], v74
  v_smfmac_f32_16x16x64_bf16 v[20:23], v[8:11], a[112:119], v74
  v_add_f32 v28, v28, v30
  v_add_f32 v32, v32, v34
  v_cvt_pk_bf16_f32 v30, v28, v32
  v_smfmac_f32_16x16x64_bf16 v[20:23], v[16:19], a[128:135], v74
  ds_write_b32 v79, v30 offset:256
  v_add_f32 v29, v29, v31
  v_add_f32 v33, v33, v35
  v_cvt_pk_bf16_f32 v31, v29, v33
  v_smfmac_f32_16x16x64_bf16 v[20:23], v[0:3], a[144:151], v74
  ds_write_b32 v79, v31 offset:832
  v_smfmac_f32_16x16x64_bf16 v[20:23], v[12:15], a[160:167], v74
  v_smfmac_f32_16x16x64_bf16 v[24:27], v[4:7], a[104:111], v74
  v_smfmac_f32_16x16x64_bf16 v[24:27], v[8:11], a[120:127], v74
  v_smfmac_f32_16x16x64_bf16 v[24:27], v[16:19], a[136:143], v74
  s_waitcnt lgkmcnt(0)
  s_barrier
  ds_read_b64 v[52:53], v77 offset:392
  v_add_f32 v20, v20, v22
  v_smfmac_f32_16x16x64_bf16 v[24:27], v[0:3], a[152:159], v74
  v_add_f32 v21, v21, v23
  v_smfmac_f32_16x16x64_bf16 v[24:27], v[12:15], a[168:175], v74
  v_cvt_pk_bf16_f32 v54, v20, v21
  s_add_u32 s68, s68, 655360
  s_nop 3
  v_add_f32 v24, v24, v26
  v_add_f32 v25, v25, v27
  v_cvt_pk_bf16_f32 v55, v24, v25
  s_waitcnt lgkmcnt(0)
  buffer_store_dwordx4 v[52:55], v76, s[8:11], s68 offen sc1
  s_branch Cs3_done
Cs3_lastp:
  s_add_u32 s72, s72, 2
  s_cmp_ge_u32 s72, 131072
  s_cbranch_scc1 Cs3_lastg
  s_barrier
  buffer_load_dwordx4 v76, s[8:11], s85 offen offset:0 sc1 lds
  buffer_load_dwordx4 v76, s[8:11], s85 offen offset:1024 sc1 lds
  s_waitcnt vmcnt(0)
  s_barrier
  s_branch Cs3_lastr
Cs3_done:
  s_branch L_cexit
L_conf:
  s_nop 11
  s_waitcnt vmcnt(0) lgkmcnt(0)
  s_barrier
  s_cmp_eq_u32 s52, 0
  s_cbranch_scc0 L_cf2
  s_mov_b64 exec, 1
  s_lshl_b32 s57, s2, 2
  v_mov_b32 v1, 0
L_cf0:
  s_cmp_eq_u32 s54, -1
  s_cbranch_scc1 L_cf1
  s_mov_b32 s55, s54
  s_lshr_b64 s[54:55], s[54:55], s0
  s_ff0_i32_b32 s56, s54
  s_add_u32 s0, s0, s56
  s_and_b32 s0, s0, 31
  s_lshl_b32 s56, 1, s0
  v_mov_b32 v35, s56
  buffer_atomic_or v35, v1, s[12:15], s57 offen sc0
  s_waitcnt vmcnt(0)
  v_readfirstlane_b32 s54, v35
  s_nop 0
  s_bitcmp1_b32 s54, s0
  s_cbranch_scc1 L_cf0
  v_mov_b32 v35, s0
  s_branch L_cf3
L_cf1:
  v_mov_b32 v35, 1
  buffer_atomic_add v35, v1, s[12:15], 0 offen offset:40 sc0
  s_waitcnt vmcnt(0)
  v_add_u32 v35, 32, v35
L_cf3:
  ds_write_b32 v33, v35
  s_mov_b64 exec, -1
  s_waitcnt lgkmcnt(0)
L_cf2:
  s_barrier
  ds_read_b32 v32, v33
  s_waitcnt lgkmcnt(0)
  v_readfirstlane_b32 s0, v32
  v_mbcnt_lo_u32_b32 v0, -1, 0
  v_mbcnt_hi_u32_b32 v0, -1, v0
  s_mov_b32 s1, 1
  s_cmp_lt_u32 s0, 32
  s_cbranch_scc1 L_role
  s_sub_u32 s53, s0, 32
  s_mov_b32 s57, 0
L_sur:
  s_load_dwordx16 s[60:75], s[12:13], 0 glc
  s_add_u32 s57, s57, 1
  s_waitcnt lgkmcnt(0)
  s_mov_b32 s55, s70
  s_bcnt1_i32_b32 s56, s60
  s_add_u32 s55, s55, s56
  s_bcnt1_i32_b32 s56, s61
  s_add_u32 s55, s55, s56
  s_bcnt1_i32_b32 s56, s62
  s_add_u32 s55, s55, s56
  s_bcnt1_i32_b32 s56, s63
  s_add_u32 s55, s55, s56
  s_bcnt1_i32_b32 s56, s64
  s_add_u32 s55, s55, s56
  s_bcnt1_i32_b32 s56, s65
  s_add_u32 s55, s55, s56
  s_bcnt1_i32_b32 s56, s66
  s_add_u32 s55, s55, s56
  s_bcnt1_i32_b32 s56, s67
  s_add_u32 s55, s55, s56
  s_cmp_ge_u32 s57, 131072
  s_cbranch_scc1 L_end
  s_cmp_lt_u32 s55, 256
  s_cbranch_scc1 L_sur
  s_mov_b32 s2, 0
  s_mov_b32 s54, s60
  s_bcnt0_i32_b32 s56, s54
  s_cmp_lt_u32 s53, s56
  s_cbranch_scc1 L_sur2
  s_sub_u32 s53, s53, s56
  s_mov_b32 s2, 1
  s_mov_b32 s54, s61
  s_bcnt0_i32_b32 s56, s54
  s_cmp_lt_u32 s53, s56
  s_cbranch_scc1 L_sur2
  s_sub_u32 s53, s53, s56
  s_mov_b32 s2, 2
  s_mov_b32 s54, s62
  s_bcnt0_i32_b32 s56, s54
  s_cmp_lt_u32 s53, s56
  s_cbranch_scc1 L_sur2
  s_sub_u32 s53, s53, s56
  s_mov_b32 s2, 3
  s_mov_b32 s54, s63
  s_bcnt0_i32_b32 s56, s54
  s_cmp_lt_u32 s53, s56
  s_cbranch_scc1 L_sur2
  s_sub_u32 s53, s53, s56
  s_mov_b32 s2, 4
  s_mov_b32 s54, s64
  s_bcnt0_i32_b32 s56, s54
  s_cmp_lt_u32 s53, s56
  s_cbranch_scc1 L_sur2
  s_sub_u32 s53, s53, s56
  s_mov_b32 s2, 5
  s_mov_b32 s54, s65
  s_bcnt0_i32_b32 s56, s54
  s_cmp_lt_u32 s53, s56
  s_cbranch_scc1 L_sur2
  s_sub_u32 s53, s53, s56
  s_mov_b32 s2, 6
  s_mov_b32 s54, s66
  s_bcnt0_i32_b32 s56, s54
  s_cmp_lt_u32 s53, s56
  s_cbranch_scc1 L_sur2
  s_sub_u32 s53, s53, s56
  s_mov_b32 s2, 7
  s_mov_b32 s54, s67
  s_bcnt0_i32_b32 s56, s54
  s_cmp_lt_u32 s53, s56
  s_cbranch_scc1 L_sur2
  s_sub_u32 s53, s53, s56
  s_branch L_end
L_sur2:
  s_ff0_i32_b32 s0, s54
  s_bitset1_b32 s54, s0
  s_sub_u32 s53, s53, 1
  s_cbranch_scc0 L_sur2
  s_branch L_role
L_worker:
  s_lshl_b32 s54, s2, 2
  s_lshr_b32 s54, 1412567136, s54
  s_and_b32 s54, s54, 7
  s_lshl_b32 s54, s54, 5
  s_add_u32 s53, s53, s54
  s_getpc_b64 s[80:81]
L_pc_2:
  s_and_b32 s55, s0, 1
  s_lshl_b32 s55, s55, 2
  s_add_u32 s55, s55, s52
  s_lshl_b32 s55, s55, 13
  v_and_b32 v199, 63, v0
  v_lshl_add_u32 v199, v199, 7, s55
  s_sub_u32 s82, s80, (L_pc_2 - L_w0)
  s_subb_u32 s83, s81, 0
  v_min_u32 v198, (L_w4 - L_w0), v199
  global_load_dword v196, v198, s[82:83]
  v_min_u32 v199, (L_end - L_pc_2), v199
  global_load_dword v196, v199, s[80:81]
  v_and_b32 v200, 63, v0
  v_lshlrev_b32 v201, 4, v200
  v_lshrrev_b32 v211, 3, v200
  s_lshl_b32 s54, s52, 3
  v_add_u32 v211, s54, v211
  v_bfe_u32 v212, v211, 1, 3
  v_and_b32 v213, 7, v200
  v_xor_b32 v212, v212, v213
  v_mul_u32_u24 v211, 1152, v211
  v_lshl_add_u32 v202, v212, 4, v211
  s_mul_i32 s67, s52, 9216
  v_and_b32 v211, 31, v200
  v_lshrrev_b32 v212, 3, v211
  v_mul_u32_u24 v212, 9216, v212
  v_and_b32 v213, 7, v211
  v_lshl_add_u32 v212, v213, 7, v212
  v_bfe_u32 v213, v211, 1, 3
  v_lshrrev_b32 v214, 5, v200
  v_xor_b32 v213, v213, v214
  v_lshl_add_u32 v203, v213, 4, v212
  v_xor_b32 v204, 32, v203
  v_xor_b32 v205, 64, v203
  v_xor_b32 v206, 0x60, v203
  v_bfe_u32 v211, v200, 2, 2
  v_lshl_add_u32 v212, v214, 3, v211
  v_lshlrev_b32 v212, 8, v212
  v_xor_b32 v211, s52, v211
  v_lshl_add_u32 v212, v211, 6, v212
  v_bfe_u32 v213, v200, 4, 1
  v_and_b32 v211, 3, v200
  v_lshl_add_u32 v210, v213, 5, v212
  v_lshl_add_u32 v210, v211, 3, v210
  v_lshl_add_u32 v209, v213, 4, v212
  v_and_b32 v213, 1, v211
  v_lshl_add_u32 v209, v213, 3, v209
  v_lshrrev_b32 v213, 1, v211
  v_lshl_add_u32 v209, v213, 5, v209
  s_mov_b32 s65, 0
  s_mul_i32 s58, s53, 9363
  s_lshr_b32 s58, s58, 16
  s_mul_i32 s54, s58, 7
  s_sub_u32 s59, s53, s54
  s_mul_i32 s60, s59, 36864
  s_add_u32 m0, s67, 0
  s_nop 0
  buffer_load_dwordx4 v202, s[4:7], s60 offen offset:0 lds
  s_add_u32 m0, s67, 896
  s_nop 0
  buffer_load_dwordx4 v202, s[4:7], s60 offen offset:128 lds
  s_add_u32 m0, s67, 1792
  s_nop 0
  buffer_load_dwordx4 v202, s[4:7], s60 offen offset:256 lds
  s_add_u32 m0, s67, 2688
  s_nop 0
  buffer_load_dwordx4 v202, s[4:7], s60 offen offset:384 lds
  s_add_u32 m0, s67, 3584
  s_nop 0
  buffer_load_dwordx4 v202, s[4:7], s60 offen offset:512 lds
  s_add_u32 m0, s67, 4480
  s_nop 0
  buffer_load_dwordx4 v202, s[4:7], s60 offen offset:640 lds
  s_add_u32 m0, s67, 5376
  s_nop 0
  buffer_load_dwordx4 v202, s[4:7], s60 offen offset:768 lds
  s_add_u32 m0, s67, 6272
  s_nop 0
  buffer_load_dwordx4 v202, s[4:7], s60 offen offset:896 lds
  s_add_u32 m0, s67, 7168
  s_nop 0
  buffer_load_dwordx4 v202, s[4:7], s60 offen offset:1024 lds
  v_lshrrev_b32 v211, 4, v200
  v_lshlrev_b32 v212, 2, v211
  v_and_b32 v213, 15, v200
  v_xor_b32 v212, v212, v213
  v_lshlrev_b32 v212, 4, v212
  v_lshl_add_u32 v207, v211, 13, v212
  s_lshl_b32 s62, s58, 8
  s_lshl_b32 s54, s52, 15
  s_add_u32 s62, s62, s54
  s_lshl_b32 s61, s52, 10
  s_add_u32 s61, s61, 36864
  s_add_u32 m0, s61, 0
  s_add_u32 s54, s62, 0
  buffer_load_dwordx4 v207, s[20:23], s54 offen lds
  s_add_u32 m0, s61, 4096
  s_add_u32 s54, s62, 131072
  buffer_load_dwordx4 v207, s[20:23], s54 offen lds
  s_add_u32 m0, s61, 8192
  s_add_u32 s54, s62, 262144
  buffer_load_dwordx4 v207, s[20:23], s54 offen lds
  s_add_u32 m0, s61, 12288
  s_add_u32 s54, s62, 393216
  buffer_load_dwordx4 v207, s[20:23], s54 offen lds
  s_add_u32 m0, s61, 16384
  s_add_u32 s54, s62, 0
  buffer_load_dwordx4 v207, s[24:27], s54 offen lds
  s_add_u32 m0, s61, 20480
  s_add_u32 s54, s62, 131072
  buffer_load_dwordx4 v207, s[24:27], s54 offen lds
  s_add_u32 m0, s61, 24576
  s_add_u32 s54, s62, 262144
  buffer_load_dwordx4 v207, s[24:27], s54 offen lds
  s_add_u32 m0, s61, 28672
  s_add_u32 s54, s62, 393216
  buffer_load_dwordx4 v207, s[24:27], s54 offen lds
  s_add_u32 m0, s61, 32768
  s_add_u32 s54, s62, 524288
  buffer_load_dwordx4 v207, s[20:23], s54 offen lds
  s_add_u32 m0, s61, 36864
  s_add_u32 s54, s62, 655360
  buffer_load_dwordx4 v207, s[20:23], s54 offen lds
  s_add_u32 m0, s61, 40960
  s_add_u32 s54, s62, 786432
  buffer_load_dwordx4 v207, s[20:23], s54 offen lds
  s_add_u32 m0, s61, 45056
  s_add_u32 s54, s62, 917504
  buffer_load_dwordx4 v207, s[20:23], s54 offen lds
  s_add_u32 m0, s61, 49152
  s_add_u32 s54, s62, 524288
  buffer_load_dwordx4 v207, s[24:27], s54 offen lds
  s_add_u32 m0, s61, 53248
  s_add_u32 s54, s62, 655360
  buffer_load_dwordx4 v207, s[24:27], s54 offen lds
  s_add_u32 m0, s61, 57344
  s_add_u32 s54, s62, 786432
  buffer_load_dwordx4 v207, s[24:27], s54 offen lds
  s_add_u32 m0, s61, 61440
  s_add_u32 s54, s62, 917504
  buffer_load_dwordx4 v207, s[24:27], s54 offen lds
  s_add_u32 m0, s61, 65536
  s_add_u32 s54, s62, 1048576
  buffer_load_dwordx4 v207, s[20:23], s54 offen lds
  s_add_u32 m0, s61, 69632
  s_add_u32 s54, s62, 1179648
  buffer_load_dwordx4 v207, s[20:23], s54 offen lds
  s_add_u32 m0, s61, 73728
  s_add_u32 s54, s62, 1310720
  buffer_load_dwordx4 v207, s[20:23], s54 offen lds
  s_add_u32 m0, s61, 77824
  s_add_u32 s54, s62, 1441792
  buffer_load_dwordx4 v207, s[20:23], s54 offen lds
  s_add_u32 m0, s61, 81920
  s_add_u32 s54, s62, 1048576
  buffer_load_dwordx4 v207, s[24:27], s54 offen lds
  s_add_u32 m0, s61, 86016
  s_add_u32 s54, s62, 1179648
  buffer_load_dwordx4 v207, s[24:27], s54 offen lds
  s_add_u32 m0, s61, 90112
  s_add_u32 s54, s62, 1310720
  buffer_load_dwordx4 v207, s[24:27], s54 offen lds
  s_add_u32 m0, s61, 94208
  s_add_u32 s54, s62, 1441792
  buffer_load_dwordx4 v207, s[24:27], s54 offen lds
  v_bfe_u32 v211, v200, 3, 2
  v_lshlrev_b32 v216, 11, v211
  v_bfe_u32 v211, v200, 1, 2
  v_lshl_add_u32 v216, v211, 6, v216
  v_lshrrev_b32 v212, 5, v200
  v_lshl_add_u32 v216, v212, 5, v216
  v_and_b32 v211, 1, v200
  v_lshl_add_u32 v216, v211, 4, v216
  v_bfe_u32 v211, v200, 4, 1
  v_lshlrev_b32 v217, 10, v211
  v_lshl_add_u32 v217, v212, 9, v217
  v_and_b32 v211, 15, v200
  v_lshl_add_u32 v217, v211, 4, v217
  s_lshl_b32 s54, s52, 11
  s_add_u32 s54, s54, 8192
  v_add_u32 v217, s54, v217
  s_waitcnt vmcnt(20) lgkmcnt(0)
  s_barrier
  s_add_u32 m0, s61, 98304
  s_add_u32 s54, s62, 1572864
  buffer_load_dwordx4 v207, s[20:23], s54 offen lds
  s_add_u32 m0, s61, 102400
  s_add_u32 s54, s62, 1703936
  buffer_load_dwordx4 v207, s[20:23], s54 offen lds
  s_add_u32 m0, s61, 106496
  s_add_u32 s54, s62, 1835008
  buffer_load_dwordx4 v207, s[20:23], s54 offen lds
  s_add_u32 m0, s61, 110592
  s_add_u32 s54, s62, 1966080
  buffer_load_dwordx4 v207, s[20:23], s54 offen lds
  v_add_u32 v215, 36864, v209
  ds_read_b64_tr_b16 a[0:1], v215 offset:0
  ds_read_b64_tr_b16 a[2:3], v215 offset:1024
  ds_read_b64_tr_b16 a[4:5], v215 offset:4096
  ds_read_b64_tr_b16 a[6:7], v215 offset:5120
  ds_read_b64_tr_b16 a[8:9], v215 offset:8192
  ds_read_b64_tr_b16 a[10:11], v215 offset:9216
  ds_read_b64_tr_b16 a[12:13], v215 offset:12288
  ds_read_b64_tr_b16 a[14:15], v215 offset:13312
  s_waitcnt vmcnt(20) lgkmcnt(0)
  s_barrier
  s_add_u32 m0, s61, 0
  s_add_u32 s54, s62, 1572864
  buffer_load_dwordx4 v207, s[24:27], s54 offen lds
  s_add_u32 m0, s61, 4096
  s_add_u32 s54, s62, 1703936
  buffer_load_dwordx4 v207, s[24:27], s54 offen lds
  s_add_u32 m0, s61, 8192
  s_add_u32 s54, s62, 1835008
  buffer_load_dwordx4 v207, s[24:27], s54 offen lds
  s_add_u32 m0, s61, 12288
  s_add_u32 s54, s62, 1966080
  buffer_load_dwordx4 v207, s[24:27], s54 offen lds
  v_add_u32 v215, 53248, v210
  ds_read_b64_tr_b16 a[144:145], v215 offset:0
  ds_read_b64_tr_b16 a[146:147], v215 offset:1024
  ds_read_b64_tr_b16 a[148:149], v215 offset:4096
  ds_read_b64_tr_b16 a[150:151], v215 offset:5120
  ds_read_b64_tr_b16 a[152:153], v215 offset:8192
  ds_read_b64_tr_b16 a[154:155], v215 offset:9216
  ds_read_b64_tr_b16 a[156:157], v215 offset:12288
  ds_read_b64_tr_b16 a[158:159], v215 offset:13312
  s_waitcnt vmcnt(20) lgkmcnt(0)
  s_barrier
  s_add_u32 m0, s61, 16384
  s_add_u32 s54, s62, 2097152
  buffer_load_dwordx4 v207, s[20:23], s54 offen lds
  s_add_u32 m0, s61, 20480
  s_add_u32 s54, s62, 2228224
  buffer_load_dwordx4 v207, s[20:23], s54 offen lds
  s_add_u32 m0, s61, 24576
  s_add_u32 s54, s62, 2359296
  buffer_load_dwordx4 v207, s[20:23], s54 offen lds
  s_add_u32 m0, s61, 28672
  s_add_u32 s54, s62, 2490368
  buffer_load_dwordx4 v207, s[20:23], s54 offen lds
  v_add_u32 v215, 69632, v209
  ds_read_b64_tr_b16 a[16:17], v215 offset:0
  ds_read_b64_tr_b16 a[18:19], v215 offset:1024
  ds_read_b64_tr_b16 a[20:21], v215 offset:4096
  ds_read_b64_tr_b16 a[22:23], v215 offset:5120
  ds_read_b64_tr_b16 a[24:25], v215 offset:8192
  ds_read_b64_tr_b16 a[26:27], v215 offset:9216
  ds_read_b64_tr_b16 a[28:29], v215 offset:12288
  ds_read_b64_tr_b16 a[30:31], v215 offset:13312
  s_waitcnt vmcnt(20) lgkmcnt(0)
  s_barrier
  s_add_u32 m0, s61, 32768
  s_add_u32 s54, s62, 2097152
  buffer_load_dwordx4 v207, s[24:27], s54 offen lds
  s_add_u32 m0, s61, 36864
  s_add_u32 s54, s62, 2228224
  buffer_load_dwordx4 v207, s[24:27], s54 offen lds
  s_add_u32 m0, s61, 40960
  s_add_u32 s54, s62, 2359296
  buffer_load_dwordx4 v207, s[24:27], s54 offen lds
  s_add_u32 m0, s61, 45056
  s_add_u32 s54, s62, 2490368
  buffer_load_dwordx4 v207, s[24:27], s54 offen lds
  v_add_u32 v215, 86016, v210
  ds_read_b64_tr_b16 a[160:161], v215 offset:0
  ds_read_b64_tr_b16 a[162:163], v215 offset:1024
  ds_read_b64_tr_b16 a[164:165], v215 offset:4096
  ds_read_b64_tr_b16 a[166:167], v215 offset:5120
  ds_read_b64_tr_b16 a[168:169], v215 offset:8192
  ds_read_b64_tr_b16 a[170:171], v215 offset:9216
  ds_read_b64_tr_b16 a[172:173], v215 offset:12288
  ds_read_b64_tr_b16 a[174:175], v215 offset:13312
  s_waitcnt vmcnt(20) lgkmcnt(0)
  s_barrier
  s_add_u32 m0, s61, 49152
  s_add_u32 s54, s62, 2621440
  buffer_load_dwordx4 v207, s[20:23], s54 offen lds
  s_add_u32 m0, s61, 53248
  s_add_u32 s54, s62, 2752512
  buffer_load_dwordx4 v207, s[20:23], s54 offen lds
  s_add_u32 m0, s61, 57344
  s_add_u32 s54, s62, 2883584
  buffer_load_dwordx4 v207, s[20:23], s54 offen lds
  s_add_u32 m0, s61, 61440
  s_add_u32 s54, s62, 3014656
  buffer_load_dwordx4 v207, s[20:23], s54 offen lds
  v_add_u32 v215, 102400, v209
  ds_read_b64_tr_b16 a[32:33], v215 offset:0
  ds_read_b64_tr_b16 a[34:35], v215 offset:1024
  ds_read_b64_tr_b16 a[36:37], v215 offset:4096
  ds_read_b64_tr_b16 a[38:39], v215 offset:5120
  ds_read_b64_tr_b16 a[40:41], v215 offset:8192
  ds_read_b64_tr_b16 a[42:43], v215 offset:9216
  ds_read_b64_tr_b16 a[44:45], v215 offset:12288
  ds_read_b64_tr_b16 a[46:47], v215 offset:13312
  s_waitcnt vmcnt(20) lgkmcnt(0)
  s_barrier
  s_add_u32 m0, s61, 65536
  s_add_u32 s54, s62, 2621440
  buffer_load_dwordx4 v207, s[24:27], s54 offen lds
  s_add_u32 m0, s61, 69632
  s_add_u32 s54, s62, 2752512
  buffer_load_dwordx4 v207, s[24:27], s54 offen lds
  s_add_u32 m0, s61, 73728
  s_add_u32 s54, s62, 2883584
  buffer_load_dwordx4 v207, s[24:27], s54 offen lds
  s_add_u32 m0, s61, 77824
  s_add_u32 s54, s62, 3014656
  buffer_load_dwordx4 v207, s[24:27], s54 offen lds
  v_add_u32 v215, 118784, v210
  ds_read_b64_tr_b16 a[176:177], v215 offset:0
  ds_read_b64_tr_b16 a[178:179], v215 offset:1024
  ds_read_b64_tr_b16 a[180:181], v215 offset:4096
  ds_read_b64_tr_b16 a[182:183], v215 offset:5120
  ds_read_b64_tr_b16 a[184:185], v215 offset:8192
  ds_read_b64_tr_b16 a[186:187], v215 offset:9216
  ds_read_b64_tr_b16 a[188:189], v215 offset:12288
  ds_read_b64_tr_b16 a[190:191], v215 offset:13312
  s_waitcnt vmcnt(20) lgkmcnt(0)
  s_barrier
  s_add_u32 m0, s61, 81920
  s_add_u32 s54, s62, 3145728
  buffer_load_dwordx4 v207, s[20:23], s54 offen lds
  s_add_u32 m0, s61, 86016
  s_add_u32 s54, s62, 3276800
  buffer_load_dwordx4 v207, s[20:23], s54 offen lds
  s_add_u32 m0, s61, 90112
  s_add_u32 s54, s62, 3407872
  buffer_load_dwordx4 v207, s[20:23], s54 offen lds
  s_add_u32 m0, s61, 94208
  s_add_u32 s54, s62, 3538944
  buffer_load_dwordx4 v207, s[20:23], s54 offen lds
  v_add_u32 v215, 135168, v209
  ds_read_b64_tr_b16 a[48:49], v215 offset:0
  ds_read_b64_tr_b16 a[50:51], v215 offset:1024
  ds_read_b64_tr_b16 a[52:53], v215 offset:4096
  ds_read_b64_tr_b16 a[54:55], v215 offset:5120
  ds_read_b64_tr_b16 a[56:57], v215 offset:8192
  ds_read_b64_tr_b16 a[58:59], v215 offset:9216
  ds_read_b64_tr_b16 a[60:61], v215 offset:12288
  ds_read_b64_tr_b16 a[62:63], v215 offset:13312
  s_waitcnt vmcnt(20) lgkmcnt(0)
  s_barrier
  s_add_u32 m0, s61, 98304
  s_add_u32 s54, s62, 3145728
  buffer_load_dwordx4 v207, s[24:27], s54 offen lds
  s_add_u32 m0, s61, 102400
  s_add_u32 s54, s62, 3276800
  buffer_load_dwordx4 v207, s[24:27], s54 offen lds
  s_add_u32 m0, s61, 106496
  s_add_u32 s54, s62, 3407872
  buffer_load_dwordx4 v207, s[24:27], s54 offen lds
  s_add_u32 m0, s61, 110592
  s_add_u32 s54, s62, 3538944
  buffer_load_dwordx4 v207, s[24:27], s54 offen lds
  v_add_u32 v215, 36864, v210
  ds_read_b64_tr_b16 a[192:193], v215 offset:0
  ds_read_b64_tr_b16 a[194:195], v215 offset:1024
  ds_read_b64_tr_b16 a[196:197], v215 offset:4096
  ds_read_b64_tr_b16 a[198:199], v215 offset:5120
  ds_read_b64_tr_b16 a[200:201], v215 offset:8192
  ds_read_b64_tr_b16 a[202:203], v215 offset:9216
  ds_read_b64_tr_b16 a[204:205], v215 offset:12288
  ds_read_b64_tr_b16 a[206:207], v215 offset:13312
  s_waitcnt vmcnt(20) lgkmcnt(0)
  s_barrier
  s_add_u32 m0, s61, 0
  s_add_u32 s54, s62, 3670016
  buffer_load_dwordx4 v207, s[20:23], s54 offen lds
  s_add_u32 m0, s61, 4096
  s_add_u32 s54, s62, 3801088
  buffer_load_dwordx4 v207, s[20:23], s54 offen lds
  s_add_u32 m0, s61, 8192
  s_add_u32 s54, s62, 3932160
  buffer_load_dwordx4 v207, s[20:23], s54 offen lds
  s_add_u32 m0, s61, 12288
  s_add_u32 s54, s62, 4063232
  buffer_load_dwordx4 v207, s[20:23], s54 offen lds
  v_add_u32 v215, 53248, v209
  ds_read_b64_tr_b16 a[64:65], v215 offset:0
  ds_read_b64_tr_b16 a[66:67], v215 offset:1024
  ds_read_b64_tr_b16 a[68:69], v215 offset:4096
  ds_read_b64_tr_b16 a[70:71], v215 offset:5120
  ds_read_b64_tr_b16 a[72:73], v215 offset:8192
  ds_read_b64_tr_b16 a[74:75], v215 offset:9216
  ds_read_b64_tr_b16 a[76:77], v215 offset:12288
  ds_read_b64_tr_b16 a[78:79], v215 offset:13312
  s_waitcnt vmcnt(20) lgkmcnt(0)
  s_barrier
  s_add_u32 m0, s61, 16384
  s_add_u32 s54, s62, 3670016
  buffer_load_dwordx4 v207, s[24:27], s54 offen lds
  s_add_u32 m0, s61, 20480
  s_add_u32 s54, s62, 3801088
  buffer_load_dwordx4 v207, s[24:27], s54 offen lds
  s_add_u32 m0, s61, 24576
  s_add_u32 s54, s62, 3932160
  buffer_load_dwordx4 v207, s[24:27], s54 offen lds
  s_add_u32 m0, s61, 28672
  s_add_u32 s54, s62, 4063232
  buffer_load_dwordx4 v207, s[24:27], s54 offen lds
  v_add_u32 v215, 69632, v210
  ds_read_b64_tr_b16 a[208:209], v215 offset:0
  ds_read_b64_tr_b16 a[210:211], v215 offset:1024
  ds_read_b64_tr_b16 a[212:213], v215 offset:4096
  ds_read_b64_tr_b16 a[214:215], v215 offset:5120
  ds_read_b64_tr_b16 a[216:217], v215 offset:8192
  ds_read_b64_tr_b16 a[218:219], v215 offset:9216
  ds_read_b64_tr_b16 a[220:221], v215 offset:12288
  ds_read_b64_tr_b16 a[222:223], v215 offset:13312
  s_waitcnt vmcnt(20) lgkmcnt(0)
  s_barrier
  s_add_u32 m0, s61, 32768
  s_add_u32 s54, s62, 4194304
  buffer_load_dwordx4 v207, s[20:23], s54 offen lds
  s_add_u32 m0, s61, 36864
  s_add_u32 s54, s62, 4325376
  buffer_load_dwordx4 v207, s[20:23], s54 offen lds
  s_add_u32 m0, s61, 40960
  s_add_u32 s54, s62, 4456448
  buffer_load_dwordx4 v207, s[20:23], s54 offen lds
  s_add_u32 m0, s61, 45056
  s_add_u32 s54, s62, 4587520
  buffer_load_dwordx4 v207, s[20:23], s54 offen lds
  v_add_u32 v215, 86016, v209
  ds_read_b64_tr_b16 a[80:81], v215 offset:0
  ds_read_b64_tr_b16 a[82:83], v215 offset:1024
  ds_read_b64_tr_b16 a[84:85], v215 offset:4096
  ds_read_b64_tr_b16 a[86:87], v215 offset:5120
  ds_read_b64_tr_b16 a[88:89], v215 offset:8192
  ds_read_b64_tr_b16 a[90:91], v215 offset:9216
  ds_read_b64_tr_b16 a[92:93], v215 offset:12288
  ds_read_b64_tr_b16 a[94:95], v215 offset:13312
  s_waitcnt vmcnt(20) lgkmcnt(0)
  s_barrier
  s_add_u32 m0, s61, 49152
  s_add_u32 s54, s62, 4194304
  buffer_load_dwordx4 v207, s[24:27], s54 offen lds
  s_add_u32 m0, s61, 53248
  s_add_u32 s54, s62, 4325376
  buffer_load_dwordx4 v207, s[24:27], s54 offen lds
  s_add_u32 m0, s61, 57344
  s_add_u32 s54, s62, 4456448
  buffer_load_dwordx4 v207, s[24:27], s54 offen lds
  s_add_u32 m0, s61, 61440
  s_add_u32 s54, s62, 4587520
  buffer_load_dwordx4 v207, s[24:27], s54 offen lds
  s_mul_i32 s54, s53, 21120
  s_lshl_b32 s55, s52, 13
  s_add_u32 s54, s54, s55
  s_cmp_eq_u32 s52, 3
  s_cselect_b32 s54, 0x10000000, s54
  v_lshlrev_b32 v211, 3, v201
  buffer_load_dword v196, v211, s[28:31], s54 offen
  v_add_u32 v215, 102400, v210
  ds_read_b64_tr_b16 a[224:225], v215 offset:0
  ds_read_b64_tr_b16 a[226:227], v215 offset:1024
  ds_read_b64_tr_b16 a[228:229], v215 offset:4096
  ds_read_b64_tr_b16 a[230:231], v215 offset:5120
  ds_read_b64_tr_b16 a[232:233], v215 offset:8192
  ds_read_b64_tr_b16 a[234:235], v215 offset:9216
  ds_read_b64_tr_b16 a[236:237], v215 offset:12288
  ds_read_b64_tr_b16 a[238:239], v215 offset:13312
  s_waitcnt vmcnt(21) lgkmcnt(0)
  s_barrier
  s_lshl_b32 s54, s53, 13
  s_lshr_b32 s55, s53, 6
  s_or_b32 s55, s55, s52
  s_cmp_eq_u32 s55, 0
  s_cselect_b32 s54, s54, 0x10000000
  v_lshlrev_b32 v211, 3, v201
  s_add_u32 s54, s54, 3145728
  buffer_load_dword v196, v211, s[16:19], s54 offen
  v_add_u32 v215, 118784, v209
  ds_read_b64_tr_b16 a[96:97], v215 offset:0
  ds_read_b64_tr_b16 a[98:99], v215 offset:1024
  ds_read_b64_tr_b16 a[100:101], v215 offset:4096
  ds_read_b64_tr_b16 a[102:103], v215 offset:5120
  ds_read_b64_tr_b16 a[104:105], v215 offset:8192
  ds_read_b64_tr_b16 a[106:107], v215 offset:9216
  ds_read_b64_tr_b16 a[108:109], v215 offset:12288
  ds_read_b64_tr_b16 a[110:111], v215 offset:13312
  s_waitcnt vmcnt(18) lgkmcnt(0)
  s_barrier
  s_lshl_b32 s55, s2, 2
  s_or_b32 s56, s52, s1
  s_cmp_eq_u32 s56, 0
  s_cselect_b32 s55, s55, 0x1000
  s_lshl_b32 s56, 1, s0
  v_mov_b32 v197, s56
  s_mov_b64 exec, 1
  buffer_atomic_or v197, off, s[12:15], s55 sc0
  s_mov_b64 exec, -1
  v_add_u32 v215, 135168, v210
  ds_read_b64_tr_b16 a[240:241], v215 offset:0
  ds_read_b64_tr_b16 a[242:243], v215 offset:1024
  ds_read_b64_tr_b16 a[244:245], v215 offset:4096
  ds_read_b64_tr_b16 a[246:247], v215 offset:5120
  ds_read_b64_tr_b16 a[248:249], v215 offset:8192
  ds_read_b64_tr_b16 a[250:251], v215 offset:9216
  ds_read_b64_tr_b16 a[252:253], v215 offset:12288
  ds_read_b64_tr_b16 a[254:255], v215 offset:13312
  s_waitcnt vmcnt(15) lgkmcnt(0)
  s_barrier
  v_add_u32 v215, 36864, v209
  ds_read_b64_tr_b16 a[112:113], v215 offset:0
  ds_read_b64_tr_b16 a[114:115], v215 offset:1024
  ds_read_b64_tr_b16 a[116:117], v215 offset:4096
  ds_read_b64_tr_b16 a[118:119], v215 offset:5120
  ds_read_b64_tr_b16 a[120:121], v215 offset:8192
  ds_read_b64_tr_b16 a[122:123], v215 offset:9216
  ds_read_b64_tr_b16 a[124:125], v215 offset:12288
  ds_read_b64_tr_b16 a[126:127], v215 offset:13312
  s_waitcnt vmcnt(11) lgkmcnt(0)
  s_barrier
  v_add_u32 v215, 53248, v210
  ds_read_b64_tr_b16 v[224:225], v215 offset:0
  ds_read_b64_tr_b16 v[226:227], v215 offset:1024
  ds_read_b64_tr_b16 v[228:229], v215 offset:4096
  ds_read_b64_tr_b16 v[230:231], v215 offset:5120
  ds_read_b64_tr_b16 v[232:233], v215 offset:8192
  ds_read_b64_tr_b16 v[234:235], v215 offset:9216
  ds_read_b64_tr_b16 v[236:237], v215 offset:12288
  ds_read_b64_tr_b16 v[238:239], v215 offset:13312
  s_waitcnt vmcnt(7) lgkmcnt(0)
  s_barrier
  v_add_u32 v215, 69632, v209
  ds_read_b64_tr_b16 a[128:129], v215 offset:0
  ds_read_b64_tr_b16 a[130:131], v215 offset:1024
  ds_read_b64_tr_b16 a[132:133], v215 offset:4096
  ds_read_b64_tr_b16 a[134:135], v215 offset:5120
  ds_read_b64_tr_b16 a[136:137], v215 offset:8192
  ds_read_b64_tr_b16 a[138:139], v215 offset:9216
  ds_read_b64_tr_b16 a[140:141], v215 offset:12288
  ds_read_b64_tr_b16 a[142:143], v215 offset:13312
  s_waitcnt vmcnt(3) lgkmcnt(0)
  s_barrier
  v_add_u32 v215, 86016, v210
  ds_read_b64_tr_b16 v[240:241], v215 offset:0
  ds_read_b64_tr_b16 v[242:243], v215 offset:1024
  ds_read_b64_tr_b16 v[244:245], v215 offset:4096
  ds_read_b64_tr_b16 v[246:247], v215 offset:5120
  ds_read_b64_tr_b16 v[248:249], v215 offset:8192
  ds_read_b64_tr_b16 v[250:251], v215 offset:9216
  ds_read_b64_tr_b16 v[252:253], v215 offset:12288
  ds_read_b64_tr_b16 v[254:255], v215 offset:13312
  s_waitcnt lgkmcnt(0)
  s_barrier
  s_mov_b32 s68, 1040356334
  s_lshl_b32 s69, s52, 9
  s_lshl_b32 s70, s58, 2
  s_add_u32 s70, s70, 128
  s_mul_i32 s66, s58, -12288
  s_lshl_b32 s54, s52, 10
  s_add_u32 s66, s66, s54
  s_add_u32 s66, s66, 524288
  v_mov_b32 v64, -1
  v_mov_b32 v65, -1
  v_mov_b32 v66, -1
  v_mov_b32 v67, -1
  s_add_u32 s60, s60, 258048
  ds_read_b128 v[32:35], v203 offset:0
  ds_read_b128 v[36:39], v204 offset:0
  ds_read_b128 v[40:43], v205 offset:0
  s_waitcnt lgkmcnt(2)
  v_mfma_f32_32x32x16_bf16 v[0:15], a[0:3], v[32:35], 0
  ds_read_b128 v[44:47], v206 offset:0
  s_add_u32 m0, s67, 36864
  s_nop 0
  buffer_load_dwordx4 v202, s[4:7], s60 offen offset:0 lds
  v_mfma_f32_32x32x16_bf16 v[16:31], v[32:35], a[144:147], 0
  s_waitcnt lgkmcnt(2)
  v_mfma_f32_32x32x16_bf16 v[0:15], a[4:7], v[36:39], v[0:15]
  ds_read_b128 v[32:35], v203 offset:1024
  s_add_u32 m0, s67, 37760
  s_nop 0
  buffer_load_dwordx4 v202, s[4:7], s60 offen offset:128 lds
  v_mfma_f32_32x32x16_bf16 v[16:31], v[36:39], a[148:151], v[16:31]
  s_waitcnt lgkmcnt(2)
  v_mfma_f32_32x32x16_bf16 v[0:15], a[8:11], v[40:43], v[0:15]
  ds_read_b128 v[36:39], v204 offset:1024
  s_add_u32 m0, s67, 38656
  s_nop 0
  buffer_load_dwordx4 v202, s[4:7], s60 offen offset:256 lds
  v_mfma_f32_32x32x16_bf16 v[16:31], v[40:43], a[152:155], v[16:31]
  s_waitcnt lgkmcnt(2)
  v_mfma_f32_32x32x16_bf16 v[0:15], a[12:15], v[44:47], v[0:15]
  ds_read_b128 v[40:43], v205 offset:1024
  s_add_u32 m0, s67, 39552
  s_nop 0
  buffer_load_dwordx4 v202, s[4:7], s60 offen offset:384 lds
  v_mfma_f32_32x32x16_bf16 v[16:31], v[44:47], a[156:159], v[16:31]
  s_waitcnt lgkmcnt(2)
  v_mfma_f32_32x32x16_bf16 v[0:15], a[16:19], v[32:35], v[0:15]
  ds_read_b128 v[44:47], v206 offset:1024
  s_add_u32 m0, s67, 40448
  s_nop 0
  buffer_load_dwordx4 v202, s[4:7], s60 offen offset:512 lds
  v_mfma_f32_32x32x16_bf16 v[16:31], v[32:35], a[160:163], v[16:31]
  s_waitcnt lgkmcnt(2)
  v_mfma_f32_32x32x16_bf16 v[0:15], a[20:23], v[36:39], v[0:15]
  ds_read_b128 v[32:35], v203 offset:2048
  s_add_u32 m0, s67, 41344
  s_nop 0
  buffer_load_dwordx4 v202, s[4:7], s60 offen offset:640 lds
  v_mfma_f32_32x32x16_bf16 v[16:31], v[36:39], a[164:167], v[16:31]
  s_waitcnt lgkmcnt(2)
  v_mfma_f32_32x32x16_bf16 v[0:15], a[24:27], v[40:43], v[0:15]
  ds_read_b128 v[36:39], v204 offset:2048
  s_add_u32 m0, s67, 42240
  s_nop 0
  buffer_load_dwordx4 v202, s[4:7], s60 offen offset:768 lds
  v_mfma_f32_32x32x16_bf16 v[16:31], v[40:43], a[168:171], v[16:31]
  s_waitcnt lgkmcnt(2)
  v_mfma_f32_32x32x16_bf16 v[0:15], a[28:31], v[44:47], v[0:15]
  ds_read_b128 v[40:43], v205 offset:2048
  s_add_u32 m0, s67, 43136
  s_nop 0
  buffer_load_dwordx4 v202, s[4:7], s60 offen offset:896 lds
  v_mfma_f32_32x32x16_bf16 v[16:31], v[44:47], a[172:175], v[16:31]
  s_waitcnt lgkmcnt(2)
  v_mfma_f32_32x32x16_bf16 v[0:15], a[32:35], v[32:35], v[0:15]
  ds_read_b128 v[44:47], v206 offset:2048
  s_add_u32 m0, s67, 44032
  s_nop 0
  buffer_load_dwordx4 v202, s[4:7], s60 offen offset:1024 lds
  v_mfma_f32_32x32x16_bf16 v[16:31], v[32:35], a[176:179], v[16:31]
  s_waitcnt lgkmcnt(2)
  v_mfma_f32_32x32x16_bf16 v[0:15], a[36:39], v[36:39], v[0:15]
  ds_read_b128 v[32:35], v203 offset:3072
  v_mfma_f32_32x32x16_bf16 v[16:31], v[36:39], a[180:183], v[16:31]
  s_waitcnt lgkmcnt(2)
  v_mfma_f32_32x32x16_bf16 v[0:15], a[40:43], v[40:43], v[0:15]
  ds_read_b128 v[36:39], v204 offset:3072
  v_mfma_f32_32x32x16_bf16 v[16:31], v[40:43], a[184:187], v[16:31]
  s_waitcnt lgkmcnt(2)
  v_mfma_f32_32x32x16_bf16 v[0:15], a[44:47], v[44:47], v[0:15]
  ds_read_b128 v[40:43], v205 offset:3072
  v_mfma_f32_32x32x16_bf16 v[16:31], v[44:47], a[188:191], v[16:31]
  s_waitcnt lgkmcnt(2)
  v_mfma_f32_32x32x16_bf16 v[0:15], a[48:51], v[32:35], v[0:15]
  ds_read_b128 v[44:47], v206 offset:3072
  v_mfma_f32_32x32x16_bf16 v[16:31], v[32:35], a[192:195], v[16:31]
  s_waitcnt lgkmcnt(2)
  v_mfma_f32_32x32x16_bf16 v[0:15], a[52:55], v[36:39], v[0:15]
  ds_read_b128 v[32:35], v203 offset:4096
  v_mfma_f32_32x32x16_bf16 v[16:31], v[36:39], a[196:199], v[16:31]
  s_waitcnt lgkmcnt(2)
  v_mfma_f32_32x32x16_bf16 v[0:15], a[56:59], v[40:43], v[0:15]
  ds_read_b128 v[36:39], v204 offset:4096
  v_mfma_f32_32x32x16_bf16 v[16:31], v[40:43], a[200:203], v[16:31]
  s_waitcnt lgkmcnt(2)
  v_mfma_f32_32x32x16_bf16 v[0:15], a[60:63], v[44:47], v[0:15]
  ds_read_b128 v[40:43], v205 offset:4096
  v_mfma_f32_32x32x16_bf16 v[16:31], v[44:47], a[204:207], v[16:31]
  s_waitcnt lgkmcnt(2)
  v_mfma_f32_32x32x16_bf16 v[0:15], a[64:67], v[32:35], v[0:15]
  ds_read_b128 v[44:47], v206 offset:4096
  v_mfma_f32_32x32x16_bf16 v[16:31], v[32:35], a[208:211], v[16:31]
  s_waitcnt lgkmcnt(2)
  v_mfma_f32_32x32x16_bf16 v[0:15], a[68:71], v[36:39], v[0:15]
  ds_read_b128 v[32:35], v203 offset:5120
  v_mfma_f32_32x32x16_bf16 v[16:31], v[36:39], a[212:215], v[16:31]
  s_waitcnt lgkmcnt(2)
  v_mfma_f32_32x32x16_bf16 v[0:15], a[72:75], v[40:43], v[0:15]
  ds_read_b128 v[36:39], v204 offset:5120
  v_mfma_f32_32x32x16_bf16 v[16:31], v[40:43], a[216:219], v[16:31]
  s_waitcnt lgkmcnt(2)
  v_mfma_f32_32x32x16_bf16 v[0:15], a[76:79], v[44:47], v[0:15]
  ds_read_b128 v[40:43], v205 offset:5120
  v_mfma_f32_32x32x16_bf16 v[16:31], v[44:47], a[220:223], v[16:31]
  s_waitcnt lgkmcnt(2)
  v_mfma_f32_32x32x16_bf16 v[0:15], a[80:83], v[32:35], v[0:15]
  ds_read_b128 v[44:47], v206 offset:5120
  v_mfma_f32_32x32x16_bf16 v[16:31], v[32:35], a[224:227], v[16:31]
  s_waitcnt lgkmcnt(2)
  v_mfma_f32_32x32x16_bf16 v[0:15], a[84:87], v[36:39], v[0:15]
  ds_read_b128 v[32:35], v203 offset:6144
  v_mfma_f32_32x32x16_bf16 v[16:31], v[36:39], a[228:231], v[16:31]
  s_waitcnt lgkmcnt(2)
  v_mfma_f32_32x32x16_bf16 v[0:15], a[88:91], v[40:43], v[0:15]
  ds_read_b128 v[36:39], v204 offset:6144
  v_mfma_f32_32x32x16_bf16 v[16:31], v[40:43], a[232:235], v[16:31]
  s_waitcnt lgkmcnt(2)
  v_mfma_f32_32x32x16_bf16 v[0:15], a[92:95], v[44:47], v[0:15]
  ds_read_b128 v[40:43], v205 offset:6144
  v_mfma_f32_32x32x16_bf16 v[16:31], v[44:47], a[236:239], v[16:31]
  s_waitcnt lgkmcnt(2)
  v_mfma_f32_32x32x16_bf16 v[0:15], a[96:99], v[32:35], v[0:15]
  ds_read_b128 v[44:47], v206 offset:6144
  v_mfma_f32_32x32x16_bf16 v[16:31], v[32:35], a[240:243], v[16:31]
  s_waitcnt lgkmcnt(2)
  v_mfma_f32_32x32x16_bf16 v[0:15], a[100:103], v[36:39], v[0:15]
  ds_read_b128 v[32:35], v203 offset:7168
  v_mfma_f32_32x32x16_bf16 v[16:31], v[36:39], a[244:247], v[16:31]
  s_waitcnt lgkmcnt(2)
  v_mfma_f32_32x32x16_bf16 v[0:15], a[104:107], v[40:43], v[0:15]
  ds_read_b128 v[36:39], v204 offset:7168
  v_mfma_f32_32x32x16_bf16 v[16:31], v[40:43], a[248:251], v[16:31]
  s_waitcnt lgkmcnt(2)
  v_mfma_f32_32x32x16_bf16 v[0:15], a[108:111], v[44:47], v[0:15]
  ds_read_b128 v[40:43], v205 offset:7168
  v_mfma_f32_32x32x16_bf16 v[16:31], v[44:47], a[252:255], v[16:31]
  s_waitcnt lgkmcnt(2)
  v_mfma_f32_32x32x16_bf16 v[0:15], a[112:115], v[32:35], v[0:15]
  ds_read_b128 v[44:47], v206 offset:7168
  v_mfma_f32_32x32x16_bf16 v[16:31], v[32:35], v[224:227], v[16:31]
  s_waitcnt lgkmcnt(2)
  v_mfma_f32_32x32x16_bf16 v[0:15], a[116:119], v[36:39], v[0:15]
  ds_read_b128 v[32:35], v203 offset:8192
  v_mfma_f32_32x32x16_bf16 v[16:31], v[36:39], v[228:231], v[16:31]
  s_waitcnt lgkmcnt(2)
  v_mfma_f32_32x32x16_bf16 v[0:15], a[120:123], v[40:43], v[0:15]
  ds_read_b128 v[36:39], v204 offset:8192
  v_mfma_f32_32x32x16_bf16 v[16:31], v[40:43], v[232:235], v[16:31]
  s_waitcnt lgkmcnt(2)
  v_mfma_f32_32x32x16_bf16 v[0:15], a[124:127], v[44:47], v[0:15]
  ds_read_b128 v[40:43], v205 offset:8192
  v_mfma_f32_32x32x16_bf16 v[16:31], v[44:47], v[236:239], v[16:31]
  s_waitcnt lgkmcnt(2)
  v_mfma_f32_32x32x16_bf16 v[0:15], a[128:131], v[32:35], v[0:15]
  ds_read_b128 v[44:47], v206 offset:8192
  v_mfma_f32_32x32x16_bf16 v[16:31], v[32:35], v[240:243], v[16:31]
  s_waitcnt lgkmcnt(2)
  v_mfma_f32_32x32x16_bf16 v[0:15], a[132:135], v[36:39], v[0:15]
  v_mfma_f32_32x32x16_bf16 v[16:31], v[36:39], v[244:247], v[16:31]
  s_waitcnt lgkmcnt(1)
  v_mfma_f32_32x32x16_bf16 v[0:15], a[136:139], v[40:43], v[0:15]
  v_mfma_f32_32x32x16_bf16 v[16:31], v[40:43], v[248:251], v[16:31]
  s_waitcnt lgkmcnt(0)
  v_mfma_f32_32x32x16_bf16 v[0:15], a[140:143], v[44:47], v[0:15]
  v_mfma_f32_32x32x16_bf16 v[16:31], v[44:47], v[252:255], v[16:31]
  s_mul_i32 s64, s59, 655360
  s_lshl_b32 s55, s58, 14
  s_add_u32 s64, s64, s55
  s_add_u32 s64, s64, 1048576
  s_add_u32 s72, s64, s69
  s_add_u32 s73, s64, s66
  s_add_u32 s59, s59, 7
  s_waitcnt vmcnt(0)
  s_barrier
  s_cmp_eq_u32 s1, 1
  s_cbranch_scc1 W_ver_ok
  v_mov_b32 v33, 163832
  s_cmp_eq_u32 s52, 0
  s_cbranch_scc0 W_ver_b
  s_waitcnt vmcnt(0)
  s_mov_b64 exec, 1
  ds_write_b32 v33, v197
  s_mov_b64 exec, -1
  s_waitcnt lgkmcnt(0)
W_ver_b:
  s_barrier
  ds_read_b32 v32, v33
  s_waitcnt lgkmcnt(0)
  v_readfirstlane_b32 s54, v32
  s_nop 0
  s_bitcmp1_b32 s54, s0
  s_cbranch_scc1 L_conf
W_ver_ok:
  s_lshr_b32 s55, s53, 1
  s_and_b32 s56, s53, 1
  s_lshl_b32 s56, s56, 13
  s_lshl_b32 s55, s55, 8
  s_add_u32 s55, s55, s56
  s_add_u32 s55, s55, 393216
  s_cmp_lt_u32 s53, 64
  s_cselect_b32 s71, s55, 268435456
  v_mov_b32 v211, 0
  s_mov_b64 exec, 1
  buffer_store_dword v211, v211, s[8:11], s71 offen sc1
  s_mov_b64 exec, -1
  s_cmp_eq_u32 s59, 7
  s_cbranch_scc0 KV_na
  s_mul_i32 s54, s58, 2176
  s_mul_i32 s55, s52, 69632
  s_add_u32 s55, s55, s54
  s_add_u32 s55, s55, 0
  s_add_u32 s54, s54, 278528
  s_and_b32 s56, s58, 7
  s_lshl_b32 s56, s56, 12
  s_bfe_u32 s57, s58, 0x10003
  s_lshl_b32 s57, s57, 11
  s_add_u32 s56, s56, s57
  s_add_u32 s54, s56, 262144
  s_lshr_b32 s57, s58, 4
  s_lshl_b32 s57, s57, 15
  s_add_u32 s56, s56, s57
  s_lshl_b32 s57, s52, 16
  s_add_u32 s56, s56, s57
  s_add_u32 s55, s56, 0
  s_lshl_b32 s56, s58, 14
  s_mul_i32 s57, s52, 3072
  s_add_u32 s56, s56, s57
  s_add_u32 s56, s56, 360448
  s_cmp_lt_u32 s58, 2
  s_cselect_b32 s56, s56, 268435456
  s_cmp_eq_u32 s52, 0
  s_cselect_b32 s54, s54, 268435456
  buffer_store_dwordx4 v[64:67], v201, s[8:11], s55 offen offset:0 sc1
  buffer_store_dwordx4 v[64:67], v201, s[8:11], s55 offen offset:1024 sc1
  buffer_store_dwordx4 v[64:67], v201, s[8:11], s54 offen offset:0 sc1
  buffer_store_dwordx4 v[64:67], v201, s[8:11], s54 offen offset:1024 sc1
  buffer_store_dwordx4 v[64:67], v201, s[8:11], s56 offen offset:0 sc1
  buffer_store_dwordx4 v[64:67], v201, s[8:11], s56 offen offset:1024 sc1
  buffer_store_dwordx4 v[64:67], v201, s[8:11], s56 offen offset:2048 sc1
KV_na:
KV_loop:
  s_add_u32 s60, s60, 258048
  ds_read_b128 v[32:35], v203 offset:36864
  ds_read_b128 v[36:39], v204 offset:36864
  ds_read_b128 v[40:43], v205 offset:36864
  s_waitcnt lgkmcnt(2)
  v_mfma_f32_32x32x16_bf16 v[68:83], a[0:3], v[32:35], 0
  ds_read_b128 v[44:47], v206 offset:36864
  s_add_u32 m0, s67, 0
  s_nop 0
  buffer_load_dwordx4 v202, s[4:7], s60 offen offset:0 lds
  v_mfma_f32_32x32x16_bf16 v[84:99], v[32:35], a[144:147], 0
  s_waitcnt lgkmcnt(2)
  v_mfma_f32_32x32x16_bf16 v[68:83], a[4:7], v[36:39], v[68:83]
  ds_read_b128 v[32:35], v203 offset:37888
  s_add_u32 m0, s67, 896
  s_nop 0
  buffer_load_dwordx4 v202, s[4:7], s60 offen offset:128 lds
  v_mfma_f32_32x32x16_bf16 v[84:99], v[36:39], a[148:151], v[84:99]
  s_waitcnt lgkmcnt(2)
  v_mfma_f32_32x32x16_bf16 v[68:83], a[8:11], v[40:43], v[68:83]
  ds_read_b128 v[36:39], v204 offset:37888
  s_add_u32 m0, s67, 1792
  s_nop 0
  buffer_load_dwordx4 v202, s[4:7], s60 offen offset:256 lds
  v_mfma_f32_32x32x16_bf16 v[84:99], v[40:43], a[152:155], v[84:99]
  s_waitcnt lgkmcnt(2)
  v_mfma_f32_32x32x16_bf16 v[68:83], a[12:15], v[44:47], v[68:83]
  ds_read_b128 v[40:43], v205 offset:37888
  s_add_u32 m0, s67, 2688
  s_nop 0
  buffer_load_dwordx4 v202, s[4:7], s60 offen offset:384 lds
  v_mfma_f32_32x32x16_bf16 v[84:99], v[44:47], a[156:159], v[84:99]
  s_waitcnt lgkmcnt(2)
  v_mfma_f32_32x32x16_bf16 v[68:83], a[16:19], v[32:35], v[68:83]
  ds_read_b128 v[44:47], v206 offset:37888
  s_add_u32 m0, s67, 3584
  s_nop 0
  buffer_load_dwordx4 v202, s[4:7], s60 offen offset:512 lds
  v_mfma_f32_32x32x16_bf16 v[84:99], v[32:35], a[160:163], v[84:99]
  s_waitcnt lgkmcnt(2)
  v_mfma_f32_32x32x16_bf16 v[68:83], a[20:23], v[36:39], v[68:83]
  ds_read_b128 v[32:35], v203 offset:38912
  s_add_u32 m0, s67, 4480
  s_nop 0
  buffer_load_dwordx4 v202, s[4:7], s60 offen offset:640 lds
  v_mfma_f32_32x32x16_bf16 v[84:99], v[36:39], a[164:167], v[84:99]
  s_waitcnt lgkmcnt(2)
  v_mfma_f32_32x32x16_bf16 v[68:83], a[24:27], v[40:43], v[68:83]
  ds_read_b128 v[36:39], v204 offset:38912
  s_add_u32 m0, s67, 5376
  s_nop 0
  buffer_load_dwordx4 v202, s[4:7], s60 offen offset:768 lds
  v_mfma_f32_32x32x16_bf16 v[84:99], v[40:43], a[168:171], v[84:99]
  s_waitcnt lgkmcnt(2)
  v_mfma_f32_32x32x16_bf16 v[68:83], a[28:31], v[44:47], v[68:83]
  ds_read_b128 v[40:43], v205 offset:38912
  s_add_u32 m0, s67, 6272
  s_nop 0
  buffer_load_dwordx4 v202, s[4:7], s60 offen offset:896 lds
  v_mfma_f32_32x32x16_bf16 v[84:99], v[44:47], a[172:175], v[84:99]
  s_waitcnt lgkmcnt(2)
  v_mfma_f32_32x32x16_bf16 v[68:83], a[32:35], v[32:35], v[68:83]
  ds_read_b128 v[44:47], v206 offset:38912
  s_add_u32 m0, s67, 7168
  s_nop 0
  buffer_load_dwordx4 v202, s[4:7], s60 offen offset:1024 lds
  v_mfma_f32_32x32x16_bf16 v[84:99], v[32:35], a[176:179], v[84:99]
  s_waitcnt lgkmcnt(2)
  v_mfma_f32_32x32x16_bf16 v[68:83], a[36:39], v[36:39], v[68:83]
  ds_read_b128 v[32:35], v203 offset:39936
  v_mul_f32 v0, s68, v0
  v_mul_f32 v1, s68, v1
  v_mul_f32 v2, s68, v2
  v_mul_f32 v3, s68, v3
  v_mfma_f32_32x32x16_bf16 v[84:99], v[36:39], a[180:183], v[84:99]
  v_mul_f32 v4, s68, v4
  v_mul_f32 v5, s68, v5
  v_mul_f32 v6, s68, v6
  v_mul_f32 v7, s68, v7
  s_waitcnt lgkmcnt(2)
  v_mfma_f32_32x32x16_bf16 v[68:83], a[40:43], v[40:43], v[68:83]
  ds_read_b128 v[36:39], v204 offset:39936
  v_cvt_pk_bf16_f32 v48, v0, v4
  v_cvt_pk_bf16_f32 v49, v1, v5
  v_cvt_pk_bf16_f32 v50, v2, v6
  v_cvt_pk_bf16_f32 v51, v3, v7
  v_mfma_f32_32x32x16_bf16 v[84:99], v[40:43], a[184:187], v[84:99]
  buffer_store_dwordx4 v[48:51], v216, s[8:11], s72 offen offset:0 sc1
  s_waitcnt lgkmcnt(2)
  v_mfma_f32_32x32x16_bf16 v[68:83], a[44:47], v[44:47], v[68:83]
  ds_read_b128 v[40:43], v205 offset:39936
  v_mfma_f32_32x32x16_bf16 v[84:99], v[44:47], a[188:191], v[84:99]
  s_waitcnt lgkmcnt(2)
  v_mfma_f32_32x32x16_bf16 v[68:83], a[48:51], v[32:35], v[68:83]
  ds_read_b128 v[44:47], v206 offset:39936
  v_mul_f32 v8, s68, v8
  v_mul_f32 v9, s68, v9
  v_mul_f32 v10, s68, v10
  v_mul_f32 v11, s68, v11
  v_mfma_f32_32x32x16_bf16 v[84:99], v[32:35], a[192:195], v[84:99]
  v_mul_f32 v12, s68, v12
  v_mul_f32 v13, s68, v13
  v_mul_f32 v14, s68, v14
  v_mul_f32 v15, s68, v15
  s_waitcnt lgkmcnt(2)
  v_mfma_f32_32x32x16_bf16 v[68:83], a[52:55], v[36:39], v[68:83]
  ds_read_b128 v[32:35], v203 offset:40960
  v_cvt_pk_bf16_f32 v52, v8, v12
  v_cvt_pk_bf16_f32 v53, v9, v13
  v_cvt_pk_bf16_f32 v54, v10, v14
  v_cvt_pk_bf16_f32 v55, v11, v15
  v_mfma_f32_32x32x16_bf16 v[84:99], v[36:39], a[196:199], v[84:99]
  buffer_store_dwordx4 v[52:55], v216, s[8:11], s72 offen offset:256 sc1
  s_waitcnt lgkmcnt(2)
  v_mfma_f32_32x32x16_bf16 v[68:83], a[56:59], v[40:43], v[68:83]
  ds_read_b128 v[36:39], v204 offset:40960
  v_mfma_f32_32x32x16_bf16 v[84:99], v[40:43], a[200:203], v[84:99]
  s_waitcnt lgkmcnt(2)
  v_mfma_f32_32x32x16_bf16 v[68:83], a[60:63], v[44:47], v[68:83]
  ds_read_b128 v[40:43], v205 offset:40960
  v_cvt_pk_bf16_f32 v56, v16, v17
  v_cvt_pk_bf16_f32 v57, v20, v21
  v_cvt_pk_bf16_f32 v58, v24, v25
  v_cvt_pk_bf16_f32 v59, v28, v29
  v_mfma_f32_32x32x16_bf16 v[84:99], v[44:47], a[204:207], v[84:99]
  buffer_store_dwordx4 v[56:59], v217, s[8:11], s64 offen offset:0 sc1
  s_waitcnt lgkmcnt(2)
  v_mfma_f32_32x32x16_bf16 v[68:83], a[64:67], v[32:35], v[68:83]
  ds_read_b128 v[44:47], v206 offset:40960
  v_mfma_f32_32x32x16_bf16 v[84:99], v[32:35], a[208:211], v[84:99]
  s_waitcnt lgkmcnt(2)
  v_mfma_f32_32x32x16_bf16 v[68:83], a[68:71], v[36:39], v[68:83]
  ds_read_b128 v[32:35], v203 offset:41984
  v_cvt_pk_bf16_f32 v60, v18, v19
  v_cvt_pk_bf16_f32 v61, v22, v23
  v_cvt_pk_bf16_f32 v62, v26, v27
  v_cvt_pk_bf16_f32 v63, v30, v31
  v_mfma_f32_32x32x16_bf16 v[84:99], v[36:39], a[212:215], v[84:99]
  buffer_store_dwordx4 v[60:63], v217, s[8:11], s64 offen offset:256 sc1
  s_waitcnt lgkmcnt(2)
  v_mfma_f32_32x32x16_bf16 v[68:83], a[72:75], v[40:43], v[68:83]
  ds_read_b128 v[36:39], v204 offset:41984
  v_mfma_f32_32x32x16_bf16 v[84:99], v[40:43], a[216:219], v[84:99]
  s_waitcnt lgkmcnt(2)
  v_mfma_f32_32x32x16_bf16 v[68:83], a[76:79], v[44:47], v[68:83]
  ds_read_b128 v[40:43], v205 offset:41984
  buffer_store_dwordx4 v[64:67], v201, s[8:11], s73 offen sc1
  v_mfma_f32_32x32x16_bf16 v[84:99], v[44:47], a[220:223], v[84:99]
  s_waitcnt lgkmcnt(2)
  v_mfma_f32_32x32x16_bf16 v[68:83], a[80:83], v[32:35], v[68:83]
  ds_read_b128 v[44:47], v206 offset:41984
  v_mfma_f32_32x32x16_bf16 v[84:99], v[32:35], a[224:227], v[84:99]
  s_waitcnt lgkmcnt(2)
  v_mfma_f32_32x32x16_bf16 v[68:83], a[84:87], v[36:39], v[68:83]
  ds_read_b128 v[32:35], v203 offset:43008
  v_mfma_f32_32x32x16_bf16 v[84:99], v[36:39], a[228:231], v[84:99]
  s_waitcnt lgkmcnt(2)
  v_mfma_f32_32x32x16_bf16 v[68:83], a[88:91], v[40:43], v[68:83]
  ds_read_b128 v[36:39], v204 offset:43008
  v_mfma_f32_32x32x16_bf16 v[84:99], v[40:43], a[232:235], v[84:99]
  s_waitcnt lgkmcnt(2)
  v_mfma_f32_32x32x16_bf16 v[68:83], a[92:95], v[44:47], v[68:83]
  ds_read_b128 v[40:43], v205 offset:43008
  v_mfma_f32_32x32x16_bf16 v[84:99], v[44:47], a[236:239], v[84:99]
  s_waitcnt lgkmcnt(2)
  v_mfma_f32_32x32x16_bf16 v[68:83], a[96:99], v[32:35], v[68:83]
  ds_read_b128 v[44:47], v206 offset:43008
  v_mfma_f32_32x32x16_bf16 v[84:99], v[32:35], a[240:243], v[84:99]
  s_waitcnt lgkmcnt(2)
  v_mfma_f32_32x32x16_bf16 v[68:83], a[100:103], v[36:39], v[68:83]
  ds_read_b128 v[32:35], v203 offset:44032
  v_mfma_f32_32x32x16_bf16 v[84:99], v[36:39], a[244:247], v[84:99]
  s_waitcnt lgkmcnt(2)
  v_mfma_f32_32x32x16_bf16 v[68:83], a[104:107], v[40:43], v[68:83]
  ds_read_b128 v[36:39], v204 offset:44032
  v_mfma_f32_32x32x16_bf16 v[84:99], v[40:43], a[248:251], v[84:99]
  s_waitcnt lgkmcnt(2)
  v_mfma_f32_32x32x16_bf16 v[68:83], a[108:111], v[44:47], v[68:83]
  ds_read_b128 v[40:43], v205 offset:44032
  v_mfma_f32_32x32x16_bf16 v[84:99], v[44:47], a[252:255], v[84:99]
  s_waitcnt lgkmcnt(2)
  v_mfma_f32_32x32x16_bf16 v[68:83], a[112:115], v[32:35], v[68:83]
  ds_read_b128 v[44:47], v206 offset:44032
  v_mfma_f32_32x32x16_bf16 v[84:99], v[32:35], v[224:227], v[84:99]
  s_waitcnt lgkmcnt(2)
  v_mfma_f32_32x32x16_bf16 v[68:83], a[116:119], v[36:39], v[68:83]
  ds_read_b128 v[32:35], v203 offset:45056
  v_mfma_f32_32x32x16_bf16 v[84:99], v[36:39], v[228:231], v[84:99]
  s_waitcnt lgkmcnt(2)
  v_mfma_f32_32x32x16_bf16 v[68:83], a[120:123], v[40:43], v[68:83]
  ds_read_b128 v[36:39], v204 offset:45056
  v_mfma_f32_32x32x16_bf16 v[84:99], v[40:43], v[232:235], v[84:99]
  s_waitcnt lgkmcnt(2)
  v_mfma_f32_32x32x16_bf16 v[68:83], a[124:127], v[44:47], v[68:83]
  ds_read_b128 v[40:43], v205 offset:45056
  v_mfma_f32_32x32x16_bf16 v[84:99], v[44:47], v[236:239], v[84:99]
  s_waitcnt lgkmcnt(2)
  v_mfma_f32_32x32x16_bf16 v[68:83], a[128:131], v[32:35], v[68:83]
  ds_read_b128 v[44:47], v206 offset:45056
  v_mfma_f32_32x32x16_bf16 v[84:99], v[32:35], v[240:243], v[84:99]
  s_waitcnt lgkmcnt(2)
  v_mfma_f32_32x32x16_bf16 v[68:83], a[132:135], v[36:39], v[68:83]
  v_mfma_f32_32x32x16_bf16 v[84:99], v[36:39], v[244:247], v[84:99]
  s_waitcnt lgkmcnt(1)
  v_mfma_f32_32x32x16_bf16 v[68:83], a[136:139], v[40:43], v[68:83]
  v_mfma_f32_32x32x16_bf16 v[84:99], v[40:43], v[248:251], v[84:99]
  s_waitcnt lgkmcnt(0)
  v_mfma_f32_32x32x16_bf16 v[68:83], a[140:143], v[44:47], v[68:83]
  v_mfma_f32_32x32x16_bf16 v[84:99], v[44:47], v[252:255], v[84:99]
  s_mul_i32 s64, s59, 655360
  s_lshl_b32 s55, s58, 14
  s_add_u32 s64, s64, s55
  s_add_u32 s64, s64, 1048576
  s_add_u32 s72, s64, s69
  s_add_u32 s73, s64, s66
  s_add_u32 s59, s59, 7
  s_cmp_ge_u32 s59, 64
  s_cbranch_scc1 KV_done1
  s_waitcnt vmcnt(5)
  s_barrier
  s_add_u32 s60, s60, 258048
  ds_read_b128 v[32:35], v203 offset:0
  ds_read_b128 v[36:39], v204 offset:0
  ds_read_b128 v[40:43], v205 offset:0
  s_waitcnt lgkmcnt(2)
  v_mfma_f32_32x32x16_bf16 v[0:15], a[0:3], v[32:35], 0
  ds_read_b128 v[44:47], v206 offset:0
  s_add_u32 m0, s67, 36864
  s_nop 0
  buffer_load_dwordx4 v202, s[4:7], s60 offen offset:0 lds
  v_mfma_f32_32x32x16_bf16 v[16:31], v[32:35], a[144:147], 0
  s_waitcnt lgkmcnt(2)
  v_mfma_f32_32x32x16_bf16 v[0:15], a[4:7], v[36:39], v[0:15]
  ds_read_b128 v[32:35], v203 offset:1024
  s_add_u32 m0, s67, 37760
  s_nop 0
  buffer_load_dwordx4 v202, s[4:7], s60 offen offset:128 lds
  v_mfma_f32_32x32x16_bf16 v[16:31], v[36:39], a[148:151], v[16:31]
  s_waitcnt lgkmcnt(2)
  v_mfma_f32_32x32x16_bf16 v[0:15], a[8:11], v[40:43], v[0:15]
  ds_read_b128 v[36:39], v204 offset:1024
  s_add_u32 m0, s67, 38656
  s_nop 0
  buffer_load_dwordx4 v202, s[4:7], s60 offen offset:256 lds
  v_mfma_f32_32x32x16_bf16 v[16:31], v[40:43], a[152:155], v[16:31]
  s_waitcnt lgkmcnt(2)
  v_mfma_f32_32x32x16_bf16 v[0:15], a[12:15], v[44:47], v[0:15]
  ds_read_b128 v[40:43], v205 offset:1024
  s_add_u32 m0, s67, 39552
  s_nop 0
  buffer_load_dwordx4 v202, s[4:7], s60 offen offset:384 lds
  v_mfma_f32_32x32x16_bf16 v[16:31], v[44:47], a[156:159], v[16:31]
  s_waitcnt lgkmcnt(2)
  v_mfma_f32_32x32x16_bf16 v[0:15], a[16:19], v[32:35], v[0:15]
  ds_read_b128 v[44:47], v206 offset:1024
  s_add_u32 m0, s67, 40448
  s_nop 0
  buffer_load_dwordx4 v202, s[4:7], s60 offen offset:512 lds
  v_mfma_f32_32x32x16_bf16 v[16:31], v[32:35], a[160:163], v[16:31]
  s_waitcnt lgkmcnt(2)
  v_mfma_f32_32x32x16_bf16 v[0:15], a[20:23], v[36:39], v[0:15]
  ds_read_b128 v[32:35], v203 offset:2048
  s_add_u32 m0, s67, 41344
  s_nop 0
  buffer_load_dwordx4 v202, s[4:7], s60 offen offset:640 lds
  v_mfma_f32_32x32x16_bf16 v[16:31], v[36:39], a[164:167], v[16:31]
  s_waitcnt lgkmcnt(2)
  v_mfma_f32_32x32x16_bf16 v[0:15], a[24:27], v[40:43], v[0:15]
  ds_read_b128 v[36:39], v204 offset:2048
  s_add_u32 m0, s67, 42240
  s_nop 0
  buffer_load_dwordx4 v202, s[4:7], s60 offen offset:768 lds
  v_mfma_f32_32x32x16_bf16 v[16:31], v[40:43], a[168:171], v[16:31]
  s_waitcnt lgkmcnt(2)
  v_mfma_f32_32x32x16_bf16 v[0:15], a[28:31], v[44:47], v[0:15]
  ds_read_b128 v[40:43], v205 offset:2048
  s_add_u32 m0, s67, 43136
  s_nop 0
  buffer_load_dwordx4 v202, s[4:7], s60 offen offset:896 lds
  v_mfma_f32_32x32x16_bf16 v[16:31], v[44:47], a[172:175], v[16:31]
  s_waitcnt lgkmcnt(2)
  v_mfma_f32_32x32x16_bf16 v[0:15], a[32:35], v[32:35], v[0:15]
  ds_read_b128 v[44:47], v206 offset:2048
  s_add_u32 m0, s67, 44032
  s_nop 0
  buffer_load_dwordx4 v202, s[4:7], s60 offen offset:1024 lds
  v_mfma_f32_32x32x16_bf16 v[16:31], v[32:35], a[176:179], v[16:31]
  s_waitcnt lgkmcnt(2)
  v_mfma_f32_32x32x16_bf16 v[0:15], a[36:39], v[36:39], v[0:15]
  ds_read_b128 v[32:35], v203 offset:3072
  v_mul_f32 v68, s68, v68
  v_mul_f32 v69, s68, v69
  v_mul_f32 v70, s68, v70
  v_mul_f32 v71, s68, v71
  v_mfma_f32_32x32x16_bf16 v[16:31], v[36:39], a[180:183], v[16:31]
  v_mul_f32 v72, s68, v72
  v_mul_f32 v73, s68, v73
  v_mul_f32 v74, s68, v74
  v_mul_f32 v75, s68, v75
  s_waitcnt lgkmcnt(2)
  v_mfma_f32_32x32x16_bf16 v[0:15], a[40:43], v[40:43], v[0:15]
  ds_read_b128 v[36:39], v204 offset:3072
  v_cvt_pk_bf16_f32 v48, v68, v72
  v_cvt_pk_bf16_f32 v49, v69, v73
  v_cvt_pk_bf16_f32 v50, v70, v74
  v_cvt_pk_bf16_f32 v51, v71, v75
  v_mfma_f32_32x32x16_bf16 v[16:31], v[40:43], a[184:187], v[16:31]
  buffer_store_dwordx4 v[48:51], v216, s[8:11], s72 offen offset:0 sc1
  s_waitcnt lgkmcnt(2)
  v_mfma_f32_32x32x16_bf16 v[0:15], a[44:47], v[44:47], v[0:15]
  ds_read_b128 v[40:43], v205 offset:3072
  v_mfma_f32_32x32x16_bf16 v[16:31], v[44:47], a[188:191], v[16:31]
  s_waitcnt lgkmcnt(2)
  v_mfma_f32_32x32x16_bf16 v[0:15], a[48:51], v[32:35], v[0:15]
  ds_read_b128 v[44:47], v206 offset:3072
  v_mul_f32 v76, s68, v76
  v_mul_f32 v77, s68, v77
  v_mul_f32 v78, s68, v78
  v_mul_f32 v79, s68, v79
  v_mfma_f32_32x32x16_bf16 v[16:31], v[32:35], a[192:195], v[16:31]
  v_mul_f32 v80, s68, v80
  v_mul_f32 v81, s68, v81
  v_mul_f32 v82, s68, v82
  v_mul_f32 v83, s68, v83
  s_waitcnt lgkmcnt(2)
  v_mfma_f32_32x32x16_bf16 v[0:15], a[52:55], v[36:39], v[0:15]
  ds_read_b128 v[32:35], v203 offset:4096
  v_cvt_pk_bf16_f32 v52, v76, v80
  v_cvt_pk_bf16_f32 v53, v77, v81
  v_cvt_pk_bf16_f32 v54, v78, v82
  v_cvt_pk_bf16_f32 v55, v79, v83
  v_mfma_f32_32x32x16_bf16 v[16:31], v[36:39], a[196:199], v[16:31]
  buffer_store_dwordx4 v[52:55], v216, s[8:11], s72 offen offset:256 sc1
  s_waitcnt lgkmcnt(2)
  v_mfma_f32_32x32x16_bf16 v[0:15], a[56:59], v[40:43], v[0:15]
  ds_read_b128 v[36:39], v204 offset:4096
  v_mfma_f32_32x32x16_bf16 v[16:31], v[40:43], a[200:203], v[16:31]
  s_waitcnt lgkmcnt(2)
  v_mfma_f32_32x32x16_bf16 v[0:15], a[60:63], v[44:47], v[0:15]
  ds_read_b128 v[40:43], v205 offset:4096
  v_cvt_pk_bf16_f32 v56, v84, v85
  v_cvt_pk_bf16_f32 v57, v88, v89
  v_cvt_pk_bf16_f32 v58, v92, v93
  v_cvt_pk_bf16_f32 v59, v96, v97
  v_mfma_f32_32x32x16_bf16 v[16:31], v[44:47], a[204:207], v[16:31]
  buffer_store_dwordx4 v[56:59], v217, s[8:11], s64 offen offset:0 sc1
  s_waitcnt lgkmcnt(2)
  v_mfma_f32_32x32x16_bf16 v[0:15], a[64:67], v[32:35], v[0:15]
  ds_read_b128 v[44:47], v206 offset:4096
  v_mfma_f32_32x32x16_bf16 v[16:31], v[32:35], a[208:211], v[16:31]
  s_waitcnt lgkmcnt(2)
  v_mfma_f32_32x32x16_bf16 v[0:15], a[68:71], v[36:39], v[0:15]
  ds_read_b128 v[32:35], v203 offset:5120
  v_cvt_pk_bf16_f32 v60, v86, v87
  v_cvt_pk_bf16_f32 v61, v90, v91
  v_cvt_pk_bf16_f32 v62, v94, v95
  v_cvt_pk_bf16_f32 v63, v98, v99
  v_mfma_f32_32x32x16_bf16 v[16:31], v[36:39], a[212:215], v[16:31]
  buffer_store_dwordx4 v[60:63], v217, s[8:11], s64 offen offset:256 sc1
  s_waitcnt lgkmcnt(2)
  v_mfma_f32_32x32x16_bf16 v[0:15], a[72:75], v[40:43], v[0:15]
  ds_read_b128 v[36:39], v204 offset:5120
  v_mfma_f32_32x32x16_bf16 v[16:31], v[40:43], a[216:219], v[16:31]
  s_waitcnt lgkmcnt(2)
  v_mfma_f32_32x32x16_bf16 v[0:15], a[76:79], v[44:47], v[0:15]
  ds_read_b128 v[40:43], v205 offset:5120
  buffer_store_dwordx4 v[64:67], v201, s[8:11], s73 offen sc1
  v_mfma_f32_32x32x16_bf16 v[16:31], v[44:47], a[220:223], v[16:31]
  s_waitcnt lgkmcnt(2)
  v_mfma_f32_32x32x16_bf16 v[0:15], a[80:83], v[32:35], v[0:15]
  ds_read_b128 v[44:47], v206 offset:5120
  v_mfma_f32_32x32x16_bf16 v[16:31], v[32:35], a[224:227], v[16:31]
  s_waitcnt lgkmcnt(2)
  v_mfma_f32_32x32x16_bf16 v[0:15], a[84:87], v[36:39], v[0:15]
  ds_read_b128 v[32:35], v203 offset:6144
  v_mfma_f32_32x32x16_bf16 v[16:31], v[36:39], a[228:231], v[16:31]
  s_waitcnt lgkmcnt(2)
  v_mfma_f32_32x32x16_bf16 v[0:15], a[88:91], v[40:43], v[0:15]
  ds_read_b128 v[36:39], v204 offset:6144
  v_mfma_f32_32x32x16_bf16 v[16:31], v[40:43], a[232:235], v[16:31]
  s_waitcnt lgkmcnt(2)
  v_mfma_f32_32x32x16_bf16 v[0:15], a[92:95], v[44:47], v[0:15]
  ds_read_b128 v[40:43], v205 offset:6144
  v_mfma_f32_32x32x16_bf16 v[16:31], v[44:47], a[236:239], v[16:31]
  s_waitcnt lgkmcnt(2)
  v_mfma_f32_32x32x16_bf16 v[0:15], a[96:99], v[32:35], v[0:15]
  ds_read_b128 v[44:47], v206 offset:6144
  v_mfma_f32_32x32x16_bf16 v[16:31], v[32:35], a[240:243], v[16:31]
  s_waitcnt lgkmcnt(2)
  v_mfma_f32_32x32x16_bf16 v[0:15], a[100:103], v[36:39], v[0:15]
  ds_read_b128 v[32:35], v203 offset:7168
  v_mfma_f32_32x32x16_bf16 v[16:31], v[36:39], a[244:247], v[16:31]
  s_waitcnt lgkmcnt(2)
  v_mfma_f32_32x32x16_bf16 v[0:15], a[104:107], v[40:43], v[0:15]
  ds_read_b128 v[36:39], v204 offset:7168
  v_mfma_f32_32x32x16_bf16 v[16:31], v[40:43], a[248:251], v[16:31]
  s_waitcnt lgkmcnt(2)
  v_mfma_f32_32x32x16_bf16 v[0:15], a[108:111], v[44:47], v[0:15]
  ds_read_b128 v[40:43], v205 offset:7168
  v_mfma_f32_32x32x16_bf16 v[16:31], v[44:47], a[252:255], v[16:31]
  s_waitcnt lgkmcnt(2)
  v_mfma_f32_32x32x16_bf16 v[0:15], a[112:115], v[32:35], v[0:15]
  ds_read_b128 v[44:47], v206 offset:7168
  v_mfma_f32_32x32x16_bf16 v[16:31], v[32:35], v[224:227], v[16:31]
  s_waitcnt lgkmcnt(2)
  v_mfma_f32_32x32x16_bf16 v[0:15], a[116:119], v[36:39], v[0:15]
  ds_read_b128 v[32:35], v203 offset:8192
  v_mfma_f32_32x32x16_bf16 v[16:31], v[36:39], v[228:231], v[16:31]
  s_waitcnt lgkmcnt(2)
  v_mfma_f32_32x32x16_bf16 v[0:15], a[120:123], v[40:43], v[0:15]
  ds_read_b128 v[36:39], v204 offset:8192
  v_mfma_f32_32x32x16_bf16 v[16:31], v[40:43], v[232:235], v[16:31]
  s_waitcnt lgkmcnt(2)
  v_mfma_f32_32x32x16_bf16 v[0:15], a[124:127], v[44:47], v[0:15]
  ds_read_b128 v[40:43], v205 offset:8192
  v_mfma_f32_32x32x16_bf16 v[16:31], v[44:47], v[236:239], v[16:31]
  s_waitcnt lgkmcnt(2)
  v_mfma_f32_32x32x16_bf16 v[0:15], a[128:131], v[32:35], v[0:15]
  ds_read_b128 v[44:47], v206 offset:8192
  v_mfma_f32_32x32x16_bf16 v[16:31], v[32:35], v[240:243], v[16:31]
  s_waitcnt lgkmcnt(2)
  v_mfma_f32_32x32x16_bf16 v[0:15], a[132:135], v[36:39], v[0:15]
  v_mfma_f32_32x32x16_bf16 v[16:31], v[36:39], v[244:247], v[16:31]
  s_waitcnt lgkmcnt(1)
  v_mfma_f32_32x32x16_bf16 v[0:15], a[136:139], v[40:43], v[0:15]
  v_mfma_f32_32x32x16_bf16 v[16:31], v[40:43], v[248:251], v[16:31]
  s_waitcnt lgkmcnt(0)
  v_mfma_f32_32x32x16_bf16 v[0:15], a[140:143], v[44:47], v[0:15]
  v_mfma_f32_32x32x16_bf16 v[16:31], v[44:47], v[252:255], v[16:31]
  s_mul_i32 s64, s59, 655360
  s_lshl_b32 s55, s58, 14
  s_add_u32 s64, s64, s55
  s_add_u32 s64, s64, 1048576
  s_add_u32 s72, s64, s69
  s_add_u32 s73, s64, s66
  s_add_u32 s59, s59, 7
  s_cmp_ge_u32 s59, 64
  s_cbranch_scc1 KV_done0
  s_sub_u32 s54, s59, 21
  s_cmp_lt_u32 s54, 7
  s_cbranch_scc1 KV_early
  s_waitcnt vmcnt(5)
  s_barrier
KV_cont:
  s_branch KV_loop
KV_early:
  s_waitcnt vmcnt(0)
  s_barrier
  s_cmp_eq_u32 s52, 0
  s_cbranch_scc0 KV_sig0
  v_mov_b32 v211, 1
  v_mov_b32 v212, 0
  s_mov_b64 exec, 1
  buffer_atomic_add v211, v212, s[12:15], s70 offen
  s_mov_b64 exec, -1
KV_sig0:
  s_branch KV_cont
KV_done1:
  s_nop 11
  v_mul_f32 v68, s68, v68
  v_mul_f32 v69, s68, v69
  v_mul_f32 v70, s68, v70
  v_mul_f32 v71, s68, v71
  v_mul_f32 v72, s68, v72
  v_mul_f32 v73, s68, v73
  v_mul_f32 v74, s68, v74
  v_mul_f32 v75, s68, v75
  v_cvt_pk_bf16_f32 v48, v68, v72
  v_cvt_pk_bf16_f32 v49, v69, v73
  v_cvt_pk_bf16_f32 v50, v70, v74
  v_cvt_pk_bf16_f32 v51, v71, v75
  buffer_store_dwordx4 v[48:51], v216, s[8:11], s72 offen offset:0 sc1
  v_mul_f32 v76, s68, v76
  v_mul_f32 v77, s68, v77
  v_mul_f32 v78, s68, v78
  v_mul_f32 v79, s68, v79
  v_mul_f32 v80, s68, v80
  v_mul_f32 v81, s68, v81
  v_mul_f32 v82, s68, v82
  v_mul_f32 v83, s68, v83
  v_cvt_pk_bf16_f32 v52, v76, v80
  v_cvt_pk_bf16_f32 v53, v77, v81
  v_cvt_pk_bf16_f32 v54, v78, v82
  v_cvt_pk_bf16_f32 v55, v79, v83
  buffer_store_dwordx4 v[52:55], v216, s[8:11], s72 offen offset:256 sc1
  v_cvt_pk_bf16_f32 v56, v84, v85
  v_cvt_pk_bf16_f32 v57, v88, v89
  v_cvt_pk_bf16_f32 v58, v92, v93
  v_cvt_pk_bf16_f32 v59, v96, v97
  buffer_store_dwordx4 v[56:59], v217, s[8:11], s64 offen offset:0 sc1
  v_cvt_pk_bf16_f32 v60, v86, v87
  v_cvt_pk_bf16_f32 v61, v90, v91
  v_cvt_pk_bf16_f32 v62, v94, v95
  v_cvt_pk_bf16_f32 v63, v98, v99
  buffer_store_dwordx4 v[60:63], v217, s[8:11], s64 offen offset:256 sc1
  buffer_store_dwordx4 v[64:67], v201, s[8:11], s73 offen sc1
  s_branch KV_fin
KV_done0:
  s_nop 11
  v_mul_f32 v0, s68, v0
  v_mul_f32 v1, s68, v1
  v_mul_f32 v2, s68, v2
  v_mul_f32 v3, s68, v3
  v_mul_f32 v4, s68, v4
  v_mul_f32 v5, s68, v5
  v_mul_f32 v6, s68, v6
  v_mul_f32 v7, s68, v7
  v_cvt_pk_bf16_f32 v48, v0, v4
  v_cvt_pk_bf16_f32 v49, v1, v5
  v_cvt_pk_bf16_f32 v50, v2, v6
  v_cvt_pk_bf16_f32 v51, v3, v7
  buffer_store_dwordx4 v[48:51], v216, s[8:11], s72 offen offset:0 sc1
  v_mul_f32 v8, s68, v8
  v_mul_f32 v9, s68, v9
  v_mul_f32 v10, s68, v10
  v_mul_f32 v11, s68, v11
  v_mul_f32 v12, s68, v12
  v_mul_f32 v13, s68, v13
  v_mul_f32 v14, s68, v14
  v_mul_f32 v15, s68, v15
  v_cvt_pk_bf16_f32 v52, v8, v12
  v_cvt_pk_bf16_f32 v53, v9, v13
  v_cvt_pk_bf16_f32 v54, v10, v14
  v_cvt_pk_bf16_f32 v55, v11, v15
  buffer_store_dwordx4 v[52:55], v216, s[8:11], s72 offen offset:256 sc1
  v_cvt_pk_bf16_f32 v56, v16, v17
  v_cvt_pk_bf16_f32 v57, v20, v21
  v_cvt_pk_bf16_f32 v58, v24, v25
  v_cvt_pk_bf16_f32 v59, v28, v29
  buffer_store_dwordx4 v[56:59], v217, s[8:11], s64 offen offset:0 sc1
  v_cvt_pk_bf16_f32 v60, v18, v19
  v_cvt_pk_bf16_f32 v61, v22, v23
  v_cvt_pk_bf16_f32 v62, v26, v27
  v_cvt_pk_bf16_f32 v63, v30, v31
  buffer_store_dwordx4 v[60:63], v217, s[8:11], s64 offen offset:256 sc1
  buffer_store_dwordx4 v[64:67], v201, s[8:11], s73 offen sc1
KV_fin:
  s_waitcnt vmcnt(0)
  s_barrier
  s_cmp_eq_u32 s52, 0
  s_cbranch_scc0 KV_sig
  v_mov_b32 v211, 256
  v_mov_b32 v212, 0
  s_mov_b64 exec, 1
  buffer_atomic_add v211, v212, s[12:15], s70 offen
  s_mov_b64 exec, -1
KV_sig:
  s_cmp_ge_u32 s53, 208
  s_cbranch_scc1 L_exit
  s_cmp_ge_u32 s53, 192
  s_cbranch_scc1 W_o
  s_cmp_lt_u32 s53, 64
  s_cbranch_scc1 W_h
  s_sub_u32 s54, s53, 64
  s_lshr_b32 s68, s54, 4
  s_and_b32 s69, s54, 15
  s_lshl_b32 s60, s69, 2
  s_sub_u32 s60, s60, 1
  s_max_i32 s60, s60, 0
  s_mul_i32 s60, s60, 36864
  s_add_u32 m0, s67, 0
  s_nop 0
  buffer_load_dwordx4 v202, s[4:7], s60 offen offset:0 lds
  s_add_u32 m0, s67, 896
  s_nop 0
  buffer_load_dwordx4 v202, s[4:7], s60 offen offset:128 lds
  s_add_u32 m0, s67, 1792
  s_nop 0
  buffer_load_dwordx4 v202, s[4:7], s60 offen offset:256 lds
  s_add_u32 m0, s67, 2688
  s_nop 0
  buffer_load_dwordx4 v202, s[4:7], s60 offen offset:384 lds
  s_add_u32 m0, s67, 3584
  s_nop 0
  buffer_load_dwordx4 v202, s[4:7], s60 offen offset:512 lds
  s_add_u32 m0, s67, 4480
  s_nop 0
  buffer_load_dwordx4 v202, s[4:7], s60 offen offset:640 lds
  s_add_u32 m0, s67, 5376
  s_nop 0
  buffer_load_dwordx4 v202, s[4:7], s60 offen offset:768 lds
  s_add_u32 m0, s67, 6272
  s_nop 0
  buffer_load_dwordx4 v202, s[4:7], s60 offen offset:896 lds
  s_add_u32 m0, s67, 7168
  s_nop 0
  buffer_load_dwordx4 v202, s[4:7], s60 offen offset:1024 lds
  v_and_b32 v211, 15, v200
  v_mul_u32_u24 v211, 72, v211
  v_lshrrev_b32 v212, 4, v200
  v_mul_u32_u24 v213, 1152, v212
  v_add_u32 v213, v213, v211
  s_lshl_b32 s54, s54, 2
  s_add_u32 s70, s54, s52
  s_mul_i32 s55, s70, 4608
  buffer_load_dwordx4 v[48:51], v213, s[4:7], s55 offen offset:0
  buffer_load_dwordx4 v[52:55], v213, s[4:7], s55 offen offset:16
  buffer_load_dwordx4 v[56:59], v213, s[4:7], s55 offen offset:32
  buffer_load_dwordx4 v[60:63], v213, s[4:7], s55 offen offset:48
  buffer_load_dwordx2 v[64:65], v213, s[4:7], s55 offen offset:64
  buffer_load_dwordx4 v[68:71], v211, s[44:47], 0 offen offset:0
  buffer_load_dwordx4 v[72:75], v211, s[44:47], 0 offen offset:16
  buffer_load_dwordx4 v[76:79], v211, s[44:47], 0 offen offset:32
  buffer_load_dwordx4 v[80:83], v211, s[44:47], 0 offen offset:48
  buffer_load_dwordx2 v[84:85], v211, s[44:47], 0 offen offset:64
  v_mov_b32 v0, 0
  v_mov_b32 v1, 0x3f803f80
  s_waitcnt vmcnt(9)
  v_lshlrev_b32 v2, 16, v48
  s_waitcnt vmcnt(4)
  v_lshlrev_b32 v3, 16, v68
  v_and_b32 v4, 0xffff0000, v48
  v_and_b32 v5, 0xffff0000, v68
  v_mul_f32 v2, v2, v3
  v_mul_f32 v4, v4, v5
  v_cvt_pk_bf16_f32 v2, v2, v4
  v_lshlrev_b32 v3, 16, v2
  v_and_b32 v4, 0xffff0000, v2
  v_add_f32 v0, v0, v3
  v_add_f32 v0, v0, v4
  v_lshlrev_b32 v2, 16, v49
  v_lshlrev_b32 v3, 16, v69
  v_and_b32 v4, 0xffff0000, v49
  v_and_b32 v5, 0xffff0000, v69
  v_mul_f32 v2, v2, v3
  v_mul_f32 v4, v4, v5
  v_cvt_pk_bf16_f32 v2, v2, v4
  v_lshlrev_b32 v3, 16, v2
  v_and_b32 v4, 0xffff0000, v2
  v_add_f32 v0, v0, v3
  v_add_f32 v0, v0, v4
  v_lshlrev_b32 v2, 16, v50
  v_lshlrev_b32 v3, 16, v70
  v_and_b32 v4, 0xffff0000, v50
  v_and_b32 v5, 0xffff0000, v70
  v_mul_f32 v2, v2, v3
  v_mul_f32 v4, v4, v5
  v_cvt_pk_bf16_f32 v2, v2, v4
  v_lshlrev_b32 v3, 16, v2
  v_and_b32 v4, 0xffff0000, v2
  v_add_f32 v0, v0, v3
  v_add_f32 v0, v0, v4
  v_lshlrev_b32 v2, 16, v51
  v_lshlrev_b32 v3, 16, v71
  v_and_b32 v4, 0xffff0000, v51
  v_and_b32 v5, 0xffff0000, v71
  v_mul_f32 v2, v2, v3
  v_mul_f32 v4, v4, v5
  v_cvt_pk_bf16_f32 v2, v2, v4
  v_lshlrev_b32 v3, 16, v2
  v_and_b32 v4, 0xffff0000, v2
  v_add_f32 v0, v0, v3
  v_add_f32 v0, v0, v4
  v_lshlrev_b32 v2, 16, v52
  s_waitcnt vmcnt(3)
  v_lshlrev_b32 v3, 16, v72
  v_and_b32 v4, 0xffff0000, v52
  v_and_b32 v5, 0xffff0000, v72
  v_mul_f32 v2, v2, v3
  v_mul_f32 v4, v4, v5
  v_cvt_pk_bf16_f32 v2, v2, v4
  v_lshlrev_b32 v3, 16, v2
  v_and_b32 v4, 0xffff0000, v2
  v_add_f32 v0, v0, v3
  v_add_f32 v0, v0, v4
  v_lshlrev_b32 v2, 16, v53
  v_lshlrev_b32 v3, 16, v73
  v_and_b32 v4, 0xffff0000, v53
  v_and_b32 v5, 0xffff0000, v73
  v_mul_f32 v2, v2, v3
  v_mul_f32 v4, v4, v5
  v_cvt_pk_bf16_f32 v2, v2, v4
  v_lshlrev_b32 v3, 16, v2
  v_and_b32 v4, 0xffff0000, v2
  v_add_f32 v0, v0, v3
  v_add_f32 v0, v0, v4
  v_lshlrev_b32 v2, 16, v54
  v_lshlrev_b32 v3, 16, v74
  v_and_b32 v4, 0xffff0000, v54
  v_and_b32 v5, 0xffff0000, v74
  v_mul_f32 v2, v2, v3
  v_mul_f32 v4, v4, v5
  v_cvt_pk_bf16_f32 v2, v2, v4
  v_lshlrev_b32 v3, 16, v2
  v_and_b32 v4, 0xffff0000, v2
  v_add_f32 v0, v0, v3
  v_add_f32 v0, v0, v4
  v_lshlrev_b32 v2, 16, v55
  v_lshlrev_b32 v3, 16, v75
  v_and_b32 v4, 0xffff0000, v55
  v_and_b32 v5, 0xffff0000, v75
  v_mul_f32 v2, v2, v3
  v_mul_f32 v4, v4, v5
  v_cvt_pk_bf16_f32 v2, v2, v4
  v_lshlrev_b32 v3, 16, v2
  v_and_b32 v4, 0xffff0000, v2
  v_add_f32 v0, v0, v3
  v_add_f32 v0, v0, v4
  v_lshlrev_b32 v2, 16, v56
  s_waitcnt vmcnt(2)
  v_lshlrev_b32 v3, 16, v76
  v_and_b32 v4, 0xffff0000, v56
  v_and_b32 v5, 0xffff0000, v76
  v_mul_f32 v2, v2, v3
  v_mul_f32 v4, v4, v5
  v_cvt_pk_bf16_f32 v2, v2, v4
  v_lshlrev_b32 v3, 16, v2
  v_and_b32 v4, 0xffff0000, v2
  v_add_f32 v0, v0, v3
  v_add_f32 v0, v0, v4
  v_lshlrev_b32 v2, 16, v57
  v_lshlrev_b32 v3, 16, v77
  v_and_b32 v4, 0xffff0000, v57
  v_and_b32 v5, 0xffff0000, v77
  v_mul_f32 v2, v2, v3
  v_mul_f32 v4, v4, v5
  v_cvt_pk_bf16_f32 v2, v2, v4
  v_lshlrev_b32 v3, 16, v2
  v_and_b32 v4, 0xffff0000, v2
  v_add_f32 v0, v0, v3
  v_add_f32 v0, v0, v4
  v_lshlrev_b32 v2, 16, v58
  v_lshlrev_b32 v3, 16, v78
  v_and_b32 v4, 0xffff0000, v58
  v_and_b32 v5, 0xffff0000, v78
  v_mul_f32 v2, v2, v3
  v_mul_f32 v4, v4, v5
  v_cvt_pk_bf16_f32 v2, v2, v4
  v_lshlrev_b32 v3, 16, v2
  v_and_b32 v4, 0xffff0000, v2
  v_add_f32 v0, v0, v3
  v_add_f32 v0, v0, v4
  v_lshlrev_b32 v2, 16, v59
  v_lshlrev_b32 v3, 16, v79
  v_and_b32 v4, 0xffff0000, v59
  v_and_b32 v5, 0xffff0000, v79
  v_mul_f32 v2, v2, v3
  v_mul_f32 v4, v4, v5
  v_cvt_pk_bf16_f32 v2, v2, v4
  v_lshlrev_b32 v3, 16, v2
  v_and_b32 v4, 0xffff0000, v2
  v_add_f32 v0, v0, v3
  v_add_f32 v0, v0, v4
  v_lshlrev_b32 v2, 16, v60
  s_waitcnt vmcnt(1)
  v_lshlrev_b32 v3, 16, v80
  v_and_b32 v4, 0xffff0000, v60
  v_and_b32 v5, 0xffff0000, v80
  v_mul_f32 v2, v2, v3
  v_mul_f32 v4, v4, v5
  v_cvt_pk_bf16_f32 v2, v2, v4
  v_lshlrev_b32 v3, 16, v2
  v_and_b32 v4, 0xffff0000, v2
  v_add_f32 v0, v0, v3
  v_add_f32 v0, v0, v4
  v_lshlrev_b32 v2, 16, v61
  v_lshlrev_b32 v3, 16, v81
  v_and_b32 v4, 0xffff0000, v61
  v_and_b32 v5, 0xffff0000, v81
  v_mul_f32 v2, v2, v3
  v_mul_f32 v4, v4, v5
  v_cvt_pk_bf16_f32 v2, v2, v4
  v_lshlrev_b32 v3, 16, v2
  v_and_b32 v4, 0xffff0000, v2
  v_add_f32 v0, v0, v3
  v_add_f32 v0, v0, v4
  v_lshlrev_b32 v2, 16, v62
  v_lshlrev_b32 v3, 16, v82
  v_and_b32 v4, 0xffff0000, v62
  v_and_b32 v5, 0xffff0000, v82
  v_mul_f32 v2, v2, v3
  v_mul_f32 v4, v4, v5
  v_cvt_pk_bf16_f32 v2, v2, v4
  v_lshlrev_b32 v3, 16, v2
  v_and_b32 v4, 0xffff0000, v2
  v_add_f32 v0, v0, v3
  v_add_f32 v0, v0, v4
  v_lshlrev_b32 v2, 16, v63
  v_lshlrev_b32 v3, 16, v83
  v_and_b32 v4, 0xffff0000, v63
  v_and_b32 v5, 0xffff0000, v83
  v_mul_f32 v2, v2, v3
  v_mul_f32 v4, v4, v5
  v_cvt_pk_bf16_f32 v2, v2, v4
  v_lshlrev_b32 v3, 16, v2
  v_and_b32 v4, 0xffff0000, v2
  v_add_f32 v0, v0, v3
  v_add_f32 v0, v0, v4
  v_lshlrev_b32 v2, 16, v64
  s_waitcnt vmcnt(0)
  v_lshlrev_b32 v3, 16, v84
  v_and_b32 v4, 0xffff0000, v64
  v_and_b32 v5, 0xffff0000, v84
  v_mul_f32 v2, v2, v3
  v_mul_f32 v4, v4, v5
  v_cvt_pk_bf16_f32 v2, v2, v4
  v_lshlrev_b32 v3, 16, v2
  v_and_b32 v4, 0xffff0000, v2
  v_add_f32 v0, v0, v3
  v_add_f32 v0, v0, v4
  v_lshlrev_b32 v2, 16, v65
  v_lshlrev_b32 v3, 16, v85
  v_and_b32 v4, 0xffff0000, v65
  v_and_b32 v5, 0xffff0000, v85
  v_mul_f32 v2, v2, v3
  v_mul_f32 v4, v4, v5
  v_cvt_pk_bf16_f32 v2, v2, v4
  v_lshlrev_b32 v3, 16, v2
  v_and_b32 v4, 0xffff0000, v2
  v_add_f32 v0, v0, v3
  v_add_f32 v0, v0, v4
  s_nop 1
  v_add_f32_dpp v0, v0, v0 row_ror:1 row_mask:0xf bank_mask:0xf
  s_nop 1
  v_add_f32_dpp v0, v0, v0 row_ror:2 row_mask:0xf bank_mask:0xf
  s_nop 1
  v_add_f32_dpp v0, v0, v0 row_ror:4 row_mask:0xf bank_mask:0xf
  s_nop 1
  v_add_f32_dpp v0, v0, v0 row_ror:8 row_mask:0xf bank_mask:0xf
  v_cvt_pk_bf16_f32 v0, v0, v0
  v_lshlrev_b32 v0, 16, v0
  v_mul_f32 v0, 3216550459, v0
  v_exp_f32 v0, v0
  s_nop 0
  v_add_f32 v0, 1.0, v0
  v_rcp_f32 v0, v0
  s_nop 0
  v_cvt_pk_bf16_f32 v0, v0, v0
  v_lshlrev_b32 v0, 16, v0
  v_lshlrev_b32 v212, 2, v212
  s_lshl_b32 s55, s70, 4
  s_add_u32 s55, s55, 66060288
  s_mov_b32 exec_lo, 0x00010001
  s_mov_b32 exec_hi, 0x00010001
  buffer_store_dword v0, v212, s[8:11], s55 offen sc1
  s_mov_b64 exec, -1
  v_lshrrev_b32 v211, 4, v200
  v_lshlrev_b32 v212, 2, v211
  v_and_b32 v213, 15, v200
  v_xor_b32 v212, v212, v213
  v_mul_u32_u24 v211, 3456, v211
  v_mov_b32 v2, 0x40000000
  v_add_u32 v213, 0, v212
  v_mul_u32_u24 v214, 57, v213
  v_lshrrev_b32 v214, 9, v214
  v_mul_u32_u24 v214, 1008, v214
  v_lshl_add_u32 v214, v213, 4, v214
  v_add_u32 v214, v214, v211
  v_cmp_lt_u32 vcc, 26, v213
  s_nop 1
  v_cndmask_b32 v207, v214, v2, vcc
  v_add_u32 v213, 16, v212
  v_mul_u32_u24 v214, 57, v213
  v_lshrrev_b32 v214, 9, v214
  v_mul_u32_u24 v214, 1008, v214
  v_lshl_add_u32 v214, v213, 4, v214
  v_add_u32 v214, v214, v211
  v_cmp_lt_u32 vcc, 26, v213
  s_nop 1
  v_cndmask_b32 v208, v214, v2, vcc
  s_mul_i32 s62, s68, 144
  s_mul_i32 s54, s52, 13824
  s_add_u32 s62, s62, s54
  s_waitcnt vmcnt(0)
  s_lshl_b32 s61, s52, 10
  s_add_u32 s61, s61, 36864
  s_add_u32 m0, s61, 0
  s_add_u32 s54, s62, 0
  buffer_load_dwordx4 v207, s[36:39], s54 offen lds
  s_add_u32 m0, s61, 4096
  s_add_u32 s54, s62, 55296
  buffer_load_dwordx4 v207, s[36:39], s54 offen lds
  s_add_u32 m0, s61, 8192
  s_add_u32 s54, s62, 110592
  buffer_load_dwordx4 v207, s[36:39], s54 offen lds
  s_add_u32 m0, s61, 12288
  s_add_u32 s54, s62, 165888
  buffer_load_dwordx4 v207, s[36:39], s54 offen lds
  s_add_u32 m0, s61, 16384
  s_add_u32 s54, s62, 0
  buffer_load_dwordx4 v208, s[36:39], s54 offen lds
  s_add_u32 m0, s61, 20480
  s_add_u32 s54, s62, 55296
  buffer_load_dwordx4 v208, s[36:39], s54 offen lds
  s_add_u32 m0, s61, 24576
  s_add_u32 s54, s62, 110592
  buffer_load_dwordx4 v208, s[36:39], s54 offen lds
  s_add_u32 m0, s61, 28672
  s_add_u32 s54, s62, 165888
  buffer_load_dwordx4 v208, s[36:39], s54 offen lds
  s_add_u32 m0, s61, 32768
  s_add_u32 s54, s62, 221184
  buffer_load_dwordx4 v207, s[36:39], s54 offen lds
  s_add_u32 m0, s61, 36864
  s_add_u32 s54, s62, 276480
  buffer_load_dwordx4 v207, s[36:39], s54 offen lds
  s_add_u32 m0, s61, 40960
  s_add_u32 s54, s62, 331776
  buffer_load_dwordx4 v207, s[36:39], s54 offen lds
  s_add_u32 m0, s61, 45056
  s_add_u32 s54, s62, 387072
  buffer_load_dwordx4 v207, s[36:39], s54 offen lds
  s_add_u32 m0, s61, 49152
  s_add_u32 s54, s62, 221184
  buffer_load_dwordx4 v208, s[36:39], s54 offen lds
  s_add_u32 m0, s61, 53248
  s_add_u32 s54, s62, 276480
  buffer_load_dwordx4 v208, s[36:39], s54 offen lds
  s_add_u32 m0, s61, 57344
  s_add_u32 s54, s62, 331776
  buffer_load_dwordx4 v208, s[36:39], s54 offen lds
  s_add_u32 m0, s61, 61440
  s_add_u32 s54, s62, 387072
  buffer_load_dwordx4 v208, s[36:39], s54 offen lds
  s_add_u32 m0, s61, 65536
  s_add_u32 s54, s62, 442368
  buffer_load_dwordx4 v207, s[36:39], s54 offen lds
  s_add_u32 m0, s61, 69632
  s_add_u32 s54, s62, 497664
  buffer_load_dwordx4 v207, s[36:39], s54 offen lds
  s_add_u32 m0, s61, 73728
  s_add_u32 s54, s62, 552960
  buffer_load_dwordx4 v207, s[36:39], s54 offen lds
  s_add_u32 m0, s61, 77824
  s_add_u32 s54, s62, 608256
  buffer_load_dwordx4 v207, s[36:39], s54 offen lds
  s_add_u32 m0, s61, 81920
  s_add_u32 s54, s62, 442368
  buffer_load_dwordx4 v208, s[36:39], s54 offen lds
  s_add_u32 m0, s61, 86016
  s_add_u32 s54, s62, 497664
  buffer_load_dwordx4 v208, s[36:39], s54 offen lds
  s_add_u32 m0, s61, 90112
  s_add_u32 s54, s62, 552960
  buffer_load_dwordx4 v208, s[36:39], s54 offen lds
  s_add_u32 m0, s61, 94208
  s_add_u32 s54, s62, 608256
  buffer_load_dwordx4 v208, s[36:39], s54 offen lds
  s_waitcnt vmcnt(20) lgkmcnt(0)
  s_barrier
  s_add_u32 m0, s61, 98304
  s_add_u32 s54, s62, 663552
  buffer_load_dwordx4 v207, s[36:39], s54 offen lds
  s_add_u32 m0, s61, 102400
  s_add_u32 s54, s62, 718848
  buffer_load_dwordx4 v207, s[36:39], s54 offen lds
  s_add_u32 m0, s61, 106496
  s_add_u32 s54, s62, 774144
  buffer_load_dwordx4 v207, s[36:39], s54 offen lds
  s_add_u32 m0, s61, 110592
  s_add_u32 s54, s62, 829440
  buffer_load_dwordx4 v207, s[36:39], s54 offen lds
  v_add_u32 v215, 36864, v210
  ds_read_b64_tr_b16 a[0:1], v215 offset:0
  ds_read_b64_tr_b16 a[2:3], v215 offset:1024
  ds_read_b64_tr_b16 a[4:5], v215 offset:4096
  ds_read_b64_tr_b16 a[6:7], v215 offset:5120
  ds_read_b64_tr_b16 a[8:9], v215 offset:8192
  ds_read_b64_tr_b16 a[10:11], v215 offset:9216
  ds_read_b64_tr_b16 a[12:13], v215 offset:12288
  ds_read_b64_tr_b16 a[14:15], v215 offset:13312
  s_waitcnt vmcnt(20) lgkmcnt(0)
  s_barrier
  s_add_u32 m0, s61, 0
  s_add_u32 s54, s62, 663552
  buffer_load_dwordx4 v208, s[36:39], s54 offen lds
  s_add_u32 m0, s61, 4096
  s_add_u32 s54, s62, 718848
  buffer_load_dwordx4 v208, s[36:39], s54 offen lds
  s_add_u32 m0, s61, 8192
  s_add_u32 s54, s62, 774144
  buffer_load_dwordx4 v208, s[36:39], s54 offen lds
  s_add_u32 m0, s61, 12288
  s_add_u32 s54, s62, 829440
  buffer_load_dwordx4 v208, s[36:39], s54 offen lds
  v_add_u32 v215, 53248, v210
  ds_read_b64_tr_b16 a[144:145], v215 offset:0
  ds_read_b64_tr_b16 a[146:147], v215 offset:1024
  ds_read_b64_tr_b16 a[148:149], v215 offset:4096
  ds_read_b64_tr_b16 a[150:151], v215 offset:5120
  ds_read_b64_tr_b16 a[152:153], v215 offset:8192
  ds_read_b64_tr_b16 a[154:155], v215 offset:9216
  ds_read_b64_tr_b16 a[156:157], v215 offset:12288
  ds_read_b64_tr_b16 a[158:159], v215 offset:13312
  s_waitcnt vmcnt(20) lgkmcnt(0)
  s_barrier
  s_add_u32 m0, s61, 16384
  s_add_u32 s54, s62, 884736
  buffer_load_dwordx4 v207, s[36:39], s54 offen lds
  s_add_u32 m0, s61, 20480
  s_add_u32 s54, s62, 940032
  buffer_load_dwordx4 v207, s[36:39], s54 offen lds
  s_add_u32 m0, s61, 24576
  s_add_u32 s54, s62, 995328
  buffer_load_dwordx4 v207, s[36:39], s54 offen lds
  s_add_u32 m0, s61, 28672
  s_add_u32 s54, s62, 1050624
  buffer_load_dwordx4 v207, s[36:39], s54 offen lds
  v_add_u32 v215, 69632, v210
  ds_read_b64_tr_b16 a[16:17], v215 offset:0
  ds_read_b64_tr_b16 a[18:19], v215 offset:1024
  ds_read_b64_tr_b16 a[20:21], v215 offset:4096
  ds_read_b64_tr_b16 a[22:23], v215 offset:5120
  ds_read_b64_tr_b16 a[24:25], v215 offset:8192
  ds_read_b64_tr_b16 a[26:27], v215 offset:9216
  ds_read_b64_tr_b16 a[28:29], v215 offset:12288
  ds_read_b64_tr_b16 a[30:31], v215 offset:13312
  s_waitcnt vmcnt(20) lgkmcnt(0)
  s_barrier
  s_add_u32 m0, s61, 32768
  s_add_u32 s54, s62, 884736
  buffer_load_dwordx4 v208, s[36:39], s54 offen lds
  s_add_u32 m0, s61, 36864
  s_add_u32 s54, s62, 940032
  buffer_load_dwordx4 v208, s[36:39], s54 offen lds
  s_add_u32 m0, s61, 40960
  s_add_u32 s54, s62, 995328
  buffer_load_dwordx4 v208, s[36:39], s54 offen lds
  s_add_u32 m0, s61, 45056
  s_add_u32 s54, s62, 1050624
  buffer_load_dwordx4 v208, s[36:39], s54 offen lds
  v_add_u32 v215, 86016, v210
  ds_read_b64_tr_b16 a[160:161], v215 offset:0
  ds_read_b64_tr_b16 a[162:163], v215 offset:1024
  ds_read_b64_tr_b16 a[164:165], v215 offset:4096
  ds_read_b64_tr_b16 a[166:167], v215 offset:5120
  ds_read_b64_tr_b16 a[168:169], v215 offset:8192
  ds_read_b64_tr_b16 a[170:171], v215 offset:9216
  ds_read_b64_tr_b16 a[172:173], v215 offset:12288
  ds_read_b64_tr_b16 a[174:175], v215 offset:13312
  s_waitcnt vmcnt(20) lgkmcnt(0)
  s_barrier
  s_add_u32 m0, s61, 49152
  s_add_u32 s54, s62, 1105920
  buffer_load_dwordx4 v207, s[36:39], s54 offen lds
  s_add_u32 m0, s61, 53248
  s_add_u32 s54, s62, 1161216
  buffer_load_dwordx4 v207, s[36:39], s54 offen lds
  s_add_u32 m0, s61, 57344
  s_add_u32 s54, s62, 1216512
  buffer_load_dwordx4 v207, s[36:39], s54 offen lds
  s_add_u32 m0, s61, 61440
  s_add_u32 s54, s62, 1271808
  buffer_load_dwordx4 v207, s[36:39], s54 offen lds
  v_add_u32 v215, 102400, v210
  ds_read_b64_tr_b16 a[32:33], v215 offset:0
  ds_read_b64_tr_b16 a[34:35], v215 offset:1024
  ds_read_b64_tr_b16 a[36:37], v215 offset:4096
  ds_read_b64_tr_b16 a[38:39], v215 offset:5120
  ds_read_b64_tr_b16 a[40:41], v215 offset:8192
  ds_read_b64_tr_b16 a[42:43], v215 offset:9216
  ds_read_b64_tr_b16 a[44:45], v215 offset:12288
  ds_read_b64_tr_b16 a[46:47], v215 offset:13312
  s_waitcnt vmcnt(20) lgkmcnt(0)
  s_barrier
  s_add_u32 m0, s61, 65536
  s_add_u32 s54, s62, 1105920
  buffer_load_dwordx4 v208, s[36:39], s54 offen lds
  s_add_u32 m0, s61, 69632
  s_add_u32 s54, s62, 1161216
  buffer_load_dwordx4 v208, s[36:39], s54 offen lds
  s_add_u32 m0, s61, 73728
  s_add_u32 s54, s62, 1216512
  buffer_load_dwordx4 v208, s[36:39], s54 offen lds
  s_add_u32 m0, s61, 77824
  s_add_u32 s54, s62, 1271808
  buffer_load_dwordx4 v208, s[36:39], s54 offen lds
  v_add_u32 v215, 118784, v210
  ds_read_b64_tr_b16 a[176:177], v215 offset:0
  ds_read_b64_tr_b16 a[178:179], v215 offset:1024
  ds_read_b64_tr_b16 a[180:181], v215 offset:4096
  ds_read_b64_tr_b16 a[182:183], v215 offset:5120
  ds_read_b64_tr_b16 a[184:185], v215 offset:8192
  ds_read_b64_tr_b16 a[186:187], v215 offset:9216
  ds_read_b64_tr_b16 a[188:189], v215 offset:12288
  ds_read_b64_tr_b16 a[190:191], v215 offset:13312
  s_waitcnt vmcnt(20) lgkmcnt(0)
  s_barrier
  s_add_u32 m0, s61, 81920
  s_add_u32 s54, s62, 1327104
  buffer_load_dwordx4 v207, s[36:39], s54 offen lds
  s_add_u32 m0, s61, 86016
  s_add_u32 s54, s62, 1382400
  buffer_load_dwordx4 v207, s[36:39], s54 offen lds
  s_add_u32 m0, s61, 90112
  s_add_u32 s54, s62, 1437696
  buffer_load_dwordx4 v207, s[36:39], s54 offen lds
  s_add_u32 m0, s61, 94208
  s_add_u32 s54, s62, 1492992
  buffer_load_dwordx4 v207, s[36:39], s54 offen lds
  v_add_u32 v215, 135168, v210
  ds_read_b64_tr_b16 a[48:49], v215 offset:0
  ds_read_b64_tr_b16 a[50:51], v215 offset:1024
  ds_read_b64_tr_b16 a[52:53], v215 offset:4096
  ds_read_b64_tr_b16 a[54:55], v215 offset:5120
  ds_read_b64_tr_b16 a[56:57], v215 offset:8192
  ds_read_b64_tr_b16 a[58:59], v215 offset:9216
  ds_read_b64_tr_b16 a[60:61], v215 offset:12288
  ds_read_b64_tr_b16 a[62:63], v215 offset:13312
  s_waitcnt vmcnt(20) lgkmcnt(0)
  s_barrier
  s_add_u32 m0, s61, 98304
  s_add_u32 s54, s62, 1327104
  buffer_load_dwordx4 v208, s[36:39], s54 offen lds
  s_add_u32 m0, s61, 102400
  s_add_u32 s54, s62, 1382400
  buffer_load_dwordx4 v208, s[36:39], s54 offen lds
  s_add_u32 m0, s61, 106496
  s_add_u32 s54, s62, 1437696
  buffer_load_dwordx4 v208, s[36:39], s54 offen lds
  s_add_u32 m0, s61, 110592
  s_add_u32 s54, s62, 1492992
  buffer_load_dwordx4 v208, s[36:39], s54 offen lds
  v_add_u32 v215, 36864, v210
  ds_read_b64_tr_b16 a[192:193], v215 offset:0
  ds_read_b64_tr_b16 a[194:195], v215 offset:1024
  ds_read_b64_tr_b16 a[196:197], v215 offset:4096
  ds_read_b64_tr_b16 a[198:199], v215 offset:5120
  ds_read_b64_tr_b16 a[200:201], v215 offset:8192
  ds_read_b64_tr_b16 a[202:203], v215 offset:9216
  ds_read_b64_tr_b16 a[204:205], v215 offset:12288
  ds_read_b64_tr_b16 a[206:207], v215 offset:13312
  s_waitcnt vmcnt(20) lgkmcnt(0)
  s_barrier
  s_add_u32 m0, s61, 0
  s_add_u32 s54, s62, 1548288
  buffer_load_dwordx4 v207, s[36:39], s54 offen lds
  s_add_u32 m0, s61, 4096
  s_add_u32 s54, s62, 1603584
  buffer_load_dwordx4 v207, s[36:39], s54 offen lds
  s_add_u32 m0, s61, 8192
  s_add_u32 s54, s62, 1658880
  buffer_load_dwordx4 v207, s[36:39], s54 offen lds
  s_add_u32 m0, s61, 12288
  s_add_u32 s54, s62, 1714176
  buffer_load_dwordx4 v207, s[36:39], s54 offen lds
  v_add_u32 v215, 53248, v210
  ds_read_b64_tr_b16 a[64:65], v215 offset:0
  ds_read_b64_tr_b16 a[66:67], v215 offset:1024
  ds_read_b64_tr_b16 a[68:69], v215 offset:4096
  ds_read_b64_tr_b16 a[70:71], v215 offset:5120
  ds_read_b64_tr_b16 a[72:73], v215 offset:8192
  ds_read_b64_tr_b16 a[74:75], v215 offset:9216
  ds_read_b64_tr_b16 a[76:77], v215 offset:12288
  ds_read_b64_tr_b16 a[78:79], v215 offset:13312
  s_waitcnt vmcnt(20) lgkmcnt(0)
  s_barrier
  s_add_u32 m0, s61, 16384
  s_add_u32 s54, s62, 1548288
  buffer_load_dwordx4 v208, s[36:39], s54 offen lds
  s_add_u32 m0, s61, 20480
  s_add_u32 s54, s62, 1603584
  buffer_load_dwordx4 v208, s[36:39], s54 offen lds
  s_add_u32 m0, s61, 24576
  s_add_u32 s54, s62, 1658880
  buffer_load_dwordx4 v208, s[36:39], s54 offen lds
  s_add_u32 m0, s61, 28672
  s_add_u32 s54, s62, 1714176
  buffer_load_dwordx4 v208, s[36:39], s54 offen lds
  v_add_u32 v215, 69632, v210
  ds_read_b64_tr_b16 a[208:209], v215 offset:0
  ds_read_b64_tr_b16 a[210:211], v215 offset:1024
  ds_read_b64_tr_b16 a[212:213], v215 offset:4096
  ds_read_b64_tr_b16 a[214:215], v215 offset:5120
  ds_read_b64_tr_b16 a[216:217], v215 offset:8192
  ds_read_b64_tr_b16 a[218:219], v215 offset:9216
  ds_read_b64_tr_b16 a[220:221], v215 offset:12288
  ds_read_b64_tr_b16 a[222:223], v215 offset:13312
  s_waitcnt vmcnt(20) lgkmcnt(0)
  s_barrier
  s_add_u32 m0, s61, 32768
  s_add_u32 s54, s62, 1769472
  buffer_load_dwordx4 v207, s[36:39], s54 offen lds
  s_add_u32 m0, s61, 36864
  s_add_u32 s54, s62, 1824768
  buffer_load_dwordx4 v207, s[36:39], s54 offen lds
  s_add_u32 m0, s61, 40960
  s_add_u32 s54, s62, 1880064
  buffer_load_dwordx4 v207, s[36:39], s54 offen lds
  s_add_u32 m0, s61, 45056
  s_add_u32 s54, s62, 1935360
  buffer_load_dwordx4 v207, s[36:39], s54 offen lds
  v_add_u32 v215, 86016, v210
  ds_read_b64_tr_b16 a[80:81], v215 offset:0
  ds_read_b64_tr_b16 a[82:83], v215 offset:1024
  ds_read_b64_tr_b16 a[84:85], v215 offset:4096
  ds_read_b64_tr_b16 a[86:87], v215 offset:5120
  ds_read_b64_tr_b16 a[88:89], v215 offset:8192
  ds_read_b64_tr_b16 a[90:91], v215 offset:9216
  ds_read_b64_tr_b16 a[92:93], v215 offset:12288
  ds_read_b64_tr_b16 a[94:95], v215 offset:13312
  s_waitcnt vmcnt(20) lgkmcnt(0)
  s_barrier
  s_add_u32 m0, s61, 49152
  s_add_u32 s54, s62, 1769472
  buffer_load_dwordx4 v208, s[36:39], s54 offen lds
  s_add_u32 m0, s61, 53248
  s_add_u32 s54, s62, 1824768
  buffer_load_dwordx4 v208, s[36:39], s54 offen lds
  s_add_u32 m0, s61, 57344
  s_add_u32 s54, s62, 1880064
  buffer_load_dwordx4 v208, s[36:39], s54 offen lds
  s_add_u32 m0, s61, 61440
  s_add_u32 s54, s62, 1935360
  buffer_load_dwordx4 v208, s[36:39], s54 offen lds
  v_add_u32 v215, 102400, v210
  ds_read_b64_tr_b16 a[224:225], v215 offset:0
  ds_read_b64_tr_b16 a[226:227], v215 offset:1024
  ds_read_b64_tr_b16 a[228:229], v215 offset:4096
  ds_read_b64_tr_b16 a[230:231], v215 offset:5120
  ds_read_b64_tr_b16 a[232:233], v215 offset:8192
  ds_read_b64_tr_b16 a[234:235], v215 offset:9216
  ds_read_b64_tr_b16 a[236:237], v215 offset:12288
  ds_read_b64_tr_b16 a[238:239], v215 offset:13312
  s_waitcnt vmcnt(20) lgkmcnt(0)
  s_barrier
  v_add_u32 v215, 118784, v210
  ds_read_b64_tr_b16 a[96:97], v215 offset:0
  ds_read_b64_tr_b16 a[98:99], v215 offset:1024
  ds_read_b64_tr_b16 a[100:101], v215 offset:4096
  ds_read_b64_tr_b16 a[102:103], v215 offset:5120
  ds_read_b64_tr_b16 a[104:105], v215 offset:8192
  ds_read_b64_tr_b16 a[106:107], v215 offset:9216
  ds_read_b64_tr_b16 a[108:109], v215 offset:12288
  ds_read_b64_tr_b16 a[110:111], v215 offset:13312
  s_waitcnt vmcnt(16) lgkmcnt(0)
  s_barrier
  v_add_u32 v215, 135168, v210
  ds_read_b64_tr_b16 a[240:241], v215 offset:0
  ds_read_b64_tr_b16 a[242:243], v215 offset:1024
  ds_read_b64_tr_b16 a[244:245], v215 offset:4096
  ds_read_b64_tr_b16 a[246:247], v215 offset:5120
  ds_read_b64_tr_b16 a[248:249], v215 offset:8192
  ds_read_b64_tr_b16 a[250:251], v215 offset:9216
  ds_read_b64_tr_b16 a[252:253], v215 offset:12288
  ds_read_b64_tr_b16 a[254:255], v215 offset:13312
  s_waitcnt vmcnt(12) lgkmcnt(0)
  s_barrier
  v_add_u32 v215, 36864, v210
  ds_read_b64_tr_b16 a[112:113], v215 offset:0
  ds_read_b64_tr_b16 a[114:115], v215 offset:1024
  ds_read_b64_tr_b16 a[116:117], v215 offset:4096
  ds_read_b64_tr_b16 a[118:119], v215 offset:5120
  ds_read_b64_tr_b16 a[120:121], v215 offset:8192
  ds_read_b64_tr_b16 a[122:123], v215 offset:9216
  ds_read_b64_tr_b16 a[124:125], v215 offset:12288
  ds_read_b64_tr_b16 a[126:127], v215 offset:13312
  s_waitcnt vmcnt(8) lgkmcnt(0)
  s_barrier
  v_add_u32 v215, 53248, v210
  ds_read_b64_tr_b16 v[224:225], v215 offset:0
  ds_read_b64_tr_b16 v[226:227], v215 offset:1024
  ds_read_b64_tr_b16 v[228:229], v215 offset:4096
  ds_read_b64_tr_b16 v[230:231], v215 offset:5120
  ds_read_b64_tr_b16 v[232:233], v215 offset:8192
  ds_read_b64_tr_b16 v[234:235], v215 offset:9216
  ds_read_b64_tr_b16 v[236:237], v215 offset:12288
  ds_read_b64_tr_b16 v[238:239], v215 offset:13312
  s_waitcnt vmcnt(4) lgkmcnt(0)
  s_barrier
  v_add_u32 v215, 69632, v210
  ds_read_b64_tr_b16 a[128:129], v215 offset:0
  ds_read_b64_tr_b16 a[130:131], v215 offset:1024
  ds_read_b64_tr_b16 a[132:133], v215 offset:4096
  ds_read_b64_tr_b16 a[134:135], v215 offset:5120
  ds_read_b64_tr_b16 a[136:137], v215 offset:8192
  ds_read_b64_tr_b16 a[138:139], v215 offset:9216
  ds_read_b64_tr_b16 a[140:141], v215 offset:12288
  ds_read_b64_tr_b16 a[142:143], v215 offset:13312
  s_waitcnt vmcnt(0) lgkmcnt(0)
  s_barrier
  v_add_u32 v215, 86016, v210
  ds_read_b64_tr_b16 v[240:241], v215 offset:0
  ds_read_b64_tr_b16 v[242:243], v215 offset:1024
  ds_read_b64_tr_b16 v[244:245], v215 offset:4096
  ds_read_b64_tr_b16 v[246:247], v215 offset:5120
  ds_read_b64_tr_b16 v[248:249], v215 offset:8192
  ds_read_b64_tr_b16 v[250:251], v215 offset:9216
  ds_read_b64_tr_b16 v[252:253], v215 offset:12288
  ds_read_b64_tr_b16 v[254:255], v215 offset:13312
  s_waitcnt lgkmcnt(0)
  s_barrier
  v_and_b32 v211, 31, v200
  v_mul_u32_u24 v218, 516, v211
  v_lshrrev_b32 v212, 5, v200
  v_lshl_add_u32 v218, v212, 3, v218
  s_lshl_b32 s54, s52, 6
  s_add_u32 s54, s54, 73728
  v_add_u32 v218, s54, v218
  s_lshl_b32 s60, s69, 2
  s_mul_i32 s60, s60, 36864
  ds_read_b128 v[32:35], v203 offset:0
  ds_read_b128 v[36:39], v204 offset:0
  ds_read_b128 v[40:43], v205 offset:0
  s_waitcnt lgkmcnt(2)
  v_mfma_f32_32x32x16_bf16 v[0:15], a[0:3], v[32:35], 0
  ds_read_b128 v[44:47], v206 offset:0
  s_add_u32 m0, s67, 36864
  s_nop 0
  buffer_load_dwordx4 v202, s[4:7], s60 offen offset:0 lds
  v_mfma_f32_32x32x16_bf16 v[16:31], a[144:147], v[32:35], 0
  s_waitcnt lgkmcnt(2)
  v_mfma_f32_32x32x16_bf16 v[0:15], a[4:7], v[36:39], v[0:15]
  ds_read_b128 v[32:35], v203 offset:1024
  s_add_u32 m0, s67, 37760
  s_nop 0
  buffer_load_dwordx4 v202, s[4:7], s60 offen offset:128 lds
  v_mfma_f32_32x32x16_bf16 v[16:31], a[148:151], v[36:39], v[16:31]
  s_waitcnt lgkmcnt(2)
  v_mfma_f32_32x32x16_bf16 v[0:15], a[8:11], v[40:43], v[0:15]
  ds_read_b128 v[36:39], v204 offset:1024
  s_add_u32 m0, s67, 38656
  s_nop 0
  buffer_load_dwordx4 v202, s[4:7], s60 offen offset:256 lds
  v_mfma_f32_32x32x16_bf16 v[16:31], a[152:155], v[40:43], v[16:31]
  s_waitcnt lgkmcnt(2)
  v_mfma_f32_32x32x16_bf16 v[0:15], a[12:15], v[44:47], v[0:15]
  ds_read_b128 v[40:43], v205 offset:1024
  s_add_u32 m0, s67, 39552
  s_nop 0
  buffer_load_dwordx4 v202, s[4:7], s60 offen offset:384 lds
  v_mfma_f32_32x32x16_bf16 v[16:31], a[156:159], v[44:47], v[16:31]
  s_waitcnt lgkmcnt(2)
  v_mfma_f32_32x32x16_bf16 v[0:15], a[16:19], v[32:35], v[0:15]
  ds_read_b128 v[44:47], v206 offset:1024
  s_add_u32 m0, s67, 40448
  s_nop 0
  buffer_load_dwordx4 v202, s[4:7], s60 offen offset:512 lds
  v_mfma_f32_32x32x16_bf16 v[16:31], a[160:163], v[32:35], v[16:31]
  s_waitcnt lgkmcnt(2)
  v_mfma_f32_32x32x16_bf16 v[0:15], a[20:23], v[36:39], v[0:15]
  ds_read_b128 v[32:35], v203 offset:2048
  s_add_u32 m0, s67, 41344
  s_nop 0
  buffer_load_dwordx4 v202, s[4:7], s60 offen offset:640 lds
  v_mfma_f32_32x32x16_bf16 v[16:31], a[164:167], v[36:39], v[16:31]
  s_waitcnt lgkmcnt(2)
  v_mfma_f32_32x32x16_bf16 v[0:15], a[24:27], v[40:43], v[0:15]
  ds_read_b128 v[36:39], v204 offset:2048
  s_add_u32 m0, s67, 42240
  s_nop 0
  buffer_load_dwordx4 v202, s[4:7], s60 offen offset:768 lds
  v_mfma_f32_32x32x16_bf16 v[16:31], a[168:171], v[40:43], v[16:31]
  s_waitcnt lgkmcnt(2)
  v_mfma_f32_32x32x16_bf16 v[0:15], a[28:31], v[44:47], v[0:15]
  ds_read_b128 v[40:43], v205 offset:2048
  s_add_u32 m0, s67, 43136
  s_nop 0
  buffer_load_dwordx4 v202, s[4:7], s60 offen offset:896 lds
  v_mfma_f32_32x32x16_bf16 v[16:31], a[172:175], v[44:47], v[16:31]
  s_waitcnt lgkmcnt(2)
  v_mfma_f32_32x32x16_bf16 v[0:15], a[32:35], v[32:35], v[0:15]
  ds_read_b128 v[44:47], v206 offset:2048
  s_add_u32 m0, s67, 44032
  s_nop 0
  buffer_load_dwordx4 v202, s[4:7], s60 offen offset:1024 lds
  v_mfma_f32_32x32x16_bf16 v[16:31], a[176:179], v[32:35], v[16:31]
  s_waitcnt lgkmcnt(2)
  v_mfma_f32_32x32x16_bf16 v[0:15], a[36:39], v[36:39], v[0:15]
  ds_read_b128 v[32:35], v203 offset:3072
  v_mfma_f32_32x32x16_bf16 v[16:31], a[180:183], v[36:39], v[16:31]
  s_waitcnt lgkmcnt(2)
  v_mfma_f32_32x32x16_bf16 v[0:15], a[40:43], v[40:43], v[0:15]
  ds_read_b128 v[36:39], v204 offset:3072
  v_mfma_f32_32x32x16_bf16 v[16:31], a[184:187], v[40:43], v[16:31]
  s_waitcnt lgkmcnt(2)
  v_mfma_f32_32x32x16_bf16 v[0:15], a[44:47], v[44:47], v[0:15]
  ds_read_b128 v[40:43], v205 offset:3072
  v_mfma_f32_32x32x16_bf16 v[16:31], a[188:191], v[44:47], v[16:31]
  s_waitcnt lgkmcnt(2)
  v_mfma_f32_32x32x16_bf16 v[0:15], a[48:51], v[32:35], v[0:15]
  ds_read_b128 v[44:47], v206 offset:3072
  v_mfma_f32_32x32x16_bf16 v[16:31], a[192:195], v[32:35], v[16:31]
  s_waitcnt lgkmcnt(2)
  v_mfma_f32_32x32x16_bf16 v[0:15], a[52:55], v[36:39], v[0:15]
  ds_read_b128 v[32:35], v203 offset:4096
  v_mfma_f32_32x32x16_bf16 v[16:31], a[196:199], v[36:39], v[16:31]
  s_waitcnt lgkmcnt(2)
  v_mfma_f32_32x32x16_bf16 v[0:15], a[56:59], v[40:43], v[0:15]
  ds_read_b128 v[36:39], v204 offset:4096
  v_mfma_f32_32x32x16_bf16 v[16:31], a[200:203], v[40:43], v[16:31]
  s_waitcnt lgkmcnt(2)
  v_mfma_f32_32x32x16_bf16 v[0:15], a[60:63], v[44:47], v[0:15]
  ds_read_b128 v[40:43], v205 offset:4096
  v_mfma_f32_32x32x16_bf16 v[16:31], a[204:207], v[44:47], v[16:31]
  s_waitcnt lgkmcnt(2)
  v_mfma_f32_32x32x16_bf16 v[0:15], a[64:67], v[32:35], v[0:15]
  ds_read_b128 v[44:47], v206 offset:4096
  v_mfma_f32_32x32x16_bf16 v[16:31], a[208:211], v[32:35], v[16:31]
  s_waitcnt lgkmcnt(2)
  v_mfma_f32_32x32x16_bf16 v[0:15], a[68:71], v[36:39], v[0:15]
  ds_read_b128 v[32:35], v203 offset:5120
  v_mfma_f32_32x32x16_bf16 v[16:31], a[212:215], v[36:39], v[16:31]
  s_waitcnt lgkmcnt(2)
  v_mfma_f32_32x32x16_bf16 v[0:15], a[72:75], v[40:43], v[0:15]
  ds_read_b128 v[36:39], v204 offset:5120
  v_mfma_f32_32x32x16_bf16 v[16:31], a[216:219], v[40:43], v[16:31]
  s_waitcnt lgkmcnt(2)
  v_mfma_f32_32x32x16_bf16 v[0:15], a[76:79], v[44:47], v[0:15]
  ds_read_b128 v[40:43], v205 offset:5120
  v_mfma_f32_32x32x16_bf16 v[16:31], a[220:223], v[44:47], v[16:31]
  s_waitcnt lgkmcnt(2)
  v_mfma_f32_32x32x16_bf16 v[0:15], a[80:83], v[32:35], v[0:15]
  ds_read_b128 v[44:47], v206 offset:5120
  v_mfma_f32_32x32x16_bf16 v[16:31], a[224:227], v[32:35], v[16:31]
  s_waitcnt lgkmcnt(2)
  v_mfma_f32_32x32x16_bf16 v[0:15], a[84:87], v[36:39], v[0:15]
  ds_read_b128 v[32:35], v203 offset:6144
  v_mfma_f32_32x32x16_bf16 v[16:31], a[228:231], v[36:39], v[16:31]
  s_waitcnt lgkmcnt(2)
  v_mfma_f32_32x32x16_bf16 v[0:15], a[88:91], v[40:43], v[0:15]
  ds_read_b128 v[36:39], v204 offset:6144
  v_mfma_f32_32x32x16_bf16 v[16:31], a[232:235], v[40:43], v[16:31]
  s_waitcnt lgkmcnt(2)
  v_mfma_f32_32x32x16_bf16 v[0:15], a[92:95], v[44:47], v[0:15]
  ds_read_b128 v[40:43], v205 offset:6144
  v_mfma_f32_32x32x16_bf16 v[16:31], a[236:239], v[44:47], v[16:31]
  s_waitcnt lgkmcnt(2)
  v_mfma_f32_32x32x16_bf16 v[0:15], a[96:99], v[32:35], v[0:15]
  ds_read_b128 v[44:47], v206 offset:6144
  v_mfma_f32_32x32x16_bf16 v[16:31], a[240:243], v[32:35], v[16:31]
  s_waitcnt lgkmcnt(2)
  v_mfma_f32_32x32x16_bf16 v[0:15], a[100:103], v[36:39], v[0:15]
  ds_read_b128 v[32:35], v203 offset:7168
  v_mfma_f32_32x32x16_bf16 v[16:31], a[244:247], v[36:39], v[16:31]
  s_waitcnt lgkmcnt(2)
  v_mfma_f32_32x32x16_bf16 v[0:15], a[104:107], v[40:43], v[0:15]
  ds_read_b128 v[36:39], v204 offset:7168
  v_mfma_f32_32x32x16_bf16 v[16:31], a[248:251], v[40:43], v[16:31]
  s_waitcnt lgkmcnt(2)
  v_mfma_f32_32x32x16_bf16 v[0:15], a[108:111], v[44:47], v[0:15]
  ds_read_b128 v[40:43], v205 offset:7168
  v_mfma_f32_32x32x16_bf16 v[16:31], a[252:255], v[44:47], v[16:31]
  s_waitcnt lgkmcnt(2)
  v_mfma_f32_32x32x16_bf16 v[0:15], a[112:115], v[32:35], v[0:15]
  ds_read_b128 v[44:47], v206 offset:7168
  v_mfma_f32_32x32x16_bf16 v[16:31], v[224:227], v[32:35], v[16:31]
  s_waitcnt lgkmcnt(2)
  v_mfma_f32_32x32x16_bf16 v[0:15], a[116:119], v[36:39], v[0:15]
  ds_read_b128 v[32:35], v203 offset:8192
  v_mfma_f32_32x32x16_bf16 v[16:31], v[228:231], v[36:39], v[16:31]
  s_waitcnt lgkmcnt(2)
  v_mfma_f32_32x32x16_bf16 v[0:15], a[120:123], v[40:43], v[0:15]
  ds_read_b128 v[36:39], v204 offset:8192
  v_mfma_f32_32x32x16_bf16 v[16:31], v[232:235], v[40:43], v[16:31]
  s_waitcnt lgkmcnt(2)
  v_mfma_f32_32x32x16_bf16 v[0:15], a[124:127], v[44:47], v[0:15]
  ds_read_b128 v[40:43], v205 offset:8192
  v_mfma_f32_32x32x16_bf16 v[16:31], v[236:239], v[44:47], v[16:31]
  s_waitcnt lgkmcnt(2)
  v_mfma_f32_32x32x16_bf16 v[0:15], a[128:131], v[32:35], v[0:15]
  ds_read_b128 v[44:47], v206 offset:8192
  v_mfma_f32_32x32x16_bf16 v[16:31], v[240:243], v[32:35], v[16:31]
  s_waitcnt lgkmcnt(2)
  v_mfma_f32_32x32x16_bf16 v[0:15], a[132:135], v[36:39], v[0:15]
  v_mfma_f32_32x32x16_bf16 v[16:31], v[244:247], v[36:39], v[16:31]
  s_waitcnt lgkmcnt(1)
  v_mfma_f32_32x32x16_bf16 v[0:15], a[136:139], v[40:43], v[0:15]
  v_mfma_f32_32x32x16_bf16 v[16:31], v[248:251], v[40:43], v[16:31]
  s_waitcnt lgkmcnt(0)
  v_mfma_f32_32x32x16_bf16 v[0:15], a[140:143], v[44:47], v[0:15]
  v_mfma_f32_32x32x16_bf16 v[16:31], v[252:255], v[44:47], v[16:31]
  s_add_u32 s60, s60, 36864
  s_nop 2
  v_cvt_pk_bf16_f32 v48, v0, v1
  v_cvt_pk_bf16_f32 v49, v2, v3
  ds_write2_b32 v218, v48, v49 offset0:0 offset1:1
  v_cvt_pk_bf16_f32 v48, v4, v5
  v_cvt_pk_bf16_f32 v49, v6, v7
  ds_write2_b32 v218, v48, v49 offset0:4 offset1:5
  v_cvt_pk_bf16_f32 v48, v8, v9
  v_cvt_pk_bf16_f32 v49, v10, v11
  ds_write2_b32 v218, v48, v49 offset0:8 offset1:9
  v_cvt_pk_bf16_f32 v48, v12, v13
  v_cvt_pk_bf16_f32 v49, v14, v15
  ds_write2_b32 v218, v48, v49 offset0:12 offset1:13
  v_cvt_pk_bf16_f32 v48, v16, v17
  v_cvt_pk_bf16_f32 v49, v18, v19
  ds_write2_b32 v218, v48, v49 offset0:64 offset1:65
  v_cvt_pk_bf16_f32 v48, v20, v21
  v_cvt_pk_bf16_f32 v49, v22, v23
  ds_write2_b32 v218, v48, v49 offset0:68 offset1:69
  v_cvt_pk_bf16_f32 v48, v24, v25
  v_cvt_pk_bf16_f32 v49, v26, v27
  ds_write2_b32 v218, v48, v49 offset0:72 offset1:73
  v_cvt_pk_bf16_f32 v48, v28, v29
  v_cvt_pk_bf16_f32 v49, v30, v31
  ds_write2_b32 v218, v48, v49 offset0:76 offset1:77
  v_add_u32 v218, 16512, v218
  s_waitcnt vmcnt(0) lgkmcnt(0)
  s_barrier
  ds_read_b128 v[32:35], v203 offset:36864
  ds_read_b128 v[36:39], v204 offset:36864
  ds_read_b128 v[40:43], v205 offset:36864
  s_waitcnt lgkmcnt(2)
  v_mfma_f32_32x32x16_bf16 v[0:15], a[0:3], v[32:35], 0
  ds_read_b128 v[44:47], v206 offset:36864
  s_add_u32 m0, s67, 0
  s_nop 0
  buffer_load_dwordx4 v202, s[4:7], s60 offen offset:0 lds
  v_mfma_f32_32x32x16_bf16 v[16:31], a[144:147], v[32:35], 0
  s_waitcnt lgkmcnt(2)
  v_mfma_f32_32x32x16_bf16 v[0:15], a[4:7], v[36:39], v[0:15]
  ds_read_b128 v[32:35], v203 offset:37888
  s_add_u32 m0, s67, 896
  s_nop 0
  buffer_load_dwordx4 v202, s[4:7], s60 offen offset:128 lds
  v_mfma_f32_32x32x16_bf16 v[16:31], a[148:151], v[36:39], v[16:31]
  s_waitcnt lgkmcnt(2)
  v_mfma_f32_32x32x16_bf16 v[0:15], a[8:11], v[40:43], v[0:15]
  ds_read_b128 v[36:39], v204 offset:37888
  s_add_u32 m0, s67, 1792
  s_nop 0
  buffer_load_dwordx4 v202, s[4:7], s60 offen offset:256 lds
  v_mfma_f32_32x32x16_bf16 v[16:31], a[152:155], v[40:43], v[16:31]
  s_waitcnt lgkmcnt(2)
  v_mfma_f32_32x32x16_bf16 v[0:15], a[12:15], v[44:47], v[0:15]
  ds_read_b128 v[40:43], v205 offset:37888
  s_add_u32 m0, s67, 2688
  s_nop 0
  buffer_load_dwordx4 v202, s[4:7], s60 offen offset:384 lds
  v_mfma_f32_32x32x16_bf16 v[16:31], a[156:159], v[44:47], v[16:31]
  s_waitcnt lgkmcnt(2)
  v_mfma_f32_32x32x16_bf16 v[0:15], a[16:19], v[32:35], v[0:15]
  ds_read_b128 v[44:47], v206 offset:37888
  s_add_u32 m0, s67, 3584
  s_nop 0
  buffer_load_dwordx4 v202, s[4:7], s60 offen offset:512 lds
  v_mfma_f32_32x32x16_bf16 v[16:31], a[160:163], v[32:35], v[16:31]
  s_waitcnt lgkmcnt(2)
  v_mfma_f32_32x32x16_bf16 v[0:15], a[20:23], v[36:39], v[0:15]
  ds_read_b128 v[32:35], v203 offset:38912
  s_add_u32 m0, s67, 4480
  s_nop 0
  buffer_load_dwordx4 v202, s[4:7], s60 offen offset:640 lds
  v_mfma_f32_32x32x16_bf16 v[16:31], a[164:167], v[36:39], v[16:31]
  s_waitcnt lgkmcnt(2)
  v_mfma_f32_32x32x16_bf16 v[0:15], a[24:27], v[40:43], v[0:15]
  ds_read_b128 v[36:39], v204 offset:38912
  s_add_u32 m0, s67, 5376
  s_nop 0
  buffer_load_dwordx4 v202, s[4:7], s60 offen offset:768 lds
  v_mfma_f32_32x32x16_bf16 v[16:31], a[168:171], v[40:43], v[16:31]
  s_waitcnt lgkmcnt(2)
  v_mfma_f32_32x32x16_bf16 v[0:15], a[28:31], v[44:47], v[0:15]
  ds_read_b128 v[40:43], v205 offset:38912
  s_add_u32 m0, s67, 6272
  s_nop 0
  buffer_load_dwordx4 v202, s[4:7], s60 offen offset:896 lds
  v_mfma_f32_32x32x16_bf16 v[16:31], a[172:175], v[44:47], v[16:31]
  s_waitcnt lgkmcnt(2)
  v_mfma_f32_32x32x16_bf16 v[0:15], a[32:35], v[32:35], v[0:15]
  ds_read_b128 v[44:47], v206 offset:38912
  s_add_u32 m0, s67, 7168
  s_nop 0
  buffer_load_dwordx4 v202, s[4:7], s60 offen offset:1024 lds
  v_mfma_f32_32x32x16_bf16 v[16:31], a[176:179], v[32:35], v[16:31]
  s_waitcnt lgkmcnt(2)
  v_mfma_f32_32x32x16_bf16 v[0:15], a[36:39], v[36:39], v[0:15]
  ds_read_b128 v[32:35], v203 offset:39936
  v_mfma_f32_32x32x16_bf16 v[16:31], a[180:183], v[36:39], v[16:31]
  s_waitcnt lgkmcnt(2)
  v_mfma_f32_32x32x16_bf16 v[0:15], a[40:43], v[40:43], v[0:15]
  ds_read_b128 v[36:39], v204 offset:39936
  v_mfma_f32_32x32x16_bf16 v[16:31], a[184:187], v[40:43], v[16:31]
  s_waitcnt lgkmcnt(2)
  v_mfma_f32_32x32x16_bf16 v[0:15], a[44:47], v[44:47], v[0:15]
  ds_read_b128 v[40:43], v205 offset:39936
  v_mfma_f32_32x32x16_bf16 v[16:31], a[188:191], v[44:47], v[16:31]
  s_waitcnt lgkmcnt(2)
  v_mfma_f32_32x32x16_bf16 v[0:15], a[48:51], v[32:35], v[0:15]
  ds_read_b128 v[44:47], v206 offset:39936
  v_mfma_f32_32x32x16_bf16 v[16:31], a[192:195], v[32:35], v[16:31]
  s_waitcnt lgkmcnt(2)
  v_mfma_f32_32x32x16_bf16 v[0:15], a[52:55], v[36:39], v[0:15]
  ds_read_b128 v[32:35], v203 offset:40960
  v_mfma_f32_32x32x16_bf16 v[16:31], a[196:199], v[36:39], v[16:31]
  s_waitcnt lgkmcnt(2)
  v_mfma_f32_32x32x16_bf16 v[0:15], a[56:59], v[40:43], v[0:15]
  ds_read_b128 v[36:39], v204 offset:40960
  v_mfma_f32_32x32x16_bf16 v[16:31], a[200:203], v[40:43], v[16:31]
  s_waitcnt lgkmcnt(2)
  v_mfma_f32_32x32x16_bf16 v[0:15], a[60:63], v[44:47], v[0:15]
  ds_read_b128 v[40:43], v205 offset:40960
  v_mfma_f32_32x32x16_bf16 v[16:31], a[204:207], v[44:47], v[16:31]
  s_waitcnt lgkmcnt(2)
  v_mfma_f32_32x32x16_bf16 v[0:15], a[64:67], v[32:35], v[0:15]
  ds_read_b128 v[44:47], v206 offset:40960
  v_mfma_f32_32x32x16_bf16 v[16:31], a[208:211], v[32:35], v[16:31]
  s_waitcnt lgkmcnt(2)
  v_mfma_f32_32x32x16_bf16 v[0:15], a[68:71], v[36:39], v[0:15]
  ds_read_b128 v[32:35], v203 offset:41984
  v_mfma_f32_32x32x16_bf16 v[16:31], a[212:215], v[36:39], v[16:31]
  s_waitcnt lgkmcnt(2)
  v_mfma_f32_32x32x16_bf16 v[0:15], a[72:75], v[40:43], v[0:15]
  ds_read_b128 v[36:39], v204 offset:41984
  v_mfma_f32_32x32x16_bf16 v[16:31], a[216:219], v[40:43], v[16:31]
  s_waitcnt lgkmcnt(2)
  v_mfma_f32_32x32x16_bf16 v[0:15], a[76:79], v[44:47], v[0:15]
  ds_read_b128 v[40:43], v205 offset:41984
  v_mfma_f32_32x32x16_bf16 v[16:31], a[220:223], v[44:47], v[16:31]
  s_waitcnt lgkmcnt(2)
  v_mfma_f32_32x32x16_bf16 v[0:15], a[80:83], v[32:35], v[0:15]
  ds_read_b128 v[44:47], v206 offset:41984
  v_mfma_f32_32x32x16_bf16 v[16:31], a[224:227], v[32:35], v[16:31]
  s_waitcnt lgkmcnt(2)
  v_mfma_f32_32x32x16_bf16 v[0:15], a[84:87], v[36:39], v[0:15]
  ds_read_b128 v[32:35], v203 offset:43008
  v_mfma_f32_32x32x16_bf16 v[16:31], a[228:231], v[36:39], v[16:31]
  s_waitcnt lgkmcnt(2)
  v_mfma_f32_32x32x16_bf16 v[0:15], a[88:91], v[40:43], v[0:15]
  ds_read_b128 v[36:39], v204 offset:43008
  v_mfma_f32_32x32x16_bf16 v[16:31], a[232:235], v[40:43], v[16:31]
  s_waitcnt lgkmcnt(2)
  v_mfma_f32_32x32x16_bf16 v[0:15], a[92:95], v[44:47], v[0:15]
  ds_read_b128 v[40:43], v205 offset:43008
  v_mfma_f32_32x32x16_bf16 v[16:31], a[236:239], v[44:47], v[16:31]
  s_waitcnt lgkmcnt(2)
  v_mfma_f32_32x32x16_bf16 v[0:15], a[96:99], v[32:35], v[0:15]
  ds_read_b128 v[44:47], v206 offset:43008
  v_mfma_f32_32x32x16_bf16 v[16:31], a[240:243], v[32:35], v[16:31]
  s_waitcnt lgkmcnt(2)
  v_mfma_f32_32x32x16_bf16 v[0:15], a[100:103], v[36:39], v[0:15]
  ds_read_b128 v[32:35], v203 offset:44032
  v_mfma_f32_32x32x16_bf16 v[16:31], a[244:247], v[36:39], v[16:31]
  s_waitcnt lgkmcnt(2)
  v_mfma_f32_32x32x16_bf16 v[0:15], a[104:107], v[40:43], v[0:15]
  ds_read_b128 v[36:39], v204 offset:44032
  v_mfma_f32_32x32x16_bf16 v[16:31], a[248:251], v[40:43], v[16:31]
  s_waitcnt lgkmcnt(2)
  v_mfma_f32_32x32x16_bf16 v[0:15], a[108:111], v[44:47], v[0:15]
  ds_read_b128 v[40:43], v205 offset:44032
  v_mfma_f32_32x32x16_bf16 v[16:31], a[252:255], v[44:47], v[16:31]
  s_waitcnt lgkmcnt(2)
  v_mfma_f32_32x32x16_bf16 v[0:15], a[112:115], v[32:35], v[0:15]
  ds_read_b128 v[44:47], v206 offset:44032
  v_mfma_f32_32x32x16_bf16 v[16:31], v[224:227], v[32:35], v[16:31]
  s_waitcnt lgkmcnt(2)
  v_mfma_f32_32x32x16_bf16 v[0:15], a[116:119], v[36:39], v[0:15]
  ds_read_b128 v[32:35], v203 offset:45056
  v_mfma_f32_32x32x16_bf16 v[16:31], v[228:231], v[36:39], v[16:31]
  s_waitcnt lgkmcnt(2)
  v_mfma_f32_32x32x16_bf16 v[0:15], a[120:123], v[40:43], v[0:15]
  ds_read_b128 v[36:39], v204 offset:45056
  v_mfma_f32_32x32x16_bf16 v[16:31], v[232:235], v[40:43], v[16:31]
  s_waitcnt lgkmcnt(2)
  v_mfma_f32_32x32x16_bf16 v[0:15], a[124:127], v[44:47], v[0:15]
  ds_read_b128 v[40:43], v205 offset:45056
  v_mfma_f32_32x32x16_bf16 v[16:31], v[236:239], v[44:47], v[16:31]
  s_waitcnt lgkmcnt(2)
  v_mfma_f32_32x32x16_bf16 v[0:15], a[128:131], v[32:35], v[0:15]
  ds_read_b128 v[44:47], v206 offset:45056
  v_mfma_f32_32x32x16_bf16 v[16:31], v[240:243], v[32:35], v[16:31]
  s_waitcnt lgkmcnt(2)
  v_mfma_f32_32x32x16_bf16 v[0:15], a[132:135], v[36:39], v[0:15]
  v_mfma_f32_32x32x16_bf16 v[16:31], v[244:247], v[36:39], v[16:31]
  s_waitcnt lgkmcnt(1)
  v_mfma_f32_32x32x16_bf16 v[0:15], a[136:139], v[40:43], v[0:15]
  v_mfma_f32_32x32x16_bf16 v[16:31], v[248:251], v[40:43], v[16:31]
  s_waitcnt lgkmcnt(0)
  v_mfma_f32_32x32x16_bf16 v[0:15], a[140:143], v[44:47], v[0:15]
  v_mfma_f32_32x32x16_bf16 v[16:31], v[252:255], v[44:47], v[16:31]
  s_add_u32 s60, s60, 36864
  s_nop 2
  v_cvt_pk_bf16_f32 v48, v0, v1
  v_cvt_pk_bf16_f32 v49, v2, v3
  ds_write2_b32 v218, v48, v49 offset0:0 offset1:1
  v_cvt_pk_bf16_f32 v48, v4, v5
  v_cvt_pk_bf16_f32 v49, v6, v7
  ds_write2_b32 v218, v48, v49 offset0:4 offset1:5
  v_cvt_pk_bf16_f32 v48, v8, v9
  v_cvt_pk_bf16_f32 v49, v10, v11
  ds_write2_b32 v218, v48, v49 offset0:8 offset1:9
  v_cvt_pk_bf16_f32 v48, v12, v13
  v_cvt_pk_bf16_f32 v49, v14, v15
  ds_write2_b32 v218, v48, v49 offset0:12 offset1:13
  v_cvt_pk_bf16_f32 v48, v16, v17
  v_cvt_pk_bf16_f32 v49, v18, v19
  ds_write2_b32 v218, v48, v49 offset0:64 offset1:65
  v_cvt_pk_bf16_f32 v48, v20, v21
  v_cvt_pk_bf16_f32 v49, v22, v23
  ds_write2_b32 v218, v48, v49 offset0:68 offset1:69
  v_cvt_pk_bf16_f32 v48, v24, v25
  v_cvt_pk_bf16_f32 v49, v26, v27
  ds_write2_b32 v218, v48, v49 offset0:72 offset1:73
  v_cvt_pk_bf16_f32 v48, v28, v29
  v_cvt_pk_bf16_f32 v49, v30, v31
  ds_write2_b32 v218, v48, v49 offset0:76 offset1:77
  v_add_u32 v218, 16512, v218
  s_waitcnt vmcnt(0) lgkmcnt(0)
  s_barrier
  ds_read_b128 v[32:35], v203 offset:0
  ds_read_b128 v[36:39], v204 offset:0
  ds_read_b128 v[40:43], v205 offset:0
  s_waitcnt lgkmcnt(2)
  v_mfma_f32_32x32x16_bf16 v[0:15], a[0:3], v[32:35], 0
  ds_read_b128 v[44:47], v206 offset:0
  s_add_u32 m0, s67, 36864
  s_nop 0
  buffer_load_dwordx4 v202, s[4:7], s60 offen offset:0 lds
  v_mfma_f32_32x32x16_bf16 v[16:31], a[144:147], v[32:35], 0
  s_waitcnt lgkmcnt(2)
  v_mfma_f32_32x32x16_bf16 v[0:15], a[4:7], v[36:39], v[0:15]
  ds_read_b128 v[32:35], v203 offset:1024
  s_add_u32 m0, s67, 37760
  s_nop 0
  buffer_load_dwordx4 v202, s[4:7], s60 offen offset:128 lds
  v_mfma_f32_32x32x16_bf16 v[16:31], a[148:151], v[36:39], v[16:31]
  s_waitcnt lgkmcnt(2)
  v_mfma_f32_32x32x16_bf16 v[0:15], a[8:11], v[40:43], v[0:15]
  ds_read_b128 v[36:39], v204 offset:1024
  s_add_u32 m0, s67, 38656
  s_nop 0
  buffer_load_dwordx4 v202, s[4:7], s60 offen offset:256 lds
  v_mfma_f32_32x32x16_bf16 v[16:31], a[152:155], v[40:43], v[16:31]
  s_waitcnt lgkmcnt(2)
  v_mfma_f32_32x32x16_bf16 v[0:15], a[12:15], v[44:47], v[0:15]
  ds_read_b128 v[40:43], v205 offset:1024
  s_add_u32 m0, s67, 39552
  s_nop 0
  buffer_load_dwordx4 v202, s[4:7], s60 offen offset:384 lds
  v_mfma_f32_32x32x16_bf16 v[16:31], a[156:159], v[44:47], v[16:31]
  s_waitcnt lgkmcnt(2)
  v_mfma_f32_32x32x16_bf16 v[0:15], a[16:19], v[32:35], v[0:15]
  ds_read_b128 v[44:47], v206 offset:1024
  s_add_u32 m0, s67, 40448
  s_nop 0
  buffer_load_dwordx4 v202, s[4:7], s60 offen offset:512 lds
  v_mfma_f32_32x32x16_bf16 v[16:31], a[160:163], v[32:35], v[16:31]
  s_waitcnt lgkmcnt(2)
  v_mfma_f32_32x32x16_bf16 v[0:15], a[20:23], v[36:39], v[0:15]
  ds_read_b128 v[32:35], v203 offset:2048
  s_add_u32 m0, s67, 41344
  s_nop 0
  buffer_load_dwordx4 v202, s[4:7], s60 offen offset:640 lds
  v_mfma_f32_32x32x16_bf16 v[16:31], a[164:167], v[36:39], v[16:31]
  s_waitcnt lgkmcnt(2)
  v_mfma_f32_32x32x16_bf16 v[0:15], a[24:27], v[40:43], v[0:15]
  ds_read_b128 v[36:39], v204 offset:2048
  s_add_u32 m0, s67, 42240
  s_nop 0
  buffer_load_dwordx4 v202, s[4:7], s60 offen offset:768 lds
  v_mfma_f32_32x32x16_bf16 v[16:31], a[168:171], v[40:43], v[16:31]
  s_waitcnt lgkmcnt(2)
  v_mfma_f32_32x32x16_bf16 v[0:15], a[28:31], v[44:47], v[0:15]
  ds_read_b128 v[40:43], v205 offset:2048
  s_add_u32 m0, s67, 43136
  s_nop 0
  buffer_load_dwordx4 v202, s[4:7], s60 offen offset:896 lds
  v_mfma_f32_32x32x16_bf16 v[16:31], a[172:175], v[44:47], v[16:31]
  s_waitcnt lgkmcnt(2)
  v_mfma_f32_32x32x16_bf16 v[0:15], a[32:35], v[32:35], v[0:15]
  ds_read_b128 v[44:47], v206 offset:2048
  s_add_u32 m0, s67, 44032
  s_nop 0
  buffer_load_dwordx4 v202, s[4:7], s60 offen offset:1024 lds
  v_mfma_f32_32x32x16_bf16 v[16:31], a[176:179], v[32:35], v[16:31]
  s_waitcnt lgkmcnt(2)
  v_mfma_f32_32x32x16_bf16 v[0:15], a[36:39], v[36:39], v[0:15]
  ds_read_b128 v[32:35], v203 offset:3072
  v_mfma_f32_32x32x16_bf16 v[16:31], a[180:183], v[36:39], v[16:31]
  s_waitcnt lgkmcnt(2)
  v_mfma_f32_32x32x16_bf16 v[0:15], a[40:43], v[40:43], v[0:15]
  ds_read_b128 v[36:39], v204 offset:3072
  v_mfma_f32_32x32x16_bf16 v[16:31], a[184:187], v[40:43], v[16:31]
  s_waitcnt lgkmcnt(2)
  v_mfma_f32_32x32x16_bf16 v[0:15], a[44:47], v[44:47], v[0:15]
  ds_read_b128 v[40:43], v205 offset:3072
  v_mfma_f32_32x32x16_bf16 v[16:31], a[188:191], v[44:47], v[16:31]
  s_waitcnt lgkmcnt(2)
  v_mfma_f32_32x32x16_bf16 v[0:15], a[48:51], v[32:35], v[0:15]
  ds_read_b128 v[44:47], v206 offset:3072
  v_mfma_f32_32x32x16_bf16 v[16:31], a[192:195], v[32:35], v[16:31]
  s_waitcnt lgkmcnt(2)
  v_mfma_f32_32x32x16_bf16 v[0:15], a[52:55], v[36:39], v[0:15]
  ds_read_b128 v[32:35], v203 offset:4096
  v_mfma_f32_32x32x16_bf16 v[16:31], a[196:199], v[36:39], v[16:31]
  s_waitcnt lgkmcnt(2)
  v_mfma_f32_32x32x16_bf16 v[0:15], a[56:59], v[40:43], v[0:15]
  ds_read_b128 v[36:39], v204 offset:4096
  v_mfma_f32_32x32x16_bf16 v[16:31], a[200:203], v[40:43], v[16:31]
  s_waitcnt lgkmcnt(2)
  v_mfma_f32_32x32x16_bf16 v[0:15], a[60:63], v[44:47], v[0:15]
  ds_read_b128 v[40:43], v205 offset:4096
  v_mfma_f32_32x32x16_bf16 v[16:31], a[204:207], v[44:47], v[16:31]
  s_waitcnt lgkmcnt(2)
  v_mfma_f32_32x32x16_bf16 v[0:15], a[64:67], v[32:35], v[0:15]
  ds_read_b128 v[44:47], v206 offset:4096
  v_mfma_f32_32x32x16_bf16 v[16:31], a[208:211], v[32:35], v[16:31]
  s_waitcnt lgkmcnt(2)
  v_mfma_f32_32x32x16_bf16 v[0:15], a[68:71], v[36:39], v[0:15]
  ds_read_b128 v[32:35], v203 offset:5120
  v_mfma_f32_32x32x16_bf16 v[16:31], a[212:215], v[36:39], v[16:31]
  s_waitcnt lgkmcnt(2)
  v_mfma_f32_32x32x16_bf16 v[0:15], a[72:75], v[40:43], v[0:15]
  ds_read_b128 v[36:39], v204 offset:5120
  v_mfma_f32_32x32x16_bf16 v[16:31], a[216:219], v[40:43], v[16:31]
  s_waitcnt lgkmcnt(2)
  v_mfma_f32_32x32x16_bf16 v[0:15], a[76:79], v[44:47], v[0:15]
  ds_read_b128 v[40:43], v205 offset:5120
  v_mfma_f32_32x32x16_bf16 v[16:31], a[220:223], v[44:47], v[16:31]
  s_waitcnt lgkmcnt(2)
  v_mfma_f32_32x32x16_bf16 v[0:15], a[80:83], v[32:35], v[0:15]
  ds_read_b128 v[44:47], v206 offset:5120
  v_mfma_f32_32x32x16_bf16 v[16:31], a[224:227], v[32:35], v[16:31]
  s_waitcnt lgkmcnt(2)
  v_mfma_f32_32x32x16_bf16 v[0:15], a[84:87], v[36:39], v[0:15]
  ds_read_b128 v[32:35], v203 offset:6144
  v_mfma_f32_32x32x16_bf16 v[16:31], a[228:231], v[36:39], v[16:31]
  s_waitcnt lgkmcnt(2)
  v_mfma_f32_32x32x16_bf16 v[0:15], a[88:91], v[40:43], v[0:15]
  ds_read_b128 v[36:39], v204 offset:6144
  v_mfma_f32_32x32x16_bf16 v[16:31], a[232:235], v[40:43], v[16:31]
  s_waitcnt lgkmcnt(2)
  v_mfma_f32_32x32x16_bf16 v[0:15], a[92:95], v[44:47], v[0:15]
  ds_read_b128 v[40:43], v205 offset:6144
  v_mfma_f32_32x32x16_bf16 v[16:31], a[236:239], v[44:47], v[16:31]
  s_waitcnt lgkmcnt(2)
  v_mfma_f32_32x32x16_bf16 v[0:15], a[96:99], v[32:35], v[0:15]
  ds_read_b128 v[44:47], v206 offset:6144
  v_mfma_f32_32x32x16_bf16 v[16:31], a[240:243], v[32:35], v[16:31]
  s_waitcnt lgkmcnt(2)
  v_mfma_f32_32x32x16_bf16 v[0:15], a[100:103], v[36:39], v[0:15]
  ds_read_b128 v[32:35], v203 offset:7168
  v_mfma_f32_32x32x16_bf16 v[16:31], a[244:247], v[36:39], v[16:31]
  s_waitcnt lgkmcnt(2)
  v_mfma_f32_32x32x16_bf16 v[0:15], a[104:107], v[40:43], v[0:15]
  ds_read_b128 v[36:39], v204 offset:7168
  v_mfma_f32_32x32x16_bf16 v[16:31], a[248:251], v[40:43], v[16:31]
  s_waitcnt lgkmcnt(2)
  v_mfma_f32_32x32x16_bf16 v[0:15], a[108:111], v[44:47], v[0:15]
  ds_read_b128 v[40:43], v205 offset:7168
  v_mfma_f32_32x32x16_bf16 v[16:31], a[252:255], v[44:47], v[16:31]
  s_waitcnt lgkmcnt(2)
  v_mfma_f32_32x32x16_bf16 v[0:15], a[112:115], v[32:35], v[0:15]
  ds_read_b128 v[44:47], v206 offset:7168
  v_mfma_f32_32x32x16_bf16 v[16:31], v[224:227], v[32:35], v[16:31]
  s_waitcnt lgkmcnt(2)
  v_mfma_f32_32x32x16_bf16 v[0:15], a[116:119], v[36:39], v[0:15]
  ds_read_b128 v[32:35], v203 offset:8192
  v_mfma_f32_32x32x16_bf16 v[16:31], v[228:231], v[36:39], v[16:31]
  s_waitcnt lgkmcnt(2)
  v_mfma_f32_32x32x16_bf16 v[0:15], a[120:123], v[40:43], v[0:15]
  ds_read_b128 v[36:39], v204 offset:8192
  v_mfma_f32_32x32x16_bf16 v[16:31], v[232:235], v[40:43], v[16:31]
  s_waitcnt lgkmcnt(2)
  v_mfma_f32_32x32x16_bf16 v[0:15], a[124:127], v[44:47], v[0:15]
  ds_read_b128 v[40:43], v205 offset:8192
  v_mfma_f32_32x32x16_bf16 v[16:31], v[236:239], v[44:47], v[16:31]
  s_waitcnt lgkmcnt(2)
  v_mfma_f32_32x32x16_bf16 v[0:15], a[128:131], v[32:35], v[0:15]
  ds_read_b128 v[44:47], v206 offset:8192
  v_mfma_f32_32x32x16_bf16 v[16:31], v[240:243], v[32:35], v[16:31]
  s_waitcnt lgkmcnt(2)
  v_mfma_f32_32x32x16_bf16 v[0:15], a[132:135], v[36:39], v[0:15]
  v_mfma_f32_32x32x16_bf16 v[16:31], v[244:247], v[36:39], v[16:31]
  s_waitcnt lgkmcnt(1)
  v_mfma_f32_32x32x16_bf16 v[0:15], a[136:139], v[40:43], v[0:15]
  v_mfma_f32_32x32x16_bf16 v[16:31], v[248:251], v[40:43], v[16:31]
  s_waitcnt lgkmcnt(0)
  v_mfma_f32_32x32x16_bf16 v[0:15], a[140:143], v[44:47], v[0:15]
  v_mfma_f32_32x32x16_bf16 v[16:31], v[252:255], v[44:47], v[16:31]
  s_add_u32 s60, s60, 36864
  s_nop 2
  v_cvt_pk_bf16_f32 v48, v0, v1
  v_cvt_pk_bf16_f32 v49, v2, v3
  ds_write2_b32 v218, v48, v49 offset0:0 offset1:1
  v_cvt_pk_bf16_f32 v48, v4, v5
  v_cvt_pk_bf16_f32 v49, v6, v7
  ds_write2_b32 v218, v48, v49 offset0:4 offset1:5
  v_cvt_pk_bf16_f32 v48, v8, v9
  v_cvt_pk_bf16_f32 v49, v10, v11
  ds_write2_b32 v218, v48, v49 offset0:8 offset1:9
  v_cvt_pk_bf16_f32 v48, v12, v13
  v_cvt_pk_bf16_f32 v49, v14, v15
  ds_write2_b32 v218, v48, v49 offset0:12 offset1:13
  v_cvt_pk_bf16_f32 v48, v16, v17
  v_cvt_pk_bf16_f32 v49, v18, v19
  ds_write2_b32 v218, v48, v49 offset0:64 offset1:65
  v_cvt_pk_bf16_f32 v48, v20, v21
  v_cvt_pk_bf16_f32 v49, v22, v23
  ds_write2_b32 v218, v48, v49 offset0:68 offset1:69
  v_cvt_pk_bf16_f32 v48, v24, v25
  v_cvt_pk_bf16_f32 v49, v26, v27
  ds_write2_b32 v218, v48, v49 offset0:72 offset1:73
  v_cvt_pk_bf16_f32 v48, v28, v29
  v_cvt_pk_bf16_f32 v49, v30, v31
  ds_write2_b32 v218, v48, v49 offset0:76 offset1:77
  v_add_u32 v218, 16512, v218
  s_waitcnt vmcnt(0) lgkmcnt(0)
  s_barrier
  ds_read_b128 v[32:35], v203 offset:36864
  ds_read_b128 v[36:39], v204 offset:36864
  ds_read_b128 v[40:43], v205 offset:36864
  s_waitcnt lgkmcnt(2)
  v_mfma_f32_32x32x16_bf16 v[0:15], a[0:3], v[32:35], 0
  ds_read_b128 v[44:47], v206 offset:36864
  s_add_u32 m0, s67, 0
  s_nop 0
  buffer_load_dwordx4 v202, s[4:7], s60 offen offset:0 lds
  v_mfma_f32_32x32x16_bf16 v[16:31], a[144:147], v[32:35], 0
  s_waitcnt lgkmcnt(2)
  v_mfma_f32_32x32x16_bf16 v[0:15], a[4:7], v[36:39], v[0:15]
  ds_read_b128 v[32:35], v203 offset:37888
  s_add_u32 m0, s67, 896
  s_nop 0
  buffer_load_dwordx4 v202, s[4:7], s60 offen offset:128 lds
  v_mfma_f32_32x32x16_bf16 v[16:31], a[148:151], v[36:39], v[16:31]
  s_waitcnt lgkmcnt(2)
  v_mfma_f32_32x32x16_bf16 v[0:15], a[8:11], v[40:43], v[0:15]
  ds_read_b128 v[36:39], v204 offset:37888
  s_add_u32 m0, s67, 1792
  s_nop 0
  buffer_load_dwordx4 v202, s[4:7], s60 offen offset:256 lds
  v_mfma_f32_32x32x16_bf16 v[16:31], a[152:155], v[40:43], v[16:31]
  s_waitcnt lgkmcnt(2)
  v_mfma_f32_32x32x16_bf16 v[0:15], a[12:15], v[44:47], v[0:15]
  ds_read_b128 v[40:43], v205 offset:37888
  s_add_u32 m0, s67, 2688
  s_nop 0
  buffer_load_dwordx4 v202, s[4:7], s60 offen offset:384 lds
  v_mfma_f32_32x32x16_bf16 v[16:31], a[156:159], v[44:47], v[16:31]
  s_waitcnt lgkmcnt(2)
  v_mfma_f32_32x32x16_bf16 v[0:15], a[16:19], v[32:35], v[0:15]
  ds_read_b128 v[44:47], v206 offset:37888
  s_add_u32 m0, s67, 3584
  s_nop 0
  buffer_load_dwordx4 v202, s[4:7], s60 offen offset:512 lds
  v_mfma_f32_32x32x16_bf16 v[16:31], a[160:163], v[32:35], v[16:31]
  s_waitcnt lgkmcnt(2)
  v_mfma_f32_32x32x16_bf16 v[0:15], a[20:23], v[36:39], v[0:15]
  ds_read_b128 v[32:35], v203 offset:38912
  s_add_u32 m0, s67, 4480
  s_nop 0
  buffer_load_dwordx4 v202, s[4:7], s60 offen offset:640 lds
  v_mfma_f32_32x32x16_bf16 v[16:31], a[164:167], v[36:39], v[16:31]
  s_waitcnt lgkmcnt(2)
  v_mfma_f32_32x32x16_bf16 v[0:15], a[24:27], v[40:43], v[0:15]
  ds_read_b128 v[36:39], v204 offset:38912
  s_add_u32 m0, s67, 5376
  s_nop 0
  buffer_load_dwordx4 v202, s[4:7], s60 offen offset:768 lds
  v_mfma_f32_32x32x16_bf16 v[16:31], a[168:171], v[40:43], v[16:31]
  s_waitcnt lgkmcnt(2)
  v_mfma_f32_32x32x16_bf16 v[0:15], a[28:31], v[44:47], v[0:15]
  ds_read_b128 v[40:43], v205 offset:38912
  s_add_u32 m0, s67, 6272
  s_nop 0
  buffer_load_dwordx4 v202, s[4:7], s60 offen offset:896 lds
  v_mfma_f32_32x32x16_bf16 v[16:31], a[172:175], v[44:47], v[16:31]
  s_waitcnt lgkmcnt(2)
  v_mfma_f32_32x32x16_bf16 v[0:15], a[32:35], v[32:35], v[0:15]
  ds_read_b128 v[44:47], v206 offset:38912
  s_add_u32 m0, s67, 7168
  s_nop 0
  buffer_load_dwordx4 v202, s[4:7], s60 offen offset:1024 lds
  v_mfma_f32_32x32x16_bf16 v[16:31], a[176:179], v[32:35], v[16:31]
  s_waitcnt lgkmcnt(2)
  v_mfma_f32_32x32x16_bf16 v[0:15], a[36:39], v[36:39], v[0:15]
  ds_read_b128 v[32:35], v203 offset:39936
  v_mfma_f32_32x32x16_bf16 v[16:31], a[180:183], v[36:39], v[16:31]
  s_waitcnt lgkmcnt(2)
  v_mfma_f32_32x32x16_bf16 v[0:15], a[40:43], v[40:43], v[0:15]
  ds_read_b128 v[36:39], v204 offset:39936
  v_mfma_f32_32x32x16_bf16 v[16:31], a[184:187], v[40:43], v[16:31]
  s_waitcnt lgkmcnt(2)
  v_mfma_f32_32x32x16_bf16 v[0:15], a[44:47], v[44:47], v[0:15]
  ds_read_b128 v[40:43], v205 offset:39936
  v_mfma_f32_32x32x16_bf16 v[16:31], a[188:191], v[44:47], v[16:31]
  s_waitcnt lgkmcnt(2)
  v_mfma_f32_32x32x16_bf16 v[0:15], a[48:51], v[32:35], v[0:15]
  ds_read_b128 v[44:47], v206 offset:39936
  v_mfma_f32_32x32x16_bf16 v[16:31], a[192:195], v[32:35], v[16:31]
  s_waitcnt lgkmcnt(2)
  v_mfma_f32_32x32x16_bf16 v[0:15], a[52:55], v[36:39], v[0:15]
  ds_read_b128 v[32:35], v203 offset:40960
  v_mfma_f32_32x32x16_bf16 v[16:31], a[196:199], v[36:39], v[16:31]
  s_waitcnt lgkmcnt(2)
  v_mfma_f32_32x32x16_bf16 v[0:15], a[56:59], v[40:43], v[0:15]
  ds_read_b128 v[36:39], v204 offset:40960
  v_mfma_f32_32x32x16_bf16 v[16:31], a[200:203], v[40:43], v[16:31]
  s_waitcnt lgkmcnt(2)
  v_mfma_f32_32x32x16_bf16 v[0:15], a[60:63], v[44:47], v[0:15]
  ds_read_b128 v[40:43], v205 offset:40960
  v_mfma_f32_32x32x16_bf16 v[16:31], a[204:207], v[44:47], v[16:31]
  s_waitcnt lgkmcnt(2)
  v_mfma_f32_32x32x16_bf16 v[0:15], a[64:67], v[32:35], v[0:15]
  ds_read_b128 v[44:47], v206 offset:40960
  v_mfma_f32_32x32x16_bf16 v[16:31], a[208:211], v[32:35], v[16:31]
  s_waitcnt lgkmcnt(2)
  v_mfma_f32_32x32x16_bf16 v[0:15], a[68:71], v[36:39], v[0:15]
  ds_read_b128 v[32:35], v203 offset:41984
  v_mfma_f32_32x32x16_bf16 v[16:31], a[212:215], v[36:39], v[16:31]
  s_waitcnt lgkmcnt(2)
  v_mfma_f32_32x32x16_bf16 v[0:15], a[72:75], v[40:43], v[0:15]
  ds_read_b128 v[36:39], v204 offset:41984
  v_mfma_f32_32x32x16_bf16 v[16:31], a[216:219], v[40:43], v[16:31]
  s_waitcnt lgkmcnt(2)
  v_mfma_f32_32x32x16_bf16 v[0:15], a[76:79], v[44:47], v[0:15]
  ds_read_b128 v[40:43], v205 offset:41984
  v_mfma_f32_32x32x16_bf16 v[16:31], a[220:223], v[44:47], v[16:31]
  s_waitcnt lgkmcnt(2)
  v_mfma_f32_32x32x16_bf16 v[0:15], a[80:83], v[32:35], v[0:15]
  ds_read_b128 v[44:47], v206 offset:41984
  v_mfma_f32_32x32x16_bf16 v[16:31], a[224:227], v[32:35], v[16:31]
  s_waitcnt lgkmcnt(2)
  v_mfma_f32_32x32x16_bf16 v[0:15], a[84:87], v[36:39], v[0:15]
  ds_read_b128 v[32:35], v203 offset:43008
  v_mfma_f32_32x32x16_bf16 v[16:31], a[228:231], v[36:39], v[16:31]
  s_waitcnt lgkmcnt(2)
  v_mfma_f32_32x32x16_bf16 v[0:15], a[88:91], v[40:43], v[0:15]
  ds_read_b128 v[36:39], v204 offset:43008
  v_mfma_f32_32x32x16_bf16 v[16:31], a[232:235], v[40:43], v[16:31]
  s_waitcnt lgkmcnt(2)
  v_mfma_f32_32x32x16_bf16 v[0:15], a[92:95], v[44:47], v[0:15]
  ds_read_b128 v[40:43], v205 offset:43008
  v_mfma_f32_32x32x16_bf16 v[16:31], a[236:239], v[44:47], v[16:31]
  s_waitcnt lgkmcnt(2)
  v_mfma_f32_32x32x16_bf16 v[0:15], a[96:99], v[32:35], v[0:15]
  ds_read_b128 v[44:47], v206 offset:43008
  v_mfma_f32_32x32x16_bf16 v[16:31], a[240:243], v[32:35], v[16:31]
  s_waitcnt lgkmcnt(2)
  v_mfma_f32_32x32x16_bf16 v[0:15], a[100:103], v[36:39], v[0:15]
  ds_read_b128 v[32:35], v203 offset:44032
  v_mfma_f32_32x32x16_bf16 v[16:31], a[244:247], v[36:39], v[16:31]
  s_waitcnt lgkmcnt(2)
  v_mfma_f32_32x32x16_bf16 v[0:15], a[104:107], v[40:43], v[0:15]
  ds_read_b128 v[36:39], v204 offset:44032
  v_mfma_f32_32x32x16_bf16 v[16:31], a[248:251], v[40:43], v[16:31]
  s_waitcnt lgkmcnt(2)
  v_mfma_f32_32x32x16_bf16 v[0:15], a[108:111], v[44:47], v[0:15]
  ds_read_b128 v[40:43], v205 offset:44032
  v_mfma_f32_32x32x16_bf16 v[16:31], a[252:255], v[44:47], v[16:31]
  s_waitcnt lgkmcnt(2)
  v_mfma_f32_32x32x16_bf16 v[0:15], a[112:115], v[32:35], v[0:15]
  ds_read_b128 v[44:47], v206 offset:44032
  v_mfma_f32_32x32x16_bf16 v[16:31], v[224:227], v[32:35], v[16:31]
  s_waitcnt lgkmcnt(2)
  v_mfma_f32_32x32x16_bf16 v[0:15], a[116:119], v[36:39], v[0:15]
  ds_read_b128 v[32:35], v203 offset:45056
  v_mfma_f32_32x32x16_bf16 v[16:31], v[228:231], v[36:39], v[16:31]
  s_waitcnt lgkmcnt(2)
  v_mfma_f32_32x32x16_bf16 v[0:15], a[120:123], v[40:43], v[0:15]
  ds_read_b128 v[36:39], v204 offset:45056
  v_mfma_f32_32x32x16_bf16 v[16:31], v[232:235], v[40:43], v[16:31]
  s_waitcnt lgkmcnt(2)
  v_mfma_f32_32x32x16_bf16 v[0:15], a[124:127], v[44:47], v[0:15]
  ds_read_b128 v[40:43], v205 offset:45056
  v_mfma_f32_32x32x16_bf16 v[16:31], v[236:239], v[44:47], v[16:31]
  s_waitcnt lgkmcnt(2)
  v_mfma_f32_32x32x16_bf16 v[0:15], a[128:131], v[32:35], v[0:15]
  ds_read_b128 v[44:47], v206 offset:45056
  v_mfma_f32_32x32x16_bf16 v[16:31], v[240:243], v[32:35], v[16:31]
  s_waitcnt lgkmcnt(2)
  v_mfma_f32_32x32x16_bf16 v[0:15], a[132:135], v[36:39], v[0:15]
  v_mfma_f32_32x32x16_bf16 v[16:31], v[244:247], v[36:39], v[16:31]
  s_waitcnt lgkmcnt(1)
  v_mfma_f32_32x32x16_bf16 v[0:15], a[136:139], v[40:43], v[0:15]
  v_mfma_f32_32x32x16_bf16 v[16:31], v[248:251], v[40:43], v[16:31]
  s_waitcnt lgkmcnt(0)
  v_mfma_f32_32x32x16_bf16 v[0:15], a[140:143], v[44:47], v[0:15]
  v_mfma_f32_32x32x16_bf16 v[16:31], v[252:255], v[44:47], v[16:31]
  s_add_u32 s60, s60, 36864
  s_nop 2
  v_cvt_pk_bf16_f32 v48, v0, v1
  v_cvt_pk_bf16_f32 v49, v2, v3
  ds_write2_b32 v218, v48, v49 offset0:0 offset1:1
  v_cvt_pk_bf16_f32 v48, v4, v5
  v_cvt_pk_bf16_f32 v49, v6, v7
  ds_write2_b32 v218, v48, v49 offset0:4 offset1:5
  v_cvt_pk_bf16_f32 v48, v8, v9
  v_cvt_pk_bf16_f32 v49, v10, v11
  ds_write2_b32 v218, v48, v49 offset0:8 offset1:9
  v_cvt_pk_bf16_f32 v48, v12, v13
  v_cvt_pk_bf16_f32 v49, v14, v15
  ds_write2_b32 v218, v48, v49 offset0:12 offset1:13
  v_cvt_pk_bf16_f32 v48, v16, v17
  v_cvt_pk_bf16_f32 v49, v18, v19
  ds_write2_b32 v218, v48, v49 offset0:64 offset1:65
  v_cvt_pk_bf16_f32 v48, v20, v21
  v_cvt_pk_bf16_f32 v49, v22, v23
  ds_write2_b32 v218, v48, v49 offset0:68 offset1:69
  v_cvt_pk_bf16_f32 v48, v24, v25
  v_cvt_pk_bf16_f32 v49, v26, v27
  ds_write2_b32 v218, v48, v49 offset0:72 offset1:73
  v_cvt_pk_bf16_f32 v48, v28, v29
  v_cvt_pk_bf16_f32 v49, v30, v31
  ds_write2_b32 v218, v48, v49 offset0:76 offset1:77
  v_add_u32 v218, 16512, v218
  s_waitcnt vmcnt(0) lgkmcnt(0)
  s_barrier
  ds_read_b128 v[32:35], v203 offset:0
  ds_read_b128 v[36:39], v204 offset:0
  ds_read_b128 v[40:43], v205 offset:0
  s_waitcnt lgkmcnt(2)
  v_mfma_f32_32x32x16_bf16 v[0:15], a[0:3], v[32:35], 0
  ds_read_b128 v[44:47], v206 offset:0
  v_mfma_f32_32x32x16_bf16 v[16:31], a[144:147], v[32:35], 0
  s_waitcnt lgkmcnt(2)
  v_mfma_f32_32x32x16_bf16 v[0:15], a[4:7], v[36:39], v[0:15]
  ds_read_b128 v[32:35], v203 offset:1024
  v_mfma_f32_32x32x16_bf16 v[16:31], a[148:151], v[36:39], v[16:31]
  s_waitcnt lgkmcnt(2)
  v_mfma_f32_32x32x16_bf16 v[0:15], a[8:11], v[40:43], v[0:15]
  ds_read_b128 v[36:39], v204 offset:1024
  v_mfma_f32_32x32x16_bf16 v[16:31], a[152:155], v[40:43], v[16:31]
  s_waitcnt lgkmcnt(2)
  v_mfma_f32_32x32x16_bf16 v[0:15], a[12:15], v[44:47], v[0:15]
  ds_read_b128 v[40:43], v205 offset:1024
  v_mfma_f32_32x32x16_bf16 v[16:31], a[156:159], v[44:47], v[16:31]
  s_waitcnt lgkmcnt(2)
  v_mfma_f32_32x32x16_bf16 v[0:15], a[16:19], v[32:35], v[0:15]
  ds_read_b128 v[44:47], v206 offset:1024
  v_mfma_f32_32x32x16_bf16 v[16:31], a[160:163], v[32:35], v[16:31]
  s_waitcnt lgkmcnt(2)
  v_mfma_f32_32x32x16_bf16 v[0:15], a[20:23], v[36:39], v[0:15]
  ds_read_b128 v[32:35], v203 offset:2048
  v_mfma_f32_32x32x16_bf16 v[16:31], a[164:167], v[36:39], v[16:31]
  s_waitcnt lgkmcnt(2)
  v_mfma_f32_32x32x16_bf16 v[0:15], a[24:27], v[40:43], v[0:15]
  ds_read_b128 v[36:39], v204 offset:2048
  v_mfma_f32_32x32x16_bf16 v[16:31], a[168:171], v[40:43], v[16:31]
  s_waitcnt lgkmcnt(2)
  v_mfma_f32_32x32x16_bf16 v[0:15], a[28:31], v[44:47], v[0:15]
  ds_read_b128 v[40:43], v205 offset:2048
  v_mfma_f32_32x32x16_bf16 v[16:31], a[172:175], v[44:47], v[16:31]
  s_waitcnt lgkmcnt(2)
  v_mfma_f32_32x32x16_bf16 v[0:15], a[32:35], v[32:35], v[0:15]
  ds_read_b128 v[44:47], v206 offset:2048
  v_mfma_f32_32x32x16_bf16 v[16:31], a[176:179], v[32:35], v[16:31]
  s_waitcnt lgkmcnt(2)
  v_mfma_f32_32x32x16_bf16 v[0:15], a[36:39], v[36:39], v[0:15]
  ds_read_b128 v[32:35], v203 offset:3072
  v_mfma_f32_32x32x16_bf16 v[16:31], a[180:183], v[36:39], v[16:31]
  s_waitcnt lgkmcnt(2)
  v_mfma_f32_32x32x16_bf16 v[0:15], a[40:43], v[40:43], v[0:15]
  ds_read_b128 v[36:39], v204 offset:3072
  v_mfma_f32_32x32x16_bf16 v[16:31], a[184:187], v[40:43], v[16:31]
  s_waitcnt lgkmcnt(2)
  v_mfma_f32_32x32x16_bf16 v[0:15], a[44:47], v[44:47], v[0:15]
  ds_read_b128 v[40:43], v205 offset:3072
  v_mfma_f32_32x32x16_bf16 v[16:31], a[188:191], v[44:47], v[16:31]
  s_waitcnt lgkmcnt(2)
  v_mfma_f32_32x32x16_bf16 v[0:15], a[48:51], v[32:35], v[0:15]
  ds_read_b128 v[44:47], v206 offset:3072
  v_mfma_f32_32x32x16_bf16 v[16:31], a[192:195], v[32:35], v[16:31]
  s_waitcnt lgkmcnt(2)
  v_mfma_f32_32x32x16_bf16 v[0:15], a[52:55], v[36:39], v[0:15]
  ds_read_b128 v[32:35], v203 offset:4096
  v_mfma_f32_32x32x16_bf16 v[16:31], a[196:199], v[36:39], v[16:31]
  s_waitcnt lgkmcnt(2)
  v_mfma_f32_32x32x16_bf16 v[0:15], a[56:59], v[40:43], v[0:15]
  ds_read_b128 v[36:39], v204 offset:4096
  v_mfma_f32_32x32x16_bf16 v[16:31], a[200:203], v[40:43], v[16:31]
  s_waitcnt lgkmcnt(2)
  v_mfma_f32_32x32x16_bf16 v[0:15], a[60:63], v[44:47], v[0:15]
  ds_read_b128 v[40:43], v205 offset:4096
  v_mfma_f32_32x32x16_bf16 v[16:31], a[204:207], v[44:47], v[16:31]
  s_waitcnt lgkmcnt(2)
  v_mfma_f32_32x32x16_bf16 v[0:15], a[64:67], v[32:35], v[0:15]
  ds_read_b128 v[44:47], v206 offset:4096
  v_mfma_f32_32x32x16_bf16 v[16:31], a[208:211], v[32:35], v[16:31]
  s_waitcnt lgkmcnt(2)
  v_mfma_f32_32x32x16_bf16 v[0:15], a[68:71], v[36:39], v[0:15]
  ds_read_b128 v[32:35], v203 offset:5120
  v_mfma_f32_32x32x16_bf16 v[16:31], a[212:215], v[36:39], v[16:31]
  s_waitcnt lgkmcnt(2)
  v_mfma_f32_32x32x16_bf16 v[0:15], a[72:75], v[40:43], v[0:15]
  ds_read_b128 v[36:39], v204 offset:5120
  v_mfma_f32_32x32x16_bf16 v[16:31], a[216:219], v[40:43], v[16:31]
  s_waitcnt lgkmcnt(2)
  v_mfma_f32_32x32x16_bf16 v[0:15], a[76:79], v[44:47], v[0:15]
  ds_read_b128 v[40:43], v205 offset:5120
  v_mfma_f32_32x32x16_bf16 v[16:31], a[220:223], v[44:47], v[16:31]
  s_waitcnt lgkmcnt(2)
  v_mfma_f32_32x32x16_bf16 v[0:15], a[80:83], v[32:35], v[0:15]
  ds_read_b128 v[44:47], v206 offset:5120
  v_mfma_f32_32x32x16_bf16 v[16:31], a[224:227], v[32:35], v[16:31]
  s_waitcnt lgkmcnt(2)
  v_mfma_f32_32x32x16_bf16 v[0:15], a[84:87], v[36:39], v[0:15]
  ds_read_b128 v[32:35], v203 offset:6144
  v_mfma_f32_32x32x16_bf16 v[16:31], a[228:231], v[36:39], v[16:31]
  s_waitcnt lgkmcnt(2)
  v_mfma_f32_32x32x16_bf16 v[0:15], a[88:91], v[40:43], v[0:15]
  ds_read_b128 v[36:39], v204 offset:6144
  v_mfma_f32_32x32x16_bf16 v[16:31], a[232:235], v[40:43], v[16:31]
  s_waitcnt lgkmcnt(2)
  v_mfma_f32_32x32x16_bf16 v[0:15], a[92:95], v[44:47], v[0:15]
  ds_read_b128 v[40:43], v205 offset:6144
  v_mfma_f32_32x32x16_bf16 v[16:31], a[236:239], v[44:47], v[16:31]
  s_waitcnt lgkmcnt(2)
  v_mfma_f32_32x32x16_bf16 v[0:15], a[96:99], v[32:35], v[0:15]
  ds_read_b128 v[44:47], v206 offset:6144
  v_mfma_f32_32x32x16_bf16 v[16:31], a[240:243], v[32:35], v[16:31]
  s_waitcnt lgkmcnt(2)
  v_mfma_f32_32x32x16_bf16 v[0:15], a[100:103], v[36:39], v[0:15]
  ds_read_b128 v[32:35], v203 offset:7168
  v_mfma_f32_32x32x16_bf16 v[16:31], a[244:247], v[36:39], v[16:31]
  s_waitcnt lgkmcnt(2)
  v_mfma_f32_32x32x16_bf16 v[0:15], a[104:107], v[40:43], v[0:15]
  ds_read_b128 v[36:39], v204 offset:7168
  v_mfma_f32_32x32x16_bf16 v[16:31], a[248:251], v[40:43], v[16:31]
  s_waitcnt lgkmcnt(2)
  v_mfma_f32_32x32x16_bf16 v[0:15], a[108:111], v[44:47], v[0:15]
  ds_read_b128 v[40:43], v205 offset:7168
  v_mfma_f32_32x32x16_bf16 v[16:31], a[252:255], v[44:47], v[16:31]
  s_waitcnt lgkmcnt(2)
  v_mfma_f32_32x32x16_bf16 v[0:15], a[112:115], v[32:35], v[0:15]
  ds_read_b128 v[44:47], v206 offset:7168
  v_mfma_f32_32x32x16_bf16 v[16:31], v[224:227], v[32:35], v[16:31]
  s_waitcnt lgkmcnt(2)
  v_mfma_f32_32x32x16_bf16 v[0:15], a[116:119], v[36:39], v[0:15]
  ds_read_b128 v[32:35], v203 offset:8192
  v_mfma_f32_32x32x16_bf16 v[16:31], v[228:231], v[36:39], v[16:31]
  s_waitcnt lgkmcnt(2)
  v_mfma_f32_32x32x16_bf16 v[0:15], a[120:123], v[40:43], v[0:15]
  ds_read_b128 v[36:39], v204 offset:8192
  v_mfma_f32_32x32x16_bf16 v[16:31], v[232:235], v[40:43], v[16:31]
  s_waitcnt lgkmcnt(2)
  v_mfma_f32_32x32x16_bf16 v[0:15], a[124:127], v[44:47], v[0:15]
  ds_read_b128 v[40:43], v205 offset:8192
  v_mfma_f32_32x32x16_bf16 v[16:31], v[236:239], v[44:47], v[16:31]
  s_waitcnt lgkmcnt(2)
  v_mfma_f32_32x32x16_bf16 v[0:15], a[128:131], v[32:35], v[0:15]
  ds_read_b128 v[44:47], v206 offset:8192
  v_mfma_f32_32x32x16_bf16 v[16:31], v[240:243], v[32:35], v[16:31]
  s_waitcnt lgkmcnt(2)
  v_mfma_f32_32x32x16_bf16 v[0:15], a[132:135], v[36:39], v[0:15]
  v_mfma_f32_32x32x16_bf16 v[16:31], v[244:247], v[36:39], v[16:31]
  s_waitcnt lgkmcnt(1)
  v_mfma_f32_32x32x16_bf16 v[0:15], a[136:139], v[40:43], v[0:15]
  v_mfma_f32_32x32x16_bf16 v[16:31], v[248:251], v[40:43], v[16:31]
  s_waitcnt lgkmcnt(0)
  v_mfma_f32_32x32x16_bf16 v[0:15], a[140:143], v[44:47], v[0:15]
  v_mfma_f32_32x32x16_bf16 v[16:31], v[252:255], v[44:47], v[16:31]
  s_add_u32 s60, s60, 36864
  s_nop 2
  v_cvt_pk_bf16_f32 v48, v0, v1
  v_cvt_pk_bf16_f32 v49, v2, v3
  ds_write2_b32 v218, v48, v49 offset0:0 offset1:1
  v_cvt_pk_bf16_f32 v48, v4, v5
  v_cvt_pk_bf16_f32 v49, v6, v7
  ds_write2_b32 v218, v48, v49 offset0:4 offset1:5
  v_cvt_pk_bf16_f32 v48, v8, v9
  v_cvt_pk_bf16_f32 v49, v10, v11
  ds_write2_b32 v218, v48, v49 offset0:8 offset1:9
  v_cvt_pk_bf16_f32 v48, v12, v13
  v_cvt_pk_bf16_f32 v49, v14, v15
  ds_write2_b32 v218, v48, v49 offset0:12 offset1:13
  v_cvt_pk_bf16_f32 v48, v16, v17
  v_cvt_pk_bf16_f32 v49, v18, v19
  ds_write2_b32 v218, v48, v49 offset0:64 offset1:65
  v_cvt_pk_bf16_f32 v48, v20, v21
  v_cvt_pk_bf16_f32 v49, v22, v23
  ds_write2_b32 v218, v48, v49 offset0:68 offset1:69
  v_cvt_pk_bf16_f32 v48, v24, v25
  v_cvt_pk_bf16_f32 v49, v26, v27
  ds_write2_b32 v218, v48, v49 offset0:72 offset1:73
  v_cvt_pk_bf16_f32 v48, v28, v29
  v_cvt_pk_bf16_f32 v49, v30, v31
  ds_write2_b32 v218, v48, v49 offset0:76 offset1:77
  v_add_u32 v218, 16512, v218
  s_waitcnt vmcnt(0) lgkmcnt(0)
  s_barrier
  v_mul_u32_u24 v219, 516, v200
  s_mul_i32 s54, s52, 36
  s_add_u32 s55, s54, 83016
  v_add_u32 v219, s55, v219
  v_mul_u32_u24 v220, 144, v200
  v_add_u32 v220, s54, v220
  s_mul_i32 s54, s52, 3072
  v_add_u32 v218, s54, v201
  s_lshl_b32 s55, s68, 4
  s_add_u32 s55, s55, s69
  s_mul_i32 s64, s55, 18432
  s_add_u32 s64, s64, 62914560
  s_cmp_eq_u32 s52, 3
  s_cselect_b32 s64, 268435456, s64
  s_lshl_b32 s66, s69, 7
  s_mov_b32 s57, 1051597459
  ds_read_b32 v0, v219 offset:7224
  ds_read_b32 v1, v219 offset:7228
  ds_read_b32 v2, v219 offset:7232
  ds_read_b32 v3, v219 offset:7236
  ds_read_b32 v4, v219 offset:7240
  ds_read_b32 v5, v219 offset:7244
  ds_read_b32 v6, v219 offset:7248
  ds_read_b32 v7, v219 offset:7252
  ds_read_b32 v8, v219 offset:7256
  ds_read_b32 v16, v219 offset:7368
  ds_read_b32 v17, v219 offset:7372
  ds_read_b32 v18, v219 offset:7376
  ds_read_b32 v19, v219 offset:7380
  ds_read_b32 v20, v219 offset:7384
  ds_read_b32 v21, v219 offset:7388
  ds_read_b32 v22, v219 offset:7392
  ds_read_b32 v23, v219 offset:7396
  ds_read_b32 v24, v219 offset:7400
  ds_read_b32 v25, v219 offset:6336
  ds_read_b32 v26, v219 offset:6340
  ds_read_b32 v27, v219 offset:6344
  ds_read_b32 v28, v219 offset:6348
  ds_read_b32 v29, v219 offset:6352
  ds_read_b32 v30, v219 offset:6356
  ds_read_b32 v31, v219 offset:6360
  ds_read_b32 v32, v219 offset:6364
  ds_read_b32 v33, v219 offset:6368
  ds_read_b32 v34, v219 offset:5304
  ds_read_b32 v35, v219 offset:5308
  ds_read_b32 v36, v219 offset:5312
  ds_read_b32 v37, v219 offset:5316
  ds_read_b32 v38, v219 offset:5320
  ds_read_b32 v39, v219 offset:5324
  ds_read_b32 v40, v219 offset:5328
  ds_read_b32 v41, v219 offset:5332
  ds_read_b32 v42, v219 offset:5336
  ds_read_b32 v43, v219 offset:4272
  ds_read_b32 v44, v219 offset:4276
  ds_read_b32 v45, v219 offset:4280
  ds_read_b32 v46, v219 offset:4284
  ds_read_b32 v47, v219 offset:4288
  ds_read_b32 v48, v219 offset:4292
  ds_read_b32 v49, v219 offset:4296
  ds_read_b32 v50, v219 offset:4300
  ds_read_b32 v51, v219 offset:4304
  ds_read_b32 v52, v219 offset:3240
  ds_read_b32 v53, v219 offset:3244
  ds_read_b32 v54, v219 offset:3248
  ds_read_b32 v55, v219 offset:3252
  ds_read_b32 v56, v219 offset:3256
  ds_read_b32 v57, v219 offset:3260
  ds_read_b32 v58, v219 offset:3264
  ds_read_b32 v59, v219 offset:3268
  ds_read_b32 v60, v219 offset:3272
  ds_read_b32 v61, v219 offset:2208
  ds_read_b32 v62, v219 offset:2212
  ds_read_b32 v63, v219 offset:2216
  ds_read_b32 v64, v219 offset:2220
  ds_read_b32 v65, v219 offset:2224
  ds_read_b32 v66, v219 offset:2228
  ds_read_b32 v67, v219 offset:2232
  ds_read_b32 v68, v219 offset:2236
  ds_read_b32 v69, v219 offset:2240
  ds_read_b32 v70, v219 offset:1176
  ds_read_b32 v71, v219 offset:1180
  ds_read_b32 v72, v219 offset:1184
  ds_read_b32 v73, v219 offset:1188
  ds_read_b32 v74, v219 offset:1192
  ds_read_b32 v75, v219 offset:1196
  ds_read_b32 v76, v219 offset:1200
  ds_read_b32 v77, v219 offset:1204
  ds_read_b32 v78, v219 offset:1208
  ds_read_b32 v79, v219 offset:144
  ds_read_b32 v80, v219 offset:148
  ds_read_b32 v81, v219 offset:152
  ds_read_b32 v82, v219 offset:156
  ds_read_b32 v83, v219 offset:160
  ds_read_b32 v84, v219 offset:164
  ds_read_b32 v85, v219 offset:168
  ds_read_b32 v86, v219 offset:172
  ds_read_b32 v87, v219 offset:176
  v_mov_b32 v100, 0
  v_mov_b32 v101, 0
  v_mov_b32 v102, 0
  v_mov_b32 v103, 0
  v_mov_b32 v104, 0
  v_mov_b32 v105, 0
  v_mov_b32 v106, 0
  v_mov_b32 v107, 0
  s_waitcnt lgkmcnt(15)
  v_dot2c_f32_bf16 v100, v0, v16
  v_dot2c_f32_bf16 v101, v0, v25
  v_dot2c_f32_bf16 v102, v0, v34
  v_dot2c_f32_bf16 v103, v0, v43
  v_dot2c_f32_bf16 v104, v0, v52
  v_dot2c_f32_bf16 v105, v0, v61
  v_dot2c_f32_bf16 v106, v0, v70
  s_waitcnt lgkmcnt(8)
  v_dot2c_f32_bf16 v107, v0, v79
  v_dot2c_f32_bf16 v100, v1, v17
  v_dot2c_f32_bf16 v101, v1, v26
  v_dot2c_f32_bf16 v102, v1, v35
  v_dot2c_f32_bf16 v103, v1, v44
  v_dot2c_f32_bf16 v104, v1, v53
  v_dot2c_f32_bf16 v105, v1, v62
  v_dot2c_f32_bf16 v106, v1, v71
  s_waitcnt lgkmcnt(7)
  v_dot2c_f32_bf16 v107, v1, v80
  v_dot2c_f32_bf16 v100, v2, v18
  v_dot2c_f32_bf16 v101, v2, v27
  v_dot2c_f32_bf16 v102, v2, v36
  v_dot2c_f32_bf16 v103, v2, v45
  v_dot2c_f32_bf16 v104, v2, v54
  v_dot2c_f32_bf16 v105, v2, v63
  v_dot2c_f32_bf16 v106, v2, v72
  s_waitcnt lgkmcnt(6)
  v_dot2c_f32_bf16 v107, v2, v81
  v_dot2c_f32_bf16 v100, v3, v19
  v_dot2c_f32_bf16 v101, v3, v28
  v_dot2c_f32_bf16 v102, v3, v37
  v_dot2c_f32_bf16 v103, v3, v46
  v_dot2c_f32_bf16 v104, v3, v55
  v_dot2c_f32_bf16 v105, v3, v64
  v_dot2c_f32_bf16 v106, v3, v73
  s_waitcnt lgkmcnt(5)
  v_dot2c_f32_bf16 v107, v3, v82
  v_dot2c_f32_bf16 v100, v4, v20
  v_dot2c_f32_bf16 v101, v4, v29
  v_dot2c_f32_bf16 v102, v4, v38
  v_dot2c_f32_bf16 v103, v4, v47
  v_dot2c_f32_bf16 v104, v4, v56
  v_dot2c_f32_bf16 v105, v4, v65
  v_dot2c_f32_bf16 v106, v4, v74
  s_waitcnt lgkmcnt(4)
  v_dot2c_f32_bf16 v107, v4, v83
  v_dot2c_f32_bf16 v100, v5, v21
  v_dot2c_f32_bf16 v101, v5, v30
  v_dot2c_f32_bf16 v102, v5, v39
  v_dot2c_f32_bf16 v103, v5, v48
  v_dot2c_f32_bf16 v104, v5, v57
  v_dot2c_f32_bf16 v105, v5, v66
  v_dot2c_f32_bf16 v106, v5, v75
  s_waitcnt lgkmcnt(3)
  v_dot2c_f32_bf16 v107, v5, v84
  v_dot2c_f32_bf16 v100, v6, v22
  v_dot2c_f32_bf16 v101, v6, v31
  v_dot2c_f32_bf16 v102, v6, v40
  v_dot2c_f32_bf16 v103, v6, v49
  v_dot2c_f32_bf16 v104, v6, v58
  v_dot2c_f32_bf16 v105, v6, v67
  v_dot2c_f32_bf16 v106, v6, v76
  s_waitcnt lgkmcnt(2)
  v_dot2c_f32_bf16 v107, v6, v85
  v_dot2c_f32_bf16 v100, v7, v23
  v_dot2c_f32_bf16 v101, v7, v32
  v_dot2c_f32_bf16 v102, v7, v41
  v_dot2c_f32_bf16 v103, v7, v50
  v_dot2c_f32_bf16 v104, v7, v59
  v_dot2c_f32_bf16 v105, v7, v68
  v_dot2c_f32_bf16 v106, v7, v77
  s_waitcnt lgkmcnt(1)
  v_dot2c_f32_bf16 v107, v7, v86
  v_dot2c_f32_bf16 v100, v8, v24
  v_dot2c_f32_bf16 v101, v8, v33
  v_dot2c_f32_bf16 v102, v8, v42
  v_dot2c_f32_bf16 v103, v8, v51
  v_dot2c_f32_bf16 v104, v8, v60
  v_dot2c_f32_bf16 v105, v8, v69
  v_dot2c_f32_bf16 v106, v8, v78
  s_waitcnt lgkmcnt(0)
  v_dot2c_f32_bf16 v107, v8, v87
  ds_read_b32 v16, v219 offset:7512
  ds_read_b32 v17, v219 offset:7516
  ds_read_b32 v18, v219 offset:7520
  ds_read_b32 v19, v219 offset:7524
  ds_read_b32 v20, v219 offset:7528
  ds_read_b32 v21, v219 offset:7532
  ds_read_b32 v22, v219 offset:7536
  ds_read_b32 v23, v219 offset:7540
  ds_read_b32 v24, v219 offset:7544
  ds_read_b32 v25, v219 offset:6480
  ds_read_b32 v26, v219 offset:6484
  ds_read_b32 v27, v219 offset:6488
  ds_read_b32 v28, v219 offset:6492
  ds_read_b32 v29, v219 offset:6496
  ds_read_b32 v30, v219 offset:6500
  ds_read_b32 v31, v219 offset:6504
  ds_read_b32 v32, v219 offset:6508
  ds_read_b32 v33, v219 offset:6512
  ds_read_b32 v34, v219 offset:5448
  ds_read_b32 v35, v219 offset:5452
  ds_read_b32 v36, v219 offset:5456
  ds_read_b32 v37, v219 offset:5460
  ds_read_b32 v38, v219 offset:5464
  ds_read_b32 v39, v219 offset:5468
  ds_read_b32 v40, v219 offset:5472
  ds_read_b32 v41, v219 offset:5476
  ds_read_b32 v42, v219 offset:5480
  ds_read_b32 v43, v219 offset:4416
  ds_read_b32 v44, v219 offset:4420
  ds_read_b32 v45, v219 offset:4424
  ds_read_b32 v46, v219 offset:4428
  ds_read_b32 v47, v219 offset:4432
  ds_read_b32 v48, v219 offset:4436
  ds_read_b32 v49, v219 offset:4440
  ds_read_b32 v50, v219 offset:4444
  ds_read_b32 v51, v219 offset:4448
  ds_read_b32 v52, v219 offset:3384
  ds_read_b32 v53, v219 offset:3388
  ds_read_b32 v54, v219 offset:3392
  ds_read_b32 v55, v219 offset:3396
  ds_read_b32 v56, v219 offset:3400
  ds_read_b32 v57, v219 offset:3404
  ds_read_b32 v58, v219 offset:3408
  ds_read_b32 v59, v219 offset:3412
  ds_read_b32 v60, v219 offset:3416
  ds_read_b32 v61, v219 offset:2352
  ds_read_b32 v62, v219 offset:2356
  ds_read_b32 v63, v219 offset:2360
  ds_read_b32 v64, v219 offset:2364
  ds_read_b32 v65, v219 offset:2368
  ds_read_b32 v66, v219 offset:2372
  ds_read_b32 v67, v219 offset:2376
  ds_read_b32 v68, v219 offset:2380
  ds_read_b32 v69, v219 offset:2384
  ds_read_b32 v70, v219 offset:1320
  ds_read_b32 v71, v219 offset:1324
  ds_read_b32 v72, v219 offset:1328
  ds_read_b32 v73, v219 offset:1332
  ds_read_b32 v74, v219 offset:1336
  ds_read_b32 v75, v219 offset:1340
  ds_read_b32 v76, v219 offset:1344
  ds_read_b32 v77, v219 offset:1348
  ds_read_b32 v78, v219 offset:1352
  ds_read_b32 v79, v219 offset:288
  ds_read_b32 v80, v219 offset:292
  ds_read_b32 v81, v219 offset:296
  ds_read_b32 v82, v219 offset:300
  ds_read_b32 v83, v219 offset:304
  ds_read_b32 v84, v219 offset:308
  ds_read_b32 v85, v219 offset:312
  ds_read_b32 v86, v219 offset:316
  ds_read_b32 v87, v219 offset:320
  v_add_u32 v211, s66, v200
  v_mov_b32 v212, 0xf149f2ca
  v_mul_f32 v100, s57, v100
  v_mul_f32 v101, s57, v101
  v_mul_f32 v102, s57, v102
  v_mul_f32 v103, s57, v103
  v_mul_f32 v104, s57, v104
  v_mul_f32 v105, s57, v105
  v_mul_f32 v106, s57, v106
  v_mul_f32 v107, s57, v107
  v_cmp_gt_u32 vcc, 2, v211
  s_nop 1
  v_cndmask_b32 v101, v101, v212, vcc
  v_cmp_gt_u32 vcc, 4, v211
  s_nop 1
  v_cndmask_b32 v102, v102, v212, vcc
  v_cmp_gt_u32 vcc, 6, v211
  s_nop 1
  v_cndmask_b32 v103, v103, v212, vcc
  v_cmp_gt_u32 vcc, 8, v211
  s_nop 1
  v_cndmask_b32 v104, v104, v212, vcc
  v_cmp_gt_u32 vcc, 10, v211
  s_nop 1
  v_cndmask_b32 v105, v105, v212, vcc
  v_cmp_gt_u32 vcc, 12, v211
  s_nop 1
  v_cndmask_b32 v106, v106, v212, vcc
  v_cmp_gt_u32 vcc, 14, v211
  s_nop 1
  v_cndmask_b32 v107, v107, v212, vcc
  v_max3_f32 v213, v100, v101, v102
  v_max3_f32 v213, v213, v103, v104
  v_max3_f32 v213, v213, v105, v106
  v_max_f32 v213, v213, v107
  v_sub_f32 v100, v100, v213
  v_sub_f32 v101, v101, v213
  v_sub_f32 v102, v102, v213
  v_sub_f32 v103, v103, v213
  v_sub_f32 v104, v104, v213
  v_sub_f32 v105, v105, v213
  v_sub_f32 v106, v106, v213
  v_sub_f32 v107, v107, v213
  v_exp_f32 v100, v100
  v_exp_f32 v101, v101
  v_exp_f32 v102, v102
  v_exp_f32 v103, v103
  v_exp_f32 v104, v104
  v_exp_f32 v105, v105
  v_exp_f32 v106, v106
  v_exp_f32 v107, v107
  v_add_f32 v213, v100, v101
  v_add_f32 v213, v213, v102
  v_add_f32 v213, v213, v103
  v_add_f32 v213, v213, v104
  v_add_f32 v213, v213, v105
  v_add_f32 v213, v213, v106
  v_add_f32 v213, v213, v107
  v_rcp_f32 v213, v213
  v_mov_b32 v214, 0
  v_mul_f32 v100, v213, v100
  v_mul_f32 v101, v213, v101
  v_mul_f32 v102, v213, v102
  v_mul_f32 v103, v213, v103
  v_mul_f32 v104, v213, v104
  v_mul_f32 v105, v213, v105
  v_mul_f32 v106, v213, v106
  v_mul_f32 v107, v213, v107
  v_mov_b32 v112, 0
  v_mov_b32 v113, 0
  v_mov_b32 v114, 0
  v_mov_b32 v115, 0
  v_mov_b32 v116, 0
  v_mov_b32 v117, 0
  v_mov_b32 v118, 0
  v_mov_b32 v119, 0
  v_mov_b32 v120, 0
  v_mov_b32 v121, 0
  v_mov_b32 v122, 0
  v_mov_b32 v123, 0
  v_mov_b32 v124, 0
  v_mov_b32 v125, 0
  v_mov_b32 v126, 0
  v_mov_b32 v127, 0
  v_mov_b32 v128, 0
  v_mov_b32 v129, 0
  v_cvt_pk_bf16_f32 v0, v100, v214
  v_cvt_pk_bf16_f32 v1, v214, v100
  s_waitcnt lgkmcnt(15)
  v_dot2c_f32_bf16 v112, v16, v0
  v_dot2c_f32_bf16 v113, v16, v1
  v_dot2c_f32_bf16 v114, v17, v0
  v_dot2c_f32_bf16 v115, v17, v1
  v_dot2c_f32_bf16 v116, v18, v0
  v_dot2c_f32_bf16 v117, v18, v1
  v_dot2c_f32_bf16 v118, v19, v0
  v_dot2c_f32_bf16 v119, v19, v1
  v_dot2c_f32_bf16 v120, v20, v0
  v_dot2c_f32_bf16 v121, v20, v1
  v_dot2c_f32_bf16 v122, v21, v0
  v_dot2c_f32_bf16 v123, v21, v1
  v_dot2c_f32_bf16 v124, v22, v0
  v_dot2c_f32_bf16 v125, v22, v1
  v_dot2c_f32_bf16 v126, v23, v0
  v_dot2c_f32_bf16 v127, v23, v1
  v_dot2c_f32_bf16 v128, v24, v0
  v_dot2c_f32_bf16 v129, v24, v1
  v_cvt_pk_bf16_f32 v2, v101, v214
  v_cvt_pk_bf16_f32 v3, v214, v101
  v_dot2c_f32_bf16 v112, v25, v2
  v_dot2c_f32_bf16 v113, v25, v3
  v_dot2c_f32_bf16 v114, v26, v2
  v_dot2c_f32_bf16 v115, v26, v3
  v_dot2c_f32_bf16 v116, v27, v2
  v_dot2c_f32_bf16 v117, v27, v3
  v_dot2c_f32_bf16 v118, v28, v2
  v_dot2c_f32_bf16 v119, v28, v3
  v_dot2c_f32_bf16 v120, v29, v2
  v_dot2c_f32_bf16 v121, v29, v3
  v_dot2c_f32_bf16 v122, v30, v2
  v_dot2c_f32_bf16 v123, v30, v3
  v_dot2c_f32_bf16 v124, v31, v2
  v_dot2c_f32_bf16 v125, v31, v3
  v_dot2c_f32_bf16 v126, v32, v2
  v_dot2c_f32_bf16 v127, v32, v3
  v_dot2c_f32_bf16 v128, v33, v2
  v_dot2c_f32_bf16 v129, v33, v3
  v_cvt_pk_bf16_f32 v0, v102, v214
  v_cvt_pk_bf16_f32 v1, v214, v102
  v_dot2c_f32_bf16 v112, v34, v0
  v_dot2c_f32_bf16 v113, v34, v1
  v_dot2c_f32_bf16 v114, v35, v0
  v_dot2c_f32_bf16 v115, v35, v1
  v_dot2c_f32_bf16 v116, v36, v0
  v_dot2c_f32_bf16 v117, v36, v1
  v_dot2c_f32_bf16 v118, v37, v0
  v_dot2c_f32_bf16 v119, v37, v1
  v_dot2c_f32_bf16 v120, v38, v0
  v_dot2c_f32_bf16 v121, v38, v1
  v_dot2c_f32_bf16 v122, v39, v0
  v_dot2c_f32_bf16 v123, v39, v1
  v_dot2c_f32_bf16 v124, v40, v0
  v_dot2c_f32_bf16 v125, v40, v1
  v_dot2c_f32_bf16 v126, v41, v0
  v_dot2c_f32_bf16 v127, v41, v1
  v_dot2c_f32_bf16 v128, v42, v0
  v_dot2c_f32_bf16 v129, v42, v1
  v_cvt_pk_bf16_f32 v2, v103, v214
  v_cvt_pk_bf16_f32 v3, v214, v103
  v_dot2c_f32_bf16 v112, v43, v2
  v_dot2c_f32_bf16 v113, v43, v3
  v_dot2c_f32_bf16 v114, v44, v2
  v_dot2c_f32_bf16 v115, v44, v3
  v_dot2c_f32_bf16 v116, v45, v2
  v_dot2c_f32_bf16 v117, v45, v3
  v_dot2c_f32_bf16 v118, v46, v2
  v_dot2c_f32_bf16 v119, v46, v3
  v_dot2c_f32_bf16 v120, v47, v2
  v_dot2c_f32_bf16 v121, v47, v3
  v_dot2c_f32_bf16 v122, v48, v2
  v_dot2c_f32_bf16 v123, v48, v3
  v_dot2c_f32_bf16 v124, v49, v2
  v_dot2c_f32_bf16 v125, v49, v3
  v_dot2c_f32_bf16 v126, v50, v2
  v_dot2c_f32_bf16 v127, v50, v3
  v_dot2c_f32_bf16 v128, v51, v2
  v_dot2c_f32_bf16 v129, v51, v3
  v_cvt_pk_bf16_f32 v0, v104, v214
  v_cvt_pk_bf16_f32 v1, v214, v104
  v_dot2c_f32_bf16 v112, v52, v0
  v_dot2c_f32_bf16 v113, v52, v1
  v_dot2c_f32_bf16 v114, v53, v0
  v_dot2c_f32_bf16 v115, v53, v1
  v_dot2c_f32_bf16 v116, v54, v0
  v_dot2c_f32_bf16 v117, v54, v1
  v_dot2c_f32_bf16 v118, v55, v0
  v_dot2c_f32_bf16 v119, v55, v1
  v_dot2c_f32_bf16 v120, v56, v0
  v_dot2c_f32_bf16 v121, v56, v1
  v_dot2c_f32_bf16 v122, v57, v0
  v_dot2c_f32_bf16 v123, v57, v1
  v_dot2c_f32_bf16 v124, v58, v0
  v_dot2c_f32_bf16 v125, v58, v1
  v_dot2c_f32_bf16 v126, v59, v0
  v_dot2c_f32_bf16 v127, v59, v1
  v_dot2c_f32_bf16 v128, v60, v0
  v_dot2c_f32_bf16 v129, v60, v1
  v_cvt_pk_bf16_f32 v2, v105, v214
  v_cvt_pk_bf16_f32 v3, v214, v105
  v_dot2c_f32_bf16 v112, v61, v2
  v_dot2c_f32_bf16 v113, v61, v3
  v_dot2c_f32_bf16 v114, v62, v2
  v_dot2c_f32_bf16 v115, v62, v3
  v_dot2c_f32_bf16 v116, v63, v2
  v_dot2c_f32_bf16 v117, v63, v3
  v_dot2c_f32_bf16 v118, v64, v2
  v_dot2c_f32_bf16 v119, v64, v3
  v_dot2c_f32_bf16 v120, v65, v2
  v_dot2c_f32_bf16 v121, v65, v3
  v_dot2c_f32_bf16 v122, v66, v2
  v_dot2c_f32_bf16 v123, v66, v3
  v_dot2c_f32_bf16 v124, v67, v2
  v_dot2c_f32_bf16 v125, v67, v3
  v_dot2c_f32_bf16 v126, v68, v2
  v_dot2c_f32_bf16 v127, v68, v3
  v_dot2c_f32_bf16 v128, v69, v2
  v_dot2c_f32_bf16 v129, v69, v3
  v_cvt_pk_bf16_f32 v0, v106, v214
  v_cvt_pk_bf16_f32 v1, v214, v106
  v_dot2c_f32_bf16 v112, v70, v0
  v_dot2c_f32_bf16 v113, v70, v1
  v_dot2c_f32_bf16 v114, v71, v0
  v_dot2c_f32_bf16 v115, v71, v1
  v_dot2c_f32_bf16 v116, v72, v0
  v_dot2c_f32_bf16 v117, v72, v1
  s_waitcnt lgkmcnt(14)
  v_dot2c_f32_bf16 v118, v73, v0
  v_dot2c_f32_bf16 v119, v73, v1
  s_waitcnt lgkmcnt(13)
  v_dot2c_f32_bf16 v120, v74, v0
  v_dot2c_f32_bf16 v121, v74, v1
  s_waitcnt lgkmcnt(12)
  v_dot2c_f32_bf16 v122, v75, v0
  v_dot2c_f32_bf16 v123, v75, v1
  s_waitcnt lgkmcnt(11)
  v_dot2c_f32_bf16 v124, v76, v0
  v_dot2c_f32_bf16 v125, v76, v1
  s_waitcnt lgkmcnt(10)
  v_dot2c_f32_bf16 v126, v77, v0
  v_dot2c_f32_bf16 v127, v77, v1
  s_waitcnt lgkmcnt(9)
  v_dot2c_f32_bf16 v128, v78, v0
  v_dot2c_f32_bf16 v129, v78, v1
  v_cvt_pk_bf16_f32 v2, v107, v214
  v_cvt_pk_bf16_f32 v3, v214, v107
  s_waitcnt lgkmcnt(8)
  v_dot2c_f32_bf16 v112, v79, v2
  v_dot2c_f32_bf16 v113, v79, v3
  s_waitcnt lgkmcnt(7)
  v_dot2c_f32_bf16 v114, v80, v2
  v_dot2c_f32_bf16 v115, v80, v3
  s_waitcnt lgkmcnt(6)
  v_dot2c_f32_bf16 v116, v81, v2
  v_dot2c_f32_bf16 v117, v81, v3
  s_waitcnt lgkmcnt(5)
  v_dot2c_f32_bf16 v118, v82, v2
  v_dot2c_f32_bf16 v119, v82, v3
  s_waitcnt lgkmcnt(4)
  v_dot2c_f32_bf16 v120, v83, v2
  v_dot2c_f32_bf16 v121, v83, v3
  s_waitcnt lgkmcnt(3)
  v_dot2c_f32_bf16 v122, v84, v2
  v_dot2c_f32_bf16 v123, v84, v3
  s_waitcnt lgkmcnt(2)
  v_dot2c_f32_bf16 v124, v85, v2
  v_dot2c_f32_bf16 v125, v85, v3
  s_waitcnt lgkmcnt(1)
  v_dot2c_f32_bf16 v126, v86, v2
  v_dot2c_f32_bf16 v127, v86, v3
  s_waitcnt lgkmcnt(0)
  v_dot2c_f32_bf16 v128, v87, v2
  v_dot2c_f32_bf16 v129, v87, v3
  v_cvt_pk_bf16_f32 v132, v112, v113
  v_cvt_pk_bf16_f32 v133, v114, v115
  v_cvt_pk_bf16_f32 v134, v116, v117
  v_cvt_pk_bf16_f32 v135, v118, v119
  v_cvt_pk_bf16_f32 v136, v120, v121
  v_cvt_pk_bf16_f32 v137, v122, v123
  v_cvt_pk_bf16_f32 v138, v124, v125
  v_cvt_pk_bf16_f32 v139, v126, v127
  v_cvt_pk_bf16_f32 v140, v128, v129
  ds_write_b32 v220, v132 offset:0
  ds_write_b32 v220, v133 offset:4
  ds_write_b32 v220, v134 offset:8
  ds_write_b32 v220, v135 offset:12
  ds_write_b32 v220, v136 offset:16
  ds_write_b32 v220, v137 offset:20
  ds_write_b32 v220, v138 offset:24
  ds_write_b32 v220, v139 offset:28
  ds_write_b32 v220, v140 offset:32
  s_waitcnt lgkmcnt(0)
  s_barrier
  ds_read_b128 v[144:147], v218 offset:0
  ds_read_b128 v[148:151], v218 offset:1024
  ds_read_b128 v[152:155], v218 offset:2048
  s_waitcnt lgkmcnt(2)
  buffer_store_dwordx4 v[144:147], v218, s[8:11], s64 offen offset:0 sc1
  s_waitcnt lgkmcnt(1)
  buffer_store_dwordx4 v[148:151], v218, s[8:11], s64 offen offset:1024 sc1
  s_waitcnt lgkmcnt(0)
  buffer_store_dwordx4 v[152:155], v218, s[8:11], s64 offen offset:2048 sc1
  v_add_u32 v219, 33024, v219
  s_add_u32 s66, s66, 64
  s_add_u32 s64, s64, 9216
  ds_read_b32 v0, v219 offset:7224
  ds_read_b32 v1, v219 offset:7228
  ds_read_b32 v2, v219 offset:7232
  ds_read_b32 v3, v219 offset:7236
  ds_read_b32 v4, v219 offset:7240
  ds_read_b32 v5, v219 offset:7244
  ds_read_b32 v6, v219 offset:7248
  ds_read_b32 v7, v219 offset:7252
  ds_read_b32 v8, v219 offset:7256
  ds_read_b32 v16, v219 offset:7368
  ds_read_b32 v17, v219 offset:7372
  ds_read_b32 v18, v219 offset:7376
  ds_read_b32 v19, v219 offset:7380
  ds_read_b32 v20, v219 offset:7384
  ds_read_b32 v21, v219 offset:7388
  ds_read_b32 v22, v219 offset:7392
  ds_read_b32 v23, v219 offset:7396
  ds_read_b32 v24, v219 offset:7400
  ds_read_b32 v25, v219 offset:6336
  ds_read_b32 v26, v219 offset:6340
  ds_read_b32 v27, v219 offset:6344
  ds_read_b32 v28, v219 offset:6348
  ds_read_b32 v29, v219 offset:6352
  ds_read_b32 v30, v219 offset:6356
  ds_read_b32 v31, v219 offset:6360
  ds_read_b32 v32, v219 offset:6364
  ds_read_b32 v33, v219 offset:6368
  ds_read_b32 v34, v219 offset:5304
  ds_read_b32 v35, v219 offset:5308
  ds_read_b32 v36, v219 offset:5312
  ds_read_b32 v37, v219 offset:5316
  ds_read_b32 v38, v219 offset:5320
  ds_read_b32 v39, v219 offset:5324
  ds_read_b32 v40, v219 offset:5328
  ds_read_b32 v41, v219 offset:5332
  ds_read_b32 v42, v219 offset:5336
  ds_read_b32 v43, v219 offset:4272
  ds_read_b32 v44, v219 offset:4276
  ds_read_b32 v45, v219 offset:4280
  ds_read_b32 v46, v219 offset:4284
  ds_read_b32 v47, v219 offset:4288
  ds_read_b32 v48, v219 offset:4292
  ds_read_b32 v49, v219 offset:4296
  ds_read_b32 v50, v219 offset:4300
  ds_read_b32 v51, v219 offset:4304
  ds_read_b32 v52, v219 offset:3240
  ds_read_b32 v53, v219 offset:3244
  ds_read_b32 v54, v219 offset:3248
  ds_read_b32 v55, v219 offset:3252
  ds_read_b32 v56, v219 offset:3256
  ds_read_b32 v57, v219 offset:3260
  ds_read_b32 v58, v219 offset:3264
  ds_read_b32 v59, v219 offset:3268
  ds_read_b32 v60, v219 offset:3272
  ds_read_b32 v61, v219 offset:2208
  ds_read_b32 v62, v219 offset:2212
  ds_read_b32 v63, v219 offset:2216
  ds_read_b32 v64, v219 offset:2220
  ds_read_b32 v65, v219 offset:2224
  ds_read_b32 v66, v219 offset:2228
  ds_read_b32 v67, v219 offset:2232
  ds_read_b32 v68, v219 offset:2236
  ds_read_b32 v69, v219 offset:2240
  ds_read_b32 v70, v219 offset:1176
  ds_read_b32 v71, v219 offset:1180
  ds_read_b32 v72, v219 offset:1184
  ds_read_b32 v73, v219 offset:1188
  ds_read_b32 v74, v219 offset:1192
  ds_read_b32 v75, v219 offset:1196
  ds_read_b32 v76, v219 offset:1200
  ds_read_b32 v77, v219 offset:1204
  ds_read_b32 v78, v219 offset:1208
  ds_read_b32 v79, v219 offset:144
  ds_read_b32 v80, v219 offset:148
  ds_read_b32 v81, v219 offset:152
  ds_read_b32 v82, v219 offset:156
  ds_read_b32 v83, v219 offset:160
  ds_read_b32 v84, v219 offset:164
  ds_read_b32 v85, v219 offset:168
  ds_read_b32 v86, v219 offset:172
  ds_read_b32 v87, v219 offset:176
  v_mov_b32 v100, 0
  v_mov_b32 v101, 0
  v_mov_b32 v102, 0
  v_mov_b32 v103, 0
  v_mov_b32 v104, 0
  v_mov_b32 v105, 0
  v_mov_b32 v106, 0
  v_mov_b32 v107, 0
  s_waitcnt lgkmcnt(15)
  v_dot2c_f32_bf16 v100, v0, v16
  v_dot2c_f32_bf16 v101, v0, v25
  v_dot2c_f32_bf16 v102, v0, v34
  v_dot2c_f32_bf16 v103, v0, v43
  v_dot2c_f32_bf16 v104, v0, v52
  v_dot2c_f32_bf16 v105, v0, v61
  v_dot2c_f32_bf16 v106, v0, v70
  s_waitcnt lgkmcnt(8)
  v_dot2c_f32_bf16 v107, v0, v79
  v_dot2c_f32_bf16 v100, v1, v17
  v_dot2c_f32_bf16 v101, v1, v26
  v_dot2c_f32_bf16 v102, v1, v35
  v_dot2c_f32_bf16 v103, v1, v44
  v_dot2c_f32_bf16 v104, v1, v53
  v_dot2c_f32_bf16 v105, v1, v62
  v_dot2c_f32_bf16 v106, v1, v71
  s_waitcnt lgkmcnt(7)
  v_dot2c_f32_bf16 v107, v1, v80
  v_dot2c_f32_bf16 v100, v2, v18
  v_dot2c_f32_bf16 v101, v2, v27
  v_dot2c_f32_bf16 v102, v2, v36
  v_dot2c_f32_bf16 v103, v2, v45
  v_dot2c_f32_bf16 v104, v2, v54
  v_dot2c_f32_bf16 v105, v2, v63
  v_dot2c_f32_bf16 v106, v2, v72
  s_waitcnt lgkmcnt(6)
  v_dot2c_f32_bf16 v107, v2, v81
  v_dot2c_f32_bf16 v100, v3, v19
  v_dot2c_f32_bf16 v101, v3, v28
  v_dot2c_f32_bf16 v102, v3, v37
  v_dot2c_f32_bf16 v103, v3, v46
  v_dot2c_f32_bf16 v104, v3, v55
  v_dot2c_f32_bf16 v105, v3, v64
  v_dot2c_f32_bf16 v106, v3, v73
  s_waitcnt lgkmcnt(5)
  v_dot2c_f32_bf16 v107, v3, v82
  v_dot2c_f32_bf16 v100, v4, v20
  v_dot2c_f32_bf16 v101, v4, v29
  v_dot2c_f32_bf16 v102, v4, v38
  v_dot2c_f32_bf16 v103, v4, v47
  v_dot2c_f32_bf16 v104, v4, v56
  v_dot2c_f32_bf16 v105, v4, v65
  v_dot2c_f32_bf16 v106, v4, v74
  s_waitcnt lgkmcnt(4)
  v_dot2c_f32_bf16 v107, v4, v83
  v_dot2c_f32_bf16 v100, v5, v21
  v_dot2c_f32_bf16 v101, v5, v30
  v_dot2c_f32_bf16 v102, v5, v39
  v_dot2c_f32_bf16 v103, v5, v48
  v_dot2c_f32_bf16 v104, v5, v57
  v_dot2c_f32_bf16 v105, v5, v66
  v_dot2c_f32_bf16 v106, v5, v75
  s_waitcnt lgkmcnt(3)
  v_dot2c_f32_bf16 v107, v5, v84
  v_dot2c_f32_bf16 v100, v6, v22
  v_dot2c_f32_bf16 v101, v6, v31
  v_dot2c_f32_bf16 v102, v6, v40
  v_dot2c_f32_bf16 v103, v6, v49
  v_dot2c_f32_bf16 v104, v6, v58
  v_dot2c_f32_bf16 v105, v6, v67
  v_dot2c_f32_bf16 v106, v6, v76
  s_waitcnt lgkmcnt(2)
  v_dot2c_f32_bf16 v107, v6, v85
  v_dot2c_f32_bf16 v100, v7, v23
  v_dot2c_f32_bf16 v101, v7, v32
  v_dot2c_f32_bf16 v102, v7, v41
  v_dot2c_f32_bf16 v103, v7, v50
  v_dot2c_f32_bf16 v104, v7, v59
  v_dot2c_f32_bf16 v105, v7, v68
  v_dot2c_f32_bf16 v106, v7, v77
  s_waitcnt lgkmcnt(1)
  v_dot2c_f32_bf16 v107, v7, v86
  v_dot2c_f32_bf16 v100, v8, v24
  v_dot2c_f32_bf16 v101, v8, v33
  v_dot2c_f32_bf16 v102, v8, v42
  v_dot2c_f32_bf16 v103, v8, v51
  v_dot2c_f32_bf16 v104, v8, v60
  v_dot2c_f32_bf16 v105, v8, v69
  v_dot2c_f32_bf16 v106, v8, v78
  s_waitcnt lgkmcnt(0)
  v_dot2c_f32_bf16 v107, v8, v87
  ds_read_b32 v16, v219 offset:7512
  ds_read_b32 v17, v219 offset:7516
  ds_read_b32 v18, v219 offset:7520
  ds_read_b32 v19, v219 offset:7524
  ds_read_b32 v20, v219 offset:7528
  ds_read_b32 v21, v219 offset:7532
  ds_read_b32 v22, v219 offset:7536
  ds_read_b32 v23, v219 offset:7540
  ds_read_b32 v24, v219 offset:7544
  ds_read_b32 v25, v219 offset:6480
  ds_read_b32 v26, v219 offset:6484
  ds_read_b32 v27, v219 offset:6488
  ds_read_b32 v28, v219 offset:6492
  ds_read_b32 v29, v219 offset:6496
  ds_read_b32 v30, v219 offset:6500
  ds_read_b32 v31, v219 offset:6504
  ds_read_b32 v32, v219 offset:6508
  ds_read_b32 v33, v219 offset:6512
  ds_read_b32 v34, v219 offset:5448
  ds_read_b32 v35, v219 offset:5452
  ds_read_b32 v36, v219 offset:5456
  ds_read_b32 v37, v219 offset:5460
  ds_read_b32 v38, v219 offset:5464
  ds_read_b32 v39, v219 offset:5468
  ds_read_b32 v40, v219 offset:5472
  ds_read_b32 v41, v219 offset:5476
  ds_read_b32 v42, v219 offset:5480
  ds_read_b32 v43, v219 offset:4416
  ds_read_b32 v44, v219 offset:4420
  ds_read_b32 v45, v219 offset:4424
  ds_read_b32 v46, v219 offset:4428
  ds_read_b32 v47, v219 offset:4432
  ds_read_b32 v48, v219 offset:4436
  ds_read_b32 v49, v219 offset:4440
  ds_read_b32 v50, v219 offset:4444
  ds_read_b32 v51, v219 offset:4448
  ds_read_b32 v52, v219 offset:3384
  ds_read_b32 v53, v219 offset:3388
  ds_read_b32 v54, v219 offset:3392
  ds_read_b32 v55, v219 offset:3396
  ds_read_b32 v56, v219 offset:3400
  ds_read_b32 v57, v219 offset:3404
  ds_read_b32 v58, v219 offset:3408
  ds_read_b32 v59, v219 offset:3412
  ds_read_b32 v60, v219 offset:3416
  ds_read_b32 v61, v219 offset:2352
  ds_read_b32 v62, v219 offset:2356
  ds_read_b32 v63, v219 offset:2360
  ds_read_b32 v64, v219 offset:2364
  ds_read_b32 v65, v219 offset:2368
  ds_read_b32 v66, v219 offset:2372
  ds_read_b32 v67, v219 offset:2376
  ds_read_b32 v68, v219 offset:2380
  ds_read_b32 v69, v219 offset:2384
  ds_read_b32 v70, v219 offset:1320
  ds_read_b32 v71, v219 offset:1324
  ds_read_b32 v72, v219 offset:1328
  ds_read_b32 v73, v219 offset:1332
  ds_read_b32 v74, v219 offset:1336
  ds_read_b32 v75, v219 offset:1340
  ds_read_b32 v76, v219 offset:1344
  ds_read_b32 v77, v219 offset:1348
  ds_read_b32 v78, v219 offset:1352
  ds_read_b32 v79, v219 offset:288
  ds_read_b32 v80, v219 offset:292
  ds_read_b32 v81, v219 offset:296
  ds_read_b32 v82, v219 offset:300
  ds_read_b32 v83, v219 offset:304
  ds_read_b32 v84, v219 offset:308
  ds_read_b32 v85, v219 offset:312
  ds_read_b32 v86, v219 offset:316
  ds_read_b32 v87, v219 offset:320
  v_add_u32 v211, s66, v200
  v_mov_b32 v212, 0xf149f2ca
  v_mul_f32 v100, s57, v100
  v_mul_f32 v101, s57, v101
  v_mul_f32 v102, s57, v102
  v_mul_f32 v103, s57, v103
  v_mul_f32 v104, s57, v104
  v_mul_f32 v105, s57, v105
  v_mul_f32 v106, s57, v106
  v_mul_f32 v107, s57, v107
  v_cmp_gt_u32 vcc, 2, v211
  s_nop 1
  v_cndmask_b32 v101, v101, v212, vcc
  v_cmp_gt_u32 vcc, 4, v211
  s_nop 1
  v_cndmask_b32 v102, v102, v212, vcc
  v_cmp_gt_u32 vcc, 6, v211
  s_nop 1
  v_cndmask_b32 v103, v103, v212, vcc
  v_cmp_gt_u32 vcc, 8, v211
  s_nop 1
  v_cndmask_b32 v104, v104, v212, vcc
  v_cmp_gt_u32 vcc, 10, v211
  s_nop 1
  v_cndmask_b32 v105, v105, v212, vcc
  v_cmp_gt_u32 vcc, 12, v211
  s_nop 1
  v_cndmask_b32 v106, v106, v212, vcc
  v_cmp_gt_u32 vcc, 14, v211
  s_nop 1
  v_cndmask_b32 v107, v107, v212, vcc
  v_max3_f32 v213, v100, v101, v102
  v_max3_f32 v213, v213, v103, v104
  v_max3_f32 v213, v213, v105, v106
  v_max_f32 v213, v213, v107
  v_sub_f32 v100, v100, v213
  v_sub_f32 v101, v101, v213
  v_sub_f32 v102, v102, v213
  v_sub_f32 v103, v103, v213
  v_sub_f32 v104, v104, v213
  v_sub_f32 v105, v105, v213
  v_sub_f32 v106, v106, v213
  v_sub_f32 v107, v107, v213
  v_exp_f32 v100, v100
  v_exp_f32 v101, v101
  v_exp_f32 v102, v102
  v_exp_f32 v103, v103
  v_exp_f32 v104, v104
  v_exp_f32 v105, v105
  v_exp_f32 v106, v106
  v_exp_f32 v107, v107
  v_add_f32 v213, v100, v101
  v_add_f32 v213, v213, v102
  v_add_f32 v213, v213, v103
  v_add_f32 v213, v213, v104
  v_add_f32 v213, v213, v105
  v_add_f32 v213, v213, v106
  v_add_f32 v213, v213, v107
  v_rcp_f32 v213, v213
  v_mov_b32 v214, 0
  v_mul_f32 v100, v213, v100
  v_mul_f32 v101, v213, v101
  v_mul_f32 v102, v213, v102
  v_mul_f32 v103, v213, v103
  v_mul_f32 v104, v213, v104
  v_mul_f32 v105, v213, v105
  v_mul_f32 v106, v213, v106
  v_mul_f32 v107, v213, v107
  v_mov_b32 v112, 0
  v_mov_b32 v113, 0
  v_mov_b32 v114, 0
  v_mov_b32 v115, 0
  v_mov_b32 v116, 0
  v_mov_b32 v117, 0
  v_mov_b32 v118, 0
  v_mov_b32 v119, 0
  v_mov_b32 v120, 0
  v_mov_b32 v121, 0
  v_mov_b32 v122, 0
  v_mov_b32 v123, 0
  v_mov_b32 v124, 0
  v_mov_b32 v125, 0
  v_mov_b32 v126, 0
  v_mov_b32 v127, 0
  v_mov_b32 v128, 0
  v_mov_b32 v129, 0
  v_cvt_pk_bf16_f32 v0, v100, v214
  v_cvt_pk_bf16_f32 v1, v214, v100
  s_waitcnt lgkmcnt(15)
  v_dot2c_f32_bf16 v112, v16, v0
  v_dot2c_f32_bf16 v113, v16, v1
  v_dot2c_f32_bf16 v114, v17, v0
  v_dot2c_f32_bf16 v115, v17, v1
  v_dot2c_f32_bf16 v116, v18, v0
  v_dot2c_f32_bf16 v117, v18, v1
  v_dot2c_f32_bf16 v118, v19, v0
  v_dot2c_f32_bf16 v119, v19, v1
  v_dot2c_f32_bf16 v120, v20, v0
  v_dot2c_f32_bf16 v121, v20, v1
  v_dot2c_f32_bf16 v122, v21, v0
  v_dot2c_f32_bf16 v123, v21, v1
  v_dot2c_f32_bf16 v124, v22, v0
  v_dot2c_f32_bf16 v125, v22, v1
  v_dot2c_f32_bf16 v126, v23, v0
  v_dot2c_f32_bf16 v127, v23, v1
  v_dot2c_f32_bf16 v128, v24, v0
  v_dot2c_f32_bf16 v129, v24, v1
  v_cvt_pk_bf16_f32 v2, v101, v214
  v_cvt_pk_bf16_f32 v3, v214, v101
  v_dot2c_f32_bf16 v112, v25, v2
  v_dot2c_f32_bf16 v113, v25, v3
  v_dot2c_f32_bf16 v114, v26, v2
  v_dot2c_f32_bf16 v115, v26, v3
  v_dot2c_f32_bf16 v116, v27, v2
  v_dot2c_f32_bf16 v117, v27, v3
  v_dot2c_f32_bf16 v118, v28, v2
  v_dot2c_f32_bf16 v119, v28, v3
  v_dot2c_f32_bf16 v120, v29, v2
  v_dot2c_f32_bf16 v121, v29, v3
  v_dot2c_f32_bf16 v122, v30, v2
  v_dot2c_f32_bf16 v123, v30, v3
  v_dot2c_f32_bf16 v124, v31, v2
  v_dot2c_f32_bf16 v125, v31, v3
  v_dot2c_f32_bf16 v126, v32, v2
  v_dot2c_f32_bf16 v127, v32, v3
  v_dot2c_f32_bf16 v128, v33, v2
  v_dot2c_f32_bf16 v129, v33, v3
  v_cvt_pk_bf16_f32 v0, v102, v214
  v_cvt_pk_bf16_f32 v1, v214, v102
  v_dot2c_f32_bf16 v112, v34, v0
  v_dot2c_f32_bf16 v113, v34, v1
  v_dot2c_f32_bf16 v114, v35, v0
  v_dot2c_f32_bf16 v115, v35, v1
  v_dot2c_f32_bf16 v116, v36, v0
  v_dot2c_f32_bf16 v117, v36, v1
  v_dot2c_f32_bf16 v118, v37, v0
  v_dot2c_f32_bf16 v119, v37, v1
  v_dot2c_f32_bf16 v120, v38, v0
  v_dot2c_f32_bf16 v121, v38, v1
  v_dot2c_f32_bf16 v122, v39, v0
  v_dot2c_f32_bf16 v123, v39, v1
  v_dot2c_f32_bf16 v124, v40, v0
  v_dot2c_f32_bf16 v125, v40, v1
  v_dot2c_f32_bf16 v126, v41, v0
  v_dot2c_f32_bf16 v127, v41, v1
  v_dot2c_f32_bf16 v128, v42, v0
  v_dot2c_f32_bf16 v129, v42, v1
  v_cvt_pk_bf16_f32 v2, v103, v214
  v_cvt_pk_bf16_f32 v3, v214, v103
  v_dot2c_f32_bf16 v112, v43, v2
  v_dot2c_f32_bf16 v113, v43, v3
  v_dot2c_f32_bf16 v114, v44, v2
  v_dot2c_f32_bf16 v115, v44, v3
  v_dot2c_f32_bf16 v116, v45, v2
  v_dot2c_f32_bf16 v117, v45, v3
  v_dot2c_f32_bf16 v118, v46, v2
  v_dot2c_f32_bf16 v119, v46, v3
  v_dot2c_f32_bf16 v120, v47, v2
  v_dot2c_f32_bf16 v121, v47, v3
  v_dot2c_f32_bf16 v122, v48, v2
  v_dot2c_f32_bf16 v123, v48, v3
  v_dot2c_f32_bf16 v124, v49, v2
  v_dot2c_f32_bf16 v125, v49, v3
  v_dot2c_f32_bf16 v126, v50, v2
  v_dot2c_f32_bf16 v127, v50, v3
  v_dot2c_f32_bf16 v128, v51, v2
  v_dot2c_f32_bf16 v129, v51, v3
  v_cvt_pk_bf16_f32 v0, v104, v214
  v_cvt_pk_bf16_f32 v1, v214, v104
  v_dot2c_f32_bf16 v112, v52, v0
  v_dot2c_f32_bf16 v113, v52, v1
  v_dot2c_f32_bf16 v114, v53, v0
  v_dot2c_f32_bf16 v115, v53, v1
  v_dot2c_f32_bf16 v116, v54, v0
  v_dot2c_f32_bf16 v117, v54, v1
  v_dot2c_f32_bf16 v118, v55, v0
  v_dot2c_f32_bf16 v119, v55, v1
  v_dot2c_f32_bf16 v120, v56, v0
  v_dot2c_f32_bf16 v121, v56, v1
  v_dot2c_f32_bf16 v122, v57, v0
  v_dot2c_f32_bf16 v123, v57, v1
  v_dot2c_f32_bf16 v124, v58, v0
  v_dot2c_f32_bf16 v125, v58, v1
  v_dot2c_f32_bf16 v126, v59, v0
  v_dot2c_f32_bf16 v127, v59, v1
  v_dot2c_f32_bf16 v128, v60, v0
  v_dot2c_f32_bf16 v129, v60, v1
  v_cvt_pk_bf16_f32 v2, v105, v214
  v_cvt_pk_bf16_f32 v3, v214, v105
  v_dot2c_f32_bf16 v112, v61, v2
  v_dot2c_f32_bf16 v113, v61, v3
  v_dot2c_f32_bf16 v114, v62, v2
  v_dot2c_f32_bf16 v115, v62, v3
  v_dot2c_f32_bf16 v116, v63, v2
  v_dot2c_f32_bf16 v117, v63, v3
  v_dot2c_f32_bf16 v118, v64, v2
  v_dot2c_f32_bf16 v119, v64, v3
  v_dot2c_f32_bf16 v120, v65, v2
  v_dot2c_f32_bf16 v121, v65, v3
  v_dot2c_f32_bf16 v122, v66, v2
  v_dot2c_f32_bf16 v123, v66, v3
  v_dot2c_f32_bf16 v124, v67, v2
  v_dot2c_f32_bf16 v125, v67, v3
  v_dot2c_f32_bf16 v126, v68, v2
  v_dot2c_f32_bf16 v127, v68, v3
  v_dot2c_f32_bf16 v128, v69, v2
  v_dot2c_f32_bf16 v129, v69, v3
  v_cvt_pk_bf16_f32 v0, v106, v214
  v_cvt_pk_bf16_f32 v1, v214, v106
  v_dot2c_f32_bf16 v112, v70, v0
  v_dot2c_f32_bf16 v113, v70, v1
  v_dot2c_f32_bf16 v114, v71, v0
  v_dot2c_f32_bf16 v115, v71, v1
  v_dot2c_f32_bf16 v116, v72, v0
  v_dot2c_f32_bf16 v117, v72, v1
  s_waitcnt lgkmcnt(14)
  v_dot2c_f32_bf16 v118, v73, v0
  v_dot2c_f32_bf16 v119, v73, v1
  s_waitcnt lgkmcnt(13)
  v_dot2c_f32_bf16 v120, v74, v0
  v_dot2c_f32_bf16 v121, v74, v1
  s_waitcnt lgkmcnt(12)
  v_dot2c_f32_bf16 v122, v75, v0
  v_dot2c_f32_bf16 v123, v75, v1
  s_waitcnt lgkmcnt(11)
  v_dot2c_f32_bf16 v124, v76, v0
  v_dot2c_f32_bf16 v125, v76, v1
  s_waitcnt lgkmcnt(10)
  v_dot2c_f32_bf16 v126, v77, v0
  v_dot2c_f32_bf16 v127, v77, v1
  s_waitcnt lgkmcnt(9)
  v_dot2c_f32_bf16 v128, v78, v0
  v_dot2c_f32_bf16 v129, v78, v1
  v_cvt_pk_bf16_f32 v2, v107, v214
  v_cvt_pk_bf16_f32 v3, v214, v107
  s_waitcnt lgkmcnt(8)
  v_dot2c_f32_bf16 v112, v79, v2
  v_dot2c_f32_bf16 v113, v79, v3
  s_waitcnt lgkmcnt(7)
  v_dot2c_f32_bf16 v114, v80, v2
  v_dot2c_f32_bf16 v115, v80, v3
  s_waitcnt lgkmcnt(6)
  v_dot2c_f32_bf16 v116, v81, v2
  v_dot2c_f32_bf16 v117, v81, v3
  s_waitcnt lgkmcnt(5)
  v_dot2c_f32_bf16 v118, v82, v2
  v_dot2c_f32_bf16 v119, v82, v3
  s_waitcnt lgkmcnt(4)
  v_dot2c_f32_bf16 v120, v83, v2
  v_dot2c_f32_bf16 v121, v83, v3
  s_waitcnt lgkmcnt(3)
  v_dot2c_f32_bf16 v122, v84, v2
  v_dot2c_f32_bf16 v123, v84, v3
  s_waitcnt lgkmcnt(2)
  v_dot2c_f32_bf16 v124, v85, v2
  v_dot2c_f32_bf16 v125, v85, v3
  s_waitcnt lgkmcnt(1)
  v_dot2c_f32_bf16 v126, v86, v2
  v_dot2c_f32_bf16 v127, v86, v3
  s_waitcnt lgkmcnt(0)
  v_dot2c_f32_bf16 v128, v87, v2
  v_dot2c_f32_bf16 v129, v87, v3
  v_cvt_pk_bf16_f32 v132, v112, v113
  v_cvt_pk_bf16_f32 v133, v114, v115
  v_cvt_pk_bf16_f32 v134, v116, v117
  v_cvt_pk_bf16_f32 v135, v118, v119
  v_cvt_pk_bf16_f32 v136, v120, v121
  v_cvt_pk_bf16_f32 v137, v122, v123
  v_cvt_pk_bf16_f32 v138, v124, v125
  v_cvt_pk_bf16_f32 v139, v126, v127
  v_cvt_pk_bf16_f32 v140, v128, v129
  ds_write_b32 v220, v132 offset:16384
  ds_write_b32 v220, v133 offset:16388
  ds_write_b32 v220, v134 offset:16392
  ds_write_b32 v220, v135 offset:16396
  ds_write_b32 v220, v136 offset:16400
  ds_write_b32 v220, v137 offset:16404
  ds_write_b32 v220, v138 offset:16408
  ds_write_b32 v220, v139 offset:16412
  ds_write_b32 v220, v140 offset:16416
  s_waitcnt lgkmcnt(0)
  s_barrier
  ds_read_b128 v[144:147], v218 offset:16384
  ds_read_b128 v[148:151], v218 offset:17408
  ds_read_b128 v[152:155], v218 offset:18432
  s_waitcnt lgkmcnt(2)
  buffer_store_dwordx4 v[144:147], v218, s[8:11], s64 offen offset:0 sc1
  s_waitcnt lgkmcnt(1)
  buffer_store_dwordx4 v[148:151], v218, s[8:11], s64 offen offset:1024 sc1
  s_waitcnt lgkmcnt(0)
  buffer_store_dwordx4 v[152:155], v218, s[8:11], s64 offen offset:2048 sc1
  s_mov_b32 s56, 36
  s_waitcnt vmcnt(0)
  s_barrier
  s_cmp_eq_u32 s52, 0
  s_cbranch_scc0 A_sig
  v_mov_b32 v211, 1
  v_mov_b32 v212, 0
  s_mov_b64 exec, 1
  buffer_atomic_add v211, v212, s[12:15], s56 offen
  s_mov_b64 exec, -1
A_sig:
W_o:
  s_and_b32 s54, s53, 31
  s_mul_i32 s68, s54, 57
  s_lshr_b32 s68, s68, 9
  s_mul_i32 s56, s68, 9
  s_sub_u32 s70, s54, s56
  s_bfe_u32 s55, s53, 0x10005
  s_mul_i32 s55, s55, 9
  s_add_u32 s70, s70, s55
  s_bfe_u32 s69, s53, 0x10006
  s_lshr_b32 s55, s53, 5
  s_mul_i32 s56, s55, 5
  s_add_u32 s56, s56, s54
  s_sub_u32 s56, s56, 37
  s_add_u32 s57, s54, 20
  s_cmp_eq_u32 s55, 6
  s_cselect_b32 s56, s57, s56
  s_cselect_b32 s68, 3, s68
  s_cmp_ge_u32 s56, 18
  s_cselect_b32 s55, 1, 0
  s_cselect_b32 s57, 18, 0
  s_sub_u32 s56, s56, s57
  s_cmp_eq_u32 s68, 3
  s_cselect_b32 s69, s55, s69
  s_cselect_b32 s70, s56, s70
  v_lshrrev_b32 v211, 2, v200
  v_mul_u32_u24 v211, 1152, v211
  v_and_b32 v212, 3, v200
  v_lshl_add_u32 v207, v212, 4, v211
  s_lshl_b32 s54, s70, 6
  s_mul_i32 s55, s52, 1179648
  s_add_u32 s62, s54, s55
  s_mul_i32 s55, s52, 184320
  s_add_u32 s63, s54, s55
  s_mul_i32 s61, s52, 40960
  v_bfe_u32 v211, v200, 2, 2
  v_lshlrev_b32 v212, 4, v212
  v_add_u32 v212, s61, v212
  v_lshl_add_u32 v212, v211, 6, v212
  v_lshrrev_b32 v213, 4, v200
  v_lshl_add_u32 v210, v213, 9, v212
  v_lshrrev_b32 v214, 5, v200
  v_lshl_add_u32 v209, v214, 10, v212
  v_and_b32 v214, 1, v213
  v_lshl_add_u32 v209, v214, 8, v209
  s_add_u32 m0, s61, 0
  s_add_u32 s54, s62, 0
  buffer_load_dwordx4 v207, s[28:31], s54 offen lds
  s_add_u32 m0, s61, 1024
  s_add_u32 s54, s62, 18432
  buffer_load_dwordx4 v207, s[28:31], s54 offen lds
  s_add_u32 m0, s61, 2048
  s_add_u32 s54, s62, 36864
  buffer_load_dwordx4 v207, s[28:31], s54 offen lds
  s_add_u32 m0, s61, 3072
  s_add_u32 s54, s62, 55296
  buffer_load_dwordx4 v207, s[28:31], s54 offen lds
  s_add_u32 m0, s61, 4096
  s_add_u32 s54, s62, 73728
  buffer_load_dwordx4 v207, s[28:31], s54 offen lds
  s_add_u32 m0, s61, 5120
  s_add_u32 s54, s62, 92160
  buffer_load_dwordx4 v207, s[28:31], s54 offen lds
  s_add_u32 m0, s61, 6144
  s_add_u32 s54, s62, 110592
  buffer_load_dwordx4 v207, s[28:31], s54 offen lds
  s_add_u32 m0, s61, 7168
  s_add_u32 s54, s62, 129024
  buffer_load_dwordx4 v207, s[28:31], s54 offen lds
  s_add_u32 m0, s61, 8192
  s_add_u32 s54, s62, 147456
  buffer_load_dwordx4 v207, s[28:31], s54 offen lds
  s_add_u32 m0, s61, 9216
  s_add_u32 s54, s62, 165888
  buffer_load_dwordx4 v207, s[28:31], s54 offen lds
  s_add_u32 m0, s61, 10240
  s_add_u32 s54, s62, 184320
  buffer_load_dwordx4 v207, s[28:31], s54 offen lds
  s_add_u32 m0, s61, 11264
  s_add_u32 s54, s62, 202752
  buffer_load_dwordx4 v207, s[28:31], s54 offen lds
  s_add_u32 m0, s61, 12288
  s_add_u32 s54, s62, 221184
  buffer_load_dwordx4 v207, s[28:31], s54 offen lds
  s_add_u32 m0, s61, 13312
  s_add_u32 s54, s62, 239616
  buffer_load_dwordx4 v207, s[28:31], s54 offen lds
  s_add_u32 m0, s61, 14336
  s_add_u32 s54, s62, 258048
  buffer_load_dwordx4 v207, s[28:31], s54 offen lds
  s_add_u32 m0, s61, 15360
  s_add_u32 s54, s62, 276480
  buffer_load_dwordx4 v207, s[28:31], s54 offen lds
  s_add_u32 m0, s61, 16384
  s_add_u32 s54, s62, 294912
  buffer_load_dwordx4 v207, s[28:31], s54 offen lds
  s_add_u32 m0, s61, 17408
  s_add_u32 s54, s62, 313344
  buffer_load_dwordx4 v207, s[28:31], s54 offen lds
  s_add_u32 m0, s61, 18432
  s_add_u32 s54, s62, 331776
  buffer_load_dwordx4 v207, s[28:31], s54 offen lds
  s_add_u32 m0, s61, 19456
  s_add_u32 s54, s62, 350208
  buffer_load_dwordx4 v207, s[28:31], s54 offen lds
  s_add_u32 m0, s61, 20480
  s_add_u32 s54, s62, 368640
  buffer_load_dwordx4 v207, s[28:31], s54 offen lds
  s_add_u32 m0, s61, 21504
  s_add_u32 s54, s62, 387072
  buffer_load_dwordx4 v207, s[28:31], s54 offen lds
  s_add_u32 m0, s61, 22528
  s_add_u32 s54, s62, 405504
  buffer_load_dwordx4 v207, s[28:31], s54 offen lds
  s_add_u32 m0, s61, 23552
  s_add_u32 s54, s62, 423936
  buffer_load_dwordx4 v207, s[28:31], s54 offen lds
  s_add_u32 m0, s61, 24576
  s_add_u32 s54, s62, 442368
  buffer_load_dwordx4 v207, s[28:31], s54 offen lds
  s_add_u32 m0, s61, 25600
  s_add_u32 s54, s62, 460800
  buffer_load_dwordx4 v207, s[28:31], s54 offen lds
  s_add_u32 m0, s61, 26624
  s_add_u32 s54, s62, 479232
  buffer_load_dwordx4 v207, s[28:31], s54 offen lds
  s_add_u32 m0, s61, 27648
  s_add_u32 s54, s62, 497664
  buffer_load_dwordx4 v207, s[28:31], s54 offen lds
  s_add_u32 m0, s61, 28672
  s_add_u32 s54, s62, 516096
  buffer_load_dwordx4 v207, s[28:31], s54 offen lds
  s_add_u32 m0, s61, 29696
  s_add_u32 s54, s62, 534528
  buffer_load_dwordx4 v207, s[28:31], s54 offen lds
  s_add_u32 m0, s61, 30720
  s_add_u32 s54, s62, 552960
  buffer_load_dwordx4 v207, s[28:31], s54 offen lds
  s_add_u32 m0, s61, 31744
  s_add_u32 s54, s62, 571392
  buffer_load_dwordx4 v207, s[28:31], s54 offen lds
  s_add_u32 m0, s61, 32768
  s_add_u32 s54, s62, 589824
  buffer_load_dwordx4 v207, s[28:31], s54 offen lds
  s_add_u32 m0, s61, 33792
  s_add_u32 s54, s62, 608256
  buffer_load_dwordx4 v207, s[28:31], s54 offen lds
  s_add_u32 m0, s61, 34816
  s_add_u32 s54, s62, 626688
  buffer_load_dwordx4 v207, s[28:31], s54 offen lds
  s_add_u32 m0, s61, 35840
  s_add_u32 s54, s62, 645120
  buffer_load_dwordx4 v207, s[28:31], s54 offen lds
  s_add_u32 m0, s61, 36864
  s_add_u32 s54, s62, 663552
  buffer_load_dwordx4 v207, s[28:31], s54 offen lds
  s_add_u32 m0, s61, 37888
  s_add_u32 s54, s62, 681984
  buffer_load_dwordx4 v207, s[28:31], s54 offen lds
  s_waitcnt vmcnt(36) lgkmcnt(0)
  s_add_u32 m0, s61, 38912
  s_add_u32 s54, s62, 700416
  buffer_load_dwordx4 v207, s[28:31], s54 offen lds
  s_add_u32 m0, s61, 39936
  s_add_u32 s54, s62, 718848
  buffer_load_dwordx4 v207, s[28:31], s54 offen lds
  ds_read_b64_tr_b16 a[0:1], v209 offset:0
  ds_read_b64_tr_b16 a[2:3], v209 offset:512
  ds_read_b64_tr_b16 a[4:5], v209 offset:8
  ds_read_b64_tr_b16 a[6:7], v209 offset:520
  s_waitcnt vmcnt(36) lgkmcnt(0)
  s_add_u32 m0, s61, 0
  s_add_u32 s54, s62, 737280
  buffer_load_dwordx4 v207, s[28:31], s54 offen lds
  s_add_u32 m0, s61, 1024
  s_add_u32 s54, s62, 755712
  buffer_load_dwordx4 v207, s[28:31], s54 offen lds
  ds_read_b64_tr_b16 a[8:9], v209 offset:2048
  ds_read_b64_tr_b16 a[10:11], v209 offset:2560
  ds_read_b64_tr_b16 a[12:13], v209 offset:2056
  ds_read_b64_tr_b16 a[14:15], v209 offset:2568
  s_waitcnt vmcnt(36) lgkmcnt(0)
  s_add_u32 m0, s61, 2048
  s_add_u32 s54, s62, 774144
  buffer_load_dwordx4 v207, s[28:31], s54 offen lds
  s_add_u32 m0, s61, 3072
  s_add_u32 s54, s62, 792576
  buffer_load_dwordx4 v207, s[28:31], s54 offen lds
  ds_read_b64_tr_b16 a[16:17], v209 offset:4096
  ds_read_b64_tr_b16 a[18:19], v209 offset:4608
  ds_read_b64_tr_b16 a[20:21], v209 offset:4104
  ds_read_b64_tr_b16 a[22:23], v209 offset:4616
  s_waitcnt vmcnt(36) lgkmcnt(0)
  s_add_u32 m0, s61, 4096
  s_add_u32 s54, s62, 811008
  buffer_load_dwordx4 v207, s[28:31], s54 offen lds
  s_add_u32 m0, s61, 5120
  s_add_u32 s54, s62, 829440
  buffer_load_dwordx4 v207, s[28:31], s54 offen lds
  ds_read_b64_tr_b16 a[24:25], v209 offset:6144
  ds_read_b64_tr_b16 a[26:27], v209 offset:6656
  ds_read_b64_tr_b16 a[28:29], v209 offset:6152
  ds_read_b64_tr_b16 a[30:31], v209 offset:6664
  s_waitcnt vmcnt(36) lgkmcnt(0)
  s_add_u32 m0, s61, 6144
  s_add_u32 s54, s62, 847872
  buffer_load_dwordx4 v207, s[28:31], s54 offen lds
  s_add_u32 m0, s61, 7168
  s_add_u32 s54, s62, 866304
  buffer_load_dwordx4 v207, s[28:31], s54 offen lds
  ds_read_b64_tr_b16 a[32:33], v209 offset:8192
  ds_read_b64_tr_b16 a[34:35], v209 offset:8704
  ds_read_b64_tr_b16 a[36:37], v209 offset:8200
  ds_read_b64_tr_b16 a[38:39], v209 offset:8712
  s_waitcnt vmcnt(36) lgkmcnt(0)
  s_add_u32 m0, s61, 8192
  s_add_u32 s54, s62, 884736
  buffer_load_dwordx4 v207, s[28:31], s54 offen lds
  s_add_u32 m0, s61, 9216
  s_add_u32 s54, s62, 903168
  buffer_load_dwordx4 v207, s[28:31], s54 offen lds
  ds_read_b64_tr_b16 a[40:41], v209 offset:10240
  ds_read_b64_tr_b16 a[42:43], v209 offset:10752
  ds_read_b64_tr_b16 a[44:45], v209 offset:10248
  ds_read_b64_tr_b16 a[46:47], v209 offset:10760
  s_waitcnt vmcnt(36) lgkmcnt(0)
  s_add_u32 m0, s61, 10240
  s_add_u32 s54, s62, 921600
  buffer_load_dwordx4 v207, s[28:31], s54 offen lds
  s_add_u32 m0, s61, 11264
  s_add_u32 s54, s62, 940032
  buffer_load_dwordx4 v207, s[28:31], s54 offen lds
  ds_read_b64_tr_b16 a[48:49], v209 offset:12288
  ds_read_b64_tr_b16 a[50:51], v209 offset:12800
  ds_read_b64_tr_b16 a[52:53], v209 offset:12296
  ds_read_b64_tr_b16 a[54:55], v209 offset:12808
  s_waitcnt vmcnt(36) lgkmcnt(0)
  s_add_u32 m0, s61, 12288
  s_add_u32 s54, s62, 958464
  buffer_load_dwordx4 v207, s[28:31], s54 offen lds
  s_add_u32 m0, s61, 13312
  s_add_u32 s54, s62, 976896
  buffer_load_dwordx4 v207, s[28:31], s54 offen lds
  ds_read_b64_tr_b16 a[56:57], v209 offset:14336
  ds_read_b64_tr_b16 a[58:59], v209 offset:14848
  ds_read_b64_tr_b16 a[60:61], v209 offset:14344
  ds_read_b64_tr_b16 a[62:63], v209 offset:14856
  s_waitcnt vmcnt(36) lgkmcnt(0)
  s_add_u32 m0, s61, 14336
  s_add_u32 s54, s62, 995328
  buffer_load_dwordx4 v207, s[28:31], s54 offen lds
  s_add_u32 m0, s61, 15360
  s_add_u32 s54, s62, 1013760
  buffer_load_dwordx4 v207, s[28:31], s54 offen lds
  ds_read_b64_tr_b16 a[64:65], v209 offset:16384
  ds_read_b64_tr_b16 a[66:67], v209 offset:16896
  ds_read_b64_tr_b16 a[68:69], v209 offset:16392
  ds_read_b64_tr_b16 a[70:71], v209 offset:16904
  s_waitcnt vmcnt(36) lgkmcnt(0)
  s_add_u32 m0, s61, 16384
  s_add_u32 s54, s62, 1032192
  buffer_load_dwordx4 v207, s[28:31], s54 offen lds
  s_add_u32 m0, s61, 17408
  s_add_u32 s54, s62, 1050624
  buffer_load_dwordx4 v207, s[28:31], s54 offen lds
  ds_read_b64_tr_b16 a[72:73], v209 offset:18432
  ds_read_b64_tr_b16 a[74:75], v209 offset:18944
  ds_read_b64_tr_b16 a[76:77], v209 offset:18440
  ds_read_b64_tr_b16 a[78:79], v209 offset:18952
  s_waitcnt vmcnt(36) lgkmcnt(0)
  s_add_u32 m0, s61, 18432
  s_add_u32 s54, s62, 1069056
  buffer_load_dwordx4 v207, s[28:31], s54 offen lds
  s_add_u32 m0, s61, 19456
  s_add_u32 s54, s62, 1087488
  buffer_load_dwordx4 v207, s[28:31], s54 offen lds
  ds_read_b64_tr_b16 a[80:81], v209 offset:20480
  ds_read_b64_tr_b16 a[82:83], v209 offset:20992
  ds_read_b64_tr_b16 a[84:85], v209 offset:20488
  ds_read_b64_tr_b16 a[86:87], v209 offset:21000
  s_waitcnt vmcnt(36) lgkmcnt(0)
  s_add_u32 m0, s61, 20480
  s_add_u32 s54, s62, 1105920
  buffer_load_dwordx4 v207, s[28:31], s54 offen lds
  s_add_u32 m0, s61, 21504
  s_add_u32 s54, s62, 1124352
  buffer_load_dwordx4 v207, s[28:31], s54 offen lds
  ds_read_b64_tr_b16 a[88:89], v209 offset:22528
  ds_read_b64_tr_b16 a[90:91], v209 offset:23040
  ds_read_b64_tr_b16 a[92:93], v209 offset:22536
  ds_read_b64_tr_b16 a[94:95], v209 offset:23048
  s_waitcnt vmcnt(36) lgkmcnt(0)
  s_add_u32 m0, s61, 22528
  s_add_u32 s54, s62, 1142784
  buffer_load_dwordx4 v207, s[28:31], s54 offen lds
  s_add_u32 m0, s61, 23552
  s_add_u32 s54, s62, 1161216
  buffer_load_dwordx4 v207, s[28:31], s54 offen lds
  ds_read_b64_tr_b16 a[96:97], v209 offset:24576
  ds_read_b64_tr_b16 a[98:99], v209 offset:25088
  ds_read_b64_tr_b16 a[100:101], v209 offset:24584
  ds_read_b64_tr_b16 a[102:103], v209 offset:25096
  s_waitcnt vmcnt(36) lgkmcnt(0)
  s_add_u32 m0, s61, 24576
  s_add_u32 s54, s63, 0
  buffer_load_dwordx4 v207, s[40:43], s54 offen lds
  s_add_u32 m0, s61, 25600
  s_add_u32 s54, s63, 18432
  buffer_load_dwordx4 v207, s[40:43], s54 offen lds
  ds_read_b64_tr_b16 a[104:105], v209 offset:26624
  ds_read_b64_tr_b16 a[106:107], v209 offset:27136
  ds_read_b64_tr_b16 a[108:109], v209 offset:26632
  ds_read_b64_tr_b16 a[110:111], v209 offset:27144
  s_waitcnt vmcnt(36) lgkmcnt(0)
  s_add_u32 m0, s61, 26624
  s_add_u32 s54, s63, 36864
  buffer_load_dwordx4 v207, s[40:43], s54 offen lds
  s_add_u32 m0, s61, 27648
  s_add_u32 s54, s63, 55296
  buffer_load_dwordx4 v207, s[40:43], s54 offen lds
  ds_read_b64_tr_b16 a[112:113], v209 offset:28672
  ds_read_b64_tr_b16 a[114:115], v209 offset:29184
  ds_read_b64_tr_b16 a[116:117], v209 offset:28680
  ds_read_b64_tr_b16 a[118:119], v209 offset:29192
  s_waitcnt vmcnt(36) lgkmcnt(0)
  s_add_u32 m0, s61, 28672
  s_add_u32 s54, s63, 73728
  buffer_load_dwordx4 v207, s[40:43], s54 offen lds
  s_add_u32 m0, s61, 29696
  s_add_u32 s54, s63, 92160
  buffer_load_dwordx4 v207, s[40:43], s54 offen lds
  ds_read_b64_tr_b16 a[120:121], v209 offset:30720
  ds_read_b64_tr_b16 a[122:123], v209 offset:31232
  ds_read_b64_tr_b16 a[124:125], v209 offset:30728
  ds_read_b64_tr_b16 a[126:127], v209 offset:31240
  s_waitcnt vmcnt(36) lgkmcnt(0)
  s_add_u32 m0, s61, 30720
  s_add_u32 s54, s63, 110592
  buffer_load_dwordx4 v207, s[40:43], s54 offen lds
  s_add_u32 m0, s61, 31744
  s_add_u32 s54, s63, 129024
  buffer_load_dwordx4 v207, s[40:43], s54 offen lds
  ds_read_b64_tr_b16 a[128:129], v209 offset:32768
  ds_read_b64_tr_b16 a[130:131], v209 offset:33280
  ds_read_b64_tr_b16 a[132:133], v209 offset:32776
  ds_read_b64_tr_b16 a[134:135], v209 offset:33288
  s_waitcnt vmcnt(36) lgkmcnt(0)
  s_add_u32 m0, s61, 32768
  s_add_u32 s54, s63, 147456
  buffer_load_dwordx4 v207, s[40:43], s54 offen lds
  s_add_u32 m0, s61, 33792
  s_add_u32 s54, s63, 165888
  buffer_load_dwordx4 v207, s[40:43], s54 offen lds
  ds_read_b64_tr_b16 a[136:137], v209 offset:34816
  ds_read_b64_tr_b16 a[138:139], v209 offset:35328
  ds_read_b64_tr_b16 a[140:141], v209 offset:34824
  ds_read_b64_tr_b16 a[142:143], v209 offset:35336
  s_waitcnt vmcnt(36) lgkmcnt(0)
  ds_read_b64_tr_b16 a[144:145], v209 offset:36864
  ds_read_b64_tr_b16 a[146:147], v209 offset:37376
  ds_read_b64_tr_b16 a[148:149], v209 offset:36872
  ds_read_b64_tr_b16 a[150:151], v209 offset:37384
  s_waitcnt vmcnt(34) lgkmcnt(0)
  ds_read_b64_tr_b16 a[152:153], v209 offset:38912
  ds_read_b64_tr_b16 a[154:155], v209 offset:39424
  ds_read_b64_tr_b16 a[156:157], v209 offset:38920
  ds_read_b64_tr_b16 a[158:159], v209 offset:39432
  s_waitcnt vmcnt(32) lgkmcnt(0)
  ds_read_b64_tr_b16 a[160:161], v209 offset:0
  ds_read_b64_tr_b16 a[162:163], v209 offset:512
  ds_read_b64_tr_b16 a[164:165], v209 offset:8
  ds_read_b64_tr_b16 a[166:167], v209 offset:520
  s_waitcnt vmcnt(30) lgkmcnt(0)
  ds_read_b64_tr_b16 a[168:169], v209 offset:2048
  ds_read_b64_tr_b16 a[170:171], v209 offset:2560
  ds_read_b64_tr_b16 a[172:173], v209 offset:2056
  ds_read_b64_tr_b16 a[174:175], v209 offset:2568
  s_waitcnt vmcnt(28) lgkmcnt(0)
  ds_read_b64_tr_b16 a[176:177], v209 offset:4096
  ds_read_b64_tr_b16 a[178:179], v209 offset:4608
  ds_read_b64_tr_b16 a[180:181], v209 offset:4104
  ds_read_b64_tr_b16 a[182:183], v209 offset:4616
  s_waitcnt vmcnt(26) lgkmcnt(0)
  ds_read_b64_tr_b16 a[184:185], v209 offset:6144
  ds_read_b64_tr_b16 a[186:187], v209 offset:6656
  ds_read_b64_tr_b16 a[188:189], v209 offset:6152
  ds_read_b64_tr_b16 a[190:191], v209 offset:6664
  s_waitcnt vmcnt(24) lgkmcnt(0)
  ds_read_b64_tr_b16 a[192:193], v209 offset:8192
  ds_read_b64_tr_b16 a[194:195], v209 offset:8704
  ds_read_b64_tr_b16 a[196:197], v209 offset:8200
  ds_read_b64_tr_b16 a[198:199], v209 offset:8712
  s_waitcnt vmcnt(22) lgkmcnt(0)
  ds_read_b64_tr_b16 a[200:201], v209 offset:10240
  ds_read_b64_tr_b16 a[202:203], v209 offset:10752
  ds_read_b64_tr_b16 a[204:205], v209 offset:10248
  ds_read_b64_tr_b16 a[206:207], v209 offset:10760
  s_waitcnt vmcnt(20) lgkmcnt(0)
  ds_read_b64_tr_b16 a[208:209], v209 offset:12288
  ds_read_b64_tr_b16 a[210:211], v209 offset:12800
  ds_read_b64_tr_b16 a[212:213], v209 offset:12296
  ds_read_b64_tr_b16 a[214:215], v209 offset:12808
  s_waitcnt vmcnt(18) lgkmcnt(0)
  ds_read_b64_tr_b16 a[216:217], v209 offset:14336
  ds_read_b64_tr_b16 a[218:219], v209 offset:14848
  ds_read_b64_tr_b16 a[220:221], v209 offset:14344
  ds_read_b64_tr_b16 a[222:223], v209 offset:14856
  s_waitcnt vmcnt(16) lgkmcnt(0)
  ds_read_b64_tr_b16 a[224:225], v209 offset:16384
  ds_read_b64_tr_b16 a[226:227], v209 offset:16896
  ds_read_b64_tr_b16 a[228:229], v209 offset:16392
  ds_read_b64_tr_b16 a[230:231], v209 offset:16904
  s_waitcnt vmcnt(14) lgkmcnt(0)
  ds_read_b64_tr_b16 a[232:233], v209 offset:18432
  ds_read_b64_tr_b16 a[234:235], v209 offset:18944
  ds_read_b64_tr_b16 a[236:237], v209 offset:18440
  ds_read_b64_tr_b16 a[238:239], v209 offset:18952
  s_waitcnt vmcnt(12) lgkmcnt(0)
  ds_read_b64_tr_b16 a[240:241], v209 offset:20480
  ds_read_b64_tr_b16 a[242:243], v209 offset:20992
  ds_read_b64_tr_b16 a[244:245], v209 offset:20488
  ds_read_b64_tr_b16 a[246:247], v209 offset:21000
  s_waitcnt vmcnt(10) lgkmcnt(0)
  ds_read_b64_tr_b16 a[248:249], v209 offset:22528
  ds_read_b64_tr_b16 a[250:251], v209 offset:23040
  ds_read_b64_tr_b16 a[252:253], v209 offset:22536
  ds_read_b64_tr_b16 a[254:255], v209 offset:23048
  s_waitcnt vmcnt(8) lgkmcnt(0)
  ds_read_b64_tr_b16 v[216:217], v210 offset:24576
  ds_read_b64_tr_b16 v[218:219], v210 offset:24832
  ds_read_b64_tr_b16 v[220:221], v210 offset:24584
  ds_read_b64_tr_b16 v[222:223], v210 offset:24840
  s_waitcnt vmcnt(6) lgkmcnt(0)
  ds_read_b64_tr_b16 v[224:225], v210 offset:26624
  ds_read_b64_tr_b16 v[226:227], v210 offset:26880
  ds_read_b64_tr_b16 v[228:229], v210 offset:26632
  ds_read_b64_tr_b16 v[230:231], v210 offset:26888
  s_waitcnt vmcnt(4) lgkmcnt(0)
  ds_read_b64_tr_b16 v[232:233], v210 offset:28672
  ds_read_b64_tr_b16 v[234:235], v210 offset:28928
  ds_read_b64_tr_b16 v[236:237], v210 offset:28680
  ds_read_b64_tr_b16 v[238:239], v210 offset:28936
  s_waitcnt vmcnt(2) lgkmcnt(0)
  ds_read_b64_tr_b16 v[240:241], v210 offset:30720
  ds_read_b64_tr_b16 v[242:243], v210 offset:30976
  ds_read_b64_tr_b16 v[244:245], v210 offset:30728
  ds_read_b64_tr_b16 v[246:247], v210 offset:30984
  s_waitcnt vmcnt(0) lgkmcnt(0)
  ds_read_b64_tr_b16 v[248:249], v210 offset:32768
  ds_read_b64_tr_b16 v[250:251], v210 offset:33024
  ds_read_b64_tr_b16 v[252:253], v210 offset:32776
  ds_read_b64_tr_b16 v[254:255], v210 offset:33032
  v_and_b32 v211, 15, v200
  s_lshl_b32 s54, s69, 4
  v_add_u32 v211, s54, v211
  v_lshl_add_u32 v212, v214, 5, v211
  v_lshlrev_b32 v164, 4, v212
  v_lshrrev_b32 v212, 5, v200
  v_lshl_add_u32 v164, v212, 10, v164
  v_mul_u32_u24 v167, 1152, v211
  v_lshl_add_u32 v167, v213, 4, v167
  v_lshlrev_b32 v166, 2, v211
  v_mul_u32_u24 v211, 144, v211
  s_mul_i32 s54, s52, 20
  s_mov_b32 s55, 294768
  v_mov_b32 v214, 0x40000000
  v_add_u32 v212, s54, v213
  v_add_u32 v212, 0, v212
  v_mul_u32_u24 v176, 57, v212
  v_lshrrev_b32 v176, 9, v176
  v_mul_lo_u32 v176, v176, s55
  v_lshl_add_u32 v176, v212, 4, v176
  v_add_u32 v176, v176, v211
  v_cmp_lt_u32 vcc, 71, v212
  s_nop 1
  v_cndmask_b32 v176, v176, v214, vcc
  v_add_u32 v212, s54, v213
  v_add_u32 v212, 4, v212
  v_mul_u32_u24 v177, 57, v212
  v_lshrrev_b32 v177, 9, v177
  v_mul_lo_u32 v177, v177, s55
  v_lshl_add_u32 v177, v212, 4, v177
  v_add_u32 v177, v177, v211
  v_cmp_lt_u32 vcc, 71, v212
  s_nop 1
  v_cndmask_b32 v177, v177, v214, vcc
  v_add_u32 v212, s54, v213
  v_add_u32 v212, 8, v212
  v_mul_u32_u24 v178, 57, v212
  v_lshrrev_b32 v178, 9, v178
  v_mul_lo_u32 v178, v178, s55
  v_lshl_add_u32 v178, v212, 4, v178
  v_add_u32 v178, v178, v211
  v_cmp_lt_u32 vcc, 71, v212
  s_nop 1
  v_cndmask_b32 v178, v178, v214, vcc
  v_add_u32 v212, s54, v213
  v_add_u32 v212, 12, v212
  v_mul_u32_u24 v179, 57, v212
  v_lshrrev_b32 v179, 9, v179
  v_mul_lo_u32 v179, v179, s55
  v_lshl_add_u32 v179, v212, 4, v179
  v_add_u32 v179, v179, v211
  v_cmp_lt_u32 vcc, 71, v212
  s_nop 1
  v_cndmask_b32 v179, v179, v214, vcc
  v_add_u32 v212, s54, v213
  v_add_u32 v212, 16, v212
  v_mul_u32_u24 v180, 57, v212
  v_lshrrev_b32 v180, 9, v180
  v_mul_lo_u32 v180, v180, s55
  v_lshl_add_u32 v180, v212, 4, v180
  v_add_u32 v180, v180, v211
  v_cmp_lt_u32 vcc, 71, v212
  s_nop 1
  v_cndmask_b32 v180, v180, v214, vcc
  v_lshlrev_b32 v208, 2, v200
  s_lshl_b32 s54, s52, 11
  v_add_u32 v168, s54, v201
  s_mov_b32 s56, 128
  s_mov_b32 s57, 36
  s_waitcnt lgkmcnt(0)
  s_cmp_eq_u32 s52, 0
  s_cbranch_scc0 O_p1_d
  s_mov_b32 exec_hi, 0
  s_mov_b32 exec_lo, -1
O_p1:
  buffer_load_dword v211, v208, s[12:15], s56 offen sc1
  s_add_u32 s65, s65, 1
  s_waitcnt vmcnt(0)
  v_cmp_gt_u32 vcc, 0x700, v211
  s_cbranch_vccz O_p1_x
  s_sleep 16
  s_cmp_lt_u32 s65, 131072
  s_cbranch_scc1 O_p1
O_p1_x:
  s_mov_b64 exec, -1
O_p1_d:
  s_barrier
  s_cmp_eq_u32 s52, 0
  s_cbranch_scc0 O_a_d
  s_mov_b32 exec_hi, 0
  s_mov_b32 exec_lo, 1
O_a:
  buffer_load_dword v211, v208, s[12:15], s57 offen sc1
  s_add_u32 s65, s65, 1
  s_waitcnt vmcnt(0)
  v_cmp_gt_u32 vcc, 0x80, v211
  s_cbranch_vccz O_a_x
  s_sleep 16
  s_cmp_lt_u32 s65, 131072
  s_cbranch_scc1 O_a
O_a_x:
  s_mov_b64 exec, -1
O_a_d:
  s_barrier
  s_and_b32 s54, s68, 1
  v_bfe_u32 v211, v200, 3, 1
  v_cmp_ne_u32 vcc, s54, v211
  v_xor_b32 v211, 0x880, v164
  v_mov_b32 v212, 0x40000000
  v_cndmask_b32 v172, v164, v211, vcc
  v_cndmask_b32 v173, v167, v212, vcc
  s_lshr_b32 s54, s68, 1
  s_sub_u32 s59, 1, s54
  s_sub_u32 s76, 61, s54
  s_lshl_b32 s54, s68, 3
  s_lshr_b32 s75, 0x3e020403, s54
  s_and_b32 s75, s75, 0xff
  s_mul_i32 s55, s59, 4608
  s_add_u32 s55, s55, 62914560
  buffer_load_dwordx4 v[128:131], v176, s[8:11], s55 offen sc1
  buffer_load_dwordx4 v[132:135], v177, s[8:11], s55 offen sc1
  buffer_load_dwordx4 v[136:139], v178, s[8:11], s55 offen sc1
  buffer_load_dwordx4 v[140:143], v179, s[8:11], s55 offen sc1
  buffer_load_dwordx4 v[144:147], v180, s[8:11], s55 offen sc1
  s_lshl_b32 s55, s59, 7
  s_add_u32 s55, s55, 66060288
  buffer_load_dword v171, v166, s[8:11], s55 offen sc1
  v_mov_b32 v169, 0
  v_lshlrev_b32 v208, 8, v200
  s_mov_b32 s66, 393216
  s_waitcnt vmcnt(0)
O_loop:
  v_mfma_f32_16x16x32_bf16 v[156:159], v[216:219], v[128:131], 0
  v_mfma_f32_16x16x32_bf16 v[160:163], v[220:223], v[128:131], 0
  v_mfma_f32_16x16x32_bf16 v[156:159], v[224:227], v[132:135], v[156:159]
  v_mfma_f32_16x16x32_bf16 v[160:163], v[228:231], v[132:135], v[160:163]
  v_mfma_f32_16x16x32_bf16 v[156:159], v[232:235], v[136:139], v[156:159]
  v_mfma_f32_16x16x32_bf16 v[160:163], v[236:239], v[136:139], v[160:163]
  v_mfma_f32_16x16x32_bf16 v[156:159], v[240:243], v[140:143], v[156:159]
  v_mfma_f32_16x16x32_bf16 v[160:163], v[244:247], v[140:143], v[160:163]
  v_mfma_f32_16x16x32_bf16 v[156:159], v[248:251], v[144:147], v[156:159]
  v_mfma_f32_16x16x32_bf16 v[160:163], v[252:255], v[144:147], v[160:163]
  s_mul_i32 s64, s59, 36864
  s_lshl_b32 s54, s70, 6
  s_add_u32 s64, s64, s54
  s_add_u32 s71, s59, 2
  s_lshl_b32 s55, s59, 18
  s_lshl_b32 s54, s52, 16
  s_add_u32 s55, s55, s54
  s_add_u32 s63, s55, 46137344
  s_and_b32 s54, s59, 1
  s_lshl_b32 s54, s54, 2
  s_add_u32 s54, s54, s52
  s_lshl_b32 s54, s54, 3
  s_lshl_b64 s[72:73], 0xff, s54
  v_sub_f32 v165, 1.0, v171
  v_cvt_pk_bf16_f32 v165, v165, v165
  v_lshlrev_b32 v165, 16, v165
  v_mul_f32 v156, v171, v156
  v_mul_f32 v157, v171, v157
  v_mul_f32 v158, v171, v158
  v_mul_f32 v159, v171, v159
  v_mul_f32 v160, v171, v160
  v_mul_f32 v161, v171, v161
  v_mul_f32 v162, v171, v162
  v_mul_f32 v163, v171, v163
  s_add_u32 s57, s59, 3
  s_cmp_lt_u32 s59, 2
  s_cselect_b32 s57, s75, s57
  s_cmp_gt_u32 s57, 59
  s_cselect_b32 s57, s76, s57
  s_add_u32 s74, s59, 2
  s_cmp_ge_u32 s59, 60
  s_cselect_b32 s57, s74, s57
  s_min_u32 s74, s57, 63
  s_sub_u32 s77, s71, 6
  s_branch O_pc
O_pl:
  v_cmp_gt_i32 vcc, s77, v169
  s_nop 0
  s_and_b64 vcc, vcc, s[72:73]
  s_cbranch_scc0 O_pn
  s_sleep 24
O_pn:
  s_sleep 1
  s_mov_b64 exec, s[72:73]
  buffer_load_dword v169, v208, s[8:11], s66 offen sc1
  s_mov_b64 exec, -1
  s_add_u32 s65, s65, 1
  s_cmp_ge_u32 s65, 131072
  s_cbranch_scc1 O_ld
  s_waitcnt vmcnt(0)
O_pc:
  v_cmp_gt_u32 vcc, s71, v169
  s_nop 0
  s_and_b64 vcc, vcc, s[72:73]
  s_cbranch_scc1 O_pl
O_ld:
  s_mov_b32 s62, s63
  s_add_u32 s65, s65, 1
  s_cmp_lt_u32 s65, 131072
  s_cselect_b32 s56, -2, -1
  s_sub_u32 s54, s59, 2
  s_cmp_lt_u32 s54, 58
  s_cbranch_scc1 O_full
  buffer_load_dwordx4 v[0:3], v172, s[8:11], s62 offen sc1
  s_add_u32 s62, s62, 4096
  buffer_load_dwordx4 v[4:7], v172, s[8:11], s62 offen sc1
  s_add_u32 s62, s62, 4096
  buffer_load_dwordx4 v[8:11], v172, s[8:11], s62 offen sc1
  s_add_u32 s62, s62, 4096
  buffer_load_dwordx4 v[12:15], v172, s[8:11], s62 offen sc1
  s_add_u32 s62, s62, 4096
  buffer_load_dwordx4 v[16:19], v172, s[8:11], s62 offen sc1
  s_add_u32 s62, s62, 4096
  buffer_load_dwordx4 v[20:23], v172, s[8:11], s62 offen sc1
  s_add_u32 s62, s62, 4096
  buffer_load_dwordx4 v[24:27], v172, s[8:11], s62 offen sc1
  s_add_u32 s62, s62, 4096
  buffer_load_dwordx4 v[28:31], v172, s[8:11], s62 offen sc1
  s_add_u32 s62, s62, 4096
  buffer_load_dwordx4 v[32:35], v172, s[8:11], s62 offen sc1
  s_add_u32 s62, s62, 4096
  buffer_load_dwordx4 v[36:39], v172, s[8:11], s62 offen sc1
  s_add_u32 s62, s62, 4096
  buffer_load_dwordx4 v[40:43], v172, s[8:11], s62 offen sc1
  s_add_u32 s62, s62, 4096
  buffer_load_dwordx4 v[44:47], v172, s[8:11], s62 offen sc1
  s_add_u32 s62, s62, 4096
  buffer_load_dwordx4 v[48:51], v172, s[8:11], s62 offen sc1
  s_add_u32 s62, s62, 4096
  buffer_load_dwordx4 v[52:55], v172, s[8:11], s62 offen sc1
  s_add_u32 s62, s62, 4096
  buffer_load_dwordx4 v[56:59], v172, s[8:11], s62 offen sc1
  s_add_u32 s62, s62, 4096
  buffer_load_dwordx4 v[60:63], v172, s[8:11], s62 offen sc1
  s_add_u32 s62, s62, 4096
  s_mul_i32 s55, s74, 4608
  s_add_u32 s55, s55, 62914560
  buffer_load_dwordx4 v[128:131], v176, s[8:11], s55 offen sc1
  buffer_load_dwordx4 v[132:135], v177, s[8:11], s55 offen sc1
  buffer_load_dwordx4 v[136:139], v178, s[8:11], s55 offen sc1
  buffer_load_dwordx4 v[140:143], v179, s[8:11], s55 offen sc1
  buffer_load_dwordx4 v[144:147], v180, s[8:11], s55 offen sc1
  s_lshl_b32 s55, s74, 7
  s_add_u32 s55, s55, 66060288
  buffer_load_dword v171, v166, s[8:11], s55 offen sc1
  v_mov_b32 v174, v173
  s_waitcnt vmcnt(21)
  v_mfma_f32_16x16x32_bf16 v[148:151], a[0:3], v[0:3], 0
  v_mfma_f32_16x16x32_bf16 v[152:155], a[4:7], v[0:3], 0
  v_mfma_f32_16x16x32_bf16 v[184:187], a[8:11], v[0:3], 0
  v_mfma_f32_16x16x32_bf16 v[188:191], a[12:15], v[0:3], 0
  v_max3_u32 v170, v0, v1, v0
  v_max3_u32 v170, v2, v3, v170
  s_waitcnt vmcnt(20)
  v_mfma_f32_16x16x32_bf16 v[148:151], a[16:19], v[4:7], v[148:151]
  v_mfma_f32_16x16x32_bf16 v[152:155], a[20:23], v[4:7], v[152:155]
  v_mfma_f32_16x16x32_bf16 v[184:187], a[24:27], v[4:7], v[184:187]
  v_mfma_f32_16x16x32_bf16 v[188:191], a[28:31], v[4:7], v[188:191]
  v_max3_u32 v170, v4, v5, v170
  v_max3_u32 v170, v6, v7, v170
  s_waitcnt vmcnt(19)
  v_mfma_f32_16x16x32_bf16 v[148:151], a[32:35], v[8:11], v[148:151]
  v_mfma_f32_16x16x32_bf16 v[152:155], a[36:39], v[8:11], v[152:155]
  v_mfma_f32_16x16x32_bf16 v[184:187], a[40:43], v[8:11], v[184:187]
  v_mfma_f32_16x16x32_bf16 v[188:191], a[44:47], v[8:11], v[188:191]
  v_max3_u32 v170, v8, v9, v170
  v_max3_u32 v170, v10, v11, v170
  s_waitcnt vmcnt(18)
  v_mfma_f32_16x16x32_bf16 v[148:151], a[48:51], v[12:15], v[148:151]
  v_mfma_f32_16x16x32_bf16 v[152:155], a[52:55], v[12:15], v[152:155]
  v_mfma_f32_16x16x32_bf16 v[184:187], a[56:59], v[12:15], v[184:187]
  v_mfma_f32_16x16x32_bf16 v[188:191], a[60:63], v[12:15], v[188:191]
  v_max3_u32 v170, v12, v13, v170
  v_max3_u32 v170, v14, v15, v170
  s_waitcnt vmcnt(17)
  v_mfma_f32_16x16x32_bf16 v[148:151], a[64:67], v[16:19], v[148:151]
  v_mfma_f32_16x16x32_bf16 v[152:155], a[68:71], v[16:19], v[152:155]
  v_mfma_f32_16x16x32_bf16 v[184:187], a[72:75], v[16:19], v[184:187]
  v_mfma_f32_16x16x32_bf16 v[188:191], a[76:79], v[16:19], v[188:191]
  v_max3_u32 v170, v16, v17, v170
  v_max3_u32 v170, v18, v19, v170
  s_waitcnt vmcnt(16)
  v_mfma_f32_16x16x32_bf16 v[148:151], a[80:83], v[20:23], v[148:151]
  v_mfma_f32_16x16x32_bf16 v[152:155], a[84:87], v[20:23], v[152:155]
  v_mfma_f32_16x16x32_bf16 v[184:187], a[88:91], v[20:23], v[184:187]
  v_mfma_f32_16x16x32_bf16 v[188:191], a[92:95], v[20:23], v[188:191]
  v_max3_u32 v170, v20, v21, v170
  v_max3_u32 v170, v22, v23, v170
  s_waitcnt vmcnt(15)
  v_mfma_f32_16x16x32_bf16 v[148:151], a[96:99], v[24:27], v[148:151]
  v_mfma_f32_16x16x32_bf16 v[152:155], a[100:103], v[24:27], v[152:155]
  v_mfma_f32_16x16x32_bf16 v[184:187], a[104:107], v[24:27], v[184:187]
  v_mfma_f32_16x16x32_bf16 v[188:191], a[108:111], v[24:27], v[188:191]
  v_max3_u32 v170, v24, v25, v170
  v_max3_u32 v170, v26, v27, v170
  s_waitcnt vmcnt(14)
  v_mfma_f32_16x16x32_bf16 v[148:151], a[112:115], v[28:31], v[148:151]
  v_mfma_f32_16x16x32_bf16 v[152:155], a[116:119], v[28:31], v[152:155]
  v_mfma_f32_16x16x32_bf16 v[184:187], a[120:123], v[28:31], v[184:187]
  v_mfma_f32_16x16x32_bf16 v[188:191], a[124:127], v[28:31], v[188:191]
  v_max3_u32 v170, v28, v29, v170
  v_max3_u32 v170, v30, v31, v170
  s_waitcnt vmcnt(13)
  v_mfma_f32_16x16x32_bf16 v[148:151], a[128:131], v[32:35], v[148:151]
  v_mfma_f32_16x16x32_bf16 v[152:155], a[132:135], v[32:35], v[152:155]
  v_mfma_f32_16x16x32_bf16 v[184:187], a[136:139], v[32:35], v[184:187]
  v_mfma_f32_16x16x32_bf16 v[188:191], a[140:143], v[32:35], v[188:191]
  v_max3_u32 v170, v32, v33, v170
  v_max3_u32 v170, v34, v35, v170
  s_waitcnt vmcnt(12)
  v_mfma_f32_16x16x32_bf16 v[148:151], a[144:147], v[36:39], v[148:151]
  v_mfma_f32_16x16x32_bf16 v[152:155], a[148:151], v[36:39], v[152:155]
  v_mfma_f32_16x16x32_bf16 v[184:187], a[152:155], v[36:39], v[184:187]
  v_mfma_f32_16x16x32_bf16 v[188:191], a[156:159], v[36:39], v[188:191]
  v_max3_u32 v170, v36, v37, v170
  v_max3_u32 v170, v38, v39, v170
  s_waitcnt vmcnt(11)
  v_mfma_f32_16x16x32_bf16 v[148:151], a[160:163], v[40:43], v[148:151]
  v_mfma_f32_16x16x32_bf16 v[152:155], a[164:167], v[40:43], v[152:155]
  v_mfma_f32_16x16x32_bf16 v[184:187], a[168:171], v[40:43], v[184:187]
  v_mfma_f32_16x16x32_bf16 v[188:191], a[172:175], v[40:43], v[188:191]
  v_max3_u32 v170, v40, v41, v170
  v_max3_u32 v170, v42, v43, v170
  s_waitcnt vmcnt(10)
  v_mfma_f32_16x16x32_bf16 v[148:151], a[176:179], v[44:47], v[148:151]
  v_mfma_f32_16x16x32_bf16 v[152:155], a[180:183], v[44:47], v[152:155]
  v_mfma_f32_16x16x32_bf16 v[184:187], a[184:187], v[44:47], v[184:187]
  v_mfma_f32_16x16x32_bf16 v[188:191], a[188:191], v[44:47], v[188:191]
  v_max3_u32 v170, v44, v45, v170
  v_max3_u32 v170, v46, v47, v170
  s_waitcnt vmcnt(9)
  v_mfma_f32_16x16x32_bf16 v[148:151], a[192:195], v[48:51], v[148:151]
  v_mfma_f32_16x16x32_bf16 v[152:155], a[196:199], v[48:51], v[152:155]
  v_mfma_f32_16x16x32_bf16 v[184:187], a[200:203], v[48:51], v[184:187]
  v_mfma_f32_16x16x32_bf16 v[188:191], a[204:207], v[48:51], v[188:191]
  v_max3_u32 v170, v48, v49, v170
  v_max3_u32 v170, v50, v51, v170
  s_waitcnt vmcnt(8)
  v_mfma_f32_16x16x32_bf16 v[148:151], a[208:211], v[52:55], v[148:151]
  v_mfma_f32_16x16x32_bf16 v[152:155], a[212:215], v[52:55], v[152:155]
  v_mfma_f32_16x16x32_bf16 v[184:187], a[216:219], v[52:55], v[184:187]
  v_mfma_f32_16x16x32_bf16 v[188:191], a[220:223], v[52:55], v[188:191]
  v_max3_u32 v170, v52, v53, v170
  v_max3_u32 v170, v54, v55, v170
  s_waitcnt vmcnt(7)
  v_mfma_f32_16x16x32_bf16 v[148:151], a[224:227], v[56:59], v[148:151]
  v_mfma_f32_16x16x32_bf16 v[152:155], a[228:231], v[56:59], v[152:155]
  v_mfma_f32_16x16x32_bf16 v[184:187], a[232:235], v[56:59], v[184:187]
  v_mfma_f32_16x16x32_bf16 v[188:191], a[236:239], v[56:59], v[188:191]
  v_max3_u32 v170, v56, v57, v170
  v_max3_u32 v170, v58, v59, v170
  s_waitcnt vmcnt(6)
  v_mfma_f32_16x16x32_bf16 v[148:151], a[240:243], v[60:63], v[148:151]
  v_mfma_f32_16x16x32_bf16 v[152:155], a[244:247], v[60:63], v[152:155]
  v_mfma_f32_16x16x32_bf16 v[184:187], a[248:251], v[60:63], v[184:187]
  v_mfma_f32_16x16x32_bf16 v[188:191], a[252:255], v[60:63], v[188:191]
  v_max3_u32 v170, v60, v61, v170
  v_max3_u32 v170, v62, v63, v170
  v_cmp_lt_u32 vcc, s56, v170
  s_cbranch_vccnz O_ld
  v_add_f32_dpp v148, v184, v148 row_ror:8 row_mask:0xf bank_mask:0xf
  v_add_f32_dpp v149, v185, v149 row_ror:8 row_mask:0xf bank_mask:0xf
  v_add_f32_dpp v150, v186, v150 row_ror:8 row_mask:0xf bank_mask:0xf
  v_add_f32_dpp v151, v187, v151 row_ror:8 row_mask:0xf bank_mask:0xf
  v_add_f32_dpp v152, v188, v152 row_ror:8 row_mask:0xf bank_mask:0xf
  v_add_f32_dpp v153, v189, v153 row_ror:8 row_mask:0xf bank_mask:0xf
  v_add_f32_dpp v154, v190, v154 row_ror:8 row_mask:0xf bank_mask:0xf
  v_add_f32_dpp v155, v191, v155 row_ror:8 row_mask:0xf bank_mask:0xf
  s_branch O_mix
O_full:
  buffer_load_dwordx4 v[0:3], v164, s[8:11], s62 offen offset:0 sc1
  buffer_load_dwordx4 v[4:7], v164, s[8:11], s62 offen offset:2048 sc1
  s_add_u32 s62, s62, 4096
  buffer_load_dwordx4 v[8:11], v164, s[8:11], s62 offen offset:0 sc1
  buffer_load_dwordx4 v[12:15], v164, s[8:11], s62 offen offset:2048 sc1
  s_add_u32 s62, s62, 4096
  buffer_load_dwordx4 v[16:19], v164, s[8:11], s62 offen offset:0 sc1
  buffer_load_dwordx4 v[20:23], v164, s[8:11], s62 offen offset:2048 sc1
  s_add_u32 s62, s62, 4096
  buffer_load_dwordx4 v[24:27], v164, s[8:11], s62 offen offset:0 sc1
  buffer_load_dwordx4 v[28:31], v164, s[8:11], s62 offen offset:2048 sc1
  s_add_u32 s62, s62, 4096
  buffer_load_dwordx4 v[32:35], v164, s[8:11], s62 offen offset:0 sc1
  buffer_load_dwordx4 v[36:39], v164, s[8:11], s62 offen offset:2048 sc1
  s_add_u32 s62, s62, 4096
  buffer_load_dwordx4 v[40:43], v164, s[8:11], s62 offen offset:0 sc1
  buffer_load_dwordx4 v[44:47], v164, s[8:11], s62 offen offset:2048 sc1
  s_add_u32 s62, s62, 4096
  buffer_load_dwordx4 v[48:51], v164, s[8:11], s62 offen offset:0 sc1
  buffer_load_dwordx4 v[52:55], v164, s[8:11], s62 offen offset:2048 sc1
  s_add_u32 s62, s62, 4096
  buffer_load_dwordx4 v[56:59], v164, s[8:11], s62 offen offset:0 sc1
  buffer_load_dwordx4 v[60:63], v164, s[8:11], s62 offen offset:2048 sc1
  s_add_u32 s62, s62, 4096
  buffer_load_dwordx4 v[64:67], v164, s[8:11], s62 offen offset:0 sc1
  buffer_load_dwordx4 v[68:71], v164, s[8:11], s62 offen offset:2048 sc1
  s_add_u32 s62, s62, 4096
  buffer_load_dwordx4 v[72:75], v164, s[8:11], s62 offen offset:0 sc1
  buffer_load_dwordx4 v[76:79], v164, s[8:11], s62 offen offset:2048 sc1
  s_add_u32 s62, s62, 4096
  buffer_load_dwordx4 v[80:83], v164, s[8:11], s62 offen offset:0 sc1
  buffer_load_dwordx4 v[84:87], v164, s[8:11], s62 offen offset:2048 sc1
  s_add_u32 s62, s62, 4096
  buffer_load_dwordx4 v[88:91], v164, s[8:11], s62 offen offset:0 sc1
  buffer_load_dwordx4 v[92:95], v164, s[8:11], s62 offen offset:2048 sc1
  s_add_u32 s62, s62, 4096
  buffer_load_dwordx4 v[96:99], v164, s[8:11], s62 offen offset:0 sc1
  buffer_load_dwordx4 v[100:103], v164, s[8:11], s62 offen offset:2048 sc1
  s_add_u32 s62, s62, 4096
  buffer_load_dwordx4 v[104:107], v164, s[8:11], s62 offen offset:0 sc1
  buffer_load_dwordx4 v[108:111], v164, s[8:11], s62 offen offset:2048 sc1
  s_add_u32 s62, s62, 4096
  buffer_load_dwordx4 v[112:115], v164, s[8:11], s62 offen offset:0 sc1
  buffer_load_dwordx4 v[116:119], v164, s[8:11], s62 offen offset:2048 sc1
  s_add_u32 s62, s62, 4096
  buffer_load_dwordx4 v[120:123], v164, s[8:11], s62 offen offset:0 sc1
  buffer_load_dwordx4 v[124:127], v164, s[8:11], s62 offen offset:2048 sc1
  s_add_u32 s62, s62, 4096
  s_mul_i32 s55, s74, 4608
  s_add_u32 s55, s55, 62914560
  buffer_load_dwordx4 v[128:131], v176, s[8:11], s55 offen sc1
  buffer_load_dwordx4 v[132:135], v177, s[8:11], s55 offen sc1
  buffer_load_dwordx4 v[136:139], v178, s[8:11], s55 offen sc1
  buffer_load_dwordx4 v[140:143], v179, s[8:11], s55 offen sc1
  buffer_load_dwordx4 v[144:147], v180, s[8:11], s55 offen sc1
  s_lshl_b32 s55, s74, 7
  s_add_u32 s55, s55, 66060288
  buffer_load_dword v171, v166, s[8:11], s55 offen sc1
  v_mov_b32 v174, v167
  s_waitcnt vmcnt(37)
  v_mfma_f32_16x16x32_bf16 v[148:151], a[0:3], v[0:3], 0
  v_mfma_f32_16x16x32_bf16 v[152:155], a[4:7], v[0:3], 0
  v_max3_u32 v170, v0, v1, v0
  v_max3_u32 v170, v2, v3, v170
  s_waitcnt vmcnt(36)
  v_mfma_f32_16x16x32_bf16 v[148:151], a[8:11], v[4:7], v[148:151]
  v_mfma_f32_16x16x32_bf16 v[152:155], a[12:15], v[4:7], v[152:155]
  v_max3_u32 v170, v4, v5, v170
  v_max3_u32 v170, v6, v7, v170
  s_waitcnt vmcnt(35)
  v_mfma_f32_16x16x32_bf16 v[148:151], a[16:19], v[8:11], v[148:151]
  v_mfma_f32_16x16x32_bf16 v[152:155], a[20:23], v[8:11], v[152:155]
  v_max3_u32 v170, v8, v9, v170
  v_max3_u32 v170, v10, v11, v170
  s_waitcnt vmcnt(34)
  v_mfma_f32_16x16x32_bf16 v[148:151], a[24:27], v[12:15], v[148:151]
  v_mfma_f32_16x16x32_bf16 v[152:155], a[28:31], v[12:15], v[152:155]
  v_max3_u32 v170, v12, v13, v170
  v_max3_u32 v170, v14, v15, v170
  s_waitcnt vmcnt(33)
  v_mfma_f32_16x16x32_bf16 v[148:151], a[32:35], v[16:19], v[148:151]
  v_mfma_f32_16x16x32_bf16 v[152:155], a[36:39], v[16:19], v[152:155]
  v_max3_u32 v170, v16, v17, v170
  v_max3_u32 v170, v18, v19, v170
  s_waitcnt vmcnt(32)
  v_mfma_f32_16x16x32_bf16 v[148:151], a[40:43], v[20:23], v[148:151]
  v_mfma_f32_16x16x32_bf16 v[152:155], a[44:47], v[20:23], v[152:155]
  v_max3_u32 v170, v20, v21, v170
  v_max3_u32 v170, v22, v23, v170
  s_waitcnt vmcnt(31)
  v_mfma_f32_16x16x32_bf16 v[148:151], a[48:51], v[24:27], v[148:151]
  v_mfma_f32_16x16x32_bf16 v[152:155], a[52:55], v[24:27], v[152:155]
  v_max3_u32 v170, v24, v25, v170
  v_max3_u32 v170, v26, v27, v170
  s_waitcnt vmcnt(30)
  v_mfma_f32_16x16x32_bf16 v[148:151], a[56:59], v[28:31], v[148:151]
  v_mfma_f32_16x16x32_bf16 v[152:155], a[60:63], v[28:31], v[152:155]
  v_max3_u32 v170, v28, v29, v170
  v_max3_u32 v170, v30, v31, v170
  s_waitcnt vmcnt(29)
  v_mfma_f32_16x16x32_bf16 v[148:151], a[64:67], v[32:35], v[148:151]
  v_mfma_f32_16x16x32_bf16 v[152:155], a[68:71], v[32:35], v[152:155]
  v_max3_u32 v170, v32, v33, v170
  v_max3_u32 v170, v34, v35, v170
  s_waitcnt vmcnt(28)
  v_mfma_f32_16x16x32_bf16 v[148:151], a[72:75], v[36:39], v[148:151]
  v_mfma_f32_16x16x32_bf16 v[152:155], a[76:79], v[36:39], v[152:155]
  v_max3_u32 v170, v36, v37, v170
  v_max3_u32 v170, v38, v39, v170
  s_waitcnt vmcnt(27)
  v_mfma_f32_16x16x32_bf16 v[148:151], a[80:83], v[40:43], v[148:151]
  v_mfma_f32_16x16x32_bf16 v[152:155], a[84:87], v[40:43], v[152:155]
  v_max3_u32 v170, v40, v41, v170
  v_max3_u32 v170, v42, v43, v170
  s_waitcnt vmcnt(26)
  v_mfma_f32_16x16x32_bf16 v[148:151], a[88:91], v[44:47], v[148:151]
  v_mfma_f32_16x16x32_bf16 v[152:155], a[92:95], v[44:47], v[152:155]
  v_max3_u32 v170, v44, v45, v170
  v_max3_u32 v170, v46, v47, v170
  s_waitcnt vmcnt(25)
  v_mfma_f32_16x16x32_bf16 v[148:151], a[96:99], v[48:51], v[148:151]
  v_mfma_f32_16x16x32_bf16 v[152:155], a[100:103], v[48:51], v[152:155]
  v_max3_u32 v170, v48, v49, v170
  v_max3_u32 v170, v50, v51, v170
  s_waitcnt vmcnt(24)
  v_mfma_f32_16x16x32_bf16 v[148:151], a[104:107], v[52:55], v[148:151]
  v_mfma_f32_16x16x32_bf16 v[152:155], a[108:111], v[52:55], v[152:155]
  v_max3_u32 v170, v52, v53, v170
  v_max3_u32 v170, v54, v55, v170
  s_waitcnt vmcnt(23)
  v_mfma_f32_16x16x32_bf16 v[148:151], a[112:115], v[56:59], v[148:151]
  v_mfma_f32_16x16x32_bf16 v[152:155], a[116:119], v[56:59], v[152:155]
  v_max3_u32 v170, v56, v57, v170
  v_max3_u32 v170, v58, v59, v170
  s_waitcnt vmcnt(22)
  v_mfma_f32_16x16x32_bf16 v[148:151], a[120:123], v[60:63], v[148:151]
  v_mfma_f32_16x16x32_bf16 v[152:155], a[124:127], v[60:63], v[152:155]
  v_max3_u32 v170, v60, v61, v170
  v_max3_u32 v170, v62, v63, v170
  s_waitcnt vmcnt(21)
  v_mfma_f32_16x16x32_bf16 v[148:151], a[128:131], v[64:67], v[148:151]
  v_mfma_f32_16x16x32_bf16 v[152:155], a[132:135], v[64:67], v[152:155]
  v_max3_u32 v170, v64, v65, v170
  v_max3_u32 v170, v66, v67, v170
  s_waitcnt vmcnt(20)
  v_mfma_f32_16x16x32_bf16 v[148:151], a[136:139], v[68:71], v[148:151]
  v_mfma_f32_16x16x32_bf16 v[152:155], a[140:143], v[68:71], v[152:155]
  v_max3_u32 v170, v68, v69, v170
  v_max3_u32 v170, v70, v71, v170
  s_waitcnt vmcnt(19)
  v_mfma_f32_16x16x32_bf16 v[148:151], a[144:147], v[72:75], v[148:151]
  v_mfma_f32_16x16x32_bf16 v[152:155], a[148:151], v[72:75], v[152:155]
  v_max3_u32 v170, v72, v73, v170
  v_max3_u32 v170, v74, v75, v170
  s_waitcnt vmcnt(18)
  v_mfma_f32_16x16x32_bf16 v[148:151], a[152:155], v[76:79], v[148:151]
  v_mfma_f32_16x16x32_bf16 v[152:155], a[156:159], v[76:79], v[152:155]
  v_max3_u32 v170, v76, v77, v170
  v_max3_u32 v170, v78, v79, v170
  s_waitcnt vmcnt(17)
  v_mfma_f32_16x16x32_bf16 v[148:151], a[160:163], v[80:83], v[148:151]
  v_mfma_f32_16x16x32_bf16 v[152:155], a[164:167], v[80:83], v[152:155]
  v_max3_u32 v170, v80, v81, v170
  v_max3_u32 v170, v82, v83, v170
  s_waitcnt vmcnt(16)
  v_mfma_f32_16x16x32_bf16 v[148:151], a[168:171], v[84:87], v[148:151]
  v_mfma_f32_16x16x32_bf16 v[152:155], a[172:175], v[84:87], v[152:155]
  v_max3_u32 v170, v84, v85, v170
  v_max3_u32 v170, v86, v87, v170
  s_waitcnt vmcnt(15)
  v_mfma_f32_16x16x32_bf16 v[148:151], a[176:179], v[88:91], v[148:151]
  v_mfma_f32_16x16x32_bf16 v[152:155], a[180:183], v[88:91], v[152:155]
  v_max3_u32 v170, v88, v89, v170
  v_max3_u32 v170, v90, v91, v170
  s_waitcnt vmcnt(14)
  v_mfma_f32_16x16x32_bf16 v[148:151], a[184:187], v[92:95], v[148:151]
  v_mfma_f32_16x16x32_bf16 v[152:155], a[188:191], v[92:95], v[152:155]
  v_max3_u32 v170, v92, v93, v170
  v_max3_u32 v170, v94, v95, v170
  s_waitcnt vmcnt(13)
  v_mfma_f32_16x16x32_bf16 v[148:151], a[192:195], v[96:99], v[148:151]
  v_mfma_f32_16x16x32_bf16 v[152:155], a[196:199], v[96:99], v[152:155]
  v_max3_u32 v170, v96, v97, v170
  v_max3_u32 v170, v98, v99, v170
  s_waitcnt vmcnt(12)
  v_mfma_f32_16x16x32_bf16 v[148:151], a[200:203], v[100:103], v[148:151]
  v_mfma_f32_16x16x32_bf16 v[152:155], a[204:207], v[100:103], v[152:155]
  v_max3_u32 v170, v100, v101, v170
  v_max3_u32 v170, v102, v103, v170
  s_waitcnt vmcnt(11)
  v_mfma_f32_16x16x32_bf16 v[148:151], a[208:211], v[104:107], v[148:151]
  v_mfma_f32_16x16x32_bf16 v[152:155], a[212:215], v[104:107], v[152:155]
  v_max3_u32 v170, v104, v105, v170
  v_max3_u32 v170, v106, v107, v170
  s_waitcnt vmcnt(10)
  v_mfma_f32_16x16x32_bf16 v[148:151], a[216:219], v[108:111], v[148:151]
  v_mfma_f32_16x16x32_bf16 v[152:155], a[220:223], v[108:111], v[152:155]
  v_max3_u32 v170, v108, v109, v170
  v_max3_u32 v170, v110, v111, v170
  s_waitcnt vmcnt(9)
  v_mfma_f32_16x16x32_bf16 v[148:151], a[224:227], v[112:115], v[148:151]
  v_mfma_f32_16x16x32_bf16 v[152:155], a[228:231], v[112:115], v[152:155]
  v_max3_u32 v170, v112, v113, v170
  v_max3_u32 v170, v114, v115, v170
  s_waitcnt vmcnt(8)
  v_mfma_f32_16x16x32_bf16 v[148:151], a[232:235], v[116:119], v[148:151]
  v_mfma_f32_16x16x32_bf16 v[152:155], a[236:239], v[116:119], v[152:155]
  v_max3_u32 v170, v116, v117, v170
  v_max3_u32 v170, v118, v119, v170
  s_waitcnt vmcnt(7)
  v_mfma_f32_16x16x32_bf16 v[148:151], a[240:243], v[120:123], v[148:151]
  v_mfma_f32_16x16x32_bf16 v[152:155], a[244:247], v[120:123], v[152:155]
  v_max3_u32 v170, v120, v121, v170
  v_max3_u32 v170, v122, v123, v170
  s_waitcnt vmcnt(6)
  v_mfma_f32_16x16x32_bf16 v[148:151], a[248:251], v[124:127], v[148:151]
  v_mfma_f32_16x16x32_bf16 v[152:155], a[252:255], v[124:127], v[152:155]
  v_max3_u32 v170, v124, v125, v170
  v_max3_u32 v170, v126, v127, v170
  v_cmp_lt_u32 vcc, s56, v170
  s_cbranch_vccnz O_ld
O_mix:
  v_fmac_f32 v156, v165, v148
  v_fmac_f32 v157, v165, v149
  v_fmac_f32 v158, v165, v150
  v_fmac_f32 v159, v165, v151
  v_fmac_f32 v160, v165, v152
  v_fmac_f32 v161, v165, v153
  v_fmac_f32 v162, v165, v154
  v_fmac_f32 v163, v165, v155
  ds_write_b128 v168, v[156:159]
  ds_write_b128 v168, v[160:163] offset:1024
  v_xor_b32 v168, 0x2000, v168
  s_mov_b32 s59, s57
  s_waitcnt lgkmcnt(0)
  s_barrier
  s_cmp_eq_u32 s52, 0
  s_cbranch_scc0 O_next
  v_xor_b32 v211, 0x2000, v168
  ds_read_b128 v[0:3], v211 offset:2048
  ds_read_b128 v[4:7], v211 offset:3072
  ds_read_b128 v[8:11], v211 offset:4096
  ds_read_b128 v[12:15], v211 offset:5120
  ds_read_b128 v[16:19], v211 offset:6144
  ds_read_b128 v[20:23], v211 offset:7168
  s_waitcnt lgkmcnt(5)
  v_add_f32 v156, v156, v0
  v_add_f32 v157, v157, v1
  v_add_f32 v158, v158, v2
  v_add_f32 v159, v159, v3
  s_waitcnt lgkmcnt(4)
  v_add_f32 v160, v160, v4
  v_add_f32 v161, v161, v5
  v_add_f32 v162, v162, v6
  v_add_f32 v163, v163, v7
  s_waitcnt lgkmcnt(3)
  v_add_f32 v156, v156, v8
  v_add_f32 v157, v157, v9
  v_add_f32 v158, v158, v10
  v_add_f32 v159, v159, v11
  s_waitcnt lgkmcnt(2)
  v_add_f32 v160, v160, v12
  v_add_f32 v161, v161, v13
  v_add_f32 v162, v162, v14
  v_add_f32 v163, v163, v15
  s_waitcnt lgkmcnt(1)
  v_add_f32 v156, v156, v16
  v_add_f32 v157, v157, v17
  v_add_f32 v158, v158, v18
  v_add_f32 v159, v159, v19
  s_waitcnt lgkmcnt(0)
  v_add_f32 v160, v160, v20
  v_add_f32 v161, v161, v21
  v_add_f32 v162, v162, v22
  v_add_f32 v163, v163, v23
  v_cvt_pk_bf16_f32 v148, v156, v157
  v_cvt_pk_bf16_f32 v149, v158, v159
  v_cvt_pk_bf16_f32 v150, v160, v161
  v_cvt_pk_bf16_f32 v151, v162, v163
  buffer_store_dwordx4 v[148:151], v174, s[48:51], s64 offen sc1
  s_waitcnt vmcnt(1)
  s_branch O_nx2
O_next:
  s_waitcnt vmcnt(0)
O_nx2:
  s_cmp_lt_u32 s59, 64
  s_cbranch_scc1 O_loop
  s_branch L_exit
W_h:
  s_lshr_b32 s58, s53, 1
  s_and_b32 s59, s53, 1
  s_mul_i32 s60, s59, 36864
  s_add_u32 m0, s67, 0
  s_nop 0
  buffer_load_dwordx4 v202, s[4:7], s60 offen offset:0 lds
  s_add_u32 m0, s67, 896
  s_nop 0
  buffer_load_dwordx4 v202, s[4:7], s60 offen offset:128 lds
  s_add_u32 m0, s67, 1792
  s_nop 0
  buffer_load_dwordx4 v202, s[4:7], s60 offen offset:256 lds
  s_add_u32 m0, s67, 2688
  s_nop 0
  buffer_load_dwordx4 v202, s[4:7], s60 offen offset:384 lds
  s_add_u32 m0, s67, 3584
  s_nop 0
  buffer_load_dwordx4 v202, s[4:7], s60 offen offset:512 lds
  s_add_u32 m0, s67, 4480
  s_nop 0
  buffer_load_dwordx4 v202, s[4:7], s60 offen offset:640 lds
  s_add_u32 m0, s67, 5376
  s_nop 0
  buffer_load_dwordx4 v202, s[4:7], s60 offen offset:768 lds
  s_add_u32 m0, s67, 6272
  s_nop 0
  buffer_load_dwordx4 v202, s[4:7], s60 offen offset:896 lds
  s_add_u32 m0, s67, 7168
  s_nop 0
  buffer_load_dwordx4 v202, s[4:7], s60 offen offset:1024 lds
  v_lshrrev_b32 v211, 4, v200
  v_lshlrev_b32 v212, 2, v211
  v_and_b32 v213, 15, v200
  v_xor_b32 v212, v212, v213
  v_lshlrev_b32 v212, 4, v212
  v_lshl_add_u32 v207, v211, 13, v212
  s_lshl_b32 s62, s58, 8
  s_lshl_b32 s54, s52, 15
  s_add_u32 s62, s62, s54
  s_lshl_b32 s61, s52, 10
  s_add_u32 s61, s61, 36864
  s_add_u32 m0, s61, 0
  s_add_u32 s54, s62, 0
  buffer_load_dwordx4 v207, s[16:19], s54 offen lds
  s_add_u32 m0, s61, 4096
  s_add_u32 s54, s62, 131072
  buffer_load_dwordx4 v207, s[16:19], s54 offen lds
  s_add_u32 m0, s61, 8192
  s_add_u32 s54, s62, 262144
  buffer_load_dwordx4 v207, s[16:19], s54 offen lds
  s_add_u32 m0, s61, 12288
  s_add_u32 s54, s62, 393216
  buffer_load_dwordx4 v207, s[16:19], s54 offen lds
  s_add_u32 m0, s61, 16384
  s_add_u32 s54, s62, 524288
  buffer_load_dwordx4 v207, s[16:19], s54 offen lds
  s_add_u32 m0, s61, 20480
  s_add_u32 s54, s62, 655360
  buffer_load_dwordx4 v207, s[16:19], s54 offen lds
  s_add_u32 m0, s61, 24576
  s_add_u32 s54, s62, 786432
  buffer_load_dwordx4 v207, s[16:19], s54 offen lds
  s_add_u32 m0, s61, 28672
  s_add_u32 s54, s62, 917504
  buffer_load_dwordx4 v207, s[16:19], s54 offen lds
  s_add_u32 m0, s61, 32768
  s_add_u32 s54, s62, 1048576
  buffer_load_dwordx4 v207, s[16:19], s54 offen lds
  s_add_u32 m0, s61, 36864
  s_add_u32 s54, s62, 1179648
  buffer_load_dwordx4 v207, s[16:19], s54 offen lds
  s_add_u32 m0, s61, 40960
  s_add_u32 s54, s62, 1310720
  buffer_load_dwordx4 v207, s[16:19], s54 offen lds
  s_add_u32 m0, s61, 45056
  s_add_u32 s54, s62, 1441792
  buffer_load_dwordx4 v207, s[16:19], s54 offen lds
  s_add_u32 m0, s61, 49152
  s_add_u32 s54, s62, 1572864
  buffer_load_dwordx4 v207, s[16:19], s54 offen lds
  s_add_u32 m0, s61, 53248
  s_add_u32 s54, s62, 1703936
  buffer_load_dwordx4 v207, s[16:19], s54 offen lds
  s_add_u32 m0, s61, 57344
  s_add_u32 s54, s62, 1835008
  buffer_load_dwordx4 v207, s[16:19], s54 offen lds
  s_add_u32 m0, s61, 61440
  s_add_u32 s54, s62, 1966080
  buffer_load_dwordx4 v207, s[16:19], s54 offen lds
  s_add_u32 m0, s61, 65536
  s_add_u32 s54, s62, 2097152
  buffer_load_dwordx4 v207, s[16:19], s54 offen lds
  s_add_u32 m0, s61, 69632
  s_add_u32 s54, s62, 2228224
  buffer_load_dwordx4 v207, s[16:19], s54 offen lds
  s_add_u32 m0, s61, 73728
  s_add_u32 s54, s62, 2359296
  buffer_load_dwordx4 v207, s[16:19], s54 offen lds
  s_add_u32 m0, s61, 77824
  s_add_u32 s54, s62, 2490368
  buffer_load_dwordx4 v207, s[16:19], s54 offen lds
  s_add_u32 m0, s61, 81920
  s_add_u32 s54, s62, 2621440
  buffer_load_dwordx4 v207, s[16:19], s54 offen lds
  s_add_u32 m0, s61, 86016
  s_add_u32 s54, s62, 2752512
  buffer_load_dwordx4 v207, s[16:19], s54 offen lds
  s_add_u32 m0, s61, 90112
  s_add_u32 s54, s62, 2883584
  buffer_load_dwordx4 v207, s[16:19], s54 offen lds
  s_add_u32 m0, s61, 94208
  s_add_u32 s54, s62, 3014656
  buffer_load_dwordx4 v207, s[16:19], s54 offen lds
  s_waitcnt vmcnt(20) lgkmcnt(0)
  s_barrier
  s_add_u32 m0, s61, 98304
  s_add_u32 s54, s62, 3145728
  buffer_load_dwordx4 v207, s[16:19], s54 offen lds
  s_add_u32 m0, s61, 102400
  s_add_u32 s54, s62, 3276800
  buffer_load_dwordx4 v207, s[16:19], s54 offen lds
  s_add_u32 m0, s61, 106496
  s_add_u32 s54, s62, 3407872
  buffer_load_dwordx4 v207, s[16:19], s54 offen lds
  s_add_u32 m0, s61, 110592
  s_add_u32 s54, s62, 3538944
  buffer_load_dwordx4 v207, s[16:19], s54 offen lds
  v_add_u32 v215, 36864, v209
  ds_read_b64_tr_b16 a[0:1], v215 offset:0
  ds_read_b64_tr_b16 a[2:3], v215 offset:1024
  ds_read_b64_tr_b16 a[4:5], v215 offset:4096
  ds_read_b64_tr_b16 a[6:7], v215 offset:5120
  ds_read_b64_tr_b16 a[8:9], v215 offset:8192
  ds_read_b64_tr_b16 a[10:11], v215 offset:9216
  ds_read_b64_tr_b16 a[12:13], v215 offset:12288
  ds_read_b64_tr_b16 a[14:15], v215 offset:13312
  s_waitcnt vmcnt(20) lgkmcnt(0)
  s_barrier
  s_add_u32 m0, s61, 0
  s_add_u32 s54, s62, 3670016
  buffer_load_dwordx4 v207, s[16:19], s54 offen lds
  s_add_u32 m0, s61, 4096
  s_add_u32 s54, s62, 3801088
  buffer_load_dwordx4 v207, s[16:19], s54 offen lds
  s_add_u32 m0, s61, 8192
  s_add_u32 s54, s62, 3932160
  buffer_load_dwordx4 v207, s[16:19], s54 offen lds
  s_add_u32 m0, s61, 12288
  s_add_u32 s54, s62, 4063232
  buffer_load_dwordx4 v207, s[16:19], s54 offen lds
  v_add_u32 v215, 53248, v209
  ds_read_b64_tr_b16 a[16:17], v215 offset:0
  ds_read_b64_tr_b16 a[18:19], v215 offset:1024
  ds_read_b64_tr_b16 a[20:21], v215 offset:4096
  ds_read_b64_tr_b16 a[22:23], v215 offset:5120
  ds_read_b64_tr_b16 a[24:25], v215 offset:8192
  ds_read_b64_tr_b16 a[26:27], v215 offset:9216
  ds_read_b64_tr_b16 a[28:29], v215 offset:12288
  ds_read_b64_tr_b16 a[30:31], v215 offset:13312
  s_waitcnt vmcnt(20) lgkmcnt(0)
  s_barrier
  s_add_u32 m0, s61, 16384
  s_add_u32 s54, s62, 4194304
  buffer_load_dwordx4 v207, s[16:19], s54 offen lds
  s_add_u32 m0, s61, 20480
  s_add_u32 s54, s62, 4325376
  buffer_load_dwordx4 v207, s[16:19], s54 offen lds
  s_add_u32 m0, s61, 24576
  s_add_u32 s54, s62, 4456448
  buffer_load_dwordx4 v207, s[16:19], s54 offen lds
  s_add_u32 m0, s61, 28672
  s_add_u32 s54, s62, 4587520
  buffer_load_dwordx4 v207, s[16:19], s54 offen lds
  v_add_u32 v215, 69632, v209
  ds_read_b64_tr_b16 a[32:33], v215 offset:0
  ds_read_b64_tr_b16 a[34:35], v215 offset:1024
  ds_read_b64_tr_b16 a[36:37], v215 offset:4096
  ds_read_b64_tr_b16 a[38:39], v215 offset:5120
  ds_read_b64_tr_b16 a[40:41], v215 offset:8192
  ds_read_b64_tr_b16 a[42:43], v215 offset:9216
  ds_read_b64_tr_b16 a[44:45], v215 offset:12288
  ds_read_b64_tr_b16 a[46:47], v215 offset:13312
  s_waitcnt vmcnt(20) lgkmcnt(0)
  s_barrier
  v_add_u32 v215, 86016, v209
  ds_read_b64_tr_b16 a[48:49], v215 offset:0
  ds_read_b64_tr_b16 a[50:51], v215 offset:1024
  ds_read_b64_tr_b16 a[52:53], v215 offset:4096
  ds_read_b64_tr_b16 a[54:55], v215 offset:5120
  ds_read_b64_tr_b16 a[56:57], v215 offset:8192
  ds_read_b64_tr_b16 a[58:59], v215 offset:9216
  ds_read_b64_tr_b16 a[60:61], v215 offset:12288
  ds_read_b64_tr_b16 a[62:63], v215 offset:13312
  s_waitcnt vmcnt(16) lgkmcnt(0)
  s_barrier
  v_add_u32 v215, 102400, v209
  ds_read_b64_tr_b16 a[64:65], v215 offset:0
  ds_read_b64_tr_b16 a[66:67], v215 offset:1024
  ds_read_b64_tr_b16 a[68:69], v215 offset:4096
  ds_read_b64_tr_b16 a[70:71], v215 offset:5120
  ds_read_b64_tr_b16 a[72:73], v215 offset:8192
  ds_read_b64_tr_b16 a[74:75], v215 offset:9216
  ds_read_b64_tr_b16 a[76:77], v215 offset:12288
  ds_read_b64_tr_b16 a[78:79], v215 offset:13312
  s_waitcnt vmcnt(12) lgkmcnt(0)
  s_barrier
  v_add_u32 v215, 118784, v209
  ds_read_b64_tr_b16 a[80:81], v215 offset:0
  ds_read_b64_tr_b16 a[82:83], v215 offset:1024
  ds_read_b64_tr_b16 a[84:85], v215 offset:4096
  ds_read_b64_tr_b16 a[86:87], v215 offset:5120
  ds_read_b64_tr_b16 a[88:89], v215 offset:8192
  ds_read_b64_tr_b16 a[90:91], v215 offset:9216
  ds_read_b64_tr_b16 a[92:93], v215 offset:12288
  ds_read_b64_tr_b16 a[94:95], v215 offset:13312
  s_waitcnt vmcnt(8) lgkmcnt(0)
  s_barrier
  v_add_u32 v215, 135168, v209
  ds_read_b64_tr_b16 a[96:97], v215 offset:0
  ds_read_b64_tr_b16 a[98:99], v215 offset:1024
  ds_read_b64_tr_b16 a[100:101], v215 offset:4096
  ds_read_b64_tr_b16 a[102:103], v215 offset:5120
  ds_read_b64_tr_b16 a[104:105], v215 offset:8192
  ds_read_b64_tr_b16 a[106:107], v215 offset:9216
  ds_read_b64_tr_b16 a[108:109], v215 offset:12288
  ds_read_b64_tr_b16 a[110:111], v215 offset:13312
  s_waitcnt vmcnt(4) lgkmcnt(0)
  s_barrier
  v_add_u32 v215, 36864, v209
  ds_read_b64_tr_b16 a[112:113], v215 offset:0
  ds_read_b64_tr_b16 a[114:115], v215 offset:1024
  ds_read_b64_tr_b16 a[116:117], v215 offset:4096
  ds_read_b64_tr_b16 a[118:119], v215 offset:5120
  ds_read_b64_tr_b16 a[120:121], v215 offset:8192
  ds_read_b64_tr_b16 a[122:123], v215 offset:9216
  ds_read_b64_tr_b16 a[124:125], v215 offset:12288
  ds_read_b64_tr_b16 a[126:127], v215 offset:13312
  s_waitcnt vmcnt(0) lgkmcnt(0)
  s_barrier
  v_add_u32 v215, 53248, v209
  ds_read_b64_tr_b16 a[128:129], v215 offset:0
  ds_read_b64_tr_b16 a[130:131], v215 offset:1024
  ds_read_b64_tr_b16 a[132:133], v215 offset:4096
  ds_read_b64_tr_b16 a[134:135], v215 offset:5120
  ds_read_b64_tr_b16 a[136:137], v215 offset:8192
  ds_read_b64_tr_b16 a[138:139], v215 offset:9216
  ds_read_b64_tr_b16 a[140:141], v215 offset:12288
  ds_read_b64_tr_b16 a[142:143], v215 offset:13312
  s_waitcnt lgkmcnt(0)
  s_barrier
  v_and_b32 v211, 31, v200
  v_lshrrev_b32 v212, 5, v200
  v_lshlrev_b32 v213, 2, v212
  v_sub_u32 v211, v211, v213
  v_mov_b32 v214, 0xf149f2ca
  v_cmp_gt_i32 vcc, 0, v211
  s_nop 1
  v_cndmask_b32 v48, 0, v214, vcc
  v_cmp_gt_i32 vcc, 1, v211
  s_nop 1
  v_cndmask_b32 v49, 0, v214, vcc
  v_cmp_gt_i32 vcc, 2, v211
  s_nop 1
  v_cndmask_b32 v50, 0, v214, vcc
  v_cmp_gt_i32 vcc, 3, v211
  s_nop 1
  v_cndmask_b32 v51, 0, v214, vcc
  v_cmp_gt_i32 vcc, 8, v211
  s_nop 1
  v_cndmask_b32 v52, 0, v214, vcc
  v_cmp_gt_i32 vcc, 9, v211
  s_nop 1
  v_cndmask_b32 v53, 0, v214, vcc
  v_cmp_gt_i32 vcc, 10, v211
  s_nop 1
  v_cndmask_b32 v54, 0, v214, vcc
  v_cmp_gt_i32 vcc, 11, v211
  s_nop 1
  v_cndmask_b32 v55, 0, v214, vcc
  v_cmp_gt_i32 vcc, 16, v211
  s_nop 1
  v_cndmask_b32 v56, 0, v214, vcc
  v_cmp_gt_i32 vcc, 17, v211
  s_nop 1
  v_cndmask_b32 v57, 0, v214, vcc
  v_cmp_gt_i32 vcc, 18, v211
  s_nop 1
  v_cndmask_b32 v58, 0, v214, vcc
  v_cmp_gt_i32 vcc, 19, v211
  s_nop 1
  v_cndmask_b32 v59, 0, v214, vcc
  v_cmp_gt_i32 vcc, 24, v211
  s_nop 1
  v_cndmask_b32 v60, 0, v214, vcc
  v_cmp_gt_i32 vcc, 25, v211
  s_nop 1
  v_cndmask_b32 v61, 0, v214, vcc
  v_cmp_gt_i32 vcc, 26, v211
  s_nop 1
  v_cndmask_b32 v62, 0, v214, vcc
  v_cmp_gt_i32 vcc, 27, v211
  s_nop 1
  v_cndmask_b32 v63, 0, v214, vcc
  v_and_b32 v218, 0xff, v216
  v_add_u32 v218, 81920, v218
  v_and_b32 v211, 15, v200
  v_lshl_add_u32 v211, v212, 5, v211
  v_lshlrev_b32 v219, 3, v211
  v_bfe_u32 v211, v200, 4, 1
  v_lshl_add_u32 v219, v211, 2, v219
  s_lshl_b32 s54, s52, 9
  s_add_u32 s54, s54, 83968
  v_add_u32 v219, s54, v219
  v_lshl_add_u32 v221, v200, 3, s54
  s_lshr_b32 s54, s52, 1
  s_lshl_b32 s54, s54, 10
  s_and_b32 s55, s52, 1
  s_lshl_b32 s55, s55, 3
  s_add_u32 s54, s54, s55
  s_add_u32 s54, s54, 81920
  v_add_u32 v220, s54, v201
  s_lshl_b32 s54, s52, 11
  s_add_u32 s54, s54, 73728
  v_add_u32 v215, s54, v201
  v_add_u32 v208, 73728, v201
  s_mov_b32 s68, 1040356334
  s_cmp_eq_u32 s52, 0
  s_cselect_b32 s71, s71, 268435456
  s_lshl_b32 s56, s58, 2
  s_add_u32 s56, s56, 128
  v_mov_b32 v176, -1
  v_mov_b32 v177, -1
  v_mov_b32 v178, -1
  v_mov_b32 v179, -1
  s_cmp_eq_u32 s52, 0
  s_cbranch_scc0 AT_p1_d
  s_mov_b32 exec_hi, 0
  s_mov_b32 exec_lo, 1
AT_p1:
  buffer_load_dword v211, v201, s[12:15], s56 offen sc1
  s_add_u32 s65, s65, 1
  s_waitcnt vmcnt(0)
  v_cmp_gt_u32 vcc, 0x700, v211
  s_cbranch_vccz AT_p1_x
  s_sleep 8
  s_cmp_lt_u32 s65, 131072
  s_cbranch_scc1 AT_p1
AT_p1_x:
  s_mov_b64 exec, -1
AT_p1_d:
  s_barrier
  s_mov_b32 s74, s59
  s_mul_i32 s66, s59, 655360
  s_lshl_b32 s55, s58, 14
  s_add_u32 s55, s55, s66
  s_add_u32 s55, s55, 1048576
  s_lshl_b32 s73, s58, 2
  s_add_u32 s73, s73, s52
  s_lshl_b32 s72, s59, 7
  s_add_u32 s72, s72, s73
  s_lshl_b32 s72, s72, 11
  s_add_u32 s72, s72, 46137344
  s_lshl_b32 s73, s73, 10
  s_add_u32 s73, s73, s66
  s_add_u32 s73, s73, 1572864
  s_add_u32 s59, s59, 2
  buffer_load_dwordx4 v[128:131], v216, s[8:11], s55 offen offset:0 sc1
  buffer_load_dwordx4 v[132:135], v216, s[8:11], s55 offen offset:256 sc1
  buffer_load_dwordx4 v[136:139], v216, s[8:11], s55 offen offset:512 sc1
  buffer_load_dwordx4 v[140:143], v216, s[8:11], s55 offen offset:768 sc1
  buffer_load_dwordx4 v[144:147], v216, s[8:11], s55 offen offset:1024 sc1
  buffer_load_dwordx4 v[148:151], v216, s[8:11], s55 offen offset:1280 sc1
  buffer_load_dwordx4 v[152:155], v216, s[8:11], s55 offen offset:1536 sc1
  buffer_load_dwordx4 v[156:159], v216, s[8:11], s55 offen offset:1792 sc1
  buffer_load_dwordx4 v[160:163], v217, s[8:11], s55 offen offset:0 sc1
  buffer_load_dwordx4 v[164:167], v217, s[8:11], s55 offen offset:256 sc1
  s_add_u32 s60, s60, 73728
  ds_read_b128 v[32:35], v203 offset:0
  ds_read_b128 v[36:39], v204 offset:0
  ds_read_b128 v[40:43], v205 offset:0
  s_waitcnt lgkmcnt(2)
  v_mfma_f32_32x32x16_bf16 v[240:255], a[0:3], v[32:35], 0
  ds_read_b128 v[44:47], v206 offset:0
  s_add_u32 m0, s67, 36864
  s_nop 0
  buffer_load_dwordx4 v202, s[4:7], s60 offen offset:0 lds
  s_waitcnt lgkmcnt(2)
  v_mfma_f32_32x32x16_bf16 v[240:255], a[4:7], v[36:39], v[240:255]
  ds_read_b128 v[32:35], v203 offset:1024
  s_waitcnt lgkmcnt(2)
  v_mfma_f32_32x32x16_bf16 v[240:255], a[8:11], v[40:43], v[240:255]
  ds_read_b128 v[36:39], v204 offset:1024
  s_add_u32 m0, s67, 37760
  s_nop 0
  buffer_load_dwordx4 v202, s[4:7], s60 offen offset:128 lds
  s_waitcnt lgkmcnt(2)
  v_mfma_f32_32x32x16_bf16 v[240:255], a[12:15], v[44:47], v[240:255]
  ds_read_b128 v[40:43], v205 offset:1024
  s_waitcnt lgkmcnt(2)
  v_mfma_f32_32x32x16_bf16 v[240:255], a[16:19], v[32:35], v[240:255]
  ds_read_b128 v[44:47], v206 offset:1024
  s_add_u32 m0, s67, 38656
  s_nop 0
  buffer_load_dwordx4 v202, s[4:7], s60 offen offset:256 lds
  s_waitcnt lgkmcnt(2)
  v_mfma_f32_32x32x16_bf16 v[240:255], a[20:23], v[36:39], v[240:255]
  ds_read_b128 v[32:35], v203 offset:2048
  s_waitcnt lgkmcnt(2)
  v_mfma_f32_32x32x16_bf16 v[240:255], a[24:27], v[40:43], v[240:255]
  ds_read_b128 v[36:39], v204 offset:2048
  s_add_u32 m0, s67, 39552
  s_nop 0
  buffer_load_dwordx4 v202, s[4:7], s60 offen offset:384 lds
  s_waitcnt lgkmcnt(2)
  v_mfma_f32_32x32x16_bf16 v[240:255], a[28:31], v[44:47], v[240:255]
  ds_read_b128 v[40:43], v205 offset:2048
  s_waitcnt lgkmcnt(2)
  v_mfma_f32_32x32x16_bf16 v[240:255], a[32:35], v[32:35], v[240:255]
  ds_read_b128 v[44:47], v206 offset:2048
  s_add_u32 m0, s67, 40448
  s_nop 0
  buffer_load_dwordx4 v202, s[4:7], s60 offen offset:512 lds
  s_waitcnt lgkmcnt(2)
  v_mfma_f32_32x32x16_bf16 v[240:255], a[36:39], v[36:39], v[240:255]
  ds_read_b128 v[32:35], v203 offset:3072
  s_waitcnt lgkmcnt(2)
  v_mfma_f32_32x32x16_bf16 v[240:255], a[40:43], v[40:43], v[240:255]
  ds_read_b128 v[36:39], v204 offset:3072
  s_add_u32 m0, s67, 41344
  s_nop 0
  buffer_load_dwordx4 v202, s[4:7], s60 offen offset:640 lds
  s_waitcnt lgkmcnt(2)
  v_mfma_f32_32x32x16_bf16 v[240:255], a[44:47], v[44:47], v[240:255]
  ds_read_b128 v[40:43], v205 offset:3072
  s_waitcnt lgkmcnt(2)
  v_mfma_f32_32x32x16_bf16 v[240:255], a[48:51], v[32:35], v[240:255]
  ds_read_b128 v[44:47], v206 offset:3072
  s_add_u32 m0, s67, 42240
  s_nop 0
  buffer_load_dwordx4 v202, s[4:7], s60 offen offset:768 lds
  s_waitcnt lgkmcnt(2)
  v_mfma_f32_32x32x16_bf16 v[240:255], a[52:55], v[36:39], v[240:255]
  ds_read_b128 v[32:35], v203 offset:4096
  s_waitcnt lgkmcnt(2)
  v_mfma_f32_32x32x16_bf16 v[240:255], a[56:59], v[40:43], v[240:255]
  ds_read_b128 v[36:39], v204 offset:4096
  s_add_u32 m0, s67, 43136
  s_nop 0
  buffer_load_dwordx4 v202, s[4:7], s60 offen offset:896 lds
  s_waitcnt lgkmcnt(2)
  v_mfma_f32_32x32x16_bf16 v[240:255], a[60:63], v[44:47], v[240:255]
  ds_read_b128 v[40:43], v205 offset:4096
  s_waitcnt lgkmcnt(2)
  v_mfma_f32_32x32x16_bf16 v[240:255], a[64:67], v[32:35], v[240:255]
  ds_read_b128 v[44:47], v206 offset:4096
  s_add_u32 m0, s67, 44032
  s_nop 0
  buffer_load_dwordx4 v202, s[4:7], s60 offen offset:1024 lds
  s_waitcnt lgkmcnt(2)
  v_mfma_f32_32x32x16_bf16 v[240:255], a[68:71], v[36:39], v[240:255]
  ds_read_b128 v[32:35], v203 offset:5120
  s_waitcnt lgkmcnt(2)
  v_mfma_f32_32x32x16_bf16 v[240:255], a[72:75], v[40:43], v[240:255]
  ds_read_b128 v[36:39], v204 offset:5120
  buffer_store_dwordx4 v[176:179], v201, s[8:11], s72 offen offset:0 sc1
  s_waitcnt lgkmcnt(2)
  v_mfma_f32_32x32x16_bf16 v[240:255], a[76:79], v[44:47], v[240:255]
  ds_read_b128 v[40:43], v205 offset:5120
  s_waitcnt lgkmcnt(2)
  v_mfma_f32_32x32x16_bf16 v[240:255], a[80:83], v[32:35], v[240:255]
  ds_read_b128 v[44:47], v206 offset:5120
  buffer_store_dwordx4 v[176:179], v201, s[8:11], s72 offen offset:1024 sc1
  s_waitcnt lgkmcnt(2)
  v_mfma_f32_32x32x16_bf16 v[240:255], a[84:87], v[36:39], v[240:255]
  ds_read_b128 v[32:35], v203 offset:6144
  s_waitcnt lgkmcnt(2)
  v_mfma_f32_32x32x16_bf16 v[240:255], a[88:91], v[40:43], v[240:255]
  ds_read_b128 v[36:39], v204 offset:6144
  s_waitcnt lgkmcnt(2)
  v_mfma_f32_32x32x16_bf16 v[240:255], a[92:95], v[44:47], v[240:255]
  ds_read_b128 v[40:43], v205 offset:6144
  s_waitcnt lgkmcnt(2)
  v_mfma_f32_32x32x16_bf16 v[240:255], a[96:99], v[32:35], v[240:255]
  ds_read_b128 v[44:47], v206 offset:6144
  s_waitcnt lgkmcnt(2)
  v_mfma_f32_32x32x16_bf16 v[240:255], a[100:103], v[36:39], v[240:255]
  ds_read_b128 v[32:35], v203 offset:7168
  s_waitcnt lgkmcnt(2)
  v_mfma_f32_32x32x16_bf16 v[240:255], a[104:107], v[40:43], v[240:255]
  ds_read_b128 v[36:39], v204 offset:7168
  s_waitcnt lgkmcnt(2)
  v_mfma_f32_32x32x16_bf16 v[240:255], a[108:111], v[44:47], v[240:255]
  ds_read_b128 v[40:43], v205 offset:7168
  s_waitcnt lgkmcnt(2)
  v_mfma_f32_32x32x16_bf16 v[240:255], a[112:115], v[32:35], v[240:255]
  ds_read_b128 v[44:47], v206 offset:7168
  s_waitcnt lgkmcnt(2)
  v_mfma_f32_32x32x16_bf16 v[240:255], a[116:119], v[36:39], v[240:255]
  ds_read_b128 v[32:35], v203 offset:8192
  s_waitcnt lgkmcnt(2)
  v_mfma_f32_32x32x16_bf16 v[240:255], a[120:123], v[40:43], v[240:255]
  ds_read_b128 v[36:39], v204 offset:8192
  s_waitcnt lgkmcnt(2)
  v_mfma_f32_32x32x16_bf16 v[240:255], a[124:127], v[44:47], v[240:255]
  ds_read_b128 v[40:43], v205 offset:8192
  s_waitcnt lgkmcnt(2)
  v_mfma_f32_32x32x16_bf16 v[240:255], a[128:131], v[32:35], v[240:255]
  ds_read_b128 v[44:47], v206 offset:8192
  s_waitcnt lgkmcnt(2)
  v_mfma_f32_32x32x16_bf16 v[240:255], a[132:135], v[36:39], v[240:255]
  s_waitcnt lgkmcnt(1)
  v_mfma_f32_32x32x16_bf16 v[240:255], a[136:139], v[40:43], v[240:255]
  s_waitcnt lgkmcnt(0)
  v_mfma_f32_32x32x16_bf16 v[240:255], a[140:143], v[44:47], v[240:255]
  s_nop 11
  v_cvt_pk_bf16_f32 v16, v240, v244
  v_cvt_pk_bf16_f32 v17, v241, v245
  v_cvt_pk_bf16_f32 v18, v242, v246
  v_cvt_pk_bf16_f32 v19, v243, v247
  ds_write_b128 v215, v[16:19] offset:0
  v_cvt_pk_bf16_f32 v20, v248, v252
  v_cvt_pk_bf16_f32 v21, v249, v253
  v_cvt_pk_bf16_f32 v22, v250, v254
  v_cvt_pk_bf16_f32 v23, v251, v255
  ds_write_b128 v215, v[20:23] offset:1024
  s_waitcnt lgkmcnt(0)
  s_barrier
  ds_read_b128 v[96:99], v208 offset:0
  ds_read_b128 v[100:103], v208 offset:1024
  ds_read_b128 v[104:107], v208 offset:2048
  ds_read_b128 v[108:111], v208 offset:3072
  ds_read_b128 v[112:115], v208 offset:4096
  ds_read_b128 v[116:119], v208 offset:5120
  ds_read_b128 v[120:123], v208 offset:6144
  ds_read_b128 v[124:127], v208 offset:7168
  s_waitcnt vmcnt(20) lgkmcnt(7)
  v_mfma_f32_32x32x16_bf16 v[64:79], v[128:131], v[96:99], v[48:63]
  s_waitcnt vmcnt(19) lgkmcnt(6)
  v_mfma_f32_32x32x16_bf16 v[64:79], v[132:135], v[100:103], v[64:79]
  s_waitcnt vmcnt(18) lgkmcnt(5)
  v_mfma_f32_32x32x16_bf16 v[64:79], v[136:139], v[104:107], v[64:79]
  s_waitcnt vmcnt(17) lgkmcnt(4)
  v_mfma_f32_32x32x16_bf16 v[64:79], v[140:143], v[108:111], v[64:79]
  s_waitcnt vmcnt(16) lgkmcnt(3)
  v_mfma_f32_32x32x16_bf16 v[64:79], v[144:147], v[112:115], v[64:79]
  s_waitcnt vmcnt(15) lgkmcnt(2)
  v_mfma_f32_32x32x16_bf16 v[64:79], v[148:151], v[116:119], v[64:79]
  s_waitcnt vmcnt(14) lgkmcnt(1)
  v_mfma_f32_32x32x16_bf16 v[64:79], v[152:155], v[120:123], v[64:79]
  s_waitcnt vmcnt(13) lgkmcnt(0)
  v_mfma_f32_32x32x16_bf16 v[64:79], v[156:159], v[124:127], v[64:79]
  s_nop 11
  v_max3_f32 v180, v64, v65, v66
  v_max3_f32 v180, v180, v67, v68
  v_max3_f32 v180, v180, v69, v70
  v_max3_f32 v180, v180, v71, v72
  v_max3_f32 v180, v180, v73, v74
  v_max3_f32 v180, v180, v75, v76
  v_max3_f32 v180, v180, v77, v78
  v_max_f32 v180, v180, v79
  v_mov_b32 v181, v180
  s_nop 1
  v_permlane32_swap_b32 v180, v181
  v_max_f32 v180, v180, v181
  v_sub_f32 v64, v64, v180
  v_sub_f32 v65, v65, v180
  v_sub_f32 v66, v66, v180
  v_sub_f32 v67, v67, v180
  v_sub_f32 v68, v68, v180
  v_sub_f32 v69, v69, v180
  v_sub_f32 v70, v70, v180
  v_sub_f32 v71, v71, v180
  v_sub_f32 v72, v72, v180
  v_sub_f32 v73, v73, v180
  v_sub_f32 v74, v74, v180
  v_sub_f32 v75, v75, v180
  v_sub_f32 v76, v76, v180
  v_sub_f32 v77, v77, v180
  v_sub_f32 v78, v78, v180
  v_sub_f32 v79, v79, v180
  v_exp_f32 v64, v64
  v_exp_f32 v65, v65
  v_exp_f32 v66, v66
  v_exp_f32 v67, v67
  v_exp_f32 v68, v68
  v_exp_f32 v69, v69
  v_exp_f32 v70, v70
  v_exp_f32 v71, v71
  v_exp_f32 v72, v72
  v_exp_f32 v73, v73
  v_exp_f32 v74, v74
  v_exp_f32 v75, v75
  v_exp_f32 v76, v76
  v_exp_f32 v77, v77
  v_exp_f32 v78, v78
  v_exp_f32 v79, v79
  v_cvt_pk_bf16_f32 v20, v64, v65
  v_cvt_pk_bf16_f32 v21, v68, v69
  v_cvt_pk_bf16_f32 v22, v72, v73
  v_cvt_pk_bf16_f32 v23, v76, v77
  v_cvt_pk_bf16_f32 v24, v66, v67
  v_cvt_pk_bf16_f32 v25, v70, v71
  v_cvt_pk_bf16_f32 v26, v74, v75
  v_cvt_pk_bf16_f32 v27, v78, v79
  s_waitcnt vmcnt(12)
  v_mfma_f32_32x32x16_bf16 v[0:15], v[160:163], v[20:23], 0
  v_add_f32 v182, v64, v65
  v_add_f32 v182, v182, v66
  v_add_f32 v182, v182, v67
  v_add_f32 v182, v182, v68
  v_add_f32 v182, v182, v69
  v_add_f32 v182, v182, v70
  v_add_f32 v182, v182, v71
  s_waitcnt vmcnt(11)
  v_mfma_f32_32x32x16_bf16 v[0:15], v[164:167], v[24:27], v[0:15]
  v_add_f32 v182, v182, v72
  v_add_f32 v182, v182, v73
  v_add_f32 v182, v182, v74
  v_add_f32 v182, v182, v75
  v_add_f32 v182, v182, v76
  v_add_f32 v182, v182, v77
  v_add_f32 v182, v182, v78
  v_add_f32 v182, v182, v79
  s_waitcnt vmcnt(0)
  s_barrier
AT_loop:
  s_cmp_ge_u32 s59, 64
  s_cbranch_scc1 AT_l0
  s_mov_b32 s77, s59
  s_mul_i32 s66, s59, 655360
  s_lshl_b32 s55, s58, 14
  s_add_u32 s55, s55, s66
  s_add_u32 s55, s55, 1048576
  s_lshl_b32 s76, s58, 2
  s_add_u32 s76, s76, s52
  s_lshl_b32 s75, s59, 7
  s_add_u32 s75, s75, s76
  s_lshl_b32 s75, s75, 11
  s_add_u32 s75, s75, 46137344
  s_lshl_b32 s76, s76, 10
  s_add_u32 s76, s76, s66
  s_add_u32 s76, s76, 1572864
  s_add_u32 s59, s59, 2
  buffer_load_dwordx4 v[128:131], v216, s[8:11], s55 offen offset:0 sc1
  buffer_load_dwordx4 v[132:135], v216, s[8:11], s55 offen offset:256 sc1
  buffer_load_dwordx4 v[136:139], v216, s[8:11], s55 offen offset:512 sc1
  buffer_load_dwordx4 v[140:143], v216, s[8:11], s55 offen offset:768 sc1
  buffer_load_dwordx4 v[144:147], v216, s[8:11], s55 offen offset:1024 sc1
  buffer_load_dwordx4 v[148:151], v216, s[8:11], s55 offen offset:1280 sc1
  buffer_load_dwordx4 v[152:155], v216, s[8:11], s55 offen offset:1536 sc1
  buffer_load_dwordx4 v[156:159], v216, s[8:11], s55 offen offset:1792 sc1
  buffer_load_dwordx4 v[160:163], v217, s[8:11], s55 offen offset:0 sc1
  buffer_load_dwordx4 v[164:167], v217, s[8:11], s55 offen offset:256 sc1
  s_or_b32 s70, s73, 0xc00
  buffer_load_dword v172, off, s[8:11], s70 sc1
  s_add_u32 s60, s60, 73728
  ds_read_b128 v[32:35], v203 offset:36864
  ds_read_b128 v[36:39], v204 offset:36864
  ds_read_b128 v[40:43], v205 offset:36864
  s_waitcnt lgkmcnt(2)
  v_mfma_f32_32x32x16_bf16 v[240:255], a[0:3], v[32:35], 0
  ds_read_b128 v[44:47], v206 offset:36864
  s_add_u32 m0, s67, 0
  s_nop 0
  buffer_load_dwordx4 v202, s[4:7], s60 offen offset:0 lds
  s_waitcnt lgkmcnt(2)
  v_mfma_f32_32x32x16_bf16 v[240:255], a[4:7], v[36:39], v[240:255]
  ds_read_b128 v[32:35], v203 offset:37888
  s_waitcnt lgkmcnt(2)
  v_mfma_f32_32x32x16_bf16 v[240:255], a[8:11], v[40:43], v[240:255]
  ds_read_b128 v[36:39], v204 offset:37888
  s_add_u32 m0, s67, 896
  s_nop 0
  buffer_load_dwordx4 v202, s[4:7], s60 offen offset:128 lds
  s_waitcnt lgkmcnt(2)
  v_mfma_f32_32x32x16_bf16 v[240:255], a[12:15], v[44:47], v[240:255]
  ds_read_b128 v[40:43], v205 offset:37888
  s_waitcnt lgkmcnt(2)
  v_mfma_f32_32x32x16_bf16 v[240:255], a[16:19], v[32:35], v[240:255]
  ds_read_b128 v[44:47], v206 offset:37888
  s_add_u32 m0, s67, 1792
  s_nop 0
  buffer_load_dwordx4 v202, s[4:7], s60 offen offset:256 lds
  s_waitcnt lgkmcnt(2)
  v_mfma_f32_32x32x16_bf16 v[240:255], a[20:23], v[36:39], v[240:255]
  ds_read_b128 v[32:35], v203 offset:38912
  s_waitcnt lgkmcnt(2)
  v_mfma_f32_32x32x16_bf16 v[240:255], a[24:27], v[40:43], v[240:255]
  ds_read_b128 v[36:39], v204 offset:38912
  s_add_u32 m0, s67, 2688
  s_nop 0
  buffer_load_dwordx4 v202, s[4:7], s60 offen offset:384 lds
  s_waitcnt lgkmcnt(2)
  v_mfma_f32_32x32x16_bf16 v[240:255], a[28:31], v[44:47], v[240:255]
  ds_read_b128 v[40:43], v205 offset:38912
  s_waitcnt lgkmcnt(2)
  v_mfma_f32_32x32x16_bf16 v[240:255], a[32:35], v[32:35], v[240:255]
  ds_read_b128 v[44:47], v206 offset:38912
  s_add_u32 m0, s67, 3584
  s_nop 0
  buffer_load_dwordx4 v202, s[4:7], s60 offen offset:512 lds
  s_waitcnt lgkmcnt(2)
  v_mfma_f32_32x32x16_bf16 v[240:255], a[36:39], v[36:39], v[240:255]
  ds_read_b128 v[32:35], v203 offset:39936
  s_waitcnt lgkmcnt(2)
  v_mfma_f32_32x32x16_bf16 v[240:255], a[40:43], v[40:43], v[240:255]
  ds_read_b128 v[36:39], v204 offset:39936
  s_add_u32 m0, s67, 4480
  s_nop 0
  buffer_load_dwordx4 v202, s[4:7], s60 offen offset:640 lds
  s_waitcnt lgkmcnt(2)
  v_mfma_f32_32x32x16_bf16 v[240:255], a[44:47], v[44:47], v[240:255]
  ds_read_b128 v[40:43], v205 offset:39936
  s_waitcnt lgkmcnt(2)
  v_mfma_f32_32x32x16_bf16 v[240:255], a[48:51], v[32:35], v[240:255]
  ds_read_b128 v[44:47], v206 offset:39936
  s_add_u32 m0, s67, 5376
  s_nop 0
  buffer_load_dwordx4 v202, s[4:7], s60 offen offset:768 lds
  s_waitcnt lgkmcnt(2)
  v_mfma_f32_32x32x16_bf16 v[240:255], a[52:55], v[36:39], v[240:255]
  ds_read_b128 v[32:35], v203 offset:40960
  s_waitcnt lgkmcnt(2)
  v_mfma_f32_32x32x16_bf16 v[240:255], a[56:59], v[40:43], v[240:255]
  ds_read_b128 v[36:39], v204 offset:40960
  s_add_u32 m0, s67, 6272
  s_nop 0
  buffer_load_dwordx4 v202, s[4:7], s60 offen offset:896 lds
  s_waitcnt lgkmcnt(2)
  v_mfma_f32_32x32x16_bf16 v[240:255], a[60:63], v[44:47], v[240:255]
  ds_read_b128 v[40:43], v205 offset:40960
  s_waitcnt lgkmcnt(2)
  v_mfma_f32_32x32x16_bf16 v[240:255], a[64:67], v[32:35], v[240:255]
  ds_read_b128 v[44:47], v206 offset:40960
  s_add_u32 m0, s67, 7168
  s_nop 0
  buffer_load_dwordx4 v202, s[4:7], s60 offen offset:1024 lds
  s_waitcnt lgkmcnt(2)
  v_mfma_f32_32x32x16_bf16 v[240:255], a[68:71], v[36:39], v[240:255]
  ds_read_b128 v[32:35], v203 offset:41984
  s_waitcnt lgkmcnt(2)
  v_mfma_f32_32x32x16_bf16 v[240:255], a[72:75], v[40:43], v[240:255]
  ds_read_b128 v[36:39], v204 offset:41984
  buffer_store_dwordx4 v[176:179], v201, s[8:11], s75 offen offset:0 sc1
  s_waitcnt lgkmcnt(2)
  v_mfma_f32_32x32x16_bf16 v[240:255], a[76:79], v[44:47], v[240:255]
  ds_read_b128 v[40:43], v205 offset:41984
  s_waitcnt lgkmcnt(2)
  v_mfma_f32_32x32x16_bf16 v[240:255], a[80:83], v[32:35], v[240:255]
  ds_read_b128 v[44:47], v206 offset:41984
  buffer_store_dwordx4 v[176:179], v201, s[8:11], s75 offen offset:1024 sc1
  s_waitcnt lgkmcnt(2)
  v_mfma_f32_32x32x16_bf16 v[240:255], a[84:87], v[36:39], v[240:255]
  ds_read_b128 v[32:35], v203 offset:43008
  s_waitcnt lgkmcnt(2)
  v_mfma_f32_32x32x16_bf16 v[240:255], a[88:91], v[40:43], v[240:255]
  ds_read_b128 v[36:39], v204 offset:43008
  s_waitcnt lgkmcnt(2)
  v_mfma_f32_32x32x16_bf16 v[240:255], a[92:95], v[44:47], v[240:255]
  ds_read_b128 v[40:43], v205 offset:43008
  s_waitcnt lgkmcnt(2)
  v_mfma_f32_32x32x16_bf16 v[240:255], a[96:99], v[32:35], v[240:255]
  ds_read_b128 v[44:47], v206 offset:43008
  s_waitcnt lgkmcnt(2)
  v_mfma_f32_32x32x16_bf16 v[240:255], a[100:103], v[36:39], v[240:255]
  ds_read_b128 v[32:35], v203 offset:44032
  s_waitcnt lgkmcnt(2)
  v_mfma_f32_32x32x16_bf16 v[240:255], a[104:107], v[40:43], v[240:255]
  ds_read_b128 v[36:39], v204 offset:44032
  s_waitcnt lgkmcnt(2)
  v_mfma_f32_32x32x16_bf16 v[240:255], a[108:111], v[44:47], v[240:255]
  ds_read_b128 v[40:43], v205 offset:44032
  s_waitcnt lgkmcnt(2)
  v_mfma_f32_32x32x16_bf16 v[240:255], a[112:115], v[32:35], v[240:255]
  ds_read_b128 v[44:47], v206 offset:44032
  s_waitcnt lgkmcnt(2)
  v_mfma_f32_32x32x16_bf16 v[240:255], a[116:119], v[36:39], v[240:255]
  ds_read_b128 v[32:35], v203 offset:45056
  s_waitcnt lgkmcnt(2)
  v_mfma_f32_32x32x16_bf16 v[240:255], a[120:123], v[40:43], v[240:255]
  ds_read_b128 v[36:39], v204 offset:45056
  s_waitcnt lgkmcnt(2)
  v_mfma_f32_32x32x16_bf16 v[240:255], a[124:127], v[44:47], v[240:255]
  ds_read_b128 v[40:43], v205 offset:45056
  s_waitcnt lgkmcnt(2)
  v_mfma_f32_32x32x16_bf16 v[240:255], a[128:131], v[32:35], v[240:255]
  ds_read_b128 v[44:47], v206 offset:45056
  s_waitcnt lgkmcnt(2)
  v_mfma_f32_32x32x16_bf16 v[240:255], a[132:135], v[36:39], v[240:255]
  s_waitcnt lgkmcnt(1)
  v_mfma_f32_32x32x16_bf16 v[240:255], a[136:139], v[40:43], v[240:255]
  s_waitcnt lgkmcnt(0)
  v_mfma_f32_32x32x16_bf16 v[240:255], a[140:143], v[44:47], v[240:255]
  s_nop 11
  v_cvt_pk_bf16_f32 v16, v240, v244
  v_cvt_pk_bf16_f32 v17, v241, v245
  v_cvt_pk_bf16_f32 v18, v242, v246
  v_cvt_pk_bf16_f32 v19, v243, v247
  ds_write_b128 v215, v[16:19] offset:0
  v_cvt_pk_bf16_f32 v20, v248, v252
  v_cvt_pk_bf16_f32 v21, v249, v253
  v_cvt_pk_bf16_f32 v22, v250, v254
  v_cvt_pk_bf16_f32 v23, v251, v255
  ds_write_b128 v215, v[20:23] offset:1024
  s_waitcnt lgkmcnt(0)
  s_barrier
  ds_read_b128 a[144:147], v208 offset:0
  ds_read_b128 a[148:151], v208 offset:1024
  ds_read_b128 a[152:155], v208 offset:2048
  ds_read_b128 a[156:159], v208 offset:3072
  ds_read_b128 a[160:163], v208 offset:4096
  ds_read_b128 a[164:167], v208 offset:5120
  ds_read_b128 a[168:171], v208 offset:6144
  ds_read_b128 a[172:175], v208 offset:7168
  s_waitcnt vmcnt(11)
  v_cmp_eq_u32 vcc, -1, v172
  s_mov_b32 s69, 0
  s_cbranch_vccnz AT_e1
  s_mov_b32 s69, 1
  buffer_load_dwordx4 v[172:175], v201, s[8:11], s73 offen sc1
AT_e1:
  s_waitcnt lgkmcnt(7)
  v_mfma_f32_32x32x16_bf16 v[64:79], v[128:131], a[144:147], v[48:63]
  s_waitcnt lgkmcnt(6)
  v_mfma_f32_32x32x16_bf16 v[64:79], v[132:135], a[148:151], v[64:79]
  s_waitcnt lgkmcnt(5)
  v_mfma_f32_32x32x16_bf16 v[64:79], v[136:139], a[152:155], v[64:79]
  s_waitcnt lgkmcnt(4)
  v_mfma_f32_32x32x16_bf16 v[64:79], v[140:143], a[156:159], v[64:79]
  s_waitcnt lgkmcnt(3)
  v_mfma_f32_32x32x16_bf16 v[64:79], v[144:147], a[160:163], v[64:79]
  s_waitcnt lgkmcnt(2)
  v_mfma_f32_32x32x16_bf16 v[64:79], v[148:151], a[164:167], v[64:79]
  s_waitcnt lgkmcnt(1)
  v_mfma_f32_32x32x16_bf16 v[64:79], v[152:155], a[168:171], v[64:79]
  s_waitcnt lgkmcnt(0)
  v_mfma_f32_32x32x16_bf16 v[64:79], v[156:159], a[172:175], v[64:79]
  s_nop 11
  v_max3_f32 v184, v64, v65, v66
  v_max3_f32 v184, v184, v67, v68
  v_max3_f32 v184, v184, v69, v70
  v_max3_f32 v184, v184, v71, v72
  v_max3_f32 v184, v184, v73, v74
  v_max3_f32 v184, v184, v75, v76
  v_max3_f32 v184, v184, v77, v78
  v_max_f32 v184, v184, v79
  v_mov_b32 v185, v184
  s_nop 1
  v_permlane32_swap_b32 v184, v185
  v_max_f32 v184, v184, v185
  v_sub_f32 v64, v64, v184
  v_sub_f32 v65, v65, v184
  v_sub_f32 v66, v66, v184
  v_sub_f32 v67, v67, v184
  v_sub_f32 v68, v68, v184
  v_sub_f32 v69, v69, v184
  v_sub_f32 v70, v70, v184
  v_sub_f32 v71, v71, v184
  v_sub_f32 v72, v72, v184
  v_sub_f32 v73, v73, v184
  v_sub_f32 v74, v74, v184
  v_sub_f32 v75, v75, v184
  v_sub_f32 v76, v76, v184
  v_sub_f32 v77, v77, v184
  v_sub_f32 v78, v78, v184
  v_sub_f32 v79, v79, v184
  v_exp_f32 v64, v64
  v_exp_f32 v65, v65
  v_exp_f32 v66, v66
  v_exp_f32 v67, v67
  v_exp_f32 v68, v68
  v_exp_f32 v69, v69
  v_exp_f32 v70, v70
  v_exp_f32 v71, v71
  v_exp_f32 v72, v72
  v_exp_f32 v73, v73
  v_exp_f32 v74, v74
  v_exp_f32 v75, v75
  v_exp_f32 v76, v76
  v_exp_f32 v77, v77
  v_exp_f32 v78, v78
  v_exp_f32 v79, v79
  v_cvt_pk_bf16_f32 v20, v64, v65
  v_cvt_pk_bf16_f32 v21, v68, v69
  v_cvt_pk_bf16_f32 v22, v72, v73
  v_cvt_pk_bf16_f32 v23, v76, v77
  v_cvt_pk_bf16_f32 v24, v66, v67
  v_cvt_pk_bf16_f32 v25, v70, v71
  v_cvt_pk_bf16_f32 v26, v74, v75
  v_cvt_pk_bf16_f32 v27, v78, v79
  v_mfma_f32_32x32x16_bf16 v[224:239], v[160:163], v[20:23], 0
  v_add_f32 v186, v64, v65
  v_add_f32 v186, v186, v66
  v_add_f32 v186, v186, v67
  v_add_f32 v186, v186, v68
  v_add_f32 v186, v186, v69
  v_add_f32 v186, v186, v70
  v_add_f32 v186, v186, v71
  v_mfma_f32_32x32x16_bf16 v[224:239], v[164:167], v[24:27], v[224:239]
  v_add_f32 v186, v186, v72
  v_add_f32 v186, v186, v73
  v_add_f32 v186, v186, v74
  v_add_f32 v186, v186, v75
  v_add_f32 v186, v186, v76
  v_add_f32 v186, v186, v77
  v_add_f32 v186, v186, v78
  v_add_f32 v186, v186, v79
AT_l0:
  s_cmp_eq_u32 s69, 1
  s_cbranch_scc1 AT_v0
  s_or_b32 s70, s73, 0xc00
  s_cmp_eq_u32 s74, 63
  s_cselect_b32 s54, 655360, 0
  s_sub_u32 s70, s70, s54
  s_branch AT_c0
AT_h0:
  s_sleep 1
AT_c0:
  buffer_load_dword v172, off, s[8:11], s70 sc1
  s_add_u32 s65, s65, 1
  s_cmp_lt_u32 s65, 131072
  s_cselect_b32 s54, -2, -1
  s_waitcnt vmcnt(0)
  v_cmp_lt_u32 vcc, s54, v172
  s_cbranch_vccnz AT_h0
AT_k0:
  buffer_load_dwordx4 v[172:175], v201, s[8:11], s73 offen sc1
AT_v0:
  s_mov_b32 s69, 0
  s_add_u32 s65, s65, 1
  s_cmp_lt_u32 s65, 131072
  s_cselect_b32 s54, -2, -1
  s_waitcnt vmcnt(0)
  ds_write_b64 v220, v[172:173] offset:0
  ds_write_b64 v221, v[174:175] offset:0
  v_max3_u32 v213, v172, v173, v174
  v_max_u32 v213, v213, v175
  v_cmp_lt_u32 vcc, s54, v213
  s_cbranch_vccnz AT_k0
  s_waitcnt lgkmcnt(0)
  s_barrier
  ds_read_b128 v[128:131], v218 offset:0
  ds_read_b128 v[132:135], v218 offset:256
  ds_read_b128 v[136:139], v218 offset:512
  ds_read_b128 v[140:143], v218 offset:768
  ds_read_b128 v[144:147], v218 offset:1024
  ds_read_b128 v[148:151], v218 offset:1280
  ds_read_b128 v[152:155], v218 offset:1536
  ds_read_b128 v[156:159], v218 offset:1792
  ds_read_b32 v168, v219 offset:0
  ds_read_b32 v169, v219 offset:128
  s_add_u32 s74, s74, 2
  v_mov_b32 v212, s74
  s_waitcnt lgkmcnt(9)
  v_mfma_f32_32x32x16_bf16 v[80:95], v[128:131], v[96:99], 0
  s_waitcnt lgkmcnt(8)
  v_mfma_f32_32x32x16_bf16 v[80:95], v[132:135], v[100:103], v[80:95]
  s_waitcnt lgkmcnt(7)
  v_mfma_f32_32x32x16_bf16 v[80:95], v[136:139], v[104:107], v[80:95]
  s_waitcnt lgkmcnt(6)
  v_mfma_f32_32x32x16_bf16 v[80:95], v[140:143], v[108:111], v[80:95]
  s_mov_b64 exec, 1
  buffer_store_dword v212, v201, s[8:11], s71 offen sc1
  s_mov_b64 exec, -1
  s_waitcnt lgkmcnt(5)
  v_mfma_f32_32x32x16_bf16 v[80:95], v[144:147], v[112:115], v[80:95]
  s_waitcnt lgkmcnt(4)
  v_mfma_f32_32x32x16_bf16 v[80:95], v[148:151], v[116:119], v[80:95]
  s_waitcnt lgkmcnt(3)
  v_mfma_f32_32x32x16_bf16 v[80:95], v[152:155], v[120:123], v[80:95]
  s_waitcnt lgkmcnt(2)
  v_mfma_f32_32x32x16_bf16 v[80:95], v[156:159], v[124:127], v[80:95]
  s_nop 11
  v_mul_f32 v80, s68, v80
  v_mul_f32 v81, s68, v81
  v_mul_f32 v82, s68, v82
  v_mul_f32 v83, s68, v83
  v_max3_f32 v84, v180, v80, v81
  v_max3_f32 v84, v84, v82, v83
  v_mov_b32 v85, v84
  s_nop 1
  v_permlane32_swap_b32 v84, v85
  v_max_f32 v84, v84, v85
  v_sub_f32 v86, v180, v84
  v_sub_f32 v80, v80, v84
  v_sub_f32 v81, v81, v84
  v_sub_f32 v82, v82, v84
  v_sub_f32 v83, v83, v84
  v_exp_f32 v86, v86
  v_exp_f32 v80, v80
  v_exp_f32 v81, v81
  v_exp_f32 v82, v82
  v_exp_f32 v83, v83
  v_fma_f32 v182, v182, v86, v80
  v_add_f32 v84, v81, v82
  v_add_f32 v182, v182, v83
  v_add_f32 v182, v182, v84
  v_mov_b32 v183, v182
  s_nop 1
  v_permlane32_swap_b32 v182, v183
  v_add_f32 v182, v182, v183
  v_rcp_f32 v182, v182
  s_nop 0
  v_mul_f32 v86, v86, v182
  v_mul_f32 v80, v182, v80
  v_mul_f32 v81, v182, v81
  v_mul_f32 v82, v182, v82
  v_mul_f32 v83, v182, v83
  v_cvt_pk_bf16_f32 v28, v80, v81
  v_cvt_pk_bf16_f32 v29, v82, v83
  v_mul_f32 v0, v86, v0
  v_mul_f32 v1, v86, v1
  v_mul_f32 v2, v86, v2
  v_mul_f32 v3, v86, v3
  v_mul_f32 v4, v86, v4
  v_mul_f32 v5, v86, v5
  v_mul_f32 v6, v86, v6
  v_mul_f32 v7, v86, v7
  v_mul_f32 v8, v86, v8
  v_mul_f32 v9, v86, v9
  v_mul_f32 v10, v86, v10
  v_mul_f32 v11, v86, v11
  v_mul_f32 v12, v86, v12
  v_mul_f32 v13, v86, v13
  v_mul_f32 v14, v86, v14
  v_mul_f32 v15, v86, v15
  s_waitcnt lgkmcnt(0)
  s_nop 0
  v_mfma_f32_32x32x8_bf16 v[0:15], v[168:169], v[28:29], v[0:15]
  s_nop 11
  v_cvt_pk_bf16_f32 v20, v0, v1
  v_cvt_pk_bf16_f32 v21, v2, v3
  v_cvt_pk_bf16_f32 v22, v4, v5
  v_cvt_pk_bf16_f32 v23, v6, v7
  buffer_store_dwordx4 v[20:23], v201, s[8:11], s72 offen offset:0 sc1
  v_cvt_pk_bf16_f32 v24, v8, v9
  v_cvt_pk_bf16_f32 v25, v10, v11
  v_cvt_pk_bf16_f32 v26, v12, v13
  v_cvt_pk_bf16_f32 v27, v14, v15
  buffer_store_dwordx4 v[24:27], v201, s[8:11], s72 offen offset:1024 sc1
  s_cmp_ge_u32 s74, 64
  s_cbranch_scc1 L_exit
  s_cmp_ge_u32 s59, 64
  s_cbranch_scc1 AT_l1
  s_mov_b32 s74, s59
  s_mul_i32 s66, s59, 655360
  s_lshl_b32 s55, s58, 14
  s_add_u32 s55, s55, s66
  s_add_u32 s55, s55, 1048576
  s_lshl_b32 s73, s58, 2
  s_add_u32 s73, s73, s52
  s_lshl_b32 s72, s59, 7
  s_add_u32 s72, s72, s73
  s_lshl_b32 s72, s72, 11
  s_add_u32 s72, s72, 46137344
  s_lshl_b32 s73, s73, 10
  s_add_u32 s73, s73, s66
  s_add_u32 s73, s73, 1572864
  s_add_u32 s59, s59, 2
  buffer_load_dwordx4 v[128:131], v216, s[8:11], s55 offen offset:0 sc1
  buffer_load_dwordx4 v[132:135], v216, s[8:11], s55 offen offset:256 sc1
  buffer_load_dwordx4 v[136:139], v216, s[8:11], s55 offen offset:512 sc1
  buffer_load_dwordx4 v[140:143], v216, s[8:11], s55 offen offset:768 sc1
  buffer_load_dwordx4 v[144:147], v216, s[8:11], s55 offen offset:1024 sc1
  buffer_load_dwordx4 v[148:151], v216, s[8:11], s55 offen offset:1280 sc1
  buffer_load_dwordx4 v[152:155], v216, s[8:11], s55 offen offset:1536 sc1
  buffer_load_dwordx4 v[156:159], v216, s[8:11], s55 offen offset:1792 sc1
  buffer_load_dwordx4 v[160:163], v217, s[8:11], s55 offen offset:0 sc1
  buffer_load_dwordx4 v[164:167], v217, s[8:11], s55 offen offset:256 sc1
  s_or_b32 s70, s76, 0xc00
  buffer_load_dword v172, off, s[8:11], s70 sc1
  s_add_u32 s60, s60, 73728
  ds_read_b128 v[32:35], v203 offset:0
  ds_read_b128 v[36:39], v204 offset:0
  ds_read_b128 v[40:43], v205 offset:0
  s_waitcnt lgkmcnt(2)
  v_mfma_f32_32x32x16_bf16 v[240:255], a[0:3], v[32:35], 0
  ds_read_b128 v[44:47], v206 offset:0
  s_add_u32 m0, s67, 36864
  s_nop 0
  buffer_load_dwordx4 v202, s[4:7], s60 offen offset:0 lds
  s_waitcnt lgkmcnt(2)
  v_mfma_f32_32x32x16_bf16 v[240:255], a[4:7], v[36:39], v[240:255]
  ds_read_b128 v[32:35], v203 offset:1024
  s_waitcnt lgkmcnt(2)
  v_mfma_f32_32x32x16_bf16 v[240:255], a[8:11], v[40:43], v[240:255]
  ds_read_b128 v[36:39], v204 offset:1024
  s_add_u32 m0, s67, 37760
  s_nop 0
  buffer_load_dwordx4 v202, s[4:7], s60 offen offset:128 lds
  s_waitcnt lgkmcnt(2)
  v_mfma_f32_32x32x16_bf16 v[240:255], a[12:15], v[44:47], v[240:255]
  ds_read_b128 v[40:43], v205 offset:1024
  s_waitcnt lgkmcnt(2)
  v_mfma_f32_32x32x16_bf16 v[240:255], a[16:19], v[32:35], v[240:255]
  ds_read_b128 v[44:47], v206 offset:1024
  s_add_u32 m0, s67, 38656
  s_nop 0
  buffer_load_dwordx4 v202, s[4:7], s60 offen offset:256 lds
  s_waitcnt lgkmcnt(2)
  v_mfma_f32_32x32x16_bf16 v[240:255], a[20:23], v[36:39], v[240:255]
  ds_read_b128 v[32:35], v203 offset:2048
  s_waitcnt lgkmcnt(2)
  v_mfma_f32_32x32x16_bf16 v[240:255], a[24:27], v[40:43], v[240:255]
  ds_read_b128 v[36:39], v204 offset:2048
  s_add_u32 m0, s67, 39552
  s_nop 0
  buffer_load_dwordx4 v202, s[4:7], s60 offen offset:384 lds
  s_waitcnt lgkmcnt(2)
  v_mfma_f32_32x32x16_bf16 v[240:255], a[28:31], v[44:47], v[240:255]
  ds_read_b128 v[40:43], v205 offset:2048
  s_waitcnt lgkmcnt(2)
  v_mfma_f32_32x32x16_bf16 v[240:255], a[32:35], v[32:35], v[240:255]
  ds_read_b128 v[44:47], v206 offset:2048
  s_add_u32 m0, s67, 40448
  s_nop 0
  buffer_load_dwordx4 v202, s[4:7], s60 offen offset:512 lds
  s_waitcnt lgkmcnt(2)
  v_mfma_f32_32x32x16_bf16 v[240:255], a[36:39], v[36:39], v[240:255]
  ds_read_b128 v[32:35], v203 offset:3072
  s_waitcnt lgkmcnt(2)
  v_mfma_f32_32x32x16_bf16 v[240:255], a[40:43], v[40:43], v[240:255]
  ds_read_b128 v[36:39], v204 offset:3072
  s_add_u32 m0, s67, 41344
  s_nop 0
  buffer_load_dwordx4 v202, s[4:7], s60 offen offset:640 lds
  s_waitcnt lgkmcnt(2)
  v_mfma_f32_32x32x16_bf16 v[240:255], a[44:47], v[44:47], v[240:255]
  ds_read_b128 v[40:43], v205 offset:3072
  s_waitcnt lgkmcnt(2)
  v_mfma_f32_32x32x16_bf16 v[240:255], a[48:51], v[32:35], v[240:255]
  ds_read_b128 v[44:47], v206 offset:3072
  s_add_u32 m0, s67, 42240
  s_nop 0
  buffer_load_dwordx4 v202, s[4:7], s60 offen offset:768 lds
  s_waitcnt lgkmcnt(2)
  v_mfma_f32_32x32x16_bf16 v[240:255], a[52:55], v[36:39], v[240:255]
  ds_read_b128 v[32:35], v203 offset:4096
  s_waitcnt lgkmcnt(2)
  v_mfma_f32_32x32x16_bf16 v[240:255], a[56:59], v[40:43], v[240:255]
  ds_read_b128 v[36:39], v204 offset:4096
  s_add_u32 m0, s67, 43136
  s_nop 0
  buffer_load_dwordx4 v202, s[4:7], s60 offen offset:896 lds
  s_waitcnt lgkmcnt(2)
  v_mfma_f32_32x32x16_bf16 v[240:255], a[60:63], v[44:47], v[240:255]
  ds_read_b128 v[40:43], v205 offset:4096
  s_waitcnt lgkmcnt(2)
  v_mfma_f32_32x32x16_bf16 v[240:255], a[64:67], v[32:35], v[240:255]
  ds_read_b128 v[44:47], v206 offset:4096
  s_add_u32 m0, s67, 44032
  s_nop 0
  buffer_load_dwordx4 v202, s[4:7], s60 offen offset:1024 lds
  s_waitcnt lgkmcnt(2)
  v_mfma_f32_32x32x16_bf16 v[240:255], a[68:71], v[36:39], v[240:255]
  ds_read_b128 v[32:35], v203 offset:5120
  s_waitcnt lgkmcnt(2)
  v_mfma_f32_32x32x16_bf16 v[240:255], a[72:75], v[40:43], v[240:255]
  ds_read_b128 v[36:39], v204 offset:5120
  buffer_store_dwordx4 v[176:179], v201, s[8:11], s72 offen offset:0 sc1
  s_waitcnt lgkmcnt(2)
  v_mfma_f32_32x32x16_bf16 v[240:255], a[76:79], v[44:47], v[240:255]
  ds_read_b128 v[40:43], v205 offset:5120
  s_waitcnt lgkmcnt(2)
  v_mfma_f32_32x32x16_bf16 v[240:255], a[80:83], v[32:35], v[240:255]
  ds_read_b128 v[44:47], v206 offset:5120
  buffer_store_dwordx4 v[176:179], v201, s[8:11], s72 offen offset:1024 sc1
  s_waitcnt lgkmcnt(2)
  v_mfma_f32_32x32x16_bf16 v[240:255], a[84:87], v[36:39], v[240:255]
  ds_read_b128 v[32:35], v203 offset:6144
  s_waitcnt lgkmcnt(2)
  v_mfma_f32_32x32x16_bf16 v[240:255], a[88:91], v[40:43], v[240:255]
  ds_read_b128 v[36:39], v204 offset:6144
  s_waitcnt lgkmcnt(2)
  v_mfma_f32_32x32x16_bf16 v[240:255], a[92:95], v[44:47], v[240:255]
  ds_read_b128 v[40:43], v205 offset:6144
  s_waitcnt lgkmcnt(2)
  v_mfma_f32_32x32x16_bf16 v[240:255], a[96:99], v[32:35], v[240:255]
  ds_read_b128 v[44:47], v206 offset:6144
  s_waitcnt lgkmcnt(2)
  v_mfma_f32_32x32x16_bf16 v[240:255], a[100:103], v[36:39], v[240:255]
  ds_read_b128 v[32:35], v203 offset:7168
  s_waitcnt lgkmcnt(2)
  v_mfma_f32_32x32x16_bf16 v[240:255], a[104:107], v[40:43], v[240:255]
  ds_read_b128 v[36:39], v204 offset:7168
  s_waitcnt lgkmcnt(2)
  v_mfma_f32_32x32x16_bf16 v[240:255], a[108:111], v[44:47], v[240:255]
  ds_read_b128 v[40:43], v205 offset:7168
  s_waitcnt lgkmcnt(2)
  v_mfma_f32_32x32x16_bf16 v[240:255], a[112:115], v[32:35], v[240:255]
  ds_read_b128 v[44:47], v206 offset:7168
  s_waitcnt lgkmcnt(2)
  v_mfma_f32_32x32x16_bf16 v[240:255], a[116:119], v[36:39], v[240:255]
  ds_read_b128 v[32:35], v203 offset:8192
  s_waitcnt lgkmcnt(2)
  v_mfma_f32_32x32x16_bf16 v[240:255], a[120:123], v[40:43], v[240:255]
  ds_read_b128 v[36:39], v204 offset:8192
  s_waitcnt lgkmcnt(2)
  v_mfma_f32_32x32x16_bf16 v[240:255], a[124:127], v[44:47], v[240:255]
  ds_read_b128 v[40:43], v205 offset:8192
  s_waitcnt lgkmcnt(2)
  v_mfma_f32_32x32x16_bf16 v[240:255], a[128:131], v[32:35], v[240:255]
  ds_read_b128 v[44:47], v206 offset:8192
  s_waitcnt lgkmcnt(2)
  v_mfma_f32_32x32x16_bf16 v[240:255], a[132:135], v[36:39], v[240:255]
  s_waitcnt lgkmcnt(1)
  v_mfma_f32_32x32x16_bf16 v[240:255], a[136:139], v[40:43], v[240:255]
  s_waitcnt lgkmcnt(0)
  v_mfma_f32_32x32x16_bf16 v[240:255], a[140:143], v[44:47], v[240:255]
  s_nop 11
  v_cvt_pk_bf16_f32 v16, v240, v244
  v_cvt_pk_bf16_f32 v17, v241, v245
  v_cvt_pk_bf16_f32 v18, v242, v246
  v_cvt_pk_bf16_f32 v19, v243, v247
  ds_write_b128 v215, v[16:19] offset:0
  v_cvt_pk_bf16_f32 v20, v248, v252
  v_cvt_pk_bf16_f32 v21, v249, v253
  v_cvt_pk_bf16_f32 v22, v250, v254
  v_cvt_pk_bf16_f32 v23, v251, v255
  ds_write_b128 v215, v[20:23] offset:1024
  s_waitcnt lgkmcnt(0)
  s_barrier
  ds_read_b128 v[96:99], v208 offset:0
  ds_read_b128 v[100:103], v208 offset:1024
  ds_read_b128 v[104:107], v208 offset:2048
  ds_read_b128 v[108:111], v208 offset:3072
  ds_read_b128 v[112:115], v208 offset:4096
  ds_read_b128 v[116:119], v208 offset:5120
  ds_read_b128 v[120:123], v208 offset:6144
  ds_read_b128 v[124:127], v208 offset:7168
  s_waitcnt vmcnt(11)
  v_cmp_eq_u32 vcc, -1, v172
  s_mov_b32 s69, 0
  s_cbranch_vccnz AT_e0
  s_mov_b32 s69, 1
  buffer_load_dwordx4 v[172:175], v201, s[8:11], s76 offen sc1
AT_e0:
  s_waitcnt lgkmcnt(7)
  v_mfma_f32_32x32x16_bf16 v[64:79], v[128:131], v[96:99], v[48:63]
  s_waitcnt lgkmcnt(6)
  v_mfma_f32_32x32x16_bf16 v[64:79], v[132:135], v[100:103], v[64:79]
  s_waitcnt lgkmcnt(5)
  v_mfma_f32_32x32x16_bf16 v[64:79], v[136:139], v[104:107], v[64:79]
  s_waitcnt lgkmcnt(4)
  v_mfma_f32_32x32x16_bf16 v[64:79], v[140:143], v[108:111], v[64:79]
  s_waitcnt lgkmcnt(3)
  v_mfma_f32_32x32x16_bf16 v[64:79], v[144:147], v[112:115], v[64:79]
  s_waitcnt lgkmcnt(2)
  v_mfma_f32_32x32x16_bf16 v[64:79], v[148:151], v[116:119], v[64:79]
  s_waitcnt lgkmcnt(1)
  v_mfma_f32_32x32x16_bf16 v[64:79], v[152:155], v[120:123], v[64:79]
  s_waitcnt lgkmcnt(0)
  v_mfma_f32_32x32x16_bf16 v[64:79], v[156:159], v[124:127], v[64:79]
  s_nop 11
  v_max3_f32 v180, v64, v65, v66
  v_max3_f32 v180, v180, v67, v68
  v_max3_f32 v180, v180, v69, v70
  v_max3_f32 v180, v180, v71, v72
  v_max3_f32 v180, v180, v73, v74
  v_max3_f32 v180, v180, v75, v76
  v_max3_f32 v180, v180, v77, v78
  v_max_f32 v180, v180, v79
  v_mov_b32 v181, v180
  s_nop 1
  v_permlane32_swap_b32 v180, v181
  v_max_f32 v180, v180, v181
  v_sub_f32 v64, v64, v180
  v_sub_f32 v65, v65, v180
  v_sub_f32 v66, v66, v180
  v_sub_f32 v67, v67, v180
  v_sub_f32 v68, v68, v180
  v_sub_f32 v69, v69, v180
  v_sub_f32 v70, v70, v180
  v_sub_f32 v71, v71, v180
  v_sub_f32 v72, v72, v180
  v_sub_f32 v73, v73, v180
  v_sub_f32 v74, v74, v180
  v_sub_f32 v75, v75, v180
  v_sub_f32 v76, v76, v180
  v_sub_f32 v77, v77, v180
  v_sub_f32 v78, v78, v180
  v_sub_f32 v79, v79, v180
  v_exp_f32 v64, v64
  v_exp_f32 v65, v65
  v_exp_f32 v66, v66
  v_exp_f32 v67, v67
  v_exp_f32 v68, v68
  v_exp_f32 v69, v69
  v_exp_f32 v70, v70
  v_exp_f32 v71, v71
  v_exp_f32 v72, v72
  v_exp_f32 v73, v73
  v_exp_f32 v74, v74
  v_exp_f32 v75, v75
  v_exp_f32 v76, v76
  v_exp_f32 v77, v77
  v_exp_f32 v78, v78
  v_exp_f32 v79, v79
  v_cvt_pk_bf16_f32 v20, v64, v65
  v_cvt_pk_bf16_f32 v21, v68, v69
  v_cvt_pk_bf16_f32 v22, v72, v73
  v_cvt_pk_bf16_f32 v23, v76, v77
  v_cvt_pk_bf16_f32 v24, v66, v67
  v_cvt_pk_bf16_f32 v25, v70, v71
  v_cvt_pk_bf16_f32 v26, v74, v75
  v_cvt_pk_bf16_f32 v27, v78, v79
  v_mfma_f32_32x32x16_bf16 v[0:15], v[160:163], v[20:23], 0
  v_add_f32 v182, v64, v65
  v_add_f32 v182, v182, v66
  v_add_f32 v182, v182, v67
  v_add_f32 v182, v182, v68
  v_add_f32 v182, v182, v69
  v_add_f32 v182, v182, v70
  v_add_f32 v182, v182, v71
  v_mfma_f32_32x32x16_bf16 v[0:15], v[164:167], v[24:27], v[0:15]
  v_add_f32 v182, v182, v72
  v_add_f32 v182, v182, v73
  v_add_f32 v182, v182, v74
  v_add_f32 v182, v182, v75
  v_add_f32 v182, v182, v76
  v_add_f32 v182, v182, v77
  v_add_f32 v182, v182, v78
  v_add_f32 v182, v182, v79
AT_l1:
  s_cmp_eq_u32 s69, 1
  s_cbranch_scc1 AT_v1
  s_or_b32 s70, s76, 0xc00
  s_cmp_eq_u32 s77, 63
  s_cselect_b32 s54, 655360, 0
  s_sub_u32 s70, s70, s54
  s_branch AT_c1
AT_h1:
  s_sleep 1
AT_c1:
  buffer_load_dword v172, off, s[8:11], s70 sc1
  s_add_u32 s65, s65, 1
  s_cmp_lt_u32 s65, 131072
  s_cselect_b32 s54, -2, -1
  s_waitcnt vmcnt(0)
  v_cmp_lt_u32 vcc, s54, v172
  s_cbranch_vccnz AT_h1
AT_k1:
  buffer_load_dwordx4 v[172:175], v201, s[8:11], s76 offen sc1
AT_v1:
  s_mov_b32 s69, 0
  s_add_u32 s65, s65, 1
  s_cmp_lt_u32 s65, 131072
  s_cselect_b32 s54, -2, -1
  s_waitcnt vmcnt(0)
  ds_write_b64 v220, v[172:173] offset:4096
  ds_write_b64 v221, v[174:175] offset:4096
  v_max3_u32 v213, v172, v173, v174
  v_max_u32 v213, v213, v175
  v_cmp_lt_u32 vcc, s54, v213
  s_cbranch_vccnz AT_k1
  s_waitcnt lgkmcnt(0)
  s_barrier
  ds_read_b128 v[128:131], v218 offset:4096
  ds_read_b128 v[132:135], v218 offset:4352
  ds_read_b128 v[136:139], v218 offset:4608
  ds_read_b128 v[140:143], v218 offset:4864
  ds_read_b128 v[144:147], v218 offset:5120
  ds_read_b128 v[148:151], v218 offset:5376
  ds_read_b128 v[152:155], v218 offset:5632
  ds_read_b128 v[156:159], v218 offset:5888
  ds_read_b32 v168, v219 offset:4096
  ds_read_b32 v169, v219 offset:4224
  s_add_u32 s77, s77, 2
  v_mov_b32 v212, s77
  s_waitcnt lgkmcnt(9)
  v_mfma_f32_32x32x16_bf16 v[80:95], v[128:131], a[144:147], 0
  s_waitcnt lgkmcnt(8)
  v_mfma_f32_32x32x16_bf16 v[80:95], v[132:135], a[148:151], v[80:95]
  s_waitcnt lgkmcnt(7)
  v_mfma_f32_32x32x16_bf16 v[80:95], v[136:139], a[152:155], v[80:95]
  s_waitcnt lgkmcnt(6)
  v_mfma_f32_32x32x16_bf16 v[80:95], v[140:143], a[156:159], v[80:95]
  s_mov_b64 exec, 1
  buffer_store_dword v212, v201, s[8:11], s71 offen sc1
  s_mov_b64 exec, -1
  s_waitcnt lgkmcnt(5)
  v_mfma_f32_32x32x16_bf16 v[80:95], v[144:147], a[160:163], v[80:95]
  s_waitcnt lgkmcnt(4)
  v_mfma_f32_32x32x16_bf16 v[80:95], v[148:151], a[164:167], v[80:95]
  s_waitcnt lgkmcnt(3)
  v_mfma_f32_32x32x16_bf16 v[80:95], v[152:155], a[168:171], v[80:95]
  s_waitcnt lgkmcnt(2)
  v_mfma_f32_32x32x16_bf16 v[80:95], v[156:159], a[172:175], v[80:95]
  s_nop 11
  v_mul_f32 v80, s68, v80
  v_mul_f32 v81, s68, v81
  v_mul_f32 v82, s68, v82
  v_mul_f32 v83, s68, v83
  v_max3_f32 v84, v184, v80, v81
  v_max3_f32 v84, v84, v82, v83
  v_mov_b32 v85, v84
  s_nop 1
  v_permlane32_swap_b32 v84, v85
  v_max_f32 v84, v84, v85
  v_sub_f32 v86, v184, v84
  v_sub_f32 v80, v80, v84
  v_sub_f32 v81, v81, v84
  v_sub_f32 v82, v82, v84
  v_sub_f32 v83, v83, v84
  v_exp_f32 v86, v86
  v_exp_f32 v80, v80
  v_exp_f32 v81, v81
  v_exp_f32 v82, v82
  v_exp_f32 v83, v83
  v_fma_f32 v186, v186, v86, v80
  v_add_f32 v84, v81, v82
  v_add_f32 v186, v186, v83
  v_add_f32 v186, v186, v84
  v_mov_b32 v187, v186
  s_nop 1
  v_permlane32_swap_b32 v186, v187
  v_add_f32 v186, v186, v187
  v_rcp_f32 v186, v186
  s_nop 0
  v_mul_f32 v86, v86, v186
  v_mul_f32 v80, v186, v80
  v_mul_f32 v81, v186, v81
  v_mul_f32 v82, v186, v82
  v_mul_f32 v83, v186, v83
  v_cvt_pk_bf16_f32 v28, v80, v81
  v_cvt_pk_bf16_f32 v29, v82, v83
  v_mul_f32 v224, v86, v224
  v_mul_f32 v225, v86, v225
  v_mul_f32 v226, v86, v226
  v_mul_f32 v227, v86, v227
  v_mul_f32 v228, v86, v228
  v_mul_f32 v229, v86, v229
  v_mul_f32 v230, v86, v230
  v_mul_f32 v231, v86, v231
  v_mul_f32 v232, v86, v232
  v_mul_f32 v233, v86, v233
  v_mul_f32 v234, v86, v234
  v_mul_f32 v235, v86, v235
  v_mul_f32 v236, v86, v236
  v_mul_f32 v237, v86, v237
  v_mul_f32 v238, v86, v238
  v_mul_f32 v239, v86, v239
  s_waitcnt lgkmcnt(0)
  s_nop 0
  v_mfma_f32_32x32x8_bf16 v[224:239], v[168:169], v[28:29], v[224:239]
  s_nop 11
  v_cvt_pk_bf16_f32 v20, v224, v225
  v_cvt_pk_bf16_f32 v21, v226, v227
  v_cvt_pk_bf16_f32 v22, v228, v229
  v_cvt_pk_bf16_f32 v23, v230, v231
  buffer_store_dwordx4 v[20:23], v201, s[8:11], s75 offen offset:0 sc1
  v_cvt_pk_bf16_f32 v24, v232, v233
  v_cvt_pk_bf16_f32 v25, v234, v235
  v_cvt_pk_bf16_f32 v26, v236, v237
  v_cvt_pk_bf16_f32 v27, v238, v239
  buffer_store_dwordx4 v[24:27], v201, s[8:11], s75 offen offset:1024 sc1
  s_cmp_ge_u32 s77, 64
  s_cbranch_scc1 L_exit
  s_branch AT_loop
L_cexit:
  s_or_b32 s54, s52, s53
  s_cmp_eq_u32 s54, 0
  s_cbranch_scc0 L_nwb
  s_waitcnt vmcnt(0)
  buffer_wbl2 sc1
L_nwb:
L_exit:
L_end:
s_endpgm
.section .rodata,"a"
.p2align 6
.amdhsa_kernel gated_mix__sliding_local_dilated__memory_aug_recurrent_mem_tr__prompt_kernel
  .amdhsa_next_free_vgpr 512
  .amdhsa_next_free_sgpr 102
  .amdhsa_accum_offset 256
  .amdhsa_group_segment_fixed_size 0
  .amdhsa_kernarg_size 112
  .amdhsa_user_sgpr_count 2
  .amdhsa_user_sgpr_kernarg_segment_ptr 1
  .amdhsa_system_sgpr_workgroup_id_x 1
.end_amdhsa_kernel
```
